```python
import torch

def _softmax(x, axis=-1):
    return torch.softmax(x, dim=axis)
def _gelu(x):
    return torch.nn.functional.gelu(x, approximate="tanh")
def _silu(x):
    return torch.nn.functional.silu(x)
def _sigmoid(x):
    return torch.sigmoid(x)
def _layernorm(x, axis=-1, eps=1e-5):
    m = x.mean(dim=axis, keepdim=True)
    v = x.var(dim=axis, keepdim=True, unbiased=False)
    return (x - m) / torch.sqrt(v + eps)
def _scatter_add(tgt, idx, src, axis=0):
    return tgt.clone().index_add_(axis, idx, src)
def _segment_sum(src, seg, n):
    out = torch.zeros((n,) + src.shape[1:], dtype=src.dtype)
    return out.index_add_(0, seg, src)
def _pad(x, pw):
    flat = tuple(v for pair in reversed(pw) for v in pair)
    return torch.nn.functional.pad(x, flat)

kernel_name = 'interleave_layers__sliding_local_dilated__swiglu_ffn__prompt'

def setup_inputs():

    _w = (lambda a: (lambda t: t.to(torch.bfloat16) if t.is_floating_point() else t)(torch.as_tensor(a)))
    def _A_setup():
        B, S, D = 1, 2048, 1024
        return {
            "x": _w((lambda *s: torch.randn(*s, dtype=torch.bfloat16) * 0.05)(B, S, D)),
            "wqkv": _w((lambda *s: torch.randn(*s, dtype=torch.bfloat16) * 0.05)(D, 3 * D)),
            "wo": _w((lambda *s: torch.randn(*s, dtype=torch.bfloat16) * 0.05)(D, D)),
        }
    _A_in = _A_setup()

    def _B_setup():
        B, S, D, F = 1, 2048, 1024, 3584
        return {
            "x": _w((lambda *s: torch.randn(*s, dtype=torch.bfloat16) * 0.05)(B, S, D)),
            "w_gate": _w((lambda *s: torch.randn(*s, dtype=torch.bfloat16) * 0.05)(D, F)),
            "w_up": _w((lambda *s: torch.randn(*s, dtype=torch.bfloat16) * 0.05)(D, F)),
            "w_down": _w((lambda *s: torch.randn(*s, dtype=torch.bfloat16) * 0.05)(F, D)),
        }
    _B_in = _B_setup()

    return {
        "A_x": _A_in["x"],
        "A_wqkv": _A_in["wqkv"],
        "A_wo": _A_in["wo"],
        "B_x": _B_in["x"],
        "B_w_gate": _B_in["w_gate"],
        "B_w_up": _B_in["w_up"],
        "B_w_down": _B_in["w_down"],
    }

def reference(A_x, A_wqkv, A_wo, B_x, B_w_gate, B_w_up, B_w_down):
    def _A_ref(x, wqkv, wo):
        B, S, D = x.shape
        H = 32; Dh = D // H
        W, dil = 8, 2
        qkv = (lambda x, *d: x.permute(*d))((x @ wqkv).reshape(B, S, 3, H, Dh), 2, 0, 3, 1, 4)
        q, k, v = qkv[0], qkv[1], qkv[2]
        scale = Dh ** -0.5
        pos = torch.arange(S)
        off = torch.arange(W) * dil
        idx = pos[:, None] - off[None, :]
        mask = idx >= 0
        idx_c = torch.where(mask, idx, 0).reshape(-1)
        kg = k[:, :, idx_c, :].reshape(B, H, S, W, Dh)
        vg = v[:, :, idx_c, :].reshape(B, H, S, W, Dh)
        logits = torch.einsum("bhsd,bhswd->bhsw", q, kg) * scale
        logits = torch.where(mask[None, None, :, :], logits, -1e9)
        attn = _softmax(logits, axis=-1)
        o = torch.einsum("bhsw,bhswd->bhsd", attn, vg)
        return (lambda x, *d: x.permute(*d))(o, 0, 2, 1, 3).reshape(B, S, D) @ wo

    def _B_ref(x, w_gate, w_up, w_down):
        g = _silu(x @ w_gate)
        u = x @ w_up
        return (g * u) @ w_down

    x = A_x
    x = x + _A_ref(_layernorm(x, axis=-1), A_wqkv, A_wo)
    x = x + _B_ref(_layernorm(x, axis=-1), B_w_gate, B_w_up, B_w_down)
    x = x + _A_ref(_layernorm(x, axis=-1), A_wqkv, A_wo)
    x = x + _B_ref(_layernorm(x, axis=-1), B_w_gate, B_w_up, B_w_down)
    return x
```

```asm
; @launch kernel=pre_kernel grid=(256,1,1) block=(256,1,1) lds=4096
; @launch kernel=qkv1_kernel grid=(256,1,1) block=(256,1,1) lds=143360
; @launch kernel=wo1_kernel grid=(256,1,1) block=(256,1,1) lds=82176
; @launch kernel=gu1_kernel grid=(256,1,1) block=(256,1,1) lds=140288
; @launch kernel=dn1_kernel grid=(256,1,1) block=(256,1,1) lds=82176
; @launch kernel=qkv2_kernel grid=(256,1,1) block=(256,1,1) lds=143360
; @launch kernel=wo2_kernel grid=(256,1,1) block=(256,1,1) lds=82176
; @launch kernel=gu2_kernel grid=(256,1,1) block=(256,1,1) lds=140288
; @launch kernel=dn2_kernel grid=(256,1,1) block=(256,1,1) lds=82176
.amdgcn_target "amdgcn-amd-amdhsa--gfx950"
.text
.globl pre_kernel
.p2align 8
.type pre_kernel,@function
pre_kernel:
    s_cmp_ge_u32 s2, 256
    s_cbranch_scc1 pre_kernel_end
    s_load_dwordx2 s[10:11], s[0:1], 0
    s_load_dwordx2 s[12:13], s[0:1], 72
    s_load_dwordx2 s[14:15], s[0:1], 8
    s_load_dwordx2 s[16:17], s[0:1], 32
    s_load_dwordx2 s[18:19], s[0:1], 40
    v_lshrrev_b32 v2, 6, v0
    v_and_b32 v1, 63, v0
    v_readfirstlane_b32 s3, v2
    s_and_b32 s4, s2, 7
    s_lshr_b32 s5, s2, 3
    s_lshr_b32 s6, s4, 1
    s_lshl_b32 s6, s6, 2
    s_and_b32 s7, s5, 3
    s_add_u32 s6, s6, s7
    s_and_b32 s7, s4, 1
    s_lshl_b32 s7, s7, 3
    s_lshr_b32 s8, s5, 2
    s_add_u32 s7, s7, s8
    s_lshr_b32 s20, s6, 1
    s_lshl_b32 s20, s20, 8
    s_and_b32 s21, s6, 1
    s_add_u32 s20, s20, s21
    s_lshl_b32 s21, s3, 6
    s_add_u32 s20, s20, s21
    s_add_u32 s20, s20, 0
    s_lshl_b32 s20, s20, 11
    s_lshl_b32 s21, s7, 7
    s_add_u32 s20, s20, s21
    v_and_b32 v4, 15, v1
    v_lshlrev_b32 v4, 12, v4
    v_bfe_u32 v6, v1, 4, 1
    v_lshl_add_u32 v4, v6, 5, v4
    v_bfe_u32 v6, v1, 5, 1
    v_lshl_add_u32 v4, v6, 4, v4
    v_add_u32 v4, s20, v4
    v_add_u32 v5, 0x10000, v4
    s_waitcnt lgkmcnt(0)
    s_mov_b32 s24, s10
    s_mov_b32 s25, s11
    s_mov_b32 s26, 4194304
    s_mov_b32 s27, 0x20000
    s_mov_b32 s28, s12
    s_mov_b32 s29, s13
    s_mov_b32 s30, 4194304
    s_mov_b32 s31, 0x20000
    s_add_u32 s32, s12, 58720256
    s_addc_u32 s33, s13, 0
    s_mov_b32 s34, 262144
    s_mov_b32 s35, 0x20000
    buffer_load_dwordx4 v[8:11], v4, s[24:27], 0 offen offset:0
    buffer_load_dwordx4 v[12:15], v4, s[24:27], 0 offen offset:64
    buffer_load_dwordx4 v[16:19], v5, s[24:27], 0 offen offset:0
    buffer_load_dwordx4 v[20:23], v5, s[24:27], 0 offen offset:64
    s_lshl_b32 s20, s7, 18
    s_lshl_b32 s21, s6, 13
    s_add_u32 s20, s20, s21
    s_lshl_b32 s21, s3, 11
    s_add_u32 s20, s20, s21
    s_add_u32 s21, s20, 0x20000
    v_lshlrev_b32 v7, 4, v1
    v_mov_b32 v40, 0
    v_mov_b32 v41, 0
    v_mov_b32 v42, 0
    v_mov_b32 v43, 0
    s_waitcnt vmcnt(3)
    v_permlane16_swap_b32 v8, v10
    v_permlane16_swap_b32 v9, v11
    buffer_store_dwordx4 v[8:11], v7, s[28:31], s20 offen offset:0
    v_lshlrev_b32 v30, 16, v8
    v_and_b32 v31, 0xffff0000, v8
    v_pk_add_f32 v[40:41], v[40:41], v[30:31]
    v_pk_fma_f32 v[42:43], v[30:31], v[30:31], v[42:43]
    v_lshlrev_b32 v30, 16, v9
    v_and_b32 v31, 0xffff0000, v9
    v_pk_add_f32 v[40:41], v[40:41], v[30:31]
    v_pk_fma_f32 v[42:43], v[30:31], v[30:31], v[42:43]
    v_lshlrev_b32 v30, 16, v10
    v_and_b32 v31, 0xffff0000, v10
    v_pk_add_f32 v[40:41], v[40:41], v[30:31]
    v_pk_fma_f32 v[42:43], v[30:31], v[30:31], v[42:43]
    v_lshlrev_b32 v30, 16, v11
    v_and_b32 v31, 0xffff0000, v11
    v_pk_add_f32 v[40:41], v[40:41], v[30:31]
    v_pk_fma_f32 v[42:43], v[30:31], v[30:31], v[42:43]
    s_waitcnt vmcnt(3)
    v_permlane16_swap_b32 v12, v14
    v_permlane16_swap_b32 v13, v15
    buffer_store_dwordx4 v[12:15], v7, s[28:31], s21 offen offset:0
    v_lshlrev_b32 v30, 16, v12
    v_and_b32 v31, 0xffff0000, v12
    v_pk_add_f32 v[40:41], v[40:41], v[30:31]
    v_pk_fma_f32 v[42:43], v[30:31], v[30:31], v[42:43]
    v_lshlrev_b32 v30, 16, v13
    v_and_b32 v31, 0xffff0000, v13
    v_pk_add_f32 v[40:41], v[40:41], v[30:31]
    v_pk_fma_f32 v[42:43], v[30:31], v[30:31], v[42:43]
    v_lshlrev_b32 v30, 16, v14
    v_and_b32 v31, 0xffff0000, v14
    v_pk_add_f32 v[40:41], v[40:41], v[30:31]
    v_pk_fma_f32 v[42:43], v[30:31], v[30:31], v[42:43]
    v_lshlrev_b32 v30, 16, v15
    v_and_b32 v31, 0xffff0000, v15
    v_pk_add_f32 v[40:41], v[40:41], v[30:31]
    v_pk_fma_f32 v[42:43], v[30:31], v[30:31], v[42:43]
    v_add_f32 v40, v40, v41
    v_add_f32 v42, v42, v43
    v_mov_b32 v44, 0
    v_mov_b32 v45, 0
    v_mov_b32 v46, 0
    v_mov_b32 v47, 0
    s_waitcnt vmcnt(3)
    v_permlane16_swap_b32 v16, v18
    v_permlane16_swap_b32 v17, v19
    buffer_store_dwordx4 v[16:19], v7, s[28:31], s20 offen offset:1024
    v_lshlrev_b32 v30, 16, v16
    v_and_b32 v31, 0xffff0000, v16
    v_pk_add_f32 v[44:45], v[44:45], v[30:31]
    v_pk_fma_f32 v[46:47], v[30:31], v[30:31], v[46:47]
    v_lshlrev_b32 v30, 16, v17
    v_and_b32 v31, 0xffff0000, v17
    v_pk_add_f32 v[44:45], v[44:45], v[30:31]
    v_pk_fma_f32 v[46:47], v[30:31], v[30:31], v[46:47]
    v_lshlrev_b32 v30, 16, v18
    v_and_b32 v31, 0xffff0000, v18
    v_pk_add_f32 v[44:45], v[44:45], v[30:31]
    v_pk_fma_f32 v[46:47], v[30:31], v[30:31], v[46:47]
    v_lshlrev_b32 v30, 16, v19
    v_and_b32 v31, 0xffff0000, v19
    v_pk_add_f32 v[44:45], v[44:45], v[30:31]
    v_pk_fma_f32 v[46:47], v[30:31], v[30:31], v[46:47]
    s_waitcnt vmcnt(3)
    v_permlane16_swap_b32 v20, v22
    v_permlane16_swap_b32 v21, v23
    buffer_store_dwordx4 v[20:23], v7, s[28:31], s21 offen offset:1024
    v_lshlrev_b32 v30, 16, v20
    v_and_b32 v31, 0xffff0000, v20
    v_pk_add_f32 v[44:45], v[44:45], v[30:31]
    v_pk_fma_f32 v[46:47], v[30:31], v[30:31], v[46:47]
    v_lshlrev_b32 v30, 16, v21
    v_and_b32 v31, 0xffff0000, v21
    v_pk_add_f32 v[44:45], v[44:45], v[30:31]
    v_pk_fma_f32 v[46:47], v[30:31], v[30:31], v[46:47]
    v_lshlrev_b32 v30, 16, v22
    v_and_b32 v31, 0xffff0000, v22
    v_pk_add_f32 v[44:45], v[44:45], v[30:31]
    v_pk_fma_f32 v[46:47], v[30:31], v[30:31], v[46:47]
    v_lshlrev_b32 v30, 16, v23
    v_and_b32 v31, 0xffff0000, v23
    v_pk_add_f32 v[44:45], v[44:45], v[30:31]
    v_pk_fma_f32 v[46:47], v[30:31], v[30:31], v[46:47]
    v_add_f32 v44, v44, v45
    v_add_f32 v46, v46, v47
    s_nop 0
    v_permlane16_swap_b32 v40, v44
    v_permlane16_swap_b32 v42, v46
    v_add_f32 v40, v40, v44
    v_add_f32 v42, v42, v46
    s_lshl_b32 s22, s7, 14
    s_lshl_b32 s23, s6, 10
    s_add_u32 s22, s22, s23
    s_lshl_b32 s23, s3, 8
    s_add_u32 s22, s22, s23
    v_permlane32_swap_b32 v40, v42
    v_and_b32 v30, 31, v1
    v_lshlrev_b32 v30, 3, v30
    v_lshrrev_b32 v44, 5, v1
    v_lshl_add_u32 v30, v44, 2, v30
    v_add_f32 v40, v40, v42
    buffer_store_dword v40, v30, s[32:35], s22 offen
    s_cmp_ge_u32 s2, 160
    s_cbranch_scc1 pre_kernel_fin
    s_cmp_lt_u32 s2, 104
    s_cselect_b32 s36, s16, s18
    s_cselect_b32 s37, s17, s19
    s_cselect_b32 s40, 48, 104
    s_cmp_lt_u32 s2, 48
    s_cselect_b32 s36, s14, s36
    s_cselect_b32 s37, s15, s37
    s_cselect_b32 s40, 0, s40
    s_movk_i32 s41, 7168
    s_cselect_b32 s41, 6144, s41
    s_lshl_b32 s38, s41, 10
    s_mov_b32 s39, 0x20000
    s_sub_u32 s40, s2, s40
    s_lshl_b32 s40, s40, 7
    s_lshl_b32 s42, s3, 8
    s_mul_i32 s42, s42, s41
    s_add_u32 s40, s40, s42
    s_lshl_b32 s42, s41, 3
    v_lshrrev_b32 v4, 3, v1
    v_mul_lo_u32 v4, v4, s41
    v_and_b32 v5, 7, v1
    v_lshl_add_u32 v4, v5, 4, v4
    buffer_load_dwordx4 v[64:67], v4, s[36:39], s40 offen
    s_add_u32 s40, s40, s42
    buffer_load_dwordx4 v[68:71], v4, s[36:39], s40 offen
    s_add_u32 s40, s40, s42
    buffer_load_dwordx4 v[72:75], v4, s[36:39], s40 offen
    s_add_u32 s40, s40, s42
    buffer_load_dwordx4 v[76:79], v4, s[36:39], s40 offen
    s_add_u32 s40, s40, s42
    buffer_load_dwordx4 v[80:83], v4, s[36:39], s40 offen
    s_add_u32 s40, s40, s42
    buffer_load_dwordx4 v[84:87], v4, s[36:39], s40 offen
    s_add_u32 s40, s40, s42
    buffer_load_dwordx4 v[88:91], v4, s[36:39], s40 offen
    s_add_u32 s40, s40, s42
    buffer_load_dwordx4 v[92:95], v4, s[36:39], s40 offen
    s_add_u32 s40, s40, s42
    buffer_load_dwordx4 v[96:99], v4, s[36:39], s40 offen
    s_add_u32 s40, s40, s42
    buffer_load_dwordx4 v[100:103], v4, s[36:39], s40 offen
    s_add_u32 s40, s40, s42
    buffer_load_dwordx4 v[104:107], v4, s[36:39], s40 offen
    s_add_u32 s40, s40, s42
    buffer_load_dwordx4 v[108:111], v4, s[36:39], s40 offen
    s_add_u32 s40, s40, s42
    buffer_load_dwordx4 v[112:115], v4, s[36:39], s40 offen
    s_add_u32 s40, s40, s42
    buffer_load_dwordx4 v[116:119], v4, s[36:39], s40 offen
    s_add_u32 s40, s40, s42
    buffer_load_dwordx4 v[120:123], v4, s[36:39], s40 offen
    s_add_u32 s40, s40, s42
    buffer_load_dwordx4 v[124:127], v4, s[36:39], s40 offen
    s_add_u32 s40, s40, s42
    buffer_load_dwordx4 v[128:131], v4, s[36:39], s40 offen
    s_add_u32 s40, s40, s42
    buffer_load_dwordx4 v[132:135], v4, s[36:39], s40 offen
    s_add_u32 s40, s40, s42
    buffer_load_dwordx4 v[136:139], v4, s[36:39], s40 offen
    s_add_u32 s40, s40, s42
    buffer_load_dwordx4 v[140:143], v4, s[36:39], s40 offen
    s_add_u32 s40, s40, s42
    buffer_load_dwordx4 v[144:147], v4, s[36:39], s40 offen
    s_add_u32 s40, s40, s42
    buffer_load_dwordx4 v[148:151], v4, s[36:39], s40 offen
    s_add_u32 s40, s40, s42
    buffer_load_dwordx4 v[152:155], v4, s[36:39], s40 offen
    s_add_u32 s40, s40, s42
    buffer_load_dwordx4 v[156:159], v4, s[36:39], s40 offen
    s_add_u32 s40, s40, s42
    buffer_load_dwordx4 v[160:163], v4, s[36:39], s40 offen
    s_add_u32 s40, s40, s42
    buffer_load_dwordx4 v[164:167], v4, s[36:39], s40 offen
    s_add_u32 s40, s40, s42
    buffer_load_dwordx4 v[168:171], v4, s[36:39], s40 offen
    s_add_u32 s40, s40, s42
    buffer_load_dwordx4 v[172:175], v4, s[36:39], s40 offen
    s_add_u32 s40, s40, s42
    buffer_load_dwordx4 v[176:179], v4, s[36:39], s40 offen
    s_add_u32 s40, s40, s42
    buffer_load_dwordx4 v[180:183], v4, s[36:39], s40 offen
    s_add_u32 s40, s40, s42
    buffer_load_dwordx4 v[184:187], v4, s[36:39], s40 offen
    s_add_u32 s40, s40, s42
    buffer_load_dwordx4 v[188:191], v4, s[36:39], s40 offen
    s_add_u32 s40, s40, s42
    v_and_b32 v5, 15, v1
    v_and_b32 v6, 1, v1
    v_lshlrev_b32 v6, 4, v6
    v_mov_b32 v7, 0x3f80
    v_lshlrev_b32 v6, v6, v7
    v_lshrrev_b32 v5, 1, v5
    v_cmp_eq_u32 vcc, 0, v5
    s_nop 1
    v_cndmask_b32 v48, 0, v6, vcc
    v_cmp_eq_u32 vcc, 1, v5
    s_nop 1
    v_cndmask_b32 v49, 0, v6, vcc
    v_cmp_eq_u32 vcc, 2, v5
    s_nop 1
    v_cndmask_b32 v50, 0, v6, vcc
    v_cmp_eq_u32 vcc, 3, v5
    s_nop 1
    v_cndmask_b32 v51, 0, v6, vcc
    s_nop 0
    s_waitcnt vmcnt(31)
    v_mfma_f32_16x16x32_bf16 v[52:55], v[48:51], v[64:67], 0
    s_waitcnt vmcnt(30)
    v_mfma_f32_16x16x32_bf16 v[52:55], v[48:51], v[68:71], v[52:55]
    s_waitcnt vmcnt(29)
    v_mfma_f32_16x16x32_bf16 v[52:55], v[48:51], v[72:75], v[52:55]
    s_waitcnt vmcnt(28)
    v_mfma_f32_16x16x32_bf16 v[52:55], v[48:51], v[76:79], v[52:55]
    s_waitcnt vmcnt(27)
    v_mfma_f32_16x16x32_bf16 v[52:55], v[48:51], v[80:83], v[52:55]
    s_waitcnt vmcnt(26)
    v_mfma_f32_16x16x32_bf16 v[52:55], v[48:51], v[84:87], v[52:55]
    s_waitcnt vmcnt(25)
    v_mfma_f32_16x16x32_bf16 v[52:55], v[48:51], v[88:91], v[52:55]
    s_waitcnt vmcnt(24)
    v_mfma_f32_16x16x32_bf16 v[52:55], v[48:51], v[92:95], v[52:55]
    s_waitcnt vmcnt(23)
    v_mfma_f32_16x16x32_bf16 v[52:55], v[48:51], v[96:99], v[52:55]
    s_waitcnt vmcnt(22)
    v_mfma_f32_16x16x32_bf16 v[52:55], v[48:51], v[100:103], v[52:55]
    s_waitcnt vmcnt(21)
    v_mfma_f32_16x16x32_bf16 v[52:55], v[48:51], v[104:107], v[52:55]
    s_waitcnt vmcnt(20)
    v_mfma_f32_16x16x32_bf16 v[52:55], v[48:51], v[108:111], v[52:55]
    s_waitcnt vmcnt(19)
    v_mfma_f32_16x16x32_bf16 v[52:55], v[48:51], v[112:115], v[52:55]
    s_waitcnt vmcnt(18)
    v_mfma_f32_16x16x32_bf16 v[52:55], v[48:51], v[116:119], v[52:55]
    s_waitcnt vmcnt(17)
    v_mfma_f32_16x16x32_bf16 v[52:55], v[48:51], v[120:123], v[52:55]
    s_waitcnt vmcnt(16)
    v_mfma_f32_16x16x32_bf16 v[52:55], v[48:51], v[124:127], v[52:55]
    s_waitcnt vmcnt(15)
    v_mfma_f32_16x16x32_bf16 v[52:55], v[48:51], v[128:131], v[52:55]
    s_waitcnt vmcnt(14)
    v_mfma_f32_16x16x32_bf16 v[52:55], v[48:51], v[132:135], v[52:55]
    s_waitcnt vmcnt(13)
    v_mfma_f32_16x16x32_bf16 v[52:55], v[48:51], v[136:139], v[52:55]
    s_waitcnt vmcnt(12)
    v_mfma_f32_16x16x32_bf16 v[52:55], v[48:51], v[140:143], v[52:55]
    s_waitcnt vmcnt(11)
    v_mfma_f32_16x16x32_bf16 v[52:55], v[48:51], v[144:147], v[52:55]
    s_waitcnt vmcnt(10)
    v_mfma_f32_16x16x32_bf16 v[52:55], v[48:51], v[148:151], v[52:55]
    s_waitcnt vmcnt(9)
    v_mfma_f32_16x16x32_bf16 v[52:55], v[48:51], v[152:155], v[52:55]
    s_waitcnt vmcnt(8)
    v_mfma_f32_16x16x32_bf16 v[52:55], v[48:51], v[156:159], v[52:55]
    s_waitcnt vmcnt(7)
    v_mfma_f32_16x16x32_bf16 v[52:55], v[48:51], v[160:163], v[52:55]
    s_waitcnt vmcnt(6)
    v_mfma_f32_16x16x32_bf16 v[52:55], v[48:51], v[164:167], v[52:55]
    s_waitcnt vmcnt(5)
    v_mfma_f32_16x16x32_bf16 v[52:55], v[48:51], v[168:171], v[52:55]
    s_waitcnt vmcnt(4)
    v_mfma_f32_16x16x32_bf16 v[52:55], v[48:51], v[172:175], v[52:55]
    s_waitcnt vmcnt(3)
    v_mfma_f32_16x16x32_bf16 v[52:55], v[48:51], v[176:179], v[52:55]
    s_waitcnt vmcnt(2)
    v_mfma_f32_16x16x32_bf16 v[52:55], v[48:51], v[180:183], v[52:55]
    s_waitcnt vmcnt(1)
    v_mfma_f32_16x16x32_bf16 v[52:55], v[48:51], v[184:187], v[52:55]
    s_waitcnt vmcnt(0)
    v_mfma_f32_16x16x32_bf16 v[52:55], v[48:51], v[188:191], v[52:55]
    s_nop 7
    v_add_f32_dpp v56, v52, v52 row_ror:8 row_mask:0xf bank_mask:0xf
    v_add_f32_dpp v57, v53, v53 row_ror:8 row_mask:0xf bank_mask:0xf
    v_add_f32_dpp v58, v54, v54 row_ror:8 row_mask:0xf bank_mask:0xf
    v_add_f32_dpp v59, v55, v55 row_ror:8 row_mask:0xf bank_mask:0xf
    v_and_b32 v5, 7, v1
    v_lshlrev_b32 v5, 5, v5
    v_bfe_u32 v6, v1, 4, 1
    v_lshl_add_u32 v5, v6, 4, v5
    v_bfe_u32 v6, v1, 5, 1
    v_lshl_add_u32 v5, v6, 10, v5
    s_lshl_b32 s42, s3, 8
    v_add_u32 v5, s42, v5
    ds_write_b128 v5, v[56:59]
    s_waitcnt lgkmcnt(0)
    s_barrier
    v_lshlrev_b32 v5, 2, v1
    ds_read_b32 v8, v5 offset:0
    ds_read_b32 v9, v5 offset:256
    ds_read_b32 v10, v5 offset:512
    ds_read_b32 v11, v5 offset:768
    s_add_u32 s44, s12, 60817408
    s_addc_u32 s45, s13, 0
    s_mov_b32 s46, 40960
    s_mov_b32 s47, 0x20000
    s_waitcnt lgkmcnt(2)
    v_add_f32 v8, v8, v9
    s_waitcnt lgkmcnt(0)
    v_add_f32 v10, v10, v11
    v_add_f32 v8, v8, v10
    s_lshl_b32 s42, s2, 8
    buffer_store_dword v8, v5, s[44:47], s42 offen
pre_kernel_fin:
pre_kernel_end:
    s_endpgm
.text
.globl qkv1_kernel
.p2align 8
.type qkv1_kernel,@function
qkv1_kernel:
    s_cmp_ge_u32 s2, 256
    s_cbranch_scc1 qkv1_kernel_end
    s_load_dwordx2 s[10:11], s[0:1], 72
    s_load_dwordx2 s[12:13], s[0:1], 8
    v_lshrrev_b32 v2, 6, v0
    v_and_b32 v1, 63, v0
    v_readfirstlane_b32 s3, v2
    s_and_b32 s4, s2, 7
    s_lshr_b32 s5, s2, 3
    s_and_b32 s6, s4, 1
    s_lshl_b32 s6, s6, 3
    s_and_b32 s7, s5, 7
    s_add_u32 s6, s6, s7
    s_lshr_b32 s7, s4, 1
    s_lshl_b32 s7, s7, 2
    s_lshr_b32 s8, s5, 3
    s_add_u32 s7, s7, s8
    s_and_b32 s8, s3, 1
    s_lshr_b32 s9, s3, 1
    s_lshl_b32 s20, s6, 13
    s_lshl_b32 s21, s3, 11
    s_add_u32 s20, s20, s21
    v_lshl_add_u32 v4, v1, 4, s20
    s_lshl_b32 s16, s6, 3
    s_sub_u32 s16, s16, 9
    s_cmp_lt_u32 s6, 2
    s_cselect_b32 s16, 7, s16
    s_lshl_b32 s20, s16, 10
    s_lshl_b32 s21, s3, 8
    s_add_u32 s20, s20, s21
    s_sub_u32 s20, s20, 2048
    v_lshl_add_u32 v5, v1, 2, s20
    v_bfe_u32 v34, v1, 3, 1
    v_lshrrev_b32 v35, 4, v1
    v_lshl_add_u32 v34, v35, 3, v34
    s_lshl_b32 s21, s3, 1
    v_add_u32 v34, s21, v34
    v_mul_u32_u24 v34, 6144, v34
    v_and_b32 v35, 7, v1
    v_lshl_add_u32 v34, v35, 4, v34
    s_lshl_b32 s21, s7, 7
    v_add_u32 v6, s21, v34
    v_add_u32 v7, 1024, v6
    v_add_u32 v8, 2048, v6
    s_mul_i32 s21, s8, 4608
    v_lshl_add_u32 v10, v1, 4, s21
    v_lshrrev_b32 v34, 4, v1
    v_mul_u32_u24 v34, 2304, v34
    v_and_b32 v35, 15, v1
    v_lshl_add_u32 v12, v35, 4, v34
    v_bfe_u32 v34, v1, 3, 2
    v_mul_u32_u24 v34, 3104, v34
    v_bfe_u32 v35, v1, 2, 1
    v_lshl_add_u32 v34, v35, 7, v34
    v_bfe_u32 v35, v1, 5, 1
    v_lshl_add_u32 v34, v35, 8, v34
    v_and_b32 v35, 3, v1
    v_lshl_add_u32 v34, v35, 3, v34
    s_lshl_b32 s21, s9, 6
    v_add_u32 v14, s21, v34
    v_add_u32 v11, 64896, v10
    v_add_u32 v13, 64896, v12
    v_add_u32 v15, 64896, v14
    s_mul_i32 s22, s3, 2304
    s_mul_i32 s24, s3, 3104
    s_add_u32 s24, s24, 9216
    s_mov_b32 s23, 0
    s_mov_b32 s25, 0
    s_lshl_b32 s20, s6, 10
    v_lshl_add_u32 v34, v0, 3, s20
    s_lshl_b32 s20, s16, 7
    v_and_b32 v35, 15, v1
    v_lshl_add_u32 v35, v35, 3, s20
    v_cmp_gt_u32 vcc, 128, v0
    s_nop 1
    v_cndmask_b32 v9, v35, v34, vcc
    s_waitcnt lgkmcnt(0)
    s_mov_b32 s28, s10
    s_mov_b32 s29, s11
    s_mov_b32 s30, 4194304
    s_mov_b32 s31, 0x20000
    s_mov_b32 s32, s12
    s_mov_b32 s33, s13
    s_mov_b32 s34, 6291456
    s_mov_b32 s35, 0x20000
    s_add_u32 s36, s10, 58720256
    s_addc_u32 s37, s11, 0
    s_mov_b32 s38, 262144
    s_mov_b32 s39, 0x20000
    s_add_u32 s44, s10, 60817408
    s_addc_u32 s45, s11, 0
    s_mov_b32 s46, 12288
    s_mov_b32 s47, 0x20000
    s_waitcnt lgkmcnt(0)
    s_cmp_eq_u32 s8, 1
    s_cbranch_scc1 qkv1_kernel_t1
    s_add_u32 m0, s24, 0
    s_nop 0
    buffer_load_dwordx4 v6, s[32:35], s25 offen lds
    buffer_load_dwordx4 v7, s[32:35], s25 offen offset:1024 lds
    buffer_load_dwordx4 v8, s[32:35], s25 offen offset:2048 lds
    s_add_u32 s25, s25, 196608
    s_add_u32 m0, s22, 0
    s_nop 0
    buffer_load_dwordx4 v4, s[28:31], s23 offen lds
    buffer_load_dwordx4 v4, s[28:31], s23 offen offset:1024 lds
    buffer_load_dword v5, s[28:31], s23 offen offset:2048 lds
    s_add_u32 s23, s23, 0x20000
    s_mov_b32 s26, 0
    buffer_load_dwordx2 v[48:49], v9, s[36:39], s26 offen
    s_mov_b32 s26, 16384
    buffer_load_dwordx2 v[50:51], v9, s[36:39], s26 offen
    s_mov_b32 s26, 32768
    buffer_load_dwordx2 v[52:53], v9, s[36:39], s26 offen
    s_mov_b32 s26, 49152
    buffer_load_dwordx2 v[54:55], v9, s[36:39], s26 offen
    s_mov_b32 s26, 65536
    buffer_load_dwordx2 v[56:57], v9, s[36:39], s26 offen
    s_mov_b32 s26, 81920
    buffer_load_dwordx2 v[58:59], v9, s[36:39], s26 offen
    s_mov_b32 s26, 98304
    buffer_load_dwordx2 v[60:61], v9, s[36:39], s26 offen
    s_mov_b32 s26, 114688
    buffer_load_dwordx2 v[62:63], v9, s[36:39], s26 offen
    s_mov_b32 s26, 131072
    buffer_load_dwordx2 v[64:65], v9, s[36:39], s26 offen
    s_mov_b32 s26, 147456
    buffer_load_dwordx2 v[66:67], v9, s[36:39], s26 offen
    s_mov_b32 s26, 163840
    buffer_load_dwordx2 v[68:69], v9, s[36:39], s26 offen
    s_mov_b32 s26, 180224
    buffer_load_dwordx2 v[70:71], v9, s[36:39], s26 offen
    s_mov_b32 s26, 196608
    buffer_load_dwordx2 v[72:73], v9, s[36:39], s26 offen
    s_mov_b32 s26, 212992
    buffer_load_dwordx2 v[74:75], v9, s[36:39], s26 offen
    s_mov_b32 s26, 229376
    buffer_load_dwordx2 v[76:77], v9, s[36:39], s26 offen
    s_mov_b32 s26, 245760
    buffer_load_dwordx2 v[78:79], v9, s[36:39], s26 offen
    s_add_u32 m0, s24, 21632
    s_nop 0
    buffer_load_dwordx4 v6, s[32:35], s25 offen lds
    buffer_load_dwordx4 v7, s[32:35], s25 offen offset:1024 lds
    buffer_load_dwordx4 v8, s[32:35], s25 offen offset:2048 lds
    s_add_u32 s25, s25, 196608
    s_add_u32 m0, s22, 21632
    s_nop 0
    buffer_load_dwordx4 v4, s[28:31], s23 offen lds
    buffer_load_dwordx4 v4, s[28:31], s23 offen offset:1024 lds
    buffer_load_dword v5, s[28:31], s23 offen offset:2048 lds
    s_add_u32 s23, s23, 0x20000
    s_add_u32 m0, s24, 43264
    s_nop 0
    buffer_load_dwordx4 v6, s[32:35], s25 offen lds
    buffer_load_dwordx4 v7, s[32:35], s25 offen offset:1024 lds
    buffer_load_dwordx4 v8, s[32:35], s25 offen offset:2048 lds
    s_add_u32 s25, s25, 196608
    s_add_u32 m0, s22, 43264
    s_nop 0
    buffer_load_dwordx4 v4, s[28:31], s23 offen lds
    buffer_load_dwordx4 v4, s[28:31], s23 offen offset:1024 lds
    buffer_load_dword v5, s[28:31], s23 offen offset:2048 lds
    s_add_u32 s23, s23, 0x20000
    s_add_u32 m0, s24, 64896
    s_nop 0
    buffer_load_dwordx4 v6, s[32:35], s25 offen lds
    buffer_load_dwordx4 v7, s[32:35], s25 offen offset:1024 lds
    buffer_load_dwordx4 v8, s[32:35], s25 offen offset:2048 lds
    s_add_u32 s25, s25, 196608
    s_add_u32 m0, s22, 64896
    s_nop 0
    buffer_load_dwordx4 v4, s[28:31], s23 offen lds
    buffer_load_dwordx4 v4, s[28:31], s23 offen offset:1024 lds
    buffer_load_dword v5, s[28:31], s23 offen offset:2048 lds
    s_add_u32 s23, s23, 0x20000
    s_add_u32 m0, s24, 86528
    s_nop 0
    buffer_load_dwordx4 v6, s[32:35], s25 offen lds
    buffer_load_dwordx4 v7, s[32:35], s25 offen offset:1024 lds
    buffer_load_dwordx4 v8, s[32:35], s25 offen offset:2048 lds
    s_add_u32 s25, s25, 196608
    s_add_u32 m0, s22, 86528
    s_nop 0
    buffer_load_dwordx4 v4, s[28:31], s23 offen lds
    buffer_load_dwordx4 v4, s[28:31], s23 offen offset:1024 lds
    buffer_load_dword v5, s[28:31], s23 offen offset:2048 lds
    s_add_u32 s23, s23, 0x20000
    s_add_u32 m0, s24, 108160
    s_nop 0
    buffer_load_dwordx4 v6, s[32:35], s25 offen lds
    buffer_load_dwordx4 v7, s[32:35], s25 offen offset:1024 lds
    buffer_load_dwordx4 v8, s[32:35], s25 offen offset:2048 lds
    s_add_u32 s25, s25, 196608
    s_add_u32 m0, s22, 108160
    s_nop 0
    buffer_load_dwordx4 v4, s[28:31], s23 offen lds
    buffer_load_dwordx4 v4, s[28:31], s23 offen offset:1024 lds
    buffer_load_dword v5, s[28:31], s23 offen offset:2048 lds
    s_add_u32 s23, s23, 0x20000
    s_lshl_b32 s20, s7, 8
    s_lshl_b32 s21, s9, 7
    s_add_u32 s20, s20, s21
    s_add_u32 s21, s20, 4096
    s_add_u32 s26, s20, 8192
    v_lshrrev_b32 v34, 4, v1
    v_lshlrev_b32 v34, 4, v34
    v_and_b32 v35, 15, v1
    v_lshlrev_b32 v35, 2, v35
    buffer_load_dwordx4 v[16:19], v34, s[44:47], s20 offen offset:0
    buffer_load_dwordx4 v[20:23], v34, s[44:47], s20 offen offset:64
    buffer_load_dwordx4 v[24:27], v34, s[44:47], s21 offen offset:0
    buffer_load_dwordx4 v[28:31], v34, s[44:47], s21 offen offset:64
    buffer_load_dword v32, v35, s[44:47], s26 offen offset:0
    buffer_load_dword v33, v35, s[44:47], s26 offen offset:64
    s_add_u32 s40, s10, 4194304
    s_addc_u32 s41, s11, 0
    s_mov_b32 s42, 4194304
    s_mov_b32 s43, 0x20000
    v_lshrrev_b32 v34, 4, v1
    v_lshlrev_b32 v34, 2, v34
    v_and_b32 v35, 15, v1
    v_sub_u32 v34, v35, v34
    v_mov_b32 v35, 0xf149f2ca
    v_subrev_u32 v44, 0, v34
    v_cmp_gt_u32 vcc, 8, v44
    s_nop 1
    v_cndmask_b32 v40, v35, 0, vcc
    v_cmp_gt_i32 vcc, -8, v44
    s_nop 1
    v_cndmask_b32 v36, v35, 0, vcc
    v_subrev_u32 v44, 1, v34
    v_cmp_gt_u32 vcc, 8, v44
    s_nop 1
    v_cndmask_b32 v41, v35, 0, vcc
    v_cmp_gt_i32 vcc, -8, v44
    s_nop 1
    v_cndmask_b32 v37, v35, 0, vcc
    v_subrev_u32 v44, 2, v34
    v_cmp_gt_u32 vcc, 8, v44
    s_nop 1
    v_cndmask_b32 v42, v35, 0, vcc
    v_cmp_gt_i32 vcc, -8, v44
    s_nop 1
    v_cndmask_b32 v38, v35, 0, vcc
    v_subrev_u32 v44, 3, v34
    v_cmp_gt_u32 vcc, 8, v44
    s_nop 1
    v_cndmask_b32 v43, v35, 0, vcc
    v_cmp_gt_i32 vcc, -8, v44
    s_nop 1
    v_cndmask_b32 v39, v35, 0, vcc
    s_cmp_lt_u32 s6, 2
    s_cselect_b64 vcc, -1, 0
    v_cndmask_b32 v44, v36, v35, vcc
    v_cndmask_b32 v45, v37, v35, vcc
    v_cndmask_b32 v46, v38, v35, vcc
    v_cndmask_b32 v47, v39, v35, vcc
    s_waitcnt vmcnt(52)
    s_barrier
    ds_read_b64_tr_b16 a[20:21], v14 offset:9216
    ds_read_b64_tr_b16 a[22:23], v14 offset:9728
    ds_read_b64_tr_b16 a[24:25], v14 offset:9248
    ds_read_b64_tr_b16 a[26:27], v14 offset:9760
    ds_read_b64_tr_b16 a[28:29], v14 offset:10240
    ds_read_b64_tr_b16 a[30:31], v14 offset:10752
    ds_read_b64_tr_b16 a[32:33], v14 offset:10272
    ds_read_b64_tr_b16 a[34:35], v14 offset:10784
    ds_read_b128 a[0:3], v10 offset:0
    ds_read_b128 a[4:7], v10 offset:1024
    ds_read_b64_tr_b16 a[36:37], v14 offset:11264
    ds_read_b64_tr_b16 a[38:39], v14 offset:11776
    ds_read_b128 a[8:11], v10 offset:2304
    ds_read_b128 a[12:15], v10 offset:3328
    ds_read_b64_tr_b16 a[40:41], v14 offset:11296
    ds_read_b64_tr_b16 a[42:43], v14 offset:11808
    ds_read_b128 a[16:19], v12 offset:2048
    s_waitcnt vmcnt(43)
    v_pk_add_f32 v[48:49], v[48:49], v[64:65]
    s_waitcnt vmcnt(42)
    v_pk_add_f32 v[50:51], v[50:51], v[66:67]
    s_waitcnt vmcnt(41)
    v_pk_add_f32 v[52:53], v[52:53], v[68:69]
    s_waitcnt vmcnt(40)
    v_pk_add_f32 v[54:55], v[54:55], v[70:71]
    s_waitcnt vmcnt(39)
    v_pk_add_f32 v[56:57], v[56:57], v[72:73]
    s_waitcnt vmcnt(38)
    v_pk_add_f32 v[58:59], v[58:59], v[74:75]
    s_waitcnt vmcnt(37)
    v_pk_add_f32 v[60:61], v[60:61], v[76:77]
    s_waitcnt vmcnt(36)
    v_pk_add_f32 v[62:63], v[62:63], v[78:79]
    v_pk_add_f32 v[48:49], v[48:49], v[56:57]
    v_pk_add_f32 v[50:51], v[50:51], v[58:59]
    v_pk_add_f32 v[52:53], v[52:53], v[60:61]
    v_pk_add_f32 v[54:55], v[54:55], v[62:63]
    v_pk_add_f32 v[48:49], v[48:49], v[52:53]
    v_pk_add_f32 v[50:51], v[50:51], v[54:55]
    v_pk_add_f32 v[48:49], v[48:49], v[50:51]
    v_mul_f32 v48, 0xba800000, v48
    v_mul_f32 v49, 0x3a800000, v49
    v_fma_f32 v49, -v48, v48, v49
    v_max_f32 v49, 0, v49
    v_add_f32 v49, 0x3727c5ac, v49
    v_rsq_f32 v50, v49
    s_nop 0
    v_mov_b32 v49, v50
    v_mul_f32 v50, 0x3e8293ee, v50
    v_min_u32 v34, 191, v0
    v_lshlrev_b32 v35, 2, v34
    v_lshlrev_b32 v34, 4, v34
    v_add_u32 v34, 129792, v34
    v_add_u32 v35, 132864, v35
    ds_write_b128 v34, v[48:51]
    ds_write_b32 v35, v48
    ds_write_b32 v35, v49 offset:768
    s_waitcnt lgkmcnt(0)
    v_mov_b32 v48, 0
    v_mov_b32 v49, 0
    v_mov_b32 v50, 0
    v_mov_b32 v51, 0
    v_mov_b32 v52, 0
    v_mov_b32 v53, 0
    v_mov_b32 v54, 0
    v_mov_b32 v55, 0
    v_mov_b32 v56, 0
    v_mov_b32 v57, 0
    v_mov_b32 v58, 0
    v_mov_b32 v59, 0
    v_mov_b32 v60, 0
    v_mov_b32 v61, 0
    v_mov_b32 v62, 0
    v_mov_b32 v63, 0
    v_mov_b32 v64, 0
    v_mov_b32 v65, 0
    v_mov_b32 v66, 0
    v_mov_b32 v67, 0
    v_mov_b32 v68, 0
    v_mov_b32 v69, 0
    v_mov_b32 v70, 0
    v_mov_b32 v71, 0
    v_mov_b32 v72, 0
    v_mov_b32 v73, 0
    v_mov_b32 v74, 0
    v_mov_b32 v75, 0
    v_mov_b32 v76, 0
    v_mov_b32 v77, 0
    v_mov_b32 v78, 0
    v_mov_b32 v79, 0
    v_mov_b32 v80, 0
    v_mov_b32 v81, 0
    v_mov_b32 v82, 0
    v_mov_b32 v83, 0
    v_mov_b32 v84, 0
    v_mov_b32 v85, 0
    v_mov_b32 v86, 0
    v_mov_b32 v87, 0
    v_mov_b32 v88, 0
    v_mov_b32 v89, 0
    v_mov_b32 v90, 0
    v_mov_b32 v91, 0
    v_mov_b32 v92, 0
    v_mov_b32 v93, 0
    v_mov_b32 v94, 0
    v_mov_b32 v95, 0
    v_mov_b32 v96, 0
    v_mov_b32 v97, 0
    v_mov_b32 v98, 0
    v_mov_b32 v99, 0
    v_mov_b32 v100, 0
    v_mov_b32 v101, 0
    v_mov_b32 v102, 0
    v_mov_b32 v103, 0
    v_mov_b32 v104, 0
    v_mov_b32 v105, 0
    v_mov_b32 v106, 0
    v_mov_b32 v107, 0
    v_mov_b32 v108, 0
    v_mov_b32 v109, 0
    v_mov_b32 v110, 0
    v_mov_b32 v111, 0
    v_mov_b32 v112, 0
    v_mov_b32 v113, 0
    v_mov_b32 v114, 0
    v_mov_b32 v115, 0
    v_mov_b32 v116, 0
    v_mov_b32 v117, 0
    v_mov_b32 v118, 0
    v_mov_b32 v119, 0
    v_mov_b32 v120, 0
    v_mov_b32 v121, 0
    v_mov_b32 v122, 0
    v_mov_b32 v123, 0
    v_mov_b32 v124, 0
    v_mov_b32 v125, 0
    v_mov_b32 v126, 0
    v_mov_b32 v127, 0
    v_mov_b32 v128, 0
    v_mov_b32 v129, 0
    v_mov_b32 v130, 0
    v_mov_b32 v131, 0
    v_mov_b32 v132, 0
    v_mov_b32 v133, 0
    v_mov_b32 v134, 0
    v_mov_b32 v135, 0
    v_mov_b32 v136, 0
    v_mov_b32 v137, 0
    v_mov_b32 v138, 0
    v_mov_b32 v139, 0
    v_mov_b32 v140, 0
    v_mov_b32 v141, 0
    v_mov_b32 v142, 0
    v_mov_b32 v143, 0
    v_mov_b32 v144, 0
    v_mov_b32 v145, 0
    v_mov_b32 v146, 0
    v_mov_b32 v147, 0
    v_mov_b32 v148, 0
    v_mov_b32 v149, 0
    v_mov_b32 v150, 0
    v_mov_b32 v151, 0
    s_mov_b32 s48, 4
.p2align 6
qkv1_kernel_t0_loop:
    s_waitcnt lgkmcnt(0)
    s_waitcnt vmcnt(24)
    s_barrier
    v_mfma_f32_16x16x32_bf16 v[48:51], a[20:23], a[0:3], v[48:51]
    ds_read_b64_tr_b16 a[64:65], v14 offset:30848
    v_mfma_f32_16x16x32_bf16 v[52:55], a[20:23], a[4:7], v[52:55]
    ds_read_b64_tr_b16 a[66:67], v14 offset:31360
    s_add_u32 m0, s24, 0
    s_nop 0
    buffer_load_dwordx4 v6, s[32:35], s25 offen lds
    v_mfma_f32_16x16x32_bf16 v[56:59], a[20:23], a[8:11], v[56:59]
    ds_read_b64_tr_b16 a[68:69], v14 offset:30880
    v_mfma_f32_16x16x32_bf16 v[60:63], a[20:23], a[12:15], v[60:63]
    ds_read_b64_tr_b16 a[70:71], v14 offset:31392
    v_mfma_f32_16x16x32_bf16 v[64:67], a[24:27], a[0:3], v[64:67]
    v_mfma_f32_16x16x32_bf16 v[68:71], a[24:27], a[4:7], v[68:71]
    ds_read_b64_tr_b16 a[72:73], v14 offset:31872
    buffer_load_dwordx4 v7, s[32:35], s25 offen offset:1024 lds
    v_mfma_f32_16x16x32_bf16 v[72:75], a[24:27], a[8:11], v[72:75]
    ds_read_b64_tr_b16 a[74:75], v14 offset:32384
    v_mfma_f32_16x16x32_bf16 v[76:79], a[24:27], a[12:15], v[76:79]
    ds_read_b64_tr_b16 a[76:77], v14 offset:31904
    v_mfma_f32_16x16x32_bf16 v[80:83], a[28:31], a[0:3], v[80:83]
    v_mfma_f32_16x16x32_bf16 v[84:87], a[28:31], a[4:7], v[84:87]
    ds_read_b64_tr_b16 a[78:79], v14 offset:32416
    buffer_load_dwordx4 v8, s[32:35], s25 offen offset:2048 lds
    s_add_u32 s25, s25, 196608
    v_mfma_f32_16x16x32_bf16 v[88:91], a[28:31], a[8:11], v[88:91]
    ds_read_b128 a[44:47], v10 offset:21632
    v_mfma_f32_16x16x32_bf16 v[92:95], a[28:31], a[12:15], v[92:95]
    ds_read_b128 a[48:51], v10 offset:22656
    v_mfma_f32_16x16x32_bf16 v[144:147], a[28:31], a[16:19], v[144:147]
    ds_read_b64_tr_b16 a[80:81], v14 offset:32896
    v_mfma_f32_16x16x32_bf16 v[96:99], a[32:35], a[0:3], v[96:99]
    s_add_u32 m0, s22, 0
    s_nop 0
    buffer_load_dwordx4 v4, s[28:31], s23 offen lds
    v_mfma_f32_16x16x32_bf16 v[100:103], a[32:35], a[4:7], v[100:103]
    ds_read_b64_tr_b16 a[82:83], v14 offset:33408
    v_mfma_f32_16x16x32_bf16 v[104:107], a[32:35], a[8:11], v[104:107]
    ds_read_b128 a[52:55], v10 offset:23936
    v_mfma_f32_16x16x32_bf16 v[108:111], a[32:35], a[12:15], v[108:111]
    ds_read_b128 a[56:59], v10 offset:24960
    v_mfma_f32_16x16x32_bf16 v[148:151], a[32:35], a[16:19], v[148:151]
    buffer_load_dwordx4 v4, s[28:31], s23 offen offset:1024 lds
    v_mfma_f32_16x16x32_bf16 v[112:115], a[0:3], a[36:39], v[112:115]
    ds_read_b64_tr_b16 a[84:85], v14 offset:32928
    v_mfma_f32_16x16x32_bf16 v[116:119], a[4:7], a[36:39], v[116:119]
    ds_read_b64_tr_b16 a[86:87], v14 offset:33440
    v_mfma_f32_16x16x32_bf16 v[120:123], a[8:11], a[36:39], v[120:123]
    ds_read_b128 a[60:63], v12 offset:23680
    v_mfma_f32_16x16x32_bf16 v[124:127], a[12:15], a[36:39], v[124:127]
    buffer_load_dword v5, s[28:31], s23 offen offset:2048 lds
    s_add_u32 s23, s23, 0x20000
    v_mfma_f32_16x16x32_bf16 v[128:131], a[0:3], a[40:43], v[128:131]
    v_mfma_f32_16x16x32_bf16 v[132:135], a[4:7], a[40:43], v[132:135]
    v_mfma_f32_16x16x32_bf16 v[136:139], a[8:11], a[40:43], v[136:139]
    v_mfma_f32_16x16x32_bf16 v[140:143], a[12:15], a[40:43], v[140:143]
    s_waitcnt lgkmcnt(0)
    s_waitcnt vmcnt(24)
    s_barrier
    v_mfma_f32_16x16x32_bf16 v[48:51], a[64:67], a[44:47], v[48:51]
    ds_read_b64_tr_b16 a[20:21], v14 offset:52480
    v_mfma_f32_16x16x32_bf16 v[52:55], a[64:67], a[48:51], v[52:55]
    ds_read_b64_tr_b16 a[22:23], v14 offset:52992
    s_add_u32 m0, s24, 21632
    s_nop 0
    buffer_load_dwordx4 v6, s[32:35], s25 offen lds
    v_mfma_f32_16x16x32_bf16 v[56:59], a[64:67], a[52:55], v[56:59]
    ds_read_b64_tr_b16 a[24:25], v14 offset:52512
    v_mfma_f32_16x16x32_bf16 v[60:63], a[64:67], a[56:59], v[60:63]
    ds_read_b64_tr_b16 a[26:27], v14 offset:53024
    v_mfma_f32_16x16x32_bf16 v[64:67], a[68:71], a[44:47], v[64:67]
    v_mfma_f32_16x16x32_bf16 v[68:71], a[68:71], a[48:51], v[68:71]
    ds_read_b64_tr_b16 a[28:29], v14 offset:53504
    buffer_load_dwordx4 v7, s[32:35], s25 offen offset:1024 lds
    v_mfma_f32_16x16x32_bf16 v[72:75], a[68:71], a[52:55], v[72:75]
    ds_read_b64_tr_b16 a[30:31], v14 offset:54016
    v_mfma_f32_16x16x32_bf16 v[76:79], a[68:71], a[56:59], v[76:79]
    ds_read_b64_tr_b16 a[32:33], v14 offset:53536
    v_mfma_f32_16x16x32_bf16 v[80:83], a[72:75], a[44:47], v[80:83]
    v_mfma_f32_16x16x32_bf16 v[84:87], a[72:75], a[48:51], v[84:87]
    ds_read_b64_tr_b16 a[34:35], v14 offset:54048
    buffer_load_dwordx4 v8, s[32:35], s25 offen offset:2048 lds
    s_add_u32 s25, s25, 196608
    v_mfma_f32_16x16x32_bf16 v[88:91], a[72:75], a[52:55], v[88:91]
    ds_read_b128 a[0:3], v10 offset:43264
    v_mfma_f32_16x16x32_bf16 v[92:95], a[72:75], a[56:59], v[92:95]
    ds_read_b128 a[4:7], v10 offset:44288
    v_mfma_f32_16x16x32_bf16 v[144:147], a[72:75], a[60:63], v[144:147]
    ds_read_b64_tr_b16 a[36:37], v14 offset:54528
    v_mfma_f32_16x16x32_bf16 v[96:99], a[76:79], a[44:47], v[96:99]
    s_add_u32 m0, s22, 21632
    s_nop 0
    buffer_load_dwordx4 v4, s[28:31], s23 offen lds
    v_mfma_f32_16x16x32_bf16 v[100:103], a[76:79], a[48:51], v[100:103]
    ds_read_b64_tr_b16 a[38:39], v14 offset:55040
    v_mfma_f32_16x16x32_bf16 v[104:107], a[76:79], a[52:55], v[104:107]
    ds_read_b128 a[8:11], v10 offset:45568
    v_mfma_f32_16x16x32_bf16 v[108:111], a[76:79], a[56:59], v[108:111]
    ds_read_b128 a[12:15], v10 offset:46592
    v_mfma_f32_16x16x32_bf16 v[148:151], a[76:79], a[60:63], v[148:151]
    buffer_load_dwordx4 v4, s[28:31], s23 offen offset:1024 lds
    v_mfma_f32_16x16x32_bf16 v[112:115], a[44:47], a[80:83], v[112:115]
    ds_read_b64_tr_b16 a[40:41], v14 offset:54560
    v_mfma_f32_16x16x32_bf16 v[116:119], a[48:51], a[80:83], v[116:119]
    ds_read_b64_tr_b16 a[42:43], v14 offset:55072
    v_mfma_f32_16x16x32_bf16 v[120:123], a[52:55], a[80:83], v[120:123]
    ds_read_b128 a[16:19], v12 offset:45312
    v_mfma_f32_16x16x32_bf16 v[124:127], a[56:59], a[80:83], v[124:127]
    buffer_load_dword v5, s[28:31], s23 offen offset:2048 lds
    s_add_u32 s23, s23, 0x20000
    v_mfma_f32_16x16x32_bf16 v[128:131], a[44:47], a[84:87], v[128:131]
    v_mfma_f32_16x16x32_bf16 v[132:135], a[48:51], a[84:87], v[132:135]
    v_mfma_f32_16x16x32_bf16 v[136:139], a[52:55], a[84:87], v[136:139]
    v_mfma_f32_16x16x32_bf16 v[140:143], a[56:59], a[84:87], v[140:143]
    s_waitcnt lgkmcnt(0)
    s_waitcnt vmcnt(24)
    s_barrier
    v_mfma_f32_16x16x32_bf16 v[48:51], a[20:23], a[0:3], v[48:51]
    ds_read_b64_tr_b16 a[64:65], v15 offset:9216
    v_mfma_f32_16x16x32_bf16 v[52:55], a[20:23], a[4:7], v[52:55]
    ds_read_b64_tr_b16 a[66:67], v15 offset:9728
    s_add_u32 m0, s24, 43264
    s_nop 0
    buffer_load_dwordx4 v6, s[32:35], s25 offen lds
    v_mfma_f32_16x16x32_bf16 v[56:59], a[20:23], a[8:11], v[56:59]
    ds_read_b64_tr_b16 a[68:69], v15 offset:9248
    v_mfma_f32_16x16x32_bf16 v[60:63], a[20:23], a[12:15], v[60:63]
    ds_read_b64_tr_b16 a[70:71], v15 offset:9760
    v_mfma_f32_16x16x32_bf16 v[64:67], a[24:27], a[0:3], v[64:67]
    v_mfma_f32_16x16x32_bf16 v[68:71], a[24:27], a[4:7], v[68:71]
    ds_read_b64_tr_b16 a[72:73], v15 offset:10240
    buffer_load_dwordx4 v7, s[32:35], s25 offen offset:1024 lds
    v_mfma_f32_16x16x32_bf16 v[72:75], a[24:27], a[8:11], v[72:75]
    ds_read_b64_tr_b16 a[74:75], v15 offset:10752
    v_mfma_f32_16x16x32_bf16 v[76:79], a[24:27], a[12:15], v[76:79]
    ds_read_b64_tr_b16 a[76:77], v15 offset:10272
    v_mfma_f32_16x16x32_bf16 v[80:83], a[28:31], a[0:3], v[80:83]
    v_mfma_f32_16x16x32_bf16 v[84:87], a[28:31], a[4:7], v[84:87]
    ds_read_b64_tr_b16 a[78:79], v15 offset:10784
    buffer_load_dwordx4 v8, s[32:35], s25 offen offset:2048 lds
    s_add_u32 s25, s25, 196608
    v_mfma_f32_16x16x32_bf16 v[88:91], a[28:31], a[8:11], v[88:91]
    ds_read_b128 a[44:47], v11 offset:0
    v_mfma_f32_16x16x32_bf16 v[92:95], a[28:31], a[12:15], v[92:95]
    ds_read_b128 a[48:51], v11 offset:1024
    v_mfma_f32_16x16x32_bf16 v[144:147], a[28:31], a[16:19], v[144:147]
    ds_read_b64_tr_b16 a[80:81], v15 offset:11264
    v_mfma_f32_16x16x32_bf16 v[96:99], a[32:35], a[0:3], v[96:99]
    s_add_u32 m0, s22, 43264
    s_nop 0
    buffer_load_dwordx4 v4, s[28:31], s23 offen lds
    v_mfma_f32_16x16x32_bf16 v[100:103], a[32:35], a[4:7], v[100:103]
    ds_read_b64_tr_b16 a[82:83], v15 offset:11776
    v_mfma_f32_16x16x32_bf16 v[104:107], a[32:35], a[8:11], v[104:107]
    ds_read_b128 a[52:55], v11 offset:2304
    v_mfma_f32_16x16x32_bf16 v[108:111], a[32:35], a[12:15], v[108:111]
    ds_read_b128 a[56:59], v11 offset:3328
    v_mfma_f32_16x16x32_bf16 v[148:151], a[32:35], a[16:19], v[148:151]
    buffer_load_dwordx4 v4, s[28:31], s23 offen offset:1024 lds
    v_mfma_f32_16x16x32_bf16 v[112:115], a[0:3], a[36:39], v[112:115]
    ds_read_b64_tr_b16 a[84:85], v15 offset:11296
    v_mfma_f32_16x16x32_bf16 v[116:119], a[4:7], a[36:39], v[116:119]
    ds_read_b64_tr_b16 a[86:87], v15 offset:11808
    v_mfma_f32_16x16x32_bf16 v[120:123], a[8:11], a[36:39], v[120:123]
    ds_read_b128 a[60:63], v13 offset:2048
    v_mfma_f32_16x16x32_bf16 v[124:127], a[12:15], a[36:39], v[124:127]
    buffer_load_dword v5, s[28:31], s23 offen offset:2048 lds
    s_add_u32 s23, s23, 0x20000
    v_mfma_f32_16x16x32_bf16 v[128:131], a[0:3], a[40:43], v[128:131]
    v_mfma_f32_16x16x32_bf16 v[132:135], a[4:7], a[40:43], v[132:135]
    v_mfma_f32_16x16x32_bf16 v[136:139], a[8:11], a[40:43], v[136:139]
    v_mfma_f32_16x16x32_bf16 v[140:143], a[12:15], a[40:43], v[140:143]
    s_waitcnt lgkmcnt(0)
    s_waitcnt vmcnt(24)
    s_barrier
    v_mfma_f32_16x16x32_bf16 v[48:51], a[64:67], a[44:47], v[48:51]
    ds_read_b64_tr_b16 a[20:21], v15 offset:30848
    v_mfma_f32_16x16x32_bf16 v[52:55], a[64:67], a[48:51], v[52:55]
    ds_read_b64_tr_b16 a[22:23], v15 offset:31360
    s_add_u32 m0, s24, 64896
    s_nop 0
    buffer_load_dwordx4 v6, s[32:35], s25 offen lds
    v_mfma_f32_16x16x32_bf16 v[56:59], a[64:67], a[52:55], v[56:59]
    ds_read_b64_tr_b16 a[24:25], v15 offset:30880
    v_mfma_f32_16x16x32_bf16 v[60:63], a[64:67], a[56:59], v[60:63]
    ds_read_b64_tr_b16 a[26:27], v15 offset:31392
    v_mfma_f32_16x16x32_bf16 v[64:67], a[68:71], a[44:47], v[64:67]
    v_mfma_f32_16x16x32_bf16 v[68:71], a[68:71], a[48:51], v[68:71]
    ds_read_b64_tr_b16 a[28:29], v15 offset:31872
    buffer_load_dwordx4 v7, s[32:35], s25 offen offset:1024 lds
    v_mfma_f32_16x16x32_bf16 v[72:75], a[68:71], a[52:55], v[72:75]
    ds_read_b64_tr_b16 a[30:31], v15 offset:32384
    v_mfma_f32_16x16x32_bf16 v[76:79], a[68:71], a[56:59], v[76:79]
    ds_read_b64_tr_b16 a[32:33], v15 offset:31904
    v_mfma_f32_16x16x32_bf16 v[80:83], a[72:75], a[44:47], v[80:83]
    v_mfma_f32_16x16x32_bf16 v[84:87], a[72:75], a[48:51], v[84:87]
    ds_read_b64_tr_b16 a[34:35], v15 offset:32416
    buffer_load_dwordx4 v8, s[32:35], s25 offen offset:2048 lds
    s_add_u32 s25, s25, 196608
    v_mfma_f32_16x16x32_bf16 v[88:91], a[72:75], a[52:55], v[88:91]
    ds_read_b128 a[0:3], v11 offset:21632
    v_mfma_f32_16x16x32_bf16 v[92:95], a[72:75], a[56:59], v[92:95]
    ds_read_b128 a[4:7], v11 offset:22656
    v_mfma_f32_16x16x32_bf16 v[144:147], a[72:75], a[60:63], v[144:147]
    ds_read_b64_tr_b16 a[36:37], v15 offset:32896
    v_mfma_f32_16x16x32_bf16 v[96:99], a[76:79], a[44:47], v[96:99]
    s_add_u32 m0, s22, 64896
    s_nop 0
    buffer_load_dwordx4 v4, s[28:31], s23 offen lds
    v_mfma_f32_16x16x32_bf16 v[100:103], a[76:79], a[48:51], v[100:103]
    ds_read_b64_tr_b16 a[38:39], v15 offset:33408
    v_mfma_f32_16x16x32_bf16 v[104:107], a[76:79], a[52:55], v[104:107]
    ds_read_b128 a[8:11], v11 offset:23936
    v_mfma_f32_16x16x32_bf16 v[108:111], a[76:79], a[56:59], v[108:111]
    ds_read_b128 a[12:15], v11 offset:24960
    v_mfma_f32_16x16x32_bf16 v[148:151], a[76:79], a[60:63], v[148:151]
    buffer_load_dwordx4 v4, s[28:31], s23 offen offset:1024 lds
    v_mfma_f32_16x16x32_bf16 v[112:115], a[44:47], a[80:83], v[112:115]
    ds_read_b64_tr_b16 a[40:41], v15 offset:32928
    v_mfma_f32_16x16x32_bf16 v[116:119], a[48:51], a[80:83], v[116:119]
    ds_read_b64_tr_b16 a[42:43], v15 offset:33440
    v_mfma_f32_16x16x32_bf16 v[120:123], a[52:55], a[80:83], v[120:123]
    ds_read_b128 a[16:19], v13 offset:23680
    v_mfma_f32_16x16x32_bf16 v[124:127], a[56:59], a[80:83], v[124:127]
    buffer_load_dword v5, s[28:31], s23 offen offset:2048 lds
    s_add_u32 s23, s23, 0x20000
    v_mfma_f32_16x16x32_bf16 v[128:131], a[44:47], a[84:87], v[128:131]
    v_mfma_f32_16x16x32_bf16 v[132:135], a[48:51], a[84:87], v[132:135]
    v_mfma_f32_16x16x32_bf16 v[136:139], a[52:55], a[84:87], v[136:139]
    v_mfma_f32_16x16x32_bf16 v[140:143], a[56:59], a[84:87], v[140:143]
    s_waitcnt lgkmcnt(0)
    s_waitcnt vmcnt(24)
    s_barrier
    v_mfma_f32_16x16x32_bf16 v[48:51], a[20:23], a[0:3], v[48:51]
    ds_read_b64_tr_b16 a[64:65], v15 offset:52480
    v_mfma_f32_16x16x32_bf16 v[52:55], a[20:23], a[4:7], v[52:55]
    ds_read_b64_tr_b16 a[66:67], v15 offset:52992
    s_add_u32 m0, s24, 86528
    s_nop 0
    buffer_load_dwordx4 v6, s[32:35], s25 offen lds
    v_mfma_f32_16x16x32_bf16 v[56:59], a[20:23], a[8:11], v[56:59]
    ds_read_b64_tr_b16 a[68:69], v15 offset:52512
    v_mfma_f32_16x16x32_bf16 v[60:63], a[20:23], a[12:15], v[60:63]
    ds_read_b64_tr_b16 a[70:71], v15 offset:53024
    v_mfma_f32_16x16x32_bf16 v[64:67], a[24:27], a[0:3], v[64:67]
    v_mfma_f32_16x16x32_bf16 v[68:71], a[24:27], a[4:7], v[68:71]
    ds_read_b64_tr_b16 a[72:73], v15 offset:53504
    buffer_load_dwordx4 v7, s[32:35], s25 offen offset:1024 lds
    v_mfma_f32_16x16x32_bf16 v[72:75], a[24:27], a[8:11], v[72:75]
    ds_read_b64_tr_b16 a[74:75], v15 offset:54016
    v_mfma_f32_16x16x32_bf16 v[76:79], a[24:27], a[12:15], v[76:79]
    ds_read_b64_tr_b16 a[76:77], v15 offset:53536
    v_mfma_f32_16x16x32_bf16 v[80:83], a[28:31], a[0:3], v[80:83]
    v_mfma_f32_16x16x32_bf16 v[84:87], a[28:31], a[4:7], v[84:87]
    ds_read_b64_tr_b16 a[78:79], v15 offset:54048
    buffer_load_dwordx4 v8, s[32:35], s25 offen offset:2048 lds
    s_add_u32 s25, s25, 196608
    v_mfma_f32_16x16x32_bf16 v[88:91], a[28:31], a[8:11], v[88:91]
    ds_read_b128 a[44:47], v11 offset:43264
    v_mfma_f32_16x16x32_bf16 v[92:95], a[28:31], a[12:15], v[92:95]
    ds_read_b128 a[48:51], v11 offset:44288
    v_mfma_f32_16x16x32_bf16 v[144:147], a[28:31], a[16:19], v[144:147]
    ds_read_b64_tr_b16 a[80:81], v15 offset:54528
    v_mfma_f32_16x16x32_bf16 v[96:99], a[32:35], a[0:3], v[96:99]
    s_add_u32 m0, s22, 86528
    s_nop 0
    buffer_load_dwordx4 v4, s[28:31], s23 offen lds
    v_mfma_f32_16x16x32_bf16 v[100:103], a[32:35], a[4:7], v[100:103]
    ds_read_b64_tr_b16 a[82:83], v15 offset:55040
    v_mfma_f32_16x16x32_bf16 v[104:107], a[32:35], a[8:11], v[104:107]
    ds_read_b128 a[52:55], v11 offset:45568
    v_mfma_f32_16x16x32_bf16 v[108:111], a[32:35], a[12:15], v[108:111]
    ds_read_b128 a[56:59], v11 offset:46592
    v_mfma_f32_16x16x32_bf16 v[148:151], a[32:35], a[16:19], v[148:151]
    buffer_load_dwordx4 v4, s[28:31], s23 offen offset:1024 lds
    v_mfma_f32_16x16x32_bf16 v[112:115], a[0:3], a[36:39], v[112:115]
    ds_read_b64_tr_b16 a[84:85], v15 offset:54560
    v_mfma_f32_16x16x32_bf16 v[116:119], a[4:7], a[36:39], v[116:119]
    ds_read_b64_tr_b16 a[86:87], v15 offset:55072
    v_mfma_f32_16x16x32_bf16 v[120:123], a[8:11], a[36:39], v[120:123]
    ds_read_b128 a[60:63], v13 offset:45312
    v_mfma_f32_16x16x32_bf16 v[124:127], a[12:15], a[36:39], v[124:127]
    buffer_load_dword v5, s[28:31], s23 offen offset:2048 lds
    s_add_u32 s23, s23, 0x20000
    v_mfma_f32_16x16x32_bf16 v[128:131], a[0:3], a[40:43], v[128:131]
    v_mfma_f32_16x16x32_bf16 v[132:135], a[4:7], a[40:43], v[132:135]
    v_mfma_f32_16x16x32_bf16 v[136:139], a[8:11], a[40:43], v[136:139]
    v_mfma_f32_16x16x32_bf16 v[140:143], a[12:15], a[40:43], v[140:143]
    s_waitcnt lgkmcnt(0)
    s_waitcnt vmcnt(24)
    s_barrier
    v_mfma_f32_16x16x32_bf16 v[48:51], a[64:67], a[44:47], v[48:51]
    ds_read_b64_tr_b16 a[20:21], v14 offset:9216
    v_mfma_f32_16x16x32_bf16 v[52:55], a[64:67], a[48:51], v[52:55]
    ds_read_b64_tr_b16 a[22:23], v14 offset:9728
    s_add_u32 m0, s24, 108160
    s_nop 0
    buffer_load_dwordx4 v6, s[32:35], s25 offen lds
    v_mfma_f32_16x16x32_bf16 v[56:59], a[64:67], a[52:55], v[56:59]
    ds_read_b64_tr_b16 a[24:25], v14 offset:9248
    v_mfma_f32_16x16x32_bf16 v[60:63], a[64:67], a[56:59], v[60:63]
    ds_read_b64_tr_b16 a[26:27], v14 offset:9760
    v_mfma_f32_16x16x32_bf16 v[64:67], a[68:71], a[44:47], v[64:67]
    v_mfma_f32_16x16x32_bf16 v[68:71], a[68:71], a[48:51], v[68:71]
    ds_read_b64_tr_b16 a[28:29], v14 offset:10240
    buffer_load_dwordx4 v7, s[32:35], s25 offen offset:1024 lds
    v_mfma_f32_16x16x32_bf16 v[72:75], a[68:71], a[52:55], v[72:75]
    ds_read_b64_tr_b16 a[30:31], v14 offset:10752
    v_mfma_f32_16x16x32_bf16 v[76:79], a[68:71], a[56:59], v[76:79]
    ds_read_b64_tr_b16 a[32:33], v14 offset:10272
    v_mfma_f32_16x16x32_bf16 v[80:83], a[72:75], a[44:47], v[80:83]
    v_mfma_f32_16x16x32_bf16 v[84:87], a[72:75], a[48:51], v[84:87]
    ds_read_b64_tr_b16 a[34:35], v14 offset:10784
    buffer_load_dwordx4 v8, s[32:35], s25 offen offset:2048 lds
    s_add_u32 s25, s25, 196608
    v_mfma_f32_16x16x32_bf16 v[88:91], a[72:75], a[52:55], v[88:91]
    ds_read_b128 a[0:3], v10 offset:0
    v_mfma_f32_16x16x32_bf16 v[92:95], a[72:75], a[56:59], v[92:95]
    ds_read_b128 a[4:7], v10 offset:1024
    v_mfma_f32_16x16x32_bf16 v[144:147], a[72:75], a[60:63], v[144:147]
    ds_read_b64_tr_b16 a[36:37], v14 offset:11264
    v_mfma_f32_16x16x32_bf16 v[96:99], a[76:79], a[44:47], v[96:99]
    s_add_u32 m0, s22, 108160
    s_nop 0
    buffer_load_dwordx4 v4, s[28:31], s23 offen lds
    v_mfma_f32_16x16x32_bf16 v[100:103], a[76:79], a[48:51], v[100:103]
    ds_read_b64_tr_b16 a[38:39], v14 offset:11776
    v_mfma_f32_16x16x32_bf16 v[104:107], a[76:79], a[52:55], v[104:107]
    ds_read_b128 a[8:11], v10 offset:2304
    v_mfma_f32_16x16x32_bf16 v[108:111], a[76:79], a[56:59], v[108:111]
    ds_read_b128 a[12:15], v10 offset:3328
    v_mfma_f32_16x16x32_bf16 v[148:151], a[76:79], a[60:63], v[148:151]
    buffer_load_dwordx4 v4, s[28:31], s23 offen offset:1024 lds
    v_mfma_f32_16x16x32_bf16 v[112:115], a[44:47], a[80:83], v[112:115]
    ds_read_b64_tr_b16 a[40:41], v14 offset:11296
    v_mfma_f32_16x16x32_bf16 v[116:119], a[48:51], a[80:83], v[116:119]
    ds_read_b64_tr_b16 a[42:43], v14 offset:11808
    v_mfma_f32_16x16x32_bf16 v[120:123], a[52:55], a[80:83], v[120:123]
    ds_read_b128 a[16:19], v12 offset:2048
    v_mfma_f32_16x16x32_bf16 v[124:127], a[56:59], a[80:83], v[124:127]
    buffer_load_dword v5, s[28:31], s23 offen offset:2048 lds
    s_add_u32 s23, s23, 0x20000
    v_mfma_f32_16x16x32_bf16 v[128:131], a[44:47], a[84:87], v[128:131]
    v_mfma_f32_16x16x32_bf16 v[132:135], a[48:51], a[84:87], v[132:135]
    v_mfma_f32_16x16x32_bf16 v[136:139], a[52:55], a[84:87], v[136:139]
    v_mfma_f32_16x16x32_bf16 v[140:143], a[56:59], a[84:87], v[140:143]
    s_sub_u32 s48, s48, 1
    s_cmp_lg_u32 s48, 0
    s_cbranch_scc1 qkv1_kernel_t0_loop
    s_waitcnt lgkmcnt(0)
    s_waitcnt vmcnt(24)
    s_barrier
    v_mfma_f32_16x16x32_bf16 v[48:51], a[20:23], a[0:3], v[48:51]
    ds_read_b64_tr_b16 a[64:65], v14 offset:30848
    v_mfma_f32_16x16x32_bf16 v[52:55], a[20:23], a[4:7], v[52:55]
    ds_read_b64_tr_b16 a[66:67], v14 offset:31360
    s_add_u32 m0, s24, 0
    s_nop 0
    buffer_load_dwordx4 v6, s[32:35], s25 offen lds
    v_mfma_f32_16x16x32_bf16 v[56:59], a[20:23], a[8:11], v[56:59]
    ds_read_b64_tr_b16 a[68:69], v14 offset:30880
    v_mfma_f32_16x16x32_bf16 v[60:63], a[20:23], a[12:15], v[60:63]
    ds_read_b64_tr_b16 a[70:71], v14 offset:31392
    v_mfma_f32_16x16x32_bf16 v[64:67], a[24:27], a[0:3], v[64:67]
    v_mfma_f32_16x16x32_bf16 v[68:71], a[24:27], a[4:7], v[68:71]
    ds_read_b64_tr_b16 a[72:73], v14 offset:31872
    buffer_load_dwordx4 v7, s[32:35], s25 offen offset:1024 lds
    v_mfma_f32_16x16x32_bf16 v[72:75], a[24:27], a[8:11], v[72:75]
    ds_read_b64_tr_b16 a[74:75], v14 offset:32384
    v_mfma_f32_16x16x32_bf16 v[76:79], a[24:27], a[12:15], v[76:79]
    ds_read_b64_tr_b16 a[76:77], v14 offset:31904
    v_mfma_f32_16x16x32_bf16 v[80:83], a[28:31], a[0:3], v[80:83]
    v_mfma_f32_16x16x32_bf16 v[84:87], a[28:31], a[4:7], v[84:87]
    ds_read_b64_tr_b16 a[78:79], v14 offset:32416
    buffer_load_dwordx4 v8, s[32:35], s25 offen offset:2048 lds
    s_add_u32 s25, s25, 196608
    v_mfma_f32_16x16x32_bf16 v[88:91], a[28:31], a[8:11], v[88:91]
    ds_read_b128 a[44:47], v10 offset:21632
    v_mfma_f32_16x16x32_bf16 v[92:95], a[28:31], a[12:15], v[92:95]
    ds_read_b128 a[48:51], v10 offset:22656
    v_mfma_f32_16x16x32_bf16 v[144:147], a[28:31], a[16:19], v[144:147]
    ds_read_b64_tr_b16 a[80:81], v14 offset:32896
    v_mfma_f32_16x16x32_bf16 v[96:99], a[32:35], a[0:3], v[96:99]
    s_add_u32 m0, s22, 0
    s_nop 0
    buffer_load_dwordx4 v4, s[28:31], s23 offen lds
    v_mfma_f32_16x16x32_bf16 v[100:103], a[32:35], a[4:7], v[100:103]
    ds_read_b64_tr_b16 a[82:83], v14 offset:33408
    v_mfma_f32_16x16x32_bf16 v[104:107], a[32:35], a[8:11], v[104:107]
    ds_read_b128 a[52:55], v10 offset:23936
    v_mfma_f32_16x16x32_bf16 v[108:111], a[32:35], a[12:15], v[108:111]
    ds_read_b128 a[56:59], v10 offset:24960
    v_mfma_f32_16x16x32_bf16 v[148:151], a[32:35], a[16:19], v[148:151]
    buffer_load_dwordx4 v4, s[28:31], s23 offen offset:1024 lds
    v_mfma_f32_16x16x32_bf16 v[112:115], a[0:3], a[36:39], v[112:115]
    ds_read_b64_tr_b16 a[84:85], v14 offset:32928
    v_mfma_f32_16x16x32_bf16 v[116:119], a[4:7], a[36:39], v[116:119]
    ds_read_b64_tr_b16 a[86:87], v14 offset:33440
    v_mfma_f32_16x16x32_bf16 v[120:123], a[8:11], a[36:39], v[120:123]
    ds_read_b128 a[60:63], v12 offset:23680
    v_mfma_f32_16x16x32_bf16 v[124:127], a[12:15], a[36:39], v[124:127]
    buffer_load_dword v5, s[28:31], s23 offen offset:2048 lds
    s_add_u32 s23, s23, 0x20000
    v_mfma_f32_16x16x32_bf16 v[128:131], a[0:3], a[40:43], v[128:131]
    v_mfma_f32_16x16x32_bf16 v[132:135], a[4:7], a[40:43], v[132:135]
    v_mfma_f32_16x16x32_bf16 v[136:139], a[8:11], a[40:43], v[136:139]
    v_mfma_f32_16x16x32_bf16 v[140:143], a[12:15], a[40:43], v[140:143]
    s_waitcnt lgkmcnt(0)
    s_waitcnt vmcnt(24)
    s_barrier
    v_mfma_f32_16x16x32_bf16 v[48:51], a[64:67], a[44:47], v[48:51]
    ds_read_b64_tr_b16 a[20:21], v14 offset:52480
    v_mfma_f32_16x16x32_bf16 v[52:55], a[64:67], a[48:51], v[52:55]
    ds_read_b64_tr_b16 a[22:23], v14 offset:52992
    s_add_u32 m0, s24, 21632
    s_nop 0
    buffer_load_dwordx4 v6, s[32:35], s25 offen lds
    v_mfma_f32_16x16x32_bf16 v[56:59], a[64:67], a[52:55], v[56:59]
    ds_read_b64_tr_b16 a[24:25], v14 offset:52512
    v_mfma_f32_16x16x32_bf16 v[60:63], a[64:67], a[56:59], v[60:63]
    ds_read_b64_tr_b16 a[26:27], v14 offset:53024
    v_mfma_f32_16x16x32_bf16 v[64:67], a[68:71], a[44:47], v[64:67]
    v_mfma_f32_16x16x32_bf16 v[68:71], a[68:71], a[48:51], v[68:71]
    ds_read_b64_tr_b16 a[28:29], v14 offset:53504
    buffer_load_dwordx4 v7, s[32:35], s25 offen offset:1024 lds
    v_mfma_f32_16x16x32_bf16 v[72:75], a[68:71], a[52:55], v[72:75]
    ds_read_b64_tr_b16 a[30:31], v14 offset:54016
    v_mfma_f32_16x16x32_bf16 v[76:79], a[68:71], a[56:59], v[76:79]
    ds_read_b64_tr_b16 a[32:33], v14 offset:53536
    v_mfma_f32_16x16x32_bf16 v[80:83], a[72:75], a[44:47], v[80:83]
    v_mfma_f32_16x16x32_bf16 v[84:87], a[72:75], a[48:51], v[84:87]
    ds_read_b64_tr_b16 a[34:35], v14 offset:54048
    buffer_load_dwordx4 v8, s[32:35], s25 offen offset:2048 lds
    s_add_u32 s25, s25, 196608
    v_mfma_f32_16x16x32_bf16 v[88:91], a[72:75], a[52:55], v[88:91]
    ds_read_b128 a[0:3], v10 offset:43264
    v_mfma_f32_16x16x32_bf16 v[92:95], a[72:75], a[56:59], v[92:95]
    ds_read_b128 a[4:7], v10 offset:44288
    v_mfma_f32_16x16x32_bf16 v[144:147], a[72:75], a[60:63], v[144:147]
    ds_read_b64_tr_b16 a[36:37], v14 offset:54528
    v_mfma_f32_16x16x32_bf16 v[96:99], a[76:79], a[44:47], v[96:99]
    s_add_u32 m0, s22, 21632
    s_nop 0
    buffer_load_dwordx4 v4, s[28:31], s23 offen lds
    v_mfma_f32_16x16x32_bf16 v[100:103], a[76:79], a[48:51], v[100:103]
    ds_read_b64_tr_b16 a[38:39], v14 offset:55040
    v_mfma_f32_16x16x32_bf16 v[104:107], a[76:79], a[52:55], v[104:107]
    ds_read_b128 a[8:11], v10 offset:45568
    v_mfma_f32_16x16x32_bf16 v[108:111], a[76:79], a[56:59], v[108:111]
    ds_read_b128 a[12:15], v10 offset:46592
    v_mfma_f32_16x16x32_bf16 v[148:151], a[76:79], a[60:63], v[148:151]
    buffer_load_dwordx4 v4, s[28:31], s23 offen offset:1024 lds
    v_mfma_f32_16x16x32_bf16 v[112:115], a[44:47], a[80:83], v[112:115]
    ds_read_b64_tr_b16 a[40:41], v14 offset:54560
    v_mfma_f32_16x16x32_bf16 v[116:119], a[48:51], a[80:83], v[116:119]
    ds_read_b64_tr_b16 a[42:43], v14 offset:55072
    v_mfma_f32_16x16x32_bf16 v[120:123], a[52:55], a[80:83], v[120:123]
    ds_read_b128 a[16:19], v12 offset:45312
    v_mfma_f32_16x16x32_bf16 v[124:127], a[56:59], a[80:83], v[124:127]
    buffer_load_dword v5, s[28:31], s23 offen offset:2048 lds
    s_add_u32 s23, s23, 0x20000
    v_mfma_f32_16x16x32_bf16 v[128:131], a[44:47], a[84:87], v[128:131]
    v_mfma_f32_16x16x32_bf16 v[132:135], a[48:51], a[84:87], v[132:135]
    v_mfma_f32_16x16x32_bf16 v[136:139], a[52:55], a[84:87], v[136:139]
    v_mfma_f32_16x16x32_bf16 v[140:143], a[56:59], a[84:87], v[140:143]
    s_waitcnt lgkmcnt(0)
    s_waitcnt vmcnt(24)
    s_barrier
    v_mfma_f32_16x16x32_bf16 v[48:51], a[20:23], a[0:3], v[48:51]
    ds_read_b64_tr_b16 a[64:65], v15 offset:9216
    v_mfma_f32_16x16x32_bf16 v[52:55], a[20:23], a[4:7], v[52:55]
    ds_read_b64_tr_b16 a[66:67], v15 offset:9728
    v_mfma_f32_16x16x32_bf16 v[56:59], a[20:23], a[8:11], v[56:59]
    ds_read_b64_tr_b16 a[68:69], v15 offset:9248
    v_mfma_f32_16x16x32_bf16 v[60:63], a[20:23], a[12:15], v[60:63]
    ds_read_b64_tr_b16 a[70:71], v15 offset:9760
    v_mfma_f32_16x16x32_bf16 v[64:67], a[24:27], a[0:3], v[64:67]
    v_mfma_f32_16x16x32_bf16 v[68:71], a[24:27], a[4:7], v[68:71]
    ds_read_b64_tr_b16 a[72:73], v15 offset:10240
    v_mfma_f32_16x16x32_bf16 v[72:75], a[24:27], a[8:11], v[72:75]
    ds_read_b64_tr_b16 a[74:75], v15 offset:10752
    v_mfma_f32_16x16x32_bf16 v[76:79], a[24:27], a[12:15], v[76:79]
    ds_read_b64_tr_b16 a[76:77], v15 offset:10272
    v_mfma_f32_16x16x32_bf16 v[80:83], a[28:31], a[0:3], v[80:83]
    v_mfma_f32_16x16x32_bf16 v[84:87], a[28:31], a[4:7], v[84:87]
    ds_read_b64_tr_b16 a[78:79], v15 offset:10784
    v_mfma_f32_16x16x32_bf16 v[88:91], a[28:31], a[8:11], v[88:91]
    ds_read_b128 a[44:47], v11 offset:0
    v_mfma_f32_16x16x32_bf16 v[92:95], a[28:31], a[12:15], v[92:95]
    ds_read_b128 a[48:51], v11 offset:1024
    v_mfma_f32_16x16x32_bf16 v[144:147], a[28:31], a[16:19], v[144:147]
    ds_read_b64_tr_b16 a[80:81], v15 offset:11264
    v_mfma_f32_16x16x32_bf16 v[96:99], a[32:35], a[0:3], v[96:99]
    v_mfma_f32_16x16x32_bf16 v[100:103], a[32:35], a[4:7], v[100:103]
    ds_read_b64_tr_b16 a[82:83], v15 offset:11776
    v_mfma_f32_16x16x32_bf16 v[104:107], a[32:35], a[8:11], v[104:107]
    ds_read_b128 a[52:55], v11 offset:2304
    v_mfma_f32_16x16x32_bf16 v[108:111], a[32:35], a[12:15], v[108:111]
    ds_read_b128 a[56:59], v11 offset:3328
    v_mfma_f32_16x16x32_bf16 v[148:151], a[32:35], a[16:19], v[148:151]
    v_mfma_f32_16x16x32_bf16 v[112:115], a[0:3], a[36:39], v[112:115]
    ds_read_b64_tr_b16 a[84:85], v15 offset:11296
    v_mfma_f32_16x16x32_bf16 v[116:119], a[4:7], a[36:39], v[116:119]
    ds_read_b64_tr_b16 a[86:87], v15 offset:11808
    v_mfma_f32_16x16x32_bf16 v[120:123], a[8:11], a[36:39], v[120:123]
    ds_read_b128 a[60:63], v13 offset:2048
    v_mfma_f32_16x16x32_bf16 v[124:127], a[12:15], a[36:39], v[124:127]
    v_mfma_f32_16x16x32_bf16 v[128:131], a[0:3], a[40:43], v[128:131]
    v_mfma_f32_16x16x32_bf16 v[132:135], a[4:7], a[40:43], v[132:135]
    v_mfma_f32_16x16x32_bf16 v[136:139], a[8:11], a[40:43], v[136:139]
    v_mfma_f32_16x16x32_bf16 v[140:143], a[12:15], a[40:43], v[140:143]
    s_waitcnt lgkmcnt(0)
    s_waitcnt vmcnt(18)
    s_barrier
    v_mfma_f32_16x16x32_bf16 v[48:51], a[64:67], a[44:47], v[48:51]
    ds_read_b64_tr_b16 a[20:21], v15 offset:30848
    v_mfma_f32_16x16x32_bf16 v[52:55], a[64:67], a[48:51], v[52:55]
    ds_read_b64_tr_b16 a[22:23], v15 offset:31360
    v_mfma_f32_16x16x32_bf16 v[56:59], a[64:67], a[52:55], v[56:59]
    ds_read_b64_tr_b16 a[24:25], v15 offset:30880
    v_mfma_f32_16x16x32_bf16 v[60:63], a[64:67], a[56:59], v[60:63]
    ds_read_b64_tr_b16 a[26:27], v15 offset:31392
    v_mfma_f32_16x16x32_bf16 v[64:67], a[68:71], a[44:47], v[64:67]
    v_mfma_f32_16x16x32_bf16 v[68:71], a[68:71], a[48:51], v[68:71]
    ds_read_b64_tr_b16 a[28:29], v15 offset:31872
    v_mfma_f32_16x16x32_bf16 v[72:75], a[68:71], a[52:55], v[72:75]
    ds_read_b64_tr_b16 a[30:31], v15 offset:32384
    v_mfma_f32_16x16x32_bf16 v[76:79], a[68:71], a[56:59], v[76:79]
    ds_read_b64_tr_b16 a[32:33], v15 offset:31904
    v_mfma_f32_16x16x32_bf16 v[80:83], a[72:75], a[44:47], v[80:83]
    v_mfma_f32_16x16x32_bf16 v[84:87], a[72:75], a[48:51], v[84:87]
    ds_read_b64_tr_b16 a[34:35], v15 offset:32416
    v_mfma_f32_16x16x32_bf16 v[88:91], a[72:75], a[52:55], v[88:91]
    ds_read_b128 a[0:3], v11 offset:21632
    v_mfma_f32_16x16x32_bf16 v[92:95], a[72:75], a[56:59], v[92:95]
    ds_read_b128 a[4:7], v11 offset:22656
    v_mfma_f32_16x16x32_bf16 v[144:147], a[72:75], a[60:63], v[144:147]
    ds_read_b64_tr_b16 a[36:37], v15 offset:32896
    v_mfma_f32_16x16x32_bf16 v[96:99], a[76:79], a[44:47], v[96:99]
    v_mfma_f32_16x16x32_bf16 v[100:103], a[76:79], a[48:51], v[100:103]
    ds_read_b64_tr_b16 a[38:39], v15 offset:33408
    v_mfma_f32_16x16x32_bf16 v[104:107], a[76:79], a[52:55], v[104:107]
    ds_read_b128 a[8:11], v11 offset:23936
    v_mfma_f32_16x16x32_bf16 v[108:111], a[76:79], a[56:59], v[108:111]
    ds_read_b128 a[12:15], v11 offset:24960
    v_mfma_f32_16x16x32_bf16 v[148:151], a[76:79], a[60:63], v[148:151]
    v_mfma_f32_16x16x32_bf16 v[112:115], a[44:47], a[80:83], v[112:115]
    ds_read_b64_tr_b16 a[40:41], v15 offset:32928
    v_mfma_f32_16x16x32_bf16 v[116:119], a[48:51], a[80:83], v[116:119]
    ds_read_b64_tr_b16 a[42:43], v15 offset:33440
    v_mfma_f32_16x16x32_bf16 v[120:123], a[52:55], a[80:83], v[120:123]
    ds_read_b128 a[16:19], v13 offset:23680
    v_mfma_f32_16x16x32_bf16 v[124:127], a[56:59], a[80:83], v[124:127]
    v_mfma_f32_16x16x32_bf16 v[128:131], a[44:47], a[84:87], v[128:131]
    v_mfma_f32_16x16x32_bf16 v[132:135], a[48:51], a[84:87], v[132:135]
    v_mfma_f32_16x16x32_bf16 v[136:139], a[52:55], a[84:87], v[136:139]
    v_mfma_f32_16x16x32_bf16 v[140:143], a[56:59], a[84:87], v[140:143]
    s_waitcnt lgkmcnt(0)
    s_waitcnt vmcnt(12)
    s_barrier
    v_mfma_f32_16x16x32_bf16 v[48:51], a[20:23], a[0:3], v[48:51]
    ds_read_b64_tr_b16 a[64:65], v15 offset:52480
    v_mfma_f32_16x16x32_bf16 v[52:55], a[20:23], a[4:7], v[52:55]
    ds_read_b64_tr_b16 a[66:67], v15 offset:52992
    v_mfma_f32_16x16x32_bf16 v[56:59], a[20:23], a[8:11], v[56:59]
    ds_read_b64_tr_b16 a[68:69], v15 offset:52512
    v_mfma_f32_16x16x32_bf16 v[60:63], a[20:23], a[12:15], v[60:63]
    ds_read_b64_tr_b16 a[70:71], v15 offset:53024
    v_mfma_f32_16x16x32_bf16 v[64:67], a[24:27], a[0:3], v[64:67]
    v_mfma_f32_16x16x32_bf16 v[68:71], a[24:27], a[4:7], v[68:71]
    ds_read_b64_tr_b16 a[72:73], v15 offset:53504
    v_mfma_f32_16x16x32_bf16 v[72:75], a[24:27], a[8:11], v[72:75]
    ds_read_b64_tr_b16 a[74:75], v15 offset:54016
    v_mfma_f32_16x16x32_bf16 v[76:79], a[24:27], a[12:15], v[76:79]
    ds_read_b64_tr_b16 a[76:77], v15 offset:53536
    v_mfma_f32_16x16x32_bf16 v[80:83], a[28:31], a[0:3], v[80:83]
    v_mfma_f32_16x16x32_bf16 v[84:87], a[28:31], a[4:7], v[84:87]
    ds_read_b64_tr_b16 a[78:79], v15 offset:54048
    v_mfma_f32_16x16x32_bf16 v[88:91], a[28:31], a[8:11], v[88:91]
    ds_read_b128 a[44:47], v11 offset:43264
    v_mfma_f32_16x16x32_bf16 v[92:95], a[28:31], a[12:15], v[92:95]
    ds_read_b128 a[48:51], v11 offset:44288
    v_mfma_f32_16x16x32_bf16 v[144:147], a[28:31], a[16:19], v[144:147]
    ds_read_b64_tr_b16 a[80:81], v15 offset:54528
    v_mfma_f32_16x16x32_bf16 v[96:99], a[32:35], a[0:3], v[96:99]
    v_mfma_f32_16x16x32_bf16 v[100:103], a[32:35], a[4:7], v[100:103]
    ds_read_b64_tr_b16 a[82:83], v15 offset:55040
    v_mfma_f32_16x16x32_bf16 v[104:107], a[32:35], a[8:11], v[104:107]
    ds_read_b128 a[52:55], v11 offset:45568
    v_mfma_f32_16x16x32_bf16 v[108:111], a[32:35], a[12:15], v[108:111]
    ds_read_b128 a[56:59], v11 offset:46592
    v_mfma_f32_16x16x32_bf16 v[148:151], a[32:35], a[16:19], v[148:151]
    v_mfma_f32_16x16x32_bf16 v[112:115], a[0:3], a[36:39], v[112:115]
    ds_read_b64_tr_b16 a[84:85], v15 offset:54560
    v_mfma_f32_16x16x32_bf16 v[116:119], a[4:7], a[36:39], v[116:119]
    ds_read_b64_tr_b16 a[86:87], v15 offset:55072
    v_mfma_f32_16x16x32_bf16 v[120:123], a[8:11], a[36:39], v[120:123]
    ds_read_b128 a[60:63], v13 offset:45312
    v_mfma_f32_16x16x32_bf16 v[124:127], a[12:15], a[36:39], v[124:127]
    v_mfma_f32_16x16x32_bf16 v[128:131], a[0:3], a[40:43], v[128:131]
    v_mfma_f32_16x16x32_bf16 v[132:135], a[4:7], a[40:43], v[132:135]
    v_mfma_f32_16x16x32_bf16 v[136:139], a[8:11], a[40:43], v[136:139]
    v_mfma_f32_16x16x32_bf16 v[140:143], a[12:15], a[40:43], v[140:143]
    s_waitcnt lgkmcnt(0)
    s_waitcnt vmcnt(6)
    s_barrier
    v_mfma_f32_16x16x32_bf16 v[48:51], a[64:67], a[44:47], v[48:51]
    ds_read_b64_tr_b16 a[20:21], v14 offset:9216
    v_mfma_f32_16x16x32_bf16 v[52:55], a[64:67], a[48:51], v[52:55]
    ds_read_b64_tr_b16 a[22:23], v14 offset:9728
    v_mfma_f32_16x16x32_bf16 v[56:59], a[64:67], a[52:55], v[56:59]
    ds_read_b64_tr_b16 a[24:25], v14 offset:9248
    v_mfma_f32_16x16x32_bf16 v[60:63], a[64:67], a[56:59], v[60:63]
    ds_read_b64_tr_b16 a[26:27], v14 offset:9760
    v_mfma_f32_16x16x32_bf16 v[64:67], a[68:71], a[44:47], v[64:67]
    v_mfma_f32_16x16x32_bf16 v[68:71], a[68:71], a[48:51], v[68:71]
    ds_read_b64_tr_b16 a[28:29], v14 offset:10240
    v_mfma_f32_16x16x32_bf16 v[72:75], a[68:71], a[52:55], v[72:75]
    ds_read_b64_tr_b16 a[30:31], v14 offset:10752
    v_mfma_f32_16x16x32_bf16 v[76:79], a[68:71], a[56:59], v[76:79]
    ds_read_b64_tr_b16 a[32:33], v14 offset:10272
    v_mfma_f32_16x16x32_bf16 v[80:83], a[72:75], a[44:47], v[80:83]
    v_mfma_f32_16x16x32_bf16 v[84:87], a[72:75], a[48:51], v[84:87]
    ds_read_b64_tr_b16 a[34:35], v14 offset:10784
    v_mfma_f32_16x16x32_bf16 v[88:91], a[72:75], a[52:55], v[88:91]
    ds_read_b128 a[0:3], v10 offset:0
    v_mfma_f32_16x16x32_bf16 v[92:95], a[72:75], a[56:59], v[92:95]
    ds_read_b128 a[4:7], v10 offset:1024
    v_mfma_f32_16x16x32_bf16 v[144:147], a[72:75], a[60:63], v[144:147]
    ds_read_b64_tr_b16 a[36:37], v14 offset:11264
    v_mfma_f32_16x16x32_bf16 v[96:99], a[76:79], a[44:47], v[96:99]
    v_mfma_f32_16x16x32_bf16 v[100:103], a[76:79], a[48:51], v[100:103]
    ds_read_b64_tr_b16 a[38:39], v14 offset:11776
    v_mfma_f32_16x16x32_bf16 v[104:107], a[76:79], a[52:55], v[104:107]
    ds_read_b128 a[8:11], v10 offset:2304
    v_mfma_f32_16x16x32_bf16 v[108:111], a[76:79], a[56:59], v[108:111]
    ds_read_b128 a[12:15], v10 offset:3328
    v_mfma_f32_16x16x32_bf16 v[148:151], a[76:79], a[60:63], v[148:151]
    v_mfma_f32_16x16x32_bf16 v[112:115], a[44:47], a[80:83], v[112:115]
    ds_read_b64_tr_b16 a[40:41], v14 offset:11296
    v_mfma_f32_16x16x32_bf16 v[116:119], a[48:51], a[80:83], v[116:119]
    ds_read_b64_tr_b16 a[42:43], v14 offset:11808
    v_mfma_f32_16x16x32_bf16 v[120:123], a[52:55], a[80:83], v[120:123]
    ds_read_b128 a[16:19], v12 offset:2048
    v_mfma_f32_16x16x32_bf16 v[124:127], a[56:59], a[80:83], v[124:127]
    v_mfma_f32_16x16x32_bf16 v[128:131], a[44:47], a[84:87], v[128:131]
    v_mfma_f32_16x16x32_bf16 v[132:135], a[48:51], a[84:87], v[132:135]
    v_mfma_f32_16x16x32_bf16 v[136:139], a[52:55], a[84:87], v[136:139]
    v_mfma_f32_16x16x32_bf16 v[140:143], a[56:59], a[84:87], v[140:143]
    s_waitcnt lgkmcnt(0)
    s_waitcnt vmcnt(0)
    s_barrier
    v_mfma_f32_16x16x32_bf16 v[48:51], a[20:23], a[0:3], v[48:51]
    ds_read_b64_tr_b16 a[64:65], v14 offset:30848
    v_mfma_f32_16x16x32_bf16 v[52:55], a[20:23], a[4:7], v[52:55]
    ds_read_b64_tr_b16 a[66:67], v14 offset:31360
    v_mfma_f32_16x16x32_bf16 v[56:59], a[20:23], a[8:11], v[56:59]
    ds_read_b64_tr_b16 a[68:69], v14 offset:30880
    v_mfma_f32_16x16x32_bf16 v[60:63], a[20:23], a[12:15], v[60:63]
    ds_read_b64_tr_b16 a[70:71], v14 offset:31392
    v_mfma_f32_16x16x32_bf16 v[64:67], a[24:27], a[0:3], v[64:67]
    v_mfma_f32_16x16x32_bf16 v[68:71], a[24:27], a[4:7], v[68:71]
    ds_read_b64_tr_b16 a[72:73], v14 offset:31872
    v_mfma_f32_16x16x32_bf16 v[72:75], a[24:27], a[8:11], v[72:75]
    ds_read_b64_tr_b16 a[74:75], v14 offset:32384
    v_mfma_f32_16x16x32_bf16 v[76:79], a[24:27], a[12:15], v[76:79]
    ds_read_b64_tr_b16 a[76:77], v14 offset:31904
    v_mfma_f32_16x16x32_bf16 v[80:83], a[28:31], a[0:3], v[80:83]
    v_mfma_f32_16x16x32_bf16 v[84:87], a[28:31], a[4:7], v[84:87]
    ds_read_b64_tr_b16 a[78:79], v14 offset:32416
    v_mfma_f32_16x16x32_bf16 v[88:91], a[28:31], a[8:11], v[88:91]
    ds_read_b128 a[44:47], v10 offset:21632
    v_mfma_f32_16x16x32_bf16 v[92:95], a[28:31], a[12:15], v[92:95]
    ds_read_b128 a[48:51], v10 offset:22656
    v_mfma_f32_16x16x32_bf16 v[144:147], a[28:31], a[16:19], v[144:147]
    ds_read_b64_tr_b16 a[80:81], v14 offset:32896
    v_mfma_f32_16x16x32_bf16 v[96:99], a[32:35], a[0:3], v[96:99]
    v_mfma_f32_16x16x32_bf16 v[100:103], a[32:35], a[4:7], v[100:103]
    ds_read_b64_tr_b16 a[82:83], v14 offset:33408
    v_mfma_f32_16x16x32_bf16 v[104:107], a[32:35], a[8:11], v[104:107]
    ds_read_b128 a[52:55], v10 offset:23936
    v_mfma_f32_16x16x32_bf16 v[108:111], a[32:35], a[12:15], v[108:111]
    ds_read_b128 a[56:59], v10 offset:24960
    v_mfma_f32_16x16x32_bf16 v[148:151], a[32:35], a[16:19], v[148:151]
    v_mfma_f32_16x16x32_bf16 v[112:115], a[0:3], a[36:39], v[112:115]
    ds_read_b64_tr_b16 a[84:85], v14 offset:32928
    v_mfma_f32_16x16x32_bf16 v[116:119], a[4:7], a[36:39], v[116:119]
    ds_read_b64_tr_b16 a[86:87], v14 offset:33440
    v_mfma_f32_16x16x32_bf16 v[120:123], a[8:11], a[36:39], v[120:123]
    ds_read_b128 a[60:63], v12 offset:23680
    v_mfma_f32_16x16x32_bf16 v[124:127], a[12:15], a[36:39], v[124:127]
    v_mfma_f32_16x16x32_bf16 v[128:131], a[0:3], a[40:43], v[128:131]
    v_mfma_f32_16x16x32_bf16 v[132:135], a[4:7], a[40:43], v[132:135]
    v_mfma_f32_16x16x32_bf16 v[136:139], a[8:11], a[40:43], v[136:139]
    v_mfma_f32_16x16x32_bf16 v[140:143], a[12:15], a[40:43], v[140:143]
    s_waitcnt lgkmcnt(0)
    v_mfma_f32_16x16x32_bf16 v[48:51], a[64:67], a[44:47], v[48:51]
    v_mfma_f32_16x16x32_bf16 v[52:55], a[64:67], a[48:51], v[52:55]
    v_mfma_f32_16x16x32_bf16 v[56:59], a[64:67], a[52:55], v[56:59]
    v_mfma_f32_16x16x32_bf16 v[60:63], a[64:67], a[56:59], v[60:63]
    v_mfma_f32_16x16x32_bf16 v[64:67], a[68:71], a[44:47], v[64:67]
    v_mfma_f32_16x16x32_bf16 v[68:71], a[68:71], a[48:51], v[68:71]
    v_mfma_f32_16x16x32_bf16 v[72:75], a[68:71], a[52:55], v[72:75]
    v_mfma_f32_16x16x32_bf16 v[76:79], a[68:71], a[56:59], v[76:79]
    v_mfma_f32_16x16x32_bf16 v[80:83], a[72:75], a[44:47], v[80:83]
    v_mfma_f32_16x16x32_bf16 v[84:87], a[72:75], a[48:51], v[84:87]
    v_mfma_f32_16x16x32_bf16 v[88:91], a[72:75], a[52:55], v[88:91]
    v_mfma_f32_16x16x32_bf16 v[92:95], a[72:75], a[56:59], v[92:95]
    v_mfma_f32_16x16x32_bf16 v[144:147], a[72:75], a[60:63], v[144:147]
    v_mfma_f32_16x16x32_bf16 v[96:99], a[76:79], a[44:47], v[96:99]
    v_mfma_f32_16x16x32_bf16 v[100:103], a[76:79], a[48:51], v[100:103]
    v_mfma_f32_16x16x32_bf16 v[104:107], a[76:79], a[52:55], v[104:107]
    v_mfma_f32_16x16x32_bf16 v[108:111], a[76:79], a[56:59], v[108:111]
    v_mfma_f32_16x16x32_bf16 v[148:151], a[76:79], a[60:63], v[148:151]
    v_mfma_f32_16x16x32_bf16 v[112:115], a[44:47], a[80:83], v[112:115]
    v_mfma_f32_16x16x32_bf16 v[116:119], a[48:51], a[80:83], v[116:119]
    v_mfma_f32_16x16x32_bf16 v[120:123], a[52:55], a[80:83], v[120:123]
    v_mfma_f32_16x16x32_bf16 v[124:127], a[56:59], a[80:83], v[124:127]
    v_mfma_f32_16x16x32_bf16 v[128:131], a[44:47], a[84:87], v[128:131]
    v_mfma_f32_16x16x32_bf16 v[132:135], a[48:51], a[84:87], v[132:135]
    v_mfma_f32_16x16x32_bf16 v[136:139], a[52:55], a[84:87], v[136:139]
    v_mfma_f32_16x16x32_bf16 v[140:143], a[56:59], a[84:87], v[140:143]
    v_and_b32 v6, 15, v1
    v_lshlrev_b32 v6, 4, v6
    v_add_u32 v6, 129792, v6
    v_lshrrev_b32 v7, 4, v1
    v_lshlrev_b32 v7, 4, v7
    v_add_u32 v7, 132864, v7
    s_lshl_b32 s20, s3, 11
    s_add_u32 s20, s20, 135168
    v_lshl_add_u32 v8, v1, 4, s20
    v_xor_b32 v9, 2048, v8
    ds_read_b128 v[216:219], v6 offset:0
    ds_read_b128 v[220:223], v6 offset:256
    ds_read_b128 v[224:227], v6 offset:512
    ds_read_b128 v[228:231], v6 offset:768
    ds_read_b128 v[232:235], v6 offset:2048
    v_mov_b32 v244, 0x3f803f80
    v_mov_b32 v245, 0x3f803f80
    v_mov_b32 v246, 0x3f803f80
    v_mov_b32 v247, 0x3f803f80
    s_waitcnt lgkmcnt(1)
    v_pk_fma_f32 v[92:93], v[24:25], v[228:229], v[92:93] op_sel_hi:[1,0,1]
    v_pk_mul_f32 v[92:93], v[92:93], v[228:229] op_sel:[0,1] op_sel_hi:[1,1]
    v_cvt_pk_bf16_f32 v192, v92, v93
    v_pk_fma_f32 v[94:95], v[26:27], v[228:229], v[94:95] op_sel_hi:[1,0,1]
    v_pk_mul_f32 v[94:95], v[94:95], v[228:229] op_sel:[0,1] op_sel_hi:[1,1]
    v_cvt_pk_bf16_f32 v193, v94, v95
    v_pk_fma_f32 v[108:109], v[28:29], v[228:229], v[108:109] op_sel_hi:[1,0,1]
    v_pk_mul_f32 v[108:109], v[108:109], v[228:229] op_sel:[0,1] op_sel_hi:[1,1]
    v_cvt_pk_bf16_f32 v194, v108, v109
    v_pk_fma_f32 v[110:111], v[30:31], v[228:229], v[110:111] op_sel_hi:[1,0,1]
    v_pk_mul_f32 v[110:111], v[110:111], v[228:229] op_sel:[0,1] op_sel_hi:[1,1]
    v_cvt_pk_bf16_f32 v195, v110, v111
    ds_read_b128 v[236:239], v7 offset:192
    ds_read_b128 v[240:243], v7 offset:960
    s_waitcnt lgkmcnt(1)
    v_pk_fma_f32 v[124:125], v[236:237], v[32:33], v[124:125] op_sel_hi:[1,0,1]
    s_waitcnt lgkmcnt(0)
    v_pk_mul_f32 v[124:125], v[124:125], v[240:241]
    v_cvt_pk_bf16_f32 v204, v124, v125
    v_pk_fma_f32 v[126:127], v[238:239], v[32:33], v[126:127] op_sel_hi:[1,0,1]
    v_pk_mul_f32 v[126:127], v[126:127], v[242:243]
    v_cvt_pk_bf16_f32 v205, v126, v127
    v_pk_fma_f32 v[140:141], v[236:237], v[32:33], v[140:141] op_sel:[0,1,0] op_sel_hi:[1,1,1]
    v_pk_mul_f32 v[140:141], v[140:141], v[240:241]
    v_cvt_pk_bf16_f32 v214, v140, v141
    v_pk_fma_f32 v[142:143], v[238:239], v[32:33], v[142:143] op_sel:[0,1,0] op_sel_hi:[1,1,1]
    v_pk_mul_f32 v[142:143], v[142:143], v[242:243]
    v_cvt_pk_bf16_f32 v215, v142, v143
    ds_write_b128 v8, v[192:195]
    ds_write_b64 v8, v[204:205] offset:1024
    ds_write_b64 v8, v[214:215] offset:1032
    v_pk_fma_f32 v[144:145], v[24:25], v[232:233], v[144:145] op_sel_hi:[1,0,1]
    v_pk_mul_f32 v[144:145], v[144:145], v[232:233] op_sel:[0,1] op_sel_hi:[1,1]
    v_cvt_pk_bf16_f32 v176, v144, v145
    v_pk_fma_f32 v[146:147], v[26:27], v[232:233], v[146:147] op_sel_hi:[1,0,1]
    v_pk_mul_f32 v[146:147], v[146:147], v[232:233] op_sel:[0,1] op_sel_hi:[1,1]
    v_cvt_pk_bf16_f32 v177, v146, v147
    v_pk_fma_f32 v[148:149], v[28:29], v[232:233], v[148:149] op_sel_hi:[1,0,1]
    v_pk_mul_f32 v[148:149], v[148:149], v[232:233] op_sel:[0,1] op_sel_hi:[1,1]
    v_cvt_pk_bf16_f32 v178, v148, v149
    v_pk_fma_f32 v[150:151], v[30:31], v[232:233], v[150:151] op_sel_hi:[1,0,1]
    v_pk_mul_f32 v[150:151], v[150:151], v[232:233] op_sel:[0,1] op_sel_hi:[1,1]
    v_cvt_pk_bf16_f32 v179, v150, v151
    v_pk_fma_f32 v[80:81], v[24:25], v[216:217], v[80:81] op_sel_hi:[1,0,1]
    v_pk_mul_f32 v[80:81], v[80:81], v[216:217] op_sel:[0,1] op_sel_hi:[1,1]
    v_cvt_pk_bf16_f32 v180, v80, v81
    v_pk_fma_f32 v[82:83], v[26:27], v[216:217], v[82:83] op_sel_hi:[1,0,1]
    v_pk_mul_f32 v[82:83], v[82:83], v[216:217] op_sel:[0,1] op_sel_hi:[1,1]
    v_cvt_pk_bf16_f32 v181, v82, v83
    v_pk_fma_f32 v[96:97], v[28:29], v[216:217], v[96:97] op_sel_hi:[1,0,1]
    v_pk_mul_f32 v[96:97], v[96:97], v[216:217] op_sel:[0,1] op_sel_hi:[1,1]
    v_cvt_pk_bf16_f32 v182, v96, v97
    v_pk_fma_f32 v[98:99], v[30:31], v[216:217], v[98:99] op_sel_hi:[1,0,1]
    v_pk_mul_f32 v[98:99], v[98:99], v[216:217] op_sel:[0,1] op_sel_hi:[1,1]
    v_cvt_pk_bf16_f32 v183, v98, v99
    ds_read_b128 v[236:239], v7 offset:0
    ds_read_b128 v[240:243], v7 offset:768
    s_waitcnt lgkmcnt(1)
    v_pk_fma_f32 v[112:113], v[236:237], v[32:33], v[112:113] op_sel_hi:[1,0,1]
    s_waitcnt lgkmcnt(0)
    v_pk_mul_f32 v[112:113], v[112:113], v[240:241]
    v_cvt_pk_bf16_f32 v198, v112, v113
    v_pk_fma_f32 v[114:115], v[238:239], v[32:33], v[114:115] op_sel_hi:[1,0,1]
    v_pk_mul_f32 v[114:115], v[114:115], v[242:243]
    v_cvt_pk_bf16_f32 v199, v114, v115
    v_pk_fma_f32 v[128:129], v[236:237], v[32:33], v[128:129] op_sel:[0,1,0] op_sel_hi:[1,1,1]
    v_pk_mul_f32 v[128:129], v[128:129], v[240:241]
    v_cvt_pk_bf16_f32 v208, v128, v129
    v_pk_fma_f32 v[130:131], v[238:239], v[32:33], v[130:131] op_sel:[0,1,0] op_sel_hi:[1,1,1]
    v_pk_mul_f32 v[130:131], v[130:131], v[242:243]
    v_cvt_pk_bf16_f32 v209, v130, v131
    v_pk_fma_f32 v[84:85], v[24:25], v[220:221], v[84:85] op_sel_hi:[1,0,1]
    v_pk_mul_f32 v[84:85], v[84:85], v[220:221] op_sel:[0,1] op_sel_hi:[1,1]
    v_cvt_pk_bf16_f32 v184, v84, v85
    v_pk_fma_f32 v[86:87], v[26:27], v[220:221], v[86:87] op_sel_hi:[1,0,1]
    v_pk_mul_f32 v[86:87], v[86:87], v[220:221] op_sel:[0,1] op_sel_hi:[1,1]
    v_cvt_pk_bf16_f32 v185, v86, v87
    v_pk_fma_f32 v[100:101], v[28:29], v[220:221], v[100:101] op_sel_hi:[1,0,1]
    v_pk_mul_f32 v[100:101], v[100:101], v[220:221] op_sel:[0,1] op_sel_hi:[1,1]
    v_cvt_pk_bf16_f32 v186, v100, v101
    v_pk_fma_f32 v[102:103], v[30:31], v[220:221], v[102:103] op_sel_hi:[1,0,1]
    v_pk_mul_f32 v[102:103], v[102:103], v[220:221] op_sel:[0,1] op_sel_hi:[1,1]
    v_cvt_pk_bf16_f32 v187, v102, v103
    ds_read_b128 v[236:239], v7 offset:64
    ds_read_b128 v[240:243], v7 offset:832
    s_waitcnt lgkmcnt(1)
    v_pk_fma_f32 v[116:117], v[236:237], v[32:33], v[116:117] op_sel_hi:[1,0,1]
    s_waitcnt lgkmcnt(0)
    v_pk_mul_f32 v[116:117], v[116:117], v[240:241]
    v_cvt_pk_bf16_f32 v200, v116, v117
    v_pk_fma_f32 v[118:119], v[238:239], v[32:33], v[118:119] op_sel_hi:[1,0,1]
    v_pk_mul_f32 v[118:119], v[118:119], v[242:243]
    v_cvt_pk_bf16_f32 v201, v118, v119
    v_pk_fma_f32 v[132:133], v[236:237], v[32:33], v[132:133] op_sel:[0,1,0] op_sel_hi:[1,1,1]
    v_pk_mul_f32 v[132:133], v[132:133], v[240:241]
    v_cvt_pk_bf16_f32 v210, v132, v133
    v_pk_fma_f32 v[134:135], v[238:239], v[32:33], v[134:135] op_sel:[0,1,0] op_sel_hi:[1,1,1]
    v_pk_mul_f32 v[134:135], v[134:135], v[242:243]
    v_cvt_pk_bf16_f32 v211, v134, v135
    v_pk_fma_f32 v[88:89], v[24:25], v[224:225], v[88:89] op_sel_hi:[1,0,1]
    v_pk_mul_f32 v[88:89], v[88:89], v[224:225] op_sel:[0,1] op_sel_hi:[1,1]
    v_cvt_pk_bf16_f32 v188, v88, v89
    v_pk_fma_f32 v[90:91], v[26:27], v[224:225], v[90:91] op_sel_hi:[1,0,1]
    v_pk_mul_f32 v[90:91], v[90:91], v[224:225] op_sel:[0,1] op_sel_hi:[1,1]
    v_cvt_pk_bf16_f32 v189, v90, v91
    v_pk_fma_f32 v[104:105], v[28:29], v[224:225], v[104:105] op_sel_hi:[1,0,1]
    v_pk_mul_f32 v[104:105], v[104:105], v[224:225] op_sel:[0,1] op_sel_hi:[1,1]
    v_cvt_pk_bf16_f32 v190, v104, v105
    v_pk_fma_f32 v[106:107], v[30:31], v[224:225], v[106:107] op_sel_hi:[1,0,1]
    v_pk_mul_f32 v[106:107], v[106:107], v[224:225] op_sel:[0,1] op_sel_hi:[1,1]
    v_cvt_pk_bf16_f32 v191, v106, v107
    ds_read_b128 v[236:239], v7 offset:128
    ds_read_b128 v[240:243], v7 offset:896
    s_waitcnt lgkmcnt(1)
    v_pk_fma_f32 v[120:121], v[236:237], v[32:33], v[120:121] op_sel_hi:[1,0,1]
    s_waitcnt lgkmcnt(0)
    v_pk_mul_f32 v[120:121], v[120:121], v[240:241]
    v_cvt_pk_bf16_f32 v202, v120, v121
    v_pk_fma_f32 v[122:123], v[238:239], v[32:33], v[122:123] op_sel_hi:[1,0,1]
    v_pk_mul_f32 v[122:123], v[122:123], v[242:243]
    v_cvt_pk_bf16_f32 v203, v122, v123
    v_pk_fma_f32 v[136:137], v[236:237], v[32:33], v[136:137] op_sel:[0,1,0] op_sel_hi:[1,1,1]
    v_pk_mul_f32 v[136:137], v[136:137], v[240:241]
    v_cvt_pk_bf16_f32 v212, v136, v137
    v_pk_fma_f32 v[138:139], v[238:239], v[32:33], v[138:139] op_sel:[0,1,0] op_sel_hi:[1,1,1]
    v_pk_mul_f32 v[138:139], v[138:139], v[242:243]
    v_cvt_pk_bf16_f32 v213, v138, v139
    s_waitcnt lgkmcnt(0)
    s_barrier
    ds_read_b64 v[196:197], v9 offset:1024
    ds_read_b64 v[206:207], v9 offset:1032
    v_pk_fma_f32 v[48:49], v[16:17], v[216:217], v[48:49] op_sel_hi:[1,0,1]
    v_pk_mul_f32 v[48:49], v[48:49], v[218:219] op_sel_hi:[1,0]
    v_cvt_pk_bf16_f32 v160, v48, v49
    v_pk_fma_f32 v[50:51], v[18:19], v[216:217], v[50:51] op_sel_hi:[1,0,1]
    v_pk_mul_f32 v[50:51], v[50:51], v[218:219] op_sel_hi:[1,0]
    v_cvt_pk_bf16_f32 v161, v50, v51
    v_pk_fma_f32 v[64:65], v[20:21], v[216:217], v[64:65] op_sel_hi:[1,0,1]
    v_pk_mul_f32 v[64:65], v[64:65], v[218:219] op_sel_hi:[1,0]
    v_cvt_pk_bf16_f32 v162, v64, v65
    v_pk_fma_f32 v[66:67], v[22:23], v[216:217], v[66:67] op_sel_hi:[1,0,1]
    v_pk_mul_f32 v[66:67], v[66:67], v[218:219] op_sel_hi:[1,0]
    v_cvt_pk_bf16_f32 v163, v66, v67
    v_pk_fma_f32 v[52:53], v[16:17], v[220:221], v[52:53] op_sel_hi:[1,0,1]
    v_pk_mul_f32 v[52:53], v[52:53], v[222:223] op_sel_hi:[1,0]
    v_cvt_pk_bf16_f32 v164, v52, v53
    v_pk_fma_f32 v[54:55], v[18:19], v[220:221], v[54:55] op_sel_hi:[1,0,1]
    v_pk_mul_f32 v[54:55], v[54:55], v[222:223] op_sel_hi:[1,0]
    v_cvt_pk_bf16_f32 v165, v54, v55
    v_pk_fma_f32 v[68:69], v[20:21], v[220:221], v[68:69] op_sel_hi:[1,0,1]
    v_pk_mul_f32 v[68:69], v[68:69], v[222:223] op_sel_hi:[1,0]
    v_cvt_pk_bf16_f32 v166, v68, v69
    v_pk_fma_f32 v[70:71], v[22:23], v[220:221], v[70:71] op_sel_hi:[1,0,1]
    v_pk_mul_f32 v[70:71], v[70:71], v[222:223] op_sel_hi:[1,0]
    v_cvt_pk_bf16_f32 v167, v70, v71
    v_pk_fma_f32 v[56:57], v[16:17], v[224:225], v[56:57] op_sel_hi:[1,0,1]
    v_pk_mul_f32 v[56:57], v[56:57], v[226:227] op_sel_hi:[1,0]
    v_cvt_pk_bf16_f32 v168, v56, v57
    v_pk_fma_f32 v[58:59], v[18:19], v[224:225], v[58:59] op_sel_hi:[1,0,1]
    v_pk_mul_f32 v[58:59], v[58:59], v[226:227] op_sel_hi:[1,0]
    v_cvt_pk_bf16_f32 v169, v58, v59
    v_pk_fma_f32 v[72:73], v[20:21], v[224:225], v[72:73] op_sel_hi:[1,0,1]
    v_pk_mul_f32 v[72:73], v[72:73], v[226:227] op_sel_hi:[1,0]
    v_cvt_pk_bf16_f32 v170, v72, v73
    v_pk_fma_f32 v[74:75], v[22:23], v[224:225], v[74:75] op_sel_hi:[1,0,1]
    v_pk_mul_f32 v[74:75], v[74:75], v[226:227] op_sel_hi:[1,0]
    v_cvt_pk_bf16_f32 v171, v74, v75
    v_pk_fma_f32 v[60:61], v[16:17], v[228:229], v[60:61] op_sel_hi:[1,0,1]
    v_pk_mul_f32 v[60:61], v[60:61], v[230:231] op_sel_hi:[1,0]
    v_cvt_pk_bf16_f32 v172, v60, v61
    v_pk_fma_f32 v[62:63], v[18:19], v[228:229], v[62:63] op_sel_hi:[1,0,1]
    v_pk_mul_f32 v[62:63], v[62:63], v[230:231] op_sel_hi:[1,0]
    v_cvt_pk_bf16_f32 v173, v62, v63
    v_pk_fma_f32 v[76:77], v[20:21], v[228:229], v[76:77] op_sel_hi:[1,0,1]
    v_pk_mul_f32 v[76:77], v[76:77], v[230:231] op_sel_hi:[1,0]
    v_cvt_pk_bf16_f32 v174, v76, v77
    v_pk_fma_f32 v[78:79], v[22:23], v[228:229], v[78:79] op_sel_hi:[1,0,1]
    v_pk_mul_f32 v[78:79], v[78:79], v[230:231] op_sel_hi:[1,0]
    v_cvt_pk_bf16_f32 v175, v78, v79
    v_mfma_f32_16x16x32_bf16 v[56:59], v[180:183], v[164:167], v[36:39]
    v_mfma_f32_16x16x32_bf16 v[60:63], v[184:187], v[164:167], v[40:43]
    v_mfma_f32_16x16x32_bf16 v[64:67], v[184:187], v[168:171], v[36:39]
    v_mfma_f32_16x16x32_bf16 v[68:71], v[188:191], v[168:171], v[40:43]
    v_mfma_f32_16x16x32_bf16 v[72:75], v[188:191], v[172:175], v[36:39]
    v_mfma_f32_16x16x32_bf16 v[76:79], v[192:195], v[172:175], v[40:43]
    v_mfma_f32_16x16x32_bf16 v[48:51], v[176:179], v[160:163], v[44:47]
    v_mfma_f32_16x16x32_bf16 v[52:55], v[180:183], v[160:163], v[40:43]
    s_nop 0
    v_max3_f32 v82, v56, v57, v58
    v_max3_f32 v83, v59, v60, v61
    v_max3_f32 v82, v82, v62, v63
    v_max_f32 v82, v82, v83
    v_mov_b32 v83, v82
    v_max3_f32 v84, v64, v65, v66
    v_max3_f32 v85, v67, v68, v69
    v_max3_f32 v84, v84, v70, v71
    v_max_f32 v84, v84, v85
    v_mov_b32 v85, v84
    v_max3_f32 v86, v72, v73, v74
    v_max3_f32 v87, v75, v76, v77
    v_max3_f32 v86, v86, v78, v79
    v_max_f32 v86, v86, v87
    v_mov_b32 v87, v86
    v_max3_f32 v80, v48, v49, v50
    v_max3_f32 v81, v51, v52, v53
    v_max3_f32 v80, v80, v54, v55
    v_max_f32 v80, v80, v81
    v_mov_b32 v81, v80
    v_permlane16_swap_b32 v82, v83
    v_permlane16_swap_b32 v84, v85
    v_permlane16_swap_b32 v86, v87
    v_permlane16_swap_b32 v80, v81
    v_max_f32 v82, v82, v83
    v_mov_b32 v83, v82
    v_max_f32 v84, v84, v85
    v_mov_b32 v85, v84
    v_max_f32 v86, v86, v87
    v_mov_b32 v87, v86
    v_max_f32 v80, v80, v81
    v_mov_b32 v81, v80
    v_permlane32_swap_b32 v82, v83
    v_permlane32_swap_b32 v84, v85
    v_permlane32_swap_b32 v86, v87
    v_permlane32_swap_b32 v80, v81
    v_max_f32 v82, v82, v83
    v_max_f32 v84, v84, v85
    v_max_f32 v86, v86, v87
    v_max_f32 v80, v80, v81
    s_lshl_b32 s20, s7, 1
    s_add_u32 s20, s20, s9
    s_lshl_b32 s20, s20, 17
    s_lshl_b32 s21, s6, 13
    s_add_u32 s20, s20, s21
    s_add_u32 s20, s20, 0
    v_lshlrev_b32 v6, 4, v1
    v_pk_add_f32 v[56:57], v[56:57], v[82:83] op_sel_hi:[1,0] neg_lo:[0,1] neg_hi:[0,1]
    v_pk_add_f32 v[58:59], v[58:59], v[82:83] op_sel_hi:[1,0] neg_lo:[0,1] neg_hi:[0,1]
    v_pk_add_f32 v[60:61], v[60:61], v[82:83] op_sel_hi:[1,0] neg_lo:[0,1] neg_hi:[0,1]
    v_pk_add_f32 v[62:63], v[62:63], v[82:83] op_sel_hi:[1,0] neg_lo:[0,1] neg_hi:[0,1]
    v_exp_f32 v56, v56
    v_exp_f32 v57, v57
    v_exp_f32 v58, v58
    v_exp_f32 v59, v59
    v_exp_f32 v60, v60
    v_exp_f32 v61, v61
    v_exp_f32 v62, v62
    v_exp_f32 v63, v63
    v_cvt_pk_bf16_f32 v92, v56, v57
    v_cvt_pk_bf16_f32 v93, v58, v59
    v_cvt_pk_bf16_f32 v94, v60, v61
    v_cvt_pk_bf16_f32 v95, v62, v63
    s_nop 1
    v_mfma_f32_16x16x32_bf16 v[124:127], v[244:247], v[92:95], 0
    v_mfma_f32_16x16x32_bf16 v[116:119], v[198:201], v[92:95], 0
    v_mfma_f32_16x16x32_bf16 v[120:123], v[208:211], v[92:95], 0
    v_pk_add_f32 v[64:65], v[64:65], v[84:85] op_sel_hi:[1,0] neg_lo:[0,1] neg_hi:[0,1]
    v_pk_add_f32 v[66:67], v[66:67], v[84:85] op_sel_hi:[1,0] neg_lo:[0,1] neg_hi:[0,1]
    v_pk_add_f32 v[68:69], v[68:69], v[84:85] op_sel_hi:[1,0] neg_lo:[0,1] neg_hi:[0,1]
    v_pk_add_f32 v[70:71], v[70:71], v[84:85] op_sel_hi:[1,0] neg_lo:[0,1] neg_hi:[0,1]
    v_exp_f32 v64, v64
    v_exp_f32 v65, v65
    v_exp_f32 v66, v66
    v_exp_f32 v67, v67
    v_exp_f32 v68, v68
    v_exp_f32 v69, v69
    v_exp_f32 v70, v70
    v_exp_f32 v71, v71
    v_cvt_pk_bf16_f32 v96, v64, v65
    v_cvt_pk_bf16_f32 v97, v66, v67
    v_cvt_pk_bf16_f32 v98, v68, v69
    v_cvt_pk_bf16_f32 v99, v70, v71
    s_nop 1
    v_mfma_f32_16x16x32_bf16 v[136:139], v[244:247], v[96:99], 0
    v_mfma_f32_16x16x32_bf16 v[128:131], v[200:203], v[96:99], 0
    v_mfma_f32_16x16x32_bf16 v[132:135], v[210:213], v[96:99], 0
    v_pk_add_f32 v[72:73], v[72:73], v[86:87] op_sel_hi:[1,0] neg_lo:[0,1] neg_hi:[0,1]
    v_pk_add_f32 v[74:75], v[74:75], v[86:87] op_sel_hi:[1,0] neg_lo:[0,1] neg_hi:[0,1]
    v_pk_add_f32 v[76:77], v[76:77], v[86:87] op_sel_hi:[1,0] neg_lo:[0,1] neg_hi:[0,1]
    v_pk_add_f32 v[78:79], v[78:79], v[86:87] op_sel_hi:[1,0] neg_lo:[0,1] neg_hi:[0,1]
    v_exp_f32 v72, v72
    v_exp_f32 v73, v73
    v_exp_f32 v74, v74
    v_exp_f32 v75, v75
    v_exp_f32 v76, v76
    v_exp_f32 v77, v77
    v_exp_f32 v78, v78
    v_exp_f32 v79, v79
    v_cvt_pk_bf16_f32 v100, v72, v73
    v_cvt_pk_bf16_f32 v101, v74, v75
    v_cvt_pk_bf16_f32 v102, v76, v77
    v_cvt_pk_bf16_f32 v103, v78, v79
    s_nop 1
    v_mfma_f32_16x16x32_bf16 v[148:151], v[244:247], v[100:103], 0
    v_mfma_f32_16x16x32_bf16 v[140:143], v[202:205], v[100:103], 0
    v_mfma_f32_16x16x32_bf16 v[144:147], v[212:215], v[100:103], 0
    v_pk_add_f32 v[48:49], v[48:49], v[80:81] op_sel_hi:[1,0] neg_lo:[0,1] neg_hi:[0,1]
    v_pk_add_f32 v[50:51], v[50:51], v[80:81] op_sel_hi:[1,0] neg_lo:[0,1] neg_hi:[0,1]
    v_pk_add_f32 v[52:53], v[52:53], v[80:81] op_sel_hi:[1,0] neg_lo:[0,1] neg_hi:[0,1]
    v_pk_add_f32 v[54:55], v[54:55], v[80:81] op_sel_hi:[1,0] neg_lo:[0,1] neg_hi:[0,1]
    v_exp_f32 v48, v48
    v_exp_f32 v49, v49
    v_exp_f32 v50, v50
    v_exp_f32 v51, v51
    v_exp_f32 v52, v52
    v_exp_f32 v53, v53
    v_exp_f32 v54, v54
    v_exp_f32 v55, v55
    v_cvt_pk_bf16_f32 v88, v48, v49
    v_cvt_pk_bf16_f32 v89, v50, v51
    v_cvt_pk_bf16_f32 v90, v52, v53
    v_cvt_pk_bf16_f32 v91, v54, v55
    s_nop 1
    v_mfma_f32_16x16x32_bf16 v[112:115], v[244:247], v[88:91], 0
    s_waitcnt lgkmcnt(1)
    v_mfma_f32_16x16x32_bf16 v[104:107], v[196:199], v[88:91], 0
    s_waitcnt lgkmcnt(0)
    v_mfma_f32_16x16x32_bf16 v[108:111], v[206:209], v[88:91], 0
    v_rcp_f32 v124, v124
    s_nop 0
    v_pk_mul_f32 v[116:117], v[116:117], v[124:125] op_sel_hi:[1,0]
    v_pk_mul_f32 v[118:119], v[118:119], v[124:125] op_sel_hi:[1,0]
    v_pk_mul_f32 v[120:121], v[120:121], v[124:125] op_sel_hi:[1,0]
    v_pk_mul_f32 v[122:123], v[122:123], v[124:125] op_sel_hi:[1,0]
    v_cvt_pk_bf16_f32 v164, v116, v117
    v_cvt_pk_bf16_f32 v165, v118, v119
    v_cvt_pk_bf16_f32 v166, v120, v121
    v_cvt_pk_bf16_f32 v167, v122, v123
    buffer_store_dwordx4 v[164:167], v6, s[40:43], s20 offen offset:1024
    v_rcp_f32 v136, v136
    s_nop 0
    v_pk_mul_f32 v[128:129], v[128:129], v[136:137] op_sel_hi:[1,0]
    v_pk_mul_f32 v[130:131], v[130:131], v[136:137] op_sel_hi:[1,0]
    v_pk_mul_f32 v[132:133], v[132:133], v[136:137] op_sel_hi:[1,0]
    v_pk_mul_f32 v[134:135], v[134:135], v[136:137] op_sel_hi:[1,0]
    v_cvt_pk_bf16_f32 v168, v128, v129
    v_cvt_pk_bf16_f32 v169, v130, v131
    v_cvt_pk_bf16_f32 v170, v132, v133
    v_cvt_pk_bf16_f32 v171, v134, v135
    buffer_store_dwordx4 v[168:171], v6, s[40:43], s20 offen offset:2048
    v_rcp_f32 v148, v148
    s_nop 0
    v_pk_mul_f32 v[140:141], v[140:141], v[148:149] op_sel_hi:[1,0]
    v_pk_mul_f32 v[142:143], v[142:143], v[148:149] op_sel_hi:[1,0]
    v_pk_mul_f32 v[144:145], v[144:145], v[148:149] op_sel_hi:[1,0]
    v_pk_mul_f32 v[146:147], v[146:147], v[148:149] op_sel_hi:[1,0]
    v_cvt_pk_bf16_f32 v172, v140, v141
    v_cvt_pk_bf16_f32 v173, v142, v143
    v_cvt_pk_bf16_f32 v174, v144, v145
    v_cvt_pk_bf16_f32 v175, v146, v147
    buffer_store_dwordx4 v[172:175], v6, s[40:43], s20 offen offset:3072
    v_rcp_f32 v112, v112
    s_nop 0
    v_pk_mul_f32 v[104:105], v[104:105], v[112:113] op_sel_hi:[1,0]
    v_pk_mul_f32 v[106:107], v[106:107], v[112:113] op_sel_hi:[1,0]
    v_pk_mul_f32 v[108:109], v[108:109], v[112:113] op_sel_hi:[1,0]
    v_pk_mul_f32 v[110:111], v[110:111], v[112:113] op_sel_hi:[1,0]
    v_cvt_pk_bf16_f32 v160, v104, v105
    v_cvt_pk_bf16_f32 v161, v106, v107
    v_cvt_pk_bf16_f32 v162, v108, v109
    v_cvt_pk_bf16_f32 v163, v110, v111
    buffer_store_dwordx4 v[160:163], v6, s[40:43], s20 offen offset:0
    s_endpgm
qkv1_kernel_t1:
    s_add_u32 m0, s24, 0
    s_nop 0
    buffer_load_dwordx4 v6, s[32:35], s25 offen lds
    buffer_load_dwordx4 v7, s[32:35], s25 offen offset:1024 lds
    buffer_load_dwordx4 v8, s[32:35], s25 offen offset:2048 lds
    s_add_u32 s25, s25, 196608
    s_add_u32 m0, s22, 0
    s_nop 0
    buffer_load_dwordx4 v4, s[28:31], s23 offen lds
    buffer_load_dwordx4 v4, s[28:31], s23 offen offset:1024 lds
    buffer_load_dword v5, s[28:31], s23 offen offset:2048 lds
    s_add_u32 s23, s23, 0x20000
    s_mov_b32 s26, 0
    buffer_load_dwordx2 v[48:49], v9, s[36:39], s26 offen
    s_mov_b32 s26, 16384
    buffer_load_dwordx2 v[50:51], v9, s[36:39], s26 offen
    s_mov_b32 s26, 32768
    buffer_load_dwordx2 v[52:53], v9, s[36:39], s26 offen
    s_mov_b32 s26, 49152
    buffer_load_dwordx2 v[54:55], v9, s[36:39], s26 offen
    s_mov_b32 s26, 65536
    buffer_load_dwordx2 v[56:57], v9, s[36:39], s26 offen
    s_mov_b32 s26, 81920
    buffer_load_dwordx2 v[58:59], v9, s[36:39], s26 offen
    s_mov_b32 s26, 98304
    buffer_load_dwordx2 v[60:61], v9, s[36:39], s26 offen
    s_mov_b32 s26, 114688
    buffer_load_dwordx2 v[62:63], v9, s[36:39], s26 offen
    s_mov_b32 s26, 131072
    buffer_load_dwordx2 v[64:65], v9, s[36:39], s26 offen
    s_mov_b32 s26, 147456
    buffer_load_dwordx2 v[66:67], v9, s[36:39], s26 offen
    s_mov_b32 s26, 163840
    buffer_load_dwordx2 v[68:69], v9, s[36:39], s26 offen
    s_mov_b32 s26, 180224
    buffer_load_dwordx2 v[70:71], v9, s[36:39], s26 offen
    s_mov_b32 s26, 196608
    buffer_load_dwordx2 v[72:73], v9, s[36:39], s26 offen
    s_mov_b32 s26, 212992
    buffer_load_dwordx2 v[74:75], v9, s[36:39], s26 offen
    s_mov_b32 s26, 229376
    buffer_load_dwordx2 v[76:77], v9, s[36:39], s26 offen
    s_mov_b32 s26, 245760
    buffer_load_dwordx2 v[78:79], v9, s[36:39], s26 offen
    s_add_u32 m0, s24, 21632
    s_nop 0
    buffer_load_dwordx4 v6, s[32:35], s25 offen lds
    buffer_load_dwordx4 v7, s[32:35], s25 offen offset:1024 lds
    buffer_load_dwordx4 v8, s[32:35], s25 offen offset:2048 lds
    s_add_u32 s25, s25, 196608
    s_add_u32 m0, s22, 21632
    s_nop 0
    buffer_load_dwordx4 v4, s[28:31], s23 offen lds
    buffer_load_dwordx4 v4, s[28:31], s23 offen offset:1024 lds
    buffer_load_dword v5, s[28:31], s23 offen offset:2048 lds
    s_add_u32 s23, s23, 0x20000
    s_add_u32 m0, s24, 43264
    s_nop 0
    buffer_load_dwordx4 v6, s[32:35], s25 offen lds
    buffer_load_dwordx4 v7, s[32:35], s25 offen offset:1024 lds
    buffer_load_dwordx4 v8, s[32:35], s25 offen offset:2048 lds
    s_add_u32 s25, s25, 196608
    s_add_u32 m0, s22, 43264
    s_nop 0
    buffer_load_dwordx4 v4, s[28:31], s23 offen lds
    buffer_load_dwordx4 v4, s[28:31], s23 offen offset:1024 lds
    buffer_load_dword v5, s[28:31], s23 offen offset:2048 lds
    s_add_u32 s23, s23, 0x20000
    s_add_u32 m0, s24, 64896
    s_nop 0
    buffer_load_dwordx4 v6, s[32:35], s25 offen lds
    buffer_load_dwordx4 v7, s[32:35], s25 offen offset:1024 lds
    buffer_load_dwordx4 v8, s[32:35], s25 offen offset:2048 lds
    s_add_u32 s25, s25, 196608
    s_add_u32 m0, s22, 64896
    s_nop 0
    buffer_load_dwordx4 v4, s[28:31], s23 offen lds
    buffer_load_dwordx4 v4, s[28:31], s23 offen offset:1024 lds
    buffer_load_dword v5, s[28:31], s23 offen offset:2048 lds
    s_add_u32 s23, s23, 0x20000
    s_add_u32 m0, s24, 86528
    s_nop 0
    buffer_load_dwordx4 v6, s[32:35], s25 offen lds
    buffer_load_dwordx4 v7, s[32:35], s25 offen offset:1024 lds
    buffer_load_dwordx4 v8, s[32:35], s25 offen offset:2048 lds
    s_add_u32 s25, s25, 196608
    s_add_u32 m0, s22, 86528
    s_nop 0
    buffer_load_dwordx4 v4, s[28:31], s23 offen lds
    buffer_load_dwordx4 v4, s[28:31], s23 offen offset:1024 lds
    buffer_load_dword v5, s[28:31], s23 offen offset:2048 lds
    s_add_u32 s23, s23, 0x20000
    s_add_u32 m0, s24, 108160
    s_nop 0
    buffer_load_dwordx4 v6, s[32:35], s25 offen lds
    buffer_load_dwordx4 v7, s[32:35], s25 offen offset:1024 lds
    buffer_load_dwordx4 v8, s[32:35], s25 offen offset:2048 lds
    s_add_u32 s25, s25, 196608
    s_add_u32 m0, s22, 108160
    s_nop 0
    buffer_load_dwordx4 v4, s[28:31], s23 offen lds
    buffer_load_dwordx4 v4, s[28:31], s23 offen offset:1024 lds
    buffer_load_dword v5, s[28:31], s23 offen offset:2048 lds
    s_add_u32 s23, s23, 0x20000
    s_lshl_b32 s20, s7, 8
    s_lshl_b32 s21, s9, 7
    s_add_u32 s20, s20, s21
    s_add_u32 s21, s20, 4096
    s_add_u32 s26, s20, 8192
    v_lshrrev_b32 v34, 4, v1
    v_lshlrev_b32 v34, 4, v34
    v_and_b32 v35, 15, v1
    v_lshlrev_b32 v35, 2, v35
    buffer_load_dwordx4 v[16:19], v34, s[44:47], s20 offen offset:0
    buffer_load_dwordx4 v[20:23], v34, s[44:47], s20 offen offset:64
    buffer_load_dwordx4 v[24:27], v34, s[44:47], s21 offen offset:0
    buffer_load_dwordx4 v[28:31], v34, s[44:47], s21 offen offset:64
    buffer_load_dword v32, v35, s[44:47], s26 offen offset:0
    buffer_load_dword v33, v35, s[44:47], s26 offen offset:64
    s_add_u32 s40, s10, 4194304
    s_addc_u32 s41, s11, 0
    s_mov_b32 s42, 4194304
    s_mov_b32 s43, 0x20000
    v_lshrrev_b32 v34, 4, v1
    v_lshlrev_b32 v34, 2, v34
    v_and_b32 v35, 15, v1
    v_sub_u32 v34, v35, v34
    v_mov_b32 v35, 0xf149f2ca
    v_subrev_u32 v44, 0, v34
    v_cmp_gt_u32 vcc, 8, v44
    s_nop 1
    v_cndmask_b32 v40, v35, 0, vcc
    v_cmp_gt_i32 vcc, -8, v44
    s_nop 1
    v_cndmask_b32 v36, v35, 0, vcc
    v_subrev_u32 v44, 1, v34
    v_cmp_gt_u32 vcc, 8, v44
    s_nop 1
    v_cndmask_b32 v41, v35, 0, vcc
    v_cmp_gt_i32 vcc, -8, v44
    s_nop 1
    v_cndmask_b32 v37, v35, 0, vcc
    v_subrev_u32 v44, 2, v34
    v_cmp_gt_u32 vcc, 8, v44
    s_nop 1
    v_cndmask_b32 v42, v35, 0, vcc
    v_cmp_gt_i32 vcc, -8, v44
    s_nop 1
    v_cndmask_b32 v38, v35, 0, vcc
    v_subrev_u32 v44, 3, v34
    v_cmp_gt_u32 vcc, 8, v44
    s_nop 1
    v_cndmask_b32 v43, v35, 0, vcc
    v_cmp_gt_i32 vcc, -8, v44
    s_nop 1
    v_cndmask_b32 v39, v35, 0, vcc
    s_waitcnt vmcnt(52)
    s_barrier
    ds_read_b64_tr_b16 a[20:21], v14 offset:9216
    ds_read_b64_tr_b16 a[22:23], v14 offset:9728
    ds_read_b64_tr_b16 a[24:25], v14 offset:9248
    ds_read_b64_tr_b16 a[26:27], v14 offset:9760
    ds_read_b64_tr_b16 a[28:29], v14 offset:10240
    ds_read_b64_tr_b16 a[30:31], v14 offset:10752
    ds_read_b64_tr_b16 a[32:33], v14 offset:10272
    ds_read_b64_tr_b16 a[34:35], v14 offset:10784
    ds_read_b128 a[0:3], v10 offset:0
    ds_read_b128 a[4:7], v10 offset:1024
    ds_read_b64_tr_b16 a[36:37], v14 offset:11264
    ds_read_b64_tr_b16 a[38:39], v14 offset:11776
    ds_read_b128 a[8:11], v10 offset:2304
    ds_read_b128 a[12:15], v10 offset:3328
    ds_read_b64_tr_b16 a[40:41], v14 offset:11296
    ds_read_b64_tr_b16 a[42:43], v14 offset:11808
    ds_read_b128 a[16:19], v12 offset:2048
    s_waitcnt vmcnt(43)
    v_pk_add_f32 v[48:49], v[48:49], v[64:65]
    s_waitcnt vmcnt(42)
    v_pk_add_f32 v[50:51], v[50:51], v[66:67]
    s_waitcnt vmcnt(41)
    v_pk_add_f32 v[52:53], v[52:53], v[68:69]
    s_waitcnt vmcnt(40)
    v_pk_add_f32 v[54:55], v[54:55], v[70:71]
    s_waitcnt vmcnt(39)
    v_pk_add_f32 v[56:57], v[56:57], v[72:73]
    s_waitcnt vmcnt(38)
    v_pk_add_f32 v[58:59], v[58:59], v[74:75]
    s_waitcnt vmcnt(37)
    v_pk_add_f32 v[60:61], v[60:61], v[76:77]
    s_waitcnt vmcnt(36)
    v_pk_add_f32 v[62:63], v[62:63], v[78:79]
    v_pk_add_f32 v[48:49], v[48:49], v[56:57]
    v_pk_add_f32 v[50:51], v[50:51], v[58:59]
    v_pk_add_f32 v[52:53], v[52:53], v[60:61]
    v_pk_add_f32 v[54:55], v[54:55], v[62:63]
    v_pk_add_f32 v[48:49], v[48:49], v[52:53]
    v_pk_add_f32 v[50:51], v[50:51], v[54:55]
    v_pk_add_f32 v[48:49], v[48:49], v[50:51]
    v_mul_f32 v48, 0xba800000, v48
    v_mul_f32 v49, 0x3a800000, v49
    v_fma_f32 v49, -v48, v48, v49
    v_max_f32 v49, 0, v49
    v_add_f32 v49, 0x3727c5ac, v49
    v_rsq_f32 v50, v49
    s_nop 0
    v_mov_b32 v49, v50
    v_mul_f32 v50, 0x3e8293ee, v50
    v_min_u32 v34, 191, v0
    v_lshlrev_b32 v35, 2, v34
    v_lshlrev_b32 v34, 4, v34
    v_add_u32 v34, 129792, v34
    v_add_u32 v35, 132864, v35
    ds_write_b128 v34, v[48:51]
    ds_write_b32 v35, v48
    ds_write_b32 v35, v49 offset:768
    s_waitcnt lgkmcnt(0)
    v_mov_b32 v48, 0
    v_mov_b32 v49, 0
    v_mov_b32 v50, 0
    v_mov_b32 v51, 0
    v_mov_b32 v52, 0
    v_mov_b32 v53, 0
    v_mov_b32 v54, 0
    v_mov_b32 v55, 0
    v_mov_b32 v56, 0
    v_mov_b32 v57, 0
    v_mov_b32 v58, 0
    v_mov_b32 v59, 0
    v_mov_b32 v60, 0
    v_mov_b32 v61, 0
    v_mov_b32 v62, 0
    v_mov_b32 v63, 0
    v_mov_b32 v64, 0
    v_mov_b32 v65, 0
    v_mov_b32 v66, 0
    v_mov_b32 v67, 0
    v_mov_b32 v68, 0
    v_mov_b32 v69, 0
    v_mov_b32 v70, 0
    v_mov_b32 v71, 0
    v_mov_b32 v72, 0
    v_mov_b32 v73, 0
    v_mov_b32 v74, 0
    v_mov_b32 v75, 0
    v_mov_b32 v76, 0
    v_mov_b32 v77, 0
    v_mov_b32 v78, 0
    v_mov_b32 v79, 0
    v_mov_b32 v80, 0
    v_mov_b32 v81, 0
    v_mov_b32 v82, 0
    v_mov_b32 v83, 0
    v_mov_b32 v84, 0
    v_mov_b32 v85, 0
    v_mov_b32 v86, 0
    v_mov_b32 v87, 0
    v_mov_b32 v88, 0
    v_mov_b32 v89, 0
    v_mov_b32 v90, 0
    v_mov_b32 v91, 0
    v_mov_b32 v92, 0
    v_mov_b32 v93, 0
    v_mov_b32 v94, 0
    v_mov_b32 v95, 0
    v_mov_b32 v96, 0
    v_mov_b32 v97, 0
    v_mov_b32 v98, 0
    v_mov_b32 v99, 0
    v_mov_b32 v100, 0
    v_mov_b32 v101, 0
    v_mov_b32 v102, 0
    v_mov_b32 v103, 0
    v_mov_b32 v104, 0
    v_mov_b32 v105, 0
    v_mov_b32 v106, 0
    v_mov_b32 v107, 0
    v_mov_b32 v108, 0
    v_mov_b32 v109, 0
    v_mov_b32 v110, 0
    v_mov_b32 v111, 0
    v_mov_b32 v112, 0
    v_mov_b32 v113, 0
    v_mov_b32 v114, 0
    v_mov_b32 v115, 0
    v_mov_b32 v116, 0
    v_mov_b32 v117, 0
    v_mov_b32 v118, 0
    v_mov_b32 v119, 0
    v_mov_b32 v120, 0
    v_mov_b32 v121, 0
    v_mov_b32 v122, 0
    v_mov_b32 v123, 0
    v_mov_b32 v124, 0
    v_mov_b32 v125, 0
    v_mov_b32 v126, 0
    v_mov_b32 v127, 0
    v_mov_b32 v128, 0
    v_mov_b32 v129, 0
    v_mov_b32 v130, 0
    v_mov_b32 v131, 0
    v_mov_b32 v132, 0
    v_mov_b32 v133, 0
    v_mov_b32 v134, 0
    v_mov_b32 v135, 0
    v_mov_b32 v136, 0
    v_mov_b32 v137, 0
    v_mov_b32 v138, 0
    v_mov_b32 v139, 0
    v_mov_b32 v140, 0
    v_mov_b32 v141, 0
    v_mov_b32 v142, 0
    v_mov_b32 v143, 0
    v_mov_b32 v144, 0
    v_mov_b32 v145, 0
    v_mov_b32 v146, 0
    v_mov_b32 v147, 0
    v_mov_b32 v148, 0
    v_mov_b32 v149, 0
    v_mov_b32 v150, 0
    v_mov_b32 v151, 0
    s_mov_b32 s48, 4
.p2align 6
qkv1_kernel_t1_loop:
    s_waitcnt lgkmcnt(0)
    s_waitcnt vmcnt(24)
    s_barrier
    v_mfma_f32_16x16x32_bf16 v[48:51], a[20:23], a[0:3], v[48:51]
    ds_read_b64_tr_b16 a[64:65], v14 offset:30848
    v_mfma_f32_16x16x32_bf16 v[52:55], a[20:23], a[4:7], v[52:55]
    ds_read_b64_tr_b16 a[66:67], v14 offset:31360
    s_add_u32 m0, s24, 0
    s_nop 0
    buffer_load_dwordx4 v6, s[32:35], s25 offen lds
    v_mfma_f32_16x16x32_bf16 v[56:59], a[20:23], a[8:11], v[56:59]
    ds_read_b64_tr_b16 a[68:69], v14 offset:30880
    v_mfma_f32_16x16x32_bf16 v[60:63], a[20:23], a[12:15], v[60:63]
    ds_read_b64_tr_b16 a[70:71], v14 offset:31392
    v_mfma_f32_16x16x32_bf16 v[64:67], a[24:27], a[0:3], v[64:67]
    v_mfma_f32_16x16x32_bf16 v[68:71], a[24:27], a[4:7], v[68:71]
    ds_read_b64_tr_b16 a[72:73], v14 offset:31872
    buffer_load_dwordx4 v7, s[32:35], s25 offen offset:1024 lds
    v_mfma_f32_16x16x32_bf16 v[72:75], a[24:27], a[8:11], v[72:75]
    ds_read_b64_tr_b16 a[74:75], v14 offset:32384
    v_mfma_f32_16x16x32_bf16 v[76:79], a[24:27], a[12:15], v[76:79]
    ds_read_b64_tr_b16 a[76:77], v14 offset:31904
    v_mfma_f32_16x16x32_bf16 v[80:83], a[28:31], a[0:3], v[80:83]
    v_mfma_f32_16x16x32_bf16 v[84:87], a[28:31], a[4:7], v[84:87]
    ds_read_b64_tr_b16 a[78:79], v14 offset:32416
    buffer_load_dwordx4 v8, s[32:35], s25 offen offset:2048 lds
    s_add_u32 s25, s25, 196608
    v_mfma_f32_16x16x32_bf16 v[88:91], a[28:31], a[8:11], v[88:91]
    ds_read_b128 a[44:47], v10 offset:21632
    v_mfma_f32_16x16x32_bf16 v[92:95], a[28:31], a[12:15], v[92:95]
    ds_read_b128 a[48:51], v10 offset:22656
    v_mfma_f32_16x16x32_bf16 v[96:99], a[32:35], a[0:3], v[96:99]
    ds_read_b64_tr_b16 a[80:81], v14 offset:32896
    v_mfma_f32_16x16x32_bf16 v[100:103], a[32:35], a[4:7], v[100:103]
    s_add_u32 m0, s22, 0
    s_nop 0
    buffer_load_dwordx4 v4, s[28:31], s23 offen lds
    v_mfma_f32_16x16x32_bf16 v[104:107], a[32:35], a[8:11], v[104:107]
    ds_read_b64_tr_b16 a[82:83], v14 offset:33408
    v_mfma_f32_16x16x32_bf16 v[108:111], a[32:35], a[12:15], v[108:111]
    ds_read_b128 a[52:55], v10 offset:23936
    v_mfma_f32_16x16x32_bf16 v[112:115], a[0:3], a[36:39], v[112:115]
    ds_read_b128 a[56:59], v10 offset:24960
    v_mfma_f32_16x16x32_bf16 v[116:119], a[4:7], a[36:39], v[116:119]
    buffer_load_dwordx4 v4, s[28:31], s23 offen offset:1024 lds
    v_mfma_f32_16x16x32_bf16 v[120:123], a[8:11], a[36:39], v[120:123]
    ds_read_b64_tr_b16 a[84:85], v14 offset:32928
    v_mfma_f32_16x16x32_bf16 v[124:127], a[12:15], a[36:39], v[124:127]
    ds_read_b64_tr_b16 a[86:87], v14 offset:33440
    v_mfma_f32_16x16x32_bf16 v[144:147], a[16:19], a[36:39], v[144:147]
    ds_read_b128 a[60:63], v12 offset:23680
    v_mfma_f32_16x16x32_bf16 v[128:131], a[0:3], a[40:43], v[128:131]
    buffer_load_dword v5, s[28:31], s23 offen offset:2048 lds
    s_add_u32 s23, s23, 0x20000
    v_mfma_f32_16x16x32_bf16 v[132:135], a[4:7], a[40:43], v[132:135]
    v_mfma_f32_16x16x32_bf16 v[136:139], a[8:11], a[40:43], v[136:139]
    v_mfma_f32_16x16x32_bf16 v[140:143], a[12:15], a[40:43], v[140:143]
    v_mfma_f32_16x16x32_bf16 v[148:151], a[16:19], a[40:43], v[148:151]
    s_waitcnt lgkmcnt(0)
    s_waitcnt vmcnt(24)
    s_barrier
    v_mfma_f32_16x16x32_bf16 v[48:51], a[64:67], a[44:47], v[48:51]
    ds_read_b64_tr_b16 a[20:21], v14 offset:52480
    v_mfma_f32_16x16x32_bf16 v[52:55], a[64:67], a[48:51], v[52:55]
    ds_read_b64_tr_b16 a[22:23], v14 offset:52992
    s_add_u32 m0, s24, 21632
    s_nop 0
    buffer_load_dwordx4 v6, s[32:35], s25 offen lds
    v_mfma_f32_16x16x32_bf16 v[56:59], a[64:67], a[52:55], v[56:59]
    ds_read_b64_tr_b16 a[24:25], v14 offset:52512
    v_mfma_f32_16x16x32_bf16 v[60:63], a[64:67], a[56:59], v[60:63]
    ds_read_b64_tr_b16 a[26:27], v14 offset:53024
    v_mfma_f32_16x16x32_bf16 v[64:67], a[68:71], a[44:47], v[64:67]
    v_mfma_f32_16x16x32_bf16 v[68:71], a[68:71], a[48:51], v[68:71]
    ds_read_b64_tr_b16 a[28:29], v14 offset:53504
    buffer_load_dwordx4 v7, s[32:35], s25 offen offset:1024 lds
    v_mfma_f32_16x16x32_bf16 v[72:75], a[68:71], a[52:55], v[72:75]
    ds_read_b64_tr_b16 a[30:31], v14 offset:54016
    v_mfma_f32_16x16x32_bf16 v[76:79], a[68:71], a[56:59], v[76:79]
    ds_read_b64_tr_b16 a[32:33], v14 offset:53536
    v_mfma_f32_16x16x32_bf16 v[80:83], a[72:75], a[44:47], v[80:83]
    v_mfma_f32_16x16x32_bf16 v[84:87], a[72:75], a[48:51], v[84:87]
    ds_read_b64_tr_b16 a[34:35], v14 offset:54048
    buffer_load_dwordx4 v8, s[32:35], s25 offen offset:2048 lds
    s_add_u32 s25, s25, 196608
    v_mfma_f32_16x16x32_bf16 v[88:91], a[72:75], a[52:55], v[88:91]
    ds_read_b128 a[0:3], v10 offset:43264
    v_mfma_f32_16x16x32_bf16 v[92:95], a[72:75], a[56:59], v[92:95]
    ds_read_b128 a[4:7], v10 offset:44288
    v_mfma_f32_16x16x32_bf16 v[96:99], a[76:79], a[44:47], v[96:99]
    ds_read_b64_tr_b16 a[36:37], v14 offset:54528
    v_mfma_f32_16x16x32_bf16 v[100:103], a[76:79], a[48:51], v[100:103]
    s_add_u32 m0, s22, 21632
    s_nop 0
    buffer_load_dwordx4 v4, s[28:31], s23 offen lds
    v_mfma_f32_16x16x32_bf16 v[104:107], a[76:79], a[52:55], v[104:107]
    ds_read_b64_tr_b16 a[38:39], v14 offset:55040
    v_mfma_f32_16x16x32_bf16 v[108:111], a[76:79], a[56:59], v[108:111]
    ds_read_b128 a[8:11], v10 offset:45568
    v_mfma_f32_16x16x32_bf16 v[112:115], a[44:47], a[80:83], v[112:115]
    ds_read_b128 a[12:15], v10 offset:46592
    v_mfma_f32_16x16x32_bf16 v[116:119], a[48:51], a[80:83], v[116:119]
    buffer_load_dwordx4 v4, s[28:31], s23 offen offset:1024 lds
    v_mfma_f32_16x16x32_bf16 v[120:123], a[52:55], a[80:83], v[120:123]
    ds_read_b64_tr_b16 a[40:41], v14 offset:54560
    v_mfma_f32_16x16x32_bf16 v[124:127], a[56:59], a[80:83], v[124:127]
    ds_read_b64_tr_b16 a[42:43], v14 offset:55072
    v_mfma_f32_16x16x32_bf16 v[144:147], a[60:63], a[80:83], v[144:147]
    ds_read_b128 a[16:19], v12 offset:45312
    v_mfma_f32_16x16x32_bf16 v[128:131], a[44:47], a[84:87], v[128:131]
    buffer_load_dword v5, s[28:31], s23 offen offset:2048 lds
    s_add_u32 s23, s23, 0x20000
    v_mfma_f32_16x16x32_bf16 v[132:135], a[48:51], a[84:87], v[132:135]
    v_mfma_f32_16x16x32_bf16 v[136:139], a[52:55], a[84:87], v[136:139]
    v_mfma_f32_16x16x32_bf16 v[140:143], a[56:59], a[84:87], v[140:143]
    v_mfma_f32_16x16x32_bf16 v[148:151], a[60:63], a[84:87], v[148:151]
    s_waitcnt lgkmcnt(0)
    s_waitcnt vmcnt(24)
    s_barrier
    v_mfma_f32_16x16x32_bf16 v[48:51], a[20:23], a[0:3], v[48:51]
    ds_read_b64_tr_b16 a[64:65], v15 offset:9216
    v_mfma_f32_16x16x32_bf16 v[52:55], a[20:23], a[4:7], v[52:55]
    ds_read_b64_tr_b16 a[66:67], v15 offset:9728
    s_add_u32 m0, s24, 43264
    s_nop 0
    buffer_load_dwordx4 v6, s[32:35], s25 offen lds
    v_mfma_f32_16x16x32_bf16 v[56:59], a[20:23], a[8:11], v[56:59]
    ds_read_b64_tr_b16 a[68:69], v15 offset:9248
    v_mfma_f32_16x16x32_bf16 v[60:63], a[20:23], a[12:15], v[60:63]
    ds_read_b64_tr_b16 a[70:71], v15 offset:9760
    v_mfma_f32_16x16x32_bf16 v[64:67], a[24:27], a[0:3], v[64:67]
    v_mfma_f32_16x16x32_bf16 v[68:71], a[24:27], a[4:7], v[68:71]
    ds_read_b64_tr_b16 a[72:73], v15 offset:10240
    buffer_load_dwordx4 v7, s[32:35], s25 offen offset:1024 lds
    v_mfma_f32_16x16x32_bf16 v[72:75], a[24:27], a[8:11], v[72:75]
    ds_read_b64_tr_b16 a[74:75], v15 offset:10752
    v_mfma_f32_16x16x32_bf16 v[76:79], a[24:27], a[12:15], v[76:79]
    ds_read_b64_tr_b16 a[76:77], v15 offset:10272
    v_mfma_f32_16x16x32_bf16 v[80:83], a[28:31], a[0:3], v[80:83]
    v_mfma_f32_16x16x32_bf16 v[84:87], a[28:31], a[4:7], v[84:87]
    ds_read_b64_tr_b16 a[78:79], v15 offset:10784
    buffer_load_dwordx4 v8, s[32:35], s25 offen offset:2048 lds
    s_add_u32 s25, s25, 196608
    v_mfma_f32_16x16x32_bf16 v[88:91], a[28:31], a[8:11], v[88:91]
    ds_read_b128 a[44:47], v11 offset:0
    v_mfma_f32_16x16x32_bf16 v[92:95], a[28:31], a[12:15], v[92:95]
    ds_read_b128 a[48:51], v11 offset:1024
    v_mfma_f32_16x16x32_bf16 v[96:99], a[32:35], a[0:3], v[96:99]
    ds_read_b64_tr_b16 a[80:81], v15 offset:11264
    v_mfma_f32_16x16x32_bf16 v[100:103], a[32:35], a[4:7], v[100:103]
    s_add_u32 m0, s22, 43264
    s_nop 0
    buffer_load_dwordx4 v4, s[28:31], s23 offen lds
    v_mfma_f32_16x16x32_bf16 v[104:107], a[32:35], a[8:11], v[104:107]
    ds_read_b64_tr_b16 a[82:83], v15 offset:11776
    v_mfma_f32_16x16x32_bf16 v[108:111], a[32:35], a[12:15], v[108:111]
    ds_read_b128 a[52:55], v11 offset:2304
    v_mfma_f32_16x16x32_bf16 v[112:115], a[0:3], a[36:39], v[112:115]
    ds_read_b128 a[56:59], v11 offset:3328
    v_mfma_f32_16x16x32_bf16 v[116:119], a[4:7], a[36:39], v[116:119]
    buffer_load_dwordx4 v4, s[28:31], s23 offen offset:1024 lds
    v_mfma_f32_16x16x32_bf16 v[120:123], a[8:11], a[36:39], v[120:123]
    ds_read_b64_tr_b16 a[84:85], v15 offset:11296
    v_mfma_f32_16x16x32_bf16 v[124:127], a[12:15], a[36:39], v[124:127]
    ds_read_b64_tr_b16 a[86:87], v15 offset:11808
    v_mfma_f32_16x16x32_bf16 v[144:147], a[16:19], a[36:39], v[144:147]
    ds_read_b128 a[60:63], v13 offset:2048
    v_mfma_f32_16x16x32_bf16 v[128:131], a[0:3], a[40:43], v[128:131]
    buffer_load_dword v5, s[28:31], s23 offen offset:2048 lds
    s_add_u32 s23, s23, 0x20000
    v_mfma_f32_16x16x32_bf16 v[132:135], a[4:7], a[40:43], v[132:135]
    v_mfma_f32_16x16x32_bf16 v[136:139], a[8:11], a[40:43], v[136:139]
    v_mfma_f32_16x16x32_bf16 v[140:143], a[12:15], a[40:43], v[140:143]
    v_mfma_f32_16x16x32_bf16 v[148:151], a[16:19], a[40:43], v[148:151]
    s_waitcnt lgkmcnt(0)
    s_waitcnt vmcnt(24)
    s_barrier
    v_mfma_f32_16x16x32_bf16 v[48:51], a[64:67], a[44:47], v[48:51]
    ds_read_b64_tr_b16 a[20:21], v15 offset:30848
    v_mfma_f32_16x16x32_bf16 v[52:55], a[64:67], a[48:51], v[52:55]
    ds_read_b64_tr_b16 a[22:23], v15 offset:31360
    s_add_u32 m0, s24, 64896
    s_nop 0
    buffer_load_dwordx4 v6, s[32:35], s25 offen lds
    v_mfma_f32_16x16x32_bf16 v[56:59], a[64:67], a[52:55], v[56:59]
    ds_read_b64_tr_b16 a[24:25], v15 offset:30880
    v_mfma_f32_16x16x32_bf16 v[60:63], a[64:67], a[56:59], v[60:63]
    ds_read_b64_tr_b16 a[26:27], v15 offset:31392
    v_mfma_f32_16x16x32_bf16 v[64:67], a[68:71], a[44:47], v[64:67]
    v_mfma_f32_16x16x32_bf16 v[68:71], a[68:71], a[48:51], v[68:71]
    ds_read_b64_tr_b16 a[28:29], v15 offset:31872
    buffer_load_dwordx4 v7, s[32:35], s25 offen offset:1024 lds
    v_mfma_f32_16x16x32_bf16 v[72:75], a[68:71], a[52:55], v[72:75]
    ds_read_b64_tr_b16 a[30:31], v15 offset:32384
    v_mfma_f32_16x16x32_bf16 v[76:79], a[68:71], a[56:59], v[76:79]
    ds_read_b64_tr_b16 a[32:33], v15 offset:31904
    v_mfma_f32_16x16x32_bf16 v[80:83], a[72:75], a[44:47], v[80:83]
    v_mfma_f32_16x16x32_bf16 v[84:87], a[72:75], a[48:51], v[84:87]
    ds_read_b64_tr_b16 a[34:35], v15 offset:32416
    buffer_load_dwordx4 v8, s[32:35], s25 offen offset:2048 lds
    s_add_u32 s25, s25, 196608
    v_mfma_f32_16x16x32_bf16 v[88:91], a[72:75], a[52:55], v[88:91]
    ds_read_b128 a[0:3], v11 offset:21632
    v_mfma_f32_16x16x32_bf16 v[92:95], a[72:75], a[56:59], v[92:95]
    ds_read_b128 a[4:7], v11 offset:22656
    v_mfma_f32_16x16x32_bf16 v[96:99], a[76:79], a[44:47], v[96:99]
    ds_read_b64_tr_b16 a[36:37], v15 offset:32896
    v_mfma_f32_16x16x32_bf16 v[100:103], a[76:79], a[48:51], v[100:103]
    s_add_u32 m0, s22, 64896
    s_nop 0
    buffer_load_dwordx4 v4, s[28:31], s23 offen lds
    v_mfma_f32_16x16x32_bf16 v[104:107], a[76:79], a[52:55], v[104:107]
    ds_read_b64_tr_b16 a[38:39], v15 offset:33408
    v_mfma_f32_16x16x32_bf16 v[108:111], a[76:79], a[56:59], v[108:111]
    ds_read_b128 a[8:11], v11 offset:23936
    v_mfma_f32_16x16x32_bf16 v[112:115], a[44:47], a[80:83], v[112:115]
    ds_read_b128 a[12:15], v11 offset:24960
    v_mfma_f32_16x16x32_bf16 v[116:119], a[48:51], a[80:83], v[116:119]
    buffer_load_dwordx4 v4, s[28:31], s23 offen offset:1024 lds
    v_mfma_f32_16x16x32_bf16 v[120:123], a[52:55], a[80:83], v[120:123]
    ds_read_b64_tr_b16 a[40:41], v15 offset:32928
    v_mfma_f32_16x16x32_bf16 v[124:127], a[56:59], a[80:83], v[124:127]
    ds_read_b64_tr_b16 a[42:43], v15 offset:33440
    v_mfma_f32_16x16x32_bf16 v[144:147], a[60:63], a[80:83], v[144:147]
    ds_read_b128 a[16:19], v13 offset:23680
    v_mfma_f32_16x16x32_bf16 v[128:131], a[44:47], a[84:87], v[128:131]
    buffer_load_dword v5, s[28:31], s23 offen offset:2048 lds
    s_add_u32 s23, s23, 0x20000
    v_mfma_f32_16x16x32_bf16 v[132:135], a[48:51], a[84:87], v[132:135]
    v_mfma_f32_16x16x32_bf16 v[136:139], a[52:55], a[84:87], v[136:139]
    v_mfma_f32_16x16x32_bf16 v[140:143], a[56:59], a[84:87], v[140:143]
    v_mfma_f32_16x16x32_bf16 v[148:151], a[60:63], a[84:87], v[148:151]
    s_waitcnt lgkmcnt(0)
    s_waitcnt vmcnt(24)
    s_barrier
    v_mfma_f32_16x16x32_bf16 v[48:51], a[20:23], a[0:3], v[48:51]
    ds_read_b64_tr_b16 a[64:65], v15 offset:52480
    v_mfma_f32_16x16x32_bf16 v[52:55], a[20:23], a[4:7], v[52:55]
    ds_read_b64_tr_b16 a[66:67], v15 offset:52992
    s_add_u32 m0, s24, 86528
    s_nop 0
    buffer_load_dwordx4 v6, s[32:35], s25 offen lds
    v_mfma_f32_16x16x32_bf16 v[56:59], a[20:23], a[8:11], v[56:59]
    ds_read_b64_tr_b16 a[68:69], v15 offset:52512
    v_mfma_f32_16x16x32_bf16 v[60:63], a[20:23], a[12:15], v[60:63]
    ds_read_b64_tr_b16 a[70:71], v15 offset:53024
    v_mfma_f32_16x16x32_bf16 v[64:67], a[24:27], a[0:3], v[64:67]
    v_mfma_f32_16x16x32_bf16 v[68:71], a[24:27], a[4:7], v[68:71]
    ds_read_b64_tr_b16 a[72:73], v15 offset:53504
    buffer_load_dwordx4 v7, s[32:35], s25 offen offset:1024 lds
    v_mfma_f32_16x16x32_bf16 v[72:75], a[24:27], a[8:11], v[72:75]
    ds_read_b64_tr_b16 a[74:75], v15 offset:54016
    v_mfma_f32_16x16x32_bf16 v[76:79], a[24:27], a[12:15], v[76:79]
    ds_read_b64_tr_b16 a[76:77], v15 offset:53536
    v_mfma_f32_16x16x32_bf16 v[80:83], a[28:31], a[0:3], v[80:83]
    v_mfma_f32_16x16x32_bf16 v[84:87], a[28:31], a[4:7], v[84:87]
    ds_read_b64_tr_b16 a[78:79], v15 offset:54048
    buffer_load_dwordx4 v8, s[32:35], s25 offen offset:2048 lds
    s_add_u32 s25, s25, 196608
    v_mfma_f32_16x16x32_bf16 v[88:91], a[28:31], a[8:11], v[88:91]
    ds_read_b128 a[44:47], v11 offset:43264
    v_mfma_f32_16x16x32_bf16 v[92:95], a[28:31], a[12:15], v[92:95]
    ds_read_b128 a[48:51], v11 offset:44288
    v_mfma_f32_16x16x32_bf16 v[96:99], a[32:35], a[0:3], v[96:99]
    ds_read_b64_tr_b16 a[80:81], v15 offset:54528
    v_mfma_f32_16x16x32_bf16 v[100:103], a[32:35], a[4:7], v[100:103]
    s_add_u32 m0, s22, 86528
    s_nop 0
    buffer_load_dwordx4 v4, s[28:31], s23 offen lds
    v_mfma_f32_16x16x32_bf16 v[104:107], a[32:35], a[8:11], v[104:107]
    ds_read_b64_tr_b16 a[82:83], v15 offset:55040
    v_mfma_f32_16x16x32_bf16 v[108:111], a[32:35], a[12:15], v[108:111]
    ds_read_b128 a[52:55], v11 offset:45568
    v_mfma_f32_16x16x32_bf16 v[112:115], a[0:3], a[36:39], v[112:115]
    ds_read_b128 a[56:59], v11 offset:46592
    v_mfma_f32_16x16x32_bf16 v[116:119], a[4:7], a[36:39], v[116:119]
    buffer_load_dwordx4 v4, s[28:31], s23 offen offset:1024 lds
    v_mfma_f32_16x16x32_bf16 v[120:123], a[8:11], a[36:39], v[120:123]
    ds_read_b64_tr_b16 a[84:85], v15 offset:54560
    v_mfma_f32_16x16x32_bf16 v[124:127], a[12:15], a[36:39], v[124:127]
    ds_read_b64_tr_b16 a[86:87], v15 offset:55072
    v_mfma_f32_16x16x32_bf16 v[144:147], a[16:19], a[36:39], v[144:147]
    ds_read_b128 a[60:63], v13 offset:45312
    v_mfma_f32_16x16x32_bf16 v[128:131], a[0:3], a[40:43], v[128:131]
    buffer_load_dword v5, s[28:31], s23 offen offset:2048 lds
    s_add_u32 s23, s23, 0x20000
    v_mfma_f32_16x16x32_bf16 v[132:135], a[4:7], a[40:43], v[132:135]
    v_mfma_f32_16x16x32_bf16 v[136:139], a[8:11], a[40:43], v[136:139]
    v_mfma_f32_16x16x32_bf16 v[140:143], a[12:15], a[40:43], v[140:143]
    v_mfma_f32_16x16x32_bf16 v[148:151], a[16:19], a[40:43], v[148:151]
    s_waitcnt lgkmcnt(0)
    s_waitcnt vmcnt(24)
    s_barrier
    v_mfma_f32_16x16x32_bf16 v[48:51], a[64:67], a[44:47], v[48:51]
    ds_read_b64_tr_b16 a[20:21], v14 offset:9216
    v_mfma_f32_16x16x32_bf16 v[52:55], a[64:67], a[48:51], v[52:55]
    ds_read_b64_tr_b16 a[22:23], v14 offset:9728
    s_add_u32 m0, s24, 108160
    s_nop 0
    buffer_load_dwordx4 v6, s[32:35], s25 offen lds
    v_mfma_f32_16x16x32_bf16 v[56:59], a[64:67], a[52:55], v[56:59]
    ds_read_b64_tr_b16 a[24:25], v14 offset:9248
    v_mfma_f32_16x16x32_bf16 v[60:63], a[64:67], a[56:59], v[60:63]
    ds_read_b64_tr_b16 a[26:27], v14 offset:9760
    v_mfma_f32_16x16x32_bf16 v[64:67], a[68:71], a[44:47], v[64:67]
    v_mfma_f32_16x16x32_bf16 v[68:71], a[68:71], a[48:51], v[68:71]
    ds_read_b64_tr_b16 a[28:29], v14 offset:10240
    buffer_load_dwordx4 v7, s[32:35], s25 offen offset:1024 lds
    v_mfma_f32_16x16x32_bf16 v[72:75], a[68:71], a[52:55], v[72:75]
    ds_read_b64_tr_b16 a[30:31], v14 offset:10752
    v_mfma_f32_16x16x32_bf16 v[76:79], a[68:71], a[56:59], v[76:79]
    ds_read_b64_tr_b16 a[32:33], v14 offset:10272
    v_mfma_f32_16x16x32_bf16 v[80:83], a[72:75], a[44:47], v[80:83]
    v_mfma_f32_16x16x32_bf16 v[84:87], a[72:75], a[48:51], v[84:87]
    ds_read_b64_tr_b16 a[34:35], v14 offset:10784
    buffer_load_dwordx4 v8, s[32:35], s25 offen offset:2048 lds
    s_add_u32 s25, s25, 196608
    v_mfma_f32_16x16x32_bf16 v[88:91], a[72:75], a[52:55], v[88:91]
    ds_read_b128 a[0:3], v10 offset:0
    v_mfma_f32_16x16x32_bf16 v[92:95], a[72:75], a[56:59], v[92:95]
    ds_read_b128 a[4:7], v10 offset:1024
    v_mfma_f32_16x16x32_bf16 v[96:99], a[76:79], a[44:47], v[96:99]
    ds_read_b64_tr_b16 a[36:37], v14 offset:11264
    v_mfma_f32_16x16x32_bf16 v[100:103], a[76:79], a[48:51], v[100:103]
    s_add_u32 m0, s22, 108160
    s_nop 0
    buffer_load_dwordx4 v4, s[28:31], s23 offen lds
    v_mfma_f32_16x16x32_bf16 v[104:107], a[76:79], a[52:55], v[104:107]
    ds_read_b64_tr_b16 a[38:39], v14 offset:11776
    v_mfma_f32_16x16x32_bf16 v[108:111], a[76:79], a[56:59], v[108:111]
    ds_read_b128 a[8:11], v10 offset:2304
    v_mfma_f32_16x16x32_bf16 v[112:115], a[44:47], a[80:83], v[112:115]
    ds_read_b128 a[12:15], v10 offset:3328
    v_mfma_f32_16x16x32_bf16 v[116:119], a[48:51], a[80:83], v[116:119]
    buffer_load_dwordx4 v4, s[28:31], s23 offen offset:1024 lds
    v_mfma_f32_16x16x32_bf16 v[120:123], a[52:55], a[80:83], v[120:123]
    ds_read_b64_tr_b16 a[40:41], v14 offset:11296
    v_mfma_f32_16x16x32_bf16 v[124:127], a[56:59], a[80:83], v[124:127]
    ds_read_b64_tr_b16 a[42:43], v14 offset:11808
    v_mfma_f32_16x16x32_bf16 v[144:147], a[60:63], a[80:83], v[144:147]
    ds_read_b128 a[16:19], v12 offset:2048
    v_mfma_f32_16x16x32_bf16 v[128:131], a[44:47], a[84:87], v[128:131]
    buffer_load_dword v5, s[28:31], s23 offen offset:2048 lds
    s_add_u32 s23, s23, 0x20000
    v_mfma_f32_16x16x32_bf16 v[132:135], a[48:51], a[84:87], v[132:135]
    v_mfma_f32_16x16x32_bf16 v[136:139], a[52:55], a[84:87], v[136:139]
    v_mfma_f32_16x16x32_bf16 v[140:143], a[56:59], a[84:87], v[140:143]
    v_mfma_f32_16x16x32_bf16 v[148:151], a[60:63], a[84:87], v[148:151]
    s_sub_u32 s48, s48, 1
    s_cmp_lg_u32 s48, 0
    s_cbranch_scc1 qkv1_kernel_t1_loop
    s_waitcnt lgkmcnt(0)
    s_waitcnt vmcnt(24)
    s_barrier
    v_mfma_f32_16x16x32_bf16 v[48:51], a[20:23], a[0:3], v[48:51]
    ds_read_b64_tr_b16 a[64:65], v14 offset:30848
    v_mfma_f32_16x16x32_bf16 v[52:55], a[20:23], a[4:7], v[52:55]
    ds_read_b64_tr_b16 a[66:67], v14 offset:31360
    s_add_u32 m0, s24, 0
    s_nop 0
    buffer_load_dwordx4 v6, s[32:35], s25 offen lds
    v_mfma_f32_16x16x32_bf16 v[56:59], a[20:23], a[8:11], v[56:59]
    ds_read_b64_tr_b16 a[68:69], v14 offset:30880
    v_mfma_f32_16x16x32_bf16 v[60:63], a[20:23], a[12:15], v[60:63]
    ds_read_b64_tr_b16 a[70:71], v14 offset:31392
    v_mfma_f32_16x16x32_bf16 v[64:67], a[24:27], a[0:3], v[64:67]
    v_mfma_f32_16x16x32_bf16 v[68:71], a[24:27], a[4:7], v[68:71]
    ds_read_b64_tr_b16 a[72:73], v14 offset:31872
    buffer_load_dwordx4 v7, s[32:35], s25 offen offset:1024 lds
    v_mfma_f32_16x16x32_bf16 v[72:75], a[24:27], a[8:11], v[72:75]
    ds_read_b64_tr_b16 a[74:75], v14 offset:32384
    v_mfma_f32_16x16x32_bf16 v[76:79], a[24:27], a[12:15], v[76:79]
    ds_read_b64_tr_b16 a[76:77], v14 offset:31904
    v_mfma_f32_16x16x32_bf16 v[80:83], a[28:31], a[0:3], v[80:83]
    v_mfma_f32_16x16x32_bf16 v[84:87], a[28:31], a[4:7], v[84:87]
    ds_read_b64_tr_b16 a[78:79], v14 offset:32416
    buffer_load_dwordx4 v8, s[32:35], s25 offen offset:2048 lds
    s_add_u32 s25, s25, 196608
    v_mfma_f32_16x16x32_bf16 v[88:91], a[28:31], a[8:11], v[88:91]
    ds_read_b128 a[44:47], v10 offset:21632
    v_mfma_f32_16x16x32_bf16 v[92:95], a[28:31], a[12:15], v[92:95]
    ds_read_b128 a[48:51], v10 offset:22656
    v_mfma_f32_16x16x32_bf16 v[96:99], a[32:35], a[0:3], v[96:99]
    ds_read_b64_tr_b16 a[80:81], v14 offset:32896
    v_mfma_f32_16x16x32_bf16 v[100:103], a[32:35], a[4:7], v[100:103]
    s_add_u32 m0, s22, 0
    s_nop 0
    buffer_load_dwordx4 v4, s[28:31], s23 offen lds
    v_mfma_f32_16x16x32_bf16 v[104:107], a[32:35], a[8:11], v[104:107]
    ds_read_b64_tr_b16 a[82:83], v14 offset:33408
    v_mfma_f32_16x16x32_bf16 v[108:111], a[32:35], a[12:15], v[108:111]
    ds_read_b128 a[52:55], v10 offset:23936
    v_mfma_f32_16x16x32_bf16 v[112:115], a[0:3], a[36:39], v[112:115]
    ds_read_b128 a[56:59], v10 offset:24960
    v_mfma_f32_16x16x32_bf16 v[116:119], a[4:7], a[36:39], v[116:119]
    buffer_load_dwordx4 v4, s[28:31], s23 offen offset:1024 lds
    v_mfma_f32_16x16x32_bf16 v[120:123], a[8:11], a[36:39], v[120:123]
    ds_read_b64_tr_b16 a[84:85], v14 offset:32928
    v_mfma_f32_16x16x32_bf16 v[124:127], a[12:15], a[36:39], v[124:127]
    ds_read_b64_tr_b16 a[86:87], v14 offset:33440
    v_mfma_f32_16x16x32_bf16 v[144:147], a[16:19], a[36:39], v[144:147]
    ds_read_b128 a[60:63], v12 offset:23680
    v_mfma_f32_16x16x32_bf16 v[128:131], a[0:3], a[40:43], v[128:131]
    buffer_load_dword v5, s[28:31], s23 offen offset:2048 lds
    s_add_u32 s23, s23, 0x20000
    v_mfma_f32_16x16x32_bf16 v[132:135], a[4:7], a[40:43], v[132:135]
    v_mfma_f32_16x16x32_bf16 v[136:139], a[8:11], a[40:43], v[136:139]
    v_mfma_f32_16x16x32_bf16 v[140:143], a[12:15], a[40:43], v[140:143]
    v_mfma_f32_16x16x32_bf16 v[148:151], a[16:19], a[40:43], v[148:151]
    s_waitcnt lgkmcnt(0)
    s_waitcnt vmcnt(24)
    s_barrier
    v_mfma_f32_16x16x32_bf16 v[48:51], a[64:67], a[44:47], v[48:51]
    ds_read_b64_tr_b16 a[20:21], v14 offset:52480
    v_mfma_f32_16x16x32_bf16 v[52:55], a[64:67], a[48:51], v[52:55]
    ds_read_b64_tr_b16 a[22:23], v14 offset:52992
    s_add_u32 m0, s24, 21632
    s_nop 0
    buffer_load_dwordx4 v6, s[32:35], s25 offen lds
    v_mfma_f32_16x16x32_bf16 v[56:59], a[64:67], a[52:55], v[56:59]
    ds_read_b64_tr_b16 a[24:25], v14 offset:52512
    v_mfma_f32_16x16x32_bf16 v[60:63], a[64:67], a[56:59], v[60:63]
    ds_read_b64_tr_b16 a[26:27], v14 offset:53024
    v_mfma_f32_16x16x32_bf16 v[64:67], a[68:71], a[44:47], v[64:67]
    v_mfma_f32_16x16x32_bf16 v[68:71], a[68:71], a[48:51], v[68:71]
    ds_read_b64_tr_b16 a[28:29], v14 offset:53504
    buffer_load_dwordx4 v7, s[32:35], s25 offen offset:1024 lds
    v_mfma_f32_16x16x32_bf16 v[72:75], a[68:71], a[52:55], v[72:75]
    ds_read_b64_tr_b16 a[30:31], v14 offset:54016
    v_mfma_f32_16x16x32_bf16 v[76:79], a[68:71], a[56:59], v[76:79]
    ds_read_b64_tr_b16 a[32:33], v14 offset:53536
    v_mfma_f32_16x16x32_bf16 v[80:83], a[72:75], a[44:47], v[80:83]
    v_mfma_f32_16x16x32_bf16 v[84:87], a[72:75], a[48:51], v[84:87]
    ds_read_b64_tr_b16 a[34:35], v14 offset:54048
    buffer_load_dwordx4 v8, s[32:35], s25 offen offset:2048 lds
    s_add_u32 s25, s25, 196608
    v_mfma_f32_16x16x32_bf16 v[88:91], a[72:75], a[52:55], v[88:91]
    ds_read_b128 a[0:3], v10 offset:43264
    v_mfma_f32_16x16x32_bf16 v[92:95], a[72:75], a[56:59], v[92:95]
    ds_read_b128 a[4:7], v10 offset:44288
    v_mfma_f32_16x16x32_bf16 v[96:99], a[76:79], a[44:47], v[96:99]
    ds_read_b64_tr_b16 a[36:37], v14 offset:54528
    v_mfma_f32_16x16x32_bf16 v[100:103], a[76:79], a[48:51], v[100:103]
    s_add_u32 m0, s22, 21632
    s_nop 0
    buffer_load_dwordx4 v4, s[28:31], s23 offen lds
    v_mfma_f32_16x16x32_bf16 v[104:107], a[76:79], a[52:55], v[104:107]
    ds_read_b64_tr_b16 a[38:39], v14 offset:55040
    v_mfma_f32_16x16x32_bf16 v[108:111], a[76:79], a[56:59], v[108:111]
    ds_read_b128 a[8:11], v10 offset:45568
    v_mfma_f32_16x16x32_bf16 v[112:115], a[44:47], a[80:83], v[112:115]
    ds_read_b128 a[12:15], v10 offset:46592
    v_mfma_f32_16x16x32_bf16 v[116:119], a[48:51], a[80:83], v[116:119]
    buffer_load_dwordx4 v4, s[28:31], s23 offen offset:1024 lds
    v_mfma_f32_16x16x32_bf16 v[120:123], a[52:55], a[80:83], v[120:123]
    ds_read_b64_tr_b16 a[40:41], v14 offset:54560
    v_mfma_f32_16x16x32_bf16 v[124:127], a[56:59], a[80:83], v[124:127]
    ds_read_b64_tr_b16 a[42:43], v14 offset:55072
    v_mfma_f32_16x16x32_bf16 v[144:147], a[60:63], a[80:83], v[144:147]
    ds_read_b128 a[16:19], v12 offset:45312
    v_mfma_f32_16x16x32_bf16 v[128:131], a[44:47], a[84:87], v[128:131]
    buffer_load_dword v5, s[28:31], s23 offen offset:2048 lds
    s_add_u32 s23, s23, 0x20000
    v_mfma_f32_16x16x32_bf16 v[132:135], a[48:51], a[84:87], v[132:135]
    v_mfma_f32_16x16x32_bf16 v[136:139], a[52:55], a[84:87], v[136:139]
    v_mfma_f32_16x16x32_bf16 v[140:143], a[56:59], a[84:87], v[140:143]
    v_mfma_f32_16x16x32_bf16 v[148:151], a[60:63], a[84:87], v[148:151]
    s_waitcnt lgkmcnt(0)
    s_waitcnt vmcnt(24)
    s_barrier
    v_mfma_f32_16x16x32_bf16 v[48:51], a[20:23], a[0:3], v[48:51]
    ds_read_b64_tr_b16 a[64:65], v15 offset:9216
    v_mfma_f32_16x16x32_bf16 v[52:55], a[20:23], a[4:7], v[52:55]
    ds_read_b64_tr_b16 a[66:67], v15 offset:9728
    v_mfma_f32_16x16x32_bf16 v[56:59], a[20:23], a[8:11], v[56:59]
    ds_read_b64_tr_b16 a[68:69], v15 offset:9248
    v_mfma_f32_16x16x32_bf16 v[60:63], a[20:23], a[12:15], v[60:63]
    ds_read_b64_tr_b16 a[70:71], v15 offset:9760
    v_mfma_f32_16x16x32_bf16 v[64:67], a[24:27], a[0:3], v[64:67]
    v_mfma_f32_16x16x32_bf16 v[68:71], a[24:27], a[4:7], v[68:71]
    ds_read_b64_tr_b16 a[72:73], v15 offset:10240
    v_mfma_f32_16x16x32_bf16 v[72:75], a[24:27], a[8:11], v[72:75]
    ds_read_b64_tr_b16 a[74:75], v15 offset:10752
    v_mfma_f32_16x16x32_bf16 v[76:79], a[24:27], a[12:15], v[76:79]
    ds_read_b64_tr_b16 a[76:77], v15 offset:10272
    v_mfma_f32_16x16x32_bf16 v[80:83], a[28:31], a[0:3], v[80:83]
    v_mfma_f32_16x16x32_bf16 v[84:87], a[28:31], a[4:7], v[84:87]
    ds_read_b64_tr_b16 a[78:79], v15 offset:10784
    v_mfma_f32_16x16x32_bf16 v[88:91], a[28:31], a[8:11], v[88:91]
    ds_read_b128 a[44:47], v11 offset:0
    v_mfma_f32_16x16x32_bf16 v[92:95], a[28:31], a[12:15], v[92:95]
    ds_read_b128 a[48:51], v11 offset:1024
    v_mfma_f32_16x16x32_bf16 v[96:99], a[32:35], a[0:3], v[96:99]
    ds_read_b64_tr_b16 a[80:81], v15 offset:11264
    v_mfma_f32_16x16x32_bf16 v[100:103], a[32:35], a[4:7], v[100:103]
    v_mfma_f32_16x16x32_bf16 v[104:107], a[32:35], a[8:11], v[104:107]
    ds_read_b64_tr_b16 a[82:83], v15 offset:11776
    v_mfma_f32_16x16x32_bf16 v[108:111], a[32:35], a[12:15], v[108:111]
    ds_read_b128 a[52:55], v11 offset:2304
    v_mfma_f32_16x16x32_bf16 v[112:115], a[0:3], a[36:39], v[112:115]
    ds_read_b128 a[56:59], v11 offset:3328
    v_mfma_f32_16x16x32_bf16 v[116:119], a[4:7], a[36:39], v[116:119]
    v_mfma_f32_16x16x32_bf16 v[120:123], a[8:11], a[36:39], v[120:123]
    ds_read_b64_tr_b16 a[84:85], v15 offset:11296
    v_mfma_f32_16x16x32_bf16 v[124:127], a[12:15], a[36:39], v[124:127]
    ds_read_b64_tr_b16 a[86:87], v15 offset:11808
    v_mfma_f32_16x16x32_bf16 v[144:147], a[16:19], a[36:39], v[144:147]
    ds_read_b128 a[60:63], v13 offset:2048
    v_mfma_f32_16x16x32_bf16 v[128:131], a[0:3], a[40:43], v[128:131]
    v_mfma_f32_16x16x32_bf16 v[132:135], a[4:7], a[40:43], v[132:135]
    v_mfma_f32_16x16x32_bf16 v[136:139], a[8:11], a[40:43], v[136:139]
    v_mfma_f32_16x16x32_bf16 v[140:143], a[12:15], a[40:43], v[140:143]
    v_mfma_f32_16x16x32_bf16 v[148:151], a[16:19], a[40:43], v[148:151]
    s_waitcnt lgkmcnt(0)
    s_waitcnt vmcnt(18)
    s_barrier
    v_mfma_f32_16x16x32_bf16 v[48:51], a[64:67], a[44:47], v[48:51]
    ds_read_b64_tr_b16 a[20:21], v15 offset:30848
    v_mfma_f32_16x16x32_bf16 v[52:55], a[64:67], a[48:51], v[52:55]
    ds_read_b64_tr_b16 a[22:23], v15 offset:31360
    v_mfma_f32_16x16x32_bf16 v[56:59], a[64:67], a[52:55], v[56:59]
    ds_read_b64_tr_b16 a[24:25], v15 offset:30880
    v_mfma_f32_16x16x32_bf16 v[60:63], a[64:67], a[56:59], v[60:63]
    ds_read_b64_tr_b16 a[26:27], v15 offset:31392
    v_mfma_f32_16x16x32_bf16 v[64:67], a[68:71], a[44:47], v[64:67]
    v_mfma_f32_16x16x32_bf16 v[68:71], a[68:71], a[48:51], v[68:71]
    ds_read_b64_tr_b16 a[28:29], v15 offset:31872
    v_mfma_f32_16x16x32_bf16 v[72:75], a[68:71], a[52:55], v[72:75]
    ds_read_b64_tr_b16 a[30:31], v15 offset:32384
    v_mfma_f32_16x16x32_bf16 v[76:79], a[68:71], a[56:59], v[76:79]
    ds_read_b64_tr_b16 a[32:33], v15 offset:31904
    v_mfma_f32_16x16x32_bf16 v[80:83], a[72:75], a[44:47], v[80:83]
    v_mfma_f32_16x16x32_bf16 v[84:87], a[72:75], a[48:51], v[84:87]
    ds_read_b64_tr_b16 a[34:35], v15 offset:32416
    v_mfma_f32_16x16x32_bf16 v[88:91], a[72:75], a[52:55], v[88:91]
    ds_read_b128 a[0:3], v11 offset:21632
    v_mfma_f32_16x16x32_bf16 v[92:95], a[72:75], a[56:59], v[92:95]
    ds_read_b128 a[4:7], v11 offset:22656
    v_mfma_f32_16x16x32_bf16 v[96:99], a[76:79], a[44:47], v[96:99]
    ds_read_b64_tr_b16 a[36:37], v15 offset:32896
    v_mfma_f32_16x16x32_bf16 v[100:103], a[76:79], a[48:51], v[100:103]
    v_mfma_f32_16x16x32_bf16 v[104:107], a[76:79], a[52:55], v[104:107]
    ds_read_b64_tr_b16 a[38:39], v15 offset:33408
    v_mfma_f32_16x16x32_bf16 v[108:111], a[76:79], a[56:59], v[108:111]
    ds_read_b128 a[8:11], v11 offset:23936
    v_mfma_f32_16x16x32_bf16 v[112:115], a[44:47], a[80:83], v[112:115]
    ds_read_b128 a[12:15], v11 offset:24960
    v_mfma_f32_16x16x32_bf16 v[116:119], a[48:51], a[80:83], v[116:119]
    v_mfma_f32_16x16x32_bf16 v[120:123], a[52:55], a[80:83], v[120:123]
    ds_read_b64_tr_b16 a[40:41], v15 offset:32928
    v_mfma_f32_16x16x32_bf16 v[124:127], a[56:59], a[80:83], v[124:127]
    ds_read_b64_tr_b16 a[42:43], v15 offset:33440
    v_mfma_f32_16x16x32_bf16 v[144:147], a[60:63], a[80:83], v[144:147]
    ds_read_b128 a[16:19], v13 offset:23680
    v_mfma_f32_16x16x32_bf16 v[128:131], a[44:47], a[84:87], v[128:131]
    v_mfma_f32_16x16x32_bf16 v[132:135], a[48:51], a[84:87], v[132:135]
    v_mfma_f32_16x16x32_bf16 v[136:139], a[52:55], a[84:87], v[136:139]
    v_mfma_f32_16x16x32_bf16 v[140:143], a[56:59], a[84:87], v[140:143]
    v_mfma_f32_16x16x32_bf16 v[148:151], a[60:63], a[84:87], v[148:151]
    s_waitcnt lgkmcnt(0)
    s_waitcnt vmcnt(12)
    s_barrier
    v_mfma_f32_16x16x32_bf16 v[48:51], a[20:23], a[0:3], v[48:51]
    ds_read_b64_tr_b16 a[64:65], v15 offset:52480
    v_mfma_f32_16x16x32_bf16 v[52:55], a[20:23], a[4:7], v[52:55]
    ds_read_b64_tr_b16 a[66:67], v15 offset:52992
    v_mfma_f32_16x16x32_bf16 v[56:59], a[20:23], a[8:11], v[56:59]
    ds_read_b64_tr_b16 a[68:69], v15 offset:52512
    v_mfma_f32_16x16x32_bf16 v[60:63], a[20:23], a[12:15], v[60:63]
    ds_read_b64_tr_b16 a[70:71], v15 offset:53024
    v_mfma_f32_16x16x32_bf16 v[64:67], a[24:27], a[0:3], v[64:67]
    v_mfma_f32_16x16x32_bf16 v[68:71], a[24:27], a[4:7], v[68:71]
    ds_read_b64_tr_b16 a[72:73], v15 offset:53504
    v_mfma_f32_16x16x32_bf16 v[72:75], a[24:27], a[8:11], v[72:75]
    ds_read_b64_tr_b16 a[74:75], v15 offset:54016
    v_mfma_f32_16x16x32_bf16 v[76:79], a[24:27], a[12:15], v[76:79]
    ds_read_b64_tr_b16 a[76:77], v15 offset:53536
    v_mfma_f32_16x16x32_bf16 v[80:83], a[28:31], a[0:3], v[80:83]
    v_mfma_f32_16x16x32_bf16 v[84:87], a[28:31], a[4:7], v[84:87]
    ds_read_b64_tr_b16 a[78:79], v15 offset:54048
    v_mfma_f32_16x16x32_bf16 v[88:91], a[28:31], a[8:11], v[88:91]
    ds_read_b128 a[44:47], v11 offset:43264
    v_mfma_f32_16x16x32_bf16 v[92:95], a[28:31], a[12:15], v[92:95]
    ds_read_b128 a[48:51], v11 offset:44288
    v_mfma_f32_16x16x32_bf16 v[96:99], a[32:35], a[0:3], v[96:99]
    ds_read_b64_tr_b16 a[80:81], v15 offset:54528
    v_mfma_f32_16x16x32_bf16 v[100:103], a[32:35], a[4:7], v[100:103]
    v_mfma_f32_16x16x32_bf16 v[104:107], a[32:35], a[8:11], v[104:107]
    ds_read_b64_tr_b16 a[82:83], v15 offset:55040
    v_mfma_f32_16x16x32_bf16 v[108:111], a[32:35], a[12:15], v[108:111]
    ds_read_b128 a[52:55], v11 offset:45568
    v_mfma_f32_16x16x32_bf16 v[112:115], a[0:3], a[36:39], v[112:115]
    ds_read_b128 a[56:59], v11 offset:46592
    v_mfma_f32_16x16x32_bf16 v[116:119], a[4:7], a[36:39], v[116:119]
    v_mfma_f32_16x16x32_bf16 v[120:123], a[8:11], a[36:39], v[120:123]
    ds_read_b64_tr_b16 a[84:85], v15 offset:54560
    v_mfma_f32_16x16x32_bf16 v[124:127], a[12:15], a[36:39], v[124:127]
    ds_read_b64_tr_b16 a[86:87], v15 offset:55072
    v_mfma_f32_16x16x32_bf16 v[144:147], a[16:19], a[36:39], v[144:147]
    ds_read_b128 a[60:63], v13 offset:45312
    v_mfma_f32_16x16x32_bf16 v[128:131], a[0:3], a[40:43], v[128:131]
    v_mfma_f32_16x16x32_bf16 v[132:135], a[4:7], a[40:43], v[132:135]
    v_mfma_f32_16x16x32_bf16 v[136:139], a[8:11], a[40:43], v[136:139]
    v_mfma_f32_16x16x32_bf16 v[140:143], a[12:15], a[40:43], v[140:143]
    v_mfma_f32_16x16x32_bf16 v[148:151], a[16:19], a[40:43], v[148:151]
    s_waitcnt lgkmcnt(0)
    s_waitcnt vmcnt(6)
    s_barrier
    v_mfma_f32_16x16x32_bf16 v[48:51], a[64:67], a[44:47], v[48:51]
    ds_read_b64_tr_b16 a[20:21], v14 offset:9216
    v_mfma_f32_16x16x32_bf16 v[52:55], a[64:67], a[48:51], v[52:55]
    ds_read_b64_tr_b16 a[22:23], v14 offset:9728
    v_mfma_f32_16x16x32_bf16 v[56:59], a[64:67], a[52:55], v[56:59]
    ds_read_b64_tr_b16 a[24:25], v14 offset:9248
    v_mfma_f32_16x16x32_bf16 v[60:63], a[64:67], a[56:59], v[60:63]
    ds_read_b64_tr_b16 a[26:27], v14 offset:9760
    v_mfma_f32_16x16x32_bf16 v[64:67], a[68:71], a[44:47], v[64:67]
    v_mfma_f32_16x16x32_bf16 v[68:71], a[68:71], a[48:51], v[68:71]
    ds_read_b64_tr_b16 a[28:29], v14 offset:10240
    v_mfma_f32_16x16x32_bf16 v[72:75], a[68:71], a[52:55], v[72:75]
    ds_read_b64_tr_b16 a[30:31], v14 offset:10752
    v_mfma_f32_16x16x32_bf16 v[76:79], a[68:71], a[56:59], v[76:79]
    ds_read_b64_tr_b16 a[32:33], v14 offset:10272
    v_mfma_f32_16x16x32_bf16 v[80:83], a[72:75], a[44:47], v[80:83]
    v_mfma_f32_16x16x32_bf16 v[84:87], a[72:75], a[48:51], v[84:87]
    ds_read_b64_tr_b16 a[34:35], v14 offset:10784
    v_mfma_f32_16x16x32_bf16 v[88:91], a[72:75], a[52:55], v[88:91]
    ds_read_b128 a[0:3], v10 offset:0
    v_mfma_f32_16x16x32_bf16 v[92:95], a[72:75], a[56:59], v[92:95]
    ds_read_b128 a[4:7], v10 offset:1024
    v_mfma_f32_16x16x32_bf16 v[96:99], a[76:79], a[44:47], v[96:99]
    ds_read_b64_tr_b16 a[36:37], v14 offset:11264
    v_mfma_f32_16x16x32_bf16 v[100:103], a[76:79], a[48:51], v[100:103]
    v_mfma_f32_16x16x32_bf16 v[104:107], a[76:79], a[52:55], v[104:107]
    ds_read_b64_tr_b16 a[38:39], v14 offset:11776
    v_mfma_f32_16x16x32_bf16 v[108:111], a[76:79], a[56:59], v[108:111]
    ds_read_b128 a[8:11], v10 offset:2304
    v_mfma_f32_16x16x32_bf16 v[112:115], a[44:47], a[80:83], v[112:115]
    ds_read_b128 a[12:15], v10 offset:3328
    v_mfma_f32_16x16x32_bf16 v[116:119], a[48:51], a[80:83], v[116:119]
    v_mfma_f32_16x16x32_bf16 v[120:123], a[52:55], a[80:83], v[120:123]
    ds_read_b64_tr_b16 a[40:41], v14 offset:11296
    v_mfma_f32_16x16x32_bf16 v[124:127], a[56:59], a[80:83], v[124:127]
    ds_read_b64_tr_b16 a[42:43], v14 offset:11808
    v_mfma_f32_16x16x32_bf16 v[144:147], a[60:63], a[80:83], v[144:147]
    ds_read_b128 a[16:19], v12 offset:2048
    v_mfma_f32_16x16x32_bf16 v[128:131], a[44:47], a[84:87], v[128:131]
    v_mfma_f32_16x16x32_bf16 v[132:135], a[48:51], a[84:87], v[132:135]
    v_mfma_f32_16x16x32_bf16 v[136:139], a[52:55], a[84:87], v[136:139]
    v_mfma_f32_16x16x32_bf16 v[140:143], a[56:59], a[84:87], v[140:143]
    v_mfma_f32_16x16x32_bf16 v[148:151], a[60:63], a[84:87], v[148:151]
    s_waitcnt lgkmcnt(0)
    s_waitcnt vmcnt(0)
    s_barrier
    v_mfma_f32_16x16x32_bf16 v[48:51], a[20:23], a[0:3], v[48:51]
    ds_read_b64_tr_b16 a[64:65], v14 offset:30848
    v_mfma_f32_16x16x32_bf16 v[52:55], a[20:23], a[4:7], v[52:55]
    ds_read_b64_tr_b16 a[66:67], v14 offset:31360
    v_mfma_f32_16x16x32_bf16 v[56:59], a[20:23], a[8:11], v[56:59]
    ds_read_b64_tr_b16 a[68:69], v14 offset:30880
    v_mfma_f32_16x16x32_bf16 v[60:63], a[20:23], a[12:15], v[60:63]
    ds_read_b64_tr_b16 a[70:71], v14 offset:31392
    v_mfma_f32_16x16x32_bf16 v[64:67], a[24:27], a[0:3], v[64:67]
    v_mfma_f32_16x16x32_bf16 v[68:71], a[24:27], a[4:7], v[68:71]
    ds_read_b64_tr_b16 a[72:73], v14 offset:31872
    v_mfma_f32_16x16x32_bf16 v[72:75], a[24:27], a[8:11], v[72:75]
    ds_read_b64_tr_b16 a[74:75], v14 offset:32384
    v_mfma_f32_16x16x32_bf16 v[76:79], a[24:27], a[12:15], v[76:79]
    ds_read_b64_tr_b16 a[76:77], v14 offset:31904
    v_mfma_f32_16x16x32_bf16 v[80:83], a[28:31], a[0:3], v[80:83]
    v_mfma_f32_16x16x32_bf16 v[84:87], a[28:31], a[4:7], v[84:87]
    ds_read_b64_tr_b16 a[78:79], v14 offset:32416
    v_mfma_f32_16x16x32_bf16 v[88:91], a[28:31], a[8:11], v[88:91]
    ds_read_b128 a[44:47], v10 offset:21632
    v_mfma_f32_16x16x32_bf16 v[92:95], a[28:31], a[12:15], v[92:95]
    ds_read_b128 a[48:51], v10 offset:22656
    v_mfma_f32_16x16x32_bf16 v[96:99], a[32:35], a[0:3], v[96:99]
    ds_read_b64_tr_b16 a[80:81], v14 offset:32896
    v_mfma_f32_16x16x32_bf16 v[100:103], a[32:35], a[4:7], v[100:103]
    v_mfma_f32_16x16x32_bf16 v[104:107], a[32:35], a[8:11], v[104:107]
    ds_read_b64_tr_b16 a[82:83], v14 offset:33408
    v_mfma_f32_16x16x32_bf16 v[108:111], a[32:35], a[12:15], v[108:111]
    ds_read_b128 a[52:55], v10 offset:23936
    v_mfma_f32_16x16x32_bf16 v[112:115], a[0:3], a[36:39], v[112:115]
    ds_read_b128 a[56:59], v10 offset:24960
    v_mfma_f32_16x16x32_bf16 v[116:119], a[4:7], a[36:39], v[116:119]
    v_mfma_f32_16x16x32_bf16 v[120:123], a[8:11], a[36:39], v[120:123]
    ds_read_b64_tr_b16 a[84:85], v14 offset:32928
    v_mfma_f32_16x16x32_bf16 v[124:127], a[12:15], a[36:39], v[124:127]
    ds_read_b64_tr_b16 a[86:87], v14 offset:33440
    v_mfma_f32_16x16x32_bf16 v[144:147], a[16:19], a[36:39], v[144:147]
    ds_read_b128 a[60:63], v12 offset:23680
    v_mfma_f32_16x16x32_bf16 v[128:131], a[0:3], a[40:43], v[128:131]
    v_mfma_f32_16x16x32_bf16 v[132:135], a[4:7], a[40:43], v[132:135]
    v_mfma_f32_16x16x32_bf16 v[136:139], a[8:11], a[40:43], v[136:139]
    v_mfma_f32_16x16x32_bf16 v[140:143], a[12:15], a[40:43], v[140:143]
    v_mfma_f32_16x16x32_bf16 v[148:151], a[16:19], a[40:43], v[148:151]
    s_waitcnt lgkmcnt(0)
    v_mfma_f32_16x16x32_bf16 v[48:51], a[64:67], a[44:47], v[48:51]
    v_mfma_f32_16x16x32_bf16 v[52:55], a[64:67], a[48:51], v[52:55]
    v_mfma_f32_16x16x32_bf16 v[56:59], a[64:67], a[52:55], v[56:59]
    v_mfma_f32_16x16x32_bf16 v[60:63], a[64:67], a[56:59], v[60:63]
    v_mfma_f32_16x16x32_bf16 v[64:67], a[68:71], a[44:47], v[64:67]
    v_mfma_f32_16x16x32_bf16 v[68:71], a[68:71], a[48:51], v[68:71]
    v_mfma_f32_16x16x32_bf16 v[72:75], a[68:71], a[52:55], v[72:75]
    v_mfma_f32_16x16x32_bf16 v[76:79], a[68:71], a[56:59], v[76:79]
    v_mfma_f32_16x16x32_bf16 v[80:83], a[72:75], a[44:47], v[80:83]
    v_mfma_f32_16x16x32_bf16 v[84:87], a[72:75], a[48:51], v[84:87]
    v_mfma_f32_16x16x32_bf16 v[88:91], a[72:75], a[52:55], v[88:91]
    v_mfma_f32_16x16x32_bf16 v[92:95], a[72:75], a[56:59], v[92:95]
    v_mfma_f32_16x16x32_bf16 v[96:99], a[76:79], a[44:47], v[96:99]
    v_mfma_f32_16x16x32_bf16 v[100:103], a[76:79], a[48:51], v[100:103]
    v_mfma_f32_16x16x32_bf16 v[104:107], a[76:79], a[52:55], v[104:107]
    v_mfma_f32_16x16x32_bf16 v[108:111], a[76:79], a[56:59], v[108:111]
    v_mfma_f32_16x16x32_bf16 v[112:115], a[44:47], a[80:83], v[112:115]
    v_mfma_f32_16x16x32_bf16 v[116:119], a[48:51], a[80:83], v[116:119]
    v_mfma_f32_16x16x32_bf16 v[120:123], a[52:55], a[80:83], v[120:123]
    v_mfma_f32_16x16x32_bf16 v[124:127], a[56:59], a[80:83], v[124:127]
    v_mfma_f32_16x16x32_bf16 v[144:147], a[60:63], a[80:83], v[144:147]
    v_mfma_f32_16x16x32_bf16 v[128:131], a[44:47], a[84:87], v[128:131]
    v_mfma_f32_16x16x32_bf16 v[132:135], a[48:51], a[84:87], v[132:135]
    v_mfma_f32_16x16x32_bf16 v[136:139], a[52:55], a[84:87], v[136:139]
    v_mfma_f32_16x16x32_bf16 v[140:143], a[56:59], a[84:87], v[140:143]
    v_mfma_f32_16x16x32_bf16 v[148:151], a[60:63], a[84:87], v[148:151]
    v_and_b32 v6, 15, v1
    v_lshlrev_b32 v6, 4, v6
    v_add_u32 v6, 129792, v6
    v_lshrrev_b32 v7, 4, v1
    v_lshlrev_b32 v7, 4, v7
    v_add_u32 v7, 132864, v7
    s_lshl_b32 s20, s3, 11
    s_add_u32 s20, s20, 135168
    v_lshl_add_u32 v8, v1, 4, s20
    v_xor_b32 v9, 2048, v8
    ds_read_b128 v[216:219], v6 offset:1024
    ds_read_b128 v[220:223], v6 offset:1280
    ds_read_b128 v[224:227], v6 offset:1536
    ds_read_b128 v[228:231], v6 offset:1792
    v_mov_b32 v244, 0x3f803f80
    v_mov_b32 v245, 0x3f803f80
    v_mov_b32 v246, 0x3f803f80
    v_mov_b32 v247, 0x3f803f80
    ds_read_b128 v[236:239], v7 offset:512
    ds_read_b128 v[240:243], v7 offset:1280
    s_waitcnt lgkmcnt(1)
    v_pk_fma_f32 v[144:145], v[236:237], v[32:33], v[144:145] op_sel_hi:[1,0,1]
    s_waitcnt lgkmcnt(0)
    v_pk_mul_f32 v[144:145], v[144:145], v[240:241]
    v_cvt_pk_bf16_f32 v12, v144, v145
    v_pk_fma_f32 v[146:147], v[238:239], v[32:33], v[146:147] op_sel_hi:[1,0,1]
    v_pk_mul_f32 v[146:147], v[146:147], v[242:243]
    v_cvt_pk_bf16_f32 v13, v146, v147
    v_pk_fma_f32 v[148:149], v[236:237], v[32:33], v[148:149] op_sel:[0,1,0] op_sel_hi:[1,1,1]
    v_pk_mul_f32 v[148:149], v[148:149], v[240:241]
    v_cvt_pk_bf16_f32 v14, v148, v149
    v_pk_fma_f32 v[150:151], v[238:239], v[32:33], v[150:151] op_sel:[0,1,0] op_sel_hi:[1,1,1]
    v_pk_mul_f32 v[150:151], v[150:151], v[242:243]
    v_cvt_pk_bf16_f32 v15, v150, v151
    ds_write_b128 v8, v[12:15] offset:1024
    v_pk_fma_f32 v[80:81], v[24:25], v[216:217], v[80:81] op_sel_hi:[1,0,1]
    v_pk_mul_f32 v[80:81], v[80:81], v[216:217] op_sel:[0,1] op_sel_hi:[1,1]
    v_cvt_pk_bf16_f32 v180, v80, v81
    v_pk_fma_f32 v[82:83], v[26:27], v[216:217], v[82:83] op_sel_hi:[1,0,1]
    v_pk_mul_f32 v[82:83], v[82:83], v[216:217] op_sel:[0,1] op_sel_hi:[1,1]
    v_cvt_pk_bf16_f32 v181, v82, v83
    v_pk_fma_f32 v[96:97], v[28:29], v[216:217], v[96:97] op_sel_hi:[1,0,1]
    v_pk_mul_f32 v[96:97], v[96:97], v[216:217] op_sel:[0,1] op_sel_hi:[1,1]
    v_cvt_pk_bf16_f32 v182, v96, v97
    v_pk_fma_f32 v[98:99], v[30:31], v[216:217], v[98:99] op_sel_hi:[1,0,1]
    v_pk_mul_f32 v[98:99], v[98:99], v[216:217] op_sel:[0,1] op_sel_hi:[1,1]
    v_cvt_pk_bf16_f32 v183, v98, v99
    ds_read_b128 v[236:239], v7 offset:256
    ds_read_b128 v[240:243], v7 offset:1024
    s_waitcnt lgkmcnt(1)
    v_pk_fma_f32 v[112:113], v[236:237], v[32:33], v[112:113] op_sel_hi:[1,0,1]
    s_waitcnt lgkmcnt(0)
    v_pk_mul_f32 v[112:113], v[112:113], v[240:241]
    v_cvt_pk_bf16_f32 v198, v112, v113
    v_pk_fma_f32 v[114:115], v[238:239], v[32:33], v[114:115] op_sel_hi:[1,0,1]
    v_pk_mul_f32 v[114:115], v[114:115], v[242:243]
    v_cvt_pk_bf16_f32 v199, v114, v115
    v_pk_fma_f32 v[128:129], v[236:237], v[32:33], v[128:129] op_sel:[0,1,0] op_sel_hi:[1,1,1]
    v_pk_mul_f32 v[128:129], v[128:129], v[240:241]
    v_cvt_pk_bf16_f32 v208, v128, v129
    v_pk_fma_f32 v[130:131], v[238:239], v[32:33], v[130:131] op_sel:[0,1,0] op_sel_hi:[1,1,1]
    v_pk_mul_f32 v[130:131], v[130:131], v[242:243]
    v_cvt_pk_bf16_f32 v209, v130, v131
    v_pk_fma_f32 v[84:85], v[24:25], v[220:221], v[84:85] op_sel_hi:[1,0,1]
    v_pk_mul_f32 v[84:85], v[84:85], v[220:221] op_sel:[0,1] op_sel_hi:[1,1]
    v_cvt_pk_bf16_f32 v184, v84, v85
    v_pk_fma_f32 v[86:87], v[26:27], v[220:221], v[86:87] op_sel_hi:[1,0,1]
    v_pk_mul_f32 v[86:87], v[86:87], v[220:221] op_sel:[0,1] op_sel_hi:[1,1]
    v_cvt_pk_bf16_f32 v185, v86, v87
    v_pk_fma_f32 v[100:101], v[28:29], v[220:221], v[100:101] op_sel_hi:[1,0,1]
    v_pk_mul_f32 v[100:101], v[100:101], v[220:221] op_sel:[0,1] op_sel_hi:[1,1]
    v_cvt_pk_bf16_f32 v186, v100, v101
    v_pk_fma_f32 v[102:103], v[30:31], v[220:221], v[102:103] op_sel_hi:[1,0,1]
    v_pk_mul_f32 v[102:103], v[102:103], v[220:221] op_sel:[0,1] op_sel_hi:[1,1]
    v_cvt_pk_bf16_f32 v187, v102, v103
    ds_read_b128 v[236:239], v7 offset:320
    ds_read_b128 v[240:243], v7 offset:1088
    s_waitcnt lgkmcnt(1)
    v_pk_fma_f32 v[116:117], v[236:237], v[32:33], v[116:117] op_sel_hi:[1,0,1]
    s_waitcnt lgkmcnt(0)
    v_pk_mul_f32 v[116:117], v[116:117], v[240:241]
    v_cvt_pk_bf16_f32 v200, v116, v117
    v_pk_fma_f32 v[118:119], v[238:239], v[32:33], v[118:119] op_sel_hi:[1,0,1]
    v_pk_mul_f32 v[118:119], v[118:119], v[242:243]
    v_cvt_pk_bf16_f32 v201, v118, v119
    v_pk_fma_f32 v[132:133], v[236:237], v[32:33], v[132:133] op_sel:[0,1,0] op_sel_hi:[1,1,1]
    v_pk_mul_f32 v[132:133], v[132:133], v[240:241]
    v_cvt_pk_bf16_f32 v210, v132, v133
    v_pk_fma_f32 v[134:135], v[238:239], v[32:33], v[134:135] op_sel:[0,1,0] op_sel_hi:[1,1,1]
    v_pk_mul_f32 v[134:135], v[134:135], v[242:243]
    v_cvt_pk_bf16_f32 v211, v134, v135
    v_pk_fma_f32 v[88:89], v[24:25], v[224:225], v[88:89] op_sel_hi:[1,0,1]
    v_pk_mul_f32 v[88:89], v[88:89], v[224:225] op_sel:[0,1] op_sel_hi:[1,1]
    v_cvt_pk_bf16_f32 v188, v88, v89
    v_pk_fma_f32 v[90:91], v[26:27], v[224:225], v[90:91] op_sel_hi:[1,0,1]
    v_pk_mul_f32 v[90:91], v[90:91], v[224:225] op_sel:[0,1] op_sel_hi:[1,1]
    v_cvt_pk_bf16_f32 v189, v90, v91
    v_pk_fma_f32 v[104:105], v[28:29], v[224:225], v[104:105] op_sel_hi:[1,0,1]
    v_pk_mul_f32 v[104:105], v[104:105], v[224:225] op_sel:[0,1] op_sel_hi:[1,1]
    v_cvt_pk_bf16_f32 v190, v104, v105
    v_pk_fma_f32 v[106:107], v[30:31], v[224:225], v[106:107] op_sel_hi:[1,0,1]
    v_pk_mul_f32 v[106:107], v[106:107], v[224:225] op_sel:[0,1] op_sel_hi:[1,1]
    v_cvt_pk_bf16_f32 v191, v106, v107
    ds_read_b128 v[236:239], v7 offset:384
    ds_read_b128 v[240:243], v7 offset:1152
    s_waitcnt lgkmcnt(1)
    v_pk_fma_f32 v[120:121], v[236:237], v[32:33], v[120:121] op_sel_hi:[1,0,1]
    s_waitcnt lgkmcnt(0)
    v_pk_mul_f32 v[120:121], v[120:121], v[240:241]
    v_cvt_pk_bf16_f32 v202, v120, v121
    v_pk_fma_f32 v[122:123], v[238:239], v[32:33], v[122:123] op_sel_hi:[1,0,1]
    v_pk_mul_f32 v[122:123], v[122:123], v[242:243]
    v_cvt_pk_bf16_f32 v203, v122, v123
    v_pk_fma_f32 v[136:137], v[236:237], v[32:33], v[136:137] op_sel:[0,1,0] op_sel_hi:[1,1,1]
    v_pk_mul_f32 v[136:137], v[136:137], v[240:241]
    v_cvt_pk_bf16_f32 v212, v136, v137
    v_pk_fma_f32 v[138:139], v[238:239], v[32:33], v[138:139] op_sel:[0,1,0] op_sel_hi:[1,1,1]
    v_pk_mul_f32 v[138:139], v[138:139], v[242:243]
    v_cvt_pk_bf16_f32 v213, v138, v139
    v_pk_fma_f32 v[92:93], v[24:25], v[228:229], v[92:93] op_sel_hi:[1,0,1]
    v_pk_mul_f32 v[92:93], v[92:93], v[228:229] op_sel:[0,1] op_sel_hi:[1,1]
    v_cvt_pk_bf16_f32 v192, v92, v93
    v_pk_fma_f32 v[94:95], v[26:27], v[228:229], v[94:95] op_sel_hi:[1,0,1]
    v_pk_mul_f32 v[94:95], v[94:95], v[228:229] op_sel:[0,1] op_sel_hi:[1,1]
    v_cvt_pk_bf16_f32 v193, v94, v95
    v_pk_fma_f32 v[108:109], v[28:29], v[228:229], v[108:109] op_sel_hi:[1,0,1]
    v_pk_mul_f32 v[108:109], v[108:109], v[228:229] op_sel:[0,1] op_sel_hi:[1,1]
    v_cvt_pk_bf16_f32 v194, v108, v109
    v_pk_fma_f32 v[110:111], v[30:31], v[228:229], v[110:111] op_sel_hi:[1,0,1]
    v_pk_mul_f32 v[110:111], v[110:111], v[228:229] op_sel:[0,1] op_sel_hi:[1,1]
    v_cvt_pk_bf16_f32 v195, v110, v111
    ds_read_b128 v[236:239], v7 offset:448
    ds_read_b128 v[240:243], v7 offset:1216
    s_waitcnt lgkmcnt(1)
    v_pk_fma_f32 v[124:125], v[236:237], v[32:33], v[124:125] op_sel_hi:[1,0,1]
    s_waitcnt lgkmcnt(0)
    v_pk_mul_f32 v[124:125], v[124:125], v[240:241]
    v_cvt_pk_bf16_f32 v204, v124, v125
    v_pk_fma_f32 v[126:127], v[238:239], v[32:33], v[126:127] op_sel_hi:[1,0,1]
    v_pk_mul_f32 v[126:127], v[126:127], v[242:243]
    v_cvt_pk_bf16_f32 v205, v126, v127
    v_pk_fma_f32 v[140:141], v[236:237], v[32:33], v[140:141] op_sel:[0,1,0] op_sel_hi:[1,1,1]
    v_pk_mul_f32 v[140:141], v[140:141], v[240:241]
    v_cvt_pk_bf16_f32 v214, v140, v141
    v_pk_fma_f32 v[142:143], v[238:239], v[32:33], v[142:143] op_sel:[0,1,0] op_sel_hi:[1,1,1]
    v_pk_mul_f32 v[142:143], v[142:143], v[242:243]
    v_cvt_pk_bf16_f32 v215, v142, v143
    s_waitcnt lgkmcnt(0)
    s_barrier
    ds_read_b128 v[176:179], v9
    ds_read_b64 v[196:197], v9 offset:1024
    ds_read_b64 v[206:207], v9 offset:1032
    v_pk_fma_f32 v[48:49], v[16:17], v[216:217], v[48:49] op_sel_hi:[1,0,1]
    v_pk_mul_f32 v[48:49], v[48:49], v[218:219] op_sel_hi:[1,0]
    v_cvt_pk_bf16_f32 v160, v48, v49
    v_pk_fma_f32 v[50:51], v[18:19], v[216:217], v[50:51] op_sel_hi:[1,0,1]
    v_pk_mul_f32 v[50:51], v[50:51], v[218:219] op_sel_hi:[1,0]
    v_cvt_pk_bf16_f32 v161, v50, v51
    v_pk_fma_f32 v[64:65], v[20:21], v[216:217], v[64:65] op_sel_hi:[1,0,1]
    v_pk_mul_f32 v[64:65], v[64:65], v[218:219] op_sel_hi:[1,0]
    v_cvt_pk_bf16_f32 v162, v64, v65
    v_pk_fma_f32 v[66:67], v[22:23], v[216:217], v[66:67] op_sel_hi:[1,0,1]
    v_pk_mul_f32 v[66:67], v[66:67], v[218:219] op_sel_hi:[1,0]
    v_cvt_pk_bf16_f32 v163, v66, v67
    v_pk_fma_f32 v[52:53], v[16:17], v[220:221], v[52:53] op_sel_hi:[1,0,1]
    v_pk_mul_f32 v[52:53], v[52:53], v[222:223] op_sel_hi:[1,0]
    v_cvt_pk_bf16_f32 v164, v52, v53
    v_pk_fma_f32 v[54:55], v[18:19], v[220:221], v[54:55] op_sel_hi:[1,0,1]
    v_pk_mul_f32 v[54:55], v[54:55], v[222:223] op_sel_hi:[1,0]
    v_cvt_pk_bf16_f32 v165, v54, v55
    v_pk_fma_f32 v[68:69], v[20:21], v[220:221], v[68:69] op_sel_hi:[1,0,1]
    v_pk_mul_f32 v[68:69], v[68:69], v[222:223] op_sel_hi:[1,0]
    v_cvt_pk_bf16_f32 v166, v68, v69
    v_pk_fma_f32 v[70:71], v[22:23], v[220:221], v[70:71] op_sel_hi:[1,0,1]
    v_pk_mul_f32 v[70:71], v[70:71], v[222:223] op_sel_hi:[1,0]
    v_cvt_pk_bf16_f32 v167, v70, v71
    v_pk_fma_f32 v[56:57], v[16:17], v[224:225], v[56:57] op_sel_hi:[1,0,1]
    v_pk_mul_f32 v[56:57], v[56:57], v[226:227] op_sel_hi:[1,0]
    v_cvt_pk_bf16_f32 v168, v56, v57
    v_pk_fma_f32 v[58:59], v[18:19], v[224:225], v[58:59] op_sel_hi:[1,0,1]
    v_pk_mul_f32 v[58:59], v[58:59], v[226:227] op_sel_hi:[1,0]
    v_cvt_pk_bf16_f32 v169, v58, v59
    v_pk_fma_f32 v[72:73], v[20:21], v[224:225], v[72:73] op_sel_hi:[1,0,1]
    v_pk_mul_f32 v[72:73], v[72:73], v[226:227] op_sel_hi:[1,0]
    v_cvt_pk_bf16_f32 v170, v72, v73
    v_pk_fma_f32 v[74:75], v[22:23], v[224:225], v[74:75] op_sel_hi:[1,0,1]
    v_pk_mul_f32 v[74:75], v[74:75], v[226:227] op_sel_hi:[1,0]
    v_cvt_pk_bf16_f32 v171, v74, v75
    v_pk_fma_f32 v[60:61], v[16:17], v[228:229], v[60:61] op_sel_hi:[1,0,1]
    v_pk_mul_f32 v[60:61], v[60:61], v[230:231] op_sel_hi:[1,0]
    v_cvt_pk_bf16_f32 v172, v60, v61
    v_pk_fma_f32 v[62:63], v[18:19], v[228:229], v[62:63] op_sel_hi:[1,0,1]
    v_pk_mul_f32 v[62:63], v[62:63], v[230:231] op_sel_hi:[1,0]
    v_cvt_pk_bf16_f32 v173, v62, v63
    v_pk_fma_f32 v[76:77], v[20:21], v[228:229], v[76:77] op_sel_hi:[1,0,1]
    v_pk_mul_f32 v[76:77], v[76:77], v[230:231] op_sel_hi:[1,0]
    v_cvt_pk_bf16_f32 v174, v76, v77
    v_pk_fma_f32 v[78:79], v[22:23], v[228:229], v[78:79] op_sel_hi:[1,0,1]
    v_pk_mul_f32 v[78:79], v[78:79], v[230:231] op_sel_hi:[1,0]
    v_cvt_pk_bf16_f32 v175, v78, v79
    v_mfma_f32_16x16x32_bf16 v[56:59], v[180:183], v[164:167], v[36:39]
    v_mfma_f32_16x16x32_bf16 v[60:63], v[184:187], v[164:167], v[40:43]
    v_mfma_f32_16x16x32_bf16 v[64:67], v[184:187], v[168:171], v[36:39]
    v_mfma_f32_16x16x32_bf16 v[68:71], v[188:191], v[168:171], v[40:43]
    v_mfma_f32_16x16x32_bf16 v[72:75], v[188:191], v[172:175], v[36:39]
    v_mfma_f32_16x16x32_bf16 v[76:79], v[192:195], v[172:175], v[40:43]
    s_waitcnt lgkmcnt(2)
    v_mfma_f32_16x16x32_bf16 v[48:51], v[176:179], v[160:163], v[36:39]
    v_mfma_f32_16x16x32_bf16 v[52:55], v[180:183], v[160:163], v[40:43]
    v_max3_f32 v82, v56, v57, v58
    v_max3_f32 v83, v59, v60, v61
    v_max3_f32 v82, v82, v62, v63
    v_max_f32 v82, v82, v83
    v_mov_b32 v83, v82
    v_max3_f32 v84, v64, v65, v66
    v_max3_f32 v85, v67, v68, v69
    v_max3_f32 v84, v84, v70, v71
    v_max_f32 v84, v84, v85
    v_mov_b32 v85, v84
    v_max3_f32 v86, v72, v73, v74
    v_max3_f32 v87, v75, v76, v77
    v_max3_f32 v86, v86, v78, v79
    v_max_f32 v86, v86, v87
    v_mov_b32 v87, v86
    v_max3_f32 v80, v48, v49, v50
    v_max3_f32 v81, v51, v52, v53
    v_max3_f32 v80, v80, v54, v55
    v_max_f32 v80, v80, v81
    v_mov_b32 v81, v80
    v_permlane16_swap_b32 v82, v83
    v_permlane16_swap_b32 v84, v85
    v_permlane16_swap_b32 v86, v87
    v_permlane16_swap_b32 v80, v81
    v_max_f32 v82, v82, v83
    v_mov_b32 v83, v82
    v_max_f32 v84, v84, v85
    v_mov_b32 v85, v84
    v_max_f32 v86, v86, v87
    v_mov_b32 v87, v86
    v_max_f32 v80, v80, v81
    v_mov_b32 v81, v80
    v_permlane32_swap_b32 v82, v83
    v_permlane32_swap_b32 v84, v85
    v_permlane32_swap_b32 v86, v87
    v_permlane32_swap_b32 v80, v81
    v_max_f32 v82, v82, v83
    v_max_f32 v84, v84, v85
    v_max_f32 v86, v86, v87
    v_max_f32 v80, v80, v81
    s_lshl_b32 s20, s7, 1
    s_add_u32 s20, s20, s9
    s_lshl_b32 s20, s20, 17
    s_lshl_b32 s21, s6, 13
    s_add_u32 s20, s20, s21
    s_add_u32 s20, s20, 4096
    v_lshlrev_b32 v6, 4, v1
    v_pk_add_f32 v[56:57], v[56:57], v[82:83] op_sel_hi:[1,0] neg_lo:[0,1] neg_hi:[0,1]
    v_pk_add_f32 v[58:59], v[58:59], v[82:83] op_sel_hi:[1,0] neg_lo:[0,1] neg_hi:[0,1]
    v_pk_add_f32 v[60:61], v[60:61], v[82:83] op_sel_hi:[1,0] neg_lo:[0,1] neg_hi:[0,1]
    v_pk_add_f32 v[62:63], v[62:63], v[82:83] op_sel_hi:[1,0] neg_lo:[0,1] neg_hi:[0,1]
    v_exp_f32 v56, v56
    v_exp_f32 v57, v57
    v_exp_f32 v58, v58
    v_exp_f32 v59, v59
    v_exp_f32 v60, v60
    v_exp_f32 v61, v61
    v_exp_f32 v62, v62
    v_exp_f32 v63, v63
    v_cvt_pk_bf16_f32 v92, v56, v57
    v_cvt_pk_bf16_f32 v93, v58, v59
    v_cvt_pk_bf16_f32 v94, v60, v61
    v_cvt_pk_bf16_f32 v95, v62, v63
    s_nop 1
    v_mfma_f32_16x16x32_bf16 v[124:127], v[244:247], v[92:95], 0
    v_mfma_f32_16x16x32_bf16 v[116:119], v[198:201], v[92:95], 0
    v_mfma_f32_16x16x32_bf16 v[120:123], v[208:211], v[92:95], 0
    v_pk_add_f32 v[64:65], v[64:65], v[84:85] op_sel_hi:[1,0] neg_lo:[0,1] neg_hi:[0,1]
    v_pk_add_f32 v[66:67], v[66:67], v[84:85] op_sel_hi:[1,0] neg_lo:[0,1] neg_hi:[0,1]
    v_pk_add_f32 v[68:69], v[68:69], v[84:85] op_sel_hi:[1,0] neg_lo:[0,1] neg_hi:[0,1]
    v_pk_add_f32 v[70:71], v[70:71], v[84:85] op_sel_hi:[1,0] neg_lo:[0,1] neg_hi:[0,1]
    v_exp_f32 v64, v64
    v_exp_f32 v65, v65
    v_exp_f32 v66, v66
    v_exp_f32 v67, v67
    v_exp_f32 v68, v68
    v_exp_f32 v69, v69
    v_exp_f32 v70, v70
    v_exp_f32 v71, v71
    v_cvt_pk_bf16_f32 v96, v64, v65
    v_cvt_pk_bf16_f32 v97, v66, v67
    v_cvt_pk_bf16_f32 v98, v68, v69
    v_cvt_pk_bf16_f32 v99, v70, v71
    s_nop 1
    v_mfma_f32_16x16x32_bf16 v[136:139], v[244:247], v[96:99], 0
    v_mfma_f32_16x16x32_bf16 v[128:131], v[200:203], v[96:99], 0
    v_mfma_f32_16x16x32_bf16 v[132:135], v[210:213], v[96:99], 0
    v_pk_add_f32 v[72:73], v[72:73], v[86:87] op_sel_hi:[1,0] neg_lo:[0,1] neg_hi:[0,1]
    v_pk_add_f32 v[74:75], v[74:75], v[86:87] op_sel_hi:[1,0] neg_lo:[0,1] neg_hi:[0,1]
    v_pk_add_f32 v[76:77], v[76:77], v[86:87] op_sel_hi:[1,0] neg_lo:[0,1] neg_hi:[0,1]
    v_pk_add_f32 v[78:79], v[78:79], v[86:87] op_sel_hi:[1,0] neg_lo:[0,1] neg_hi:[0,1]
    v_exp_f32 v72, v72
    v_exp_f32 v73, v73
    v_exp_f32 v74, v74
    v_exp_f32 v75, v75
    v_exp_f32 v76, v76
    v_exp_f32 v77, v77
    v_exp_f32 v78, v78
    v_exp_f32 v79, v79
    v_cvt_pk_bf16_f32 v100, v72, v73
    v_cvt_pk_bf16_f32 v101, v74, v75
    v_cvt_pk_bf16_f32 v102, v76, v77
    v_cvt_pk_bf16_f32 v103, v78, v79
    s_nop 1
    v_mfma_f32_16x16x32_bf16 v[148:151], v[244:247], v[100:103], 0
    v_mfma_f32_16x16x32_bf16 v[140:143], v[202:205], v[100:103], 0
    v_mfma_f32_16x16x32_bf16 v[144:147], v[212:215], v[100:103], 0
    v_pk_add_f32 v[48:49], v[48:49], v[80:81] op_sel_hi:[1,0] neg_lo:[0,1] neg_hi:[0,1]
    v_pk_add_f32 v[50:51], v[50:51], v[80:81] op_sel_hi:[1,0] neg_lo:[0,1] neg_hi:[0,1]
    v_pk_add_f32 v[52:53], v[52:53], v[80:81] op_sel_hi:[1,0] neg_lo:[0,1] neg_hi:[0,1]
    v_pk_add_f32 v[54:55], v[54:55], v[80:81] op_sel_hi:[1,0] neg_lo:[0,1] neg_hi:[0,1]
    v_exp_f32 v48, v48
    v_exp_f32 v49, v49
    v_exp_f32 v50, v50
    v_exp_f32 v51, v51
    v_exp_f32 v52, v52
    v_exp_f32 v53, v53
    v_exp_f32 v54, v54
    v_exp_f32 v55, v55
    v_cvt_pk_bf16_f32 v88, v48, v49
    v_cvt_pk_bf16_f32 v89, v50, v51
    v_cvt_pk_bf16_f32 v90, v52, v53
    v_cvt_pk_bf16_f32 v91, v54, v55
    s_nop 1
    v_mfma_f32_16x16x32_bf16 v[112:115], v[244:247], v[88:91], 0
    s_waitcnt lgkmcnt(1)
    v_mfma_f32_16x16x32_bf16 v[104:107], v[196:199], v[88:91], 0
    s_waitcnt lgkmcnt(0)
    v_mfma_f32_16x16x32_bf16 v[108:111], v[206:209], v[88:91], 0
    v_rcp_f32 v124, v124
    s_nop 0
    v_pk_mul_f32 v[116:117], v[116:117], v[124:125] op_sel_hi:[1,0]
    v_pk_mul_f32 v[118:119], v[118:119], v[124:125] op_sel_hi:[1,0]
    v_pk_mul_f32 v[120:121], v[120:121], v[124:125] op_sel_hi:[1,0]
    v_pk_mul_f32 v[122:123], v[122:123], v[124:125] op_sel_hi:[1,0]
    v_cvt_pk_bf16_f32 v164, v116, v117
    v_cvt_pk_bf16_f32 v165, v118, v119
    v_cvt_pk_bf16_f32 v166, v120, v121
    v_cvt_pk_bf16_f32 v167, v122, v123
    buffer_store_dwordx4 v[164:167], v6, s[40:43], s20 offen offset:1024
    v_rcp_f32 v136, v136
    s_nop 0
    v_pk_mul_f32 v[128:129], v[128:129], v[136:137] op_sel_hi:[1,0]
    v_pk_mul_f32 v[130:131], v[130:131], v[136:137] op_sel_hi:[1,0]
    v_pk_mul_f32 v[132:133], v[132:133], v[136:137] op_sel_hi:[1,0]
    v_pk_mul_f32 v[134:135], v[134:135], v[136:137] op_sel_hi:[1,0]
    v_cvt_pk_bf16_f32 v168, v128, v129
    v_cvt_pk_bf16_f32 v169, v130, v131
    v_cvt_pk_bf16_f32 v170, v132, v133
    v_cvt_pk_bf16_f32 v171, v134, v135
    buffer_store_dwordx4 v[168:171], v6, s[40:43], s20 offen offset:2048
    v_rcp_f32 v148, v148
    s_nop 0
    v_pk_mul_f32 v[140:141], v[140:141], v[148:149] op_sel_hi:[1,0]
    v_pk_mul_f32 v[142:143], v[142:143], v[148:149] op_sel_hi:[1,0]
    v_pk_mul_f32 v[144:145], v[144:145], v[148:149] op_sel_hi:[1,0]
    v_pk_mul_f32 v[146:147], v[146:147], v[148:149] op_sel_hi:[1,0]
    v_cvt_pk_bf16_f32 v172, v140, v141
    v_cvt_pk_bf16_f32 v173, v142, v143
    v_cvt_pk_bf16_f32 v174, v144, v145
    v_cvt_pk_bf16_f32 v175, v146, v147
    buffer_store_dwordx4 v[172:175], v6, s[40:43], s20 offen offset:3072
    v_rcp_f32 v112, v112
    s_nop 0
    v_pk_mul_f32 v[104:105], v[104:105], v[112:113] op_sel_hi:[1,0]
    v_pk_mul_f32 v[106:107], v[106:107], v[112:113] op_sel_hi:[1,0]
    v_pk_mul_f32 v[108:109], v[108:109], v[112:113] op_sel_hi:[1,0]
    v_pk_mul_f32 v[110:111], v[110:111], v[112:113] op_sel_hi:[1,0]
    v_cvt_pk_bf16_f32 v160, v104, v105
    v_cvt_pk_bf16_f32 v161, v106, v107
    v_cvt_pk_bf16_f32 v162, v108, v109
    v_cvt_pk_bf16_f32 v163, v110, v111
    buffer_store_dwordx4 v[160:163], v6, s[40:43], s20 offen offset:0
    s_endpgm
qkv1_kernel_end:
    s_endpgm
.text
.globl wo1_kernel
.p2align 8
.type wo1_kernel,@function
wo1_kernel:
    s_cmp_ge_u32 s2, 256
    s_cbranch_scc1 wo1_kernel_end
    s_load_dwordx2 s[10:11], s[0:1], 72
    s_load_dwordx2 s[12:13], s[0:1], 16
    v_lshrrev_b32 v2, 6, v0
    v_and_b32 v1, 63, v0
    v_readfirstlane_b32 s3, v2
    s_and_b32 s4, s2, 7
    s_lshr_b32 s5, s2, 3
    s_lshr_b32 s6, s4, 1
    s_lshl_b32 s6, s6, 2
    s_and_b32 s7, s5, 3
    s_add_u32 s6, s6, s7
    s_and_b32 s7, s4, 1
    s_lshl_b32 s7, s7, 3
    s_lshr_b32 s8, s5, 2
    s_add_u32 s7, s7, s8
    s_lshl_b32 s20, s6, 13
    s_lshl_b32 s21, s3, 11
    s_add_u32 s20, s20, s21
    v_lshl_add_u32 v4, v1, 4, s20
    v_bfe_u32 v8, v1, 3, 1
    v_lshrrev_b32 v9, 4, v1
    v_lshl_add_u32 v8, v9, 3, v8
    s_lshl_b32 s21, s3, 1
    v_add_u32 v8, s21, v8
    v_lshlrev_b32 v8, 11, v8
    v_and_b32 v9, 7, v1
    v_lshl_add_u32 v8, v9, 4, v8
    s_lshl_b32 s21, s7, 7
    v_add_u32 v5, s21, v8
    v_add_u32 v6, 64512, v5
    v_bfe_u32 v8, v1, 3, 2
    v_mul_u32_u24 v8, 2080, v8
    v_bfe_u32 v9, v1, 2, 1
    v_lshl_add_u32 v8, v9, 7, v8
    v_bfe_u32 v9, v1, 5, 1
    v_lshl_add_u32 v8, v9, 8, v8
    v_and_b32 v9, 3, v1
    v_lshl_add_u32 v7, v9, 3, v8
    s_mul_i32 s22, s3, 2080
    s_mov_b32 s23, 0
    s_mov_b32 s24, 0x20000
    s_mov_b32 s25, 0
    s_waitcnt lgkmcnt(0)
    s_add_u32 s28, s10, 4194304
    s_addc_u32 s29, s11, 0
    s_mov_b32 s30, 4194304
    s_mov_b32 s31, 0x20000
    s_mov_b32 s32, s12
    s_mov_b32 s33, s13
    s_mov_b32 s34, 2097152
    s_mov_b32 s35, 0x20000
    s_add_u32 m0, s22, 0
    s_nop 0
    buffer_load_dwordx4 v5, s[32:35], s25 offen lds
    buffer_load_dwordx4 v6, s[32:35], s25 offen offset:1024 lds
    s_add_u32 s25, s25, 0x20000
    buffer_load_dwordx4 v[48:51], v4, s[28:31], s23 offen offset:0
    buffer_load_dwordx4 v[52:55], v4, s[28:31], s23 offen offset:1024
    s_add_u32 s23, s23, 0x40000
    buffer_load_dwordx4 v[56:59], v4, s[28:31], s24 offen offset:0
    buffer_load_dwordx4 v[60:63], v4, s[28:31], s24 offen offset:1024
    s_add_u32 s24, s24, 0x40000
    s_add_u32 m0, s22, 8320
    s_nop 0
    buffer_load_dwordx4 v5, s[32:35], s25 offen lds
    buffer_load_dwordx4 v6, s[32:35], s25 offen offset:1024 lds
    s_add_u32 s25, s25, 0x20000
    buffer_load_dwordx4 v[64:67], v4, s[28:31], s23 offen offset:0
    buffer_load_dwordx4 v[68:71], v4, s[28:31], s23 offen offset:1024
    s_add_u32 s23, s23, 0x40000
    buffer_load_dwordx4 v[72:75], v4, s[28:31], s24 offen offset:0
    buffer_load_dwordx4 v[76:79], v4, s[28:31], s24 offen offset:1024
    s_add_u32 s24, s24, 0x40000
    s_add_u32 m0, s22, 16640
    s_nop 0
    buffer_load_dwordx4 v5, s[32:35], s25 offen lds
    buffer_load_dwordx4 v6, s[32:35], s25 offen offset:1024 lds
    s_add_u32 s25, s25, 0x20000
    buffer_load_dwordx4 v[80:83], v4, s[28:31], s23 offen offset:0
    buffer_load_dwordx4 v[84:87], v4, s[28:31], s23 offen offset:1024
    s_add_u32 s23, s23, 0x40000
    buffer_load_dwordx4 v[88:91], v4, s[28:31], s24 offen offset:0
    buffer_load_dwordx4 v[92:95], v4, s[28:31], s24 offen offset:1024
    s_add_u32 s24, s24, 0x40000
    s_add_u32 m0, s22, 24960
    s_nop 0
    buffer_load_dwordx4 v5, s[32:35], s25 offen lds
    buffer_load_dwordx4 v6, s[32:35], s25 offen offset:1024 lds
    s_add_u32 s25, s25, 0x20000
    buffer_load_dwordx4 v[96:99], v4, s[28:31], s23 offen offset:0
    buffer_load_dwordx4 v[100:103], v4, s[28:31], s23 offen offset:1024
    s_add_u32 s23, s23, 0x40000
    buffer_load_dwordx4 v[104:107], v4, s[28:31], s24 offen offset:0
    buffer_load_dwordx4 v[108:111], v4, s[28:31], s24 offen offset:1024
    s_add_u32 s24, s24, 0x40000
    s_add_u32 m0, s22, 33280
    s_nop 0
    buffer_load_dwordx4 v5, s[32:35], s25 offen lds
    buffer_load_dwordx4 v6, s[32:35], s25 offen offset:1024 lds
    s_add_u32 s25, s25, 0x20000
    buffer_load_dwordx4 v[112:115], v4, s[28:31], s23 offen offset:0
    buffer_load_dwordx4 v[116:119], v4, s[28:31], s23 offen offset:1024
    s_add_u32 s23, s23, 0x40000
    buffer_load_dwordx4 v[120:123], v4, s[28:31], s24 offen offset:0
    buffer_load_dwordx4 v[124:127], v4, s[28:31], s24 offen offset:1024
    s_add_u32 s24, s24, 0x40000
    s_add_u32 m0, s22, 41600
    s_nop 0
    buffer_load_dwordx4 v5, s[32:35], s25 offen lds
    buffer_load_dwordx4 v6, s[32:35], s25 offen offset:1024 lds
    s_add_u32 s25, s25, 0x20000
    buffer_load_dwordx4 v[128:131], v4, s[28:31], s23 offen offset:0
    buffer_load_dwordx4 v[132:135], v4, s[28:31], s23 offen offset:1024
    s_add_u32 s23, s23, 0x40000
    buffer_load_dwordx4 v[136:139], v4, s[28:31], s24 offen offset:0
    buffer_load_dwordx4 v[140:143], v4, s[28:31], s24 offen offset:1024
    s_add_u32 s24, s24, 0x40000
    s_add_u32 m0, s22, 49920
    s_nop 0
    buffer_load_dwordx4 v5, s[32:35], s25 offen lds
    buffer_load_dwordx4 v6, s[32:35], s25 offen offset:1024 lds
    s_add_u32 s25, s25, 0x20000
    buffer_load_dwordx4 v[144:147], v4, s[28:31], s23 offen offset:0
    buffer_load_dwordx4 v[148:151], v4, s[28:31], s23 offen offset:1024
    s_add_u32 s23, s23, 0x40000
    buffer_load_dwordx4 v[152:155], v4, s[28:31], s24 offen offset:0
    buffer_load_dwordx4 v[156:159], v4, s[28:31], s24 offen offset:1024
    s_add_u32 s24, s24, 0x40000
    s_add_u32 m0, s22, 58240
    s_nop 0
    buffer_load_dwordx4 v5, s[32:35], s25 offen lds
    buffer_load_dwordx4 v6, s[32:35], s25 offen offset:1024 lds
    s_add_u32 s25, s25, 0x20000
    v_mov_b32 v16, 0
    v_mov_b32 v17, 0
    v_mov_b32 v18, 0
    v_mov_b32 v19, 0
    v_mov_b32 v20, 0
    v_mov_b32 v21, 0
    v_mov_b32 v22, 0
    v_mov_b32 v23, 0
    v_mov_b32 v24, 0
    v_mov_b32 v25, 0
    v_mov_b32 v26, 0
    v_mov_b32 v27, 0
    v_mov_b32 v28, 0
    v_mov_b32 v29, 0
    v_mov_b32 v30, 0
    v_mov_b32 v31, 0
    v_mov_b32 v32, 0
    v_mov_b32 v33, 0
    v_mov_b32 v34, 0
    v_mov_b32 v35, 0
    v_mov_b32 v36, 0
    v_mov_b32 v37, 0
    v_mov_b32 v38, 0
    v_mov_b32 v39, 0
    v_mov_b32 v40, 0
    v_mov_b32 v41, 0
    v_mov_b32 v42, 0
    v_mov_b32 v43, 0
    v_mov_b32 v44, 0
    v_mov_b32 v45, 0
    v_mov_b32 v46, 0
    v_mov_b32 v47, 0
    s_mov_b32 s36, s10
    s_mov_b32 s37, s11
    s_mov_b32 s38, 4194304
    s_mov_b32 s39, 0x20000
    s_lshl_b32 s26, s7, 18
    s_add_u32 s27, s26, 0x20000
    s_add_u32 s40, s10, 8388608
    s_addc_u32 s41, s11, 0
    s_mov_b32 s42, 4194304
    s_mov_b32 s43, 0x20000
    s_add_u32 s44, s10, 58982400
    s_addc_u32 s45, s11, 0
    s_mov_b32 s46, 262144
    s_mov_b32 s47, 0x20000
    s_waitcnt vmcnt(42)
    s_barrier
    ds_read_b64_tr_b16 a[0:1], v7 offset:0
    ds_read_b64_tr_b16 a[2:3], v7 offset:512
    ds_read_b64_tr_b16 a[4:5], v7 offset:32
    ds_read_b64_tr_b16 a[6:7], v7 offset:544
    ds_read_b64_tr_b16 a[8:9], v7 offset:64
    ds_read_b64_tr_b16 a[10:11], v7 offset:576
    ds_read_b64_tr_b16 a[12:13], v7 offset:96
    ds_read_b64_tr_b16 a[14:15], v7 offset:608
    ds_read_b64_tr_b16 a[16:17], v7 offset:1024
    ds_read_b64_tr_b16 a[18:19], v7 offset:1536
    ds_read_b64_tr_b16 a[20:21], v7 offset:1056
    ds_read_b64_tr_b16 a[22:23], v7 offset:1568
    ds_read_b64_tr_b16 a[24:25], v7 offset:1088
    ds_read_b64_tr_b16 a[26:27], v7 offset:1600
    ds_read_b64_tr_b16 a[28:29], v7 offset:1120
    ds_read_b64_tr_b16 a[30:31], v7 offset:1632
    s_mov_b32 s48, 1
.p2align 6
wo1_kernel_loop:
    s_waitcnt lgkmcnt(0)
    s_waitcnt vmcnt(36)
    s_barrier
    v_mfma_f32_16x16x32_bf16 v[16:19], a[0:3], v[48:51], v[16:19]
    ds_read_b64_tr_b16 a[32:33], v7 offset:8320
    ds_read_b64_tr_b16 a[34:35], v7 offset:8832
    s_add_u32 m0, s22, 0
    s_nop 0
    buffer_load_dwordx4 v5, s[32:35], s25 offen lds
    v_mfma_f32_16x16x32_bf16 v[32:35], a[0:3], v[52:55], v[32:35]
    ds_read_b64_tr_b16 a[36:37], v7 offset:8352
    v_mfma_f32_16x16x32_bf16 v[20:23], a[4:7], v[48:51], v[20:23]
    ds_read_b64_tr_b16 a[38:39], v7 offset:8864
    buffer_load_dwordx4 v[160:163], v4, s[28:31], s23 offen offset:0
    v_mfma_f32_16x16x32_bf16 v[36:39], a[4:7], v[52:55], v[36:39]
    ds_read_b64_tr_b16 a[40:41], v7 offset:8384
    v_mfma_f32_16x16x32_bf16 v[24:27], a[8:11], v[48:51], v[24:27]
    ds_read_b64_tr_b16 a[42:43], v7 offset:8896
    ds_read_b64_tr_b16 a[44:45], v7 offset:8416
    v_mfma_f32_16x16x32_bf16 v[40:43], a[8:11], v[52:55], v[40:43]
    ds_read_b64_tr_b16 a[46:47], v7 offset:8928
    buffer_load_dwordx4 v[164:167], v4, s[28:31], s23 offen offset:1024
    s_add_u32 s23, s23, 0x40000
    v_mfma_f32_16x16x32_bf16 v[28:31], a[12:15], v[48:51], v[28:31]
    ds_read_b64_tr_b16 a[48:49], v7 offset:9344
    v_mfma_f32_16x16x32_bf16 v[44:47], a[12:15], v[52:55], v[44:47]
    ds_read_b64_tr_b16 a[50:51], v7 offset:9856
    v_mfma_f32_16x16x32_bf16 v[16:19], a[16:19], v[56:59], v[16:19]
    ds_read_b64_tr_b16 a[52:53], v7 offset:9376
    ds_read_b64_tr_b16 a[54:55], v7 offset:9888
    buffer_load_dwordx4 v6, s[32:35], s25 offen offset:1024 lds
    s_add_u32 s25, s25, 0x20000
    v_mfma_f32_16x16x32_bf16 v[32:35], a[16:19], v[60:63], v[32:35]
    ds_read_b64_tr_b16 a[56:57], v7 offset:9408
    v_mfma_f32_16x16x32_bf16 v[20:23], a[20:23], v[56:59], v[20:23]
    ds_read_b64_tr_b16 a[58:59], v7 offset:9920
    buffer_load_dwordx4 v[168:171], v4, s[28:31], s24 offen offset:0
    v_mfma_f32_16x16x32_bf16 v[36:39], a[20:23], v[60:63], v[36:39]
    ds_read_b64_tr_b16 a[60:61], v7 offset:9440
    v_mfma_f32_16x16x32_bf16 v[24:27], a[24:27], v[56:59], v[24:27]
    ds_read_b64_tr_b16 a[62:63], v7 offset:9952
    v_mfma_f32_16x16x32_bf16 v[40:43], a[24:27], v[60:63], v[40:43]
    buffer_load_dwordx4 v[172:175], v4, s[28:31], s24 offen offset:1024
    s_add_u32 s24, s24, 0x40000
    v_mfma_f32_16x16x32_bf16 v[28:31], a[28:31], v[56:59], v[28:31]
    v_mfma_f32_16x16x32_bf16 v[44:47], a[28:31], v[60:63], v[44:47]
    s_waitcnt lgkmcnt(0)
    s_waitcnt vmcnt(36)
    s_barrier
    v_mfma_f32_16x16x32_bf16 v[16:19], a[32:35], v[64:67], v[16:19]
    ds_read_b64_tr_b16 a[0:1], v7 offset:16640
    ds_read_b64_tr_b16 a[2:3], v7 offset:17152
    s_add_u32 m0, s22, 8320
    s_nop 0
    buffer_load_dwordx4 v5, s[32:35], s25 offen lds
    v_mfma_f32_16x16x32_bf16 v[32:35], a[32:35], v[68:71], v[32:35]
    ds_read_b64_tr_b16 a[4:5], v7 offset:16672
    v_mfma_f32_16x16x32_bf16 v[20:23], a[36:39], v[64:67], v[20:23]
    ds_read_b64_tr_b16 a[6:7], v7 offset:17184
    buffer_load_dwordx4 v[48:51], v4, s[28:31], s23 offen offset:0
    v_mfma_f32_16x16x32_bf16 v[36:39], a[36:39], v[68:71], v[36:39]
    ds_read_b64_tr_b16 a[8:9], v7 offset:16704
    v_mfma_f32_16x16x32_bf16 v[24:27], a[40:43], v[64:67], v[24:27]
    ds_read_b64_tr_b16 a[10:11], v7 offset:17216
    ds_read_b64_tr_b16 a[12:13], v7 offset:16736
    v_mfma_f32_16x16x32_bf16 v[40:43], a[40:43], v[68:71], v[40:43]
    ds_read_b64_tr_b16 a[14:15], v7 offset:17248
    buffer_load_dwordx4 v[52:55], v4, s[28:31], s23 offen offset:1024
    s_add_u32 s23, s23, 0x40000
    v_mfma_f32_16x16x32_bf16 v[28:31], a[44:47], v[64:67], v[28:31]
    ds_read_b64_tr_b16 a[16:17], v7 offset:17664
    v_mfma_f32_16x16x32_bf16 v[44:47], a[44:47], v[68:71], v[44:47]
    ds_read_b64_tr_b16 a[18:19], v7 offset:18176
    v_mfma_f32_16x16x32_bf16 v[16:19], a[48:51], v[72:75], v[16:19]
    ds_read_b64_tr_b16 a[20:21], v7 offset:17696
    ds_read_b64_tr_b16 a[22:23], v7 offset:18208
    buffer_load_dwordx4 v6, s[32:35], s25 offen offset:1024 lds
    s_add_u32 s25, s25, 0x20000
    v_mfma_f32_16x16x32_bf16 v[32:35], a[48:51], v[76:79], v[32:35]
    ds_read_b64_tr_b16 a[24:25], v7 offset:17728
    v_mfma_f32_16x16x32_bf16 v[20:23], a[52:55], v[72:75], v[20:23]
    ds_read_b64_tr_b16 a[26:27], v7 offset:18240
    buffer_load_dwordx4 v[56:59], v4, s[28:31], s24 offen offset:0
    v_mfma_f32_16x16x32_bf16 v[36:39], a[52:55], v[76:79], v[36:39]
    ds_read_b64_tr_b16 a[28:29], v7 offset:17760
    v_mfma_f32_16x16x32_bf16 v[24:27], a[56:59], v[72:75], v[24:27]
    ds_read_b64_tr_b16 a[30:31], v7 offset:18272
    v_mfma_f32_16x16x32_bf16 v[40:43], a[56:59], v[76:79], v[40:43]
    buffer_load_dwordx4 v[60:63], v4, s[28:31], s24 offen offset:1024
    s_add_u32 s24, s24, 0x40000
    v_mfma_f32_16x16x32_bf16 v[28:31], a[60:63], v[72:75], v[28:31]
    v_mfma_f32_16x16x32_bf16 v[44:47], a[60:63], v[76:79], v[44:47]
    s_waitcnt lgkmcnt(0)
    s_waitcnt vmcnt(36)
    s_barrier
    v_mfma_f32_16x16x32_bf16 v[16:19], a[0:3], v[80:83], v[16:19]
    ds_read_b64_tr_b16 a[32:33], v7 offset:24960
    ds_read_b64_tr_b16 a[34:35], v7 offset:25472
    s_add_u32 m0, s22, 16640
    s_nop 0
    buffer_load_dwordx4 v5, s[32:35], s25 offen lds
    v_mfma_f32_16x16x32_bf16 v[32:35], a[0:3], v[84:87], v[32:35]
    ds_read_b64_tr_b16 a[36:37], v7 offset:24992
    v_mfma_f32_16x16x32_bf16 v[20:23], a[4:7], v[80:83], v[20:23]
    ds_read_b64_tr_b16 a[38:39], v7 offset:25504
    buffer_load_dwordx4 v[64:67], v4, s[28:31], s23 offen offset:0
    v_mfma_f32_16x16x32_bf16 v[36:39], a[4:7], v[84:87], v[36:39]
    ds_read_b64_tr_b16 a[40:41], v7 offset:25024
    v_mfma_f32_16x16x32_bf16 v[24:27], a[8:11], v[80:83], v[24:27]
    ds_read_b64_tr_b16 a[42:43], v7 offset:25536
    ds_read_b64_tr_b16 a[44:45], v7 offset:25056
    v_mfma_f32_16x16x32_bf16 v[40:43], a[8:11], v[84:87], v[40:43]
    ds_read_b64_tr_b16 a[46:47], v7 offset:25568
    buffer_load_dwordx4 v[68:71], v4, s[28:31], s23 offen offset:1024
    s_add_u32 s23, s23, 0x40000
    v_mfma_f32_16x16x32_bf16 v[28:31], a[12:15], v[80:83], v[28:31]
    ds_read_b64_tr_b16 a[48:49], v7 offset:25984
    v_mfma_f32_16x16x32_bf16 v[44:47], a[12:15], v[84:87], v[44:47]
    ds_read_b64_tr_b16 a[50:51], v7 offset:26496
    v_mfma_f32_16x16x32_bf16 v[16:19], a[16:19], v[88:91], v[16:19]
    ds_read_b64_tr_b16 a[52:53], v7 offset:26016
    ds_read_b64_tr_b16 a[54:55], v7 offset:26528
    buffer_load_dwordx4 v6, s[32:35], s25 offen offset:1024 lds
    s_add_u32 s25, s25, 0x20000
    v_mfma_f32_16x16x32_bf16 v[32:35], a[16:19], v[92:95], v[32:35]
    ds_read_b64_tr_b16 a[56:57], v7 offset:26048
    v_mfma_f32_16x16x32_bf16 v[20:23], a[20:23], v[88:91], v[20:23]
    ds_read_b64_tr_b16 a[58:59], v7 offset:26560
    buffer_load_dwordx4 v[72:75], v4, s[28:31], s24 offen offset:0
    v_mfma_f32_16x16x32_bf16 v[36:39], a[20:23], v[92:95], v[36:39]
    ds_read_b64_tr_b16 a[60:61], v7 offset:26080
    v_mfma_f32_16x16x32_bf16 v[24:27], a[24:27], v[88:91], v[24:27]
    ds_read_b64_tr_b16 a[62:63], v7 offset:26592
    v_mfma_f32_16x16x32_bf16 v[40:43], a[24:27], v[92:95], v[40:43]
    buffer_load_dwordx4 v[76:79], v4, s[28:31], s24 offen offset:1024
    s_add_u32 s24, s24, 0x40000
    v_mfma_f32_16x16x32_bf16 v[28:31], a[28:31], v[88:91], v[28:31]
    v_mfma_f32_16x16x32_bf16 v[44:47], a[28:31], v[92:95], v[44:47]
    s_waitcnt lgkmcnt(0)
    s_waitcnt vmcnt(36)
    s_barrier
    v_mfma_f32_16x16x32_bf16 v[16:19], a[32:35], v[96:99], v[16:19]
    ds_read_b64_tr_b16 a[0:1], v7 offset:33280
    ds_read_b64_tr_b16 a[2:3], v7 offset:33792
    s_add_u32 m0, s22, 24960
    s_nop 0
    buffer_load_dwordx4 v5, s[32:35], s25 offen lds
    v_mfma_f32_16x16x32_bf16 v[32:35], a[32:35], v[100:103], v[32:35]
    ds_read_b64_tr_b16 a[4:5], v7 offset:33312
    v_mfma_f32_16x16x32_bf16 v[20:23], a[36:39], v[96:99], v[20:23]
    ds_read_b64_tr_b16 a[6:7], v7 offset:33824
    buffer_load_dwordx4 v[80:83], v4, s[28:31], s23 offen offset:0
    v_mfma_f32_16x16x32_bf16 v[36:39], a[36:39], v[100:103], v[36:39]
    ds_read_b64_tr_b16 a[8:9], v7 offset:33344
    v_mfma_f32_16x16x32_bf16 v[24:27], a[40:43], v[96:99], v[24:27]
    ds_read_b64_tr_b16 a[10:11], v7 offset:33856
    ds_read_b64_tr_b16 a[12:13], v7 offset:33376
    v_mfma_f32_16x16x32_bf16 v[40:43], a[40:43], v[100:103], v[40:43]
    ds_read_b64_tr_b16 a[14:15], v7 offset:33888
    buffer_load_dwordx4 v[84:87], v4, s[28:31], s23 offen offset:1024
    s_add_u32 s23, s23, 0x40000
    v_mfma_f32_16x16x32_bf16 v[28:31], a[44:47], v[96:99], v[28:31]
    ds_read_b64_tr_b16 a[16:17], v7 offset:34304
    v_mfma_f32_16x16x32_bf16 v[44:47], a[44:47], v[100:103], v[44:47]
    ds_read_b64_tr_b16 a[18:19], v7 offset:34816
    v_mfma_f32_16x16x32_bf16 v[16:19], a[48:51], v[104:107], v[16:19]
    ds_read_b64_tr_b16 a[20:21], v7 offset:34336
    ds_read_b64_tr_b16 a[22:23], v7 offset:34848
    buffer_load_dwordx4 v6, s[32:35], s25 offen offset:1024 lds
    s_add_u32 s25, s25, 0x20000
    v_mfma_f32_16x16x32_bf16 v[32:35], a[48:51], v[108:111], v[32:35]
    ds_read_b64_tr_b16 a[24:25], v7 offset:34368
    v_mfma_f32_16x16x32_bf16 v[20:23], a[52:55], v[104:107], v[20:23]
    ds_read_b64_tr_b16 a[26:27], v7 offset:34880
    buffer_load_dwordx4 v[88:91], v4, s[28:31], s24 offen offset:0
    v_mfma_f32_16x16x32_bf16 v[36:39], a[52:55], v[108:111], v[36:39]
    ds_read_b64_tr_b16 a[28:29], v7 offset:34400
    v_mfma_f32_16x16x32_bf16 v[24:27], a[56:59], v[104:107], v[24:27]
    ds_read_b64_tr_b16 a[30:31], v7 offset:34912
    v_mfma_f32_16x16x32_bf16 v[40:43], a[56:59], v[108:111], v[40:43]
    buffer_load_dwordx4 v[92:95], v4, s[28:31], s24 offen offset:1024
    s_add_u32 s24, s24, 0x40000
    v_mfma_f32_16x16x32_bf16 v[28:31], a[60:63], v[104:107], v[28:31]
    v_mfma_f32_16x16x32_bf16 v[44:47], a[60:63], v[108:111], v[44:47]
    s_waitcnt lgkmcnt(0)
    s_waitcnt vmcnt(36)
    s_barrier
    v_mfma_f32_16x16x32_bf16 v[16:19], a[0:3], v[112:115], v[16:19]
    ds_read_b64_tr_b16 a[32:33], v7 offset:41600
    ds_read_b64_tr_b16 a[34:35], v7 offset:42112
    s_add_u32 m0, s22, 33280
    s_nop 0
    buffer_load_dwordx4 v5, s[32:35], s25 offen lds
    v_mfma_f32_16x16x32_bf16 v[32:35], a[0:3], v[116:119], v[32:35]
    ds_read_b64_tr_b16 a[36:37], v7 offset:41632
    v_mfma_f32_16x16x32_bf16 v[20:23], a[4:7], v[112:115], v[20:23]
    ds_read_b64_tr_b16 a[38:39], v7 offset:42144
    buffer_load_dwordx4 v[96:99], v4, s[28:31], s23 offen offset:0
    v_mfma_f32_16x16x32_bf16 v[36:39], a[4:7], v[116:119], v[36:39]
    ds_read_b64_tr_b16 a[40:41], v7 offset:41664
    v_mfma_f32_16x16x32_bf16 v[24:27], a[8:11], v[112:115], v[24:27]
    ds_read_b64_tr_b16 a[42:43], v7 offset:42176
    ds_read_b64_tr_b16 a[44:45], v7 offset:41696
    v_mfma_f32_16x16x32_bf16 v[40:43], a[8:11], v[116:119], v[40:43]
    ds_read_b64_tr_b16 a[46:47], v7 offset:42208
    buffer_load_dwordx4 v[100:103], v4, s[28:31], s23 offen offset:1024
    s_add_u32 s23, s23, 0x40000
    v_mfma_f32_16x16x32_bf16 v[28:31], a[12:15], v[112:115], v[28:31]
    ds_read_b64_tr_b16 a[48:49], v7 offset:42624
    v_mfma_f32_16x16x32_bf16 v[44:47], a[12:15], v[116:119], v[44:47]
    ds_read_b64_tr_b16 a[50:51], v7 offset:43136
    v_mfma_f32_16x16x32_bf16 v[16:19], a[16:19], v[120:123], v[16:19]
    ds_read_b64_tr_b16 a[52:53], v7 offset:42656
    ds_read_b64_tr_b16 a[54:55], v7 offset:43168
    buffer_load_dwordx4 v6, s[32:35], s25 offen offset:1024 lds
    s_add_u32 s25, s25, 0x20000
    v_mfma_f32_16x16x32_bf16 v[32:35], a[16:19], v[124:127], v[32:35]
    ds_read_b64_tr_b16 a[56:57], v7 offset:42688
    v_mfma_f32_16x16x32_bf16 v[20:23], a[20:23], v[120:123], v[20:23]
    ds_read_b64_tr_b16 a[58:59], v7 offset:43200
    buffer_load_dwordx4 v[104:107], v4, s[28:31], s24 offen offset:0
    v_mfma_f32_16x16x32_bf16 v[36:39], a[20:23], v[124:127], v[36:39]
    ds_read_b64_tr_b16 a[60:61], v7 offset:42720
    v_mfma_f32_16x16x32_bf16 v[24:27], a[24:27], v[120:123], v[24:27]
    ds_read_b64_tr_b16 a[62:63], v7 offset:43232
    v_mfma_f32_16x16x32_bf16 v[40:43], a[24:27], v[124:127], v[40:43]
    buffer_load_dwordx4 v[108:111], v4, s[28:31], s24 offen offset:1024
    s_add_u32 s24, s24, 0x40000
    v_mfma_f32_16x16x32_bf16 v[28:31], a[28:31], v[120:123], v[28:31]
    v_mfma_f32_16x16x32_bf16 v[44:47], a[28:31], v[124:127], v[44:47]
    s_waitcnt lgkmcnt(0)
    s_waitcnt vmcnt(36)
    s_barrier
    v_mfma_f32_16x16x32_bf16 v[16:19], a[32:35], v[128:131], v[16:19]
    ds_read_b64_tr_b16 a[0:1], v7 offset:49920
    ds_read_b64_tr_b16 a[2:3], v7 offset:50432
    s_add_u32 m0, s22, 41600
    s_nop 0
    buffer_load_dwordx4 v5, s[32:35], s25 offen lds
    v_mfma_f32_16x16x32_bf16 v[32:35], a[32:35], v[132:135], v[32:35]
    ds_read_b64_tr_b16 a[4:5], v7 offset:49952
    v_mfma_f32_16x16x32_bf16 v[20:23], a[36:39], v[128:131], v[20:23]
    ds_read_b64_tr_b16 a[6:7], v7 offset:50464
    buffer_load_dwordx4 v[112:115], v4, s[28:31], s23 offen offset:0
    v_mfma_f32_16x16x32_bf16 v[36:39], a[36:39], v[132:135], v[36:39]
    ds_read_b64_tr_b16 a[8:9], v7 offset:49984
    v_mfma_f32_16x16x32_bf16 v[24:27], a[40:43], v[128:131], v[24:27]
    ds_read_b64_tr_b16 a[10:11], v7 offset:50496
    ds_read_b64_tr_b16 a[12:13], v7 offset:50016
    v_mfma_f32_16x16x32_bf16 v[40:43], a[40:43], v[132:135], v[40:43]
    ds_read_b64_tr_b16 a[14:15], v7 offset:50528
    buffer_load_dwordx4 v[116:119], v4, s[28:31], s23 offen offset:1024
    s_add_u32 s23, s23, 0x40000
    v_mfma_f32_16x16x32_bf16 v[28:31], a[44:47], v[128:131], v[28:31]
    ds_read_b64_tr_b16 a[16:17], v7 offset:50944
    v_mfma_f32_16x16x32_bf16 v[44:47], a[44:47], v[132:135], v[44:47]
    ds_read_b64_tr_b16 a[18:19], v7 offset:51456
    v_mfma_f32_16x16x32_bf16 v[16:19], a[48:51], v[136:139], v[16:19]
    ds_read_b64_tr_b16 a[20:21], v7 offset:50976
    ds_read_b64_tr_b16 a[22:23], v7 offset:51488
    buffer_load_dwordx4 v6, s[32:35], s25 offen offset:1024 lds
    s_add_u32 s25, s25, 0x20000
    v_mfma_f32_16x16x32_bf16 v[32:35], a[48:51], v[140:143], v[32:35]
    ds_read_b64_tr_b16 a[24:25], v7 offset:51008
    v_mfma_f32_16x16x32_bf16 v[20:23], a[52:55], v[136:139], v[20:23]
    ds_read_b64_tr_b16 a[26:27], v7 offset:51520
    buffer_load_dwordx4 v[120:123], v4, s[28:31], s24 offen offset:0
    v_mfma_f32_16x16x32_bf16 v[36:39], a[52:55], v[140:143], v[36:39]
    ds_read_b64_tr_b16 a[28:29], v7 offset:51040
    v_mfma_f32_16x16x32_bf16 v[24:27], a[56:59], v[136:139], v[24:27]
    ds_read_b64_tr_b16 a[30:31], v7 offset:51552
    v_mfma_f32_16x16x32_bf16 v[40:43], a[56:59], v[140:143], v[40:43]
    buffer_load_dwordx4 v[124:127], v4, s[28:31], s24 offen offset:1024
    s_add_u32 s24, s24, 0x40000
    v_mfma_f32_16x16x32_bf16 v[28:31], a[60:63], v[136:139], v[28:31]
    v_mfma_f32_16x16x32_bf16 v[44:47], a[60:63], v[140:143], v[44:47]
    s_waitcnt lgkmcnt(0)
    s_waitcnt vmcnt(36)
    s_barrier
    v_mfma_f32_16x16x32_bf16 v[16:19], a[0:3], v[144:147], v[16:19]
    ds_read_b64_tr_b16 a[32:33], v7 offset:58240
    ds_read_b64_tr_b16 a[34:35], v7 offset:58752
    s_add_u32 m0, s22, 49920
    s_nop 0
    buffer_load_dwordx4 v5, s[32:35], s25 offen lds
    v_mfma_f32_16x16x32_bf16 v[32:35], a[0:3], v[148:151], v[32:35]
    ds_read_b64_tr_b16 a[36:37], v7 offset:58272
    v_mfma_f32_16x16x32_bf16 v[20:23], a[4:7], v[144:147], v[20:23]
    ds_read_b64_tr_b16 a[38:39], v7 offset:58784
    buffer_load_dwordx4 v[128:131], v4, s[28:31], s23 offen offset:0
    v_mfma_f32_16x16x32_bf16 v[36:39], a[4:7], v[148:151], v[36:39]
    ds_read_b64_tr_b16 a[40:41], v7 offset:58304
    v_mfma_f32_16x16x32_bf16 v[24:27], a[8:11], v[144:147], v[24:27]
    ds_read_b64_tr_b16 a[42:43], v7 offset:58816
    ds_read_b64_tr_b16 a[44:45], v7 offset:58336
    v_mfma_f32_16x16x32_bf16 v[40:43], a[8:11], v[148:151], v[40:43]
    ds_read_b64_tr_b16 a[46:47], v7 offset:58848
    buffer_load_dwordx4 v[132:135], v4, s[28:31], s23 offen offset:1024
    s_add_u32 s23, s23, 0x40000
    v_mfma_f32_16x16x32_bf16 v[28:31], a[12:15], v[144:147], v[28:31]
    ds_read_b64_tr_b16 a[48:49], v7 offset:59264
    v_mfma_f32_16x16x32_bf16 v[44:47], a[12:15], v[148:151], v[44:47]
    ds_read_b64_tr_b16 a[50:51], v7 offset:59776
    v_mfma_f32_16x16x32_bf16 v[16:19], a[16:19], v[152:155], v[16:19]
    ds_read_b64_tr_b16 a[52:53], v7 offset:59296
    ds_read_b64_tr_b16 a[54:55], v7 offset:59808
    buffer_load_dwordx4 v6, s[32:35], s25 offen offset:1024 lds
    s_add_u32 s25, s25, 0x20000
    v_mfma_f32_16x16x32_bf16 v[32:35], a[16:19], v[156:159], v[32:35]
    ds_read_b64_tr_b16 a[56:57], v7 offset:59328
    v_mfma_f32_16x16x32_bf16 v[20:23], a[20:23], v[152:155], v[20:23]
    ds_read_b64_tr_b16 a[58:59], v7 offset:59840
    buffer_load_dwordx4 v[136:139], v4, s[28:31], s24 offen offset:0
    v_mfma_f32_16x16x32_bf16 v[36:39], a[20:23], v[156:159], v[36:39]
    ds_read_b64_tr_b16 a[60:61], v7 offset:59360
    v_mfma_f32_16x16x32_bf16 v[24:27], a[24:27], v[152:155], v[24:27]
    ds_read_b64_tr_b16 a[62:63], v7 offset:59872
    v_mfma_f32_16x16x32_bf16 v[40:43], a[24:27], v[156:159], v[40:43]
    buffer_load_dwordx4 v[140:143], v4, s[28:31], s24 offen offset:1024
    s_add_u32 s24, s24, 0x40000
    v_mfma_f32_16x16x32_bf16 v[28:31], a[28:31], v[152:155], v[28:31]
    v_mfma_f32_16x16x32_bf16 v[44:47], a[28:31], v[156:159], v[44:47]
    s_waitcnt lgkmcnt(0)
    s_waitcnt vmcnt(38)
    s_barrier
    v_mfma_f32_16x16x32_bf16 v[16:19], a[32:35], v[160:163], v[16:19]
    ds_read_b64_tr_b16 a[0:1], v7 offset:0
    ds_read_b64_tr_b16 a[2:3], v7 offset:512
    s_add_u32 m0, s22, 58240
    s_nop 0
    buffer_load_dwordx4 v5, s[32:35], s25 offen lds
    v_mfma_f32_16x16x32_bf16 v[32:35], a[32:35], v[164:167], v[32:35]
    ds_read_b64_tr_b16 a[4:5], v7 offset:32
    v_mfma_f32_16x16x32_bf16 v[20:23], a[36:39], v[160:163], v[20:23]
    ds_read_b64_tr_b16 a[6:7], v7 offset:544
    buffer_load_dwordx4 v[144:147], v4, s[28:31], s23 offen offset:0
    v_mfma_f32_16x16x32_bf16 v[36:39], a[36:39], v[164:167], v[36:39]
    ds_read_b64_tr_b16 a[8:9], v7 offset:64
    v_mfma_f32_16x16x32_bf16 v[24:27], a[40:43], v[160:163], v[24:27]
    ds_read_b64_tr_b16 a[10:11], v7 offset:576
    ds_read_b64_tr_b16 a[12:13], v7 offset:96
    v_mfma_f32_16x16x32_bf16 v[40:43], a[40:43], v[164:167], v[40:43]
    ds_read_b64_tr_b16 a[14:15], v7 offset:608
    buffer_load_dwordx4 v[148:151], v4, s[28:31], s23 offen offset:1024
    s_add_u32 s23, s23, 0x40000
    v_mfma_f32_16x16x32_bf16 v[28:31], a[44:47], v[160:163], v[28:31]
    ds_read_b64_tr_b16 a[16:17], v7 offset:1024
    v_mfma_f32_16x16x32_bf16 v[44:47], a[44:47], v[164:167], v[44:47]
    ds_read_b64_tr_b16 a[18:19], v7 offset:1536
    s_waitcnt vmcnt(40)
    v_mfma_f32_16x16x32_bf16 v[16:19], a[48:51], v[168:171], v[16:19]
    ds_read_b64_tr_b16 a[20:21], v7 offset:1056
    ds_read_b64_tr_b16 a[22:23], v7 offset:1568
    buffer_load_dwordx4 v6, s[32:35], s25 offen offset:1024 lds
    s_add_u32 s25, s25, 0x20000
    s_waitcnt vmcnt(40)
    v_mfma_f32_16x16x32_bf16 v[32:35], a[48:51], v[172:175], v[32:35]
    ds_read_b64_tr_b16 a[24:25], v7 offset:1088
    v_mfma_f32_16x16x32_bf16 v[20:23], a[52:55], v[168:171], v[20:23]
    ds_read_b64_tr_b16 a[26:27], v7 offset:1600
    buffer_load_dwordx4 v[152:155], v4, s[28:31], s24 offen offset:0
    v_mfma_f32_16x16x32_bf16 v[36:39], a[52:55], v[172:175], v[36:39]
    ds_read_b64_tr_b16 a[28:29], v7 offset:1120
    v_mfma_f32_16x16x32_bf16 v[24:27], a[56:59], v[168:171], v[24:27]
    ds_read_b64_tr_b16 a[30:31], v7 offset:1632
    v_mfma_f32_16x16x32_bf16 v[40:43], a[56:59], v[172:175], v[40:43]
    buffer_load_dwordx4 v[156:159], v4, s[28:31], s24 offen offset:1024
    s_add_u32 s24, s24, 0x40000
    v_mfma_f32_16x16x32_bf16 v[28:31], a[60:63], v[168:171], v[28:31]
    v_mfma_f32_16x16x32_bf16 v[44:47], a[60:63], v[172:175], v[44:47]
    s_sub_u32 s48, s48, 1
    s_cmp_lg_u32 s48, 0
    s_cbranch_scc1 wo1_kernel_loop
    s_waitcnt lgkmcnt(0)
    s_waitcnt vmcnt(38)
    s_barrier
    v_mfma_f32_16x16x32_bf16 v[16:19], a[0:3], v[48:51], v[16:19]
    ds_read_b64_tr_b16 a[32:33], v7 offset:8320
    ds_read_b64_tr_b16 a[34:35], v7 offset:8832
    buffer_load_dwordx4 v[160:163], v4, s[28:31], s23 offen offset:0
    v_mfma_f32_16x16x32_bf16 v[32:35], a[0:3], v[52:55], v[32:35]
    ds_read_b64_tr_b16 a[36:37], v7 offset:8352
    v_mfma_f32_16x16x32_bf16 v[20:23], a[4:7], v[48:51], v[20:23]
    ds_read_b64_tr_b16 a[38:39], v7 offset:8864
    v_mfma_f32_16x16x32_bf16 v[36:39], a[4:7], v[52:55], v[36:39]
    ds_read_b64_tr_b16 a[40:41], v7 offset:8384
    v_mfma_f32_16x16x32_bf16 v[24:27], a[8:11], v[48:51], v[24:27]
    ds_read_b64_tr_b16 a[42:43], v7 offset:8896
    ds_read_b64_tr_b16 a[44:45], v7 offset:8416
    buffer_load_dwordx4 v[164:167], v4, s[28:31], s23 offen offset:1024
    s_add_u32 s23, s23, 0x40000
    v_mfma_f32_16x16x32_bf16 v[40:43], a[8:11], v[52:55], v[40:43]
    ds_read_b64_tr_b16 a[46:47], v7 offset:8928
    v_mfma_f32_16x16x32_bf16 v[28:31], a[12:15], v[48:51], v[28:31]
    ds_read_b64_tr_b16 a[48:49], v7 offset:9344
    v_mfma_f32_16x16x32_bf16 v[44:47], a[12:15], v[52:55], v[44:47]
    ds_read_b64_tr_b16 a[50:51], v7 offset:9856
    s_waitcnt vmcnt(39)
    v_mfma_f32_16x16x32_bf16 v[16:19], a[16:19], v[56:59], v[16:19]
    ds_read_b64_tr_b16 a[52:53], v7 offset:9376
    ds_read_b64_tr_b16 a[54:55], v7 offset:9888
    buffer_load_dwordx4 v[168:171], v4, s[28:31], s24 offen offset:0
    s_waitcnt vmcnt(39)
    v_mfma_f32_16x16x32_bf16 v[32:35], a[16:19], v[60:63], v[32:35]
    ds_read_b64_tr_b16 a[56:57], v7 offset:9408
    v_mfma_f32_16x16x32_bf16 v[20:23], a[20:23], v[56:59], v[20:23]
    ds_read_b64_tr_b16 a[58:59], v7 offset:9920
    v_mfma_f32_16x16x32_bf16 v[36:39], a[20:23], v[60:63], v[36:39]
    ds_read_b64_tr_b16 a[60:61], v7 offset:9440
    v_mfma_f32_16x16x32_bf16 v[24:27], a[24:27], v[56:59], v[24:27]
    ds_read_b64_tr_b16 a[62:63], v7 offset:9952
    buffer_load_dwordx4 v[172:175], v4, s[28:31], s24 offen offset:1024
    s_add_u32 s24, s24, 0x40000
    v_mfma_f32_16x16x32_bf16 v[40:43], a[24:27], v[60:63], v[40:43]
    v_mfma_f32_16x16x32_bf16 v[28:31], a[28:31], v[56:59], v[28:31]
    v_mfma_f32_16x16x32_bf16 v[44:47], a[28:31], v[60:63], v[44:47]
    s_waitcnt lgkmcnt(0)
    s_waitcnt vmcnt(36)
    s_barrier
    v_mfma_f32_16x16x32_bf16 v[16:19], a[32:35], v[64:67], v[16:19]
    ds_read_b64_tr_b16 a[0:1], v7 offset:16640
    ds_read_b64_tr_b16 a[2:3], v7 offset:17152
    buffer_load_dwordx4 v[176:179], v4, s[36:39], s26 offen offset:0
    v_mfma_f32_16x16x32_bf16 v[32:35], a[32:35], v[68:71], v[32:35]
    ds_read_b64_tr_b16 a[4:5], v7 offset:16672
    v_mfma_f32_16x16x32_bf16 v[20:23], a[36:39], v[64:67], v[20:23]
    ds_read_b64_tr_b16 a[6:7], v7 offset:17184
    v_mfma_f32_16x16x32_bf16 v[36:39], a[36:39], v[68:71], v[36:39]
    ds_read_b64_tr_b16 a[8:9], v7 offset:16704
    v_mfma_f32_16x16x32_bf16 v[24:27], a[40:43], v[64:67], v[24:27]
    ds_read_b64_tr_b16 a[10:11], v7 offset:17216
    ds_read_b64_tr_b16 a[12:13], v7 offset:16736
    buffer_load_dwordx4 v[180:183], v4, s[36:39], s27 offen offset:0
    v_mfma_f32_16x16x32_bf16 v[40:43], a[40:43], v[68:71], v[40:43]
    ds_read_b64_tr_b16 a[14:15], v7 offset:17248
    v_mfma_f32_16x16x32_bf16 v[28:31], a[44:47], v[64:67], v[28:31]
    ds_read_b64_tr_b16 a[16:17], v7 offset:17664
    v_mfma_f32_16x16x32_bf16 v[44:47], a[44:47], v[68:71], v[44:47]
    ds_read_b64_tr_b16 a[18:19], v7 offset:18176
    s_waitcnt vmcnt(37)
    v_mfma_f32_16x16x32_bf16 v[16:19], a[48:51], v[72:75], v[16:19]
    ds_read_b64_tr_b16 a[20:21], v7 offset:17696
    ds_read_b64_tr_b16 a[22:23], v7 offset:18208
    buffer_load_dwordx4 v[184:187], v4, s[36:39], s26 offen offset:1024
    s_waitcnt vmcnt(37)
    v_mfma_f32_16x16x32_bf16 v[32:35], a[48:51], v[76:79], v[32:35]
    ds_read_b64_tr_b16 a[24:25], v7 offset:17728
    v_mfma_f32_16x16x32_bf16 v[20:23], a[52:55], v[72:75], v[20:23]
    ds_read_b64_tr_b16 a[26:27], v7 offset:18240
    v_mfma_f32_16x16x32_bf16 v[36:39], a[52:55], v[76:79], v[36:39]
    ds_read_b64_tr_b16 a[28:29], v7 offset:17760
    v_mfma_f32_16x16x32_bf16 v[24:27], a[56:59], v[72:75], v[24:27]
    ds_read_b64_tr_b16 a[30:31], v7 offset:18272
    buffer_load_dwordx4 v[188:191], v4, s[36:39], s27 offen offset:1024
    v_mfma_f32_16x16x32_bf16 v[40:43], a[56:59], v[76:79], v[40:43]
    v_mfma_f32_16x16x32_bf16 v[28:31], a[60:63], v[72:75], v[28:31]
    v_mfma_f32_16x16x32_bf16 v[44:47], a[60:63], v[76:79], v[44:47]
    s_waitcnt lgkmcnt(0)
    s_waitcnt vmcnt(34)
    s_barrier
    v_mfma_f32_16x16x32_bf16 v[16:19], a[0:3], v[80:83], v[16:19]
    ds_read_b64_tr_b16 a[32:33], v7 offset:24960
    ds_read_b64_tr_b16 a[34:35], v7 offset:25472
    v_mfma_f32_16x16x32_bf16 v[32:35], a[0:3], v[84:87], v[32:35]
    ds_read_b64_tr_b16 a[36:37], v7 offset:24992
    v_mfma_f32_16x16x32_bf16 v[20:23], a[4:7], v[80:83], v[20:23]
    ds_read_b64_tr_b16 a[38:39], v7 offset:25504
    v_mfma_f32_16x16x32_bf16 v[36:39], a[4:7], v[84:87], v[36:39]
    ds_read_b64_tr_b16 a[40:41], v7 offset:25024
    v_mfma_f32_16x16x32_bf16 v[24:27], a[8:11], v[80:83], v[24:27]
    ds_read_b64_tr_b16 a[42:43], v7 offset:25536
    ds_read_b64_tr_b16 a[44:45], v7 offset:25056
    v_mfma_f32_16x16x32_bf16 v[40:43], a[8:11], v[84:87], v[40:43]
    ds_read_b64_tr_b16 a[46:47], v7 offset:25568
    v_mfma_f32_16x16x32_bf16 v[28:31], a[12:15], v[80:83], v[28:31]
    ds_read_b64_tr_b16 a[48:49], v7 offset:25984
    v_mfma_f32_16x16x32_bf16 v[44:47], a[12:15], v[84:87], v[44:47]
    ds_read_b64_tr_b16 a[50:51], v7 offset:26496
    s_waitcnt vmcnt(33)
    v_mfma_f32_16x16x32_bf16 v[16:19], a[16:19], v[88:91], v[16:19]
    ds_read_b64_tr_b16 a[52:53], v7 offset:26016
    ds_read_b64_tr_b16 a[54:55], v7 offset:26528
    s_waitcnt vmcnt(32)
    v_mfma_f32_16x16x32_bf16 v[32:35], a[16:19], v[92:95], v[32:35]
    ds_read_b64_tr_b16 a[56:57], v7 offset:26048
    v_mfma_f32_16x16x32_bf16 v[20:23], a[20:23], v[88:91], v[20:23]
    ds_read_b64_tr_b16 a[58:59], v7 offset:26560
    v_mfma_f32_16x16x32_bf16 v[36:39], a[20:23], v[92:95], v[36:39]
    ds_read_b64_tr_b16 a[60:61], v7 offset:26080
    v_mfma_f32_16x16x32_bf16 v[24:27], a[24:27], v[88:91], v[24:27]
    ds_read_b64_tr_b16 a[62:63], v7 offset:26592
    v_mfma_f32_16x16x32_bf16 v[40:43], a[24:27], v[92:95], v[40:43]
    v_mfma_f32_16x16x32_bf16 v[28:31], a[28:31], v[88:91], v[28:31]
    v_mfma_f32_16x16x32_bf16 v[44:47], a[28:31], v[92:95], v[44:47]
    s_waitcnt lgkmcnt(0)
    s_waitcnt vmcnt(28)
    s_barrier
    v_mfma_f32_16x16x32_bf16 v[16:19], a[32:35], v[96:99], v[16:19]
    ds_read_b64_tr_b16 a[0:1], v7 offset:33280
    ds_read_b64_tr_b16 a[2:3], v7 offset:33792
    v_mfma_f32_16x16x32_bf16 v[32:35], a[32:35], v[100:103], v[32:35]
    ds_read_b64_tr_b16 a[4:5], v7 offset:33312
    v_mfma_f32_16x16x32_bf16 v[20:23], a[36:39], v[96:99], v[20:23]
    ds_read_b64_tr_b16 a[6:7], v7 offset:33824
    v_mfma_f32_16x16x32_bf16 v[36:39], a[36:39], v[100:103], v[36:39]
    ds_read_b64_tr_b16 a[8:9], v7 offset:33344
    v_mfma_f32_16x16x32_bf16 v[24:27], a[40:43], v[96:99], v[24:27]
    ds_read_b64_tr_b16 a[10:11], v7 offset:33856
    ds_read_b64_tr_b16 a[12:13], v7 offset:33376
    v_mfma_f32_16x16x32_bf16 v[40:43], a[40:43], v[100:103], v[40:43]
    ds_read_b64_tr_b16 a[14:15], v7 offset:33888
    v_mfma_f32_16x16x32_bf16 v[28:31], a[44:47], v[96:99], v[28:31]
    ds_read_b64_tr_b16 a[16:17], v7 offset:34304
    v_mfma_f32_16x16x32_bf16 v[44:47], a[44:47], v[100:103], v[44:47]
    ds_read_b64_tr_b16 a[18:19], v7 offset:34816
    s_waitcnt vmcnt(27)
    v_mfma_f32_16x16x32_bf16 v[16:19], a[48:51], v[104:107], v[16:19]
    ds_read_b64_tr_b16 a[20:21], v7 offset:34336
    ds_read_b64_tr_b16 a[22:23], v7 offset:34848
    s_waitcnt vmcnt(26)
    v_mfma_f32_16x16x32_bf16 v[32:35], a[48:51], v[108:111], v[32:35]
    ds_read_b64_tr_b16 a[24:25], v7 offset:34368
    v_mfma_f32_16x16x32_bf16 v[20:23], a[52:55], v[104:107], v[20:23]
    ds_read_b64_tr_b16 a[26:27], v7 offset:34880
    v_mfma_f32_16x16x32_bf16 v[36:39], a[52:55], v[108:111], v[36:39]
    ds_read_b64_tr_b16 a[28:29], v7 offset:34400
    v_mfma_f32_16x16x32_bf16 v[24:27], a[56:59], v[104:107], v[24:27]
    ds_read_b64_tr_b16 a[30:31], v7 offset:34912
    v_mfma_f32_16x16x32_bf16 v[40:43], a[56:59], v[108:111], v[40:43]
    v_mfma_f32_16x16x32_bf16 v[28:31], a[60:63], v[104:107], v[28:31]
    v_mfma_f32_16x16x32_bf16 v[44:47], a[60:63], v[108:111], v[44:47]
    s_waitcnt lgkmcnt(0)
    s_waitcnt vmcnt(22)
    s_barrier
    v_mfma_f32_16x16x32_bf16 v[16:19], a[0:3], v[112:115], v[16:19]
    ds_read_b64_tr_b16 a[32:33], v7 offset:41600
    ds_read_b64_tr_b16 a[34:35], v7 offset:42112
    v_mfma_f32_16x16x32_bf16 v[32:35], a[0:3], v[116:119], v[32:35]
    ds_read_b64_tr_b16 a[36:37], v7 offset:41632
    v_mfma_f32_16x16x32_bf16 v[20:23], a[4:7], v[112:115], v[20:23]
    ds_read_b64_tr_b16 a[38:39], v7 offset:42144
    v_mfma_f32_16x16x32_bf16 v[36:39], a[4:7], v[116:119], v[36:39]
    ds_read_b64_tr_b16 a[40:41], v7 offset:41664
    v_mfma_f32_16x16x32_bf16 v[24:27], a[8:11], v[112:115], v[24:27]
    ds_read_b64_tr_b16 a[42:43], v7 offset:42176
    ds_read_b64_tr_b16 a[44:45], v7 offset:41696
    v_mfma_f32_16x16x32_bf16 v[40:43], a[8:11], v[116:119], v[40:43]
    ds_read_b64_tr_b16 a[46:47], v7 offset:42208
    v_mfma_f32_16x16x32_bf16 v[28:31], a[12:15], v[112:115], v[28:31]
    ds_read_b64_tr_b16 a[48:49], v7 offset:42624
    v_mfma_f32_16x16x32_bf16 v[44:47], a[12:15], v[116:119], v[44:47]
    ds_read_b64_tr_b16 a[50:51], v7 offset:43136
    s_waitcnt vmcnt(21)
    v_mfma_f32_16x16x32_bf16 v[16:19], a[16:19], v[120:123], v[16:19]
    ds_read_b64_tr_b16 a[52:53], v7 offset:42656
    ds_read_b64_tr_b16 a[54:55], v7 offset:43168
    s_waitcnt vmcnt(20)
    v_mfma_f32_16x16x32_bf16 v[32:35], a[16:19], v[124:127], v[32:35]
    ds_read_b64_tr_b16 a[56:57], v7 offset:42688
    v_mfma_f32_16x16x32_bf16 v[20:23], a[20:23], v[120:123], v[20:23]
    ds_read_b64_tr_b16 a[58:59], v7 offset:43200
    v_mfma_f32_16x16x32_bf16 v[36:39], a[20:23], v[124:127], v[36:39]
    ds_read_b64_tr_b16 a[60:61], v7 offset:42720
    v_mfma_f32_16x16x32_bf16 v[24:27], a[24:27], v[120:123], v[24:27]
    ds_read_b64_tr_b16 a[62:63], v7 offset:43232
    v_mfma_f32_16x16x32_bf16 v[40:43], a[24:27], v[124:127], v[40:43]
    v_mfma_f32_16x16x32_bf16 v[28:31], a[28:31], v[120:123], v[28:31]
    v_mfma_f32_16x16x32_bf16 v[44:47], a[28:31], v[124:127], v[44:47]
    s_waitcnt lgkmcnt(0)
    s_waitcnt vmcnt(16)
    s_barrier
    v_mfma_f32_16x16x32_bf16 v[16:19], a[32:35], v[128:131], v[16:19]
    ds_read_b64_tr_b16 a[0:1], v7 offset:49920
    ds_read_b64_tr_b16 a[2:3], v7 offset:50432
    v_mfma_f32_16x16x32_bf16 v[32:35], a[32:35], v[132:135], v[32:35]
    ds_read_b64_tr_b16 a[4:5], v7 offset:49952
    v_mfma_f32_16x16x32_bf16 v[20:23], a[36:39], v[128:131], v[20:23]
    ds_read_b64_tr_b16 a[6:7], v7 offset:50464
    v_mfma_f32_16x16x32_bf16 v[36:39], a[36:39], v[132:135], v[36:39]
    ds_read_b64_tr_b16 a[8:9], v7 offset:49984
    v_mfma_f32_16x16x32_bf16 v[24:27], a[40:43], v[128:131], v[24:27]
    ds_read_b64_tr_b16 a[10:11], v7 offset:50496
    ds_read_b64_tr_b16 a[12:13], v7 offset:50016
    v_mfma_f32_16x16x32_bf16 v[40:43], a[40:43], v[132:135], v[40:43]
    ds_read_b64_tr_b16 a[14:15], v7 offset:50528
    v_mfma_f32_16x16x32_bf16 v[28:31], a[44:47], v[128:131], v[28:31]
    ds_read_b64_tr_b16 a[16:17], v7 offset:50944
    v_mfma_f32_16x16x32_bf16 v[44:47], a[44:47], v[132:135], v[44:47]
    ds_read_b64_tr_b16 a[18:19], v7 offset:51456
    s_waitcnt vmcnt(15)
    v_mfma_f32_16x16x32_bf16 v[16:19], a[48:51], v[136:139], v[16:19]
    ds_read_b64_tr_b16 a[20:21], v7 offset:50976
    ds_read_b64_tr_b16 a[22:23], v7 offset:51488
    s_waitcnt vmcnt(14)
    v_mfma_f32_16x16x32_bf16 v[32:35], a[48:51], v[140:143], v[32:35]
    ds_read_b64_tr_b16 a[24:25], v7 offset:51008
    v_mfma_f32_16x16x32_bf16 v[20:23], a[52:55], v[136:139], v[20:23]
    ds_read_b64_tr_b16 a[26:27], v7 offset:51520
    v_mfma_f32_16x16x32_bf16 v[36:39], a[52:55], v[140:143], v[36:39]
    ds_read_b64_tr_b16 a[28:29], v7 offset:51040
    v_mfma_f32_16x16x32_bf16 v[24:27], a[56:59], v[136:139], v[24:27]
    ds_read_b64_tr_b16 a[30:31], v7 offset:51552
    v_mfma_f32_16x16x32_bf16 v[40:43], a[56:59], v[140:143], v[40:43]
    v_mfma_f32_16x16x32_bf16 v[28:31], a[60:63], v[136:139], v[28:31]
    v_mfma_f32_16x16x32_bf16 v[44:47], a[60:63], v[140:143], v[44:47]
    s_waitcnt lgkmcnt(0)
    s_waitcnt vmcnt(10)
    s_barrier
    v_mfma_f32_16x16x32_bf16 v[16:19], a[0:3], v[144:147], v[16:19]
    ds_read_b64_tr_b16 a[32:33], v7 offset:58240
    ds_read_b64_tr_b16 a[34:35], v7 offset:58752
    v_mfma_f32_16x16x32_bf16 v[32:35], a[0:3], v[148:151], v[32:35]
    ds_read_b64_tr_b16 a[36:37], v7 offset:58272
    v_mfma_f32_16x16x32_bf16 v[20:23], a[4:7], v[144:147], v[20:23]
    ds_read_b64_tr_b16 a[38:39], v7 offset:58784
    v_mfma_f32_16x16x32_bf16 v[36:39], a[4:7], v[148:151], v[36:39]
    ds_read_b64_tr_b16 a[40:41], v7 offset:58304
    v_mfma_f32_16x16x32_bf16 v[24:27], a[8:11], v[144:147], v[24:27]
    ds_read_b64_tr_b16 a[42:43], v7 offset:58816
    ds_read_b64_tr_b16 a[44:45], v7 offset:58336
    v_mfma_f32_16x16x32_bf16 v[40:43], a[8:11], v[148:151], v[40:43]
    ds_read_b64_tr_b16 a[46:47], v7 offset:58848
    v_mfma_f32_16x16x32_bf16 v[28:31], a[12:15], v[144:147], v[28:31]
    ds_read_b64_tr_b16 a[48:49], v7 offset:59264
    v_mfma_f32_16x16x32_bf16 v[44:47], a[12:15], v[148:151], v[44:47]
    ds_read_b64_tr_b16 a[50:51], v7 offset:59776
    s_waitcnt vmcnt(9)
    v_mfma_f32_16x16x32_bf16 v[16:19], a[16:19], v[152:155], v[16:19]
    ds_read_b64_tr_b16 a[52:53], v7 offset:59296
    ds_read_b64_tr_b16 a[54:55], v7 offset:59808
    s_waitcnt vmcnt(8)
    v_mfma_f32_16x16x32_bf16 v[32:35], a[16:19], v[156:159], v[32:35]
    ds_read_b64_tr_b16 a[56:57], v7 offset:59328
    v_mfma_f32_16x16x32_bf16 v[20:23], a[20:23], v[152:155], v[20:23]
    ds_read_b64_tr_b16 a[58:59], v7 offset:59840
    v_mfma_f32_16x16x32_bf16 v[36:39], a[20:23], v[156:159], v[36:39]
    ds_read_b64_tr_b16 a[60:61], v7 offset:59360
    v_mfma_f32_16x16x32_bf16 v[24:27], a[24:27], v[152:155], v[24:27]
    ds_read_b64_tr_b16 a[62:63], v7 offset:59872
    v_mfma_f32_16x16x32_bf16 v[40:43], a[24:27], v[156:159], v[40:43]
    v_mfma_f32_16x16x32_bf16 v[28:31], a[28:31], v[152:155], v[28:31]
    v_mfma_f32_16x16x32_bf16 v[44:47], a[28:31], v[156:159], v[44:47]
    s_waitcnt lgkmcnt(0)
    s_waitcnt vmcnt(7)
    v_mfma_f32_16x16x32_bf16 v[16:19], a[32:35], v[160:163], v[16:19]
    s_waitcnt vmcnt(6)
    v_mfma_f32_16x16x32_bf16 v[32:35], a[32:35], v[164:167], v[32:35]
    v_mfma_f32_16x16x32_bf16 v[20:23], a[36:39], v[160:163], v[20:23]
    v_mfma_f32_16x16x32_bf16 v[36:39], a[36:39], v[164:167], v[36:39]
    v_mfma_f32_16x16x32_bf16 v[24:27], a[40:43], v[160:163], v[24:27]
    v_mfma_f32_16x16x32_bf16 v[40:43], a[40:43], v[164:167], v[40:43]
    v_mfma_f32_16x16x32_bf16 v[28:31], a[44:47], v[160:163], v[28:31]
    v_mfma_f32_16x16x32_bf16 v[44:47], a[44:47], v[164:167], v[44:47]
    s_waitcnt vmcnt(5)
    v_mfma_f32_16x16x32_bf16 v[16:19], a[48:51], v[168:171], v[16:19]
    s_waitcnt vmcnt(4)
    v_mfma_f32_16x16x32_bf16 v[32:35], a[48:51], v[172:175], v[32:35]
    v_mfma_f32_16x16x32_bf16 v[20:23], a[52:55], v[168:171], v[20:23]
    v_mfma_f32_16x16x32_bf16 v[36:39], a[52:55], v[172:175], v[36:39]
    v_mfma_f32_16x16x32_bf16 v[24:27], a[56:59], v[168:171], v[24:27]
    v_mfma_f32_16x16x32_bf16 v[40:43], a[56:59], v[172:175], v[40:43]
    v_mfma_f32_16x16x32_bf16 v[28:31], a[60:63], v[168:171], v[28:31]
    v_mfma_f32_16x16x32_bf16 v[44:47], a[60:63], v[172:175], v[44:47]
    s_waitcnt vmcnt(3)
    v_lshlrev_b32 v68, 16, v176
    v_and_b32 v69, 0xffff0000, v176
    v_pk_add_f32 v[16:17], v[16:17], v[68:69]
    v_cvt_pk_bf16_f32 v48, v16, v17
    v_lshlrev_b32 v70, 16, v177
    v_and_b32 v71, 0xffff0000, v177
    v_pk_add_f32 v[18:19], v[18:19], v[70:71]
    v_cvt_pk_bf16_f32 v49, v18, v19
    v_lshlrev_b32 v68, 16, v178
    v_and_b32 v69, 0xffff0000, v178
    v_pk_add_f32 v[20:21], v[20:21], v[68:69]
    v_cvt_pk_bf16_f32 v50, v20, v21
    v_lshlrev_b32 v70, 16, v179
    v_and_b32 v71, 0xffff0000, v179
    v_pk_add_f32 v[22:23], v[22:23], v[70:71]
    v_cvt_pk_bf16_f32 v51, v22, v23
    buffer_store_dwordx4 v[48:51], v4, s[40:43], s26 offen offset:0
    s_waitcnt vmcnt(3)
    v_lshlrev_b32 v68, 16, v180
    v_and_b32 v69, 0xffff0000, v180
    v_pk_add_f32 v[24:25], v[24:25], v[68:69]
    v_cvt_pk_bf16_f32 v52, v24, v25
    v_lshlrev_b32 v70, 16, v181
    v_and_b32 v71, 0xffff0000, v181
    v_pk_add_f32 v[26:27], v[26:27], v[70:71]
    v_cvt_pk_bf16_f32 v53, v26, v27
    v_lshlrev_b32 v68, 16, v182
    v_and_b32 v69, 0xffff0000, v182
    v_pk_add_f32 v[28:29], v[28:29], v[68:69]
    v_cvt_pk_bf16_f32 v54, v28, v29
    v_lshlrev_b32 v70, 16, v183
    v_and_b32 v71, 0xffff0000, v183
    v_pk_add_f32 v[30:31], v[30:31], v[70:71]
    v_cvt_pk_bf16_f32 v55, v30, v31
    buffer_store_dwordx4 v[52:55], v4, s[40:43], s27 offen offset:0
    s_waitcnt vmcnt(3)
    v_lshlrev_b32 v68, 16, v184
    v_and_b32 v69, 0xffff0000, v184
    v_pk_add_f32 v[32:33], v[32:33], v[68:69]
    v_cvt_pk_bf16_f32 v56, v32, v33
    v_lshlrev_b32 v70, 16, v185
    v_and_b32 v71, 0xffff0000, v185
    v_pk_add_f32 v[34:35], v[34:35], v[70:71]
    v_cvt_pk_bf16_f32 v57, v34, v35
    v_lshlrev_b32 v68, 16, v186
    v_and_b32 v69, 0xffff0000, v186
    v_pk_add_f32 v[36:37], v[36:37], v[68:69]
    v_cvt_pk_bf16_f32 v58, v36, v37
    v_lshlrev_b32 v70, 16, v187
    v_and_b32 v71, 0xffff0000, v187
    v_pk_add_f32 v[38:39], v[38:39], v[70:71]
    v_cvt_pk_bf16_f32 v59, v38, v39
    buffer_store_dwordx4 v[56:59], v4, s[40:43], s26 offen offset:1024
    s_waitcnt vmcnt(3)
    v_lshlrev_b32 v68, 16, v188
    v_and_b32 v69, 0xffff0000, v188
    v_pk_add_f32 v[40:41], v[40:41], v[68:69]
    v_cvt_pk_bf16_f32 v60, v40, v41
    v_lshlrev_b32 v70, 16, v189
    v_and_b32 v71, 0xffff0000, v189
    v_pk_add_f32 v[42:43], v[42:43], v[70:71]
    v_cvt_pk_bf16_f32 v61, v42, v43
    v_lshlrev_b32 v68, 16, v190
    v_and_b32 v69, 0xffff0000, v190
    v_pk_add_f32 v[44:45], v[44:45], v[68:69]
    v_cvt_pk_bf16_f32 v62, v44, v45
    v_lshlrev_b32 v70, 16, v191
    v_and_b32 v71, 0xffff0000, v191
    v_pk_add_f32 v[46:47], v[46:47], v[70:71]
    v_cvt_pk_bf16_f32 v63, v46, v47
    buffer_store_dwordx4 v[60:63], v4, s[40:43], s27 offen offset:1024
    v_pk_mul_f32 v[90:91], v[16:17], v[16:17]
    v_pk_fma_f32 v[90:91], v[18:19], v[18:19], v[90:91]
    v_pk_add_f32 v[88:89], v[16:17], v[18:19]
    v_pk_fma_f32 v[90:91], v[20:21], v[20:21], v[90:91]
    v_pk_add_f32 v[88:89], v[88:89], v[20:21]
    v_pk_fma_f32 v[90:91], v[22:23], v[22:23], v[90:91]
    v_pk_add_f32 v[88:89], v[88:89], v[22:23]
    v_pk_fma_f32 v[90:91], v[24:25], v[24:25], v[90:91]
    v_pk_add_f32 v[88:89], v[88:89], v[24:25]
    v_pk_fma_f32 v[90:91], v[26:27], v[26:27], v[90:91]
    v_pk_add_f32 v[88:89], v[88:89], v[26:27]
    v_pk_fma_f32 v[90:91], v[28:29], v[28:29], v[90:91]
    v_pk_add_f32 v[88:89], v[88:89], v[28:29]
    v_pk_fma_f32 v[90:91], v[30:31], v[30:31], v[90:91]
    v_pk_add_f32 v[88:89], v[88:89], v[30:31]
    v_add_f32 v88, v88, v89
    v_add_f32 v90, v90, v91
    v_pk_mul_f32 v[94:95], v[32:33], v[32:33]
    v_pk_fma_f32 v[94:95], v[34:35], v[34:35], v[94:95]
    v_pk_add_f32 v[92:93], v[32:33], v[34:35]
    v_pk_fma_f32 v[94:95], v[36:37], v[36:37], v[94:95]
    v_pk_add_f32 v[92:93], v[92:93], v[36:37]
    v_pk_fma_f32 v[94:95], v[38:39], v[38:39], v[94:95]
    v_pk_add_f32 v[92:93], v[92:93], v[38:39]
    v_pk_fma_f32 v[94:95], v[40:41], v[40:41], v[94:95]
    v_pk_add_f32 v[92:93], v[92:93], v[40:41]
    v_pk_fma_f32 v[94:95], v[42:43], v[42:43], v[94:95]
    v_pk_add_f32 v[92:93], v[92:93], v[42:43]
    v_pk_fma_f32 v[94:95], v[44:45], v[44:45], v[94:95]
    v_pk_add_f32 v[92:93], v[92:93], v[44:45]
    v_pk_fma_f32 v[94:95], v[46:47], v[46:47], v[94:95]
    v_pk_add_f32 v[92:93], v[92:93], v[46:47]
    v_add_f32 v92, v92, v93
    v_add_f32 v94, v94, v95
    s_nop 0
    v_permlane16_swap_b32 v88, v92
    v_permlane16_swap_b32 v90, v94
    v_add_f32 v88, v88, v92
    v_add_f32 v90, v90, v94
    s_lshl_b32 s50, s7, 14
    s_lshl_b32 s51, s6, 10
    s_add_u32 s50, s50, s51
    s_lshl_b32 s51, s3, 8
    s_add_u32 s50, s50, s51
    v_permlane32_swap_b32 v88, v90
    v_and_b32 v78, 31, v1
    v_lshlrev_b32 v78, 3, v78
    v_lshrrev_b32 v92, 5, v1
    v_lshl_add_u32 v78, v92, 2, v78
    v_add_f32 v88, v88, v90
    buffer_store_dword v88, v78, s[44:47], s50 offen
wo1_kernel_end:
    s_endpgm
.text
.globl gu1_kernel
.p2align 8
.type gu1_kernel,@function
gu1_kernel:
    s_cmp_ge_u32 s2, 256
    s_cbranch_scc1 gu1_kernel_end
    s_load_dwordx2 s[10:11], s[0:1], 72
    s_load_dwordx2 s[12:13], s[0:1], 32
    s_load_dwordx2 s[14:15], s[0:1], 40
    v_lshrrev_b32 v2, 6, v0
    v_and_b32 v1, 63, v0
    v_readfirstlane_b32 s3, v2
    s_and_b32 s4, s2, 7
    s_lshr_b32 s5, s2, 3
    s_and_b32 s6, s4, 1
    s_lshl_b32 s6, s6, 2
    s_and_b32 s7, s5, 3
    s_add_u32 s6, s6, s7
    s_lshr_b32 s7, s4, 1
    s_lshl_b32 s7, s7, 3
    s_lshr_b32 s8, s5, 2
    s_add_u32 s7, s7, s8
    s_and_b32 s8, s7, 1
    s_lshr_b32 s9, s7, 1
    s_lshl_b32 s20, s6, 14
    s_lshl_b32 s21, s3, 12
    s_add_u32 s20, s20, s21
    s_lshl_b32 s21, s8, 11
    s_add_u32 s20, s20, s21
    v_lshl_add_u32 v4, v1, 4, s20
    v_xor_b32 v5, 2048, v4
    s_mul_i32 s16, s9, 448
    s_mul_i32 s21, s8, 192
    s_add_u32 s16, s16, s21
    s_and_b32 s21, s3, 1
    s_mul_i32 s21, s21, 28672
    s_add_u32 s21, s21, s16
    v_lshrrev_b32 v14, 4, v1
    v_mul_u32_u24 v14, 57344, v14
    v_and_b32 v15, 15, v1
    v_lshl_add_u32 v14, v15, 4, v14
    v_add_u32 v6, s21, v14
    v_add_u32 v7, 6112, v6
    v_add_u32 v8, 12224, v6
    v_add_u32 v9, 18336, v6
    v_bfe_u32 v14, v1, 2, 3
    v_mul_u32_u24 v14, 1056, v14
    v_bfe_u32 v15, v1, 5, 1
    v_lshl_add_u32 v14, v15, 8, v14
    v_and_b32 v15, 3, v1
    v_lshl_add_u32 v14, v15, 3, v14
    s_lshl_b32 s17, s8, 6
    s_xor_b32 s18, s8, 1
    s_mul_i32 s18, s18, 192
    v_add_u32 v10, s17, v14
    v_add_u32 v12, s18, v14
    v_add_u32 v11, 67584, v10
    v_add_u32 v13, 67584, v12
    s_mul_i32 s22, s3, 4224
    s_mov_b32 s23, 0
    s_mov_b32 s25, 0
    s_lshl_b32 s21, s6, 11
    v_lshl_add_u32 v16, v0, 3, s21
    s_waitcnt lgkmcnt(0)
    s_add_u32 s28, s10, 8388608
    s_addc_u32 s29, s11, 0
    s_mov_b32 s30, 4194304
    s_mov_b32 s31, 0x20000
    s_cmp_lt_u32 s3, 2
    s_cselect_b32 s32, s12, s14
    s_cselect_b32 s33, s13, s15
    s_mov_b32 s34, 7340032
    s_mov_b32 s35, 0x20000
    s_add_u32 s36, s10, 58982400
    s_addc_u32 s37, s11, 0
    s_mov_b32 s38, 262144
    s_mov_b32 s39, 0x20000
    s_add_u32 s44, s10, 60829696
    s_addc_u32 s45, s11, 0
    s_mov_b32 s46, 28672
    s_mov_b32 s47, 0x20000
    s_add_u32 m0, s22, 0
    s_nop 0
    buffer_load_dwordx4 v6, s[32:35], s25 offen offset:0 lds
    buffer_load_dwordx4 v7, s[32:35], s25 offen offset:1056 lds
    buffer_load_dwordx4 v8, s[32:35], s25 offen offset:2112 lds
    buffer_load_dwordx4 v9, s[32:35], s25 offen offset:3168 lds
    s_add_u32 s25, s25, 229376
    buffer_load_dwordx4 a[128:131], v4, s[28:31], s23 offen offset:0
    buffer_load_dwordx4 a[132:135], v4, s[28:31], s23 offen offset:1024
    buffer_load_dwordx4 a[136:139], v5, s[28:31], s23 offen offset:0
    buffer_load_dwordx4 a[140:143], v5, s[28:31], s23 offen offset:1024
    s_add_u32 s23, s23, 0x20000
    s_mov_b32 s26, 0
    buffer_load_dwordx2 v[32:33], v16, s[36:39], s26 offen
    s_mov_b32 s26, 16384
    buffer_load_dwordx2 v[34:35], v16, s[36:39], s26 offen
    s_mov_b32 s26, 32768
    buffer_load_dwordx2 v[36:37], v16, s[36:39], s26 offen
    s_mov_b32 s26, 49152
    buffer_load_dwordx2 v[38:39], v16, s[36:39], s26 offen
    s_mov_b32 s26, 65536
    buffer_load_dwordx2 v[40:41], v16, s[36:39], s26 offen
    s_mov_b32 s26, 81920
    buffer_load_dwordx2 v[42:43], v16, s[36:39], s26 offen
    s_mov_b32 s26, 98304
    buffer_load_dwordx2 v[44:45], v16, s[36:39], s26 offen
    s_mov_b32 s26, 114688
    buffer_load_dwordx2 v[46:47], v16, s[36:39], s26 offen
    s_mov_b32 s26, 131072
    buffer_load_dwordx2 v[48:49], v16, s[36:39], s26 offen
    s_mov_b32 s26, 147456
    buffer_load_dwordx2 v[50:51], v16, s[36:39], s26 offen
    s_mov_b32 s26, 163840
    buffer_load_dwordx2 v[52:53], v16, s[36:39], s26 offen
    s_mov_b32 s26, 180224
    buffer_load_dwordx2 v[54:55], v16, s[36:39], s26 offen
    s_mov_b32 s26, 196608
    buffer_load_dwordx2 v[56:57], v16, s[36:39], s26 offen
    s_mov_b32 s26, 212992
    buffer_load_dwordx2 v[58:59], v16, s[36:39], s26 offen
    s_mov_b32 s26, 229376
    buffer_load_dwordx2 v[60:61], v16, s[36:39], s26 offen
    s_mov_b32 s26, 245760
    buffer_load_dwordx2 v[62:63], v16, s[36:39], s26 offen
    s_lshr_b32 s21, s3, 1
    s_mul_i32 s21, s21, 14336
    s_lshl_b32 s26, s16, 1
    s_add_u32 s21, s21, s26
    s_and_b32 s26, s3, 1
    s_lshl_b32 s26, s26, 8
    s_add_u32 s21, s21, s26
    s_lshl_b32 s26, s3, 8
    s_add_u32 m0, s26, 139264
    v_lshlrev_b32 v17, 2, v1
    buffer_load_dword v17, s[44:47], s21 offen lds
    s_add_u32 m0, s22, 16896
    s_nop 0
    buffer_load_dwordx4 v6, s[32:35], s25 offen offset:0 lds
    buffer_load_dwordx4 v7, s[32:35], s25 offen offset:1056 lds
    buffer_load_dwordx4 v8, s[32:35], s25 offen offset:2112 lds
    buffer_load_dwordx4 v9, s[32:35], s25 offen offset:3168 lds
    s_add_u32 s25, s25, 229376
    buffer_load_dwordx4 a[144:147], v4, s[28:31], s23 offen offset:0
    buffer_load_dwordx4 a[148:151], v4, s[28:31], s23 offen offset:1024
    buffer_load_dwordx4 a[152:155], v5, s[28:31], s23 offen offset:0
    buffer_load_dwordx4 a[156:159], v5, s[28:31], s23 offen offset:1024
    s_add_u32 s23, s23, 0x20000
    s_add_u32 m0, s22, 33792
    s_nop 0
    buffer_load_dwordx4 v6, s[32:35], s25 offen offset:0 lds
    buffer_load_dwordx4 v7, s[32:35], s25 offen offset:1056 lds
    buffer_load_dwordx4 v8, s[32:35], s25 offen offset:2112 lds
    buffer_load_dwordx4 v9, s[32:35], s25 offen offset:3168 lds
    s_add_u32 s25, s25, 229376
    buffer_load_dwordx4 a[160:163], v4, s[28:31], s23 offen offset:0
    buffer_load_dwordx4 a[164:167], v4, s[28:31], s23 offen offset:1024
    buffer_load_dwordx4 a[168:171], v5, s[28:31], s23 offen offset:0
    buffer_load_dwordx4 a[172:175], v5, s[28:31], s23 offen offset:1024
    s_add_u32 s23, s23, 0x20000
    s_add_u32 m0, s22, 50688
    s_nop 0
    buffer_load_dwordx4 v6, s[32:35], s25 offen offset:0 lds
    buffer_load_dwordx4 v7, s[32:35], s25 offen offset:1056 lds
    buffer_load_dwordx4 v8, s[32:35], s25 offen offset:2112 lds
    buffer_load_dwordx4 v9, s[32:35], s25 offen offset:3168 lds
    s_add_u32 s25, s25, 229376
    s_add_u32 s40, s10, 25165824
    s_addc_u32 s41, s11, 0
    s_mov_b32 s42, 14680064
    s_mov_b32 s43, 0x20000
    s_waitcnt vmcnt(41)
    s_barrier
    ds_read_b64_tr_b16 a[0:1], v10 offset:0
    ds_read_b64_tr_b16 a[2:3], v10 offset:512
    ds_read_b64_tr_b16 a[4:5], v10 offset:32
    ds_read_b64_tr_b16 a[6:7], v10 offset:544
    ds_read_b64_tr_b16 a[8:9], v10 offset:8448
    ds_read_b64_tr_b16 a[10:11], v10 offset:8960
    ds_read_b64_tr_b16 a[12:13], v10 offset:8480
    ds_read_b64_tr_b16 a[14:15], v10 offset:8992
    ds_read_b64_tr_b16 a[16:17], v10 offset:64
    ds_read_b64_tr_b16 a[18:19], v10 offset:576
    ds_read_b64_tr_b16 a[20:21], v10 offset:96
    ds_read_b64_tr_b16 a[22:23], v10 offset:608
    ds_read_b64_tr_b16 a[24:25], v10 offset:8512
    ds_read_b64_tr_b16 a[26:27], v10 offset:9024
    ds_read_b64_tr_b16 a[28:29], v10 offset:8544
    ds_read_b64_tr_b16 a[30:31], v10 offset:9056
    ds_read_b64_tr_b16 a[32:33], v10 offset:128
    ds_read_b64_tr_b16 a[34:35], v10 offset:640
    ds_read_b64_tr_b16 a[36:37], v10 offset:160
    ds_read_b64_tr_b16 a[38:39], v10 offset:672
    ds_read_b64_tr_b16 a[40:41], v10 offset:8576
    ds_read_b64_tr_b16 a[42:43], v10 offset:9088
    ds_read_b64_tr_b16 a[44:45], v10 offset:8608
    ds_read_b64_tr_b16 a[46:47], v10 offset:9120
    ds_read_b64_tr_b16 a[48:49], v12 offset:0
    ds_read_b64_tr_b16 a[50:51], v12 offset:512
    ds_read_b64_tr_b16 a[52:53], v12 offset:32
    ds_read_b64_tr_b16 a[54:55], v12 offset:544
    ds_read_b64_tr_b16 a[56:57], v12 offset:8448
    ds_read_b64_tr_b16 a[58:59], v12 offset:8960
    ds_read_b64_tr_b16 a[60:61], v12 offset:8480
    ds_read_b64_tr_b16 a[62:63], v12 offset:8992
    s_waitcnt vmcnt(28)
    v_pk_add_f32 v[32:33], v[32:33], v[48:49]
    s_waitcnt vmcnt(27)
    v_pk_add_f32 v[34:35], v[34:35], v[50:51]
    s_waitcnt vmcnt(26)
    v_pk_add_f32 v[36:37], v[36:37], v[52:53]
    s_waitcnt vmcnt(25)
    v_pk_add_f32 v[38:39], v[38:39], v[54:55]
    s_waitcnt vmcnt(24)
    v_pk_add_f32 v[40:41], v[40:41], v[56:57]
    s_waitcnt vmcnt(23)
    v_pk_add_f32 v[42:43], v[42:43], v[58:59]
    s_waitcnt vmcnt(22)
    v_pk_add_f32 v[44:45], v[44:45], v[60:61]
    s_waitcnt vmcnt(21)
    v_pk_add_f32 v[46:47], v[46:47], v[62:63]
    v_pk_add_f32 v[32:33], v[32:33], v[40:41]
    v_pk_add_f32 v[34:35], v[34:35], v[42:43]
    v_pk_add_f32 v[36:37], v[36:37], v[44:45]
    v_pk_add_f32 v[38:39], v[38:39], v[46:47]
    v_pk_add_f32 v[32:33], v[32:33], v[36:37]
    v_pk_add_f32 v[34:35], v[34:35], v[38:39]
    v_pk_add_f32 v[32:33], v[32:33], v[34:35]
    v_mul_f32 v32, 0xba800000, v32
    v_mul_f32 v33, 0x3a800000, v33
    v_fma_f32 v33, -v32, v32, v33
    v_max_f32 v33, 0, v33
    v_add_f32 v33, 0x3727c5ac, v33
    v_rsq_f32 v34, v33
    s_nop 0
    v_mul_f32 v34, 0xbfb8aa3b, v34
    v_lshlrev_b32 v16, 4, v0
    v_add_u32 v16, 135168, v16
    ds_write_b128 v16, v[32:35]
    s_waitcnt lgkmcnt(0)
    v_mov_b32 v32, 0
    v_mov_b32 v33, 0
    v_mov_b32 v34, 0
    v_mov_b32 v35, 0
    v_mov_b32 v36, 0
    v_mov_b32 v37, 0
    v_mov_b32 v38, 0
    v_mov_b32 v39, 0
    v_mov_b32 v40, 0
    v_mov_b32 v41, 0
    v_mov_b32 v42, 0
    v_mov_b32 v43, 0
    v_mov_b32 v44, 0
    v_mov_b32 v45, 0
    v_mov_b32 v46, 0
    v_mov_b32 v47, 0
    v_mov_b32 v48, 0
    v_mov_b32 v49, 0
    v_mov_b32 v50, 0
    v_mov_b32 v51, 0
    v_mov_b32 v52, 0
    v_mov_b32 v53, 0
    v_mov_b32 v54, 0
    v_mov_b32 v55, 0
    v_mov_b32 v56, 0
    v_mov_b32 v57, 0
    v_mov_b32 v58, 0
    v_mov_b32 v59, 0
    v_mov_b32 v60, 0
    v_mov_b32 v61, 0
    v_mov_b32 v62, 0
    v_mov_b32 v63, 0
    v_mov_b32 v64, 0
    v_mov_b32 v65, 0
    v_mov_b32 v66, 0
    v_mov_b32 v67, 0
    v_mov_b32 v68, 0
    v_mov_b32 v69, 0
    v_mov_b32 v70, 0
    v_mov_b32 v71, 0
    v_mov_b32 v72, 0
    v_mov_b32 v73, 0
    v_mov_b32 v74, 0
    v_mov_b32 v75, 0
    v_mov_b32 v76, 0
    v_mov_b32 v77, 0
    v_mov_b32 v78, 0
    v_mov_b32 v79, 0
    v_mov_b32 v80, 0
    v_mov_b32 v81, 0
    v_mov_b32 v82, 0
    v_mov_b32 v83, 0
    v_mov_b32 v84, 0
    v_mov_b32 v85, 0
    v_mov_b32 v86, 0
    v_mov_b32 v87, 0
    v_mov_b32 v88, 0
    v_mov_b32 v89, 0
    v_mov_b32 v90, 0
    v_mov_b32 v91, 0
    v_mov_b32 v92, 0
    v_mov_b32 v93, 0
    v_mov_b32 v94, 0
    v_mov_b32 v95, 0
    v_mov_b32 v96, 0
    v_mov_b32 v97, 0
    v_mov_b32 v98, 0
    v_mov_b32 v99, 0
    v_mov_b32 v100, 0
    v_mov_b32 v101, 0
    v_mov_b32 v102, 0
    v_mov_b32 v103, 0
    v_mov_b32 v104, 0
    v_mov_b32 v105, 0
    v_mov_b32 v106, 0
    v_mov_b32 v107, 0
    v_mov_b32 v108, 0
    v_mov_b32 v109, 0
    v_mov_b32 v110, 0
    v_mov_b32 v111, 0
    v_mov_b32 v112, 0
    v_mov_b32 v113, 0
    v_mov_b32 v114, 0
    v_mov_b32 v115, 0
    v_mov_b32 v116, 0
    v_mov_b32 v117, 0
    v_mov_b32 v118, 0
    v_mov_b32 v119, 0
    v_mov_b32 v120, 0
    v_mov_b32 v121, 0
    v_mov_b32 v122, 0
    v_mov_b32 v123, 0
    v_mov_b32 v124, 0
    v_mov_b32 v125, 0
    v_mov_b32 v126, 0
    v_mov_b32 v127, 0
    v_mov_b32 v128, 0
    v_mov_b32 v129, 0
    v_mov_b32 v130, 0
    v_mov_b32 v131, 0
    v_mov_b32 v132, 0
    v_mov_b32 v133, 0
    v_mov_b32 v134, 0
    v_mov_b32 v135, 0
    v_mov_b32 v136, 0
    v_mov_b32 v137, 0
    v_mov_b32 v138, 0
    v_mov_b32 v139, 0
    v_mov_b32 v140, 0
    v_mov_b32 v141, 0
    v_mov_b32 v142, 0
    v_mov_b32 v143, 0
    v_mov_b32 v144, 0
    v_mov_b32 v145, 0
    v_mov_b32 v146, 0
    v_mov_b32 v147, 0
    v_mov_b32 v148, 0
    v_mov_b32 v149, 0
    v_mov_b32 v150, 0
    v_mov_b32 v151, 0
    v_mov_b32 v152, 0
    v_mov_b32 v153, 0
    v_mov_b32 v154, 0
    v_mov_b32 v155, 0
    v_mov_b32 v156, 0
    v_mov_b32 v157, 0
    v_mov_b32 v158, 0
    v_mov_b32 v159, 0
    v_mov_b32 v160, 0
    v_mov_b32 v161, 0
    v_mov_b32 v162, 0
    v_mov_b32 v163, 0
    v_mov_b32 v164, 0
    v_mov_b32 v165, 0
    v_mov_b32 v166, 0
    v_mov_b32 v167, 0
    v_mov_b32 v168, 0
    v_mov_b32 v169, 0
    v_mov_b32 v170, 0
    v_mov_b32 v171, 0
    v_mov_b32 v172, 0
    v_mov_b32 v173, 0
    v_mov_b32 v174, 0
    v_mov_b32 v175, 0
    v_mov_b32 v176, 0
    v_mov_b32 v177, 0
    v_mov_b32 v178, 0
    v_mov_b32 v179, 0
    v_mov_b32 v180, 0
    v_mov_b32 v181, 0
    v_mov_b32 v182, 0
    v_mov_b32 v183, 0
    v_mov_b32 v184, 0
    v_mov_b32 v185, 0
    v_mov_b32 v186, 0
    v_mov_b32 v187, 0
    v_mov_b32 v188, 0
    v_mov_b32 v189, 0
    v_mov_b32 v190, 0
    v_mov_b32 v191, 0
    v_mov_b32 v192, 0
    v_mov_b32 v193, 0
    v_mov_b32 v194, 0
    v_mov_b32 v195, 0
    v_mov_b32 v196, 0
    v_mov_b32 v197, 0
    v_mov_b32 v198, 0
    v_mov_b32 v199, 0
    v_mov_b32 v200, 0
    v_mov_b32 v201, 0
    v_mov_b32 v202, 0
    v_mov_b32 v203, 0
    v_mov_b32 v204, 0
    v_mov_b32 v205, 0
    v_mov_b32 v206, 0
    v_mov_b32 v207, 0
    v_mov_b32 v208, 0
    v_mov_b32 v209, 0
    v_mov_b32 v210, 0
    v_mov_b32 v211, 0
    v_mov_b32 v212, 0
    v_mov_b32 v213, 0
    v_mov_b32 v214, 0
    v_mov_b32 v215, 0
    v_mov_b32 v216, 0
    v_mov_b32 v217, 0
    v_mov_b32 v218, 0
    v_mov_b32 v219, 0
    v_mov_b32 v220, 0
    v_mov_b32 v221, 0
    v_mov_b32 v222, 0
    v_mov_b32 v223, 0
    v_mov_b32 v224, 0
    v_mov_b32 v225, 0
    v_mov_b32 v226, 0
    v_mov_b32 v227, 0
    v_mov_b32 v228, 0
    v_mov_b32 v229, 0
    v_mov_b32 v230, 0
    v_mov_b32 v231, 0
    v_mov_b32 v232, 0
    v_mov_b32 v233, 0
    v_mov_b32 v234, 0
    v_mov_b32 v235, 0
    v_mov_b32 v236, 0
    v_mov_b32 v237, 0
    v_mov_b32 v238, 0
    v_mov_b32 v239, 0
    v_mov_b32 v240, 0
    v_mov_b32 v241, 0
    v_mov_b32 v242, 0
    v_mov_b32 v243, 0
    v_mov_b32 v244, 0
    v_mov_b32 v245, 0
    v_mov_b32 v246, 0
    v_mov_b32 v247, 0
    v_mov_b32 v248, 0
    v_mov_b32 v249, 0
    v_mov_b32 v250, 0
    v_mov_b32 v251, 0
    v_mov_b32 v252, 0
    v_mov_b32 v253, 0
    v_mov_b32 v254, 0
    v_mov_b32 v255, 0
    s_mov_b32 s48, 3
.p2align 6
gu1_kernel_loop:
    s_waitcnt lgkmcnt(0)
    s_waitcnt vmcnt(16)
    s_barrier
    v_mfma_f32_16x16x32_bf16 v[32:35], a[0:3], a[128:131], v[32:35]
    ds_read_b64_tr_b16 a[64:65], v10 offset:16896
    v_mfma_f32_16x16x32_bf16 v[36:39], a[0:3], a[132:135], v[36:39]
    ds_read_b64_tr_b16 a[66:67], v10 offset:17408
    s_add_u32 m0, s22, 67584
    s_nop 0
    buffer_load_dwordx4 v6, s[32:35], s25 offen offset:0 lds
    v_mfma_f32_16x16x32_bf16 v[40:43], a[0:3], a[136:139], v[40:43]
    v_mfma_f32_16x16x32_bf16 v[44:47], a[0:3], a[140:143], v[44:47]
    ds_read_b64_tr_b16 a[68:69], v10 offset:16928
    v_mfma_f32_16x16x32_bf16 v[48:51], a[4:7], a[128:131], v[48:51]
    ds_read_b64_tr_b16 a[70:71], v10 offset:17440
    v_mfma_f32_16x16x32_bf16 v[52:55], a[4:7], a[132:135], v[52:55]
    v_mfma_f32_16x16x32_bf16 v[56:59], a[4:7], a[136:139], v[56:59]
    ds_read_b64_tr_b16 a[72:73], v10 offset:25344
    v_mfma_f32_16x16x32_bf16 v[60:63], a[4:7], a[140:143], v[60:63]
    ds_read_b64_tr_b16 a[74:75], v10 offset:25856
    buffer_load_dwordx4 a[176:179], v4, s[28:31], s23 offen offset:0
    v_mfma_f32_16x16x32_bf16 v[64:67], a[8:11], a[128:131], v[64:67]
    v_mfma_f32_16x16x32_bf16 v[68:71], a[8:11], a[132:135], v[68:71]
    ds_read_b64_tr_b16 a[76:77], v10 offset:25376
    v_mfma_f32_16x16x32_bf16 v[72:75], a[8:11], a[136:139], v[72:75]
    ds_read_b64_tr_b16 a[78:79], v10 offset:25888
    v_mfma_f32_16x16x32_bf16 v[76:79], a[8:11], a[140:143], v[76:79]
    v_mfma_f32_16x16x32_bf16 v[80:83], a[12:15], a[128:131], v[80:83]
    ds_read_b64_tr_b16 a[80:81], v10 offset:16960
    v_mfma_f32_16x16x32_bf16 v[84:87], a[12:15], a[132:135], v[84:87]
    v_mfma_f32_16x16x32_bf16 v[88:91], a[12:15], a[136:139], v[88:91]
    ds_read_b64_tr_b16 a[82:83], v10 offset:17472
    buffer_load_dwordx4 v7, s[32:35], s25 offen offset:1056 lds
    v_mfma_f32_16x16x32_bf16 v[92:95], a[12:15], a[140:143], v[92:95]
    ds_read_b64_tr_b16 a[84:85], v10 offset:16992
    v_mfma_f32_16x16x32_bf16 v[96:99], a[16:19], a[128:131], v[96:99]
    v_mfma_f32_16x16x32_bf16 v[100:103], a[16:19], a[132:135], v[100:103]
    ds_read_b64_tr_b16 a[86:87], v10 offset:17504
    v_mfma_f32_16x16x32_bf16 v[104:107], a[16:19], a[136:139], v[104:107]
    ds_read_b64_tr_b16 a[88:89], v10 offset:25408
    v_mfma_f32_16x16x32_bf16 v[108:111], a[16:19], a[140:143], v[108:111]
    v_mfma_f32_16x16x32_bf16 v[112:115], a[20:23], a[128:131], v[112:115]
    ds_read_b64_tr_b16 a[90:91], v10 offset:25920
    v_mfma_f32_16x16x32_bf16 v[116:119], a[20:23], a[132:135], v[116:119]
    ds_read_b64_tr_b16 a[92:93], v10 offset:25440
    buffer_load_dwordx4 a[180:183], v4, s[28:31], s23 offen offset:1024
    v_mfma_f32_16x16x32_bf16 v[120:123], a[20:23], a[136:139], v[120:123]
    v_mfma_f32_16x16x32_bf16 v[124:127], a[20:23], a[140:143], v[124:127]
    ds_read_b64_tr_b16 a[94:95], v10 offset:25952
    v_mfma_f32_16x16x32_bf16 v[128:131], a[24:27], a[128:131], v[128:131]
    v_mfma_f32_16x16x32_bf16 v[132:135], a[24:27], a[132:135], v[132:135]
    ds_read_b64_tr_b16 a[96:97], v10 offset:17024
    v_mfma_f32_16x16x32_bf16 v[136:139], a[24:27], a[136:139], v[136:139]
    ds_read_b64_tr_b16 a[98:99], v10 offset:17536
    v_mfma_f32_16x16x32_bf16 v[140:143], a[24:27], a[140:143], v[140:143]
    v_mfma_f32_16x16x32_bf16 v[144:147], a[28:31], a[128:131], v[144:147]
    ds_read_b64_tr_b16 a[100:101], v10 offset:17056
    buffer_load_dwordx4 v8, s[32:35], s25 offen offset:2112 lds
    v_mfma_f32_16x16x32_bf16 v[148:151], a[28:31], a[132:135], v[148:151]
    ds_read_b64_tr_b16 a[102:103], v10 offset:17568
    v_mfma_f32_16x16x32_bf16 v[152:155], a[28:31], a[136:139], v[152:155]
    v_mfma_f32_16x16x32_bf16 v[156:159], a[28:31], a[140:143], v[156:159]
    ds_read_b64_tr_b16 a[104:105], v10 offset:25472
    v_mfma_f32_16x16x32_bf16 v[160:163], a[32:35], a[128:131], v[160:163]
    ds_read_b64_tr_b16 a[106:107], v10 offset:25984
    v_mfma_f32_16x16x32_bf16 v[164:167], a[32:35], a[132:135], v[164:167]
    v_mfma_f32_16x16x32_bf16 v[168:171], a[32:35], a[136:139], v[168:171]
    ds_read_b64_tr_b16 a[108:109], v10 offset:25504
    v_mfma_f32_16x16x32_bf16 v[172:175], a[32:35], a[140:143], v[172:175]
    ds_read_b64_tr_b16 a[110:111], v10 offset:26016
    buffer_load_dwordx4 a[184:187], v5, s[28:31], s23 offen offset:0
    v_mfma_f32_16x16x32_bf16 v[176:179], a[36:39], a[128:131], v[176:179]
    v_mfma_f32_16x16x32_bf16 v[180:183], a[36:39], a[132:135], v[180:183]
    ds_read_b64_tr_b16 a[112:113], v12 offset:16896
    v_mfma_f32_16x16x32_bf16 v[184:187], a[36:39], a[136:139], v[184:187]
    v_mfma_f32_16x16x32_bf16 v[188:191], a[36:39], a[140:143], v[188:191]
    ds_read_b64_tr_b16 a[114:115], v12 offset:17408
    v_mfma_f32_16x16x32_bf16 v[192:195], a[40:43], a[128:131], v[192:195]
    ds_read_b64_tr_b16 a[116:117], v12 offset:16928
    v_mfma_f32_16x16x32_bf16 v[196:199], a[40:43], a[132:135], v[196:199]
    v_mfma_f32_16x16x32_bf16 v[200:203], a[40:43], a[136:139], v[200:203]
    ds_read_b64_tr_b16 a[118:119], v12 offset:17440
    buffer_load_dwordx4 v9, s[32:35], s25 offen offset:3168 lds
    s_add_u32 s25, s25, 229376
    v_mfma_f32_16x16x32_bf16 v[204:207], a[40:43], a[140:143], v[204:207]
    ds_read_b64_tr_b16 a[120:121], v12 offset:25344
    v_mfma_f32_16x16x32_bf16 v[208:211], a[44:47], a[128:131], v[208:211]
    v_mfma_f32_16x16x32_bf16 v[212:215], a[44:47], a[132:135], v[212:215]
    ds_read_b64_tr_b16 a[122:123], v12 offset:25856
    v_mfma_f32_16x16x32_bf16 v[216:219], a[44:47], a[136:139], v[216:219]
    ds_read_b64_tr_b16 a[124:125], v12 offset:25376
    v_mfma_f32_16x16x32_bf16 v[220:223], a[44:47], a[140:143], v[220:223]
    v_mfma_f32_16x16x32_bf16 v[224:227], a[48:51], a[128:131], v[224:227]
    ds_read_b64_tr_b16 a[126:127], v12 offset:25888
    v_mfma_f32_16x16x32_bf16 v[228:231], a[48:51], a[132:135], v[228:231]
    buffer_load_dwordx4 a[188:191], v5, s[28:31], s23 offen offset:1024
    s_add_u32 s23, s23, 0x20000
    v_mfma_f32_16x16x32_bf16 v[232:235], a[52:55], a[128:131], v[232:235]
    v_mfma_f32_16x16x32_bf16 v[236:239], a[52:55], a[132:135], v[236:239]
    v_mfma_f32_16x16x32_bf16 v[240:243], a[56:59], a[128:131], v[240:243]
    v_mfma_f32_16x16x32_bf16 v[244:247], a[56:59], a[132:135], v[244:247]
    v_mfma_f32_16x16x32_bf16 v[248:251], a[60:63], a[128:131], v[248:251]
    v_mfma_f32_16x16x32_bf16 v[252:255], a[60:63], a[132:135], v[252:255]
    s_waitcnt lgkmcnt(0)
    s_waitcnt vmcnt(16)
    s_barrier
    v_mfma_f32_16x16x32_bf16 v[32:35], a[64:67], a[144:147], v[32:35]
    ds_read_b64_tr_b16 a[0:1], v10 offset:33792
    v_mfma_f32_16x16x32_bf16 v[36:39], a[64:67], a[148:151], v[36:39]
    ds_read_b64_tr_b16 a[2:3], v10 offset:34304
    s_add_u32 m0, s22, 84480
    s_nop 0
    buffer_load_dwordx4 v6, s[32:35], s25 offen offset:0 lds
    v_mfma_f32_16x16x32_bf16 v[40:43], a[64:67], a[152:155], v[40:43]
    v_mfma_f32_16x16x32_bf16 v[44:47], a[64:67], a[156:159], v[44:47]
    ds_read_b64_tr_b16 a[4:5], v10 offset:33824
    v_mfma_f32_16x16x32_bf16 v[48:51], a[68:71], a[144:147], v[48:51]
    ds_read_b64_tr_b16 a[6:7], v10 offset:34336
    v_mfma_f32_16x16x32_bf16 v[52:55], a[68:71], a[148:151], v[52:55]
    v_mfma_f32_16x16x32_bf16 v[56:59], a[68:71], a[152:155], v[56:59]
    ds_read_b64_tr_b16 a[8:9], v10 offset:42240
    v_mfma_f32_16x16x32_bf16 v[60:63], a[68:71], a[156:159], v[60:63]
    ds_read_b64_tr_b16 a[10:11], v10 offset:42752
    buffer_load_dwordx4 a[128:131], v4, s[28:31], s23 offen offset:0
    v_mfma_f32_16x16x32_bf16 v[64:67], a[72:75], a[144:147], v[64:67]
    v_mfma_f32_16x16x32_bf16 v[68:71], a[72:75], a[148:151], v[68:71]
    ds_read_b64_tr_b16 a[12:13], v10 offset:42272
    v_mfma_f32_16x16x32_bf16 v[72:75], a[72:75], a[152:155], v[72:75]
    ds_read_b64_tr_b16 a[14:15], v10 offset:42784
    v_mfma_f32_16x16x32_bf16 v[76:79], a[72:75], a[156:159], v[76:79]
    v_mfma_f32_16x16x32_bf16 v[80:83], a[76:79], a[144:147], v[80:83]
    ds_read_b64_tr_b16 a[16:17], v10 offset:33856
    v_mfma_f32_16x16x32_bf16 v[84:87], a[76:79], a[148:151], v[84:87]
    v_mfma_f32_16x16x32_bf16 v[88:91], a[76:79], a[152:155], v[88:91]
    ds_read_b64_tr_b16 a[18:19], v10 offset:34368
    buffer_load_dwordx4 v7, s[32:35], s25 offen offset:1056 lds
    v_mfma_f32_16x16x32_bf16 v[92:95], a[76:79], a[156:159], v[92:95]
    ds_read_b64_tr_b16 a[20:21], v10 offset:33888
    v_mfma_f32_16x16x32_bf16 v[96:99], a[80:83], a[144:147], v[96:99]
    v_mfma_f32_16x16x32_bf16 v[100:103], a[80:83], a[148:151], v[100:103]
    ds_read_b64_tr_b16 a[22:23], v10 offset:34400
    v_mfma_f32_16x16x32_bf16 v[104:107], a[80:83], a[152:155], v[104:107]
    ds_read_b64_tr_b16 a[24:25], v10 offset:42304
    v_mfma_f32_16x16x32_bf16 v[108:111], a[80:83], a[156:159], v[108:111]
    v_mfma_f32_16x16x32_bf16 v[112:115], a[84:87], a[144:147], v[112:115]
    ds_read_b64_tr_b16 a[26:27], v10 offset:42816
    v_mfma_f32_16x16x32_bf16 v[116:119], a[84:87], a[148:151], v[116:119]
    ds_read_b64_tr_b16 a[28:29], v10 offset:42336
    buffer_load_dwordx4 a[132:135], v4, s[28:31], s23 offen offset:1024
    v_mfma_f32_16x16x32_bf16 v[120:123], a[84:87], a[152:155], v[120:123]
    v_mfma_f32_16x16x32_bf16 v[124:127], a[84:87], a[156:159], v[124:127]
    ds_read_b64_tr_b16 a[30:31], v10 offset:42848
    v_mfma_f32_16x16x32_bf16 v[128:131], a[88:91], a[144:147], v[128:131]
    v_mfma_f32_16x16x32_bf16 v[132:135], a[88:91], a[148:151], v[132:135]
    ds_read_b64_tr_b16 a[32:33], v10 offset:33920
    v_mfma_f32_16x16x32_bf16 v[136:139], a[88:91], a[152:155], v[136:139]
    ds_read_b64_tr_b16 a[34:35], v10 offset:34432
    v_mfma_f32_16x16x32_bf16 v[140:143], a[88:91], a[156:159], v[140:143]
    v_mfma_f32_16x16x32_bf16 v[144:147], a[92:95], a[144:147], v[144:147]
    ds_read_b64_tr_b16 a[36:37], v10 offset:33952
    buffer_load_dwordx4 v8, s[32:35], s25 offen offset:2112 lds
    v_mfma_f32_16x16x32_bf16 v[148:151], a[92:95], a[148:151], v[148:151]
    ds_read_b64_tr_b16 a[38:39], v10 offset:34464
    v_mfma_f32_16x16x32_bf16 v[152:155], a[92:95], a[152:155], v[152:155]
    v_mfma_f32_16x16x32_bf16 v[156:159], a[92:95], a[156:159], v[156:159]
    ds_read_b64_tr_b16 a[40:41], v10 offset:42368
    v_mfma_f32_16x16x32_bf16 v[160:163], a[96:99], a[144:147], v[160:163]
    ds_read_b64_tr_b16 a[42:43], v10 offset:42880
    v_mfma_f32_16x16x32_bf16 v[164:167], a[96:99], a[148:151], v[164:167]
    v_mfma_f32_16x16x32_bf16 v[168:171], a[96:99], a[152:155], v[168:171]
    ds_read_b64_tr_b16 a[44:45], v10 offset:42400
    v_mfma_f32_16x16x32_bf16 v[172:175], a[96:99], a[156:159], v[172:175]
    ds_read_b64_tr_b16 a[46:47], v10 offset:42912
    buffer_load_dwordx4 a[136:139], v5, s[28:31], s23 offen offset:0
    v_mfma_f32_16x16x32_bf16 v[176:179], a[100:103], a[144:147], v[176:179]
    v_mfma_f32_16x16x32_bf16 v[180:183], a[100:103], a[148:151], v[180:183]
    ds_read_b64_tr_b16 a[48:49], v12 offset:33792
    v_mfma_f32_16x16x32_bf16 v[184:187], a[100:103], a[152:155], v[184:187]
    v_mfma_f32_16x16x32_bf16 v[188:191], a[100:103], a[156:159], v[188:191]
    ds_read_b64_tr_b16 a[50:51], v12 offset:34304
    v_mfma_f32_16x16x32_bf16 v[192:195], a[104:107], a[144:147], v[192:195]
    ds_read_b64_tr_b16 a[52:53], v12 offset:33824
    v_mfma_f32_16x16x32_bf16 v[196:199], a[104:107], a[148:151], v[196:199]
    v_mfma_f32_16x16x32_bf16 v[200:203], a[104:107], a[152:155], v[200:203]
    ds_read_b64_tr_b16 a[54:55], v12 offset:34336
    buffer_load_dwordx4 v9, s[32:35], s25 offen offset:3168 lds
    s_add_u32 s25, s25, 229376
    v_mfma_f32_16x16x32_bf16 v[204:207], a[104:107], a[156:159], v[204:207]
    ds_read_b64_tr_b16 a[56:57], v12 offset:42240
    v_mfma_f32_16x16x32_bf16 v[208:211], a[108:111], a[144:147], v[208:211]
    v_mfma_f32_16x16x32_bf16 v[212:215], a[108:111], a[148:151], v[212:215]
    ds_read_b64_tr_b16 a[58:59], v12 offset:42752
    v_mfma_f32_16x16x32_bf16 v[216:219], a[108:111], a[152:155], v[216:219]
    ds_read_b64_tr_b16 a[60:61], v12 offset:42272
    v_mfma_f32_16x16x32_bf16 v[220:223], a[108:111], a[156:159], v[220:223]
    v_mfma_f32_16x16x32_bf16 v[224:227], a[112:115], a[144:147], v[224:227]
    ds_read_b64_tr_b16 a[62:63], v12 offset:42784
    v_mfma_f32_16x16x32_bf16 v[228:231], a[112:115], a[148:151], v[228:231]
    buffer_load_dwordx4 a[140:143], v5, s[28:31], s23 offen offset:1024
    s_add_u32 s23, s23, 0x20000
    v_mfma_f32_16x16x32_bf16 v[232:235], a[116:119], a[144:147], v[232:235]
    v_mfma_f32_16x16x32_bf16 v[236:239], a[116:119], a[148:151], v[236:239]
    v_mfma_f32_16x16x32_bf16 v[240:243], a[120:123], a[144:147], v[240:243]
    v_mfma_f32_16x16x32_bf16 v[244:247], a[120:123], a[148:151], v[244:247]
    v_mfma_f32_16x16x32_bf16 v[248:251], a[124:127], a[144:147], v[248:251]
    v_mfma_f32_16x16x32_bf16 v[252:255], a[124:127], a[148:151], v[252:255]
    s_waitcnt lgkmcnt(0)
    s_waitcnt vmcnt(16)
    s_barrier
    v_mfma_f32_16x16x32_bf16 v[32:35], a[0:3], a[160:163], v[32:35]
    ds_read_b64_tr_b16 a[64:65], v10 offset:50688
    v_mfma_f32_16x16x32_bf16 v[36:39], a[0:3], a[164:167], v[36:39]
    ds_read_b64_tr_b16 a[66:67], v10 offset:51200
    s_add_u32 m0, s22, 101376
    s_nop 0
    buffer_load_dwordx4 v6, s[32:35], s25 offen offset:0 lds
    v_mfma_f32_16x16x32_bf16 v[40:43], a[0:3], a[168:171], v[40:43]
    v_mfma_f32_16x16x32_bf16 v[44:47], a[0:3], a[172:175], v[44:47]
    ds_read_b64_tr_b16 a[68:69], v10 offset:50720
    v_mfma_f32_16x16x32_bf16 v[48:51], a[4:7], a[160:163], v[48:51]
    ds_read_b64_tr_b16 a[70:71], v10 offset:51232
    v_mfma_f32_16x16x32_bf16 v[52:55], a[4:7], a[164:167], v[52:55]
    v_mfma_f32_16x16x32_bf16 v[56:59], a[4:7], a[168:171], v[56:59]
    ds_read_b64_tr_b16 a[72:73], v10 offset:59136
    v_mfma_f32_16x16x32_bf16 v[60:63], a[4:7], a[172:175], v[60:63]
    ds_read_b64_tr_b16 a[74:75], v10 offset:59648
    buffer_load_dwordx4 a[144:147], v4, s[28:31], s23 offen offset:0
    v_mfma_f32_16x16x32_bf16 v[64:67], a[8:11], a[160:163], v[64:67]
    v_mfma_f32_16x16x32_bf16 v[68:71], a[8:11], a[164:167], v[68:71]
    ds_read_b64_tr_b16 a[76:77], v10 offset:59168
    v_mfma_f32_16x16x32_bf16 v[72:75], a[8:11], a[168:171], v[72:75]
    ds_read_b64_tr_b16 a[78:79], v10 offset:59680
    v_mfma_f32_16x16x32_bf16 v[76:79], a[8:11], a[172:175], v[76:79]
    v_mfma_f32_16x16x32_bf16 v[80:83], a[12:15], a[160:163], v[80:83]
    ds_read_b64_tr_b16 a[80:81], v10 offset:50752
    v_mfma_f32_16x16x32_bf16 v[84:87], a[12:15], a[164:167], v[84:87]
    v_mfma_f32_16x16x32_bf16 v[88:91], a[12:15], a[168:171], v[88:91]
    ds_read_b64_tr_b16 a[82:83], v10 offset:51264
    buffer_load_dwordx4 v7, s[32:35], s25 offen offset:1056 lds
    v_mfma_f32_16x16x32_bf16 v[92:95], a[12:15], a[172:175], v[92:95]
    ds_read_b64_tr_b16 a[84:85], v10 offset:50784
    v_mfma_f32_16x16x32_bf16 v[96:99], a[16:19], a[160:163], v[96:99]
    v_mfma_f32_16x16x32_bf16 v[100:103], a[16:19], a[164:167], v[100:103]
    ds_read_b64_tr_b16 a[86:87], v10 offset:51296
    v_mfma_f32_16x16x32_bf16 v[104:107], a[16:19], a[168:171], v[104:107]
    ds_read_b64_tr_b16 a[88:89], v10 offset:59200
    v_mfma_f32_16x16x32_bf16 v[108:111], a[16:19], a[172:175], v[108:111]
    v_mfma_f32_16x16x32_bf16 v[112:115], a[20:23], a[160:163], v[112:115]
    ds_read_b64_tr_b16 a[90:91], v10 offset:59712
    v_mfma_f32_16x16x32_bf16 v[116:119], a[20:23], a[164:167], v[116:119]
    ds_read_b64_tr_b16 a[92:93], v10 offset:59232
    buffer_load_dwordx4 a[148:151], v4, s[28:31], s23 offen offset:1024
    v_mfma_f32_16x16x32_bf16 v[120:123], a[20:23], a[168:171], v[120:123]
    v_mfma_f32_16x16x32_bf16 v[124:127], a[20:23], a[172:175], v[124:127]
    ds_read_b64_tr_b16 a[94:95], v10 offset:59744
    v_mfma_f32_16x16x32_bf16 v[128:131], a[24:27], a[160:163], v[128:131]
    v_mfma_f32_16x16x32_bf16 v[132:135], a[24:27], a[164:167], v[132:135]
    ds_read_b64_tr_b16 a[96:97], v10 offset:50816
    v_mfma_f32_16x16x32_bf16 v[136:139], a[24:27], a[168:171], v[136:139]
    ds_read_b64_tr_b16 a[98:99], v10 offset:51328
    v_mfma_f32_16x16x32_bf16 v[140:143], a[24:27], a[172:175], v[140:143]
    v_mfma_f32_16x16x32_bf16 v[144:147], a[28:31], a[160:163], v[144:147]
    ds_read_b64_tr_b16 a[100:101], v10 offset:50848
    buffer_load_dwordx4 v8, s[32:35], s25 offen offset:2112 lds
    v_mfma_f32_16x16x32_bf16 v[148:151], a[28:31], a[164:167], v[148:151]
    ds_read_b64_tr_b16 a[102:103], v10 offset:51360
    v_mfma_f32_16x16x32_bf16 v[152:155], a[28:31], a[168:171], v[152:155]
    v_mfma_f32_16x16x32_bf16 v[156:159], a[28:31], a[172:175], v[156:159]
    ds_read_b64_tr_b16 a[104:105], v10 offset:59264
    v_mfma_f32_16x16x32_bf16 v[160:163], a[32:35], a[160:163], v[160:163]
    ds_read_b64_tr_b16 a[106:107], v10 offset:59776
    v_mfma_f32_16x16x32_bf16 v[164:167], a[32:35], a[164:167], v[164:167]
    v_mfma_f32_16x16x32_bf16 v[168:171], a[32:35], a[168:171], v[168:171]
    ds_read_b64_tr_b16 a[108:109], v10 offset:59296
    v_mfma_f32_16x16x32_bf16 v[172:175], a[32:35], a[172:175], v[172:175]
    ds_read_b64_tr_b16 a[110:111], v10 offset:59808
    buffer_load_dwordx4 a[152:155], v5, s[28:31], s23 offen offset:0
    v_mfma_f32_16x16x32_bf16 v[176:179], a[36:39], a[160:163], v[176:179]
    v_mfma_f32_16x16x32_bf16 v[180:183], a[36:39], a[164:167], v[180:183]
    ds_read_b64_tr_b16 a[112:113], v12 offset:50688
    v_mfma_f32_16x16x32_bf16 v[184:187], a[36:39], a[168:171], v[184:187]
    v_mfma_f32_16x16x32_bf16 v[188:191], a[36:39], a[172:175], v[188:191]
    ds_read_b64_tr_b16 a[114:115], v12 offset:51200
    v_mfma_f32_16x16x32_bf16 v[192:195], a[40:43], a[160:163], v[192:195]
    ds_read_b64_tr_b16 a[116:117], v12 offset:50720
    v_mfma_f32_16x16x32_bf16 v[196:199], a[40:43], a[164:167], v[196:199]
    v_mfma_f32_16x16x32_bf16 v[200:203], a[40:43], a[168:171], v[200:203]
    ds_read_b64_tr_b16 a[118:119], v12 offset:51232
    buffer_load_dwordx4 v9, s[32:35], s25 offen offset:3168 lds
    s_add_u32 s25, s25, 229376
    v_mfma_f32_16x16x32_bf16 v[204:207], a[40:43], a[172:175], v[204:207]
    ds_read_b64_tr_b16 a[120:121], v12 offset:59136
    v_mfma_f32_16x16x32_bf16 v[208:211], a[44:47], a[160:163], v[208:211]
    v_mfma_f32_16x16x32_bf16 v[212:215], a[44:47], a[164:167], v[212:215]
    ds_read_b64_tr_b16 a[122:123], v12 offset:59648
    v_mfma_f32_16x16x32_bf16 v[216:219], a[44:47], a[168:171], v[216:219]
    ds_read_b64_tr_b16 a[124:125], v12 offset:59168
    v_mfma_f32_16x16x32_bf16 v[220:223], a[44:47], a[172:175], v[220:223]
    v_mfma_f32_16x16x32_bf16 v[224:227], a[48:51], a[160:163], v[224:227]
    ds_read_b64_tr_b16 a[126:127], v12 offset:59680
    v_mfma_f32_16x16x32_bf16 v[228:231], a[48:51], a[164:167], v[228:231]
    buffer_load_dwordx4 a[156:159], v5, s[28:31], s23 offen offset:1024
    s_add_u32 s23, s23, 0x20000
    v_mfma_f32_16x16x32_bf16 v[232:235], a[52:55], a[160:163], v[232:235]
    v_mfma_f32_16x16x32_bf16 v[236:239], a[52:55], a[164:167], v[236:239]
    v_mfma_f32_16x16x32_bf16 v[240:243], a[56:59], a[160:163], v[240:243]
    v_mfma_f32_16x16x32_bf16 v[244:247], a[56:59], a[164:167], v[244:247]
    v_mfma_f32_16x16x32_bf16 v[248:251], a[60:63], a[160:163], v[248:251]
    v_mfma_f32_16x16x32_bf16 v[252:255], a[60:63], a[164:167], v[252:255]
    s_waitcnt lgkmcnt(0)
    s_waitcnt vmcnt(17)
    s_barrier
    v_mfma_f32_16x16x32_bf16 v[32:35], a[64:67], a[176:179], v[32:35]
    ds_read_b64_tr_b16 a[0:1], v11 offset:0
    v_mfma_f32_16x16x32_bf16 v[36:39], a[64:67], a[180:183], v[36:39]
    ds_read_b64_tr_b16 a[2:3], v11 offset:512
    s_add_u32 m0, s22, 118272
    s_nop 0
    buffer_load_dwordx4 v6, s[32:35], s25 offen offset:0 lds
    v_mfma_f32_16x16x32_bf16 v[40:43], a[64:67], a[184:187], v[40:43]
    s_waitcnt vmcnt(17)
    v_mfma_f32_16x16x32_bf16 v[44:47], a[64:67], a[188:191], v[44:47]
    ds_read_b64_tr_b16 a[4:5], v11 offset:32
    v_mfma_f32_16x16x32_bf16 v[48:51], a[68:71], a[176:179], v[48:51]
    ds_read_b64_tr_b16 a[6:7], v11 offset:544
    v_mfma_f32_16x16x32_bf16 v[52:55], a[68:71], a[180:183], v[52:55]
    v_mfma_f32_16x16x32_bf16 v[56:59], a[68:71], a[184:187], v[56:59]
    ds_read_b64_tr_b16 a[8:9], v11 offset:8448
    v_mfma_f32_16x16x32_bf16 v[60:63], a[68:71], a[188:191], v[60:63]
    ds_read_b64_tr_b16 a[10:11], v11 offset:8960
    buffer_load_dwordx4 a[160:163], v4, s[28:31], s23 offen offset:0
    v_mfma_f32_16x16x32_bf16 v[64:67], a[72:75], a[176:179], v[64:67]
    v_mfma_f32_16x16x32_bf16 v[68:71], a[72:75], a[180:183], v[68:71]
    ds_read_b64_tr_b16 a[12:13], v11 offset:8480
    v_mfma_f32_16x16x32_bf16 v[72:75], a[72:75], a[184:187], v[72:75]
    ds_read_b64_tr_b16 a[14:15], v11 offset:8992
    v_mfma_f32_16x16x32_bf16 v[76:79], a[72:75], a[188:191], v[76:79]
    v_mfma_f32_16x16x32_bf16 v[80:83], a[76:79], a[176:179], v[80:83]
    ds_read_b64_tr_b16 a[16:17], v11 offset:64
    v_mfma_f32_16x16x32_bf16 v[84:87], a[76:79], a[180:183], v[84:87]
    v_mfma_f32_16x16x32_bf16 v[88:91], a[76:79], a[184:187], v[88:91]
    ds_read_b64_tr_b16 a[18:19], v11 offset:576
    buffer_load_dwordx4 v7, s[32:35], s25 offen offset:1056 lds
    v_mfma_f32_16x16x32_bf16 v[92:95], a[76:79], a[188:191], v[92:95]
    ds_read_b64_tr_b16 a[20:21], v11 offset:96
    v_mfma_f32_16x16x32_bf16 v[96:99], a[80:83], a[176:179], v[96:99]
    v_mfma_f32_16x16x32_bf16 v[100:103], a[80:83], a[180:183], v[100:103]
    ds_read_b64_tr_b16 a[22:23], v11 offset:608
    v_mfma_f32_16x16x32_bf16 v[104:107], a[80:83], a[184:187], v[104:107]
    ds_read_b64_tr_b16 a[24:25], v11 offset:8512
    v_mfma_f32_16x16x32_bf16 v[108:111], a[80:83], a[188:191], v[108:111]
    v_mfma_f32_16x16x32_bf16 v[112:115], a[84:87], a[176:179], v[112:115]
    ds_read_b64_tr_b16 a[26:27], v11 offset:9024
    v_mfma_f32_16x16x32_bf16 v[116:119], a[84:87], a[180:183], v[116:119]
    ds_read_b64_tr_b16 a[28:29], v11 offset:8544
    buffer_load_dwordx4 a[164:167], v4, s[28:31], s23 offen offset:1024
    v_mfma_f32_16x16x32_bf16 v[120:123], a[84:87], a[184:187], v[120:123]
    v_mfma_f32_16x16x32_bf16 v[124:127], a[84:87], a[188:191], v[124:127]
    ds_read_b64_tr_b16 a[30:31], v11 offset:9056
    v_mfma_f32_16x16x32_bf16 v[128:131], a[88:91], a[176:179], v[128:131]
    v_mfma_f32_16x16x32_bf16 v[132:135], a[88:91], a[180:183], v[132:135]
    ds_read_b64_tr_b16 a[32:33], v11 offset:128
    v_mfma_f32_16x16x32_bf16 v[136:139], a[88:91], a[184:187], v[136:139]
    ds_read_b64_tr_b16 a[34:35], v11 offset:640
    v_mfma_f32_16x16x32_bf16 v[140:143], a[88:91], a[188:191], v[140:143]
    v_mfma_f32_16x16x32_bf16 v[144:147], a[92:95], a[176:179], v[144:147]
    ds_read_b64_tr_b16 a[36:37], v11 offset:160
    buffer_load_dwordx4 v8, s[32:35], s25 offen offset:2112 lds
    v_mfma_f32_16x16x32_bf16 v[148:151], a[92:95], a[180:183], v[148:151]
    ds_read_b64_tr_b16 a[38:39], v11 offset:672
    v_mfma_f32_16x16x32_bf16 v[152:155], a[92:95], a[184:187], v[152:155]
    v_mfma_f32_16x16x32_bf16 v[156:159], a[92:95], a[188:191], v[156:159]
    ds_read_b64_tr_b16 a[40:41], v11 offset:8576
    v_mfma_f32_16x16x32_bf16 v[160:163], a[96:99], a[176:179], v[160:163]
    ds_read_b64_tr_b16 a[42:43], v11 offset:9088
    v_mfma_f32_16x16x32_bf16 v[164:167], a[96:99], a[180:183], v[164:167]
    v_mfma_f32_16x16x32_bf16 v[168:171], a[96:99], a[184:187], v[168:171]
    ds_read_b64_tr_b16 a[44:45], v11 offset:8608
    v_mfma_f32_16x16x32_bf16 v[172:175], a[96:99], a[188:191], v[172:175]
    ds_read_b64_tr_b16 a[46:47], v11 offset:9120
    buffer_load_dwordx4 a[168:171], v5, s[28:31], s23 offen offset:0
    v_mfma_f32_16x16x32_bf16 v[176:179], a[100:103], a[176:179], v[176:179]
    v_mfma_f32_16x16x32_bf16 v[180:183], a[100:103], a[180:183], v[180:183]
    ds_read_b64_tr_b16 a[48:49], v13 offset:0
    v_mfma_f32_16x16x32_bf16 v[184:187], a[100:103], a[184:187], v[184:187]
    v_mfma_f32_16x16x32_bf16 v[188:191], a[100:103], a[188:191], v[188:191]
    ds_read_b64_tr_b16 a[50:51], v13 offset:512
    v_mfma_f32_16x16x32_bf16 v[192:195], a[104:107], a[176:179], v[192:195]
    ds_read_b64_tr_b16 a[52:53], v13 offset:32
    v_mfma_f32_16x16x32_bf16 v[196:199], a[104:107], a[180:183], v[196:199]
    v_mfma_f32_16x16x32_bf16 v[200:203], a[104:107], a[184:187], v[200:203]
    ds_read_b64_tr_b16 a[54:55], v13 offset:544
    buffer_load_dwordx4 v9, s[32:35], s25 offen offset:3168 lds
    s_add_u32 s25, s25, 229376
    v_mfma_f32_16x16x32_bf16 v[204:207], a[104:107], a[188:191], v[204:207]
    ds_read_b64_tr_b16 a[56:57], v13 offset:8448
    v_mfma_f32_16x16x32_bf16 v[208:211], a[108:111], a[176:179], v[208:211]
    v_mfma_f32_16x16x32_bf16 v[212:215], a[108:111], a[180:183], v[212:215]
    ds_read_b64_tr_b16 a[58:59], v13 offset:8960
    v_mfma_f32_16x16x32_bf16 v[216:219], a[108:111], a[184:187], v[216:219]
    ds_read_b64_tr_b16 a[60:61], v13 offset:8480
    v_mfma_f32_16x16x32_bf16 v[220:223], a[108:111], a[188:191], v[220:223]
    v_mfma_f32_16x16x32_bf16 v[224:227], a[112:115], a[176:179], v[224:227]
    ds_read_b64_tr_b16 a[62:63], v13 offset:8992
    v_mfma_f32_16x16x32_bf16 v[228:231], a[112:115], a[180:183], v[228:231]
    buffer_load_dwordx4 a[172:175], v5, s[28:31], s23 offen offset:1024
    s_add_u32 s23, s23, 0x20000
    v_mfma_f32_16x16x32_bf16 v[232:235], a[116:119], a[176:179], v[232:235]
    v_mfma_f32_16x16x32_bf16 v[236:239], a[116:119], a[180:183], v[236:239]
    v_mfma_f32_16x16x32_bf16 v[240:243], a[120:123], a[176:179], v[240:243]
    v_mfma_f32_16x16x32_bf16 v[244:247], a[120:123], a[180:183], v[244:247]
    v_mfma_f32_16x16x32_bf16 v[248:251], a[124:127], a[176:179], v[248:251]
    v_mfma_f32_16x16x32_bf16 v[252:255], a[124:127], a[180:183], v[252:255]
    s_waitcnt lgkmcnt(0)
    s_waitcnt vmcnt(17)
    s_barrier
    v_mfma_f32_16x16x32_bf16 v[32:35], a[0:3], a[128:131], v[32:35]
    ds_read_b64_tr_b16 a[64:65], v11 offset:16896
    v_mfma_f32_16x16x32_bf16 v[36:39], a[0:3], a[132:135], v[36:39]
    ds_read_b64_tr_b16 a[66:67], v11 offset:17408
    s_add_u32 m0, s22, 0
    s_nop 0
    buffer_load_dwordx4 v6, s[32:35], s25 offen offset:0 lds
    v_mfma_f32_16x16x32_bf16 v[40:43], a[0:3], a[136:139], v[40:43]
    s_waitcnt vmcnt(17)
    v_mfma_f32_16x16x32_bf16 v[44:47], a[0:3], a[140:143], v[44:47]
    ds_read_b64_tr_b16 a[68:69], v11 offset:16928
    v_mfma_f32_16x16x32_bf16 v[48:51], a[4:7], a[128:131], v[48:51]
    ds_read_b64_tr_b16 a[70:71], v11 offset:17440
    v_mfma_f32_16x16x32_bf16 v[52:55], a[4:7], a[132:135], v[52:55]
    v_mfma_f32_16x16x32_bf16 v[56:59], a[4:7], a[136:139], v[56:59]
    ds_read_b64_tr_b16 a[72:73], v11 offset:25344
    v_mfma_f32_16x16x32_bf16 v[60:63], a[4:7], a[140:143], v[60:63]
    ds_read_b64_tr_b16 a[74:75], v11 offset:25856
    buffer_load_dwordx4 a[176:179], v4, s[28:31], s23 offen offset:0
    v_mfma_f32_16x16x32_bf16 v[64:67], a[8:11], a[128:131], v[64:67]
    v_mfma_f32_16x16x32_bf16 v[68:71], a[8:11], a[132:135], v[68:71]
    ds_read_b64_tr_b16 a[76:77], v11 offset:25376
    v_mfma_f32_16x16x32_bf16 v[72:75], a[8:11], a[136:139], v[72:75]
    ds_read_b64_tr_b16 a[78:79], v11 offset:25888
    v_mfma_f32_16x16x32_bf16 v[76:79], a[8:11], a[140:143], v[76:79]
    v_mfma_f32_16x16x32_bf16 v[80:83], a[12:15], a[128:131], v[80:83]
    ds_read_b64_tr_b16 a[80:81], v11 offset:16960
    v_mfma_f32_16x16x32_bf16 v[84:87], a[12:15], a[132:135], v[84:87]
    v_mfma_f32_16x16x32_bf16 v[88:91], a[12:15], a[136:139], v[88:91]
    ds_read_b64_tr_b16 a[82:83], v11 offset:17472
    buffer_load_dwordx4 v7, s[32:35], s25 offen offset:1056 lds
    v_mfma_f32_16x16x32_bf16 v[92:95], a[12:15], a[140:143], v[92:95]
    ds_read_b64_tr_b16 a[84:85], v11 offset:16992
    v_mfma_f32_16x16x32_bf16 v[96:99], a[16:19], a[128:131], v[96:99]
    v_mfma_f32_16x16x32_bf16 v[100:103], a[16:19], a[132:135], v[100:103]
    ds_read_b64_tr_b16 a[86:87], v11 offset:17504
    v_mfma_f32_16x16x32_bf16 v[104:107], a[16:19], a[136:139], v[104:107]
    ds_read_b64_tr_b16 a[88:89], v11 offset:25408
    v_mfma_f32_16x16x32_bf16 v[108:111], a[16:19], a[140:143], v[108:111]
    v_mfma_f32_16x16x32_bf16 v[112:115], a[20:23], a[128:131], v[112:115]
    ds_read_b64_tr_b16 a[90:91], v11 offset:25920
    v_mfma_f32_16x16x32_bf16 v[116:119], a[20:23], a[132:135], v[116:119]
    ds_read_b64_tr_b16 a[92:93], v11 offset:25440
    buffer_load_dwordx4 a[180:183], v4, s[28:31], s23 offen offset:1024
    v_mfma_f32_16x16x32_bf16 v[120:123], a[20:23], a[136:139], v[120:123]
    v_mfma_f32_16x16x32_bf16 v[124:127], a[20:23], a[140:143], v[124:127]
    ds_read_b64_tr_b16 a[94:95], v11 offset:25952
    v_mfma_f32_16x16x32_bf16 v[128:131], a[24:27], a[128:131], v[128:131]
    v_mfma_f32_16x16x32_bf16 v[132:135], a[24:27], a[132:135], v[132:135]
    ds_read_b64_tr_b16 a[96:97], v11 offset:17024
    v_mfma_f32_16x16x32_bf16 v[136:139], a[24:27], a[136:139], v[136:139]
    ds_read_b64_tr_b16 a[98:99], v11 offset:17536
    v_mfma_f32_16x16x32_bf16 v[140:143], a[24:27], a[140:143], v[140:143]
    v_mfma_f32_16x16x32_bf16 v[144:147], a[28:31], a[128:131], v[144:147]
    ds_read_b64_tr_b16 a[100:101], v11 offset:17056
    buffer_load_dwordx4 v8, s[32:35], s25 offen offset:2112 lds
    v_mfma_f32_16x16x32_bf16 v[148:151], a[28:31], a[132:135], v[148:151]
    ds_read_b64_tr_b16 a[102:103], v11 offset:17568
    v_mfma_f32_16x16x32_bf16 v[152:155], a[28:31], a[136:139], v[152:155]
    v_mfma_f32_16x16x32_bf16 v[156:159], a[28:31], a[140:143], v[156:159]
    ds_read_b64_tr_b16 a[104:105], v11 offset:25472
    v_mfma_f32_16x16x32_bf16 v[160:163], a[32:35], a[128:131], v[160:163]
    ds_read_b64_tr_b16 a[106:107], v11 offset:25984
    v_mfma_f32_16x16x32_bf16 v[164:167], a[32:35], a[132:135], v[164:167]
    v_mfma_f32_16x16x32_bf16 v[168:171], a[32:35], a[136:139], v[168:171]
    ds_read_b64_tr_b16 a[108:109], v11 offset:25504
    v_mfma_f32_16x16x32_bf16 v[172:175], a[32:35], a[140:143], v[172:175]
    ds_read_b64_tr_b16 a[110:111], v11 offset:26016
    buffer_load_dwordx4 a[184:187], v5, s[28:31], s23 offen offset:0
    v_mfma_f32_16x16x32_bf16 v[176:179], a[36:39], a[128:131], v[176:179]
    v_mfma_f32_16x16x32_bf16 v[180:183], a[36:39], a[132:135], v[180:183]
    ds_read_b64_tr_b16 a[112:113], v13 offset:16896
    v_mfma_f32_16x16x32_bf16 v[184:187], a[36:39], a[136:139], v[184:187]
    v_mfma_f32_16x16x32_bf16 v[188:191], a[36:39], a[140:143], v[188:191]
    ds_read_b64_tr_b16 a[114:115], v13 offset:17408
    v_mfma_f32_16x16x32_bf16 v[192:195], a[40:43], a[128:131], v[192:195]
    ds_read_b64_tr_b16 a[116:117], v13 offset:16928
    v_mfma_f32_16x16x32_bf16 v[196:199], a[40:43], a[132:135], v[196:199]
    v_mfma_f32_16x16x32_bf16 v[200:203], a[40:43], a[136:139], v[200:203]
    ds_read_b64_tr_b16 a[118:119], v13 offset:17440
    buffer_load_dwordx4 v9, s[32:35], s25 offen offset:3168 lds
    s_add_u32 s25, s25, 229376
    v_mfma_f32_16x16x32_bf16 v[204:207], a[40:43], a[140:143], v[204:207]
    ds_read_b64_tr_b16 a[120:121], v13 offset:25344
    v_mfma_f32_16x16x32_bf16 v[208:211], a[44:47], a[128:131], v[208:211]
    v_mfma_f32_16x16x32_bf16 v[212:215], a[44:47], a[132:135], v[212:215]
    ds_read_b64_tr_b16 a[122:123], v13 offset:25856
    v_mfma_f32_16x16x32_bf16 v[216:219], a[44:47], a[136:139], v[216:219]
    ds_read_b64_tr_b16 a[124:125], v13 offset:25376
    v_mfma_f32_16x16x32_bf16 v[220:223], a[44:47], a[140:143], v[220:223]
    v_mfma_f32_16x16x32_bf16 v[224:227], a[48:51], a[128:131], v[224:227]
    ds_read_b64_tr_b16 a[126:127], v13 offset:25888
    v_mfma_f32_16x16x32_bf16 v[228:231], a[48:51], a[132:135], v[228:231]
    buffer_load_dwordx4 a[188:191], v5, s[28:31], s23 offen offset:1024
    s_add_u32 s23, s23, 0x20000
    v_mfma_f32_16x16x32_bf16 v[232:235], a[52:55], a[128:131], v[232:235]
    v_mfma_f32_16x16x32_bf16 v[236:239], a[52:55], a[132:135], v[236:239]
    v_mfma_f32_16x16x32_bf16 v[240:243], a[56:59], a[128:131], v[240:243]
    v_mfma_f32_16x16x32_bf16 v[244:247], a[56:59], a[132:135], v[244:247]
    v_mfma_f32_16x16x32_bf16 v[248:251], a[60:63], a[128:131], v[248:251]
    v_mfma_f32_16x16x32_bf16 v[252:255], a[60:63], a[132:135], v[252:255]
    s_waitcnt lgkmcnt(0)
    s_waitcnt vmcnt(17)
    s_barrier
    v_mfma_f32_16x16x32_bf16 v[32:35], a[64:67], a[144:147], v[32:35]
    ds_read_b64_tr_b16 a[0:1], v11 offset:33792
    v_mfma_f32_16x16x32_bf16 v[36:39], a[64:67], a[148:151], v[36:39]
    ds_read_b64_tr_b16 a[2:3], v11 offset:34304
    s_add_u32 m0, s22, 16896
    s_nop 0
    buffer_load_dwordx4 v6, s[32:35], s25 offen offset:0 lds
    v_mfma_f32_16x16x32_bf16 v[40:43], a[64:67], a[152:155], v[40:43]
    s_waitcnt vmcnt(17)
    v_mfma_f32_16x16x32_bf16 v[44:47], a[64:67], a[156:159], v[44:47]
    ds_read_b64_tr_b16 a[4:5], v11 offset:33824
    v_mfma_f32_16x16x32_bf16 v[48:51], a[68:71], a[144:147], v[48:51]
    ds_read_b64_tr_b16 a[6:7], v11 offset:34336
    v_mfma_f32_16x16x32_bf16 v[52:55], a[68:71], a[148:151], v[52:55]
    v_mfma_f32_16x16x32_bf16 v[56:59], a[68:71], a[152:155], v[56:59]
    ds_read_b64_tr_b16 a[8:9], v11 offset:42240
    v_mfma_f32_16x16x32_bf16 v[60:63], a[68:71], a[156:159], v[60:63]
    ds_read_b64_tr_b16 a[10:11], v11 offset:42752
    buffer_load_dwordx4 a[128:131], v4, s[28:31], s23 offen offset:0
    v_mfma_f32_16x16x32_bf16 v[64:67], a[72:75], a[144:147], v[64:67]
    v_mfma_f32_16x16x32_bf16 v[68:71], a[72:75], a[148:151], v[68:71]
    ds_read_b64_tr_b16 a[12:13], v11 offset:42272
    v_mfma_f32_16x16x32_bf16 v[72:75], a[72:75], a[152:155], v[72:75]
    ds_read_b64_tr_b16 a[14:15], v11 offset:42784
    v_mfma_f32_16x16x32_bf16 v[76:79], a[72:75], a[156:159], v[76:79]
    v_mfma_f32_16x16x32_bf16 v[80:83], a[76:79], a[144:147], v[80:83]
    ds_read_b64_tr_b16 a[16:17], v11 offset:33856
    v_mfma_f32_16x16x32_bf16 v[84:87], a[76:79], a[148:151], v[84:87]
    v_mfma_f32_16x16x32_bf16 v[88:91], a[76:79], a[152:155], v[88:91]
    ds_read_b64_tr_b16 a[18:19], v11 offset:34368
    buffer_load_dwordx4 v7, s[32:35], s25 offen offset:1056 lds
    v_mfma_f32_16x16x32_bf16 v[92:95], a[76:79], a[156:159], v[92:95]
    ds_read_b64_tr_b16 a[20:21], v11 offset:33888
    v_mfma_f32_16x16x32_bf16 v[96:99], a[80:83], a[144:147], v[96:99]
    v_mfma_f32_16x16x32_bf16 v[100:103], a[80:83], a[148:151], v[100:103]
    ds_read_b64_tr_b16 a[22:23], v11 offset:34400
    v_mfma_f32_16x16x32_bf16 v[104:107], a[80:83], a[152:155], v[104:107]
    ds_read_b64_tr_b16 a[24:25], v11 offset:42304
    v_mfma_f32_16x16x32_bf16 v[108:111], a[80:83], a[156:159], v[108:111]
    v_mfma_f32_16x16x32_bf16 v[112:115], a[84:87], a[144:147], v[112:115]
    ds_read_b64_tr_b16 a[26:27], v11 offset:42816
    v_mfma_f32_16x16x32_bf16 v[116:119], a[84:87], a[148:151], v[116:119]
    ds_read_b64_tr_b16 a[28:29], v11 offset:42336
    buffer_load_dwordx4 a[132:135], v4, s[28:31], s23 offen offset:1024
    v_mfma_f32_16x16x32_bf16 v[120:123], a[84:87], a[152:155], v[120:123]
    v_mfma_f32_16x16x32_bf16 v[124:127], a[84:87], a[156:159], v[124:127]
    ds_read_b64_tr_b16 a[30:31], v11 offset:42848
    v_mfma_f32_16x16x32_bf16 v[128:131], a[88:91], a[144:147], v[128:131]
    v_mfma_f32_16x16x32_bf16 v[132:135], a[88:91], a[148:151], v[132:135]
    ds_read_b64_tr_b16 a[32:33], v11 offset:33920
    v_mfma_f32_16x16x32_bf16 v[136:139], a[88:91], a[152:155], v[136:139]
    ds_read_b64_tr_b16 a[34:35], v11 offset:34432
    v_mfma_f32_16x16x32_bf16 v[140:143], a[88:91], a[156:159], v[140:143]
    v_mfma_f32_16x16x32_bf16 v[144:147], a[92:95], a[144:147], v[144:147]
    ds_read_b64_tr_b16 a[36:37], v11 offset:33952
    buffer_load_dwordx4 v8, s[32:35], s25 offen offset:2112 lds
    v_mfma_f32_16x16x32_bf16 v[148:151], a[92:95], a[148:151], v[148:151]
    ds_read_b64_tr_b16 a[38:39], v11 offset:34464
    v_mfma_f32_16x16x32_bf16 v[152:155], a[92:95], a[152:155], v[152:155]
    v_mfma_f32_16x16x32_bf16 v[156:159], a[92:95], a[156:159], v[156:159]
    ds_read_b64_tr_b16 a[40:41], v11 offset:42368
    v_mfma_f32_16x16x32_bf16 v[160:163], a[96:99], a[144:147], v[160:163]
    ds_read_b64_tr_b16 a[42:43], v11 offset:42880
    v_mfma_f32_16x16x32_bf16 v[164:167], a[96:99], a[148:151], v[164:167]
    v_mfma_f32_16x16x32_bf16 v[168:171], a[96:99], a[152:155], v[168:171]
    ds_read_b64_tr_b16 a[44:45], v11 offset:42400
    v_mfma_f32_16x16x32_bf16 v[172:175], a[96:99], a[156:159], v[172:175]
    ds_read_b64_tr_b16 a[46:47], v11 offset:42912
    buffer_load_dwordx4 a[136:139], v5, s[28:31], s23 offen offset:0
    v_mfma_f32_16x16x32_bf16 v[176:179], a[100:103], a[144:147], v[176:179]
    v_mfma_f32_16x16x32_bf16 v[180:183], a[100:103], a[148:151], v[180:183]
    ds_read_b64_tr_b16 a[48:49], v13 offset:33792
    v_mfma_f32_16x16x32_bf16 v[184:187], a[100:103], a[152:155], v[184:187]
    v_mfma_f32_16x16x32_bf16 v[188:191], a[100:103], a[156:159], v[188:191]
    ds_read_b64_tr_b16 a[50:51], v13 offset:34304
    v_mfma_f32_16x16x32_bf16 v[192:195], a[104:107], a[144:147], v[192:195]
    ds_read_b64_tr_b16 a[52:53], v13 offset:33824
    v_mfma_f32_16x16x32_bf16 v[196:199], a[104:107], a[148:151], v[196:199]
    v_mfma_f32_16x16x32_bf16 v[200:203], a[104:107], a[152:155], v[200:203]
    ds_read_b64_tr_b16 a[54:55], v13 offset:34336
    buffer_load_dwordx4 v9, s[32:35], s25 offen offset:3168 lds
    s_add_u32 s25, s25, 229376
    v_mfma_f32_16x16x32_bf16 v[204:207], a[104:107], a[156:159], v[204:207]
    ds_read_b64_tr_b16 a[56:57], v13 offset:42240
    v_mfma_f32_16x16x32_bf16 v[208:211], a[108:111], a[144:147], v[208:211]
    v_mfma_f32_16x16x32_bf16 v[212:215], a[108:111], a[148:151], v[212:215]
    ds_read_b64_tr_b16 a[58:59], v13 offset:42752
    v_mfma_f32_16x16x32_bf16 v[216:219], a[108:111], a[152:155], v[216:219]
    ds_read_b64_tr_b16 a[60:61], v13 offset:42272
    v_mfma_f32_16x16x32_bf16 v[220:223], a[108:111], a[156:159], v[220:223]
    v_mfma_f32_16x16x32_bf16 v[224:227], a[112:115], a[144:147], v[224:227]
    ds_read_b64_tr_b16 a[62:63], v13 offset:42784
    v_mfma_f32_16x16x32_bf16 v[228:231], a[112:115], a[148:151], v[228:231]
    buffer_load_dwordx4 a[140:143], v5, s[28:31], s23 offen offset:1024
    s_add_u32 s23, s23, 0x20000
    v_mfma_f32_16x16x32_bf16 v[232:235], a[116:119], a[144:147], v[232:235]
    v_mfma_f32_16x16x32_bf16 v[236:239], a[116:119], a[148:151], v[236:239]
    v_mfma_f32_16x16x32_bf16 v[240:243], a[120:123], a[144:147], v[240:243]
    v_mfma_f32_16x16x32_bf16 v[244:247], a[120:123], a[148:151], v[244:247]
    v_mfma_f32_16x16x32_bf16 v[248:251], a[124:127], a[144:147], v[248:251]
    v_mfma_f32_16x16x32_bf16 v[252:255], a[124:127], a[148:151], v[252:255]
    s_waitcnt lgkmcnt(0)
    s_waitcnt vmcnt(17)
    s_barrier
    v_mfma_f32_16x16x32_bf16 v[32:35], a[0:3], a[160:163], v[32:35]
    ds_read_b64_tr_b16 a[64:65], v11 offset:50688
    v_mfma_f32_16x16x32_bf16 v[36:39], a[0:3], a[164:167], v[36:39]
    ds_read_b64_tr_b16 a[66:67], v11 offset:51200
    s_add_u32 m0, s22, 33792
    s_nop 0
    buffer_load_dwordx4 v6, s[32:35], s25 offen offset:0 lds
    v_mfma_f32_16x16x32_bf16 v[40:43], a[0:3], a[168:171], v[40:43]
    s_waitcnt vmcnt(17)
    v_mfma_f32_16x16x32_bf16 v[44:47], a[0:3], a[172:175], v[44:47]
    ds_read_b64_tr_b16 a[68:69], v11 offset:50720
    v_mfma_f32_16x16x32_bf16 v[48:51], a[4:7], a[160:163], v[48:51]
    ds_read_b64_tr_b16 a[70:71], v11 offset:51232
    v_mfma_f32_16x16x32_bf16 v[52:55], a[4:7], a[164:167], v[52:55]
    v_mfma_f32_16x16x32_bf16 v[56:59], a[4:7], a[168:171], v[56:59]
    ds_read_b64_tr_b16 a[72:73], v11 offset:59136
    v_mfma_f32_16x16x32_bf16 v[60:63], a[4:7], a[172:175], v[60:63]
    ds_read_b64_tr_b16 a[74:75], v11 offset:59648
    buffer_load_dwordx4 a[144:147], v4, s[28:31], s23 offen offset:0
    v_mfma_f32_16x16x32_bf16 v[64:67], a[8:11], a[160:163], v[64:67]
    v_mfma_f32_16x16x32_bf16 v[68:71], a[8:11], a[164:167], v[68:71]
    ds_read_b64_tr_b16 a[76:77], v11 offset:59168
    v_mfma_f32_16x16x32_bf16 v[72:75], a[8:11], a[168:171], v[72:75]
    ds_read_b64_tr_b16 a[78:79], v11 offset:59680
    v_mfma_f32_16x16x32_bf16 v[76:79], a[8:11], a[172:175], v[76:79]
    v_mfma_f32_16x16x32_bf16 v[80:83], a[12:15], a[160:163], v[80:83]
    ds_read_b64_tr_b16 a[80:81], v11 offset:50752
    v_mfma_f32_16x16x32_bf16 v[84:87], a[12:15], a[164:167], v[84:87]
    v_mfma_f32_16x16x32_bf16 v[88:91], a[12:15], a[168:171], v[88:91]
    ds_read_b64_tr_b16 a[82:83], v11 offset:51264
    buffer_load_dwordx4 v7, s[32:35], s25 offen offset:1056 lds
    v_mfma_f32_16x16x32_bf16 v[92:95], a[12:15], a[172:175], v[92:95]
    ds_read_b64_tr_b16 a[84:85], v11 offset:50784
    v_mfma_f32_16x16x32_bf16 v[96:99], a[16:19], a[160:163], v[96:99]
    v_mfma_f32_16x16x32_bf16 v[100:103], a[16:19], a[164:167], v[100:103]
    ds_read_b64_tr_b16 a[86:87], v11 offset:51296
    v_mfma_f32_16x16x32_bf16 v[104:107], a[16:19], a[168:171], v[104:107]
    ds_read_b64_tr_b16 a[88:89], v11 offset:59200
    v_mfma_f32_16x16x32_bf16 v[108:111], a[16:19], a[172:175], v[108:111]
    v_mfma_f32_16x16x32_bf16 v[112:115], a[20:23], a[160:163], v[112:115]
    ds_read_b64_tr_b16 a[90:91], v11 offset:59712
    v_mfma_f32_16x16x32_bf16 v[116:119], a[20:23], a[164:167], v[116:119]
    ds_read_b64_tr_b16 a[92:93], v11 offset:59232
    buffer_load_dwordx4 a[148:151], v4, s[28:31], s23 offen offset:1024
    v_mfma_f32_16x16x32_bf16 v[120:123], a[20:23], a[168:171], v[120:123]
    v_mfma_f32_16x16x32_bf16 v[124:127], a[20:23], a[172:175], v[124:127]
    ds_read_b64_tr_b16 a[94:95], v11 offset:59744
    v_mfma_f32_16x16x32_bf16 v[128:131], a[24:27], a[160:163], v[128:131]
    v_mfma_f32_16x16x32_bf16 v[132:135], a[24:27], a[164:167], v[132:135]
    ds_read_b64_tr_b16 a[96:97], v11 offset:50816
    v_mfma_f32_16x16x32_bf16 v[136:139], a[24:27], a[168:171], v[136:139]
    ds_read_b64_tr_b16 a[98:99], v11 offset:51328
    v_mfma_f32_16x16x32_bf16 v[140:143], a[24:27], a[172:175], v[140:143]
    v_mfma_f32_16x16x32_bf16 v[144:147], a[28:31], a[160:163], v[144:147]
    ds_read_b64_tr_b16 a[100:101], v11 offset:50848
    buffer_load_dwordx4 v8, s[32:35], s25 offen offset:2112 lds
    v_mfma_f32_16x16x32_bf16 v[148:151], a[28:31], a[164:167], v[148:151]
    ds_read_b64_tr_b16 a[102:103], v11 offset:51360
    v_mfma_f32_16x16x32_bf16 v[152:155], a[28:31], a[168:171], v[152:155]
    v_mfma_f32_16x16x32_bf16 v[156:159], a[28:31], a[172:175], v[156:159]
    ds_read_b64_tr_b16 a[104:105], v11 offset:59264
    v_mfma_f32_16x16x32_bf16 v[160:163], a[32:35], a[160:163], v[160:163]
    ds_read_b64_tr_b16 a[106:107], v11 offset:59776
    v_mfma_f32_16x16x32_bf16 v[164:167], a[32:35], a[164:167], v[164:167]
    v_mfma_f32_16x16x32_bf16 v[168:171], a[32:35], a[168:171], v[168:171]
    ds_read_b64_tr_b16 a[108:109], v11 offset:59296
    v_mfma_f32_16x16x32_bf16 v[172:175], a[32:35], a[172:175], v[172:175]
    ds_read_b64_tr_b16 a[110:111], v11 offset:59808
    buffer_load_dwordx4 a[152:155], v5, s[28:31], s23 offen offset:0
    v_mfma_f32_16x16x32_bf16 v[176:179], a[36:39], a[160:163], v[176:179]
    v_mfma_f32_16x16x32_bf16 v[180:183], a[36:39], a[164:167], v[180:183]
    ds_read_b64_tr_b16 a[112:113], v13 offset:50688
    v_mfma_f32_16x16x32_bf16 v[184:187], a[36:39], a[168:171], v[184:187]
    v_mfma_f32_16x16x32_bf16 v[188:191], a[36:39], a[172:175], v[188:191]
    ds_read_b64_tr_b16 a[114:115], v13 offset:51200
    v_mfma_f32_16x16x32_bf16 v[192:195], a[40:43], a[160:163], v[192:195]
    ds_read_b64_tr_b16 a[116:117], v13 offset:50720
    v_mfma_f32_16x16x32_bf16 v[196:199], a[40:43], a[164:167], v[196:199]
    v_mfma_f32_16x16x32_bf16 v[200:203], a[40:43], a[168:171], v[200:203]
    ds_read_b64_tr_b16 a[118:119], v13 offset:51232
    buffer_load_dwordx4 v9, s[32:35], s25 offen offset:3168 lds
    s_add_u32 s25, s25, 229376
    v_mfma_f32_16x16x32_bf16 v[204:207], a[40:43], a[172:175], v[204:207]
    ds_read_b64_tr_b16 a[120:121], v13 offset:59136
    v_mfma_f32_16x16x32_bf16 v[208:211], a[44:47], a[160:163], v[208:211]
    v_mfma_f32_16x16x32_bf16 v[212:215], a[44:47], a[164:167], v[212:215]
    ds_read_b64_tr_b16 a[122:123], v13 offset:59648
    v_mfma_f32_16x16x32_bf16 v[216:219], a[44:47], a[168:171], v[216:219]
    ds_read_b64_tr_b16 a[124:125], v13 offset:59168
    v_mfma_f32_16x16x32_bf16 v[220:223], a[44:47], a[172:175], v[220:223]
    v_mfma_f32_16x16x32_bf16 v[224:227], a[48:51], a[160:163], v[224:227]
    ds_read_b64_tr_b16 a[126:127], v13 offset:59680
    v_mfma_f32_16x16x32_bf16 v[228:231], a[48:51], a[164:167], v[228:231]
    buffer_load_dwordx4 a[156:159], v5, s[28:31], s23 offen offset:1024
    s_add_u32 s23, s23, 0x20000
    v_mfma_f32_16x16x32_bf16 v[232:235], a[52:55], a[160:163], v[232:235]
    v_mfma_f32_16x16x32_bf16 v[236:239], a[52:55], a[164:167], v[236:239]
    v_mfma_f32_16x16x32_bf16 v[240:243], a[56:59], a[160:163], v[240:243]
    v_mfma_f32_16x16x32_bf16 v[244:247], a[56:59], a[164:167], v[244:247]
    v_mfma_f32_16x16x32_bf16 v[248:251], a[60:63], a[160:163], v[248:251]
    v_mfma_f32_16x16x32_bf16 v[252:255], a[60:63], a[164:167], v[252:255]
    s_waitcnt lgkmcnt(0)
    s_waitcnt vmcnt(17)
    s_barrier
    v_mfma_f32_16x16x32_bf16 v[32:35], a[64:67], a[176:179], v[32:35]
    ds_read_b64_tr_b16 a[0:1], v10 offset:0
    v_mfma_f32_16x16x32_bf16 v[36:39], a[64:67], a[180:183], v[36:39]
    ds_read_b64_tr_b16 a[2:3], v10 offset:512
    s_add_u32 m0, s22, 50688
    s_nop 0
    buffer_load_dwordx4 v6, s[32:35], s25 offen offset:0 lds
    v_mfma_f32_16x16x32_bf16 v[40:43], a[64:67], a[184:187], v[40:43]
    s_waitcnt vmcnt(17)
    v_mfma_f32_16x16x32_bf16 v[44:47], a[64:67], a[188:191], v[44:47]
    ds_read_b64_tr_b16 a[4:5], v10 offset:32
    v_mfma_f32_16x16x32_bf16 v[48:51], a[68:71], a[176:179], v[48:51]
    ds_read_b64_tr_b16 a[6:7], v10 offset:544
    v_mfma_f32_16x16x32_bf16 v[52:55], a[68:71], a[180:183], v[52:55]
    v_mfma_f32_16x16x32_bf16 v[56:59], a[68:71], a[184:187], v[56:59]
    ds_read_b64_tr_b16 a[8:9], v10 offset:8448
    v_mfma_f32_16x16x32_bf16 v[60:63], a[68:71], a[188:191], v[60:63]
    ds_read_b64_tr_b16 a[10:11], v10 offset:8960
    buffer_load_dwordx4 a[160:163], v4, s[28:31], s23 offen offset:0
    v_mfma_f32_16x16x32_bf16 v[64:67], a[72:75], a[176:179], v[64:67]
    v_mfma_f32_16x16x32_bf16 v[68:71], a[72:75], a[180:183], v[68:71]
    ds_read_b64_tr_b16 a[12:13], v10 offset:8480
    v_mfma_f32_16x16x32_bf16 v[72:75], a[72:75], a[184:187], v[72:75]
    ds_read_b64_tr_b16 a[14:15], v10 offset:8992
    v_mfma_f32_16x16x32_bf16 v[76:79], a[72:75], a[188:191], v[76:79]
    v_mfma_f32_16x16x32_bf16 v[80:83], a[76:79], a[176:179], v[80:83]
    ds_read_b64_tr_b16 a[16:17], v10 offset:64
    v_mfma_f32_16x16x32_bf16 v[84:87], a[76:79], a[180:183], v[84:87]
    v_mfma_f32_16x16x32_bf16 v[88:91], a[76:79], a[184:187], v[88:91]
    ds_read_b64_tr_b16 a[18:19], v10 offset:576
    buffer_load_dwordx4 v7, s[32:35], s25 offen offset:1056 lds
    v_mfma_f32_16x16x32_bf16 v[92:95], a[76:79], a[188:191], v[92:95]
    ds_read_b64_tr_b16 a[20:21], v10 offset:96
    v_mfma_f32_16x16x32_bf16 v[96:99], a[80:83], a[176:179], v[96:99]
    v_mfma_f32_16x16x32_bf16 v[100:103], a[80:83], a[180:183], v[100:103]
    ds_read_b64_tr_b16 a[22:23], v10 offset:608
    v_mfma_f32_16x16x32_bf16 v[104:107], a[80:83], a[184:187], v[104:107]
    ds_read_b64_tr_b16 a[24:25], v10 offset:8512
    v_mfma_f32_16x16x32_bf16 v[108:111], a[80:83], a[188:191], v[108:111]
    v_mfma_f32_16x16x32_bf16 v[112:115], a[84:87], a[176:179], v[112:115]
    ds_read_b64_tr_b16 a[26:27], v10 offset:9024
    v_mfma_f32_16x16x32_bf16 v[116:119], a[84:87], a[180:183], v[116:119]
    ds_read_b64_tr_b16 a[28:29], v10 offset:8544
    buffer_load_dwordx4 a[164:167], v4, s[28:31], s23 offen offset:1024
    v_mfma_f32_16x16x32_bf16 v[120:123], a[84:87], a[184:187], v[120:123]
    v_mfma_f32_16x16x32_bf16 v[124:127], a[84:87], a[188:191], v[124:127]
    ds_read_b64_tr_b16 a[30:31], v10 offset:9056
    v_mfma_f32_16x16x32_bf16 v[128:131], a[88:91], a[176:179], v[128:131]
    v_mfma_f32_16x16x32_bf16 v[132:135], a[88:91], a[180:183], v[132:135]
    ds_read_b64_tr_b16 a[32:33], v10 offset:128
    v_mfma_f32_16x16x32_bf16 v[136:139], a[88:91], a[184:187], v[136:139]
    ds_read_b64_tr_b16 a[34:35], v10 offset:640
    v_mfma_f32_16x16x32_bf16 v[140:143], a[88:91], a[188:191], v[140:143]
    v_mfma_f32_16x16x32_bf16 v[144:147], a[92:95], a[176:179], v[144:147]
    ds_read_b64_tr_b16 a[36:37], v10 offset:160
    buffer_load_dwordx4 v8, s[32:35], s25 offen offset:2112 lds
    v_mfma_f32_16x16x32_bf16 v[148:151], a[92:95], a[180:183], v[148:151]
    ds_read_b64_tr_b16 a[38:39], v10 offset:672
    v_mfma_f32_16x16x32_bf16 v[152:155], a[92:95], a[184:187], v[152:155]
    v_mfma_f32_16x16x32_bf16 v[156:159], a[92:95], a[188:191], v[156:159]
    ds_read_b64_tr_b16 a[40:41], v10 offset:8576
    v_mfma_f32_16x16x32_bf16 v[160:163], a[96:99], a[176:179], v[160:163]
    ds_read_b64_tr_b16 a[42:43], v10 offset:9088
    v_mfma_f32_16x16x32_bf16 v[164:167], a[96:99], a[180:183], v[164:167]
    v_mfma_f32_16x16x32_bf16 v[168:171], a[96:99], a[184:187], v[168:171]
    ds_read_b64_tr_b16 a[44:45], v10 offset:8608
    v_mfma_f32_16x16x32_bf16 v[172:175], a[96:99], a[188:191], v[172:175]
    ds_read_b64_tr_b16 a[46:47], v10 offset:9120
    buffer_load_dwordx4 a[168:171], v5, s[28:31], s23 offen offset:0
    v_mfma_f32_16x16x32_bf16 v[176:179], a[100:103], a[176:179], v[176:179]
    v_mfma_f32_16x16x32_bf16 v[180:183], a[100:103], a[180:183], v[180:183]
    ds_read_b64_tr_b16 a[48:49], v12 offset:0
    v_mfma_f32_16x16x32_bf16 v[184:187], a[100:103], a[184:187], v[184:187]
    v_mfma_f32_16x16x32_bf16 v[188:191], a[100:103], a[188:191], v[188:191]
    ds_read_b64_tr_b16 a[50:51], v12 offset:512
    v_mfma_f32_16x16x32_bf16 v[192:195], a[104:107], a[176:179], v[192:195]
    ds_read_b64_tr_b16 a[52:53], v12 offset:32
    v_mfma_f32_16x16x32_bf16 v[196:199], a[104:107], a[180:183], v[196:199]
    v_mfma_f32_16x16x32_bf16 v[200:203], a[104:107], a[184:187], v[200:203]
    ds_read_b64_tr_b16 a[54:55], v12 offset:544
    buffer_load_dwordx4 v9, s[32:35], s25 offen offset:3168 lds
    s_add_u32 s25, s25, 229376
    v_mfma_f32_16x16x32_bf16 v[204:207], a[104:107], a[188:191], v[204:207]
    ds_read_b64_tr_b16 a[56:57], v12 offset:8448
    v_mfma_f32_16x16x32_bf16 v[208:211], a[108:111], a[176:179], v[208:211]
    v_mfma_f32_16x16x32_bf16 v[212:215], a[108:111], a[180:183], v[212:215]
    ds_read_b64_tr_b16 a[58:59], v12 offset:8960
    v_mfma_f32_16x16x32_bf16 v[216:219], a[108:111], a[184:187], v[216:219]
    ds_read_b64_tr_b16 a[60:61], v12 offset:8480
    v_mfma_f32_16x16x32_bf16 v[220:223], a[108:111], a[188:191], v[220:223]
    v_mfma_f32_16x16x32_bf16 v[224:227], a[112:115], a[176:179], v[224:227]
    ds_read_b64_tr_b16 a[62:63], v12 offset:8992
    v_mfma_f32_16x16x32_bf16 v[228:231], a[112:115], a[180:183], v[228:231]
    buffer_load_dwordx4 a[172:175], v5, s[28:31], s23 offen offset:1024
    s_add_u32 s23, s23, 0x20000
    v_mfma_f32_16x16x32_bf16 v[232:235], a[116:119], a[176:179], v[232:235]
    v_mfma_f32_16x16x32_bf16 v[236:239], a[116:119], a[180:183], v[236:239]
    v_mfma_f32_16x16x32_bf16 v[240:243], a[120:123], a[176:179], v[240:243]
    v_mfma_f32_16x16x32_bf16 v[244:247], a[120:123], a[180:183], v[244:247]
    v_mfma_f32_16x16x32_bf16 v[248:251], a[124:127], a[176:179], v[248:251]
    v_mfma_f32_16x16x32_bf16 v[252:255], a[124:127], a[180:183], v[252:255]
    s_sub_u32 s48, s48, 1
    s_cmp_lg_u32 s48, 0
    s_cbranch_scc1 gu1_kernel_loop
    s_waitcnt lgkmcnt(0)
    s_waitcnt vmcnt(17)
    s_barrier
    v_mfma_f32_16x16x32_bf16 v[32:35], a[0:3], a[128:131], v[32:35]
    ds_read_b64_tr_b16 a[64:65], v10 offset:16896
    v_mfma_f32_16x16x32_bf16 v[36:39], a[0:3], a[132:135], v[36:39]
    ds_read_b64_tr_b16 a[66:67], v10 offset:17408
    s_add_u32 m0, s22, 67584
    s_nop 0
    buffer_load_dwordx4 v6, s[32:35], s25 offen offset:0 lds
    v_mfma_f32_16x16x32_bf16 v[40:43], a[0:3], a[136:139], v[40:43]
    s_waitcnt vmcnt(17)
    v_mfma_f32_16x16x32_bf16 v[44:47], a[0:3], a[140:143], v[44:47]
    ds_read_b64_tr_b16 a[68:69], v10 offset:16928
    v_mfma_f32_16x16x32_bf16 v[48:51], a[4:7], a[128:131], v[48:51]
    ds_read_b64_tr_b16 a[70:71], v10 offset:17440
    v_mfma_f32_16x16x32_bf16 v[52:55], a[4:7], a[132:135], v[52:55]
    v_mfma_f32_16x16x32_bf16 v[56:59], a[4:7], a[136:139], v[56:59]
    ds_read_b64_tr_b16 a[72:73], v10 offset:25344
    v_mfma_f32_16x16x32_bf16 v[60:63], a[4:7], a[140:143], v[60:63]
    ds_read_b64_tr_b16 a[74:75], v10 offset:25856
    buffer_load_dwordx4 a[176:179], v4, s[28:31], s23 offen offset:0
    v_mfma_f32_16x16x32_bf16 v[64:67], a[8:11], a[128:131], v[64:67]
    v_mfma_f32_16x16x32_bf16 v[68:71], a[8:11], a[132:135], v[68:71]
    ds_read_b64_tr_b16 a[76:77], v10 offset:25376
    v_mfma_f32_16x16x32_bf16 v[72:75], a[8:11], a[136:139], v[72:75]
    ds_read_b64_tr_b16 a[78:79], v10 offset:25888
    v_mfma_f32_16x16x32_bf16 v[76:79], a[8:11], a[140:143], v[76:79]
    v_mfma_f32_16x16x32_bf16 v[80:83], a[12:15], a[128:131], v[80:83]
    ds_read_b64_tr_b16 a[80:81], v10 offset:16960
    v_mfma_f32_16x16x32_bf16 v[84:87], a[12:15], a[132:135], v[84:87]
    v_mfma_f32_16x16x32_bf16 v[88:91], a[12:15], a[136:139], v[88:91]
    ds_read_b64_tr_b16 a[82:83], v10 offset:17472
    buffer_load_dwordx4 v7, s[32:35], s25 offen offset:1056 lds
    v_mfma_f32_16x16x32_bf16 v[92:95], a[12:15], a[140:143], v[92:95]
    ds_read_b64_tr_b16 a[84:85], v10 offset:16992
    v_mfma_f32_16x16x32_bf16 v[96:99], a[16:19], a[128:131], v[96:99]
    v_mfma_f32_16x16x32_bf16 v[100:103], a[16:19], a[132:135], v[100:103]
    ds_read_b64_tr_b16 a[86:87], v10 offset:17504
    v_mfma_f32_16x16x32_bf16 v[104:107], a[16:19], a[136:139], v[104:107]
    ds_read_b64_tr_b16 a[88:89], v10 offset:25408
    v_mfma_f32_16x16x32_bf16 v[108:111], a[16:19], a[140:143], v[108:111]
    v_mfma_f32_16x16x32_bf16 v[112:115], a[20:23], a[128:131], v[112:115]
    ds_read_b64_tr_b16 a[90:91], v10 offset:25920
    v_mfma_f32_16x16x32_bf16 v[116:119], a[20:23], a[132:135], v[116:119]
    ds_read_b64_tr_b16 a[92:93], v10 offset:25440
    buffer_load_dwordx4 a[180:183], v4, s[28:31], s23 offen offset:1024
    v_mfma_f32_16x16x32_bf16 v[120:123], a[20:23], a[136:139], v[120:123]
    v_mfma_f32_16x16x32_bf16 v[124:127], a[20:23], a[140:143], v[124:127]
    ds_read_b64_tr_b16 a[94:95], v10 offset:25952
    v_mfma_f32_16x16x32_bf16 v[128:131], a[24:27], a[128:131], v[128:131]
    v_mfma_f32_16x16x32_bf16 v[132:135], a[24:27], a[132:135], v[132:135]
    ds_read_b64_tr_b16 a[96:97], v10 offset:17024
    v_mfma_f32_16x16x32_bf16 v[136:139], a[24:27], a[136:139], v[136:139]
    ds_read_b64_tr_b16 a[98:99], v10 offset:17536
    v_mfma_f32_16x16x32_bf16 v[140:143], a[24:27], a[140:143], v[140:143]
    v_mfma_f32_16x16x32_bf16 v[144:147], a[28:31], a[128:131], v[144:147]
    ds_read_b64_tr_b16 a[100:101], v10 offset:17056
    buffer_load_dwordx4 v8, s[32:35], s25 offen offset:2112 lds
    v_mfma_f32_16x16x32_bf16 v[148:151], a[28:31], a[132:135], v[148:151]
    ds_read_b64_tr_b16 a[102:103], v10 offset:17568
    v_mfma_f32_16x16x32_bf16 v[152:155], a[28:31], a[136:139], v[152:155]
    v_mfma_f32_16x16x32_bf16 v[156:159], a[28:31], a[140:143], v[156:159]
    ds_read_b64_tr_b16 a[104:105], v10 offset:25472
    v_mfma_f32_16x16x32_bf16 v[160:163], a[32:35], a[128:131], v[160:163]
    ds_read_b64_tr_b16 a[106:107], v10 offset:25984
    v_mfma_f32_16x16x32_bf16 v[164:167], a[32:35], a[132:135], v[164:167]
    v_mfma_f32_16x16x32_bf16 v[168:171], a[32:35], a[136:139], v[168:171]
    ds_read_b64_tr_b16 a[108:109], v10 offset:25504
    v_mfma_f32_16x16x32_bf16 v[172:175], a[32:35], a[140:143], v[172:175]
    ds_read_b64_tr_b16 a[110:111], v10 offset:26016
    buffer_load_dwordx4 a[184:187], v5, s[28:31], s23 offen offset:0
    v_mfma_f32_16x16x32_bf16 v[176:179], a[36:39], a[128:131], v[176:179]
    v_mfma_f32_16x16x32_bf16 v[180:183], a[36:39], a[132:135], v[180:183]
    ds_read_b64_tr_b16 a[112:113], v12 offset:16896
    v_mfma_f32_16x16x32_bf16 v[184:187], a[36:39], a[136:139], v[184:187]
    v_mfma_f32_16x16x32_bf16 v[188:191], a[36:39], a[140:143], v[188:191]
    ds_read_b64_tr_b16 a[114:115], v12 offset:17408
    v_mfma_f32_16x16x32_bf16 v[192:195], a[40:43], a[128:131], v[192:195]
    ds_read_b64_tr_b16 a[116:117], v12 offset:16928
    v_mfma_f32_16x16x32_bf16 v[196:199], a[40:43], a[132:135], v[196:199]
    v_mfma_f32_16x16x32_bf16 v[200:203], a[40:43], a[136:139], v[200:203]
    ds_read_b64_tr_b16 a[118:119], v12 offset:17440
    buffer_load_dwordx4 v9, s[32:35], s25 offen offset:3168 lds
    s_add_u32 s25, s25, 229376
    v_mfma_f32_16x16x32_bf16 v[204:207], a[40:43], a[140:143], v[204:207]
    ds_read_b64_tr_b16 a[120:121], v12 offset:25344
    v_mfma_f32_16x16x32_bf16 v[208:211], a[44:47], a[128:131], v[208:211]
    v_mfma_f32_16x16x32_bf16 v[212:215], a[44:47], a[132:135], v[212:215]
    ds_read_b64_tr_b16 a[122:123], v12 offset:25856
    v_mfma_f32_16x16x32_bf16 v[216:219], a[44:47], a[136:139], v[216:219]
    ds_read_b64_tr_b16 a[124:125], v12 offset:25376
    v_mfma_f32_16x16x32_bf16 v[220:223], a[44:47], a[140:143], v[220:223]
    v_mfma_f32_16x16x32_bf16 v[224:227], a[48:51], a[128:131], v[224:227]
    ds_read_b64_tr_b16 a[126:127], v12 offset:25888
    v_mfma_f32_16x16x32_bf16 v[228:231], a[48:51], a[132:135], v[228:231]
    buffer_load_dwordx4 a[188:191], v5, s[28:31], s23 offen offset:1024
    s_add_u32 s23, s23, 0x20000
    v_mfma_f32_16x16x32_bf16 v[232:235], a[52:55], a[128:131], v[232:235]
    v_mfma_f32_16x16x32_bf16 v[236:239], a[52:55], a[132:135], v[236:239]
    v_mfma_f32_16x16x32_bf16 v[240:243], a[56:59], a[128:131], v[240:243]
    v_mfma_f32_16x16x32_bf16 v[244:247], a[56:59], a[132:135], v[244:247]
    v_mfma_f32_16x16x32_bf16 v[248:251], a[60:63], a[128:131], v[248:251]
    v_mfma_f32_16x16x32_bf16 v[252:255], a[60:63], a[132:135], v[252:255]
    s_waitcnt lgkmcnt(0)
    s_waitcnt vmcnt(17)
    s_barrier
    v_mfma_f32_16x16x32_bf16 v[32:35], a[64:67], a[144:147], v[32:35]
    ds_read_b64_tr_b16 a[0:1], v10 offset:33792
    v_mfma_f32_16x16x32_bf16 v[36:39], a[64:67], a[148:151], v[36:39]
    ds_read_b64_tr_b16 a[2:3], v10 offset:34304
    s_add_u32 m0, s22, 84480
    s_nop 0
    buffer_load_dwordx4 v6, s[32:35], s25 offen offset:0 lds
    v_mfma_f32_16x16x32_bf16 v[40:43], a[64:67], a[152:155], v[40:43]
    s_waitcnt vmcnt(17)
    v_mfma_f32_16x16x32_bf16 v[44:47], a[64:67], a[156:159], v[44:47]
    ds_read_b64_tr_b16 a[4:5], v10 offset:33824
    v_mfma_f32_16x16x32_bf16 v[48:51], a[68:71], a[144:147], v[48:51]
    ds_read_b64_tr_b16 a[6:7], v10 offset:34336
    v_mfma_f32_16x16x32_bf16 v[52:55], a[68:71], a[148:151], v[52:55]
    v_mfma_f32_16x16x32_bf16 v[56:59], a[68:71], a[152:155], v[56:59]
    ds_read_b64_tr_b16 a[8:9], v10 offset:42240
    v_mfma_f32_16x16x32_bf16 v[60:63], a[68:71], a[156:159], v[60:63]
    ds_read_b64_tr_b16 a[10:11], v10 offset:42752
    buffer_load_dwordx4 a[128:131], v4, s[28:31], s23 offen offset:0
    v_mfma_f32_16x16x32_bf16 v[64:67], a[72:75], a[144:147], v[64:67]
    v_mfma_f32_16x16x32_bf16 v[68:71], a[72:75], a[148:151], v[68:71]
    ds_read_b64_tr_b16 a[12:13], v10 offset:42272
    v_mfma_f32_16x16x32_bf16 v[72:75], a[72:75], a[152:155], v[72:75]
    ds_read_b64_tr_b16 a[14:15], v10 offset:42784
    v_mfma_f32_16x16x32_bf16 v[76:79], a[72:75], a[156:159], v[76:79]
    v_mfma_f32_16x16x32_bf16 v[80:83], a[76:79], a[144:147], v[80:83]
    ds_read_b64_tr_b16 a[16:17], v10 offset:33856
    v_mfma_f32_16x16x32_bf16 v[84:87], a[76:79], a[148:151], v[84:87]
    v_mfma_f32_16x16x32_bf16 v[88:91], a[76:79], a[152:155], v[88:91]
    ds_read_b64_tr_b16 a[18:19], v10 offset:34368
    buffer_load_dwordx4 v7, s[32:35], s25 offen offset:1056 lds
    v_mfma_f32_16x16x32_bf16 v[92:95], a[76:79], a[156:159], v[92:95]
    ds_read_b64_tr_b16 a[20:21], v10 offset:33888
    v_mfma_f32_16x16x32_bf16 v[96:99], a[80:83], a[144:147], v[96:99]
    v_mfma_f32_16x16x32_bf16 v[100:103], a[80:83], a[148:151], v[100:103]
    ds_read_b64_tr_b16 a[22:23], v10 offset:34400
    v_mfma_f32_16x16x32_bf16 v[104:107], a[80:83], a[152:155], v[104:107]
    ds_read_b64_tr_b16 a[24:25], v10 offset:42304
    v_mfma_f32_16x16x32_bf16 v[108:111], a[80:83], a[156:159], v[108:111]
    v_mfma_f32_16x16x32_bf16 v[112:115], a[84:87], a[144:147], v[112:115]
    ds_read_b64_tr_b16 a[26:27], v10 offset:42816
    v_mfma_f32_16x16x32_bf16 v[116:119], a[84:87], a[148:151], v[116:119]
    ds_read_b64_tr_b16 a[28:29], v10 offset:42336
    buffer_load_dwordx4 a[132:135], v4, s[28:31], s23 offen offset:1024
    v_mfma_f32_16x16x32_bf16 v[120:123], a[84:87], a[152:155], v[120:123]
    v_mfma_f32_16x16x32_bf16 v[124:127], a[84:87], a[156:159], v[124:127]
    ds_read_b64_tr_b16 a[30:31], v10 offset:42848
    v_mfma_f32_16x16x32_bf16 v[128:131], a[88:91], a[144:147], v[128:131]
    v_mfma_f32_16x16x32_bf16 v[132:135], a[88:91], a[148:151], v[132:135]
    ds_read_b64_tr_b16 a[32:33], v10 offset:33920
    v_mfma_f32_16x16x32_bf16 v[136:139], a[88:91], a[152:155], v[136:139]
    ds_read_b64_tr_b16 a[34:35], v10 offset:34432
    v_mfma_f32_16x16x32_bf16 v[140:143], a[88:91], a[156:159], v[140:143]
    v_mfma_f32_16x16x32_bf16 v[144:147], a[92:95], a[144:147], v[144:147]
    ds_read_b64_tr_b16 a[36:37], v10 offset:33952
    buffer_load_dwordx4 v8, s[32:35], s25 offen offset:2112 lds
    v_mfma_f32_16x16x32_bf16 v[148:151], a[92:95], a[148:151], v[148:151]
    ds_read_b64_tr_b16 a[38:39], v10 offset:34464
    v_mfma_f32_16x16x32_bf16 v[152:155], a[92:95], a[152:155], v[152:155]
    v_mfma_f32_16x16x32_bf16 v[156:159], a[92:95], a[156:159], v[156:159]
    ds_read_b64_tr_b16 a[40:41], v10 offset:42368
    v_mfma_f32_16x16x32_bf16 v[160:163], a[96:99], a[144:147], v[160:163]
    ds_read_b64_tr_b16 a[42:43], v10 offset:42880
    v_mfma_f32_16x16x32_bf16 v[164:167], a[96:99], a[148:151], v[164:167]
    v_mfma_f32_16x16x32_bf16 v[168:171], a[96:99], a[152:155], v[168:171]
    ds_read_b64_tr_b16 a[44:45], v10 offset:42400
    v_mfma_f32_16x16x32_bf16 v[172:175], a[96:99], a[156:159], v[172:175]
    ds_read_b64_tr_b16 a[46:47], v10 offset:42912
    buffer_load_dwordx4 a[136:139], v5, s[28:31], s23 offen offset:0
    v_mfma_f32_16x16x32_bf16 v[176:179], a[100:103], a[144:147], v[176:179]
    v_mfma_f32_16x16x32_bf16 v[180:183], a[100:103], a[148:151], v[180:183]
    ds_read_b64_tr_b16 a[48:49], v12 offset:33792
    v_mfma_f32_16x16x32_bf16 v[184:187], a[100:103], a[152:155], v[184:187]
    v_mfma_f32_16x16x32_bf16 v[188:191], a[100:103], a[156:159], v[188:191]
    ds_read_b64_tr_b16 a[50:51], v12 offset:34304
    v_mfma_f32_16x16x32_bf16 v[192:195], a[104:107], a[144:147], v[192:195]
    ds_read_b64_tr_b16 a[52:53], v12 offset:33824
    v_mfma_f32_16x16x32_bf16 v[196:199], a[104:107], a[148:151], v[196:199]
    v_mfma_f32_16x16x32_bf16 v[200:203], a[104:107], a[152:155], v[200:203]
    ds_read_b64_tr_b16 a[54:55], v12 offset:34336
    buffer_load_dwordx4 v9, s[32:35], s25 offen offset:3168 lds
    s_add_u32 s25, s25, 229376
    v_mfma_f32_16x16x32_bf16 v[204:207], a[104:107], a[156:159], v[204:207]
    ds_read_b64_tr_b16 a[56:57], v12 offset:42240
    v_mfma_f32_16x16x32_bf16 v[208:211], a[108:111], a[144:147], v[208:211]
    v_mfma_f32_16x16x32_bf16 v[212:215], a[108:111], a[148:151], v[212:215]
    ds_read_b64_tr_b16 a[58:59], v12 offset:42752
    v_mfma_f32_16x16x32_bf16 v[216:219], a[108:111], a[152:155], v[216:219]
    ds_read_b64_tr_b16 a[60:61], v12 offset:42272
    v_mfma_f32_16x16x32_bf16 v[220:223], a[108:111], a[156:159], v[220:223]
    v_mfma_f32_16x16x32_bf16 v[224:227], a[112:115], a[144:147], v[224:227]
    ds_read_b64_tr_b16 a[62:63], v12 offset:42784
    v_mfma_f32_16x16x32_bf16 v[228:231], a[112:115], a[148:151], v[228:231]
    buffer_load_dwordx4 a[140:143], v5, s[28:31], s23 offen offset:1024
    s_add_u32 s23, s23, 0x20000
    v_mfma_f32_16x16x32_bf16 v[232:235], a[116:119], a[144:147], v[232:235]
    v_mfma_f32_16x16x32_bf16 v[236:239], a[116:119], a[148:151], v[236:239]
    v_mfma_f32_16x16x32_bf16 v[240:243], a[120:123], a[144:147], v[240:243]
    v_mfma_f32_16x16x32_bf16 v[244:247], a[120:123], a[148:151], v[244:247]
    v_mfma_f32_16x16x32_bf16 v[248:251], a[124:127], a[144:147], v[248:251]
    v_mfma_f32_16x16x32_bf16 v[252:255], a[124:127], a[148:151], v[252:255]
    s_waitcnt lgkmcnt(0)
    s_waitcnt vmcnt(17)
    s_barrier
    v_mfma_f32_16x16x32_bf16 v[32:35], a[0:3], a[160:163], v[32:35]
    ds_read_b64_tr_b16 a[64:65], v10 offset:50688
    v_mfma_f32_16x16x32_bf16 v[36:39], a[0:3], a[164:167], v[36:39]
    ds_read_b64_tr_b16 a[66:67], v10 offset:51200
    s_add_u32 m0, s22, 101376
    s_nop 0
    buffer_load_dwordx4 v6, s[32:35], s25 offen offset:0 lds
    v_mfma_f32_16x16x32_bf16 v[40:43], a[0:3], a[168:171], v[40:43]
    s_waitcnt vmcnt(17)
    v_mfma_f32_16x16x32_bf16 v[44:47], a[0:3], a[172:175], v[44:47]
    ds_read_b64_tr_b16 a[68:69], v10 offset:50720
    v_mfma_f32_16x16x32_bf16 v[48:51], a[4:7], a[160:163], v[48:51]
    ds_read_b64_tr_b16 a[70:71], v10 offset:51232
    v_mfma_f32_16x16x32_bf16 v[52:55], a[4:7], a[164:167], v[52:55]
    v_mfma_f32_16x16x32_bf16 v[56:59], a[4:7], a[168:171], v[56:59]
    ds_read_b64_tr_b16 a[72:73], v10 offset:59136
    v_mfma_f32_16x16x32_bf16 v[60:63], a[4:7], a[172:175], v[60:63]
    ds_read_b64_tr_b16 a[74:75], v10 offset:59648
    buffer_load_dwordx4 a[144:147], v4, s[28:31], s23 offen offset:0
    v_mfma_f32_16x16x32_bf16 v[64:67], a[8:11], a[160:163], v[64:67]
    v_mfma_f32_16x16x32_bf16 v[68:71], a[8:11], a[164:167], v[68:71]
    ds_read_b64_tr_b16 a[76:77], v10 offset:59168
    v_mfma_f32_16x16x32_bf16 v[72:75], a[8:11], a[168:171], v[72:75]
    ds_read_b64_tr_b16 a[78:79], v10 offset:59680
    v_mfma_f32_16x16x32_bf16 v[76:79], a[8:11], a[172:175], v[76:79]
    v_mfma_f32_16x16x32_bf16 v[80:83], a[12:15], a[160:163], v[80:83]
    ds_read_b64_tr_b16 a[80:81], v10 offset:50752
    v_mfma_f32_16x16x32_bf16 v[84:87], a[12:15], a[164:167], v[84:87]
    v_mfma_f32_16x16x32_bf16 v[88:91], a[12:15], a[168:171], v[88:91]
    ds_read_b64_tr_b16 a[82:83], v10 offset:51264
    buffer_load_dwordx4 v7, s[32:35], s25 offen offset:1056 lds
    v_mfma_f32_16x16x32_bf16 v[92:95], a[12:15], a[172:175], v[92:95]
    ds_read_b64_tr_b16 a[84:85], v10 offset:50784
    v_mfma_f32_16x16x32_bf16 v[96:99], a[16:19], a[160:163], v[96:99]
    v_mfma_f32_16x16x32_bf16 v[100:103], a[16:19], a[164:167], v[100:103]
    ds_read_b64_tr_b16 a[86:87], v10 offset:51296
    v_mfma_f32_16x16x32_bf16 v[104:107], a[16:19], a[168:171], v[104:107]
    ds_read_b64_tr_b16 a[88:89], v10 offset:59200
    v_mfma_f32_16x16x32_bf16 v[108:111], a[16:19], a[172:175], v[108:111]
    v_mfma_f32_16x16x32_bf16 v[112:115], a[20:23], a[160:163], v[112:115]
    ds_read_b64_tr_b16 a[90:91], v10 offset:59712
    v_mfma_f32_16x16x32_bf16 v[116:119], a[20:23], a[164:167], v[116:119]
    ds_read_b64_tr_b16 a[92:93], v10 offset:59232
    buffer_load_dwordx4 a[148:151], v4, s[28:31], s23 offen offset:1024
    v_mfma_f32_16x16x32_bf16 v[120:123], a[20:23], a[168:171], v[120:123]
    v_mfma_f32_16x16x32_bf16 v[124:127], a[20:23], a[172:175], v[124:127]
    ds_read_b64_tr_b16 a[94:95], v10 offset:59744
    v_mfma_f32_16x16x32_bf16 v[128:131], a[24:27], a[160:163], v[128:131]
    v_mfma_f32_16x16x32_bf16 v[132:135], a[24:27], a[164:167], v[132:135]
    ds_read_b64_tr_b16 a[96:97], v10 offset:50816
    v_mfma_f32_16x16x32_bf16 v[136:139], a[24:27], a[168:171], v[136:139]
    ds_read_b64_tr_b16 a[98:99], v10 offset:51328
    v_mfma_f32_16x16x32_bf16 v[140:143], a[24:27], a[172:175], v[140:143]
    v_mfma_f32_16x16x32_bf16 v[144:147], a[28:31], a[160:163], v[144:147]
    ds_read_b64_tr_b16 a[100:101], v10 offset:50848
    buffer_load_dwordx4 v8, s[32:35], s25 offen offset:2112 lds
    v_mfma_f32_16x16x32_bf16 v[148:151], a[28:31], a[164:167], v[148:151]
    ds_read_b64_tr_b16 a[102:103], v10 offset:51360
    v_mfma_f32_16x16x32_bf16 v[152:155], a[28:31], a[168:171], v[152:155]
    v_mfma_f32_16x16x32_bf16 v[156:159], a[28:31], a[172:175], v[156:159]
    ds_read_b64_tr_b16 a[104:105], v10 offset:59264
    v_mfma_f32_16x16x32_bf16 v[160:163], a[32:35], a[160:163], v[160:163]
    ds_read_b64_tr_b16 a[106:107], v10 offset:59776
    v_mfma_f32_16x16x32_bf16 v[164:167], a[32:35], a[164:167], v[164:167]
    v_mfma_f32_16x16x32_bf16 v[168:171], a[32:35], a[168:171], v[168:171]
    ds_read_b64_tr_b16 a[108:109], v10 offset:59296
    v_mfma_f32_16x16x32_bf16 v[172:175], a[32:35], a[172:175], v[172:175]
    ds_read_b64_tr_b16 a[110:111], v10 offset:59808
    buffer_load_dwordx4 a[152:155], v5, s[28:31], s23 offen offset:0
    v_mfma_f32_16x16x32_bf16 v[176:179], a[36:39], a[160:163], v[176:179]
    v_mfma_f32_16x16x32_bf16 v[180:183], a[36:39], a[164:167], v[180:183]
    ds_read_b64_tr_b16 a[112:113], v12 offset:50688
    v_mfma_f32_16x16x32_bf16 v[184:187], a[36:39], a[168:171], v[184:187]
    v_mfma_f32_16x16x32_bf16 v[188:191], a[36:39], a[172:175], v[188:191]
    ds_read_b64_tr_b16 a[114:115], v12 offset:51200
    v_mfma_f32_16x16x32_bf16 v[192:195], a[40:43], a[160:163], v[192:195]
    ds_read_b64_tr_b16 a[116:117], v12 offset:50720
    v_mfma_f32_16x16x32_bf16 v[196:199], a[40:43], a[164:167], v[196:199]
    v_mfma_f32_16x16x32_bf16 v[200:203], a[40:43], a[168:171], v[200:203]
    ds_read_b64_tr_b16 a[118:119], v12 offset:51232
    buffer_load_dwordx4 v9, s[32:35], s25 offen offset:3168 lds
    s_add_u32 s25, s25, 229376
    v_mfma_f32_16x16x32_bf16 v[204:207], a[40:43], a[172:175], v[204:207]
    ds_read_b64_tr_b16 a[120:121], v12 offset:59136
    v_mfma_f32_16x16x32_bf16 v[208:211], a[44:47], a[160:163], v[208:211]
    v_mfma_f32_16x16x32_bf16 v[212:215], a[44:47], a[164:167], v[212:215]
    ds_read_b64_tr_b16 a[122:123], v12 offset:59648
    v_mfma_f32_16x16x32_bf16 v[216:219], a[44:47], a[168:171], v[216:219]
    ds_read_b64_tr_b16 a[124:125], v12 offset:59168
    v_mfma_f32_16x16x32_bf16 v[220:223], a[44:47], a[172:175], v[220:223]
    v_mfma_f32_16x16x32_bf16 v[224:227], a[48:51], a[160:163], v[224:227]
    ds_read_b64_tr_b16 a[126:127], v12 offset:59680
    v_mfma_f32_16x16x32_bf16 v[228:231], a[48:51], a[164:167], v[228:231]
    buffer_load_dwordx4 a[156:159], v5, s[28:31], s23 offen offset:1024
    s_add_u32 s23, s23, 0x20000
    v_mfma_f32_16x16x32_bf16 v[232:235], a[52:55], a[160:163], v[232:235]
    v_mfma_f32_16x16x32_bf16 v[236:239], a[52:55], a[164:167], v[236:239]
    v_mfma_f32_16x16x32_bf16 v[240:243], a[56:59], a[160:163], v[240:243]
    v_mfma_f32_16x16x32_bf16 v[244:247], a[56:59], a[164:167], v[244:247]
    v_mfma_f32_16x16x32_bf16 v[248:251], a[60:63], a[160:163], v[248:251]
    v_mfma_f32_16x16x32_bf16 v[252:255], a[60:63], a[164:167], v[252:255]
    s_waitcnt lgkmcnt(0)
    s_waitcnt vmcnt(17)
    s_barrier
    v_mfma_f32_16x16x32_bf16 v[32:35], a[64:67], a[176:179], v[32:35]
    ds_read_b64_tr_b16 a[0:1], v11 offset:0
    v_mfma_f32_16x16x32_bf16 v[36:39], a[64:67], a[180:183], v[36:39]
    ds_read_b64_tr_b16 a[2:3], v11 offset:512
    s_add_u32 m0, s22, 118272
    s_nop 0
    buffer_load_dwordx4 v6, s[32:35], s25 offen offset:0 lds
    v_mfma_f32_16x16x32_bf16 v[40:43], a[64:67], a[184:187], v[40:43]
    s_waitcnt vmcnt(17)
    v_mfma_f32_16x16x32_bf16 v[44:47], a[64:67], a[188:191], v[44:47]
    ds_read_b64_tr_b16 a[4:5], v11 offset:32
    v_mfma_f32_16x16x32_bf16 v[48:51], a[68:71], a[176:179], v[48:51]
    ds_read_b64_tr_b16 a[6:7], v11 offset:544
    v_mfma_f32_16x16x32_bf16 v[52:55], a[68:71], a[180:183], v[52:55]
    v_mfma_f32_16x16x32_bf16 v[56:59], a[68:71], a[184:187], v[56:59]
    ds_read_b64_tr_b16 a[8:9], v11 offset:8448
    v_mfma_f32_16x16x32_bf16 v[60:63], a[68:71], a[188:191], v[60:63]
    ds_read_b64_tr_b16 a[10:11], v11 offset:8960
    buffer_load_dwordx4 a[160:163], v4, s[28:31], s23 offen offset:0
    v_mfma_f32_16x16x32_bf16 v[64:67], a[72:75], a[176:179], v[64:67]
    v_mfma_f32_16x16x32_bf16 v[68:71], a[72:75], a[180:183], v[68:71]
    ds_read_b64_tr_b16 a[12:13], v11 offset:8480
    v_mfma_f32_16x16x32_bf16 v[72:75], a[72:75], a[184:187], v[72:75]
    ds_read_b64_tr_b16 a[14:15], v11 offset:8992
    v_mfma_f32_16x16x32_bf16 v[76:79], a[72:75], a[188:191], v[76:79]
    v_mfma_f32_16x16x32_bf16 v[80:83], a[76:79], a[176:179], v[80:83]
    ds_read_b64_tr_b16 a[16:17], v11 offset:64
    v_mfma_f32_16x16x32_bf16 v[84:87], a[76:79], a[180:183], v[84:87]
    v_mfma_f32_16x16x32_bf16 v[88:91], a[76:79], a[184:187], v[88:91]
    ds_read_b64_tr_b16 a[18:19], v11 offset:576
    buffer_load_dwordx4 v7, s[32:35], s25 offen offset:1056 lds
    v_mfma_f32_16x16x32_bf16 v[92:95], a[76:79], a[188:191], v[92:95]
    ds_read_b64_tr_b16 a[20:21], v11 offset:96
    v_mfma_f32_16x16x32_bf16 v[96:99], a[80:83], a[176:179], v[96:99]
    v_mfma_f32_16x16x32_bf16 v[100:103], a[80:83], a[180:183], v[100:103]
    ds_read_b64_tr_b16 a[22:23], v11 offset:608
    v_mfma_f32_16x16x32_bf16 v[104:107], a[80:83], a[184:187], v[104:107]
    ds_read_b64_tr_b16 a[24:25], v11 offset:8512
    v_mfma_f32_16x16x32_bf16 v[108:111], a[80:83], a[188:191], v[108:111]
    v_mfma_f32_16x16x32_bf16 v[112:115], a[84:87], a[176:179], v[112:115]
    ds_read_b64_tr_b16 a[26:27], v11 offset:9024
    v_mfma_f32_16x16x32_bf16 v[116:119], a[84:87], a[180:183], v[116:119]
    ds_read_b64_tr_b16 a[28:29], v11 offset:8544
    buffer_load_dwordx4 a[164:167], v4, s[28:31], s23 offen offset:1024
    v_mfma_f32_16x16x32_bf16 v[120:123], a[84:87], a[184:187], v[120:123]
    v_mfma_f32_16x16x32_bf16 v[124:127], a[84:87], a[188:191], v[124:127]
    ds_read_b64_tr_b16 a[30:31], v11 offset:9056
    v_mfma_f32_16x16x32_bf16 v[128:131], a[88:91], a[176:179], v[128:131]
    v_mfma_f32_16x16x32_bf16 v[132:135], a[88:91], a[180:183], v[132:135]
    ds_read_b64_tr_b16 a[32:33], v11 offset:128
    v_mfma_f32_16x16x32_bf16 v[136:139], a[88:91], a[184:187], v[136:139]
    ds_read_b64_tr_b16 a[34:35], v11 offset:640
    v_mfma_f32_16x16x32_bf16 v[140:143], a[88:91], a[188:191], v[140:143]
    v_mfma_f32_16x16x32_bf16 v[144:147], a[92:95], a[176:179], v[144:147]
    ds_read_b64_tr_b16 a[36:37], v11 offset:160
    buffer_load_dwordx4 v8, s[32:35], s25 offen offset:2112 lds
    v_mfma_f32_16x16x32_bf16 v[148:151], a[92:95], a[180:183], v[148:151]
    ds_read_b64_tr_b16 a[38:39], v11 offset:672
    v_mfma_f32_16x16x32_bf16 v[152:155], a[92:95], a[184:187], v[152:155]
    v_mfma_f32_16x16x32_bf16 v[156:159], a[92:95], a[188:191], v[156:159]
    ds_read_b64_tr_b16 a[40:41], v11 offset:8576
    v_mfma_f32_16x16x32_bf16 v[160:163], a[96:99], a[176:179], v[160:163]
    ds_read_b64_tr_b16 a[42:43], v11 offset:9088
    v_mfma_f32_16x16x32_bf16 v[164:167], a[96:99], a[180:183], v[164:167]
    v_mfma_f32_16x16x32_bf16 v[168:171], a[96:99], a[184:187], v[168:171]
    ds_read_b64_tr_b16 a[44:45], v11 offset:8608
    v_mfma_f32_16x16x32_bf16 v[172:175], a[96:99], a[188:191], v[172:175]
    ds_read_b64_tr_b16 a[46:47], v11 offset:9120
    buffer_load_dwordx4 a[168:171], v5, s[28:31], s23 offen offset:0
    v_mfma_f32_16x16x32_bf16 v[176:179], a[100:103], a[176:179], v[176:179]
    v_mfma_f32_16x16x32_bf16 v[180:183], a[100:103], a[180:183], v[180:183]
    ds_read_b64_tr_b16 a[48:49], v13 offset:0
    v_mfma_f32_16x16x32_bf16 v[184:187], a[100:103], a[184:187], v[184:187]
    v_mfma_f32_16x16x32_bf16 v[188:191], a[100:103], a[188:191], v[188:191]
    ds_read_b64_tr_b16 a[50:51], v13 offset:512
    v_mfma_f32_16x16x32_bf16 v[192:195], a[104:107], a[176:179], v[192:195]
    ds_read_b64_tr_b16 a[52:53], v13 offset:32
    v_mfma_f32_16x16x32_bf16 v[196:199], a[104:107], a[180:183], v[196:199]
    v_mfma_f32_16x16x32_bf16 v[200:203], a[104:107], a[184:187], v[200:203]
    ds_read_b64_tr_b16 a[54:55], v13 offset:544
    buffer_load_dwordx4 v9, s[32:35], s25 offen offset:3168 lds
    s_add_u32 s25, s25, 229376
    v_mfma_f32_16x16x32_bf16 v[204:207], a[104:107], a[188:191], v[204:207]
    ds_read_b64_tr_b16 a[56:57], v13 offset:8448
    v_mfma_f32_16x16x32_bf16 v[208:211], a[108:111], a[176:179], v[208:211]
    v_mfma_f32_16x16x32_bf16 v[212:215], a[108:111], a[180:183], v[212:215]
    ds_read_b64_tr_b16 a[58:59], v13 offset:8960
    v_mfma_f32_16x16x32_bf16 v[216:219], a[108:111], a[184:187], v[216:219]
    ds_read_b64_tr_b16 a[60:61], v13 offset:8480
    v_mfma_f32_16x16x32_bf16 v[220:223], a[108:111], a[188:191], v[220:223]
    v_mfma_f32_16x16x32_bf16 v[224:227], a[112:115], a[176:179], v[224:227]
    ds_read_b64_tr_b16 a[62:63], v13 offset:8992
    v_mfma_f32_16x16x32_bf16 v[228:231], a[112:115], a[180:183], v[228:231]
    buffer_load_dwordx4 a[172:175], v5, s[28:31], s23 offen offset:1024
    s_add_u32 s23, s23, 0x20000
    v_mfma_f32_16x16x32_bf16 v[232:235], a[116:119], a[176:179], v[232:235]
    v_mfma_f32_16x16x32_bf16 v[236:239], a[116:119], a[180:183], v[236:239]
    v_mfma_f32_16x16x32_bf16 v[240:243], a[120:123], a[176:179], v[240:243]
    v_mfma_f32_16x16x32_bf16 v[244:247], a[120:123], a[180:183], v[244:247]
    v_mfma_f32_16x16x32_bf16 v[248:251], a[124:127], a[176:179], v[248:251]
    v_mfma_f32_16x16x32_bf16 v[252:255], a[124:127], a[180:183], v[252:255]
    s_waitcnt lgkmcnt(0)
    s_waitcnt vmcnt(17)
    s_barrier
    v_mfma_f32_16x16x32_bf16 v[32:35], a[0:3], a[128:131], v[32:35]
    ds_read_b64_tr_b16 a[64:65], v11 offset:16896
    v_mfma_f32_16x16x32_bf16 v[36:39], a[0:3], a[132:135], v[36:39]
    ds_read_b64_tr_b16 a[66:67], v11 offset:17408
    buffer_load_dwordx4 a[176:179], v4, s[28:31], s23 offen offset:0
    v_mfma_f32_16x16x32_bf16 v[40:43], a[0:3], a[136:139], v[40:43]
    s_waitcnt vmcnt(17)
    v_mfma_f32_16x16x32_bf16 v[44:47], a[0:3], a[140:143], v[44:47]
    ds_read_b64_tr_b16 a[68:69], v11 offset:16928
    v_mfma_f32_16x16x32_bf16 v[48:51], a[4:7], a[128:131], v[48:51]
    ds_read_b64_tr_b16 a[70:71], v11 offset:17440
    v_mfma_f32_16x16x32_bf16 v[52:55], a[4:7], a[132:135], v[52:55]
    v_mfma_f32_16x16x32_bf16 v[56:59], a[4:7], a[136:139], v[56:59]
    ds_read_b64_tr_b16 a[72:73], v11 offset:25344
    v_mfma_f32_16x16x32_bf16 v[60:63], a[4:7], a[140:143], v[60:63]
    ds_read_b64_tr_b16 a[74:75], v11 offset:25856
    v_mfma_f32_16x16x32_bf16 v[64:67], a[8:11], a[128:131], v[64:67]
    v_mfma_f32_16x16x32_bf16 v[68:71], a[8:11], a[132:135], v[68:71]
    ds_read_b64_tr_b16 a[76:77], v11 offset:25376
    v_mfma_f32_16x16x32_bf16 v[72:75], a[8:11], a[136:139], v[72:75]
    ds_read_b64_tr_b16 a[78:79], v11 offset:25888
    v_mfma_f32_16x16x32_bf16 v[76:79], a[8:11], a[140:143], v[76:79]
    v_mfma_f32_16x16x32_bf16 v[80:83], a[12:15], a[128:131], v[80:83]
    ds_read_b64_tr_b16 a[80:81], v11 offset:16960
    v_mfma_f32_16x16x32_bf16 v[84:87], a[12:15], a[132:135], v[84:87]
    v_mfma_f32_16x16x32_bf16 v[88:91], a[12:15], a[136:139], v[88:91]
    ds_read_b64_tr_b16 a[82:83], v11 offset:17472
    buffer_load_dwordx4 a[180:183], v4, s[28:31], s23 offen offset:1024
    v_mfma_f32_16x16x32_bf16 v[92:95], a[12:15], a[140:143], v[92:95]
    ds_read_b64_tr_b16 a[84:85], v11 offset:16992
    v_mfma_f32_16x16x32_bf16 v[96:99], a[16:19], a[128:131], v[96:99]
    v_mfma_f32_16x16x32_bf16 v[100:103], a[16:19], a[132:135], v[100:103]
    ds_read_b64_tr_b16 a[86:87], v11 offset:17504
    v_mfma_f32_16x16x32_bf16 v[104:107], a[16:19], a[136:139], v[104:107]
    ds_read_b64_tr_b16 a[88:89], v11 offset:25408
    v_mfma_f32_16x16x32_bf16 v[108:111], a[16:19], a[140:143], v[108:111]
    v_mfma_f32_16x16x32_bf16 v[112:115], a[20:23], a[128:131], v[112:115]
    ds_read_b64_tr_b16 a[90:91], v11 offset:25920
    v_mfma_f32_16x16x32_bf16 v[116:119], a[20:23], a[132:135], v[116:119]
    ds_read_b64_tr_b16 a[92:93], v11 offset:25440
    v_mfma_f32_16x16x32_bf16 v[120:123], a[20:23], a[136:139], v[120:123]
    v_mfma_f32_16x16x32_bf16 v[124:127], a[20:23], a[140:143], v[124:127]
    ds_read_b64_tr_b16 a[94:95], v11 offset:25952
    v_mfma_f32_16x16x32_bf16 v[128:131], a[24:27], a[128:131], v[128:131]
    v_mfma_f32_16x16x32_bf16 v[132:135], a[24:27], a[132:135], v[132:135]
    ds_read_b64_tr_b16 a[96:97], v11 offset:17024
    v_mfma_f32_16x16x32_bf16 v[136:139], a[24:27], a[136:139], v[136:139]
    ds_read_b64_tr_b16 a[98:99], v11 offset:17536
    v_mfma_f32_16x16x32_bf16 v[140:143], a[24:27], a[140:143], v[140:143]
    v_mfma_f32_16x16x32_bf16 v[144:147], a[28:31], a[128:131], v[144:147]
    ds_read_b64_tr_b16 a[100:101], v11 offset:17056
    buffer_load_dwordx4 a[184:187], v5, s[28:31], s23 offen offset:0
    v_mfma_f32_16x16x32_bf16 v[148:151], a[28:31], a[132:135], v[148:151]
    ds_read_b64_tr_b16 a[102:103], v11 offset:17568
    v_mfma_f32_16x16x32_bf16 v[152:155], a[28:31], a[136:139], v[152:155]
    v_mfma_f32_16x16x32_bf16 v[156:159], a[28:31], a[140:143], v[156:159]
    ds_read_b64_tr_b16 a[104:105], v11 offset:25472
    v_mfma_f32_16x16x32_bf16 v[160:163], a[32:35], a[128:131], v[160:163]
    ds_read_b64_tr_b16 a[106:107], v11 offset:25984
    v_mfma_f32_16x16x32_bf16 v[164:167], a[32:35], a[132:135], v[164:167]
    v_mfma_f32_16x16x32_bf16 v[168:171], a[32:35], a[136:139], v[168:171]
    ds_read_b64_tr_b16 a[108:109], v11 offset:25504
    v_mfma_f32_16x16x32_bf16 v[172:175], a[32:35], a[140:143], v[172:175]
    ds_read_b64_tr_b16 a[110:111], v11 offset:26016
    v_mfma_f32_16x16x32_bf16 v[176:179], a[36:39], a[128:131], v[176:179]
    v_mfma_f32_16x16x32_bf16 v[180:183], a[36:39], a[132:135], v[180:183]
    ds_read_b64_tr_b16 a[112:113], v13 offset:16896
    v_mfma_f32_16x16x32_bf16 v[184:187], a[36:39], a[136:139], v[184:187]
    v_mfma_f32_16x16x32_bf16 v[188:191], a[36:39], a[140:143], v[188:191]
    ds_read_b64_tr_b16 a[114:115], v13 offset:17408
    v_mfma_f32_16x16x32_bf16 v[192:195], a[40:43], a[128:131], v[192:195]
    ds_read_b64_tr_b16 a[116:117], v13 offset:16928
    v_mfma_f32_16x16x32_bf16 v[196:199], a[40:43], a[132:135], v[196:199]
    v_mfma_f32_16x16x32_bf16 v[200:203], a[40:43], a[136:139], v[200:203]
    ds_read_b64_tr_b16 a[118:119], v13 offset:17440
    buffer_load_dwordx4 a[188:191], v5, s[28:31], s23 offen offset:1024
    s_add_u32 s23, s23, 0x20000
    v_mfma_f32_16x16x32_bf16 v[204:207], a[40:43], a[140:143], v[204:207]
    ds_read_b64_tr_b16 a[120:121], v13 offset:25344
    v_mfma_f32_16x16x32_bf16 v[208:211], a[44:47], a[128:131], v[208:211]
    v_mfma_f32_16x16x32_bf16 v[212:215], a[44:47], a[132:135], v[212:215]
    ds_read_b64_tr_b16 a[122:123], v13 offset:25856
    v_mfma_f32_16x16x32_bf16 v[216:219], a[44:47], a[136:139], v[216:219]
    ds_read_b64_tr_b16 a[124:125], v13 offset:25376
    v_mfma_f32_16x16x32_bf16 v[220:223], a[44:47], a[140:143], v[220:223]
    v_mfma_f32_16x16x32_bf16 v[224:227], a[48:51], a[128:131], v[224:227]
    ds_read_b64_tr_b16 a[126:127], v13 offset:25888
    v_mfma_f32_16x16x32_bf16 v[228:231], a[48:51], a[132:135], v[228:231]
    v_mfma_f32_16x16x32_bf16 v[232:235], a[52:55], a[128:131], v[232:235]
    v_mfma_f32_16x16x32_bf16 v[236:239], a[52:55], a[132:135], v[236:239]
    v_mfma_f32_16x16x32_bf16 v[240:243], a[56:59], a[128:131], v[240:243]
    v_mfma_f32_16x16x32_bf16 v[244:247], a[56:59], a[132:135], v[244:247]
    v_mfma_f32_16x16x32_bf16 v[248:251], a[60:63], a[128:131], v[248:251]
    v_mfma_f32_16x16x32_bf16 v[252:255], a[60:63], a[132:135], v[252:255]
    s_waitcnt lgkmcnt(0)
    s_waitcnt vmcnt(13)
    s_barrier
    v_mfma_f32_16x16x32_bf16 v[32:35], a[64:67], a[144:147], v[32:35]
    ds_read_b64_tr_b16 a[0:1], v11 offset:33792
    v_mfma_f32_16x16x32_bf16 v[36:39], a[64:67], a[148:151], v[36:39]
    ds_read_b64_tr_b16 a[2:3], v11 offset:34304
    v_mfma_f32_16x16x32_bf16 v[40:43], a[64:67], a[152:155], v[40:43]
    s_waitcnt vmcnt(12)
    v_mfma_f32_16x16x32_bf16 v[44:47], a[64:67], a[156:159], v[44:47]
    ds_read_b64_tr_b16 a[4:5], v11 offset:33824
    v_mfma_f32_16x16x32_bf16 v[48:51], a[68:71], a[144:147], v[48:51]
    ds_read_b64_tr_b16 a[6:7], v11 offset:34336
    v_mfma_f32_16x16x32_bf16 v[52:55], a[68:71], a[148:151], v[52:55]
    v_mfma_f32_16x16x32_bf16 v[56:59], a[68:71], a[152:155], v[56:59]
    ds_read_b64_tr_b16 a[8:9], v11 offset:42240
    v_mfma_f32_16x16x32_bf16 v[60:63], a[68:71], a[156:159], v[60:63]
    ds_read_b64_tr_b16 a[10:11], v11 offset:42752
    v_mfma_f32_16x16x32_bf16 v[64:67], a[72:75], a[144:147], v[64:67]
    v_mfma_f32_16x16x32_bf16 v[68:71], a[72:75], a[148:151], v[68:71]
    ds_read_b64_tr_b16 a[12:13], v11 offset:42272
    v_mfma_f32_16x16x32_bf16 v[72:75], a[72:75], a[152:155], v[72:75]
    ds_read_b64_tr_b16 a[14:15], v11 offset:42784
    v_mfma_f32_16x16x32_bf16 v[76:79], a[72:75], a[156:159], v[76:79]
    v_mfma_f32_16x16x32_bf16 v[80:83], a[76:79], a[144:147], v[80:83]
    ds_read_b64_tr_b16 a[16:17], v11 offset:33856
    v_mfma_f32_16x16x32_bf16 v[84:87], a[76:79], a[148:151], v[84:87]
    v_mfma_f32_16x16x32_bf16 v[88:91], a[76:79], a[152:155], v[88:91]
    ds_read_b64_tr_b16 a[18:19], v11 offset:34368
    v_mfma_f32_16x16x32_bf16 v[92:95], a[76:79], a[156:159], v[92:95]
    ds_read_b64_tr_b16 a[20:21], v11 offset:33888
    v_mfma_f32_16x16x32_bf16 v[96:99], a[80:83], a[144:147], v[96:99]
    v_mfma_f32_16x16x32_bf16 v[100:103], a[80:83], a[148:151], v[100:103]
    ds_read_b64_tr_b16 a[22:23], v11 offset:34400
    v_mfma_f32_16x16x32_bf16 v[104:107], a[80:83], a[152:155], v[104:107]
    ds_read_b64_tr_b16 a[24:25], v11 offset:42304
    v_mfma_f32_16x16x32_bf16 v[108:111], a[80:83], a[156:159], v[108:111]
    v_mfma_f32_16x16x32_bf16 v[112:115], a[84:87], a[144:147], v[112:115]
    ds_read_b64_tr_b16 a[26:27], v11 offset:42816
    v_mfma_f32_16x16x32_bf16 v[116:119], a[84:87], a[148:151], v[116:119]
    ds_read_b64_tr_b16 a[28:29], v11 offset:42336
    v_mfma_f32_16x16x32_bf16 v[120:123], a[84:87], a[152:155], v[120:123]
    v_mfma_f32_16x16x32_bf16 v[124:127], a[84:87], a[156:159], v[124:127]
    ds_read_b64_tr_b16 a[30:31], v11 offset:42848
    v_mfma_f32_16x16x32_bf16 v[128:131], a[88:91], a[144:147], v[128:131]
    v_mfma_f32_16x16x32_bf16 v[132:135], a[88:91], a[148:151], v[132:135]
    ds_read_b64_tr_b16 a[32:33], v11 offset:33920
    v_mfma_f32_16x16x32_bf16 v[136:139], a[88:91], a[152:155], v[136:139]
    ds_read_b64_tr_b16 a[34:35], v11 offset:34432
    v_mfma_f32_16x16x32_bf16 v[140:143], a[88:91], a[156:159], v[140:143]
    v_mfma_f32_16x16x32_bf16 v[144:147], a[92:95], a[144:147], v[144:147]
    ds_read_b64_tr_b16 a[36:37], v11 offset:33952
    v_mfma_f32_16x16x32_bf16 v[148:151], a[92:95], a[148:151], v[148:151]
    ds_read_b64_tr_b16 a[38:39], v11 offset:34464
    v_mfma_f32_16x16x32_bf16 v[152:155], a[92:95], a[152:155], v[152:155]
    v_mfma_f32_16x16x32_bf16 v[156:159], a[92:95], a[156:159], v[156:159]
    ds_read_b64_tr_b16 a[40:41], v11 offset:42368
    v_mfma_f32_16x16x32_bf16 v[160:163], a[96:99], a[144:147], v[160:163]
    ds_read_b64_tr_b16 a[42:43], v11 offset:42880
    v_mfma_f32_16x16x32_bf16 v[164:167], a[96:99], a[148:151], v[164:167]
    v_mfma_f32_16x16x32_bf16 v[168:171], a[96:99], a[152:155], v[168:171]
    ds_read_b64_tr_b16 a[44:45], v11 offset:42400
    v_mfma_f32_16x16x32_bf16 v[172:175], a[96:99], a[156:159], v[172:175]
    ds_read_b64_tr_b16 a[46:47], v11 offset:42912
    v_mfma_f32_16x16x32_bf16 v[176:179], a[100:103], a[144:147], v[176:179]
    v_mfma_f32_16x16x32_bf16 v[180:183], a[100:103], a[148:151], v[180:183]
    ds_read_b64_tr_b16 a[48:49], v13 offset:33792
    v_mfma_f32_16x16x32_bf16 v[184:187], a[100:103], a[152:155], v[184:187]
    v_mfma_f32_16x16x32_bf16 v[188:191], a[100:103], a[156:159], v[188:191]
    ds_read_b64_tr_b16 a[50:51], v13 offset:34304
    v_mfma_f32_16x16x32_bf16 v[192:195], a[104:107], a[144:147], v[192:195]
    ds_read_b64_tr_b16 a[52:53], v13 offset:33824
    v_mfma_f32_16x16x32_bf16 v[196:199], a[104:107], a[148:151], v[196:199]
    v_mfma_f32_16x16x32_bf16 v[200:203], a[104:107], a[152:155], v[200:203]
    ds_read_b64_tr_b16 a[54:55], v13 offset:34336
    v_mfma_f32_16x16x32_bf16 v[204:207], a[104:107], a[156:159], v[204:207]
    ds_read_b64_tr_b16 a[56:57], v13 offset:42240
    v_mfma_f32_16x16x32_bf16 v[208:211], a[108:111], a[144:147], v[208:211]
    v_mfma_f32_16x16x32_bf16 v[212:215], a[108:111], a[148:151], v[212:215]
    ds_read_b64_tr_b16 a[58:59], v13 offset:42752
    v_mfma_f32_16x16x32_bf16 v[216:219], a[108:111], a[152:155], v[216:219]
    ds_read_b64_tr_b16 a[60:61], v13 offset:42272
    v_mfma_f32_16x16x32_bf16 v[220:223], a[108:111], a[156:159], v[220:223]
    v_mfma_f32_16x16x32_bf16 v[224:227], a[112:115], a[144:147], v[224:227]
    ds_read_b64_tr_b16 a[62:63], v13 offset:42784
    v_mfma_f32_16x16x32_bf16 v[228:231], a[112:115], a[148:151], v[228:231]
    v_mfma_f32_16x16x32_bf16 v[232:235], a[116:119], a[144:147], v[232:235]
    v_mfma_f32_16x16x32_bf16 v[236:239], a[116:119], a[148:151], v[236:239]
    v_mfma_f32_16x16x32_bf16 v[240:243], a[120:123], a[144:147], v[240:243]
    v_mfma_f32_16x16x32_bf16 v[244:247], a[120:123], a[148:151], v[244:247]
    v_mfma_f32_16x16x32_bf16 v[248:251], a[124:127], a[144:147], v[248:251]
    v_mfma_f32_16x16x32_bf16 v[252:255], a[124:127], a[148:151], v[252:255]
    s_waitcnt lgkmcnt(0)
    s_waitcnt vmcnt(5)
    s_barrier
    v_mfma_f32_16x16x32_bf16 v[32:35], a[0:3], a[160:163], v[32:35]
    ds_read_b64_tr_b16 a[64:65], v11 offset:50688
    v_mfma_f32_16x16x32_bf16 v[36:39], a[0:3], a[164:167], v[36:39]
    ds_read_b64_tr_b16 a[66:67], v11 offset:51200
    v_mfma_f32_16x16x32_bf16 v[40:43], a[0:3], a[168:171], v[40:43]
    s_waitcnt vmcnt(4)
    v_mfma_f32_16x16x32_bf16 v[44:47], a[0:3], a[172:175], v[44:47]
    ds_read_b64_tr_b16 a[68:69], v11 offset:50720
    v_mfma_f32_16x16x32_bf16 v[48:51], a[4:7], a[160:163], v[48:51]
    ds_read_b64_tr_b16 a[70:71], v11 offset:51232
    v_mfma_f32_16x16x32_bf16 v[52:55], a[4:7], a[164:167], v[52:55]
    v_mfma_f32_16x16x32_bf16 v[56:59], a[4:7], a[168:171], v[56:59]
    ds_read_b64_tr_b16 a[72:73], v11 offset:59136
    v_mfma_f32_16x16x32_bf16 v[60:63], a[4:7], a[172:175], v[60:63]
    ds_read_b64_tr_b16 a[74:75], v11 offset:59648
    v_mfma_f32_16x16x32_bf16 v[64:67], a[8:11], a[160:163], v[64:67]
    v_mfma_f32_16x16x32_bf16 v[68:71], a[8:11], a[164:167], v[68:71]
    ds_read_b64_tr_b16 a[76:77], v11 offset:59168
    v_mfma_f32_16x16x32_bf16 v[72:75], a[8:11], a[168:171], v[72:75]
    ds_read_b64_tr_b16 a[78:79], v11 offset:59680
    v_mfma_f32_16x16x32_bf16 v[76:79], a[8:11], a[172:175], v[76:79]
    v_mfma_f32_16x16x32_bf16 v[80:83], a[12:15], a[160:163], v[80:83]
    ds_read_b64_tr_b16 a[80:81], v11 offset:50752
    v_mfma_f32_16x16x32_bf16 v[84:87], a[12:15], a[164:167], v[84:87]
    v_mfma_f32_16x16x32_bf16 v[88:91], a[12:15], a[168:171], v[88:91]
    ds_read_b64_tr_b16 a[82:83], v11 offset:51264
    v_mfma_f32_16x16x32_bf16 v[92:95], a[12:15], a[172:175], v[92:95]
    ds_read_b64_tr_b16 a[84:85], v11 offset:50784
    v_mfma_f32_16x16x32_bf16 v[96:99], a[16:19], a[160:163], v[96:99]
    v_mfma_f32_16x16x32_bf16 v[100:103], a[16:19], a[164:167], v[100:103]
    ds_read_b64_tr_b16 a[86:87], v11 offset:51296
    v_mfma_f32_16x16x32_bf16 v[104:107], a[16:19], a[168:171], v[104:107]
    ds_read_b64_tr_b16 a[88:89], v11 offset:59200
    v_mfma_f32_16x16x32_bf16 v[108:111], a[16:19], a[172:175], v[108:111]
    v_mfma_f32_16x16x32_bf16 v[112:115], a[20:23], a[160:163], v[112:115]
    ds_read_b64_tr_b16 a[90:91], v11 offset:59712
    v_mfma_f32_16x16x32_bf16 v[116:119], a[20:23], a[164:167], v[116:119]
    ds_read_b64_tr_b16 a[92:93], v11 offset:59232
    v_mfma_f32_16x16x32_bf16 v[120:123], a[20:23], a[168:171], v[120:123]
    v_mfma_f32_16x16x32_bf16 v[124:127], a[20:23], a[172:175], v[124:127]
    ds_read_b64_tr_b16 a[94:95], v11 offset:59744
    v_mfma_f32_16x16x32_bf16 v[128:131], a[24:27], a[160:163], v[128:131]
    v_mfma_f32_16x16x32_bf16 v[132:135], a[24:27], a[164:167], v[132:135]
    ds_read_b64_tr_b16 a[96:97], v11 offset:50816
    v_mfma_f32_16x16x32_bf16 v[136:139], a[24:27], a[168:171], v[136:139]
    ds_read_b64_tr_b16 a[98:99], v11 offset:51328
    v_mfma_f32_16x16x32_bf16 v[140:143], a[24:27], a[172:175], v[140:143]
    v_mfma_f32_16x16x32_bf16 v[144:147], a[28:31], a[160:163], v[144:147]
    ds_read_b64_tr_b16 a[100:101], v11 offset:50848
    v_mfma_f32_16x16x32_bf16 v[148:151], a[28:31], a[164:167], v[148:151]
    ds_read_b64_tr_b16 a[102:103], v11 offset:51360
    v_mfma_f32_16x16x32_bf16 v[152:155], a[28:31], a[168:171], v[152:155]
    v_mfma_f32_16x16x32_bf16 v[156:159], a[28:31], a[172:175], v[156:159]
    ds_read_b64_tr_b16 a[104:105], v11 offset:59264
    v_mfma_f32_16x16x32_bf16 v[160:163], a[32:35], a[160:163], v[160:163]
    ds_read_b64_tr_b16 a[106:107], v11 offset:59776
    v_mfma_f32_16x16x32_bf16 v[164:167], a[32:35], a[164:167], v[164:167]
    v_mfma_f32_16x16x32_bf16 v[168:171], a[32:35], a[168:171], v[168:171]
    ds_read_b64_tr_b16 a[108:109], v11 offset:59296
    v_mfma_f32_16x16x32_bf16 v[172:175], a[32:35], a[172:175], v[172:175]
    ds_read_b64_tr_b16 a[110:111], v11 offset:59808
    v_mfma_f32_16x16x32_bf16 v[176:179], a[36:39], a[160:163], v[176:179]
    v_mfma_f32_16x16x32_bf16 v[180:183], a[36:39], a[164:167], v[180:183]
    ds_read_b64_tr_b16 a[112:113], v13 offset:50688
    v_mfma_f32_16x16x32_bf16 v[184:187], a[36:39], a[168:171], v[184:187]
    v_mfma_f32_16x16x32_bf16 v[188:191], a[36:39], a[172:175], v[188:191]
    ds_read_b64_tr_b16 a[114:115], v13 offset:51200
    v_mfma_f32_16x16x32_bf16 v[192:195], a[40:43], a[160:163], v[192:195]
    ds_read_b64_tr_b16 a[116:117], v13 offset:50720
    v_mfma_f32_16x16x32_bf16 v[196:199], a[40:43], a[164:167], v[196:199]
    v_mfma_f32_16x16x32_bf16 v[200:203], a[40:43], a[168:171], v[200:203]
    ds_read_b64_tr_b16 a[118:119], v13 offset:51232
    v_mfma_f32_16x16x32_bf16 v[204:207], a[40:43], a[172:175], v[204:207]
    ds_read_b64_tr_b16 a[120:121], v13 offset:59136
    v_mfma_f32_16x16x32_bf16 v[208:211], a[44:47], a[160:163], v[208:211]
    v_mfma_f32_16x16x32_bf16 v[212:215], a[44:47], a[164:167], v[212:215]
    ds_read_b64_tr_b16 a[122:123], v13 offset:59648
    v_mfma_f32_16x16x32_bf16 v[216:219], a[44:47], a[168:171], v[216:219]
    ds_read_b64_tr_b16 a[124:125], v13 offset:59168
    v_mfma_f32_16x16x32_bf16 v[220:223], a[44:47], a[172:175], v[220:223]
    v_mfma_f32_16x16x32_bf16 v[224:227], a[48:51], a[160:163], v[224:227]
    ds_read_b64_tr_b16 a[126:127], v13 offset:59680
    v_mfma_f32_16x16x32_bf16 v[228:231], a[48:51], a[164:167], v[228:231]
    v_mfma_f32_16x16x32_bf16 v[232:235], a[52:55], a[160:163], v[232:235]
    v_mfma_f32_16x16x32_bf16 v[236:239], a[52:55], a[164:167], v[236:239]
    v_mfma_f32_16x16x32_bf16 v[240:243], a[56:59], a[160:163], v[240:243]
    v_mfma_f32_16x16x32_bf16 v[244:247], a[56:59], a[164:167], v[244:247]
    v_mfma_f32_16x16x32_bf16 v[248:251], a[60:63], a[160:163], v[248:251]
    v_mfma_f32_16x16x32_bf16 v[252:255], a[60:63], a[164:167], v[252:255]
    s_waitcnt lgkmcnt(0)
    s_waitcnt vmcnt(3)
    v_mfma_f32_16x16x32_bf16 v[32:35], a[64:67], a[176:179], v[32:35]
    s_waitcnt vmcnt(2)
    v_mfma_f32_16x16x32_bf16 v[36:39], a[64:67], a[180:183], v[36:39]
    s_waitcnt vmcnt(1)
    v_mfma_f32_16x16x32_bf16 v[40:43], a[64:67], a[184:187], v[40:43]
    s_waitcnt vmcnt(0)
    v_mfma_f32_16x16x32_bf16 v[44:47], a[64:67], a[188:191], v[44:47]
    v_mfma_f32_16x16x32_bf16 v[48:51], a[68:71], a[176:179], v[48:51]
    v_mfma_f32_16x16x32_bf16 v[52:55], a[68:71], a[180:183], v[52:55]
    v_mfma_f32_16x16x32_bf16 v[56:59], a[68:71], a[184:187], v[56:59]
    v_mfma_f32_16x16x32_bf16 v[60:63], a[68:71], a[188:191], v[60:63]
    v_mfma_f32_16x16x32_bf16 v[64:67], a[72:75], a[176:179], v[64:67]
    v_mfma_f32_16x16x32_bf16 v[68:71], a[72:75], a[180:183], v[68:71]
    v_mfma_f32_16x16x32_bf16 v[72:75], a[72:75], a[184:187], v[72:75]
    v_mfma_f32_16x16x32_bf16 v[76:79], a[72:75], a[188:191], v[76:79]
    v_mfma_f32_16x16x32_bf16 v[80:83], a[76:79], a[176:179], v[80:83]
    v_mfma_f32_16x16x32_bf16 v[84:87], a[76:79], a[180:183], v[84:87]
    v_mfma_f32_16x16x32_bf16 v[88:91], a[76:79], a[184:187], v[88:91]
    v_mfma_f32_16x16x32_bf16 v[92:95], a[76:79], a[188:191], v[92:95]
    v_mfma_f32_16x16x32_bf16 v[96:99], a[80:83], a[176:179], v[96:99]
    v_mfma_f32_16x16x32_bf16 v[100:103], a[80:83], a[180:183], v[100:103]
    v_mfma_f32_16x16x32_bf16 v[104:107], a[80:83], a[184:187], v[104:107]
    v_mfma_f32_16x16x32_bf16 v[108:111], a[80:83], a[188:191], v[108:111]
    v_mfma_f32_16x16x32_bf16 v[112:115], a[84:87], a[176:179], v[112:115]
    v_mfma_f32_16x16x32_bf16 v[116:119], a[84:87], a[180:183], v[116:119]
    v_mfma_f32_16x16x32_bf16 v[120:123], a[84:87], a[184:187], v[120:123]
    v_mfma_f32_16x16x32_bf16 v[124:127], a[84:87], a[188:191], v[124:127]
    v_mfma_f32_16x16x32_bf16 v[128:131], a[88:91], a[176:179], v[128:131]
    v_mfma_f32_16x16x32_bf16 v[132:135], a[88:91], a[180:183], v[132:135]
    v_mfma_f32_16x16x32_bf16 v[136:139], a[88:91], a[184:187], v[136:139]
    v_mfma_f32_16x16x32_bf16 v[140:143], a[88:91], a[188:191], v[140:143]
    v_mfma_f32_16x16x32_bf16 v[144:147], a[92:95], a[176:179], v[144:147]
    v_mfma_f32_16x16x32_bf16 v[148:151], a[92:95], a[180:183], v[148:151]
    v_mfma_f32_16x16x32_bf16 v[152:155], a[92:95], a[184:187], v[152:155]
    v_mfma_f32_16x16x32_bf16 v[156:159], a[92:95], a[188:191], v[156:159]
    v_mfma_f32_16x16x32_bf16 v[160:163], a[96:99], a[176:179], v[160:163]
    v_mfma_f32_16x16x32_bf16 v[164:167], a[96:99], a[180:183], v[164:167]
    v_mfma_f32_16x16x32_bf16 v[168:171], a[96:99], a[184:187], v[168:171]
    v_mfma_f32_16x16x32_bf16 v[172:175], a[96:99], a[188:191], v[172:175]
    v_mfma_f32_16x16x32_bf16 v[176:179], a[100:103], a[176:179], v[176:179]
    v_mfma_f32_16x16x32_bf16 v[180:183], a[100:103], a[180:183], v[180:183]
    v_mfma_f32_16x16x32_bf16 v[184:187], a[100:103], a[184:187], v[184:187]
    v_mfma_f32_16x16x32_bf16 v[188:191], a[100:103], a[188:191], v[188:191]
    v_mfma_f32_16x16x32_bf16 v[192:195], a[104:107], a[176:179], v[192:195]
    v_mfma_f32_16x16x32_bf16 v[196:199], a[104:107], a[180:183], v[196:199]
    v_mfma_f32_16x16x32_bf16 v[200:203], a[104:107], a[184:187], v[200:203]
    v_mfma_f32_16x16x32_bf16 v[204:207], a[104:107], a[188:191], v[204:207]
    v_mfma_f32_16x16x32_bf16 v[208:211], a[108:111], a[176:179], v[208:211]
    v_mfma_f32_16x16x32_bf16 v[212:215], a[108:111], a[180:183], v[212:215]
    v_mfma_f32_16x16x32_bf16 v[216:219], a[108:111], a[184:187], v[216:219]
    v_mfma_f32_16x16x32_bf16 v[220:223], a[108:111], a[188:191], v[220:223]
    v_mfma_f32_16x16x32_bf16 v[224:227], a[112:115], a[176:179], v[224:227]
    v_mfma_f32_16x16x32_bf16 v[228:231], a[112:115], a[180:183], v[228:231]
    v_mfma_f32_16x16x32_bf16 v[232:235], a[116:119], a[176:179], v[232:235]
    v_mfma_f32_16x16x32_bf16 v[236:239], a[116:119], a[180:183], v[236:239]
    v_mfma_f32_16x16x32_bf16 v[240:243], a[120:123], a[176:179], v[240:243]
    v_mfma_f32_16x16x32_bf16 v[244:247], a[120:123], a[180:183], v[244:247]
    v_mfma_f32_16x16x32_bf16 v[248:251], a[124:127], a[176:179], v[248:251]
    v_mfma_f32_16x16x32_bf16 v[252:255], a[124:127], a[180:183], v[252:255]
    s_lshl_b32 s20, s3, 10
    s_lshl_b32 s21, s8, 9
    s_add_u32 s20, s20, s21
    s_add_u32 s20, s20, 135168
    v_and_b32 v6, 15, v1
    v_lshl_add_u32 v6, v6, 4, s20
    v_xor_b32 v7, 512, v6
    ds_read_b128 v[16:19], v6 offset:0
    ds_read_b128 v[20:23], v6 offset:256
    ds_read_b128 v[24:27], v7 offset:0
    ds_read_b128 v[28:31], v7 offset:256
    v_lshrrev_b32 v6, 4, v1
    v_lshlrev_b32 v6, 4, v6
    s_lshl_b32 s20, s17, 1
    s_lshl_b32 s21, s18, 1
    s_add_u32 s20, s20, 139264
    s_add_u32 s21, s21, 139264
    v_add_u32 v7, s21, v6
    v_add_u32 v6, s20, v6
    s_mul_i32 s20, s9, 7
    s_add_u32 s53, s20, 3
    s_lshl_b32 s53, s53, 17
    s_lshl_b32 s21, s8, 2
    s_add_u32 s20, s20, s21
    s_lshl_b32 s50, s20, 17
    s_add_u32 s51, s50, 0x20000
    s_add_u32 s52, s50, 0x40000
    ds_read_b128 v[8:11], v6 offset:0
    ds_read_b128 v[12:15], v6 offset:512
    s_waitcnt lgkmcnt(1)
    v_pk_fma_f32 v[32:33], v[8:9], v[16:17], v[32:33] op_sel_hi:[1,0,1]
    s_waitcnt lgkmcnt(0)
    v_pk_fma_f32 v[64:65], v[12:13], v[16:17], v[64:65] op_sel_hi:[1,0,1]
    v_pk_fma_f32 v[34:35], v[10:11], v[16:17], v[34:35] op_sel_hi:[1,0,1]
    v_pk_fma_f32 v[66:67], v[14:15], v[16:17], v[66:67] op_sel_hi:[1,0,1]
    v_pk_fma_f32 v[36:37], v[8:9], v[20:21], v[36:37] op_sel_hi:[1,0,1]
    v_pk_fma_f32 v[68:69], v[12:13], v[20:21], v[68:69] op_sel_hi:[1,0,1]
    v_pk_fma_f32 v[38:39], v[10:11], v[20:21], v[38:39] op_sel_hi:[1,0,1]
    v_pk_fma_f32 v[70:71], v[14:15], v[20:21], v[70:71] op_sel_hi:[1,0,1]
    v_pk_fma_f32 v[40:41], v[8:9], v[24:25], v[40:41] op_sel_hi:[1,0,1]
    v_pk_fma_f32 v[72:73], v[12:13], v[24:25], v[72:73] op_sel_hi:[1,0,1]
    v_pk_fma_f32 v[42:43], v[10:11], v[24:25], v[42:43] op_sel_hi:[1,0,1]
    v_pk_fma_f32 v[74:75], v[14:15], v[24:25], v[74:75] op_sel_hi:[1,0,1]
    v_pk_fma_f32 v[44:45], v[8:9], v[28:29], v[44:45] op_sel_hi:[1,0,1]
    v_pk_fma_f32 v[76:77], v[12:13], v[28:29], v[76:77] op_sel_hi:[1,0,1]
    v_pk_fma_f32 v[46:47], v[10:11], v[28:29], v[46:47] op_sel_hi:[1,0,1]
    v_pk_fma_f32 v[78:79], v[14:15], v[28:29], v[78:79] op_sel_hi:[1,0,1]
    ds_read_b128 v[8:11], v6 offset:64
    ds_read_b128 v[12:15], v6 offset:576
    s_waitcnt lgkmcnt(1)
    v_pk_fma_f32 v[48:49], v[8:9], v[16:17], v[48:49] op_sel_hi:[1,0,1]
    s_waitcnt lgkmcnt(0)
    v_pk_fma_f32 v[80:81], v[12:13], v[16:17], v[80:81] op_sel_hi:[1,0,1]
    v_pk_fma_f32 v[50:51], v[10:11], v[16:17], v[50:51] op_sel_hi:[1,0,1]
    v_pk_fma_f32 v[82:83], v[14:15], v[16:17], v[82:83] op_sel_hi:[1,0,1]
    v_pk_fma_f32 v[52:53], v[8:9], v[20:21], v[52:53] op_sel_hi:[1,0,1]
    v_pk_fma_f32 v[84:85], v[12:13], v[20:21], v[84:85] op_sel_hi:[1,0,1]
    v_pk_fma_f32 v[54:55], v[10:11], v[20:21], v[54:55] op_sel_hi:[1,0,1]
    v_pk_fma_f32 v[86:87], v[14:15], v[20:21], v[86:87] op_sel_hi:[1,0,1]
    v_pk_fma_f32 v[56:57], v[8:9], v[24:25], v[56:57] op_sel_hi:[1,0,1]
    v_pk_fma_f32 v[88:89], v[12:13], v[24:25], v[88:89] op_sel_hi:[1,0,1]
    v_pk_fma_f32 v[58:59], v[10:11], v[24:25], v[58:59] op_sel_hi:[1,0,1]
    v_pk_fma_f32 v[90:91], v[14:15], v[24:25], v[90:91] op_sel_hi:[1,0,1]
    v_pk_fma_f32 v[60:61], v[8:9], v[28:29], v[60:61] op_sel_hi:[1,0,1]
    v_pk_fma_f32 v[92:93], v[12:13], v[28:29], v[92:93] op_sel_hi:[1,0,1]
    v_pk_fma_f32 v[62:63], v[10:11], v[28:29], v[62:63] op_sel_hi:[1,0,1]
    v_pk_fma_f32 v[94:95], v[14:15], v[28:29], v[94:95] op_sel_hi:[1,0,1]
    v_pk_mul_f32 v[64:65], v[64:65], v[32:33]
    v_pk_mul_f32 v[32:33], v[32:33], v[18:19] op_sel_hi:[1,0]
    v_pk_mul_f32 v[66:67], v[66:67], v[34:35]
    v_pk_mul_f32 v[34:35], v[34:35], v[18:19] op_sel_hi:[1,0]
    v_pk_mul_f32 v[80:81], v[80:81], v[48:49]
    v_pk_mul_f32 v[48:49], v[48:49], v[18:19] op_sel_hi:[1,0]
    v_pk_mul_f32 v[82:83], v[82:83], v[50:51]
    v_pk_mul_f32 v[50:51], v[50:51], v[18:19] op_sel_hi:[1,0]
    v_exp_f32 v32, v32
    v_exp_f32 v33, v33
    v_exp_f32 v34, v34
    v_exp_f32 v35, v35
    v_exp_f32 v48, v48
    v_exp_f32 v49, v49
    v_exp_f32 v50, v50
    v_exp_f32 v51, v51
    v_pk_fma_f32 v[32:33], v[32:33], v[16:17], v[16:17] op_sel:[0,1,1] op_sel_hi:[1,1,1]
    v_pk_fma_f32 v[34:35], v[34:35], v[16:17], v[16:17] op_sel:[0,1,1] op_sel_hi:[1,1,1]
    v_pk_fma_f32 v[48:49], v[48:49], v[16:17], v[16:17] op_sel:[0,1,1] op_sel_hi:[1,1,1]
    v_pk_fma_f32 v[50:51], v[50:51], v[16:17], v[16:17] op_sel:[0,1,1] op_sel_hi:[1,1,1]
    v_rcp_f32 v32, v32
    v_rcp_f32 v33, v33
    v_rcp_f32 v34, v34
    v_rcp_f32 v35, v35
    v_rcp_f32 v48, v48
    v_rcp_f32 v49, v49
    v_rcp_f32 v50, v50
    v_rcp_f32 v51, v51
    v_pk_mul_f32 v[64:65], v[64:65], v[32:33]
    v_pk_mul_f32 v[66:67], v[66:67], v[34:35]
    v_pk_mul_f32 v[80:81], v[80:81], v[48:49]
    v_pk_mul_f32 v[82:83], v[82:83], v[50:51]
    v_cvt_pk_bf16_f32 v32, v64, v65
    v_cvt_pk_bf16_f32 v33, v66, v67
    v_cvt_pk_bf16_f32 v34, v80, v81
    v_cvt_pk_bf16_f32 v35, v82, v83
    buffer_store_dwordx4 v[32:35], v4, s[40:43], s50 offen offset:0
    v_pk_mul_f32 v[68:69], v[68:69], v[36:37]
    v_pk_mul_f32 v[36:37], v[36:37], v[22:23] op_sel_hi:[1,0]
    v_pk_mul_f32 v[70:71], v[70:71], v[38:39]
    v_pk_mul_f32 v[38:39], v[38:39], v[22:23] op_sel_hi:[1,0]
    v_pk_mul_f32 v[84:85], v[84:85], v[52:53]
    v_pk_mul_f32 v[52:53], v[52:53], v[22:23] op_sel_hi:[1,0]
    v_pk_mul_f32 v[86:87], v[86:87], v[54:55]
    v_pk_mul_f32 v[54:55], v[54:55], v[22:23] op_sel_hi:[1,0]
    v_exp_f32 v36, v36
    v_exp_f32 v37, v37
    v_exp_f32 v38, v38
    v_exp_f32 v39, v39
    v_exp_f32 v52, v52
    v_exp_f32 v53, v53
    v_exp_f32 v54, v54
    v_exp_f32 v55, v55
    v_pk_fma_f32 v[36:37], v[36:37], v[20:21], v[20:21] op_sel:[0,1,1] op_sel_hi:[1,1,1]
    v_pk_fma_f32 v[38:39], v[38:39], v[20:21], v[20:21] op_sel:[0,1,1] op_sel_hi:[1,1,1]
    v_pk_fma_f32 v[52:53], v[52:53], v[20:21], v[20:21] op_sel:[0,1,1] op_sel_hi:[1,1,1]
    v_pk_fma_f32 v[54:55], v[54:55], v[20:21], v[20:21] op_sel:[0,1,1] op_sel_hi:[1,1,1]
    v_rcp_f32 v36, v36
    v_rcp_f32 v37, v37
    v_rcp_f32 v38, v38
    v_rcp_f32 v39, v39
    v_rcp_f32 v52, v52
    v_rcp_f32 v53, v53
    v_rcp_f32 v54, v54
    v_rcp_f32 v55, v55
    v_pk_mul_f32 v[68:69], v[68:69], v[36:37]
    v_pk_mul_f32 v[70:71], v[70:71], v[38:39]
    v_pk_mul_f32 v[84:85], v[84:85], v[52:53]
    v_pk_mul_f32 v[86:87], v[86:87], v[54:55]
    v_cvt_pk_bf16_f32 v36, v68, v69
    v_cvt_pk_bf16_f32 v37, v70, v71
    v_cvt_pk_bf16_f32 v38, v84, v85
    v_cvt_pk_bf16_f32 v39, v86, v87
    buffer_store_dwordx4 v[36:39], v4, s[40:43], s50 offen offset:1024
    v_pk_mul_f32 v[72:73], v[72:73], v[40:41]
    v_pk_mul_f32 v[40:41], v[40:41], v[26:27] op_sel_hi:[1,0]
    v_pk_mul_f32 v[74:75], v[74:75], v[42:43]
    v_pk_mul_f32 v[42:43], v[42:43], v[26:27] op_sel_hi:[1,0]
    v_pk_mul_f32 v[88:89], v[88:89], v[56:57]
    v_pk_mul_f32 v[56:57], v[56:57], v[26:27] op_sel_hi:[1,0]
    v_pk_mul_f32 v[90:91], v[90:91], v[58:59]
    v_pk_mul_f32 v[58:59], v[58:59], v[26:27] op_sel_hi:[1,0]
    v_exp_f32 v40, v40
    v_exp_f32 v41, v41
    v_exp_f32 v42, v42
    v_exp_f32 v43, v43
    v_exp_f32 v56, v56
    v_exp_f32 v57, v57
    v_exp_f32 v58, v58
    v_exp_f32 v59, v59
    v_pk_fma_f32 v[40:41], v[40:41], v[24:25], v[24:25] op_sel:[0,1,1] op_sel_hi:[1,1,1]
    v_pk_fma_f32 v[42:43], v[42:43], v[24:25], v[24:25] op_sel:[0,1,1] op_sel_hi:[1,1,1]
    v_pk_fma_f32 v[56:57], v[56:57], v[24:25], v[24:25] op_sel:[0,1,1] op_sel_hi:[1,1,1]
    v_pk_fma_f32 v[58:59], v[58:59], v[24:25], v[24:25] op_sel:[0,1,1] op_sel_hi:[1,1,1]
    v_rcp_f32 v40, v40
    v_rcp_f32 v41, v41
    v_rcp_f32 v42, v42
    v_rcp_f32 v43, v43
    v_rcp_f32 v56, v56
    v_rcp_f32 v57, v57
    v_rcp_f32 v58, v58
    v_rcp_f32 v59, v59
    v_pk_mul_f32 v[72:73], v[72:73], v[40:41]
    v_pk_mul_f32 v[74:75], v[74:75], v[42:43]
    v_pk_mul_f32 v[88:89], v[88:89], v[56:57]
    v_pk_mul_f32 v[90:91], v[90:91], v[58:59]
    v_cvt_pk_bf16_f32 v40, v72, v73
    v_cvt_pk_bf16_f32 v41, v74, v75
    v_cvt_pk_bf16_f32 v42, v88, v89
    v_cvt_pk_bf16_f32 v43, v90, v91
    buffer_store_dwordx4 v[40:43], v5, s[40:43], s50 offen offset:0
    v_pk_mul_f32 v[76:77], v[76:77], v[44:45]
    v_pk_mul_f32 v[44:45], v[44:45], v[30:31] op_sel_hi:[1,0]
    v_pk_mul_f32 v[78:79], v[78:79], v[46:47]
    v_pk_mul_f32 v[46:47], v[46:47], v[30:31] op_sel_hi:[1,0]
    v_pk_mul_f32 v[92:93], v[92:93], v[60:61]
    v_pk_mul_f32 v[60:61], v[60:61], v[30:31] op_sel_hi:[1,0]
    v_pk_mul_f32 v[94:95], v[94:95], v[62:63]
    v_pk_mul_f32 v[62:63], v[62:63], v[30:31] op_sel_hi:[1,0]
    v_exp_f32 v44, v44
    v_exp_f32 v45, v45
    v_exp_f32 v46, v46
    v_exp_f32 v47, v47
    v_exp_f32 v60, v60
    v_exp_f32 v61, v61
    v_exp_f32 v62, v62
    v_exp_f32 v63, v63
    v_pk_fma_f32 v[44:45], v[44:45], v[28:29], v[28:29] op_sel:[0,1,1] op_sel_hi:[1,1,1]
    v_pk_fma_f32 v[46:47], v[46:47], v[28:29], v[28:29] op_sel:[0,1,1] op_sel_hi:[1,1,1]
    v_pk_fma_f32 v[60:61], v[60:61], v[28:29], v[28:29] op_sel:[0,1,1] op_sel_hi:[1,1,1]
    v_pk_fma_f32 v[62:63], v[62:63], v[28:29], v[28:29] op_sel:[0,1,1] op_sel_hi:[1,1,1]
    v_rcp_f32 v44, v44
    v_rcp_f32 v45, v45
    v_rcp_f32 v46, v46
    v_rcp_f32 v47, v47
    v_rcp_f32 v60, v60
    v_rcp_f32 v61, v61
    v_rcp_f32 v62, v62
    v_rcp_f32 v63, v63
    v_pk_mul_f32 v[76:77], v[76:77], v[44:45]
    v_pk_mul_f32 v[78:79], v[78:79], v[46:47]
    v_pk_mul_f32 v[92:93], v[92:93], v[60:61]
    v_pk_mul_f32 v[94:95], v[94:95], v[62:63]
    v_cvt_pk_bf16_f32 v44, v76, v77
    v_cvt_pk_bf16_f32 v45, v78, v79
    v_cvt_pk_bf16_f32 v46, v92, v93
    v_cvt_pk_bf16_f32 v47, v94, v95
    buffer_store_dwordx4 v[44:47], v5, s[40:43], s50 offen offset:1024
    ds_read_b128 v[8:11], v6 offset:128
    ds_read_b128 v[12:15], v6 offset:640
    s_waitcnt lgkmcnt(1)
    v_pk_fma_f32 v[96:97], v[8:9], v[16:17], v[96:97] op_sel_hi:[1,0,1]
    s_waitcnt lgkmcnt(0)
    v_pk_fma_f32 v[128:129], v[12:13], v[16:17], v[128:129] op_sel_hi:[1,0,1]
    v_pk_fma_f32 v[98:99], v[10:11], v[16:17], v[98:99] op_sel_hi:[1,0,1]
    v_pk_fma_f32 v[130:131], v[14:15], v[16:17], v[130:131] op_sel_hi:[1,0,1]
    v_pk_fma_f32 v[100:101], v[8:9], v[20:21], v[100:101] op_sel_hi:[1,0,1]
    v_pk_fma_f32 v[132:133], v[12:13], v[20:21], v[132:133] op_sel_hi:[1,0,1]
    v_pk_fma_f32 v[102:103], v[10:11], v[20:21], v[102:103] op_sel_hi:[1,0,1]
    v_pk_fma_f32 v[134:135], v[14:15], v[20:21], v[134:135] op_sel_hi:[1,0,1]
    v_pk_fma_f32 v[104:105], v[8:9], v[24:25], v[104:105] op_sel_hi:[1,0,1]
    v_pk_fma_f32 v[136:137], v[12:13], v[24:25], v[136:137] op_sel_hi:[1,0,1]
    v_pk_fma_f32 v[106:107], v[10:11], v[24:25], v[106:107] op_sel_hi:[1,0,1]
    v_pk_fma_f32 v[138:139], v[14:15], v[24:25], v[138:139] op_sel_hi:[1,0,1]
    v_pk_fma_f32 v[108:109], v[8:9], v[28:29], v[108:109] op_sel_hi:[1,0,1]
    v_pk_fma_f32 v[140:141], v[12:13], v[28:29], v[140:141] op_sel_hi:[1,0,1]
    v_pk_fma_f32 v[110:111], v[10:11], v[28:29], v[110:111] op_sel_hi:[1,0,1]
    v_pk_fma_f32 v[142:143], v[14:15], v[28:29], v[142:143] op_sel_hi:[1,0,1]
    ds_read_b128 v[8:11], v6 offset:192
    ds_read_b128 v[12:15], v6 offset:704
    s_waitcnt lgkmcnt(1)
    v_pk_fma_f32 v[112:113], v[8:9], v[16:17], v[112:113] op_sel_hi:[1,0,1]
    s_waitcnt lgkmcnt(0)
    v_pk_fma_f32 v[144:145], v[12:13], v[16:17], v[144:145] op_sel_hi:[1,0,1]
    v_pk_fma_f32 v[114:115], v[10:11], v[16:17], v[114:115] op_sel_hi:[1,0,1]
    v_pk_fma_f32 v[146:147], v[14:15], v[16:17], v[146:147] op_sel_hi:[1,0,1]
    v_pk_fma_f32 v[116:117], v[8:9], v[20:21], v[116:117] op_sel_hi:[1,0,1]
    v_pk_fma_f32 v[148:149], v[12:13], v[20:21], v[148:149] op_sel_hi:[1,0,1]
    v_pk_fma_f32 v[118:119], v[10:11], v[20:21], v[118:119] op_sel_hi:[1,0,1]
    v_pk_fma_f32 v[150:151], v[14:15], v[20:21], v[150:151] op_sel_hi:[1,0,1]
    v_pk_fma_f32 v[120:121], v[8:9], v[24:25], v[120:121] op_sel_hi:[1,0,1]
    v_pk_fma_f32 v[152:153], v[12:13], v[24:25], v[152:153] op_sel_hi:[1,0,1]
    v_pk_fma_f32 v[122:123], v[10:11], v[24:25], v[122:123] op_sel_hi:[1,0,1]
    v_pk_fma_f32 v[154:155], v[14:15], v[24:25], v[154:155] op_sel_hi:[1,0,1]
    v_pk_fma_f32 v[124:125], v[8:9], v[28:29], v[124:125] op_sel_hi:[1,0,1]
    v_pk_fma_f32 v[156:157], v[12:13], v[28:29], v[156:157] op_sel_hi:[1,0,1]
    v_pk_fma_f32 v[126:127], v[10:11], v[28:29], v[126:127] op_sel_hi:[1,0,1]
    v_pk_fma_f32 v[158:159], v[14:15], v[28:29], v[158:159] op_sel_hi:[1,0,1]
    v_pk_mul_f32 v[128:129], v[128:129], v[96:97]
    v_pk_mul_f32 v[96:97], v[96:97], v[18:19] op_sel_hi:[1,0]
    v_pk_mul_f32 v[130:131], v[130:131], v[98:99]
    v_pk_mul_f32 v[98:99], v[98:99], v[18:19] op_sel_hi:[1,0]
    v_pk_mul_f32 v[144:145], v[144:145], v[112:113]
    v_pk_mul_f32 v[112:113], v[112:113], v[18:19] op_sel_hi:[1,0]
    v_pk_mul_f32 v[146:147], v[146:147], v[114:115]
    v_pk_mul_f32 v[114:115], v[114:115], v[18:19] op_sel_hi:[1,0]
    v_exp_f32 v96, v96
    v_exp_f32 v97, v97
    v_exp_f32 v98, v98
    v_exp_f32 v99, v99
    v_exp_f32 v112, v112
    v_exp_f32 v113, v113
    v_exp_f32 v114, v114
    v_exp_f32 v115, v115
    v_pk_fma_f32 v[96:97], v[96:97], v[16:17], v[16:17] op_sel:[0,1,1] op_sel_hi:[1,1,1]
    v_pk_fma_f32 v[98:99], v[98:99], v[16:17], v[16:17] op_sel:[0,1,1] op_sel_hi:[1,1,1]
    v_pk_fma_f32 v[112:113], v[112:113], v[16:17], v[16:17] op_sel:[0,1,1] op_sel_hi:[1,1,1]
    v_pk_fma_f32 v[114:115], v[114:115], v[16:17], v[16:17] op_sel:[0,1,1] op_sel_hi:[1,1,1]
    v_rcp_f32 v96, v96
    v_rcp_f32 v97, v97
    v_rcp_f32 v98, v98
    v_rcp_f32 v99, v99
    v_rcp_f32 v112, v112
    v_rcp_f32 v113, v113
    v_rcp_f32 v114, v114
    v_rcp_f32 v115, v115
    v_pk_mul_f32 v[128:129], v[128:129], v[96:97]
    v_pk_mul_f32 v[130:131], v[130:131], v[98:99]
    v_pk_mul_f32 v[144:145], v[144:145], v[112:113]
    v_pk_mul_f32 v[146:147], v[146:147], v[114:115]
    v_cvt_pk_bf16_f32 v96, v128, v129
    v_cvt_pk_bf16_f32 v97, v130, v131
    v_cvt_pk_bf16_f32 v98, v144, v145
    v_cvt_pk_bf16_f32 v99, v146, v147
    buffer_store_dwordx4 v[96:99], v4, s[40:43], s51 offen offset:0
    v_pk_mul_f32 v[132:133], v[132:133], v[100:101]
    v_pk_mul_f32 v[100:101], v[100:101], v[22:23] op_sel_hi:[1,0]
    v_pk_mul_f32 v[134:135], v[134:135], v[102:103]
    v_pk_mul_f32 v[102:103], v[102:103], v[22:23] op_sel_hi:[1,0]
    v_pk_mul_f32 v[148:149], v[148:149], v[116:117]
    v_pk_mul_f32 v[116:117], v[116:117], v[22:23] op_sel_hi:[1,0]
    v_pk_mul_f32 v[150:151], v[150:151], v[118:119]
    v_pk_mul_f32 v[118:119], v[118:119], v[22:23] op_sel_hi:[1,0]
    v_exp_f32 v100, v100
    v_exp_f32 v101, v101
    v_exp_f32 v102, v102
    v_exp_f32 v103, v103
    v_exp_f32 v116, v116
    v_exp_f32 v117, v117
    v_exp_f32 v118, v118
    v_exp_f32 v119, v119
    v_pk_fma_f32 v[100:101], v[100:101], v[20:21], v[20:21] op_sel:[0,1,1] op_sel_hi:[1,1,1]
    v_pk_fma_f32 v[102:103], v[102:103], v[20:21], v[20:21] op_sel:[0,1,1] op_sel_hi:[1,1,1]
    v_pk_fma_f32 v[116:117], v[116:117], v[20:21], v[20:21] op_sel:[0,1,1] op_sel_hi:[1,1,1]
    v_pk_fma_f32 v[118:119], v[118:119], v[20:21], v[20:21] op_sel:[0,1,1] op_sel_hi:[1,1,1]
    v_rcp_f32 v100, v100
    v_rcp_f32 v101, v101
    v_rcp_f32 v102, v102
    v_rcp_f32 v103, v103
    v_rcp_f32 v116, v116
    v_rcp_f32 v117, v117
    v_rcp_f32 v118, v118
    v_rcp_f32 v119, v119
    v_pk_mul_f32 v[132:133], v[132:133], v[100:101]
    v_pk_mul_f32 v[134:135], v[134:135], v[102:103]
    v_pk_mul_f32 v[148:149], v[148:149], v[116:117]
    v_pk_mul_f32 v[150:151], v[150:151], v[118:119]
    v_cvt_pk_bf16_f32 v100, v132, v133
    v_cvt_pk_bf16_f32 v101, v134, v135
    v_cvt_pk_bf16_f32 v102, v148, v149
    v_cvt_pk_bf16_f32 v103, v150, v151
    buffer_store_dwordx4 v[100:103], v4, s[40:43], s51 offen offset:1024
    v_pk_mul_f32 v[136:137], v[136:137], v[104:105]
    v_pk_mul_f32 v[104:105], v[104:105], v[26:27] op_sel_hi:[1,0]
    v_pk_mul_f32 v[138:139], v[138:139], v[106:107]
    v_pk_mul_f32 v[106:107], v[106:107], v[26:27] op_sel_hi:[1,0]
    v_pk_mul_f32 v[152:153], v[152:153], v[120:121]
    v_pk_mul_f32 v[120:121], v[120:121], v[26:27] op_sel_hi:[1,0]
    v_pk_mul_f32 v[154:155], v[154:155], v[122:123]
    v_pk_mul_f32 v[122:123], v[122:123], v[26:27] op_sel_hi:[1,0]
    v_exp_f32 v104, v104
    v_exp_f32 v105, v105
    v_exp_f32 v106, v106
    v_exp_f32 v107, v107
    v_exp_f32 v120, v120
    v_exp_f32 v121, v121
    v_exp_f32 v122, v122
    v_exp_f32 v123, v123
    v_pk_fma_f32 v[104:105], v[104:105], v[24:25], v[24:25] op_sel:[0,1,1] op_sel_hi:[1,1,1]
    v_pk_fma_f32 v[106:107], v[106:107], v[24:25], v[24:25] op_sel:[0,1,1] op_sel_hi:[1,1,1]
    v_pk_fma_f32 v[120:121], v[120:121], v[24:25], v[24:25] op_sel:[0,1,1] op_sel_hi:[1,1,1]
    v_pk_fma_f32 v[122:123], v[122:123], v[24:25], v[24:25] op_sel:[0,1,1] op_sel_hi:[1,1,1]
    v_rcp_f32 v104, v104
    v_rcp_f32 v105, v105
    v_rcp_f32 v106, v106
    v_rcp_f32 v107, v107
    v_rcp_f32 v120, v120
    v_rcp_f32 v121, v121
    v_rcp_f32 v122, v122
    v_rcp_f32 v123, v123
    v_pk_mul_f32 v[136:137], v[136:137], v[104:105]
    v_pk_mul_f32 v[138:139], v[138:139], v[106:107]
    v_pk_mul_f32 v[152:153], v[152:153], v[120:121]
    v_pk_mul_f32 v[154:155], v[154:155], v[122:123]
    v_cvt_pk_bf16_f32 v104, v136, v137
    v_cvt_pk_bf16_f32 v105, v138, v139
    v_cvt_pk_bf16_f32 v106, v152, v153
    v_cvt_pk_bf16_f32 v107, v154, v155
    buffer_store_dwordx4 v[104:107], v5, s[40:43], s51 offen offset:0
    v_pk_mul_f32 v[140:141], v[140:141], v[108:109]
    v_pk_mul_f32 v[108:109], v[108:109], v[30:31] op_sel_hi:[1,0]
    v_pk_mul_f32 v[142:143], v[142:143], v[110:111]
    v_pk_mul_f32 v[110:111], v[110:111], v[30:31] op_sel_hi:[1,0]
    v_pk_mul_f32 v[156:157], v[156:157], v[124:125]
    v_pk_mul_f32 v[124:125], v[124:125], v[30:31] op_sel_hi:[1,0]
    v_pk_mul_f32 v[158:159], v[158:159], v[126:127]
    v_pk_mul_f32 v[126:127], v[126:127], v[30:31] op_sel_hi:[1,0]
    v_exp_f32 v108, v108
    v_exp_f32 v109, v109
    v_exp_f32 v110, v110
    v_exp_f32 v111, v111
    v_exp_f32 v124, v124
    v_exp_f32 v125, v125
    v_exp_f32 v126, v126
    v_exp_f32 v127, v127
    v_pk_fma_f32 v[108:109], v[108:109], v[28:29], v[28:29] op_sel:[0,1,1] op_sel_hi:[1,1,1]
    v_pk_fma_f32 v[110:111], v[110:111], v[28:29], v[28:29] op_sel:[0,1,1] op_sel_hi:[1,1,1]
    v_pk_fma_f32 v[124:125], v[124:125], v[28:29], v[28:29] op_sel:[0,1,1] op_sel_hi:[1,1,1]
    v_pk_fma_f32 v[126:127], v[126:127], v[28:29], v[28:29] op_sel:[0,1,1] op_sel_hi:[1,1,1]
    v_rcp_f32 v108, v108
    v_rcp_f32 v109, v109
    v_rcp_f32 v110, v110
    v_rcp_f32 v111, v111
    v_rcp_f32 v124, v124
    v_rcp_f32 v125, v125
    v_rcp_f32 v126, v126
    v_rcp_f32 v127, v127
    v_pk_mul_f32 v[140:141], v[140:141], v[108:109]
    v_pk_mul_f32 v[142:143], v[142:143], v[110:111]
    v_pk_mul_f32 v[156:157], v[156:157], v[124:125]
    v_pk_mul_f32 v[158:159], v[158:159], v[126:127]
    v_cvt_pk_bf16_f32 v108, v140, v141
    v_cvt_pk_bf16_f32 v109, v142, v143
    v_cvt_pk_bf16_f32 v110, v156, v157
    v_cvt_pk_bf16_f32 v111, v158, v159
    buffer_store_dwordx4 v[108:111], v5, s[40:43], s51 offen offset:1024
    ds_read_b128 v[8:11], v6 offset:256
    ds_read_b128 v[12:15], v6 offset:768
    s_waitcnt lgkmcnt(1)
    v_pk_fma_f32 v[160:161], v[8:9], v[16:17], v[160:161] op_sel_hi:[1,0,1]
    s_waitcnt lgkmcnt(0)
    v_pk_fma_f32 v[192:193], v[12:13], v[16:17], v[192:193] op_sel_hi:[1,0,1]
    v_pk_fma_f32 v[162:163], v[10:11], v[16:17], v[162:163] op_sel_hi:[1,0,1]
    v_pk_fma_f32 v[194:195], v[14:15], v[16:17], v[194:195] op_sel_hi:[1,0,1]
    v_pk_fma_f32 v[164:165], v[8:9], v[20:21], v[164:165] op_sel_hi:[1,0,1]
    v_pk_fma_f32 v[196:197], v[12:13], v[20:21], v[196:197] op_sel_hi:[1,0,1]
    v_pk_fma_f32 v[166:167], v[10:11], v[20:21], v[166:167] op_sel_hi:[1,0,1]
    v_pk_fma_f32 v[198:199], v[14:15], v[20:21], v[198:199] op_sel_hi:[1,0,1]
    v_pk_fma_f32 v[168:169], v[8:9], v[24:25], v[168:169] op_sel_hi:[1,0,1]
    v_pk_fma_f32 v[200:201], v[12:13], v[24:25], v[200:201] op_sel_hi:[1,0,1]
    v_pk_fma_f32 v[170:171], v[10:11], v[24:25], v[170:171] op_sel_hi:[1,0,1]
    v_pk_fma_f32 v[202:203], v[14:15], v[24:25], v[202:203] op_sel_hi:[1,0,1]
    v_pk_fma_f32 v[172:173], v[8:9], v[28:29], v[172:173] op_sel_hi:[1,0,1]
    v_pk_fma_f32 v[204:205], v[12:13], v[28:29], v[204:205] op_sel_hi:[1,0,1]
    v_pk_fma_f32 v[174:175], v[10:11], v[28:29], v[174:175] op_sel_hi:[1,0,1]
    v_pk_fma_f32 v[206:207], v[14:15], v[28:29], v[206:207] op_sel_hi:[1,0,1]
    ds_read_b128 v[8:11], v6 offset:320
    ds_read_b128 v[12:15], v6 offset:832
    s_waitcnt lgkmcnt(1)
    v_pk_fma_f32 v[176:177], v[8:9], v[16:17], v[176:177] op_sel_hi:[1,0,1]
    s_waitcnt lgkmcnt(0)
    v_pk_fma_f32 v[208:209], v[12:13], v[16:17], v[208:209] op_sel_hi:[1,0,1]
    v_pk_fma_f32 v[178:179], v[10:11], v[16:17], v[178:179] op_sel_hi:[1,0,1]
    v_pk_fma_f32 v[210:211], v[14:15], v[16:17], v[210:211] op_sel_hi:[1,0,1]
    v_pk_fma_f32 v[180:181], v[8:9], v[20:21], v[180:181] op_sel_hi:[1,0,1]
    v_pk_fma_f32 v[212:213], v[12:13], v[20:21], v[212:213] op_sel_hi:[1,0,1]
    v_pk_fma_f32 v[182:183], v[10:11], v[20:21], v[182:183] op_sel_hi:[1,0,1]
    v_pk_fma_f32 v[214:215], v[14:15], v[20:21], v[214:215] op_sel_hi:[1,0,1]
    v_pk_fma_f32 v[184:185], v[8:9], v[24:25], v[184:185] op_sel_hi:[1,0,1]
    v_pk_fma_f32 v[216:217], v[12:13], v[24:25], v[216:217] op_sel_hi:[1,0,1]
    v_pk_fma_f32 v[186:187], v[10:11], v[24:25], v[186:187] op_sel_hi:[1,0,1]
    v_pk_fma_f32 v[218:219], v[14:15], v[24:25], v[218:219] op_sel_hi:[1,0,1]
    v_pk_fma_f32 v[188:189], v[8:9], v[28:29], v[188:189] op_sel_hi:[1,0,1]
    v_pk_fma_f32 v[220:221], v[12:13], v[28:29], v[220:221] op_sel_hi:[1,0,1]
    v_pk_fma_f32 v[190:191], v[10:11], v[28:29], v[190:191] op_sel_hi:[1,0,1]
    v_pk_fma_f32 v[222:223], v[14:15], v[28:29], v[222:223] op_sel_hi:[1,0,1]
    v_pk_mul_f32 v[192:193], v[192:193], v[160:161]
    v_pk_mul_f32 v[160:161], v[160:161], v[18:19] op_sel_hi:[1,0]
    v_pk_mul_f32 v[194:195], v[194:195], v[162:163]
    v_pk_mul_f32 v[162:163], v[162:163], v[18:19] op_sel_hi:[1,0]
    v_pk_mul_f32 v[208:209], v[208:209], v[176:177]
    v_pk_mul_f32 v[176:177], v[176:177], v[18:19] op_sel_hi:[1,0]
    v_pk_mul_f32 v[210:211], v[210:211], v[178:179]
    v_pk_mul_f32 v[178:179], v[178:179], v[18:19] op_sel_hi:[1,0]
    v_exp_f32 v160, v160
    v_exp_f32 v161, v161
    v_exp_f32 v162, v162
    v_exp_f32 v163, v163
    v_exp_f32 v176, v176
    v_exp_f32 v177, v177
    v_exp_f32 v178, v178
    v_exp_f32 v179, v179
    v_pk_fma_f32 v[160:161], v[160:161], v[16:17], v[16:17] op_sel:[0,1,1] op_sel_hi:[1,1,1]
    v_pk_fma_f32 v[162:163], v[162:163], v[16:17], v[16:17] op_sel:[0,1,1] op_sel_hi:[1,1,1]
    v_pk_fma_f32 v[176:177], v[176:177], v[16:17], v[16:17] op_sel:[0,1,1] op_sel_hi:[1,1,1]
    v_pk_fma_f32 v[178:179], v[178:179], v[16:17], v[16:17] op_sel:[0,1,1] op_sel_hi:[1,1,1]
    v_rcp_f32 v160, v160
    v_rcp_f32 v161, v161
    v_rcp_f32 v162, v162
    v_rcp_f32 v163, v163
    v_rcp_f32 v176, v176
    v_rcp_f32 v177, v177
    v_rcp_f32 v178, v178
    v_rcp_f32 v179, v179
    v_pk_mul_f32 v[192:193], v[192:193], v[160:161]
    v_pk_mul_f32 v[194:195], v[194:195], v[162:163]
    v_pk_mul_f32 v[208:209], v[208:209], v[176:177]
    v_pk_mul_f32 v[210:211], v[210:211], v[178:179]
    v_cvt_pk_bf16_f32 v160, v192, v193
    v_cvt_pk_bf16_f32 v161, v194, v195
    v_cvt_pk_bf16_f32 v162, v208, v209
    v_cvt_pk_bf16_f32 v163, v210, v211
    buffer_store_dwordx4 v[160:163], v4, s[40:43], s52 offen offset:0
    v_pk_mul_f32 v[196:197], v[196:197], v[164:165]
    v_pk_mul_f32 v[164:165], v[164:165], v[22:23] op_sel_hi:[1,0]
    v_pk_mul_f32 v[198:199], v[198:199], v[166:167]
    v_pk_mul_f32 v[166:167], v[166:167], v[22:23] op_sel_hi:[1,0]
    v_pk_mul_f32 v[212:213], v[212:213], v[180:181]
    v_pk_mul_f32 v[180:181], v[180:181], v[22:23] op_sel_hi:[1,0]
    v_pk_mul_f32 v[214:215], v[214:215], v[182:183]
    v_pk_mul_f32 v[182:183], v[182:183], v[22:23] op_sel_hi:[1,0]
    v_exp_f32 v164, v164
    v_exp_f32 v165, v165
    v_exp_f32 v166, v166
    v_exp_f32 v167, v167
    v_exp_f32 v180, v180
    v_exp_f32 v181, v181
    v_exp_f32 v182, v182
    v_exp_f32 v183, v183
    v_pk_fma_f32 v[164:165], v[164:165], v[20:21], v[20:21] op_sel:[0,1,1] op_sel_hi:[1,1,1]
    v_pk_fma_f32 v[166:167], v[166:167], v[20:21], v[20:21] op_sel:[0,1,1] op_sel_hi:[1,1,1]
    v_pk_fma_f32 v[180:181], v[180:181], v[20:21], v[20:21] op_sel:[0,1,1] op_sel_hi:[1,1,1]
    v_pk_fma_f32 v[182:183], v[182:183], v[20:21], v[20:21] op_sel:[0,1,1] op_sel_hi:[1,1,1]
    v_rcp_f32 v164, v164
    v_rcp_f32 v165, v165
    v_rcp_f32 v166, v166
    v_rcp_f32 v167, v167
    v_rcp_f32 v180, v180
    v_rcp_f32 v181, v181
    v_rcp_f32 v182, v182
    v_rcp_f32 v183, v183
    v_pk_mul_f32 v[196:197], v[196:197], v[164:165]
    v_pk_mul_f32 v[198:199], v[198:199], v[166:167]
    v_pk_mul_f32 v[212:213], v[212:213], v[180:181]
    v_pk_mul_f32 v[214:215], v[214:215], v[182:183]
    v_cvt_pk_bf16_f32 v164, v196, v197
    v_cvt_pk_bf16_f32 v165, v198, v199
    v_cvt_pk_bf16_f32 v166, v212, v213
    v_cvt_pk_bf16_f32 v167, v214, v215
    buffer_store_dwordx4 v[164:167], v4, s[40:43], s52 offen offset:1024
    v_pk_mul_f32 v[200:201], v[200:201], v[168:169]
    v_pk_mul_f32 v[168:169], v[168:169], v[26:27] op_sel_hi:[1,0]
    v_pk_mul_f32 v[202:203], v[202:203], v[170:171]
    v_pk_mul_f32 v[170:171], v[170:171], v[26:27] op_sel_hi:[1,0]
    v_pk_mul_f32 v[216:217], v[216:217], v[184:185]
    v_pk_mul_f32 v[184:185], v[184:185], v[26:27] op_sel_hi:[1,0]
    v_pk_mul_f32 v[218:219], v[218:219], v[186:187]
    v_pk_mul_f32 v[186:187], v[186:187], v[26:27] op_sel_hi:[1,0]
    v_exp_f32 v168, v168
    v_exp_f32 v169, v169
    v_exp_f32 v170, v170
    v_exp_f32 v171, v171
    v_exp_f32 v184, v184
    v_exp_f32 v185, v185
    v_exp_f32 v186, v186
    v_exp_f32 v187, v187
    v_pk_fma_f32 v[168:169], v[168:169], v[24:25], v[24:25] op_sel:[0,1,1] op_sel_hi:[1,1,1]
    v_pk_fma_f32 v[170:171], v[170:171], v[24:25], v[24:25] op_sel:[0,1,1] op_sel_hi:[1,1,1]
    v_pk_fma_f32 v[184:185], v[184:185], v[24:25], v[24:25] op_sel:[0,1,1] op_sel_hi:[1,1,1]
    v_pk_fma_f32 v[186:187], v[186:187], v[24:25], v[24:25] op_sel:[0,1,1] op_sel_hi:[1,1,1]
    v_rcp_f32 v168, v168
    v_rcp_f32 v169, v169
    v_rcp_f32 v170, v170
    v_rcp_f32 v171, v171
    v_rcp_f32 v184, v184
    v_rcp_f32 v185, v185
    v_rcp_f32 v186, v186
    v_rcp_f32 v187, v187
    v_pk_mul_f32 v[200:201], v[200:201], v[168:169]
    v_pk_mul_f32 v[202:203], v[202:203], v[170:171]
    v_pk_mul_f32 v[216:217], v[216:217], v[184:185]
    v_pk_mul_f32 v[218:219], v[218:219], v[186:187]
    v_cvt_pk_bf16_f32 v168, v200, v201
    v_cvt_pk_bf16_f32 v169, v202, v203
    v_cvt_pk_bf16_f32 v170, v216, v217
    v_cvt_pk_bf16_f32 v171, v218, v219
    buffer_store_dwordx4 v[168:171], v5, s[40:43], s52 offen offset:0
    v_pk_mul_f32 v[204:205], v[204:205], v[172:173]
    v_pk_mul_f32 v[172:173], v[172:173], v[30:31] op_sel_hi:[1,0]
    v_pk_mul_f32 v[206:207], v[206:207], v[174:175]
    v_pk_mul_f32 v[174:175], v[174:175], v[30:31] op_sel_hi:[1,0]
    v_pk_mul_f32 v[220:221], v[220:221], v[188:189]
    v_pk_mul_f32 v[188:189], v[188:189], v[30:31] op_sel_hi:[1,0]
    v_pk_mul_f32 v[222:223], v[222:223], v[190:191]
    v_pk_mul_f32 v[190:191], v[190:191], v[30:31] op_sel_hi:[1,0]
    v_exp_f32 v172, v172
    v_exp_f32 v173, v173
    v_exp_f32 v174, v174
    v_exp_f32 v175, v175
    v_exp_f32 v188, v188
    v_exp_f32 v189, v189
    v_exp_f32 v190, v190
    v_exp_f32 v191, v191
    v_pk_fma_f32 v[172:173], v[172:173], v[28:29], v[28:29] op_sel:[0,1,1] op_sel_hi:[1,1,1]
    v_pk_fma_f32 v[174:175], v[174:175], v[28:29], v[28:29] op_sel:[0,1,1] op_sel_hi:[1,1,1]
    v_pk_fma_f32 v[188:189], v[188:189], v[28:29], v[28:29] op_sel:[0,1,1] op_sel_hi:[1,1,1]
    v_pk_fma_f32 v[190:191], v[190:191], v[28:29], v[28:29] op_sel:[0,1,1] op_sel_hi:[1,1,1]
    v_rcp_f32 v172, v172
    v_rcp_f32 v173, v173
    v_rcp_f32 v174, v174
    v_rcp_f32 v175, v175
    v_rcp_f32 v188, v188
    v_rcp_f32 v189, v189
    v_rcp_f32 v190, v190
    v_rcp_f32 v191, v191
    v_pk_mul_f32 v[204:205], v[204:205], v[172:173]
    v_pk_mul_f32 v[206:207], v[206:207], v[174:175]
    v_pk_mul_f32 v[220:221], v[220:221], v[188:189]
    v_pk_mul_f32 v[222:223], v[222:223], v[190:191]
    v_cvt_pk_bf16_f32 v172, v204, v205
    v_cvt_pk_bf16_f32 v173, v206, v207
    v_cvt_pk_bf16_f32 v174, v220, v221
    v_cvt_pk_bf16_f32 v175, v222, v223
    buffer_store_dwordx4 v[172:175], v5, s[40:43], s52 offen offset:1024
    ds_read_b128 v[8:11], v7 offset:0
    ds_read_b128 v[12:15], v7 offset:512
    s_waitcnt lgkmcnt(1)
    v_pk_fma_f32 v[224:225], v[8:9], v[16:17], v[224:225] op_sel_hi:[1,0,1]
    s_waitcnt lgkmcnt(0)
    v_pk_fma_f32 v[240:241], v[12:13], v[16:17], v[240:241] op_sel_hi:[1,0,1]
    v_pk_fma_f32 v[226:227], v[10:11], v[16:17], v[226:227] op_sel_hi:[1,0,1]
    v_pk_fma_f32 v[242:243], v[14:15], v[16:17], v[242:243] op_sel_hi:[1,0,1]
    v_pk_fma_f32 v[228:229], v[8:9], v[20:21], v[228:229] op_sel_hi:[1,0,1]
    v_pk_fma_f32 v[244:245], v[12:13], v[20:21], v[244:245] op_sel_hi:[1,0,1]
    v_pk_fma_f32 v[230:231], v[10:11], v[20:21], v[230:231] op_sel_hi:[1,0,1]
    v_pk_fma_f32 v[246:247], v[14:15], v[20:21], v[246:247] op_sel_hi:[1,0,1]
    ds_read_b128 v[8:11], v7 offset:64
    ds_read_b128 v[12:15], v7 offset:576
    s_waitcnt lgkmcnt(1)
    v_pk_fma_f32 v[232:233], v[8:9], v[16:17], v[232:233] op_sel_hi:[1,0,1]
    s_waitcnt lgkmcnt(0)
    v_pk_fma_f32 v[248:249], v[12:13], v[16:17], v[248:249] op_sel_hi:[1,0,1]
    v_pk_fma_f32 v[234:235], v[10:11], v[16:17], v[234:235] op_sel_hi:[1,0,1]
    v_pk_fma_f32 v[250:251], v[14:15], v[16:17], v[250:251] op_sel_hi:[1,0,1]
    v_pk_fma_f32 v[236:237], v[8:9], v[20:21], v[236:237] op_sel_hi:[1,0,1]
    v_pk_fma_f32 v[252:253], v[12:13], v[20:21], v[252:253] op_sel_hi:[1,0,1]
    v_pk_fma_f32 v[238:239], v[10:11], v[20:21], v[238:239] op_sel_hi:[1,0,1]
    v_pk_fma_f32 v[254:255], v[14:15], v[20:21], v[254:255] op_sel_hi:[1,0,1]
    v_pk_mul_f32 v[240:241], v[240:241], v[224:225]
    v_pk_mul_f32 v[224:225], v[224:225], v[18:19] op_sel_hi:[1,0]
    v_pk_mul_f32 v[242:243], v[242:243], v[226:227]
    v_pk_mul_f32 v[226:227], v[226:227], v[18:19] op_sel_hi:[1,0]
    v_pk_mul_f32 v[248:249], v[248:249], v[232:233]
    v_pk_mul_f32 v[232:233], v[232:233], v[18:19] op_sel_hi:[1,0]
    v_pk_mul_f32 v[250:251], v[250:251], v[234:235]
    v_pk_mul_f32 v[234:235], v[234:235], v[18:19] op_sel_hi:[1,0]
    v_exp_f32 v224, v224
    v_exp_f32 v225, v225
    v_exp_f32 v226, v226
    v_exp_f32 v227, v227
    v_exp_f32 v232, v232
    v_exp_f32 v233, v233
    v_exp_f32 v234, v234
    v_exp_f32 v235, v235
    v_pk_fma_f32 v[224:225], v[224:225], v[16:17], v[16:17] op_sel:[0,1,1] op_sel_hi:[1,1,1]
    v_pk_fma_f32 v[226:227], v[226:227], v[16:17], v[16:17] op_sel:[0,1,1] op_sel_hi:[1,1,1]
    v_pk_fma_f32 v[232:233], v[232:233], v[16:17], v[16:17] op_sel:[0,1,1] op_sel_hi:[1,1,1]
    v_pk_fma_f32 v[234:235], v[234:235], v[16:17], v[16:17] op_sel:[0,1,1] op_sel_hi:[1,1,1]
    v_rcp_f32 v224, v224
    v_rcp_f32 v225, v225
    v_rcp_f32 v226, v226
    v_rcp_f32 v227, v227
    v_rcp_f32 v232, v232
    v_rcp_f32 v233, v233
    v_rcp_f32 v234, v234
    v_rcp_f32 v235, v235
    v_pk_mul_f32 v[240:241], v[240:241], v[224:225]
    v_pk_mul_f32 v[242:243], v[242:243], v[226:227]
    v_pk_mul_f32 v[248:249], v[248:249], v[232:233]
    v_pk_mul_f32 v[250:251], v[250:251], v[234:235]
    v_cvt_pk_bf16_f32 v224, v240, v241
    v_cvt_pk_bf16_f32 v225, v242, v243
    v_cvt_pk_bf16_f32 v226, v248, v249
    v_cvt_pk_bf16_f32 v227, v250, v251
    buffer_store_dwordx4 v[224:227], v4, s[40:43], s53 offen offset:0
    v_pk_mul_f32 v[244:245], v[244:245], v[228:229]
    v_pk_mul_f32 v[228:229], v[228:229], v[22:23] op_sel_hi:[1,0]
    v_pk_mul_f32 v[246:247], v[246:247], v[230:231]
    v_pk_mul_f32 v[230:231], v[230:231], v[22:23] op_sel_hi:[1,0]
    v_pk_mul_f32 v[252:253], v[252:253], v[236:237]
    v_pk_mul_f32 v[236:237], v[236:237], v[22:23] op_sel_hi:[1,0]
    v_pk_mul_f32 v[254:255], v[254:255], v[238:239]
    v_pk_mul_f32 v[238:239], v[238:239], v[22:23] op_sel_hi:[1,0]
    v_exp_f32 v228, v228
    v_exp_f32 v229, v229
    v_exp_f32 v230, v230
    v_exp_f32 v231, v231
    v_exp_f32 v236, v236
    v_exp_f32 v237, v237
    v_exp_f32 v238, v238
    v_exp_f32 v239, v239
    v_pk_fma_f32 v[228:229], v[228:229], v[20:21], v[20:21] op_sel:[0,1,1] op_sel_hi:[1,1,1]
    v_pk_fma_f32 v[230:231], v[230:231], v[20:21], v[20:21] op_sel:[0,1,1] op_sel_hi:[1,1,1]
    v_pk_fma_f32 v[236:237], v[236:237], v[20:21], v[20:21] op_sel:[0,1,1] op_sel_hi:[1,1,1]
    v_pk_fma_f32 v[238:239], v[238:239], v[20:21], v[20:21] op_sel:[0,1,1] op_sel_hi:[1,1,1]
    v_rcp_f32 v228, v228
    v_rcp_f32 v229, v229
    v_rcp_f32 v230, v230
    v_rcp_f32 v231, v231
    v_rcp_f32 v236, v236
    v_rcp_f32 v237, v237
    v_rcp_f32 v238, v238
    v_rcp_f32 v239, v239
    v_pk_mul_f32 v[244:245], v[244:245], v[228:229]
    v_pk_mul_f32 v[246:247], v[246:247], v[230:231]
    v_pk_mul_f32 v[252:253], v[252:253], v[236:237]
    v_pk_mul_f32 v[254:255], v[254:255], v[238:239]
    v_cvt_pk_bf16_f32 v228, v244, v245
    v_cvt_pk_bf16_f32 v229, v246, v247
    v_cvt_pk_bf16_f32 v230, v252, v253
    v_cvt_pk_bf16_f32 v231, v254, v255
    buffer_store_dwordx4 v[228:231], v4, s[40:43], s53 offen offset:1024
gu1_kernel_end:
    s_endpgm
.text
.globl dn1_kernel
.p2align 8
.type dn1_kernel,@function
dn1_kernel:
    s_cmp_ge_u32 s2, 256
    s_cbranch_scc1 dn1_kernel_end
    s_load_dwordx2 s[10:11], s[0:1], 72
    s_load_dwordx2 s[12:13], s[0:1], 48
    v_lshrrev_b32 v2, 6, v0
    v_and_b32 v1, 63, v0
    v_readfirstlane_b32 s3, v2
    s_and_b32 s4, s2, 7
    s_lshr_b32 s5, s2, 3
    s_lshr_b32 s6, s4, 1
    s_lshl_b32 s6, s6, 2
    s_and_b32 s7, s5, 3
    s_add_u32 s6, s6, s7
    s_and_b32 s7, s4, 1
    s_lshl_b32 s7, s7, 3
    s_lshr_b32 s8, s5, 2
    s_add_u32 s7, s7, s8
    s_lshl_b32 s20, s6, 13
    s_lshl_b32 s21, s3, 11
    s_add_u32 s20, s20, s21
    v_lshl_add_u32 v4, v1, 4, s20
    v_bfe_u32 v8, v1, 3, 1
    v_lshrrev_b32 v9, 4, v1
    v_lshl_add_u32 v8, v9, 3, v8
    s_lshl_b32 s21, s3, 1
    v_add_u32 v8, s21, v8
    v_lshlrev_b32 v8, 11, v8
    v_and_b32 v9, 7, v1
    v_lshl_add_u32 v8, v9, 4, v8
    s_lshl_b32 s21, s7, 7
    v_add_u32 v5, s21, v8
    v_add_u32 v6, 64512, v5
    v_bfe_u32 v8, v1, 3, 2
    v_mul_u32_u24 v8, 2080, v8
    v_bfe_u32 v9, v1, 2, 1
    v_lshl_add_u32 v8, v9, 7, v8
    v_bfe_u32 v9, v1, 5, 1
    v_lshl_add_u32 v8, v9, 8, v8
    v_and_b32 v9, 3, v1
    v_lshl_add_u32 v7, v9, 3, v8
    s_mul_i32 s22, s3, 2080
    s_mov_b32 s23, 0
    s_mov_b32 s24, 0x20000
    s_mov_b32 s25, 0
    s_waitcnt lgkmcnt(0)
    s_add_u32 s28, s10, 25165824
    s_addc_u32 s29, s11, 0
    s_mov_b32 s30, 14680064
    s_mov_b32 s31, 0x20000
    s_mov_b32 s32, s12
    s_mov_b32 s33, s13
    s_mov_b32 s34, 7340032
    s_mov_b32 s35, 0x20000
    s_add_u32 m0, s22, 0
    s_nop 0
    buffer_load_dwordx4 v5, s[32:35], s25 offen lds
    buffer_load_dwordx4 v6, s[32:35], s25 offen offset:1024 lds
    s_add_u32 s25, s25, 0x20000
    buffer_load_dwordx4 v[48:51], v4, s[28:31], s23 offen offset:0
    buffer_load_dwordx4 v[52:55], v4, s[28:31], s23 offen offset:1024
    s_add_u32 s23, s23, 0x40000
    buffer_load_dwordx4 v[56:59], v4, s[28:31], s24 offen offset:0
    buffer_load_dwordx4 v[60:63], v4, s[28:31], s24 offen offset:1024
    s_add_u32 s24, s24, 0x40000
    s_add_u32 m0, s22, 8320
    s_nop 0
    buffer_load_dwordx4 v5, s[32:35], s25 offen lds
    buffer_load_dwordx4 v6, s[32:35], s25 offen offset:1024 lds
    s_add_u32 s25, s25, 0x20000
    buffer_load_dwordx4 v[64:67], v4, s[28:31], s23 offen offset:0
    buffer_load_dwordx4 v[68:71], v4, s[28:31], s23 offen offset:1024
    s_add_u32 s23, s23, 0x40000
    buffer_load_dwordx4 v[72:75], v4, s[28:31], s24 offen offset:0
    buffer_load_dwordx4 v[76:79], v4, s[28:31], s24 offen offset:1024
    s_add_u32 s24, s24, 0x40000
    s_add_u32 m0, s22, 16640
    s_nop 0
    buffer_load_dwordx4 v5, s[32:35], s25 offen lds
    buffer_load_dwordx4 v6, s[32:35], s25 offen offset:1024 lds
    s_add_u32 s25, s25, 0x20000
    buffer_load_dwordx4 v[80:83], v4, s[28:31], s23 offen offset:0
    buffer_load_dwordx4 v[84:87], v4, s[28:31], s23 offen offset:1024
    s_add_u32 s23, s23, 0x40000
    buffer_load_dwordx4 v[88:91], v4, s[28:31], s24 offen offset:0
    buffer_load_dwordx4 v[92:95], v4, s[28:31], s24 offen offset:1024
    s_add_u32 s24, s24, 0x40000
    s_add_u32 m0, s22, 24960
    s_nop 0
    buffer_load_dwordx4 v5, s[32:35], s25 offen lds
    buffer_load_dwordx4 v6, s[32:35], s25 offen offset:1024 lds
    s_add_u32 s25, s25, 0x20000
    buffer_load_dwordx4 v[96:99], v4, s[28:31], s23 offen offset:0
    buffer_load_dwordx4 v[100:103], v4, s[28:31], s23 offen offset:1024
    s_add_u32 s23, s23, 0x40000
    buffer_load_dwordx4 v[104:107], v4, s[28:31], s24 offen offset:0
    buffer_load_dwordx4 v[108:111], v4, s[28:31], s24 offen offset:1024
    s_add_u32 s24, s24, 0x40000
    s_add_u32 m0, s22, 33280
    s_nop 0
    buffer_load_dwordx4 v5, s[32:35], s25 offen lds
    buffer_load_dwordx4 v6, s[32:35], s25 offen offset:1024 lds
    s_add_u32 s25, s25, 0x20000
    buffer_load_dwordx4 v[112:115], v4, s[28:31], s23 offen offset:0
    buffer_load_dwordx4 v[116:119], v4, s[28:31], s23 offen offset:1024
    s_add_u32 s23, s23, 0x40000
    buffer_load_dwordx4 v[120:123], v4, s[28:31], s24 offen offset:0
    buffer_load_dwordx4 v[124:127], v4, s[28:31], s24 offen offset:1024
    s_add_u32 s24, s24, 0x40000
    s_add_u32 m0, s22, 41600
    s_nop 0
    buffer_load_dwordx4 v5, s[32:35], s25 offen lds
    buffer_load_dwordx4 v6, s[32:35], s25 offen offset:1024 lds
    s_add_u32 s25, s25, 0x20000
    buffer_load_dwordx4 v[128:131], v4, s[28:31], s23 offen offset:0
    buffer_load_dwordx4 v[132:135], v4, s[28:31], s23 offen offset:1024
    s_add_u32 s23, s23, 0x40000
    buffer_load_dwordx4 v[136:139], v4, s[28:31], s24 offen offset:0
    buffer_load_dwordx4 v[140:143], v4, s[28:31], s24 offen offset:1024
    s_add_u32 s24, s24, 0x40000
    s_add_u32 m0, s22, 49920
    s_nop 0
    buffer_load_dwordx4 v5, s[32:35], s25 offen lds
    buffer_load_dwordx4 v6, s[32:35], s25 offen offset:1024 lds
    s_add_u32 s25, s25, 0x20000
    buffer_load_dwordx4 v[144:147], v4, s[28:31], s23 offen offset:0
    buffer_load_dwordx4 v[148:151], v4, s[28:31], s23 offen offset:1024
    s_add_u32 s23, s23, 0x40000
    buffer_load_dwordx4 v[152:155], v4, s[28:31], s24 offen offset:0
    buffer_load_dwordx4 v[156:159], v4, s[28:31], s24 offen offset:1024
    s_add_u32 s24, s24, 0x40000
    s_add_u32 m0, s22, 58240
    s_nop 0
    buffer_load_dwordx4 v5, s[32:35], s25 offen lds
    buffer_load_dwordx4 v6, s[32:35], s25 offen offset:1024 lds
    s_add_u32 s25, s25, 0x20000
    v_mov_b32 v16, 0
    v_mov_b32 v17, 0
    v_mov_b32 v18, 0
    v_mov_b32 v19, 0
    v_mov_b32 v20, 0
    v_mov_b32 v21, 0
    v_mov_b32 v22, 0
    v_mov_b32 v23, 0
    v_mov_b32 v24, 0
    v_mov_b32 v25, 0
    v_mov_b32 v26, 0
    v_mov_b32 v27, 0
    v_mov_b32 v28, 0
    v_mov_b32 v29, 0
    v_mov_b32 v30, 0
    v_mov_b32 v31, 0
    v_mov_b32 v32, 0
    v_mov_b32 v33, 0
    v_mov_b32 v34, 0
    v_mov_b32 v35, 0
    v_mov_b32 v36, 0
    v_mov_b32 v37, 0
    v_mov_b32 v38, 0
    v_mov_b32 v39, 0
    v_mov_b32 v40, 0
    v_mov_b32 v41, 0
    v_mov_b32 v42, 0
    v_mov_b32 v43, 0
    v_mov_b32 v44, 0
    v_mov_b32 v45, 0
    v_mov_b32 v46, 0
    v_mov_b32 v47, 0
    s_add_u32 s36, s10, 8388608
    s_addc_u32 s37, s11, 0
    s_mov_b32 s38, 4194304
    s_mov_b32 s39, 0x20000
    s_lshl_b32 s26, s7, 18
    s_add_u32 s27, s26, 0x20000
    s_add_u32 s40, s10, 12582912
    s_addc_u32 s41, s11, 0
    s_mov_b32 s42, 4194304
    s_mov_b32 s43, 0x20000
    s_add_u32 s44, s10, 59244544
    s_addc_u32 s45, s11, 0
    s_mov_b32 s46, 262144
    s_mov_b32 s47, 0x20000
    s_waitcnt vmcnt(42)
    s_barrier
    ds_read_b64_tr_b16 a[0:1], v7 offset:0
    ds_read_b64_tr_b16 a[2:3], v7 offset:512
    ds_read_b64_tr_b16 a[4:5], v7 offset:32
    ds_read_b64_tr_b16 a[6:7], v7 offset:544
    ds_read_b64_tr_b16 a[8:9], v7 offset:64
    ds_read_b64_tr_b16 a[10:11], v7 offset:576
    ds_read_b64_tr_b16 a[12:13], v7 offset:96
    ds_read_b64_tr_b16 a[14:15], v7 offset:608
    ds_read_b64_tr_b16 a[16:17], v7 offset:1024
    ds_read_b64_tr_b16 a[18:19], v7 offset:1536
    ds_read_b64_tr_b16 a[20:21], v7 offset:1056
    ds_read_b64_tr_b16 a[22:23], v7 offset:1568
    ds_read_b64_tr_b16 a[24:25], v7 offset:1088
    ds_read_b64_tr_b16 a[26:27], v7 offset:1600
    ds_read_b64_tr_b16 a[28:29], v7 offset:1120
    ds_read_b64_tr_b16 a[30:31], v7 offset:1632
    s_mov_b32 s48, 6
.p2align 6
dn1_kernel_loop:
    s_waitcnt lgkmcnt(0)
    s_waitcnt vmcnt(36)
    s_barrier
    v_mfma_f32_16x16x32_bf16 v[16:19], a[0:3], v[48:51], v[16:19]
    ds_read_b64_tr_b16 a[32:33], v7 offset:8320
    ds_read_b64_tr_b16 a[34:35], v7 offset:8832
    s_add_u32 m0, s22, 0
    s_nop 0
    buffer_load_dwordx4 v5, s[32:35], s25 offen lds
    v_mfma_f32_16x16x32_bf16 v[32:35], a[0:3], v[52:55], v[32:35]
    ds_read_b64_tr_b16 a[36:37], v7 offset:8352
    v_mfma_f32_16x16x32_bf16 v[20:23], a[4:7], v[48:51], v[20:23]
    ds_read_b64_tr_b16 a[38:39], v7 offset:8864
    buffer_load_dwordx4 v[160:163], v4, s[28:31], s23 offen offset:0
    v_mfma_f32_16x16x32_bf16 v[36:39], a[4:7], v[52:55], v[36:39]
    ds_read_b64_tr_b16 a[40:41], v7 offset:8384
    v_mfma_f32_16x16x32_bf16 v[24:27], a[8:11], v[48:51], v[24:27]
    ds_read_b64_tr_b16 a[42:43], v7 offset:8896
    ds_read_b64_tr_b16 a[44:45], v7 offset:8416
    v_mfma_f32_16x16x32_bf16 v[40:43], a[8:11], v[52:55], v[40:43]
    ds_read_b64_tr_b16 a[46:47], v7 offset:8928
    buffer_load_dwordx4 v[164:167], v4, s[28:31], s23 offen offset:1024
    s_add_u32 s23, s23, 0x40000
    v_mfma_f32_16x16x32_bf16 v[28:31], a[12:15], v[48:51], v[28:31]
    ds_read_b64_tr_b16 a[48:49], v7 offset:9344
    v_mfma_f32_16x16x32_bf16 v[44:47], a[12:15], v[52:55], v[44:47]
    ds_read_b64_tr_b16 a[50:51], v7 offset:9856
    v_mfma_f32_16x16x32_bf16 v[16:19], a[16:19], v[56:59], v[16:19]
    ds_read_b64_tr_b16 a[52:53], v7 offset:9376
    ds_read_b64_tr_b16 a[54:55], v7 offset:9888
    buffer_load_dwordx4 v6, s[32:35], s25 offen offset:1024 lds
    s_add_u32 s25, s25, 0x20000
    v_mfma_f32_16x16x32_bf16 v[32:35], a[16:19], v[60:63], v[32:35]
    ds_read_b64_tr_b16 a[56:57], v7 offset:9408
    v_mfma_f32_16x16x32_bf16 v[20:23], a[20:23], v[56:59], v[20:23]
    ds_read_b64_tr_b16 a[58:59], v7 offset:9920
    buffer_load_dwordx4 v[168:171], v4, s[28:31], s24 offen offset:0
    v_mfma_f32_16x16x32_bf16 v[36:39], a[20:23], v[60:63], v[36:39]
    ds_read_b64_tr_b16 a[60:61], v7 offset:9440
    v_mfma_f32_16x16x32_bf16 v[24:27], a[24:27], v[56:59], v[24:27]
    ds_read_b64_tr_b16 a[62:63], v7 offset:9952
    v_mfma_f32_16x16x32_bf16 v[40:43], a[24:27], v[60:63], v[40:43]
    buffer_load_dwordx4 v[172:175], v4, s[28:31], s24 offen offset:1024
    s_add_u32 s24, s24, 0x40000
    v_mfma_f32_16x16x32_bf16 v[28:31], a[28:31], v[56:59], v[28:31]
    v_mfma_f32_16x16x32_bf16 v[44:47], a[28:31], v[60:63], v[44:47]
    s_waitcnt lgkmcnt(0)
    s_waitcnt vmcnt(36)
    s_barrier
    v_mfma_f32_16x16x32_bf16 v[16:19], a[32:35], v[64:67], v[16:19]
    ds_read_b64_tr_b16 a[0:1], v7 offset:16640
    ds_read_b64_tr_b16 a[2:3], v7 offset:17152
    s_add_u32 m0, s22, 8320
    s_nop 0
    buffer_load_dwordx4 v5, s[32:35], s25 offen lds
    v_mfma_f32_16x16x32_bf16 v[32:35], a[32:35], v[68:71], v[32:35]
    ds_read_b64_tr_b16 a[4:5], v7 offset:16672
    v_mfma_f32_16x16x32_bf16 v[20:23], a[36:39], v[64:67], v[20:23]
    ds_read_b64_tr_b16 a[6:7], v7 offset:17184
    buffer_load_dwordx4 v[48:51], v4, s[28:31], s23 offen offset:0
    v_mfma_f32_16x16x32_bf16 v[36:39], a[36:39], v[68:71], v[36:39]
    ds_read_b64_tr_b16 a[8:9], v7 offset:16704
    v_mfma_f32_16x16x32_bf16 v[24:27], a[40:43], v[64:67], v[24:27]
    ds_read_b64_tr_b16 a[10:11], v7 offset:17216
    ds_read_b64_tr_b16 a[12:13], v7 offset:16736
    v_mfma_f32_16x16x32_bf16 v[40:43], a[40:43], v[68:71], v[40:43]
    ds_read_b64_tr_b16 a[14:15], v7 offset:17248
    buffer_load_dwordx4 v[52:55], v4, s[28:31], s23 offen offset:1024
    s_add_u32 s23, s23, 0x40000
    v_mfma_f32_16x16x32_bf16 v[28:31], a[44:47], v[64:67], v[28:31]
    ds_read_b64_tr_b16 a[16:17], v7 offset:17664
    v_mfma_f32_16x16x32_bf16 v[44:47], a[44:47], v[68:71], v[44:47]
    ds_read_b64_tr_b16 a[18:19], v7 offset:18176
    v_mfma_f32_16x16x32_bf16 v[16:19], a[48:51], v[72:75], v[16:19]
    ds_read_b64_tr_b16 a[20:21], v7 offset:17696
    ds_read_b64_tr_b16 a[22:23], v7 offset:18208
    buffer_load_dwordx4 v6, s[32:35], s25 offen offset:1024 lds
    s_add_u32 s25, s25, 0x20000
    v_mfma_f32_16x16x32_bf16 v[32:35], a[48:51], v[76:79], v[32:35]
    ds_read_b64_tr_b16 a[24:25], v7 offset:17728
    v_mfma_f32_16x16x32_bf16 v[20:23], a[52:55], v[72:75], v[20:23]
    ds_read_b64_tr_b16 a[26:27], v7 offset:18240
    buffer_load_dwordx4 v[56:59], v4, s[28:31], s24 offen offset:0
    v_mfma_f32_16x16x32_bf16 v[36:39], a[52:55], v[76:79], v[36:39]
    ds_read_b64_tr_b16 a[28:29], v7 offset:17760
    v_mfma_f32_16x16x32_bf16 v[24:27], a[56:59], v[72:75], v[24:27]
    ds_read_b64_tr_b16 a[30:31], v7 offset:18272
    v_mfma_f32_16x16x32_bf16 v[40:43], a[56:59], v[76:79], v[40:43]
    buffer_load_dwordx4 v[60:63], v4, s[28:31], s24 offen offset:1024
    s_add_u32 s24, s24, 0x40000
    v_mfma_f32_16x16x32_bf16 v[28:31], a[60:63], v[72:75], v[28:31]
    v_mfma_f32_16x16x32_bf16 v[44:47], a[60:63], v[76:79], v[44:47]
    s_waitcnt lgkmcnt(0)
    s_waitcnt vmcnt(36)
    s_barrier
    v_mfma_f32_16x16x32_bf16 v[16:19], a[0:3], v[80:83], v[16:19]
    ds_read_b64_tr_b16 a[32:33], v7 offset:24960
    ds_read_b64_tr_b16 a[34:35], v7 offset:25472
    s_add_u32 m0, s22, 16640
    s_nop 0
    buffer_load_dwordx4 v5, s[32:35], s25 offen lds
    v_mfma_f32_16x16x32_bf16 v[32:35], a[0:3], v[84:87], v[32:35]
    ds_read_b64_tr_b16 a[36:37], v7 offset:24992
    v_mfma_f32_16x16x32_bf16 v[20:23], a[4:7], v[80:83], v[20:23]
    ds_read_b64_tr_b16 a[38:39], v7 offset:25504
    buffer_load_dwordx4 v[64:67], v4, s[28:31], s23 offen offset:0
    v_mfma_f32_16x16x32_bf16 v[36:39], a[4:7], v[84:87], v[36:39]
    ds_read_b64_tr_b16 a[40:41], v7 offset:25024
    v_mfma_f32_16x16x32_bf16 v[24:27], a[8:11], v[80:83], v[24:27]
    ds_read_b64_tr_b16 a[42:43], v7 offset:25536
    ds_read_b64_tr_b16 a[44:45], v7 offset:25056
    v_mfma_f32_16x16x32_bf16 v[40:43], a[8:11], v[84:87], v[40:43]
    ds_read_b64_tr_b16 a[46:47], v7 offset:25568
    buffer_load_dwordx4 v[68:71], v4, s[28:31], s23 offen offset:1024
    s_add_u32 s23, s23, 0x40000
    v_mfma_f32_16x16x32_bf16 v[28:31], a[12:15], v[80:83], v[28:31]
    ds_read_b64_tr_b16 a[48:49], v7 offset:25984
    v_mfma_f32_16x16x32_bf16 v[44:47], a[12:15], v[84:87], v[44:47]
    ds_read_b64_tr_b16 a[50:51], v7 offset:26496
    v_mfma_f32_16x16x32_bf16 v[16:19], a[16:19], v[88:91], v[16:19]
    ds_read_b64_tr_b16 a[52:53], v7 offset:26016
    ds_read_b64_tr_b16 a[54:55], v7 offset:26528
    buffer_load_dwordx4 v6, s[32:35], s25 offen offset:1024 lds
    s_add_u32 s25, s25, 0x20000
    v_mfma_f32_16x16x32_bf16 v[32:35], a[16:19], v[92:95], v[32:35]
    ds_read_b64_tr_b16 a[56:57], v7 offset:26048
    v_mfma_f32_16x16x32_bf16 v[20:23], a[20:23], v[88:91], v[20:23]
    ds_read_b64_tr_b16 a[58:59], v7 offset:26560
    buffer_load_dwordx4 v[72:75], v4, s[28:31], s24 offen offset:0
    v_mfma_f32_16x16x32_bf16 v[36:39], a[20:23], v[92:95], v[36:39]
    ds_read_b64_tr_b16 a[60:61], v7 offset:26080
    v_mfma_f32_16x16x32_bf16 v[24:27], a[24:27], v[88:91], v[24:27]
    ds_read_b64_tr_b16 a[62:63], v7 offset:26592
    v_mfma_f32_16x16x32_bf16 v[40:43], a[24:27], v[92:95], v[40:43]
    buffer_load_dwordx4 v[76:79], v4, s[28:31], s24 offen offset:1024
    s_add_u32 s24, s24, 0x40000
    v_mfma_f32_16x16x32_bf16 v[28:31], a[28:31], v[88:91], v[28:31]
    v_mfma_f32_16x16x32_bf16 v[44:47], a[28:31], v[92:95], v[44:47]
    s_waitcnt lgkmcnt(0)
    s_waitcnt vmcnt(36)
    s_barrier
    v_mfma_f32_16x16x32_bf16 v[16:19], a[32:35], v[96:99], v[16:19]
    ds_read_b64_tr_b16 a[0:1], v7 offset:33280
    ds_read_b64_tr_b16 a[2:3], v7 offset:33792
    s_add_u32 m0, s22, 24960
    s_nop 0
    buffer_load_dwordx4 v5, s[32:35], s25 offen lds
    v_mfma_f32_16x16x32_bf16 v[32:35], a[32:35], v[100:103], v[32:35]
    ds_read_b64_tr_b16 a[4:5], v7 offset:33312
    v_mfma_f32_16x16x32_bf16 v[20:23], a[36:39], v[96:99], v[20:23]
    ds_read_b64_tr_b16 a[6:7], v7 offset:33824
    buffer_load_dwordx4 v[80:83], v4, s[28:31], s23 offen offset:0
    v_mfma_f32_16x16x32_bf16 v[36:39], a[36:39], v[100:103], v[36:39]
    ds_read_b64_tr_b16 a[8:9], v7 offset:33344
    v_mfma_f32_16x16x32_bf16 v[24:27], a[40:43], v[96:99], v[24:27]
    ds_read_b64_tr_b16 a[10:11], v7 offset:33856
    ds_read_b64_tr_b16 a[12:13], v7 offset:33376
    v_mfma_f32_16x16x32_bf16 v[40:43], a[40:43], v[100:103], v[40:43]
    ds_read_b64_tr_b16 a[14:15], v7 offset:33888
    buffer_load_dwordx4 v[84:87], v4, s[28:31], s23 offen offset:1024
    s_add_u32 s23, s23, 0x40000
    v_mfma_f32_16x16x32_bf16 v[28:31], a[44:47], v[96:99], v[28:31]
    ds_read_b64_tr_b16 a[16:17], v7 offset:34304
    v_mfma_f32_16x16x32_bf16 v[44:47], a[44:47], v[100:103], v[44:47]
    ds_read_b64_tr_b16 a[18:19], v7 offset:34816
    v_mfma_f32_16x16x32_bf16 v[16:19], a[48:51], v[104:107], v[16:19]
    ds_read_b64_tr_b16 a[20:21], v7 offset:34336
    ds_read_b64_tr_b16 a[22:23], v7 offset:34848
    buffer_load_dwordx4 v6, s[32:35], s25 offen offset:1024 lds
    s_add_u32 s25, s25, 0x20000
    v_mfma_f32_16x16x32_bf16 v[32:35], a[48:51], v[108:111], v[32:35]
    ds_read_b64_tr_b16 a[24:25], v7 offset:34368
    v_mfma_f32_16x16x32_bf16 v[20:23], a[52:55], v[104:107], v[20:23]
    ds_read_b64_tr_b16 a[26:27], v7 offset:34880
    buffer_load_dwordx4 v[88:91], v4, s[28:31], s24 offen offset:0
    v_mfma_f32_16x16x32_bf16 v[36:39], a[52:55], v[108:111], v[36:39]
    ds_read_b64_tr_b16 a[28:29], v7 offset:34400
    v_mfma_f32_16x16x32_bf16 v[24:27], a[56:59], v[104:107], v[24:27]
    ds_read_b64_tr_b16 a[30:31], v7 offset:34912
    v_mfma_f32_16x16x32_bf16 v[40:43], a[56:59], v[108:111], v[40:43]
    buffer_load_dwordx4 v[92:95], v4, s[28:31], s24 offen offset:1024
    s_add_u32 s24, s24, 0x40000
    v_mfma_f32_16x16x32_bf16 v[28:31], a[60:63], v[104:107], v[28:31]
    v_mfma_f32_16x16x32_bf16 v[44:47], a[60:63], v[108:111], v[44:47]
    s_waitcnt lgkmcnt(0)
    s_waitcnt vmcnt(36)
    s_barrier
    v_mfma_f32_16x16x32_bf16 v[16:19], a[0:3], v[112:115], v[16:19]
    ds_read_b64_tr_b16 a[32:33], v7 offset:41600
    ds_read_b64_tr_b16 a[34:35], v7 offset:42112
    s_add_u32 m0, s22, 33280
    s_nop 0
    buffer_load_dwordx4 v5, s[32:35], s25 offen lds
    v_mfma_f32_16x16x32_bf16 v[32:35], a[0:3], v[116:119], v[32:35]
    ds_read_b64_tr_b16 a[36:37], v7 offset:41632
    v_mfma_f32_16x16x32_bf16 v[20:23], a[4:7], v[112:115], v[20:23]
    ds_read_b64_tr_b16 a[38:39], v7 offset:42144
    buffer_load_dwordx4 v[96:99], v4, s[28:31], s23 offen offset:0
    v_mfma_f32_16x16x32_bf16 v[36:39], a[4:7], v[116:119], v[36:39]
    ds_read_b64_tr_b16 a[40:41], v7 offset:41664
    v_mfma_f32_16x16x32_bf16 v[24:27], a[8:11], v[112:115], v[24:27]
    ds_read_b64_tr_b16 a[42:43], v7 offset:42176
    ds_read_b64_tr_b16 a[44:45], v7 offset:41696
    v_mfma_f32_16x16x32_bf16 v[40:43], a[8:11], v[116:119], v[40:43]
    ds_read_b64_tr_b16 a[46:47], v7 offset:42208
    buffer_load_dwordx4 v[100:103], v4, s[28:31], s23 offen offset:1024
    s_add_u32 s23, s23, 0x40000
    v_mfma_f32_16x16x32_bf16 v[28:31], a[12:15], v[112:115], v[28:31]
    ds_read_b64_tr_b16 a[48:49], v7 offset:42624
    v_mfma_f32_16x16x32_bf16 v[44:47], a[12:15], v[116:119], v[44:47]
    ds_read_b64_tr_b16 a[50:51], v7 offset:43136
    v_mfma_f32_16x16x32_bf16 v[16:19], a[16:19], v[120:123], v[16:19]
    ds_read_b64_tr_b16 a[52:53], v7 offset:42656
    ds_read_b64_tr_b16 a[54:55], v7 offset:43168
    buffer_load_dwordx4 v6, s[32:35], s25 offen offset:1024 lds
    s_add_u32 s25, s25, 0x20000
    v_mfma_f32_16x16x32_bf16 v[32:35], a[16:19], v[124:127], v[32:35]
    ds_read_b64_tr_b16 a[56:57], v7 offset:42688
    v_mfma_f32_16x16x32_bf16 v[20:23], a[20:23], v[120:123], v[20:23]
    ds_read_b64_tr_b16 a[58:59], v7 offset:43200
    buffer_load_dwordx4 v[104:107], v4, s[28:31], s24 offen offset:0
    v_mfma_f32_16x16x32_bf16 v[36:39], a[20:23], v[124:127], v[36:39]
    ds_read_b64_tr_b16 a[60:61], v7 offset:42720
    v_mfma_f32_16x16x32_bf16 v[24:27], a[24:27], v[120:123], v[24:27]
    ds_read_b64_tr_b16 a[62:63], v7 offset:43232
    v_mfma_f32_16x16x32_bf16 v[40:43], a[24:27], v[124:127], v[40:43]
    buffer_load_dwordx4 v[108:111], v4, s[28:31], s24 offen offset:1024
    s_add_u32 s24, s24, 0x40000
    v_mfma_f32_16x16x32_bf16 v[28:31], a[28:31], v[120:123], v[28:31]
    v_mfma_f32_16x16x32_bf16 v[44:47], a[28:31], v[124:127], v[44:47]
    s_waitcnt lgkmcnt(0)
    s_waitcnt vmcnt(36)
    s_barrier
    v_mfma_f32_16x16x32_bf16 v[16:19], a[32:35], v[128:131], v[16:19]
    ds_read_b64_tr_b16 a[0:1], v7 offset:49920
    ds_read_b64_tr_b16 a[2:3], v7 offset:50432
    s_add_u32 m0, s22, 41600
    s_nop 0
    buffer_load_dwordx4 v5, s[32:35], s25 offen lds
    v_mfma_f32_16x16x32_bf16 v[32:35], a[32:35], v[132:135], v[32:35]
    ds_read_b64_tr_b16 a[4:5], v7 offset:49952
    v_mfma_f32_16x16x32_bf16 v[20:23], a[36:39], v[128:131], v[20:23]
    ds_read_b64_tr_b16 a[6:7], v7 offset:50464
    buffer_load_dwordx4 v[112:115], v4, s[28:31], s23 offen offset:0
    v_mfma_f32_16x16x32_bf16 v[36:39], a[36:39], v[132:135], v[36:39]
    ds_read_b64_tr_b16 a[8:9], v7 offset:49984
    v_mfma_f32_16x16x32_bf16 v[24:27], a[40:43], v[128:131], v[24:27]
    ds_read_b64_tr_b16 a[10:11], v7 offset:50496
    ds_read_b64_tr_b16 a[12:13], v7 offset:50016
    v_mfma_f32_16x16x32_bf16 v[40:43], a[40:43], v[132:135], v[40:43]
    ds_read_b64_tr_b16 a[14:15], v7 offset:50528
    buffer_load_dwordx4 v[116:119], v4, s[28:31], s23 offen offset:1024
    s_add_u32 s23, s23, 0x40000
    v_mfma_f32_16x16x32_bf16 v[28:31], a[44:47], v[128:131], v[28:31]
    ds_read_b64_tr_b16 a[16:17], v7 offset:50944
    v_mfma_f32_16x16x32_bf16 v[44:47], a[44:47], v[132:135], v[44:47]
    ds_read_b64_tr_b16 a[18:19], v7 offset:51456
    v_mfma_f32_16x16x32_bf16 v[16:19], a[48:51], v[136:139], v[16:19]
    ds_read_b64_tr_b16 a[20:21], v7 offset:50976
    ds_read_b64_tr_b16 a[22:23], v7 offset:51488
    buffer_load_dwordx4 v6, s[32:35], s25 offen offset:1024 lds
    s_add_u32 s25, s25, 0x20000
    v_mfma_f32_16x16x32_bf16 v[32:35], a[48:51], v[140:143], v[32:35]
    ds_read_b64_tr_b16 a[24:25], v7 offset:51008
    v_mfma_f32_16x16x32_bf16 v[20:23], a[52:55], v[136:139], v[20:23]
    ds_read_b64_tr_b16 a[26:27], v7 offset:51520
    buffer_load_dwordx4 v[120:123], v4, s[28:31], s24 offen offset:0
    v_mfma_f32_16x16x32_bf16 v[36:39], a[52:55], v[140:143], v[36:39]
    ds_read_b64_tr_b16 a[28:29], v7 offset:51040
    v_mfma_f32_16x16x32_bf16 v[24:27], a[56:59], v[136:139], v[24:27]
    ds_read_b64_tr_b16 a[30:31], v7 offset:51552
    v_mfma_f32_16x16x32_bf16 v[40:43], a[56:59], v[140:143], v[40:43]
    buffer_load_dwordx4 v[124:127], v4, s[28:31], s24 offen offset:1024
    s_add_u32 s24, s24, 0x40000
    v_mfma_f32_16x16x32_bf16 v[28:31], a[60:63], v[136:139], v[28:31]
    v_mfma_f32_16x16x32_bf16 v[44:47], a[60:63], v[140:143], v[44:47]
    s_waitcnt lgkmcnt(0)
    s_waitcnt vmcnt(36)
    s_barrier
    v_mfma_f32_16x16x32_bf16 v[16:19], a[0:3], v[144:147], v[16:19]
    ds_read_b64_tr_b16 a[32:33], v7 offset:58240
    ds_read_b64_tr_b16 a[34:35], v7 offset:58752
    s_add_u32 m0, s22, 49920
    s_nop 0
    buffer_load_dwordx4 v5, s[32:35], s25 offen lds
    v_mfma_f32_16x16x32_bf16 v[32:35], a[0:3], v[148:151], v[32:35]
    ds_read_b64_tr_b16 a[36:37], v7 offset:58272
    v_mfma_f32_16x16x32_bf16 v[20:23], a[4:7], v[144:147], v[20:23]
    ds_read_b64_tr_b16 a[38:39], v7 offset:58784
    buffer_load_dwordx4 v[128:131], v4, s[28:31], s23 offen offset:0
    v_mfma_f32_16x16x32_bf16 v[36:39], a[4:7], v[148:151], v[36:39]
    ds_read_b64_tr_b16 a[40:41], v7 offset:58304
    v_mfma_f32_16x16x32_bf16 v[24:27], a[8:11], v[144:147], v[24:27]
    ds_read_b64_tr_b16 a[42:43], v7 offset:58816
    ds_read_b64_tr_b16 a[44:45], v7 offset:58336
    v_mfma_f32_16x16x32_bf16 v[40:43], a[8:11], v[148:151], v[40:43]
    ds_read_b64_tr_b16 a[46:47], v7 offset:58848
    buffer_load_dwordx4 v[132:135], v4, s[28:31], s23 offen offset:1024
    s_add_u32 s23, s23, 0x40000
    v_mfma_f32_16x16x32_bf16 v[28:31], a[12:15], v[144:147], v[28:31]
    ds_read_b64_tr_b16 a[48:49], v7 offset:59264
    v_mfma_f32_16x16x32_bf16 v[44:47], a[12:15], v[148:151], v[44:47]
    ds_read_b64_tr_b16 a[50:51], v7 offset:59776
    v_mfma_f32_16x16x32_bf16 v[16:19], a[16:19], v[152:155], v[16:19]
    ds_read_b64_tr_b16 a[52:53], v7 offset:59296
    ds_read_b64_tr_b16 a[54:55], v7 offset:59808
    buffer_load_dwordx4 v6, s[32:35], s25 offen offset:1024 lds
    s_add_u32 s25, s25, 0x20000
    v_mfma_f32_16x16x32_bf16 v[32:35], a[16:19], v[156:159], v[32:35]
    ds_read_b64_tr_b16 a[56:57], v7 offset:59328
    v_mfma_f32_16x16x32_bf16 v[20:23], a[20:23], v[152:155], v[20:23]
    ds_read_b64_tr_b16 a[58:59], v7 offset:59840
    buffer_load_dwordx4 v[136:139], v4, s[28:31], s24 offen offset:0
    v_mfma_f32_16x16x32_bf16 v[36:39], a[20:23], v[156:159], v[36:39]
    ds_read_b64_tr_b16 a[60:61], v7 offset:59360
    v_mfma_f32_16x16x32_bf16 v[24:27], a[24:27], v[152:155], v[24:27]
    ds_read_b64_tr_b16 a[62:63], v7 offset:59872
    v_mfma_f32_16x16x32_bf16 v[40:43], a[24:27], v[156:159], v[40:43]
    buffer_load_dwordx4 v[140:143], v4, s[28:31], s24 offen offset:1024
    s_add_u32 s24, s24, 0x40000
    v_mfma_f32_16x16x32_bf16 v[28:31], a[28:31], v[152:155], v[28:31]
    v_mfma_f32_16x16x32_bf16 v[44:47], a[28:31], v[156:159], v[44:47]
    s_waitcnt lgkmcnt(0)
    s_waitcnt vmcnt(38)
    s_barrier
    v_mfma_f32_16x16x32_bf16 v[16:19], a[32:35], v[160:163], v[16:19]
    ds_read_b64_tr_b16 a[0:1], v7 offset:0
    ds_read_b64_tr_b16 a[2:3], v7 offset:512
    s_add_u32 m0, s22, 58240
    s_nop 0
    buffer_load_dwordx4 v5, s[32:35], s25 offen lds
    v_mfma_f32_16x16x32_bf16 v[32:35], a[32:35], v[164:167], v[32:35]
    ds_read_b64_tr_b16 a[4:5], v7 offset:32
    v_mfma_f32_16x16x32_bf16 v[20:23], a[36:39], v[160:163], v[20:23]
    ds_read_b64_tr_b16 a[6:7], v7 offset:544
    buffer_load_dwordx4 v[144:147], v4, s[28:31], s23 offen offset:0
    v_mfma_f32_16x16x32_bf16 v[36:39], a[36:39], v[164:167], v[36:39]
    ds_read_b64_tr_b16 a[8:9], v7 offset:64
    v_mfma_f32_16x16x32_bf16 v[24:27], a[40:43], v[160:163], v[24:27]
    ds_read_b64_tr_b16 a[10:11], v7 offset:576
    ds_read_b64_tr_b16 a[12:13], v7 offset:96
    v_mfma_f32_16x16x32_bf16 v[40:43], a[40:43], v[164:167], v[40:43]
    ds_read_b64_tr_b16 a[14:15], v7 offset:608
    buffer_load_dwordx4 v[148:151], v4, s[28:31], s23 offen offset:1024
    s_add_u32 s23, s23, 0x40000
    v_mfma_f32_16x16x32_bf16 v[28:31], a[44:47], v[160:163], v[28:31]
    ds_read_b64_tr_b16 a[16:17], v7 offset:1024
    v_mfma_f32_16x16x32_bf16 v[44:47], a[44:47], v[164:167], v[44:47]
    ds_read_b64_tr_b16 a[18:19], v7 offset:1536
    s_waitcnt vmcnt(40)
    v_mfma_f32_16x16x32_bf16 v[16:19], a[48:51], v[168:171], v[16:19]
    ds_read_b64_tr_b16 a[20:21], v7 offset:1056
    ds_read_b64_tr_b16 a[22:23], v7 offset:1568
    buffer_load_dwordx4 v6, s[32:35], s25 offen offset:1024 lds
    s_add_u32 s25, s25, 0x20000
    s_waitcnt vmcnt(40)
    v_mfma_f32_16x16x32_bf16 v[32:35], a[48:51], v[172:175], v[32:35]
    ds_read_b64_tr_b16 a[24:25], v7 offset:1088
    v_mfma_f32_16x16x32_bf16 v[20:23], a[52:55], v[168:171], v[20:23]
    ds_read_b64_tr_b16 a[26:27], v7 offset:1600
    buffer_load_dwordx4 v[152:155], v4, s[28:31], s24 offen offset:0
    v_mfma_f32_16x16x32_bf16 v[36:39], a[52:55], v[172:175], v[36:39]
    ds_read_b64_tr_b16 a[28:29], v7 offset:1120
    v_mfma_f32_16x16x32_bf16 v[24:27], a[56:59], v[168:171], v[24:27]
    ds_read_b64_tr_b16 a[30:31], v7 offset:1632
    v_mfma_f32_16x16x32_bf16 v[40:43], a[56:59], v[172:175], v[40:43]
    buffer_load_dwordx4 v[156:159], v4, s[28:31], s24 offen offset:1024
    s_add_u32 s24, s24, 0x40000
    v_mfma_f32_16x16x32_bf16 v[28:31], a[60:63], v[168:171], v[28:31]
    v_mfma_f32_16x16x32_bf16 v[44:47], a[60:63], v[172:175], v[44:47]
    s_sub_u32 s48, s48, 1
    s_cmp_lg_u32 s48, 0
    s_cbranch_scc1 dn1_kernel_loop
    s_waitcnt lgkmcnt(0)
    s_waitcnt vmcnt(38)
    s_barrier
    v_mfma_f32_16x16x32_bf16 v[16:19], a[0:3], v[48:51], v[16:19]
    ds_read_b64_tr_b16 a[32:33], v7 offset:8320
    ds_read_b64_tr_b16 a[34:35], v7 offset:8832
    buffer_load_dwordx4 v[160:163], v4, s[28:31], s23 offen offset:0
    v_mfma_f32_16x16x32_bf16 v[32:35], a[0:3], v[52:55], v[32:35]
    ds_read_b64_tr_b16 a[36:37], v7 offset:8352
    v_mfma_f32_16x16x32_bf16 v[20:23], a[4:7], v[48:51], v[20:23]
    ds_read_b64_tr_b16 a[38:39], v7 offset:8864
    v_mfma_f32_16x16x32_bf16 v[36:39], a[4:7], v[52:55], v[36:39]
    ds_read_b64_tr_b16 a[40:41], v7 offset:8384
    v_mfma_f32_16x16x32_bf16 v[24:27], a[8:11], v[48:51], v[24:27]
    ds_read_b64_tr_b16 a[42:43], v7 offset:8896
    ds_read_b64_tr_b16 a[44:45], v7 offset:8416
    buffer_load_dwordx4 v[164:167], v4, s[28:31], s23 offen offset:1024
    s_add_u32 s23, s23, 0x40000
    v_mfma_f32_16x16x32_bf16 v[40:43], a[8:11], v[52:55], v[40:43]
    ds_read_b64_tr_b16 a[46:47], v7 offset:8928
    v_mfma_f32_16x16x32_bf16 v[28:31], a[12:15], v[48:51], v[28:31]
    ds_read_b64_tr_b16 a[48:49], v7 offset:9344
    v_mfma_f32_16x16x32_bf16 v[44:47], a[12:15], v[52:55], v[44:47]
    ds_read_b64_tr_b16 a[50:51], v7 offset:9856
    s_waitcnt vmcnt(39)
    v_mfma_f32_16x16x32_bf16 v[16:19], a[16:19], v[56:59], v[16:19]
    ds_read_b64_tr_b16 a[52:53], v7 offset:9376
    ds_read_b64_tr_b16 a[54:55], v7 offset:9888
    buffer_load_dwordx4 v[168:171], v4, s[28:31], s24 offen offset:0
    s_waitcnt vmcnt(39)
    v_mfma_f32_16x16x32_bf16 v[32:35], a[16:19], v[60:63], v[32:35]
    ds_read_b64_tr_b16 a[56:57], v7 offset:9408
    v_mfma_f32_16x16x32_bf16 v[20:23], a[20:23], v[56:59], v[20:23]
    ds_read_b64_tr_b16 a[58:59], v7 offset:9920
    v_mfma_f32_16x16x32_bf16 v[36:39], a[20:23], v[60:63], v[36:39]
    ds_read_b64_tr_b16 a[60:61], v7 offset:9440
    v_mfma_f32_16x16x32_bf16 v[24:27], a[24:27], v[56:59], v[24:27]
    ds_read_b64_tr_b16 a[62:63], v7 offset:9952
    buffer_load_dwordx4 v[172:175], v4, s[28:31], s24 offen offset:1024
    s_add_u32 s24, s24, 0x40000
    v_mfma_f32_16x16x32_bf16 v[40:43], a[24:27], v[60:63], v[40:43]
    v_mfma_f32_16x16x32_bf16 v[28:31], a[28:31], v[56:59], v[28:31]
    v_mfma_f32_16x16x32_bf16 v[44:47], a[28:31], v[60:63], v[44:47]
    s_waitcnt lgkmcnt(0)
    s_waitcnt vmcnt(36)
    s_barrier
    v_mfma_f32_16x16x32_bf16 v[16:19], a[32:35], v[64:67], v[16:19]
    ds_read_b64_tr_b16 a[0:1], v7 offset:16640
    ds_read_b64_tr_b16 a[2:3], v7 offset:17152
    buffer_load_dwordx4 v[176:179], v4, s[36:39], s26 offen offset:0
    v_mfma_f32_16x16x32_bf16 v[32:35], a[32:35], v[68:71], v[32:35]
    ds_read_b64_tr_b16 a[4:5], v7 offset:16672
    v_mfma_f32_16x16x32_bf16 v[20:23], a[36:39], v[64:67], v[20:23]
    ds_read_b64_tr_b16 a[6:7], v7 offset:17184
    v_mfma_f32_16x16x32_bf16 v[36:39], a[36:39], v[68:71], v[36:39]
    ds_read_b64_tr_b16 a[8:9], v7 offset:16704
    v_mfma_f32_16x16x32_bf16 v[24:27], a[40:43], v[64:67], v[24:27]
    ds_read_b64_tr_b16 a[10:11], v7 offset:17216
    ds_read_b64_tr_b16 a[12:13], v7 offset:16736
    buffer_load_dwordx4 v[180:183], v4, s[36:39], s27 offen offset:0
    v_mfma_f32_16x16x32_bf16 v[40:43], a[40:43], v[68:71], v[40:43]
    ds_read_b64_tr_b16 a[14:15], v7 offset:17248
    v_mfma_f32_16x16x32_bf16 v[28:31], a[44:47], v[64:67], v[28:31]
    ds_read_b64_tr_b16 a[16:17], v7 offset:17664
    v_mfma_f32_16x16x32_bf16 v[44:47], a[44:47], v[68:71], v[44:47]
    ds_read_b64_tr_b16 a[18:19], v7 offset:18176
    s_waitcnt vmcnt(37)
    v_mfma_f32_16x16x32_bf16 v[16:19], a[48:51], v[72:75], v[16:19]
    ds_read_b64_tr_b16 a[20:21], v7 offset:17696
    ds_read_b64_tr_b16 a[22:23], v7 offset:18208
    buffer_load_dwordx4 v[184:187], v4, s[36:39], s26 offen offset:1024
    s_waitcnt vmcnt(37)
    v_mfma_f32_16x16x32_bf16 v[32:35], a[48:51], v[76:79], v[32:35]
    ds_read_b64_tr_b16 a[24:25], v7 offset:17728
    v_mfma_f32_16x16x32_bf16 v[20:23], a[52:55], v[72:75], v[20:23]
    ds_read_b64_tr_b16 a[26:27], v7 offset:18240
    v_mfma_f32_16x16x32_bf16 v[36:39], a[52:55], v[76:79], v[36:39]
    ds_read_b64_tr_b16 a[28:29], v7 offset:17760
    v_mfma_f32_16x16x32_bf16 v[24:27], a[56:59], v[72:75], v[24:27]
    ds_read_b64_tr_b16 a[30:31], v7 offset:18272
    buffer_load_dwordx4 v[188:191], v4, s[36:39], s27 offen offset:1024
    v_mfma_f32_16x16x32_bf16 v[40:43], a[56:59], v[76:79], v[40:43]
    v_mfma_f32_16x16x32_bf16 v[28:31], a[60:63], v[72:75], v[28:31]
    v_mfma_f32_16x16x32_bf16 v[44:47], a[60:63], v[76:79], v[44:47]
    s_waitcnt lgkmcnt(0)
    s_waitcnt vmcnt(34)
    s_barrier
    v_mfma_f32_16x16x32_bf16 v[16:19], a[0:3], v[80:83], v[16:19]
    ds_read_b64_tr_b16 a[32:33], v7 offset:24960
    ds_read_b64_tr_b16 a[34:35], v7 offset:25472
    v_mfma_f32_16x16x32_bf16 v[32:35], a[0:3], v[84:87], v[32:35]
    ds_read_b64_tr_b16 a[36:37], v7 offset:24992
    v_mfma_f32_16x16x32_bf16 v[20:23], a[4:7], v[80:83], v[20:23]
    ds_read_b64_tr_b16 a[38:39], v7 offset:25504
    v_mfma_f32_16x16x32_bf16 v[36:39], a[4:7], v[84:87], v[36:39]
    ds_read_b64_tr_b16 a[40:41], v7 offset:25024
    v_mfma_f32_16x16x32_bf16 v[24:27], a[8:11], v[80:83], v[24:27]
    ds_read_b64_tr_b16 a[42:43], v7 offset:25536
    ds_read_b64_tr_b16 a[44:45], v7 offset:25056
    v_mfma_f32_16x16x32_bf16 v[40:43], a[8:11], v[84:87], v[40:43]
    ds_read_b64_tr_b16 a[46:47], v7 offset:25568
    v_mfma_f32_16x16x32_bf16 v[28:31], a[12:15], v[80:83], v[28:31]
    ds_read_b64_tr_b16 a[48:49], v7 offset:25984
    v_mfma_f32_16x16x32_bf16 v[44:47], a[12:15], v[84:87], v[44:47]
    ds_read_b64_tr_b16 a[50:51], v7 offset:26496
    s_waitcnt vmcnt(33)
    v_mfma_f32_16x16x32_bf16 v[16:19], a[16:19], v[88:91], v[16:19]
    ds_read_b64_tr_b16 a[52:53], v7 offset:26016
    ds_read_b64_tr_b16 a[54:55], v7 offset:26528
    s_waitcnt vmcnt(32)
    v_mfma_f32_16x16x32_bf16 v[32:35], a[16:19], v[92:95], v[32:35]
    ds_read_b64_tr_b16 a[56:57], v7 offset:26048
    v_mfma_f32_16x16x32_bf16 v[20:23], a[20:23], v[88:91], v[20:23]
    ds_read_b64_tr_b16 a[58:59], v7 offset:26560
    v_mfma_f32_16x16x32_bf16 v[36:39], a[20:23], v[92:95], v[36:39]
    ds_read_b64_tr_b16 a[60:61], v7 offset:26080
    v_mfma_f32_16x16x32_bf16 v[24:27], a[24:27], v[88:91], v[24:27]
    ds_read_b64_tr_b16 a[62:63], v7 offset:26592
    v_mfma_f32_16x16x32_bf16 v[40:43], a[24:27], v[92:95], v[40:43]
    v_mfma_f32_16x16x32_bf16 v[28:31], a[28:31], v[88:91], v[28:31]
    v_mfma_f32_16x16x32_bf16 v[44:47], a[28:31], v[92:95], v[44:47]
    s_waitcnt lgkmcnt(0)
    s_waitcnt vmcnt(28)
    s_barrier
    v_mfma_f32_16x16x32_bf16 v[16:19], a[32:35], v[96:99], v[16:19]
    ds_read_b64_tr_b16 a[0:1], v7 offset:33280
    ds_read_b64_tr_b16 a[2:3], v7 offset:33792
    v_mfma_f32_16x16x32_bf16 v[32:35], a[32:35], v[100:103], v[32:35]
    ds_read_b64_tr_b16 a[4:5], v7 offset:33312
    v_mfma_f32_16x16x32_bf16 v[20:23], a[36:39], v[96:99], v[20:23]
    ds_read_b64_tr_b16 a[6:7], v7 offset:33824
    v_mfma_f32_16x16x32_bf16 v[36:39], a[36:39], v[100:103], v[36:39]
    ds_read_b64_tr_b16 a[8:9], v7 offset:33344
    v_mfma_f32_16x16x32_bf16 v[24:27], a[40:43], v[96:99], v[24:27]
    ds_read_b64_tr_b16 a[10:11], v7 offset:33856
    ds_read_b64_tr_b16 a[12:13], v7 offset:33376
    v_mfma_f32_16x16x32_bf16 v[40:43], a[40:43], v[100:103], v[40:43]
    ds_read_b64_tr_b16 a[14:15], v7 offset:33888
    v_mfma_f32_16x16x32_bf16 v[28:31], a[44:47], v[96:99], v[28:31]
    ds_read_b64_tr_b16 a[16:17], v7 offset:34304
    v_mfma_f32_16x16x32_bf16 v[44:47], a[44:47], v[100:103], v[44:47]
    ds_read_b64_tr_b16 a[18:19], v7 offset:34816
    s_waitcnt vmcnt(27)
    v_mfma_f32_16x16x32_bf16 v[16:19], a[48:51], v[104:107], v[16:19]
    ds_read_b64_tr_b16 a[20:21], v7 offset:34336
    ds_read_b64_tr_b16 a[22:23], v7 offset:34848
    s_waitcnt vmcnt(26)
    v_mfma_f32_16x16x32_bf16 v[32:35], a[48:51], v[108:111], v[32:35]
    ds_read_b64_tr_b16 a[24:25], v7 offset:34368
    v_mfma_f32_16x16x32_bf16 v[20:23], a[52:55], v[104:107], v[20:23]
    ds_read_b64_tr_b16 a[26:27], v7 offset:34880
    v_mfma_f32_16x16x32_bf16 v[36:39], a[52:55], v[108:111], v[36:39]
    ds_read_b64_tr_b16 a[28:29], v7 offset:34400
    v_mfma_f32_16x16x32_bf16 v[24:27], a[56:59], v[104:107], v[24:27]
    ds_read_b64_tr_b16 a[30:31], v7 offset:34912
    v_mfma_f32_16x16x32_bf16 v[40:43], a[56:59], v[108:111], v[40:43]
    v_mfma_f32_16x16x32_bf16 v[28:31], a[60:63], v[104:107], v[28:31]
    v_mfma_f32_16x16x32_bf16 v[44:47], a[60:63], v[108:111], v[44:47]
    s_waitcnt lgkmcnt(0)
    s_waitcnt vmcnt(22)
    s_barrier
    v_mfma_f32_16x16x32_bf16 v[16:19], a[0:3], v[112:115], v[16:19]
    ds_read_b64_tr_b16 a[32:33], v7 offset:41600
    ds_read_b64_tr_b16 a[34:35], v7 offset:42112
    v_mfma_f32_16x16x32_bf16 v[32:35], a[0:3], v[116:119], v[32:35]
    ds_read_b64_tr_b16 a[36:37], v7 offset:41632
    v_mfma_f32_16x16x32_bf16 v[20:23], a[4:7], v[112:115], v[20:23]
    ds_read_b64_tr_b16 a[38:39], v7 offset:42144
    v_mfma_f32_16x16x32_bf16 v[36:39], a[4:7], v[116:119], v[36:39]
    ds_read_b64_tr_b16 a[40:41], v7 offset:41664
    v_mfma_f32_16x16x32_bf16 v[24:27], a[8:11], v[112:115], v[24:27]
    ds_read_b64_tr_b16 a[42:43], v7 offset:42176
    ds_read_b64_tr_b16 a[44:45], v7 offset:41696
    v_mfma_f32_16x16x32_bf16 v[40:43], a[8:11], v[116:119], v[40:43]
    ds_read_b64_tr_b16 a[46:47], v7 offset:42208
    v_mfma_f32_16x16x32_bf16 v[28:31], a[12:15], v[112:115], v[28:31]
    ds_read_b64_tr_b16 a[48:49], v7 offset:42624
    v_mfma_f32_16x16x32_bf16 v[44:47], a[12:15], v[116:119], v[44:47]
    ds_read_b64_tr_b16 a[50:51], v7 offset:43136
    s_waitcnt vmcnt(21)
    v_mfma_f32_16x16x32_bf16 v[16:19], a[16:19], v[120:123], v[16:19]
    ds_read_b64_tr_b16 a[52:53], v7 offset:42656
    ds_read_b64_tr_b16 a[54:55], v7 offset:43168
    s_waitcnt vmcnt(20)
    v_mfma_f32_16x16x32_bf16 v[32:35], a[16:19], v[124:127], v[32:35]
    ds_read_b64_tr_b16 a[56:57], v7 offset:42688
    v_mfma_f32_16x16x32_bf16 v[20:23], a[20:23], v[120:123], v[20:23]
    ds_read_b64_tr_b16 a[58:59], v7 offset:43200
    v_mfma_f32_16x16x32_bf16 v[36:39], a[20:23], v[124:127], v[36:39]
    ds_read_b64_tr_b16 a[60:61], v7 offset:42720
    v_mfma_f32_16x16x32_bf16 v[24:27], a[24:27], v[120:123], v[24:27]
    ds_read_b64_tr_b16 a[62:63], v7 offset:43232
    v_mfma_f32_16x16x32_bf16 v[40:43], a[24:27], v[124:127], v[40:43]
    v_mfma_f32_16x16x32_bf16 v[28:31], a[28:31], v[120:123], v[28:31]
    v_mfma_f32_16x16x32_bf16 v[44:47], a[28:31], v[124:127], v[44:47]
    s_waitcnt lgkmcnt(0)
    s_waitcnt vmcnt(16)
    s_barrier
    v_mfma_f32_16x16x32_bf16 v[16:19], a[32:35], v[128:131], v[16:19]
    ds_read_b64_tr_b16 a[0:1], v7 offset:49920
    ds_read_b64_tr_b16 a[2:3], v7 offset:50432
    v_mfma_f32_16x16x32_bf16 v[32:35], a[32:35], v[132:135], v[32:35]
    ds_read_b64_tr_b16 a[4:5], v7 offset:49952
    v_mfma_f32_16x16x32_bf16 v[20:23], a[36:39], v[128:131], v[20:23]
    ds_read_b64_tr_b16 a[6:7], v7 offset:50464
    v_mfma_f32_16x16x32_bf16 v[36:39], a[36:39], v[132:135], v[36:39]
    ds_read_b64_tr_b16 a[8:9], v7 offset:49984
    v_mfma_f32_16x16x32_bf16 v[24:27], a[40:43], v[128:131], v[24:27]
    ds_read_b64_tr_b16 a[10:11], v7 offset:50496
    ds_read_b64_tr_b16 a[12:13], v7 offset:50016
    v_mfma_f32_16x16x32_bf16 v[40:43], a[40:43], v[132:135], v[40:43]
    ds_read_b64_tr_b16 a[14:15], v7 offset:50528
    v_mfma_f32_16x16x32_bf16 v[28:31], a[44:47], v[128:131], v[28:31]
    ds_read_b64_tr_b16 a[16:17], v7 offset:50944
    v_mfma_f32_16x16x32_bf16 v[44:47], a[44:47], v[132:135], v[44:47]
    ds_read_b64_tr_b16 a[18:19], v7 offset:51456
    s_waitcnt vmcnt(15)
    v_mfma_f32_16x16x32_bf16 v[16:19], a[48:51], v[136:139], v[16:19]
    ds_read_b64_tr_b16 a[20:21], v7 offset:50976
    ds_read_b64_tr_b16 a[22:23], v7 offset:51488
    s_waitcnt vmcnt(14)
    v_mfma_f32_16x16x32_bf16 v[32:35], a[48:51], v[140:143], v[32:35]
    ds_read_b64_tr_b16 a[24:25], v7 offset:51008
    v_mfma_f32_16x16x32_bf16 v[20:23], a[52:55], v[136:139], v[20:23]
    ds_read_b64_tr_b16 a[26:27], v7 offset:51520
    v_mfma_f32_16x16x32_bf16 v[36:39], a[52:55], v[140:143], v[36:39]
    ds_read_b64_tr_b16 a[28:29], v7 offset:51040
    v_mfma_f32_16x16x32_bf16 v[24:27], a[56:59], v[136:139], v[24:27]
    ds_read_b64_tr_b16 a[30:31], v7 offset:51552
    v_mfma_f32_16x16x32_bf16 v[40:43], a[56:59], v[140:143], v[40:43]
    v_mfma_f32_16x16x32_bf16 v[28:31], a[60:63], v[136:139], v[28:31]
    v_mfma_f32_16x16x32_bf16 v[44:47], a[60:63], v[140:143], v[44:47]
    s_waitcnt lgkmcnt(0)
    s_waitcnt vmcnt(10)
    s_barrier
    v_mfma_f32_16x16x32_bf16 v[16:19], a[0:3], v[144:147], v[16:19]
    ds_read_b64_tr_b16 a[32:33], v7 offset:58240
    ds_read_b64_tr_b16 a[34:35], v7 offset:58752
    v_mfma_f32_16x16x32_bf16 v[32:35], a[0:3], v[148:151], v[32:35]
    ds_read_b64_tr_b16 a[36:37], v7 offset:58272
    v_mfma_f32_16x16x32_bf16 v[20:23], a[4:7], v[144:147], v[20:23]
    ds_read_b64_tr_b16 a[38:39], v7 offset:58784
    v_mfma_f32_16x16x32_bf16 v[36:39], a[4:7], v[148:151], v[36:39]
    ds_read_b64_tr_b16 a[40:41], v7 offset:58304
    v_mfma_f32_16x16x32_bf16 v[24:27], a[8:11], v[144:147], v[24:27]
    ds_read_b64_tr_b16 a[42:43], v7 offset:58816
    ds_read_b64_tr_b16 a[44:45], v7 offset:58336
    v_mfma_f32_16x16x32_bf16 v[40:43], a[8:11], v[148:151], v[40:43]
    ds_read_b64_tr_b16 a[46:47], v7 offset:58848
    v_mfma_f32_16x16x32_bf16 v[28:31], a[12:15], v[144:147], v[28:31]
    ds_read_b64_tr_b16 a[48:49], v7 offset:59264
    v_mfma_f32_16x16x32_bf16 v[44:47], a[12:15], v[148:151], v[44:47]
    ds_read_b64_tr_b16 a[50:51], v7 offset:59776
    s_waitcnt vmcnt(9)
    v_mfma_f32_16x16x32_bf16 v[16:19], a[16:19], v[152:155], v[16:19]
    ds_read_b64_tr_b16 a[52:53], v7 offset:59296
    ds_read_b64_tr_b16 a[54:55], v7 offset:59808
    s_waitcnt vmcnt(8)
    v_mfma_f32_16x16x32_bf16 v[32:35], a[16:19], v[156:159], v[32:35]
    ds_read_b64_tr_b16 a[56:57], v7 offset:59328
    v_mfma_f32_16x16x32_bf16 v[20:23], a[20:23], v[152:155], v[20:23]
    ds_read_b64_tr_b16 a[58:59], v7 offset:59840
    v_mfma_f32_16x16x32_bf16 v[36:39], a[20:23], v[156:159], v[36:39]
    ds_read_b64_tr_b16 a[60:61], v7 offset:59360
    v_mfma_f32_16x16x32_bf16 v[24:27], a[24:27], v[152:155], v[24:27]
    ds_read_b64_tr_b16 a[62:63], v7 offset:59872
    v_mfma_f32_16x16x32_bf16 v[40:43], a[24:27], v[156:159], v[40:43]
    v_mfma_f32_16x16x32_bf16 v[28:31], a[28:31], v[152:155], v[28:31]
    v_mfma_f32_16x16x32_bf16 v[44:47], a[28:31], v[156:159], v[44:47]
    s_waitcnt lgkmcnt(0)
    s_waitcnt vmcnt(7)
    v_mfma_f32_16x16x32_bf16 v[16:19], a[32:35], v[160:163], v[16:19]
    s_waitcnt vmcnt(6)
    v_mfma_f32_16x16x32_bf16 v[32:35], a[32:35], v[164:167], v[32:35]
    v_mfma_f32_16x16x32_bf16 v[20:23], a[36:39], v[160:163], v[20:23]
    v_mfma_f32_16x16x32_bf16 v[36:39], a[36:39], v[164:167], v[36:39]
    v_mfma_f32_16x16x32_bf16 v[24:27], a[40:43], v[160:163], v[24:27]
    v_mfma_f32_16x16x32_bf16 v[40:43], a[40:43], v[164:167], v[40:43]
    v_mfma_f32_16x16x32_bf16 v[28:31], a[44:47], v[160:163], v[28:31]
    v_mfma_f32_16x16x32_bf16 v[44:47], a[44:47], v[164:167], v[44:47]
    s_waitcnt vmcnt(5)
    v_mfma_f32_16x16x32_bf16 v[16:19], a[48:51], v[168:171], v[16:19]
    s_waitcnt vmcnt(4)
    v_mfma_f32_16x16x32_bf16 v[32:35], a[48:51], v[172:175], v[32:35]
    v_mfma_f32_16x16x32_bf16 v[20:23], a[52:55], v[168:171], v[20:23]
    v_mfma_f32_16x16x32_bf16 v[36:39], a[52:55], v[172:175], v[36:39]
    v_mfma_f32_16x16x32_bf16 v[24:27], a[56:59], v[168:171], v[24:27]
    v_mfma_f32_16x16x32_bf16 v[40:43], a[56:59], v[172:175], v[40:43]
    v_mfma_f32_16x16x32_bf16 v[28:31], a[60:63], v[168:171], v[28:31]
    v_mfma_f32_16x16x32_bf16 v[44:47], a[60:63], v[172:175], v[44:47]
    s_waitcnt vmcnt(3)
    v_lshlrev_b32 v68, 16, v176
    v_and_b32 v69, 0xffff0000, v176
    v_pk_add_f32 v[16:17], v[16:17], v[68:69]
    v_cvt_pk_bf16_f32 v48, v16, v17
    v_lshlrev_b32 v70, 16, v177
    v_and_b32 v71, 0xffff0000, v177
    v_pk_add_f32 v[18:19], v[18:19], v[70:71]
    v_cvt_pk_bf16_f32 v49, v18, v19
    v_lshlrev_b32 v68, 16, v178
    v_and_b32 v69, 0xffff0000, v178
    v_pk_add_f32 v[20:21], v[20:21], v[68:69]
    v_cvt_pk_bf16_f32 v50, v20, v21
    v_lshlrev_b32 v70, 16, v179
    v_and_b32 v71, 0xffff0000, v179
    v_pk_add_f32 v[22:23], v[22:23], v[70:71]
    v_cvt_pk_bf16_f32 v51, v22, v23
    buffer_store_dwordx4 v[48:51], v4, s[40:43], s26 offen offset:0
    s_waitcnt vmcnt(3)
    v_lshlrev_b32 v68, 16, v180
    v_and_b32 v69, 0xffff0000, v180
    v_pk_add_f32 v[24:25], v[24:25], v[68:69]
    v_cvt_pk_bf16_f32 v52, v24, v25
    v_lshlrev_b32 v70, 16, v181
    v_and_b32 v71, 0xffff0000, v181
    v_pk_add_f32 v[26:27], v[26:27], v[70:71]
    v_cvt_pk_bf16_f32 v53, v26, v27
    v_lshlrev_b32 v68, 16, v182
    v_and_b32 v69, 0xffff0000, v182
    v_pk_add_f32 v[28:29], v[28:29], v[68:69]
    v_cvt_pk_bf16_f32 v54, v28, v29
    v_lshlrev_b32 v70, 16, v183
    v_and_b32 v71, 0xffff0000, v183
    v_pk_add_f32 v[30:31], v[30:31], v[70:71]
    v_cvt_pk_bf16_f32 v55, v30, v31
    buffer_store_dwordx4 v[52:55], v4, s[40:43], s27 offen offset:0
    s_waitcnt vmcnt(3)
    v_lshlrev_b32 v68, 16, v184
    v_and_b32 v69, 0xffff0000, v184
    v_pk_add_f32 v[32:33], v[32:33], v[68:69]
    v_cvt_pk_bf16_f32 v56, v32, v33
    v_lshlrev_b32 v70, 16, v185
    v_and_b32 v71, 0xffff0000, v185
    v_pk_add_f32 v[34:35], v[34:35], v[70:71]
    v_cvt_pk_bf16_f32 v57, v34, v35
    v_lshlrev_b32 v68, 16, v186
    v_and_b32 v69, 0xffff0000, v186
    v_pk_add_f32 v[36:37], v[36:37], v[68:69]
    v_cvt_pk_bf16_f32 v58, v36, v37
    v_lshlrev_b32 v70, 16, v187
    v_and_b32 v71, 0xffff0000, v187
    v_pk_add_f32 v[38:39], v[38:39], v[70:71]
    v_cvt_pk_bf16_f32 v59, v38, v39
    buffer_store_dwordx4 v[56:59], v4, s[40:43], s26 offen offset:1024
    s_waitcnt vmcnt(3)
    v_lshlrev_b32 v68, 16, v188
    v_and_b32 v69, 0xffff0000, v188
    v_pk_add_f32 v[40:41], v[40:41], v[68:69]
    v_cvt_pk_bf16_f32 v60, v40, v41
    v_lshlrev_b32 v70, 16, v189
    v_and_b32 v71, 0xffff0000, v189
    v_pk_add_f32 v[42:43], v[42:43], v[70:71]
    v_cvt_pk_bf16_f32 v61, v42, v43
    v_lshlrev_b32 v68, 16, v190
    v_and_b32 v69, 0xffff0000, v190
    v_pk_add_f32 v[44:45], v[44:45], v[68:69]
    v_cvt_pk_bf16_f32 v62, v44, v45
    v_lshlrev_b32 v70, 16, v191
    v_and_b32 v71, 0xffff0000, v191
    v_pk_add_f32 v[46:47], v[46:47], v[70:71]
    v_cvt_pk_bf16_f32 v63, v46, v47
    buffer_store_dwordx4 v[60:63], v4, s[40:43], s27 offen offset:1024
    v_pk_mul_f32 v[90:91], v[16:17], v[16:17]
    v_pk_fma_f32 v[90:91], v[18:19], v[18:19], v[90:91]
    v_pk_add_f32 v[88:89], v[16:17], v[18:19]
    v_pk_fma_f32 v[90:91], v[20:21], v[20:21], v[90:91]
    v_pk_add_f32 v[88:89], v[88:89], v[20:21]
    v_pk_fma_f32 v[90:91], v[22:23], v[22:23], v[90:91]
    v_pk_add_f32 v[88:89], v[88:89], v[22:23]
    v_pk_fma_f32 v[90:91], v[24:25], v[24:25], v[90:91]
    v_pk_add_f32 v[88:89], v[88:89], v[24:25]
    v_pk_fma_f32 v[90:91], v[26:27], v[26:27], v[90:91]
    v_pk_add_f32 v[88:89], v[88:89], v[26:27]
    v_pk_fma_f32 v[90:91], v[28:29], v[28:29], v[90:91]
    v_pk_add_f32 v[88:89], v[88:89], v[28:29]
    v_pk_fma_f32 v[90:91], v[30:31], v[30:31], v[90:91]
    v_pk_add_f32 v[88:89], v[88:89], v[30:31]
    v_add_f32 v88, v88, v89
    v_add_f32 v90, v90, v91
    v_pk_mul_f32 v[94:95], v[32:33], v[32:33]
    v_pk_fma_f32 v[94:95], v[34:35], v[34:35], v[94:95]
    v_pk_add_f32 v[92:93], v[32:33], v[34:35]
    v_pk_fma_f32 v[94:95], v[36:37], v[36:37], v[94:95]
    v_pk_add_f32 v[92:93], v[92:93], v[36:37]
    v_pk_fma_f32 v[94:95], v[38:39], v[38:39], v[94:95]
    v_pk_add_f32 v[92:93], v[92:93], v[38:39]
    v_pk_fma_f32 v[94:95], v[40:41], v[40:41], v[94:95]
    v_pk_add_f32 v[92:93], v[92:93], v[40:41]
    v_pk_fma_f32 v[94:95], v[42:43], v[42:43], v[94:95]
    v_pk_add_f32 v[92:93], v[92:93], v[42:43]
    v_pk_fma_f32 v[94:95], v[44:45], v[44:45], v[94:95]
    v_pk_add_f32 v[92:93], v[92:93], v[44:45]
    v_pk_fma_f32 v[94:95], v[46:47], v[46:47], v[94:95]
    v_pk_add_f32 v[92:93], v[92:93], v[46:47]
    v_add_f32 v92, v92, v93
    v_add_f32 v94, v94, v95
    s_nop 0
    v_permlane16_swap_b32 v88, v92
    v_permlane16_swap_b32 v90, v94
    v_add_f32 v88, v88, v92
    v_add_f32 v90, v90, v94
    s_lshl_b32 s50, s7, 14
    s_lshl_b32 s51, s6, 10
    s_add_u32 s50, s50, s51
    s_lshl_b32 s51, s3, 8
    s_add_u32 s50, s50, s51
    v_permlane32_swap_b32 v88, v90
    v_and_b32 v78, 31, v1
    v_lshlrev_b32 v78, 3, v78
    v_lshrrev_b32 v92, 5, v1
    v_lshl_add_u32 v78, v92, 2, v78
    v_add_f32 v88, v88, v90
    buffer_store_dword v88, v78, s[44:47], s50 offen
dn1_kernel_end:
    s_endpgm
.text
.globl qkv2_kernel
.p2align 8
.type qkv2_kernel,@function
qkv2_kernel:
    s_cmp_ge_u32 s2, 256
    s_cbranch_scc1 qkv2_kernel_end
    s_load_dwordx2 s[10:11], s[0:1], 72
    s_load_dwordx2 s[12:13], s[0:1], 8
    v_lshrrev_b32 v2, 6, v0
    v_and_b32 v1, 63, v0
    v_readfirstlane_b32 s3, v2
    s_and_b32 s4, s2, 7
    s_lshr_b32 s5, s2, 3
    s_and_b32 s6, s4, 1
    s_lshl_b32 s6, s6, 3
    s_and_b32 s7, s5, 7
    s_add_u32 s6, s6, s7
    s_lshr_b32 s7, s4, 1
    s_lshl_b32 s7, s7, 2
    s_lshr_b32 s8, s5, 3
    s_add_u32 s7, s7, s8
    s_and_b32 s8, s3, 1
    s_lshr_b32 s9, s3, 1
    s_lshl_b32 s20, s6, 13
    s_lshl_b32 s21, s3, 11
    s_add_u32 s20, s20, s21
    v_lshl_add_u32 v4, v1, 4, s20
    s_lshl_b32 s16, s6, 3
    s_sub_u32 s16, s16, 9
    s_cmp_lt_u32 s6, 2
    s_cselect_b32 s16, 7, s16
    s_lshl_b32 s20, s16, 10
    s_lshl_b32 s21, s3, 8
    s_add_u32 s20, s20, s21
    s_sub_u32 s20, s20, 2048
    v_lshl_add_u32 v5, v1, 2, s20
    v_bfe_u32 v34, v1, 3, 1
    v_lshrrev_b32 v35, 4, v1
    v_lshl_add_u32 v34, v35, 3, v34
    s_lshl_b32 s21, s3, 1
    v_add_u32 v34, s21, v34
    v_mul_u32_u24 v34, 6144, v34
    v_and_b32 v35, 7, v1
    v_lshl_add_u32 v34, v35, 4, v34
    s_lshl_b32 s21, s7, 7
    v_add_u32 v6, s21, v34
    v_add_u32 v7, 1024, v6
    v_add_u32 v8, 2048, v6
    s_mul_i32 s21, s8, 4608
    v_lshl_add_u32 v10, v1, 4, s21
    v_lshrrev_b32 v34, 4, v1
    v_mul_u32_u24 v34, 2304, v34
    v_and_b32 v35, 15, v1
    v_lshl_add_u32 v12, v35, 4, v34
    v_bfe_u32 v34, v1, 3, 2
    v_mul_u32_u24 v34, 3104, v34
    v_bfe_u32 v35, v1, 2, 1
    v_lshl_add_u32 v34, v35, 7, v34
    v_bfe_u32 v35, v1, 5, 1
    v_lshl_add_u32 v34, v35, 8, v34
    v_and_b32 v35, 3, v1
    v_lshl_add_u32 v34, v35, 3, v34
    s_lshl_b32 s21, s9, 6
    v_add_u32 v14, s21, v34
    v_add_u32 v11, 64896, v10
    v_add_u32 v13, 64896, v12
    v_add_u32 v15, 64896, v14
    s_mul_i32 s22, s3, 2304
    s_mul_i32 s24, s3, 3104
    s_add_u32 s24, s24, 9216
    s_mov_b32 s23, 0
    s_mov_b32 s25, 0
    s_lshl_b32 s20, s6, 10
    v_lshl_add_u32 v34, v0, 3, s20
    s_lshl_b32 s20, s16, 7
    v_and_b32 v35, 15, v1
    v_lshl_add_u32 v35, v35, 3, s20
    v_cmp_gt_u32 vcc, 128, v0
    s_nop 1
    v_cndmask_b32 v9, v35, v34, vcc
    s_waitcnt lgkmcnt(0)
    s_add_u32 s28, s10, 12582912
    s_addc_u32 s29, s11, 0
    s_mov_b32 s30, 4194304
    s_mov_b32 s31, 0x20000
    s_mov_b32 s32, s12
    s_mov_b32 s33, s13
    s_mov_b32 s34, 6291456
    s_mov_b32 s35, 0x20000
    s_add_u32 s36, s10, 59244544
    s_addc_u32 s37, s11, 0
    s_mov_b32 s38, 262144
    s_mov_b32 s39, 0x20000
    s_add_u32 s44, s10, 60817408
    s_addc_u32 s45, s11, 0
    s_mov_b32 s46, 12288
    s_mov_b32 s47, 0x20000
    s_waitcnt lgkmcnt(0)
    s_cmp_eq_u32 s8, 1
    s_cbranch_scc1 qkv2_kernel_t1
    s_add_u32 m0, s24, 0
    s_nop 0
    buffer_load_dwordx4 v6, s[32:35], s25 offen lds
    buffer_load_dwordx4 v7, s[32:35], s25 offen offset:1024 lds
    buffer_load_dwordx4 v8, s[32:35], s25 offen offset:2048 lds
    s_add_u32 s25, s25, 196608
    s_add_u32 m0, s22, 0
    s_nop 0
    buffer_load_dwordx4 v4, s[28:31], s23 offen lds
    buffer_load_dwordx4 v4, s[28:31], s23 offen offset:1024 lds
    buffer_load_dword v5, s[28:31], s23 offen offset:2048 lds
    s_add_u32 s23, s23, 0x20000
    s_mov_b32 s26, 0
    buffer_load_dwordx2 v[48:49], v9, s[36:39], s26 offen
    s_mov_b32 s26, 16384
    buffer_load_dwordx2 v[50:51], v9, s[36:39], s26 offen
    s_mov_b32 s26, 32768
    buffer_load_dwordx2 v[52:53], v9, s[36:39], s26 offen
    s_mov_b32 s26, 49152
    buffer_load_dwordx2 v[54:55], v9, s[36:39], s26 offen
    s_mov_b32 s26, 65536
    buffer_load_dwordx2 v[56:57], v9, s[36:39], s26 offen
    s_mov_b32 s26, 81920
    buffer_load_dwordx2 v[58:59], v9, s[36:39], s26 offen
    s_mov_b32 s26, 98304
    buffer_load_dwordx2 v[60:61], v9, s[36:39], s26 offen
    s_mov_b32 s26, 114688
    buffer_load_dwordx2 v[62:63], v9, s[36:39], s26 offen
    s_mov_b32 s26, 131072
    buffer_load_dwordx2 v[64:65], v9, s[36:39], s26 offen
    s_mov_b32 s26, 147456
    buffer_load_dwordx2 v[66:67], v9, s[36:39], s26 offen
    s_mov_b32 s26, 163840
    buffer_load_dwordx2 v[68:69], v9, s[36:39], s26 offen
    s_mov_b32 s26, 180224
    buffer_load_dwordx2 v[70:71], v9, s[36:39], s26 offen
    s_mov_b32 s26, 196608
    buffer_load_dwordx2 v[72:73], v9, s[36:39], s26 offen
    s_mov_b32 s26, 212992
    buffer_load_dwordx2 v[74:75], v9, s[36:39], s26 offen
    s_mov_b32 s26, 229376
    buffer_load_dwordx2 v[76:77], v9, s[36:39], s26 offen
    s_mov_b32 s26, 245760
    buffer_load_dwordx2 v[78:79], v9, s[36:39], s26 offen
    s_add_u32 m0, s24, 21632
    s_nop 0
    buffer_load_dwordx4 v6, s[32:35], s25 offen lds
    buffer_load_dwordx4 v7, s[32:35], s25 offen offset:1024 lds
    buffer_load_dwordx4 v8, s[32:35], s25 offen offset:2048 lds
    s_add_u32 s25, s25, 196608
    s_add_u32 m0, s22, 21632
    s_nop 0
    buffer_load_dwordx4 v4, s[28:31], s23 offen lds
    buffer_load_dwordx4 v4, s[28:31], s23 offen offset:1024 lds
    buffer_load_dword v5, s[28:31], s23 offen offset:2048 lds
    s_add_u32 s23, s23, 0x20000
    s_add_u32 m0, s24, 43264
    s_nop 0
    buffer_load_dwordx4 v6, s[32:35], s25 offen lds
    buffer_load_dwordx4 v7, s[32:35], s25 offen offset:1024 lds
    buffer_load_dwordx4 v8, s[32:35], s25 offen offset:2048 lds
    s_add_u32 s25, s25, 196608
    s_add_u32 m0, s22, 43264
    s_nop 0
    buffer_load_dwordx4 v4, s[28:31], s23 offen lds
    buffer_load_dwordx4 v4, s[28:31], s23 offen offset:1024 lds
    buffer_load_dword v5, s[28:31], s23 offen offset:2048 lds
    s_add_u32 s23, s23, 0x20000
    s_add_u32 m0, s24, 64896
    s_nop 0
    buffer_load_dwordx4 v6, s[32:35], s25 offen lds
    buffer_load_dwordx4 v7, s[32:35], s25 offen offset:1024 lds
    buffer_load_dwordx4 v8, s[32:35], s25 offen offset:2048 lds
    s_add_u32 s25, s25, 196608
    s_add_u32 m0, s22, 64896
    s_nop 0
    buffer_load_dwordx4 v4, s[28:31], s23 offen lds
    buffer_load_dwordx4 v4, s[28:31], s23 offen offset:1024 lds
    buffer_load_dword v5, s[28:31], s23 offen offset:2048 lds
    s_add_u32 s23, s23, 0x20000
    s_add_u32 m0, s24, 86528
    s_nop 0
    buffer_load_dwordx4 v6, s[32:35], s25 offen lds
    buffer_load_dwordx4 v7, s[32:35], s25 offen offset:1024 lds
    buffer_load_dwordx4 v8, s[32:35], s25 offen offset:2048 lds
    s_add_u32 s25, s25, 196608
    s_add_u32 m0, s22, 86528
    s_nop 0
    buffer_load_dwordx4 v4, s[28:31], s23 offen lds
    buffer_load_dwordx4 v4, s[28:31], s23 offen offset:1024 lds
    buffer_load_dword v5, s[28:31], s23 offen offset:2048 lds
    s_add_u32 s23, s23, 0x20000
    s_add_u32 m0, s24, 108160
    s_nop 0
    buffer_load_dwordx4 v6, s[32:35], s25 offen lds
    buffer_load_dwordx4 v7, s[32:35], s25 offen offset:1024 lds
    buffer_load_dwordx4 v8, s[32:35], s25 offen offset:2048 lds
    s_add_u32 s25, s25, 196608
    s_add_u32 m0, s22, 108160
    s_nop 0
    buffer_load_dwordx4 v4, s[28:31], s23 offen lds
    buffer_load_dwordx4 v4, s[28:31], s23 offen offset:1024 lds
    buffer_load_dword v5, s[28:31], s23 offen offset:2048 lds
    s_add_u32 s23, s23, 0x20000
    s_lshl_b32 s20, s7, 8
    s_lshl_b32 s21, s9, 7
    s_add_u32 s20, s20, s21
    s_add_u32 s21, s20, 4096
    s_add_u32 s26, s20, 8192
    v_lshrrev_b32 v34, 4, v1
    v_lshlrev_b32 v34, 4, v34
    v_and_b32 v35, 15, v1
    v_lshlrev_b32 v35, 2, v35
    buffer_load_dwordx4 v[16:19], v34, s[44:47], s20 offen offset:0
    buffer_load_dwordx4 v[20:23], v34, s[44:47], s20 offen offset:64
    buffer_load_dwordx4 v[24:27], v34, s[44:47], s21 offen offset:0
    buffer_load_dwordx4 v[28:31], v34, s[44:47], s21 offen offset:64
    buffer_load_dword v32, v35, s[44:47], s26 offen offset:0
    buffer_load_dword v33, v35, s[44:47], s26 offen offset:64
    s_add_u32 s40, s10, 16777216
    s_addc_u32 s41, s11, 0
    s_mov_b32 s42, 4194304
    s_mov_b32 s43, 0x20000
    v_lshrrev_b32 v34, 4, v1
    v_lshlrev_b32 v34, 2, v34
    v_and_b32 v35, 15, v1
    v_sub_u32 v34, v35, v34
    v_mov_b32 v35, 0xf149f2ca
    v_subrev_u32 v44, 0, v34
    v_cmp_gt_u32 vcc, 8, v44
    s_nop 1
    v_cndmask_b32 v40, v35, 0, vcc
    v_cmp_gt_i32 vcc, -8, v44
    s_nop 1
    v_cndmask_b32 v36, v35, 0, vcc
    v_subrev_u32 v44, 1, v34
    v_cmp_gt_u32 vcc, 8, v44
    s_nop 1
    v_cndmask_b32 v41, v35, 0, vcc
    v_cmp_gt_i32 vcc, -8, v44
    s_nop 1
    v_cndmask_b32 v37, v35, 0, vcc
    v_subrev_u32 v44, 2, v34
    v_cmp_gt_u32 vcc, 8, v44
    s_nop 1
    v_cndmask_b32 v42, v35, 0, vcc
    v_cmp_gt_i32 vcc, -8, v44
    s_nop 1
    v_cndmask_b32 v38, v35, 0, vcc
    v_subrev_u32 v44, 3, v34
    v_cmp_gt_u32 vcc, 8, v44
    s_nop 1
    v_cndmask_b32 v43, v35, 0, vcc
    v_cmp_gt_i32 vcc, -8, v44
    s_nop 1
    v_cndmask_b32 v39, v35, 0, vcc
    s_cmp_lt_u32 s6, 2
    s_cselect_b64 vcc, -1, 0
    v_cndmask_b32 v44, v36, v35, vcc
    v_cndmask_b32 v45, v37, v35, vcc
    v_cndmask_b32 v46, v38, v35, vcc
    v_cndmask_b32 v47, v39, v35, vcc
    s_waitcnt vmcnt(52)
    s_barrier
    ds_read_b64_tr_b16 a[20:21], v14 offset:9216
    ds_read_b64_tr_b16 a[22:23], v14 offset:9728
    ds_read_b64_tr_b16 a[24:25], v14 offset:9248
    ds_read_b64_tr_b16 a[26:27], v14 offset:9760
    ds_read_b64_tr_b16 a[28:29], v14 offset:10240
    ds_read_b64_tr_b16 a[30:31], v14 offset:10752
    ds_read_b64_tr_b16 a[32:33], v14 offset:10272
    ds_read_b64_tr_b16 a[34:35], v14 offset:10784
    ds_read_b128 a[0:3], v10 offset:0
    ds_read_b128 a[4:7], v10 offset:1024
    ds_read_b64_tr_b16 a[36:37], v14 offset:11264
    ds_read_b64_tr_b16 a[38:39], v14 offset:11776
    ds_read_b128 a[8:11], v10 offset:2304
    ds_read_b128 a[12:15], v10 offset:3328
    ds_read_b64_tr_b16 a[40:41], v14 offset:11296
    ds_read_b64_tr_b16 a[42:43], v14 offset:11808
    ds_read_b128 a[16:19], v12 offset:2048
    s_waitcnt vmcnt(43)
    v_pk_add_f32 v[48:49], v[48:49], v[64:65]
    s_waitcnt vmcnt(42)
    v_pk_add_f32 v[50:51], v[50:51], v[66:67]
    s_waitcnt vmcnt(41)
    v_pk_add_f32 v[52:53], v[52:53], v[68:69]
    s_waitcnt vmcnt(40)
    v_pk_add_f32 v[54:55], v[54:55], v[70:71]
    s_waitcnt vmcnt(39)
    v_pk_add_f32 v[56:57], v[56:57], v[72:73]
    s_waitcnt vmcnt(38)
    v_pk_add_f32 v[58:59], v[58:59], v[74:75]
    s_waitcnt vmcnt(37)
    v_pk_add_f32 v[60:61], v[60:61], v[76:77]
    s_waitcnt vmcnt(36)
    v_pk_add_f32 v[62:63], v[62:63], v[78:79]
    v_pk_add_f32 v[48:49], v[48:49], v[56:57]
    v_pk_add_f32 v[50:51], v[50:51], v[58:59]
    v_pk_add_f32 v[52:53], v[52:53], v[60:61]
    v_pk_add_f32 v[54:55], v[54:55], v[62:63]
    v_pk_add_f32 v[48:49], v[48:49], v[52:53]
    v_pk_add_f32 v[50:51], v[50:51], v[54:55]
    v_pk_add_f32 v[48:49], v[48:49], v[50:51]
    v_mul_f32 v48, 0xba800000, v48
    v_mul_f32 v49, 0x3a800000, v49
    v_fma_f32 v49, -v48, v48, v49
    v_max_f32 v49, 0, v49
    v_add_f32 v49, 0x3727c5ac, v49
    v_rsq_f32 v50, v49
    s_nop 0
    v_mov_b32 v49, v50
    v_mul_f32 v50, 0x3e8293ee, v50
    v_min_u32 v34, 191, v0
    v_lshlrev_b32 v35, 2, v34
    v_lshlrev_b32 v34, 4, v34
    v_add_u32 v34, 129792, v34
    v_add_u32 v35, 132864, v35
    ds_write_b128 v34, v[48:51]
    ds_write_b32 v35, v48
    ds_write_b32 v35, v49 offset:768
    s_waitcnt lgkmcnt(0)
    v_mov_b32 v48, 0
    v_mov_b32 v49, 0
    v_mov_b32 v50, 0
    v_mov_b32 v51, 0
    v_mov_b32 v52, 0
    v_mov_b32 v53, 0
    v_mov_b32 v54, 0
    v_mov_b32 v55, 0
    v_mov_b32 v56, 0
    v_mov_b32 v57, 0
    v_mov_b32 v58, 0
    v_mov_b32 v59, 0
    v_mov_b32 v60, 0
    v_mov_b32 v61, 0
    v_mov_b32 v62, 0
    v_mov_b32 v63, 0
    v_mov_b32 v64, 0
    v_mov_b32 v65, 0
    v_mov_b32 v66, 0
    v_mov_b32 v67, 0
    v_mov_b32 v68, 0
    v_mov_b32 v69, 0
    v_mov_b32 v70, 0
    v_mov_b32 v71, 0
    v_mov_b32 v72, 0
    v_mov_b32 v73, 0
    v_mov_b32 v74, 0
    v_mov_b32 v75, 0
    v_mov_b32 v76, 0
    v_mov_b32 v77, 0
    v_mov_b32 v78, 0
    v_mov_b32 v79, 0
    v_mov_b32 v80, 0
    v_mov_b32 v81, 0
    v_mov_b32 v82, 0
    v_mov_b32 v83, 0
    v_mov_b32 v84, 0
    v_mov_b32 v85, 0
    v_mov_b32 v86, 0
    v_mov_b32 v87, 0
    v_mov_b32 v88, 0
    v_mov_b32 v89, 0
    v_mov_b32 v90, 0
    v_mov_b32 v91, 0
    v_mov_b32 v92, 0
    v_mov_b32 v93, 0
    v_mov_b32 v94, 0
    v_mov_b32 v95, 0
    v_mov_b32 v96, 0
    v_mov_b32 v97, 0
    v_mov_b32 v98, 0
    v_mov_b32 v99, 0
    v_mov_b32 v100, 0
    v_mov_b32 v101, 0
    v_mov_b32 v102, 0
    v_mov_b32 v103, 0
    v_mov_b32 v104, 0
    v_mov_b32 v105, 0
    v_mov_b32 v106, 0
    v_mov_b32 v107, 0
    v_mov_b32 v108, 0
    v_mov_b32 v109, 0
    v_mov_b32 v110, 0
    v_mov_b32 v111, 0
    v_mov_b32 v112, 0
    v_mov_b32 v113, 0
    v_mov_b32 v114, 0
    v_mov_b32 v115, 0
    v_mov_b32 v116, 0
    v_mov_b32 v117, 0
    v_mov_b32 v118, 0
    v_mov_b32 v119, 0
    v_mov_b32 v120, 0
    v_mov_b32 v121, 0
    v_mov_b32 v122, 0
    v_mov_b32 v123, 0
    v_mov_b32 v124, 0
    v_mov_b32 v125, 0
    v_mov_b32 v126, 0
    v_mov_b32 v127, 0
    v_mov_b32 v128, 0
    v_mov_b32 v129, 0
    v_mov_b32 v130, 0
    v_mov_b32 v131, 0
    v_mov_b32 v132, 0
    v_mov_b32 v133, 0
    v_mov_b32 v134, 0
    v_mov_b32 v135, 0
    v_mov_b32 v136, 0
    v_mov_b32 v137, 0
    v_mov_b32 v138, 0
    v_mov_b32 v139, 0
    v_mov_b32 v140, 0
    v_mov_b32 v141, 0
    v_mov_b32 v142, 0
    v_mov_b32 v143, 0
    v_mov_b32 v144, 0
    v_mov_b32 v145, 0
    v_mov_b32 v146, 0
    v_mov_b32 v147, 0
    v_mov_b32 v148, 0
    v_mov_b32 v149, 0
    v_mov_b32 v150, 0
    v_mov_b32 v151, 0
    s_mov_b32 s48, 4
.p2align 6
qkv2_kernel_t0_loop:
    s_waitcnt lgkmcnt(0)
    s_waitcnt vmcnt(24)
    s_barrier
    v_mfma_f32_16x16x32_bf16 v[48:51], a[20:23], a[0:3], v[48:51]
    ds_read_b64_tr_b16 a[64:65], v14 offset:30848
    v_mfma_f32_16x16x32_bf16 v[52:55], a[20:23], a[4:7], v[52:55]
    ds_read_b64_tr_b16 a[66:67], v14 offset:31360
    s_add_u32 m0, s24, 0
    s_nop 0
    buffer_load_dwordx4 v6, s[32:35], s25 offen lds
    v_mfma_f32_16x16x32_bf16 v[56:59], a[20:23], a[8:11], v[56:59]
    ds_read_b64_tr_b16 a[68:69], v14 offset:30880
    v_mfma_f32_16x16x32_bf16 v[60:63], a[20:23], a[12:15], v[60:63]
    ds_read_b64_tr_b16 a[70:71], v14 offset:31392
    v_mfma_f32_16x16x32_bf16 v[64:67], a[24:27], a[0:3], v[64:67]
    v_mfma_f32_16x16x32_bf16 v[68:71], a[24:27], a[4:7], v[68:71]
    ds_read_b64_tr_b16 a[72:73], v14 offset:31872
    buffer_load_dwordx4 v7, s[32:35], s25 offen offset:1024 lds
    v_mfma_f32_16x16x32_bf16 v[72:75], a[24:27], a[8:11], v[72:75]
    ds_read_b64_tr_b16 a[74:75], v14 offset:32384
    v_mfma_f32_16x16x32_bf16 v[76:79], a[24:27], a[12:15], v[76:79]
    ds_read_b64_tr_b16 a[76:77], v14 offset:31904
    v_mfma_f32_16x16x32_bf16 v[80:83], a[28:31], a[0:3], v[80:83]
    v_mfma_f32_16x16x32_bf16 v[84:87], a[28:31], a[4:7], v[84:87]
    ds_read_b64_tr_b16 a[78:79], v14 offset:32416
    buffer_load_dwordx4 v8, s[32:35], s25 offen offset:2048 lds
    s_add_u32 s25, s25, 196608
    v_mfma_f32_16x16x32_bf16 v[88:91], a[28:31], a[8:11], v[88:91]
    ds_read_b128 a[44:47], v10 offset:21632
    v_mfma_f32_16x16x32_bf16 v[92:95], a[28:31], a[12:15], v[92:95]
    ds_read_b128 a[48:51], v10 offset:22656
    v_mfma_f32_16x16x32_bf16 v[144:147], a[28:31], a[16:19], v[144:147]
    ds_read_b64_tr_b16 a[80:81], v14 offset:32896
    v_mfma_f32_16x16x32_bf16 v[96:99], a[32:35], a[0:3], v[96:99]
    s_add_u32 m0, s22, 0
    s_nop 0
    buffer_load_dwordx4 v4, s[28:31], s23 offen lds
    v_mfma_f32_16x16x32_bf16 v[100:103], a[32:35], a[4:7], v[100:103]
    ds_read_b64_tr_b16 a[82:83], v14 offset:33408
    v_mfma_f32_16x16x32_bf16 v[104:107], a[32:35], a[8:11], v[104:107]
    ds_read_b128 a[52:55], v10 offset:23936
    v_mfma_f32_16x16x32_bf16 v[108:111], a[32:35], a[12:15], v[108:111]
    ds_read_b128 a[56:59], v10 offset:24960
    v_mfma_f32_16x16x32_bf16 v[148:151], a[32:35], a[16:19], v[148:151]
    buffer_load_dwordx4 v4, s[28:31], s23 offen offset:1024 lds
    v_mfma_f32_16x16x32_bf16 v[112:115], a[0:3], a[36:39], v[112:115]
    ds_read_b64_tr_b16 a[84:85], v14 offset:32928
    v_mfma_f32_16x16x32_bf16 v[116:119], a[4:7], a[36:39], v[116:119]
    ds_read_b64_tr_b16 a[86:87], v14 offset:33440
    v_mfma_f32_16x16x32_bf16 v[120:123], a[8:11], a[36:39], v[120:123]
    ds_read_b128 a[60:63], v12 offset:23680
    v_mfma_f32_16x16x32_bf16 v[124:127], a[12:15], a[36:39], v[124:127]
    buffer_load_dword v5, s[28:31], s23 offen offset:2048 lds
    s_add_u32 s23, s23, 0x20000
    v_mfma_f32_16x16x32_bf16 v[128:131], a[0:3], a[40:43], v[128:131]
    v_mfma_f32_16x16x32_bf16 v[132:135], a[4:7], a[40:43], v[132:135]
    v_mfma_f32_16x16x32_bf16 v[136:139], a[8:11], a[40:43], v[136:139]
    v_mfma_f32_16x16x32_bf16 v[140:143], a[12:15], a[40:43], v[140:143]
    s_waitcnt lgkmcnt(0)
    s_waitcnt vmcnt(24)
    s_barrier
    v_mfma_f32_16x16x32_bf16 v[48:51], a[64:67], a[44:47], v[48:51]
    ds_read_b64_tr_b16 a[20:21], v14 offset:52480
    v_mfma_f32_16x16x32_bf16 v[52:55], a[64:67], a[48:51], v[52:55]
    ds_read_b64_tr_b16 a[22:23], v14 offset:52992
    s_add_u32 m0, s24, 21632
    s_nop 0
    buffer_load_dwordx4 v6, s[32:35], s25 offen lds
    v_mfma_f32_16x16x32_bf16 v[56:59], a[64:67], a[52:55], v[56:59]
    ds_read_b64_tr_b16 a[24:25], v14 offset:52512
    v_mfma_f32_16x16x32_bf16 v[60:63], a[64:67], a[56:59], v[60:63]
    ds_read_b64_tr_b16 a[26:27], v14 offset:53024
    v_mfma_f32_16x16x32_bf16 v[64:67], a[68:71], a[44:47], v[64:67]
    v_mfma_f32_16x16x32_bf16 v[68:71], a[68:71], a[48:51], v[68:71]
    ds_read_b64_tr_b16 a[28:29], v14 offset:53504
    buffer_load_dwordx4 v7, s[32:35], s25 offen offset:1024 lds
    v_mfma_f32_16x16x32_bf16 v[72:75], a[68:71], a[52:55], v[72:75]
    ds_read_b64_tr_b16 a[30:31], v14 offset:54016
    v_mfma_f32_16x16x32_bf16 v[76:79], a[68:71], a[56:59], v[76:79]
    ds_read_b64_tr_b16 a[32:33], v14 offset:53536
    v_mfma_f32_16x16x32_bf16 v[80:83], a[72:75], a[44:47], v[80:83]
    v_mfma_f32_16x16x32_bf16 v[84:87], a[72:75], a[48:51], v[84:87]
    ds_read_b64_tr_b16 a[34:35], v14 offset:54048
    buffer_load_dwordx4 v8, s[32:35], s25 offen offset:2048 lds
    s_add_u32 s25, s25, 196608
    v_mfma_f32_16x16x32_bf16 v[88:91], a[72:75], a[52:55], v[88:91]
    ds_read_b128 a[0:3], v10 offset:43264
    v_mfma_f32_16x16x32_bf16 v[92:95], a[72:75], a[56:59], v[92:95]
    ds_read_b128 a[4:7], v10 offset:44288
    v_mfma_f32_16x16x32_bf16 v[144:147], a[72:75], a[60:63], v[144:147]
    ds_read_b64_tr_b16 a[36:37], v14 offset:54528
    v_mfma_f32_16x16x32_bf16 v[96:99], a[76:79], a[44:47], v[96:99]
    s_add_u32 m0, s22, 21632
    s_nop 0
    buffer_load_dwordx4 v4, s[28:31], s23 offen lds
    v_mfma_f32_16x16x32_bf16 v[100:103], a[76:79], a[48:51], v[100:103]
    ds_read_b64_tr_b16 a[38:39], v14 offset:55040
    v_mfma_f32_16x16x32_bf16 v[104:107], a[76:79], a[52:55], v[104:107]
    ds_read_b128 a[8:11], v10 offset:45568
    v_mfma_f32_16x16x32_bf16 v[108:111], a[76:79], a[56:59], v[108:111]
    ds_read_b128 a[12:15], v10 offset:46592
    v_mfma_f32_16x16x32_bf16 v[148:151], a[76:79], a[60:63], v[148:151]
    buffer_load_dwordx4 v4, s[28:31], s23 offen offset:1024 lds
    v_mfma_f32_16x16x32_bf16 v[112:115], a[44:47], a[80:83], v[112:115]
    ds_read_b64_tr_b16 a[40:41], v14 offset:54560
    v_mfma_f32_16x16x32_bf16 v[116:119], a[48:51], a[80:83], v[116:119]
    ds_read_b64_tr_b16 a[42:43], v14 offset:55072
    v_mfma_f32_16x16x32_bf16 v[120:123], a[52:55], a[80:83], v[120:123]
    ds_read_b128 a[16:19], v12 offset:45312
    v_mfma_f32_16x16x32_bf16 v[124:127], a[56:59], a[80:83], v[124:127]
    buffer_load_dword v5, s[28:31], s23 offen offset:2048 lds
    s_add_u32 s23, s23, 0x20000
    v_mfma_f32_16x16x32_bf16 v[128:131], a[44:47], a[84:87], v[128:131]
    v_mfma_f32_16x16x32_bf16 v[132:135], a[48:51], a[84:87], v[132:135]
    v_mfma_f32_16x16x32_bf16 v[136:139], a[52:55], a[84:87], v[136:139]
    v_mfma_f32_16x16x32_bf16 v[140:143], a[56:59], a[84:87], v[140:143]
    s_waitcnt lgkmcnt(0)
    s_waitcnt vmcnt(24)
    s_barrier
    v_mfma_f32_16x16x32_bf16 v[48:51], a[20:23], a[0:3], v[48:51]
    ds_read_b64_tr_b16 a[64:65], v15 offset:9216
    v_mfma_f32_16x16x32_bf16 v[52:55], a[20:23], a[4:7], v[52:55]
    ds_read_b64_tr_b16 a[66:67], v15 offset:9728
    s_add_u32 m0, s24, 43264
    s_nop 0
    buffer_load_dwordx4 v6, s[32:35], s25 offen lds
    v_mfma_f32_16x16x32_bf16 v[56:59], a[20:23], a[8:11], v[56:59]
    ds_read_b64_tr_b16 a[68:69], v15 offset:9248
    v_mfma_f32_16x16x32_bf16 v[60:63], a[20:23], a[12:15], v[60:63]
    ds_read_b64_tr_b16 a[70:71], v15 offset:9760
    v_mfma_f32_16x16x32_bf16 v[64:67], a[24:27], a[0:3], v[64:67]
    v_mfma_f32_16x16x32_bf16 v[68:71], a[24:27], a[4:7], v[68:71]
    ds_read_b64_tr_b16 a[72:73], v15 offset:10240
    buffer_load_dwordx4 v7, s[32:35], s25 offen offset:1024 lds
    v_mfma_f32_16x16x32_bf16 v[72:75], a[24:27], a[8:11], v[72:75]
    ds_read_b64_tr_b16 a[74:75], v15 offset:10752
    v_mfma_f32_16x16x32_bf16 v[76:79], a[24:27], a[12:15], v[76:79]
    ds_read_b64_tr_b16 a[76:77], v15 offset:10272
    v_mfma_f32_16x16x32_bf16 v[80:83], a[28:31], a[0:3], v[80:83]
    v_mfma_f32_16x16x32_bf16 v[84:87], a[28:31], a[4:7], v[84:87]
    ds_read_b64_tr_b16 a[78:79], v15 offset:10784
    buffer_load_dwordx4 v8, s[32:35], s25 offen offset:2048 lds
    s_add_u32 s25, s25, 196608
    v_mfma_f32_16x16x32_bf16 v[88:91], a[28:31], a[8:11], v[88:91]
    ds_read_b128 a[44:47], v11 offset:0
    v_mfma_f32_16x16x32_bf16 v[92:95], a[28:31], a[12:15], v[92:95]
    ds_read_b128 a[48:51], v11 offset:1024
    v_mfma_f32_16x16x32_bf16 v[144:147], a[28:31], a[16:19], v[144:147]
    ds_read_b64_tr_b16 a[80:81], v15 offset:11264
    v_mfma_f32_16x16x32_bf16 v[96:99], a[32:35], a[0:3], v[96:99]
    s_add_u32 m0, s22, 43264
    s_nop 0
    buffer_load_dwordx4 v4, s[28:31], s23 offen lds
    v_mfma_f32_16x16x32_bf16 v[100:103], a[32:35], a[4:7], v[100:103]
    ds_read_b64_tr_b16 a[82:83], v15 offset:11776
    v_mfma_f32_16x16x32_bf16 v[104:107], a[32:35], a[8:11], v[104:107]
    ds_read_b128 a[52:55], v11 offset:2304
    v_mfma_f32_16x16x32_bf16 v[108:111], a[32:35], a[12:15], v[108:111]
    ds_read_b128 a[56:59], v11 offset:3328
    v_mfma_f32_16x16x32_bf16 v[148:151], a[32:35], a[16:19], v[148:151]
    buffer_load_dwordx4 v4, s[28:31], s23 offen offset:1024 lds
    v_mfma_f32_16x16x32_bf16 v[112:115], a[0:3], a[36:39], v[112:115]
    ds_read_b64_tr_b16 a[84:85], v15 offset:11296
    v_mfma_f32_16x16x32_bf16 v[116:119], a[4:7], a[36:39], v[116:119]
    ds_read_b64_tr_b16 a[86:87], v15 offset:11808
    v_mfma_f32_16x16x32_bf16 v[120:123], a[8:11], a[36:39], v[120:123]
    ds_read_b128 a[60:63], v13 offset:2048
    v_mfma_f32_16x16x32_bf16 v[124:127], a[12:15], a[36:39], v[124:127]
    buffer_load_dword v5, s[28:31], s23 offen offset:2048 lds
    s_add_u32 s23, s23, 0x20000
    v_mfma_f32_16x16x32_bf16 v[128:131], a[0:3], a[40:43], v[128:131]
    v_mfma_f32_16x16x32_bf16 v[132:135], a[4:7], a[40:43], v[132:135]
    v_mfma_f32_16x16x32_bf16 v[136:139], a[8:11], a[40:43], v[136:139]
    v_mfma_f32_16x16x32_bf16 v[140:143], a[12:15], a[40:43], v[140:143]
    s_waitcnt lgkmcnt(0)
    s_waitcnt vmcnt(24)
    s_barrier
    v_mfma_f32_16x16x32_bf16 v[48:51], a[64:67], a[44:47], v[48:51]
    ds_read_b64_tr_b16 a[20:21], v15 offset:30848
    v_mfma_f32_16x16x32_bf16 v[52:55], a[64:67], a[48:51], v[52:55]
    ds_read_b64_tr_b16 a[22:23], v15 offset:31360
    s_add_u32 m0, s24, 64896
    s_nop 0
    buffer_load_dwordx4 v6, s[32:35], s25 offen lds
    v_mfma_f32_16x16x32_bf16 v[56:59], a[64:67], a[52:55], v[56:59]
    ds_read_b64_tr_b16 a[24:25], v15 offset:30880
    v_mfma_f32_16x16x32_bf16 v[60:63], a[64:67], a[56:59], v[60:63]
    ds_read_b64_tr_b16 a[26:27], v15 offset:31392
    v_mfma_f32_16x16x32_bf16 v[64:67], a[68:71], a[44:47], v[64:67]
    v_mfma_f32_16x16x32_bf16 v[68:71], a[68:71], a[48:51], v[68:71]
    ds_read_b64_tr_b16 a[28:29], v15 offset:31872
    buffer_load_dwordx4 v7, s[32:35], s25 offen offset:1024 lds
    v_mfma_f32_16x16x32_bf16 v[72:75], a[68:71], a[52:55], v[72:75]
    ds_read_b64_tr_b16 a[30:31], v15 offset:32384
    v_mfma_f32_16x16x32_bf16 v[76:79], a[68:71], a[56:59], v[76:79]
    ds_read_b64_tr_b16 a[32:33], v15 offset:31904
    v_mfma_f32_16x16x32_bf16 v[80:83], a[72:75], a[44:47], v[80:83]
    v_mfma_f32_16x16x32_bf16 v[84:87], a[72:75], a[48:51], v[84:87]
    ds_read_b64_tr_b16 a[34:35], v15 offset:32416
    buffer_load_dwordx4 v8, s[32:35], s25 offen offset:2048 lds
    s_add_u32 s25, s25, 196608
    v_mfma_f32_16x16x32_bf16 v[88:91], a[72:75], a[52:55], v[88:91]
    ds_read_b128 a[0:3], v11 offset:21632
    v_mfma_f32_16x16x32_bf16 v[92:95], a[72:75], a[56:59], v[92:95]
    ds_read_b128 a[4:7], v11 offset:22656
    v_mfma_f32_16x16x32_bf16 v[144:147], a[72:75], a[60:63], v[144:147]
    ds_read_b64_tr_b16 a[36:37], v15 offset:32896
    v_mfma_f32_16x16x32_bf16 v[96:99], a[76:79], a[44:47], v[96:99]
    s_add_u32 m0, s22, 64896
    s_nop 0
    buffer_load_dwordx4 v4, s[28:31], s23 offen lds
    v_mfma_f32_16x16x32_bf16 v[100:103], a[76:79], a[48:51], v[100:103]
    ds_read_b64_tr_b16 a[38:39], v15 offset:33408
    v_mfma_f32_16x16x32_bf16 v[104:107], a[76:79], a[52:55], v[104:107]
    ds_read_b128 a[8:11], v11 offset:23936
    v_mfma_f32_16x16x32_bf16 v[108:111], a[76:79], a[56:59], v[108:111]
    ds_read_b128 a[12:15], v11 offset:24960
    v_mfma_f32_16x16x32_bf16 v[148:151], a[76:79], a[60:63], v[148:151]
    buffer_load_dwordx4 v4, s[28:31], s23 offen offset:1024 lds
    v_mfma_f32_16x16x32_bf16 v[112:115], a[44:47], a[80:83], v[112:115]
    ds_read_b64_tr_b16 a[40:41], v15 offset:32928
    v_mfma_f32_16x16x32_bf16 v[116:119], a[48:51], a[80:83], v[116:119]
    ds_read_b64_tr_b16 a[42:43], v15 offset:33440
    v_mfma_f32_16x16x32_bf16 v[120:123], a[52:55], a[80:83], v[120:123]
    ds_read_b128 a[16:19], v13 offset:23680
    v_mfma_f32_16x16x32_bf16 v[124:127], a[56:59], a[80:83], v[124:127]
    buffer_load_dword v5, s[28:31], s23 offen offset:2048 lds
    s_add_u32 s23, s23, 0x20000
    v_mfma_f32_16x16x32_bf16 v[128:131], a[44:47], a[84:87], v[128:131]
    v_mfma_f32_16x16x32_bf16 v[132:135], a[48:51], a[84:87], v[132:135]
    v_mfma_f32_16x16x32_bf16 v[136:139], a[52:55], a[84:87], v[136:139]
    v_mfma_f32_16x16x32_bf16 v[140:143], a[56:59], a[84:87], v[140:143]
    s_waitcnt lgkmcnt(0)
    s_waitcnt vmcnt(24)
    s_barrier
    v_mfma_f32_16x16x32_bf16 v[48:51], a[20:23], a[0:3], v[48:51]
    ds_read_b64_tr_b16 a[64:65], v15 offset:52480
    v_mfma_f32_16x16x32_bf16 v[52:55], a[20:23], a[4:7], v[52:55]
    ds_read_b64_tr_b16 a[66:67], v15 offset:52992
    s_add_u32 m0, s24, 86528
    s_nop 0
    buffer_load_dwordx4 v6, s[32:35], s25 offen lds
    v_mfma_f32_16x16x32_bf16 v[56:59], a[20:23], a[8:11], v[56:59]
    ds_read_b64_tr_b16 a[68:69], v15 offset:52512
    v_mfma_f32_16x16x32_bf16 v[60:63], a[20:23], a[12:15], v[60:63]
    ds_read_b64_tr_b16 a[70:71], v15 offset:53024
    v_mfma_f32_16x16x32_bf16 v[64:67], a[24:27], a[0:3], v[64:67]
    v_mfma_f32_16x16x32_bf16 v[68:71], a[24:27], a[4:7], v[68:71]
    ds_read_b64_tr_b16 a[72:73], v15 offset:53504
    buffer_load_dwordx4 v7, s[32:35], s25 offen offset:1024 lds
    v_mfma_f32_16x16x32_bf16 v[72:75], a[24:27], a[8:11], v[72:75]
    ds_read_b64_tr_b16 a[74:75], v15 offset:54016
    v_mfma_f32_16x16x32_bf16 v[76:79], a[24:27], a[12:15], v[76:79]
    ds_read_b64_tr_b16 a[76:77], v15 offset:53536
    v_mfma_f32_16x16x32_bf16 v[80:83], a[28:31], a[0:3], v[80:83]
    v_mfma_f32_16x16x32_bf16 v[84:87], a[28:31], a[4:7], v[84:87]
    ds_read_b64_tr_b16 a[78:79], v15 offset:54048
    buffer_load_dwordx4 v8, s[32:35], s25 offen offset:2048 lds
    s_add_u32 s25, s25, 196608
    v_mfma_f32_16x16x32_bf16 v[88:91], a[28:31], a[8:11], v[88:91]
    ds_read_b128 a[44:47], v11 offset:43264
    v_mfma_f32_16x16x32_bf16 v[92:95], a[28:31], a[12:15], v[92:95]
    ds_read_b128 a[48:51], v11 offset:44288
    v_mfma_f32_16x16x32_bf16 v[144:147], a[28:31], a[16:19], v[144:147]
    ds_read_b64_tr_b16 a[80:81], v15 offset:54528
    v_mfma_f32_16x16x32_bf16 v[96:99], a[32:35], a[0:3], v[96:99]
    s_add_u32 m0, s22, 86528
    s_nop 0
    buffer_load_dwordx4 v4, s[28:31], s23 offen lds
    v_mfma_f32_16x16x32_bf16 v[100:103], a[32:35], a[4:7], v[100:103]
    ds_read_b64_tr_b16 a[82:83], v15 offset:55040
    v_mfma_f32_16x16x32_bf16 v[104:107], a[32:35], a[8:11], v[104:107]
    ds_read_b128 a[52:55], v11 offset:45568
    v_mfma_f32_16x16x32_bf16 v[108:111], a[32:35], a[12:15], v[108:111]
    ds_read_b128 a[56:59], v11 offset:46592
    v_mfma_f32_16x16x32_bf16 v[148:151], a[32:35], a[16:19], v[148:151]
    buffer_load_dwordx4 v4, s[28:31], s23 offen offset:1024 lds
    v_mfma_f32_16x16x32_bf16 v[112:115], a[0:3], a[36:39], v[112:115]
    ds_read_b64_tr_b16 a[84:85], v15 offset:54560
    v_mfma_f32_16x16x32_bf16 v[116:119], a[4:7], a[36:39], v[116:119]
    ds_read_b64_tr_b16 a[86:87], v15 offset:55072
    v_mfma_f32_16x16x32_bf16 v[120:123], a[8:11], a[36:39], v[120:123]
    ds_read_b128 a[60:63], v13 offset:45312
    v_mfma_f32_16x16x32_bf16 v[124:127], a[12:15], a[36:39], v[124:127]
    buffer_load_dword v5, s[28:31], s23 offen offset:2048 lds
    s_add_u32 s23, s23, 0x20000
    v_mfma_f32_16x16x32_bf16 v[128:131], a[0:3], a[40:43], v[128:131]
    v_mfma_f32_16x16x32_bf16 v[132:135], a[4:7], a[40:43], v[132:135]
    v_mfma_f32_16x16x32_bf16 v[136:139], a[8:11], a[40:43], v[136:139]
    v_mfma_f32_16x16x32_bf16 v[140:143], a[12:15], a[40:43], v[140:143]
    s_waitcnt lgkmcnt(0)
    s_waitcnt vmcnt(24)
    s_barrier
    v_mfma_f32_16x16x32_bf16 v[48:51], a[64:67], a[44:47], v[48:51]
    ds_read_b64_tr_b16 a[20:21], v14 offset:9216
    v_mfma_f32_16x16x32_bf16 v[52:55], a[64:67], a[48:51], v[52:55]
    ds_read_b64_tr_b16 a[22:23], v14 offset:9728
    s_add_u32 m0, s24, 108160
    s_nop 0
    buffer_load_dwordx4 v6, s[32:35], s25 offen lds
    v_mfma_f32_16x16x32_bf16 v[56:59], a[64:67], a[52:55], v[56:59]
    ds_read_b64_tr_b16 a[24:25], v14 offset:9248
    v_mfma_f32_16x16x32_bf16 v[60:63], a[64:67], a[56:59], v[60:63]
    ds_read_b64_tr_b16 a[26:27], v14 offset:9760
    v_mfma_f32_16x16x32_bf16 v[64:67], a[68:71], a[44:47], v[64:67]
    v_mfma_f32_16x16x32_bf16 v[68:71], a[68:71], a[48:51], v[68:71]
    ds_read_b64_tr_b16 a[28:29], v14 offset:10240
    buffer_load_dwordx4 v7, s[32:35], s25 offen offset:1024 lds
    v_mfma_f32_16x16x32_bf16 v[72:75], a[68:71], a[52:55], v[72:75]
    ds_read_b64_tr_b16 a[30:31], v14 offset:10752
    v_mfma_f32_16x16x32_bf16 v[76:79], a[68:71], a[56:59], v[76:79]
    ds_read_b64_tr_b16 a[32:33], v14 offset:10272
    v_mfma_f32_16x16x32_bf16 v[80:83], a[72:75], a[44:47], v[80:83]
    v_mfma_f32_16x16x32_bf16 v[84:87], a[72:75], a[48:51], v[84:87]
    ds_read_b64_tr_b16 a[34:35], v14 offset:10784
    buffer_load_dwordx4 v8, s[32:35], s25 offen offset:2048 lds
    s_add_u32 s25, s25, 196608
    v_mfma_f32_16x16x32_bf16 v[88:91], a[72:75], a[52:55], v[88:91]
    ds_read_b128 a[0:3], v10 offset:0
    v_mfma_f32_16x16x32_bf16 v[92:95], a[72:75], a[56:59], v[92:95]
    ds_read_b128 a[4:7], v10 offset:1024
    v_mfma_f32_16x16x32_bf16 v[144:147], a[72:75], a[60:63], v[144:147]
    ds_read_b64_tr_b16 a[36:37], v14 offset:11264
    v_mfma_f32_16x16x32_bf16 v[96:99], a[76:79], a[44:47], v[96:99]
    s_add_u32 m0, s22, 108160
    s_nop 0
    buffer_load_dwordx4 v4, s[28:31], s23 offen lds
    v_mfma_f32_16x16x32_bf16 v[100:103], a[76:79], a[48:51], v[100:103]
    ds_read_b64_tr_b16 a[38:39], v14 offset:11776
    v_mfma_f32_16x16x32_bf16 v[104:107], a[76:79], a[52:55], v[104:107]
    ds_read_b128 a[8:11], v10 offset:2304
    v_mfma_f32_16x16x32_bf16 v[108:111], a[76:79], a[56:59], v[108:111]
    ds_read_b128 a[12:15], v10 offset:3328
    v_mfma_f32_16x16x32_bf16 v[148:151], a[76:79], a[60:63], v[148:151]
    buffer_load_dwordx4 v4, s[28:31], s23 offen offset:1024 lds
    v_mfma_f32_16x16x32_bf16 v[112:115], a[44:47], a[80:83], v[112:115]
    ds_read_b64_tr_b16 a[40:41], v14 offset:11296
    v_mfma_f32_16x16x32_bf16 v[116:119], a[48:51], a[80:83], v[116:119]
    ds_read_b64_tr_b16 a[42:43], v14 offset:11808
    v_mfma_f32_16x16x32_bf16 v[120:123], a[52:55], a[80:83], v[120:123]
    ds_read_b128 a[16:19], v12 offset:2048
    v_mfma_f32_16x16x32_bf16 v[124:127], a[56:59], a[80:83], v[124:127]
    buffer_load_dword v5, s[28:31], s23 offen offset:2048 lds
    s_add_u32 s23, s23, 0x20000
    v_mfma_f32_16x16x32_bf16 v[128:131], a[44:47], a[84:87], v[128:131]
    v_mfma_f32_16x16x32_bf16 v[132:135], a[48:51], a[84:87], v[132:135]
    v_mfma_f32_16x16x32_bf16 v[136:139], a[52:55], a[84:87], v[136:139]
    v_mfma_f32_16x16x32_bf16 v[140:143], a[56:59], a[84:87], v[140:143]
    s_sub_u32 s48, s48, 1
    s_cmp_lg_u32 s48, 0
    s_cbranch_scc1 qkv2_kernel_t0_loop
    s_waitcnt lgkmcnt(0)
    s_waitcnt vmcnt(24)
    s_barrier
    v_mfma_f32_16x16x32_bf16 v[48:51], a[20:23], a[0:3], v[48:51]
    ds_read_b64_tr_b16 a[64:65], v14 offset:30848
    v_mfma_f32_16x16x32_bf16 v[52:55], a[20:23], a[4:7], v[52:55]
    ds_read_b64_tr_b16 a[66:67], v14 offset:31360
    s_add_u32 m0, s24, 0
    s_nop 0
    buffer_load_dwordx4 v6, s[32:35], s25 offen lds
    v_mfma_f32_16x16x32_bf16 v[56:59], a[20:23], a[8:11], v[56:59]
    ds_read_b64_tr_b16 a[68:69], v14 offset:30880
    v_mfma_f32_16x16x32_bf16 v[60:63], a[20:23], a[12:15], v[60:63]
    ds_read_b64_tr_b16 a[70:71], v14 offset:31392
    v_mfma_f32_16x16x32_bf16 v[64:67], a[24:27], a[0:3], v[64:67]
    v_mfma_f32_16x16x32_bf16 v[68:71], a[24:27], a[4:7], v[68:71]
    ds_read_b64_tr_b16 a[72:73], v14 offset:31872
    buffer_load_dwordx4 v7, s[32:35], s25 offen offset:1024 lds
    v_mfma_f32_16x16x32_bf16 v[72:75], a[24:27], a[8:11], v[72:75]
    ds_read_b64_tr_b16 a[74:75], v14 offset:32384
    v_mfma_f32_16x16x32_bf16 v[76:79], a[24:27], a[12:15], v[76:79]
    ds_read_b64_tr_b16 a[76:77], v14 offset:31904
    v_mfma_f32_16x16x32_bf16 v[80:83], a[28:31], a[0:3], v[80:83]
    v_mfma_f32_16x16x32_bf16 v[84:87], a[28:31], a[4:7], v[84:87]
    ds_read_b64_tr_b16 a[78:79], v14 offset:32416
    buffer_load_dwordx4 v8, s[32:35], s25 offen offset:2048 lds
    s_add_u32 s25, s25, 196608
    v_mfma_f32_16x16x32_bf16 v[88:91], a[28:31], a[8:11], v[88:91]
    ds_read_b128 a[44:47], v10 offset:21632
    v_mfma_f32_16x16x32_bf16 v[92:95], a[28:31], a[12:15], v[92:95]
    ds_read_b128 a[48:51], v10 offset:22656
    v_mfma_f32_16x16x32_bf16 v[144:147], a[28:31], a[16:19], v[144:147]
    ds_read_b64_tr_b16 a[80:81], v14 offset:32896
    v_mfma_f32_16x16x32_bf16 v[96:99], a[32:35], a[0:3], v[96:99]
    s_add_u32 m0, s22, 0
    s_nop 0
    buffer_load_dwordx4 v4, s[28:31], s23 offen lds
    v_mfma_f32_16x16x32_bf16 v[100:103], a[32:35], a[4:7], v[100:103]
    ds_read_b64_tr_b16 a[82:83], v14 offset:33408
    v_mfma_f32_16x16x32_bf16 v[104:107], a[32:35], a[8:11], v[104:107]
    ds_read_b128 a[52:55], v10 offset:23936
    v_mfma_f32_16x16x32_bf16 v[108:111], a[32:35], a[12:15], v[108:111]
    ds_read_b128 a[56:59], v10 offset:24960
    v_mfma_f32_16x16x32_bf16 v[148:151], a[32:35], a[16:19], v[148:151]
    buffer_load_dwordx4 v4, s[28:31], s23 offen offset:1024 lds
    v_mfma_f32_16x16x32_bf16 v[112:115], a[0:3], a[36:39], v[112:115]
    ds_read_b64_tr_b16 a[84:85], v14 offset:32928
    v_mfma_f32_16x16x32_bf16 v[116:119], a[4:7], a[36:39], v[116:119]
    ds_read_b64_tr_b16 a[86:87], v14 offset:33440
    v_mfma_f32_16x16x32_bf16 v[120:123], a[8:11], a[36:39], v[120:123]
    ds_read_b128 a[60:63], v12 offset:23680
    v_mfma_f32_16x16x32_bf16 v[124:127], a[12:15], a[36:39], v[124:127]
    buffer_load_dword v5, s[28:31], s23 offen offset:2048 lds
    s_add_u32 s23, s23, 0x20000
    v_mfma_f32_16x16x32_bf16 v[128:131], a[0:3], a[40:43], v[128:131]
    v_mfma_f32_16x16x32_bf16 v[132:135], a[4:7], a[40:43], v[132:135]
    v_mfma_f32_16x16x32_bf16 v[136:139], a[8:11], a[40:43], v[136:139]
    v_mfma_f32_16x16x32_bf16 v[140:143], a[12:15], a[40:43], v[140:143]
    s_waitcnt lgkmcnt(0)
    s_waitcnt vmcnt(24)
    s_barrier
    v_mfma_f32_16x16x32_bf16 v[48:51], a[64:67], a[44:47], v[48:51]
    ds_read_b64_tr_b16 a[20:21], v14 offset:52480
    v_mfma_f32_16x16x32_bf16 v[52:55], a[64:67], a[48:51], v[52:55]
    ds_read_b64_tr_b16 a[22:23], v14 offset:52992
    s_add_u32 m0, s24, 21632
    s_nop 0
    buffer_load_dwordx4 v6, s[32:35], s25 offen lds
    v_mfma_f32_16x16x32_bf16 v[56:59], a[64:67], a[52:55], v[56:59]
    ds_read_b64_tr_b16 a[24:25], v14 offset:52512
    v_mfma_f32_16x16x32_bf16 v[60:63], a[64:67], a[56:59], v[60:63]
    ds_read_b64_tr_b16 a[26:27], v14 offset:53024
    v_mfma_f32_16x16x32_bf16 v[64:67], a[68:71], a[44:47], v[64:67]
    v_mfma_f32_16x16x32_bf16 v[68:71], a[68:71], a[48:51], v[68:71]
    ds_read_b64_tr_b16 a[28:29], v14 offset:53504
    buffer_load_dwordx4 v7, s[32:35], s25 offen offset:1024 lds
    v_mfma_f32_16x16x32_bf16 v[72:75], a[68:71], a[52:55], v[72:75]
    ds_read_b64_tr_b16 a[30:31], v14 offset:54016
    v_mfma_f32_16x16x32_bf16 v[76:79], a[68:71], a[56:59], v[76:79]
    ds_read_b64_tr_b16 a[32:33], v14 offset:53536
    v_mfma_f32_16x16x32_bf16 v[80:83], a[72:75], a[44:47], v[80:83]
    v_mfma_f32_16x16x32_bf16 v[84:87], a[72:75], a[48:51], v[84:87]
    ds_read_b64_tr_b16 a[34:35], v14 offset:54048
    buffer_load_dwordx4 v8, s[32:35], s25 offen offset:2048 lds
    s_add_u32 s25, s25, 196608
    v_mfma_f32_16x16x32_bf16 v[88:91], a[72:75], a[52:55], v[88:91]
    ds_read_b128 a[0:3], v10 offset:43264
    v_mfma_f32_16x16x32_bf16 v[92:95], a[72:75], a[56:59], v[92:95]
    ds_read_b128 a[4:7], v10 offset:44288
    v_mfma_f32_16x16x32_bf16 v[144:147], a[72:75], a[60:63], v[144:147]
    ds_read_b64_tr_b16 a[36:37], v14 offset:54528
    v_mfma_f32_16x16x32_bf16 v[96:99], a[76:79], a[44:47], v[96:99]
    s_add_u32 m0, s22, 21632
    s_nop 0
    buffer_load_dwordx4 v4, s[28:31], s23 offen lds
    v_mfma_f32_16x16x32_bf16 v[100:103], a[76:79], a[48:51], v[100:103]
    ds_read_b64_tr_b16 a[38:39], v14 offset:55040
    v_mfma_f32_16x16x32_bf16 v[104:107], a[76:79], a[52:55], v[104:107]
    ds_read_b128 a[8:11], v10 offset:45568
    v_mfma_f32_16x16x32_bf16 v[108:111], a[76:79], a[56:59], v[108:111]
    ds_read_b128 a[12:15], v10 offset:46592
    v_mfma_f32_16x16x32_bf16 v[148:151], a[76:79], a[60:63], v[148:151]
    buffer_load_dwordx4 v4, s[28:31], s23 offen offset:1024 lds
    v_mfma_f32_16x16x32_bf16 v[112:115], a[44:47], a[80:83], v[112:115]
    ds_read_b64_tr_b16 a[40:41], v14 offset:54560
    v_mfma_f32_16x16x32_bf16 v[116:119], a[48:51], a[80:83], v[116:119]
    ds_read_b64_tr_b16 a[42:43], v14 offset:55072
    v_mfma_f32_16x16x32_bf16 v[120:123], a[52:55], a[80:83], v[120:123]
    ds_read_b128 a[16:19], v12 offset:45312
    v_mfma_f32_16x16x32_bf16 v[124:127], a[56:59], a[80:83], v[124:127]
    buffer_load_dword v5, s[28:31], s23 offen offset:2048 lds
    s_add_u32 s23, s23, 0x20000
    v_mfma_f32_16x16x32_bf16 v[128:131], a[44:47], a[84:87], v[128:131]
    v_mfma_f32_16x16x32_bf16 v[132:135], a[48:51], a[84:87], v[132:135]
    v_mfma_f32_16x16x32_bf16 v[136:139], a[52:55], a[84:87], v[136:139]
    v_mfma_f32_16x16x32_bf16 v[140:143], a[56:59], a[84:87], v[140:143]
    s_waitcnt lgkmcnt(0)
    s_waitcnt vmcnt(24)
    s_barrier
    v_mfma_f32_16x16x32_bf16 v[48:51], a[20:23], a[0:3], v[48:51]
    ds_read_b64_tr_b16 a[64:65], v15 offset:9216
    v_mfma_f32_16x16x32_bf16 v[52:55], a[20:23], a[4:7], v[52:55]
    ds_read_b64_tr_b16 a[66:67], v15 offset:9728
    v_mfma_f32_16x16x32_bf16 v[56:59], a[20:23], a[8:11], v[56:59]
    ds_read_b64_tr_b16 a[68:69], v15 offset:9248
    v_mfma_f32_16x16x32_bf16 v[60:63], a[20:23], a[12:15], v[60:63]
    ds_read_b64_tr_b16 a[70:71], v15 offset:9760
    v_mfma_f32_16x16x32_bf16 v[64:67], a[24:27], a[0:3], v[64:67]
    v_mfma_f32_16x16x32_bf16 v[68:71], a[24:27], a[4:7], v[68:71]
    ds_read_b64_tr_b16 a[72:73], v15 offset:10240
    v_mfma_f32_16x16x32_bf16 v[72:75], a[24:27], a[8:11], v[72:75]
    ds_read_b64_tr_b16 a[74:75], v15 offset:10752
    v_mfma_f32_16x16x32_bf16 v[76:79], a[24:27], a[12:15], v[76:79]
    ds_read_b64_tr_b16 a[76:77], v15 offset:10272
    v_mfma_f32_16x16x32_bf16 v[80:83], a[28:31], a[0:3], v[80:83]
    v_mfma_f32_16x16x32_bf16 v[84:87], a[28:31], a[4:7], v[84:87]
    ds_read_b64_tr_b16 a[78:79], v15 offset:10784
    v_mfma_f32_16x16x32_bf16 v[88:91], a[28:31], a[8:11], v[88:91]
    ds_read_b128 a[44:47], v11 offset:0
    v_mfma_f32_16x16x32_bf16 v[92:95], a[28:31], a[12:15], v[92:95]
    ds_read_b128 a[48:51], v11 offset:1024
    v_mfma_f32_16x16x32_bf16 v[144:147], a[28:31], a[16:19], v[144:147]
    ds_read_b64_tr_b16 a[80:81], v15 offset:11264
    v_mfma_f32_16x16x32_bf16 v[96:99], a[32:35], a[0:3], v[96:99]
    v_mfma_f32_16x16x32_bf16 v[100:103], a[32:35], a[4:7], v[100:103]
    ds_read_b64_tr_b16 a[82:83], v15 offset:11776
    v_mfma_f32_16x16x32_bf16 v[104:107], a[32:35], a[8:11], v[104:107]
    ds_read_b128 a[52:55], v11 offset:2304
    v_mfma_f32_16x16x32_bf16 v[108:111], a[32:35], a[12:15], v[108:111]
    ds_read_b128 a[56:59], v11 offset:3328
    v_mfma_f32_16x16x32_bf16 v[148:151], a[32:35], a[16:19], v[148:151]
    v_mfma_f32_16x16x32_bf16 v[112:115], a[0:3], a[36:39], v[112:115]
    ds_read_b64_tr_b16 a[84:85], v15 offset:11296
    v_mfma_f32_16x16x32_bf16 v[116:119], a[4:7], a[36:39], v[116:119]
    ds_read_b64_tr_b16 a[86:87], v15 offset:11808
    v_mfma_f32_16x16x32_bf16 v[120:123], a[8:11], a[36:39], v[120:123]
    ds_read_b128 a[60:63], v13 offset:2048
    v_mfma_f32_16x16x32_bf16 v[124:127], a[12:15], a[36:39], v[124:127]
    v_mfma_f32_16x16x32_bf16 v[128:131], a[0:3], a[40:43], v[128:131]
    v_mfma_f32_16x16x32_bf16 v[132:135], a[4:7], a[40:43], v[132:135]
    v_mfma_f32_16x16x32_bf16 v[136:139], a[8:11], a[40:43], v[136:139]
    v_mfma_f32_16x16x32_bf16 v[140:143], a[12:15], a[40:43], v[140:143]
    s_waitcnt lgkmcnt(0)
    s_waitcnt vmcnt(18)
    s_barrier
    v_mfma_f32_16x16x32_bf16 v[48:51], a[64:67], a[44:47], v[48:51]
    ds_read_b64_tr_b16 a[20:21], v15 offset:30848
    v_mfma_f32_16x16x32_bf16 v[52:55], a[64:67], a[48:51], v[52:55]
    ds_read_b64_tr_b16 a[22:23], v15 offset:31360
    v_mfma_f32_16x16x32_bf16 v[56:59], a[64:67], a[52:55], v[56:59]
    ds_read_b64_tr_b16 a[24:25], v15 offset:30880
    v_mfma_f32_16x16x32_bf16 v[60:63], a[64:67], a[56:59], v[60:63]
    ds_read_b64_tr_b16 a[26:27], v15 offset:31392
    v_mfma_f32_16x16x32_bf16 v[64:67], a[68:71], a[44:47], v[64:67]
    v_mfma_f32_16x16x32_bf16 v[68:71], a[68:71], a[48:51], v[68:71]
    ds_read_b64_tr_b16 a[28:29], v15 offset:31872
    v_mfma_f32_16x16x32_bf16 v[72:75], a[68:71], a[52:55], v[72:75]
    ds_read_b64_tr_b16 a[30:31], v15 offset:32384
    v_mfma_f32_16x16x32_bf16 v[76:79], a[68:71], a[56:59], v[76:79]
    ds_read_b64_tr_b16 a[32:33], v15 offset:31904
    v_mfma_f32_16x16x32_bf16 v[80:83], a[72:75], a[44:47], v[80:83]
    v_mfma_f32_16x16x32_bf16 v[84:87], a[72:75], a[48:51], v[84:87]
    ds_read_b64_tr_b16 a[34:35], v15 offset:32416
    v_mfma_f32_16x16x32_bf16 v[88:91], a[72:75], a[52:55], v[88:91]
    ds_read_b128 a[0:3], v11 offset:21632
    v_mfma_f32_16x16x32_bf16 v[92:95], a[72:75], a[56:59], v[92:95]
    ds_read_b128 a[4:7], v11 offset:22656
    v_mfma_f32_16x16x32_bf16 v[144:147], a[72:75], a[60:63], v[144:147]
    ds_read_b64_tr_b16 a[36:37], v15 offset:32896
    v_mfma_f32_16x16x32_bf16 v[96:99], a[76:79], a[44:47], v[96:99]
    v_mfma_f32_16x16x32_bf16 v[100:103], a[76:79], a[48:51], v[100:103]
    ds_read_b64_tr_b16 a[38:39], v15 offset:33408
    v_mfma_f32_16x16x32_bf16 v[104:107], a[76:79], a[52:55], v[104:107]
    ds_read_b128 a[8:11], v11 offset:23936
    v_mfma_f32_16x16x32_bf16 v[108:111], a[76:79], a[56:59], v[108:111]
    ds_read_b128 a[12:15], v11 offset:24960
    v_mfma_f32_16x16x32_bf16 v[148:151], a[76:79], a[60:63], v[148:151]
    v_mfma_f32_16x16x32_bf16 v[112:115], a[44:47], a[80:83], v[112:115]
    ds_read_b64_tr_b16 a[40:41], v15 offset:32928
    v_mfma_f32_16x16x32_bf16 v[116:119], a[48:51], a[80:83], v[116:119]
    ds_read_b64_tr_b16 a[42:43], v15 offset:33440
    v_mfma_f32_16x16x32_bf16 v[120:123], a[52:55], a[80:83], v[120:123]
    ds_read_b128 a[16:19], v13 offset:23680
    v_mfma_f32_16x16x32_bf16 v[124:127], a[56:59], a[80:83], v[124:127]
    v_mfma_f32_16x16x32_bf16 v[128:131], a[44:47], a[84:87], v[128:131]
    v_mfma_f32_16x16x32_bf16 v[132:135], a[48:51], a[84:87], v[132:135]
    v_mfma_f32_16x16x32_bf16 v[136:139], a[52:55], a[84:87], v[136:139]
    v_mfma_f32_16x16x32_bf16 v[140:143], a[56:59], a[84:87], v[140:143]
    s_waitcnt lgkmcnt(0)
    s_waitcnt vmcnt(12)
    s_barrier
    v_mfma_f32_16x16x32_bf16 v[48:51], a[20:23], a[0:3], v[48:51]
    ds_read_b64_tr_b16 a[64:65], v15 offset:52480
    v_mfma_f32_16x16x32_bf16 v[52:55], a[20:23], a[4:7], v[52:55]
    ds_read_b64_tr_b16 a[66:67], v15 offset:52992
    v_mfma_f32_16x16x32_bf16 v[56:59], a[20:23], a[8:11], v[56:59]
    ds_read_b64_tr_b16 a[68:69], v15 offset:52512
    v_mfma_f32_16x16x32_bf16 v[60:63], a[20:23], a[12:15], v[60:63]
    ds_read_b64_tr_b16 a[70:71], v15 offset:53024
    v_mfma_f32_16x16x32_bf16 v[64:67], a[24:27], a[0:3], v[64:67]
    v_mfma_f32_16x16x32_bf16 v[68:71], a[24:27], a[4:7], v[68:71]
    ds_read_b64_tr_b16 a[72:73], v15 offset:53504
    v_mfma_f32_16x16x32_bf16 v[72:75], a[24:27], a[8:11], v[72:75]
    ds_read_b64_tr_b16 a[74:75], v15 offset:54016
    v_mfma_f32_16x16x32_bf16 v[76:79], a[24:27], a[12:15], v[76:79]
    ds_read_b64_tr_b16 a[76:77], v15 offset:53536
    v_mfma_f32_16x16x32_bf16 v[80:83], a[28:31], a[0:3], v[80:83]
    v_mfma_f32_16x16x32_bf16 v[84:87], a[28:31], a[4:7], v[84:87]
    ds_read_b64_tr_b16 a[78:79], v15 offset:54048
    v_mfma_f32_16x16x32_bf16 v[88:91], a[28:31], a[8:11], v[88:91]
    ds_read_b128 a[44:47], v11 offset:43264
    v_mfma_f32_16x16x32_bf16 v[92:95], a[28:31], a[12:15], v[92:95]
    ds_read_b128 a[48:51], v11 offset:44288
    v_mfma_f32_16x16x32_bf16 v[144:147], a[28:31], a[16:19], v[144:147]
    ds_read_b64_tr_b16 a[80:81], v15 offset:54528
    v_mfma_f32_16x16x32_bf16 v[96:99], a[32:35], a[0:3], v[96:99]
    v_mfma_f32_16x16x32_bf16 v[100:103], a[32:35], a[4:7], v[100:103]
    ds_read_b64_tr_b16 a[82:83], v15 offset:55040
    v_mfma_f32_16x16x32_bf16 v[104:107], a[32:35], a[8:11], v[104:107]
    ds_read_b128 a[52:55], v11 offset:45568
    v_mfma_f32_16x16x32_bf16 v[108:111], a[32:35], a[12:15], v[108:111]
    ds_read_b128 a[56:59], v11 offset:46592
    v_mfma_f32_16x16x32_bf16 v[148:151], a[32:35], a[16:19], v[148:151]
    v_mfma_f32_16x16x32_bf16 v[112:115], a[0:3], a[36:39], v[112:115]
    ds_read_b64_tr_b16 a[84:85], v15 offset:54560
    v_mfma_f32_16x16x32_bf16 v[116:119], a[4:7], a[36:39], v[116:119]
    ds_read_b64_tr_b16 a[86:87], v15 offset:55072
    v_mfma_f32_16x16x32_bf16 v[120:123], a[8:11], a[36:39], v[120:123]
    ds_read_b128 a[60:63], v13 offset:45312
    v_mfma_f32_16x16x32_bf16 v[124:127], a[12:15], a[36:39], v[124:127]
    v_mfma_f32_16x16x32_bf16 v[128:131], a[0:3], a[40:43], v[128:131]
    v_mfma_f32_16x16x32_bf16 v[132:135], a[4:7], a[40:43], v[132:135]
    v_mfma_f32_16x16x32_bf16 v[136:139], a[8:11], a[40:43], v[136:139]
    v_mfma_f32_16x16x32_bf16 v[140:143], a[12:15], a[40:43], v[140:143]
    s_waitcnt lgkmcnt(0)
    s_waitcnt vmcnt(6)
    s_barrier
    v_mfma_f32_16x16x32_bf16 v[48:51], a[64:67], a[44:47], v[48:51]
    ds_read_b64_tr_b16 a[20:21], v14 offset:9216
    v_mfma_f32_16x16x32_bf16 v[52:55], a[64:67], a[48:51], v[52:55]
    ds_read_b64_tr_b16 a[22:23], v14 offset:9728
    v_mfma_f32_16x16x32_bf16 v[56:59], a[64:67], a[52:55], v[56:59]
    ds_read_b64_tr_b16 a[24:25], v14 offset:9248
    v_mfma_f32_16x16x32_bf16 v[60:63], a[64:67], a[56:59], v[60:63]
    ds_read_b64_tr_b16 a[26:27], v14 offset:9760
    v_mfma_f32_16x16x32_bf16 v[64:67], a[68:71], a[44:47], v[64:67]
    v_mfma_f32_16x16x32_bf16 v[68:71], a[68:71], a[48:51], v[68:71]
    ds_read_b64_tr_b16 a[28:29], v14 offset:10240
    v_mfma_f32_16x16x32_bf16 v[72:75], a[68:71], a[52:55], v[72:75]
    ds_read_b64_tr_b16 a[30:31], v14 offset:10752
    v_mfma_f32_16x16x32_bf16 v[76:79], a[68:71], a[56:59], v[76:79]
    ds_read_b64_tr_b16 a[32:33], v14 offset:10272
    v_mfma_f32_16x16x32_bf16 v[80:83], a[72:75], a[44:47], v[80:83]
    v_mfma_f32_16x16x32_bf16 v[84:87], a[72:75], a[48:51], v[84:87]
    ds_read_b64_tr_b16 a[34:35], v14 offset:10784
    v_mfma_f32_16x16x32_bf16 v[88:91], a[72:75], a[52:55], v[88:91]
    ds_read_b128 a[0:3], v10 offset:0
    v_mfma_f32_16x16x32_bf16 v[92:95], a[72:75], a[56:59], v[92:95]
    ds_read_b128 a[4:7], v10 offset:1024
    v_mfma_f32_16x16x32_bf16 v[144:147], a[72:75], a[60:63], v[144:147]
    ds_read_b64_tr_b16 a[36:37], v14 offset:11264
    v_mfma_f32_16x16x32_bf16 v[96:99], a[76:79], a[44:47], v[96:99]
    v_mfma_f32_16x16x32_bf16 v[100:103], a[76:79], a[48:51], v[100:103]
    ds_read_b64_tr_b16 a[38:39], v14 offset:11776
    v_mfma_f32_16x16x32_bf16 v[104:107], a[76:79], a[52:55], v[104:107]
    ds_read_b128 a[8:11], v10 offset:2304
    v_mfma_f32_16x16x32_bf16 v[108:111], a[76:79], a[56:59], v[108:111]
    ds_read_b128 a[12:15], v10 offset:3328
    v_mfma_f32_16x16x32_bf16 v[148:151], a[76:79], a[60:63], v[148:151]
    v_mfma_f32_16x16x32_bf16 v[112:115], a[44:47], a[80:83], v[112:115]
    ds_read_b64_tr_b16 a[40:41], v14 offset:11296
    v_mfma_f32_16x16x32_bf16 v[116:119], a[48:51], a[80:83], v[116:119]
    ds_read_b64_tr_b16 a[42:43], v14 offset:11808
    v_mfma_f32_16x16x32_bf16 v[120:123], a[52:55], a[80:83], v[120:123]
    ds_read_b128 a[16:19], v12 offset:2048
    v_mfma_f32_16x16x32_bf16 v[124:127], a[56:59], a[80:83], v[124:127]
    v_mfma_f32_16x16x32_bf16 v[128:131], a[44:47], a[84:87], v[128:131]
    v_mfma_f32_16x16x32_bf16 v[132:135], a[48:51], a[84:87], v[132:135]
    v_mfma_f32_16x16x32_bf16 v[136:139], a[52:55], a[84:87], v[136:139]
    v_mfma_f32_16x16x32_bf16 v[140:143], a[56:59], a[84:87], v[140:143]
    s_waitcnt lgkmcnt(0)
    s_waitcnt vmcnt(0)
    s_barrier
    v_mfma_f32_16x16x32_bf16 v[48:51], a[20:23], a[0:3], v[48:51]
    ds_read_b64_tr_b16 a[64:65], v14 offset:30848
    v_mfma_f32_16x16x32_bf16 v[52:55], a[20:23], a[4:7], v[52:55]
    ds_read_b64_tr_b16 a[66:67], v14 offset:31360
    v_mfma_f32_16x16x32_bf16 v[56:59], a[20:23], a[8:11], v[56:59]
    ds_read_b64_tr_b16 a[68:69], v14 offset:30880
    v_mfma_f32_16x16x32_bf16 v[60:63], a[20:23], a[12:15], v[60:63]
    ds_read_b64_tr_b16 a[70:71], v14 offset:31392
    v_mfma_f32_16x16x32_bf16 v[64:67], a[24:27], a[0:3], v[64:67]
    v_mfma_f32_16x16x32_bf16 v[68:71], a[24:27], a[4:7], v[68:71]
    ds_read_b64_tr_b16 a[72:73], v14 offset:31872
    v_mfma_f32_16x16x32_bf16 v[72:75], a[24:27], a[8:11], v[72:75]
    ds_read_b64_tr_b16 a[74:75], v14 offset:32384
    v_mfma_f32_16x16x32_bf16 v[76:79], a[24:27], a[12:15], v[76:79]
    ds_read_b64_tr_b16 a[76:77], v14 offset:31904
    v_mfma_f32_16x16x32_bf16 v[80:83], a[28:31], a[0:3], v[80:83]
    v_mfma_f32_16x16x32_bf16 v[84:87], a[28:31], a[4:7], v[84:87]
    ds_read_b64_tr_b16 a[78:79], v14 offset:32416
    v_mfma_f32_16x16x32_bf16 v[88:91], a[28:31], a[8:11], v[88:91]
    ds_read_b128 a[44:47], v10 offset:21632
    v_mfma_f32_16x16x32_bf16 v[92:95], a[28:31], a[12:15], v[92:95]
    ds_read_b128 a[48:51], v10 offset:22656
    v_mfma_f32_16x16x32_bf16 v[144:147], a[28:31], a[16:19], v[144:147]
    ds_read_b64_tr_b16 a[80:81], v14 offset:32896
    v_mfma_f32_16x16x32_bf16 v[96:99], a[32:35], a[0:3], v[96:99]
    v_mfma_f32_16x16x32_bf16 v[100:103], a[32:35], a[4:7], v[100:103]
    ds_read_b64_tr_b16 a[82:83], v14 offset:33408
    v_mfma_f32_16x16x32_bf16 v[104:107], a[32:35], a[8:11], v[104:107]
    ds_read_b128 a[52:55], v10 offset:23936
    v_mfma_f32_16x16x32_bf16 v[108:111], a[32:35], a[12:15], v[108:111]
    ds_read_b128 a[56:59], v10 offset:24960
    v_mfma_f32_16x16x32_bf16 v[148:151], a[32:35], a[16:19], v[148:151]
    v_mfma_f32_16x16x32_bf16 v[112:115], a[0:3], a[36:39], v[112:115]
    ds_read_b64_tr_b16 a[84:85], v14 offset:32928
    v_mfma_f32_16x16x32_bf16 v[116:119], a[4:7], a[36:39], v[116:119]
    ds_read_b64_tr_b16 a[86:87], v14 offset:33440
    v_mfma_f32_16x16x32_bf16 v[120:123], a[8:11], a[36:39], v[120:123]
    ds_read_b128 a[60:63], v12 offset:23680
    v_mfma_f32_16x16x32_bf16 v[124:127], a[12:15], a[36:39], v[124:127]
    v_mfma_f32_16x16x32_bf16 v[128:131], a[0:3], a[40:43], v[128:131]
    v_mfma_f32_16x16x32_bf16 v[132:135], a[4:7], a[40:43], v[132:135]
    v_mfma_f32_16x16x32_bf16 v[136:139], a[8:11], a[40:43], v[136:139]
    v_mfma_f32_16x16x32_bf16 v[140:143], a[12:15], a[40:43], v[140:143]
    s_waitcnt lgkmcnt(0)
    v_mfma_f32_16x16x32_bf16 v[48:51], a[64:67], a[44:47], v[48:51]
    v_mfma_f32_16x16x32_bf16 v[52:55], a[64:67], a[48:51], v[52:55]
    v_mfma_f32_16x16x32_bf16 v[56:59], a[64:67], a[52:55], v[56:59]
    v_mfma_f32_16x16x32_bf16 v[60:63], a[64:67], a[56:59], v[60:63]
    v_mfma_f32_16x16x32_bf16 v[64:67], a[68:71], a[44:47], v[64:67]
    v_mfma_f32_16x16x32_bf16 v[68:71], a[68:71], a[48:51], v[68:71]
    v_mfma_f32_16x16x32_bf16 v[72:75], a[68:71], a[52:55], v[72:75]
    v_mfma_f32_16x16x32_bf16 v[76:79], a[68:71], a[56:59], v[76:79]
    v_mfma_f32_16x16x32_bf16 v[80:83], a[72:75], a[44:47], v[80:83]
    v_mfma_f32_16x16x32_bf16 v[84:87], a[72:75], a[48:51], v[84:87]
    v_mfma_f32_16x16x32_bf16 v[88:91], a[72:75], a[52:55], v[88:91]
    v_mfma_f32_16x16x32_bf16 v[92:95], a[72:75], a[56:59], v[92:95]
    v_mfma_f32_16x16x32_bf16 v[144:147], a[72:75], a[60:63], v[144:147]
    v_mfma_f32_16x16x32_bf16 v[96:99], a[76:79], a[44:47], v[96:99]
    v_mfma_f32_16x16x32_bf16 v[100:103], a[76:79], a[48:51], v[100:103]
    v_mfma_f32_16x16x32_bf16 v[104:107], a[76:79], a[52:55], v[104:107]
    v_mfma_f32_16x16x32_bf16 v[108:111], a[76:79], a[56:59], v[108:111]
    v_mfma_f32_16x16x32_bf16 v[148:151], a[76:79], a[60:63], v[148:151]
    v_mfma_f32_16x16x32_bf16 v[112:115], a[44:47], a[80:83], v[112:115]
    v_mfma_f32_16x16x32_bf16 v[116:119], a[48:51], a[80:83], v[116:119]
    v_mfma_f32_16x16x32_bf16 v[120:123], a[52:55], a[80:83], v[120:123]
    v_mfma_f32_16x16x32_bf16 v[124:127], a[56:59], a[80:83], v[124:127]
    v_mfma_f32_16x16x32_bf16 v[128:131], a[44:47], a[84:87], v[128:131]
    v_mfma_f32_16x16x32_bf16 v[132:135], a[48:51], a[84:87], v[132:135]
    v_mfma_f32_16x16x32_bf16 v[136:139], a[52:55], a[84:87], v[136:139]
    v_mfma_f32_16x16x32_bf16 v[140:143], a[56:59], a[84:87], v[140:143]
    v_and_b32 v6, 15, v1
    v_lshlrev_b32 v6, 4, v6
    v_add_u32 v6, 129792, v6
    v_lshrrev_b32 v7, 4, v1
    v_lshlrev_b32 v7, 4, v7
    v_add_u32 v7, 132864, v7
    s_lshl_b32 s20, s3, 11
    s_add_u32 s20, s20, 135168
    v_lshl_add_u32 v8, v1, 4, s20
    v_xor_b32 v9, 2048, v8
    ds_read_b128 v[216:219], v6 offset:0
    ds_read_b128 v[220:223], v6 offset:256
    ds_read_b128 v[224:227], v6 offset:512
    ds_read_b128 v[228:231], v6 offset:768
    ds_read_b128 v[232:235], v6 offset:2048
    v_mov_b32 v244, 0x3f803f80
    v_mov_b32 v245, 0x3f803f80
    v_mov_b32 v246, 0x3f803f80
    v_mov_b32 v247, 0x3f803f80
    s_waitcnt lgkmcnt(1)
    v_pk_fma_f32 v[92:93], v[24:25], v[228:229], v[92:93] op_sel_hi:[1,0,1]
    v_pk_mul_f32 v[92:93], v[92:93], v[228:229] op_sel:[0,1] op_sel_hi:[1,1]
    v_cvt_pk_bf16_f32 v192, v92, v93
    v_pk_fma_f32 v[94:95], v[26:27], v[228:229], v[94:95] op_sel_hi:[1,0,1]
    v_pk_mul_f32 v[94:95], v[94:95], v[228:229] op_sel:[0,1] op_sel_hi:[1,1]
    v_cvt_pk_bf16_f32 v193, v94, v95
    v_pk_fma_f32 v[108:109], v[28:29], v[228:229], v[108:109] op_sel_hi:[1,0,1]
    v_pk_mul_f32 v[108:109], v[108:109], v[228:229] op_sel:[0,1] op_sel_hi:[1,1]
    v_cvt_pk_bf16_f32 v194, v108, v109
    v_pk_fma_f32 v[110:111], v[30:31], v[228:229], v[110:111] op_sel_hi:[1,0,1]
    v_pk_mul_f32 v[110:111], v[110:111], v[228:229] op_sel:[0,1] op_sel_hi:[1,1]
    v_cvt_pk_bf16_f32 v195, v110, v111
    ds_read_b128 v[236:239], v7 offset:192
    ds_read_b128 v[240:243], v7 offset:960
    s_waitcnt lgkmcnt(1)
    v_pk_fma_f32 v[124:125], v[236:237], v[32:33], v[124:125] op_sel_hi:[1,0,1]
    s_waitcnt lgkmcnt(0)
    v_pk_mul_f32 v[124:125], v[124:125], v[240:241]
    v_cvt_pk_bf16_f32 v204, v124, v125
    v_pk_fma_f32 v[126:127], v[238:239], v[32:33], v[126:127] op_sel_hi:[1,0,1]
    v_pk_mul_f32 v[126:127], v[126:127], v[242:243]
    v_cvt_pk_bf16_f32 v205, v126, v127
    v_pk_fma_f32 v[140:141], v[236:237], v[32:33], v[140:141] op_sel:[0,1,0] op_sel_hi:[1,1,1]
    v_pk_mul_f32 v[140:141], v[140:141], v[240:241]
    v_cvt_pk_bf16_f32 v214, v140, v141
    v_pk_fma_f32 v[142:143], v[238:239], v[32:33], v[142:143] op_sel:[0,1,0] op_sel_hi:[1,1,1]
    v_pk_mul_f32 v[142:143], v[142:143], v[242:243]
    v_cvt_pk_bf16_f32 v215, v142, v143
    ds_write_b128 v8, v[192:195]
    ds_write_b64 v8, v[204:205] offset:1024
    ds_write_b64 v8, v[214:215] offset:1032
    v_pk_fma_f32 v[144:145], v[24:25], v[232:233], v[144:145] op_sel_hi:[1,0,1]
    v_pk_mul_f32 v[144:145], v[144:145], v[232:233] op_sel:[0,1] op_sel_hi:[1,1]
    v_cvt_pk_bf16_f32 v176, v144, v145
    v_pk_fma_f32 v[146:147], v[26:27], v[232:233], v[146:147] op_sel_hi:[1,0,1]
    v_pk_mul_f32 v[146:147], v[146:147], v[232:233] op_sel:[0,1] op_sel_hi:[1,1]
    v_cvt_pk_bf16_f32 v177, v146, v147
    v_pk_fma_f32 v[148:149], v[28:29], v[232:233], v[148:149] op_sel_hi:[1,0,1]
    v_pk_mul_f32 v[148:149], v[148:149], v[232:233] op_sel:[0,1] op_sel_hi:[1,1]
    v_cvt_pk_bf16_f32 v178, v148, v149
    v_pk_fma_f32 v[150:151], v[30:31], v[232:233], v[150:151] op_sel_hi:[1,0,1]
    v_pk_mul_f32 v[150:151], v[150:151], v[232:233] op_sel:[0,1] op_sel_hi:[1,1]
    v_cvt_pk_bf16_f32 v179, v150, v151
    v_pk_fma_f32 v[80:81], v[24:25], v[216:217], v[80:81] op_sel_hi:[1,0,1]
    v_pk_mul_f32 v[80:81], v[80:81], v[216:217] op_sel:[0,1] op_sel_hi:[1,1]
    v_cvt_pk_bf16_f32 v180, v80, v81
    v_pk_fma_f32 v[82:83], v[26:27], v[216:217], v[82:83] op_sel_hi:[1,0,1]
    v_pk_mul_f32 v[82:83], v[82:83], v[216:217] op_sel:[0,1] op_sel_hi:[1,1]
    v_cvt_pk_bf16_f32 v181, v82, v83
    v_pk_fma_f32 v[96:97], v[28:29], v[216:217], v[96:97] op_sel_hi:[1,0,1]
    v_pk_mul_f32 v[96:97], v[96:97], v[216:217] op_sel:[0,1] op_sel_hi:[1,1]
    v_cvt_pk_bf16_f32 v182, v96, v97
    v_pk_fma_f32 v[98:99], v[30:31], v[216:217], v[98:99] op_sel_hi:[1,0,1]
    v_pk_mul_f32 v[98:99], v[98:99], v[216:217] op_sel:[0,1] op_sel_hi:[1,1]
    v_cvt_pk_bf16_f32 v183, v98, v99
    ds_read_b128 v[236:239], v7 offset:0
    ds_read_b128 v[240:243], v7 offset:768
    s_waitcnt lgkmcnt(1)
    v_pk_fma_f32 v[112:113], v[236:237], v[32:33], v[112:113] op_sel_hi:[1,0,1]
    s_waitcnt lgkmcnt(0)
    v_pk_mul_f32 v[112:113], v[112:113], v[240:241]
    v_cvt_pk_bf16_f32 v198, v112, v113
    v_pk_fma_f32 v[114:115], v[238:239], v[32:33], v[114:115] op_sel_hi:[1,0,1]
    v_pk_mul_f32 v[114:115], v[114:115], v[242:243]
    v_cvt_pk_bf16_f32 v199, v114, v115
    v_pk_fma_f32 v[128:129], v[236:237], v[32:33], v[128:129] op_sel:[0,1,0] op_sel_hi:[1,1,1]
    v_pk_mul_f32 v[128:129], v[128:129], v[240:241]
    v_cvt_pk_bf16_f32 v208, v128, v129
    v_pk_fma_f32 v[130:131], v[238:239], v[32:33], v[130:131] op_sel:[0,1,0] op_sel_hi:[1,1,1]
    v_pk_mul_f32 v[130:131], v[130:131], v[242:243]
    v_cvt_pk_bf16_f32 v209, v130, v131
    v_pk_fma_f32 v[84:85], v[24:25], v[220:221], v[84:85] op_sel_hi:[1,0,1]
    v_pk_mul_f32 v[84:85], v[84:85], v[220:221] op_sel:[0,1] op_sel_hi:[1,1]
    v_cvt_pk_bf16_f32 v184, v84, v85
    v_pk_fma_f32 v[86:87], v[26:27], v[220:221], v[86:87] op_sel_hi:[1,0,1]
    v_pk_mul_f32 v[86:87], v[86:87], v[220:221] op_sel:[0,1] op_sel_hi:[1,1]
    v_cvt_pk_bf16_f32 v185, v86, v87
    v_pk_fma_f32 v[100:101], v[28:29], v[220:221], v[100:101] op_sel_hi:[1,0,1]
    v_pk_mul_f32 v[100:101], v[100:101], v[220:221] op_sel:[0,1] op_sel_hi:[1,1]
    v_cvt_pk_bf16_f32 v186, v100, v101
    v_pk_fma_f32 v[102:103], v[30:31], v[220:221], v[102:103] op_sel_hi:[1,0,1]
    v_pk_mul_f32 v[102:103], v[102:103], v[220:221] op_sel:[0,1] op_sel_hi:[1,1]
    v_cvt_pk_bf16_f32 v187, v102, v103
    ds_read_b128 v[236:239], v7 offset:64
    ds_read_b128 v[240:243], v7 offset:832
    s_waitcnt lgkmcnt(1)
    v_pk_fma_f32 v[116:117], v[236:237], v[32:33], v[116:117] op_sel_hi:[1,0,1]
    s_waitcnt lgkmcnt(0)
    v_pk_mul_f32 v[116:117], v[116:117], v[240:241]
    v_cvt_pk_bf16_f32 v200, v116, v117
    v_pk_fma_f32 v[118:119], v[238:239], v[32:33], v[118:119] op_sel_hi:[1,0,1]
    v_pk_mul_f32 v[118:119], v[118:119], v[242:243]
    v_cvt_pk_bf16_f32 v201, v118, v119
    v_pk_fma_f32 v[132:133], v[236:237], v[32:33], v[132:133] op_sel:[0,1,0] op_sel_hi:[1,1,1]
    v_pk_mul_f32 v[132:133], v[132:133], v[240:241]
    v_cvt_pk_bf16_f32 v210, v132, v133
    v_pk_fma_f32 v[134:135], v[238:239], v[32:33], v[134:135] op_sel:[0,1,0] op_sel_hi:[1,1,1]
    v_pk_mul_f32 v[134:135], v[134:135], v[242:243]
    v_cvt_pk_bf16_f32 v211, v134, v135
    v_pk_fma_f32 v[88:89], v[24:25], v[224:225], v[88:89] op_sel_hi:[1,0,1]
    v_pk_mul_f32 v[88:89], v[88:89], v[224:225] op_sel:[0,1] op_sel_hi:[1,1]
    v_cvt_pk_bf16_f32 v188, v88, v89
    v_pk_fma_f32 v[90:91], v[26:27], v[224:225], v[90:91] op_sel_hi:[1,0,1]
    v_pk_mul_f32 v[90:91], v[90:91], v[224:225] op_sel:[0,1] op_sel_hi:[1,1]
    v_cvt_pk_bf16_f32 v189, v90, v91
    v_pk_fma_f32 v[104:105], v[28:29], v[224:225], v[104:105] op_sel_hi:[1,0,1]
    v_pk_mul_f32 v[104:105], v[104:105], v[224:225] op_sel:[0,1] op_sel_hi:[1,1]
    v_cvt_pk_bf16_f32 v190, v104, v105
    v_pk_fma_f32 v[106:107], v[30:31], v[224:225], v[106:107] op_sel_hi:[1,0,1]
    v_pk_mul_f32 v[106:107], v[106:107], v[224:225] op_sel:[0,1] op_sel_hi:[1,1]
    v_cvt_pk_bf16_f32 v191, v106, v107
    ds_read_b128 v[236:239], v7 offset:128
    ds_read_b128 v[240:243], v7 offset:896
    s_waitcnt lgkmcnt(1)
    v_pk_fma_f32 v[120:121], v[236:237], v[32:33], v[120:121] op_sel_hi:[1,0,1]
    s_waitcnt lgkmcnt(0)
    v_pk_mul_f32 v[120:121], v[120:121], v[240:241]
    v_cvt_pk_bf16_f32 v202, v120, v121
    v_pk_fma_f32 v[122:123], v[238:239], v[32:33], v[122:123] op_sel_hi:[1,0,1]
    v_pk_mul_f32 v[122:123], v[122:123], v[242:243]
    v_cvt_pk_bf16_f32 v203, v122, v123
    v_pk_fma_f32 v[136:137], v[236:237], v[32:33], v[136:137] op_sel:[0,1,0] op_sel_hi:[1,1,1]
    v_pk_mul_f32 v[136:137], v[136:137], v[240:241]
    v_cvt_pk_bf16_f32 v212, v136, v137
    v_pk_fma_f32 v[138:139], v[238:239], v[32:33], v[138:139] op_sel:[0,1,0] op_sel_hi:[1,1,1]
    v_pk_mul_f32 v[138:139], v[138:139], v[242:243]
    v_cvt_pk_bf16_f32 v213, v138, v139
    s_waitcnt lgkmcnt(0)
    s_barrier
    ds_read_b64 v[196:197], v9 offset:1024
    ds_read_b64 v[206:207], v9 offset:1032
    v_pk_fma_f32 v[48:49], v[16:17], v[216:217], v[48:49] op_sel_hi:[1,0,1]
    v_pk_mul_f32 v[48:49], v[48:49], v[218:219] op_sel_hi:[1,0]
    v_cvt_pk_bf16_f32 v160, v48, v49
    v_pk_fma_f32 v[50:51], v[18:19], v[216:217], v[50:51] op_sel_hi:[1,0,1]
    v_pk_mul_f32 v[50:51], v[50:51], v[218:219] op_sel_hi:[1,0]
    v_cvt_pk_bf16_f32 v161, v50, v51
    v_pk_fma_f32 v[64:65], v[20:21], v[216:217], v[64:65] op_sel_hi:[1,0,1]
    v_pk_mul_f32 v[64:65], v[64:65], v[218:219] op_sel_hi:[1,0]
    v_cvt_pk_bf16_f32 v162, v64, v65
    v_pk_fma_f32 v[66:67], v[22:23], v[216:217], v[66:67] op_sel_hi:[1,0,1]
    v_pk_mul_f32 v[66:67], v[66:67], v[218:219] op_sel_hi:[1,0]
    v_cvt_pk_bf16_f32 v163, v66, v67
    v_pk_fma_f32 v[52:53], v[16:17], v[220:221], v[52:53] op_sel_hi:[1,0,1]
    v_pk_mul_f32 v[52:53], v[52:53], v[222:223] op_sel_hi:[1,0]
    v_cvt_pk_bf16_f32 v164, v52, v53
    v_pk_fma_f32 v[54:55], v[18:19], v[220:221], v[54:55] op_sel_hi:[1,0,1]
    v_pk_mul_f32 v[54:55], v[54:55], v[222:223] op_sel_hi:[1,0]
    v_cvt_pk_bf16_f32 v165, v54, v55
    v_pk_fma_f32 v[68:69], v[20:21], v[220:221], v[68:69] op_sel_hi:[1,0,1]
    v_pk_mul_f32 v[68:69], v[68:69], v[222:223] op_sel_hi:[1,0]
    v_cvt_pk_bf16_f32 v166, v68, v69
    v_pk_fma_f32 v[70:71], v[22:23], v[220:221], v[70:71] op_sel_hi:[1,0,1]
    v_pk_mul_f32 v[70:71], v[70:71], v[222:223] op_sel_hi:[1,0]
    v_cvt_pk_bf16_f32 v167, v70, v71
    v_pk_fma_f32 v[56:57], v[16:17], v[224:225], v[56:57] op_sel_hi:[1,0,1]
    v_pk_mul_f32 v[56:57], v[56:57], v[226:227] op_sel_hi:[1,0]
    v_cvt_pk_bf16_f32 v168, v56, v57
    v_pk_fma_f32 v[58:59], v[18:19], v[224:225], v[58:59] op_sel_hi:[1,0,1]
    v_pk_mul_f32 v[58:59], v[58:59], v[226:227] op_sel_hi:[1,0]
    v_cvt_pk_bf16_f32 v169, v58, v59
    v_pk_fma_f32 v[72:73], v[20:21], v[224:225], v[72:73] op_sel_hi:[1,0,1]
    v_pk_mul_f32 v[72:73], v[72:73], v[226:227] op_sel_hi:[1,0]
    v_cvt_pk_bf16_f32 v170, v72, v73
    v_pk_fma_f32 v[74:75], v[22:23], v[224:225], v[74:75] op_sel_hi:[1,0,1]
    v_pk_mul_f32 v[74:75], v[74:75], v[226:227] op_sel_hi:[1,0]
    v_cvt_pk_bf16_f32 v171, v74, v75
    v_pk_fma_f32 v[60:61], v[16:17], v[228:229], v[60:61] op_sel_hi:[1,0,1]
    v_pk_mul_f32 v[60:61], v[60:61], v[230:231] op_sel_hi:[1,0]
    v_cvt_pk_bf16_f32 v172, v60, v61
    v_pk_fma_f32 v[62:63], v[18:19], v[228:229], v[62:63] op_sel_hi:[1,0,1]
    v_pk_mul_f32 v[62:63], v[62:63], v[230:231] op_sel_hi:[1,0]
    v_cvt_pk_bf16_f32 v173, v62, v63
    v_pk_fma_f32 v[76:77], v[20:21], v[228:229], v[76:77] op_sel_hi:[1,0,1]
    v_pk_mul_f32 v[76:77], v[76:77], v[230:231] op_sel_hi:[1,0]
    v_cvt_pk_bf16_f32 v174, v76, v77
    v_pk_fma_f32 v[78:79], v[22:23], v[228:229], v[78:79] op_sel_hi:[1,0,1]
    v_pk_mul_f32 v[78:79], v[78:79], v[230:231] op_sel_hi:[1,0]
    v_cvt_pk_bf16_f32 v175, v78, v79
    v_mfma_f32_16x16x32_bf16 v[56:59], v[180:183], v[164:167], v[36:39]
    v_mfma_f32_16x16x32_bf16 v[60:63], v[184:187], v[164:167], v[40:43]
    v_mfma_f32_16x16x32_bf16 v[64:67], v[184:187], v[168:171], v[36:39]
    v_mfma_f32_16x16x32_bf16 v[68:71], v[188:191], v[168:171], v[40:43]
    v_mfma_f32_16x16x32_bf16 v[72:75], v[188:191], v[172:175], v[36:39]
    v_mfma_f32_16x16x32_bf16 v[76:79], v[192:195], v[172:175], v[40:43]
    v_mfma_f32_16x16x32_bf16 v[48:51], v[176:179], v[160:163], v[44:47]
    v_mfma_f32_16x16x32_bf16 v[52:55], v[180:183], v[160:163], v[40:43]
    s_nop 0
    v_max3_f32 v82, v56, v57, v58
    v_max3_f32 v83, v59, v60, v61
    v_max3_f32 v82, v82, v62, v63
    v_max_f32 v82, v82, v83
    v_mov_b32 v83, v82
    v_max3_f32 v84, v64, v65, v66
    v_max3_f32 v85, v67, v68, v69
    v_max3_f32 v84, v84, v70, v71
    v_max_f32 v84, v84, v85
    v_mov_b32 v85, v84
    v_max3_f32 v86, v72, v73, v74
    v_max3_f32 v87, v75, v76, v77
    v_max3_f32 v86, v86, v78, v79
    v_max_f32 v86, v86, v87
    v_mov_b32 v87, v86
    v_max3_f32 v80, v48, v49, v50
    v_max3_f32 v81, v51, v52, v53
    v_max3_f32 v80, v80, v54, v55
    v_max_f32 v80, v80, v81
    v_mov_b32 v81, v80
    v_permlane16_swap_b32 v82, v83
    v_permlane16_swap_b32 v84, v85
    v_permlane16_swap_b32 v86, v87
    v_permlane16_swap_b32 v80, v81
    v_max_f32 v82, v82, v83
    v_mov_b32 v83, v82
    v_max_f32 v84, v84, v85
    v_mov_b32 v85, v84
    v_max_f32 v86, v86, v87
    v_mov_b32 v87, v86
    v_max_f32 v80, v80, v81
    v_mov_b32 v81, v80
    v_permlane32_swap_b32 v82, v83
    v_permlane32_swap_b32 v84, v85
    v_permlane32_swap_b32 v86, v87
    v_permlane32_swap_b32 v80, v81
    v_max_f32 v82, v82, v83
    v_max_f32 v84, v84, v85
    v_max_f32 v86, v86, v87
    v_max_f32 v80, v80, v81
    s_lshl_b32 s20, s7, 1
    s_add_u32 s20, s20, s9
    s_lshl_b32 s20, s20, 17
    s_lshl_b32 s21, s6, 13
    s_add_u32 s20, s20, s21
    s_add_u32 s20, s20, 0
    v_lshlrev_b32 v6, 4, v1
    v_pk_add_f32 v[56:57], v[56:57], v[82:83] op_sel_hi:[1,0] neg_lo:[0,1] neg_hi:[0,1]
    v_pk_add_f32 v[58:59], v[58:59], v[82:83] op_sel_hi:[1,0] neg_lo:[0,1] neg_hi:[0,1]
    v_pk_add_f32 v[60:61], v[60:61], v[82:83] op_sel_hi:[1,0] neg_lo:[0,1] neg_hi:[0,1]
    v_pk_add_f32 v[62:63], v[62:63], v[82:83] op_sel_hi:[1,0] neg_lo:[0,1] neg_hi:[0,1]
    v_exp_f32 v56, v56
    v_exp_f32 v57, v57
    v_exp_f32 v58, v58
    v_exp_f32 v59, v59
    v_exp_f32 v60, v60
    v_exp_f32 v61, v61
    v_exp_f32 v62, v62
    v_exp_f32 v63, v63
    v_cvt_pk_bf16_f32 v92, v56, v57
    v_cvt_pk_bf16_f32 v93, v58, v59
    v_cvt_pk_bf16_f32 v94, v60, v61
    v_cvt_pk_bf16_f32 v95, v62, v63
    s_nop 1
    v_mfma_f32_16x16x32_bf16 v[124:127], v[244:247], v[92:95], 0
    v_mfma_f32_16x16x32_bf16 v[116:119], v[198:201], v[92:95], 0
    v_mfma_f32_16x16x32_bf16 v[120:123], v[208:211], v[92:95], 0
    v_pk_add_f32 v[64:65], v[64:65], v[84:85] op_sel_hi:[1,0] neg_lo:[0,1] neg_hi:[0,1]
    v_pk_add_f32 v[66:67], v[66:67], v[84:85] op_sel_hi:[1,0] neg_lo:[0,1] neg_hi:[0,1]
    v_pk_add_f32 v[68:69], v[68:69], v[84:85] op_sel_hi:[1,0] neg_lo:[0,1] neg_hi:[0,1]
    v_pk_add_f32 v[70:71], v[70:71], v[84:85] op_sel_hi:[1,0] neg_lo:[0,1] neg_hi:[0,1]
    v_exp_f32 v64, v64
    v_exp_f32 v65, v65
    v_exp_f32 v66, v66
    v_exp_f32 v67, v67
    v_exp_f32 v68, v68
    v_exp_f32 v69, v69
    v_exp_f32 v70, v70
    v_exp_f32 v71, v71
    v_cvt_pk_bf16_f32 v96, v64, v65
    v_cvt_pk_bf16_f32 v97, v66, v67
    v_cvt_pk_bf16_f32 v98, v68, v69
    v_cvt_pk_bf16_f32 v99, v70, v71
    s_nop 1
    v_mfma_f32_16x16x32_bf16 v[136:139], v[244:247], v[96:99], 0
    v_mfma_f32_16x16x32_bf16 v[128:131], v[200:203], v[96:99], 0
    v_mfma_f32_16x16x32_bf16 v[132:135], v[210:213], v[96:99], 0
    v_pk_add_f32 v[72:73], v[72:73], v[86:87] op_sel_hi:[1,0] neg_lo:[0,1] neg_hi:[0,1]
    v_pk_add_f32 v[74:75], v[74:75], v[86:87] op_sel_hi:[1,0] neg_lo:[0,1] neg_hi:[0,1]
    v_pk_add_f32 v[76:77], v[76:77], v[86:87] op_sel_hi:[1,0] neg_lo:[0,1] neg_hi:[0,1]
    v_pk_add_f32 v[78:79], v[78:79], v[86:87] op_sel_hi:[1,0] neg_lo:[0,1] neg_hi:[0,1]
    v_exp_f32 v72, v72
    v_exp_f32 v73, v73
    v_exp_f32 v74, v74
    v_exp_f32 v75, v75
    v_exp_f32 v76, v76
    v_exp_f32 v77, v77
    v_exp_f32 v78, v78
    v_exp_f32 v79, v79
    v_cvt_pk_bf16_f32 v100, v72, v73
    v_cvt_pk_bf16_f32 v101, v74, v75
    v_cvt_pk_bf16_f32 v102, v76, v77
    v_cvt_pk_bf16_f32 v103, v78, v79
    s_nop 1
    v_mfma_f32_16x16x32_bf16 v[148:151], v[244:247], v[100:103], 0
    v_mfma_f32_16x16x32_bf16 v[140:143], v[202:205], v[100:103], 0
    v_mfma_f32_16x16x32_bf16 v[144:147], v[212:215], v[100:103], 0
    v_pk_add_f32 v[48:49], v[48:49], v[80:81] op_sel_hi:[1,0] neg_lo:[0,1] neg_hi:[0,1]
    v_pk_add_f32 v[50:51], v[50:51], v[80:81] op_sel_hi:[1,0] neg_lo:[0,1] neg_hi:[0,1]
    v_pk_add_f32 v[52:53], v[52:53], v[80:81] op_sel_hi:[1,0] neg_lo:[0,1] neg_hi:[0,1]
    v_pk_add_f32 v[54:55], v[54:55], v[80:81] op_sel_hi:[1,0] neg_lo:[0,1] neg_hi:[0,1]
    v_exp_f32 v48, v48
    v_exp_f32 v49, v49
    v_exp_f32 v50, v50
    v_exp_f32 v51, v51
    v_exp_f32 v52, v52
    v_exp_f32 v53, v53
    v_exp_f32 v54, v54
    v_exp_f32 v55, v55
    v_cvt_pk_bf16_f32 v88, v48, v49
    v_cvt_pk_bf16_f32 v89, v50, v51
    v_cvt_pk_bf16_f32 v90, v52, v53
    v_cvt_pk_bf16_f32 v91, v54, v55
    s_nop 1
    v_mfma_f32_16x16x32_bf16 v[112:115], v[244:247], v[88:91], 0
    s_waitcnt lgkmcnt(1)
    v_mfma_f32_16x16x32_bf16 v[104:107], v[196:199], v[88:91], 0
    s_waitcnt lgkmcnt(0)
    v_mfma_f32_16x16x32_bf16 v[108:111], v[206:209], v[88:91], 0
    v_rcp_f32 v124, v124
    s_nop 0
    v_pk_mul_f32 v[116:117], v[116:117], v[124:125] op_sel_hi:[1,0]
    v_pk_mul_f32 v[118:119], v[118:119], v[124:125] op_sel_hi:[1,0]
    v_pk_mul_f32 v[120:121], v[120:121], v[124:125] op_sel_hi:[1,0]
    v_pk_mul_f32 v[122:123], v[122:123], v[124:125] op_sel_hi:[1,0]
    v_cvt_pk_bf16_f32 v164, v116, v117
    v_cvt_pk_bf16_f32 v165, v118, v119
    v_cvt_pk_bf16_f32 v166, v120, v121
    v_cvt_pk_bf16_f32 v167, v122, v123
    buffer_store_dwordx4 v[164:167], v6, s[40:43], s20 offen offset:1024
    v_rcp_f32 v136, v136
    s_nop 0
    v_pk_mul_f32 v[128:129], v[128:129], v[136:137] op_sel_hi:[1,0]
    v_pk_mul_f32 v[130:131], v[130:131], v[136:137] op_sel_hi:[1,0]
    v_pk_mul_f32 v[132:133], v[132:133], v[136:137] op_sel_hi:[1,0]
    v_pk_mul_f32 v[134:135], v[134:135], v[136:137] op_sel_hi:[1,0]
    v_cvt_pk_bf16_f32 v168, v128, v129
    v_cvt_pk_bf16_f32 v169, v130, v131
    v_cvt_pk_bf16_f32 v170, v132, v133
    v_cvt_pk_bf16_f32 v171, v134, v135
    buffer_store_dwordx4 v[168:171], v6, s[40:43], s20 offen offset:2048
    v_rcp_f32 v148, v148
    s_nop 0
    v_pk_mul_f32 v[140:141], v[140:141], v[148:149] op_sel_hi:[1,0]
    v_pk_mul_f32 v[142:143], v[142:143], v[148:149] op_sel_hi:[1,0]
    v_pk_mul_f32 v[144:145], v[144:145], v[148:149] op_sel_hi:[1,0]
    v_pk_mul_f32 v[146:147], v[146:147], v[148:149] op_sel_hi:[1,0]
    v_cvt_pk_bf16_f32 v172, v140, v141
    v_cvt_pk_bf16_f32 v173, v142, v143
    v_cvt_pk_bf16_f32 v174, v144, v145
    v_cvt_pk_bf16_f32 v175, v146, v147
    buffer_store_dwordx4 v[172:175], v6, s[40:43], s20 offen offset:3072
    v_rcp_f32 v112, v112
    s_nop 0
    v_pk_mul_f32 v[104:105], v[104:105], v[112:113] op_sel_hi:[1,0]
    v_pk_mul_f32 v[106:107], v[106:107], v[112:113] op_sel_hi:[1,0]
    v_pk_mul_f32 v[108:109], v[108:109], v[112:113] op_sel_hi:[1,0]
    v_pk_mul_f32 v[110:111], v[110:111], v[112:113] op_sel_hi:[1,0]
    v_cvt_pk_bf16_f32 v160, v104, v105
    v_cvt_pk_bf16_f32 v161, v106, v107
    v_cvt_pk_bf16_f32 v162, v108, v109
    v_cvt_pk_bf16_f32 v163, v110, v111
    buffer_store_dwordx4 v[160:163], v6, s[40:43], s20 offen offset:0
    s_endpgm
qkv2_kernel_t1:
    s_add_u32 m0, s24, 0
    s_nop 0
    buffer_load_dwordx4 v6, s[32:35], s25 offen lds
    buffer_load_dwordx4 v7, s[32:35], s25 offen offset:1024 lds
    buffer_load_dwordx4 v8, s[32:35], s25 offen offset:2048 lds
    s_add_u32 s25, s25, 196608
    s_add_u32 m0, s22, 0
    s_nop 0
    buffer_load_dwordx4 v4, s[28:31], s23 offen lds
    buffer_load_dwordx4 v4, s[28:31], s23 offen offset:1024 lds
    buffer_load_dword v5, s[28:31], s23 offen offset:2048 lds
    s_add_u32 s23, s23, 0x20000
    s_mov_b32 s26, 0
    buffer_load_dwordx2 v[48:49], v9, s[36:39], s26 offen
    s_mov_b32 s26, 16384
    buffer_load_dwordx2 v[50:51], v9, s[36:39], s26 offen
    s_mov_b32 s26, 32768
    buffer_load_dwordx2 v[52:53], v9, s[36:39], s26 offen
    s_mov_b32 s26, 49152
    buffer_load_dwordx2 v[54:55], v9, s[36:39], s26 offen
    s_mov_b32 s26, 65536
    buffer_load_dwordx2 v[56:57], v9, s[36:39], s26 offen
    s_mov_b32 s26, 81920
    buffer_load_dwordx2 v[58:59], v9, s[36:39], s26 offen
    s_mov_b32 s26, 98304
    buffer_load_dwordx2 v[60:61], v9, s[36:39], s26 offen
    s_mov_b32 s26, 114688
    buffer_load_dwordx2 v[62:63], v9, s[36:39], s26 offen
    s_mov_b32 s26, 131072
    buffer_load_dwordx2 v[64:65], v9, s[36:39], s26 offen
    s_mov_b32 s26, 147456
    buffer_load_dwordx2 v[66:67], v9, s[36:39], s26 offen
    s_mov_b32 s26, 163840
    buffer_load_dwordx2 v[68:69], v9, s[36:39], s26 offen
    s_mov_b32 s26, 180224
    buffer_load_dwordx2 v[70:71], v9, s[36:39], s26 offen
    s_mov_b32 s26, 196608
    buffer_load_dwordx2 v[72:73], v9, s[36:39], s26 offen
    s_mov_b32 s26, 212992
    buffer_load_dwordx2 v[74:75], v9, s[36:39], s26 offen
    s_mov_b32 s26, 229376
    buffer_load_dwordx2 v[76:77], v9, s[36:39], s26 offen
    s_mov_b32 s26, 245760
    buffer_load_dwordx2 v[78:79], v9, s[36:39], s26 offen
    s_add_u32 m0, s24, 21632
    s_nop 0
    buffer_load_dwordx4 v6, s[32:35], s25 offen lds
    buffer_load_dwordx4 v7, s[32:35], s25 offen offset:1024 lds
    buffer_load_dwordx4 v8, s[32:35], s25 offen offset:2048 lds
    s_add_u32 s25, s25, 196608
    s_add_u32 m0, s22, 21632
    s_nop 0
    buffer_load_dwordx4 v4, s[28:31], s23 offen lds
    buffer_load_dwordx4 v4, s[28:31], s23 offen offset:1024 lds
    buffer_load_dword v5, s[28:31], s23 offen offset:2048 lds
    s_add_u32 s23, s23, 0x20000
    s_add_u32 m0, s24, 43264
    s_nop 0
    buffer_load_dwordx4 v6, s[32:35], s25 offen lds
    buffer_load_dwordx4 v7, s[32:35], s25 offen offset:1024 lds
    buffer_load_dwordx4 v8, s[32:35], s25 offen offset:2048 lds
    s_add_u32 s25, s25, 196608
    s_add_u32 m0, s22, 43264
    s_nop 0
    buffer_load_dwordx4 v4, s[28:31], s23 offen lds
    buffer_load_dwordx4 v4, s[28:31], s23 offen offset:1024 lds
    buffer_load_dword v5, s[28:31], s23 offen offset:2048 lds
    s_add_u32 s23, s23, 0x20000
    s_add_u32 m0, s24, 64896
    s_nop 0
    buffer_load_dwordx4 v6, s[32:35], s25 offen lds
    buffer_load_dwordx4 v7, s[32:35], s25 offen offset:1024 lds
    buffer_load_dwordx4 v8, s[32:35], s25 offen offset:2048 lds
    s_add_u32 s25, s25, 196608
    s_add_u32 m0, s22, 64896
    s_nop 0
    buffer_load_dwordx4 v4, s[28:31], s23 offen lds
    buffer_load_dwordx4 v4, s[28:31], s23 offen offset:1024 lds
    buffer_load_dword v5, s[28:31], s23 offen offset:2048 lds
    s_add_u32 s23, s23, 0x20000
    s_add_u32 m0, s24, 86528
    s_nop 0
    buffer_load_dwordx4 v6, s[32:35], s25 offen lds
    buffer_load_dwordx4 v7, s[32:35], s25 offen offset:1024 lds
    buffer_load_dwordx4 v8, s[32:35], s25 offen offset:2048 lds
    s_add_u32 s25, s25, 196608
    s_add_u32 m0, s22, 86528
    s_nop 0
    buffer_load_dwordx4 v4, s[28:31], s23 offen lds
    buffer_load_dwordx4 v4, s[28:31], s23 offen offset:1024 lds
    buffer_load_dword v5, s[28:31], s23 offen offset:2048 lds
    s_add_u32 s23, s23, 0x20000
    s_add_u32 m0, s24, 108160
    s_nop 0
    buffer_load_dwordx4 v6, s[32:35], s25 offen lds
    buffer_load_dwordx4 v7, s[32:35], s25 offen offset:1024 lds
    buffer_load_dwordx4 v8, s[32:35], s25 offen offset:2048 lds
    s_add_u32 s25, s25, 196608
    s_add_u32 m0, s22, 108160
    s_nop 0
    buffer_load_dwordx4 v4, s[28:31], s23 offen lds
    buffer_load_dwordx4 v4, s[28:31], s23 offen offset:1024 lds
    buffer_load_dword v5, s[28:31], s23 offen offset:2048 lds
    s_add_u32 s23, s23, 0x20000
    s_lshl_b32 s20, s7, 8
    s_lshl_b32 s21, s9, 7
    s_add_u32 s20, s20, s21
    s_add_u32 s21, s20, 4096
    s_add_u32 s26, s20, 8192
    v_lshrrev_b32 v34, 4, v1
    v_lshlrev_b32 v34, 4, v34
    v_and_b32 v35, 15, v1
    v_lshlrev_b32 v35, 2, v35
    buffer_load_dwordx4 v[16:19], v34, s[44:47], s20 offen offset:0
    buffer_load_dwordx4 v[20:23], v34, s[44:47], s20 offen offset:64
    buffer_load_dwordx4 v[24:27], v34, s[44:47], s21 offen offset:0
    buffer_load_dwordx4 v[28:31], v34, s[44:47], s21 offen offset:64
    buffer_load_dword v32, v35, s[44:47], s26 offen offset:0
    buffer_load_dword v33, v35, s[44:47], s26 offen offset:64
    s_add_u32 s40, s10, 16777216
    s_addc_u32 s41, s11, 0
    s_mov_b32 s42, 4194304
    s_mov_b32 s43, 0x20000
    v_lshrrev_b32 v34, 4, v1
    v_lshlrev_b32 v34, 2, v34
    v_and_b32 v35, 15, v1
    v_sub_u32 v34, v35, v34
    v_mov_b32 v35, 0xf149f2ca
    v_subrev_u32 v44, 0, v34
    v_cmp_gt_u32 vcc, 8, v44
    s_nop 1
    v_cndmask_b32 v40, v35, 0, vcc
    v_cmp_gt_i32 vcc, -8, v44
    s_nop 1
    v_cndmask_b32 v36, v35, 0, vcc
    v_subrev_u32 v44, 1, v34
    v_cmp_gt_u32 vcc, 8, v44
    s_nop 1
    v_cndmask_b32 v41, v35, 0, vcc
    v_cmp_gt_i32 vcc, -8, v44
    s_nop 1
    v_cndmask_b32 v37, v35, 0, vcc
    v_subrev_u32 v44, 2, v34
    v_cmp_gt_u32 vcc, 8, v44
    s_nop 1
    v_cndmask_b32 v42, v35, 0, vcc
    v_cmp_gt_i32 vcc, -8, v44
    s_nop 1
    v_cndmask_b32 v38, v35, 0, vcc
    v_subrev_u32 v44, 3, v34
    v_cmp_gt_u32 vcc, 8, v44
    s_nop 1
    v_cndmask_b32 v43, v35, 0, vcc
    v_cmp_gt_i32 vcc, -8, v44
    s_nop 1
    v_cndmask_b32 v39, v35, 0, vcc
    s_waitcnt vmcnt(52)
    s_barrier
    ds_read_b64_tr_b16 a[20:21], v14 offset:9216
    ds_read_b64_tr_b16 a[22:23], v14 offset:9728
    ds_read_b64_tr_b16 a[24:25], v14 offset:9248
    ds_read_b64_tr_b16 a[26:27], v14 offset:9760
    ds_read_b64_tr_b16 a[28:29], v14 offset:10240
    ds_read_b64_tr_b16 a[30:31], v14 offset:10752
    ds_read_b64_tr_b16 a[32:33], v14 offset:10272
    ds_read_b64_tr_b16 a[34:35], v14 offset:10784
    ds_read_b128 a[0:3], v10 offset:0
    ds_read_b128 a[4:7], v10 offset:1024
    ds_read_b64_tr_b16 a[36:37], v14 offset:11264
    ds_read_b64_tr_b16 a[38:39], v14 offset:11776
    ds_read_b128 a[8:11], v10 offset:2304
    ds_read_b128 a[12:15], v10 offset:3328
    ds_read_b64_tr_b16 a[40:41], v14 offset:11296
    ds_read_b64_tr_b16 a[42:43], v14 offset:11808
    ds_read_b128 a[16:19], v12 offset:2048
    s_waitcnt vmcnt(43)
    v_pk_add_f32 v[48:49], v[48:49], v[64:65]
    s_waitcnt vmcnt(42)
    v_pk_add_f32 v[50:51], v[50:51], v[66:67]
    s_waitcnt vmcnt(41)
    v_pk_add_f32 v[52:53], v[52:53], v[68:69]
    s_waitcnt vmcnt(40)
    v_pk_add_f32 v[54:55], v[54:55], v[70:71]
    s_waitcnt vmcnt(39)
    v_pk_add_f32 v[56:57], v[56:57], v[72:73]
    s_waitcnt vmcnt(38)
    v_pk_add_f32 v[58:59], v[58:59], v[74:75]
    s_waitcnt vmcnt(37)
    v_pk_add_f32 v[60:61], v[60:61], v[76:77]
    s_waitcnt vmcnt(36)
    v_pk_add_f32 v[62:63], v[62:63], v[78:79]
    v_pk_add_f32 v[48:49], v[48:49], v[56:57]
    v_pk_add_f32 v[50:51], v[50:51], v[58:59]
    v_pk_add_f32 v[52:53], v[52:53], v[60:61]
    v_pk_add_f32 v[54:55], v[54:55], v[62:63]
    v_pk_add_f32 v[48:49], v[48:49], v[52:53]
    v_pk_add_f32 v[50:51], v[50:51], v[54:55]
    v_pk_add_f32 v[48:49], v[48:49], v[50:51]
    v_mul_f32 v48, 0xba800000, v48
    v_mul_f32 v49, 0x3a800000, v49
    v_fma_f32 v49, -v48, v48, v49
    v_max_f32 v49, 0, v49
    v_add_f32 v49, 0x3727c5ac, v49
    v_rsq_f32 v50, v49
    s_nop 0
    v_mov_b32 v49, v50
    v_mul_f32 v50, 0x3e8293ee, v50
    v_min_u32 v34, 191, v0
    v_lshlrev_b32 v35, 2, v34
    v_lshlrev_b32 v34, 4, v34
    v_add_u32 v34, 129792, v34
    v_add_u32 v35, 132864, v35
    ds_write_b128 v34, v[48:51]
    ds_write_b32 v35, v48
    ds_write_b32 v35, v49 offset:768
    s_waitcnt lgkmcnt(0)
    v_mov_b32 v48, 0
    v_mov_b32 v49, 0
    v_mov_b32 v50, 0
    v_mov_b32 v51, 0
    v_mov_b32 v52, 0
    v_mov_b32 v53, 0
    v_mov_b32 v54, 0
    v_mov_b32 v55, 0
    v_mov_b32 v56, 0
    v_mov_b32 v57, 0
    v_mov_b32 v58, 0
    v_mov_b32 v59, 0
    v_mov_b32 v60, 0
    v_mov_b32 v61, 0
    v_mov_b32 v62, 0
    v_mov_b32 v63, 0
    v_mov_b32 v64, 0
    v_mov_b32 v65, 0
    v_mov_b32 v66, 0
    v_mov_b32 v67, 0
    v_mov_b32 v68, 0
    v_mov_b32 v69, 0
    v_mov_b32 v70, 0
    v_mov_b32 v71, 0
    v_mov_b32 v72, 0
    v_mov_b32 v73, 0
    v_mov_b32 v74, 0
    v_mov_b32 v75, 0
    v_mov_b32 v76, 0
    v_mov_b32 v77, 0
    v_mov_b32 v78, 0
    v_mov_b32 v79, 0
    v_mov_b32 v80, 0
    v_mov_b32 v81, 0
    v_mov_b32 v82, 0
    v_mov_b32 v83, 0
    v_mov_b32 v84, 0
    v_mov_b32 v85, 0
    v_mov_b32 v86, 0
    v_mov_b32 v87, 0
    v_mov_b32 v88, 0
    v_mov_b32 v89, 0
    v_mov_b32 v90, 0
    v_mov_b32 v91, 0
    v_mov_b32 v92, 0
    v_mov_b32 v93, 0
    v_mov_b32 v94, 0
    v_mov_b32 v95, 0
    v_mov_b32 v96, 0
    v_mov_b32 v97, 0
    v_mov_b32 v98, 0
    v_mov_b32 v99, 0
    v_mov_b32 v100, 0
    v_mov_b32 v101, 0
    v_mov_b32 v102, 0
    v_mov_b32 v103, 0
    v_mov_b32 v104, 0
    v_mov_b32 v105, 0
    v_mov_b32 v106, 0
    v_mov_b32 v107, 0
    v_mov_b32 v108, 0
    v_mov_b32 v109, 0
    v_mov_b32 v110, 0
    v_mov_b32 v111, 0
    v_mov_b32 v112, 0
    v_mov_b32 v113, 0
    v_mov_b32 v114, 0
    v_mov_b32 v115, 0
    v_mov_b32 v116, 0
    v_mov_b32 v117, 0
    v_mov_b32 v118, 0
    v_mov_b32 v119, 0
    v_mov_b32 v120, 0
    v_mov_b32 v121, 0
    v_mov_b32 v122, 0
    v_mov_b32 v123, 0
    v_mov_b32 v124, 0
    v_mov_b32 v125, 0
    v_mov_b32 v126, 0
    v_mov_b32 v127, 0
    v_mov_b32 v128, 0
    v_mov_b32 v129, 0
    v_mov_b32 v130, 0
    v_mov_b32 v131, 0
    v_mov_b32 v132, 0
    v_mov_b32 v133, 0
    v_mov_b32 v134, 0
    v_mov_b32 v135, 0
    v_mov_b32 v136, 0
    v_mov_b32 v137, 0
    v_mov_b32 v138, 0
    v_mov_b32 v139, 0
    v_mov_b32 v140, 0
    v_mov_b32 v141, 0
    v_mov_b32 v142, 0
    v_mov_b32 v143, 0
    v_mov_b32 v144, 0
    v_mov_b32 v145, 0
    v_mov_b32 v146, 0
    v_mov_b32 v147, 0
    v_mov_b32 v148, 0
    v_mov_b32 v149, 0
    v_mov_b32 v150, 0
    v_mov_b32 v151, 0
    s_mov_b32 s48, 4
.p2align 6
qkv2_kernel_t1_loop:
    s_waitcnt lgkmcnt(0)
    s_waitcnt vmcnt(24)
    s_barrier
    v_mfma_f32_16x16x32_bf16 v[48:51], a[20:23], a[0:3], v[48:51]
    ds_read_b64_tr_b16 a[64:65], v14 offset:30848
    v_mfma_f32_16x16x32_bf16 v[52:55], a[20:23], a[4:7], v[52:55]
    ds_read_b64_tr_b16 a[66:67], v14 offset:31360
    s_add_u32 m0, s24, 0
    s_nop 0
    buffer_load_dwordx4 v6, s[32:35], s25 offen lds
    v_mfma_f32_16x16x32_bf16 v[56:59], a[20:23], a[8:11], v[56:59]
    ds_read_b64_tr_b16 a[68:69], v14 offset:30880
    v_mfma_f32_16x16x32_bf16 v[60:63], a[20:23], a[12:15], v[60:63]
    ds_read_b64_tr_b16 a[70:71], v14 offset:31392
    v_mfma_f32_16x16x32_bf16 v[64:67], a[24:27], a[0:3], v[64:67]
    v_mfma_f32_16x16x32_bf16 v[68:71], a[24:27], a[4:7], v[68:71]
    ds_read_b64_tr_b16 a[72:73], v14 offset:31872
    buffer_load_dwordx4 v7, s[32:35], s25 offen offset:1024 lds
    v_mfma_f32_16x16x32_bf16 v[72:75], a[24:27], a[8:11], v[72:75]
    ds_read_b64_tr_b16 a[74:75], v14 offset:32384
    v_mfma_f32_16x16x32_bf16 v[76:79], a[24:27], a[12:15], v[76:79]
    ds_read_b64_tr_b16 a[76:77], v14 offset:31904
    v_mfma_f32_16x16x32_bf16 v[80:83], a[28:31], a[0:3], v[80:83]
    v_mfma_f32_16x16x32_bf16 v[84:87], a[28:31], a[4:7], v[84:87]
    ds_read_b64_tr_b16 a[78:79], v14 offset:32416
    buffer_load_dwordx4 v8, s[32:35], s25 offen offset:2048 lds
    s_add_u32 s25, s25, 196608
    v_mfma_f32_16x16x32_bf16 v[88:91], a[28:31], a[8:11], v[88:91]
    ds_read_b128 a[44:47], v10 offset:21632
    v_mfma_f32_16x16x32_bf16 v[92:95], a[28:31], a[12:15], v[92:95]
    ds_read_b128 a[48:51], v10 offset:22656
    v_mfma_f32_16x16x32_bf16 v[96:99], a[32:35], a[0:3], v[96:99]
    ds_read_b64_tr_b16 a[80:81], v14 offset:32896
    v_mfma_f32_16x16x32_bf16 v[100:103], a[32:35], a[4:7], v[100:103]
    s_add_u32 m0, s22, 0
    s_nop 0
    buffer_load_dwordx4 v4, s[28:31], s23 offen lds
    v_mfma_f32_16x16x32_bf16 v[104:107], a[32:35], a[8:11], v[104:107]
    ds_read_b64_tr_b16 a[82:83], v14 offset:33408
    v_mfma_f32_16x16x32_bf16 v[108:111], a[32:35], a[12:15], v[108:111]
    ds_read_b128 a[52:55], v10 offset:23936
    v_mfma_f32_16x16x32_bf16 v[112:115], a[0:3], a[36:39], v[112:115]
    ds_read_b128 a[56:59], v10 offset:24960
    v_mfma_f32_16x16x32_bf16 v[116:119], a[4:7], a[36:39], v[116:119]
    buffer_load_dwordx4 v4, s[28:31], s23 offen offset:1024 lds
    v_mfma_f32_16x16x32_bf16 v[120:123], a[8:11], a[36:39], v[120:123]
    ds_read_b64_tr_b16 a[84:85], v14 offset:32928
    v_mfma_f32_16x16x32_bf16 v[124:127], a[12:15], a[36:39], v[124:127]
    ds_read_b64_tr_b16 a[86:87], v14 offset:33440
    v_mfma_f32_16x16x32_bf16 v[144:147], a[16:19], a[36:39], v[144:147]
    ds_read_b128 a[60:63], v12 offset:23680
    v_mfma_f32_16x16x32_bf16 v[128:131], a[0:3], a[40:43], v[128:131]
    buffer_load_dword v5, s[28:31], s23 offen offset:2048 lds
    s_add_u32 s23, s23, 0x20000
    v_mfma_f32_16x16x32_bf16 v[132:135], a[4:7], a[40:43], v[132:135]
    v_mfma_f32_16x16x32_bf16 v[136:139], a[8:11], a[40:43], v[136:139]
    v_mfma_f32_16x16x32_bf16 v[140:143], a[12:15], a[40:43], v[140:143]
    v_mfma_f32_16x16x32_bf16 v[148:151], a[16:19], a[40:43], v[148:151]
    s_waitcnt lgkmcnt(0)
    s_waitcnt vmcnt(24)
    s_barrier
    v_mfma_f32_16x16x32_bf16 v[48:51], a[64:67], a[44:47], v[48:51]
    ds_read_b64_tr_b16 a[20:21], v14 offset:52480
    v_mfma_f32_16x16x32_bf16 v[52:55], a[64:67], a[48:51], v[52:55]
    ds_read_b64_tr_b16 a[22:23], v14 offset:52992
    s_add_u32 m0, s24, 21632
    s_nop 0
    buffer_load_dwordx4 v6, s[32:35], s25 offen lds
    v_mfma_f32_16x16x32_bf16 v[56:59], a[64:67], a[52:55], v[56:59]
    ds_read_b64_tr_b16 a[24:25], v14 offset:52512
    v_mfma_f32_16x16x32_bf16 v[60:63], a[64:67], a[56:59], v[60:63]
    ds_read_b64_tr_b16 a[26:27], v14 offset:53024
    v_mfma_f32_16x16x32_bf16 v[64:67], a[68:71], a[44:47], v[64:67]
    v_mfma_f32_16x16x32_bf16 v[68:71], a[68:71], a[48:51], v[68:71]
    ds_read_b64_tr_b16 a[28:29], v14 offset:53504
    buffer_load_dwordx4 v7, s[32:35], s25 offen offset:1024 lds
    v_mfma_f32_16x16x32_bf16 v[72:75], a[68:71], a[52:55], v[72:75]
    ds_read_b64_tr_b16 a[30:31], v14 offset:54016
    v_mfma_f32_16x16x32_bf16 v[76:79], a[68:71], a[56:59], v[76:79]
    ds_read_b64_tr_b16 a[32:33], v14 offset:53536
    v_mfma_f32_16x16x32_bf16 v[80:83], a[72:75], a[44:47], v[80:83]
    v_mfma_f32_16x16x32_bf16 v[84:87], a[72:75], a[48:51], v[84:87]
    ds_read_b64_tr_b16 a[34:35], v14 offset:54048
    buffer_load_dwordx4 v8, s[32:35], s25 offen offset:2048 lds
    s_add_u32 s25, s25, 196608
    v_mfma_f32_16x16x32_bf16 v[88:91], a[72:75], a[52:55], v[88:91]
    ds_read_b128 a[0:3], v10 offset:43264
    v_mfma_f32_16x16x32_bf16 v[92:95], a[72:75], a[56:59], v[92:95]
    ds_read_b128 a[4:7], v10 offset:44288
    v_mfma_f32_16x16x32_bf16 v[96:99], a[76:79], a[44:47], v[96:99]
    ds_read_b64_tr_b16 a[36:37], v14 offset:54528
    v_mfma_f32_16x16x32_bf16 v[100:103], a[76:79], a[48:51], v[100:103]
    s_add_u32 m0, s22, 21632
    s_nop 0
    buffer_load_dwordx4 v4, s[28:31], s23 offen lds
    v_mfma_f32_16x16x32_bf16 v[104:107], a[76:79], a[52:55], v[104:107]
    ds_read_b64_tr_b16 a[38:39], v14 offset:55040
    v_mfma_f32_16x16x32_bf16 v[108:111], a[76:79], a[56:59], v[108:111]
    ds_read_b128 a[8:11], v10 offset:45568
    v_mfma_f32_16x16x32_bf16 v[112:115], a[44:47], a[80:83], v[112:115]
    ds_read_b128 a[12:15], v10 offset:46592
    v_mfma_f32_16x16x32_bf16 v[116:119], a[48:51], a[80:83], v[116:119]
    buffer_load_dwordx4 v4, s[28:31], s23 offen offset:1024 lds
    v_mfma_f32_16x16x32_bf16 v[120:123], a[52:55], a[80:83], v[120:123]
    ds_read_b64_tr_b16 a[40:41], v14 offset:54560
    v_mfma_f32_16x16x32_bf16 v[124:127], a[56:59], a[80:83], v[124:127]
    ds_read_b64_tr_b16 a[42:43], v14 offset:55072
    v_mfma_f32_16x16x32_bf16 v[144:147], a[60:63], a[80:83], v[144:147]
    ds_read_b128 a[16:19], v12 offset:45312
    v_mfma_f32_16x16x32_bf16 v[128:131], a[44:47], a[84:87], v[128:131]
    buffer_load_dword v5, s[28:31], s23 offen offset:2048 lds
    s_add_u32 s23, s23, 0x20000
    v_mfma_f32_16x16x32_bf16 v[132:135], a[48:51], a[84:87], v[132:135]
    v_mfma_f32_16x16x32_bf16 v[136:139], a[52:55], a[84:87], v[136:139]
    v_mfma_f32_16x16x32_bf16 v[140:143], a[56:59], a[84:87], v[140:143]
    v_mfma_f32_16x16x32_bf16 v[148:151], a[60:63], a[84:87], v[148:151]
    s_waitcnt lgkmcnt(0)
    s_waitcnt vmcnt(24)
    s_barrier
    v_mfma_f32_16x16x32_bf16 v[48:51], a[20:23], a[0:3], v[48:51]
    ds_read_b64_tr_b16 a[64:65], v15 offset:9216
    v_mfma_f32_16x16x32_bf16 v[52:55], a[20:23], a[4:7], v[52:55]
    ds_read_b64_tr_b16 a[66:67], v15 offset:9728
    s_add_u32 m0, s24, 43264
    s_nop 0
    buffer_load_dwordx4 v6, s[32:35], s25 offen lds
    v_mfma_f32_16x16x32_bf16 v[56:59], a[20:23], a[8:11], v[56:59]
    ds_read_b64_tr_b16 a[68:69], v15 offset:9248
    v_mfma_f32_16x16x32_bf16 v[60:63], a[20:23], a[12:15], v[60:63]
    ds_read_b64_tr_b16 a[70:71], v15 offset:9760
    v_mfma_f32_16x16x32_bf16 v[64:67], a[24:27], a[0:3], v[64:67]
    v_mfma_f32_16x16x32_bf16 v[68:71], a[24:27], a[4:7], v[68:71]
    ds_read_b64_tr_b16 a[72:73], v15 offset:10240
    buffer_load_dwordx4 v7, s[32:35], s25 offen offset:1024 lds
    v_mfma_f32_16x16x32_bf16 v[72:75], a[24:27], a[8:11], v[72:75]
    ds_read_b64_tr_b16 a[74:75], v15 offset:10752
    v_mfma_f32_16x16x32_bf16 v[76:79], a[24:27], a[12:15], v[76:79]
    ds_read_b64_tr_b16 a[76:77], v15 offset:10272
    v_mfma_f32_16x16x32_bf16 v[80:83], a[28:31], a[0:3], v[80:83]
    v_mfma_f32_16x16x32_bf16 v[84:87], a[28:31], a[4:7], v[84:87]
    ds_read_b64_tr_b16 a[78:79], v15 offset:10784
    buffer_load_dwordx4 v8, s[32:35], s25 offen offset:2048 lds
    s_add_u32 s25, s25, 196608
    v_mfma_f32_16x16x32_bf16 v[88:91], a[28:31], a[8:11], v[88:91]
    ds_read_b128 a[44:47], v11 offset:0
    v_mfma_f32_16x16x32_bf16 v[92:95], a[28:31], a[12:15], v[92:95]
    ds_read_b128 a[48:51], v11 offset:1024
    v_mfma_f32_16x16x32_bf16 v[96:99], a[32:35], a[0:3], v[96:99]
    ds_read_b64_tr_b16 a[80:81], v15 offset:11264
    v_mfma_f32_16x16x32_bf16 v[100:103], a[32:35], a[4:7], v[100:103]
    s_add_u32 m0, s22, 43264
    s_nop 0
    buffer_load_dwordx4 v4, s[28:31], s23 offen lds
    v_mfma_f32_16x16x32_bf16 v[104:107], a[32:35], a[8:11], v[104:107]
    ds_read_b64_tr_b16 a[82:83], v15 offset:11776
    v_mfma_f32_16x16x32_bf16 v[108:111], a[32:35], a[12:15], v[108:111]
    ds_read_b128 a[52:55], v11 offset:2304
    v_mfma_f32_16x16x32_bf16 v[112:115], a[0:3], a[36:39], v[112:115]
    ds_read_b128 a[56:59], v11 offset:3328
    v_mfma_f32_16x16x32_bf16 v[116:119], a[4:7], a[36:39], v[116:119]
    buffer_load_dwordx4 v4, s[28:31], s23 offen offset:1024 lds
    v_mfma_f32_16x16x32_bf16 v[120:123], a[8:11], a[36:39], v[120:123]
    ds_read_b64_tr_b16 a[84:85], v15 offset:11296
    v_mfma_f32_16x16x32_bf16 v[124:127], a[12:15], a[36:39], v[124:127]
    ds_read_b64_tr_b16 a[86:87], v15 offset:11808
    v_mfma_f32_16x16x32_bf16 v[144:147], a[16:19], a[36:39], v[144:147]
    ds_read_b128 a[60:63], v13 offset:2048
    v_mfma_f32_16x16x32_bf16 v[128:131], a[0:3], a[40:43], v[128:131]
    buffer_load_dword v5, s[28:31], s23 offen offset:2048 lds
    s_add_u32 s23, s23, 0x20000
    v_mfma_f32_16x16x32_bf16 v[132:135], a[4:7], a[40:43], v[132:135]
    v_mfma_f32_16x16x32_bf16 v[136:139], a[8:11], a[40:43], v[136:139]
    v_mfma_f32_16x16x32_bf16 v[140:143], a[12:15], a[40:43], v[140:143]
    v_mfma_f32_16x16x32_bf16 v[148:151], a[16:19], a[40:43], v[148:151]
    s_waitcnt lgkmcnt(0)
    s_waitcnt vmcnt(24)
    s_barrier
    v_mfma_f32_16x16x32_bf16 v[48:51], a[64:67], a[44:47], v[48:51]
    ds_read_b64_tr_b16 a[20:21], v15 offset:30848
    v_mfma_f32_16x16x32_bf16 v[52:55], a[64:67], a[48:51], v[52:55]
    ds_read_b64_tr_b16 a[22:23], v15 offset:31360
    s_add_u32 m0, s24, 64896
    s_nop 0
    buffer_load_dwordx4 v6, s[32:35], s25 offen lds
    v_mfma_f32_16x16x32_bf16 v[56:59], a[64:67], a[52:55], v[56:59]
    ds_read_b64_tr_b16 a[24:25], v15 offset:30880
    v_mfma_f32_16x16x32_bf16 v[60:63], a[64:67], a[56:59], v[60:63]
    ds_read_b64_tr_b16 a[26:27], v15 offset:31392
    v_mfma_f32_16x16x32_bf16 v[64:67], a[68:71], a[44:47], v[64:67]
    v_mfma_f32_16x16x32_bf16 v[68:71], a[68:71], a[48:51], v[68:71]
    ds_read_b64_tr_b16 a[28:29], v15 offset:31872
    buffer_load_dwordx4 v7, s[32:35], s25 offen offset:1024 lds
    v_mfma_f32_16x16x32_bf16 v[72:75], a[68:71], a[52:55], v[72:75]
    ds_read_b64_tr_b16 a[30:31], v15 offset:32384
    v_mfma_f32_16x16x32_bf16 v[76:79], a[68:71], a[56:59], v[76:79]
    ds_read_b64_tr_b16 a[32:33], v15 offset:31904
    v_mfma_f32_16x16x32_bf16 v[80:83], a[72:75], a[44:47], v[80:83]
    v_mfma_f32_16x16x32_bf16 v[84:87], a[72:75], a[48:51], v[84:87]
    ds_read_b64_tr_b16 a[34:35], v15 offset:32416
    buffer_load_dwordx4 v8, s[32:35], s25 offen offset:2048 lds
    s_add_u32 s25, s25, 196608
    v_mfma_f32_16x16x32_bf16 v[88:91], a[72:75], a[52:55], v[88:91]
    ds_read_b128 a[0:3], v11 offset:21632
    v_mfma_f32_16x16x32_bf16 v[92:95], a[72:75], a[56:59], v[92:95]
    ds_read_b128 a[4:7], v11 offset:22656
    v_mfma_f32_16x16x32_bf16 v[96:99], a[76:79], a[44:47], v[96:99]
    ds_read_b64_tr_b16 a[36:37], v15 offset:32896
    v_mfma_f32_16x16x32_bf16 v[100:103], a[76:79], a[48:51], v[100:103]
    s_add_u32 m0, s22, 64896
    s_nop 0
    buffer_load_dwordx4 v4, s[28:31], s23 offen lds
    v_mfma_f32_16x16x32_bf16 v[104:107], a[76:79], a[52:55], v[104:107]
    ds_read_b64_tr_b16 a[38:39], v15 offset:33408
    v_mfma_f32_16x16x32_bf16 v[108:111], a[76:79], a[56:59], v[108:111]
    ds_read_b128 a[8:11], v11 offset:23936
    v_mfma_f32_16x16x32_bf16 v[112:115], a[44:47], a[80:83], v[112:115]
    ds_read_b128 a[12:15], v11 offset:24960
    v_mfma_f32_16x16x32_bf16 v[116:119], a[48:51], a[80:83], v[116:119]
    buffer_load_dwordx4 v4, s[28:31], s23 offen offset:1024 lds
    v_mfma_f32_16x16x32_bf16 v[120:123], a[52:55], a[80:83], v[120:123]
    ds_read_b64_tr_b16 a[40:41], v15 offset:32928
    v_mfma_f32_16x16x32_bf16 v[124:127], a[56:59], a[80:83], v[124:127]
    ds_read_b64_tr_b16 a[42:43], v15 offset:33440
    v_mfma_f32_16x16x32_bf16 v[144:147], a[60:63], a[80:83], v[144:147]
    ds_read_b128 a[16:19], v13 offset:23680
    v_mfma_f32_16x16x32_bf16 v[128:131], a[44:47], a[84:87], v[128:131]
    buffer_load_dword v5, s[28:31], s23 offen offset:2048 lds
    s_add_u32 s23, s23, 0x20000
    v_mfma_f32_16x16x32_bf16 v[132:135], a[48:51], a[84:87], v[132:135]
    v_mfma_f32_16x16x32_bf16 v[136:139], a[52:55], a[84:87], v[136:139]
    v_mfma_f32_16x16x32_bf16 v[140:143], a[56:59], a[84:87], v[140:143]
    v_mfma_f32_16x16x32_bf16 v[148:151], a[60:63], a[84:87], v[148:151]
    s_waitcnt lgkmcnt(0)
    s_waitcnt vmcnt(24)
    s_barrier
    v_mfma_f32_16x16x32_bf16 v[48:51], a[20:23], a[0:3], v[48:51]
    ds_read_b64_tr_b16 a[64:65], v15 offset:52480
    v_mfma_f32_16x16x32_bf16 v[52:55], a[20:23], a[4:7], v[52:55]
    ds_read_b64_tr_b16 a[66:67], v15 offset:52992
    s_add_u32 m0, s24, 86528
    s_nop 0
    buffer_load_dwordx4 v6, s[32:35], s25 offen lds
    v_mfma_f32_16x16x32_bf16 v[56:59], a[20:23], a[8:11], v[56:59]
    ds_read_b64_tr_b16 a[68:69], v15 offset:52512
    v_mfma_f32_16x16x32_bf16 v[60:63], a[20:23], a[12:15], v[60:63]
    ds_read_b64_tr_b16 a[70:71], v15 offset:53024
    v_mfma_f32_16x16x32_bf16 v[64:67], a[24:27], a[0:3], v[64:67]
    v_mfma_f32_16x16x32_bf16 v[68:71], a[24:27], a[4:7], v[68:71]
    ds_read_b64_tr_b16 a[72:73], v15 offset:53504
    buffer_load_dwordx4 v7, s[32:35], s25 offen offset:1024 lds
    v_mfma_f32_16x16x32_bf16 v[72:75], a[24:27], a[8:11], v[72:75]
    ds_read_b64_tr_b16 a[74:75], v15 offset:54016
    v_mfma_f32_16x16x32_bf16 v[76:79], a[24:27], a[12:15], v[76:79]
    ds_read_b64_tr_b16 a[76:77], v15 offset:53536
    v_mfma_f32_16x16x32_bf16 v[80:83], a[28:31], a[0:3], v[80:83]
    v_mfma_f32_16x16x32_bf16 v[84:87], a[28:31], a[4:7], v[84:87]
    ds_read_b64_tr_b16 a[78:79], v15 offset:54048
    buffer_load_dwordx4 v8, s[32:35], s25 offen offset:2048 lds
    s_add_u32 s25, s25, 196608
    v_mfma_f32_16x16x32_bf16 v[88:91], a[28:31], a[8:11], v[88:91]
    ds_read_b128 a[44:47], v11 offset:43264
    v_mfma_f32_16x16x32_bf16 v[92:95], a[28:31], a[12:15], v[92:95]
    ds_read_b128 a[48:51], v11 offset:44288
    v_mfma_f32_16x16x32_bf16 v[96:99], a[32:35], a[0:3], v[96:99]
    ds_read_b64_tr_b16 a[80:81], v15 offset:54528
    v_mfma_f32_16x16x32_bf16 v[100:103], a[32:35], a[4:7], v[100:103]
    s_add_u32 m0, s22, 86528
    s_nop 0
    buffer_load_dwordx4 v4, s[28:31], s23 offen lds
    v_mfma_f32_16x16x32_bf16 v[104:107], a[32:35], a[8:11], v[104:107]
    ds_read_b64_tr_b16 a[82:83], v15 offset:55040
    v_mfma_f32_16x16x32_bf16 v[108:111], a[32:35], a[12:15], v[108:111]
    ds_read_b128 a[52:55], v11 offset:45568
    v_mfma_f32_16x16x32_bf16 v[112:115], a[0:3], a[36:39], v[112:115]
    ds_read_b128 a[56:59], v11 offset:46592
    v_mfma_f32_16x16x32_bf16 v[116:119], a[4:7], a[36:39], v[116:119]
    buffer_load_dwordx4 v4, s[28:31], s23 offen offset:1024 lds
    v_mfma_f32_16x16x32_bf16 v[120:123], a[8:11], a[36:39], v[120:123]
    ds_read_b64_tr_b16 a[84:85], v15 offset:54560
    v_mfma_f32_16x16x32_bf16 v[124:127], a[12:15], a[36:39], v[124:127]
    ds_read_b64_tr_b16 a[86:87], v15 offset:55072
    v_mfma_f32_16x16x32_bf16 v[144:147], a[16:19], a[36:39], v[144:147]
    ds_read_b128 a[60:63], v13 offset:45312
    v_mfma_f32_16x16x32_bf16 v[128:131], a[0:3], a[40:43], v[128:131]
    buffer_load_dword v5, s[28:31], s23 offen offset:2048 lds
    s_add_u32 s23, s23, 0x20000
    v_mfma_f32_16x16x32_bf16 v[132:135], a[4:7], a[40:43], v[132:135]
    v_mfma_f32_16x16x32_bf16 v[136:139], a[8:11], a[40:43], v[136:139]
    v_mfma_f32_16x16x32_bf16 v[140:143], a[12:15], a[40:43], v[140:143]
    v_mfma_f32_16x16x32_bf16 v[148:151], a[16:19], a[40:43], v[148:151]
    s_waitcnt lgkmcnt(0)
    s_waitcnt vmcnt(24)
    s_barrier
    v_mfma_f32_16x16x32_bf16 v[48:51], a[64:67], a[44:47], v[48:51]
    ds_read_b64_tr_b16 a[20:21], v14 offset:9216
    v_mfma_f32_16x16x32_bf16 v[52:55], a[64:67], a[48:51], v[52:55]
    ds_read_b64_tr_b16 a[22:23], v14 offset:9728
    s_add_u32 m0, s24, 108160
    s_nop 0
    buffer_load_dwordx4 v6, s[32:35], s25 offen lds
    v_mfma_f32_16x16x32_bf16 v[56:59], a[64:67], a[52:55], v[56:59]
    ds_read_b64_tr_b16 a[24:25], v14 offset:9248
    v_mfma_f32_16x16x32_bf16 v[60:63], a[64:67], a[56:59], v[60:63]
    ds_read_b64_tr_b16 a[26:27], v14 offset:9760
    v_mfma_f32_16x16x32_bf16 v[64:67], a[68:71], a[44:47], v[64:67]
    v_mfma_f32_16x16x32_bf16 v[68:71], a[68:71], a[48:51], v[68:71]
    ds_read_b64_tr_b16 a[28:29], v14 offset:10240
    buffer_load_dwordx4 v7, s[32:35], s25 offen offset:1024 lds
    v_mfma_f32_16x16x32_bf16 v[72:75], a[68:71], a[52:55], v[72:75]
    ds_read_b64_tr_b16 a[30:31], v14 offset:10752
    v_mfma_f32_16x16x32_bf16 v[76:79], a[68:71], a[56:59], v[76:79]
    ds_read_b64_tr_b16 a[32:33], v14 offset:10272
    v_mfma_f32_16x16x32_bf16 v[80:83], a[72:75], a[44:47], v[80:83]
    v_mfma_f32_16x16x32_bf16 v[84:87], a[72:75], a[48:51], v[84:87]
    ds_read_b64_tr_b16 a[34:35], v14 offset:10784
    buffer_load_dwordx4 v8, s[32:35], s25 offen offset:2048 lds
    s_add_u32 s25, s25, 196608
    v_mfma_f32_16x16x32_bf16 v[88:91], a[72:75], a[52:55], v[88:91]
    ds_read_b128 a[0:3], v10 offset:0
    v_mfma_f32_16x16x32_bf16 v[92:95], a[72:75], a[56:59], v[92:95]
    ds_read_b128 a[4:7], v10 offset:1024
    v_mfma_f32_16x16x32_bf16 v[96:99], a[76:79], a[44:47], v[96:99]
    ds_read_b64_tr_b16 a[36:37], v14 offset:11264
    v_mfma_f32_16x16x32_bf16 v[100:103], a[76:79], a[48:51], v[100:103]
    s_add_u32 m0, s22, 108160
    s_nop 0
    buffer_load_dwordx4 v4, s[28:31], s23 offen lds
    v_mfma_f32_16x16x32_bf16 v[104:107], a[76:79], a[52:55], v[104:107]
    ds_read_b64_tr_b16 a[38:39], v14 offset:11776
    v_mfma_f32_16x16x32_bf16 v[108:111], a[76:79], a[56:59], v[108:111]
    ds_read_b128 a[8:11], v10 offset:2304
    v_mfma_f32_16x16x32_bf16 v[112:115], a[44:47], a[80:83], v[112:115]
    ds_read_b128 a[12:15], v10 offset:3328
    v_mfma_f32_16x16x32_bf16 v[116:119], a[48:51], a[80:83], v[116:119]
    buffer_load_dwordx4 v4, s[28:31], s23 offen offset:1024 lds
    v_mfma_f32_16x16x32_bf16 v[120:123], a[52:55], a[80:83], v[120:123]
    ds_read_b64_tr_b16 a[40:41], v14 offset:11296
    v_mfma_f32_16x16x32_bf16 v[124:127], a[56:59], a[80:83], v[124:127]
    ds_read_b64_tr_b16 a[42:43], v14 offset:11808
    v_mfma_f32_16x16x32_bf16 v[144:147], a[60:63], a[80:83], v[144:147]
    ds_read_b128 a[16:19], v12 offset:2048
    v_mfma_f32_16x16x32_bf16 v[128:131], a[44:47], a[84:87], v[128:131]
    buffer_load_dword v5, s[28:31], s23 offen offset:2048 lds
    s_add_u32 s23, s23, 0x20000
    v_mfma_f32_16x16x32_bf16 v[132:135], a[48:51], a[84:87], v[132:135]
    v_mfma_f32_16x16x32_bf16 v[136:139], a[52:55], a[84:87], v[136:139]
    v_mfma_f32_16x16x32_bf16 v[140:143], a[56:59], a[84:87], v[140:143]
    v_mfma_f32_16x16x32_bf16 v[148:151], a[60:63], a[84:87], v[148:151]
    s_sub_u32 s48, s48, 1
    s_cmp_lg_u32 s48, 0
    s_cbranch_scc1 qkv2_kernel_t1_loop
    s_waitcnt lgkmcnt(0)
    s_waitcnt vmcnt(24)
    s_barrier
    v_mfma_f32_16x16x32_bf16 v[48:51], a[20:23], a[0:3], v[48:51]
    ds_read_b64_tr_b16 a[64:65], v14 offset:30848
    v_mfma_f32_16x16x32_bf16 v[52:55], a[20:23], a[4:7], v[52:55]
    ds_read_b64_tr_b16 a[66:67], v14 offset:31360
    s_add_u32 m0, s24, 0
    s_nop 0
    buffer_load_dwordx4 v6, s[32:35], s25 offen lds
    v_mfma_f32_16x16x32_bf16 v[56:59], a[20:23], a[8:11], v[56:59]
    ds_read_b64_tr_b16 a[68:69], v14 offset:30880
    v_mfma_f32_16x16x32_bf16 v[60:63], a[20:23], a[12:15], v[60:63]
    ds_read_b64_tr_b16 a[70:71], v14 offset:31392
    v_mfma_f32_16x16x32_bf16 v[64:67], a[24:27], a[0:3], v[64:67]
    v_mfma_f32_16x16x32_bf16 v[68:71], a[24:27], a[4:7], v[68:71]
    ds_read_b64_tr_b16 a[72:73], v14 offset:31872
    buffer_load_dwordx4 v7, s[32:35], s25 offen offset:1024 lds
    v_mfma_f32_16x16x32_bf16 v[72:75], a[24:27], a[8:11], v[72:75]
    ds_read_b64_tr_b16 a[74:75], v14 offset:32384
    v_mfma_f32_16x16x32_bf16 v[76:79], a[24:27], a[12:15], v[76:79]
    ds_read_b64_tr_b16 a[76:77], v14 offset:31904
    v_mfma_f32_16x16x32_bf16 v[80:83], a[28:31], a[0:3], v[80:83]
    v_mfma_f32_16x16x32_bf16 v[84:87], a[28:31], a[4:7], v[84:87]
    ds_read_b64_tr_b16 a[78:79], v14 offset:32416
    buffer_load_dwordx4 v8, s[32:35], s25 offen offset:2048 lds
    s_add_u32 s25, s25, 196608
    v_mfma_f32_16x16x32_bf16 v[88:91], a[28:31], a[8:11], v[88:91]
    ds_read_b128 a[44:47], v10 offset:21632
    v_mfma_f32_16x16x32_bf16 v[92:95], a[28:31], a[12:15], v[92:95]
    ds_read_b128 a[48:51], v10 offset:22656
    v_mfma_f32_16x16x32_bf16 v[96:99], a[32:35], a[0:3], v[96:99]
    ds_read_b64_tr_b16 a[80:81], v14 offset:32896
    v_mfma_f32_16x16x32_bf16 v[100:103], a[32:35], a[4:7], v[100:103]
    s_add_u32 m0, s22, 0
    s_nop 0
    buffer_load_dwordx4 v4, s[28:31], s23 offen lds
    v_mfma_f32_16x16x32_bf16 v[104:107], a[32:35], a[8:11], v[104:107]
    ds_read_b64_tr_b16 a[82:83], v14 offset:33408
    v_mfma_f32_16x16x32_bf16 v[108:111], a[32:35], a[12:15], v[108:111]
    ds_read_b128 a[52:55], v10 offset:23936
    v_mfma_f32_16x16x32_bf16 v[112:115], a[0:3], a[36:39], v[112:115]
    ds_read_b128 a[56:59], v10 offset:24960
    v_mfma_f32_16x16x32_bf16 v[116:119], a[4:7], a[36:39], v[116:119]
    buffer_load_dwordx4 v4, s[28:31], s23 offen offset:1024 lds
    v_mfma_f32_16x16x32_bf16 v[120:123], a[8:11], a[36:39], v[120:123]
    ds_read_b64_tr_b16 a[84:85], v14 offset:32928
    v_mfma_f32_16x16x32_bf16 v[124:127], a[12:15], a[36:39], v[124:127]
    ds_read_b64_tr_b16 a[86:87], v14 offset:33440
    v_mfma_f32_16x16x32_bf16 v[144:147], a[16:19], a[36:39], v[144:147]
    ds_read_b128 a[60:63], v12 offset:23680
    v_mfma_f32_16x16x32_bf16 v[128:131], a[0:3], a[40:43], v[128:131]
    buffer_load_dword v5, s[28:31], s23 offen offset:2048 lds
    s_add_u32 s23, s23, 0x20000
    v_mfma_f32_16x16x32_bf16 v[132:135], a[4:7], a[40:43], v[132:135]
    v_mfma_f32_16x16x32_bf16 v[136:139], a[8:11], a[40:43], v[136:139]
    v_mfma_f32_16x16x32_bf16 v[140:143], a[12:15], a[40:43], v[140:143]
    v_mfma_f32_16x16x32_bf16 v[148:151], a[16:19], a[40:43], v[148:151]
    s_waitcnt lgkmcnt(0)
    s_waitcnt vmcnt(24)
    s_barrier
    v_mfma_f32_16x16x32_bf16 v[48:51], a[64:67], a[44:47], v[48:51]
    ds_read_b64_tr_b16 a[20:21], v14 offset:52480
    v_mfma_f32_16x16x32_bf16 v[52:55], a[64:67], a[48:51], v[52:55]
    ds_read_b64_tr_b16 a[22:23], v14 offset:52992
    s_add_u32 m0, s24, 21632
    s_nop 0
    buffer_load_dwordx4 v6, s[32:35], s25 offen lds
    v_mfma_f32_16x16x32_bf16 v[56:59], a[64:67], a[52:55], v[56:59]
    ds_read_b64_tr_b16 a[24:25], v14 offset:52512
    v_mfma_f32_16x16x32_bf16 v[60:63], a[64:67], a[56:59], v[60:63]
    ds_read_b64_tr_b16 a[26:27], v14 offset:53024
    v_mfma_f32_16x16x32_bf16 v[64:67], a[68:71], a[44:47], v[64:67]
    v_mfma_f32_16x16x32_bf16 v[68:71], a[68:71], a[48:51], v[68:71]
    ds_read_b64_tr_b16 a[28:29], v14 offset:53504
    buffer_load_dwordx4 v7, s[32:35], s25 offen offset:1024 lds
    v_mfma_f32_16x16x32_bf16 v[72:75], a[68:71], a[52:55], v[72:75]
    ds_read_b64_tr_b16 a[30:31], v14 offset:54016
    v_mfma_f32_16x16x32_bf16 v[76:79], a[68:71], a[56:59], v[76:79]
    ds_read_b64_tr_b16 a[32:33], v14 offset:53536
    v_mfma_f32_16x16x32_bf16 v[80:83], a[72:75], a[44:47], v[80:83]
    v_mfma_f32_16x16x32_bf16 v[84:87], a[72:75], a[48:51], v[84:87]
    ds_read_b64_tr_b16 a[34:35], v14 offset:54048
    buffer_load_dwordx4 v8, s[32:35], s25 offen offset:2048 lds
    s_add_u32 s25, s25, 196608
    v_mfma_f32_16x16x32_bf16 v[88:91], a[72:75], a[52:55], v[88:91]
    ds_read_b128 a[0:3], v10 offset:43264
    v_mfma_f32_16x16x32_bf16 v[92:95], a[72:75], a[56:59], v[92:95]
    ds_read_b128 a[4:7], v10 offset:44288
    v_mfma_f32_16x16x32_bf16 v[96:99], a[76:79], a[44:47], v[96:99]
    ds_read_b64_tr_b16 a[36:37], v14 offset:54528
    v_mfma_f32_16x16x32_bf16 v[100:103], a[76:79], a[48:51], v[100:103]
    s_add_u32 m0, s22, 21632
    s_nop 0
    buffer_load_dwordx4 v4, s[28:31], s23 offen lds
    v_mfma_f32_16x16x32_bf16 v[104:107], a[76:79], a[52:55], v[104:107]
    ds_read_b64_tr_b16 a[38:39], v14 offset:55040
    v_mfma_f32_16x16x32_bf16 v[108:111], a[76:79], a[56:59], v[108:111]
    ds_read_b128 a[8:11], v10 offset:45568
    v_mfma_f32_16x16x32_bf16 v[112:115], a[44:47], a[80:83], v[112:115]
    ds_read_b128 a[12:15], v10 offset:46592
    v_mfma_f32_16x16x32_bf16 v[116:119], a[48:51], a[80:83], v[116:119]
    buffer_load_dwordx4 v4, s[28:31], s23 offen offset:1024 lds
    v_mfma_f32_16x16x32_bf16 v[120:123], a[52:55], a[80:83], v[120:123]
    ds_read_b64_tr_b16 a[40:41], v14 offset:54560
    v_mfma_f32_16x16x32_bf16 v[124:127], a[56:59], a[80:83], v[124:127]
    ds_read_b64_tr_b16 a[42:43], v14 offset:55072
    v_mfma_f32_16x16x32_bf16 v[144:147], a[60:63], a[80:83], v[144:147]
    ds_read_b128 a[16:19], v12 offset:45312
    v_mfma_f32_16x16x32_bf16 v[128:131], a[44:47], a[84:87], v[128:131]
    buffer_load_dword v5, s[28:31], s23 offen offset:2048 lds
    s_add_u32 s23, s23, 0x20000
    v_mfma_f32_16x16x32_bf16 v[132:135], a[48:51], a[84:87], v[132:135]
    v_mfma_f32_16x16x32_bf16 v[136:139], a[52:55], a[84:87], v[136:139]
    v_mfma_f32_16x16x32_bf16 v[140:143], a[56:59], a[84:87], v[140:143]
    v_mfma_f32_16x16x32_bf16 v[148:151], a[60:63], a[84:87], v[148:151]
    s_waitcnt lgkmcnt(0)
    s_waitcnt vmcnt(24)
    s_barrier
    v_mfma_f32_16x16x32_bf16 v[48:51], a[20:23], a[0:3], v[48:51]
    ds_read_b64_tr_b16 a[64:65], v15 offset:9216
    v_mfma_f32_16x16x32_bf16 v[52:55], a[20:23], a[4:7], v[52:55]
    ds_read_b64_tr_b16 a[66:67], v15 offset:9728
    v_mfma_f32_16x16x32_bf16 v[56:59], a[20:23], a[8:11], v[56:59]
    ds_read_b64_tr_b16 a[68:69], v15 offset:9248
    v_mfma_f32_16x16x32_bf16 v[60:63], a[20:23], a[12:15], v[60:63]
    ds_read_b64_tr_b16 a[70:71], v15 offset:9760
    v_mfma_f32_16x16x32_bf16 v[64:67], a[24:27], a[0:3], v[64:67]
    v_mfma_f32_16x16x32_bf16 v[68:71], a[24:27], a[4:7], v[68:71]
    ds_read_b64_tr_b16 a[72:73], v15 offset:10240
    v_mfma_f32_16x16x32_bf16 v[72:75], a[24:27], a[8:11], v[72:75]
    ds_read_b64_tr_b16 a[74:75], v15 offset:10752
    v_mfma_f32_16x16x32_bf16 v[76:79], a[24:27], a[12:15], v[76:79]
    ds_read_b64_tr_b16 a[76:77], v15 offset:10272
    v_mfma_f32_16x16x32_bf16 v[80:83], a[28:31], a[0:3], v[80:83]
    v_mfma_f32_16x16x32_bf16 v[84:87], a[28:31], a[4:7], v[84:87]
    ds_read_b64_tr_b16 a[78:79], v15 offset:10784
    v_mfma_f32_16x16x32_bf16 v[88:91], a[28:31], a[8:11], v[88:91]
    ds_read_b128 a[44:47], v11 offset:0
    v_mfma_f32_16x16x32_bf16 v[92:95], a[28:31], a[12:15], v[92:95]
    ds_read_b128 a[48:51], v11 offset:1024
    v_mfma_f32_16x16x32_bf16 v[96:99], a[32:35], a[0:3], v[96:99]
    ds_read_b64_tr_b16 a[80:81], v15 offset:11264
    v_mfma_f32_16x16x32_bf16 v[100:103], a[32:35], a[4:7], v[100:103]
    v_mfma_f32_16x16x32_bf16 v[104:107], a[32:35], a[8:11], v[104:107]
    ds_read_b64_tr_b16 a[82:83], v15 offset:11776
    v_mfma_f32_16x16x32_bf16 v[108:111], a[32:35], a[12:15], v[108:111]
    ds_read_b128 a[52:55], v11 offset:2304
    v_mfma_f32_16x16x32_bf16 v[112:115], a[0:3], a[36:39], v[112:115]
    ds_read_b128 a[56:59], v11 offset:3328
    v_mfma_f32_16x16x32_bf16 v[116:119], a[4:7], a[36:39], v[116:119]
    v_mfma_f32_16x16x32_bf16 v[120:123], a[8:11], a[36:39], v[120:123]
    ds_read_b64_tr_b16 a[84:85], v15 offset:11296
    v_mfma_f32_16x16x32_bf16 v[124:127], a[12:15], a[36:39], v[124:127]
    ds_read_b64_tr_b16 a[86:87], v15 offset:11808
    v_mfma_f32_16x16x32_bf16 v[144:147], a[16:19], a[36:39], v[144:147]
    ds_read_b128 a[60:63], v13 offset:2048
    v_mfma_f32_16x16x32_bf16 v[128:131], a[0:3], a[40:43], v[128:131]
    v_mfma_f32_16x16x32_bf16 v[132:135], a[4:7], a[40:43], v[132:135]
    v_mfma_f32_16x16x32_bf16 v[136:139], a[8:11], a[40:43], v[136:139]
    v_mfma_f32_16x16x32_bf16 v[140:143], a[12:15], a[40:43], v[140:143]
    v_mfma_f32_16x16x32_bf16 v[148:151], a[16:19], a[40:43], v[148:151]
    s_waitcnt lgkmcnt(0)
    s_waitcnt vmcnt(18)
    s_barrier
    v_mfma_f32_16x16x32_bf16 v[48:51], a[64:67], a[44:47], v[48:51]
    ds_read_b64_tr_b16 a[20:21], v15 offset:30848
    v_mfma_f32_16x16x32_bf16 v[52:55], a[64:67], a[48:51], v[52:55]
    ds_read_b64_tr_b16 a[22:23], v15 offset:31360
    v_mfma_f32_16x16x32_bf16 v[56:59], a[64:67], a[52:55], v[56:59]
    ds_read_b64_tr_b16 a[24:25], v15 offset:30880
    v_mfma_f32_16x16x32_bf16 v[60:63], a[64:67], a[56:59], v[60:63]
    ds_read_b64_tr_b16 a[26:27], v15 offset:31392
    v_mfma_f32_16x16x32_bf16 v[64:67], a[68:71], a[44:47], v[64:67]
    v_mfma_f32_16x16x32_bf16 v[68:71], a[68:71], a[48:51], v[68:71]
    ds_read_b64_tr_b16 a[28:29], v15 offset:31872
    v_mfma_f32_16x16x32_bf16 v[72:75], a[68:71], a[52:55], v[72:75]
    ds_read_b64_tr_b16 a[30:31], v15 offset:32384
    v_mfma_f32_16x16x32_bf16 v[76:79], a[68:71], a[56:59], v[76:79]
    ds_read_b64_tr_b16 a[32:33], v15 offset:31904
    v_mfma_f32_16x16x32_bf16 v[80:83], a[72:75], a[44:47], v[80:83]
    v_mfma_f32_16x16x32_bf16 v[84:87], a[72:75], a[48:51], v[84:87]
    ds_read_b64_tr_b16 a[34:35], v15 offset:32416
    v_mfma_f32_16x16x32_bf16 v[88:91], a[72:75], a[52:55], v[88:91]
    ds_read_b128 a[0:3], v11 offset:21632
    v_mfma_f32_16x16x32_bf16 v[92:95], a[72:75], a[56:59], v[92:95]
    ds_read_b128 a[4:7], v11 offset:22656
    v_mfma_f32_16x16x32_bf16 v[96:99], a[76:79], a[44:47], v[96:99]
    ds_read_b64_tr_b16 a[36:37], v15 offset:32896
    v_mfma_f32_16x16x32_bf16 v[100:103], a[76:79], a[48:51], v[100:103]
    v_mfma_f32_16x16x32_bf16 v[104:107], a[76:79], a[52:55], v[104:107]
    ds_read_b64_tr_b16 a[38:39], v15 offset:33408
    v_mfma_f32_16x16x32_bf16 v[108:111], a[76:79], a[56:59], v[108:111]
    ds_read_b128 a[8:11], v11 offset:23936
    v_mfma_f32_16x16x32_bf16 v[112:115], a[44:47], a[80:83], v[112:115]
    ds_read_b128 a[12:15], v11 offset:24960
    v_mfma_f32_16x16x32_bf16 v[116:119], a[48:51], a[80:83], v[116:119]
    v_mfma_f32_16x16x32_bf16 v[120:123], a[52:55], a[80:83], v[120:123]
    ds_read_b64_tr_b16 a[40:41], v15 offset:32928
    v_mfma_f32_16x16x32_bf16 v[124:127], a[56:59], a[80:83], v[124:127]
    ds_read_b64_tr_b16 a[42:43], v15 offset:33440
    v_mfma_f32_16x16x32_bf16 v[144:147], a[60:63], a[80:83], v[144:147]
    ds_read_b128 a[16:19], v13 offset:23680
    v_mfma_f32_16x16x32_bf16 v[128:131], a[44:47], a[84:87], v[128:131]
    v_mfma_f32_16x16x32_bf16 v[132:135], a[48:51], a[84:87], v[132:135]
    v_mfma_f32_16x16x32_bf16 v[136:139], a[52:55], a[84:87], v[136:139]
    v_mfma_f32_16x16x32_bf16 v[140:143], a[56:59], a[84:87], v[140:143]
    v_mfma_f32_16x16x32_bf16 v[148:151], a[60:63], a[84:87], v[148:151]
    s_waitcnt lgkmcnt(0)
    s_waitcnt vmcnt(12)
    s_barrier
    v_mfma_f32_16x16x32_bf16 v[48:51], a[20:23], a[0:3], v[48:51]
    ds_read_b64_tr_b16 a[64:65], v15 offset:52480
    v_mfma_f32_16x16x32_bf16 v[52:55], a[20:23], a[4:7], v[52:55]
    ds_read_b64_tr_b16 a[66:67], v15 offset:52992
    v_mfma_f32_16x16x32_bf16 v[56:59], a[20:23], a[8:11], v[56:59]
    ds_read_b64_tr_b16 a[68:69], v15 offset:52512
    v_mfma_f32_16x16x32_bf16 v[60:63], a[20:23], a[12:15], v[60:63]
    ds_read_b64_tr_b16 a[70:71], v15 offset:53024
    v_mfma_f32_16x16x32_bf16 v[64:67], a[24:27], a[0:3], v[64:67]
    v_mfma_f32_16x16x32_bf16 v[68:71], a[24:27], a[4:7], v[68:71]
    ds_read_b64_tr_b16 a[72:73], v15 offset:53504
    v_mfma_f32_16x16x32_bf16 v[72:75], a[24:27], a[8:11], v[72:75]
    ds_read_b64_tr_b16 a[74:75], v15 offset:54016
    v_mfma_f32_16x16x32_bf16 v[76:79], a[24:27], a[12:15], v[76:79]
    ds_read_b64_tr_b16 a[76:77], v15 offset:53536
    v_mfma_f32_16x16x32_bf16 v[80:83], a[28:31], a[0:3], v[80:83]
    v_mfma_f32_16x16x32_bf16 v[84:87], a[28:31], a[4:7], v[84:87]
    ds_read_b64_tr_b16 a[78:79], v15 offset:54048
    v_mfma_f32_16x16x32_bf16 v[88:91], a[28:31], a[8:11], v[88:91]
    ds_read_b128 a[44:47], v11 offset:43264
    v_mfma_f32_16x16x32_bf16 v[92:95], a[28:31], a[12:15], v[92:95]
    ds_read_b128 a[48:51], v11 offset:44288
    v_mfma_f32_16x16x32_bf16 v[96:99], a[32:35], a[0:3], v[96:99]
    ds_read_b64_tr_b16 a[80:81], v15 offset:54528
    v_mfma_f32_16x16x32_bf16 v[100:103], a[32:35], a[4:7], v[100:103]
    v_mfma_f32_16x16x32_bf16 v[104:107], a[32:35], a[8:11], v[104:107]
    ds_read_b64_tr_b16 a[82:83], v15 offset:55040
    v_mfma_f32_16x16x32_bf16 v[108:111], a[32:35], a[12:15], v[108:111]
    ds_read_b128 a[52:55], v11 offset:45568
    v_mfma_f32_16x16x32_bf16 v[112:115], a[0:3], a[36:39], v[112:115]
    ds_read_b128 a[56:59], v11 offset:46592
    v_mfma_f32_16x16x32_bf16 v[116:119], a[4:7], a[36:39], v[116:119]
    v_mfma_f32_16x16x32_bf16 v[120:123], a[8:11], a[36:39], v[120:123]
    ds_read_b64_tr_b16 a[84:85], v15 offset:54560
    v_mfma_f32_16x16x32_bf16 v[124:127], a[12:15], a[36:39], v[124:127]
    ds_read_b64_tr_b16 a[86:87], v15 offset:55072
    v_mfma_f32_16x16x32_bf16 v[144:147], a[16:19], a[36:39], v[144:147]
    ds_read_b128 a[60:63], v13 offset:45312
    v_mfma_f32_16x16x32_bf16 v[128:131], a[0:3], a[40:43], v[128:131]
    v_mfma_f32_16x16x32_bf16 v[132:135], a[4:7], a[40:43], v[132:135]
    v_mfma_f32_16x16x32_bf16 v[136:139], a[8:11], a[40:43], v[136:139]
    v_mfma_f32_16x16x32_bf16 v[140:143], a[12:15], a[40:43], v[140:143]
    v_mfma_f32_16x16x32_bf16 v[148:151], a[16:19], a[40:43], v[148:151]
    s_waitcnt lgkmcnt(0)
    s_waitcnt vmcnt(6)
    s_barrier
    v_mfma_f32_16x16x32_bf16 v[48:51], a[64:67], a[44:47], v[48:51]
    ds_read_b64_tr_b16 a[20:21], v14 offset:9216
    v_mfma_f32_16x16x32_bf16 v[52:55], a[64:67], a[48:51], v[52:55]
    ds_read_b64_tr_b16 a[22:23], v14 offset:9728
    v_mfma_f32_16x16x32_bf16 v[56:59], a[64:67], a[52:55], v[56:59]
    ds_read_b64_tr_b16 a[24:25], v14 offset:9248
    v_mfma_f32_16x16x32_bf16 v[60:63], a[64:67], a[56:59], v[60:63]
    ds_read_b64_tr_b16 a[26:27], v14 offset:9760
    v_mfma_f32_16x16x32_bf16 v[64:67], a[68:71], a[44:47], v[64:67]
    v_mfma_f32_16x16x32_bf16 v[68:71], a[68:71], a[48:51], v[68:71]
    ds_read_b64_tr_b16 a[28:29], v14 offset:10240
    v_mfma_f32_16x16x32_bf16 v[72:75], a[68:71], a[52:55], v[72:75]
    ds_read_b64_tr_b16 a[30:31], v14 offset:10752
    v_mfma_f32_16x16x32_bf16 v[76:79], a[68:71], a[56:59], v[76:79]
    ds_read_b64_tr_b16 a[32:33], v14 offset:10272
    v_mfma_f32_16x16x32_bf16 v[80:83], a[72:75], a[44:47], v[80:83]
    v_mfma_f32_16x16x32_bf16 v[84:87], a[72:75], a[48:51], v[84:87]
    ds_read_b64_tr_b16 a[34:35], v14 offset:10784
    v_mfma_f32_16x16x32_bf16 v[88:91], a[72:75], a[52:55], v[88:91]
    ds_read_b128 a[0:3], v10 offset:0
    v_mfma_f32_16x16x32_bf16 v[92:95], a[72:75], a[56:59], v[92:95]
    ds_read_b128 a[4:7], v10 offset:1024
    v_mfma_f32_16x16x32_bf16 v[96:99], a[76:79], a[44:47], v[96:99]
    ds_read_b64_tr_b16 a[36:37], v14 offset:11264
    v_mfma_f32_16x16x32_bf16 v[100:103], a[76:79], a[48:51], v[100:103]
    v_mfma_f32_16x16x32_bf16 v[104:107], a[76:79], a[52:55], v[104:107]
    ds_read_b64_tr_b16 a[38:39], v14 offset:11776
    v_mfma_f32_16x16x32_bf16 v[108:111], a[76:79], a[56:59], v[108:111]
    ds_read_b128 a[8:11], v10 offset:2304
    v_mfma_f32_16x16x32_bf16 v[112:115], a[44:47], a[80:83], v[112:115]
    ds_read_b128 a[12:15], v10 offset:3328
    v_mfma_f32_16x16x32_bf16 v[116:119], a[48:51], a[80:83], v[116:119]
    v_mfma_f32_16x16x32_bf16 v[120:123], a[52:55], a[80:83], v[120:123]
    ds_read_b64_tr_b16 a[40:41], v14 offset:11296
    v_mfma_f32_16x16x32_bf16 v[124:127], a[56:59], a[80:83], v[124:127]
    ds_read_b64_tr_b16 a[42:43], v14 offset:11808
    v_mfma_f32_16x16x32_bf16 v[144:147], a[60:63], a[80:83], v[144:147]
    ds_read_b128 a[16:19], v12 offset:2048
    v_mfma_f32_16x16x32_bf16 v[128:131], a[44:47], a[84:87], v[128:131]
    v_mfma_f32_16x16x32_bf16 v[132:135], a[48:51], a[84:87], v[132:135]
    v_mfma_f32_16x16x32_bf16 v[136:139], a[52:55], a[84:87], v[136:139]
    v_mfma_f32_16x16x32_bf16 v[140:143], a[56:59], a[84:87], v[140:143]
    v_mfma_f32_16x16x32_bf16 v[148:151], a[60:63], a[84:87], v[148:151]
    s_waitcnt lgkmcnt(0)
    s_waitcnt vmcnt(0)
    s_barrier
    v_mfma_f32_16x16x32_bf16 v[48:51], a[20:23], a[0:3], v[48:51]
    ds_read_b64_tr_b16 a[64:65], v14 offset:30848
    v_mfma_f32_16x16x32_bf16 v[52:55], a[20:23], a[4:7], v[52:55]
    ds_read_b64_tr_b16 a[66:67], v14 offset:31360
    v_mfma_f32_16x16x32_bf16 v[56:59], a[20:23], a[8:11], v[56:59]
    ds_read_b64_tr_b16 a[68:69], v14 offset:30880
    v_mfma_f32_16x16x32_bf16 v[60:63], a[20:23], a[12:15], v[60:63]
    ds_read_b64_tr_b16 a[70:71], v14 offset:31392
    v_mfma_f32_16x16x32_bf16 v[64:67], a[24:27], a[0:3], v[64:67]
    v_mfma_f32_16x16x32_bf16 v[68:71], a[24:27], a[4:7], v[68:71]
    ds_read_b64_tr_b16 a[72:73], v14 offset:31872
    v_mfma_f32_16x16x32_bf16 v[72:75], a[24:27], a[8:11], v[72:75]
    ds_read_b64_tr_b16 a[74:75], v14 offset:32384
    v_mfma_f32_16x16x32_bf16 v[76:79], a[24:27], a[12:15], v[76:79]
    ds_read_b64_tr_b16 a[76:77], v14 offset:31904
    v_mfma_f32_16x16x32_bf16 v[80:83], a[28:31], a[0:3], v[80:83]
    v_mfma_f32_16x16x32_bf16 v[84:87], a[28:31], a[4:7], v[84:87]
    ds_read_b64_tr_b16 a[78:79], v14 offset:32416
    v_mfma_f32_16x16x32_bf16 v[88:91], a[28:31], a[8:11], v[88:91]
    ds_read_b128 a[44:47], v10 offset:21632
    v_mfma_f32_16x16x32_bf16 v[92:95], a[28:31], a[12:15], v[92:95]
    ds_read_b128 a[48:51], v10 offset:22656
    v_mfma_f32_16x16x32_bf16 v[96:99], a[32:35], a[0:3], v[96:99]
    ds_read_b64_tr_b16 a[80:81], v14 offset:32896
    v_mfma_f32_16x16x32_bf16 v[100:103], a[32:35], a[4:7], v[100:103]
    v_mfma_f32_16x16x32_bf16 v[104:107], a[32:35], a[8:11], v[104:107]
    ds_read_b64_tr_b16 a[82:83], v14 offset:33408
    v_mfma_f32_16x16x32_bf16 v[108:111], a[32:35], a[12:15], v[108:111]
    ds_read_b128 a[52:55], v10 offset:23936
    v_mfma_f32_16x16x32_bf16 v[112:115], a[0:3], a[36:39], v[112:115]
    ds_read_b128 a[56:59], v10 offset:24960
    v_mfma_f32_16x16x32_bf16 v[116:119], a[4:7], a[36:39], v[116:119]
    v_mfma_f32_16x16x32_bf16 v[120:123], a[8:11], a[36:39], v[120:123]
    ds_read_b64_tr_b16 a[84:85], v14 offset:32928
    v_mfma_f32_16x16x32_bf16 v[124:127], a[12:15], a[36:39], v[124:127]
    ds_read_b64_tr_b16 a[86:87], v14 offset:33440
    v_mfma_f32_16x16x32_bf16 v[144:147], a[16:19], a[36:39], v[144:147]
    ds_read_b128 a[60:63], v12 offset:23680
    v_mfma_f32_16x16x32_bf16 v[128:131], a[0:3], a[40:43], v[128:131]
    v_mfma_f32_16x16x32_bf16 v[132:135], a[4:7], a[40:43], v[132:135]
    v_mfma_f32_16x16x32_bf16 v[136:139], a[8:11], a[40:43], v[136:139]
    v_mfma_f32_16x16x32_bf16 v[140:143], a[12:15], a[40:43], v[140:143]
    v_mfma_f32_16x16x32_bf16 v[148:151], a[16:19], a[40:43], v[148:151]
    s_waitcnt lgkmcnt(0)
    v_mfma_f32_16x16x32_bf16 v[48:51], a[64:67], a[44:47], v[48:51]
    v_mfma_f32_16x16x32_bf16 v[52:55], a[64:67], a[48:51], v[52:55]
    v_mfma_f32_16x16x32_bf16 v[56:59], a[64:67], a[52:55], v[56:59]
    v_mfma_f32_16x16x32_bf16 v[60:63], a[64:67], a[56:59], v[60:63]
    v_mfma_f32_16x16x32_bf16 v[64:67], a[68:71], a[44:47], v[64:67]
    v_mfma_f32_16x16x32_bf16 v[68:71], a[68:71], a[48:51], v[68:71]
    v_mfma_f32_16x16x32_bf16 v[72:75], a[68:71], a[52:55], v[72:75]
    v_mfma_f32_16x16x32_bf16 v[76:79], a[68:71], a[56:59], v[76:79]
    v_mfma_f32_16x16x32_bf16 v[80:83], a[72:75], a[44:47], v[80:83]
    v_mfma_f32_16x16x32_bf16 v[84:87], a[72:75], a[48:51], v[84:87]
    v_mfma_f32_16x16x32_bf16 v[88:91], a[72:75], a[52:55], v[88:91]
    v_mfma_f32_16x16x32_bf16 v[92:95], a[72:75], a[56:59], v[92:95]
    v_mfma_f32_16x16x32_bf16 v[96:99], a[76:79], a[44:47], v[96:99]
    v_mfma_f32_16x16x32_bf16 v[100:103], a[76:79], a[48:51], v[100:103]
    v_mfma_f32_16x16x32_bf16 v[104:107], a[76:79], a[52:55], v[104:107]
    v_mfma_f32_16x16x32_bf16 v[108:111], a[76:79], a[56:59], v[108:111]
    v_mfma_f32_16x16x32_bf16 v[112:115], a[44:47], a[80:83], v[112:115]
    v_mfma_f32_16x16x32_bf16 v[116:119], a[48:51], a[80:83], v[116:119]
    v_mfma_f32_16x16x32_bf16 v[120:123], a[52:55], a[80:83], v[120:123]
    v_mfma_f32_16x16x32_bf16 v[124:127], a[56:59], a[80:83], v[124:127]
    v_mfma_f32_16x16x32_bf16 v[144:147], a[60:63], a[80:83], v[144:147]
    v_mfma_f32_16x16x32_bf16 v[128:131], a[44:47], a[84:87], v[128:131]
    v_mfma_f32_16x16x32_bf16 v[132:135], a[48:51], a[84:87], v[132:135]
    v_mfma_f32_16x16x32_bf16 v[136:139], a[52:55], a[84:87], v[136:139]
    v_mfma_f32_16x16x32_bf16 v[140:143], a[56:59], a[84:87], v[140:143]
    v_mfma_f32_16x16x32_bf16 v[148:151], a[60:63], a[84:87], v[148:151]
    v_and_b32 v6, 15, v1
    v_lshlrev_b32 v6, 4, v6
    v_add_u32 v6, 129792, v6
    v_lshrrev_b32 v7, 4, v1
    v_lshlrev_b32 v7, 4, v7
    v_add_u32 v7, 132864, v7
    s_lshl_b32 s20, s3, 11
    s_add_u32 s20, s20, 135168
    v_lshl_add_u32 v8, v1, 4, s20
    v_xor_b32 v9, 2048, v8
    ds_read_b128 v[216:219], v6 offset:1024
    ds_read_b128 v[220:223], v6 offset:1280
    ds_read_b128 v[224:227], v6 offset:1536
    ds_read_b128 v[228:231], v6 offset:1792
    v_mov_b32 v244, 0x3f803f80
    v_mov_b32 v245, 0x3f803f80
    v_mov_b32 v246, 0x3f803f80
    v_mov_b32 v247, 0x3f803f80
    ds_read_b128 v[236:239], v7 offset:512
    ds_read_b128 v[240:243], v7 offset:1280
    s_waitcnt lgkmcnt(1)
    v_pk_fma_f32 v[144:145], v[236:237], v[32:33], v[144:145] op_sel_hi:[1,0,1]
    s_waitcnt lgkmcnt(0)
    v_pk_mul_f32 v[144:145], v[144:145], v[240:241]
    v_cvt_pk_bf16_f32 v12, v144, v145
    v_pk_fma_f32 v[146:147], v[238:239], v[32:33], v[146:147] op_sel_hi:[1,0,1]
    v_pk_mul_f32 v[146:147], v[146:147], v[242:243]
    v_cvt_pk_bf16_f32 v13, v146, v147
    v_pk_fma_f32 v[148:149], v[236:237], v[32:33], v[148:149] op_sel:[0,1,0] op_sel_hi:[1,1,1]
    v_pk_mul_f32 v[148:149], v[148:149], v[240:241]
    v_cvt_pk_bf16_f32 v14, v148, v149
    v_pk_fma_f32 v[150:151], v[238:239], v[32:33], v[150:151] op_sel:[0,1,0] op_sel_hi:[1,1,1]
    v_pk_mul_f32 v[150:151], v[150:151], v[242:243]
    v_cvt_pk_bf16_f32 v15, v150, v151
    ds_write_b128 v8, v[12:15] offset:1024
    v_pk_fma_f32 v[80:81], v[24:25], v[216:217], v[80:81] op_sel_hi:[1,0,1]
    v_pk_mul_f32 v[80:81], v[80:81], v[216:217] op_sel:[0,1] op_sel_hi:[1,1]
    v_cvt_pk_bf16_f32 v180, v80, v81
    v_pk_fma_f32 v[82:83], v[26:27], v[216:217], v[82:83] op_sel_hi:[1,0,1]
    v_pk_mul_f32 v[82:83], v[82:83], v[216:217] op_sel:[0,1] op_sel_hi:[1,1]
    v_cvt_pk_bf16_f32 v181, v82, v83
    v_pk_fma_f32 v[96:97], v[28:29], v[216:217], v[96:97] op_sel_hi:[1,0,1]
    v_pk_mul_f32 v[96:97], v[96:97], v[216:217] op_sel:[0,1] op_sel_hi:[1,1]
    v_cvt_pk_bf16_f32 v182, v96, v97
    v_pk_fma_f32 v[98:99], v[30:31], v[216:217], v[98:99] op_sel_hi:[1,0,1]
    v_pk_mul_f32 v[98:99], v[98:99], v[216:217] op_sel:[0,1] op_sel_hi:[1,1]
    v_cvt_pk_bf16_f32 v183, v98, v99
    ds_read_b128 v[236:239], v7 offset:256
    ds_read_b128 v[240:243], v7 offset:1024
    s_waitcnt lgkmcnt(1)
    v_pk_fma_f32 v[112:113], v[236:237], v[32:33], v[112:113] op_sel_hi:[1,0,1]
    s_waitcnt lgkmcnt(0)
    v_pk_mul_f32 v[112:113], v[112:113], v[240:241]
    v_cvt_pk_bf16_f32 v198, v112, v113
    v_pk_fma_f32 v[114:115], v[238:239], v[32:33], v[114:115] op_sel_hi:[1,0,1]
    v_pk_mul_f32 v[114:115], v[114:115], v[242:243]
    v_cvt_pk_bf16_f32 v199, v114, v115
    v_pk_fma_f32 v[128:129], v[236:237], v[32:33], v[128:129] op_sel:[0,1,0] op_sel_hi:[1,1,1]
    v_pk_mul_f32 v[128:129], v[128:129], v[240:241]
    v_cvt_pk_bf16_f32 v208, v128, v129
    v_pk_fma_f32 v[130:131], v[238:239], v[32:33], v[130:131] op_sel:[0,1,0] op_sel_hi:[1,1,1]
    v_pk_mul_f32 v[130:131], v[130:131], v[242:243]
    v_cvt_pk_bf16_f32 v209, v130, v131
    v_pk_fma_f32 v[84:85], v[24:25], v[220:221], v[84:85] op_sel_hi:[1,0,1]
    v_pk_mul_f32 v[84:85], v[84:85], v[220:221] op_sel:[0,1] op_sel_hi:[1,1]
    v_cvt_pk_bf16_f32 v184, v84, v85
    v_pk_fma_f32 v[86:87], v[26:27], v[220:221], v[86:87] op_sel_hi:[1,0,1]
    v_pk_mul_f32 v[86:87], v[86:87], v[220:221] op_sel:[0,1] op_sel_hi:[1,1]
    v_cvt_pk_bf16_f32 v185, v86, v87
    v_pk_fma_f32 v[100:101], v[28:29], v[220:221], v[100:101] op_sel_hi:[1,0,1]
    v_pk_mul_f32 v[100:101], v[100:101], v[220:221] op_sel:[0,1] op_sel_hi:[1,1]
    v_cvt_pk_bf16_f32 v186, v100, v101
    v_pk_fma_f32 v[102:103], v[30:31], v[220:221], v[102:103] op_sel_hi:[1,0,1]
    v_pk_mul_f32 v[102:103], v[102:103], v[220:221] op_sel:[0,1] op_sel_hi:[1,1]
    v_cvt_pk_bf16_f32 v187, v102, v103
    ds_read_b128 v[236:239], v7 offset:320
    ds_read_b128 v[240:243], v7 offset:1088
    s_waitcnt lgkmcnt(1)
    v_pk_fma_f32 v[116:117], v[236:237], v[32:33], v[116:117] op_sel_hi:[1,0,1]
    s_waitcnt lgkmcnt(0)
    v_pk_mul_f32 v[116:117], v[116:117], v[240:241]
    v_cvt_pk_bf16_f32 v200, v116, v117
    v_pk_fma_f32 v[118:119], v[238:239], v[32:33], v[118:119] op_sel_hi:[1,0,1]
    v_pk_mul_f32 v[118:119], v[118:119], v[242:243]
    v_cvt_pk_bf16_f32 v201, v118, v119
    v_pk_fma_f32 v[132:133], v[236:237], v[32:33], v[132:133] op_sel:[0,1,0] op_sel_hi:[1,1,1]
    v_pk_mul_f32 v[132:133], v[132:133], v[240:241]
    v_cvt_pk_bf16_f32 v210, v132, v133
    v_pk_fma_f32 v[134:135], v[238:239], v[32:33], v[134:135] op_sel:[0,1,0] op_sel_hi:[1,1,1]
    v_pk_mul_f32 v[134:135], v[134:135], v[242:243]
    v_cvt_pk_bf16_f32 v211, v134, v135
    v_pk_fma_f32 v[88:89], v[24:25], v[224:225], v[88:89] op_sel_hi:[1,0,1]
    v_pk_mul_f32 v[88:89], v[88:89], v[224:225] op_sel:[0,1] op_sel_hi:[1,1]
    v_cvt_pk_bf16_f32 v188, v88, v89
    v_pk_fma_f32 v[90:91], v[26:27], v[224:225], v[90:91] op_sel_hi:[1,0,1]
    v_pk_mul_f32 v[90:91], v[90:91], v[224:225] op_sel:[0,1] op_sel_hi:[1,1]
    v_cvt_pk_bf16_f32 v189, v90, v91
    v_pk_fma_f32 v[104:105], v[28:29], v[224:225], v[104:105] op_sel_hi:[1,0,1]
    v_pk_mul_f32 v[104:105], v[104:105], v[224:225] op_sel:[0,1] op_sel_hi:[1,1]
    v_cvt_pk_bf16_f32 v190, v104, v105
    v_pk_fma_f32 v[106:107], v[30:31], v[224:225], v[106:107] op_sel_hi:[1,0,1]
    v_pk_mul_f32 v[106:107], v[106:107], v[224:225] op_sel:[0,1] op_sel_hi:[1,1]
    v_cvt_pk_bf16_f32 v191, v106, v107
    ds_read_b128 v[236:239], v7 offset:384
    ds_read_b128 v[240:243], v7 offset:1152
    s_waitcnt lgkmcnt(1)
    v_pk_fma_f32 v[120:121], v[236:237], v[32:33], v[120:121] op_sel_hi:[1,0,1]
    s_waitcnt lgkmcnt(0)
    v_pk_mul_f32 v[120:121], v[120:121], v[240:241]
    v_cvt_pk_bf16_f32 v202, v120, v121
    v_pk_fma_f32 v[122:123], v[238:239], v[32:33], v[122:123] op_sel_hi:[1,0,1]
    v_pk_mul_f32 v[122:123], v[122:123], v[242:243]
    v_cvt_pk_bf16_f32 v203, v122, v123
    v_pk_fma_f32 v[136:137], v[236:237], v[32:33], v[136:137] op_sel:[0,1,0] op_sel_hi:[1,1,1]
    v_pk_mul_f32 v[136:137], v[136:137], v[240:241]
    v_cvt_pk_bf16_f32 v212, v136, v137
    v_pk_fma_f32 v[138:139], v[238:239], v[32:33], v[138:139] op_sel:[0,1,0] op_sel_hi:[1,1,1]
    v_pk_mul_f32 v[138:139], v[138:139], v[242:243]
    v_cvt_pk_bf16_f32 v213, v138, v139
    v_pk_fma_f32 v[92:93], v[24:25], v[228:229], v[92:93] op_sel_hi:[1,0,1]
    v_pk_mul_f32 v[92:93], v[92:93], v[228:229] op_sel:[0,1] op_sel_hi:[1,1]
    v_cvt_pk_bf16_f32 v192, v92, v93
    v_pk_fma_f32 v[94:95], v[26:27], v[228:229], v[94:95] op_sel_hi:[1,0,1]
    v_pk_mul_f32 v[94:95], v[94:95], v[228:229] op_sel:[0,1] op_sel_hi:[1,1]
    v_cvt_pk_bf16_f32 v193, v94, v95
    v_pk_fma_f32 v[108:109], v[28:29], v[228:229], v[108:109] op_sel_hi:[1,0,1]
    v_pk_mul_f32 v[108:109], v[108:109], v[228:229] op_sel:[0,1] op_sel_hi:[1,1]
    v_cvt_pk_bf16_f32 v194, v108, v109
    v_pk_fma_f32 v[110:111], v[30:31], v[228:229], v[110:111] op_sel_hi:[1,0,1]
    v_pk_mul_f32 v[110:111], v[110:111], v[228:229] op_sel:[0,1] op_sel_hi:[1,1]
    v_cvt_pk_bf16_f32 v195, v110, v111
    ds_read_b128 v[236:239], v7 offset:448
    ds_read_b128 v[240:243], v7 offset:1216
    s_waitcnt lgkmcnt(1)
    v_pk_fma_f32 v[124:125], v[236:237], v[32:33], v[124:125] op_sel_hi:[1,0,1]
    s_waitcnt lgkmcnt(0)
    v_pk_mul_f32 v[124:125], v[124:125], v[240:241]
    v_cvt_pk_bf16_f32 v204, v124, v125
    v_pk_fma_f32 v[126:127], v[238:239], v[32:33], v[126:127] op_sel_hi:[1,0,1]
    v_pk_mul_f32 v[126:127], v[126:127], v[242:243]
    v_cvt_pk_bf16_f32 v205, v126, v127
    v_pk_fma_f32 v[140:141], v[236:237], v[32:33], v[140:141] op_sel:[0,1,0] op_sel_hi:[1,1,1]
    v_pk_mul_f32 v[140:141], v[140:141], v[240:241]
    v_cvt_pk_bf16_f32 v214, v140, v141
    v_pk_fma_f32 v[142:143], v[238:239], v[32:33], v[142:143] op_sel:[0,1,0] op_sel_hi:[1,1,1]
    v_pk_mul_f32 v[142:143], v[142:143], v[242:243]
    v_cvt_pk_bf16_f32 v215, v142, v143
    s_waitcnt lgkmcnt(0)
    s_barrier
    ds_read_b128 v[176:179], v9
    ds_read_b64 v[196:197], v9 offset:1024
    ds_read_b64 v[206:207], v9 offset:1032
    v_pk_fma_f32 v[48:49], v[16:17], v[216:217], v[48:49] op_sel_hi:[1,0,1]
    v_pk_mul_f32 v[48:49], v[48:49], v[218:219] op_sel_hi:[1,0]
    v_cvt_pk_bf16_f32 v160, v48, v49
    v_pk_fma_f32 v[50:51], v[18:19], v[216:217], v[50:51] op_sel_hi:[1,0,1]
    v_pk_mul_f32 v[50:51], v[50:51], v[218:219] op_sel_hi:[1,0]
    v_cvt_pk_bf16_f32 v161, v50, v51
    v_pk_fma_f32 v[64:65], v[20:21], v[216:217], v[64:65] op_sel_hi:[1,0,1]
    v_pk_mul_f32 v[64:65], v[64:65], v[218:219] op_sel_hi:[1,0]
    v_cvt_pk_bf16_f32 v162, v64, v65
    v_pk_fma_f32 v[66:67], v[22:23], v[216:217], v[66:67] op_sel_hi:[1,0,1]
    v_pk_mul_f32 v[66:67], v[66:67], v[218:219] op_sel_hi:[1,0]
    v_cvt_pk_bf16_f32 v163, v66, v67
    v_pk_fma_f32 v[52:53], v[16:17], v[220:221], v[52:53] op_sel_hi:[1,0,1]
    v_pk_mul_f32 v[52:53], v[52:53], v[222:223] op_sel_hi:[1,0]
    v_cvt_pk_bf16_f32 v164, v52, v53
    v_pk_fma_f32 v[54:55], v[18:19], v[220:221], v[54:55] op_sel_hi:[1,0,1]
    v_pk_mul_f32 v[54:55], v[54:55], v[222:223] op_sel_hi:[1,0]
    v_cvt_pk_bf16_f32 v165, v54, v55
    v_pk_fma_f32 v[68:69], v[20:21], v[220:221], v[68:69] op_sel_hi:[1,0,1]
    v_pk_mul_f32 v[68:69], v[68:69], v[222:223] op_sel_hi:[1,0]
    v_cvt_pk_bf16_f32 v166, v68, v69
    v_pk_fma_f32 v[70:71], v[22:23], v[220:221], v[70:71] op_sel_hi:[1,0,1]
    v_pk_mul_f32 v[70:71], v[70:71], v[222:223] op_sel_hi:[1,0]
    v_cvt_pk_bf16_f32 v167, v70, v71
    v_pk_fma_f32 v[56:57], v[16:17], v[224:225], v[56:57] op_sel_hi:[1,0,1]
    v_pk_mul_f32 v[56:57], v[56:57], v[226:227] op_sel_hi:[1,0]
    v_cvt_pk_bf16_f32 v168, v56, v57
    v_pk_fma_f32 v[58:59], v[18:19], v[224:225], v[58:59] op_sel_hi:[1,0,1]
    v_pk_mul_f32 v[58:59], v[58:59], v[226:227] op_sel_hi:[1,0]
    v_cvt_pk_bf16_f32 v169, v58, v59
    v_pk_fma_f32 v[72:73], v[20:21], v[224:225], v[72:73] op_sel_hi:[1,0,1]
    v_pk_mul_f32 v[72:73], v[72:73], v[226:227] op_sel_hi:[1,0]
    v_cvt_pk_bf16_f32 v170, v72, v73
    v_pk_fma_f32 v[74:75], v[22:23], v[224:225], v[74:75] op_sel_hi:[1,0,1]
    v_pk_mul_f32 v[74:75], v[74:75], v[226:227] op_sel_hi:[1,0]
    v_cvt_pk_bf16_f32 v171, v74, v75
    v_pk_fma_f32 v[60:61], v[16:17], v[228:229], v[60:61] op_sel_hi:[1,0,1]
    v_pk_mul_f32 v[60:61], v[60:61], v[230:231] op_sel_hi:[1,0]
    v_cvt_pk_bf16_f32 v172, v60, v61
    v_pk_fma_f32 v[62:63], v[18:19], v[228:229], v[62:63] op_sel_hi:[1,0,1]
    v_pk_mul_f32 v[62:63], v[62:63], v[230:231] op_sel_hi:[1,0]
    v_cvt_pk_bf16_f32 v173, v62, v63
    v_pk_fma_f32 v[76:77], v[20:21], v[228:229], v[76:77] op_sel_hi:[1,0,1]
    v_pk_mul_f32 v[76:77], v[76:77], v[230:231] op_sel_hi:[1,0]
    v_cvt_pk_bf16_f32 v174, v76, v77
    v_pk_fma_f32 v[78:79], v[22:23], v[228:229], v[78:79] op_sel_hi:[1,0,1]
    v_pk_mul_f32 v[78:79], v[78:79], v[230:231] op_sel_hi:[1,0]
    v_cvt_pk_bf16_f32 v175, v78, v79
    v_mfma_f32_16x16x32_bf16 v[56:59], v[180:183], v[164:167], v[36:39]
    v_mfma_f32_16x16x32_bf16 v[60:63], v[184:187], v[164:167], v[40:43]
    v_mfma_f32_16x16x32_bf16 v[64:67], v[184:187], v[168:171], v[36:39]
    v_mfma_f32_16x16x32_bf16 v[68:71], v[188:191], v[168:171], v[40:43]
    v_mfma_f32_16x16x32_bf16 v[72:75], v[188:191], v[172:175], v[36:39]
    v_mfma_f32_16x16x32_bf16 v[76:79], v[192:195], v[172:175], v[40:43]
    s_waitcnt lgkmcnt(2)
    v_mfma_f32_16x16x32_bf16 v[48:51], v[176:179], v[160:163], v[36:39]
    v_mfma_f32_16x16x32_bf16 v[52:55], v[180:183], v[160:163], v[40:43]
    v_max3_f32 v82, v56, v57, v58
    v_max3_f32 v83, v59, v60, v61
    v_max3_f32 v82, v82, v62, v63
    v_max_f32 v82, v82, v83
    v_mov_b32 v83, v82
    v_max3_f32 v84, v64, v65, v66
    v_max3_f32 v85, v67, v68, v69
    v_max3_f32 v84, v84, v70, v71
    v_max_f32 v84, v84, v85
    v_mov_b32 v85, v84
    v_max3_f32 v86, v72, v73, v74
    v_max3_f32 v87, v75, v76, v77
    v_max3_f32 v86, v86, v78, v79
    v_max_f32 v86, v86, v87
    v_mov_b32 v87, v86
    v_max3_f32 v80, v48, v49, v50
    v_max3_f32 v81, v51, v52, v53
    v_max3_f32 v80, v80, v54, v55
    v_max_f32 v80, v80, v81
    v_mov_b32 v81, v80
    v_permlane16_swap_b32 v82, v83
    v_permlane16_swap_b32 v84, v85
    v_permlane16_swap_b32 v86, v87
    v_permlane16_swap_b32 v80, v81
    v_max_f32 v82, v82, v83
    v_mov_b32 v83, v82
    v_max_f32 v84, v84, v85
    v_mov_b32 v85, v84
    v_max_f32 v86, v86, v87
    v_mov_b32 v87, v86
    v_max_f32 v80, v80, v81
    v_mov_b32 v81, v80
    v_permlane32_swap_b32 v82, v83
    v_permlane32_swap_b32 v84, v85
    v_permlane32_swap_b32 v86, v87
    v_permlane32_swap_b32 v80, v81
    v_max_f32 v82, v82, v83
    v_max_f32 v84, v84, v85
    v_max_f32 v86, v86, v87
    v_max_f32 v80, v80, v81
    s_lshl_b32 s20, s7, 1
    s_add_u32 s20, s20, s9
    s_lshl_b32 s20, s20, 17
    s_lshl_b32 s21, s6, 13
    s_add_u32 s20, s20, s21
    s_add_u32 s20, s20, 4096
    v_lshlrev_b32 v6, 4, v1
    v_pk_add_f32 v[56:57], v[56:57], v[82:83] op_sel_hi:[1,0] neg_lo:[0,1] neg_hi:[0,1]
    v_pk_add_f32 v[58:59], v[58:59], v[82:83] op_sel_hi:[1,0] neg_lo:[0,1] neg_hi:[0,1]
    v_pk_add_f32 v[60:61], v[60:61], v[82:83] op_sel_hi:[1,0] neg_lo:[0,1] neg_hi:[0,1]
    v_pk_add_f32 v[62:63], v[62:63], v[82:83] op_sel_hi:[1,0] neg_lo:[0,1] neg_hi:[0,1]
    v_exp_f32 v56, v56
    v_exp_f32 v57, v57
    v_exp_f32 v58, v58
    v_exp_f32 v59, v59
    v_exp_f32 v60, v60
    v_exp_f32 v61, v61
    v_exp_f32 v62, v62
    v_exp_f32 v63, v63
    v_cvt_pk_bf16_f32 v92, v56, v57
    v_cvt_pk_bf16_f32 v93, v58, v59
    v_cvt_pk_bf16_f32 v94, v60, v61
    v_cvt_pk_bf16_f32 v95, v62, v63
    s_nop 1
    v_mfma_f32_16x16x32_bf16 v[124:127], v[244:247], v[92:95], 0
    v_mfma_f32_16x16x32_bf16 v[116:119], v[198:201], v[92:95], 0
    v_mfma_f32_16x16x32_bf16 v[120:123], v[208:211], v[92:95], 0
    v_pk_add_f32 v[64:65], v[64:65], v[84:85] op_sel_hi:[1,0] neg_lo:[0,1] neg_hi:[0,1]
    v_pk_add_f32 v[66:67], v[66:67], v[84:85] op_sel_hi:[1,0] neg_lo:[0,1] neg_hi:[0,1]
    v_pk_add_f32 v[68:69], v[68:69], v[84:85] op_sel_hi:[1,0] neg_lo:[0,1] neg_hi:[0,1]
    v_pk_add_f32 v[70:71], v[70:71], v[84:85] op_sel_hi:[1,0] neg_lo:[0,1] neg_hi:[0,1]
    v_exp_f32 v64, v64
    v_exp_f32 v65, v65
    v_exp_f32 v66, v66
    v_exp_f32 v67, v67
    v_exp_f32 v68, v68
    v_exp_f32 v69, v69
    v_exp_f32 v70, v70
    v_exp_f32 v71, v71
    v_cvt_pk_bf16_f32 v96, v64, v65
    v_cvt_pk_bf16_f32 v97, v66, v67
    v_cvt_pk_bf16_f32 v98, v68, v69
    v_cvt_pk_bf16_f32 v99, v70, v71
    s_nop 1
    v_mfma_f32_16x16x32_bf16 v[136:139], v[244:247], v[96:99], 0
    v_mfma_f32_16x16x32_bf16 v[128:131], v[200:203], v[96:99], 0
    v_mfma_f32_16x16x32_bf16 v[132:135], v[210:213], v[96:99], 0
    v_pk_add_f32 v[72:73], v[72:73], v[86:87] op_sel_hi:[1,0] neg_lo:[0,1] neg_hi:[0,1]
    v_pk_add_f32 v[74:75], v[74:75], v[86:87] op_sel_hi:[1,0] neg_lo:[0,1] neg_hi:[0,1]
    v_pk_add_f32 v[76:77], v[76:77], v[86:87] op_sel_hi:[1,0] neg_lo:[0,1] neg_hi:[0,1]
    v_pk_add_f32 v[78:79], v[78:79], v[86:87] op_sel_hi:[1,0] neg_lo:[0,1] neg_hi:[0,1]
    v_exp_f32 v72, v72
    v_exp_f32 v73, v73
    v_exp_f32 v74, v74
    v_exp_f32 v75, v75
    v_exp_f32 v76, v76
    v_exp_f32 v77, v77
    v_exp_f32 v78, v78
    v_exp_f32 v79, v79
    v_cvt_pk_bf16_f32 v100, v72, v73
    v_cvt_pk_bf16_f32 v101, v74, v75
    v_cvt_pk_bf16_f32 v102, v76, v77
    v_cvt_pk_bf16_f32 v103, v78, v79
    s_nop 1
    v_mfma_f32_16x16x32_bf16 v[148:151], v[244:247], v[100:103], 0
    v_mfma_f32_16x16x32_bf16 v[140:143], v[202:205], v[100:103], 0
    v_mfma_f32_16x16x32_bf16 v[144:147], v[212:215], v[100:103], 0
    v_pk_add_f32 v[48:49], v[48:49], v[80:81] op_sel_hi:[1,0] neg_lo:[0,1] neg_hi:[0,1]
    v_pk_add_f32 v[50:51], v[50:51], v[80:81] op_sel_hi:[1,0] neg_lo:[0,1] neg_hi:[0,1]
    v_pk_add_f32 v[52:53], v[52:53], v[80:81] op_sel_hi:[1,0] neg_lo:[0,1] neg_hi:[0,1]
    v_pk_add_f32 v[54:55], v[54:55], v[80:81] op_sel_hi:[1,0] neg_lo:[0,1] neg_hi:[0,1]
    v_exp_f32 v48, v48
    v_exp_f32 v49, v49
    v_exp_f32 v50, v50
    v_exp_f32 v51, v51
    v_exp_f32 v52, v52
    v_exp_f32 v53, v53
    v_exp_f32 v54, v54
    v_exp_f32 v55, v55
    v_cvt_pk_bf16_f32 v88, v48, v49
    v_cvt_pk_bf16_f32 v89, v50, v51
    v_cvt_pk_bf16_f32 v90, v52, v53
    v_cvt_pk_bf16_f32 v91, v54, v55
    s_nop 1
    v_mfma_f32_16x16x32_bf16 v[112:115], v[244:247], v[88:91], 0
    s_waitcnt lgkmcnt(1)
    v_mfma_f32_16x16x32_bf16 v[104:107], v[196:199], v[88:91], 0
    s_waitcnt lgkmcnt(0)
    v_mfma_f32_16x16x32_bf16 v[108:111], v[206:209], v[88:91], 0
    v_rcp_f32 v124, v124
    s_nop 0
    v_pk_mul_f32 v[116:117], v[116:117], v[124:125] op_sel_hi:[1,0]
    v_pk_mul_f32 v[118:119], v[118:119], v[124:125] op_sel_hi:[1,0]
    v_pk_mul_f32 v[120:121], v[120:121], v[124:125] op_sel_hi:[1,0]
    v_pk_mul_f32 v[122:123], v[122:123], v[124:125] op_sel_hi:[1,0]
    v_cvt_pk_bf16_f32 v164, v116, v117
    v_cvt_pk_bf16_f32 v165, v118, v119
    v_cvt_pk_bf16_f32 v166, v120, v121
    v_cvt_pk_bf16_f32 v167, v122, v123
    buffer_store_dwordx4 v[164:167], v6, s[40:43], s20 offen offset:1024
    v_rcp_f32 v136, v136
    s_nop 0
    v_pk_mul_f32 v[128:129], v[128:129], v[136:137] op_sel_hi:[1,0]
    v_pk_mul_f32 v[130:131], v[130:131], v[136:137] op_sel_hi:[1,0]
    v_pk_mul_f32 v[132:133], v[132:133], v[136:137] op_sel_hi:[1,0]
    v_pk_mul_f32 v[134:135], v[134:135], v[136:137] op_sel_hi:[1,0]
    v_cvt_pk_bf16_f32 v168, v128, v129
    v_cvt_pk_bf16_f32 v169, v130, v131
    v_cvt_pk_bf16_f32 v170, v132, v133
    v_cvt_pk_bf16_f32 v171, v134, v135
    buffer_store_dwordx4 v[168:171], v6, s[40:43], s20 offen offset:2048
    v_rcp_f32 v148, v148
    s_nop 0
    v_pk_mul_f32 v[140:141], v[140:141], v[148:149] op_sel_hi:[1,0]
    v_pk_mul_f32 v[142:143], v[142:143], v[148:149] op_sel_hi:[1,0]
    v_pk_mul_f32 v[144:145], v[144:145], v[148:149] op_sel_hi:[1,0]
    v_pk_mul_f32 v[146:147], v[146:147], v[148:149] op_sel_hi:[1,0]
    v_cvt_pk_bf16_f32 v172, v140, v141
    v_cvt_pk_bf16_f32 v173, v142, v143
    v_cvt_pk_bf16_f32 v174, v144, v145
    v_cvt_pk_bf16_f32 v175, v146, v147
    buffer_store_dwordx4 v[172:175], v6, s[40:43], s20 offen offset:3072
    v_rcp_f32 v112, v112
    s_nop 0
    v_pk_mul_f32 v[104:105], v[104:105], v[112:113] op_sel_hi:[1,0]
    v_pk_mul_f32 v[106:107], v[106:107], v[112:113] op_sel_hi:[1,0]
    v_pk_mul_f32 v[108:109], v[108:109], v[112:113] op_sel_hi:[1,0]
    v_pk_mul_f32 v[110:111], v[110:111], v[112:113] op_sel_hi:[1,0]
    v_cvt_pk_bf16_f32 v160, v104, v105
    v_cvt_pk_bf16_f32 v161, v106, v107
    v_cvt_pk_bf16_f32 v162, v108, v109
    v_cvt_pk_bf16_f32 v163, v110, v111
    buffer_store_dwordx4 v[160:163], v6, s[40:43], s20 offen offset:0
    s_endpgm
qkv2_kernel_end:
    s_endpgm
.text
.globl wo2_kernel
.p2align 8
.type wo2_kernel,@function
wo2_kernel:
    s_cmp_ge_u32 s2, 256
    s_cbranch_scc1 wo2_kernel_end
    s_load_dwordx2 s[10:11], s[0:1], 72
    s_load_dwordx2 s[12:13], s[0:1], 16
    v_lshrrev_b32 v2, 6, v0
    v_and_b32 v1, 63, v0
    v_readfirstlane_b32 s3, v2
    s_and_b32 s4, s2, 7
    s_lshr_b32 s5, s2, 3
    s_lshr_b32 s6, s4, 1
    s_lshl_b32 s6, s6, 2
    s_and_b32 s7, s5, 3
    s_add_u32 s6, s6, s7
    s_and_b32 s7, s4, 1
    s_lshl_b32 s7, s7, 3
    s_lshr_b32 s8, s5, 2
    s_add_u32 s7, s7, s8
    s_lshl_b32 s20, s6, 13
    s_lshl_b32 s21, s3, 11
    s_add_u32 s20, s20, s21
    v_lshl_add_u32 v4, v1, 4, s20
    v_bfe_u32 v8, v1, 3, 1
    v_lshrrev_b32 v9, 4, v1
    v_lshl_add_u32 v8, v9, 3, v8
    s_lshl_b32 s21, s3, 1
    v_add_u32 v8, s21, v8
    v_lshlrev_b32 v8, 11, v8
    v_and_b32 v9, 7, v1
    v_lshl_add_u32 v8, v9, 4, v8
    s_lshl_b32 s21, s7, 7
    v_add_u32 v5, s21, v8
    v_add_u32 v6, 64512, v5
    v_bfe_u32 v8, v1, 3, 2
    v_mul_u32_u24 v8, 2080, v8
    v_bfe_u32 v9, v1, 2, 1
    v_lshl_add_u32 v8, v9, 7, v8
    v_bfe_u32 v9, v1, 5, 1
    v_lshl_add_u32 v8, v9, 8, v8
    v_and_b32 v9, 3, v1
    v_lshl_add_u32 v7, v9, 3, v8
    s_mul_i32 s22, s3, 2080
    s_mov_b32 s23, 0
    s_mov_b32 s24, 0x20000
    s_mov_b32 s25, 0
    s_waitcnt lgkmcnt(0)
    s_add_u32 s28, s10, 16777216
    s_addc_u32 s29, s11, 0
    s_mov_b32 s30, 4194304
    s_mov_b32 s31, 0x20000
    s_mov_b32 s32, s12
    s_mov_b32 s33, s13
    s_mov_b32 s34, 2097152
    s_mov_b32 s35, 0x20000
    s_add_u32 m0, s22, 0
    s_nop 0
    buffer_load_dwordx4 v5, s[32:35], s25 offen lds
    buffer_load_dwordx4 v6, s[32:35], s25 offen offset:1024 lds
    s_add_u32 s25, s25, 0x20000
    buffer_load_dwordx4 v[48:51], v4, s[28:31], s23 offen offset:0
    buffer_load_dwordx4 v[52:55], v4, s[28:31], s23 offen offset:1024
    s_add_u32 s23, s23, 0x40000
    buffer_load_dwordx4 v[56:59], v4, s[28:31], s24 offen offset:0
    buffer_load_dwordx4 v[60:63], v4, s[28:31], s24 offen offset:1024
    s_add_u32 s24, s24, 0x40000
    s_add_u32 m0, s22, 8320
    s_nop 0
    buffer_load_dwordx4 v5, s[32:35], s25 offen lds
    buffer_load_dwordx4 v6, s[32:35], s25 offen offset:1024 lds
    s_add_u32 s25, s25, 0x20000
    buffer_load_dwordx4 v[64:67], v4, s[28:31], s23 offen offset:0
    buffer_load_dwordx4 v[68:71], v4, s[28:31], s23 offen offset:1024
    s_add_u32 s23, s23, 0x40000
    buffer_load_dwordx4 v[72:75], v4, s[28:31], s24 offen offset:0
    buffer_load_dwordx4 v[76:79], v4, s[28:31], s24 offen offset:1024
    s_add_u32 s24, s24, 0x40000
    s_add_u32 m0, s22, 16640
    s_nop 0
    buffer_load_dwordx4 v5, s[32:35], s25 offen lds
    buffer_load_dwordx4 v6, s[32:35], s25 offen offset:1024 lds
    s_add_u32 s25, s25, 0x20000
    buffer_load_dwordx4 v[80:83], v4, s[28:31], s23 offen offset:0
    buffer_load_dwordx4 v[84:87], v4, s[28:31], s23 offen offset:1024
    s_add_u32 s23, s23, 0x40000
    buffer_load_dwordx4 v[88:91], v4, s[28:31], s24 offen offset:0
    buffer_load_dwordx4 v[92:95], v4, s[28:31], s24 offen offset:1024
    s_add_u32 s24, s24, 0x40000
    s_add_u32 m0, s22, 24960
    s_nop 0
    buffer_load_dwordx4 v5, s[32:35], s25 offen lds
    buffer_load_dwordx4 v6, s[32:35], s25 offen offset:1024 lds
    s_add_u32 s25, s25, 0x20000
    buffer_load_dwordx4 v[96:99], v4, s[28:31], s23 offen offset:0
    buffer_load_dwordx4 v[100:103], v4, s[28:31], s23 offen offset:1024
    s_add_u32 s23, s23, 0x40000
    buffer_load_dwordx4 v[104:107], v4, s[28:31], s24 offen offset:0
    buffer_load_dwordx4 v[108:111], v4, s[28:31], s24 offen offset:1024
    s_add_u32 s24, s24, 0x40000
    s_add_u32 m0, s22, 33280
    s_nop 0
    buffer_load_dwordx4 v5, s[32:35], s25 offen lds
    buffer_load_dwordx4 v6, s[32:35], s25 offen offset:1024 lds
    s_add_u32 s25, s25, 0x20000
    buffer_load_dwordx4 v[112:115], v4, s[28:31], s23 offen offset:0
    buffer_load_dwordx4 v[116:119], v4, s[28:31], s23 offen offset:1024
    s_add_u32 s23, s23, 0x40000
    buffer_load_dwordx4 v[120:123], v4, s[28:31], s24 offen offset:0
    buffer_load_dwordx4 v[124:127], v4, s[28:31], s24 offen offset:1024
    s_add_u32 s24, s24, 0x40000
    s_add_u32 m0, s22, 41600
    s_nop 0
    buffer_load_dwordx4 v5, s[32:35], s25 offen lds
    buffer_load_dwordx4 v6, s[32:35], s25 offen offset:1024 lds
    s_add_u32 s25, s25, 0x20000
    buffer_load_dwordx4 v[128:131], v4, s[28:31], s23 offen offset:0
    buffer_load_dwordx4 v[132:135], v4, s[28:31], s23 offen offset:1024
    s_add_u32 s23, s23, 0x40000
    buffer_load_dwordx4 v[136:139], v4, s[28:31], s24 offen offset:0
    buffer_load_dwordx4 v[140:143], v4, s[28:31], s24 offen offset:1024
    s_add_u32 s24, s24, 0x40000
    s_add_u32 m0, s22, 49920
    s_nop 0
    buffer_load_dwordx4 v5, s[32:35], s25 offen lds
    buffer_load_dwordx4 v6, s[32:35], s25 offen offset:1024 lds
    s_add_u32 s25, s25, 0x20000
    buffer_load_dwordx4 v[144:147], v4, s[28:31], s23 offen offset:0
    buffer_load_dwordx4 v[148:151], v4, s[28:31], s23 offen offset:1024
    s_add_u32 s23, s23, 0x40000
    buffer_load_dwordx4 v[152:155], v4, s[28:31], s24 offen offset:0
    buffer_load_dwordx4 v[156:159], v4, s[28:31], s24 offen offset:1024
    s_add_u32 s24, s24, 0x40000
    s_add_u32 m0, s22, 58240
    s_nop 0
    buffer_load_dwordx4 v5, s[32:35], s25 offen lds
    buffer_load_dwordx4 v6, s[32:35], s25 offen offset:1024 lds
    s_add_u32 s25, s25, 0x20000
    v_mov_b32 v16, 0
    v_mov_b32 v17, 0
    v_mov_b32 v18, 0
    v_mov_b32 v19, 0
    v_mov_b32 v20, 0
    v_mov_b32 v21, 0
    v_mov_b32 v22, 0
    v_mov_b32 v23, 0
    v_mov_b32 v24, 0
    v_mov_b32 v25, 0
    v_mov_b32 v26, 0
    v_mov_b32 v27, 0
    v_mov_b32 v28, 0
    v_mov_b32 v29, 0
    v_mov_b32 v30, 0
    v_mov_b32 v31, 0
    v_mov_b32 v32, 0
    v_mov_b32 v33, 0
    v_mov_b32 v34, 0
    v_mov_b32 v35, 0
    v_mov_b32 v36, 0
    v_mov_b32 v37, 0
    v_mov_b32 v38, 0
    v_mov_b32 v39, 0
    v_mov_b32 v40, 0
    v_mov_b32 v41, 0
    v_mov_b32 v42, 0
    v_mov_b32 v43, 0
    v_mov_b32 v44, 0
    v_mov_b32 v45, 0
    v_mov_b32 v46, 0
    v_mov_b32 v47, 0
    s_add_u32 s36, s10, 12582912
    s_addc_u32 s37, s11, 0
    s_mov_b32 s38, 4194304
    s_mov_b32 s39, 0x20000
    s_lshl_b32 s26, s7, 18
    s_add_u32 s27, s26, 0x20000
    s_add_u32 s40, s10, 20971520
    s_addc_u32 s41, s11, 0
    s_mov_b32 s42, 4194304
    s_mov_b32 s43, 0x20000
    s_add_u32 s44, s10, 59506688
    s_addc_u32 s45, s11, 0
    s_mov_b32 s46, 262144
    s_mov_b32 s47, 0x20000
    s_waitcnt vmcnt(42)
    s_barrier
    ds_read_b64_tr_b16 a[0:1], v7 offset:0
    ds_read_b64_tr_b16 a[2:3], v7 offset:512
    ds_read_b64_tr_b16 a[4:5], v7 offset:32
    ds_read_b64_tr_b16 a[6:7], v7 offset:544
    ds_read_b64_tr_b16 a[8:9], v7 offset:64
    ds_read_b64_tr_b16 a[10:11], v7 offset:576
    ds_read_b64_tr_b16 a[12:13], v7 offset:96
    ds_read_b64_tr_b16 a[14:15], v7 offset:608
    ds_read_b64_tr_b16 a[16:17], v7 offset:1024
    ds_read_b64_tr_b16 a[18:19], v7 offset:1536
    ds_read_b64_tr_b16 a[20:21], v7 offset:1056
    ds_read_b64_tr_b16 a[22:23], v7 offset:1568
    ds_read_b64_tr_b16 a[24:25], v7 offset:1088
    ds_read_b64_tr_b16 a[26:27], v7 offset:1600
    ds_read_b64_tr_b16 a[28:29], v7 offset:1120
    ds_read_b64_tr_b16 a[30:31], v7 offset:1632
    s_mov_b32 s48, 1
.p2align 6
wo2_kernel_loop:
    s_waitcnt lgkmcnt(0)
    s_waitcnt vmcnt(36)
    s_barrier
    v_mfma_f32_16x16x32_bf16 v[16:19], a[0:3], v[48:51], v[16:19]
    ds_read_b64_tr_b16 a[32:33], v7 offset:8320
    ds_read_b64_tr_b16 a[34:35], v7 offset:8832
    s_add_u32 m0, s22, 0
    s_nop 0
    buffer_load_dwordx4 v5, s[32:35], s25 offen lds
    v_mfma_f32_16x16x32_bf16 v[32:35], a[0:3], v[52:55], v[32:35]
    ds_read_b64_tr_b16 a[36:37], v7 offset:8352
    v_mfma_f32_16x16x32_bf16 v[20:23], a[4:7], v[48:51], v[20:23]
    ds_read_b64_tr_b16 a[38:39], v7 offset:8864
    buffer_load_dwordx4 v[160:163], v4, s[28:31], s23 offen offset:0
    v_mfma_f32_16x16x32_bf16 v[36:39], a[4:7], v[52:55], v[36:39]
    ds_read_b64_tr_b16 a[40:41], v7 offset:8384
    v_mfma_f32_16x16x32_bf16 v[24:27], a[8:11], v[48:51], v[24:27]
    ds_read_b64_tr_b16 a[42:43], v7 offset:8896
    ds_read_b64_tr_b16 a[44:45], v7 offset:8416
    v_mfma_f32_16x16x32_bf16 v[40:43], a[8:11], v[52:55], v[40:43]
    ds_read_b64_tr_b16 a[46:47], v7 offset:8928
    buffer_load_dwordx4 v[164:167], v4, s[28:31], s23 offen offset:1024
    s_add_u32 s23, s23, 0x40000
    v_mfma_f32_16x16x32_bf16 v[28:31], a[12:15], v[48:51], v[28:31]
    ds_read_b64_tr_b16 a[48:49], v7 offset:9344
    v_mfma_f32_16x16x32_bf16 v[44:47], a[12:15], v[52:55], v[44:47]
    ds_read_b64_tr_b16 a[50:51], v7 offset:9856
    v_mfma_f32_16x16x32_bf16 v[16:19], a[16:19], v[56:59], v[16:19]
    ds_read_b64_tr_b16 a[52:53], v7 offset:9376
    ds_read_b64_tr_b16 a[54:55], v7 offset:9888
    buffer_load_dwordx4 v6, s[32:35], s25 offen offset:1024 lds
    s_add_u32 s25, s25, 0x20000
    v_mfma_f32_16x16x32_bf16 v[32:35], a[16:19], v[60:63], v[32:35]
    ds_read_b64_tr_b16 a[56:57], v7 offset:9408
    v_mfma_f32_16x16x32_bf16 v[20:23], a[20:23], v[56:59], v[20:23]
    ds_read_b64_tr_b16 a[58:59], v7 offset:9920
    buffer_load_dwordx4 v[168:171], v4, s[28:31], s24 offen offset:0
    v_mfma_f32_16x16x32_bf16 v[36:39], a[20:23], v[60:63], v[36:39]
    ds_read_b64_tr_b16 a[60:61], v7 offset:9440
    v_mfma_f32_16x16x32_bf16 v[24:27], a[24:27], v[56:59], v[24:27]
    ds_read_b64_tr_b16 a[62:63], v7 offset:9952
    v_mfma_f32_16x16x32_bf16 v[40:43], a[24:27], v[60:63], v[40:43]
    buffer_load_dwordx4 v[172:175], v4, s[28:31], s24 offen offset:1024
    s_add_u32 s24, s24, 0x40000
    v_mfma_f32_16x16x32_bf16 v[28:31], a[28:31], v[56:59], v[28:31]
    v_mfma_f32_16x16x32_bf16 v[44:47], a[28:31], v[60:63], v[44:47]
    s_waitcnt lgkmcnt(0)
    s_waitcnt vmcnt(36)
    s_barrier
    v_mfma_f32_16x16x32_bf16 v[16:19], a[32:35], v[64:67], v[16:19]
    ds_read_b64_tr_b16 a[0:1], v7 offset:16640
    ds_read_b64_tr_b16 a[2:3], v7 offset:17152
    s_add_u32 m0, s22, 8320
    s_nop 0
    buffer_load_dwordx4 v5, s[32:35], s25 offen lds
    v_mfma_f32_16x16x32_bf16 v[32:35], a[32:35], v[68:71], v[32:35]
    ds_read_b64_tr_b16 a[4:5], v7 offset:16672
    v_mfma_f32_16x16x32_bf16 v[20:23], a[36:39], v[64:67], v[20:23]
    ds_read_b64_tr_b16 a[6:7], v7 offset:17184
    buffer_load_dwordx4 v[48:51], v4, s[28:31], s23 offen offset:0
    v_mfma_f32_16x16x32_bf16 v[36:39], a[36:39], v[68:71], v[36:39]
    ds_read_b64_tr_b16 a[8:9], v7 offset:16704
    v_mfma_f32_16x16x32_bf16 v[24:27], a[40:43], v[64:67], v[24:27]
    ds_read_b64_tr_b16 a[10:11], v7 offset:17216
    ds_read_b64_tr_b16 a[12:13], v7 offset:16736
    v_mfma_f32_16x16x32_bf16 v[40:43], a[40:43], v[68:71], v[40:43]
    ds_read_b64_tr_b16 a[14:15], v7 offset:17248
    buffer_load_dwordx4 v[52:55], v4, s[28:31], s23 offen offset:1024
    s_add_u32 s23, s23, 0x40000
    v_mfma_f32_16x16x32_bf16 v[28:31], a[44:47], v[64:67], v[28:31]
    ds_read_b64_tr_b16 a[16:17], v7 offset:17664
    v_mfma_f32_16x16x32_bf16 v[44:47], a[44:47], v[68:71], v[44:47]
    ds_read_b64_tr_b16 a[18:19], v7 offset:18176
    v_mfma_f32_16x16x32_bf16 v[16:19], a[48:51], v[72:75], v[16:19]
    ds_read_b64_tr_b16 a[20:21], v7 offset:17696
    ds_read_b64_tr_b16 a[22:23], v7 offset:18208
    buffer_load_dwordx4 v6, s[32:35], s25 offen offset:1024 lds
    s_add_u32 s25, s25, 0x20000
    v_mfma_f32_16x16x32_bf16 v[32:35], a[48:51], v[76:79], v[32:35]
    ds_read_b64_tr_b16 a[24:25], v7 offset:17728
    v_mfma_f32_16x16x32_bf16 v[20:23], a[52:55], v[72:75], v[20:23]
    ds_read_b64_tr_b16 a[26:27], v7 offset:18240
    buffer_load_dwordx4 v[56:59], v4, s[28:31], s24 offen offset:0
    v_mfma_f32_16x16x32_bf16 v[36:39], a[52:55], v[76:79], v[36:39]
    ds_read_b64_tr_b16 a[28:29], v7 offset:17760
    v_mfma_f32_16x16x32_bf16 v[24:27], a[56:59], v[72:75], v[24:27]
    ds_read_b64_tr_b16 a[30:31], v7 offset:18272
    v_mfma_f32_16x16x32_bf16 v[40:43], a[56:59], v[76:79], v[40:43]
    buffer_load_dwordx4 v[60:63], v4, s[28:31], s24 offen offset:1024
    s_add_u32 s24, s24, 0x40000
    v_mfma_f32_16x16x32_bf16 v[28:31], a[60:63], v[72:75], v[28:31]
    v_mfma_f32_16x16x32_bf16 v[44:47], a[60:63], v[76:79], v[44:47]
    s_waitcnt lgkmcnt(0)
    s_waitcnt vmcnt(36)
    s_barrier
    v_mfma_f32_16x16x32_bf16 v[16:19], a[0:3], v[80:83], v[16:19]
    ds_read_b64_tr_b16 a[32:33], v7 offset:24960
    ds_read_b64_tr_b16 a[34:35], v7 offset:25472
    s_add_u32 m0, s22, 16640
    s_nop 0
    buffer_load_dwordx4 v5, s[32:35], s25 offen lds
    v_mfma_f32_16x16x32_bf16 v[32:35], a[0:3], v[84:87], v[32:35]
    ds_read_b64_tr_b16 a[36:37], v7 offset:24992
    v_mfma_f32_16x16x32_bf16 v[20:23], a[4:7], v[80:83], v[20:23]
    ds_read_b64_tr_b16 a[38:39], v7 offset:25504
    buffer_load_dwordx4 v[64:67], v4, s[28:31], s23 offen offset:0
    v_mfma_f32_16x16x32_bf16 v[36:39], a[4:7], v[84:87], v[36:39]
    ds_read_b64_tr_b16 a[40:41], v7 offset:25024
    v_mfma_f32_16x16x32_bf16 v[24:27], a[8:11], v[80:83], v[24:27]
    ds_read_b64_tr_b16 a[42:43], v7 offset:25536
    ds_read_b64_tr_b16 a[44:45], v7 offset:25056
    v_mfma_f32_16x16x32_bf16 v[40:43], a[8:11], v[84:87], v[40:43]
    ds_read_b64_tr_b16 a[46:47], v7 offset:25568
    buffer_load_dwordx4 v[68:71], v4, s[28:31], s23 offen offset:1024
    s_add_u32 s23, s23, 0x40000
    v_mfma_f32_16x16x32_bf16 v[28:31], a[12:15], v[80:83], v[28:31]
    ds_read_b64_tr_b16 a[48:49], v7 offset:25984
    v_mfma_f32_16x16x32_bf16 v[44:47], a[12:15], v[84:87], v[44:47]
    ds_read_b64_tr_b16 a[50:51], v7 offset:26496
    v_mfma_f32_16x16x32_bf16 v[16:19], a[16:19], v[88:91], v[16:19]
    ds_read_b64_tr_b16 a[52:53], v7 offset:26016
    ds_read_b64_tr_b16 a[54:55], v7 offset:26528
    buffer_load_dwordx4 v6, s[32:35], s25 offen offset:1024 lds
    s_add_u32 s25, s25, 0x20000
    v_mfma_f32_16x16x32_bf16 v[32:35], a[16:19], v[92:95], v[32:35]
    ds_read_b64_tr_b16 a[56:57], v7 offset:26048
    v_mfma_f32_16x16x32_bf16 v[20:23], a[20:23], v[88:91], v[20:23]
    ds_read_b64_tr_b16 a[58:59], v7 offset:26560
    buffer_load_dwordx4 v[72:75], v4, s[28:31], s24 offen offset:0
    v_mfma_f32_16x16x32_bf16 v[36:39], a[20:23], v[92:95], v[36:39]
    ds_read_b64_tr_b16 a[60:61], v7 offset:26080
    v_mfma_f32_16x16x32_bf16 v[24:27], a[24:27], v[88:91], v[24:27]
    ds_read_b64_tr_b16 a[62:63], v7 offset:26592
    v_mfma_f32_16x16x32_bf16 v[40:43], a[24:27], v[92:95], v[40:43]
    buffer_load_dwordx4 v[76:79], v4, s[28:31], s24 offen offset:1024
    s_add_u32 s24, s24, 0x40000
    v_mfma_f32_16x16x32_bf16 v[28:31], a[28:31], v[88:91], v[28:31]
    v_mfma_f32_16x16x32_bf16 v[44:47], a[28:31], v[92:95], v[44:47]
    s_waitcnt lgkmcnt(0)
    s_waitcnt vmcnt(36)
    s_barrier
    v_mfma_f32_16x16x32_bf16 v[16:19], a[32:35], v[96:99], v[16:19]
    ds_read_b64_tr_b16 a[0:1], v7 offset:33280
    ds_read_b64_tr_b16 a[2:3], v7 offset:33792
    s_add_u32 m0, s22, 24960
    s_nop 0
    buffer_load_dwordx4 v5, s[32:35], s25 offen lds
    v_mfma_f32_16x16x32_bf16 v[32:35], a[32:35], v[100:103], v[32:35]
    ds_read_b64_tr_b16 a[4:5], v7 offset:33312
    v_mfma_f32_16x16x32_bf16 v[20:23], a[36:39], v[96:99], v[20:23]
    ds_read_b64_tr_b16 a[6:7], v7 offset:33824
    buffer_load_dwordx4 v[80:83], v4, s[28:31], s23 offen offset:0
    v_mfma_f32_16x16x32_bf16 v[36:39], a[36:39], v[100:103], v[36:39]
    ds_read_b64_tr_b16 a[8:9], v7 offset:33344
    v_mfma_f32_16x16x32_bf16 v[24:27], a[40:43], v[96:99], v[24:27]
    ds_read_b64_tr_b16 a[10:11], v7 offset:33856
    ds_read_b64_tr_b16 a[12:13], v7 offset:33376
    v_mfma_f32_16x16x32_bf16 v[40:43], a[40:43], v[100:103], v[40:43]
    ds_read_b64_tr_b16 a[14:15], v7 offset:33888
    buffer_load_dwordx4 v[84:87], v4, s[28:31], s23 offen offset:1024
    s_add_u32 s23, s23, 0x40000
    v_mfma_f32_16x16x32_bf16 v[28:31], a[44:47], v[96:99], v[28:31]
    ds_read_b64_tr_b16 a[16:17], v7 offset:34304
    v_mfma_f32_16x16x32_bf16 v[44:47], a[44:47], v[100:103], v[44:47]
    ds_read_b64_tr_b16 a[18:19], v7 offset:34816
    v_mfma_f32_16x16x32_bf16 v[16:19], a[48:51], v[104:107], v[16:19]
    ds_read_b64_tr_b16 a[20:21], v7 offset:34336
    ds_read_b64_tr_b16 a[22:23], v7 offset:34848
    buffer_load_dwordx4 v6, s[32:35], s25 offen offset:1024 lds
    s_add_u32 s25, s25, 0x20000
    v_mfma_f32_16x16x32_bf16 v[32:35], a[48:51], v[108:111], v[32:35]
    ds_read_b64_tr_b16 a[24:25], v7 offset:34368
    v_mfma_f32_16x16x32_bf16 v[20:23], a[52:55], v[104:107], v[20:23]
    ds_read_b64_tr_b16 a[26:27], v7 offset:34880
    buffer_load_dwordx4 v[88:91], v4, s[28:31], s24 offen offset:0
    v_mfma_f32_16x16x32_bf16 v[36:39], a[52:55], v[108:111], v[36:39]
    ds_read_b64_tr_b16 a[28:29], v7 offset:34400
    v_mfma_f32_16x16x32_bf16 v[24:27], a[56:59], v[104:107], v[24:27]
    ds_read_b64_tr_b16 a[30:31], v7 offset:34912
    v_mfma_f32_16x16x32_bf16 v[40:43], a[56:59], v[108:111], v[40:43]
    buffer_load_dwordx4 v[92:95], v4, s[28:31], s24 offen offset:1024
    s_add_u32 s24, s24, 0x40000
    v_mfma_f32_16x16x32_bf16 v[28:31], a[60:63], v[104:107], v[28:31]
    v_mfma_f32_16x16x32_bf16 v[44:47], a[60:63], v[108:111], v[44:47]
    s_waitcnt lgkmcnt(0)
    s_waitcnt vmcnt(36)
    s_barrier
    v_mfma_f32_16x16x32_bf16 v[16:19], a[0:3], v[112:115], v[16:19]
    ds_read_b64_tr_b16 a[32:33], v7 offset:41600
    ds_read_b64_tr_b16 a[34:35], v7 offset:42112
    s_add_u32 m0, s22, 33280
    s_nop 0
    buffer_load_dwordx4 v5, s[32:35], s25 offen lds
    v_mfma_f32_16x16x32_bf16 v[32:35], a[0:3], v[116:119], v[32:35]
    ds_read_b64_tr_b16 a[36:37], v7 offset:41632
    v_mfma_f32_16x16x32_bf16 v[20:23], a[4:7], v[112:115], v[20:23]
    ds_read_b64_tr_b16 a[38:39], v7 offset:42144
    buffer_load_dwordx4 v[96:99], v4, s[28:31], s23 offen offset:0
    v_mfma_f32_16x16x32_bf16 v[36:39], a[4:7], v[116:119], v[36:39]
    ds_read_b64_tr_b16 a[40:41], v7 offset:41664
    v_mfma_f32_16x16x32_bf16 v[24:27], a[8:11], v[112:115], v[24:27]
    ds_read_b64_tr_b16 a[42:43], v7 offset:42176
    ds_read_b64_tr_b16 a[44:45], v7 offset:41696
    v_mfma_f32_16x16x32_bf16 v[40:43], a[8:11], v[116:119], v[40:43]
    ds_read_b64_tr_b16 a[46:47], v7 offset:42208
    buffer_load_dwordx4 v[100:103], v4, s[28:31], s23 offen offset:1024
    s_add_u32 s23, s23, 0x40000
    v_mfma_f32_16x16x32_bf16 v[28:31], a[12:15], v[112:115], v[28:31]
    ds_read_b64_tr_b16 a[48:49], v7 offset:42624
    v_mfma_f32_16x16x32_bf16 v[44:47], a[12:15], v[116:119], v[44:47]
    ds_read_b64_tr_b16 a[50:51], v7 offset:43136
    v_mfma_f32_16x16x32_bf16 v[16:19], a[16:19], v[120:123], v[16:19]
    ds_read_b64_tr_b16 a[52:53], v7 offset:42656
    ds_read_b64_tr_b16 a[54:55], v7 offset:43168
    buffer_load_dwordx4 v6, s[32:35], s25 offen offset:1024 lds
    s_add_u32 s25, s25, 0x20000
    v_mfma_f32_16x16x32_bf16 v[32:35], a[16:19], v[124:127], v[32:35]
    ds_read_b64_tr_b16 a[56:57], v7 offset:42688
    v_mfma_f32_16x16x32_bf16 v[20:23], a[20:23], v[120:123], v[20:23]
    ds_read_b64_tr_b16 a[58:59], v7 offset:43200
    buffer_load_dwordx4 v[104:107], v4, s[28:31], s24 offen offset:0
    v_mfma_f32_16x16x32_bf16 v[36:39], a[20:23], v[124:127], v[36:39]
    ds_read_b64_tr_b16 a[60:61], v7 offset:42720
    v_mfma_f32_16x16x32_bf16 v[24:27], a[24:27], v[120:123], v[24:27]
    ds_read_b64_tr_b16 a[62:63], v7 offset:43232
    v_mfma_f32_16x16x32_bf16 v[40:43], a[24:27], v[124:127], v[40:43]
    buffer_load_dwordx4 v[108:111], v4, s[28:31], s24 offen offset:1024
    s_add_u32 s24, s24, 0x40000
    v_mfma_f32_16x16x32_bf16 v[28:31], a[28:31], v[120:123], v[28:31]
    v_mfma_f32_16x16x32_bf16 v[44:47], a[28:31], v[124:127], v[44:47]
    s_waitcnt lgkmcnt(0)
    s_waitcnt vmcnt(36)
    s_barrier
    v_mfma_f32_16x16x32_bf16 v[16:19], a[32:35], v[128:131], v[16:19]
    ds_read_b64_tr_b16 a[0:1], v7 offset:49920
    ds_read_b64_tr_b16 a[2:3], v7 offset:50432
    s_add_u32 m0, s22, 41600
    s_nop 0
    buffer_load_dwordx4 v5, s[32:35], s25 offen lds
    v_mfma_f32_16x16x32_bf16 v[32:35], a[32:35], v[132:135], v[32:35]
    ds_read_b64_tr_b16 a[4:5], v7 offset:49952
    v_mfma_f32_16x16x32_bf16 v[20:23], a[36:39], v[128:131], v[20:23]
    ds_read_b64_tr_b16 a[6:7], v7 offset:50464
    buffer_load_dwordx4 v[112:115], v4, s[28:31], s23 offen offset:0
    v_mfma_f32_16x16x32_bf16 v[36:39], a[36:39], v[132:135], v[36:39]
    ds_read_b64_tr_b16 a[8:9], v7 offset:49984
    v_mfma_f32_16x16x32_bf16 v[24:27], a[40:43], v[128:131], v[24:27]
    ds_read_b64_tr_b16 a[10:11], v7 offset:50496
    ds_read_b64_tr_b16 a[12:13], v7 offset:50016
    v_mfma_f32_16x16x32_bf16 v[40:43], a[40:43], v[132:135], v[40:43]
    ds_read_b64_tr_b16 a[14:15], v7 offset:50528
    buffer_load_dwordx4 v[116:119], v4, s[28:31], s23 offen offset:1024
    s_add_u32 s23, s23, 0x40000
    v_mfma_f32_16x16x32_bf16 v[28:31], a[44:47], v[128:131], v[28:31]
    ds_read_b64_tr_b16 a[16:17], v7 offset:50944
    v_mfma_f32_16x16x32_bf16 v[44:47], a[44:47], v[132:135], v[44:47]
    ds_read_b64_tr_b16 a[18:19], v7 offset:51456
    v_mfma_f32_16x16x32_bf16 v[16:19], a[48:51], v[136:139], v[16:19]
    ds_read_b64_tr_b16 a[20:21], v7 offset:50976
    ds_read_b64_tr_b16 a[22:23], v7 offset:51488
    buffer_load_dwordx4 v6, s[32:35], s25 offen offset:1024 lds
    s_add_u32 s25, s25, 0x20000
    v_mfma_f32_16x16x32_bf16 v[32:35], a[48:51], v[140:143], v[32:35]
    ds_read_b64_tr_b16 a[24:25], v7 offset:51008
    v_mfma_f32_16x16x32_bf16 v[20:23], a[52:55], v[136:139], v[20:23]
    ds_read_b64_tr_b16 a[26:27], v7 offset:51520
    buffer_load_dwordx4 v[120:123], v4, s[28:31], s24 offen offset:0
    v_mfma_f32_16x16x32_bf16 v[36:39], a[52:55], v[140:143], v[36:39]
    ds_read_b64_tr_b16 a[28:29], v7 offset:51040
    v_mfma_f32_16x16x32_bf16 v[24:27], a[56:59], v[136:139], v[24:27]
    ds_read_b64_tr_b16 a[30:31], v7 offset:51552
    v_mfma_f32_16x16x32_bf16 v[40:43], a[56:59], v[140:143], v[40:43]
    buffer_load_dwordx4 v[124:127], v4, s[28:31], s24 offen offset:1024
    s_add_u32 s24, s24, 0x40000
    v_mfma_f32_16x16x32_bf16 v[28:31], a[60:63], v[136:139], v[28:31]
    v_mfma_f32_16x16x32_bf16 v[44:47], a[60:63], v[140:143], v[44:47]
    s_waitcnt lgkmcnt(0)
    s_waitcnt vmcnt(36)
    s_barrier
    v_mfma_f32_16x16x32_bf16 v[16:19], a[0:3], v[144:147], v[16:19]
    ds_read_b64_tr_b16 a[32:33], v7 offset:58240
    ds_read_b64_tr_b16 a[34:35], v7 offset:58752
    s_add_u32 m0, s22, 49920
    s_nop 0
    buffer_load_dwordx4 v5, s[32:35], s25 offen lds
    v_mfma_f32_16x16x32_bf16 v[32:35], a[0:3], v[148:151], v[32:35]
    ds_read_b64_tr_b16 a[36:37], v7 offset:58272
    v_mfma_f32_16x16x32_bf16 v[20:23], a[4:7], v[144:147], v[20:23]
    ds_read_b64_tr_b16 a[38:39], v7 offset:58784
    buffer_load_dwordx4 v[128:131], v4, s[28:31], s23 offen offset:0
    v_mfma_f32_16x16x32_bf16 v[36:39], a[4:7], v[148:151], v[36:39]
    ds_read_b64_tr_b16 a[40:41], v7 offset:58304
    v_mfma_f32_16x16x32_bf16 v[24:27], a[8:11], v[144:147], v[24:27]
    ds_read_b64_tr_b16 a[42:43], v7 offset:58816
    ds_read_b64_tr_b16 a[44:45], v7 offset:58336
    v_mfma_f32_16x16x32_bf16 v[40:43], a[8:11], v[148:151], v[40:43]
    ds_read_b64_tr_b16 a[46:47], v7 offset:58848
    buffer_load_dwordx4 v[132:135], v4, s[28:31], s23 offen offset:1024
    s_add_u32 s23, s23, 0x40000
    v_mfma_f32_16x16x32_bf16 v[28:31], a[12:15], v[144:147], v[28:31]
    ds_read_b64_tr_b16 a[48:49], v7 offset:59264
    v_mfma_f32_16x16x32_bf16 v[44:47], a[12:15], v[148:151], v[44:47]
    ds_read_b64_tr_b16 a[50:51], v7 offset:59776
    v_mfma_f32_16x16x32_bf16 v[16:19], a[16:19], v[152:155], v[16:19]
    ds_read_b64_tr_b16 a[52:53], v7 offset:59296
    ds_read_b64_tr_b16 a[54:55], v7 offset:59808
    buffer_load_dwordx4 v6, s[32:35], s25 offen offset:1024 lds
    s_add_u32 s25, s25, 0x20000
    v_mfma_f32_16x16x32_bf16 v[32:35], a[16:19], v[156:159], v[32:35]
    ds_read_b64_tr_b16 a[56:57], v7 offset:59328
    v_mfma_f32_16x16x32_bf16 v[20:23], a[20:23], v[152:155], v[20:23]
    ds_read_b64_tr_b16 a[58:59], v7 offset:59840
    buffer_load_dwordx4 v[136:139], v4, s[28:31], s24 offen offset:0
    v_mfma_f32_16x16x32_bf16 v[36:39], a[20:23], v[156:159], v[36:39]
    ds_read_b64_tr_b16 a[60:61], v7 offset:59360
    v_mfma_f32_16x16x32_bf16 v[24:27], a[24:27], v[152:155], v[24:27]
    ds_read_b64_tr_b16 a[62:63], v7 offset:59872
    v_mfma_f32_16x16x32_bf16 v[40:43], a[24:27], v[156:159], v[40:43]
    buffer_load_dwordx4 v[140:143], v4, s[28:31], s24 offen offset:1024
    s_add_u32 s24, s24, 0x40000
    v_mfma_f32_16x16x32_bf16 v[28:31], a[28:31], v[152:155], v[28:31]
    v_mfma_f32_16x16x32_bf16 v[44:47], a[28:31], v[156:159], v[44:47]
    s_waitcnt lgkmcnt(0)
    s_waitcnt vmcnt(38)
    s_barrier
    v_mfma_f32_16x16x32_bf16 v[16:19], a[32:35], v[160:163], v[16:19]
    ds_read_b64_tr_b16 a[0:1], v7 offset:0
    ds_read_b64_tr_b16 a[2:3], v7 offset:512
    s_add_u32 m0, s22, 58240
    s_nop 0
    buffer_load_dwordx4 v5, s[32:35], s25 offen lds
    v_mfma_f32_16x16x32_bf16 v[32:35], a[32:35], v[164:167], v[32:35]
    ds_read_b64_tr_b16 a[4:5], v7 offset:32
    v_mfma_f32_16x16x32_bf16 v[20:23], a[36:39], v[160:163], v[20:23]
    ds_read_b64_tr_b16 a[6:7], v7 offset:544
    buffer_load_dwordx4 v[144:147], v4, s[28:31], s23 offen offset:0
    v_mfma_f32_16x16x32_bf16 v[36:39], a[36:39], v[164:167], v[36:39]
    ds_read_b64_tr_b16 a[8:9], v7 offset:64
    v_mfma_f32_16x16x32_bf16 v[24:27], a[40:43], v[160:163], v[24:27]
    ds_read_b64_tr_b16 a[10:11], v7 offset:576
    ds_read_b64_tr_b16 a[12:13], v7 offset:96
    v_mfma_f32_16x16x32_bf16 v[40:43], a[40:43], v[164:167], v[40:43]
    ds_read_b64_tr_b16 a[14:15], v7 offset:608
    buffer_load_dwordx4 v[148:151], v4, s[28:31], s23 offen offset:1024
    s_add_u32 s23, s23, 0x40000
    v_mfma_f32_16x16x32_bf16 v[28:31], a[44:47], v[160:163], v[28:31]
    ds_read_b64_tr_b16 a[16:17], v7 offset:1024
    v_mfma_f32_16x16x32_bf16 v[44:47], a[44:47], v[164:167], v[44:47]
    ds_read_b64_tr_b16 a[18:19], v7 offset:1536
    s_waitcnt vmcnt(40)
    v_mfma_f32_16x16x32_bf16 v[16:19], a[48:51], v[168:171], v[16:19]
    ds_read_b64_tr_b16 a[20:21], v7 offset:1056
    ds_read_b64_tr_b16 a[22:23], v7 offset:1568
    buffer_load_dwordx4 v6, s[32:35], s25 offen offset:1024 lds
    s_add_u32 s25, s25, 0x20000
    s_waitcnt vmcnt(40)
    v_mfma_f32_16x16x32_bf16 v[32:35], a[48:51], v[172:175], v[32:35]
    ds_read_b64_tr_b16 a[24:25], v7 offset:1088
    v_mfma_f32_16x16x32_bf16 v[20:23], a[52:55], v[168:171], v[20:23]
    ds_read_b64_tr_b16 a[26:27], v7 offset:1600
    buffer_load_dwordx4 v[152:155], v4, s[28:31], s24 offen offset:0
    v_mfma_f32_16x16x32_bf16 v[36:39], a[52:55], v[172:175], v[36:39]
    ds_read_b64_tr_b16 a[28:29], v7 offset:1120
    v_mfma_f32_16x16x32_bf16 v[24:27], a[56:59], v[168:171], v[24:27]
    ds_read_b64_tr_b16 a[30:31], v7 offset:1632
    v_mfma_f32_16x16x32_bf16 v[40:43], a[56:59], v[172:175], v[40:43]
    buffer_load_dwordx4 v[156:159], v4, s[28:31], s24 offen offset:1024
    s_add_u32 s24, s24, 0x40000
    v_mfma_f32_16x16x32_bf16 v[28:31], a[60:63], v[168:171], v[28:31]
    v_mfma_f32_16x16x32_bf16 v[44:47], a[60:63], v[172:175], v[44:47]
    s_sub_u32 s48, s48, 1
    s_cmp_lg_u32 s48, 0
    s_cbranch_scc1 wo2_kernel_loop
    s_waitcnt lgkmcnt(0)
    s_waitcnt vmcnt(38)
    s_barrier
    v_mfma_f32_16x16x32_bf16 v[16:19], a[0:3], v[48:51], v[16:19]
    ds_read_b64_tr_b16 a[32:33], v7 offset:8320
    ds_read_b64_tr_b16 a[34:35], v7 offset:8832
    buffer_load_dwordx4 v[160:163], v4, s[28:31], s23 offen offset:0
    v_mfma_f32_16x16x32_bf16 v[32:35], a[0:3], v[52:55], v[32:35]
    ds_read_b64_tr_b16 a[36:37], v7 offset:8352
    v_mfma_f32_16x16x32_bf16 v[20:23], a[4:7], v[48:51], v[20:23]
    ds_read_b64_tr_b16 a[38:39], v7 offset:8864
    v_mfma_f32_16x16x32_bf16 v[36:39], a[4:7], v[52:55], v[36:39]
    ds_read_b64_tr_b16 a[40:41], v7 offset:8384
    v_mfma_f32_16x16x32_bf16 v[24:27], a[8:11], v[48:51], v[24:27]
    ds_read_b64_tr_b16 a[42:43], v7 offset:8896
    ds_read_b64_tr_b16 a[44:45], v7 offset:8416
    buffer_load_dwordx4 v[164:167], v4, s[28:31], s23 offen offset:1024
    s_add_u32 s23, s23, 0x40000
    v_mfma_f32_16x16x32_bf16 v[40:43], a[8:11], v[52:55], v[40:43]
    ds_read_b64_tr_b16 a[46:47], v7 offset:8928
    v_mfma_f32_16x16x32_bf16 v[28:31], a[12:15], v[48:51], v[28:31]
    ds_read_b64_tr_b16 a[48:49], v7 offset:9344
    v_mfma_f32_16x16x32_bf16 v[44:47], a[12:15], v[52:55], v[44:47]
    ds_read_b64_tr_b16 a[50:51], v7 offset:9856
    s_waitcnt vmcnt(39)
    v_mfma_f32_16x16x32_bf16 v[16:19], a[16:19], v[56:59], v[16:19]
    ds_read_b64_tr_b16 a[52:53], v7 offset:9376
    ds_read_b64_tr_b16 a[54:55], v7 offset:9888
    buffer_load_dwordx4 v[168:171], v4, s[28:31], s24 offen offset:0
    s_waitcnt vmcnt(39)
    v_mfma_f32_16x16x32_bf16 v[32:35], a[16:19], v[60:63], v[32:35]
    ds_read_b64_tr_b16 a[56:57], v7 offset:9408
    v_mfma_f32_16x16x32_bf16 v[20:23], a[20:23], v[56:59], v[20:23]
    ds_read_b64_tr_b16 a[58:59], v7 offset:9920
    v_mfma_f32_16x16x32_bf16 v[36:39], a[20:23], v[60:63], v[36:39]
    ds_read_b64_tr_b16 a[60:61], v7 offset:9440
    v_mfma_f32_16x16x32_bf16 v[24:27], a[24:27], v[56:59], v[24:27]
    ds_read_b64_tr_b16 a[62:63], v7 offset:9952
    buffer_load_dwordx4 v[172:175], v4, s[28:31], s24 offen offset:1024
    s_add_u32 s24, s24, 0x40000
    v_mfma_f32_16x16x32_bf16 v[40:43], a[24:27], v[60:63], v[40:43]
    v_mfma_f32_16x16x32_bf16 v[28:31], a[28:31], v[56:59], v[28:31]
    v_mfma_f32_16x16x32_bf16 v[44:47], a[28:31], v[60:63], v[44:47]
    s_waitcnt lgkmcnt(0)
    s_waitcnt vmcnt(36)
    s_barrier
    v_mfma_f32_16x16x32_bf16 v[16:19], a[32:35], v[64:67], v[16:19]
    ds_read_b64_tr_b16 a[0:1], v7 offset:16640
    ds_read_b64_tr_b16 a[2:3], v7 offset:17152
    buffer_load_dwordx4 v[176:179], v4, s[36:39], s26 offen offset:0
    v_mfma_f32_16x16x32_bf16 v[32:35], a[32:35], v[68:71], v[32:35]
    ds_read_b64_tr_b16 a[4:5], v7 offset:16672
    v_mfma_f32_16x16x32_bf16 v[20:23], a[36:39], v[64:67], v[20:23]
    ds_read_b64_tr_b16 a[6:7], v7 offset:17184
    v_mfma_f32_16x16x32_bf16 v[36:39], a[36:39], v[68:71], v[36:39]
    ds_read_b64_tr_b16 a[8:9], v7 offset:16704
    v_mfma_f32_16x16x32_bf16 v[24:27], a[40:43], v[64:67], v[24:27]
    ds_read_b64_tr_b16 a[10:11], v7 offset:17216
    ds_read_b64_tr_b16 a[12:13], v7 offset:16736
    buffer_load_dwordx4 v[180:183], v4, s[36:39], s27 offen offset:0
    v_mfma_f32_16x16x32_bf16 v[40:43], a[40:43], v[68:71], v[40:43]
    ds_read_b64_tr_b16 a[14:15], v7 offset:17248
    v_mfma_f32_16x16x32_bf16 v[28:31], a[44:47], v[64:67], v[28:31]
    ds_read_b64_tr_b16 a[16:17], v7 offset:17664
    v_mfma_f32_16x16x32_bf16 v[44:47], a[44:47], v[68:71], v[44:47]
    ds_read_b64_tr_b16 a[18:19], v7 offset:18176
    s_waitcnt vmcnt(37)
    v_mfma_f32_16x16x32_bf16 v[16:19], a[48:51], v[72:75], v[16:19]
    ds_read_b64_tr_b16 a[20:21], v7 offset:17696
    ds_read_b64_tr_b16 a[22:23], v7 offset:18208
    buffer_load_dwordx4 v[184:187], v4, s[36:39], s26 offen offset:1024
    s_waitcnt vmcnt(37)
    v_mfma_f32_16x16x32_bf16 v[32:35], a[48:51], v[76:79], v[32:35]
    ds_read_b64_tr_b16 a[24:25], v7 offset:17728
    v_mfma_f32_16x16x32_bf16 v[20:23], a[52:55], v[72:75], v[20:23]
    ds_read_b64_tr_b16 a[26:27], v7 offset:18240
    v_mfma_f32_16x16x32_bf16 v[36:39], a[52:55], v[76:79], v[36:39]
    ds_read_b64_tr_b16 a[28:29], v7 offset:17760
    v_mfma_f32_16x16x32_bf16 v[24:27], a[56:59], v[72:75], v[24:27]
    ds_read_b64_tr_b16 a[30:31], v7 offset:18272
    buffer_load_dwordx4 v[188:191], v4, s[36:39], s27 offen offset:1024
    v_mfma_f32_16x16x32_bf16 v[40:43], a[56:59], v[76:79], v[40:43]
    v_mfma_f32_16x16x32_bf16 v[28:31], a[60:63], v[72:75], v[28:31]
    v_mfma_f32_16x16x32_bf16 v[44:47], a[60:63], v[76:79], v[44:47]
    s_waitcnt lgkmcnt(0)
    s_waitcnt vmcnt(34)
    s_barrier
    v_mfma_f32_16x16x32_bf16 v[16:19], a[0:3], v[80:83], v[16:19]
    ds_read_b64_tr_b16 a[32:33], v7 offset:24960
    ds_read_b64_tr_b16 a[34:35], v7 offset:25472
    v_mfma_f32_16x16x32_bf16 v[32:35], a[0:3], v[84:87], v[32:35]
    ds_read_b64_tr_b16 a[36:37], v7 offset:24992
    v_mfma_f32_16x16x32_bf16 v[20:23], a[4:7], v[80:83], v[20:23]
    ds_read_b64_tr_b16 a[38:39], v7 offset:25504
    v_mfma_f32_16x16x32_bf16 v[36:39], a[4:7], v[84:87], v[36:39]
    ds_read_b64_tr_b16 a[40:41], v7 offset:25024
    v_mfma_f32_16x16x32_bf16 v[24:27], a[8:11], v[80:83], v[24:27]
    ds_read_b64_tr_b16 a[42:43], v7 offset:25536
    ds_read_b64_tr_b16 a[44:45], v7 offset:25056
    v_mfma_f32_16x16x32_bf16 v[40:43], a[8:11], v[84:87], v[40:43]
    ds_read_b64_tr_b16 a[46:47], v7 offset:25568
    v_mfma_f32_16x16x32_bf16 v[28:31], a[12:15], v[80:83], v[28:31]
    ds_read_b64_tr_b16 a[48:49], v7 offset:25984
    v_mfma_f32_16x16x32_bf16 v[44:47], a[12:15], v[84:87], v[44:47]
    ds_read_b64_tr_b16 a[50:51], v7 offset:26496
    s_waitcnt vmcnt(33)
    v_mfma_f32_16x16x32_bf16 v[16:19], a[16:19], v[88:91], v[16:19]
    ds_read_b64_tr_b16 a[52:53], v7 offset:26016
    ds_read_b64_tr_b16 a[54:55], v7 offset:26528
    s_waitcnt vmcnt(32)
    v_mfma_f32_16x16x32_bf16 v[32:35], a[16:19], v[92:95], v[32:35]
    ds_read_b64_tr_b16 a[56:57], v7 offset:26048
    v_mfma_f32_16x16x32_bf16 v[20:23], a[20:23], v[88:91], v[20:23]
    ds_read_b64_tr_b16 a[58:59], v7 offset:26560
    v_mfma_f32_16x16x32_bf16 v[36:39], a[20:23], v[92:95], v[36:39]
    ds_read_b64_tr_b16 a[60:61], v7 offset:26080
    v_mfma_f32_16x16x32_bf16 v[24:27], a[24:27], v[88:91], v[24:27]
    ds_read_b64_tr_b16 a[62:63], v7 offset:26592
    v_mfma_f32_16x16x32_bf16 v[40:43], a[24:27], v[92:95], v[40:43]
    v_mfma_f32_16x16x32_bf16 v[28:31], a[28:31], v[88:91], v[28:31]
    v_mfma_f32_16x16x32_bf16 v[44:47], a[28:31], v[92:95], v[44:47]
    s_waitcnt lgkmcnt(0)
    s_waitcnt vmcnt(28)
    s_barrier
    v_mfma_f32_16x16x32_bf16 v[16:19], a[32:35], v[96:99], v[16:19]
    ds_read_b64_tr_b16 a[0:1], v7 offset:33280
    ds_read_b64_tr_b16 a[2:3], v7 offset:33792
    v_mfma_f32_16x16x32_bf16 v[32:35], a[32:35], v[100:103], v[32:35]
    ds_read_b64_tr_b16 a[4:5], v7 offset:33312
    v_mfma_f32_16x16x32_bf16 v[20:23], a[36:39], v[96:99], v[20:23]
    ds_read_b64_tr_b16 a[6:7], v7 offset:33824
    v_mfma_f32_16x16x32_bf16 v[36:39], a[36:39], v[100:103], v[36:39]
    ds_read_b64_tr_b16 a[8:9], v7 offset:33344
    v_mfma_f32_16x16x32_bf16 v[24:27], a[40:43], v[96:99], v[24:27]
    ds_read_b64_tr_b16 a[10:11], v7 offset:33856
    ds_read_b64_tr_b16 a[12:13], v7 offset:33376
    v_mfma_f32_16x16x32_bf16 v[40:43], a[40:43], v[100:103], v[40:43]
    ds_read_b64_tr_b16 a[14:15], v7 offset:33888
    v_mfma_f32_16x16x32_bf16 v[28:31], a[44:47], v[96:99], v[28:31]
    ds_read_b64_tr_b16 a[16:17], v7 offset:34304
    v_mfma_f32_16x16x32_bf16 v[44:47], a[44:47], v[100:103], v[44:47]
    ds_read_b64_tr_b16 a[18:19], v7 offset:34816
    s_waitcnt vmcnt(27)
    v_mfma_f32_16x16x32_bf16 v[16:19], a[48:51], v[104:107], v[16:19]
    ds_read_b64_tr_b16 a[20:21], v7 offset:34336
    ds_read_b64_tr_b16 a[22:23], v7 offset:34848
    s_waitcnt vmcnt(26)
    v_mfma_f32_16x16x32_bf16 v[32:35], a[48:51], v[108:111], v[32:35]
    ds_read_b64_tr_b16 a[24:25], v7 offset:34368
    v_mfma_f32_16x16x32_bf16 v[20:23], a[52:55], v[104:107], v[20:23]
    ds_read_b64_tr_b16 a[26:27], v7 offset:34880
    v_mfma_f32_16x16x32_bf16 v[36:39], a[52:55], v[108:111], v[36:39]
    ds_read_b64_tr_b16 a[28:29], v7 offset:34400
    v_mfma_f32_16x16x32_bf16 v[24:27], a[56:59], v[104:107], v[24:27]
    ds_read_b64_tr_b16 a[30:31], v7 offset:34912
    v_mfma_f32_16x16x32_bf16 v[40:43], a[56:59], v[108:111], v[40:43]
    v_mfma_f32_16x16x32_bf16 v[28:31], a[60:63], v[104:107], v[28:31]
    v_mfma_f32_16x16x32_bf16 v[44:47], a[60:63], v[108:111], v[44:47]
    s_waitcnt lgkmcnt(0)
    s_waitcnt vmcnt(22)
    s_barrier
    v_mfma_f32_16x16x32_bf16 v[16:19], a[0:3], v[112:115], v[16:19]
    ds_read_b64_tr_b16 a[32:33], v7 offset:41600
    ds_read_b64_tr_b16 a[34:35], v7 offset:42112
    v_mfma_f32_16x16x32_bf16 v[32:35], a[0:3], v[116:119], v[32:35]
    ds_read_b64_tr_b16 a[36:37], v7 offset:41632
    v_mfma_f32_16x16x32_bf16 v[20:23], a[4:7], v[112:115], v[20:23]
    ds_read_b64_tr_b16 a[38:39], v7 offset:42144
    v_mfma_f32_16x16x32_bf16 v[36:39], a[4:7], v[116:119], v[36:39]
    ds_read_b64_tr_b16 a[40:41], v7 offset:41664
    v_mfma_f32_16x16x32_bf16 v[24:27], a[8:11], v[112:115], v[24:27]
    ds_read_b64_tr_b16 a[42:43], v7 offset:42176
    ds_read_b64_tr_b16 a[44:45], v7 offset:41696
    v_mfma_f32_16x16x32_bf16 v[40:43], a[8:11], v[116:119], v[40:43]
    ds_read_b64_tr_b16 a[46:47], v7 offset:42208
    v_mfma_f32_16x16x32_bf16 v[28:31], a[12:15], v[112:115], v[28:31]
    ds_read_b64_tr_b16 a[48:49], v7 offset:42624
    v_mfma_f32_16x16x32_bf16 v[44:47], a[12:15], v[116:119], v[44:47]
    ds_read_b64_tr_b16 a[50:51], v7 offset:43136
    s_waitcnt vmcnt(21)
    v_mfma_f32_16x16x32_bf16 v[16:19], a[16:19], v[120:123], v[16:19]
    ds_read_b64_tr_b16 a[52:53], v7 offset:42656
    ds_read_b64_tr_b16 a[54:55], v7 offset:43168
    s_waitcnt vmcnt(20)
    v_mfma_f32_16x16x32_bf16 v[32:35], a[16:19], v[124:127], v[32:35]
    ds_read_b64_tr_b16 a[56:57], v7 offset:42688
    v_mfma_f32_16x16x32_bf16 v[20:23], a[20:23], v[120:123], v[20:23]
    ds_read_b64_tr_b16 a[58:59], v7 offset:43200
    v_mfma_f32_16x16x32_bf16 v[36:39], a[20:23], v[124:127], v[36:39]
    ds_read_b64_tr_b16 a[60:61], v7 offset:42720
    v_mfma_f32_16x16x32_bf16 v[24:27], a[24:27], v[120:123], v[24:27]
    ds_read_b64_tr_b16 a[62:63], v7 offset:43232
    v_mfma_f32_16x16x32_bf16 v[40:43], a[24:27], v[124:127], v[40:43]
    v_mfma_f32_16x16x32_bf16 v[28:31], a[28:31], v[120:123], v[28:31]
    v_mfma_f32_16x16x32_bf16 v[44:47], a[28:31], v[124:127], v[44:47]
    s_waitcnt lgkmcnt(0)
    s_waitcnt vmcnt(16)
    s_barrier
    v_mfma_f32_16x16x32_bf16 v[16:19], a[32:35], v[128:131], v[16:19]
    ds_read_b64_tr_b16 a[0:1], v7 offset:49920
    ds_read_b64_tr_b16 a[2:3], v7 offset:50432
    v_mfma_f32_16x16x32_bf16 v[32:35], a[32:35], v[132:135], v[32:35]
    ds_read_b64_tr_b16 a[4:5], v7 offset:49952
    v_mfma_f32_16x16x32_bf16 v[20:23], a[36:39], v[128:131], v[20:23]
    ds_read_b64_tr_b16 a[6:7], v7 offset:50464
    v_mfma_f32_16x16x32_bf16 v[36:39], a[36:39], v[132:135], v[36:39]
    ds_read_b64_tr_b16 a[8:9], v7 offset:49984
    v_mfma_f32_16x16x32_bf16 v[24:27], a[40:43], v[128:131], v[24:27]
    ds_read_b64_tr_b16 a[10:11], v7 offset:50496
    ds_read_b64_tr_b16 a[12:13], v7 offset:50016
    v_mfma_f32_16x16x32_bf16 v[40:43], a[40:43], v[132:135], v[40:43]
    ds_read_b64_tr_b16 a[14:15], v7 offset:50528
    v_mfma_f32_16x16x32_bf16 v[28:31], a[44:47], v[128:131], v[28:31]
    ds_read_b64_tr_b16 a[16:17], v7 offset:50944
    v_mfma_f32_16x16x32_bf16 v[44:47], a[44:47], v[132:135], v[44:47]
    ds_read_b64_tr_b16 a[18:19], v7 offset:51456
    s_waitcnt vmcnt(15)
    v_mfma_f32_16x16x32_bf16 v[16:19], a[48:51], v[136:139], v[16:19]
    ds_read_b64_tr_b16 a[20:21], v7 offset:50976
    ds_read_b64_tr_b16 a[22:23], v7 offset:51488
    s_waitcnt vmcnt(14)
    v_mfma_f32_16x16x32_bf16 v[32:35], a[48:51], v[140:143], v[32:35]
    ds_read_b64_tr_b16 a[24:25], v7 offset:51008
    v_mfma_f32_16x16x32_bf16 v[20:23], a[52:55], v[136:139], v[20:23]
    ds_read_b64_tr_b16 a[26:27], v7 offset:51520
    v_mfma_f32_16x16x32_bf16 v[36:39], a[52:55], v[140:143], v[36:39]
    ds_read_b64_tr_b16 a[28:29], v7 offset:51040
    v_mfma_f32_16x16x32_bf16 v[24:27], a[56:59], v[136:139], v[24:27]
    ds_read_b64_tr_b16 a[30:31], v7 offset:51552
    v_mfma_f32_16x16x32_bf16 v[40:43], a[56:59], v[140:143], v[40:43]
    v_mfma_f32_16x16x32_bf16 v[28:31], a[60:63], v[136:139], v[28:31]
    v_mfma_f32_16x16x32_bf16 v[44:47], a[60:63], v[140:143], v[44:47]
    s_waitcnt lgkmcnt(0)
    s_waitcnt vmcnt(10)
    s_barrier
    v_mfma_f32_16x16x32_bf16 v[16:19], a[0:3], v[144:147], v[16:19]
    ds_read_b64_tr_b16 a[32:33], v7 offset:58240
    ds_read_b64_tr_b16 a[34:35], v7 offset:58752
    v_mfma_f32_16x16x32_bf16 v[32:35], a[0:3], v[148:151], v[32:35]
    ds_read_b64_tr_b16 a[36:37], v7 offset:58272
    v_mfma_f32_16x16x32_bf16 v[20:23], a[4:7], v[144:147], v[20:23]
    ds_read_b64_tr_b16 a[38:39], v7 offset:58784
    v_mfma_f32_16x16x32_bf16 v[36:39], a[4:7], v[148:151], v[36:39]
    ds_read_b64_tr_b16 a[40:41], v7 offset:58304
    v_mfma_f32_16x16x32_bf16 v[24:27], a[8:11], v[144:147], v[24:27]
    ds_read_b64_tr_b16 a[42:43], v7 offset:58816
    ds_read_b64_tr_b16 a[44:45], v7 offset:58336
    v_mfma_f32_16x16x32_bf16 v[40:43], a[8:11], v[148:151], v[40:43]
    ds_read_b64_tr_b16 a[46:47], v7 offset:58848
    v_mfma_f32_16x16x32_bf16 v[28:31], a[12:15], v[144:147], v[28:31]
    ds_read_b64_tr_b16 a[48:49], v7 offset:59264
    v_mfma_f32_16x16x32_bf16 v[44:47], a[12:15], v[148:151], v[44:47]
    ds_read_b64_tr_b16 a[50:51], v7 offset:59776
    s_waitcnt vmcnt(9)
    v_mfma_f32_16x16x32_bf16 v[16:19], a[16:19], v[152:155], v[16:19]
    ds_read_b64_tr_b16 a[52:53], v7 offset:59296
    ds_read_b64_tr_b16 a[54:55], v7 offset:59808
    s_waitcnt vmcnt(8)
    v_mfma_f32_16x16x32_bf16 v[32:35], a[16:19], v[156:159], v[32:35]
    ds_read_b64_tr_b16 a[56:57], v7 offset:59328
    v_mfma_f32_16x16x32_bf16 v[20:23], a[20:23], v[152:155], v[20:23]
    ds_read_b64_tr_b16 a[58:59], v7 offset:59840
    v_mfma_f32_16x16x32_bf16 v[36:39], a[20:23], v[156:159], v[36:39]
    ds_read_b64_tr_b16 a[60:61], v7 offset:59360
    v_mfma_f32_16x16x32_bf16 v[24:27], a[24:27], v[152:155], v[24:27]
    ds_read_b64_tr_b16 a[62:63], v7 offset:59872
    v_mfma_f32_16x16x32_bf16 v[40:43], a[24:27], v[156:159], v[40:43]
    v_mfma_f32_16x16x32_bf16 v[28:31], a[28:31], v[152:155], v[28:31]
    v_mfma_f32_16x16x32_bf16 v[44:47], a[28:31], v[156:159], v[44:47]
    s_waitcnt lgkmcnt(0)
    s_waitcnt vmcnt(7)
    v_mfma_f32_16x16x32_bf16 v[16:19], a[32:35], v[160:163], v[16:19]
    s_waitcnt vmcnt(6)
    v_mfma_f32_16x16x32_bf16 v[32:35], a[32:35], v[164:167], v[32:35]
    v_mfma_f32_16x16x32_bf16 v[20:23], a[36:39], v[160:163], v[20:23]
    v_mfma_f32_16x16x32_bf16 v[36:39], a[36:39], v[164:167], v[36:39]
    v_mfma_f32_16x16x32_bf16 v[24:27], a[40:43], v[160:163], v[24:27]
    v_mfma_f32_16x16x32_bf16 v[40:43], a[40:43], v[164:167], v[40:43]
    v_mfma_f32_16x16x32_bf16 v[28:31], a[44:47], v[160:163], v[28:31]
    v_mfma_f32_16x16x32_bf16 v[44:47], a[44:47], v[164:167], v[44:47]
    s_waitcnt vmcnt(5)
    v_mfma_f32_16x16x32_bf16 v[16:19], a[48:51], v[168:171], v[16:19]
    s_waitcnt vmcnt(4)
    v_mfma_f32_16x16x32_bf16 v[32:35], a[48:51], v[172:175], v[32:35]
    v_mfma_f32_16x16x32_bf16 v[20:23], a[52:55], v[168:171], v[20:23]
    v_mfma_f32_16x16x32_bf16 v[36:39], a[52:55], v[172:175], v[36:39]
    v_mfma_f32_16x16x32_bf16 v[24:27], a[56:59], v[168:171], v[24:27]
    v_mfma_f32_16x16x32_bf16 v[40:43], a[56:59], v[172:175], v[40:43]
    v_mfma_f32_16x16x32_bf16 v[28:31], a[60:63], v[168:171], v[28:31]
    v_mfma_f32_16x16x32_bf16 v[44:47], a[60:63], v[172:175], v[44:47]
    s_waitcnt vmcnt(3)
    v_lshlrev_b32 v68, 16, v176
    v_and_b32 v69, 0xffff0000, v176
    v_pk_add_f32 v[16:17], v[16:17], v[68:69]
    v_cvt_pk_bf16_f32 v48, v16, v17
    v_lshlrev_b32 v70, 16, v177
    v_and_b32 v71, 0xffff0000, v177
    v_pk_add_f32 v[18:19], v[18:19], v[70:71]
    v_cvt_pk_bf16_f32 v49, v18, v19
    v_lshlrev_b32 v68, 16, v178
    v_and_b32 v69, 0xffff0000, v178
    v_pk_add_f32 v[20:21], v[20:21], v[68:69]
    v_cvt_pk_bf16_f32 v50, v20, v21
    v_lshlrev_b32 v70, 16, v179
    v_and_b32 v71, 0xffff0000, v179
    v_pk_add_f32 v[22:23], v[22:23], v[70:71]
    v_cvt_pk_bf16_f32 v51, v22, v23
    buffer_store_dwordx4 v[48:51], v4, s[40:43], s26 offen offset:0
    s_waitcnt vmcnt(3)
    v_lshlrev_b32 v68, 16, v180
    v_and_b32 v69, 0xffff0000, v180
    v_pk_add_f32 v[24:25], v[24:25], v[68:69]
    v_cvt_pk_bf16_f32 v52, v24, v25
    v_lshlrev_b32 v70, 16, v181
    v_and_b32 v71, 0xffff0000, v181
    v_pk_add_f32 v[26:27], v[26:27], v[70:71]
    v_cvt_pk_bf16_f32 v53, v26, v27
    v_lshlrev_b32 v68, 16, v182
    v_and_b32 v69, 0xffff0000, v182
    v_pk_add_f32 v[28:29], v[28:29], v[68:69]
    v_cvt_pk_bf16_f32 v54, v28, v29
    v_lshlrev_b32 v70, 16, v183
    v_and_b32 v71, 0xffff0000, v183
    v_pk_add_f32 v[30:31], v[30:31], v[70:71]
    v_cvt_pk_bf16_f32 v55, v30, v31
    buffer_store_dwordx4 v[52:55], v4, s[40:43], s27 offen offset:0
    s_waitcnt vmcnt(3)
    v_lshlrev_b32 v68, 16, v184
    v_and_b32 v69, 0xffff0000, v184
    v_pk_add_f32 v[32:33], v[32:33], v[68:69]
    v_cvt_pk_bf16_f32 v56, v32, v33
    v_lshlrev_b32 v70, 16, v185
    v_and_b32 v71, 0xffff0000, v185
    v_pk_add_f32 v[34:35], v[34:35], v[70:71]
    v_cvt_pk_bf16_f32 v57, v34, v35
    v_lshlrev_b32 v68, 16, v186
    v_and_b32 v69, 0xffff0000, v186
    v_pk_add_f32 v[36:37], v[36:37], v[68:69]
    v_cvt_pk_bf16_f32 v58, v36, v37
    v_lshlrev_b32 v70, 16, v187
    v_and_b32 v71, 0xffff0000, v187
    v_pk_add_f32 v[38:39], v[38:39], v[70:71]
    v_cvt_pk_bf16_f32 v59, v38, v39
    buffer_store_dwordx4 v[56:59], v4, s[40:43], s26 offen offset:1024
    s_waitcnt vmcnt(3)
    v_lshlrev_b32 v68, 16, v188
    v_and_b32 v69, 0xffff0000, v188
    v_pk_add_f32 v[40:41], v[40:41], v[68:69]
    v_cvt_pk_bf16_f32 v60, v40, v41
    v_lshlrev_b32 v70, 16, v189
    v_and_b32 v71, 0xffff0000, v189
    v_pk_add_f32 v[42:43], v[42:43], v[70:71]
    v_cvt_pk_bf16_f32 v61, v42, v43
    v_lshlrev_b32 v68, 16, v190
    v_and_b32 v69, 0xffff0000, v190
    v_pk_add_f32 v[44:45], v[44:45], v[68:69]
    v_cvt_pk_bf16_f32 v62, v44, v45
    v_lshlrev_b32 v70, 16, v191
    v_and_b32 v71, 0xffff0000, v191
    v_pk_add_f32 v[46:47], v[46:47], v[70:71]
    v_cvt_pk_bf16_f32 v63, v46, v47
    buffer_store_dwordx4 v[60:63], v4, s[40:43], s27 offen offset:1024
    v_pk_mul_f32 v[90:91], v[16:17], v[16:17]
    v_pk_fma_f32 v[90:91], v[18:19], v[18:19], v[90:91]
    v_pk_add_f32 v[88:89], v[16:17], v[18:19]
    v_pk_fma_f32 v[90:91], v[20:21], v[20:21], v[90:91]
    v_pk_add_f32 v[88:89], v[88:89], v[20:21]
    v_pk_fma_f32 v[90:91], v[22:23], v[22:23], v[90:91]
    v_pk_add_f32 v[88:89], v[88:89], v[22:23]
    v_pk_fma_f32 v[90:91], v[24:25], v[24:25], v[90:91]
    v_pk_add_f32 v[88:89], v[88:89], v[24:25]
    v_pk_fma_f32 v[90:91], v[26:27], v[26:27], v[90:91]
    v_pk_add_f32 v[88:89], v[88:89], v[26:27]
    v_pk_fma_f32 v[90:91], v[28:29], v[28:29], v[90:91]
    v_pk_add_f32 v[88:89], v[88:89], v[28:29]
    v_pk_fma_f32 v[90:91], v[30:31], v[30:31], v[90:91]
    v_pk_add_f32 v[88:89], v[88:89], v[30:31]
    v_add_f32 v88, v88, v89
    v_add_f32 v90, v90, v91
    v_pk_mul_f32 v[94:95], v[32:33], v[32:33]
    v_pk_fma_f32 v[94:95], v[34:35], v[34:35], v[94:95]
    v_pk_add_f32 v[92:93], v[32:33], v[34:35]
    v_pk_fma_f32 v[94:95], v[36:37], v[36:37], v[94:95]
    v_pk_add_f32 v[92:93], v[92:93], v[36:37]
    v_pk_fma_f32 v[94:95], v[38:39], v[38:39], v[94:95]
    v_pk_add_f32 v[92:93], v[92:93], v[38:39]
    v_pk_fma_f32 v[94:95], v[40:41], v[40:41], v[94:95]
    v_pk_add_f32 v[92:93], v[92:93], v[40:41]
    v_pk_fma_f32 v[94:95], v[42:43], v[42:43], v[94:95]
    v_pk_add_f32 v[92:93], v[92:93], v[42:43]
    v_pk_fma_f32 v[94:95], v[44:45], v[44:45], v[94:95]
    v_pk_add_f32 v[92:93], v[92:93], v[44:45]
    v_pk_fma_f32 v[94:95], v[46:47], v[46:47], v[94:95]
    v_pk_add_f32 v[92:93], v[92:93], v[46:47]
    v_add_f32 v92, v92, v93
    v_add_f32 v94, v94, v95
    s_nop 0
    v_permlane16_swap_b32 v88, v92
    v_permlane16_swap_b32 v90, v94
    v_add_f32 v88, v88, v92
    v_add_f32 v90, v90, v94
    s_lshl_b32 s50, s7, 14
    s_lshl_b32 s51, s6, 10
    s_add_u32 s50, s50, s51
    s_lshl_b32 s51, s3, 8
    s_add_u32 s50, s50, s51
    v_permlane32_swap_b32 v88, v90
    v_and_b32 v78, 31, v1
    v_lshlrev_b32 v78, 3, v78
    v_lshrrev_b32 v92, 5, v1
    v_lshl_add_u32 v78, v92, 2, v78
    v_add_f32 v88, v88, v90
    buffer_store_dword v88, v78, s[44:47], s50 offen
wo2_kernel_end:
    s_endpgm
.text
.globl gu2_kernel
.p2align 8
.type gu2_kernel,@function
gu2_kernel:
    s_cmp_ge_u32 s2, 256
    s_cbranch_scc1 gu2_kernel_end
    s_load_dwordx2 s[10:11], s[0:1], 72
    s_load_dwordx2 s[12:13], s[0:1], 32
    s_load_dwordx2 s[14:15], s[0:1], 40
    v_lshrrev_b32 v2, 6, v0
    v_and_b32 v1, 63, v0
    v_readfirstlane_b32 s3, v2
    s_and_b32 s4, s2, 7
    s_lshr_b32 s5, s2, 3
    s_and_b32 s6, s4, 1
    s_lshl_b32 s6, s6, 2
    s_and_b32 s7, s5, 3
    s_add_u32 s6, s6, s7
    s_lshr_b32 s7, s4, 1
    s_lshl_b32 s7, s7, 3
    s_lshr_b32 s8, s5, 2
    s_add_u32 s7, s7, s8
    s_and_b32 s8, s7, 1
    s_lshr_b32 s9, s7, 1
    s_lshl_b32 s20, s6, 14
    s_lshl_b32 s21, s3, 12
    s_add_u32 s20, s20, s21
    s_lshl_b32 s21, s8, 11
    s_add_u32 s20, s20, s21
    v_lshl_add_u32 v4, v1, 4, s20
    v_xor_b32 v5, 2048, v4
    s_mul_i32 s16, s9, 448
    s_mul_i32 s21, s8, 192
    s_add_u32 s16, s16, s21
    s_and_b32 s21, s3, 1
    s_mul_i32 s21, s21, 28672
    s_add_u32 s21, s21, s16
    v_lshrrev_b32 v14, 4, v1
    v_mul_u32_u24 v14, 57344, v14
    v_and_b32 v15, 15, v1
    v_lshl_add_u32 v14, v15, 4, v14
    v_add_u32 v6, s21, v14
    v_add_u32 v7, 6112, v6
    v_add_u32 v8, 12224, v6
    v_add_u32 v9, 18336, v6
    v_bfe_u32 v14, v1, 2, 3
    v_mul_u32_u24 v14, 1056, v14
    v_bfe_u32 v15, v1, 5, 1
    v_lshl_add_u32 v14, v15, 8, v14
    v_and_b32 v15, 3, v1
    v_lshl_add_u32 v14, v15, 3, v14
    s_lshl_b32 s17, s8, 6
    s_xor_b32 s18, s8, 1
    s_mul_i32 s18, s18, 192
    v_add_u32 v10, s17, v14
    v_add_u32 v12, s18, v14
    v_add_u32 v11, 67584, v10
    v_add_u32 v13, 67584, v12
    s_mul_i32 s22, s3, 4224
    s_mov_b32 s23, 0
    s_mov_b32 s25, 0
    s_lshl_b32 s21, s6, 11
    v_lshl_add_u32 v16, v0, 3, s21
    s_waitcnt lgkmcnt(0)
    s_add_u32 s28, s10, 20971520
    s_addc_u32 s29, s11, 0
    s_mov_b32 s30, 4194304
    s_mov_b32 s31, 0x20000
    s_cmp_lt_u32 s3, 2
    s_cselect_b32 s32, s12, s14
    s_cselect_b32 s33, s13, s15
    s_mov_b32 s34, 7340032
    s_mov_b32 s35, 0x20000
    s_add_u32 s36, s10, 59506688
    s_addc_u32 s37, s11, 0
    s_mov_b32 s38, 262144
    s_mov_b32 s39, 0x20000
    s_add_u32 s44, s10, 60829696
    s_addc_u32 s45, s11, 0
    s_mov_b32 s46, 28672
    s_mov_b32 s47, 0x20000
    s_add_u32 m0, s22, 0
    s_nop 0
    buffer_load_dwordx4 v6, s[32:35], s25 offen offset:0 lds
    buffer_load_dwordx4 v7, s[32:35], s25 offen offset:1056 lds
    buffer_load_dwordx4 v8, s[32:35], s25 offen offset:2112 lds
    buffer_load_dwordx4 v9, s[32:35], s25 offen offset:3168 lds
    s_add_u32 s25, s25, 229376
    buffer_load_dwordx4 a[128:131], v4, s[28:31], s23 offen offset:0
    buffer_load_dwordx4 a[132:135], v4, s[28:31], s23 offen offset:1024
    buffer_load_dwordx4 a[136:139], v5, s[28:31], s23 offen offset:0
    buffer_load_dwordx4 a[140:143], v5, s[28:31], s23 offen offset:1024
    s_add_u32 s23, s23, 0x20000
    s_mov_b32 s26, 0
    buffer_load_dwordx2 v[32:33], v16, s[36:39], s26 offen
    s_mov_b32 s26, 16384
    buffer_load_dwordx2 v[34:35], v16, s[36:39], s26 offen
    s_mov_b32 s26, 32768
    buffer_load_dwordx2 v[36:37], v16, s[36:39], s26 offen
    s_mov_b32 s26, 49152
    buffer_load_dwordx2 v[38:39], v16, s[36:39], s26 offen
    s_mov_b32 s26, 65536
    buffer_load_dwordx2 v[40:41], v16, s[36:39], s26 offen
    s_mov_b32 s26, 81920
    buffer_load_dwordx2 v[42:43], v16, s[36:39], s26 offen
    s_mov_b32 s26, 98304
    buffer_load_dwordx2 v[44:45], v16, s[36:39], s26 offen
    s_mov_b32 s26, 114688
    buffer_load_dwordx2 v[46:47], v16, s[36:39], s26 offen
    s_mov_b32 s26, 131072
    buffer_load_dwordx2 v[48:49], v16, s[36:39], s26 offen
    s_mov_b32 s26, 147456
    buffer_load_dwordx2 v[50:51], v16, s[36:39], s26 offen
    s_mov_b32 s26, 163840
    buffer_load_dwordx2 v[52:53], v16, s[36:39], s26 offen
    s_mov_b32 s26, 180224
    buffer_load_dwordx2 v[54:55], v16, s[36:39], s26 offen
    s_mov_b32 s26, 196608
    buffer_load_dwordx2 v[56:57], v16, s[36:39], s26 offen
    s_mov_b32 s26, 212992
    buffer_load_dwordx2 v[58:59], v16, s[36:39], s26 offen
    s_mov_b32 s26, 229376
    buffer_load_dwordx2 v[60:61], v16, s[36:39], s26 offen
    s_mov_b32 s26, 245760
    buffer_load_dwordx2 v[62:63], v16, s[36:39], s26 offen
    s_lshr_b32 s21, s3, 1
    s_mul_i32 s21, s21, 14336
    s_lshl_b32 s26, s16, 1
    s_add_u32 s21, s21, s26
    s_and_b32 s26, s3, 1
    s_lshl_b32 s26, s26, 8
    s_add_u32 s21, s21, s26
    s_lshl_b32 s26, s3, 8
    s_add_u32 m0, s26, 139264
    v_lshlrev_b32 v17, 2, v1
    buffer_load_dword v17, s[44:47], s21 offen lds
    s_add_u32 m0, s22, 16896
    s_nop 0
    buffer_load_dwordx4 v6, s[32:35], s25 offen offset:0 lds
    buffer_load_dwordx4 v7, s[32:35], s25 offen offset:1056 lds
    buffer_load_dwordx4 v8, s[32:35], s25 offen offset:2112 lds
    buffer_load_dwordx4 v9, s[32:35], s25 offen offset:3168 lds
    s_add_u32 s25, s25, 229376
    buffer_load_dwordx4 a[144:147], v4, s[28:31], s23 offen offset:0
    buffer_load_dwordx4 a[148:151], v4, s[28:31], s23 offen offset:1024
    buffer_load_dwordx4 a[152:155], v5, s[28:31], s23 offen offset:0
    buffer_load_dwordx4 a[156:159], v5, s[28:31], s23 offen offset:1024
    s_add_u32 s23, s23, 0x20000
    s_add_u32 m0, s22, 33792
    s_nop 0
    buffer_load_dwordx4 v6, s[32:35], s25 offen offset:0 lds
    buffer_load_dwordx4 v7, s[32:35], s25 offen offset:1056 lds
    buffer_load_dwordx4 v8, s[32:35], s25 offen offset:2112 lds
    buffer_load_dwordx4 v9, s[32:35], s25 offen offset:3168 lds
    s_add_u32 s25, s25, 229376
    buffer_load_dwordx4 a[160:163], v4, s[28:31], s23 offen offset:0
    buffer_load_dwordx4 a[164:167], v4, s[28:31], s23 offen offset:1024
    buffer_load_dwordx4 a[168:171], v5, s[28:31], s23 offen offset:0
    buffer_load_dwordx4 a[172:175], v5, s[28:31], s23 offen offset:1024
    s_add_u32 s23, s23, 0x20000
    s_add_u32 m0, s22, 50688
    s_nop 0
    buffer_load_dwordx4 v6, s[32:35], s25 offen offset:0 lds
    buffer_load_dwordx4 v7, s[32:35], s25 offen offset:1056 lds
    buffer_load_dwordx4 v8, s[32:35], s25 offen offset:2112 lds
    buffer_load_dwordx4 v9, s[32:35], s25 offen offset:3168 lds
    s_add_u32 s25, s25, 229376
    s_add_u32 s40, s10, 41943040
    s_addc_u32 s41, s11, 0
    s_mov_b32 s42, 14680064
    s_mov_b32 s43, 0x20000
    s_waitcnt vmcnt(41)
    s_barrier
    ds_read_b64_tr_b16 a[0:1], v10 offset:0
    ds_read_b64_tr_b16 a[2:3], v10 offset:512
    ds_read_b64_tr_b16 a[4:5], v10 offset:32
    ds_read_b64_tr_b16 a[6:7], v10 offset:544
    ds_read_b64_tr_b16 a[8:9], v10 offset:8448
    ds_read_b64_tr_b16 a[10:11], v10 offset:8960
    ds_read_b64_tr_b16 a[12:13], v10 offset:8480
    ds_read_b64_tr_b16 a[14:15], v10 offset:8992
    ds_read_b64_tr_b16 a[16:17], v10 offset:64
    ds_read_b64_tr_b16 a[18:19], v10 offset:576
    ds_read_b64_tr_b16 a[20:21], v10 offset:96
    ds_read_b64_tr_b16 a[22:23], v10 offset:608
    ds_read_b64_tr_b16 a[24:25], v10 offset:8512
    ds_read_b64_tr_b16 a[26:27], v10 offset:9024
    ds_read_b64_tr_b16 a[28:29], v10 offset:8544
    ds_read_b64_tr_b16 a[30:31], v10 offset:9056
    ds_read_b64_tr_b16 a[32:33], v10 offset:128
    ds_read_b64_tr_b16 a[34:35], v10 offset:640
    ds_read_b64_tr_b16 a[36:37], v10 offset:160
    ds_read_b64_tr_b16 a[38:39], v10 offset:672
    ds_read_b64_tr_b16 a[40:41], v10 offset:8576
    ds_read_b64_tr_b16 a[42:43], v10 offset:9088
    ds_read_b64_tr_b16 a[44:45], v10 offset:8608
    ds_read_b64_tr_b16 a[46:47], v10 offset:9120
    ds_read_b64_tr_b16 a[48:49], v12 offset:0
    ds_read_b64_tr_b16 a[50:51], v12 offset:512
    ds_read_b64_tr_b16 a[52:53], v12 offset:32
    ds_read_b64_tr_b16 a[54:55], v12 offset:544
    ds_read_b64_tr_b16 a[56:57], v12 offset:8448
    ds_read_b64_tr_b16 a[58:59], v12 offset:8960
    ds_read_b64_tr_b16 a[60:61], v12 offset:8480
    ds_read_b64_tr_b16 a[62:63], v12 offset:8992
    s_waitcnt vmcnt(28)
    v_pk_add_f32 v[32:33], v[32:33], v[48:49]
    s_waitcnt vmcnt(27)
    v_pk_add_f32 v[34:35], v[34:35], v[50:51]
    s_waitcnt vmcnt(26)
    v_pk_add_f32 v[36:37], v[36:37], v[52:53]
    s_waitcnt vmcnt(25)
    v_pk_add_f32 v[38:39], v[38:39], v[54:55]
    s_waitcnt vmcnt(24)
    v_pk_add_f32 v[40:41], v[40:41], v[56:57]
    s_waitcnt vmcnt(23)
    v_pk_add_f32 v[42:43], v[42:43], v[58:59]
    s_waitcnt vmcnt(22)
    v_pk_add_f32 v[44:45], v[44:45], v[60:61]
    s_waitcnt vmcnt(21)
    v_pk_add_f32 v[46:47], v[46:47], v[62:63]
    v_pk_add_f32 v[32:33], v[32:33], v[40:41]
    v_pk_add_f32 v[34:35], v[34:35], v[42:43]
    v_pk_add_f32 v[36:37], v[36:37], v[44:45]
    v_pk_add_f32 v[38:39], v[38:39], v[46:47]
    v_pk_add_f32 v[32:33], v[32:33], v[36:37]
    v_pk_add_f32 v[34:35], v[34:35], v[38:39]
    v_pk_add_f32 v[32:33], v[32:33], v[34:35]
    v_mul_f32 v32, 0xba800000, v32
    v_mul_f32 v33, 0x3a800000, v33
    v_fma_f32 v33, -v32, v32, v33
    v_max_f32 v33, 0, v33
    v_add_f32 v33, 0x3727c5ac, v33
    v_rsq_f32 v34, v33
    s_nop 0
    v_mul_f32 v34, 0xbfb8aa3b, v34
    v_lshlrev_b32 v16, 4, v0
    v_add_u32 v16, 135168, v16
    ds_write_b128 v16, v[32:35]
    s_waitcnt lgkmcnt(0)
    v_mov_b32 v32, 0
    v_mov_b32 v33, 0
    v_mov_b32 v34, 0
    v_mov_b32 v35, 0
    v_mov_b32 v36, 0
    v_mov_b32 v37, 0
    v_mov_b32 v38, 0
    v_mov_b32 v39, 0
    v_mov_b32 v40, 0
    v_mov_b32 v41, 0
    v_mov_b32 v42, 0
    v_mov_b32 v43, 0
    v_mov_b32 v44, 0
    v_mov_b32 v45, 0
    v_mov_b32 v46, 0
    v_mov_b32 v47, 0
    v_mov_b32 v48, 0
    v_mov_b32 v49, 0
    v_mov_b32 v50, 0
    v_mov_b32 v51, 0
    v_mov_b32 v52, 0
    v_mov_b32 v53, 0
    v_mov_b32 v54, 0
    v_mov_b32 v55, 0
    v_mov_b32 v56, 0
    v_mov_b32 v57, 0
    v_mov_b32 v58, 0
    v_mov_b32 v59, 0
    v_mov_b32 v60, 0
    v_mov_b32 v61, 0
    v_mov_b32 v62, 0
    v_mov_b32 v63, 0
    v_mov_b32 v64, 0
    v_mov_b32 v65, 0
    v_mov_b32 v66, 0
    v_mov_b32 v67, 0
    v_mov_b32 v68, 0
    v_mov_b32 v69, 0
    v_mov_b32 v70, 0
    v_mov_b32 v71, 0
    v_mov_b32 v72, 0
    v_mov_b32 v73, 0
    v_mov_b32 v74, 0
    v_mov_b32 v75, 0
    v_mov_b32 v76, 0
    v_mov_b32 v77, 0
    v_mov_b32 v78, 0
    v_mov_b32 v79, 0
    v_mov_b32 v80, 0
    v_mov_b32 v81, 0
    v_mov_b32 v82, 0
    v_mov_b32 v83, 0
    v_mov_b32 v84, 0
    v_mov_b32 v85, 0
    v_mov_b32 v86, 0
    v_mov_b32 v87, 0
    v_mov_b32 v88, 0
    v_mov_b32 v89, 0
    v_mov_b32 v90, 0
    v_mov_b32 v91, 0
    v_mov_b32 v92, 0
    v_mov_b32 v93, 0
    v_mov_b32 v94, 0
    v_mov_b32 v95, 0
    v_mov_b32 v96, 0
    v_mov_b32 v97, 0
    v_mov_b32 v98, 0
    v_mov_b32 v99, 0
    v_mov_b32 v100, 0
    v_mov_b32 v101, 0
    v_mov_b32 v102, 0
    v_mov_b32 v103, 0
    v_mov_b32 v104, 0
    v_mov_b32 v105, 0
    v_mov_b32 v106, 0
    v_mov_b32 v107, 0
    v_mov_b32 v108, 0
    v_mov_b32 v109, 0
    v_mov_b32 v110, 0
    v_mov_b32 v111, 0
    v_mov_b32 v112, 0
    v_mov_b32 v113, 0
    v_mov_b32 v114, 0
    v_mov_b32 v115, 0
    v_mov_b32 v116, 0
    v_mov_b32 v117, 0
    v_mov_b32 v118, 0
    v_mov_b32 v119, 0
    v_mov_b32 v120, 0
    v_mov_b32 v121, 0
    v_mov_b32 v122, 0
    v_mov_b32 v123, 0
    v_mov_b32 v124, 0
    v_mov_b32 v125, 0
    v_mov_b32 v126, 0
    v_mov_b32 v127, 0
    v_mov_b32 v128, 0
    v_mov_b32 v129, 0
    v_mov_b32 v130, 0
    v_mov_b32 v131, 0
    v_mov_b32 v132, 0
    v_mov_b32 v133, 0
    v_mov_b32 v134, 0
    v_mov_b32 v135, 0
    v_mov_b32 v136, 0
    v_mov_b32 v137, 0
    v_mov_b32 v138, 0
    v_mov_b32 v139, 0
    v_mov_b32 v140, 0
    v_mov_b32 v141, 0
    v_mov_b32 v142, 0
    v_mov_b32 v143, 0
    v_mov_b32 v144, 0
    v_mov_b32 v145, 0
    v_mov_b32 v146, 0
    v_mov_b32 v147, 0
    v_mov_b32 v148, 0
    v_mov_b32 v149, 0
    v_mov_b32 v150, 0
    v_mov_b32 v151, 0
    v_mov_b32 v152, 0
    v_mov_b32 v153, 0
    v_mov_b32 v154, 0
    v_mov_b32 v155, 0
    v_mov_b32 v156, 0
    v_mov_b32 v157, 0
    v_mov_b32 v158, 0
    v_mov_b32 v159, 0
    v_mov_b32 v160, 0
    v_mov_b32 v161, 0
    v_mov_b32 v162, 0
    v_mov_b32 v163, 0
    v_mov_b32 v164, 0
    v_mov_b32 v165, 0
    v_mov_b32 v166, 0
    v_mov_b32 v167, 0
    v_mov_b32 v168, 0
    v_mov_b32 v169, 0
    v_mov_b32 v170, 0
    v_mov_b32 v171, 0
    v_mov_b32 v172, 0
    v_mov_b32 v173, 0
    v_mov_b32 v174, 0
    v_mov_b32 v175, 0
    v_mov_b32 v176, 0
    v_mov_b32 v177, 0
    v_mov_b32 v178, 0
    v_mov_b32 v179, 0
    v_mov_b32 v180, 0
    v_mov_b32 v181, 0
    v_mov_b32 v182, 0
    v_mov_b32 v183, 0
    v_mov_b32 v184, 0
    v_mov_b32 v185, 0
    v_mov_b32 v186, 0
    v_mov_b32 v187, 0
    v_mov_b32 v188, 0
    v_mov_b32 v189, 0
    v_mov_b32 v190, 0
    v_mov_b32 v191, 0
    v_mov_b32 v192, 0
    v_mov_b32 v193, 0
    v_mov_b32 v194, 0
    v_mov_b32 v195, 0
    v_mov_b32 v196, 0
    v_mov_b32 v197, 0
    v_mov_b32 v198, 0
    v_mov_b32 v199, 0
    v_mov_b32 v200, 0
    v_mov_b32 v201, 0
    v_mov_b32 v202, 0
    v_mov_b32 v203, 0
    v_mov_b32 v204, 0
    v_mov_b32 v205, 0
    v_mov_b32 v206, 0
    v_mov_b32 v207, 0
    v_mov_b32 v208, 0
    v_mov_b32 v209, 0
    v_mov_b32 v210, 0
    v_mov_b32 v211, 0
    v_mov_b32 v212, 0
    v_mov_b32 v213, 0
    v_mov_b32 v214, 0
    v_mov_b32 v215, 0
    v_mov_b32 v216, 0
    v_mov_b32 v217, 0
    v_mov_b32 v218, 0
    v_mov_b32 v219, 0
    v_mov_b32 v220, 0
    v_mov_b32 v221, 0
    v_mov_b32 v222, 0
    v_mov_b32 v223, 0
    v_mov_b32 v224, 0
    v_mov_b32 v225, 0
    v_mov_b32 v226, 0
    v_mov_b32 v227, 0
    v_mov_b32 v228, 0
    v_mov_b32 v229, 0
    v_mov_b32 v230, 0
    v_mov_b32 v231, 0
    v_mov_b32 v232, 0
    v_mov_b32 v233, 0
    v_mov_b32 v234, 0
    v_mov_b32 v235, 0
    v_mov_b32 v236, 0
    v_mov_b32 v237, 0
    v_mov_b32 v238, 0
    v_mov_b32 v239, 0
    v_mov_b32 v240, 0
    v_mov_b32 v241, 0
    v_mov_b32 v242, 0
    v_mov_b32 v243, 0
    v_mov_b32 v244, 0
    v_mov_b32 v245, 0
    v_mov_b32 v246, 0
    v_mov_b32 v247, 0
    v_mov_b32 v248, 0
    v_mov_b32 v249, 0
    v_mov_b32 v250, 0
    v_mov_b32 v251, 0
    v_mov_b32 v252, 0
    v_mov_b32 v253, 0
    v_mov_b32 v254, 0
    v_mov_b32 v255, 0
    s_mov_b32 s48, 3
.p2align 6
gu2_kernel_loop:
    s_waitcnt lgkmcnt(0)
    s_waitcnt vmcnt(16)
    s_barrier
    v_mfma_f32_16x16x32_bf16 v[32:35], a[0:3], a[128:131], v[32:35]
    ds_read_b64_tr_b16 a[64:65], v10 offset:16896
    v_mfma_f32_16x16x32_bf16 v[36:39], a[0:3], a[132:135], v[36:39]
    ds_read_b64_tr_b16 a[66:67], v10 offset:17408
    s_add_u32 m0, s22, 67584
    s_nop 0
    buffer_load_dwordx4 v6, s[32:35], s25 offen offset:0 lds
    v_mfma_f32_16x16x32_bf16 v[40:43], a[0:3], a[136:139], v[40:43]
    v_mfma_f32_16x16x32_bf16 v[44:47], a[0:3], a[140:143], v[44:47]
    ds_read_b64_tr_b16 a[68:69], v10 offset:16928
    v_mfma_f32_16x16x32_bf16 v[48:51], a[4:7], a[128:131], v[48:51]
    ds_read_b64_tr_b16 a[70:71], v10 offset:17440
    v_mfma_f32_16x16x32_bf16 v[52:55], a[4:7], a[132:135], v[52:55]
    v_mfma_f32_16x16x32_bf16 v[56:59], a[4:7], a[136:139], v[56:59]
    ds_read_b64_tr_b16 a[72:73], v10 offset:25344
    v_mfma_f32_16x16x32_bf16 v[60:63], a[4:7], a[140:143], v[60:63]
    ds_read_b64_tr_b16 a[74:75], v10 offset:25856
    buffer_load_dwordx4 a[176:179], v4, s[28:31], s23 offen offset:0
    v_mfma_f32_16x16x32_bf16 v[64:67], a[8:11], a[128:131], v[64:67]
    v_mfma_f32_16x16x32_bf16 v[68:71], a[8:11], a[132:135], v[68:71]
    ds_read_b64_tr_b16 a[76:77], v10 offset:25376
    v_mfma_f32_16x16x32_bf16 v[72:75], a[8:11], a[136:139], v[72:75]
    ds_read_b64_tr_b16 a[78:79], v10 offset:25888
    v_mfma_f32_16x16x32_bf16 v[76:79], a[8:11], a[140:143], v[76:79]
    v_mfma_f32_16x16x32_bf16 v[80:83], a[12:15], a[128:131], v[80:83]
    ds_read_b64_tr_b16 a[80:81], v10 offset:16960
    v_mfma_f32_16x16x32_bf16 v[84:87], a[12:15], a[132:135], v[84:87]
    v_mfma_f32_16x16x32_bf16 v[88:91], a[12:15], a[136:139], v[88:91]
    ds_read_b64_tr_b16 a[82:83], v10 offset:17472
    buffer_load_dwordx4 v7, s[32:35], s25 offen offset:1056 lds
    v_mfma_f32_16x16x32_bf16 v[92:95], a[12:15], a[140:143], v[92:95]
    ds_read_b64_tr_b16 a[84:85], v10 offset:16992
    v_mfma_f32_16x16x32_bf16 v[96:99], a[16:19], a[128:131], v[96:99]
    v_mfma_f32_16x16x32_bf16 v[100:103], a[16:19], a[132:135], v[100:103]
    ds_read_b64_tr_b16 a[86:87], v10 offset:17504
    v_mfma_f32_16x16x32_bf16 v[104:107], a[16:19], a[136:139], v[104:107]
    ds_read_b64_tr_b16 a[88:89], v10 offset:25408
    v_mfma_f32_16x16x32_bf16 v[108:111], a[16:19], a[140:143], v[108:111]
    v_mfma_f32_16x16x32_bf16 v[112:115], a[20:23], a[128:131], v[112:115]
    ds_read_b64_tr_b16 a[90:91], v10 offset:25920
    v_mfma_f32_16x16x32_bf16 v[116:119], a[20:23], a[132:135], v[116:119]
    ds_read_b64_tr_b16 a[92:93], v10 offset:25440
    buffer_load_dwordx4 a[180:183], v4, s[28:31], s23 offen offset:1024
    v_mfma_f32_16x16x32_bf16 v[120:123], a[20:23], a[136:139], v[120:123]
    v_mfma_f32_16x16x32_bf16 v[124:127], a[20:23], a[140:143], v[124:127]
    ds_read_b64_tr_b16 a[94:95], v10 offset:25952
    v_mfma_f32_16x16x32_bf16 v[128:131], a[24:27], a[128:131], v[128:131]
    v_mfma_f32_16x16x32_bf16 v[132:135], a[24:27], a[132:135], v[132:135]
    ds_read_b64_tr_b16 a[96:97], v10 offset:17024
    v_mfma_f32_16x16x32_bf16 v[136:139], a[24:27], a[136:139], v[136:139]
    ds_read_b64_tr_b16 a[98:99], v10 offset:17536
    v_mfma_f32_16x16x32_bf16 v[140:143], a[24:27], a[140:143], v[140:143]
    v_mfma_f32_16x16x32_bf16 v[144:147], a[28:31], a[128:131], v[144:147]
    ds_read_b64_tr_b16 a[100:101], v10 offset:17056
    buffer_load_dwordx4 v8, s[32:35], s25 offen offset:2112 lds
    v_mfma_f32_16x16x32_bf16 v[148:151], a[28:31], a[132:135], v[148:151]
    ds_read_b64_tr_b16 a[102:103], v10 offset:17568
    v_mfma_f32_16x16x32_bf16 v[152:155], a[28:31], a[136:139], v[152:155]
    v_mfma_f32_16x16x32_bf16 v[156:159], a[28:31], a[140:143], v[156:159]
    ds_read_b64_tr_b16 a[104:105], v10 offset:25472
    v_mfma_f32_16x16x32_bf16 v[160:163], a[32:35], a[128:131], v[160:163]
    ds_read_b64_tr_b16 a[106:107], v10 offset:25984
    v_mfma_f32_16x16x32_bf16 v[164:167], a[32:35], a[132:135], v[164:167]
    v_mfma_f32_16x16x32_bf16 v[168:171], a[32:35], a[136:139], v[168:171]
    ds_read_b64_tr_b16 a[108:109], v10 offset:25504
    v_mfma_f32_16x16x32_bf16 v[172:175], a[32:35], a[140:143], v[172:175]
    ds_read_b64_tr_b16 a[110:111], v10 offset:26016
    buffer_load_dwordx4 a[184:187], v5, s[28:31], s23 offen offset:0
    v_mfma_f32_16x16x32_bf16 v[176:179], a[36:39], a[128:131], v[176:179]
    v_mfma_f32_16x16x32_bf16 v[180:183], a[36:39], a[132:135], v[180:183]
    ds_read_b64_tr_b16 a[112:113], v12 offset:16896
    v_mfma_f32_16x16x32_bf16 v[184:187], a[36:39], a[136:139], v[184:187]
    v_mfma_f32_16x16x32_bf16 v[188:191], a[36:39], a[140:143], v[188:191]
    ds_read_b64_tr_b16 a[114:115], v12 offset:17408
    v_mfma_f32_16x16x32_bf16 v[192:195], a[40:43], a[128:131], v[192:195]
    ds_read_b64_tr_b16 a[116:117], v12 offset:16928
    v_mfma_f32_16x16x32_bf16 v[196:199], a[40:43], a[132:135], v[196:199]
    v_mfma_f32_16x16x32_bf16 v[200:203], a[40:43], a[136:139], v[200:203]
    ds_read_b64_tr_b16 a[118:119], v12 offset:17440
    buffer_load_dwordx4 v9, s[32:35], s25 offen offset:3168 lds
    s_add_u32 s25, s25, 229376
    v_mfma_f32_16x16x32_bf16 v[204:207], a[40:43], a[140:143], v[204:207]
    ds_read_b64_tr_b16 a[120:121], v12 offset:25344
    v_mfma_f32_16x16x32_bf16 v[208:211], a[44:47], a[128:131], v[208:211]
    v_mfma_f32_16x16x32_bf16 v[212:215], a[44:47], a[132:135], v[212:215]
    ds_read_b64_tr_b16 a[122:123], v12 offset:25856
    v_mfma_f32_16x16x32_bf16 v[216:219], a[44:47], a[136:139], v[216:219]
    ds_read_b64_tr_b16 a[124:125], v12 offset:25376
    v_mfma_f32_16x16x32_bf16 v[220:223], a[44:47], a[140:143], v[220:223]
    v_mfma_f32_16x16x32_bf16 v[224:227], a[48:51], a[128:131], v[224:227]
    ds_read_b64_tr_b16 a[126:127], v12 offset:25888
    v_mfma_f32_16x16x32_bf16 v[228:231], a[48:51], a[132:135], v[228:231]
    buffer_load_dwordx4 a[188:191], v5, s[28:31], s23 offen offset:1024
    s_add_u32 s23, s23, 0x20000
    v_mfma_f32_16x16x32_bf16 v[232:235], a[52:55], a[128:131], v[232:235]
    v_mfma_f32_16x16x32_bf16 v[236:239], a[52:55], a[132:135], v[236:239]
    v_mfma_f32_16x16x32_bf16 v[240:243], a[56:59], a[128:131], v[240:243]
    v_mfma_f32_16x16x32_bf16 v[244:247], a[56:59], a[132:135], v[244:247]
    v_mfma_f32_16x16x32_bf16 v[248:251], a[60:63], a[128:131], v[248:251]
    v_mfma_f32_16x16x32_bf16 v[252:255], a[60:63], a[132:135], v[252:255]
    s_waitcnt lgkmcnt(0)
    s_waitcnt vmcnt(16)
    s_barrier
    v_mfma_f32_16x16x32_bf16 v[32:35], a[64:67], a[144:147], v[32:35]
    ds_read_b64_tr_b16 a[0:1], v10 offset:33792
    v_mfma_f32_16x16x32_bf16 v[36:39], a[64:67], a[148:151], v[36:39]
    ds_read_b64_tr_b16 a[2:3], v10 offset:34304
    s_add_u32 m0, s22, 84480
    s_nop 0
    buffer_load_dwordx4 v6, s[32:35], s25 offen offset:0 lds
    v_mfma_f32_16x16x32_bf16 v[40:43], a[64:67], a[152:155], v[40:43]
    v_mfma_f32_16x16x32_bf16 v[44:47], a[64:67], a[156:159], v[44:47]
    ds_read_b64_tr_b16 a[4:5], v10 offset:33824
    v_mfma_f32_16x16x32_bf16 v[48:51], a[68:71], a[144:147], v[48:51]
    ds_read_b64_tr_b16 a[6:7], v10 offset:34336
    v_mfma_f32_16x16x32_bf16 v[52:55], a[68:71], a[148:151], v[52:55]
    v_mfma_f32_16x16x32_bf16 v[56:59], a[68:71], a[152:155], v[56:59]
    ds_read_b64_tr_b16 a[8:9], v10 offset:42240
    v_mfma_f32_16x16x32_bf16 v[60:63], a[68:71], a[156:159], v[60:63]
    ds_read_b64_tr_b16 a[10:11], v10 offset:42752
    buffer_load_dwordx4 a[128:131], v4, s[28:31], s23 offen offset:0
    v_mfma_f32_16x16x32_bf16 v[64:67], a[72:75], a[144:147], v[64:67]
    v_mfma_f32_16x16x32_bf16 v[68:71], a[72:75], a[148:151], v[68:71]
    ds_read_b64_tr_b16 a[12:13], v10 offset:42272
    v_mfma_f32_16x16x32_bf16 v[72:75], a[72:75], a[152:155], v[72:75]
    ds_read_b64_tr_b16 a[14:15], v10 offset:42784
    v_mfma_f32_16x16x32_bf16 v[76:79], a[72:75], a[156:159], v[76:79]
    v_mfma_f32_16x16x32_bf16 v[80:83], a[76:79], a[144:147], v[80:83]
    ds_read_b64_tr_b16 a[16:17], v10 offset:33856
    v_mfma_f32_16x16x32_bf16 v[84:87], a[76:79], a[148:151], v[84:87]
    v_mfma_f32_16x16x32_bf16 v[88:91], a[76:79], a[152:155], v[88:91]
    ds_read_b64_tr_b16 a[18:19], v10 offset:34368
    buffer_load_dwordx4 v7, s[32:35], s25 offen offset:1056 lds
    v_mfma_f32_16x16x32_bf16 v[92:95], a[76:79], a[156:159], v[92:95]
    ds_read_b64_tr_b16 a[20:21], v10 offset:33888
    v_mfma_f32_16x16x32_bf16 v[96:99], a[80:83], a[144:147], v[96:99]
    v_mfma_f32_16x16x32_bf16 v[100:103], a[80:83], a[148:151], v[100:103]
    ds_read_b64_tr_b16 a[22:23], v10 offset:34400
    v_mfma_f32_16x16x32_bf16 v[104:107], a[80:83], a[152:155], v[104:107]
    ds_read_b64_tr_b16 a[24:25], v10 offset:42304
    v_mfma_f32_16x16x32_bf16 v[108:111], a[80:83], a[156:159], v[108:111]
    v_mfma_f32_16x16x32_bf16 v[112:115], a[84:87], a[144:147], v[112:115]
    ds_read_b64_tr_b16 a[26:27], v10 offset:42816
    v_mfma_f32_16x16x32_bf16 v[116:119], a[84:87], a[148:151], v[116:119]
    ds_read_b64_tr_b16 a[28:29], v10 offset:42336
    buffer_load_dwordx4 a[132:135], v4, s[28:31], s23 offen offset:1024
    v_mfma_f32_16x16x32_bf16 v[120:123], a[84:87], a[152:155], v[120:123]
    v_mfma_f32_16x16x32_bf16 v[124:127], a[84:87], a[156:159], v[124:127]
    ds_read_b64_tr_b16 a[30:31], v10 offset:42848
    v_mfma_f32_16x16x32_bf16 v[128:131], a[88:91], a[144:147], v[128:131]
    v_mfma_f32_16x16x32_bf16 v[132:135], a[88:91], a[148:151], v[132:135]
    ds_read_b64_tr_b16 a[32:33], v10 offset:33920
    v_mfma_f32_16x16x32_bf16 v[136:139], a[88:91], a[152:155], v[136:139]
    ds_read_b64_tr_b16 a[34:35], v10 offset:34432
    v_mfma_f32_16x16x32_bf16 v[140:143], a[88:91], a[156:159], v[140:143]
    v_mfma_f32_16x16x32_bf16 v[144:147], a[92:95], a[144:147], v[144:147]
    ds_read_b64_tr_b16 a[36:37], v10 offset:33952
    buffer_load_dwordx4 v8, s[32:35], s25 offen offset:2112 lds
    v_mfma_f32_16x16x32_bf16 v[148:151], a[92:95], a[148:151], v[148:151]
    ds_read_b64_tr_b16 a[38:39], v10 offset:34464
    v_mfma_f32_16x16x32_bf16 v[152:155], a[92:95], a[152:155], v[152:155]
    v_mfma_f32_16x16x32_bf16 v[156:159], a[92:95], a[156:159], v[156:159]
    ds_read_b64_tr_b16 a[40:41], v10 offset:42368
    v_mfma_f32_16x16x32_bf16 v[160:163], a[96:99], a[144:147], v[160:163]
    ds_read_b64_tr_b16 a[42:43], v10 offset:42880
    v_mfma_f32_16x16x32_bf16 v[164:167], a[96:99], a[148:151], v[164:167]
    v_mfma_f32_16x16x32_bf16 v[168:171], a[96:99], a[152:155], v[168:171]
    ds_read_b64_tr_b16 a[44:45], v10 offset:42400
    v_mfma_f32_16x16x32_bf16 v[172:175], a[96:99], a[156:159], v[172:175]
    ds_read_b64_tr_b16 a[46:47], v10 offset:42912
    buffer_load_dwordx4 a[136:139], v5, s[28:31], s23 offen offset:0
    v_mfma_f32_16x16x32_bf16 v[176:179], a[100:103], a[144:147], v[176:179]
    v_mfma_f32_16x16x32_bf16 v[180:183], a[100:103], a[148:151], v[180:183]
    ds_read_b64_tr_b16 a[48:49], v12 offset:33792
    v_mfma_f32_16x16x32_bf16 v[184:187], a[100:103], a[152:155], v[184:187]
    v_mfma_f32_16x16x32_bf16 v[188:191], a[100:103], a[156:159], v[188:191]
    ds_read_b64_tr_b16 a[50:51], v12 offset:34304
    v_mfma_f32_16x16x32_bf16 v[192:195], a[104:107], a[144:147], v[192:195]
    ds_read_b64_tr_b16 a[52:53], v12 offset:33824
    v_mfma_f32_16x16x32_bf16 v[196:199], a[104:107], a[148:151], v[196:199]
    v_mfma_f32_16x16x32_bf16 v[200:203], a[104:107], a[152:155], v[200:203]
    ds_read_b64_tr_b16 a[54:55], v12 offset:34336
    buffer_load_dwordx4 v9, s[32:35], s25 offen offset:3168 lds
    s_add_u32 s25, s25, 229376
    v_mfma_f32_16x16x32_bf16 v[204:207], a[104:107], a[156:159], v[204:207]
    ds_read_b64_tr_b16 a[56:57], v12 offset:42240
    v_mfma_f32_16x16x32_bf16 v[208:211], a[108:111], a[144:147], v[208:211]
    v_mfma_f32_16x16x32_bf16 v[212:215], a[108:111], a[148:151], v[212:215]
    ds_read_b64_tr_b16 a[58:59], v12 offset:42752
    v_mfma_f32_16x16x32_bf16 v[216:219], a[108:111], a[152:155], v[216:219]
    ds_read_b64_tr_b16 a[60:61], v12 offset:42272
    v_mfma_f32_16x16x32_bf16 v[220:223], a[108:111], a[156:159], v[220:223]
    v_mfma_f32_16x16x32_bf16 v[224:227], a[112:115], a[144:147], v[224:227]
    ds_read_b64_tr_b16 a[62:63], v12 offset:42784
    v_mfma_f32_16x16x32_bf16 v[228:231], a[112:115], a[148:151], v[228:231]
    buffer_load_dwordx4 a[140:143], v5, s[28:31], s23 offen offset:1024
    s_add_u32 s23, s23, 0x20000
    v_mfma_f32_16x16x32_bf16 v[232:235], a[116:119], a[144:147], v[232:235]
    v_mfma_f32_16x16x32_bf16 v[236:239], a[116:119], a[148:151], v[236:239]
    v_mfma_f32_16x16x32_bf16 v[240:243], a[120:123], a[144:147], v[240:243]
    v_mfma_f32_16x16x32_bf16 v[244:247], a[120:123], a[148:151], v[244:247]
    v_mfma_f32_16x16x32_bf16 v[248:251], a[124:127], a[144:147], v[248:251]
    v_mfma_f32_16x16x32_bf16 v[252:255], a[124:127], a[148:151], v[252:255]
    s_waitcnt lgkmcnt(0)
    s_waitcnt vmcnt(16)
    s_barrier
    v_mfma_f32_16x16x32_bf16 v[32:35], a[0:3], a[160:163], v[32:35]
    ds_read_b64_tr_b16 a[64:65], v10 offset:50688
    v_mfma_f32_16x16x32_bf16 v[36:39], a[0:3], a[164:167], v[36:39]
    ds_read_b64_tr_b16 a[66:67], v10 offset:51200
    s_add_u32 m0, s22, 101376
    s_nop 0
    buffer_load_dwordx4 v6, s[32:35], s25 offen offset:0 lds
    v_mfma_f32_16x16x32_bf16 v[40:43], a[0:3], a[168:171], v[40:43]
    v_mfma_f32_16x16x32_bf16 v[44:47], a[0:3], a[172:175], v[44:47]
    ds_read_b64_tr_b16 a[68:69], v10 offset:50720
    v_mfma_f32_16x16x32_bf16 v[48:51], a[4:7], a[160:163], v[48:51]
    ds_read_b64_tr_b16 a[70:71], v10 offset:51232
    v_mfma_f32_16x16x32_bf16 v[52:55], a[4:7], a[164:167], v[52:55]
    v_mfma_f32_16x16x32_bf16 v[56:59], a[4:7], a[168:171], v[56:59]
    ds_read_b64_tr_b16 a[72:73], v10 offset:59136
    v_mfma_f32_16x16x32_bf16 v[60:63], a[4:7], a[172:175], v[60:63]
    ds_read_b64_tr_b16 a[74:75], v10 offset:59648
    buffer_load_dwordx4 a[144:147], v4, s[28:31], s23 offen offset:0
    v_mfma_f32_16x16x32_bf16 v[64:67], a[8:11], a[160:163], v[64:67]
    v_mfma_f32_16x16x32_bf16 v[68:71], a[8:11], a[164:167], v[68:71]
    ds_read_b64_tr_b16 a[76:77], v10 offset:59168
    v_mfma_f32_16x16x32_bf16 v[72:75], a[8:11], a[168:171], v[72:75]
    ds_read_b64_tr_b16 a[78:79], v10 offset:59680
    v_mfma_f32_16x16x32_bf16 v[76:79], a[8:11], a[172:175], v[76:79]
    v_mfma_f32_16x16x32_bf16 v[80:83], a[12:15], a[160:163], v[80:83]
    ds_read_b64_tr_b16 a[80:81], v10 offset:50752
    v_mfma_f32_16x16x32_bf16 v[84:87], a[12:15], a[164:167], v[84:87]
    v_mfma_f32_16x16x32_bf16 v[88:91], a[12:15], a[168:171], v[88:91]
    ds_read_b64_tr_b16 a[82:83], v10 offset:51264
    buffer_load_dwordx4 v7, s[32:35], s25 offen offset:1056 lds
    v_mfma_f32_16x16x32_bf16 v[92:95], a[12:15], a[172:175], v[92:95]
    ds_read_b64_tr_b16 a[84:85], v10 offset:50784
    v_mfma_f32_16x16x32_bf16 v[96:99], a[16:19], a[160:163], v[96:99]
    v_mfma_f32_16x16x32_bf16 v[100:103], a[16:19], a[164:167], v[100:103]
    ds_read_b64_tr_b16 a[86:87], v10 offset:51296
    v_mfma_f32_16x16x32_bf16 v[104:107], a[16:19], a[168:171], v[104:107]
    ds_read_b64_tr_b16 a[88:89], v10 offset:59200
    v_mfma_f32_16x16x32_bf16 v[108:111], a[16:19], a[172:175], v[108:111]
    v_mfma_f32_16x16x32_bf16 v[112:115], a[20:23], a[160:163], v[112:115]
    ds_read_b64_tr_b16 a[90:91], v10 offset:59712
    v_mfma_f32_16x16x32_bf16 v[116:119], a[20:23], a[164:167], v[116:119]
    ds_read_b64_tr_b16 a[92:93], v10 offset:59232
    buffer_load_dwordx4 a[148:151], v4, s[28:31], s23 offen offset:1024
    v_mfma_f32_16x16x32_bf16 v[120:123], a[20:23], a[168:171], v[120:123]
    v_mfma_f32_16x16x32_bf16 v[124:127], a[20:23], a[172:175], v[124:127]
    ds_read_b64_tr_b16 a[94:95], v10 offset:59744
    v_mfma_f32_16x16x32_bf16 v[128:131], a[24:27], a[160:163], v[128:131]
    v_mfma_f32_16x16x32_bf16 v[132:135], a[24:27], a[164:167], v[132:135]
    ds_read_b64_tr_b16 a[96:97], v10 offset:50816
    v_mfma_f32_16x16x32_bf16 v[136:139], a[24:27], a[168:171], v[136:139]
    ds_read_b64_tr_b16 a[98:99], v10 offset:51328
    v_mfma_f32_16x16x32_bf16 v[140:143], a[24:27], a[172:175], v[140:143]
    v_mfma_f32_16x16x32_bf16 v[144:147], a[28:31], a[160:163], v[144:147]
    ds_read_b64_tr_b16 a[100:101], v10 offset:50848
    buffer_load_dwordx4 v8, s[32:35], s25 offen offset:2112 lds
    v_mfma_f32_16x16x32_bf16 v[148:151], a[28:31], a[164:167], v[148:151]
    ds_read_b64_tr_b16 a[102:103], v10 offset:51360
    v_mfma_f32_16x16x32_bf16 v[152:155], a[28:31], a[168:171], v[152:155]
    v_mfma_f32_16x16x32_bf16 v[156:159], a[28:31], a[172:175], v[156:159]
    ds_read_b64_tr_b16 a[104:105], v10 offset:59264
    v_mfma_f32_16x16x32_bf16 v[160:163], a[32:35], a[160:163], v[160:163]
    ds_read_b64_tr_b16 a[106:107], v10 offset:59776
    v_mfma_f32_16x16x32_bf16 v[164:167], a[32:35], a[164:167], v[164:167]
    v_mfma_f32_16x16x32_bf16 v[168:171], a[32:35], a[168:171], v[168:171]
    ds_read_b64_tr_b16 a[108:109], v10 offset:59296
    v_mfma_f32_16x16x32_bf16 v[172:175], a[32:35], a[172:175], v[172:175]
    ds_read_b64_tr_b16 a[110:111], v10 offset:59808
    buffer_load_dwordx4 a[152:155], v5, s[28:31], s23 offen offset:0
    v_mfma_f32_16x16x32_bf16 v[176:179], a[36:39], a[160:163], v[176:179]
    v_mfma_f32_16x16x32_bf16 v[180:183], a[36:39], a[164:167], v[180:183]
    ds_read_b64_tr_b16 a[112:113], v12 offset:50688
    v_mfma_f32_16x16x32_bf16 v[184:187], a[36:39], a[168:171], v[184:187]
    v_mfma_f32_16x16x32_bf16 v[188:191], a[36:39], a[172:175], v[188:191]
    ds_read_b64_tr_b16 a[114:115], v12 offset:51200
    v_mfma_f32_16x16x32_bf16 v[192:195], a[40:43], a[160:163], v[192:195]
    ds_read_b64_tr_b16 a[116:117], v12 offset:50720
    v_mfma_f32_16x16x32_bf16 v[196:199], a[40:43], a[164:167], v[196:199]
    v_mfma_f32_16x16x32_bf16 v[200:203], a[40:43], a[168:171], v[200:203]
    ds_read_b64_tr_b16 a[118:119], v12 offset:51232
    buffer_load_dwordx4 v9, s[32:35], s25 offen offset:3168 lds
    s_add_u32 s25, s25, 229376
    v_mfma_f32_16x16x32_bf16 v[204:207], a[40:43], a[172:175], v[204:207]
    ds_read_b64_tr_b16 a[120:121], v12 offset:59136
    v_mfma_f32_16x16x32_bf16 v[208:211], a[44:47], a[160:163], v[208:211]
    v_mfma_f32_16x16x32_bf16 v[212:215], a[44:47], a[164:167], v[212:215]
    ds_read_b64_tr_b16 a[122:123], v12 offset:59648
    v_mfma_f32_16x16x32_bf16 v[216:219], a[44:47], a[168:171], v[216:219]
    ds_read_b64_tr_b16 a[124:125], v12 offset:59168
    v_mfma_f32_16x16x32_bf16 v[220:223], a[44:47], a[172:175], v[220:223]
    v_mfma_f32_16x16x32_bf16 v[224:227], a[48:51], a[160:163], v[224:227]
    ds_read_b64_tr_b16 a[126:127], v12 offset:59680
    v_mfma_f32_16x16x32_bf16 v[228:231], a[48:51], a[164:167], v[228:231]
    buffer_load_dwordx4 a[156:159], v5, s[28:31], s23 offen offset:1024
    s_add_u32 s23, s23, 0x20000
    v_mfma_f32_16x16x32_bf16 v[232:235], a[52:55], a[160:163], v[232:235]
    v_mfma_f32_16x16x32_bf16 v[236:239], a[52:55], a[164:167], v[236:239]
    v_mfma_f32_16x16x32_bf16 v[240:243], a[56:59], a[160:163], v[240:243]
    v_mfma_f32_16x16x32_bf16 v[244:247], a[56:59], a[164:167], v[244:247]
    v_mfma_f32_16x16x32_bf16 v[248:251], a[60:63], a[160:163], v[248:251]
    v_mfma_f32_16x16x32_bf16 v[252:255], a[60:63], a[164:167], v[252:255]
    s_waitcnt lgkmcnt(0)
    s_waitcnt vmcnt(17)
    s_barrier
    v_mfma_f32_16x16x32_bf16 v[32:35], a[64:67], a[176:179], v[32:35]
    ds_read_b64_tr_b16 a[0:1], v11 offset:0
    v_mfma_f32_16x16x32_bf16 v[36:39], a[64:67], a[180:183], v[36:39]
    ds_read_b64_tr_b16 a[2:3], v11 offset:512
    s_add_u32 m0, s22, 118272
    s_nop 0
    buffer_load_dwordx4 v6, s[32:35], s25 offen offset:0 lds
    v_mfma_f32_16x16x32_bf16 v[40:43], a[64:67], a[184:187], v[40:43]
    s_waitcnt vmcnt(17)
    v_mfma_f32_16x16x32_bf16 v[44:47], a[64:67], a[188:191], v[44:47]
    ds_read_b64_tr_b16 a[4:5], v11 offset:32
    v_mfma_f32_16x16x32_bf16 v[48:51], a[68:71], a[176:179], v[48:51]
    ds_read_b64_tr_b16 a[6:7], v11 offset:544
    v_mfma_f32_16x16x32_bf16 v[52:55], a[68:71], a[180:183], v[52:55]
    v_mfma_f32_16x16x32_bf16 v[56:59], a[68:71], a[184:187], v[56:59]
    ds_read_b64_tr_b16 a[8:9], v11 offset:8448
    v_mfma_f32_16x16x32_bf16 v[60:63], a[68:71], a[188:191], v[60:63]
    ds_read_b64_tr_b16 a[10:11], v11 offset:8960
    buffer_load_dwordx4 a[160:163], v4, s[28:31], s23 offen offset:0
    v_mfma_f32_16x16x32_bf16 v[64:67], a[72:75], a[176:179], v[64:67]
    v_mfma_f32_16x16x32_bf16 v[68:71], a[72:75], a[180:183], v[68:71]
    ds_read_b64_tr_b16 a[12:13], v11 offset:8480
    v_mfma_f32_16x16x32_bf16 v[72:75], a[72:75], a[184:187], v[72:75]
    ds_read_b64_tr_b16 a[14:15], v11 offset:8992
    v_mfma_f32_16x16x32_bf16 v[76:79], a[72:75], a[188:191], v[76:79]
    v_mfma_f32_16x16x32_bf16 v[80:83], a[76:79], a[176:179], v[80:83]
    ds_read_b64_tr_b16 a[16:17], v11 offset:64
    v_mfma_f32_16x16x32_bf16 v[84:87], a[76:79], a[180:183], v[84:87]
    v_mfma_f32_16x16x32_bf16 v[88:91], a[76:79], a[184:187], v[88:91]
    ds_read_b64_tr_b16 a[18:19], v11 offset:576
    buffer_load_dwordx4 v7, s[32:35], s25 offen offset:1056 lds
    v_mfma_f32_16x16x32_bf16 v[92:95], a[76:79], a[188:191], v[92:95]
    ds_read_b64_tr_b16 a[20:21], v11 offset:96
    v_mfma_f32_16x16x32_bf16 v[96:99], a[80:83], a[176:179], v[96:99]
    v_mfma_f32_16x16x32_bf16 v[100:103], a[80:83], a[180:183], v[100:103]
    ds_read_b64_tr_b16 a[22:23], v11 offset:608
    v_mfma_f32_16x16x32_bf16 v[104:107], a[80:83], a[184:187], v[104:107]
    ds_read_b64_tr_b16 a[24:25], v11 offset:8512
    v_mfma_f32_16x16x32_bf16 v[108:111], a[80:83], a[188:191], v[108:111]
    v_mfma_f32_16x16x32_bf16 v[112:115], a[84:87], a[176:179], v[112:115]
    ds_read_b64_tr_b16 a[26:27], v11 offset:9024
    v_mfma_f32_16x16x32_bf16 v[116:119], a[84:87], a[180:183], v[116:119]
    ds_read_b64_tr_b16 a[28:29], v11 offset:8544
    buffer_load_dwordx4 a[164:167], v4, s[28:31], s23 offen offset:1024
    v_mfma_f32_16x16x32_bf16 v[120:123], a[84:87], a[184:187], v[120:123]
    v_mfma_f32_16x16x32_bf16 v[124:127], a[84:87], a[188:191], v[124:127]
    ds_read_b64_tr_b16 a[30:31], v11 offset:9056
    v_mfma_f32_16x16x32_bf16 v[128:131], a[88:91], a[176:179], v[128:131]
    v_mfma_f32_16x16x32_bf16 v[132:135], a[88:91], a[180:183], v[132:135]
    ds_read_b64_tr_b16 a[32:33], v11 offset:128
    v_mfma_f32_16x16x32_bf16 v[136:139], a[88:91], a[184:187], v[136:139]
    ds_read_b64_tr_b16 a[34:35], v11 offset:640
    v_mfma_f32_16x16x32_bf16 v[140:143], a[88:91], a[188:191], v[140:143]
    v_mfma_f32_16x16x32_bf16 v[144:147], a[92:95], a[176:179], v[144:147]
    ds_read_b64_tr_b16 a[36:37], v11 offset:160
    buffer_load_dwordx4 v8, s[32:35], s25 offen offset:2112 lds
    v_mfma_f32_16x16x32_bf16 v[148:151], a[92:95], a[180:183], v[148:151]
    ds_read_b64_tr_b16 a[38:39], v11 offset:672
    v_mfma_f32_16x16x32_bf16 v[152:155], a[92:95], a[184:187], v[152:155]
    v_mfma_f32_16x16x32_bf16 v[156:159], a[92:95], a[188:191], v[156:159]
    ds_read_b64_tr_b16 a[40:41], v11 offset:8576
    v_mfma_f32_16x16x32_bf16 v[160:163], a[96:99], a[176:179], v[160:163]
    ds_read_b64_tr_b16 a[42:43], v11 offset:9088
    v_mfma_f32_16x16x32_bf16 v[164:167], a[96:99], a[180:183], v[164:167]
    v_mfma_f32_16x16x32_bf16 v[168:171], a[96:99], a[184:187], v[168:171]
    ds_read_b64_tr_b16 a[44:45], v11 offset:8608
    v_mfma_f32_16x16x32_bf16 v[172:175], a[96:99], a[188:191], v[172:175]
    ds_read_b64_tr_b16 a[46:47], v11 offset:9120
    buffer_load_dwordx4 a[168:171], v5, s[28:31], s23 offen offset:0
    v_mfma_f32_16x16x32_bf16 v[176:179], a[100:103], a[176:179], v[176:179]
    v_mfma_f32_16x16x32_bf16 v[180:183], a[100:103], a[180:183], v[180:183]
    ds_read_b64_tr_b16 a[48:49], v13 offset:0
    v_mfma_f32_16x16x32_bf16 v[184:187], a[100:103], a[184:187], v[184:187]
    v_mfma_f32_16x16x32_bf16 v[188:191], a[100:103], a[188:191], v[188:191]
    ds_read_b64_tr_b16 a[50:51], v13 offset:512
    v_mfma_f32_16x16x32_bf16 v[192:195], a[104:107], a[176:179], v[192:195]
    ds_read_b64_tr_b16 a[52:53], v13 offset:32
    v_mfma_f32_16x16x32_bf16 v[196:199], a[104:107], a[180:183], v[196:199]
    v_mfma_f32_16x16x32_bf16 v[200:203], a[104:107], a[184:187], v[200:203]
    ds_read_b64_tr_b16 a[54:55], v13 offset:544
    buffer_load_dwordx4 v9, s[32:35], s25 offen offset:3168 lds
    s_add_u32 s25, s25, 229376
    v_mfma_f32_16x16x32_bf16 v[204:207], a[104:107], a[188:191], v[204:207]
    ds_read_b64_tr_b16 a[56:57], v13 offset:8448
    v_mfma_f32_16x16x32_bf16 v[208:211], a[108:111], a[176:179], v[208:211]
    v_mfma_f32_16x16x32_bf16 v[212:215], a[108:111], a[180:183], v[212:215]
    ds_read_b64_tr_b16 a[58:59], v13 offset:8960
    v_mfma_f32_16x16x32_bf16 v[216:219], a[108:111], a[184:187], v[216:219]
    ds_read_b64_tr_b16 a[60:61], v13 offset:8480
    v_mfma_f32_16x16x32_bf16 v[220:223], a[108:111], a[188:191], v[220:223]
    v_mfma_f32_16x16x32_bf16 v[224:227], a[112:115], a[176:179], v[224:227]
    ds_read_b64_tr_b16 a[62:63], v13 offset:8992
    v_mfma_f32_16x16x32_bf16 v[228:231], a[112:115], a[180:183], v[228:231]
    buffer_load_dwordx4 a[172:175], v5, s[28:31], s23 offen offset:1024
    s_add_u32 s23, s23, 0x20000
    v_mfma_f32_16x16x32_bf16 v[232:235], a[116:119], a[176:179], v[232:235]
    v_mfma_f32_16x16x32_bf16 v[236:239], a[116:119], a[180:183], v[236:239]
    v_mfma_f32_16x16x32_bf16 v[240:243], a[120:123], a[176:179], v[240:243]
    v_mfma_f32_16x16x32_bf16 v[244:247], a[120:123], a[180:183], v[244:247]
    v_mfma_f32_16x16x32_bf16 v[248:251], a[124:127], a[176:179], v[248:251]
    v_mfma_f32_16x16x32_bf16 v[252:255], a[124:127], a[180:183], v[252:255]
    s_waitcnt lgkmcnt(0)
    s_waitcnt vmcnt(17)
    s_barrier
    v_mfma_f32_16x16x32_bf16 v[32:35], a[0:3], a[128:131], v[32:35]
    ds_read_b64_tr_b16 a[64:65], v11 offset:16896
    v_mfma_f32_16x16x32_bf16 v[36:39], a[0:3], a[132:135], v[36:39]
    ds_read_b64_tr_b16 a[66:67], v11 offset:17408
    s_add_u32 m0, s22, 0
    s_nop 0
    buffer_load_dwordx4 v6, s[32:35], s25 offen offset:0 lds
    v_mfma_f32_16x16x32_bf16 v[40:43], a[0:3], a[136:139], v[40:43]
    s_waitcnt vmcnt(17)
    v_mfma_f32_16x16x32_bf16 v[44:47], a[0:3], a[140:143], v[44:47]
    ds_read_b64_tr_b16 a[68:69], v11 offset:16928
    v_mfma_f32_16x16x32_bf16 v[48:51], a[4:7], a[128:131], v[48:51]
    ds_read_b64_tr_b16 a[70:71], v11 offset:17440
    v_mfma_f32_16x16x32_bf16 v[52:55], a[4:7], a[132:135], v[52:55]
    v_mfma_f32_16x16x32_bf16 v[56:59], a[4:7], a[136:139], v[56:59]
    ds_read_b64_tr_b16 a[72:73], v11 offset:25344
    v_mfma_f32_16x16x32_bf16 v[60:63], a[4:7], a[140:143], v[60:63]
    ds_read_b64_tr_b16 a[74:75], v11 offset:25856
    buffer_load_dwordx4 a[176:179], v4, s[28:31], s23 offen offset:0
    v_mfma_f32_16x16x32_bf16 v[64:67], a[8:11], a[128:131], v[64:67]
    v_mfma_f32_16x16x32_bf16 v[68:71], a[8:11], a[132:135], v[68:71]
    ds_read_b64_tr_b16 a[76:77], v11 offset:25376
    v_mfma_f32_16x16x32_bf16 v[72:75], a[8:11], a[136:139], v[72:75]
    ds_read_b64_tr_b16 a[78:79], v11 offset:25888
    v_mfma_f32_16x16x32_bf16 v[76:79], a[8:11], a[140:143], v[76:79]
    v_mfma_f32_16x16x32_bf16 v[80:83], a[12:15], a[128:131], v[80:83]
    ds_read_b64_tr_b16 a[80:81], v11 offset:16960
    v_mfma_f32_16x16x32_bf16 v[84:87], a[12:15], a[132:135], v[84:87]
    v_mfma_f32_16x16x32_bf16 v[88:91], a[12:15], a[136:139], v[88:91]
    ds_read_b64_tr_b16 a[82:83], v11 offset:17472
    buffer_load_dwordx4 v7, s[32:35], s25 offen offset:1056 lds
    v_mfma_f32_16x16x32_bf16 v[92:95], a[12:15], a[140:143], v[92:95]
    ds_read_b64_tr_b16 a[84:85], v11 offset:16992
    v_mfma_f32_16x16x32_bf16 v[96:99], a[16:19], a[128:131], v[96:99]
    v_mfma_f32_16x16x32_bf16 v[100:103], a[16:19], a[132:135], v[100:103]
    ds_read_b64_tr_b16 a[86:87], v11 offset:17504
    v_mfma_f32_16x16x32_bf16 v[104:107], a[16:19], a[136:139], v[104:107]
    ds_read_b64_tr_b16 a[88:89], v11 offset:25408
    v_mfma_f32_16x16x32_bf16 v[108:111], a[16:19], a[140:143], v[108:111]
    v_mfma_f32_16x16x32_bf16 v[112:115], a[20:23], a[128:131], v[112:115]
    ds_read_b64_tr_b16 a[90:91], v11 offset:25920
    v_mfma_f32_16x16x32_bf16 v[116:119], a[20:23], a[132:135], v[116:119]
    ds_read_b64_tr_b16 a[92:93], v11 offset:25440
    buffer_load_dwordx4 a[180:183], v4, s[28:31], s23 offen offset:1024
    v_mfma_f32_16x16x32_bf16 v[120:123], a[20:23], a[136:139], v[120:123]
    v_mfma_f32_16x16x32_bf16 v[124:127], a[20:23], a[140:143], v[124:127]
    ds_read_b64_tr_b16 a[94:95], v11 offset:25952
    v_mfma_f32_16x16x32_bf16 v[128:131], a[24:27], a[128:131], v[128:131]
    v_mfma_f32_16x16x32_bf16 v[132:135], a[24:27], a[132:135], v[132:135]
    ds_read_b64_tr_b16 a[96:97], v11 offset:17024
    v_mfma_f32_16x16x32_bf16 v[136:139], a[24:27], a[136:139], v[136:139]
    ds_read_b64_tr_b16 a[98:99], v11 offset:17536
    v_mfma_f32_16x16x32_bf16 v[140:143], a[24:27], a[140:143], v[140:143]
    v_mfma_f32_16x16x32_bf16 v[144:147], a[28:31], a[128:131], v[144:147]
    ds_read_b64_tr_b16 a[100:101], v11 offset:17056
    buffer_load_dwordx4 v8, s[32:35], s25 offen offset:2112 lds
    v_mfma_f32_16x16x32_bf16 v[148:151], a[28:31], a[132:135], v[148:151]
    ds_read_b64_tr_b16 a[102:103], v11 offset:17568
    v_mfma_f32_16x16x32_bf16 v[152:155], a[28:31], a[136:139], v[152:155]
    v_mfma_f32_16x16x32_bf16 v[156:159], a[28:31], a[140:143], v[156:159]
    ds_read_b64_tr_b16 a[104:105], v11 offset:25472
    v_mfma_f32_16x16x32_bf16 v[160:163], a[32:35], a[128:131], v[160:163]
    ds_read_b64_tr_b16 a[106:107], v11 offset:25984
    v_mfma_f32_16x16x32_bf16 v[164:167], a[32:35], a[132:135], v[164:167]
    v_mfma_f32_16x16x32_bf16 v[168:171], a[32:35], a[136:139], v[168:171]
    ds_read_b64_tr_b16 a[108:109], v11 offset:25504
    v_mfma_f32_16x16x32_bf16 v[172:175], a[32:35], a[140:143], v[172:175]
    ds_read_b64_tr_b16 a[110:111], v11 offset:26016
    buffer_load_dwordx4 a[184:187], v5, s[28:31], s23 offen offset:0
    v_mfma_f32_16x16x32_bf16 v[176:179], a[36:39], a[128:131], v[176:179]
    v_mfma_f32_16x16x32_bf16 v[180:183], a[36:39], a[132:135], v[180:183]
    ds_read_b64_tr_b16 a[112:113], v13 offset:16896
    v_mfma_f32_16x16x32_bf16 v[184:187], a[36:39], a[136:139], v[184:187]
    v_mfma_f32_16x16x32_bf16 v[188:191], a[36:39], a[140:143], v[188:191]
    ds_read_b64_tr_b16 a[114:115], v13 offset:17408
    v_mfma_f32_16x16x32_bf16 v[192:195], a[40:43], a[128:131], v[192:195]
    ds_read_b64_tr_b16 a[116:117], v13 offset:16928
    v_mfma_f32_16x16x32_bf16 v[196:199], a[40:43], a[132:135], v[196:199]
    v_mfma_f32_16x16x32_bf16 v[200:203], a[40:43], a[136:139], v[200:203]
    ds_read_b64_tr_b16 a[118:119], v13 offset:17440
    buffer_load_dwordx4 v9, s[32:35], s25 offen offset:3168 lds
    s_add_u32 s25, s25, 229376
    v_mfma_f32_16x16x32_bf16 v[204:207], a[40:43], a[140:143], v[204:207]
    ds_read_b64_tr_b16 a[120:121], v13 offset:25344
    v_mfma_f32_16x16x32_bf16 v[208:211], a[44:47], a[128:131], v[208:211]
    v_mfma_f32_16x16x32_bf16 v[212:215], a[44:47], a[132:135], v[212:215]
    ds_read_b64_tr_b16 a[122:123], v13 offset:25856
    v_mfma_f32_16x16x32_bf16 v[216:219], a[44:47], a[136:139], v[216:219]
    ds_read_b64_tr_b16 a[124:125], v13 offset:25376
    v_mfma_f32_16x16x32_bf16 v[220:223], a[44:47], a[140:143], v[220:223]
    v_mfma_f32_16x16x32_bf16 v[224:227], a[48:51], a[128:131], v[224:227]
    ds_read_b64_tr_b16 a[126:127], v13 offset:25888
    v_mfma_f32_16x16x32_bf16 v[228:231], a[48:51], a[132:135], v[228:231]
    buffer_load_dwordx4 a[188:191], v5, s[28:31], s23 offen offset:1024
    s_add_u32 s23, s23, 0x20000
    v_mfma_f32_16x16x32_bf16 v[232:235], a[52:55], a[128:131], v[232:235]
    v_mfma_f32_16x16x32_bf16 v[236:239], a[52:55], a[132:135], v[236:239]
    v_mfma_f32_16x16x32_bf16 v[240:243], a[56:59], a[128:131], v[240:243]
    v_mfma_f32_16x16x32_bf16 v[244:247], a[56:59], a[132:135], v[244:247]
    v_mfma_f32_16x16x32_bf16 v[248:251], a[60:63], a[128:131], v[248:251]
    v_mfma_f32_16x16x32_bf16 v[252:255], a[60:63], a[132:135], v[252:255]
    s_waitcnt lgkmcnt(0)
    s_waitcnt vmcnt(17)
    s_barrier
    v_mfma_f32_16x16x32_bf16 v[32:35], a[64:67], a[144:147], v[32:35]
    ds_read_b64_tr_b16 a[0:1], v11 offset:33792
    v_mfma_f32_16x16x32_bf16 v[36:39], a[64:67], a[148:151], v[36:39]
    ds_read_b64_tr_b16 a[2:3], v11 offset:34304
    s_add_u32 m0, s22, 16896
    s_nop 0
    buffer_load_dwordx4 v6, s[32:35], s25 offen offset:0 lds
    v_mfma_f32_16x16x32_bf16 v[40:43], a[64:67], a[152:155], v[40:43]
    s_waitcnt vmcnt(17)
    v_mfma_f32_16x16x32_bf16 v[44:47], a[64:67], a[156:159], v[44:47]
    ds_read_b64_tr_b16 a[4:5], v11 offset:33824
    v_mfma_f32_16x16x32_bf16 v[48:51], a[68:71], a[144:147], v[48:51]
    ds_read_b64_tr_b16 a[6:7], v11 offset:34336
    v_mfma_f32_16x16x32_bf16 v[52:55], a[68:71], a[148:151], v[52:55]
    v_mfma_f32_16x16x32_bf16 v[56:59], a[68:71], a[152:155], v[56:59]
    ds_read_b64_tr_b16 a[8:9], v11 offset:42240
    v_mfma_f32_16x16x32_bf16 v[60:63], a[68:71], a[156:159], v[60:63]
    ds_read_b64_tr_b16 a[10:11], v11 offset:42752
    buffer_load_dwordx4 a[128:131], v4, s[28:31], s23 offen offset:0
    v_mfma_f32_16x16x32_bf16 v[64:67], a[72:75], a[144:147], v[64:67]
    v_mfma_f32_16x16x32_bf16 v[68:71], a[72:75], a[148:151], v[68:71]
    ds_read_b64_tr_b16 a[12:13], v11 offset:42272
    v_mfma_f32_16x16x32_bf16 v[72:75], a[72:75], a[152:155], v[72:75]
    ds_read_b64_tr_b16 a[14:15], v11 offset:42784
    v_mfma_f32_16x16x32_bf16 v[76:79], a[72:75], a[156:159], v[76:79]
    v_mfma_f32_16x16x32_bf16 v[80:83], a[76:79], a[144:147], v[80:83]
    ds_read_b64_tr_b16 a[16:17], v11 offset:33856
    v_mfma_f32_16x16x32_bf16 v[84:87], a[76:79], a[148:151], v[84:87]
    v_mfma_f32_16x16x32_bf16 v[88:91], a[76:79], a[152:155], v[88:91]
    ds_read_b64_tr_b16 a[18:19], v11 offset:34368
    buffer_load_dwordx4 v7, s[32:35], s25 offen offset:1056 lds
    v_mfma_f32_16x16x32_bf16 v[92:95], a[76:79], a[156:159], v[92:95]
    ds_read_b64_tr_b16 a[20:21], v11 offset:33888
    v_mfma_f32_16x16x32_bf16 v[96:99], a[80:83], a[144:147], v[96:99]
    v_mfma_f32_16x16x32_bf16 v[100:103], a[80:83], a[148:151], v[100:103]
    ds_read_b64_tr_b16 a[22:23], v11 offset:34400
    v_mfma_f32_16x16x32_bf16 v[104:107], a[80:83], a[152:155], v[104:107]
    ds_read_b64_tr_b16 a[24:25], v11 offset:42304
    v_mfma_f32_16x16x32_bf16 v[108:111], a[80:83], a[156:159], v[108:111]
    v_mfma_f32_16x16x32_bf16 v[112:115], a[84:87], a[144:147], v[112:115]
    ds_read_b64_tr_b16 a[26:27], v11 offset:42816
    v_mfma_f32_16x16x32_bf16 v[116:119], a[84:87], a[148:151], v[116:119]
    ds_read_b64_tr_b16 a[28:29], v11 offset:42336
    buffer_load_dwordx4 a[132:135], v4, s[28:31], s23 offen offset:1024
    v_mfma_f32_16x16x32_bf16 v[120:123], a[84:87], a[152:155], v[120:123]
    v_mfma_f32_16x16x32_bf16 v[124:127], a[84:87], a[156:159], v[124:127]
    ds_read_b64_tr_b16 a[30:31], v11 offset:42848
    v_mfma_f32_16x16x32_bf16 v[128:131], a[88:91], a[144:147], v[128:131]
    v_mfma_f32_16x16x32_bf16 v[132:135], a[88:91], a[148:151], v[132:135]
    ds_read_b64_tr_b16 a[32:33], v11 offset:33920
    v_mfma_f32_16x16x32_bf16 v[136:139], a[88:91], a[152:155], v[136:139]
    ds_read_b64_tr_b16 a[34:35], v11 offset:34432
    v_mfma_f32_16x16x32_bf16 v[140:143], a[88:91], a[156:159], v[140:143]
    v_mfma_f32_16x16x32_bf16 v[144:147], a[92:95], a[144:147], v[144:147]
    ds_read_b64_tr_b16 a[36:37], v11 offset:33952
    buffer_load_dwordx4 v8, s[32:35], s25 offen offset:2112 lds
    v_mfma_f32_16x16x32_bf16 v[148:151], a[92:95], a[148:151], v[148:151]
    ds_read_b64_tr_b16 a[38:39], v11 offset:34464
    v_mfma_f32_16x16x32_bf16 v[152:155], a[92:95], a[152:155], v[152:155]
    v_mfma_f32_16x16x32_bf16 v[156:159], a[92:95], a[156:159], v[156:159]
    ds_read_b64_tr_b16 a[40:41], v11 offset:42368
    v_mfma_f32_16x16x32_bf16 v[160:163], a[96:99], a[144:147], v[160:163]
    ds_read_b64_tr_b16 a[42:43], v11 offset:42880
    v_mfma_f32_16x16x32_bf16 v[164:167], a[96:99], a[148:151], v[164:167]
    v_mfma_f32_16x16x32_bf16 v[168:171], a[96:99], a[152:155], v[168:171]
    ds_read_b64_tr_b16 a[44:45], v11 offset:42400
    v_mfma_f32_16x16x32_bf16 v[172:175], a[96:99], a[156:159], v[172:175]
    ds_read_b64_tr_b16 a[46:47], v11 offset:42912
    buffer_load_dwordx4 a[136:139], v5, s[28:31], s23 offen offset:0
    v_mfma_f32_16x16x32_bf16 v[176:179], a[100:103], a[144:147], v[176:179]
    v_mfma_f32_16x16x32_bf16 v[180:183], a[100:103], a[148:151], v[180:183]
    ds_read_b64_tr_b16 a[48:49], v13 offset:33792
    v_mfma_f32_16x16x32_bf16 v[184:187], a[100:103], a[152:155], v[184:187]
    v_mfma_f32_16x16x32_bf16 v[188:191], a[100:103], a[156:159], v[188:191]
    ds_read_b64_tr_b16 a[50:51], v13 offset:34304
    v_mfma_f32_16x16x32_bf16 v[192:195], a[104:107], a[144:147], v[192:195]
    ds_read_b64_tr_b16 a[52:53], v13 offset:33824
    v_mfma_f32_16x16x32_bf16 v[196:199], a[104:107], a[148:151], v[196:199]
    v_mfma_f32_16x16x32_bf16 v[200:203], a[104:107], a[152:155], v[200:203]
    ds_read_b64_tr_b16 a[54:55], v13 offset:34336
    buffer_load_dwordx4 v9, s[32:35], s25 offen offset:3168 lds
    s_add_u32 s25, s25, 229376
    v_mfma_f32_16x16x32_bf16 v[204:207], a[104:107], a[156:159], v[204:207]
    ds_read_b64_tr_b16 a[56:57], v13 offset:42240
    v_mfma_f32_16x16x32_bf16 v[208:211], a[108:111], a[144:147], v[208:211]
    v_mfma_f32_16x16x32_bf16 v[212:215], a[108:111], a[148:151], v[212:215]
    ds_read_b64_tr_b16 a[58:59], v13 offset:42752
    v_mfma_f32_16x16x32_bf16 v[216:219], a[108:111], a[152:155], v[216:219]
    ds_read_b64_tr_b16 a[60:61], v13 offset:42272
    v_mfma_f32_16x16x32_bf16 v[220:223], a[108:111], a[156:159], v[220:223]
    v_mfma_f32_16x16x32_bf16 v[224:227], a[112:115], a[144:147], v[224:227]
    ds_read_b64_tr_b16 a[62:63], v13 offset:42784
    v_mfma_f32_16x16x32_bf16 v[228:231], a[112:115], a[148:151], v[228:231]
    buffer_load_dwordx4 a[140:143], v5, s[28:31], s23 offen offset:1024
    s_add_u32 s23, s23, 0x20000
    v_mfma_f32_16x16x32_bf16 v[232:235], a[116:119], a[144:147], v[232:235]
    v_mfma_f32_16x16x32_bf16 v[236:239], a[116:119], a[148:151], v[236:239]
    v_mfma_f32_16x16x32_bf16 v[240:243], a[120:123], a[144:147], v[240:243]
    v_mfma_f32_16x16x32_bf16 v[244:247], a[120:123], a[148:151], v[244:247]
    v_mfma_f32_16x16x32_bf16 v[248:251], a[124:127], a[144:147], v[248:251]
    v_mfma_f32_16x16x32_bf16 v[252:255], a[124:127], a[148:151], v[252:255]
    s_waitcnt lgkmcnt(0)
    s_waitcnt vmcnt(17)
    s_barrier
    v_mfma_f32_16x16x32_bf16 v[32:35], a[0:3], a[160:163], v[32:35]
    ds_read_b64_tr_b16 a[64:65], v11 offset:50688
    v_mfma_f32_16x16x32_bf16 v[36:39], a[0:3], a[164:167], v[36:39]
    ds_read_b64_tr_b16 a[66:67], v11 offset:51200
    s_add_u32 m0, s22, 33792
    s_nop 0
    buffer_load_dwordx4 v6, s[32:35], s25 offen offset:0 lds
    v_mfma_f32_16x16x32_bf16 v[40:43], a[0:3], a[168:171], v[40:43]
    s_waitcnt vmcnt(17)
    v_mfma_f32_16x16x32_bf16 v[44:47], a[0:3], a[172:175], v[44:47]
    ds_read_b64_tr_b16 a[68:69], v11 offset:50720
    v_mfma_f32_16x16x32_bf16 v[48:51], a[4:7], a[160:163], v[48:51]
    ds_read_b64_tr_b16 a[70:71], v11 offset:51232
    v_mfma_f32_16x16x32_bf16 v[52:55], a[4:7], a[164:167], v[52:55]
    v_mfma_f32_16x16x32_bf16 v[56:59], a[4:7], a[168:171], v[56:59]
    ds_read_b64_tr_b16 a[72:73], v11 offset:59136
    v_mfma_f32_16x16x32_bf16 v[60:63], a[4:7], a[172:175], v[60:63]
    ds_read_b64_tr_b16 a[74:75], v11 offset:59648
    buffer_load_dwordx4 a[144:147], v4, s[28:31], s23 offen offset:0
    v_mfma_f32_16x16x32_bf16 v[64:67], a[8:11], a[160:163], v[64:67]
    v_mfma_f32_16x16x32_bf16 v[68:71], a[8:11], a[164:167], v[68:71]
    ds_read_b64_tr_b16 a[76:77], v11 offset:59168
    v_mfma_f32_16x16x32_bf16 v[72:75], a[8:11], a[168:171], v[72:75]
    ds_read_b64_tr_b16 a[78:79], v11 offset:59680
    v_mfma_f32_16x16x32_bf16 v[76:79], a[8:11], a[172:175], v[76:79]
    v_mfma_f32_16x16x32_bf16 v[80:83], a[12:15], a[160:163], v[80:83]
    ds_read_b64_tr_b16 a[80:81], v11 offset:50752
    v_mfma_f32_16x16x32_bf16 v[84:87], a[12:15], a[164:167], v[84:87]
    v_mfma_f32_16x16x32_bf16 v[88:91], a[12:15], a[168:171], v[88:91]
    ds_read_b64_tr_b16 a[82:83], v11 offset:51264
    buffer_load_dwordx4 v7, s[32:35], s25 offen offset:1056 lds
    v_mfma_f32_16x16x32_bf16 v[92:95], a[12:15], a[172:175], v[92:95]
    ds_read_b64_tr_b16 a[84:85], v11 offset:50784
    v_mfma_f32_16x16x32_bf16 v[96:99], a[16:19], a[160:163], v[96:99]
    v_mfma_f32_16x16x32_bf16 v[100:103], a[16:19], a[164:167], v[100:103]
    ds_read_b64_tr_b16 a[86:87], v11 offset:51296
    v_mfma_f32_16x16x32_bf16 v[104:107], a[16:19], a[168:171], v[104:107]
    ds_read_b64_tr_b16 a[88:89], v11 offset:59200
    v_mfma_f32_16x16x32_bf16 v[108:111], a[16:19], a[172:175], v[108:111]
    v_mfma_f32_16x16x32_bf16 v[112:115], a[20:23], a[160:163], v[112:115]
    ds_read_b64_tr_b16 a[90:91], v11 offset:59712
    v_mfma_f32_16x16x32_bf16 v[116:119], a[20:23], a[164:167], v[116:119]
    ds_read_b64_tr_b16 a[92:93], v11 offset:59232
    buffer_load_dwordx4 a[148:151], v4, s[28:31], s23 offen offset:1024
    v_mfma_f32_16x16x32_bf16 v[120:123], a[20:23], a[168:171], v[120:123]
    v_mfma_f32_16x16x32_bf16 v[124:127], a[20:23], a[172:175], v[124:127]
    ds_read_b64_tr_b16 a[94:95], v11 offset:59744
    v_mfma_f32_16x16x32_bf16 v[128:131], a[24:27], a[160:163], v[128:131]
    v_mfma_f32_16x16x32_bf16 v[132:135], a[24:27], a[164:167], v[132:135]
    ds_read_b64_tr_b16 a[96:97], v11 offset:50816
    v_mfma_f32_16x16x32_bf16 v[136:139], a[24:27], a[168:171], v[136:139]
    ds_read_b64_tr_b16 a[98:99], v11 offset:51328
    v_mfma_f32_16x16x32_bf16 v[140:143], a[24:27], a[172:175], v[140:143]
    v_mfma_f32_16x16x32_bf16 v[144:147], a[28:31], a[160:163], v[144:147]
    ds_read_b64_tr_b16 a[100:101], v11 offset:50848
    buffer_load_dwordx4 v8, s[32:35], s25 offen offset:2112 lds
    v_mfma_f32_16x16x32_bf16 v[148:151], a[28:31], a[164:167], v[148:151]
    ds_read_b64_tr_b16 a[102:103], v11 offset:51360
    v_mfma_f32_16x16x32_bf16 v[152:155], a[28:31], a[168:171], v[152:155]
    v_mfma_f32_16x16x32_bf16 v[156:159], a[28:31], a[172:175], v[156:159]
    ds_read_b64_tr_b16 a[104:105], v11 offset:59264
    v_mfma_f32_16x16x32_bf16 v[160:163], a[32:35], a[160:163], v[160:163]
    ds_read_b64_tr_b16 a[106:107], v11 offset:59776
    v_mfma_f32_16x16x32_bf16 v[164:167], a[32:35], a[164:167], v[164:167]
    v_mfma_f32_16x16x32_bf16 v[168:171], a[32:35], a[168:171], v[168:171]
    ds_read_b64_tr_b16 a[108:109], v11 offset:59296
    v_mfma_f32_16x16x32_bf16 v[172:175], a[32:35], a[172:175], v[172:175]
    ds_read_b64_tr_b16 a[110:111], v11 offset:59808
    buffer_load_dwordx4 a[152:155], v5, s[28:31], s23 offen offset:0
    v_mfma_f32_16x16x32_bf16 v[176:179], a[36:39], a[160:163], v[176:179]
    v_mfma_f32_16x16x32_bf16 v[180:183], a[36:39], a[164:167], v[180:183]
    ds_read_b64_tr_b16 a[112:113], v13 offset:50688
    v_mfma_f32_16x16x32_bf16 v[184:187], a[36:39], a[168:171], v[184:187]
    v_mfma_f32_16x16x32_bf16 v[188:191], a[36:39], a[172:175], v[188:191]
    ds_read_b64_tr_b16 a[114:115], v13 offset:51200
    v_mfma_f32_16x16x32_bf16 v[192:195], a[40:43], a[160:163], v[192:195]
    ds_read_b64_tr_b16 a[116:117], v13 offset:50720
    v_mfma_f32_16x16x32_bf16 v[196:199], a[40:43], a[164:167], v[196:199]
    v_mfma_f32_16x16x32_bf16 v[200:203], a[40:43], a[168:171], v[200:203]
    ds_read_b64_tr_b16 a[118:119], v13 offset:51232
    buffer_load_dwordx4 v9, s[32:35], s25 offen offset:3168 lds
    s_add_u32 s25, s25, 229376
    v_mfma_f32_16x16x32_bf16 v[204:207], a[40:43], a[172:175], v[204:207]
    ds_read_b64_tr_b16 a[120:121], v13 offset:59136
    v_mfma_f32_16x16x32_bf16 v[208:211], a[44:47], a[160:163], v[208:211]
    v_mfma_f32_16x16x32_bf16 v[212:215], a[44:47], a[164:167], v[212:215]
    ds_read_b64_tr_b16 a[122:123], v13 offset:59648
    v_mfma_f32_16x16x32_bf16 v[216:219], a[44:47], a[168:171], v[216:219]
    ds_read_b64_tr_b16 a[124:125], v13 offset:59168
    v_mfma_f32_16x16x32_bf16 v[220:223], a[44:47], a[172:175], v[220:223]
    v_mfma_f32_16x16x32_bf16 v[224:227], a[48:51], a[160:163], v[224:227]
    ds_read_b64_tr_b16 a[126:127], v13 offset:59680
    v_mfma_f32_16x16x32_bf16 v[228:231], a[48:51], a[164:167], v[228:231]
    buffer_load_dwordx4 a[156:159], v5, s[28:31], s23 offen offset:1024
    s_add_u32 s23, s23, 0x20000
    v_mfma_f32_16x16x32_bf16 v[232:235], a[52:55], a[160:163], v[232:235]
    v_mfma_f32_16x16x32_bf16 v[236:239], a[52:55], a[164:167], v[236:239]
    v_mfma_f32_16x16x32_bf16 v[240:243], a[56:59], a[160:163], v[240:243]
    v_mfma_f32_16x16x32_bf16 v[244:247], a[56:59], a[164:167], v[244:247]
    v_mfma_f32_16x16x32_bf16 v[248:251], a[60:63], a[160:163], v[248:251]
    v_mfma_f32_16x16x32_bf16 v[252:255], a[60:63], a[164:167], v[252:255]
    s_waitcnt lgkmcnt(0)
    s_waitcnt vmcnt(17)
    s_barrier
    v_mfma_f32_16x16x32_bf16 v[32:35], a[64:67], a[176:179], v[32:35]
    ds_read_b64_tr_b16 a[0:1], v10 offset:0
    v_mfma_f32_16x16x32_bf16 v[36:39], a[64:67], a[180:183], v[36:39]
    ds_read_b64_tr_b16 a[2:3], v10 offset:512
    s_add_u32 m0, s22, 50688
    s_nop 0
    buffer_load_dwordx4 v6, s[32:35], s25 offen offset:0 lds
    v_mfma_f32_16x16x32_bf16 v[40:43], a[64:67], a[184:187], v[40:43]
    s_waitcnt vmcnt(17)
    v_mfma_f32_16x16x32_bf16 v[44:47], a[64:67], a[188:191], v[44:47]
    ds_read_b64_tr_b16 a[4:5], v10 offset:32
    v_mfma_f32_16x16x32_bf16 v[48:51], a[68:71], a[176:179], v[48:51]
    ds_read_b64_tr_b16 a[6:7], v10 offset:544
    v_mfma_f32_16x16x32_bf16 v[52:55], a[68:71], a[180:183], v[52:55]
    v_mfma_f32_16x16x32_bf16 v[56:59], a[68:71], a[184:187], v[56:59]
    ds_read_b64_tr_b16 a[8:9], v10 offset:8448
    v_mfma_f32_16x16x32_bf16 v[60:63], a[68:71], a[188:191], v[60:63]
    ds_read_b64_tr_b16 a[10:11], v10 offset:8960
    buffer_load_dwordx4 a[160:163], v4, s[28:31], s23 offen offset:0
    v_mfma_f32_16x16x32_bf16 v[64:67], a[72:75], a[176:179], v[64:67]
    v_mfma_f32_16x16x32_bf16 v[68:71], a[72:75], a[180:183], v[68:71]
    ds_read_b64_tr_b16 a[12:13], v10 offset:8480
    v_mfma_f32_16x16x32_bf16 v[72:75], a[72:75], a[184:187], v[72:75]
    ds_read_b64_tr_b16 a[14:15], v10 offset:8992
    v_mfma_f32_16x16x32_bf16 v[76:79], a[72:75], a[188:191], v[76:79]
    v_mfma_f32_16x16x32_bf16 v[80:83], a[76:79], a[176:179], v[80:83]
    ds_read_b64_tr_b16 a[16:17], v10 offset:64
    v_mfma_f32_16x16x32_bf16 v[84:87], a[76:79], a[180:183], v[84:87]
    v_mfma_f32_16x16x32_bf16 v[88:91], a[76:79], a[184:187], v[88:91]
    ds_read_b64_tr_b16 a[18:19], v10 offset:576
    buffer_load_dwordx4 v7, s[32:35], s25 offen offset:1056 lds
    v_mfma_f32_16x16x32_bf16 v[92:95], a[76:79], a[188:191], v[92:95]
    ds_read_b64_tr_b16 a[20:21], v10 offset:96
    v_mfma_f32_16x16x32_bf16 v[96:99], a[80:83], a[176:179], v[96:99]
    v_mfma_f32_16x16x32_bf16 v[100:103], a[80:83], a[180:183], v[100:103]
    ds_read_b64_tr_b16 a[22:23], v10 offset:608
    v_mfma_f32_16x16x32_bf16 v[104:107], a[80:83], a[184:187], v[104:107]
    ds_read_b64_tr_b16 a[24:25], v10 offset:8512
    v_mfma_f32_16x16x32_bf16 v[108:111], a[80:83], a[188:191], v[108:111]
    v_mfma_f32_16x16x32_bf16 v[112:115], a[84:87], a[176:179], v[112:115]
    ds_read_b64_tr_b16 a[26:27], v10 offset:9024
    v_mfma_f32_16x16x32_bf16 v[116:119], a[84:87], a[180:183], v[116:119]
    ds_read_b64_tr_b16 a[28:29], v10 offset:8544
    buffer_load_dwordx4 a[164:167], v4, s[28:31], s23 offen offset:1024
    v_mfma_f32_16x16x32_bf16 v[120:123], a[84:87], a[184:187], v[120:123]
    v_mfma_f32_16x16x32_bf16 v[124:127], a[84:87], a[188:191], v[124:127]
    ds_read_b64_tr_b16 a[30:31], v10 offset:9056
    v_mfma_f32_16x16x32_bf16 v[128:131], a[88:91], a[176:179], v[128:131]
    v_mfma_f32_16x16x32_bf16 v[132:135], a[88:91], a[180:183], v[132:135]
    ds_read_b64_tr_b16 a[32:33], v10 offset:128
    v_mfma_f32_16x16x32_bf16 v[136:139], a[88:91], a[184:187], v[136:139]
    ds_read_b64_tr_b16 a[34:35], v10 offset:640
    v_mfma_f32_16x16x32_bf16 v[140:143], a[88:91], a[188:191], v[140:143]
    v_mfma_f32_16x16x32_bf16 v[144:147], a[92:95], a[176:179], v[144:147]
    ds_read_b64_tr_b16 a[36:37], v10 offset:160
    buffer_load_dwordx4 v8, s[32:35], s25 offen offset:2112 lds
    v_mfma_f32_16x16x32_bf16 v[148:151], a[92:95], a[180:183], v[148:151]
    ds_read_b64_tr_b16 a[38:39], v10 offset:672
    v_mfma_f32_16x16x32_bf16 v[152:155], a[92:95], a[184:187], v[152:155]
    v_mfma_f32_16x16x32_bf16 v[156:159], a[92:95], a[188:191], v[156:159]
    ds_read_b64_tr_b16 a[40:41], v10 offset:8576
    v_mfma_f32_16x16x32_bf16 v[160:163], a[96:99], a[176:179], v[160:163]
    ds_read_b64_tr_b16 a[42:43], v10 offset:9088
    v_mfma_f32_16x16x32_bf16 v[164:167], a[96:99], a[180:183], v[164:167]
    v_mfma_f32_16x16x32_bf16 v[168:171], a[96:99], a[184:187], v[168:171]
    ds_read_b64_tr_b16 a[44:45], v10 offset:8608
    v_mfma_f32_16x16x32_bf16 v[172:175], a[96:99], a[188:191], v[172:175]
    ds_read_b64_tr_b16 a[46:47], v10 offset:9120
    buffer_load_dwordx4 a[168:171], v5, s[28:31], s23 offen offset:0
    v_mfma_f32_16x16x32_bf16 v[176:179], a[100:103], a[176:179], v[176:179]
    v_mfma_f32_16x16x32_bf16 v[180:183], a[100:103], a[180:183], v[180:183]
    ds_read_b64_tr_b16 a[48:49], v12 offset:0
    v_mfma_f32_16x16x32_bf16 v[184:187], a[100:103], a[184:187], v[184:187]
    v_mfma_f32_16x16x32_bf16 v[188:191], a[100:103], a[188:191], v[188:191]
    ds_read_b64_tr_b16 a[50:51], v12 offset:512
    v_mfma_f32_16x16x32_bf16 v[192:195], a[104:107], a[176:179], v[192:195]
    ds_read_b64_tr_b16 a[52:53], v12 offset:32
    v_mfma_f32_16x16x32_bf16 v[196:199], a[104:107], a[180:183], v[196:199]
    v_mfma_f32_16x16x32_bf16 v[200:203], a[104:107], a[184:187], v[200:203]
    ds_read_b64_tr_b16 a[54:55], v12 offset:544
    buffer_load_dwordx4 v9, s[32:35], s25 offen offset:3168 lds
    s_add_u32 s25, s25, 229376
    v_mfma_f32_16x16x32_bf16 v[204:207], a[104:107], a[188:191], v[204:207]
    ds_read_b64_tr_b16 a[56:57], v12 offset:8448
    v_mfma_f32_16x16x32_bf16 v[208:211], a[108:111], a[176:179], v[208:211]
    v_mfma_f32_16x16x32_bf16 v[212:215], a[108:111], a[180:183], v[212:215]
    ds_read_b64_tr_b16 a[58:59], v12 offset:8960
    v_mfma_f32_16x16x32_bf16 v[216:219], a[108:111], a[184:187], v[216:219]
    ds_read_b64_tr_b16 a[60:61], v12 offset:8480
    v_mfma_f32_16x16x32_bf16 v[220:223], a[108:111], a[188:191], v[220:223]
    v_mfma_f32_16x16x32_bf16 v[224:227], a[112:115], a[176:179], v[224:227]
    ds_read_b64_tr_b16 a[62:63], v12 offset:8992
    v_mfma_f32_16x16x32_bf16 v[228:231], a[112:115], a[180:183], v[228:231]
    buffer_load_dwordx4 a[172:175], v5, s[28:31], s23 offen offset:1024
    s_add_u32 s23, s23, 0x20000
    v_mfma_f32_16x16x32_bf16 v[232:235], a[116:119], a[176:179], v[232:235]
    v_mfma_f32_16x16x32_bf16 v[236:239], a[116:119], a[180:183], v[236:239]
    v_mfma_f32_16x16x32_bf16 v[240:243], a[120:123], a[176:179], v[240:243]
    v_mfma_f32_16x16x32_bf16 v[244:247], a[120:123], a[180:183], v[244:247]
    v_mfma_f32_16x16x32_bf16 v[248:251], a[124:127], a[176:179], v[248:251]
    v_mfma_f32_16x16x32_bf16 v[252:255], a[124:127], a[180:183], v[252:255]
    s_sub_u32 s48, s48, 1
    s_cmp_lg_u32 s48, 0
    s_cbranch_scc1 gu2_kernel_loop
    s_waitcnt lgkmcnt(0)
    s_waitcnt vmcnt(17)
    s_barrier
    v_mfma_f32_16x16x32_bf16 v[32:35], a[0:3], a[128:131], v[32:35]
    ds_read_b64_tr_b16 a[64:65], v10 offset:16896
    v_mfma_f32_16x16x32_bf16 v[36:39], a[0:3], a[132:135], v[36:39]
    ds_read_b64_tr_b16 a[66:67], v10 offset:17408
    s_add_u32 m0, s22, 67584
    s_nop 0
    buffer_load_dwordx4 v6, s[32:35], s25 offen offset:0 lds
    v_mfma_f32_16x16x32_bf16 v[40:43], a[0:3], a[136:139], v[40:43]
    s_waitcnt vmcnt(17)
    v_mfma_f32_16x16x32_bf16 v[44:47], a[0:3], a[140:143], v[44:47]
    ds_read_b64_tr_b16 a[68:69], v10 offset:16928
    v_mfma_f32_16x16x32_bf16 v[48:51], a[4:7], a[128:131], v[48:51]
    ds_read_b64_tr_b16 a[70:71], v10 offset:17440
    v_mfma_f32_16x16x32_bf16 v[52:55], a[4:7], a[132:135], v[52:55]
    v_mfma_f32_16x16x32_bf16 v[56:59], a[4:7], a[136:139], v[56:59]
    ds_read_b64_tr_b16 a[72:73], v10 offset:25344
    v_mfma_f32_16x16x32_bf16 v[60:63], a[4:7], a[140:143], v[60:63]
    ds_read_b64_tr_b16 a[74:75], v10 offset:25856
    buffer_load_dwordx4 a[176:179], v4, s[28:31], s23 offen offset:0
    v_mfma_f32_16x16x32_bf16 v[64:67], a[8:11], a[128:131], v[64:67]
    v_mfma_f32_16x16x32_bf16 v[68:71], a[8:11], a[132:135], v[68:71]
    ds_read_b64_tr_b16 a[76:77], v10 offset:25376
    v_mfma_f32_16x16x32_bf16 v[72:75], a[8:11], a[136:139], v[72:75]
    ds_read_b64_tr_b16 a[78:79], v10 offset:25888
    v_mfma_f32_16x16x32_bf16 v[76:79], a[8:11], a[140:143], v[76:79]
    v_mfma_f32_16x16x32_bf16 v[80:83], a[12:15], a[128:131], v[80:83]
    ds_read_b64_tr_b16 a[80:81], v10 offset:16960
    v_mfma_f32_16x16x32_bf16 v[84:87], a[12:15], a[132:135], v[84:87]
    v_mfma_f32_16x16x32_bf16 v[88:91], a[12:15], a[136:139], v[88:91]
    ds_read_b64_tr_b16 a[82:83], v10 offset:17472
    buffer_load_dwordx4 v7, s[32:35], s25 offen offset:1056 lds
    v_mfma_f32_16x16x32_bf16 v[92:95], a[12:15], a[140:143], v[92:95]
    ds_read_b64_tr_b16 a[84:85], v10 offset:16992
    v_mfma_f32_16x16x32_bf16 v[96:99], a[16:19], a[128:131], v[96:99]
    v_mfma_f32_16x16x32_bf16 v[100:103], a[16:19], a[132:135], v[100:103]
    ds_read_b64_tr_b16 a[86:87], v10 offset:17504
    v_mfma_f32_16x16x32_bf16 v[104:107], a[16:19], a[136:139], v[104:107]
    ds_read_b64_tr_b16 a[88:89], v10 offset:25408
    v_mfma_f32_16x16x32_bf16 v[108:111], a[16:19], a[140:143], v[108:111]
    v_mfma_f32_16x16x32_bf16 v[112:115], a[20:23], a[128:131], v[112:115]
    ds_read_b64_tr_b16 a[90:91], v10 offset:25920
    v_mfma_f32_16x16x32_bf16 v[116:119], a[20:23], a[132:135], v[116:119]
    ds_read_b64_tr_b16 a[92:93], v10 offset:25440
    buffer_load_dwordx4 a[180:183], v4, s[28:31], s23 offen offset:1024
    v_mfma_f32_16x16x32_bf16 v[120:123], a[20:23], a[136:139], v[120:123]
    v_mfma_f32_16x16x32_bf16 v[124:127], a[20:23], a[140:143], v[124:127]
    ds_read_b64_tr_b16 a[94:95], v10 offset:25952
    v_mfma_f32_16x16x32_bf16 v[128:131], a[24:27], a[128:131], v[128:131]
    v_mfma_f32_16x16x32_bf16 v[132:135], a[24:27], a[132:135], v[132:135]
    ds_read_b64_tr_b16 a[96:97], v10 offset:17024
    v_mfma_f32_16x16x32_bf16 v[136:139], a[24:27], a[136:139], v[136:139]
    ds_read_b64_tr_b16 a[98:99], v10 offset:17536
    v_mfma_f32_16x16x32_bf16 v[140:143], a[24:27], a[140:143], v[140:143]
    v_mfma_f32_16x16x32_bf16 v[144:147], a[28:31], a[128:131], v[144:147]
    ds_read_b64_tr_b16 a[100:101], v10 offset:17056
    buffer_load_dwordx4 v8, s[32:35], s25 offen offset:2112 lds
    v_mfma_f32_16x16x32_bf16 v[148:151], a[28:31], a[132:135], v[148:151]
    ds_read_b64_tr_b16 a[102:103], v10 offset:17568
    v_mfma_f32_16x16x32_bf16 v[152:155], a[28:31], a[136:139], v[152:155]
    v_mfma_f32_16x16x32_bf16 v[156:159], a[28:31], a[140:143], v[156:159]
    ds_read_b64_tr_b16 a[104:105], v10 offset:25472
    v_mfma_f32_16x16x32_bf16 v[160:163], a[32:35], a[128:131], v[160:163]
    ds_read_b64_tr_b16 a[106:107], v10 offset:25984
    v_mfma_f32_16x16x32_bf16 v[164:167], a[32:35], a[132:135], v[164:167]
    v_mfma_f32_16x16x32_bf16 v[168:171], a[32:35], a[136:139], v[168:171]
    ds_read_b64_tr_b16 a[108:109], v10 offset:25504
    v_mfma_f32_16x16x32_bf16 v[172:175], a[32:35], a[140:143], v[172:175]
    ds_read_b64_tr_b16 a[110:111], v10 offset:26016
    buffer_load_dwordx4 a[184:187], v5, s[28:31], s23 offen offset:0
    v_mfma_f32_16x16x32_bf16 v[176:179], a[36:39], a[128:131], v[176:179]
    v_mfma_f32_16x16x32_bf16 v[180:183], a[36:39], a[132:135], v[180:183]
    ds_read_b64_tr_b16 a[112:113], v12 offset:16896
    v_mfma_f32_16x16x32_bf16 v[184:187], a[36:39], a[136:139], v[184:187]
    v_mfma_f32_16x16x32_bf16 v[188:191], a[36:39], a[140:143], v[188:191]
    ds_read_b64_tr_b16 a[114:115], v12 offset:17408
    v_mfma_f32_16x16x32_bf16 v[192:195], a[40:43], a[128:131], v[192:195]
    ds_read_b64_tr_b16 a[116:117], v12 offset:16928
    v_mfma_f32_16x16x32_bf16 v[196:199], a[40:43], a[132:135], v[196:199]
    v_mfma_f32_16x16x32_bf16 v[200:203], a[40:43], a[136:139], v[200:203]
    ds_read_b64_tr_b16 a[118:119], v12 offset:17440
    buffer_load_dwordx4 v9, s[32:35], s25 offen offset:3168 lds
    s_add_u32 s25, s25, 229376
    v_mfma_f32_16x16x32_bf16 v[204:207], a[40:43], a[140:143], v[204:207]
    ds_read_b64_tr_b16 a[120:121], v12 offset:25344
    v_mfma_f32_16x16x32_bf16 v[208:211], a[44:47], a[128:131], v[208:211]
    v_mfma_f32_16x16x32_bf16 v[212:215], a[44:47], a[132:135], v[212:215]
    ds_read_b64_tr_b16 a[122:123], v12 offset:25856
    v_mfma_f32_16x16x32_bf16 v[216:219], a[44:47], a[136:139], v[216:219]
    ds_read_b64_tr_b16 a[124:125], v12 offset:25376
    v_mfma_f32_16x16x32_bf16 v[220:223], a[44:47], a[140:143], v[220:223]
    v_mfma_f32_16x16x32_bf16 v[224:227], a[48:51], a[128:131], v[224:227]
    ds_read_b64_tr_b16 a[126:127], v12 offset:25888
    v_mfma_f32_16x16x32_bf16 v[228:231], a[48:51], a[132:135], v[228:231]
    buffer_load_dwordx4 a[188:191], v5, s[28:31], s23 offen offset:1024
    s_add_u32 s23, s23, 0x20000
    v_mfma_f32_16x16x32_bf16 v[232:235], a[52:55], a[128:131], v[232:235]
    v_mfma_f32_16x16x32_bf16 v[236:239], a[52:55], a[132:135], v[236:239]
    v_mfma_f32_16x16x32_bf16 v[240:243], a[56:59], a[128:131], v[240:243]
    v_mfma_f32_16x16x32_bf16 v[244:247], a[56:59], a[132:135], v[244:247]
    v_mfma_f32_16x16x32_bf16 v[248:251], a[60:63], a[128:131], v[248:251]
    v_mfma_f32_16x16x32_bf16 v[252:255], a[60:63], a[132:135], v[252:255]
    s_waitcnt lgkmcnt(0)
    s_waitcnt vmcnt(17)
    s_barrier
    v_mfma_f32_16x16x32_bf16 v[32:35], a[64:67], a[144:147], v[32:35]
    ds_read_b64_tr_b16 a[0:1], v10 offset:33792
    v_mfma_f32_16x16x32_bf16 v[36:39], a[64:67], a[148:151], v[36:39]
    ds_read_b64_tr_b16 a[2:3], v10 offset:34304
    s_add_u32 m0, s22, 84480
    s_nop 0
    buffer_load_dwordx4 v6, s[32:35], s25 offen offset:0 lds
    v_mfma_f32_16x16x32_bf16 v[40:43], a[64:67], a[152:155], v[40:43]
    s_waitcnt vmcnt(17)
    v_mfma_f32_16x16x32_bf16 v[44:47], a[64:67], a[156:159], v[44:47]
    ds_read_b64_tr_b16 a[4:5], v10 offset:33824
    v_mfma_f32_16x16x32_bf16 v[48:51], a[68:71], a[144:147], v[48:51]
    ds_read_b64_tr_b16 a[6:7], v10 offset:34336
    v_mfma_f32_16x16x32_bf16 v[52:55], a[68:71], a[148:151], v[52:55]
    v_mfma_f32_16x16x32_bf16 v[56:59], a[68:71], a[152:155], v[56:59]
    ds_read_b64_tr_b16 a[8:9], v10 offset:42240
    v_mfma_f32_16x16x32_bf16 v[60:63], a[68:71], a[156:159], v[60:63]
    ds_read_b64_tr_b16 a[10:11], v10 offset:42752
    buffer_load_dwordx4 a[128:131], v4, s[28:31], s23 offen offset:0
    v_mfma_f32_16x16x32_bf16 v[64:67], a[72:75], a[144:147], v[64:67]
    v_mfma_f32_16x16x32_bf16 v[68:71], a[72:75], a[148:151], v[68:71]
    ds_read_b64_tr_b16 a[12:13], v10 offset:42272
    v_mfma_f32_16x16x32_bf16 v[72:75], a[72:75], a[152:155], v[72:75]
    ds_read_b64_tr_b16 a[14:15], v10 offset:42784
    v_mfma_f32_16x16x32_bf16 v[76:79], a[72:75], a[156:159], v[76:79]
    v_mfma_f32_16x16x32_bf16 v[80:83], a[76:79], a[144:147], v[80:83]
    ds_read_b64_tr_b16 a[16:17], v10 offset:33856
    v_mfma_f32_16x16x32_bf16 v[84:87], a[76:79], a[148:151], v[84:87]
    v_mfma_f32_16x16x32_bf16 v[88:91], a[76:79], a[152:155], v[88:91]
    ds_read_b64_tr_b16 a[18:19], v10 offset:34368
    buffer_load_dwordx4 v7, s[32:35], s25 offen offset:1056 lds
    v_mfma_f32_16x16x32_bf16 v[92:95], a[76:79], a[156:159], v[92:95]
    ds_read_b64_tr_b16 a[20:21], v10 offset:33888
    v_mfma_f32_16x16x32_bf16 v[96:99], a[80:83], a[144:147], v[96:99]
    v_mfma_f32_16x16x32_bf16 v[100:103], a[80:83], a[148:151], v[100:103]
    ds_read_b64_tr_b16 a[22:23], v10 offset:34400
    v_mfma_f32_16x16x32_bf16 v[104:107], a[80:83], a[152:155], v[104:107]
    ds_read_b64_tr_b16 a[24:25], v10 offset:42304
    v_mfma_f32_16x16x32_bf16 v[108:111], a[80:83], a[156:159], v[108:111]
    v_mfma_f32_16x16x32_bf16 v[112:115], a[84:87], a[144:147], v[112:115]
    ds_read_b64_tr_b16 a[26:27], v10 offset:42816
    v_mfma_f32_16x16x32_bf16 v[116:119], a[84:87], a[148:151], v[116:119]
    ds_read_b64_tr_b16 a[28:29], v10 offset:42336
    buffer_load_dwordx4 a[132:135], v4, s[28:31], s23 offen offset:1024
    v_mfma_f32_16x16x32_bf16 v[120:123], a[84:87], a[152:155], v[120:123]
    v_mfma_f32_16x16x32_bf16 v[124:127], a[84:87], a[156:159], v[124:127]
    ds_read_b64_tr_b16 a[30:31], v10 offset:42848
    v_mfma_f32_16x16x32_bf16 v[128:131], a[88:91], a[144:147], v[128:131]
    v_mfma_f32_16x16x32_bf16 v[132:135], a[88:91], a[148:151], v[132:135]
    ds_read_b64_tr_b16 a[32:33], v10 offset:33920
    v_mfma_f32_16x16x32_bf16 v[136:139], a[88:91], a[152:155], v[136:139]
    ds_read_b64_tr_b16 a[34:35], v10 offset:34432
    v_mfma_f32_16x16x32_bf16 v[140:143], a[88:91], a[156:159], v[140:143]
    v_mfma_f32_16x16x32_bf16 v[144:147], a[92:95], a[144:147], v[144:147]
    ds_read_b64_tr_b16 a[36:37], v10 offset:33952
    buffer_load_dwordx4 v8, s[32:35], s25 offen offset:2112 lds
    v_mfma_f32_16x16x32_bf16 v[148:151], a[92:95], a[148:151], v[148:151]
    ds_read_b64_tr_b16 a[38:39], v10 offset:34464
    v_mfma_f32_16x16x32_bf16 v[152:155], a[92:95], a[152:155], v[152:155]
    v_mfma_f32_16x16x32_bf16 v[156:159], a[92:95], a[156:159], v[156:159]
    ds_read_b64_tr_b16 a[40:41], v10 offset:42368
    v_mfma_f32_16x16x32_bf16 v[160:163], a[96:99], a[144:147], v[160:163]
    ds_read_b64_tr_b16 a[42:43], v10 offset:42880
    v_mfma_f32_16x16x32_bf16 v[164:167], a[96:99], a[148:151], v[164:167]
    v_mfma_f32_16x16x32_bf16 v[168:171], a[96:99], a[152:155], v[168:171]
    ds_read_b64_tr_b16 a[44:45], v10 offset:42400
    v_mfma_f32_16x16x32_bf16 v[172:175], a[96:99], a[156:159], v[172:175]
    ds_read_b64_tr_b16 a[46:47], v10 offset:42912
    buffer_load_dwordx4 a[136:139], v5, s[28:31], s23 offen offset:0
    v_mfma_f32_16x16x32_bf16 v[176:179], a[100:103], a[144:147], v[176:179]
    v_mfma_f32_16x16x32_bf16 v[180:183], a[100:103], a[148:151], v[180:183]
    ds_read_b64_tr_b16 a[48:49], v12 offset:33792
    v_mfma_f32_16x16x32_bf16 v[184:187], a[100:103], a[152:155], v[184:187]
    v_mfma_f32_16x16x32_bf16 v[188:191], a[100:103], a[156:159], v[188:191]
    ds_read_b64_tr_b16 a[50:51], v12 offset:34304
    v_mfma_f32_16x16x32_bf16 v[192:195], a[104:107], a[144:147], v[192:195]
    ds_read_b64_tr_b16 a[52:53], v12 offset:33824
    v_mfma_f32_16x16x32_bf16 v[196:199], a[104:107], a[148:151], v[196:199]
    v_mfma_f32_16x16x32_bf16 v[200:203], a[104:107], a[152:155], v[200:203]
    ds_read_b64_tr_b16 a[54:55], v12 offset:34336
    buffer_load_dwordx4 v9, s[32:35], s25 offen offset:3168 lds
    s_add_u32 s25, s25, 229376
    v_mfma_f32_16x16x32_bf16 v[204:207], a[104:107], a[156:159], v[204:207]
    ds_read_b64_tr_b16 a[56:57], v12 offset:42240
    v_mfma_f32_16x16x32_bf16 v[208:211], a[108:111], a[144:147], v[208:211]
    v_mfma_f32_16x16x32_bf16 v[212:215], a[108:111], a[148:151], v[212:215]
    ds_read_b64_tr_b16 a[58:59], v12 offset:42752
    v_mfma_f32_16x16x32_bf16 v[216:219], a[108:111], a[152:155], v[216:219]
    ds_read_b64_tr_b16 a[60:61], v12 offset:42272
    v_mfma_f32_16x16x32_bf16 v[220:223], a[108:111], a[156:159], v[220:223]
    v_mfma_f32_16x16x32_bf16 v[224:227], a[112:115], a[144:147], v[224:227]
    ds_read_b64_tr_b16 a[62:63], v12 offset:42784
    v_mfma_f32_16x16x32_bf16 v[228:231], a[112:115], a[148:151], v[228:231]
    buffer_load_dwordx4 a[140:143], v5, s[28:31], s23 offen offset:1024
    s_add_u32 s23, s23, 0x20000
    v_mfma_f32_16x16x32_bf16 v[232:235], a[116:119], a[144:147], v[232:235]
    v_mfma_f32_16x16x32_bf16 v[236:239], a[116:119], a[148:151], v[236:239]
    v_mfma_f32_16x16x32_bf16 v[240:243], a[120:123], a[144:147], v[240:243]
    v_mfma_f32_16x16x32_bf16 v[244:247], a[120:123], a[148:151], v[244:247]
    v_mfma_f32_16x16x32_bf16 v[248:251], a[124:127], a[144:147], v[248:251]
    v_mfma_f32_16x16x32_bf16 v[252:255], a[124:127], a[148:151], v[252:255]
    s_waitcnt lgkmcnt(0)
    s_waitcnt vmcnt(17)
    s_barrier
    v_mfma_f32_16x16x32_bf16 v[32:35], a[0:3], a[160:163], v[32:35]
    ds_read_b64_tr_b16 a[64:65], v10 offset:50688
    v_mfma_f32_16x16x32_bf16 v[36:39], a[0:3], a[164:167], v[36:39]
    ds_read_b64_tr_b16 a[66:67], v10 offset:51200
    s_add_u32 m0, s22, 101376
    s_nop 0
    buffer_load_dwordx4 v6, s[32:35], s25 offen offset:0 lds
    v_mfma_f32_16x16x32_bf16 v[40:43], a[0:3], a[168:171], v[40:43]
    s_waitcnt vmcnt(17)
    v_mfma_f32_16x16x32_bf16 v[44:47], a[0:3], a[172:175], v[44:47]
    ds_read_b64_tr_b16 a[68:69], v10 offset:50720
    v_mfma_f32_16x16x32_bf16 v[48:51], a[4:7], a[160:163], v[48:51]
    ds_read_b64_tr_b16 a[70:71], v10 offset:51232
    v_mfma_f32_16x16x32_bf16 v[52:55], a[4:7], a[164:167], v[52:55]
    v_mfma_f32_16x16x32_bf16 v[56:59], a[4:7], a[168:171], v[56:59]
    ds_read_b64_tr_b16 a[72:73], v10 offset:59136
    v_mfma_f32_16x16x32_bf16 v[60:63], a[4:7], a[172:175], v[60:63]
    ds_read_b64_tr_b16 a[74:75], v10 offset:59648
    buffer_load_dwordx4 a[144:147], v4, s[28:31], s23 offen offset:0
    v_mfma_f32_16x16x32_bf16 v[64:67], a[8:11], a[160:163], v[64:67]
    v_mfma_f32_16x16x32_bf16 v[68:71], a[8:11], a[164:167], v[68:71]
    ds_read_b64_tr_b16 a[76:77], v10 offset:59168
    v_mfma_f32_16x16x32_bf16 v[72:75], a[8:11], a[168:171], v[72:75]
    ds_read_b64_tr_b16 a[78:79], v10 offset:59680
    v_mfma_f32_16x16x32_bf16 v[76:79], a[8:11], a[172:175], v[76:79]
    v_mfma_f32_16x16x32_bf16 v[80:83], a[12:15], a[160:163], v[80:83]
    ds_read_b64_tr_b16 a[80:81], v10 offset:50752
    v_mfma_f32_16x16x32_bf16 v[84:87], a[12:15], a[164:167], v[84:87]
    v_mfma_f32_16x16x32_bf16 v[88:91], a[12:15], a[168:171], v[88:91]
    ds_read_b64_tr_b16 a[82:83], v10 offset:51264
    buffer_load_dwordx4 v7, s[32:35], s25 offen offset:1056 lds
    v_mfma_f32_16x16x32_bf16 v[92:95], a[12:15], a[172:175], v[92:95]
    ds_read_b64_tr_b16 a[84:85], v10 offset:50784
    v_mfma_f32_16x16x32_bf16 v[96:99], a[16:19], a[160:163], v[96:99]
    v_mfma_f32_16x16x32_bf16 v[100:103], a[16:19], a[164:167], v[100:103]
    ds_read_b64_tr_b16 a[86:87], v10 offset:51296
    v_mfma_f32_16x16x32_bf16 v[104:107], a[16:19], a[168:171], v[104:107]
    ds_read_b64_tr_b16 a[88:89], v10 offset:59200
    v_mfma_f32_16x16x32_bf16 v[108:111], a[16:19], a[172:175], v[108:111]
    v_mfma_f32_16x16x32_bf16 v[112:115], a[20:23], a[160:163], v[112:115]
    ds_read_b64_tr_b16 a[90:91], v10 offset:59712
    v_mfma_f32_16x16x32_bf16 v[116:119], a[20:23], a[164:167], v[116:119]
    ds_read_b64_tr_b16 a[92:93], v10 offset:59232
    buffer_load_dwordx4 a[148:151], v4, s[28:31], s23 offen offset:1024
    v_mfma_f32_16x16x32_bf16 v[120:123], a[20:23], a[168:171], v[120:123]
    v_mfma_f32_16x16x32_bf16 v[124:127], a[20:23], a[172:175], v[124:127]
    ds_read_b64_tr_b16 a[94:95], v10 offset:59744
    v_mfma_f32_16x16x32_bf16 v[128:131], a[24:27], a[160:163], v[128:131]
    v_mfma_f32_16x16x32_bf16 v[132:135], a[24:27], a[164:167], v[132:135]
    ds_read_b64_tr_b16 a[96:97], v10 offset:50816
    v_mfma_f32_16x16x32_bf16 v[136:139], a[24:27], a[168:171], v[136:139]
    ds_read_b64_tr_b16 a[98:99], v10 offset:51328
    v_mfma_f32_16x16x32_bf16 v[140:143], a[24:27], a[172:175], v[140:143]
    v_mfma_f32_16x16x32_bf16 v[144:147], a[28:31], a[160:163], v[144:147]
    ds_read_b64_tr_b16 a[100:101], v10 offset:50848
    buffer_load_dwordx4 v8, s[32:35], s25 offen offset:2112 lds
    v_mfma_f32_16x16x32_bf16 v[148:151], a[28:31], a[164:167], v[148:151]
    ds_read_b64_tr_b16 a[102:103], v10 offset:51360
    v_mfma_f32_16x16x32_bf16 v[152:155], a[28:31], a[168:171], v[152:155]
    v_mfma_f32_16x16x32_bf16 v[156:159], a[28:31], a[172:175], v[156:159]
    ds_read_b64_tr_b16 a[104:105], v10 offset:59264
    v_mfma_f32_16x16x32_bf16 v[160:163], a[32:35], a[160:163], v[160:163]
    ds_read_b64_tr_b16 a[106:107], v10 offset:59776
    v_mfma_f32_16x16x32_bf16 v[164:167], a[32:35], a[164:167], v[164:167]
    v_mfma_f32_16x16x32_bf16 v[168:171], a[32:35], a[168:171], v[168:171]
    ds_read_b64_tr_b16 a[108:109], v10 offset:59296
    v_mfma_f32_16x16x32_bf16 v[172:175], a[32:35], a[172:175], v[172:175]
    ds_read_b64_tr_b16 a[110:111], v10 offset:59808
    buffer_load_dwordx4 a[152:155], v5, s[28:31], s23 offen offset:0
    v_mfma_f32_16x16x32_bf16 v[176:179], a[36:39], a[160:163], v[176:179]
    v_mfma_f32_16x16x32_bf16 v[180:183], a[36:39], a[164:167], v[180:183]
    ds_read_b64_tr_b16 a[112:113], v12 offset:50688
    v_mfma_f32_16x16x32_bf16 v[184:187], a[36:39], a[168:171], v[184:187]
    v_mfma_f32_16x16x32_bf16 v[188:191], a[36:39], a[172:175], v[188:191]
    ds_read_b64_tr_b16 a[114:115], v12 offset:51200
    v_mfma_f32_16x16x32_bf16 v[192:195], a[40:43], a[160:163], v[192:195]
    ds_read_b64_tr_b16 a[116:117], v12 offset:50720
    v_mfma_f32_16x16x32_bf16 v[196:199], a[40:43], a[164:167], v[196:199]
    v_mfma_f32_16x16x32_bf16 v[200:203], a[40:43], a[168:171], v[200:203]
    ds_read_b64_tr_b16 a[118:119], v12 offset:51232
    buffer_load_dwordx4 v9, s[32:35], s25 offen offset:3168 lds
    s_add_u32 s25, s25, 229376
    v_mfma_f32_16x16x32_bf16 v[204:207], a[40:43], a[172:175], v[204:207]
    ds_read_b64_tr_b16 a[120:121], v12 offset:59136
    v_mfma_f32_16x16x32_bf16 v[208:211], a[44:47], a[160:163], v[208:211]
    v_mfma_f32_16x16x32_bf16 v[212:215], a[44:47], a[164:167], v[212:215]
    ds_read_b64_tr_b16 a[122:123], v12 offset:59648
    v_mfma_f32_16x16x32_bf16 v[216:219], a[44:47], a[168:171], v[216:219]
    ds_read_b64_tr_b16 a[124:125], v12 offset:59168
    v_mfma_f32_16x16x32_bf16 v[220:223], a[44:47], a[172:175], v[220:223]
    v_mfma_f32_16x16x32_bf16 v[224:227], a[48:51], a[160:163], v[224:227]
    ds_read_b64_tr_b16 a[126:127], v12 offset:59680
    v_mfma_f32_16x16x32_bf16 v[228:231], a[48:51], a[164:167], v[228:231]
    buffer_load_dwordx4 a[156:159], v5, s[28:31], s23 offen offset:1024
    s_add_u32 s23, s23, 0x20000
    v_mfma_f32_16x16x32_bf16 v[232:235], a[52:55], a[160:163], v[232:235]
    v_mfma_f32_16x16x32_bf16 v[236:239], a[52:55], a[164:167], v[236:239]
    v_mfma_f32_16x16x32_bf16 v[240:243], a[56:59], a[160:163], v[240:243]
    v_mfma_f32_16x16x32_bf16 v[244:247], a[56:59], a[164:167], v[244:247]
    v_mfma_f32_16x16x32_bf16 v[248:251], a[60:63], a[160:163], v[248:251]
    v_mfma_f32_16x16x32_bf16 v[252:255], a[60:63], a[164:167], v[252:255]
    s_waitcnt lgkmcnt(0)
    s_waitcnt vmcnt(17)
    s_barrier
    v_mfma_f32_16x16x32_bf16 v[32:35], a[64:67], a[176:179], v[32:35]
    ds_read_b64_tr_b16 a[0:1], v11 offset:0
    v_mfma_f32_16x16x32_bf16 v[36:39], a[64:67], a[180:183], v[36:39]
    ds_read_b64_tr_b16 a[2:3], v11 offset:512
    s_add_u32 m0, s22, 118272
    s_nop 0
    buffer_load_dwordx4 v6, s[32:35], s25 offen offset:0 lds
    v_mfma_f32_16x16x32_bf16 v[40:43], a[64:67], a[184:187], v[40:43]
    s_waitcnt vmcnt(17)
    v_mfma_f32_16x16x32_bf16 v[44:47], a[64:67], a[188:191], v[44:47]
    ds_read_b64_tr_b16 a[4:5], v11 offset:32
    v_mfma_f32_16x16x32_bf16 v[48:51], a[68:71], a[176:179], v[48:51]
    ds_read_b64_tr_b16 a[6:7], v11 offset:544
    v_mfma_f32_16x16x32_bf16 v[52:55], a[68:71], a[180:183], v[52:55]
    v_mfma_f32_16x16x32_bf16 v[56:59], a[68:71], a[184:187], v[56:59]
    ds_read_b64_tr_b16 a[8:9], v11 offset:8448
    v_mfma_f32_16x16x32_bf16 v[60:63], a[68:71], a[188:191], v[60:63]
    ds_read_b64_tr_b16 a[10:11], v11 offset:8960
    buffer_load_dwordx4 a[160:163], v4, s[28:31], s23 offen offset:0
    v_mfma_f32_16x16x32_bf16 v[64:67], a[72:75], a[176:179], v[64:67]
    v_mfma_f32_16x16x32_bf16 v[68:71], a[72:75], a[180:183], v[68:71]
    ds_read_b64_tr_b16 a[12:13], v11 offset:8480
    v_mfma_f32_16x16x32_bf16 v[72:75], a[72:75], a[184:187], v[72:75]
    ds_read_b64_tr_b16 a[14:15], v11 offset:8992
    v_mfma_f32_16x16x32_bf16 v[76:79], a[72:75], a[188:191], v[76:79]
    v_mfma_f32_16x16x32_bf16 v[80:83], a[76:79], a[176:179], v[80:83]
    ds_read_b64_tr_b16 a[16:17], v11 offset:64
    v_mfma_f32_16x16x32_bf16 v[84:87], a[76:79], a[180:183], v[84:87]
    v_mfma_f32_16x16x32_bf16 v[88:91], a[76:79], a[184:187], v[88:91]
    ds_read_b64_tr_b16 a[18:19], v11 offset:576
    buffer_load_dwordx4 v7, s[32:35], s25 offen offset:1056 lds
    v_mfma_f32_16x16x32_bf16 v[92:95], a[76:79], a[188:191], v[92:95]
    ds_read_b64_tr_b16 a[20:21], v11 offset:96
    v_mfma_f32_16x16x32_bf16 v[96:99], a[80:83], a[176:179], v[96:99]
    v_mfma_f32_16x16x32_bf16 v[100:103], a[80:83], a[180:183], v[100:103]
    ds_read_b64_tr_b16 a[22:23], v11 offset:608
    v_mfma_f32_16x16x32_bf16 v[104:107], a[80:83], a[184:187], v[104:107]
    ds_read_b64_tr_b16 a[24:25], v11 offset:8512
    v_mfma_f32_16x16x32_bf16 v[108:111], a[80:83], a[188:191], v[108:111]
    v_mfma_f32_16x16x32_bf16 v[112:115], a[84:87], a[176:179], v[112:115]
    ds_read_b64_tr_b16 a[26:27], v11 offset:9024
    v_mfma_f32_16x16x32_bf16 v[116:119], a[84:87], a[180:183], v[116:119]
    ds_read_b64_tr_b16 a[28:29], v11 offset:8544
    buffer_load_dwordx4 a[164:167], v4, s[28:31], s23 offen offset:1024
    v_mfma_f32_16x16x32_bf16 v[120:123], a[84:87], a[184:187], v[120:123]
    v_mfma_f32_16x16x32_bf16 v[124:127], a[84:87], a[188:191], v[124:127]
    ds_read_b64_tr_b16 a[30:31], v11 offset:9056
    v_mfma_f32_16x16x32_bf16 v[128:131], a[88:91], a[176:179], v[128:131]
    v_mfma_f32_16x16x32_bf16 v[132:135], a[88:91], a[180:183], v[132:135]
    ds_read_b64_tr_b16 a[32:33], v11 offset:128
    v_mfma_f32_16x16x32_bf16 v[136:139], a[88:91], a[184:187], v[136:139]
    ds_read_b64_tr_b16 a[34:35], v11 offset:640
    v_mfma_f32_16x16x32_bf16 v[140:143], a[88:91], a[188:191], v[140:143]
    v_mfma_f32_16x16x32_bf16 v[144:147], a[92:95], a[176:179], v[144:147]
    ds_read_b64_tr_b16 a[36:37], v11 offset:160
    buffer_load_dwordx4 v8, s[32:35], s25 offen offset:2112 lds
    v_mfma_f32_16x16x32_bf16 v[148:151], a[92:95], a[180:183], v[148:151]
    ds_read_b64_tr_b16 a[38:39], v11 offset:672
    v_mfma_f32_16x16x32_bf16 v[152:155], a[92:95], a[184:187], v[152:155]
    v_mfma_f32_16x16x32_bf16 v[156:159], a[92:95], a[188:191], v[156:159]
    ds_read_b64_tr_b16 a[40:41], v11 offset:8576
    v_mfma_f32_16x16x32_bf16 v[160:163], a[96:99], a[176:179], v[160:163]
    ds_read_b64_tr_b16 a[42:43], v11 offset:9088
    v_mfma_f32_16x16x32_bf16 v[164:167], a[96:99], a[180:183], v[164:167]
    v_mfma_f32_16x16x32_bf16 v[168:171], a[96:99], a[184:187], v[168:171]
    ds_read_b64_tr_b16 a[44:45], v11 offset:8608
    v_mfma_f32_16x16x32_bf16 v[172:175], a[96:99], a[188:191], v[172:175]
    ds_read_b64_tr_b16 a[46:47], v11 offset:9120
    buffer_load_dwordx4 a[168:171], v5, s[28:31], s23 offen offset:0
    v_mfma_f32_16x16x32_bf16 v[176:179], a[100:103], a[176:179], v[176:179]
    v_mfma_f32_16x16x32_bf16 v[180:183], a[100:103], a[180:183], v[180:183]
    ds_read_b64_tr_b16 a[48:49], v13 offset:0
    v_mfma_f32_16x16x32_bf16 v[184:187], a[100:103], a[184:187], v[184:187]
    v_mfma_f32_16x16x32_bf16 v[188:191], a[100:103], a[188:191], v[188:191]
    ds_read_b64_tr_b16 a[50:51], v13 offset:512
    v_mfma_f32_16x16x32_bf16 v[192:195], a[104:107], a[176:179], v[192:195]
    ds_read_b64_tr_b16 a[52:53], v13 offset:32
    v_mfma_f32_16x16x32_bf16 v[196:199], a[104:107], a[180:183], v[196:199]
    v_mfma_f32_16x16x32_bf16 v[200:203], a[104:107], a[184:187], v[200:203]
    ds_read_b64_tr_b16 a[54:55], v13 offset:544
    buffer_load_dwordx4 v9, s[32:35], s25 offen offset:3168 lds
    s_add_u32 s25, s25, 229376
    v_mfma_f32_16x16x32_bf16 v[204:207], a[104:107], a[188:191], v[204:207]
    ds_read_b64_tr_b16 a[56:57], v13 offset:8448
    v_mfma_f32_16x16x32_bf16 v[208:211], a[108:111], a[176:179], v[208:211]
    v_mfma_f32_16x16x32_bf16 v[212:215], a[108:111], a[180:183], v[212:215]
    ds_read_b64_tr_b16 a[58:59], v13 offset:8960
    v_mfma_f32_16x16x32_bf16 v[216:219], a[108:111], a[184:187], v[216:219]
    ds_read_b64_tr_b16 a[60:61], v13 offset:8480
    v_mfma_f32_16x16x32_bf16 v[220:223], a[108:111], a[188:191], v[220:223]
    v_mfma_f32_16x16x32_bf16 v[224:227], a[112:115], a[176:179], v[224:227]
    ds_read_b64_tr_b16 a[62:63], v13 offset:8992
    v_mfma_f32_16x16x32_bf16 v[228:231], a[112:115], a[180:183], v[228:231]
    buffer_load_dwordx4 a[172:175], v5, s[28:31], s23 offen offset:1024
    s_add_u32 s23, s23, 0x20000
    v_mfma_f32_16x16x32_bf16 v[232:235], a[116:119], a[176:179], v[232:235]
    v_mfma_f32_16x16x32_bf16 v[236:239], a[116:119], a[180:183], v[236:239]
    v_mfma_f32_16x16x32_bf16 v[240:243], a[120:123], a[176:179], v[240:243]
    v_mfma_f32_16x16x32_bf16 v[244:247], a[120:123], a[180:183], v[244:247]
    v_mfma_f32_16x16x32_bf16 v[248:251], a[124:127], a[176:179], v[248:251]
    v_mfma_f32_16x16x32_bf16 v[252:255], a[124:127], a[180:183], v[252:255]
    s_waitcnt lgkmcnt(0)
    s_waitcnt vmcnt(17)
    s_barrier
    v_mfma_f32_16x16x32_bf16 v[32:35], a[0:3], a[128:131], v[32:35]
    ds_read_b64_tr_b16 a[64:65], v11 offset:16896
    v_mfma_f32_16x16x32_bf16 v[36:39], a[0:3], a[132:135], v[36:39]
    ds_read_b64_tr_b16 a[66:67], v11 offset:17408
    buffer_load_dwordx4 a[176:179], v4, s[28:31], s23 offen offset:0
    v_mfma_f32_16x16x32_bf16 v[40:43], a[0:3], a[136:139], v[40:43]
    s_waitcnt vmcnt(17)
    v_mfma_f32_16x16x32_bf16 v[44:47], a[0:3], a[140:143], v[44:47]
    ds_read_b64_tr_b16 a[68:69], v11 offset:16928
    v_mfma_f32_16x16x32_bf16 v[48:51], a[4:7], a[128:131], v[48:51]
    ds_read_b64_tr_b16 a[70:71], v11 offset:17440
    v_mfma_f32_16x16x32_bf16 v[52:55], a[4:7], a[132:135], v[52:55]
    v_mfma_f32_16x16x32_bf16 v[56:59], a[4:7], a[136:139], v[56:59]
    ds_read_b64_tr_b16 a[72:73], v11 offset:25344
    v_mfma_f32_16x16x32_bf16 v[60:63], a[4:7], a[140:143], v[60:63]
    ds_read_b64_tr_b16 a[74:75], v11 offset:25856
    v_mfma_f32_16x16x32_bf16 v[64:67], a[8:11], a[128:131], v[64:67]
    v_mfma_f32_16x16x32_bf16 v[68:71], a[8:11], a[132:135], v[68:71]
    ds_read_b64_tr_b16 a[76:77], v11 offset:25376
    v_mfma_f32_16x16x32_bf16 v[72:75], a[8:11], a[136:139], v[72:75]
    ds_read_b64_tr_b16 a[78:79], v11 offset:25888
    v_mfma_f32_16x16x32_bf16 v[76:79], a[8:11], a[140:143], v[76:79]
    v_mfma_f32_16x16x32_bf16 v[80:83], a[12:15], a[128:131], v[80:83]
    ds_read_b64_tr_b16 a[80:81], v11 offset:16960
    v_mfma_f32_16x16x32_bf16 v[84:87], a[12:15], a[132:135], v[84:87]
    v_mfma_f32_16x16x32_bf16 v[88:91], a[12:15], a[136:139], v[88:91]
    ds_read_b64_tr_b16 a[82:83], v11 offset:17472
    buffer_load_dwordx4 a[180:183], v4, s[28:31], s23 offen offset:1024
    v_mfma_f32_16x16x32_bf16 v[92:95], a[12:15], a[140:143], v[92:95]
    ds_read_b64_tr_b16 a[84:85], v11 offset:16992
    v_mfma_f32_16x16x32_bf16 v[96:99], a[16:19], a[128:131], v[96:99]
    v_mfma_f32_16x16x32_bf16 v[100:103], a[16:19], a[132:135], v[100:103]
    ds_read_b64_tr_b16 a[86:87], v11 offset:17504
    v_mfma_f32_16x16x32_bf16 v[104:107], a[16:19], a[136:139], v[104:107]
    ds_read_b64_tr_b16 a[88:89], v11 offset:25408
    v_mfma_f32_16x16x32_bf16 v[108:111], a[16:19], a[140:143], v[108:111]
    v_mfma_f32_16x16x32_bf16 v[112:115], a[20:23], a[128:131], v[112:115]
    ds_read_b64_tr_b16 a[90:91], v11 offset:25920
    v_mfma_f32_16x16x32_bf16 v[116:119], a[20:23], a[132:135], v[116:119]
    ds_read_b64_tr_b16 a[92:93], v11 offset:25440
    v_mfma_f32_16x16x32_bf16 v[120:123], a[20:23], a[136:139], v[120:123]
    v_mfma_f32_16x16x32_bf16 v[124:127], a[20:23], a[140:143], v[124:127]
    ds_read_b64_tr_b16 a[94:95], v11 offset:25952
    v_mfma_f32_16x16x32_bf16 v[128:131], a[24:27], a[128:131], v[128:131]
    v_mfma_f32_16x16x32_bf16 v[132:135], a[24:27], a[132:135], v[132:135]
    ds_read_b64_tr_b16 a[96:97], v11 offset:17024
    v_mfma_f32_16x16x32_bf16 v[136:139], a[24:27], a[136:139], v[136:139]
    ds_read_b64_tr_b16 a[98:99], v11 offset:17536
    v_mfma_f32_16x16x32_bf16 v[140:143], a[24:27], a[140:143], v[140:143]
    v_mfma_f32_16x16x32_bf16 v[144:147], a[28:31], a[128:131], v[144:147]
    ds_read_b64_tr_b16 a[100:101], v11 offset:17056
    buffer_load_dwordx4 a[184:187], v5, s[28:31], s23 offen offset:0
    v_mfma_f32_16x16x32_bf16 v[148:151], a[28:31], a[132:135], v[148:151]
    ds_read_b64_tr_b16 a[102:103], v11 offset:17568
    v_mfma_f32_16x16x32_bf16 v[152:155], a[28:31], a[136:139], v[152:155]
    v_mfma_f32_16x16x32_bf16 v[156:159], a[28:31], a[140:143], v[156:159]
    ds_read_b64_tr_b16 a[104:105], v11 offset:25472
    v_mfma_f32_16x16x32_bf16 v[160:163], a[32:35], a[128:131], v[160:163]
    ds_read_b64_tr_b16 a[106:107], v11 offset:25984
    v_mfma_f32_16x16x32_bf16 v[164:167], a[32:35], a[132:135], v[164:167]
    v_mfma_f32_16x16x32_bf16 v[168:171], a[32:35], a[136:139], v[168:171]
    ds_read_b64_tr_b16 a[108:109], v11 offset:25504
    v_mfma_f32_16x16x32_bf16 v[172:175], a[32:35], a[140:143], v[172:175]
    ds_read_b64_tr_b16 a[110:111], v11 offset:26016
    v_mfma_f32_16x16x32_bf16 v[176:179], a[36:39], a[128:131], v[176:179]
    v_mfma_f32_16x16x32_bf16 v[180:183], a[36:39], a[132:135], v[180:183]
    ds_read_b64_tr_b16 a[112:113], v13 offset:16896
    v_mfma_f32_16x16x32_bf16 v[184:187], a[36:39], a[136:139], v[184:187]
    v_mfma_f32_16x16x32_bf16 v[188:191], a[36:39], a[140:143], v[188:191]
    ds_read_b64_tr_b16 a[114:115], v13 offset:17408
    v_mfma_f32_16x16x32_bf16 v[192:195], a[40:43], a[128:131], v[192:195]
    ds_read_b64_tr_b16 a[116:117], v13 offset:16928
    v_mfma_f32_16x16x32_bf16 v[196:199], a[40:43], a[132:135], v[196:199]
    v_mfma_f32_16x16x32_bf16 v[200:203], a[40:43], a[136:139], v[200:203]
    ds_read_b64_tr_b16 a[118:119], v13 offset:17440
    buffer_load_dwordx4 a[188:191], v5, s[28:31], s23 offen offset:1024
    s_add_u32 s23, s23, 0x20000
    v_mfma_f32_16x16x32_bf16 v[204:207], a[40:43], a[140:143], v[204:207]
    ds_read_b64_tr_b16 a[120:121], v13 offset:25344
    v_mfma_f32_16x16x32_bf16 v[208:211], a[44:47], a[128:131], v[208:211]
    v_mfma_f32_16x16x32_bf16 v[212:215], a[44:47], a[132:135], v[212:215]
    ds_read_b64_tr_b16 a[122:123], v13 offset:25856
    v_mfma_f32_16x16x32_bf16 v[216:219], a[44:47], a[136:139], v[216:219]
    ds_read_b64_tr_b16 a[124:125], v13 offset:25376
    v_mfma_f32_16x16x32_bf16 v[220:223], a[44:47], a[140:143], v[220:223]
    v_mfma_f32_16x16x32_bf16 v[224:227], a[48:51], a[128:131], v[224:227]
    ds_read_b64_tr_b16 a[126:127], v13 offset:25888
    v_mfma_f32_16x16x32_bf16 v[228:231], a[48:51], a[132:135], v[228:231]
    v_mfma_f32_16x16x32_bf16 v[232:235], a[52:55], a[128:131], v[232:235]
    v_mfma_f32_16x16x32_bf16 v[236:239], a[52:55], a[132:135], v[236:239]
    v_mfma_f32_16x16x32_bf16 v[240:243], a[56:59], a[128:131], v[240:243]
    v_mfma_f32_16x16x32_bf16 v[244:247], a[56:59], a[132:135], v[244:247]
    v_mfma_f32_16x16x32_bf16 v[248:251], a[60:63], a[128:131], v[248:251]
    v_mfma_f32_16x16x32_bf16 v[252:255], a[60:63], a[132:135], v[252:255]
    s_waitcnt lgkmcnt(0)
    s_waitcnt vmcnt(13)
    s_barrier
    v_mfma_f32_16x16x32_bf16 v[32:35], a[64:67], a[144:147], v[32:35]
    ds_read_b64_tr_b16 a[0:1], v11 offset:33792
    v_mfma_f32_16x16x32_bf16 v[36:39], a[64:67], a[148:151], v[36:39]
    ds_read_b64_tr_b16 a[2:3], v11 offset:34304
    v_mfma_f32_16x16x32_bf16 v[40:43], a[64:67], a[152:155], v[40:43]
    s_waitcnt vmcnt(12)
    v_mfma_f32_16x16x32_bf16 v[44:47], a[64:67], a[156:159], v[44:47]
    ds_read_b64_tr_b16 a[4:5], v11 offset:33824
    v_mfma_f32_16x16x32_bf16 v[48:51], a[68:71], a[144:147], v[48:51]
    ds_read_b64_tr_b16 a[6:7], v11 offset:34336
    v_mfma_f32_16x16x32_bf16 v[52:55], a[68:71], a[148:151], v[52:55]
    v_mfma_f32_16x16x32_bf16 v[56:59], a[68:71], a[152:155], v[56:59]
    ds_read_b64_tr_b16 a[8:9], v11 offset:42240
    v_mfma_f32_16x16x32_bf16 v[60:63], a[68:71], a[156:159], v[60:63]
    ds_read_b64_tr_b16 a[10:11], v11 offset:42752
    v_mfma_f32_16x16x32_bf16 v[64:67], a[72:75], a[144:147], v[64:67]
    v_mfma_f32_16x16x32_bf16 v[68:71], a[72:75], a[148:151], v[68:71]
    ds_read_b64_tr_b16 a[12:13], v11 offset:42272
    v_mfma_f32_16x16x32_bf16 v[72:75], a[72:75], a[152:155], v[72:75]
    ds_read_b64_tr_b16 a[14:15], v11 offset:42784
    v_mfma_f32_16x16x32_bf16 v[76:79], a[72:75], a[156:159], v[76:79]
    v_mfma_f32_16x16x32_bf16 v[80:83], a[76:79], a[144:147], v[80:83]
    ds_read_b64_tr_b16 a[16:17], v11 offset:33856
    v_mfma_f32_16x16x32_bf16 v[84:87], a[76:79], a[148:151], v[84:87]
    v_mfma_f32_16x16x32_bf16 v[88:91], a[76:79], a[152:155], v[88:91]
    ds_read_b64_tr_b16 a[18:19], v11 offset:34368
    v_mfma_f32_16x16x32_bf16 v[92:95], a[76:79], a[156:159], v[92:95]
    ds_read_b64_tr_b16 a[20:21], v11 offset:33888
    v_mfma_f32_16x16x32_bf16 v[96:99], a[80:83], a[144:147], v[96:99]
    v_mfma_f32_16x16x32_bf16 v[100:103], a[80:83], a[148:151], v[100:103]
    ds_read_b64_tr_b16 a[22:23], v11 offset:34400
    v_mfma_f32_16x16x32_bf16 v[104:107], a[80:83], a[152:155], v[104:107]
    ds_read_b64_tr_b16 a[24:25], v11 offset:42304
    v_mfma_f32_16x16x32_bf16 v[108:111], a[80:83], a[156:159], v[108:111]
    v_mfma_f32_16x16x32_bf16 v[112:115], a[84:87], a[144:147], v[112:115]
    ds_read_b64_tr_b16 a[26:27], v11 offset:42816
    v_mfma_f32_16x16x32_bf16 v[116:119], a[84:87], a[148:151], v[116:119]
    ds_read_b64_tr_b16 a[28:29], v11 offset:42336
    v_mfma_f32_16x16x32_bf16 v[120:123], a[84:87], a[152:155], v[120:123]
    v_mfma_f32_16x16x32_bf16 v[124:127], a[84:87], a[156:159], v[124:127]
    ds_read_b64_tr_b16 a[30:31], v11 offset:42848
    v_mfma_f32_16x16x32_bf16 v[128:131], a[88:91], a[144:147], v[128:131]
    v_mfma_f32_16x16x32_bf16 v[132:135], a[88:91], a[148:151], v[132:135]
    ds_read_b64_tr_b16 a[32:33], v11 offset:33920
    v_mfma_f32_16x16x32_bf16 v[136:139], a[88:91], a[152:155], v[136:139]
    ds_read_b64_tr_b16 a[34:35], v11 offset:34432
    v_mfma_f32_16x16x32_bf16 v[140:143], a[88:91], a[156:159], v[140:143]
    v_mfma_f32_16x16x32_bf16 v[144:147], a[92:95], a[144:147], v[144:147]
    ds_read_b64_tr_b16 a[36:37], v11 offset:33952
    v_mfma_f32_16x16x32_bf16 v[148:151], a[92:95], a[148:151], v[148:151]
    ds_read_b64_tr_b16 a[38:39], v11 offset:34464
    v_mfma_f32_16x16x32_bf16 v[152:155], a[92:95], a[152:155], v[152:155]
    v_mfma_f32_16x16x32_bf16 v[156:159], a[92:95], a[156:159], v[156:159]
    ds_read_b64_tr_b16 a[40:41], v11 offset:42368
    v_mfma_f32_16x16x32_bf16 v[160:163], a[96:99], a[144:147], v[160:163]
    ds_read_b64_tr_b16 a[42:43], v11 offset:42880
    v_mfma_f32_16x16x32_bf16 v[164:167], a[96:99], a[148:151], v[164:167]
    v_mfma_f32_16x16x32_bf16 v[168:171], a[96:99], a[152:155], v[168:171]
    ds_read_b64_tr_b16 a[44:45], v11 offset:42400
    v_mfma_f32_16x16x32_bf16 v[172:175], a[96:99], a[156:159], v[172:175]
    ds_read_b64_tr_b16 a[46:47], v11 offset:42912
    v_mfma_f32_16x16x32_bf16 v[176:179], a[100:103], a[144:147], v[176:179]
    v_mfma_f32_16x16x32_bf16 v[180:183], a[100:103], a[148:151], v[180:183]
    ds_read_b64_tr_b16 a[48:49], v13 offset:33792
    v_mfma_f32_16x16x32_bf16 v[184:187], a[100:103], a[152:155], v[184:187]
    v_mfma_f32_16x16x32_bf16 v[188:191], a[100:103], a[156:159], v[188:191]
    ds_read_b64_tr_b16 a[50:51], v13 offset:34304
    v_mfma_f32_16x16x32_bf16 v[192:195], a[104:107], a[144:147], v[192:195]
    ds_read_b64_tr_b16 a[52:53], v13 offset:33824
    v_mfma_f32_16x16x32_bf16 v[196:199], a[104:107], a[148:151], v[196:199]
    v_mfma_f32_16x16x32_bf16 v[200:203], a[104:107], a[152:155], v[200:203]
    ds_read_b64_tr_b16 a[54:55], v13 offset:34336
    v_mfma_f32_16x16x32_bf16 v[204:207], a[104:107], a[156:159], v[204:207]
    ds_read_b64_tr_b16 a[56:57], v13 offset:42240
    v_mfma_f32_16x16x32_bf16 v[208:211], a[108:111], a[144:147], v[208:211]
    v_mfma_f32_16x16x32_bf16 v[212:215], a[108:111], a[148:151], v[212:215]
    ds_read_b64_tr_b16 a[58:59], v13 offset:42752
    v_mfma_f32_16x16x32_bf16 v[216:219], a[108:111], a[152:155], v[216:219]
    ds_read_b64_tr_b16 a[60:61], v13 offset:42272
    v_mfma_f32_16x16x32_bf16 v[220:223], a[108:111], a[156:159], v[220:223]
    v_mfma_f32_16x16x32_bf16 v[224:227], a[112:115], a[144:147], v[224:227]
    ds_read_b64_tr_b16 a[62:63], v13 offset:42784
    v_mfma_f32_16x16x32_bf16 v[228:231], a[112:115], a[148:151], v[228:231]
    v_mfma_f32_16x16x32_bf16 v[232:235], a[116:119], a[144:147], v[232:235]
    v_mfma_f32_16x16x32_bf16 v[236:239], a[116:119], a[148:151], v[236:239]
    v_mfma_f32_16x16x32_bf16 v[240:243], a[120:123], a[144:147], v[240:243]
    v_mfma_f32_16x16x32_bf16 v[244:247], a[120:123], a[148:151], v[244:247]
    v_mfma_f32_16x16x32_bf16 v[248:251], a[124:127], a[144:147], v[248:251]
    v_mfma_f32_16x16x32_bf16 v[252:255], a[124:127], a[148:151], v[252:255]
    s_waitcnt lgkmcnt(0)
    s_waitcnt vmcnt(5)
    s_barrier
    v_mfma_f32_16x16x32_bf16 v[32:35], a[0:3], a[160:163], v[32:35]
    ds_read_b64_tr_b16 a[64:65], v11 offset:50688
    v_mfma_f32_16x16x32_bf16 v[36:39], a[0:3], a[164:167], v[36:39]
    ds_read_b64_tr_b16 a[66:67], v11 offset:51200
    v_mfma_f32_16x16x32_bf16 v[40:43], a[0:3], a[168:171], v[40:43]
    s_waitcnt vmcnt(4)
    v_mfma_f32_16x16x32_bf16 v[44:47], a[0:3], a[172:175], v[44:47]
    ds_read_b64_tr_b16 a[68:69], v11 offset:50720
    v_mfma_f32_16x16x32_bf16 v[48:51], a[4:7], a[160:163], v[48:51]
    ds_read_b64_tr_b16 a[70:71], v11 offset:51232
    v_mfma_f32_16x16x32_bf16 v[52:55], a[4:7], a[164:167], v[52:55]
    v_mfma_f32_16x16x32_bf16 v[56:59], a[4:7], a[168:171], v[56:59]
    ds_read_b64_tr_b16 a[72:73], v11 offset:59136
    v_mfma_f32_16x16x32_bf16 v[60:63], a[4:7], a[172:175], v[60:63]
    ds_read_b64_tr_b16 a[74:75], v11 offset:59648
    v_mfma_f32_16x16x32_bf16 v[64:67], a[8:11], a[160:163], v[64:67]
    v_mfma_f32_16x16x32_bf16 v[68:71], a[8:11], a[164:167], v[68:71]
    ds_read_b64_tr_b16 a[76:77], v11 offset:59168
    v_mfma_f32_16x16x32_bf16 v[72:75], a[8:11], a[168:171], v[72:75]
    ds_read_b64_tr_b16 a[78:79], v11 offset:59680
    v_mfma_f32_16x16x32_bf16 v[76:79], a[8:11], a[172:175], v[76:79]
    v_mfma_f32_16x16x32_bf16 v[80:83], a[12:15], a[160:163], v[80:83]
    ds_read_b64_tr_b16 a[80:81], v11 offset:50752
    v_mfma_f32_16x16x32_bf16 v[84:87], a[12:15], a[164:167], v[84:87]
    v_mfma_f32_16x16x32_bf16 v[88:91], a[12:15], a[168:171], v[88:91]
    ds_read_b64_tr_b16 a[82:83], v11 offset:51264
    v_mfma_f32_16x16x32_bf16 v[92:95], a[12:15], a[172:175], v[92:95]
    ds_read_b64_tr_b16 a[84:85], v11 offset:50784
    v_mfma_f32_16x16x32_bf16 v[96:99], a[16:19], a[160:163], v[96:99]
    v_mfma_f32_16x16x32_bf16 v[100:103], a[16:19], a[164:167], v[100:103]
    ds_read_b64_tr_b16 a[86:87], v11 offset:51296
    v_mfma_f32_16x16x32_bf16 v[104:107], a[16:19], a[168:171], v[104:107]
    ds_read_b64_tr_b16 a[88:89], v11 offset:59200
    v_mfma_f32_16x16x32_bf16 v[108:111], a[16:19], a[172:175], v[108:111]
    v_mfma_f32_16x16x32_bf16 v[112:115], a[20:23], a[160:163], v[112:115]
    ds_read_b64_tr_b16 a[90:91], v11 offset:59712
    v_mfma_f32_16x16x32_bf16 v[116:119], a[20:23], a[164:167], v[116:119]
    ds_read_b64_tr_b16 a[92:93], v11 offset:59232
    v_mfma_f32_16x16x32_bf16 v[120:123], a[20:23], a[168:171], v[120:123]
    v_mfma_f32_16x16x32_bf16 v[124:127], a[20:23], a[172:175], v[124:127]
    ds_read_b64_tr_b16 a[94:95], v11 offset:59744
    v_mfma_f32_16x16x32_bf16 v[128:131], a[24:27], a[160:163], v[128:131]
    v_mfma_f32_16x16x32_bf16 v[132:135], a[24:27], a[164:167], v[132:135]
    ds_read_b64_tr_b16 a[96:97], v11 offset:50816
    v_mfma_f32_16x16x32_bf16 v[136:139], a[24:27], a[168:171], v[136:139]
    ds_read_b64_tr_b16 a[98:99], v11 offset:51328
    v_mfma_f32_16x16x32_bf16 v[140:143], a[24:27], a[172:175], v[140:143]
    v_mfma_f32_16x16x32_bf16 v[144:147], a[28:31], a[160:163], v[144:147]
    ds_read_b64_tr_b16 a[100:101], v11 offset:50848
    v_mfma_f32_16x16x32_bf16 v[148:151], a[28:31], a[164:167], v[148:151]
    ds_read_b64_tr_b16 a[102:103], v11 offset:51360
    v_mfma_f32_16x16x32_bf16 v[152:155], a[28:31], a[168:171], v[152:155]
    v_mfma_f32_16x16x32_bf16 v[156:159], a[28:31], a[172:175], v[156:159]
    ds_read_b64_tr_b16 a[104:105], v11 offset:59264
    v_mfma_f32_16x16x32_bf16 v[160:163], a[32:35], a[160:163], v[160:163]
    ds_read_b64_tr_b16 a[106:107], v11 offset:59776
    v_mfma_f32_16x16x32_bf16 v[164:167], a[32:35], a[164:167], v[164:167]
    v_mfma_f32_16x16x32_bf16 v[168:171], a[32:35], a[168:171], v[168:171]
    ds_read_b64_tr_b16 a[108:109], v11 offset:59296
    v_mfma_f32_16x16x32_bf16 v[172:175], a[32:35], a[172:175], v[172:175]
    ds_read_b64_tr_b16 a[110:111], v11 offset:59808
    v_mfma_f32_16x16x32_bf16 v[176:179], a[36:39], a[160:163], v[176:179]
    v_mfma_f32_16x16x32_bf16 v[180:183], a[36:39], a[164:167], v[180:183]
    ds_read_b64_tr_b16 a[112:113], v13 offset:50688
    v_mfma_f32_16x16x32_bf16 v[184:187], a[36:39], a[168:171], v[184:187]
    v_mfma_f32_16x16x32_bf16 v[188:191], a[36:39], a[172:175], v[188:191]
    ds_read_b64_tr_b16 a[114:115], v13 offset:51200
    v_mfma_f32_16x16x32_bf16 v[192:195], a[40:43], a[160:163], v[192:195]
    ds_read_b64_tr_b16 a[116:117], v13 offset:50720
    v_mfma_f32_16x16x32_bf16 v[196:199], a[40:43], a[164:167], v[196:199]
    v_mfma_f32_16x16x32_bf16 v[200:203], a[40:43], a[168:171], v[200:203]
    ds_read_b64_tr_b16 a[118:119], v13 offset:51232
    v_mfma_f32_16x16x32_bf16 v[204:207], a[40:43], a[172:175], v[204:207]
    ds_read_b64_tr_b16 a[120:121], v13 offset:59136
    v_mfma_f32_16x16x32_bf16 v[208:211], a[44:47], a[160:163], v[208:211]
    v_mfma_f32_16x16x32_bf16 v[212:215], a[44:47], a[164:167], v[212:215]
    ds_read_b64_tr_b16 a[122:123], v13 offset:59648
    v_mfma_f32_16x16x32_bf16 v[216:219], a[44:47], a[168:171], v[216:219]
    ds_read_b64_tr_b16 a[124:125], v13 offset:59168
    v_mfma_f32_16x16x32_bf16 v[220:223], a[44:47], a[172:175], v[220:223]
    v_mfma_f32_16x16x32_bf16 v[224:227], a[48:51], a[160:163], v[224:227]
    ds_read_b64_tr_b16 a[126:127], v13 offset:59680
    v_mfma_f32_16x16x32_bf16 v[228:231], a[48:51], a[164:167], v[228:231]
    v_mfma_f32_16x16x32_bf16 v[232:235], a[52:55], a[160:163], v[232:235]
    v_mfma_f32_16x16x32_bf16 v[236:239], a[52:55], a[164:167], v[236:239]
    v_mfma_f32_16x16x32_bf16 v[240:243], a[56:59], a[160:163], v[240:243]
    v_mfma_f32_16x16x32_bf16 v[244:247], a[56:59], a[164:167], v[244:247]
    v_mfma_f32_16x16x32_bf16 v[248:251], a[60:63], a[160:163], v[248:251]
    v_mfma_f32_16x16x32_bf16 v[252:255], a[60:63], a[164:167], v[252:255]
    s_waitcnt lgkmcnt(0)
    s_waitcnt vmcnt(3)
    v_mfma_f32_16x16x32_bf16 v[32:35], a[64:67], a[176:179], v[32:35]
    s_waitcnt vmcnt(2)
    v_mfma_f32_16x16x32_bf16 v[36:39], a[64:67], a[180:183], v[36:39]
    s_waitcnt vmcnt(1)
    v_mfma_f32_16x16x32_bf16 v[40:43], a[64:67], a[184:187], v[40:43]
    s_waitcnt vmcnt(0)
    v_mfma_f32_16x16x32_bf16 v[44:47], a[64:67], a[188:191], v[44:47]
    v_mfma_f32_16x16x32_bf16 v[48:51], a[68:71], a[176:179], v[48:51]
    v_mfma_f32_16x16x32_bf16 v[52:55], a[68:71], a[180:183], v[52:55]
    v_mfma_f32_16x16x32_bf16 v[56:59], a[68:71], a[184:187], v[56:59]
    v_mfma_f32_16x16x32_bf16 v[60:63], a[68:71], a[188:191], v[60:63]
    v_mfma_f32_16x16x32_bf16 v[64:67], a[72:75], a[176:179], v[64:67]
    v_mfma_f32_16x16x32_bf16 v[68:71], a[72:75], a[180:183], v[68:71]
    v_mfma_f32_16x16x32_bf16 v[72:75], a[72:75], a[184:187], v[72:75]
    v_mfma_f32_16x16x32_bf16 v[76:79], a[72:75], a[188:191], v[76:79]
    v_mfma_f32_16x16x32_bf16 v[80:83], a[76:79], a[176:179], v[80:83]
    v_mfma_f32_16x16x32_bf16 v[84:87], a[76:79], a[180:183], v[84:87]
    v_mfma_f32_16x16x32_bf16 v[88:91], a[76:79], a[184:187], v[88:91]
    v_mfma_f32_16x16x32_bf16 v[92:95], a[76:79], a[188:191], v[92:95]
    v_mfma_f32_16x16x32_bf16 v[96:99], a[80:83], a[176:179], v[96:99]
    v_mfma_f32_16x16x32_bf16 v[100:103], a[80:83], a[180:183], v[100:103]
    v_mfma_f32_16x16x32_bf16 v[104:107], a[80:83], a[184:187], v[104:107]
    v_mfma_f32_16x16x32_bf16 v[108:111], a[80:83], a[188:191], v[108:111]
    v_mfma_f32_16x16x32_bf16 v[112:115], a[84:87], a[176:179], v[112:115]
    v_mfma_f32_16x16x32_bf16 v[116:119], a[84:87], a[180:183], v[116:119]
    v_mfma_f32_16x16x32_bf16 v[120:123], a[84:87], a[184:187], v[120:123]
    v_mfma_f32_16x16x32_bf16 v[124:127], a[84:87], a[188:191], v[124:127]
    v_mfma_f32_16x16x32_bf16 v[128:131], a[88:91], a[176:179], v[128:131]
    v_mfma_f32_16x16x32_bf16 v[132:135], a[88:91], a[180:183], v[132:135]
    v_mfma_f32_16x16x32_bf16 v[136:139], a[88:91], a[184:187], v[136:139]
    v_mfma_f32_16x16x32_bf16 v[140:143], a[88:91], a[188:191], v[140:143]
    v_mfma_f32_16x16x32_bf16 v[144:147], a[92:95], a[176:179], v[144:147]
    v_mfma_f32_16x16x32_bf16 v[148:151], a[92:95], a[180:183], v[148:151]
    v_mfma_f32_16x16x32_bf16 v[152:155], a[92:95], a[184:187], v[152:155]
    v_mfma_f32_16x16x32_bf16 v[156:159], a[92:95], a[188:191], v[156:159]
    v_mfma_f32_16x16x32_bf16 v[160:163], a[96:99], a[176:179], v[160:163]
    v_mfma_f32_16x16x32_bf16 v[164:167], a[96:99], a[180:183], v[164:167]
    v_mfma_f32_16x16x32_bf16 v[168:171], a[96:99], a[184:187], v[168:171]
    v_mfma_f32_16x16x32_bf16 v[172:175], a[96:99], a[188:191], v[172:175]
    v_mfma_f32_16x16x32_bf16 v[176:179], a[100:103], a[176:179], v[176:179]
    v_mfma_f32_16x16x32_bf16 v[180:183], a[100:103], a[180:183], v[180:183]
    v_mfma_f32_16x16x32_bf16 v[184:187], a[100:103], a[184:187], v[184:187]
    v_mfma_f32_16x16x32_bf16 v[188:191], a[100:103], a[188:191], v[188:191]
    v_mfma_f32_16x16x32_bf16 v[192:195], a[104:107], a[176:179], v[192:195]
    v_mfma_f32_16x16x32_bf16 v[196:199], a[104:107], a[180:183], v[196:199]
    v_mfma_f32_16x16x32_bf16 v[200:203], a[104:107], a[184:187], v[200:203]
    v_mfma_f32_16x16x32_bf16 v[204:207], a[104:107], a[188:191], v[204:207]
    v_mfma_f32_16x16x32_bf16 v[208:211], a[108:111], a[176:179], v[208:211]
    v_mfma_f32_16x16x32_bf16 v[212:215], a[108:111], a[180:183], v[212:215]
    v_mfma_f32_16x16x32_bf16 v[216:219], a[108:111], a[184:187], v[216:219]
    v_mfma_f32_16x16x32_bf16 v[220:223], a[108:111], a[188:191], v[220:223]
    v_mfma_f32_16x16x32_bf16 v[224:227], a[112:115], a[176:179], v[224:227]
    v_mfma_f32_16x16x32_bf16 v[228:231], a[112:115], a[180:183], v[228:231]
    v_mfma_f32_16x16x32_bf16 v[232:235], a[116:119], a[176:179], v[232:235]
    v_mfma_f32_16x16x32_bf16 v[236:239], a[116:119], a[180:183], v[236:239]
    v_mfma_f32_16x16x32_bf16 v[240:243], a[120:123], a[176:179], v[240:243]
    v_mfma_f32_16x16x32_bf16 v[244:247], a[120:123], a[180:183], v[244:247]
    v_mfma_f32_16x16x32_bf16 v[248:251], a[124:127], a[176:179], v[248:251]
    v_mfma_f32_16x16x32_bf16 v[252:255], a[124:127], a[180:183], v[252:255]
    s_lshl_b32 s20, s3, 10
    s_lshl_b32 s21, s8, 9
    s_add_u32 s20, s20, s21
    s_add_u32 s20, s20, 135168
    v_and_b32 v6, 15, v1
    v_lshl_add_u32 v6, v6, 4, s20
    v_xor_b32 v7, 512, v6
    ds_read_b128 v[16:19], v6 offset:0
    ds_read_b128 v[20:23], v6 offset:256
    ds_read_b128 v[24:27], v7 offset:0
    ds_read_b128 v[28:31], v7 offset:256
    v_lshrrev_b32 v6, 4, v1
    v_lshlrev_b32 v6, 4, v6
    s_lshl_b32 s20, s17, 1
    s_lshl_b32 s21, s18, 1
    s_add_u32 s20, s20, 139264
    s_add_u32 s21, s21, 139264
    v_add_u32 v7, s21, v6
    v_add_u32 v6, s20, v6
    s_mul_i32 s20, s9, 7
    s_add_u32 s53, s20, 3
    s_lshl_b32 s53, s53, 17
    s_lshl_b32 s21, s8, 2
    s_add_u32 s20, s20, s21
    s_lshl_b32 s50, s20, 17
    s_add_u32 s51, s50, 0x20000
    s_add_u32 s52, s50, 0x40000
    ds_read_b128 v[8:11], v6 offset:0
    ds_read_b128 v[12:15], v6 offset:512
    s_waitcnt lgkmcnt(1)
    v_pk_fma_f32 v[32:33], v[8:9], v[16:17], v[32:33] op_sel_hi:[1,0,1]
    s_waitcnt lgkmcnt(0)
    v_pk_fma_f32 v[64:65], v[12:13], v[16:17], v[64:65] op_sel_hi:[1,0,1]
    v_pk_fma_f32 v[34:35], v[10:11], v[16:17], v[34:35] op_sel_hi:[1,0,1]
    v_pk_fma_f32 v[66:67], v[14:15], v[16:17], v[66:67] op_sel_hi:[1,0,1]
    v_pk_fma_f32 v[36:37], v[8:9], v[20:21], v[36:37] op_sel_hi:[1,0,1]
    v_pk_fma_f32 v[68:69], v[12:13], v[20:21], v[68:69] op_sel_hi:[1,0,1]
    v_pk_fma_f32 v[38:39], v[10:11], v[20:21], v[38:39] op_sel_hi:[1,0,1]
    v_pk_fma_f32 v[70:71], v[14:15], v[20:21], v[70:71] op_sel_hi:[1,0,1]
    v_pk_fma_f32 v[40:41], v[8:9], v[24:25], v[40:41] op_sel_hi:[1,0,1]
    v_pk_fma_f32 v[72:73], v[12:13], v[24:25], v[72:73] op_sel_hi:[1,0,1]
    v_pk_fma_f32 v[42:43], v[10:11], v[24:25], v[42:43] op_sel_hi:[1,0,1]
    v_pk_fma_f32 v[74:75], v[14:15], v[24:25], v[74:75] op_sel_hi:[1,0,1]
    v_pk_fma_f32 v[44:45], v[8:9], v[28:29], v[44:45] op_sel_hi:[1,0,1]
    v_pk_fma_f32 v[76:77], v[12:13], v[28:29], v[76:77] op_sel_hi:[1,0,1]
    v_pk_fma_f32 v[46:47], v[10:11], v[28:29], v[46:47] op_sel_hi:[1,0,1]
    v_pk_fma_f32 v[78:79], v[14:15], v[28:29], v[78:79] op_sel_hi:[1,0,1]
    ds_read_b128 v[8:11], v6 offset:64
    ds_read_b128 v[12:15], v6 offset:576
    s_waitcnt lgkmcnt(1)
    v_pk_fma_f32 v[48:49], v[8:9], v[16:17], v[48:49] op_sel_hi:[1,0,1]
    s_waitcnt lgkmcnt(0)
    v_pk_fma_f32 v[80:81], v[12:13], v[16:17], v[80:81] op_sel_hi:[1,0,1]
    v_pk_fma_f32 v[50:51], v[10:11], v[16:17], v[50:51] op_sel_hi:[1,0,1]
    v_pk_fma_f32 v[82:83], v[14:15], v[16:17], v[82:83] op_sel_hi:[1,0,1]
    v_pk_fma_f32 v[52:53], v[8:9], v[20:21], v[52:53] op_sel_hi:[1,0,1]
    v_pk_fma_f32 v[84:85], v[12:13], v[20:21], v[84:85] op_sel_hi:[1,0,1]
    v_pk_fma_f32 v[54:55], v[10:11], v[20:21], v[54:55] op_sel_hi:[1,0,1]
    v_pk_fma_f32 v[86:87], v[14:15], v[20:21], v[86:87] op_sel_hi:[1,0,1]
    v_pk_fma_f32 v[56:57], v[8:9], v[24:25], v[56:57] op_sel_hi:[1,0,1]
    v_pk_fma_f32 v[88:89], v[12:13], v[24:25], v[88:89] op_sel_hi:[1,0,1]
    v_pk_fma_f32 v[58:59], v[10:11], v[24:25], v[58:59] op_sel_hi:[1,0,1]
    v_pk_fma_f32 v[90:91], v[14:15], v[24:25], v[90:91] op_sel_hi:[1,0,1]
    v_pk_fma_f32 v[60:61], v[8:9], v[28:29], v[60:61] op_sel_hi:[1,0,1]
    v_pk_fma_f32 v[92:93], v[12:13], v[28:29], v[92:93] op_sel_hi:[1,0,1]
    v_pk_fma_f32 v[62:63], v[10:11], v[28:29], v[62:63] op_sel_hi:[1,0,1]
    v_pk_fma_f32 v[94:95], v[14:15], v[28:29], v[94:95] op_sel_hi:[1,0,1]
    v_pk_mul_f32 v[64:65], v[64:65], v[32:33]
    v_pk_mul_f32 v[32:33], v[32:33], v[18:19] op_sel_hi:[1,0]
    v_pk_mul_f32 v[66:67], v[66:67], v[34:35]
    v_pk_mul_f32 v[34:35], v[34:35], v[18:19] op_sel_hi:[1,0]
    v_pk_mul_f32 v[80:81], v[80:81], v[48:49]
    v_pk_mul_f32 v[48:49], v[48:49], v[18:19] op_sel_hi:[1,0]
    v_pk_mul_f32 v[82:83], v[82:83], v[50:51]
    v_pk_mul_f32 v[50:51], v[50:51], v[18:19] op_sel_hi:[1,0]
    v_exp_f32 v32, v32
    v_exp_f32 v33, v33
    v_exp_f32 v34, v34
    v_exp_f32 v35, v35
    v_exp_f32 v48, v48
    v_exp_f32 v49, v49
    v_exp_f32 v50, v50
    v_exp_f32 v51, v51
    v_pk_fma_f32 v[32:33], v[32:33], v[16:17], v[16:17] op_sel:[0,1,1] op_sel_hi:[1,1,1]
    v_pk_fma_f32 v[34:35], v[34:35], v[16:17], v[16:17] op_sel:[0,1,1] op_sel_hi:[1,1,1]
    v_pk_fma_f32 v[48:49], v[48:49], v[16:17], v[16:17] op_sel:[0,1,1] op_sel_hi:[1,1,1]
    v_pk_fma_f32 v[50:51], v[50:51], v[16:17], v[16:17] op_sel:[0,1,1] op_sel_hi:[1,1,1]
    v_rcp_f32 v32, v32
    v_rcp_f32 v33, v33
    v_rcp_f32 v34, v34
    v_rcp_f32 v35, v35
    v_rcp_f32 v48, v48
    v_rcp_f32 v49, v49
    v_rcp_f32 v50, v50
    v_rcp_f32 v51, v51
    v_pk_mul_f32 v[64:65], v[64:65], v[32:33]
    v_pk_mul_f32 v[66:67], v[66:67], v[34:35]
    v_pk_mul_f32 v[80:81], v[80:81], v[48:49]
    v_pk_mul_f32 v[82:83], v[82:83], v[50:51]
    v_cvt_pk_bf16_f32 v32, v64, v65
    v_cvt_pk_bf16_f32 v33, v66, v67
    v_cvt_pk_bf16_f32 v34, v80, v81
    v_cvt_pk_bf16_f32 v35, v82, v83
    buffer_store_dwordx4 v[32:35], v4, s[40:43], s50 offen offset:0
    v_pk_mul_f32 v[68:69], v[68:69], v[36:37]
    v_pk_mul_f32 v[36:37], v[36:37], v[22:23] op_sel_hi:[1,0]
    v_pk_mul_f32 v[70:71], v[70:71], v[38:39]
    v_pk_mul_f32 v[38:39], v[38:39], v[22:23] op_sel_hi:[1,0]
    v_pk_mul_f32 v[84:85], v[84:85], v[52:53]
    v_pk_mul_f32 v[52:53], v[52:53], v[22:23] op_sel_hi:[1,0]
    v_pk_mul_f32 v[86:87], v[86:87], v[54:55]
    v_pk_mul_f32 v[54:55], v[54:55], v[22:23] op_sel_hi:[1,0]
    v_exp_f32 v36, v36
    v_exp_f32 v37, v37
    v_exp_f32 v38, v38
    v_exp_f32 v39, v39
    v_exp_f32 v52, v52
    v_exp_f32 v53, v53
    v_exp_f32 v54, v54
    v_exp_f32 v55, v55
    v_pk_fma_f32 v[36:37], v[36:37], v[20:21], v[20:21] op_sel:[0,1,1] op_sel_hi:[1,1,1]
    v_pk_fma_f32 v[38:39], v[38:39], v[20:21], v[20:21] op_sel:[0,1,1] op_sel_hi:[1,1,1]
    v_pk_fma_f32 v[52:53], v[52:53], v[20:21], v[20:21] op_sel:[0,1,1] op_sel_hi:[1,1,1]
    v_pk_fma_f32 v[54:55], v[54:55], v[20:21], v[20:21] op_sel:[0,1,1] op_sel_hi:[1,1,1]
    v_rcp_f32 v36, v36
    v_rcp_f32 v37, v37
    v_rcp_f32 v38, v38
    v_rcp_f32 v39, v39
    v_rcp_f32 v52, v52
    v_rcp_f32 v53, v53
    v_rcp_f32 v54, v54
    v_rcp_f32 v55, v55
    v_pk_mul_f32 v[68:69], v[68:69], v[36:37]
    v_pk_mul_f32 v[70:71], v[70:71], v[38:39]
    v_pk_mul_f32 v[84:85], v[84:85], v[52:53]
    v_pk_mul_f32 v[86:87], v[86:87], v[54:55]
    v_cvt_pk_bf16_f32 v36, v68, v69
    v_cvt_pk_bf16_f32 v37, v70, v71
    v_cvt_pk_bf16_f32 v38, v84, v85
    v_cvt_pk_bf16_f32 v39, v86, v87
    buffer_store_dwordx4 v[36:39], v4, s[40:43], s50 offen offset:1024
    v_pk_mul_f32 v[72:73], v[72:73], v[40:41]
    v_pk_mul_f32 v[40:41], v[40:41], v[26:27] op_sel_hi:[1,0]
    v_pk_mul_f32 v[74:75], v[74:75], v[42:43]
    v_pk_mul_f32 v[42:43], v[42:43], v[26:27] op_sel_hi:[1,0]
    v_pk_mul_f32 v[88:89], v[88:89], v[56:57]
    v_pk_mul_f32 v[56:57], v[56:57], v[26:27] op_sel_hi:[1,0]
    v_pk_mul_f32 v[90:91], v[90:91], v[58:59]
    v_pk_mul_f32 v[58:59], v[58:59], v[26:27] op_sel_hi:[1,0]
    v_exp_f32 v40, v40
    v_exp_f32 v41, v41
    v_exp_f32 v42, v42
    v_exp_f32 v43, v43
    v_exp_f32 v56, v56
    v_exp_f32 v57, v57
    v_exp_f32 v58, v58
    v_exp_f32 v59, v59
    v_pk_fma_f32 v[40:41], v[40:41], v[24:25], v[24:25] op_sel:[0,1,1] op_sel_hi:[1,1,1]
    v_pk_fma_f32 v[42:43], v[42:43], v[24:25], v[24:25] op_sel:[0,1,1] op_sel_hi:[1,1,1]
    v_pk_fma_f32 v[56:57], v[56:57], v[24:25], v[24:25] op_sel:[0,1,1] op_sel_hi:[1,1,1]
    v_pk_fma_f32 v[58:59], v[58:59], v[24:25], v[24:25] op_sel:[0,1,1] op_sel_hi:[1,1,1]
    v_rcp_f32 v40, v40
    v_rcp_f32 v41, v41
    v_rcp_f32 v42, v42
    v_rcp_f32 v43, v43
    v_rcp_f32 v56, v56
    v_rcp_f32 v57, v57
    v_rcp_f32 v58, v58
    v_rcp_f32 v59, v59
    v_pk_mul_f32 v[72:73], v[72:73], v[40:41]
    v_pk_mul_f32 v[74:75], v[74:75], v[42:43]
    v_pk_mul_f32 v[88:89], v[88:89], v[56:57]
    v_pk_mul_f32 v[90:91], v[90:91], v[58:59]
    v_cvt_pk_bf16_f32 v40, v72, v73
    v_cvt_pk_bf16_f32 v41, v74, v75
    v_cvt_pk_bf16_f32 v42, v88, v89
    v_cvt_pk_bf16_f32 v43, v90, v91
    buffer_store_dwordx4 v[40:43], v5, s[40:43], s50 offen offset:0
    v_pk_mul_f32 v[76:77], v[76:77], v[44:45]
    v_pk_mul_f32 v[44:45], v[44:45], v[30:31] op_sel_hi:[1,0]
    v_pk_mul_f32 v[78:79], v[78:79], v[46:47]
    v_pk_mul_f32 v[46:47], v[46:47], v[30:31] op_sel_hi:[1,0]
    v_pk_mul_f32 v[92:93], v[92:93], v[60:61]
    v_pk_mul_f32 v[60:61], v[60:61], v[30:31] op_sel_hi:[1,0]
    v_pk_mul_f32 v[94:95], v[94:95], v[62:63]
    v_pk_mul_f32 v[62:63], v[62:63], v[30:31] op_sel_hi:[1,0]
    v_exp_f32 v44, v44
    v_exp_f32 v45, v45
    v_exp_f32 v46, v46
    v_exp_f32 v47, v47
    v_exp_f32 v60, v60
    v_exp_f32 v61, v61
    v_exp_f32 v62, v62
    v_exp_f32 v63, v63
    v_pk_fma_f32 v[44:45], v[44:45], v[28:29], v[28:29] op_sel:[0,1,1] op_sel_hi:[1,1,1]
    v_pk_fma_f32 v[46:47], v[46:47], v[28:29], v[28:29] op_sel:[0,1,1] op_sel_hi:[1,1,1]
    v_pk_fma_f32 v[60:61], v[60:61], v[28:29], v[28:29] op_sel:[0,1,1] op_sel_hi:[1,1,1]
    v_pk_fma_f32 v[62:63], v[62:63], v[28:29], v[28:29] op_sel:[0,1,1] op_sel_hi:[1,1,1]
    v_rcp_f32 v44, v44
    v_rcp_f32 v45, v45
    v_rcp_f32 v46, v46
    v_rcp_f32 v47, v47
    v_rcp_f32 v60, v60
    v_rcp_f32 v61, v61
    v_rcp_f32 v62, v62
    v_rcp_f32 v63, v63
    v_pk_mul_f32 v[76:77], v[76:77], v[44:45]
    v_pk_mul_f32 v[78:79], v[78:79], v[46:47]
    v_pk_mul_f32 v[92:93], v[92:93], v[60:61]
    v_pk_mul_f32 v[94:95], v[94:95], v[62:63]
    v_cvt_pk_bf16_f32 v44, v76, v77
    v_cvt_pk_bf16_f32 v45, v78, v79
    v_cvt_pk_bf16_f32 v46, v92, v93
    v_cvt_pk_bf16_f32 v47, v94, v95
    buffer_store_dwordx4 v[44:47], v5, s[40:43], s50 offen offset:1024
    ds_read_b128 v[8:11], v6 offset:128
    ds_read_b128 v[12:15], v6 offset:640
    s_waitcnt lgkmcnt(1)
    v_pk_fma_f32 v[96:97], v[8:9], v[16:17], v[96:97] op_sel_hi:[1,0,1]
    s_waitcnt lgkmcnt(0)
    v_pk_fma_f32 v[128:129], v[12:13], v[16:17], v[128:129] op_sel_hi:[1,0,1]
    v_pk_fma_f32 v[98:99], v[10:11], v[16:17], v[98:99] op_sel_hi:[1,0,1]
    v_pk_fma_f32 v[130:131], v[14:15], v[16:17], v[130:131] op_sel_hi:[1,0,1]
    v_pk_fma_f32 v[100:101], v[8:9], v[20:21], v[100:101] op_sel_hi:[1,0,1]
    v_pk_fma_f32 v[132:133], v[12:13], v[20:21], v[132:133] op_sel_hi:[1,0,1]
    v_pk_fma_f32 v[102:103], v[10:11], v[20:21], v[102:103] op_sel_hi:[1,0,1]
    v_pk_fma_f32 v[134:135], v[14:15], v[20:21], v[134:135] op_sel_hi:[1,0,1]
    v_pk_fma_f32 v[104:105], v[8:9], v[24:25], v[104:105] op_sel_hi:[1,0,1]
    v_pk_fma_f32 v[136:137], v[12:13], v[24:25], v[136:137] op_sel_hi:[1,0,1]
    v_pk_fma_f32 v[106:107], v[10:11], v[24:25], v[106:107] op_sel_hi:[1,0,1]
    v_pk_fma_f32 v[138:139], v[14:15], v[24:25], v[138:139] op_sel_hi:[1,0,1]
    v_pk_fma_f32 v[108:109], v[8:9], v[28:29], v[108:109] op_sel_hi:[1,0,1]
    v_pk_fma_f32 v[140:141], v[12:13], v[28:29], v[140:141] op_sel_hi:[1,0,1]
    v_pk_fma_f32 v[110:111], v[10:11], v[28:29], v[110:111] op_sel_hi:[1,0,1]
    v_pk_fma_f32 v[142:143], v[14:15], v[28:29], v[142:143] op_sel_hi:[1,0,1]
    ds_read_b128 v[8:11], v6 offset:192
    ds_read_b128 v[12:15], v6 offset:704
    s_waitcnt lgkmcnt(1)
    v_pk_fma_f32 v[112:113], v[8:9], v[16:17], v[112:113] op_sel_hi:[1,0,1]
    s_waitcnt lgkmcnt(0)
    v_pk_fma_f32 v[144:145], v[12:13], v[16:17], v[144:145] op_sel_hi:[1,0,1]
    v_pk_fma_f32 v[114:115], v[10:11], v[16:17], v[114:115] op_sel_hi:[1,0,1]
    v_pk_fma_f32 v[146:147], v[14:15], v[16:17], v[146:147] op_sel_hi:[1,0,1]
    v_pk_fma_f32 v[116:117], v[8:9], v[20:21], v[116:117] op_sel_hi:[1,0,1]
    v_pk_fma_f32 v[148:149], v[12:13], v[20:21], v[148:149] op_sel_hi:[1,0,1]
    v_pk_fma_f32 v[118:119], v[10:11], v[20:21], v[118:119] op_sel_hi:[1,0,1]
    v_pk_fma_f32 v[150:151], v[14:15], v[20:21], v[150:151] op_sel_hi:[1,0,1]
    v_pk_fma_f32 v[120:121], v[8:9], v[24:25], v[120:121] op_sel_hi:[1,0,1]
    v_pk_fma_f32 v[152:153], v[12:13], v[24:25], v[152:153] op_sel_hi:[1,0,1]
    v_pk_fma_f32 v[122:123], v[10:11], v[24:25], v[122:123] op_sel_hi:[1,0,1]
    v_pk_fma_f32 v[154:155], v[14:15], v[24:25], v[154:155] op_sel_hi:[1,0,1]
    v_pk_fma_f32 v[124:125], v[8:9], v[28:29], v[124:125] op_sel_hi:[1,0,1]
    v_pk_fma_f32 v[156:157], v[12:13], v[28:29], v[156:157] op_sel_hi:[1,0,1]
    v_pk_fma_f32 v[126:127], v[10:11], v[28:29], v[126:127] op_sel_hi:[1,0,1]
    v_pk_fma_f32 v[158:159], v[14:15], v[28:29], v[158:159] op_sel_hi:[1,0,1]
    v_pk_mul_f32 v[128:129], v[128:129], v[96:97]
    v_pk_mul_f32 v[96:97], v[96:97], v[18:19] op_sel_hi:[1,0]
    v_pk_mul_f32 v[130:131], v[130:131], v[98:99]
    v_pk_mul_f32 v[98:99], v[98:99], v[18:19] op_sel_hi:[1,0]
    v_pk_mul_f32 v[144:145], v[144:145], v[112:113]
    v_pk_mul_f32 v[112:113], v[112:113], v[18:19] op_sel_hi:[1,0]
    v_pk_mul_f32 v[146:147], v[146:147], v[114:115]
    v_pk_mul_f32 v[114:115], v[114:115], v[18:19] op_sel_hi:[1,0]
    v_exp_f32 v96, v96
    v_exp_f32 v97, v97
    v_exp_f32 v98, v98
    v_exp_f32 v99, v99
    v_exp_f32 v112, v112
    v_exp_f32 v113, v113
    v_exp_f32 v114, v114
    v_exp_f32 v115, v115
    v_pk_fma_f32 v[96:97], v[96:97], v[16:17], v[16:17] op_sel:[0,1,1] op_sel_hi:[1,1,1]
    v_pk_fma_f32 v[98:99], v[98:99], v[16:17], v[16:17] op_sel:[0,1,1] op_sel_hi:[1,1,1]
    v_pk_fma_f32 v[112:113], v[112:113], v[16:17], v[16:17] op_sel:[0,1,1] op_sel_hi:[1,1,1]
    v_pk_fma_f32 v[114:115], v[114:115], v[16:17], v[16:17] op_sel:[0,1,1] op_sel_hi:[1,1,1]
    v_rcp_f32 v96, v96
    v_rcp_f32 v97, v97
    v_rcp_f32 v98, v98
    v_rcp_f32 v99, v99
    v_rcp_f32 v112, v112
    v_rcp_f32 v113, v113
    v_rcp_f32 v114, v114
    v_rcp_f32 v115, v115
    v_pk_mul_f32 v[128:129], v[128:129], v[96:97]
    v_pk_mul_f32 v[130:131], v[130:131], v[98:99]
    v_pk_mul_f32 v[144:145], v[144:145], v[112:113]
    v_pk_mul_f32 v[146:147], v[146:147], v[114:115]
    v_cvt_pk_bf16_f32 v96, v128, v129
    v_cvt_pk_bf16_f32 v97, v130, v131
    v_cvt_pk_bf16_f32 v98, v144, v145
    v_cvt_pk_bf16_f32 v99, v146, v147
    buffer_store_dwordx4 v[96:99], v4, s[40:43], s51 offen offset:0
    v_pk_mul_f32 v[132:133], v[132:133], v[100:101]
    v_pk_mul_f32 v[100:101], v[100:101], v[22:23] op_sel_hi:[1,0]
    v_pk_mul_f32 v[134:135], v[134:135], v[102:103]
    v_pk_mul_f32 v[102:103], v[102:103], v[22:23] op_sel_hi:[1,0]
    v_pk_mul_f32 v[148:149], v[148:149], v[116:117]
    v_pk_mul_f32 v[116:117], v[116:117], v[22:23] op_sel_hi:[1,0]
    v_pk_mul_f32 v[150:151], v[150:151], v[118:119]
    v_pk_mul_f32 v[118:119], v[118:119], v[22:23] op_sel_hi:[1,0]
    v_exp_f32 v100, v100
    v_exp_f32 v101, v101
    v_exp_f32 v102, v102
    v_exp_f32 v103, v103
    v_exp_f32 v116, v116
    v_exp_f32 v117, v117
    v_exp_f32 v118, v118
    v_exp_f32 v119, v119
    v_pk_fma_f32 v[100:101], v[100:101], v[20:21], v[20:21] op_sel:[0,1,1] op_sel_hi:[1,1,1]
    v_pk_fma_f32 v[102:103], v[102:103], v[20:21], v[20:21] op_sel:[0,1,1] op_sel_hi:[1,1,1]
    v_pk_fma_f32 v[116:117], v[116:117], v[20:21], v[20:21] op_sel:[0,1,1] op_sel_hi:[1,1,1]
    v_pk_fma_f32 v[118:119], v[118:119], v[20:21], v[20:21] op_sel:[0,1,1] op_sel_hi:[1,1,1]
    v_rcp_f32 v100, v100
    v_rcp_f32 v101, v101
    v_rcp_f32 v102, v102
    v_rcp_f32 v103, v103
    v_rcp_f32 v116, v116
    v_rcp_f32 v117, v117
    v_rcp_f32 v118, v118
    v_rcp_f32 v119, v119
    v_pk_mul_f32 v[132:133], v[132:133], v[100:101]
    v_pk_mul_f32 v[134:135], v[134:135], v[102:103]
    v_pk_mul_f32 v[148:149], v[148:149], v[116:117]
    v_pk_mul_f32 v[150:151], v[150:151], v[118:119]
    v_cvt_pk_bf16_f32 v100, v132, v133
    v_cvt_pk_bf16_f32 v101, v134, v135
    v_cvt_pk_bf16_f32 v102, v148, v149
    v_cvt_pk_bf16_f32 v103, v150, v151
    buffer_store_dwordx4 v[100:103], v4, s[40:43], s51 offen offset:1024
    v_pk_mul_f32 v[136:137], v[136:137], v[104:105]
    v_pk_mul_f32 v[104:105], v[104:105], v[26:27] op_sel_hi:[1,0]
    v_pk_mul_f32 v[138:139], v[138:139], v[106:107]
    v_pk_mul_f32 v[106:107], v[106:107], v[26:27] op_sel_hi:[1,0]
    v_pk_mul_f32 v[152:153], v[152:153], v[120:121]
    v_pk_mul_f32 v[120:121], v[120:121], v[26:27] op_sel_hi:[1,0]
    v_pk_mul_f32 v[154:155], v[154:155], v[122:123]
    v_pk_mul_f32 v[122:123], v[122:123], v[26:27] op_sel_hi:[1,0]
    v_exp_f32 v104, v104
    v_exp_f32 v105, v105
    v_exp_f32 v106, v106
    v_exp_f32 v107, v107
    v_exp_f32 v120, v120
    v_exp_f32 v121, v121
    v_exp_f32 v122, v122
    v_exp_f32 v123, v123
    v_pk_fma_f32 v[104:105], v[104:105], v[24:25], v[24:25] op_sel:[0,1,1] op_sel_hi:[1,1,1]
    v_pk_fma_f32 v[106:107], v[106:107], v[24:25], v[24:25] op_sel:[0,1,1] op_sel_hi:[1,1,1]
    v_pk_fma_f32 v[120:121], v[120:121], v[24:25], v[24:25] op_sel:[0,1,1] op_sel_hi:[1,1,1]
    v_pk_fma_f32 v[122:123], v[122:123], v[24:25], v[24:25] op_sel:[0,1,1] op_sel_hi:[1,1,1]
    v_rcp_f32 v104, v104
    v_rcp_f32 v105, v105
    v_rcp_f32 v106, v106
    v_rcp_f32 v107, v107
    v_rcp_f32 v120, v120
    v_rcp_f32 v121, v121
    v_rcp_f32 v122, v122
    v_rcp_f32 v123, v123
    v_pk_mul_f32 v[136:137], v[136:137], v[104:105]
    v_pk_mul_f32 v[138:139], v[138:139], v[106:107]
    v_pk_mul_f32 v[152:153], v[152:153], v[120:121]
    v_pk_mul_f32 v[154:155], v[154:155], v[122:123]
    v_cvt_pk_bf16_f32 v104, v136, v137
    v_cvt_pk_bf16_f32 v105, v138, v139
    v_cvt_pk_bf16_f32 v106, v152, v153
    v_cvt_pk_bf16_f32 v107, v154, v155
    buffer_store_dwordx4 v[104:107], v5, s[40:43], s51 offen offset:0
    v_pk_mul_f32 v[140:141], v[140:141], v[108:109]
    v_pk_mul_f32 v[108:109], v[108:109], v[30:31] op_sel_hi:[1,0]
    v_pk_mul_f32 v[142:143], v[142:143], v[110:111]
    v_pk_mul_f32 v[110:111], v[110:111], v[30:31] op_sel_hi:[1,0]
    v_pk_mul_f32 v[156:157], v[156:157], v[124:125]
    v_pk_mul_f32 v[124:125], v[124:125], v[30:31] op_sel_hi:[1,0]
    v_pk_mul_f32 v[158:159], v[158:159], v[126:127]
    v_pk_mul_f32 v[126:127], v[126:127], v[30:31] op_sel_hi:[1,0]
    v_exp_f32 v108, v108
    v_exp_f32 v109, v109
    v_exp_f32 v110, v110
    v_exp_f32 v111, v111
    v_exp_f32 v124, v124
    v_exp_f32 v125, v125
    v_exp_f32 v126, v126
    v_exp_f32 v127, v127
    v_pk_fma_f32 v[108:109], v[108:109], v[28:29], v[28:29] op_sel:[0,1,1] op_sel_hi:[1,1,1]
    v_pk_fma_f32 v[110:111], v[110:111], v[28:29], v[28:29] op_sel:[0,1,1] op_sel_hi:[1,1,1]
    v_pk_fma_f32 v[124:125], v[124:125], v[28:29], v[28:29] op_sel:[0,1,1] op_sel_hi:[1,1,1]
    v_pk_fma_f32 v[126:127], v[126:127], v[28:29], v[28:29] op_sel:[0,1,1] op_sel_hi:[1,1,1]
    v_rcp_f32 v108, v108
    v_rcp_f32 v109, v109
    v_rcp_f32 v110, v110
    v_rcp_f32 v111, v111
    v_rcp_f32 v124, v124
    v_rcp_f32 v125, v125
    v_rcp_f32 v126, v126
    v_rcp_f32 v127, v127
    v_pk_mul_f32 v[140:141], v[140:141], v[108:109]
    v_pk_mul_f32 v[142:143], v[142:143], v[110:111]
    v_pk_mul_f32 v[156:157], v[156:157], v[124:125]
    v_pk_mul_f32 v[158:159], v[158:159], v[126:127]
    v_cvt_pk_bf16_f32 v108, v140, v141
    v_cvt_pk_bf16_f32 v109, v142, v143
    v_cvt_pk_bf16_f32 v110, v156, v157
    v_cvt_pk_bf16_f32 v111, v158, v159
    buffer_store_dwordx4 v[108:111], v5, s[40:43], s51 offen offset:1024
    ds_read_b128 v[8:11], v6 offset:256
    ds_read_b128 v[12:15], v6 offset:768
    s_waitcnt lgkmcnt(1)
    v_pk_fma_f32 v[160:161], v[8:9], v[16:17], v[160:161] op_sel_hi:[1,0,1]
    s_waitcnt lgkmcnt(0)
    v_pk_fma_f32 v[192:193], v[12:13], v[16:17], v[192:193] op_sel_hi:[1,0,1]
    v_pk_fma_f32 v[162:163], v[10:11], v[16:17], v[162:163] op_sel_hi:[1,0,1]
    v_pk_fma_f32 v[194:195], v[14:15], v[16:17], v[194:195] op_sel_hi:[1,0,1]
    v_pk_fma_f32 v[164:165], v[8:9], v[20:21], v[164:165] op_sel_hi:[1,0,1]
    v_pk_fma_f32 v[196:197], v[12:13], v[20:21], v[196:197] op_sel_hi:[1,0,1]
    v_pk_fma_f32 v[166:167], v[10:11], v[20:21], v[166:167] op_sel_hi:[1,0,1]
    v_pk_fma_f32 v[198:199], v[14:15], v[20:21], v[198:199] op_sel_hi:[1,0,1]
    v_pk_fma_f32 v[168:169], v[8:9], v[24:25], v[168:169] op_sel_hi:[1,0,1]
    v_pk_fma_f32 v[200:201], v[12:13], v[24:25], v[200:201] op_sel_hi:[1,0,1]
    v_pk_fma_f32 v[170:171], v[10:11], v[24:25], v[170:171] op_sel_hi:[1,0,1]
    v_pk_fma_f32 v[202:203], v[14:15], v[24:25], v[202:203] op_sel_hi:[1,0,1]
    v_pk_fma_f32 v[172:173], v[8:9], v[28:29], v[172:173] op_sel_hi:[1,0,1]
    v_pk_fma_f32 v[204:205], v[12:13], v[28:29], v[204:205] op_sel_hi:[1,0,1]
    v_pk_fma_f32 v[174:175], v[10:11], v[28:29], v[174:175] op_sel_hi:[1,0,1]
    v_pk_fma_f32 v[206:207], v[14:15], v[28:29], v[206:207] op_sel_hi:[1,0,1]
    ds_read_b128 v[8:11], v6 offset:320
    ds_read_b128 v[12:15], v6 offset:832
    s_waitcnt lgkmcnt(1)
    v_pk_fma_f32 v[176:177], v[8:9], v[16:17], v[176:177] op_sel_hi:[1,0,1]
    s_waitcnt lgkmcnt(0)
    v_pk_fma_f32 v[208:209], v[12:13], v[16:17], v[208:209] op_sel_hi:[1,0,1]
    v_pk_fma_f32 v[178:179], v[10:11], v[16:17], v[178:179] op_sel_hi:[1,0,1]
    v_pk_fma_f32 v[210:211], v[14:15], v[16:17], v[210:211] op_sel_hi:[1,0,1]
    v_pk_fma_f32 v[180:181], v[8:9], v[20:21], v[180:181] op_sel_hi:[1,0,1]
    v_pk_fma_f32 v[212:213], v[12:13], v[20:21], v[212:213] op_sel_hi:[1,0,1]
    v_pk_fma_f32 v[182:183], v[10:11], v[20:21], v[182:183] op_sel_hi:[1,0,1]
    v_pk_fma_f32 v[214:215], v[14:15], v[20:21], v[214:215] op_sel_hi:[1,0,1]
    v_pk_fma_f32 v[184:185], v[8:9], v[24:25], v[184:185] op_sel_hi:[1,0,1]
    v_pk_fma_f32 v[216:217], v[12:13], v[24:25], v[216:217] op_sel_hi:[1,0,1]
    v_pk_fma_f32 v[186:187], v[10:11], v[24:25], v[186:187] op_sel_hi:[1,0,1]
    v_pk_fma_f32 v[218:219], v[14:15], v[24:25], v[218:219] op_sel_hi:[1,0,1]
    v_pk_fma_f32 v[188:189], v[8:9], v[28:29], v[188:189] op_sel_hi:[1,0,1]
    v_pk_fma_f32 v[220:221], v[12:13], v[28:29], v[220:221] op_sel_hi:[1,0,1]
    v_pk_fma_f32 v[190:191], v[10:11], v[28:29], v[190:191] op_sel_hi:[1,0,1]
    v_pk_fma_f32 v[222:223], v[14:15], v[28:29], v[222:223] op_sel_hi:[1,0,1]
    v_pk_mul_f32 v[192:193], v[192:193], v[160:161]
    v_pk_mul_f32 v[160:161], v[160:161], v[18:19] op_sel_hi:[1,0]
    v_pk_mul_f32 v[194:195], v[194:195], v[162:163]
    v_pk_mul_f32 v[162:163], v[162:163], v[18:19] op_sel_hi:[1,0]
    v_pk_mul_f32 v[208:209], v[208:209], v[176:177]
    v_pk_mul_f32 v[176:177], v[176:177], v[18:19] op_sel_hi:[1,0]
    v_pk_mul_f32 v[210:211], v[210:211], v[178:179]
    v_pk_mul_f32 v[178:179], v[178:179], v[18:19] op_sel_hi:[1,0]
    v_exp_f32 v160, v160
    v_exp_f32 v161, v161
    v_exp_f32 v162, v162
    v_exp_f32 v163, v163
    v_exp_f32 v176, v176
    v_exp_f32 v177, v177
    v_exp_f32 v178, v178
    v_exp_f32 v179, v179
    v_pk_fma_f32 v[160:161], v[160:161], v[16:17], v[16:17] op_sel:[0,1,1] op_sel_hi:[1,1,1]
    v_pk_fma_f32 v[162:163], v[162:163], v[16:17], v[16:17] op_sel:[0,1,1] op_sel_hi:[1,1,1]
    v_pk_fma_f32 v[176:177], v[176:177], v[16:17], v[16:17] op_sel:[0,1,1] op_sel_hi:[1,1,1]
    v_pk_fma_f32 v[178:179], v[178:179], v[16:17], v[16:17] op_sel:[0,1,1] op_sel_hi:[1,1,1]
    v_rcp_f32 v160, v160
    v_rcp_f32 v161, v161
    v_rcp_f32 v162, v162
    v_rcp_f32 v163, v163
    v_rcp_f32 v176, v176
    v_rcp_f32 v177, v177
    v_rcp_f32 v178, v178
    v_rcp_f32 v179, v179
    v_pk_mul_f32 v[192:193], v[192:193], v[160:161]
    v_pk_mul_f32 v[194:195], v[194:195], v[162:163]
    v_pk_mul_f32 v[208:209], v[208:209], v[176:177]
    v_pk_mul_f32 v[210:211], v[210:211], v[178:179]
    v_cvt_pk_bf16_f32 v160, v192, v193
    v_cvt_pk_bf16_f32 v161, v194, v195
    v_cvt_pk_bf16_f32 v162, v208, v209
    v_cvt_pk_bf16_f32 v163, v210, v211
    buffer_store_dwordx4 v[160:163], v4, s[40:43], s52 offen offset:0
    v_pk_mul_f32 v[196:197], v[196:197], v[164:165]
    v_pk_mul_f32 v[164:165], v[164:165], v[22:23] op_sel_hi:[1,0]
    v_pk_mul_f32 v[198:199], v[198:199], v[166:167]
    v_pk_mul_f32 v[166:167], v[166:167], v[22:23] op_sel_hi:[1,0]
    v_pk_mul_f32 v[212:213], v[212:213], v[180:181]
    v_pk_mul_f32 v[180:181], v[180:181], v[22:23] op_sel_hi:[1,0]
    v_pk_mul_f32 v[214:215], v[214:215], v[182:183]
    v_pk_mul_f32 v[182:183], v[182:183], v[22:23] op_sel_hi:[1,0]
    v_exp_f32 v164, v164
    v_exp_f32 v165, v165
    v_exp_f32 v166, v166
    v_exp_f32 v167, v167
    v_exp_f32 v180, v180
    v_exp_f32 v181, v181
    v_exp_f32 v182, v182
    v_exp_f32 v183, v183
    v_pk_fma_f32 v[164:165], v[164:165], v[20:21], v[20:21] op_sel:[0,1,1] op_sel_hi:[1,1,1]
    v_pk_fma_f32 v[166:167], v[166:167], v[20:21], v[20:21] op_sel:[0,1,1] op_sel_hi:[1,1,1]
    v_pk_fma_f32 v[180:181], v[180:181], v[20:21], v[20:21] op_sel:[0,1,1] op_sel_hi:[1,1,1]
    v_pk_fma_f32 v[182:183], v[182:183], v[20:21], v[20:21] op_sel:[0,1,1] op_sel_hi:[1,1,1]
    v_rcp_f32 v164, v164
    v_rcp_f32 v165, v165
    v_rcp_f32 v166, v166
    v_rcp_f32 v167, v167
    v_rcp_f32 v180, v180
    v_rcp_f32 v181, v181
    v_rcp_f32 v182, v182
    v_rcp_f32 v183, v183
    v_pk_mul_f32 v[196:197], v[196:197], v[164:165]
    v_pk_mul_f32 v[198:199], v[198:199], v[166:167]
    v_pk_mul_f32 v[212:213], v[212:213], v[180:181]
    v_pk_mul_f32 v[214:215], v[214:215], v[182:183]
    v_cvt_pk_bf16_f32 v164, v196, v197
    v_cvt_pk_bf16_f32 v165, v198, v199
    v_cvt_pk_bf16_f32 v166, v212, v213
    v_cvt_pk_bf16_f32 v167, v214, v215
    buffer_store_dwordx4 v[164:167], v4, s[40:43], s52 offen offset:1024
    v_pk_mul_f32 v[200:201], v[200:201], v[168:169]
    v_pk_mul_f32 v[168:169], v[168:169], v[26:27] op_sel_hi:[1,0]
    v_pk_mul_f32 v[202:203], v[202:203], v[170:171]
    v_pk_mul_f32 v[170:171], v[170:171], v[26:27] op_sel_hi:[1,0]
    v_pk_mul_f32 v[216:217], v[216:217], v[184:185]
    v_pk_mul_f32 v[184:185], v[184:185], v[26:27] op_sel_hi:[1,0]
    v_pk_mul_f32 v[218:219], v[218:219], v[186:187]
    v_pk_mul_f32 v[186:187], v[186:187], v[26:27] op_sel_hi:[1,0]
    v_exp_f32 v168, v168
    v_exp_f32 v169, v169
    v_exp_f32 v170, v170
    v_exp_f32 v171, v171
    v_exp_f32 v184, v184
    v_exp_f32 v185, v185
    v_exp_f32 v186, v186
    v_exp_f32 v187, v187
    v_pk_fma_f32 v[168:169], v[168:169], v[24:25], v[24:25] op_sel:[0,1,1] op_sel_hi:[1,1,1]
    v_pk_fma_f32 v[170:171], v[170:171], v[24:25], v[24:25] op_sel:[0,1,1] op_sel_hi:[1,1,1]
    v_pk_fma_f32 v[184:185], v[184:185], v[24:25], v[24:25] op_sel:[0,1,1] op_sel_hi:[1,1,1]
    v_pk_fma_f32 v[186:187], v[186:187], v[24:25], v[24:25] op_sel:[0,1,1] op_sel_hi:[1,1,1]
    v_rcp_f32 v168, v168
    v_rcp_f32 v169, v169
    v_rcp_f32 v170, v170
    v_rcp_f32 v171, v171
    v_rcp_f32 v184, v184
    v_rcp_f32 v185, v185
    v_rcp_f32 v186, v186
    v_rcp_f32 v187, v187
    v_pk_mul_f32 v[200:201], v[200:201], v[168:169]
    v_pk_mul_f32 v[202:203], v[202:203], v[170:171]
    v_pk_mul_f32 v[216:217], v[216:217], v[184:185]
    v_pk_mul_f32 v[218:219], v[218:219], v[186:187]
    v_cvt_pk_bf16_f32 v168, v200, v201
    v_cvt_pk_bf16_f32 v169, v202, v203
    v_cvt_pk_bf16_f32 v170, v216, v217
    v_cvt_pk_bf16_f32 v171, v218, v219
    buffer_store_dwordx4 v[168:171], v5, s[40:43], s52 offen offset:0
    v_pk_mul_f32 v[204:205], v[204:205], v[172:173]
    v_pk_mul_f32 v[172:173], v[172:173], v[30:31] op_sel_hi:[1,0]
    v_pk_mul_f32 v[206:207], v[206:207], v[174:175]
    v_pk_mul_f32 v[174:175], v[174:175], v[30:31] op_sel_hi:[1,0]
    v_pk_mul_f32 v[220:221], v[220:221], v[188:189]
    v_pk_mul_f32 v[188:189], v[188:189], v[30:31] op_sel_hi:[1,0]
    v_pk_mul_f32 v[222:223], v[222:223], v[190:191]
    v_pk_mul_f32 v[190:191], v[190:191], v[30:31] op_sel_hi:[1,0]
    v_exp_f32 v172, v172
    v_exp_f32 v173, v173
    v_exp_f32 v174, v174
    v_exp_f32 v175, v175
    v_exp_f32 v188, v188
    v_exp_f32 v189, v189
    v_exp_f32 v190, v190
    v_exp_f32 v191, v191
    v_pk_fma_f32 v[172:173], v[172:173], v[28:29], v[28:29] op_sel:[0,1,1] op_sel_hi:[1,1,1]
    v_pk_fma_f32 v[174:175], v[174:175], v[28:29], v[28:29] op_sel:[0,1,1] op_sel_hi:[1,1,1]
    v_pk_fma_f32 v[188:189], v[188:189], v[28:29], v[28:29] op_sel:[0,1,1] op_sel_hi:[1,1,1]
    v_pk_fma_f32 v[190:191], v[190:191], v[28:29], v[28:29] op_sel:[0,1,1] op_sel_hi:[1,1,1]
    v_rcp_f32 v172, v172
    v_rcp_f32 v173, v173
    v_rcp_f32 v174, v174
    v_rcp_f32 v175, v175
    v_rcp_f32 v188, v188
    v_rcp_f32 v189, v189
    v_rcp_f32 v190, v190
    v_rcp_f32 v191, v191
    v_pk_mul_f32 v[204:205], v[204:205], v[172:173]
    v_pk_mul_f32 v[206:207], v[206:207], v[174:175]
    v_pk_mul_f32 v[220:221], v[220:221], v[188:189]
    v_pk_mul_f32 v[222:223], v[222:223], v[190:191]
    v_cvt_pk_bf16_f32 v172, v204, v205
    v_cvt_pk_bf16_f32 v173, v206, v207
    v_cvt_pk_bf16_f32 v174, v220, v221
    v_cvt_pk_bf16_f32 v175, v222, v223
    buffer_store_dwordx4 v[172:175], v5, s[40:43], s52 offen offset:1024
    ds_read_b128 v[8:11], v7 offset:0
    ds_read_b128 v[12:15], v7 offset:512
    s_waitcnt lgkmcnt(1)
    v_pk_fma_f32 v[224:225], v[8:9], v[16:17], v[224:225] op_sel_hi:[1,0,1]
    s_waitcnt lgkmcnt(0)
    v_pk_fma_f32 v[240:241], v[12:13], v[16:17], v[240:241] op_sel_hi:[1,0,1]
    v_pk_fma_f32 v[226:227], v[10:11], v[16:17], v[226:227] op_sel_hi:[1,0,1]
    v_pk_fma_f32 v[242:243], v[14:15], v[16:17], v[242:243] op_sel_hi:[1,0,1]
    v_pk_fma_f32 v[228:229], v[8:9], v[20:21], v[228:229] op_sel_hi:[1,0,1]
    v_pk_fma_f32 v[244:245], v[12:13], v[20:21], v[244:245] op_sel_hi:[1,0,1]
    v_pk_fma_f32 v[230:231], v[10:11], v[20:21], v[230:231] op_sel_hi:[1,0,1]
    v_pk_fma_f32 v[246:247], v[14:15], v[20:21], v[246:247] op_sel_hi:[1,0,1]
    ds_read_b128 v[8:11], v7 offset:64
    ds_read_b128 v[12:15], v7 offset:576
    s_waitcnt lgkmcnt(1)
    v_pk_fma_f32 v[232:233], v[8:9], v[16:17], v[232:233] op_sel_hi:[1,0,1]
    s_waitcnt lgkmcnt(0)
    v_pk_fma_f32 v[248:249], v[12:13], v[16:17], v[248:249] op_sel_hi:[1,0,1]
    v_pk_fma_f32 v[234:235], v[10:11], v[16:17], v[234:235] op_sel_hi:[1,0,1]
    v_pk_fma_f32 v[250:251], v[14:15], v[16:17], v[250:251] op_sel_hi:[1,0,1]
    v_pk_fma_f32 v[236:237], v[8:9], v[20:21], v[236:237] op_sel_hi:[1,0,1]
    v_pk_fma_f32 v[252:253], v[12:13], v[20:21], v[252:253] op_sel_hi:[1,0,1]
    v_pk_fma_f32 v[238:239], v[10:11], v[20:21], v[238:239] op_sel_hi:[1,0,1]
    v_pk_fma_f32 v[254:255], v[14:15], v[20:21], v[254:255] op_sel_hi:[1,0,1]
    v_pk_mul_f32 v[240:241], v[240:241], v[224:225]
    v_pk_mul_f32 v[224:225], v[224:225], v[18:19] op_sel_hi:[1,0]
    v_pk_mul_f32 v[242:243], v[242:243], v[226:227]
    v_pk_mul_f32 v[226:227], v[226:227], v[18:19] op_sel_hi:[1,0]
    v_pk_mul_f32 v[248:249], v[248:249], v[232:233]
    v_pk_mul_f32 v[232:233], v[232:233], v[18:19] op_sel_hi:[1,0]
    v_pk_mul_f32 v[250:251], v[250:251], v[234:235]
    v_pk_mul_f32 v[234:235], v[234:235], v[18:19] op_sel_hi:[1,0]
    v_exp_f32 v224, v224
    v_exp_f32 v225, v225
    v_exp_f32 v226, v226
    v_exp_f32 v227, v227
    v_exp_f32 v232, v232
    v_exp_f32 v233, v233
    v_exp_f32 v234, v234
    v_exp_f32 v235, v235
    v_pk_fma_f32 v[224:225], v[224:225], v[16:17], v[16:17] op_sel:[0,1,1] op_sel_hi:[1,1,1]
    v_pk_fma_f32 v[226:227], v[226:227], v[16:17], v[16:17] op_sel:[0,1,1] op_sel_hi:[1,1,1]
    v_pk_fma_f32 v[232:233], v[232:233], v[16:17], v[16:17] op_sel:[0,1,1] op_sel_hi:[1,1,1]
    v_pk_fma_f32 v[234:235], v[234:235], v[16:17], v[16:17] op_sel:[0,1,1] op_sel_hi:[1,1,1]
    v_rcp_f32 v224, v224
    v_rcp_f32 v225, v225
    v_rcp_f32 v226, v226
    v_rcp_f32 v227, v227
    v_rcp_f32 v232, v232
    v_rcp_f32 v233, v233
    v_rcp_f32 v234, v234
    v_rcp_f32 v235, v235
    v_pk_mul_f32 v[240:241], v[240:241], v[224:225]
    v_pk_mul_f32 v[242:243], v[242:243], v[226:227]
    v_pk_mul_f32 v[248:249], v[248:249], v[232:233]
    v_pk_mul_f32 v[250:251], v[250:251], v[234:235]
    v_cvt_pk_bf16_f32 v224, v240, v241
    v_cvt_pk_bf16_f32 v225, v242, v243
    v_cvt_pk_bf16_f32 v226, v248, v249
    v_cvt_pk_bf16_f32 v227, v250, v251
    buffer_store_dwordx4 v[224:227], v4, s[40:43], s53 offen offset:0
    v_pk_mul_f32 v[244:245], v[244:245], v[228:229]
    v_pk_mul_f32 v[228:229], v[228:229], v[22:23] op_sel_hi:[1,0]
    v_pk_mul_f32 v[246:247], v[246:247], v[230:231]
    v_pk_mul_f32 v[230:231], v[230:231], v[22:23] op_sel_hi:[1,0]
    v_pk_mul_f32 v[252:253], v[252:253], v[236:237]
    v_pk_mul_f32 v[236:237], v[236:237], v[22:23] op_sel_hi:[1,0]
    v_pk_mul_f32 v[254:255], v[254:255], v[238:239]
    v_pk_mul_f32 v[238:239], v[238:239], v[22:23] op_sel_hi:[1,0]
    v_exp_f32 v228, v228
    v_exp_f32 v229, v229
    v_exp_f32 v230, v230
    v_exp_f32 v231, v231
    v_exp_f32 v236, v236
    v_exp_f32 v237, v237
    v_exp_f32 v238, v238
    v_exp_f32 v239, v239
    v_pk_fma_f32 v[228:229], v[228:229], v[20:21], v[20:21] op_sel:[0,1,1] op_sel_hi:[1,1,1]
    v_pk_fma_f32 v[230:231], v[230:231], v[20:21], v[20:21] op_sel:[0,1,1] op_sel_hi:[1,1,1]
    v_pk_fma_f32 v[236:237], v[236:237], v[20:21], v[20:21] op_sel:[0,1,1] op_sel_hi:[1,1,1]
    v_pk_fma_f32 v[238:239], v[238:239], v[20:21], v[20:21] op_sel:[0,1,1] op_sel_hi:[1,1,1]
    v_rcp_f32 v228, v228
    v_rcp_f32 v229, v229
    v_rcp_f32 v230, v230
    v_rcp_f32 v231, v231
    v_rcp_f32 v236, v236
    v_rcp_f32 v237, v237
    v_rcp_f32 v238, v238
    v_rcp_f32 v239, v239
    v_pk_mul_f32 v[244:245], v[244:245], v[228:229]
    v_pk_mul_f32 v[246:247], v[246:247], v[230:231]
    v_pk_mul_f32 v[252:253], v[252:253], v[236:237]
    v_pk_mul_f32 v[254:255], v[254:255], v[238:239]
    v_cvt_pk_bf16_f32 v228, v244, v245
    v_cvt_pk_bf16_f32 v229, v246, v247
    v_cvt_pk_bf16_f32 v230, v252, v253
    v_cvt_pk_bf16_f32 v231, v254, v255
    buffer_store_dwordx4 v[228:231], v4, s[40:43], s53 offen offset:1024
gu2_kernel_end:
    s_endpgm
.text
.globl dn2_kernel
.p2align 8
.type dn2_kernel,@function
dn2_kernel:
    s_cmp_ge_u32 s2, 256
    s_cbranch_scc1 dn2_kernel_end
    s_load_dwordx2 s[10:11], s[0:1], 72
    s_load_dwordx2 s[12:13], s[0:1], 48
    s_load_dwordx2 s[14:15], s[0:1], 56
    v_lshrrev_b32 v2, 6, v0
    v_and_b32 v1, 63, v0
    v_readfirstlane_b32 s3, v2
    s_and_b32 s4, s2, 7
    s_lshr_b32 s5, s2, 3
    s_lshr_b32 s6, s4, 1
    s_lshl_b32 s6, s6, 2
    s_and_b32 s7, s5, 3
    s_add_u32 s6, s6, s7
    s_and_b32 s7, s4, 1
    s_lshl_b32 s7, s7, 3
    s_lshr_b32 s8, s5, 2
    s_add_u32 s7, s7, s8
    s_lshl_b32 s20, s6, 13
    s_lshl_b32 s21, s3, 11
    s_add_u32 s20, s20, s21
    v_lshl_add_u32 v4, v1, 4, s20
    v_bfe_u32 v8, v1, 3, 1
    v_lshrrev_b32 v9, 4, v1
    v_lshl_add_u32 v8, v9, 3, v8
    s_lshl_b32 s21, s3, 1
    v_add_u32 v8, s21, v8
    v_lshlrev_b32 v8, 11, v8
    v_and_b32 v9, 7, v1
    v_lshl_add_u32 v8, v9, 4, v8
    s_lshl_b32 s21, s7, 7
    v_add_u32 v5, s21, v8
    v_add_u32 v6, 64512, v5
    v_bfe_u32 v8, v1, 3, 2
    v_mul_u32_u24 v8, 2080, v8
    v_bfe_u32 v9, v1, 2, 1
    v_lshl_add_u32 v8, v9, 7, v8
    v_bfe_u32 v9, v1, 5, 1
    v_lshl_add_u32 v8, v9, 8, v8
    v_and_b32 v9, 3, v1
    v_lshl_add_u32 v7, v9, 3, v8
    s_mul_i32 s22, s3, 2080
    s_mov_b32 s23, 0
    s_mov_b32 s24, 0x20000
    s_mov_b32 s25, 0
    s_waitcnt lgkmcnt(0)
    s_add_u32 s28, s10, 41943040
    s_addc_u32 s29, s11, 0
    s_mov_b32 s30, 14680064
    s_mov_b32 s31, 0x20000
    s_mov_b32 s32, s12
    s_mov_b32 s33, s13
    s_mov_b32 s34, 7340032
    s_mov_b32 s35, 0x20000
    s_add_u32 m0, s22, 0
    s_nop 0
    buffer_load_dwordx4 v5, s[32:35], s25 offen lds
    buffer_load_dwordx4 v6, s[32:35], s25 offen offset:1024 lds
    s_add_u32 s25, s25, 0x20000
    buffer_load_dwordx4 v[48:51], v4, s[28:31], s23 offen offset:0
    buffer_load_dwordx4 v[52:55], v4, s[28:31], s23 offen offset:1024
    s_add_u32 s23, s23, 0x40000
    buffer_load_dwordx4 v[56:59], v4, s[28:31], s24 offen offset:0
    buffer_load_dwordx4 v[60:63], v4, s[28:31], s24 offen offset:1024
    s_add_u32 s24, s24, 0x40000
    s_add_u32 m0, s22, 8320
    s_nop 0
    buffer_load_dwordx4 v5, s[32:35], s25 offen lds
    buffer_load_dwordx4 v6, s[32:35], s25 offen offset:1024 lds
    s_add_u32 s25, s25, 0x20000
    buffer_load_dwordx4 v[64:67], v4, s[28:31], s23 offen offset:0
    buffer_load_dwordx4 v[68:71], v4, s[28:31], s23 offen offset:1024
    s_add_u32 s23, s23, 0x40000
    buffer_load_dwordx4 v[72:75], v4, s[28:31], s24 offen offset:0
    buffer_load_dwordx4 v[76:79], v4, s[28:31], s24 offen offset:1024
    s_add_u32 s24, s24, 0x40000
    s_add_u32 m0, s22, 16640
    s_nop 0
    buffer_load_dwordx4 v5, s[32:35], s25 offen lds
    buffer_load_dwordx4 v6, s[32:35], s25 offen offset:1024 lds
    s_add_u32 s25, s25, 0x20000
    buffer_load_dwordx4 v[80:83], v4, s[28:31], s23 offen offset:0
    buffer_load_dwordx4 v[84:87], v4, s[28:31], s23 offen offset:1024
    s_add_u32 s23, s23, 0x40000
    buffer_load_dwordx4 v[88:91], v4, s[28:31], s24 offen offset:0
    buffer_load_dwordx4 v[92:95], v4, s[28:31], s24 offen offset:1024
    s_add_u32 s24, s24, 0x40000
    s_add_u32 m0, s22, 24960
    s_nop 0
    buffer_load_dwordx4 v5, s[32:35], s25 offen lds
    buffer_load_dwordx4 v6, s[32:35], s25 offen offset:1024 lds
    s_add_u32 s25, s25, 0x20000
    buffer_load_dwordx4 v[96:99], v4, s[28:31], s23 offen offset:0
    buffer_load_dwordx4 v[100:103], v4, s[28:31], s23 offen offset:1024
    s_add_u32 s23, s23, 0x40000
    buffer_load_dwordx4 v[104:107], v4, s[28:31], s24 offen offset:0
    buffer_load_dwordx4 v[108:111], v4, s[28:31], s24 offen offset:1024
    s_add_u32 s24, s24, 0x40000
    s_add_u32 m0, s22, 33280
    s_nop 0
    buffer_load_dwordx4 v5, s[32:35], s25 offen lds
    buffer_load_dwordx4 v6, s[32:35], s25 offen offset:1024 lds
    s_add_u32 s25, s25, 0x20000
    buffer_load_dwordx4 v[112:115], v4, s[28:31], s23 offen offset:0
    buffer_load_dwordx4 v[116:119], v4, s[28:31], s23 offen offset:1024
    s_add_u32 s23, s23, 0x40000
    buffer_load_dwordx4 v[120:123], v4, s[28:31], s24 offen offset:0
    buffer_load_dwordx4 v[124:127], v4, s[28:31], s24 offen offset:1024
    s_add_u32 s24, s24, 0x40000
    s_add_u32 m0, s22, 41600
    s_nop 0
    buffer_load_dwordx4 v5, s[32:35], s25 offen lds
    buffer_load_dwordx4 v6, s[32:35], s25 offen offset:1024 lds
    s_add_u32 s25, s25, 0x20000
    buffer_load_dwordx4 v[128:131], v4, s[28:31], s23 offen offset:0
    buffer_load_dwordx4 v[132:135], v4, s[28:31], s23 offen offset:1024
    s_add_u32 s23, s23, 0x40000
    buffer_load_dwordx4 v[136:139], v4, s[28:31], s24 offen offset:0
    buffer_load_dwordx4 v[140:143], v4, s[28:31], s24 offen offset:1024
    s_add_u32 s24, s24, 0x40000
    s_add_u32 m0, s22, 49920
    s_nop 0
    buffer_load_dwordx4 v5, s[32:35], s25 offen lds
    buffer_load_dwordx4 v6, s[32:35], s25 offen offset:1024 lds
    s_add_u32 s25, s25, 0x20000
    buffer_load_dwordx4 v[144:147], v4, s[28:31], s23 offen offset:0
    buffer_load_dwordx4 v[148:151], v4, s[28:31], s23 offen offset:1024
    s_add_u32 s23, s23, 0x40000
    buffer_load_dwordx4 v[152:155], v4, s[28:31], s24 offen offset:0
    buffer_load_dwordx4 v[156:159], v4, s[28:31], s24 offen offset:1024
    s_add_u32 s24, s24, 0x40000
    s_add_u32 m0, s22, 58240
    s_nop 0
    buffer_load_dwordx4 v5, s[32:35], s25 offen lds
    buffer_load_dwordx4 v6, s[32:35], s25 offen offset:1024 lds
    s_add_u32 s25, s25, 0x20000
    v_mov_b32 v16, 0
    v_mov_b32 v17, 0
    v_mov_b32 v18, 0
    v_mov_b32 v19, 0
    v_mov_b32 v20, 0
    v_mov_b32 v21, 0
    v_mov_b32 v22, 0
    v_mov_b32 v23, 0
    v_mov_b32 v24, 0
    v_mov_b32 v25, 0
    v_mov_b32 v26, 0
    v_mov_b32 v27, 0
    v_mov_b32 v28, 0
    v_mov_b32 v29, 0
    v_mov_b32 v30, 0
    v_mov_b32 v31, 0
    v_mov_b32 v32, 0
    v_mov_b32 v33, 0
    v_mov_b32 v34, 0
    v_mov_b32 v35, 0
    v_mov_b32 v36, 0
    v_mov_b32 v37, 0
    v_mov_b32 v38, 0
    v_mov_b32 v39, 0
    v_mov_b32 v40, 0
    v_mov_b32 v41, 0
    v_mov_b32 v42, 0
    v_mov_b32 v43, 0
    v_mov_b32 v44, 0
    v_mov_b32 v45, 0
    v_mov_b32 v46, 0
    v_mov_b32 v47, 0
    s_add_u32 s36, s10, 20971520
    s_addc_u32 s37, s11, 0
    s_mov_b32 s38, 4194304
    s_mov_b32 s39, 0x20000
    s_lshl_b32 s26, s7, 18
    s_add_u32 s27, s26, 0x20000
    s_mov_b32 s40, s14
    s_mov_b32 s41, s15
    s_mov_b32 s42, 4194304
    s_mov_b32 s43, 0x20000
    s_lshr_b32 s44, s6, 1
    s_lshl_b32 s44, s44, 8
    s_and_b32 s45, s6, 1
    s_add_u32 s44, s44, s45
    s_lshl_b32 s45, s3, 6
    s_add_u32 s44, s44, s45
    s_add_u32 s44, s44, 0
    s_lshl_b32 s44, s44, 11
    s_lshl_b32 s45, s7, 7
    s_add_u32 s44, s44, s45
    v_and_b32 v10, 15, v1
    v_lshlrev_b32 v10, 12, v10
    v_bfe_u32 v9, v1, 4, 1
    v_lshl_add_u32 v10, v9, 5, v10
    v_bfe_u32 v9, v1, 5, 1
    v_lshl_add_u32 v10, v9, 4, v10
    v_add_u32 v10, s44, v10
    v_add_u32 v11, 0x10000, v10
    s_waitcnt vmcnt(42)
    s_barrier
    ds_read_b64_tr_b16 a[0:1], v7 offset:0
    ds_read_b64_tr_b16 a[2:3], v7 offset:512
    ds_read_b64_tr_b16 a[4:5], v7 offset:32
    ds_read_b64_tr_b16 a[6:7], v7 offset:544
    ds_read_b64_tr_b16 a[8:9], v7 offset:64
    ds_read_b64_tr_b16 a[10:11], v7 offset:576
    ds_read_b64_tr_b16 a[12:13], v7 offset:96
    ds_read_b64_tr_b16 a[14:15], v7 offset:608
    ds_read_b64_tr_b16 a[16:17], v7 offset:1024
    ds_read_b64_tr_b16 a[18:19], v7 offset:1536
    ds_read_b64_tr_b16 a[20:21], v7 offset:1056
    ds_read_b64_tr_b16 a[22:23], v7 offset:1568
    ds_read_b64_tr_b16 a[24:25], v7 offset:1088
    ds_read_b64_tr_b16 a[26:27], v7 offset:1600
    ds_read_b64_tr_b16 a[28:29], v7 offset:1120
    ds_read_b64_tr_b16 a[30:31], v7 offset:1632
    s_mov_b32 s48, 6
.p2align 6
dn2_kernel_loop:
    s_waitcnt lgkmcnt(0)
    s_waitcnt vmcnt(36)
    s_barrier
    v_mfma_f32_16x16x32_bf16 v[16:19], a[0:3], v[48:51], v[16:19]
    ds_read_b64_tr_b16 a[32:33], v7 offset:8320
    ds_read_b64_tr_b16 a[34:35], v7 offset:8832
    s_add_u32 m0, s22, 0
    s_nop 0
    buffer_load_dwordx4 v5, s[32:35], s25 offen lds
    v_mfma_f32_16x16x32_bf16 v[32:35], a[0:3], v[52:55], v[32:35]
    ds_read_b64_tr_b16 a[36:37], v7 offset:8352
    v_mfma_f32_16x16x32_bf16 v[20:23], a[4:7], v[48:51], v[20:23]
    ds_read_b64_tr_b16 a[38:39], v7 offset:8864
    buffer_load_dwordx4 v[160:163], v4, s[28:31], s23 offen offset:0
    v_mfma_f32_16x16x32_bf16 v[36:39], a[4:7], v[52:55], v[36:39]
    ds_read_b64_tr_b16 a[40:41], v7 offset:8384
    v_mfma_f32_16x16x32_bf16 v[24:27], a[8:11], v[48:51], v[24:27]
    ds_read_b64_tr_b16 a[42:43], v7 offset:8896
    ds_read_b64_tr_b16 a[44:45], v7 offset:8416
    v_mfma_f32_16x16x32_bf16 v[40:43], a[8:11], v[52:55], v[40:43]
    ds_read_b64_tr_b16 a[46:47], v7 offset:8928
    buffer_load_dwordx4 v[164:167], v4, s[28:31], s23 offen offset:1024
    s_add_u32 s23, s23, 0x40000
    v_mfma_f32_16x16x32_bf16 v[28:31], a[12:15], v[48:51], v[28:31]
    ds_read_b64_tr_b16 a[48:49], v7 offset:9344
    v_mfma_f32_16x16x32_bf16 v[44:47], a[12:15], v[52:55], v[44:47]
    ds_read_b64_tr_b16 a[50:51], v7 offset:9856
    v_mfma_f32_16x16x32_bf16 v[16:19], a[16:19], v[56:59], v[16:19]
    ds_read_b64_tr_b16 a[52:53], v7 offset:9376
    ds_read_b64_tr_b16 a[54:55], v7 offset:9888
    buffer_load_dwordx4 v6, s[32:35], s25 offen offset:1024 lds
    s_add_u32 s25, s25, 0x20000
    v_mfma_f32_16x16x32_bf16 v[32:35], a[16:19], v[60:63], v[32:35]
    ds_read_b64_tr_b16 a[56:57], v7 offset:9408
    v_mfma_f32_16x16x32_bf16 v[20:23], a[20:23], v[56:59], v[20:23]
    ds_read_b64_tr_b16 a[58:59], v7 offset:9920
    buffer_load_dwordx4 v[168:171], v4, s[28:31], s24 offen offset:0
    v_mfma_f32_16x16x32_bf16 v[36:39], a[20:23], v[60:63], v[36:39]
    ds_read_b64_tr_b16 a[60:61], v7 offset:9440
    v_mfma_f32_16x16x32_bf16 v[24:27], a[24:27], v[56:59], v[24:27]
    ds_read_b64_tr_b16 a[62:63], v7 offset:9952
    v_mfma_f32_16x16x32_bf16 v[40:43], a[24:27], v[60:63], v[40:43]
    buffer_load_dwordx4 v[172:175], v4, s[28:31], s24 offen offset:1024
    s_add_u32 s24, s24, 0x40000
    v_mfma_f32_16x16x32_bf16 v[28:31], a[28:31], v[56:59], v[28:31]
    v_mfma_f32_16x16x32_bf16 v[44:47], a[28:31], v[60:63], v[44:47]
    s_waitcnt lgkmcnt(0)
    s_waitcnt vmcnt(36)
    s_barrier
    v_mfma_f32_16x16x32_bf16 v[16:19], a[32:35], v[64:67], v[16:19]
    ds_read_b64_tr_b16 a[0:1], v7 offset:16640
    ds_read_b64_tr_b16 a[2:3], v7 offset:17152
    s_add_u32 m0, s22, 8320
    s_nop 0
    buffer_load_dwordx4 v5, s[32:35], s25 offen lds
    v_mfma_f32_16x16x32_bf16 v[32:35], a[32:35], v[68:71], v[32:35]
    ds_read_b64_tr_b16 a[4:5], v7 offset:16672
    v_mfma_f32_16x16x32_bf16 v[20:23], a[36:39], v[64:67], v[20:23]
    ds_read_b64_tr_b16 a[6:7], v7 offset:17184
    buffer_load_dwordx4 v[48:51], v4, s[28:31], s23 offen offset:0
    v_mfma_f32_16x16x32_bf16 v[36:39], a[36:39], v[68:71], v[36:39]
    ds_read_b64_tr_b16 a[8:9], v7 offset:16704
    v_mfma_f32_16x16x32_bf16 v[24:27], a[40:43], v[64:67], v[24:27]
    ds_read_b64_tr_b16 a[10:11], v7 offset:17216
    ds_read_b64_tr_b16 a[12:13], v7 offset:16736
    v_mfma_f32_16x16x32_bf16 v[40:43], a[40:43], v[68:71], v[40:43]
    ds_read_b64_tr_b16 a[14:15], v7 offset:17248
    buffer_load_dwordx4 v[52:55], v4, s[28:31], s23 offen offset:1024
    s_add_u32 s23, s23, 0x40000
    v_mfma_f32_16x16x32_bf16 v[28:31], a[44:47], v[64:67], v[28:31]
    ds_read_b64_tr_b16 a[16:17], v7 offset:17664
    v_mfma_f32_16x16x32_bf16 v[44:47], a[44:47], v[68:71], v[44:47]
    ds_read_b64_tr_b16 a[18:19], v7 offset:18176
    v_mfma_f32_16x16x32_bf16 v[16:19], a[48:51], v[72:75], v[16:19]
    ds_read_b64_tr_b16 a[20:21], v7 offset:17696
    ds_read_b64_tr_b16 a[22:23], v7 offset:18208
    buffer_load_dwordx4 v6, s[32:35], s25 offen offset:1024 lds
    s_add_u32 s25, s25, 0x20000
    v_mfma_f32_16x16x32_bf16 v[32:35], a[48:51], v[76:79], v[32:35]
    ds_read_b64_tr_b16 a[24:25], v7 offset:17728
    v_mfma_f32_16x16x32_bf16 v[20:23], a[52:55], v[72:75], v[20:23]
    ds_read_b64_tr_b16 a[26:27], v7 offset:18240
    buffer_load_dwordx4 v[56:59], v4, s[28:31], s24 offen offset:0
    v_mfma_f32_16x16x32_bf16 v[36:39], a[52:55], v[76:79], v[36:39]
    ds_read_b64_tr_b16 a[28:29], v7 offset:17760
    v_mfma_f32_16x16x32_bf16 v[24:27], a[56:59], v[72:75], v[24:27]
    ds_read_b64_tr_b16 a[30:31], v7 offset:18272
    v_mfma_f32_16x16x32_bf16 v[40:43], a[56:59], v[76:79], v[40:43]
    buffer_load_dwordx4 v[60:63], v4, s[28:31], s24 offen offset:1024
    s_add_u32 s24, s24, 0x40000
    v_mfma_f32_16x16x32_bf16 v[28:31], a[60:63], v[72:75], v[28:31]
    v_mfma_f32_16x16x32_bf16 v[44:47], a[60:63], v[76:79], v[44:47]
    s_waitcnt lgkmcnt(0)
    s_waitcnt vmcnt(36)
    s_barrier
    v_mfma_f32_16x16x32_bf16 v[16:19], a[0:3], v[80:83], v[16:19]
    ds_read_b64_tr_b16 a[32:33], v7 offset:24960
    ds_read_b64_tr_b16 a[34:35], v7 offset:25472
    s_add_u32 m0, s22, 16640
    s_nop 0
    buffer_load_dwordx4 v5, s[32:35], s25 offen lds
    v_mfma_f32_16x16x32_bf16 v[32:35], a[0:3], v[84:87], v[32:35]
    ds_read_b64_tr_b16 a[36:37], v7 offset:24992
    v_mfma_f32_16x16x32_bf16 v[20:23], a[4:7], v[80:83], v[20:23]
    ds_read_b64_tr_b16 a[38:39], v7 offset:25504
    buffer_load_dwordx4 v[64:67], v4, s[28:31], s23 offen offset:0
    v_mfma_f32_16x16x32_bf16 v[36:39], a[4:7], v[84:87], v[36:39]
    ds_read_b64_tr_b16 a[40:41], v7 offset:25024
    v_mfma_f32_16x16x32_bf16 v[24:27], a[8:11], v[80:83], v[24:27]
    ds_read_b64_tr_b16 a[42:43], v7 offset:25536
    ds_read_b64_tr_b16 a[44:45], v7 offset:25056
    v_mfma_f32_16x16x32_bf16 v[40:43], a[8:11], v[84:87], v[40:43]
    ds_read_b64_tr_b16 a[46:47], v7 offset:25568
    buffer_load_dwordx4 v[68:71], v4, s[28:31], s23 offen offset:1024
    s_add_u32 s23, s23, 0x40000
    v_mfma_f32_16x16x32_bf16 v[28:31], a[12:15], v[80:83], v[28:31]
    ds_read_b64_tr_b16 a[48:49], v7 offset:25984
    v_mfma_f32_16x16x32_bf16 v[44:47], a[12:15], v[84:87], v[44:47]
    ds_read_b64_tr_b16 a[50:51], v7 offset:26496
    v_mfma_f32_16x16x32_bf16 v[16:19], a[16:19], v[88:91], v[16:19]
    ds_read_b64_tr_b16 a[52:53], v7 offset:26016
    ds_read_b64_tr_b16 a[54:55], v7 offset:26528
    buffer_load_dwordx4 v6, s[32:35], s25 offen offset:1024 lds
    s_add_u32 s25, s25, 0x20000
    v_mfma_f32_16x16x32_bf16 v[32:35], a[16:19], v[92:95], v[32:35]
    ds_read_b64_tr_b16 a[56:57], v7 offset:26048
    v_mfma_f32_16x16x32_bf16 v[20:23], a[20:23], v[88:91], v[20:23]
    ds_read_b64_tr_b16 a[58:59], v7 offset:26560
    buffer_load_dwordx4 v[72:75], v4, s[28:31], s24 offen offset:0
    v_mfma_f32_16x16x32_bf16 v[36:39], a[20:23], v[92:95], v[36:39]
    ds_read_b64_tr_b16 a[60:61], v7 offset:26080
    v_mfma_f32_16x16x32_bf16 v[24:27], a[24:27], v[88:91], v[24:27]
    ds_read_b64_tr_b16 a[62:63], v7 offset:26592
    v_mfma_f32_16x16x32_bf16 v[40:43], a[24:27], v[92:95], v[40:43]
    buffer_load_dwordx4 v[76:79], v4, s[28:31], s24 offen offset:1024
    s_add_u32 s24, s24, 0x40000
    v_mfma_f32_16x16x32_bf16 v[28:31], a[28:31], v[88:91], v[28:31]
    v_mfma_f32_16x16x32_bf16 v[44:47], a[28:31], v[92:95], v[44:47]
    s_waitcnt lgkmcnt(0)
    s_waitcnt vmcnt(36)
    s_barrier
    v_mfma_f32_16x16x32_bf16 v[16:19], a[32:35], v[96:99], v[16:19]
    ds_read_b64_tr_b16 a[0:1], v7 offset:33280
    ds_read_b64_tr_b16 a[2:3], v7 offset:33792
    s_add_u32 m0, s22, 24960
    s_nop 0
    buffer_load_dwordx4 v5, s[32:35], s25 offen lds
    v_mfma_f32_16x16x32_bf16 v[32:35], a[32:35], v[100:103], v[32:35]
    ds_read_b64_tr_b16 a[4:5], v7 offset:33312
    v_mfma_f32_16x16x32_bf16 v[20:23], a[36:39], v[96:99], v[20:23]
    ds_read_b64_tr_b16 a[6:7], v7 offset:33824
    buffer_load_dwordx4 v[80:83], v4, s[28:31], s23 offen offset:0
    v_mfma_f32_16x16x32_bf16 v[36:39], a[36:39], v[100:103], v[36:39]
    ds_read_b64_tr_b16 a[8:9], v7 offset:33344
    v_mfma_f32_16x16x32_bf16 v[24:27], a[40:43], v[96:99], v[24:27]
    ds_read_b64_tr_b16 a[10:11], v7 offset:33856
    ds_read_b64_tr_b16 a[12:13], v7 offset:33376
    v_mfma_f32_16x16x32_bf16 v[40:43], a[40:43], v[100:103], v[40:43]
    ds_read_b64_tr_b16 a[14:15], v7 offset:33888
    buffer_load_dwordx4 v[84:87], v4, s[28:31], s23 offen offset:1024
    s_add_u32 s23, s23, 0x40000
    v_mfma_f32_16x16x32_bf16 v[28:31], a[44:47], v[96:99], v[28:31]
    ds_read_b64_tr_b16 a[16:17], v7 offset:34304
    v_mfma_f32_16x16x32_bf16 v[44:47], a[44:47], v[100:103], v[44:47]
    ds_read_b64_tr_b16 a[18:19], v7 offset:34816
    v_mfma_f32_16x16x32_bf16 v[16:19], a[48:51], v[104:107], v[16:19]
    ds_read_b64_tr_b16 a[20:21], v7 offset:34336
    ds_read_b64_tr_b16 a[22:23], v7 offset:34848
    buffer_load_dwordx4 v6, s[32:35], s25 offen offset:1024 lds
    s_add_u32 s25, s25, 0x20000
    v_mfma_f32_16x16x32_bf16 v[32:35], a[48:51], v[108:111], v[32:35]
    ds_read_b64_tr_b16 a[24:25], v7 offset:34368
    v_mfma_f32_16x16x32_bf16 v[20:23], a[52:55], v[104:107], v[20:23]
    ds_read_b64_tr_b16 a[26:27], v7 offset:34880
    buffer_load_dwordx4 v[88:91], v4, s[28:31], s24 offen offset:0
    v_mfma_f32_16x16x32_bf16 v[36:39], a[52:55], v[108:111], v[36:39]
    ds_read_b64_tr_b16 a[28:29], v7 offset:34400
    v_mfma_f32_16x16x32_bf16 v[24:27], a[56:59], v[104:107], v[24:27]
    ds_read_b64_tr_b16 a[30:31], v7 offset:34912
    v_mfma_f32_16x16x32_bf16 v[40:43], a[56:59], v[108:111], v[40:43]
    buffer_load_dwordx4 v[92:95], v4, s[28:31], s24 offen offset:1024
    s_add_u32 s24, s24, 0x40000
    v_mfma_f32_16x16x32_bf16 v[28:31], a[60:63], v[104:107], v[28:31]
    v_mfma_f32_16x16x32_bf16 v[44:47], a[60:63], v[108:111], v[44:47]
    s_waitcnt lgkmcnt(0)
    s_waitcnt vmcnt(36)
    s_barrier
    v_mfma_f32_16x16x32_bf16 v[16:19], a[0:3], v[112:115], v[16:19]
    ds_read_b64_tr_b16 a[32:33], v7 offset:41600
    ds_read_b64_tr_b16 a[34:35], v7 offset:42112
    s_add_u32 m0, s22, 33280
    s_nop 0
    buffer_load_dwordx4 v5, s[32:35], s25 offen lds
    v_mfma_f32_16x16x32_bf16 v[32:35], a[0:3], v[116:119], v[32:35]
    ds_read_b64_tr_b16 a[36:37], v7 offset:41632
    v_mfma_f32_16x16x32_bf16 v[20:23], a[4:7], v[112:115], v[20:23]
    ds_read_b64_tr_b16 a[38:39], v7 offset:42144
    buffer_load_dwordx4 v[96:99], v4, s[28:31], s23 offen offset:0
    v_mfma_f32_16x16x32_bf16 v[36:39], a[4:7], v[116:119], v[36:39]
    ds_read_b64_tr_b16 a[40:41], v7 offset:41664
    v_mfma_f32_16x16x32_bf16 v[24:27], a[8:11], v[112:115], v[24:27]
    ds_read_b64_tr_b16 a[42:43], v7 offset:42176
    ds_read_b64_tr_b16 a[44:45], v7 offset:41696
    v_mfma_f32_16x16x32_bf16 v[40:43], a[8:11], v[116:119], v[40:43]
    ds_read_b64_tr_b16 a[46:47], v7 offset:42208
    buffer_load_dwordx4 v[100:103], v4, s[28:31], s23 offen offset:1024
    s_add_u32 s23, s23, 0x40000
    v_mfma_f32_16x16x32_bf16 v[28:31], a[12:15], v[112:115], v[28:31]
    ds_read_b64_tr_b16 a[48:49], v7 offset:42624
    v_mfma_f32_16x16x32_bf16 v[44:47], a[12:15], v[116:119], v[44:47]
    ds_read_b64_tr_b16 a[50:51], v7 offset:43136
    v_mfma_f32_16x16x32_bf16 v[16:19], a[16:19], v[120:123], v[16:19]
    ds_read_b64_tr_b16 a[52:53], v7 offset:42656
    ds_read_b64_tr_b16 a[54:55], v7 offset:43168
    buffer_load_dwordx4 v6, s[32:35], s25 offen offset:1024 lds
    s_add_u32 s25, s25, 0x20000
    v_mfma_f32_16x16x32_bf16 v[32:35], a[16:19], v[124:127], v[32:35]
    ds_read_b64_tr_b16 a[56:57], v7 offset:42688
    v_mfma_f32_16x16x32_bf16 v[20:23], a[20:23], v[120:123], v[20:23]
    ds_read_b64_tr_b16 a[58:59], v7 offset:43200
    buffer_load_dwordx4 v[104:107], v4, s[28:31], s24 offen offset:0
    v_mfma_f32_16x16x32_bf16 v[36:39], a[20:23], v[124:127], v[36:39]
    ds_read_b64_tr_b16 a[60:61], v7 offset:42720
    v_mfma_f32_16x16x32_bf16 v[24:27], a[24:27], v[120:123], v[24:27]
    ds_read_b64_tr_b16 a[62:63], v7 offset:43232
    v_mfma_f32_16x16x32_bf16 v[40:43], a[24:27], v[124:127], v[40:43]
    buffer_load_dwordx4 v[108:111], v4, s[28:31], s24 offen offset:1024
    s_add_u32 s24, s24, 0x40000
    v_mfma_f32_16x16x32_bf16 v[28:31], a[28:31], v[120:123], v[28:31]
    v_mfma_f32_16x16x32_bf16 v[44:47], a[28:31], v[124:127], v[44:47]
    s_waitcnt lgkmcnt(0)
    s_waitcnt vmcnt(36)
    s_barrier
    v_mfma_f32_16x16x32_bf16 v[16:19], a[32:35], v[128:131], v[16:19]
    ds_read_b64_tr_b16 a[0:1], v7 offset:49920
    ds_read_b64_tr_b16 a[2:3], v7 offset:50432
    s_add_u32 m0, s22, 41600
    s_nop 0
    buffer_load_dwordx4 v5, s[32:35], s25 offen lds
    v_mfma_f32_16x16x32_bf16 v[32:35], a[32:35], v[132:135], v[32:35]
    ds_read_b64_tr_b16 a[4:5], v7 offset:49952
    v_mfma_f32_16x16x32_bf16 v[20:23], a[36:39], v[128:131], v[20:23]
    ds_read_b64_tr_b16 a[6:7], v7 offset:50464
    buffer_load_dwordx4 v[112:115], v4, s[28:31], s23 offen offset:0
    v_mfma_f32_16x16x32_bf16 v[36:39], a[36:39], v[132:135], v[36:39]
    ds_read_b64_tr_b16 a[8:9], v7 offset:49984
    v_mfma_f32_16x16x32_bf16 v[24:27], a[40:43], v[128:131], v[24:27]
    ds_read_b64_tr_b16 a[10:11], v7 offset:50496
    ds_read_b64_tr_b16 a[12:13], v7 offset:50016
    v_mfma_f32_16x16x32_bf16 v[40:43], a[40:43], v[132:135], v[40:43]
    ds_read_b64_tr_b16 a[14:15], v7 offset:50528
    buffer_load_dwordx4 v[116:119], v4, s[28:31], s23 offen offset:1024
    s_add_u32 s23, s23, 0x40000
    v_mfma_f32_16x16x32_bf16 v[28:31], a[44:47], v[128:131], v[28:31]
    ds_read_b64_tr_b16 a[16:17], v7 offset:50944
    v_mfma_f32_16x16x32_bf16 v[44:47], a[44:47], v[132:135], v[44:47]
    ds_read_b64_tr_b16 a[18:19], v7 offset:51456
    v_mfma_f32_16x16x32_bf16 v[16:19], a[48:51], v[136:139], v[16:19]
    ds_read_b64_tr_b16 a[20:21], v7 offset:50976
    ds_read_b64_tr_b16 a[22:23], v7 offset:51488
    buffer_load_dwordx4 v6, s[32:35], s25 offen offset:1024 lds
    s_add_u32 s25, s25, 0x20000
    v_mfma_f32_16x16x32_bf16 v[32:35], a[48:51], v[140:143], v[32:35]
    ds_read_b64_tr_b16 a[24:25], v7 offset:51008
    v_mfma_f32_16x16x32_bf16 v[20:23], a[52:55], v[136:139], v[20:23]
    ds_read_b64_tr_b16 a[26:27], v7 offset:51520
    buffer_load_dwordx4 v[120:123], v4, s[28:31], s24 offen offset:0
    v_mfma_f32_16x16x32_bf16 v[36:39], a[52:55], v[140:143], v[36:39]
    ds_read_b64_tr_b16 a[28:29], v7 offset:51040
    v_mfma_f32_16x16x32_bf16 v[24:27], a[56:59], v[136:139], v[24:27]
    ds_read_b64_tr_b16 a[30:31], v7 offset:51552
    v_mfma_f32_16x16x32_bf16 v[40:43], a[56:59], v[140:143], v[40:43]
    buffer_load_dwordx4 v[124:127], v4, s[28:31], s24 offen offset:1024
    s_add_u32 s24, s24, 0x40000
    v_mfma_f32_16x16x32_bf16 v[28:31], a[60:63], v[136:139], v[28:31]
    v_mfma_f32_16x16x32_bf16 v[44:47], a[60:63], v[140:143], v[44:47]
    s_waitcnt lgkmcnt(0)
    s_waitcnt vmcnt(36)
    s_barrier
    v_mfma_f32_16x16x32_bf16 v[16:19], a[0:3], v[144:147], v[16:19]
    ds_read_b64_tr_b16 a[32:33], v7 offset:58240
    ds_read_b64_tr_b16 a[34:35], v7 offset:58752
    s_add_u32 m0, s22, 49920
    s_nop 0
    buffer_load_dwordx4 v5, s[32:35], s25 offen lds
    v_mfma_f32_16x16x32_bf16 v[32:35], a[0:3], v[148:151], v[32:35]
    ds_read_b64_tr_b16 a[36:37], v7 offset:58272
    v_mfma_f32_16x16x32_bf16 v[20:23], a[4:7], v[144:147], v[20:23]
    ds_read_b64_tr_b16 a[38:39], v7 offset:58784
    buffer_load_dwordx4 v[128:131], v4, s[28:31], s23 offen offset:0
    v_mfma_f32_16x16x32_bf16 v[36:39], a[4:7], v[148:151], v[36:39]
    ds_read_b64_tr_b16 a[40:41], v7 offset:58304
    v_mfma_f32_16x16x32_bf16 v[24:27], a[8:11], v[144:147], v[24:27]
    ds_read_b64_tr_b16 a[42:43], v7 offset:58816
    ds_read_b64_tr_b16 a[44:45], v7 offset:58336
    v_mfma_f32_16x16x32_bf16 v[40:43], a[8:11], v[148:151], v[40:43]
    ds_read_b64_tr_b16 a[46:47], v7 offset:58848
    buffer_load_dwordx4 v[132:135], v4, s[28:31], s23 offen offset:1024
    s_add_u32 s23, s23, 0x40000
    v_mfma_f32_16x16x32_bf16 v[28:31], a[12:15], v[144:147], v[28:31]
    ds_read_b64_tr_b16 a[48:49], v7 offset:59264
    v_mfma_f32_16x16x32_bf16 v[44:47], a[12:15], v[148:151], v[44:47]
    ds_read_b64_tr_b16 a[50:51], v7 offset:59776
    v_mfma_f32_16x16x32_bf16 v[16:19], a[16:19], v[152:155], v[16:19]
    ds_read_b64_tr_b16 a[52:53], v7 offset:59296
    ds_read_b64_tr_b16 a[54:55], v7 offset:59808
    buffer_load_dwordx4 v6, s[32:35], s25 offen offset:1024 lds
    s_add_u32 s25, s25, 0x20000
    v_mfma_f32_16x16x32_bf16 v[32:35], a[16:19], v[156:159], v[32:35]
    ds_read_b64_tr_b16 a[56:57], v7 offset:59328
    v_mfma_f32_16x16x32_bf16 v[20:23], a[20:23], v[152:155], v[20:23]
    ds_read_b64_tr_b16 a[58:59], v7 offset:59840
    buffer_load_dwordx4 v[136:139], v4, s[28:31], s24 offen offset:0
    v_mfma_f32_16x16x32_bf16 v[36:39], a[20:23], v[156:159], v[36:39]
    ds_read_b64_tr_b16 a[60:61], v7 offset:59360
    v_mfma_f32_16x16x32_bf16 v[24:27], a[24:27], v[152:155], v[24:27]
    ds_read_b64_tr_b16 a[62:63], v7 offset:59872
    v_mfma_f32_16x16x32_bf16 v[40:43], a[24:27], v[156:159], v[40:43]
    buffer_load_dwordx4 v[140:143], v4, s[28:31], s24 offen offset:1024
    s_add_u32 s24, s24, 0x40000
    v_mfma_f32_16x16x32_bf16 v[28:31], a[28:31], v[152:155], v[28:31]
    v_mfma_f32_16x16x32_bf16 v[44:47], a[28:31], v[156:159], v[44:47]
    s_waitcnt lgkmcnt(0)
    s_waitcnt vmcnt(38)
    s_barrier
    v_mfma_f32_16x16x32_bf16 v[16:19], a[32:35], v[160:163], v[16:19]
    ds_read_b64_tr_b16 a[0:1], v7 offset:0
    ds_read_b64_tr_b16 a[2:3], v7 offset:512
    s_add_u32 m0, s22, 58240
    s_nop 0
    buffer_load_dwordx4 v5, s[32:35], s25 offen lds
    v_mfma_f32_16x16x32_bf16 v[32:35], a[32:35], v[164:167], v[32:35]
    ds_read_b64_tr_b16 a[4:5], v7 offset:32
    v_mfma_f32_16x16x32_bf16 v[20:23], a[36:39], v[160:163], v[20:23]
    ds_read_b64_tr_b16 a[6:7], v7 offset:544
    buffer_load_dwordx4 v[144:147], v4, s[28:31], s23 offen offset:0
    v_mfma_f32_16x16x32_bf16 v[36:39], a[36:39], v[164:167], v[36:39]
    ds_read_b64_tr_b16 a[8:9], v7 offset:64
    v_mfma_f32_16x16x32_bf16 v[24:27], a[40:43], v[160:163], v[24:27]
    ds_read_b64_tr_b16 a[10:11], v7 offset:576
    ds_read_b64_tr_b16 a[12:13], v7 offset:96
    v_mfma_f32_16x16x32_bf16 v[40:43], a[40:43], v[164:167], v[40:43]
    ds_read_b64_tr_b16 a[14:15], v7 offset:608
    buffer_load_dwordx4 v[148:151], v4, s[28:31], s23 offen offset:1024
    s_add_u32 s23, s23, 0x40000
    v_mfma_f32_16x16x32_bf16 v[28:31], a[44:47], v[160:163], v[28:31]
    ds_read_b64_tr_b16 a[16:17], v7 offset:1024
    v_mfma_f32_16x16x32_bf16 v[44:47], a[44:47], v[164:167], v[44:47]
    ds_read_b64_tr_b16 a[18:19], v7 offset:1536
    s_waitcnt vmcnt(40)
    v_mfma_f32_16x16x32_bf16 v[16:19], a[48:51], v[168:171], v[16:19]
    ds_read_b64_tr_b16 a[20:21], v7 offset:1056
    ds_read_b64_tr_b16 a[22:23], v7 offset:1568
    buffer_load_dwordx4 v6, s[32:35], s25 offen offset:1024 lds
    s_add_u32 s25, s25, 0x20000
    s_waitcnt vmcnt(40)
    v_mfma_f32_16x16x32_bf16 v[32:35], a[48:51], v[172:175], v[32:35]
    ds_read_b64_tr_b16 a[24:25], v7 offset:1088
    v_mfma_f32_16x16x32_bf16 v[20:23], a[52:55], v[168:171], v[20:23]
    ds_read_b64_tr_b16 a[26:27], v7 offset:1600
    buffer_load_dwordx4 v[152:155], v4, s[28:31], s24 offen offset:0
    v_mfma_f32_16x16x32_bf16 v[36:39], a[52:55], v[172:175], v[36:39]
    ds_read_b64_tr_b16 a[28:29], v7 offset:1120
    v_mfma_f32_16x16x32_bf16 v[24:27], a[56:59], v[168:171], v[24:27]
    ds_read_b64_tr_b16 a[30:31], v7 offset:1632
    v_mfma_f32_16x16x32_bf16 v[40:43], a[56:59], v[172:175], v[40:43]
    buffer_load_dwordx4 v[156:159], v4, s[28:31], s24 offen offset:1024
    s_add_u32 s24, s24, 0x40000
    v_mfma_f32_16x16x32_bf16 v[28:31], a[60:63], v[168:171], v[28:31]
    v_mfma_f32_16x16x32_bf16 v[44:47], a[60:63], v[172:175], v[44:47]
    s_sub_u32 s48, s48, 1
    s_cmp_lg_u32 s48, 0
    s_cbranch_scc1 dn2_kernel_loop
    s_waitcnt lgkmcnt(0)
    s_waitcnt vmcnt(38)
    s_barrier
    v_mfma_f32_16x16x32_bf16 v[16:19], a[0:3], v[48:51], v[16:19]
    ds_read_b64_tr_b16 a[32:33], v7 offset:8320
    ds_read_b64_tr_b16 a[34:35], v7 offset:8832
    buffer_load_dwordx4 v[160:163], v4, s[28:31], s23 offen offset:0
    v_mfma_f32_16x16x32_bf16 v[32:35], a[0:3], v[52:55], v[32:35]
    ds_read_b64_tr_b16 a[36:37], v7 offset:8352
    v_mfma_f32_16x16x32_bf16 v[20:23], a[4:7], v[48:51], v[20:23]
    ds_read_b64_tr_b16 a[38:39], v7 offset:8864
    v_mfma_f32_16x16x32_bf16 v[36:39], a[4:7], v[52:55], v[36:39]
    ds_read_b64_tr_b16 a[40:41], v7 offset:8384
    v_mfma_f32_16x16x32_bf16 v[24:27], a[8:11], v[48:51], v[24:27]
    ds_read_b64_tr_b16 a[42:43], v7 offset:8896
    ds_read_b64_tr_b16 a[44:45], v7 offset:8416
    buffer_load_dwordx4 v[164:167], v4, s[28:31], s23 offen offset:1024
    s_add_u32 s23, s23, 0x40000
    v_mfma_f32_16x16x32_bf16 v[40:43], a[8:11], v[52:55], v[40:43]
    ds_read_b64_tr_b16 a[46:47], v7 offset:8928
    v_mfma_f32_16x16x32_bf16 v[28:31], a[12:15], v[48:51], v[28:31]
    ds_read_b64_tr_b16 a[48:49], v7 offset:9344
    v_mfma_f32_16x16x32_bf16 v[44:47], a[12:15], v[52:55], v[44:47]
    ds_read_b64_tr_b16 a[50:51], v7 offset:9856
    s_waitcnt vmcnt(39)
    v_mfma_f32_16x16x32_bf16 v[16:19], a[16:19], v[56:59], v[16:19]
    ds_read_b64_tr_b16 a[52:53], v7 offset:9376
    ds_read_b64_tr_b16 a[54:55], v7 offset:9888
    buffer_load_dwordx4 v[168:171], v4, s[28:31], s24 offen offset:0
    s_waitcnt vmcnt(39)
    v_mfma_f32_16x16x32_bf16 v[32:35], a[16:19], v[60:63], v[32:35]
    ds_read_b64_tr_b16 a[56:57], v7 offset:9408
    v_mfma_f32_16x16x32_bf16 v[20:23], a[20:23], v[56:59], v[20:23]
    ds_read_b64_tr_b16 a[58:59], v7 offset:9920
    v_mfma_f32_16x16x32_bf16 v[36:39], a[20:23], v[60:63], v[36:39]
    ds_read_b64_tr_b16 a[60:61], v7 offset:9440
    v_mfma_f32_16x16x32_bf16 v[24:27], a[24:27], v[56:59], v[24:27]
    ds_read_b64_tr_b16 a[62:63], v7 offset:9952
    buffer_load_dwordx4 v[172:175], v4, s[28:31], s24 offen offset:1024
    s_add_u32 s24, s24, 0x40000
    v_mfma_f32_16x16x32_bf16 v[40:43], a[24:27], v[60:63], v[40:43]
    v_mfma_f32_16x16x32_bf16 v[28:31], a[28:31], v[56:59], v[28:31]
    v_mfma_f32_16x16x32_bf16 v[44:47], a[28:31], v[60:63], v[44:47]
    s_waitcnt lgkmcnt(0)
    s_waitcnt vmcnt(36)
    s_barrier
    v_mfma_f32_16x16x32_bf16 v[16:19], a[32:35], v[64:67], v[16:19]
    ds_read_b64_tr_b16 a[0:1], v7 offset:16640
    ds_read_b64_tr_b16 a[2:3], v7 offset:17152
    buffer_load_dwordx4 v[176:179], v4, s[36:39], s26 offen offset:0
    v_mfma_f32_16x16x32_bf16 v[32:35], a[32:35], v[68:71], v[32:35]
    ds_read_b64_tr_b16 a[4:5], v7 offset:16672
    v_mfma_f32_16x16x32_bf16 v[20:23], a[36:39], v[64:67], v[20:23]
    ds_read_b64_tr_b16 a[6:7], v7 offset:17184
    v_mfma_f32_16x16x32_bf16 v[36:39], a[36:39], v[68:71], v[36:39]
    ds_read_b64_tr_b16 a[8:9], v7 offset:16704
    v_mfma_f32_16x16x32_bf16 v[24:27], a[40:43], v[64:67], v[24:27]
    ds_read_b64_tr_b16 a[10:11], v7 offset:17216
    ds_read_b64_tr_b16 a[12:13], v7 offset:16736
    buffer_load_dwordx4 v[180:183], v4, s[36:39], s27 offen offset:0
    v_mfma_f32_16x16x32_bf16 v[40:43], a[40:43], v[68:71], v[40:43]
    ds_read_b64_tr_b16 a[14:15], v7 offset:17248
    v_mfma_f32_16x16x32_bf16 v[28:31], a[44:47], v[64:67], v[28:31]
    ds_read_b64_tr_b16 a[16:17], v7 offset:17664
    v_mfma_f32_16x16x32_bf16 v[44:47], a[44:47], v[68:71], v[44:47]
    ds_read_b64_tr_b16 a[18:19], v7 offset:18176
    s_waitcnt vmcnt(37)
    v_mfma_f32_16x16x32_bf16 v[16:19], a[48:51], v[72:75], v[16:19]
    ds_read_b64_tr_b16 a[20:21], v7 offset:17696
    ds_read_b64_tr_b16 a[22:23], v7 offset:18208
    buffer_load_dwordx4 v[184:187], v4, s[36:39], s26 offen offset:1024
    s_waitcnt vmcnt(37)
    v_mfma_f32_16x16x32_bf16 v[32:35], a[48:51], v[76:79], v[32:35]
    ds_read_b64_tr_b16 a[24:25], v7 offset:17728
    v_mfma_f32_16x16x32_bf16 v[20:23], a[52:55], v[72:75], v[20:23]
    ds_read_b64_tr_b16 a[26:27], v7 offset:18240
    v_mfma_f32_16x16x32_bf16 v[36:39], a[52:55], v[76:79], v[36:39]
    ds_read_b64_tr_b16 a[28:29], v7 offset:17760
    v_mfma_f32_16x16x32_bf16 v[24:27], a[56:59], v[72:75], v[24:27]
    ds_read_b64_tr_b16 a[30:31], v7 offset:18272
    buffer_load_dwordx4 v[188:191], v4, s[36:39], s27 offen offset:1024
    v_mfma_f32_16x16x32_bf16 v[40:43], a[56:59], v[76:79], v[40:43]
    v_mfma_f32_16x16x32_bf16 v[28:31], a[60:63], v[72:75], v[28:31]
    v_mfma_f32_16x16x32_bf16 v[44:47], a[60:63], v[76:79], v[44:47]
    s_waitcnt lgkmcnt(0)
    s_waitcnt vmcnt(34)
    s_barrier
    v_mfma_f32_16x16x32_bf16 v[16:19], a[0:3], v[80:83], v[16:19]
    ds_read_b64_tr_b16 a[32:33], v7 offset:24960
    ds_read_b64_tr_b16 a[34:35], v7 offset:25472
    v_mfma_f32_16x16x32_bf16 v[32:35], a[0:3], v[84:87], v[32:35]
    ds_read_b64_tr_b16 a[36:37], v7 offset:24992
    v_mfma_f32_16x16x32_bf16 v[20:23], a[4:7], v[80:83], v[20:23]
    ds_read_b64_tr_b16 a[38:39], v7 offset:25504
    v_mfma_f32_16x16x32_bf16 v[36:39], a[4:7], v[84:87], v[36:39]
    ds_read_b64_tr_b16 a[40:41], v7 offset:25024
    v_mfma_f32_16x16x32_bf16 v[24:27], a[8:11], v[80:83], v[24:27]
    ds_read_b64_tr_b16 a[42:43], v7 offset:25536
    ds_read_b64_tr_b16 a[44:45], v7 offset:25056
    v_mfma_f32_16x16x32_bf16 v[40:43], a[8:11], v[84:87], v[40:43]
    ds_read_b64_tr_b16 a[46:47], v7 offset:25568
    v_mfma_f32_16x16x32_bf16 v[28:31], a[12:15], v[80:83], v[28:31]
    ds_read_b64_tr_b16 a[48:49], v7 offset:25984
    v_mfma_f32_16x16x32_bf16 v[44:47], a[12:15], v[84:87], v[44:47]
    ds_read_b64_tr_b16 a[50:51], v7 offset:26496
    s_waitcnt vmcnt(33)
    v_mfma_f32_16x16x32_bf16 v[16:19], a[16:19], v[88:91], v[16:19]
    ds_read_b64_tr_b16 a[52:53], v7 offset:26016
    ds_read_b64_tr_b16 a[54:55], v7 offset:26528
    s_waitcnt vmcnt(32)
    v_mfma_f32_16x16x32_bf16 v[32:35], a[16:19], v[92:95], v[32:35]
    ds_read_b64_tr_b16 a[56:57], v7 offset:26048
    v_mfma_f32_16x16x32_bf16 v[20:23], a[20:23], v[88:91], v[20:23]
    ds_read_b64_tr_b16 a[58:59], v7 offset:26560
    v_mfma_f32_16x16x32_bf16 v[36:39], a[20:23], v[92:95], v[36:39]
    ds_read_b64_tr_b16 a[60:61], v7 offset:26080
    v_mfma_f32_16x16x32_bf16 v[24:27], a[24:27], v[88:91], v[24:27]
    ds_read_b64_tr_b16 a[62:63], v7 offset:26592
    v_mfma_f32_16x16x32_bf16 v[40:43], a[24:27], v[92:95], v[40:43]
    v_mfma_f32_16x16x32_bf16 v[28:31], a[28:31], v[88:91], v[28:31]
    v_mfma_f32_16x16x32_bf16 v[44:47], a[28:31], v[92:95], v[44:47]
    s_waitcnt lgkmcnt(0)
    s_waitcnt vmcnt(28)
    s_barrier
    v_mfma_f32_16x16x32_bf16 v[16:19], a[32:35], v[96:99], v[16:19]
    ds_read_b64_tr_b16 a[0:1], v7 offset:33280
    ds_read_b64_tr_b16 a[2:3], v7 offset:33792
    v_mfma_f32_16x16x32_bf16 v[32:35], a[32:35], v[100:103], v[32:35]
    ds_read_b64_tr_b16 a[4:5], v7 offset:33312
    v_mfma_f32_16x16x32_bf16 v[20:23], a[36:39], v[96:99], v[20:23]
    ds_read_b64_tr_b16 a[6:7], v7 offset:33824
    v_mfma_f32_16x16x32_bf16 v[36:39], a[36:39], v[100:103], v[36:39]
    ds_read_b64_tr_b16 a[8:9], v7 offset:33344
    v_mfma_f32_16x16x32_bf16 v[24:27], a[40:43], v[96:99], v[24:27]
    ds_read_b64_tr_b16 a[10:11], v7 offset:33856
    ds_read_b64_tr_b16 a[12:13], v7 offset:33376
    v_mfma_f32_16x16x32_bf16 v[40:43], a[40:43], v[100:103], v[40:43]
    ds_read_b64_tr_b16 a[14:15], v7 offset:33888
    v_mfma_f32_16x16x32_bf16 v[28:31], a[44:47], v[96:99], v[28:31]
    ds_read_b64_tr_b16 a[16:17], v7 offset:34304
    v_mfma_f32_16x16x32_bf16 v[44:47], a[44:47], v[100:103], v[44:47]
    ds_read_b64_tr_b16 a[18:19], v7 offset:34816
    s_waitcnt vmcnt(27)
    v_mfma_f32_16x16x32_bf16 v[16:19], a[48:51], v[104:107], v[16:19]
    ds_read_b64_tr_b16 a[20:21], v7 offset:34336
    ds_read_b64_tr_b16 a[22:23], v7 offset:34848
    s_waitcnt vmcnt(26)
    v_mfma_f32_16x16x32_bf16 v[32:35], a[48:51], v[108:111], v[32:35]
    ds_read_b64_tr_b16 a[24:25], v7 offset:34368
    v_mfma_f32_16x16x32_bf16 v[20:23], a[52:55], v[104:107], v[20:23]
    ds_read_b64_tr_b16 a[26:27], v7 offset:34880
    v_mfma_f32_16x16x32_bf16 v[36:39], a[52:55], v[108:111], v[36:39]
    ds_read_b64_tr_b16 a[28:29], v7 offset:34400
    v_mfma_f32_16x16x32_bf16 v[24:27], a[56:59], v[104:107], v[24:27]
    ds_read_b64_tr_b16 a[30:31], v7 offset:34912
    v_mfma_f32_16x16x32_bf16 v[40:43], a[56:59], v[108:111], v[40:43]
    v_mfma_f32_16x16x32_bf16 v[28:31], a[60:63], v[104:107], v[28:31]
    v_mfma_f32_16x16x32_bf16 v[44:47], a[60:63], v[108:111], v[44:47]
    s_waitcnt lgkmcnt(0)
    s_waitcnt vmcnt(22)
    s_barrier
    v_mfma_f32_16x16x32_bf16 v[16:19], a[0:3], v[112:115], v[16:19]
    ds_read_b64_tr_b16 a[32:33], v7 offset:41600
    ds_read_b64_tr_b16 a[34:35], v7 offset:42112
    v_mfma_f32_16x16x32_bf16 v[32:35], a[0:3], v[116:119], v[32:35]
    ds_read_b64_tr_b16 a[36:37], v7 offset:41632
    v_mfma_f32_16x16x32_bf16 v[20:23], a[4:7], v[112:115], v[20:23]
    ds_read_b64_tr_b16 a[38:39], v7 offset:42144
    v_mfma_f32_16x16x32_bf16 v[36:39], a[4:7], v[116:119], v[36:39]
    ds_read_b64_tr_b16 a[40:41], v7 offset:41664
    v_mfma_f32_16x16x32_bf16 v[24:27], a[8:11], v[112:115], v[24:27]
    ds_read_b64_tr_b16 a[42:43], v7 offset:42176
    ds_read_b64_tr_b16 a[44:45], v7 offset:41696
    v_mfma_f32_16x16x32_bf16 v[40:43], a[8:11], v[116:119], v[40:43]
    ds_read_b64_tr_b16 a[46:47], v7 offset:42208
    v_mfma_f32_16x16x32_bf16 v[28:31], a[12:15], v[112:115], v[28:31]
    ds_read_b64_tr_b16 a[48:49], v7 offset:42624
    v_mfma_f32_16x16x32_bf16 v[44:47], a[12:15], v[116:119], v[44:47]
    ds_read_b64_tr_b16 a[50:51], v7 offset:43136
    s_waitcnt vmcnt(21)
    v_mfma_f32_16x16x32_bf16 v[16:19], a[16:19], v[120:123], v[16:19]
    ds_read_b64_tr_b16 a[52:53], v7 offset:42656
    ds_read_b64_tr_b16 a[54:55], v7 offset:43168
    s_waitcnt vmcnt(20)
    v_mfma_f32_16x16x32_bf16 v[32:35], a[16:19], v[124:127], v[32:35]
    ds_read_b64_tr_b16 a[56:57], v7 offset:42688
    v_mfma_f32_16x16x32_bf16 v[20:23], a[20:23], v[120:123], v[20:23]
    ds_read_b64_tr_b16 a[58:59], v7 offset:43200
    v_mfma_f32_16x16x32_bf16 v[36:39], a[20:23], v[124:127], v[36:39]
    ds_read_b64_tr_b16 a[60:61], v7 offset:42720
    v_mfma_f32_16x16x32_bf16 v[24:27], a[24:27], v[120:123], v[24:27]
    ds_read_b64_tr_b16 a[62:63], v7 offset:43232
    v_mfma_f32_16x16x32_bf16 v[40:43], a[24:27], v[124:127], v[40:43]
    v_mfma_f32_16x16x32_bf16 v[28:31], a[28:31], v[120:123], v[28:31]
    v_mfma_f32_16x16x32_bf16 v[44:47], a[28:31], v[124:127], v[44:47]
    s_waitcnt lgkmcnt(0)
    s_waitcnt vmcnt(16)
    s_barrier
    v_mfma_f32_16x16x32_bf16 v[16:19], a[32:35], v[128:131], v[16:19]
    ds_read_b64_tr_b16 a[0:1], v7 offset:49920
    ds_read_b64_tr_b16 a[2:3], v7 offset:50432
    v_mfma_f32_16x16x32_bf16 v[32:35], a[32:35], v[132:135], v[32:35]
    ds_read_b64_tr_b16 a[4:5], v7 offset:49952
    v_mfma_f32_16x16x32_bf16 v[20:23], a[36:39], v[128:131], v[20:23]
    ds_read_b64_tr_b16 a[6:7], v7 offset:50464
    v_mfma_f32_16x16x32_bf16 v[36:39], a[36:39], v[132:135], v[36:39]
    ds_read_b64_tr_b16 a[8:9], v7 offset:49984
    v_mfma_f32_16x16x32_bf16 v[24:27], a[40:43], v[128:131], v[24:27]
    ds_read_b64_tr_b16 a[10:11], v7 offset:50496
    ds_read_b64_tr_b16 a[12:13], v7 offset:50016
    v_mfma_f32_16x16x32_bf16 v[40:43], a[40:43], v[132:135], v[40:43]
    ds_read_b64_tr_b16 a[14:15], v7 offset:50528
    v_mfma_f32_16x16x32_bf16 v[28:31], a[44:47], v[128:131], v[28:31]
    ds_read_b64_tr_b16 a[16:17], v7 offset:50944
    v_mfma_f32_16x16x32_bf16 v[44:47], a[44:47], v[132:135], v[44:47]
    ds_read_b64_tr_b16 a[18:19], v7 offset:51456
    s_waitcnt vmcnt(15)
    v_mfma_f32_16x16x32_bf16 v[16:19], a[48:51], v[136:139], v[16:19]
    ds_read_b64_tr_b16 a[20:21], v7 offset:50976
    ds_read_b64_tr_b16 a[22:23], v7 offset:51488
    s_waitcnt vmcnt(14)
    v_mfma_f32_16x16x32_bf16 v[32:35], a[48:51], v[140:143], v[32:35]
    ds_read_b64_tr_b16 a[24:25], v7 offset:51008
    v_mfma_f32_16x16x32_bf16 v[20:23], a[52:55], v[136:139], v[20:23]
    ds_read_b64_tr_b16 a[26:27], v7 offset:51520
    v_mfma_f32_16x16x32_bf16 v[36:39], a[52:55], v[140:143], v[36:39]
    ds_read_b64_tr_b16 a[28:29], v7 offset:51040
    v_mfma_f32_16x16x32_bf16 v[24:27], a[56:59], v[136:139], v[24:27]
    ds_read_b64_tr_b16 a[30:31], v7 offset:51552
    v_mfma_f32_16x16x32_bf16 v[40:43], a[56:59], v[140:143], v[40:43]
    v_mfma_f32_16x16x32_bf16 v[28:31], a[60:63], v[136:139], v[28:31]
    v_mfma_f32_16x16x32_bf16 v[44:47], a[60:63], v[140:143], v[44:47]
    s_waitcnt lgkmcnt(0)
    s_waitcnt vmcnt(10)
    s_barrier
    v_mfma_f32_16x16x32_bf16 v[16:19], a[0:3], v[144:147], v[16:19]
    ds_read_b64_tr_b16 a[32:33], v7 offset:58240
    ds_read_b64_tr_b16 a[34:35], v7 offset:58752
    v_mfma_f32_16x16x32_bf16 v[32:35], a[0:3], v[148:151], v[32:35]
    ds_read_b64_tr_b16 a[36:37], v7 offset:58272
    v_mfma_f32_16x16x32_bf16 v[20:23], a[4:7], v[144:147], v[20:23]
    ds_read_b64_tr_b16 a[38:39], v7 offset:58784
    v_mfma_f32_16x16x32_bf16 v[36:39], a[4:7], v[148:151], v[36:39]
    ds_read_b64_tr_b16 a[40:41], v7 offset:58304
    v_mfma_f32_16x16x32_bf16 v[24:27], a[8:11], v[144:147], v[24:27]
    ds_read_b64_tr_b16 a[42:43], v7 offset:58816
    ds_read_b64_tr_b16 a[44:45], v7 offset:58336
    v_mfma_f32_16x16x32_bf16 v[40:43], a[8:11], v[148:151], v[40:43]
    ds_read_b64_tr_b16 a[46:47], v7 offset:58848
    v_mfma_f32_16x16x32_bf16 v[28:31], a[12:15], v[144:147], v[28:31]
    ds_read_b64_tr_b16 a[48:49], v7 offset:59264
    v_mfma_f32_16x16x32_bf16 v[44:47], a[12:15], v[148:151], v[44:47]
    ds_read_b64_tr_b16 a[50:51], v7 offset:59776
    s_waitcnt vmcnt(9)
    v_mfma_f32_16x16x32_bf16 v[16:19], a[16:19], v[152:155], v[16:19]
    ds_read_b64_tr_b16 a[52:53], v7 offset:59296
    ds_read_b64_tr_b16 a[54:55], v7 offset:59808
    s_waitcnt vmcnt(8)
    v_mfma_f32_16x16x32_bf16 v[32:35], a[16:19], v[156:159], v[32:35]
    ds_read_b64_tr_b16 a[56:57], v7 offset:59328
    v_mfma_f32_16x16x32_bf16 v[20:23], a[20:23], v[152:155], v[20:23]
    ds_read_b64_tr_b16 a[58:59], v7 offset:59840
    v_mfma_f32_16x16x32_bf16 v[36:39], a[20:23], v[156:159], v[36:39]
    ds_read_b64_tr_b16 a[60:61], v7 offset:59360
    v_mfma_f32_16x16x32_bf16 v[24:27], a[24:27], v[152:155], v[24:27]
    ds_read_b64_tr_b16 a[62:63], v7 offset:59872
    v_mfma_f32_16x16x32_bf16 v[40:43], a[24:27], v[156:159], v[40:43]
    v_mfma_f32_16x16x32_bf16 v[28:31], a[28:31], v[152:155], v[28:31]
    v_mfma_f32_16x16x32_bf16 v[44:47], a[28:31], v[156:159], v[44:47]
    s_waitcnt lgkmcnt(0)
    s_waitcnt vmcnt(7)
    v_mfma_f32_16x16x32_bf16 v[16:19], a[32:35], v[160:163], v[16:19]
    s_waitcnt vmcnt(6)
    v_mfma_f32_16x16x32_bf16 v[32:35], a[32:35], v[164:167], v[32:35]
    v_mfma_f32_16x16x32_bf16 v[20:23], a[36:39], v[160:163], v[20:23]
    v_mfma_f32_16x16x32_bf16 v[36:39], a[36:39], v[164:167], v[36:39]
    v_mfma_f32_16x16x32_bf16 v[24:27], a[40:43], v[160:163], v[24:27]
    v_mfma_f32_16x16x32_bf16 v[40:43], a[40:43], v[164:167], v[40:43]
    v_mfma_f32_16x16x32_bf16 v[28:31], a[44:47], v[160:163], v[28:31]
    v_mfma_f32_16x16x32_bf16 v[44:47], a[44:47], v[164:167], v[44:47]
    s_waitcnt vmcnt(5)
    v_mfma_f32_16x16x32_bf16 v[16:19], a[48:51], v[168:171], v[16:19]
    s_waitcnt vmcnt(4)
    v_mfma_f32_16x16x32_bf16 v[32:35], a[48:51], v[172:175], v[32:35]
    v_mfma_f32_16x16x32_bf16 v[20:23], a[52:55], v[168:171], v[20:23]
    v_mfma_f32_16x16x32_bf16 v[36:39], a[52:55], v[172:175], v[36:39]
    v_mfma_f32_16x16x32_bf16 v[24:27], a[56:59], v[168:171], v[24:27]
    v_mfma_f32_16x16x32_bf16 v[40:43], a[56:59], v[172:175], v[40:43]
    v_mfma_f32_16x16x32_bf16 v[28:31], a[60:63], v[168:171], v[28:31]
    v_mfma_f32_16x16x32_bf16 v[44:47], a[60:63], v[172:175], v[44:47]
    s_waitcnt vmcnt(3)
    v_lshlrev_b32 v68, 16, v176
    v_and_b32 v69, 0xffff0000, v176
    v_pk_add_f32 v[16:17], v[16:17], v[68:69]
    v_cvt_pk_bf16_f32 v48, v16, v17
    v_lshlrev_b32 v70, 16, v177
    v_and_b32 v71, 0xffff0000, v177
    v_pk_add_f32 v[18:19], v[18:19], v[70:71]
    v_cvt_pk_bf16_f32 v49, v18, v19
    v_lshlrev_b32 v68, 16, v178
    v_and_b32 v69, 0xffff0000, v178
    v_pk_add_f32 v[20:21], v[20:21], v[68:69]
    v_cvt_pk_bf16_f32 v50, v20, v21
    v_lshlrev_b32 v70, 16, v179
    v_and_b32 v71, 0xffff0000, v179
    v_pk_add_f32 v[22:23], v[22:23], v[70:71]
    v_cvt_pk_bf16_f32 v51, v22, v23
    v_permlane16_swap_b32 v48, v50
    s_nop 0
    v_permlane16_swap_b32 v49, v51
    buffer_store_dwordx4 v[48:51], v10, s[40:43], 0 offen offset:0
    s_waitcnt vmcnt(3)
    v_lshlrev_b32 v68, 16, v180
    v_and_b32 v69, 0xffff0000, v180
    v_pk_add_f32 v[24:25], v[24:25], v[68:69]
    v_cvt_pk_bf16_f32 v52, v24, v25
    v_lshlrev_b32 v70, 16, v181
    v_and_b32 v71, 0xffff0000, v181
    v_pk_add_f32 v[26:27], v[26:27], v[70:71]
    v_cvt_pk_bf16_f32 v53, v26, v27
    v_lshlrev_b32 v68, 16, v182
    v_and_b32 v69, 0xffff0000, v182
    v_pk_add_f32 v[28:29], v[28:29], v[68:69]
    v_cvt_pk_bf16_f32 v54, v28, v29
    v_lshlrev_b32 v70, 16, v183
    v_and_b32 v71, 0xffff0000, v183
    v_pk_add_f32 v[30:31], v[30:31], v[70:71]
    v_cvt_pk_bf16_f32 v55, v30, v31
    v_permlane16_swap_b32 v52, v54
    s_nop 0
    v_permlane16_swap_b32 v53, v55
    buffer_store_dwordx4 v[52:55], v10, s[40:43], 0 offen offset:64
    s_waitcnt vmcnt(3)
    v_lshlrev_b32 v68, 16, v184
    v_and_b32 v69, 0xffff0000, v184
    v_pk_add_f32 v[32:33], v[32:33], v[68:69]
    v_cvt_pk_bf16_f32 v56, v32, v33
    v_lshlrev_b32 v70, 16, v185
    v_and_b32 v71, 0xffff0000, v185
    v_pk_add_f32 v[34:35], v[34:35], v[70:71]
    v_cvt_pk_bf16_f32 v57, v34, v35
    v_lshlrev_b32 v68, 16, v186
    v_and_b32 v69, 0xffff0000, v186
    v_pk_add_f32 v[36:37], v[36:37], v[68:69]
    v_cvt_pk_bf16_f32 v58, v36, v37
    v_lshlrev_b32 v70, 16, v187
    v_and_b32 v71, 0xffff0000, v187
    v_pk_add_f32 v[38:39], v[38:39], v[70:71]
    v_cvt_pk_bf16_f32 v59, v38, v39
    v_permlane16_swap_b32 v56, v58
    s_nop 0
    v_permlane16_swap_b32 v57, v59
    buffer_store_dwordx4 v[56:59], v11, s[40:43], 0 offen offset:0
    s_waitcnt vmcnt(3)
    v_lshlrev_b32 v68, 16, v188
    v_and_b32 v69, 0xffff0000, v188
    v_pk_add_f32 v[40:41], v[40:41], v[68:69]
    v_cvt_pk_bf16_f32 v60, v40, v41
    v_lshlrev_b32 v70, 16, v189
    v_and_b32 v71, 0xffff0000, v189
    v_pk_add_f32 v[42:43], v[42:43], v[70:71]
    v_cvt_pk_bf16_f32 v61, v42, v43
    v_lshlrev_b32 v68, 16, v190
    v_and_b32 v69, 0xffff0000, v190
    v_pk_add_f32 v[44:45], v[44:45], v[68:69]
    v_cvt_pk_bf16_f32 v62, v44, v45
    v_lshlrev_b32 v70, 16, v191
    v_and_b32 v71, 0xffff0000, v191
    v_pk_add_f32 v[46:47], v[46:47], v[70:71]
    v_cvt_pk_bf16_f32 v63, v46, v47
    v_permlane16_swap_b32 v60, v62
    s_nop 0
    v_permlane16_swap_b32 v61, v63
    buffer_store_dwordx4 v[60:63], v11, s[40:43], 0 offen offset:64
dn2_kernel_end:
    s_endpgm
.section .rodata,"a"
.p2align 6
.amdhsa_kernel pre_kernel
  .amdhsa_next_free_vgpr 192
  .amdhsa_next_free_sgpr 102
  .amdhsa_accum_offset 192
  .amdhsa_group_segment_fixed_size 0
  .amdhsa_kernarg_size 80
  .amdhsa_user_sgpr_count 2
  .amdhsa_user_sgpr_kernarg_segment_ptr 1
  .amdhsa_system_sgpr_workgroup_id_x 1
  .amdhsa_float_denorm_mode_32 3
.end_amdhsa_kernel
.section .rodata,"a"
.p2align 6
.amdhsa_kernel qkv1_kernel
  .amdhsa_next_free_vgpr 336
  .amdhsa_next_free_sgpr 102
  .amdhsa_accum_offset 248
  .amdhsa_group_segment_fixed_size 0
  .amdhsa_kernarg_size 80
  .amdhsa_user_sgpr_count 2
  .amdhsa_user_sgpr_kernarg_segment_ptr 1
  .amdhsa_system_sgpr_workgroup_id_x 1
  .amdhsa_float_denorm_mode_32 3
.end_amdhsa_kernel
.section .rodata,"a"
.p2align 6
.amdhsa_kernel wo1_kernel
  .amdhsa_next_free_vgpr 256
  .amdhsa_next_free_sgpr 102
  .amdhsa_accum_offset 192
  .amdhsa_group_segment_fixed_size 0
  .amdhsa_kernarg_size 80
  .amdhsa_user_sgpr_count 2
  .amdhsa_user_sgpr_kernarg_segment_ptr 1
  .amdhsa_system_sgpr_workgroup_id_x 1
  .amdhsa_float_denorm_mode_32 3
.end_amdhsa_kernel
.section .rodata,"a"
.p2align 6
.amdhsa_kernel gu1_kernel
  .amdhsa_next_free_vgpr 448
  .amdhsa_next_free_sgpr 102
  .amdhsa_accum_offset 256
  .amdhsa_group_segment_fixed_size 0
  .amdhsa_kernarg_size 80
  .amdhsa_user_sgpr_count 2
  .amdhsa_user_sgpr_kernarg_segment_ptr 1
  .amdhsa_system_sgpr_workgroup_id_x 1
  .amdhsa_float_denorm_mode_32 3
.end_amdhsa_kernel
.section .rodata,"a"
.p2align 6
.amdhsa_kernel dn1_kernel
  .amdhsa_next_free_vgpr 256
  .amdhsa_next_free_sgpr 102
  .amdhsa_accum_offset 192
  .amdhsa_group_segment_fixed_size 0
  .amdhsa_kernarg_size 80
  .amdhsa_user_sgpr_count 2
  .amdhsa_user_sgpr_kernarg_segment_ptr 1
  .amdhsa_system_sgpr_workgroup_id_x 1
  .amdhsa_float_denorm_mode_32 3
.end_amdhsa_kernel
.section .rodata,"a"
.p2align 6
.amdhsa_kernel qkv2_kernel
  .amdhsa_next_free_vgpr 336
  .amdhsa_next_free_sgpr 102
  .amdhsa_accum_offset 248
  .amdhsa_group_segment_fixed_size 0
  .amdhsa_kernarg_size 80
  .amdhsa_user_sgpr_count 2
  .amdhsa_user_sgpr_kernarg_segment_ptr 1
  .amdhsa_system_sgpr_workgroup_id_x 1
  .amdhsa_float_denorm_mode_32 3
.end_amdhsa_kernel
.section .rodata,"a"
.p2align 6
.amdhsa_kernel wo2_kernel
  .amdhsa_next_free_vgpr 256
  .amdhsa_next_free_sgpr 102
  .amdhsa_accum_offset 192
  .amdhsa_group_segment_fixed_size 0
  .amdhsa_kernarg_size 80
  .amdhsa_user_sgpr_count 2
  .amdhsa_user_sgpr_kernarg_segment_ptr 1
  .amdhsa_system_sgpr_workgroup_id_x 1
  .amdhsa_float_denorm_mode_32 3
.end_amdhsa_kernel
.section .rodata,"a"
.p2align 6
.amdhsa_kernel gu2_kernel
  .amdhsa_next_free_vgpr 448
  .amdhsa_next_free_sgpr 102
  .amdhsa_accum_offset 256
  .amdhsa_group_segment_fixed_size 0
  .amdhsa_kernarg_size 80
  .amdhsa_user_sgpr_count 2
  .amdhsa_user_sgpr_kernarg_segment_ptr 1
  .amdhsa_system_sgpr_workgroup_id_x 1
  .amdhsa_float_denorm_mode_32 3
.end_amdhsa_kernel
.section .rodata,"a"
.p2align 6
.amdhsa_kernel dn2_kernel
  .amdhsa_next_free_vgpr 256
  .amdhsa_next_free_sgpr 102
  .amdhsa_accum_offset 192
  .amdhsa_group_segment_fixed_size 0
  .amdhsa_kernarg_size 80
  .amdhsa_user_sgpr_count 2
  .amdhsa_user_sgpr_kernarg_segment_ptr 1
  .amdhsa_system_sgpr_workgroup_id_x 1
  .amdhsa_float_denorm_mode_32 3
.end_amdhsa_kernel
```

```asm
; @launch grid=(256,1,1) block=(256,1,1) lds=157952
.amdgcn_target "amdgcn-amd-amdhsa--gfx950"
.text
.globl interleave_layers__sliding_local_dilated__swiglu_ffn__prompt_kernel
.p2align 8
.type interleave_layers__sliding_local_dilated__swiglu_ffn__prompt_kernel,@function
interleave_layers__sliding_local_dilated__swiglu_ffn__prompt_kernel:
    s_cmp_ge_u32 s2, 256
    s_cbranch_scc1 .Lend
    s_load_dwordx4 s[68:71], s[0:1], 0
    s_load_dwordx2 s[72:73], s[0:1], 16
    s_load_dwordx8 s[76:83], s[0:1], 32
    s_load_dwordx4 s[84:87], s[0:1], 64
    v_lshrrev_b32 v2, 6, v0
    v_and_b32 v1, 63, v0
    v_readfirstlane_b32 s3, v2
    s_and_b32 s4, s2, 7
    s_lshr_b32 s5, s2, 3
    s_lshr_b32 s6, s4, 1
    s_lshl_b32 s6, s6, 2
    s_and_b32 s62, s5, 3
    s_add_u32 s6, s6, s62
    s_and_b32 s7, s4, 1
    s_lshl_b32 s7, s7, 3
    s_lshr_b32 s62, s5, 2
    s_add_u32 s7, s7, s62
    s_lshr_b32 s8, s4, 2
    s_lshl_b32 s8, s8, 3
    s_and_b32 s62, s5, 7
    s_add_u32 s8, s8, s62
    s_and_b32 s9, s4, 3
    s_lshl_b32 s9, s9, 2
    s_lshr_b32 s62, s5, 3
    s_add_u32 s9, s9, s62
    s_lshr_b32 s10, s4, 2
    s_lshl_b32 s10, s10, 2
    s_and_b32 s62, s5, 3
    s_add_u32 s10, s10, s62
    s_and_b32 s11, s4, 3
    s_lshl_b32 s11, s11, 3
    s_lshr_b32 s62, s5, 2
    s_add_u32 s11, s11, s62
    s_and_b32 s12, s11, 1
    s_lshr_b32 s13, s11, 1
    s_mul_i32 s51, s13, 448
    s_mul_i32 s62, s12, 192
    s_add_u32 s51, s51, s62
    s_and_b32 s48, s3, 1
    s_lshr_b32 s49, s3, 1
    s_lshl_b32 s50, s8, 3
    s_sub_u32 s50, s50, 9
    s_cmp_lt_u32 s8, 2
    s_cselect_b32 s50, 7, s50
    s_mov_b32 s14, 0
    s_mov_b32 s44, 30408704
    s_lshr_b32 s62, s6, 1
    s_lshl_b32 s62, s62, 8
    s_and_b32 s63, s6, 1
    s_add_u32 s62, s62, s63
    s_lshl_b32 s63, s3, 6
    s_add_u32 s62, s62, s63
    s_lshl_b32 s62, s62, 11
    s_lshl_b32 s63, s7, 7
    s_add_u32 s62, s62, s63
    v_and_b32 v160, 15, v1
    v_lshlrev_b32 v160, 12, v160
    v_bfe_u32 v2, v1, 4, 1
    v_lshl_add_u32 v160, v2, 5, v160
    v_bfe_u32 v2, v1, 5, 1
    v_lshl_add_u32 v160, v2, 4, v160
    v_add_u32 v160, s62, v160
    v_add_u32 v161, 0x10000, v160
    s_min_u32 s64, s3, 2
    s_lshl_b32 s65, s64, 11
    s_mul_i32 s66, s8, 393216
    s_add_u32 s65, s65, s66
    s_lshl_b32 s66, s9, 7
    s_add_u32 s65, s65, s66
    v_lshrrev_b32 v9, 3, v1
    v_mul_u32_u24 v9, 6144, v9
    v_and_b32 v2, 7, v1
    v_lshl_add_u32 v9, v2, 4, v9
    s_waitcnt lgkmcnt(0)
    s_mov_b32 s36, s68
    s_mov_b32 s37, s69
    s_mov_b32 s38, 4194304
    s_mov_b32 s39, 0x20000
    s_mov_b32 s16, s86
    s_mov_b32 s17, s87
    s_mov_b32 s18, 134217728
    s_mov_b32 s19, 0x20000
    s_lshl_b32 s67, s2, 2
    s_add_u32 s67, s67, s3
    v_lshlrev_b32 v27, 7, v1
    v_mov_b32 v28, 0
    s_cmp_lg_u32 s67, 3
    s_cbranch_scc1 .Lz1
    s_mov_b32 s62, 30408704
    buffer_store_dword v28, v27, s[16:19], s62 offen sc1
    s_mov_b32 s62, 30416896
    buffer_store_dword v28, v27, s[16:19], s62 offen sc1
    s_mov_b32 s62, 30425088
    buffer_store_dword v28, v27, s[16:19], s62 offen sc1
.Lz1:
    buffer_load_dwordx4 v[128:131], v160, s[36:39], 0 offen offset:0
    buffer_load_dwordx4 v[132:135], v160, s[36:39], 0 offen offset:64
    buffer_load_dwordx4 v[136:139], v161, s[36:39], 0 offen offset:0
    buffer_load_dwordx4 v[140:143], v161, s[36:39], 0 offen offset:64
    s_mov_b32 s20, s70
    s_mov_b32 s21, s71
    s_mov_b32 s22, 6291456
    s_mov_b32 s23, 0x20000
    buffer_load_dwordx4 v[64:67], v9, s[20:23], s65 offen
    s_add_u32 s65, s65, 49152
    buffer_load_dwordx4 v[68:71], v9, s[20:23], s65 offen
    s_add_u32 s65, s65, 49152
    buffer_load_dwordx4 v[72:75], v9, s[20:23], s65 offen
    s_add_u32 s65, s65, 49152
    buffer_load_dwordx4 v[76:79], v9, s[20:23], s65 offen
    s_add_u32 s65, s65, 49152
    buffer_load_dwordx4 v[80:83], v9, s[20:23], s65 offen
    s_add_u32 s65, s65, 49152
    buffer_load_dwordx4 v[84:87], v9, s[20:23], s65 offen
    s_add_u32 s65, s65, 49152
    buffer_load_dwordx4 v[88:91], v9, s[20:23], s65 offen
    s_add_u32 s65, s65, 49152
    buffer_load_dwordx4 v[92:95], v9, s[20:23], s65 offen
    s_add_u32 s65, s65, 49152
    s_mov_b32 s40, s84
    s_mov_b32 s41, s85
    s_mov_b32 s42, 256
    s_mov_b32 s43, 0x20000
    s_mov_b32 s24, s72
    s_mov_b32 s25, s73
    s_mov_b32 s26, 2097152
    s_mov_b32 s27, 0x20000
    s_mov_b32 s28, s80
    s_mov_b32 s29, s81
    s_mov_b32 s30, 7340032
    s_mov_b32 s31, 0x20000
    s_cmp_lt_u32 s3, 2
    s_cselect_b32 s32, s76, s78
    s_cselect_b32 s33, s77, s79
    s_mov_b32 s34, 7340032
    s_mov_b32 s35, 0x20000
    s_mov_b32 s46, s82
    s_mov_b32 s47, s83
    v_mov_b32 v29, 1
    s_cmp_lg_u32 s67, 3
    s_cbranch_scc1 .Lz2
    s_waitcnt vmcnt(12)
    s_mov_b64 exec, 1
    buffer_store_dword v29, v28, s[40:43], 0 offen sc1
    s_mov_b64 exec, -1
.Lz2:
    s_getpc_b64 s[62:63]
.Lpc:
    s_and_b32 s64, s5, 1
    s_lshl_b32 s64, s64, 2
    s_add_u32 s64, s64, s3
    s_lshl_b32 s64, s64, 13
    v_add_u32 v30, s64, v27
    v_min_u32 v30, .Lend-.Lpc, v30
    global_load_dword v31, v30, s[62:63]
    v_bfe_u32 v18, v1, 3, 1
    v_lshrrev_b32 v2, 4, v1
    v_lshl_add_u32 v18, v2, 3, v18
    s_lshl_b32 s62, s3, 1
    v_add_u32 v18, s62, v18
    v_mul_u32_u24 v18, 6144, v18
    v_and_b32 v2, 7, v1
    v_lshl_add_u32 v18, v2, 4, v18
    s_lshl_b32 s62, s9, 7
    v_add_u32 v18, s62, v18
    v_add_u32 v19, 1024, v18
    v_add_u32 v20, 2048, v18
    s_lshl_b32 s62, s6, 13
    s_lshl_b32 s63, s3, 11
    s_add_u32 s62, s62, s63
    v_lshl_add_u32 v4, v1, 4, s62
    s_mul_i32 s59, s3, 3104
    s_mov_b32 s58, 0
    s_add_u32 m0, s59, 66560
    s_nop 0
    buffer_load_dwordx4 v18, s[20:23], s58 offen lds
    buffer_load_dwordx4 v19, s[20:23], s58 offen offset:1024 lds
    buffer_load_dwordx4 v20, s[20:23], s58 offen offset:2048 lds
    s_add_u32 s58, s58, 196608
    s_add_u32 m0, s59, 78976
    s_nop 0
    buffer_load_dwordx4 v18, s[20:23], s58 offen lds
    buffer_load_dwordx4 v19, s[20:23], s58 offen offset:1024 lds
    buffer_load_dwordx4 v20, s[20:23], s58 offen offset:2048 lds
    s_add_u32 s58, s58, 196608
    v_and_b32 v2, 1, v1
    v_lshlrev_b32 v2, 4, v2
    v_mov_b32 v9, 0x3f80
    v_lshlrev_b32 v2, v2, v9
    v_bfe_u32 v9, v1, 1, 3
    v_cmp_eq_u32 vcc, 0, v9
    s_nop 1
    v_cndmask_b32 v96, 0, v2, vcc
    v_cmp_eq_u32 vcc, 1, v9
    s_nop 1
    v_cndmask_b32 v97, 0, v2, vcc
    v_cmp_eq_u32 vcc, 2, v9
    s_nop 1
    v_cndmask_b32 v98, 0, v2, vcc
    v_cmp_eq_u32 vcc, 3, v9
    s_nop 1
    v_cndmask_b32 v99, 0, v2, vcc
    s_waitcnt vmcnt(18)
    v_permlane16_swap_b32 v128, v130
    v_permlane16_swap_b32 v129, v131
    v_lshlrev_b32 v32, 16, v128
    v_and_b32 v33, 0xffff0000, v128
    v_lshlrev_b32 v34, 16, v129
    v_and_b32 v35, 0xffff0000, v129
    v_lshlrev_b32 v36, 16, v130
    v_and_b32 v37, 0xffff0000, v130
    v_lshlrev_b32 v38, 16, v131
    v_and_b32 v39, 0xffff0000, v131
    s_waitcnt vmcnt(17)
    v_permlane16_swap_b32 v132, v134
    v_permlane16_swap_b32 v133, v135
    v_lshlrev_b32 v40, 16, v132
    v_and_b32 v41, 0xffff0000, v132
    v_lshlrev_b32 v42, 16, v133
    v_and_b32 v43, 0xffff0000, v133
    v_lshlrev_b32 v44, 16, v134
    v_and_b32 v45, 0xffff0000, v134
    v_lshlrev_b32 v46, 16, v135
    v_and_b32 v47, 0xffff0000, v135
    s_waitcnt vmcnt(16)
    v_permlane16_swap_b32 v136, v138
    v_permlane16_swap_b32 v137, v139
    v_lshlrev_b32 v48, 16, v136
    v_and_b32 v49, 0xffff0000, v136
    v_lshlrev_b32 v50, 16, v137
    v_and_b32 v51, 0xffff0000, v137
    v_lshlrev_b32 v52, 16, v138
    v_and_b32 v53, 0xffff0000, v138
    v_lshlrev_b32 v54, 16, v139
    v_and_b32 v55, 0xffff0000, v139
    s_waitcnt vmcnt(15)
    v_permlane16_swap_b32 v140, v142
    v_permlane16_swap_b32 v141, v143
    v_lshlrev_b32 v56, 16, v140
    v_and_b32 v57, 0xffff0000, v140
    v_lshlrev_b32 v58, 16, v141
    v_and_b32 v59, 0xffff0000, v141
    v_lshlrev_b32 v60, 16, v142
    v_and_b32 v61, 0xffff0000, v142
    v_lshlrev_b32 v62, 16, v143
    v_and_b32 v63, 0xffff0000, v143
    s_lshl_b32 s62, s7, 18
    s_add_u32 s62, s62, s14
    s_add_u32 s62, s62, 0
    s_add_u32 s63, s62, 0x20000
    buffer_store_dwordx4 v[128:131], v4, s[16:19], s62 offen offset:0 sc1
    buffer_store_dwordx4 v[132:135], v4, s[16:19], s63 offen offset:0 sc1
    buffer_store_dwordx4 v[136:139], v4, s[16:19], s62 offen offset:1024 sc1
    buffer_store_dwordx4 v[140:143], v4, s[16:19], s63 offen offset:1024 sc1
    v_pk_mul_f32 v[146:147], v[32:33], v[32:33]
    v_pk_fma_f32 v[146:147], v[34:35], v[34:35], v[146:147]
    v_pk_add_f32 v[144:145], v[32:33], v[34:35]
    v_pk_fma_f32 v[146:147], v[36:37], v[36:37], v[146:147]
    v_pk_add_f32 v[144:145], v[144:145], v[36:37]
    v_pk_fma_f32 v[146:147], v[38:39], v[38:39], v[146:147]
    v_pk_add_f32 v[144:145], v[144:145], v[38:39]
    v_pk_fma_f32 v[146:147], v[40:41], v[40:41], v[146:147]
    v_pk_add_f32 v[144:145], v[144:145], v[40:41]
    v_pk_fma_f32 v[146:147], v[42:43], v[42:43], v[146:147]
    v_pk_add_f32 v[144:145], v[144:145], v[42:43]
    v_pk_fma_f32 v[146:147], v[44:45], v[44:45], v[146:147]
    v_pk_add_f32 v[144:145], v[144:145], v[44:45]
    v_pk_fma_f32 v[146:147], v[46:47], v[46:47], v[146:147]
    v_pk_add_f32 v[144:145], v[144:145], v[46:47]
    v_add_f32 v144, v144, v145
    v_add_f32 v146, v146, v147
    v_pk_mul_f32 v[150:151], v[48:49], v[48:49]
    v_pk_fma_f32 v[150:151], v[50:51], v[50:51], v[150:151]
    v_pk_add_f32 v[148:149], v[48:49], v[50:51]
    v_pk_fma_f32 v[150:151], v[52:53], v[52:53], v[150:151]
    v_pk_add_f32 v[148:149], v[148:149], v[52:53]
    v_pk_fma_f32 v[150:151], v[54:55], v[54:55], v[150:151]
    v_pk_add_f32 v[148:149], v[148:149], v[54:55]
    v_pk_fma_f32 v[150:151], v[56:57], v[56:57], v[150:151]
    v_pk_add_f32 v[148:149], v[148:149], v[56:57]
    v_pk_fma_f32 v[150:151], v[58:59], v[58:59], v[150:151]
    v_pk_add_f32 v[148:149], v[148:149], v[58:59]
    v_pk_fma_f32 v[150:151], v[60:61], v[60:61], v[150:151]
    v_pk_add_f32 v[148:149], v[148:149], v[60:61]
    v_pk_fma_f32 v[150:151], v[62:63], v[62:63], v[150:151]
    v_pk_add_f32 v[148:149], v[148:149], v[62:63]
    v_add_f32 v148, v148, v149
    v_add_f32 v150, v150, v151
    s_nop 0
    v_permlane16_swap_b32 v144, v148
    v_permlane16_swap_b32 v146, v150
    v_add_f32 v144, v144, v148
    v_add_f32 v146, v146, v150
    s_lshl_b32 s64, s7, 14
    s_lshl_b32 s65, s6, 10
    s_add_u32 s64, s64, s65
    s_lshl_b32 s65, s3, 8
    s_add_u32 s64, s64, s65
    s_add_u32 s64, s64, s14
    s_add_u32 s64, s64, 29360128
    v_permlane32_swap_b32 v144, v146
    v_and_b32 v152, 31, v1
    v_lshlrev_b32 v152, 3, v152
    v_lshrrev_b32 v153, 5, v1
    v_lshl_add_u32 v152, v153, 2, v152
    v_add_f32 v144, v144, v146
    buffer_store_dword v144, v152, s[16:19], s64 offen sc1
    s_waitcnt vmcnt(19)
    v_mfma_f32_16x16x32_bf16 v[100:103], v[96:99], v[64:67], 0
    s_waitcnt vmcnt(18)
    v_mfma_f32_16x16x32_bf16 v[100:103], v[96:99], v[68:71], v[100:103]
    s_waitcnt vmcnt(17)
    v_mfma_f32_16x16x32_bf16 v[100:103], v[96:99], v[72:75], v[100:103]
    s_waitcnt vmcnt(16)
    v_mfma_f32_16x16x32_bf16 v[100:103], v[96:99], v[76:79], v[100:103]
    s_waitcnt vmcnt(15)
    v_mfma_f32_16x16x32_bf16 v[100:103], v[96:99], v[80:83], v[100:103]
    s_waitcnt vmcnt(14)
    v_mfma_f32_16x16x32_bf16 v[100:103], v[96:99], v[84:87], v[100:103]
    s_waitcnt vmcnt(13)
    v_mfma_f32_16x16x32_bf16 v[100:103], v[96:99], v[88:91], v[100:103]
    s_waitcnt vmcnt(12)
    v_mfma_f32_16x16x32_bf16 v[100:103], v[96:99], v[92:95], v[100:103]
    s_min_u32 s64, s3, 2
    s_lshl_b32 s64, s64, 12
    s_mul_i32 s65, s8, 12288
    s_add_u32 s64, s64, s65
    s_lshl_b32 s65, s9, 8
    s_add_u32 s64, s64, s65
    s_add_u32 s64, s64, 31457280
    v_and_b32 v9, 7, v1
    v_lshlrev_b32 v9, 5, v9
    v_bfe_u32 v2, v1, 4, 1
    v_lshl_add_u32 v9, v2, 4, v9
    v_and_b32 v2, 0x28, v1
    v_lshl_add_u32 v9, v2, 25, v9
    v_add_f32_dpp v104, v100, v100 row_ror:8 row_mask:0xf bank_mask:0xf
    v_add_f32_dpp v105, v101, v101 row_ror:8 row_mask:0xf bank_mask:0xf
    v_add_f32_dpp v106, v102, v102 row_ror:8 row_mask:0xf bank_mask:0xf
    v_add_f32_dpp v107, v103, v103 row_ror:8 row_mask:0xf bank_mask:0xf
    buffer_store_dwordx4 v[104:107], v9, s[16:19], s64 offen sc1
    buffer_load_dword v255, v28, s[40:43], 0 offen sc1
    s_mov_b32 s36, s46
    s_mov_b32 s37, s47
    s_nop 1
    v_accvgpr_write_b32 a224, v32
    v_accvgpr_write_b32 a225, v33
    v_accvgpr_write_b32 a226, v34
    v_accvgpr_write_b32 a227, v35
    v_accvgpr_write_b32 a228, v36
    v_accvgpr_write_b32 a229, v37
    v_accvgpr_write_b32 a230, v38
    v_accvgpr_write_b32 a231, v39
    v_accvgpr_write_b32 a232, v40
    v_accvgpr_write_b32 a233, v41
    v_accvgpr_write_b32 a234, v42
    v_accvgpr_write_b32 a235, v43
    v_accvgpr_write_b32 a236, v44
    v_accvgpr_write_b32 a237, v45
    v_accvgpr_write_b32 a238, v46
    v_accvgpr_write_b32 a239, v47
    v_accvgpr_write_b32 a240, v48
    v_accvgpr_write_b32 a241, v49
    v_accvgpr_write_b32 a242, v50
    v_accvgpr_write_b32 a243, v51
    v_accvgpr_write_b32 a244, v52
    v_accvgpr_write_b32 a245, v53
    v_accvgpr_write_b32 a246, v54
    v_accvgpr_write_b32 a247, v55
    v_accvgpr_write_b32 a248, v56
    v_accvgpr_write_b32 a249, v57
    v_accvgpr_write_b32 a250, v58
    v_accvgpr_write_b32 a251, v59
    v_accvgpr_write_b32 a252, v60
    v_accvgpr_write_b32 a253, v61
    v_accvgpr_write_b32 a254, v62
    v_accvgpr_write_b32 a255, v63
    s_lshl_b32 s62, s8, 13
    s_lshl_b32 s63, s3, 11
    s_add_u32 s62, s62, s63
    v_lshl_add_u32 v21, v1, 4, s62
    s_lshl_b32 s62, s50, 10
    s_lshl_b32 s63, s3, 8
    s_add_u32 s62, s62, s63
    s_sub_u32 s62, s62, 2048
    v_lshl_add_u32 v22, v1, 2, s62
    s_mul_i32 s62, s48, 4608
    v_lshl_add_u32 v23, v1, 4, s62
    v_lshrrev_b32 v24, 4, v1
    v_mul_u32_u24 v24, 2304, v24
    v_and_b32 v2, 15, v1
    v_lshl_add_u32 v24, v2, 4, v24
    v_bfe_u32 v25, v1, 3, 2
    v_mul_u32_u24 v25, 3104, v25
    v_bfe_u32 v2, v1, 2, 1
    v_lshl_add_u32 v25, v2, 7, v25
    v_bfe_u32 v2, v1, 5, 1
    v_lshl_add_u32 v25, v2, 8, v25
    v_and_b32 v2, 3, v1
    v_lshl_add_u32 v25, v2, 3, v25
    s_lshl_b32 s62, s49, 6
    s_add_u32 s62, s62, 66560
    v_add_u32 v25, s62, v25
    s_lshl_b32 s62, s8, 10
    v_lshl_add_u32 v26, v0, 3, s62
    s_lshl_b32 s62, s50, 7
    v_and_b32 v2, 15, v1
    v_lshl_add_u32 v2, v2, 3, s62
    v_cmp_gt_u32 vcc, 128, v0
    s_nop 1
    v_cndmask_b32 v26, v2, v26, vcc
    s_add_u32 s52, s14, 0
    s_mov_b32 s54, s58
    s_mov_b32 s56, s59
    s_mul_i32 s55, s3, 2304
    s_mul_i32 s59, s3, 2080
    v_bfe_u32 v5, v1, 3, 1
    v_lshrrev_b32 v2, 4, v1
    v_lshl_add_u32 v5, v2, 3, v5
    s_lshl_b32 s62, s3, 1
    v_add_u32 v5, s62, v5
    v_mul_u32_u24 v5, 2048, v5
    v_and_b32 v2, 7, v1
    v_lshl_add_u32 v5, v2, 4, v5
    s_lshl_b32 s62, s7, 7
    v_add_u32 v5, s62, v5
    v_add_u32 v6, 64512, v5
    s_lshl_b32 s62, s6, 7
    s_add_u32 s62, s62, s44
    s_add_u32 s62, s62, 0
    s_lshl_b32 s63, s9, 7
    s_add_u32 s63, s63, 30425088
    s_lshl_b32 s64, s8, 7
    s_add_u32 s64, s64, s44
    s_add_u32 s64, s64, 0
    s_lshr_b32 s65, s50, 3
    s_lshl_b32 s65, s65, 7
    s_add_u32 s65, s65, s44
    s_add_u32 s65, s65, 0
    v_mov_b32 v252, s62
    v_mov_b32 v253, s64
    v_mov_b32 v254, 16
    v_writelane_b32 v252, s63, 1
    v_writelane_b32 v253, s65, 1
    v_writelane_b32 v253, s63, 2
    s_waitcnt vmcnt(0) lgkmcnt(0)
    s_cmp_lg_u32 s3, 0
    s_cbranch_scc1 .Lrdyok4
    s_mov_b32 s15, 0
    v_mov_b32 v2, 0
.Lrdy3:
    v_cmp_ne_u32 vcc, 0, v255
    s_add_u32 s15, s15, 1
    s_cbranch_vccnz .Lrdyok4
    s_cmp_gt_u32 s15, 100000
    s_cbranch_scc1 .Lrdyok4
    buffer_load_dword v255, v2, s[40:43], 0 offen sc1
    s_waitcnt vmcnt(0)
    s_branch .Lrdy3
.Lrdyok4:

    s_barrier
    s_cmp_lg_u32 s3, 0
    s_cbranch_scc1 .Lnosig5
    v_mov_b32 v255, 1
    s_mov_b64 exec, 3
    buffer_atomic_add v255, v252, s[16:19], 0 offen
    s_mov_b64 exec, -1
.Lnosig5:
    s_add_u32 m0, s56, 91392
    s_nop 0
    buffer_load_dwordx4 v18, s[20:23], s54 offen lds
    buffer_load_dwordx4 v19, s[20:23], s54 offen offset:1024 lds
    buffer_load_dwordx4 v20, s[20:23], s54 offen offset:2048 lds
    s_add_u32 s54, s54, 196608
    s_add_u32 m0, s56, 103808
    s_nop 0
    buffer_load_dwordx4 v18, s[20:23], s54 offen lds
    buffer_load_dwordx4 v19, s[20:23], s54 offen offset:1024 lds
    buffer_load_dwordx4 v20, s[20:23], s54 offen offset:2048 lds
    s_add_u32 s54, s54, 196608
    s_add_u32 m0, s56, 116224
    s_nop 0
    buffer_load_dwordx4 v18, s[20:23], s54 offen lds
    buffer_load_dwordx4 v19, s[20:23], s54 offen offset:1024 lds
    buffer_load_dwordx4 v20, s[20:23], s54 offen offset:2048 lds
    s_add_u32 s54, s54, 196608
    s_add_u32 m0, s56, 128640
    s_nop 0
    buffer_load_dwordx4 v18, s[20:23], s54 offen lds
    buffer_load_dwordx4 v19, s[20:23], s54 offen offset:1024 lds
    buffer_load_dwordx4 v20, s[20:23], s54 offen offset:2048 lds
    s_add_u32 s54, s54, 196608
    ds_read_b64_tr_b16 a[20:21], v25 offset:0
    ds_read_b64_tr_b16 a[22:23], v25 offset:512
    ds_read_b64_tr_b16 a[24:25], v25 offset:32
    ds_read_b64_tr_b16 a[26:27], v25 offset:544
    ds_read_b64_tr_b16 a[28:29], v25 offset:1024
    ds_read_b64_tr_b16 a[30:31], v25 offset:1536
    ds_read_b64_tr_b16 a[32:33], v25 offset:1056
    ds_read_b64_tr_b16 a[34:35], v25 offset:1568
    ds_read_b64_tr_b16 a[36:37], v25 offset:2048
    ds_read_b64_tr_b16 a[38:39], v25 offset:2560
    ds_read_b64_tr_b16 a[40:41], v25 offset:2080
    ds_read_b64_tr_b16 a[42:43], v25 offset:2592
    v_lshrrev_b32 v2, 4, v1
    v_lshlrev_b32 v2, 2, v2
    v_and_b32 v27, 15, v1
    v_sub_u32 v2, v27, v2
    v_mov_b32 v27, 0xf149f2ca
    v_subrev_u32 v54, 0, v2
    v_cmp_gt_u32 vcc, 8, v54
    s_nop 1
    v_cndmask_b32 v50, v27, 0, vcc
    v_cmp_gt_i32 vcc, -8, v54
    s_nop 1
    v_cndmask_b32 v46, v27, 0, vcc
    v_subrev_u32 v54, 1, v2
    v_cmp_gt_u32 vcc, 8, v54
    s_nop 1
    v_cndmask_b32 v51, v27, 0, vcc
    v_cmp_gt_i32 vcc, -8, v54
    s_nop 1
    v_cndmask_b32 v47, v27, 0, vcc
    v_subrev_u32 v54, 2, v2
    v_cmp_gt_u32 vcc, 8, v54
    s_nop 1
    v_cndmask_b32 v52, v27, 0, vcc
    v_cmp_gt_i32 vcc, -8, v54
    s_nop 1
    v_cndmask_b32 v48, v27, 0, vcc
    v_subrev_u32 v54, 3, v2
    v_cmp_gt_u32 vcc, 8, v54
    s_nop 1
    v_cndmask_b32 v53, v27, 0, vcc
    v_cmp_gt_i32 vcc, -8, v54
    s_nop 1
    v_cndmask_b32 v49, v27, 0, vcc
    s_cmp_lt_u32 s8, 2
    s_cselect_b64 vcc, -1, 0
    v_cndmask_b32 v54, v46, v27, vcc
    v_cndmask_b32 v55, v47, v27, vcc
    v_cndmask_b32 v56, v48, v27, vcc
    v_cndmask_b32 v57, v49, v27, vcc
    v_mov_b64 v[60:61], 0
    v_mov_b64 v[62:63], 0
    v_mov_b64 v[64:65], 0
    v_mov_b64 v[66:67], 0
    v_mov_b64 v[68:69], 0
    v_mov_b64 v[70:71], 0
    v_mov_b64 v[72:73], 0
    v_mov_b64 v[74:75], 0
    v_mov_b64 v[76:77], 0
    v_mov_b64 v[78:79], 0
    v_mov_b64 v[80:81], 0
    v_mov_b64 v[82:83], 0
    v_mov_b64 v[84:85], 0
    v_mov_b64 v[86:87], 0
    v_mov_b64 v[88:89], 0
    v_mov_b64 v[90:91], 0
    v_mov_b64 v[92:93], 0
    v_mov_b64 v[94:95], 0
    v_mov_b64 v[96:97], 0
    v_mov_b64 v[98:99], 0
    v_mov_b64 v[100:101], 0
    v_mov_b64 v[102:103], 0
    v_mov_b64 v[104:105], 0
    v_mov_b64 v[106:107], 0
    v_mov_b64 v[108:109], 0
    v_mov_b64 v[110:111], 0
    v_mov_b64 v[112:113], 0
    v_mov_b64 v[114:115], 0
    v_mov_b64 v[116:117], 0
    v_mov_b64 v[118:119], 0
    v_mov_b64 v[120:121], 0
    v_mov_b64 v[122:123], 0
    v_mov_b64 v[124:125], 0
    v_mov_b64 v[126:127], 0
    v_mov_b64 v[128:129], 0
    v_mov_b64 v[130:131], 0
    v_mov_b64 v[132:133], 0
    v_mov_b64 v[134:135], 0
    v_mov_b64 v[136:137], 0
    v_mov_b64 v[138:139], 0
    v_mov_b64 v[140:141], 0
    v_mov_b64 v[142:143], 0
    v_mov_b64 v[144:145], 0
    v_mov_b64 v[146:147], 0
    v_mov_b64 v[148:149], 0
    v_mov_b64 v[150:151], 0
    v_mov_b64 v[152:153], 0
    v_mov_b64 v[154:155], 0
    v_mov_b64 v[156:157], 0
    v_mov_b64 v[158:159], 0
    v_mov_b64 v[160:161], 0
    v_mov_b64 v[162:163], 0
    s_waitcnt lgkmcnt(0)
    s_cmp_lg_u32 s3, 1
    s_cbranch_scc1 .Lnopoll8
    s_mov_b64 exec, 7
    s_mov_b32 s15, 0
.Lpoll6:
    buffer_load_dword v255, v253, s[16:19], 0 offen sc1
    s_add_u32 s15, s15, 1
    s_cmp_gt_u32 s15, 100000
    s_cbranch_scc1 .Lgot7
    s_waitcnt vmcnt(0)
    v_cmp_ne_u32 vcc, v255, v254
    s_nop 0
    s_cbranch_vccnz .Lpoll6
.Lgot7:
    s_waitcnt vmcnt(0)
    s_mov_b64 exec, -1
.Lnopoll8:
    s_barrier

.Llayer:
    s_cmp_eq_u32 s48, 1
    s_cbranch_scc1 .Lqkv1
    s_add_u32 m0, s55, 0
    s_nop 0
    buffer_load_dwordx4 v21, s[16:19], s52 offen sc1 lds
    buffer_load_dwordx4 v21, s[16:19], s52 offen offset:1024 sc1 lds
    buffer_load_dword v22, s[16:19], s52 offen offset:2048 sc1 lds
    s_add_u32 s52, s52, 0x20000
    s_add_u32 m0, s55, 9216
    s_nop 0
    buffer_load_dwordx4 v21, s[16:19], s52 offen sc1 lds
    buffer_load_dwordx4 v21, s[16:19], s52 offen offset:1024 sc1 lds
    buffer_load_dword v22, s[16:19], s52 offen offset:2048 sc1 lds
    s_add_u32 s52, s52, 0x20000
    s_add_u32 m0, s55, 18432
    s_nop 0
    buffer_load_dwordx4 v21, s[16:19], s52 offen sc1 lds
    buffer_load_dwordx4 v21, s[16:19], s52 offen offset:1024 sc1 lds
    buffer_load_dword v22, s[16:19], s52 offen offset:2048 sc1 lds
    s_add_u32 s52, s52, 0x20000
    s_add_u32 m0, s55, 27648
    s_nop 0
    buffer_load_dwordx4 v21, s[16:19], s52 offen sc1 lds
    buffer_load_dwordx4 v21, s[16:19], s52 offen offset:1024 sc1 lds
    buffer_load_dword v22, s[16:19], s52 offen offset:2048 sc1 lds
    s_add_u32 s52, s52, 0x20000
    s_add_u32 m0, s55, 36864
    s_nop 0
    buffer_load_dwordx4 v21, s[16:19], s52 offen sc1 lds
    buffer_load_dwordx4 v21, s[16:19], s52 offen offset:1024 sc1 lds
    buffer_load_dword v22, s[16:19], s52 offen offset:2048 sc1 lds
    s_add_u32 s52, s52, 0x20000
    s_add_u32 m0, s55, 46080
    s_nop 0
    buffer_load_dwordx4 v21, s[16:19], s52 offen sc1 lds
    buffer_load_dwordx4 v21, s[16:19], s52 offen offset:1024 sc1 lds
    buffer_load_dword v22, s[16:19], s52 offen offset:2048 sc1 lds
    s_add_u32 s52, s52, 0x20000
    s_waitcnt vmcnt(15)
    s_barrier
    ds_read_b128 a[0:3], v23 offset:0
    ds_read_b128 a[4:7], v23 offset:1024
    ds_read_b128 a[8:11], v23 offset:2304
    ds_read_b128 a[12:15], v23 offset:3328
    ds_read_b128 a[16:19], v24 offset:2048
    s_cmp_lg_u32 s14, 0
    s_cbranch_scc1 .Ll09
    v_min_u32 v2, 191, v0
    v_lshrrev_b32 v27, 6, v2
    v_lshlrev_b32 v27, 12, v27
    v_and_b32 v2, 63, v2
    v_lshl_add_u32 v2, v2, 2, v27
    s_lshl_b32 s62, s9, 8
    s_add_u32 s62, s62, 31457280
    buffer_load_dword v200, v2, s[16:19], s62 offen sc1
    s_add_u32 s62, s62, 12288
    buffer_load_dword v201, v2, s[16:19], s62 offen sc1
    s_add_u32 s62, s62, 12288
    buffer_load_dword v202, v2, s[16:19], s62 offen sc1
    s_add_u32 s62, s62, 12288
    buffer_load_dword v203, v2, s[16:19], s62 offen sc1
    s_add_u32 s62, s62, 12288
    buffer_load_dword v204, v2, s[16:19], s62 offen sc1
    s_add_u32 s62, s62, 12288
    buffer_load_dword v205, v2, s[16:19], s62 offen sc1
    s_add_u32 s62, s62, 12288
    buffer_load_dword v206, v2, s[16:19], s62 offen sc1
    s_add_u32 s62, s62, 12288
    buffer_load_dword v207, v2, s[16:19], s62 offen sc1
    s_add_u32 s62, s62, 12288
    buffer_load_dword v208, v2, s[16:19], s62 offen sc1
    s_add_u32 s62, s62, 12288
    buffer_load_dword v209, v2, s[16:19], s62 offen sc1
    s_add_u32 s62, s62, 12288
    buffer_load_dword v210, v2, s[16:19], s62 offen sc1
    s_add_u32 s62, s62, 12288
    buffer_load_dword v211, v2, s[16:19], s62 offen sc1
    s_add_u32 s62, s62, 12288
    buffer_load_dword v212, v2, s[16:19], s62 offen sc1
    s_add_u32 s62, s62, 12288
    buffer_load_dword v213, v2, s[16:19], s62 offen sc1
    s_add_u32 s62, s62, 12288
    buffer_load_dword v214, v2, s[16:19], s62 offen sc1
    s_add_u32 s62, s62, 12288
    buffer_load_dword v215, v2, s[16:19], s62 offen sc1
    s_add_u32 s62, s62, 12288
    s_lshl_b32 s62, s2, 1
    s_add_u32 s62, s62, s48
    s_mul_i32 s62, s62, 14336
    v_min_u32 v2, 55, v1
    v_lshlrev_b32 v2, 7, v2
    buffer_load_dword v216, v2, s[32:35], s62 offen
    s_add_u32 s62, s62, 7168
    buffer_load_dword v217, v2, s[32:35], s62 offen
    s_lshl_b32 s62, s2, 13
    v_lshrrev_b32 v2, 2, v0
    v_lshlrev_b32 v2, 7, v2
    buffer_load_dword v218, v2, s[24:27], s62 offen
.Ll09:

    s_mov_b32 s15, 4
.p2align 6
.Lqk10:
    s_waitcnt lgkmcnt(0)
    s_waitcnt vmcnt(12)
    s_barrier
    v_mfma_f32_16x16x32_bf16 v[60:63], a[20:23], a[0:3], v[60:63]
    s_add_u32 m0, s56, 66560
    ds_read_b64_tr_b16 a[64:65], v25 offset:12416
    v_mfma_f32_16x16x32_bf16 v[64:67], a[20:23], a[4:7], v[64:67]
    buffer_load_dwordx4 v18, s[20:23], s54 offen lds
    v_mfma_f32_16x16x32_bf16 v[68:71], a[20:23], a[8:11], v[68:71]
    ds_read_b64_tr_b16 a[66:67], v25 offset:12928
    v_mfma_f32_16x16x32_bf16 v[72:75], a[20:23], a[12:15], v[72:75]
    ds_read_b64_tr_b16 a[68:69], v25 offset:12448
    ds_read_b64_tr_b16 a[70:71], v25 offset:12960
    v_mfma_f32_16x16x32_bf16 v[76:79], a[24:27], a[0:3], v[76:79]
    ds_read_b64_tr_b16 a[72:73], v25 offset:13440
    v_mfma_f32_16x16x32_bf16 v[80:83], a[24:27], a[4:7], v[80:83]
    buffer_load_dwordx4 v19, s[20:23], s54 offen offset:1024 lds
    v_mfma_f32_16x16x32_bf16 v[84:87], a[24:27], a[8:11], v[84:87]
    ds_read_b64_tr_b16 a[74:75], v25 offset:13952
    v_mfma_f32_16x16x32_bf16 v[88:91], a[24:27], a[12:15], v[88:91]
    ds_read_b64_tr_b16 a[76:77], v25 offset:13472
    v_mfma_f32_16x16x32_bf16 v[92:95], a[28:31], a[0:3], v[92:95]
    ds_read_b64_tr_b16 a[78:79], v25 offset:13984
    ds_read_b128 a[44:47], v23 offset:9216
    v_mfma_f32_16x16x32_bf16 v[96:99], a[28:31], a[4:7], v[96:99]
    buffer_load_dwordx4 v20, s[20:23], s54 offen offset:2048 lds
    v_mfma_f32_16x16x32_bf16 v[100:103], a[28:31], a[8:11], v[100:103]
    s_add_u32 s54, s54, 196608
    v_mfma_f32_16x16x32_bf16 v[104:107], a[28:31], a[12:15], v[104:107]
    ds_read_b128 a[48:51], v23 offset:10240
    ds_read_b64_tr_b16 a[80:81], v25 offset:14464
    v_mfma_f32_16x16x32_bf16 v[156:159], a[28:31], a[16:19], v[156:159]
    s_add_u32 m0, s55, 0
    v_mfma_f32_16x16x32_bf16 v[108:111], a[32:35], a[0:3], v[108:111]
    buffer_load_dwordx4 v21, s[16:19], s52 offen sc1 lds
    v_mfma_f32_16x16x32_bf16 v[112:115], a[32:35], a[4:7], v[112:115]
    ds_read_b64_tr_b16 a[82:83], v25 offset:14976
    v_mfma_f32_16x16x32_bf16 v[116:119], a[32:35], a[8:11], v[116:119]
    ds_read_b128 a[52:55], v23 offset:11520
    ds_read_b128 a[56:59], v23 offset:12544
    v_mfma_f32_16x16x32_bf16 v[120:123], a[32:35], a[12:15], v[120:123]
    ds_read_b64_tr_b16 a[84:85], v25 offset:14496
    v_mfma_f32_16x16x32_bf16 v[160:163], a[32:35], a[16:19], v[160:163]
    buffer_load_dwordx4 v21, s[16:19], s52 offen offset:1024 sc1 lds
    v_mfma_f32_16x16x32_bf16 v[124:127], a[0:3], a[36:39], v[124:127]
    ds_read_b64_tr_b16 a[86:87], v25 offset:15008
    v_mfma_f32_16x16x32_bf16 v[128:131], a[4:7], a[36:39], v[128:131]
    ds_read_b128 a[60:63], v24 offset:11264
    v_mfma_f32_16x16x32_bf16 v[132:135], a[8:11], a[36:39], v[132:135]
    v_mfma_f32_16x16x32_bf16 v[136:139], a[12:15], a[36:39], v[136:139]
    buffer_load_dword v22, s[16:19], s52 offen offset:2048 sc1 lds
    v_mfma_f32_16x16x32_bf16 v[140:143], a[0:3], a[40:43], v[140:143]
    s_add_u32 s52, s52, 0x20000
    v_mfma_f32_16x16x32_bf16 v[144:147], a[4:7], a[40:43], v[144:147]
    v_mfma_f32_16x16x32_bf16 v[148:151], a[8:11], a[40:43], v[148:151]
    v_mfma_f32_16x16x32_bf16 v[152:155], a[12:15], a[40:43], v[152:155]
    s_waitcnt lgkmcnt(0)
    s_waitcnt vmcnt(15)
    s_barrier
    v_mfma_f32_16x16x32_bf16 v[60:63], a[64:67], a[44:47], v[60:63]
    s_add_u32 m0, s56, 78976
    ds_read_b64_tr_b16 a[20:21], v25 offset:24832
    v_mfma_f32_16x16x32_bf16 v[64:67], a[64:67], a[48:51], v[64:67]
    buffer_load_dwordx4 v18, s[20:23], s54 offen lds
    v_mfma_f32_16x16x32_bf16 v[68:71], a[64:67], a[52:55], v[68:71]
    ds_read_b64_tr_b16 a[22:23], v25 offset:25344
    v_mfma_f32_16x16x32_bf16 v[72:75], a[64:67], a[56:59], v[72:75]
    ds_read_b64_tr_b16 a[24:25], v25 offset:24864
    ds_read_b64_tr_b16 a[26:27], v25 offset:25376
    v_mfma_f32_16x16x32_bf16 v[76:79], a[68:71], a[44:47], v[76:79]
    ds_read_b64_tr_b16 a[28:29], v25 offset:25856
    v_mfma_f32_16x16x32_bf16 v[80:83], a[68:71], a[48:51], v[80:83]
    buffer_load_dwordx4 v19, s[20:23], s54 offen offset:1024 lds
    v_mfma_f32_16x16x32_bf16 v[84:87], a[68:71], a[52:55], v[84:87]
    ds_read_b64_tr_b16 a[30:31], v25 offset:26368
    v_mfma_f32_16x16x32_bf16 v[88:91], a[68:71], a[56:59], v[88:91]
    ds_read_b64_tr_b16 a[32:33], v25 offset:25888
    v_mfma_f32_16x16x32_bf16 v[92:95], a[72:75], a[44:47], v[92:95]
    ds_read_b64_tr_b16 a[34:35], v25 offset:26400
    ds_read_b128 a[0:3], v23 offset:18432
    v_mfma_f32_16x16x32_bf16 v[96:99], a[72:75], a[48:51], v[96:99]
    buffer_load_dwordx4 v20, s[20:23], s54 offen offset:2048 lds
    v_mfma_f32_16x16x32_bf16 v[100:103], a[72:75], a[52:55], v[100:103]
    s_add_u32 s54, s54, 196608
    v_mfma_f32_16x16x32_bf16 v[104:107], a[72:75], a[56:59], v[104:107]
    ds_read_b128 a[4:7], v23 offset:19456
    ds_read_b64_tr_b16 a[36:37], v25 offset:26880
    v_mfma_f32_16x16x32_bf16 v[156:159], a[72:75], a[60:63], v[156:159]
    s_add_u32 m0, s55, 9216
    v_mfma_f32_16x16x32_bf16 v[108:111], a[76:79], a[44:47], v[108:111]
    buffer_load_dwordx4 v21, s[16:19], s52 offen sc1 lds
    v_mfma_f32_16x16x32_bf16 v[112:115], a[76:79], a[48:51], v[112:115]
    ds_read_b64_tr_b16 a[38:39], v25 offset:27392
    v_mfma_f32_16x16x32_bf16 v[116:119], a[76:79], a[52:55], v[116:119]
    ds_read_b128 a[8:11], v23 offset:20736
    ds_read_b128 a[12:15], v23 offset:21760
    v_mfma_f32_16x16x32_bf16 v[120:123], a[76:79], a[56:59], v[120:123]
    ds_read_b64_tr_b16 a[40:41], v25 offset:26912
    v_mfma_f32_16x16x32_bf16 v[160:163], a[76:79], a[60:63], v[160:163]
    buffer_load_dwordx4 v21, s[16:19], s52 offen offset:1024 sc1 lds
    v_mfma_f32_16x16x32_bf16 v[124:127], a[44:47], a[80:83], v[124:127]
    ds_read_b64_tr_b16 a[42:43], v25 offset:27424
    v_mfma_f32_16x16x32_bf16 v[128:131], a[48:51], a[80:83], v[128:131]
    ds_read_b128 a[16:19], v24 offset:20480
    v_mfma_f32_16x16x32_bf16 v[132:135], a[52:55], a[80:83], v[132:135]
    v_mfma_f32_16x16x32_bf16 v[136:139], a[56:59], a[80:83], v[136:139]
    buffer_load_dword v22, s[16:19], s52 offen offset:2048 sc1 lds
    v_mfma_f32_16x16x32_bf16 v[140:143], a[44:47], a[84:87], v[140:143]
    s_add_u32 s52, s52, 0x20000
    v_mfma_f32_16x16x32_bf16 v[144:147], a[48:51], a[84:87], v[144:147]
    v_mfma_f32_16x16x32_bf16 v[148:151], a[52:55], a[84:87], v[148:151]
    v_mfma_f32_16x16x32_bf16 v[152:155], a[56:59], a[84:87], v[152:155]
    s_waitcnt lgkmcnt(0)
    s_waitcnt vmcnt(18)
    s_barrier
    v_mfma_f32_16x16x32_bf16 v[60:63], a[20:23], a[0:3], v[60:63]
    s_add_u32 m0, s56, 91392
    ds_read_b64_tr_b16 a[64:65], v25 offset:37248
    v_mfma_f32_16x16x32_bf16 v[64:67], a[20:23], a[4:7], v[64:67]
    buffer_load_dwordx4 v18, s[20:23], s54 offen lds
    v_mfma_f32_16x16x32_bf16 v[68:71], a[20:23], a[8:11], v[68:71]
    ds_read_b64_tr_b16 a[66:67], v25 offset:37760
    v_mfma_f32_16x16x32_bf16 v[72:75], a[20:23], a[12:15], v[72:75]
    ds_read_b64_tr_b16 a[68:69], v25 offset:37280
    ds_read_b64_tr_b16 a[70:71], v25 offset:37792
    v_mfma_f32_16x16x32_bf16 v[76:79], a[24:27], a[0:3], v[76:79]
    ds_read_b64_tr_b16 a[72:73], v25 offset:38272
    v_mfma_f32_16x16x32_bf16 v[80:83], a[24:27], a[4:7], v[80:83]
    buffer_load_dwordx4 v19, s[20:23], s54 offen offset:1024 lds
    v_mfma_f32_16x16x32_bf16 v[84:87], a[24:27], a[8:11], v[84:87]
    ds_read_b64_tr_b16 a[74:75], v25 offset:38784
    v_mfma_f32_16x16x32_bf16 v[88:91], a[24:27], a[12:15], v[88:91]
    ds_read_b64_tr_b16 a[76:77], v25 offset:38304
    v_mfma_f32_16x16x32_bf16 v[92:95], a[28:31], a[0:3], v[92:95]
    ds_read_b64_tr_b16 a[78:79], v25 offset:38816
    ds_read_b128 a[44:47], v23 offset:27648
    v_mfma_f32_16x16x32_bf16 v[96:99], a[28:31], a[4:7], v[96:99]
    buffer_load_dwordx4 v20, s[20:23], s54 offen offset:2048 lds
    v_mfma_f32_16x16x32_bf16 v[100:103], a[28:31], a[8:11], v[100:103]
    s_add_u32 s54, s54, 196608
    v_mfma_f32_16x16x32_bf16 v[104:107], a[28:31], a[12:15], v[104:107]
    ds_read_b128 a[48:51], v23 offset:28672
    ds_read_b64_tr_b16 a[80:81], v25 offset:39296
    v_mfma_f32_16x16x32_bf16 v[156:159], a[28:31], a[16:19], v[156:159]
    s_add_u32 m0, s55, 18432
    v_mfma_f32_16x16x32_bf16 v[108:111], a[32:35], a[0:3], v[108:111]
    buffer_load_dwordx4 v21, s[16:19], s52 offen sc1 lds
    v_mfma_f32_16x16x32_bf16 v[112:115], a[32:35], a[4:7], v[112:115]
    ds_read_b64_tr_b16 a[82:83], v25 offset:39808
    v_mfma_f32_16x16x32_bf16 v[116:119], a[32:35], a[8:11], v[116:119]
    ds_read_b128 a[52:55], v23 offset:29952
    ds_read_b128 a[56:59], v23 offset:30976
    v_mfma_f32_16x16x32_bf16 v[120:123], a[32:35], a[12:15], v[120:123]
    ds_read_b64_tr_b16 a[84:85], v25 offset:39328
    v_mfma_f32_16x16x32_bf16 v[160:163], a[32:35], a[16:19], v[160:163]
    buffer_load_dwordx4 v21, s[16:19], s52 offen offset:1024 sc1 lds
    v_mfma_f32_16x16x32_bf16 v[124:127], a[0:3], a[36:39], v[124:127]
    ds_read_b64_tr_b16 a[86:87], v25 offset:39840
    v_mfma_f32_16x16x32_bf16 v[128:131], a[4:7], a[36:39], v[128:131]
    ds_read_b128 a[60:63], v24 offset:29696
    v_mfma_f32_16x16x32_bf16 v[132:135], a[8:11], a[36:39], v[132:135]
    v_mfma_f32_16x16x32_bf16 v[136:139], a[12:15], a[36:39], v[136:139]
    buffer_load_dword v22, s[16:19], s52 offen offset:2048 sc1 lds
    v_mfma_f32_16x16x32_bf16 v[140:143], a[0:3], a[40:43], v[140:143]
    s_add_u32 s52, s52, 0x20000
    v_mfma_f32_16x16x32_bf16 v[144:147], a[4:7], a[40:43], v[144:147]
    v_mfma_f32_16x16x32_bf16 v[148:151], a[8:11], a[40:43], v[148:151]
    v_mfma_f32_16x16x32_bf16 v[152:155], a[12:15], a[40:43], v[152:155]
    s_waitcnt lgkmcnt(0)
    s_waitcnt vmcnt(21)
    s_barrier
    v_mfma_f32_16x16x32_bf16 v[60:63], a[64:67], a[44:47], v[60:63]
    s_add_u32 m0, s56, 103808
    ds_read_b64_tr_b16 a[20:21], v25 offset:49664
    v_mfma_f32_16x16x32_bf16 v[64:67], a[64:67], a[48:51], v[64:67]
    buffer_load_dwordx4 v18, s[20:23], s54 offen lds
    v_mfma_f32_16x16x32_bf16 v[68:71], a[64:67], a[52:55], v[68:71]
    ds_read_b64_tr_b16 a[22:23], v25 offset:50176
    v_mfma_f32_16x16x32_bf16 v[72:75], a[64:67], a[56:59], v[72:75]
    ds_read_b64_tr_b16 a[24:25], v25 offset:49696
    ds_read_b64_tr_b16 a[26:27], v25 offset:50208
    v_mfma_f32_16x16x32_bf16 v[76:79], a[68:71], a[44:47], v[76:79]
    ds_read_b64_tr_b16 a[28:29], v25 offset:50688
    v_mfma_f32_16x16x32_bf16 v[80:83], a[68:71], a[48:51], v[80:83]
    buffer_load_dwordx4 v19, s[20:23], s54 offen offset:1024 lds
    v_mfma_f32_16x16x32_bf16 v[84:87], a[68:71], a[52:55], v[84:87]
    ds_read_b64_tr_b16 a[30:31], v25 offset:51200
    v_mfma_f32_16x16x32_bf16 v[88:91], a[68:71], a[56:59], v[88:91]
    ds_read_b64_tr_b16 a[32:33], v25 offset:50720
    v_mfma_f32_16x16x32_bf16 v[92:95], a[72:75], a[44:47], v[92:95]
    ds_read_b64_tr_b16 a[34:35], v25 offset:51232
    ds_read_b128 a[0:3], v23 offset:36864
    v_mfma_f32_16x16x32_bf16 v[96:99], a[72:75], a[48:51], v[96:99]
    buffer_load_dwordx4 v20, s[20:23], s54 offen offset:2048 lds
    v_mfma_f32_16x16x32_bf16 v[100:103], a[72:75], a[52:55], v[100:103]
    s_add_u32 s54, s54, 196608
    v_mfma_f32_16x16x32_bf16 v[104:107], a[72:75], a[56:59], v[104:107]
    ds_read_b128 a[4:7], v23 offset:37888
    ds_read_b64_tr_b16 a[36:37], v25 offset:51712
    v_mfma_f32_16x16x32_bf16 v[156:159], a[72:75], a[60:63], v[156:159]
    s_add_u32 m0, s55, 27648
    v_mfma_f32_16x16x32_bf16 v[108:111], a[76:79], a[44:47], v[108:111]
    buffer_load_dwordx4 v21, s[16:19], s52 offen sc1 lds
    v_mfma_f32_16x16x32_bf16 v[112:115], a[76:79], a[48:51], v[112:115]
    ds_read_b64_tr_b16 a[38:39], v25 offset:52224
    v_mfma_f32_16x16x32_bf16 v[116:119], a[76:79], a[52:55], v[116:119]
    ds_read_b128 a[8:11], v23 offset:39168
    ds_read_b128 a[12:15], v23 offset:40192
    v_mfma_f32_16x16x32_bf16 v[120:123], a[76:79], a[56:59], v[120:123]
    ds_read_b64_tr_b16 a[40:41], v25 offset:51744
    v_mfma_f32_16x16x32_bf16 v[160:163], a[76:79], a[60:63], v[160:163]
    buffer_load_dwordx4 v21, s[16:19], s52 offen offset:1024 sc1 lds
    v_mfma_f32_16x16x32_bf16 v[124:127], a[44:47], a[80:83], v[124:127]
    ds_read_b64_tr_b16 a[42:43], v25 offset:52256
    v_mfma_f32_16x16x32_bf16 v[128:131], a[48:51], a[80:83], v[128:131]
    ds_read_b128 a[16:19], v24 offset:38912
    v_mfma_f32_16x16x32_bf16 v[132:135], a[52:55], a[80:83], v[132:135]
    v_mfma_f32_16x16x32_bf16 v[136:139], a[56:59], a[80:83], v[136:139]
    buffer_load_dword v22, s[16:19], s52 offen offset:2048 sc1 lds
    v_mfma_f32_16x16x32_bf16 v[140:143], a[44:47], a[84:87], v[140:143]
    s_add_u32 s52, s52, 0x20000
    v_mfma_f32_16x16x32_bf16 v[144:147], a[48:51], a[84:87], v[144:147]
    v_mfma_f32_16x16x32_bf16 v[148:151], a[52:55], a[84:87], v[148:151]
    v_mfma_f32_16x16x32_bf16 v[152:155], a[56:59], a[84:87], v[152:155]
    s_waitcnt lgkmcnt(0)
    s_waitcnt vmcnt(24)
    s_barrier
    v_mfma_f32_16x16x32_bf16 v[60:63], a[20:23], a[0:3], v[60:63]
    s_add_u32 m0, s56, 116224
    ds_read_b64_tr_b16 a[64:65], v25 offset:62080
    v_mfma_f32_16x16x32_bf16 v[64:67], a[20:23], a[4:7], v[64:67]
    buffer_load_dwordx4 v18, s[20:23], s54 offen lds
    v_mfma_f32_16x16x32_bf16 v[68:71], a[20:23], a[8:11], v[68:71]
    ds_read_b64_tr_b16 a[66:67], v25 offset:62592
    v_mfma_f32_16x16x32_bf16 v[72:75], a[20:23], a[12:15], v[72:75]
    ds_read_b64_tr_b16 a[68:69], v25 offset:62112
    ds_read_b64_tr_b16 a[70:71], v25 offset:62624
    v_mfma_f32_16x16x32_bf16 v[76:79], a[24:27], a[0:3], v[76:79]
    ds_read_b64_tr_b16 a[72:73], v25 offset:63104
    v_mfma_f32_16x16x32_bf16 v[80:83], a[24:27], a[4:7], v[80:83]
    buffer_load_dwordx4 v19, s[20:23], s54 offen offset:1024 lds
    v_mfma_f32_16x16x32_bf16 v[84:87], a[24:27], a[8:11], v[84:87]
    ds_read_b64_tr_b16 a[74:75], v25 offset:63616
    v_mfma_f32_16x16x32_bf16 v[88:91], a[24:27], a[12:15], v[88:91]
    ds_read_b64_tr_b16 a[76:77], v25 offset:63136
    v_mfma_f32_16x16x32_bf16 v[92:95], a[28:31], a[0:3], v[92:95]
    ds_read_b64_tr_b16 a[78:79], v25 offset:63648
    ds_read_b128 a[44:47], v23 offset:46080
    v_mfma_f32_16x16x32_bf16 v[96:99], a[28:31], a[4:7], v[96:99]
    buffer_load_dwordx4 v20, s[20:23], s54 offen offset:2048 lds
    v_mfma_f32_16x16x32_bf16 v[100:103], a[28:31], a[8:11], v[100:103]
    s_add_u32 s54, s54, 196608
    v_mfma_f32_16x16x32_bf16 v[104:107], a[28:31], a[12:15], v[104:107]
    ds_read_b128 a[48:51], v23 offset:47104
    ds_read_b64_tr_b16 a[80:81], v25 offset:64128
    v_mfma_f32_16x16x32_bf16 v[156:159], a[28:31], a[16:19], v[156:159]
    s_add_u32 m0, s55, 36864
    v_mfma_f32_16x16x32_bf16 v[108:111], a[32:35], a[0:3], v[108:111]
    buffer_load_dwordx4 v21, s[16:19], s52 offen sc1 lds
    v_mfma_f32_16x16x32_bf16 v[112:115], a[32:35], a[4:7], v[112:115]
    ds_read_b64_tr_b16 a[82:83], v25 offset:64640
    v_mfma_f32_16x16x32_bf16 v[116:119], a[32:35], a[8:11], v[116:119]
    ds_read_b128 a[52:55], v23 offset:48384
    ds_read_b128 a[56:59], v23 offset:49408
    v_mfma_f32_16x16x32_bf16 v[120:123], a[32:35], a[12:15], v[120:123]
    ds_read_b64_tr_b16 a[84:85], v25 offset:64160
    v_mfma_f32_16x16x32_bf16 v[160:163], a[32:35], a[16:19], v[160:163]
    buffer_load_dwordx4 v21, s[16:19], s52 offen offset:1024 sc1 lds
    v_mfma_f32_16x16x32_bf16 v[124:127], a[0:3], a[36:39], v[124:127]
    ds_read_b64_tr_b16 a[86:87], v25 offset:64672
    v_mfma_f32_16x16x32_bf16 v[128:131], a[4:7], a[36:39], v[128:131]
    ds_read_b128 a[60:63], v24 offset:48128
    v_mfma_f32_16x16x32_bf16 v[132:135], a[8:11], a[36:39], v[132:135]
    v_mfma_f32_16x16x32_bf16 v[136:139], a[12:15], a[36:39], v[136:139]
    buffer_load_dword v22, s[16:19], s52 offen offset:2048 sc1 lds
    v_mfma_f32_16x16x32_bf16 v[140:143], a[0:3], a[40:43], v[140:143]
    s_add_u32 s52, s52, 0x20000
    v_mfma_f32_16x16x32_bf16 v[144:147], a[4:7], a[40:43], v[144:147]
    v_mfma_f32_16x16x32_bf16 v[148:151], a[8:11], a[40:43], v[148:151]
    v_mfma_f32_16x16x32_bf16 v[152:155], a[12:15], a[40:43], v[152:155]
    s_waitcnt lgkmcnt(0)
    s_waitcnt vmcnt(24)
    s_barrier
    v_mfma_f32_16x16x32_bf16 v[60:63], a[64:67], a[44:47], v[60:63]
    s_add_u32 m0, s56, 128640
    ds_read_b64_tr_b16 a[20:21], v25 offset:0
    v_mfma_f32_16x16x32_bf16 v[64:67], a[64:67], a[48:51], v[64:67]
    buffer_load_dwordx4 v18, s[20:23], s54 offen lds
    v_mfma_f32_16x16x32_bf16 v[68:71], a[64:67], a[52:55], v[68:71]
    ds_read_b64_tr_b16 a[22:23], v25 offset:512
    v_mfma_f32_16x16x32_bf16 v[72:75], a[64:67], a[56:59], v[72:75]
    ds_read_b64_tr_b16 a[24:25], v25 offset:32
    ds_read_b64_tr_b16 a[26:27], v25 offset:544
    v_mfma_f32_16x16x32_bf16 v[76:79], a[68:71], a[44:47], v[76:79]
    ds_read_b64_tr_b16 a[28:29], v25 offset:1024
    v_mfma_f32_16x16x32_bf16 v[80:83], a[68:71], a[48:51], v[80:83]
    buffer_load_dwordx4 v19, s[20:23], s54 offen offset:1024 lds
    v_mfma_f32_16x16x32_bf16 v[84:87], a[68:71], a[52:55], v[84:87]
    ds_read_b64_tr_b16 a[30:31], v25 offset:1536
    v_mfma_f32_16x16x32_bf16 v[88:91], a[68:71], a[56:59], v[88:91]
    ds_read_b64_tr_b16 a[32:33], v25 offset:1056
    v_mfma_f32_16x16x32_bf16 v[92:95], a[72:75], a[44:47], v[92:95]
    ds_read_b64_tr_b16 a[34:35], v25 offset:1568
    ds_read_b128 a[0:3], v23 offset:0
    v_mfma_f32_16x16x32_bf16 v[96:99], a[72:75], a[48:51], v[96:99]
    buffer_load_dwordx4 v20, s[20:23], s54 offen offset:2048 lds
    v_mfma_f32_16x16x32_bf16 v[100:103], a[72:75], a[52:55], v[100:103]
    s_add_u32 s54, s54, 196608
    v_mfma_f32_16x16x32_bf16 v[104:107], a[72:75], a[56:59], v[104:107]
    ds_read_b128 a[4:7], v23 offset:1024
    ds_read_b64_tr_b16 a[36:37], v25 offset:2048
    v_mfma_f32_16x16x32_bf16 v[156:159], a[72:75], a[60:63], v[156:159]
    s_add_u32 m0, s55, 46080
    v_mfma_f32_16x16x32_bf16 v[108:111], a[76:79], a[44:47], v[108:111]
    buffer_load_dwordx4 v21, s[16:19], s52 offen sc1 lds
    v_mfma_f32_16x16x32_bf16 v[112:115], a[76:79], a[48:51], v[112:115]
    ds_read_b64_tr_b16 a[38:39], v25 offset:2560
    v_mfma_f32_16x16x32_bf16 v[116:119], a[76:79], a[52:55], v[116:119]
    ds_read_b128 a[8:11], v23 offset:2304
    ds_read_b128 a[12:15], v23 offset:3328
    v_mfma_f32_16x16x32_bf16 v[120:123], a[76:79], a[56:59], v[120:123]
    ds_read_b64_tr_b16 a[40:41], v25 offset:2080
    v_mfma_f32_16x16x32_bf16 v[160:163], a[76:79], a[60:63], v[160:163]
    buffer_load_dwordx4 v21, s[16:19], s52 offen offset:1024 sc1 lds
    v_mfma_f32_16x16x32_bf16 v[124:127], a[44:47], a[80:83], v[124:127]
    ds_read_b64_tr_b16 a[42:43], v25 offset:2592
    v_mfma_f32_16x16x32_bf16 v[128:131], a[48:51], a[80:83], v[128:131]
    ds_read_b128 a[16:19], v24 offset:2048
    v_mfma_f32_16x16x32_bf16 v[132:135], a[52:55], a[80:83], v[132:135]
    v_mfma_f32_16x16x32_bf16 v[136:139], a[56:59], a[80:83], v[136:139]
    buffer_load_dword v22, s[16:19], s52 offen offset:2048 sc1 lds
    v_mfma_f32_16x16x32_bf16 v[140:143], a[44:47], a[84:87], v[140:143]
    s_add_u32 s52, s52, 0x20000
    v_mfma_f32_16x16x32_bf16 v[144:147], a[48:51], a[84:87], v[144:147]
    v_mfma_f32_16x16x32_bf16 v[148:151], a[52:55], a[84:87], v[148:151]
    v_mfma_f32_16x16x32_bf16 v[152:155], a[56:59], a[84:87], v[152:155]
    s_sub_u32 s15, s15, 1
    s_cmp_lg_u32 s15, 0
    s_cbranch_scc1 .Lqk10
    s_cmp_lg_u32 s14, 0
    s_cbranch_scc1 .Ll011
    v_add_f32 v200, v200, v201
    v_add_f32 v200, v200, v202
    v_add_f32 v200, v200, v203
    v_add_f32 v200, v200, v204
    v_add_f32 v200, v200, v205
    v_add_f32 v200, v200, v206
    v_add_f32 v200, v200, v207
    v_add_f32 v200, v200, v208
    v_add_f32 v200, v200, v209
    v_add_f32 v200, v200, v210
    v_add_f32 v200, v200, v211
    v_add_f32 v200, v200, v212
    v_add_f32 v200, v200, v213
    v_add_f32 v200, v200, v214
    v_add_f32 v200, v200, v215
    v_min_u32 v2, 191, v0
    v_lshlrev_b32 v2, 2, v2
    v_add_u32 v2, 156160, v2
    ds_write_b32 v2, v200
.Ll011:

    s_waitcnt lgkmcnt(0)
    s_waitcnt vmcnt(24)
    s_barrier
    v_mfma_f32_16x16x32_bf16 v[60:63], a[20:23], a[0:3], v[60:63]
    s_add_u32 m0, s56, 66560
    ds_read_b64_tr_b16 a[64:65], v25 offset:12416
    v_mfma_f32_16x16x32_bf16 v[64:67], a[20:23], a[4:7], v[64:67]
    buffer_load_dwordx4 v18, s[20:23], s54 offen lds
    v_mfma_f32_16x16x32_bf16 v[68:71], a[20:23], a[8:11], v[68:71]
    ds_read_b64_tr_b16 a[66:67], v25 offset:12928
    ds_read_b64_tr_b16 a[68:69], v25 offset:12448
    v_mfma_f32_16x16x32_bf16 v[72:75], a[20:23], a[12:15], v[72:75]
    buffer_load_dwordx4 v19, s[20:23], s54 offen offset:1024 lds
    v_mfma_f32_16x16x32_bf16 v[76:79], a[24:27], a[0:3], v[76:79]
    ds_read_b64_tr_b16 a[70:71], v25 offset:12960
    ds_read_b64_tr_b16 a[72:73], v25 offset:13440
    v_mfma_f32_16x16x32_bf16 v[80:83], a[24:27], a[4:7], v[80:83]
    ds_read_b64_tr_b16 a[74:75], v25 offset:13952
    ds_read_b64_tr_b16 a[76:77], v25 offset:13472
    v_mfma_f32_16x16x32_bf16 v[84:87], a[24:27], a[8:11], v[84:87]
    buffer_load_dwordx4 v20, s[20:23], s54 offen offset:2048 lds
    v_mfma_f32_16x16x32_bf16 v[88:91], a[24:27], a[12:15], v[88:91]
    s_add_u32 s54, s54, 196608
    s_add_u32 m0, s55, 0
    v_mfma_f32_16x16x32_bf16 v[92:95], a[28:31], a[0:3], v[92:95]
    buffer_load_dwordx4 v21, s[16:19], s52 offen sc1 lds
    v_mfma_f32_16x16x32_bf16 v[96:99], a[28:31], a[4:7], v[96:99]
    ds_read_b64_tr_b16 a[78:79], v25 offset:13984
    ds_read_b128 a[44:47], v23 offset:9216
    v_mfma_f32_16x16x32_bf16 v[100:103], a[28:31], a[8:11], v[100:103]
    ds_read_b128 a[48:51], v23 offset:10240
    ds_read_b64_tr_b16 a[80:81], v25 offset:14464
    v_mfma_f32_16x16x32_bf16 v[104:107], a[28:31], a[12:15], v[104:107]
    buffer_load_dwordx4 v21, s[16:19], s52 offen offset:1024 sc1 lds
    v_mfma_f32_16x16x32_bf16 v[156:159], a[28:31], a[16:19], v[156:159]
    ds_read_b64_tr_b16 a[82:83], v25 offset:14976
    ds_read_b128 a[52:55], v23 offset:11520
    v_mfma_f32_16x16x32_bf16 v[108:111], a[32:35], a[0:3], v[108:111]
    buffer_load_dword v22, s[16:19], s52 offen offset:2048 sc1 lds
    v_mfma_f32_16x16x32_bf16 v[112:115], a[32:35], a[4:7], v[112:115]
    s_add_u32 s52, s52, 0x20000
    ds_read_b128 a[56:59], v23 offset:12544
    v_mfma_f32_16x16x32_bf16 v[116:119], a[32:35], a[8:11], v[116:119]
    s_add_u32 s67, s14, 29360128
    ds_read_b64_tr_b16 a[84:85], v25 offset:14496
    v_mfma_f32_16x16x32_bf16 v[120:123], a[32:35], a[12:15], v[120:123]
    buffer_load_dwordx2 v[164:165], v26, s[16:19], s67 offen sc1
    v_mfma_f32_16x16x32_bf16 v[160:163], a[32:35], a[16:19], v[160:163]
    s_add_u32 s67, s14, 29376512
    ds_read_b64_tr_b16 a[86:87], v25 offset:15008
    v_mfma_f32_16x16x32_bf16 v[124:127], a[0:3], a[36:39], v[124:127]
    buffer_load_dwordx2 v[166:167], v26, s[16:19], s67 offen sc1
    v_mfma_f32_16x16x32_bf16 v[128:131], a[4:7], a[36:39], v[128:131]
    ds_read_b128 a[60:63], v24 offset:11264
    v_mfma_f32_16x16x32_bf16 v[132:135], a[8:11], a[36:39], v[132:135]
    s_add_u32 s67, s14, 29392896
    v_mfma_f32_16x16x32_bf16 v[136:139], a[12:15], a[36:39], v[136:139]
    buffer_load_dwordx2 v[168:169], v26, s[16:19], s67 offen sc1
    v_mfma_f32_16x16x32_bf16 v[140:143], a[0:3], a[40:43], v[140:143]
    s_add_u32 s67, s14, 29409280
    v_mfma_f32_16x16x32_bf16 v[144:147], a[4:7], a[40:43], v[144:147]
    buffer_load_dwordx2 v[170:171], v26, s[16:19], s67 offen sc1
    v_mfma_f32_16x16x32_bf16 v[148:151], a[8:11], a[40:43], v[148:151]
    v_mfma_f32_16x16x32_bf16 v[152:155], a[12:15], a[40:43], v[152:155]
    s_waitcnt lgkmcnt(0)
    s_waitcnt vmcnt(28)
    s_barrier
    v_mfma_f32_16x16x32_bf16 v[60:63], a[64:67], a[44:47], v[60:63]
    s_add_u32 m0, s56, 78976
    ds_read_b64_tr_b16 a[20:21], v25 offset:24832
    v_mfma_f32_16x16x32_bf16 v[64:67], a[64:67], a[48:51], v[64:67]
    buffer_load_dwordx4 v18, s[20:23], s54 offen lds
    v_mfma_f32_16x16x32_bf16 v[68:71], a[64:67], a[52:55], v[68:71]
    ds_read_b64_tr_b16 a[22:23], v25 offset:25344
    ds_read_b64_tr_b16 a[24:25], v25 offset:24864
    v_mfma_f32_16x16x32_bf16 v[72:75], a[64:67], a[56:59], v[72:75]
    buffer_load_dwordx4 v19, s[20:23], s54 offen offset:1024 lds
    v_mfma_f32_16x16x32_bf16 v[76:79], a[68:71], a[44:47], v[76:79]
    ds_read_b64_tr_b16 a[26:27], v25 offset:25376
    ds_read_b64_tr_b16 a[28:29], v25 offset:25856
    v_mfma_f32_16x16x32_bf16 v[80:83], a[68:71], a[48:51], v[80:83]
    ds_read_b64_tr_b16 a[30:31], v25 offset:26368
    ds_read_b64_tr_b16 a[32:33], v25 offset:25888
    v_mfma_f32_16x16x32_bf16 v[84:87], a[68:71], a[52:55], v[84:87]
    buffer_load_dwordx4 v20, s[20:23], s54 offen offset:2048 lds
    v_mfma_f32_16x16x32_bf16 v[88:91], a[68:71], a[56:59], v[88:91]
    s_add_u32 s54, s54, 196608
    s_add_u32 m0, s55, 9216
    v_mfma_f32_16x16x32_bf16 v[92:95], a[72:75], a[44:47], v[92:95]
    buffer_load_dwordx4 v21, s[16:19], s52 offen sc1 lds
    v_mfma_f32_16x16x32_bf16 v[96:99], a[72:75], a[48:51], v[96:99]
    ds_read_b64_tr_b16 a[34:35], v25 offset:26400
    ds_read_b128 a[0:3], v23 offset:18432
    v_mfma_f32_16x16x32_bf16 v[100:103], a[72:75], a[52:55], v[100:103]
    ds_read_b128 a[4:7], v23 offset:19456
    ds_read_b64_tr_b16 a[36:37], v25 offset:26880
    v_mfma_f32_16x16x32_bf16 v[104:107], a[72:75], a[56:59], v[104:107]
    buffer_load_dwordx4 v21, s[16:19], s52 offen offset:1024 sc1 lds
    v_mfma_f32_16x16x32_bf16 v[156:159], a[72:75], a[60:63], v[156:159]
    ds_read_b64_tr_b16 a[38:39], v25 offset:27392
    ds_read_b128 a[8:11], v23 offset:20736
    v_mfma_f32_16x16x32_bf16 v[108:111], a[76:79], a[44:47], v[108:111]
    buffer_load_dword v22, s[16:19], s52 offen offset:2048 sc1 lds
    v_mfma_f32_16x16x32_bf16 v[112:115], a[76:79], a[48:51], v[112:115]
    s_add_u32 s52, s52, 0x20000
    ds_read_b128 a[12:15], v23 offset:21760
    v_mfma_f32_16x16x32_bf16 v[116:119], a[76:79], a[52:55], v[116:119]
    s_add_u32 s67, s14, 29425664
    ds_read_b64_tr_b16 a[40:41], v25 offset:26912
    v_mfma_f32_16x16x32_bf16 v[120:123], a[76:79], a[56:59], v[120:123]
    buffer_load_dwordx2 v[172:173], v26, s[16:19], s67 offen sc1
    v_mfma_f32_16x16x32_bf16 v[160:163], a[76:79], a[60:63], v[160:163]
    s_add_u32 s67, s14, 29442048
    ds_read_b64_tr_b16 a[42:43], v25 offset:27424
    v_mfma_f32_16x16x32_bf16 v[124:127], a[44:47], a[80:83], v[124:127]
    buffer_load_dwordx2 v[174:175], v26, s[16:19], s67 offen sc1
    v_mfma_f32_16x16x32_bf16 v[128:131], a[48:51], a[80:83], v[128:131]
    ds_read_b128 a[16:19], v24 offset:20480
    v_mfma_f32_16x16x32_bf16 v[132:135], a[52:55], a[80:83], v[132:135]
    s_add_u32 s67, s14, 29458432
    v_mfma_f32_16x16x32_bf16 v[136:139], a[56:59], a[80:83], v[136:139]
    buffer_load_dwordx2 v[176:177], v26, s[16:19], s67 offen sc1
    v_mfma_f32_16x16x32_bf16 v[140:143], a[44:47], a[84:87], v[140:143]
    s_add_u32 s67, s14, 29474816
    v_mfma_f32_16x16x32_bf16 v[144:147], a[48:51], a[84:87], v[144:147]
    buffer_load_dwordx2 v[178:179], v26, s[16:19], s67 offen sc1
    v_mfma_f32_16x16x32_bf16 v[148:151], a[52:55], a[84:87], v[148:151]
    v_mfma_f32_16x16x32_bf16 v[152:155], a[56:59], a[84:87], v[152:155]
    s_waitcnt lgkmcnt(0)
    s_waitcnt vmcnt(32)
    s_barrier
    v_mfma_f32_16x16x32_bf16 v[60:63], a[20:23], a[0:3], v[60:63]
    s_add_u32 s67, s14, 29491200
    ds_read_b64_tr_b16 a[64:65], v25 offset:37248
    v_mfma_f32_16x16x32_bf16 v[64:67], a[20:23], a[4:7], v[64:67]
    buffer_load_dwordx2 v[180:181], v26, s[16:19], s67 offen sc1
    ds_read_b64_tr_b16 a[66:67], v25 offset:37760
    v_mfma_f32_16x16x32_bf16 v[68:71], a[20:23], a[8:11], v[68:71]
    s_add_u32 s67, s14, 29507584
    ds_read_b64_tr_b16 a[68:69], v25 offset:37280
    v_mfma_f32_16x16x32_bf16 v[72:75], a[20:23], a[12:15], v[72:75]
    buffer_load_dwordx2 v[182:183], v26, s[16:19], s67 offen sc1
    v_mfma_f32_16x16x32_bf16 v[76:79], a[24:27], a[0:3], v[76:79]
    ds_read_b64_tr_b16 a[70:71], v25 offset:37792
    ds_read_b64_tr_b16 a[72:73], v25 offset:38272
    v_mfma_f32_16x16x32_bf16 v[80:83], a[24:27], a[4:7], v[80:83]
    s_add_u32 s67, s14, 29523968
    ds_read_b64_tr_b16 a[74:75], v25 offset:38784
    v_mfma_f32_16x16x32_bf16 v[84:87], a[24:27], a[8:11], v[84:87]
    buffer_load_dwordx2 v[184:185], v26, s[16:19], s67 offen sc1
    v_mfma_f32_16x16x32_bf16 v[88:91], a[24:27], a[12:15], v[88:91]
    s_add_u32 s67, s14, 29540352
    ds_read_b64_tr_b16 a[76:77], v25 offset:38304
    v_mfma_f32_16x16x32_bf16 v[92:95], a[28:31], a[0:3], v[92:95]
    buffer_load_dwordx2 v[186:187], v26, s[16:19], s67 offen sc1
    ds_read_b64_tr_b16 a[78:79], v25 offset:38816
    v_mfma_f32_16x16x32_bf16 v[96:99], a[28:31], a[4:7], v[96:99]
    ds_read_b128 a[44:47], v23 offset:27648
    v_mfma_f32_16x16x32_bf16 v[100:103], a[28:31], a[8:11], v[100:103]
    s_add_u32 s67, s14, 29556736
    ds_read_b128 a[48:51], v23 offset:28672
    v_mfma_f32_16x16x32_bf16 v[104:107], a[28:31], a[12:15], v[104:107]
    buffer_load_dwordx2 v[188:189], v26, s[16:19], s67 offen sc1
    v_mfma_f32_16x16x32_bf16 v[156:159], a[28:31], a[16:19], v[156:159]
    s_add_u32 s67, s14, 29573120
    ds_read_b64_tr_b16 a[80:81], v25 offset:39296
    v_mfma_f32_16x16x32_bf16 v[108:111], a[32:35], a[0:3], v[108:111]
    buffer_load_dwordx2 v[190:191], v26, s[16:19], s67 offen sc1
    ds_read_b64_tr_b16 a[82:83], v25 offset:39808
    v_mfma_f32_16x16x32_bf16 v[112:115], a[32:35], a[4:7], v[112:115]
    ds_read_b128 a[52:55], v23 offset:29952
    v_mfma_f32_16x16x32_bf16 v[116:119], a[32:35], a[8:11], v[116:119]
    s_add_u32 s67, s14, 29589504
    ds_read_b128 a[56:59], v23 offset:30976
    v_mfma_f32_16x16x32_bf16 v[120:123], a[32:35], a[12:15], v[120:123]
    buffer_load_dwordx2 v[192:193], v26, s[16:19], s67 offen sc1
    ds_read_b64_tr_b16 a[84:85], v25 offset:39328
    v_mfma_f32_16x16x32_bf16 v[160:163], a[32:35], a[16:19], v[160:163]
    s_add_u32 s67, s14, 29605888
    ds_read_b64_tr_b16 a[86:87], v25 offset:39840
    v_mfma_f32_16x16x32_bf16 v[124:127], a[0:3], a[36:39], v[124:127]
    buffer_load_dwordx2 v[194:195], v26, s[16:19], s67 offen sc1
    v_mfma_f32_16x16x32_bf16 v[128:131], a[4:7], a[36:39], v[128:131]
    ds_read_b128 a[60:63], v24 offset:29696
    v_mfma_f32_16x16x32_bf16 v[132:135], a[8:11], a[36:39], v[132:135]
    s_add_u32 m0, s59, 58240
    s_mov_b32 s58, 1966080
    v_mfma_f32_16x16x32_bf16 v[136:139], a[12:15], a[36:39], v[136:139]
    buffer_load_dwordx4 v5, s[24:27], s58 offen lds
    v_mfma_f32_16x16x32_bf16 v[140:143], a[0:3], a[40:43], v[140:143]
    v_mfma_f32_16x16x32_bf16 v[144:147], a[4:7], a[40:43], v[144:147]
    buffer_load_dwordx4 v6, s[24:27], s58 offen offset:1024 lds
    v_mfma_f32_16x16x32_bf16 v[148:151], a[8:11], a[40:43], v[148:151]
    v_mfma_f32_16x16x32_bf16 v[152:155], a[12:15], a[40:43], v[152:155]
    s_waitcnt lgkmcnt(0)
    s_waitcnt vmcnt(36)
    s_barrier
    v_mfma_f32_16x16x32_bf16 v[60:63], a[64:67], a[44:47], v[60:63]
    s_add_u32 m0, s59, 91520
    s_mov_b32 s58, 393216
    v_mfma_f32_16x16x32_bf16 v[64:67], a[64:67], a[48:51], v[64:67]
    buffer_load_dwordx4 v5, s[24:27], s58 offen lds
    v_mfma_f32_16x16x32_bf16 v[68:71], a[64:67], a[52:55], v[68:71]
    ds_read_b64_tr_b16 a[20:21], v25 offset:49664
    ds_read_b64_tr_b16 a[22:23], v25 offset:50176
    v_mfma_f32_16x16x32_bf16 v[72:75], a[64:67], a[56:59], v[72:75]
    ds_read_b64_tr_b16 a[24:25], v25 offset:49696
    v_mfma_f32_16x16x32_bf16 v[76:79], a[68:71], a[44:47], v[76:79]
    ds_read_b64_tr_b16 a[26:27], v25 offset:50208
    ds_read_b64_tr_b16 a[28:29], v25 offset:50688
    v_mfma_f32_16x16x32_bf16 v[80:83], a[68:71], a[48:51], v[80:83]
    buffer_load_dwordx4 v6, s[24:27], s58 offen offset:1024 lds
    v_mfma_f32_16x16x32_bf16 v[84:87], a[68:71], a[52:55], v[84:87]
    ds_read_b64_tr_b16 a[30:31], v25 offset:51200
    v_mfma_f32_16x16x32_bf16 v[88:91], a[68:71], a[56:59], v[88:91]
    ds_read_b64_tr_b16 a[32:33], v25 offset:50720
    ds_read_b64_tr_b16 a[34:35], v25 offset:51232
    v_mfma_f32_16x16x32_bf16 v[92:95], a[72:75], a[44:47], v[92:95]
    s_add_u32 m0, s59, 24960
    s_mov_b32 s58, 1441792
    v_mfma_f32_16x16x32_bf16 v[96:99], a[72:75], a[48:51], v[96:99]
    buffer_load_dwordx4 v5, s[24:27], s58 offen lds
    v_mfma_f32_16x16x32_bf16 v[100:103], a[72:75], a[52:55], v[100:103]
    ds_read_b128 a[0:3], v23 offset:36864
    v_mfma_f32_16x16x32_bf16 v[104:107], a[72:75], a[56:59], v[104:107]
    ds_read_b128 a[4:7], v23 offset:37888
    v_mfma_f32_16x16x32_bf16 v[156:159], a[72:75], a[60:63], v[156:159]
    ds_read_b64_tr_b16 a[36:37], v25 offset:51712
    ds_read_b64_tr_b16 a[38:39], v25 offset:52224
    v_mfma_f32_16x16x32_bf16 v[108:111], a[76:79], a[44:47], v[108:111]
    buffer_load_dwordx4 v6, s[24:27], s58 offen offset:1024 lds
    v_mfma_f32_16x16x32_bf16 v[112:115], a[76:79], a[48:51], v[112:115]
    ds_read_b128 a[8:11], v23 offset:39168
    v_mfma_f32_16x16x32_bf16 v[116:119], a[76:79], a[52:55], v[116:119]
    ds_read_b128 a[12:15], v23 offset:40192
    ds_read_b64_tr_b16 a[40:41], v25 offset:51744
    v_mfma_f32_16x16x32_bf16 v[120:123], a[76:79], a[56:59], v[120:123]
    s_add_u32 m0, s59, 99840
    s_mov_b32 s58, 524288
    v_mfma_f32_16x16x32_bf16 v[160:163], a[76:79], a[60:63], v[160:163]
    buffer_load_dwordx4 v5, s[24:27], s58 offen lds
    v_mfma_f32_16x16x32_bf16 v[124:127], a[44:47], a[80:83], v[124:127]
    ds_read_b64_tr_b16 a[42:43], v25 offset:52256
    v_mfma_f32_16x16x32_bf16 v[128:131], a[48:51], a[80:83], v[128:131]
    ds_read_b128 a[16:19], v24 offset:38912
    v_mfma_f32_16x16x32_bf16 v[132:135], a[52:55], a[80:83], v[132:135]
    v_mfma_f32_16x16x32_bf16 v[136:139], a[56:59], a[80:83], v[136:139]
    buffer_load_dwordx4 v6, s[24:27], s58 offen offset:1024 lds
    v_mfma_f32_16x16x32_bf16 v[140:143], a[44:47], a[84:87], v[140:143]
    v_mfma_f32_16x16x32_bf16 v[144:147], a[48:51], a[84:87], v[144:147]
    v_mfma_f32_16x16x32_bf16 v[148:151], a[52:55], a[84:87], v[148:151]
    v_mfma_f32_16x16x32_bf16 v[152:155], a[56:59], a[84:87], v[152:155]
    s_waitcnt lgkmcnt(0)
    s_waitcnt vmcnt(36)
    s_barrier
    v_mfma_f32_16x16x32_bf16 v[60:63], a[20:23], a[0:3], v[60:63]
    s_add_u32 m0, s59, 33280
    s_mov_b32 s58, 1572864
    v_mfma_f32_16x16x32_bf16 v[64:67], a[20:23], a[4:7], v[64:67]
    buffer_load_dwordx4 v5, s[24:27], s58 offen lds
    v_mfma_f32_16x16x32_bf16 v[68:71], a[20:23], a[8:11], v[68:71]
    ds_read_b64_tr_b16 a[64:65], v25 offset:62080
    ds_read_b64_tr_b16 a[66:67], v25 offset:62592
    v_mfma_f32_16x16x32_bf16 v[72:75], a[20:23], a[12:15], v[72:75]
    ds_read_b64_tr_b16 a[68:69], v25 offset:62112
    v_mfma_f32_16x16x32_bf16 v[76:79], a[24:27], a[0:3], v[76:79]
    ds_read_b64_tr_b16 a[70:71], v25 offset:62624
    ds_read_b64_tr_b16 a[72:73], v25 offset:63104
    v_mfma_f32_16x16x32_bf16 v[80:83], a[24:27], a[4:7], v[80:83]
    buffer_load_dwordx4 v6, s[24:27], s58 offen offset:1024 lds
    v_mfma_f32_16x16x32_bf16 v[84:87], a[24:27], a[8:11], v[84:87]
    ds_read_b64_tr_b16 a[74:75], v25 offset:63616
    v_mfma_f32_16x16x32_bf16 v[88:91], a[24:27], a[12:15], v[88:91]
    ds_read_b64_tr_b16 a[76:77], v25 offset:63136
    ds_read_b64_tr_b16 a[78:79], v25 offset:63648
    v_mfma_f32_16x16x32_bf16 v[92:95], a[28:31], a[0:3], v[92:95]
    s_add_u32 m0, s59, 108160
    s_mov_b32 s58, 655360
    v_mfma_f32_16x16x32_bf16 v[96:99], a[28:31], a[4:7], v[96:99]
    buffer_load_dwordx4 v5, s[24:27], s58 offen lds
    v_mfma_f32_16x16x32_bf16 v[100:103], a[28:31], a[8:11], v[100:103]
    ds_read_b128 a[44:47], v23 offset:46080
    v_mfma_f32_16x16x32_bf16 v[104:107], a[28:31], a[12:15], v[104:107]
    ds_read_b128 a[48:51], v23 offset:47104
    v_mfma_f32_16x16x32_bf16 v[156:159], a[28:31], a[16:19], v[156:159]
    ds_read_b64_tr_b16 a[80:81], v25 offset:64128
    ds_read_b64_tr_b16 a[82:83], v25 offset:64640
    v_mfma_f32_16x16x32_bf16 v[108:111], a[32:35], a[0:3], v[108:111]
    buffer_load_dwordx4 v6, s[24:27], s58 offen offset:1024 lds
    v_mfma_f32_16x16x32_bf16 v[112:115], a[32:35], a[4:7], v[112:115]
    ds_read_b128 a[52:55], v23 offset:48384
    v_mfma_f32_16x16x32_bf16 v[116:119], a[32:35], a[8:11], v[116:119]
    ds_read_b128 a[56:59], v23 offset:49408
    ds_read_b64_tr_b16 a[84:85], v25 offset:64160
    v_mfma_f32_16x16x32_bf16 v[120:123], a[32:35], a[12:15], v[120:123]
    s_add_u32 m0, s59, 116480
    s_mov_b32 s58, 786432
    v_mfma_f32_16x16x32_bf16 v[160:163], a[32:35], a[16:19], v[160:163]
    buffer_load_dwordx4 v5, s[24:27], s58 offen lds
    v_mfma_f32_16x16x32_bf16 v[124:127], a[0:3], a[36:39], v[124:127]
    ds_read_b64_tr_b16 a[86:87], v25 offset:64672
    v_mfma_f32_16x16x32_bf16 v[128:131], a[4:7], a[36:39], v[128:131]
    ds_read_b128 a[60:63], v24 offset:48128
    v_mfma_f32_16x16x32_bf16 v[132:135], a[8:11], a[36:39], v[132:135]
    v_mfma_f32_16x16x32_bf16 v[136:139], a[12:15], a[36:39], v[136:139]
    buffer_load_dwordx4 v6, s[24:27], s58 offen offset:1024 lds
    v_mfma_f32_16x16x32_bf16 v[140:143], a[0:3], a[40:43], v[140:143]
    v_mfma_f32_16x16x32_bf16 v[144:147], a[4:7], a[40:43], v[144:147]
    v_mfma_f32_16x16x32_bf16 v[148:151], a[8:11], a[40:43], v[148:151]
    v_mfma_f32_16x16x32_bf16 v[152:155], a[12:15], a[40:43], v[152:155]
    s_waitcnt lgkmcnt(0)
    s_waitcnt vmcnt(36)
    s_barrier
    v_mfma_f32_16x16x32_bf16 v[60:63], a[64:67], a[44:47], v[60:63]
    s_add_u32 m0, s59, 41600
    s_mov_b32 s58, 1703936
    v_mfma_f32_16x16x32_bf16 v[64:67], a[64:67], a[48:51], v[64:67]
    buffer_load_dwordx4 v5, s[24:27], s58 offen lds
    v_mfma_f32_16x16x32_bf16 v[68:71], a[64:67], a[52:55], v[68:71]
    ds_read_b64_tr_b16 a[20:21], v25 offset:0
    ds_read_b64_tr_b16 a[22:23], v25 offset:512
    v_mfma_f32_16x16x32_bf16 v[72:75], a[64:67], a[56:59], v[72:75]
    ds_read_b64_tr_b16 a[24:25], v25 offset:32
    s_waitcnt vmcnt(22)
    v_pk_add_f32 v[164:165], v[164:165], v[180:181]
    v_mfma_f32_16x16x32_bf16 v[76:79], a[68:71], a[44:47], v[76:79]
    ds_read_b64_tr_b16 a[26:27], v25 offset:544
    ds_read_b64_tr_b16 a[28:29], v25 offset:1024
    v_mfma_f32_16x16x32_bf16 v[80:83], a[68:71], a[48:51], v[80:83]
    buffer_load_dwordx4 v6, s[24:27], s58 offen offset:1024 lds
    v_mfma_f32_16x16x32_bf16 v[84:87], a[68:71], a[52:55], v[84:87]
    ds_read_b64_tr_b16 a[30:31], v25 offset:1536
    s_waitcnt vmcnt(22)
    v_pk_add_f32 v[166:167], v[166:167], v[182:183]
    v_mfma_f32_16x16x32_bf16 v[88:91], a[68:71], a[56:59], v[88:91]
    ds_read_b64_tr_b16 a[32:33], v25 offset:1056
    ds_read_b64_tr_b16 a[34:35], v25 offset:1568
    v_mfma_f32_16x16x32_bf16 v[92:95], a[72:75], a[44:47], v[92:95]
    s_add_u32 m0, s59, 49920
    s_mov_b32 s58, 1835008
    v_mfma_f32_16x16x32_bf16 v[96:99], a[72:75], a[48:51], v[96:99]
    buffer_load_dwordx4 v5, s[24:27], s58 offen lds
    v_mfma_f32_16x16x32_bf16 v[100:103], a[72:75], a[52:55], v[100:103]
    ds_read_b128 a[0:3], v23 offset:0
    s_waitcnt vmcnt(22)
    v_pk_add_f32 v[168:169], v[168:169], v[184:185]
    v_mfma_f32_16x16x32_bf16 v[104:107], a[72:75], a[56:59], v[104:107]
    ds_read_b128 a[4:7], v23 offset:1024
    s_waitcnt vmcnt(21)
    v_pk_add_f32 v[170:171], v[170:171], v[186:187]
    v_mfma_f32_16x16x32_bf16 v[156:159], a[72:75], a[60:63], v[156:159]
    ds_read_b64_tr_b16 a[36:37], v25 offset:2048
    ds_read_b64_tr_b16 a[38:39], v25 offset:2560
    v_mfma_f32_16x16x32_bf16 v[108:111], a[76:79], a[44:47], v[108:111]
    buffer_load_dwordx4 v6, s[24:27], s58 offen offset:1024 lds
    v_mfma_f32_16x16x32_bf16 v[112:115], a[76:79], a[48:51], v[112:115]
    ds_read_b128 a[8:11], v23 offset:2304
    s_waitcnt vmcnt(21)
    v_pk_add_f32 v[172:173], v[172:173], v[188:189]
    v_mfma_f32_16x16x32_bf16 v[116:119], a[76:79], a[52:55], v[116:119]
    ds_read_b128 a[12:15], v23 offset:3328
    ds_read_b64_tr_b16 a[40:41], v25 offset:2080
    v_mfma_f32_16x16x32_bf16 v[120:123], a[76:79], a[56:59], v[120:123]
    s_add_u32 m0, s59, 124800
    s_mov_b32 s58, 917504
    v_mfma_f32_16x16x32_bf16 v[160:163], a[76:79], a[60:63], v[160:163]
    buffer_load_dwordx4 v5, s[24:27], s58 offen lds
    v_mfma_f32_16x16x32_bf16 v[124:127], a[44:47], a[80:83], v[124:127]
    ds_read_b64_tr_b16 a[42:43], v25 offset:2592
    s_waitcnt vmcnt(21)
    v_pk_add_f32 v[174:175], v[174:175], v[190:191]
    v_mfma_f32_16x16x32_bf16 v[128:131], a[48:51], a[80:83], v[128:131]
    ds_read_b128 a[16:19], v24 offset:2048
    s_waitcnt vmcnt(20)
    v_pk_add_f32 v[176:177], v[176:177], v[192:193]
    v_mfma_f32_16x16x32_bf16 v[132:135], a[52:55], a[80:83], v[132:135]
    s_waitcnt vmcnt(19)
    v_pk_add_f32 v[178:179], v[178:179], v[194:195]
    v_mfma_f32_16x16x32_bf16 v[136:139], a[56:59], a[80:83], v[136:139]
    buffer_load_dwordx4 v6, s[24:27], s58 offen offset:1024 lds
    v_mfma_f32_16x16x32_bf16 v[140:143], a[44:47], a[84:87], v[140:143]
    v_pk_add_f32 v[164:165], v[164:165], v[172:173]
    v_pk_add_f32 v[166:167], v[166:167], v[174:175]
    v_mfma_f32_16x16x32_bf16 v[144:147], a[48:51], a[84:87], v[144:147]
    v_pk_add_f32 v[168:169], v[168:169], v[176:177]
    v_pk_add_f32 v[170:171], v[170:171], v[178:179]
    v_mfma_f32_16x16x32_bf16 v[148:151], a[52:55], a[84:87], v[148:151]
    v_pk_add_f32 v[164:165], v[164:165], v[168:169]
    v_pk_add_f32 v[166:167], v[166:167], v[170:171]
    v_mfma_f32_16x16x32_bf16 v[152:155], a[56:59], a[84:87], v[152:155]
    v_pk_add_f32 v[164:165], v[164:165], v[166:167]
    s_waitcnt lgkmcnt(0)
    s_barrier
    v_mfma_f32_16x16x32_bf16 v[60:63], a[20:23], a[0:3], v[60:63]
    s_add_u32 m0, s59, 0
    s_mov_b32 s58, 1048576
    v_mfma_f32_16x16x32_bf16 v[64:67], a[20:23], a[4:7], v[64:67]
    buffer_load_dwordx4 v5, s[24:27], s58 offen lds
    v_mfma_f32_16x16x32_bf16 v[68:71], a[20:23], a[8:11], v[68:71]
    ds_read_b64_tr_b16 a[64:65], v25 offset:12416
    ds_read_b64_tr_b16 a[66:67], v25 offset:12928
    v_mfma_f32_16x16x32_bf16 v[72:75], a[20:23], a[12:15], v[72:75]
    ds_read_b64_tr_b16 a[68:69], v25 offset:12448
    v_mul_f32 v164, 0xba800000, v164
    v_mfma_f32_16x16x32_bf16 v[76:79], a[24:27], a[0:3], v[76:79]
    ds_read_b64_tr_b16 a[70:71], v25 offset:12960
    v_mul_f32 v165, 0x3a800000, v165
    v_mfma_f32_16x16x32_bf16 v[80:83], a[24:27], a[4:7], v[80:83]
    ds_read_b64_tr_b16 a[72:73], v25 offset:13440
    v_fma_f32 v165, -v164, v164, v165
    v_mfma_f32_16x16x32_bf16 v[84:87], a[24:27], a[8:11], v[84:87]
    ds_read_b64_tr_b16 a[74:75], v25 offset:13952
    ds_read_b64_tr_b16 a[76:77], v25 offset:13472
    v_mfma_f32_16x16x32_bf16 v[88:91], a[24:27], a[12:15], v[88:91]
    buffer_load_dwordx4 v6, s[24:27], s58 offen offset:1024 lds
    v_mfma_f32_16x16x32_bf16 v[92:95], a[28:31], a[0:3], v[92:95]
    ds_read_b64_tr_b16 a[78:79], v25 offset:13984
    v_mfma_f32_16x16x32_bf16 v[96:99], a[28:31], a[4:7], v[96:99]
    ds_read_b128 a[44:47], v23 offset:9216
    v_max_f32 v165, 0, v165
    v_mfma_f32_16x16x32_bf16 v[100:103], a[28:31], a[8:11], v[100:103]
    ds_read_b128 a[48:51], v23 offset:10240
    v_add_f32 v165, 0x3727c5ac, v165
    v_mfma_f32_16x16x32_bf16 v[104:107], a[28:31], a[12:15], v[104:107]
    ds_read_b64_tr_b16 a[80:81], v25 offset:14464
    v_mfma_f32_16x16x32_bf16 v[156:159], a[28:31], a[16:19], v[156:159]
    s_add_u32 m0, s59, 66560
    s_mov_b32 s58, 0
    v_mfma_f32_16x16x32_bf16 v[108:111], a[32:35], a[0:3], v[108:111]
    buffer_load_dwordx4 v5, s[24:27], s58 offen lds
    v_mfma_f32_16x16x32_bf16 v[112:115], a[32:35], a[4:7], v[112:115]
    ds_read_b64_tr_b16 a[82:83], v25 offset:14976
    ds_read_b128 a[52:55], v23 offset:11520
    v_mfma_f32_16x16x32_bf16 v[116:119], a[32:35], a[8:11], v[116:119]
    ds_read_b128 a[56:59], v23 offset:12544
    v_rsq_f32 v166, v165
    v_mfma_f32_16x16x32_bf16 v[120:123], a[32:35], a[12:15], v[120:123]
    ds_read_b64_tr_b16 a[84:85], v25 offset:14496
    v_min_u32 v2, 191, v0
    v_mfma_f32_16x16x32_bf16 v[160:163], a[32:35], a[16:19], v[160:163]
    ds_read_b64_tr_b16 a[86:87], v25 offset:15008
    v_mfma_f32_16x16x32_bf16 v[124:127], a[0:3], a[36:39], v[124:127]
    ds_read_b128 a[60:63], v24 offset:11264
    v_lshlrev_b32 v27, 2, v2
    v_mfma_f32_16x16x32_bf16 v[128:131], a[4:7], a[36:39], v[128:131]
    buffer_load_dwordx4 v6, s[24:27], s58 offen offset:1024 lds
    v_mfma_f32_16x16x32_bf16 v[132:135], a[8:11], a[36:39], v[132:135]
    v_mov_b32 v165, v166
    v_mul_f32 v166, 0x3e8293ee, v166
    v_mfma_f32_16x16x32_bf16 v[136:139], a[12:15], a[36:39], v[136:139]
    v_lshlrev_b32 v2, 4, v2
    v_mfma_f32_16x16x32_bf16 v[140:143], a[0:3], a[40:43], v[140:143]
    v_add_u32 v2, 151552, v2
    v_mfma_f32_16x16x32_bf16 v[144:147], a[4:7], a[40:43], v[144:147]
    v_add_u32 v27, 154624, v27
    ds_write_b128 v2, v[164:167]
    v_mfma_f32_16x16x32_bf16 v[148:151], a[8:11], a[40:43], v[148:151]
    ds_write_b32 v27, v164
    v_mfma_f32_16x16x32_bf16 v[152:155], a[12:15], a[40:43], v[152:155]
    ds_write_b32 v27, v165 offset:768
    s_waitcnt lgkmcnt(0)
    s_barrier
    v_mfma_f32_16x16x32_bf16 v[60:63], a[64:67], a[44:47], v[60:63]
    s_add_u32 m0, s59, 8320
    s_mov_b32 s58, 1179648
    v_and_b32 v10, 15, v1
    v_mfma_f32_16x16x32_bf16 v[64:67], a[64:67], a[48:51], v[64:67]
    buffer_load_dwordx4 v5, s[24:27], s58 offen lds
    v_lshlrev_b32 v12, 2, v10
    v_mfma_f32_16x16x32_bf16 v[68:71], a[64:67], a[52:55], v[68:71]
    v_lshlrev_b32 v10, 4, v10
    v_mfma_f32_16x16x32_bf16 v[72:75], a[64:67], a[56:59], v[72:75]
    v_add_u32 v10, 151552, v10
    v_lshrrev_b32 v11, 4, v1
    v_mfma_f32_16x16x32_bf16 v[76:79], a[68:71], a[44:47], v[76:79]
    buffer_load_dwordx4 v6, s[24:27], s58 offen offset:1024 lds
    v_mfma_f32_16x16x32_bf16 v[80:83], a[68:71], a[48:51], v[80:83]
    v_lshlrev_b32 v11, 4, v11
    s_lshl_b32 s62, s49, 7
    v_mfma_f32_16x16x32_bf16 v[84:87], a[68:71], a[52:55], v[84:87]
    s_add_u32 m0, s59, 16640
    s_mov_b32 s58, 1310720
    s_add_u32 s62, s62, 156160
    v_mfma_f32_16x16x32_bf16 v[88:91], a[68:71], a[56:59], v[88:91]
    buffer_load_dwordx4 v5, s[24:27], s58 offen lds
    v_mfma_f32_16x16x32_bf16 v[92:95], a[72:75], a[44:47], v[92:95]
    v_add_u32 v12, s62, v12
    v_add_u32 v13, s62, v11
    v_mfma_f32_16x16x32_bf16 v[96:99], a[72:75], a[48:51], v[96:99]
    v_add_u32 v11, 154624, v11
    ds_read_b128 v[220:223], v10 offset:0
    v_mfma_f32_16x16x32_bf16 v[100:103], a[72:75], a[52:55], v[100:103]
    buffer_load_dwordx4 v6, s[24:27], s58 offen offset:1024 lds
    v_mfma_f32_16x16x32_bf16 v[104:107], a[72:75], a[56:59], v[104:107]
    ds_read_b128 v[224:227], v10 offset:256
    ds_read_b128 v[228:231], v10 offset:512
    v_mfma_f32_16x16x32_bf16 v[156:159], a[72:75], a[60:63], v[156:159]
    s_add_u32 m0, s59, 74880
    s_mov_b32 s58, 131072
    v_mfma_f32_16x16x32_bf16 v[108:111], a[76:79], a[44:47], v[108:111]
    buffer_load_dwordx4 v5, s[24:27], s58 offen lds
    ds_read_b128 v[232:235], v10 offset:768
    v_mfma_f32_16x16x32_bf16 v[112:115], a[76:79], a[48:51], v[112:115]
    ds_read_b128 v[236:239], v10 offset:2048
    ds_read_b128 v[28:31], v13 offset:0
    v_mfma_f32_16x16x32_bf16 v[116:119], a[76:79], a[52:55], v[116:119]
    ds_read_b128 v[32:35], v13 offset:64
    v_mfma_f32_16x16x32_bf16 v[120:123], a[76:79], a[56:59], v[120:123]
    buffer_load_dwordx4 v6, s[24:27], s58 offen offset:1024 lds
    ds_read_b128 v[36:39], v13 offset:256
    v_mfma_f32_16x16x32_bf16 v[160:163], a[76:79], a[60:63], v[160:163]
    ds_read_b128 v[40:43], v13 offset:320
    v_mfma_f32_16x16x32_bf16 v[124:127], a[44:47], a[80:83], v[124:127]
    s_add_u32 m0, s59, 83200
    s_mov_b32 s58, 262144
    ds_read_b32 v44, v12 offset:512
    v_mfma_f32_16x16x32_bf16 v[128:131], a[48:51], a[80:83], v[128:131]
    buffer_load_dwordx4 v5, s[24:27], s58 offen lds
    ds_read_b32 v45, v12 offset:576
    v_mfma_f32_16x16x32_bf16 v[132:135], a[52:55], a[80:83], v[132:135]
    s_lshl_b32 s62, s3, 11
    v_mfma_f32_16x16x32_bf16 v[136:139], a[56:59], a[80:83], v[136:139]
    s_add_u32 s62, s62, 143360
    v_lshl_add_u32 v8, v1, 4, s62
    v_mfma_f32_16x16x32_bf16 v[140:143], a[44:47], a[84:87], v[140:143]
    buffer_load_dwordx4 v6, s[24:27], s58 offen offset:1024 lds
    v_mfma_f32_16x16x32_bf16 v[144:147], a[48:51], a[84:87], v[144:147]
    v_xor_b32 v9, 2048, v8
    v_mov_b32 v248, 0x3f803f80
    v_mfma_f32_16x16x32_bf16 v[148:151], a[52:55], a[84:87], v[148:151]
    v_mov_b32 v249, 0x3f803f80
    v_mov_b32 v250, 0x3f803f80
    v_mfma_f32_16x16x32_bf16 v[152:155], a[56:59], a[84:87], v[152:155]
    v_mov_b32 v251, 0x3f803f80
    ds_read_b128 v[240:243], v11 offset:192
    ds_read_b128 v[244:247], v11 offset:960
    s_waitcnt lgkmcnt(5)
    v_pk_fma_f32 v[104:105], v[36:37], v[232:233], v[104:105] op_sel_hi:[1,0,1]
    v_pk_mul_f32 v[104:105], v[104:105], v[232:233] op_sel:[0,1] op_sel_hi:[1,1]
    v_cvt_pk_bf16_f32 v196, v104, v105
    v_pk_fma_f32 v[106:107], v[38:39], v[232:233], v[106:107] op_sel_hi:[1,0,1]
    v_pk_mul_f32 v[106:107], v[106:107], v[232:233] op_sel:[0,1] op_sel_hi:[1,1]
    v_cvt_pk_bf16_f32 v197, v106, v107
    s_waitcnt lgkmcnt(4)
    v_pk_fma_f32 v[120:121], v[40:41], v[232:233], v[120:121] op_sel_hi:[1,0,1]
    v_pk_mul_f32 v[120:121], v[120:121], v[232:233] op_sel:[0,1] op_sel_hi:[1,1]
    v_cvt_pk_bf16_f32 v198, v120, v121
    v_pk_fma_f32 v[122:123], v[42:43], v[232:233], v[122:123] op_sel_hi:[1,0,1]
    v_pk_mul_f32 v[122:123], v[122:123], v[232:233] op_sel:[0,1] op_sel_hi:[1,1]
    v_cvt_pk_bf16_f32 v199, v122, v123
    ds_write_b128 v8, v[196:199]
    v_pk_fma_f32 v[156:157], v[36:37], v[236:237], v[156:157] op_sel_hi:[1,0,1]
    v_pk_mul_f32 v[156:157], v[156:157], v[236:237] op_sel:[0,1] op_sel_hi:[1,1]
    v_cvt_pk_bf16_f32 v180, v156, v157
    v_pk_fma_f32 v[158:159], v[38:39], v[236:237], v[158:159] op_sel_hi:[1,0,1]
    v_pk_mul_f32 v[158:159], v[158:159], v[236:237] op_sel:[0,1] op_sel_hi:[1,1]
    v_cvt_pk_bf16_f32 v181, v158, v159
    v_pk_fma_f32 v[160:161], v[40:41], v[236:237], v[160:161] op_sel_hi:[1,0,1]
    v_pk_mul_f32 v[160:161], v[160:161], v[236:237] op_sel:[0,1] op_sel_hi:[1,1]
    v_cvt_pk_bf16_f32 v182, v160, v161
    s_waitcnt lgkmcnt(2)
    v_pk_fma_f32 v[136:137], v[240:241], v[44:45], v[136:137] op_sel_hi:[1,0,1]
    s_waitcnt lgkmcnt(1)
    v_pk_mul_f32 v[136:137], v[136:137], v[244:245]
    v_cvt_pk_bf16_f32 v208, v136, v137
    v_pk_fma_f32 v[138:139], v[242:243], v[44:45], v[138:139] op_sel_hi:[1,0,1]
    v_pk_mul_f32 v[138:139], v[138:139], v[246:247]
    v_cvt_pk_bf16_f32 v209, v138, v139
    ds_write_b64 v8, v[208:209] offset:1024
    v_pk_fma_f32 v[152:153], v[240:241], v[44:45], v[152:153] op_sel:[0,1,0] op_sel_hi:[1,1,1]
    v_pk_mul_f32 v[152:153], v[152:153], v[244:245]
    v_cvt_pk_bf16_f32 v218, v152, v153
    v_pk_fma_f32 v[154:155], v[242:243], v[44:45], v[154:155] op_sel:[0,1,0] op_sel_hi:[1,1,1]
    v_pk_mul_f32 v[154:155], v[154:155], v[246:247]
    v_cvt_pk_bf16_f32 v219, v154, v155
    ds_write_b64 v8, v[218:219] offset:1032
    v_pk_fma_f32 v[162:163], v[42:43], v[236:237], v[162:163] op_sel_hi:[1,0,1]
    v_pk_mul_f32 v[162:163], v[162:163], v[236:237] op_sel:[0,1] op_sel_hi:[1,1]
    v_cvt_pk_bf16_f32 v183, v162, v163
    v_pk_fma_f32 v[100:101], v[36:37], v[228:229], v[100:101] op_sel_hi:[1,0,1]
    v_pk_mul_f32 v[100:101], v[100:101], v[228:229] op_sel:[0,1] op_sel_hi:[1,1]
    v_cvt_pk_bf16_f32 v192, v100, v101
    v_pk_fma_f32 v[102:103], v[38:39], v[228:229], v[102:103] op_sel_hi:[1,0,1]
    v_pk_mul_f32 v[102:103], v[102:103], v[228:229] op_sel:[0,1] op_sel_hi:[1,1]
    v_cvt_pk_bf16_f32 v193, v102, v103
    v_pk_fma_f32 v[116:117], v[40:41], v[228:229], v[116:117] op_sel_hi:[1,0,1]
    v_pk_mul_f32 v[116:117], v[116:117], v[228:229] op_sel:[0,1] op_sel_hi:[1,1]
    v_cvt_pk_bf16_f32 v194, v116, v117
    v_pk_fma_f32 v[118:119], v[42:43], v[228:229], v[118:119] op_sel_hi:[1,0,1]
    v_pk_mul_f32 v[118:119], v[118:119], v[228:229] op_sel:[0,1] op_sel_hi:[1,1]
    v_cvt_pk_bf16_f32 v195, v118, v119
    v_pk_fma_f32 v[96:97], v[36:37], v[224:225], v[96:97] op_sel_hi:[1,0,1]
    v_pk_mul_f32 v[96:97], v[96:97], v[224:225] op_sel:[0,1] op_sel_hi:[1,1]
    v_cvt_pk_bf16_f32 v188, v96, v97
    v_pk_fma_f32 v[98:99], v[38:39], v[224:225], v[98:99] op_sel_hi:[1,0,1]
    v_pk_mul_f32 v[98:99], v[98:99], v[224:225] op_sel:[0,1] op_sel_hi:[1,1]
    v_cvt_pk_bf16_f32 v189, v98, v99
    v_pk_fma_f32 v[112:113], v[40:41], v[224:225], v[112:113] op_sel_hi:[1,0,1]
    v_pk_mul_f32 v[112:113], v[112:113], v[224:225] op_sel:[0,1] op_sel_hi:[1,1]
    v_cvt_pk_bf16_f32 v190, v112, v113
    v_pk_fma_f32 v[114:115], v[42:43], v[224:225], v[114:115] op_sel_hi:[1,0,1]
    v_pk_mul_f32 v[114:115], v[114:115], v[224:225] op_sel:[0,1] op_sel_hi:[1,1]
    v_cvt_pk_bf16_f32 v191, v114, v115
    v_pk_fma_f32 v[92:93], v[36:37], v[220:221], v[92:93] op_sel_hi:[1,0,1]
    v_pk_mul_f32 v[92:93], v[92:93], v[220:221] op_sel:[0,1] op_sel_hi:[1,1]
    v_cvt_pk_bf16_f32 v184, v92, v93
    v_pk_fma_f32 v[94:95], v[38:39], v[220:221], v[94:95] op_sel_hi:[1,0,1]
    v_pk_mul_f32 v[94:95], v[94:95], v[220:221] op_sel:[0,1] op_sel_hi:[1,1]
    v_cvt_pk_bf16_f32 v185, v94, v95
    v_pk_fma_f32 v[108:109], v[40:41], v[220:221], v[108:109] op_sel_hi:[1,0,1]
    v_pk_mul_f32 v[108:109], v[108:109], v[220:221] op_sel:[0,1] op_sel_hi:[1,1]
    v_cvt_pk_bf16_f32 v186, v108, v109
    v_pk_fma_f32 v[110:111], v[42:43], v[220:221], v[110:111] op_sel_hi:[1,0,1]
    v_pk_mul_f32 v[110:111], v[110:111], v[220:221] op_sel:[0,1] op_sel_hi:[1,1]
    v_cvt_pk_bf16_f32 v187, v110, v111
    s_waitcnt lgkmcnt(0)
    s_barrier
    ds_read_b64 v[200:201], v9 offset:1024
    ds_read_b64 v[210:211], v9 offset:1032
    ds_read_b128 v[18:21], v11 offset:128
    ds_read_b128 v[22:25], v11 offset:896
    s_lshl_b32 s62, s9, 1
    s_add_u32 s62, s62, s49
    s_lshl_b32 s62, s62, 17
    s_lshl_b32 s63, s8, 13
    s_add_u32 s62, s62, s63
    s_add_u32 s62, s62, s14
    s_add_u32 s62, s62, 4194304
    v_lshlrev_b32 v2, 4, v1
    v_pk_fma_f32 v[72:73], v[28:29], v[232:233], v[72:73] op_sel_hi:[1,0,1]
    v_pk_mul_f32 v[72:73], v[72:73], v[234:235] op_sel_hi:[1,0]
    v_cvt_pk_bf16_f32 v176, v72, v73
    v_pk_fma_f32 v[74:75], v[30:31], v[232:233], v[74:75] op_sel_hi:[1,0,1]
    v_pk_mul_f32 v[74:75], v[74:75], v[234:235] op_sel_hi:[1,0]
    v_cvt_pk_bf16_f32 v177, v74, v75
    v_pk_fma_f32 v[88:89], v[32:33], v[232:233], v[88:89] op_sel_hi:[1,0,1]
    v_pk_mul_f32 v[88:89], v[88:89], v[234:235] op_sel_hi:[1,0]
    v_cvt_pk_bf16_f32 v178, v88, v89
    v_pk_fma_f32 v[90:91], v[34:35], v[232:233], v[90:91] op_sel_hi:[1,0,1]
    v_pk_mul_f32 v[90:91], v[90:91], v[234:235] op_sel_hi:[1,0]
    v_cvt_pk_bf16_f32 v179, v90, v91
    v_pk_fma_f32 v[68:69], v[28:29], v[228:229], v[68:69] op_sel_hi:[1,0,1]
    v_pk_mul_f32 v[68:69], v[68:69], v[230:231] op_sel_hi:[1,0]
    v_mfma_f32_16x16x32_bf16 v[116:119], v[192:195], v[176:179], v[46:49]
    s_waitcnt lgkmcnt(1)
    v_pk_fma_f32 v[132:133], v[18:19], v[44:45], v[132:133] op_sel_hi:[1,0,1]
    s_waitcnt lgkmcnt(0)
    v_pk_mul_f32 v[132:133], v[132:133], v[22:23]
    v_mfma_f32_16x16x32_bf16 v[120:123], v[196:199], v[176:179], v[50:53]
    v_cvt_pk_bf16_f32 v206, v132, v133
    v_pk_fma_f32 v[134:135], v[20:21], v[44:45], v[134:135] op_sel_hi:[1,0,1]
    v_pk_mul_f32 v[134:135], v[134:135], v[24:25]
    v_cvt_pk_bf16_f32 v207, v134, v135
    v_pk_fma_f32 v[148:149], v[18:19], v[44:45], v[148:149] op_sel:[0,1,0] op_sel_hi:[1,1,1]
    v_pk_mul_f32 v[148:149], v[148:149], v[22:23]
    v_cvt_pk_bf16_f32 v216, v148, v149
    v_pk_fma_f32 v[150:151], v[20:21], v[44:45], v[150:151] op_sel:[0,1,0] op_sel_hi:[1,1,1]
    v_pk_mul_f32 v[150:151], v[150:151], v[24:25]
    v_cvt_pk_bf16_f32 v217, v150, v151
    v_max3_f32 v162, v116, v117, v118
    v_max3_f32 v163, v119, v120, v121
    v_max3_f32 v162, v162, v122, v123
    v_max_f32 v162, v162, v163
    v_mov_b32 v163, v162
    v_cvt_pk_bf16_f32 v172, v68, v69
    v_pk_fma_f32 v[70:71], v[30:31], v[228:229], v[70:71] op_sel_hi:[1,0,1]
    v_permlane16_swap_b32 v162, v163
    v_pk_mul_f32 v[70:71], v[70:71], v[230:231] op_sel_hi:[1,0]
    v_max_f32 v162, v162, v163
    v_mov_b32 v163, v162
    v_cvt_pk_bf16_f32 v173, v70, v71
    v_pk_fma_f32 v[84:85], v[32:33], v[228:229], v[84:85] op_sel_hi:[1,0,1]
    v_permlane32_swap_b32 v162, v163
    v_pk_mul_f32 v[84:85], v[84:85], v[230:231] op_sel_hi:[1,0]
    v_max_f32 v162, v162, v163
    v_pk_add_f32 v[116:117], v[116:117], v[162:163] op_sel_hi:[1,0] neg_lo:[0,1] neg_hi:[0,1]
    v_exp_f32 v116, v116
    v_pk_add_f32 v[118:119], v[118:119], v[162:163] op_sel_hi:[1,0] neg_lo:[0,1] neg_hi:[0,1]
    v_exp_f32 v117, v117
    v_pk_add_f32 v[120:121], v[120:121], v[162:163] op_sel_hi:[1,0] neg_lo:[0,1] neg_hi:[0,1]
    v_exp_f32 v118, v118
    v_pk_add_f32 v[122:123], v[122:123], v[162:163] op_sel_hi:[1,0] neg_lo:[0,1] neg_hi:[0,1]
    v_exp_f32 v119, v119
    v_cvt_pk_bf16_f32 v72, v116, v117
    v_exp_f32 v120, v120
    v_cvt_pk_bf16_f32 v73, v118, v119
    v_exp_f32 v121, v121
    v_cvt_pk_bf16_f32 v174, v84, v85
    v_exp_f32 v122, v122
    v_cvt_pk_bf16_f32 v74, v120, v121
    v_exp_f32 v123, v123
    v_pk_fma_f32 v[86:87], v[34:35], v[228:229], v[86:87] op_sel_hi:[1,0,1]
    v_cvt_pk_bf16_f32 v75, v122, v123
    v_pk_mul_f32 v[86:87], v[86:87], v[230:231] op_sel_hi:[1,0]
    v_cvt_pk_bf16_f32 v175, v86, v87
    v_mfma_f32_16x16x32_bf16 v[88:91], v[248:251], v[72:75], 0
    v_pk_fma_f32 v[64:65], v[28:29], v[224:225], v[64:65] op_sel_hi:[1,0,1]
    v_pk_mul_f32 v[64:65], v[64:65], v[226:227] op_sel_hi:[1,0]
    v_mfma_f32_16x16x32_bf16 v[116:119], v[206:209], v[72:75], 0
    v_cvt_pk_bf16_f32 v168, v64, v65
    v_pk_fma_f32 v[66:67], v[30:31], v[224:225], v[66:67] op_sel_hi:[1,0,1]
    v_mfma_f32_16x16x32_bf16 v[120:123], v[216:219], v[72:75], 0
    s_nop 1
    v_rcp_f32 v88, v88
    v_pk_mul_f32 v[66:67], v[66:67], v[226:227] op_sel_hi:[1,0]
    v_mfma_f32_16x16x32_bf16 v[108:111], v[188:191], v[172:175], v[46:49]
    v_pk_mul_f32 v[116:117], v[116:117], v[88:89] op_sel_hi:[1,0]
    v_pk_mul_f32 v[118:119], v[118:119], v[88:89] op_sel_hi:[1,0]
    v_mfma_f32_16x16x32_bf16 v[112:115], v[192:195], v[172:175], v[50:53]
    v_pk_mul_f32 v[120:121], v[120:121], v[88:89] op_sel_hi:[1,0]
    v_pk_mul_f32 v[122:123], v[122:123], v[88:89] op_sel_hi:[1,0]
    v_cvt_pk_bf16_f32 v176, v116, v117
    v_cvt_pk_bf16_f32 v177, v118, v119
    v_cvt_pk_bf16_f32 v178, v120, v121
    v_cvt_pk_bf16_f32 v179, v122, v123
    buffer_store_dwordx4 v[176:179], v2, s[16:19], s62 offen offset:3072 sc1
    ds_read_b128 v[240:243], v11 offset:64
    ds_read_b128 v[244:247], v11 offset:832
    v_max3_f32 v160, v108, v109, v110
    v_max3_f32 v161, v111, v112, v113
    v_max3_f32 v160, v160, v114, v115
    v_max_f32 v160, v160, v161
    v_mov_b32 v161, v160
    v_cvt_pk_bf16_f32 v169, v66, v67
    v_pk_fma_f32 v[80:81], v[32:33], v[224:225], v[80:81] op_sel_hi:[1,0,1]
    v_permlane16_swap_b32 v160, v161
    v_pk_mul_f32 v[80:81], v[80:81], v[226:227] op_sel_hi:[1,0]
    v_max_f32 v160, v160, v161
    v_mov_b32 v161, v160
    v_cvt_pk_bf16_f32 v170, v80, v81
    v_pk_fma_f32 v[82:83], v[34:35], v[224:225], v[82:83] op_sel_hi:[1,0,1]
    v_permlane32_swap_b32 v160, v161
    v_pk_mul_f32 v[82:83], v[82:83], v[226:227] op_sel_hi:[1,0]
    v_max_f32 v160, v160, v161
    v_pk_add_f32 v[108:109], v[108:109], v[160:161] op_sel_hi:[1,0] neg_lo:[0,1] neg_hi:[0,1]
    v_exp_f32 v108, v108
    v_pk_add_f32 v[110:111], v[110:111], v[160:161] op_sel_hi:[1,0] neg_lo:[0,1] neg_hi:[0,1]
    v_exp_f32 v109, v109
    v_pk_add_f32 v[112:113], v[112:113], v[160:161] op_sel_hi:[1,0] neg_lo:[0,1] neg_hi:[0,1]
    v_exp_f32 v110, v110
    s_waitcnt lgkmcnt(1)
    v_pk_fma_f32 v[128:129], v[240:241], v[44:45], v[128:129] op_sel_hi:[1,0,1]
    v_exp_f32 v111, v111
    s_waitcnt lgkmcnt(0)
    v_pk_mul_f32 v[128:129], v[128:129], v[244:245]
    v_exp_f32 v112, v112
    v_cvt_pk_bf16_f32 v204, v128, v129
    v_exp_f32 v113, v113
    v_pk_fma_f32 v[130:131], v[242:243], v[44:45], v[130:131] op_sel_hi:[1,0,1]
    v_pk_mul_f32 v[130:131], v[130:131], v[246:247]
    v_cvt_pk_bf16_f32 v205, v130, v131
    v_pk_fma_f32 v[144:145], v[240:241], v[44:45], v[144:145] op_sel:[0,1,0] op_sel_hi:[1,1,1]
    v_pk_mul_f32 v[144:145], v[144:145], v[244:245]
    v_cvt_pk_bf16_f32 v214, v144, v145
    v_pk_fma_f32 v[146:147], v[242:243], v[44:45], v[146:147] op_sel:[0,1,0] op_sel_hi:[1,1,1]
    v_pk_mul_f32 v[146:147], v[146:147], v[246:247]
    v_cvt_pk_bf16_f32 v215, v146, v147
    v_pk_add_f32 v[114:115], v[114:115], v[160:161] op_sel_hi:[1,0] neg_lo:[0,1] neg_hi:[0,1]
    v_exp_f32 v114, v114
    v_cvt_pk_bf16_f32 v68, v108, v109
    v_exp_f32 v115, v115
    v_cvt_pk_bf16_f32 v69, v110, v111
    v_cvt_pk_bf16_f32 v70, v112, v113
    v_cvt_pk_bf16_f32 v71, v114, v115
    v_cvt_pk_bf16_f32 v171, v82, v83
    v_pk_fma_f32 v[60:61], v[28:29], v[220:221], v[60:61] op_sel_hi:[1,0,1]
    v_mfma_f32_16x16x32_bf16 v[84:87], v[248:251], v[68:71], 0
    v_pk_mul_f32 v[60:61], v[60:61], v[222:223] op_sel_hi:[1,0]
    v_cvt_pk_bf16_f32 v164, v60, v61
    v_mfma_f32_16x16x32_bf16 v[108:111], v[204:207], v[68:71], 0
    v_pk_fma_f32 v[62:63], v[30:31], v[220:221], v[62:63] op_sel_hi:[1,0,1]
    v_pk_mul_f32 v[62:63], v[62:63], v[222:223] op_sel_hi:[1,0]
    v_mfma_f32_16x16x32_bf16 v[112:115], v[214:217], v[68:71], 0
    s_nop 1
    v_rcp_f32 v84, v84
    v_cvt_pk_bf16_f32 v165, v62, v63
    v_mfma_f32_16x16x32_bf16 v[100:103], v[184:187], v[168:171], v[46:49]
    v_pk_mul_f32 v[108:109], v[108:109], v[84:85] op_sel_hi:[1,0]
    v_pk_mul_f32 v[110:111], v[110:111], v[84:85] op_sel_hi:[1,0]
    v_mfma_f32_16x16x32_bf16 v[104:107], v[188:191], v[168:171], v[50:53]
    v_pk_mul_f32 v[112:113], v[112:113], v[84:85] op_sel_hi:[1,0]
    v_pk_mul_f32 v[114:115], v[114:115], v[84:85] op_sel_hi:[1,0]
    v_cvt_pk_bf16_f32 v172, v108, v109
    v_cvt_pk_bf16_f32 v173, v110, v111
    v_cvt_pk_bf16_f32 v174, v112, v113
    v_cvt_pk_bf16_f32 v175, v114, v115
    buffer_store_dwordx4 v[172:175], v2, s[16:19], s62 offen offset:2048 sc1
    ds_read_b128 v[18:21], v11 offset:0
    ds_read_b128 v[22:25], v11 offset:768
    v_max3_f32 v158, v100, v101, v102
    v_max3_f32 v159, v103, v104, v105
    v_max3_f32 v158, v158, v106, v107
    v_max_f32 v158, v158, v159
    v_mov_b32 v159, v158
    v_pk_fma_f32 v[76:77], v[32:33], v[220:221], v[76:77] op_sel_hi:[1,0,1]
    v_pk_mul_f32 v[76:77], v[76:77], v[222:223] op_sel_hi:[1,0]
    v_permlane16_swap_b32 v158, v159
    v_cvt_pk_bf16_f32 v166, v76, v77
    v_max_f32 v158, v158, v159
    v_mov_b32 v159, v158
    v_pk_fma_f32 v[78:79], v[34:35], v[220:221], v[78:79] op_sel_hi:[1,0,1]
    v_pk_mul_f32 v[78:79], v[78:79], v[222:223] op_sel_hi:[1,0]
    v_permlane32_swap_b32 v158, v159
    v_cvt_pk_bf16_f32 v167, v78, v79
    v_max_f32 v158, v158, v159
    v_pk_add_f32 v[100:101], v[100:101], v[158:159] op_sel_hi:[1,0] neg_lo:[0,1] neg_hi:[0,1]
    v_exp_f32 v100, v100
    v_mfma_f32_16x16x32_bf16 v[92:95], v[180:183], v[164:167], v[54:57]
    v_exp_f32 v101, v101
    v_pk_add_f32 v[102:103], v[102:103], v[158:159] op_sel_hi:[1,0] neg_lo:[0,1] neg_hi:[0,1]
    v_exp_f32 v102, v102
    v_mfma_f32_16x16x32_bf16 v[96:99], v[184:187], v[164:167], v[50:53]
    v_exp_f32 v103, v103
    s_waitcnt lgkmcnt(1)
    v_pk_fma_f32 v[124:125], v[18:19], v[44:45], v[124:125] op_sel_hi:[1,0,1]
    s_waitcnt lgkmcnt(0)
    v_pk_mul_f32 v[124:125], v[124:125], v[22:23]
    v_cvt_pk_bf16_f32 v202, v124, v125
    v_pk_fma_f32 v[126:127], v[20:21], v[44:45], v[126:127] op_sel_hi:[1,0,1]
    v_pk_mul_f32 v[126:127], v[126:127], v[24:25]
    v_cvt_pk_bf16_f32 v203, v126, v127
    v_pk_fma_f32 v[140:141], v[18:19], v[44:45], v[140:141] op_sel:[0,1,0] op_sel_hi:[1,1,1]
    v_pk_mul_f32 v[140:141], v[140:141], v[22:23]
    v_cvt_pk_bf16_f32 v212, v140, v141
    v_pk_fma_f32 v[142:143], v[20:21], v[44:45], v[142:143] op_sel:[0,1,0] op_sel_hi:[1,1,1]
    v_pk_mul_f32 v[142:143], v[142:143], v[24:25]
    v_cvt_pk_bf16_f32 v213, v142, v143
    v_pk_add_f32 v[104:105], v[104:105], v[158:159] op_sel_hi:[1,0] neg_lo:[0,1] neg_hi:[0,1]
    v_exp_f32 v104, v104
    v_pk_add_f32 v[106:107], v[106:107], v[158:159] op_sel_hi:[1,0] neg_lo:[0,1] neg_hi:[0,1]
    v_exp_f32 v105, v105
    v_cvt_pk_bf16_f32 v64, v100, v101
    v_exp_f32 v106, v106
    v_cvt_pk_bf16_f32 v65, v102, v103
    v_exp_f32 v107, v107
    v_cvt_pk_bf16_f32 v66, v104, v105
    v_cvt_pk_bf16_f32 v67, v106, v107
    v_max3_f32 v156, v92, v93, v94
    v_max3_f32 v157, v95, v96, v97
    v_mfma_f32_16x16x32_bf16 v[80:83], v[248:251], v[64:67], 0
    v_max3_f32 v156, v156, v98, v99
    v_max_f32 v156, v156, v157
    v_mfma_f32_16x16x32_bf16 v[100:103], v[202:205], v[64:67], 0
    v_mov_b32 v157, v156
    v_mfma_f32_16x16x32_bf16 v[104:107], v[212:215], v[64:67], 0
    s_nop 2
    v_rcp_f32 v80, v80
    v_permlane16_swap_b32 v156, v157
    s_nop 0
    v_pk_mul_f32 v[100:101], v[100:101], v[80:81] op_sel_hi:[1,0]
    v_pk_mul_f32 v[102:103], v[102:103], v[80:81] op_sel_hi:[1,0]
    v_cvt_pk_bf16_f32 v168, v100, v101
    v_cvt_pk_bf16_f32 v169, v102, v103
    v_pk_mul_f32 v[104:105], v[104:105], v[80:81] op_sel_hi:[1,0]
    v_pk_mul_f32 v[106:107], v[106:107], v[80:81] op_sel_hi:[1,0]
    v_cvt_pk_bf16_f32 v170, v104, v105
    v_cvt_pk_bf16_f32 v171, v106, v107
    buffer_store_dwordx4 v[168:171], v2, s[16:19], s62 offen offset:1024 sc1
    v_max_f32 v156, v156, v157
    v_mov_b32 v157, v156
    s_nop 1
    v_permlane32_swap_b32 v156, v157
    v_max_f32 v156, v156, v157
    v_pk_add_f32 v[92:93], v[92:93], v[156:157] op_sel_hi:[1,0] neg_lo:[0,1] neg_hi:[0,1]
    v_exp_f32 v92, v92
    v_pk_add_f32 v[94:95], v[94:95], v[156:157] op_sel_hi:[1,0] neg_lo:[0,1] neg_hi:[0,1]
    v_exp_f32 v93, v93
    v_pk_add_f32 v[96:97], v[96:97], v[156:157] op_sel_hi:[1,0] neg_lo:[0,1] neg_hi:[0,1]
    v_exp_f32 v94, v94
    v_pk_add_f32 v[98:99], v[98:99], v[156:157] op_sel_hi:[1,0] neg_lo:[0,1] neg_hi:[0,1]
    v_exp_f32 v95, v95
    v_cvt_pk_bf16_f32 v60, v92, v93
    v_exp_f32 v96, v96
    v_cvt_pk_bf16_f32 v61, v94, v95
    v_exp_f32 v97, v97
    v_exp_f32 v98, v98
    v_cvt_pk_bf16_f32 v62, v96, v97
    v_exp_f32 v99, v99
    s_nop 0
    v_cvt_pk_bf16_f32 v63, v98, v99
    s_nop 1
    v_mfma_f32_16x16x32_bf16 v[76:79], v[248:251], v[60:63], 0
    v_mfma_f32_16x16x32_bf16 v[92:95], v[200:203], v[60:63], 0
    v_mfma_f32_16x16x32_bf16 v[96:99], v[210:213], v[60:63], 0
    s_nop 5
    v_rcp_f32 v76, v76
    s_nop 0
    v_pk_mul_f32 v[92:93], v[92:93], v[76:77] op_sel_hi:[1,0]
    v_pk_mul_f32 v[94:95], v[94:95], v[76:77] op_sel_hi:[1,0]
    v_cvt_pk_bf16_f32 v164, v92, v93
    v_cvt_pk_bf16_f32 v165, v94, v95
    v_pk_mul_f32 v[96:97], v[96:97], v[76:77] op_sel_hi:[1,0]
    v_pk_mul_f32 v[98:99], v[98:99], v[76:77] op_sel_hi:[1,0]
    v_cvt_pk_bf16_f32 v166, v96, v97
    v_cvt_pk_bf16_f32 v167, v98, v99
    buffer_store_dwordx4 v[164:167], v2, s[16:19], s62 offen offset:0 sc1
    s_nop 1
    s_branch .Lqkvend
.Lqkv1:
    s_add_u32 m0, s55, 0
    s_nop 0
    buffer_load_dwordx4 v21, s[16:19], s52 offen sc1 lds
    buffer_load_dwordx4 v21, s[16:19], s52 offen offset:1024 sc1 lds
    buffer_load_dword v22, s[16:19], s52 offen offset:2048 sc1 lds
    s_add_u32 s52, s52, 0x20000
    s_add_u32 m0, s55, 9216
    s_nop 0
    buffer_load_dwordx4 v21, s[16:19], s52 offen sc1 lds
    buffer_load_dwordx4 v21, s[16:19], s52 offen offset:1024 sc1 lds
    buffer_load_dword v22, s[16:19], s52 offen offset:2048 sc1 lds
    s_add_u32 s52, s52, 0x20000
    s_add_u32 m0, s55, 18432
    s_nop 0
    buffer_load_dwordx4 v21, s[16:19], s52 offen sc1 lds
    buffer_load_dwordx4 v21, s[16:19], s52 offen offset:1024 sc1 lds
    buffer_load_dword v22, s[16:19], s52 offen offset:2048 sc1 lds
    s_add_u32 s52, s52, 0x20000
    s_add_u32 m0, s55, 27648
    s_nop 0
    buffer_load_dwordx4 v21, s[16:19], s52 offen sc1 lds
    buffer_load_dwordx4 v21, s[16:19], s52 offen offset:1024 sc1 lds
    buffer_load_dword v22, s[16:19], s52 offen offset:2048 sc1 lds
    s_add_u32 s52, s52, 0x20000
    s_add_u32 m0, s55, 36864
    s_nop 0
    buffer_load_dwordx4 v21, s[16:19], s52 offen sc1 lds
    buffer_load_dwordx4 v21, s[16:19], s52 offen offset:1024 sc1 lds
    buffer_load_dword v22, s[16:19], s52 offen offset:2048 sc1 lds
    s_add_u32 s52, s52, 0x20000
    s_add_u32 m0, s55, 46080
    s_nop 0
    buffer_load_dwordx4 v21, s[16:19], s52 offen sc1 lds
    buffer_load_dwordx4 v21, s[16:19], s52 offen offset:1024 sc1 lds
    buffer_load_dword v22, s[16:19], s52 offen offset:2048 sc1 lds
    s_add_u32 s52, s52, 0x20000
    s_waitcnt vmcnt(15)
    s_barrier
    ds_read_b128 a[0:3], v23 offset:0
    ds_read_b128 a[4:7], v23 offset:1024
    ds_read_b128 a[8:11], v23 offset:2304
    ds_read_b128 a[12:15], v23 offset:3328
    ds_read_b128 a[16:19], v24 offset:2048
    s_cmp_lg_u32 s14, 0
    s_cbranch_scc1 .Ll012
    v_min_u32 v2, 191, v0
    v_lshrrev_b32 v27, 6, v2
    v_lshlrev_b32 v27, 12, v27
    v_and_b32 v2, 63, v2
    v_lshl_add_u32 v2, v2, 2, v27
    s_lshl_b32 s62, s9, 8
    s_add_u32 s62, s62, 31457280
    buffer_load_dword v200, v2, s[16:19], s62 offen sc1
    s_add_u32 s62, s62, 12288
    buffer_load_dword v201, v2, s[16:19], s62 offen sc1
    s_add_u32 s62, s62, 12288
    buffer_load_dword v202, v2, s[16:19], s62 offen sc1
    s_add_u32 s62, s62, 12288
    buffer_load_dword v203, v2, s[16:19], s62 offen sc1
    s_add_u32 s62, s62, 12288
    buffer_load_dword v204, v2, s[16:19], s62 offen sc1
    s_add_u32 s62, s62, 12288
    buffer_load_dword v205, v2, s[16:19], s62 offen sc1
    s_add_u32 s62, s62, 12288
    buffer_load_dword v206, v2, s[16:19], s62 offen sc1
    s_add_u32 s62, s62, 12288
    buffer_load_dword v207, v2, s[16:19], s62 offen sc1
    s_add_u32 s62, s62, 12288
    buffer_load_dword v208, v2, s[16:19], s62 offen sc1
    s_add_u32 s62, s62, 12288
    buffer_load_dword v209, v2, s[16:19], s62 offen sc1
    s_add_u32 s62, s62, 12288
    buffer_load_dword v210, v2, s[16:19], s62 offen sc1
    s_add_u32 s62, s62, 12288
    buffer_load_dword v211, v2, s[16:19], s62 offen sc1
    s_add_u32 s62, s62, 12288
    buffer_load_dword v212, v2, s[16:19], s62 offen sc1
    s_add_u32 s62, s62, 12288
    buffer_load_dword v213, v2, s[16:19], s62 offen sc1
    s_add_u32 s62, s62, 12288
    buffer_load_dword v214, v2, s[16:19], s62 offen sc1
    s_add_u32 s62, s62, 12288
    buffer_load_dword v215, v2, s[16:19], s62 offen sc1
    s_add_u32 s62, s62, 12288
    s_lshl_b32 s62, s2, 1
    s_add_u32 s62, s62, s48
    s_mul_i32 s62, s62, 14336
    v_min_u32 v2, 55, v1
    v_lshlrev_b32 v2, 7, v2
    buffer_load_dword v216, v2, s[32:35], s62 offen
    s_add_u32 s62, s62, 7168
    buffer_load_dword v217, v2, s[32:35], s62 offen
    s_lshl_b32 s62, s2, 13
    v_lshrrev_b32 v2, 2, v0
    v_lshlrev_b32 v2, 7, v2
    buffer_load_dword v218, v2, s[24:27], s62 offen
.Ll012:

    s_mov_b32 s15, 4
.p2align 6
.Lqk13:
    s_waitcnt lgkmcnt(0)
    s_waitcnt vmcnt(12)
    s_barrier
    v_mfma_f32_16x16x32_bf16 v[60:63], a[20:23], a[0:3], v[60:63]
    s_add_u32 m0, s56, 66560
    ds_read_b64_tr_b16 a[64:65], v25 offset:12416
    v_mfma_f32_16x16x32_bf16 v[64:67], a[20:23], a[4:7], v[64:67]
    buffer_load_dwordx4 v18, s[20:23], s54 offen lds
    v_mfma_f32_16x16x32_bf16 v[68:71], a[20:23], a[8:11], v[68:71]
    ds_read_b64_tr_b16 a[66:67], v25 offset:12928
    v_mfma_f32_16x16x32_bf16 v[72:75], a[20:23], a[12:15], v[72:75]
    ds_read_b64_tr_b16 a[68:69], v25 offset:12448
    ds_read_b64_tr_b16 a[70:71], v25 offset:12960
    v_mfma_f32_16x16x32_bf16 v[76:79], a[24:27], a[0:3], v[76:79]
    ds_read_b64_tr_b16 a[72:73], v25 offset:13440
    v_mfma_f32_16x16x32_bf16 v[80:83], a[24:27], a[4:7], v[80:83]
    buffer_load_dwordx4 v19, s[20:23], s54 offen offset:1024 lds
    v_mfma_f32_16x16x32_bf16 v[84:87], a[24:27], a[8:11], v[84:87]
    ds_read_b64_tr_b16 a[74:75], v25 offset:13952
    v_mfma_f32_16x16x32_bf16 v[88:91], a[24:27], a[12:15], v[88:91]
    ds_read_b64_tr_b16 a[76:77], v25 offset:13472
    v_mfma_f32_16x16x32_bf16 v[92:95], a[28:31], a[0:3], v[92:95]
    ds_read_b64_tr_b16 a[78:79], v25 offset:13984
    ds_read_b128 a[44:47], v23 offset:9216
    v_mfma_f32_16x16x32_bf16 v[96:99], a[28:31], a[4:7], v[96:99]
    buffer_load_dwordx4 v20, s[20:23], s54 offen offset:2048 lds
    v_mfma_f32_16x16x32_bf16 v[100:103], a[28:31], a[8:11], v[100:103]
    s_add_u32 s54, s54, 196608
    v_mfma_f32_16x16x32_bf16 v[104:107], a[28:31], a[12:15], v[104:107]
    ds_read_b128 a[48:51], v23 offset:10240
    ds_read_b64_tr_b16 a[80:81], v25 offset:14464
    v_mfma_f32_16x16x32_bf16 v[108:111], a[32:35], a[0:3], v[108:111]
    s_add_u32 m0, s55, 0
    v_mfma_f32_16x16x32_bf16 v[112:115], a[32:35], a[4:7], v[112:115]
    buffer_load_dwordx4 v21, s[16:19], s52 offen sc1 lds
    v_mfma_f32_16x16x32_bf16 v[116:119], a[32:35], a[8:11], v[116:119]
    ds_read_b64_tr_b16 a[82:83], v25 offset:14976
    v_mfma_f32_16x16x32_bf16 v[120:123], a[32:35], a[12:15], v[120:123]
    ds_read_b128 a[52:55], v23 offset:11520
    ds_read_b128 a[56:59], v23 offset:12544
    v_mfma_f32_16x16x32_bf16 v[124:127], a[0:3], a[36:39], v[124:127]
    ds_read_b64_tr_b16 a[84:85], v25 offset:14496
    v_mfma_f32_16x16x32_bf16 v[128:131], a[4:7], a[36:39], v[128:131]
    buffer_load_dwordx4 v21, s[16:19], s52 offen offset:1024 sc1 lds
    v_mfma_f32_16x16x32_bf16 v[132:135], a[8:11], a[36:39], v[132:135]
    ds_read_b64_tr_b16 a[86:87], v25 offset:15008
    v_mfma_f32_16x16x32_bf16 v[136:139], a[12:15], a[36:39], v[136:139]
    ds_read_b128 a[60:63], v24 offset:11264
    v_mfma_f32_16x16x32_bf16 v[156:159], a[16:19], a[36:39], v[156:159]
    v_mfma_f32_16x16x32_bf16 v[140:143], a[0:3], a[40:43], v[140:143]
    buffer_load_dword v22, s[16:19], s52 offen offset:2048 sc1 lds
    v_mfma_f32_16x16x32_bf16 v[144:147], a[4:7], a[40:43], v[144:147]
    s_add_u32 s52, s52, 0x20000
    v_mfma_f32_16x16x32_bf16 v[148:151], a[8:11], a[40:43], v[148:151]
    v_mfma_f32_16x16x32_bf16 v[152:155], a[12:15], a[40:43], v[152:155]
    v_mfma_f32_16x16x32_bf16 v[160:163], a[16:19], a[40:43], v[160:163]
    s_waitcnt lgkmcnt(0)
    s_waitcnt vmcnt(15)
    s_barrier
    v_mfma_f32_16x16x32_bf16 v[60:63], a[64:67], a[44:47], v[60:63]
    s_add_u32 m0, s56, 78976
    ds_read_b64_tr_b16 a[20:21], v25 offset:24832
    v_mfma_f32_16x16x32_bf16 v[64:67], a[64:67], a[48:51], v[64:67]
    buffer_load_dwordx4 v18, s[20:23], s54 offen lds
    v_mfma_f32_16x16x32_bf16 v[68:71], a[64:67], a[52:55], v[68:71]
    ds_read_b64_tr_b16 a[22:23], v25 offset:25344
    v_mfma_f32_16x16x32_bf16 v[72:75], a[64:67], a[56:59], v[72:75]
    ds_read_b64_tr_b16 a[24:25], v25 offset:24864
    ds_read_b64_tr_b16 a[26:27], v25 offset:25376
    v_mfma_f32_16x16x32_bf16 v[76:79], a[68:71], a[44:47], v[76:79]
    ds_read_b64_tr_b16 a[28:29], v25 offset:25856
    v_mfma_f32_16x16x32_bf16 v[80:83], a[68:71], a[48:51], v[80:83]
    buffer_load_dwordx4 v19, s[20:23], s54 offen offset:1024 lds
    v_mfma_f32_16x16x32_bf16 v[84:87], a[68:71], a[52:55], v[84:87]
    ds_read_b64_tr_b16 a[30:31], v25 offset:26368
    v_mfma_f32_16x16x32_bf16 v[88:91], a[68:71], a[56:59], v[88:91]
    ds_read_b64_tr_b16 a[32:33], v25 offset:25888
    v_mfma_f32_16x16x32_bf16 v[92:95], a[72:75], a[44:47], v[92:95]
    ds_read_b64_tr_b16 a[34:35], v25 offset:26400
    ds_read_b128 a[0:3], v23 offset:18432
    v_mfma_f32_16x16x32_bf16 v[96:99], a[72:75], a[48:51], v[96:99]
    buffer_load_dwordx4 v20, s[20:23], s54 offen offset:2048 lds
    v_mfma_f32_16x16x32_bf16 v[100:103], a[72:75], a[52:55], v[100:103]
    s_add_u32 s54, s54, 196608
    v_mfma_f32_16x16x32_bf16 v[104:107], a[72:75], a[56:59], v[104:107]
    ds_read_b128 a[4:7], v23 offset:19456
    ds_read_b64_tr_b16 a[36:37], v25 offset:26880
    v_mfma_f32_16x16x32_bf16 v[108:111], a[76:79], a[44:47], v[108:111]
    s_add_u32 m0, s55, 9216
    v_mfma_f32_16x16x32_bf16 v[112:115], a[76:79], a[48:51], v[112:115]
    buffer_load_dwordx4 v21, s[16:19], s52 offen sc1 lds
    v_mfma_f32_16x16x32_bf16 v[116:119], a[76:79], a[52:55], v[116:119]
    ds_read_b64_tr_b16 a[38:39], v25 offset:27392
    v_mfma_f32_16x16x32_bf16 v[120:123], a[76:79], a[56:59], v[120:123]
    ds_read_b128 a[8:11], v23 offset:20736
    ds_read_b128 a[12:15], v23 offset:21760
    v_mfma_f32_16x16x32_bf16 v[124:127], a[44:47], a[80:83], v[124:127]
    ds_read_b64_tr_b16 a[40:41], v25 offset:26912
    v_mfma_f32_16x16x32_bf16 v[128:131], a[48:51], a[80:83], v[128:131]
    buffer_load_dwordx4 v21, s[16:19], s52 offen offset:1024 sc1 lds
    v_mfma_f32_16x16x32_bf16 v[132:135], a[52:55], a[80:83], v[132:135]
    ds_read_b64_tr_b16 a[42:43], v25 offset:27424
    v_mfma_f32_16x16x32_bf16 v[136:139], a[56:59], a[80:83], v[136:139]
    ds_read_b128 a[16:19], v24 offset:20480
    v_mfma_f32_16x16x32_bf16 v[156:159], a[60:63], a[80:83], v[156:159]
    v_mfma_f32_16x16x32_bf16 v[140:143], a[44:47], a[84:87], v[140:143]
    buffer_load_dword v22, s[16:19], s52 offen offset:2048 sc1 lds
    v_mfma_f32_16x16x32_bf16 v[144:147], a[48:51], a[84:87], v[144:147]
    s_add_u32 s52, s52, 0x20000
    v_mfma_f32_16x16x32_bf16 v[148:151], a[52:55], a[84:87], v[148:151]
    v_mfma_f32_16x16x32_bf16 v[152:155], a[56:59], a[84:87], v[152:155]
    v_mfma_f32_16x16x32_bf16 v[160:163], a[60:63], a[84:87], v[160:163]
    s_waitcnt lgkmcnt(0)
    s_waitcnt vmcnt(18)
    s_barrier
    v_mfma_f32_16x16x32_bf16 v[60:63], a[20:23], a[0:3], v[60:63]
    s_add_u32 m0, s56, 91392
    ds_read_b64_tr_b16 a[64:65], v25 offset:37248
    v_mfma_f32_16x16x32_bf16 v[64:67], a[20:23], a[4:7], v[64:67]
    buffer_load_dwordx4 v18, s[20:23], s54 offen lds
    v_mfma_f32_16x16x32_bf16 v[68:71], a[20:23], a[8:11], v[68:71]
    ds_read_b64_tr_b16 a[66:67], v25 offset:37760
    v_mfma_f32_16x16x32_bf16 v[72:75], a[20:23], a[12:15], v[72:75]
    ds_read_b64_tr_b16 a[68:69], v25 offset:37280
    ds_read_b64_tr_b16 a[70:71], v25 offset:37792
    v_mfma_f32_16x16x32_bf16 v[76:79], a[24:27], a[0:3], v[76:79]
    ds_read_b64_tr_b16 a[72:73], v25 offset:38272
    v_mfma_f32_16x16x32_bf16 v[80:83], a[24:27], a[4:7], v[80:83]
    buffer_load_dwordx4 v19, s[20:23], s54 offen offset:1024 lds
    v_mfma_f32_16x16x32_bf16 v[84:87], a[24:27], a[8:11], v[84:87]
    ds_read_b64_tr_b16 a[74:75], v25 offset:38784
    v_mfma_f32_16x16x32_bf16 v[88:91], a[24:27], a[12:15], v[88:91]
    ds_read_b64_tr_b16 a[76:77], v25 offset:38304
    v_mfma_f32_16x16x32_bf16 v[92:95], a[28:31], a[0:3], v[92:95]
    ds_read_b64_tr_b16 a[78:79], v25 offset:38816
    ds_read_b128 a[44:47], v23 offset:27648
    v_mfma_f32_16x16x32_bf16 v[96:99], a[28:31], a[4:7], v[96:99]
    buffer_load_dwordx4 v20, s[20:23], s54 offen offset:2048 lds
    v_mfma_f32_16x16x32_bf16 v[100:103], a[28:31], a[8:11], v[100:103]
    s_add_u32 s54, s54, 196608
    v_mfma_f32_16x16x32_bf16 v[104:107], a[28:31], a[12:15], v[104:107]
    ds_read_b128 a[48:51], v23 offset:28672
    ds_read_b64_tr_b16 a[80:81], v25 offset:39296
    v_mfma_f32_16x16x32_bf16 v[108:111], a[32:35], a[0:3], v[108:111]
    s_add_u32 m0, s55, 18432
    v_mfma_f32_16x16x32_bf16 v[112:115], a[32:35], a[4:7], v[112:115]
    buffer_load_dwordx4 v21, s[16:19], s52 offen sc1 lds
    v_mfma_f32_16x16x32_bf16 v[116:119], a[32:35], a[8:11], v[116:119]
    ds_read_b64_tr_b16 a[82:83], v25 offset:39808
    v_mfma_f32_16x16x32_bf16 v[120:123], a[32:35], a[12:15], v[120:123]
    ds_read_b128 a[52:55], v23 offset:29952
    ds_read_b128 a[56:59], v23 offset:30976
    v_mfma_f32_16x16x32_bf16 v[124:127], a[0:3], a[36:39], v[124:127]
    ds_read_b64_tr_b16 a[84:85], v25 offset:39328
    v_mfma_f32_16x16x32_bf16 v[128:131], a[4:7], a[36:39], v[128:131]
    buffer_load_dwordx4 v21, s[16:19], s52 offen offset:1024 sc1 lds
    v_mfma_f32_16x16x32_bf16 v[132:135], a[8:11], a[36:39], v[132:135]
    ds_read_b64_tr_b16 a[86:87], v25 offset:39840
    v_mfma_f32_16x16x32_bf16 v[136:139], a[12:15], a[36:39], v[136:139]
    ds_read_b128 a[60:63], v24 offset:29696
    v_mfma_f32_16x16x32_bf16 v[156:159], a[16:19], a[36:39], v[156:159]
    v_mfma_f32_16x16x32_bf16 v[140:143], a[0:3], a[40:43], v[140:143]
    buffer_load_dword v22, s[16:19], s52 offen offset:2048 sc1 lds
    v_mfma_f32_16x16x32_bf16 v[144:147], a[4:7], a[40:43], v[144:147]
    s_add_u32 s52, s52, 0x20000
    v_mfma_f32_16x16x32_bf16 v[148:151], a[8:11], a[40:43], v[148:151]
    v_mfma_f32_16x16x32_bf16 v[152:155], a[12:15], a[40:43], v[152:155]
    v_mfma_f32_16x16x32_bf16 v[160:163], a[16:19], a[40:43], v[160:163]
    s_waitcnt lgkmcnt(0)
    s_waitcnt vmcnt(21)
    s_barrier
    v_mfma_f32_16x16x32_bf16 v[60:63], a[64:67], a[44:47], v[60:63]
    s_add_u32 m0, s56, 103808
    ds_read_b64_tr_b16 a[20:21], v25 offset:49664
    v_mfma_f32_16x16x32_bf16 v[64:67], a[64:67], a[48:51], v[64:67]
    buffer_load_dwordx4 v18, s[20:23], s54 offen lds
    v_mfma_f32_16x16x32_bf16 v[68:71], a[64:67], a[52:55], v[68:71]
    ds_read_b64_tr_b16 a[22:23], v25 offset:50176
    v_mfma_f32_16x16x32_bf16 v[72:75], a[64:67], a[56:59], v[72:75]
    ds_read_b64_tr_b16 a[24:25], v25 offset:49696
    ds_read_b64_tr_b16 a[26:27], v25 offset:50208
    v_mfma_f32_16x16x32_bf16 v[76:79], a[68:71], a[44:47], v[76:79]
    ds_read_b64_tr_b16 a[28:29], v25 offset:50688
    v_mfma_f32_16x16x32_bf16 v[80:83], a[68:71], a[48:51], v[80:83]
    buffer_load_dwordx4 v19, s[20:23], s54 offen offset:1024 lds
    v_mfma_f32_16x16x32_bf16 v[84:87], a[68:71], a[52:55], v[84:87]
    ds_read_b64_tr_b16 a[30:31], v25 offset:51200
    v_mfma_f32_16x16x32_bf16 v[88:91], a[68:71], a[56:59], v[88:91]
    ds_read_b64_tr_b16 a[32:33], v25 offset:50720
    v_mfma_f32_16x16x32_bf16 v[92:95], a[72:75], a[44:47], v[92:95]
    ds_read_b64_tr_b16 a[34:35], v25 offset:51232
    ds_read_b128 a[0:3], v23 offset:36864
    v_mfma_f32_16x16x32_bf16 v[96:99], a[72:75], a[48:51], v[96:99]
    buffer_load_dwordx4 v20, s[20:23], s54 offen offset:2048 lds
    v_mfma_f32_16x16x32_bf16 v[100:103], a[72:75], a[52:55], v[100:103]
    s_add_u32 s54, s54, 196608
    v_mfma_f32_16x16x32_bf16 v[104:107], a[72:75], a[56:59], v[104:107]
    ds_read_b128 a[4:7], v23 offset:37888
    ds_read_b64_tr_b16 a[36:37], v25 offset:51712
    v_mfma_f32_16x16x32_bf16 v[108:111], a[76:79], a[44:47], v[108:111]
    s_add_u32 m0, s55, 27648
    v_mfma_f32_16x16x32_bf16 v[112:115], a[76:79], a[48:51], v[112:115]
    buffer_load_dwordx4 v21, s[16:19], s52 offen sc1 lds
    v_mfma_f32_16x16x32_bf16 v[116:119], a[76:79], a[52:55], v[116:119]
    ds_read_b64_tr_b16 a[38:39], v25 offset:52224
    v_mfma_f32_16x16x32_bf16 v[120:123], a[76:79], a[56:59], v[120:123]
    ds_read_b128 a[8:11], v23 offset:39168
    ds_read_b128 a[12:15], v23 offset:40192
    v_mfma_f32_16x16x32_bf16 v[124:127], a[44:47], a[80:83], v[124:127]
    ds_read_b64_tr_b16 a[40:41], v25 offset:51744
    v_mfma_f32_16x16x32_bf16 v[128:131], a[48:51], a[80:83], v[128:131]
    buffer_load_dwordx4 v21, s[16:19], s52 offen offset:1024 sc1 lds
    v_mfma_f32_16x16x32_bf16 v[132:135], a[52:55], a[80:83], v[132:135]
    ds_read_b64_tr_b16 a[42:43], v25 offset:52256
    v_mfma_f32_16x16x32_bf16 v[136:139], a[56:59], a[80:83], v[136:139]
    ds_read_b128 a[16:19], v24 offset:38912
    v_mfma_f32_16x16x32_bf16 v[156:159], a[60:63], a[80:83], v[156:159]
    v_mfma_f32_16x16x32_bf16 v[140:143], a[44:47], a[84:87], v[140:143]
    buffer_load_dword v22, s[16:19], s52 offen offset:2048 sc1 lds
    v_mfma_f32_16x16x32_bf16 v[144:147], a[48:51], a[84:87], v[144:147]
    s_add_u32 s52, s52, 0x20000
    v_mfma_f32_16x16x32_bf16 v[148:151], a[52:55], a[84:87], v[148:151]
    v_mfma_f32_16x16x32_bf16 v[152:155], a[56:59], a[84:87], v[152:155]
    v_mfma_f32_16x16x32_bf16 v[160:163], a[60:63], a[84:87], v[160:163]
    s_waitcnt lgkmcnt(0)
    s_waitcnt vmcnt(24)
    s_barrier
    v_mfma_f32_16x16x32_bf16 v[60:63], a[20:23], a[0:3], v[60:63]
    s_add_u32 m0, s56, 116224
    ds_read_b64_tr_b16 a[64:65], v25 offset:62080
    v_mfma_f32_16x16x32_bf16 v[64:67], a[20:23], a[4:7], v[64:67]
    buffer_load_dwordx4 v18, s[20:23], s54 offen lds
    v_mfma_f32_16x16x32_bf16 v[68:71], a[20:23], a[8:11], v[68:71]
    ds_read_b64_tr_b16 a[66:67], v25 offset:62592
    v_mfma_f32_16x16x32_bf16 v[72:75], a[20:23], a[12:15], v[72:75]
    ds_read_b64_tr_b16 a[68:69], v25 offset:62112
    ds_read_b64_tr_b16 a[70:71], v25 offset:62624
    v_mfma_f32_16x16x32_bf16 v[76:79], a[24:27], a[0:3], v[76:79]
    ds_read_b64_tr_b16 a[72:73], v25 offset:63104
    v_mfma_f32_16x16x32_bf16 v[80:83], a[24:27], a[4:7], v[80:83]
    buffer_load_dwordx4 v19, s[20:23], s54 offen offset:1024 lds
    v_mfma_f32_16x16x32_bf16 v[84:87], a[24:27], a[8:11], v[84:87]
    ds_read_b64_tr_b16 a[74:75], v25 offset:63616
    v_mfma_f32_16x16x32_bf16 v[88:91], a[24:27], a[12:15], v[88:91]
    ds_read_b64_tr_b16 a[76:77], v25 offset:63136
    v_mfma_f32_16x16x32_bf16 v[92:95], a[28:31], a[0:3], v[92:95]
    ds_read_b64_tr_b16 a[78:79], v25 offset:63648
    ds_read_b128 a[44:47], v23 offset:46080
    v_mfma_f32_16x16x32_bf16 v[96:99], a[28:31], a[4:7], v[96:99]
    buffer_load_dwordx4 v20, s[20:23], s54 offen offset:2048 lds
    v_mfma_f32_16x16x32_bf16 v[100:103], a[28:31], a[8:11], v[100:103]
    s_add_u32 s54, s54, 196608
    v_mfma_f32_16x16x32_bf16 v[104:107], a[28:31], a[12:15], v[104:107]
    ds_read_b128 a[48:51], v23 offset:47104
    ds_read_b64_tr_b16 a[80:81], v25 offset:64128
    v_mfma_f32_16x16x32_bf16 v[108:111], a[32:35], a[0:3], v[108:111]
    s_add_u32 m0, s55, 36864
    v_mfma_f32_16x16x32_bf16 v[112:115], a[32:35], a[4:7], v[112:115]
    buffer_load_dwordx4 v21, s[16:19], s52 offen sc1 lds
    v_mfma_f32_16x16x32_bf16 v[116:119], a[32:35], a[8:11], v[116:119]
    ds_read_b64_tr_b16 a[82:83], v25 offset:64640
    v_mfma_f32_16x16x32_bf16 v[120:123], a[32:35], a[12:15], v[120:123]
    ds_read_b128 a[52:55], v23 offset:48384
    ds_read_b128 a[56:59], v23 offset:49408
    v_mfma_f32_16x16x32_bf16 v[124:127], a[0:3], a[36:39], v[124:127]
    ds_read_b64_tr_b16 a[84:85], v25 offset:64160
    v_mfma_f32_16x16x32_bf16 v[128:131], a[4:7], a[36:39], v[128:131]
    buffer_load_dwordx4 v21, s[16:19], s52 offen offset:1024 sc1 lds
    v_mfma_f32_16x16x32_bf16 v[132:135], a[8:11], a[36:39], v[132:135]
    ds_read_b64_tr_b16 a[86:87], v25 offset:64672
    v_mfma_f32_16x16x32_bf16 v[136:139], a[12:15], a[36:39], v[136:139]
    ds_read_b128 a[60:63], v24 offset:48128
    v_mfma_f32_16x16x32_bf16 v[156:159], a[16:19], a[36:39], v[156:159]
    v_mfma_f32_16x16x32_bf16 v[140:143], a[0:3], a[40:43], v[140:143]
    buffer_load_dword v22, s[16:19], s52 offen offset:2048 sc1 lds
    v_mfma_f32_16x16x32_bf16 v[144:147], a[4:7], a[40:43], v[144:147]
    s_add_u32 s52, s52, 0x20000
    v_mfma_f32_16x16x32_bf16 v[148:151], a[8:11], a[40:43], v[148:151]
    v_mfma_f32_16x16x32_bf16 v[152:155], a[12:15], a[40:43], v[152:155]
    v_mfma_f32_16x16x32_bf16 v[160:163], a[16:19], a[40:43], v[160:163]
    s_waitcnt lgkmcnt(0)
    s_waitcnt vmcnt(24)
    s_barrier
    v_mfma_f32_16x16x32_bf16 v[60:63], a[64:67], a[44:47], v[60:63]
    s_add_u32 m0, s56, 128640
    ds_read_b64_tr_b16 a[20:21], v25 offset:0
    v_mfma_f32_16x16x32_bf16 v[64:67], a[64:67], a[48:51], v[64:67]
    buffer_load_dwordx4 v18, s[20:23], s54 offen lds
    v_mfma_f32_16x16x32_bf16 v[68:71], a[64:67], a[52:55], v[68:71]
    ds_read_b64_tr_b16 a[22:23], v25 offset:512
    v_mfma_f32_16x16x32_bf16 v[72:75], a[64:67], a[56:59], v[72:75]
    ds_read_b64_tr_b16 a[24:25], v25 offset:32
    ds_read_b64_tr_b16 a[26:27], v25 offset:544
    v_mfma_f32_16x16x32_bf16 v[76:79], a[68:71], a[44:47], v[76:79]
    ds_read_b64_tr_b16 a[28:29], v25 offset:1024
    v_mfma_f32_16x16x32_bf16 v[80:83], a[68:71], a[48:51], v[80:83]
    buffer_load_dwordx4 v19, s[20:23], s54 offen offset:1024 lds
    v_mfma_f32_16x16x32_bf16 v[84:87], a[68:71], a[52:55], v[84:87]
    ds_read_b64_tr_b16 a[30:31], v25 offset:1536
    v_mfma_f32_16x16x32_bf16 v[88:91], a[68:71], a[56:59], v[88:91]
    ds_read_b64_tr_b16 a[32:33], v25 offset:1056
    v_mfma_f32_16x16x32_bf16 v[92:95], a[72:75], a[44:47], v[92:95]
    ds_read_b64_tr_b16 a[34:35], v25 offset:1568
    ds_read_b128 a[0:3], v23 offset:0
    v_mfma_f32_16x16x32_bf16 v[96:99], a[72:75], a[48:51], v[96:99]
    buffer_load_dwordx4 v20, s[20:23], s54 offen offset:2048 lds
    v_mfma_f32_16x16x32_bf16 v[100:103], a[72:75], a[52:55], v[100:103]
    s_add_u32 s54, s54, 196608
    v_mfma_f32_16x16x32_bf16 v[104:107], a[72:75], a[56:59], v[104:107]
    ds_read_b128 a[4:7], v23 offset:1024
    ds_read_b64_tr_b16 a[36:37], v25 offset:2048
    v_mfma_f32_16x16x32_bf16 v[108:111], a[76:79], a[44:47], v[108:111]
    s_add_u32 m0, s55, 46080
    v_mfma_f32_16x16x32_bf16 v[112:115], a[76:79], a[48:51], v[112:115]
    buffer_load_dwordx4 v21, s[16:19], s52 offen sc1 lds
    v_mfma_f32_16x16x32_bf16 v[116:119], a[76:79], a[52:55], v[116:119]
    ds_read_b64_tr_b16 a[38:39], v25 offset:2560
    v_mfma_f32_16x16x32_bf16 v[120:123], a[76:79], a[56:59], v[120:123]
    ds_read_b128 a[8:11], v23 offset:2304
    ds_read_b128 a[12:15], v23 offset:3328
    v_mfma_f32_16x16x32_bf16 v[124:127], a[44:47], a[80:83], v[124:127]
    ds_read_b64_tr_b16 a[40:41], v25 offset:2080
    v_mfma_f32_16x16x32_bf16 v[128:131], a[48:51], a[80:83], v[128:131]
    buffer_load_dwordx4 v21, s[16:19], s52 offen offset:1024 sc1 lds
    v_mfma_f32_16x16x32_bf16 v[132:135], a[52:55], a[80:83], v[132:135]
    ds_read_b64_tr_b16 a[42:43], v25 offset:2592
    v_mfma_f32_16x16x32_bf16 v[136:139], a[56:59], a[80:83], v[136:139]
    ds_read_b128 a[16:19], v24 offset:2048
    v_mfma_f32_16x16x32_bf16 v[156:159], a[60:63], a[80:83], v[156:159]
    v_mfma_f32_16x16x32_bf16 v[140:143], a[44:47], a[84:87], v[140:143]
    buffer_load_dword v22, s[16:19], s52 offen offset:2048 sc1 lds
    v_mfma_f32_16x16x32_bf16 v[144:147], a[48:51], a[84:87], v[144:147]
    s_add_u32 s52, s52, 0x20000
    v_mfma_f32_16x16x32_bf16 v[148:151], a[52:55], a[84:87], v[148:151]
    v_mfma_f32_16x16x32_bf16 v[152:155], a[56:59], a[84:87], v[152:155]
    v_mfma_f32_16x16x32_bf16 v[160:163], a[60:63], a[84:87], v[160:163]
    s_sub_u32 s15, s15, 1
    s_cmp_lg_u32 s15, 0
    s_cbranch_scc1 .Lqk13
    s_cmp_lg_u32 s14, 0
    s_cbranch_scc1 .Ll014
    v_add_f32 v200, v200, v201
    v_add_f32 v200, v200, v202
    v_add_f32 v200, v200, v203
    v_add_f32 v200, v200, v204
    v_add_f32 v200, v200, v205
    v_add_f32 v200, v200, v206
    v_add_f32 v200, v200, v207
    v_add_f32 v200, v200, v208
    v_add_f32 v200, v200, v209
    v_add_f32 v200, v200, v210
    v_add_f32 v200, v200, v211
    v_add_f32 v200, v200, v212
    v_add_f32 v200, v200, v213
    v_add_f32 v200, v200, v214
    v_add_f32 v200, v200, v215
    v_min_u32 v2, 191, v0
    v_lshlrev_b32 v2, 2, v2
    v_add_u32 v2, 156160, v2
    ds_write_b32 v2, v200
.Ll014:

    s_waitcnt lgkmcnt(0)
    s_waitcnt vmcnt(24)
    s_barrier
    v_mfma_f32_16x16x32_bf16 v[60:63], a[20:23], a[0:3], v[60:63]
    s_add_u32 m0, s56, 66560
    ds_read_b64_tr_b16 a[64:65], v25 offset:12416
    v_mfma_f32_16x16x32_bf16 v[64:67], a[20:23], a[4:7], v[64:67]
    buffer_load_dwordx4 v18, s[20:23], s54 offen lds
    v_mfma_f32_16x16x32_bf16 v[68:71], a[20:23], a[8:11], v[68:71]
    ds_read_b64_tr_b16 a[66:67], v25 offset:12928
    ds_read_b64_tr_b16 a[68:69], v25 offset:12448
    v_mfma_f32_16x16x32_bf16 v[72:75], a[20:23], a[12:15], v[72:75]
    buffer_load_dwordx4 v19, s[20:23], s54 offen offset:1024 lds
    v_mfma_f32_16x16x32_bf16 v[76:79], a[24:27], a[0:3], v[76:79]
    ds_read_b64_tr_b16 a[70:71], v25 offset:12960
    ds_read_b64_tr_b16 a[72:73], v25 offset:13440
    v_mfma_f32_16x16x32_bf16 v[80:83], a[24:27], a[4:7], v[80:83]
    ds_read_b64_tr_b16 a[74:75], v25 offset:13952
    ds_read_b64_tr_b16 a[76:77], v25 offset:13472
    v_mfma_f32_16x16x32_bf16 v[84:87], a[24:27], a[8:11], v[84:87]
    buffer_load_dwordx4 v20, s[20:23], s54 offen offset:2048 lds
    v_mfma_f32_16x16x32_bf16 v[88:91], a[24:27], a[12:15], v[88:91]
    s_add_u32 s54, s54, 196608
    s_add_u32 m0, s55, 0
    v_mfma_f32_16x16x32_bf16 v[92:95], a[28:31], a[0:3], v[92:95]
    buffer_load_dwordx4 v21, s[16:19], s52 offen sc1 lds
    v_mfma_f32_16x16x32_bf16 v[96:99], a[28:31], a[4:7], v[96:99]
    ds_read_b64_tr_b16 a[78:79], v25 offset:13984
    ds_read_b128 a[44:47], v23 offset:9216
    v_mfma_f32_16x16x32_bf16 v[100:103], a[28:31], a[8:11], v[100:103]
    ds_read_b128 a[48:51], v23 offset:10240
    ds_read_b64_tr_b16 a[80:81], v25 offset:14464
    v_mfma_f32_16x16x32_bf16 v[104:107], a[28:31], a[12:15], v[104:107]
    buffer_load_dwordx4 v21, s[16:19], s52 offen offset:1024 sc1 lds
    v_mfma_f32_16x16x32_bf16 v[108:111], a[32:35], a[0:3], v[108:111]
    ds_read_b64_tr_b16 a[82:83], v25 offset:14976
    ds_read_b128 a[52:55], v23 offset:11520
    v_mfma_f32_16x16x32_bf16 v[112:115], a[32:35], a[4:7], v[112:115]
    buffer_load_dword v22, s[16:19], s52 offen offset:2048 sc1 lds
    v_mfma_f32_16x16x32_bf16 v[116:119], a[32:35], a[8:11], v[116:119]
    s_add_u32 s52, s52, 0x20000
    ds_read_b128 a[56:59], v23 offset:12544
    v_mfma_f32_16x16x32_bf16 v[120:123], a[32:35], a[12:15], v[120:123]
    s_add_u32 s67, s14, 29360128
    ds_read_b64_tr_b16 a[84:85], v25 offset:14496
    v_mfma_f32_16x16x32_bf16 v[124:127], a[0:3], a[36:39], v[124:127]
    buffer_load_dwordx2 v[164:165], v26, s[16:19], s67 offen sc1
    v_mfma_f32_16x16x32_bf16 v[128:131], a[4:7], a[36:39], v[128:131]
    s_add_u32 s67, s14, 29376512
    ds_read_b64_tr_b16 a[86:87], v25 offset:15008
    v_mfma_f32_16x16x32_bf16 v[132:135], a[8:11], a[36:39], v[132:135]
    buffer_load_dwordx2 v[166:167], v26, s[16:19], s67 offen sc1
    v_mfma_f32_16x16x32_bf16 v[136:139], a[12:15], a[36:39], v[136:139]
    ds_read_b128 a[60:63], v24 offset:11264
    v_mfma_f32_16x16x32_bf16 v[156:159], a[16:19], a[36:39], v[156:159]
    s_add_u32 s67, s14, 29392896
    v_mfma_f32_16x16x32_bf16 v[140:143], a[0:3], a[40:43], v[140:143]
    buffer_load_dwordx2 v[168:169], v26, s[16:19], s67 offen sc1
    v_mfma_f32_16x16x32_bf16 v[144:147], a[4:7], a[40:43], v[144:147]
    s_add_u32 s67, s14, 29409280
    v_mfma_f32_16x16x32_bf16 v[148:151], a[8:11], a[40:43], v[148:151]
    buffer_load_dwordx2 v[170:171], v26, s[16:19], s67 offen sc1
    v_mfma_f32_16x16x32_bf16 v[152:155], a[12:15], a[40:43], v[152:155]
    v_mfma_f32_16x16x32_bf16 v[160:163], a[16:19], a[40:43], v[160:163]
    s_waitcnt lgkmcnt(0)
    s_waitcnt vmcnt(28)
    s_barrier
    v_mfma_f32_16x16x32_bf16 v[60:63], a[64:67], a[44:47], v[60:63]
    s_add_u32 m0, s56, 78976
    ds_read_b64_tr_b16 a[20:21], v25 offset:24832
    v_mfma_f32_16x16x32_bf16 v[64:67], a[64:67], a[48:51], v[64:67]
    buffer_load_dwordx4 v18, s[20:23], s54 offen lds
    v_mfma_f32_16x16x32_bf16 v[68:71], a[64:67], a[52:55], v[68:71]
    ds_read_b64_tr_b16 a[22:23], v25 offset:25344
    ds_read_b64_tr_b16 a[24:25], v25 offset:24864
    v_mfma_f32_16x16x32_bf16 v[72:75], a[64:67], a[56:59], v[72:75]
    buffer_load_dwordx4 v19, s[20:23], s54 offen offset:1024 lds
    v_mfma_f32_16x16x32_bf16 v[76:79], a[68:71], a[44:47], v[76:79]
    ds_read_b64_tr_b16 a[26:27], v25 offset:25376
    ds_read_b64_tr_b16 a[28:29], v25 offset:25856
    v_mfma_f32_16x16x32_bf16 v[80:83], a[68:71], a[48:51], v[80:83]
    ds_read_b64_tr_b16 a[30:31], v25 offset:26368
    ds_read_b64_tr_b16 a[32:33], v25 offset:25888
    v_mfma_f32_16x16x32_bf16 v[84:87], a[68:71], a[52:55], v[84:87]
    buffer_load_dwordx4 v20, s[20:23], s54 offen offset:2048 lds
    v_mfma_f32_16x16x32_bf16 v[88:91], a[68:71], a[56:59], v[88:91]
    s_add_u32 s54, s54, 196608
    s_add_u32 m0, s55, 9216
    v_mfma_f32_16x16x32_bf16 v[92:95], a[72:75], a[44:47], v[92:95]
    buffer_load_dwordx4 v21, s[16:19], s52 offen sc1 lds
    v_mfma_f32_16x16x32_bf16 v[96:99], a[72:75], a[48:51], v[96:99]
    ds_read_b64_tr_b16 a[34:35], v25 offset:26400
    ds_read_b128 a[0:3], v23 offset:18432
    v_mfma_f32_16x16x32_bf16 v[100:103], a[72:75], a[52:55], v[100:103]
    ds_read_b128 a[4:7], v23 offset:19456
    ds_read_b64_tr_b16 a[36:37], v25 offset:26880
    v_mfma_f32_16x16x32_bf16 v[104:107], a[72:75], a[56:59], v[104:107]
    buffer_load_dwordx4 v21, s[16:19], s52 offen offset:1024 sc1 lds
    v_mfma_f32_16x16x32_bf16 v[108:111], a[76:79], a[44:47], v[108:111]
    ds_read_b64_tr_b16 a[38:39], v25 offset:27392
    ds_read_b128 a[8:11], v23 offset:20736
    v_mfma_f32_16x16x32_bf16 v[112:115], a[76:79], a[48:51], v[112:115]
    buffer_load_dword v22, s[16:19], s52 offen offset:2048 sc1 lds
    v_mfma_f32_16x16x32_bf16 v[116:119], a[76:79], a[52:55], v[116:119]
    s_add_u32 s52, s52, 0x20000
    ds_read_b128 a[12:15], v23 offset:21760
    v_mfma_f32_16x16x32_bf16 v[120:123], a[76:79], a[56:59], v[120:123]
    s_add_u32 s67, s14, 29425664
    ds_read_b64_tr_b16 a[40:41], v25 offset:26912
    v_mfma_f32_16x16x32_bf16 v[124:127], a[44:47], a[80:83], v[124:127]
    buffer_load_dwordx2 v[172:173], v26, s[16:19], s67 offen sc1
    v_mfma_f32_16x16x32_bf16 v[128:131], a[48:51], a[80:83], v[128:131]
    s_add_u32 s67, s14, 29442048
    ds_read_b64_tr_b16 a[42:43], v25 offset:27424
    v_mfma_f32_16x16x32_bf16 v[132:135], a[52:55], a[80:83], v[132:135]
    buffer_load_dwordx2 v[174:175], v26, s[16:19], s67 offen sc1
    v_mfma_f32_16x16x32_bf16 v[136:139], a[56:59], a[80:83], v[136:139]
    ds_read_b128 a[16:19], v24 offset:20480
    v_mfma_f32_16x16x32_bf16 v[156:159], a[60:63], a[80:83], v[156:159]
    s_add_u32 s67, s14, 29458432
    v_mfma_f32_16x16x32_bf16 v[140:143], a[44:47], a[84:87], v[140:143]
    buffer_load_dwordx2 v[176:177], v26, s[16:19], s67 offen sc1
    v_mfma_f32_16x16x32_bf16 v[144:147], a[48:51], a[84:87], v[144:147]
    s_add_u32 s67, s14, 29474816
    v_mfma_f32_16x16x32_bf16 v[148:151], a[52:55], a[84:87], v[148:151]
    buffer_load_dwordx2 v[178:179], v26, s[16:19], s67 offen sc1
    v_mfma_f32_16x16x32_bf16 v[152:155], a[56:59], a[84:87], v[152:155]
    v_mfma_f32_16x16x32_bf16 v[160:163], a[60:63], a[84:87], v[160:163]
    s_waitcnt lgkmcnt(0)
    s_waitcnt vmcnt(32)
    s_barrier
    v_mfma_f32_16x16x32_bf16 v[60:63], a[20:23], a[0:3], v[60:63]
    s_add_u32 s67, s14, 29491200
    ds_read_b64_tr_b16 a[64:65], v25 offset:37248
    v_mfma_f32_16x16x32_bf16 v[64:67], a[20:23], a[4:7], v[64:67]
    buffer_load_dwordx2 v[180:181], v26, s[16:19], s67 offen sc1
    ds_read_b64_tr_b16 a[66:67], v25 offset:37760
    v_mfma_f32_16x16x32_bf16 v[68:71], a[20:23], a[8:11], v[68:71]
    s_add_u32 s67, s14, 29507584
    ds_read_b64_tr_b16 a[68:69], v25 offset:37280
    v_mfma_f32_16x16x32_bf16 v[72:75], a[20:23], a[12:15], v[72:75]
    buffer_load_dwordx2 v[182:183], v26, s[16:19], s67 offen sc1
    v_mfma_f32_16x16x32_bf16 v[76:79], a[24:27], a[0:3], v[76:79]
    ds_read_b64_tr_b16 a[70:71], v25 offset:37792
    ds_read_b64_tr_b16 a[72:73], v25 offset:38272
    v_mfma_f32_16x16x32_bf16 v[80:83], a[24:27], a[4:7], v[80:83]
    s_add_u32 s67, s14, 29523968
    ds_read_b64_tr_b16 a[74:75], v25 offset:38784
    v_mfma_f32_16x16x32_bf16 v[84:87], a[24:27], a[8:11], v[84:87]
    buffer_load_dwordx2 v[184:185], v26, s[16:19], s67 offen sc1
    v_mfma_f32_16x16x32_bf16 v[88:91], a[24:27], a[12:15], v[88:91]
    s_add_u32 s67, s14, 29540352
    ds_read_b64_tr_b16 a[76:77], v25 offset:38304
    v_mfma_f32_16x16x32_bf16 v[92:95], a[28:31], a[0:3], v[92:95]
    buffer_load_dwordx2 v[186:187], v26, s[16:19], s67 offen sc1
    ds_read_b64_tr_b16 a[78:79], v25 offset:38816
    v_mfma_f32_16x16x32_bf16 v[96:99], a[28:31], a[4:7], v[96:99]
    ds_read_b128 a[44:47], v23 offset:27648
    v_mfma_f32_16x16x32_bf16 v[100:103], a[28:31], a[8:11], v[100:103]
    s_add_u32 s67, s14, 29556736
    ds_read_b128 a[48:51], v23 offset:28672
    v_mfma_f32_16x16x32_bf16 v[104:107], a[28:31], a[12:15], v[104:107]
    buffer_load_dwordx2 v[188:189], v26, s[16:19], s67 offen sc1
    v_mfma_f32_16x16x32_bf16 v[108:111], a[32:35], a[0:3], v[108:111]
    s_add_u32 s67, s14, 29573120
    ds_read_b64_tr_b16 a[80:81], v25 offset:39296
    v_mfma_f32_16x16x32_bf16 v[112:115], a[32:35], a[4:7], v[112:115]
    buffer_load_dwordx2 v[190:191], v26, s[16:19], s67 offen sc1
    ds_read_b64_tr_b16 a[82:83], v25 offset:39808
    v_mfma_f32_16x16x32_bf16 v[116:119], a[32:35], a[8:11], v[116:119]
    ds_read_b128 a[52:55], v23 offset:29952
    v_mfma_f32_16x16x32_bf16 v[120:123], a[32:35], a[12:15], v[120:123]
    s_add_u32 s67, s14, 29589504
    ds_read_b128 a[56:59], v23 offset:30976
    v_mfma_f32_16x16x32_bf16 v[124:127], a[0:3], a[36:39], v[124:127]
    buffer_load_dwordx2 v[192:193], v26, s[16:19], s67 offen sc1
    ds_read_b64_tr_b16 a[84:85], v25 offset:39328
    v_mfma_f32_16x16x32_bf16 v[128:131], a[4:7], a[36:39], v[128:131]
    s_add_u32 s67, s14, 29605888
    ds_read_b64_tr_b16 a[86:87], v25 offset:39840
    v_mfma_f32_16x16x32_bf16 v[132:135], a[8:11], a[36:39], v[132:135]
    buffer_load_dwordx2 v[194:195], v26, s[16:19], s67 offen sc1
    v_mfma_f32_16x16x32_bf16 v[136:139], a[12:15], a[36:39], v[136:139]
    ds_read_b128 a[60:63], v24 offset:29696
    v_mfma_f32_16x16x32_bf16 v[156:159], a[16:19], a[36:39], v[156:159]
    s_add_u32 m0, s59, 58240
    s_mov_b32 s58, 1966080
    v_mfma_f32_16x16x32_bf16 v[140:143], a[0:3], a[40:43], v[140:143]
    buffer_load_dwordx4 v5, s[24:27], s58 offen lds
    v_mfma_f32_16x16x32_bf16 v[144:147], a[4:7], a[40:43], v[144:147]
    v_mfma_f32_16x16x32_bf16 v[148:151], a[8:11], a[40:43], v[148:151]
    buffer_load_dwordx4 v6, s[24:27], s58 offen offset:1024 lds
    v_mfma_f32_16x16x32_bf16 v[152:155], a[12:15], a[40:43], v[152:155]
    v_mfma_f32_16x16x32_bf16 v[160:163], a[16:19], a[40:43], v[160:163]
    s_waitcnt lgkmcnt(0)
    s_waitcnt vmcnt(36)
    s_barrier
    v_mfma_f32_16x16x32_bf16 v[60:63], a[64:67], a[44:47], v[60:63]
    s_add_u32 m0, s59, 91520
    s_mov_b32 s58, 393216
    v_mfma_f32_16x16x32_bf16 v[64:67], a[64:67], a[48:51], v[64:67]
    buffer_load_dwordx4 v5, s[24:27], s58 offen lds
    v_mfma_f32_16x16x32_bf16 v[68:71], a[64:67], a[52:55], v[68:71]
    ds_read_b64_tr_b16 a[20:21], v25 offset:49664
    ds_read_b64_tr_b16 a[22:23], v25 offset:50176
    v_mfma_f32_16x16x32_bf16 v[72:75], a[64:67], a[56:59], v[72:75]
    ds_read_b64_tr_b16 a[24:25], v25 offset:49696
    v_mfma_f32_16x16x32_bf16 v[76:79], a[68:71], a[44:47], v[76:79]
    ds_read_b64_tr_b16 a[26:27], v25 offset:50208
    ds_read_b64_tr_b16 a[28:29], v25 offset:50688
    v_mfma_f32_16x16x32_bf16 v[80:83], a[68:71], a[48:51], v[80:83]
    buffer_load_dwordx4 v6, s[24:27], s58 offen offset:1024 lds
    v_mfma_f32_16x16x32_bf16 v[84:87], a[68:71], a[52:55], v[84:87]
    ds_read_b64_tr_b16 a[30:31], v25 offset:51200
    v_mfma_f32_16x16x32_bf16 v[88:91], a[68:71], a[56:59], v[88:91]
    ds_read_b64_tr_b16 a[32:33], v25 offset:50720
    ds_read_b64_tr_b16 a[34:35], v25 offset:51232
    v_mfma_f32_16x16x32_bf16 v[92:95], a[72:75], a[44:47], v[92:95]
    s_add_u32 m0, s59, 24960
    s_mov_b32 s58, 1441792
    v_mfma_f32_16x16x32_bf16 v[96:99], a[72:75], a[48:51], v[96:99]
    buffer_load_dwordx4 v5, s[24:27], s58 offen lds
    v_mfma_f32_16x16x32_bf16 v[100:103], a[72:75], a[52:55], v[100:103]
    ds_read_b128 a[0:3], v23 offset:36864
    v_mfma_f32_16x16x32_bf16 v[104:107], a[72:75], a[56:59], v[104:107]
    ds_read_b128 a[4:7], v23 offset:37888
    v_mfma_f32_16x16x32_bf16 v[108:111], a[76:79], a[44:47], v[108:111]
    ds_read_b64_tr_b16 a[36:37], v25 offset:51712
    ds_read_b64_tr_b16 a[38:39], v25 offset:52224
    v_mfma_f32_16x16x32_bf16 v[112:115], a[76:79], a[48:51], v[112:115]
    buffer_load_dwordx4 v6, s[24:27], s58 offen offset:1024 lds
    v_mfma_f32_16x16x32_bf16 v[116:119], a[76:79], a[52:55], v[116:119]
    ds_read_b128 a[8:11], v23 offset:39168
    v_mfma_f32_16x16x32_bf16 v[120:123], a[76:79], a[56:59], v[120:123]
    ds_read_b128 a[12:15], v23 offset:40192
    ds_read_b64_tr_b16 a[40:41], v25 offset:51744
    v_mfma_f32_16x16x32_bf16 v[124:127], a[44:47], a[80:83], v[124:127]
    s_add_u32 m0, s59, 99840
    s_mov_b32 s58, 524288
    v_mfma_f32_16x16x32_bf16 v[128:131], a[48:51], a[80:83], v[128:131]
    buffer_load_dwordx4 v5, s[24:27], s58 offen lds
    v_mfma_f32_16x16x32_bf16 v[132:135], a[52:55], a[80:83], v[132:135]
    ds_read_b64_tr_b16 a[42:43], v25 offset:52256
    v_mfma_f32_16x16x32_bf16 v[136:139], a[56:59], a[80:83], v[136:139]
    ds_read_b128 a[16:19], v24 offset:38912
    v_mfma_f32_16x16x32_bf16 v[156:159], a[60:63], a[80:83], v[156:159]
    v_mfma_f32_16x16x32_bf16 v[140:143], a[44:47], a[84:87], v[140:143]
    buffer_load_dwordx4 v6, s[24:27], s58 offen offset:1024 lds
    v_mfma_f32_16x16x32_bf16 v[144:147], a[48:51], a[84:87], v[144:147]
    v_mfma_f32_16x16x32_bf16 v[148:151], a[52:55], a[84:87], v[148:151]
    v_mfma_f32_16x16x32_bf16 v[152:155], a[56:59], a[84:87], v[152:155]
    v_mfma_f32_16x16x32_bf16 v[160:163], a[60:63], a[84:87], v[160:163]
    s_waitcnt lgkmcnt(0)
    s_waitcnt vmcnt(36)
    s_barrier
    v_mfma_f32_16x16x32_bf16 v[60:63], a[20:23], a[0:3], v[60:63]
    s_add_u32 m0, s59, 33280
    s_mov_b32 s58, 1572864
    v_mfma_f32_16x16x32_bf16 v[64:67], a[20:23], a[4:7], v[64:67]
    buffer_load_dwordx4 v5, s[24:27], s58 offen lds
    v_mfma_f32_16x16x32_bf16 v[68:71], a[20:23], a[8:11], v[68:71]
    ds_read_b64_tr_b16 a[64:65], v25 offset:62080
    ds_read_b64_tr_b16 a[66:67], v25 offset:62592
    v_mfma_f32_16x16x32_bf16 v[72:75], a[20:23], a[12:15], v[72:75]
    ds_read_b64_tr_b16 a[68:69], v25 offset:62112
    v_mfma_f32_16x16x32_bf16 v[76:79], a[24:27], a[0:3], v[76:79]
    ds_read_b64_tr_b16 a[70:71], v25 offset:62624
    ds_read_b64_tr_b16 a[72:73], v25 offset:63104
    v_mfma_f32_16x16x32_bf16 v[80:83], a[24:27], a[4:7], v[80:83]
    buffer_load_dwordx4 v6, s[24:27], s58 offen offset:1024 lds
    v_mfma_f32_16x16x32_bf16 v[84:87], a[24:27], a[8:11], v[84:87]
    ds_read_b64_tr_b16 a[74:75], v25 offset:63616
    v_mfma_f32_16x16x32_bf16 v[88:91], a[24:27], a[12:15], v[88:91]
    ds_read_b64_tr_b16 a[76:77], v25 offset:63136
    ds_read_b64_tr_b16 a[78:79], v25 offset:63648
    v_mfma_f32_16x16x32_bf16 v[92:95], a[28:31], a[0:3], v[92:95]
    s_add_u32 m0, s59, 108160
    s_mov_b32 s58, 655360
    v_mfma_f32_16x16x32_bf16 v[96:99], a[28:31], a[4:7], v[96:99]
    buffer_load_dwordx4 v5, s[24:27], s58 offen lds
    v_mfma_f32_16x16x32_bf16 v[100:103], a[28:31], a[8:11], v[100:103]
    ds_read_b128 a[44:47], v23 offset:46080
    v_mfma_f32_16x16x32_bf16 v[104:107], a[28:31], a[12:15], v[104:107]
    ds_read_b128 a[48:51], v23 offset:47104
    v_mfma_f32_16x16x32_bf16 v[108:111], a[32:35], a[0:3], v[108:111]
    ds_read_b64_tr_b16 a[80:81], v25 offset:64128
    ds_read_b64_tr_b16 a[82:83], v25 offset:64640
    v_mfma_f32_16x16x32_bf16 v[112:115], a[32:35], a[4:7], v[112:115]
    buffer_load_dwordx4 v6, s[24:27], s58 offen offset:1024 lds
    v_mfma_f32_16x16x32_bf16 v[116:119], a[32:35], a[8:11], v[116:119]
    ds_read_b128 a[52:55], v23 offset:48384
    v_mfma_f32_16x16x32_bf16 v[120:123], a[32:35], a[12:15], v[120:123]
    ds_read_b128 a[56:59], v23 offset:49408
    ds_read_b64_tr_b16 a[84:85], v25 offset:64160
    v_mfma_f32_16x16x32_bf16 v[124:127], a[0:3], a[36:39], v[124:127]
    s_add_u32 m0, s59, 116480
    s_mov_b32 s58, 786432
    v_mfma_f32_16x16x32_bf16 v[128:131], a[4:7], a[36:39], v[128:131]
    buffer_load_dwordx4 v5, s[24:27], s58 offen lds
    v_mfma_f32_16x16x32_bf16 v[132:135], a[8:11], a[36:39], v[132:135]
    ds_read_b64_tr_b16 a[86:87], v25 offset:64672
    v_mfma_f32_16x16x32_bf16 v[136:139], a[12:15], a[36:39], v[136:139]
    ds_read_b128 a[60:63], v24 offset:48128
    v_mfma_f32_16x16x32_bf16 v[156:159], a[16:19], a[36:39], v[156:159]
    v_mfma_f32_16x16x32_bf16 v[140:143], a[0:3], a[40:43], v[140:143]
    buffer_load_dwordx4 v6, s[24:27], s58 offen offset:1024 lds
    v_mfma_f32_16x16x32_bf16 v[144:147], a[4:7], a[40:43], v[144:147]
    v_mfma_f32_16x16x32_bf16 v[148:151], a[8:11], a[40:43], v[148:151]
    v_mfma_f32_16x16x32_bf16 v[152:155], a[12:15], a[40:43], v[152:155]
    v_mfma_f32_16x16x32_bf16 v[160:163], a[16:19], a[40:43], v[160:163]
    s_waitcnt lgkmcnt(0)
    s_waitcnt vmcnt(36)
    s_barrier
    v_mfma_f32_16x16x32_bf16 v[60:63], a[64:67], a[44:47], v[60:63]
    s_add_u32 m0, s59, 41600
    s_mov_b32 s58, 1703936
    v_mfma_f32_16x16x32_bf16 v[64:67], a[64:67], a[48:51], v[64:67]
    buffer_load_dwordx4 v5, s[24:27], s58 offen lds
    v_mfma_f32_16x16x32_bf16 v[68:71], a[64:67], a[52:55], v[68:71]
    ds_read_b64_tr_b16 a[20:21], v25 offset:0
    ds_read_b64_tr_b16 a[22:23], v25 offset:512
    v_mfma_f32_16x16x32_bf16 v[72:75], a[64:67], a[56:59], v[72:75]
    ds_read_b64_tr_b16 a[24:25], v25 offset:32
    s_waitcnt vmcnt(22)
    v_pk_add_f32 v[164:165], v[164:165], v[180:181]
    v_mfma_f32_16x16x32_bf16 v[76:79], a[68:71], a[44:47], v[76:79]
    ds_read_b64_tr_b16 a[26:27], v25 offset:544
    ds_read_b64_tr_b16 a[28:29], v25 offset:1024
    v_mfma_f32_16x16x32_bf16 v[80:83], a[68:71], a[48:51], v[80:83]
    buffer_load_dwordx4 v6, s[24:27], s58 offen offset:1024 lds
    v_mfma_f32_16x16x32_bf16 v[84:87], a[68:71], a[52:55], v[84:87]
    ds_read_b64_tr_b16 a[30:31], v25 offset:1536
    s_waitcnt vmcnt(22)
    v_pk_add_f32 v[166:167], v[166:167], v[182:183]
    v_mfma_f32_16x16x32_bf16 v[88:91], a[68:71], a[56:59], v[88:91]
    ds_read_b64_tr_b16 a[32:33], v25 offset:1056
    ds_read_b64_tr_b16 a[34:35], v25 offset:1568
    v_mfma_f32_16x16x32_bf16 v[92:95], a[72:75], a[44:47], v[92:95]
    s_add_u32 m0, s59, 49920
    s_mov_b32 s58, 1835008
    v_mfma_f32_16x16x32_bf16 v[96:99], a[72:75], a[48:51], v[96:99]
    buffer_load_dwordx4 v5, s[24:27], s58 offen lds
    v_mfma_f32_16x16x32_bf16 v[100:103], a[72:75], a[52:55], v[100:103]
    ds_read_b128 a[0:3], v23 offset:0
    s_waitcnt vmcnt(22)
    v_pk_add_f32 v[168:169], v[168:169], v[184:185]
    v_mfma_f32_16x16x32_bf16 v[104:107], a[72:75], a[56:59], v[104:107]
    ds_read_b128 a[4:7], v23 offset:1024
    s_waitcnt vmcnt(21)
    v_pk_add_f32 v[170:171], v[170:171], v[186:187]
    v_mfma_f32_16x16x32_bf16 v[108:111], a[76:79], a[44:47], v[108:111]
    ds_read_b64_tr_b16 a[36:37], v25 offset:2048
    ds_read_b64_tr_b16 a[38:39], v25 offset:2560
    v_mfma_f32_16x16x32_bf16 v[112:115], a[76:79], a[48:51], v[112:115]
    buffer_load_dwordx4 v6, s[24:27], s58 offen offset:1024 lds
    v_mfma_f32_16x16x32_bf16 v[116:119], a[76:79], a[52:55], v[116:119]
    ds_read_b128 a[8:11], v23 offset:2304
    s_waitcnt vmcnt(21)
    v_pk_add_f32 v[172:173], v[172:173], v[188:189]
    v_mfma_f32_16x16x32_bf16 v[120:123], a[76:79], a[56:59], v[120:123]
    ds_read_b128 a[12:15], v23 offset:3328
    ds_read_b64_tr_b16 a[40:41], v25 offset:2080
    v_mfma_f32_16x16x32_bf16 v[124:127], a[44:47], a[80:83], v[124:127]
    s_add_u32 m0, s59, 124800
    s_mov_b32 s58, 917504
    v_mfma_f32_16x16x32_bf16 v[128:131], a[48:51], a[80:83], v[128:131]
    buffer_load_dwordx4 v5, s[24:27], s58 offen lds
    v_mfma_f32_16x16x32_bf16 v[132:135], a[52:55], a[80:83], v[132:135]
    ds_read_b64_tr_b16 a[42:43], v25 offset:2592
    s_waitcnt vmcnt(21)
    v_pk_add_f32 v[174:175], v[174:175], v[190:191]
    v_mfma_f32_16x16x32_bf16 v[136:139], a[56:59], a[80:83], v[136:139]
    ds_read_b128 a[16:19], v24 offset:2048
    s_waitcnt vmcnt(20)
    v_pk_add_f32 v[176:177], v[176:177], v[192:193]
    v_mfma_f32_16x16x32_bf16 v[156:159], a[60:63], a[80:83], v[156:159]
    s_waitcnt vmcnt(19)
    v_pk_add_f32 v[178:179], v[178:179], v[194:195]
    v_mfma_f32_16x16x32_bf16 v[140:143], a[44:47], a[84:87], v[140:143]
    buffer_load_dwordx4 v6, s[24:27], s58 offen offset:1024 lds
    v_mfma_f32_16x16x32_bf16 v[144:147], a[48:51], a[84:87], v[144:147]
    v_pk_add_f32 v[164:165], v[164:165], v[172:173]
    v_pk_add_f32 v[166:167], v[166:167], v[174:175]
    v_mfma_f32_16x16x32_bf16 v[148:151], a[52:55], a[84:87], v[148:151]
    v_pk_add_f32 v[168:169], v[168:169], v[176:177]
    v_pk_add_f32 v[170:171], v[170:171], v[178:179]
    v_mfma_f32_16x16x32_bf16 v[152:155], a[56:59], a[84:87], v[152:155]
    v_pk_add_f32 v[164:165], v[164:165], v[168:169]
    v_pk_add_f32 v[166:167], v[166:167], v[170:171]
    v_mfma_f32_16x16x32_bf16 v[160:163], a[60:63], a[84:87], v[160:163]
    v_pk_add_f32 v[164:165], v[164:165], v[166:167]
    s_waitcnt lgkmcnt(0)
    s_barrier
    v_mfma_f32_16x16x32_bf16 v[60:63], a[20:23], a[0:3], v[60:63]
    s_add_u32 m0, s59, 0
    s_mov_b32 s58, 1048576
    v_mfma_f32_16x16x32_bf16 v[64:67], a[20:23], a[4:7], v[64:67]
    buffer_load_dwordx4 v5, s[24:27], s58 offen lds
    v_mfma_f32_16x16x32_bf16 v[68:71], a[20:23], a[8:11], v[68:71]
    ds_read_b64_tr_b16 a[64:65], v25 offset:12416
    ds_read_b64_tr_b16 a[66:67], v25 offset:12928
    v_mfma_f32_16x16x32_bf16 v[72:75], a[20:23], a[12:15], v[72:75]
    ds_read_b64_tr_b16 a[68:69], v25 offset:12448
    v_mul_f32 v164, 0xba800000, v164
    v_mfma_f32_16x16x32_bf16 v[76:79], a[24:27], a[0:3], v[76:79]
    ds_read_b64_tr_b16 a[70:71], v25 offset:12960
    v_mul_f32 v165, 0x3a800000, v165
    v_mfma_f32_16x16x32_bf16 v[80:83], a[24:27], a[4:7], v[80:83]
    ds_read_b64_tr_b16 a[72:73], v25 offset:13440
    v_fma_f32 v165, -v164, v164, v165
    v_mfma_f32_16x16x32_bf16 v[84:87], a[24:27], a[8:11], v[84:87]
    ds_read_b64_tr_b16 a[74:75], v25 offset:13952
    ds_read_b64_tr_b16 a[76:77], v25 offset:13472
    v_mfma_f32_16x16x32_bf16 v[88:91], a[24:27], a[12:15], v[88:91]
    buffer_load_dwordx4 v6, s[24:27], s58 offen offset:1024 lds
    v_mfma_f32_16x16x32_bf16 v[92:95], a[28:31], a[0:3], v[92:95]
    ds_read_b64_tr_b16 a[78:79], v25 offset:13984
    v_mfma_f32_16x16x32_bf16 v[96:99], a[28:31], a[4:7], v[96:99]
    ds_read_b128 a[44:47], v23 offset:9216
    v_max_f32 v165, 0, v165
    v_mfma_f32_16x16x32_bf16 v[100:103], a[28:31], a[8:11], v[100:103]
    ds_read_b128 a[48:51], v23 offset:10240
    v_add_f32 v165, 0x3727c5ac, v165
    v_mfma_f32_16x16x32_bf16 v[104:107], a[28:31], a[12:15], v[104:107]
    ds_read_b64_tr_b16 a[80:81], v25 offset:14464
    v_mfma_f32_16x16x32_bf16 v[108:111], a[32:35], a[0:3], v[108:111]
    s_add_u32 m0, s59, 66560
    s_mov_b32 s58, 0
    v_mfma_f32_16x16x32_bf16 v[112:115], a[32:35], a[4:7], v[112:115]
    buffer_load_dwordx4 v5, s[24:27], s58 offen lds
    v_mfma_f32_16x16x32_bf16 v[116:119], a[32:35], a[8:11], v[116:119]
    ds_read_b64_tr_b16 a[82:83], v25 offset:14976
    ds_read_b128 a[52:55], v23 offset:11520
    v_mfma_f32_16x16x32_bf16 v[120:123], a[32:35], a[12:15], v[120:123]
    ds_read_b128 a[56:59], v23 offset:12544
    v_rsq_f32 v166, v165
    v_mfma_f32_16x16x32_bf16 v[124:127], a[0:3], a[36:39], v[124:127]
    ds_read_b64_tr_b16 a[84:85], v25 offset:14496
    v_min_u32 v2, 191, v0
    v_mfma_f32_16x16x32_bf16 v[128:131], a[4:7], a[36:39], v[128:131]
    ds_read_b64_tr_b16 a[86:87], v25 offset:15008
    v_mfma_f32_16x16x32_bf16 v[132:135], a[8:11], a[36:39], v[132:135]
    ds_read_b128 a[60:63], v24 offset:11264
    v_lshlrev_b32 v27, 2, v2
    v_mfma_f32_16x16x32_bf16 v[136:139], a[12:15], a[36:39], v[136:139]
    buffer_load_dwordx4 v6, s[24:27], s58 offen offset:1024 lds
    v_mfma_f32_16x16x32_bf16 v[156:159], a[16:19], a[36:39], v[156:159]
    v_mov_b32 v165, v166
    v_mul_f32 v166, 0x3e8293ee, v166
    v_mfma_f32_16x16x32_bf16 v[140:143], a[0:3], a[40:43], v[140:143]
    v_lshlrev_b32 v2, 4, v2
    v_mfma_f32_16x16x32_bf16 v[144:147], a[4:7], a[40:43], v[144:147]
    v_add_u32 v2, 151552, v2
    v_mfma_f32_16x16x32_bf16 v[148:151], a[8:11], a[40:43], v[148:151]
    v_add_u32 v27, 154624, v27
    ds_write_b128 v2, v[164:167]
    v_mfma_f32_16x16x32_bf16 v[152:155], a[12:15], a[40:43], v[152:155]
    ds_write_b32 v27, v164
    v_mfma_f32_16x16x32_bf16 v[160:163], a[16:19], a[40:43], v[160:163]
    ds_write_b32 v27, v165 offset:768
    s_waitcnt lgkmcnt(0)
    s_barrier
    v_mfma_f32_16x16x32_bf16 v[60:63], a[64:67], a[44:47], v[60:63]
    s_add_u32 m0, s59, 8320
    s_mov_b32 s58, 1179648
    v_and_b32 v10, 15, v1
    v_mfma_f32_16x16x32_bf16 v[64:67], a[64:67], a[48:51], v[64:67]
    buffer_load_dwordx4 v5, s[24:27], s58 offen lds
    v_lshlrev_b32 v12, 2, v10
    v_mfma_f32_16x16x32_bf16 v[68:71], a[64:67], a[52:55], v[68:71]
    v_lshlrev_b32 v10, 4, v10
    v_mfma_f32_16x16x32_bf16 v[72:75], a[64:67], a[56:59], v[72:75]
    v_add_u32 v10, 151552, v10
    v_lshrrev_b32 v11, 4, v1
    v_mfma_f32_16x16x32_bf16 v[76:79], a[68:71], a[44:47], v[76:79]
    buffer_load_dwordx4 v6, s[24:27], s58 offen offset:1024 lds
    v_mfma_f32_16x16x32_bf16 v[80:83], a[68:71], a[48:51], v[80:83]
    v_lshlrev_b32 v11, 4, v11
    s_lshl_b32 s62, s49, 7
    v_mfma_f32_16x16x32_bf16 v[84:87], a[68:71], a[52:55], v[84:87]
    s_add_u32 m0, s59, 16640
    s_mov_b32 s58, 1310720
    v_mfma_f32_16x16x32_bf16 v[88:91], a[68:71], a[56:59], v[88:91]
    buffer_load_dwordx4 v5, s[24:27], s58 offen lds
    s_add_u32 s62, s62, 156160
    v_mfma_f32_16x16x32_bf16 v[92:95], a[72:75], a[44:47], v[92:95]
    v_add_u32 v12, s62, v12
    v_add_u32 v13, s62, v11
    v_mfma_f32_16x16x32_bf16 v[96:99], a[72:75], a[48:51], v[96:99]
    v_add_u32 v11, 154624, v11
    v_mfma_f32_16x16x32_bf16 v[100:103], a[72:75], a[52:55], v[100:103]
    buffer_load_dwordx4 v6, s[24:27], s58 offen offset:1024 lds
    ds_read_b128 v[220:223], v10 offset:1024
    v_mfma_f32_16x16x32_bf16 v[104:107], a[72:75], a[56:59], v[104:107]
    ds_read_b128 v[224:227], v10 offset:1280
    v_mfma_f32_16x16x32_bf16 v[108:111], a[76:79], a[44:47], v[108:111]
    s_add_u32 m0, s59, 74880
    s_mov_b32 s58, 131072
    ds_read_b128 v[228:231], v10 offset:1536
    v_mfma_f32_16x16x32_bf16 v[112:115], a[76:79], a[48:51], v[112:115]
    buffer_load_dwordx4 v5, s[24:27], s58 offen lds
    v_mfma_f32_16x16x32_bf16 v[116:119], a[76:79], a[52:55], v[116:119]
    ds_read_b128 v[232:235], v10 offset:1792
    ds_read_b128 v[28:31], v13 offset:0
    v_mfma_f32_16x16x32_bf16 v[120:123], a[76:79], a[56:59], v[120:123]
    ds_read_b128 v[32:35], v13 offset:64
    ds_read_b128 v[36:39], v13 offset:256
    v_mfma_f32_16x16x32_bf16 v[124:127], a[44:47], a[80:83], v[124:127]
    buffer_load_dwordx4 v6, s[24:27], s58 offen offset:1024 lds
    v_mfma_f32_16x16x32_bf16 v[128:131], a[48:51], a[80:83], v[128:131]
    ds_read_b128 v[40:43], v13 offset:320
    ds_read_b32 v44, v12 offset:512
    v_mfma_f32_16x16x32_bf16 v[132:135], a[52:55], a[80:83], v[132:135]
    s_add_u32 m0, s59, 83200
    s_mov_b32 s58, 262144
    v_mfma_f32_16x16x32_bf16 v[136:139], a[56:59], a[80:83], v[136:139]
    buffer_load_dwordx4 v5, s[24:27], s58 offen lds
    ds_read_b32 v45, v12 offset:576
    v_mfma_f32_16x16x32_bf16 v[156:159], a[60:63], a[80:83], v[156:159]
    s_lshl_b32 s62, s3, 11
    s_add_u32 s62, s62, 143360
    v_mfma_f32_16x16x32_bf16 v[140:143], a[44:47], a[84:87], v[140:143]
    v_lshl_add_u32 v8, v1, 4, s62
    v_mfma_f32_16x16x32_bf16 v[144:147], a[48:51], a[84:87], v[144:147]
    buffer_load_dwordx4 v6, s[24:27], s58 offen offset:1024 lds
    v_xor_b32 v9, 2048, v8
    v_mfma_f32_16x16x32_bf16 v[148:151], a[52:55], a[84:87], v[148:151]
    v_mov_b32 v248, 0x3f803f80
    v_mfma_f32_16x16x32_bf16 v[152:155], a[56:59], a[84:87], v[152:155]
    v_mov_b32 v249, 0x3f803f80
    v_mov_b32 v250, 0x3f803f80
    v_mfma_f32_16x16x32_bf16 v[160:163], a[60:63], a[84:87], v[160:163]
    v_mov_b32 v251, 0x3f803f80
    ds_read_b128 v[240:243], v11 offset:512
    ds_read_b128 v[244:247], v11 offset:1280
    s_waitcnt lgkmcnt(5)
    v_pk_fma_f32 v[104:105], v[36:37], v[232:233], v[104:105] op_sel_hi:[1,0,1]
    v_pk_mul_f32 v[104:105], v[104:105], v[232:233] op_sel:[0,1] op_sel_hi:[1,1]
    v_cvt_pk_bf16_f32 v196, v104, v105
    v_pk_fma_f32 v[106:107], v[38:39], v[232:233], v[106:107] op_sel_hi:[1,0,1]
    v_pk_mul_f32 v[106:107], v[106:107], v[232:233] op_sel:[0,1] op_sel_hi:[1,1]
    v_cvt_pk_bf16_f32 v197, v106, v107
    s_waitcnt lgkmcnt(4)
    v_pk_fma_f32 v[120:121], v[40:41], v[232:233], v[120:121] op_sel_hi:[1,0,1]
    v_pk_mul_f32 v[120:121], v[120:121], v[232:233] op_sel:[0,1] op_sel_hi:[1,1]
    v_cvt_pk_bf16_f32 v198, v120, v121
    v_pk_fma_f32 v[122:123], v[42:43], v[232:233], v[122:123] op_sel_hi:[1,0,1]
    v_pk_mul_f32 v[122:123], v[122:123], v[232:233] op_sel:[0,1] op_sel_hi:[1,1]
    v_cvt_pk_bf16_f32 v199, v122, v123
    v_pk_fma_f32 v[100:101], v[36:37], v[228:229], v[100:101] op_sel_hi:[1,0,1]
    v_pk_mul_f32 v[100:101], v[100:101], v[228:229] op_sel:[0,1] op_sel_hi:[1,1]
    v_cvt_pk_bf16_f32 v192, v100, v101
    v_pk_fma_f32 v[102:103], v[38:39], v[228:229], v[102:103] op_sel_hi:[1,0,1]
    v_pk_mul_f32 v[102:103], v[102:103], v[228:229] op_sel:[0,1] op_sel_hi:[1,1]
    v_cvt_pk_bf16_f32 v193, v102, v103
    v_pk_fma_f32 v[116:117], v[40:41], v[228:229], v[116:117] op_sel_hi:[1,0,1]
    v_pk_mul_f32 v[116:117], v[116:117], v[228:229] op_sel:[0,1] op_sel_hi:[1,1]
    v_cvt_pk_bf16_f32 v194, v116, v117
    v_pk_fma_f32 v[118:119], v[42:43], v[228:229], v[118:119] op_sel_hi:[1,0,1]
    s_waitcnt lgkmcnt(1)
    v_pk_fma_f32 v[156:157], v[240:241], v[44:45], v[156:157] op_sel_hi:[1,0,1]
    s_waitcnt lgkmcnt(0)
    v_pk_mul_f32 v[156:157], v[156:157], v[244:245]
    v_cvt_pk_bf16_f32 v12, v156, v157
    v_pk_fma_f32 v[158:159], v[242:243], v[44:45], v[158:159] op_sel_hi:[1,0,1]
    v_pk_mul_f32 v[158:159], v[158:159], v[246:247]
    v_cvt_pk_bf16_f32 v13, v158, v159
    v_pk_fma_f32 v[160:161], v[240:241], v[44:45], v[160:161] op_sel:[0,1,0] op_sel_hi:[1,1,1]
    v_pk_mul_f32 v[160:161], v[160:161], v[244:245]
    v_cvt_pk_bf16_f32 v14, v160, v161
    v_pk_fma_f32 v[162:163], v[242:243], v[44:45], v[162:163] op_sel:[0,1,0] op_sel_hi:[1,1,1]
    v_pk_mul_f32 v[162:163], v[162:163], v[246:247]
    v_cvt_pk_bf16_f32 v15, v162, v163
    ds_write_b128 v8, v[12:15] offset:1024
    ds_read_b128 v[18:21], v11 offset:448
    ds_read_b128 v[22:25], v11 offset:1216
    v_pk_mul_f32 v[118:119], v[118:119], v[228:229] op_sel:[0,1] op_sel_hi:[1,1]
    v_cvt_pk_bf16_f32 v195, v118, v119
    v_pk_fma_f32 v[96:97], v[36:37], v[224:225], v[96:97] op_sel_hi:[1,0,1]
    v_pk_mul_f32 v[96:97], v[96:97], v[224:225] op_sel:[0,1] op_sel_hi:[1,1]
    v_cvt_pk_bf16_f32 v188, v96, v97
    v_pk_fma_f32 v[98:99], v[38:39], v[224:225], v[98:99] op_sel_hi:[1,0,1]
    v_pk_mul_f32 v[98:99], v[98:99], v[224:225] op_sel:[0,1] op_sel_hi:[1,1]
    v_cvt_pk_bf16_f32 v189, v98, v99
    v_pk_fma_f32 v[112:113], v[40:41], v[224:225], v[112:113] op_sel_hi:[1,0,1]
    v_pk_mul_f32 v[112:113], v[112:113], v[224:225] op_sel:[0,1] op_sel_hi:[1,1]
    v_cvt_pk_bf16_f32 v190, v112, v113
    v_pk_fma_f32 v[114:115], v[42:43], v[224:225], v[114:115] op_sel_hi:[1,0,1]
    v_pk_mul_f32 v[114:115], v[114:115], v[224:225] op_sel:[0,1] op_sel_hi:[1,1]
    v_cvt_pk_bf16_f32 v191, v114, v115
    v_pk_fma_f32 v[92:93], v[36:37], v[220:221], v[92:93] op_sel_hi:[1,0,1]
    v_pk_mul_f32 v[92:93], v[92:93], v[220:221] op_sel:[0,1] op_sel_hi:[1,1]
    v_cvt_pk_bf16_f32 v184, v92, v93
    v_pk_fma_f32 v[94:95], v[38:39], v[220:221], v[94:95] op_sel_hi:[1,0,1]
    v_pk_mul_f32 v[94:95], v[94:95], v[220:221] op_sel:[0,1] op_sel_hi:[1,1]
    v_cvt_pk_bf16_f32 v185, v94, v95
    v_pk_fma_f32 v[108:109], v[40:41], v[220:221], v[108:109] op_sel_hi:[1,0,1]
    v_pk_mul_f32 v[108:109], v[108:109], v[220:221] op_sel:[0,1] op_sel_hi:[1,1]
    s_waitcnt lgkmcnt(1)
    v_pk_fma_f32 v[136:137], v[18:19], v[44:45], v[136:137] op_sel_hi:[1,0,1]
    s_waitcnt lgkmcnt(0)
    v_pk_mul_f32 v[136:137], v[136:137], v[22:23]
    v_cvt_pk_bf16_f32 v208, v136, v137
    v_pk_fma_f32 v[138:139], v[20:21], v[44:45], v[138:139] op_sel_hi:[1,0,1]
    v_pk_mul_f32 v[138:139], v[138:139], v[24:25]
    v_cvt_pk_bf16_f32 v209, v138, v139
    v_pk_fma_f32 v[152:153], v[18:19], v[44:45], v[152:153] op_sel:[0,1,0] op_sel_hi:[1,1,1]
    v_pk_mul_f32 v[152:153], v[152:153], v[22:23]
    v_cvt_pk_bf16_f32 v218, v152, v153
    v_pk_fma_f32 v[154:155], v[20:21], v[44:45], v[154:155] op_sel:[0,1,0] op_sel_hi:[1,1,1]
    v_pk_mul_f32 v[154:155], v[154:155], v[24:25]
    v_cvt_pk_bf16_f32 v219, v154, v155
    v_cvt_pk_bf16_f32 v186, v108, v109
    v_pk_fma_f32 v[110:111], v[42:43], v[220:221], v[110:111] op_sel_hi:[1,0,1]
    v_pk_mul_f32 v[110:111], v[110:111], v[220:221] op_sel:[0,1] op_sel_hi:[1,1]
    v_cvt_pk_bf16_f32 v187, v110, v111
    s_waitcnt lgkmcnt(0)
    s_barrier
    ds_read_b128 v[180:183], v9
    ds_read_b64 v[200:201], v9 offset:1024
    ds_read_b64 v[210:211], v9 offset:1032
    ds_read_b128 v[240:243], v11 offset:384
    ds_read_b128 v[244:247], v11 offset:1152
    s_lshl_b32 s62, s9, 1
    s_add_u32 s62, s62, s49
    s_lshl_b32 s62, s62, 17
    s_lshl_b32 s63, s8, 13
    s_add_u32 s62, s62, s63
    s_add_u32 s62, s62, s14
    s_add_u32 s62, s62, 4198400
    v_lshlrev_b32 v2, 4, v1
    v_pk_fma_f32 v[72:73], v[28:29], v[232:233], v[72:73] op_sel_hi:[1,0,1]
    v_pk_mul_f32 v[72:73], v[72:73], v[234:235] op_sel_hi:[1,0]
    v_cvt_pk_bf16_f32 v176, v72, v73
    v_pk_fma_f32 v[74:75], v[30:31], v[232:233], v[74:75] op_sel_hi:[1,0,1]
    v_pk_mul_f32 v[74:75], v[74:75], v[234:235] op_sel_hi:[1,0]
    v_cvt_pk_bf16_f32 v177, v74, v75
    v_pk_fma_f32 v[88:89], v[32:33], v[232:233], v[88:89] op_sel_hi:[1,0,1]
    v_pk_mul_f32 v[88:89], v[88:89], v[234:235] op_sel_hi:[1,0]
    v_cvt_pk_bf16_f32 v178, v88, v89
    v_pk_fma_f32 v[90:91], v[34:35], v[232:233], v[90:91] op_sel_hi:[1,0,1]
    v_pk_mul_f32 v[90:91], v[90:91], v[234:235] op_sel_hi:[1,0]
    v_cvt_pk_bf16_f32 v179, v90, v91
    v_pk_fma_f32 v[68:69], v[28:29], v[228:229], v[68:69] op_sel_hi:[1,0,1]
    v_pk_mul_f32 v[68:69], v[68:69], v[230:231] op_sel_hi:[1,0]
    v_mfma_f32_16x16x32_bf16 v[116:119], v[192:195], v[176:179], v[46:49]
    s_waitcnt lgkmcnt(1)
    v_pk_fma_f32 v[132:133], v[240:241], v[44:45], v[132:133] op_sel_hi:[1,0,1]
    s_waitcnt lgkmcnt(0)
    v_pk_mul_f32 v[132:133], v[132:133], v[244:245]
    v_mfma_f32_16x16x32_bf16 v[120:123], v[196:199], v[176:179], v[50:53]
    v_cvt_pk_bf16_f32 v206, v132, v133
    v_pk_fma_f32 v[134:135], v[242:243], v[44:45], v[134:135] op_sel_hi:[1,0,1]
    v_pk_mul_f32 v[134:135], v[134:135], v[246:247]
    v_cvt_pk_bf16_f32 v207, v134, v135
    v_pk_fma_f32 v[148:149], v[240:241], v[44:45], v[148:149] op_sel:[0,1,0] op_sel_hi:[1,1,1]
    v_pk_mul_f32 v[148:149], v[148:149], v[244:245]
    v_cvt_pk_bf16_f32 v216, v148, v149
    v_pk_fma_f32 v[150:151], v[242:243], v[44:45], v[150:151] op_sel:[0,1,0] op_sel_hi:[1,1,1]
    v_pk_mul_f32 v[150:151], v[150:151], v[246:247]
    v_cvt_pk_bf16_f32 v217, v150, v151
    v_max3_f32 v162, v116, v117, v118
    v_max3_f32 v163, v119, v120, v121
    v_max3_f32 v162, v162, v122, v123
    v_max_f32 v162, v162, v163
    v_mov_b32 v163, v162
    v_cvt_pk_bf16_f32 v172, v68, v69
    v_pk_fma_f32 v[70:71], v[30:31], v[228:229], v[70:71] op_sel_hi:[1,0,1]
    v_permlane16_swap_b32 v162, v163
    v_pk_mul_f32 v[70:71], v[70:71], v[230:231] op_sel_hi:[1,0]
    v_max_f32 v162, v162, v163
    v_mov_b32 v163, v162
    v_cvt_pk_bf16_f32 v173, v70, v71
    v_pk_fma_f32 v[84:85], v[32:33], v[228:229], v[84:85] op_sel_hi:[1,0,1]
    v_permlane32_swap_b32 v162, v163
    v_pk_mul_f32 v[84:85], v[84:85], v[230:231] op_sel_hi:[1,0]
    v_max_f32 v162, v162, v163
    v_pk_add_f32 v[116:117], v[116:117], v[162:163] op_sel_hi:[1,0] neg_lo:[0,1] neg_hi:[0,1]
    v_exp_f32 v116, v116
    v_pk_add_f32 v[118:119], v[118:119], v[162:163] op_sel_hi:[1,0] neg_lo:[0,1] neg_hi:[0,1]
    v_exp_f32 v117, v117
    v_pk_add_f32 v[120:121], v[120:121], v[162:163] op_sel_hi:[1,0] neg_lo:[0,1] neg_hi:[0,1]
    v_exp_f32 v118, v118
    v_pk_add_f32 v[122:123], v[122:123], v[162:163] op_sel_hi:[1,0] neg_lo:[0,1] neg_hi:[0,1]
    v_exp_f32 v119, v119
    v_cvt_pk_bf16_f32 v72, v116, v117
    v_exp_f32 v120, v120
    v_cvt_pk_bf16_f32 v73, v118, v119
    v_exp_f32 v121, v121
    v_cvt_pk_bf16_f32 v174, v84, v85
    v_exp_f32 v122, v122
    v_cvt_pk_bf16_f32 v74, v120, v121
    v_exp_f32 v123, v123
    v_pk_fma_f32 v[86:87], v[34:35], v[228:229], v[86:87] op_sel_hi:[1,0,1]
    v_cvt_pk_bf16_f32 v75, v122, v123
    v_pk_mul_f32 v[86:87], v[86:87], v[230:231] op_sel_hi:[1,0]
    v_cvt_pk_bf16_f32 v175, v86, v87
    v_mfma_f32_16x16x32_bf16 v[88:91], v[248:251], v[72:75], 0
    v_pk_fma_f32 v[64:65], v[28:29], v[224:225], v[64:65] op_sel_hi:[1,0,1]
    v_pk_mul_f32 v[64:65], v[64:65], v[226:227] op_sel_hi:[1,0]
    v_mfma_f32_16x16x32_bf16 v[116:119], v[206:209], v[72:75], 0
    v_cvt_pk_bf16_f32 v168, v64, v65
    v_pk_fma_f32 v[66:67], v[30:31], v[224:225], v[66:67] op_sel_hi:[1,0,1]
    v_mfma_f32_16x16x32_bf16 v[120:123], v[216:219], v[72:75], 0
    s_nop 1
    v_rcp_f32 v88, v88
    v_pk_mul_f32 v[66:67], v[66:67], v[226:227] op_sel_hi:[1,0]
    v_mfma_f32_16x16x32_bf16 v[108:111], v[188:191], v[172:175], v[46:49]
    v_pk_mul_f32 v[116:117], v[116:117], v[88:89] op_sel_hi:[1,0]
    v_pk_mul_f32 v[118:119], v[118:119], v[88:89] op_sel_hi:[1,0]
    v_mfma_f32_16x16x32_bf16 v[112:115], v[192:195], v[172:175], v[50:53]
    v_pk_mul_f32 v[120:121], v[120:121], v[88:89] op_sel_hi:[1,0]
    v_pk_mul_f32 v[122:123], v[122:123], v[88:89] op_sel_hi:[1,0]
    v_cvt_pk_bf16_f32 v176, v116, v117
    v_cvt_pk_bf16_f32 v177, v118, v119
    v_cvt_pk_bf16_f32 v178, v120, v121
    v_cvt_pk_bf16_f32 v179, v122, v123
    buffer_store_dwordx4 v[176:179], v2, s[16:19], s62 offen offset:3072 sc1
    ds_read_b128 v[18:21], v11 offset:320
    ds_read_b128 v[22:25], v11 offset:1088
    v_max3_f32 v160, v108, v109, v110
    v_max3_f32 v161, v111, v112, v113
    v_max3_f32 v160, v160, v114, v115
    v_max_f32 v160, v160, v161
    v_mov_b32 v161, v160
    v_cvt_pk_bf16_f32 v169, v66, v67
    v_pk_fma_f32 v[80:81], v[32:33], v[224:225], v[80:81] op_sel_hi:[1,0,1]
    v_permlane16_swap_b32 v160, v161
    v_pk_mul_f32 v[80:81], v[80:81], v[226:227] op_sel_hi:[1,0]
    v_max_f32 v160, v160, v161
    v_mov_b32 v161, v160
    v_cvt_pk_bf16_f32 v170, v80, v81
    v_pk_fma_f32 v[82:83], v[34:35], v[224:225], v[82:83] op_sel_hi:[1,0,1]
    v_permlane32_swap_b32 v160, v161
    v_pk_mul_f32 v[82:83], v[82:83], v[226:227] op_sel_hi:[1,0]
    v_max_f32 v160, v160, v161
    v_pk_add_f32 v[108:109], v[108:109], v[160:161] op_sel_hi:[1,0] neg_lo:[0,1] neg_hi:[0,1]
    v_exp_f32 v108, v108
    v_pk_add_f32 v[110:111], v[110:111], v[160:161] op_sel_hi:[1,0] neg_lo:[0,1] neg_hi:[0,1]
    v_exp_f32 v109, v109
    v_pk_add_f32 v[112:113], v[112:113], v[160:161] op_sel_hi:[1,0] neg_lo:[0,1] neg_hi:[0,1]
    v_exp_f32 v110, v110
    s_waitcnt lgkmcnt(1)
    v_pk_fma_f32 v[128:129], v[18:19], v[44:45], v[128:129] op_sel_hi:[1,0,1]
    v_exp_f32 v111, v111
    s_waitcnt lgkmcnt(0)
    v_pk_mul_f32 v[128:129], v[128:129], v[22:23]
    v_exp_f32 v112, v112
    v_cvt_pk_bf16_f32 v204, v128, v129
    v_exp_f32 v113, v113
    v_pk_fma_f32 v[130:131], v[20:21], v[44:45], v[130:131] op_sel_hi:[1,0,1]
    v_pk_mul_f32 v[130:131], v[130:131], v[24:25]
    v_cvt_pk_bf16_f32 v205, v130, v131
    v_pk_fma_f32 v[144:145], v[18:19], v[44:45], v[144:145] op_sel:[0,1,0] op_sel_hi:[1,1,1]
    v_pk_mul_f32 v[144:145], v[144:145], v[22:23]
    v_cvt_pk_bf16_f32 v214, v144, v145
    v_pk_fma_f32 v[146:147], v[20:21], v[44:45], v[146:147] op_sel:[0,1,0] op_sel_hi:[1,1,1]
    v_pk_mul_f32 v[146:147], v[146:147], v[24:25]
    v_cvt_pk_bf16_f32 v215, v146, v147
    v_pk_add_f32 v[114:115], v[114:115], v[160:161] op_sel_hi:[1,0] neg_lo:[0,1] neg_hi:[0,1]
    v_exp_f32 v114, v114
    v_cvt_pk_bf16_f32 v68, v108, v109
    v_exp_f32 v115, v115
    v_cvt_pk_bf16_f32 v69, v110, v111
    v_cvt_pk_bf16_f32 v70, v112, v113
    v_cvt_pk_bf16_f32 v71, v114, v115
    v_cvt_pk_bf16_f32 v171, v82, v83
    v_pk_fma_f32 v[60:61], v[28:29], v[220:221], v[60:61] op_sel_hi:[1,0,1]
    v_mfma_f32_16x16x32_bf16 v[84:87], v[248:251], v[68:71], 0
    v_pk_mul_f32 v[60:61], v[60:61], v[222:223] op_sel_hi:[1,0]
    v_cvt_pk_bf16_f32 v164, v60, v61
    v_mfma_f32_16x16x32_bf16 v[108:111], v[204:207], v[68:71], 0
    v_pk_fma_f32 v[62:63], v[30:31], v[220:221], v[62:63] op_sel_hi:[1,0,1]
    v_pk_mul_f32 v[62:63], v[62:63], v[222:223] op_sel_hi:[1,0]
    v_mfma_f32_16x16x32_bf16 v[112:115], v[214:217], v[68:71], 0
    s_nop 1
    v_rcp_f32 v84, v84
    v_cvt_pk_bf16_f32 v165, v62, v63
    v_mfma_f32_16x16x32_bf16 v[100:103], v[184:187], v[168:171], v[46:49]
    v_pk_mul_f32 v[108:109], v[108:109], v[84:85] op_sel_hi:[1,0]
    v_pk_mul_f32 v[110:111], v[110:111], v[84:85] op_sel_hi:[1,0]
    v_mfma_f32_16x16x32_bf16 v[104:107], v[188:191], v[168:171], v[50:53]
    v_pk_mul_f32 v[112:113], v[112:113], v[84:85] op_sel_hi:[1,0]
    v_pk_mul_f32 v[114:115], v[114:115], v[84:85] op_sel_hi:[1,0]
    v_cvt_pk_bf16_f32 v172, v108, v109
    v_cvt_pk_bf16_f32 v173, v110, v111
    v_cvt_pk_bf16_f32 v174, v112, v113
    v_cvt_pk_bf16_f32 v175, v114, v115
    buffer_store_dwordx4 v[172:175], v2, s[16:19], s62 offen offset:2048 sc1
    ds_read_b128 v[240:243], v11 offset:256
    ds_read_b128 v[244:247], v11 offset:1024
    v_max3_f32 v158, v100, v101, v102
    v_max3_f32 v159, v103, v104, v105
    v_max3_f32 v158, v158, v106, v107
    v_max_f32 v158, v158, v159
    v_mov_b32 v159, v158
    v_pk_fma_f32 v[76:77], v[32:33], v[220:221], v[76:77] op_sel_hi:[1,0,1]
    v_pk_mul_f32 v[76:77], v[76:77], v[222:223] op_sel_hi:[1,0]
    v_permlane16_swap_b32 v158, v159
    v_cvt_pk_bf16_f32 v166, v76, v77
    v_max_f32 v158, v158, v159
    v_mov_b32 v159, v158
    v_pk_fma_f32 v[78:79], v[34:35], v[220:221], v[78:79] op_sel_hi:[1,0,1]
    v_pk_mul_f32 v[78:79], v[78:79], v[222:223] op_sel_hi:[1,0]
    v_permlane32_swap_b32 v158, v159
    v_cvt_pk_bf16_f32 v167, v78, v79
    v_max_f32 v158, v158, v159
    v_pk_add_f32 v[100:101], v[100:101], v[158:159] op_sel_hi:[1,0] neg_lo:[0,1] neg_hi:[0,1]
    v_exp_f32 v100, v100
    v_mfma_f32_16x16x32_bf16 v[92:95], v[180:183], v[164:167], v[46:49]
    v_exp_f32 v101, v101
    v_pk_add_f32 v[102:103], v[102:103], v[158:159] op_sel_hi:[1,0] neg_lo:[0,1] neg_hi:[0,1]
    v_exp_f32 v102, v102
    v_mfma_f32_16x16x32_bf16 v[96:99], v[184:187], v[164:167], v[50:53]
    v_exp_f32 v103, v103
    s_waitcnt lgkmcnt(1)
    v_pk_fma_f32 v[124:125], v[240:241], v[44:45], v[124:125] op_sel_hi:[1,0,1]
    s_waitcnt lgkmcnt(0)
    v_pk_mul_f32 v[124:125], v[124:125], v[244:245]
    v_cvt_pk_bf16_f32 v202, v124, v125
    v_pk_fma_f32 v[126:127], v[242:243], v[44:45], v[126:127] op_sel_hi:[1,0,1]
    v_pk_mul_f32 v[126:127], v[126:127], v[246:247]
    v_cvt_pk_bf16_f32 v203, v126, v127
    v_pk_fma_f32 v[140:141], v[240:241], v[44:45], v[140:141] op_sel:[0,1,0] op_sel_hi:[1,1,1]
    v_pk_mul_f32 v[140:141], v[140:141], v[244:245]
    v_cvt_pk_bf16_f32 v212, v140, v141
    v_pk_fma_f32 v[142:143], v[242:243], v[44:45], v[142:143] op_sel:[0,1,0] op_sel_hi:[1,1,1]
    v_pk_mul_f32 v[142:143], v[142:143], v[246:247]
    v_cvt_pk_bf16_f32 v213, v142, v143
    v_pk_add_f32 v[104:105], v[104:105], v[158:159] op_sel_hi:[1,0] neg_lo:[0,1] neg_hi:[0,1]
    v_exp_f32 v104, v104
    v_pk_add_f32 v[106:107], v[106:107], v[158:159] op_sel_hi:[1,0] neg_lo:[0,1] neg_hi:[0,1]
    v_exp_f32 v105, v105
    v_cvt_pk_bf16_f32 v64, v100, v101
    v_exp_f32 v106, v106
    v_cvt_pk_bf16_f32 v65, v102, v103
    v_exp_f32 v107, v107
    v_cvt_pk_bf16_f32 v66, v104, v105
    v_cvt_pk_bf16_f32 v67, v106, v107
    v_max3_f32 v156, v92, v93, v94
    v_max3_f32 v157, v95, v96, v97
    v_mfma_f32_16x16x32_bf16 v[80:83], v[248:251], v[64:67], 0
    v_max3_f32 v156, v156, v98, v99
    v_max_f32 v156, v156, v157
    v_mfma_f32_16x16x32_bf16 v[100:103], v[202:205], v[64:67], 0
    v_mov_b32 v157, v156
    v_mfma_f32_16x16x32_bf16 v[104:107], v[212:215], v[64:67], 0
    s_nop 2
    v_rcp_f32 v80, v80
    v_permlane16_swap_b32 v156, v157
    s_nop 0
    v_pk_mul_f32 v[100:101], v[100:101], v[80:81] op_sel_hi:[1,0]
    v_pk_mul_f32 v[102:103], v[102:103], v[80:81] op_sel_hi:[1,0]
    v_cvt_pk_bf16_f32 v168, v100, v101
    v_cvt_pk_bf16_f32 v169, v102, v103
    v_pk_mul_f32 v[104:105], v[104:105], v[80:81] op_sel_hi:[1,0]
    v_pk_mul_f32 v[106:107], v[106:107], v[80:81] op_sel_hi:[1,0]
    v_cvt_pk_bf16_f32 v170, v104, v105
    v_cvt_pk_bf16_f32 v171, v106, v107
    buffer_store_dwordx4 v[168:171], v2, s[16:19], s62 offen offset:1024 sc1
    v_max_f32 v156, v156, v157
    v_mov_b32 v157, v156
    s_nop 1
    v_permlane32_swap_b32 v156, v157
    v_max_f32 v156, v156, v157
    v_pk_add_f32 v[92:93], v[92:93], v[156:157] op_sel_hi:[1,0] neg_lo:[0,1] neg_hi:[0,1]
    v_exp_f32 v92, v92
    v_pk_add_f32 v[94:95], v[94:95], v[156:157] op_sel_hi:[1,0] neg_lo:[0,1] neg_hi:[0,1]
    v_exp_f32 v93, v93
    v_pk_add_f32 v[96:97], v[96:97], v[156:157] op_sel_hi:[1,0] neg_lo:[0,1] neg_hi:[0,1]
    v_exp_f32 v94, v94
    v_pk_add_f32 v[98:99], v[98:99], v[156:157] op_sel_hi:[1,0] neg_lo:[0,1] neg_hi:[0,1]
    v_exp_f32 v95, v95
    v_cvt_pk_bf16_f32 v60, v92, v93
    v_exp_f32 v96, v96
    v_cvt_pk_bf16_f32 v61, v94, v95
    v_exp_f32 v97, v97
    v_exp_f32 v98, v98
    v_cvt_pk_bf16_f32 v62, v96, v97
    v_exp_f32 v99, v99
    s_nop 0
    v_cvt_pk_bf16_f32 v63, v98, v99
    s_nop 1
    v_mfma_f32_16x16x32_bf16 v[76:79], v[248:251], v[60:63], 0
    v_mfma_f32_16x16x32_bf16 v[92:95], v[200:203], v[60:63], 0
    v_mfma_f32_16x16x32_bf16 v[96:99], v[210:213], v[60:63], 0
    s_nop 5
    v_rcp_f32 v76, v76
    s_nop 0
    v_pk_mul_f32 v[92:93], v[92:93], v[76:77] op_sel_hi:[1,0]
    v_pk_mul_f32 v[94:95], v[94:95], v[76:77] op_sel_hi:[1,0]
    v_cvt_pk_bf16_f32 v164, v92, v93
    v_cvt_pk_bf16_f32 v165, v94, v95
    v_pk_mul_f32 v[96:97], v[96:97], v[76:77] op_sel_hi:[1,0]
    v_pk_mul_f32 v[98:99], v[98:99], v[76:77] op_sel_hi:[1,0]
    v_cvt_pk_bf16_f32 v166, v96, v97
    v_cvt_pk_bf16_f32 v167, v98, v99
    buffer_store_dwordx4 v[164:167], v2, s[16:19], s62 offen offset:0 sc1
    s_nop 1
.Lqkvend:
    s_lshl_b32 s62, s6, 13
    s_lshl_b32 s63, s3, 11
    s_add_u32 s62, s62, s63
    v_lshl_add_u32 v4, v1, 4, s62
    v_bfe_u32 v5, v1, 3, 1
    v_lshrrev_b32 v2, 4, v1
    v_lshl_add_u32 v5, v2, 3, v5
    s_lshl_b32 s62, s3, 1
    v_add_u32 v5, s62, v5
    v_mul_u32_u24 v5, 2048, v5
    v_and_b32 v2, 7, v1
    v_lshl_add_u32 v5, v2, 4, v5
    s_lshl_b32 s62, s7, 7
    v_add_u32 v5, s62, v5
    v_add_u32 v6, 64512, v5
    v_bfe_u32 v8, v1, 3, 2
    v_mul_u32_u24 v8, 2080, v8
    v_bfe_u32 v2, v1, 2, 1
    v_lshl_add_u32 v8, v2, 7, v8
    v_bfe_u32 v2, v1, 5, 1
    v_lshl_add_u32 v8, v2, 8, v8
    v_and_b32 v2, 3, v1
    v_lshl_add_u32 v8, v2, 3, v8
    s_mov_b32 s57, 66560
    v_add_u32 v7, s57, v8
    s_add_u32 s52, s14, 4194304
    s_add_u32 s53, s52, 0x20000
    s_mov_b32 s54, 2097152
    s_mul_i32 s56, s3, 2080
    v_accvgpr_read_b32 v32, a224
    v_accvgpr_read_b32 v33, a225
    v_accvgpr_read_b32 v34, a226
    v_accvgpr_read_b32 v35, a227
    v_accvgpr_read_b32 v36, a228
    v_accvgpr_read_b32 v37, a229
    v_accvgpr_read_b32 v38, a230
    v_accvgpr_read_b32 v39, a231
    v_accvgpr_read_b32 v40, a232
    v_accvgpr_read_b32 v41, a233
    v_accvgpr_read_b32 v42, a234
    v_accvgpr_read_b32 v43, a235
    v_accvgpr_read_b32 v44, a236
    v_accvgpr_read_b32 v45, a237
    v_accvgpr_read_b32 v46, a238
    v_accvgpr_read_b32 v47, a239
    v_accvgpr_read_b32 v48, a240
    v_accvgpr_read_b32 v49, a241
    v_accvgpr_read_b32 v50, a242
    v_accvgpr_read_b32 v51, a243
    v_accvgpr_read_b32 v52, a244
    v_accvgpr_read_b32 v53, a245
    v_accvgpr_read_b32 v54, a246
    v_accvgpr_read_b32 v55, a247
    v_accvgpr_read_b32 v56, a248
    v_accvgpr_read_b32 v57, a249
    v_accvgpr_read_b32 v58, a250
    v_accvgpr_read_b32 v59, a251
    v_accvgpr_read_b32 v60, a252
    v_accvgpr_read_b32 v61, a253
    v_accvgpr_read_b32 v62, a254
    v_accvgpr_read_b32 v63, a255
    s_and_b32 s62, s3, 1
    s_mul_i32 s62, s62, 28672
    s_add_u32 s62, s62, s51
    v_lshrrev_b32 v12, 4, v1
    v_mul_u32_u24 v12, 57344, v12
    v_and_b32 v2, 15, v1
    v_lshl_add_u32 v12, v2, 4, v12
    v_add_u32 v12, s62, v12
    v_add_u32 v13, 6112, v12
    v_add_u32 v14, 12224, v12
    v_add_u32 v15, 18336, v12
    s_mul_i32 s59, s3, 4224
    s_mov_b32 s58, 0
    s_lshl_b32 s62, s8, 7
    s_add_u32 s62, s62, s44
    s_add_u32 s62, s62, 2048
    s_lshl_b32 s64, s6, 7
    s_add_u32 s64, s64, s44
    s_add_u32 s64, s64, 2048
    v_mov_b32 v252, s62
    v_mov_b32 v253, s64
    v_mov_b32 v254, 16
    s_waitcnt vmcnt(0) lgkmcnt(0)

    s_barrier
    s_cmp_lg_u32 s3, 0
    s_cbranch_scc1 .Lnosig15
    v_mov_b32 v255, 1
    s_mov_b64 exec, 1
    buffer_atomic_add v255, v252, s[16:19], 0 offen
    s_mov_b64 exec, -1
.Lnosig15:
    ds_read_b64_tr_b16 a[0:1], v7 offset:0
    ds_read_b64_tr_b16 a[2:3], v7 offset:512
    ds_read_b64_tr_b16 a[4:5], v7 offset:32
    ds_read_b64_tr_b16 a[6:7], v7 offset:544
    ds_read_b64_tr_b16 a[8:9], v7 offset:64
    ds_read_b64_tr_b16 a[10:11], v7 offset:576
    ds_read_b64_tr_b16 a[12:13], v7 offset:96
    ds_read_b64_tr_b16 a[14:15], v7 offset:608
    ds_read_b64_tr_b16 a[16:17], v7 offset:1024
    ds_read_b64_tr_b16 a[18:19], v7 offset:1536
    ds_read_b64_tr_b16 a[20:21], v7 offset:1056
    ds_read_b64_tr_b16 a[22:23], v7 offset:1568
    ds_read_b64_tr_b16 a[24:25], v7 offset:1088
    ds_read_b64_tr_b16 a[26:27], v7 offset:1600
    ds_read_b64_tr_b16 a[28:29], v7 offset:1120
    ds_read_b64_tr_b16 a[30:31], v7 offset:1632
    s_cmp_lg_u32 s14, 0
    s_cbranch_scc1 .Ll016
    s_lshl_b32 s62, s10, 1
    s_add_u32 s62, s62, s48
    s_mul_i32 s63, s62, 458752
    s_add_u32 s63, s63, s51
    v_lshrrev_b32 v9, 4, v1
    v_mul_u32_u24 v9, 7168, v9
    v_and_b32 v2, 15, v1
    v_lshl_add_u32 v9, v2, 4, v9
    buffer_load_dwordx4 v[160:163], v9, s[32:35], s63 offen
    s_add_u32 s63, s63, 28672
    buffer_load_dwordx4 v[164:167], v9, s[32:35], s63 offen
    s_add_u32 s63, s63, 28672
    buffer_load_dwordx4 v[168:171], v9, s[32:35], s63 offen
    s_add_u32 s63, s63, 28672
    buffer_load_dwordx4 v[172:175], v9, s[32:35], s63 offen
    s_add_u32 s63, s63, 28672
    buffer_load_dwordx4 v[176:179], v9, s[32:35], s63 offen
    s_add_u32 s63, s63, 28672
    buffer_load_dwordx4 v[180:183], v9, s[32:35], s63 offen
    s_add_u32 s63, s63, 28672
    buffer_load_dwordx4 v[184:187], v9, s[32:35], s63 offen
    s_add_u32 s63, s63, 28672
    buffer_load_dwordx4 v[188:191], v9, s[32:35], s63 offen
    s_add_u32 s63, s63, 28672
    buffer_load_dwordx4 v[192:195], v9, s[32:35], s63 offen
    s_add_u32 s63, s63, 28672
    buffer_load_dwordx4 v[196:199], v9, s[32:35], s63 offen
    s_add_u32 s63, s63, 28672
    buffer_load_dwordx4 v[200:203], v9, s[32:35], s63 offen
    s_add_u32 s63, s63, 28672
    buffer_load_dwordx4 v[204:207], v9, s[32:35], s63 offen
    s_add_u32 s63, s63, 28672
    buffer_load_dwordx4 v[208:211], v9, s[32:35], s63 offen
    s_add_u32 s63, s63, 28672
    buffer_load_dwordx4 v[212:215], v9, s[32:35], s63 offen
    s_add_u32 s63, s63, 28672
    buffer_load_dwordx4 v[216:219], v9, s[32:35], s63 offen
    s_add_u32 s63, s63, 28672
    buffer_load_dwordx4 v[220:223], v9, s[32:35], s63 offen
    s_add_u32 s63, s63, 28672
    v_and_b32 v2, 1, v1
    v_lshlrev_b32 v2, 4, v2
    v_mov_b32 v9, 0x3f80
    v_lshlrev_b32 v2, v2, v9
    v_bfe_u32 v9, v1, 1, 3
    v_cmp_eq_u32 vcc, 0, v9
    s_nop 1
    v_cndmask_b32 v224, 0, v2, vcc
    v_cmp_eq_u32 vcc, 1, v9
    s_nop 1
    v_cndmask_b32 v225, 0, v2, vcc
    v_cmp_eq_u32 vcc, 2, v9
    s_nop 1
    v_cndmask_b32 v226, 0, v2, vcc
    v_cmp_eq_u32 vcc, 3, v9
    s_nop 1
    v_cndmask_b32 v227, 0, v2, vcc
    s_lshl_b32 s62, s62, 15
    s_lshl_b32 s63, s11, 10
    s_add_u32 s62, s62, s63
    s_lshl_b32 s63, s49, 9
    s_add_u32 s62, s62, s63
    s_add_u32 s62, s62, 31719424
    v_and_b32 v9, 15, v1
    v_lshlrev_b32 v9, 5, v9
    v_bfe_u32 v2, v1, 4, 1
    v_lshl_add_u32 v9, v2, 4, v9
    v_and_b32 v2, 0x20, v1
    v_lshl_add_u32 v9, v2, 25, v9
    s_waitcnt vmcnt(15)
    v_mfma_f32_16x16x32_bf16 v[228:231], v[224:227], v[160:163], 0
    s_waitcnt vmcnt(14)
    v_mfma_f32_16x16x32_bf16 v[228:231], v[224:227], v[164:167], v[228:231]
    s_waitcnt vmcnt(13)
    v_mfma_f32_16x16x32_bf16 v[228:231], v[224:227], v[168:171], v[228:231]
    s_waitcnt vmcnt(12)
    v_mfma_f32_16x16x32_bf16 v[228:231], v[224:227], v[172:175], v[228:231]
    s_waitcnt vmcnt(11)
    v_mfma_f32_16x16x32_bf16 v[228:231], v[224:227], v[176:179], v[228:231]
    s_waitcnt vmcnt(10)
    v_mfma_f32_16x16x32_bf16 v[228:231], v[224:227], v[180:183], v[228:231]
    s_waitcnt vmcnt(9)
    v_mfma_f32_16x16x32_bf16 v[228:231], v[224:227], v[184:187], v[228:231]
    s_waitcnt vmcnt(8)
    v_mfma_f32_16x16x32_bf16 v[228:231], v[224:227], v[188:191], v[228:231]
    s_waitcnt vmcnt(7)
    v_mfma_f32_16x16x32_bf16 v[228:231], v[224:227], v[192:195], v[228:231]
    s_waitcnt vmcnt(6)
    v_mfma_f32_16x16x32_bf16 v[228:231], v[224:227], v[196:199], v[228:231]
    s_waitcnt vmcnt(5)
    v_mfma_f32_16x16x32_bf16 v[228:231], v[224:227], v[200:203], v[228:231]
    s_waitcnt vmcnt(4)
    v_mfma_f32_16x16x32_bf16 v[228:231], v[224:227], v[204:207], v[228:231]
    s_waitcnt vmcnt(3)
    v_mfma_f32_16x16x32_bf16 v[228:231], v[224:227], v[208:211], v[228:231]
    s_waitcnt vmcnt(2)
    v_mfma_f32_16x16x32_bf16 v[228:231], v[224:227], v[212:215], v[228:231]
    s_waitcnt vmcnt(1)
    v_mfma_f32_16x16x32_bf16 v[228:231], v[224:227], v[216:219], v[228:231]
    s_waitcnt vmcnt(0)
    v_mfma_f32_16x16x32_bf16 v[228:231], v[224:227], v[220:223], v[228:231]
    s_nop 7
    buffer_store_dwordx4 v[228:231], v9, s[16:19], s62 offen sc1
    s_nop 1
.Ll016:

    s_waitcnt lgkmcnt(0)
    s_cmp_lg_u32 s3, 1
    s_cbranch_scc1 .Lnopoll19
    s_mov_b64 exec, 1
    s_mov_b32 s15, 0
.Lpoll17:
    buffer_load_dword v255, v253, s[16:19], 0 offen sc1
    s_add_u32 s15, s15, 1
    s_cmp_gt_u32 s15, 100000
    s_cbranch_scc1 .Lgot18
    s_waitcnt vmcnt(0)
    v_cmp_ne_u32 vcc, v255, v254
    s_nop 0
    s_cbranch_vccnz .Lpoll17
.Lgot18:
    s_waitcnt vmcnt(0)
    s_mov_b64 exec, -1
.Lnopoll19:
    s_barrier

    buffer_load_dwordx4 v[64:67], v4, s[16:19], s52 offen offset:0 sc1
    buffer_load_dwordx4 v[68:71], v4, s[16:19], s52 offen offset:1024 sc1
    s_add_u32 s52, s52, 0x40000
    buffer_load_dwordx4 v[72:75], v4, s[16:19], s53 offen offset:0 sc1
    buffer_load_dwordx4 v[76:79], v4, s[16:19], s53 offen offset:1024 sc1
    s_add_u32 s53, s53, 0x40000
    buffer_load_dwordx4 v[80:83], v4, s[16:19], s52 offen offset:0 sc1
    buffer_load_dwordx4 v[84:87], v4, s[16:19], s52 offen offset:1024 sc1
    s_add_u32 s52, s52, 0x40000
    buffer_load_dwordx4 v[88:91], v4, s[16:19], s53 offen offset:0 sc1
    buffer_load_dwordx4 v[92:95], v4, s[16:19], s53 offen offset:1024 sc1
    s_add_u32 s53, s53, 0x40000
    buffer_load_dwordx4 v[96:99], v4, s[16:19], s52 offen offset:0 sc1
    buffer_load_dwordx4 v[100:103], v4, s[16:19], s52 offen offset:1024 sc1
    s_add_u32 s52, s52, 0x40000
    buffer_load_dwordx4 v[104:107], v4, s[16:19], s53 offen offset:0 sc1
    buffer_load_dwordx4 v[108:111], v4, s[16:19], s53 offen offset:1024 sc1
    s_add_u32 s53, s53, 0x40000
    s_mov_b32 s15, 3
.p2align 6
.Lpj20:
    s_waitcnt lgkmcnt(0)
    s_waitcnt vmcnt(11)
    v_mfma_f32_16x16x32_bf16 v[32:35], a[0:3], v[64:67], v[32:35]
    ds_read_b64_tr_b16 a[32:33], v7 offset:8320
    ds_read_b64_tr_b16 a[34:35], v7 offset:8832
    s_waitcnt vmcnt(10)
    v_mfma_f32_16x16x32_bf16 v[48:51], a[0:3], v[68:71], v[48:51]
    buffer_load_dwordx4 v[112:115], v4, s[16:19], s52 offen offset:0 sc1
    ds_read_b64_tr_b16 a[36:37], v7 offset:8352
    v_mfma_f32_16x16x32_bf16 v[36:39], a[4:7], v[64:67], v[36:39]
    ds_read_b64_tr_b16 a[38:39], v7 offset:8864
    ds_read_b64_tr_b16 a[40:41], v7 offset:8384
    v_mfma_f32_16x16x32_bf16 v[52:55], a[4:7], v[68:71], v[52:55]
    ds_read_b64_tr_b16 a[42:43], v7 offset:8896
    ds_read_b64_tr_b16 a[44:45], v7 offset:8416
    v_mfma_f32_16x16x32_bf16 v[40:43], a[8:11], v[64:67], v[40:43]
    buffer_load_dwordx4 v[116:119], v4, s[16:19], s52 offen offset:1024 sc1
    v_mfma_f32_16x16x32_bf16 v[56:59], a[8:11], v[68:71], v[56:59]
    s_add_u32 s52, s52, 0x40000
    ds_read_b64_tr_b16 a[46:47], v7 offset:8928
    v_mfma_f32_16x16x32_bf16 v[44:47], a[12:15], v[64:67], v[44:47]
    ds_read_b64_tr_b16 a[48:49], v7 offset:9344
    ds_read_b64_tr_b16 a[50:51], v7 offset:9856
    v_mfma_f32_16x16x32_bf16 v[60:63], a[12:15], v[68:71], v[60:63]
    ds_read_b64_tr_b16 a[52:53], v7 offset:9376
    ds_read_b64_tr_b16 a[54:55], v7 offset:9888
    s_waitcnt vmcnt(11)
    v_mfma_f32_16x16x32_bf16 v[32:35], a[16:19], v[72:75], v[32:35]
    buffer_load_dwordx4 v[120:123], v4, s[16:19], s53 offen offset:0 sc1
    ds_read_b64_tr_b16 a[56:57], v7 offset:9408
    s_waitcnt vmcnt(11)
    v_mfma_f32_16x16x32_bf16 v[48:51], a[16:19], v[76:79], v[48:51]
    ds_read_b64_tr_b16 a[58:59], v7 offset:9920
    ds_read_b64_tr_b16 a[60:61], v7 offset:9440
    v_mfma_f32_16x16x32_bf16 v[36:39], a[20:23], v[72:75], v[36:39]
    ds_read_b64_tr_b16 a[62:63], v7 offset:9952
    v_mfma_f32_16x16x32_bf16 v[52:55], a[20:23], v[76:79], v[52:55]
    v_mfma_f32_16x16x32_bf16 v[40:43], a[24:27], v[72:75], v[40:43]
    buffer_load_dwordx4 v[124:127], v4, s[16:19], s53 offen offset:1024 sc1
    v_mfma_f32_16x16x32_bf16 v[56:59], a[24:27], v[76:79], v[56:59]
    s_add_u32 s53, s53, 0x40000
    v_mfma_f32_16x16x32_bf16 v[44:47], a[28:31], v[72:75], v[44:47]
    v_mfma_f32_16x16x32_bf16 v[60:63], a[28:31], v[76:79], v[60:63]
    s_waitcnt lgkmcnt(0)
    s_waitcnt vmcnt(11)
    v_mfma_f32_16x16x32_bf16 v[32:35], a[32:35], v[80:83], v[32:35]
    ds_read_b64_tr_b16 a[0:1], v7 offset:16640
    ds_read_b64_tr_b16 a[2:3], v7 offset:17152
    s_waitcnt vmcnt(10)
    v_mfma_f32_16x16x32_bf16 v[48:51], a[32:35], v[84:87], v[48:51]
    buffer_load_dwordx4 v[64:67], v4, s[16:19], s52 offen offset:0 sc1
    ds_read_b64_tr_b16 a[4:5], v7 offset:16672
    v_mfma_f32_16x16x32_bf16 v[36:39], a[36:39], v[80:83], v[36:39]
    ds_read_b64_tr_b16 a[6:7], v7 offset:17184
    ds_read_b64_tr_b16 a[8:9], v7 offset:16704
    v_mfma_f32_16x16x32_bf16 v[52:55], a[36:39], v[84:87], v[52:55]
    ds_read_b64_tr_b16 a[10:11], v7 offset:17216
    ds_read_b64_tr_b16 a[12:13], v7 offset:16736
    v_mfma_f32_16x16x32_bf16 v[40:43], a[40:43], v[80:83], v[40:43]
    buffer_load_dwordx4 v[68:71], v4, s[16:19], s52 offen offset:1024 sc1
    v_mfma_f32_16x16x32_bf16 v[56:59], a[40:43], v[84:87], v[56:59]
    s_add_u32 s52, s52, 0x40000
    ds_read_b64_tr_b16 a[14:15], v7 offset:17248
    v_mfma_f32_16x16x32_bf16 v[44:47], a[44:47], v[80:83], v[44:47]
    ds_read_b64_tr_b16 a[16:17], v7 offset:17664
    ds_read_b64_tr_b16 a[18:19], v7 offset:18176
    v_mfma_f32_16x16x32_bf16 v[60:63], a[44:47], v[84:87], v[60:63]
    ds_read_b64_tr_b16 a[20:21], v7 offset:17696
    ds_read_b64_tr_b16 a[22:23], v7 offset:18208
    s_waitcnt vmcnt(11)
    v_mfma_f32_16x16x32_bf16 v[32:35], a[48:51], v[88:91], v[32:35]
    buffer_load_dwordx4 v[72:75], v4, s[16:19], s53 offen offset:0 sc1
    ds_read_b64_tr_b16 a[24:25], v7 offset:17728
    s_waitcnt vmcnt(11)
    v_mfma_f32_16x16x32_bf16 v[48:51], a[48:51], v[92:95], v[48:51]
    ds_read_b64_tr_b16 a[26:27], v7 offset:18240
    ds_read_b64_tr_b16 a[28:29], v7 offset:17760
    v_mfma_f32_16x16x32_bf16 v[36:39], a[52:55], v[88:91], v[36:39]
    ds_read_b64_tr_b16 a[30:31], v7 offset:18272
    v_mfma_f32_16x16x32_bf16 v[52:55], a[52:55], v[92:95], v[52:55]
    v_mfma_f32_16x16x32_bf16 v[40:43], a[56:59], v[88:91], v[40:43]
    buffer_load_dwordx4 v[76:79], v4, s[16:19], s53 offen offset:1024 sc1
    v_mfma_f32_16x16x32_bf16 v[56:59], a[56:59], v[92:95], v[56:59]
    s_add_u32 s53, s53, 0x40000
    v_mfma_f32_16x16x32_bf16 v[44:47], a[60:63], v[88:91], v[44:47]
    v_mfma_f32_16x16x32_bf16 v[60:63], a[60:63], v[92:95], v[60:63]
    s_waitcnt lgkmcnt(0)
    s_waitcnt vmcnt(11)
    v_mfma_f32_16x16x32_bf16 v[32:35], a[0:3], v[96:99], v[32:35]
    ds_read_b64_tr_b16 a[32:33], v7 offset:24960
    ds_read_b64_tr_b16 a[34:35], v7 offset:25472
    s_waitcnt vmcnt(10)
    v_mfma_f32_16x16x32_bf16 v[48:51], a[0:3], v[100:103], v[48:51]
    buffer_load_dwordx4 v[80:83], v4, s[16:19], s52 offen offset:0 sc1
    ds_read_b64_tr_b16 a[36:37], v7 offset:24992
    v_mfma_f32_16x16x32_bf16 v[36:39], a[4:7], v[96:99], v[36:39]
    ds_read_b64_tr_b16 a[38:39], v7 offset:25504
    ds_read_b64_tr_b16 a[40:41], v7 offset:25024
    v_mfma_f32_16x16x32_bf16 v[52:55], a[4:7], v[100:103], v[52:55]
    ds_read_b64_tr_b16 a[42:43], v7 offset:25536
    ds_read_b64_tr_b16 a[44:45], v7 offset:25056
    v_mfma_f32_16x16x32_bf16 v[40:43], a[8:11], v[96:99], v[40:43]
    buffer_load_dwordx4 v[84:87], v4, s[16:19], s52 offen offset:1024 sc1
    v_mfma_f32_16x16x32_bf16 v[56:59], a[8:11], v[100:103], v[56:59]
    s_add_u32 s52, s52, 0x40000
    ds_read_b64_tr_b16 a[46:47], v7 offset:25568
    v_mfma_f32_16x16x32_bf16 v[44:47], a[12:15], v[96:99], v[44:47]
    ds_read_b64_tr_b16 a[48:49], v7 offset:25984
    ds_read_b64_tr_b16 a[50:51], v7 offset:26496
    v_mfma_f32_16x16x32_bf16 v[60:63], a[12:15], v[100:103], v[60:63]
    ds_read_b64_tr_b16 a[52:53], v7 offset:26016
    ds_read_b64_tr_b16 a[54:55], v7 offset:26528
    s_waitcnt vmcnt(11)
    v_mfma_f32_16x16x32_bf16 v[32:35], a[16:19], v[104:107], v[32:35]
    buffer_load_dwordx4 v[88:91], v4, s[16:19], s53 offen offset:0 sc1
    ds_read_b64_tr_b16 a[56:57], v7 offset:26048
    s_waitcnt vmcnt(11)
    v_mfma_f32_16x16x32_bf16 v[48:51], a[16:19], v[108:111], v[48:51]
    ds_read_b64_tr_b16 a[58:59], v7 offset:26560
    ds_read_b64_tr_b16 a[60:61], v7 offset:26080
    v_mfma_f32_16x16x32_bf16 v[36:39], a[20:23], v[104:107], v[36:39]
    ds_read_b64_tr_b16 a[62:63], v7 offset:26592
    v_mfma_f32_16x16x32_bf16 v[52:55], a[20:23], v[108:111], v[52:55]
    v_mfma_f32_16x16x32_bf16 v[40:43], a[24:27], v[104:107], v[40:43]
    buffer_load_dwordx4 v[92:95], v4, s[16:19], s53 offen offset:1024 sc1
    v_mfma_f32_16x16x32_bf16 v[56:59], a[24:27], v[108:111], v[56:59]
    s_add_u32 s53, s53, 0x40000
    v_mfma_f32_16x16x32_bf16 v[44:47], a[28:31], v[104:107], v[44:47]
    v_mfma_f32_16x16x32_bf16 v[60:63], a[28:31], v[108:111], v[60:63]
    s_waitcnt lgkmcnt(0)
    s_add_u32 s57, s57, 33280
    s_cmp_eq_u32 s57, 133120
    s_cselect_b32 s57, 0, s57
    v_add_u32 v7, s57, v8
    s_waitcnt vmcnt(11)
    v_mfma_f32_16x16x32_bf16 v[32:35], a[32:35], v[112:115], v[32:35]
    ds_read_b64_tr_b16 a[0:1], v7 offset:0
    ds_read_b64_tr_b16 a[2:3], v7 offset:512
    s_waitcnt vmcnt(10)
    v_mfma_f32_16x16x32_bf16 v[48:51], a[32:35], v[116:119], v[48:51]
    buffer_load_dwordx4 v[96:99], v4, s[16:19], s52 offen offset:0 sc1
    ds_read_b64_tr_b16 a[4:5], v7 offset:32
    v_mfma_f32_16x16x32_bf16 v[36:39], a[36:39], v[112:115], v[36:39]
    ds_read_b64_tr_b16 a[6:7], v7 offset:544
    ds_read_b64_tr_b16 a[8:9], v7 offset:64
    v_mfma_f32_16x16x32_bf16 v[52:55], a[36:39], v[116:119], v[52:55]
    ds_read_b64_tr_b16 a[10:11], v7 offset:576
    ds_read_b64_tr_b16 a[12:13], v7 offset:96
    v_mfma_f32_16x16x32_bf16 v[40:43], a[40:43], v[112:115], v[40:43]
    buffer_load_dwordx4 v[100:103], v4, s[16:19], s52 offen offset:1024 sc1
    v_mfma_f32_16x16x32_bf16 v[56:59], a[40:43], v[116:119], v[56:59]
    s_add_u32 s52, s52, 0x40000
    ds_read_b64_tr_b16 a[14:15], v7 offset:608
    v_mfma_f32_16x16x32_bf16 v[44:47], a[44:47], v[112:115], v[44:47]
    ds_read_b64_tr_b16 a[16:17], v7 offset:1024
    ds_read_b64_tr_b16 a[18:19], v7 offset:1536
    v_mfma_f32_16x16x32_bf16 v[60:63], a[44:47], v[116:119], v[60:63]
    ds_read_b64_tr_b16 a[20:21], v7 offset:1056
    ds_read_b64_tr_b16 a[22:23], v7 offset:1568
    s_waitcnt vmcnt(11)
    v_mfma_f32_16x16x32_bf16 v[32:35], a[48:51], v[120:123], v[32:35]
    buffer_load_dwordx4 v[104:107], v4, s[16:19], s53 offen offset:0 sc1
    ds_read_b64_tr_b16 a[24:25], v7 offset:1088
    s_waitcnt vmcnt(11)
    v_mfma_f32_16x16x32_bf16 v[48:51], a[48:51], v[124:127], v[48:51]
    ds_read_b64_tr_b16 a[26:27], v7 offset:1600
    ds_read_b64_tr_b16 a[28:29], v7 offset:1120
    v_mfma_f32_16x16x32_bf16 v[36:39], a[52:55], v[120:123], v[36:39]
    ds_read_b64_tr_b16 a[30:31], v7 offset:1632
    v_mfma_f32_16x16x32_bf16 v[52:55], a[52:55], v[124:127], v[52:55]
    v_mfma_f32_16x16x32_bf16 v[40:43], a[56:59], v[120:123], v[40:43]
    buffer_load_dwordx4 v[108:111], v4, s[16:19], s53 offen offset:1024 sc1
    v_mfma_f32_16x16x32_bf16 v[56:59], a[56:59], v[124:127], v[56:59]
    s_add_u32 s53, s53, 0x40000
    v_mfma_f32_16x16x32_bf16 v[44:47], a[60:63], v[120:123], v[44:47]
    v_mfma_f32_16x16x32_bf16 v[60:63], a[60:63], v[124:127], v[60:63]
    s_sub_u32 s15, s15, 1
    s_cmp_lg_u32 s15, 0
    s_cbranch_scc1 .Lpj20
    s_waitcnt lgkmcnt(0)
    s_barrier
    s_waitcnt vmcnt(11)
    v_mfma_f32_16x16x32_bf16 v[32:35], a[0:3], v[64:67], v[32:35]
    ds_read_b64_tr_b16 a[32:33], v7 offset:8320
    ds_read_b64_tr_b16 a[34:35], v7 offset:8832
    ds_read_b64_tr_b16 a[36:37], v7 offset:8352
    s_waitcnt vmcnt(10)
    v_mfma_f32_16x16x32_bf16 v[48:51], a[0:3], v[68:71], v[48:51]
    buffer_load_dwordx4 v[112:115], v4, s[16:19], s52 offen offset:0 sc1
    ds_read_b64_tr_b16 a[38:39], v7 offset:8864
    v_mfma_f32_16x16x32_bf16 v[36:39], a[4:7], v[64:67], v[36:39]
    buffer_load_dwordx4 v[116:119], v4, s[16:19], s52 offen offset:1024 sc1
    ds_read_b64_tr_b16 a[40:41], v7 offset:8384
    v_mfma_f32_16x16x32_bf16 v[52:55], a[4:7], v[68:71], v[52:55]
    s_add_u32 s52, s52, 0x40000
    ds_read_b64_tr_b16 a[42:43], v7 offset:8896
    ds_read_b64_tr_b16 a[44:45], v7 offset:8416
    v_mfma_f32_16x16x32_bf16 v[40:43], a[8:11], v[64:67], v[40:43]
    buffer_load_dwordx4 v[120:123], v4, s[16:19], s53 offen offset:0 sc1
    ds_read_b64_tr_b16 a[46:47], v7 offset:8928
    v_mfma_f32_16x16x32_bf16 v[56:59], a[8:11], v[68:71], v[56:59]
    ds_read_b64_tr_b16 a[48:49], v7 offset:9344
    ds_read_b64_tr_b16 a[50:51], v7 offset:9856
    v_mfma_f32_16x16x32_bf16 v[44:47], a[12:15], v[64:67], v[44:47]
    buffer_load_dwordx4 v[124:127], v4, s[16:19], s53 offen offset:1024 sc1
    ds_read_b64_tr_b16 a[52:53], v7 offset:9376
    v_mfma_f32_16x16x32_bf16 v[60:63], a[12:15], v[68:71], v[60:63]
    s_add_u32 s53, s53, 0x40000
    s_add_u32 m0, s59, 83200
    ds_read_b64_tr_b16 a[54:55], v7 offset:9888
    s_waitcnt vmcnt(13)
    v_mfma_f32_16x16x32_bf16 v[32:35], a[16:19], v[72:75], v[32:35]
    buffer_load_dwordx4 v12, s[32:35], s58 offen offset:0 lds
    ds_read_b64_tr_b16 a[56:57], v7 offset:9408
    s_waitcnt vmcnt(13)
    v_mfma_f32_16x16x32_bf16 v[48:51], a[16:19], v[76:79], v[48:51]
    ds_read_b64_tr_b16 a[58:59], v7 offset:9920
    ds_read_b64_tr_b16 a[60:61], v7 offset:9440
    ds_read_b64_tr_b16 a[62:63], v7 offset:9952
    v_mfma_f32_16x16x32_bf16 v[36:39], a[20:23], v[72:75], v[36:39]
    buffer_load_dwordx4 v13, s[32:35], s58 offen offset:1056 lds
    v_mfma_f32_16x16x32_bf16 v[52:55], a[20:23], v[76:79], v[52:55]
    v_mfma_f32_16x16x32_bf16 v[40:43], a[24:27], v[72:75], v[40:43]
    buffer_load_dwordx4 v14, s[32:35], s58 offen offset:2112 lds
    v_mfma_f32_16x16x32_bf16 v[56:59], a[24:27], v[76:79], v[56:59]
    v_mfma_f32_16x16x32_bf16 v[44:47], a[28:31], v[72:75], v[44:47]
    buffer_load_dwordx4 v15, s[32:35], s58 offen offset:3168 lds
    v_mfma_f32_16x16x32_bf16 v[60:63], a[28:31], v[76:79], v[60:63]
    s_add_u32 s58, s58, 229376
    s_waitcnt lgkmcnt(0)
    s_waitcnt vmcnt(15)
    v_mfma_f32_16x16x32_bf16 v[32:35], a[32:35], v[80:83], v[32:35]
    s_add_u32 m0, s59, 100096
    ds_read_b64_tr_b16 a[0:1], v7 offset:16640
    ds_read_b64_tr_b16 a[2:3], v7 offset:17152
    s_waitcnt vmcnt(14)
    v_mfma_f32_16x16x32_bf16 v[48:51], a[32:35], v[84:87], v[48:51]
    buffer_load_dwordx4 v12, s[32:35], s58 offen offset:0 lds
    v_mfma_f32_16x16x32_bf16 v[36:39], a[36:39], v[80:83], v[36:39]
    ds_read_b64_tr_b16 a[4:5], v7 offset:16672
    ds_read_b64_tr_b16 a[6:7], v7 offset:17184
    v_mfma_f32_16x16x32_bf16 v[52:55], a[36:39], v[84:87], v[52:55]
    ds_read_b64_tr_b16 a[8:9], v7 offset:16704
    ds_read_b64_tr_b16 a[10:11], v7 offset:17216
    v_mfma_f32_16x16x32_bf16 v[40:43], a[40:43], v[80:83], v[40:43]
    buffer_load_dwordx4 v13, s[32:35], s58 offen offset:1056 lds
    ds_read_b64_tr_b16 a[12:13], v7 offset:16736
    v_mfma_f32_16x16x32_bf16 v[56:59], a[40:43], v[84:87], v[56:59]
    ds_read_b64_tr_b16 a[14:15], v7 offset:17248
    v_mfma_f32_16x16x32_bf16 v[44:47], a[44:47], v[80:83], v[44:47]
    ds_read_b64_tr_b16 a[16:17], v7 offset:17664
    ds_read_b64_tr_b16 a[18:19], v7 offset:18176
    v_mfma_f32_16x16x32_bf16 v[60:63], a[44:47], v[84:87], v[60:63]
    ds_read_b64_tr_b16 a[20:21], v7 offset:17696
    ds_read_b64_tr_b16 a[22:23], v7 offset:18208
    s_waitcnt vmcnt(15)
    v_mfma_f32_16x16x32_bf16 v[32:35], a[48:51], v[88:91], v[32:35]
    buffer_load_dwordx4 v14, s[32:35], s58 offen offset:2112 lds
    ds_read_b64_tr_b16 a[24:25], v7 offset:17728
    s_waitcnt vmcnt(15)
    v_mfma_f32_16x16x32_bf16 v[48:51], a[48:51], v[92:95], v[48:51]
    ds_read_b64_tr_b16 a[26:27], v7 offset:18240
    ds_read_b64_tr_b16 a[28:29], v7 offset:17760
    v_mfma_f32_16x16x32_bf16 v[36:39], a[52:55], v[88:91], v[36:39]
    ds_read_b64_tr_b16 a[30:31], v7 offset:18272
    v_mfma_f32_16x16x32_bf16 v[52:55], a[52:55], v[92:95], v[52:55]
    v_mfma_f32_16x16x32_bf16 v[40:43], a[56:59], v[88:91], v[40:43]
    buffer_load_dwordx4 v15, s[32:35], s58 offen offset:3168 lds
    v_mfma_f32_16x16x32_bf16 v[56:59], a[56:59], v[92:95], v[56:59]
    s_add_u32 s58, s58, 229376
    v_mfma_f32_16x16x32_bf16 v[44:47], a[60:63], v[88:91], v[44:47]
    v_mfma_f32_16x16x32_bf16 v[60:63], a[60:63], v[92:95], v[60:63]
    s_waitcnt lgkmcnt(0)
    s_waitcnt vmcnt(15)
    v_mfma_f32_16x16x32_bf16 v[32:35], a[0:3], v[96:99], v[32:35]
    s_add_u32 m0, s59, 116992
    ds_read_b64_tr_b16 a[32:33], v7 offset:24960
    ds_read_b64_tr_b16 a[34:35], v7 offset:25472
    s_waitcnt vmcnt(14)
    v_mfma_f32_16x16x32_bf16 v[48:51], a[0:3], v[100:103], v[48:51]
    buffer_load_dwordx4 v12, s[32:35], s58 offen offset:0 lds
    v_mfma_f32_16x16x32_bf16 v[36:39], a[4:7], v[96:99], v[36:39]
    ds_read_b64_tr_b16 a[36:37], v7 offset:24992
    ds_read_b64_tr_b16 a[38:39], v7 offset:25504
    v_mfma_f32_16x16x32_bf16 v[52:55], a[4:7], v[100:103], v[52:55]
    ds_read_b64_tr_b16 a[40:41], v7 offset:25024
    ds_read_b64_tr_b16 a[42:43], v7 offset:25536
    v_mfma_f32_16x16x32_bf16 v[40:43], a[8:11], v[96:99], v[40:43]
    buffer_load_dwordx4 v13, s[32:35], s58 offen offset:1056 lds
    ds_read_b64_tr_b16 a[44:45], v7 offset:25056
    v_mfma_f32_16x16x32_bf16 v[56:59], a[8:11], v[100:103], v[56:59]
    ds_read_b64_tr_b16 a[46:47], v7 offset:25568
    v_mfma_f32_16x16x32_bf16 v[44:47], a[12:15], v[96:99], v[44:47]
    ds_read_b64_tr_b16 a[48:49], v7 offset:25984
    ds_read_b64_tr_b16 a[50:51], v7 offset:26496
    v_mfma_f32_16x16x32_bf16 v[60:63], a[12:15], v[100:103], v[60:63]
    ds_read_b64_tr_b16 a[52:53], v7 offset:26016
    ds_read_b64_tr_b16 a[54:55], v7 offset:26528
    s_waitcnt vmcnt(15)
    v_mfma_f32_16x16x32_bf16 v[32:35], a[16:19], v[104:107], v[32:35]
    buffer_load_dwordx4 v14, s[32:35], s58 offen offset:2112 lds
    ds_read_b64_tr_b16 a[56:57], v7 offset:26048
    s_waitcnt vmcnt(15)
    v_mfma_f32_16x16x32_bf16 v[48:51], a[16:19], v[108:111], v[48:51]
    ds_read_b64_tr_b16 a[58:59], v7 offset:26560
    ds_read_b64_tr_b16 a[60:61], v7 offset:26080
    v_mfma_f32_16x16x32_bf16 v[36:39], a[20:23], v[104:107], v[36:39]
    ds_read_b64_tr_b16 a[62:63], v7 offset:26592
    v_mfma_f32_16x16x32_bf16 v[52:55], a[20:23], v[108:111], v[52:55]
    v_mfma_f32_16x16x32_bf16 v[40:43], a[24:27], v[104:107], v[40:43]
    buffer_load_dwordx4 v15, s[32:35], s58 offen offset:3168 lds
    v_mfma_f32_16x16x32_bf16 v[56:59], a[24:27], v[108:111], v[56:59]
    s_add_u32 s58, s58, 229376
    v_mfma_f32_16x16x32_bf16 v[44:47], a[28:31], v[104:107], v[44:47]
    v_mfma_f32_16x16x32_bf16 v[60:63], a[28:31], v[108:111], v[60:63]
    s_waitcnt lgkmcnt(0)
    s_waitcnt vmcnt(15)
    v_mfma_f32_16x16x32_bf16 v[32:35], a[32:35], v[112:115], v[32:35]
    s_add_u32 m0, s59, 133888
    s_waitcnt vmcnt(14)
    v_mfma_f32_16x16x32_bf16 v[48:51], a[32:35], v[116:119], v[48:51]
    buffer_load_dwordx4 v12, s[32:35], s58 offen offset:0 lds
    v_mfma_f32_16x16x32_bf16 v[36:39], a[36:39], v[112:115], v[36:39]
    v_mfma_f32_16x16x32_bf16 v[52:55], a[36:39], v[116:119], v[52:55]
    v_mfma_f32_16x16x32_bf16 v[40:43], a[40:43], v[112:115], v[40:43]
    buffer_load_dwordx4 v13, s[32:35], s58 offen offset:1056 lds
    v_mfma_f32_16x16x32_bf16 v[56:59], a[40:43], v[116:119], v[56:59]
    v_mfma_f32_16x16x32_bf16 v[44:47], a[44:47], v[112:115], v[44:47]
    v_mfma_f32_16x16x32_bf16 v[60:63], a[44:47], v[116:119], v[60:63]
    s_waitcnt vmcnt(15)
    v_mfma_f32_16x16x32_bf16 v[32:35], a[48:51], v[120:123], v[32:35]
    buffer_load_dwordx4 v14, s[32:35], s58 offen offset:2112 lds
    s_waitcnt vmcnt(15)
    v_mfma_f32_16x16x32_bf16 v[48:51], a[48:51], v[124:127], v[48:51]
    v_mfma_f32_16x16x32_bf16 v[36:39], a[52:55], v[120:123], v[36:39]
    v_mfma_f32_16x16x32_bf16 v[52:55], a[52:55], v[124:127], v[52:55]
    v_mfma_f32_16x16x32_bf16 v[40:43], a[56:59], v[120:123], v[40:43]
    buffer_load_dwordx4 v15, s[32:35], s58 offen offset:3168 lds
    v_mfma_f32_16x16x32_bf16 v[56:59], a[56:59], v[124:127], v[56:59]
    s_add_u32 s58, s58, 229376
    v_mfma_f32_16x16x32_bf16 v[44:47], a[60:63], v[120:123], v[44:47]
    v_mfma_f32_16x16x32_bf16 v[60:63], a[60:63], v[124:127], v[60:63]
    s_lshl_b32 s62, s7, 18
    s_add_u32 s62, s62, s14
    s_add_u32 s62, s62, 8388608
    s_add_u32 s63, s62, 0x20000
    v_cvt_pk_bf16_f32 v128, v32, v33
    v_cvt_pk_bf16_f32 v129, v34, v35
    v_cvt_pk_bf16_f32 v130, v36, v37
    v_cvt_pk_bf16_f32 v131, v38, v39
    buffer_store_dwordx4 v[128:131], v4, s[16:19], s62 offen offset:0 sc1
    v_cvt_pk_bf16_f32 v132, v40, v41
    v_cvt_pk_bf16_f32 v133, v42, v43
    v_cvt_pk_bf16_f32 v134, v44, v45
    v_cvt_pk_bf16_f32 v135, v46, v47
    buffer_store_dwordx4 v[132:135], v4, s[16:19], s63 offen offset:0 sc1
    v_cvt_pk_bf16_f32 v136, v48, v49
    v_cvt_pk_bf16_f32 v137, v50, v51
    v_cvt_pk_bf16_f32 v138, v52, v53
    v_cvt_pk_bf16_f32 v139, v54, v55
    buffer_store_dwordx4 v[136:139], v4, s[16:19], s62 offen offset:1024 sc1
    v_cvt_pk_bf16_f32 v140, v56, v57
    v_cvt_pk_bf16_f32 v141, v58, v59
    v_cvt_pk_bf16_f32 v142, v60, v61
    v_cvt_pk_bf16_f32 v143, v62, v63
    buffer_store_dwordx4 v[140:143], v4, s[16:19], s63 offen offset:1024 sc1
    v_pk_mul_f32 v[146:147], v[32:33], v[32:33]
    v_pk_fma_f32 v[146:147], v[34:35], v[34:35], v[146:147]
    v_pk_add_f32 v[144:145], v[32:33], v[34:35]
    v_pk_fma_f32 v[146:147], v[36:37], v[36:37], v[146:147]
    v_pk_add_f32 v[144:145], v[144:145], v[36:37]
    v_pk_fma_f32 v[146:147], v[38:39], v[38:39], v[146:147]
    v_pk_add_f32 v[144:145], v[144:145], v[38:39]
    v_pk_fma_f32 v[146:147], v[40:41], v[40:41], v[146:147]
    v_pk_add_f32 v[144:145], v[144:145], v[40:41]
    v_pk_fma_f32 v[146:147], v[42:43], v[42:43], v[146:147]
    v_pk_add_f32 v[144:145], v[144:145], v[42:43]
    v_pk_fma_f32 v[146:147], v[44:45], v[44:45], v[146:147]
    v_pk_add_f32 v[144:145], v[144:145], v[44:45]
    v_pk_fma_f32 v[146:147], v[46:47], v[46:47], v[146:147]
    v_pk_add_f32 v[144:145], v[144:145], v[46:47]
    v_add_f32 v144, v144, v145
    v_add_f32 v146, v146, v147
    v_pk_mul_f32 v[150:151], v[48:49], v[48:49]
    v_pk_fma_f32 v[150:151], v[50:51], v[50:51], v[150:151]
    v_pk_add_f32 v[148:149], v[48:49], v[50:51]
    v_pk_fma_f32 v[150:151], v[52:53], v[52:53], v[150:151]
    v_pk_add_f32 v[148:149], v[148:149], v[52:53]
    v_pk_fma_f32 v[150:151], v[54:55], v[54:55], v[150:151]
    v_pk_add_f32 v[148:149], v[148:149], v[54:55]
    v_pk_fma_f32 v[150:151], v[56:57], v[56:57], v[150:151]
    v_pk_add_f32 v[148:149], v[148:149], v[56:57]
    v_pk_fma_f32 v[150:151], v[58:59], v[58:59], v[150:151]
    v_pk_add_f32 v[148:149], v[148:149], v[58:59]
    v_pk_fma_f32 v[150:151], v[60:61], v[60:61], v[150:151]
    v_pk_add_f32 v[148:149], v[148:149], v[60:61]
    v_pk_fma_f32 v[150:151], v[62:63], v[62:63], v[150:151]
    v_pk_add_f32 v[148:149], v[148:149], v[62:63]
    v_add_f32 v148, v148, v149
    v_add_f32 v150, v150, v151
    s_lshl_b32 s64, s7, 14
    v_permlane16_swap_b32 v144, v148
    s_lshl_b32 s65, s6, 10
    v_permlane16_swap_b32 v146, v150
    v_add_f32 v144, v144, v148
    v_add_f32 v146, v146, v150
    s_add_u32 s64, s64, s65
    s_lshl_b32 s65, s3, 8
    v_permlane32_swap_b32 v144, v146
    s_add_u32 s64, s64, s65
    s_add_u32 s64, s64, s14
    s_add_u32 s64, s64, 29622272
    v_and_b32 v152, 31, v1
    v_lshlrev_b32 v152, 3, v152
    v_lshrrev_b32 v153, 5, v1
    v_lshl_add_u32 v152, v153, 2, v152
    v_add_f32 v144, v144, v146
    buffer_store_dword v144, v152, s[16:19], s64 offen sc1
    s_nop 1
    v_accvgpr_write_b32 a224, v32
    v_accvgpr_write_b32 a225, v33
    v_accvgpr_write_b32 a226, v34
    v_accvgpr_write_b32 a227, v35
    v_accvgpr_write_b32 a228, v36
    v_accvgpr_write_b32 a229, v37
    v_accvgpr_write_b32 a230, v38
    v_accvgpr_write_b32 a231, v39
    v_accvgpr_write_b32 a232, v40
    v_accvgpr_write_b32 a233, v41
    v_accvgpr_write_b32 a234, v42
    v_accvgpr_write_b32 a235, v43
    v_accvgpr_write_b32 a236, v44
    v_accvgpr_write_b32 a237, v45
    v_accvgpr_write_b32 a238, v46
    v_accvgpr_write_b32 a239, v47
    v_accvgpr_write_b32 a240, v48
    v_accvgpr_write_b32 a241, v49
    v_accvgpr_write_b32 a242, v50
    v_accvgpr_write_b32 a243, v51
    v_accvgpr_write_b32 a244, v52
    v_accvgpr_write_b32 a245, v53
    v_accvgpr_write_b32 a246, v54
    v_accvgpr_write_b32 a247, v55
    v_accvgpr_write_b32 a248, v56
    v_accvgpr_write_b32 a249, v57
    v_accvgpr_write_b32 a250, v58
    v_accvgpr_write_b32 a251, v59
    v_accvgpr_write_b32 a252, v60
    v_accvgpr_write_b32 a253, v61
    v_accvgpr_write_b32 a254, v62
    v_accvgpr_write_b32 a255, v63
    s_lshl_b32 s62, s10, 14
    s_lshl_b32 s63, s3, 12
    s_add_u32 s62, s62, s63
    s_lshl_b32 s63, s12, 11
    s_add_u32 s62, s62, s63
    v_lshl_add_u32 v10, v1, 4, s62
    v_xor_b32 v11, 2048, v10
    v_bfe_u32 v16, v1, 2, 3
    v_mul_u32_u24 v16, 1056, v16
    v_bfe_u32 v2, v1, 5, 1
    v_lshl_add_u32 v16, v2, 8, v16
    v_and_b32 v2, 3, v1
    v_lshl_add_u32 v16, v2, 3, v16
    s_lshl_b32 s62, s12, 6
    s_add_u32 s62, s62, 83200
    s_xor_b32 s63, s12, 1
    s_mul_i32 s63, s63, 192
    s_add_u32 s63, s63, 83200
    v_add_u32 v17, s63, v16
    v_add_u32 v16, s62, v16
    s_add_u32 s52, s14, 8388608
    s_mov_b32 s54, s58
    s_mov_b32 s55, s59
    s_mul_i32 s59, s3, 2080
    s_lshl_b32 s62, s10, 11
    v_lshl_add_u32 v4, v0, 3, s62
    s_lshl_b32 s62, s6, 7
    s_add_u32 s62, s62, s44
    s_add_u32 s62, s62, 4096
    s_lshl_b32 s63, s11, 7
    s_add_u32 s63, s63, 30427136
    s_lshl_b32 s64, s10, 1
    s_lshl_b32 s64, s64, 7
    s_add_u32 s64, s64, s44
    s_add_u32 s64, s64, 4096
    s_add_u32 s65, s64, 128
    s_cmp_eq_u32 s14, 0
    s_cselect_b32 s66, 3, 1
    s_mov_b32 s67, 0
    v_mov_b32 v252, s62
    v_mov_b32 v253, s64
    v_mov_b32 v254, 16
    v_writelane_b32 v252, s63, 1
    v_writelane_b32 v253, s65, 1
    v_writelane_b32 v253, s63, 2
    v_writelane_b32 v254, 8, 2
    s_waitcnt vmcnt(0) lgkmcnt(0)

    s_barrier
    s_cmp_lg_u32 s3, 0
    s_cbranch_scc1 .Lnosig21
    v_mov_b32 v255, 1
    s_mov_b64 exec, s[66:67]
    buffer_atomic_add v255, v252, s[16:19], 0 offen
    s_mov_b64 exec, -1
.Lnosig21:
    ds_read_b64_tr_b16 a[0:1], v16 offset:0
    ds_read_b64_tr_b16 a[2:3], v16 offset:512
    ds_read_b64_tr_b16 a[4:5], v16 offset:32
    ds_read_b64_tr_b16 a[6:7], v16 offset:544
    ds_read_b64_tr_b16 a[8:9], v16 offset:8448
    ds_read_b64_tr_b16 a[10:11], v16 offset:8960
    ds_read_b64_tr_b16 a[12:13], v16 offset:8480
    ds_read_b64_tr_b16 a[14:15], v16 offset:8992
    ds_read_b64_tr_b16 a[16:17], v16 offset:64
    ds_read_b64_tr_b16 a[18:19], v16 offset:576
    ds_read_b64_tr_b16 a[20:21], v16 offset:96
    ds_read_b64_tr_b16 a[22:23], v16 offset:608
    ds_read_b64_tr_b16 a[24:25], v16 offset:8512
    ds_read_b64_tr_b16 a[26:27], v16 offset:9024
    ds_read_b64_tr_b16 a[28:29], v16 offset:8544
    ds_read_b64_tr_b16 a[30:31], v16 offset:9056
    ds_read_b64_tr_b16 a[32:33], v16 offset:128
    ds_read_b64_tr_b16 a[34:35], v16 offset:640
    ds_read_b64_tr_b16 a[36:37], v16 offset:160
    ds_read_b64_tr_b16 a[38:39], v16 offset:672
    ds_read_b64_tr_b16 a[40:41], v16 offset:8576
    ds_read_b64_tr_b16 a[42:43], v16 offset:9088
    ds_read_b64_tr_b16 a[44:45], v16 offset:8608
    ds_read_b64_tr_b16 a[46:47], v16 offset:9120
    ds_read_b64_tr_b16 a[48:49], v17 offset:0
    ds_read_b64_tr_b16 a[50:51], v17 offset:512
    ds_read_b64_tr_b16 a[52:53], v17 offset:32
    ds_read_b64_tr_b16 a[54:55], v17 offset:544
    ds_read_b64_tr_b16 a[56:57], v17 offset:8448
    ds_read_b64_tr_b16 a[58:59], v17 offset:8960
    ds_read_b64_tr_b16 a[60:61], v17 offset:8480
    ds_read_b64_tr_b16 a[62:63], v17 offset:8992
    v_mov_b64 v[32:33], 0
    v_mov_b64 v[34:35], 0
    v_mov_b64 v[36:37], 0
    v_mov_b64 v[38:39], 0
    v_mov_b64 v[40:41], 0
    v_mov_b64 v[42:43], 0
    v_mov_b64 v[44:45], 0
    v_mov_b64 v[46:47], 0
    v_mov_b64 v[48:49], 0
    v_mov_b64 v[50:51], 0
    v_mov_b64 v[52:53], 0
    v_mov_b64 v[54:55], 0
    v_mov_b64 v[56:57], 0
    v_mov_b64 v[58:59], 0
    v_mov_b64 v[60:61], 0
    v_mov_b64 v[62:63], 0
    v_mov_b64 v[64:65], 0
    v_mov_b64 v[66:67], 0
    v_mov_b64 v[68:69], 0
    v_mov_b64 v[70:71], 0
    v_mov_b64 v[72:73], 0
    v_mov_b64 v[74:75], 0
    v_mov_b64 v[76:77], 0
    v_mov_b64 v[78:79], 0
    v_mov_b64 v[80:81], 0
    v_mov_b64 v[82:83], 0
    v_mov_b64 v[84:85], 0
    v_mov_b64 v[86:87], 0
    v_mov_b64 v[88:89], 0
    v_mov_b64 v[90:91], 0
    v_mov_b64 v[92:93], 0
    v_mov_b64 v[94:95], 0
    v_mov_b64 v[96:97], 0
    v_mov_b64 v[98:99], 0
    v_mov_b64 v[100:101], 0
    v_mov_b64 v[102:103], 0
    v_mov_b64 v[104:105], 0
    v_mov_b64 v[106:107], 0
    v_mov_b64 v[108:109], 0
    v_mov_b64 v[110:111], 0
    v_mov_b64 v[112:113], 0
    v_mov_b64 v[114:115], 0
    v_mov_b64 v[116:117], 0
    v_mov_b64 v[118:119], 0
    v_mov_b64 v[120:121], 0
    v_mov_b64 v[122:123], 0
    v_mov_b64 v[124:125], 0
    v_mov_b64 v[126:127], 0
    v_mov_b64 v[128:129], 0
    v_mov_b64 v[130:131], 0
    v_mov_b64 v[132:133], 0
    v_mov_b64 v[134:135], 0
    v_mov_b64 v[136:137], 0
    v_mov_b64 v[138:139], 0
    v_mov_b64 v[140:141], 0
    v_mov_b64 v[142:143], 0
    v_mov_b64 v[144:145], 0
    v_mov_b64 v[146:147], 0
    v_mov_b64 v[148:149], 0
    v_mov_b64 v[150:151], 0
    v_mov_b64 v[152:153], 0
    v_mov_b64 v[154:155], 0
    v_mov_b64 v[156:157], 0
    v_mov_b64 v[158:159], 0
    v_mov_b64 v[160:161], 0
    v_mov_b64 v[162:163], 0
    v_mov_b64 v[164:165], 0
    v_mov_b64 v[166:167], 0
    v_mov_b64 v[168:169], 0
    v_mov_b64 v[170:171], 0
    v_mov_b64 v[172:173], 0
    v_mov_b64 v[174:175], 0
    v_mov_b64 v[176:177], 0
    v_mov_b64 v[178:179], 0
    v_mov_b64 v[180:181], 0
    v_mov_b64 v[182:183], 0
    v_mov_b64 v[184:185], 0
    v_mov_b64 v[186:187], 0
    v_mov_b64 v[188:189], 0
    v_mov_b64 v[190:191], 0
    v_mov_b64 v[192:193], 0
    v_mov_b64 v[194:195], 0
    v_mov_b64 v[196:197], 0
    v_mov_b64 v[198:199], 0
    v_mov_b64 v[200:201], 0
    v_mov_b64 v[202:203], 0
    v_mov_b64 v[204:205], 0
    v_mov_b64 v[206:207], 0
    v_mov_b64 v[208:209], 0
    v_mov_b64 v[210:211], 0
    v_mov_b64 v[212:213], 0
    v_mov_b64 v[214:215], 0
    v_mov_b64 v[216:217], 0
    v_mov_b64 v[218:219], 0
    v_mov_b64 v[220:221], 0
    v_mov_b64 v[222:223], 0
    v_mov_b64 v[224:225], 0
    v_mov_b64 v[226:227], 0
    v_mov_b64 v[228:229], 0
    v_mov_b64 v[230:231], 0
    v_mov_b64 v[232:233], 0
    v_mov_b64 v[234:235], 0
    v_mov_b64 v[236:237], 0
    v_mov_b64 v[238:239], 0
    v_mov_b64 v[240:241], 0
    v_mov_b64 v[242:243], 0
    v_mov_b64 v[244:245], 0
    v_mov_b64 v[246:247], 0
    v_mov_b64 v[248:249], 0
    v_mov_b64 v[250:251], 0
    s_waitcnt lgkmcnt(0)
    s_cmp_lg_u32 s3, 1
    s_cbranch_scc1 .Lnopoll24
    s_mov_b64 exec, 7
    s_mov_b32 s15, 0
.Lpoll22:
    buffer_load_dword v255, v253, s[16:19], 0 offen sc1
    s_add_u32 s15, s15, 1
    s_cmp_gt_u32 s15, 100000
    s_cbranch_scc1 .Lgot23
    s_waitcnt vmcnt(0)
    v_cmp_ne_u32 vcc, v255, v254
    s_nop 0
    s_cbranch_vccnz .Lpoll22
.Lgot23:
    s_waitcnt vmcnt(0)
    s_mov_b64 exec, -1
.Lnopoll24:
    s_barrier

    buffer_load_dwordx4 a[128:131], v10, s[16:19], s52 offen offset:0 sc1
    buffer_load_dwordx4 a[132:135], v10, s[16:19], s52 offen offset:1024 sc1
    buffer_load_dwordx4 a[136:139], v11, s[16:19], s52 offen offset:0 sc1
    buffer_load_dwordx4 a[140:143], v11, s[16:19], s52 offen offset:1024 sc1
    s_add_u32 s52, s52, 0x20000
    buffer_load_dwordx4 a[144:147], v10, s[16:19], s52 offen offset:0 sc1
    buffer_load_dwordx4 a[148:151], v10, s[16:19], s52 offen offset:1024 sc1
    buffer_load_dwordx4 a[152:155], v11, s[16:19], s52 offen offset:0 sc1
    buffer_load_dwordx4 a[156:159], v11, s[16:19], s52 offen offset:1024 sc1
    s_add_u32 s52, s52, 0x20000
    buffer_load_dwordx4 a[160:163], v10, s[16:19], s52 offen offset:0 sc1
    buffer_load_dwordx4 a[164:167], v10, s[16:19], s52 offen offset:1024 sc1
    buffer_load_dwordx4 a[168:171], v11, s[16:19], s52 offen offset:0 sc1
    buffer_load_dwordx4 a[172:175], v11, s[16:19], s52 offen offset:1024 sc1
    s_add_u32 s52, s52, 0x20000
    v_mov_b64 v[252:253], 0
    v_mov_b64 v[254:255], 0
    s_cmp_lg_u32 s14, 0
    s_cbranch_scc1 .Ll025
    s_lshl_b32 s62, s11, 10
    s_add_u32 s62, s62, 31719424
    v_lshlrev_b32 v2, 2, v0
    buffer_load_dword v18, v2, s[16:19], s62 offen sc1
    s_add_u32 s62, s62, 32768
    buffer_load_dword v19, v2, s[16:19], s62 offen sc1
    s_add_u32 s62, s62, 32768
    buffer_load_dword v20, v2, s[16:19], s62 offen sc1
    s_add_u32 s62, s62, 32768
    buffer_load_dword v21, v2, s[16:19], s62 offen sc1
    s_add_u32 s62, s62, 32768
    buffer_load_dword v22, v2, s[16:19], s62 offen sc1
    s_add_u32 s62, s62, 32768
    buffer_load_dword v23, v2, s[16:19], s62 offen sc1
    s_add_u32 s62, s62, 32768
    buffer_load_dword v24, v2, s[16:19], s62 offen sc1
    s_add_u32 s62, s62, 32768
    buffer_load_dword v25, v2, s[16:19], s62 offen sc1
    s_add_u32 s62, s62, 32768
    buffer_load_dword v26, v2, s[16:19], s62 offen sc1
    s_add_u32 s62, s62, 32768
    buffer_load_dword v27, v2, s[16:19], s62 offen sc1
    s_add_u32 s62, s62, 32768
    buffer_load_dword v28, v2, s[16:19], s62 offen sc1
    s_add_u32 s62, s62, 32768
    buffer_load_dword v29, v2, s[16:19], s62 offen sc1
    s_add_u32 s62, s62, 32768
    buffer_load_dword v30, v2, s[16:19], s62 offen sc1
    s_add_u32 s62, s62, 32768
    buffer_load_dword v31, v2, s[16:19], s62 offen sc1
    s_add_u32 s62, s62, 32768
    buffer_load_dword v8, v2, s[16:19], s62 offen sc1
    s_add_u32 s62, s62, 32768
    buffer_load_dword v9, v2, s[16:19], s62 offen sc1
    s_add_u32 s62, s62, 32768
    s_mul_i32 s62, s2, 28672
    v_min_u32 v7, 223, v0
    v_lshlrev_b32 v7, 7, v7
    buffer_load_dword v7, v7, s[28:31], s62 offen
.Ll025:

    s_mov_b32 s15, 7
.p2align 6
.Lgu26:
    s_waitcnt lgkmcnt(0)
    s_waitcnt vmcnt(17)
    s_barrier
    s_waitcnt vmcnt(11)
    v_mfma_f32_16x16x32_bf16 v[32:35], a[0:3], a[128:131], v[32:35]
    s_add_u32 m0, s55, 83200
    s_waitcnt vmcnt(10)
    v_mfma_f32_16x16x32_bf16 v[36:39], a[0:3], a[132:135], v[36:39]
    buffer_load_dwordx4 v12, s[32:35], s54 offen offset:0 lds
    s_waitcnt vmcnt(10)
    v_mfma_f32_16x16x32_bf16 v[40:43], a[0:3], a[136:139], v[40:43]
    ds_read_b64_tr_b16 a[64:65], v16 offset:16896
    s_waitcnt vmcnt(9)
    v_mfma_f32_16x16x32_bf16 v[44:47], a[0:3], a[140:143], v[44:47]
    ds_read_b64_tr_b16 a[66:67], v16 offset:17408
    v_mfma_f32_16x16x32_bf16 v[48:51], a[4:7], a[128:131], v[48:51]
    ds_read_b64_tr_b16 a[68:69], v16 offset:16928
    v_mfma_f32_16x16x32_bf16 v[52:55], a[4:7], a[132:135], v[52:55]
    ds_read_b64_tr_b16 a[70:71], v16 offset:17440
    v_mfma_f32_16x16x32_bf16 v[56:59], a[4:7], a[136:139], v[56:59]
    ds_read_b64_tr_b16 a[72:73], v16 offset:25344
    v_mfma_f32_16x16x32_bf16 v[60:63], a[4:7], a[140:143], v[60:63]
    buffer_load_dwordx4 a[176:179], v10, s[16:19], s52 offen offset:0 sc1
    v_mfma_f32_16x16x32_bf16 v[64:67], a[8:11], a[128:131], v[64:67]
    v_mfma_f32_16x16x32_bf16 v[68:71], a[8:11], a[132:135], v[68:71]
    ds_read_b64_tr_b16 a[74:75], v16 offset:25856
    v_mfma_f32_16x16x32_bf16 v[72:75], a[8:11], a[136:139], v[72:75]
    ds_read_b64_tr_b16 a[76:77], v16 offset:25376
    v_mfma_f32_16x16x32_bf16 v[76:79], a[8:11], a[140:143], v[76:79]
    ds_read_b64_tr_b16 a[78:79], v16 offset:25888
    v_mfma_f32_16x16x32_bf16 v[80:83], a[12:15], a[128:131], v[80:83]
    ds_read_b64_tr_b16 a[80:81], v16 offset:16960
    v_mfma_f32_16x16x32_bf16 v[84:87], a[12:15], a[132:135], v[84:87]
    ds_read_b64_tr_b16 a[82:83], v16 offset:17472
    v_mfma_f32_16x16x32_bf16 v[88:91], a[12:15], a[136:139], v[88:91]
    buffer_load_dwordx4 v13, s[32:35], s54 offen offset:1056 lds
    v_mfma_f32_16x16x32_bf16 v[92:95], a[12:15], a[140:143], v[92:95]
    v_mfma_f32_16x16x32_bf16 v[96:99], a[16:19], a[128:131], v[96:99]
    ds_read_b64_tr_b16 a[84:85], v16 offset:16992
    v_mfma_f32_16x16x32_bf16 v[100:103], a[16:19], a[132:135], v[100:103]
    ds_read_b64_tr_b16 a[86:87], v16 offset:17504
    v_mfma_f32_16x16x32_bf16 v[104:107], a[16:19], a[136:139], v[104:107]
    ds_read_b64_tr_b16 a[88:89], v16 offset:25408
    v_mfma_f32_16x16x32_bf16 v[108:111], a[16:19], a[140:143], v[108:111]
    ds_read_b64_tr_b16 a[90:91], v16 offset:25920
    v_mfma_f32_16x16x32_bf16 v[112:115], a[20:23], a[128:131], v[112:115]
    v_mfma_f32_16x16x32_bf16 v[116:119], a[20:23], a[132:135], v[116:119]
    buffer_load_dwordx4 a[180:183], v10, s[16:19], s52 offen offset:1024 sc1
    v_mfma_f32_16x16x32_bf16 v[120:123], a[20:23], a[136:139], v[120:123]
    ds_read_b64_tr_b16 a[92:93], v16 offset:25440
    v_mfma_f32_16x16x32_bf16 v[124:127], a[20:23], a[140:143], v[124:127]
    ds_read_b64_tr_b16 a[94:95], v16 offset:25952
    v_mfma_f32_16x16x32_bf16 v[128:131], a[24:27], a[128:131], v[128:131]
    ds_read_b64_tr_b16 a[96:97], v16 offset:17024
    v_mfma_f32_16x16x32_bf16 v[132:135], a[24:27], a[132:135], v[132:135]
    ds_read_b64_tr_b16 a[98:99], v16 offset:17536
    v_mfma_f32_16x16x32_bf16 v[136:139], a[24:27], a[136:139], v[136:139]
    ds_read_b64_tr_b16 a[100:101], v16 offset:17056
    v_mfma_f32_16x16x32_bf16 v[140:143], a[24:27], a[140:143], v[140:143]
    v_mfma_f32_16x16x32_bf16 v[144:147], a[28:31], a[128:131], v[144:147]
    buffer_load_dwordx4 v14, s[32:35], s54 offen offset:2112 lds
    v_mfma_f32_16x16x32_bf16 v[148:151], a[28:31], a[132:135], v[148:151]
    ds_read_b64_tr_b16 a[102:103], v16 offset:17568
    v_mfma_f32_16x16x32_bf16 v[152:155], a[28:31], a[136:139], v[152:155]
    ds_read_b64_tr_b16 a[104:105], v16 offset:25472
    v_mfma_f32_16x16x32_bf16 v[156:159], a[28:31], a[140:143], v[156:159]
    ds_read_b64_tr_b16 a[106:107], v16 offset:25984
    v_mfma_f32_16x16x32_bf16 v[160:163], a[32:35], a[128:131], v[160:163]
    ds_read_b64_tr_b16 a[108:109], v16 offset:25504
    v_mfma_f32_16x16x32_bf16 v[164:167], a[32:35], a[132:135], v[164:167]
    v_mfma_f32_16x16x32_bf16 v[168:171], a[32:35], a[136:139], v[168:171]
    ds_read_b64_tr_b16 a[110:111], v16 offset:26016
    v_mfma_f32_16x16x32_bf16 v[172:175], a[32:35], a[140:143], v[172:175]
    buffer_load_dwordx4 a[184:187], v11, s[16:19], s52 offen offset:0 sc1
    v_mfma_f32_16x16x32_bf16 v[176:179], a[36:39], a[128:131], v[176:179]
    ds_read_b64_tr_b16 a[112:113], v17 offset:16896
    v_mfma_f32_16x16x32_bf16 v[180:183], a[36:39], a[132:135], v[180:183]
    ds_read_b64_tr_b16 a[114:115], v17 offset:17408
    v_mfma_f32_16x16x32_bf16 v[184:187], a[36:39], a[136:139], v[184:187]
    ds_read_b64_tr_b16 a[116:117], v17 offset:16928
    v_mfma_f32_16x16x32_bf16 v[188:191], a[36:39], a[140:143], v[188:191]
    ds_read_b64_tr_b16 a[118:119], v17 offset:17440
    v_mfma_f32_16x16x32_bf16 v[192:195], a[40:43], a[128:131], v[192:195]
    v_mfma_f32_16x16x32_bf16 v[196:199], a[40:43], a[132:135], v[196:199]
    ds_read_b64_tr_b16 a[120:121], v17 offset:25344
    v_mfma_f32_16x16x32_bf16 v[200:203], a[40:43], a[136:139], v[200:203]
    buffer_load_dwordx4 v15, s[32:35], s54 offen offset:3168 lds
    v_mfma_f32_16x16x32_bf16 v[204:207], a[40:43], a[140:143], v[204:207]
    s_add_u32 s54, s54, 229376
    v_mfma_f32_16x16x32_bf16 v[208:211], a[44:47], a[128:131], v[208:211]
    ds_read_b64_tr_b16 a[122:123], v17 offset:25856
    v_mfma_f32_16x16x32_bf16 v[212:215], a[44:47], a[132:135], v[212:215]
    ds_read_b64_tr_b16 a[124:125], v17 offset:25376
    v_mfma_f32_16x16x32_bf16 v[216:219], a[44:47], a[136:139], v[216:219]
    ds_read_b64_tr_b16 a[126:127], v17 offset:25888
    v_mfma_f32_16x16x32_bf16 v[220:223], a[44:47], a[140:143], v[220:223]
    v_mfma_f32_16x16x32_bf16 v[224:227], a[48:51], a[128:131], v[224:227]
    v_mfma_f32_16x16x32_bf16 v[228:231], a[48:51], a[132:135], v[228:231]
    buffer_load_dwordx4 a[188:191], v11, s[16:19], s52 offen offset:1024 sc1
    v_mfma_f32_16x16x32_bf16 v[232:235], a[52:55], a[128:131], v[232:235]
    s_add_u32 s52, s52, 0x20000
    v_mfma_f32_16x16x32_bf16 v[236:239], a[52:55], a[132:135], v[236:239]
    v_mfma_f32_16x16x32_bf16 v[240:243], a[56:59], a[128:131], v[240:243]
    v_mfma_f32_16x16x32_bf16 v[244:247], a[56:59], a[132:135], v[244:247]
    v_mfma_f32_16x16x32_bf16 v[248:251], a[60:63], a[128:131], v[248:251]
    v_mfma_f32_16x16x32_bf16 v[252:255], a[60:63], a[132:135], v[252:255]
    s_waitcnt lgkmcnt(0)
    s_barrier
    s_waitcnt vmcnt(15)
    v_mfma_f32_16x16x32_bf16 v[32:35], a[64:67], a[144:147], v[32:35]
    s_add_u32 m0, s55, 100096
    s_waitcnt vmcnt(14)
    v_mfma_f32_16x16x32_bf16 v[36:39], a[64:67], a[148:151], v[36:39]
    buffer_load_dwordx4 v12, s[32:35], s54 offen offset:0 lds
    s_waitcnt vmcnt(14)
    v_mfma_f32_16x16x32_bf16 v[40:43], a[64:67], a[152:155], v[40:43]
    ds_read_b64_tr_b16 a[0:1], v16 offset:33792
    s_waitcnt vmcnt(13)
    v_mfma_f32_16x16x32_bf16 v[44:47], a[64:67], a[156:159], v[44:47]
    ds_read_b64_tr_b16 a[2:3], v16 offset:34304
    v_mfma_f32_16x16x32_bf16 v[48:51], a[68:71], a[144:147], v[48:51]
    ds_read_b64_tr_b16 a[4:5], v16 offset:33824
    v_mfma_f32_16x16x32_bf16 v[52:55], a[68:71], a[148:151], v[52:55]
    ds_read_b64_tr_b16 a[6:7], v16 offset:34336
    v_mfma_f32_16x16x32_bf16 v[56:59], a[68:71], a[152:155], v[56:59]
    ds_read_b64_tr_b16 a[8:9], v16 offset:42240
    v_mfma_f32_16x16x32_bf16 v[60:63], a[68:71], a[156:159], v[60:63]
    buffer_load_dwordx4 a[128:131], v10, s[16:19], s52 offen offset:0 sc1
    v_mfma_f32_16x16x32_bf16 v[64:67], a[72:75], a[144:147], v[64:67]
    v_mfma_f32_16x16x32_bf16 v[68:71], a[72:75], a[148:151], v[68:71]
    ds_read_b64_tr_b16 a[10:11], v16 offset:42752
    v_mfma_f32_16x16x32_bf16 v[72:75], a[72:75], a[152:155], v[72:75]
    ds_read_b64_tr_b16 a[12:13], v16 offset:42272
    v_mfma_f32_16x16x32_bf16 v[76:79], a[72:75], a[156:159], v[76:79]
    ds_read_b64_tr_b16 a[14:15], v16 offset:42784
    v_mfma_f32_16x16x32_bf16 v[80:83], a[76:79], a[144:147], v[80:83]
    ds_read_b64_tr_b16 a[16:17], v16 offset:33856
    v_mfma_f32_16x16x32_bf16 v[84:87], a[76:79], a[148:151], v[84:87]
    ds_read_b64_tr_b16 a[18:19], v16 offset:34368
    v_mfma_f32_16x16x32_bf16 v[88:91], a[76:79], a[152:155], v[88:91]
    buffer_load_dwordx4 v13, s[32:35], s54 offen offset:1056 lds
    v_mfma_f32_16x16x32_bf16 v[92:95], a[76:79], a[156:159], v[92:95]
    v_mfma_f32_16x16x32_bf16 v[96:99], a[80:83], a[144:147], v[96:99]
    ds_read_b64_tr_b16 a[20:21], v16 offset:33888
    v_mfma_f32_16x16x32_bf16 v[100:103], a[80:83], a[148:151], v[100:103]
    ds_read_b64_tr_b16 a[22:23], v16 offset:34400
    v_mfma_f32_16x16x32_bf16 v[104:107], a[80:83], a[152:155], v[104:107]
    ds_read_b64_tr_b16 a[24:25], v16 offset:42304
    v_mfma_f32_16x16x32_bf16 v[108:111], a[80:83], a[156:159], v[108:111]
    ds_read_b64_tr_b16 a[26:27], v16 offset:42816
    v_mfma_f32_16x16x32_bf16 v[112:115], a[84:87], a[144:147], v[112:115]
    v_mfma_f32_16x16x32_bf16 v[116:119], a[84:87], a[148:151], v[116:119]
    buffer_load_dwordx4 a[132:135], v10, s[16:19], s52 offen offset:1024 sc1
    v_mfma_f32_16x16x32_bf16 v[120:123], a[84:87], a[152:155], v[120:123]
    ds_read_b64_tr_b16 a[28:29], v16 offset:42336
    v_mfma_f32_16x16x32_bf16 v[124:127], a[84:87], a[156:159], v[124:127]
    ds_read_b64_tr_b16 a[30:31], v16 offset:42848
    v_mfma_f32_16x16x32_bf16 v[128:131], a[88:91], a[144:147], v[128:131]
    ds_read_b64_tr_b16 a[32:33], v16 offset:33920
    v_mfma_f32_16x16x32_bf16 v[132:135], a[88:91], a[148:151], v[132:135]
    ds_read_b64_tr_b16 a[34:35], v16 offset:34432
    v_mfma_f32_16x16x32_bf16 v[136:139], a[88:91], a[152:155], v[136:139]
    ds_read_b64_tr_b16 a[36:37], v16 offset:33952
    v_mfma_f32_16x16x32_bf16 v[140:143], a[88:91], a[156:159], v[140:143]
    v_mfma_f32_16x16x32_bf16 v[144:147], a[92:95], a[144:147], v[144:147]
    buffer_load_dwordx4 v14, s[32:35], s54 offen offset:2112 lds
    v_mfma_f32_16x16x32_bf16 v[148:151], a[92:95], a[148:151], v[148:151]
    ds_read_b64_tr_b16 a[38:39], v16 offset:34464
    v_mfma_f32_16x16x32_bf16 v[152:155], a[92:95], a[152:155], v[152:155]
    ds_read_b64_tr_b16 a[40:41], v16 offset:42368
    v_mfma_f32_16x16x32_bf16 v[156:159], a[92:95], a[156:159], v[156:159]
    ds_read_b64_tr_b16 a[42:43], v16 offset:42880
    v_mfma_f32_16x16x32_bf16 v[160:163], a[96:99], a[144:147], v[160:163]
    ds_read_b64_tr_b16 a[44:45], v16 offset:42400
    v_mfma_f32_16x16x32_bf16 v[164:167], a[96:99], a[148:151], v[164:167]
    v_mfma_f32_16x16x32_bf16 v[168:171], a[96:99], a[152:155], v[168:171]
    ds_read_b64_tr_b16 a[46:47], v16 offset:42912
    v_mfma_f32_16x16x32_bf16 v[172:175], a[96:99], a[156:159], v[172:175]
    buffer_load_dwordx4 a[136:139], v11, s[16:19], s52 offen offset:0 sc1
    v_mfma_f32_16x16x32_bf16 v[176:179], a[100:103], a[144:147], v[176:179]
    ds_read_b64_tr_b16 a[48:49], v17 offset:33792
    v_mfma_f32_16x16x32_bf16 v[180:183], a[100:103], a[148:151], v[180:183]
    ds_read_b64_tr_b16 a[50:51], v17 offset:34304
    v_mfma_f32_16x16x32_bf16 v[184:187], a[100:103], a[152:155], v[184:187]
    ds_read_b64_tr_b16 a[52:53], v17 offset:33824
    v_mfma_f32_16x16x32_bf16 v[188:191], a[100:103], a[156:159], v[188:191]
    ds_read_b64_tr_b16 a[54:55], v17 offset:34336
    v_mfma_f32_16x16x32_bf16 v[192:195], a[104:107], a[144:147], v[192:195]
    v_mfma_f32_16x16x32_bf16 v[196:199], a[104:107], a[148:151], v[196:199]
    ds_read_b64_tr_b16 a[56:57], v17 offset:42240
    v_mfma_f32_16x16x32_bf16 v[200:203], a[104:107], a[152:155], v[200:203]
    buffer_load_dwordx4 v15, s[32:35], s54 offen offset:3168 lds
    v_mfma_f32_16x16x32_bf16 v[204:207], a[104:107], a[156:159], v[204:207]
    s_add_u32 s54, s54, 229376
    v_mfma_f32_16x16x32_bf16 v[208:211], a[108:111], a[144:147], v[208:211]
    ds_read_b64_tr_b16 a[58:59], v17 offset:42752
    v_mfma_f32_16x16x32_bf16 v[212:215], a[108:111], a[148:151], v[212:215]
    ds_read_b64_tr_b16 a[60:61], v17 offset:42272
    v_mfma_f32_16x16x32_bf16 v[216:219], a[108:111], a[152:155], v[216:219]
    ds_read_b64_tr_b16 a[62:63], v17 offset:42784
    v_mfma_f32_16x16x32_bf16 v[220:223], a[108:111], a[156:159], v[220:223]
    v_mfma_f32_16x16x32_bf16 v[224:227], a[112:115], a[144:147], v[224:227]
    v_mfma_f32_16x16x32_bf16 v[228:231], a[112:115], a[148:151], v[228:231]
    buffer_load_dwordx4 a[140:143], v11, s[16:19], s52 offen offset:1024 sc1
    v_mfma_f32_16x16x32_bf16 v[232:235], a[116:119], a[144:147], v[232:235]
    s_add_u32 s52, s52, 0x20000
    v_mfma_f32_16x16x32_bf16 v[236:239], a[116:119], a[148:151], v[236:239]
    v_mfma_f32_16x16x32_bf16 v[240:243], a[120:123], a[144:147], v[240:243]
    v_mfma_f32_16x16x32_bf16 v[244:247], a[120:123], a[148:151], v[244:247]
    v_mfma_f32_16x16x32_bf16 v[248:251], a[124:127], a[144:147], v[248:251]
    v_mfma_f32_16x16x32_bf16 v[252:255], a[124:127], a[148:151], v[252:255]
    s_waitcnt lgkmcnt(0)
    s_waitcnt vmcnt(17)
    s_barrier
    s_waitcnt vmcnt(19)
    v_mfma_f32_16x16x32_bf16 v[32:35], a[0:3], a[160:163], v[32:35]
    s_add_u32 m0, s55, 116992
    s_waitcnt vmcnt(18)
    v_mfma_f32_16x16x32_bf16 v[36:39], a[0:3], a[164:167], v[36:39]
    buffer_load_dwordx4 v12, s[32:35], s54 offen offset:0 lds
    s_waitcnt vmcnt(18)
    v_mfma_f32_16x16x32_bf16 v[40:43], a[0:3], a[168:171], v[40:43]
    ds_read_b64_tr_b16 a[64:65], v16 offset:50688
    s_waitcnt vmcnt(17)
    v_mfma_f32_16x16x32_bf16 v[44:47], a[0:3], a[172:175], v[44:47]
    ds_read_b64_tr_b16 a[66:67], v16 offset:51200
    v_mfma_f32_16x16x32_bf16 v[48:51], a[4:7], a[160:163], v[48:51]
    ds_read_b64_tr_b16 a[68:69], v16 offset:50720
    v_mfma_f32_16x16x32_bf16 v[52:55], a[4:7], a[164:167], v[52:55]
    ds_read_b64_tr_b16 a[70:71], v16 offset:51232
    v_mfma_f32_16x16x32_bf16 v[56:59], a[4:7], a[168:171], v[56:59]
    ds_read_b64_tr_b16 a[72:73], v16 offset:59136
    v_mfma_f32_16x16x32_bf16 v[60:63], a[4:7], a[172:175], v[60:63]
    buffer_load_dwordx4 a[144:147], v10, s[16:19], s52 offen offset:0 sc1
    v_mfma_f32_16x16x32_bf16 v[64:67], a[8:11], a[160:163], v[64:67]
    v_mfma_f32_16x16x32_bf16 v[68:71], a[8:11], a[164:167], v[68:71]
    ds_read_b64_tr_b16 a[74:75], v16 offset:59648
    v_mfma_f32_16x16x32_bf16 v[72:75], a[8:11], a[168:171], v[72:75]
    ds_read_b64_tr_b16 a[76:77], v16 offset:59168
    v_mfma_f32_16x16x32_bf16 v[76:79], a[8:11], a[172:175], v[76:79]
    ds_read_b64_tr_b16 a[78:79], v16 offset:59680
    v_mfma_f32_16x16x32_bf16 v[80:83], a[12:15], a[160:163], v[80:83]
    ds_read_b64_tr_b16 a[80:81], v16 offset:50752
    v_mfma_f32_16x16x32_bf16 v[84:87], a[12:15], a[164:167], v[84:87]
    ds_read_b64_tr_b16 a[82:83], v16 offset:51264
    v_mfma_f32_16x16x32_bf16 v[88:91], a[12:15], a[168:171], v[88:91]
    buffer_load_dwordx4 v13, s[32:35], s54 offen offset:1056 lds
    v_mfma_f32_16x16x32_bf16 v[92:95], a[12:15], a[172:175], v[92:95]
    v_mfma_f32_16x16x32_bf16 v[96:99], a[16:19], a[160:163], v[96:99]
    ds_read_b64_tr_b16 a[84:85], v16 offset:50784
    v_mfma_f32_16x16x32_bf16 v[100:103], a[16:19], a[164:167], v[100:103]
    ds_read_b64_tr_b16 a[86:87], v16 offset:51296
    v_mfma_f32_16x16x32_bf16 v[104:107], a[16:19], a[168:171], v[104:107]
    ds_read_b64_tr_b16 a[88:89], v16 offset:59200
    v_mfma_f32_16x16x32_bf16 v[108:111], a[16:19], a[172:175], v[108:111]
    ds_read_b64_tr_b16 a[90:91], v16 offset:59712
    v_mfma_f32_16x16x32_bf16 v[112:115], a[20:23], a[160:163], v[112:115]
    v_mfma_f32_16x16x32_bf16 v[116:119], a[20:23], a[164:167], v[116:119]
    buffer_load_dwordx4 a[148:151], v10, s[16:19], s52 offen offset:1024 sc1
    v_mfma_f32_16x16x32_bf16 v[120:123], a[20:23], a[168:171], v[120:123]
    ds_read_b64_tr_b16 a[92:93], v16 offset:59232
    v_mfma_f32_16x16x32_bf16 v[124:127], a[20:23], a[172:175], v[124:127]
    ds_read_b64_tr_b16 a[94:95], v16 offset:59744
    v_mfma_f32_16x16x32_bf16 v[128:131], a[24:27], a[160:163], v[128:131]
    ds_read_b64_tr_b16 a[96:97], v16 offset:50816
    v_mfma_f32_16x16x32_bf16 v[132:135], a[24:27], a[164:167], v[132:135]
    ds_read_b64_tr_b16 a[98:99], v16 offset:51328
    v_mfma_f32_16x16x32_bf16 v[136:139], a[24:27], a[168:171], v[136:139]
    ds_read_b64_tr_b16 a[100:101], v16 offset:50848
    v_mfma_f32_16x16x32_bf16 v[140:143], a[24:27], a[172:175], v[140:143]
    v_mfma_f32_16x16x32_bf16 v[144:147], a[28:31], a[160:163], v[144:147]
    buffer_load_dwordx4 v14, s[32:35], s54 offen offset:2112 lds
    v_mfma_f32_16x16x32_bf16 v[148:151], a[28:31], a[164:167], v[148:151]
    ds_read_b64_tr_b16 a[102:103], v16 offset:51360
    v_mfma_f32_16x16x32_bf16 v[152:155], a[28:31], a[168:171], v[152:155]
    ds_read_b64_tr_b16 a[104:105], v16 offset:59264
    v_mfma_f32_16x16x32_bf16 v[156:159], a[28:31], a[172:175], v[156:159]
    ds_read_b64_tr_b16 a[106:107], v16 offset:59776
    v_mfma_f32_16x16x32_bf16 v[160:163], a[32:35], a[160:163], v[160:163]
    ds_read_b64_tr_b16 a[108:109], v16 offset:59296
    v_mfma_f32_16x16x32_bf16 v[164:167], a[32:35], a[164:167], v[164:167]
    v_mfma_f32_16x16x32_bf16 v[168:171], a[32:35], a[168:171], v[168:171]
    ds_read_b64_tr_b16 a[110:111], v16 offset:59808
    v_mfma_f32_16x16x32_bf16 v[172:175], a[32:35], a[172:175], v[172:175]
    buffer_load_dwordx4 a[152:155], v11, s[16:19], s52 offen offset:0 sc1
    v_mfma_f32_16x16x32_bf16 v[176:179], a[36:39], a[160:163], v[176:179]
    ds_read_b64_tr_b16 a[112:113], v17 offset:50688
    v_mfma_f32_16x16x32_bf16 v[180:183], a[36:39], a[164:167], v[180:183]
    ds_read_b64_tr_b16 a[114:115], v17 offset:51200
    v_mfma_f32_16x16x32_bf16 v[184:187], a[36:39], a[168:171], v[184:187]
    ds_read_b64_tr_b16 a[116:117], v17 offset:50720
    v_mfma_f32_16x16x32_bf16 v[188:191], a[36:39], a[172:175], v[188:191]
    ds_read_b64_tr_b16 a[118:119], v17 offset:51232
    v_mfma_f32_16x16x32_bf16 v[192:195], a[40:43], a[160:163], v[192:195]
    v_mfma_f32_16x16x32_bf16 v[196:199], a[40:43], a[164:167], v[196:199]
    ds_read_b64_tr_b16 a[120:121], v17 offset:59136
    v_mfma_f32_16x16x32_bf16 v[200:203], a[40:43], a[168:171], v[200:203]
    buffer_load_dwordx4 v15, s[32:35], s54 offen offset:3168 lds
    v_mfma_f32_16x16x32_bf16 v[204:207], a[40:43], a[172:175], v[204:207]
    s_add_u32 s54, s54, 229376
    v_mfma_f32_16x16x32_bf16 v[208:211], a[44:47], a[160:163], v[208:211]
    ds_read_b64_tr_b16 a[122:123], v17 offset:59648
    v_mfma_f32_16x16x32_bf16 v[212:215], a[44:47], a[164:167], v[212:215]
    ds_read_b64_tr_b16 a[124:125], v17 offset:59168
    v_mfma_f32_16x16x32_bf16 v[216:219], a[44:47], a[168:171], v[216:219]
    ds_read_b64_tr_b16 a[126:127], v17 offset:59680
    v_mfma_f32_16x16x32_bf16 v[220:223], a[44:47], a[172:175], v[220:223]
    v_mfma_f32_16x16x32_bf16 v[224:227], a[48:51], a[160:163], v[224:227]
    v_mfma_f32_16x16x32_bf16 v[228:231], a[48:51], a[164:167], v[228:231]
    buffer_load_dwordx4 a[156:159], v11, s[16:19], s52 offen offset:1024 sc1
    v_mfma_f32_16x16x32_bf16 v[232:235], a[52:55], a[160:163], v[232:235]
    s_add_u32 s52, s52, 0x20000
    v_mfma_f32_16x16x32_bf16 v[236:239], a[52:55], a[164:167], v[236:239]
    v_mfma_f32_16x16x32_bf16 v[240:243], a[56:59], a[160:163], v[240:243]
    v_mfma_f32_16x16x32_bf16 v[244:247], a[56:59], a[164:167], v[244:247]
    v_mfma_f32_16x16x32_bf16 v[248:251], a[60:63], a[160:163], v[248:251]
    v_mfma_f32_16x16x32_bf16 v[252:255], a[60:63], a[164:167], v[252:255]
    s_waitcnt lgkmcnt(0)
    s_waitcnt vmcnt(17)
    s_barrier
    v_mfma_f32_16x16x32_bf16 v[32:35], a[64:67], a[176:179], v[32:35]
    s_add_u32 m0, s55, 133888
    v_mfma_f32_16x16x32_bf16 v[36:39], a[64:67], a[180:183], v[36:39]
    buffer_load_dwordx4 v12, s[32:35], s54 offen offset:0 lds
    v_mfma_f32_16x16x32_bf16 v[40:43], a[64:67], a[184:187], v[40:43]
    ds_read_b64_tr_b16 a[0:1], v16 offset:0
    s_waitcnt vmcnt(17)
    v_mfma_f32_16x16x32_bf16 v[44:47], a[64:67], a[188:191], v[44:47]
    ds_read_b64_tr_b16 a[2:3], v16 offset:512
    v_mfma_f32_16x16x32_bf16 v[48:51], a[68:71], a[176:179], v[48:51]
    ds_read_b64_tr_b16 a[4:5], v16 offset:32
    v_mfma_f32_16x16x32_bf16 v[52:55], a[68:71], a[180:183], v[52:55]
    ds_read_b64_tr_b16 a[6:7], v16 offset:544
    v_mfma_f32_16x16x32_bf16 v[56:59], a[68:71], a[184:187], v[56:59]
    ds_read_b64_tr_b16 a[8:9], v16 offset:8448
    v_mfma_f32_16x16x32_bf16 v[60:63], a[68:71], a[188:191], v[60:63]
    buffer_load_dwordx4 a[160:163], v10, s[16:19], s52 offen offset:0 sc1
    v_mfma_f32_16x16x32_bf16 v[64:67], a[72:75], a[176:179], v[64:67]
    v_mfma_f32_16x16x32_bf16 v[68:71], a[72:75], a[180:183], v[68:71]
    ds_read_b64_tr_b16 a[10:11], v16 offset:8960
    v_mfma_f32_16x16x32_bf16 v[72:75], a[72:75], a[184:187], v[72:75]
    ds_read_b64_tr_b16 a[12:13], v16 offset:8480
    v_mfma_f32_16x16x32_bf16 v[76:79], a[72:75], a[188:191], v[76:79]
    ds_read_b64_tr_b16 a[14:15], v16 offset:8992
    v_mfma_f32_16x16x32_bf16 v[80:83], a[76:79], a[176:179], v[80:83]
    ds_read_b64_tr_b16 a[16:17], v16 offset:64
    v_mfma_f32_16x16x32_bf16 v[84:87], a[76:79], a[180:183], v[84:87]
    ds_read_b64_tr_b16 a[18:19], v16 offset:576
    v_mfma_f32_16x16x32_bf16 v[88:91], a[76:79], a[184:187], v[88:91]
    buffer_load_dwordx4 v13, s[32:35], s54 offen offset:1056 lds
    v_mfma_f32_16x16x32_bf16 v[92:95], a[76:79], a[188:191], v[92:95]
    v_mfma_f32_16x16x32_bf16 v[96:99], a[80:83], a[176:179], v[96:99]
    ds_read_b64_tr_b16 a[20:21], v16 offset:96
    v_mfma_f32_16x16x32_bf16 v[100:103], a[80:83], a[180:183], v[100:103]
    ds_read_b64_tr_b16 a[22:23], v16 offset:608
    v_mfma_f32_16x16x32_bf16 v[104:107], a[80:83], a[184:187], v[104:107]
    ds_read_b64_tr_b16 a[24:25], v16 offset:8512
    v_mfma_f32_16x16x32_bf16 v[108:111], a[80:83], a[188:191], v[108:111]
    ds_read_b64_tr_b16 a[26:27], v16 offset:9024
    v_mfma_f32_16x16x32_bf16 v[112:115], a[84:87], a[176:179], v[112:115]
    v_mfma_f32_16x16x32_bf16 v[116:119], a[84:87], a[180:183], v[116:119]
    buffer_load_dwordx4 a[164:167], v10, s[16:19], s52 offen offset:1024 sc1
    v_mfma_f32_16x16x32_bf16 v[120:123], a[84:87], a[184:187], v[120:123]
    ds_read_b64_tr_b16 a[28:29], v16 offset:8544
    v_mfma_f32_16x16x32_bf16 v[124:127], a[84:87], a[188:191], v[124:127]
    ds_read_b64_tr_b16 a[30:31], v16 offset:9056
    v_mfma_f32_16x16x32_bf16 v[128:131], a[88:91], a[176:179], v[128:131]
    ds_read_b64_tr_b16 a[32:33], v16 offset:128
    v_mfma_f32_16x16x32_bf16 v[132:135], a[88:91], a[180:183], v[132:135]
    ds_read_b64_tr_b16 a[34:35], v16 offset:640
    v_mfma_f32_16x16x32_bf16 v[136:139], a[88:91], a[184:187], v[136:139]
    ds_read_b64_tr_b16 a[36:37], v16 offset:160
    v_mfma_f32_16x16x32_bf16 v[140:143], a[88:91], a[188:191], v[140:143]
    v_mfma_f32_16x16x32_bf16 v[144:147], a[92:95], a[176:179], v[144:147]
    buffer_load_dwordx4 v14, s[32:35], s54 offen offset:2112 lds
    v_mfma_f32_16x16x32_bf16 v[148:151], a[92:95], a[180:183], v[148:151]
    ds_read_b64_tr_b16 a[38:39], v16 offset:672
    v_mfma_f32_16x16x32_bf16 v[152:155], a[92:95], a[184:187], v[152:155]
    ds_read_b64_tr_b16 a[40:41], v16 offset:8576
    v_mfma_f32_16x16x32_bf16 v[156:159], a[92:95], a[188:191], v[156:159]
    ds_read_b64_tr_b16 a[42:43], v16 offset:9088
    v_mfma_f32_16x16x32_bf16 v[160:163], a[96:99], a[176:179], v[160:163]
    ds_read_b64_tr_b16 a[44:45], v16 offset:8608
    v_mfma_f32_16x16x32_bf16 v[164:167], a[96:99], a[180:183], v[164:167]
    v_mfma_f32_16x16x32_bf16 v[168:171], a[96:99], a[184:187], v[168:171]
    ds_read_b64_tr_b16 a[46:47], v16 offset:9120
    v_mfma_f32_16x16x32_bf16 v[172:175], a[96:99], a[188:191], v[172:175]
    buffer_load_dwordx4 a[168:171], v11, s[16:19], s52 offen offset:0 sc1
    v_mfma_f32_16x16x32_bf16 v[176:179], a[100:103], a[176:179], v[176:179]
    ds_read_b64_tr_b16 a[48:49], v17 offset:0
    v_mfma_f32_16x16x32_bf16 v[180:183], a[100:103], a[180:183], v[180:183]
    ds_read_b64_tr_b16 a[50:51], v17 offset:512
    v_mfma_f32_16x16x32_bf16 v[184:187], a[100:103], a[184:187], v[184:187]
    ds_read_b64_tr_b16 a[52:53], v17 offset:32
    v_mfma_f32_16x16x32_bf16 v[188:191], a[100:103], a[188:191], v[188:191]
    ds_read_b64_tr_b16 a[54:55], v17 offset:544
    v_mfma_f32_16x16x32_bf16 v[192:195], a[104:107], a[176:179], v[192:195]
    v_mfma_f32_16x16x32_bf16 v[196:199], a[104:107], a[180:183], v[196:199]
    ds_read_b64_tr_b16 a[56:57], v17 offset:8448
    v_mfma_f32_16x16x32_bf16 v[200:203], a[104:107], a[184:187], v[200:203]
    buffer_load_dwordx4 v15, s[32:35], s54 offen offset:3168 lds
    v_mfma_f32_16x16x32_bf16 v[204:207], a[104:107], a[188:191], v[204:207]
    s_add_u32 s54, s54, 229376
    v_mfma_f32_16x16x32_bf16 v[208:211], a[108:111], a[176:179], v[208:211]
    ds_read_b64_tr_b16 a[58:59], v17 offset:8960
    v_mfma_f32_16x16x32_bf16 v[212:215], a[108:111], a[180:183], v[212:215]
    ds_read_b64_tr_b16 a[60:61], v17 offset:8480
    v_mfma_f32_16x16x32_bf16 v[216:219], a[108:111], a[184:187], v[216:219]
    ds_read_b64_tr_b16 a[62:63], v17 offset:8992
    v_mfma_f32_16x16x32_bf16 v[220:223], a[108:111], a[188:191], v[220:223]
    v_mfma_f32_16x16x32_bf16 v[224:227], a[112:115], a[176:179], v[224:227]
    v_mfma_f32_16x16x32_bf16 v[228:231], a[112:115], a[180:183], v[228:231]
    buffer_load_dwordx4 a[172:175], v11, s[16:19], s52 offen offset:1024 sc1
    v_mfma_f32_16x16x32_bf16 v[232:235], a[116:119], a[176:179], v[232:235]
    s_add_u32 s52, s52, 0x20000
    v_mfma_f32_16x16x32_bf16 v[236:239], a[116:119], a[180:183], v[236:239]
    v_mfma_f32_16x16x32_bf16 v[240:243], a[120:123], a[176:179], v[240:243]
    v_mfma_f32_16x16x32_bf16 v[244:247], a[120:123], a[180:183], v[244:247]
    v_mfma_f32_16x16x32_bf16 v[248:251], a[124:127], a[176:179], v[248:251]
    v_mfma_f32_16x16x32_bf16 v[252:255], a[124:127], a[180:183], v[252:255]
    s_sub_u32 s15, s15, 1
    s_cmp_lg_u32 s15, 0
    s_cbranch_scc1 .Lgu26
    s_cmp_lg_u32 s14, 0
    s_cbranch_scc1 .Ll027
    v_add_f32 v18, v18, v19
    v_add_f32 v18, v18, v20
    v_add_f32 v18, v18, v21
    v_add_f32 v18, v18, v22
    v_add_f32 v18, v18, v23
    v_add_f32 v18, v18, v24
    v_add_f32 v18, v18, v25
    v_add_f32 v18, v18, v26
    v_add_f32 v18, v18, v27
    v_add_f32 v18, v18, v28
    v_add_f32 v18, v18, v29
    v_add_f32 v18, v18, v30
    v_add_f32 v18, v18, v31
    v_add_f32 v18, v18, v8
    v_add_f32 v18, v18, v9
    v_lshlrev_b32 v2, 2, v0
    v_add_u32 v2, 156928, v2
    ds_write_b32 v2, v18
.Ll027:

    s_waitcnt lgkmcnt(0)
    s_waitcnt vmcnt(17)
    s_barrier
    v_mfma_f32_16x16x32_bf16 v[32:35], a[0:3], a[128:131], v[32:35]
    ds_read_b64_tr_b16 a[64:65], v16 offset:16896
    ds_read_b64_tr_b16 a[66:67], v16 offset:17408
    v_mfma_f32_16x16x32_bf16 v[36:39], a[0:3], a[132:135], v[36:39]
    buffer_load_dwordx4 a[176:179], v10, s[16:19], s52 offen offset:0 sc1
    v_mfma_f32_16x16x32_bf16 v[40:43], a[0:3], a[136:139], v[40:43]
    ds_read_b64_tr_b16 a[68:69], v16 offset:16928
    ds_read_b64_tr_b16 a[70:71], v16 offset:17440
    s_waitcnt vmcnt(17)
    v_mfma_f32_16x16x32_bf16 v[44:47], a[0:3], a[140:143], v[44:47]
    buffer_load_dwordx4 a[180:183], v10, s[16:19], s52 offen offset:1024 sc1
    v_mfma_f32_16x16x32_bf16 v[48:51], a[4:7], a[128:131], v[48:51]
    ds_read_b64_tr_b16 a[72:73], v16 offset:25344
    ds_read_b64_tr_b16 a[74:75], v16 offset:25856
    v_mfma_f32_16x16x32_bf16 v[52:55], a[4:7], a[132:135], v[52:55]
    buffer_load_dwordx4 a[184:187], v11, s[16:19], s52 offen offset:0 sc1
    v_mfma_f32_16x16x32_bf16 v[56:59], a[4:7], a[136:139], v[56:59]
    ds_read_b64_tr_b16 a[76:77], v16 offset:25376
    ds_read_b64_tr_b16 a[78:79], v16 offset:25888
    v_mfma_f32_16x16x32_bf16 v[60:63], a[4:7], a[140:143], v[60:63]
    buffer_load_dwordx4 a[188:191], v11, s[16:19], s52 offen offset:1024 sc1
    v_mfma_f32_16x16x32_bf16 v[64:67], a[8:11], a[128:131], v[64:67]
    s_add_u32 s52, s52, 0x20000
    ds_read_b64_tr_b16 a[80:81], v16 offset:16960
    v_mfma_f32_16x16x32_bf16 v[68:71], a[8:11], a[132:135], v[68:71]
    s_add_u32 s67, s14, 29622272
    ds_read_b64_tr_b16 a[82:83], v16 offset:17472
    v_mfma_f32_16x16x32_bf16 v[72:75], a[8:11], a[136:139], v[72:75]
    buffer_load_dwordx2 a[192:193], v4, s[16:19], s67 offen sc1
    v_mfma_f32_16x16x32_bf16 v[76:79], a[8:11], a[140:143], v[76:79]
    s_add_u32 s67, s14, 29638656
    ds_read_b64_tr_b16 a[84:85], v16 offset:16992
    v_mfma_f32_16x16x32_bf16 v[80:83], a[12:15], a[128:131], v[80:83]
    buffer_load_dwordx2 a[194:195], v4, s[16:19], s67 offen sc1
    v_mfma_f32_16x16x32_bf16 v[84:87], a[12:15], a[132:135], v[84:87]
    s_add_u32 s67, s14, 29655040
    v_mfma_f32_16x16x32_bf16 v[88:91], a[12:15], a[136:139], v[88:91]
    buffer_load_dwordx2 a[196:197], v4, s[16:19], s67 offen sc1
    v_mfma_f32_16x16x32_bf16 v[92:95], a[12:15], a[140:143], v[92:95]
    ds_read_b64_tr_b16 a[86:87], v16 offset:17504
    ds_read_b64_tr_b16 a[88:89], v16 offset:25408
    v_mfma_f32_16x16x32_bf16 v[96:99], a[16:19], a[128:131], v[96:99]
    s_add_u32 s67, s14, 29671424
    ds_read_b64_tr_b16 a[90:91], v16 offset:25920
    v_mfma_f32_16x16x32_bf16 v[100:103], a[16:19], a[132:135], v[100:103]
    buffer_load_dwordx2 a[198:199], v4, s[16:19], s67 offen sc1
    v_mfma_f32_16x16x32_bf16 v[104:107], a[16:19], a[136:139], v[104:107]
    s_add_u32 s67, s14, 29687808
    ds_read_b64_tr_b16 a[92:93], v16 offset:25440
    v_mfma_f32_16x16x32_bf16 v[108:111], a[16:19], a[140:143], v[108:111]
    buffer_load_dwordx2 a[200:201], v4, s[16:19], s67 offen sc1
    v_mfma_f32_16x16x32_bf16 v[112:115], a[20:23], a[128:131], v[112:115]
    s_add_u32 s67, s14, 29704192
    ds_read_b64_tr_b16 a[94:95], v16 offset:25952
    v_mfma_f32_16x16x32_bf16 v[116:119], a[20:23], a[132:135], v[116:119]
    buffer_load_dwordx2 a[202:203], v4, s[16:19], s67 offen sc1
    v_mfma_f32_16x16x32_bf16 v[120:123], a[20:23], a[136:139], v[120:123]
    s_add_u32 s67, s14, 29720576
    ds_read_b64_tr_b16 a[96:97], v16 offset:17024
    v_mfma_f32_16x16x32_bf16 v[124:127], a[20:23], a[140:143], v[124:127]
    buffer_load_dwordx2 a[204:205], v4, s[16:19], s67 offen sc1
    v_mfma_f32_16x16x32_bf16 v[128:131], a[24:27], a[128:131], v[128:131]
    ds_read_b64_tr_b16 a[98:99], v16 offset:17536
    ds_read_b64_tr_b16 a[100:101], v16 offset:17056
    v_mfma_f32_16x16x32_bf16 v[132:135], a[24:27], a[132:135], v[132:135]
    s_add_u32 s67, s14, 29736960
    ds_read_b64_tr_b16 a[102:103], v16 offset:17568
    v_mfma_f32_16x16x32_bf16 v[136:139], a[24:27], a[136:139], v[136:139]
    buffer_load_dwordx2 a[206:207], v4, s[16:19], s67 offen sc1
    v_mfma_f32_16x16x32_bf16 v[140:143], a[24:27], a[140:143], v[140:143]
    s_add_u32 s67, s14, 29753344
    ds_read_b64_tr_b16 a[104:105], v16 offset:25472
    v_mfma_f32_16x16x32_bf16 v[144:147], a[28:31], a[128:131], v[144:147]
    buffer_load_dwordx2 a[208:209], v4, s[16:19], s67 offen sc1
    v_mfma_f32_16x16x32_bf16 v[148:151], a[28:31], a[132:135], v[148:151]
    s_add_u32 s67, s14, 29769728
    ds_read_b64_tr_b16 a[106:107], v16 offset:25984
    v_mfma_f32_16x16x32_bf16 v[152:155], a[28:31], a[136:139], v[152:155]
    buffer_load_dwordx2 a[210:211], v4, s[16:19], s67 offen sc1
    v_mfma_f32_16x16x32_bf16 v[156:159], a[28:31], a[140:143], v[156:159]
    ds_read_b64_tr_b16 a[108:109], v16 offset:25504
    v_mfma_f32_16x16x32_bf16 v[160:163], a[32:35], a[128:131], v[160:163]
    s_add_u32 s67, s14, 29786112
    ds_read_b64_tr_b16 a[110:111], v16 offset:26016
    v_mfma_f32_16x16x32_bf16 v[164:167], a[32:35], a[132:135], v[164:167]
    buffer_load_dwordx2 a[212:213], v4, s[16:19], s67 offen sc1
    v_mfma_f32_16x16x32_bf16 v[168:171], a[32:35], a[136:139], v[168:171]
    s_add_u32 s67, s14, 29802496
    ds_read_b64_tr_b16 a[112:113], v17 offset:16896
    v_mfma_f32_16x16x32_bf16 v[172:175], a[32:35], a[140:143], v[172:175]
    buffer_load_dwordx2 a[214:215], v4, s[16:19], s67 offen sc1
    v_mfma_f32_16x16x32_bf16 v[176:179], a[36:39], a[128:131], v[176:179]
    s_add_u32 s67, s14, 29818880
    ds_read_b64_tr_b16 a[114:115], v17 offset:17408
    v_mfma_f32_16x16x32_bf16 v[180:183], a[36:39], a[132:135], v[180:183]
    buffer_load_dwordx2 a[216:217], v4, s[16:19], s67 offen sc1
    v_mfma_f32_16x16x32_bf16 v[184:187], a[36:39], a[136:139], v[184:187]
    s_add_u32 s67, s14, 29835264
    ds_read_b64_tr_b16 a[116:117], v17 offset:16928
    v_mfma_f32_16x16x32_bf16 v[188:191], a[36:39], a[140:143], v[188:191]
    buffer_load_dwordx2 a[218:219], v4, s[16:19], s67 offen sc1
    v_mfma_f32_16x16x32_bf16 v[192:195], a[40:43], a[128:131], v[192:195]
    ds_read_b64_tr_b16 a[118:119], v17 offset:17440
    ds_read_b64_tr_b16 a[120:121], v17 offset:25344
    v_mfma_f32_16x16x32_bf16 v[196:199], a[40:43], a[132:135], v[196:199]
    s_add_u32 s67, s14, 29851648
    ds_read_b64_tr_b16 a[122:123], v17 offset:25856
    v_mfma_f32_16x16x32_bf16 v[200:203], a[40:43], a[136:139], v[200:203]
    buffer_load_dwordx2 a[220:221], v4, s[16:19], s67 offen sc1
    v_mfma_f32_16x16x32_bf16 v[204:207], a[40:43], a[140:143], v[204:207]
    s_add_u32 s67, s14, 29868032
    ds_read_b64_tr_b16 a[124:125], v17 offset:25376
    v_mfma_f32_16x16x32_bf16 v[208:211], a[44:47], a[128:131], v[208:211]
    buffer_load_dwordx2 a[222:223], v4, s[16:19], s67 offen sc1
    v_mfma_f32_16x16x32_bf16 v[212:215], a[44:47], a[132:135], v[212:215]
    s_add_u32 m0, s59, 0
    s_mov_b32 s58, 0
    v_mfma_f32_16x16x32_bf16 v[216:219], a[44:47], a[136:139], v[216:219]
    buffer_load_dwordx4 v5, s[28:31], s58 offen lds
    v_mfma_f32_16x16x32_bf16 v[220:223], a[44:47], a[140:143], v[220:223]
    ds_read_b64_tr_b16 a[126:127], v17 offset:25888
    v_mfma_f32_16x16x32_bf16 v[224:227], a[48:51], a[128:131], v[224:227]
    v_mfma_f32_16x16x32_bf16 v[228:231], a[48:51], a[132:135], v[228:231]
    buffer_load_dwordx4 v6, s[28:31], s58 offen offset:1024 lds
    v_mfma_f32_16x16x32_bf16 v[232:235], a[52:55], a[128:131], v[232:235]
    s_add_u32 m0, s59, 8320
    s_mov_b32 s58, 131072
    v_mfma_f32_16x16x32_bf16 v[236:239], a[52:55], a[132:135], v[236:239]
    buffer_load_dwordx4 v5, s[28:31], s58 offen lds
    v_mfma_f32_16x16x32_bf16 v[240:243], a[56:59], a[128:131], v[240:243]
    v_mfma_f32_16x16x32_bf16 v[244:247], a[56:59], a[132:135], v[244:247]
    buffer_load_dwordx4 v6, s[28:31], s58 offen offset:1024 lds
    v_mfma_f32_16x16x32_bf16 v[248:251], a[60:63], a[128:131], v[248:251]
    v_mfma_f32_16x16x32_bf16 v[252:255], a[60:63], a[132:135], v[252:255]
    s_waitcnt lgkmcnt(0)
    s_waitcnt vmcnt(33)
    s_barrier
    v_mfma_f32_16x16x32_bf16 v[32:35], a[64:67], a[144:147], v[32:35]
    s_add_u32 m0, s59, 16640
    s_mov_b32 s58, 262144
    v_mfma_f32_16x16x32_bf16 v[36:39], a[64:67], a[148:151], v[36:39]
    buffer_load_dwordx4 v5, s[28:31], s58 offen lds
    v_mfma_f32_16x16x32_bf16 v[40:43], a[64:67], a[152:155], v[40:43]
    ds_read_b64_tr_b16 a[0:1], v16 offset:33792
    s_waitcnt vmcnt(33)
    v_mfma_f32_16x16x32_bf16 v[44:47], a[64:67], a[156:159], v[44:47]
    ds_read_b64_tr_b16 a[2:3], v16 offset:34304
    v_mfma_f32_16x16x32_bf16 v[48:51], a[68:71], a[144:147], v[48:51]
    ds_read_b64_tr_b16 a[4:5], v16 offset:33824
    v_mfma_f32_16x16x32_bf16 v[52:55], a[68:71], a[148:151], v[52:55]
    ds_read_b64_tr_b16 a[6:7], v16 offset:34336
    v_mfma_f32_16x16x32_bf16 v[56:59], a[68:71], a[152:155], v[56:59]
    buffer_load_dwordx4 v6, s[28:31], s58 offen offset:1024 lds
    v_mfma_f32_16x16x32_bf16 v[60:63], a[68:71], a[156:159], v[60:63]
    ds_read_b64_tr_b16 a[8:9], v16 offset:42240
    v_mfma_f32_16x16x32_bf16 v[64:67], a[72:75], a[144:147], v[64:67]
    ds_read_b64_tr_b16 a[10:11], v16 offset:42752
    v_mfma_f32_16x16x32_bf16 v[68:71], a[72:75], a[148:151], v[68:71]
    ds_read_b64_tr_b16 a[12:13], v16 offset:42272
    v_mfma_f32_16x16x32_bf16 v[72:75], a[72:75], a[152:155], v[72:75]
    ds_read_b64_tr_b16 a[14:15], v16 offset:42784
    v_mfma_f32_16x16x32_bf16 v[76:79], a[72:75], a[156:159], v[76:79]
    s_add_u32 m0, s59, 24960
    s_mov_b32 s58, 393216
    v_mfma_f32_16x16x32_bf16 v[80:83], a[76:79], a[144:147], v[80:83]
    buffer_load_dwordx4 v5, s[28:31], s58 offen lds
    v_mfma_f32_16x16x32_bf16 v[84:87], a[76:79], a[148:151], v[84:87]
    ds_read_b64_tr_b16 a[16:17], v16 offset:33856
    v_mfma_f32_16x16x32_bf16 v[88:91], a[76:79], a[152:155], v[88:91]
    ds_read_b64_tr_b16 a[18:19], v16 offset:34368
    v_mfma_f32_16x16x32_bf16 v[92:95], a[76:79], a[156:159], v[92:95]
    ds_read_b64_tr_b16 a[20:21], v16 offset:33888
    v_mfma_f32_16x16x32_bf16 v[96:99], a[80:83], a[144:147], v[96:99]
    ds_read_b64_tr_b16 a[22:23], v16 offset:34400
    v_mfma_f32_16x16x32_bf16 v[100:103], a[80:83], a[148:151], v[100:103]
    buffer_load_dwordx4 v6, s[28:31], s58 offen offset:1024 lds
    v_mfma_f32_16x16x32_bf16 v[104:107], a[80:83], a[152:155], v[104:107]
    ds_read_b64_tr_b16 a[24:25], v16 offset:42304
    v_mfma_f32_16x16x32_bf16 v[108:111], a[80:83], a[156:159], v[108:111]
    ds_read_b64_tr_b16 a[26:27], v16 offset:42816
    v_mfma_f32_16x16x32_bf16 v[112:115], a[84:87], a[144:147], v[112:115]
    ds_read_b64_tr_b16 a[28:29], v16 offset:42336
    v_mfma_f32_16x16x32_bf16 v[116:119], a[84:87], a[148:151], v[116:119]
    ds_read_b64_tr_b16 a[30:31], v16 offset:42848
    v_mfma_f32_16x16x32_bf16 v[120:123], a[84:87], a[152:155], v[120:123]
    s_add_u32 m0, s59, 83200
    s_mov_b32 s58, 1310720
    v_mfma_f32_16x16x32_bf16 v[124:127], a[84:87], a[156:159], v[124:127]
    buffer_load_dwordx4 v5, s[28:31], s58 offen lds
    v_mfma_f32_16x16x32_bf16 v[128:131], a[88:91], a[144:147], v[128:131]
    v_mfma_f32_16x16x32_bf16 v[132:135], a[88:91], a[148:151], v[132:135]
    ds_read_b64_tr_b16 a[32:33], v16 offset:33920
    v_mfma_f32_16x16x32_bf16 v[136:139], a[88:91], a[152:155], v[136:139]
    ds_read_b64_tr_b16 a[34:35], v16 offset:34432
    v_mfma_f32_16x16x32_bf16 v[140:143], a[88:91], a[156:159], v[140:143]
    ds_read_b64_tr_b16 a[36:37], v16 offset:33952
    v_mfma_f32_16x16x32_bf16 v[144:147], a[92:95], a[144:147], v[144:147]
    buffer_load_dwordx4 v6, s[28:31], s58 offen offset:1024 lds
    v_mfma_f32_16x16x32_bf16 v[148:151], a[92:95], a[148:151], v[148:151]
    ds_read_b64_tr_b16 a[38:39], v16 offset:34464
    v_mfma_f32_16x16x32_bf16 v[152:155], a[92:95], a[152:155], v[152:155]
    ds_read_b64_tr_b16 a[40:41], v16 offset:42368
    v_mfma_f32_16x16x32_bf16 v[156:159], a[92:95], a[156:159], v[156:159]
    ds_read_b64_tr_b16 a[42:43], v16 offset:42880
    v_mfma_f32_16x16x32_bf16 v[160:163], a[96:99], a[144:147], v[160:163]
    ds_read_b64_tr_b16 a[44:45], v16 offset:42400
    v_mfma_f32_16x16x32_bf16 v[164:167], a[96:99], a[148:151], v[164:167]
    s_add_u32 m0, s59, 91520
    s_mov_b32 s58, 1441792
    v_mfma_f32_16x16x32_bf16 v[168:171], a[96:99], a[152:155], v[168:171]
    buffer_load_dwordx4 v5, s[28:31], s58 offen lds
    v_mfma_f32_16x16x32_bf16 v[172:175], a[96:99], a[156:159], v[172:175]
    ds_read_b64_tr_b16 a[46:47], v16 offset:42912
    v_mfma_f32_16x16x32_bf16 v[176:179], a[100:103], a[144:147], v[176:179]
    ds_read_b64_tr_b16 a[48:49], v17 offset:33792
    v_mfma_f32_16x16x32_bf16 v[180:183], a[100:103], a[148:151], v[180:183]
    ds_read_b64_tr_b16 a[50:51], v17 offset:34304
    v_mfma_f32_16x16x32_bf16 v[184:187], a[100:103], a[152:155], v[184:187]
    ds_read_b64_tr_b16 a[52:53], v17 offset:33824
    v_mfma_f32_16x16x32_bf16 v[188:191], a[100:103], a[156:159], v[188:191]
    buffer_load_dwordx4 v6, s[28:31], s58 offen offset:1024 lds
    v_mfma_f32_16x16x32_bf16 v[192:195], a[104:107], a[144:147], v[192:195]
    ds_read_b64_tr_b16 a[54:55], v17 offset:34336
    v_mfma_f32_16x16x32_bf16 v[196:199], a[104:107], a[148:151], v[196:199]
    ds_read_b64_tr_b16 a[56:57], v17 offset:42240
    v_mfma_f32_16x16x32_bf16 v[200:203], a[104:107], a[152:155], v[200:203]
    ds_read_b64_tr_b16 a[58:59], v17 offset:42752
    v_mfma_f32_16x16x32_bf16 v[204:207], a[104:107], a[156:159], v[204:207]
    ds_read_b64_tr_b16 a[60:61], v17 offset:42272
    v_mfma_f32_16x16x32_bf16 v[208:211], a[108:111], a[144:147], v[208:211]
    s_add_u32 m0, s59, 33280
    s_mov_b32 s58, 524288
    v_mfma_f32_16x16x32_bf16 v[212:215], a[108:111], a[148:151], v[212:215]
    buffer_load_dwordx4 v5, s[28:31], s58 offen lds
    v_mfma_f32_16x16x32_bf16 v[216:219], a[108:111], a[152:155], v[216:219]
    ds_read_b64_tr_b16 a[62:63], v17 offset:42784
    v_mfma_f32_16x16x32_bf16 v[220:223], a[108:111], a[156:159], v[220:223]
    v_mfma_f32_16x16x32_bf16 v[224:227], a[112:115], a[144:147], v[224:227]
    v_mfma_f32_16x16x32_bf16 v[228:231], a[112:115], a[148:151], v[228:231]
    v_mfma_f32_16x16x32_bf16 v[232:235], a[116:119], a[144:147], v[232:235]
    buffer_load_dwordx4 v6, s[28:31], s58 offen offset:1024 lds
    v_mfma_f32_16x16x32_bf16 v[236:239], a[116:119], a[148:151], v[236:239]
    v_mfma_f32_16x16x32_bf16 v[240:243], a[120:123], a[144:147], v[240:243]
    v_mfma_f32_16x16x32_bf16 v[244:247], a[120:123], a[148:151], v[244:247]
    v_mfma_f32_16x16x32_bf16 v[248:251], a[124:127], a[144:147], v[248:251]
    v_mfma_f32_16x16x32_bf16 v[252:255], a[124:127], a[148:151], v[252:255]
    s_waitcnt lgkmcnt(0)
    s_waitcnt vmcnt(35)
    s_barrier
    v_mfma_f32_16x16x32_bf16 v[32:35], a[0:3], a[160:163], v[32:35]
    s_add_u32 m0, s59, 41600
    s_mov_b32 s58, 655360
    v_mfma_f32_16x16x32_bf16 v[36:39], a[0:3], a[164:167], v[36:39]
    buffer_load_dwordx4 v5, s[28:31], s58 offen lds
    v_mfma_f32_16x16x32_bf16 v[40:43], a[0:3], a[168:171], v[40:43]
    ds_read_b64_tr_b16 a[64:65], v16 offset:50688
    s_waitcnt vmcnt(35)
    v_mfma_f32_16x16x32_bf16 v[44:47], a[0:3], a[172:175], v[44:47]
    ds_read_b64_tr_b16 a[66:67], v16 offset:51200
    v_mfma_f32_16x16x32_bf16 v[48:51], a[4:7], a[160:163], v[48:51]
    ds_read_b64_tr_b16 a[68:69], v16 offset:50720
    v_mfma_f32_16x16x32_bf16 v[52:55], a[4:7], a[164:167], v[52:55]
    ds_read_b64_tr_b16 a[70:71], v16 offset:51232
    v_mfma_f32_16x16x32_bf16 v[56:59], a[4:7], a[168:171], v[56:59]
    buffer_load_dwordx4 v6, s[28:31], s58 offen offset:1024 lds
    v_mfma_f32_16x16x32_bf16 v[60:63], a[4:7], a[172:175], v[60:63]
    ds_read_b64_tr_b16 a[72:73], v16 offset:59136
    v_mfma_f32_16x16x32_bf16 v[64:67], a[8:11], a[160:163], v[64:67]
    ds_read_b64_tr_b16 a[74:75], v16 offset:59648
    v_mfma_f32_16x16x32_bf16 v[68:71], a[8:11], a[164:167], v[68:71]
    ds_read_b64_tr_b16 a[76:77], v16 offset:59168
    v_mfma_f32_16x16x32_bf16 v[72:75], a[8:11], a[168:171], v[72:75]
    ds_read_b64_tr_b16 a[78:79], v16 offset:59680
    v_mfma_f32_16x16x32_bf16 v[76:79], a[8:11], a[172:175], v[76:79]
    s_add_u32 m0, s59, 49920
    s_mov_b32 s58, 786432
    v_mfma_f32_16x16x32_bf16 v[80:83], a[12:15], a[160:163], v[80:83]
    buffer_load_dwordx4 v5, s[28:31], s58 offen lds
    v_mfma_f32_16x16x32_bf16 v[84:87], a[12:15], a[164:167], v[84:87]
    ds_read_b64_tr_b16 a[80:81], v16 offset:50752
    v_mfma_f32_16x16x32_bf16 v[88:91], a[12:15], a[168:171], v[88:91]
    ds_read_b64_tr_b16 a[82:83], v16 offset:51264
    v_mfma_f32_16x16x32_bf16 v[92:95], a[12:15], a[172:175], v[92:95]
    ds_read_b64_tr_b16 a[84:85], v16 offset:50784
    v_mfma_f32_16x16x32_bf16 v[96:99], a[16:19], a[160:163], v[96:99]
    ds_read_b64_tr_b16 a[86:87], v16 offset:51296
    v_mfma_f32_16x16x32_bf16 v[100:103], a[16:19], a[164:167], v[100:103]
    buffer_load_dwordx4 v6, s[28:31], s58 offen offset:1024 lds
    v_mfma_f32_16x16x32_bf16 v[104:107], a[16:19], a[168:171], v[104:107]
    ds_read_b64_tr_b16 a[88:89], v16 offset:59200
    v_mfma_f32_16x16x32_bf16 v[108:111], a[16:19], a[172:175], v[108:111]
    ds_read_b64_tr_b16 a[90:91], v16 offset:59712
    v_mfma_f32_16x16x32_bf16 v[112:115], a[20:23], a[160:163], v[112:115]
    ds_read_b64_tr_b16 a[92:93], v16 offset:59232
    v_mfma_f32_16x16x32_bf16 v[116:119], a[20:23], a[164:167], v[116:119]
    ds_read_b64_tr_b16 a[94:95], v16 offset:59744
    v_mfma_f32_16x16x32_bf16 v[120:123], a[20:23], a[168:171], v[120:123]
    s_add_u32 m0, s59, 99840
    s_mov_b32 s58, 1572864
    v_mfma_f32_16x16x32_bf16 v[124:127], a[20:23], a[172:175], v[124:127]
    buffer_load_dwordx4 v5, s[28:31], s58 offen lds
    v_mfma_f32_16x16x32_bf16 v[128:131], a[24:27], a[160:163], v[128:131]
    v_mfma_f32_16x16x32_bf16 v[132:135], a[24:27], a[164:167], v[132:135]
    ds_read_b64_tr_b16 a[96:97], v16 offset:50816
    v_mfma_f32_16x16x32_bf16 v[136:139], a[24:27], a[168:171], v[136:139]
    ds_read_b64_tr_b16 a[98:99], v16 offset:51328
    v_mfma_f32_16x16x32_bf16 v[140:143], a[24:27], a[172:175], v[140:143]
    ds_read_b64_tr_b16 a[100:101], v16 offset:50848
    v_mfma_f32_16x16x32_bf16 v[144:147], a[28:31], a[160:163], v[144:147]
    buffer_load_dwordx4 v6, s[28:31], s58 offen offset:1024 lds
    v_mfma_f32_16x16x32_bf16 v[148:151], a[28:31], a[164:167], v[148:151]
    ds_read_b64_tr_b16 a[102:103], v16 offset:51360
    v_mfma_f32_16x16x32_bf16 v[152:155], a[28:31], a[168:171], v[152:155]
    ds_read_b64_tr_b16 a[104:105], v16 offset:59264
    v_mfma_f32_16x16x32_bf16 v[156:159], a[28:31], a[172:175], v[156:159]
    ds_read_b64_tr_b16 a[106:107], v16 offset:59776
    v_mfma_f32_16x16x32_bf16 v[160:163], a[32:35], a[160:163], v[160:163]
    ds_read_b64_tr_b16 a[108:109], v16 offset:59296
    v_mfma_f32_16x16x32_bf16 v[164:167], a[32:35], a[164:167], v[164:167]
    s_add_u32 m0, s59, 108160
    s_mov_b32 s58, 1703936
    v_mfma_f32_16x16x32_bf16 v[168:171], a[32:35], a[168:171], v[168:171]
    buffer_load_dwordx4 v5, s[28:31], s58 offen lds
    v_mfma_f32_16x16x32_bf16 v[172:175], a[32:35], a[172:175], v[172:175]
    ds_read_b64_tr_b16 a[110:111], v16 offset:59808
    v_mfma_f32_16x16x32_bf16 v[176:179], a[36:39], a[160:163], v[176:179]
    ds_read_b64_tr_b16 a[112:113], v17 offset:50688
    v_mfma_f32_16x16x32_bf16 v[180:183], a[36:39], a[164:167], v[180:183]
    ds_read_b64_tr_b16 a[114:115], v17 offset:51200
    v_mfma_f32_16x16x32_bf16 v[184:187], a[36:39], a[168:171], v[184:187]
    ds_read_b64_tr_b16 a[116:117], v17 offset:50720
    v_mfma_f32_16x16x32_bf16 v[188:191], a[36:39], a[172:175], v[188:191]
    buffer_load_dwordx4 v6, s[28:31], s58 offen offset:1024 lds
    v_mfma_f32_16x16x32_bf16 v[192:195], a[40:43], a[160:163], v[192:195]
    ds_read_b64_tr_b16 a[118:119], v17 offset:51232
    v_mfma_f32_16x16x32_bf16 v[196:199], a[40:43], a[164:167], v[196:199]
    ds_read_b64_tr_b16 a[120:121], v17 offset:59136
    v_mfma_f32_16x16x32_bf16 v[200:203], a[40:43], a[168:171], v[200:203]
    ds_read_b64_tr_b16 a[122:123], v17 offset:59648
    v_mfma_f32_16x16x32_bf16 v[204:207], a[40:43], a[172:175], v[204:207]
    ds_read_b64_tr_b16 a[124:125], v17 offset:59168
    v_mfma_f32_16x16x32_bf16 v[208:211], a[44:47], a[160:163], v[208:211]
    s_add_u32 m0, s59, 58240
    s_mov_b32 s58, 917504
    v_mfma_f32_16x16x32_bf16 v[212:215], a[44:47], a[164:167], v[212:215]
    buffer_load_dwordx4 v5, s[28:31], s58 offen lds
    v_mfma_f32_16x16x32_bf16 v[216:219], a[44:47], a[168:171], v[216:219]
    ds_read_b64_tr_b16 a[126:127], v17 offset:59680
    v_mfma_f32_16x16x32_bf16 v[220:223], a[44:47], a[172:175], v[220:223]
    v_mfma_f32_16x16x32_bf16 v[224:227], a[48:51], a[160:163], v[224:227]
    v_mfma_f32_16x16x32_bf16 v[228:231], a[48:51], a[164:167], v[228:231]
    v_mfma_f32_16x16x32_bf16 v[232:235], a[52:55], a[160:163], v[232:235]
    buffer_load_dwordx4 v6, s[28:31], s58 offen offset:1024 lds
    v_mfma_f32_16x16x32_bf16 v[236:239], a[52:55], a[164:167], v[236:239]
    v_mfma_f32_16x16x32_bf16 v[240:243], a[56:59], a[160:163], v[240:243]
    v_mfma_f32_16x16x32_bf16 v[244:247], a[56:59], a[164:167], v[244:247]
    v_mfma_f32_16x16x32_bf16 v[248:251], a[60:63], a[160:163], v[248:251]
    v_mfma_f32_16x16x32_bf16 v[252:255], a[60:63], a[164:167], v[252:255]
    s_waitcnt lgkmcnt(0)
    s_waitcnt vmcnt(43)
    v_mfma_f32_16x16x32_bf16 v[32:35], a[64:67], a[176:179], v[32:35]
    s_add_u32 m0, s59, 66560
    s_mov_b32 s58, 1048576
    s_waitcnt vmcnt(42)
    v_mfma_f32_16x16x32_bf16 v[36:39], a[64:67], a[180:183], v[36:39]
    buffer_load_dwordx4 v5, s[28:31], s58 offen lds
    s_waitcnt vmcnt(42)
    v_mfma_f32_16x16x32_bf16 v[40:43], a[64:67], a[184:187], v[40:43]
    s_waitcnt vmcnt(40)
    v_accvgpr_read_b32 v20, a192
    v_accvgpr_read_b32 v21, a193
    v_mfma_f32_16x16x32_bf16 v[44:47], a[64:67], a[188:191], v[44:47]
    s_waitcnt vmcnt(39)
    v_accvgpr_read_b32 v18, a194
    v_mfma_f32_16x16x32_bf16 v[48:51], a[68:71], a[176:179], v[48:51]
    v_accvgpr_read_b32 v19, a195
    v_mfma_f32_16x16x32_bf16 v[52:55], a[68:71], a[180:183], v[52:55]
    v_pk_add_f32 v[20:21], v[20:21], v[18:19]
    s_waitcnt vmcnt(38)
    v_accvgpr_read_b32 v18, a196
    v_mfma_f32_16x16x32_bf16 v[56:59], a[68:71], a[184:187], v[56:59]
    v_accvgpr_read_b32 v19, a197
    v_mfma_f32_16x16x32_bf16 v[60:63], a[68:71], a[188:191], v[60:63]
    buffer_load_dwordx4 v6, s[28:31], s58 offen offset:1024 lds
    v_mfma_f32_16x16x32_bf16 v[64:67], a[72:75], a[176:179], v[64:67]
    v_pk_add_f32 v[20:21], v[20:21], v[18:19]
    v_mfma_f32_16x16x32_bf16 v[68:71], a[72:75], a[180:183], v[68:71]
    s_waitcnt vmcnt(38)
    v_accvgpr_read_b32 v18, a198
    v_accvgpr_read_b32 v19, a199
    v_mfma_f32_16x16x32_bf16 v[72:75], a[72:75], a[184:187], v[72:75]
    v_pk_add_f32 v[20:21], v[20:21], v[18:19]
    v_mfma_f32_16x16x32_bf16 v[76:79], a[72:75], a[188:191], v[76:79]
    s_waitcnt vmcnt(37)
    v_accvgpr_read_b32 v18, a200
    v_mfma_f32_16x16x32_bf16 v[80:83], a[76:79], a[176:179], v[80:83]
    v_accvgpr_read_b32 v19, a201
    v_mfma_f32_16x16x32_bf16 v[84:87], a[76:79], a[180:183], v[84:87]
    s_add_u32 m0, s59, 74880
    s_mov_b32 s58, 1179648
    v_mfma_f32_16x16x32_bf16 v[88:91], a[76:79], a[184:187], v[88:91]
    buffer_load_dwordx4 v5, s[28:31], s58 offen lds
    v_mfma_f32_16x16x32_bf16 v[92:95], a[76:79], a[188:191], v[92:95]
    v_pk_add_f32 v[20:21], v[20:21], v[18:19]
    s_waitcnt vmcnt(37)
    v_accvgpr_read_b32 v18, a202
    v_mfma_f32_16x16x32_bf16 v[96:99], a[80:83], a[176:179], v[96:99]
    v_accvgpr_read_b32 v19, a203
    v_mfma_f32_16x16x32_bf16 v[100:103], a[80:83], a[180:183], v[100:103]
    v_pk_add_f32 v[20:21], v[20:21], v[18:19]
    v_mfma_f32_16x16x32_bf16 v[104:107], a[80:83], a[184:187], v[104:107]
    s_waitcnt vmcnt(36)
    v_accvgpr_read_b32 v18, a204
    v_accvgpr_read_b32 v19, a205
    v_mfma_f32_16x16x32_bf16 v[108:111], a[80:83], a[188:191], v[108:111]
    v_pk_add_f32 v[20:21], v[20:21], v[18:19]
    v_mfma_f32_16x16x32_bf16 v[112:115], a[84:87], a[176:179], v[112:115]
    s_waitcnt vmcnt(35)
    v_accvgpr_read_b32 v18, a206
    v_mfma_f32_16x16x32_bf16 v[116:119], a[84:87], a[180:183], v[116:119]
    buffer_load_dwordx4 v6, s[28:31], s58 offen offset:1024 lds
    v_mfma_f32_16x16x32_bf16 v[120:123], a[84:87], a[184:187], v[120:123]
    v_accvgpr_read_b32 v19, a207
    v_pk_add_f32 v[20:21], v[20:21], v[18:19]
    v_mfma_f32_16x16x32_bf16 v[124:127], a[84:87], a[188:191], v[124:127]
    s_waitcnt vmcnt(35)
    v_accvgpr_read_b32 v18, a208
    v_mfma_f32_16x16x32_bf16 v[128:131], a[88:91], a[176:179], v[128:131]
    v_accvgpr_read_b32 v19, a209
    v_mfma_f32_16x16x32_bf16 v[132:135], a[88:91], a[180:183], v[132:135]
    v_pk_add_f32 v[20:21], v[20:21], v[18:19]
    v_mfma_f32_16x16x32_bf16 v[136:139], a[88:91], a[184:187], v[136:139]
    s_waitcnt vmcnt(34)
    v_accvgpr_read_b32 v18, a210
    v_accvgpr_read_b32 v19, a211
    v_mfma_f32_16x16x32_bf16 v[140:143], a[88:91], a[188:191], v[140:143]
    s_add_u32 m0, s59, 116480
    s_mov_b32 s58, 1835008
    v_mfma_f32_16x16x32_bf16 v[144:147], a[92:95], a[176:179], v[144:147]
    buffer_load_dwordx4 v5, s[28:31], s58 offen lds
    v_mfma_f32_16x16x32_bf16 v[148:151], a[92:95], a[180:183], v[148:151]
    v_pk_add_f32 v[20:21], v[20:21], v[18:19]
    v_mfma_f32_16x16x32_bf16 v[152:155], a[92:95], a[184:187], v[152:155]
    s_waitcnt vmcnt(34)
    v_accvgpr_read_b32 v18, a212
    v_mfma_f32_16x16x32_bf16 v[156:159], a[92:95], a[188:191], v[156:159]
    v_accvgpr_read_b32 v19, a213
    v_pk_add_f32 v[20:21], v[20:21], v[18:19]
    v_mfma_f32_16x16x32_bf16 v[160:163], a[96:99], a[176:179], v[160:163]
    s_waitcnt vmcnt(33)
    v_accvgpr_read_b32 v18, a214
    v_mfma_f32_16x16x32_bf16 v[164:167], a[96:99], a[180:183], v[164:167]
    v_accvgpr_read_b32 v19, a215
    v_mfma_f32_16x16x32_bf16 v[168:171], a[96:99], a[184:187], v[168:171]
    v_pk_add_f32 v[20:21], v[20:21], v[18:19]
    v_mfma_f32_16x16x32_bf16 v[172:175], a[96:99], a[188:191], v[172:175]
    buffer_load_dwordx4 v6, s[28:31], s58 offen offset:1024 lds
    v_mfma_f32_16x16x32_bf16 v[176:179], a[100:103], a[176:179], v[176:179]
    s_waitcnt vmcnt(33)
    v_accvgpr_read_b32 v18, a216
    v_accvgpr_read_b32 v19, a217
    v_mfma_f32_16x16x32_bf16 v[180:183], a[100:103], a[180:183], v[180:183]
    v_pk_add_f32 v[20:21], v[20:21], v[18:19]
    v_mfma_f32_16x16x32_bf16 v[184:187], a[100:103], a[184:187], v[184:187]
    s_waitcnt vmcnt(32)
    v_accvgpr_read_b32 v18, a218
    v_mfma_f32_16x16x32_bf16 v[188:191], a[100:103], a[188:191], v[188:191]
    v_accvgpr_read_b32 v19, a219
    v_pk_add_f32 v[20:21], v[20:21], v[18:19]
    v_mfma_f32_16x16x32_bf16 v[192:195], a[104:107], a[176:179], v[192:195]
    s_waitcnt vmcnt(31)
    v_accvgpr_read_b32 v18, a220
    v_mfma_f32_16x16x32_bf16 v[196:199], a[104:107], a[180:183], v[196:199]
    s_add_u32 m0, s59, 124800
    s_mov_b32 s58, 1966080
    v_mfma_f32_16x16x32_bf16 v[200:203], a[104:107], a[184:187], v[200:203]
    buffer_load_dwordx4 v5, s[28:31], s58 offen lds
    v_mfma_f32_16x16x32_bf16 v[204:207], a[104:107], a[188:191], v[204:207]
    v_accvgpr_read_b32 v19, a221
    v_mfma_f32_16x16x32_bf16 v[208:211], a[108:111], a[176:179], v[208:211]
    v_pk_add_f32 v[20:21], v[20:21], v[18:19]
    s_waitcnt vmcnt(31)
    v_accvgpr_read_b32 v18, a222
    v_mfma_f32_16x16x32_bf16 v[212:215], a[108:111], a[180:183], v[212:215]
    v_accvgpr_read_b32 v19, a223
    v_mfma_f32_16x16x32_bf16 v[216:219], a[108:111], a[184:187], v[216:219]
    v_pk_add_f32 v[20:21], v[20:21], v[18:19]
    v_mfma_f32_16x16x32_bf16 v[220:223], a[108:111], a[188:191], v[220:223]
    v_mul_f32 v20, 0xba800000, v20
    v_mfma_f32_16x16x32_bf16 v[224:227], a[112:115], a[176:179], v[224:227]
    v_mul_f32 v21, 0x3a800000, v21
    v_fma_f32 v21, -v20, v20, v21
    v_mfma_f32_16x16x32_bf16 v[228:231], a[112:115], a[180:183], v[228:231]
    buffer_load_dwordx4 v6, s[28:31], s58 offen offset:1024 lds
    v_mfma_f32_16x16x32_bf16 v[232:235], a[116:119], a[176:179], v[232:235]
    v_max_f32 v21, 0, v21
    v_mfma_f32_16x16x32_bf16 v[236:239], a[116:119], a[180:183], v[236:239]
    v_add_f32 v21, 0x3727c5ac, v21
    v_mfma_f32_16x16x32_bf16 v[240:243], a[120:123], a[176:179], v[240:243]
    v_rsq_f32 v22, v21
    v_lshlrev_b32 v18, 4, v0
    v_mfma_f32_16x16x32_bf16 v[244:247], a[120:123], a[180:183], v[244:247]
    v_add_u32 v18, 151552, v18
    v_mfma_f32_16x16x32_bf16 v[248:251], a[124:127], a[176:179], v[248:251]
    v_mul_f32 v22, 0xbfb8aa3b, v22
    v_mfma_f32_16x16x32_bf16 v[252:255], a[124:127], a[180:183], v[252:255]
    ds_write_b128 v18, v[20:23]
    s_lshl_b32 s62, s3, 10
    s_lshl_b32 s63, s12, 9
    s_add_u32 s62, s62, s63
    s_add_u32 s62, s62, 151552
    v_and_b32 v2, 15, v1
    v_lshl_add_u32 v2, v2, 4, s62
    ds_read_b128 v[16:19], v2 offset:0
    ds_read_b128 v[20:23], v2 offset:256
    v_xor_b32 v8, 512, v2
    ds_read_b128 v[24:27], v8 offset:0
    ds_read_b128 v[28:31], v8 offset:256
    s_lshl_b32 s62, s12, 7
    s_add_u32 s62, s62, 156928
    s_xor_b32 s63, s12, 1
    s_mul_i32 s63, s63, 384
    s_add_u32 s63, s63, 156928
    v_lshrrev_b32 v9, 4, v1
    v_lshlrev_b32 v9, 4, v9
    v_add_u32 v8, s63, v9
    v_add_u32 v9, s62, v9
    ds_read_b128 v[4:7], v9 offset:0
    ds_read_b128 v[12:15], v9 offset:512
    s_mul_i32 s66, s13, 7
    s_lshl_b32 s66, s66, 17
    s_add_u32 s66, s66, s14
    s_add_u32 s66, s66, 12582912
    s_add_u32 s65, s66, 393216
    s_lshl_b32 s62, s12, 19
    s_add_u32 s62, s62, s66
    s_add_u32 s63, s62, 0x20000
    s_add_u32 s64, s62, 0x40000
    s_waitcnt lgkmcnt(1)
    v_pk_fma_f32 v[32:33], v[4:5], v[16:17], v[32:33] op_sel_hi:[1,0,1]
    s_waitcnt lgkmcnt(0)
    v_pk_fma_f32 v[64:65], v[12:13], v[16:17], v[64:65] op_sel_hi:[1,0,1]
    v_pk_fma_f32 v[34:35], v[6:7], v[16:17], v[34:35] op_sel_hi:[1,0,1]
    v_pk_fma_f32 v[66:67], v[14:15], v[16:17], v[66:67] op_sel_hi:[1,0,1]
    v_pk_fma_f32 v[36:37], v[4:5], v[20:21], v[36:37] op_sel_hi:[1,0,1]
    v_pk_fma_f32 v[68:69], v[12:13], v[20:21], v[68:69] op_sel_hi:[1,0,1]
    v_pk_fma_f32 v[38:39], v[6:7], v[20:21], v[38:39] op_sel_hi:[1,0,1]
    v_pk_fma_f32 v[70:71], v[14:15], v[20:21], v[70:71] op_sel_hi:[1,0,1]
    v_pk_fma_f32 v[40:41], v[4:5], v[24:25], v[40:41] op_sel_hi:[1,0,1]
    v_pk_fma_f32 v[72:73], v[12:13], v[24:25], v[72:73] op_sel_hi:[1,0,1]
    v_pk_fma_f32 v[42:43], v[6:7], v[24:25], v[42:43] op_sel_hi:[1,0,1]
    v_pk_fma_f32 v[74:75], v[14:15], v[24:25], v[74:75] op_sel_hi:[1,0,1]
    v_pk_fma_f32 v[44:45], v[4:5], v[28:29], v[44:45] op_sel_hi:[1,0,1]
    v_pk_fma_f32 v[76:77], v[12:13], v[28:29], v[76:77] op_sel_hi:[1,0,1]
    v_pk_fma_f32 v[46:47], v[6:7], v[28:29], v[46:47] op_sel_hi:[1,0,1]
    ds_read_b128 v[4:7], v9 offset:64
    v_pk_fma_f32 v[78:79], v[14:15], v[28:29], v[78:79] op_sel_hi:[1,0,1]
    ds_read_b128 v[12:15], v9 offset:576
    v_pk_mul_f32 v[64:65], v[64:65], v[32:33]
    v_pk_mul_f32 v[32:33], v[32:33], v[18:19] op_sel_hi:[1,0]
    v_exp_f32 v32, v32
    v_pk_mul_f32 v[66:67], v[66:67], v[34:35]
    v_exp_f32 v33, v33
    v_pk_mul_f32 v[34:35], v[34:35], v[18:19] op_sel_hi:[1,0]
    v_exp_f32 v34, v34
    v_pk_fma_f32 v[32:33], v[32:33], v[16:17], v[16:17] op_sel:[0,1,1] op_sel_hi:[1,1,1]
    v_exp_f32 v35, v35
    v_pk_mul_f32 v[68:69], v[68:69], v[36:37]
    v_rcp_f32 v32, v32
    v_pk_fma_f32 v[34:35], v[34:35], v[16:17], v[16:17] op_sel:[0,1,1] op_sel_hi:[1,1,1]
    v_rcp_f32 v33, v33
    v_pk_mul_f32 v[36:37], v[36:37], v[22:23] op_sel_hi:[1,0]
    v_rcp_f32 v34, v34
    v_pk_mul_f32 v[64:65], v[64:65], v[32:33]
    v_rcp_f32 v35, v35
    v_cvt_pk_bf16_f32 v32, v64, v65
    v_exp_f32 v36, v36
    v_pk_mul_f32 v[66:67], v[66:67], v[34:35]
    v_exp_f32 v37, v37
    s_waitcnt lgkmcnt(1)
    v_pk_fma_f32 v[48:49], v[4:5], v[16:17], v[48:49] op_sel_hi:[1,0,1]
    v_pk_fma_f32 v[50:51], v[6:7], v[16:17], v[50:51] op_sel_hi:[1,0,1]
    s_waitcnt lgkmcnt(0)
    v_pk_fma_f32 v[80:81], v[12:13], v[16:17], v[80:81] op_sel_hi:[1,0,1]
    v_pk_fma_f32 v[82:83], v[14:15], v[16:17], v[82:83] op_sel_hi:[1,0,1]
    v_pk_fma_f32 v[52:53], v[4:5], v[20:21], v[52:53] op_sel_hi:[1,0,1]
    v_pk_fma_f32 v[84:85], v[12:13], v[20:21], v[84:85] op_sel_hi:[1,0,1]
    v_pk_fma_f32 v[54:55], v[6:7], v[20:21], v[54:55] op_sel_hi:[1,0,1]
    v_pk_fma_f32 v[86:87], v[14:15], v[20:21], v[86:87] op_sel_hi:[1,0,1]
    v_pk_fma_f32 v[56:57], v[4:5], v[24:25], v[56:57] op_sel_hi:[1,0,1]
    v_pk_fma_f32 v[88:89], v[12:13], v[24:25], v[88:89] op_sel_hi:[1,0,1]
    v_pk_fma_f32 v[58:59], v[6:7], v[24:25], v[58:59] op_sel_hi:[1,0,1]
    v_pk_fma_f32 v[90:91], v[14:15], v[24:25], v[90:91] op_sel_hi:[1,0,1]
    v_pk_fma_f32 v[60:61], v[4:5], v[28:29], v[60:61] op_sel_hi:[1,0,1]
    v_pk_fma_f32 v[92:93], v[12:13], v[28:29], v[92:93] op_sel_hi:[1,0,1]
    v_pk_fma_f32 v[62:63], v[6:7], v[28:29], v[62:63] op_sel_hi:[1,0,1]
    v_pk_fma_f32 v[94:95], v[14:15], v[28:29], v[94:95] op_sel_hi:[1,0,1]
    v_pk_mul_f32 v[80:81], v[80:81], v[48:49]
    v_pk_mul_f32 v[48:49], v[48:49], v[18:19] op_sel_hi:[1,0]
    v_exp_f32 v48, v48
    v_pk_mul_f32 v[82:83], v[82:83], v[50:51]
    v_exp_f32 v49, v49
    v_pk_mul_f32 v[50:51], v[50:51], v[18:19] op_sel_hi:[1,0]
    v_exp_f32 v50, v50
    v_pk_fma_f32 v[48:49], v[48:49], v[16:17], v[16:17] op_sel:[0,1,1] op_sel_hi:[1,1,1]
    v_exp_f32 v51, v51
    v_cvt_pk_bf16_f32 v33, v66, v67
    v_rcp_f32 v48, v48
    v_pk_fma_f32 v[50:51], v[50:51], v[16:17], v[16:17] op_sel:[0,1,1] op_sel_hi:[1,1,1]
    v_rcp_f32 v49, v49
    v_pk_mul_f32 v[70:71], v[70:71], v[38:39]
    v_rcp_f32 v50, v50
    v_pk_mul_f32 v[80:81], v[80:81], v[48:49]
    v_rcp_f32 v51, v51
    v_cvt_pk_bf16_f32 v34, v80, v81
    v_pk_mul_f32 v[82:83], v[82:83], v[50:51]
    v_cvt_pk_bf16_f32 v35, v82, v83
    buffer_store_dwordx4 v[32:35], v10, s[16:19], s62 offen offset:0 sc1
    v_pk_mul_f32 v[38:39], v[38:39], v[22:23] op_sel_hi:[1,0]
    v_exp_f32 v38, v38
    v_pk_mul_f32 v[84:85], v[84:85], v[52:53]
    v_exp_f32 v39, v39
    v_pk_mul_f32 v[52:53], v[52:53], v[22:23] op_sel_hi:[1,0]
    v_exp_f32 v52, v52
    v_pk_mul_f32 v[86:87], v[86:87], v[54:55]
    v_exp_f32 v53, v53
    v_pk_mul_f32 v[54:55], v[54:55], v[22:23] op_sel_hi:[1,0]
    v_exp_f32 v54, v54
    v_pk_fma_f32 v[36:37], v[36:37], v[20:21], v[20:21] op_sel:[0,1,1] op_sel_hi:[1,1,1]
    v_exp_f32 v55, v55
    v_pk_fma_f32 v[38:39], v[38:39], v[20:21], v[20:21] op_sel:[0,1,1] op_sel_hi:[1,1,1]
    v_rcp_f32 v36, v36
    v_pk_fma_f32 v[52:53], v[52:53], v[20:21], v[20:21] op_sel:[0,1,1] op_sel_hi:[1,1,1]
    v_rcp_f32 v37, v37
    v_pk_fma_f32 v[54:55], v[54:55], v[20:21], v[20:21] op_sel:[0,1,1] op_sel_hi:[1,1,1]
    v_rcp_f32 v38, v38
    v_pk_mul_f32 v[68:69], v[68:69], v[36:37]
    v_rcp_f32 v39, v39
    v_cvt_pk_bf16_f32 v36, v68, v69
    v_rcp_f32 v52, v52
    v_pk_mul_f32 v[70:71], v[70:71], v[38:39]
    v_rcp_f32 v53, v53
    v_cvt_pk_bf16_f32 v37, v70, v71
    v_rcp_f32 v54, v54
    v_pk_mul_f32 v[84:85], v[84:85], v[52:53]
    v_rcp_f32 v55, v55
    v_cvt_pk_bf16_f32 v38, v84, v85
    v_pk_mul_f32 v[86:87], v[86:87], v[54:55]
    v_cvt_pk_bf16_f32 v39, v86, v87
    buffer_store_dwordx4 v[36:39], v10, s[16:19], s62 offen offset:1024 sc1
    v_pk_mul_f32 v[72:73], v[72:73], v[40:41]
    v_pk_mul_f32 v[40:41], v[40:41], v[26:27] op_sel_hi:[1,0]
    v_exp_f32 v40, v40
    v_pk_mul_f32 v[74:75], v[74:75], v[42:43]
    v_exp_f32 v41, v41
    v_pk_mul_f32 v[42:43], v[42:43], v[26:27] op_sel_hi:[1,0]
    v_exp_f32 v42, v42
    v_pk_mul_f32 v[88:89], v[88:89], v[56:57]
    v_exp_f32 v43, v43
    v_pk_mul_f32 v[56:57], v[56:57], v[26:27] op_sel_hi:[1,0]
    v_exp_f32 v56, v56
    v_pk_mul_f32 v[90:91], v[90:91], v[58:59]
    v_exp_f32 v57, v57
    v_pk_mul_f32 v[58:59], v[58:59], v[26:27] op_sel_hi:[1,0]
    v_exp_f32 v58, v58
    v_pk_fma_f32 v[40:41], v[40:41], v[24:25], v[24:25] op_sel:[0,1,1] op_sel_hi:[1,1,1]
    v_exp_f32 v59, v59
    v_pk_fma_f32 v[42:43], v[42:43], v[24:25], v[24:25] op_sel:[0,1,1] op_sel_hi:[1,1,1]
    v_rcp_f32 v40, v40
    v_pk_fma_f32 v[56:57], v[56:57], v[24:25], v[24:25] op_sel:[0,1,1] op_sel_hi:[1,1,1]
    v_rcp_f32 v41, v41
    v_pk_fma_f32 v[58:59], v[58:59], v[24:25], v[24:25] op_sel:[0,1,1] op_sel_hi:[1,1,1]
    v_rcp_f32 v42, v42
    v_pk_mul_f32 v[72:73], v[72:73], v[40:41]
    v_rcp_f32 v43, v43
    v_cvt_pk_bf16_f32 v40, v72, v73
    v_rcp_f32 v56, v56
    v_pk_mul_f32 v[74:75], v[74:75], v[42:43]
    v_rcp_f32 v57, v57
    v_cvt_pk_bf16_f32 v41, v74, v75
    v_rcp_f32 v58, v58
    v_pk_mul_f32 v[88:89], v[88:89], v[56:57]
    v_rcp_f32 v59, v59
    v_cvt_pk_bf16_f32 v42, v88, v89
    v_pk_mul_f32 v[90:91], v[90:91], v[58:59]
    v_cvt_pk_bf16_f32 v43, v90, v91
    buffer_store_dwordx4 v[40:43], v11, s[16:19], s62 offen offset:0 sc1
    v_pk_mul_f32 v[76:77], v[76:77], v[44:45]
    v_pk_mul_f32 v[44:45], v[44:45], v[30:31] op_sel_hi:[1,0]
    v_exp_f32 v44, v44
    v_pk_mul_f32 v[78:79], v[78:79], v[46:47]
    v_exp_f32 v45, v45
    v_pk_mul_f32 v[46:47], v[46:47], v[30:31] op_sel_hi:[1,0]
    v_exp_f32 v46, v46
    v_pk_mul_f32 v[92:93], v[92:93], v[60:61]
    v_exp_f32 v47, v47
    v_pk_mul_f32 v[60:61], v[60:61], v[30:31] op_sel_hi:[1,0]
    v_exp_f32 v60, v60
    v_pk_mul_f32 v[94:95], v[94:95], v[62:63]
    v_exp_f32 v61, v61
    v_pk_mul_f32 v[62:63], v[62:63], v[30:31] op_sel_hi:[1,0]
    v_exp_f32 v62, v62
    v_pk_fma_f32 v[44:45], v[44:45], v[28:29], v[28:29] op_sel:[0,1,1] op_sel_hi:[1,1,1]
    v_exp_f32 v63, v63
    v_pk_fma_f32 v[46:47], v[46:47], v[28:29], v[28:29] op_sel:[0,1,1] op_sel_hi:[1,1,1]
    v_rcp_f32 v44, v44
    v_pk_fma_f32 v[60:61], v[60:61], v[28:29], v[28:29] op_sel:[0,1,1] op_sel_hi:[1,1,1]
    v_rcp_f32 v45, v45
    v_pk_fma_f32 v[62:63], v[62:63], v[28:29], v[28:29] op_sel:[0,1,1] op_sel_hi:[1,1,1]
    v_rcp_f32 v46, v46
    v_pk_mul_f32 v[76:77], v[76:77], v[44:45]
    v_rcp_f32 v47, v47
    v_cvt_pk_bf16_f32 v44, v76, v77
    v_rcp_f32 v60, v60
    v_pk_mul_f32 v[78:79], v[78:79], v[46:47]
    v_rcp_f32 v61, v61
    v_cvt_pk_bf16_f32 v45, v78, v79
    v_rcp_f32 v62, v62
    v_pk_mul_f32 v[92:93], v[92:93], v[60:61]
    v_rcp_f32 v63, v63
    v_cvt_pk_bf16_f32 v46, v92, v93
    v_pk_mul_f32 v[94:95], v[94:95], v[62:63]
    v_cvt_pk_bf16_f32 v47, v94, v95
    buffer_store_dwordx4 v[44:47], v11, s[16:19], s62 offen offset:1024 sc1
    ds_read_b128 v[4:7], v9 offset:128
    ds_read_b128 v[12:15], v9 offset:640
    s_waitcnt lgkmcnt(1)
    v_pk_fma_f32 v[96:97], v[4:5], v[16:17], v[96:97] op_sel_hi:[1,0,1]
    s_waitcnt lgkmcnt(0)
    v_pk_fma_f32 v[128:129], v[12:13], v[16:17], v[128:129] op_sel_hi:[1,0,1]
    v_pk_fma_f32 v[98:99], v[6:7], v[16:17], v[98:99] op_sel_hi:[1,0,1]
    v_pk_fma_f32 v[130:131], v[14:15], v[16:17], v[130:131] op_sel_hi:[1,0,1]
    v_pk_fma_f32 v[100:101], v[4:5], v[20:21], v[100:101] op_sel_hi:[1,0,1]
    v_pk_fma_f32 v[132:133], v[12:13], v[20:21], v[132:133] op_sel_hi:[1,0,1]
    v_pk_fma_f32 v[102:103], v[6:7], v[20:21], v[102:103] op_sel_hi:[1,0,1]
    v_pk_fma_f32 v[134:135], v[14:15], v[20:21], v[134:135] op_sel_hi:[1,0,1]
    v_pk_fma_f32 v[104:105], v[4:5], v[24:25], v[104:105] op_sel_hi:[1,0,1]
    v_pk_fma_f32 v[136:137], v[12:13], v[24:25], v[136:137] op_sel_hi:[1,0,1]
    v_pk_fma_f32 v[106:107], v[6:7], v[24:25], v[106:107] op_sel_hi:[1,0,1]
    v_pk_fma_f32 v[138:139], v[14:15], v[24:25], v[138:139] op_sel_hi:[1,0,1]
    v_pk_fma_f32 v[108:109], v[4:5], v[28:29], v[108:109] op_sel_hi:[1,0,1]
    v_pk_fma_f32 v[140:141], v[12:13], v[28:29], v[140:141] op_sel_hi:[1,0,1]
    v_pk_fma_f32 v[110:111], v[6:7], v[28:29], v[110:111] op_sel_hi:[1,0,1]
    ds_read_b128 v[4:7], v9 offset:192
    v_pk_fma_f32 v[142:143], v[14:15], v[28:29], v[142:143] op_sel_hi:[1,0,1]
    ds_read_b128 v[12:15], v9 offset:704
    v_pk_mul_f32 v[128:129], v[128:129], v[96:97]
    v_pk_mul_f32 v[96:97], v[96:97], v[18:19] op_sel_hi:[1,0]
    v_exp_f32 v96, v96
    v_pk_mul_f32 v[130:131], v[130:131], v[98:99]
    v_exp_f32 v97, v97
    v_pk_mul_f32 v[98:99], v[98:99], v[18:19] op_sel_hi:[1,0]
    v_exp_f32 v98, v98
    v_pk_fma_f32 v[96:97], v[96:97], v[16:17], v[16:17] op_sel:[0,1,1] op_sel_hi:[1,1,1]
    v_exp_f32 v99, v99
    v_pk_mul_f32 v[132:133], v[132:133], v[100:101]
    v_rcp_f32 v96, v96
    v_pk_fma_f32 v[98:99], v[98:99], v[16:17], v[16:17] op_sel:[0,1,1] op_sel_hi:[1,1,1]
    v_rcp_f32 v97, v97
    v_pk_mul_f32 v[100:101], v[100:101], v[22:23] op_sel_hi:[1,0]
    v_rcp_f32 v98, v98
    v_pk_mul_f32 v[128:129], v[128:129], v[96:97]
    v_rcp_f32 v99, v99
    v_cvt_pk_bf16_f32 v96, v128, v129
    v_exp_f32 v100, v100
    v_pk_mul_f32 v[130:131], v[130:131], v[98:99]
    v_exp_f32 v101, v101
    s_waitcnt lgkmcnt(1)
    v_pk_fma_f32 v[112:113], v[4:5], v[16:17], v[112:113] op_sel_hi:[1,0,1]
    v_pk_fma_f32 v[114:115], v[6:7], v[16:17], v[114:115] op_sel_hi:[1,0,1]
    s_waitcnt lgkmcnt(0)
    v_pk_fma_f32 v[144:145], v[12:13], v[16:17], v[144:145] op_sel_hi:[1,0,1]
    v_pk_fma_f32 v[146:147], v[14:15], v[16:17], v[146:147] op_sel_hi:[1,0,1]
    v_pk_fma_f32 v[116:117], v[4:5], v[20:21], v[116:117] op_sel_hi:[1,0,1]
    v_pk_fma_f32 v[148:149], v[12:13], v[20:21], v[148:149] op_sel_hi:[1,0,1]
    v_pk_fma_f32 v[118:119], v[6:7], v[20:21], v[118:119] op_sel_hi:[1,0,1]
    v_pk_fma_f32 v[150:151], v[14:15], v[20:21], v[150:151] op_sel_hi:[1,0,1]
    v_pk_fma_f32 v[120:121], v[4:5], v[24:25], v[120:121] op_sel_hi:[1,0,1]
    v_pk_fma_f32 v[152:153], v[12:13], v[24:25], v[152:153] op_sel_hi:[1,0,1]
    v_pk_fma_f32 v[122:123], v[6:7], v[24:25], v[122:123] op_sel_hi:[1,0,1]
    v_pk_fma_f32 v[154:155], v[14:15], v[24:25], v[154:155] op_sel_hi:[1,0,1]
    v_pk_fma_f32 v[124:125], v[4:5], v[28:29], v[124:125] op_sel_hi:[1,0,1]
    v_pk_fma_f32 v[156:157], v[12:13], v[28:29], v[156:157] op_sel_hi:[1,0,1]
    v_pk_fma_f32 v[126:127], v[6:7], v[28:29], v[126:127] op_sel_hi:[1,0,1]
    v_pk_fma_f32 v[158:159], v[14:15], v[28:29], v[158:159] op_sel_hi:[1,0,1]
    v_pk_mul_f32 v[144:145], v[144:145], v[112:113]
    v_pk_mul_f32 v[112:113], v[112:113], v[18:19] op_sel_hi:[1,0]
    v_exp_f32 v112, v112
    v_pk_mul_f32 v[146:147], v[146:147], v[114:115]
    v_exp_f32 v113, v113
    v_pk_mul_f32 v[114:115], v[114:115], v[18:19] op_sel_hi:[1,0]
    v_exp_f32 v114, v114
    v_pk_fma_f32 v[112:113], v[112:113], v[16:17], v[16:17] op_sel:[0,1,1] op_sel_hi:[1,1,1]
    v_exp_f32 v115, v115
    v_cvt_pk_bf16_f32 v97, v130, v131
    v_rcp_f32 v112, v112
    v_pk_fma_f32 v[114:115], v[114:115], v[16:17], v[16:17] op_sel:[0,1,1] op_sel_hi:[1,1,1]
    v_rcp_f32 v113, v113
    v_pk_mul_f32 v[134:135], v[134:135], v[102:103]
    v_rcp_f32 v114, v114
    v_pk_mul_f32 v[144:145], v[144:145], v[112:113]
    v_rcp_f32 v115, v115
    v_cvt_pk_bf16_f32 v98, v144, v145
    v_pk_mul_f32 v[146:147], v[146:147], v[114:115]
    v_cvt_pk_bf16_f32 v99, v146, v147
    buffer_store_dwordx4 v[96:99], v10, s[16:19], s63 offen offset:0 sc1
    v_pk_mul_f32 v[102:103], v[102:103], v[22:23] op_sel_hi:[1,0]
    v_exp_f32 v102, v102
    v_pk_mul_f32 v[148:149], v[148:149], v[116:117]
    v_exp_f32 v103, v103
    v_pk_mul_f32 v[116:117], v[116:117], v[22:23] op_sel_hi:[1,0]
    v_exp_f32 v116, v116
    v_pk_mul_f32 v[150:151], v[150:151], v[118:119]
    v_exp_f32 v117, v117
    v_pk_mul_f32 v[118:119], v[118:119], v[22:23] op_sel_hi:[1,0]
    v_exp_f32 v118, v118
    v_pk_fma_f32 v[100:101], v[100:101], v[20:21], v[20:21] op_sel:[0,1,1] op_sel_hi:[1,1,1]
    v_exp_f32 v119, v119
    v_pk_fma_f32 v[102:103], v[102:103], v[20:21], v[20:21] op_sel:[0,1,1] op_sel_hi:[1,1,1]
    v_rcp_f32 v100, v100
    v_pk_fma_f32 v[116:117], v[116:117], v[20:21], v[20:21] op_sel:[0,1,1] op_sel_hi:[1,1,1]
    v_rcp_f32 v101, v101
    v_pk_fma_f32 v[118:119], v[118:119], v[20:21], v[20:21] op_sel:[0,1,1] op_sel_hi:[1,1,1]
    v_rcp_f32 v102, v102
    v_pk_mul_f32 v[132:133], v[132:133], v[100:101]
    v_rcp_f32 v103, v103
    v_cvt_pk_bf16_f32 v100, v132, v133
    v_rcp_f32 v116, v116
    v_pk_mul_f32 v[134:135], v[134:135], v[102:103]
    v_rcp_f32 v117, v117
    v_cvt_pk_bf16_f32 v101, v134, v135
    v_rcp_f32 v118, v118
    v_pk_mul_f32 v[148:149], v[148:149], v[116:117]
    v_rcp_f32 v119, v119
    v_cvt_pk_bf16_f32 v102, v148, v149
    v_pk_mul_f32 v[150:151], v[150:151], v[118:119]
    v_cvt_pk_bf16_f32 v103, v150, v151
    buffer_store_dwordx4 v[100:103], v10, s[16:19], s63 offen offset:1024 sc1
    v_pk_mul_f32 v[136:137], v[136:137], v[104:105]
    v_pk_mul_f32 v[104:105], v[104:105], v[26:27] op_sel_hi:[1,0]
    v_exp_f32 v104, v104
    v_pk_mul_f32 v[138:139], v[138:139], v[106:107]
    v_exp_f32 v105, v105
    v_pk_mul_f32 v[106:107], v[106:107], v[26:27] op_sel_hi:[1,0]
    v_exp_f32 v106, v106
    v_pk_mul_f32 v[152:153], v[152:153], v[120:121]
    v_exp_f32 v107, v107
    v_pk_mul_f32 v[120:121], v[120:121], v[26:27] op_sel_hi:[1,0]
    v_exp_f32 v120, v120
    v_pk_mul_f32 v[154:155], v[154:155], v[122:123]
    v_exp_f32 v121, v121
    v_pk_mul_f32 v[122:123], v[122:123], v[26:27] op_sel_hi:[1,0]
    v_exp_f32 v122, v122
    v_pk_fma_f32 v[104:105], v[104:105], v[24:25], v[24:25] op_sel:[0,1,1] op_sel_hi:[1,1,1]
    v_exp_f32 v123, v123
    v_pk_fma_f32 v[106:107], v[106:107], v[24:25], v[24:25] op_sel:[0,1,1] op_sel_hi:[1,1,1]
    v_rcp_f32 v104, v104
    v_pk_fma_f32 v[120:121], v[120:121], v[24:25], v[24:25] op_sel:[0,1,1] op_sel_hi:[1,1,1]
    v_rcp_f32 v105, v105
    v_pk_fma_f32 v[122:123], v[122:123], v[24:25], v[24:25] op_sel:[0,1,1] op_sel_hi:[1,1,1]
    v_rcp_f32 v106, v106
    v_pk_mul_f32 v[136:137], v[136:137], v[104:105]
    v_rcp_f32 v107, v107
    v_cvt_pk_bf16_f32 v104, v136, v137
    v_rcp_f32 v120, v120
    v_pk_mul_f32 v[138:139], v[138:139], v[106:107]
    v_rcp_f32 v121, v121
    v_cvt_pk_bf16_f32 v105, v138, v139
    v_rcp_f32 v122, v122
    v_pk_mul_f32 v[152:153], v[152:153], v[120:121]
    v_rcp_f32 v123, v123
    v_cvt_pk_bf16_f32 v106, v152, v153
    v_pk_mul_f32 v[154:155], v[154:155], v[122:123]
    v_cvt_pk_bf16_f32 v107, v154, v155
    buffer_store_dwordx4 v[104:107], v11, s[16:19], s63 offen offset:0 sc1
    v_pk_mul_f32 v[140:141], v[140:141], v[108:109]
    v_pk_mul_f32 v[108:109], v[108:109], v[30:31] op_sel_hi:[1,0]
    v_exp_f32 v108, v108
    v_pk_mul_f32 v[142:143], v[142:143], v[110:111]
    v_exp_f32 v109, v109
    v_pk_mul_f32 v[110:111], v[110:111], v[30:31] op_sel_hi:[1,0]
    v_exp_f32 v110, v110
    v_pk_mul_f32 v[156:157], v[156:157], v[124:125]
    v_exp_f32 v111, v111
    v_pk_mul_f32 v[124:125], v[124:125], v[30:31] op_sel_hi:[1,0]
    v_exp_f32 v124, v124
    v_pk_mul_f32 v[158:159], v[158:159], v[126:127]
    v_exp_f32 v125, v125
    v_pk_mul_f32 v[126:127], v[126:127], v[30:31] op_sel_hi:[1,0]
    v_exp_f32 v126, v126
    v_pk_fma_f32 v[108:109], v[108:109], v[28:29], v[28:29] op_sel:[0,1,1] op_sel_hi:[1,1,1]
    v_exp_f32 v127, v127
    v_pk_fma_f32 v[110:111], v[110:111], v[28:29], v[28:29] op_sel:[0,1,1] op_sel_hi:[1,1,1]
    v_rcp_f32 v108, v108
    v_pk_fma_f32 v[124:125], v[124:125], v[28:29], v[28:29] op_sel:[0,1,1] op_sel_hi:[1,1,1]
    v_rcp_f32 v109, v109
    v_pk_fma_f32 v[126:127], v[126:127], v[28:29], v[28:29] op_sel:[0,1,1] op_sel_hi:[1,1,1]
    v_rcp_f32 v110, v110
    v_pk_mul_f32 v[140:141], v[140:141], v[108:109]
    v_rcp_f32 v111, v111
    v_cvt_pk_bf16_f32 v108, v140, v141
    v_rcp_f32 v124, v124
    v_pk_mul_f32 v[142:143], v[142:143], v[110:111]
    v_rcp_f32 v125, v125
    v_cvt_pk_bf16_f32 v109, v142, v143
    v_rcp_f32 v126, v126
    v_pk_mul_f32 v[156:157], v[156:157], v[124:125]
    v_rcp_f32 v127, v127
    v_cvt_pk_bf16_f32 v110, v156, v157
    v_pk_mul_f32 v[158:159], v[158:159], v[126:127]
    v_cvt_pk_bf16_f32 v111, v158, v159
    buffer_store_dwordx4 v[108:111], v11, s[16:19], s63 offen offset:1024 sc1
    ds_read_b128 v[4:7], v9 offset:256
    ds_read_b128 v[12:15], v9 offset:768
    s_waitcnt lgkmcnt(1)
    v_pk_fma_f32 v[160:161], v[4:5], v[16:17], v[160:161] op_sel_hi:[1,0,1]
    s_waitcnt lgkmcnt(0)
    v_pk_fma_f32 v[192:193], v[12:13], v[16:17], v[192:193] op_sel_hi:[1,0,1]
    v_pk_fma_f32 v[162:163], v[6:7], v[16:17], v[162:163] op_sel_hi:[1,0,1]
    v_pk_fma_f32 v[194:195], v[14:15], v[16:17], v[194:195] op_sel_hi:[1,0,1]
    v_pk_fma_f32 v[164:165], v[4:5], v[20:21], v[164:165] op_sel_hi:[1,0,1]
    v_pk_fma_f32 v[196:197], v[12:13], v[20:21], v[196:197] op_sel_hi:[1,0,1]
    v_pk_fma_f32 v[166:167], v[6:7], v[20:21], v[166:167] op_sel_hi:[1,0,1]
    v_pk_fma_f32 v[198:199], v[14:15], v[20:21], v[198:199] op_sel_hi:[1,0,1]
    v_pk_fma_f32 v[168:169], v[4:5], v[24:25], v[168:169] op_sel_hi:[1,0,1]
    v_pk_fma_f32 v[200:201], v[12:13], v[24:25], v[200:201] op_sel_hi:[1,0,1]
    v_pk_fma_f32 v[170:171], v[6:7], v[24:25], v[170:171] op_sel_hi:[1,0,1]
    v_pk_fma_f32 v[202:203], v[14:15], v[24:25], v[202:203] op_sel_hi:[1,0,1]
    v_pk_fma_f32 v[172:173], v[4:5], v[28:29], v[172:173] op_sel_hi:[1,0,1]
    v_pk_fma_f32 v[204:205], v[12:13], v[28:29], v[204:205] op_sel_hi:[1,0,1]
    v_pk_fma_f32 v[174:175], v[6:7], v[28:29], v[174:175] op_sel_hi:[1,0,1]
    ds_read_b128 v[4:7], v9 offset:320
    v_pk_fma_f32 v[206:207], v[14:15], v[28:29], v[206:207] op_sel_hi:[1,0,1]
    ds_read_b128 v[12:15], v9 offset:832
    v_pk_mul_f32 v[192:193], v[192:193], v[160:161]
    v_pk_mul_f32 v[160:161], v[160:161], v[18:19] op_sel_hi:[1,0]
    v_exp_f32 v160, v160
    v_pk_mul_f32 v[194:195], v[194:195], v[162:163]
    v_exp_f32 v161, v161
    v_pk_mul_f32 v[162:163], v[162:163], v[18:19] op_sel_hi:[1,0]
    v_exp_f32 v162, v162
    v_pk_fma_f32 v[160:161], v[160:161], v[16:17], v[16:17] op_sel:[0,1,1] op_sel_hi:[1,1,1]
    v_exp_f32 v163, v163
    v_pk_mul_f32 v[196:197], v[196:197], v[164:165]
    v_rcp_f32 v160, v160
    v_pk_fma_f32 v[162:163], v[162:163], v[16:17], v[16:17] op_sel:[0,1,1] op_sel_hi:[1,1,1]
    v_rcp_f32 v161, v161
    v_pk_mul_f32 v[164:165], v[164:165], v[22:23] op_sel_hi:[1,0]
    v_rcp_f32 v162, v162
    v_pk_mul_f32 v[192:193], v[192:193], v[160:161]
    v_rcp_f32 v163, v163
    v_cvt_pk_bf16_f32 v160, v192, v193
    v_exp_f32 v164, v164
    v_pk_mul_f32 v[194:195], v[194:195], v[162:163]
    v_exp_f32 v165, v165
    s_waitcnt lgkmcnt(1)
    v_pk_fma_f32 v[176:177], v[4:5], v[16:17], v[176:177] op_sel_hi:[1,0,1]
    v_pk_fma_f32 v[178:179], v[6:7], v[16:17], v[178:179] op_sel_hi:[1,0,1]
    s_waitcnt lgkmcnt(0)
    v_pk_fma_f32 v[208:209], v[12:13], v[16:17], v[208:209] op_sel_hi:[1,0,1]
    v_pk_fma_f32 v[210:211], v[14:15], v[16:17], v[210:211] op_sel_hi:[1,0,1]
    v_pk_fma_f32 v[180:181], v[4:5], v[20:21], v[180:181] op_sel_hi:[1,0,1]
    v_pk_fma_f32 v[212:213], v[12:13], v[20:21], v[212:213] op_sel_hi:[1,0,1]
    v_pk_fma_f32 v[182:183], v[6:7], v[20:21], v[182:183] op_sel_hi:[1,0,1]
    v_pk_fma_f32 v[214:215], v[14:15], v[20:21], v[214:215] op_sel_hi:[1,0,1]
    v_pk_fma_f32 v[184:185], v[4:5], v[24:25], v[184:185] op_sel_hi:[1,0,1]
    v_pk_fma_f32 v[216:217], v[12:13], v[24:25], v[216:217] op_sel_hi:[1,0,1]
    v_pk_fma_f32 v[186:187], v[6:7], v[24:25], v[186:187] op_sel_hi:[1,0,1]
    v_pk_fma_f32 v[218:219], v[14:15], v[24:25], v[218:219] op_sel_hi:[1,0,1]
    v_pk_fma_f32 v[188:189], v[4:5], v[28:29], v[188:189] op_sel_hi:[1,0,1]
    v_pk_fma_f32 v[220:221], v[12:13], v[28:29], v[220:221] op_sel_hi:[1,0,1]
    v_pk_fma_f32 v[190:191], v[6:7], v[28:29], v[190:191] op_sel_hi:[1,0,1]
    v_pk_fma_f32 v[222:223], v[14:15], v[28:29], v[222:223] op_sel_hi:[1,0,1]
    v_pk_mul_f32 v[208:209], v[208:209], v[176:177]
    v_pk_mul_f32 v[176:177], v[176:177], v[18:19] op_sel_hi:[1,0]
    v_exp_f32 v176, v176
    v_pk_mul_f32 v[210:211], v[210:211], v[178:179]
    v_exp_f32 v177, v177
    v_pk_mul_f32 v[178:179], v[178:179], v[18:19] op_sel_hi:[1,0]
    v_exp_f32 v178, v178
    v_pk_fma_f32 v[176:177], v[176:177], v[16:17], v[16:17] op_sel:[0,1,1] op_sel_hi:[1,1,1]
    v_exp_f32 v179, v179
    v_cvt_pk_bf16_f32 v161, v194, v195
    v_rcp_f32 v176, v176
    v_pk_fma_f32 v[178:179], v[178:179], v[16:17], v[16:17] op_sel:[0,1,1] op_sel_hi:[1,1,1]
    v_rcp_f32 v177, v177
    v_pk_mul_f32 v[198:199], v[198:199], v[166:167]
    v_rcp_f32 v178, v178
    v_pk_mul_f32 v[208:209], v[208:209], v[176:177]
    v_rcp_f32 v179, v179
    v_cvt_pk_bf16_f32 v162, v208, v209
    v_pk_mul_f32 v[210:211], v[210:211], v[178:179]
    v_cvt_pk_bf16_f32 v163, v210, v211
    buffer_store_dwordx4 v[160:163], v10, s[16:19], s64 offen offset:0 sc1
    v_pk_mul_f32 v[166:167], v[166:167], v[22:23] op_sel_hi:[1,0]
    v_exp_f32 v166, v166
    v_pk_mul_f32 v[212:213], v[212:213], v[180:181]
    v_exp_f32 v167, v167
    v_pk_mul_f32 v[180:181], v[180:181], v[22:23] op_sel_hi:[1,0]
    v_exp_f32 v180, v180
    v_pk_mul_f32 v[214:215], v[214:215], v[182:183]
    v_exp_f32 v181, v181
    v_pk_mul_f32 v[182:183], v[182:183], v[22:23] op_sel_hi:[1,0]
    v_exp_f32 v182, v182
    v_pk_fma_f32 v[164:165], v[164:165], v[20:21], v[20:21] op_sel:[0,1,1] op_sel_hi:[1,1,1]
    v_exp_f32 v183, v183
    v_pk_fma_f32 v[166:167], v[166:167], v[20:21], v[20:21] op_sel:[0,1,1] op_sel_hi:[1,1,1]
    v_rcp_f32 v164, v164
    v_pk_fma_f32 v[180:181], v[180:181], v[20:21], v[20:21] op_sel:[0,1,1] op_sel_hi:[1,1,1]
    v_rcp_f32 v165, v165
    v_pk_fma_f32 v[182:183], v[182:183], v[20:21], v[20:21] op_sel:[0,1,1] op_sel_hi:[1,1,1]
    v_rcp_f32 v166, v166
    v_pk_mul_f32 v[196:197], v[196:197], v[164:165]
    v_rcp_f32 v167, v167
    v_cvt_pk_bf16_f32 v164, v196, v197
    v_rcp_f32 v180, v180
    v_pk_mul_f32 v[198:199], v[198:199], v[166:167]
    v_rcp_f32 v181, v181
    v_cvt_pk_bf16_f32 v165, v198, v199
    v_rcp_f32 v182, v182
    v_pk_mul_f32 v[212:213], v[212:213], v[180:181]
    v_rcp_f32 v183, v183
    v_cvt_pk_bf16_f32 v166, v212, v213
    v_pk_mul_f32 v[214:215], v[214:215], v[182:183]
    v_cvt_pk_bf16_f32 v167, v214, v215
    buffer_store_dwordx4 v[164:167], v10, s[16:19], s64 offen offset:1024 sc1
    v_pk_mul_f32 v[200:201], v[200:201], v[168:169]
    v_pk_mul_f32 v[168:169], v[168:169], v[26:27] op_sel_hi:[1,0]
    v_exp_f32 v168, v168
    v_pk_mul_f32 v[202:203], v[202:203], v[170:171]
    v_exp_f32 v169, v169
    v_pk_mul_f32 v[170:171], v[170:171], v[26:27] op_sel_hi:[1,0]
    v_exp_f32 v170, v170
    v_pk_mul_f32 v[216:217], v[216:217], v[184:185]
    v_exp_f32 v171, v171
    v_pk_mul_f32 v[184:185], v[184:185], v[26:27] op_sel_hi:[1,0]
    v_exp_f32 v184, v184
    v_pk_mul_f32 v[218:219], v[218:219], v[186:187]
    v_exp_f32 v185, v185
    v_pk_mul_f32 v[186:187], v[186:187], v[26:27] op_sel_hi:[1,0]
    v_exp_f32 v186, v186
    v_pk_fma_f32 v[168:169], v[168:169], v[24:25], v[24:25] op_sel:[0,1,1] op_sel_hi:[1,1,1]
    v_exp_f32 v187, v187
    v_pk_fma_f32 v[170:171], v[170:171], v[24:25], v[24:25] op_sel:[0,1,1] op_sel_hi:[1,1,1]
    v_rcp_f32 v168, v168
    v_pk_fma_f32 v[184:185], v[184:185], v[24:25], v[24:25] op_sel:[0,1,1] op_sel_hi:[1,1,1]
    v_rcp_f32 v169, v169
    v_pk_fma_f32 v[186:187], v[186:187], v[24:25], v[24:25] op_sel:[0,1,1] op_sel_hi:[1,1,1]
    v_rcp_f32 v170, v170
    v_pk_mul_f32 v[200:201], v[200:201], v[168:169]
    v_rcp_f32 v171, v171
    v_cvt_pk_bf16_f32 v168, v200, v201
    v_rcp_f32 v184, v184
    v_pk_mul_f32 v[202:203], v[202:203], v[170:171]
    v_rcp_f32 v185, v185
    v_cvt_pk_bf16_f32 v169, v202, v203
    v_rcp_f32 v186, v186
    v_pk_mul_f32 v[216:217], v[216:217], v[184:185]
    v_rcp_f32 v187, v187
    v_cvt_pk_bf16_f32 v170, v216, v217
    v_pk_mul_f32 v[218:219], v[218:219], v[186:187]
    v_cvt_pk_bf16_f32 v171, v218, v219
    buffer_store_dwordx4 v[168:171], v11, s[16:19], s64 offen offset:0 sc1
    v_pk_mul_f32 v[204:205], v[204:205], v[172:173]
    v_pk_mul_f32 v[172:173], v[172:173], v[30:31] op_sel_hi:[1,0]
    v_exp_f32 v172, v172
    v_pk_mul_f32 v[206:207], v[206:207], v[174:175]
    v_exp_f32 v173, v173
    v_pk_mul_f32 v[174:175], v[174:175], v[30:31] op_sel_hi:[1,0]
    v_exp_f32 v174, v174
    v_pk_mul_f32 v[220:221], v[220:221], v[188:189]
    v_exp_f32 v175, v175
    v_pk_mul_f32 v[188:189], v[188:189], v[30:31] op_sel_hi:[1,0]
    v_exp_f32 v188, v188
    v_pk_mul_f32 v[222:223], v[222:223], v[190:191]
    v_exp_f32 v189, v189
    v_pk_mul_f32 v[190:191], v[190:191], v[30:31] op_sel_hi:[1,0]
    v_exp_f32 v190, v190
    v_pk_fma_f32 v[172:173], v[172:173], v[28:29], v[28:29] op_sel:[0,1,1] op_sel_hi:[1,1,1]
    v_exp_f32 v191, v191
    v_pk_fma_f32 v[174:175], v[174:175], v[28:29], v[28:29] op_sel:[0,1,1] op_sel_hi:[1,1,1]
    v_rcp_f32 v172, v172
    v_pk_fma_f32 v[188:189], v[188:189], v[28:29], v[28:29] op_sel:[0,1,1] op_sel_hi:[1,1,1]
    v_rcp_f32 v173, v173
    v_pk_fma_f32 v[190:191], v[190:191], v[28:29], v[28:29] op_sel:[0,1,1] op_sel_hi:[1,1,1]
    v_rcp_f32 v174, v174
    v_pk_mul_f32 v[204:205], v[204:205], v[172:173]
    v_rcp_f32 v175, v175
    v_cvt_pk_bf16_f32 v172, v204, v205
    v_rcp_f32 v188, v188
    v_pk_mul_f32 v[206:207], v[206:207], v[174:175]
    v_rcp_f32 v189, v189
    v_cvt_pk_bf16_f32 v173, v206, v207
    v_rcp_f32 v190, v190
    v_pk_mul_f32 v[220:221], v[220:221], v[188:189]
    v_rcp_f32 v191, v191
    v_cvt_pk_bf16_f32 v174, v220, v221
    v_pk_mul_f32 v[222:223], v[222:223], v[190:191]
    v_cvt_pk_bf16_f32 v175, v222, v223
    buffer_store_dwordx4 v[172:175], v11, s[16:19], s64 offen offset:1024 sc1
    ds_read_b128 v[4:7], v8 offset:0
    ds_read_b128 v[12:15], v8 offset:512
    s_waitcnt lgkmcnt(1)
    v_pk_fma_f32 v[224:225], v[4:5], v[16:17], v[224:225] op_sel_hi:[1,0,1]
    s_waitcnt lgkmcnt(0)
    v_pk_fma_f32 v[240:241], v[12:13], v[16:17], v[240:241] op_sel_hi:[1,0,1]
    v_pk_fma_f32 v[226:227], v[6:7], v[16:17], v[226:227] op_sel_hi:[1,0,1]
    v_pk_fma_f32 v[242:243], v[14:15], v[16:17], v[242:243] op_sel_hi:[1,0,1]
    v_pk_fma_f32 v[228:229], v[4:5], v[20:21], v[228:229] op_sel_hi:[1,0,1]
    v_pk_fma_f32 v[244:245], v[12:13], v[20:21], v[244:245] op_sel_hi:[1,0,1]
    v_pk_fma_f32 v[230:231], v[6:7], v[20:21], v[230:231] op_sel_hi:[1,0,1]
    ds_read_b128 v[4:7], v8 offset:64
    v_pk_fma_f32 v[246:247], v[14:15], v[20:21], v[246:247] op_sel_hi:[1,0,1]
    ds_read_b128 v[12:15], v8 offset:576
    v_pk_mul_f32 v[240:241], v[240:241], v[224:225]
    v_pk_mul_f32 v[224:225], v[224:225], v[18:19] op_sel_hi:[1,0]
    v_exp_f32 v224, v224
    v_pk_mul_f32 v[242:243], v[242:243], v[226:227]
    v_exp_f32 v225, v225
    v_pk_mul_f32 v[226:227], v[226:227], v[18:19] op_sel_hi:[1,0]
    v_exp_f32 v226, v226
    v_pk_fma_f32 v[224:225], v[224:225], v[16:17], v[16:17] op_sel:[0,1,1] op_sel_hi:[1,1,1]
    v_exp_f32 v227, v227
    v_pk_mul_f32 v[244:245], v[244:245], v[228:229]
    v_rcp_f32 v224, v224
    v_pk_fma_f32 v[226:227], v[226:227], v[16:17], v[16:17] op_sel:[0,1,1] op_sel_hi:[1,1,1]
    v_rcp_f32 v225, v225
    v_pk_mul_f32 v[228:229], v[228:229], v[22:23] op_sel_hi:[1,0]
    v_rcp_f32 v226, v226
    v_pk_mul_f32 v[240:241], v[240:241], v[224:225]
    v_rcp_f32 v227, v227
    v_cvt_pk_bf16_f32 v224, v240, v241
    v_exp_f32 v228, v228
    v_pk_mul_f32 v[242:243], v[242:243], v[226:227]
    v_exp_f32 v229, v229
    s_waitcnt lgkmcnt(1)
    v_pk_fma_f32 v[232:233], v[4:5], v[16:17], v[232:233] op_sel_hi:[1,0,1]
    v_pk_fma_f32 v[234:235], v[6:7], v[16:17], v[234:235] op_sel_hi:[1,0,1]
    s_waitcnt lgkmcnt(0)
    v_pk_fma_f32 v[248:249], v[12:13], v[16:17], v[248:249] op_sel_hi:[1,0,1]
    v_pk_fma_f32 v[250:251], v[14:15], v[16:17], v[250:251] op_sel_hi:[1,0,1]
    v_pk_fma_f32 v[236:237], v[4:5], v[20:21], v[236:237] op_sel_hi:[1,0,1]
    v_pk_fma_f32 v[252:253], v[12:13], v[20:21], v[252:253] op_sel_hi:[1,0,1]
    v_pk_fma_f32 v[238:239], v[6:7], v[20:21], v[238:239] op_sel_hi:[1,0,1]
    v_pk_fma_f32 v[254:255], v[14:15], v[20:21], v[254:255] op_sel_hi:[1,0,1]
    v_pk_mul_f32 v[248:249], v[248:249], v[232:233]
    v_pk_mul_f32 v[232:233], v[232:233], v[18:19] op_sel_hi:[1,0]
    v_exp_f32 v232, v232
    v_pk_mul_f32 v[250:251], v[250:251], v[234:235]
    v_exp_f32 v233, v233
    v_pk_mul_f32 v[234:235], v[234:235], v[18:19] op_sel_hi:[1,0]
    v_exp_f32 v234, v234
    v_pk_fma_f32 v[232:233], v[232:233], v[16:17], v[16:17] op_sel:[0,1,1] op_sel_hi:[1,1,1]
    v_exp_f32 v235, v235
    v_cvt_pk_bf16_f32 v225, v242, v243
    v_rcp_f32 v232, v232
    v_pk_fma_f32 v[234:235], v[234:235], v[16:17], v[16:17] op_sel:[0,1,1] op_sel_hi:[1,1,1]
    v_rcp_f32 v233, v233
    v_pk_mul_f32 v[246:247], v[246:247], v[230:231]
    v_rcp_f32 v234, v234
    v_pk_mul_f32 v[248:249], v[248:249], v[232:233]
    v_rcp_f32 v235, v235
    v_cvt_pk_bf16_f32 v226, v248, v249
    v_pk_mul_f32 v[250:251], v[250:251], v[234:235]
    v_cvt_pk_bf16_f32 v227, v250, v251
    buffer_store_dwordx4 v[224:227], v10, s[16:19], s65 offen offset:0 sc1
    v_pk_mul_f32 v[230:231], v[230:231], v[22:23] op_sel_hi:[1,0]
    v_exp_f32 v230, v230
    v_pk_mul_f32 v[252:253], v[252:253], v[236:237]
    v_exp_f32 v231, v231
    v_pk_mul_f32 v[236:237], v[236:237], v[22:23] op_sel_hi:[1,0]
    v_exp_f32 v236, v236
    v_pk_mul_f32 v[254:255], v[254:255], v[238:239]
    v_exp_f32 v237, v237
    v_pk_mul_f32 v[238:239], v[238:239], v[22:23] op_sel_hi:[1,0]
    v_exp_f32 v238, v238
    v_pk_fma_f32 v[228:229], v[228:229], v[20:21], v[20:21] op_sel:[0,1,1] op_sel_hi:[1,1,1]
    v_exp_f32 v239, v239
    v_pk_fma_f32 v[230:231], v[230:231], v[20:21], v[20:21] op_sel:[0,1,1] op_sel_hi:[1,1,1]
    v_rcp_f32 v228, v228
    v_pk_fma_f32 v[236:237], v[236:237], v[20:21], v[20:21] op_sel:[0,1,1] op_sel_hi:[1,1,1]
    v_rcp_f32 v229, v229
    v_pk_fma_f32 v[238:239], v[238:239], v[20:21], v[20:21] op_sel:[0,1,1] op_sel_hi:[1,1,1]
    v_rcp_f32 v230, v230
    v_pk_mul_f32 v[244:245], v[244:245], v[228:229]
    v_rcp_f32 v231, v231
    v_cvt_pk_bf16_f32 v228, v244, v245
    v_rcp_f32 v236, v236
    v_pk_mul_f32 v[246:247], v[246:247], v[230:231]
    v_rcp_f32 v237, v237
    v_cvt_pk_bf16_f32 v229, v246, v247
    v_rcp_f32 v238, v238
    v_pk_mul_f32 v[252:253], v[252:253], v[236:237]
    v_rcp_f32 v239, v239
    v_cvt_pk_bf16_f32 v230, v252, v253
    v_pk_mul_f32 v[254:255], v[254:255], v[238:239]
    v_cvt_pk_bf16_f32 v231, v254, v255
    buffer_store_dwordx4 v[228:231], v10, s[16:19], s65 offen offset:1024 sc1
    s_nop 1
    s_lshl_b32 s62, s6, 13
    s_lshl_b32 s63, s3, 11
    s_add_u32 s62, s62, s63
    v_lshl_add_u32 v4, v1, 4, s62
    v_bfe_u32 v5, v1, 3, 1
    v_lshrrev_b32 v2, 4, v1
    v_lshl_add_u32 v5, v2, 3, v5
    s_lshl_b32 s62, s3, 1
    v_add_u32 v5, s62, v5
    v_mul_u32_u24 v5, 2048, v5
    v_and_b32 v2, 7, v1
    v_lshl_add_u32 v5, v2, 4, v5
    s_lshl_b32 s62, s7, 7
    v_add_u32 v5, s62, v5
    v_add_u32 v6, 64512, v5
    v_bfe_u32 v8, v1, 3, 2
    v_mul_u32_u24 v8, 2080, v8
    v_bfe_u32 v2, v1, 2, 1
    v_lshl_add_u32 v8, v2, 7, v8
    v_bfe_u32 v2, v1, 5, 1
    v_lshl_add_u32 v8, v2, 8, v8
    v_and_b32 v2, 3, v1
    v_lshl_add_u32 v8, v2, 3, v8
    s_mov_b32 s57, 0
    v_add_u32 v7, s57, v8
    s_add_u32 s52, s14, 12582912
    s_add_u32 s53, s52, 0x20000
    s_mov_b32 s54, 2097152
    s_mul_i32 s56, s3, 2080
    v_accvgpr_read_b32 v32, a224
    v_accvgpr_read_b32 v33, a225
    v_accvgpr_read_b32 v34, a226
    v_accvgpr_read_b32 v35, a227
    v_accvgpr_read_b32 v36, a228
    v_accvgpr_read_b32 v37, a229
    v_accvgpr_read_b32 v38, a230
    v_accvgpr_read_b32 v39, a231
    v_accvgpr_read_b32 v40, a232
    v_accvgpr_read_b32 v41, a233
    v_accvgpr_read_b32 v42, a234
    v_accvgpr_read_b32 v43, a235
    v_accvgpr_read_b32 v44, a236
    v_accvgpr_read_b32 v45, a237
    v_accvgpr_read_b32 v46, a238
    v_accvgpr_read_b32 v47, a239
    v_accvgpr_read_b32 v48, a240
    v_accvgpr_read_b32 v49, a241
    v_accvgpr_read_b32 v50, a242
    v_accvgpr_read_b32 v51, a243
    v_accvgpr_read_b32 v52, a244
    v_accvgpr_read_b32 v53, a245
    v_accvgpr_read_b32 v54, a246
    v_accvgpr_read_b32 v55, a247
    v_accvgpr_read_b32 v56, a248
    v_accvgpr_read_b32 v57, a249
    v_accvgpr_read_b32 v58, a250
    v_accvgpr_read_b32 v59, a251
    v_accvgpr_read_b32 v60, a252
    v_accvgpr_read_b32 v61, a253
    v_accvgpr_read_b32 v62, a254
    v_accvgpr_read_b32 v63, a255
    v_bfe_u32 v18, v1, 3, 1
    v_lshrrev_b32 v2, 4, v1
    v_lshl_add_u32 v18, v2, 3, v18
    s_lshl_b32 s62, s3, 1
    v_add_u32 v18, s62, v18
    v_mul_u32_u24 v18, 6144, v18
    v_and_b32 v2, 7, v1
    v_lshl_add_u32 v18, v2, 4, v18
    s_lshl_b32 s62, s9, 7
    v_add_u32 v18, s62, v18
    v_add_u32 v19, 1024, v18
    v_add_u32 v20, 2048, v18
    s_mul_i32 s59, s3, 3104
    s_mov_b32 s58, 0
    s_cmp_eq_u32 s14, 0
    s_cselect_b32 s22, s22, 0
    s_lshr_b32 s62, s6, 1
    s_lshl_b32 s62, s62, 8
    s_and_b32 s63, s6, 1
    s_add_u32 s62, s62, s63
    s_lshl_b32 s63, s3, 6
    s_add_u32 s62, s62, s63
    s_lshl_b32 s62, s62, 11
    s_lshl_b32 s63, s7, 7
    s_add_u32 s62, s62, s63
    v_and_b32 v160, 15, v1
    v_lshlrev_b32 v160, 12, v160
    v_bfe_u32 v2, v1, 4, 1
    v_lshl_add_u32 v160, v2, 5, v160
    v_bfe_u32 v2, v1, 5, 1
    v_lshl_add_u32 v160, v2, 4, v160
    v_add_u32 v160, s62, v160
    v_add_u32 v161, 0x10000, v160
    s_lshl_b32 s62, s10, 1
    s_add_u32 s62, s62, s12
    s_lshl_b32 s62, s62, 7
    s_add_u32 s62, s62, s44
    s_add_u32 s62, s62, 6144
    s_and_b32 s64, s6, 14
    s_lshl_b32 s64, s64, 7
    s_add_u32 s64, s64, s44
    s_add_u32 s64, s64, 6144
    s_add_u32 s65, s64, 128
    v_mov_b32 v252, s62
    v_mov_b32 v253, s64
    v_mov_b32 v254, 16
    v_writelane_b32 v253, s65, 1
    s_waitcnt vmcnt(0) lgkmcnt(0)

    s_barrier
    s_cmp_lg_u32 s3, 0
    s_cbranch_scc1 .Lnosig28
    v_mov_b32 v255, 1
    s_mov_b64 exec, 1
    buffer_atomic_add v255, v252, s[16:19], 0 offen
    s_mov_b64 exec, -1
.Lnosig28:
    ds_read_b64_tr_b16 a[0:1], v7 offset:0
    ds_read_b64_tr_b16 a[2:3], v7 offset:512
    ds_read_b64_tr_b16 a[4:5], v7 offset:32
    ds_read_b64_tr_b16 a[6:7], v7 offset:544
    ds_read_b64_tr_b16 a[8:9], v7 offset:64
    ds_read_b64_tr_b16 a[10:11], v7 offset:576
    ds_read_b64_tr_b16 a[12:13], v7 offset:96
    ds_read_b64_tr_b16 a[14:15], v7 offset:608
    ds_read_b64_tr_b16 a[16:17], v7 offset:1024
    ds_read_b64_tr_b16 a[18:19], v7 offset:1536
    ds_read_b64_tr_b16 a[20:21], v7 offset:1056
    ds_read_b64_tr_b16 a[22:23], v7 offset:1568
    ds_read_b64_tr_b16 a[24:25], v7 offset:1088
    ds_read_b64_tr_b16 a[26:27], v7 offset:1600
    ds_read_b64_tr_b16 a[28:29], v7 offset:1120
    ds_read_b64_tr_b16 a[30:31], v7 offset:1632
    s_waitcnt lgkmcnt(0)
    s_cmp_lg_u32 s3, 1
    s_cbranch_scc1 .Lnopoll31
    s_mov_b64 exec, 3
    s_mov_b32 s15, 0
.Lpoll29:
    buffer_load_dword v255, v253, s[16:19], 0 offen sc1
    s_add_u32 s15, s15, 1
    s_cmp_gt_u32 s15, 100000
    s_cbranch_scc1 .Lgot30
    s_waitcnt vmcnt(0)
    v_cmp_ne_u32 vcc, v255, v254
    s_nop 0
    s_cbranch_vccnz .Lpoll29
.Lgot30:
    s_waitcnt vmcnt(0)
    s_mov_b64 exec, -1
.Lnopoll31:
    s_barrier

    buffer_load_dwordx4 v[64:67], v4, s[16:19], s52 offen offset:0 sc1
    buffer_load_dwordx4 v[68:71], v4, s[16:19], s52 offen offset:1024 sc1
    s_add_u32 s52, s52, 0x40000
    buffer_load_dwordx4 v[72:75], v4, s[16:19], s53 offen offset:0 sc1
    buffer_load_dwordx4 v[76:79], v4, s[16:19], s53 offen offset:1024 sc1
    s_add_u32 s53, s53, 0x40000
    buffer_load_dwordx4 v[80:83], v4, s[16:19], s52 offen offset:0 sc1
    buffer_load_dwordx4 v[84:87], v4, s[16:19], s52 offen offset:1024 sc1
    s_add_u32 s52, s52, 0x40000
    buffer_load_dwordx4 v[88:91], v4, s[16:19], s53 offen offset:0 sc1
    buffer_load_dwordx4 v[92:95], v4, s[16:19], s53 offen offset:1024 sc1
    s_add_u32 s53, s53, 0x40000
    buffer_load_dwordx4 v[96:99], v4, s[16:19], s52 offen offset:0 sc1
    buffer_load_dwordx4 v[100:103], v4, s[16:19], s52 offen offset:1024 sc1
    s_add_u32 s52, s52, 0x40000
    buffer_load_dwordx4 v[104:107], v4, s[16:19], s53 offen offset:0 sc1
    buffer_load_dwordx4 v[108:111], v4, s[16:19], s53 offen offset:1024 sc1
    s_add_u32 s53, s53, 0x40000
    s_mov_b32 s15, 10
.p2align 6
.Lpj32:
    s_waitcnt lgkmcnt(0)
    s_barrier
    s_add_u32 s55, s56, s57
    s_waitcnt vmcnt(11)
    v_mfma_f32_16x16x32_bf16 v[32:35], a[0:3], v[64:67], v[32:35]
    s_add_u32 m0, s55, 0
    ds_read_b64_tr_b16 a[32:33], v7 offset:8320
    ds_read_b64_tr_b16 a[34:35], v7 offset:8832
    s_waitcnt vmcnt(10)
    v_mfma_f32_16x16x32_bf16 v[48:51], a[0:3], v[68:71], v[48:51]
    buffer_load_dwordx4 v5, s[28:31], s54 offen lds
    ds_read_b64_tr_b16 a[36:37], v7 offset:8352
    v_mfma_f32_16x16x32_bf16 v[36:39], a[4:7], v[64:67], v[36:39]
    ds_read_b64_tr_b16 a[38:39], v7 offset:8864
    ds_read_b64_tr_b16 a[40:41], v7 offset:8384
    v_mfma_f32_16x16x32_bf16 v[52:55], a[4:7], v[68:71], v[52:55]
    buffer_load_dwordx4 v[112:115], v4, s[16:19], s52 offen offset:0 sc1
    ds_read_b64_tr_b16 a[42:43], v7 offset:8896
    v_mfma_f32_16x16x32_bf16 v[40:43], a[8:11], v[64:67], v[40:43]
    ds_read_b64_tr_b16 a[44:45], v7 offset:8416
    ds_read_b64_tr_b16 a[46:47], v7 offset:8928
    v_mfma_f32_16x16x32_bf16 v[56:59], a[8:11], v[68:71], v[56:59]
    ds_read_b64_tr_b16 a[48:49], v7 offset:9344
    ds_read_b64_tr_b16 a[50:51], v7 offset:9856
    v_mfma_f32_16x16x32_bf16 v[44:47], a[12:15], v[64:67], v[44:47]
    buffer_load_dwordx4 v[116:119], v4, s[16:19], s52 offen offset:1024 sc1
    ds_read_b64_tr_b16 a[52:53], v7 offset:9376
    v_mfma_f32_16x16x32_bf16 v[60:63], a[12:15], v[68:71], v[60:63]
    s_add_u32 s52, s52, 0x40000
    ds_read_b64_tr_b16 a[54:55], v7 offset:9888
    s_waitcnt vmcnt(12)
    v_mfma_f32_16x16x32_bf16 v[32:35], a[16:19], v[72:75], v[32:35]
    buffer_load_dwordx4 v6, s[28:31], s54 offen offset:1024 lds
    ds_read_b64_tr_b16 a[56:57], v7 offset:9408
    s_waitcnt vmcnt(12)
    v_mfma_f32_16x16x32_bf16 v[48:51], a[16:19], v[76:79], v[48:51]
    s_add_u32 s54, s54, 0x20000
    ds_read_b64_tr_b16 a[58:59], v7 offset:9920
    v_mfma_f32_16x16x32_bf16 v[36:39], a[20:23], v[72:75], v[36:39]
    ds_read_b64_tr_b16 a[60:61], v7 offset:9440
    ds_read_b64_tr_b16 a[62:63], v7 offset:9952
    v_mfma_f32_16x16x32_bf16 v[52:55], a[20:23], v[76:79], v[52:55]
    buffer_load_dwordx4 v[120:123], v4, s[16:19], s53 offen offset:0 sc1
    v_mfma_f32_16x16x32_bf16 v[40:43], a[24:27], v[72:75], v[40:43]
    v_mfma_f32_16x16x32_bf16 v[56:59], a[24:27], v[76:79], v[56:59]
    buffer_load_dwordx4 v[124:127], v4, s[16:19], s53 offen offset:1024 sc1
    v_mfma_f32_16x16x32_bf16 v[44:47], a[28:31], v[72:75], v[44:47]
    s_add_u32 s53, s53, 0x40000
    v_mfma_f32_16x16x32_bf16 v[60:63], a[28:31], v[76:79], v[60:63]
    s_waitcnt lgkmcnt(0)
    s_barrier
    s_waitcnt vmcnt(13)
    v_mfma_f32_16x16x32_bf16 v[32:35], a[32:35], v[80:83], v[32:35]
    s_add_u32 m0, s55, 8320
    ds_read_b64_tr_b16 a[0:1], v7 offset:16640
    ds_read_b64_tr_b16 a[2:3], v7 offset:17152
    s_waitcnt vmcnt(12)
    v_mfma_f32_16x16x32_bf16 v[48:51], a[32:35], v[84:87], v[48:51]
    buffer_load_dwordx4 v5, s[28:31], s54 offen lds
    ds_read_b64_tr_b16 a[4:5], v7 offset:16672
    v_mfma_f32_16x16x32_bf16 v[36:39], a[36:39], v[80:83], v[36:39]
    ds_read_b64_tr_b16 a[6:7], v7 offset:17184
    ds_read_b64_tr_b16 a[8:9], v7 offset:16704
    v_mfma_f32_16x16x32_bf16 v[52:55], a[36:39], v[84:87], v[52:55]
    buffer_load_dwordx4 v[64:67], v4, s[16:19], s52 offen offset:0 sc1
    ds_read_b64_tr_b16 a[10:11], v7 offset:17216
    v_mfma_f32_16x16x32_bf16 v[40:43], a[40:43], v[80:83], v[40:43]
    ds_read_b64_tr_b16 a[12:13], v7 offset:16736
    ds_read_b64_tr_b16 a[14:15], v7 offset:17248
    v_mfma_f32_16x16x32_bf16 v[56:59], a[40:43], v[84:87], v[56:59]
    ds_read_b64_tr_b16 a[16:17], v7 offset:17664
    ds_read_b64_tr_b16 a[18:19], v7 offset:18176
    v_mfma_f32_16x16x32_bf16 v[44:47], a[44:47], v[80:83], v[44:47]
    buffer_load_dwordx4 v[68:71], v4, s[16:19], s52 offen offset:1024 sc1
    ds_read_b64_tr_b16 a[20:21], v7 offset:17696
    v_mfma_f32_16x16x32_bf16 v[60:63], a[44:47], v[84:87], v[60:63]
    s_add_u32 s52, s52, 0x40000
    ds_read_b64_tr_b16 a[22:23], v7 offset:18208
    s_waitcnt vmcnt(14)
    v_mfma_f32_16x16x32_bf16 v[32:35], a[48:51], v[88:91], v[32:35]
    buffer_load_dwordx4 v6, s[28:31], s54 offen offset:1024 lds
    ds_read_b64_tr_b16 a[24:25], v7 offset:17728
    s_waitcnt vmcnt(14)
    v_mfma_f32_16x16x32_bf16 v[48:51], a[48:51], v[92:95], v[48:51]
    s_add_u32 s54, s54, 0x20000
    ds_read_b64_tr_b16 a[26:27], v7 offset:18240
    v_mfma_f32_16x16x32_bf16 v[36:39], a[52:55], v[88:91], v[36:39]
    ds_read_b64_tr_b16 a[28:29], v7 offset:17760
    ds_read_b64_tr_b16 a[30:31], v7 offset:18272
    v_mfma_f32_16x16x32_bf16 v[52:55], a[52:55], v[92:95], v[52:55]
    buffer_load_dwordx4 v[72:75], v4, s[16:19], s53 offen offset:0 sc1
    v_mfma_f32_16x16x32_bf16 v[40:43], a[56:59], v[88:91], v[40:43]
    v_mfma_f32_16x16x32_bf16 v[56:59], a[56:59], v[92:95], v[56:59]
    buffer_load_dwordx4 v[76:79], v4, s[16:19], s53 offen offset:1024 sc1
    v_mfma_f32_16x16x32_bf16 v[44:47], a[60:63], v[88:91], v[44:47]
    s_add_u32 s53, s53, 0x40000
    v_mfma_f32_16x16x32_bf16 v[60:63], a[60:63], v[92:95], v[60:63]
    s_waitcnt lgkmcnt(0)
    s_barrier
    s_waitcnt vmcnt(15)
    v_mfma_f32_16x16x32_bf16 v[32:35], a[0:3], v[96:99], v[32:35]
    s_add_u32 m0, s55, 16640
    ds_read_b64_tr_b16 a[32:33], v7 offset:24960
    ds_read_b64_tr_b16 a[34:35], v7 offset:25472
    s_waitcnt vmcnt(14)
    v_mfma_f32_16x16x32_bf16 v[48:51], a[0:3], v[100:103], v[48:51]
    buffer_load_dwordx4 v5, s[28:31], s54 offen lds
    ds_read_b64_tr_b16 a[36:37], v7 offset:24992
    v_mfma_f32_16x16x32_bf16 v[36:39], a[4:7], v[96:99], v[36:39]
    ds_read_b64_tr_b16 a[38:39], v7 offset:25504
    ds_read_b64_tr_b16 a[40:41], v7 offset:25024
    v_mfma_f32_16x16x32_bf16 v[52:55], a[4:7], v[100:103], v[52:55]
    buffer_load_dwordx4 v[80:83], v4, s[16:19], s52 offen offset:0 sc1
    ds_read_b64_tr_b16 a[42:43], v7 offset:25536
    v_mfma_f32_16x16x32_bf16 v[40:43], a[8:11], v[96:99], v[40:43]
    ds_read_b64_tr_b16 a[44:45], v7 offset:25056
    ds_read_b64_tr_b16 a[46:47], v7 offset:25568
    v_mfma_f32_16x16x32_bf16 v[56:59], a[8:11], v[100:103], v[56:59]
    ds_read_b64_tr_b16 a[48:49], v7 offset:25984
    ds_read_b64_tr_b16 a[50:51], v7 offset:26496
    v_mfma_f32_16x16x32_bf16 v[44:47], a[12:15], v[96:99], v[44:47]
    buffer_load_dwordx4 v[84:87], v4, s[16:19], s52 offen offset:1024 sc1
    ds_read_b64_tr_b16 a[52:53], v7 offset:26016
    v_mfma_f32_16x16x32_bf16 v[60:63], a[12:15], v[100:103], v[60:63]
    s_add_u32 s52, s52, 0x40000
    ds_read_b64_tr_b16 a[54:55], v7 offset:26528
    s_waitcnt vmcnt(16)
    v_mfma_f32_16x16x32_bf16 v[32:35], a[16:19], v[104:107], v[32:35]
    buffer_load_dwordx4 v6, s[28:31], s54 offen offset:1024 lds
    ds_read_b64_tr_b16 a[56:57], v7 offset:26048
    s_waitcnt vmcnt(16)
    v_mfma_f32_16x16x32_bf16 v[48:51], a[16:19], v[108:111], v[48:51]
    s_add_u32 s54, s54, 0x20000
    ds_read_b64_tr_b16 a[58:59], v7 offset:26560
    v_mfma_f32_16x16x32_bf16 v[36:39], a[20:23], v[104:107], v[36:39]
    ds_read_b64_tr_b16 a[60:61], v7 offset:26080
    ds_read_b64_tr_b16 a[62:63], v7 offset:26592
    v_mfma_f32_16x16x32_bf16 v[52:55], a[20:23], v[108:111], v[52:55]
    buffer_load_dwordx4 v[88:91], v4, s[16:19], s53 offen offset:0 sc1
    v_mfma_f32_16x16x32_bf16 v[40:43], a[24:27], v[104:107], v[40:43]
    v_mfma_f32_16x16x32_bf16 v[56:59], a[24:27], v[108:111], v[56:59]
    buffer_load_dwordx4 v[92:95], v4, s[16:19], s53 offen offset:1024 sc1
    v_mfma_f32_16x16x32_bf16 v[44:47], a[28:31], v[104:107], v[44:47]
    s_add_u32 s53, s53, 0x40000
    v_mfma_f32_16x16x32_bf16 v[60:63], a[28:31], v[108:111], v[60:63]
    s_waitcnt lgkmcnt(0)
    s_barrier
    s_add_u32 s57, s57, 33280
    s_cmp_eq_u32 s57, 133120
    s_cselect_b32 s57, 0, s57
    v_add_u32 v7, s57, v8
    s_waitcnt vmcnt(16)
    v_mfma_f32_16x16x32_bf16 v[32:35], a[32:35], v[112:115], v[32:35]
    s_add_u32 m0, s55, 24960
    ds_read_b64_tr_b16 a[0:1], v7 offset:0
    ds_read_b64_tr_b16 a[2:3], v7 offset:512
    s_waitcnt vmcnt(15)
    v_mfma_f32_16x16x32_bf16 v[48:51], a[32:35], v[116:119], v[48:51]
    buffer_load_dwordx4 v5, s[28:31], s54 offen lds
    ds_read_b64_tr_b16 a[4:5], v7 offset:32
    v_mfma_f32_16x16x32_bf16 v[36:39], a[36:39], v[112:115], v[36:39]
    ds_read_b64_tr_b16 a[6:7], v7 offset:544
    ds_read_b64_tr_b16 a[8:9], v7 offset:64
    v_mfma_f32_16x16x32_bf16 v[52:55], a[36:39], v[116:119], v[52:55]
    buffer_load_dwordx4 v[96:99], v4, s[16:19], s52 offen offset:0 sc1
    ds_read_b64_tr_b16 a[10:11], v7 offset:576
    v_mfma_f32_16x16x32_bf16 v[40:43], a[40:43], v[112:115], v[40:43]
    ds_read_b64_tr_b16 a[12:13], v7 offset:96
    ds_read_b64_tr_b16 a[14:15], v7 offset:608
    v_mfma_f32_16x16x32_bf16 v[56:59], a[40:43], v[116:119], v[56:59]
    ds_read_b64_tr_b16 a[16:17], v7 offset:1024
    ds_read_b64_tr_b16 a[18:19], v7 offset:1536
    v_mfma_f32_16x16x32_bf16 v[44:47], a[44:47], v[112:115], v[44:47]
    buffer_load_dwordx4 v[100:103], v4, s[16:19], s52 offen offset:1024 sc1
    ds_read_b64_tr_b16 a[20:21], v7 offset:1056
    v_mfma_f32_16x16x32_bf16 v[60:63], a[44:47], v[116:119], v[60:63]
    s_add_u32 s52, s52, 0x40000
    ds_read_b64_tr_b16 a[22:23], v7 offset:1568
    s_waitcnt vmcnt(16)
    v_mfma_f32_16x16x32_bf16 v[32:35], a[48:51], v[120:123], v[32:35]
    buffer_load_dwordx4 v6, s[28:31], s54 offen offset:1024 lds
    ds_read_b64_tr_b16 a[24:25], v7 offset:1088
    s_waitcnt vmcnt(16)
    v_mfma_f32_16x16x32_bf16 v[48:51], a[48:51], v[124:127], v[48:51]
    s_add_u32 s54, s54, 0x20000
    ds_read_b64_tr_b16 a[26:27], v7 offset:1600
    v_mfma_f32_16x16x32_bf16 v[36:39], a[52:55], v[120:123], v[36:39]
    ds_read_b64_tr_b16 a[28:29], v7 offset:1120
    ds_read_b64_tr_b16 a[30:31], v7 offset:1632
    v_mfma_f32_16x16x32_bf16 v[52:55], a[52:55], v[124:127], v[52:55]
    buffer_load_dwordx4 v[104:107], v4, s[16:19], s53 offen offset:0 sc1
    v_mfma_f32_16x16x32_bf16 v[40:43], a[56:59], v[120:123], v[40:43]
    v_mfma_f32_16x16x32_bf16 v[56:59], a[56:59], v[124:127], v[56:59]
    buffer_load_dwordx4 v[108:111], v4, s[16:19], s53 offen offset:1024 sc1
    v_mfma_f32_16x16x32_bf16 v[44:47], a[60:63], v[120:123], v[44:47]
    s_add_u32 s53, s53, 0x40000
    v_mfma_f32_16x16x32_bf16 v[60:63], a[60:63], v[124:127], v[60:63]
    s_sub_u32 s15, s15, 1
    s_cmp_lg_u32 s15, 0
    s_cbranch_scc1 .Lpj32
    s_mov_b32 s15, 3
.p2align 6
.Lpj33:
    s_waitcnt lgkmcnt(0)
    s_barrier
    s_waitcnt vmcnt(11)
    v_mfma_f32_16x16x32_bf16 v[32:35], a[0:3], v[64:67], v[32:35]
    ds_read_b64_tr_b16 a[32:33], v7 offset:8320
    ds_read_b64_tr_b16 a[34:35], v7 offset:8832
    s_waitcnt vmcnt(10)
    v_mfma_f32_16x16x32_bf16 v[48:51], a[0:3], v[68:71], v[48:51]
    buffer_load_dwordx4 v[112:115], v4, s[16:19], s52 offen offset:0 sc1
    ds_read_b64_tr_b16 a[36:37], v7 offset:8352
    v_mfma_f32_16x16x32_bf16 v[36:39], a[4:7], v[64:67], v[36:39]
    ds_read_b64_tr_b16 a[38:39], v7 offset:8864
    ds_read_b64_tr_b16 a[40:41], v7 offset:8384
    v_mfma_f32_16x16x32_bf16 v[52:55], a[4:7], v[68:71], v[52:55]
    ds_read_b64_tr_b16 a[42:43], v7 offset:8896
    ds_read_b64_tr_b16 a[44:45], v7 offset:8416
    v_mfma_f32_16x16x32_bf16 v[40:43], a[8:11], v[64:67], v[40:43]
    buffer_load_dwordx4 v[116:119], v4, s[16:19], s52 offen offset:1024 sc1
    v_mfma_f32_16x16x32_bf16 v[56:59], a[8:11], v[68:71], v[56:59]
    s_add_u32 s52, s52, 0x40000
    ds_read_b64_tr_b16 a[46:47], v7 offset:8928
    v_mfma_f32_16x16x32_bf16 v[44:47], a[12:15], v[64:67], v[44:47]
    ds_read_b64_tr_b16 a[48:49], v7 offset:9344
    ds_read_b64_tr_b16 a[50:51], v7 offset:9856
    v_mfma_f32_16x16x32_bf16 v[60:63], a[12:15], v[68:71], v[60:63]
    ds_read_b64_tr_b16 a[52:53], v7 offset:9376
    ds_read_b64_tr_b16 a[54:55], v7 offset:9888
    s_waitcnt vmcnt(11)
    v_mfma_f32_16x16x32_bf16 v[32:35], a[16:19], v[72:75], v[32:35]
    buffer_load_dwordx4 v[120:123], v4, s[16:19], s53 offen offset:0 sc1
    ds_read_b64_tr_b16 a[56:57], v7 offset:9408
    s_waitcnt vmcnt(11)
    v_mfma_f32_16x16x32_bf16 v[48:51], a[16:19], v[76:79], v[48:51]
    ds_read_b64_tr_b16 a[58:59], v7 offset:9920
    ds_read_b64_tr_b16 a[60:61], v7 offset:9440
    v_mfma_f32_16x16x32_bf16 v[36:39], a[20:23], v[72:75], v[36:39]
    ds_read_b64_tr_b16 a[62:63], v7 offset:9952
    v_mfma_f32_16x16x32_bf16 v[52:55], a[20:23], v[76:79], v[52:55]
    v_mfma_f32_16x16x32_bf16 v[40:43], a[24:27], v[72:75], v[40:43]
    buffer_load_dwordx4 v[124:127], v4, s[16:19], s53 offen offset:1024 sc1
    v_mfma_f32_16x16x32_bf16 v[56:59], a[24:27], v[76:79], v[56:59]
    s_add_u32 s53, s53, 0x40000
    v_mfma_f32_16x16x32_bf16 v[44:47], a[28:31], v[72:75], v[44:47]
    v_mfma_f32_16x16x32_bf16 v[60:63], a[28:31], v[76:79], v[60:63]
    s_waitcnt lgkmcnt(0)
    s_waitcnt vmcnt(11)
    v_mfma_f32_16x16x32_bf16 v[32:35], a[32:35], v[80:83], v[32:35]
    ds_read_b64_tr_b16 a[0:1], v7 offset:16640
    ds_read_b64_tr_b16 a[2:3], v7 offset:17152
    s_waitcnt vmcnt(10)
    v_mfma_f32_16x16x32_bf16 v[48:51], a[32:35], v[84:87], v[48:51]
    buffer_load_dwordx4 v[64:67], v4, s[16:19], s52 offen offset:0 sc1
    ds_read_b64_tr_b16 a[4:5], v7 offset:16672
    v_mfma_f32_16x16x32_bf16 v[36:39], a[36:39], v[80:83], v[36:39]
    ds_read_b64_tr_b16 a[6:7], v7 offset:17184
    ds_read_b64_tr_b16 a[8:9], v7 offset:16704
    v_mfma_f32_16x16x32_bf16 v[52:55], a[36:39], v[84:87], v[52:55]
    ds_read_b64_tr_b16 a[10:11], v7 offset:17216
    ds_read_b64_tr_b16 a[12:13], v7 offset:16736
    v_mfma_f32_16x16x32_bf16 v[40:43], a[40:43], v[80:83], v[40:43]
    buffer_load_dwordx4 v[68:71], v4, s[16:19], s52 offen offset:1024 sc1
    v_mfma_f32_16x16x32_bf16 v[56:59], a[40:43], v[84:87], v[56:59]
    s_add_u32 s52, s52, 0x40000
    ds_read_b64_tr_b16 a[14:15], v7 offset:17248
    v_mfma_f32_16x16x32_bf16 v[44:47], a[44:47], v[80:83], v[44:47]
    ds_read_b64_tr_b16 a[16:17], v7 offset:17664
    ds_read_b64_tr_b16 a[18:19], v7 offset:18176
    v_mfma_f32_16x16x32_bf16 v[60:63], a[44:47], v[84:87], v[60:63]
    ds_read_b64_tr_b16 a[20:21], v7 offset:17696
    ds_read_b64_tr_b16 a[22:23], v7 offset:18208
    s_waitcnt vmcnt(11)
    v_mfma_f32_16x16x32_bf16 v[32:35], a[48:51], v[88:91], v[32:35]
    buffer_load_dwordx4 v[72:75], v4, s[16:19], s53 offen offset:0 sc1
    ds_read_b64_tr_b16 a[24:25], v7 offset:17728
    s_waitcnt vmcnt(11)
    v_mfma_f32_16x16x32_bf16 v[48:51], a[48:51], v[92:95], v[48:51]
    ds_read_b64_tr_b16 a[26:27], v7 offset:18240
    ds_read_b64_tr_b16 a[28:29], v7 offset:17760
    v_mfma_f32_16x16x32_bf16 v[36:39], a[52:55], v[88:91], v[36:39]
    ds_read_b64_tr_b16 a[30:31], v7 offset:18272
    v_mfma_f32_16x16x32_bf16 v[52:55], a[52:55], v[92:95], v[52:55]
    v_mfma_f32_16x16x32_bf16 v[40:43], a[56:59], v[88:91], v[40:43]
    buffer_load_dwordx4 v[76:79], v4, s[16:19], s53 offen offset:1024 sc1
    v_mfma_f32_16x16x32_bf16 v[56:59], a[56:59], v[92:95], v[56:59]
    s_add_u32 s53, s53, 0x40000
    v_mfma_f32_16x16x32_bf16 v[44:47], a[60:63], v[88:91], v[44:47]
    v_mfma_f32_16x16x32_bf16 v[60:63], a[60:63], v[92:95], v[60:63]
    s_waitcnt lgkmcnt(0)
    s_waitcnt vmcnt(11)
    v_mfma_f32_16x16x32_bf16 v[32:35], a[0:3], v[96:99], v[32:35]
    ds_read_b64_tr_b16 a[32:33], v7 offset:24960
    ds_read_b64_tr_b16 a[34:35], v7 offset:25472
    s_waitcnt vmcnt(10)
    v_mfma_f32_16x16x32_bf16 v[48:51], a[0:3], v[100:103], v[48:51]
    buffer_load_dwordx4 v[80:83], v4, s[16:19], s52 offen offset:0 sc1
    ds_read_b64_tr_b16 a[36:37], v7 offset:24992
    v_mfma_f32_16x16x32_bf16 v[36:39], a[4:7], v[96:99], v[36:39]
    ds_read_b64_tr_b16 a[38:39], v7 offset:25504
    ds_read_b64_tr_b16 a[40:41], v7 offset:25024
    v_mfma_f32_16x16x32_bf16 v[52:55], a[4:7], v[100:103], v[52:55]
    ds_read_b64_tr_b16 a[42:43], v7 offset:25536
    ds_read_b64_tr_b16 a[44:45], v7 offset:25056
    v_mfma_f32_16x16x32_bf16 v[40:43], a[8:11], v[96:99], v[40:43]
    buffer_load_dwordx4 v[84:87], v4, s[16:19], s52 offen offset:1024 sc1
    v_mfma_f32_16x16x32_bf16 v[56:59], a[8:11], v[100:103], v[56:59]
    s_add_u32 s52, s52, 0x40000
    ds_read_b64_tr_b16 a[46:47], v7 offset:25568
    v_mfma_f32_16x16x32_bf16 v[44:47], a[12:15], v[96:99], v[44:47]
    ds_read_b64_tr_b16 a[48:49], v7 offset:25984
    ds_read_b64_tr_b16 a[50:51], v7 offset:26496
    v_mfma_f32_16x16x32_bf16 v[60:63], a[12:15], v[100:103], v[60:63]
    ds_read_b64_tr_b16 a[52:53], v7 offset:26016
    ds_read_b64_tr_b16 a[54:55], v7 offset:26528
    s_waitcnt vmcnt(11)
    v_mfma_f32_16x16x32_bf16 v[32:35], a[16:19], v[104:107], v[32:35]
    buffer_load_dwordx4 v[88:91], v4, s[16:19], s53 offen offset:0 sc1
    ds_read_b64_tr_b16 a[56:57], v7 offset:26048
    s_waitcnt vmcnt(11)
    v_mfma_f32_16x16x32_bf16 v[48:51], a[16:19], v[108:111], v[48:51]
    ds_read_b64_tr_b16 a[58:59], v7 offset:26560
    ds_read_b64_tr_b16 a[60:61], v7 offset:26080
    v_mfma_f32_16x16x32_bf16 v[36:39], a[20:23], v[104:107], v[36:39]
    ds_read_b64_tr_b16 a[62:63], v7 offset:26592
    v_mfma_f32_16x16x32_bf16 v[52:55], a[20:23], v[108:111], v[52:55]
    v_mfma_f32_16x16x32_bf16 v[40:43], a[24:27], v[104:107], v[40:43]
    buffer_load_dwordx4 v[92:95], v4, s[16:19], s53 offen offset:1024 sc1
    v_mfma_f32_16x16x32_bf16 v[56:59], a[24:27], v[108:111], v[56:59]
    s_add_u32 s53, s53, 0x40000
    v_mfma_f32_16x16x32_bf16 v[44:47], a[28:31], v[104:107], v[44:47]
    v_mfma_f32_16x16x32_bf16 v[60:63], a[28:31], v[108:111], v[60:63]
    s_waitcnt lgkmcnt(0)
    s_add_u32 s57, s57, 33280
    s_cmp_eq_u32 s57, 133120
    s_cselect_b32 s57, 0, s57
    v_add_u32 v7, s57, v8
    s_waitcnt vmcnt(11)
    v_mfma_f32_16x16x32_bf16 v[32:35], a[32:35], v[112:115], v[32:35]
    ds_read_b64_tr_b16 a[0:1], v7 offset:0
    ds_read_b64_tr_b16 a[2:3], v7 offset:512
    s_waitcnt vmcnt(10)
    v_mfma_f32_16x16x32_bf16 v[48:51], a[32:35], v[116:119], v[48:51]
    buffer_load_dwordx4 v[96:99], v4, s[16:19], s52 offen offset:0 sc1
    ds_read_b64_tr_b16 a[4:5], v7 offset:32
    v_mfma_f32_16x16x32_bf16 v[36:39], a[36:39], v[112:115], v[36:39]
    ds_read_b64_tr_b16 a[6:7], v7 offset:544
    ds_read_b64_tr_b16 a[8:9], v7 offset:64
    v_mfma_f32_16x16x32_bf16 v[52:55], a[36:39], v[116:119], v[52:55]
    ds_read_b64_tr_b16 a[10:11], v7 offset:576
    ds_read_b64_tr_b16 a[12:13], v7 offset:96
    v_mfma_f32_16x16x32_bf16 v[40:43], a[40:43], v[112:115], v[40:43]
    buffer_load_dwordx4 v[100:103], v4, s[16:19], s52 offen offset:1024 sc1
    v_mfma_f32_16x16x32_bf16 v[56:59], a[40:43], v[116:119], v[56:59]
    s_add_u32 s52, s52, 0x40000
    ds_read_b64_tr_b16 a[14:15], v7 offset:608
    v_mfma_f32_16x16x32_bf16 v[44:47], a[44:47], v[112:115], v[44:47]
    ds_read_b64_tr_b16 a[16:17], v7 offset:1024
    ds_read_b64_tr_b16 a[18:19], v7 offset:1536
    v_mfma_f32_16x16x32_bf16 v[60:63], a[44:47], v[116:119], v[60:63]
    ds_read_b64_tr_b16 a[20:21], v7 offset:1056
    ds_read_b64_tr_b16 a[22:23], v7 offset:1568
    s_waitcnt vmcnt(11)
    v_mfma_f32_16x16x32_bf16 v[32:35], a[48:51], v[120:123], v[32:35]
    buffer_load_dwordx4 v[104:107], v4, s[16:19], s53 offen offset:0 sc1
    ds_read_b64_tr_b16 a[24:25], v7 offset:1088
    s_waitcnt vmcnt(11)
    v_mfma_f32_16x16x32_bf16 v[48:51], a[48:51], v[124:127], v[48:51]
    ds_read_b64_tr_b16 a[26:27], v7 offset:1600
    ds_read_b64_tr_b16 a[28:29], v7 offset:1120
    v_mfma_f32_16x16x32_bf16 v[36:39], a[52:55], v[120:123], v[36:39]
    ds_read_b64_tr_b16 a[30:31], v7 offset:1632
    v_mfma_f32_16x16x32_bf16 v[52:55], a[52:55], v[124:127], v[52:55]
    v_mfma_f32_16x16x32_bf16 v[40:43], a[56:59], v[120:123], v[40:43]
    buffer_load_dwordx4 v[108:111], v4, s[16:19], s53 offen offset:1024 sc1
    v_mfma_f32_16x16x32_bf16 v[56:59], a[56:59], v[124:127], v[56:59]
    s_add_u32 s53, s53, 0x40000
    v_mfma_f32_16x16x32_bf16 v[44:47], a[60:63], v[120:123], v[44:47]
    v_mfma_f32_16x16x32_bf16 v[60:63], a[60:63], v[124:127], v[60:63]
    s_sub_u32 s15, s15, 1
    s_cmp_lg_u32 s15, 0
    s_cbranch_scc1 .Lpj33
    s_waitcnt lgkmcnt(0)
    s_barrier
    s_waitcnt vmcnt(11)
    v_mfma_f32_16x16x32_bf16 v[32:35], a[0:3], v[64:67], v[32:35]
    ds_read_b64_tr_b16 a[32:33], v7 offset:8320
    ds_read_b64_tr_b16 a[34:35], v7 offset:8832
    ds_read_b64_tr_b16 a[36:37], v7 offset:8352
    s_waitcnt vmcnt(10)
    v_mfma_f32_16x16x32_bf16 v[48:51], a[0:3], v[68:71], v[48:51]
    buffer_load_dwordx4 v[112:115], v4, s[16:19], s52 offen offset:0 sc1
    ds_read_b64_tr_b16 a[38:39], v7 offset:8864
    v_mfma_f32_16x16x32_bf16 v[36:39], a[4:7], v[64:67], v[36:39]
    buffer_load_dwordx4 v[116:119], v4, s[16:19], s52 offen offset:1024 sc1
    s_add_u32 s52, s52, 0x40000
    v_mfma_f32_16x16x32_bf16 v[52:55], a[4:7], v[68:71], v[52:55]
    ds_read_b64_tr_b16 a[40:41], v7 offset:8384
    ds_read_b64_tr_b16 a[42:43], v7 offset:8896
    v_mfma_f32_16x16x32_bf16 v[40:43], a[8:11], v[64:67], v[40:43]
    buffer_load_dwordx4 v[120:123], v4, s[16:19], s53 offen offset:0 sc1
    ds_read_b64_tr_b16 a[44:45], v7 offset:8416
    v_mfma_f32_16x16x32_bf16 v[56:59], a[8:11], v[68:71], v[56:59]
    ds_read_b64_tr_b16 a[46:47], v7 offset:8928
    ds_read_b64_tr_b16 a[48:49], v7 offset:9344
    ds_read_b64_tr_b16 a[50:51], v7 offset:9856
    v_mfma_f32_16x16x32_bf16 v[44:47], a[12:15], v[64:67], v[44:47]
    buffer_load_dwordx4 v[124:127], v4, s[16:19], s53 offen offset:1024 sc1
    s_add_u32 s53, s53, 0x40000
    s_add_u32 m0, s59, 66560
    v_mfma_f32_16x16x32_bf16 v[60:63], a[12:15], v[68:71], v[60:63]
    buffer_load_dwordx4 v18, s[20:23], s58 offen lds
    ds_read_b64_tr_b16 a[52:53], v7 offset:9376
    s_waitcnt vmcnt(14)
    v_mfma_f32_16x16x32_bf16 v[32:35], a[16:19], v[72:75], v[32:35]
    ds_read_b64_tr_b16 a[54:55], v7 offset:9888
    ds_read_b64_tr_b16 a[56:57], v7 offset:9408
    s_waitcnt vmcnt(13)
    v_mfma_f32_16x16x32_bf16 v[48:51], a[16:19], v[76:79], v[48:51]
    buffer_load_dwordx4 v19, s[20:23], s58 offen offset:1024 lds
    ds_read_b64_tr_b16 a[58:59], v7 offset:9920
    v_mfma_f32_16x16x32_bf16 v[36:39], a[20:23], v[72:75], v[36:39]
    ds_read_b64_tr_b16 a[60:61], v7 offset:9440
    ds_read_b64_tr_b16 a[62:63], v7 offset:9952
    v_mfma_f32_16x16x32_bf16 v[52:55], a[20:23], v[76:79], v[52:55]
    buffer_load_dwordx4 v20, s[20:23], s58 offen offset:2048 lds
    s_add_u32 s58, s58, 196608
    s_add_u32 m0, s59, 78976
    v_mfma_f32_16x16x32_bf16 v[40:43], a[24:27], v[72:75], v[40:43]
    buffer_load_dwordx4 v18, s[20:23], s58 offen lds
    v_mfma_f32_16x16x32_bf16 v[56:59], a[24:27], v[76:79], v[56:59]
    v_mfma_f32_16x16x32_bf16 v[44:47], a[28:31], v[72:75], v[44:47]
    buffer_load_dwordx4 v19, s[20:23], s58 offen offset:1024 lds
    v_mfma_f32_16x16x32_bf16 v[60:63], a[28:31], v[76:79], v[60:63]
    s_waitcnt lgkmcnt(0)
    s_waitcnt vmcnt(16)
    v_mfma_f32_16x16x32_bf16 v[32:35], a[32:35], v[80:83], v[32:35]
    ds_read_b64_tr_b16 a[0:1], v7 offset:16640
    ds_read_b64_tr_b16 a[2:3], v7 offset:17152
    ds_read_b64_tr_b16 a[4:5], v7 offset:16672
    s_waitcnt vmcnt(15)
    v_mfma_f32_16x16x32_bf16 v[48:51], a[32:35], v[84:87], v[48:51]
    buffer_load_dwordx4 v20, s[20:23], s58 offen offset:2048 lds
    v_mfma_f32_16x16x32_bf16 v[36:39], a[36:39], v[80:83], v[36:39]
    s_add_u32 s58, s58, 196608
    ds_read_b64_tr_b16 a[6:7], v7 offset:17184
    ds_read_b64_tr_b16 a[8:9], v7 offset:16704
    v_mfma_f32_16x16x32_bf16 v[52:55], a[36:39], v[84:87], v[52:55]
    s_add_u32 m0, s59, 91392
    ds_read_b64_tr_b16 a[10:11], v7 offset:17216
    v_mfma_f32_16x16x32_bf16 v[40:43], a[40:43], v[80:83], v[40:43]
    buffer_load_dwordx4 v18, s[20:23], s58 offen lds
    ds_read_b64_tr_b16 a[12:13], v7 offset:16736
    v_mfma_f32_16x16x32_bf16 v[56:59], a[40:43], v[84:87], v[56:59]
    ds_read_b64_tr_b16 a[14:15], v7 offset:17248
    ds_read_b64_tr_b16 a[16:17], v7 offset:17664
    v_mfma_f32_16x16x32_bf16 v[44:47], a[44:47], v[80:83], v[44:47]
    ds_read_b64_tr_b16 a[18:19], v7 offset:18176
    ds_read_b64_tr_b16 a[20:21], v7 offset:17696
    v_mfma_f32_16x16x32_bf16 v[60:63], a[44:47], v[84:87], v[60:63]
    buffer_load_dwordx4 v19, s[20:23], s58 offen offset:1024 lds
    ds_read_b64_tr_b16 a[22:23], v7 offset:18208
    s_waitcnt vmcnt(17)
    v_mfma_f32_16x16x32_bf16 v[32:35], a[48:51], v[88:91], v[32:35]
    ds_read_b64_tr_b16 a[24:25], v7 offset:17728
    ds_read_b64_tr_b16 a[26:27], v7 offset:18240
    s_waitcnt vmcnt(16)
    v_mfma_f32_16x16x32_bf16 v[48:51], a[48:51], v[92:95], v[48:51]
    ds_read_b64_tr_b16 a[28:29], v7 offset:17760
    ds_read_b64_tr_b16 a[30:31], v7 offset:18272
    v_mfma_f32_16x16x32_bf16 v[36:39], a[52:55], v[88:91], v[36:39]
    buffer_load_dwordx4 v20, s[20:23], s58 offen offset:2048 lds
    v_mfma_f32_16x16x32_bf16 v[52:55], a[52:55], v[92:95], v[52:55]
    s_add_u32 s58, s58, 196608
    v_mfma_f32_16x16x32_bf16 v[40:43], a[56:59], v[88:91], v[40:43]
    s_add_u32 m0, s59, 103808
    v_mfma_f32_16x16x32_bf16 v[56:59], a[56:59], v[92:95], v[56:59]
    buffer_load_dwordx4 v18, s[20:23], s58 offen lds
    v_mfma_f32_16x16x32_bf16 v[44:47], a[60:63], v[88:91], v[44:47]
    v_mfma_f32_16x16x32_bf16 v[60:63], a[60:63], v[92:95], v[60:63]
    s_waitcnt lgkmcnt(0)
    s_waitcnt vmcnt(17)
    v_mfma_f32_16x16x32_bf16 v[32:35], a[0:3], v[96:99], v[32:35]
    ds_read_b64_tr_b16 a[32:33], v7 offset:24960
    ds_read_b64_tr_b16 a[34:35], v7 offset:25472
    ds_read_b64_tr_b16 a[36:37], v7 offset:24992
    s_waitcnt vmcnt(16)
    v_mfma_f32_16x16x32_bf16 v[48:51], a[0:3], v[100:103], v[48:51]
    buffer_load_dwordx4 v19, s[20:23], s58 offen offset:1024 lds
    v_mfma_f32_16x16x32_bf16 v[36:39], a[4:7], v[96:99], v[36:39]
    ds_read_b64_tr_b16 a[38:39], v7 offset:25504
    ds_read_b64_tr_b16 a[40:41], v7 offset:25024
    v_mfma_f32_16x16x32_bf16 v[52:55], a[4:7], v[100:103], v[52:55]
    ds_read_b64_tr_b16 a[42:43], v7 offset:25536
    ds_read_b64_tr_b16 a[44:45], v7 offset:25056
    v_mfma_f32_16x16x32_bf16 v[40:43], a[8:11], v[96:99], v[40:43]
    buffer_load_dwordx4 v20, s[20:23], s58 offen offset:2048 lds
    ds_read_b64_tr_b16 a[46:47], v7 offset:25568
    v_mfma_f32_16x16x32_bf16 v[56:59], a[8:11], v[100:103], v[56:59]
    s_add_u32 s58, s58, 196608
    ds_read_b64_tr_b16 a[48:49], v7 offset:25984
    ds_read_b64_tr_b16 a[50:51], v7 offset:26496
    v_mfma_f32_16x16x32_bf16 v[44:47], a[12:15], v[96:99], v[44:47]
    s_add_u32 m0, s59, 116224
    ds_read_b64_tr_b16 a[52:53], v7 offset:26016
    v_mfma_f32_16x16x32_bf16 v[60:63], a[12:15], v[100:103], v[60:63]
    buffer_load_dwordx4 v18, s[20:23], s58 offen lds
    ds_read_b64_tr_b16 a[54:55], v7 offset:26528
    s_waitcnt vmcnt(18)
    v_mfma_f32_16x16x32_bf16 v[32:35], a[16:19], v[104:107], v[32:35]
    ds_read_b64_tr_b16 a[56:57], v7 offset:26048
    ds_read_b64_tr_b16 a[58:59], v7 offset:26560
    s_waitcnt vmcnt(17)
    v_mfma_f32_16x16x32_bf16 v[48:51], a[16:19], v[108:111], v[48:51]
    ds_read_b64_tr_b16 a[60:61], v7 offset:26080
    ds_read_b64_tr_b16 a[62:63], v7 offset:26592
    v_mfma_f32_16x16x32_bf16 v[36:39], a[20:23], v[104:107], v[36:39]
    buffer_load_dwordx4 v19, s[20:23], s58 offen offset:1024 lds
    v_mfma_f32_16x16x32_bf16 v[52:55], a[20:23], v[108:111], v[52:55]
    v_mfma_f32_16x16x32_bf16 v[40:43], a[24:27], v[104:107], v[40:43]
    v_mfma_f32_16x16x32_bf16 v[56:59], a[24:27], v[108:111], v[56:59]
    buffer_load_dwordx4 v20, s[20:23], s58 offen offset:2048 lds
    v_mfma_f32_16x16x32_bf16 v[44:47], a[28:31], v[104:107], v[44:47]
    s_add_u32 s58, s58, 196608
    v_mfma_f32_16x16x32_bf16 v[60:63], a[28:31], v[108:111], v[60:63]
    s_waitcnt lgkmcnt(0)
    s_waitcnt vmcnt(18)
    v_mfma_f32_16x16x32_bf16 v[32:35], a[32:35], v[112:115], v[32:35]
    s_add_u32 m0, s59, 128640
    s_waitcnt vmcnt(17)
    v_mfma_f32_16x16x32_bf16 v[48:51], a[32:35], v[116:119], v[48:51]
    buffer_load_dwordx4 v18, s[20:23], s58 offen lds
    v_mfma_f32_16x16x32_bf16 v[36:39], a[36:39], v[112:115], v[36:39]
    v_mfma_f32_16x16x32_bf16 v[52:55], a[36:39], v[116:119], v[52:55]
    v_mfma_f32_16x16x32_bf16 v[40:43], a[40:43], v[112:115], v[40:43]
    v_mfma_f32_16x16x32_bf16 v[56:59], a[40:43], v[116:119], v[56:59]
    v_mfma_f32_16x16x32_bf16 v[44:47], a[44:47], v[112:115], v[44:47]
    buffer_load_dwordx4 v19, s[20:23], s58 offen offset:1024 lds
    v_mfma_f32_16x16x32_bf16 v[60:63], a[44:47], v[116:119], v[60:63]
    s_waitcnt vmcnt(18)
    v_mfma_f32_16x16x32_bf16 v[32:35], a[48:51], v[120:123], v[32:35]
    s_waitcnt vmcnt(17)
    v_mfma_f32_16x16x32_bf16 v[48:51], a[48:51], v[124:127], v[48:51]
    v_mfma_f32_16x16x32_bf16 v[36:39], a[52:55], v[120:123], v[36:39]
    v_mfma_f32_16x16x32_bf16 v[52:55], a[52:55], v[124:127], v[52:55]
    buffer_load_dwordx4 v20, s[20:23], s58 offen offset:2048 lds
    v_mfma_f32_16x16x32_bf16 v[40:43], a[56:59], v[120:123], v[40:43]
    s_add_u32 s58, s58, 196608
    v_mfma_f32_16x16x32_bf16 v[56:59], a[56:59], v[124:127], v[56:59]
    v_mfma_f32_16x16x32_bf16 v[44:47], a[60:63], v[120:123], v[44:47]
    v_mfma_f32_16x16x32_bf16 v[60:63], a[60:63], v[124:127], v[60:63]
    s_cmp_lg_u32 s14, 0
    s_nop 7
    s_cbranch_scc1 .Lfinal
    s_lshl_b32 s62, s7, 18
    s_add_u32 s62, s62, s14
    s_add_u32 s62, s62, 33554432
    s_add_u32 s63, s62, 0x20000
    v_cvt_pk_bf16_f32 v128, v32, v33
    v_cvt_pk_bf16_f32 v129, v34, v35
    v_cvt_pk_bf16_f32 v130, v36, v37
    v_cvt_pk_bf16_f32 v131, v38, v39
    buffer_store_dwordx4 v[128:131], v4, s[16:19], s62 offen offset:0 sc1
    v_cvt_pk_bf16_f32 v132, v40, v41
    v_cvt_pk_bf16_f32 v133, v42, v43
    v_cvt_pk_bf16_f32 v134, v44, v45
    v_cvt_pk_bf16_f32 v135, v46, v47
    buffer_store_dwordx4 v[132:135], v4, s[16:19], s63 offen offset:0 sc1
    v_cvt_pk_bf16_f32 v136, v48, v49
    v_cvt_pk_bf16_f32 v137, v50, v51
    v_cvt_pk_bf16_f32 v138, v52, v53
    v_cvt_pk_bf16_f32 v139, v54, v55
    buffer_store_dwordx4 v[136:139], v4, s[16:19], s62 offen offset:1024 sc1
    v_cvt_pk_bf16_f32 v140, v56, v57
    v_cvt_pk_bf16_f32 v141, v58, v59
    v_cvt_pk_bf16_f32 v142, v60, v61
    v_cvt_pk_bf16_f32 v143, v62, v63
    buffer_store_dwordx4 v[140:143], v4, s[16:19], s63 offen offset:1024 sc1
    v_pk_mul_f32 v[146:147], v[32:33], v[32:33]
    v_pk_fma_f32 v[146:147], v[34:35], v[34:35], v[146:147]
    v_pk_add_f32 v[144:145], v[32:33], v[34:35]
    v_pk_fma_f32 v[146:147], v[36:37], v[36:37], v[146:147]
    v_pk_add_f32 v[144:145], v[144:145], v[36:37]
    v_pk_fma_f32 v[146:147], v[38:39], v[38:39], v[146:147]
    v_pk_add_f32 v[144:145], v[144:145], v[38:39]
    v_pk_fma_f32 v[146:147], v[40:41], v[40:41], v[146:147]
    v_pk_add_f32 v[144:145], v[144:145], v[40:41]
    v_pk_fma_f32 v[146:147], v[42:43], v[42:43], v[146:147]
    v_pk_add_f32 v[144:145], v[144:145], v[42:43]
    v_pk_fma_f32 v[146:147], v[44:45], v[44:45], v[146:147]
    v_pk_add_f32 v[144:145], v[144:145], v[44:45]
    v_pk_fma_f32 v[146:147], v[46:47], v[46:47], v[146:147]
    v_pk_add_f32 v[144:145], v[144:145], v[46:47]
    v_add_f32 v144, v144, v145
    v_add_f32 v146, v146, v147
    v_pk_mul_f32 v[150:151], v[48:49], v[48:49]
    v_pk_fma_f32 v[150:151], v[50:51], v[50:51], v[150:151]
    v_pk_add_f32 v[148:149], v[48:49], v[50:51]
    v_pk_fma_f32 v[150:151], v[52:53], v[52:53], v[150:151]
    v_pk_add_f32 v[148:149], v[148:149], v[52:53]
    v_pk_fma_f32 v[150:151], v[54:55], v[54:55], v[150:151]
    v_pk_add_f32 v[148:149], v[148:149], v[54:55]
    v_pk_fma_f32 v[150:151], v[56:57], v[56:57], v[150:151]
    v_pk_add_f32 v[148:149], v[148:149], v[56:57]
    v_pk_fma_f32 v[150:151], v[58:59], v[58:59], v[150:151]
    v_pk_add_f32 v[148:149], v[148:149], v[58:59]
    v_pk_fma_f32 v[150:151], v[60:61], v[60:61], v[150:151]
    v_pk_add_f32 v[148:149], v[148:149], v[60:61]
    v_pk_fma_f32 v[150:151], v[62:63], v[62:63], v[150:151]
    v_pk_add_f32 v[148:149], v[148:149], v[62:63]
    v_add_f32 v148, v148, v149
    v_add_f32 v150, v150, v151
    s_lshl_b32 s64, s7, 14
    v_permlane16_swap_b32 v144, v148
    s_lshl_b32 s65, s6, 10
    v_permlane16_swap_b32 v146, v150
    v_add_f32 v144, v144, v148
    v_add_f32 v146, v146, v150
    s_add_u32 s64, s64, s65
    s_lshl_b32 s65, s3, 8
    v_permlane32_swap_b32 v144, v146
    s_add_u32 s64, s64, s65
    s_add_u32 s64, s64, s14
    s_add_u32 s64, s64, 62914560
    v_and_b32 v152, 31, v1
    v_lshlrev_b32 v152, 3, v152
    v_lshrrev_b32 v153, 5, v1
    v_lshl_add_u32 v152, v153, 2, v152
    v_add_f32 v144, v144, v146
    buffer_store_dword v144, v152, s[16:19], s64 offen sc1
    s_nop 1
    v_accvgpr_write_b32 a224, v32
    v_accvgpr_write_b32 a225, v33
    v_accvgpr_write_b32 a226, v34
    v_accvgpr_write_b32 a227, v35
    v_accvgpr_write_b32 a228, v36
    v_accvgpr_write_b32 a229, v37
    v_accvgpr_write_b32 a230, v38
    v_accvgpr_write_b32 a231, v39
    v_accvgpr_write_b32 a232, v40
    v_accvgpr_write_b32 a233, v41
    v_accvgpr_write_b32 a234, v42
    v_accvgpr_write_b32 a235, v43
    v_accvgpr_write_b32 a236, v44
    v_accvgpr_write_b32 a237, v45
    v_accvgpr_write_b32 a238, v46
    v_accvgpr_write_b32 a239, v47
    v_accvgpr_write_b32 a240, v48
    v_accvgpr_write_b32 a241, v49
    v_accvgpr_write_b32 a242, v50
    v_accvgpr_write_b32 a243, v51
    v_accvgpr_write_b32 a244, v52
    v_accvgpr_write_b32 a245, v53
    v_accvgpr_write_b32 a246, v54
    v_accvgpr_write_b32 a247, v55
    v_accvgpr_write_b32 a248, v56
    v_accvgpr_write_b32 a249, v57
    v_accvgpr_write_b32 a250, v58
    v_accvgpr_write_b32 a251, v59
    v_accvgpr_write_b32 a252, v60
    v_accvgpr_write_b32 a253, v61
    v_accvgpr_write_b32 a254, v62
    v_accvgpr_write_b32 a255, v63
    s_add_u32 s14, s14, 33554432
    s_add_u32 s44, s44, 8192
    s_lshl_b32 s62, s8, 13
    s_lshl_b32 s63, s3, 11
    s_add_u32 s62, s62, s63
    v_lshl_add_u32 v21, v1, 4, s62
    s_lshl_b32 s62, s50, 10
    s_lshl_b32 s63, s3, 8
    s_add_u32 s62, s62, s63
    s_sub_u32 s62, s62, 2048
    v_lshl_add_u32 v22, v1, 2, s62
    s_mul_i32 s62, s48, 4608
    v_lshl_add_u32 v23, v1, 4, s62
    v_lshrrev_b32 v24, 4, v1
    v_mul_u32_u24 v24, 2304, v24
    v_and_b32 v2, 15, v1
    v_lshl_add_u32 v24, v2, 4, v24
    v_bfe_u32 v25, v1, 3, 2
    v_mul_u32_u24 v25, 3104, v25
    v_bfe_u32 v2, v1, 2, 1
    v_lshl_add_u32 v25, v2, 7, v25
    v_bfe_u32 v2, v1, 5, 1
    v_lshl_add_u32 v25, v2, 8, v25
    v_and_b32 v2, 3, v1
    v_lshl_add_u32 v25, v2, 3, v25
    s_lshl_b32 s62, s49, 6
    s_add_u32 s62, s62, 66560
    v_add_u32 v25, s62, v25
    s_lshl_b32 s62, s8, 10
    v_lshl_add_u32 v26, v0, 3, s62
    s_lshl_b32 s62, s50, 7
    v_and_b32 v2, 15, v1
    v_lshl_add_u32 v2, v2, 3, s62
    v_cmp_gt_u32 vcc, 128, v0
    s_nop 1
    v_cndmask_b32 v26, v2, v26, vcc
    s_add_u32 s52, s14, 0
    s_mov_b32 s54, s58
    s_mov_b32 s56, s59
    s_mul_i32 s55, s3, 2304
    s_mul_i32 s59, s3, 2080
    v_bfe_u32 v5, v1, 3, 1
    v_lshrrev_b32 v2, 4, v1
    v_lshl_add_u32 v5, v2, 3, v5
    s_lshl_b32 s62, s3, 1
    v_add_u32 v5, s62, v5
    v_mul_u32_u24 v5, 2048, v5
    v_and_b32 v2, 7, v1
    v_lshl_add_u32 v5, v2, 4, v5
    s_lshl_b32 s62, s7, 7
    v_add_u32 v5, s62, v5
    v_add_u32 v6, 64512, v5
    s_lshl_b32 s62, s6, 7
    s_add_u32 s62, s62, s44
    s_add_u32 s62, s62, 0
    s_lshl_b32 s64, s8, 7
    s_add_u32 s64, s64, s44
    s_add_u32 s64, s64, 0
    s_lshr_b32 s65, s50, 3
    s_lshl_b32 s65, s65, 7
    s_add_u32 s65, s65, s44
    s_add_u32 s65, s65, 0
    v_mov_b32 v252, s62
    v_mov_b32 v253, s64
    v_mov_b32 v254, 16
    v_writelane_b32 v253, s65, 1
    s_waitcnt vmcnt(0) lgkmcnt(0)

    s_barrier
    s_cmp_lg_u32 s3, 0
    s_cbranch_scc1 .Lnosig34
    v_mov_b32 v255, 1
    s_mov_b64 exec, 1
    buffer_atomic_add v255, v252, s[16:19], 0 offen
    s_mov_b64 exec, -1
.Lnosig34:
    ds_read_b64_tr_b16 a[20:21], v25 offset:0
    ds_read_b64_tr_b16 a[22:23], v25 offset:512
    ds_read_b64_tr_b16 a[24:25], v25 offset:32
    ds_read_b64_tr_b16 a[26:27], v25 offset:544
    ds_read_b64_tr_b16 a[28:29], v25 offset:1024
    ds_read_b64_tr_b16 a[30:31], v25 offset:1536
    ds_read_b64_tr_b16 a[32:33], v25 offset:1056
    ds_read_b64_tr_b16 a[34:35], v25 offset:1568
    ds_read_b64_tr_b16 a[36:37], v25 offset:2048
    ds_read_b64_tr_b16 a[38:39], v25 offset:2560
    ds_read_b64_tr_b16 a[40:41], v25 offset:2080
    ds_read_b64_tr_b16 a[42:43], v25 offset:2592
    v_lshrrev_b32 v2, 4, v1
    v_lshlrev_b32 v2, 2, v2
    v_and_b32 v27, 15, v1
    v_sub_u32 v2, v27, v2
    v_mov_b32 v27, 0xf149f2ca
    v_subrev_u32 v54, 0, v2
    v_cmp_gt_u32 vcc, 8, v54
    s_nop 1
    v_cndmask_b32 v50, v27, 0, vcc
    v_cmp_gt_i32 vcc, -8, v54
    s_nop 1
    v_cndmask_b32 v46, v27, 0, vcc
    v_subrev_u32 v54, 1, v2
    v_cmp_gt_u32 vcc, 8, v54
    s_nop 1
    v_cndmask_b32 v51, v27, 0, vcc
    v_cmp_gt_i32 vcc, -8, v54
    s_nop 1
    v_cndmask_b32 v47, v27, 0, vcc
    v_subrev_u32 v54, 2, v2
    v_cmp_gt_u32 vcc, 8, v54
    s_nop 1
    v_cndmask_b32 v52, v27, 0, vcc
    v_cmp_gt_i32 vcc, -8, v54
    s_nop 1
    v_cndmask_b32 v48, v27, 0, vcc
    v_subrev_u32 v54, 3, v2
    v_cmp_gt_u32 vcc, 8, v54
    s_nop 1
    v_cndmask_b32 v53, v27, 0, vcc
    v_cmp_gt_i32 vcc, -8, v54
    s_nop 1
    v_cndmask_b32 v49, v27, 0, vcc
    s_cmp_lt_u32 s8, 2
    s_cselect_b64 vcc, -1, 0
    v_cndmask_b32 v54, v46, v27, vcc
    v_cndmask_b32 v55, v47, v27, vcc
    v_cndmask_b32 v56, v48, v27, vcc
    v_cndmask_b32 v57, v49, v27, vcc
    v_mov_b64 v[60:61], 0
    v_mov_b64 v[62:63], 0
    v_mov_b64 v[64:65], 0
    v_mov_b64 v[66:67], 0
    v_mov_b64 v[68:69], 0
    v_mov_b64 v[70:71], 0
    v_mov_b64 v[72:73], 0
    v_mov_b64 v[74:75], 0
    v_mov_b64 v[76:77], 0
    v_mov_b64 v[78:79], 0
    v_mov_b64 v[80:81], 0
    v_mov_b64 v[82:83], 0
    v_mov_b64 v[84:85], 0
    v_mov_b64 v[86:87], 0
    v_mov_b64 v[88:89], 0
    v_mov_b64 v[90:91], 0
    v_mov_b64 v[92:93], 0
    v_mov_b64 v[94:95], 0
    v_mov_b64 v[96:97], 0
    v_mov_b64 v[98:99], 0
    v_mov_b64 v[100:101], 0
    v_mov_b64 v[102:103], 0
    v_mov_b64 v[104:105], 0
    v_mov_b64 v[106:107], 0
    v_mov_b64 v[108:109], 0
    v_mov_b64 v[110:111], 0
    v_mov_b64 v[112:113], 0
    v_mov_b64 v[114:115], 0
    v_mov_b64 v[116:117], 0
    v_mov_b64 v[118:119], 0
    v_mov_b64 v[120:121], 0
    v_mov_b64 v[122:123], 0
    v_mov_b64 v[124:125], 0
    v_mov_b64 v[126:127], 0
    v_mov_b64 v[128:129], 0
    v_mov_b64 v[130:131], 0
    v_mov_b64 v[132:133], 0
    v_mov_b64 v[134:135], 0
    v_mov_b64 v[136:137], 0
    v_mov_b64 v[138:139], 0
    v_mov_b64 v[140:141], 0
    v_mov_b64 v[142:143], 0
    v_mov_b64 v[144:145], 0
    v_mov_b64 v[146:147], 0
    v_mov_b64 v[148:149], 0
    v_mov_b64 v[150:151], 0
    v_mov_b64 v[152:153], 0
    v_mov_b64 v[154:155], 0
    v_mov_b64 v[156:157], 0
    v_mov_b64 v[158:159], 0
    v_mov_b64 v[160:161], 0
    v_mov_b64 v[162:163], 0
    s_waitcnt lgkmcnt(0)
    s_cmp_lg_u32 s3, 1
    s_cbranch_scc1 .Lnopoll37
    s_mov_b64 exec, 3
    s_mov_b32 s15, 0
.Lpoll35:
    buffer_load_dword v255, v253, s[16:19], 0 offen sc1
    s_add_u32 s15, s15, 1
    s_cmp_gt_u32 s15, 100000
    s_cbranch_scc1 .Lgot36
    s_waitcnt vmcnt(0)
    v_cmp_ne_u32 vcc, v255, v254
    s_nop 0
    s_cbranch_vccnz .Lpoll35
.Lgot36:
    s_waitcnt vmcnt(0)
    s_mov_b64 exec, -1
.Lnopoll37:
    s_barrier

    s_branch .Llayer
.Lfinal:
    v_cvt_pk_bf16_f32 v128, v32, v33
    v_cvt_pk_bf16_f32 v129, v34, v35
    v_cvt_pk_bf16_f32 v130, v36, v37
    v_cvt_pk_bf16_f32 v131, v38, v39
    v_cvt_pk_bf16_f32 v132, v40, v41
    v_permlane16_swap_b32 v128, v130
    v_cvt_pk_bf16_f32 v133, v42, v43
    v_permlane16_swap_b32 v129, v131
    v_cvt_pk_bf16_f32 v134, v44, v45
    buffer_store_dwordx4 v[128:131], v160, s[36:39], 0 offen offset:0
    v_cvt_pk_bf16_f32 v135, v46, v47
    v_permlane16_swap_b32 v132, v134
    v_cvt_pk_bf16_f32 v136, v48, v49
    v_permlane16_swap_b32 v133, v135
    v_cvt_pk_bf16_f32 v137, v50, v51
    buffer_store_dwordx4 v[132:135], v160, s[36:39], 0 offen offset:64
    v_cvt_pk_bf16_f32 v138, v52, v53
    v_cvt_pk_bf16_f32 v139, v54, v55
    v_cvt_pk_bf16_f32 v140, v56, v57
    v_permlane16_swap_b32 v136, v138
    v_cvt_pk_bf16_f32 v141, v58, v59
    v_permlane16_swap_b32 v137, v139
    v_cvt_pk_bf16_f32 v142, v60, v61
    buffer_store_dwordx4 v[136:139], v161, s[36:39], 0 offen offset:0
    v_cvt_pk_bf16_f32 v143, v62, v63
    v_permlane16_swap_b32 v140, v142
    s_nop 0
    v_permlane16_swap_b32 v141, v143
    buffer_store_dwordx4 v[140:143], v161, s[36:39], 0 offen offset:64
.Lend:
    s_endpgm
.section .rodata,"a"
.p2align 6
.amdhsa_kernel interleave_layers__sliding_local_dilated__swiglu_ffn__prompt_kernel
  .amdhsa_next_free_vgpr 512
  .amdhsa_next_free_sgpr 102
  .amdhsa_accum_offset 256
  .amdhsa_group_segment_fixed_size 0
  .amdhsa_kernarg_size 80
  .amdhsa_user_sgpr_count 2
  .amdhsa_user_sgpr_kernarg_segment_ptr 1
  .amdhsa_system_sgpr_workgroup_id_x 1
  .amdhsa_float_denorm_mode_32 3
.end_amdhsa_kernel
```

```asm
; @launch grid=(256,1,1) block=(256,1,1) lds=161536
.amdgcn_target "amdgcn-amd-amdhsa--gfx950"
.text
.globl interleave_layers__sliding_local_dilated__swiglu_ffn__prompt_kernel
.p2align 8
.type interleave_layers__sliding_local_dilated__swiglu_ffn__prompt_kernel,@function
interleave_layers__sliding_local_dilated__swiglu_ffn__prompt_kernel:
s_load_dwordx4 s[68:71], s[0:1], 0
s_load_dwordx2 s[72:73], s[0:1], 16
s_load_dwordx8 s[76:83], s[0:1], 32
s_load_dwordx4 s[84:87], s[0:1], 64
s_cmp_lt_u32 s2, 256
s_cbranch_scc1 .Lgo
s_endpgm
.p2align 12
.Lgo:
v_lshrrev_b32 v2, 6, v0
v_and_b32 v1, 63, v0
v_readfirstlane_b32 s3, v2
s_and_b32 s4, s2, 7
s_lshr_b32 s5, s2, 3
s_lshr_b32 s6, s4, 1
s_lshl_b32 s6, s6, 2
s_and_b32 s62, s5, 3
s_add_u32 s6, s6, s62
s_and_b32 s7, s4, 1
s_lshl_b32 s7, s7, 3
s_lshr_b32 s62, s5, 2
s_add_u32 s7, s7, s62
s_lshr_b32 s8, s4, 2
s_lshl_b32 s8, s8, 3
s_and_b32 s62, s5, 7
s_add_u32 s8, s8, s62
s_and_b32 s9, s4, 3
s_lshl_b32 s9, s9, 2
s_lshr_b32 s62, s5, 3
s_add_u32 s9, s9, s62
s_lshr_b32 s62, s6, 1
s_lshl_b32 s62, s62, 8
s_and_b32 s63, s6, 1
s_add_u32 s62, s62, s63
s_lshl_b32 s63, s3, 6
s_add_u32 s62, s62, s63
s_lshl_b32 s62, s62, 11
s_lshl_b32 s63, s7, 7
s_add_u32 s62, s62, s63
v_and_b32 v160, 15, v1
v_lshlrev_b32 v160, 12, v160
v_bfe_u32 v2, v1, 4, 1
v_lshl_add_u32 v160, v2, 5, v160
v_bfe_u32 v2, v1, 5, 1
v_lshl_add_u32 v160, v2, 4, v160
v_add_u32 v160, s62, v160
v_add_u32 v161, 0x10000, v160
s_sub_u32 s64, s3, 1
s_max_i32 s64, s64, 0
s_lshl_b32 s64, s64, 11
s_lshl_b32 s66, s9, 7
s_add_u32 s66, s66, s64
s_cmp_eq_u32 s3, 1
s_cselect_b32 s66, 8388608, s66
s_mul_i32 s65, s8, 73728
s_add_u32 s65, s65, s66
v_lshrrev_b32 v9, 2, v1
v_min_u32 v9, 11, v9
v_mul_u32_u24 v9, 6144, v9
s_waitcnt lgkmcnt(0)
s_mov_b32 s36, s68
s_mov_b32 s37, s69
s_mov_b32 s38, 4194304
s_mov_b32 s39, 0x20000
s_mov_b32 s16, s86
s_mov_b32 s17, s87
s_mov_b32 s18, 268435456
s_mov_b32 s19, 0x20000
s_lshl_b32 s67, s2, 2
s_add_u32 s67, s67, s3
v_mov_b32 v28, 0
s_cmp_lg_u32 s67, 3
s_cbranch_scc1 .Lz1
v_lshlrev_b32 v27, 7, v1
s_mov_b32 s62, 30408704
buffer_store_dword v28, v27, s[16:19], s62 offen sc1
s_mov_b32 s62, 30416896
buffer_store_dword v28, v27, s[16:19], s62 offen sc1
v_mov_b32 v64, 0x3f803f80
v_mov_b32 v65, 0x3f803f80
v_mov_b32 v66, 0x3f803f80
v_mov_b32 v67, 0x3f803f80
v_lshlrev_b32 v27, 17, v1
s_mov_b32 s62, 134217728
buffer_store_dwordx4 v[64:67], v27, s[16:19], s62 offen sc1
.Lz1:
buffer_load_dwordx4 v[128:131], v160, s[36:39], 0 offen nt
buffer_load_dwordx4 v[132:135], v160, s[36:39], 0 offen offset:64 nt
buffer_load_dwordx4 v[136:139], v161, s[36:39], 0 offen nt
buffer_load_dwordx4 v[140:143], v161, s[36:39], 0 offen offset:64 nt
s_mov_b32 s20, s70
s_mov_b32 s21, s71
s_mov_b32 s22, 6291456
s_mov_b32 s23, 0x20000
buffer_load_dword v30, v9, s[20:23], s65 offen
s_mov_b32 s40, s84
s_mov_b32 s41, s85
s_mov_b32 s42, 256
s_mov_b32 s43, 0x20000
v_mov_b32 v29, 1
s_cmp_lg_u32 s67, 3
s_cbranch_scc1 .Lz2
s_waitcnt vmcnt(5)
s_mov_b64 exec, 1
buffer_store_dword v29, v28, s[40:43], 0 offen sc1
s_mov_b64 exec, -1
.Lz2:
s_getpc_b64 s[62:63]
.Lpc:
s_lshl_b32 s64, s5, 12
v_lshrrev_b32 v31, 3, v0
v_lshl_add_u32 v31, v31, 7, s64
v_min_u32 v31, .Lend-.Lpc, v31
global_load_dword v31, v31, s[62:63]
s_mov_b32 s24, s72
s_mov_b32 s25, s73
s_mov_b32 s26, 2097152
s_mov_b32 s27, 0x20000
s_mov_b32 s28, s80
s_mov_b32 s29, s81
s_mov_b32 s30, 7340032
s_mov_b32 s31, 0x20000
s_cmp_lt_u32 s3, 2
s_cselect_b32 s32, s76, s78
s_cselect_b32 s33, s77, s79
s_mov_b32 s34, 7340032
s_mov_b32 s35, 0x20000
s_mov_b32 s36, s82
s_mov_b32 s37, s83
s_lshr_b32 s10, s4, 2
s_lshl_b32 s10, s10, 2
s_and_b32 s62, s5, 3
s_add_u32 s10, s10, s62
s_and_b32 s11, s4, 3
s_lshl_b32 s11, s11, 3
s_lshr_b32 s62, s5, 2
s_add_u32 s11, s11, s62
s_and_b32 s12, s11, 1
s_lshr_b32 s13, s11, 1
s_mul_i32 s51, s13, 448
s_mul_i32 s62, s12, 192
s_add_u32 s51, s51, s62
s_and_b32 s48, s3, 1
s_lshr_b32 s49, s3, 1
s_lshl_b32 s50, s8, 3
s_sub_u32 s50, s50, 9
s_cmp_lt_u32 s8, 2
s_cselect_b32 s50, 7, s50
s_mul_i32 s44, s8, 147456
s_add_u32 s44, s44, s66
s_add_u32 s44, s44, 1179648
s_mul_i32 s45, s8, 172032
s_add_u32 s45, s45, s66
s_add_u32 s45, s45, 3538944
v_lshrrev_b32 v14, 1, v1
v_min_u32 v14, 27, v14
v_mul_u32_u24 v14, 6144, v14
s_lshl_b32 s46, s2, 13
v_lshrrev_b32 v15, 2, v0
v_lshlrev_b32 v15, 7, v15
s_lshl_b32 s62, s2, 1
s_add_u32 s62, s62, s48
s_mul_i32 s62, s62, 1792
v_lshrrev_b32 v16, 2, v1
v_min_u32 v16, 13, v16
v_lshl_add_u32 v16, v16, 7, s62
v_bfe_u32 v18, v1, 3, 1
v_lshrrev_b32 v2, 4, v1
v_lshl_add_u32 v18, v2, 3, v18
s_lshl_b32 s62, s3, 1
v_add_u32 v18, s62, v18
v_mul_u32_u24 v18, 6144, v18
v_and_b32 v2, 7, v1
v_lshl_add_u32 v18, v2, 4, v18
s_lshl_b32 s62, s9, 7
v_add_u32 v18, s62, v18
v_add_u32 v19, 1024, v18
v_add_u32 v20, 2048, v18
s_mul_i32 s59, s3, 3104
s_mov_b32 s58, 0
s_lshl_b32 s62, s6, 13
s_lshl_b32 s63, s3, 11
s_add_u32 s62, s62, s63
v_lshl_add_u32 v4, v1, 4, s62
v_lshrrev_b32 v2, 3, v1
v_cmp_eq_u32 vcc, 3, v2
v_add_u32 v2, 67108480, v4
s_nop 0
v_cndmask_b32 v4, v4, v2, vcc
s_lshl_b32 s64, s6, 14
s_lshl_b32 s65, s49, 13
s_add_u32 s64, s64, s65
s_lshl_b32 s65, s7, 9
s_add_u32 s64, s64, s65
s_lshl_b32 s65, s48, 8
s_add_u32 s64, s64, s65
s_add_u32 s64, s64, 29360128
v_and_b32 v152, 31, v1
v_lshlrev_b32 v152, 3, v152
v_lshrrev_b32 v153, 5, v1
v_lshl_add_u32 v152, v153, 2, v152
s_lshl_b32 s62, s7, 18
s_add_u32 s62, s62, 0
s_add_u32 s63, s62, 0x20000
s_waitcnt vmcnt(5)
v_permlane16_swap_b32 v128, v130
v_permlane16_swap_b32 v129, v131
s_waitcnt vmcnt(4)
v_permlane16_swap_b32 v132, v134
v_permlane16_swap_b32 v133, v135
s_waitcnt vmcnt(3)
v_permlane16_swap_b32 v136, v138
v_permlane16_swap_b32 v137, v139
s_waitcnt vmcnt(2)
v_permlane16_swap_b32 v140, v142
v_permlane16_swap_b32 v141, v143
buffer_store_dwordx4 v[128:131], v4, s[16:19], s62 offen sc1
buffer_store_dwordx4 v[132:135], v4, s[16:19], s63 offen sc1
buffer_store_dwordx4 v[136:139], v4, s[16:19], s62 offen offset:1024 sc1
buffer_store_dwordx4 v[140:143], v4, s[16:19], s63 offen offset:1024 sc1
v_lshlrev_b32 v32, 16, v128
v_and_b32 v33, 0xffff0000, v128
v_lshlrev_b32 v34, 16, v129
v_and_b32 v35, 0xffff0000, v129
v_lshlrev_b32 v36, 16, v130
v_and_b32 v37, 0xffff0000, v130
v_lshlrev_b32 v38, 16, v131
v_and_b32 v39, 0xffff0000, v131
v_lshlrev_b32 v40, 16, v132
v_and_b32 v41, 0xffff0000, v132
v_lshlrev_b32 v42, 16, v133
v_and_b32 v43, 0xffff0000, v133
v_lshlrev_b32 v44, 16, v134
v_and_b32 v45, 0xffff0000, v134
v_lshlrev_b32 v46, 16, v135
v_and_b32 v47, 0xffff0000, v135
v_lshlrev_b32 v48, 16, v136
v_and_b32 v49, 0xffff0000, v136
v_lshlrev_b32 v50, 16, v137
v_and_b32 v51, 0xffff0000, v137
v_lshlrev_b32 v52, 16, v138
v_and_b32 v53, 0xffff0000, v138
v_lshlrev_b32 v54, 16, v139
v_and_b32 v55, 0xffff0000, v139
v_lshlrev_b32 v56, 16, v140
v_and_b32 v57, 0xffff0000, v140
v_lshlrev_b32 v58, 16, v141
v_and_b32 v59, 0xffff0000, v141
v_lshlrev_b32 v60, 16, v142
v_and_b32 v61, 0xffff0000, v142
v_lshlrev_b32 v62, 16, v143
v_and_b32 v63, 0xffff0000, v143
v_pk_mul_f32 v[146:147], v[32:33], v[32:33]
v_pk_mul_f32 v[150:151], v[48:49], v[48:49]
v_pk_fma_f32 v[146:147], v[34:35], v[34:35], v[146:147]
v_pk_add_f32 v[144:145], v[32:33], v[34:35]
v_pk_fma_f32 v[150:151], v[50:51], v[50:51], v[150:151]
v_pk_add_f32 v[148:149], v[48:49], v[50:51]
v_pk_fma_f32 v[146:147], v[36:37], v[36:37], v[146:147]
v_pk_add_f32 v[144:145], v[144:145], v[36:37]
v_pk_fma_f32 v[150:151], v[52:53], v[52:53], v[150:151]
v_pk_add_f32 v[148:149], v[148:149], v[52:53]
v_pk_fma_f32 v[146:147], v[38:39], v[38:39], v[146:147]
v_pk_add_f32 v[144:145], v[144:145], v[38:39]
v_pk_fma_f32 v[150:151], v[54:55], v[54:55], v[150:151]
v_pk_add_f32 v[148:149], v[148:149], v[54:55]
v_pk_fma_f32 v[146:147], v[40:41], v[40:41], v[146:147]
v_pk_add_f32 v[144:145], v[144:145], v[40:41]
v_pk_fma_f32 v[150:151], v[56:57], v[56:57], v[150:151]
v_pk_add_f32 v[148:149], v[148:149], v[56:57]
v_pk_fma_f32 v[146:147], v[42:43], v[42:43], v[146:147]
v_pk_add_f32 v[144:145], v[144:145], v[42:43]
v_pk_fma_f32 v[150:151], v[58:59], v[58:59], v[150:151]
v_pk_add_f32 v[148:149], v[148:149], v[58:59]
v_pk_fma_f32 v[146:147], v[44:45], v[44:45], v[146:147]
v_pk_add_f32 v[144:145], v[144:145], v[44:45]
v_pk_fma_f32 v[150:151], v[60:61], v[60:61], v[150:151]
v_pk_add_f32 v[148:149], v[148:149], v[60:61]
v_pk_fma_f32 v[146:147], v[46:47], v[46:47], v[146:147]
v_pk_add_f32 v[144:145], v[144:145], v[46:47]
v_pk_fma_f32 v[150:151], v[62:63], v[62:63], v[150:151]
v_pk_add_f32 v[148:149], v[148:149], v[62:63]
v_add_f32 v144, v144, v145
v_add_f32 v146, v146, v147
v_add_f32 v148, v148, v149
v_add_f32 v150, v150, v151
s_nop 0
v_permlane16_swap_b32 v144, v148
v_permlane16_swap_b32 v146, v150
v_add_f32 v144, v144, v148
v_add_f32 v146, v146, v150
s_nop 1
v_permlane32_swap_b32 v144, v146
v_add_f32 v144, v144, v146
buffer_store_dword v144, v152, s[16:19], s64 offen sc1
buffer_load_dword v255, v28, s[40:43], 0 offen sc1
s_add_u32 m0, s59, 66560
s_nop 0
buffer_load_dwordx4 v18, s[20:23], s58 offen lds
buffer_load_dwordx4 v19, s[20:23], s58 offen offset:1024 lds
buffer_load_dwordx4 v20, s[20:23], s58 offen offset:2048 lds
s_add_u32 s58, s58, 196608
s_add_u32 m0, s59, 78976
s_nop 0
buffer_load_dwordx4 v18, s[20:23], s58 offen lds
buffer_load_dwordx4 v19, s[20:23], s58 offen offset:1024 lds
buffer_load_dwordx4 v20, s[20:23], s58 offen offset:2048 lds
s_add_u32 s58, s58, 196608
s_add_u32 m0, s59, 91392
s_nop 0
buffer_load_dwordx4 v18, s[20:23], s58 offen lds
buffer_load_dwordx4 v19, s[20:23], s58 offen offset:1024 lds
buffer_load_dwordx4 v20, s[20:23], s58 offen offset:2048 lds
s_add_u32 s58, s58, 196608
s_add_u32 m0, s59, 103808
s_nop 0
buffer_load_dwordx4 v18, s[20:23], s58 offen lds
buffer_load_dwordx4 v19, s[20:23], s58 offen offset:1024 lds
buffer_load_dwordx4 v20, s[20:23], s58 offen offset:2048 lds
s_add_u32 s58, s58, 196608
s_add_u32 m0, s59, 116224
s_nop 0
buffer_load_dwordx4 v18, s[20:23], s58 offen lds
buffer_load_dwordx4 v19, s[20:23], s58 offen offset:1024 lds
buffer_load_dwordx4 v20, s[20:23], s58 offen offset:2048 lds
s_add_u32 s58, s58, 196608
s_add_u32 m0, s59, 128640
s_nop 0
buffer_load_dwordx4 v18, s[20:23], s58 offen lds
buffer_load_dwordx4 v19, s[20:23], s58 offen offset:1024 lds
buffer_load_dwordx4 v20, s[20:23], s58 offen offset:2048 lds
s_add_u32 s58, s58, 196608
s_nop 1
v_accvgpr_write_b32 a224, v32
v_accvgpr_write_b32 a225, v33
v_accvgpr_write_b32 a226, v34
v_accvgpr_write_b32 a227, v35
v_accvgpr_write_b32 a228, v36
v_accvgpr_write_b32 a229, v37
v_accvgpr_write_b32 a230, v38
v_accvgpr_write_b32 a231, v39
v_accvgpr_write_b32 a232, v40
v_accvgpr_write_b32 a233, v41
v_accvgpr_write_b32 a234, v42
v_accvgpr_write_b32 a235, v43
v_accvgpr_write_b32 a236, v44
v_accvgpr_write_b32 a237, v45
v_accvgpr_write_b32 a238, v46
v_accvgpr_write_b32 a239, v47
v_accvgpr_write_b32 a240, v48
v_accvgpr_write_b32 a241, v49
v_accvgpr_write_b32 a242, v50
v_accvgpr_write_b32 a243, v51
v_accvgpr_write_b32 a244, v52
v_accvgpr_write_b32 a245, v53
v_accvgpr_write_b32 a246, v54
v_accvgpr_write_b32 a247, v55
v_accvgpr_write_b32 a248, v56
v_accvgpr_write_b32 a249, v57
v_accvgpr_write_b32 a250, v58
v_accvgpr_write_b32 a251, v59
v_accvgpr_write_b32 a252, v60
v_accvgpr_write_b32 a253, v61
v_accvgpr_write_b32 a254, v62
v_accvgpr_write_b32 a255, v63
s_lshl_b32 s62, s8, 13
s_lshl_b32 s63, s3, 11
s_add_u32 s62, s62, s63
v_lshl_add_u32 v21, v1, 4, s62
v_lshrrev_b32 v2, 3, v1
v_cmp_eq_u32 vcc, 3, v2
v_add_u32 v2, 67108480, v21
s_nop 0
v_cndmask_b32 v21, v21, v2, vcc
s_lshl_b32 s62, s50, 10
s_sub_u32 s62, s62, 2048
v_lshl_add_u32 v22, v0, 2, s62
v_lshrrev_b32 v2, 5, v0
v_cmp_eq_u32 vcc, 3, v2
v_add_u32 v2, 67108480, v22
s_nop 0
v_cndmask_b32 v22, v22, v2, vcc
v_lshlrev_b32 v2, 2, v1
v_add_u32 v2, 134215680, v2
v_cmp_gt_u32 vcc, 4, v1
s_nop 1
v_cndmask_b32 v22, v22, v2, vcc
s_mul_i32 s62, s48, 4608
v_lshl_add_u32 v23, v1, 4, s62
v_lshrrev_b32 v24, 4, v1
v_mul_u32_u24 v24, 2304, v24
v_and_b32 v2, 15, v1
v_lshl_add_u32 v24, v2, 4, v24
v_bfe_u32 v25, v1, 3, 2
v_mul_u32_u24 v25, 3104, v25
v_bfe_u32 v2, v1, 2, 1
v_lshl_add_u32 v25, v2, 7, v25
v_bfe_u32 v2, v1, 5, 1
v_lshl_add_u32 v25, v2, 8, v25
v_and_b32 v2, 3, v1
v_lshl_add_u32 v25, v2, 3, v25
s_lshl_b32 s62, s49, 6
s_add_u32 s62, s62, 66560
v_add_u32 v25, s62, v25
s_lshl_b32 s62, s8, 1
s_add_u32 s62, s62, s3
s_lshr_b32 s63, s50, 2
s_cmp_lt_u32 s3, 2
s_cselect_b32 s62, s62, s63
s_lshl_b32 s62, s62, 13
v_lshl_add_u32 v26, v1, 4, s62
s_mov_b32 s52, 0
s_mov_b32 s54, s58
s_mov_b32 s56, s59
s_mul_i32 s55, s3, 2304
s_mul_i32 s59, s3, 2080
v_bfe_u32 v5, v1, 3, 1
v_lshrrev_b32 v2, 4, v1
v_lshl_add_u32 v5, v2, 3, v5
s_lshl_b32 s62, s3, 1
v_add_u32 v5, s62, v5
v_mul_u32_u24 v5, 2048, v5
v_and_b32 v2, 7, v1
v_lshl_add_u32 v5, v2, 4, v5
s_lshl_b32 s62, s7, 7
v_add_u32 v5, s62, v5
v_add_u32 v6, 64512, v5
s_lshl_b32 s62, s6, 7
s_add_u32 s62, s62, 30408704
s_lshl_b32 s64, s8, 7
s_add_u32 s64, s64, 30408704
s_lshr_b32 s65, s50, 3
s_lshl_b32 s65, s65, 7
s_add_u32 s65, s65, 30408704
v_mov_b32 v252, s62
v_mov_b32 v253, s64
v_writelane_b32 v253, s65, 1
s_waitcnt vmcnt(18) lgkmcnt(0)
s_cmp_lg_u32 s3, 1
s_cbranch_scc1 .Lrdyok4
s_mov_b32 s15, 0
v_mov_b32 v2, 0
.Lrdy3:
v_cmp_ne_u32 vcc, 0, v255
s_add_u32 s15, s15, 1
s_cbranch_vccnz .Lrdyok4
s_cmp_gt_u32 s15, 100000
s_cbranch_scc1 .Lrdyok4
buffer_load_dword v255, v2, s[40:43], 0 offen sc1
s_waitcnt vmcnt(0)
s_branch .Lrdy3
.Lrdyok4:
s_barrier
s_cmp_lg_u32 s3, 1
s_cbranch_scc1 .Lnosig5
v_mov_b32 v255, 1
s_mov_b64 exec, 1
buffer_atomic_add v255, v252, s[16:19], 0 offen
s_mov_b64 exec, -1
.Lnosig5:
v_lshrrev_b32 v2, 4, v1
v_lshlrev_b32 v2, 2, v2
v_and_b32 v13, 15, v1
v_sub_u32 v2, v13, v2
v_mov_b32 v13, 0xff61b1e6
v_subrev_u32 v54, 0, v2
v_cmp_gt_u32 vcc, 8, v54
s_nop 1
v_cndmask_b32 v50, v13, 0, vcc
v_cmp_gt_i32 vcc, -8, v54
s_nop 1
v_cndmask_b32 v46, v13, 0, vcc
v_subrev_u32 v54, 1, v2
v_cmp_gt_u32 vcc, 8, v54
s_nop 1
v_cndmask_b32 v51, v13, 0, vcc
v_cmp_gt_i32 vcc, -8, v54
s_nop 1
v_cndmask_b32 v47, v13, 0, vcc
v_subrev_u32 v54, 2, v2
v_cmp_gt_u32 vcc, 8, v54
s_nop 1
v_cndmask_b32 v52, v13, 0, vcc
v_cmp_gt_i32 vcc, -8, v54
s_nop 1
v_cndmask_b32 v48, v13, 0, vcc
v_subrev_u32 v54, 3, v2
v_cmp_gt_u32 vcc, 8, v54
s_nop 1
v_cndmask_b32 v53, v13, 0, vcc
v_cmp_gt_i32 vcc, -8, v54
s_nop 1
v_cndmask_b32 v49, v13, 0, vcc
s_cmp_lt_u32 s8, 2
s_cselect_b64 vcc, -1, 0
v_cndmask_b32 v54, v46, v13, vcc
v_cndmask_b32 v55, v47, v13, vcc
v_cndmask_b32 v56, v48, v13, vcc
v_cndmask_b32 v57, v49, v13, vcc
v_mov_b64 v[60:61], 0
v_mov_b64 v[62:63], 0
v_mov_b64 v[64:65], 0
v_mov_b64 v[66:67], 0
v_mov_b64 v[68:69], 0
v_mov_b64 v[70:71], 0
v_mov_b64 v[72:73], 0
v_mov_b64 v[74:75], 0
v_mov_b64 v[76:77], 0
v_mov_b64 v[78:79], 0
v_mov_b64 v[80:81], 0
v_mov_b64 v[82:83], 0
v_mov_b64 v[84:85], 0
v_mov_b64 v[86:87], 0
v_mov_b64 v[88:89], 0
v_mov_b64 v[90:91], 0
v_mov_b64 v[92:93], 0
v_mov_b64 v[94:95], 0
v_mov_b64 v[96:97], 0
v_mov_b64 v[98:99], 0
v_mov_b64 v[100:101], 0
v_mov_b64 v[102:103], 0
v_mov_b64 v[104:105], 0
v_mov_b64 v[106:107], 0
v_mov_b64 v[108:109], 0
v_mov_b64 v[110:111], 0
v_mov_b64 v[112:113], 0
v_mov_b64 v[114:115], 0
v_mov_b64 v[116:117], 0
v_mov_b64 v[118:119], 0
v_mov_b64 v[120:121], 0
v_mov_b64 v[122:123], 0
v_mov_b64 v[124:125], 0
v_mov_b64 v[126:127], 0
v_mov_b64 v[128:129], 0
v_mov_b64 v[130:131], 0
v_mov_b64 v[132:133], 0
v_mov_b64 v[134:135], 0
v_mov_b64 v[136:137], 0
v_mov_b64 v[138:139], 0
v_mov_b64 v[140:141], 0
v_mov_b64 v[142:143], 0
v_mov_b64 v[144:145], 0
v_mov_b64 v[146:147], 0
v_mov_b64 v[148:149], 0
v_mov_b64 v[150:151], 0
v_mov_b64 v[152:153], 0
v_mov_b64 v[154:155], 0
v_mov_b64 v[156:157], 0
v_mov_b64 v[158:159], 0
v_mov_b64 v[160:161], 0
v_mov_b64 v[162:163], 0
v_mov_b64 v[244:245], 0
v_mov_b64 v[246:247], 0
v_and_b32 v10, 15, v1
v_lshlrev_b32 v12, 2, v10
v_lshlrev_b32 v10, 4, v10
v_add_u32 v10, 151552, v10
v_lshrrev_b32 v11, 4, v1
v_lshlrev_b32 v11, 4, v11
s_lshl_b32 s62, s49, 7
s_add_u32 s62, s62, 157696
v_add_u32 v12, s62, v12
v_add_u32 v13, s62, v11
v_add_u32 v11, 155648, v11
s_lshl_b32 s62, s3, 11
s_add_u32 s62, s62, 143360
v_lshl_add_u32 v8, v1, 4, s62
v_xor_b32 v9, 2048, v8
v_mov_b32 v248, 0x3f803f80
v_mov_b32 v249, 0x3f803f80
v_mov_b32 v250, 0x3f803f80
v_mov_b32 v251, 0x3f803f80
v_and_b32 v7, 31, v1
v_lshrrev_b32 v2, 5, v1
v_lshl_add_u32 v7, v7, 1, v2
v_and_b32 v2, 0xc0, v0
v_add_u32 v7, v7, v2
v_lshlrev_b32 v17, 2, v7
v_add_u32 v17, 155648, v17
v_lshlrev_b32 v7, 4, v7
v_add_u32 v7, 151552, v7
s_lshl_b32 s74, s9, 1
s_add_u32 s74, s74, s49
s_lshl_b32 s74, s74, 17
s_lshl_b32 s63, s8, 13
s_add_u32 s74, s74, s63
s_lshl_b32 s63, s48, 12
s_add_u32 s74, s74, s63
s_add_u32 s74, s74, 4194304
s_mov_b32 s62, 0
v_lshl_add_u32 v4, v1, 4, s62
v_lshrrev_b32 v2, 3, v1
v_cmp_eq_u32 vcc, 3, v2
v_add_u32 v2, 67108480, v4
s_nop 0
v_cndmask_b32 v4, v4, v2, vcc
s_waitcnt lgkmcnt(0)
s_cmp_lg_u32 s3, 1
s_cbranch_scc1 .Lnopoll8
s_mov_b64 exec, 3
s_mov_b32 s15, 0
.Lpoll6:
buffer_load_dword v255, v253, s[16:19], 0 offen sc1
s_add_u32 s15, s15, 1
s_cmp_gt_u32 s15, 100000
s_cbranch_scc1 .Lgot7
s_waitcnt vmcnt(0)
v_cmp_ne_u32 vcc, 16, v255
s_nop 0
s_cbranch_vccnz .Lpoll6
.Lgot7:
s_waitcnt vmcnt(0)
s_branch .Lnopoll8r
.Lnopoll8:
s_mov_b64 exec, 0
s_cmp_eq_u32 s3, 2
s_cbranch_scc1 .Lpad1
s_cmp_eq_u32 s3, 3
s_cbranch_scc1 .Lpad2
s_branch .Lpad3
.Lnopoll8r:
s_mov_b64 exec, -1
s_barrier
s_cmp_eq_u32 s48, 1
s_cbranch_scc1 .Lqkv9
s_add_u32 m0, s55, 0
s_nop 0
buffer_load_dwordx4 v21, s[16:19], s52 offen sc1 lds
buffer_load_dwordx4 v21, s[16:19], s52 offen offset:1024 sc1 lds
buffer_load_dword v22, s[16:19], s52 offen offset:2048 sc1 lds
s_add_u32 s52, s52, 0x20000
s_add_u32 m0, s55, 9216
s_nop 0
buffer_load_dwordx4 v21, s[16:19], s52 offen sc1 lds
buffer_load_dwordx4 v21, s[16:19], s52 offen offset:1024 sc1 lds
buffer_load_dword v22, s[16:19], s52 offen offset:2048 sc1 lds
s_add_u32 s52, s52, 0x20000
s_add_u32 m0, s55, 18432
s_nop 0
buffer_load_dwordx4 v21, s[16:19], s52 offen sc1 lds
buffer_load_dwordx4 v21, s[16:19], s52 offen offset:1024 sc1 lds
buffer_load_dword v22, s[16:19], s52 offen offset:2048 sc1 lds
s_add_u32 s52, s52, 0x20000
s_add_u32 m0, s55, 27648
s_nop 0
buffer_load_dwordx4 v21, s[16:19], s52 offen sc1 lds
buffer_load_dwordx4 v21, s[16:19], s52 offen offset:1024 sc1 lds
buffer_load_dword v22, s[16:19], s52 offen offset:2048 sc1 lds
s_add_u32 s52, s52, 0x20000
s_add_u32 m0, s55, 36864
s_nop 0
buffer_load_dwordx4 v21, s[16:19], s52 offen sc1 lds
buffer_load_dwordx4 v21, s[16:19], s52 offen offset:1024 sc1 lds
buffer_load_dword v22, s[16:19], s52 offen offset:2048 sc1 lds
s_add_u32 s52, s52, 0x20000
s_add_u32 m0, s55, 46080
s_nop 0
buffer_load_dwordx4 v21, s[16:19], s52 offen sc1 lds
buffer_load_dwordx4 v21, s[16:19], s52 offen offset:1024 sc1 lds
buffer_load_dword v22, s[16:19], s52 offen offset:2048 sc1 lds
s_add_u32 s52, s52, 0x20000
s_waitcnt vmcnt(15)
s_barrier
ds_read_b128 a[0:3], v23
ds_read_b128 a[4:7], v23 offset:1024
ds_read_b128 a[8:11], v23 offset:2304
ds_read_b128 a[12:15], v23 offset:3328
ds_read_b128 a[16:19], v24 offset:2048
ds_read_b64_tr_b16 a[20:21], v25
ds_read_b64_tr_b16 a[22:23], v25 offset:512
ds_read_b64_tr_b16 a[24:25], v25 offset:32
ds_read_b64_tr_b16 a[26:27], v25 offset:544
ds_read_b64_tr_b16 a[28:29], v25 offset:1024
ds_read_b64_tr_b16 a[30:31], v25 offset:1536
ds_read_b64_tr_b16 a[32:33], v25 offset:1056
ds_read_b64_tr_b16 a[34:35], v25 offset:1568
ds_read_b64_tr_b16 a[36:37], v25 offset:2048
ds_read_b64_tr_b16 a[38:39], v25 offset:2560
ds_read_b64_tr_b16 a[40:41], v25 offset:2080
ds_read_b64_tr_b16 a[42:43], v25 offset:2592
s_mov_b32 s15, 4
.p2align 6
.Lk11:
s_waitcnt vmcnt(12) lgkmcnt(0)
s_barrier
v_mfma_f32_16x16x32_bf16 v[60:63], a[20:23], a[0:3], v[60:63]
ds_read_b64_tr_b16 a[64:65], v25 offset:12416
s_add_u32 m0, s56, 66560
v_mfma_f32_16x16x32_bf16 v[64:67], a[20:23], a[4:7], v[64:67]
buffer_load_dwordx4 v18, s[20:23], s54 offen lds
v_mfma_f32_16x16x32_bf16 v[68:71], a[20:23], a[8:11], v[68:71]
ds_read_b64_tr_b16 a[66:67], v25 offset:12928
v_mfma_f32_16x16x32_bf16 v[72:75], a[20:23], a[12:15], v[72:75]
ds_read_b64_tr_b16 a[68:69], v25 offset:12448
ds_read_b64_tr_b16 a[70:71], v25 offset:12960
v_mfma_f32_16x16x32_bf16 v[244:247], a[20:23], a[16:19], v[244:247]
buffer_load_dwordx4 v19, s[20:23], s54 offen offset:1024 lds
v_mfma_f32_16x16x32_bf16 v[76:79], a[24:27], a[0:3], v[76:79]
ds_read_b64_tr_b16 a[72:73], v25 offset:13440
v_mfma_f32_16x16x32_bf16 v[80:83], a[24:27], a[4:7], v[80:83]
ds_read_b64_tr_b16 a[74:75], v25 offset:13952
v_mfma_f32_16x16x32_bf16 v[84:87], a[24:27], a[8:11], v[84:87]
ds_read_b64_tr_b16 a[76:77], v25 offset:13472
ds_read_b64_tr_b16 a[78:79], v25 offset:13984
v_mfma_f32_16x16x32_bf16 v[88:91], a[24:27], a[12:15], v[88:91]
buffer_load_dwordx4 v20, s[20:23], s54 offen offset:2048 lds
v_mfma_f32_16x16x32_bf16 v[92:95], a[28:31], a[0:3], v[92:95]
s_add_u32 s54, s54, 196608
v_mfma_f32_16x16x32_bf16 v[96:99], a[28:31], a[4:7], v[96:99]
ds_read_b128 a[44:47], v23 offset:9216
s_add_u32 m0, s55, 0
v_mfma_f32_16x16x32_bf16 v[100:103], a[28:31], a[8:11], v[100:103]
buffer_load_dwordx4 v21, s[16:19], s52 offen sc1 lds
v_mfma_f32_16x16x32_bf16 v[104:107], a[28:31], a[12:15], v[104:107]
ds_read_b128 a[48:51], v23 offset:10240
v_mfma_f32_16x16x32_bf16 v[156:159], a[28:31], a[16:19], v[156:159]
ds_read_b64_tr_b16 a[80:81], v25 offset:14464
.Lpad1:
s_cbranch_execz .Lpad4
ds_read_b64_tr_b16 a[82:83], v25 offset:14976
v_mfma_f32_16x16x32_bf16 v[108:111], a[32:35], a[0:3], v[108:111]
ds_read_b128 a[52:55], v23 offset:11520
v_mfma_f32_16x16x32_bf16 v[112:115], a[32:35], a[4:7], v[112:115]
buffer_load_dwordx4 v21, s[16:19], s52 offen offset:1024 sc1 lds
v_mfma_f32_16x16x32_bf16 v[116:119], a[32:35], a[8:11], v[116:119]
ds_read_b128 a[56:59], v23 offset:12544
v_mfma_f32_16x16x32_bf16 v[120:123], a[32:35], a[12:15], v[120:123]
ds_read_b64_tr_b16 a[84:85], v25 offset:14496
ds_read_b64_tr_b16 a[86:87], v25 offset:15008
v_mfma_f32_16x16x32_bf16 v[160:163], a[32:35], a[16:19], v[160:163]
buffer_load_dword v22, s[16:19], s52 offen offset:2048 sc1 lds
v_mfma_f32_16x16x32_bf16 v[124:127], a[0:3], a[36:39], v[124:127]
s_add_u32 s52, s52, 0x20000
v_mfma_f32_16x16x32_bf16 v[128:131], a[4:7], a[36:39], v[128:131]
ds_read_b128 a[60:63], v24 offset:11264
v_mfma_f32_16x16x32_bf16 v[132:135], a[8:11], a[36:39], v[132:135]
s_cmp_eq_u32 s15, 4
s_cselect_b32 s67, s44, 16777216
v_mfma_f32_16x16x32_bf16 v[136:139], a[12:15], a[36:39], v[136:139]
buffer_load_dword v27, v14, s[20:23], s67 offen
v_mfma_f32_16x16x32_bf16 v[140:143], a[0:3], a[40:43], v[140:143]
v_mfma_f32_16x16x32_bf16 v[144:147], a[4:7], a[40:43], v[144:147]
v_mfma_f32_16x16x32_bf16 v[148:151], a[8:11], a[40:43], v[148:151]
v_mfma_f32_16x16x32_bf16 v[152:155], a[12:15], a[40:43], v[152:155]
s_waitcnt vmcnt(16) lgkmcnt(0)
s_barrier
v_mfma_f32_16x16x32_bf16 v[60:63], a[64:67], a[44:47], v[60:63]
ds_read_b64_tr_b16 a[20:21], v25 offset:24832
s_add_u32 m0, s56, 78976
v_mfma_f32_16x16x32_bf16 v[64:67], a[64:67], a[48:51], v[64:67]
buffer_load_dwordx4 v18, s[20:23], s54 offen lds
v_mfma_f32_16x16x32_bf16 v[68:71], a[64:67], a[52:55], v[68:71]
ds_read_b64_tr_b16 a[22:23], v25 offset:25344
v_mfma_f32_16x16x32_bf16 v[72:75], a[64:67], a[56:59], v[72:75]
ds_read_b64_tr_b16 a[24:25], v25 offset:24864
v_mfma_f32_16x16x32_bf16 v[244:247], a[64:67], a[60:63], v[244:247]
ds_read_b64_tr_b16 a[26:27], v25 offset:25376
ds_read_b64_tr_b16 a[28:29], v25 offset:25856
v_mfma_f32_16x16x32_bf16 v[76:79], a[68:71], a[44:47], v[76:79]
buffer_load_dwordx4 v19, s[20:23], s54 offen offset:1024 lds
v_mfma_f32_16x16x32_bf16 v[80:83], a[68:71], a[48:51], v[80:83]
ds_read_b64_tr_b16 a[30:31], v25 offset:26368
v_mfma_f32_16x16x32_bf16 v[84:87], a[68:71], a[52:55], v[84:87]
ds_read_b64_tr_b16 a[32:33], v25 offset:25888
v_mfma_f32_16x16x32_bf16 v[88:91], a[68:71], a[56:59], v[88:91]
ds_read_b64_tr_b16 a[34:35], v25 offset:26400
v_mfma_f32_16x16x32_bf16 v[92:95], a[72:75], a[44:47], v[92:95]
buffer_load_dwordx4 v20, s[20:23], s54 offen offset:2048 lds
v_mfma_f32_16x16x32_bf16 v[96:99], a[72:75], a[48:51], v[96:99]
ds_read_b128 a[0:3], v23 offset:18432
s_add_u32 s54, s54, 196608
v_mfma_f32_16x16x32_bf16 v[100:103], a[72:75], a[52:55], v[100:103]
ds_read_b128 a[4:7], v23 offset:19456
v_mfma_f32_16x16x32_bf16 v[104:107], a[72:75], a[56:59], v[104:107]
s_add_u32 m0, s55, 9216
v_mfma_f32_16x16x32_bf16 v[156:159], a[72:75], a[60:63], v[156:159]
buffer_load_dwordx4 v21, s[16:19], s52 offen sc1 lds
v_mfma_f32_16x16x32_bf16 v[108:111], a[76:79], a[44:47], v[108:111]
ds_read_b64_tr_b16 a[36:37], v25 offset:26880
ds_read_b64_tr_b16 a[38:39], v25 offset:27392
v_mfma_f32_16x16x32_bf16 v[112:115], a[76:79], a[48:51], v[112:115]
ds_read_b128 a[8:11], v23 offset:20736
v_mfma_f32_16x16x32_bf16 v[116:119], a[76:79], a[52:55], v[116:119]
ds_read_b128 a[12:15], v23 offset:21760
v_mfma_f32_16x16x32_bf16 v[120:123], a[76:79], a[56:59], v[120:123]
buffer_load_dwordx4 v21, s[16:19], s52 offen offset:1024 sc1 lds
v_mfma_f32_16x16x32_bf16 v[160:163], a[76:79], a[60:63], v[160:163]
ds_read_b64_tr_b16 a[40:41], v25 offset:26912
v_mfma_f32_16x16x32_bf16 v[124:127], a[44:47], a[80:83], v[124:127]
ds_read_b64_tr_b16 a[42:43], v25 offset:27424
v_mfma_f32_16x16x32_bf16 v[128:131], a[48:51], a[80:83], v[128:131]
ds_read_b128 a[16:19], v24 offset:20480
v_mfma_f32_16x16x32_bf16 v[132:135], a[52:55], a[80:83], v[132:135]
buffer_load_dword v22, s[16:19], s52 offen offset:2048 sc1 lds
v_mfma_f32_16x16x32_bf16 v[136:139], a[56:59], a[80:83], v[136:139]
s_add_u32 s52, s52, 0x20000
v_mfma_f32_16x16x32_bf16 v[140:143], a[44:47], a[84:87], v[140:143]
v_mfma_f32_16x16x32_bf16 v[144:147], a[48:51], a[84:87], v[144:147]
v_mfma_f32_16x16x32_bf16 v[148:151], a[52:55], a[84:87], v[148:151]
v_mfma_f32_16x16x32_bf16 v[152:155], a[56:59], a[84:87], v[152:155]
s_waitcnt vmcnt(19) lgkmcnt(0)
s_barrier
v_mfma_f32_16x16x32_bf16 v[60:63], a[20:23], a[0:3], v[60:63]
ds_read_b64_tr_b16 a[64:65], v25 offset:37248
s_add_u32 m0, s56, 91392
v_mfma_f32_16x16x32_bf16 v[64:67], a[20:23], a[4:7], v[64:67]
buffer_load_dwordx4 v18, s[20:23], s54 offen lds
v_mfma_f32_16x16x32_bf16 v[68:71], a[20:23], a[8:11], v[68:71]
ds_read_b64_tr_b16 a[66:67], v25 offset:37760
v_mfma_f32_16x16x32_bf16 v[72:75], a[20:23], a[12:15], v[72:75]
ds_read_b64_tr_b16 a[68:69], v25 offset:37280
ds_read_b64_tr_b16 a[70:71], v25 offset:37792
v_mfma_f32_16x16x32_bf16 v[244:247], a[20:23], a[16:19], v[244:247]
buffer_load_dwordx4 v19, s[20:23], s54 offen offset:1024 lds
v_mfma_f32_16x16x32_bf16 v[76:79], a[24:27], a[0:3], v[76:79]
ds_read_b64_tr_b16 a[72:73], v25 offset:38272
v_mfma_f32_16x16x32_bf16 v[80:83], a[24:27], a[4:7], v[80:83]
ds_read_b64_tr_b16 a[74:75], v25 offset:38784
v_mfma_f32_16x16x32_bf16 v[84:87], a[24:27], a[8:11], v[84:87]
ds_read_b64_tr_b16 a[76:77], v25 offset:38304
ds_read_b64_tr_b16 a[78:79], v25 offset:38816
v_mfma_f32_16x16x32_bf16 v[88:91], a[24:27], a[12:15], v[88:91]
buffer_load_dwordx4 v20, s[20:23], s54 offen offset:2048 lds
v_mfma_f32_16x16x32_bf16 v[92:95], a[28:31], a[0:3], v[92:95]
s_add_u32 s54, s54, 196608
v_mfma_f32_16x16x32_bf16 v[96:99], a[28:31], a[4:7], v[96:99]
ds_read_b128 a[44:47], v23 offset:27648
s_add_u32 m0, s55, 18432
v_mfma_f32_16x16x32_bf16 v[100:103], a[28:31], a[8:11], v[100:103]
buffer_load_dwordx4 v21, s[16:19], s52 offen sc1 lds
v_mfma_f32_16x16x32_bf16 v[104:107], a[28:31], a[12:15], v[104:107]
ds_read_b128 a[48:51], v23 offset:28672
v_mfma_f32_16x16x32_bf16 v[156:159], a[28:31], a[16:19], v[156:159]
ds_read_b64_tr_b16 a[80:81], v25 offset:39296
ds_read_b64_tr_b16 a[82:83], v25 offset:39808
v_mfma_f32_16x16x32_bf16 v[108:111], a[32:35], a[0:3], v[108:111]
ds_read_b128 a[52:55], v23 offset:29952
v_mfma_f32_16x16x32_bf16 v[112:115], a[32:35], a[4:7], v[112:115]
buffer_load_dwordx4 v21, s[16:19], s52 offen offset:1024 sc1 lds
v_mfma_f32_16x16x32_bf16 v[116:119], a[32:35], a[8:11], v[116:119]
ds_read_b128 a[56:59], v23 offset:30976
v_mfma_f32_16x16x32_bf16 v[120:123], a[32:35], a[12:15], v[120:123]
ds_read_b64_tr_b16 a[84:85], v25 offset:39328
ds_read_b64_tr_b16 a[86:87], v25 offset:39840
v_mfma_f32_16x16x32_bf16 v[160:163], a[32:35], a[16:19], v[160:163]
buffer_load_dword v22, s[16:19], s52 offen offset:2048 sc1 lds
v_mfma_f32_16x16x32_bf16 v[124:127], a[0:3], a[36:39], v[124:127]
s_add_u32 s52, s52, 0x20000
v_mfma_f32_16x16x32_bf16 v[128:131], a[4:7], a[36:39], v[128:131]
ds_read_b128 a[60:63], v24 offset:29696
v_mfma_f32_16x16x32_bf16 v[132:135], a[8:11], a[36:39], v[132:135]
s_cmp_eq_u32 s15, 3
s_cselect_b32 s67, s45, 16777216
v_mfma_f32_16x16x32_bf16 v[136:139], a[12:15], a[36:39], v[136:139]
buffer_load_dword v27, v14, s[20:23], s67 offen
v_mfma_f32_16x16x32_bf16 v[140:143], a[0:3], a[40:43], v[140:143]
v_mfma_f32_16x16x32_bf16 v[144:147], a[4:7], a[40:43], v[144:147]
v_mfma_f32_16x16x32_bf16 v[148:151], a[8:11], a[40:43], v[148:151]
v_mfma_f32_16x16x32_bf16 v[152:155], a[12:15], a[40:43], v[152:155]
s_waitcnt vmcnt(23) lgkmcnt(0)
s_barrier
v_mfma_f32_16x16x32_bf16 v[60:63], a[64:67], a[44:47], v[60:63]
ds_read_b64_tr_b16 a[20:21], v25 offset:49664
s_add_u32 m0, s56, 103808
v_mfma_f32_16x16x32_bf16 v[64:67], a[64:67], a[48:51], v[64:67]
buffer_load_dwordx4 v18, s[20:23], s54 offen lds
v_mfma_f32_16x16x32_bf16 v[68:71], a[64:67], a[52:55], v[68:71]
ds_read_b64_tr_b16 a[22:23], v25 offset:50176
v_mfma_f32_16x16x32_bf16 v[72:75], a[64:67], a[56:59], v[72:75]
ds_read_b64_tr_b16 a[24:25], v25 offset:49696
v_mfma_f32_16x16x32_bf16 v[244:247], a[64:67], a[60:63], v[244:247]
ds_read_b64_tr_b16 a[26:27], v25 offset:50208
ds_read_b64_tr_b16 a[28:29], v25 offset:50688
v_mfma_f32_16x16x32_bf16 v[76:79], a[68:71], a[44:47], v[76:79]
buffer_load_dwordx4 v19, s[20:23], s54 offen offset:1024 lds
v_mfma_f32_16x16x32_bf16 v[80:83], a[68:71], a[48:51], v[80:83]
ds_read_b64_tr_b16 a[30:31], v25 offset:51200
v_mfma_f32_16x16x32_bf16 v[84:87], a[68:71], a[52:55], v[84:87]
ds_read_b64_tr_b16 a[32:33], v25 offset:50720
v_mfma_f32_16x16x32_bf16 v[88:91], a[68:71], a[56:59], v[88:91]
ds_read_b64_tr_b16 a[34:35], v25 offset:51232
v_mfma_f32_16x16x32_bf16 v[92:95], a[72:75], a[44:47], v[92:95]
buffer_load_dwordx4 v20, s[20:23], s54 offen offset:2048 lds
v_mfma_f32_16x16x32_bf16 v[96:99], a[72:75], a[48:51], v[96:99]
ds_read_b128 a[0:3], v23 offset:36864
s_add_u32 s54, s54, 196608
v_mfma_f32_16x16x32_bf16 v[100:103], a[72:75], a[52:55], v[100:103]
ds_read_b128 a[4:7], v23 offset:37888
v_mfma_f32_16x16x32_bf16 v[104:107], a[72:75], a[56:59], v[104:107]
s_add_u32 m0, s55, 27648
v_mfma_f32_16x16x32_bf16 v[156:159], a[72:75], a[60:63], v[156:159]
buffer_load_dwordx4 v21, s[16:19], s52 offen sc1 lds
v_mfma_f32_16x16x32_bf16 v[108:111], a[76:79], a[44:47], v[108:111]
ds_read_b64_tr_b16 a[36:37], v25 offset:51712
ds_read_b64_tr_b16 a[38:39], v25 offset:52224
v_mfma_f32_16x16x32_bf16 v[112:115], a[76:79], a[48:51], v[112:115]
ds_read_b128 a[8:11], v23 offset:39168
v_mfma_f32_16x16x32_bf16 v[116:119], a[76:79], a[52:55], v[116:119]
ds_read_b128 a[12:15], v23 offset:40192
v_mfma_f32_16x16x32_bf16 v[120:123], a[76:79], a[56:59], v[120:123]
buffer_load_dwordx4 v21, s[16:19], s52 offen offset:1024 sc1 lds
v_mfma_f32_16x16x32_bf16 v[160:163], a[76:79], a[60:63], v[160:163]
ds_read_b64_tr_b16 a[40:41], v25 offset:51744
v_mfma_f32_16x16x32_bf16 v[124:127], a[44:47], a[80:83], v[124:127]
ds_read_b64_tr_b16 a[42:43], v25 offset:52256
v_mfma_f32_16x16x32_bf16 v[128:131], a[48:51], a[80:83], v[128:131]
ds_read_b128 a[16:19], v24 offset:38912
v_mfma_f32_16x16x32_bf16 v[132:135], a[52:55], a[80:83], v[132:135]
buffer_load_dword v22, s[16:19], s52 offen offset:2048 sc1 lds
v_mfma_f32_16x16x32_bf16 v[136:139], a[56:59], a[80:83], v[136:139]
s_add_u32 s52, s52, 0x20000
v_mfma_f32_16x16x32_bf16 v[140:143], a[44:47], a[84:87], v[140:143]
v_mfma_f32_16x16x32_bf16 v[144:147], a[48:51], a[84:87], v[144:147]
v_mfma_f32_16x16x32_bf16 v[148:151], a[52:55], a[84:87], v[148:151]
v_mfma_f32_16x16x32_bf16 v[152:155], a[56:59], a[84:87], v[152:155]
s_waitcnt vmcnt(26) lgkmcnt(0)
s_barrier
v_mfma_f32_16x16x32_bf16 v[60:63], a[20:23], a[0:3], v[60:63]
ds_read_b64_tr_b16 a[64:65], v25 offset:62080
s_add_u32 m0, s56, 116224
v_mfma_f32_16x16x32_bf16 v[64:67], a[20:23], a[4:7], v[64:67]
buffer_load_dwordx4 v18, s[20:23], s54 offen lds
v_mfma_f32_16x16x32_bf16 v[68:71], a[20:23], a[8:11], v[68:71]
ds_read_b64_tr_b16 a[66:67], v25 offset:62592
v_mfma_f32_16x16x32_bf16 v[72:75], a[20:23], a[12:15], v[72:75]
ds_read_b64_tr_b16 a[68:69], v25 offset:62112
v_mfma_f32_16x16x32_bf16 v[244:247], a[20:23], a[16:19], v[244:247]
ds_read_b64_tr_b16 a[70:71], v25 offset:62624
ds_read_b64_tr_b16 a[72:73], v25 offset:63104
v_mfma_f32_16x16x32_bf16 v[76:79], a[24:27], a[0:3], v[76:79]
buffer_load_dwordx4 v19, s[20:23], s54 offen offset:1024 lds
v_mfma_f32_16x16x32_bf16 v[80:83], a[24:27], a[4:7], v[80:83]
ds_read_b64_tr_b16 a[74:75], v25 offset:63616
v_mfma_f32_16x16x32_bf16 v[84:87], a[24:27], a[8:11], v[84:87]
ds_read_b64_tr_b16 a[76:77], v25 offset:63136
v_mfma_f32_16x16x32_bf16 v[88:91], a[24:27], a[12:15], v[88:91]
ds_read_b64_tr_b16 a[78:79], v25 offset:63648
v_mfma_f32_16x16x32_bf16 v[92:95], a[28:31], a[0:3], v[92:95]
buffer_load_dwordx4 v20, s[20:23], s54 offen offset:2048 lds
v_mfma_f32_16x16x32_bf16 v[96:99], a[28:31], a[4:7], v[96:99]
ds_read_b128 a[44:47], v23 offset:46080
s_add_u32 s54, s54, 196608
v_mfma_f32_16x16x32_bf16 v[100:103], a[28:31], a[8:11], v[100:103]
ds_read_b128 a[48:51], v23 offset:47104
v_mfma_f32_16x16x32_bf16 v[104:107], a[28:31], a[12:15], v[104:107]
s_add_u32 m0, s55, 36864
v_mfma_f32_16x16x32_bf16 v[156:159], a[28:31], a[16:19], v[156:159]
buffer_load_dwordx4 v21, s[16:19], s52 offen sc1 lds
v_mfma_f32_16x16x32_bf16 v[108:111], a[32:35], a[0:3], v[108:111]
ds_read_b64_tr_b16 a[80:81], v25 offset:64128
ds_read_b64_tr_b16 a[82:83], v25 offset:64640
v_mfma_f32_16x16x32_bf16 v[112:115], a[32:35], a[4:7], v[112:115]
ds_read_b128 a[52:55], v23 offset:48384
v_mfma_f32_16x16x32_bf16 v[116:119], a[32:35], a[8:11], v[116:119]
ds_read_b128 a[56:59], v23 offset:49408
v_mfma_f32_16x16x32_bf16 v[120:123], a[32:35], a[12:15], v[120:123]
buffer_load_dwordx4 v21, s[16:19], s52 offen offset:1024 sc1 lds
v_mfma_f32_16x16x32_bf16 v[160:163], a[32:35], a[16:19], v[160:163]
ds_read_b64_tr_b16 a[84:85], v25 offset:64160
v_mfma_f32_16x16x32_bf16 v[124:127], a[0:3], a[36:39], v[124:127]
ds_read_b64_tr_b16 a[86:87], v25 offset:64672
v_mfma_f32_16x16x32_bf16 v[128:131], a[4:7], a[36:39], v[128:131]
ds_read_b128 a[60:63], v24 offset:48128
v_mfma_f32_16x16x32_bf16 v[132:135], a[8:11], a[36:39], v[132:135]
buffer_load_dword v22, s[16:19], s52 offen offset:2048 sc1 lds
v_mfma_f32_16x16x32_bf16 v[136:139], a[12:15], a[36:39], v[136:139]
s_add_u32 s52, s52, 0x20000
v_mfma_f32_16x16x32_bf16 v[140:143], a[0:3], a[40:43], v[140:143]
v_mfma_f32_16x16x32_bf16 v[144:147], a[4:7], a[40:43], v[144:147]
v_mfma_f32_16x16x32_bf16 v[148:151], a[8:11], a[40:43], v[148:151]
v_mfma_f32_16x16x32_bf16 v[152:155], a[12:15], a[40:43], v[152:155]
s_waitcnt vmcnt(26) lgkmcnt(0)
s_barrier
v_mfma_f32_16x16x32_bf16 v[60:63], a[64:67], a[44:47], v[60:63]
ds_read_b64_tr_b16 a[20:21], v25
s_add_u32 m0, s56, 128640
v_mfma_f32_16x16x32_bf16 v[64:67], a[64:67], a[48:51], v[64:67]
buffer_load_dwordx4 v18, s[20:23], s54 offen lds
v_mfma_f32_16x16x32_bf16 v[68:71], a[64:67], a[52:55], v[68:71]
ds_read_b64_tr_b16 a[22:23], v25 offset:512
v_mfma_f32_16x16x32_bf16 v[72:75], a[64:67], a[56:59], v[72:75]
ds_read_b64_tr_b16 a[24:25], v25 offset:32
ds_read_b64_tr_b16 a[26:27], v25 offset:544
v_mfma_f32_16x16x32_bf16 v[244:247], a[64:67], a[60:63], v[244:247]
buffer_load_dwordx4 v19, s[20:23], s54 offen offset:1024 lds
v_mfma_f32_16x16x32_bf16 v[76:79], a[68:71], a[44:47], v[76:79]
ds_read_b64_tr_b16 a[28:29], v25 offset:1024
v_mfma_f32_16x16x32_bf16 v[80:83], a[68:71], a[48:51], v[80:83]
ds_read_b64_tr_b16 a[30:31], v25 offset:1536
v_mfma_f32_16x16x32_bf16 v[84:87], a[68:71], a[52:55], v[84:87]
ds_read_b64_tr_b16 a[32:33], v25 offset:1056
ds_read_b64_tr_b16 a[34:35], v25 offset:1568
v_mfma_f32_16x16x32_bf16 v[88:91], a[68:71], a[56:59], v[88:91]
buffer_load_dwordx4 v20, s[20:23], s54 offen offset:2048 lds
v_mfma_f32_16x16x32_bf16 v[92:95], a[72:75], a[44:47], v[92:95]
s_add_u32 s54, s54, 196608
v_mfma_f32_16x16x32_bf16 v[96:99], a[72:75], a[48:51], v[96:99]
ds_read_b128 a[0:3], v23
s_add_u32 m0, s55, 46080
v_mfma_f32_16x16x32_bf16 v[100:103], a[72:75], a[52:55], v[100:103]
buffer_load_dwordx4 v21, s[16:19], s52 offen sc1 lds
v_mfma_f32_16x16x32_bf16 v[104:107], a[72:75], a[56:59], v[104:107]
ds_read_b128 a[4:7], v23 offset:1024
v_mfma_f32_16x16x32_bf16 v[156:159], a[72:75], a[60:63], v[156:159]
ds_read_b64_tr_b16 a[36:37], v25 offset:2048
ds_read_b64_tr_b16 a[38:39], v25 offset:2560
v_mfma_f32_16x16x32_bf16 v[108:111], a[76:79], a[44:47], v[108:111]
ds_read_b128 a[8:11], v23 offset:2304
v_mfma_f32_16x16x32_bf16 v[112:115], a[76:79], a[48:51], v[112:115]
buffer_load_dwordx4 v21, s[16:19], s52 offen offset:1024 sc1 lds
v_mfma_f32_16x16x32_bf16 v[116:119], a[76:79], a[52:55], v[116:119]
ds_read_b128 a[12:15], v23 offset:3328
v_mfma_f32_16x16x32_bf16 v[120:123], a[76:79], a[56:59], v[120:123]
ds_read_b64_tr_b16 a[40:41], v25 offset:2080
ds_read_b64_tr_b16 a[42:43], v25 offset:2592
v_mfma_f32_16x16x32_bf16 v[160:163], a[76:79], a[60:63], v[160:163]
buffer_load_dword v22, s[16:19], s52 offen offset:2048 sc1 lds
v_mfma_f32_16x16x32_bf16 v[124:127], a[44:47], a[80:83], v[124:127]
s_add_u32 s52, s52, 0x20000
v_mfma_f32_16x16x32_bf16 v[128:131], a[48:51], a[80:83], v[128:131]
ds_read_b128 a[16:19], v24 offset:2048
v_mfma_f32_16x16x32_bf16 v[132:135], a[52:55], a[80:83], v[132:135]
s_cmp_eq_u32 s15, 2
s_cselect_b32 s67, s46, 16777216
v_mfma_f32_16x16x32_bf16 v[136:139], a[56:59], a[80:83], v[136:139]
buffer_load_dword v27, v15, s[24:27], s67 offen
v_mfma_f32_16x16x32_bf16 v[140:143], a[44:47], a[84:87], v[140:143]
v_mfma_f32_16x16x32_bf16 v[144:147], a[48:51], a[84:87], v[144:147]
v_mfma_f32_16x16x32_bf16 v[148:151], a[52:55], a[84:87], v[148:151]
v_mfma_f32_16x16x32_bf16 v[152:155], a[56:59], a[84:87], v[152:155]
s_sub_u32 s15, s15, 1
s_cmp_lg_u32 s15, 0
s_cbranch_scc1 .Lk11
s_waitcnt vmcnt(26) lgkmcnt(0)
s_barrier
v_mfma_f32_16x16x32_bf16 v[60:63], a[20:23], a[0:3], v[60:63]
ds_read_b64_tr_b16 a[64:65], v25 offset:12416
s_add_u32 m0, s56, 66560
v_mfma_f32_16x16x32_bf16 v[64:67], a[20:23], a[4:7], v[64:67]
buffer_load_dwordx4 v18, s[20:23], s54 offen lds
v_mfma_f32_16x16x32_bf16 v[68:71], a[20:23], a[8:11], v[68:71]
ds_read_b64_tr_b16 a[66:67], v25 offset:12928
v_mfma_f32_16x16x32_bf16 v[72:75], a[20:23], a[12:15], v[72:75]
ds_read_b64_tr_b16 a[68:69], v25 offset:12448
ds_read_b64_tr_b16 a[70:71], v25 offset:12960
v_mfma_f32_16x16x32_bf16 v[244:247], a[20:23], a[16:19], v[244:247]
buffer_load_dwordx4 v19, s[20:23], s54 offen offset:1024 lds
v_mfma_f32_16x16x32_bf16 v[76:79], a[24:27], a[0:3], v[76:79]
ds_read_b64_tr_b16 a[72:73], v25 offset:13440
v_mfma_f32_16x16x32_bf16 v[80:83], a[24:27], a[4:7], v[80:83]
ds_read_b64_tr_b16 a[74:75], v25 offset:13952
v_mfma_f32_16x16x32_bf16 v[84:87], a[24:27], a[8:11], v[84:87]
ds_read_b64_tr_b16 a[76:77], v25 offset:13472
ds_read_b64_tr_b16 a[78:79], v25 offset:13984
v_mfma_f32_16x16x32_bf16 v[88:91], a[24:27], a[12:15], v[88:91]
buffer_load_dwordx4 v20, s[20:23], s54 offen offset:2048 lds
v_mfma_f32_16x16x32_bf16 v[92:95], a[28:31], a[0:3], v[92:95]
s_add_u32 s54, s54, 196608
v_mfma_f32_16x16x32_bf16 v[96:99], a[28:31], a[4:7], v[96:99]
ds_read_b128 a[44:47], v23 offset:9216
s_add_u32 m0, s55, 0
v_mfma_f32_16x16x32_bf16 v[100:103], a[28:31], a[8:11], v[100:103]
buffer_load_dwordx4 v21, s[16:19], s52 offen sc1 lds
v_mfma_f32_16x16x32_bf16 v[104:107], a[28:31], a[12:15], v[104:107]
ds_read_b128 a[48:51], v23 offset:10240
v_mfma_f32_16x16x32_bf16 v[156:159], a[28:31], a[16:19], v[156:159]
ds_read_b64_tr_b16 a[80:81], v25 offset:14464
ds_read_b64_tr_b16 a[82:83], v25 offset:14976
v_mfma_f32_16x16x32_bf16 v[108:111], a[32:35], a[0:3], v[108:111]
ds_read_b128 a[52:55], v23 offset:11520
v_mfma_f32_16x16x32_bf16 v[112:115], a[32:35], a[4:7], v[112:115]
buffer_load_dwordx4 v21, s[16:19], s52 offen offset:1024 sc1 lds
v_mfma_f32_16x16x32_bf16 v[116:119], a[32:35], a[8:11], v[116:119]
ds_read_b128 a[56:59], v23 offset:12544
v_mfma_f32_16x16x32_bf16 v[120:123], a[32:35], a[12:15], v[120:123]
ds_read_b64_tr_b16 a[84:85], v25 offset:14496
ds_read_b64_tr_b16 a[86:87], v25 offset:15008
v_mfma_f32_16x16x32_bf16 v[160:163], a[32:35], a[16:19], v[160:163]
buffer_load_dword v22, s[16:19], s52 offen offset:2048 sc1 lds
v_mfma_f32_16x16x32_bf16 v[124:127], a[0:3], a[36:39], v[124:127]
s_add_u32 s52, s52, 0x20000
v_mfma_f32_16x16x32_bf16 v[128:131], a[4:7], a[36:39], v[128:131]
ds_read_b128 a[60:63], v24 offset:11264
v_mfma_f32_16x16x32_bf16 v[132:135], a[8:11], a[36:39], v[132:135]
s_mov_b32 s67, 29360128
v_mfma_f32_16x16x32_bf16 v[136:139], a[12:15], a[36:39], v[136:139]
buffer_load_dwordx4 v[164:167], v26, s[16:19], s67 offen sc1
v_mfma_f32_16x16x32_bf16 v[140:143], a[0:3], a[40:43], v[140:143]
v_mfma_f32_16x16x32_bf16 v[144:147], a[4:7], a[40:43], v[144:147]
v_mfma_f32_16x16x32_bf16 v[148:151], a[8:11], a[40:43], v[148:151]
v_mfma_f32_16x16x32_bf16 v[152:155], a[12:15], a[40:43], v[152:155]
s_waitcnt vmcnt(27) lgkmcnt(0)
s_barrier
v_mfma_f32_16x16x32_bf16 v[60:63], a[64:67], a[44:47], v[60:63]
ds_read_b64_tr_b16 a[20:21], v25 offset:24832
s_add_u32 m0, s56, 78976
v_mfma_f32_16x16x32_bf16 v[64:67], a[64:67], a[48:51], v[64:67]
buffer_load_dwordx4 v18, s[20:23], s54 offen lds
v_mfma_f32_16x16x32_bf16 v[68:71], a[64:67], a[52:55], v[68:71]
ds_read_b64_tr_b16 a[22:23], v25 offset:25344
v_mfma_f32_16x16x32_bf16 v[72:75], a[64:67], a[56:59], v[72:75]
ds_read_b64_tr_b16 a[24:25], v25 offset:24864
ds_read_b64_tr_b16 a[26:27], v25 offset:25376
v_mfma_f32_16x16x32_bf16 v[244:247], a[64:67], a[60:63], v[244:247]
buffer_load_dwordx4 v19, s[20:23], s54 offen offset:1024 lds
v_mfma_f32_16x16x32_bf16 v[76:79], a[68:71], a[44:47], v[76:79]
ds_read_b64_tr_b16 a[28:29], v25 offset:25856
v_mfma_f32_16x16x32_bf16 v[80:83], a[68:71], a[48:51], v[80:83]
ds_read_b64_tr_b16 a[30:31], v25 offset:26368
v_mfma_f32_16x16x32_bf16 v[84:87], a[68:71], a[52:55], v[84:87]
ds_read_b64_tr_b16 a[32:33], v25 offset:25888
ds_read_b64_tr_b16 a[34:35], v25 offset:26400
v_mfma_f32_16x16x32_bf16 v[88:91], a[68:71], a[56:59], v[88:91]
buffer_load_dwordx4 v20, s[20:23], s54 offen offset:2048 lds
v_mfma_f32_16x16x32_bf16 v[92:95], a[72:75], a[44:47], v[92:95]
s_add_u32 s54, s54, 196608
v_mfma_f32_16x16x32_bf16 v[96:99], a[72:75], a[48:51], v[96:99]
ds_read_b128 a[0:3], v23 offset:18432
s_add_u32 m0, s55, 9216
v_mfma_f32_16x16x32_bf16 v[100:103], a[72:75], a[52:55], v[100:103]
buffer_load_dwordx4 v21, s[16:19], s52 offen sc1 lds
v_mfma_f32_16x16x32_bf16 v[104:107], a[72:75], a[56:59], v[104:107]
ds_read_b128 a[4:7], v23 offset:19456
v_mfma_f32_16x16x32_bf16 v[156:159], a[72:75], a[60:63], v[156:159]
ds_read_b64_tr_b16 a[36:37], v25 offset:26880
ds_read_b64_tr_b16 a[38:39], v25 offset:27392
v_mfma_f32_16x16x32_bf16 v[108:111], a[76:79], a[44:47], v[108:111]
ds_read_b128 a[8:11], v23 offset:20736
v_mfma_f32_16x16x32_bf16 v[112:115], a[76:79], a[48:51], v[112:115]
buffer_load_dwordx4 v21, s[16:19], s52 offen offset:1024 sc1 lds
v_mfma_f32_16x16x32_bf16 v[116:119], a[76:79], a[52:55], v[116:119]
ds_read_b128 a[12:15], v23 offset:21760
v_mfma_f32_16x16x32_bf16 v[120:123], a[76:79], a[56:59], v[120:123]
ds_read_b64_tr_b16 a[40:41], v25 offset:26912
ds_read_b64_tr_b16 a[42:43], v25 offset:27424
v_mfma_f32_16x16x32_bf16 v[160:163], a[76:79], a[60:63], v[160:163]
buffer_load_dword v22, s[16:19], s52 offen offset:2048 sc1 lds
v_mfma_f32_16x16x32_bf16 v[124:127], a[44:47], a[80:83], v[124:127]
s_add_u32 s52, s52, 0x20000
v_mfma_f32_16x16x32_bf16 v[128:131], a[48:51], a[80:83], v[128:131]
ds_read_b128 a[16:19], v24 offset:20480
v_mfma_f32_16x16x32_bf16 v[132:135], a[52:55], a[80:83], v[132:135]
v_mfma_f32_16x16x32_bf16 v[136:139], a[56:59], a[80:83], v[136:139]
buffer_load_dwordx4 v[168:171], v26, s[16:19], s67 offen offset:1024 sc1
v_mfma_f32_16x16x32_bf16 v[140:143], a[44:47], a[84:87], v[140:143]
v_mfma_f32_16x16x32_bf16 v[144:147], a[48:51], a[84:87], v[144:147]
v_mfma_f32_16x16x32_bf16 v[148:151], a[52:55], a[84:87], v[148:151]
v_mfma_f32_16x16x32_bf16 v[152:155], a[56:59], a[84:87], v[152:155]
s_waitcnt vmcnt(27) lgkmcnt(0)
s_barrier
v_mfma_f32_16x16x32_bf16 v[60:63], a[20:23], a[0:3], v[60:63]
ds_read_b64_tr_b16 a[64:65], v25 offset:37248
ds_read_b64_tr_b16 a[66:67], v25 offset:37760
v_mfma_f32_16x16x32_bf16 v[64:67], a[20:23], a[4:7], v[64:67]
buffer_load_dwordx4 v[172:175], v26, s[16:19], s67 offen offset:2048 sc1
v_mfma_f32_16x16x32_bf16 v[68:71], a[20:23], a[8:11], v[68:71]
ds_read_b64_tr_b16 a[68:69], v25 offset:37280
v_mfma_f32_16x16x32_bf16 v[72:75], a[20:23], a[12:15], v[72:75]
ds_read_b64_tr_b16 a[70:71], v25 offset:37792
v_mfma_f32_16x16x32_bf16 v[244:247], a[20:23], a[16:19], v[244:247]
ds_read_b64_tr_b16 a[72:73], v25 offset:38272
v_mfma_f32_16x16x32_bf16 v[76:79], a[24:27], a[0:3], v[76:79]
buffer_load_dwordx4 v[176:179], v26, s[16:19], s67 offen offset:3072 sc1
v_mfma_f32_16x16x32_bf16 v[80:83], a[24:27], a[4:7], v[80:83]
ds_read_b64_tr_b16 a[74:75], v25 offset:38784
v_mfma_f32_16x16x32_bf16 v[84:87], a[24:27], a[8:11], v[84:87]
ds_read_b64_tr_b16 a[76:77], v25 offset:38304
v_mfma_f32_16x16x32_bf16 v[88:91], a[24:27], a[12:15], v[88:91]
ds_read_b64_tr_b16 a[78:79], v25 offset:38816
s_mov_b32 s67, 29364224
v_mfma_f32_16x16x32_bf16 v[92:95], a[28:31], a[0:3], v[92:95]
buffer_load_dwordx4 v[180:183], v26, s[16:19], s67 offen sc1
v_mfma_f32_16x16x32_bf16 v[96:99], a[28:31], a[4:7], v[96:99]
ds_read_b128 a[44:47], v23 offset:27648
v_mfma_f32_16x16x32_bf16 v[100:103], a[28:31], a[8:11], v[100:103]
ds_read_b128 a[48:51], v23 offset:28672
v_mfma_f32_16x16x32_bf16 v[104:107], a[28:31], a[12:15], v[104:107]
ds_read_b64_tr_b16 a[80:81], v25 offset:39296
v_mfma_f32_16x16x32_bf16 v[156:159], a[28:31], a[16:19], v[156:159]
buffer_load_dwordx4 v[184:187], v26, s[16:19], s67 offen offset:1024 sc1
v_mfma_f32_16x16x32_bf16 v[108:111], a[32:35], a[0:3], v[108:111]
ds_read_b64_tr_b16 a[82:83], v25 offset:39808
v_mfma_f32_16x16x32_bf16 v[112:115], a[32:35], a[4:7], v[112:115]
ds_read_b128 a[52:55], v23 offset:29952
v_mfma_f32_16x16x32_bf16 v[116:119], a[32:35], a[8:11], v[116:119]
ds_read_b128 a[56:59], v23 offset:30976
v_mfma_f32_16x16x32_bf16 v[120:123], a[32:35], a[12:15], v[120:123]
buffer_load_dwordx4 v[188:191], v26, s[16:19], s67 offen offset:2048 sc1
v_mfma_f32_16x16x32_bf16 v[160:163], a[32:35], a[16:19], v[160:163]
ds_read_b64_tr_b16 a[84:85], v25 offset:39328
v_mfma_f32_16x16x32_bf16 v[124:127], a[0:3], a[36:39], v[124:127]
ds_read_b64_tr_b16 a[86:87], v25 offset:39840
v_mfma_f32_16x16x32_bf16 v[128:131], a[4:7], a[36:39], v[128:131]
ds_read_b128 a[60:63], v24 offset:29696
v_mfma_f32_16x16x32_bf16 v[132:135], a[8:11], a[36:39], v[132:135]
buffer_load_dwordx4 v[192:195], v26, s[16:19], s67 offen offset:3072 sc1
v_mfma_f32_16x16x32_bf16 v[136:139], a[12:15], a[36:39], v[136:139]
v_mfma_f32_16x16x32_bf16 v[140:143], a[0:3], a[40:43], v[140:143]
v_mfma_f32_16x16x32_bf16 v[144:147], a[4:7], a[40:43], v[144:147]
v_mfma_f32_16x16x32_bf16 v[148:151], a[8:11], a[40:43], v[148:151]
v_mfma_f32_16x16x32_bf16 v[152:155], a[12:15], a[40:43], v[152:155]
s_waitcnt vmcnt(27) lgkmcnt(0)
s_barrier
v_mfma_f32_16x16x32_bf16 v[60:63], a[64:67], a[44:47], v[60:63]
ds_read_b64_tr_b16 a[20:21], v25 offset:49664
s_add_u32 m0, s59, 58240
s_mov_b32 s58, 1966080
v_mfma_f32_16x16x32_bf16 v[64:67], a[64:67], a[48:51], v[64:67]
buffer_load_dwordx4 v5, s[24:27], s58 offen lds
v_mfma_f32_16x16x32_bf16 v[68:71], a[64:67], a[52:55], v[68:71]
ds_read_b64_tr_b16 a[22:23], v25 offset:50176
v_mfma_f32_16x16x32_bf16 v[72:75], a[64:67], a[56:59], v[72:75]
ds_read_b64_tr_b16 a[24:25], v25 offset:49696
v_mfma_f32_16x16x32_bf16 v[244:247], a[64:67], a[60:63], v[244:247]
ds_read_b64_tr_b16 a[26:27], v25 offset:50208
ds_read_b64_tr_b16 a[28:29], v25 offset:50688
v_mfma_f32_16x16x32_bf16 v[76:79], a[68:71], a[44:47], v[76:79]
buffer_load_dwordx4 v6, s[24:27], s58 offen offset:1024 lds
v_mfma_f32_16x16x32_bf16 v[80:83], a[68:71], a[48:51], v[80:83]
ds_read_b64_tr_b16 a[30:31], v25 offset:51200
v_mfma_f32_16x16x32_bf16 v[84:87], a[68:71], a[52:55], v[84:87]
ds_read_b64_tr_b16 a[32:33], v25 offset:50720
v_mfma_f32_16x16x32_bf16 v[88:91], a[68:71], a[56:59], v[88:91]
ds_read_b64_tr_b16 a[34:35], v25 offset:51232
s_add_u32 m0, s59, 91520
s_mov_b32 s58, 393216
v_mfma_f32_16x16x32_bf16 v[92:95], a[72:75], a[44:47], v[92:95]
buffer_load_dwordx4 v5, s[24:27], s58 offen lds
v_mfma_f32_16x16x32_bf16 v[96:99], a[72:75], a[48:51], v[96:99]
ds_read_b128 a[0:3], v23 offset:36864
v_mfma_f32_16x16x32_bf16 v[100:103], a[72:75], a[52:55], v[100:103]
ds_read_b128 a[4:7], v23 offset:37888
v_mfma_f32_16x16x32_bf16 v[104:107], a[72:75], a[56:59], v[104:107]
ds_read_b64_tr_b16 a[36:37], v25 offset:51712
v_mfma_f32_16x16x32_bf16 v[156:159], a[72:75], a[60:63], v[156:159]
buffer_load_dwordx4 v6, s[24:27], s58 offen offset:1024 lds
v_mfma_f32_16x16x32_bf16 v[108:111], a[76:79], a[44:47], v[108:111]
ds_read_b64_tr_b16 a[38:39], v25 offset:52224
v_mfma_f32_16x16x32_bf16 v[112:115], a[76:79], a[48:51], v[112:115]
ds_read_b128 a[8:11], v23 offset:39168
v_mfma_f32_16x16x32_bf16 v[116:119], a[76:79], a[52:55], v[116:119]
ds_read_b128 a[12:15], v23 offset:40192
s_add_u32 m0, s59, 24960
.Lpad2:
s_cbranch_execz .Lpad5
s_mov_b32 s58, 1441792
v_mfma_f32_16x16x32_bf16 v[120:123], a[76:79], a[56:59], v[120:123]
buffer_load_dwordx4 v5, s[24:27], s58 offen lds
v_mfma_f32_16x16x32_bf16 v[160:163], a[76:79], a[60:63], v[160:163]
ds_read_b64_tr_b16 a[40:41], v25 offset:51744
v_mfma_f32_16x16x32_bf16 v[124:127], a[44:47], a[80:83], v[124:127]
ds_read_b64_tr_b16 a[42:43], v25 offset:52256
v_mfma_f32_16x16x32_bf16 v[128:131], a[48:51], a[80:83], v[128:131]
ds_read_b128 a[16:19], v24 offset:38912
v_mfma_f32_16x16x32_bf16 v[132:135], a[52:55], a[80:83], v[132:135]
buffer_load_dwordx4 v6, s[24:27], s58 offen offset:1024 lds
v_mfma_f32_16x16x32_bf16 v[136:139], a[56:59], a[80:83], v[136:139]
v_mfma_f32_16x16x32_bf16 v[140:143], a[44:47], a[84:87], v[140:143]
v_mfma_f32_16x16x32_bf16 v[144:147], a[48:51], a[84:87], v[144:147]
v_mfma_f32_16x16x32_bf16 v[148:151], a[52:55], a[84:87], v[148:151]
v_mfma_f32_16x16x32_bf16 v[152:155], a[56:59], a[84:87], v[152:155]
s_waitcnt vmcnt(27) lgkmcnt(0)
s_barrier
v_mfma_f32_16x16x32_bf16 v[60:63], a[20:23], a[0:3], v[60:63]
ds_read_b64_tr_b16 a[64:65], v25 offset:62080
s_add_u32 m0, s59, 99840
s_mov_b32 s58, 524288
v_mfma_f32_16x16x32_bf16 v[64:67], a[20:23], a[4:7], v[64:67]
buffer_load_dwordx4 v5, s[24:27], s58 offen lds
v_mfma_f32_16x16x32_bf16 v[68:71], a[20:23], a[8:11], v[68:71]
ds_read_b64_tr_b16 a[66:67], v25 offset:62592
s_waitcnt vmcnt(10)
v_add_f32 v164, v164, v180
v_mfma_f32_16x16x32_bf16 v[72:75], a[20:23], a[12:15], v[72:75]
ds_read_b64_tr_b16 a[68:69], v25 offset:62112
v_add_f32 v165, v165, v181
v_mfma_f32_16x16x32_bf16 v[244:247], a[20:23], a[16:19], v[244:247]
ds_read_b64_tr_b16 a[70:71], v25 offset:62624
ds_read_b64_tr_b16 a[72:73], v25 offset:63104
v_mfma_f32_16x16x32_bf16 v[76:79], a[24:27], a[0:3], v[76:79]
buffer_load_dwordx4 v6, s[24:27], s58 offen offset:1024 lds
v_mfma_f32_16x16x32_bf16 v[80:83], a[24:27], a[4:7], v[80:83]
ds_read_b64_tr_b16 a[74:75], v25 offset:63616
v_add_f32 v166, v166, v182
v_mfma_f32_16x16x32_bf16 v[84:87], a[24:27], a[8:11], v[84:87]
ds_read_b64_tr_b16 a[76:77], v25 offset:63136
v_mfma_f32_16x16x32_bf16 v[88:91], a[24:27], a[12:15], v[88:91]
ds_read_b64_tr_b16 a[78:79], v25 offset:63648
s_add_u32 m0, s59, 33280
s_mov_b32 s58, 1572864
v_mfma_f32_16x16x32_bf16 v[92:95], a[28:31], a[0:3], v[92:95]
buffer_load_dwordx4 v5, s[24:27], s58 offen lds
v_mfma_f32_16x16x32_bf16 v[96:99], a[28:31], a[4:7], v[96:99]
ds_read_b128 a[44:47], v23 offset:46080
v_add_f32 v167, v167, v183
v_mfma_f32_16x16x32_bf16 v[100:103], a[28:31], a[8:11], v[100:103]
ds_read_b128 a[48:51], v23 offset:47104
s_waitcnt vmcnt(11)
v_add_f32 v168, v168, v184
v_mfma_f32_16x16x32_bf16 v[104:107], a[28:31], a[12:15], v[104:107]
ds_read_b64_tr_b16 a[80:81], v25 offset:64128
v_mfma_f32_16x16x32_bf16 v[156:159], a[28:31], a[16:19], v[156:159]
buffer_load_dwordx4 v6, s[24:27], s58 offen offset:1024 lds
v_mfma_f32_16x16x32_bf16 v[108:111], a[32:35], a[0:3], v[108:111]
ds_read_b64_tr_b16 a[82:83], v25 offset:64640
v_add_f32 v169, v169, v185
v_mfma_f32_16x16x32_bf16 v[112:115], a[32:35], a[4:7], v[112:115]
ds_read_b128 a[52:55], v23 offset:48384
v_add_f32 v170, v170, v186
v_mfma_f32_16x16x32_bf16 v[116:119], a[32:35], a[8:11], v[116:119]
ds_read_b128 a[56:59], v23 offset:49408
s_add_u32 m0, s59, 108160
s_mov_b32 s58, 655360
v_mfma_f32_16x16x32_bf16 v[120:123], a[32:35], a[12:15], v[120:123]
buffer_load_dwordx4 v5, s[24:27], s58 offen lds
v_mfma_f32_16x16x32_bf16 v[160:163], a[32:35], a[16:19], v[160:163]
ds_read_b64_tr_b16 a[84:85], v25 offset:64160
v_mfma_f32_16x16x32_bf16 v[124:127], a[0:3], a[36:39], v[124:127]
ds_read_b64_tr_b16 a[86:87], v25 offset:64672
v_add_f32 v171, v171, v187
v_mfma_f32_16x16x32_bf16 v[128:131], a[4:7], a[36:39], v[128:131]
ds_read_b128 a[60:63], v24 offset:48128
s_waitcnt vmcnt(12)
v_add_f32 v172, v172, v188
v_mfma_f32_16x16x32_bf16 v[132:135], a[8:11], a[36:39], v[132:135]
buffer_load_dwordx4 v6, s[24:27], s58 offen offset:1024 lds
v_mfma_f32_16x16x32_bf16 v[136:139], a[12:15], a[36:39], v[136:139]
v_add_f32 v173, v173, v189
v_mfma_f32_16x16x32_bf16 v[140:143], a[0:3], a[40:43], v[140:143]
v_add_f32 v174, v174, v190
v_add_f32 v175, v175, v191
v_mfma_f32_16x16x32_bf16 v[144:147], a[4:7], a[40:43], v[144:147]
s_waitcnt vmcnt(12)
v_add_f32 v176, v176, v192
v_mfma_f32_16x16x32_bf16 v[148:151], a[8:11], a[40:43], v[148:151]
v_add_f32 v177, v177, v193
v_mfma_f32_16x16x32_bf16 v[152:155], a[12:15], a[40:43], v[152:155]
s_waitcnt lgkmcnt(0)
s_barrier
v_mfma_f32_16x16x32_bf16 v[60:63], a[64:67], a[44:47], v[60:63]
ds_read_b64_tr_b16 a[20:21], v25
s_add_u32 m0, s59, 116480
s_mov_b32 s58, 786432
v_mfma_f32_16x16x32_bf16 v[64:67], a[64:67], a[48:51], v[64:67]
buffer_load_dwordx4 v5, s[24:27], s58 offen lds
v_mfma_f32_16x16x32_bf16 v[68:71], a[64:67], a[52:55], v[68:71]
ds_read_b64_tr_b16 a[22:23], v25 offset:512
v_add_f32 v178, v178, v194
v_mfma_f32_16x16x32_bf16 v[72:75], a[64:67], a[56:59], v[72:75]
ds_read_b64_tr_b16 a[24:25], v25 offset:32
v_add_f32 v179, v179, v195
v_mfma_f32_16x16x32_bf16 v[244:247], a[64:67], a[60:63], v[244:247]
ds_read_b64_tr_b16 a[26:27], v25 offset:544
ds_read_b64_tr_b16 a[28:29], v25 offset:1024
v_mfma_f32_16x16x32_bf16 v[76:79], a[68:71], a[44:47], v[76:79]
buffer_load_dwordx4 v6, s[24:27], s58 offen offset:1024 lds
v_mfma_f32_16x16x32_bf16 v[80:83], a[68:71], a[48:51], v[80:83]
ds_read_b64_tr_b16 a[30:31], v25 offset:1536
v_add_f32 v164, v164, v172
v_mfma_f32_16x16x32_bf16 v[84:87], a[68:71], a[52:55], v[84:87]
ds_read_b64_tr_b16 a[32:33], v25 offset:1056
v_mfma_f32_16x16x32_bf16 v[88:91], a[68:71], a[56:59], v[88:91]
ds_read_b64_tr_b16 a[34:35], v25 offset:1568
s_add_u32 m0, s59, 41600
s_mov_b32 s58, 1703936
v_mfma_f32_16x16x32_bf16 v[92:95], a[72:75], a[44:47], v[92:95]
buffer_load_dwordx4 v5, s[24:27], s58 offen lds
v_mfma_f32_16x16x32_bf16 v[96:99], a[72:75], a[48:51], v[96:99]
ds_read_b128 a[0:3], v23
v_add_f32 v165, v165, v173
v_mfma_f32_16x16x32_bf16 v[100:103], a[72:75], a[52:55], v[100:103]
ds_read_b128 a[4:7], v23 offset:1024
v_add_f32 v166, v166, v174
v_mfma_f32_16x16x32_bf16 v[104:107], a[72:75], a[56:59], v[104:107]
ds_read_b64_tr_b16 a[36:37], v25 offset:2048
v_mfma_f32_16x16x32_bf16 v[156:159], a[72:75], a[60:63], v[156:159]
buffer_load_dwordx4 v6, s[24:27], s58 offen offset:1024 lds
v_mfma_f32_16x16x32_bf16 v[108:111], a[76:79], a[44:47], v[108:111]
ds_read_b64_tr_b16 a[38:39], v25 offset:2560
v_add_f32 v167, v167, v175
v_mfma_f32_16x16x32_bf16 v[112:115], a[76:79], a[48:51], v[112:115]
ds_read_b128 a[8:11], v23 offset:2304
v_add_f32 v168, v168, v176
v_mfma_f32_16x16x32_bf16 v[116:119], a[76:79], a[52:55], v[116:119]
ds_read_b128 a[12:15], v23 offset:3328
s_add_u32 m0, s59, 49920
s_mov_b32 s58, 1835008
v_mfma_f32_16x16x32_bf16 v[120:123], a[76:79], a[56:59], v[120:123]
buffer_load_dwordx4 v5, s[24:27], s58 offen lds
v_mfma_f32_16x16x32_bf16 v[160:163], a[76:79], a[60:63], v[160:163]
ds_read_b64_tr_b16 a[40:41], v25 offset:2080
v_mfma_f32_16x16x32_bf16 v[124:127], a[44:47], a[80:83], v[124:127]
ds_read_b64_tr_b16 a[42:43], v25 offset:2592
v_add_f32 v169, v169, v177
v_mfma_f32_16x16x32_bf16 v[128:131], a[48:51], a[80:83], v[128:131]
ds_read_b128 a[16:19], v24 offset:2048
v_add_f32 v170, v170, v178
v_mfma_f32_16x16x32_bf16 v[132:135], a[52:55], a[80:83], v[132:135]
buffer_load_dwordx4 v6, s[24:27], s58 offen offset:1024 lds
v_mfma_f32_16x16x32_bf16 v[136:139], a[56:59], a[80:83], v[136:139]
v_add_f32 v171, v171, v179
v_mfma_f32_16x16x32_bf16 v[140:143], a[44:47], a[84:87], v[140:143]
v_add_f32 v164, v164, v168
v_add_f32 v165, v165, v169
v_mfma_f32_16x16x32_bf16 v[144:147], a[48:51], a[84:87], v[144:147]
v_add_f32 v166, v166, v170
v_mfma_f32_16x16x32_bf16 v[148:151], a[52:55], a[84:87], v[148:151]
v_add_f32 v167, v167, v171
v_mfma_f32_16x16x32_bf16 v[152:155], a[56:59], a[84:87], v[152:155]
s_waitcnt lgkmcnt(0)
s_barrier
v_mfma_f32_16x16x32_bf16 v[60:63], a[20:23], a[0:3], v[60:63]
ds_read_b64_tr_b16 a[64:65], v25 offset:12416
s_add_u32 m0, s59, 124800
s_mov_b32 s58, 917504
v_mfma_f32_16x16x32_bf16 v[64:67], a[20:23], a[4:7], v[64:67]
buffer_load_dwordx4 v5, s[24:27], s58 offen lds
v_mfma_f32_16x16x32_bf16 v[68:71], a[20:23], a[8:11], v[68:71]
ds_read_b64_tr_b16 a[66:67], v25 offset:12928
v_permlane32_swap_b32 v164, v166
v_mfma_f32_16x16x32_bf16 v[72:75], a[20:23], a[12:15], v[72:75]
ds_read_b64_tr_b16 a[68:69], v25 offset:12448
v_permlane32_swap_b32 v165, v167
v_mfma_f32_16x16x32_bf16 v[244:247], a[20:23], a[16:19], v[244:247]
ds_read_b64_tr_b16 a[70:71], v25 offset:12960
v_mfma_f32_16x16x32_bf16 v[76:79], a[24:27], a[0:3], v[76:79]
ds_read_b64_tr_b16 a[72:73], v25 offset:13440
v_add_f32 v164, v164, v166
v_mfma_f32_16x16x32_bf16 v[80:83], a[24:27], a[4:7], v[80:83]
ds_read_b64_tr_b16 a[74:75], v25 offset:13952
v_mfma_f32_16x16x32_bf16 v[84:87], a[24:27], a[8:11], v[84:87]
buffer_load_dwordx4 v6, s[24:27], s58 offen offset:1024 lds
v_mfma_f32_16x16x32_bf16 v[88:91], a[24:27], a[12:15], v[88:91]
ds_read_b64_tr_b16 a[76:77], v25 offset:13472
v_add_f32 v165, v165, v167
v_mfma_f32_16x16x32_bf16 v[92:95], a[28:31], a[0:3], v[92:95]
ds_read_b64_tr_b16 a[78:79], v25 offset:13984
v_mul_f32 v164, 0xba800000, v164
v_mfma_f32_16x16x32_bf16 v[96:99], a[28:31], a[4:7], v[96:99]
ds_read_b128 a[44:47], v23 offset:9216
ds_read_b128 a[48:51], v23 offset:10240
v_mfma_f32_16x16x32_bf16 v[100:103], a[28:31], a[8:11], v[100:103]
ds_read_b64_tr_b16 a[80:81], v25 offset:14464
v_mfma_f32_16x16x32_bf16 v[104:107], a[28:31], a[12:15], v[104:107]
s_add_u32 m0, s59, 0
s_mov_b32 s58, 1048576
v_mul_f32 v165, 0x3a800000, v165
v_mfma_f32_16x16x32_bf16 v[156:159], a[28:31], a[16:19], v[156:159]
buffer_load_dwordx4 v5, s[24:27], s58 offen lds
v_mfma_f32_16x16x32_bf16 v[108:111], a[32:35], a[0:3], v[108:111]
ds_read_b64_tr_b16 a[82:83], v25 offset:14976
v_mfma_f32_16x16x32_bf16 v[112:115], a[32:35], a[4:7], v[112:115]
ds_read_b128 a[52:55], v23 offset:11520
v_fma_f32 v165, -v164, v164, v165
v_mfma_f32_16x16x32_bf16 v[116:119], a[32:35], a[8:11], v[116:119]
ds_read_b128 a[56:59], v23 offset:12544
v_max_f32 v165, 0, v165
v_mfma_f32_16x16x32_bf16 v[120:123], a[32:35], a[12:15], v[120:123]
ds_read_b64_tr_b16 a[84:85], v25 offset:14496
v_mfma_f32_16x16x32_bf16 v[160:163], a[32:35], a[16:19], v[160:163]
ds_read_b64_tr_b16 a[86:87], v25 offset:15008
v_add_f32 v165, 0x3727c5ac, v165
v_mfma_f32_16x16x32_bf16 v[124:127], a[0:3], a[36:39], v[124:127]
buffer_load_dwordx4 v6, s[24:27], s58 offen offset:1024 lds
v_mfma_f32_16x16x32_bf16 v[128:131], a[4:7], a[36:39], v[128:131]
ds_read_b128 a[60:63], v24 offset:11264
v_mfma_f32_16x16x32_bf16 v[132:135], a[8:11], a[36:39], v[132:135]
v_rsq_f32 v166, v165
s_nop 0
v_mov_b32 v165, v166
v_mfma_f32_16x16x32_bf16 v[136:139], a[12:15], a[36:39], v[136:139]
v_mul_f32 v166, 0x3e8293ee, v166
v_mfma_f32_16x16x32_bf16 v[140:143], a[0:3], a[40:43], v[140:143]
ds_write_b128 v7, v[164:167]
v_mfma_f32_16x16x32_bf16 v[144:147], a[4:7], a[40:43], v[144:147]
ds_write_b32 v17, v164
v_mfma_f32_16x16x32_bf16 v[148:151], a[8:11], a[40:43], v[148:151]
ds_write_b32 v17, v165 offset:1024
v_mfma_f32_16x16x32_bf16 v[152:155], a[12:15], a[40:43], v[152:155]
s_waitcnt lgkmcnt(0)
s_barrier
v_mfma_f32_16x16x32_bf16 v[244:247], a[64:67], a[60:63], v[244:247]
ds_read_b128 v[232:235], v10 offset:768
v_mfma_f32_16x16x32_bf16 v[156:159], a[72:75], a[60:63], v[156:159]
ds_read_b128 v[236:239], v10 offset:2816
v_mfma_f32_16x16x32_bf16 v[160:163], a[76:79], a[60:63], v[160:163]
ds_read_b128 v[228:231], v10 offset:512
v_mfma_f32_16x16x32_bf16 v[104:107], a[72:75], a[56:59], v[104:107]
ds_read_b128 v[224:227], v10 offset:256
v_mfma_f32_16x16x32_bf16 v[120:123], a[76:79], a[56:59], v[120:123]
ds_read_b128 v[220:223], v10
v_mfma_f32_16x16x32_bf16 v[136:139], a[56:59], a[80:83], v[136:139]
v_mfma_f32_16x16x32_bf16 v[152:155], a[56:59], a[84:87], v[152:155]
v_mfma_f32_16x16x32_bf16 v[100:103], a[72:75], a[52:55], v[100:103]
v_mfma_f32_16x16x32_bf16 v[116:119], a[76:79], a[52:55], v[116:119]
s_mov_b32 exec_lo, 0x10001
s_mov_b32 exec_hi, 0x10001
ds_write_b128 v13, v[244:247]
ds_write_b128 v13, v[156:159] offset:256
ds_write_b128 v13, v[160:163] offset:320
s_mov_b64 exec, -1
v_mfma_f32_16x16x32_bf16 v[96:99], a[72:75], a[48:51], v[96:99]
v_mfma_f32_16x16x32_bf16 v[112:115], a[76:79], a[48:51], v[112:115]
v_mfma_f32_16x16x32_bf16 v[92:95], a[72:75], a[44:47], v[92:95]
v_mfma_f32_16x16x32_bf16 v[108:111], a[76:79], a[44:47], v[108:111]
v_mfma_f32_16x16x32_bf16 v[72:75], a[64:67], a[56:59], v[72:75]
v_mfma_f32_16x16x32_bf16 v[88:91], a[68:71], a[56:59], v[88:91]
s_waitcnt lgkmcnt(0)
s_barrier
v_mfma_f32_16x16x32_bf16 v[132:135], a[52:55], a[80:83], v[132:135]
ds_read_b128 v[28:31], v13
s_add_u32 m0, s59, 66560
v_mfma_f32_16x16x32_bf16 v[148:151], a[52:55], a[84:87], v[148:151]
ds_read_b128 v[32:35], v13 offset:64
s_mov_b32 s58, 0
v_mfma_f32_16x16x32_bf16 v[68:71], a[64:67], a[52:55], v[68:71]
ds_read_b128 v[36:39], v13 offset:256
s_mov_b32 s67, 917504
v_mfma_f32_16x16x32_bf16 v[84:87], a[68:71], a[52:55], v[84:87]
ds_read_b128 v[40:43], v13 offset:320
v_mfma_f32_16x16x32_bf16 v[128:131], a[48:51], a[80:83], v[128:131]
ds_read_b32 v44, v12 offset:512
v_mfma_f32_16x16x32_bf16 v[144:147], a[48:51], a[84:87], v[144:147]
ds_read_b32 v45, v12 offset:576
v_mfma_f32_16x16x32_bf16 v[64:67], a[64:67], a[48:51], v[64:67]
ds_read_b128 v[240:243], v11 offset:192
v_mfma_f32_16x16x32_bf16 v[80:83], a[68:71], a[48:51], v[80:83]
ds_read_b128 v[244:247], v11 offset:1216
buffer_load_dwordx4 v5, s[24:27], s58 offen lds
ds_read_b128 v[18:21], v11 offset:128
s_waitcnt lgkmcnt(8)
v_pk_fma_f32 v[72:73], v[28:29], v[232:233], v[72:73] op_sel_hi:[1,0,1]
v_cvt_pk_bf16_f32 v176, v72, v73
v_pk_fma_f32 v[74:75], v[30:31], v[232:233], v[74:75] op_sel_hi:[1,0,1]
v_cvt_pk_bf16_f32 v177, v74, v75
s_waitcnt lgkmcnt(7)
v_pk_fma_f32 v[88:89], v[32:33], v[232:233], v[88:89] op_sel_hi:[1,0,1]
s_waitcnt lgkmcnt(6)
v_pk_fma_f32 v[104:105], v[36:37], v[232:233], v[104:105] op_sel_hi:[1,0,1]
v_pk_mul_f32 v[104:105], v[104:105], v[232:233] op_sel:[0,1] op_sel_hi:[1,1]
v_cvt_pk_bf16_f32 v196, v104, v105
v_pk_fma_f32 v[106:107], v[38:39], v[232:233], v[106:107] op_sel_hi:[1,0,1]
v_pk_mul_f32 v[106:107], v[106:107], v[232:233] op_sel:[0,1] op_sel_hi:[1,1]
v_cvt_pk_bf16_f32 v197, v106, v107
s_waitcnt lgkmcnt(5)
v_pk_fma_f32 v[120:121], v[40:41], v[232:233], v[120:121] op_sel_hi:[1,0,1]
v_pk_mul_f32 v[120:121], v[120:121], v[232:233] op_sel:[0,1] op_sel_hi:[1,1]
v_cvt_pk_bf16_f32 v198, v120, v121
v_pk_fma_f32 v[122:123], v[42:43], v[232:233], v[122:123] op_sel_hi:[1,0,1]
v_pk_mul_f32 v[122:123], v[122:123], v[232:233] op_sel:[0,1] op_sel_hi:[1,1]
v_cvt_pk_bf16_f32 v199, v122, v123
ds_write_b128 v8, v[196:199]
buffer_load_dwordx4 v6, s[24:27], s58 offen offset:1024 lds
s_waitcnt lgkmcnt(3)
v_pk_fma_f32 v[136:137], v[240:241], v[44:45], v[136:137] op_sel_hi:[1,0,1]
v_pk_fma_f32 v[138:139], v[242:243], v[44:45], v[138:139] op_sel_hi:[1,0,1]
v_pk_fma_f32 v[152:153], v[240:241], v[44:45], v[152:153] op_sel:[0,1,0] op_sel_hi:[1,1,1]
s_waitcnt lgkmcnt(2)
v_pk_mul_f32 v[136:137], v[136:137], v[244:245]
v_cvt_pk_bf16_f32 v208, v136, v137
v_pk_mul_f32 v[138:139], v[138:139], v[246:247]
v_cvt_pk_bf16_f32 v209, v138, v139
v_pk_mul_f32 v[152:153], v[152:153], v[244:245]
v_cvt_pk_bf16_f32 v218, v152, v153
v_pk_fma_f32 v[154:155], v[242:243], v[44:45], v[154:155] op_sel:[0,1,0] op_sel_hi:[1,1,1]
v_pk_mul_f32 v[154:155], v[154:155], v[246:247]
v_cvt_pk_bf16_f32 v219, v154, v155
ds_write_b64 v8, v[208:209] offset:1024
ds_write_b64 v8, v[218:219] offset:1032
s_add_u32 m0, s59, 8320
s_mov_b32 s58, 1179648
buffer_load_dwordx4 v5, s[24:27], s58 offen lds
v_pk_fma_f32 v[100:101], v[36:37], v[228:229], v[100:101] op_sel_hi:[1,0,1]
v_pk_mul_f32 v[100:101], v[100:101], v[228:229] op_sel:[0,1] op_sel_hi:[1,1]
v_cvt_pk_bf16_f32 v192, v100, v101
v_pk_fma_f32 v[102:103], v[38:39], v[228:229], v[102:103] op_sel_hi:[1,0,1]
v_pk_mul_f32 v[102:103], v[102:103], v[228:229] op_sel:[0,1] op_sel_hi:[1,1]
v_cvt_pk_bf16_f32 v193, v102, v103
v_pk_fma_f32 v[116:117], v[40:41], v[228:229], v[116:117] op_sel_hi:[1,0,1]
v_pk_mul_f32 v[116:117], v[116:117], v[228:229] op_sel:[0,1] op_sel_hi:[1,1]
v_cvt_pk_bf16_f32 v194, v116, v117
v_pk_fma_f32 v[118:119], v[42:43], v[228:229], v[118:119] op_sel_hi:[1,0,1]
v_pk_mul_f32 v[118:119], v[118:119], v[228:229] op_sel:[0,1] op_sel_hi:[1,1]
v_cvt_pk_bf16_f32 v195, v118, v119
v_cvt_pk_bf16_f32 v178, v88, v89
buffer_load_dwordx4 v6, s[24:27], s58 offen offset:1024 lds
s_add_u32 m0, s59, 16640
s_mov_b32 s58, 1310720
v_pk_fma_f32 v[90:91], v[34:35], v[232:233], v[90:91] op_sel_hi:[1,0,1]
v_cvt_pk_bf16_f32 v179, v90, v91
ds_read_b128 v[22:25], v11 offset:1152
s_waitcnt lgkmcnt(4)
v_pk_fma_f32 v[132:133], v[18:19], v[44:45], v[132:133] op_sel_hi:[1,0,1]
v_pk_fma_f32 v[134:135], v[20:21], v[44:45], v[134:135] op_sel_hi:[1,0,1]
v_pk_fma_f32 v[148:149], v[18:19], v[44:45], v[148:149] op_sel:[0,1,0] op_sel_hi:[1,1,1]
s_waitcnt lgkmcnt(1)
s_barrier
ds_read_b64 v[200:201], v9 offset:1024
ds_read_b64 v[210:211], v9 offset:1032
buffer_load_dwordx4 v5, s[24:27], s58 offen lds
v_pk_fma_f32 v[150:151], v[20:21], v[44:45], v[150:151] op_sel:[0,1,0] op_sel_hi:[1,1,1]
v_pk_fma_f32 v[96:97], v[36:37], v[224:225], v[96:97] op_sel_hi:[1,0,1]
v_pk_mul_f32 v[96:97], v[96:97], v[224:225] op_sel:[0,1] op_sel_hi:[1,1]
v_cvt_pk_bf16_f32 v188, v96, v97
v_pk_fma_f32 v[98:99], v[38:39], v[224:225], v[98:99] op_sel_hi:[1,0,1]
v_pk_mul_f32 v[98:99], v[98:99], v[224:225] op_sel:[0,1] op_sel_hi:[1,1]
v_cvt_pk_bf16_f32 v189, v98, v99
v_pk_fma_f32 v[112:113], v[40:41], v[224:225], v[112:113] op_sel_hi:[1,0,1]
v_pk_mul_f32 v[112:113], v[112:113], v[224:225] op_sel:[0,1] op_sel_hi:[1,1]
v_cvt_pk_bf16_f32 v190, v112, v113
v_pk_fma_f32 v[114:115], v[42:43], v[224:225], v[114:115] op_sel_hi:[1,0,1]
v_pk_mul_f32 v[114:115], v[114:115], v[224:225] op_sel:[0,1] op_sel_hi:[1,1]
v_cvt_pk_bf16_f32 v191, v114, v115
buffer_load_dwordx4 v6, s[24:27], s58 offen offset:1024 lds
s_add_u32 m0, s59, 74880
s_mov_b32 s58, 131072
v_pk_fma_f32 v[68:69], v[28:29], v[228:229], v[68:69] op_sel_hi:[1,0,1]
s_waitcnt lgkmcnt(2)
v_pk_mul_f32 v[132:133], v[132:133], v[22:23]
v_cvt_pk_bf16_f32 v206, v132, v133
v_pk_mul_f32 v[134:135], v[134:135], v[24:25]
v_cvt_pk_bf16_f32 v207, v134, v135
v_pk_mul_f32 v[148:149], v[148:149], v[22:23]
v_cvt_pk_bf16_f32 v216, v148, v149
v_pk_mul_f32 v[150:151], v[150:151], v[24:25]
v_cvt_pk_bf16_f32 v217, v150, v151
v_cvt_pk_bf16_f32 v172, v68, v69
v_pk_fma_f32 v[70:71], v[30:31], v[228:229], v[70:71] op_sel_hi:[1,0,1]
buffer_load_dwordx4 v5, s[24:27], s58 offen lds
v_cvt_pk_bf16_f32 v173, v70, v71
v_pk_fma_f32 v[84:85], v[32:33], v[228:229], v[84:85] op_sel_hi:[1,0,1]
v_cvt_pk_bf16_f32 v174, v84, v85
v_pk_fma_f32 v[86:87], v[34:35], v[228:229], v[86:87] op_sel_hi:[1,0,1]
v_cvt_pk_bf16_f32 v175, v86, v87
ds_read_b128 v[240:243], v11 offset:64
ds_read_b128 v[244:247], v11 offset:1088
v_pk_fma_f32 v[92:93], v[36:37], v[220:221], v[92:93] op_sel_hi:[1,0,1]
v_pk_mul_f32 v[92:93], v[92:93], v[220:221] op_sel:[0,1] op_sel_hi:[1,1]
v_cvt_pk_bf16_f32 v184, v92, v93
v_pk_fma_f32 v[94:95], v[38:39], v[220:221], v[94:95] op_sel_hi:[1,0,1]
buffer_load_dwordx4 v6, s[24:27], s58 offen offset:1024 lds
s_add_u32 m0, s59, 83200
s_mov_b32 s58, 262144
v_pk_mul_f32 v[94:95], v[94:95], v[220:221] op_sel:[0,1] op_sel_hi:[1,1]
v_cvt_pk_bf16_f32 v185, v94, v95
v_pk_fma_f32 v[108:109], v[40:41], v[220:221], v[108:109] op_sel_hi:[1,0,1]
v_pk_mul_f32 v[108:109], v[108:109], v[220:221] op_sel:[0,1] op_sel_hi:[1,1]
v_cvt_pk_bf16_f32 v186, v108, v109
v_pk_fma_f32 v[110:111], v[42:43], v[220:221], v[110:111] op_sel_hi:[1,0,1]
v_pk_mul_f32 v[110:111], v[110:111], v[220:221] op_sel:[0,1] op_sel_hi:[1,1]
v_cvt_pk_bf16_f32 v187, v110, v111
v_pk_fma_f32 v[64:65], v[28:29], v[224:225], v[64:65] op_sel_hi:[1,0,1]
v_cvt_pk_bf16_f32 v168, v64, v65
v_pk_fma_f32 v[66:67], v[30:31], v[224:225], v[66:67] op_sel_hi:[1,0,1]
buffer_load_dwordx4 v5, s[24:27], s58 offen lds
v_cvt_pk_bf16_f32 v169, v66, v67
v_pk_fma_f32 v[80:81], v[32:33], v[224:225], v[80:81] op_sel_hi:[1,0,1]
v_cvt_pk_bf16_f32 v170, v80, v81
v_pk_fma_f32 v[82:83], v[34:35], v[224:225], v[82:83] op_sel_hi:[1,0,1]
v_cvt_pk_bf16_f32 v171, v82, v83
s_waitcnt lgkmcnt(1)
v_pk_fma_f32 v[128:129], v[240:241], v[44:45], v[128:129] op_sel_hi:[1,0,1]
v_pk_fma_f32 v[130:131], v[242:243], v[44:45], v[130:131] op_sel_hi:[1,0,1]
s_waitcnt lgkmcnt(0)
v_pk_mul_f32 v[128:129], v[128:129], v[244:245]
v_cvt_pk_bf16_f32 v204, v128, v129
v_pk_mul_f32 v[130:131], v[130:131], v[246:247]
v_cvt_pk_bf16_f32 v205, v130, v131
v_pk_fma_f32 v[144:145], v[240:241], v[44:45], v[144:145] op_sel:[0,1,0] op_sel_hi:[1,1,1]
v_pk_mul_f32 v[144:145], v[144:145], v[244:245]
buffer_load_dwordx4 v6, s[24:27], s58 offen offset:1024 lds
v_cvt_pk_bf16_f32 v214, v144, v145
v_pk_fma_f32 v[146:147], v[242:243], v[44:45], v[146:147] op_sel:[0,1,0] op_sel_hi:[1,1,1]
v_pk_mul_f32 v[146:147], v[146:147], v[246:247]
v_cvt_pk_bf16_f32 v215, v146, v147
ds_read_b128 v[18:21], v11
ds_read_b128 v[22:25], v11 offset:1024
v_pk_fma_f32 v[156:157], v[36:37], v[236:237], v[156:157] op_sel_hi:[1,0,1]
v_pk_mul_f32 v[156:157], v[156:157], v[236:237] op_sel:[0,1] op_sel_hi:[1,1]
v_cvt_pk_bf16_f32 v180, v156, v157
v_pk_fma_f32 v[158:159], v[38:39], v[236:237], v[158:159] op_sel_hi:[1,0,1]
v_pk_mul_f32 v[158:159], v[158:159], v[236:237] op_sel:[0,1] op_sel_hi:[1,1]
buffer_load_dword v27, v16, s[32:35], 0 offen
v_cvt_pk_bf16_f32 v181, v158, v159
v_pk_fma_f32 v[160:161], v[40:41], v[236:237], v[160:161] op_sel_hi:[1,0,1]
v_pk_mul_f32 v[160:161], v[160:161], v[236:237] op_sel:[0,1] op_sel_hi:[1,1]
v_cvt_pk_bf16_f32 v182, v160, v161
v_pk_fma_f32 v[162:163], v[42:43], v[236:237], v[162:163] op_sel_hi:[1,0,1]
v_pk_mul_f32 v[162:163], v[162:163], v[236:237] op_sel:[0,1] op_sel_hi:[1,1]
s_nop 1
v_mfma_f32_16x16x32_bf16 v[124:127], a[44:47], a[80:83], v[124:127]
v_cvt_pk_bf16_f32 v183, v162, v163
v_mfma_f32_16x16x32_bf16 v[140:143], a[44:47], a[84:87], v[140:143]
buffer_load_dword v27, v16, s[32:35], s67 offen
v_mfma_f32_16x16x32_bf16 v[60:63], a[64:67], a[44:47], v[60:63]
v_mfma_f32_16x16x32_bf16 v[76:79], a[68:71], a[44:47], v[76:79]
v_mfma_f32_16x16x32_bf16 v[104:107], v[192:195], v[176:179], v[46:49]
s_nop 0
s_waitcnt lgkmcnt(1)
v_pk_fma_f32 v[124:125], v[18:19], v[44:45], v[124:125] op_sel_hi:[1,0,1]
s_waitcnt lgkmcnt(0)
v_pk_mul_f32 v[124:125], v[124:125], v[22:23]
s_nop 2
v_max3_f32 v88, v104, v105, v106
v_cvt_pk_bf16_f32 v202, v124, v125
v_pk_fma_f32 v[126:127], v[20:21], v[44:45], v[126:127] op_sel_hi:[1,0,1]
v_pk_mul_f32 v[126:127], v[126:127], v[24:25]
v_cvt_pk_bf16_f32 v203, v126, v127
v_pk_fma_f32 v[140:141], v[18:19], v[44:45], v[140:141] op_sel:[0,1,0] op_sel_hi:[1,1,1]
v_pk_mul_f32 v[140:141], v[140:141], v[22:23]
v_cvt_pk_bf16_f32 v212, v140, v141
v_pk_fma_f32 v[142:143], v[20:21], v[44:45], v[142:143] op_sel:[0,1,0] op_sel_hi:[1,1,1]
v_pk_mul_f32 v[142:143], v[142:143], v[24:25]
v_cvt_pk_bf16_f32 v213, v142, v143
v_pk_fma_f32 v[60:61], v[28:29], v[220:221], v[60:61] op_sel_hi:[1,0,1]
v_cvt_pk_bf16_f32 v164, v60, v61
v_pk_fma_f32 v[62:63], v[30:31], v[220:221], v[62:63] op_sel_hi:[1,0,1]
v_cvt_pk_bf16_f32 v165, v62, v63
v_pk_fma_f32 v[76:77], v[32:33], v[220:221], v[76:77] op_sel_hi:[1,0,1]
v_cvt_pk_bf16_f32 v166, v76, v77
v_pk_fma_f32 v[78:79], v[34:35], v[220:221], v[78:79] op_sel_hi:[1,0,1]
s_nop 1
v_mfma_f32_16x16x32_bf16 v[120:123], v[196:199], v[176:179], v[50:53]
v_cvt_pk_bf16_f32 v167, v78, v79
v_mfma_f32_16x16x32_bf16 v[100:103], v[188:191], v[172:175], v[46:49]
v_mfma_f32_16x16x32_bf16 v[116:119], v[192:195], v[172:175], v[50:53]
s_nop 4
v_max3_f32 v89, v107, v120, v121
v_max3_f32 v88, v88, v122, v123
v_mfma_f32_16x16x32_bf16 v[96:99], v[184:187], v[168:171], v[46:49]
v_max_f32 v90, v88, v89
v_max_f32 v89, v88, v89
v_mfma_f32_16x16x32_bf16 v[112:115], v[188:191], v[168:171], v[50:53]
s_nop 0
v_permlane16_swap_b32 v90, v89
v_max3_f32 v84, v100, v101, v102
v_mfma_f32_16x16x32_bf16 v[92:95], v[180:183], v[164:167], v[54:57]
v_max_f32 v88, v90, v89
v_max_f32 v89, v90, v89
v_mfma_f32_16x16x32_bf16 v[108:111], v[184:187], v[164:167], v[50:53]
s_nop 0
v_permlane32_swap_b32 v88, v89
v_max3_f32 v85, v103, v116, v117
v_max3_f32 v84, v84, v118, v119
v_max_f32 v88, v88, v89
v_mul_f32 v88, v88, v234
v_pk_fma_f32 v[104:105], v[104:105], v[234:235], v[88:89] op_sel_hi:[1,0,0] neg_lo:[0,0,1] neg_hi:[0,0,1]
v_exp_f32 v104, v104
v_pk_fma_f32 v[106:107], v[106:107], v[234:235], v[88:89] op_sel_hi:[1,0,0] neg_lo:[0,0,1] neg_hi:[0,0,1]
v_exp_f32 v105, v105
v_pk_fma_f32 v[120:121], v[120:121], v[234:235], v[88:89] op_sel_hi:[1,0,0] neg_lo:[0,0,1] neg_hi:[0,0,1]
v_exp_f32 v106, v106
v_pk_fma_f32 v[122:123], v[122:123], v[234:235], v[88:89] op_sel_hi:[1,0,0] neg_lo:[0,0,1] neg_hi:[0,0,1]
v_exp_f32 v107, v107
v_cvt_pk_bf16_f32 v72, v104, v105
v_exp_f32 v120, v120
v_cvt_pk_bf16_f32 v73, v106, v107
v_exp_f32 v121, v121
v_max_f32 v86, v84, v85
v_exp_f32 v122, v122
v_cvt_pk_bf16_f32 v74, v120, v121
v_exp_f32 v123, v123
v_max_f32 v85, v84, v85
v_max3_f32 v80, v96, v97, v98
v_cvt_pk_bf16_f32 v75, v122, v123
v_permlane16_swap_b32 v86, v85
v_max3_f32 v81, v99, v112, v113
v_mfma_f32_16x16x32_bf16 v[88:91], v[248:251], v[72:75], 0
v_max_f32 v84, v86, v85
v_max_f32 v85, v86, v85
v_mfma_f32_16x16x32_bf16 v[104:107], v[206:209], v[72:75], 0
s_nop 0
v_permlane32_swap_b32 v84, v85
v_max3_f32 v80, v80, v114, v115
v_mfma_f32_16x16x32_bf16 v[120:123], v[216:219], v[72:75], 0
s_nop 0
v_rcp_f32 v88, v88
v_max_f32 v84, v84, v85
v_mul_f32 v84, v84, v230
v_max_f32 v82, v80, v81
v_max_f32 v81, v80, v81
v_pk_mul_f32 v[104:105], v[104:105], v[88:89] op_sel_hi:[1,0]
v_pk_mul_f32 v[106:107], v[106:107], v[88:89] op_sel_hi:[1,0]
v_permlane16_swap_b32 v82, v81
v_pk_mul_f32 v[120:121], v[120:121], v[88:89] op_sel_hi:[1,0]
v_pk_mul_f32 v[122:123], v[122:123], v[88:89] op_sel_hi:[1,0]
v_cvt_pk_bf16_f32 v176, v104, v105
v_cvt_pk_bf16_f32 v177, v106, v107
v_cvt_pk_bf16_f32 v178, v120, v121
v_cvt_pk_bf16_f32 v179, v122, v123
buffer_store_dwordx4 v[176:179], v4, s[16:19], s74 offen offset:3072 sc1
v_pk_fma_f32 v[100:101], v[100:101], v[230:231], v[84:85] op_sel_hi:[1,0,0] neg_lo:[0,0,1] neg_hi:[0,0,1]
v_exp_f32 v100, v100
v_pk_fma_f32 v[102:103], v[102:103], v[230:231], v[84:85] op_sel_hi:[1,0,0] neg_lo:[0,0,1] neg_hi:[0,0,1]
v_exp_f32 v101, v101
v_pk_fma_f32 v[116:117], v[116:117], v[230:231], v[84:85] op_sel_hi:[1,0,0] neg_lo:[0,0,1] neg_hi:[0,0,1]
v_exp_f32 v102, v102
v_pk_fma_f32 v[118:119], v[118:119], v[230:231], v[84:85] op_sel_hi:[1,0,0] neg_lo:[0,0,1] neg_hi:[0,0,1]
v_exp_f32 v103, v103
v_cvt_pk_bf16_f32 v68, v100, v101
v_exp_f32 v116, v116
v_cvt_pk_bf16_f32 v69, v102, v103
v_exp_f32 v117, v117
v_max_f32 v80, v82, v81
v_exp_f32 v118, v118
v_cvt_pk_bf16_f32 v70, v116, v117
v_exp_f32 v119, v119
v_max_f32 v81, v82, v81
v_max3_f32 v76, v92, v93, v94
v_cvt_pk_bf16_f32 v71, v118, v119
v_permlane32_swap_b32 v80, v81
v_max3_f32 v77, v95, v108, v109
v_mfma_f32_16x16x32_bf16 v[84:87], v[248:251], v[68:71], 0
v_max_f32 v80, v80, v81
.Lpad3:
s_cbranch_execz .Lpad6
v_mul_f32 v80, v80, v226
v_mfma_f32_16x16x32_bf16 v[100:103], v[204:207], v[68:71], 0
v_max3_f32 v76, v76, v110, v111
v_max_f32 v78, v76, v77
v_mfma_f32_16x16x32_bf16 v[116:119], v[214:217], v[68:71], 0
s_nop 1
v_rcp_f32 v84, v84
v_max_f32 v77, v76, v77
s_nop 1
v_permlane16_swap_b32 v78, v77
v_pk_mul_f32 v[100:101], v[100:101], v[84:85] op_sel_hi:[1,0]
v_pk_mul_f32 v[102:103], v[102:103], v[84:85] op_sel_hi:[1,0]
v_pk_mul_f32 v[116:117], v[116:117], v[84:85] op_sel_hi:[1,0]
v_pk_mul_f32 v[118:119], v[118:119], v[84:85] op_sel_hi:[1,0]
v_cvt_pk_bf16_f32 v172, v100, v101
v_cvt_pk_bf16_f32 v173, v102, v103
v_cvt_pk_bf16_f32 v174, v116, v117
v_cvt_pk_bf16_f32 v175, v118, v119
buffer_store_dwordx4 v[172:175], v4, s[16:19], s74 offen offset:2048 sc1
v_pk_fma_f32 v[96:97], v[96:97], v[226:227], v[80:81] op_sel_hi:[1,0,0] neg_lo:[0,0,1] neg_hi:[0,0,1]
v_exp_f32 v96, v96
v_pk_fma_f32 v[98:99], v[98:99], v[226:227], v[80:81] op_sel_hi:[1,0,0] neg_lo:[0,0,1] neg_hi:[0,0,1]
v_exp_f32 v97, v97
v_pk_fma_f32 v[112:113], v[112:113], v[226:227], v[80:81] op_sel_hi:[1,0,0] neg_lo:[0,0,1] neg_hi:[0,0,1]
v_exp_f32 v98, v98
v_pk_fma_f32 v[114:115], v[114:115], v[226:227], v[80:81] op_sel_hi:[1,0,0] neg_lo:[0,0,1] neg_hi:[0,0,1]
v_exp_f32 v99, v99
v_cvt_pk_bf16_f32 v64, v96, v97
v_exp_f32 v112, v112
v_cvt_pk_bf16_f32 v65, v98, v99
v_exp_f32 v113, v113
v_max_f32 v76, v78, v77
v_exp_f32 v114, v114
v_cvt_pk_bf16_f32 v66, v112, v113
v_exp_f32 v115, v115
v_max_f32 v77, v78, v77
v_cvt_pk_bf16_f32 v67, v114, v115
s_nop 0
v_permlane32_swap_b32 v76, v77
v_mfma_f32_16x16x32_bf16 v[80:83], v[248:251], v[64:67], 0
v_max_f32 v76, v76, v77
v_mul_f32 v76, v76, v222
v_mfma_f32_16x16x32_bf16 v[96:99], v[202:205], v[64:67], 0
v_mfma_f32_16x16x32_bf16 v[112:115], v[212:215], v[64:67], 0
s_nop 3
v_rcp_f32 v80, v80
s_nop 1
v_pk_mul_f32 v[96:97], v[96:97], v[80:81] op_sel_hi:[1,0]
v_pk_mul_f32 v[98:99], v[98:99], v[80:81] op_sel_hi:[1,0]
v_pk_mul_f32 v[112:113], v[112:113], v[80:81] op_sel_hi:[1,0]
v_pk_mul_f32 v[114:115], v[114:115], v[80:81] op_sel_hi:[1,0]
v_cvt_pk_bf16_f32 v168, v96, v97
v_cvt_pk_bf16_f32 v169, v98, v99
v_cvt_pk_bf16_f32 v170, v112, v113
v_cvt_pk_bf16_f32 v171, v114, v115
buffer_store_dwordx4 v[168:171], v4, s[16:19], s74 offen offset:1024 sc1
v_pk_fma_f32 v[92:93], v[92:93], v[222:223], v[76:77] op_sel_hi:[1,0,0] neg_lo:[0,0,1] neg_hi:[0,0,1]
v_exp_f32 v92, v92
v_pk_fma_f32 v[94:95], v[94:95], v[222:223], v[76:77] op_sel_hi:[1,0,0] neg_lo:[0,0,1] neg_hi:[0,0,1]
v_exp_f32 v93, v93
v_pk_fma_f32 v[108:109], v[108:109], v[222:223], v[76:77] op_sel_hi:[1,0,0] neg_lo:[0,0,1] neg_hi:[0,0,1]
v_exp_f32 v94, v94
v_pk_fma_f32 v[110:111], v[110:111], v[222:223], v[76:77] op_sel_hi:[1,0,0] neg_lo:[0,0,1] neg_hi:[0,0,1]
v_exp_f32 v95, v95
v_cvt_pk_bf16_f32 v60, v92, v93
v_exp_f32 v108, v108
v_cvt_pk_bf16_f32 v61, v94, v95
v_exp_f32 v109, v109
v_exp_f32 v110, v110
v_cvt_pk_bf16_f32 v62, v108, v109
v_exp_f32 v111, v111
s_nop 0
v_cvt_pk_bf16_f32 v63, v110, v111
s_nop 1
v_mfma_f32_16x16x32_bf16 v[76:79], v[248:251], v[60:63], 0
v_mfma_f32_16x16x32_bf16 v[92:95], v[200:203], v[60:63], 0
v_mfma_f32_16x16x32_bf16 v[108:111], v[210:213], v[60:63], 0
s_nop 5
v_rcp_f32 v76, v76
s_nop 0
v_pk_mul_f32 v[92:93], v[92:93], v[76:77] op_sel_hi:[1,0]
v_pk_mul_f32 v[94:95], v[94:95], v[76:77] op_sel_hi:[1,0]
v_pk_mul_f32 v[108:109], v[108:109], v[76:77] op_sel_hi:[1,0]
v_pk_mul_f32 v[110:111], v[110:111], v[76:77] op_sel_hi:[1,0]
v_cvt_pk_bf16_f32 v164, v92, v93
v_cvt_pk_bf16_f32 v165, v94, v95
v_cvt_pk_bf16_f32 v166, v108, v109
v_cvt_pk_bf16_f32 v167, v110, v111
buffer_store_dwordx4 v[164:167], v4, s[16:19], s74 offen sc1
s_nop 1
s_branch .Lqkve10
.Lqkv9:
.Lpad4:
s_cbranch_execz .Lpad7
s_add_u32 m0, s55, 0
s_nop 0
buffer_load_dwordx4 v21, s[16:19], s52 offen sc1 lds
buffer_load_dwordx4 v21, s[16:19], s52 offen offset:1024 sc1 lds
buffer_load_dword v22, s[16:19], s52 offen offset:2048 sc1 lds
s_add_u32 s52, s52, 0x20000
s_add_u32 m0, s55, 9216
s_nop 0
buffer_load_dwordx4 v21, s[16:19], s52 offen sc1 lds
buffer_load_dwordx4 v21, s[16:19], s52 offen offset:1024 sc1 lds
buffer_load_dword v22, s[16:19], s52 offen offset:2048 sc1 lds
s_add_u32 s52, s52, 0x20000
s_add_u32 m0, s55, 18432
s_nop 0
buffer_load_dwordx4 v21, s[16:19], s52 offen sc1 lds
buffer_load_dwordx4 v21, s[16:19], s52 offen offset:1024 sc1 lds
buffer_load_dword v22, s[16:19], s52 offen offset:2048 sc1 lds
s_add_u32 s52, s52, 0x20000
s_add_u32 m0, s55, 27648
s_nop 0
buffer_load_dwordx4 v21, s[16:19], s52 offen sc1 lds
buffer_load_dwordx4 v21, s[16:19], s52 offen offset:1024 sc1 lds
buffer_load_dword v22, s[16:19], s52 offen offset:2048 sc1 lds
s_add_u32 s52, s52, 0x20000
s_add_u32 m0, s55, 36864
s_nop 0
buffer_load_dwordx4 v21, s[16:19], s52 offen sc1 lds
buffer_load_dwordx4 v21, s[16:19], s52 offen offset:1024 sc1 lds
buffer_load_dword v22, s[16:19], s52 offen offset:2048 sc1 lds
s_add_u32 s52, s52, 0x20000
s_add_u32 m0, s55, 46080
s_nop 0
buffer_load_dwordx4 v21, s[16:19], s52 offen sc1 lds
buffer_load_dwordx4 v21, s[16:19], s52 offen offset:1024 sc1 lds
buffer_load_dword v22, s[16:19], s52 offen offset:2048 sc1 lds
s_add_u32 s52, s52, 0x20000
s_waitcnt vmcnt(15)
s_barrier
ds_read_b128 a[0:3], v23
ds_read_b128 a[4:7], v23 offset:1024
ds_read_b128 a[8:11], v23 offset:2304
ds_read_b128 a[12:15], v23 offset:3328
ds_read_b128 a[16:19], v24 offset:2048
ds_read_b64_tr_b16 a[20:21], v25
ds_read_b64_tr_b16 a[22:23], v25 offset:512
ds_read_b64_tr_b16 a[24:25], v25 offset:32
ds_read_b64_tr_b16 a[26:27], v25 offset:544
ds_read_b64_tr_b16 a[28:29], v25 offset:1024
ds_read_b64_tr_b16 a[30:31], v25 offset:1536
ds_read_b64_tr_b16 a[32:33], v25 offset:1056
ds_read_b64_tr_b16 a[34:35], v25 offset:1568
ds_read_b64_tr_b16 a[36:37], v25 offset:2048
ds_read_b64_tr_b16 a[38:39], v25 offset:2560
ds_read_b64_tr_b16 a[40:41], v25 offset:2080
ds_read_b64_tr_b16 a[42:43], v25 offset:2592
s_mov_b32 s15, 4
.p2align 6
.Lk12:
s_waitcnt vmcnt(12) lgkmcnt(0)
s_barrier
v_mfma_f32_16x16x32_bf16 v[60:63], a[20:23], a[0:3], v[60:63]
ds_read_b64_tr_b16 a[64:65], v25 offset:12416
s_add_u32 m0, s56, 66560
v_mfma_f32_16x16x32_bf16 v[64:67], a[20:23], a[4:7], v[64:67]
buffer_load_dwordx4 v18, s[20:23], s54 offen lds
v_mfma_f32_16x16x32_bf16 v[68:71], a[20:23], a[8:11], v[68:71]
ds_read_b64_tr_b16 a[66:67], v25 offset:12928
v_mfma_f32_16x16x32_bf16 v[72:75], a[20:23], a[12:15], v[72:75]
ds_read_b64_tr_b16 a[68:69], v25 offset:12448
ds_read_b64_tr_b16 a[70:71], v25 offset:12960
v_mfma_f32_16x16x32_bf16 v[76:79], a[24:27], a[0:3], v[76:79]
buffer_load_dwordx4 v19, s[20:23], s54 offen offset:1024 lds
v_mfma_f32_16x16x32_bf16 v[80:83], a[24:27], a[4:7], v[80:83]
ds_read_b64_tr_b16 a[72:73], v25 offset:13440
v_mfma_f32_16x16x32_bf16 v[84:87], a[24:27], a[8:11], v[84:87]
ds_read_b64_tr_b16 a[74:75], v25 offset:13952
v_mfma_f32_16x16x32_bf16 v[88:91], a[24:27], a[12:15], v[88:91]
ds_read_b64_tr_b16 a[76:77], v25 offset:13472
ds_read_b64_tr_b16 a[78:79], v25 offset:13984
v_mfma_f32_16x16x32_bf16 v[244:247], a[24:27], a[16:19], v[244:247]
buffer_load_dwordx4 v20, s[20:23], s54 offen offset:2048 lds
v_mfma_f32_16x16x32_bf16 v[92:95], a[28:31], a[0:3], v[92:95]
s_add_u32 s54, s54, 196608
v_mfma_f32_16x16x32_bf16 v[96:99], a[28:31], a[4:7], v[96:99]
ds_read_b128 a[44:47], v23 offset:9216
s_add_u32 m0, s55, 0
v_mfma_f32_16x16x32_bf16 v[100:103], a[28:31], a[8:11], v[100:103]
buffer_load_dwordx4 v21, s[16:19], s52 offen sc1 lds
v_mfma_f32_16x16x32_bf16 v[104:107], a[28:31], a[12:15], v[104:107]
ds_read_b128 a[48:51], v23 offset:10240
v_mfma_f32_16x16x32_bf16 v[108:111], a[32:35], a[0:3], v[108:111]
ds_read_b64_tr_b16 a[80:81], v25 offset:14464
ds_read_b64_tr_b16 a[82:83], v25 offset:14976
v_mfma_f32_16x16x32_bf16 v[112:115], a[32:35], a[4:7], v[112:115]
ds_read_b128 a[52:55], v23 offset:11520
v_mfma_f32_16x16x32_bf16 v[116:119], a[32:35], a[8:11], v[116:119]
buffer_load_dwordx4 v21, s[16:19], s52 offen offset:1024 sc1 lds
v_mfma_f32_16x16x32_bf16 v[120:123], a[32:35], a[12:15], v[120:123]
ds_read_b128 a[56:59], v23 offset:12544
v_mfma_f32_16x16x32_bf16 v[124:127], a[0:3], a[36:39], v[124:127]
ds_read_b64_tr_b16 a[84:85], v25 offset:14496
ds_read_b64_tr_b16 a[86:87], v25 offset:15008
v_mfma_f32_16x16x32_bf16 v[128:131], a[4:7], a[36:39], v[128:131]
buffer_load_dword v22, s[16:19], s52 offen offset:2048 sc1 lds
v_mfma_f32_16x16x32_bf16 v[132:135], a[8:11], a[36:39], v[132:135]
s_add_u32 s52, s52, 0x20000
v_mfma_f32_16x16x32_bf16 v[136:139], a[12:15], a[36:39], v[136:139]
ds_read_b128 a[60:63], v24 offset:11264
v_mfma_f32_16x16x32_bf16 v[156:159], a[16:19], a[36:39], v[156:159]
s_cmp_eq_u32 s15, 4
s_cselect_b32 s67, s44, 16777216
v_mfma_f32_16x16x32_bf16 v[140:143], a[0:3], a[40:43], v[140:143]
buffer_load_dword v27, v14, s[20:23], s67 offen
v_mfma_f32_16x16x32_bf16 v[144:147], a[4:7], a[40:43], v[144:147]
v_mfma_f32_16x16x32_bf16 v[148:151], a[8:11], a[40:43], v[148:151]
v_mfma_f32_16x16x32_bf16 v[152:155], a[12:15], a[40:43], v[152:155]
v_mfma_f32_16x16x32_bf16 v[160:163], a[16:19], a[40:43], v[160:163]
s_waitcnt vmcnt(16) lgkmcnt(0)
s_barrier
v_mfma_f32_16x16x32_bf16 v[60:63], a[64:67], a[44:47], v[60:63]
ds_read_b64_tr_b16 a[20:21], v25 offset:24832
s_add_u32 m0, s56, 78976
v_mfma_f32_16x16x32_bf16 v[64:67], a[64:67], a[48:51], v[64:67]
buffer_load_dwordx4 v18, s[20:23], s54 offen lds
v_mfma_f32_16x16x32_bf16 v[68:71], a[64:67], a[52:55], v[68:71]
ds_read_b64_tr_b16 a[22:23], v25 offset:25344
v_mfma_f32_16x16x32_bf16 v[72:75], a[64:67], a[56:59], v[72:75]
ds_read_b64_tr_b16 a[24:25], v25 offset:24864
v_mfma_f32_16x16x32_bf16 v[76:79], a[68:71], a[44:47], v[76:79]
ds_read_b64_tr_b16 a[26:27], v25 offset:25376
ds_read_b64_tr_b16 a[28:29], v25 offset:25856
v_mfma_f32_16x16x32_bf16 v[80:83], a[68:71], a[48:51], v[80:83]
buffer_load_dwordx4 v19, s[20:23], s54 offen offset:1024 lds
v_mfma_f32_16x16x32_bf16 v[84:87], a[68:71], a[52:55], v[84:87]
ds_read_b64_tr_b16 a[30:31], v25 offset:26368
v_mfma_f32_16x16x32_bf16 v[88:91], a[68:71], a[56:59], v[88:91]
ds_read_b64_tr_b16 a[32:33], v25 offset:25888
v_mfma_f32_16x16x32_bf16 v[244:247], a[68:71], a[60:63], v[244:247]
ds_read_b64_tr_b16 a[34:35], v25 offset:26400
v_mfma_f32_16x16x32_bf16 v[92:95], a[72:75], a[44:47], v[92:95]
buffer_load_dwordx4 v20, s[20:23], s54 offen offset:2048 lds
v_mfma_f32_16x16x32_bf16 v[96:99], a[72:75], a[48:51], v[96:99]
ds_read_b128 a[0:3], v23 offset:18432
s_add_u32 s54, s54, 196608
v_mfma_f32_16x16x32_bf16 v[100:103], a[72:75], a[52:55], v[100:103]
ds_read_b128 a[4:7], v23 offset:19456
v_mfma_f32_16x16x32_bf16 v[104:107], a[72:75], a[56:59], v[104:107]
s_add_u32 m0, s55, 9216
v_mfma_f32_16x16x32_bf16 v[108:111], a[76:79], a[44:47], v[108:111]
buffer_load_dwordx4 v21, s[16:19], s52 offen sc1 lds
v_mfma_f32_16x16x32_bf16 v[112:115], a[76:79], a[48:51], v[112:115]
ds_read_b64_tr_b16 a[36:37], v25 offset:26880
ds_read_b64_tr_b16 a[38:39], v25 offset:27392
v_mfma_f32_16x16x32_bf16 v[116:119], a[76:79], a[52:55], v[116:119]
ds_read_b128 a[8:11], v23 offset:20736
v_mfma_f32_16x16x32_bf16 v[120:123], a[76:79], a[56:59], v[120:123]
ds_read_b128 a[12:15], v23 offset:21760
v_mfma_f32_16x16x32_bf16 v[124:127], a[44:47], a[80:83], v[124:127]
buffer_load_dwordx4 v21, s[16:19], s52 offen offset:1024 sc1 lds
v_mfma_f32_16x16x32_bf16 v[128:131], a[48:51], a[80:83], v[128:131]
ds_read_b64_tr_b16 a[40:41], v25 offset:26912
v_mfma_f32_16x16x32_bf16 v[132:135], a[52:55], a[80:83], v[132:135]
ds_read_b64_tr_b16 a[42:43], v25 offset:27424
v_mfma_f32_16x16x32_bf16 v[136:139], a[56:59], a[80:83], v[136:139]
ds_read_b128 a[16:19], v24 offset:20480
v_mfma_f32_16x16x32_bf16 v[156:159], a[60:63], a[80:83], v[156:159]
buffer_load_dword v22, s[16:19], s52 offen offset:2048 sc1 lds
v_mfma_f32_16x16x32_bf16 v[140:143], a[44:47], a[84:87], v[140:143]
s_add_u32 s52, s52, 0x20000
v_mfma_f32_16x16x32_bf16 v[144:147], a[48:51], a[84:87], v[144:147]
v_mfma_f32_16x16x32_bf16 v[148:151], a[52:55], a[84:87], v[148:151]
v_mfma_f32_16x16x32_bf16 v[152:155], a[56:59], a[84:87], v[152:155]
v_mfma_f32_16x16x32_bf16 v[160:163], a[60:63], a[84:87], v[160:163]
s_waitcnt vmcnt(19) lgkmcnt(0)
s_barrier
v_mfma_f32_16x16x32_bf16 v[60:63], a[20:23], a[0:3], v[60:63]
ds_read_b64_tr_b16 a[64:65], v25 offset:37248
s_add_u32 m0, s56, 91392
v_mfma_f32_16x16x32_bf16 v[64:67], a[20:23], a[4:7], v[64:67]
buffer_load_dwordx4 v18, s[20:23], s54 offen lds
v_mfma_f32_16x16x32_bf16 v[68:71], a[20:23], a[8:11], v[68:71]
ds_read_b64_tr_b16 a[66:67], v25 offset:37760
v_mfma_f32_16x16x32_bf16 v[72:75], a[20:23], a[12:15], v[72:75]
ds_read_b64_tr_b16 a[68:69], v25 offset:37280
ds_read_b64_tr_b16 a[70:71], v25 offset:37792
v_mfma_f32_16x16x32_bf16 v[76:79], a[24:27], a[0:3], v[76:79]
buffer_load_dwordx4 v19, s[20:23], s54 offen offset:1024 lds
v_mfma_f32_16x16x32_bf16 v[80:83], a[24:27], a[4:7], v[80:83]
ds_read_b64_tr_b16 a[72:73], v25 offset:38272
v_mfma_f32_16x16x32_bf16 v[84:87], a[24:27], a[8:11], v[84:87]
ds_read_b64_tr_b16 a[74:75], v25 offset:38784
v_mfma_f32_16x16x32_bf16 v[88:91], a[24:27], a[12:15], v[88:91]
ds_read_b64_tr_b16 a[76:77], v25 offset:38304
ds_read_b64_tr_b16 a[78:79], v25 offset:38816
v_mfma_f32_16x16x32_bf16 v[244:247], a[24:27], a[16:19], v[244:247]
buffer_load_dwordx4 v20, s[20:23], s54 offen offset:2048 lds
v_mfma_f32_16x16x32_bf16 v[92:95], a[28:31], a[0:3], v[92:95]
s_add_u32 s54, s54, 196608
v_mfma_f32_16x16x32_bf16 v[96:99], a[28:31], a[4:7], v[96:99]
ds_read_b128 a[44:47], v23 offset:27648
s_add_u32 m0, s55, 18432
v_mfma_f32_16x16x32_bf16 v[100:103], a[28:31], a[8:11], v[100:103]
buffer_load_dwordx4 v21, s[16:19], s52 offen sc1 lds
v_mfma_f32_16x16x32_bf16 v[104:107], a[28:31], a[12:15], v[104:107]
ds_read_b128 a[48:51], v23 offset:28672
v_mfma_f32_16x16x32_bf16 v[108:111], a[32:35], a[0:3], v[108:111]
ds_read_b64_tr_b16 a[80:81], v25 offset:39296
ds_read_b64_tr_b16 a[82:83], v25 offset:39808
v_mfma_f32_16x16x32_bf16 v[112:115], a[32:35], a[4:7], v[112:115]
ds_read_b128 a[52:55], v23 offset:29952
v_mfma_f32_16x16x32_bf16 v[116:119], a[32:35], a[8:11], v[116:119]
buffer_load_dwordx4 v21, s[16:19], s52 offen offset:1024 sc1 lds
v_mfma_f32_16x16x32_bf16 v[120:123], a[32:35], a[12:15], v[120:123]
ds_read_b128 a[56:59], v23 offset:30976
v_mfma_f32_16x16x32_bf16 v[124:127], a[0:3], a[36:39], v[124:127]
ds_read_b64_tr_b16 a[84:85], v25 offset:39328
ds_read_b64_tr_b16 a[86:87], v25 offset:39840
v_mfma_f32_16x16x32_bf16 v[128:131], a[4:7], a[36:39], v[128:131]
buffer_load_dword v22, s[16:19], s52 offen offset:2048 sc1 lds
v_mfma_f32_16x16x32_bf16 v[132:135], a[8:11], a[36:39], v[132:135]
s_add_u32 s52, s52, 0x20000
v_mfma_f32_16x16x32_bf16 v[136:139], a[12:15], a[36:39], v[136:139]
ds_read_b128 a[60:63], v24 offset:29696
v_mfma_f32_16x16x32_bf16 v[156:159], a[16:19], a[36:39], v[156:159]
s_cmp_eq_u32 s15, 3
s_cselect_b32 s67, s45, 16777216
v_mfma_f32_16x16x32_bf16 v[140:143], a[0:3], a[40:43], v[140:143]
buffer_load_dword v27, v14, s[20:23], s67 offen
v_mfma_f32_16x16x32_bf16 v[144:147], a[4:7], a[40:43], v[144:147]
v_mfma_f32_16x16x32_bf16 v[148:151], a[8:11], a[40:43], v[148:151]
v_mfma_f32_16x16x32_bf16 v[152:155], a[12:15], a[40:43], v[152:155]
v_mfma_f32_16x16x32_bf16 v[160:163], a[16:19], a[40:43], v[160:163]
s_waitcnt vmcnt(23) lgkmcnt(0)
s_barrier
v_mfma_f32_16x16x32_bf16 v[60:63], a[64:67], a[44:47], v[60:63]
ds_read_b64_tr_b16 a[20:21], v25 offset:49664
s_add_u32 m0, s56, 103808
v_mfma_f32_16x16x32_bf16 v[64:67], a[64:67], a[48:51], v[64:67]
buffer_load_dwordx4 v18, s[20:23], s54 offen lds
v_mfma_f32_16x16x32_bf16 v[68:71], a[64:67], a[52:55], v[68:71]
ds_read_b64_tr_b16 a[22:23], v25 offset:50176
v_mfma_f32_16x16x32_bf16 v[72:75], a[64:67], a[56:59], v[72:75]
ds_read_b64_tr_b16 a[24:25], v25 offset:49696
v_mfma_f32_16x16x32_bf16 v[76:79], a[68:71], a[44:47], v[76:79]
ds_read_b64_tr_b16 a[26:27], v25 offset:50208
ds_read_b64_tr_b16 a[28:29], v25 offset:50688
v_mfma_f32_16x16x32_bf16 v[80:83], a[68:71], a[48:51], v[80:83]
buffer_load_dwordx4 v19, s[20:23], s54 offen offset:1024 lds
v_mfma_f32_16x16x32_bf16 v[84:87], a[68:71], a[52:55], v[84:87]
ds_read_b64_tr_b16 a[30:31], v25 offset:51200
v_mfma_f32_16x16x32_bf16 v[88:91], a[68:71], a[56:59], v[88:91]
ds_read_b64_tr_b16 a[32:33], v25 offset:50720
v_mfma_f32_16x16x32_bf16 v[244:247], a[68:71], a[60:63], v[244:247]
ds_read_b64_tr_b16 a[34:35], v25 offset:51232
v_mfma_f32_16x16x32_bf16 v[92:95], a[72:75], a[44:47], v[92:95]
buffer_load_dwordx4 v20, s[20:23], s54 offen offset:2048 lds
v_mfma_f32_16x16x32_bf16 v[96:99], a[72:75], a[48:51], v[96:99]
ds_read_b128 a[0:3], v23 offset:36864
s_add_u32 s54, s54, 196608
v_mfma_f32_16x16x32_bf16 v[100:103], a[72:75], a[52:55], v[100:103]
ds_read_b128 a[4:7], v23 offset:37888
v_mfma_f32_16x16x32_bf16 v[104:107], a[72:75], a[56:59], v[104:107]
s_add_u32 m0, s55, 27648
v_mfma_f32_16x16x32_bf16 v[108:111], a[76:79], a[44:47], v[108:111]
buffer_load_dwordx4 v21, s[16:19], s52 offen sc1 lds
v_mfma_f32_16x16x32_bf16 v[112:115], a[76:79], a[48:51], v[112:115]
ds_read_b64_tr_b16 a[36:37], v25 offset:51712
ds_read_b64_tr_b16 a[38:39], v25 offset:52224
v_mfma_f32_16x16x32_bf16 v[116:119], a[76:79], a[52:55], v[116:119]
ds_read_b128 a[8:11], v23 offset:39168
v_mfma_f32_16x16x32_bf16 v[120:123], a[76:79], a[56:59], v[120:123]
ds_read_b128 a[12:15], v23 offset:40192
v_mfma_f32_16x16x32_bf16 v[124:127], a[44:47], a[80:83], v[124:127]
buffer_load_dwordx4 v21, s[16:19], s52 offen offset:1024 sc1 lds
v_mfma_f32_16x16x32_bf16 v[128:131], a[48:51], a[80:83], v[128:131]
ds_read_b64_tr_b16 a[40:41], v25 offset:51744
v_mfma_f32_16x16x32_bf16 v[132:135], a[52:55], a[80:83], v[132:135]
ds_read_b64_tr_b16 a[42:43], v25 offset:52256
v_mfma_f32_16x16x32_bf16 v[136:139], a[56:59], a[80:83], v[136:139]
ds_read_b128 a[16:19], v24 offset:38912
v_mfma_f32_16x16x32_bf16 v[156:159], a[60:63], a[80:83], v[156:159]
buffer_load_dword v22, s[16:19], s52 offen offset:2048 sc1 lds
v_mfma_f32_16x16x32_bf16 v[140:143], a[44:47], a[84:87], v[140:143]
s_add_u32 s52, s52, 0x20000
v_mfma_f32_16x16x32_bf16 v[144:147], a[48:51], a[84:87], v[144:147]
v_mfma_f32_16x16x32_bf16 v[148:151], a[52:55], a[84:87], v[148:151]
v_mfma_f32_16x16x32_bf16 v[152:155], a[56:59], a[84:87], v[152:155]
v_mfma_f32_16x16x32_bf16 v[160:163], a[60:63], a[84:87], v[160:163]
s_waitcnt vmcnt(26) lgkmcnt(0)
s_barrier
v_mfma_f32_16x16x32_bf16 v[60:63], a[20:23], a[0:3], v[60:63]
ds_read_b64_tr_b16 a[64:65], v25 offset:62080
s_add_u32 m0, s56, 116224
v_mfma_f32_16x16x32_bf16 v[64:67], a[20:23], a[4:7], v[64:67]
buffer_load_dwordx4 v18, s[20:23], s54 offen lds
v_mfma_f32_16x16x32_bf16 v[68:71], a[20:23], a[8:11], v[68:71]
ds_read_b64_tr_b16 a[66:67], v25 offset:62592
v_mfma_f32_16x16x32_bf16 v[72:75], a[20:23], a[12:15], v[72:75]
ds_read_b64_tr_b16 a[68:69], v25 offset:62112
v_mfma_f32_16x16x32_bf16 v[76:79], a[24:27], a[0:3], v[76:79]
ds_read_b64_tr_b16 a[70:71], v25 offset:62624
ds_read_b64_tr_b16 a[72:73], v25 offset:63104
v_mfma_f32_16x16x32_bf16 v[80:83], a[24:27], a[4:7], v[80:83]
buffer_load_dwordx4 v19, s[20:23], s54 offen offset:1024 lds
v_mfma_f32_16x16x32_bf16 v[84:87], a[24:27], a[8:11], v[84:87]
ds_read_b64_tr_b16 a[74:75], v25 offset:63616
v_mfma_f32_16x16x32_bf16 v[88:91], a[24:27], a[12:15], v[88:91]
ds_read_b64_tr_b16 a[76:77], v25 offset:63136
v_mfma_f32_16x16x32_bf16 v[244:247], a[24:27], a[16:19], v[244:247]
ds_read_b64_tr_b16 a[78:79], v25 offset:63648
v_mfma_f32_16x16x32_bf16 v[92:95], a[28:31], a[0:3], v[92:95]
buffer_load_dwordx4 v20, s[20:23], s54 offen offset:2048 lds
v_mfma_f32_16x16x32_bf16 v[96:99], a[28:31], a[4:7], v[96:99]
ds_read_b128 a[44:47], v23 offset:46080
s_add_u32 s54, s54, 196608
v_mfma_f32_16x16x32_bf16 v[100:103], a[28:31], a[8:11], v[100:103]
ds_read_b128 a[48:51], v23 offset:47104
v_mfma_f32_16x16x32_bf16 v[104:107], a[28:31], a[12:15], v[104:107]
s_add_u32 m0, s55, 36864
v_mfma_f32_16x16x32_bf16 v[108:111], a[32:35], a[0:3], v[108:111]
buffer_load_dwordx4 v21, s[16:19], s52 offen sc1 lds
v_mfma_f32_16x16x32_bf16 v[112:115], a[32:35], a[4:7], v[112:115]
ds_read_b64_tr_b16 a[80:81], v25 offset:64128
ds_read_b64_tr_b16 a[82:83], v25 offset:64640
v_mfma_f32_16x16x32_bf16 v[116:119], a[32:35], a[8:11], v[116:119]
ds_read_b128 a[52:55], v23 offset:48384
v_mfma_f32_16x16x32_bf16 v[120:123], a[32:35], a[12:15], v[120:123]
ds_read_b128 a[56:59], v23 offset:49408
v_mfma_f32_16x16x32_bf16 v[124:127], a[0:3], a[36:39], v[124:127]
buffer_load_dwordx4 v21, s[16:19], s52 offen offset:1024 sc1 lds
v_mfma_f32_16x16x32_bf16 v[128:131], a[4:7], a[36:39], v[128:131]
ds_read_b64_tr_b16 a[84:85], v25 offset:64160
v_mfma_f32_16x16x32_bf16 v[132:135], a[8:11], a[36:39], v[132:135]
ds_read_b64_tr_b16 a[86:87], v25 offset:64672
v_mfma_f32_16x16x32_bf16 v[136:139], a[12:15], a[36:39], v[136:139]
ds_read_b128 a[60:63], v24 offset:48128
v_mfma_f32_16x16x32_bf16 v[156:159], a[16:19], a[36:39], v[156:159]
buffer_load_dword v22, s[16:19], s52 offen offset:2048 sc1 lds
v_mfma_f32_16x16x32_bf16 v[140:143], a[0:3], a[40:43], v[140:143]
s_add_u32 s52, s52, 0x20000
v_mfma_f32_16x16x32_bf16 v[144:147], a[4:7], a[40:43], v[144:147]
v_mfma_f32_16x16x32_bf16 v[148:151], a[8:11], a[40:43], v[148:151]
v_mfma_f32_16x16x32_bf16 v[152:155], a[12:15], a[40:43], v[152:155]
v_mfma_f32_16x16x32_bf16 v[160:163], a[16:19], a[40:43], v[160:163]
s_waitcnt vmcnt(26) lgkmcnt(0)
s_barrier
v_mfma_f32_16x16x32_bf16 v[60:63], a[64:67], a[44:47], v[60:63]
ds_read_b64_tr_b16 a[20:21], v25
s_add_u32 m0, s56, 128640
v_mfma_f32_16x16x32_bf16 v[64:67], a[64:67], a[48:51], v[64:67]
buffer_load_dwordx4 v18, s[20:23], s54 offen lds
v_mfma_f32_16x16x32_bf16 v[68:71], a[64:67], a[52:55], v[68:71]
ds_read_b64_tr_b16 a[22:23], v25 offset:512
v_mfma_f32_16x16x32_bf16 v[72:75], a[64:67], a[56:59], v[72:75]
ds_read_b64_tr_b16 a[24:25], v25 offset:32
ds_read_b64_tr_b16 a[26:27], v25 offset:544
v_mfma_f32_16x16x32_bf16 v[76:79], a[68:71], a[44:47], v[76:79]
buffer_load_dwordx4 v19, s[20:23], s54 offen offset:1024 lds
v_mfma_f32_16x16x32_bf16 v[80:83], a[68:71], a[48:51], v[80:83]
ds_read_b64_tr_b16 a[28:29], v25 offset:1024
v_mfma_f32_16x16x32_bf16 v[84:87], a[68:71], a[52:55], v[84:87]
ds_read_b64_tr_b16 a[30:31], v25 offset:1536
v_mfma_f32_16x16x32_bf16 v[88:91], a[68:71], a[56:59], v[88:91]
ds_read_b64_tr_b16 a[32:33], v25 offset:1056
ds_read_b64_tr_b16 a[34:35], v25 offset:1568
v_mfma_f32_16x16x32_bf16 v[244:247], a[68:71], a[60:63], v[244:247]
buffer_load_dwordx4 v20, s[20:23], s54 offen offset:2048 lds
v_mfma_f32_16x16x32_bf16 v[92:95], a[72:75], a[44:47], v[92:95]
s_add_u32 s54, s54, 196608
v_mfma_f32_16x16x32_bf16 v[96:99], a[72:75], a[48:51], v[96:99]
ds_read_b128 a[0:3], v23
s_add_u32 m0, s55, 46080
v_mfma_f32_16x16x32_bf16 v[100:103], a[72:75], a[52:55], v[100:103]
buffer_load_dwordx4 v21, s[16:19], s52 offen sc1 lds
v_mfma_f32_16x16x32_bf16 v[104:107], a[72:75], a[56:59], v[104:107]
ds_read_b128 a[4:7], v23 offset:1024
v_mfma_f32_16x16x32_bf16 v[108:111], a[76:79], a[44:47], v[108:111]
ds_read_b64_tr_b16 a[36:37], v25 offset:2048
ds_read_b64_tr_b16 a[38:39], v25 offset:2560
v_mfma_f32_16x16x32_bf16 v[112:115], a[76:79], a[48:51], v[112:115]
ds_read_b128 a[8:11], v23 offset:2304
v_mfma_f32_16x16x32_bf16 v[116:119], a[76:79], a[52:55], v[116:119]
buffer_load_dwordx4 v21, s[16:19], s52 offen offset:1024 sc1 lds
v_mfma_f32_16x16x32_bf16 v[120:123], a[76:79], a[56:59], v[120:123]
ds_read_b128 a[12:15], v23 offset:3328
v_mfma_f32_16x16x32_bf16 v[124:127], a[44:47], a[80:83], v[124:127]
ds_read_b64_tr_b16 a[40:41], v25 offset:2080
ds_read_b64_tr_b16 a[42:43], v25 offset:2592
v_mfma_f32_16x16x32_bf16 v[128:131], a[48:51], a[80:83], v[128:131]
buffer_load_dword v22, s[16:19], s52 offen offset:2048 sc1 lds
v_mfma_f32_16x16x32_bf16 v[132:135], a[52:55], a[80:83], v[132:135]
s_add_u32 s52, s52, 0x20000
v_mfma_f32_16x16x32_bf16 v[136:139], a[56:59], a[80:83], v[136:139]
ds_read_b128 a[16:19], v24 offset:2048
v_mfma_f32_16x16x32_bf16 v[156:159], a[60:63], a[80:83], v[156:159]
s_cmp_eq_u32 s15, 2
s_cselect_b32 s67, s46, 16777216
v_mfma_f32_16x16x32_bf16 v[140:143], a[44:47], a[84:87], v[140:143]
buffer_load_dword v27, v15, s[24:27], s67 offen
v_mfma_f32_16x16x32_bf16 v[144:147], a[48:51], a[84:87], v[144:147]
v_mfma_f32_16x16x32_bf16 v[148:151], a[52:55], a[84:87], v[148:151]
v_mfma_f32_16x16x32_bf16 v[152:155], a[56:59], a[84:87], v[152:155]
v_mfma_f32_16x16x32_bf16 v[160:163], a[60:63], a[84:87], v[160:163]
s_sub_u32 s15, s15, 1
s_cmp_lg_u32 s15, 0
s_cbranch_scc1 .Lk12
s_waitcnt vmcnt(26) lgkmcnt(0)
s_barrier
v_mfma_f32_16x16x32_bf16 v[60:63], a[20:23], a[0:3], v[60:63]
ds_read_b64_tr_b16 a[64:65], v25 offset:12416
s_add_u32 m0, s56, 66560
v_mfma_f32_16x16x32_bf16 v[64:67], a[20:23], a[4:7], v[64:67]
buffer_load_dwordx4 v18, s[20:23], s54 offen lds
v_mfma_f32_16x16x32_bf16 v[68:71], a[20:23], a[8:11], v[68:71]
ds_read_b64_tr_b16 a[66:67], v25 offset:12928
v_mfma_f32_16x16x32_bf16 v[72:75], a[20:23], a[12:15], v[72:75]
ds_read_b64_tr_b16 a[68:69], v25 offset:12448
ds_read_b64_tr_b16 a[70:71], v25 offset:12960
v_mfma_f32_16x16x32_bf16 v[76:79], a[24:27], a[0:3], v[76:79]
buffer_load_dwordx4 v19, s[20:23], s54 offen offset:1024 lds
v_mfma_f32_16x16x32_bf16 v[80:83], a[24:27], a[4:7], v[80:83]
ds_read_b64_tr_b16 a[72:73], v25 offset:13440
v_mfma_f32_16x16x32_bf16 v[84:87], a[24:27], a[8:11], v[84:87]
ds_read_b64_tr_b16 a[74:75], v25 offset:13952
v_mfma_f32_16x16x32_bf16 v[88:91], a[24:27], a[12:15], v[88:91]
ds_read_b64_tr_b16 a[76:77], v25 offset:13472
ds_read_b64_tr_b16 a[78:79], v25 offset:13984
v_mfma_f32_16x16x32_bf16 v[244:247], a[24:27], a[16:19], v[244:247]
buffer_load_dwordx4 v20, s[20:23], s54 offen offset:2048 lds
v_mfma_f32_16x16x32_bf16 v[92:95], a[28:31], a[0:3], v[92:95]
s_add_u32 s54, s54, 196608
v_mfma_f32_16x16x32_bf16 v[96:99], a[28:31], a[4:7], v[96:99]
ds_read_b128 a[44:47], v23 offset:9216
s_add_u32 m0, s55, 0
v_mfma_f32_16x16x32_bf16 v[100:103], a[28:31], a[8:11], v[100:103]
buffer_load_dwordx4 v21, s[16:19], s52 offen sc1 lds
v_mfma_f32_16x16x32_bf16 v[104:107], a[28:31], a[12:15], v[104:107]
ds_read_b128 a[48:51], v23 offset:10240
v_mfma_f32_16x16x32_bf16 v[108:111], a[32:35], a[0:3], v[108:111]
ds_read_b64_tr_b16 a[80:81], v25 offset:14464
ds_read_b64_tr_b16 a[82:83], v25 offset:14976
v_mfma_f32_16x16x32_bf16 v[112:115], a[32:35], a[4:7], v[112:115]
ds_read_b128 a[52:55], v23 offset:11520
v_mfma_f32_16x16x32_bf16 v[116:119], a[32:35], a[8:11], v[116:119]
buffer_load_dwordx4 v21, s[16:19], s52 offen offset:1024 sc1 lds
v_mfma_f32_16x16x32_bf16 v[120:123], a[32:35], a[12:15], v[120:123]
ds_read_b128 a[56:59], v23 offset:12544
v_mfma_f32_16x16x32_bf16 v[124:127], a[0:3], a[36:39], v[124:127]
ds_read_b64_tr_b16 a[84:85], v25 offset:14496
ds_read_b64_tr_b16 a[86:87], v25 offset:15008
v_mfma_f32_16x16x32_bf16 v[128:131], a[4:7], a[36:39], v[128:131]
buffer_load_dword v22, s[16:19], s52 offen offset:2048 sc1 lds
v_mfma_f32_16x16x32_bf16 v[132:135], a[8:11], a[36:39], v[132:135]
.Lpad5:
s_cbranch_execz .Lnopoll8r
s_add_u32 s52, s52, 0x20000
v_mfma_f32_16x16x32_bf16 v[136:139], a[12:15], a[36:39], v[136:139]
ds_read_b128 a[60:63], v24 offset:11264
v_mfma_f32_16x16x32_bf16 v[156:159], a[16:19], a[36:39], v[156:159]
s_mov_b32 s67, 29360128
v_mfma_f32_16x16x32_bf16 v[140:143], a[0:3], a[40:43], v[140:143]
buffer_load_dwordx4 v[164:167], v26, s[16:19], s67 offen sc1
v_mfma_f32_16x16x32_bf16 v[144:147], a[4:7], a[40:43], v[144:147]
v_mfma_f32_16x16x32_bf16 v[148:151], a[8:11], a[40:43], v[148:151]
v_mfma_f32_16x16x32_bf16 v[152:155], a[12:15], a[40:43], v[152:155]
v_mfma_f32_16x16x32_bf16 v[160:163], a[16:19], a[40:43], v[160:163]
s_waitcnt vmcnt(27) lgkmcnt(0)
s_barrier
v_mfma_f32_16x16x32_bf16 v[60:63], a[64:67], a[44:47], v[60:63]
ds_read_b64_tr_b16 a[20:21], v25 offset:24832
s_add_u32 m0, s56, 78976
v_mfma_f32_16x16x32_bf16 v[64:67], a[64:67], a[48:51], v[64:67]
buffer_load_dwordx4 v18, s[20:23], s54 offen lds
v_mfma_f32_16x16x32_bf16 v[68:71], a[64:67], a[52:55], v[68:71]
ds_read_b64_tr_b16 a[22:23], v25 offset:25344
v_mfma_f32_16x16x32_bf16 v[72:75], a[64:67], a[56:59], v[72:75]
ds_read_b64_tr_b16 a[24:25], v25 offset:24864
ds_read_b64_tr_b16 a[26:27], v25 offset:25376
v_mfma_f32_16x16x32_bf16 v[76:79], a[68:71], a[44:47], v[76:79]
buffer_load_dwordx4 v19, s[20:23], s54 offen offset:1024 lds
v_mfma_f32_16x16x32_bf16 v[80:83], a[68:71], a[48:51], v[80:83]
ds_read_b64_tr_b16 a[28:29], v25 offset:25856
v_mfma_f32_16x16x32_bf16 v[84:87], a[68:71], a[52:55], v[84:87]
ds_read_b64_tr_b16 a[30:31], v25 offset:26368
v_mfma_f32_16x16x32_bf16 v[88:91], a[68:71], a[56:59], v[88:91]
ds_read_b64_tr_b16 a[32:33], v25 offset:25888
ds_read_b64_tr_b16 a[34:35], v25 offset:26400
v_mfma_f32_16x16x32_bf16 v[244:247], a[68:71], a[60:63], v[244:247]
buffer_load_dwordx4 v20, s[20:23], s54 offen offset:2048 lds
v_mfma_f32_16x16x32_bf16 v[92:95], a[72:75], a[44:47], v[92:95]
s_add_u32 s54, s54, 196608
v_mfma_f32_16x16x32_bf16 v[96:99], a[72:75], a[48:51], v[96:99]
ds_read_b128 a[0:3], v23 offset:18432
s_add_u32 m0, s55, 9216
v_mfma_f32_16x16x32_bf16 v[100:103], a[72:75], a[52:55], v[100:103]
buffer_load_dwordx4 v21, s[16:19], s52 offen sc1 lds
v_mfma_f32_16x16x32_bf16 v[104:107], a[72:75], a[56:59], v[104:107]
ds_read_b128 a[4:7], v23 offset:19456
v_mfma_f32_16x16x32_bf16 v[108:111], a[76:79], a[44:47], v[108:111]
ds_read_b64_tr_b16 a[36:37], v25 offset:26880
ds_read_b64_tr_b16 a[38:39], v25 offset:27392
v_mfma_f32_16x16x32_bf16 v[112:115], a[76:79], a[48:51], v[112:115]
ds_read_b128 a[8:11], v23 offset:20736
v_mfma_f32_16x16x32_bf16 v[116:119], a[76:79], a[52:55], v[116:119]
buffer_load_dwordx4 v21, s[16:19], s52 offen offset:1024 sc1 lds
v_mfma_f32_16x16x32_bf16 v[120:123], a[76:79], a[56:59], v[120:123]
ds_read_b128 a[12:15], v23 offset:21760
v_mfma_f32_16x16x32_bf16 v[124:127], a[44:47], a[80:83], v[124:127]
ds_read_b64_tr_b16 a[40:41], v25 offset:26912
ds_read_b64_tr_b16 a[42:43], v25 offset:27424
v_mfma_f32_16x16x32_bf16 v[128:131], a[48:51], a[80:83], v[128:131]
buffer_load_dword v22, s[16:19], s52 offen offset:2048 sc1 lds
v_mfma_f32_16x16x32_bf16 v[132:135], a[52:55], a[80:83], v[132:135]
s_add_u32 s52, s52, 0x20000
v_mfma_f32_16x16x32_bf16 v[136:139], a[56:59], a[80:83], v[136:139]
ds_read_b128 a[16:19], v24 offset:20480
v_mfma_f32_16x16x32_bf16 v[156:159], a[60:63], a[80:83], v[156:159]
v_mfma_f32_16x16x32_bf16 v[140:143], a[44:47], a[84:87], v[140:143]
buffer_load_dwordx4 v[168:171], v26, s[16:19], s67 offen offset:1024 sc1
v_mfma_f32_16x16x32_bf16 v[144:147], a[48:51], a[84:87], v[144:147]
v_mfma_f32_16x16x32_bf16 v[148:151], a[52:55], a[84:87], v[148:151]
v_mfma_f32_16x16x32_bf16 v[152:155], a[56:59], a[84:87], v[152:155]
v_mfma_f32_16x16x32_bf16 v[160:163], a[60:63], a[84:87], v[160:163]
s_waitcnt vmcnt(27) lgkmcnt(0)
s_barrier
v_mfma_f32_16x16x32_bf16 v[60:63], a[20:23], a[0:3], v[60:63]
ds_read_b64_tr_b16 a[64:65], v25 offset:37248
ds_read_b64_tr_b16 a[66:67], v25 offset:37760
v_mfma_f32_16x16x32_bf16 v[64:67], a[20:23], a[4:7], v[64:67]
buffer_load_dwordx4 v[172:175], v26, s[16:19], s67 offen offset:2048 sc1
v_mfma_f32_16x16x32_bf16 v[68:71], a[20:23], a[8:11], v[68:71]
ds_read_b64_tr_b16 a[68:69], v25 offset:37280
v_mfma_f32_16x16x32_bf16 v[72:75], a[20:23], a[12:15], v[72:75]
ds_read_b64_tr_b16 a[70:71], v25 offset:37792
v_mfma_f32_16x16x32_bf16 v[76:79], a[24:27], a[0:3], v[76:79]
ds_read_b64_tr_b16 a[72:73], v25 offset:38272
v_mfma_f32_16x16x32_bf16 v[80:83], a[24:27], a[4:7], v[80:83]
buffer_load_dwordx4 v[176:179], v26, s[16:19], s67 offen offset:3072 sc1
v_mfma_f32_16x16x32_bf16 v[84:87], a[24:27], a[8:11], v[84:87]
ds_read_b64_tr_b16 a[74:75], v25 offset:38784
v_mfma_f32_16x16x32_bf16 v[88:91], a[24:27], a[12:15], v[88:91]
ds_read_b64_tr_b16 a[76:77], v25 offset:38304
v_mfma_f32_16x16x32_bf16 v[244:247], a[24:27], a[16:19], v[244:247]
ds_read_b64_tr_b16 a[78:79], v25 offset:38816
s_mov_b32 s67, 29364224
v_mfma_f32_16x16x32_bf16 v[92:95], a[28:31], a[0:3], v[92:95]
buffer_load_dwordx4 v[180:183], v26, s[16:19], s67 offen sc1
v_mfma_f32_16x16x32_bf16 v[96:99], a[28:31], a[4:7], v[96:99]
ds_read_b128 a[44:47], v23 offset:27648
v_mfma_f32_16x16x32_bf16 v[100:103], a[28:31], a[8:11], v[100:103]
ds_read_b128 a[48:51], v23 offset:28672
v_mfma_f32_16x16x32_bf16 v[104:107], a[28:31], a[12:15], v[104:107]
ds_read_b64_tr_b16 a[80:81], v25 offset:39296
v_mfma_f32_16x16x32_bf16 v[108:111], a[32:35], a[0:3], v[108:111]
buffer_load_dwordx4 v[184:187], v26, s[16:19], s67 offen offset:1024 sc1
v_mfma_f32_16x16x32_bf16 v[112:115], a[32:35], a[4:7], v[112:115]
ds_read_b64_tr_b16 a[82:83], v25 offset:39808
v_mfma_f32_16x16x32_bf16 v[116:119], a[32:35], a[8:11], v[116:119]
ds_read_b128 a[52:55], v23 offset:29952
v_mfma_f32_16x16x32_bf16 v[120:123], a[32:35], a[12:15], v[120:123]
ds_read_b128 a[56:59], v23 offset:30976
v_mfma_f32_16x16x32_bf16 v[124:127], a[0:3], a[36:39], v[124:127]
buffer_load_dwordx4 v[188:191], v26, s[16:19], s67 offen offset:2048 sc1
v_mfma_f32_16x16x32_bf16 v[128:131], a[4:7], a[36:39], v[128:131]
ds_read_b64_tr_b16 a[84:85], v25 offset:39328
v_mfma_f32_16x16x32_bf16 v[132:135], a[8:11], a[36:39], v[132:135]
ds_read_b64_tr_b16 a[86:87], v25 offset:39840
v_mfma_f32_16x16x32_bf16 v[136:139], a[12:15], a[36:39], v[136:139]
ds_read_b128 a[60:63], v24 offset:29696
v_mfma_f32_16x16x32_bf16 v[156:159], a[16:19], a[36:39], v[156:159]
buffer_load_dwordx4 v[192:195], v26, s[16:19], s67 offen offset:3072 sc1
v_mfma_f32_16x16x32_bf16 v[140:143], a[0:3], a[40:43], v[140:143]
v_mfma_f32_16x16x32_bf16 v[144:147], a[4:7], a[40:43], v[144:147]
v_mfma_f32_16x16x32_bf16 v[148:151], a[8:11], a[40:43], v[148:151]
v_mfma_f32_16x16x32_bf16 v[152:155], a[12:15], a[40:43], v[152:155]
v_mfma_f32_16x16x32_bf16 v[160:163], a[16:19], a[40:43], v[160:163]
s_waitcnt vmcnt(27) lgkmcnt(0)
s_barrier
v_mfma_f32_16x16x32_bf16 v[60:63], a[64:67], a[44:47], v[60:63]
ds_read_b64_tr_b16 a[20:21], v25 offset:49664
s_add_u32 m0, s59, 58240
s_mov_b32 s58, 1966080
v_mfma_f32_16x16x32_bf16 v[64:67], a[64:67], a[48:51], v[64:67]
buffer_load_dwordx4 v5, s[24:27], s58 offen lds
v_mfma_f32_16x16x32_bf16 v[68:71], a[64:67], a[52:55], v[68:71]
ds_read_b64_tr_b16 a[22:23], v25 offset:50176
v_mfma_f32_16x16x32_bf16 v[72:75], a[64:67], a[56:59], v[72:75]
ds_read_b64_tr_b16 a[24:25], v25 offset:49696
v_mfma_f32_16x16x32_bf16 v[76:79], a[68:71], a[44:47], v[76:79]
ds_read_b64_tr_b16 a[26:27], v25 offset:50208
ds_read_b64_tr_b16 a[28:29], v25 offset:50688
v_mfma_f32_16x16x32_bf16 v[80:83], a[68:71], a[48:51], v[80:83]
buffer_load_dwordx4 v6, s[24:27], s58 offen offset:1024 lds
v_mfma_f32_16x16x32_bf16 v[84:87], a[68:71], a[52:55], v[84:87]
ds_read_b64_tr_b16 a[30:31], v25 offset:51200
v_mfma_f32_16x16x32_bf16 v[88:91], a[68:71], a[56:59], v[88:91]
ds_read_b64_tr_b16 a[32:33], v25 offset:50720
v_mfma_f32_16x16x32_bf16 v[244:247], a[68:71], a[60:63], v[244:247]
ds_read_b64_tr_b16 a[34:35], v25 offset:51232
s_add_u32 m0, s59, 91520
s_mov_b32 s58, 393216
v_mfma_f32_16x16x32_bf16 v[92:95], a[72:75], a[44:47], v[92:95]
buffer_load_dwordx4 v5, s[24:27], s58 offen lds
v_mfma_f32_16x16x32_bf16 v[96:99], a[72:75], a[48:51], v[96:99]
ds_read_b128 a[0:3], v23 offset:36864
v_mfma_f32_16x16x32_bf16 v[100:103], a[72:75], a[52:55], v[100:103]
ds_read_b128 a[4:7], v23 offset:37888
v_mfma_f32_16x16x32_bf16 v[104:107], a[72:75], a[56:59], v[104:107]
ds_read_b64_tr_b16 a[36:37], v25 offset:51712
v_mfma_f32_16x16x32_bf16 v[108:111], a[76:79], a[44:47], v[108:111]
buffer_load_dwordx4 v6, s[24:27], s58 offen offset:1024 lds
v_mfma_f32_16x16x32_bf16 v[112:115], a[76:79], a[48:51], v[112:115]
ds_read_b64_tr_b16 a[38:39], v25 offset:52224
v_mfma_f32_16x16x32_bf16 v[116:119], a[76:79], a[52:55], v[116:119]
ds_read_b128 a[8:11], v23 offset:39168
v_mfma_f32_16x16x32_bf16 v[120:123], a[76:79], a[56:59], v[120:123]
ds_read_b128 a[12:15], v23 offset:40192
s_add_u32 m0, s59, 24960
s_mov_b32 s58, 1441792
v_mfma_f32_16x16x32_bf16 v[124:127], a[44:47], a[80:83], v[124:127]
buffer_load_dwordx4 v5, s[24:27], s58 offen lds
v_mfma_f32_16x16x32_bf16 v[128:131], a[48:51], a[80:83], v[128:131]
ds_read_b64_tr_b16 a[40:41], v25 offset:51744
v_mfma_f32_16x16x32_bf16 v[132:135], a[52:55], a[80:83], v[132:135]
ds_read_b64_tr_b16 a[42:43], v25 offset:52256
v_mfma_f32_16x16x32_bf16 v[136:139], a[56:59], a[80:83], v[136:139]
ds_read_b128 a[16:19], v24 offset:38912
v_mfma_f32_16x16x32_bf16 v[156:159], a[60:63], a[80:83], v[156:159]
buffer_load_dwordx4 v6, s[24:27], s58 offen offset:1024 lds
v_mfma_f32_16x16x32_bf16 v[140:143], a[44:47], a[84:87], v[140:143]
v_mfma_f32_16x16x32_bf16 v[144:147], a[48:51], a[84:87], v[144:147]
v_mfma_f32_16x16x32_bf16 v[148:151], a[52:55], a[84:87], v[148:151]
v_mfma_f32_16x16x32_bf16 v[152:155], a[56:59], a[84:87], v[152:155]
v_mfma_f32_16x16x32_bf16 v[160:163], a[60:63], a[84:87], v[160:163]
s_waitcnt vmcnt(27) lgkmcnt(0)
s_barrier
v_mfma_f32_16x16x32_bf16 v[60:63], a[20:23], a[0:3], v[60:63]
ds_read_b64_tr_b16 a[64:65], v25 offset:62080
s_add_u32 m0, s59, 99840
s_mov_b32 s58, 524288
v_mfma_f32_16x16x32_bf16 v[64:67], a[20:23], a[4:7], v[64:67]
buffer_load_dwordx4 v5, s[24:27], s58 offen lds
v_mfma_f32_16x16x32_bf16 v[68:71], a[20:23], a[8:11], v[68:71]
ds_read_b64_tr_b16 a[66:67], v25 offset:62592
s_waitcnt vmcnt(10)
v_add_f32 v164, v164, v180
v_mfma_f32_16x16x32_bf16 v[72:75], a[20:23], a[12:15], v[72:75]
ds_read_b64_tr_b16 a[68:69], v25 offset:62112
v_add_f32 v165, v165, v181
v_mfma_f32_16x16x32_bf16 v[76:79], a[24:27], a[0:3], v[76:79]
ds_read_b64_tr_b16 a[70:71], v25 offset:62624
ds_read_b64_tr_b16 a[72:73], v25 offset:63104
v_mfma_f32_16x16x32_bf16 v[80:83], a[24:27], a[4:7], v[80:83]
buffer_load_dwordx4 v6, s[24:27], s58 offen offset:1024 lds
v_mfma_f32_16x16x32_bf16 v[84:87], a[24:27], a[8:11], v[84:87]
ds_read_b64_tr_b16 a[74:75], v25 offset:63616
v_add_f32 v166, v166, v182
v_mfma_f32_16x16x32_bf16 v[88:91], a[24:27], a[12:15], v[88:91]
ds_read_b64_tr_b16 a[76:77], v25 offset:63136
v_mfma_f32_16x16x32_bf16 v[244:247], a[24:27], a[16:19], v[244:247]
ds_read_b64_tr_b16 a[78:79], v25 offset:63648
s_add_u32 m0, s59, 33280
s_mov_b32 s58, 1572864
v_mfma_f32_16x16x32_bf16 v[92:95], a[28:31], a[0:3], v[92:95]
buffer_load_dwordx4 v5, s[24:27], s58 offen lds
v_mfma_f32_16x16x32_bf16 v[96:99], a[28:31], a[4:7], v[96:99]
ds_read_b128 a[44:47], v23 offset:46080
v_add_f32 v167, v167, v183
v_mfma_f32_16x16x32_bf16 v[100:103], a[28:31], a[8:11], v[100:103]
ds_read_b128 a[48:51], v23 offset:47104
s_waitcnt vmcnt(11)
v_add_f32 v168, v168, v184
v_mfma_f32_16x16x32_bf16 v[104:107], a[28:31], a[12:15], v[104:107]
ds_read_b64_tr_b16 a[80:81], v25 offset:64128
v_mfma_f32_16x16x32_bf16 v[108:111], a[32:35], a[0:3], v[108:111]
buffer_load_dwordx4 v6, s[24:27], s58 offen offset:1024 lds
v_mfma_f32_16x16x32_bf16 v[112:115], a[32:35], a[4:7], v[112:115]
ds_read_b64_tr_b16 a[82:83], v25 offset:64640
v_add_f32 v169, v169, v185
v_mfma_f32_16x16x32_bf16 v[116:119], a[32:35], a[8:11], v[116:119]
ds_read_b128 a[52:55], v23 offset:48384
v_add_f32 v170, v170, v186
v_mfma_f32_16x16x32_bf16 v[120:123], a[32:35], a[12:15], v[120:123]
ds_read_b128 a[56:59], v23 offset:49408
s_add_u32 m0, s59, 108160
s_mov_b32 s58, 655360
v_mfma_f32_16x16x32_bf16 v[124:127], a[0:3], a[36:39], v[124:127]
buffer_load_dwordx4 v5, s[24:27], s58 offen lds
v_mfma_f32_16x16x32_bf16 v[128:131], a[4:7], a[36:39], v[128:131]
ds_read_b64_tr_b16 a[84:85], v25 offset:64160
v_mfma_f32_16x16x32_bf16 v[132:135], a[8:11], a[36:39], v[132:135]
ds_read_b64_tr_b16 a[86:87], v25 offset:64672
v_add_f32 v171, v171, v187
v_mfma_f32_16x16x32_bf16 v[136:139], a[12:15], a[36:39], v[136:139]
ds_read_b128 a[60:63], v24 offset:48128
s_waitcnt vmcnt(12)
v_add_f32 v172, v172, v188
v_mfma_f32_16x16x32_bf16 v[156:159], a[16:19], a[36:39], v[156:159]
buffer_load_dwordx4 v6, s[24:27], s58 offen offset:1024 lds
v_mfma_f32_16x16x32_bf16 v[140:143], a[0:3], a[40:43], v[140:143]
v_add_f32 v173, v173, v189
v_mfma_f32_16x16x32_bf16 v[144:147], a[4:7], a[40:43], v[144:147]
v_add_f32 v174, v174, v190
v_add_f32 v175, v175, v191
v_mfma_f32_16x16x32_bf16 v[148:151], a[8:11], a[40:43], v[148:151]
s_waitcnt vmcnt(12)
v_add_f32 v176, v176, v192
v_mfma_f32_16x16x32_bf16 v[152:155], a[12:15], a[40:43], v[152:155]
v_add_f32 v177, v177, v193
v_mfma_f32_16x16x32_bf16 v[160:163], a[16:19], a[40:43], v[160:163]
s_waitcnt lgkmcnt(0)
s_barrier
v_mfma_f32_16x16x32_bf16 v[60:63], a[64:67], a[44:47], v[60:63]
ds_read_b64_tr_b16 a[20:21], v25
s_add_u32 m0, s59, 116480
s_mov_b32 s58, 786432
v_mfma_f32_16x16x32_bf16 v[64:67], a[64:67], a[48:51], v[64:67]
buffer_load_dwordx4 v5, s[24:27], s58 offen lds
v_mfma_f32_16x16x32_bf16 v[68:71], a[64:67], a[52:55], v[68:71]
ds_read_b64_tr_b16 a[22:23], v25 offset:512
v_add_f32 v178, v178, v194
v_mfma_f32_16x16x32_bf16 v[72:75], a[64:67], a[56:59], v[72:75]
ds_read_b64_tr_b16 a[24:25], v25 offset:32
v_add_f32 v179, v179, v195
v_mfma_f32_16x16x32_bf16 v[76:79], a[68:71], a[44:47], v[76:79]
ds_read_b64_tr_b16 a[26:27], v25 offset:544
ds_read_b64_tr_b16 a[28:29], v25 offset:1024
v_mfma_f32_16x16x32_bf16 v[80:83], a[68:71], a[48:51], v[80:83]
buffer_load_dwordx4 v6, s[24:27], s58 offen offset:1024 lds
v_mfma_f32_16x16x32_bf16 v[84:87], a[68:71], a[52:55], v[84:87]
ds_read_b64_tr_b16 a[30:31], v25 offset:1536
v_add_f32 v164, v164, v172
v_mfma_f32_16x16x32_bf16 v[88:91], a[68:71], a[56:59], v[88:91]
ds_read_b64_tr_b16 a[32:33], v25 offset:1056
v_mfma_f32_16x16x32_bf16 v[244:247], a[68:71], a[60:63], v[244:247]
ds_read_b64_tr_b16 a[34:35], v25 offset:1568
s_add_u32 m0, s59, 41600
s_mov_b32 s58, 1703936
v_mfma_f32_16x16x32_bf16 v[92:95], a[72:75], a[44:47], v[92:95]
buffer_load_dwordx4 v5, s[24:27], s58 offen lds
v_mfma_f32_16x16x32_bf16 v[96:99], a[72:75], a[48:51], v[96:99]
ds_read_b128 a[0:3], v23
v_add_f32 v165, v165, v173
v_mfma_f32_16x16x32_bf16 v[100:103], a[72:75], a[52:55], v[100:103]
ds_read_b128 a[4:7], v23 offset:1024
v_add_f32 v166, v166, v174
v_mfma_f32_16x16x32_bf16 v[104:107], a[72:75], a[56:59], v[104:107]
ds_read_b64_tr_b16 a[36:37], v25 offset:2048
v_mfma_f32_16x16x32_bf16 v[108:111], a[76:79], a[44:47], v[108:111]
buffer_load_dwordx4 v6, s[24:27], s58 offen offset:1024 lds
v_mfma_f32_16x16x32_bf16 v[112:115], a[76:79], a[48:51], v[112:115]
ds_read_b64_tr_b16 a[38:39], v25 offset:2560
v_add_f32 v167, v167, v175
v_mfma_f32_16x16x32_bf16 v[116:119], a[76:79], a[52:55], v[116:119]
ds_read_b128 a[8:11], v23 offset:2304
v_add_f32 v168, v168, v176
v_mfma_f32_16x16x32_bf16 v[120:123], a[76:79], a[56:59], v[120:123]
ds_read_b128 a[12:15], v23 offset:3328
s_add_u32 m0, s59, 49920
s_mov_b32 s58, 1835008
v_mfma_f32_16x16x32_bf16 v[124:127], a[44:47], a[80:83], v[124:127]
buffer_load_dwordx4 v5, s[24:27], s58 offen lds
v_mfma_f32_16x16x32_bf16 v[128:131], a[48:51], a[80:83], v[128:131]
ds_read_b64_tr_b16 a[40:41], v25 offset:2080
v_mfma_f32_16x16x32_bf16 v[132:135], a[52:55], a[80:83], v[132:135]
ds_read_b64_tr_b16 a[42:43], v25 offset:2592
v_add_f32 v169, v169, v177
v_mfma_f32_16x16x32_bf16 v[136:139], a[56:59], a[80:83], v[136:139]
ds_read_b128 a[16:19], v24 offset:2048
v_add_f32 v170, v170, v178
v_mfma_f32_16x16x32_bf16 v[156:159], a[60:63], a[80:83], v[156:159]
buffer_load_dwordx4 v6, s[24:27], s58 offen offset:1024 lds
v_mfma_f32_16x16x32_bf16 v[140:143], a[44:47], a[84:87], v[140:143]
v_add_f32 v171, v171, v179
v_mfma_f32_16x16x32_bf16 v[144:147], a[48:51], a[84:87], v[144:147]
v_add_f32 v164, v164, v168
v_add_f32 v165, v165, v169
v_mfma_f32_16x16x32_bf16 v[148:151], a[52:55], a[84:87], v[148:151]
v_add_f32 v166, v166, v170
v_mfma_f32_16x16x32_bf16 v[152:155], a[56:59], a[84:87], v[152:155]
v_add_f32 v167, v167, v171
v_mfma_f32_16x16x32_bf16 v[160:163], a[60:63], a[84:87], v[160:163]
s_waitcnt lgkmcnt(0)
s_barrier
v_mfma_f32_16x16x32_bf16 v[60:63], a[20:23], a[0:3], v[60:63]
ds_read_b64_tr_b16 a[64:65], v25 offset:12416
s_add_u32 m0, s59, 124800
s_mov_b32 s58, 917504
v_mfma_f32_16x16x32_bf16 v[64:67], a[20:23], a[4:7], v[64:67]
buffer_load_dwordx4 v5, s[24:27], s58 offen lds
v_mfma_f32_16x16x32_bf16 v[68:71], a[20:23], a[8:11], v[68:71]
ds_read_b64_tr_b16 a[66:67], v25 offset:12928
v_permlane32_swap_b32 v164, v166
v_mfma_f32_16x16x32_bf16 v[72:75], a[20:23], a[12:15], v[72:75]
ds_read_b64_tr_b16 a[68:69], v25 offset:12448
v_permlane32_swap_b32 v165, v167
v_mfma_f32_16x16x32_bf16 v[76:79], a[24:27], a[0:3], v[76:79]
ds_read_b64_tr_b16 a[70:71], v25 offset:12960
v_mfma_f32_16x16x32_bf16 v[80:83], a[24:27], a[4:7], v[80:83]
ds_read_b64_tr_b16 a[72:73], v25 offset:13440
v_add_f32 v164, v164, v166
v_mfma_f32_16x16x32_bf16 v[84:87], a[24:27], a[8:11], v[84:87]
ds_read_b64_tr_b16 a[74:75], v25 offset:13952
v_mfma_f32_16x16x32_bf16 v[88:91], a[24:27], a[12:15], v[88:91]
buffer_load_dwordx4 v6, s[24:27], s58 offen offset:1024 lds
v_mfma_f32_16x16x32_bf16 v[244:247], a[24:27], a[16:19], v[244:247]
ds_read_b64_tr_b16 a[76:77], v25 offset:13472
v_add_f32 v165, v165, v167
v_mfma_f32_16x16x32_bf16 v[92:95], a[28:31], a[0:3], v[92:95]
ds_read_b64_tr_b16 a[78:79], v25 offset:13984
v_mul_f32 v164, 0xba800000, v164
v_mfma_f32_16x16x32_bf16 v[96:99], a[28:31], a[4:7], v[96:99]
ds_read_b128 a[44:47], v23 offset:9216
ds_read_b128 a[48:51], v23 offset:10240
v_mfma_f32_16x16x32_bf16 v[100:103], a[28:31], a[8:11], v[100:103]
ds_read_b64_tr_b16 a[80:81], v25 offset:14464
v_mfma_f32_16x16x32_bf16 v[104:107], a[28:31], a[12:15], v[104:107]
s_add_u32 m0, s59, 0
s_mov_b32 s58, 1048576
v_mul_f32 v165, 0x3a800000, v165
v_mfma_f32_16x16x32_bf16 v[108:111], a[32:35], a[0:3], v[108:111]
buffer_load_dwordx4 v5, s[24:27], s58 offen lds
v_mfma_f32_16x16x32_bf16 v[112:115], a[32:35], a[4:7], v[112:115]
ds_read_b64_tr_b16 a[82:83], v25 offset:14976
v_mfma_f32_16x16x32_bf16 v[116:119], a[32:35], a[8:11], v[116:119]
ds_read_b128 a[52:55], v23 offset:11520
v_fma_f32 v165, -v164, v164, v165
v_mfma_f32_16x16x32_bf16 v[120:123], a[32:35], a[12:15], v[120:123]
ds_read_b128 a[56:59], v23 offset:12544
v_max_f32 v165, 0, v165
v_mfma_f32_16x16x32_bf16 v[124:127], a[0:3], a[36:39], v[124:127]
ds_read_b64_tr_b16 a[84:85], v25 offset:14496
v_mfma_f32_16x16x32_bf16 v[128:131], a[4:7], a[36:39], v[128:131]
ds_read_b64_tr_b16 a[86:87], v25 offset:15008
v_add_f32 v165, 0x3727c5ac, v165
v_mfma_f32_16x16x32_bf16 v[132:135], a[8:11], a[36:39], v[132:135]
buffer_load_dwordx4 v6, s[24:27], s58 offen offset:1024 lds
v_mfma_f32_16x16x32_bf16 v[136:139], a[12:15], a[36:39], v[136:139]
ds_read_b128 a[60:63], v24 offset:11264
v_mfma_f32_16x16x32_bf16 v[156:159], a[16:19], a[36:39], v[156:159]
v_rsq_f32 v166, v165
s_nop 0
v_mov_b32 v165, v166
v_mfma_f32_16x16x32_bf16 v[140:143], a[0:3], a[40:43], v[140:143]
v_mul_f32 v166, 0x3e8293ee, v166
v_mfma_f32_16x16x32_bf16 v[144:147], a[4:7], a[40:43], v[144:147]
ds_write_b128 v7, v[164:167]
v_mfma_f32_16x16x32_bf16 v[148:151], a[8:11], a[40:43], v[148:151]
ds_write_b32 v17, v164
v_mfma_f32_16x16x32_bf16 v[152:155], a[12:15], a[40:43], v[152:155]
ds_write_b32 v17, v165 offset:1024
v_mfma_f32_16x16x32_bf16 v[160:163], a[16:19], a[40:43], v[160:163]
s_waitcnt lgkmcnt(0)
s_barrier
v_mfma_f32_16x16x32_bf16 v[244:247], a[68:71], a[60:63], v[244:247]
ds_read_b128 v[232:235], v10 offset:1792
v_mfma_f32_16x16x32_bf16 v[156:159], a[60:63], a[80:83], v[156:159]
ds_read_b128 v[228:231], v10 offset:1536
v_mfma_f32_16x16x32_bf16 v[160:163], a[60:63], a[84:87], v[160:163]
ds_read_b128 v[224:227], v10 offset:1280
v_mfma_f32_16x16x32_bf16 v[104:107], a[72:75], a[56:59], v[104:107]
ds_read_b128 v[220:223], v10 offset:1024
v_mfma_f32_16x16x32_bf16 v[120:123], a[76:79], a[56:59], v[120:123]
v_mfma_f32_16x16x32_bf16 v[136:139], a[56:59], a[80:83], v[136:139]
v_mfma_f32_16x16x32_bf16 v[152:155], a[56:59], a[84:87], v[152:155]
v_mfma_f32_16x16x32_bf16 v[100:103], a[72:75], a[52:55], v[100:103]
v_mfma_f32_16x16x32_bf16 v[116:119], a[76:79], a[52:55], v[116:119]
s_mov_b32 exec_lo, 0x10001
s_mov_b32 exec_hi, 0x10001
ds_write_b128 v13, v[244:247] offset:64
s_mov_b64 exec, 0xffff
ds_write_b32 v12, v156 offset:512
ds_write_b32 v12, v160 offset:576
s_mov_b64 exec, -1
v_mfma_f32_16x16x32_bf16 v[96:99], a[72:75], a[48:51], v[96:99]
v_mfma_f32_16x16x32_bf16 v[112:115], a[76:79], a[48:51], v[112:115]
v_mfma_f32_16x16x32_bf16 v[92:95], a[72:75], a[44:47], v[92:95]
v_mfma_f32_16x16x32_bf16 v[108:111], a[76:79], a[44:47], v[108:111]
v_mfma_f32_16x16x32_bf16 v[72:75], a[64:67], a[56:59], v[72:75]
v_mfma_f32_16x16x32_bf16 v[88:91], a[68:71], a[56:59], v[88:91]
s_waitcnt lgkmcnt(0)
s_barrier
v_mfma_f32_16x16x32_bf16 v[132:135], a[52:55], a[80:83], v[132:135]
ds_read_b128 v[28:31], v13
s_add_u32 m0, s59, 66560
v_mfma_f32_16x16x32_bf16 v[148:151], a[52:55], a[84:87], v[148:151]
ds_read_b128 v[32:35], v13 offset:64
s_mov_b32 s58, 0
v_mfma_f32_16x16x32_bf16 v[68:71], a[64:67], a[52:55], v[68:71]
ds_read_b128 v[36:39], v13 offset:256
s_mov_b32 s67, 917504
v_mfma_f32_16x16x32_bf16 v[84:87], a[68:71], a[52:55], v[84:87]
ds_read_b128 v[40:43], v13 offset:320
v_mfma_f32_16x16x32_bf16 v[128:131], a[48:51], a[80:83], v[128:131]
ds_read_b32 v44, v12 offset:512
v_mfma_f32_16x16x32_bf16 v[144:147], a[48:51], a[84:87], v[144:147]
ds_read_b32 v45, v12 offset:576
v_mfma_f32_16x16x32_bf16 v[64:67], a[64:67], a[48:51], v[64:67]
ds_read_b128 v[240:243], v11 offset:704
v_mfma_f32_16x16x32_bf16 v[80:83], a[68:71], a[48:51], v[80:83]
ds_read_b128 v[244:247], v11 offset:1728
buffer_load_dwordx4 v5, s[24:27], s58 offen lds
ds_read_b128 v[18:21], v11 offset:448
ds_read_b128 v[22:25], v11 offset:1472
s_waitcnt lgkmcnt(9)
v_pk_fma_f32 v[72:73], v[28:29], v[232:233], v[72:73] op_sel_hi:[1,0,1]
v_cvt_pk_bf16_f32 v176, v72, v73
v_pk_fma_f32 v[74:75], v[30:31], v[232:233], v[74:75] op_sel_hi:[1,0,1]
s_waitcnt lgkmcnt(7)
v_pk_fma_f32 v[104:105], v[36:37], v[232:233], v[104:105] op_sel_hi:[1,0,1]
v_pk_mul_f32 v[104:105], v[104:105], v[232:233] op_sel:[0,1] op_sel_hi:[1,1]
v_cvt_pk_bf16_f32 v196, v104, v105
v_pk_fma_f32 v[106:107], v[38:39], v[232:233], v[106:107] op_sel_hi:[1,0,1]
v_pk_mul_f32 v[106:107], v[106:107], v[232:233] op_sel:[0,1] op_sel_hi:[1,1]
v_cvt_pk_bf16_f32 v197, v106, v107
buffer_load_dwordx4 v6, s[24:27], s58 offen offset:1024 lds
s_add_u32 m0, s59, 8320
s_mov_b32 s58, 1179648
s_waitcnt lgkmcnt(6)
v_pk_fma_f32 v[120:121], v[40:41], v[232:233], v[120:121] op_sel_hi:[1,0,1]
v_pk_mul_f32 v[120:121], v[120:121], v[232:233] op_sel:[0,1] op_sel_hi:[1,1]
v_cvt_pk_bf16_f32 v198, v120, v121
v_pk_fma_f32 v[122:123], v[42:43], v[232:233], v[122:123] op_sel_hi:[1,0,1]
v_pk_mul_f32 v[122:123], v[122:123], v[232:233] op_sel:[0,1] op_sel_hi:[1,1]
s_waitcnt lgkmcnt(3)
v_pk_fma_f32 v[156:157], v[240:241], v[44:45], v[156:157] op_sel_hi:[1,0,1]
v_pk_fma_f32 v[158:159], v[242:243], v[44:45], v[158:159] op_sel_hi:[1,0,1]
v_pk_fma_f32 v[160:161], v[240:241], v[44:45], v[160:161] op_sel:[0,1,0] op_sel_hi:[1,1,1]
v_pk_fma_f32 v[162:163], v[242:243], v[44:45], v[162:163] op_sel:[0,1,0] op_sel_hi:[1,1,1]
s_waitcnt lgkmcnt(2)
v_pk_mul_f32 v[156:157], v[156:157], v[244:245]
v_cvt_pk_bf16_f32 v236, v156, v157
v_pk_mul_f32 v[158:159], v[158:159], v[246:247]
v_cvt_pk_bf16_f32 v237, v158, v159
v_pk_mul_f32 v[160:161], v[160:161], v[244:245]
v_cvt_pk_bf16_f32 v238, v160, v161
v_pk_mul_f32 v[162:163], v[162:163], v[246:247]
v_cvt_pk_bf16_f32 v239, v162, v163
ds_write_b128 v8, v[236:239] offset:1024
buffer_load_dwordx4 v5, s[24:27], s58 offen lds
v_cvt_pk_bf16_f32 v199, v122, v123
s_waitcnt lgkmcnt(2)
v_pk_fma_f32 v[136:137], v[18:19], v[44:45], v[136:137] op_sel_hi:[1,0,1]
s_waitcnt lgkmcnt(1)
v_pk_mul_f32 v[136:137], v[136:137], v[22:23]
v_cvt_pk_bf16_f32 v208, v136, v137
v_pk_fma_f32 v[138:139], v[20:21], v[44:45], v[138:139] op_sel_hi:[1,0,1]
v_pk_mul_f32 v[138:139], v[138:139], v[24:25]
v_cvt_pk_bf16_f32 v209, v138, v139
v_pk_fma_f32 v[152:153], v[18:19], v[44:45], v[152:153] op_sel:[0,1,0] op_sel_hi:[1,1,1]
v_pk_mul_f32 v[152:153], v[152:153], v[22:23]
v_cvt_pk_bf16_f32 v218, v152, v153
v_pk_fma_f32 v[154:155], v[20:21], v[44:45], v[154:155] op_sel:[0,1,0] op_sel_hi:[1,1,1]
v_pk_mul_f32 v[154:155], v[154:155], v[24:25]
v_cvt_pk_bf16_f32 v219, v154, v155
buffer_load_dwordx4 v6, s[24:27], s58 offen offset:1024 lds
s_add_u32 m0, s59, 16640
s_mov_b32 s58, 1310720
v_pk_fma_f32 v[100:101], v[36:37], v[228:229], v[100:101] op_sel_hi:[1,0,1]
v_pk_mul_f32 v[100:101], v[100:101], v[228:229] op_sel:[0,1] op_sel_hi:[1,1]
v_cvt_pk_bf16_f32 v192, v100, v101
v_pk_fma_f32 v[102:103], v[38:39], v[228:229], v[102:103] op_sel_hi:[1,0,1]
v_pk_mul_f32 v[102:103], v[102:103], v[228:229] op_sel:[0,1] op_sel_hi:[1,1]
v_cvt_pk_bf16_f32 v193, v102, v103
v_pk_fma_f32 v[116:117], v[40:41], v[228:229], v[116:117] op_sel_hi:[1,0,1]
v_pk_mul_f32 v[116:117], v[116:117], v[228:229] op_sel:[0,1] op_sel_hi:[1,1]
v_cvt_pk_bf16_f32 v194, v116, v117
s_waitcnt lgkmcnt(0)
s_barrier
ds_read_b128 v[180:183], v9
ds_read_b64 v[200:201], v9 offset:1024
ds_read_b64 v[210:211], v9 offset:1032
buffer_load_dwordx4 v5, s[24:27], s58 offen lds
v_pk_fma_f32 v[118:119], v[42:43], v[228:229], v[118:119] op_sel_hi:[1,0,1]
v_pk_mul_f32 v[118:119], v[118:119], v[228:229] op_sel:[0,1] op_sel_hi:[1,1]
v_cvt_pk_bf16_f32 v195, v118, v119
v_cvt_pk_bf16_f32 v177, v74, v75
v_pk_fma_f32 v[88:89], v[32:33], v[232:233], v[88:89] op_sel_hi:[1,0,1]
v_cvt_pk_bf16_f32 v178, v88, v89
v_pk_fma_f32 v[90:91], v[34:35], v[232:233], v[90:91] op_sel_hi:[1,0,1]
v_cvt_pk_bf16_f32 v179, v90, v91
ds_read_b128 v[240:243], v11 offset:384
ds_read_b128 v[244:247], v11 offset:1408
v_pk_fma_f32 v[96:97], v[36:37], v[224:225], v[96:97] op_sel_hi:[1,0,1]
buffer_load_dwordx4 v6, s[24:27], s58 offen offset:1024 lds
s_add_u32 m0, s59, 74880
s_mov_b32 s58, 131072
v_pk_mul_f32 v[96:97], v[96:97], v[224:225] op_sel:[0,1] op_sel_hi:[1,1]
v_cvt_pk_bf16_f32 v188, v96, v97
v_pk_fma_f32 v[98:99], v[38:39], v[224:225], v[98:99] op_sel_hi:[1,0,1]
v_pk_mul_f32 v[98:99], v[98:99], v[224:225] op_sel:[0,1] op_sel_hi:[1,1]
v_cvt_pk_bf16_f32 v189, v98, v99
v_pk_fma_f32 v[112:113], v[40:41], v[224:225], v[112:113] op_sel_hi:[1,0,1]
v_pk_mul_f32 v[112:113], v[112:113], v[224:225] op_sel:[0,1] op_sel_hi:[1,1]
v_cvt_pk_bf16_f32 v190, v112, v113
v_pk_fma_f32 v[114:115], v[42:43], v[224:225], v[114:115] op_sel_hi:[1,0,1]
v_pk_mul_f32 v[114:115], v[114:115], v[224:225] op_sel:[0,1] op_sel_hi:[1,1]
v_cvt_pk_bf16_f32 v191, v114, v115
buffer_load_dwordx4 v5, s[24:27], s58 offen lds
v_pk_fma_f32 v[68:69], v[28:29], v[228:229], v[68:69] op_sel_hi:[1,0,1]
v_cvt_pk_bf16_f32 v172, v68, v69
.Lpad6:
s_cbranch_execz .Lnopoll8r
v_pk_fma_f32 v[70:71], v[30:31], v[228:229], v[70:71] op_sel_hi:[1,0,1]
v_cvt_pk_bf16_f32 v173, v70, v71
v_pk_fma_f32 v[84:85], v[32:33], v[228:229], v[84:85] op_sel_hi:[1,0,1]
v_cvt_pk_bf16_f32 v174, v84, v85
v_pk_fma_f32 v[86:87], v[34:35], v[228:229], v[86:87] op_sel_hi:[1,0,1]
v_cvt_pk_bf16_f32 v175, v86, v87
s_waitcnt lgkmcnt(1)
v_pk_fma_f32 v[132:133], v[240:241], v[44:45], v[132:133] op_sel_hi:[1,0,1]
v_pk_fma_f32 v[134:135], v[242:243], v[44:45], v[134:135] op_sel_hi:[1,0,1]
s_waitcnt lgkmcnt(0)
v_pk_mul_f32 v[132:133], v[132:133], v[244:245]
v_cvt_pk_bf16_f32 v206, v132, v133
v_pk_mul_f32 v[134:135], v[134:135], v[246:247]
buffer_load_dwordx4 v6, s[24:27], s58 offen offset:1024 lds
s_add_u32 m0, s59, 83200
s_mov_b32 s58, 262144
v_cvt_pk_bf16_f32 v207, v134, v135
v_pk_fma_f32 v[148:149], v[240:241], v[44:45], v[148:149] op_sel:[0,1,0] op_sel_hi:[1,1,1]
v_pk_mul_f32 v[148:149], v[148:149], v[244:245]
v_cvt_pk_bf16_f32 v216, v148, v149
v_pk_fma_f32 v[150:151], v[242:243], v[44:45], v[150:151] op_sel:[0,1,0] op_sel_hi:[1,1,1]
v_pk_mul_f32 v[150:151], v[150:151], v[246:247]
v_cvt_pk_bf16_f32 v217, v150, v151
ds_read_b128 v[18:21], v11 offset:320
ds_read_b128 v[22:25], v11 offset:1344
buffer_load_dwordx4 v5, s[24:27], s58 offen lds
v_pk_fma_f32 v[92:93], v[36:37], v[220:221], v[92:93] op_sel_hi:[1,0,1]
v_pk_mul_f32 v[92:93], v[92:93], v[220:221] op_sel:[0,1] op_sel_hi:[1,1]
v_cvt_pk_bf16_f32 v184, v92, v93
v_pk_fma_f32 v[94:95], v[38:39], v[220:221], v[94:95] op_sel_hi:[1,0,1]
v_pk_mul_f32 v[94:95], v[94:95], v[220:221] op_sel:[0,1] op_sel_hi:[1,1]
v_cvt_pk_bf16_f32 v185, v94, v95
v_pk_fma_f32 v[108:109], v[40:41], v[220:221], v[108:109] op_sel_hi:[1,0,1]
v_pk_mul_f32 v[108:109], v[108:109], v[220:221] op_sel:[0,1] op_sel_hi:[1,1]
v_cvt_pk_bf16_f32 v186, v108, v109
v_pk_fma_f32 v[110:111], v[42:43], v[220:221], v[110:111] op_sel_hi:[1,0,1]
v_pk_mul_f32 v[110:111], v[110:111], v[220:221] op_sel:[0,1] op_sel_hi:[1,1]
v_cvt_pk_bf16_f32 v187, v110, v111
v_pk_fma_f32 v[64:65], v[28:29], v[224:225], v[64:65] op_sel_hi:[1,0,1]
buffer_load_dwordx4 v6, s[24:27], s58 offen offset:1024 lds
v_cvt_pk_bf16_f32 v168, v64, v65
v_pk_fma_f32 v[66:67], v[30:31], v[224:225], v[66:67] op_sel_hi:[1,0,1]
v_cvt_pk_bf16_f32 v169, v66, v67
v_pk_fma_f32 v[80:81], v[32:33], v[224:225], v[80:81] op_sel_hi:[1,0,1]
v_cvt_pk_bf16_f32 v170, v80, v81
v_pk_fma_f32 v[82:83], v[34:35], v[224:225], v[82:83] op_sel_hi:[1,0,1]
v_cvt_pk_bf16_f32 v171, v82, v83
ds_read_b128 v[240:243], v11 offset:256
s_waitcnt lgkmcnt(2)
v_pk_fma_f32 v[128:129], v[18:19], v[44:45], v[128:129] op_sel_hi:[1,0,1]
v_pk_fma_f32 v[130:131], v[20:21], v[44:45], v[130:131] op_sel_hi:[1,0,1]
s_waitcnt lgkmcnt(1)
v_pk_mul_f32 v[128:129], v[128:129], v[22:23]
v_cvt_pk_bf16_f32 v204, v128, v129
buffer_load_dword v27, v16, s[32:35], 0 offen
v_pk_mul_f32 v[130:131], v[130:131], v[24:25]
v_cvt_pk_bf16_f32 v205, v130, v131
v_pk_fma_f32 v[144:145], v[18:19], v[44:45], v[144:145] op_sel:[0,1,0] op_sel_hi:[1,1,1]
v_pk_mul_f32 v[144:145], v[144:145], v[22:23]
v_cvt_pk_bf16_f32 v214, v144, v145
v_pk_fma_f32 v[146:147], v[20:21], v[44:45], v[146:147] op_sel:[0,1,0] op_sel_hi:[1,1,1]
v_pk_mul_f32 v[146:147], v[146:147], v[24:25]
s_nop 1
v_mfma_f32_16x16x32_bf16 v[124:127], a[44:47], a[80:83], v[124:127]
ds_read_b128 v[244:247], v11 offset:1280
v_cvt_pk_bf16_f32 v215, v146, v147
v_mfma_f32_16x16x32_bf16 v[140:143], a[44:47], a[84:87], v[140:143]
buffer_load_dword v27, v16, s[32:35], s67 offen
v_mfma_f32_16x16x32_bf16 v[60:63], a[64:67], a[44:47], v[60:63]
v_mfma_f32_16x16x32_bf16 v[76:79], a[68:71], a[44:47], v[76:79]
v_mfma_f32_16x16x32_bf16 v[104:107], v[192:195], v[176:179], v[46:49]
s_waitcnt lgkmcnt(1)
v_pk_fma_f32 v[124:125], v[240:241], v[44:45], v[124:125] op_sel_hi:[1,0,1]
v_pk_fma_f32 v[126:127], v[242:243], v[44:45], v[126:127] op_sel_hi:[1,0,1]
s_nop 4
v_max3_f32 v88, v104, v105, v106
v_pk_fma_f32 v[140:141], v[240:241], v[44:45], v[140:141] op_sel:[0,1,0] op_sel_hi:[1,1,1]
v_pk_fma_f32 v[142:143], v[242:243], v[44:45], v[142:143] op_sel:[0,1,0] op_sel_hi:[1,1,1]
v_pk_fma_f32 v[60:61], v[28:29], v[220:221], v[60:61] op_sel_hi:[1,0,1]
v_cvt_pk_bf16_f32 v164, v60, v61
v_pk_fma_f32 v[62:63], v[30:31], v[220:221], v[62:63] op_sel_hi:[1,0,1]
v_cvt_pk_bf16_f32 v165, v62, v63
v_pk_fma_f32 v[76:77], v[32:33], v[220:221], v[76:77] op_sel_hi:[1,0,1]
s_waitcnt lgkmcnt(0)
v_pk_mul_f32 v[124:125], v[124:125], v[244:245]
v_cvt_pk_bf16_f32 v202, v124, v125
v_pk_mul_f32 v[126:127], v[126:127], v[246:247]
v_cvt_pk_bf16_f32 v203, v126, v127
v_pk_mul_f32 v[140:141], v[140:141], v[244:245]
v_cvt_pk_bf16_f32 v212, v140, v141
v_pk_mul_f32 v[142:143], v[142:143], v[246:247]
v_cvt_pk_bf16_f32 v213, v142, v143
v_cvt_pk_bf16_f32 v166, v76, v77
v_pk_fma_f32 v[78:79], v[34:35], v[220:221], v[78:79] op_sel_hi:[1,0,1]
s_nop 1
v_mfma_f32_16x16x32_bf16 v[120:123], v[196:199], v[176:179], v[50:53]
v_cvt_pk_bf16_f32 v167, v78, v79
v_mfma_f32_16x16x32_bf16 v[100:103], v[188:191], v[172:175], v[46:49]
v_mfma_f32_16x16x32_bf16 v[116:119], v[192:195], v[172:175], v[50:53]
s_nop 4
v_max3_f32 v89, v107, v120, v121
v_max3_f32 v88, v88, v122, v123
v_mfma_f32_16x16x32_bf16 v[96:99], v[184:187], v[168:171], v[46:49]
v_max_f32 v90, v88, v89
v_max_f32 v89, v88, v89
v_mfma_f32_16x16x32_bf16 v[112:115], v[188:191], v[168:171], v[50:53]
s_nop 0
v_permlane16_swap_b32 v90, v89
v_max3_f32 v84, v100, v101, v102
v_mfma_f32_16x16x32_bf16 v[92:95], v[180:183], v[164:167], v[46:49]
v_max_f32 v88, v90, v89
v_max_f32 v89, v90, v89
v_mfma_f32_16x16x32_bf16 v[108:111], v[184:187], v[164:167], v[50:53]
s_nop 0
v_permlane32_swap_b32 v88, v89
v_max3_f32 v85, v103, v116, v117
v_max3_f32 v84, v84, v118, v119
v_max_f32 v88, v88, v89
v_mul_f32 v88, v88, v234
v_pk_fma_f32 v[104:105], v[104:105], v[234:235], v[88:89] op_sel_hi:[1,0,0] neg_lo:[0,0,1] neg_hi:[0,0,1]
v_exp_f32 v104, v104
v_pk_fma_f32 v[106:107], v[106:107], v[234:235], v[88:89] op_sel_hi:[1,0,0] neg_lo:[0,0,1] neg_hi:[0,0,1]
v_exp_f32 v105, v105
v_pk_fma_f32 v[120:121], v[120:121], v[234:235], v[88:89] op_sel_hi:[1,0,0] neg_lo:[0,0,1] neg_hi:[0,0,1]
v_exp_f32 v106, v106
v_pk_fma_f32 v[122:123], v[122:123], v[234:235], v[88:89] op_sel_hi:[1,0,0] neg_lo:[0,0,1] neg_hi:[0,0,1]
v_exp_f32 v107, v107
v_cvt_pk_bf16_f32 v72, v104, v105
v_exp_f32 v120, v120
v_cvt_pk_bf16_f32 v73, v106, v107
v_exp_f32 v121, v121
v_max_f32 v86, v84, v85
v_exp_f32 v122, v122
v_cvt_pk_bf16_f32 v74, v120, v121
v_exp_f32 v123, v123
v_max_f32 v85, v84, v85
v_max3_f32 v80, v96, v97, v98
v_cvt_pk_bf16_f32 v75, v122, v123
v_permlane16_swap_b32 v86, v85
v_max3_f32 v81, v99, v112, v113
v_mfma_f32_16x16x32_bf16 v[88:91], v[248:251], v[72:75], 0
v_max_f32 v84, v86, v85
v_max_f32 v85, v86, v85
v_mfma_f32_16x16x32_bf16 v[104:107], v[206:209], v[72:75], 0
s_nop 0
v_permlane32_swap_b32 v84, v85
v_max3_f32 v80, v80, v114, v115
v_mfma_f32_16x16x32_bf16 v[120:123], v[216:219], v[72:75], 0
s_nop 0
v_rcp_f32 v88, v88
v_max_f32 v84, v84, v85
v_mul_f32 v84, v84, v230
v_max_f32 v82, v80, v81
v_max_f32 v81, v80, v81
v_pk_mul_f32 v[104:105], v[104:105], v[88:89] op_sel_hi:[1,0]
v_pk_mul_f32 v[106:107], v[106:107], v[88:89] op_sel_hi:[1,0]
v_permlane16_swap_b32 v82, v81
v_pk_mul_f32 v[120:121], v[120:121], v[88:89] op_sel_hi:[1,0]
v_pk_mul_f32 v[122:123], v[122:123], v[88:89] op_sel_hi:[1,0]
v_cvt_pk_bf16_f32 v176, v104, v105
v_cvt_pk_bf16_f32 v177, v106, v107
v_cvt_pk_bf16_f32 v178, v120, v121
v_cvt_pk_bf16_f32 v179, v122, v123
buffer_store_dwordx4 v[176:179], v4, s[16:19], s74 offen offset:3072 sc1
v_pk_fma_f32 v[100:101], v[100:101], v[230:231], v[84:85] op_sel_hi:[1,0,0] neg_lo:[0,0,1] neg_hi:[0,0,1]
v_exp_f32 v100, v100
v_pk_fma_f32 v[102:103], v[102:103], v[230:231], v[84:85] op_sel_hi:[1,0,0] neg_lo:[0,0,1] neg_hi:[0,0,1]
v_exp_f32 v101, v101
v_pk_fma_f32 v[116:117], v[116:117], v[230:231], v[84:85] op_sel_hi:[1,0,0] neg_lo:[0,0,1] neg_hi:[0,0,1]
v_exp_f32 v102, v102
v_pk_fma_f32 v[118:119], v[118:119], v[230:231], v[84:85] op_sel_hi:[1,0,0] neg_lo:[0,0,1] neg_hi:[0,0,1]
v_exp_f32 v103, v103
v_cvt_pk_bf16_f32 v68, v100, v101
v_exp_f32 v116, v116
v_cvt_pk_bf16_f32 v69, v102, v103
v_exp_f32 v117, v117
v_max_f32 v80, v82, v81
v_exp_f32 v118, v118
v_cvt_pk_bf16_f32 v70, v116, v117
v_exp_f32 v119, v119
v_max_f32 v81, v82, v81
v_max3_f32 v76, v92, v93, v94
v_cvt_pk_bf16_f32 v71, v118, v119
v_permlane32_swap_b32 v80, v81
v_max3_f32 v77, v95, v108, v109
v_mfma_f32_16x16x32_bf16 v[84:87], v[248:251], v[68:71], 0
v_max_f32 v80, v80, v81
v_mul_f32 v80, v80, v226
v_mfma_f32_16x16x32_bf16 v[100:103], v[204:207], v[68:71], 0
v_max3_f32 v76, v76, v110, v111
v_max_f32 v78, v76, v77
v_mfma_f32_16x16x32_bf16 v[116:119], v[214:217], v[68:71], 0
s_nop 1
v_rcp_f32 v84, v84
v_max_f32 v77, v76, v77
s_nop 1
v_permlane16_swap_b32 v78, v77
v_pk_mul_f32 v[100:101], v[100:101], v[84:85] op_sel_hi:[1,0]
v_pk_mul_f32 v[102:103], v[102:103], v[84:85] op_sel_hi:[1,0]
v_pk_mul_f32 v[116:117], v[116:117], v[84:85] op_sel_hi:[1,0]
v_pk_mul_f32 v[118:119], v[118:119], v[84:85] op_sel_hi:[1,0]
v_cvt_pk_bf16_f32 v172, v100, v101
v_cvt_pk_bf16_f32 v173, v102, v103
v_cvt_pk_bf16_f32 v174, v116, v117
v_cvt_pk_bf16_f32 v175, v118, v119
buffer_store_dwordx4 v[172:175], v4, s[16:19], s74 offen offset:2048 sc1
v_pk_fma_f32 v[96:97], v[96:97], v[226:227], v[80:81] op_sel_hi:[1,0,0] neg_lo:[0,0,1] neg_hi:[0,0,1]
v_exp_f32 v96, v96
v_pk_fma_f32 v[98:99], v[98:99], v[226:227], v[80:81] op_sel_hi:[1,0,0] neg_lo:[0,0,1] neg_hi:[0,0,1]
v_exp_f32 v97, v97
v_pk_fma_f32 v[112:113], v[112:113], v[226:227], v[80:81] op_sel_hi:[1,0,0] neg_lo:[0,0,1] neg_hi:[0,0,1]
v_exp_f32 v98, v98
v_pk_fma_f32 v[114:115], v[114:115], v[226:227], v[80:81] op_sel_hi:[1,0,0] neg_lo:[0,0,1] neg_hi:[0,0,1]
v_exp_f32 v99, v99
v_cvt_pk_bf16_f32 v64, v96, v97
v_exp_f32 v112, v112
v_cvt_pk_bf16_f32 v65, v98, v99
v_exp_f32 v113, v113
v_max_f32 v76, v78, v77
v_exp_f32 v114, v114
v_cvt_pk_bf16_f32 v66, v112, v113
v_exp_f32 v115, v115
v_max_f32 v77, v78, v77
v_cvt_pk_bf16_f32 v67, v114, v115
s_nop 0
v_permlane32_swap_b32 v76, v77
v_mfma_f32_16x16x32_bf16 v[80:83], v[248:251], v[64:67], 0
v_max_f32 v76, v76, v77
v_mul_f32 v76, v76, v222
v_mfma_f32_16x16x32_bf16 v[96:99], v[202:205], v[64:67], 0
v_mfma_f32_16x16x32_bf16 v[112:115], v[212:215], v[64:67], 0
s_nop 3
v_rcp_f32 v80, v80
s_nop 1
v_pk_mul_f32 v[96:97], v[96:97], v[80:81] op_sel_hi:[1,0]
v_pk_mul_f32 v[98:99], v[98:99], v[80:81] op_sel_hi:[1,0]
v_pk_mul_f32 v[112:113], v[112:113], v[80:81] op_sel_hi:[1,0]
v_pk_mul_f32 v[114:115], v[114:115], v[80:81] op_sel_hi:[1,0]
v_cvt_pk_bf16_f32 v168, v96, v97
v_cvt_pk_bf16_f32 v169, v98, v99
v_cvt_pk_bf16_f32 v170, v112, v113
v_cvt_pk_bf16_f32 v171, v114, v115
buffer_store_dwordx4 v[168:171], v4, s[16:19], s74 offen offset:1024 sc1
v_pk_fma_f32 v[92:93], v[92:93], v[222:223], v[76:77] op_sel_hi:[1,0,0] neg_lo:[0,0,1] neg_hi:[0,0,1]
v_exp_f32 v92, v92
v_pk_fma_f32 v[94:95], v[94:95], v[222:223], v[76:77] op_sel_hi:[1,0,0] neg_lo:[0,0,1] neg_hi:[0,0,1]
v_exp_f32 v93, v93
v_pk_fma_f32 v[108:109], v[108:109], v[222:223], v[76:77] op_sel_hi:[1,0,0] neg_lo:[0,0,1] neg_hi:[0,0,1]
v_exp_f32 v94, v94
v_pk_fma_f32 v[110:111], v[110:111], v[222:223], v[76:77] op_sel_hi:[1,0,0] neg_lo:[0,0,1] neg_hi:[0,0,1]
v_exp_f32 v95, v95
v_cvt_pk_bf16_f32 v60, v92, v93
v_exp_f32 v108, v108
v_cvt_pk_bf16_f32 v61, v94, v95
v_exp_f32 v109, v109
v_exp_f32 v110, v110
v_cvt_pk_bf16_f32 v62, v108, v109
v_exp_f32 v111, v111
s_nop 0
v_cvt_pk_bf16_f32 v63, v110, v111
s_nop 1
v_mfma_f32_16x16x32_bf16 v[76:79], v[248:251], v[60:63], 0
v_mfma_f32_16x16x32_bf16 v[92:95], v[200:203], v[60:63], 0
v_mfma_f32_16x16x32_bf16 v[108:111], v[210:213], v[60:63], 0
s_nop 5
v_rcp_f32 v76, v76
s_nop 0
v_pk_mul_f32 v[92:93], v[92:93], v[76:77] op_sel_hi:[1,0]
v_pk_mul_f32 v[94:95], v[94:95], v[76:77] op_sel_hi:[1,0]
v_pk_mul_f32 v[108:109], v[108:109], v[76:77] op_sel_hi:[1,0]
v_pk_mul_f32 v[110:111], v[110:111], v[76:77] op_sel_hi:[1,0]
v_cvt_pk_bf16_f32 v164, v92, v93
v_cvt_pk_bf16_f32 v165, v94, v95
v_cvt_pk_bf16_f32 v166, v108, v109
v_cvt_pk_bf16_f32 v167, v110, v111
buffer_store_dwordx4 v[164:167], v4, s[16:19], s74 offen sc1
s_nop 1
.Lqkve10:
.Lpad7:
s_cbranch_execz .Lnopoll8r
s_lshl_b32 s62, s6, 13
s_lshl_b32 s63, s3, 11
s_add_u32 s62, s62, s63
v_lshl_add_u32 v4, v1, 4, s62
v_lshrrev_b32 v2, 3, v1
v_cmp_eq_u32 vcc, 3, v2
v_add_u32 v2, 67108480, v4
s_nop 0
v_cndmask_b32 v4, v4, v2, vcc
v_bfe_u32 v5, v1, 3, 1
v_lshrrev_b32 v2, 4, v1
v_lshl_add_u32 v5, v2, 3, v5
s_lshl_b32 s62, s3, 1
v_add_u32 v5, s62, v5
v_mul_u32_u24 v5, 2048, v5
v_and_b32 v2, 7, v1
v_lshl_add_u32 v5, v2, 4, v5
s_lshl_b32 s62, s7, 7
v_add_u32 v5, s62, v5
v_add_u32 v6, 64512, v5
v_bfe_u32 v8, v1, 3, 2
v_mul_u32_u24 v8, 2080, v8
v_bfe_u32 v2, v1, 2, 1
v_lshl_add_u32 v8, v2, 7, v8
v_bfe_u32 v2, v1, 5, 1
v_lshl_add_u32 v8, v2, 8, v8
v_and_b32 v2, 3, v1
v_lshl_add_u32 v8, v2, 3, v8
s_mov_b32 s57, 66560
v_add_u32 v7, s57, v8
s_mov_b32 s52, 4194304
s_mov_b32 s53, 4325376
s_mov_b32 s54, 2097152
s_mul_i32 s56, s3, 2080
v_accvgpr_read_b32 v32, a224
v_accvgpr_read_b32 v33, a225
v_accvgpr_read_b32 v34, a226
v_accvgpr_read_b32 v35, a227
v_accvgpr_read_b32 v36, a228
v_accvgpr_read_b32 v37, a229
v_accvgpr_read_b32 v38, a230
v_accvgpr_read_b32 v39, a231
v_accvgpr_read_b32 v40, a232
v_accvgpr_read_b32 v41, a233
v_accvgpr_read_b32 v42, a234
v_accvgpr_read_b32 v43, a235
v_accvgpr_read_b32 v44, a236
v_accvgpr_read_b32 v45, a237
v_accvgpr_read_b32 v46, a238
v_accvgpr_read_b32 v47, a239
v_accvgpr_read_b32 v48, a240
v_accvgpr_read_b32 v49, a241
v_accvgpr_read_b32 v50, a242
v_accvgpr_read_b32 v51, a243
v_accvgpr_read_b32 v52, a244
v_accvgpr_read_b32 v53, a245
v_accvgpr_read_b32 v54, a246
v_accvgpr_read_b32 v55, a247
v_accvgpr_read_b32 v56, a248
v_accvgpr_read_b32 v57, a249
v_accvgpr_read_b32 v58, a250
v_accvgpr_read_b32 v59, a251
v_accvgpr_read_b32 v60, a252
v_accvgpr_read_b32 v61, a253
v_accvgpr_read_b32 v62, a254
v_accvgpr_read_b32 v63, a255
s_and_b32 s62, s3, 1
s_mul_i32 s62, s62, 28672
s_add_u32 s62, s62, s51
v_lshrrev_b32 v12, 4, v1
v_mul_u32_u24 v12, 57344, v12
v_and_b32 v2, 15, v1
v_lshl_add_u32 v12, v2, 4, v12
v_add_u32 v12, s62, v12
v_add_u32 v13, 6112, v12
v_add_u32 v14, 12224, v12
v_add_u32 v15, 18336, v12
s_mul_i32 s59, s3, 4224
s_mov_b32 s58, 0
s_lshl_b32 s62, s8, 7
s_add_u32 s62, s62, 30410752
s_lshl_b32 s64, s6, 7
s_add_u32 s64, s64, 30410752
v_mov_b32 v252, s62
v_mov_b32 v253, s64
s_waitcnt vmcnt(0) lgkmcnt(0)
s_barrier
s_cmp_lg_u32 s3, 0
s_cbranch_scc1 .Lnosig13
v_mov_b32 v255, 1
s_mov_b64 exec, 1
buffer_atomic_add v255, v252, s[16:19], 0 offen
s_mov_b64 exec, -1
.Lnosig13:
ds_read_b64_tr_b16 a[0:1], v7
ds_read_b64_tr_b16 a[2:3], v7 offset:512
ds_read_b64_tr_b16 a[4:5], v7 offset:32
ds_read_b64_tr_b16 a[6:7], v7 offset:544
ds_read_b64_tr_b16 a[8:9], v7 offset:64
ds_read_b64_tr_b16 a[10:11], v7 offset:576
ds_read_b64_tr_b16 a[12:13], v7 offset:96
ds_read_b64_tr_b16 a[14:15], v7 offset:608
ds_read_b64_tr_b16 a[16:17], v7 offset:1024
ds_read_b64_tr_b16 a[18:19], v7 offset:1536
ds_read_b64_tr_b16 a[20:21], v7 offset:1056
ds_read_b64_tr_b16 a[22:23], v7 offset:1568
ds_read_b64_tr_b16 a[24:25], v7 offset:1088
ds_read_b64_tr_b16 a[26:27], v7 offset:1600
ds_read_b64_tr_b16 a[28:29], v7 offset:1120
ds_read_b64_tr_b16 a[30:31], v7 offset:1632
s_waitcnt lgkmcnt(0)
s_cmp_lg_u32 s3, 1
s_cbranch_scc1 .Lnopoll16
s_mov_b64 exec, 1
s_mov_b32 s15, 0
.Lpoll14:
buffer_load_dword v255, v253, s[16:19], 0 offen sc1
s_add_u32 s15, s15, 1
s_cmp_gt_u32 s15, 100000
s_cbranch_scc1 .Lgot15
s_waitcnt vmcnt(0)
v_cmp_ne_u32 vcc, 16, v255
s_nop 0
s_cbranch_vccnz .Lpoll14
.Lgot15:
s_waitcnt vmcnt(0)
s_branch .Lnopoll16r
.Lnopoll16:
s_mov_b64 exec, 0
s_cmp_eq_u32 s3, 2
s_cbranch_scc1 .Lpad8
s_cmp_eq_u32 s3, 3
s_cbranch_scc1 .Lpad9
s_branch .Lnopoll16r
.Lnopoll16r:
s_mov_b64 exec, -1
s_barrier
buffer_load_dwordx4 v[64:67], v4, s[16:19], s52 offen sc1
buffer_load_dwordx4 v[68:71], v4, s[16:19], s52 offen offset:1024 sc1
s_add_u32 s52, s52, 0x40000
buffer_load_dwordx4 v[72:75], v4, s[16:19], s53 offen sc1
buffer_load_dwordx4 v[76:79], v4, s[16:19], s53 offen offset:1024 sc1
s_add_u32 s53, s53, 0x40000
buffer_load_dwordx4 v[80:83], v4, s[16:19], s52 offen sc1
buffer_load_dwordx4 v[84:87], v4, s[16:19], s52 offen offset:1024 sc1
s_add_u32 s52, s52, 0x40000
buffer_load_dwordx4 v[88:91], v4, s[16:19], s53 offen sc1
buffer_load_dwordx4 v[92:95], v4, s[16:19], s53 offen offset:1024 sc1
s_add_u32 s53, s53, 0x40000
buffer_load_dwordx4 v[96:99], v4, s[16:19], s52 offen sc1
buffer_load_dwordx4 v[100:103], v4, s[16:19], s52 offen offset:1024 sc1
s_add_u32 s52, s52, 0x40000
buffer_load_dwordx4 v[104:107], v4, s[16:19], s53 offen sc1
buffer_load_dwordx4 v[108:111], v4, s[16:19], s53 offen offset:1024 sc1
s_add_u32 s53, s53, 0x40000
s_waitcnt vmcnt(11)
v_mfma_f32_16x16x32_bf16 v[32:35], a[0:3], v[64:67], v[32:35]
ds_read_b64_tr_b16 a[32:33], v7 offset:8320
ds_read_b64_tr_b16 a[34:35], v7 offset:8832
s_waitcnt vmcnt(10)
v_mfma_f32_16x16x32_bf16 v[48:51], a[0:3], v[68:71], v[48:51]
buffer_load_dwordx4 v[112:115], v4, s[16:19], s52 offen sc1
v_mfma_f32_16x16x32_bf16 v[36:39], a[4:7], v[64:67], v[36:39]
ds_read_b64_tr_b16 a[36:37], v7 offset:8352
ds_read_b64_tr_b16 a[38:39], v7 offset:8864
v_mfma_f32_16x16x32_bf16 v[52:55], a[4:7], v[68:71], v[52:55]
ds_read_b64_tr_b16 a[40:41], v7 offset:8384
ds_read_b64_tr_b16 a[42:43], v7 offset:8896
v_mfma_f32_16x16x32_bf16 v[40:43], a[8:11], v[64:67], v[40:43]
buffer_load_dwordx4 v[116:119], v4, s[16:19], s52 offen offset:1024 sc1
v_mfma_f32_16x16x32_bf16 v[56:59], a[8:11], v[68:71], v[56:59]
ds_read_b64_tr_b16 a[44:45], v7 offset:8416
s_add_u32 s52, s52, 0x40000
v_mfma_f32_16x16x32_bf16 v[44:47], a[12:15], v[64:67], v[44:47]
ds_read_b64_tr_b16 a[46:47], v7 offset:8928
v_mfma_f32_16x16x32_bf16 v[60:63], a[12:15], v[68:71], v[60:63]
ds_read_b64_tr_b16 a[48:49], v7 offset:9344
ds_read_b64_tr_b16 a[50:51], v7 offset:9856
s_waitcnt vmcnt(11)
v_mfma_f32_16x16x32_bf16 v[32:35], a[16:19], v[72:75], v[32:35]
buffer_load_dwordx4 v[120:123], v4, s[16:19], s53 offen sc1
s_waitcnt vmcnt(11)
v_mfma_f32_16x16x32_bf16 v[48:51], a[16:19], v[76:79], v[48:51]
ds_read_b64_tr_b16 a[52:53], v7 offset:9376
ds_read_b64_tr_b16 a[54:55], v7 offset:9888
v_mfma_f32_16x16x32_bf16 v[36:39], a[20:23], v[72:75], v[36:39]
ds_read_b64_tr_b16 a[56:57], v7 offset:9408
ds_read_b64_tr_b16 a[58:59], v7 offset:9920
v_mfma_f32_16x16x32_bf16 v[52:55], a[20:23], v[76:79], v[52:55]
buffer_load_dwordx4 v[124:127], v4, s[16:19], s53 offen offset:1024 sc1
v_mfma_f32_16x16x32_bf16 v[40:43], a[24:27], v[72:75], v[40:43]
ds_read_b64_tr_b16 a[60:61], v7 offset:9440
s_add_u32 s53, s53, 0x40000
v_mfma_f32_16x16x32_bf16 v[56:59], a[24:27], v[76:79], v[56:59]
ds_read_b64_tr_b16 a[62:63], v7 offset:9952
v_mfma_f32_16x16x32_bf16 v[44:47], a[28:31], v[72:75], v[44:47]
v_mfma_f32_16x16x32_bf16 v[60:63], a[28:31], v[76:79], v[60:63]
s_waitcnt vmcnt(11) lgkmcnt(14)
v_mfma_f32_16x16x32_bf16 v[32:35], a[32:35], v[80:83], v[32:35]
ds_read_b64_tr_b16 a[0:1], v7 offset:16640
ds_read_b64_tr_b16 a[2:3], v7 offset:17152
s_waitcnt vmcnt(10)
v_mfma_f32_16x16x32_bf16 v[48:51], a[32:35], v[84:87], v[48:51]
buffer_load_dwordx4 v[64:67], v4, s[16:19], s52 offen sc1
s_waitcnt lgkmcnt(14)
v_mfma_f32_16x16x32_bf16 v[36:39], a[36:39], v[80:83], v[36:39]
ds_read_b64_tr_b16 a[4:5], v7 offset:16672
ds_read_b64_tr_b16 a[6:7], v7 offset:17184
v_mfma_f32_16x16x32_bf16 v[52:55], a[36:39], v[84:87], v[52:55]
ds_read_b64_tr_b16 a[8:9], v7 offset:16704
ds_read_b64_tr_b16 a[10:11], v7 offset:17216
s_waitcnt lgkmcnt(15)
v_mfma_f32_16x16x32_bf16 v[40:43], a[40:43], v[80:83], v[40:43]
buffer_load_dwordx4 v[68:71], v4, s[16:19], s52 offen offset:1024 sc1
v_mfma_f32_16x16x32_bf16 v[56:59], a[40:43], v[84:87], v[56:59]
ds_read_b64_tr_b16 a[12:13], v7 offset:16736
s_add_u32 s52, s52, 0x40000
s_waitcnt lgkmcnt(15)
v_mfma_f32_16x16x32_bf16 v[44:47], a[44:47], v[80:83], v[44:47]
ds_read_b64_tr_b16 a[14:15], v7 offset:17248
v_mfma_f32_16x16x32_bf16 v[60:63], a[44:47], v[84:87], v[60:63]
ds_read_b64_tr_b16 a[16:17], v7 offset:17664
ds_read_b64_tr_b16 a[18:19], v7 offset:18176
s_waitcnt vmcnt(11) lgkmcnt(15)
v_mfma_f32_16x16x32_bf16 v[32:35], a[48:51], v[88:91], v[32:35]
buffer_load_dwordx4 v[72:75], v4, s[16:19], s53 offen sc1
s_waitcnt vmcnt(11)
v_mfma_f32_16x16x32_bf16 v[48:51], a[48:51], v[92:95], v[48:51]
ds_read_b64_tr_b16 a[20:21], v7 offset:17696
ds_read_b64_tr_b16 a[22:23], v7 offset:18208
s_waitcnt lgkmcnt(15)
v_mfma_f32_16x16x32_bf16 v[36:39], a[52:55], v[88:91], v[36:39]
ds_read_b64_tr_b16 a[24:25], v7 offset:17728
ds_read_b64_tr_b16 a[26:27], v7 offset:18240
v_mfma_f32_16x16x32_bf16 v[52:55], a[52:55], v[92:95], v[52:55]
buffer_load_dwordx4 v[76:79], v4, s[16:19], s53 offen offset:1024 sc1
s_waitcnt lgkmcnt(15)
v_mfma_f32_16x16x32_bf16 v[40:43], a[56:59], v[88:91], v[40:43]
ds_read_b64_tr_b16 a[28:29], v7 offset:17760
s_add_u32 s53, s53, 0x40000
v_mfma_f32_16x16x32_bf16 v[56:59], a[56:59], v[92:95], v[56:59]
ds_read_b64_tr_b16 a[30:31], v7 offset:18272
s_waitcnt lgkmcnt(15)
v_mfma_f32_16x16x32_bf16 v[44:47], a[60:63], v[88:91], v[44:47]
v_mfma_f32_16x16x32_bf16 v[60:63], a[60:63], v[92:95], v[60:63]
s_waitcnt vmcnt(11) lgkmcnt(14)
v_mfma_f32_16x16x32_bf16 v[32:35], a[0:3], v[96:99], v[32:35]
ds_read_b64_tr_b16 a[32:33], v7 offset:24960
ds_read_b64_tr_b16 a[34:35], v7 offset:25472
s_waitcnt vmcnt(10)
v_mfma_f32_16x16x32_bf16 v[48:51], a[0:3], v[100:103], v[48:51]
buffer_load_dwordx4 v[80:83], v4, s[16:19], s52 offen sc1
s_waitcnt lgkmcnt(14)
v_mfma_f32_16x16x32_bf16 v[36:39], a[4:7], v[96:99], v[36:39]
ds_read_b64_tr_b16 a[36:37], v7 offset:24992
ds_read_b64_tr_b16 a[38:39], v7 offset:25504
v_mfma_f32_16x16x32_bf16 v[52:55], a[4:7], v[100:103], v[52:55]
ds_read_b64_tr_b16 a[40:41], v7 offset:25024
ds_read_b64_tr_b16 a[42:43], v7 offset:25536
s_waitcnt lgkmcnt(15)
v_mfma_f32_16x16x32_bf16 v[40:43], a[8:11], v[96:99], v[40:43]
buffer_load_dwordx4 v[84:87], v4, s[16:19], s52 offen offset:1024 sc1
v_mfma_f32_16x16x32_bf16 v[56:59], a[8:11], v[100:103], v[56:59]
ds_read_b64_tr_b16 a[44:45], v7 offset:25056
s_add_u32 s52, s52, 0x40000
s_waitcnt lgkmcnt(15)
v_mfma_f32_16x16x32_bf16 v[44:47], a[12:15], v[96:99], v[44:47]
ds_read_b64_tr_b16 a[46:47], v7 offset:25568
v_mfma_f32_16x16x32_bf16 v[60:63], a[12:15], v[100:103], v[60:63]
ds_read_b64_tr_b16 a[48:49], v7 offset:25984
ds_read_b64_tr_b16 a[50:51], v7 offset:26496
s_waitcnt vmcnt(11) lgkmcnt(15)
v_mfma_f32_16x16x32_bf16 v[32:35], a[16:19], v[104:107], v[32:35]
buffer_load_dwordx4 v[88:91], v4, s[16:19], s53 offen sc1
s_waitcnt vmcnt(11)
v_mfma_f32_16x16x32_bf16 v[48:51], a[16:19], v[108:111], v[48:51]
ds_read_b64_tr_b16 a[52:53], v7 offset:26016
ds_read_b64_tr_b16 a[54:55], v7 offset:26528
s_waitcnt lgkmcnt(15)
v_mfma_f32_16x16x32_bf16 v[36:39], a[20:23], v[104:107], v[36:39]
ds_read_b64_tr_b16 a[56:57], v7 offset:26048
ds_read_b64_tr_b16 a[58:59], v7 offset:26560
v_mfma_f32_16x16x32_bf16 v[52:55], a[20:23], v[108:111], v[52:55]
buffer_load_dwordx4 v[92:95], v4, s[16:19], s53 offen offset:1024 sc1
s_waitcnt lgkmcnt(15)
v_mfma_f32_16x16x32_bf16 v[40:43], a[24:27], v[104:107], v[40:43]
ds_read_b64_tr_b16 a[60:61], v7 offset:26080
s_add_u32 s53, s53, 0x40000
v_mfma_f32_16x16x32_bf16 v[56:59], a[24:27], v[108:111], v[56:59]
ds_read_b64_tr_b16 a[62:63], v7 offset:26592
s_waitcnt lgkmcnt(15)
v_mfma_f32_16x16x32_bf16 v[44:47], a[28:31], v[104:107], v[44:47]
v_mfma_f32_16x16x32_bf16 v[60:63], a[28:31], v[108:111], v[60:63]
s_waitcnt vmcnt(11) lgkmcnt(14)
v_mfma_f32_16x16x32_bf16 v[32:35], a[32:35], v[112:115], v[32:35]
ds_read_b64_tr_b16 a[0:1], v7 offset:33280
ds_read_b64_tr_b16 a[2:3], v7 offset:33792
s_waitcnt vmcnt(10)
v_mfma_f32_16x16x32_bf16 v[48:51], a[32:35], v[116:119], v[48:51]
buffer_load_dwordx4 v[96:99], v4, s[16:19], s52 offen sc1
s_waitcnt lgkmcnt(14)
v_mfma_f32_16x16x32_bf16 v[36:39], a[36:39], v[112:115], v[36:39]
ds_read_b64_tr_b16 a[4:5], v7 offset:33312
ds_read_b64_tr_b16 a[6:7], v7 offset:33824
v_mfma_f32_16x16x32_bf16 v[52:55], a[36:39], v[116:119], v[52:55]
ds_read_b64_tr_b16 a[8:9], v7 offset:33344
ds_read_b64_tr_b16 a[10:11], v7 offset:33856
s_waitcnt lgkmcnt(15)
v_mfma_f32_16x16x32_bf16 v[40:43], a[40:43], v[112:115], v[40:43]
buffer_load_dwordx4 v[100:103], v4, s[16:19], s52 offen offset:1024 sc1
v_mfma_f32_16x16x32_bf16 v[56:59], a[40:43], v[116:119], v[56:59]
ds_read_b64_tr_b16 a[12:13], v7 offset:33376
s_add_u32 s52, s52, 0x40000
s_waitcnt lgkmcnt(15)
v_mfma_f32_16x16x32_bf16 v[44:47], a[44:47], v[112:115], v[44:47]
ds_read_b64_tr_b16 a[14:15], v7 offset:33888
v_mfma_f32_16x16x32_bf16 v[60:63], a[44:47], v[116:119], v[60:63]
ds_read_b64_tr_b16 a[16:17], v7 offset:34304
ds_read_b64_tr_b16 a[18:19], v7 offset:34816
s_waitcnt vmcnt(11) lgkmcnt(15)
v_mfma_f32_16x16x32_bf16 v[32:35], a[48:51], v[120:123], v[32:35]
buffer_load_dwordx4 v[104:107], v4, s[16:19], s53 offen sc1
s_waitcnt vmcnt(11)
v_mfma_f32_16x16x32_bf16 v[48:51], a[48:51], v[124:127], v[48:51]
ds_read_b64_tr_b16 a[20:21], v7 offset:34336
ds_read_b64_tr_b16 a[22:23], v7 offset:34848
s_waitcnt lgkmcnt(15)
.Lpad8:
s_cbranch_execz .Lnopoll16r
v_mfma_f32_16x16x32_bf16 v[36:39], a[52:55], v[120:123], v[36:39]
ds_read_b64_tr_b16 a[24:25], v7 offset:34368
ds_read_b64_tr_b16 a[26:27], v7 offset:34880
v_mfma_f32_16x16x32_bf16 v[52:55], a[52:55], v[124:127], v[52:55]
buffer_load_dwordx4 v[108:111], v4, s[16:19], s53 offen offset:1024 sc1
s_waitcnt lgkmcnt(15)
v_mfma_f32_16x16x32_bf16 v[40:43], a[56:59], v[120:123], v[40:43]
ds_read_b64_tr_b16 a[28:29], v7 offset:34400
s_add_u32 s53, s53, 0x40000
v_mfma_f32_16x16x32_bf16 v[56:59], a[56:59], v[124:127], v[56:59]
ds_read_b64_tr_b16 a[30:31], v7 offset:34912
s_waitcnt lgkmcnt(15)
v_mfma_f32_16x16x32_bf16 v[44:47], a[60:63], v[120:123], v[44:47]
v_mfma_f32_16x16x32_bf16 v[60:63], a[60:63], v[124:127], v[60:63]
s_waitcnt vmcnt(11) lgkmcnt(14)
v_mfma_f32_16x16x32_bf16 v[32:35], a[0:3], v[64:67], v[32:35]
ds_read_b64_tr_b16 a[32:33], v7 offset:41600
ds_read_b64_tr_b16 a[34:35], v7 offset:42112
s_waitcnt vmcnt(10)
v_mfma_f32_16x16x32_bf16 v[48:51], a[0:3], v[68:71], v[48:51]
buffer_load_dwordx4 v[112:115], v4, s[16:19], s52 offen sc1
s_waitcnt lgkmcnt(14)
v_mfma_f32_16x16x32_bf16 v[36:39], a[4:7], v[64:67], v[36:39]
ds_read_b64_tr_b16 a[36:37], v7 offset:41632
ds_read_b64_tr_b16 a[38:39], v7 offset:42144
v_mfma_f32_16x16x32_bf16 v[52:55], a[4:7], v[68:71], v[52:55]
ds_read_b64_tr_b16 a[40:41], v7 offset:41664
ds_read_b64_tr_b16 a[42:43], v7 offset:42176
s_waitcnt lgkmcnt(15)
v_mfma_f32_16x16x32_bf16 v[40:43], a[8:11], v[64:67], v[40:43]
buffer_load_dwordx4 v[116:119], v4, s[16:19], s52 offen offset:1024 sc1
v_mfma_f32_16x16x32_bf16 v[56:59], a[8:11], v[68:71], v[56:59]
ds_read_b64_tr_b16 a[44:45], v7 offset:41696
s_add_u32 s52, s52, 0x40000
s_waitcnt lgkmcnt(15)
v_mfma_f32_16x16x32_bf16 v[44:47], a[12:15], v[64:67], v[44:47]
ds_read_b64_tr_b16 a[46:47], v7 offset:42208
v_mfma_f32_16x16x32_bf16 v[60:63], a[12:15], v[68:71], v[60:63]
ds_read_b64_tr_b16 a[48:49], v7 offset:42624
ds_read_b64_tr_b16 a[50:51], v7 offset:43136
s_waitcnt vmcnt(11) lgkmcnt(15)
v_mfma_f32_16x16x32_bf16 v[32:35], a[16:19], v[72:75], v[32:35]
buffer_load_dwordx4 v[120:123], v4, s[16:19], s53 offen sc1
s_waitcnt vmcnt(11)
v_mfma_f32_16x16x32_bf16 v[48:51], a[16:19], v[76:79], v[48:51]
ds_read_b64_tr_b16 a[52:53], v7 offset:42656
ds_read_b64_tr_b16 a[54:55], v7 offset:43168
s_waitcnt lgkmcnt(15)
v_mfma_f32_16x16x32_bf16 v[36:39], a[20:23], v[72:75], v[36:39]
ds_read_b64_tr_b16 a[56:57], v7 offset:42688
ds_read_b64_tr_b16 a[58:59], v7 offset:43200
v_mfma_f32_16x16x32_bf16 v[52:55], a[20:23], v[76:79], v[52:55]
buffer_load_dwordx4 v[124:127], v4, s[16:19], s53 offen offset:1024 sc1
s_waitcnt lgkmcnt(15)
v_mfma_f32_16x16x32_bf16 v[40:43], a[24:27], v[72:75], v[40:43]
ds_read_b64_tr_b16 a[60:61], v7 offset:42720
s_add_u32 s53, s53, 0x40000
v_mfma_f32_16x16x32_bf16 v[56:59], a[24:27], v[76:79], v[56:59]
ds_read_b64_tr_b16 a[62:63], v7 offset:43232
s_waitcnt lgkmcnt(15)
v_mfma_f32_16x16x32_bf16 v[44:47], a[28:31], v[72:75], v[44:47]
v_mfma_f32_16x16x32_bf16 v[60:63], a[28:31], v[76:79], v[60:63]
s_waitcnt vmcnt(11) lgkmcnt(14)
v_mfma_f32_16x16x32_bf16 v[32:35], a[32:35], v[80:83], v[32:35]
ds_read_b64_tr_b16 a[0:1], v7 offset:49920
ds_read_b64_tr_b16 a[2:3], v7 offset:50432
s_waitcnt vmcnt(10)
v_mfma_f32_16x16x32_bf16 v[48:51], a[32:35], v[84:87], v[48:51]
buffer_load_dwordx4 v[64:67], v4, s[16:19], s52 offen sc1
s_waitcnt lgkmcnt(14)
v_mfma_f32_16x16x32_bf16 v[36:39], a[36:39], v[80:83], v[36:39]
ds_read_b64_tr_b16 a[4:5], v7 offset:49952
ds_read_b64_tr_b16 a[6:7], v7 offset:50464
v_mfma_f32_16x16x32_bf16 v[52:55], a[36:39], v[84:87], v[52:55]
ds_read_b64_tr_b16 a[8:9], v7 offset:49984
ds_read_b64_tr_b16 a[10:11], v7 offset:50496
s_waitcnt lgkmcnt(15)
v_mfma_f32_16x16x32_bf16 v[40:43], a[40:43], v[80:83], v[40:43]
buffer_load_dwordx4 v[68:71], v4, s[16:19], s52 offen offset:1024 sc1
v_mfma_f32_16x16x32_bf16 v[56:59], a[40:43], v[84:87], v[56:59]
ds_read_b64_tr_b16 a[12:13], v7 offset:50016
s_add_u32 s52, s52, 0x40000
s_waitcnt lgkmcnt(15)
v_mfma_f32_16x16x32_bf16 v[44:47], a[44:47], v[80:83], v[44:47]
ds_read_b64_tr_b16 a[14:15], v7 offset:50528
v_mfma_f32_16x16x32_bf16 v[60:63], a[44:47], v[84:87], v[60:63]
ds_read_b64_tr_b16 a[16:17], v7 offset:50944
ds_read_b64_tr_b16 a[18:19], v7 offset:51456
s_waitcnt vmcnt(11) lgkmcnt(15)
v_mfma_f32_16x16x32_bf16 v[32:35], a[48:51], v[88:91], v[32:35]
buffer_load_dwordx4 v[72:75], v4, s[16:19], s53 offen sc1
s_waitcnt vmcnt(11)
v_mfma_f32_16x16x32_bf16 v[48:51], a[48:51], v[92:95], v[48:51]
ds_read_b64_tr_b16 a[20:21], v7 offset:50976
ds_read_b64_tr_b16 a[22:23], v7 offset:51488
s_waitcnt lgkmcnt(15)
v_mfma_f32_16x16x32_bf16 v[36:39], a[52:55], v[88:91], v[36:39]
ds_read_b64_tr_b16 a[24:25], v7 offset:51008
ds_read_b64_tr_b16 a[26:27], v7 offset:51520
v_mfma_f32_16x16x32_bf16 v[52:55], a[52:55], v[92:95], v[52:55]
buffer_load_dwordx4 v[76:79], v4, s[16:19], s53 offen offset:1024 sc1
s_waitcnt lgkmcnt(15)
v_mfma_f32_16x16x32_bf16 v[40:43], a[56:59], v[88:91], v[40:43]
ds_read_b64_tr_b16 a[28:29], v7 offset:51040
s_add_u32 s53, s53, 0x40000
v_mfma_f32_16x16x32_bf16 v[56:59], a[56:59], v[92:95], v[56:59]
ds_read_b64_tr_b16 a[30:31], v7 offset:51552
s_waitcnt lgkmcnt(15)
v_mfma_f32_16x16x32_bf16 v[44:47], a[60:63], v[88:91], v[44:47]
v_mfma_f32_16x16x32_bf16 v[60:63], a[60:63], v[92:95], v[60:63]
s_waitcnt vmcnt(11) lgkmcnt(14)
v_mfma_f32_16x16x32_bf16 v[32:35], a[0:3], v[96:99], v[32:35]
ds_read_b64_tr_b16 a[32:33], v7 offset:58240
ds_read_b64_tr_b16 a[34:35], v7 offset:58752
s_waitcnt vmcnt(10)
v_mfma_f32_16x16x32_bf16 v[48:51], a[0:3], v[100:103], v[48:51]
buffer_load_dwordx4 v[80:83], v4, s[16:19], s52 offen sc1
s_waitcnt lgkmcnt(14)
v_mfma_f32_16x16x32_bf16 v[36:39], a[4:7], v[96:99], v[36:39]
ds_read_b64_tr_b16 a[36:37], v7 offset:58272
ds_read_b64_tr_b16 a[38:39], v7 offset:58784
v_mfma_f32_16x16x32_bf16 v[52:55], a[4:7], v[100:103], v[52:55]
ds_read_b64_tr_b16 a[40:41], v7 offset:58304
ds_read_b64_tr_b16 a[42:43], v7 offset:58816
s_waitcnt lgkmcnt(15)
v_mfma_f32_16x16x32_bf16 v[40:43], a[8:11], v[96:99], v[40:43]
buffer_load_dwordx4 v[84:87], v4, s[16:19], s52 offen offset:1024 sc1
v_mfma_f32_16x16x32_bf16 v[56:59], a[8:11], v[100:103], v[56:59]
ds_read_b64_tr_b16 a[44:45], v7 offset:58336
s_add_u32 s52, s52, 0x40000
s_waitcnt lgkmcnt(15)
v_mfma_f32_16x16x32_bf16 v[44:47], a[12:15], v[96:99], v[44:47]
ds_read_b64_tr_b16 a[46:47], v7 offset:58848
v_mfma_f32_16x16x32_bf16 v[60:63], a[12:15], v[100:103], v[60:63]
ds_read_b64_tr_b16 a[48:49], v7 offset:59264
ds_read_b64_tr_b16 a[50:51], v7 offset:59776
s_waitcnt vmcnt(11) lgkmcnt(15)
v_mfma_f32_16x16x32_bf16 v[32:35], a[16:19], v[104:107], v[32:35]
buffer_load_dwordx4 v[88:91], v4, s[16:19], s53 offen sc1
s_waitcnt vmcnt(11)
v_mfma_f32_16x16x32_bf16 v[48:51], a[16:19], v[108:111], v[48:51]
ds_read_b64_tr_b16 a[52:53], v7 offset:59296
ds_read_b64_tr_b16 a[54:55], v7 offset:59808
s_waitcnt lgkmcnt(15)
v_mfma_f32_16x16x32_bf16 v[36:39], a[20:23], v[104:107], v[36:39]
ds_read_b64_tr_b16 a[56:57], v7 offset:59328
ds_read_b64_tr_b16 a[58:59], v7 offset:59840
v_mfma_f32_16x16x32_bf16 v[52:55], a[20:23], v[108:111], v[52:55]
buffer_load_dwordx4 v[92:95], v4, s[16:19], s53 offen offset:1024 sc1
s_waitcnt lgkmcnt(15)
v_mfma_f32_16x16x32_bf16 v[40:43], a[24:27], v[104:107], v[40:43]
ds_read_b64_tr_b16 a[60:61], v7 offset:59360
s_add_u32 s53, s53, 0x40000
v_mfma_f32_16x16x32_bf16 v[56:59], a[24:27], v[108:111], v[56:59]
ds_read_b64_tr_b16 a[62:63], v7 offset:59872
s_waitcnt lgkmcnt(15)
v_mfma_f32_16x16x32_bf16 v[44:47], a[28:31], v[104:107], v[44:47]
v_mfma_f32_16x16x32_bf16 v[60:63], a[28:31], v[108:111], v[60:63]
s_xor_b32 s57, s57, 66560
v_add_u32 v7, s57, v8
s_waitcnt vmcnt(11) lgkmcnt(14)
v_mfma_f32_16x16x32_bf16 v[32:35], a[32:35], v[112:115], v[32:35]
ds_read_b64_tr_b16 a[0:1], v7
ds_read_b64_tr_b16 a[2:3], v7 offset:512
s_waitcnt vmcnt(10)
v_mfma_f32_16x16x32_bf16 v[48:51], a[32:35], v[116:119], v[48:51]
buffer_load_dwordx4 v[96:99], v4, s[16:19], s52 offen sc1
s_waitcnt lgkmcnt(14)
v_mfma_f32_16x16x32_bf16 v[36:39], a[36:39], v[112:115], v[36:39]
ds_read_b64_tr_b16 a[4:5], v7 offset:32
ds_read_b64_tr_b16 a[6:7], v7 offset:544
v_mfma_f32_16x16x32_bf16 v[52:55], a[36:39], v[116:119], v[52:55]
ds_read_b64_tr_b16 a[8:9], v7 offset:64
ds_read_b64_tr_b16 a[10:11], v7 offset:576
s_waitcnt lgkmcnt(15)
v_mfma_f32_16x16x32_bf16 v[40:43], a[40:43], v[112:115], v[40:43]
buffer_load_dwordx4 v[100:103], v4, s[16:19], s52 offen offset:1024 sc1
v_mfma_f32_16x16x32_bf16 v[56:59], a[40:43], v[116:119], v[56:59]
ds_read_b64_tr_b16 a[12:13], v7 offset:96
s_add_u32 s52, s52, 0x40000
s_waitcnt lgkmcnt(15)
v_mfma_f32_16x16x32_bf16 v[44:47], a[44:47], v[112:115], v[44:47]
ds_read_b64_tr_b16 a[14:15], v7 offset:608
v_mfma_f32_16x16x32_bf16 v[60:63], a[44:47], v[116:119], v[60:63]
ds_read_b64_tr_b16 a[16:17], v7 offset:1024
ds_read_b64_tr_b16 a[18:19], v7 offset:1536
s_waitcnt vmcnt(11) lgkmcnt(15)
v_mfma_f32_16x16x32_bf16 v[32:35], a[48:51], v[120:123], v[32:35]
buffer_load_dwordx4 v[104:107], v4, s[16:19], s53 offen sc1
s_waitcnt vmcnt(11)
v_mfma_f32_16x16x32_bf16 v[48:51], a[48:51], v[124:127], v[48:51]
ds_read_b64_tr_b16 a[20:21], v7 offset:1056
ds_read_b64_tr_b16 a[22:23], v7 offset:1568
s_waitcnt lgkmcnt(15)
v_mfma_f32_16x16x32_bf16 v[36:39], a[52:55], v[120:123], v[36:39]
ds_read_b64_tr_b16 a[24:25], v7 offset:1088
ds_read_b64_tr_b16 a[26:27], v7 offset:1600
v_mfma_f32_16x16x32_bf16 v[52:55], a[52:55], v[124:127], v[52:55]
buffer_load_dwordx4 v[108:111], v4, s[16:19], s53 offen offset:1024 sc1
s_waitcnt lgkmcnt(15)
v_mfma_f32_16x16x32_bf16 v[40:43], a[56:59], v[120:123], v[40:43]
ds_read_b64_tr_b16 a[28:29], v7 offset:1120
s_add_u32 s53, s53, 0x40000
v_mfma_f32_16x16x32_bf16 v[56:59], a[56:59], v[124:127], v[56:59]
ds_read_b64_tr_b16 a[30:31], v7 offset:1632
s_waitcnt lgkmcnt(15)
v_mfma_f32_16x16x32_bf16 v[44:47], a[60:63], v[120:123], v[44:47]
v_mfma_f32_16x16x32_bf16 v[60:63], a[60:63], v[124:127], v[60:63]
s_waitcnt vmcnt(11) lgkmcnt(14)
v_mfma_f32_16x16x32_bf16 v[32:35], a[0:3], v[64:67], v[32:35]
ds_read_b64_tr_b16 a[32:33], v7 offset:8320
ds_read_b64_tr_b16 a[34:35], v7 offset:8832
s_waitcnt vmcnt(10)
v_mfma_f32_16x16x32_bf16 v[48:51], a[0:3], v[68:71], v[48:51]
buffer_load_dwordx4 v[112:115], v4, s[16:19], s52 offen sc1
s_waitcnt lgkmcnt(14)
v_mfma_f32_16x16x32_bf16 v[36:39], a[4:7], v[64:67], v[36:39]
ds_read_b64_tr_b16 a[36:37], v7 offset:8352
ds_read_b64_tr_b16 a[38:39], v7 offset:8864
v_mfma_f32_16x16x32_bf16 v[52:55], a[4:7], v[68:71], v[52:55]
ds_read_b64_tr_b16 a[40:41], v7 offset:8384
ds_read_b64_tr_b16 a[42:43], v7 offset:8896
s_waitcnt lgkmcnt(15)
v_mfma_f32_16x16x32_bf16 v[40:43], a[8:11], v[64:67], v[40:43]
buffer_load_dwordx4 v[116:119], v4, s[16:19], s52 offen offset:1024 sc1
v_mfma_f32_16x16x32_bf16 v[56:59], a[8:11], v[68:71], v[56:59]
ds_read_b64_tr_b16 a[44:45], v7 offset:8416
s_add_u32 s52, s52, 0x40000
s_waitcnt lgkmcnt(15)
v_mfma_f32_16x16x32_bf16 v[44:47], a[12:15], v[64:67], v[44:47]
ds_read_b64_tr_b16 a[46:47], v7 offset:8928
v_mfma_f32_16x16x32_bf16 v[60:63], a[12:15], v[68:71], v[60:63]
ds_read_b64_tr_b16 a[48:49], v7 offset:9344
ds_read_b64_tr_b16 a[50:51], v7 offset:9856
s_waitcnt vmcnt(11) lgkmcnt(15)
v_mfma_f32_16x16x32_bf16 v[32:35], a[16:19], v[72:75], v[32:35]
buffer_load_dwordx4 v[120:123], v4, s[16:19], s53 offen sc1
s_waitcnt vmcnt(11)
v_mfma_f32_16x16x32_bf16 v[48:51], a[16:19], v[76:79], v[48:51]
ds_read_b64_tr_b16 a[52:53], v7 offset:9376
ds_read_b64_tr_b16 a[54:55], v7 offset:9888
s_waitcnt lgkmcnt(15)
v_mfma_f32_16x16x32_bf16 v[36:39], a[20:23], v[72:75], v[36:39]
ds_read_b64_tr_b16 a[56:57], v7 offset:9408
ds_read_b64_tr_b16 a[58:59], v7 offset:9920
v_mfma_f32_16x16x32_bf16 v[52:55], a[20:23], v[76:79], v[52:55]
buffer_load_dwordx4 v[124:127], v4, s[16:19], s53 offen offset:1024 sc1
s_waitcnt lgkmcnt(15)
v_mfma_f32_16x16x32_bf16 v[40:43], a[24:27], v[72:75], v[40:43]
ds_read_b64_tr_b16 a[60:61], v7 offset:9440
s_add_u32 s53, s53, 0x40000
v_mfma_f32_16x16x32_bf16 v[56:59], a[24:27], v[76:79], v[56:59]
ds_read_b64_tr_b16 a[62:63], v7 offset:9952
s_waitcnt lgkmcnt(15)
v_mfma_f32_16x16x32_bf16 v[44:47], a[28:31], v[72:75], v[44:47]
v_mfma_f32_16x16x32_bf16 v[60:63], a[28:31], v[76:79], v[60:63]
s_waitcnt vmcnt(11) lgkmcnt(14)
v_mfma_f32_16x16x32_bf16 v[32:35], a[32:35], v[80:83], v[32:35]
ds_read_b64_tr_b16 a[0:1], v7 offset:16640
ds_read_b64_tr_b16 a[2:3], v7 offset:17152
s_waitcnt vmcnt(10)
v_mfma_f32_16x16x32_bf16 v[48:51], a[32:35], v[84:87], v[48:51]
buffer_load_dwordx4 v[64:67], v4, s[16:19], s52 offen sc1
s_waitcnt lgkmcnt(14)
v_mfma_f32_16x16x32_bf16 v[36:39], a[36:39], v[80:83], v[36:39]
ds_read_b64_tr_b16 a[4:5], v7 offset:16672
ds_read_b64_tr_b16 a[6:7], v7 offset:17184
v_mfma_f32_16x16x32_bf16 v[52:55], a[36:39], v[84:87], v[52:55]
ds_read_b64_tr_b16 a[8:9], v7 offset:16704
ds_read_b64_tr_b16 a[10:11], v7 offset:17216
s_waitcnt lgkmcnt(15)
v_mfma_f32_16x16x32_bf16 v[40:43], a[40:43], v[80:83], v[40:43]
buffer_load_dwordx4 v[68:71], v4, s[16:19], s52 offen offset:1024 sc1
v_mfma_f32_16x16x32_bf16 v[56:59], a[40:43], v[84:87], v[56:59]
ds_read_b64_tr_b16 a[12:13], v7 offset:16736
s_add_u32 s52, s52, 0x40000
s_waitcnt lgkmcnt(15)
v_mfma_f32_16x16x32_bf16 v[44:47], a[44:47], v[80:83], v[44:47]
ds_read_b64_tr_b16 a[14:15], v7 offset:17248
v_mfma_f32_16x16x32_bf16 v[60:63], a[44:47], v[84:87], v[60:63]
ds_read_b64_tr_b16 a[16:17], v7 offset:17664
ds_read_b64_tr_b16 a[18:19], v7 offset:18176
s_waitcnt vmcnt(11) lgkmcnt(15)
v_mfma_f32_16x16x32_bf16 v[32:35], a[48:51], v[88:91], v[32:35]
buffer_load_dwordx4 v[72:75], v4, s[16:19], s53 offen sc1
s_waitcnt vmcnt(11)
v_mfma_f32_16x16x32_bf16 v[48:51], a[48:51], v[92:95], v[48:51]
ds_read_b64_tr_b16 a[20:21], v7 offset:17696
ds_read_b64_tr_b16 a[22:23], v7 offset:18208
s_waitcnt lgkmcnt(15)
v_mfma_f32_16x16x32_bf16 v[36:39], a[52:55], v[88:91], v[36:39]
ds_read_b64_tr_b16 a[24:25], v7 offset:17728
ds_read_b64_tr_b16 a[26:27], v7 offset:18240
v_mfma_f32_16x16x32_bf16 v[52:55], a[52:55], v[92:95], v[52:55]
buffer_load_dwordx4 v[76:79], v4, s[16:19], s53 offen offset:1024 sc1
s_waitcnt lgkmcnt(15)
v_mfma_f32_16x16x32_bf16 v[40:43], a[56:59], v[88:91], v[40:43]
ds_read_b64_tr_b16 a[28:29], v7 offset:17760
s_add_u32 s53, s53, 0x40000
v_mfma_f32_16x16x32_bf16 v[56:59], a[56:59], v[92:95], v[56:59]
ds_read_b64_tr_b16 a[30:31], v7 offset:18272
s_waitcnt lgkmcnt(15)
v_mfma_f32_16x16x32_bf16 v[44:47], a[60:63], v[88:91], v[44:47]
v_mfma_f32_16x16x32_bf16 v[60:63], a[60:63], v[92:95], v[60:63]
s_waitcnt vmcnt(11) lgkmcnt(14)
v_mfma_f32_16x16x32_bf16 v[32:35], a[0:3], v[96:99], v[32:35]
ds_read_b64_tr_b16 a[32:33], v7 offset:24960
ds_read_b64_tr_b16 a[34:35], v7 offset:25472
s_waitcnt vmcnt(10)
v_mfma_f32_16x16x32_bf16 v[48:51], a[0:3], v[100:103], v[48:51]
buffer_load_dwordx4 v[80:83], v4, s[16:19], s52 offen sc1
s_waitcnt lgkmcnt(14)
v_mfma_f32_16x16x32_bf16 v[36:39], a[4:7], v[96:99], v[36:39]
ds_read_b64_tr_b16 a[36:37], v7 offset:24992
ds_read_b64_tr_b16 a[38:39], v7 offset:25504
v_mfma_f32_16x16x32_bf16 v[52:55], a[4:7], v[100:103], v[52:55]
ds_read_b64_tr_b16 a[40:41], v7 offset:25024
ds_read_b64_tr_b16 a[42:43], v7 offset:25536
s_waitcnt lgkmcnt(15)
v_mfma_f32_16x16x32_bf16 v[40:43], a[8:11], v[96:99], v[40:43]
buffer_load_dwordx4 v[84:87], v4, s[16:19], s52 offen offset:1024 sc1
v_mfma_f32_16x16x32_bf16 v[56:59], a[8:11], v[100:103], v[56:59]
ds_read_b64_tr_b16 a[44:45], v7 offset:25056
s_add_u32 s52, s52, 0x40000
s_waitcnt lgkmcnt(15)
v_mfma_f32_16x16x32_bf16 v[44:47], a[12:15], v[96:99], v[44:47]
ds_read_b64_tr_b16 a[46:47], v7 offset:25568
v_mfma_f32_16x16x32_bf16 v[60:63], a[12:15], v[100:103], v[60:63]
ds_read_b64_tr_b16 a[48:49], v7 offset:25984
ds_read_b64_tr_b16 a[50:51], v7 offset:26496
s_waitcnt vmcnt(11) lgkmcnt(15)
v_mfma_f32_16x16x32_bf16 v[32:35], a[16:19], v[104:107], v[32:35]
buffer_load_dwordx4 v[88:91], v4, s[16:19], s53 offen sc1
s_waitcnt vmcnt(11)
v_mfma_f32_16x16x32_bf16 v[48:51], a[16:19], v[108:111], v[48:51]
ds_read_b64_tr_b16 a[52:53], v7 offset:26016
ds_read_b64_tr_b16 a[54:55], v7 offset:26528
s_waitcnt lgkmcnt(15)
v_mfma_f32_16x16x32_bf16 v[36:39], a[20:23], v[104:107], v[36:39]
ds_read_b64_tr_b16 a[56:57], v7 offset:26048
ds_read_b64_tr_b16 a[58:59], v7 offset:26560
v_mfma_f32_16x16x32_bf16 v[52:55], a[20:23], v[108:111], v[52:55]
buffer_load_dwordx4 v[92:95], v4, s[16:19], s53 offen offset:1024 sc1
s_waitcnt lgkmcnt(15)
v_mfma_f32_16x16x32_bf16 v[40:43], a[24:27], v[104:107], v[40:43]
ds_read_b64_tr_b16 a[60:61], v7 offset:26080
s_add_u32 s53, s53, 0x40000
v_mfma_f32_16x16x32_bf16 v[56:59], a[24:27], v[108:111], v[56:59]
ds_read_b64_tr_b16 a[62:63], v7 offset:26592
s_waitcnt lgkmcnt(15)
v_mfma_f32_16x16x32_bf16 v[44:47], a[28:31], v[104:107], v[44:47]
v_mfma_f32_16x16x32_bf16 v[60:63], a[28:31], v[108:111], v[60:63]
s_waitcnt lgkmcnt(0)
s_barrier
s_waitcnt vmcnt(11)
v_mfma_f32_16x16x32_bf16 v[32:35], a[32:35], v[112:115], v[32:35]
ds_read_b64_tr_b16 a[0:1], v7 offset:33280
ds_read_b64_tr_b16 a[2:3], v7 offset:33792
ds_read_b64_tr_b16 a[4:5], v7 offset:33312
s_waitcnt vmcnt(10)
v_mfma_f32_16x16x32_bf16 v[48:51], a[32:35], v[116:119], v[48:51]
ds_read_b64_tr_b16 a[6:7], v7 offset:33824
buffer_load_dwordx4 v[96:99], v4, s[16:19], s52 offen sc1
v_mfma_f32_16x16x32_bf16 v[36:39], a[36:39], v[112:115], v[36:39]
ds_read_b64_tr_b16 a[8:9], v7 offset:33344
buffer_load_dwordx4 v[100:103], v4, s[16:19], s52 offen offset:1024 sc1
v_mfma_f32_16x16x32_bf16 v[52:55], a[36:39], v[116:119], v[52:55]
ds_read_b64_tr_b16 a[10:11], v7 offset:33856
s_add_u32 s52, s52, 0x40000
v_mfma_f32_16x16x32_bf16 v[40:43], a[40:43], v[112:115], v[40:43]
ds_read_b64_tr_b16 a[12:13], v7 offset:33376
buffer_load_dwordx4 v[104:107], v4, s[16:19], s53 offen sc1
v_mfma_f32_16x16x32_bf16 v[56:59], a[40:43], v[116:119], v[56:59]
ds_read_b64_tr_b16 a[14:15], v7 offset:33888
ds_read_b64_tr_b16 a[16:17], v7 offset:34304
ds_read_b64_tr_b16 a[18:19], v7 offset:34816
v_mfma_f32_16x16x32_bf16 v[44:47], a[44:47], v[112:115], v[44:47]
ds_read_b64_tr_b16 a[20:21], v7 offset:34336
buffer_load_dwordx4 v[108:111], v4, s[16:19], s53 offen offset:1024 sc1
v_mfma_f32_16x16x32_bf16 v[60:63], a[44:47], v[116:119], v[60:63]
ds_read_b64_tr_b16 a[22:23], v7 offset:34848
s_add_u32 s53, s53, 0x40000
s_add_u32 m0, s59, 83200
s_waitcnt vmcnt(13)
v_mfma_f32_16x16x32_bf16 v[32:35], a[48:51], v[120:123], v[32:35]
ds_read_b64_tr_b16 a[24:25], v7 offset:34368
buffer_load_dwordx4 v12, s[32:35], s58 offen lds
s_waitcnt vmcnt(13)
v_mfma_f32_16x16x32_bf16 v[48:51], a[48:51], v[124:127], v[48:51]
ds_read_b64_tr_b16 a[26:27], v7 offset:34880
buffer_load_dwordx4 v13, s[32:35], s58 offen offset:1056 lds
v_mfma_f32_16x16x32_bf16 v[36:39], a[52:55], v[120:123], v[36:39]
ds_read_b64_tr_b16 a[28:29], v7 offset:34400
ds_read_b64_tr_b16 a[30:31], v7 offset:34912
v_mfma_f32_16x16x32_bf16 v[52:55], a[52:55], v[124:127], v[52:55]
buffer_load_dwordx4 v14, s[32:35], s58 offen offset:2112 lds
v_mfma_f32_16x16x32_bf16 v[40:43], a[56:59], v[120:123], v[40:43]
v_mfma_f32_16x16x32_bf16 v[56:59], a[56:59], v[124:127], v[56:59]
buffer_load_dwordx4 v15, s[32:35], s58 offen offset:3168 lds
v_mfma_f32_16x16x32_bf16 v[44:47], a[60:63], v[120:123], v[44:47]
s_add_u32 s58, s58, 229376
v_mfma_f32_16x16x32_bf16 v[60:63], a[60:63], v[124:127], v[60:63]
s_waitcnt vmcnt(15) lgkmcnt(14)
v_mfma_f32_16x16x32_bf16 v[32:35], a[0:3], v[64:67], v[32:35]
ds_read_b64_tr_b16 a[32:33], v7 offset:41600
ds_read_b64_tr_b16 a[34:35], v7 offset:42112
s_waitcnt vmcnt(14)
v_mfma_f32_16x16x32_bf16 v[48:51], a[0:3], v[68:71], v[48:51]
ds_read_b64_tr_b16 a[36:37], v7 offset:41632
buffer_load_dwordx4 v[112:115], v4, s[16:19], s52 offen sc1
s_waitcnt lgkmcnt(15)
v_mfma_f32_16x16x32_bf16 v[36:39], a[4:7], v[64:67], v[36:39]
ds_read_b64_tr_b16 a[38:39], v7 offset:42144
buffer_load_dwordx4 v[116:119], v4, s[16:19], s52 offen offset:1024 sc1
v_mfma_f32_16x16x32_bf16 v[52:55], a[4:7], v[68:71], v[52:55]
ds_read_b64_tr_b16 a[40:41], v7 offset:41664
ds_read_b64_tr_b16 a[42:43], v7 offset:42176
s_add_u32 s52, s52, 0x40000
s_waitcnt lgkmcnt(15)
v_mfma_f32_16x16x32_bf16 v[40:43], a[8:11], v[64:67], v[40:43]
buffer_load_dwordx4 v[120:123], v4, s[16:19], s53 offen sc1
v_mfma_f32_16x16x32_bf16 v[56:59], a[8:11], v[68:71], v[56:59]
ds_read_b64_tr_b16 a[44:45], v7 offset:41696
ds_read_b64_tr_b16 a[46:47], v7 offset:42208
s_waitcnt lgkmcnt(15)
v_mfma_f32_16x16x32_bf16 v[44:47], a[12:15], v[64:67], v[44:47]
ds_read_b64_tr_b16 a[48:49], v7 offset:42624
buffer_load_dwordx4 v[124:127], v4, s[16:19], s53 offen offset:1024 sc1
v_mfma_f32_16x16x32_bf16 v[60:63], a[12:15], v[68:71], v[60:63]
ds_read_b64_tr_b16 a[50:51], v7 offset:43136
s_add_u32 s53, s53, 0x40000
s_add_u32 m0, s59, 100096
s_waitcnt vmcnt(17) lgkmcnt(15)
v_mfma_f32_16x16x32_bf16 v[32:35], a[16:19], v[72:75], v[32:35]
ds_read_b64_tr_b16 a[52:53], v7 offset:42656
buffer_load_dwordx4 v12, s[32:35], s58 offen lds
s_waitcnt vmcnt(17)
v_mfma_f32_16x16x32_bf16 v[48:51], a[16:19], v[76:79], v[48:51]
buffer_load_dwordx4 v13, s[32:35], s58 offen offset:1056 lds
s_waitcnt lgkmcnt(15)
v_mfma_f32_16x16x32_bf16 v[36:39], a[20:23], v[72:75], v[36:39]
ds_read_b64_tr_b16 a[54:55], v7 offset:43168
ds_read_b64_tr_b16 a[56:57], v7 offset:42688
v_mfma_f32_16x16x32_bf16 v[52:55], a[20:23], v[76:79], v[52:55]
ds_read_b64_tr_b16 a[58:59], v7 offset:43200
buffer_load_dwordx4 v14, s[32:35], s58 offen offset:2112 lds
s_waitcnt lgkmcnt(15)
v_mfma_f32_16x16x32_bf16 v[40:43], a[24:27], v[72:75], v[40:43]
ds_read_b64_tr_b16 a[60:61], v7 offset:42720
ds_read_b64_tr_b16 a[62:63], v7 offset:43232
v_mfma_f32_16x16x32_bf16 v[56:59], a[24:27], v[76:79], v[56:59]
buffer_load_dwordx4 v15, s[32:35], s58 offen offset:3168 lds
s_waitcnt lgkmcnt(15)
v_mfma_f32_16x16x32_bf16 v[44:47], a[28:31], v[72:75], v[44:47]
s_add_u32 s58, s58, 229376
v_mfma_f32_16x16x32_bf16 v[60:63], a[28:31], v[76:79], v[60:63]
s_waitcnt vmcnt(19) lgkmcnt(14)
v_mfma_f32_16x16x32_bf16 v[32:35], a[32:35], v[80:83], v[32:35]
ds_read_b64_tr_b16 a[0:1], v7 offset:49920
s_add_u32 m0, s59, 116992
s_waitcnt vmcnt(18)
v_mfma_f32_16x16x32_bf16 v[48:51], a[32:35], v[84:87], v[48:51]
buffer_load_dwordx4 v12, s[32:35], s58 offen lds
s_waitcnt lgkmcnt(13)
v_mfma_f32_16x16x32_bf16 v[36:39], a[36:39], v[80:83], v[36:39]
ds_read_b64_tr_b16 a[2:3], v7 offset:50432
ds_read_b64_tr_b16 a[4:5], v7 offset:49952
v_mfma_f32_16x16x32_bf16 v[52:55], a[36:39], v[84:87], v[52:55]
ds_read_b64_tr_b16 a[6:7], v7 offset:50464
ds_read_b64_tr_b16 a[8:9], v7 offset:49984
s_waitcnt lgkmcnt(15)
v_mfma_f32_16x16x32_bf16 v[40:43], a[40:43], v[80:83], v[40:43]
buffer_load_dwordx4 v13, s[32:35], s58 offen offset:1056 lds
v_mfma_f32_16x16x32_bf16 v[56:59], a[40:43], v[84:87], v[56:59]
ds_read_b64_tr_b16 a[10:11], v7 offset:50496
ds_read_b64_tr_b16 a[12:13], v7 offset:50016
s_waitcnt lgkmcnt(15)
v_mfma_f32_16x16x32_bf16 v[44:47], a[44:47], v[80:83], v[44:47]
ds_read_b64_tr_b16 a[14:15], v7 offset:50528
v_mfma_f32_16x16x32_bf16 v[60:63], a[44:47], v[84:87], v[60:63]
ds_read_b64_tr_b16 a[16:17], v7 offset:50944
ds_read_b64_tr_b16 a[18:19], v7 offset:51456
s_waitcnt vmcnt(19) lgkmcnt(15)
v_mfma_f32_16x16x32_bf16 v[32:35], a[48:51], v[88:91], v[32:35]
buffer_load_dwordx4 v14, s[32:35], s58 offen offset:2112 lds
s_waitcnt vmcnt(19)
v_mfma_f32_16x16x32_bf16 v[48:51], a[48:51], v[92:95], v[48:51]
ds_read_b64_tr_b16 a[20:21], v7 offset:50976
ds_read_b64_tr_b16 a[22:23], v7 offset:51488
s_waitcnt lgkmcnt(15)
v_mfma_f32_16x16x32_bf16 v[36:39], a[52:55], v[88:91], v[36:39]
ds_read_b64_tr_b16 a[24:25], v7 offset:51008
ds_read_b64_tr_b16 a[26:27], v7 offset:51520
v_mfma_f32_16x16x32_bf16 v[52:55], a[52:55], v[92:95], v[52:55]
buffer_load_dwordx4 v15, s[32:35], s58 offen offset:3168 lds
s_waitcnt lgkmcnt(15)
v_mfma_f32_16x16x32_bf16 v[40:43], a[56:59], v[88:91], v[40:43]
ds_read_b64_tr_b16 a[28:29], v7 offset:51040
s_add_u32 s58, s58, 229376
v_mfma_f32_16x16x32_bf16 v[56:59], a[56:59], v[92:95], v[56:59]
ds_read_b64_tr_b16 a[30:31], v7 offset:51552
s_waitcnt lgkmcnt(15)
v_mfma_f32_16x16x32_bf16 v[44:47], a[60:63], v[88:91], v[44:47]
v_mfma_f32_16x16x32_bf16 v[60:63], a[60:63], v[92:95], v[60:63]
s_waitcnt vmcnt(19) lgkmcnt(14)
v_mfma_f32_16x16x32_bf16 v[32:35], a[0:3], v[96:99], v[32:35]
ds_read_b64_tr_b16 a[32:33], v7 offset:58240
s_add_u32 m0, s59, 133888
s_waitcnt vmcnt(18)
v_mfma_f32_16x16x32_bf16 v[48:51], a[0:3], v[100:103], v[48:51]
buffer_load_dwordx4 v12, s[32:35], s58 offen lds
s_waitcnt lgkmcnt(13)
v_mfma_f32_16x16x32_bf16 v[36:39], a[4:7], v[96:99], v[36:39]
ds_read_b64_tr_b16 a[34:35], v7 offset:58752
ds_read_b64_tr_b16 a[36:37], v7 offset:58272
v_mfma_f32_16x16x32_bf16 v[52:55], a[4:7], v[100:103], v[52:55]
ds_read_b64_tr_b16 a[38:39], v7 offset:58784
ds_read_b64_tr_b16 a[40:41], v7 offset:58304
s_waitcnt lgkmcnt(15)
v_mfma_f32_16x16x32_bf16 v[40:43], a[8:11], v[96:99], v[40:43]
buffer_load_dwordx4 v13, s[32:35], s58 offen offset:1056 lds
v_mfma_f32_16x16x32_bf16 v[56:59], a[8:11], v[100:103], v[56:59]
ds_read_b64_tr_b16 a[42:43], v7 offset:58816
ds_read_b64_tr_b16 a[44:45], v7 offset:58336
s_waitcnt lgkmcnt(15)
v_mfma_f32_16x16x32_bf16 v[44:47], a[12:15], v[96:99], v[44:47]
ds_read_b64_tr_b16 a[46:47], v7 offset:58848
v_mfma_f32_16x16x32_bf16 v[60:63], a[12:15], v[100:103], v[60:63]
ds_read_b64_tr_b16 a[48:49], v7 offset:59264
ds_read_b64_tr_b16 a[50:51], v7 offset:59776
s_waitcnt vmcnt(19) lgkmcnt(15)
v_mfma_f32_16x16x32_bf16 v[32:35], a[16:19], v[104:107], v[32:35]
buffer_load_dwordx4 v14, s[32:35], s58 offen offset:2112 lds
s_waitcnt vmcnt(19)
v_mfma_f32_16x16x32_bf16 v[48:51], a[16:19], v[108:111], v[48:51]
ds_read_b64_tr_b16 a[52:53], v7 offset:59296
ds_read_b64_tr_b16 a[54:55], v7 offset:59808
s_waitcnt lgkmcnt(15)
v_mfma_f32_16x16x32_bf16 v[36:39], a[20:23], v[104:107], v[36:39]
ds_read_b64_tr_b16 a[56:57], v7 offset:59328
ds_read_b64_tr_b16 a[58:59], v7 offset:59840
v_mfma_f32_16x16x32_bf16 v[52:55], a[20:23], v[108:111], v[52:55]
buffer_load_dwordx4 v15, s[32:35], s58 offen offset:3168 lds
s_waitcnt lgkmcnt(15)
v_mfma_f32_16x16x32_bf16 v[40:43], a[24:27], v[104:107], v[40:43]
ds_read_b64_tr_b16 a[60:61], v7 offset:59360
s_add_u32 s58, s58, 229376
v_mfma_f32_16x16x32_bf16 v[56:59], a[24:27], v[108:111], v[56:59]
ds_read_b64_tr_b16 a[62:63], v7 offset:59872
s_waitcnt lgkmcnt(15)
v_mfma_f32_16x16x32_bf16 v[44:47], a[28:31], v[104:107], v[44:47]
v_mfma_f32_16x16x32_bf16 v[60:63], a[28:31], v[108:111], v[60:63]
s_waitcnt vmcnt(15) lgkmcnt(14)
v_mfma_f32_16x16x32_bf16 v[32:35], a[32:35], v[112:115], v[32:35]
s_lshl_b32 s64, s6, 14
s_lshl_b32 s65, s49, 13
s_add_u32 s64, s64, s65
s_waitcnt vmcnt(14)
v_mfma_f32_16x16x32_bf16 v[48:51], a[32:35], v[116:119], v[48:51]
s_lshl_b32 s65, s7, 9
s_add_u32 s64, s64, s65
s_lshl_b32 s65, s48, 8
s_waitcnt lgkmcnt(12)
v_mfma_f32_16x16x32_bf16 v[36:39], a[36:39], v[112:115], v[36:39]
s_add_u32 s64, s64, s65
s_add_u32 s64, s64, 29622272
v_and_b32 v152, 31, v1
v_mfma_f32_16x16x32_bf16 v[52:55], a[36:39], v[116:119], v[52:55]
s_lshl_b32 s62, s7, 18
v_lshlrev_b32 v152, 3, v152
v_lshrrev_b32 v153, 5, v1
s_waitcnt lgkmcnt(10)
v_mfma_f32_16x16x32_bf16 v[40:43], a[40:43], v[112:115], v[40:43]
s_add_u32 s62, s62, 8388608
.Lpad9:
s_cbranch_execz .Lnopoll16r
v_lshl_add_u32 v152, v153, 2, v152
s_add_u32 s63, s62, 0x20000
v_mfma_f32_16x16x32_bf16 v[56:59], a[40:43], v[116:119], v[56:59]
s_waitcnt lgkmcnt(8)
v_mfma_f32_16x16x32_bf16 v[44:47], a[44:47], v[112:115], v[44:47]
v_mfma_f32_16x16x32_bf16 v[60:63], a[44:47], v[116:119], v[60:63]
s_waitcnt vmcnt(13) lgkmcnt(6)
v_mfma_f32_16x16x32_bf16 v[32:35], a[48:51], v[120:123], v[32:35]
s_waitcnt vmcnt(12)
v_mfma_f32_16x16x32_bf16 v[48:51], a[48:51], v[124:127], v[48:51]
s_waitcnt lgkmcnt(4)
v_mfma_f32_16x16x32_bf16 v[36:39], a[52:55], v[120:123], v[36:39]
s_nop 3
v_cvt_pk_bf16_f32 v128, v32, v33
v_cvt_pk_bf16_f32 v129, v34, v35
v_mfma_f32_16x16x32_bf16 v[52:55], a[52:55], v[124:127], v[52:55]
v_cvt_pk_bf16_f32 v136, v48, v49
v_cvt_pk_bf16_f32 v137, v50, v51
s_waitcnt lgkmcnt(2)
v_mfma_f32_16x16x32_bf16 v[40:43], a[56:59], v[120:123], v[40:43]
v_cvt_pk_bf16_f32 v130, v36, v37
v_cvt_pk_bf16_f32 v131, v38, v39
v_mfma_f32_16x16x32_bf16 v[56:59], a[56:59], v[124:127], v[56:59]
buffer_store_dwordx4 v[128:131], v4, s[16:19], s62 offen sc1
s_waitcnt lgkmcnt(0)
v_mfma_f32_16x16x32_bf16 v[44:47], a[60:63], v[120:123], v[44:47]
s_nop 1
v_cvt_pk_bf16_f32 v132, v40, v41
v_cvt_pk_bf16_f32 v133, v42, v43
v_mfma_f32_16x16x32_bf16 v[60:63], a[60:63], v[124:127], v[60:63]
v_cvt_pk_bf16_f32 v138, v52, v53
v_cvt_pk_bf16_f32 v139, v54, v55
v_cvt_pk_bf16_f32 v140, v56, v57
v_cvt_pk_bf16_f32 v134, v44, v45
v_cvt_pk_bf16_f32 v135, v46, v47
v_cvt_pk_bf16_f32 v141, v58, v59
v_pk_mul_f32 v[146:147], v[32:33], v[32:33]
buffer_store_dwordx4 v[132:135], v4, s[16:19], s63 offen sc1
v_cvt_pk_bf16_f32 v142, v60, v61
v_cvt_pk_bf16_f32 v143, v62, v63
v_pk_mul_f32 v[150:151], v[48:49], v[48:49]
v_pk_fma_f32 v[146:147], v[34:35], v[34:35], v[146:147]
v_pk_add_f32 v[144:145], v[32:33], v[34:35]
v_pk_fma_f32 v[150:151], v[50:51], v[50:51], v[150:151]
v_pk_add_f32 v[148:149], v[48:49], v[50:51]
v_pk_fma_f32 v[146:147], v[36:37], v[36:37], v[146:147]
v_pk_add_f32 v[144:145], v[144:145], v[36:37]
v_pk_fma_f32 v[150:151], v[52:53], v[52:53], v[150:151]
v_pk_add_f32 v[148:149], v[148:149], v[52:53]
v_pk_fma_f32 v[146:147], v[38:39], v[38:39], v[146:147]
v_pk_add_f32 v[144:145], v[144:145], v[38:39]
buffer_store_dwordx4 v[136:139], v4, s[16:19], s62 offen offset:1024 sc1
v_pk_fma_f32 v[150:151], v[54:55], v[54:55], v[150:151]
v_pk_add_f32 v[148:149], v[148:149], v[54:55]
v_pk_fma_f32 v[146:147], v[40:41], v[40:41], v[146:147]
v_pk_add_f32 v[144:145], v[144:145], v[40:41]
v_pk_fma_f32 v[150:151], v[56:57], v[56:57], v[150:151]
v_pk_add_f32 v[148:149], v[148:149], v[56:57]
v_pk_fma_f32 v[146:147], v[42:43], v[42:43], v[146:147]
v_pk_add_f32 v[144:145], v[144:145], v[42:43]
v_pk_fma_f32 v[150:151], v[58:59], v[58:59], v[150:151]
v_pk_add_f32 v[148:149], v[148:149], v[58:59]
v_pk_fma_f32 v[146:147], v[44:45], v[44:45], v[146:147]
v_pk_add_f32 v[144:145], v[144:145], v[44:45]
v_pk_fma_f32 v[150:151], v[60:61], v[60:61], v[150:151]
buffer_store_dwordx4 v[140:143], v4, s[16:19], s63 offen offset:1024 sc1
v_pk_add_f32 v[148:149], v[148:149], v[60:61]
v_pk_fma_f32 v[146:147], v[46:47], v[46:47], v[146:147]
v_pk_add_f32 v[144:145], v[144:145], v[46:47]
v_pk_fma_f32 v[150:151], v[62:63], v[62:63], v[150:151]
v_pk_add_f32 v[148:149], v[148:149], v[62:63]
v_add_f32 v144, v144, v145
v_add_f32 v146, v146, v147
v_add_f32 v148, v148, v149
v_add_f32 v150, v150, v151
s_nop 0
v_permlane16_swap_b32 v144, v148
v_permlane16_swap_b32 v146, v150
v_add_f32 v144, v144, v148
v_add_f32 v146, v146, v150
s_nop 1
v_permlane32_swap_b32 v144, v146
v_add_f32 v144, v144, v146
buffer_store_dword v144, v152, s[16:19], s64 offen sc1
s_nop 1
v_accvgpr_write_b32 a224, v32
v_accvgpr_write_b32 a225, v33
v_accvgpr_write_b32 a226, v34
v_accvgpr_write_b32 a227, v35
v_accvgpr_write_b32 a228, v36
v_accvgpr_write_b32 a229, v37
v_accvgpr_write_b32 a230, v38
v_accvgpr_write_b32 a231, v39
v_accvgpr_write_b32 a232, v40
v_accvgpr_write_b32 a233, v41
v_accvgpr_write_b32 a234, v42
v_accvgpr_write_b32 a235, v43
v_accvgpr_write_b32 a236, v44
v_accvgpr_write_b32 a237, v45
v_accvgpr_write_b32 a238, v46
v_accvgpr_write_b32 a239, v47
v_accvgpr_write_b32 a240, v48
v_accvgpr_write_b32 a241, v49
v_accvgpr_write_b32 a242, v50
v_accvgpr_write_b32 a243, v51
v_accvgpr_write_b32 a244, v52
v_accvgpr_write_b32 a245, v53
v_accvgpr_write_b32 a246, v54
v_accvgpr_write_b32 a247, v55
v_accvgpr_write_b32 a248, v56
v_accvgpr_write_b32 a249, v57
v_accvgpr_write_b32 a250, v58
v_accvgpr_write_b32 a251, v59
v_accvgpr_write_b32 a252, v60
v_accvgpr_write_b32 a253, v61
v_accvgpr_write_b32 a254, v62
v_accvgpr_write_b32 a255, v63
s_lshl_b32 s62, s10, 14
s_lshl_b32 s63, s3, 12
s_add_u32 s62, s62, s63
s_lshl_b32 s63, s12, 11
s_add_u32 s62, s62, s63
v_lshl_add_u32 v10, v1, 4, s62
v_lshrrev_b32 v2, 3, v1
v_cmp_eq_u32 vcc, 3, v2
v_add_u32 v2, 67108480, v10
s_nop 0
v_cndmask_b32 v10, v10, v2, vcc
v_xor_b32 v11, 2048, v10
v_bfe_u32 v16, v1, 2, 3
v_mul_u32_u24 v16, 1056, v16
v_bfe_u32 v2, v1, 5, 1
v_lshl_add_u32 v16, v2, 8, v16
v_and_b32 v2, 3, v1
v_lshl_add_u32 v16, v2, 3, v16
s_lshl_b32 s62, s12, 6
s_add_u32 s62, s62, 83200
s_xor_b32 s63, s12, 1
s_mul_i32 s63, s63, 192
s_add_u32 s63, s63, 83200
v_add_u32 v17, s63, v16
v_add_u32 v16, s62, v16
s_mov_b32 s52, 8388608
s_mov_b32 s54, s58
s_mov_b32 s55, s59
s_mul_i32 s59, s3, 2080
s_lshl_b32 s62, s10, 15
s_lshl_b32 s63, s3, 13
s_add_u32 s62, s62, s63
v_lshl_add_u32 v4, v1, 4, s62
s_lshl_b32 s62, s2, 12
v_lshrrev_b32 v7, 3, v0
v_lshl_add_u32 v7, v7, 7, s62
s_mov_b32 s44, 0
s_mov_b32 s45, 1835008
s_lshl_b32 s62, s2, 1
s_add_u32 s62, s62, s48
s_mul_i32 s62, s62, 1792
v_lshrrev_b32 v8, 2, v1
v_min_u32 v8, 13, v8
v_lshl_add_u32 v8, v8, 7, s62
v_and_b32 v2, 1, v1
v_lshlrev_b32 v2, 4, v2
v_mov_b32 v9, 0x3f80
v_lshlrev_b32 v2, v2, v9
v_bfe_u32 v9, v1, 1, 3
v_cmp_eq_u32 vcc, 0, v9
s_nop 1
v_cndmask_b32 v20, 0, v2, vcc
v_cmp_eq_u32 vcc, 1, v9
s_nop 1
v_cndmask_b32 v21, 0, v2, vcc
v_cmp_eq_u32 vcc, 2, v9
s_nop 1
v_cndmask_b32 v22, 0, v2, vcc
v_cmp_eq_u32 vcc, 3, v9
s_nop 1
v_cndmask_b32 v23, 0, v2, vcc
s_add_u32 s62, s55, 83200
v_lshl_add_u32 v9, v1, 4, s62
v_mov_b64 v[24:25], 0
v_mov_b64 v[26:27], 0
s_lshl_b32 s62, s6, 7
s_add_u32 s62, s62, 30412800
s_lshl_b32 s64, s10, 1
s_lshl_b32 s64, s64, 7
s_add_u32 s64, s64, 30412800
s_add_u32 s65, s64, 128
v_mov_b32 v252, s62
v_mov_b32 v253, s64
v_writelane_b32 v253, s65, 1
s_waitcnt vmcnt(0) lgkmcnt(0)
s_barrier
s_cmp_lg_u32 s3, 0
s_cbranch_scc1 .Lnosig17
v_mov_b32 v255, 1
s_mov_b64 exec, 1
buffer_atomic_add v255, v252, s[16:19], 0 offen
s_mov_b64 exec, -1
.Lnosig17:
ds_read_b64_tr_b16 a[0:1], v16
ds_read_b64_tr_b16 a[2:3], v16 offset:512
ds_read_b64_tr_b16 a[4:5], v16 offset:32
ds_read_b64_tr_b16 a[6:7], v16 offset:544
ds_read_b64_tr_b16 a[8:9], v16 offset:8448
ds_read_b64_tr_b16 a[10:11], v16 offset:8960
ds_read_b64_tr_b16 a[12:13], v16 offset:8480
ds_read_b64_tr_b16 a[14:15], v16 offset:8992
ds_read_b64_tr_b16 a[16:17], v16 offset:64
ds_read_b64_tr_b16 a[18:19], v16 offset:576
ds_read_b64_tr_b16 a[20:21], v16 offset:96
ds_read_b64_tr_b16 a[22:23], v16 offset:608
ds_read_b64_tr_b16 a[24:25], v16 offset:8512
ds_read_b64_tr_b16 a[26:27], v16 offset:9024
ds_read_b64_tr_b16 a[28:29], v16 offset:8544
ds_read_b64_tr_b16 a[30:31], v16 offset:9056
ds_read_b64_tr_b16 a[32:33], v16 offset:128
ds_read_b64_tr_b16 a[34:35], v16 offset:640
ds_read_b64_tr_b16 a[36:37], v16 offset:160
ds_read_b64_tr_b16 a[38:39], v16 offset:672
ds_read_b64_tr_b16 a[40:41], v16 offset:8576
ds_read_b64_tr_b16 a[42:43], v16 offset:9088
ds_read_b64_tr_b16 a[44:45], v16 offset:8608
ds_read_b64_tr_b16 a[46:47], v16 offset:9120
ds_read_b64_tr_b16 a[48:49], v17
ds_read_b64_tr_b16 a[50:51], v17 offset:512
ds_read_b64_tr_b16 a[52:53], v17 offset:32
ds_read_b64_tr_b16 a[54:55], v17 offset:544
ds_read_b64_tr_b16 a[56:57], v17 offset:8448
ds_read_b64_tr_b16 a[58:59], v17 offset:8960
ds_read_b64_tr_b16 a[60:61], v17 offset:8480
ds_read_b64_tr_b16 a[62:63], v17 offset:8992
ds_read_b128 a[192:195], v9
ds_read_b128 a[196:199], v9 offset:1056
ds_read_b128 a[200:203], v9 offset:2112
ds_read_b128 a[204:207], v9 offset:3168
s_waitcnt lgkmcnt(0)
s_cmp_lg_u32 s3, 1
s_cbranch_scc1 .Lnopoll20
s_mov_b64 exec, 3
s_mov_b32 s15, 0
.Lpoll18:
buffer_load_dword v255, v253, s[16:19], 0 offen sc1
s_add_u32 s15, s15, 1
s_cmp_gt_u32 s15, 100000
s_cbranch_scc1 .Lgot19
s_waitcnt vmcnt(0)
v_cmp_ne_u32 vcc, 16, v255
s_nop 0
s_cbranch_vccnz .Lpoll18
.Lgot19:
s_waitcnt vmcnt(0)
s_branch .Lnopoll20r
.Lnopoll20:
s_mov_b64 exec, 0
s_cmp_eq_u32 s3, 2
s_cbranch_scc1 .Lpad10
s_cmp_eq_u32 s3, 3
s_cbranch_scc1 .Lpad11
s_branch .Lpad12
.Lnopoll20r:
s_mov_b64 exec, -1
s_barrier
buffer_load_dwordx4 a[128:131], v10, s[16:19], s52 offen sc1
buffer_load_dwordx4 a[132:135], v10, s[16:19], s52 offen offset:1024 sc1
buffer_load_dwordx4 a[136:139], v11, s[16:19], s52 offen sc1
buffer_load_dwordx4 a[140:143], v11, s[16:19], s52 offen offset:1024 sc1
s_add_u32 s52, s52, 0x20000
buffer_load_dwordx4 a[144:147], v10, s[16:19], s52 offen sc1
buffer_load_dwordx4 a[148:151], v10, s[16:19], s52 offen offset:1024 sc1
buffer_load_dwordx4 a[152:155], v11, s[16:19], s52 offen sc1
buffer_load_dwordx4 a[156:159], v11, s[16:19], s52 offen offset:1024 sc1
s_add_u32 s52, s52, 0x20000
s_lshl_b32 s74, s3, 13
s_add_u32 s74, s74, 49920
v_lshl_add_u32 v2, v1, 4, s74
s_waitcnt vmcnt(7)
v_mfma_f32_16x16x32_bf16 v[32:35], a[0:3], a[128:131], 0
ds_read_b64_tr_b16 a[64:65], v16 offset:16896
s_waitcnt vmcnt(6)
v_mfma_f32_16x16x32_bf16 v[36:39], a[0:3], a[132:135], 0
buffer_load_dwordx4 a[160:163], v10, s[16:19], s52 offen sc1
s_waitcnt vmcnt(6)
v_mfma_f32_16x16x32_bf16 v[40:43], a[0:3], a[136:139], 0
ds_read_b64_tr_b16 a[66:67], v16 offset:17408
s_waitcnt vmcnt(5)
v_mfma_f32_16x16x32_bf16 v[44:47], a[0:3], a[140:143], 0
ds_read_b64_tr_b16 a[68:69], v16 offset:16928
v_mfma_f32_16x16x32_bf16 v[48:51], a[4:7], a[128:131], 0
ds_read_b64_tr_b16 a[70:71], v16 offset:17440
v_mfma_f32_16x16x32_bf16 v[52:55], a[4:7], a[132:135], 0
buffer_load_dwordx4 a[164:167], v10, s[16:19], s52 offen offset:1024 sc1
v_mfma_f32_16x16x32_bf16 v[24:27], v[20:23], a[192:195], v[24:27]
ds_read_b64_tr_b16 a[72:73], v16 offset:25344
v_mfma_f32_16x16x32_bf16 v[56:59], a[4:7], a[136:139], 0
ds_read_b64_tr_b16 a[74:75], v16 offset:25856
v_mfma_f32_16x16x32_bf16 v[60:63], a[4:7], a[140:143], 0
v_mfma_f32_16x16x32_bf16 v[64:67], a[8:11], a[128:131], 0
buffer_load_dwordx4 a[168:171], v11, s[16:19], s52 offen sc1
v_mfma_f32_16x16x32_bf16 v[68:71], a[8:11], a[132:135], 0
ds_read_b64_tr_b16 a[76:77], v16 offset:25376
v_mfma_f32_16x16x32_bf16 v[72:75], a[8:11], a[136:139], 0
ds_read_b64_tr_b16 a[78:79], v16 offset:25888
v_mfma_f32_16x16x32_bf16 v[76:79], a[8:11], a[140:143], 0
ds_read_b64_tr_b16 a[80:81], v16 offset:16960
v_mfma_f32_16x16x32_bf16 v[80:83], a[12:15], a[128:131], 0
ds_read_b64_tr_b16 a[82:83], v16 offset:17472
v_mfma_f32_16x16x32_bf16 v[84:87], a[12:15], a[132:135], 0
buffer_load_dwordx4 a[172:175], v11, s[16:19], s52 offen offset:1024 sc1
v_mfma_f32_16x16x32_bf16 v[88:91], a[12:15], a[136:139], 0
ds_read_b64_tr_b16 a[84:85], v16 offset:16992
s_add_u32 s52, s52, 0x20000
v_mfma_f32_16x16x32_bf16 v[92:95], a[12:15], a[140:143], 0
ds_read_b64_tr_b16 a[86:87], v16 offset:17504
v_mfma_f32_16x16x32_bf16 v[96:99], a[16:19], a[128:131], 0
s_add_u32 m0, s55, 83200
v_mfma_f32_16x16x32_bf16 v[100:103], a[16:19], a[132:135], 0
buffer_load_dwordx4 v12, s[32:35], s54 offen lds
v_mfma_f32_16x16x32_bf16 v[24:27], v[20:23], a[196:199], v[24:27]
ds_read_b64_tr_b16 a[88:89], v16 offset:25408
v_mfma_f32_16x16x32_bf16 v[104:107], a[16:19], a[136:139], 0
ds_read_b64_tr_b16 a[90:91], v16 offset:25920
v_mfma_f32_16x16x32_bf16 v[108:111], a[16:19], a[140:143], 0
ds_read_b64_tr_b16 a[92:93], v16 offset:25440
v_mfma_f32_16x16x32_bf16 v[112:115], a[20:23], a[128:131], 0
ds_read_b64_tr_b16 a[94:95], v16 offset:25952
v_mfma_f32_16x16x32_bf16 v[116:119], a[20:23], a[132:135], 0
buffer_load_dwordx4 a[176:179], v10, s[16:19], s52 offen sc1
v_mfma_f32_16x16x32_bf16 v[120:123], a[20:23], a[136:139], 0
ds_read_b64_tr_b16 a[96:97], v16 offset:17024
v_mfma_f32_16x16x32_bf16 v[124:127], a[20:23], a[140:143], 0
ds_read_b64_tr_b16 a[98:99], v16 offset:17536
v_mfma_f32_16x16x32_bf16 v[128:131], a[24:27], a[128:131], 0
v_mfma_f32_16x16x32_bf16 v[132:135], a[24:27], a[132:135], 0
buffer_load_dwordx4 v13, s[32:35], s54 offen offset:1056 lds
v_mfma_f32_16x16x32_bf16 v[136:139], a[24:27], a[136:139], 0
ds_read_b64_tr_b16 a[100:101], v16 offset:17056
v_mfma_f32_16x16x32_bf16 v[140:143], a[24:27], a[140:143], 0
ds_read_b64_tr_b16 a[102:103], v16 offset:17568
v_mfma_f32_16x16x32_bf16 v[144:147], a[28:31], a[128:131], 0
ds_read_b64_tr_b16 a[104:105], v16 offset:25472
v_mfma_f32_16x16x32_bf16 v[148:151], a[28:31], a[132:135], 0
ds_read_b64_tr_b16 a[106:107], v16 offset:25984
v_mfma_f32_16x16x32_bf16 v[24:27], v[20:23], a[200:203], v[24:27]
buffer_load_dwordx4 a[180:183], v10, s[16:19], s52 offen offset:1024 sc1
v_mfma_f32_16x16x32_bf16 v[152:155], a[28:31], a[136:139], 0
ds_read_b64_tr_b16 a[108:109], v16 offset:25504
v_mfma_f32_16x16x32_bf16 v[156:159], a[28:31], a[140:143], 0
ds_read_b64_tr_b16 a[110:111], v16 offset:26016
v_mfma_f32_16x16x32_bf16 v[160:163], a[32:35], a[128:131], 0
v_mfma_f32_16x16x32_bf16 v[164:167], a[32:35], a[132:135], 0
buffer_load_dwordx4 v14, s[32:35], s54 offen offset:2112 lds
v_mfma_f32_16x16x32_bf16 v[168:171], a[32:35], a[136:139], 0
ds_read_b64_tr_b16 a[112:113], v17 offset:16896
v_mfma_f32_16x16x32_bf16 v[172:175], a[32:35], a[140:143], 0
ds_read_b64_tr_b16 a[114:115], v17 offset:17408
v_mfma_f32_16x16x32_bf16 v[176:179], a[36:39], a[128:131], 0
ds_read_b64_tr_b16 a[116:117], v17 offset:16928
v_mfma_f32_16x16x32_bf16 v[180:183], a[36:39], a[132:135], 0
ds_read_b64_tr_b16 a[118:119], v17 offset:17440
v_mfma_f32_16x16x32_bf16 v[184:187], a[36:39], a[136:139], 0
buffer_load_dwordx4 a[184:187], v11, s[16:19], s52 offen sc1
v_mfma_f32_16x16x32_bf16 v[188:191], a[36:39], a[140:143], 0
ds_read_b64_tr_b16 a[120:121], v17 offset:25344
v_mfma_f32_16x16x32_bf16 v[192:195], a[40:43], a[128:131], 0
ds_read_b64_tr_b16 a[122:123], v17 offset:25856
v_mfma_f32_16x16x32_bf16 v[196:199], a[40:43], a[132:135], 0
v_mfma_f32_16x16x32_bf16 v[24:27], v[20:23], a[204:207], v[24:27]
buffer_load_dwordx4 v15, s[32:35], s54 offen offset:3168 lds
v_mfma_f32_16x16x32_bf16 v[200:203], a[40:43], a[136:139], 0
ds_read_b64_tr_b16 a[124:125], v17 offset:25376
s_add_u32 s54, s54, 229376
v_mfma_f32_16x16x32_bf16 v[204:207], a[40:43], a[140:143], 0
ds_read_b64_tr_b16 a[126:127], v17 offset:25888
v_mfma_f32_16x16x32_bf16 v[208:211], a[44:47], a[128:131], 0
ds_read_b128 a[208:211], v9 offset:16896
v_mfma_f32_16x16x32_bf16 v[212:215], a[44:47], a[132:135], 0
ds_read_b128 a[212:215], v9 offset:17952
v_mfma_f32_16x16x32_bf16 v[216:219], a[44:47], a[136:139], 0
buffer_load_dwordx4 a[188:191], v11, s[16:19], s52 offen offset:1024 sc1
v_mfma_f32_16x16x32_bf16 v[220:223], a[44:47], a[140:143], 0
ds_read_b128 a[216:219], v9 offset:19008
s_add_u32 s52, s52, 0x20000
v_mfma_f32_16x16x32_bf16 v[224:227], a[48:51], a[128:131], 0
ds_read_b128 a[220:223], v9 offset:20064
v_mfma_f32_16x16x32_bf16 v[228:231], a[48:51], a[132:135], 0
v_mfma_f32_16x16x32_bf16 v[232:235], a[52:55], a[128:131], 0
buffer_load_dword v28, v8, s[32:35], s45 offen
v_mfma_f32_16x16x32_bf16 v[236:239], a[52:55], a[132:135], 0
buffer_load_dword v29, v7, s[28:31], s44 offen
s_add_u32 s44, s44, 1048576
s_add_u32 s45, s45, 917504
v_mfma_f32_16x16x32_bf16 v[240:243], a[56:59], a[128:131], 0
v_mfma_f32_16x16x32_bf16 v[244:247], a[56:59], a[132:135], 0
v_mfma_f32_16x16x32_bf16 v[248:251], a[60:63], a[128:131], 0
v_mfma_f32_16x16x32_bf16 v[252:255], a[60:63], a[132:135], 0
s_waitcnt lgkmcnt(0)
s_barrier
s_waitcnt vmcnt(17)
v_mfma_f32_16x16x32_bf16 v[32:35], a[64:67], a[144:147], v[32:35]
s_add_u32 m0, s74, 0
s_mov_b32 s67, 29622272
s_waitcnt vmcnt(16)
v_mfma_f32_16x16x32_bf16 v[36:39], a[64:67], a[148:151], v[36:39]
buffer_load_dwordx4 v4, s[16:19], s67 offen sc1 lds
s_waitcnt vmcnt(16)
v_mfma_f32_16x16x32_bf16 v[40:43], a[64:67], a[152:155], v[40:43]
ds_read_b64_tr_b16 a[0:1], v16 offset:33792
s_waitcnt vmcnt(15)
v_mfma_f32_16x16x32_bf16 v[44:47], a[64:67], a[156:159], v[44:47]
ds_read_b64_tr_b16 a[2:3], v16 offset:34304
v_mfma_f32_16x16x32_bf16 v[48:51], a[68:71], a[144:147], v[48:51]
buffer_load_dwordx4 v4, s[16:19], s67 offen offset:1024 sc1 lds
v_mfma_f32_16x16x32_bf16 v[52:55], a[68:71], a[148:151], v[52:55]
ds_read_b64_tr_b16 a[4:5], v16 offset:33824
v_mfma_f32_16x16x32_bf16 v[24:27], v[20:23], a[208:211], v[24:27]
ds_read_b64_tr_b16 a[6:7], v16 offset:34336
v_mfma_f32_16x16x32_bf16 v[56:59], a[68:71], a[152:155], v[56:59]
ds_read_b64_tr_b16 a[8:9], v16 offset:42240
v_mfma_f32_16x16x32_bf16 v[60:63], a[68:71], a[156:159], v[60:63]
buffer_load_dwordx4 v4, s[16:19], s67 offen offset:2048 sc1 lds
v_mfma_f32_16x16x32_bf16 v[64:67], a[72:75], a[144:147], v[64:67]
ds_read_b64_tr_b16 a[10:11], v16 offset:42752
v_mfma_f32_16x16x32_bf16 v[68:71], a[72:75], a[148:151], v[68:71]
ds_read_b64_tr_b16 a[12:13], v16 offset:42272
v_mfma_f32_16x16x32_bf16 v[72:75], a[72:75], a[152:155], v[72:75]
buffer_load_dwordx4 v4, s[16:19], s67 offen offset:3072 sc1 lds
v_mfma_f32_16x16x32_bf16 v[76:79], a[72:75], a[156:159], v[76:79]
ds_read_b64_tr_b16 a[14:15], v16 offset:42784
v_mfma_f32_16x16x32_bf16 v[80:83], a[76:79], a[144:147], v[80:83]
ds_read_b64_tr_b16 a[16:17], v16 offset:33856
v_mfma_f32_16x16x32_bf16 v[84:87], a[76:79], a[148:151], v[84:87]
s_add_u32 m0, s74, 4096
s_mov_b32 s67, 29626368
v_mfma_f32_16x16x32_bf16 v[88:91], a[76:79], a[152:155], v[88:91]
buffer_load_dwordx4 v4, s[16:19], s67 offen sc1 lds
v_mfma_f32_16x16x32_bf16 v[92:95], a[76:79], a[156:159], v[92:95]
ds_read_b64_tr_b16 a[18:19], v16 offset:34368
v_mfma_f32_16x16x32_bf16 v[96:99], a[80:83], a[144:147], v[96:99]
ds_read_b64_tr_b16 a[20:21], v16 offset:33888
v_mfma_f32_16x16x32_bf16 v[100:103], a[80:83], a[148:151], v[100:103]
ds_read_b64_tr_b16 a[22:23], v16 offset:34400
v_mfma_f32_16x16x32_bf16 v[24:27], v[20:23], a[212:215], v[24:27]
buffer_load_dwordx4 v4, s[16:19], s67 offen offset:1024 sc1 lds
v_mfma_f32_16x16x32_bf16 v[104:107], a[80:83], a[152:155], v[104:107]
ds_read_b64_tr_b16 a[24:25], v16 offset:42304
v_mfma_f32_16x16x32_bf16 v[108:111], a[80:83], a[156:159], v[108:111]
ds_read_b64_tr_b16 a[26:27], v16 offset:42816
v_mfma_f32_16x16x32_bf16 v[112:115], a[84:87], a[144:147], v[112:115]
buffer_load_dwordx4 v4, s[16:19], s67 offen offset:2048 sc1 lds
v_mfma_f32_16x16x32_bf16 v[116:119], a[84:87], a[148:151], v[116:119]
ds_read_b64_tr_b16 a[28:29], v16 offset:42336
v_mfma_f32_16x16x32_bf16 v[120:123], a[84:87], a[152:155], v[120:123]
ds_read_b64_tr_b16 a[30:31], v16 offset:42848
v_mfma_f32_16x16x32_bf16 v[124:127], a[84:87], a[156:159], v[124:127]
ds_read_b64_tr_b16 a[32:33], v16 offset:33920
v_mfma_f32_16x16x32_bf16 v[128:131], a[88:91], a[144:147], v[128:131]
buffer_load_dwordx4 v4, s[16:19], s67 offen offset:3072 sc1 lds
v_mfma_f32_16x16x32_bf16 v[132:135], a[88:91], a[148:151], v[132:135]
ds_read_b64_tr_b16 a[34:35], v16 offset:34432
v_mfma_f32_16x16x32_bf16 v[136:139], a[88:91], a[152:155], v[136:139]
v_mfma_f32_16x16x32_bf16 v[140:143], a[88:91], a[156:159], v[140:143]
ds_read_b64_tr_b16 a[36:37], v16 offset:33952
s_add_u32 m0, s55, 100096
v_mfma_f32_16x16x32_bf16 v[144:147], a[92:95], a[144:147], v[144:147]
buffer_load_dwordx4 v12, s[32:35], s54 offen lds
v_mfma_f32_16x16x32_bf16 v[148:151], a[92:95], a[148:151], v[148:151]
ds_read_b64_tr_b16 a[38:39], v16 offset:34464
v_mfma_f32_16x16x32_bf16 v[24:27], v[20:23], a[216:219], v[24:27]
ds_read_b64_tr_b16 a[40:41], v16 offset:42368
v_mfma_f32_16x16x32_bf16 v[152:155], a[92:95], a[152:155], v[152:155]
buffer_load_dwordx4 a[128:131], v10, s[16:19], s52 offen sc1
v_mfma_f32_16x16x32_bf16 v[156:159], a[92:95], a[156:159], v[156:159]
ds_read_b64_tr_b16 a[42:43], v16 offset:42880
v_mfma_f32_16x16x32_bf16 v[160:163], a[96:99], a[144:147], v[160:163]
ds_read_b64_tr_b16 a[44:45], v16 offset:42400
v_mfma_f32_16x16x32_bf16 v[164:167], a[96:99], a[148:151], v[164:167]
ds_read_b64_tr_b16 a[46:47], v16 offset:42912
v_mfma_f32_16x16x32_bf16 v[168:171], a[96:99], a[152:155], v[168:171]
buffer_load_dwordx4 v13, s[32:35], s54 offen offset:1056 lds
v_mfma_f32_16x16x32_bf16 v[172:175], a[96:99], a[156:159], v[172:175]
ds_read_b64_tr_b16 a[48:49], v17 offset:33792
v_mfma_f32_16x16x32_bf16 v[176:179], a[100:103], a[144:147], v[176:179]
ds_read_b64_tr_b16 a[50:51], v17 offset:34304
v_mfma_f32_16x16x32_bf16 v[180:183], a[100:103], a[148:151], v[180:183]
buffer_load_dwordx4 a[132:135], v10, s[16:19], s52 offen offset:1024 sc1
v_mfma_f32_16x16x32_bf16 v[184:187], a[100:103], a[152:155], v[184:187]
ds_read_b64_tr_b16 a[52:53], v17 offset:33824
v_mfma_f32_16x16x32_bf16 v[188:191], a[100:103], a[156:159], v[188:191]
ds_read_b64_tr_b16 a[54:55], v17 offset:34336
v_mfma_f32_16x16x32_bf16 v[192:195], a[104:107], a[144:147], v[192:195]
ds_read_b64_tr_b16 a[56:57], v17 offset:42240
v_mfma_f32_16x16x32_bf16 v[196:199], a[104:107], a[148:151], v[196:199]
buffer_load_dwordx4 v14, s[32:35], s54 offen offset:2112 lds
v_mfma_f32_16x16x32_bf16 v[24:27], v[20:23], a[220:223], v[24:27]
ds_read_b64_tr_b16 a[58:59], v17 offset:42752
v_mfma_f32_16x16x32_bf16 v[200:203], a[104:107], a[152:155], v[200:203]
ds_read_b64_tr_b16 a[60:61], v17 offset:42272
v_mfma_f32_16x16x32_bf16 v[204:207], a[104:107], a[156:159], v[204:207]
ds_read_b64_tr_b16 a[62:63], v17 offset:42784
v_mfma_f32_16x16x32_bf16 v[208:211], a[108:111], a[144:147], v[208:211]
buffer_load_dwordx4 a[136:139], v11, s[16:19], s52 offen sc1
v_mfma_f32_16x16x32_bf16 v[212:215], a[108:111], a[148:151], v[212:215]
ds_read_b128 a[192:195], v9 offset:33792
v_mfma_f32_16x16x32_bf16 v[216:219], a[108:111], a[152:155], v[216:219]
ds_read_b128 a[196:199], v9 offset:34848
v_mfma_f32_16x16x32_bf16 v[220:223], a[108:111], a[156:159], v[220:223]
buffer_load_dwordx4 v15, s[32:35], s54 offen offset:3168 lds
v_mfma_f32_16x16x32_bf16 v[224:227], a[112:115], a[144:147], v[224:227]
ds_read_b128 a[200:203], v9 offset:35904
s_add_u32 s54, s54, 229376
v_mfma_f32_16x16x32_bf16 v[228:231], a[112:115], a[148:151], v[228:231]
ds_read_b128 a[204:207], v9 offset:36960
v_mfma_f32_16x16x32_bf16 v[232:235], a[116:119], a[144:147], v[232:235]
v_mfma_f32_16x16x32_bf16 v[236:239], a[116:119], a[148:151], v[236:239]
buffer_load_dwordx4 a[140:143], v11, s[16:19], s52 offen offset:1024 sc1
v_mfma_f32_16x16x32_bf16 v[240:243], a[120:123], a[144:147], v[240:243]
s_add_u32 s52, s52, 0x20000
v_mfma_f32_16x16x32_bf16 v[244:247], a[120:123], a[148:151], v[244:247]
v_mfma_f32_16x16x32_bf16 v[248:251], a[124:127], a[144:147], v[248:251]
v_mfma_f32_16x16x32_bf16 v[252:255], a[124:127], a[148:151], v[252:255]
s_waitcnt lgkmcnt(0)
s_barrier
s_waitcnt vmcnt(29)
v_mfma_f32_16x16x32_bf16 v[32:35], a[0:3], a[160:163], v[32:35]
ds_read_b64_tr_b16 a[64:65], v16 offset:50688
s_add_u32 m0, s55, 116992
s_waitcnt vmcnt(28)
v_mfma_f32_16x16x32_bf16 v[36:39], a[0:3], a[164:167], v[36:39]
buffer_load_dwordx4 v12, s[32:35], s54 offen lds
s_waitcnt vmcnt(28)
v_mfma_f32_16x16x32_bf16 v[40:43], a[0:3], a[168:171], v[40:43]
ds_read_b64_tr_b16 a[66:67], v16 offset:51200
s_waitcnt vmcnt(27)
v_mfma_f32_16x16x32_bf16 v[44:47], a[0:3], a[172:175], v[44:47]
ds_read_b64_tr_b16 a[68:69], v16 offset:50720
v_mfma_f32_16x16x32_bf16 v[48:51], a[4:7], a[160:163], v[48:51]
ds_read_b64_tr_b16 a[70:71], v16 offset:51232
v_mfma_f32_16x16x32_bf16 v[52:55], a[4:7], a[164:167], v[52:55]
v_mfma_f32_16x16x32_bf16 v[24:27], v[20:23], a[192:195], v[24:27]
ds_read_b64_tr_b16 a[72:73], v16 offset:59136
v_mfma_f32_16x16x32_bf16 v[56:59], a[4:7], a[168:171], v[56:59]
ds_read_b64_tr_b16 a[74:75], v16 offset:59648
v_mfma_f32_16x16x32_bf16 v[60:63], a[4:7], a[172:175], v[60:63]
buffer_load_dwordx4 a[144:147], v10, s[16:19], s52 offen sc1
v_mfma_f32_16x16x32_bf16 v[64:67], a[8:11], a[160:163], v[64:67]
ds_read_b64_tr_b16 a[76:77], v16 offset:59168
v_mfma_f32_16x16x32_bf16 v[68:71], a[8:11], a[164:167], v[68:71]
v_mfma_f32_16x16x32_bf16 v[72:75], a[8:11], a[168:171], v[72:75]
ds_read_b64_tr_b16 a[78:79], v16 offset:59680
v_mfma_f32_16x16x32_bf16 v[76:79], a[8:11], a[172:175], v[76:79]
ds_read_b64_tr_b16 a[80:81], v16 offset:50752
v_lshrrev_b32 v2, 1, v2
v_mfma_f32_16x16x32_bf16 v[80:83], a[12:15], a[160:163], v[80:83]
ds_read_b64_tr_b16 a[82:83], v16 offset:51264
v_mfma_f32_16x16x32_bf16 v[84:87], a[12:15], a[164:167], v[84:87]
s_lshr_b32 s67, s74, 1
v_mfma_f32_16x16x32_bf16 v[88:91], a[12:15], a[168:171], v[88:91]
buffer_load_dwordx4 v13, s[32:35], s54 offen offset:1056 lds
v_mfma_f32_16x16x32_bf16 v[92:95], a[12:15], a[172:175], v[92:95]
ds_read_b64_tr_b16 a[84:85], v16 offset:50784
v_add_u32 v2, s67, v2
v_mfma_f32_16x16x32_bf16 v[96:99], a[16:19], a[160:163], v[96:99]
ds_read_b64_tr_b16 a[86:87], v16 offset:51296
v_mfma_f32_16x16x32_bf16 v[100:103], a[16:19], a[164:167], v[100:103]
ds_read_b64_tr_b16 a[88:89], v16 offset:59200
s_waitcnt vmcnt(11)
ds_read_b64 v[28:29], v2
v_mfma_f32_16x16x32_bf16 v[24:27], v[20:23], a[196:199], v[24:27]
ds_read_b64_tr_b16 a[90:91], v16 offset:59712
v_mfma_f32_16x16x32_bf16 v[104:107], a[16:19], a[168:171], v[104:107]
ds_read_b64 v[30:31], v2 offset:512
v_mfma_f32_16x16x32_bf16 v[108:111], a[16:19], a[172:175], v[108:111]
ds_read_b64_tr_b16 a[92:93], v16 offset:59232
v_mfma_f32_16x16x32_bf16 v[112:115], a[20:23], a[160:163], v[112:115]
buffer_load_dwordx4 a[148:151], v10, s[16:19], s52 offen offset:1024 sc1
.Lpad10:
s_cbranch_execz .Lpad13
v_mfma_f32_16x16x32_bf16 v[116:119], a[20:23], a[164:167], v[116:119]
ds_read_b64_tr_b16 a[94:95], v16 offset:59744
ds_read_b64 v[18:19], v2 offset:1024
v_mfma_f32_16x16x32_bf16 v[120:123], a[20:23], a[168:171], v[120:123]
ds_read_b64_tr_b16 a[96:97], v16 offset:50816
v_mfma_f32_16x16x32_bf16 v[124:127], a[20:23], a[172:175], v[124:127]
s_waitcnt lgkmcnt(4)
v_add_f32 v28, v28, v30
v_mfma_f32_16x16x32_bf16 v[128:131], a[24:27], a[160:163], v[128:131]
ds_read_b64_tr_b16 a[98:99], v16 offset:51328
v_add_f32 v29, v29, v31
v_mfma_f32_16x16x32_bf16 v[132:135], a[24:27], a[164:167], v[132:135]
ds_read_b64_tr_b16 a[100:101], v16 offset:50848
v_mfma_f32_16x16x32_bf16 v[136:139], a[24:27], a[168:171], v[136:139]
ds_read_b64_tr_b16 a[102:103], v16 offset:51360
ds_read_b64 v[30:31], v2 offset:1536
v_mfma_f32_16x16x32_bf16 v[140:143], a[24:27], a[172:175], v[140:143]
s_waitcnt lgkmcnt(5)
v_add_f32 v28, v28, v18
v_mfma_f32_16x16x32_bf16 v[144:147], a[28:31], a[160:163], v[144:147]
buffer_load_dwordx4 v14, s[32:35], s54 offen offset:2112 lds
v_mfma_f32_16x16x32_bf16 v[148:151], a[28:31], a[164:167], v[148:151]
ds_read_b64_tr_b16 a[104:105], v16 offset:59264
v_mfma_f32_16x16x32_bf16 v[24:27], v[20:23], a[200:203], v[24:27]
ds_read_b64_tr_b16 a[106:107], v16 offset:59776
v_mfma_f32_16x16x32_bf16 v[152:155], a[28:31], a[168:171], v[152:155]
ds_read_b64_tr_b16 a[108:109], v16 offset:59296
v_add_f32 v29, v29, v19
v_mfma_f32_16x16x32_bf16 v[156:159], a[28:31], a[172:175], v[156:159]
ds_read_b64 v[18:19], v2 offset:2048
v_mfma_f32_16x16x32_bf16 v[160:163], a[32:35], a[160:163], v[160:163]
ds_read_b64_tr_b16 a[110:111], v16 offset:59808
v_mfma_f32_16x16x32_bf16 v[164:167], a[32:35], a[164:167], v[164:167]
ds_read_b64_tr_b16 a[112:113], v17 offset:50688
s_waitcnt lgkmcnt(6)
v_add_f32 v28, v28, v30
v_mfma_f32_16x16x32_bf16 v[168:171], a[32:35], a[168:171], v[168:171]
buffer_load_dwordx4 a[152:155], v11, s[16:19], s52 offen sc1
v_mfma_f32_16x16x32_bf16 v[172:175], a[32:35], a[172:175], v[172:175]
ds_read_b64_tr_b16 a[114:115], v17 offset:51200
v_mfma_f32_16x16x32_bf16 v[176:179], a[36:39], a[160:163], v[176:179]
ds_read_b64_tr_b16 a[116:117], v17 offset:50720
v_add_f32 v29, v29, v31
v_mfma_f32_16x16x32_bf16 v[180:183], a[36:39], a[164:167], v[180:183]
ds_read_b64 v[30:31], v2 offset:2560
v_mfma_f32_16x16x32_bf16 v[184:187], a[36:39], a[168:171], v[184:187]
ds_read_b64_tr_b16 a[118:119], v17 offset:51232
v_mfma_f32_16x16x32_bf16 v[188:191], a[36:39], a[172:175], v[188:191]
ds_read_b64_tr_b16 a[120:121], v17 offset:59136
v_mfma_f32_16x16x32_bf16 v[192:195], a[40:43], a[160:163], v[192:195]
ds_read_b64_tr_b16 a[122:123], v17 offset:59648
s_waitcnt lgkmcnt(8)
v_add_f32 v28, v28, v18
v_mfma_f32_16x16x32_bf16 v[196:199], a[40:43], a[164:167], v[196:199]
buffer_load_dwordx4 v15, s[32:35], s54 offen offset:3168 lds
v_mfma_f32_16x16x32_bf16 v[24:27], v[20:23], a[204:207], v[24:27]
s_add_u32 s54, s54, 229376
v_add_f32 v29, v29, v19
v_mfma_f32_16x16x32_bf16 v[200:203], a[40:43], a[168:171], v[200:203]
ds_read_b64_tr_b16 a[124:125], v17 offset:59168
v_mfma_f32_16x16x32_bf16 v[204:207], a[40:43], a[172:175], v[204:207]
ds_read_b64_tr_b16 a[126:127], v17 offset:59680
ds_read_b64 v[18:19], v2 offset:3072
v_mfma_f32_16x16x32_bf16 v[208:211], a[44:47], a[160:163], v[208:211]
ds_read_b128 a[208:211], v9 offset:50688
v_mfma_f32_16x16x32_bf16 v[212:215], a[44:47], a[164:167], v[212:215]
s_waitcnt lgkmcnt(7)
v_add_f32 v28, v28, v30
v_mfma_f32_16x16x32_bf16 v[216:219], a[44:47], a[168:171], v[216:219]
ds_read_b128 a[212:215], v9 offset:51744
v_add_f32 v29, v29, v31
v_mfma_f32_16x16x32_bf16 v[220:223], a[44:47], a[172:175], v[220:223]
buffer_load_dwordx4 a[156:159], v11, s[16:19], s52 offen offset:1024 sc1
v_mfma_f32_16x16x32_bf16 v[224:227], a[48:51], a[160:163], v[224:227]
ds_read_b128 a[216:219], v9 offset:52800
s_add_u32 s52, s52, 0x20000
v_mfma_f32_16x16x32_bf16 v[228:231], a[48:51], a[164:167], v[228:231]
ds_read_b128 a[220:223], v9 offset:53856
v_mfma_f32_16x16x32_bf16 v[232:235], a[52:55], a[160:163], v[232:235]
ds_read_b64 v[30:31], v2 offset:3584
v_mfma_f32_16x16x32_bf16 v[236:239], a[52:55], a[164:167], v[236:239]
s_waitcnt lgkmcnt(5)
v_add_f32 v28, v28, v18
v_mfma_f32_16x16x32_bf16 v[240:243], a[56:59], a[160:163], v[240:243]
v_add_f32 v29, v29, v19
v_mfma_f32_16x16x32_bf16 v[244:247], a[56:59], a[164:167], v[244:247]
ds_read_b64 v[18:19], v2 offset:4096
v_mfma_f32_16x16x32_bf16 v[248:251], a[60:63], a[160:163], v[248:251]
v_mfma_f32_16x16x32_bf16 v[252:255], a[60:63], a[164:167], v[252:255]
s_waitcnt lgkmcnt(0)
s_barrier
v_mfma_f32_16x16x32_bf16 v[32:35], a[64:67], a[176:179], v[32:35]
ds_read_b64_tr_b16 a[0:1], v16
s_add_u32 m0, s55, 133888
v_mfma_f32_16x16x32_bf16 v[36:39], a[64:67], a[180:183], v[36:39]
buffer_load_dwordx4 v12, s[32:35], s54 offen lds
v_mfma_f32_16x16x32_bf16 v[40:43], a[64:67], a[184:187], v[40:43]
ds_read_b64_tr_b16 a[2:3], v16 offset:512
v_add_f32 v28, v28, v30
v_mfma_f32_16x16x32_bf16 v[44:47], a[64:67], a[188:191], v[44:47]
ds_read_b64_tr_b16 a[4:5], v16 offset:32
v_add_f32 v29, v29, v31
v_mfma_f32_16x16x32_bf16 v[48:51], a[68:71], a[176:179], v[48:51]
ds_read_b64_tr_b16 a[6:7], v16 offset:544
v_mfma_f32_16x16x32_bf16 v[52:55], a[68:71], a[180:183], v[52:55]
ds_read_b64 v[30:31], v2 offset:4608
v_mfma_f32_16x16x32_bf16 v[24:27], v[20:23], a[208:211], v[24:27]
ds_read_b64_tr_b16 a[8:9], v16 offset:8448
v_add_f32 v28, v28, v18
v_mfma_f32_16x16x32_bf16 v[56:59], a[68:71], a[184:187], v[56:59]
ds_read_b64_tr_b16 a[10:11], v16 offset:8960
v_mfma_f32_16x16x32_bf16 v[60:63], a[68:71], a[188:191], v[60:63]
buffer_load_dwordx4 a[160:163], v10, s[16:19], s52 offen sc1
v_mfma_f32_16x16x32_bf16 v[64:67], a[72:75], a[176:179], v[64:67]
ds_read_b64_tr_b16 a[12:13], v16 offset:8480
v_add_f32 v29, v29, v19
v_mfma_f32_16x16x32_bf16 v[68:71], a[72:75], a[180:183], v[68:71]
ds_read_b64 v[18:19], v2 offset:5120
v_mfma_f32_16x16x32_bf16 v[72:75], a[72:75], a[184:187], v[72:75]
ds_read_b64_tr_b16 a[14:15], v16 offset:8992
s_waitcnt lgkmcnt(5)
v_add_f32 v28, v28, v30
v_mfma_f32_16x16x32_bf16 v[76:79], a[72:75], a[188:191], v[76:79]
ds_read_b64_tr_b16 a[16:17], v16 offset:64
v_mfma_f32_16x16x32_bf16 v[80:83], a[76:79], a[176:179], v[80:83]
ds_read_b64_tr_b16 a[18:19], v16 offset:576
v_add_f32 v29, v29, v31
v_mfma_f32_16x16x32_bf16 v[84:87], a[76:79], a[180:183], v[84:87]
ds_read_b64 v[30:31], v2 offset:5632
v_mfma_f32_16x16x32_bf16 v[88:91], a[76:79], a[184:187], v[88:91]
buffer_load_dwordx4 v13, s[32:35], s54 offen offset:1056 lds
v_mfma_f32_16x16x32_bf16 v[92:95], a[76:79], a[188:191], v[92:95]
ds_read_b64_tr_b16 a[20:21], v16 offset:96
v_mfma_f32_16x16x32_bf16 v[96:99], a[80:83], a[176:179], v[96:99]
ds_read_b64_tr_b16 a[22:23], v16 offset:608
s_waitcnt lgkmcnt(6)
v_add_f32 v28, v28, v18
v_mfma_f32_16x16x32_bf16 v[100:103], a[80:83], a[180:183], v[100:103]
ds_read_b64_tr_b16 a[24:25], v16 offset:8512
v_mfma_f32_16x16x32_bf16 v[24:27], v[20:23], a[212:215], v[24:27]
ds_read_b64_tr_b16 a[26:27], v16 offset:9024
v_add_f32 v29, v29, v19
v_mfma_f32_16x16x32_bf16 v[104:107], a[80:83], a[184:187], v[104:107]
ds_read_b64 v[18:19], v2 offset:6144
v_mfma_f32_16x16x32_bf16 v[108:111], a[80:83], a[188:191], v[108:111]
ds_read_b64_tr_b16 a[28:29], v16 offset:8544
s_waitcnt lgkmcnt(6)
v_add_f32 v28, v28, v30
v_mfma_f32_16x16x32_bf16 v[112:115], a[84:87], a[176:179], v[112:115]
buffer_load_dwordx4 a[164:167], v10, s[16:19], s52 offen offset:1024 sc1
v_mfma_f32_16x16x32_bf16 v[116:119], a[84:87], a[180:183], v[116:119]
ds_read_b64_tr_b16 a[30:31], v16 offset:9056
v_mfma_f32_16x16x32_bf16 v[120:123], a[84:87], a[184:187], v[120:123]
ds_read_b64_tr_b16 a[32:33], v16 offset:128
v_add_f32 v29, v29, v31
v_mfma_f32_16x16x32_bf16 v[124:127], a[84:87], a[188:191], v[124:127]
ds_read_b64 v[30:31], v2 offset:6656
v_mfma_f32_16x16x32_bf16 v[128:131], a[88:91], a[176:179], v[128:131]
ds_read_b64_tr_b16 a[34:35], v16 offset:640
v_mfma_f32_16x16x32_bf16 v[132:135], a[88:91], a[180:183], v[132:135]
ds_read_b64_tr_b16 a[36:37], v16 offset:160
s_waitcnt lgkmcnt(6)
v_add_f32 v28, v28, v18
v_mfma_f32_16x16x32_bf16 v[136:139], a[88:91], a[184:187], v[136:139]
ds_read_b64_tr_b16 a[38:39], v16 offset:672
v_mfma_f32_16x16x32_bf16 v[140:143], a[88:91], a[188:191], v[140:143]
v_add_f32 v29, v29, v19
v_mfma_f32_16x16x32_bf16 v[144:147], a[92:95], a[176:179], v[144:147]
buffer_load_dwordx4 v14, s[32:35], s54 offen offset:2112 lds
v_mfma_f32_16x16x32_bf16 v[148:151], a[92:95], a[180:183], v[148:151]
ds_read_b64_tr_b16 a[40:41], v16 offset:8576
ds_read_b64 v[18:19], v2 offset:7168
v_mfma_f32_16x16x32_bf16 v[24:27], v[20:23], a[216:219], v[24:27]
ds_read_b64_tr_b16 a[42:43], v16 offset:9088
s_waitcnt lgkmcnt(6)
v_add_f32 v28, v28, v30
v_mfma_f32_16x16x32_bf16 v[152:155], a[92:95], a[184:187], v[152:155]
ds_read_b64_tr_b16 a[44:45], v16 offset:8608
v_mfma_f32_16x16x32_bf16 v[156:159], a[92:95], a[188:191], v[156:159]
v_add_f32 v29, v29, v31
v_mfma_f32_16x16x32_bf16 v[160:163], a[96:99], a[176:179], v[160:163]
ds_read_b64_tr_b16 a[46:47], v16 offset:9120
ds_read_b64 v[30:31], v2 offset:7680
v_mfma_f32_16x16x32_bf16 v[164:167], a[96:99], a[180:183], v[164:167]
ds_read_b64_tr_b16 a[48:49], v17
v_mfma_f32_16x16x32_bf16 v[168:171], a[96:99], a[184:187], v[168:171]
buffer_load_dwordx4 a[168:171], v11, s[16:19], s52 offen sc1
v_mfma_f32_16x16x32_bf16 v[172:175], a[96:99], a[188:191], v[172:175]
ds_read_b64_tr_b16 a[50:51], v17 offset:512
s_waitcnt lgkmcnt(6)
v_add_f32 v28, v28, v18
v_mfma_f32_16x16x32_bf16 v[176:179], a[100:103], a[176:179], v[176:179]
ds_read_b64_tr_b16 a[52:53], v17 offset:32
v_mfma_f32_16x16x32_bf16 v[180:183], a[100:103], a[180:183], v[180:183]
v_add_f32 v29, v29, v19
v_mfma_f32_16x16x32_bf16 v[184:187], a[100:103], a[184:187], v[184:187]
ds_read_b64_tr_b16 a[54:55], v17 offset:544
s_waitcnt lgkmcnt(4)
v_add_f32 v28, v28, v30
v_mfma_f32_16x16x32_bf16 v[188:191], a[100:103], a[188:191], v[188:191]
ds_read_b64_tr_b16 a[56:57], v17 offset:8448
v_add_f32 v29, v29, v31
v_mfma_f32_16x16x32_bf16 v[192:195], a[104:107], a[176:179], v[192:195]
ds_read_b64_tr_b16 a[58:59], v17 offset:8960
v_mfma_f32_16x16x32_bf16 v[196:199], a[104:107], a[180:183], v[196:199]
buffer_load_dwordx4 v15, s[32:35], s54 offen offset:3168 lds
v_mfma_f32_16x16x32_bf16 v[24:27], v[20:23], a[220:223], v[24:27]
s_add_u32 s54, s54, 229376
v_mul_f32 v28, 0xba800000, v28
v_mfma_f32_16x16x32_bf16 v[200:203], a[104:107], a[184:187], v[200:203]
ds_read_b64_tr_b16 a[60:61], v17 offset:8480
v_mul_f32 v29, 0x3a800000, v29
v_mfma_f32_16x16x32_bf16 v[204:207], a[104:107], a[188:191], v[204:207]
ds_read_b64_tr_b16 a[62:63], v17 offset:8992
v_mfma_f32_16x16x32_bf16 v[208:211], a[108:111], a[176:179], v[208:211]
ds_read_b128 a[192:195], v9
v_fma_f32 v29, -v28, v28, v29
v_mfma_f32_16x16x32_bf16 v[212:215], a[108:111], a[180:183], v[212:215]
v_max_f32 v29, 0, v29
v_mfma_f32_16x16x32_bf16 v[216:219], a[108:111], a[184:187], v[216:219]
ds_read_b128 a[196:199], v9 offset:1056
v_mfma_f32_16x16x32_bf16 v[220:223], a[108:111], a[188:191], v[220:223]
buffer_load_dwordx4 a[172:175], v11, s[16:19], s52 offen offset:1024 sc1
v_mfma_f32_16x16x32_bf16 v[224:227], a[112:115], a[176:179], v[224:227]
ds_read_b128 a[200:203], v9 offset:2112
s_add_u32 s52, s52, 0x20000
v_mfma_f32_16x16x32_bf16 v[228:231], a[112:115], a[180:183], v[228:231]
ds_read_b128 a[204:207], v9 offset:3168
v_add_f32 v29, 0x3727c5ac, v29
v_mfma_f32_16x16x32_bf16 v[232:235], a[116:119], a[176:179], v[232:235]
v_rsq_f32 v30, v29
v_mfma_f32_16x16x32_bf16 v[236:239], a[116:119], a[180:183], v[236:239]
v_lshlrev_b32 v18, 4, v0
v_mfma_f32_16x16x32_bf16 v[240:243], a[120:123], a[176:179], v[240:243]
v_add_u32 v18, 151552, v18
v_mfma_f32_16x16x32_bf16 v[244:247], a[120:123], a[180:183], v[244:247]
v_mul_f32 v30, 0xbfb8aa3b, v30
v_mfma_f32_16x16x32_bf16 v[248:251], a[124:127], a[176:179], v[248:251]
ds_write_b128 v18, v[28:31]
v_mfma_f32_16x16x32_bf16 v[252:255], a[124:127], a[180:183], v[252:255]
s_mov_b32 s58, 0
s_mov_b32 s67, s59
s_add_u32 s74, s59, 74880
s_mov_b32 s15, 6
.p2align 6
.Lk21:
s_waitcnt vmcnt(17) lgkmcnt(0)
s_barrier
v_mfma_f32_16x16x32_bf16 v[32:35], a[0:3], a[128:131], v[32:35]
ds_read_b64_tr_b16 a[64:65], v16 offset:16896
s_add_u32 m0, s55, 83200
v_mfma_f32_16x16x32_bf16 v[36:39], a[0:3], a[132:135], v[36:39]
buffer_load_dwordx4 v12, s[32:35], s54 offen lds
v_mfma_f32_16x16x32_bf16 v[40:43], a[0:3], a[136:139], v[40:43]
ds_read_b64_tr_b16 a[66:67], v16 offset:17408
s_waitcnt vmcnt(17)
v_mfma_f32_16x16x32_bf16 v[44:47], a[0:3], a[140:143], v[44:47]
ds_read_b64_tr_b16 a[68:69], v16 offset:16928
v_mfma_f32_16x16x32_bf16 v[48:51], a[4:7], a[128:131], v[48:51]
ds_read_b64_tr_b16 a[70:71], v16 offset:17440
v_mfma_f32_16x16x32_bf16 v[52:55], a[4:7], a[132:135], v[52:55]
ds_read_b64_tr_b16 a[72:73], v16 offset:25344
v_mfma_f32_16x16x32_bf16 v[24:27], v[20:23], a[192:195], v[24:27]
buffer_load_dwordx4 a[176:179], v10, s[16:19], s52 offen sc1
v_mfma_f32_16x16x32_bf16 v[56:59], a[4:7], a[136:139], v[56:59]
v_mfma_f32_16x16x32_bf16 v[60:63], a[4:7], a[140:143], v[60:63]
ds_read_b64_tr_b16 a[74:75], v16 offset:25856
v_mfma_f32_16x16x32_bf16 v[64:67], a[8:11], a[128:131], v[64:67]
ds_read_b64_tr_b16 a[76:77], v16 offset:25376
v_mfma_f32_16x16x32_bf16 v[68:71], a[8:11], a[132:135], v[68:71]
ds_read_b64_tr_b16 a[78:79], v16 offset:25888
v_mfma_f32_16x16x32_bf16 v[72:75], a[8:11], a[136:139], v[72:75]
ds_read_b64_tr_b16 a[80:81], v16 offset:16960
v_mfma_f32_16x16x32_bf16 v[76:79], a[8:11], a[140:143], v[76:79]
buffer_load_dwordx4 v13, s[32:35], s54 offen offset:1056 lds
v_mfma_f32_16x16x32_bf16 v[80:83], a[12:15], a[128:131], v[80:83]
v_mfma_f32_16x16x32_bf16 v[84:87], a[12:15], a[132:135], v[84:87]
ds_read_b64_tr_b16 a[82:83], v16 offset:17472
v_mfma_f32_16x16x32_bf16 v[88:91], a[12:15], a[136:139], v[88:91]
ds_read_b64_tr_b16 a[84:85], v16 offset:16992
v_mfma_f32_16x16x32_bf16 v[92:95], a[12:15], a[140:143], v[92:95]
ds_read_b64_tr_b16 a[86:87], v16 offset:17504
v_mfma_f32_16x16x32_bf16 v[96:99], a[16:19], a[128:131], v[96:99]
ds_read_b64_tr_b16 a[88:89], v16 offset:25408
v_mfma_f32_16x16x32_bf16 v[100:103], a[16:19], a[132:135], v[100:103]
buffer_load_dwordx4 a[180:183], v10, s[16:19], s52 offen offset:1024 sc1
v_mfma_f32_16x16x32_bf16 v[24:27], v[20:23], a[196:199], v[24:27]
ds_read_b64_tr_b16 a[90:91], v16 offset:25920
v_mfma_f32_16x16x32_bf16 v[104:107], a[16:19], a[136:139], v[104:107]
v_mfma_f32_16x16x32_bf16 v[108:111], a[16:19], a[140:143], v[108:111]
ds_read_b64_tr_b16 a[92:93], v16 offset:25440
v_mfma_f32_16x16x32_bf16 v[112:115], a[20:23], a[128:131], v[112:115]
ds_read_b64_tr_b16 a[94:95], v16 offset:25952
v_mfma_f32_16x16x32_bf16 v[116:119], a[20:23], a[132:135], v[116:119]
ds_read_b64_tr_b16 a[96:97], v16 offset:17024
v_mfma_f32_16x16x32_bf16 v[120:123], a[20:23], a[136:139], v[120:123]
buffer_load_dwordx4 v14, s[32:35], s54 offen offset:2112 lds
v_mfma_f32_16x16x32_bf16 v[124:127], a[20:23], a[140:143], v[124:127]
ds_read_b64_tr_b16 a[98:99], v16 offset:17536
v_mfma_f32_16x16x32_bf16 v[128:131], a[24:27], a[128:131], v[128:131]
v_mfma_f32_16x16x32_bf16 v[132:135], a[24:27], a[132:135], v[132:135]
ds_read_b64_tr_b16 a[100:101], v16 offset:17056
v_mfma_f32_16x16x32_bf16 v[136:139], a[24:27], a[136:139], v[136:139]
ds_read_b64_tr_b16 a[102:103], v16 offset:17568
v_mfma_f32_16x16x32_bf16 v[140:143], a[24:27], a[140:143], v[140:143]
ds_read_b64_tr_b16 a[104:105], v16 offset:25472
v_mfma_f32_16x16x32_bf16 v[144:147], a[28:31], a[128:131], v[144:147]
buffer_load_dwordx4 a[184:187], v11, s[16:19], s52 offen sc1
v_mfma_f32_16x16x32_bf16 v[148:151], a[28:31], a[132:135], v[148:151]
ds_read_b64_tr_b16 a[106:107], v16 offset:25984
v_mfma_f32_16x16x32_bf16 v[24:27], v[20:23], a[200:203], v[24:27]
ds_read_b64_tr_b16 a[108:109], v16 offset:25504
v_mfma_f32_16x16x32_bf16 v[152:155], a[28:31], a[136:139], v[152:155]
v_mfma_f32_16x16x32_bf16 v[156:159], a[28:31], a[140:143], v[156:159]
ds_read_b64_tr_b16 a[110:111], v16 offset:26016
v_mfma_f32_16x16x32_bf16 v[160:163], a[32:35], a[128:131], v[160:163]
buffer_load_dwordx4 v15, s[32:35], s54 offen offset:3168 lds
v_mfma_f32_16x16x32_bf16 v[164:167], a[32:35], a[132:135], v[164:167]
ds_read_b64_tr_b16 a[112:113], v17 offset:16896
s_add_u32 s54, s54, 229376
v_mfma_f32_16x16x32_bf16 v[168:171], a[32:35], a[136:139], v[168:171]
ds_read_b64_tr_b16 a[114:115], v17 offset:17408
v_mfma_f32_16x16x32_bf16 v[172:175], a[32:35], a[140:143], v[172:175]
ds_read_b64_tr_b16 a[116:117], v17 offset:16928
v_mfma_f32_16x16x32_bf16 v[176:179], a[36:39], a[128:131], v[176:179]
v_mfma_f32_16x16x32_bf16 v[180:183], a[36:39], a[132:135], v[180:183]
ds_read_b64_tr_b16 a[118:119], v17 offset:17440
v_mfma_f32_16x16x32_bf16 v[184:187], a[36:39], a[136:139], v[184:187]
buffer_load_dwordx4 a[188:191], v11, s[16:19], s52 offen offset:1024 sc1
v_mfma_f32_16x16x32_bf16 v[188:191], a[36:39], a[140:143], v[188:191]
ds_read_b64_tr_b16 a[120:121], v17 offset:25344
s_add_u32 s52, s52, 0x20000
v_mfma_f32_16x16x32_bf16 v[192:195], a[40:43], a[128:131], v[192:195]
ds_read_b64_tr_b16 a[122:123], v17 offset:25856
v_mfma_f32_16x16x32_bf16 v[196:199], a[40:43], a[132:135], v[196:199]
ds_read_b64_tr_b16 a[124:125], v17 offset:25376
v_mfma_f32_16x16x32_bf16 v[24:27], v[20:23], a[204:207], v[24:27]
ds_read_b64_tr_b16 a[126:127], v17 offset:25888
v_mfma_f32_16x16x32_bf16 v[200:203], a[40:43], a[136:139], v[200:203]
s_mov_b32 m0, s67
v_mfma_f32_16x16x32_bf16 v[204:207], a[40:43], a[140:143], v[204:207]
buffer_load_dwordx4 v5, s[28:31], s58 offen lds
v_mfma_f32_16x16x32_bf16 v[208:211], a[44:47], a[128:131], v[208:211]
ds_read_b128 a[208:211], v9 offset:16896
v_mfma_f32_16x16x32_bf16 v[212:215], a[44:47], a[132:135], v[212:215]
ds_read_b128 a[212:215], v9 offset:17952
v_mfma_f32_16x16x32_bf16 v[216:219], a[44:47], a[136:139], v[216:219]
ds_read_b128 a[216:219], v9 offset:19008
v_mfma_f32_16x16x32_bf16 v[220:223], a[44:47], a[140:143], v[220:223]
ds_read_b128 a[220:223], v9 offset:20064
v_mfma_f32_16x16x32_bf16 v[224:227], a[48:51], a[128:131], v[224:227]
v_mfma_f32_16x16x32_bf16 v[228:231], a[48:51], a[132:135], v[228:231]
buffer_load_dword v28, v8, s[32:35], s45 offen
v_mfma_f32_16x16x32_bf16 v[232:235], a[52:55], a[128:131], v[232:235]
buffer_load_dword v29, v7, s[28:31], s44 offen
s_add_u32 s44, s44, 1048576
s_add_u32 s45, s45, 917504
v_mfma_f32_16x16x32_bf16 v[236:239], a[52:55], a[132:135], v[236:239]
v_mfma_f32_16x16x32_bf16 v[240:243], a[56:59], a[128:131], v[240:243]
v_mfma_f32_16x16x32_bf16 v[244:247], a[56:59], a[132:135], v[244:247]
v_mfma_f32_16x16x32_bf16 v[248:251], a[60:63], a[128:131], v[248:251]
v_mfma_f32_16x16x32_bf16 v[252:255], a[60:63], a[132:135], v[252:255]
s_waitcnt vmcnt(20) lgkmcnt(0)
s_barrier
v_mfma_f32_16x16x32_bf16 v[32:35], a[64:67], a[144:147], v[32:35]
ds_read_b64_tr_b16 a[0:1], v16 offset:33792
s_add_u32 m0, s55, 100096
v_mfma_f32_16x16x32_bf16 v[36:39], a[64:67], a[148:151], v[36:39]
buffer_load_dwordx4 v12, s[32:35], s54 offen lds
v_mfma_f32_16x16x32_bf16 v[40:43], a[64:67], a[152:155], v[40:43]
ds_read_b64_tr_b16 a[2:3], v16 offset:34304
s_waitcnt vmcnt(20)
v_mfma_f32_16x16x32_bf16 v[44:47], a[64:67], a[156:159], v[44:47]
ds_read_b64_tr_b16 a[4:5], v16 offset:33824
v_mfma_f32_16x16x32_bf16 v[48:51], a[68:71], a[144:147], v[48:51]
ds_read_b64_tr_b16 a[6:7], v16 offset:34336
v_mfma_f32_16x16x32_bf16 v[52:55], a[68:71], a[148:151], v[52:55]
v_mfma_f32_16x16x32_bf16 v[24:27], v[20:23], a[208:211], v[24:27]
ds_read_b64_tr_b16 a[8:9], v16 offset:42240
v_mfma_f32_16x16x32_bf16 v[56:59], a[68:71], a[152:155], v[56:59]
buffer_load_dwordx4 a[128:131], v10, s[16:19], s52 offen sc1
v_mfma_f32_16x16x32_bf16 v[60:63], a[68:71], a[156:159], v[60:63]
ds_read_b64_tr_b16 a[10:11], v16 offset:42752
v_mfma_f32_16x16x32_bf16 v[64:67], a[72:75], a[144:147], v[64:67]
ds_read_b64_tr_b16 a[12:13], v16 offset:42272
v_mfma_f32_16x16x32_bf16 v[68:71], a[72:75], a[148:151], v[68:71]
ds_read_b64_tr_b16 a[14:15], v16 offset:42784
v_mfma_f32_16x16x32_bf16 v[72:75], a[72:75], a[152:155], v[72:75]
v_mfma_f32_16x16x32_bf16 v[76:79], a[72:75], a[156:159], v[76:79]
ds_read_b64_tr_b16 a[16:17], v16 offset:33856
v_mfma_f32_16x16x32_bf16 v[80:83], a[76:79], a[144:147], v[80:83]
buffer_load_dwordx4 v13, s[32:35], s54 offen offset:1056 lds
v_mfma_f32_16x16x32_bf16 v[84:87], a[76:79], a[148:151], v[84:87]
ds_read_b64_tr_b16 a[18:19], v16 offset:34368
v_mfma_f32_16x16x32_bf16 v[88:91], a[76:79], a[152:155], v[88:91]
ds_read_b64_tr_b16 a[20:21], v16 offset:33888
v_mfma_f32_16x16x32_bf16 v[92:95], a[76:79], a[156:159], v[92:95]
ds_read_b64_tr_b16 a[22:23], v16 offset:34400
v_mfma_f32_16x16x32_bf16 v[96:99], a[80:83], a[144:147], v[96:99]
v_mfma_f32_16x16x32_bf16 v[100:103], a[80:83], a[148:151], v[100:103]
ds_read_b64_tr_b16 a[24:25], v16 offset:42304
v_mfma_f32_16x16x32_bf16 v[24:27], v[20:23], a[212:215], v[24:27]
ds_read_b64_tr_b16 a[26:27], v16 offset:42816
v_mfma_f32_16x16x32_bf16 v[104:107], a[80:83], a[152:155], v[104:107]
buffer_load_dwordx4 a[132:135], v10, s[16:19], s52 offen offset:1024 sc1
v_mfma_f32_16x16x32_bf16 v[108:111], a[80:83], a[156:159], v[108:111]
ds_read_b64_tr_b16 a[28:29], v16 offset:42336
v_mfma_f32_16x16x32_bf16 v[112:115], a[84:87], a[144:147], v[112:115]
ds_read_b64_tr_b16 a[30:31], v16 offset:42848
v_mfma_f32_16x16x32_bf16 v[116:119], a[84:87], a[148:151], v[116:119]
v_mfma_f32_16x16x32_bf16 v[120:123], a[84:87], a[152:155], v[120:123]
ds_read_b64_tr_b16 a[32:33], v16 offset:33920
v_mfma_f32_16x16x32_bf16 v[124:127], a[84:87], a[156:159], v[124:127]
ds_read_b64_tr_b16 a[34:35], v16 offset:34432
v_mfma_f32_16x16x32_bf16 v[128:131], a[88:91], a[144:147], v[128:131]
buffer_load_dwordx4 v14, s[32:35], s54 offen offset:2112 lds
v_mfma_f32_16x16x32_bf16 v[132:135], a[88:91], a[148:151], v[132:135]
ds_read_b64_tr_b16 a[36:37], v16 offset:33952
v_mfma_f32_16x16x32_bf16 v[136:139], a[88:91], a[152:155], v[136:139]
ds_read_b64_tr_b16 a[38:39], v16 offset:34464
v_mfma_f32_16x16x32_bf16 v[140:143], a[88:91], a[156:159], v[140:143]
v_mfma_f32_16x16x32_bf16 v[144:147], a[92:95], a[144:147], v[144:147]
ds_read_b64_tr_b16 a[40:41], v16 offset:42368
v_mfma_f32_16x16x32_bf16 v[148:151], a[92:95], a[148:151], v[148:151]
ds_read_b64_tr_b16 a[42:43], v16 offset:42880
v_mfma_f32_16x16x32_bf16 v[24:27], v[20:23], a[216:219], v[24:27]
ds_read_b64_tr_b16 a[44:45], v16 offset:42400
v_mfma_f32_16x16x32_bf16 v[152:155], a[92:95], a[152:155], v[152:155]
buffer_load_dwordx4 a[136:139], v11, s[16:19], s52 offen sc1
v_mfma_f32_16x16x32_bf16 v[156:159], a[92:95], a[156:159], v[156:159]
ds_read_b64_tr_b16 a[46:47], v16 offset:42912
v_mfma_f32_16x16x32_bf16 v[160:163], a[96:99], a[144:147], v[160:163]
v_mfma_f32_16x16x32_bf16 v[164:167], a[96:99], a[148:151], v[164:167]
ds_read_b64_tr_b16 a[48:49], v17 offset:33792
v_mfma_f32_16x16x32_bf16 v[168:171], a[96:99], a[152:155], v[168:171]
ds_read_b64_tr_b16 a[50:51], v17 offset:34304
v_mfma_f32_16x16x32_bf16 v[172:175], a[96:99], a[156:159], v[172:175]
ds_read_b64_tr_b16 a[52:53], v17 offset:33824
v_mfma_f32_16x16x32_bf16 v[176:179], a[100:103], a[144:147], v[176:179]
buffer_load_dwordx4 v15, s[32:35], s54 offen offset:3168 lds
v_mfma_f32_16x16x32_bf16 v[180:183], a[100:103], a[148:151], v[180:183]
ds_read_b64_tr_b16 a[54:55], v17 offset:34336
s_add_u32 s54, s54, 229376
v_mfma_f32_16x16x32_bf16 v[184:187], a[100:103], a[152:155], v[184:187]
v_mfma_f32_16x16x32_bf16 v[188:191], a[100:103], a[156:159], v[188:191]
ds_read_b64_tr_b16 a[56:57], v17 offset:42240
v_mfma_f32_16x16x32_bf16 v[192:195], a[104:107], a[144:147], v[192:195]
ds_read_b64_tr_b16 a[58:59], v17 offset:42752
v_mfma_f32_16x16x32_bf16 v[196:199], a[104:107], a[148:151], v[196:199]
ds_read_b64_tr_b16 a[60:61], v17 offset:42272
v_mfma_f32_16x16x32_bf16 v[24:27], v[20:23], a[220:223], v[24:27]
ds_read_b64_tr_b16 a[62:63], v17 offset:42784
v_mfma_f32_16x16x32_bf16 v[200:203], a[104:107], a[152:155], v[200:203]
buffer_load_dwordx4 a[140:143], v11, s[16:19], s52 offen offset:1024 sc1
v_mfma_f32_16x16x32_bf16 v[204:207], a[104:107], a[156:159], v[204:207]
s_add_u32 s52, s52, 0x20000
v_mfma_f32_16x16x32_bf16 v[208:211], a[108:111], a[144:147], v[208:211]
ds_read_b128 a[192:195], v9 offset:33792
v_mfma_f32_16x16x32_bf16 v[212:215], a[108:111], a[148:151], v[212:215]
ds_read_b128 a[196:199], v9 offset:34848
v_mfma_f32_16x16x32_bf16 v[216:219], a[108:111], a[152:155], v[216:219]
ds_read_b128 a[200:203], v9 offset:35904
v_mfma_f32_16x16x32_bf16 v[220:223], a[108:111], a[156:159], v[220:223]
ds_read_b128 a[204:207], v9 offset:36960
s_mov_b32 m0, s67
v_mfma_f32_16x16x32_bf16 v[224:227], a[112:115], a[144:147], v[224:227]
buffer_load_dwordx4 v6, s[28:31], s58 offen offset:1024 lds
v_mfma_f32_16x16x32_bf16 v[228:231], a[112:115], a[148:151], v[228:231]
s_add_u32 s67, s67, 8320
s_min_u32 s67, s67, s74
s_add_u32 s58, s58, 0x20000
s_min_u32 s58, s58, 1179648
v_mfma_f32_16x16x32_bf16 v[232:235], a[116:119], a[144:147], v[232:235]
v_mfma_f32_16x16x32_bf16 v[236:239], a[116:119], a[148:151], v[236:239]
v_mfma_f32_16x16x32_bf16 v[240:243], a[120:123], a[144:147], v[240:243]
v_mfma_f32_16x16x32_bf16 v[244:247], a[120:123], a[148:151], v[244:247]
v_mfma_f32_16x16x32_bf16 v[248:251], a[124:127], a[144:147], v[248:251]
v_mfma_f32_16x16x32_bf16 v[252:255], a[124:127], a[148:151], v[252:255]
s_waitcnt vmcnt(21) lgkmcnt(0)
s_barrier
v_mfma_f32_16x16x32_bf16 v[32:35], a[0:3], a[160:163], v[32:35]
ds_read_b64_tr_b16 a[64:65], v16 offset:50688
s_add_u32 m0, s55, 116992
v_mfma_f32_16x16x32_bf16 v[36:39], a[0:3], a[164:167], v[36:39]
buffer_load_dwordx4 v12, s[32:35], s54 offen lds
v_mfma_f32_16x16x32_bf16 v[40:43], a[0:3], a[168:171], v[40:43]
ds_read_b64_tr_b16 a[66:67], v16 offset:51200
s_waitcnt vmcnt(21)
v_mfma_f32_16x16x32_bf16 v[44:47], a[0:3], a[172:175], v[44:47]
ds_read_b64_tr_b16 a[68:69], v16 offset:50720
v_mfma_f32_16x16x32_bf16 v[48:51], a[4:7], a[160:163], v[48:51]
ds_read_b64_tr_b16 a[70:71], v16 offset:51232
v_mfma_f32_16x16x32_bf16 v[52:55], a[4:7], a[164:167], v[52:55]
v_mfma_f32_16x16x32_bf16 v[24:27], v[20:23], a[192:195], v[24:27]
ds_read_b64_tr_b16 a[72:73], v16 offset:59136
v_mfma_f32_16x16x32_bf16 v[56:59], a[4:7], a[168:171], v[56:59]
buffer_load_dwordx4 a[144:147], v10, s[16:19], s52 offen sc1
v_mfma_f32_16x16x32_bf16 v[60:63], a[4:7], a[172:175], v[60:63]
ds_read_b64_tr_b16 a[74:75], v16 offset:59648
v_mfma_f32_16x16x32_bf16 v[64:67], a[8:11], a[160:163], v[64:67]
ds_read_b64_tr_b16 a[76:77], v16 offset:59168
v_mfma_f32_16x16x32_bf16 v[68:71], a[8:11], a[164:167], v[68:71]
ds_read_b64_tr_b16 a[78:79], v16 offset:59680
v_mfma_f32_16x16x32_bf16 v[72:75], a[8:11], a[168:171], v[72:75]
v_mfma_f32_16x16x32_bf16 v[76:79], a[8:11], a[172:175], v[76:79]
ds_read_b64_tr_b16 a[80:81], v16 offset:50752
v_mfma_f32_16x16x32_bf16 v[80:83], a[12:15], a[160:163], v[80:83]
buffer_load_dwordx4 v13, s[32:35], s54 offen offset:1056 lds
v_mfma_f32_16x16x32_bf16 v[84:87], a[12:15], a[164:167], v[84:87]
ds_read_b64_tr_b16 a[82:83], v16 offset:51264
v_mfma_f32_16x16x32_bf16 v[88:91], a[12:15], a[168:171], v[88:91]
ds_read_b64_tr_b16 a[84:85], v16 offset:50784
v_mfma_f32_16x16x32_bf16 v[92:95], a[12:15], a[172:175], v[92:95]
v_mfma_f32_16x16x32_bf16 v[96:99], a[16:19], a[160:163], v[96:99]
ds_read_b64_tr_b16 a[86:87], v16 offset:51296
v_mfma_f32_16x16x32_bf16 v[100:103], a[16:19], a[164:167], v[100:103]
ds_read_b64_tr_b16 a[88:89], v16 offset:59200
v_mfma_f32_16x16x32_bf16 v[24:27], v[20:23], a[196:199], v[24:27]
ds_read_b64_tr_b16 a[90:91], v16 offset:59712
v_mfma_f32_16x16x32_bf16 v[104:107], a[16:19], a[168:171], v[104:107]
buffer_load_dwordx4 a[148:151], v10, s[16:19], s52 offen offset:1024 sc1
v_mfma_f32_16x16x32_bf16 v[108:111], a[16:19], a[172:175], v[108:111]
ds_read_b64_tr_b16 a[92:93], v16 offset:59232
v_mfma_f32_16x16x32_bf16 v[112:115], a[20:23], a[160:163], v[112:115]
v_mfma_f32_16x16x32_bf16 v[116:119], a[20:23], a[164:167], v[116:119]
ds_read_b64_tr_b16 a[94:95], v16 offset:59744
v_mfma_f32_16x16x32_bf16 v[120:123], a[20:23], a[168:171], v[120:123]
ds_read_b64_tr_b16 a[96:97], v16 offset:50816
v_mfma_f32_16x16x32_bf16 v[124:127], a[20:23], a[172:175], v[124:127]
ds_read_b64_tr_b16 a[98:99], v16 offset:51328
v_mfma_f32_16x16x32_bf16 v[128:131], a[24:27], a[160:163], v[128:131]
buffer_load_dwordx4 v14, s[32:35], s54 offen offset:2112 lds
v_mfma_f32_16x16x32_bf16 v[132:135], a[24:27], a[164:167], v[132:135]
v_mfma_f32_16x16x32_bf16 v[136:139], a[24:27], a[168:171], v[136:139]
ds_read_b64_tr_b16 a[100:101], v16 offset:50848
v_mfma_f32_16x16x32_bf16 v[140:143], a[24:27], a[172:175], v[140:143]
ds_read_b64_tr_b16 a[102:103], v16 offset:51360
v_mfma_f32_16x16x32_bf16 v[144:147], a[28:31], a[160:163], v[144:147]
ds_read_b64_tr_b16 a[104:105], v16 offset:59264
v_mfma_f32_16x16x32_bf16 v[148:151], a[28:31], a[164:167], v[148:151]
.Lpad11:
s_cbranch_execz .Lnopoll20r
ds_read_b64_tr_b16 a[106:107], v16 offset:59776
v_mfma_f32_16x16x32_bf16 v[24:27], v[20:23], a[200:203], v[24:27]
v_mfma_f32_16x16x32_bf16 v[152:155], a[28:31], a[168:171], v[152:155]
buffer_load_dwordx4 a[152:155], v11, s[16:19], s52 offen sc1
v_mfma_f32_16x16x32_bf16 v[156:159], a[28:31], a[172:175], v[156:159]
ds_read_b64_tr_b16 a[108:109], v16 offset:59296
v_mfma_f32_16x16x32_bf16 v[160:163], a[32:35], a[160:163], v[160:163]
ds_read_b64_tr_b16 a[110:111], v16 offset:59808
v_mfma_f32_16x16x32_bf16 v[164:167], a[32:35], a[164:167], v[164:167]
ds_read_b64_tr_b16 a[112:113], v17 offset:50688
v_mfma_f32_16x16x32_bf16 v[168:171], a[32:35], a[168:171], v[168:171]
ds_read_b64_tr_b16 a[114:115], v17 offset:51200
v_mfma_f32_16x16x32_bf16 v[172:175], a[32:35], a[172:175], v[172:175]
v_mfma_f32_16x16x32_bf16 v[176:179], a[36:39], a[160:163], v[176:179]
buffer_load_dwordx4 v15, s[32:35], s54 offen offset:3168 lds
v_mfma_f32_16x16x32_bf16 v[180:183], a[36:39], a[164:167], v[180:183]
ds_read_b64_tr_b16 a[116:117], v17 offset:50720
s_add_u32 s54, s54, 229376
v_mfma_f32_16x16x32_bf16 v[184:187], a[36:39], a[168:171], v[184:187]
ds_read_b64_tr_b16 a[118:119], v17 offset:51232
v_mfma_f32_16x16x32_bf16 v[188:191], a[36:39], a[172:175], v[188:191]
ds_read_b64_tr_b16 a[120:121], v17 offset:59136
v_mfma_f32_16x16x32_bf16 v[192:195], a[40:43], a[160:163], v[192:195]
v_mfma_f32_16x16x32_bf16 v[196:199], a[40:43], a[164:167], v[196:199]
ds_read_b64_tr_b16 a[122:123], v17 offset:59648
v_mfma_f32_16x16x32_bf16 v[24:27], v[20:23], a[204:207], v[24:27]
ds_read_b64_tr_b16 a[124:125], v17 offset:59168
v_mfma_f32_16x16x32_bf16 v[200:203], a[40:43], a[168:171], v[200:203]
buffer_load_dwordx4 a[156:159], v11, s[16:19], s52 offen offset:1024 sc1
v_mfma_f32_16x16x32_bf16 v[204:207], a[40:43], a[172:175], v[204:207]
ds_read_b64_tr_b16 a[126:127], v17 offset:59680
s_add_u32 s52, s52, 0x20000
v_mfma_f32_16x16x32_bf16 v[208:211], a[44:47], a[160:163], v[208:211]
ds_read_b128 a[208:211], v9 offset:50688
v_mfma_f32_16x16x32_bf16 v[212:215], a[44:47], a[164:167], v[212:215]
v_mfma_f32_16x16x32_bf16 v[216:219], a[44:47], a[168:171], v[216:219]
ds_read_b128 a[212:215], v9 offset:51744
v_mfma_f32_16x16x32_bf16 v[220:223], a[44:47], a[172:175], v[220:223]
ds_read_b128 a[216:219], v9 offset:52800
s_mov_b32 m0, s67
v_mfma_f32_16x16x32_bf16 v[224:227], a[48:51], a[160:163], v[224:227]
buffer_load_dwordx4 v5, s[28:31], s58 offen lds
v_mfma_f32_16x16x32_bf16 v[228:231], a[48:51], a[164:167], v[228:231]
ds_read_b128 a[220:223], v9 offset:53856
v_mfma_f32_16x16x32_bf16 v[232:235], a[52:55], a[160:163], v[232:235]
v_mfma_f32_16x16x32_bf16 v[236:239], a[52:55], a[164:167], v[236:239]
v_mfma_f32_16x16x32_bf16 v[240:243], a[56:59], a[160:163], v[240:243]
v_mfma_f32_16x16x32_bf16 v[244:247], a[56:59], a[164:167], v[244:247]
v_mfma_f32_16x16x32_bf16 v[248:251], a[60:63], a[160:163], v[248:251]
v_mfma_f32_16x16x32_bf16 v[252:255], a[60:63], a[164:167], v[252:255]
s_waitcnt vmcnt(22) lgkmcnt(0)
s_barrier
v_mfma_f32_16x16x32_bf16 v[32:35], a[64:67], a[176:179], v[32:35]
ds_read_b64_tr_b16 a[0:1], v16
s_add_u32 m0, s55, 133888
v_mfma_f32_16x16x32_bf16 v[36:39], a[64:67], a[180:183], v[36:39]
buffer_load_dwordx4 v12, s[32:35], s54 offen lds
v_mfma_f32_16x16x32_bf16 v[40:43], a[64:67], a[184:187], v[40:43]
ds_read_b64_tr_b16 a[2:3], v16 offset:512
s_waitcnt vmcnt(22)
v_mfma_f32_16x16x32_bf16 v[44:47], a[64:67], a[188:191], v[44:47]
ds_read_b64_tr_b16 a[4:5], v16 offset:32
v_mfma_f32_16x16x32_bf16 v[48:51], a[68:71], a[176:179], v[48:51]
ds_read_b64_tr_b16 a[6:7], v16 offset:544
v_mfma_f32_16x16x32_bf16 v[52:55], a[68:71], a[180:183], v[52:55]
v_mfma_f32_16x16x32_bf16 v[24:27], v[20:23], a[208:211], v[24:27]
ds_read_b64_tr_b16 a[8:9], v16 offset:8448
v_mfma_f32_16x16x32_bf16 v[56:59], a[68:71], a[184:187], v[56:59]
buffer_load_dwordx4 a[160:163], v10, s[16:19], s52 offen sc1
v_mfma_f32_16x16x32_bf16 v[60:63], a[68:71], a[188:191], v[60:63]
ds_read_b64_tr_b16 a[10:11], v16 offset:8960
v_mfma_f32_16x16x32_bf16 v[64:67], a[72:75], a[176:179], v[64:67]
ds_read_b64_tr_b16 a[12:13], v16 offset:8480
v_mfma_f32_16x16x32_bf16 v[68:71], a[72:75], a[180:183], v[68:71]
ds_read_b64_tr_b16 a[14:15], v16 offset:8992
v_mfma_f32_16x16x32_bf16 v[72:75], a[72:75], a[184:187], v[72:75]
v_mfma_f32_16x16x32_bf16 v[76:79], a[72:75], a[188:191], v[76:79]
ds_read_b64_tr_b16 a[16:17], v16 offset:64
v_mfma_f32_16x16x32_bf16 v[80:83], a[76:79], a[176:179], v[80:83]
buffer_load_dwordx4 v13, s[32:35], s54 offen offset:1056 lds
v_mfma_f32_16x16x32_bf16 v[84:87], a[76:79], a[180:183], v[84:87]
ds_read_b64_tr_b16 a[18:19], v16 offset:576
v_mfma_f32_16x16x32_bf16 v[88:91], a[76:79], a[184:187], v[88:91]
ds_read_b64_tr_b16 a[20:21], v16 offset:96
v_mfma_f32_16x16x32_bf16 v[92:95], a[76:79], a[188:191], v[92:95]
ds_read_b64_tr_b16 a[22:23], v16 offset:608
v_mfma_f32_16x16x32_bf16 v[96:99], a[80:83], a[176:179], v[96:99]
v_mfma_f32_16x16x32_bf16 v[100:103], a[80:83], a[180:183], v[100:103]
ds_read_b64_tr_b16 a[24:25], v16 offset:8512
v_mfma_f32_16x16x32_bf16 v[24:27], v[20:23], a[212:215], v[24:27]
ds_read_b64_tr_b16 a[26:27], v16 offset:9024
v_mfma_f32_16x16x32_bf16 v[104:107], a[80:83], a[184:187], v[104:107]
buffer_load_dwordx4 a[164:167], v10, s[16:19], s52 offen offset:1024 sc1
v_mfma_f32_16x16x32_bf16 v[108:111], a[80:83], a[188:191], v[108:111]
ds_read_b64_tr_b16 a[28:29], v16 offset:8544
v_mfma_f32_16x16x32_bf16 v[112:115], a[84:87], a[176:179], v[112:115]
ds_read_b64_tr_b16 a[30:31], v16 offset:9056
v_mfma_f32_16x16x32_bf16 v[116:119], a[84:87], a[180:183], v[116:119]
v_mfma_f32_16x16x32_bf16 v[120:123], a[84:87], a[184:187], v[120:123]
ds_read_b64_tr_b16 a[32:33], v16 offset:128
v_mfma_f32_16x16x32_bf16 v[124:127], a[84:87], a[188:191], v[124:127]
ds_read_b64_tr_b16 a[34:35], v16 offset:640
v_mfma_f32_16x16x32_bf16 v[128:131], a[88:91], a[176:179], v[128:131]
buffer_load_dwordx4 v14, s[32:35], s54 offen offset:2112 lds
v_mfma_f32_16x16x32_bf16 v[132:135], a[88:91], a[180:183], v[132:135]
ds_read_b64_tr_b16 a[36:37], v16 offset:160
v_mfma_f32_16x16x32_bf16 v[136:139], a[88:91], a[184:187], v[136:139]
ds_read_b64_tr_b16 a[38:39], v16 offset:672
v_mfma_f32_16x16x32_bf16 v[140:143], a[88:91], a[188:191], v[140:143]
v_mfma_f32_16x16x32_bf16 v[144:147], a[92:95], a[176:179], v[144:147]
ds_read_b64_tr_b16 a[40:41], v16 offset:8576
v_mfma_f32_16x16x32_bf16 v[148:151], a[92:95], a[180:183], v[148:151]
ds_read_b64_tr_b16 a[42:43], v16 offset:9088
v_mfma_f32_16x16x32_bf16 v[24:27], v[20:23], a[216:219], v[24:27]
ds_read_b64_tr_b16 a[44:45], v16 offset:8608
v_mfma_f32_16x16x32_bf16 v[152:155], a[92:95], a[184:187], v[152:155]
buffer_load_dwordx4 a[168:171], v11, s[16:19], s52 offen sc1
v_mfma_f32_16x16x32_bf16 v[156:159], a[92:95], a[188:191], v[156:159]
ds_read_b64_tr_b16 a[46:47], v16 offset:9120
v_mfma_f32_16x16x32_bf16 v[160:163], a[96:99], a[176:179], v[160:163]
v_mfma_f32_16x16x32_bf16 v[164:167], a[96:99], a[180:183], v[164:167]
ds_read_b64_tr_b16 a[48:49], v17
v_mfma_f32_16x16x32_bf16 v[168:171], a[96:99], a[184:187], v[168:171]
ds_read_b64_tr_b16 a[50:51], v17 offset:512
v_mfma_f32_16x16x32_bf16 v[172:175], a[96:99], a[188:191], v[172:175]
ds_read_b64_tr_b16 a[52:53], v17 offset:32
v_mfma_f32_16x16x32_bf16 v[176:179], a[100:103], a[176:179], v[176:179]
buffer_load_dwordx4 v15, s[32:35], s54 offen offset:3168 lds
v_mfma_f32_16x16x32_bf16 v[180:183], a[100:103], a[180:183], v[180:183]
ds_read_b64_tr_b16 a[54:55], v17 offset:544
s_add_u32 s54, s54, 229376
v_mfma_f32_16x16x32_bf16 v[184:187], a[100:103], a[184:187], v[184:187]
v_mfma_f32_16x16x32_bf16 v[188:191], a[100:103], a[188:191], v[188:191]
ds_read_b64_tr_b16 a[56:57], v17 offset:8448
v_mfma_f32_16x16x32_bf16 v[192:195], a[104:107], a[176:179], v[192:195]
ds_read_b64_tr_b16 a[58:59], v17 offset:8960
v_mfma_f32_16x16x32_bf16 v[196:199], a[104:107], a[180:183], v[196:199]
ds_read_b64_tr_b16 a[60:61], v17 offset:8480
v_mfma_f32_16x16x32_bf16 v[24:27], v[20:23], a[220:223], v[24:27]
ds_read_b64_tr_b16 a[62:63], v17 offset:8992
v_mfma_f32_16x16x32_bf16 v[200:203], a[104:107], a[184:187], v[200:203]
buffer_load_dwordx4 a[172:175], v11, s[16:19], s52 offen offset:1024 sc1
v_mfma_f32_16x16x32_bf16 v[204:207], a[104:107], a[188:191], v[204:207]
s_add_u32 s52, s52, 0x20000
v_mfma_f32_16x16x32_bf16 v[208:211], a[108:111], a[176:179], v[208:211]
ds_read_b128 a[192:195], v9
v_mfma_f32_16x16x32_bf16 v[212:215], a[108:111], a[180:183], v[212:215]
ds_read_b128 a[196:199], v9 offset:1056
v_mfma_f32_16x16x32_bf16 v[216:219], a[108:111], a[184:187], v[216:219]
ds_read_b128 a[200:203], v9 offset:2112
v_mfma_f32_16x16x32_bf16 v[220:223], a[108:111], a[188:191], v[220:223]
ds_read_b128 a[204:207], v9 offset:3168
s_mov_b32 m0, s67
v_mfma_f32_16x16x32_bf16 v[224:227], a[112:115], a[176:179], v[224:227]
buffer_load_dwordx4 v6, s[28:31], s58 offen offset:1024 lds
v_mfma_f32_16x16x32_bf16 v[228:231], a[112:115], a[180:183], v[228:231]
s_add_u32 s67, s67, 8320
s_min_u32 s67, s67, s74
s_add_u32 s58, s58, 0x20000
s_min_u32 s58, s58, 1179648
v_mfma_f32_16x16x32_bf16 v[232:235], a[116:119], a[176:179], v[232:235]
v_mfma_f32_16x16x32_bf16 v[236:239], a[116:119], a[180:183], v[236:239]
v_mfma_f32_16x16x32_bf16 v[240:243], a[120:123], a[176:179], v[240:243]
v_mfma_f32_16x16x32_bf16 v[244:247], a[120:123], a[180:183], v[244:247]
v_mfma_f32_16x16x32_bf16 v[248:251], a[124:127], a[176:179], v[248:251]
v_mfma_f32_16x16x32_bf16 v[252:255], a[124:127], a[180:183], v[252:255]
s_sub_u32 s15, s15, 1
s_cmp_lg_u32 s15, 0
s_cbranch_scc1 .Lk21
s_waitcnt vmcnt(11) lgkmcnt(0)
s_barrier
v_mfma_f32_16x16x32_bf16 v[24:27], v[20:23], a[192:195], v[24:27]
buffer_load_dwordx4 a[176:179], v10, s[16:19], s52 offen sc1
v_mfma_f32_16x16x32_bf16 v[24:27], v[20:23], a[196:199], v[24:27]
ds_read_b64_tr_b16 a[64:65], v16 offset:16896
v_mov_b32 v18, v5
v_mfma_f32_16x16x32_bf16 v[24:27], v[20:23], a[200:203], v[24:27]
ds_read_b64_tr_b16 a[66:67], v16 offset:17408
v_mov_b32 v19, v6
v_mfma_f32_16x16x32_bf16 v[24:27], v[20:23], a[204:207], v[24:27]
ds_read_b64_tr_b16 a[68:69], v16 offset:16928
s_lshl_b32 s74, s48, 10
v_mfma_f32_16x16x32_bf16 v[32:35], a[0:3], a[128:131], v[32:35]
buffer_load_dwordx4 a[180:183], v10, s[16:19], s52 offen offset:1024 sc1
v_mfma_f32_16x16x32_bf16 v[36:39], a[0:3], a[132:135], v[36:39]
ds_read_b64_tr_b16 a[70:71], v16 offset:17440
s_lshl_b32 s75, s49, 9
v_mfma_f32_16x16x32_bf16 v[40:43], a[0:3], a[136:139], v[40:43]
ds_read_b64_tr_b16 a[72:73], v16 offset:25344
s_add_u32 s74, s74, s75
v_mfma_f32_16x16x32_bf16 v[44:47], a[0:3], a[140:143], v[44:47]
ds_read_b64_tr_b16 a[74:75], v16 offset:25856
s_add_u32 s74, s74, 158464
v_mfma_f32_16x16x32_bf16 v[48:51], a[4:7], a[128:131], v[48:51]
buffer_load_dwordx4 a[184:187], v11, s[16:19], s52 offen sc1
v_mfma_f32_16x16x32_bf16 v[52:55], a[4:7], a[132:135], v[52:55]
ds_read_b64_tr_b16 a[76:77], v16 offset:25376
v_bfe_u32 v2, v1, 4, 1
v_mfma_f32_16x16x32_bf16 v[56:59], a[4:7], a[136:139], v[56:59]
ds_read_b64_tr_b16 a[78:79], v16 offset:25888
s_lshl_b32 s75, s12, 9
v_mfma_f32_16x16x32_bf16 v[60:63], a[4:7], a[140:143], v[60:63]
ds_read_b64_tr_b16 a[80:81], v16 offset:33792
s_mul_i32 s66, s13, 917504
v_mfma_f32_16x16x32_bf16 v[64:67], a[8:11], a[128:131], v[64:67]
buffer_load_dwordx4 a[188:191], v11, s[16:19], s52 offen offset:1024 sc1
v_mfma_f32_16x16x32_bf16 v[68:71], a[8:11], a[132:135], v[68:71]
s_add_u32 s52, s52, 0x20000
ds_read_b64_tr_b16 a[82:83], v16 offset:34304
v_mfma_f32_16x16x32_bf16 v[72:75], a[8:11], a[136:139], v[72:75]
ds_read_b64_tr_b16 a[84:85], v16 offset:33824
s_add_u32 s66, s66, 12582912
v_mfma_f32_16x16x32_bf16 v[76:79], a[8:11], a[140:143], v[76:79]
ds_read_b64_tr_b16 a[86:87], v16 offset:34336
s_add_u32 s65, s66, 393216
v_mfma_f32_16x16x32_bf16 v[80:83], a[12:15], a[128:131], v[80:83]
ds_read_b64_tr_b16 a[88:89], v16 offset:42240
s_lshl_b32 s62, s12, 19
v_mfma_f32_16x16x32_bf16 v[84:87], a[12:15], a[132:135], v[84:87]
ds_read_b64_tr_b16 a[90:91], v16 offset:42752
s_add_u32 s62, s62, s66
v_mfma_f32_16x16x32_bf16 v[88:91], a[12:15], a[136:139], v[88:91]
ds_read_b64_tr_b16 a[92:93], v16 offset:42272
s_add_u32 s63, s62, 0x20000
v_mfma_f32_16x16x32_bf16 v[92:95], a[12:15], a[140:143], v[92:95]
ds_read_b64_tr_b16 a[94:95], v16 offset:42784
s_add_u32 s64, s62, 0x40000
v_mfma_f32_16x16x32_bf16 v[96:99], a[16:19], a[128:131], v[96:99]
ds_read_b128 a[208:211], v9 offset:16896
s_mov_b32 s58, 1310720
v_mfma_f32_16x16x32_bf16 v[100:103], a[16:19], a[132:135], v[100:103]
ds_read_b128 a[212:215], v9 offset:17952
v_mfma_f32_16x16x32_bf16 v[104:107], a[16:19], a[136:139], v[104:107]
ds_read_b128 a[216:219], v9 offset:19008
v_mfma_f32_16x16x32_bf16 v[108:111], a[16:19], a[140:143], v[108:111]
ds_read_b128 a[220:223], v9 offset:20064
v_mfma_f32_16x16x32_bf16 v[112:115], a[20:23], a[128:131], v[112:115]
ds_read_b128 a[192:195], v9 offset:33792
v_mfma_f32_16x16x32_bf16 v[116:119], a[20:23], a[132:135], v[116:119]
ds_read_b128 a[196:199], v9 offset:34848
v_mfma_f32_16x16x32_bf16 v[120:123], a[20:23], a[136:139], v[120:123]
ds_read_b128 a[200:203], v9 offset:35904
v_mfma_f32_16x16x32_bf16 v[124:127], a[20:23], a[140:143], v[124:127]
ds_read_b128 a[204:207], v9 offset:36960
v_mfma_f32_16x16x32_bf16 v[128:131], a[24:27], a[128:131], v[128:131]
ds_read_b64_tr_b16 a[16:17], v16 offset:16960
s_waitcnt lgkmcnt(8)
v_mfma_f32_16x16x32_bf16 v[24:27], v[20:23], a[208:211], v[24:27]
ds_read_b64_tr_b16 a[18:19], v16 offset:17472
s_waitcnt lgkmcnt(8)
v_mfma_f32_16x16x32_bf16 v[24:27], v[20:23], a[212:215], v[24:27]
ds_read_b64_tr_b16 a[20:21], v16 offset:16992
s_waitcnt lgkmcnt(8)
v_mfma_f32_16x16x32_bf16 v[24:27], v[20:23], a[216:219], v[24:27]
ds_read_b64_tr_b16 a[22:23], v16 offset:17504
s_waitcnt lgkmcnt(8)
v_mfma_f32_16x16x32_bf16 v[24:27], v[20:23], a[220:223], v[24:27]
s_waitcnt lgkmcnt(7)
v_mfma_f32_16x16x32_bf16 v[24:27], v[20:23], a[192:195], v[24:27]
s_waitcnt lgkmcnt(6)
v_mfma_f32_16x16x32_bf16 v[24:27], v[20:23], a[196:199], v[24:27]
s_waitcnt lgkmcnt(5)
v_mfma_f32_16x16x32_bf16 v[24:27], v[20:23], a[200:203], v[24:27]
s_waitcnt lgkmcnt(4)
v_mfma_f32_16x16x32_bf16 v[24:27], v[20:23], a[204:207], v[24:27]
v_mfma_f32_16x16x32_bf16 v[132:135], a[24:27], a[132:135], v[132:135]
s_waitcnt vmcnt(6)
s_barrier
v_mfma_f32_16x16x32_bf16 v[136:139], a[24:27], a[136:139], v[136:139]
ds_read_b128 a[208:211], v9 offset:50688
v_mfma_f32_16x16x32_bf16 v[140:143], a[24:27], a[140:143], v[140:143]
ds_read_b128 a[212:215], v9 offset:51744
v_mfma_f32_16x16x32_bf16 v[144:147], a[28:31], a[128:131], v[144:147]
ds_read_b128 a[216:219], v9 offset:52800
v_mfma_f32_16x16x32_bf16 v[148:151], a[28:31], a[132:135], v[148:151]
ds_read_b128 a[220:223], v9 offset:53856
v_and_b32 v9, 15, v1
v_mfma_f32_16x16x32_bf16 v[152:155], a[28:31], a[136:139], v[152:155]
ds_read_b64_tr_b16 a[0:1], v16 offset:50688
v_lshl_add_u32 v9, v9, 5, s74
v_mfma_f32_16x16x32_bf16 v[156:159], a[28:31], a[140:143], v[156:159]
s_lshl_b32 s74, s3, 10
v_lshl_add_u32 v9, v2, 4, v9
v_bfe_u32 v2, v1, 5, 1
v_mfma_f32_16x16x32_bf16 v[32:35], a[64:67], a[144:147], v[32:35]
s_add_u32 s74, s74, s75
v_mul_u32_u24 v2, 2816, v2
v_sub_u32 v9, v9, v2
v_mfma_f32_16x16x32_bf16 v[36:39], a[64:67], a[148:151], v[36:39]
s_add_u32 s74, s74, 151552
v_and_b32 v2, 15, v1
v_lshl_add_u32 v2, v2, 4, s74
v_mfma_f32_16x16x32_bf16 v[40:43], a[64:67], a[152:155], v[40:43]
ds_read_b32 v28, v2 offset:8
v_xor_b32 v8, 512, v2
s_waitcnt lgkmcnt(5)
v_mfma_f32_16x16x32_bf16 v[24:27], v[20:23], a[208:211], v[24:27]
ds_read_b32 v29, v2 offset:264
s_lshl_b32 s74, s12, 7
s_waitcnt lgkmcnt(5)
v_mfma_f32_16x16x32_bf16 v[24:27], v[20:23], a[212:215], v[24:27]
ds_read_b32 v30, v8 offset:8
s_add_u32 s74, s74, 160512
s_waitcnt lgkmcnt(5)
v_mfma_f32_16x16x32_bf16 v[24:27], v[20:23], a[216:219], v[24:27]
ds_read_b32 v31, v8 offset:264
s_xor_b32 s75, s12, 1
s_waitcnt lgkmcnt(5)
v_mfma_f32_16x16x32_bf16 v[24:27], v[20:23], a[220:223], v[24:27]
s_mul_i32 s75, s75, 384
s_add_u32 s75, s75, 160512
v_mfma_f32_16x16x32_bf16 v[44:47], a[64:67], a[156:159], v[44:47]
ds_read_b64_tr_b16 a[2:3], v16 offset:51200
v_mfma_f32_16x16x32_bf16 v[48:51], a[68:71], a[144:147], v[48:51]
s_nop 2
ds_write_b128 v9, v[24:27]
v_lshlrev_b32 v9, 4, v1
v_mfma_f32_16x16x32_bf16 v[52:55], a[68:71], a[148:151], v[52:55]
ds_read_b64_tr_b16 a[4:5], v16 offset:50720
v_add_u32 v9, 158464, v9
v_mfma_f32_16x16x32_bf16 v[56:59], a[68:71], a[152:155], v[56:59]
ds_read_b64_tr_b16 a[6:7], v16 offset:51232
v_mfma_f32_16x16x32_bf16 v[60:63], a[68:71], a[156:159], v[60:63]
ds_read_b64_tr_b16 a[8:9], v16 offset:59136
v_mfma_f32_16x16x32_bf16 v[64:67], a[72:75], a[144:147], v[64:67]
ds_read_b64_tr_b16 a[10:11], v16 offset:59648
v_mfma_f32_16x16x32_bf16 v[68:71], a[72:75], a[148:151], v[68:71]
ds_read_b64_tr_b16 a[12:13], v16 offset:59168
v_mfma_f32_16x16x32_bf16 v[72:75], a[72:75], a[152:155], v[72:75]
ds_read_b64_tr_b16 a[14:15], v16 offset:59680
v_mfma_f32_16x16x32_bf16 v[76:79], a[72:75], a[156:159], v[76:79]
ds_read_b64_tr_b16 a[24:25], v16 offset:25408
v_mfma_f32_16x16x32_bf16 v[80:83], a[76:79], a[144:147], v[80:83]
s_waitcnt lgkmcnt(7)
s_barrier
ds_read_b128 v[20:23], v9
v_mfma_f32_16x16x32_bf16 v[84:87], a[76:79], a[148:151], v[84:87]
ds_read_b128 v[24:27], v9 offset:1024
v_mfma_f32_16x16x32_bf16 v[88:91], a[76:79], a[152:155], v[88:91]
ds_read_b64_tr_b16 a[26:27], v16 offset:25920
v_mfma_f32_16x16x32_bf16 v[92:95], a[76:79], a[156:159], v[92:95]
ds_read_b64_tr_b16 a[28:29], v16 offset:25440
v_mfma_f32_16x16x32_bf16 v[32:35], a[80:83], a[160:163], v[32:35]
ds_read_b64_tr_b16 a[30:31], v16 offset:25952
v_mfma_f32_16x16x32_bf16 v[36:39], a[80:83], a[164:167], v[36:39]
ds_read_b64_tr_b16 a[64:65], v16 offset:33856
v_mfma_f32_16x16x32_bf16 v[40:43], a[80:83], a[168:171], v[40:43]
ds_read_b64_tr_b16 a[66:67], v16 offset:34368
s_waitcnt vmcnt(5)
v_mfma_f32_16x16x32_bf16 v[44:47], a[80:83], a[172:175], v[44:47]
ds_read_b64_tr_b16 a[68:69], v16 offset:33888
v_mfma_f32_16x16x32_bf16 v[48:51], a[84:87], a[160:163], v[48:51]
ds_read_b64_tr_b16 a[70:71], v16 offset:34400
v_mfma_f32_16x16x32_bf16 v[52:55], a[84:87], a[164:167], v[52:55]
ds_read_b64_tr_b16 a[72:73], v16 offset:42304
s_waitcnt lgkmcnt(8)
v_add_f32 v20, v20, v24
v_mfma_f32_16x16x32_bf16 v[56:59], a[84:87], a[168:171], v[56:59]
ds_read_b64_tr_b16 a[74:75], v16 offset:42816
v_add_f32 v21, v21, v25
v_mfma_f32_16x16x32_bf16 v[60:63], a[84:87], a[172:175], v[60:63]
ds_read_b64 v[24:25], v8
v_add_f32 v22, v22, v26
v_mfma_f32_16x16x32_bf16 v[64:67], a[88:91], a[160:163], v[64:67]
ds_read_b64_tr_b16 a[76:77], v16 offset:42336
v_add_f32 v23, v23, v27
v_mfma_f32_16x16x32_bf16 v[68:71], a[88:91], a[164:167], v[68:71]
ds_write_b128 v9, v[20:23] offset:2048
v_lshrrev_b32 v9, 4, v1
v_mfma_f32_16x16x32_bf16 v[72:75], a[88:91], a[168:171], v[72:75]
ds_read_b64 v[20:21], v2
v_lshlrev_b32 v9, 4, v9
v_mfma_f32_16x16x32_bf16 v[76:79], a[88:91], a[172:175], v[76:79]
ds_read_b64 v[22:23], v2 offset:256
v_mfma_f32_16x16x32_bf16 v[80:83], a[92:95], a[160:163], v[80:83]
ds_read_b64 v[26:27], v8 offset:256
v_add_u32 v8, s75, v9
v_mfma_f32_16x16x32_bf16 v[84:87], a[92:95], a[164:167], v[84:87]
ds_read_b64_tr_b16 a[78:79], v16 offset:42848
v_add_u32 v9, s74, v9
v_mfma_f32_16x16x32_bf16 v[88:91], a[92:95], a[168:171], v[88:91]
ds_read_b128 v[12:15], v9
v_mfma_f32_16x16x32_bf16 v[92:95], a[92:95], a[172:175], v[92:95]
ds_read_b128 v[4:7], v9 offset:64
s_waitcnt vmcnt(3)
v_mfma_f32_16x16x32_bf16 v[32:35], a[0:3], a[176:179], v[32:35]
ds_read_b64_tr_b16 a[80:81], v16 offset:50752
s_waitcnt vmcnt(2)
v_mfma_f32_16x16x32_bf16 v[36:39], a[0:3], a[180:183], v[36:39]
ds_read_b64_tr_b16 a[82:83], v16 offset:51264
s_waitcnt vmcnt(1)
v_mfma_f32_16x16x32_bf16 v[40:43], a[0:3], a[184:187], v[40:43]
ds_read_b64_tr_b16 a[84:85], v16 offset:50784
s_waitcnt vmcnt(0)
v_mfma_f32_16x16x32_bf16 v[44:47], a[0:3], a[188:191], v[44:47]
ds_read_b64_tr_b16 a[86:87], v16 offset:51296
v_mfma_f32_16x16x32_bf16 v[48:51], a[4:7], a[176:179], v[48:51]
ds_read_b64_tr_b16 a[88:89], v16 offset:59200
v_mfma_f32_16x16x32_bf16 v[52:55], a[4:7], a[180:183], v[52:55]
ds_read_b64_tr_b16 a[90:91], v16 offset:59712
v_mfma_f32_16x16x32_bf16 v[56:59], a[4:7], a[184:187], v[56:59]
ds_read_b64_tr_b16 a[92:93], v16 offset:59232
v_mfma_f32_16x16x32_bf16 v[60:63], a[4:7], a[188:191], v[60:63]
ds_read_b64_tr_b16 a[94:95], v16 offset:59744
ds_read_b64_tr_b16 a[0:1], v16 offset:17024
ds_read_b64_tr_b16 a[2:3], v16 offset:17536
ds_read_b64_tr_b16 a[4:5], v16 offset:17056
ds_read_b64_tr_b16 a[6:7], v16 offset:17568
s_waitcnt lgkmcnt(13)
v_pk_fma_f32 v[32:33], v[12:13], v[20:21], v[32:33] op_sel_hi:[1,0,1]
v_pk_fma_f32 v[34:35], v[14:15], v[20:21], v[34:35] op_sel_hi:[1,0,1]
v_pk_fma_f32 v[36:37], v[12:13], v[22:23], v[36:37] op_sel_hi:[1,0,1]
v_pk_fma_f32 v[38:39], v[14:15], v[22:23], v[38:39] op_sel_hi:[1,0,1]
v_pk_fma_f32 v[40:41], v[12:13], v[24:25], v[40:41] op_sel_hi:[1,0,1]
v_pk_fma_f32 v[42:43], v[14:15], v[24:25], v[42:43] op_sel_hi:[1,0,1]
v_pk_fma_f32 v[44:45], v[12:13], v[26:27], v[44:45] op_sel_hi:[1,0,1]
v_pk_fma_f32 v[46:47], v[14:15], v[26:27], v[46:47] op_sel_hi:[1,0,1]
ds_read_b128 v[12:15], v9 offset:512
s_waitcnt lgkmcnt(13)
v_pk_fma_f32 v[48:49], v[4:5], v[20:21], v[48:49] op_sel_hi:[1,0,1]
v_pk_fma_f32 v[50:51], v[6:7], v[20:21], v[50:51] op_sel_hi:[1,0,1]
v_pk_fma_f32 v[52:53], v[4:5], v[22:23], v[52:53] op_sel_hi:[1,0,1]
v_pk_fma_f32 v[54:55], v[6:7], v[22:23], v[54:55] op_sel_hi:[1,0,1]
v_pk_fma_f32 v[56:57], v[4:5], v[24:25], v[56:57] op_sel_hi:[1,0,1]
v_pk_fma_f32 v[58:59], v[6:7], v[24:25], v[58:59] op_sel_hi:[1,0,1]
v_pk_fma_f32 v[60:61], v[4:5], v[26:27], v[60:61] op_sel_hi:[1,0,1]
v_pk_fma_f32 v[62:63], v[6:7], v[26:27], v[62:63] op_sel_hi:[1,0,1]
s_nop 1
v_mfma_f32_16x16x32_bf16 v[64:67], a[8:11], a[176:179], v[64:67]
ds_read_b128 v[4:7], v9 offset:576
v_mfma_f32_16x16x32_bf16 v[68:71], a[8:11], a[180:183], v[68:71]
v_mfma_f32_16x16x32_bf16 v[72:75], a[8:11], a[184:187], v[72:75]
v_mfma_f32_16x16x32_bf16 v[76:79], a[8:11], a[188:191], v[76:79]
ds_read_b64_tr_b16 a[8:9], v16 offset:25472
v_mfma_f32_16x16x32_bf16 v[80:83], a[12:15], a[176:179], v[80:83]
ds_read_b64_tr_b16 a[10:11], v16 offset:25984
v_mfma_f32_16x16x32_bf16 v[84:87], a[12:15], a[180:183], v[84:87]
v_mfma_f32_16x16x32_bf16 v[88:91], a[12:15], a[184:187], v[88:91]
v_mfma_f32_16x16x32_bf16 v[92:95], a[12:15], a[188:191], v[92:95]
ds_read_b64_tr_b16 a[12:13], v16 offset:25504
ds_read_b64_tr_b16 a[14:15], v16 offset:26016
s_waitcnt lgkmcnt(5)
v_pk_fma_f32 v[64:65], v[12:13], v[20:21], v[64:65] op_sel_hi:[1,0,1]
v_pk_fma_f32 v[66:67], v[14:15], v[20:21], v[66:67] op_sel_hi:[1,0,1]
v_pk_fma_f32 v[68:69], v[12:13], v[22:23], v[68:69] op_sel_hi:[1,0,1]
v_pk_fma_f32 v[70:71], v[14:15], v[22:23], v[70:71] op_sel_hi:[1,0,1]
v_pk_fma_f32 v[72:73], v[12:13], v[24:25], v[72:73] op_sel_hi:[1,0,1]
v_pk_fma_f32 v[74:75], v[14:15], v[24:25], v[74:75] op_sel_hi:[1,0,1]
v_pk_fma_f32 v[76:77], v[12:13], v[26:27], v[76:77] op_sel_hi:[1,0,1]
v_pk_fma_f32 v[78:79], v[14:15], v[26:27], v[78:79] op_sel_hi:[1,0,1]
ds_read_b128 v[12:15], v9 offset:128
s_waitcnt lgkmcnt(5)
v_pk_fma_f32 v[80:81], v[4:5], v[20:21], v[80:81] op_sel_hi:[1,0,1]
v_pk_fma_f32 v[82:83], v[6:7], v[20:21], v[82:83] op_sel_hi:[1,0,1]
v_pk_fma_f32 v[84:85], v[4:5], v[22:23], v[84:85] op_sel_hi:[1,0,1]
v_pk_fma_f32 v[86:87], v[6:7], v[22:23], v[86:87] op_sel_hi:[1,0,1]
v_pk_fma_f32 v[88:89], v[4:5], v[24:25], v[88:89] op_sel_hi:[1,0,1]
v_pk_fma_f32 v[90:91], v[6:7], v[24:25], v[90:91] op_sel_hi:[1,0,1]
v_pk_fma_f32 v[92:93], v[4:5], v[26:27], v[92:93] op_sel_hi:[1,0,1]
v_pk_fma_f32 v[94:95], v[6:7], v[26:27], v[94:95] op_sel_hi:[1,0,1]
ds_read_b128 v[4:7], v9 offset:192
v_pk_mul_f32 v[64:65], v[64:65], v[32:33]
v_pk_mul_f32 v[32:33], v[32:33], v[28:29] op_sel_hi:[1,0]
v_exp_f32 v32, v32
v_pk_mul_f32 v[66:67], v[66:67], v[34:35]
v_exp_f32 v33, v33
v_pk_mul_f32 v[34:35], v[34:35], v[28:29] op_sel_hi:[1,0]
v_exp_f32 v34, v34
v_pk_mul_f32 v[80:81], v[80:81], v[48:49]
v_exp_f32 v35, v35
v_pk_mul_f32 v[48:49], v[48:49], v[28:29] op_sel_hi:[1,0]
v_exp_f32 v48, v48
v_pk_mul_f32 v[82:83], v[82:83], v[50:51]
v_exp_f32 v49, v49
v_pk_mul_f32 v[50:51], v[50:51], v[28:29] op_sel_hi:[1,0]
v_exp_f32 v50, v50
v_pk_fma_f32 v[32:33], v[32:33], v[20:21], v[20:21] op_sel:[0,1,1] op_sel_hi:[1,1,1]
v_exp_f32 v51, v51
v_pk_fma_f32 v[34:35], v[34:35], v[20:21], v[20:21] op_sel:[0,1,1] op_sel_hi:[1,1,1]
v_rcp_f32 v32, v32
v_pk_fma_f32 v[48:49], v[48:49], v[20:21], v[20:21] op_sel:[0,1,1] op_sel_hi:[1,1,1]
v_rcp_f32 v33, v33
v_pk_fma_f32 v[50:51], v[50:51], v[20:21], v[20:21] op_sel:[0,1,1] op_sel_hi:[1,1,1]
v_rcp_f32 v34, v34
v_pk_mul_f32 v[64:65], v[64:65], v[32:33]
v_rcp_f32 v35, v35
v_cvt_pk_bf16_f32 v32, v64, v65
v_rcp_f32 v48, v48
v_pk_mul_f32 v[66:67], v[66:67], v[34:35]
v_rcp_f32 v49, v49
v_cvt_pk_bf16_f32 v33, v66, v67
v_rcp_f32 v50, v50
v_pk_mul_f32 v[80:81], v[80:81], v[48:49]
v_rcp_f32 v51, v51
v_cvt_pk_bf16_f32 v34, v80, v81
v_pk_mul_f32 v[68:69], v[68:69], v[36:37]
v_pk_mul_f32 v[82:83], v[82:83], v[50:51]
v_cvt_pk_bf16_f32 v35, v82, v83
buffer_store_dwordx4 v[32:35], v10, s[16:19], s62 offen sc1
v_pk_mul_f32 v[36:37], v[36:37], v[28:29] op_sel:[0,1] op_sel_hi:[1,1]
v_exp_f32 v36, v36
v_pk_mul_f32 v[70:71], v[70:71], v[38:39]
v_exp_f32 v37, v37
v_pk_mul_f32 v[38:39], v[38:39], v[28:29] op_sel:[0,1] op_sel_hi:[1,1]
v_exp_f32 v38, v38
v_pk_mul_f32 v[84:85], v[84:85], v[52:53]
v_exp_f32 v39, v39
v_pk_mul_f32 v[52:53], v[52:53], v[28:29] op_sel:[0,1] op_sel_hi:[1,1]
v_exp_f32 v52, v52
v_pk_mul_f32 v[86:87], v[86:87], v[54:55]
v_exp_f32 v53, v53
v_pk_mul_f32 v[54:55], v[54:55], v[28:29] op_sel:[0,1] op_sel_hi:[1,1]
v_exp_f32 v54, v54
v_pk_fma_f32 v[36:37], v[36:37], v[22:23], v[22:23] op_sel:[0,1,1] op_sel_hi:[1,1,1]
v_exp_f32 v55, v55
v_pk_fma_f32 v[38:39], v[38:39], v[22:23], v[22:23] op_sel:[0,1,1] op_sel_hi:[1,1,1]
v_rcp_f32 v36, v36
v_pk_fma_f32 v[52:53], v[52:53], v[22:23], v[22:23] op_sel:[0,1,1] op_sel_hi:[1,1,1]
v_rcp_f32 v37, v37
v_pk_fma_f32 v[54:55], v[54:55], v[22:23], v[22:23] op_sel:[0,1,1] op_sel_hi:[1,1,1]
v_rcp_f32 v38, v38
v_pk_mul_f32 v[68:69], v[68:69], v[36:37]
v_rcp_f32 v39, v39
v_cvt_pk_bf16_f32 v36, v68, v69
v_rcp_f32 v52, v52
v_pk_mul_f32 v[70:71], v[70:71], v[38:39]
v_rcp_f32 v53, v53
v_cvt_pk_bf16_f32 v37, v70, v71
v_rcp_f32 v54, v54
v_pk_mul_f32 v[84:85], v[84:85], v[52:53]
v_rcp_f32 v55, v55
v_cvt_pk_bf16_f32 v38, v84, v85
v_pk_mul_f32 v[72:73], v[72:73], v[40:41]
v_pk_mul_f32 v[86:87], v[86:87], v[54:55]
v_cvt_pk_bf16_f32 v39, v86, v87
buffer_store_dwordx4 v[36:39], v10, s[16:19], s62 offen offset:1024 sc1
v_pk_mul_f32 v[40:41], v[40:41], v[30:31] op_sel_hi:[1,0]
v_exp_f32 v40, v40
v_pk_mul_f32 v[74:75], v[74:75], v[42:43]
v_exp_f32 v41, v41
v_pk_mul_f32 v[42:43], v[42:43], v[30:31] op_sel_hi:[1,0]
v_exp_f32 v42, v42
v_pk_mul_f32 v[88:89], v[88:89], v[56:57]
v_exp_f32 v43, v43
v_pk_mul_f32 v[56:57], v[56:57], v[30:31] op_sel_hi:[1,0]
v_exp_f32 v56, v56
v_pk_mul_f32 v[90:91], v[90:91], v[58:59]
v_exp_f32 v57, v57
v_pk_mul_f32 v[58:59], v[58:59], v[30:31] op_sel_hi:[1,0]
v_exp_f32 v58, v58
v_pk_fma_f32 v[40:41], v[40:41], v[24:25], v[24:25] op_sel:[0,1,1] op_sel_hi:[1,1,1]
v_exp_f32 v59, v59
v_pk_fma_f32 v[42:43], v[42:43], v[24:25], v[24:25] op_sel:[0,1,1] op_sel_hi:[1,1,1]
v_rcp_f32 v40, v40
v_pk_fma_f32 v[56:57], v[56:57], v[24:25], v[24:25] op_sel:[0,1,1] op_sel_hi:[1,1,1]
v_rcp_f32 v41, v41
v_pk_fma_f32 v[58:59], v[58:59], v[24:25], v[24:25] op_sel:[0,1,1] op_sel_hi:[1,1,1]
v_rcp_f32 v42, v42
v_pk_mul_f32 v[72:73], v[72:73], v[40:41]
v_rcp_f32 v43, v43
v_cvt_pk_bf16_f32 v40, v72, v73
v_rcp_f32 v56, v56
v_pk_mul_f32 v[74:75], v[74:75], v[42:43]
v_rcp_f32 v57, v57
v_cvt_pk_bf16_f32 v41, v74, v75
v_rcp_f32 v58, v58
v_pk_mul_f32 v[88:89], v[88:89], v[56:57]
.Lpad12:
s_cbranch_execz .Lnopoll20r
v_rcp_f32 v59, v59
v_cvt_pk_bf16_f32 v42, v88, v89
v_pk_mul_f32 v[76:77], v[76:77], v[44:45]
v_pk_mul_f32 v[90:91], v[90:91], v[58:59]
v_cvt_pk_bf16_f32 v43, v90, v91
buffer_store_dwordx4 v[40:43], v11, s[16:19], s62 offen sc1
v_pk_mul_f32 v[44:45], v[44:45], v[30:31] op_sel:[0,1] op_sel_hi:[1,1]
v_exp_f32 v44, v44
v_pk_mul_f32 v[78:79], v[78:79], v[46:47]
v_exp_f32 v45, v45
v_pk_mul_f32 v[46:47], v[46:47], v[30:31] op_sel:[0,1] op_sel_hi:[1,1]
v_exp_f32 v46, v46
v_pk_mul_f32 v[92:93], v[92:93], v[60:61]
v_exp_f32 v47, v47
v_pk_mul_f32 v[60:61], v[60:61], v[30:31] op_sel:[0,1] op_sel_hi:[1,1]
v_exp_f32 v60, v60
v_pk_mul_f32 v[94:95], v[94:95], v[62:63]
v_exp_f32 v61, v61
v_pk_mul_f32 v[62:63], v[62:63], v[30:31] op_sel:[0,1] op_sel_hi:[1,1]
v_exp_f32 v62, v62
v_pk_fma_f32 v[44:45], v[44:45], v[26:27], v[26:27] op_sel:[0,1,1] op_sel_hi:[1,1,1]
v_exp_f32 v63, v63
v_pk_fma_f32 v[46:47], v[46:47], v[26:27], v[26:27] op_sel:[0,1,1] op_sel_hi:[1,1,1]
v_rcp_f32 v44, v44
v_pk_fma_f32 v[60:61], v[60:61], v[26:27], v[26:27] op_sel:[0,1,1] op_sel_hi:[1,1,1]
v_rcp_f32 v45, v45
v_pk_fma_f32 v[62:63], v[62:63], v[26:27], v[26:27] op_sel:[0,1,1] op_sel_hi:[1,1,1]
v_rcp_f32 v46, v46
v_pk_mul_f32 v[76:77], v[76:77], v[44:45]
v_rcp_f32 v47, v47
v_cvt_pk_bf16_f32 v44, v76, v77
v_rcp_f32 v60, v60
v_pk_mul_f32 v[78:79], v[78:79], v[46:47]
v_rcp_f32 v61, v61
v_cvt_pk_bf16_f32 v45, v78, v79
v_rcp_f32 v62, v62
v_pk_mul_f32 v[92:93], v[92:93], v[60:61]
v_rcp_f32 v63, v63
v_cvt_pk_bf16_f32 v46, v92, v93
v_pk_mul_f32 v[94:95], v[94:95], v[62:63]
s_nop 1
v_mfma_f32_16x16x32_bf16 v[96:99], a[16:19], a[144:147], v[96:99]
v_cvt_pk_bf16_f32 v47, v94, v95
v_mfma_f32_16x16x32_bf16 v[100:103], a[16:19], a[148:151], v[100:103]
buffer_store_dwordx4 v[44:47], v11, s[16:19], s62 offen offset:1024 sc1
v_mfma_f32_16x16x32_bf16 v[104:107], a[16:19], a[152:155], v[104:107]
v_mfma_f32_16x16x32_bf16 v[108:111], a[16:19], a[156:159], v[108:111]
ds_read_b64_tr_b16 a[16:17], v16 offset:33920
v_mfma_f32_16x16x32_bf16 v[112:115], a[20:23], a[144:147], v[112:115]
ds_read_b64_tr_b16 a[18:19], v16 offset:34432
v_mfma_f32_16x16x32_bf16 v[116:119], a[20:23], a[148:151], v[116:119]
v_mfma_f32_16x16x32_bf16 v[120:123], a[20:23], a[152:155], v[120:123]
v_mfma_f32_16x16x32_bf16 v[124:127], a[20:23], a[156:159], v[124:127]
ds_read_b64_tr_b16 a[20:21], v16 offset:33952
v_mfma_f32_16x16x32_bf16 v[128:131], a[24:27], a[144:147], v[128:131]
ds_read_b64_tr_b16 a[22:23], v16 offset:34464
v_mfma_f32_16x16x32_bf16 v[132:135], a[24:27], a[148:151], v[132:135]
v_mfma_f32_16x16x32_bf16 v[136:139], a[24:27], a[152:155], v[136:139]
v_mfma_f32_16x16x32_bf16 v[140:143], a[24:27], a[156:159], v[140:143]
ds_read_b64_tr_b16 a[24:25], v16 offset:42368
v_mfma_f32_16x16x32_bf16 v[144:147], a[28:31], a[144:147], v[144:147]
ds_read_b64_tr_b16 a[26:27], v16 offset:42880
v_mfma_f32_16x16x32_bf16 v[148:151], a[28:31], a[148:151], v[148:151]
v_mfma_f32_16x16x32_bf16 v[152:155], a[28:31], a[152:155], v[152:155]
v_mfma_f32_16x16x32_bf16 v[156:159], a[28:31], a[156:159], v[156:159]
ds_read_b64_tr_b16 a[28:29], v16 offset:42400
v_mfma_f32_16x16x32_bf16 v[96:99], a[64:67], a[160:163], v[96:99]
ds_read_b64_tr_b16 a[30:31], v16 offset:42912
v_mfma_f32_16x16x32_bf16 v[100:103], a[64:67], a[164:167], v[100:103]
v_mfma_f32_16x16x32_bf16 v[104:107], a[64:67], a[168:171], v[104:107]
v_mfma_f32_16x16x32_bf16 v[108:111], a[64:67], a[172:175], v[108:111]
ds_read_b64_tr_b16 a[64:65], v16 offset:50816
v_mfma_f32_16x16x32_bf16 v[112:115], a[68:71], a[160:163], v[112:115]
ds_read_b64_tr_b16 a[66:67], v16 offset:51328
v_mfma_f32_16x16x32_bf16 v[116:119], a[68:71], a[164:167], v[116:119]
v_mfma_f32_16x16x32_bf16 v[120:123], a[68:71], a[168:171], v[120:123]
v_mfma_f32_16x16x32_bf16 v[124:127], a[68:71], a[172:175], v[124:127]
ds_read_b64_tr_b16 a[68:69], v16 offset:50848
v_mfma_f32_16x16x32_bf16 v[128:131], a[72:75], a[160:163], v[128:131]
ds_read_b64_tr_b16 a[70:71], v16 offset:51360
v_mfma_f32_16x16x32_bf16 v[132:135], a[72:75], a[164:167], v[132:135]
v_mfma_f32_16x16x32_bf16 v[136:139], a[72:75], a[168:171], v[136:139]
v_mfma_f32_16x16x32_bf16 v[140:143], a[72:75], a[172:175], v[140:143]
ds_read_b64_tr_b16 a[72:73], v16 offset:59264
v_mfma_f32_16x16x32_bf16 v[144:147], a[76:79], a[160:163], v[144:147]
ds_read_b64_tr_b16 a[74:75], v16 offset:59776
v_mfma_f32_16x16x32_bf16 v[148:151], a[76:79], a[164:167], v[148:151]
v_mfma_f32_16x16x32_bf16 v[152:155], a[76:79], a[168:171], v[152:155]
v_mfma_f32_16x16x32_bf16 v[156:159], a[76:79], a[172:175], v[156:159]
ds_read_b64_tr_b16 a[76:77], v16 offset:59296
v_mfma_f32_16x16x32_bf16 v[96:99], a[80:83], a[176:179], v[96:99]
ds_read_b64_tr_b16 a[78:79], v16 offset:59808
v_mfma_f32_16x16x32_bf16 v[100:103], a[80:83], a[180:183], v[100:103]
v_mfma_f32_16x16x32_bf16 v[104:107], a[80:83], a[184:187], v[104:107]
v_mfma_f32_16x16x32_bf16 v[108:111], a[80:83], a[188:191], v[108:111]
ds_read_b64_tr_b16 a[80:81], v17 offset:16896
v_mfma_f32_16x16x32_bf16 v[112:115], a[84:87], a[176:179], v[112:115]
ds_read_b64_tr_b16 a[82:83], v17 offset:17408
v_mfma_f32_16x16x32_bf16 v[116:119], a[84:87], a[180:183], v[116:119]
v_mfma_f32_16x16x32_bf16 v[120:123], a[84:87], a[184:187], v[120:123]
v_mfma_f32_16x16x32_bf16 v[124:127], a[84:87], a[188:191], v[124:127]
ds_read_b64_tr_b16 a[84:85], v17 offset:16928
ds_read_b64_tr_b16 a[86:87], v17 offset:17440
s_waitcnt lgkmcnt(15)
v_pk_fma_f32 v[96:97], v[12:13], v[20:21], v[96:97] op_sel_hi:[1,0,1]
v_pk_fma_f32 v[98:99], v[14:15], v[20:21], v[98:99] op_sel_hi:[1,0,1]
v_pk_fma_f32 v[100:101], v[12:13], v[22:23], v[100:101] op_sel_hi:[1,0,1]
v_pk_fma_f32 v[102:103], v[14:15], v[22:23], v[102:103] op_sel_hi:[1,0,1]
v_pk_fma_f32 v[104:105], v[12:13], v[24:25], v[104:105] op_sel_hi:[1,0,1]
v_pk_fma_f32 v[106:107], v[14:15], v[24:25], v[106:107] op_sel_hi:[1,0,1]
v_pk_fma_f32 v[108:109], v[12:13], v[26:27], v[108:109] op_sel_hi:[1,0,1]
v_pk_fma_f32 v[110:111], v[14:15], v[26:27], v[110:111] op_sel_hi:[1,0,1]
ds_read_b128 v[12:15], v9 offset:640
v_pk_fma_f32 v[112:113], v[4:5], v[20:21], v[112:113] op_sel_hi:[1,0,1]
v_pk_fma_f32 v[114:115], v[6:7], v[20:21], v[114:115] op_sel_hi:[1,0,1]
v_pk_fma_f32 v[116:117], v[4:5], v[22:23], v[116:117] op_sel_hi:[1,0,1]
v_pk_fma_f32 v[118:119], v[6:7], v[22:23], v[118:119] op_sel_hi:[1,0,1]
v_pk_fma_f32 v[120:121], v[4:5], v[24:25], v[120:121] op_sel_hi:[1,0,1]
v_pk_fma_f32 v[122:123], v[6:7], v[24:25], v[122:123] op_sel_hi:[1,0,1]
v_pk_fma_f32 v[124:125], v[4:5], v[26:27], v[124:125] op_sel_hi:[1,0,1]
v_pk_fma_f32 v[126:127], v[6:7], v[26:27], v[126:127] op_sel_hi:[1,0,1]
s_nop 1
v_mfma_f32_16x16x32_bf16 v[128:131], a[88:91], a[176:179], v[128:131]
ds_read_b128 v[4:7], v9 offset:704
v_mfma_f32_16x16x32_bf16 v[132:135], a[88:91], a[180:183], v[132:135]
v_mfma_f32_16x16x32_bf16 v[136:139], a[88:91], a[184:187], v[136:139]
v_mfma_f32_16x16x32_bf16 v[140:143], a[88:91], a[188:191], v[140:143]
ds_read_b64_tr_b16 a[88:89], v17 offset:25344
v_mfma_f32_16x16x32_bf16 v[144:147], a[92:95], a[176:179], v[144:147]
ds_read_b64_tr_b16 a[90:91], v17 offset:25856
v_mfma_f32_16x16x32_bf16 v[148:151], a[92:95], a[180:183], v[148:151]
v_mfma_f32_16x16x32_bf16 v[152:155], a[92:95], a[184:187], v[152:155]
v_mfma_f32_16x16x32_bf16 v[156:159], a[92:95], a[188:191], v[156:159]
ds_read_b64_tr_b16 a[92:93], v17 offset:25376
ds_read_b64_tr_b16 a[94:95], v17 offset:25888
s_waitcnt lgkmcnt(5)
v_pk_fma_f32 v[128:129], v[12:13], v[20:21], v[128:129] op_sel_hi:[1,0,1]
v_pk_fma_f32 v[130:131], v[14:15], v[20:21], v[130:131] op_sel_hi:[1,0,1]
v_pk_fma_f32 v[132:133], v[12:13], v[22:23], v[132:133] op_sel_hi:[1,0,1]
v_pk_fma_f32 v[134:135], v[14:15], v[22:23], v[134:135] op_sel_hi:[1,0,1]
v_pk_fma_f32 v[136:137], v[12:13], v[24:25], v[136:137] op_sel_hi:[1,0,1]
v_pk_fma_f32 v[138:139], v[14:15], v[24:25], v[138:139] op_sel_hi:[1,0,1]
v_pk_fma_f32 v[140:141], v[12:13], v[26:27], v[140:141] op_sel_hi:[1,0,1]
v_pk_fma_f32 v[142:143], v[14:15], v[26:27], v[142:143] op_sel_hi:[1,0,1]
ds_read_b128 v[12:15], v9 offset:256
s_waitcnt lgkmcnt(5)
v_pk_fma_f32 v[144:145], v[4:5], v[20:21], v[144:145] op_sel_hi:[1,0,1]
v_pk_fma_f32 v[146:147], v[6:7], v[20:21], v[146:147] op_sel_hi:[1,0,1]
v_pk_fma_f32 v[148:149], v[4:5], v[22:23], v[148:149] op_sel_hi:[1,0,1]
v_pk_fma_f32 v[150:151], v[6:7], v[22:23], v[150:151] op_sel_hi:[1,0,1]
v_pk_fma_f32 v[152:153], v[4:5], v[24:25], v[152:153] op_sel_hi:[1,0,1]
v_pk_fma_f32 v[154:155], v[6:7], v[24:25], v[154:155] op_sel_hi:[1,0,1]
v_pk_fma_f32 v[156:157], v[4:5], v[26:27], v[156:157] op_sel_hi:[1,0,1]
v_pk_fma_f32 v[158:159], v[6:7], v[26:27], v[158:159] op_sel_hi:[1,0,1]
ds_read_b128 v[4:7], v9 offset:320
v_pk_mul_f32 v[128:129], v[128:129], v[96:97]
v_pk_mul_f32 v[96:97], v[96:97], v[28:29] op_sel_hi:[1,0]
v_exp_f32 v96, v96
v_pk_mul_f32 v[130:131], v[130:131], v[98:99]
v_exp_f32 v97, v97
v_pk_mul_f32 v[98:99], v[98:99], v[28:29] op_sel_hi:[1,0]
v_exp_f32 v98, v98
v_pk_mul_f32 v[144:145], v[144:145], v[112:113]
v_exp_f32 v99, v99
v_pk_mul_f32 v[112:113], v[112:113], v[28:29] op_sel_hi:[1,0]
v_exp_f32 v112, v112
v_pk_mul_f32 v[146:147], v[146:147], v[114:115]
v_exp_f32 v113, v113
v_pk_mul_f32 v[114:115], v[114:115], v[28:29] op_sel_hi:[1,0]
v_exp_f32 v114, v114
v_pk_fma_f32 v[96:97], v[96:97], v[20:21], v[20:21] op_sel:[0,1,1] op_sel_hi:[1,1,1]
v_exp_f32 v115, v115
v_pk_fma_f32 v[98:99], v[98:99], v[20:21], v[20:21] op_sel:[0,1,1] op_sel_hi:[1,1,1]
v_rcp_f32 v96, v96
v_pk_fma_f32 v[112:113], v[112:113], v[20:21], v[20:21] op_sel:[0,1,1] op_sel_hi:[1,1,1]
v_rcp_f32 v97, v97
v_pk_fma_f32 v[114:115], v[114:115], v[20:21], v[20:21] op_sel:[0,1,1] op_sel_hi:[1,1,1]
v_rcp_f32 v98, v98
v_pk_mul_f32 v[128:129], v[128:129], v[96:97]
v_rcp_f32 v99, v99
v_cvt_pk_bf16_f32 v96, v128, v129
v_rcp_f32 v112, v112
v_pk_mul_f32 v[130:131], v[130:131], v[98:99]
v_rcp_f32 v113, v113
v_cvt_pk_bf16_f32 v97, v130, v131
v_rcp_f32 v114, v114
v_pk_mul_f32 v[144:145], v[144:145], v[112:113]
v_rcp_f32 v115, v115
v_cvt_pk_bf16_f32 v98, v144, v145
v_pk_mul_f32 v[132:133], v[132:133], v[100:101]
v_pk_mul_f32 v[146:147], v[146:147], v[114:115]
v_cvt_pk_bf16_f32 v99, v146, v147
buffer_store_dwordx4 v[96:99], v10, s[16:19], s63 offen sc1
v_pk_mul_f32 v[100:101], v[100:101], v[28:29] op_sel:[0,1] op_sel_hi:[1,1]
v_exp_f32 v100, v100
v_pk_mul_f32 v[134:135], v[134:135], v[102:103]
v_exp_f32 v101, v101
v_pk_mul_f32 v[102:103], v[102:103], v[28:29] op_sel:[0,1] op_sel_hi:[1,1]
v_exp_f32 v102, v102
v_pk_mul_f32 v[148:149], v[148:149], v[116:117]
v_exp_f32 v103, v103
v_pk_mul_f32 v[116:117], v[116:117], v[28:29] op_sel:[0,1] op_sel_hi:[1,1]
v_exp_f32 v116, v116
v_pk_mul_f32 v[150:151], v[150:151], v[118:119]
v_exp_f32 v117, v117
v_pk_mul_f32 v[118:119], v[118:119], v[28:29] op_sel:[0,1] op_sel_hi:[1,1]
v_exp_f32 v118, v118
v_pk_fma_f32 v[100:101], v[100:101], v[22:23], v[22:23] op_sel:[0,1,1] op_sel_hi:[1,1,1]
v_exp_f32 v119, v119
v_pk_fma_f32 v[102:103], v[102:103], v[22:23], v[22:23] op_sel:[0,1,1] op_sel_hi:[1,1,1]
v_rcp_f32 v100, v100
v_pk_fma_f32 v[116:117], v[116:117], v[22:23], v[22:23] op_sel:[0,1,1] op_sel_hi:[1,1,1]
v_rcp_f32 v101, v101
v_pk_fma_f32 v[118:119], v[118:119], v[22:23], v[22:23] op_sel:[0,1,1] op_sel_hi:[1,1,1]
v_rcp_f32 v102, v102
v_pk_mul_f32 v[132:133], v[132:133], v[100:101]
v_rcp_f32 v103, v103
v_cvt_pk_bf16_f32 v100, v132, v133
v_rcp_f32 v116, v116
v_pk_mul_f32 v[134:135], v[134:135], v[102:103]
v_rcp_f32 v117, v117
v_cvt_pk_bf16_f32 v101, v134, v135
v_rcp_f32 v118, v118
v_pk_mul_f32 v[148:149], v[148:149], v[116:117]
v_rcp_f32 v119, v119
v_cvt_pk_bf16_f32 v102, v148, v149
v_pk_mul_f32 v[136:137], v[136:137], v[104:105]
v_pk_mul_f32 v[150:151], v[150:151], v[118:119]
v_cvt_pk_bf16_f32 v103, v150, v151
buffer_store_dwordx4 v[100:103], v10, s[16:19], s63 offen offset:1024 sc1
v_pk_mul_f32 v[104:105], v[104:105], v[30:31] op_sel_hi:[1,0]
v_exp_f32 v104, v104
v_pk_mul_f32 v[138:139], v[138:139], v[106:107]
v_exp_f32 v105, v105
v_pk_mul_f32 v[106:107], v[106:107], v[30:31] op_sel_hi:[1,0]
v_exp_f32 v106, v106
v_pk_mul_f32 v[152:153], v[152:153], v[120:121]
v_exp_f32 v107, v107
v_pk_mul_f32 v[120:121], v[120:121], v[30:31] op_sel_hi:[1,0]
v_exp_f32 v120, v120
v_pk_mul_f32 v[154:155], v[154:155], v[122:123]
v_exp_f32 v121, v121
v_pk_mul_f32 v[122:123], v[122:123], v[30:31] op_sel_hi:[1,0]
v_exp_f32 v122, v122
v_pk_fma_f32 v[104:105], v[104:105], v[24:25], v[24:25] op_sel:[0,1,1] op_sel_hi:[1,1,1]
v_exp_f32 v123, v123
v_pk_fma_f32 v[106:107], v[106:107], v[24:25], v[24:25] op_sel:[0,1,1] op_sel_hi:[1,1,1]
v_rcp_f32 v104, v104
v_pk_fma_f32 v[120:121], v[120:121], v[24:25], v[24:25] op_sel:[0,1,1] op_sel_hi:[1,1,1]
v_rcp_f32 v105, v105
v_pk_fma_f32 v[122:123], v[122:123], v[24:25], v[24:25] op_sel:[0,1,1] op_sel_hi:[1,1,1]
v_rcp_f32 v106, v106
v_pk_mul_f32 v[136:137], v[136:137], v[104:105]
v_rcp_f32 v107, v107
v_cvt_pk_bf16_f32 v104, v136, v137
v_rcp_f32 v120, v120
v_pk_mul_f32 v[138:139], v[138:139], v[106:107]
v_rcp_f32 v121, v121
v_cvt_pk_bf16_f32 v105, v138, v139
v_rcp_f32 v122, v122
v_pk_mul_f32 v[152:153], v[152:153], v[120:121]
v_rcp_f32 v123, v123
v_cvt_pk_bf16_f32 v106, v152, v153
v_pk_mul_f32 v[140:141], v[140:141], v[108:109]
v_pk_mul_f32 v[154:155], v[154:155], v[122:123]
v_cvt_pk_bf16_f32 v107, v154, v155
buffer_store_dwordx4 v[104:107], v11, s[16:19], s63 offen sc1
v_pk_mul_f32 v[108:109], v[108:109], v[30:31] op_sel:[0,1] op_sel_hi:[1,1]
v_exp_f32 v108, v108
v_pk_mul_f32 v[142:143], v[142:143], v[110:111]
v_exp_f32 v109, v109
v_pk_mul_f32 v[110:111], v[110:111], v[30:31] op_sel:[0,1] op_sel_hi:[1,1]
v_exp_f32 v110, v110
v_pk_mul_f32 v[156:157], v[156:157], v[124:125]
v_exp_f32 v111, v111
v_pk_mul_f32 v[124:125], v[124:125], v[30:31] op_sel:[0,1] op_sel_hi:[1,1]
v_exp_f32 v124, v124
v_pk_mul_f32 v[158:159], v[158:159], v[126:127]
v_exp_f32 v125, v125
v_pk_mul_f32 v[126:127], v[126:127], v[30:31] op_sel:[0,1] op_sel_hi:[1,1]
v_exp_f32 v126, v126
v_pk_fma_f32 v[108:109], v[108:109], v[26:27], v[26:27] op_sel:[0,1,1] op_sel_hi:[1,1,1]
v_exp_f32 v127, v127
v_pk_fma_f32 v[110:111], v[110:111], v[26:27], v[26:27] op_sel:[0,1,1] op_sel_hi:[1,1,1]
v_rcp_f32 v108, v108
v_pk_fma_f32 v[124:125], v[124:125], v[26:27], v[26:27] op_sel:[0,1,1] op_sel_hi:[1,1,1]
v_rcp_f32 v109, v109
v_pk_fma_f32 v[126:127], v[126:127], v[26:27], v[26:27] op_sel:[0,1,1] op_sel_hi:[1,1,1]
v_rcp_f32 v110, v110
v_pk_mul_f32 v[140:141], v[140:141], v[108:109]
v_rcp_f32 v111, v111
v_cvt_pk_bf16_f32 v108, v140, v141
v_rcp_f32 v124, v124
v_pk_mul_f32 v[142:143], v[142:143], v[110:111]
v_rcp_f32 v125, v125
v_cvt_pk_bf16_f32 v109, v142, v143
v_rcp_f32 v126, v126
v_pk_mul_f32 v[156:157], v[156:157], v[124:125]
v_rcp_f32 v127, v127
v_cvt_pk_bf16_f32 v110, v156, v157
v_pk_mul_f32 v[158:159], v[158:159], v[126:127]
s_nop 1
v_mfma_f32_16x16x32_bf16 v[160:163], a[32:35], a[128:131], v[160:163]
v_cvt_pk_bf16_f32 v111, v158, v159
v_mfma_f32_16x16x32_bf16 v[164:167], a[32:35], a[132:135], v[164:167]
buffer_store_dwordx4 v[108:111], v11, s[16:19], s63 offen offset:1024 sc1
v_mfma_f32_16x16x32_bf16 v[168:171], a[32:35], a[136:139], v[168:171]
s_nop 2
s_waitcnt lgkmcnt(1)
v_fmac_f32 v160, v12, v20
v_fmac_f32 v161, v13, v20
v_mfma_f32_16x16x32_bf16 v[172:175], a[32:35], a[140:143], v[172:175]
ds_read_b64_tr_b16 a[32:33], v17 offset:33792
v_fmac_f32 v162, v14, v20
v_mfma_f32_16x16x32_bf16 v[176:179], a[36:39], a[128:131], v[176:179]
ds_read_b64_tr_b16 a[34:35], v17 offset:34304
v_fmac_f32 v163, v15, v20
v_mfma_f32_16x16x32_bf16 v[180:183], a[36:39], a[132:135], v[180:183]
v_fmac_f32 v164, v12, v22
v_fmac_f32 v165, v13, v22
v_mfma_f32_16x16x32_bf16 v[184:187], a[36:39], a[136:139], v[184:187]
v_fmac_f32 v166, v14, v22
v_fmac_f32 v167, v15, v22
v_mfma_f32_16x16x32_bf16 v[188:191], a[36:39], a[140:143], v[188:191]
ds_read_b64_tr_b16 a[36:37], v17 offset:33824
v_fmac_f32 v168, v12, v24
v_mfma_f32_16x16x32_bf16 v[192:195], a[40:43], a[128:131], v[192:195]
ds_read_b64_tr_b16 a[38:39], v17 offset:34336
v_fmac_f32 v169, v13, v24
v_mfma_f32_16x16x32_bf16 v[196:199], a[40:43], a[132:135], v[196:199]
v_fmac_f32 v170, v14, v24
v_fmac_f32 v171, v15, v24
v_mfma_f32_16x16x32_bf16 v[200:203], a[40:43], a[136:139], v[200:203]
v_fmac_f32 v172, v12, v26
v_fmac_f32 v173, v13, v26
v_mfma_f32_16x16x32_bf16 v[204:207], a[40:43], a[140:143], v[204:207]
ds_read_b64_tr_b16 a[40:41], v17 offset:42240
v_fmac_f32 v174, v14, v26
v_mfma_f32_16x16x32_bf16 v[208:211], a[44:47], a[128:131], v[208:211]
ds_read_b64_tr_b16 a[42:43], v17 offset:42752
v_fmac_f32 v175, v15, v26
v_mfma_f32_16x16x32_bf16 v[212:215], a[44:47], a[132:135], v[212:215]
ds_read_b128 v[12:15], v9 offset:768
s_waitcnt lgkmcnt(7)
v_fmac_f32 v176, v4, v20
v_mfma_f32_16x16x32_bf16 v[216:219], a[44:47], a[136:139], v[216:219]
v_fmac_f32 v177, v5, v20
v_fmac_f32 v178, v6, v20
v_mfma_f32_16x16x32_bf16 v[220:223], a[44:47], a[140:143], v[220:223]
ds_read_b64_tr_b16 a[44:45], v17 offset:42272
v_fmac_f32 v179, v7, v20
v_mfma_f32_16x16x32_bf16 v[160:163], a[0:3], a[144:147], v[160:163]
ds_read_b64_tr_b16 a[46:47], v17 offset:42784
v_fmac_f32 v180, v4, v22
v_mfma_f32_16x16x32_bf16 v[164:167], a[0:3], a[148:151], v[164:167]
v_fmac_f32 v181, v5, v22
v_fmac_f32 v182, v6, v22
v_mfma_f32_16x16x32_bf16 v[168:171], a[0:3], a[152:155], v[168:171]
v_fmac_f32 v183, v7, v22
v_fmac_f32 v184, v4, v24
v_mfma_f32_16x16x32_bf16 v[172:175], a[0:3], a[156:159], v[172:175]
ds_read_b64_tr_b16 a[0:1], v17 offset:50688
v_fmac_f32 v185, v5, v24
v_mfma_f32_16x16x32_bf16 v[176:179], a[4:7], a[144:147], v[176:179]
ds_read_b64_tr_b16 a[2:3], v17 offset:51200
v_fmac_f32 v186, v6, v24
v_mfma_f32_16x16x32_bf16 v[180:183], a[4:7], a[148:151], v[180:183]
v_fmac_f32 v187, v7, v24
v_fmac_f32 v188, v4, v26
v_mfma_f32_16x16x32_bf16 v[192:195], a[8:11], a[144:147], v[192:195]
v_fmac_f32 v189, v5, v26
v_fmac_f32 v190, v6, v26
v_mfma_f32_16x16x32_bf16 v[184:187], a[4:7], a[152:155], v[184:187]
v_fmac_f32 v191, v7, v26
v_mfma_f32_16x16x32_bf16 v[196:199], a[8:11], a[148:151], v[196:199]
ds_read_b128 v[4:7], v9 offset:832
s_nop 0
s_waitcnt lgkmcnt(5)
v_fmac_f32 v192, v12, v20
v_mfma_f32_16x16x32_bf16 v[188:191], a[4:7], a[156:159], v[188:191]
ds_read_b64_tr_b16 a[4:5], v17 offset:50720
v_fmac_f32 v193, v13, v20
v_mfma_f32_16x16x32_bf16 v[200:203], a[8:11], a[152:155], v[200:203]
ds_read_b64_tr_b16 a[6:7], v17 offset:51232
v_fmac_f32 v194, v14, v20
v_mfma_f32_16x16x32_bf16 v[204:207], a[8:11], a[156:159], v[204:207]
ds_read_b64_tr_b16 a[8:9], v17 offset:59136
v_fmac_f32 v195, v15, v20
v_mfma_f32_16x16x32_bf16 v[208:211], a[12:15], a[144:147], v[208:211]
ds_read_b64_tr_b16 a[10:11], v17 offset:59648
v_fmac_f32 v196, v12, v22
v_mfma_f32_16x16x32_bf16 v[212:215], a[12:15], a[148:151], v[212:215]
v_fmac_f32 v197, v13, v22
v_fmac_f32 v198, v14, v22
v_mfma_f32_16x16x32_bf16 v[216:219], a[12:15], a[152:155], v[216:219]
v_fmac_f32 v199, v15, v22
v_fmac_f32 v200, v12, v24
v_mfma_f32_16x16x32_bf16 v[220:223], a[12:15], a[156:159], v[220:223]
ds_read_b64_tr_b16 a[12:13], v17 offset:59168
v_fmac_f32 v201, v13, v24
v_mfma_f32_16x16x32_bf16 v[160:163], a[16:19], a[160:163], v[160:163]
ds_read_b64_tr_b16 a[14:15], v17 offset:59680
v_fmac_f32 v202, v14, v24
v_mfma_f32_16x16x32_bf16 v[164:167], a[16:19], a[164:167], v[164:167]
v_fmac_f32 v203, v15, v24
v_fmac_f32 v204, v12, v26
v_mfma_f32_16x16x32_bf16 v[168:171], a[16:19], a[168:171], v[168:171]
v_fmac_f32 v205, v13, v26
v_fmac_f32 v206, v14, v26
v_mfma_f32_16x16x32_bf16 v[172:175], a[16:19], a[172:175], v[172:175]
v_fmac_f32 v207, v15, v26
v_mfma_f32_16x16x32_bf16 v[176:179], a[20:23], a[160:163], v[176:179]
ds_read_b128 v[12:15], v8
v_mfma_f32_16x16x32_bf16 v[180:183], a[20:23], a[164:167], v[180:183]
v_mfma_f32_16x16x32_bf16 v[184:187], a[20:23], a[168:171], v[184:187]
v_mfma_f32_16x16x32_bf16 v[188:191], a[20:23], a[172:175], v[188:191]
v_mfma_f32_16x16x32_bf16 v[192:195], a[24:27], a[160:163], v[192:195]
s_waitcnt lgkmcnt(1)
s_barrier
s_add_u32 m0, s59, 83200
v_mfma_f32_16x16x32_bf16 v[196:199], a[24:27], a[164:167], v[196:199]
buffer_load_dwordx4 v18, s[28:31], s58 offen lds
v_mfma_f32_16x16x32_bf16 v[200:203], a[24:27], a[168:171], v[200:203]
v_mfma_f32_16x16x32_bf16 v[204:207], a[24:27], a[172:175], v[204:207]
v_mfma_f32_16x16x32_bf16 v[208:211], a[28:31], a[160:163], v[208:211]
v_mfma_f32_16x16x32_bf16 v[212:215], a[28:31], a[164:167], v[212:215]
buffer_load_dwordx4 v19, s[28:31], s58 offen offset:1024 lds
v_mfma_f32_16x16x32_bf16 v[216:219], a[28:31], a[168:171], v[216:219]
s_add_u32 m0, s59, 91520
s_nop 3
v_fmac_f32 v208, v4, v20
v_fmac_f32 v209, v5, v20
v_mfma_f32_16x16x32_bf16 v[220:223], a[28:31], a[172:175], v[220:223]
s_mov_b32 s58, 1441792
v_fmac_f32 v210, v6, v20
v_fmac_f32 v211, v7, v20
v_mfma_f32_16x16x32_bf16 v[160:163], a[64:67], a[176:179], v[160:163]
v_fmac_f32 v212, v4, v22
v_fmac_f32 v213, v5, v22
v_mfma_f32_16x16x32_bf16 v[164:167], a[64:67], a[180:183], v[164:167]
buffer_load_dwordx4 v18, s[28:31], s58 offen lds
v_mfma_f32_16x16x32_bf16 v[168:171], a[64:67], a[184:187], v[168:171]
v_fmac_f32 v214, v6, v22
v_fmac_f32 v215, v7, v22
v_mfma_f32_16x16x32_bf16 v[172:175], a[64:67], a[188:191], v[172:175]
v_fmac_f32 v216, v4, v24
v_fmac_f32 v217, v5, v24
v_mfma_f32_16x16x32_bf16 v[176:179], a[68:71], a[176:179], v[176:179]
v_fmac_f32 v218, v6, v24
v_fmac_f32 v219, v7, v24
v_mfma_f32_16x16x32_bf16 v[180:183], a[68:71], a[180:183], v[180:183]
buffer_load_dwordx4 v19, s[28:31], s58 offen offset:1024 lds
v_mfma_f32_16x16x32_bf16 v[184:187], a[68:71], a[184:187], v[184:187]
s_add_u32 m0, s59, 99840
v_fmac_f32 v220, v4, v26
v_fmac_f32 v221, v5, v26
v_mfma_f32_16x16x32_bf16 v[188:191], a[68:71], a[188:191], v[188:191]
s_mov_b32 s58, 1572864
v_fmac_f32 v222, v6, v26
v_fmac_f32 v223, v7, v26
v_mfma_f32_16x16x32_bf16 v[192:195], a[72:75], a[176:179], v[192:195]
ds_read_b128 v[4:7], v8 offset:64
v_mfma_f32_16x16x32_bf16 v[196:199], a[72:75], a[180:183], v[196:199]
buffer_load_dwordx4 v18, s[28:31], s58 offen lds
v_mfma_f32_16x16x32_bf16 v[200:203], a[72:75], a[184:187], v[200:203]
v_mfma_f32_16x16x32_bf16 v[204:207], a[72:75], a[188:191], v[204:207]
v_mfma_f32_16x16x32_bf16 v[208:211], a[76:79], a[176:179], v[208:211]
v_mfma_f32_16x16x32_bf16 v[212:215], a[76:79], a[180:183], v[212:215]
buffer_load_dwordx4 v19, s[28:31], s58 offen offset:1024 lds
v_mfma_f32_16x16x32_bf16 v[216:219], a[76:79], a[184:187], v[216:219]
s_add_u32 m0, s59, 108160
s_mov_b32 s58, 1703936
v_mfma_f32_16x16x32_bf16 v[220:223], a[76:79], a[188:191], v[220:223]
v_mfma_f32_16x16x32_bf16 v[224:227], a[48:51], a[128:131], v[224:227]
buffer_load_dwordx4 v18, s[28:31], s58 offen lds
v_pk_mul_f32 v[192:193], v[192:193], v[160:161]
v_pk_mul_f32 v[160:161], v[160:161], v[28:29] op_sel_hi:[1,0]
v_exp_f32 v160, v160
v_pk_mul_f32 v[194:195], v[194:195], v[162:163]
v_exp_f32 v161, v161
v_pk_mul_f32 v[162:163], v[162:163], v[28:29] op_sel_hi:[1,0]
v_exp_f32 v162, v162
v_pk_mul_f32 v[208:209], v[208:209], v[176:177]
v_exp_f32 v163, v163
v_pk_mul_f32 v[176:177], v[176:177], v[28:29] op_sel_hi:[1,0]
v_exp_f32 v176, v176
v_pk_mul_f32 v[210:211], v[210:211], v[178:179]
v_exp_f32 v177, v177
v_pk_mul_f32 v[178:179], v[178:179], v[28:29] op_sel_hi:[1,0]
v_exp_f32 v178, v178
v_pk_fma_f32 v[160:161], v[160:161], v[20:21], v[20:21] op_sel:[0,1,1] op_sel_hi:[1,1,1]
v_exp_f32 v179, v179
v_pk_fma_f32 v[162:163], v[162:163], v[20:21], v[20:21] op_sel:[0,1,1] op_sel_hi:[1,1,1]
v_rcp_f32 v160, v160
v_pk_fma_f32 v[176:177], v[176:177], v[20:21], v[20:21] op_sel:[0,1,1] op_sel_hi:[1,1,1]
v_rcp_f32 v161, v161
v_pk_fma_f32 v[178:179], v[178:179], v[20:21], v[20:21] op_sel:[0,1,1] op_sel_hi:[1,1,1]
v_rcp_f32 v162, v162
v_pk_mul_f32 v[192:193], v[192:193], v[160:161]
v_rcp_f32 v163, v163
v_cvt_pk_bf16_f32 v160, v192, v193
v_rcp_f32 v176, v176
v_pk_mul_f32 v[194:195], v[194:195], v[162:163]
v_rcp_f32 v177, v177
v_cvt_pk_bf16_f32 v161, v194, v195
v_rcp_f32 v178, v178
v_pk_mul_f32 v[208:209], v[208:209], v[176:177]
v_rcp_f32 v179, v179
v_cvt_pk_bf16_f32 v162, v208, v209
v_pk_mul_f32 v[196:197], v[196:197], v[164:165]
v_pk_mul_f32 v[210:211], v[210:211], v[178:179]
v_cvt_pk_bf16_f32 v163, v210, v211
buffer_store_dwordx4 v[160:163], v10, s[16:19], s64 offen sc1
v_pk_mul_f32 v[164:165], v[164:165], v[28:29] op_sel:[0,1] op_sel_hi:[1,1]
v_exp_f32 v164, v164
v_pk_mul_f32 v[198:199], v[198:199], v[166:167]
v_exp_f32 v165, v165
v_pk_mul_f32 v[166:167], v[166:167], v[28:29] op_sel:[0,1] op_sel_hi:[1,1]
v_exp_f32 v166, v166
v_pk_mul_f32 v[212:213], v[212:213], v[180:181]
v_exp_f32 v167, v167
v_pk_mul_f32 v[180:181], v[180:181], v[28:29] op_sel:[0,1] op_sel_hi:[1,1]
v_exp_f32 v180, v180
v_pk_mul_f32 v[214:215], v[214:215], v[182:183]
v_exp_f32 v181, v181
v_pk_mul_f32 v[182:183], v[182:183], v[28:29] op_sel:[0,1] op_sel_hi:[1,1]
v_exp_f32 v182, v182
v_pk_fma_f32 v[164:165], v[164:165], v[22:23], v[22:23] op_sel:[0,1,1] op_sel_hi:[1,1,1]
v_exp_f32 v183, v183
v_pk_fma_f32 v[166:167], v[166:167], v[22:23], v[22:23] op_sel:[0,1,1] op_sel_hi:[1,1,1]
v_rcp_f32 v164, v164
v_pk_fma_f32 v[180:181], v[180:181], v[22:23], v[22:23] op_sel:[0,1,1] op_sel_hi:[1,1,1]
v_rcp_f32 v165, v165
v_pk_fma_f32 v[182:183], v[182:183], v[22:23], v[22:23] op_sel:[0,1,1] op_sel_hi:[1,1,1]
v_rcp_f32 v166, v166
v_pk_mul_f32 v[196:197], v[196:197], v[164:165]
v_rcp_f32 v167, v167
v_cvt_pk_bf16_f32 v164, v196, v197
v_rcp_f32 v180, v180
v_pk_mul_f32 v[198:199], v[198:199], v[166:167]
v_rcp_f32 v181, v181
v_cvt_pk_bf16_f32 v165, v198, v199
v_rcp_f32 v182, v182
v_pk_mul_f32 v[212:213], v[212:213], v[180:181]
v_rcp_f32 v183, v183
v_cvt_pk_bf16_f32 v166, v212, v213
v_pk_mul_f32 v[200:201], v[200:201], v[168:169]
v_pk_mul_f32 v[214:215], v[214:215], v[182:183]
v_cvt_pk_bf16_f32 v167, v214, v215
buffer_store_dwordx4 v[164:167], v10, s[16:19], s64 offen offset:1024 sc1
v_pk_mul_f32 v[168:169], v[168:169], v[30:31] op_sel_hi:[1,0]
v_exp_f32 v168, v168
v_pk_mul_f32 v[202:203], v[202:203], v[170:171]
v_exp_f32 v169, v169
v_pk_mul_f32 v[170:171], v[170:171], v[30:31] op_sel_hi:[1,0]
v_exp_f32 v170, v170
v_pk_mul_f32 v[216:217], v[216:217], v[184:185]
v_exp_f32 v171, v171
v_pk_mul_f32 v[184:185], v[184:185], v[30:31] op_sel_hi:[1,0]
v_exp_f32 v184, v184
v_pk_mul_f32 v[218:219], v[218:219], v[186:187]
v_exp_f32 v185, v185
v_pk_mul_f32 v[186:187], v[186:187], v[30:31] op_sel_hi:[1,0]
v_exp_f32 v186, v186
v_pk_fma_f32 v[168:169], v[168:169], v[24:25], v[24:25] op_sel:[0,1,1] op_sel_hi:[1,1,1]
v_exp_f32 v187, v187
v_pk_fma_f32 v[170:171], v[170:171], v[24:25], v[24:25] op_sel:[0,1,1] op_sel_hi:[1,1,1]
v_rcp_f32 v168, v168
v_pk_fma_f32 v[184:185], v[184:185], v[24:25], v[24:25] op_sel:[0,1,1] op_sel_hi:[1,1,1]
v_rcp_f32 v169, v169
v_pk_fma_f32 v[186:187], v[186:187], v[24:25], v[24:25] op_sel:[0,1,1] op_sel_hi:[1,1,1]
v_rcp_f32 v170, v170
v_pk_mul_f32 v[200:201], v[200:201], v[168:169]
v_rcp_f32 v171, v171
v_cvt_pk_bf16_f32 v168, v200, v201
v_rcp_f32 v184, v184
v_pk_mul_f32 v[202:203], v[202:203], v[170:171]
v_rcp_f32 v185, v185
v_cvt_pk_bf16_f32 v169, v202, v203
v_rcp_f32 v186, v186
v_pk_mul_f32 v[216:217], v[216:217], v[184:185]
v_rcp_f32 v187, v187
v_cvt_pk_bf16_f32 v170, v216, v217
v_pk_mul_f32 v[204:205], v[204:205], v[172:173]
v_pk_mul_f32 v[218:219], v[218:219], v[186:187]
v_cvt_pk_bf16_f32 v171, v218, v219
buffer_store_dwordx4 v[168:171], v11, s[16:19], s64 offen sc1
v_pk_mul_f32 v[172:173], v[172:173], v[30:31] op_sel:[0,1] op_sel_hi:[1,1]
v_exp_f32 v172, v172
v_pk_mul_f32 v[206:207], v[206:207], v[174:175]
v_exp_f32 v173, v173
v_pk_mul_f32 v[174:175], v[174:175], v[30:31] op_sel:[0,1] op_sel_hi:[1,1]
v_exp_f32 v174, v174
v_pk_mul_f32 v[220:221], v[220:221], v[188:189]
v_exp_f32 v175, v175
v_pk_mul_f32 v[188:189], v[188:189], v[30:31] op_sel:[0,1] op_sel_hi:[1,1]
v_exp_f32 v188, v188
v_pk_mul_f32 v[222:223], v[222:223], v[190:191]
v_exp_f32 v189, v189
v_pk_mul_f32 v[190:191], v[190:191], v[30:31] op_sel:[0,1] op_sel_hi:[1,1]
v_exp_f32 v190, v190
v_pk_fma_f32 v[172:173], v[172:173], v[26:27], v[26:27] op_sel:[0,1,1] op_sel_hi:[1,1,1]
v_exp_f32 v191, v191
v_pk_fma_f32 v[174:175], v[174:175], v[26:27], v[26:27] op_sel:[0,1,1] op_sel_hi:[1,1,1]
v_rcp_f32 v172, v172
v_pk_fma_f32 v[188:189], v[188:189], v[26:27], v[26:27] op_sel:[0,1,1] op_sel_hi:[1,1,1]
v_rcp_f32 v173, v173
v_pk_fma_f32 v[190:191], v[190:191], v[26:27], v[26:27] op_sel:[0,1,1] op_sel_hi:[1,1,1]
v_rcp_f32 v174, v174
v_pk_mul_f32 v[204:205], v[204:205], v[172:173]
v_rcp_f32 v175, v175
v_cvt_pk_bf16_f32 v172, v204, v205
v_rcp_f32 v188, v188
v_pk_mul_f32 v[206:207], v[206:207], v[174:175]
v_rcp_f32 v189, v189
v_cvt_pk_bf16_f32 v173, v206, v207
v_rcp_f32 v190, v190
v_pk_mul_f32 v[220:221], v[220:221], v[188:189]
v_rcp_f32 v191, v191
v_cvt_pk_bf16_f32 v174, v220, v221
v_pk_mul_f32 v[222:223], v[222:223], v[190:191]
s_nop 1
v_mfma_f32_16x16x32_bf16 v[228:231], a[48:51], a[132:135], v[228:231]
.Lpad13:
s_cbranch_execz .Lnopoll20r
buffer_load_dwordx4 v19, s[28:31], s58 offen offset:1024 lds
v_mfma_f32_16x16x32_bf16 v[232:235], a[52:55], a[128:131], v[232:235]
s_add_u32 m0, s59, 116480
s_waitcnt lgkmcnt(1)
v_fmac_f32 v224, v12, v20
v_fmac_f32 v225, v13, v20
v_mfma_f32_16x16x32_bf16 v[236:239], a[52:55], a[132:135], v[236:239]
s_mov_b32 s58, 1835008
v_fmac_f32 v226, v14, v20
v_fmac_f32 v227, v15, v20
v_mfma_f32_16x16x32_bf16 v[240:243], a[56:59], a[128:131], v[240:243]
v_fmac_f32 v228, v12, v22
v_fmac_f32 v229, v13, v22
v_mfma_f32_16x16x32_bf16 v[244:247], a[56:59], a[132:135], v[244:247]
buffer_load_dwordx4 v18, s[28:31], s58 offen lds
v_mfma_f32_16x16x32_bf16 v[248:251], a[60:63], a[128:131], v[248:251]
v_fmac_f32 v230, v14, v22
v_fmac_f32 v231, v15, v22
v_mfma_f32_16x16x32_bf16 v[252:255], a[60:63], a[132:135], v[252:255]
ds_read_b128 v[12:15], v8 offset:512
s_waitcnt lgkmcnt(1)
v_fmac_f32 v232, v4, v20
v_mfma_f32_16x16x32_bf16 v[224:227], a[80:83], a[144:147], v[224:227]
v_fmac_f32 v233, v5, v20
v_fmac_f32 v234, v6, v20
v_mfma_f32_16x16x32_bf16 v[228:231], a[80:83], a[148:151], v[228:231]
buffer_load_dwordx4 v19, s[28:31], s58 offen offset:1024 lds
v_mfma_f32_16x16x32_bf16 v[240:243], a[88:91], a[144:147], v[240:243]
s_add_u32 m0, s59, 124800
v_fmac_f32 v235, v7, v20
v_fmac_f32 v236, v4, v22
v_mfma_f32_16x16x32_bf16 v[244:247], a[88:91], a[148:151], v[244:247]
s_mov_b32 s58, 1966080
v_fmac_f32 v237, v5, v22
v_fmac_f32 v238, v6, v22
v_mfma_f32_16x16x32_bf16 v[232:235], a[84:87], a[144:147], v[232:235]
v_fmac_f32 v239, v7, v22
v_cvt_pk_bf16_f32 v175, v222, v223
v_mfma_f32_16x16x32_bf16 v[248:251], a[92:95], a[144:147], v[248:251]
ds_read_b128 v[4:7], v8 offset:576
v_mfma_f32_16x16x32_bf16 v[236:239], a[84:87], a[148:151], v[236:239]
buffer_store_dwordx4 v[172:175], v11, s[16:19], s64 offen offset:1024 sc1
v_mfma_f32_16x16x32_bf16 v[252:255], a[92:95], a[148:151], v[252:255]
s_waitcnt lgkmcnt(1)
v_fmac_f32 v240, v12, v20
v_fmac_f32 v241, v13, v20
v_mfma_f32_16x16x32_bf16 v[224:227], a[32:35], a[160:163], v[224:227]
v_fmac_f32 v242, v14, v20
v_fmac_f32 v243, v15, v20
v_mfma_f32_16x16x32_bf16 v[228:231], a[32:35], a[164:167], v[228:231]
v_fmac_f32 v244, v12, v22
v_fmac_f32 v245, v13, v22
v_mfma_f32_16x16x32_bf16 v[232:235], a[36:39], a[160:163], v[232:235]
buffer_load_dwordx4 v18, s[28:31], s58 offen lds
v_mfma_f32_16x16x32_bf16 v[236:239], a[36:39], a[164:167], v[236:239]
v_fmac_f32 v246, v14, v22
v_fmac_f32 v247, v15, v22
v_mfma_f32_16x16x32_bf16 v[240:243], a[40:43], a[160:163], v[240:243]
s_nop 0
v_mfma_f32_16x16x32_bf16 v[244:247], a[40:43], a[164:167], v[244:247]
v_mfma_f32_16x16x32_bf16 v[248:251], a[44:47], a[160:163], v[248:251]
buffer_load_dwordx4 v19, s[28:31], s58 offen offset:1024 lds
v_mfma_f32_16x16x32_bf16 v[252:255], a[44:47], a[164:167], v[252:255]
v_mfma_f32_16x16x32_bf16 v[224:227], a[0:3], a[176:179], v[224:227]
s_nop 3
s_waitcnt lgkmcnt(0)
v_fmac_f32 v248, v4, v20
v_fmac_f32 v249, v5, v20
v_mfma_f32_16x16x32_bf16 v[228:231], a[0:3], a[180:183], v[228:231]
v_fmac_f32 v250, v6, v20
v_fmac_f32 v251, v7, v20
v_mfma_f32_16x16x32_bf16 v[232:235], a[4:7], a[176:179], v[232:235]
v_fmac_f32 v252, v4, v22
v_fmac_f32 v253, v5, v22
v_mfma_f32_16x16x32_bf16 v[236:239], a[4:7], a[180:183], v[236:239]
v_fmac_f32 v254, v6, v22
v_fmac_f32 v255, v7, v22
v_mfma_f32_16x16x32_bf16 v[240:243], a[8:11], a[176:179], v[240:243]
v_mfma_f32_16x16x32_bf16 v[244:247], a[8:11], a[180:183], v[244:247]
v_mfma_f32_16x16x32_bf16 v[248:251], a[12:15], a[176:179], v[248:251]
v_mfma_f32_16x16x32_bf16 v[252:255], a[12:15], a[180:183], v[252:255]
s_nop 4
v_pk_mul_f32 v[240:241], v[240:241], v[224:225]
v_pk_mul_f32 v[224:225], v[224:225], v[28:29] op_sel_hi:[1,0]
v_exp_f32 v224, v224
v_pk_mul_f32 v[242:243], v[242:243], v[226:227]
v_exp_f32 v225, v225
v_pk_mul_f32 v[226:227], v[226:227], v[28:29] op_sel_hi:[1,0]
v_exp_f32 v226, v226
v_pk_mul_f32 v[248:249], v[248:249], v[232:233]
v_exp_f32 v227, v227
v_pk_mul_f32 v[232:233], v[232:233], v[28:29] op_sel_hi:[1,0]
v_exp_f32 v232, v232
v_pk_mul_f32 v[250:251], v[250:251], v[234:235]
v_exp_f32 v233, v233
v_pk_mul_f32 v[234:235], v[234:235], v[28:29] op_sel_hi:[1,0]
v_exp_f32 v234, v234
v_pk_fma_f32 v[224:225], v[224:225], v[20:21], v[20:21] op_sel:[0,1,1] op_sel_hi:[1,1,1]
v_exp_f32 v235, v235
v_pk_fma_f32 v[226:227], v[226:227], v[20:21], v[20:21] op_sel:[0,1,1] op_sel_hi:[1,1,1]
v_rcp_f32 v224, v224
v_pk_fma_f32 v[232:233], v[232:233], v[20:21], v[20:21] op_sel:[0,1,1] op_sel_hi:[1,1,1]
v_rcp_f32 v225, v225
v_pk_fma_f32 v[234:235], v[234:235], v[20:21], v[20:21] op_sel:[0,1,1] op_sel_hi:[1,1,1]
v_rcp_f32 v226, v226
v_pk_mul_f32 v[240:241], v[240:241], v[224:225]
v_rcp_f32 v227, v227
v_cvt_pk_bf16_f32 v224, v240, v241
v_rcp_f32 v232, v232
v_pk_mul_f32 v[242:243], v[242:243], v[226:227]
v_rcp_f32 v233, v233
v_cvt_pk_bf16_f32 v225, v242, v243
v_rcp_f32 v234, v234
v_pk_mul_f32 v[248:249], v[248:249], v[232:233]
v_rcp_f32 v235, v235
v_cvt_pk_bf16_f32 v226, v248, v249
v_pk_mul_f32 v[244:245], v[244:245], v[228:229]
v_pk_mul_f32 v[250:251], v[250:251], v[234:235]
v_cvt_pk_bf16_f32 v227, v250, v251
buffer_store_dwordx4 v[224:227], v10, s[16:19], s65 offen sc1
v_pk_mul_f32 v[228:229], v[228:229], v[28:29] op_sel:[0,1] op_sel_hi:[1,1]
v_exp_f32 v228, v228
v_pk_mul_f32 v[246:247], v[246:247], v[230:231]
v_exp_f32 v229, v229
v_pk_mul_f32 v[230:231], v[230:231], v[28:29] op_sel:[0,1] op_sel_hi:[1,1]
v_exp_f32 v230, v230
v_pk_mul_f32 v[252:253], v[252:253], v[236:237]
v_exp_f32 v231, v231
v_pk_mul_f32 v[236:237], v[236:237], v[28:29] op_sel:[0,1] op_sel_hi:[1,1]
v_exp_f32 v236, v236
v_pk_mul_f32 v[254:255], v[254:255], v[238:239]
v_exp_f32 v237, v237
v_pk_mul_f32 v[238:239], v[238:239], v[28:29] op_sel:[0,1] op_sel_hi:[1,1]
v_exp_f32 v238, v238
v_pk_fma_f32 v[228:229], v[228:229], v[22:23], v[22:23] op_sel:[0,1,1] op_sel_hi:[1,1,1]
v_exp_f32 v239, v239
v_pk_fma_f32 v[230:231], v[230:231], v[22:23], v[22:23] op_sel:[0,1,1] op_sel_hi:[1,1,1]
v_rcp_f32 v228, v228
v_pk_fma_f32 v[236:237], v[236:237], v[22:23], v[22:23] op_sel:[0,1,1] op_sel_hi:[1,1,1]
v_rcp_f32 v229, v229
v_pk_fma_f32 v[238:239], v[238:239], v[22:23], v[22:23] op_sel:[0,1,1] op_sel_hi:[1,1,1]
v_rcp_f32 v230, v230
v_pk_mul_f32 v[244:245], v[244:245], v[228:229]
v_rcp_f32 v231, v231
v_cvt_pk_bf16_f32 v228, v244, v245
v_rcp_f32 v236, v236
v_pk_mul_f32 v[246:247], v[246:247], v[230:231]
v_rcp_f32 v237, v237
v_cvt_pk_bf16_f32 v229, v246, v247
v_rcp_f32 v238, v238
v_pk_mul_f32 v[252:253], v[252:253], v[236:237]
v_rcp_f32 v239, v239
v_cvt_pk_bf16_f32 v230, v252, v253
v_pk_mul_f32 v[254:255], v[254:255], v[238:239]
v_cvt_pk_bf16_f32 v231, v254, v255
buffer_store_dwordx4 v[228:231], v10, s[16:19], s65 offen offset:1024 sc1
s_nop 1
s_lshl_b32 s62, s5, 2
s_add_u32 s62, s62, s3
s_lshl_b32 s62, s62, 13
s_and_b32 s63, s7, 8
s_lshl_b32 s63, s63, 7
s_add_u32 s62, s62, s63
s_lshr_b32 s63, s28, 7
s_sub_u32 s63, 3, s63
s_and_b32 s63, s63, 7
s_lshl_b32 s63, s63, 7
s_add_u32 s62, s62, s63
v_lshrrev_b32 v9, 4, v1
v_lshl_add_u32 v9, v9, 11, s62
s_mov_b32 s44, 2097152
buffer_load_dword v27, v9, s[28:31], s44 offen
s_add_u32 s44, s44, 0x100000
s_lshl_b32 s62, s6, 13
s_lshl_b32 s63, s3, 11
s_add_u32 s62, s62, s63
v_lshl_add_u32 v4, v1, 4, s62
v_lshrrev_b32 v2, 3, v1
v_cmp_eq_u32 vcc, 3, v2
v_add_u32 v2, 67108480, v4
s_nop 0
v_cndmask_b32 v4, v4, v2, vcc
v_bfe_u32 v5, v1, 3, 1
v_lshrrev_b32 v2, 4, v1
v_lshl_add_u32 v5, v2, 3, v5
s_lshl_b32 s62, s3, 1
v_add_u32 v5, s62, v5
v_mul_u32_u24 v5, 2048, v5
v_and_b32 v2, 7, v1
v_lshl_add_u32 v5, v2, 4, v5
s_lshl_b32 s62, s7, 7
v_add_u32 v5, s62, v5
v_add_u32 v6, 64512, v5
v_bfe_u32 v8, v1, 3, 2
v_mul_u32_u24 v8, 2080, v8
v_bfe_u32 v2, v1, 2, 1
v_lshl_add_u32 v8, v2, 7, v8
v_bfe_u32 v2, v1, 5, 1
v_lshl_add_u32 v8, v2, 8, v8
v_and_b32 v2, 3, v1
v_lshl_add_u32 v8, v2, 3, v8
s_mov_b32 s57, 0
v_add_u32 v7, s57, v8
s_mov_b32 s52, 12582912
s_mov_b32 s53, 12713984
s_mov_b32 s54, 2097152
s_mul_i32 s56, s3, 2080
v_accvgpr_read_b32 v32, a224
v_accvgpr_read_b32 v33, a225
v_accvgpr_read_b32 v34, a226
v_accvgpr_read_b32 v35, a227
v_accvgpr_read_b32 v36, a228
v_accvgpr_read_b32 v37, a229
v_accvgpr_read_b32 v38, a230
v_accvgpr_read_b32 v39, a231
v_accvgpr_read_b32 v40, a232
v_accvgpr_read_b32 v41, a233
v_accvgpr_read_b32 v42, a234
v_accvgpr_read_b32 v43, a235
v_accvgpr_read_b32 v44, a236
v_accvgpr_read_b32 v45, a237
v_accvgpr_read_b32 v46, a238
v_accvgpr_read_b32 v47, a239
v_accvgpr_read_b32 v48, a240
v_accvgpr_read_b32 v49, a241
v_accvgpr_read_b32 v50, a242
v_accvgpr_read_b32 v51, a243
v_accvgpr_read_b32 v52, a244
v_accvgpr_read_b32 v53, a245
v_accvgpr_read_b32 v54, a246
v_accvgpr_read_b32 v55, a247
v_accvgpr_read_b32 v56, a248
v_accvgpr_read_b32 v57, a249
v_accvgpr_read_b32 v58, a250
v_accvgpr_read_b32 v59, a251
v_accvgpr_read_b32 v60, a252
v_accvgpr_read_b32 v61, a253
v_accvgpr_read_b32 v62, a254
v_accvgpr_read_b32 v63, a255
v_bfe_u32 v18, v1, 3, 1
v_lshrrev_b32 v2, 4, v1
v_lshl_add_u32 v18, v2, 3, v18
s_lshl_b32 s62, s3, 1
v_add_u32 v18, s62, v18
v_mul_u32_u24 v18, 6144, v18
v_and_b32 v2, 7, v1
v_lshl_add_u32 v18, v2, 4, v18
s_lshl_b32 s62, s9, 7
v_add_u32 v18, s62, v18
v_add_u32 v19, 1024, v18
v_add_u32 v20, 2048, v18
s_mul_i32 s59, s3, 3104
s_mov_b32 s58, 0
s_lshl_b32 s62, s10, 1
s_add_u32 s62, s62, s12
s_lshl_b32 s62, s62, 7
s_add_u32 s62, s62, 30414848
s_and_b32 s64, s6, 14
s_lshl_b32 s64, s64, 7
s_add_u32 s64, s64, 30414848
s_add_u32 s65, s64, 128
v_mov_b32 v252, s62
v_mov_b32 v253, s64
v_writelane_b32 v253, s65, 1
s_waitcnt vmcnt(0) lgkmcnt(0)
s_barrier
s_cmp_lg_u32 s3, 0
s_cbranch_scc1 .Lnosig22
v_mov_b32 v255, 1
s_mov_b64 exec, 1
buffer_atomic_add v255, v252, s[16:19], 0 offen
s_mov_b64 exec, -1
.Lnosig22:
ds_read_b64_tr_b16 a[0:1], v7
ds_read_b64_tr_b16 a[2:3], v7 offset:512
ds_read_b64_tr_b16 a[4:5], v7 offset:32
ds_read_b64_tr_b16 a[6:7], v7 offset:544
ds_read_b64_tr_b16 a[8:9], v7 offset:64
ds_read_b64_tr_b16 a[10:11], v7 offset:576
ds_read_b64_tr_b16 a[12:13], v7 offset:96
ds_read_b64_tr_b16 a[14:15], v7 offset:608
ds_read_b64_tr_b16 a[16:17], v7 offset:1024
ds_read_b64_tr_b16 a[18:19], v7 offset:1536
ds_read_b64_tr_b16 a[20:21], v7 offset:1056
ds_read_b64_tr_b16 a[22:23], v7 offset:1568
ds_read_b64_tr_b16 a[24:25], v7 offset:1088
ds_read_b64_tr_b16 a[26:27], v7 offset:1600
ds_read_b64_tr_b16 a[28:29], v7 offset:1120
ds_read_b64_tr_b16 a[30:31], v7 offset:1632
s_waitcnt lgkmcnt(0)
s_cmp_lg_u32 s3, 1
s_cbranch_scc1 .Lnopoll25
s_mov_b64 exec, 3
s_mov_b32 s15, 0
.Lpoll23:
buffer_load_dword v255, v253, s[16:19], 0 offen sc1
s_add_u32 s15, s15, 1
s_cmp_gt_u32 s15, 100000
s_cbranch_scc1 .Lgot24
s_waitcnt vmcnt(0)
v_cmp_ne_u32 vcc, 16, v255
s_nop 0
s_cbranch_vccnz .Lpoll23
.Lgot24:
s_waitcnt vmcnt(0)
s_branch .Lnopoll25r
.Lnopoll25:
s_mov_b64 exec, 0
s_cmp_eq_u32 s3, 2
s_cbranch_scc1 .Lpad14
s_cmp_eq_u32 s3, 3
s_cbranch_scc1 .Lpad15
s_branch .Lpad16
.Lnopoll25r:
s_mov_b64 exec, -1
s_barrier
buffer_load_dwordx4 v[64:67], v4, s[16:19], s52 offen sc1
buffer_load_dwordx4 v[68:71], v4, s[16:19], s52 offen offset:1024 sc1
s_add_u32 s52, s52, 0x40000
buffer_load_dwordx4 v[72:75], v4, s[16:19], s53 offen sc1
buffer_load_dwordx4 v[76:79], v4, s[16:19], s53 offen offset:1024 sc1
s_add_u32 s53, s53, 0x40000
buffer_load_dwordx4 v[80:83], v4, s[16:19], s52 offen sc1
buffer_load_dwordx4 v[84:87], v4, s[16:19], s52 offen offset:1024 sc1
s_add_u32 s52, s52, 0x40000
buffer_load_dwordx4 v[88:91], v4, s[16:19], s53 offen sc1
buffer_load_dwordx4 v[92:95], v4, s[16:19], s53 offen offset:1024 sc1
s_add_u32 s53, s53, 0x40000
buffer_load_dwordx4 v[96:99], v4, s[16:19], s52 offen sc1
buffer_load_dwordx4 v[100:103], v4, s[16:19], s52 offen offset:1024 sc1
s_add_u32 s52, s52, 0x40000
buffer_load_dwordx4 v[104:107], v4, s[16:19], s53 offen sc1
buffer_load_dwordx4 v[108:111], v4, s[16:19], s53 offen offset:1024 sc1
s_add_u32 s53, s53, 0x40000
s_mov_b32 s15, 5
.p2align 6
.Lk26:
s_waitcnt lgkmcnt(0)
s_barrier
s_add_u32 s55, s56, s57
s_waitcnt vmcnt(11)
v_mfma_f32_16x16x32_bf16 v[32:35], a[0:3], v[64:67], v[32:35]
ds_read_b64_tr_b16 a[32:33], v7 offset:8320
ds_read_b64_tr_b16 a[34:35], v7 offset:8832
s_add_u32 m0, s55, 0
s_waitcnt vmcnt(10)
v_mfma_f32_16x16x32_bf16 v[48:51], a[0:3], v[68:71], v[48:51]
ds_read_b64_tr_b16 a[36:37], v7 offset:8352
buffer_load_dwordx4 v5, s[28:31], s54 offen lds
v_mfma_f32_16x16x32_bf16 v[36:39], a[4:7], v[64:67], v[36:39]
ds_read_b64_tr_b16 a[38:39], v7 offset:8864
ds_read_b64_tr_b16 a[40:41], v7 offset:8384
v_mfma_f32_16x16x32_bf16 v[52:55], a[4:7], v[68:71], v[52:55]
ds_read_b64_tr_b16 a[42:43], v7 offset:8896
buffer_load_dwordx4 v[112:115], v4, s[16:19], s52 offen sc1
v_mfma_f32_16x16x32_bf16 v[40:43], a[8:11], v[64:67], v[40:43]
ds_read_b64_tr_b16 a[44:45], v7 offset:8416
ds_read_b64_tr_b16 a[46:47], v7 offset:8928
v_mfma_f32_16x16x32_bf16 v[56:59], a[8:11], v[68:71], v[56:59]
ds_read_b64_tr_b16 a[48:49], v7 offset:9344
buffer_load_dwordx4 v[116:119], v4, s[16:19], s52 offen offset:1024 sc1
v_mfma_f32_16x16x32_bf16 v[44:47], a[12:15], v[64:67], v[44:47]
ds_read_b64_tr_b16 a[50:51], v7 offset:9856
ds_read_b64_tr_b16 a[52:53], v7 offset:9376
s_add_u32 s52, s52, 0x40000
v_mfma_f32_16x16x32_bf16 v[60:63], a[12:15], v[68:71], v[60:63]
ds_read_b64_tr_b16 a[54:55], v7 offset:9888
ds_read_b64_tr_b16 a[56:57], v7 offset:9408
s_waitcnt vmcnt(12)
v_mfma_f32_16x16x32_bf16 v[32:35], a[16:19], v[72:75], v[32:35]
ds_read_b64_tr_b16 a[58:59], v7 offset:9920
buffer_load_dwordx4 v6, s[28:31], s54 offen offset:1024 lds
s_waitcnt vmcnt(12)
v_mfma_f32_16x16x32_bf16 v[48:51], a[16:19], v[76:79], v[48:51]
ds_read_b64_tr_b16 a[60:61], v7 offset:9440
ds_read_b64_tr_b16 a[62:63], v7 offset:9952
s_add_u32 s54, s54, 0x20000
v_mfma_f32_16x16x32_bf16 v[36:39], a[20:23], v[72:75], v[36:39]
buffer_load_dwordx4 v[120:123], v4, s[16:19], s53 offen sc1
v_mfma_f32_16x16x32_bf16 v[52:55], a[20:23], v[76:79], v[52:55]
v_mfma_f32_16x16x32_bf16 v[40:43], a[24:27], v[72:75], v[40:43]
buffer_load_dwordx4 v[124:127], v4, s[16:19], s53 offen offset:1024 sc1
v_mfma_f32_16x16x32_bf16 v[56:59], a[24:27], v[76:79], v[56:59]
s_add_u32 s53, s53, 0x40000
v_mfma_f32_16x16x32_bf16 v[44:47], a[28:31], v[72:75], v[44:47]
v_mfma_f32_16x16x32_bf16 v[60:63], a[28:31], v[76:79], v[60:63]
s_waitcnt lgkmcnt(0)
s_barrier
s_waitcnt vmcnt(13)
v_mfma_f32_16x16x32_bf16 v[32:35], a[32:35], v[80:83], v[32:35]
ds_read_b64_tr_b16 a[0:1], v7 offset:16640
ds_read_b64_tr_b16 a[2:3], v7 offset:17152
s_add_u32 m0, s55, 8320
s_waitcnt vmcnt(12)
v_mfma_f32_16x16x32_bf16 v[48:51], a[32:35], v[84:87], v[48:51]
ds_read_b64_tr_b16 a[4:5], v7 offset:16672
buffer_load_dwordx4 v5, s[28:31], s54 offen lds
v_mfma_f32_16x16x32_bf16 v[36:39], a[36:39], v[80:83], v[36:39]
ds_read_b64_tr_b16 a[6:7], v7 offset:17184
ds_read_b64_tr_b16 a[8:9], v7 offset:16704
v_mfma_f32_16x16x32_bf16 v[52:55], a[36:39], v[84:87], v[52:55]
ds_read_b64_tr_b16 a[10:11], v7 offset:17216
buffer_load_dwordx4 v[64:67], v4, s[16:19], s52 offen sc1
v_mfma_f32_16x16x32_bf16 v[40:43], a[40:43], v[80:83], v[40:43]
ds_read_b64_tr_b16 a[12:13], v7 offset:16736
ds_read_b64_tr_b16 a[14:15], v7 offset:17248
v_mfma_f32_16x16x32_bf16 v[56:59], a[40:43], v[84:87], v[56:59]
ds_read_b64_tr_b16 a[16:17], v7 offset:17664
buffer_load_dwordx4 v[68:71], v4, s[16:19], s52 offen offset:1024 sc1
v_mfma_f32_16x16x32_bf16 v[44:47], a[44:47], v[80:83], v[44:47]
ds_read_b64_tr_b16 a[18:19], v7 offset:18176
ds_read_b64_tr_b16 a[20:21], v7 offset:17696
s_add_u32 s52, s52, 0x40000
v_mfma_f32_16x16x32_bf16 v[60:63], a[44:47], v[84:87], v[60:63]
ds_read_b64_tr_b16 a[22:23], v7 offset:18208
buffer_load_dwordx4 v6, s[28:31], s54 offen offset:1024 lds
s_waitcnt vmcnt(15)
v_mfma_f32_16x16x32_bf16 v[32:35], a[48:51], v[88:91], v[32:35]
ds_read_b64_tr_b16 a[24:25], v7 offset:17728
ds_read_b64_tr_b16 a[26:27], v7 offset:18240
s_add_u32 s54, s54, 0x20000
s_waitcnt vmcnt(14)
v_mfma_f32_16x16x32_bf16 v[48:51], a[48:51], v[92:95], v[48:51]
ds_read_b64_tr_b16 a[28:29], v7 offset:17760
buffer_load_dwordx4 v[72:75], v4, s[16:19], s53 offen sc1
v_mfma_f32_16x16x32_bf16 v[36:39], a[52:55], v[88:91], v[36:39]
ds_read_b64_tr_b16 a[30:31], v7 offset:18272
v_mfma_f32_16x16x32_bf16 v[52:55], a[52:55], v[92:95], v[52:55]
buffer_load_dwordx4 v[76:79], v4, s[16:19], s53 offen offset:1024 sc1
v_mfma_f32_16x16x32_bf16 v[40:43], a[56:59], v[88:91], v[40:43]
s_add_u32 s53, s53, 0x40000
v_mfma_f32_16x16x32_bf16 v[56:59], a[56:59], v[92:95], v[56:59]
buffer_load_dword v27, v9, s[28:31], s44 offen
v_mfma_f32_16x16x32_bf16 v[44:47], a[60:63], v[88:91], v[44:47]
s_add_u32 s44, s44, 0x100000
v_mfma_f32_16x16x32_bf16 v[60:63], a[60:63], v[92:95], v[60:63]
s_waitcnt lgkmcnt(0)
s_barrier
s_waitcnt vmcnt(16)
v_mfma_f32_16x16x32_bf16 v[32:35], a[0:3], v[96:99], v[32:35]
ds_read_b64_tr_b16 a[32:33], v7 offset:24960
ds_read_b64_tr_b16 a[34:35], v7 offset:25472
s_add_u32 m0, s55, 16640
s_waitcnt vmcnt(15)
v_mfma_f32_16x16x32_bf16 v[48:51], a[0:3], v[100:103], v[48:51]
ds_read_b64_tr_b16 a[36:37], v7 offset:24992
buffer_load_dwordx4 v5, s[28:31], s54 offen lds
v_mfma_f32_16x16x32_bf16 v[36:39], a[4:7], v[96:99], v[36:39]
ds_read_b64_tr_b16 a[38:39], v7 offset:25504
ds_read_b64_tr_b16 a[40:41], v7 offset:25024
v_mfma_f32_16x16x32_bf16 v[52:55], a[4:7], v[100:103], v[52:55]
ds_read_b64_tr_b16 a[42:43], v7 offset:25536
buffer_load_dwordx4 v[80:83], v4, s[16:19], s52 offen sc1
v_mfma_f32_16x16x32_bf16 v[40:43], a[8:11], v[96:99], v[40:43]
ds_read_b64_tr_b16 a[44:45], v7 offset:25056
ds_read_b64_tr_b16 a[46:47], v7 offset:25568
v_mfma_f32_16x16x32_bf16 v[56:59], a[8:11], v[100:103], v[56:59]
ds_read_b64_tr_b16 a[48:49], v7 offset:25984
buffer_load_dwordx4 v[84:87], v4, s[16:19], s52 offen offset:1024 sc1
v_mfma_f32_16x16x32_bf16 v[44:47], a[12:15], v[96:99], v[44:47]
ds_read_b64_tr_b16 a[50:51], v7 offset:26496
ds_read_b64_tr_b16 a[52:53], v7 offset:26016
s_add_u32 s52, s52, 0x40000
v_mfma_f32_16x16x32_bf16 v[60:63], a[12:15], v[100:103], v[60:63]
ds_read_b64_tr_b16 a[54:55], v7 offset:26528
ds_read_b64_tr_b16 a[56:57], v7 offset:26048
s_waitcnt vmcnt(17)
v_mfma_f32_16x16x32_bf16 v[32:35], a[16:19], v[104:107], v[32:35]
ds_read_b64_tr_b16 a[58:59], v7 offset:26560
buffer_load_dwordx4 v6, s[28:31], s54 offen offset:1024 lds
s_waitcnt vmcnt(17)
v_mfma_f32_16x16x32_bf16 v[48:51], a[16:19], v[108:111], v[48:51]
ds_read_b64_tr_b16 a[60:61], v7 offset:26080
ds_read_b64_tr_b16 a[62:63], v7 offset:26592
s_add_u32 s54, s54, 0x20000
v_mfma_f32_16x16x32_bf16 v[36:39], a[20:23], v[104:107], v[36:39]
buffer_load_dwordx4 v[88:91], v4, s[16:19], s53 offen sc1
v_mfma_f32_16x16x32_bf16 v[52:55], a[20:23], v[108:111], v[52:55]
v_mfma_f32_16x16x32_bf16 v[40:43], a[24:27], v[104:107], v[40:43]
buffer_load_dwordx4 v[92:95], v4, s[16:19], s53 offen offset:1024 sc1
v_mfma_f32_16x16x32_bf16 v[56:59], a[24:27], v[108:111], v[56:59]
s_add_u32 s53, s53, 0x40000
v_mfma_f32_16x16x32_bf16 v[44:47], a[28:31], v[104:107], v[44:47]
v_mfma_f32_16x16x32_bf16 v[60:63], a[28:31], v[108:111], v[60:63]
s_waitcnt lgkmcnt(0)
s_barrier
s_waitcnt vmcnt(17)
v_mfma_f32_16x16x32_bf16 v[32:35], a[32:35], v[112:115], v[32:35]
ds_read_b64_tr_b16 a[0:1], v7 offset:33280
ds_read_b64_tr_b16 a[2:3], v7 offset:33792
s_add_u32 m0, s55, 24960
s_waitcnt vmcnt(16)
v_mfma_f32_16x16x32_bf16 v[48:51], a[32:35], v[116:119], v[48:51]
ds_read_b64_tr_b16 a[4:5], v7 offset:33312
buffer_load_dwordx4 v5, s[28:31], s54 offen lds
v_mfma_f32_16x16x32_bf16 v[36:39], a[36:39], v[112:115], v[36:39]
ds_read_b64_tr_b16 a[6:7], v7 offset:33824
ds_read_b64_tr_b16 a[8:9], v7 offset:33344
v_mfma_f32_16x16x32_bf16 v[52:55], a[36:39], v[116:119], v[52:55]
ds_read_b64_tr_b16 a[10:11], v7 offset:33856
buffer_load_dwordx4 v[96:99], v4, s[16:19], s52 offen sc1
v_mfma_f32_16x16x32_bf16 v[40:43], a[40:43], v[112:115], v[40:43]
ds_read_b64_tr_b16 a[12:13], v7 offset:33376
ds_read_b64_tr_b16 a[14:15], v7 offset:33888
v_mfma_f32_16x16x32_bf16 v[56:59], a[40:43], v[116:119], v[56:59]
ds_read_b64_tr_b16 a[16:17], v7 offset:34304
buffer_load_dwordx4 v[100:103], v4, s[16:19], s52 offen offset:1024 sc1
v_mfma_f32_16x16x32_bf16 v[44:47], a[44:47], v[112:115], v[44:47]
ds_read_b64_tr_b16 a[18:19], v7 offset:34816
ds_read_b64_tr_b16 a[20:21], v7 offset:34336
s_add_u32 s52, s52, 0x40000
v_mfma_f32_16x16x32_bf16 v[60:63], a[44:47], v[116:119], v[60:63]
ds_read_b64_tr_b16 a[22:23], v7 offset:34848
ds_read_b64_tr_b16 a[24:25], v7 offset:34368
s_waitcnt vmcnt(17)
v_mfma_f32_16x16x32_bf16 v[32:35], a[48:51], v[120:123], v[32:35]
ds_read_b64_tr_b16 a[26:27], v7 offset:34880
buffer_load_dwordx4 v6, s[28:31], s54 offen offset:1024 lds
s_waitcnt vmcnt(17)
v_mfma_f32_16x16x32_bf16 v[48:51], a[48:51], v[124:127], v[48:51]
ds_read_b64_tr_b16 a[28:29], v7 offset:34400
ds_read_b64_tr_b16 a[30:31], v7 offset:34912
s_add_u32 s54, s54, 0x20000
v_mfma_f32_16x16x32_bf16 v[36:39], a[52:55], v[120:123], v[36:39]
buffer_load_dwordx4 v[104:107], v4, s[16:19], s53 offen sc1
v_mfma_f32_16x16x32_bf16 v[52:55], a[52:55], v[124:127], v[52:55]
v_mfma_f32_16x16x32_bf16 v[40:43], a[56:59], v[120:123], v[40:43]
buffer_load_dwordx4 v[108:111], v4, s[16:19], s53 offen offset:1024 sc1
v_mfma_f32_16x16x32_bf16 v[56:59], a[56:59], v[124:127], v[56:59]
s_add_u32 s53, s53, 0x40000
v_mfma_f32_16x16x32_bf16 v[44:47], a[60:63], v[120:123], v[44:47]
v_mfma_f32_16x16x32_bf16 v[60:63], a[60:63], v[124:127], v[60:63]
s_waitcnt lgkmcnt(0)
s_barrier
s_waitcnt vmcnt(17)
v_mfma_f32_16x16x32_bf16 v[32:35], a[0:3], v[64:67], v[32:35]
ds_read_b64_tr_b16 a[32:33], v7 offset:41600
ds_read_b64_tr_b16 a[34:35], v7 offset:42112
s_add_u32 m0, s55, 33280
s_waitcnt vmcnt(16)
v_mfma_f32_16x16x32_bf16 v[48:51], a[0:3], v[68:71], v[48:51]
ds_read_b64_tr_b16 a[36:37], v7 offset:41632
buffer_load_dwordx4 v5, s[28:31], s54 offen lds
v_mfma_f32_16x16x32_bf16 v[36:39], a[4:7], v[64:67], v[36:39]
ds_read_b64_tr_b16 a[38:39], v7 offset:42144
ds_read_b64_tr_b16 a[40:41], v7 offset:41664
v_mfma_f32_16x16x32_bf16 v[52:55], a[4:7], v[68:71], v[52:55]
ds_read_b64_tr_b16 a[42:43], v7 offset:42176
buffer_load_dwordx4 v[112:115], v4, s[16:19], s52 offen sc1
v_mfma_f32_16x16x32_bf16 v[40:43], a[8:11], v[64:67], v[40:43]
ds_read_b64_tr_b16 a[44:45], v7 offset:41696
ds_read_b64_tr_b16 a[46:47], v7 offset:42208
v_mfma_f32_16x16x32_bf16 v[56:59], a[8:11], v[68:71], v[56:59]
ds_read_b64_tr_b16 a[48:49], v7 offset:42624
buffer_load_dwordx4 v[116:119], v4, s[16:19], s52 offen offset:1024 sc1
v_mfma_f32_16x16x32_bf16 v[44:47], a[12:15], v[64:67], v[44:47]
ds_read_b64_tr_b16 a[50:51], v7 offset:43136
ds_read_b64_tr_b16 a[52:53], v7 offset:42656
s_add_u32 s52, s52, 0x40000
v_mfma_f32_16x16x32_bf16 v[60:63], a[12:15], v[68:71], v[60:63]
ds_read_b64_tr_b16 a[54:55], v7 offset:43168
ds_read_b64_tr_b16 a[56:57], v7 offset:42688
s_waitcnt vmcnt(17)
v_mfma_f32_16x16x32_bf16 v[32:35], a[16:19], v[72:75], v[32:35]
ds_read_b64_tr_b16 a[58:59], v7 offset:43200
buffer_load_dwordx4 v6, s[28:31], s54 offen offset:1024 lds
s_waitcnt vmcnt(17)
v_mfma_f32_16x16x32_bf16 v[48:51], a[16:19], v[76:79], v[48:51]
ds_read_b64_tr_b16 a[60:61], v7 offset:42720
ds_read_b64_tr_b16 a[62:63], v7 offset:43232
s_add_u32 s54, s54, 0x20000
v_mfma_f32_16x16x32_bf16 v[36:39], a[20:23], v[72:75], v[36:39]
buffer_load_dwordx4 v[120:123], v4, s[16:19], s53 offen sc1
v_mfma_f32_16x16x32_bf16 v[52:55], a[20:23], v[76:79], v[52:55]
v_mfma_f32_16x16x32_bf16 v[40:43], a[24:27], v[72:75], v[40:43]
buffer_load_dwordx4 v[124:127], v4, s[16:19], s53 offen offset:1024 sc1
v_mfma_f32_16x16x32_bf16 v[56:59], a[24:27], v[76:79], v[56:59]
s_add_u32 s53, s53, 0x40000
v_mfma_f32_16x16x32_bf16 v[44:47], a[28:31], v[72:75], v[44:47]
v_mfma_f32_16x16x32_bf16 v[60:63], a[28:31], v[76:79], v[60:63]
s_waitcnt lgkmcnt(0)
s_barrier
s_waitcnt vmcnt(16)
v_mfma_f32_16x16x32_bf16 v[32:35], a[32:35], v[80:83], v[32:35]
ds_read_b64_tr_b16 a[0:1], v7 offset:49920
ds_read_b64_tr_b16 a[2:3], v7 offset:50432
s_add_u32 m0, s55, 41600
s_waitcnt vmcnt(15)
v_mfma_f32_16x16x32_bf16 v[48:51], a[32:35], v[84:87], v[48:51]
ds_read_b64_tr_b16 a[4:5], v7 offset:49952
buffer_load_dwordx4 v5, s[28:31], s54 offen lds
v_mfma_f32_16x16x32_bf16 v[36:39], a[36:39], v[80:83], v[36:39]
ds_read_b64_tr_b16 a[6:7], v7 offset:50464
ds_read_b64_tr_b16 a[8:9], v7 offset:49984
v_mfma_f32_16x16x32_bf16 v[52:55], a[36:39], v[84:87], v[52:55]
ds_read_b64_tr_b16 a[10:11], v7 offset:50496
buffer_load_dwordx4 v[64:67], v4, s[16:19], s52 offen sc1
v_mfma_f32_16x16x32_bf16 v[40:43], a[40:43], v[80:83], v[40:43]
ds_read_b64_tr_b16 a[12:13], v7 offset:50016
ds_read_b64_tr_b16 a[14:15], v7 offset:50528
v_mfma_f32_16x16x32_bf16 v[56:59], a[40:43], v[84:87], v[56:59]
ds_read_b64_tr_b16 a[16:17], v7 offset:50944
buffer_load_dwordx4 v[68:71], v4, s[16:19], s52 offen offset:1024 sc1
.Lpad14:
s_cbranch_execz .Lnopoll25r
v_mfma_f32_16x16x32_bf16 v[44:47], a[44:47], v[80:83], v[44:47]
ds_read_b64_tr_b16 a[18:19], v7 offset:51456
ds_read_b64_tr_b16 a[20:21], v7 offset:50976
s_add_u32 s52, s52, 0x40000
v_mfma_f32_16x16x32_bf16 v[60:63], a[44:47], v[84:87], v[60:63]
ds_read_b64_tr_b16 a[22:23], v7 offset:51488
ds_read_b64_tr_b16 a[24:25], v7 offset:51008
s_waitcnt vmcnt(16)
v_mfma_f32_16x16x32_bf16 v[32:35], a[48:51], v[88:91], v[32:35]
ds_read_b64_tr_b16 a[26:27], v7 offset:51520
buffer_load_dwordx4 v6, s[28:31], s54 offen offset:1024 lds
s_waitcnt vmcnt(16)
v_mfma_f32_16x16x32_bf16 v[48:51], a[48:51], v[92:95], v[48:51]
ds_read_b64_tr_b16 a[28:29], v7 offset:51040
ds_read_b64_tr_b16 a[30:31], v7 offset:51552
s_add_u32 s54, s54, 0x20000
v_mfma_f32_16x16x32_bf16 v[36:39], a[52:55], v[88:91], v[36:39]
buffer_load_dwordx4 v[72:75], v4, s[16:19], s53 offen sc1
v_mfma_f32_16x16x32_bf16 v[52:55], a[52:55], v[92:95], v[52:55]
v_mfma_f32_16x16x32_bf16 v[40:43], a[56:59], v[88:91], v[40:43]
buffer_load_dwordx4 v[76:79], v4, s[16:19], s53 offen offset:1024 sc1
v_mfma_f32_16x16x32_bf16 v[56:59], a[56:59], v[92:95], v[56:59]
s_add_u32 s53, s53, 0x40000
v_mfma_f32_16x16x32_bf16 v[44:47], a[60:63], v[88:91], v[44:47]
v_mfma_f32_16x16x32_bf16 v[60:63], a[60:63], v[92:95], v[60:63]
s_waitcnt lgkmcnt(0)
s_barrier
s_waitcnt vmcnt(16)
v_mfma_f32_16x16x32_bf16 v[32:35], a[0:3], v[96:99], v[32:35]
ds_read_b64_tr_b16 a[32:33], v7 offset:58240
ds_read_b64_tr_b16 a[34:35], v7 offset:58752
s_add_u32 m0, s55, 49920
s_waitcnt vmcnt(15)
v_mfma_f32_16x16x32_bf16 v[48:51], a[0:3], v[100:103], v[48:51]
ds_read_b64_tr_b16 a[36:37], v7 offset:58272
buffer_load_dwordx4 v5, s[28:31], s54 offen lds
v_mfma_f32_16x16x32_bf16 v[36:39], a[4:7], v[96:99], v[36:39]
ds_read_b64_tr_b16 a[38:39], v7 offset:58784
ds_read_b64_tr_b16 a[40:41], v7 offset:58304
v_mfma_f32_16x16x32_bf16 v[52:55], a[4:7], v[100:103], v[52:55]
ds_read_b64_tr_b16 a[42:43], v7 offset:58816
buffer_load_dwordx4 v[80:83], v4, s[16:19], s52 offen sc1
v_mfma_f32_16x16x32_bf16 v[40:43], a[8:11], v[96:99], v[40:43]
ds_read_b64_tr_b16 a[44:45], v7 offset:58336
ds_read_b64_tr_b16 a[46:47], v7 offset:58848
v_mfma_f32_16x16x32_bf16 v[56:59], a[8:11], v[100:103], v[56:59]
ds_read_b64_tr_b16 a[48:49], v7 offset:59264
buffer_load_dwordx4 v[84:87], v4, s[16:19], s52 offen offset:1024 sc1
v_mfma_f32_16x16x32_bf16 v[44:47], a[12:15], v[96:99], v[44:47]
ds_read_b64_tr_b16 a[50:51], v7 offset:59776
ds_read_b64_tr_b16 a[52:53], v7 offset:59296
s_add_u32 s52, s52, 0x40000
v_mfma_f32_16x16x32_bf16 v[60:63], a[12:15], v[100:103], v[60:63]
ds_read_b64_tr_b16 a[54:55], v7 offset:59808
ds_read_b64_tr_b16 a[56:57], v7 offset:59328
s_waitcnt vmcnt(16)
v_mfma_f32_16x16x32_bf16 v[32:35], a[16:19], v[104:107], v[32:35]
ds_read_b64_tr_b16 a[58:59], v7 offset:59840
buffer_load_dwordx4 v6, s[28:31], s54 offen offset:1024 lds
s_waitcnt vmcnt(16)
v_mfma_f32_16x16x32_bf16 v[48:51], a[16:19], v[108:111], v[48:51]
ds_read_b64_tr_b16 a[60:61], v7 offset:59360
ds_read_b64_tr_b16 a[62:63], v7 offset:59872
s_add_u32 s54, s54, 0x20000
v_mfma_f32_16x16x32_bf16 v[36:39], a[20:23], v[104:107], v[36:39]
buffer_load_dwordx4 v[88:91], v4, s[16:19], s53 offen sc1
v_mfma_f32_16x16x32_bf16 v[52:55], a[20:23], v[108:111], v[52:55]
v_mfma_f32_16x16x32_bf16 v[40:43], a[24:27], v[104:107], v[40:43]
buffer_load_dwordx4 v[92:95], v4, s[16:19], s53 offen offset:1024 sc1
v_mfma_f32_16x16x32_bf16 v[56:59], a[24:27], v[108:111], v[56:59]
s_add_u32 s53, s53, 0x40000
v_mfma_f32_16x16x32_bf16 v[44:47], a[28:31], v[104:107], v[44:47]
v_mfma_f32_16x16x32_bf16 v[60:63], a[28:31], v[108:111], v[60:63]
s_waitcnt lgkmcnt(0)
s_barrier
s_xor_b32 s57, s57, 66560
v_add_u32 v7, s57, v8
s_waitcnt vmcnt(16)
v_mfma_f32_16x16x32_bf16 v[32:35], a[32:35], v[112:115], v[32:35]
ds_read_b64_tr_b16 a[0:1], v7
ds_read_b64_tr_b16 a[2:3], v7 offset:512
s_add_u32 m0, s55, 58240
s_waitcnt vmcnt(15)
v_mfma_f32_16x16x32_bf16 v[48:51], a[32:35], v[116:119], v[48:51]
ds_read_b64_tr_b16 a[4:5], v7 offset:32
buffer_load_dwordx4 v5, s[28:31], s54 offen lds
v_mfma_f32_16x16x32_bf16 v[36:39], a[36:39], v[112:115], v[36:39]
ds_read_b64_tr_b16 a[6:7], v7 offset:544
ds_read_b64_tr_b16 a[8:9], v7 offset:64
v_mfma_f32_16x16x32_bf16 v[52:55], a[36:39], v[116:119], v[52:55]
ds_read_b64_tr_b16 a[10:11], v7 offset:576
buffer_load_dwordx4 v[96:99], v4, s[16:19], s52 offen sc1
v_mfma_f32_16x16x32_bf16 v[40:43], a[40:43], v[112:115], v[40:43]
ds_read_b64_tr_b16 a[12:13], v7 offset:96
ds_read_b64_tr_b16 a[14:15], v7 offset:608
v_mfma_f32_16x16x32_bf16 v[56:59], a[40:43], v[116:119], v[56:59]
ds_read_b64_tr_b16 a[16:17], v7 offset:1024
buffer_load_dwordx4 v[100:103], v4, s[16:19], s52 offen offset:1024 sc1
v_mfma_f32_16x16x32_bf16 v[44:47], a[44:47], v[112:115], v[44:47]
ds_read_b64_tr_b16 a[18:19], v7 offset:1536
ds_read_b64_tr_b16 a[20:21], v7 offset:1056
s_add_u32 s52, s52, 0x40000
v_mfma_f32_16x16x32_bf16 v[60:63], a[44:47], v[116:119], v[60:63]
ds_read_b64_tr_b16 a[22:23], v7 offset:1568
ds_read_b64_tr_b16 a[24:25], v7 offset:1088
s_waitcnt vmcnt(16)
v_mfma_f32_16x16x32_bf16 v[32:35], a[48:51], v[120:123], v[32:35]
ds_read_b64_tr_b16 a[26:27], v7 offset:1600
buffer_load_dwordx4 v6, s[28:31], s54 offen offset:1024 lds
s_waitcnt vmcnt(16)
v_mfma_f32_16x16x32_bf16 v[48:51], a[48:51], v[124:127], v[48:51]
ds_read_b64_tr_b16 a[28:29], v7 offset:1120
ds_read_b64_tr_b16 a[30:31], v7 offset:1632
s_add_u32 s54, s54, 0x20000
v_mfma_f32_16x16x32_bf16 v[36:39], a[52:55], v[120:123], v[36:39]
buffer_load_dwordx4 v[104:107], v4, s[16:19], s53 offen sc1
v_mfma_f32_16x16x32_bf16 v[52:55], a[52:55], v[124:127], v[52:55]
v_mfma_f32_16x16x32_bf16 v[40:43], a[56:59], v[120:123], v[40:43]
buffer_load_dwordx4 v[108:111], v4, s[16:19], s53 offen offset:1024 sc1
v_mfma_f32_16x16x32_bf16 v[56:59], a[56:59], v[124:127], v[56:59]
s_add_u32 s53, s53, 0x40000
v_mfma_f32_16x16x32_bf16 v[44:47], a[60:63], v[120:123], v[44:47]
v_mfma_f32_16x16x32_bf16 v[60:63], a[60:63], v[124:127], v[60:63]
s_sub_u32 s15, s15, 1
s_cmp_lg_u32 s15, 0
s_cbranch_scc1 .Lk26
s_waitcnt vmcnt(16) lgkmcnt(14)
v_mfma_f32_16x16x32_bf16 v[32:35], a[0:3], v[64:67], v[32:35]
ds_read_b64_tr_b16 a[32:33], v7 offset:8320
ds_read_b64_tr_b16 a[34:35], v7 offset:8832
s_waitcnt vmcnt(15)
v_mfma_f32_16x16x32_bf16 v[48:51], a[0:3], v[68:71], v[48:51]
buffer_load_dwordx4 v[112:115], v4, s[16:19], s52 offen sc1
s_waitcnt lgkmcnt(14)
v_mfma_f32_16x16x32_bf16 v[36:39], a[4:7], v[64:67], v[36:39]
ds_read_b64_tr_b16 a[36:37], v7 offset:8352
ds_read_b64_tr_b16 a[38:39], v7 offset:8864
v_mfma_f32_16x16x32_bf16 v[52:55], a[4:7], v[68:71], v[52:55]
ds_read_b64_tr_b16 a[40:41], v7 offset:8384
ds_read_b64_tr_b16 a[42:43], v7 offset:8896
s_waitcnt lgkmcnt(15)
v_mfma_f32_16x16x32_bf16 v[40:43], a[8:11], v[64:67], v[40:43]
buffer_load_dwordx4 v[116:119], v4, s[16:19], s52 offen offset:1024 sc1
v_mfma_f32_16x16x32_bf16 v[56:59], a[8:11], v[68:71], v[56:59]
ds_read_b64_tr_b16 a[44:45], v7 offset:8416
s_add_u32 s52, s52, 0x40000
s_waitcnt lgkmcnt(15)
v_mfma_f32_16x16x32_bf16 v[44:47], a[12:15], v[64:67], v[44:47]
ds_read_b64_tr_b16 a[46:47], v7 offset:8928
v_mfma_f32_16x16x32_bf16 v[60:63], a[12:15], v[68:71], v[60:63]
ds_read_b64_tr_b16 a[48:49], v7 offset:9344
ds_read_b64_tr_b16 a[50:51], v7 offset:9856
s_waitcnt vmcnt(15) lgkmcnt(15)
v_mfma_f32_16x16x32_bf16 v[32:35], a[16:19], v[72:75], v[32:35]
buffer_load_dwordx4 v[120:123], v4, s[16:19], s53 offen sc1
s_waitcnt vmcnt(15)
v_mfma_f32_16x16x32_bf16 v[48:51], a[16:19], v[76:79], v[48:51]
ds_read_b64_tr_b16 a[52:53], v7 offset:9376
ds_read_b64_tr_b16 a[54:55], v7 offset:9888
s_waitcnt lgkmcnt(15)
v_mfma_f32_16x16x32_bf16 v[36:39], a[20:23], v[72:75], v[36:39]
ds_read_b64_tr_b16 a[56:57], v7 offset:9408
ds_read_b64_tr_b16 a[58:59], v7 offset:9920
v_mfma_f32_16x16x32_bf16 v[52:55], a[20:23], v[76:79], v[52:55]
buffer_load_dwordx4 v[124:127], v4, s[16:19], s53 offen offset:1024 sc1
s_waitcnt lgkmcnt(15)
v_mfma_f32_16x16x32_bf16 v[40:43], a[24:27], v[72:75], v[40:43]
ds_read_b64_tr_b16 a[60:61], v7 offset:9440
s_add_u32 s53, s53, 0x40000
v_mfma_f32_16x16x32_bf16 v[56:59], a[24:27], v[76:79], v[56:59]
ds_read_b64_tr_b16 a[62:63], v7 offset:9952
s_waitcnt lgkmcnt(15)
v_mfma_f32_16x16x32_bf16 v[44:47], a[28:31], v[72:75], v[44:47]
v_mfma_f32_16x16x32_bf16 v[60:63], a[28:31], v[76:79], v[60:63]
s_waitcnt vmcnt(14) lgkmcnt(14)
v_mfma_f32_16x16x32_bf16 v[32:35], a[32:35], v[80:83], v[32:35]
ds_read_b64_tr_b16 a[0:1], v7 offset:16640
ds_read_b64_tr_b16 a[2:3], v7 offset:17152
s_waitcnt vmcnt(13)
v_mfma_f32_16x16x32_bf16 v[48:51], a[32:35], v[84:87], v[48:51]
buffer_load_dwordx4 v[64:67], v4, s[16:19], s52 offen sc1
s_waitcnt lgkmcnt(14)
v_mfma_f32_16x16x32_bf16 v[36:39], a[36:39], v[80:83], v[36:39]
ds_read_b64_tr_b16 a[4:5], v7 offset:16672
ds_read_b64_tr_b16 a[6:7], v7 offset:17184
v_mfma_f32_16x16x32_bf16 v[52:55], a[36:39], v[84:87], v[52:55]
ds_read_b64_tr_b16 a[8:9], v7 offset:16704
ds_read_b64_tr_b16 a[10:11], v7 offset:17216
s_waitcnt lgkmcnt(15)
v_mfma_f32_16x16x32_bf16 v[40:43], a[40:43], v[80:83], v[40:43]
buffer_load_dwordx4 v[68:71], v4, s[16:19], s52 offen offset:1024 sc1
v_mfma_f32_16x16x32_bf16 v[56:59], a[40:43], v[84:87], v[56:59]
ds_read_b64_tr_b16 a[12:13], v7 offset:16736
s_add_u32 s52, s52, 0x40000
s_waitcnt lgkmcnt(15)
v_mfma_f32_16x16x32_bf16 v[44:47], a[44:47], v[80:83], v[44:47]
ds_read_b64_tr_b16 a[14:15], v7 offset:17248
v_mfma_f32_16x16x32_bf16 v[60:63], a[44:47], v[84:87], v[60:63]
ds_read_b64_tr_b16 a[16:17], v7 offset:17664
ds_read_b64_tr_b16 a[18:19], v7 offset:18176
s_waitcnt vmcnt(13) lgkmcnt(15)
v_mfma_f32_16x16x32_bf16 v[32:35], a[48:51], v[88:91], v[32:35]
buffer_load_dwordx4 v[72:75], v4, s[16:19], s53 offen sc1
s_waitcnt vmcnt(13)
v_mfma_f32_16x16x32_bf16 v[48:51], a[48:51], v[92:95], v[48:51]
ds_read_b64_tr_b16 a[20:21], v7 offset:17696
ds_read_b64_tr_b16 a[22:23], v7 offset:18208
s_waitcnt lgkmcnt(15)
v_mfma_f32_16x16x32_bf16 v[36:39], a[52:55], v[88:91], v[36:39]
ds_read_b64_tr_b16 a[24:25], v7 offset:17728
ds_read_b64_tr_b16 a[26:27], v7 offset:18240
v_mfma_f32_16x16x32_bf16 v[52:55], a[52:55], v[92:95], v[52:55]
buffer_load_dwordx4 v[76:79], v4, s[16:19], s53 offen offset:1024 sc1
s_waitcnt lgkmcnt(15)
v_mfma_f32_16x16x32_bf16 v[40:43], a[56:59], v[88:91], v[40:43]
ds_read_b64_tr_b16 a[28:29], v7 offset:17760
s_add_u32 s53, s53, 0x40000
v_mfma_f32_16x16x32_bf16 v[56:59], a[56:59], v[92:95], v[56:59]
ds_read_b64_tr_b16 a[30:31], v7 offset:18272
s_waitcnt lgkmcnt(15)
v_mfma_f32_16x16x32_bf16 v[44:47], a[60:63], v[88:91], v[44:47]
v_mfma_f32_16x16x32_bf16 v[60:63], a[60:63], v[92:95], v[60:63]
s_waitcnt vmcnt(12) lgkmcnt(14)
v_mfma_f32_16x16x32_bf16 v[32:35], a[0:3], v[96:99], v[32:35]
ds_read_b64_tr_b16 a[32:33], v7 offset:24960
ds_read_b64_tr_b16 a[34:35], v7 offset:25472
s_waitcnt vmcnt(11)
v_mfma_f32_16x16x32_bf16 v[48:51], a[0:3], v[100:103], v[48:51]
buffer_load_dwordx4 v[80:83], v4, s[16:19], s52 offen sc1
s_waitcnt lgkmcnt(14)
v_mfma_f32_16x16x32_bf16 v[36:39], a[4:7], v[96:99], v[36:39]
ds_read_b64_tr_b16 a[36:37], v7 offset:24992
ds_read_b64_tr_b16 a[38:39], v7 offset:25504
v_mfma_f32_16x16x32_bf16 v[52:55], a[4:7], v[100:103], v[52:55]
ds_read_b64_tr_b16 a[40:41], v7 offset:25024
ds_read_b64_tr_b16 a[42:43], v7 offset:25536
s_waitcnt lgkmcnt(15)
v_mfma_f32_16x16x32_bf16 v[40:43], a[8:11], v[96:99], v[40:43]
buffer_load_dwordx4 v[84:87], v4, s[16:19], s52 offen offset:1024 sc1
v_mfma_f32_16x16x32_bf16 v[56:59], a[8:11], v[100:103], v[56:59]
ds_read_b64_tr_b16 a[44:45], v7 offset:25056
s_add_u32 s52, s52, 0x40000
s_waitcnt lgkmcnt(15)
v_mfma_f32_16x16x32_bf16 v[44:47], a[12:15], v[96:99], v[44:47]
ds_read_b64_tr_b16 a[46:47], v7 offset:25568
v_mfma_f32_16x16x32_bf16 v[60:63], a[12:15], v[100:103], v[60:63]
ds_read_b64_tr_b16 a[48:49], v7 offset:25984
ds_read_b64_tr_b16 a[50:51], v7 offset:26496
s_waitcnt vmcnt(11) lgkmcnt(15)
v_mfma_f32_16x16x32_bf16 v[32:35], a[16:19], v[104:107], v[32:35]
buffer_load_dwordx4 v[88:91], v4, s[16:19], s53 offen sc1
s_waitcnt vmcnt(11)
v_mfma_f32_16x16x32_bf16 v[48:51], a[16:19], v[108:111], v[48:51]
ds_read_b64_tr_b16 a[52:53], v7 offset:26016
ds_read_b64_tr_b16 a[54:55], v7 offset:26528
s_waitcnt lgkmcnt(15)
v_mfma_f32_16x16x32_bf16 v[36:39], a[20:23], v[104:107], v[36:39]
ds_read_b64_tr_b16 a[56:57], v7 offset:26048
ds_read_b64_tr_b16 a[58:59], v7 offset:26560
v_mfma_f32_16x16x32_bf16 v[52:55], a[20:23], v[108:111], v[52:55]
buffer_load_dwordx4 v[92:95], v4, s[16:19], s53 offen offset:1024 sc1
s_waitcnt lgkmcnt(15)
v_mfma_f32_16x16x32_bf16 v[40:43], a[24:27], v[104:107], v[40:43]
ds_read_b64_tr_b16 a[60:61], v7 offset:26080
s_add_u32 s53, s53, 0x40000
v_mfma_f32_16x16x32_bf16 v[56:59], a[24:27], v[108:111], v[56:59]
ds_read_b64_tr_b16 a[62:63], v7 offset:26592
s_waitcnt lgkmcnt(15)
v_mfma_f32_16x16x32_bf16 v[44:47], a[28:31], v[104:107], v[44:47]
v_mfma_f32_16x16x32_bf16 v[60:63], a[28:31], v[108:111], v[60:63]
s_waitcnt vmcnt(11) lgkmcnt(14)
v_mfma_f32_16x16x32_bf16 v[32:35], a[32:35], v[112:115], v[32:35]
ds_read_b64_tr_b16 a[0:1], v7 offset:33280
ds_read_b64_tr_b16 a[2:3], v7 offset:33792
s_waitcnt vmcnt(10)
v_mfma_f32_16x16x32_bf16 v[48:51], a[32:35], v[116:119], v[48:51]
buffer_load_dwordx4 v[96:99], v4, s[16:19], s52 offen sc1
s_waitcnt lgkmcnt(14)
v_mfma_f32_16x16x32_bf16 v[36:39], a[36:39], v[112:115], v[36:39]
ds_read_b64_tr_b16 a[4:5], v7 offset:33312
ds_read_b64_tr_b16 a[6:7], v7 offset:33824
v_mfma_f32_16x16x32_bf16 v[52:55], a[36:39], v[116:119], v[52:55]
ds_read_b64_tr_b16 a[8:9], v7 offset:33344
ds_read_b64_tr_b16 a[10:11], v7 offset:33856
s_waitcnt lgkmcnt(15)
v_mfma_f32_16x16x32_bf16 v[40:43], a[40:43], v[112:115], v[40:43]
buffer_load_dwordx4 v[100:103], v4, s[16:19], s52 offen offset:1024 sc1
v_mfma_f32_16x16x32_bf16 v[56:59], a[40:43], v[116:119], v[56:59]
ds_read_b64_tr_b16 a[12:13], v7 offset:33376
s_add_u32 s52, s52, 0x40000
s_waitcnt lgkmcnt(15)
v_mfma_f32_16x16x32_bf16 v[44:47], a[44:47], v[112:115], v[44:47]
ds_read_b64_tr_b16 a[14:15], v7 offset:33888
v_mfma_f32_16x16x32_bf16 v[60:63], a[44:47], v[116:119], v[60:63]
ds_read_b64_tr_b16 a[16:17], v7 offset:34304
ds_read_b64_tr_b16 a[18:19], v7 offset:34816
s_waitcnt vmcnt(11) lgkmcnt(15)
v_mfma_f32_16x16x32_bf16 v[32:35], a[48:51], v[120:123], v[32:35]
buffer_load_dwordx4 v[104:107], v4, s[16:19], s53 offen sc1
s_waitcnt vmcnt(11)
v_mfma_f32_16x16x32_bf16 v[48:51], a[48:51], v[124:127], v[48:51]
ds_read_b64_tr_b16 a[20:21], v7 offset:34336
ds_read_b64_tr_b16 a[22:23], v7 offset:34848
s_waitcnt lgkmcnt(15)
v_mfma_f32_16x16x32_bf16 v[36:39], a[52:55], v[120:123], v[36:39]
ds_read_b64_tr_b16 a[24:25], v7 offset:34368
ds_read_b64_tr_b16 a[26:27], v7 offset:34880
v_mfma_f32_16x16x32_bf16 v[52:55], a[52:55], v[124:127], v[52:55]
buffer_load_dwordx4 v[108:111], v4, s[16:19], s53 offen offset:1024 sc1
s_waitcnt lgkmcnt(15)
v_mfma_f32_16x16x32_bf16 v[40:43], a[56:59], v[120:123], v[40:43]
ds_read_b64_tr_b16 a[28:29], v7 offset:34400
s_add_u32 s53, s53, 0x40000
v_mfma_f32_16x16x32_bf16 v[56:59], a[56:59], v[124:127], v[56:59]
ds_read_b64_tr_b16 a[30:31], v7 offset:34912
s_waitcnt lgkmcnt(15)
v_mfma_f32_16x16x32_bf16 v[44:47], a[60:63], v[120:123], v[44:47]
v_mfma_f32_16x16x32_bf16 v[60:63], a[60:63], v[124:127], v[60:63]
s_waitcnt lgkmcnt(0)
s_barrier
s_waitcnt vmcnt(11)
v_mfma_f32_16x16x32_bf16 v[32:35], a[0:3], v[64:67], v[32:35]
ds_read_b64_tr_b16 a[32:33], v7 offset:41600
ds_read_b64_tr_b16 a[34:35], v7 offset:42112
s_waitcnt vmcnt(10)
v_mfma_f32_16x16x32_bf16 v[48:51], a[0:3], v[68:71], v[48:51]
ds_read_b64_tr_b16 a[36:37], v7 offset:41632
buffer_load_dwordx4 v[112:115], v4, s[16:19], s52 offen sc1
v_mfma_f32_16x16x32_bf16 v[36:39], a[4:7], v[64:67], v[36:39]
ds_read_b64_tr_b16 a[38:39], v7 offset:42144
ds_read_b64_tr_b16 a[40:41], v7 offset:41664
v_mfma_f32_16x16x32_bf16 v[52:55], a[4:7], v[68:71], v[52:55]
ds_read_b64_tr_b16 a[42:43], v7 offset:42176
v_mfma_f32_16x16x32_bf16 v[40:43], a[8:11], v[64:67], v[40:43]
ds_read_b64_tr_b16 a[44:45], v7 offset:41696
buffer_load_dwordx4 v[116:119], v4, s[16:19], s52 offen offset:1024 sc1
v_mfma_f32_16x16x32_bf16 v[56:59], a[8:11], v[68:71], v[56:59]
ds_read_b64_tr_b16 a[46:47], v7 offset:42208
ds_read_b64_tr_b16 a[48:49], v7 offset:42624
s_add_u32 s52, s52, 0x40000
v_mfma_f32_16x16x32_bf16 v[44:47], a[12:15], v[64:67], v[44:47]
ds_read_b64_tr_b16 a[50:51], v7 offset:43136
ds_read_b64_tr_b16 a[52:53], v7 offset:42656
v_mfma_f32_16x16x32_bf16 v[60:63], a[12:15], v[68:71], v[60:63]
ds_read_b64_tr_b16 a[54:55], v7 offset:43168
s_waitcnt vmcnt(11)
v_mfma_f32_16x16x32_bf16 v[32:35], a[16:19], v[72:75], v[32:35]
ds_read_b64_tr_b16 a[56:57], v7 offset:42688
buffer_load_dwordx4 v[120:123], v4, s[16:19], s53 offen sc1
s_waitcnt vmcnt(11)
v_mfma_f32_16x16x32_bf16 v[48:51], a[16:19], v[76:79], v[48:51]
ds_read_b64_tr_b16 a[58:59], v7 offset:43200
ds_read_b64_tr_b16 a[60:61], v7 offset:42720
v_mfma_f32_16x16x32_bf16 v[36:39], a[20:23], v[72:75], v[36:39]
ds_read_b64_tr_b16 a[62:63], v7 offset:43232
v_mfma_f32_16x16x32_bf16 v[52:55], a[20:23], v[76:79], v[52:55]
buffer_load_dwordx4 v[124:127], v4, s[16:19], s53 offen offset:1024 sc1
v_mfma_f32_16x16x32_bf16 v[40:43], a[24:27], v[72:75], v[40:43]
s_add_u32 s53, s53, 0x40000
v_mfma_f32_16x16x32_bf16 v[56:59], a[24:27], v[76:79], v[56:59]
v_mfma_f32_16x16x32_bf16 v[44:47], a[28:31], v[72:75], v[44:47]
v_mfma_f32_16x16x32_bf16 v[60:63], a[28:31], v[76:79], v[60:63]
s_waitcnt vmcnt(11) lgkmcnt(14)
v_mfma_f32_16x16x32_bf16 v[32:35], a[32:35], v[80:83], v[32:35]
ds_read_b64_tr_b16 a[0:1], v7 offset:49920
ds_read_b64_tr_b16 a[2:3], v7 offset:50432
s_waitcnt vmcnt(10)
v_mfma_f32_16x16x32_bf16 v[48:51], a[32:35], v[84:87], v[48:51]
buffer_load_dwordx4 v[64:67], v4, s[16:19], s52 offen sc1
s_waitcnt lgkmcnt(14)
v_mfma_f32_16x16x32_bf16 v[36:39], a[36:39], v[80:83], v[36:39]
ds_read_b64_tr_b16 a[4:5], v7 offset:49952
ds_read_b64_tr_b16 a[6:7], v7 offset:50464
v_mfma_f32_16x16x32_bf16 v[52:55], a[36:39], v[84:87], v[52:55]
ds_read_b64_tr_b16 a[8:9], v7 offset:49984
ds_read_b64_tr_b16 a[10:11], v7 offset:50496
s_waitcnt lgkmcnt(15)
v_mfma_f32_16x16x32_bf16 v[40:43], a[40:43], v[80:83], v[40:43]
buffer_load_dwordx4 v[68:71], v4, s[16:19], s52 offen offset:1024 sc1
v_mfma_f32_16x16x32_bf16 v[56:59], a[40:43], v[84:87], v[56:59]
ds_read_b64_tr_b16 a[12:13], v7 offset:50016
s_add_u32 s52, s52, 0x40000
s_waitcnt lgkmcnt(15)
v_mfma_f32_16x16x32_bf16 v[44:47], a[44:47], v[80:83], v[44:47]
ds_read_b64_tr_b16 a[14:15], v7 offset:50528
v_mfma_f32_16x16x32_bf16 v[60:63], a[44:47], v[84:87], v[60:63]
ds_read_b64_tr_b16 a[16:17], v7 offset:50944
ds_read_b64_tr_b16 a[18:19], v7 offset:51456
s_waitcnt vmcnt(11) lgkmcnt(15)
v_mfma_f32_16x16x32_bf16 v[32:35], a[48:51], v[88:91], v[32:35]
buffer_load_dwordx4 v[72:75], v4, s[16:19], s53 offen sc1
s_waitcnt vmcnt(11)
v_mfma_f32_16x16x32_bf16 v[48:51], a[48:51], v[92:95], v[48:51]
ds_read_b64_tr_b16 a[20:21], v7 offset:50976
ds_read_b64_tr_b16 a[22:23], v7 offset:51488
s_waitcnt lgkmcnt(15)
v_mfma_f32_16x16x32_bf16 v[36:39], a[52:55], v[88:91], v[36:39]
ds_read_b64_tr_b16 a[24:25], v7 offset:51008
ds_read_b64_tr_b16 a[26:27], v7 offset:51520
v_mfma_f32_16x16x32_bf16 v[52:55], a[52:55], v[92:95], v[52:55]
buffer_load_dwordx4 v[76:79], v4, s[16:19], s53 offen offset:1024 sc1
s_waitcnt lgkmcnt(15)
v_mfma_f32_16x16x32_bf16 v[40:43], a[56:59], v[88:91], v[40:43]
ds_read_b64_tr_b16 a[28:29], v7 offset:51040
s_add_u32 s53, s53, 0x40000
v_mfma_f32_16x16x32_bf16 v[56:59], a[56:59], v[92:95], v[56:59]
ds_read_b64_tr_b16 a[30:31], v7 offset:51552
s_waitcnt lgkmcnt(15)
v_mfma_f32_16x16x32_bf16 v[44:47], a[60:63], v[88:91], v[44:47]
v_mfma_f32_16x16x32_bf16 v[60:63], a[60:63], v[92:95], v[60:63]
s_waitcnt vmcnt(11) lgkmcnt(14)
v_mfma_f32_16x16x32_bf16 v[32:35], a[0:3], v[96:99], v[32:35]
ds_read_b64_tr_b16 a[32:33], v7 offset:58240
ds_read_b64_tr_b16 a[34:35], v7 offset:58752
s_waitcnt vmcnt(10)
v_mfma_f32_16x16x32_bf16 v[48:51], a[0:3], v[100:103], v[48:51]
buffer_load_dwordx4 v[80:83], v4, s[16:19], s52 offen sc1
s_waitcnt lgkmcnt(14)
v_mfma_f32_16x16x32_bf16 v[36:39], a[4:7], v[96:99], v[36:39]
ds_read_b64_tr_b16 a[36:37], v7 offset:58272
ds_read_b64_tr_b16 a[38:39], v7 offset:58784
v_mfma_f32_16x16x32_bf16 v[52:55], a[4:7], v[100:103], v[52:55]
ds_read_b64_tr_b16 a[40:41], v7 offset:58304
ds_read_b64_tr_b16 a[42:43], v7 offset:58816
s_waitcnt lgkmcnt(15)
v_mfma_f32_16x16x32_bf16 v[40:43], a[8:11], v[96:99], v[40:43]
buffer_load_dwordx4 v[84:87], v4, s[16:19], s52 offen offset:1024 sc1
v_mfma_f32_16x16x32_bf16 v[56:59], a[8:11], v[100:103], v[56:59]
ds_read_b64_tr_b16 a[44:45], v7 offset:58336
s_add_u32 s52, s52, 0x40000
s_waitcnt lgkmcnt(15)
v_mfma_f32_16x16x32_bf16 v[44:47], a[12:15], v[96:99], v[44:47]
ds_read_b64_tr_b16 a[46:47], v7 offset:58848
v_mfma_f32_16x16x32_bf16 v[60:63], a[12:15], v[100:103], v[60:63]
ds_read_b64_tr_b16 a[48:49], v7 offset:59264
ds_read_b64_tr_b16 a[50:51], v7 offset:59776
s_waitcnt vmcnt(11) lgkmcnt(15)
v_mfma_f32_16x16x32_bf16 v[32:35], a[16:19], v[104:107], v[32:35]
buffer_load_dwordx4 v[88:91], v4, s[16:19], s53 offen sc1
s_waitcnt vmcnt(11)
v_mfma_f32_16x16x32_bf16 v[48:51], a[16:19], v[108:111], v[48:51]
ds_read_b64_tr_b16 a[52:53], v7 offset:59296
ds_read_b64_tr_b16 a[54:55], v7 offset:59808
s_waitcnt lgkmcnt(15)
v_mfma_f32_16x16x32_bf16 v[36:39], a[20:23], v[104:107], v[36:39]
ds_read_b64_tr_b16 a[56:57], v7 offset:59328
ds_read_b64_tr_b16 a[58:59], v7 offset:59840
v_mfma_f32_16x16x32_bf16 v[52:55], a[20:23], v[108:111], v[52:55]
buffer_load_dwordx4 v[92:95], v4, s[16:19], s53 offen offset:1024 sc1
s_waitcnt lgkmcnt(15)
v_mfma_f32_16x16x32_bf16 v[40:43], a[24:27], v[104:107], v[40:43]
ds_read_b64_tr_b16 a[60:61], v7 offset:59360
s_add_u32 s53, s53, 0x40000
v_mfma_f32_16x16x32_bf16 v[56:59], a[24:27], v[108:111], v[56:59]
ds_read_b64_tr_b16 a[62:63], v7 offset:59872
s_waitcnt lgkmcnt(15)
v_mfma_f32_16x16x32_bf16 v[44:47], a[28:31], v[104:107], v[44:47]
v_mfma_f32_16x16x32_bf16 v[60:63], a[28:31], v[108:111], v[60:63]
s_xor_b32 s57, s57, 66560
v_add_u32 v7, s57, v8
s_waitcnt vmcnt(11) lgkmcnt(14)
v_mfma_f32_16x16x32_bf16 v[32:35], a[32:35], v[112:115], v[32:35]
ds_read_b64_tr_b16 a[0:1], v7
ds_read_b64_tr_b16 a[2:3], v7 offset:512
s_waitcnt vmcnt(10)
v_mfma_f32_16x16x32_bf16 v[48:51], a[32:35], v[116:119], v[48:51]
buffer_load_dwordx4 v[96:99], v4, s[16:19], s52 offen sc1
s_waitcnt lgkmcnt(14)
v_mfma_f32_16x16x32_bf16 v[36:39], a[36:39], v[112:115], v[36:39]
ds_read_b64_tr_b16 a[4:5], v7 offset:32
ds_read_b64_tr_b16 a[6:7], v7 offset:544
v_mfma_f32_16x16x32_bf16 v[52:55], a[36:39], v[116:119], v[52:55]
ds_read_b64_tr_b16 a[8:9], v7 offset:64
ds_read_b64_tr_b16 a[10:11], v7 offset:576
s_waitcnt lgkmcnt(15)
v_mfma_f32_16x16x32_bf16 v[40:43], a[40:43], v[112:115], v[40:43]
buffer_load_dwordx4 v[100:103], v4, s[16:19], s52 offen offset:1024 sc1
v_mfma_f32_16x16x32_bf16 v[56:59], a[40:43], v[116:119], v[56:59]
ds_read_b64_tr_b16 a[12:13], v7 offset:96
s_add_u32 s52, s52, 0x40000
s_waitcnt lgkmcnt(15)
v_mfma_f32_16x16x32_bf16 v[44:47], a[44:47], v[112:115], v[44:47]
ds_read_b64_tr_b16 a[14:15], v7 offset:608
v_mfma_f32_16x16x32_bf16 v[60:63], a[44:47], v[116:119], v[60:63]
ds_read_b64_tr_b16 a[16:17], v7 offset:1024
ds_read_b64_tr_b16 a[18:19], v7 offset:1536
s_waitcnt vmcnt(11) lgkmcnt(15)
v_mfma_f32_16x16x32_bf16 v[32:35], a[48:51], v[120:123], v[32:35]
buffer_load_dwordx4 v[104:107], v4, s[16:19], s53 offen sc1
s_waitcnt vmcnt(11)
v_mfma_f32_16x16x32_bf16 v[48:51], a[48:51], v[124:127], v[48:51]
ds_read_b64_tr_b16 a[20:21], v7 offset:1056
ds_read_b64_tr_b16 a[22:23], v7 offset:1568
s_waitcnt lgkmcnt(15)
v_mfma_f32_16x16x32_bf16 v[36:39], a[52:55], v[120:123], v[36:39]
ds_read_b64_tr_b16 a[24:25], v7 offset:1088
ds_read_b64_tr_b16 a[26:27], v7 offset:1600
v_mfma_f32_16x16x32_bf16 v[52:55], a[52:55], v[124:127], v[52:55]
buffer_load_dwordx4 v[108:111], v4, s[16:19], s53 offen offset:1024 sc1
s_waitcnt lgkmcnt(15)
v_mfma_f32_16x16x32_bf16 v[40:43], a[56:59], v[120:123], v[40:43]
ds_read_b64_tr_b16 a[28:29], v7 offset:1120
s_add_u32 s53, s53, 0x40000
v_mfma_f32_16x16x32_bf16 v[56:59], a[56:59], v[124:127], v[56:59]
ds_read_b64_tr_b16 a[30:31], v7 offset:1632
s_waitcnt lgkmcnt(15)
v_mfma_f32_16x16x32_bf16 v[44:47], a[60:63], v[120:123], v[44:47]
v_mfma_f32_16x16x32_bf16 v[60:63], a[60:63], v[124:127], v[60:63]
s_waitcnt vmcnt(11) lgkmcnt(14)
v_mfma_f32_16x16x32_bf16 v[32:35], a[0:3], v[64:67], v[32:35]
ds_read_b64_tr_b16 a[32:33], v7 offset:8320
ds_read_b64_tr_b16 a[34:35], v7 offset:8832
s_waitcnt vmcnt(10)
v_mfma_f32_16x16x32_bf16 v[48:51], a[0:3], v[68:71], v[48:51]
buffer_load_dwordx4 v[112:115], v4, s[16:19], s52 offen sc1
s_waitcnt lgkmcnt(14)
v_mfma_f32_16x16x32_bf16 v[36:39], a[4:7], v[64:67], v[36:39]
ds_read_b64_tr_b16 a[36:37], v7 offset:8352
ds_read_b64_tr_b16 a[38:39], v7 offset:8864
v_mfma_f32_16x16x32_bf16 v[52:55], a[4:7], v[68:71], v[52:55]
ds_read_b64_tr_b16 a[40:41], v7 offset:8384
ds_read_b64_tr_b16 a[42:43], v7 offset:8896
s_waitcnt lgkmcnt(15)
v_mfma_f32_16x16x32_bf16 v[40:43], a[8:11], v[64:67], v[40:43]
buffer_load_dwordx4 v[116:119], v4, s[16:19], s52 offen offset:1024 sc1
v_mfma_f32_16x16x32_bf16 v[56:59], a[8:11], v[68:71], v[56:59]
ds_read_b64_tr_b16 a[44:45], v7 offset:8416
s_add_u32 s52, s52, 0x40000
s_waitcnt lgkmcnt(15)
v_mfma_f32_16x16x32_bf16 v[44:47], a[12:15], v[64:67], v[44:47]
ds_read_b64_tr_b16 a[46:47], v7 offset:8928
v_mfma_f32_16x16x32_bf16 v[60:63], a[12:15], v[68:71], v[60:63]
ds_read_b64_tr_b16 a[48:49], v7 offset:9344
ds_read_b64_tr_b16 a[50:51], v7 offset:9856
s_waitcnt vmcnt(11) lgkmcnt(15)
v_mfma_f32_16x16x32_bf16 v[32:35], a[16:19], v[72:75], v[32:35]
buffer_load_dwordx4 v[120:123], v4, s[16:19], s53 offen sc1
s_waitcnt vmcnt(11)
v_mfma_f32_16x16x32_bf16 v[48:51], a[16:19], v[76:79], v[48:51]
ds_read_b64_tr_b16 a[52:53], v7 offset:9376
ds_read_b64_tr_b16 a[54:55], v7 offset:9888
s_waitcnt lgkmcnt(15)
v_mfma_f32_16x16x32_bf16 v[36:39], a[20:23], v[72:75], v[36:39]
ds_read_b64_tr_b16 a[56:57], v7 offset:9408
ds_read_b64_tr_b16 a[58:59], v7 offset:9920
v_mfma_f32_16x16x32_bf16 v[52:55], a[20:23], v[76:79], v[52:55]
buffer_load_dwordx4 v[124:127], v4, s[16:19], s53 offen offset:1024 sc1
s_waitcnt lgkmcnt(15)
v_mfma_f32_16x16x32_bf16 v[40:43], a[24:27], v[72:75], v[40:43]
ds_read_b64_tr_b16 a[60:61], v7 offset:9440
s_add_u32 s53, s53, 0x40000
v_mfma_f32_16x16x32_bf16 v[56:59], a[24:27], v[76:79], v[56:59]
ds_read_b64_tr_b16 a[62:63], v7 offset:9952
s_waitcnt lgkmcnt(15)
v_mfma_f32_16x16x32_bf16 v[44:47], a[28:31], v[72:75], v[44:47]
v_mfma_f32_16x16x32_bf16 v[60:63], a[28:31], v[76:79], v[60:63]
s_waitcnt vmcnt(11) lgkmcnt(14)
v_mfma_f32_16x16x32_bf16 v[32:35], a[32:35], v[80:83], v[32:35]
ds_read_b64_tr_b16 a[0:1], v7 offset:16640
ds_read_b64_tr_b16 a[2:3], v7 offset:17152
s_waitcnt vmcnt(10)
v_mfma_f32_16x16x32_bf16 v[48:51], a[32:35], v[84:87], v[48:51]
buffer_load_dwordx4 v[64:67], v4, s[16:19], s52 offen sc1
s_waitcnt lgkmcnt(14)
v_mfma_f32_16x16x32_bf16 v[36:39], a[36:39], v[80:83], v[36:39]
ds_read_b64_tr_b16 a[4:5], v7 offset:16672
.Lpad15:
s_cbranch_execz .Lnopoll25r
ds_read_b64_tr_b16 a[6:7], v7 offset:17184
v_mfma_f32_16x16x32_bf16 v[52:55], a[36:39], v[84:87], v[52:55]
ds_read_b64_tr_b16 a[8:9], v7 offset:16704
ds_read_b64_tr_b16 a[10:11], v7 offset:17216
s_waitcnt lgkmcnt(15)
v_mfma_f32_16x16x32_bf16 v[40:43], a[40:43], v[80:83], v[40:43]
buffer_load_dwordx4 v[68:71], v4, s[16:19], s52 offen offset:1024 sc1
v_mfma_f32_16x16x32_bf16 v[56:59], a[40:43], v[84:87], v[56:59]
ds_read_b64_tr_b16 a[12:13], v7 offset:16736
s_add_u32 s52, s52, 0x40000
s_waitcnt lgkmcnt(15)
v_mfma_f32_16x16x32_bf16 v[44:47], a[44:47], v[80:83], v[44:47]
ds_read_b64_tr_b16 a[14:15], v7 offset:17248
v_mfma_f32_16x16x32_bf16 v[60:63], a[44:47], v[84:87], v[60:63]
ds_read_b64_tr_b16 a[16:17], v7 offset:17664
ds_read_b64_tr_b16 a[18:19], v7 offset:18176
s_waitcnt vmcnt(11) lgkmcnt(15)
v_mfma_f32_16x16x32_bf16 v[32:35], a[48:51], v[88:91], v[32:35]
buffer_load_dwordx4 v[72:75], v4, s[16:19], s53 offen sc1
s_waitcnt vmcnt(11)
v_mfma_f32_16x16x32_bf16 v[48:51], a[48:51], v[92:95], v[48:51]
ds_read_b64_tr_b16 a[20:21], v7 offset:17696
ds_read_b64_tr_b16 a[22:23], v7 offset:18208
s_waitcnt lgkmcnt(15)
v_mfma_f32_16x16x32_bf16 v[36:39], a[52:55], v[88:91], v[36:39]
ds_read_b64_tr_b16 a[24:25], v7 offset:17728
ds_read_b64_tr_b16 a[26:27], v7 offset:18240
v_mfma_f32_16x16x32_bf16 v[52:55], a[52:55], v[92:95], v[52:55]
buffer_load_dwordx4 v[76:79], v4, s[16:19], s53 offen offset:1024 sc1
s_waitcnt lgkmcnt(15)
v_mfma_f32_16x16x32_bf16 v[40:43], a[56:59], v[88:91], v[40:43]
ds_read_b64_tr_b16 a[28:29], v7 offset:17760
s_add_u32 s53, s53, 0x40000
v_mfma_f32_16x16x32_bf16 v[56:59], a[56:59], v[92:95], v[56:59]
ds_read_b64_tr_b16 a[30:31], v7 offset:18272
s_waitcnt lgkmcnt(15)
v_mfma_f32_16x16x32_bf16 v[44:47], a[60:63], v[88:91], v[44:47]
v_mfma_f32_16x16x32_bf16 v[60:63], a[60:63], v[92:95], v[60:63]
s_waitcnt vmcnt(11) lgkmcnt(14)
v_mfma_f32_16x16x32_bf16 v[32:35], a[0:3], v[96:99], v[32:35]
ds_read_b64_tr_b16 a[32:33], v7 offset:24960
ds_read_b64_tr_b16 a[34:35], v7 offset:25472
s_waitcnt vmcnt(10)
v_mfma_f32_16x16x32_bf16 v[48:51], a[0:3], v[100:103], v[48:51]
buffer_load_dwordx4 v[80:83], v4, s[16:19], s52 offen sc1
s_waitcnt lgkmcnt(14)
v_mfma_f32_16x16x32_bf16 v[36:39], a[4:7], v[96:99], v[36:39]
ds_read_b64_tr_b16 a[36:37], v7 offset:24992
ds_read_b64_tr_b16 a[38:39], v7 offset:25504
v_mfma_f32_16x16x32_bf16 v[52:55], a[4:7], v[100:103], v[52:55]
ds_read_b64_tr_b16 a[40:41], v7 offset:25024
ds_read_b64_tr_b16 a[42:43], v7 offset:25536
s_waitcnt lgkmcnt(15)
v_mfma_f32_16x16x32_bf16 v[40:43], a[8:11], v[96:99], v[40:43]
buffer_load_dwordx4 v[84:87], v4, s[16:19], s52 offen offset:1024 sc1
v_mfma_f32_16x16x32_bf16 v[56:59], a[8:11], v[100:103], v[56:59]
ds_read_b64_tr_b16 a[44:45], v7 offset:25056
s_add_u32 s52, s52, 0x40000
s_waitcnt lgkmcnt(15)
v_mfma_f32_16x16x32_bf16 v[44:47], a[12:15], v[96:99], v[44:47]
ds_read_b64_tr_b16 a[46:47], v7 offset:25568
v_mfma_f32_16x16x32_bf16 v[60:63], a[12:15], v[100:103], v[60:63]
ds_read_b64_tr_b16 a[48:49], v7 offset:25984
ds_read_b64_tr_b16 a[50:51], v7 offset:26496
s_waitcnt vmcnt(11) lgkmcnt(15)
v_mfma_f32_16x16x32_bf16 v[32:35], a[16:19], v[104:107], v[32:35]
buffer_load_dwordx4 v[88:91], v4, s[16:19], s53 offen sc1
s_waitcnt vmcnt(11)
v_mfma_f32_16x16x32_bf16 v[48:51], a[16:19], v[108:111], v[48:51]
ds_read_b64_tr_b16 a[52:53], v7 offset:26016
ds_read_b64_tr_b16 a[54:55], v7 offset:26528
s_waitcnt lgkmcnt(15)
v_mfma_f32_16x16x32_bf16 v[36:39], a[20:23], v[104:107], v[36:39]
ds_read_b64_tr_b16 a[56:57], v7 offset:26048
ds_read_b64_tr_b16 a[58:59], v7 offset:26560
v_mfma_f32_16x16x32_bf16 v[52:55], a[20:23], v[108:111], v[52:55]
buffer_load_dwordx4 v[92:95], v4, s[16:19], s53 offen offset:1024 sc1
s_waitcnt lgkmcnt(15)
v_mfma_f32_16x16x32_bf16 v[40:43], a[24:27], v[104:107], v[40:43]
ds_read_b64_tr_b16 a[60:61], v7 offset:26080
s_add_u32 s53, s53, 0x40000
v_mfma_f32_16x16x32_bf16 v[56:59], a[24:27], v[108:111], v[56:59]
ds_read_b64_tr_b16 a[62:63], v7 offset:26592
s_waitcnt lgkmcnt(15)
v_mfma_f32_16x16x32_bf16 v[44:47], a[28:31], v[104:107], v[44:47]
v_mfma_f32_16x16x32_bf16 v[60:63], a[28:31], v[108:111], v[60:63]
s_waitcnt lgkmcnt(0)
s_barrier
s_waitcnt vmcnt(11)
v_mfma_f32_16x16x32_bf16 v[32:35], a[32:35], v[112:115], v[32:35]
ds_read_b64_tr_b16 a[0:1], v7 offset:33280
ds_read_b64_tr_b16 a[2:3], v7 offset:33792
ds_read_b64_tr_b16 a[4:5], v7 offset:33312
s_waitcnt vmcnt(10)
v_mfma_f32_16x16x32_bf16 v[48:51], a[32:35], v[116:119], v[48:51]
ds_read_b64_tr_b16 a[6:7], v7 offset:33824
buffer_load_dwordx4 v[96:99], v4, s[16:19], s52 offen sc1
v_mfma_f32_16x16x32_bf16 v[36:39], a[36:39], v[112:115], v[36:39]
ds_read_b64_tr_b16 a[8:9], v7 offset:33344
buffer_load_dwordx4 v[100:103], v4, s[16:19], s52 offen offset:1024 sc1
v_mfma_f32_16x16x32_bf16 v[52:55], a[36:39], v[116:119], v[52:55]
ds_read_b64_tr_b16 a[10:11], v7 offset:33856
ds_read_b64_tr_b16 a[12:13], v7 offset:33376
s_add_u32 s52, s52, 0x40000
v_mfma_f32_16x16x32_bf16 v[40:43], a[40:43], v[112:115], v[40:43]
ds_read_b64_tr_b16 a[14:15], v7 offset:33888
buffer_load_dwordx4 v[104:107], v4, s[16:19], s53 offen sc1
v_mfma_f32_16x16x32_bf16 v[56:59], a[40:43], v[116:119], v[56:59]
ds_read_b64_tr_b16 a[16:17], v7 offset:34304
buffer_load_dwordx4 v[108:111], v4, s[16:19], s53 offen offset:1024 sc1
v_mfma_f32_16x16x32_bf16 v[44:47], a[44:47], v[112:115], v[44:47]
ds_read_b64_tr_b16 a[18:19], v7 offset:34816
ds_read_b64_tr_b16 a[20:21], v7 offset:34336
s_add_u32 s53, s53, 0x40000
s_add_u32 m0, s59, 66560
v_mfma_f32_16x16x32_bf16 v[60:63], a[44:47], v[116:119], v[60:63]
ds_read_b64_tr_b16 a[22:23], v7 offset:34848
buffer_load_dwordx4 v18, s[20:23], s58 offen lds
s_waitcnt vmcnt(14)
v_mfma_f32_16x16x32_bf16 v[32:35], a[48:51], v[120:123], v[32:35]
ds_read_b64_tr_b16 a[24:25], v7 offset:34368
buffer_load_dwordx4 v19, s[20:23], s58 offen offset:1024 lds
s_waitcnt vmcnt(14)
v_mfma_f32_16x16x32_bf16 v[48:51], a[48:51], v[124:127], v[48:51]
ds_read_b64_tr_b16 a[26:27], v7 offset:34880
ds_read_b64_tr_b16 a[28:29], v7 offset:34400
ds_read_b64_tr_b16 a[30:31], v7 offset:34912
v_mfma_f32_16x16x32_bf16 v[36:39], a[52:55], v[120:123], v[36:39]
buffer_load_dwordx4 v20, s[20:23], s58 offen offset:2048 lds
v_mfma_f32_16x16x32_bf16 v[52:55], a[52:55], v[124:127], v[52:55]
s_add_u32 s58, s58, 196608
s_add_u32 m0, s59, 78976
s_nop 0
buffer_load_dwordx4 v18, s[20:23], s58 offen lds
v_mfma_f32_16x16x32_bf16 v[40:43], a[56:59], v[120:123], v[40:43]
v_mfma_f32_16x16x32_bf16 v[56:59], a[56:59], v[124:127], v[56:59]
buffer_load_dwordx4 v19, s[20:23], s58 offen offset:1024 lds
v_mfma_f32_16x16x32_bf16 v[44:47], a[60:63], v[120:123], v[44:47]
v_mfma_f32_16x16x32_bf16 v[60:63], a[60:63], v[124:127], v[60:63]
s_waitcnt vmcnt(16) lgkmcnt(14)
v_mfma_f32_16x16x32_bf16 v[32:35], a[0:3], v[64:67], v[32:35]
ds_read_b64_tr_b16 a[32:33], v7 offset:41600
ds_read_b64_tr_b16 a[34:35], v7 offset:42112
s_waitcnt vmcnt(15)
v_mfma_f32_16x16x32_bf16 v[48:51], a[0:3], v[68:71], v[48:51]
ds_read_b64_tr_b16 a[36:37], v7 offset:41632
buffer_load_dwordx4 v[112:115], v4, s[16:19], s52 offen sc1
s_waitcnt lgkmcnt(15)
v_mfma_f32_16x16x32_bf16 v[36:39], a[4:7], v[64:67], v[36:39]
ds_read_b64_tr_b16 a[38:39], v7 offset:42144
buffer_load_dwordx4 v[116:119], v4, s[16:19], s52 offen offset:1024 sc1
v_mfma_f32_16x16x32_bf16 v[52:55], a[4:7], v[68:71], v[52:55]
ds_read_b64_tr_b16 a[40:41], v7 offset:41664
ds_read_b64_tr_b16 a[42:43], v7 offset:42176
s_add_u32 s52, s52, 0x40000
s_waitcnt lgkmcnt(15)
v_mfma_f32_16x16x32_bf16 v[40:43], a[8:11], v[64:67], v[40:43]
ds_read_b64_tr_b16 a[44:45], v7 offset:41696
buffer_load_dwordx4 v[120:123], v4, s[16:19], s53 offen sc1
v_mfma_f32_16x16x32_bf16 v[56:59], a[8:11], v[68:71], v[56:59]
ds_read_b64_tr_b16 a[46:47], v7 offset:42208
buffer_load_dwordx4 v[124:127], v4, s[16:19], s53 offen offset:1024 sc1
s_waitcnt lgkmcnt(15)
v_mfma_f32_16x16x32_bf16 v[44:47], a[12:15], v[64:67], v[44:47]
ds_read_b64_tr_b16 a[48:49], v7 offset:42624
ds_read_b64_tr_b16 a[50:51], v7 offset:43136
s_add_u32 s53, s53, 0x40000
v_mfma_f32_16x16x32_bf16 v[60:63], a[12:15], v[68:71], v[60:63]
ds_read_b64_tr_b16 a[52:53], v7 offset:42656
buffer_load_dwordx4 v20, s[20:23], s58 offen offset:2048 lds
s_waitcnt vmcnt(19) lgkmcnt(15)
v_mfma_f32_16x16x32_bf16 v[32:35], a[16:19], v[72:75], v[32:35]
s_add_u32 s58, s58, 196608
s_add_u32 m0, s59, 91392
s_nop 0
buffer_load_dwordx4 v18, s[20:23], s58 offen lds
s_waitcnt vmcnt(19)
v_mfma_f32_16x16x32_bf16 v[48:51], a[16:19], v[76:79], v[48:51]
ds_read_b64_tr_b16 a[54:55], v7 offset:43168
ds_read_b64_tr_b16 a[56:57], v7 offset:42688
v_mfma_f32_16x16x32_bf16 v[36:39], a[20:23], v[72:75], v[36:39]
ds_read_b64_tr_b16 a[58:59], v7 offset:43200
buffer_load_dwordx4 v19, s[20:23], s58 offen offset:1024 lds
v_mfma_f32_16x16x32_bf16 v[52:55], a[20:23], v[76:79], v[52:55]
ds_read_b64_tr_b16 a[60:61], v7 offset:42720
buffer_load_dwordx4 v20, s[20:23], s58 offen offset:2048 lds
s_waitcnt lgkmcnt(15)
v_mfma_f32_16x16x32_bf16 v[40:43], a[24:27], v[72:75], v[40:43]
ds_read_b64_tr_b16 a[62:63], v7 offset:43232
s_add_u32 s58, s58, 196608
s_add_u32 m0, s59, 103808
v_mfma_f32_16x16x32_bf16 v[56:59], a[24:27], v[76:79], v[56:59]
buffer_load_dwordx4 v18, s[20:23], s58 offen lds
v_mfma_f32_16x16x32_bf16 v[44:47], a[28:31], v[72:75], v[44:47]
v_mfma_f32_16x16x32_bf16 v[60:63], a[28:31], v[76:79], v[60:63]
s_waitcnt vmcnt(21) lgkmcnt(14)
v_mfma_f32_16x16x32_bf16 v[32:35], a[32:35], v[80:83], v[32:35]
ds_read_b64_tr_b16 a[0:1], v7 offset:49920
ds_read_b64_tr_b16 a[2:3], v7 offset:50432
s_waitcnt vmcnt(20)
v_mfma_f32_16x16x32_bf16 v[48:51], a[32:35], v[84:87], v[48:51]
ds_read_b64_tr_b16 a[4:5], v7 offset:49952
buffer_load_dwordx4 v19, s[20:23], s58 offen offset:1024 lds
s_waitcnt lgkmcnt(15)
v_mfma_f32_16x16x32_bf16 v[36:39], a[36:39], v[80:83], v[36:39]
ds_read_b64_tr_b16 a[6:7], v7 offset:50464
v_mfma_f32_16x16x32_bf16 v[52:55], a[36:39], v[84:87], v[52:55]
ds_read_b64_tr_b16 a[8:9], v7 offset:49984
buffer_load_dwordx4 v20, s[20:23], s58 offen offset:2048 lds
s_waitcnt lgkmcnt(15)
v_mfma_f32_16x16x32_bf16 v[40:43], a[40:43], v[80:83], v[40:43]
ds_read_b64_tr_b16 a[10:11], v7 offset:50496
s_add_u32 s58, s58, 196608
v_mfma_f32_16x16x32_bf16 v[56:59], a[40:43], v[84:87], v[56:59]
ds_read_b64_tr_b16 a[12:13], v7 offset:50016
s_add_u32 m0, s59, 116224
s_waitcnt lgkmcnt(15)
v_mfma_f32_16x16x32_bf16 v[44:47], a[44:47], v[80:83], v[44:47]
ds_read_b64_tr_b16 a[14:15], v7 offset:50528
buffer_load_dwordx4 v18, s[20:23], s58 offen lds
v_mfma_f32_16x16x32_bf16 v[60:63], a[44:47], v[84:87], v[60:63]
ds_read_b64_tr_b16 a[16:17], v7 offset:50944
ds_read_b64_tr_b16 a[18:19], v7 offset:51456
s_waitcnt vmcnt(22) lgkmcnt(15)
v_mfma_f32_16x16x32_bf16 v[32:35], a[48:51], v[88:91], v[32:35]
ds_read_b64_tr_b16 a[20:21], v7 offset:50976
s_waitcnt vmcnt(21)
v_mfma_f32_16x16x32_bf16 v[48:51], a[48:51], v[92:95], v[48:51]
ds_read_b64_tr_b16 a[22:23], v7 offset:51488
buffer_load_dwordx4 v19, s[20:23], s58 offen offset:1024 lds
s_waitcnt lgkmcnt(15)
v_mfma_f32_16x16x32_bf16 v[36:39], a[52:55], v[88:91], v[36:39]
ds_read_b64_tr_b16 a[24:25], v7 offset:51008
v_mfma_f32_16x16x32_bf16 v[52:55], a[52:55], v[92:95], v[52:55]
ds_read_b64_tr_b16 a[26:27], v7 offset:51520
s_waitcnt lgkmcnt(15)
v_mfma_f32_16x16x32_bf16 v[40:43], a[56:59], v[88:91], v[40:43]
ds_read_b64_tr_b16 a[28:29], v7 offset:51040
buffer_load_dwordx4 v20, s[20:23], s58 offen offset:2048 lds
v_mfma_f32_16x16x32_bf16 v[56:59], a[56:59], v[92:95], v[56:59]
ds_read_b64_tr_b16 a[30:31], v7 offset:51552
s_add_u32 s58, s58, 196608
s_waitcnt lgkmcnt(15)
v_mfma_f32_16x16x32_bf16 v[44:47], a[60:63], v[88:91], v[44:47]
v_mfma_f32_16x16x32_bf16 v[60:63], a[60:63], v[92:95], v[60:63]
s_waitcnt vmcnt(22) lgkmcnt(14)
v_mfma_f32_16x16x32_bf16 v[32:35], a[0:3], v[96:99], v[32:35]
ds_read_b64_tr_b16 a[32:33], v7 offset:58240
s_add_u32 m0, s59, 128640
s_waitcnt vmcnt(21)
v_mfma_f32_16x16x32_bf16 v[48:51], a[0:3], v[100:103], v[48:51]
buffer_load_dwordx4 v18, s[20:23], s58 offen lds
s_waitcnt lgkmcnt(13)
v_mfma_f32_16x16x32_bf16 v[36:39], a[4:7], v[96:99], v[36:39]
ds_read_b64_tr_b16 a[34:35], v7 offset:58752
ds_read_b64_tr_b16 a[36:37], v7 offset:58272
v_mfma_f32_16x16x32_bf16 v[52:55], a[4:7], v[100:103], v[52:55]
ds_read_b64_tr_b16 a[38:39], v7 offset:58784
s_waitcnt lgkmcnt(14)
v_mfma_f32_16x16x32_bf16 v[40:43], a[8:11], v[96:99], v[40:43]
ds_read_b64_tr_b16 a[40:41], v7 offset:58304
ds_read_b64_tr_b16 a[42:43], v7 offset:58816
v_mfma_f32_16x16x32_bf16 v[56:59], a[8:11], v[100:103], v[56:59]
buffer_load_dwordx4 v19, s[20:23], s58 offen offset:1024 lds
s_waitcnt lgkmcnt(14)
v_mfma_f32_16x16x32_bf16 v[44:47], a[12:15], v[96:99], v[44:47]
ds_read_b64_tr_b16 a[44:45], v7 offset:58336
ds_read_b64_tr_b16 a[46:47], v7 offset:58848
v_mfma_f32_16x16x32_bf16 v[60:63], a[12:15], v[100:103], v[60:63]
ds_read_b64_tr_b16 a[48:49], v7 offset:59264
s_waitcnt vmcnt(22) lgkmcnt(15)
v_mfma_f32_16x16x32_bf16 v[32:35], a[16:19], v[104:107], v[32:35]
ds_read_b64_tr_b16 a[50:51], v7 offset:59776
ds_read_b64_tr_b16 a[52:53], v7 offset:59296
s_waitcnt vmcnt(21)
v_mfma_f32_16x16x32_bf16 v[48:51], a[16:19], v[108:111], v[48:51]
ds_read_b64_tr_b16 a[54:55], v7 offset:59808
s_waitcnt lgkmcnt(15)
v_mfma_f32_16x16x32_bf16 v[36:39], a[20:23], v[104:107], v[36:39]
buffer_load_dwordx4 v20, s[20:23], s58 offen offset:2048 lds
v_mfma_f32_16x16x32_bf16 v[52:55], a[20:23], v[108:111], v[52:55]
ds_read_b64_tr_b16 a[56:57], v7 offset:59328
s_add_u32 s58, s58, 196608
s_waitcnt lgkmcnt(15)
v_mfma_f32_16x16x32_bf16 v[40:43], a[24:27], v[104:107], v[40:43]
ds_read_b64_tr_b16 a[58:59], v7 offset:59840
ds_read_b64_tr_b16 a[60:61], v7 offset:59360
v_mfma_f32_16x16x32_bf16 v[56:59], a[24:27], v[108:111], v[56:59]
ds_read_b64_tr_b16 a[62:63], v7 offset:59872
s_waitcnt lgkmcnt(15)
v_mfma_f32_16x16x32_bf16 v[44:47], a[28:31], v[104:107], v[44:47]
v_mfma_f32_16x16x32_bf16 v[60:63], a[28:31], v[108:111], v[60:63]
s_waitcnt vmcnt(16) lgkmcnt(14)
v_mfma_f32_16x16x32_bf16 v[32:35], a[32:35], v[112:115], v[32:35]
s_lshl_b32 s64, s6, 14
s_lshl_b32 s65, s49, 13
s_add_u32 s64, s64, s65
s_waitcnt vmcnt(15)
v_mfma_f32_16x16x32_bf16 v[48:51], a[32:35], v[116:119], v[48:51]
s_lshl_b32 s65, s7, 9
s_add_u32 s64, s64, s65
s_lshl_b32 s65, s48, 8
s_waitcnt lgkmcnt(12)
v_mfma_f32_16x16x32_bf16 v[36:39], a[36:39], v[112:115], v[36:39]
s_add_u32 s64, s64, s65
s_add_u32 s64, s64, 62914560
v_and_b32 v152, 31, v1
v_mfma_f32_16x16x32_bf16 v[52:55], a[36:39], v[116:119], v[52:55]
s_lshl_b32 s62, s7, 18
v_lshlrev_b32 v152, 3, v152
v_lshrrev_b32 v153, 5, v1
s_waitcnt lgkmcnt(10)
v_mfma_f32_16x16x32_bf16 v[40:43], a[40:43], v[112:115], v[40:43]
s_add_u32 s62, s62, 33554432
v_lshl_add_u32 v152, v153, 2, v152
s_add_u32 s63, s62, 0x20000
v_mfma_f32_16x16x32_bf16 v[56:59], a[40:43], v[116:119], v[56:59]
s_waitcnt lgkmcnt(8)
v_mfma_f32_16x16x32_bf16 v[44:47], a[44:47], v[112:115], v[44:47]
v_mfma_f32_16x16x32_bf16 v[60:63], a[44:47], v[116:119], v[60:63]
s_waitcnt vmcnt(14) lgkmcnt(6)
v_mfma_f32_16x16x32_bf16 v[32:35], a[48:51], v[120:123], v[32:35]
s_waitcnt vmcnt(13)
v_mfma_f32_16x16x32_bf16 v[48:51], a[48:51], v[124:127], v[48:51]
s_waitcnt lgkmcnt(4)
v_mfma_f32_16x16x32_bf16 v[36:39], a[52:55], v[120:123], v[36:39]
s_nop 3
v_cvt_pk_bf16_f32 v128, v32, v33
v_cvt_pk_bf16_f32 v129, v34, v35
v_mfma_f32_16x16x32_bf16 v[52:55], a[52:55], v[124:127], v[52:55]
v_cvt_pk_bf16_f32 v136, v48, v49
v_cvt_pk_bf16_f32 v137, v50, v51
s_waitcnt lgkmcnt(2)
v_mfma_f32_16x16x32_bf16 v[40:43], a[56:59], v[120:123], v[40:43]
v_cvt_pk_bf16_f32 v130, v36, v37
v_cvt_pk_bf16_f32 v131, v38, v39
v_mfma_f32_16x16x32_bf16 v[56:59], a[56:59], v[124:127], v[56:59]
buffer_store_dwordx4 v[128:131], v4, s[16:19], s62 offen sc1
s_waitcnt lgkmcnt(0)
v_mfma_f32_16x16x32_bf16 v[44:47], a[60:63], v[120:123], v[44:47]
s_nop 1
v_cvt_pk_bf16_f32 v132, v40, v41
v_cvt_pk_bf16_f32 v133, v42, v43
v_mfma_f32_16x16x32_bf16 v[60:63], a[60:63], v[124:127], v[60:63]
v_cvt_pk_bf16_f32 v138, v52, v53
v_cvt_pk_bf16_f32 v139, v54, v55
v_cvt_pk_bf16_f32 v140, v56, v57
v_cvt_pk_bf16_f32 v134, v44, v45
v_cvt_pk_bf16_f32 v135, v46, v47
v_cvt_pk_bf16_f32 v141, v58, v59
v_pk_mul_f32 v[146:147], v[32:33], v[32:33]
buffer_store_dwordx4 v[132:135], v4, s[16:19], s63 offen sc1
v_cvt_pk_bf16_f32 v142, v60, v61
v_cvt_pk_bf16_f32 v143, v62, v63
v_pk_mul_f32 v[150:151], v[48:49], v[48:49]
v_pk_fma_f32 v[146:147], v[34:35], v[34:35], v[146:147]
v_pk_add_f32 v[144:145], v[32:33], v[34:35]
v_pk_fma_f32 v[150:151], v[50:51], v[50:51], v[150:151]
v_pk_add_f32 v[148:149], v[48:49], v[50:51]
v_pk_fma_f32 v[146:147], v[36:37], v[36:37], v[146:147]
v_pk_add_f32 v[144:145], v[144:145], v[36:37]
v_pk_fma_f32 v[150:151], v[52:53], v[52:53], v[150:151]
v_pk_add_f32 v[148:149], v[148:149], v[52:53]
v_pk_fma_f32 v[146:147], v[38:39], v[38:39], v[146:147]
v_pk_add_f32 v[144:145], v[144:145], v[38:39]
buffer_store_dwordx4 v[136:139], v4, s[16:19], s62 offen offset:1024 sc1
v_pk_fma_f32 v[150:151], v[54:55], v[54:55], v[150:151]
v_pk_add_f32 v[148:149], v[148:149], v[54:55]
v_pk_fma_f32 v[146:147], v[40:41], v[40:41], v[146:147]
v_pk_add_f32 v[144:145], v[144:145], v[40:41]
v_pk_fma_f32 v[150:151], v[56:57], v[56:57], v[150:151]
v_pk_add_f32 v[148:149], v[148:149], v[56:57]
v_pk_fma_f32 v[146:147], v[42:43], v[42:43], v[146:147]
v_pk_add_f32 v[144:145], v[144:145], v[42:43]
v_pk_fma_f32 v[150:151], v[58:59], v[58:59], v[150:151]
v_pk_add_f32 v[148:149], v[148:149], v[58:59]
v_pk_fma_f32 v[146:147], v[44:45], v[44:45], v[146:147]
v_pk_add_f32 v[144:145], v[144:145], v[44:45]
v_pk_fma_f32 v[150:151], v[60:61], v[60:61], v[150:151]
buffer_store_dwordx4 v[140:143], v4, s[16:19], s63 offen offset:1024 sc1
v_pk_add_f32 v[148:149], v[148:149], v[60:61]
v_pk_fma_f32 v[146:147], v[46:47], v[46:47], v[146:147]
v_pk_add_f32 v[144:145], v[144:145], v[46:47]
v_pk_fma_f32 v[150:151], v[62:63], v[62:63], v[150:151]
v_pk_add_f32 v[148:149], v[148:149], v[62:63]
v_add_f32 v144, v144, v145
v_add_f32 v146, v146, v147
v_add_f32 v148, v148, v149
v_add_f32 v150, v150, v151
s_nop 0
v_permlane16_swap_b32 v144, v148
v_permlane16_swap_b32 v146, v150
v_add_f32 v144, v144, v148
v_add_f32 v146, v146, v150
s_nop 1
v_permlane32_swap_b32 v144, v146
v_add_f32 v144, v144, v146
buffer_store_dword v144, v152, s[16:19], s64 offen sc1
s_nop 1
v_accvgpr_write_b32 a224, v32
v_accvgpr_write_b32 a225, v33
v_accvgpr_write_b32 a226, v34
v_accvgpr_write_b32 a227, v35
v_accvgpr_write_b32 a228, v36
v_accvgpr_write_b32 a229, v37
v_accvgpr_write_b32 a230, v38
v_accvgpr_write_b32 a231, v39
v_accvgpr_write_b32 a232, v40
v_accvgpr_write_b32 a233, v41
v_accvgpr_write_b32 a234, v42
v_accvgpr_write_b32 a235, v43
v_accvgpr_write_b32 a236, v44
v_accvgpr_write_b32 a237, v45
v_accvgpr_write_b32 a238, v46
v_accvgpr_write_b32 a239, v47
v_accvgpr_write_b32 a240, v48
v_accvgpr_write_b32 a241, v49
v_accvgpr_write_b32 a242, v50
v_accvgpr_write_b32 a243, v51
v_accvgpr_write_b32 a244, v52
v_accvgpr_write_b32 a245, v53
v_accvgpr_write_b32 a246, v54
v_accvgpr_write_b32 a247, v55
v_accvgpr_write_b32 a248, v56
v_accvgpr_write_b32 a249, v57
v_accvgpr_write_b32 a250, v58
v_accvgpr_write_b32 a251, v59
v_accvgpr_write_b32 a252, v60
v_accvgpr_write_b32 a253, v61
v_accvgpr_write_b32 a254, v62
v_accvgpr_write_b32 a255, v63
s_lshl_b32 s62, s8, 13
s_lshl_b32 s63, s3, 11
s_add_u32 s62, s62, s63
v_lshl_add_u32 v21, v1, 4, s62
v_lshrrev_b32 v2, 3, v1
v_cmp_eq_u32 vcc, 3, v2
v_add_u32 v2, 67108480, v21
s_nop 0
v_cndmask_b32 v21, v21, v2, vcc
s_lshl_b32 s62, s50, 10
s_sub_u32 s62, s62, 2048
v_lshl_add_u32 v22, v0, 2, s62
v_lshrrev_b32 v2, 5, v0
v_cmp_eq_u32 vcc, 3, v2
v_add_u32 v2, 67108480, v22
s_nop 0
v_cndmask_b32 v22, v22, v2, vcc
s_mul_i32 s62, s48, 4608
v_lshl_add_u32 v23, v1, 4, s62
v_lshrrev_b32 v24, 4, v1
v_mul_u32_u24 v24, 2304, v24
v_and_b32 v2, 15, v1
v_lshl_add_u32 v24, v2, 4, v24
v_bfe_u32 v25, v1, 3, 2
v_mul_u32_u24 v25, 3104, v25
v_bfe_u32 v2, v1, 2, 1
v_lshl_add_u32 v25, v2, 7, v25
v_bfe_u32 v2, v1, 5, 1
v_lshl_add_u32 v25, v2, 8, v25
v_and_b32 v2, 3, v1
v_lshl_add_u32 v25, v2, 3, v25
s_lshl_b32 s62, s49, 6
s_add_u32 s62, s62, 66560
v_add_u32 v25, s62, v25
s_lshl_b32 s62, s8, 1
s_add_u32 s62, s62, s3
s_lshr_b32 s63, s50, 2
s_cmp_lt_u32 s3, 2
s_cselect_b32 s62, s62, s63
s_lshl_b32 s62, s62, 13
v_lshl_add_u32 v26, v1, 4, s62
s_mov_b32 s52, 33554432
s_mov_b32 s54, s58
s_mov_b32 s56, s59
s_mul_i32 s55, s3, 2304
s_mul_i32 s59, s3, 2080
v_bfe_u32 v5, v1, 3, 1
v_lshrrev_b32 v2, 4, v1
v_lshl_add_u32 v5, v2, 3, v5
s_lshl_b32 s62, s3, 1
v_add_u32 v5, s62, v5
v_mul_u32_u24 v5, 2048, v5
v_and_b32 v2, 7, v1
v_lshl_add_u32 v5, v2, 4, v5
s_lshl_b32 s62, s7, 7
v_add_u32 v5, s62, v5
v_add_u32 v6, 64512, v5
s_lshl_b32 s62, s6, 7
s_add_u32 s62, s62, 30416896
s_lshl_b32 s64, s8, 7
s_add_u32 s64, s64, 30416896
s_lshr_b32 s65, s50, 3
s_lshl_b32 s65, s65, 7
s_add_u32 s65, s65, 30416896
v_mov_b32 v252, s62
v_mov_b32 v253, s64
v_writelane_b32 v253, s65, 1
s_waitcnt vmcnt(0) lgkmcnt(0)
s_barrier
s_cmp_lg_u32 s3, 0
s_cbranch_scc1 .Lnosig27
v_mov_b32 v255, 1
s_mov_b64 exec, 1
buffer_atomic_add v255, v252, s[16:19], 0 offen
s_mov_b64 exec, -1
.Lnosig27:
ds_read_b64_tr_b16 a[20:21], v25
ds_read_b64_tr_b16 a[22:23], v25 offset:512
ds_read_b64_tr_b16 a[24:25], v25 offset:32
ds_read_b64_tr_b16 a[26:27], v25 offset:544
ds_read_b64_tr_b16 a[28:29], v25 offset:1024
ds_read_b64_tr_b16 a[30:31], v25 offset:1536
ds_read_b64_tr_b16 a[32:33], v25 offset:1056
ds_read_b64_tr_b16 a[34:35], v25 offset:1568
ds_read_b64_tr_b16 a[36:37], v25 offset:2048
ds_read_b64_tr_b16 a[38:39], v25 offset:2560
ds_read_b64_tr_b16 a[40:41], v25 offset:2080
ds_read_b64_tr_b16 a[42:43], v25 offset:2592
v_lshrrev_b32 v2, 4, v1
v_lshlrev_b32 v2, 2, v2
v_and_b32 v13, 15, v1
v_sub_u32 v2, v13, v2
v_mov_b32 v13, 0xff61b1e6
v_subrev_u32 v54, 0, v2
v_cmp_gt_u32 vcc, 8, v54
s_nop 1
v_cndmask_b32 v50, v13, 0, vcc
v_cmp_gt_i32 vcc, -8, v54
s_nop 1
v_cndmask_b32 v46, v13, 0, vcc
v_subrev_u32 v54, 1, v2
v_cmp_gt_u32 vcc, 8, v54
s_nop 1
v_cndmask_b32 v51, v13, 0, vcc
v_cmp_gt_i32 vcc, -8, v54
s_nop 1
v_cndmask_b32 v47, v13, 0, vcc
v_subrev_u32 v54, 2, v2
v_cmp_gt_u32 vcc, 8, v54
s_nop 1
v_cndmask_b32 v52, v13, 0, vcc
v_cmp_gt_i32 vcc, -8, v54
s_nop 1
v_cndmask_b32 v48, v13, 0, vcc
v_subrev_u32 v54, 3, v2
v_cmp_gt_u32 vcc, 8, v54
s_nop 1
v_cndmask_b32 v53, v13, 0, vcc
v_cmp_gt_i32 vcc, -8, v54
s_nop 1
v_cndmask_b32 v49, v13, 0, vcc
s_cmp_lt_u32 s8, 2
s_cselect_b64 vcc, -1, 0
v_cndmask_b32 v54, v46, v13, vcc
v_cndmask_b32 v55, v47, v13, vcc
v_cndmask_b32 v56, v48, v13, vcc
v_cndmask_b32 v57, v49, v13, vcc
v_mov_b64 v[60:61], 0
v_mov_b64 v[62:63], 0
v_mov_b64 v[64:65], 0
v_mov_b64 v[66:67], 0
v_mov_b64 v[68:69], 0
v_mov_b64 v[70:71], 0
v_mov_b64 v[72:73], 0
v_mov_b64 v[74:75], 0
v_mov_b64 v[76:77], 0
v_mov_b64 v[78:79], 0
v_mov_b64 v[80:81], 0
v_mov_b64 v[82:83], 0
v_mov_b64 v[84:85], 0
v_mov_b64 v[86:87], 0
v_mov_b64 v[88:89], 0
v_mov_b64 v[90:91], 0
v_mov_b64 v[92:93], 0
v_mov_b64 v[94:95], 0
v_mov_b64 v[96:97], 0
v_mov_b64 v[98:99], 0
v_mov_b64 v[100:101], 0
v_mov_b64 v[102:103], 0
v_mov_b64 v[104:105], 0
v_mov_b64 v[106:107], 0
v_mov_b64 v[108:109], 0
v_mov_b64 v[110:111], 0
v_mov_b64 v[112:113], 0
v_mov_b64 v[114:115], 0
v_mov_b64 v[116:117], 0
v_mov_b64 v[118:119], 0
v_mov_b64 v[120:121], 0
v_mov_b64 v[122:123], 0
v_mov_b64 v[124:125], 0
v_mov_b64 v[126:127], 0
v_mov_b64 v[128:129], 0
v_mov_b64 v[130:131], 0
v_mov_b64 v[132:133], 0
v_mov_b64 v[134:135], 0
v_mov_b64 v[136:137], 0
v_mov_b64 v[138:139], 0
v_mov_b64 v[140:141], 0
v_mov_b64 v[142:143], 0
v_mov_b64 v[144:145], 0
v_mov_b64 v[146:147], 0
v_mov_b64 v[148:149], 0
v_mov_b64 v[150:151], 0
v_mov_b64 v[152:153], 0
v_mov_b64 v[154:155], 0
v_mov_b64 v[156:157], 0
v_mov_b64 v[158:159], 0
v_mov_b64 v[160:161], 0
v_mov_b64 v[162:163], 0
v_and_b32 v10, 15, v1
v_lshlrev_b32 v12, 2, v10
v_lshlrev_b32 v10, 4, v10
v_add_u32 v10, 151552, v10
v_lshrrev_b32 v11, 4, v1
v_lshlrev_b32 v11, 4, v11
s_lshl_b32 s62, s49, 7
s_add_u32 s62, s62, 157696
v_add_u32 v12, s62, v12
v_add_u32 v13, s62, v11
v_add_u32 v11, 155648, v11
s_lshl_b32 s62, s3, 11
s_add_u32 s62, s62, 143360
v_lshl_add_u32 v8, v1, 4, s62
.Lpad16:
s_cbranch_execz .Lnopoll25r
v_xor_b32 v9, 2048, v8
v_mov_b32 v248, 0x3f803f80
v_mov_b32 v249, 0x3f803f80
v_mov_b32 v250, 0x3f803f80
v_mov_b32 v251, 0x3f803f80
v_and_b32 v7, 31, v1
v_lshrrev_b32 v2, 5, v1
v_lshl_add_u32 v7, v7, 1, v2
v_and_b32 v2, 0xc0, v0
v_add_u32 v7, v7, v2
v_lshlrev_b32 v17, 2, v7
v_add_u32 v17, 155648, v17
v_lshlrev_b32 v7, 4, v7
v_add_u32 v7, 151552, v7
s_lshl_b32 s74, s9, 1
s_add_u32 s74, s74, s49
s_lshl_b32 s74, s74, 17
s_lshl_b32 s63, s8, 13
s_add_u32 s74, s74, s63
s_lshl_b32 s63, s48, 12
s_add_u32 s74, s74, s63
s_add_u32 s74, s74, 37748736
s_mov_b32 s62, 0
v_lshl_add_u32 v4, v1, 4, s62
v_lshrrev_b32 v2, 3, v1
v_cmp_eq_u32 vcc, 3, v2
v_add_u32 v2, 67108480, v4
s_nop 0
v_cndmask_b32 v4, v4, v2, vcc
ds_read_b128 v[28:31], v13
ds_read_b128 v[32:35], v13 offset:64
ds_read_b128 v[36:39], v13 offset:256
ds_read_b128 v[40:43], v13 offset:320
ds_read_b32 v44, v12 offset:512
ds_read_b32 v45, v12 offset:576
s_waitcnt lgkmcnt(0)
s_cmp_lg_u32 s3, 1
s_cbranch_scc1 .Lnopoll30
s_mov_b64 exec, 3
s_mov_b32 s15, 0
.Lpoll28:
buffer_load_dword v255, v253, s[16:19], 0 offen sc1
s_add_u32 s15, s15, 1
s_cmp_gt_u32 s15, 100000
s_cbranch_scc1 .Lgot29
s_waitcnt vmcnt(0)
v_cmp_ne_u32 vcc, 16, v255
s_nop 0
s_cbranch_vccnz .Lpoll28
.Lgot29:
s_waitcnt vmcnt(0)
s_branch .Lnopoll30r
.Lnopoll30:
s_mov_b64 exec, 0
s_cmp_eq_u32 s3, 2
s_cbranch_scc1 .Lpad17
s_cmp_eq_u32 s3, 3
s_cbranch_scc1 .Lpad18
s_branch .Lpad19
.Lnopoll30r:
s_mov_b64 exec, -1
s_barrier
s_cmp_eq_u32 s48, 1
s_cbranch_scc1 .Lqkv31
s_add_u32 m0, s55, 0
s_nop 0
buffer_load_dwordx4 v21, s[16:19], s52 offen sc1 lds
buffer_load_dwordx4 v21, s[16:19], s52 offen offset:1024 sc1 lds
buffer_load_dword v22, s[16:19], s52 offen offset:2048 sc1 lds
s_add_u32 s52, s52, 0x20000
s_add_u32 m0, s55, 9216
s_nop 0
buffer_load_dwordx4 v21, s[16:19], s52 offen sc1 lds
buffer_load_dwordx4 v21, s[16:19], s52 offen offset:1024 sc1 lds
buffer_load_dword v22, s[16:19], s52 offen offset:2048 sc1 lds
s_add_u32 s52, s52, 0x20000
s_add_u32 m0, s55, 18432
s_nop 0
buffer_load_dwordx4 v21, s[16:19], s52 offen sc1 lds
buffer_load_dwordx4 v21, s[16:19], s52 offen offset:1024 sc1 lds
buffer_load_dword v22, s[16:19], s52 offen offset:2048 sc1 lds
s_add_u32 s52, s52, 0x20000
s_add_u32 m0, s55, 27648
s_nop 0
buffer_load_dwordx4 v21, s[16:19], s52 offen sc1 lds
buffer_load_dwordx4 v21, s[16:19], s52 offen offset:1024 sc1 lds
buffer_load_dword v22, s[16:19], s52 offen offset:2048 sc1 lds
s_add_u32 s52, s52, 0x20000
s_add_u32 m0, s55, 36864
s_nop 0
buffer_load_dwordx4 v21, s[16:19], s52 offen sc1 lds
buffer_load_dwordx4 v21, s[16:19], s52 offen offset:1024 sc1 lds
buffer_load_dword v22, s[16:19], s52 offen offset:2048 sc1 lds
s_add_u32 s52, s52, 0x20000
s_add_u32 m0, s55, 46080
s_nop 0
buffer_load_dwordx4 v21, s[16:19], s52 offen sc1 lds
buffer_load_dwordx4 v21, s[16:19], s52 offen offset:1024 sc1 lds
buffer_load_dword v22, s[16:19], s52 offen offset:2048 sc1 lds
s_add_u32 s52, s52, 0x20000
s_waitcnt vmcnt(15)
s_barrier
ds_read_b128 a[0:3], v23
ds_read_b128 a[4:7], v23 offset:1024
ds_read_b128 a[8:11], v23 offset:2304
ds_read_b128 a[12:15], v23 offset:3328
ds_read_b128 a[16:19], v24 offset:2048
s_mov_b32 s15, 4
.p2align 6
.Lk33:
s_waitcnt vmcnt(12) lgkmcnt(0)
s_barrier
v_mfma_f32_16x16x32_bf16 v[60:63], a[20:23], a[0:3], v[60:63]
ds_read_b64_tr_b16 a[64:65], v25 offset:12416
s_add_u32 m0, s56, 66560
v_mfma_f32_16x16x32_bf16 v[64:67], a[20:23], a[4:7], v[64:67]
buffer_load_dwordx4 v18, s[20:23], s54 offen lds
v_mfma_f32_16x16x32_bf16 v[68:71], a[20:23], a[8:11], v[68:71]
ds_read_b64_tr_b16 a[66:67], v25 offset:12928
v_mfma_f32_16x16x32_bf16 v[72:75], a[20:23], a[12:15], v[72:75]
ds_read_b64_tr_b16 a[68:69], v25 offset:12448
ds_read_b64_tr_b16 a[70:71], v25 offset:12960
v_mfma_f32_16x16x32_bf16 v[76:79], a[24:27], a[0:3], v[76:79]
ds_read_b64_tr_b16 a[72:73], v25 offset:13440
v_mfma_f32_16x16x32_bf16 v[80:83], a[24:27], a[4:7], v[80:83]
buffer_load_dwordx4 v19, s[20:23], s54 offen offset:1024 lds
v_mfma_f32_16x16x32_bf16 v[84:87], a[24:27], a[8:11], v[84:87]
ds_read_b64_tr_b16 a[74:75], v25 offset:13952
v_mfma_f32_16x16x32_bf16 v[88:91], a[24:27], a[12:15], v[88:91]
ds_read_b64_tr_b16 a[76:77], v25 offset:13472
v_mfma_f32_16x16x32_bf16 v[92:95], a[28:31], a[0:3], v[92:95]
ds_read_b64_tr_b16 a[78:79], v25 offset:13984
ds_read_b128 a[44:47], v23 offset:9216
v_mfma_f32_16x16x32_bf16 v[96:99], a[28:31], a[4:7], v[96:99]
buffer_load_dwordx4 v20, s[20:23], s54 offen offset:2048 lds
v_mfma_f32_16x16x32_bf16 v[100:103], a[28:31], a[8:11], v[100:103]
s_add_u32 s54, s54, 196608
v_mfma_f32_16x16x32_bf16 v[104:107], a[28:31], a[12:15], v[104:107]
ds_read_b128 a[48:51], v23 offset:10240
ds_read_b64_tr_b16 a[80:81], v25 offset:14464
v_mfma_f32_16x16x32_bf16 v[156:159], a[28:31], a[16:19], v[156:159]
s_add_u32 m0, s55, 0
v_mfma_f32_16x16x32_bf16 v[108:111], a[32:35], a[0:3], v[108:111]
buffer_load_dwordx4 v21, s[16:19], s52 offen sc1 lds
v_mfma_f32_16x16x32_bf16 v[112:115], a[32:35], a[4:7], v[112:115]
ds_read_b64_tr_b16 a[82:83], v25 offset:14976
v_mfma_f32_16x16x32_bf16 v[116:119], a[32:35], a[8:11], v[116:119]
ds_read_b128 a[52:55], v23 offset:11520
ds_read_b128 a[56:59], v23 offset:12544
v_mfma_f32_16x16x32_bf16 v[120:123], a[32:35], a[12:15], v[120:123]
ds_read_b64_tr_b16 a[84:85], v25 offset:14496
v_mfma_f32_16x16x32_bf16 v[160:163], a[32:35], a[16:19], v[160:163]
buffer_load_dwordx4 v21, s[16:19], s52 offen offset:1024 sc1 lds
v_mfma_f32_16x16x32_bf16 v[124:127], a[0:3], a[36:39], v[124:127]
ds_read_b64_tr_b16 a[86:87], v25 offset:15008
v_mfma_f32_16x16x32_bf16 v[128:131], a[4:7], a[36:39], v[128:131]
ds_read_b128 a[60:63], v24 offset:11264
v_mfma_f32_16x16x32_bf16 v[132:135], a[8:11], a[36:39], v[132:135]
v_mfma_f32_16x16x32_bf16 v[136:139], a[12:15], a[36:39], v[136:139]
buffer_load_dword v22, s[16:19], s52 offen offset:2048 sc1 lds
v_mfma_f32_16x16x32_bf16 v[140:143], a[0:3], a[40:43], v[140:143]
s_add_u32 s52, s52, 0x20000
v_mfma_f32_16x16x32_bf16 v[144:147], a[4:7], a[40:43], v[144:147]
v_mfma_f32_16x16x32_bf16 v[148:151], a[8:11], a[40:43], v[148:151]
v_mfma_f32_16x16x32_bf16 v[152:155], a[12:15], a[40:43], v[152:155]
s_waitcnt vmcnt(15) lgkmcnt(0)
s_barrier
v_mfma_f32_16x16x32_bf16 v[60:63], a[64:67], a[44:47], v[60:63]
ds_read_b64_tr_b16 a[20:21], v25 offset:24832
s_add_u32 m0, s56, 78976
v_mfma_f32_16x16x32_bf16 v[64:67], a[64:67], a[48:51], v[64:67]
buffer_load_dwordx4 v18, s[20:23], s54 offen lds
v_mfma_f32_16x16x32_bf16 v[68:71], a[64:67], a[52:55], v[68:71]
ds_read_b64_tr_b16 a[22:23], v25 offset:25344
v_mfma_f32_16x16x32_bf16 v[72:75], a[64:67], a[56:59], v[72:75]
ds_read_b64_tr_b16 a[24:25], v25 offset:24864
ds_read_b64_tr_b16 a[26:27], v25 offset:25376
v_mfma_f32_16x16x32_bf16 v[76:79], a[68:71], a[44:47], v[76:79]
ds_read_b64_tr_b16 a[28:29], v25 offset:25856
v_mfma_f32_16x16x32_bf16 v[80:83], a[68:71], a[48:51], v[80:83]
buffer_load_dwordx4 v19, s[20:23], s54 offen offset:1024 lds
v_mfma_f32_16x16x32_bf16 v[84:87], a[68:71], a[52:55], v[84:87]
ds_read_b64_tr_b16 a[30:31], v25 offset:26368
v_mfma_f32_16x16x32_bf16 v[88:91], a[68:71], a[56:59], v[88:91]
ds_read_b64_tr_b16 a[32:33], v25 offset:25888
v_mfma_f32_16x16x32_bf16 v[92:95], a[72:75], a[44:47], v[92:95]
ds_read_b64_tr_b16 a[34:35], v25 offset:26400
ds_read_b128 a[0:3], v23 offset:18432
v_mfma_f32_16x16x32_bf16 v[96:99], a[72:75], a[48:51], v[96:99]
buffer_load_dwordx4 v20, s[20:23], s54 offen offset:2048 lds
v_mfma_f32_16x16x32_bf16 v[100:103], a[72:75], a[52:55], v[100:103]
s_add_u32 s54, s54, 196608
v_mfma_f32_16x16x32_bf16 v[104:107], a[72:75], a[56:59], v[104:107]
ds_read_b128 a[4:7], v23 offset:19456
ds_read_b64_tr_b16 a[36:37], v25 offset:26880
v_mfma_f32_16x16x32_bf16 v[156:159], a[72:75], a[60:63], v[156:159]
s_add_u32 m0, s55, 9216
v_mfma_f32_16x16x32_bf16 v[108:111], a[76:79], a[44:47], v[108:111]
buffer_load_dwordx4 v21, s[16:19], s52 offen sc1 lds
v_mfma_f32_16x16x32_bf16 v[112:115], a[76:79], a[48:51], v[112:115]
ds_read_b64_tr_b16 a[38:39], v25 offset:27392
v_mfma_f32_16x16x32_bf16 v[116:119], a[76:79], a[52:55], v[116:119]
ds_read_b128 a[8:11], v23 offset:20736
ds_read_b128 a[12:15], v23 offset:21760
v_mfma_f32_16x16x32_bf16 v[120:123], a[76:79], a[56:59], v[120:123]
ds_read_b64_tr_b16 a[40:41], v25 offset:26912
v_mfma_f32_16x16x32_bf16 v[160:163], a[76:79], a[60:63], v[160:163]
buffer_load_dwordx4 v21, s[16:19], s52 offen offset:1024 sc1 lds
v_mfma_f32_16x16x32_bf16 v[124:127], a[44:47], a[80:83], v[124:127]
ds_read_b64_tr_b16 a[42:43], v25 offset:27424
v_mfma_f32_16x16x32_bf16 v[128:131], a[48:51], a[80:83], v[128:131]
ds_read_b128 a[16:19], v24 offset:20480
v_mfma_f32_16x16x32_bf16 v[132:135], a[52:55], a[80:83], v[132:135]
v_mfma_f32_16x16x32_bf16 v[136:139], a[56:59], a[80:83], v[136:139]
buffer_load_dword v22, s[16:19], s52 offen offset:2048 sc1 lds
v_mfma_f32_16x16x32_bf16 v[140:143], a[44:47], a[84:87], v[140:143]
s_add_u32 s52, s52, 0x20000
v_mfma_f32_16x16x32_bf16 v[144:147], a[48:51], a[84:87], v[144:147]
v_mfma_f32_16x16x32_bf16 v[148:151], a[52:55], a[84:87], v[148:151]
v_mfma_f32_16x16x32_bf16 v[152:155], a[56:59], a[84:87], v[152:155]
s_waitcnt vmcnt(18) lgkmcnt(0)
s_barrier
v_mfma_f32_16x16x32_bf16 v[60:63], a[20:23], a[0:3], v[60:63]
ds_read_b64_tr_b16 a[64:65], v25 offset:37248
s_add_u32 m0, s56, 91392
v_mfma_f32_16x16x32_bf16 v[64:67], a[20:23], a[4:7], v[64:67]
buffer_load_dwordx4 v18, s[20:23], s54 offen lds
v_mfma_f32_16x16x32_bf16 v[68:71], a[20:23], a[8:11], v[68:71]
ds_read_b64_tr_b16 a[66:67], v25 offset:37760
v_mfma_f32_16x16x32_bf16 v[72:75], a[20:23], a[12:15], v[72:75]
ds_read_b64_tr_b16 a[68:69], v25 offset:37280
ds_read_b64_tr_b16 a[70:71], v25 offset:37792
v_mfma_f32_16x16x32_bf16 v[76:79], a[24:27], a[0:3], v[76:79]
ds_read_b64_tr_b16 a[72:73], v25 offset:38272
v_mfma_f32_16x16x32_bf16 v[80:83], a[24:27], a[4:7], v[80:83]
buffer_load_dwordx4 v19, s[20:23], s54 offen offset:1024 lds
v_mfma_f32_16x16x32_bf16 v[84:87], a[24:27], a[8:11], v[84:87]
ds_read_b64_tr_b16 a[74:75], v25 offset:38784
v_mfma_f32_16x16x32_bf16 v[88:91], a[24:27], a[12:15], v[88:91]
ds_read_b64_tr_b16 a[76:77], v25 offset:38304
v_mfma_f32_16x16x32_bf16 v[92:95], a[28:31], a[0:3], v[92:95]
ds_read_b64_tr_b16 a[78:79], v25 offset:38816
ds_read_b128 a[44:47], v23 offset:27648
v_mfma_f32_16x16x32_bf16 v[96:99], a[28:31], a[4:7], v[96:99]
buffer_load_dwordx4 v20, s[20:23], s54 offen offset:2048 lds
v_mfma_f32_16x16x32_bf16 v[100:103], a[28:31], a[8:11], v[100:103]
s_add_u32 s54, s54, 196608
v_mfma_f32_16x16x32_bf16 v[104:107], a[28:31], a[12:15], v[104:107]
ds_read_b128 a[48:51], v23 offset:28672
ds_read_b64_tr_b16 a[80:81], v25 offset:39296
v_mfma_f32_16x16x32_bf16 v[156:159], a[28:31], a[16:19], v[156:159]
s_add_u32 m0, s55, 18432
v_mfma_f32_16x16x32_bf16 v[108:111], a[32:35], a[0:3], v[108:111]
buffer_load_dwordx4 v21, s[16:19], s52 offen sc1 lds
v_mfma_f32_16x16x32_bf16 v[112:115], a[32:35], a[4:7], v[112:115]
ds_read_b64_tr_b16 a[82:83], v25 offset:39808
v_mfma_f32_16x16x32_bf16 v[116:119], a[32:35], a[8:11], v[116:119]
ds_read_b128 a[52:55], v23 offset:29952
ds_read_b128 a[56:59], v23 offset:30976
v_mfma_f32_16x16x32_bf16 v[120:123], a[32:35], a[12:15], v[120:123]
ds_read_b64_tr_b16 a[84:85], v25 offset:39328
v_mfma_f32_16x16x32_bf16 v[160:163], a[32:35], a[16:19], v[160:163]
buffer_load_dwordx4 v21, s[16:19], s52 offen offset:1024 sc1 lds
v_mfma_f32_16x16x32_bf16 v[124:127], a[0:3], a[36:39], v[124:127]
ds_read_b64_tr_b16 a[86:87], v25 offset:39840
v_mfma_f32_16x16x32_bf16 v[128:131], a[4:7], a[36:39], v[128:131]
ds_read_b128 a[60:63], v24 offset:29696
v_mfma_f32_16x16x32_bf16 v[132:135], a[8:11], a[36:39], v[132:135]
v_mfma_f32_16x16x32_bf16 v[136:139], a[12:15], a[36:39], v[136:139]
buffer_load_dword v22, s[16:19], s52 offen offset:2048 sc1 lds
v_mfma_f32_16x16x32_bf16 v[140:143], a[0:3], a[40:43], v[140:143]
s_add_u32 s52, s52, 0x20000
v_mfma_f32_16x16x32_bf16 v[144:147], a[4:7], a[40:43], v[144:147]
v_mfma_f32_16x16x32_bf16 v[148:151], a[8:11], a[40:43], v[148:151]
v_mfma_f32_16x16x32_bf16 v[152:155], a[12:15], a[40:43], v[152:155]
s_waitcnt vmcnt(21) lgkmcnt(0)
s_barrier
v_mfma_f32_16x16x32_bf16 v[60:63], a[64:67], a[44:47], v[60:63]
ds_read_b64_tr_b16 a[20:21], v25 offset:49664
s_add_u32 m0, s56, 103808
v_mfma_f32_16x16x32_bf16 v[64:67], a[64:67], a[48:51], v[64:67]
buffer_load_dwordx4 v18, s[20:23], s54 offen lds
v_mfma_f32_16x16x32_bf16 v[68:71], a[64:67], a[52:55], v[68:71]
ds_read_b64_tr_b16 a[22:23], v25 offset:50176
v_mfma_f32_16x16x32_bf16 v[72:75], a[64:67], a[56:59], v[72:75]
ds_read_b64_tr_b16 a[24:25], v25 offset:49696
ds_read_b64_tr_b16 a[26:27], v25 offset:50208
v_mfma_f32_16x16x32_bf16 v[76:79], a[68:71], a[44:47], v[76:79]
ds_read_b64_tr_b16 a[28:29], v25 offset:50688
v_mfma_f32_16x16x32_bf16 v[80:83], a[68:71], a[48:51], v[80:83]
buffer_load_dwordx4 v19, s[20:23], s54 offen offset:1024 lds
v_mfma_f32_16x16x32_bf16 v[84:87], a[68:71], a[52:55], v[84:87]
ds_read_b64_tr_b16 a[30:31], v25 offset:51200
v_mfma_f32_16x16x32_bf16 v[88:91], a[68:71], a[56:59], v[88:91]
ds_read_b64_tr_b16 a[32:33], v25 offset:50720
v_mfma_f32_16x16x32_bf16 v[92:95], a[72:75], a[44:47], v[92:95]
ds_read_b64_tr_b16 a[34:35], v25 offset:51232
ds_read_b128 a[0:3], v23 offset:36864
v_mfma_f32_16x16x32_bf16 v[96:99], a[72:75], a[48:51], v[96:99]
buffer_load_dwordx4 v20, s[20:23], s54 offen offset:2048 lds
v_mfma_f32_16x16x32_bf16 v[100:103], a[72:75], a[52:55], v[100:103]
s_add_u32 s54, s54, 196608
v_mfma_f32_16x16x32_bf16 v[104:107], a[72:75], a[56:59], v[104:107]
ds_read_b128 a[4:7], v23 offset:37888
ds_read_b64_tr_b16 a[36:37], v25 offset:51712
v_mfma_f32_16x16x32_bf16 v[156:159], a[72:75], a[60:63], v[156:159]
s_add_u32 m0, s55, 27648
v_mfma_f32_16x16x32_bf16 v[108:111], a[76:79], a[44:47], v[108:111]
buffer_load_dwordx4 v21, s[16:19], s52 offen sc1 lds
v_mfma_f32_16x16x32_bf16 v[112:115], a[76:79], a[48:51], v[112:115]
ds_read_b64_tr_b16 a[38:39], v25 offset:52224
v_mfma_f32_16x16x32_bf16 v[116:119], a[76:79], a[52:55], v[116:119]
ds_read_b128 a[8:11], v23 offset:39168
ds_read_b128 a[12:15], v23 offset:40192
v_mfma_f32_16x16x32_bf16 v[120:123], a[76:79], a[56:59], v[120:123]
ds_read_b64_tr_b16 a[40:41], v25 offset:51744
v_mfma_f32_16x16x32_bf16 v[160:163], a[76:79], a[60:63], v[160:163]
buffer_load_dwordx4 v21, s[16:19], s52 offen offset:1024 sc1 lds
v_mfma_f32_16x16x32_bf16 v[124:127], a[44:47], a[80:83], v[124:127]
ds_read_b64_tr_b16 a[42:43], v25 offset:52256
v_mfma_f32_16x16x32_bf16 v[128:131], a[48:51], a[80:83], v[128:131]
ds_read_b128 a[16:19], v24 offset:38912
v_mfma_f32_16x16x32_bf16 v[132:135], a[52:55], a[80:83], v[132:135]
v_mfma_f32_16x16x32_bf16 v[136:139], a[56:59], a[80:83], v[136:139]
buffer_load_dword v22, s[16:19], s52 offen offset:2048 sc1 lds
v_mfma_f32_16x16x32_bf16 v[140:143], a[44:47], a[84:87], v[140:143]
s_add_u32 s52, s52, 0x20000
v_mfma_f32_16x16x32_bf16 v[144:147], a[48:51], a[84:87], v[144:147]
v_mfma_f32_16x16x32_bf16 v[148:151], a[52:55], a[84:87], v[148:151]
v_mfma_f32_16x16x32_bf16 v[152:155], a[56:59], a[84:87], v[152:155]
s_waitcnt vmcnt(24) lgkmcnt(0)
s_barrier
v_mfma_f32_16x16x32_bf16 v[60:63], a[20:23], a[0:3], v[60:63]
ds_read_b64_tr_b16 a[64:65], v25 offset:62080
s_add_u32 m0, s56, 116224
v_mfma_f32_16x16x32_bf16 v[64:67], a[20:23], a[4:7], v[64:67]
buffer_load_dwordx4 v18, s[20:23], s54 offen lds
v_mfma_f32_16x16x32_bf16 v[68:71], a[20:23], a[8:11], v[68:71]
ds_read_b64_tr_b16 a[66:67], v25 offset:62592
v_mfma_f32_16x16x32_bf16 v[72:75], a[20:23], a[12:15], v[72:75]
ds_read_b64_tr_b16 a[68:69], v25 offset:62112
ds_read_b64_tr_b16 a[70:71], v25 offset:62624
v_mfma_f32_16x16x32_bf16 v[76:79], a[24:27], a[0:3], v[76:79]
ds_read_b64_tr_b16 a[72:73], v25 offset:63104
v_mfma_f32_16x16x32_bf16 v[80:83], a[24:27], a[4:7], v[80:83]
buffer_load_dwordx4 v19, s[20:23], s54 offen offset:1024 lds
v_mfma_f32_16x16x32_bf16 v[84:87], a[24:27], a[8:11], v[84:87]
ds_read_b64_tr_b16 a[74:75], v25 offset:63616
v_mfma_f32_16x16x32_bf16 v[88:91], a[24:27], a[12:15], v[88:91]
ds_read_b64_tr_b16 a[76:77], v25 offset:63136
v_mfma_f32_16x16x32_bf16 v[92:95], a[28:31], a[0:3], v[92:95]
ds_read_b64_tr_b16 a[78:79], v25 offset:63648
ds_read_b128 a[44:47], v23 offset:46080
v_mfma_f32_16x16x32_bf16 v[96:99], a[28:31], a[4:7], v[96:99]
buffer_load_dwordx4 v20, s[20:23], s54 offen offset:2048 lds
v_mfma_f32_16x16x32_bf16 v[100:103], a[28:31], a[8:11], v[100:103]
s_add_u32 s54, s54, 196608
v_mfma_f32_16x16x32_bf16 v[104:107], a[28:31], a[12:15], v[104:107]
ds_read_b128 a[48:51], v23 offset:47104
ds_read_b64_tr_b16 a[80:81], v25 offset:64128
v_mfma_f32_16x16x32_bf16 v[156:159], a[28:31], a[16:19], v[156:159]
s_add_u32 m0, s55, 36864
v_mfma_f32_16x16x32_bf16 v[108:111], a[32:35], a[0:3], v[108:111]
buffer_load_dwordx4 v21, s[16:19], s52 offen sc1 lds
v_mfma_f32_16x16x32_bf16 v[112:115], a[32:35], a[4:7], v[112:115]
ds_read_b64_tr_b16 a[82:83], v25 offset:64640
v_mfma_f32_16x16x32_bf16 v[116:119], a[32:35], a[8:11], v[116:119]
ds_read_b128 a[52:55], v23 offset:48384
ds_read_b128 a[56:59], v23 offset:49408
v_mfma_f32_16x16x32_bf16 v[120:123], a[32:35], a[12:15], v[120:123]
ds_read_b64_tr_b16 a[84:85], v25 offset:64160
v_mfma_f32_16x16x32_bf16 v[160:163], a[32:35], a[16:19], v[160:163]
buffer_load_dwordx4 v21, s[16:19], s52 offen offset:1024 sc1 lds
v_mfma_f32_16x16x32_bf16 v[124:127], a[0:3], a[36:39], v[124:127]
ds_read_b64_tr_b16 a[86:87], v25 offset:64672
v_mfma_f32_16x16x32_bf16 v[128:131], a[4:7], a[36:39], v[128:131]
ds_read_b128 a[60:63], v24 offset:48128
v_mfma_f32_16x16x32_bf16 v[132:135], a[8:11], a[36:39], v[132:135]
v_mfma_f32_16x16x32_bf16 v[136:139], a[12:15], a[36:39], v[136:139]
buffer_load_dword v22, s[16:19], s52 offen offset:2048 sc1 lds
v_mfma_f32_16x16x32_bf16 v[140:143], a[0:3], a[40:43], v[140:143]
s_add_u32 s52, s52, 0x20000
v_mfma_f32_16x16x32_bf16 v[144:147], a[4:7], a[40:43], v[144:147]
v_mfma_f32_16x16x32_bf16 v[148:151], a[8:11], a[40:43], v[148:151]
v_mfma_f32_16x16x32_bf16 v[152:155], a[12:15], a[40:43], v[152:155]
s_waitcnt vmcnt(24) lgkmcnt(0)
s_barrier
v_mfma_f32_16x16x32_bf16 v[60:63], a[64:67], a[44:47], v[60:63]
ds_read_b64_tr_b16 a[20:21], v25
s_add_u32 m0, s56, 128640
v_mfma_f32_16x16x32_bf16 v[64:67], a[64:67], a[48:51], v[64:67]
buffer_load_dwordx4 v18, s[20:23], s54 offen lds
v_mfma_f32_16x16x32_bf16 v[68:71], a[64:67], a[52:55], v[68:71]
ds_read_b64_tr_b16 a[22:23], v25 offset:512
v_mfma_f32_16x16x32_bf16 v[72:75], a[64:67], a[56:59], v[72:75]
ds_read_b64_tr_b16 a[24:25], v25 offset:32
ds_read_b64_tr_b16 a[26:27], v25 offset:544
v_mfma_f32_16x16x32_bf16 v[76:79], a[68:71], a[44:47], v[76:79]
ds_read_b64_tr_b16 a[28:29], v25 offset:1024
v_mfma_f32_16x16x32_bf16 v[80:83], a[68:71], a[48:51], v[80:83]
buffer_load_dwordx4 v19, s[20:23], s54 offen offset:1024 lds
v_mfma_f32_16x16x32_bf16 v[84:87], a[68:71], a[52:55], v[84:87]
ds_read_b64_tr_b16 a[30:31], v25 offset:1536
v_mfma_f32_16x16x32_bf16 v[88:91], a[68:71], a[56:59], v[88:91]
ds_read_b64_tr_b16 a[32:33], v25 offset:1056
v_mfma_f32_16x16x32_bf16 v[92:95], a[72:75], a[44:47], v[92:95]
ds_read_b64_tr_b16 a[34:35], v25 offset:1568
ds_read_b128 a[0:3], v23
v_mfma_f32_16x16x32_bf16 v[96:99], a[72:75], a[48:51], v[96:99]
buffer_load_dwordx4 v20, s[20:23], s54 offen offset:2048 lds
v_mfma_f32_16x16x32_bf16 v[100:103], a[72:75], a[52:55], v[100:103]
s_add_u32 s54, s54, 196608
v_mfma_f32_16x16x32_bf16 v[104:107], a[72:75], a[56:59], v[104:107]
ds_read_b128 a[4:7], v23 offset:1024
ds_read_b64_tr_b16 a[36:37], v25 offset:2048
v_mfma_f32_16x16x32_bf16 v[156:159], a[72:75], a[60:63], v[156:159]
s_add_u32 m0, s55, 46080
v_mfma_f32_16x16x32_bf16 v[108:111], a[76:79], a[44:47], v[108:111]
buffer_load_dwordx4 v21, s[16:19], s52 offen sc1 lds
v_mfma_f32_16x16x32_bf16 v[112:115], a[76:79], a[48:51], v[112:115]
ds_read_b64_tr_b16 a[38:39], v25 offset:2560
v_mfma_f32_16x16x32_bf16 v[116:119], a[76:79], a[52:55], v[116:119]
ds_read_b128 a[8:11], v23 offset:2304
ds_read_b128 a[12:15], v23 offset:3328
v_mfma_f32_16x16x32_bf16 v[120:123], a[76:79], a[56:59], v[120:123]
ds_read_b64_tr_b16 a[40:41], v25 offset:2080
v_mfma_f32_16x16x32_bf16 v[160:163], a[76:79], a[60:63], v[160:163]
buffer_load_dwordx4 v21, s[16:19], s52 offen offset:1024 sc1 lds
v_mfma_f32_16x16x32_bf16 v[124:127], a[44:47], a[80:83], v[124:127]
ds_read_b64_tr_b16 a[42:43], v25 offset:2592
v_mfma_f32_16x16x32_bf16 v[128:131], a[48:51], a[80:83], v[128:131]
ds_read_b128 a[16:19], v24 offset:2048
v_mfma_f32_16x16x32_bf16 v[132:135], a[52:55], a[80:83], v[132:135]
v_mfma_f32_16x16x32_bf16 v[136:139], a[56:59], a[80:83], v[136:139]
buffer_load_dword v22, s[16:19], s52 offen offset:2048 sc1 lds
v_mfma_f32_16x16x32_bf16 v[140:143], a[44:47], a[84:87], v[140:143]
s_add_u32 s52, s52, 0x20000
v_mfma_f32_16x16x32_bf16 v[144:147], a[48:51], a[84:87], v[144:147]
v_mfma_f32_16x16x32_bf16 v[148:151], a[52:55], a[84:87], v[148:151]
v_mfma_f32_16x16x32_bf16 v[152:155], a[56:59], a[84:87], v[152:155]
s_sub_u32 s15, s15, 1
s_cmp_lg_u32 s15, 0
s_cbranch_scc1 .Lk33
s_waitcnt vmcnt(24) lgkmcnt(0)
s_barrier
v_mfma_f32_16x16x32_bf16 v[60:63], a[20:23], a[0:3], v[60:63]
ds_read_b64_tr_b16 a[64:65], v25 offset:12416
s_add_u32 m0, s56, 66560
v_mfma_f32_16x16x32_bf16 v[64:67], a[20:23], a[4:7], v[64:67]
buffer_load_dwordx4 v18, s[20:23], s54 offen lds
v_mfma_f32_16x16x32_bf16 v[68:71], a[20:23], a[8:11], v[68:71]
ds_read_b64_tr_b16 a[66:67], v25 offset:12928
ds_read_b64_tr_b16 a[68:69], v25 offset:12448
v_mfma_f32_16x16x32_bf16 v[72:75], a[20:23], a[12:15], v[72:75]
ds_read_b64_tr_b16 a[70:71], v25 offset:12960
v_mfma_f32_16x16x32_bf16 v[76:79], a[24:27], a[0:3], v[76:79]
buffer_load_dwordx4 v19, s[20:23], s54 offen offset:1024 lds
v_mfma_f32_16x16x32_bf16 v[80:83], a[24:27], a[4:7], v[80:83]
ds_read_b64_tr_b16 a[72:73], v25 offset:13440
v_mfma_f32_16x16x32_bf16 v[84:87], a[24:27], a[8:11], v[84:87]
ds_read_b64_tr_b16 a[74:75], v25 offset:13952
ds_read_b64_tr_b16 a[76:77], v25 offset:13472
v_mfma_f32_16x16x32_bf16 v[88:91], a[24:27], a[12:15], v[88:91]
buffer_load_dwordx4 v20, s[20:23], s54 offen offset:2048 lds
v_mfma_f32_16x16x32_bf16 v[92:95], a[28:31], a[0:3], v[92:95]
ds_read_b64_tr_b16 a[78:79], v25 offset:13984
s_add_u32 s54, s54, 196608
v_mfma_f32_16x16x32_bf16 v[96:99], a[28:31], a[4:7], v[96:99]
ds_read_b128 a[44:47], v23 offset:9216
v_mfma_f32_16x16x32_bf16 v[100:103], a[28:31], a[8:11], v[100:103]
ds_read_b128 a[48:51], v23 offset:10240
s_add_u32 m0, s55, 0
v_mfma_f32_16x16x32_bf16 v[104:107], a[28:31], a[12:15], v[104:107]
buffer_load_dwordx4 v21, s[16:19], s52 offen sc1 lds
v_mfma_f32_16x16x32_bf16 v[156:159], a[28:31], a[16:19], v[156:159]
ds_read_b64_tr_b16 a[80:81], v25 offset:14464
v_mfma_f32_16x16x32_bf16 v[108:111], a[32:35], a[0:3], v[108:111]
ds_read_b64_tr_b16 a[82:83], v25 offset:14976
ds_read_b128 a[52:55], v23 offset:11520
v_mfma_f32_16x16x32_bf16 v[112:115], a[32:35], a[4:7], v[112:115]
buffer_load_dwordx4 v21, s[16:19], s52 offen offset:1024 sc1 lds
v_mfma_f32_16x16x32_bf16 v[116:119], a[32:35], a[8:11], v[116:119]
ds_read_b128 a[56:59], v23 offset:12544
v_mfma_f32_16x16x32_bf16 v[120:123], a[32:35], a[12:15], v[120:123]
ds_read_b64_tr_b16 a[84:85], v25 offset:14496
v_mfma_f32_16x16x32_bf16 v[160:163], a[32:35], a[16:19], v[160:163]
ds_read_b64_tr_b16 a[86:87], v25 offset:15008
ds_read_b128 a[60:63], v24 offset:11264
v_mfma_f32_16x16x32_bf16 v[124:127], a[0:3], a[36:39], v[124:127]
buffer_load_dword v22, s[16:19], s52 offen offset:2048 sc1 lds
v_mfma_f32_16x16x32_bf16 v[128:131], a[4:7], a[36:39], v[128:131]
s_add_u32 s52, s52, 0x20000
v_mfma_f32_16x16x32_bf16 v[132:135], a[8:11], a[36:39], v[132:135]
s_mov_b32 s67, 62914560
v_mfma_f32_16x16x32_bf16 v[136:139], a[12:15], a[36:39], v[136:139]
buffer_load_dwordx4 v[164:167], v26, s[16:19], s67 offen sc1
v_mfma_f32_16x16x32_bf16 v[140:143], a[0:3], a[40:43], v[140:143]
v_mfma_f32_16x16x32_bf16 v[144:147], a[4:7], a[40:43], v[144:147]
v_mfma_f32_16x16x32_bf16 v[148:151], a[8:11], a[40:43], v[148:151]
v_mfma_f32_16x16x32_bf16 v[152:155], a[12:15], a[40:43], v[152:155]
s_waitcnt vmcnt(25) lgkmcnt(0)
s_barrier
v_mfma_f32_16x16x32_bf16 v[60:63], a[64:67], a[44:47], v[60:63]
ds_read_b64_tr_b16 a[20:21], v25 offset:24832
s_add_u32 m0, s56, 78976
v_mfma_f32_16x16x32_bf16 v[64:67], a[64:67], a[48:51], v[64:67]
buffer_load_dwordx4 v18, s[20:23], s54 offen lds
v_mfma_f32_16x16x32_bf16 v[68:71], a[64:67], a[52:55], v[68:71]
ds_read_b64_tr_b16 a[22:23], v25 offset:25344
ds_read_b64_tr_b16 a[24:25], v25 offset:24864
v_mfma_f32_16x16x32_bf16 v[72:75], a[64:67], a[56:59], v[72:75]
ds_read_b64_tr_b16 a[26:27], v25 offset:25376
v_mfma_f32_16x16x32_bf16 v[76:79], a[68:71], a[44:47], v[76:79]
buffer_load_dwordx4 v19, s[20:23], s54 offen offset:1024 lds
v_mfma_f32_16x16x32_bf16 v[80:83], a[68:71], a[48:51], v[80:83]
ds_read_b64_tr_b16 a[28:29], v25 offset:25856
v_mfma_f32_16x16x32_bf16 v[84:87], a[68:71], a[52:55], v[84:87]
ds_read_b64_tr_b16 a[30:31], v25 offset:26368
ds_read_b64_tr_b16 a[32:33], v25 offset:25888
v_mfma_f32_16x16x32_bf16 v[88:91], a[68:71], a[56:59], v[88:91]
buffer_load_dwordx4 v20, s[20:23], s54 offen offset:2048 lds
v_mfma_f32_16x16x32_bf16 v[92:95], a[72:75], a[44:47], v[92:95]
ds_read_b64_tr_b16 a[34:35], v25 offset:26400
s_add_u32 s54, s54, 196608
v_mfma_f32_16x16x32_bf16 v[96:99], a[72:75], a[48:51], v[96:99]
ds_read_b128 a[0:3], v23 offset:18432
v_mfma_f32_16x16x32_bf16 v[100:103], a[72:75], a[52:55], v[100:103]
ds_read_b128 a[4:7], v23 offset:19456
s_add_u32 m0, s55, 9216
v_mfma_f32_16x16x32_bf16 v[104:107], a[72:75], a[56:59], v[104:107]
buffer_load_dwordx4 v21, s[16:19], s52 offen sc1 lds
v_mfma_f32_16x16x32_bf16 v[156:159], a[72:75], a[60:63], v[156:159]
ds_read_b64_tr_b16 a[36:37], v25 offset:26880
v_mfma_f32_16x16x32_bf16 v[108:111], a[76:79], a[44:47], v[108:111]
ds_read_b64_tr_b16 a[38:39], v25 offset:27392
ds_read_b128 a[8:11], v23 offset:20736
v_mfma_f32_16x16x32_bf16 v[112:115], a[76:79], a[48:51], v[112:115]
buffer_load_dwordx4 v21, s[16:19], s52 offen offset:1024 sc1 lds
v_mfma_f32_16x16x32_bf16 v[116:119], a[76:79], a[52:55], v[116:119]
ds_read_b128 a[12:15], v23 offset:21760
v_mfma_f32_16x16x32_bf16 v[120:123], a[76:79], a[56:59], v[120:123]
ds_read_b64_tr_b16 a[40:41], v25 offset:26912
v_mfma_f32_16x16x32_bf16 v[160:163], a[76:79], a[60:63], v[160:163]
ds_read_b64_tr_b16 a[42:43], v25 offset:27424
ds_read_b128 a[16:19], v24 offset:20480
v_mfma_f32_16x16x32_bf16 v[124:127], a[44:47], a[80:83], v[124:127]
buffer_load_dword v22, s[16:19], s52 offen offset:2048 sc1 lds
v_mfma_f32_16x16x32_bf16 v[128:131], a[48:51], a[80:83], v[128:131]
s_add_u32 s52, s52, 0x20000
v_mfma_f32_16x16x32_bf16 v[132:135], a[52:55], a[80:83], v[132:135]
v_mfma_f32_16x16x32_bf16 v[136:139], a[56:59], a[80:83], v[136:139]
buffer_load_dwordx4 v[168:171], v26, s[16:19], s67 offen offset:1024 sc1
v_mfma_f32_16x16x32_bf16 v[140:143], a[44:47], a[84:87], v[140:143]
.Lpad17:
s_cbranch_execz .Lpad20
v_mfma_f32_16x16x32_bf16 v[144:147], a[48:51], a[84:87], v[144:147]
v_mfma_f32_16x16x32_bf16 v[148:151], a[52:55], a[84:87], v[148:151]
v_mfma_f32_16x16x32_bf16 v[152:155], a[56:59], a[84:87], v[152:155]
s_waitcnt vmcnt(26) lgkmcnt(0)
s_barrier
v_mfma_f32_16x16x32_bf16 v[60:63], a[20:23], a[0:3], v[60:63]
ds_read_b64_tr_b16 a[64:65], v25 offset:37248
ds_read_b64_tr_b16 a[66:67], v25 offset:37760
v_mfma_f32_16x16x32_bf16 v[64:67], a[20:23], a[4:7], v[64:67]
buffer_load_dwordx4 v[172:175], v26, s[16:19], s67 offen offset:2048 sc1
v_mfma_f32_16x16x32_bf16 v[68:71], a[20:23], a[8:11], v[68:71]
ds_read_b64_tr_b16 a[68:69], v25 offset:37280
v_mfma_f32_16x16x32_bf16 v[72:75], a[20:23], a[12:15], v[72:75]
ds_read_b64_tr_b16 a[70:71], v25 offset:37792
v_mfma_f32_16x16x32_bf16 v[76:79], a[24:27], a[0:3], v[76:79]
ds_read_b64_tr_b16 a[72:73], v25 offset:38272
v_mfma_f32_16x16x32_bf16 v[80:83], a[24:27], a[4:7], v[80:83]
buffer_load_dwordx4 v[176:179], v26, s[16:19], s67 offen offset:3072 sc1
v_mfma_f32_16x16x32_bf16 v[84:87], a[24:27], a[8:11], v[84:87]
ds_read_b64_tr_b16 a[74:75], v25 offset:38784
v_mfma_f32_16x16x32_bf16 v[88:91], a[24:27], a[12:15], v[88:91]
ds_read_b64_tr_b16 a[76:77], v25 offset:38304
ds_read_b64_tr_b16 a[78:79], v25 offset:38816
v_mfma_f32_16x16x32_bf16 v[92:95], a[28:31], a[0:3], v[92:95]
s_mov_b32 s67, 62918656
v_mfma_f32_16x16x32_bf16 v[96:99], a[28:31], a[4:7], v[96:99]
buffer_load_dwordx4 v[180:183], v26, s[16:19], s67 offen sc1
v_mfma_f32_16x16x32_bf16 v[100:103], a[28:31], a[8:11], v[100:103]
ds_read_b128 a[44:47], v23 offset:27648
v_mfma_f32_16x16x32_bf16 v[104:107], a[28:31], a[12:15], v[104:107]
ds_read_b128 a[48:51], v23 offset:28672
v_mfma_f32_16x16x32_bf16 v[156:159], a[28:31], a[16:19], v[156:159]
ds_read_b64_tr_b16 a[80:81], v25 offset:39296
ds_read_b64_tr_b16 a[82:83], v25 offset:39808
v_mfma_f32_16x16x32_bf16 v[108:111], a[32:35], a[0:3], v[108:111]
buffer_load_dwordx4 v[184:187], v26, s[16:19], s67 offen offset:1024 sc1
v_mfma_f32_16x16x32_bf16 v[112:115], a[32:35], a[4:7], v[112:115]
ds_read_b128 a[52:55], v23 offset:29952
v_mfma_f32_16x16x32_bf16 v[116:119], a[32:35], a[8:11], v[116:119]
ds_read_b128 a[56:59], v23 offset:30976
v_mfma_f32_16x16x32_bf16 v[120:123], a[32:35], a[12:15], v[120:123]
ds_read_b64_tr_b16 a[84:85], v25 offset:39328
v_mfma_f32_16x16x32_bf16 v[160:163], a[32:35], a[16:19], v[160:163]
buffer_load_dwordx4 v[188:191], v26, s[16:19], s67 offen offset:2048 sc1
v_mfma_f32_16x16x32_bf16 v[124:127], a[0:3], a[36:39], v[124:127]
ds_read_b64_tr_b16 a[86:87], v25 offset:39840
v_mfma_f32_16x16x32_bf16 v[128:131], a[4:7], a[36:39], v[128:131]
ds_read_b128 a[60:63], v24 offset:29696
v_mfma_f32_16x16x32_bf16 v[132:135], a[8:11], a[36:39], v[132:135]
v_mfma_f32_16x16x32_bf16 v[136:139], a[12:15], a[36:39], v[136:139]
buffer_load_dwordx4 v[192:195], v26, s[16:19], s67 offen offset:3072 sc1
v_mfma_f32_16x16x32_bf16 v[140:143], a[0:3], a[40:43], v[140:143]
v_mfma_f32_16x16x32_bf16 v[144:147], a[4:7], a[40:43], v[144:147]
v_mfma_f32_16x16x32_bf16 v[148:151], a[8:11], a[40:43], v[148:151]
v_mfma_f32_16x16x32_bf16 v[152:155], a[12:15], a[40:43], v[152:155]
s_waitcnt vmcnt(26) lgkmcnt(0)
s_barrier
v_mfma_f32_16x16x32_bf16 v[60:63], a[64:67], a[44:47], v[60:63]
ds_read_b64_tr_b16 a[20:21], v25 offset:49664
s_add_u32 m0, s59, 58240
s_mov_b32 s58, 1966080
v_mfma_f32_16x16x32_bf16 v[64:67], a[64:67], a[48:51], v[64:67]
buffer_load_dwordx4 v5, s[24:27], s58 offen lds
v_mfma_f32_16x16x32_bf16 v[68:71], a[64:67], a[52:55], v[68:71]
ds_read_b64_tr_b16 a[22:23], v25 offset:50176
v_mfma_f32_16x16x32_bf16 v[72:75], a[64:67], a[56:59], v[72:75]
ds_read_b64_tr_b16 a[24:25], v25 offset:49696
ds_read_b64_tr_b16 a[26:27], v25 offset:50208
v_mfma_f32_16x16x32_bf16 v[76:79], a[68:71], a[44:47], v[76:79]
ds_read_b64_tr_b16 a[28:29], v25 offset:50688
v_mfma_f32_16x16x32_bf16 v[80:83], a[68:71], a[48:51], v[80:83]
buffer_load_dwordx4 v6, s[24:27], s58 offen offset:1024 lds
v_mfma_f32_16x16x32_bf16 v[84:87], a[68:71], a[52:55], v[84:87]
ds_read_b64_tr_b16 a[30:31], v25 offset:51200
v_mfma_f32_16x16x32_bf16 v[88:91], a[68:71], a[56:59], v[88:91]
ds_read_b64_tr_b16 a[32:33], v25 offset:50720
v_mfma_f32_16x16x32_bf16 v[92:95], a[72:75], a[44:47], v[92:95]
ds_read_b64_tr_b16 a[34:35], v25 offset:51232
s_add_u32 m0, s59, 91520
s_mov_b32 s58, 393216
v_mfma_f32_16x16x32_bf16 v[96:99], a[72:75], a[48:51], v[96:99]
buffer_load_dwordx4 v5, s[24:27], s58 offen lds
v_mfma_f32_16x16x32_bf16 v[100:103], a[72:75], a[52:55], v[100:103]
ds_read_b128 a[0:3], v23 offset:36864
v_mfma_f32_16x16x32_bf16 v[104:107], a[72:75], a[56:59], v[104:107]
ds_read_b128 a[4:7], v23 offset:37888
ds_read_b64_tr_b16 a[36:37], v25 offset:51712
v_mfma_f32_16x16x32_bf16 v[156:159], a[72:75], a[60:63], v[156:159]
ds_read_b64_tr_b16 a[38:39], v25 offset:52224
v_mfma_f32_16x16x32_bf16 v[108:111], a[76:79], a[44:47], v[108:111]
buffer_load_dwordx4 v6, s[24:27], s58 offen offset:1024 lds
v_mfma_f32_16x16x32_bf16 v[112:115], a[76:79], a[48:51], v[112:115]
ds_read_b128 a[8:11], v23 offset:39168
v_mfma_f32_16x16x32_bf16 v[116:119], a[76:79], a[52:55], v[116:119]
ds_read_b128 a[12:15], v23 offset:40192
v_mfma_f32_16x16x32_bf16 v[120:123], a[76:79], a[56:59], v[120:123]
ds_read_b64_tr_b16 a[40:41], v25 offset:51744
s_add_u32 m0, s59, 24960
s_mov_b32 s58, 1441792
v_mfma_f32_16x16x32_bf16 v[160:163], a[76:79], a[60:63], v[160:163]
buffer_load_dwordx4 v5, s[24:27], s58 offen lds
v_mfma_f32_16x16x32_bf16 v[124:127], a[44:47], a[80:83], v[124:127]
ds_read_b64_tr_b16 a[42:43], v25 offset:52256
v_mfma_f32_16x16x32_bf16 v[128:131], a[48:51], a[80:83], v[128:131]
ds_read_b128 a[16:19], v24 offset:38912
v_mfma_f32_16x16x32_bf16 v[132:135], a[52:55], a[80:83], v[132:135]
v_mfma_f32_16x16x32_bf16 v[136:139], a[56:59], a[80:83], v[136:139]
buffer_load_dwordx4 v6, s[24:27], s58 offen offset:1024 lds
v_mfma_f32_16x16x32_bf16 v[140:143], a[44:47], a[84:87], v[140:143]
v_mfma_f32_16x16x32_bf16 v[144:147], a[48:51], a[84:87], v[144:147]
v_mfma_f32_16x16x32_bf16 v[148:151], a[52:55], a[84:87], v[148:151]
v_mfma_f32_16x16x32_bf16 v[152:155], a[56:59], a[84:87], v[152:155]
s_waitcnt vmcnt(26) lgkmcnt(0)
s_barrier
v_mfma_f32_16x16x32_bf16 v[60:63], a[20:23], a[0:3], v[60:63]
ds_read_b64_tr_b16 a[64:65], v25 offset:62080
s_add_u32 m0, s59, 99840
s_mov_b32 s58, 524288
v_mfma_f32_16x16x32_bf16 v[64:67], a[20:23], a[4:7], v[64:67]
buffer_load_dwordx4 v5, s[24:27], s58 offen lds
v_mfma_f32_16x16x32_bf16 v[68:71], a[20:23], a[8:11], v[68:71]
ds_read_b64_tr_b16 a[66:67], v25 offset:62592
s_waitcnt vmcnt(10)
v_add_f32 v164, v164, v180
v_mfma_f32_16x16x32_bf16 v[72:75], a[20:23], a[12:15], v[72:75]
ds_read_b64_tr_b16 a[68:69], v25 offset:62112
ds_read_b64_tr_b16 a[70:71], v25 offset:62624
v_mfma_f32_16x16x32_bf16 v[76:79], a[24:27], a[0:3], v[76:79]
ds_read_b64_tr_b16 a[72:73], v25 offset:63104
v_add_f32 v165, v165, v181
v_mfma_f32_16x16x32_bf16 v[80:83], a[24:27], a[4:7], v[80:83]
buffer_load_dwordx4 v6, s[24:27], s58 offen offset:1024 lds
v_mfma_f32_16x16x32_bf16 v[84:87], a[24:27], a[8:11], v[84:87]
ds_read_b64_tr_b16 a[74:75], v25 offset:63616
v_add_f32 v166, v166, v182
v_mfma_f32_16x16x32_bf16 v[88:91], a[24:27], a[12:15], v[88:91]
ds_read_b64_tr_b16 a[76:77], v25 offset:63136
v_add_f32 v167, v167, v183
v_mfma_f32_16x16x32_bf16 v[92:95], a[28:31], a[0:3], v[92:95]
ds_read_b64_tr_b16 a[78:79], v25 offset:63648
s_add_u32 m0, s59, 33280
s_mov_b32 s58, 1572864
v_mfma_f32_16x16x32_bf16 v[96:99], a[28:31], a[4:7], v[96:99]
buffer_load_dwordx4 v5, s[24:27], s58 offen lds
v_mfma_f32_16x16x32_bf16 v[100:103], a[28:31], a[8:11], v[100:103]
ds_read_b128 a[44:47], v23 offset:46080
v_mfma_f32_16x16x32_bf16 v[104:107], a[28:31], a[12:15], v[104:107]
ds_read_b128 a[48:51], v23 offset:47104
ds_read_b64_tr_b16 a[80:81], v25 offset:64128
v_mfma_f32_16x16x32_bf16 v[156:159], a[28:31], a[16:19], v[156:159]
ds_read_b64_tr_b16 a[82:83], v25 offset:64640
s_waitcnt vmcnt(11)
v_add_f32 v168, v168, v184
v_mfma_f32_16x16x32_bf16 v[108:111], a[32:35], a[0:3], v[108:111]
buffer_load_dwordx4 v6, s[24:27], s58 offen offset:1024 lds
v_mfma_f32_16x16x32_bf16 v[112:115], a[32:35], a[4:7], v[112:115]
ds_read_b128 a[52:55], v23 offset:48384
v_add_f32 v169, v169, v185
v_mfma_f32_16x16x32_bf16 v[116:119], a[32:35], a[8:11], v[116:119]
ds_read_b128 a[56:59], v23 offset:49408
v_add_f32 v170, v170, v186
v_mfma_f32_16x16x32_bf16 v[120:123], a[32:35], a[12:15], v[120:123]
ds_read_b64_tr_b16 a[84:85], v25 offset:64160
s_add_u32 m0, s59, 108160
s_mov_b32 s58, 655360
v_mfma_f32_16x16x32_bf16 v[160:163], a[32:35], a[16:19], v[160:163]
buffer_load_dwordx4 v5, s[24:27], s58 offen lds
v_mfma_f32_16x16x32_bf16 v[124:127], a[0:3], a[36:39], v[124:127]
ds_read_b64_tr_b16 a[86:87], v25 offset:64672
v_mfma_f32_16x16x32_bf16 v[128:131], a[4:7], a[36:39], v[128:131]
ds_read_b128 a[60:63], v24 offset:48128
v_add_f32 v171, v171, v187
v_mfma_f32_16x16x32_bf16 v[132:135], a[8:11], a[36:39], v[132:135]
s_waitcnt vmcnt(12)
v_add_f32 v172, v172, v188
v_add_f32 v173, v173, v189
v_mfma_f32_16x16x32_bf16 v[136:139], a[12:15], a[36:39], v[136:139]
buffer_load_dwordx4 v6, s[24:27], s58 offen offset:1024 lds
v_mfma_f32_16x16x32_bf16 v[140:143], a[0:3], a[40:43], v[140:143]
v_add_f32 v174, v174, v190
v_mfma_f32_16x16x32_bf16 v[144:147], a[4:7], a[40:43], v[144:147]
v_add_f32 v175, v175, v191
s_waitcnt vmcnt(12)
v_add_f32 v176, v176, v192
v_mfma_f32_16x16x32_bf16 v[148:151], a[8:11], a[40:43], v[148:151]
v_add_f32 v177, v177, v193
v_mfma_f32_16x16x32_bf16 v[152:155], a[12:15], a[40:43], v[152:155]
s_waitcnt lgkmcnt(0)
s_barrier
v_mfma_f32_16x16x32_bf16 v[60:63], a[64:67], a[44:47], v[60:63]
ds_read_b64_tr_b16 a[20:21], v25
s_add_u32 m0, s59, 116480
s_mov_b32 s58, 786432
v_mfma_f32_16x16x32_bf16 v[64:67], a[64:67], a[48:51], v[64:67]
buffer_load_dwordx4 v5, s[24:27], s58 offen lds
v_mfma_f32_16x16x32_bf16 v[68:71], a[64:67], a[52:55], v[68:71]
ds_read_b64_tr_b16 a[22:23], v25 offset:512
v_add_f32 v178, v178, v194
v_mfma_f32_16x16x32_bf16 v[72:75], a[64:67], a[56:59], v[72:75]
ds_read_b64_tr_b16 a[24:25], v25 offset:32
ds_read_b64_tr_b16 a[26:27], v25 offset:544
v_mfma_f32_16x16x32_bf16 v[76:79], a[68:71], a[44:47], v[76:79]
ds_read_b64_tr_b16 a[28:29], v25 offset:1024
v_add_f32 v179, v179, v195
v_mfma_f32_16x16x32_bf16 v[80:83], a[68:71], a[48:51], v[80:83]
buffer_load_dwordx4 v6, s[24:27], s58 offen offset:1024 lds
v_mfma_f32_16x16x32_bf16 v[84:87], a[68:71], a[52:55], v[84:87]
ds_read_b64_tr_b16 a[30:31], v25 offset:1536
v_add_f32 v164, v164, v172
v_mfma_f32_16x16x32_bf16 v[88:91], a[68:71], a[56:59], v[88:91]
ds_read_b64_tr_b16 a[32:33], v25 offset:1056
v_add_f32 v165, v165, v173
v_mfma_f32_16x16x32_bf16 v[92:95], a[72:75], a[44:47], v[92:95]
ds_read_b64_tr_b16 a[34:35], v25 offset:1568
s_add_u32 m0, s59, 41600
s_mov_b32 s58, 1703936
v_mfma_f32_16x16x32_bf16 v[96:99], a[72:75], a[48:51], v[96:99]
buffer_load_dwordx4 v5, s[24:27], s58 offen lds
v_mfma_f32_16x16x32_bf16 v[100:103], a[72:75], a[52:55], v[100:103]
ds_read_b128 a[0:3], v23
v_mfma_f32_16x16x32_bf16 v[104:107], a[72:75], a[56:59], v[104:107]
ds_read_b128 a[4:7], v23 offset:1024
ds_read_b64_tr_b16 a[36:37], v25 offset:2048
v_mfma_f32_16x16x32_bf16 v[156:159], a[72:75], a[60:63], v[156:159]
ds_read_b64_tr_b16 a[38:39], v25 offset:2560
v_add_f32 v166, v166, v174
v_mfma_f32_16x16x32_bf16 v[108:111], a[76:79], a[44:47], v[108:111]
buffer_load_dwordx4 v6, s[24:27], s58 offen offset:1024 lds
v_mfma_f32_16x16x32_bf16 v[112:115], a[76:79], a[48:51], v[112:115]
ds_read_b128 a[8:11], v23 offset:2304
v_add_f32 v167, v167, v175
v_mfma_f32_16x16x32_bf16 v[116:119], a[76:79], a[52:55], v[116:119]
ds_read_b128 a[12:15], v23 offset:3328
v_add_f32 v168, v168, v176
v_mfma_f32_16x16x32_bf16 v[120:123], a[76:79], a[56:59], v[120:123]
ds_read_b64_tr_b16 a[40:41], v25 offset:2080
s_add_u32 m0, s59, 49920
s_mov_b32 s58, 1835008
v_mfma_f32_16x16x32_bf16 v[160:163], a[76:79], a[60:63], v[160:163]
buffer_load_dwordx4 v5, s[24:27], s58 offen lds
v_mfma_f32_16x16x32_bf16 v[124:127], a[44:47], a[80:83], v[124:127]
ds_read_b64_tr_b16 a[42:43], v25 offset:2592
v_mfma_f32_16x16x32_bf16 v[128:131], a[48:51], a[80:83], v[128:131]
ds_read_b128 a[16:19], v24 offset:2048
v_add_f32 v169, v169, v177
v_mfma_f32_16x16x32_bf16 v[132:135], a[52:55], a[80:83], v[132:135]
v_add_f32 v170, v170, v178
v_add_f32 v171, v171, v179
v_mfma_f32_16x16x32_bf16 v[136:139], a[56:59], a[80:83], v[136:139]
buffer_load_dwordx4 v6, s[24:27], s58 offen offset:1024 lds
v_mfma_f32_16x16x32_bf16 v[140:143], a[44:47], a[84:87], v[140:143]
v_add_f32 v164, v164, v168
v_mfma_f32_16x16x32_bf16 v[144:147], a[48:51], a[84:87], v[144:147]
v_add_f32 v165, v165, v169
v_add_f32 v166, v166, v170
v_mfma_f32_16x16x32_bf16 v[148:151], a[52:55], a[84:87], v[148:151]
v_add_f32 v167, v167, v171
v_mfma_f32_16x16x32_bf16 v[152:155], a[56:59], a[84:87], v[152:155]
s_waitcnt lgkmcnt(0)
s_barrier
v_mfma_f32_16x16x32_bf16 v[60:63], a[20:23], a[0:3], v[60:63]
ds_read_b64_tr_b16 a[64:65], v25 offset:12416
s_add_u32 m0, s59, 124800
s_mov_b32 s58, 917504
v_mfma_f32_16x16x32_bf16 v[64:67], a[20:23], a[4:7], v[64:67]
buffer_load_dwordx4 v5, s[24:27], s58 offen lds
v_mfma_f32_16x16x32_bf16 v[68:71], a[20:23], a[8:11], v[68:71]
ds_read_b64_tr_b16 a[66:67], v25 offset:12928
v_permlane32_swap_b32 v164, v166
v_mfma_f32_16x16x32_bf16 v[72:75], a[20:23], a[12:15], v[72:75]
ds_read_b64_tr_b16 a[68:69], v25 offset:12448
v_permlane32_swap_b32 v165, v167
v_mfma_f32_16x16x32_bf16 v[76:79], a[24:27], a[0:3], v[76:79]
ds_read_b64_tr_b16 a[70:71], v25 offset:12960
v_mfma_f32_16x16x32_bf16 v[80:83], a[24:27], a[4:7], v[80:83]
ds_read_b64_tr_b16 a[72:73], v25 offset:13440
ds_read_b64_tr_b16 a[74:75], v25 offset:13952
v_mfma_f32_16x16x32_bf16 v[84:87], a[24:27], a[8:11], v[84:87]
ds_read_b64_tr_b16 a[76:77], v25 offset:13472
v_add_f32 v164, v164, v166
v_mfma_f32_16x16x32_bf16 v[88:91], a[24:27], a[12:15], v[88:91]
buffer_load_dwordx4 v6, s[24:27], s58 offen offset:1024 lds
v_mfma_f32_16x16x32_bf16 v[92:95], a[28:31], a[0:3], v[92:95]
ds_read_b64_tr_b16 a[78:79], v25 offset:13984
v_add_f32 v165, v165, v167
v_mfma_f32_16x16x32_bf16 v[96:99], a[28:31], a[4:7], v[96:99]
ds_read_b128 a[44:47], v23 offset:9216
v_mfma_f32_16x16x32_bf16 v[100:103], a[28:31], a[8:11], v[100:103]
ds_read_b128 a[48:51], v23 offset:10240
v_mul_f32 v164, 0xba800000, v164
v_mfma_f32_16x16x32_bf16 v[104:107], a[28:31], a[12:15], v[104:107]
ds_read_b64_tr_b16 a[80:81], v25 offset:14464
v_mul_f32 v165, 0x3a800000, v165
v_mfma_f32_16x16x32_bf16 v[156:159], a[28:31], a[16:19], v[156:159]
ds_read_b64_tr_b16 a[82:83], v25 offset:14976
s_add_u32 m0, s59, 0
s_mov_b32 s58, 1048576
v_mfma_f32_16x16x32_bf16 v[108:111], a[32:35], a[0:3], v[108:111]
buffer_load_dwordx4 v5, s[24:27], s58 offen lds
v_mfma_f32_16x16x32_bf16 v[112:115], a[32:35], a[4:7], v[112:115]
ds_read_b128 a[52:55], v23 offset:11520
v_mfma_f32_16x16x32_bf16 v[116:119], a[32:35], a[8:11], v[116:119]
ds_read_b128 a[56:59], v23 offset:12544
v_fma_f32 v165, -v164, v164, v165
v_mfma_f32_16x16x32_bf16 v[120:123], a[32:35], a[12:15], v[120:123]
ds_read_b64_tr_b16 a[84:85], v25 offset:14496
v_max_f32 v165, 0, v165
v_mfma_f32_16x16x32_bf16 v[160:163], a[32:35], a[16:19], v[160:163]
ds_read_b64_tr_b16 a[86:87], v25 offset:15008
v_mfma_f32_16x16x32_bf16 v[124:127], a[0:3], a[36:39], v[124:127]
ds_read_b128 a[60:63], v24 offset:11264
v_add_f32 v165, 0x3727c5ac, v165
v_mfma_f32_16x16x32_bf16 v[128:131], a[4:7], a[36:39], v[128:131]
buffer_load_dwordx4 v6, s[24:27], s58 offen offset:1024 lds
v_mfma_f32_16x16x32_bf16 v[132:135], a[8:11], a[36:39], v[132:135]
v_rsq_f32 v166, v165
v_mfma_f32_16x16x32_bf16 v[136:139], a[12:15], a[36:39], v[136:139]
v_mov_b32 v165, v166
v_mul_f32 v166, 0x3e8293ee, v166
v_mfma_f32_16x16x32_bf16 v[140:143], a[0:3], a[40:43], v[140:143]
ds_write_b128 v7, v[164:167]
v_mfma_f32_16x16x32_bf16 v[144:147], a[4:7], a[40:43], v[144:147]
ds_write_b32 v17, v164
v_mfma_f32_16x16x32_bf16 v[148:151], a[8:11], a[40:43], v[148:151]
ds_write_b32 v17, v165 offset:1024
v_mfma_f32_16x16x32_bf16 v[152:155], a[12:15], a[40:43], v[152:155]
s_waitcnt lgkmcnt(0)
s_barrier
v_mfma_f32_16x16x32_bf16 v[156:159], a[72:75], a[60:63], v[156:159]
ds_read_b128 v[232:235], v10 offset:768
s_add_u32 m0, s59, 66560
v_mfma_f32_16x16x32_bf16 v[160:163], a[76:79], a[60:63], v[160:163]
ds_read_b128 v[236:239], v10 offset:2816
s_mov_b32 s58, 0
v_mfma_f32_16x16x32_bf16 v[104:107], a[72:75], a[56:59], v[104:107]
ds_read_b128 v[228:231], v10 offset:512
v_mfma_f32_16x16x32_bf16 v[120:123], a[76:79], a[56:59], v[120:123]
ds_read_b128 v[224:227], v10 offset:256
v_mfma_f32_16x16x32_bf16 v[136:139], a[56:59], a[80:83], v[136:139]
ds_read_b128 v[220:223], v10
v_mfma_f32_16x16x32_bf16 v[152:155], a[56:59], a[84:87], v[152:155]
ds_read_b128 v[240:243], v11 offset:192
v_mfma_f32_16x16x32_bf16 v[100:103], a[72:75], a[52:55], v[100:103]
ds_read_b128 v[244:247], v11 offset:1216
v_mfma_f32_16x16x32_bf16 v[116:119], a[76:79], a[52:55], v[116:119]
buffer_load_dwordx4 v5, s[24:27], s58 offen lds
ds_read_b128 v[18:21], v11 offset:128
ds_read_b128 v[22:25], v11 offset:1152
s_waitcnt lgkmcnt(8)
v_pk_fma_f32 v[104:105], v[36:37], v[232:233], v[104:105] op_sel_hi:[1,0,1]
v_pk_mul_f32 v[104:105], v[104:105], v[232:233] op_sel:[0,1] op_sel_hi:[1,1]
v_cvt_pk_bf16_f32 v196, v104, v105
v_pk_fma_f32 v[106:107], v[38:39], v[232:233], v[106:107] op_sel_hi:[1,0,1]
v_pk_mul_f32 v[106:107], v[106:107], v[232:233] op_sel:[0,1] op_sel_hi:[1,1]
v_cvt_pk_bf16_f32 v197, v106, v107
v_pk_fma_f32 v[120:121], v[40:41], v[232:233], v[120:121] op_sel_hi:[1,0,1]
v_pk_mul_f32 v[120:121], v[120:121], v[232:233] op_sel:[0,1] op_sel_hi:[1,1]
v_cvt_pk_bf16_f32 v198, v120, v121
v_pk_fma_f32 v[122:123], v[42:43], v[232:233], v[122:123] op_sel_hi:[1,0,1]
v_pk_mul_f32 v[122:123], v[122:123], v[232:233] op_sel:[0,1] op_sel_hi:[1,1]
v_cvt_pk_bf16_f32 v199, v122, v123
ds_write_b128 v8, v[196:199]
buffer_load_dwordx4 v6, s[24:27], s58 offen offset:1024 lds
s_waitcnt lgkmcnt(4)
v_pk_fma_f32 v[136:137], v[240:241], v[44:45], v[136:137] op_sel_hi:[1,0,1]
v_pk_fma_f32 v[138:139], v[242:243], v[44:45], v[138:139] op_sel_hi:[1,0,1]
v_pk_fma_f32 v[152:153], v[240:241], v[44:45], v[152:153] op_sel:[0,1,0] op_sel_hi:[1,1,1]
v_pk_fma_f32 v[154:155], v[242:243], v[44:45], v[154:155] op_sel:[0,1,0] op_sel_hi:[1,1,1]
s_waitcnt lgkmcnt(3)
v_pk_mul_f32 v[136:137], v[136:137], v[244:245]
v_cvt_pk_bf16_f32 v208, v136, v137
v_pk_mul_f32 v[138:139], v[138:139], v[246:247]
v_cvt_pk_bf16_f32 v209, v138, v139
v_pk_mul_f32 v[152:153], v[152:153], v[244:245]
v_cvt_pk_bf16_f32 v218, v152, v153
v_pk_mul_f32 v[154:155], v[154:155], v[246:247]
v_cvt_pk_bf16_f32 v219, v154, v155
ds_write_b64 v8, v[208:209] offset:1024
ds_write_b64 v8, v[218:219] offset:1032
s_add_u32 m0, s59, 8320
s_mov_b32 s58, 1179648
buffer_load_dwordx4 v5, s[24:27], s58 offen lds
v_pk_fma_f32 v[100:101], v[36:37], v[228:229], v[100:101] op_sel_hi:[1,0,1]
v_pk_mul_f32 v[100:101], v[100:101], v[228:229] op_sel:[0,1] op_sel_hi:[1,1]
v_cvt_pk_bf16_f32 v192, v100, v101
v_pk_fma_f32 v[102:103], v[38:39], v[228:229], v[102:103] op_sel_hi:[1,0,1]
v_pk_mul_f32 v[102:103], v[102:103], v[228:229] op_sel:[0,1] op_sel_hi:[1,1]
v_cvt_pk_bf16_f32 v193, v102, v103
v_pk_fma_f32 v[116:117], v[40:41], v[228:229], v[116:117] op_sel_hi:[1,0,1]
v_pk_mul_f32 v[116:117], v[116:117], v[228:229] op_sel:[0,1] op_sel_hi:[1,1]
v_cvt_pk_bf16_f32 v194, v116, v117
v_pk_fma_f32 v[118:119], v[42:43], v[228:229], v[118:119] op_sel_hi:[1,0,1]
v_pk_mul_f32 v[118:119], v[118:119], v[228:229] op_sel:[0,1] op_sel_hi:[1,1]
v_cvt_pk_bf16_f32 v195, v118, v119
ds_read_b128 v[240:243], v11 offset:64
buffer_load_dwordx4 v6, s[24:27], s58 offen offset:1024 lds
s_add_u32 m0, s59, 16640
s_mov_b32 s58, 1310720
ds_read_b128 v[244:247], v11 offset:1088
v_pk_fma_f32 v[156:157], v[36:37], v[236:237], v[156:157] op_sel_hi:[1,0,1]
v_pk_mul_f32 v[156:157], v[156:157], v[236:237] op_sel:[0,1] op_sel_hi:[1,1]
v_cvt_pk_bf16_f32 v180, v156, v157
v_pk_fma_f32 v[158:159], v[38:39], v[236:237], v[158:159] op_sel_hi:[1,0,1]
v_pk_mul_f32 v[158:159], v[158:159], v[236:237] op_sel:[0,1] op_sel_hi:[1,1]
s_waitcnt lgkmcnt(2)
s_barrier
ds_read_b64 v[200:201], v9 offset:1024
ds_read_b64 v[210:211], v9 offset:1032
buffer_load_dwordx4 v5, s[24:27], s58 offen lds
v_cvt_pk_bf16_f32 v181, v158, v159
v_pk_fma_f32 v[160:161], v[40:41], v[236:237], v[160:161] op_sel_hi:[1,0,1]
v_pk_mul_f32 v[160:161], v[160:161], v[236:237] op_sel:[0,1] op_sel_hi:[1,1]
v_cvt_pk_bf16_f32 v182, v160, v161
v_pk_fma_f32 v[162:163], v[42:43], v[236:237], v[162:163] op_sel_hi:[1,0,1]
v_pk_mul_f32 v[162:163], v[162:163], v[236:237] op_sel:[0,1] op_sel_hi:[1,1]
s_nop 1
v_mfma_f32_16x16x32_bf16 v[96:99], a[72:75], a[48:51], v[96:99]
v_cvt_pk_bf16_f32 v183, v162, v163
v_mfma_f32_16x16x32_bf16 v[112:115], a[76:79], a[48:51], v[112:115]
buffer_load_dwordx4 v6, s[24:27], s58 offen offset:1024 lds
v_mfma_f32_16x16x32_bf16 v[92:95], a[72:75], a[44:47], v[92:95]
s_add_u32 m0, s59, 74880
s_mov_b32 s58, 131072
v_mfma_f32_16x16x32_bf16 v[108:111], a[76:79], a[44:47], v[108:111]
v_mfma_f32_16x16x32_bf16 v[72:75], a[64:67], a[56:59], v[72:75]
buffer_load_dwordx4 v5, s[24:27], s58 offen lds
v_pk_fma_f32 v[96:97], v[36:37], v[224:225], v[96:97] op_sel_hi:[1,0,1]
s_nop 5
v_pk_fma_f32 v[72:73], v[28:29], v[232:233], v[72:73] op_sel_hi:[1,0,1]
v_cvt_pk_bf16_f32 v176, v72, v73
v_pk_fma_f32 v[74:75], v[30:31], v[232:233], v[74:75] op_sel_hi:[1,0,1]
v_cvt_pk_bf16_f32 v177, v74, v75
v_pk_mul_f32 v[96:97], v[96:97], v[224:225] op_sel:[0,1] op_sel_hi:[1,1]
v_cvt_pk_bf16_f32 v188, v96, v97
v_pk_fma_f32 v[98:99], v[38:39], v[224:225], v[98:99] op_sel_hi:[1,0,1]
v_pk_mul_f32 v[98:99], v[98:99], v[224:225] op_sel:[0,1] op_sel_hi:[1,1]
v_cvt_pk_bf16_f32 v189, v98, v99
v_pk_fma_f32 v[112:113], v[40:41], v[224:225], v[112:113] op_sel_hi:[1,0,1]
v_pk_mul_f32 v[112:113], v[112:113], v[224:225] op_sel:[0,1] op_sel_hi:[1,1]
v_cvt_pk_bf16_f32 v190, v112, v113
buffer_load_dwordx4 v6, s[24:27], s58 offen offset:1024 lds
s_add_u32 m0, s59, 83200
s_mov_b32 s58, 262144
v_pk_fma_f32 v[114:115], v[42:43], v[224:225], v[114:115] op_sel_hi:[1,0,1]
v_pk_mul_f32 v[114:115], v[114:115], v[224:225] op_sel:[0,1] op_sel_hi:[1,1]
v_cvt_pk_bf16_f32 v191, v114, v115
v_pk_fma_f32 v[92:93], v[36:37], v[220:221], v[92:93] op_sel_hi:[1,0,1]
v_pk_mul_f32 v[92:93], v[92:93], v[220:221] op_sel:[0,1] op_sel_hi:[1,1]
v_cvt_pk_bf16_f32 v184, v92, v93
v_pk_fma_f32 v[94:95], v[38:39], v[220:221], v[94:95] op_sel_hi:[1,0,1]
v_pk_mul_f32 v[94:95], v[94:95], v[220:221] op_sel:[0,1] op_sel_hi:[1,1]
v_cvt_pk_bf16_f32 v185, v94, v95
v_pk_fma_f32 v[108:109], v[40:41], v[220:221], v[108:109] op_sel_hi:[1,0,1]
v_pk_mul_f32 v[108:109], v[108:109], v[220:221] op_sel:[0,1] op_sel_hi:[1,1]
buffer_load_dwordx4 v5, s[24:27], s58 offen lds
v_cvt_pk_bf16_f32 v186, v108, v109
v_pk_fma_f32 v[110:111], v[42:43], v[220:221], v[110:111] op_sel_hi:[1,0,1]
v_pk_mul_f32 v[110:111], v[110:111], v[220:221] op_sel:[0,1] op_sel_hi:[1,1]
s_nop 1
v_mfma_f32_16x16x32_bf16 v[88:91], a[68:71], a[56:59], v[88:91]
v_cvt_pk_bf16_f32 v187, v110, v111
v_mfma_f32_16x16x32_bf16 v[132:135], a[52:55], a[80:83], v[132:135]
v_mfma_f32_16x16x32_bf16 v[148:151], a[52:55], a[84:87], v[148:151]
buffer_load_dwordx4 v6, s[24:27], s58 offen offset:1024 lds
v_mfma_f32_16x16x32_bf16 v[68:71], a[64:67], a[52:55], v[68:71]
v_mfma_f32_16x16x32_bf16 v[84:87], a[68:71], a[52:55], v[84:87]
s_nop 1
v_pk_fma_f32 v[88:89], v[32:33], v[232:233], v[88:89] op_sel_hi:[1,0,1]
v_cvt_pk_bf16_f32 v178, v88, v89
v_pk_fma_f32 v[90:91], v[34:35], v[232:233], v[90:91] op_sel_hi:[1,0,1]
v_cvt_pk_bf16_f32 v179, v90, v91
v_pk_fma_f32 v[132:133], v[18:19], v[44:45], v[132:133] op_sel_hi:[1,0,1]
v_pk_mul_f32 v[132:133], v[132:133], v[22:23]
v_cvt_pk_bf16_f32 v206, v132, v133
v_pk_fma_f32 v[134:135], v[20:21], v[44:45], v[134:135] op_sel_hi:[1,0,1]
v_pk_mul_f32 v[134:135], v[134:135], v[24:25]
v_cvt_pk_bf16_f32 v207, v134, v135
v_pk_fma_f32 v[148:149], v[18:19], v[44:45], v[148:149] op_sel:[0,1,0] op_sel_hi:[1,1,1]
v_pk_mul_f32 v[148:149], v[148:149], v[22:23]
v_cvt_pk_bf16_f32 v216, v148, v149
v_pk_fma_f32 v[150:151], v[20:21], v[44:45], v[150:151] op_sel:[0,1,0] op_sel_hi:[1,1,1]
v_pk_mul_f32 v[150:151], v[150:151], v[24:25]
v_cvt_pk_bf16_f32 v217, v150, v151
v_pk_fma_f32 v[68:69], v[28:29], v[228:229], v[68:69] op_sel_hi:[1,0,1]
v_cvt_pk_bf16_f32 v172, v68, v69
v_pk_fma_f32 v[70:71], v[30:31], v[228:229], v[70:71] op_sel_hi:[1,0,1]
v_cvt_pk_bf16_f32 v173, v70, v71
v_pk_fma_f32 v[84:85], v[32:33], v[228:229], v[84:85] op_sel_hi:[1,0,1]
v_cvt_pk_bf16_f32 v174, v84, v85
v_pk_fma_f32 v[86:87], v[34:35], v[228:229], v[86:87] op_sel_hi:[1,0,1]
s_nop 1
v_mfma_f32_16x16x32_bf16 v[128:131], a[48:51], a[80:83], v[128:131]
ds_read_b128 v[18:21], v11
v_cvt_pk_bf16_f32 v175, v86, v87
v_mfma_f32_16x16x32_bf16 v[144:147], a[48:51], a[84:87], v[144:147]
ds_read_b128 v[22:25], v11 offset:1024
v_mfma_f32_16x16x32_bf16 v[64:67], a[64:67], a[48:51], v[64:67]
v_mfma_f32_16x16x32_bf16 v[80:83], a[68:71], a[48:51], v[80:83]
v_mfma_f32_16x16x32_bf16 v[124:127], a[44:47], a[80:83], v[124:127]
s_waitcnt lgkmcnt(5)
v_pk_fma_f32 v[128:129], v[240:241], v[44:45], v[128:129] op_sel_hi:[1,0,1]
s_waitcnt lgkmcnt(4)
v_pk_mul_f32 v[128:129], v[128:129], v[244:245]
v_cvt_pk_bf16_f32 v204, v128, v129
v_pk_fma_f32 v[130:131], v[242:243], v[44:45], v[130:131] op_sel_hi:[1,0,1]
v_pk_mul_f32 v[130:131], v[130:131], v[246:247]
v_cvt_pk_bf16_f32 v205, v130, v131
v_pk_fma_f32 v[144:145], v[240:241], v[44:45], v[144:145] op_sel:[0,1,0] op_sel_hi:[1,1,1]
v_pk_mul_f32 v[144:145], v[144:145], v[244:245]
v_cvt_pk_bf16_f32 v214, v144, v145
v_pk_fma_f32 v[146:147], v[242:243], v[44:45], v[146:147] op_sel:[0,1,0] op_sel_hi:[1,1,1]
v_pk_mul_f32 v[146:147], v[146:147], v[246:247]
v_cvt_pk_bf16_f32 v215, v146, v147
v_pk_fma_f32 v[64:65], v[28:29], v[224:225], v[64:65] op_sel_hi:[1,0,1]
v_cvt_pk_bf16_f32 v168, v64, v65
v_pk_fma_f32 v[66:67], v[30:31], v[224:225], v[66:67] op_sel_hi:[1,0,1]
v_cvt_pk_bf16_f32 v169, v66, v67
v_pk_fma_f32 v[80:81], v[32:33], v[224:225], v[80:81] op_sel_hi:[1,0,1]
v_cvt_pk_bf16_f32 v170, v80, v81
v_pk_fma_f32 v[82:83], v[34:35], v[224:225], v[82:83] op_sel_hi:[1,0,1]
v_cvt_pk_bf16_f32 v171, v82, v83
s_waitcnt lgkmcnt(1)
v_pk_fma_f32 v[124:125], v[18:19], v[44:45], v[124:125] op_sel_hi:[1,0,1]
s_waitcnt lgkmcnt(0)
v_pk_mul_f32 v[124:125], v[124:125], v[22:23]
v_cvt_pk_bf16_f32 v202, v124, v125
v_pk_fma_f32 v[126:127], v[20:21], v[44:45], v[126:127] op_sel_hi:[1,0,1]
v_pk_mul_f32 v[126:127], v[126:127], v[24:25]
s_nop 1
v_mfma_f32_16x16x32_bf16 v[140:143], a[44:47], a[84:87], v[140:143]
v_cvt_pk_bf16_f32 v203, v126, v127
v_mfma_f32_16x16x32_bf16 v[60:63], a[64:67], a[44:47], v[60:63]
v_mfma_f32_16x16x32_bf16 v[76:79], a[68:71], a[44:47], v[76:79]
v_mfma_f32_16x16x32_bf16 v[104:107], v[192:195], v[176:179], v[46:49]
v_mfma_f32_16x16x32_bf16 v[120:123], v[196:199], v[176:179], v[50:53]
v_mfma_f32_16x16x32_bf16 v[100:103], v[188:191], v[172:175], v[46:49]
s_nop 5
v_max3_f32 v88, v104, v105, v106
v_mfma_f32_16x16x32_bf16 v[116:119], v[192:195], v[172:175], v[50:53]
v_max3_f32 v89, v107, v120, v121
v_max3_f32 v88, v88, v122, v123
v_mfma_f32_16x16x32_bf16 v[96:99], v[184:187], v[168:171], v[46:49]
v_max_f32 v90, v88, v89
v_max_f32 v89, v88, v89
v_mfma_f32_16x16x32_bf16 v[112:115], v[188:191], v[168:171], v[50:53]
s_nop 0
v_permlane16_swap_b32 v90, v89
v_max3_f32 v84, v100, v101, v102
.Lpad18:
s_cbranch_execz .Lpad21
v_max3_f32 v85, v103, v116, v117
v_max_f32 v88, v90, v89
v_max_f32 v89, v90, v89
v_max3_f32 v84, v84, v118, v119
v_max_f32 v86, v84, v85
v_permlane32_swap_b32 v88, v89
v_max_f32 v85, v84, v85
v_pk_fma_f32 v[140:141], v[18:19], v[44:45], v[140:141] op_sel:[0,1,0] op_sel_hi:[1,1,1]
v_max_f32 v88, v88, v89
v_permlane16_swap_b32 v86, v85
v_mul_f32 v88, v88, v234
v_pk_fma_f32 v[104:105], v[104:105], v[234:235], v[88:89] op_sel_hi:[1,0,0] neg_lo:[0,0,1] neg_hi:[0,0,1]
v_exp_f32 v104, v104
v_pk_fma_f32 v[106:107], v[106:107], v[234:235], v[88:89] op_sel_hi:[1,0,0] neg_lo:[0,0,1] neg_hi:[0,0,1]
v_exp_f32 v105, v105
v_pk_fma_f32 v[120:121], v[120:121], v[234:235], v[88:89] op_sel_hi:[1,0,0] neg_lo:[0,0,1] neg_hi:[0,0,1]
v_exp_f32 v106, v106
v_pk_fma_f32 v[122:123], v[122:123], v[234:235], v[88:89] op_sel_hi:[1,0,0] neg_lo:[0,0,1] neg_hi:[0,0,1]
v_exp_f32 v107, v107
v_cvt_pk_bf16_f32 v72, v104, v105
v_exp_f32 v120, v120
v_cvt_pk_bf16_f32 v73, v106, v107
v_exp_f32 v121, v121
v_max_f32 v84, v86, v85
v_exp_f32 v122, v122
v_cvt_pk_bf16_f32 v74, v120, v121
v_exp_f32 v123, v123
v_max_f32 v85, v86, v85
v_pk_mul_f32 v[140:141], v[140:141], v[22:23]
v_cvt_pk_bf16_f32 v75, v122, v123
v_permlane32_swap_b32 v84, v85
v_cvt_pk_bf16_f32 v212, v140, v141
v_pk_fma_f32 v[142:143], v[20:21], v[44:45], v[142:143] op_sel:[0,1,0] op_sel_hi:[1,1,1]
v_max_f32 v84, v84, v85
v_mul_f32 v84, v84, v230
v_pk_fma_f32 v[100:101], v[100:101], v[230:231], v[84:85] op_sel_hi:[1,0,0] neg_lo:[0,0,1] neg_hi:[0,0,1]
v_exp_f32 v100, v100
v_pk_fma_f32 v[102:103], v[102:103], v[230:231], v[84:85] op_sel_hi:[1,0,0] neg_lo:[0,0,1] neg_hi:[0,0,1]
v_exp_f32 v101, v101
v_pk_fma_f32 v[116:117], v[116:117], v[230:231], v[84:85] op_sel_hi:[1,0,0] neg_lo:[0,0,1] neg_hi:[0,0,1]
v_exp_f32 v102, v102
v_pk_fma_f32 v[118:119], v[118:119], v[230:231], v[84:85] op_sel_hi:[1,0,0] neg_lo:[0,0,1] neg_hi:[0,0,1]
v_exp_f32 v103, v103
v_cvt_pk_bf16_f32 v68, v100, v101
v_exp_f32 v116, v116
v_cvt_pk_bf16_f32 v69, v102, v103
v_exp_f32 v117, v117
v_pk_mul_f32 v[142:143], v[142:143], v[24:25]
v_exp_f32 v118, v118
v_cvt_pk_bf16_f32 v70, v116, v117
v_exp_f32 v119, v119
v_cvt_pk_bf16_f32 v213, v142, v143
v_max3_f32 v80, v96, v97, v98
v_cvt_pk_bf16_f32 v71, v118, v119
v_max3_f32 v81, v99, v112, v113
v_max3_f32 v80, v80, v114, v115
v_max_f32 v82, v80, v81
v_max_f32 v81, v80, v81
v_pk_fma_f32 v[60:61], v[28:29], v[220:221], v[60:61] op_sel_hi:[1,0,1]
v_cvt_pk_bf16_f32 v164, v60, v61
v_permlane16_swap_b32 v82, v81
v_pk_fma_f32 v[62:63], v[30:31], v[220:221], v[62:63] op_sel_hi:[1,0,1]
v_cvt_pk_bf16_f32 v165, v62, v63
v_max_f32 v80, v82, v81
v_max_f32 v81, v82, v81
v_pk_fma_f32 v[76:77], v[32:33], v[220:221], v[76:77] op_sel_hi:[1,0,1]
v_cvt_pk_bf16_f32 v166, v76, v77
v_permlane32_swap_b32 v80, v81
v_pk_fma_f32 v[78:79], v[34:35], v[220:221], v[78:79] op_sel_hi:[1,0,1]
s_nop 1
v_mfma_f32_16x16x32_bf16 v[88:91], v[248:251], v[72:75], 0
v_max_f32 v80, v80, v81
v_mul_f32 v80, v80, v226
v_mfma_f32_16x16x32_bf16 v[104:107], v[206:209], v[72:75], 0
v_cvt_pk_bf16_f32 v167, v78, v79
v_mfma_f32_16x16x32_bf16 v[120:123], v[216:219], v[72:75], 0
s_nop 2
v_rcp_f32 v88, v88
s_nop 1
v_pk_mul_f32 v[104:105], v[104:105], v[88:89] op_sel_hi:[1,0]
v_pk_mul_f32 v[106:107], v[106:107], v[88:89] op_sel_hi:[1,0]
v_pk_mul_f32 v[120:121], v[120:121], v[88:89] op_sel_hi:[1,0]
v_pk_mul_f32 v[122:123], v[122:123], v[88:89] op_sel_hi:[1,0]
v_cvt_pk_bf16_f32 v176, v104, v105
v_cvt_pk_bf16_f32 v177, v106, v107
v_cvt_pk_bf16_f32 v178, v120, v121
v_cvt_pk_bf16_f32 v179, v122, v123
buffer_store_dwordx4 v[176:179], v4, s[16:19], s74 offen offset:3072 sc1
v_pk_fma_f32 v[96:97], v[96:97], v[226:227], v[80:81] op_sel_hi:[1,0,0] neg_lo:[0,0,1] neg_hi:[0,0,1]
v_exp_f32 v96, v96
v_pk_fma_f32 v[98:99], v[98:99], v[226:227], v[80:81] op_sel_hi:[1,0,0] neg_lo:[0,0,1] neg_hi:[0,0,1]
v_exp_f32 v97, v97
v_pk_fma_f32 v[112:113], v[112:113], v[226:227], v[80:81] op_sel_hi:[1,0,0] neg_lo:[0,0,1] neg_hi:[0,0,1]
v_exp_f32 v98, v98
v_pk_fma_f32 v[114:115], v[114:115], v[226:227], v[80:81] op_sel_hi:[1,0,0] neg_lo:[0,0,1] neg_hi:[0,0,1]
v_exp_f32 v99, v99
v_cvt_pk_bf16_f32 v64, v96, v97
v_exp_f32 v112, v112
v_cvt_pk_bf16_f32 v65, v98, v99
v_exp_f32 v113, v113
v_exp_f32 v114, v114
v_cvt_pk_bf16_f32 v66, v112, v113
v_exp_f32 v115, v115
v_mfma_f32_16x16x32_bf16 v[84:87], v[248:251], v[68:71], 0
v_cvt_pk_bf16_f32 v67, v114, v115
v_mfma_f32_16x16x32_bf16 v[100:103], v[204:207], v[68:71], 0
v_mfma_f32_16x16x32_bf16 v[116:119], v[214:217], v[68:71], 0
s_nop 4
v_rcp_f32 v84, v84
v_mfma_f32_16x16x32_bf16 v[80:83], v[248:251], v[64:67], 0
v_mfma_f32_16x16x32_bf16 v[96:99], v[202:205], v[64:67], 0
v_mfma_f32_16x16x32_bf16 v[112:115], v[212:215], v[64:67], 0
s_nop 5
v_rcp_f32 v80, v80
v_pk_mul_f32 v[100:101], v[100:101], v[84:85] op_sel_hi:[1,0]
v_pk_mul_f32 v[102:103], v[102:103], v[84:85] op_sel_hi:[1,0]
v_pk_mul_f32 v[116:117], v[116:117], v[84:85] op_sel_hi:[1,0]
v_pk_mul_f32 v[118:119], v[118:119], v[84:85] op_sel_hi:[1,0]
v_cvt_pk_bf16_f32 v172, v100, v101
v_cvt_pk_bf16_f32 v173, v102, v103
v_cvt_pk_bf16_f32 v174, v116, v117
v_cvt_pk_bf16_f32 v175, v118, v119
buffer_store_dwordx4 v[172:175], v4, s[16:19], s74 offen offset:2048 sc1
v_pk_mul_f32 v[96:97], v[96:97], v[80:81] op_sel_hi:[1,0]
v_pk_mul_f32 v[98:99], v[98:99], v[80:81] op_sel_hi:[1,0]
v_pk_mul_f32 v[112:113], v[112:113], v[80:81] op_sel_hi:[1,0]
v_pk_mul_f32 v[114:115], v[114:115], v[80:81] op_sel_hi:[1,0]
s_nop 1
v_mfma_f32_16x16x32_bf16 v[92:95], v[180:183], v[164:167], v[54:57]
v_cvt_pk_bf16_f32 v168, v96, v97
v_cvt_pk_bf16_f32 v169, v98, v99
v_mfma_f32_16x16x32_bf16 v[108:111], v[184:187], v[164:167], v[50:53]
v_cvt_pk_bf16_f32 v170, v112, v113
v_cvt_pk_bf16_f32 v171, v114, v115
buffer_store_dwordx4 v[168:171], v4, s[16:19], s74 offen offset:1024 sc1
s_nop 1
v_max3_f32 v76, v92, v93, v94
s_nop 1
v_max3_f32 v77, v95, v108, v109
v_max3_f32 v76, v76, v110, v111
v_max_f32 v78, v76, v77
v_max_f32 v77, v76, v77
s_nop 1
v_permlane16_swap_b32 v78, v77
v_max_f32 v76, v78, v77
v_max_f32 v77, v78, v77
s_nop 1
v_permlane32_swap_b32 v76, v77
v_max_f32 v76, v76, v77
v_mul_f32 v76, v76, v222
v_pk_fma_f32 v[92:93], v[92:93], v[222:223], v[76:77] op_sel_hi:[1,0,0] neg_lo:[0,0,1] neg_hi:[0,0,1]
v_exp_f32 v92, v92
v_pk_fma_f32 v[94:95], v[94:95], v[222:223], v[76:77] op_sel_hi:[1,0,0] neg_lo:[0,0,1] neg_hi:[0,0,1]
v_exp_f32 v93, v93
v_pk_fma_f32 v[108:109], v[108:109], v[222:223], v[76:77] op_sel_hi:[1,0,0] neg_lo:[0,0,1] neg_hi:[0,0,1]
v_exp_f32 v94, v94
v_pk_fma_f32 v[110:111], v[110:111], v[222:223], v[76:77] op_sel_hi:[1,0,0] neg_lo:[0,0,1] neg_hi:[0,0,1]
v_exp_f32 v95, v95
v_cvt_pk_bf16_f32 v60, v92, v93
v_exp_f32 v108, v108
v_cvt_pk_bf16_f32 v61, v94, v95
v_exp_f32 v109, v109
v_exp_f32 v110, v110
v_cvt_pk_bf16_f32 v62, v108, v109
v_exp_f32 v111, v111
s_nop 0
v_cvt_pk_bf16_f32 v63, v110, v111
s_nop 1
v_mfma_f32_16x16x32_bf16 v[76:79], v[248:251], v[60:63], 0
v_mfma_f32_16x16x32_bf16 v[92:95], v[200:203], v[60:63], 0
v_mfma_f32_16x16x32_bf16 v[108:111], v[210:213], v[60:63], 0
s_nop 5
v_rcp_f32 v76, v76
s_nop 0
v_pk_mul_f32 v[92:93], v[92:93], v[76:77] op_sel_hi:[1,0]
v_pk_mul_f32 v[94:95], v[94:95], v[76:77] op_sel_hi:[1,0]
v_pk_mul_f32 v[108:109], v[108:109], v[76:77] op_sel_hi:[1,0]
v_pk_mul_f32 v[110:111], v[110:111], v[76:77] op_sel_hi:[1,0]
v_cvt_pk_bf16_f32 v164, v92, v93
v_cvt_pk_bf16_f32 v165, v94, v95
v_cvt_pk_bf16_f32 v166, v108, v109
v_cvt_pk_bf16_f32 v167, v110, v111
buffer_store_dwordx4 v[164:167], v4, s[16:19], s74 offen sc1
s_nop 1
s_branch .Lqkve32
.Lqkv31:
.Lpad19:
s_cbranch_execz .Lpad22
s_add_u32 m0, s55, 0
s_nop 0
buffer_load_dwordx4 v21, s[16:19], s52 offen sc1 lds
buffer_load_dwordx4 v21, s[16:19], s52 offen offset:1024 sc1 lds
buffer_load_dword v22, s[16:19], s52 offen offset:2048 sc1 lds
s_add_u32 s52, s52, 0x20000
s_add_u32 m0, s55, 9216
s_nop 0
buffer_load_dwordx4 v21, s[16:19], s52 offen sc1 lds
buffer_load_dwordx4 v21, s[16:19], s52 offen offset:1024 sc1 lds
buffer_load_dword v22, s[16:19], s52 offen offset:2048 sc1 lds
s_add_u32 s52, s52, 0x20000
s_add_u32 m0, s55, 18432
s_nop 0
buffer_load_dwordx4 v21, s[16:19], s52 offen sc1 lds
buffer_load_dwordx4 v21, s[16:19], s52 offen offset:1024 sc1 lds
buffer_load_dword v22, s[16:19], s52 offen offset:2048 sc1 lds
s_add_u32 s52, s52, 0x20000
s_add_u32 m0, s55, 27648
s_nop 0
buffer_load_dwordx4 v21, s[16:19], s52 offen sc1 lds
buffer_load_dwordx4 v21, s[16:19], s52 offen offset:1024 sc1 lds
buffer_load_dword v22, s[16:19], s52 offen offset:2048 sc1 lds
s_add_u32 s52, s52, 0x20000
s_add_u32 m0, s55, 36864
s_nop 0
buffer_load_dwordx4 v21, s[16:19], s52 offen sc1 lds
buffer_load_dwordx4 v21, s[16:19], s52 offen offset:1024 sc1 lds
buffer_load_dword v22, s[16:19], s52 offen offset:2048 sc1 lds
s_add_u32 s52, s52, 0x20000
s_add_u32 m0, s55, 46080
s_nop 0
buffer_load_dwordx4 v21, s[16:19], s52 offen sc1 lds
buffer_load_dwordx4 v21, s[16:19], s52 offen offset:1024 sc1 lds
buffer_load_dword v22, s[16:19], s52 offen offset:2048 sc1 lds
s_add_u32 s52, s52, 0x20000
s_waitcnt vmcnt(15)
s_barrier
ds_read_b128 a[0:3], v23
ds_read_b128 a[4:7], v23 offset:1024
ds_read_b128 a[8:11], v23 offset:2304
ds_read_b128 a[12:15], v23 offset:3328
ds_read_b128 a[16:19], v24 offset:2048
s_mov_b32 s15, 4
.p2align 6
.Lk34:
s_waitcnt vmcnt(12) lgkmcnt(0)
s_barrier
v_mfma_f32_16x16x32_bf16 v[60:63], a[20:23], a[0:3], v[60:63]
ds_read_b64_tr_b16 a[64:65], v25 offset:12416
s_add_u32 m0, s56, 66560
v_mfma_f32_16x16x32_bf16 v[64:67], a[20:23], a[4:7], v[64:67]
buffer_load_dwordx4 v18, s[20:23], s54 offen lds
v_mfma_f32_16x16x32_bf16 v[68:71], a[20:23], a[8:11], v[68:71]
ds_read_b64_tr_b16 a[66:67], v25 offset:12928
v_mfma_f32_16x16x32_bf16 v[72:75], a[20:23], a[12:15], v[72:75]
ds_read_b64_tr_b16 a[68:69], v25 offset:12448
ds_read_b64_tr_b16 a[70:71], v25 offset:12960
v_mfma_f32_16x16x32_bf16 v[76:79], a[24:27], a[0:3], v[76:79]
ds_read_b64_tr_b16 a[72:73], v25 offset:13440
v_mfma_f32_16x16x32_bf16 v[80:83], a[24:27], a[4:7], v[80:83]
buffer_load_dwordx4 v19, s[20:23], s54 offen offset:1024 lds
v_mfma_f32_16x16x32_bf16 v[84:87], a[24:27], a[8:11], v[84:87]
ds_read_b64_tr_b16 a[74:75], v25 offset:13952
v_mfma_f32_16x16x32_bf16 v[88:91], a[24:27], a[12:15], v[88:91]
ds_read_b64_tr_b16 a[76:77], v25 offset:13472
v_mfma_f32_16x16x32_bf16 v[92:95], a[28:31], a[0:3], v[92:95]
ds_read_b64_tr_b16 a[78:79], v25 offset:13984
ds_read_b128 a[44:47], v23 offset:9216
v_mfma_f32_16x16x32_bf16 v[96:99], a[28:31], a[4:7], v[96:99]
buffer_load_dwordx4 v20, s[20:23], s54 offen offset:2048 lds
v_mfma_f32_16x16x32_bf16 v[100:103], a[28:31], a[8:11], v[100:103]
s_add_u32 s54, s54, 196608
v_mfma_f32_16x16x32_bf16 v[104:107], a[28:31], a[12:15], v[104:107]
ds_read_b128 a[48:51], v23 offset:10240
ds_read_b64_tr_b16 a[80:81], v25 offset:14464
v_mfma_f32_16x16x32_bf16 v[108:111], a[32:35], a[0:3], v[108:111]
s_add_u32 m0, s55, 0
v_mfma_f32_16x16x32_bf16 v[112:115], a[32:35], a[4:7], v[112:115]
buffer_load_dwordx4 v21, s[16:19], s52 offen sc1 lds
v_mfma_f32_16x16x32_bf16 v[116:119], a[32:35], a[8:11], v[116:119]
ds_read_b64_tr_b16 a[82:83], v25 offset:14976
v_mfma_f32_16x16x32_bf16 v[120:123], a[32:35], a[12:15], v[120:123]
ds_read_b128 a[52:55], v23 offset:11520
ds_read_b128 a[56:59], v23 offset:12544
v_mfma_f32_16x16x32_bf16 v[124:127], a[0:3], a[36:39], v[124:127]
ds_read_b64_tr_b16 a[84:85], v25 offset:14496
v_mfma_f32_16x16x32_bf16 v[128:131], a[4:7], a[36:39], v[128:131]
buffer_load_dwordx4 v21, s[16:19], s52 offen offset:1024 sc1 lds
v_mfma_f32_16x16x32_bf16 v[132:135], a[8:11], a[36:39], v[132:135]
ds_read_b64_tr_b16 a[86:87], v25 offset:15008
v_mfma_f32_16x16x32_bf16 v[136:139], a[12:15], a[36:39], v[136:139]
ds_read_b128 a[60:63], v24 offset:11264
v_mfma_f32_16x16x32_bf16 v[156:159], a[16:19], a[36:39], v[156:159]
v_mfma_f32_16x16x32_bf16 v[140:143], a[0:3], a[40:43], v[140:143]
buffer_load_dword v22, s[16:19], s52 offen offset:2048 sc1 lds
v_mfma_f32_16x16x32_bf16 v[144:147], a[4:7], a[40:43], v[144:147]
s_add_u32 s52, s52, 0x20000
v_mfma_f32_16x16x32_bf16 v[148:151], a[8:11], a[40:43], v[148:151]
v_mfma_f32_16x16x32_bf16 v[152:155], a[12:15], a[40:43], v[152:155]
v_mfma_f32_16x16x32_bf16 v[160:163], a[16:19], a[40:43], v[160:163]
s_waitcnt vmcnt(15) lgkmcnt(0)
s_barrier
v_mfma_f32_16x16x32_bf16 v[60:63], a[64:67], a[44:47], v[60:63]
ds_read_b64_tr_b16 a[20:21], v25 offset:24832
s_add_u32 m0, s56, 78976
v_mfma_f32_16x16x32_bf16 v[64:67], a[64:67], a[48:51], v[64:67]
buffer_load_dwordx4 v18, s[20:23], s54 offen lds
v_mfma_f32_16x16x32_bf16 v[68:71], a[64:67], a[52:55], v[68:71]
ds_read_b64_tr_b16 a[22:23], v25 offset:25344
v_mfma_f32_16x16x32_bf16 v[72:75], a[64:67], a[56:59], v[72:75]
ds_read_b64_tr_b16 a[24:25], v25 offset:24864
ds_read_b64_tr_b16 a[26:27], v25 offset:25376
v_mfma_f32_16x16x32_bf16 v[76:79], a[68:71], a[44:47], v[76:79]
ds_read_b64_tr_b16 a[28:29], v25 offset:25856
v_mfma_f32_16x16x32_bf16 v[80:83], a[68:71], a[48:51], v[80:83]
buffer_load_dwordx4 v19, s[20:23], s54 offen offset:1024 lds
v_mfma_f32_16x16x32_bf16 v[84:87], a[68:71], a[52:55], v[84:87]
ds_read_b64_tr_b16 a[30:31], v25 offset:26368
v_mfma_f32_16x16x32_bf16 v[88:91], a[68:71], a[56:59], v[88:91]
ds_read_b64_tr_b16 a[32:33], v25 offset:25888
v_mfma_f32_16x16x32_bf16 v[92:95], a[72:75], a[44:47], v[92:95]
ds_read_b64_tr_b16 a[34:35], v25 offset:26400
ds_read_b128 a[0:3], v23 offset:18432
v_mfma_f32_16x16x32_bf16 v[96:99], a[72:75], a[48:51], v[96:99]
buffer_load_dwordx4 v20, s[20:23], s54 offen offset:2048 lds
v_mfma_f32_16x16x32_bf16 v[100:103], a[72:75], a[52:55], v[100:103]
s_add_u32 s54, s54, 196608
v_mfma_f32_16x16x32_bf16 v[104:107], a[72:75], a[56:59], v[104:107]
ds_read_b128 a[4:7], v23 offset:19456
ds_read_b64_tr_b16 a[36:37], v25 offset:26880
v_mfma_f32_16x16x32_bf16 v[108:111], a[76:79], a[44:47], v[108:111]
s_add_u32 m0, s55, 9216
v_mfma_f32_16x16x32_bf16 v[112:115], a[76:79], a[48:51], v[112:115]
buffer_load_dwordx4 v21, s[16:19], s52 offen sc1 lds
v_mfma_f32_16x16x32_bf16 v[116:119], a[76:79], a[52:55], v[116:119]
ds_read_b64_tr_b16 a[38:39], v25 offset:27392
v_mfma_f32_16x16x32_bf16 v[120:123], a[76:79], a[56:59], v[120:123]
ds_read_b128 a[8:11], v23 offset:20736
ds_read_b128 a[12:15], v23 offset:21760
v_mfma_f32_16x16x32_bf16 v[124:127], a[44:47], a[80:83], v[124:127]
ds_read_b64_tr_b16 a[40:41], v25 offset:26912
v_mfma_f32_16x16x32_bf16 v[128:131], a[48:51], a[80:83], v[128:131]
buffer_load_dwordx4 v21, s[16:19], s52 offen offset:1024 sc1 lds
v_mfma_f32_16x16x32_bf16 v[132:135], a[52:55], a[80:83], v[132:135]
ds_read_b64_tr_b16 a[42:43], v25 offset:27424
v_mfma_f32_16x16x32_bf16 v[136:139], a[56:59], a[80:83], v[136:139]
ds_read_b128 a[16:19], v24 offset:20480
v_mfma_f32_16x16x32_bf16 v[156:159], a[60:63], a[80:83], v[156:159]
v_mfma_f32_16x16x32_bf16 v[140:143], a[44:47], a[84:87], v[140:143]
buffer_load_dword v22, s[16:19], s52 offen offset:2048 sc1 lds
v_mfma_f32_16x16x32_bf16 v[144:147], a[48:51], a[84:87], v[144:147]
s_add_u32 s52, s52, 0x20000
v_mfma_f32_16x16x32_bf16 v[148:151], a[52:55], a[84:87], v[148:151]
v_mfma_f32_16x16x32_bf16 v[152:155], a[56:59], a[84:87], v[152:155]
v_mfma_f32_16x16x32_bf16 v[160:163], a[60:63], a[84:87], v[160:163]
s_waitcnt vmcnt(18) lgkmcnt(0)
s_barrier
v_mfma_f32_16x16x32_bf16 v[60:63], a[20:23], a[0:3], v[60:63]
ds_read_b64_tr_b16 a[64:65], v25 offset:37248
s_add_u32 m0, s56, 91392
v_mfma_f32_16x16x32_bf16 v[64:67], a[20:23], a[4:7], v[64:67]
buffer_load_dwordx4 v18, s[20:23], s54 offen lds
v_mfma_f32_16x16x32_bf16 v[68:71], a[20:23], a[8:11], v[68:71]
ds_read_b64_tr_b16 a[66:67], v25 offset:37760
v_mfma_f32_16x16x32_bf16 v[72:75], a[20:23], a[12:15], v[72:75]
ds_read_b64_tr_b16 a[68:69], v25 offset:37280
ds_read_b64_tr_b16 a[70:71], v25 offset:37792
v_mfma_f32_16x16x32_bf16 v[76:79], a[24:27], a[0:3], v[76:79]
ds_read_b64_tr_b16 a[72:73], v25 offset:38272
v_mfma_f32_16x16x32_bf16 v[80:83], a[24:27], a[4:7], v[80:83]
buffer_load_dwordx4 v19, s[20:23], s54 offen offset:1024 lds
v_mfma_f32_16x16x32_bf16 v[84:87], a[24:27], a[8:11], v[84:87]
ds_read_b64_tr_b16 a[74:75], v25 offset:38784
v_mfma_f32_16x16x32_bf16 v[88:91], a[24:27], a[12:15], v[88:91]
ds_read_b64_tr_b16 a[76:77], v25 offset:38304
v_mfma_f32_16x16x32_bf16 v[92:95], a[28:31], a[0:3], v[92:95]
ds_read_b64_tr_b16 a[78:79], v25 offset:38816
ds_read_b128 a[44:47], v23 offset:27648
v_mfma_f32_16x16x32_bf16 v[96:99], a[28:31], a[4:7], v[96:99]
buffer_load_dwordx4 v20, s[20:23], s54 offen offset:2048 lds
v_mfma_f32_16x16x32_bf16 v[100:103], a[28:31], a[8:11], v[100:103]
s_add_u32 s54, s54, 196608
v_mfma_f32_16x16x32_bf16 v[104:107], a[28:31], a[12:15], v[104:107]
ds_read_b128 a[48:51], v23 offset:28672
ds_read_b64_tr_b16 a[80:81], v25 offset:39296
v_mfma_f32_16x16x32_bf16 v[108:111], a[32:35], a[0:3], v[108:111]
s_add_u32 m0, s55, 18432
v_mfma_f32_16x16x32_bf16 v[112:115], a[32:35], a[4:7], v[112:115]
buffer_load_dwordx4 v21, s[16:19], s52 offen sc1 lds
v_mfma_f32_16x16x32_bf16 v[116:119], a[32:35], a[8:11], v[116:119]
ds_read_b64_tr_b16 a[82:83], v25 offset:39808
v_mfma_f32_16x16x32_bf16 v[120:123], a[32:35], a[12:15], v[120:123]
ds_read_b128 a[52:55], v23 offset:29952
ds_read_b128 a[56:59], v23 offset:30976
v_mfma_f32_16x16x32_bf16 v[124:127], a[0:3], a[36:39], v[124:127]
ds_read_b64_tr_b16 a[84:85], v25 offset:39328
v_mfma_f32_16x16x32_bf16 v[128:131], a[4:7], a[36:39], v[128:131]
buffer_load_dwordx4 v21, s[16:19], s52 offen offset:1024 sc1 lds
v_mfma_f32_16x16x32_bf16 v[132:135], a[8:11], a[36:39], v[132:135]
ds_read_b64_tr_b16 a[86:87], v25 offset:39840
v_mfma_f32_16x16x32_bf16 v[136:139], a[12:15], a[36:39], v[136:139]
ds_read_b128 a[60:63], v24 offset:29696
v_mfma_f32_16x16x32_bf16 v[156:159], a[16:19], a[36:39], v[156:159]
v_mfma_f32_16x16x32_bf16 v[140:143], a[0:3], a[40:43], v[140:143]
buffer_load_dword v22, s[16:19], s52 offen offset:2048 sc1 lds
v_mfma_f32_16x16x32_bf16 v[144:147], a[4:7], a[40:43], v[144:147]
s_add_u32 s52, s52, 0x20000
v_mfma_f32_16x16x32_bf16 v[148:151], a[8:11], a[40:43], v[148:151]
v_mfma_f32_16x16x32_bf16 v[152:155], a[12:15], a[40:43], v[152:155]
v_mfma_f32_16x16x32_bf16 v[160:163], a[16:19], a[40:43], v[160:163]
s_waitcnt vmcnt(21) lgkmcnt(0)
s_barrier
v_mfma_f32_16x16x32_bf16 v[60:63], a[64:67], a[44:47], v[60:63]
ds_read_b64_tr_b16 a[20:21], v25 offset:49664
s_add_u32 m0, s56, 103808
v_mfma_f32_16x16x32_bf16 v[64:67], a[64:67], a[48:51], v[64:67]
buffer_load_dwordx4 v18, s[20:23], s54 offen lds
v_mfma_f32_16x16x32_bf16 v[68:71], a[64:67], a[52:55], v[68:71]
ds_read_b64_tr_b16 a[22:23], v25 offset:50176
v_mfma_f32_16x16x32_bf16 v[72:75], a[64:67], a[56:59], v[72:75]
ds_read_b64_tr_b16 a[24:25], v25 offset:49696
ds_read_b64_tr_b16 a[26:27], v25 offset:50208
v_mfma_f32_16x16x32_bf16 v[76:79], a[68:71], a[44:47], v[76:79]
ds_read_b64_tr_b16 a[28:29], v25 offset:50688
v_mfma_f32_16x16x32_bf16 v[80:83], a[68:71], a[48:51], v[80:83]
buffer_load_dwordx4 v19, s[20:23], s54 offen offset:1024 lds
v_mfma_f32_16x16x32_bf16 v[84:87], a[68:71], a[52:55], v[84:87]
ds_read_b64_tr_b16 a[30:31], v25 offset:51200
v_mfma_f32_16x16x32_bf16 v[88:91], a[68:71], a[56:59], v[88:91]
ds_read_b64_tr_b16 a[32:33], v25 offset:50720
v_mfma_f32_16x16x32_bf16 v[92:95], a[72:75], a[44:47], v[92:95]
ds_read_b64_tr_b16 a[34:35], v25 offset:51232
ds_read_b128 a[0:3], v23 offset:36864
v_mfma_f32_16x16x32_bf16 v[96:99], a[72:75], a[48:51], v[96:99]
buffer_load_dwordx4 v20, s[20:23], s54 offen offset:2048 lds
v_mfma_f32_16x16x32_bf16 v[100:103], a[72:75], a[52:55], v[100:103]
s_add_u32 s54, s54, 196608
v_mfma_f32_16x16x32_bf16 v[104:107], a[72:75], a[56:59], v[104:107]
ds_read_b128 a[4:7], v23 offset:37888
ds_read_b64_tr_b16 a[36:37], v25 offset:51712
v_mfma_f32_16x16x32_bf16 v[108:111], a[76:79], a[44:47], v[108:111]
s_add_u32 m0, s55, 27648
v_mfma_f32_16x16x32_bf16 v[112:115], a[76:79], a[48:51], v[112:115]
buffer_load_dwordx4 v21, s[16:19], s52 offen sc1 lds
v_mfma_f32_16x16x32_bf16 v[116:119], a[76:79], a[52:55], v[116:119]
ds_read_b64_tr_b16 a[38:39], v25 offset:52224
v_mfma_f32_16x16x32_bf16 v[120:123], a[76:79], a[56:59], v[120:123]
ds_read_b128 a[8:11], v23 offset:39168
ds_read_b128 a[12:15], v23 offset:40192
v_mfma_f32_16x16x32_bf16 v[124:127], a[44:47], a[80:83], v[124:127]
ds_read_b64_tr_b16 a[40:41], v25 offset:51744
v_mfma_f32_16x16x32_bf16 v[128:131], a[48:51], a[80:83], v[128:131]
buffer_load_dwordx4 v21, s[16:19], s52 offen offset:1024 sc1 lds
v_mfma_f32_16x16x32_bf16 v[132:135], a[52:55], a[80:83], v[132:135]
ds_read_b64_tr_b16 a[42:43], v25 offset:52256
v_mfma_f32_16x16x32_bf16 v[136:139], a[56:59], a[80:83], v[136:139]
ds_read_b128 a[16:19], v24 offset:38912
v_mfma_f32_16x16x32_bf16 v[156:159], a[60:63], a[80:83], v[156:159]
v_mfma_f32_16x16x32_bf16 v[140:143], a[44:47], a[84:87], v[140:143]
buffer_load_dword v22, s[16:19], s52 offen offset:2048 sc1 lds
v_mfma_f32_16x16x32_bf16 v[144:147], a[48:51], a[84:87], v[144:147]
s_add_u32 s52, s52, 0x20000
v_mfma_f32_16x16x32_bf16 v[148:151], a[52:55], a[84:87], v[148:151]
v_mfma_f32_16x16x32_bf16 v[152:155], a[56:59], a[84:87], v[152:155]
v_mfma_f32_16x16x32_bf16 v[160:163], a[60:63], a[84:87], v[160:163]
s_waitcnt vmcnt(24) lgkmcnt(0)
s_barrier
v_mfma_f32_16x16x32_bf16 v[60:63], a[20:23], a[0:3], v[60:63]
ds_read_b64_tr_b16 a[64:65], v25 offset:62080
s_add_u32 m0, s56, 116224
v_mfma_f32_16x16x32_bf16 v[64:67], a[20:23], a[4:7], v[64:67]
buffer_load_dwordx4 v18, s[20:23], s54 offen lds
v_mfma_f32_16x16x32_bf16 v[68:71], a[20:23], a[8:11], v[68:71]
ds_read_b64_tr_b16 a[66:67], v25 offset:62592
v_mfma_f32_16x16x32_bf16 v[72:75], a[20:23], a[12:15], v[72:75]
ds_read_b64_tr_b16 a[68:69], v25 offset:62112
ds_read_b64_tr_b16 a[70:71], v25 offset:62624
v_mfma_f32_16x16x32_bf16 v[76:79], a[24:27], a[0:3], v[76:79]
ds_read_b64_tr_b16 a[72:73], v25 offset:63104
v_mfma_f32_16x16x32_bf16 v[80:83], a[24:27], a[4:7], v[80:83]
buffer_load_dwordx4 v19, s[20:23], s54 offen offset:1024 lds
v_mfma_f32_16x16x32_bf16 v[84:87], a[24:27], a[8:11], v[84:87]
ds_read_b64_tr_b16 a[74:75], v25 offset:63616
v_mfma_f32_16x16x32_bf16 v[88:91], a[24:27], a[12:15], v[88:91]
ds_read_b64_tr_b16 a[76:77], v25 offset:63136
v_mfma_f32_16x16x32_bf16 v[92:95], a[28:31], a[0:3], v[92:95]
ds_read_b64_tr_b16 a[78:79], v25 offset:63648
ds_read_b128 a[44:47], v23 offset:46080
v_mfma_f32_16x16x32_bf16 v[96:99], a[28:31], a[4:7], v[96:99]
buffer_load_dwordx4 v20, s[20:23], s54 offen offset:2048 lds
v_mfma_f32_16x16x32_bf16 v[100:103], a[28:31], a[8:11], v[100:103]
s_add_u32 s54, s54, 196608
v_mfma_f32_16x16x32_bf16 v[104:107], a[28:31], a[12:15], v[104:107]
ds_read_b128 a[48:51], v23 offset:47104
ds_read_b64_tr_b16 a[80:81], v25 offset:64128
v_mfma_f32_16x16x32_bf16 v[108:111], a[32:35], a[0:3], v[108:111]
s_add_u32 m0, s55, 36864
v_mfma_f32_16x16x32_bf16 v[112:115], a[32:35], a[4:7], v[112:115]
buffer_load_dwordx4 v21, s[16:19], s52 offen sc1 lds
v_mfma_f32_16x16x32_bf16 v[116:119], a[32:35], a[8:11], v[116:119]
ds_read_b64_tr_b16 a[82:83], v25 offset:64640
v_mfma_f32_16x16x32_bf16 v[120:123], a[32:35], a[12:15], v[120:123]
ds_read_b128 a[52:55], v23 offset:48384
ds_read_b128 a[56:59], v23 offset:49408
v_mfma_f32_16x16x32_bf16 v[124:127], a[0:3], a[36:39], v[124:127]
ds_read_b64_tr_b16 a[84:85], v25 offset:64160
v_mfma_f32_16x16x32_bf16 v[128:131], a[4:7], a[36:39], v[128:131]
buffer_load_dwordx4 v21, s[16:19], s52 offen offset:1024 sc1 lds
v_mfma_f32_16x16x32_bf16 v[132:135], a[8:11], a[36:39], v[132:135]
ds_read_b64_tr_b16 a[86:87], v25 offset:64672
v_mfma_f32_16x16x32_bf16 v[136:139], a[12:15], a[36:39], v[136:139]
ds_read_b128 a[60:63], v24 offset:48128
v_mfma_f32_16x16x32_bf16 v[156:159], a[16:19], a[36:39], v[156:159]
v_mfma_f32_16x16x32_bf16 v[140:143], a[0:3], a[40:43], v[140:143]
buffer_load_dword v22, s[16:19], s52 offen offset:2048 sc1 lds
v_mfma_f32_16x16x32_bf16 v[144:147], a[4:7], a[40:43], v[144:147]
s_add_u32 s52, s52, 0x20000
v_mfma_f32_16x16x32_bf16 v[148:151], a[8:11], a[40:43], v[148:151]
v_mfma_f32_16x16x32_bf16 v[152:155], a[12:15], a[40:43], v[152:155]
v_mfma_f32_16x16x32_bf16 v[160:163], a[16:19], a[40:43], v[160:163]
s_waitcnt vmcnt(24) lgkmcnt(0)
s_barrier
v_mfma_f32_16x16x32_bf16 v[60:63], a[64:67], a[44:47], v[60:63]
ds_read_b64_tr_b16 a[20:21], v25
s_add_u32 m0, s56, 128640
v_mfma_f32_16x16x32_bf16 v[64:67], a[64:67], a[48:51], v[64:67]
buffer_load_dwordx4 v18, s[20:23], s54 offen lds
v_mfma_f32_16x16x32_bf16 v[68:71], a[64:67], a[52:55], v[68:71]
ds_read_b64_tr_b16 a[22:23], v25 offset:512
v_mfma_f32_16x16x32_bf16 v[72:75], a[64:67], a[56:59], v[72:75]
ds_read_b64_tr_b16 a[24:25], v25 offset:32
ds_read_b64_tr_b16 a[26:27], v25 offset:544
v_mfma_f32_16x16x32_bf16 v[76:79], a[68:71], a[44:47], v[76:79]
ds_read_b64_tr_b16 a[28:29], v25 offset:1024
v_mfma_f32_16x16x32_bf16 v[80:83], a[68:71], a[48:51], v[80:83]
buffer_load_dwordx4 v19, s[20:23], s54 offen offset:1024 lds
v_mfma_f32_16x16x32_bf16 v[84:87], a[68:71], a[52:55], v[84:87]
ds_read_b64_tr_b16 a[30:31], v25 offset:1536
v_mfma_f32_16x16x32_bf16 v[88:91], a[68:71], a[56:59], v[88:91]
ds_read_b64_tr_b16 a[32:33], v25 offset:1056
v_mfma_f32_16x16x32_bf16 v[92:95], a[72:75], a[44:47], v[92:95]
ds_read_b64_tr_b16 a[34:35], v25 offset:1568
ds_read_b128 a[0:3], v23
v_mfma_f32_16x16x32_bf16 v[96:99], a[72:75], a[48:51], v[96:99]
buffer_load_dwordx4 v20, s[20:23], s54 offen offset:2048 lds
v_mfma_f32_16x16x32_bf16 v[100:103], a[72:75], a[52:55], v[100:103]
s_add_u32 s54, s54, 196608
v_mfma_f32_16x16x32_bf16 v[104:107], a[72:75], a[56:59], v[104:107]
ds_read_b128 a[4:7], v23 offset:1024
ds_read_b64_tr_b16 a[36:37], v25 offset:2048
v_mfma_f32_16x16x32_bf16 v[108:111], a[76:79], a[44:47], v[108:111]
s_add_u32 m0, s55, 46080
v_mfma_f32_16x16x32_bf16 v[112:115], a[76:79], a[48:51], v[112:115]
buffer_load_dwordx4 v21, s[16:19], s52 offen sc1 lds
v_mfma_f32_16x16x32_bf16 v[116:119], a[76:79], a[52:55], v[116:119]
ds_read_b64_tr_b16 a[38:39], v25 offset:2560
v_mfma_f32_16x16x32_bf16 v[120:123], a[76:79], a[56:59], v[120:123]
ds_read_b128 a[8:11], v23 offset:2304
ds_read_b128 a[12:15], v23 offset:3328
v_mfma_f32_16x16x32_bf16 v[124:127], a[44:47], a[80:83], v[124:127]
ds_read_b64_tr_b16 a[40:41], v25 offset:2080
v_mfma_f32_16x16x32_bf16 v[128:131], a[48:51], a[80:83], v[128:131]
buffer_load_dwordx4 v21, s[16:19], s52 offen offset:1024 sc1 lds
v_mfma_f32_16x16x32_bf16 v[132:135], a[52:55], a[80:83], v[132:135]
ds_read_b64_tr_b16 a[42:43], v25 offset:2592
v_mfma_f32_16x16x32_bf16 v[136:139], a[56:59], a[80:83], v[136:139]
ds_read_b128 a[16:19], v24 offset:2048
v_mfma_f32_16x16x32_bf16 v[156:159], a[60:63], a[80:83], v[156:159]
v_mfma_f32_16x16x32_bf16 v[140:143], a[44:47], a[84:87], v[140:143]
buffer_load_dword v22, s[16:19], s52 offen offset:2048 sc1 lds
v_mfma_f32_16x16x32_bf16 v[144:147], a[48:51], a[84:87], v[144:147]
s_add_u32 s52, s52, 0x20000
.Lpad20:
s_cbranch_execz .Lnopoll30r
v_mfma_f32_16x16x32_bf16 v[148:151], a[52:55], a[84:87], v[148:151]
v_mfma_f32_16x16x32_bf16 v[152:155], a[56:59], a[84:87], v[152:155]
v_mfma_f32_16x16x32_bf16 v[160:163], a[60:63], a[84:87], v[160:163]
s_sub_u32 s15, s15, 1
s_cmp_lg_u32 s15, 0
s_cbranch_scc1 .Lk34
s_waitcnt vmcnt(24) lgkmcnt(0)
s_barrier
v_mfma_f32_16x16x32_bf16 v[60:63], a[20:23], a[0:3], v[60:63]
ds_read_b64_tr_b16 a[64:65], v25 offset:12416
s_add_u32 m0, s56, 66560
v_mfma_f32_16x16x32_bf16 v[64:67], a[20:23], a[4:7], v[64:67]
buffer_load_dwordx4 v18, s[20:23], s54 offen lds
v_mfma_f32_16x16x32_bf16 v[68:71], a[20:23], a[8:11], v[68:71]
ds_read_b64_tr_b16 a[66:67], v25 offset:12928
ds_read_b64_tr_b16 a[68:69], v25 offset:12448
v_mfma_f32_16x16x32_bf16 v[72:75], a[20:23], a[12:15], v[72:75]
ds_read_b64_tr_b16 a[70:71], v25 offset:12960
v_mfma_f32_16x16x32_bf16 v[76:79], a[24:27], a[0:3], v[76:79]
buffer_load_dwordx4 v19, s[20:23], s54 offen offset:1024 lds
v_mfma_f32_16x16x32_bf16 v[80:83], a[24:27], a[4:7], v[80:83]
ds_read_b64_tr_b16 a[72:73], v25 offset:13440
v_mfma_f32_16x16x32_bf16 v[84:87], a[24:27], a[8:11], v[84:87]
ds_read_b64_tr_b16 a[74:75], v25 offset:13952
ds_read_b64_tr_b16 a[76:77], v25 offset:13472
v_mfma_f32_16x16x32_bf16 v[88:91], a[24:27], a[12:15], v[88:91]
buffer_load_dwordx4 v20, s[20:23], s54 offen offset:2048 lds
v_mfma_f32_16x16x32_bf16 v[92:95], a[28:31], a[0:3], v[92:95]
ds_read_b64_tr_b16 a[78:79], v25 offset:13984
s_add_u32 s54, s54, 196608
v_mfma_f32_16x16x32_bf16 v[96:99], a[28:31], a[4:7], v[96:99]
ds_read_b128 a[44:47], v23 offset:9216
v_mfma_f32_16x16x32_bf16 v[100:103], a[28:31], a[8:11], v[100:103]
ds_read_b128 a[48:51], v23 offset:10240
s_add_u32 m0, s55, 0
v_mfma_f32_16x16x32_bf16 v[104:107], a[28:31], a[12:15], v[104:107]
buffer_load_dwordx4 v21, s[16:19], s52 offen sc1 lds
v_mfma_f32_16x16x32_bf16 v[108:111], a[32:35], a[0:3], v[108:111]
ds_read_b64_tr_b16 a[80:81], v25 offset:14464
v_mfma_f32_16x16x32_bf16 v[112:115], a[32:35], a[4:7], v[112:115]
ds_read_b64_tr_b16 a[82:83], v25 offset:14976
ds_read_b128 a[52:55], v23 offset:11520
v_mfma_f32_16x16x32_bf16 v[116:119], a[32:35], a[8:11], v[116:119]
buffer_load_dwordx4 v21, s[16:19], s52 offen offset:1024 sc1 lds
v_mfma_f32_16x16x32_bf16 v[120:123], a[32:35], a[12:15], v[120:123]
ds_read_b128 a[56:59], v23 offset:12544
v_mfma_f32_16x16x32_bf16 v[124:127], a[0:3], a[36:39], v[124:127]
ds_read_b64_tr_b16 a[84:85], v25 offset:14496
v_mfma_f32_16x16x32_bf16 v[128:131], a[4:7], a[36:39], v[128:131]
ds_read_b64_tr_b16 a[86:87], v25 offset:15008
ds_read_b128 a[60:63], v24 offset:11264
v_mfma_f32_16x16x32_bf16 v[132:135], a[8:11], a[36:39], v[132:135]
buffer_load_dword v22, s[16:19], s52 offen offset:2048 sc1 lds
v_mfma_f32_16x16x32_bf16 v[136:139], a[12:15], a[36:39], v[136:139]
s_add_u32 s52, s52, 0x20000
v_mfma_f32_16x16x32_bf16 v[156:159], a[16:19], a[36:39], v[156:159]
s_mov_b32 s67, 62914560
v_mfma_f32_16x16x32_bf16 v[140:143], a[0:3], a[40:43], v[140:143]
buffer_load_dwordx4 v[164:167], v26, s[16:19], s67 offen sc1
v_mfma_f32_16x16x32_bf16 v[144:147], a[4:7], a[40:43], v[144:147]
v_mfma_f32_16x16x32_bf16 v[148:151], a[8:11], a[40:43], v[148:151]
v_mfma_f32_16x16x32_bf16 v[152:155], a[12:15], a[40:43], v[152:155]
v_mfma_f32_16x16x32_bf16 v[160:163], a[16:19], a[40:43], v[160:163]
s_waitcnt vmcnt(25) lgkmcnt(0)
s_barrier
v_mfma_f32_16x16x32_bf16 v[60:63], a[64:67], a[44:47], v[60:63]
ds_read_b64_tr_b16 a[20:21], v25 offset:24832
s_add_u32 m0, s56, 78976
v_mfma_f32_16x16x32_bf16 v[64:67], a[64:67], a[48:51], v[64:67]
buffer_load_dwordx4 v18, s[20:23], s54 offen lds
v_mfma_f32_16x16x32_bf16 v[68:71], a[64:67], a[52:55], v[68:71]
ds_read_b64_tr_b16 a[22:23], v25 offset:25344
ds_read_b64_tr_b16 a[24:25], v25 offset:24864
v_mfma_f32_16x16x32_bf16 v[72:75], a[64:67], a[56:59], v[72:75]
ds_read_b64_tr_b16 a[26:27], v25 offset:25376
v_mfma_f32_16x16x32_bf16 v[76:79], a[68:71], a[44:47], v[76:79]
buffer_load_dwordx4 v19, s[20:23], s54 offen offset:1024 lds
v_mfma_f32_16x16x32_bf16 v[80:83], a[68:71], a[48:51], v[80:83]
ds_read_b64_tr_b16 a[28:29], v25 offset:25856
v_mfma_f32_16x16x32_bf16 v[84:87], a[68:71], a[52:55], v[84:87]
ds_read_b64_tr_b16 a[30:31], v25 offset:26368
ds_read_b64_tr_b16 a[32:33], v25 offset:25888
v_mfma_f32_16x16x32_bf16 v[88:91], a[68:71], a[56:59], v[88:91]
buffer_load_dwordx4 v20, s[20:23], s54 offen offset:2048 lds
v_mfma_f32_16x16x32_bf16 v[92:95], a[72:75], a[44:47], v[92:95]
ds_read_b64_tr_b16 a[34:35], v25 offset:26400
s_add_u32 s54, s54, 196608
v_mfma_f32_16x16x32_bf16 v[96:99], a[72:75], a[48:51], v[96:99]
ds_read_b128 a[0:3], v23 offset:18432
v_mfma_f32_16x16x32_bf16 v[100:103], a[72:75], a[52:55], v[100:103]
ds_read_b128 a[4:7], v23 offset:19456
s_add_u32 m0, s55, 9216
v_mfma_f32_16x16x32_bf16 v[104:107], a[72:75], a[56:59], v[104:107]
buffer_load_dwordx4 v21, s[16:19], s52 offen sc1 lds
v_mfma_f32_16x16x32_bf16 v[108:111], a[76:79], a[44:47], v[108:111]
ds_read_b64_tr_b16 a[36:37], v25 offset:26880
v_mfma_f32_16x16x32_bf16 v[112:115], a[76:79], a[48:51], v[112:115]
ds_read_b64_tr_b16 a[38:39], v25 offset:27392
ds_read_b128 a[8:11], v23 offset:20736
v_mfma_f32_16x16x32_bf16 v[116:119], a[76:79], a[52:55], v[116:119]
buffer_load_dwordx4 v21, s[16:19], s52 offen offset:1024 sc1 lds
v_mfma_f32_16x16x32_bf16 v[120:123], a[76:79], a[56:59], v[120:123]
ds_read_b128 a[12:15], v23 offset:21760
v_mfma_f32_16x16x32_bf16 v[124:127], a[44:47], a[80:83], v[124:127]
ds_read_b64_tr_b16 a[40:41], v25 offset:26912
v_mfma_f32_16x16x32_bf16 v[128:131], a[48:51], a[80:83], v[128:131]
ds_read_b64_tr_b16 a[42:43], v25 offset:27424
ds_read_b128 a[16:19], v24 offset:20480
v_mfma_f32_16x16x32_bf16 v[132:135], a[52:55], a[80:83], v[132:135]
buffer_load_dword v22, s[16:19], s52 offen offset:2048 sc1 lds
v_mfma_f32_16x16x32_bf16 v[136:139], a[56:59], a[80:83], v[136:139]
s_add_u32 s52, s52, 0x20000
v_mfma_f32_16x16x32_bf16 v[156:159], a[60:63], a[80:83], v[156:159]
v_mfma_f32_16x16x32_bf16 v[140:143], a[44:47], a[84:87], v[140:143]
buffer_load_dwordx4 v[168:171], v26, s[16:19], s67 offen offset:1024 sc1
v_mfma_f32_16x16x32_bf16 v[144:147], a[48:51], a[84:87], v[144:147]
v_mfma_f32_16x16x32_bf16 v[148:151], a[52:55], a[84:87], v[148:151]
v_mfma_f32_16x16x32_bf16 v[152:155], a[56:59], a[84:87], v[152:155]
v_mfma_f32_16x16x32_bf16 v[160:163], a[60:63], a[84:87], v[160:163]
s_waitcnt vmcnt(26) lgkmcnt(0)
s_barrier
v_mfma_f32_16x16x32_bf16 v[60:63], a[20:23], a[0:3], v[60:63]
ds_read_b64_tr_b16 a[64:65], v25 offset:37248
ds_read_b64_tr_b16 a[66:67], v25 offset:37760
v_mfma_f32_16x16x32_bf16 v[64:67], a[20:23], a[4:7], v[64:67]
buffer_load_dwordx4 v[172:175], v26, s[16:19], s67 offen offset:2048 sc1
v_mfma_f32_16x16x32_bf16 v[68:71], a[20:23], a[8:11], v[68:71]
ds_read_b64_tr_b16 a[68:69], v25 offset:37280
v_mfma_f32_16x16x32_bf16 v[72:75], a[20:23], a[12:15], v[72:75]
ds_read_b64_tr_b16 a[70:71], v25 offset:37792
v_mfma_f32_16x16x32_bf16 v[76:79], a[24:27], a[0:3], v[76:79]
ds_read_b64_tr_b16 a[72:73], v25 offset:38272
v_mfma_f32_16x16x32_bf16 v[80:83], a[24:27], a[4:7], v[80:83]
buffer_load_dwordx4 v[176:179], v26, s[16:19], s67 offen offset:3072 sc1
v_mfma_f32_16x16x32_bf16 v[84:87], a[24:27], a[8:11], v[84:87]
ds_read_b64_tr_b16 a[74:75], v25 offset:38784
v_mfma_f32_16x16x32_bf16 v[88:91], a[24:27], a[12:15], v[88:91]
ds_read_b64_tr_b16 a[76:77], v25 offset:38304
ds_read_b64_tr_b16 a[78:79], v25 offset:38816
v_mfma_f32_16x16x32_bf16 v[92:95], a[28:31], a[0:3], v[92:95]
s_mov_b32 s67, 62918656
v_mfma_f32_16x16x32_bf16 v[96:99], a[28:31], a[4:7], v[96:99]
buffer_load_dwordx4 v[180:183], v26, s[16:19], s67 offen sc1
v_mfma_f32_16x16x32_bf16 v[100:103], a[28:31], a[8:11], v[100:103]
ds_read_b128 a[44:47], v23 offset:27648
v_mfma_f32_16x16x32_bf16 v[104:107], a[28:31], a[12:15], v[104:107]
ds_read_b128 a[48:51], v23 offset:28672
v_mfma_f32_16x16x32_bf16 v[108:111], a[32:35], a[0:3], v[108:111]
ds_read_b64_tr_b16 a[80:81], v25 offset:39296
ds_read_b64_tr_b16 a[82:83], v25 offset:39808
v_mfma_f32_16x16x32_bf16 v[112:115], a[32:35], a[4:7], v[112:115]
buffer_load_dwordx4 v[184:187], v26, s[16:19], s67 offen offset:1024 sc1
v_mfma_f32_16x16x32_bf16 v[116:119], a[32:35], a[8:11], v[116:119]
ds_read_b128 a[52:55], v23 offset:29952
v_mfma_f32_16x16x32_bf16 v[120:123], a[32:35], a[12:15], v[120:123]
ds_read_b128 a[56:59], v23 offset:30976
v_mfma_f32_16x16x32_bf16 v[124:127], a[0:3], a[36:39], v[124:127]
ds_read_b64_tr_b16 a[84:85], v25 offset:39328
v_mfma_f32_16x16x32_bf16 v[128:131], a[4:7], a[36:39], v[128:131]
buffer_load_dwordx4 v[188:191], v26, s[16:19], s67 offen offset:2048 sc1
v_mfma_f32_16x16x32_bf16 v[132:135], a[8:11], a[36:39], v[132:135]
ds_read_b64_tr_b16 a[86:87], v25 offset:39840
v_mfma_f32_16x16x32_bf16 v[136:139], a[12:15], a[36:39], v[136:139]
ds_read_b128 a[60:63], v24 offset:29696
v_mfma_f32_16x16x32_bf16 v[156:159], a[16:19], a[36:39], v[156:159]
v_mfma_f32_16x16x32_bf16 v[140:143], a[0:3], a[40:43], v[140:143]
buffer_load_dwordx4 v[192:195], v26, s[16:19], s67 offen offset:3072 sc1
v_mfma_f32_16x16x32_bf16 v[144:147], a[4:7], a[40:43], v[144:147]
v_mfma_f32_16x16x32_bf16 v[148:151], a[8:11], a[40:43], v[148:151]
v_mfma_f32_16x16x32_bf16 v[152:155], a[12:15], a[40:43], v[152:155]
v_mfma_f32_16x16x32_bf16 v[160:163], a[16:19], a[40:43], v[160:163]
s_waitcnt vmcnt(26) lgkmcnt(0)
s_barrier
v_mfma_f32_16x16x32_bf16 v[60:63], a[64:67], a[44:47], v[60:63]
ds_read_b64_tr_b16 a[20:21], v25 offset:49664
s_add_u32 m0, s59, 58240
s_mov_b32 s58, 1966080
v_mfma_f32_16x16x32_bf16 v[64:67], a[64:67], a[48:51], v[64:67]
buffer_load_dwordx4 v5, s[24:27], s58 offen lds
v_mfma_f32_16x16x32_bf16 v[68:71], a[64:67], a[52:55], v[68:71]
ds_read_b64_tr_b16 a[22:23], v25 offset:50176
v_mfma_f32_16x16x32_bf16 v[72:75], a[64:67], a[56:59], v[72:75]
ds_read_b64_tr_b16 a[24:25], v25 offset:49696
ds_read_b64_tr_b16 a[26:27], v25 offset:50208
v_mfma_f32_16x16x32_bf16 v[76:79], a[68:71], a[44:47], v[76:79]
ds_read_b64_tr_b16 a[28:29], v25 offset:50688
v_mfma_f32_16x16x32_bf16 v[80:83], a[68:71], a[48:51], v[80:83]
buffer_load_dwordx4 v6, s[24:27], s58 offen offset:1024 lds
v_mfma_f32_16x16x32_bf16 v[84:87], a[68:71], a[52:55], v[84:87]
ds_read_b64_tr_b16 a[30:31], v25 offset:51200
v_mfma_f32_16x16x32_bf16 v[88:91], a[68:71], a[56:59], v[88:91]
ds_read_b64_tr_b16 a[32:33], v25 offset:50720
v_mfma_f32_16x16x32_bf16 v[92:95], a[72:75], a[44:47], v[92:95]
ds_read_b64_tr_b16 a[34:35], v25 offset:51232
s_add_u32 m0, s59, 91520
s_mov_b32 s58, 393216
v_mfma_f32_16x16x32_bf16 v[96:99], a[72:75], a[48:51], v[96:99]
buffer_load_dwordx4 v5, s[24:27], s58 offen lds
v_mfma_f32_16x16x32_bf16 v[100:103], a[72:75], a[52:55], v[100:103]
ds_read_b128 a[0:3], v23 offset:36864
v_mfma_f32_16x16x32_bf16 v[104:107], a[72:75], a[56:59], v[104:107]
ds_read_b128 a[4:7], v23 offset:37888
ds_read_b64_tr_b16 a[36:37], v25 offset:51712
v_mfma_f32_16x16x32_bf16 v[108:111], a[76:79], a[44:47], v[108:111]
ds_read_b64_tr_b16 a[38:39], v25 offset:52224
v_mfma_f32_16x16x32_bf16 v[112:115], a[76:79], a[48:51], v[112:115]
buffer_load_dwordx4 v6, s[24:27], s58 offen offset:1024 lds
v_mfma_f32_16x16x32_bf16 v[116:119], a[76:79], a[52:55], v[116:119]
ds_read_b128 a[8:11], v23 offset:39168
v_mfma_f32_16x16x32_bf16 v[120:123], a[76:79], a[56:59], v[120:123]
ds_read_b128 a[12:15], v23 offset:40192
v_mfma_f32_16x16x32_bf16 v[124:127], a[44:47], a[80:83], v[124:127]
ds_read_b64_tr_b16 a[40:41], v25 offset:51744
s_add_u32 m0, s59, 24960
s_mov_b32 s58, 1441792
v_mfma_f32_16x16x32_bf16 v[128:131], a[48:51], a[80:83], v[128:131]
buffer_load_dwordx4 v5, s[24:27], s58 offen lds
v_mfma_f32_16x16x32_bf16 v[132:135], a[52:55], a[80:83], v[132:135]
ds_read_b64_tr_b16 a[42:43], v25 offset:52256
v_mfma_f32_16x16x32_bf16 v[136:139], a[56:59], a[80:83], v[136:139]
ds_read_b128 a[16:19], v24 offset:38912
v_mfma_f32_16x16x32_bf16 v[156:159], a[60:63], a[80:83], v[156:159]
v_mfma_f32_16x16x32_bf16 v[140:143], a[44:47], a[84:87], v[140:143]
buffer_load_dwordx4 v6, s[24:27], s58 offen offset:1024 lds
v_mfma_f32_16x16x32_bf16 v[144:147], a[48:51], a[84:87], v[144:147]
v_mfma_f32_16x16x32_bf16 v[148:151], a[52:55], a[84:87], v[148:151]
v_mfma_f32_16x16x32_bf16 v[152:155], a[56:59], a[84:87], v[152:155]
v_mfma_f32_16x16x32_bf16 v[160:163], a[60:63], a[84:87], v[160:163]
s_waitcnt vmcnt(26) lgkmcnt(0)
s_barrier
v_mfma_f32_16x16x32_bf16 v[60:63], a[20:23], a[0:3], v[60:63]
ds_read_b64_tr_b16 a[64:65], v25 offset:62080
s_add_u32 m0, s59, 99840
s_mov_b32 s58, 524288
v_mfma_f32_16x16x32_bf16 v[64:67], a[20:23], a[4:7], v[64:67]
buffer_load_dwordx4 v5, s[24:27], s58 offen lds
v_mfma_f32_16x16x32_bf16 v[68:71], a[20:23], a[8:11], v[68:71]
ds_read_b64_tr_b16 a[66:67], v25 offset:62592
s_waitcnt vmcnt(10)
v_add_f32 v164, v164, v180
v_mfma_f32_16x16x32_bf16 v[72:75], a[20:23], a[12:15], v[72:75]
ds_read_b64_tr_b16 a[68:69], v25 offset:62112
ds_read_b64_tr_b16 a[70:71], v25 offset:62624
v_mfma_f32_16x16x32_bf16 v[76:79], a[24:27], a[0:3], v[76:79]
ds_read_b64_tr_b16 a[72:73], v25 offset:63104
v_add_f32 v165, v165, v181
v_mfma_f32_16x16x32_bf16 v[80:83], a[24:27], a[4:7], v[80:83]
buffer_load_dwordx4 v6, s[24:27], s58 offen offset:1024 lds
v_mfma_f32_16x16x32_bf16 v[84:87], a[24:27], a[8:11], v[84:87]
ds_read_b64_tr_b16 a[74:75], v25 offset:63616
v_add_f32 v166, v166, v182
v_mfma_f32_16x16x32_bf16 v[88:91], a[24:27], a[12:15], v[88:91]
ds_read_b64_tr_b16 a[76:77], v25 offset:63136
v_add_f32 v167, v167, v183
v_mfma_f32_16x16x32_bf16 v[92:95], a[28:31], a[0:3], v[92:95]
ds_read_b64_tr_b16 a[78:79], v25 offset:63648
s_add_u32 m0, s59, 33280
s_mov_b32 s58, 1572864
v_mfma_f32_16x16x32_bf16 v[96:99], a[28:31], a[4:7], v[96:99]
buffer_load_dwordx4 v5, s[24:27], s58 offen lds
v_mfma_f32_16x16x32_bf16 v[100:103], a[28:31], a[8:11], v[100:103]
ds_read_b128 a[44:47], v23 offset:46080
v_mfma_f32_16x16x32_bf16 v[104:107], a[28:31], a[12:15], v[104:107]
ds_read_b128 a[48:51], v23 offset:47104
ds_read_b64_tr_b16 a[80:81], v25 offset:64128
v_mfma_f32_16x16x32_bf16 v[108:111], a[32:35], a[0:3], v[108:111]
ds_read_b64_tr_b16 a[82:83], v25 offset:64640
s_waitcnt vmcnt(11)
v_add_f32 v168, v168, v184
v_mfma_f32_16x16x32_bf16 v[112:115], a[32:35], a[4:7], v[112:115]
buffer_load_dwordx4 v6, s[24:27], s58 offen offset:1024 lds
v_mfma_f32_16x16x32_bf16 v[116:119], a[32:35], a[8:11], v[116:119]
ds_read_b128 a[52:55], v23 offset:48384
v_add_f32 v169, v169, v185
v_mfma_f32_16x16x32_bf16 v[120:123], a[32:35], a[12:15], v[120:123]
ds_read_b128 a[56:59], v23 offset:49408
v_add_f32 v170, v170, v186
v_mfma_f32_16x16x32_bf16 v[124:127], a[0:3], a[36:39], v[124:127]
ds_read_b64_tr_b16 a[84:85], v25 offset:64160
s_add_u32 m0, s59, 108160
s_mov_b32 s58, 655360
v_mfma_f32_16x16x32_bf16 v[128:131], a[4:7], a[36:39], v[128:131]
buffer_load_dwordx4 v5, s[24:27], s58 offen lds
v_mfma_f32_16x16x32_bf16 v[132:135], a[8:11], a[36:39], v[132:135]
ds_read_b64_tr_b16 a[86:87], v25 offset:64672
v_mfma_f32_16x16x32_bf16 v[136:139], a[12:15], a[36:39], v[136:139]
ds_read_b128 a[60:63], v24 offset:48128
v_add_f32 v171, v171, v187
v_mfma_f32_16x16x32_bf16 v[156:159], a[16:19], a[36:39], v[156:159]
s_waitcnt vmcnt(12)
v_add_f32 v172, v172, v188
v_add_f32 v173, v173, v189
v_mfma_f32_16x16x32_bf16 v[140:143], a[0:3], a[40:43], v[140:143]
buffer_load_dwordx4 v6, s[24:27], s58 offen offset:1024 lds
v_mfma_f32_16x16x32_bf16 v[144:147], a[4:7], a[40:43], v[144:147]
v_add_f32 v174, v174, v190
v_mfma_f32_16x16x32_bf16 v[148:151], a[8:11], a[40:43], v[148:151]
v_add_f32 v175, v175, v191
s_waitcnt vmcnt(12)
v_add_f32 v176, v176, v192
v_mfma_f32_16x16x32_bf16 v[152:155], a[12:15], a[40:43], v[152:155]
v_add_f32 v177, v177, v193
v_mfma_f32_16x16x32_bf16 v[160:163], a[16:19], a[40:43], v[160:163]
s_waitcnt lgkmcnt(0)
s_barrier
v_mfma_f32_16x16x32_bf16 v[60:63], a[64:67], a[44:47], v[60:63]
ds_read_b64_tr_b16 a[20:21], v25
s_add_u32 m0, s59, 116480
s_mov_b32 s58, 786432
v_mfma_f32_16x16x32_bf16 v[64:67], a[64:67], a[48:51], v[64:67]
buffer_load_dwordx4 v5, s[24:27], s58 offen lds
v_mfma_f32_16x16x32_bf16 v[68:71], a[64:67], a[52:55], v[68:71]
ds_read_b64_tr_b16 a[22:23], v25 offset:512
v_add_f32 v178, v178, v194
v_mfma_f32_16x16x32_bf16 v[72:75], a[64:67], a[56:59], v[72:75]
ds_read_b64_tr_b16 a[24:25], v25 offset:32
ds_read_b64_tr_b16 a[26:27], v25 offset:544
v_mfma_f32_16x16x32_bf16 v[76:79], a[68:71], a[44:47], v[76:79]
ds_read_b64_tr_b16 a[28:29], v25 offset:1024
v_add_f32 v179, v179, v195
v_mfma_f32_16x16x32_bf16 v[80:83], a[68:71], a[48:51], v[80:83]
buffer_load_dwordx4 v6, s[24:27], s58 offen offset:1024 lds
v_mfma_f32_16x16x32_bf16 v[84:87], a[68:71], a[52:55], v[84:87]
ds_read_b64_tr_b16 a[30:31], v25 offset:1536
v_add_f32 v164, v164, v172
v_mfma_f32_16x16x32_bf16 v[88:91], a[68:71], a[56:59], v[88:91]
ds_read_b64_tr_b16 a[32:33], v25 offset:1056
v_add_f32 v165, v165, v173
v_mfma_f32_16x16x32_bf16 v[92:95], a[72:75], a[44:47], v[92:95]
ds_read_b64_tr_b16 a[34:35], v25 offset:1568
s_add_u32 m0, s59, 41600
s_mov_b32 s58, 1703936
v_mfma_f32_16x16x32_bf16 v[96:99], a[72:75], a[48:51], v[96:99]
buffer_load_dwordx4 v5, s[24:27], s58 offen lds
v_mfma_f32_16x16x32_bf16 v[100:103], a[72:75], a[52:55], v[100:103]
ds_read_b128 a[0:3], v23
v_mfma_f32_16x16x32_bf16 v[104:107], a[72:75], a[56:59], v[104:107]
ds_read_b128 a[4:7], v23 offset:1024
ds_read_b64_tr_b16 a[36:37], v25 offset:2048
v_mfma_f32_16x16x32_bf16 v[108:111], a[76:79], a[44:47], v[108:111]
ds_read_b64_tr_b16 a[38:39], v25 offset:2560
v_add_f32 v166, v166, v174
v_mfma_f32_16x16x32_bf16 v[112:115], a[76:79], a[48:51], v[112:115]
buffer_load_dwordx4 v6, s[24:27], s58 offen offset:1024 lds
v_mfma_f32_16x16x32_bf16 v[116:119], a[76:79], a[52:55], v[116:119]
ds_read_b128 a[8:11], v23 offset:2304
v_add_f32 v167, v167, v175
v_mfma_f32_16x16x32_bf16 v[120:123], a[76:79], a[56:59], v[120:123]
ds_read_b128 a[12:15], v23 offset:3328
v_add_f32 v168, v168, v176
v_mfma_f32_16x16x32_bf16 v[124:127], a[44:47], a[80:83], v[124:127]
ds_read_b64_tr_b16 a[40:41], v25 offset:2080
s_add_u32 m0, s59, 49920
s_mov_b32 s58, 1835008
v_mfma_f32_16x16x32_bf16 v[128:131], a[48:51], a[80:83], v[128:131]
buffer_load_dwordx4 v5, s[24:27], s58 offen lds
v_mfma_f32_16x16x32_bf16 v[132:135], a[52:55], a[80:83], v[132:135]
ds_read_b64_tr_b16 a[42:43], v25 offset:2592
v_mfma_f32_16x16x32_bf16 v[136:139], a[56:59], a[80:83], v[136:139]
ds_read_b128 a[16:19], v24 offset:2048
v_add_f32 v169, v169, v177
v_mfma_f32_16x16x32_bf16 v[156:159], a[60:63], a[80:83], v[156:159]
v_add_f32 v170, v170, v178
v_add_f32 v171, v171, v179
v_mfma_f32_16x16x32_bf16 v[140:143], a[44:47], a[84:87], v[140:143]
buffer_load_dwordx4 v6, s[24:27], s58 offen offset:1024 lds
v_mfma_f32_16x16x32_bf16 v[144:147], a[48:51], a[84:87], v[144:147]
v_add_f32 v164, v164, v168
v_mfma_f32_16x16x32_bf16 v[148:151], a[52:55], a[84:87], v[148:151]
v_add_f32 v165, v165, v169
v_add_f32 v166, v166, v170
v_mfma_f32_16x16x32_bf16 v[152:155], a[56:59], a[84:87], v[152:155]
v_add_f32 v167, v167, v171
v_mfma_f32_16x16x32_bf16 v[160:163], a[60:63], a[84:87], v[160:163]
s_waitcnt lgkmcnt(0)
s_barrier
v_mfma_f32_16x16x32_bf16 v[60:63], a[20:23], a[0:3], v[60:63]
ds_read_b64_tr_b16 a[64:65], v25 offset:12416
s_add_u32 m0, s59, 124800
s_mov_b32 s58, 917504
v_mfma_f32_16x16x32_bf16 v[64:67], a[20:23], a[4:7], v[64:67]
buffer_load_dwordx4 v5, s[24:27], s58 offen lds
v_mfma_f32_16x16x32_bf16 v[68:71], a[20:23], a[8:11], v[68:71]
ds_read_b64_tr_b16 a[66:67], v25 offset:12928
v_permlane32_swap_b32 v164, v166
v_mfma_f32_16x16x32_bf16 v[72:75], a[20:23], a[12:15], v[72:75]
ds_read_b64_tr_b16 a[68:69], v25 offset:12448
v_permlane32_swap_b32 v165, v167
v_mfma_f32_16x16x32_bf16 v[76:79], a[24:27], a[0:3], v[76:79]
ds_read_b64_tr_b16 a[70:71], v25 offset:12960
v_mfma_f32_16x16x32_bf16 v[80:83], a[24:27], a[4:7], v[80:83]
ds_read_b64_tr_b16 a[72:73], v25 offset:13440
ds_read_b64_tr_b16 a[74:75], v25 offset:13952
v_mfma_f32_16x16x32_bf16 v[84:87], a[24:27], a[8:11], v[84:87]
ds_read_b64_tr_b16 a[76:77], v25 offset:13472
v_add_f32 v164, v164, v166
v_mfma_f32_16x16x32_bf16 v[88:91], a[24:27], a[12:15], v[88:91]
buffer_load_dwordx4 v6, s[24:27], s58 offen offset:1024 lds
v_mfma_f32_16x16x32_bf16 v[92:95], a[28:31], a[0:3], v[92:95]
ds_read_b64_tr_b16 a[78:79], v25 offset:13984
v_add_f32 v165, v165, v167
v_mfma_f32_16x16x32_bf16 v[96:99], a[28:31], a[4:7], v[96:99]
ds_read_b128 a[44:47], v23 offset:9216
v_mfma_f32_16x16x32_bf16 v[100:103], a[28:31], a[8:11], v[100:103]
ds_read_b128 a[48:51], v23 offset:10240
v_mul_f32 v164, 0xba800000, v164
v_mfma_f32_16x16x32_bf16 v[104:107], a[28:31], a[12:15], v[104:107]
ds_read_b64_tr_b16 a[80:81], v25 offset:14464
v_mul_f32 v165, 0x3a800000, v165
v_mfma_f32_16x16x32_bf16 v[108:111], a[32:35], a[0:3], v[108:111]
ds_read_b64_tr_b16 a[82:83], v25 offset:14976
s_add_u32 m0, s59, 0
s_mov_b32 s58, 1048576
v_mfma_f32_16x16x32_bf16 v[112:115], a[32:35], a[4:7], v[112:115]
buffer_load_dwordx4 v5, s[24:27], s58 offen lds
v_mfma_f32_16x16x32_bf16 v[116:119], a[32:35], a[8:11], v[116:119]
ds_read_b128 a[52:55], v23 offset:11520
v_mfma_f32_16x16x32_bf16 v[120:123], a[32:35], a[12:15], v[120:123]
ds_read_b128 a[56:59], v23 offset:12544
v_fma_f32 v165, -v164, v164, v165
v_mfma_f32_16x16x32_bf16 v[124:127], a[0:3], a[36:39], v[124:127]
ds_read_b64_tr_b16 a[84:85], v25 offset:14496
v_max_f32 v165, 0, v165
v_mfma_f32_16x16x32_bf16 v[128:131], a[4:7], a[36:39], v[128:131]
ds_read_b64_tr_b16 a[86:87], v25 offset:15008
v_mfma_f32_16x16x32_bf16 v[132:135], a[8:11], a[36:39], v[132:135]
ds_read_b128 a[60:63], v24 offset:11264
v_add_f32 v165, 0x3727c5ac, v165
v_mfma_f32_16x16x32_bf16 v[136:139], a[12:15], a[36:39], v[136:139]
buffer_load_dwordx4 v6, s[24:27], s58 offen offset:1024 lds
v_mfma_f32_16x16x32_bf16 v[156:159], a[16:19], a[36:39], v[156:159]
v_rsq_f32 v166, v165
v_mfma_f32_16x16x32_bf16 v[140:143], a[0:3], a[40:43], v[140:143]
v_mov_b32 v165, v166
v_mul_f32 v166, 0x3e8293ee, v166
v_mfma_f32_16x16x32_bf16 v[144:147], a[4:7], a[40:43], v[144:147]
ds_write_b128 v7, v[164:167]
v_mfma_f32_16x16x32_bf16 v[148:151], a[8:11], a[40:43], v[148:151]
ds_write_b32 v17, v164
v_mfma_f32_16x16x32_bf16 v[152:155], a[12:15], a[40:43], v[152:155]
ds_write_b32 v17, v165 offset:1024
v_mfma_f32_16x16x32_bf16 v[160:163], a[16:19], a[40:43], v[160:163]
s_waitcnt lgkmcnt(0)
s_barrier
v_mfma_f32_16x16x32_bf16 v[156:159], a[60:63], a[80:83], v[156:159]
ds_read_b128 v[232:235], v10 offset:1792
s_add_u32 m0, s59, 66560
v_mfma_f32_16x16x32_bf16 v[160:163], a[60:63], a[84:87], v[160:163]
ds_read_b128 v[228:231], v10 offset:1536
s_mov_b32 s58, 0
v_mfma_f32_16x16x32_bf16 v[104:107], a[72:75], a[56:59], v[104:107]
ds_read_b128 v[224:227], v10 offset:1280
v_mfma_f32_16x16x32_bf16 v[120:123], a[76:79], a[56:59], v[120:123]
ds_read_b128 v[220:223], v10 offset:1024
v_mfma_f32_16x16x32_bf16 v[136:139], a[56:59], a[80:83], v[136:139]
ds_read_b128 v[240:243], v11 offset:704
v_mfma_f32_16x16x32_bf16 v[152:155], a[56:59], a[84:87], v[152:155]
ds_read_b128 v[244:247], v11 offset:1728
v_mfma_f32_16x16x32_bf16 v[100:103], a[72:75], a[52:55], v[100:103]
buffer_load_dwordx4 v5, s[24:27], s58 offen lds
v_mfma_f32_16x16x32_bf16 v[116:119], a[76:79], a[52:55], v[116:119]
ds_read_b128 v[18:21], v11 offset:448
ds_read_b128 v[22:25], v11 offset:1472
s_waitcnt lgkmcnt(7)
v_pk_fma_f32 v[104:105], v[36:37], v[232:233], v[104:105] op_sel_hi:[1,0,1]
v_pk_mul_f32 v[104:105], v[104:105], v[232:233] op_sel:[0,1] op_sel_hi:[1,1]
v_cvt_pk_bf16_f32 v196, v104, v105
v_pk_fma_f32 v[106:107], v[38:39], v[232:233], v[106:107] op_sel_hi:[1,0,1]
v_pk_mul_f32 v[106:107], v[106:107], v[232:233] op_sel:[0,1] op_sel_hi:[1,1]
v_cvt_pk_bf16_f32 v197, v106, v107
buffer_load_dwordx4 v6, s[24:27], s58 offen offset:1024 lds
s_add_u32 m0, s59, 8320
s_mov_b32 s58, 1179648
v_pk_fma_f32 v[120:121], v[40:41], v[232:233], v[120:121] op_sel_hi:[1,0,1]
v_pk_mul_f32 v[120:121], v[120:121], v[232:233] op_sel:[0,1] op_sel_hi:[1,1]
v_cvt_pk_bf16_f32 v198, v120, v121
s_waitcnt lgkmcnt(3)
v_pk_fma_f32 v[156:157], v[240:241], v[44:45], v[156:157] op_sel_hi:[1,0,1]
v_pk_fma_f32 v[158:159], v[242:243], v[44:45], v[158:159] op_sel_hi:[1,0,1]
v_pk_fma_f32 v[160:161], v[240:241], v[44:45], v[160:161] op_sel:[0,1,0] op_sel_hi:[1,1,1]
v_pk_fma_f32 v[162:163], v[242:243], v[44:45], v[162:163] op_sel:[0,1,0] op_sel_hi:[1,1,1]
s_waitcnt lgkmcnt(2)
v_pk_mul_f32 v[156:157], v[156:157], v[244:245]
v_cvt_pk_bf16_f32 v236, v156, v157
v_pk_mul_f32 v[158:159], v[158:159], v[246:247]
v_cvt_pk_bf16_f32 v237, v158, v159
v_pk_mul_f32 v[160:161], v[160:161], v[244:245]
v_cvt_pk_bf16_f32 v238, v160, v161
v_pk_mul_f32 v[162:163], v[162:163], v[246:247]
v_cvt_pk_bf16_f32 v239, v162, v163
ds_write_b128 v8, v[236:239] offset:1024
buffer_load_dwordx4 v5, s[24:27], s58 offen lds
v_pk_fma_f32 v[122:123], v[42:43], v[232:233], v[122:123] op_sel_hi:[1,0,1]
v_pk_mul_f32 v[122:123], v[122:123], v[232:233] op_sel:[0,1] op_sel_hi:[1,1]
v_cvt_pk_bf16_f32 v199, v122, v123
s_waitcnt lgkmcnt(2)
v_pk_fma_f32 v[136:137], v[18:19], v[44:45], v[136:137] op_sel_hi:[1,0,1]
s_waitcnt lgkmcnt(1)
v_pk_mul_f32 v[136:137], v[136:137], v[22:23]
v_cvt_pk_bf16_f32 v208, v136, v137
v_pk_fma_f32 v[138:139], v[20:21], v[44:45], v[138:139] op_sel_hi:[1,0,1]
v_pk_mul_f32 v[138:139], v[138:139], v[24:25]
v_cvt_pk_bf16_f32 v209, v138, v139
v_pk_fma_f32 v[152:153], v[18:19], v[44:45], v[152:153] op_sel:[0,1,0] op_sel_hi:[1,1,1]
v_pk_mul_f32 v[152:153], v[152:153], v[22:23]
v_cvt_pk_bf16_f32 v218, v152, v153
v_pk_fma_f32 v[154:155], v[20:21], v[44:45], v[154:155] op_sel:[0,1,0] op_sel_hi:[1,1,1]
buffer_load_dwordx4 v6, s[24:27], s58 offen offset:1024 lds
s_add_u32 m0, s59, 16640
s_mov_b32 s58, 1310720
v_pk_mul_f32 v[154:155], v[154:155], v[24:25]
v_cvt_pk_bf16_f32 v219, v154, v155
v_pk_fma_f32 v[100:101], v[36:37], v[228:229], v[100:101] op_sel_hi:[1,0,1]
v_pk_mul_f32 v[100:101], v[100:101], v[228:229] op_sel:[0,1] op_sel_hi:[1,1]
v_cvt_pk_bf16_f32 v192, v100, v101
v_pk_fma_f32 v[102:103], v[38:39], v[228:229], v[102:103] op_sel_hi:[1,0,1]
v_pk_mul_f32 v[102:103], v[102:103], v[228:229] op_sel:[0,1] op_sel_hi:[1,1]
v_cvt_pk_bf16_f32 v193, v102, v103
v_pk_fma_f32 v[116:117], v[40:41], v[228:229], v[116:117] op_sel_hi:[1,0,1]
v_pk_mul_f32 v[116:117], v[116:117], v[228:229] op_sel:[0,1] op_sel_hi:[1,1]
v_cvt_pk_bf16_f32 v194, v116, v117
buffer_load_dwordx4 v5, s[24:27], s58 offen lds
v_pk_fma_f32 v[118:119], v[42:43], v[228:229], v[118:119] op_sel_hi:[1,0,1]
v_pk_mul_f32 v[118:119], v[118:119], v[228:229] op_sel:[0,1] op_sel_hi:[1,1]
s_nop 1
v_mfma_f32_16x16x32_bf16 v[96:99], a[72:75], a[48:51], v[96:99]
s_waitcnt lgkmcnt(0)
s_barrier
ds_read_b128 v[180:183], v9
v_mfma_f32_16x16x32_bf16 v[112:115], a[76:79], a[48:51], v[112:115]
ds_read_b64 v[200:201], v9 offset:1024
v_cvt_pk_bf16_f32 v195, v118, v119
v_mfma_f32_16x16x32_bf16 v[92:95], a[72:75], a[44:47], v[92:95]
ds_read_b64 v[210:211], v9 offset:1032
v_mfma_f32_16x16x32_bf16 v[108:111], a[76:79], a[44:47], v[108:111]
buffer_load_dwordx4 v6, s[24:27], s58 offen offset:1024 lds
s_add_u32 m0, s59, 74880
s_mov_b32 s58, 131072
ds_read_b128 v[240:243], v11 offset:384
ds_read_b128 v[244:247], v11 offset:1408
v_pk_fma_f32 v[96:97], v[36:37], v[224:225], v[96:97] op_sel_hi:[1,0,1]
v_pk_mul_f32 v[96:97], v[96:97], v[224:225] op_sel:[0,1] op_sel_hi:[1,1]
v_cvt_pk_bf16_f32 v188, v96, v97
v_pk_fma_f32 v[98:99], v[38:39], v[224:225], v[98:99] op_sel_hi:[1,0,1]
v_pk_mul_f32 v[98:99], v[98:99], v[224:225] op_sel:[0,1] op_sel_hi:[1,1]
v_cvt_pk_bf16_f32 v189, v98, v99
.Lpad21:
s_cbranch_execz .Lnopoll30r
v_pk_fma_f32 v[112:113], v[40:41], v[224:225], v[112:113] op_sel_hi:[1,0,1]
buffer_load_dwordx4 v5, s[24:27], s58 offen lds
v_pk_mul_f32 v[112:113], v[112:113], v[224:225] op_sel:[0,1] op_sel_hi:[1,1]
v_cvt_pk_bf16_f32 v190, v112, v113
v_pk_fma_f32 v[114:115], v[42:43], v[224:225], v[114:115] op_sel_hi:[1,0,1]
v_pk_mul_f32 v[114:115], v[114:115], v[224:225] op_sel:[0,1] op_sel_hi:[1,1]
v_cvt_pk_bf16_f32 v191, v114, v115
ds_read_b128 v[18:21], v11 offset:320
ds_read_b128 v[22:25], v11 offset:1344
v_pk_fma_f32 v[92:93], v[36:37], v[220:221], v[92:93] op_sel_hi:[1,0,1]
v_pk_mul_f32 v[92:93], v[92:93], v[220:221] op_sel:[0,1] op_sel_hi:[1,1]
v_cvt_pk_bf16_f32 v184, v92, v93
v_pk_fma_f32 v[94:95], v[38:39], v[220:221], v[94:95] op_sel_hi:[1,0,1]
buffer_load_dwordx4 v6, s[24:27], s58 offen offset:1024 lds
s_add_u32 m0, s59, 83200
s_mov_b32 s58, 262144
v_pk_mul_f32 v[94:95], v[94:95], v[220:221] op_sel:[0,1] op_sel_hi:[1,1]
v_cvt_pk_bf16_f32 v185, v94, v95
v_pk_fma_f32 v[108:109], v[40:41], v[220:221], v[108:109] op_sel_hi:[1,0,1]
v_pk_mul_f32 v[108:109], v[108:109], v[220:221] op_sel:[0,1] op_sel_hi:[1,1]
v_cvt_pk_bf16_f32 v186, v108, v109
v_pk_fma_f32 v[110:111], v[42:43], v[220:221], v[110:111] op_sel_hi:[1,0,1]
v_pk_mul_f32 v[110:111], v[110:111], v[220:221] op_sel:[0,1] op_sel_hi:[1,1]
s_nop 1
v_mfma_f32_16x16x32_bf16 v[72:75], a[64:67], a[56:59], v[72:75]
v_cvt_pk_bf16_f32 v187, v110, v111
v_mfma_f32_16x16x32_bf16 v[88:91], a[68:71], a[56:59], v[88:91]
buffer_load_dwordx4 v5, s[24:27], s58 offen lds
v_mfma_f32_16x16x32_bf16 v[132:135], a[52:55], a[80:83], v[132:135]
v_mfma_f32_16x16x32_bf16 v[148:151], a[52:55], a[84:87], v[148:151]
v_mfma_f32_16x16x32_bf16 v[68:71], a[64:67], a[52:55], v[68:71]
buffer_load_dwordx4 v6, s[24:27], s58 offen offset:1024 lds
s_nop 0
v_pk_fma_f32 v[72:73], v[28:29], v[232:233], v[72:73] op_sel_hi:[1,0,1]
v_cvt_pk_bf16_f32 v176, v72, v73
v_pk_fma_f32 v[74:75], v[30:31], v[232:233], v[74:75] op_sel_hi:[1,0,1]
v_cvt_pk_bf16_f32 v177, v74, v75
v_pk_fma_f32 v[88:89], v[32:33], v[232:233], v[88:89] op_sel_hi:[1,0,1]
v_cvt_pk_bf16_f32 v178, v88, v89
v_pk_fma_f32 v[90:91], v[34:35], v[232:233], v[90:91] op_sel_hi:[1,0,1]
v_cvt_pk_bf16_f32 v179, v90, v91
s_waitcnt lgkmcnt(3)
v_pk_fma_f32 v[132:133], v[240:241], v[44:45], v[132:133] op_sel_hi:[1,0,1]
s_waitcnt lgkmcnt(2)
v_pk_mul_f32 v[132:133], v[132:133], v[244:245]
v_cvt_pk_bf16_f32 v206, v132, v133
v_pk_fma_f32 v[134:135], v[242:243], v[44:45], v[134:135] op_sel_hi:[1,0,1]
v_pk_mul_f32 v[134:135], v[134:135], v[246:247]
v_cvt_pk_bf16_f32 v207, v134, v135
v_pk_fma_f32 v[148:149], v[240:241], v[44:45], v[148:149] op_sel:[0,1,0] op_sel_hi:[1,1,1]
v_pk_mul_f32 v[148:149], v[148:149], v[244:245]
v_cvt_pk_bf16_f32 v216, v148, v149
v_pk_fma_f32 v[150:151], v[242:243], v[44:45], v[150:151] op_sel:[0,1,0] op_sel_hi:[1,1,1]
v_pk_mul_f32 v[150:151], v[150:151], v[246:247]
v_cvt_pk_bf16_f32 v217, v150, v151
v_pk_fma_f32 v[68:69], v[28:29], v[228:229], v[68:69] op_sel_hi:[1,0,1]
v_cvt_pk_bf16_f32 v172, v68, v69
v_pk_fma_f32 v[70:71], v[30:31], v[228:229], v[70:71] op_sel_hi:[1,0,1]
s_nop 1
v_mfma_f32_16x16x32_bf16 v[84:87], a[68:71], a[52:55], v[84:87]
ds_read_b128 v[240:243], v11 offset:256
v_cvt_pk_bf16_f32 v173, v70, v71
v_mfma_f32_16x16x32_bf16 v[128:131], a[48:51], a[80:83], v[128:131]
ds_read_b128 v[244:247], v11 offset:1280
v_mfma_f32_16x16x32_bf16 v[144:147], a[48:51], a[84:87], v[144:147]
v_mfma_f32_16x16x32_bf16 v[64:67], a[64:67], a[48:51], v[64:67]
v_mfma_f32_16x16x32_bf16 v[80:83], a[68:71], a[48:51], v[80:83]
s_nop 0
v_pk_fma_f32 v[84:85], v[32:33], v[228:229], v[84:85] op_sel_hi:[1,0,1]
v_cvt_pk_bf16_f32 v174, v84, v85
v_pk_fma_f32 v[86:87], v[34:35], v[228:229], v[86:87] op_sel_hi:[1,0,1]
v_cvt_pk_bf16_f32 v175, v86, v87
s_waitcnt lgkmcnt(3)
v_pk_fma_f32 v[128:129], v[18:19], v[44:45], v[128:129] op_sel_hi:[1,0,1]
s_waitcnt lgkmcnt(2)
v_pk_mul_f32 v[128:129], v[128:129], v[22:23]
v_cvt_pk_bf16_f32 v204, v128, v129
v_pk_fma_f32 v[130:131], v[20:21], v[44:45], v[130:131] op_sel_hi:[1,0,1]
v_pk_mul_f32 v[130:131], v[130:131], v[24:25]
v_cvt_pk_bf16_f32 v205, v130, v131
v_pk_fma_f32 v[144:145], v[18:19], v[44:45], v[144:145] op_sel:[0,1,0] op_sel_hi:[1,1,1]
v_pk_mul_f32 v[144:145], v[144:145], v[22:23]
v_cvt_pk_bf16_f32 v214, v144, v145
v_pk_fma_f32 v[146:147], v[20:21], v[44:45], v[146:147] op_sel:[0,1,0] op_sel_hi:[1,1,1]
v_pk_mul_f32 v[146:147], v[146:147], v[24:25]
v_cvt_pk_bf16_f32 v215, v146, v147
v_pk_fma_f32 v[64:65], v[28:29], v[224:225], v[64:65] op_sel_hi:[1,0,1]
v_cvt_pk_bf16_f32 v168, v64, v65
v_pk_fma_f32 v[66:67], v[30:31], v[224:225], v[66:67] op_sel_hi:[1,0,1]
v_cvt_pk_bf16_f32 v169, v66, v67
v_pk_fma_f32 v[80:81], v[32:33], v[224:225], v[80:81] op_sel_hi:[1,0,1]
v_cvt_pk_bf16_f32 v170, v80, v81
v_pk_fma_f32 v[82:83], v[34:35], v[224:225], v[82:83] op_sel_hi:[1,0,1]
s_nop 1
v_mfma_f32_16x16x32_bf16 v[124:127], a[44:47], a[80:83], v[124:127]
v_cvt_pk_bf16_f32 v171, v82, v83
v_mfma_f32_16x16x32_bf16 v[140:143], a[44:47], a[84:87], v[140:143]
v_mfma_f32_16x16x32_bf16 v[60:63], a[64:67], a[44:47], v[60:63]
v_mfma_f32_16x16x32_bf16 v[76:79], a[68:71], a[44:47], v[76:79]
v_mfma_f32_16x16x32_bf16 v[104:107], v[192:195], v[176:179], v[46:49]
s_nop 1
s_waitcnt lgkmcnt(1)
v_pk_fma_f32 v[124:125], v[240:241], v[44:45], v[124:125] op_sel_hi:[1,0,1]
s_waitcnt lgkmcnt(0)
v_pk_mul_f32 v[124:125], v[124:125], v[244:245]
s_nop 1
v_max3_f32 v88, v104, v105, v106
v_cvt_pk_bf16_f32 v202, v124, v125
v_pk_fma_f32 v[126:127], v[242:243], v[44:45], v[126:127] op_sel_hi:[1,0,1]
v_pk_mul_f32 v[126:127], v[126:127], v[246:247]
v_cvt_pk_bf16_f32 v203, v126, v127
v_pk_fma_f32 v[140:141], v[240:241], v[44:45], v[140:141] op_sel:[0,1,0] op_sel_hi:[1,1,1]
v_pk_mul_f32 v[140:141], v[140:141], v[244:245]
v_cvt_pk_bf16_f32 v212, v140, v141
v_pk_fma_f32 v[142:143], v[242:243], v[44:45], v[142:143] op_sel:[0,1,0] op_sel_hi:[1,1,1]
v_pk_mul_f32 v[142:143], v[142:143], v[246:247]
v_cvt_pk_bf16_f32 v213, v142, v143
v_pk_fma_f32 v[60:61], v[28:29], v[220:221], v[60:61] op_sel_hi:[1,0,1]
v_cvt_pk_bf16_f32 v164, v60, v61
v_pk_fma_f32 v[62:63], v[30:31], v[220:221], v[62:63] op_sel_hi:[1,0,1]
v_cvt_pk_bf16_f32 v165, v62, v63
v_pk_fma_f32 v[76:77], v[32:33], v[220:221], v[76:77] op_sel_hi:[1,0,1]
v_cvt_pk_bf16_f32 v166, v76, v77
v_pk_fma_f32 v[78:79], v[34:35], v[220:221], v[78:79] op_sel_hi:[1,0,1]
s_nop 1
v_mfma_f32_16x16x32_bf16 v[120:123], v[196:199], v[176:179], v[50:53]
v_cvt_pk_bf16_f32 v167, v78, v79
v_mfma_f32_16x16x32_bf16 v[100:103], v[188:191], v[172:175], v[46:49]
v_mfma_f32_16x16x32_bf16 v[116:119], v[192:195], v[172:175], v[50:53]
s_nop 4
v_max3_f32 v89, v107, v120, v121
v_max3_f32 v88, v88, v122, v123
v_mfma_f32_16x16x32_bf16 v[96:99], v[184:187], v[168:171], v[46:49]
v_max_f32 v90, v88, v89
v_max_f32 v89, v88, v89
v_mfma_f32_16x16x32_bf16 v[112:115], v[188:191], v[168:171], v[50:53]
s_nop 0
v_permlane16_swap_b32 v90, v89
v_max3_f32 v84, v100, v101, v102
v_mfma_f32_16x16x32_bf16 v[92:95], v[180:183], v[164:167], v[46:49]
v_max_f32 v88, v90, v89
v_max_f32 v89, v90, v89
v_mfma_f32_16x16x32_bf16 v[108:111], v[184:187], v[164:167], v[50:53]
s_nop 0
v_permlane32_swap_b32 v88, v89
v_max3_f32 v85, v103, v116, v117
v_max3_f32 v84, v84, v118, v119
v_max_f32 v88, v88, v89
v_mul_f32 v88, v88, v234
v_pk_fma_f32 v[104:105], v[104:105], v[234:235], v[88:89] op_sel_hi:[1,0,0] neg_lo:[0,0,1] neg_hi:[0,0,1]
v_exp_f32 v104, v104
v_pk_fma_f32 v[106:107], v[106:107], v[234:235], v[88:89] op_sel_hi:[1,0,0] neg_lo:[0,0,1] neg_hi:[0,0,1]
v_exp_f32 v105, v105
v_pk_fma_f32 v[120:121], v[120:121], v[234:235], v[88:89] op_sel_hi:[1,0,0] neg_lo:[0,0,1] neg_hi:[0,0,1]
v_exp_f32 v106, v106
v_pk_fma_f32 v[122:123], v[122:123], v[234:235], v[88:89] op_sel_hi:[1,0,0] neg_lo:[0,0,1] neg_hi:[0,0,1]
v_exp_f32 v107, v107
v_cvt_pk_bf16_f32 v72, v104, v105
v_exp_f32 v120, v120
v_cvt_pk_bf16_f32 v73, v106, v107
v_exp_f32 v121, v121
v_max_f32 v86, v84, v85
v_exp_f32 v122, v122
v_cvt_pk_bf16_f32 v74, v120, v121
v_exp_f32 v123, v123
v_max_f32 v85, v84, v85
v_max3_f32 v80, v96, v97, v98
v_cvt_pk_bf16_f32 v75, v122, v123
v_permlane16_swap_b32 v86, v85
v_max3_f32 v81, v99, v112, v113
v_mfma_f32_16x16x32_bf16 v[88:91], v[248:251], v[72:75], 0
v_max_f32 v84, v86, v85
v_max_f32 v85, v86, v85
v_mfma_f32_16x16x32_bf16 v[104:107], v[206:209], v[72:75], 0
s_nop 0
v_permlane32_swap_b32 v84, v85
v_max3_f32 v80, v80, v114, v115
v_mfma_f32_16x16x32_bf16 v[120:123], v[216:219], v[72:75], 0
s_nop 0
v_rcp_f32 v88, v88
v_max_f32 v84, v84, v85
v_mul_f32 v84, v84, v230
v_max_f32 v82, v80, v81
v_max_f32 v81, v80, v81
v_pk_mul_f32 v[104:105], v[104:105], v[88:89] op_sel_hi:[1,0]
v_pk_mul_f32 v[106:107], v[106:107], v[88:89] op_sel_hi:[1,0]
v_permlane16_swap_b32 v82, v81
v_pk_mul_f32 v[120:121], v[120:121], v[88:89] op_sel_hi:[1,0]
v_pk_mul_f32 v[122:123], v[122:123], v[88:89] op_sel_hi:[1,0]
v_cvt_pk_bf16_f32 v176, v104, v105
v_cvt_pk_bf16_f32 v177, v106, v107
v_cvt_pk_bf16_f32 v178, v120, v121
v_cvt_pk_bf16_f32 v179, v122, v123
buffer_store_dwordx4 v[176:179], v4, s[16:19], s74 offen offset:3072 sc1
v_pk_fma_f32 v[100:101], v[100:101], v[230:231], v[84:85] op_sel_hi:[1,0,0] neg_lo:[0,0,1] neg_hi:[0,0,1]
v_exp_f32 v100, v100
v_pk_fma_f32 v[102:103], v[102:103], v[230:231], v[84:85] op_sel_hi:[1,0,0] neg_lo:[0,0,1] neg_hi:[0,0,1]
v_exp_f32 v101, v101
v_pk_fma_f32 v[116:117], v[116:117], v[230:231], v[84:85] op_sel_hi:[1,0,0] neg_lo:[0,0,1] neg_hi:[0,0,1]
v_exp_f32 v102, v102
v_pk_fma_f32 v[118:119], v[118:119], v[230:231], v[84:85] op_sel_hi:[1,0,0] neg_lo:[0,0,1] neg_hi:[0,0,1]
v_exp_f32 v103, v103
v_cvt_pk_bf16_f32 v68, v100, v101
v_exp_f32 v116, v116
v_cvt_pk_bf16_f32 v69, v102, v103
v_exp_f32 v117, v117
v_max_f32 v80, v82, v81
v_exp_f32 v118, v118
v_cvt_pk_bf16_f32 v70, v116, v117
v_exp_f32 v119, v119
v_max_f32 v81, v82, v81
v_max3_f32 v76, v92, v93, v94
v_cvt_pk_bf16_f32 v71, v118, v119
v_permlane32_swap_b32 v80, v81
v_max3_f32 v77, v95, v108, v109
v_mfma_f32_16x16x32_bf16 v[84:87], v[248:251], v[68:71], 0
v_max_f32 v80, v80, v81
v_mul_f32 v80, v80, v226
v_mfma_f32_16x16x32_bf16 v[100:103], v[204:207], v[68:71], 0
v_max3_f32 v76, v76, v110, v111
v_max_f32 v78, v76, v77
v_mfma_f32_16x16x32_bf16 v[116:119], v[214:217], v[68:71], 0
s_nop 1
v_rcp_f32 v84, v84
v_max_f32 v77, v76, v77
s_nop 1
v_permlane16_swap_b32 v78, v77
v_pk_mul_f32 v[100:101], v[100:101], v[84:85] op_sel_hi:[1,0]
v_pk_mul_f32 v[102:103], v[102:103], v[84:85] op_sel_hi:[1,0]
v_pk_mul_f32 v[116:117], v[116:117], v[84:85] op_sel_hi:[1,0]
v_pk_mul_f32 v[118:119], v[118:119], v[84:85] op_sel_hi:[1,0]
v_cvt_pk_bf16_f32 v172, v100, v101
v_cvt_pk_bf16_f32 v173, v102, v103
v_cvt_pk_bf16_f32 v174, v116, v117
v_cvt_pk_bf16_f32 v175, v118, v119
buffer_store_dwordx4 v[172:175], v4, s[16:19], s74 offen offset:2048 sc1
v_pk_fma_f32 v[96:97], v[96:97], v[226:227], v[80:81] op_sel_hi:[1,0,0] neg_lo:[0,0,1] neg_hi:[0,0,1]
v_exp_f32 v96, v96
v_pk_fma_f32 v[98:99], v[98:99], v[226:227], v[80:81] op_sel_hi:[1,0,0] neg_lo:[0,0,1] neg_hi:[0,0,1]
v_exp_f32 v97, v97
v_pk_fma_f32 v[112:113], v[112:113], v[226:227], v[80:81] op_sel_hi:[1,0,0] neg_lo:[0,0,1] neg_hi:[0,0,1]
v_exp_f32 v98, v98
v_pk_fma_f32 v[114:115], v[114:115], v[226:227], v[80:81] op_sel_hi:[1,0,0] neg_lo:[0,0,1] neg_hi:[0,0,1]
v_exp_f32 v99, v99
v_cvt_pk_bf16_f32 v64, v96, v97
v_exp_f32 v112, v112
v_cvt_pk_bf16_f32 v65, v98, v99
v_exp_f32 v113, v113
v_max_f32 v76, v78, v77
v_exp_f32 v114, v114
v_cvt_pk_bf16_f32 v66, v112, v113
v_exp_f32 v115, v115
v_max_f32 v77, v78, v77
v_cvt_pk_bf16_f32 v67, v114, v115
s_nop 0
v_permlane32_swap_b32 v76, v77
v_mfma_f32_16x16x32_bf16 v[80:83], v[248:251], v[64:67], 0
v_max_f32 v76, v76, v77
v_mul_f32 v76, v76, v222
v_mfma_f32_16x16x32_bf16 v[96:99], v[202:205], v[64:67], 0
v_mfma_f32_16x16x32_bf16 v[112:115], v[212:215], v[64:67], 0
s_nop 3
v_rcp_f32 v80, v80
s_nop 1
v_pk_mul_f32 v[96:97], v[96:97], v[80:81] op_sel_hi:[1,0]
v_pk_mul_f32 v[98:99], v[98:99], v[80:81] op_sel_hi:[1,0]
v_pk_mul_f32 v[112:113], v[112:113], v[80:81] op_sel_hi:[1,0]
v_pk_mul_f32 v[114:115], v[114:115], v[80:81] op_sel_hi:[1,0]
v_cvt_pk_bf16_f32 v168, v96, v97
v_cvt_pk_bf16_f32 v169, v98, v99
v_cvt_pk_bf16_f32 v170, v112, v113
v_cvt_pk_bf16_f32 v171, v114, v115
buffer_store_dwordx4 v[168:171], v4, s[16:19], s74 offen offset:1024 sc1
v_pk_fma_f32 v[92:93], v[92:93], v[222:223], v[76:77] op_sel_hi:[1,0,0] neg_lo:[0,0,1] neg_hi:[0,0,1]
v_exp_f32 v92, v92
v_pk_fma_f32 v[94:95], v[94:95], v[222:223], v[76:77] op_sel_hi:[1,0,0] neg_lo:[0,0,1] neg_hi:[0,0,1]
v_exp_f32 v93, v93
v_pk_fma_f32 v[108:109], v[108:109], v[222:223], v[76:77] op_sel_hi:[1,0,0] neg_lo:[0,0,1] neg_hi:[0,0,1]
v_exp_f32 v94, v94
v_pk_fma_f32 v[110:111], v[110:111], v[222:223], v[76:77] op_sel_hi:[1,0,0] neg_lo:[0,0,1] neg_hi:[0,0,1]
v_exp_f32 v95, v95
v_cvt_pk_bf16_f32 v60, v92, v93
v_exp_f32 v108, v108
v_cvt_pk_bf16_f32 v61, v94, v95
v_exp_f32 v109, v109
v_exp_f32 v110, v110
v_cvt_pk_bf16_f32 v62, v108, v109
v_exp_f32 v111, v111
s_nop 0
v_cvt_pk_bf16_f32 v63, v110, v111
s_nop 1
v_mfma_f32_16x16x32_bf16 v[76:79], v[248:251], v[60:63], 0
v_mfma_f32_16x16x32_bf16 v[92:95], v[200:203], v[60:63], 0
v_mfma_f32_16x16x32_bf16 v[108:111], v[210:213], v[60:63], 0
s_nop 5
v_rcp_f32 v76, v76
s_nop 0
v_pk_mul_f32 v[92:93], v[92:93], v[76:77] op_sel_hi:[1,0]
v_pk_mul_f32 v[94:95], v[94:95], v[76:77] op_sel_hi:[1,0]
v_pk_mul_f32 v[108:109], v[108:109], v[76:77] op_sel_hi:[1,0]
v_pk_mul_f32 v[110:111], v[110:111], v[76:77] op_sel_hi:[1,0]
v_cvt_pk_bf16_f32 v164, v92, v93
v_cvt_pk_bf16_f32 v165, v94, v95
v_cvt_pk_bf16_f32 v166, v108, v109
v_cvt_pk_bf16_f32 v167, v110, v111
buffer_store_dwordx4 v[164:167], v4, s[16:19], s74 offen sc1
s_nop 1
.Lqkve32:
.Lpad22:
s_cbranch_execz .Lnopoll30r
s_lshl_b32 s62, s6, 13
s_lshl_b32 s63, s3, 11
s_add_u32 s62, s62, s63
v_lshl_add_u32 v4, v1, 4, s62
v_lshrrev_b32 v2, 3, v1
v_cmp_eq_u32 vcc, 3, v2
v_add_u32 v2, 67108480, v4
s_nop 0
v_cndmask_b32 v4, v4, v2, vcc
v_bfe_u32 v5, v1, 3, 1
v_lshrrev_b32 v2, 4, v1
v_lshl_add_u32 v5, v2, 3, v5
s_lshl_b32 s62, s3, 1
v_add_u32 v5, s62, v5
v_mul_u32_u24 v5, 2048, v5
v_and_b32 v2, 7, v1
v_lshl_add_u32 v5, v2, 4, v5
s_lshl_b32 s62, s7, 7
v_add_u32 v5, s62, v5
v_add_u32 v6, 64512, v5
v_bfe_u32 v8, v1, 3, 2
v_mul_u32_u24 v8, 2080, v8
v_bfe_u32 v2, v1, 2, 1
v_lshl_add_u32 v8, v2, 7, v8
v_bfe_u32 v2, v1, 5, 1
v_lshl_add_u32 v8, v2, 8, v8
v_and_b32 v2, 3, v1
v_lshl_add_u32 v8, v2, 3, v8
s_mov_b32 s57, 66560
v_add_u32 v7, s57, v8
s_mov_b32 s52, 37748736
s_mov_b32 s53, 37879808
s_mov_b32 s54, 2097152
s_mul_i32 s56, s3, 2080
v_accvgpr_read_b32 v32, a224
v_accvgpr_read_b32 v33, a225
v_accvgpr_read_b32 v34, a226
v_accvgpr_read_b32 v35, a227
v_accvgpr_read_b32 v36, a228
v_accvgpr_read_b32 v37, a229
v_accvgpr_read_b32 v38, a230
v_accvgpr_read_b32 v39, a231
v_accvgpr_read_b32 v40, a232
v_accvgpr_read_b32 v41, a233
v_accvgpr_read_b32 v42, a234
v_accvgpr_read_b32 v43, a235
v_accvgpr_read_b32 v44, a236
v_accvgpr_read_b32 v45, a237
v_accvgpr_read_b32 v46, a238
v_accvgpr_read_b32 v47, a239
v_accvgpr_read_b32 v48, a240
v_accvgpr_read_b32 v49, a241
v_accvgpr_read_b32 v50, a242
v_accvgpr_read_b32 v51, a243
v_accvgpr_read_b32 v52, a244
v_accvgpr_read_b32 v53, a245
v_accvgpr_read_b32 v54, a246
v_accvgpr_read_b32 v55, a247
v_accvgpr_read_b32 v56, a248
v_accvgpr_read_b32 v57, a249
v_accvgpr_read_b32 v58, a250
v_accvgpr_read_b32 v59, a251
v_accvgpr_read_b32 v60, a252
v_accvgpr_read_b32 v61, a253
v_accvgpr_read_b32 v62, a254
v_accvgpr_read_b32 v63, a255
s_and_b32 s62, s3, 1
s_mul_i32 s62, s62, 28672
s_add_u32 s62, s62, s51
v_lshrrev_b32 v12, 4, v1
v_mul_u32_u24 v12, 57344, v12
v_and_b32 v2, 15, v1
v_lshl_add_u32 v12, v2, 4, v12
v_add_u32 v12, s62, v12
v_add_u32 v13, 6112, v12
v_add_u32 v14, 12224, v12
v_add_u32 v15, 18336, v12
s_mul_i32 s59, s3, 4224
s_mov_b32 s58, 0
s_lshl_b32 s62, s8, 7
s_add_u32 s62, s62, 30418944
s_lshl_b32 s64, s6, 7
s_add_u32 s64, s64, 30418944
v_mov_b32 v252, s62
v_mov_b32 v253, s64
s_waitcnt vmcnt(0) lgkmcnt(0)
s_barrier
s_cmp_lg_u32 s3, 0
s_cbranch_scc1 .Lnosig35
v_mov_b32 v255, 1
s_mov_b64 exec, 1
buffer_atomic_add v255, v252, s[16:19], 0 offen
s_mov_b64 exec, -1
.Lnosig35:
ds_read_b64_tr_b16 a[0:1], v7
ds_read_b64_tr_b16 a[2:3], v7 offset:512
ds_read_b64_tr_b16 a[4:5], v7 offset:32
ds_read_b64_tr_b16 a[6:7], v7 offset:544
ds_read_b64_tr_b16 a[8:9], v7 offset:64
ds_read_b64_tr_b16 a[10:11], v7 offset:576
ds_read_b64_tr_b16 a[12:13], v7 offset:96
ds_read_b64_tr_b16 a[14:15], v7 offset:608
ds_read_b64_tr_b16 a[16:17], v7 offset:1024
ds_read_b64_tr_b16 a[18:19], v7 offset:1536
ds_read_b64_tr_b16 a[20:21], v7 offset:1056
ds_read_b64_tr_b16 a[22:23], v7 offset:1568
ds_read_b64_tr_b16 a[24:25], v7 offset:1088
ds_read_b64_tr_b16 a[26:27], v7 offset:1600
ds_read_b64_tr_b16 a[28:29], v7 offset:1120
ds_read_b64_tr_b16 a[30:31], v7 offset:1632
s_waitcnt lgkmcnt(0)
s_cmp_lg_u32 s3, 1
s_cbranch_scc1 .Lnopoll38
s_mov_b64 exec, 1
s_mov_b32 s15, 0
.Lpoll36:
buffer_load_dword v255, v253, s[16:19], 0 offen sc1
s_add_u32 s15, s15, 1
s_cmp_gt_u32 s15, 100000
s_cbranch_scc1 .Lgot37
s_waitcnt vmcnt(0)
v_cmp_ne_u32 vcc, 16, v255
s_nop 0
s_cbranch_vccnz .Lpoll36
.Lgot37:
s_waitcnt vmcnt(0)
s_branch .Lnopoll38r
.Lnopoll38:
s_mov_b64 exec, 0
s_cmp_eq_u32 s3, 2
s_cbranch_scc1 .Lpad23
s_cmp_eq_u32 s3, 3
s_cbranch_scc1 .Lpad24
s_branch .Lnopoll38r
.Lnopoll38r:
s_mov_b64 exec, -1
s_barrier
buffer_load_dwordx4 v[64:67], v4, s[16:19], s52 offen sc1
buffer_load_dwordx4 v[68:71], v4, s[16:19], s52 offen offset:1024 sc1
s_add_u32 s52, s52, 0x40000
buffer_load_dwordx4 v[72:75], v4, s[16:19], s53 offen sc1
buffer_load_dwordx4 v[76:79], v4, s[16:19], s53 offen offset:1024 sc1
s_add_u32 s53, s53, 0x40000
buffer_load_dwordx4 v[80:83], v4, s[16:19], s52 offen sc1
buffer_load_dwordx4 v[84:87], v4, s[16:19], s52 offen offset:1024 sc1
s_add_u32 s52, s52, 0x40000
buffer_load_dwordx4 v[88:91], v4, s[16:19], s53 offen sc1
buffer_load_dwordx4 v[92:95], v4, s[16:19], s53 offen offset:1024 sc1
s_add_u32 s53, s53, 0x40000
buffer_load_dwordx4 v[96:99], v4, s[16:19], s52 offen sc1
buffer_load_dwordx4 v[100:103], v4, s[16:19], s52 offen offset:1024 sc1
s_add_u32 s52, s52, 0x40000
buffer_load_dwordx4 v[104:107], v4, s[16:19], s53 offen sc1
buffer_load_dwordx4 v[108:111], v4, s[16:19], s53 offen offset:1024 sc1
s_add_u32 s53, s53, 0x40000
s_waitcnt vmcnt(11)
v_mfma_f32_16x16x32_bf16 v[32:35], a[0:3], v[64:67], v[32:35]
ds_read_b64_tr_b16 a[32:33], v7 offset:8320
ds_read_b64_tr_b16 a[34:35], v7 offset:8832
s_waitcnt vmcnt(10)
v_mfma_f32_16x16x32_bf16 v[48:51], a[0:3], v[68:71], v[48:51]
buffer_load_dwordx4 v[112:115], v4, s[16:19], s52 offen sc1
v_mfma_f32_16x16x32_bf16 v[36:39], a[4:7], v[64:67], v[36:39]
ds_read_b64_tr_b16 a[36:37], v7 offset:8352
ds_read_b64_tr_b16 a[38:39], v7 offset:8864
v_mfma_f32_16x16x32_bf16 v[52:55], a[4:7], v[68:71], v[52:55]
ds_read_b64_tr_b16 a[40:41], v7 offset:8384
ds_read_b64_tr_b16 a[42:43], v7 offset:8896
v_mfma_f32_16x16x32_bf16 v[40:43], a[8:11], v[64:67], v[40:43]
buffer_load_dwordx4 v[116:119], v4, s[16:19], s52 offen offset:1024 sc1
v_mfma_f32_16x16x32_bf16 v[56:59], a[8:11], v[68:71], v[56:59]
ds_read_b64_tr_b16 a[44:45], v7 offset:8416
s_add_u32 s52, s52, 0x40000
v_mfma_f32_16x16x32_bf16 v[44:47], a[12:15], v[64:67], v[44:47]
ds_read_b64_tr_b16 a[46:47], v7 offset:8928
v_mfma_f32_16x16x32_bf16 v[60:63], a[12:15], v[68:71], v[60:63]
ds_read_b64_tr_b16 a[48:49], v7 offset:9344
ds_read_b64_tr_b16 a[50:51], v7 offset:9856
s_waitcnt vmcnt(11)
v_mfma_f32_16x16x32_bf16 v[32:35], a[16:19], v[72:75], v[32:35]
buffer_load_dwordx4 v[120:123], v4, s[16:19], s53 offen sc1
s_waitcnt vmcnt(11)
v_mfma_f32_16x16x32_bf16 v[48:51], a[16:19], v[76:79], v[48:51]
ds_read_b64_tr_b16 a[52:53], v7 offset:9376
ds_read_b64_tr_b16 a[54:55], v7 offset:9888
v_mfma_f32_16x16x32_bf16 v[36:39], a[20:23], v[72:75], v[36:39]
ds_read_b64_tr_b16 a[56:57], v7 offset:9408
ds_read_b64_tr_b16 a[58:59], v7 offset:9920
v_mfma_f32_16x16x32_bf16 v[52:55], a[20:23], v[76:79], v[52:55]
buffer_load_dwordx4 v[124:127], v4, s[16:19], s53 offen offset:1024 sc1
v_mfma_f32_16x16x32_bf16 v[40:43], a[24:27], v[72:75], v[40:43]
ds_read_b64_tr_b16 a[60:61], v7 offset:9440
s_add_u32 s53, s53, 0x40000
v_mfma_f32_16x16x32_bf16 v[56:59], a[24:27], v[76:79], v[56:59]
ds_read_b64_tr_b16 a[62:63], v7 offset:9952
v_mfma_f32_16x16x32_bf16 v[44:47], a[28:31], v[72:75], v[44:47]
v_mfma_f32_16x16x32_bf16 v[60:63], a[28:31], v[76:79], v[60:63]
s_waitcnt vmcnt(11) lgkmcnt(14)
v_mfma_f32_16x16x32_bf16 v[32:35], a[32:35], v[80:83], v[32:35]
ds_read_b64_tr_b16 a[0:1], v7 offset:16640
ds_read_b64_tr_b16 a[2:3], v7 offset:17152
s_waitcnt vmcnt(10)
v_mfma_f32_16x16x32_bf16 v[48:51], a[32:35], v[84:87], v[48:51]
buffer_load_dwordx4 v[64:67], v4, s[16:19], s52 offen sc1
s_waitcnt lgkmcnt(14)
v_mfma_f32_16x16x32_bf16 v[36:39], a[36:39], v[80:83], v[36:39]
ds_read_b64_tr_b16 a[4:5], v7 offset:16672
ds_read_b64_tr_b16 a[6:7], v7 offset:17184
v_mfma_f32_16x16x32_bf16 v[52:55], a[36:39], v[84:87], v[52:55]
ds_read_b64_tr_b16 a[8:9], v7 offset:16704
ds_read_b64_tr_b16 a[10:11], v7 offset:17216
s_waitcnt lgkmcnt(15)
v_mfma_f32_16x16x32_bf16 v[40:43], a[40:43], v[80:83], v[40:43]
buffer_load_dwordx4 v[68:71], v4, s[16:19], s52 offen offset:1024 sc1
v_mfma_f32_16x16x32_bf16 v[56:59], a[40:43], v[84:87], v[56:59]
ds_read_b64_tr_b16 a[12:13], v7 offset:16736
s_add_u32 s52, s52, 0x40000
s_waitcnt lgkmcnt(15)
v_mfma_f32_16x16x32_bf16 v[44:47], a[44:47], v[80:83], v[44:47]
ds_read_b64_tr_b16 a[14:15], v7 offset:17248
v_mfma_f32_16x16x32_bf16 v[60:63], a[44:47], v[84:87], v[60:63]
ds_read_b64_tr_b16 a[16:17], v7 offset:17664
ds_read_b64_tr_b16 a[18:19], v7 offset:18176
s_waitcnt vmcnt(11) lgkmcnt(15)
v_mfma_f32_16x16x32_bf16 v[32:35], a[48:51], v[88:91], v[32:35]
buffer_load_dwordx4 v[72:75], v4, s[16:19], s53 offen sc1
s_waitcnt vmcnt(11)
v_mfma_f32_16x16x32_bf16 v[48:51], a[48:51], v[92:95], v[48:51]
ds_read_b64_tr_b16 a[20:21], v7 offset:17696
ds_read_b64_tr_b16 a[22:23], v7 offset:18208
s_waitcnt lgkmcnt(15)
v_mfma_f32_16x16x32_bf16 v[36:39], a[52:55], v[88:91], v[36:39]
ds_read_b64_tr_b16 a[24:25], v7 offset:17728
ds_read_b64_tr_b16 a[26:27], v7 offset:18240
v_mfma_f32_16x16x32_bf16 v[52:55], a[52:55], v[92:95], v[52:55]
buffer_load_dwordx4 v[76:79], v4, s[16:19], s53 offen offset:1024 sc1
s_waitcnt lgkmcnt(15)
v_mfma_f32_16x16x32_bf16 v[40:43], a[56:59], v[88:91], v[40:43]
ds_read_b64_tr_b16 a[28:29], v7 offset:17760
s_add_u32 s53, s53, 0x40000
v_mfma_f32_16x16x32_bf16 v[56:59], a[56:59], v[92:95], v[56:59]
ds_read_b64_tr_b16 a[30:31], v7 offset:18272
s_waitcnt lgkmcnt(15)
v_mfma_f32_16x16x32_bf16 v[44:47], a[60:63], v[88:91], v[44:47]
v_mfma_f32_16x16x32_bf16 v[60:63], a[60:63], v[92:95], v[60:63]
s_waitcnt vmcnt(11) lgkmcnt(14)
v_mfma_f32_16x16x32_bf16 v[32:35], a[0:3], v[96:99], v[32:35]
ds_read_b64_tr_b16 a[32:33], v7 offset:24960
ds_read_b64_tr_b16 a[34:35], v7 offset:25472
s_waitcnt vmcnt(10)
v_mfma_f32_16x16x32_bf16 v[48:51], a[0:3], v[100:103], v[48:51]
buffer_load_dwordx4 v[80:83], v4, s[16:19], s52 offen sc1
s_waitcnt lgkmcnt(14)
v_mfma_f32_16x16x32_bf16 v[36:39], a[4:7], v[96:99], v[36:39]
ds_read_b64_tr_b16 a[36:37], v7 offset:24992
ds_read_b64_tr_b16 a[38:39], v7 offset:25504
v_mfma_f32_16x16x32_bf16 v[52:55], a[4:7], v[100:103], v[52:55]
ds_read_b64_tr_b16 a[40:41], v7 offset:25024
ds_read_b64_tr_b16 a[42:43], v7 offset:25536
s_waitcnt lgkmcnt(15)
v_mfma_f32_16x16x32_bf16 v[40:43], a[8:11], v[96:99], v[40:43]
buffer_load_dwordx4 v[84:87], v4, s[16:19], s52 offen offset:1024 sc1
v_mfma_f32_16x16x32_bf16 v[56:59], a[8:11], v[100:103], v[56:59]
ds_read_b64_tr_b16 a[44:45], v7 offset:25056
s_add_u32 s52, s52, 0x40000
s_waitcnt lgkmcnt(15)
v_mfma_f32_16x16x32_bf16 v[44:47], a[12:15], v[96:99], v[44:47]
ds_read_b64_tr_b16 a[46:47], v7 offset:25568
v_mfma_f32_16x16x32_bf16 v[60:63], a[12:15], v[100:103], v[60:63]
ds_read_b64_tr_b16 a[48:49], v7 offset:25984
ds_read_b64_tr_b16 a[50:51], v7 offset:26496
s_waitcnt vmcnt(11) lgkmcnt(15)
v_mfma_f32_16x16x32_bf16 v[32:35], a[16:19], v[104:107], v[32:35]
buffer_load_dwordx4 v[88:91], v4, s[16:19], s53 offen sc1
s_waitcnt vmcnt(11)
v_mfma_f32_16x16x32_bf16 v[48:51], a[16:19], v[108:111], v[48:51]
ds_read_b64_tr_b16 a[52:53], v7 offset:26016
ds_read_b64_tr_b16 a[54:55], v7 offset:26528
s_waitcnt lgkmcnt(15)
v_mfma_f32_16x16x32_bf16 v[36:39], a[20:23], v[104:107], v[36:39]
ds_read_b64_tr_b16 a[56:57], v7 offset:26048
ds_read_b64_tr_b16 a[58:59], v7 offset:26560
v_mfma_f32_16x16x32_bf16 v[52:55], a[20:23], v[108:111], v[52:55]
buffer_load_dwordx4 v[92:95], v4, s[16:19], s53 offen offset:1024 sc1
s_waitcnt lgkmcnt(15)
v_mfma_f32_16x16x32_bf16 v[40:43], a[24:27], v[104:107], v[40:43]
ds_read_b64_tr_b16 a[60:61], v7 offset:26080
s_add_u32 s53, s53, 0x40000
v_mfma_f32_16x16x32_bf16 v[56:59], a[24:27], v[108:111], v[56:59]
ds_read_b64_tr_b16 a[62:63], v7 offset:26592
s_waitcnt lgkmcnt(15)
v_mfma_f32_16x16x32_bf16 v[44:47], a[28:31], v[104:107], v[44:47]
v_mfma_f32_16x16x32_bf16 v[60:63], a[28:31], v[108:111], v[60:63]
s_waitcnt vmcnt(11) lgkmcnt(14)
v_mfma_f32_16x16x32_bf16 v[32:35], a[32:35], v[112:115], v[32:35]
ds_read_b64_tr_b16 a[0:1], v7 offset:33280
.Lpad23:
s_cbranch_execz .Lnopoll38r
ds_read_b64_tr_b16 a[2:3], v7 offset:33792
s_waitcnt vmcnt(10)
v_mfma_f32_16x16x32_bf16 v[48:51], a[32:35], v[116:119], v[48:51]
buffer_load_dwordx4 v[96:99], v4, s[16:19], s52 offen sc1
s_waitcnt lgkmcnt(14)
v_mfma_f32_16x16x32_bf16 v[36:39], a[36:39], v[112:115], v[36:39]
ds_read_b64_tr_b16 a[4:5], v7 offset:33312
ds_read_b64_tr_b16 a[6:7], v7 offset:33824
v_mfma_f32_16x16x32_bf16 v[52:55], a[36:39], v[116:119], v[52:55]
ds_read_b64_tr_b16 a[8:9], v7 offset:33344
ds_read_b64_tr_b16 a[10:11], v7 offset:33856
s_waitcnt lgkmcnt(15)
v_mfma_f32_16x16x32_bf16 v[40:43], a[40:43], v[112:115], v[40:43]
buffer_load_dwordx4 v[100:103], v4, s[16:19], s52 offen offset:1024 sc1
v_mfma_f32_16x16x32_bf16 v[56:59], a[40:43], v[116:119], v[56:59]
ds_read_b64_tr_b16 a[12:13], v7 offset:33376
s_add_u32 s52, s52, 0x40000
s_waitcnt lgkmcnt(15)
v_mfma_f32_16x16x32_bf16 v[44:47], a[44:47], v[112:115], v[44:47]
ds_read_b64_tr_b16 a[14:15], v7 offset:33888
v_mfma_f32_16x16x32_bf16 v[60:63], a[44:47], v[116:119], v[60:63]
ds_read_b64_tr_b16 a[16:17], v7 offset:34304
ds_read_b64_tr_b16 a[18:19], v7 offset:34816
s_waitcnt vmcnt(11) lgkmcnt(15)
v_mfma_f32_16x16x32_bf16 v[32:35], a[48:51], v[120:123], v[32:35]
buffer_load_dwordx4 v[104:107], v4, s[16:19], s53 offen sc1
s_waitcnt vmcnt(11)
v_mfma_f32_16x16x32_bf16 v[48:51], a[48:51], v[124:127], v[48:51]
ds_read_b64_tr_b16 a[20:21], v7 offset:34336
ds_read_b64_tr_b16 a[22:23], v7 offset:34848
s_waitcnt lgkmcnt(15)
v_mfma_f32_16x16x32_bf16 v[36:39], a[52:55], v[120:123], v[36:39]
ds_read_b64_tr_b16 a[24:25], v7 offset:34368
ds_read_b64_tr_b16 a[26:27], v7 offset:34880
v_mfma_f32_16x16x32_bf16 v[52:55], a[52:55], v[124:127], v[52:55]
buffer_load_dwordx4 v[108:111], v4, s[16:19], s53 offen offset:1024 sc1
s_waitcnt lgkmcnt(15)
v_mfma_f32_16x16x32_bf16 v[40:43], a[56:59], v[120:123], v[40:43]
ds_read_b64_tr_b16 a[28:29], v7 offset:34400
s_add_u32 s53, s53, 0x40000
v_mfma_f32_16x16x32_bf16 v[56:59], a[56:59], v[124:127], v[56:59]
ds_read_b64_tr_b16 a[30:31], v7 offset:34912
s_waitcnt lgkmcnt(15)
v_mfma_f32_16x16x32_bf16 v[44:47], a[60:63], v[120:123], v[44:47]
v_mfma_f32_16x16x32_bf16 v[60:63], a[60:63], v[124:127], v[60:63]
s_waitcnt vmcnt(11) lgkmcnt(14)
v_mfma_f32_16x16x32_bf16 v[32:35], a[0:3], v[64:67], v[32:35]
ds_read_b64_tr_b16 a[32:33], v7 offset:41600
ds_read_b64_tr_b16 a[34:35], v7 offset:42112
s_waitcnt vmcnt(10)
v_mfma_f32_16x16x32_bf16 v[48:51], a[0:3], v[68:71], v[48:51]
buffer_load_dwordx4 v[112:115], v4, s[16:19], s52 offen sc1
s_waitcnt lgkmcnt(14)
v_mfma_f32_16x16x32_bf16 v[36:39], a[4:7], v[64:67], v[36:39]
ds_read_b64_tr_b16 a[36:37], v7 offset:41632
ds_read_b64_tr_b16 a[38:39], v7 offset:42144
v_mfma_f32_16x16x32_bf16 v[52:55], a[4:7], v[68:71], v[52:55]
ds_read_b64_tr_b16 a[40:41], v7 offset:41664
ds_read_b64_tr_b16 a[42:43], v7 offset:42176
s_waitcnt lgkmcnt(15)
v_mfma_f32_16x16x32_bf16 v[40:43], a[8:11], v[64:67], v[40:43]
buffer_load_dwordx4 v[116:119], v4, s[16:19], s52 offen offset:1024 sc1
v_mfma_f32_16x16x32_bf16 v[56:59], a[8:11], v[68:71], v[56:59]
ds_read_b64_tr_b16 a[44:45], v7 offset:41696
s_add_u32 s52, s52, 0x40000
s_waitcnt lgkmcnt(15)
v_mfma_f32_16x16x32_bf16 v[44:47], a[12:15], v[64:67], v[44:47]
ds_read_b64_tr_b16 a[46:47], v7 offset:42208
v_mfma_f32_16x16x32_bf16 v[60:63], a[12:15], v[68:71], v[60:63]
ds_read_b64_tr_b16 a[48:49], v7 offset:42624
ds_read_b64_tr_b16 a[50:51], v7 offset:43136
s_waitcnt vmcnt(11) lgkmcnt(15)
v_mfma_f32_16x16x32_bf16 v[32:35], a[16:19], v[72:75], v[32:35]
buffer_load_dwordx4 v[120:123], v4, s[16:19], s53 offen sc1
s_waitcnt vmcnt(11)
v_mfma_f32_16x16x32_bf16 v[48:51], a[16:19], v[76:79], v[48:51]
ds_read_b64_tr_b16 a[52:53], v7 offset:42656
ds_read_b64_tr_b16 a[54:55], v7 offset:43168
s_waitcnt lgkmcnt(15)
v_mfma_f32_16x16x32_bf16 v[36:39], a[20:23], v[72:75], v[36:39]
ds_read_b64_tr_b16 a[56:57], v7 offset:42688
ds_read_b64_tr_b16 a[58:59], v7 offset:43200
v_mfma_f32_16x16x32_bf16 v[52:55], a[20:23], v[76:79], v[52:55]
buffer_load_dwordx4 v[124:127], v4, s[16:19], s53 offen offset:1024 sc1
s_waitcnt lgkmcnt(15)
v_mfma_f32_16x16x32_bf16 v[40:43], a[24:27], v[72:75], v[40:43]
ds_read_b64_tr_b16 a[60:61], v7 offset:42720
s_add_u32 s53, s53, 0x40000
v_mfma_f32_16x16x32_bf16 v[56:59], a[24:27], v[76:79], v[56:59]
ds_read_b64_tr_b16 a[62:63], v7 offset:43232
s_waitcnt lgkmcnt(15)
v_mfma_f32_16x16x32_bf16 v[44:47], a[28:31], v[72:75], v[44:47]
v_mfma_f32_16x16x32_bf16 v[60:63], a[28:31], v[76:79], v[60:63]
s_waitcnt vmcnt(11) lgkmcnt(14)
v_mfma_f32_16x16x32_bf16 v[32:35], a[32:35], v[80:83], v[32:35]
ds_read_b64_tr_b16 a[0:1], v7 offset:49920
ds_read_b64_tr_b16 a[2:3], v7 offset:50432
s_waitcnt vmcnt(10)
v_mfma_f32_16x16x32_bf16 v[48:51], a[32:35], v[84:87], v[48:51]
buffer_load_dwordx4 v[64:67], v4, s[16:19], s52 offen sc1
s_waitcnt lgkmcnt(14)
v_mfma_f32_16x16x32_bf16 v[36:39], a[36:39], v[80:83], v[36:39]
ds_read_b64_tr_b16 a[4:5], v7 offset:49952
ds_read_b64_tr_b16 a[6:7], v7 offset:50464
v_mfma_f32_16x16x32_bf16 v[52:55], a[36:39], v[84:87], v[52:55]
ds_read_b64_tr_b16 a[8:9], v7 offset:49984
ds_read_b64_tr_b16 a[10:11], v7 offset:50496
s_waitcnt lgkmcnt(15)
v_mfma_f32_16x16x32_bf16 v[40:43], a[40:43], v[80:83], v[40:43]
buffer_load_dwordx4 v[68:71], v4, s[16:19], s52 offen offset:1024 sc1
v_mfma_f32_16x16x32_bf16 v[56:59], a[40:43], v[84:87], v[56:59]
ds_read_b64_tr_b16 a[12:13], v7 offset:50016
s_add_u32 s52, s52, 0x40000
s_waitcnt lgkmcnt(15)
v_mfma_f32_16x16x32_bf16 v[44:47], a[44:47], v[80:83], v[44:47]
ds_read_b64_tr_b16 a[14:15], v7 offset:50528
v_mfma_f32_16x16x32_bf16 v[60:63], a[44:47], v[84:87], v[60:63]
ds_read_b64_tr_b16 a[16:17], v7 offset:50944
ds_read_b64_tr_b16 a[18:19], v7 offset:51456
s_waitcnt vmcnt(11) lgkmcnt(15)
v_mfma_f32_16x16x32_bf16 v[32:35], a[48:51], v[88:91], v[32:35]
buffer_load_dwordx4 v[72:75], v4, s[16:19], s53 offen sc1
s_waitcnt vmcnt(11)
v_mfma_f32_16x16x32_bf16 v[48:51], a[48:51], v[92:95], v[48:51]
ds_read_b64_tr_b16 a[20:21], v7 offset:50976
ds_read_b64_tr_b16 a[22:23], v7 offset:51488
s_waitcnt lgkmcnt(15)
v_mfma_f32_16x16x32_bf16 v[36:39], a[52:55], v[88:91], v[36:39]
ds_read_b64_tr_b16 a[24:25], v7 offset:51008
ds_read_b64_tr_b16 a[26:27], v7 offset:51520
v_mfma_f32_16x16x32_bf16 v[52:55], a[52:55], v[92:95], v[52:55]
buffer_load_dwordx4 v[76:79], v4, s[16:19], s53 offen offset:1024 sc1
s_waitcnt lgkmcnt(15)
v_mfma_f32_16x16x32_bf16 v[40:43], a[56:59], v[88:91], v[40:43]
ds_read_b64_tr_b16 a[28:29], v7 offset:51040
s_add_u32 s53, s53, 0x40000
v_mfma_f32_16x16x32_bf16 v[56:59], a[56:59], v[92:95], v[56:59]
ds_read_b64_tr_b16 a[30:31], v7 offset:51552
s_waitcnt lgkmcnt(15)
v_mfma_f32_16x16x32_bf16 v[44:47], a[60:63], v[88:91], v[44:47]
v_mfma_f32_16x16x32_bf16 v[60:63], a[60:63], v[92:95], v[60:63]
s_waitcnt vmcnt(11) lgkmcnt(14)
v_mfma_f32_16x16x32_bf16 v[32:35], a[0:3], v[96:99], v[32:35]
ds_read_b64_tr_b16 a[32:33], v7 offset:58240
ds_read_b64_tr_b16 a[34:35], v7 offset:58752
s_waitcnt vmcnt(10)
v_mfma_f32_16x16x32_bf16 v[48:51], a[0:3], v[100:103], v[48:51]
buffer_load_dwordx4 v[80:83], v4, s[16:19], s52 offen sc1
s_waitcnt lgkmcnt(14)
v_mfma_f32_16x16x32_bf16 v[36:39], a[4:7], v[96:99], v[36:39]
ds_read_b64_tr_b16 a[36:37], v7 offset:58272
ds_read_b64_tr_b16 a[38:39], v7 offset:58784
v_mfma_f32_16x16x32_bf16 v[52:55], a[4:7], v[100:103], v[52:55]
ds_read_b64_tr_b16 a[40:41], v7 offset:58304
ds_read_b64_tr_b16 a[42:43], v7 offset:58816
s_waitcnt lgkmcnt(15)
v_mfma_f32_16x16x32_bf16 v[40:43], a[8:11], v[96:99], v[40:43]
buffer_load_dwordx4 v[84:87], v4, s[16:19], s52 offen offset:1024 sc1
v_mfma_f32_16x16x32_bf16 v[56:59], a[8:11], v[100:103], v[56:59]
ds_read_b64_tr_b16 a[44:45], v7 offset:58336
s_add_u32 s52, s52, 0x40000
s_waitcnt lgkmcnt(15)
v_mfma_f32_16x16x32_bf16 v[44:47], a[12:15], v[96:99], v[44:47]
ds_read_b64_tr_b16 a[46:47], v7 offset:58848
v_mfma_f32_16x16x32_bf16 v[60:63], a[12:15], v[100:103], v[60:63]
ds_read_b64_tr_b16 a[48:49], v7 offset:59264
ds_read_b64_tr_b16 a[50:51], v7 offset:59776
s_waitcnt vmcnt(11) lgkmcnt(15)
v_mfma_f32_16x16x32_bf16 v[32:35], a[16:19], v[104:107], v[32:35]
buffer_load_dwordx4 v[88:91], v4, s[16:19], s53 offen sc1
s_waitcnt vmcnt(11)
v_mfma_f32_16x16x32_bf16 v[48:51], a[16:19], v[108:111], v[48:51]
ds_read_b64_tr_b16 a[52:53], v7 offset:59296
ds_read_b64_tr_b16 a[54:55], v7 offset:59808
s_waitcnt lgkmcnt(15)
v_mfma_f32_16x16x32_bf16 v[36:39], a[20:23], v[104:107], v[36:39]
ds_read_b64_tr_b16 a[56:57], v7 offset:59328
ds_read_b64_tr_b16 a[58:59], v7 offset:59840
v_mfma_f32_16x16x32_bf16 v[52:55], a[20:23], v[108:111], v[52:55]
buffer_load_dwordx4 v[92:95], v4, s[16:19], s53 offen offset:1024 sc1
s_waitcnt lgkmcnt(15)
v_mfma_f32_16x16x32_bf16 v[40:43], a[24:27], v[104:107], v[40:43]
ds_read_b64_tr_b16 a[60:61], v7 offset:59360
s_add_u32 s53, s53, 0x40000
v_mfma_f32_16x16x32_bf16 v[56:59], a[24:27], v[108:111], v[56:59]
ds_read_b64_tr_b16 a[62:63], v7 offset:59872
s_waitcnt lgkmcnt(15)
v_mfma_f32_16x16x32_bf16 v[44:47], a[28:31], v[104:107], v[44:47]
v_mfma_f32_16x16x32_bf16 v[60:63], a[28:31], v[108:111], v[60:63]
s_xor_b32 s57, s57, 66560
v_add_u32 v7, s57, v8
s_waitcnt vmcnt(11) lgkmcnt(14)
v_mfma_f32_16x16x32_bf16 v[32:35], a[32:35], v[112:115], v[32:35]
ds_read_b64_tr_b16 a[0:1], v7
ds_read_b64_tr_b16 a[2:3], v7 offset:512
s_waitcnt vmcnt(10)
v_mfma_f32_16x16x32_bf16 v[48:51], a[32:35], v[116:119], v[48:51]
buffer_load_dwordx4 v[96:99], v4, s[16:19], s52 offen sc1
s_waitcnt lgkmcnt(14)
v_mfma_f32_16x16x32_bf16 v[36:39], a[36:39], v[112:115], v[36:39]
ds_read_b64_tr_b16 a[4:5], v7 offset:32
ds_read_b64_tr_b16 a[6:7], v7 offset:544
v_mfma_f32_16x16x32_bf16 v[52:55], a[36:39], v[116:119], v[52:55]
ds_read_b64_tr_b16 a[8:9], v7 offset:64
ds_read_b64_tr_b16 a[10:11], v7 offset:576
s_waitcnt lgkmcnt(15)
v_mfma_f32_16x16x32_bf16 v[40:43], a[40:43], v[112:115], v[40:43]
buffer_load_dwordx4 v[100:103], v4, s[16:19], s52 offen offset:1024 sc1
v_mfma_f32_16x16x32_bf16 v[56:59], a[40:43], v[116:119], v[56:59]
ds_read_b64_tr_b16 a[12:13], v7 offset:96
s_add_u32 s52, s52, 0x40000
s_waitcnt lgkmcnt(15)
v_mfma_f32_16x16x32_bf16 v[44:47], a[44:47], v[112:115], v[44:47]
ds_read_b64_tr_b16 a[14:15], v7 offset:608
v_mfma_f32_16x16x32_bf16 v[60:63], a[44:47], v[116:119], v[60:63]
ds_read_b64_tr_b16 a[16:17], v7 offset:1024
ds_read_b64_tr_b16 a[18:19], v7 offset:1536
s_waitcnt vmcnt(11) lgkmcnt(15)
v_mfma_f32_16x16x32_bf16 v[32:35], a[48:51], v[120:123], v[32:35]
buffer_load_dwordx4 v[104:107], v4, s[16:19], s53 offen sc1
s_waitcnt vmcnt(11)
v_mfma_f32_16x16x32_bf16 v[48:51], a[48:51], v[124:127], v[48:51]
ds_read_b64_tr_b16 a[20:21], v7 offset:1056
ds_read_b64_tr_b16 a[22:23], v7 offset:1568
s_waitcnt lgkmcnt(15)
v_mfma_f32_16x16x32_bf16 v[36:39], a[52:55], v[120:123], v[36:39]
ds_read_b64_tr_b16 a[24:25], v7 offset:1088
ds_read_b64_tr_b16 a[26:27], v7 offset:1600
v_mfma_f32_16x16x32_bf16 v[52:55], a[52:55], v[124:127], v[52:55]
buffer_load_dwordx4 v[108:111], v4, s[16:19], s53 offen offset:1024 sc1
s_waitcnt lgkmcnt(15)
v_mfma_f32_16x16x32_bf16 v[40:43], a[56:59], v[120:123], v[40:43]
ds_read_b64_tr_b16 a[28:29], v7 offset:1120
s_add_u32 s53, s53, 0x40000
v_mfma_f32_16x16x32_bf16 v[56:59], a[56:59], v[124:127], v[56:59]
ds_read_b64_tr_b16 a[30:31], v7 offset:1632
s_waitcnt lgkmcnt(15)
v_mfma_f32_16x16x32_bf16 v[44:47], a[60:63], v[120:123], v[44:47]
v_mfma_f32_16x16x32_bf16 v[60:63], a[60:63], v[124:127], v[60:63]
s_waitcnt vmcnt(11) lgkmcnt(14)
v_mfma_f32_16x16x32_bf16 v[32:35], a[0:3], v[64:67], v[32:35]
ds_read_b64_tr_b16 a[32:33], v7 offset:8320
ds_read_b64_tr_b16 a[34:35], v7 offset:8832
s_waitcnt vmcnt(10)
v_mfma_f32_16x16x32_bf16 v[48:51], a[0:3], v[68:71], v[48:51]
buffer_load_dwordx4 v[112:115], v4, s[16:19], s52 offen sc1
s_waitcnt lgkmcnt(14)
v_mfma_f32_16x16x32_bf16 v[36:39], a[4:7], v[64:67], v[36:39]
ds_read_b64_tr_b16 a[36:37], v7 offset:8352
ds_read_b64_tr_b16 a[38:39], v7 offset:8864
v_mfma_f32_16x16x32_bf16 v[52:55], a[4:7], v[68:71], v[52:55]
ds_read_b64_tr_b16 a[40:41], v7 offset:8384
ds_read_b64_tr_b16 a[42:43], v7 offset:8896
s_waitcnt lgkmcnt(15)
v_mfma_f32_16x16x32_bf16 v[40:43], a[8:11], v[64:67], v[40:43]
buffer_load_dwordx4 v[116:119], v4, s[16:19], s52 offen offset:1024 sc1
v_mfma_f32_16x16x32_bf16 v[56:59], a[8:11], v[68:71], v[56:59]
ds_read_b64_tr_b16 a[44:45], v7 offset:8416
s_add_u32 s52, s52, 0x40000
s_waitcnt lgkmcnt(15)
v_mfma_f32_16x16x32_bf16 v[44:47], a[12:15], v[64:67], v[44:47]
ds_read_b64_tr_b16 a[46:47], v7 offset:8928
v_mfma_f32_16x16x32_bf16 v[60:63], a[12:15], v[68:71], v[60:63]
ds_read_b64_tr_b16 a[48:49], v7 offset:9344
ds_read_b64_tr_b16 a[50:51], v7 offset:9856
s_waitcnt vmcnt(11) lgkmcnt(15)
v_mfma_f32_16x16x32_bf16 v[32:35], a[16:19], v[72:75], v[32:35]
buffer_load_dwordx4 v[120:123], v4, s[16:19], s53 offen sc1
s_waitcnt vmcnt(11)
v_mfma_f32_16x16x32_bf16 v[48:51], a[16:19], v[76:79], v[48:51]
ds_read_b64_tr_b16 a[52:53], v7 offset:9376
ds_read_b64_tr_b16 a[54:55], v7 offset:9888
s_waitcnt lgkmcnt(15)
v_mfma_f32_16x16x32_bf16 v[36:39], a[20:23], v[72:75], v[36:39]
ds_read_b64_tr_b16 a[56:57], v7 offset:9408
ds_read_b64_tr_b16 a[58:59], v7 offset:9920
v_mfma_f32_16x16x32_bf16 v[52:55], a[20:23], v[76:79], v[52:55]
buffer_load_dwordx4 v[124:127], v4, s[16:19], s53 offen offset:1024 sc1
s_waitcnt lgkmcnt(15)
v_mfma_f32_16x16x32_bf16 v[40:43], a[24:27], v[72:75], v[40:43]
ds_read_b64_tr_b16 a[60:61], v7 offset:9440
s_add_u32 s53, s53, 0x40000
v_mfma_f32_16x16x32_bf16 v[56:59], a[24:27], v[76:79], v[56:59]
ds_read_b64_tr_b16 a[62:63], v7 offset:9952
s_waitcnt lgkmcnt(15)
v_mfma_f32_16x16x32_bf16 v[44:47], a[28:31], v[72:75], v[44:47]
v_mfma_f32_16x16x32_bf16 v[60:63], a[28:31], v[76:79], v[60:63]
s_waitcnt vmcnt(11) lgkmcnt(14)
v_mfma_f32_16x16x32_bf16 v[32:35], a[32:35], v[80:83], v[32:35]
ds_read_b64_tr_b16 a[0:1], v7 offset:16640
ds_read_b64_tr_b16 a[2:3], v7 offset:17152
s_waitcnt vmcnt(10)
v_mfma_f32_16x16x32_bf16 v[48:51], a[32:35], v[84:87], v[48:51]
buffer_load_dwordx4 v[64:67], v4, s[16:19], s52 offen sc1
s_waitcnt lgkmcnt(14)
v_mfma_f32_16x16x32_bf16 v[36:39], a[36:39], v[80:83], v[36:39]
ds_read_b64_tr_b16 a[4:5], v7 offset:16672
ds_read_b64_tr_b16 a[6:7], v7 offset:17184
v_mfma_f32_16x16x32_bf16 v[52:55], a[36:39], v[84:87], v[52:55]
ds_read_b64_tr_b16 a[8:9], v7 offset:16704
ds_read_b64_tr_b16 a[10:11], v7 offset:17216
s_waitcnt lgkmcnt(15)
v_mfma_f32_16x16x32_bf16 v[40:43], a[40:43], v[80:83], v[40:43]
buffer_load_dwordx4 v[68:71], v4, s[16:19], s52 offen offset:1024 sc1
v_mfma_f32_16x16x32_bf16 v[56:59], a[40:43], v[84:87], v[56:59]
ds_read_b64_tr_b16 a[12:13], v7 offset:16736
s_add_u32 s52, s52, 0x40000
s_waitcnt lgkmcnt(15)
v_mfma_f32_16x16x32_bf16 v[44:47], a[44:47], v[80:83], v[44:47]
ds_read_b64_tr_b16 a[14:15], v7 offset:17248
v_mfma_f32_16x16x32_bf16 v[60:63], a[44:47], v[84:87], v[60:63]
ds_read_b64_tr_b16 a[16:17], v7 offset:17664
ds_read_b64_tr_b16 a[18:19], v7 offset:18176
s_waitcnt vmcnt(11) lgkmcnt(15)
v_mfma_f32_16x16x32_bf16 v[32:35], a[48:51], v[88:91], v[32:35]
buffer_load_dwordx4 v[72:75], v4, s[16:19], s53 offen sc1
s_waitcnt vmcnt(11)
v_mfma_f32_16x16x32_bf16 v[48:51], a[48:51], v[92:95], v[48:51]
ds_read_b64_tr_b16 a[20:21], v7 offset:17696
ds_read_b64_tr_b16 a[22:23], v7 offset:18208
s_waitcnt lgkmcnt(15)
v_mfma_f32_16x16x32_bf16 v[36:39], a[52:55], v[88:91], v[36:39]
ds_read_b64_tr_b16 a[24:25], v7 offset:17728
ds_read_b64_tr_b16 a[26:27], v7 offset:18240
v_mfma_f32_16x16x32_bf16 v[52:55], a[52:55], v[92:95], v[52:55]
buffer_load_dwordx4 v[76:79], v4, s[16:19], s53 offen offset:1024 sc1
s_waitcnt lgkmcnt(15)
v_mfma_f32_16x16x32_bf16 v[40:43], a[56:59], v[88:91], v[40:43]
ds_read_b64_tr_b16 a[28:29], v7 offset:17760
s_add_u32 s53, s53, 0x40000
v_mfma_f32_16x16x32_bf16 v[56:59], a[56:59], v[92:95], v[56:59]
ds_read_b64_tr_b16 a[30:31], v7 offset:18272
s_waitcnt lgkmcnt(15)
v_mfma_f32_16x16x32_bf16 v[44:47], a[60:63], v[88:91], v[44:47]
v_mfma_f32_16x16x32_bf16 v[60:63], a[60:63], v[92:95], v[60:63]
s_waitcnt vmcnt(11) lgkmcnt(14)
v_mfma_f32_16x16x32_bf16 v[32:35], a[0:3], v[96:99], v[32:35]
ds_read_b64_tr_b16 a[32:33], v7 offset:24960
ds_read_b64_tr_b16 a[34:35], v7 offset:25472
s_waitcnt vmcnt(10)
v_mfma_f32_16x16x32_bf16 v[48:51], a[0:3], v[100:103], v[48:51]
buffer_load_dwordx4 v[80:83], v4, s[16:19], s52 offen sc1
s_waitcnt lgkmcnt(14)
v_mfma_f32_16x16x32_bf16 v[36:39], a[4:7], v[96:99], v[36:39]
ds_read_b64_tr_b16 a[36:37], v7 offset:24992
ds_read_b64_tr_b16 a[38:39], v7 offset:25504
v_mfma_f32_16x16x32_bf16 v[52:55], a[4:7], v[100:103], v[52:55]
ds_read_b64_tr_b16 a[40:41], v7 offset:25024
ds_read_b64_tr_b16 a[42:43], v7 offset:25536
s_waitcnt lgkmcnt(15)
v_mfma_f32_16x16x32_bf16 v[40:43], a[8:11], v[96:99], v[40:43]
buffer_load_dwordx4 v[84:87], v4, s[16:19], s52 offen offset:1024 sc1
v_mfma_f32_16x16x32_bf16 v[56:59], a[8:11], v[100:103], v[56:59]
ds_read_b64_tr_b16 a[44:45], v7 offset:25056
s_add_u32 s52, s52, 0x40000
s_waitcnt lgkmcnt(15)
v_mfma_f32_16x16x32_bf16 v[44:47], a[12:15], v[96:99], v[44:47]
ds_read_b64_tr_b16 a[46:47], v7 offset:25568
v_mfma_f32_16x16x32_bf16 v[60:63], a[12:15], v[100:103], v[60:63]
ds_read_b64_tr_b16 a[48:49], v7 offset:25984
ds_read_b64_tr_b16 a[50:51], v7 offset:26496
s_waitcnt vmcnt(11) lgkmcnt(15)
v_mfma_f32_16x16x32_bf16 v[32:35], a[16:19], v[104:107], v[32:35]
buffer_load_dwordx4 v[88:91], v4, s[16:19], s53 offen sc1
s_waitcnt vmcnt(11)
v_mfma_f32_16x16x32_bf16 v[48:51], a[16:19], v[108:111], v[48:51]
ds_read_b64_tr_b16 a[52:53], v7 offset:26016
ds_read_b64_tr_b16 a[54:55], v7 offset:26528
s_waitcnt lgkmcnt(15)
v_mfma_f32_16x16x32_bf16 v[36:39], a[20:23], v[104:107], v[36:39]
ds_read_b64_tr_b16 a[56:57], v7 offset:26048
ds_read_b64_tr_b16 a[58:59], v7 offset:26560
v_mfma_f32_16x16x32_bf16 v[52:55], a[20:23], v[108:111], v[52:55]
buffer_load_dwordx4 v[92:95], v4, s[16:19], s53 offen offset:1024 sc1
s_waitcnt lgkmcnt(15)
v_mfma_f32_16x16x32_bf16 v[40:43], a[24:27], v[104:107], v[40:43]
ds_read_b64_tr_b16 a[60:61], v7 offset:26080
s_add_u32 s53, s53, 0x40000
v_mfma_f32_16x16x32_bf16 v[56:59], a[24:27], v[108:111], v[56:59]
ds_read_b64_tr_b16 a[62:63], v7 offset:26592
s_waitcnt lgkmcnt(15)
v_mfma_f32_16x16x32_bf16 v[44:47], a[28:31], v[104:107], v[44:47]
v_mfma_f32_16x16x32_bf16 v[60:63], a[28:31], v[108:111], v[60:63]
s_waitcnt lgkmcnt(0)
s_barrier
s_waitcnt vmcnt(11)
v_mfma_f32_16x16x32_bf16 v[32:35], a[32:35], v[112:115], v[32:35]
ds_read_b64_tr_b16 a[0:1], v7 offset:33280
ds_read_b64_tr_b16 a[2:3], v7 offset:33792
ds_read_b64_tr_b16 a[4:5], v7 offset:33312
s_waitcnt vmcnt(10)
v_mfma_f32_16x16x32_bf16 v[48:51], a[32:35], v[116:119], v[48:51]
ds_read_b64_tr_b16 a[6:7], v7 offset:33824
buffer_load_dwordx4 v[96:99], v4, s[16:19], s52 offen sc1
v_mfma_f32_16x16x32_bf16 v[36:39], a[36:39], v[112:115], v[36:39]
ds_read_b64_tr_b16 a[8:9], v7 offset:33344
buffer_load_dwordx4 v[100:103], v4, s[16:19], s52 offen offset:1024 sc1
v_mfma_f32_16x16x32_bf16 v[52:55], a[36:39], v[116:119], v[52:55]
ds_read_b64_tr_b16 a[10:11], v7 offset:33856
s_add_u32 s52, s52, 0x40000
v_mfma_f32_16x16x32_bf16 v[40:43], a[40:43], v[112:115], v[40:43]
ds_read_b64_tr_b16 a[12:13], v7 offset:33376
buffer_load_dwordx4 v[104:107], v4, s[16:19], s53 offen sc1
v_mfma_f32_16x16x32_bf16 v[56:59], a[40:43], v[116:119], v[56:59]
ds_read_b64_tr_b16 a[14:15], v7 offset:33888
ds_read_b64_tr_b16 a[16:17], v7 offset:34304
ds_read_b64_tr_b16 a[18:19], v7 offset:34816
v_mfma_f32_16x16x32_bf16 v[44:47], a[44:47], v[112:115], v[44:47]
ds_read_b64_tr_b16 a[20:21], v7 offset:34336
buffer_load_dwordx4 v[108:111], v4, s[16:19], s53 offen offset:1024 sc1
v_mfma_f32_16x16x32_bf16 v[60:63], a[44:47], v[116:119], v[60:63]
ds_read_b64_tr_b16 a[22:23], v7 offset:34848
s_add_u32 s53, s53, 0x40000
s_add_u32 m0, s59, 83200
s_waitcnt vmcnt(13)
v_mfma_f32_16x16x32_bf16 v[32:35], a[48:51], v[120:123], v[32:35]
ds_read_b64_tr_b16 a[24:25], v7 offset:34368
buffer_load_dwordx4 v12, s[32:35], s58 offen lds
s_waitcnt vmcnt(13)
v_mfma_f32_16x16x32_bf16 v[48:51], a[48:51], v[124:127], v[48:51]
ds_read_b64_tr_b16 a[26:27], v7 offset:34880
buffer_load_dwordx4 v13, s[32:35], s58 offen offset:1056 lds
v_mfma_f32_16x16x32_bf16 v[36:39], a[52:55], v[120:123], v[36:39]
ds_read_b64_tr_b16 a[28:29], v7 offset:34400
ds_read_b64_tr_b16 a[30:31], v7 offset:34912
v_mfma_f32_16x16x32_bf16 v[52:55], a[52:55], v[124:127], v[52:55]
buffer_load_dwordx4 v14, s[32:35], s58 offen offset:2112 lds
v_mfma_f32_16x16x32_bf16 v[40:43], a[56:59], v[120:123], v[40:43]
v_mfma_f32_16x16x32_bf16 v[56:59], a[56:59], v[124:127], v[56:59]
buffer_load_dwordx4 v15, s[32:35], s58 offen offset:3168 lds
v_mfma_f32_16x16x32_bf16 v[44:47], a[60:63], v[120:123], v[44:47]
s_add_u32 s58, s58, 229376
v_mfma_f32_16x16x32_bf16 v[60:63], a[60:63], v[124:127], v[60:63]
s_waitcnt vmcnt(15) lgkmcnt(14)
v_mfma_f32_16x16x32_bf16 v[32:35], a[0:3], v[64:67], v[32:35]
ds_read_b64_tr_b16 a[32:33], v7 offset:41600
ds_read_b64_tr_b16 a[34:35], v7 offset:42112
s_waitcnt vmcnt(14)
v_mfma_f32_16x16x32_bf16 v[48:51], a[0:3], v[68:71], v[48:51]
ds_read_b64_tr_b16 a[36:37], v7 offset:41632
buffer_load_dwordx4 v[112:115], v4, s[16:19], s52 offen sc1
s_waitcnt lgkmcnt(15)
v_mfma_f32_16x16x32_bf16 v[36:39], a[4:7], v[64:67], v[36:39]
ds_read_b64_tr_b16 a[38:39], v7 offset:42144
buffer_load_dwordx4 v[116:119], v4, s[16:19], s52 offen offset:1024 sc1
v_mfma_f32_16x16x32_bf16 v[52:55], a[4:7], v[68:71], v[52:55]
ds_read_b64_tr_b16 a[40:41], v7 offset:41664
ds_read_b64_tr_b16 a[42:43], v7 offset:42176
s_add_u32 s52, s52, 0x40000
s_waitcnt lgkmcnt(15)
v_mfma_f32_16x16x32_bf16 v[40:43], a[8:11], v[64:67], v[40:43]
buffer_load_dwordx4 v[120:123], v4, s[16:19], s53 offen sc1
v_mfma_f32_16x16x32_bf16 v[56:59], a[8:11], v[68:71], v[56:59]
ds_read_b64_tr_b16 a[44:45], v7 offset:41696
ds_read_b64_tr_b16 a[46:47], v7 offset:42208
s_waitcnt lgkmcnt(15)
v_mfma_f32_16x16x32_bf16 v[44:47], a[12:15], v[64:67], v[44:47]
ds_read_b64_tr_b16 a[48:49], v7 offset:42624
buffer_load_dwordx4 v[124:127], v4, s[16:19], s53 offen offset:1024 sc1
v_mfma_f32_16x16x32_bf16 v[60:63], a[12:15], v[68:71], v[60:63]
ds_read_b64_tr_b16 a[50:51], v7 offset:43136
s_add_u32 s53, s53, 0x40000
s_add_u32 m0, s59, 100096
s_waitcnt vmcnt(17) lgkmcnt(15)
v_mfma_f32_16x16x32_bf16 v[32:35], a[16:19], v[72:75], v[32:35]
ds_read_b64_tr_b16 a[52:53], v7 offset:42656
buffer_load_dwordx4 v12, s[32:35], s58 offen lds
s_waitcnt vmcnt(17)
v_mfma_f32_16x16x32_bf16 v[48:51], a[16:19], v[76:79], v[48:51]
buffer_load_dwordx4 v13, s[32:35], s58 offen offset:1056 lds
s_waitcnt lgkmcnt(15)
v_mfma_f32_16x16x32_bf16 v[36:39], a[20:23], v[72:75], v[36:39]
ds_read_b64_tr_b16 a[54:55], v7 offset:43168
ds_read_b64_tr_b16 a[56:57], v7 offset:42688
v_mfma_f32_16x16x32_bf16 v[52:55], a[20:23], v[76:79], v[52:55]
ds_read_b64_tr_b16 a[58:59], v7 offset:43200
buffer_load_dwordx4 v14, s[32:35], s58 offen offset:2112 lds
s_waitcnt lgkmcnt(15)
v_mfma_f32_16x16x32_bf16 v[40:43], a[24:27], v[72:75], v[40:43]
ds_read_b64_tr_b16 a[60:61], v7 offset:42720
ds_read_b64_tr_b16 a[62:63], v7 offset:43232
v_mfma_f32_16x16x32_bf16 v[56:59], a[24:27], v[76:79], v[56:59]
buffer_load_dwordx4 v15, s[32:35], s58 offen offset:3168 lds
s_waitcnt lgkmcnt(15)
v_mfma_f32_16x16x32_bf16 v[44:47], a[28:31], v[72:75], v[44:47]
s_add_u32 s58, s58, 229376
v_mfma_f32_16x16x32_bf16 v[60:63], a[28:31], v[76:79], v[60:63]
s_waitcnt vmcnt(19) lgkmcnt(14)
v_mfma_f32_16x16x32_bf16 v[32:35], a[32:35], v[80:83], v[32:35]
ds_read_b64_tr_b16 a[0:1], v7 offset:49920
s_add_u32 m0, s59, 116992
s_waitcnt vmcnt(18)
v_mfma_f32_16x16x32_bf16 v[48:51], a[32:35], v[84:87], v[48:51]
buffer_load_dwordx4 v12, s[32:35], s58 offen lds
s_waitcnt lgkmcnt(13)
v_mfma_f32_16x16x32_bf16 v[36:39], a[36:39], v[80:83], v[36:39]
ds_read_b64_tr_b16 a[2:3], v7 offset:50432
ds_read_b64_tr_b16 a[4:5], v7 offset:49952
v_mfma_f32_16x16x32_bf16 v[52:55], a[36:39], v[84:87], v[52:55]
ds_read_b64_tr_b16 a[6:7], v7 offset:50464
ds_read_b64_tr_b16 a[8:9], v7 offset:49984
s_waitcnt lgkmcnt(15)
v_mfma_f32_16x16x32_bf16 v[40:43], a[40:43], v[80:83], v[40:43]
buffer_load_dwordx4 v13, s[32:35], s58 offen offset:1056 lds
v_mfma_f32_16x16x32_bf16 v[56:59], a[40:43], v[84:87], v[56:59]
ds_read_b64_tr_b16 a[10:11], v7 offset:50496
ds_read_b64_tr_b16 a[12:13], v7 offset:50016
s_waitcnt lgkmcnt(15)
v_mfma_f32_16x16x32_bf16 v[44:47], a[44:47], v[80:83], v[44:47]
ds_read_b64_tr_b16 a[14:15], v7 offset:50528
v_mfma_f32_16x16x32_bf16 v[60:63], a[44:47], v[84:87], v[60:63]
ds_read_b64_tr_b16 a[16:17], v7 offset:50944
ds_read_b64_tr_b16 a[18:19], v7 offset:51456
s_waitcnt vmcnt(19) lgkmcnt(15)
v_mfma_f32_16x16x32_bf16 v[32:35], a[48:51], v[88:91], v[32:35]
buffer_load_dwordx4 v14, s[32:35], s58 offen offset:2112 lds
s_waitcnt vmcnt(19)
v_mfma_f32_16x16x32_bf16 v[48:51], a[48:51], v[92:95], v[48:51]
ds_read_b64_tr_b16 a[20:21], v7 offset:50976
ds_read_b64_tr_b16 a[22:23], v7 offset:51488
s_waitcnt lgkmcnt(15)
v_mfma_f32_16x16x32_bf16 v[36:39], a[52:55], v[88:91], v[36:39]
ds_read_b64_tr_b16 a[24:25], v7 offset:51008
ds_read_b64_tr_b16 a[26:27], v7 offset:51520
v_mfma_f32_16x16x32_bf16 v[52:55], a[52:55], v[92:95], v[52:55]
buffer_load_dwordx4 v15, s[32:35], s58 offen offset:3168 lds
s_waitcnt lgkmcnt(15)
v_mfma_f32_16x16x32_bf16 v[40:43], a[56:59], v[88:91], v[40:43]
ds_read_b64_tr_b16 a[28:29], v7 offset:51040
s_add_u32 s58, s58, 229376
v_mfma_f32_16x16x32_bf16 v[56:59], a[56:59], v[92:95], v[56:59]
ds_read_b64_tr_b16 a[30:31], v7 offset:51552
s_waitcnt lgkmcnt(15)
v_mfma_f32_16x16x32_bf16 v[44:47], a[60:63], v[88:91], v[44:47]
v_mfma_f32_16x16x32_bf16 v[60:63], a[60:63], v[92:95], v[60:63]
s_waitcnt vmcnt(19) lgkmcnt(14)
v_mfma_f32_16x16x32_bf16 v[32:35], a[0:3], v[96:99], v[32:35]
ds_read_b64_tr_b16 a[32:33], v7 offset:58240
s_add_u32 m0, s59, 133888
s_waitcnt vmcnt(18)
v_mfma_f32_16x16x32_bf16 v[48:51], a[0:3], v[100:103], v[48:51]
buffer_load_dwordx4 v12, s[32:35], s58 offen lds
s_waitcnt lgkmcnt(13)
v_mfma_f32_16x16x32_bf16 v[36:39], a[4:7], v[96:99], v[36:39]
ds_read_b64_tr_b16 a[34:35], v7 offset:58752
ds_read_b64_tr_b16 a[36:37], v7 offset:58272
v_mfma_f32_16x16x32_bf16 v[52:55], a[4:7], v[100:103], v[52:55]
ds_read_b64_tr_b16 a[38:39], v7 offset:58784
ds_read_b64_tr_b16 a[40:41], v7 offset:58304
s_waitcnt lgkmcnt(15)
v_mfma_f32_16x16x32_bf16 v[40:43], a[8:11], v[96:99], v[40:43]
buffer_load_dwordx4 v13, s[32:35], s58 offen offset:1056 lds
v_mfma_f32_16x16x32_bf16 v[56:59], a[8:11], v[100:103], v[56:59]
ds_read_b64_tr_b16 a[42:43], v7 offset:58816
ds_read_b64_tr_b16 a[44:45], v7 offset:58336
s_waitcnt lgkmcnt(15)
v_mfma_f32_16x16x32_bf16 v[44:47], a[12:15], v[96:99], v[44:47]
ds_read_b64_tr_b16 a[46:47], v7 offset:58848
v_mfma_f32_16x16x32_bf16 v[60:63], a[12:15], v[100:103], v[60:63]
ds_read_b64_tr_b16 a[48:49], v7 offset:59264
ds_read_b64_tr_b16 a[50:51], v7 offset:59776
s_waitcnt vmcnt(19) lgkmcnt(15)
v_mfma_f32_16x16x32_bf16 v[32:35], a[16:19], v[104:107], v[32:35]
buffer_load_dwordx4 v14, s[32:35], s58 offen offset:2112 lds
s_waitcnt vmcnt(19)
v_mfma_f32_16x16x32_bf16 v[48:51], a[16:19], v[108:111], v[48:51]
ds_read_b64_tr_b16 a[52:53], v7 offset:59296
ds_read_b64_tr_b16 a[54:55], v7 offset:59808
.Lpad24:
s_cbranch_execz .Lnopoll38r
s_waitcnt lgkmcnt(15)
v_mfma_f32_16x16x32_bf16 v[36:39], a[20:23], v[104:107], v[36:39]
ds_read_b64_tr_b16 a[56:57], v7 offset:59328
ds_read_b64_tr_b16 a[58:59], v7 offset:59840
v_mfma_f32_16x16x32_bf16 v[52:55], a[20:23], v[108:111], v[52:55]
buffer_load_dwordx4 v15, s[32:35], s58 offen offset:3168 lds
s_waitcnt lgkmcnt(15)
v_mfma_f32_16x16x32_bf16 v[40:43], a[24:27], v[104:107], v[40:43]
ds_read_b64_tr_b16 a[60:61], v7 offset:59360
s_add_u32 s58, s58, 229376
v_mfma_f32_16x16x32_bf16 v[56:59], a[24:27], v[108:111], v[56:59]
ds_read_b64_tr_b16 a[62:63], v7 offset:59872
s_waitcnt lgkmcnt(15)
v_mfma_f32_16x16x32_bf16 v[44:47], a[28:31], v[104:107], v[44:47]
v_mfma_f32_16x16x32_bf16 v[60:63], a[28:31], v[108:111], v[60:63]
s_waitcnt vmcnt(15) lgkmcnt(14)
v_mfma_f32_16x16x32_bf16 v[32:35], a[32:35], v[112:115], v[32:35]
s_lshl_b32 s64, s6, 14
s_lshl_b32 s65, s49, 13
s_add_u32 s64, s64, s65
s_waitcnt vmcnt(14)
v_mfma_f32_16x16x32_bf16 v[48:51], a[32:35], v[116:119], v[48:51]
s_lshl_b32 s65, s7, 9
s_add_u32 s64, s64, s65
s_lshl_b32 s65, s48, 8
s_waitcnt lgkmcnt(12)
v_mfma_f32_16x16x32_bf16 v[36:39], a[36:39], v[112:115], v[36:39]
s_add_u32 s64, s64, s65
s_add_u32 s64, s64, 63176704
v_and_b32 v152, 31, v1
v_mfma_f32_16x16x32_bf16 v[52:55], a[36:39], v[116:119], v[52:55]
s_lshl_b32 s62, s7, 18
v_lshlrev_b32 v152, 3, v152
v_lshrrev_b32 v153, 5, v1
s_waitcnt lgkmcnt(10)
v_mfma_f32_16x16x32_bf16 v[40:43], a[40:43], v[112:115], v[40:43]
s_add_u32 s62, s62, 41943040
v_lshl_add_u32 v152, v153, 2, v152
s_add_u32 s63, s62, 0x20000
v_mfma_f32_16x16x32_bf16 v[56:59], a[40:43], v[116:119], v[56:59]
s_waitcnt lgkmcnt(8)
v_mfma_f32_16x16x32_bf16 v[44:47], a[44:47], v[112:115], v[44:47]
v_mfma_f32_16x16x32_bf16 v[60:63], a[44:47], v[116:119], v[60:63]
s_waitcnt vmcnt(13) lgkmcnt(6)
v_mfma_f32_16x16x32_bf16 v[32:35], a[48:51], v[120:123], v[32:35]
s_waitcnt vmcnt(12)
v_mfma_f32_16x16x32_bf16 v[48:51], a[48:51], v[124:127], v[48:51]
s_waitcnt lgkmcnt(4)
v_mfma_f32_16x16x32_bf16 v[36:39], a[52:55], v[120:123], v[36:39]
s_nop 3
v_cvt_pk_bf16_f32 v128, v32, v33
v_cvt_pk_bf16_f32 v129, v34, v35
v_mfma_f32_16x16x32_bf16 v[52:55], a[52:55], v[124:127], v[52:55]
v_cvt_pk_bf16_f32 v136, v48, v49
v_cvt_pk_bf16_f32 v137, v50, v51
s_waitcnt lgkmcnt(2)
v_mfma_f32_16x16x32_bf16 v[40:43], a[56:59], v[120:123], v[40:43]
v_cvt_pk_bf16_f32 v130, v36, v37
v_cvt_pk_bf16_f32 v131, v38, v39
v_mfma_f32_16x16x32_bf16 v[56:59], a[56:59], v[124:127], v[56:59]
buffer_store_dwordx4 v[128:131], v4, s[16:19], s62 offen sc1
s_waitcnt lgkmcnt(0)
v_mfma_f32_16x16x32_bf16 v[44:47], a[60:63], v[120:123], v[44:47]
s_nop 1
v_cvt_pk_bf16_f32 v132, v40, v41
v_cvt_pk_bf16_f32 v133, v42, v43
v_mfma_f32_16x16x32_bf16 v[60:63], a[60:63], v[124:127], v[60:63]
v_cvt_pk_bf16_f32 v138, v52, v53
v_cvt_pk_bf16_f32 v139, v54, v55
v_cvt_pk_bf16_f32 v140, v56, v57
v_cvt_pk_bf16_f32 v134, v44, v45
v_cvt_pk_bf16_f32 v135, v46, v47
v_cvt_pk_bf16_f32 v141, v58, v59
v_pk_mul_f32 v[146:147], v[32:33], v[32:33]
buffer_store_dwordx4 v[132:135], v4, s[16:19], s63 offen sc1
v_cvt_pk_bf16_f32 v142, v60, v61
v_cvt_pk_bf16_f32 v143, v62, v63
v_pk_mul_f32 v[150:151], v[48:49], v[48:49]
v_pk_fma_f32 v[146:147], v[34:35], v[34:35], v[146:147]
v_pk_add_f32 v[144:145], v[32:33], v[34:35]
v_pk_fma_f32 v[150:151], v[50:51], v[50:51], v[150:151]
v_pk_add_f32 v[148:149], v[48:49], v[50:51]
v_pk_fma_f32 v[146:147], v[36:37], v[36:37], v[146:147]
v_pk_add_f32 v[144:145], v[144:145], v[36:37]
v_pk_fma_f32 v[150:151], v[52:53], v[52:53], v[150:151]
v_pk_add_f32 v[148:149], v[148:149], v[52:53]
v_pk_fma_f32 v[146:147], v[38:39], v[38:39], v[146:147]
v_pk_add_f32 v[144:145], v[144:145], v[38:39]
buffer_store_dwordx4 v[136:139], v4, s[16:19], s62 offen offset:1024 sc1
v_pk_fma_f32 v[150:151], v[54:55], v[54:55], v[150:151]
v_pk_add_f32 v[148:149], v[148:149], v[54:55]
v_pk_fma_f32 v[146:147], v[40:41], v[40:41], v[146:147]
v_pk_add_f32 v[144:145], v[144:145], v[40:41]
v_pk_fma_f32 v[150:151], v[56:57], v[56:57], v[150:151]
v_pk_add_f32 v[148:149], v[148:149], v[56:57]
v_pk_fma_f32 v[146:147], v[42:43], v[42:43], v[146:147]
v_pk_add_f32 v[144:145], v[144:145], v[42:43]
v_pk_fma_f32 v[150:151], v[58:59], v[58:59], v[150:151]
v_pk_add_f32 v[148:149], v[148:149], v[58:59]
v_pk_fma_f32 v[146:147], v[44:45], v[44:45], v[146:147]
v_pk_add_f32 v[144:145], v[144:145], v[44:45]
v_pk_fma_f32 v[150:151], v[60:61], v[60:61], v[150:151]
buffer_store_dwordx4 v[140:143], v4, s[16:19], s63 offen offset:1024 sc1
v_pk_add_f32 v[148:149], v[148:149], v[60:61]
v_pk_fma_f32 v[146:147], v[46:47], v[46:47], v[146:147]
v_pk_add_f32 v[144:145], v[144:145], v[46:47]
v_pk_fma_f32 v[150:151], v[62:63], v[62:63], v[150:151]
v_pk_add_f32 v[148:149], v[148:149], v[62:63]
v_add_f32 v144, v144, v145
v_add_f32 v146, v146, v147
v_add_f32 v148, v148, v149
v_add_f32 v150, v150, v151
s_nop 0
v_permlane16_swap_b32 v144, v148
v_permlane16_swap_b32 v146, v150
v_add_f32 v144, v144, v148
v_add_f32 v146, v146, v150
s_nop 1
v_permlane32_swap_b32 v144, v146
v_add_f32 v144, v144, v146
buffer_store_dword v144, v152, s[16:19], s64 offen sc1
s_nop 1
v_accvgpr_write_b32 a224, v32
v_accvgpr_write_b32 a225, v33
v_accvgpr_write_b32 a226, v34
v_accvgpr_write_b32 a227, v35
v_accvgpr_write_b32 a228, v36
v_accvgpr_write_b32 a229, v37
v_accvgpr_write_b32 a230, v38
v_accvgpr_write_b32 a231, v39
v_accvgpr_write_b32 a232, v40
v_accvgpr_write_b32 a233, v41
v_accvgpr_write_b32 a234, v42
v_accvgpr_write_b32 a235, v43
v_accvgpr_write_b32 a236, v44
v_accvgpr_write_b32 a237, v45
v_accvgpr_write_b32 a238, v46
v_accvgpr_write_b32 a239, v47
v_accvgpr_write_b32 a240, v48
v_accvgpr_write_b32 a241, v49
v_accvgpr_write_b32 a242, v50
v_accvgpr_write_b32 a243, v51
v_accvgpr_write_b32 a244, v52
v_accvgpr_write_b32 a245, v53
v_accvgpr_write_b32 a246, v54
v_accvgpr_write_b32 a247, v55
v_accvgpr_write_b32 a248, v56
v_accvgpr_write_b32 a249, v57
v_accvgpr_write_b32 a250, v58
v_accvgpr_write_b32 a251, v59
v_accvgpr_write_b32 a252, v60
v_accvgpr_write_b32 a253, v61
v_accvgpr_write_b32 a254, v62
v_accvgpr_write_b32 a255, v63
s_lshl_b32 s62, s10, 14
s_lshl_b32 s63, s3, 12
s_add_u32 s62, s62, s63
s_lshl_b32 s63, s12, 11
s_add_u32 s62, s62, s63
v_lshl_add_u32 v10, v1, 4, s62
v_lshrrev_b32 v2, 3, v1
v_cmp_eq_u32 vcc, 3, v2
v_add_u32 v2, 67108480, v10
s_nop 0
v_cndmask_b32 v10, v10, v2, vcc
v_xor_b32 v11, 2048, v10
v_bfe_u32 v16, v1, 2, 3
v_mul_u32_u24 v16, 1056, v16
v_bfe_u32 v2, v1, 5, 1
v_lshl_add_u32 v16, v2, 8, v16
v_and_b32 v2, 3, v1
v_lshl_add_u32 v16, v2, 3, v16
s_lshl_b32 s62, s12, 6
s_add_u32 s62, s62, 83200
s_xor_b32 s63, s12, 1
s_mul_i32 s63, s63, 192
s_add_u32 s63, s63, 83200
v_add_u32 v17, s63, v16
v_add_u32 v16, s62, v16
s_mov_b32 s52, 41943040
s_mov_b32 s54, s58
s_mov_b32 s55, s59
s_mul_i32 s59, s3, 2080
s_lshl_b32 s62, s10, 15
s_lshl_b32 s63, s3, 13
s_add_u32 s62, s62, s63
v_lshl_add_u32 v4, v1, 4, s62
s_lshl_b32 s62, s6, 7
s_add_u32 s62, s62, 30420992
s_lshl_b32 s64, s10, 1
s_lshl_b32 s64, s64, 7
s_add_u32 s64, s64, 30420992
s_add_u32 s65, s64, 128
v_mov_b32 v252, s62
v_mov_b32 v253, s64
v_writelane_b32 v253, s65, 1
s_waitcnt vmcnt(0) lgkmcnt(0)
s_barrier
s_cmp_lg_u32 s3, 0
s_cbranch_scc1 .Lnosig39
v_mov_b32 v255, 1
s_mov_b64 exec, 1
buffer_atomic_add v255, v252, s[16:19], 0 offen
s_mov_b64 exec, -1
.Lnosig39:
ds_read_b64_tr_b16 a[0:1], v16
ds_read_b64_tr_b16 a[2:3], v16 offset:512
ds_read_b64_tr_b16 a[4:5], v16 offset:32
ds_read_b64_tr_b16 a[6:7], v16 offset:544
ds_read_b64_tr_b16 a[8:9], v16 offset:8448
ds_read_b64_tr_b16 a[10:11], v16 offset:8960
ds_read_b64_tr_b16 a[12:13], v16 offset:8480
ds_read_b64_tr_b16 a[14:15], v16 offset:8992
ds_read_b64_tr_b16 a[16:17], v16 offset:64
ds_read_b64_tr_b16 a[18:19], v16 offset:576
ds_read_b64_tr_b16 a[20:21], v16 offset:96
ds_read_b64_tr_b16 a[22:23], v16 offset:608
ds_read_b64_tr_b16 a[24:25], v16 offset:8512
ds_read_b64_tr_b16 a[26:27], v16 offset:9024
ds_read_b64_tr_b16 a[28:29], v16 offset:8544
ds_read_b64_tr_b16 a[30:31], v16 offset:9056
ds_read_b64_tr_b16 a[32:33], v16 offset:128
ds_read_b64_tr_b16 a[34:35], v16 offset:640
ds_read_b64_tr_b16 a[36:37], v16 offset:160
ds_read_b64_tr_b16 a[38:39], v16 offset:672
ds_read_b64_tr_b16 a[40:41], v16 offset:8576
ds_read_b64_tr_b16 a[42:43], v16 offset:9088
ds_read_b64_tr_b16 a[44:45], v16 offset:8608
ds_read_b64_tr_b16 a[46:47], v16 offset:9120
ds_read_b64_tr_b16 a[48:49], v17
ds_read_b64_tr_b16 a[50:51], v17 offset:512
ds_read_b64_tr_b16 a[52:53], v17 offset:32
ds_read_b64_tr_b16 a[54:55], v17 offset:544
ds_read_b64_tr_b16 a[56:57], v17 offset:8448
ds_read_b64_tr_b16 a[58:59], v17 offset:8960
ds_read_b64_tr_b16 a[60:61], v17 offset:8480
ds_read_b64_tr_b16 a[62:63], v17 offset:8992
s_waitcnt lgkmcnt(0)
s_cmp_lg_u32 s3, 1
s_cbranch_scc1 .Lnopoll42
s_mov_b64 exec, 3
s_mov_b32 s15, 0
.Lpoll40:
buffer_load_dword v255, v253, s[16:19], 0 offen sc1
s_add_u32 s15, s15, 1
s_cmp_gt_u32 s15, 100000
s_cbranch_scc1 .Lgot41
s_waitcnt vmcnt(0)
v_cmp_ne_u32 vcc, 16, v255
s_nop 0
s_cbranch_vccnz .Lpoll40
.Lgot41:
s_waitcnt vmcnt(0)
s_branch .Lnopoll42r
.Lnopoll42:
s_mov_b64 exec, 0
s_cmp_eq_u32 s3, 2
s_cbranch_scc1 .Lpad25
s_cmp_eq_u32 s3, 3
s_cbranch_scc1 .Lpad26
s_branch .Lpad27
.Lnopoll42r:
s_mov_b64 exec, -1
s_barrier
buffer_load_dwordx4 a[128:131], v10, s[16:19], s52 offen sc1
buffer_load_dwordx4 a[132:135], v10, s[16:19], s52 offen offset:1024 sc1
buffer_load_dwordx4 a[136:139], v11, s[16:19], s52 offen sc1
buffer_load_dwordx4 a[140:143], v11, s[16:19], s52 offen offset:1024 sc1
s_add_u32 s52, s52, 0x20000
buffer_load_dwordx4 a[144:147], v10, s[16:19], s52 offen sc1
buffer_load_dwordx4 a[148:151], v10, s[16:19], s52 offen offset:1024 sc1
buffer_load_dwordx4 a[152:155], v11, s[16:19], s52 offen sc1
buffer_load_dwordx4 a[156:159], v11, s[16:19], s52 offen offset:1024 sc1
s_add_u32 s52, s52, 0x20000
s_lshl_b32 s74, s3, 13
s_add_u32 s74, s74, 49920
v_lshl_add_u32 v2, v1, 4, s74
s_waitcnt vmcnt(7)
v_mfma_f32_16x16x32_bf16 v[32:35], a[0:3], a[128:131], 0
ds_read_b64_tr_b16 a[64:65], v16 offset:16896
s_waitcnt vmcnt(6)
v_mfma_f32_16x16x32_bf16 v[36:39], a[0:3], a[132:135], 0
buffer_load_dwordx4 a[160:163], v10, s[16:19], s52 offen sc1
s_waitcnt vmcnt(6)
v_mfma_f32_16x16x32_bf16 v[40:43], a[0:3], a[136:139], 0
ds_read_b64_tr_b16 a[66:67], v16 offset:17408
s_waitcnt vmcnt(5)
v_mfma_f32_16x16x32_bf16 v[44:47], a[0:3], a[140:143], 0
ds_read_b64_tr_b16 a[68:69], v16 offset:16928
v_mfma_f32_16x16x32_bf16 v[48:51], a[4:7], a[128:131], 0
ds_read_b64_tr_b16 a[70:71], v16 offset:17440
v_mfma_f32_16x16x32_bf16 v[52:55], a[4:7], a[132:135], 0
buffer_load_dwordx4 a[164:167], v10, s[16:19], s52 offen offset:1024 sc1
v_mfma_f32_16x16x32_bf16 v[56:59], a[4:7], a[136:139], 0
ds_read_b64_tr_b16 a[72:73], v16 offset:25344
v_mfma_f32_16x16x32_bf16 v[60:63], a[4:7], a[140:143], 0
v_mfma_f32_16x16x32_bf16 v[64:67], a[8:11], a[128:131], 0
ds_read_b64_tr_b16 a[74:75], v16 offset:25856
v_mfma_f32_16x16x32_bf16 v[68:71], a[8:11], a[132:135], 0
ds_read_b64_tr_b16 a[76:77], v16 offset:25376
v_mfma_f32_16x16x32_bf16 v[72:75], a[8:11], a[136:139], 0
buffer_load_dwordx4 a[168:171], v11, s[16:19], s52 offen sc1
v_mfma_f32_16x16x32_bf16 v[76:79], a[8:11], a[140:143], 0
ds_read_b64_tr_b16 a[78:79], v16 offset:25888
v_mfma_f32_16x16x32_bf16 v[80:83], a[12:15], a[128:131], 0
ds_read_b64_tr_b16 a[80:81], v16 offset:16960
v_mfma_f32_16x16x32_bf16 v[84:87], a[12:15], a[132:135], 0
ds_read_b64_tr_b16 a[82:83], v16 offset:17472
v_mfma_f32_16x16x32_bf16 v[88:91], a[12:15], a[136:139], 0
buffer_load_dwordx4 a[172:175], v11, s[16:19], s52 offen offset:1024 sc1
v_mfma_f32_16x16x32_bf16 v[92:95], a[12:15], a[140:143], 0
s_add_u32 s52, s52, 0x20000
v_mfma_f32_16x16x32_bf16 v[96:99], a[16:19], a[128:131], 0
ds_read_b64_tr_b16 a[84:85], v16 offset:16992
v_mfma_f32_16x16x32_bf16 v[100:103], a[16:19], a[132:135], 0
ds_read_b64_tr_b16 a[86:87], v16 offset:17504
v_mfma_f32_16x16x32_bf16 v[104:107], a[16:19], a[136:139], 0
ds_read_b64_tr_b16 a[88:89], v16 offset:25408
s_add_u32 m0, s55, 83200
v_mfma_f32_16x16x32_bf16 v[108:111], a[16:19], a[140:143], 0
buffer_load_dwordx4 v12, s[32:35], s54 offen lds
v_mfma_f32_16x16x32_bf16 v[112:115], a[20:23], a[128:131], 0
ds_read_b64_tr_b16 a[90:91], v16 offset:25920
v_mfma_f32_16x16x32_bf16 v[116:119], a[20:23], a[132:135], 0
v_mfma_f32_16x16x32_bf16 v[120:123], a[20:23], a[136:139], 0
ds_read_b64_tr_b16 a[92:93], v16 offset:25440
v_mfma_f32_16x16x32_bf16 v[124:127], a[20:23], a[140:143], 0
buffer_load_dwordx4 a[176:179], v10, s[16:19], s52 offen sc1
v_mfma_f32_16x16x32_bf16 v[128:131], a[24:27], a[128:131], 0
ds_read_b64_tr_b16 a[94:95], v16 offset:25952
v_mfma_f32_16x16x32_bf16 v[132:135], a[24:27], a[132:135], 0
ds_read_b64_tr_b16 a[96:97], v16 offset:17024
v_mfma_f32_16x16x32_bf16 v[136:139], a[24:27], a[136:139], 0
ds_read_b64_tr_b16 a[98:99], v16 offset:17536
v_mfma_f32_16x16x32_bf16 v[140:143], a[24:27], a[140:143], 0
ds_read_b64_tr_b16 a[100:101], v16 offset:17056
v_mfma_f32_16x16x32_bf16 v[144:147], a[28:31], a[128:131], 0
buffer_load_dwordx4 v13, s[32:35], s54 offen offset:1056 lds
v_mfma_f32_16x16x32_bf16 v[148:151], a[28:31], a[132:135], 0
v_mfma_f32_16x16x32_bf16 v[152:155], a[28:31], a[136:139], 0
ds_read_b64_tr_b16 a[102:103], v16 offset:17568
v_mfma_f32_16x16x32_bf16 v[156:159], a[28:31], a[140:143], 0
ds_read_b64_tr_b16 a[104:105], v16 offset:25472
v_mfma_f32_16x16x32_bf16 v[160:163], a[32:35], a[128:131], 0
buffer_load_dwordx4 a[180:183], v10, s[16:19], s52 offen offset:1024 sc1
v_mfma_f32_16x16x32_bf16 v[164:167], a[32:35], a[132:135], 0
ds_read_b64_tr_b16 a[106:107], v16 offset:25984
v_mfma_f32_16x16x32_bf16 v[168:171], a[32:35], a[136:139], 0
ds_read_b64_tr_b16 a[108:109], v16 offset:25504
v_mfma_f32_16x16x32_bf16 v[172:175], a[32:35], a[140:143], 0
v_mfma_f32_16x16x32_bf16 v[176:179], a[36:39], a[128:131], 0
ds_read_b64_tr_b16 a[110:111], v16 offset:26016
v_mfma_f32_16x16x32_bf16 v[180:183], a[36:39], a[132:135], 0
buffer_load_dwordx4 v14, s[32:35], s54 offen offset:2112 lds
v_mfma_f32_16x16x32_bf16 v[184:187], a[36:39], a[136:139], 0
ds_read_b64_tr_b16 a[112:113], v17 offset:16896
v_mfma_f32_16x16x32_bf16 v[188:191], a[36:39], a[140:143], 0
ds_read_b64_tr_b16 a[114:115], v17 offset:17408
v_mfma_f32_16x16x32_bf16 v[192:195], a[40:43], a[128:131], 0
ds_read_b64_tr_b16 a[116:117], v17 offset:16928
v_mfma_f32_16x16x32_bf16 v[196:199], a[40:43], a[132:135], 0
buffer_load_dwordx4 a[184:187], v11, s[16:19], s52 offen sc1
v_mfma_f32_16x16x32_bf16 v[200:203], a[40:43], a[136:139], 0
ds_read_b64_tr_b16 a[118:119], v17 offset:17440
v_mfma_f32_16x16x32_bf16 v[204:207], a[40:43], a[140:143], 0
v_mfma_f32_16x16x32_bf16 v[208:211], a[44:47], a[128:131], 0
ds_read_b64_tr_b16 a[120:121], v17 offset:25344
v_mfma_f32_16x16x32_bf16 v[212:215], a[44:47], a[132:135], 0
ds_read_b64_tr_b16 a[122:123], v17 offset:25856
v_mfma_f32_16x16x32_bf16 v[216:219], a[44:47], a[136:139], 0
buffer_load_dwordx4 v15, s[32:35], s54 offen offset:3168 lds
v_mfma_f32_16x16x32_bf16 v[220:223], a[44:47], a[140:143], 0
ds_read_b64_tr_b16 a[124:125], v17 offset:25376
s_add_u32 s54, s54, 229376
v_mfma_f32_16x16x32_bf16 v[224:227], a[48:51], a[128:131], 0
ds_read_b64_tr_b16 a[126:127], v17 offset:25888
v_mfma_f32_16x16x32_bf16 v[228:231], a[48:51], a[132:135], 0
v_mfma_f32_16x16x32_bf16 v[232:235], a[52:55], a[128:131], 0
buffer_load_dwordx4 a[188:191], v11, s[16:19], s52 offen offset:1024 sc1
v_mfma_f32_16x16x32_bf16 v[236:239], a[52:55], a[132:135], 0
s_add_u32 s52, s52, 0x20000
v_mfma_f32_16x16x32_bf16 v[240:243], a[56:59], a[128:131], 0
v_mfma_f32_16x16x32_bf16 v[244:247], a[56:59], a[132:135], 0
v_mfma_f32_16x16x32_bf16 v[248:251], a[60:63], a[128:131], 0
v_mfma_f32_16x16x32_bf16 v[252:255], a[60:63], a[132:135], 0
s_waitcnt lgkmcnt(0)
s_barrier
s_waitcnt vmcnt(15)
v_mfma_f32_16x16x32_bf16 v[32:35], a[64:67], a[144:147], v[32:35]
s_add_u32 m0, s74, 0
s_mov_b32 s67, 63176704
s_waitcnt vmcnt(14)
v_mfma_f32_16x16x32_bf16 v[36:39], a[64:67], a[148:151], v[36:39]
buffer_load_dwordx4 v4, s[16:19], s67 offen sc1 lds
s_waitcnt vmcnt(14)
v_mfma_f32_16x16x32_bf16 v[40:43], a[64:67], a[152:155], v[40:43]
ds_read_b64_tr_b16 a[0:1], v16 offset:33792
s_waitcnt vmcnt(13)
v_mfma_f32_16x16x32_bf16 v[44:47], a[64:67], a[156:159], v[44:47]
ds_read_b64_tr_b16 a[2:3], v16 offset:34304
v_mfma_f32_16x16x32_bf16 v[48:51], a[68:71], a[144:147], v[48:51]
buffer_load_dwordx4 v4, s[16:19], s67 offen offset:1024 sc1 lds
v_mfma_f32_16x16x32_bf16 v[52:55], a[68:71], a[148:151], v[52:55]
ds_read_b64_tr_b16 a[4:5], v16 offset:33824
v_mfma_f32_16x16x32_bf16 v[56:59], a[68:71], a[152:155], v[56:59]
ds_read_b64_tr_b16 a[6:7], v16 offset:34336
v_mfma_f32_16x16x32_bf16 v[60:63], a[68:71], a[156:159], v[60:63]
buffer_load_dwordx4 v4, s[16:19], s67 offen offset:2048 sc1 lds
v_mfma_f32_16x16x32_bf16 v[64:67], a[72:75], a[144:147], v[64:67]
ds_read_b64_tr_b16 a[8:9], v16 offset:42240
v_mfma_f32_16x16x32_bf16 v[68:71], a[72:75], a[148:151], v[68:71]
ds_read_b64_tr_b16 a[10:11], v16 offset:42752
v_mfma_f32_16x16x32_bf16 v[72:75], a[72:75], a[152:155], v[72:75]
ds_read_b64_tr_b16 a[12:13], v16 offset:42272
v_mfma_f32_16x16x32_bf16 v[76:79], a[72:75], a[156:159], v[76:79]
buffer_load_dwordx4 v4, s[16:19], s67 offen offset:3072 sc1 lds
v_mfma_f32_16x16x32_bf16 v[80:83], a[76:79], a[144:147], v[80:83]
ds_read_b64_tr_b16 a[14:15], v16 offset:42784
v_mfma_f32_16x16x32_bf16 v[84:87], a[76:79], a[148:151], v[84:87]
s_add_u32 m0, s74, 4096
s_mov_b32 s67, 63180800
v_mfma_f32_16x16x32_bf16 v[88:91], a[76:79], a[152:155], v[88:91]
buffer_load_dwordx4 v4, s[16:19], s67 offen sc1 lds
v_mfma_f32_16x16x32_bf16 v[92:95], a[76:79], a[156:159], v[92:95]
ds_read_b64_tr_b16 a[16:17], v16 offset:33856
v_mfma_f32_16x16x32_bf16 v[96:99], a[80:83], a[144:147], v[96:99]
ds_read_b64_tr_b16 a[18:19], v16 offset:34368
v_mfma_f32_16x16x32_bf16 v[100:103], a[80:83], a[148:151], v[100:103]
buffer_load_dwordx4 v4, s[16:19], s67 offen offset:1024 sc1 lds
v_mfma_f32_16x16x32_bf16 v[104:107], a[80:83], a[152:155], v[104:107]
ds_read_b64_tr_b16 a[20:21], v16 offset:33888
v_mfma_f32_16x16x32_bf16 v[108:111], a[80:83], a[156:159], v[108:111]
ds_read_b64_tr_b16 a[22:23], v16 offset:34400
v_mfma_f32_16x16x32_bf16 v[112:115], a[84:87], a[144:147], v[112:115]
ds_read_b64_tr_b16 a[24:25], v16 offset:42304
v_mfma_f32_16x16x32_bf16 v[116:119], a[84:87], a[148:151], v[116:119]
buffer_load_dwordx4 v4, s[16:19], s67 offen offset:2048 sc1 lds
v_mfma_f32_16x16x32_bf16 v[120:123], a[84:87], a[152:155], v[120:123]
ds_read_b64_tr_b16 a[26:27], v16 offset:42816
v_mfma_f32_16x16x32_bf16 v[124:127], a[84:87], a[156:159], v[124:127]
ds_read_b64_tr_b16 a[28:29], v16 offset:42336
v_mfma_f32_16x16x32_bf16 v[128:131], a[88:91], a[144:147], v[128:131]
buffer_load_dwordx4 v4, s[16:19], s67 offen offset:3072 sc1 lds
v_mfma_f32_16x16x32_bf16 v[132:135], a[88:91], a[148:151], v[132:135]
ds_read_b64_tr_b16 a[30:31], v16 offset:42848
v_mfma_f32_16x16x32_bf16 v[136:139], a[88:91], a[152:155], v[136:139]
v_mfma_f32_16x16x32_bf16 v[140:143], a[88:91], a[156:159], v[140:143]
ds_read_b64_tr_b16 a[32:33], v16 offset:33920
s_add_u32 m0, s55, 100096
v_mfma_f32_16x16x32_bf16 v[144:147], a[92:95], a[144:147], v[144:147]
buffer_load_dwordx4 v12, s[32:35], s54 offen lds
v_mfma_f32_16x16x32_bf16 v[148:151], a[92:95], a[148:151], v[148:151]
ds_read_b64_tr_b16 a[34:35], v16 offset:34432
v_mfma_f32_16x16x32_bf16 v[152:155], a[92:95], a[152:155], v[152:155]
ds_read_b64_tr_b16 a[36:37], v16 offset:33952
v_mfma_f32_16x16x32_bf16 v[156:159], a[92:95], a[156:159], v[156:159]
buffer_load_dwordx4 a[128:131], v10, s[16:19], s52 offen sc1
v_mfma_f32_16x16x32_bf16 v[160:163], a[96:99], a[144:147], v[160:163]
ds_read_b64_tr_b16 a[38:39], v16 offset:34464
v_mfma_f32_16x16x32_bf16 v[164:167], a[96:99], a[148:151], v[164:167]
ds_read_b64_tr_b16 a[40:41], v16 offset:42368
v_mfma_f32_16x16x32_bf16 v[168:171], a[96:99], a[152:155], v[168:171]
buffer_load_dwordx4 v13, s[32:35], s54 offen offset:1056 lds
v_mfma_f32_16x16x32_bf16 v[172:175], a[96:99], a[156:159], v[172:175]
ds_read_b64_tr_b16 a[42:43], v16 offset:42880
v_mfma_f32_16x16x32_bf16 v[176:179], a[100:103], a[144:147], v[176:179]
ds_read_b64_tr_b16 a[44:45], v16 offset:42400
v_mfma_f32_16x16x32_bf16 v[180:183], a[100:103], a[148:151], v[180:183]
ds_read_b64_tr_b16 a[46:47], v16 offset:42912
v_mfma_f32_16x16x32_bf16 v[184:187], a[100:103], a[152:155], v[184:187]
buffer_load_dwordx4 a[132:135], v10, s[16:19], s52 offen offset:1024 sc1
v_mfma_f32_16x16x32_bf16 v[188:191], a[100:103], a[156:159], v[188:191]
ds_read_b64_tr_b16 a[48:49], v17 offset:33792
v_mfma_f32_16x16x32_bf16 v[192:195], a[104:107], a[144:147], v[192:195]
ds_read_b64_tr_b16 a[50:51], v17 offset:34304
v_mfma_f32_16x16x32_bf16 v[196:199], a[104:107], a[148:151], v[196:199]
buffer_load_dwordx4 v14, s[32:35], s54 offen offset:2112 lds
v_mfma_f32_16x16x32_bf16 v[200:203], a[104:107], a[152:155], v[200:203]
ds_read_b64_tr_b16 a[52:53], v17 offset:33824
v_mfma_f32_16x16x32_bf16 v[204:207], a[104:107], a[156:159], v[204:207]
ds_read_b64_tr_b16 a[54:55], v17 offset:34336
v_mfma_f32_16x16x32_bf16 v[208:211], a[108:111], a[144:147], v[208:211]
buffer_load_dwordx4 a[136:139], v11, s[16:19], s52 offen sc1
v_mfma_f32_16x16x32_bf16 v[212:215], a[108:111], a[148:151], v[212:215]
ds_read_b64_tr_b16 a[56:57], v17 offset:42240
v_mfma_f32_16x16x32_bf16 v[216:219], a[108:111], a[152:155], v[216:219]
ds_read_b64_tr_b16 a[58:59], v17 offset:42752
v_mfma_f32_16x16x32_bf16 v[220:223], a[108:111], a[156:159], v[220:223]
ds_read_b64_tr_b16 a[60:61], v17 offset:42272
v_mfma_f32_16x16x32_bf16 v[224:227], a[112:115], a[144:147], v[224:227]
buffer_load_dwordx4 v15, s[32:35], s54 offen offset:3168 lds
v_mfma_f32_16x16x32_bf16 v[228:231], a[112:115], a[148:151], v[228:231]
ds_read_b64_tr_b16 a[62:63], v17 offset:42784
s_add_u32 s54, s54, 229376
v_mfma_f32_16x16x32_bf16 v[232:235], a[116:119], a[144:147], v[232:235]
v_mfma_f32_16x16x32_bf16 v[236:239], a[116:119], a[148:151], v[236:239]
buffer_load_dwordx4 a[140:143], v11, s[16:19], s52 offen offset:1024 sc1
v_mfma_f32_16x16x32_bf16 v[240:243], a[120:123], a[144:147], v[240:243]
s_add_u32 s52, s52, 0x20000
v_mfma_f32_16x16x32_bf16 v[244:247], a[120:123], a[148:151], v[244:247]
v_mfma_f32_16x16x32_bf16 v[248:251], a[124:127], a[144:147], v[248:251]
v_mfma_f32_16x16x32_bf16 v[252:255], a[124:127], a[148:151], v[252:255]
s_waitcnt lgkmcnt(0)
s_barrier
s_waitcnt vmcnt(27)
v_mfma_f32_16x16x32_bf16 v[32:35], a[0:3], a[160:163], v[32:35]
ds_read_b64_tr_b16 a[64:65], v16 offset:50688
s_add_u32 m0, s55, 116992
s_waitcnt vmcnt(26)
v_mfma_f32_16x16x32_bf16 v[36:39], a[0:3], a[164:167], v[36:39]
buffer_load_dwordx4 v12, s[32:35], s54 offen lds
s_waitcnt vmcnt(26)
v_mfma_f32_16x16x32_bf16 v[40:43], a[0:3], a[168:171], v[40:43]
ds_read_b64_tr_b16 a[66:67], v16 offset:51200
s_waitcnt vmcnt(25)
v_mfma_f32_16x16x32_bf16 v[44:47], a[0:3], a[172:175], v[44:47]
ds_read_b64_tr_b16 a[68:69], v16 offset:50720
v_mfma_f32_16x16x32_bf16 v[48:51], a[4:7], a[160:163], v[48:51]
v_mfma_f32_16x16x32_bf16 v[52:55], a[4:7], a[164:167], v[52:55]
ds_read_b64_tr_b16 a[70:71], v16 offset:51232
v_mfma_f32_16x16x32_bf16 v[56:59], a[4:7], a[168:171], v[56:59]
ds_read_b64_tr_b16 a[72:73], v16 offset:59136
v_mfma_f32_16x16x32_bf16 v[60:63], a[4:7], a[172:175], v[60:63]
buffer_load_dwordx4 a[144:147], v10, s[16:19], s52 offen sc1
v_mfma_f32_16x16x32_bf16 v[64:67], a[8:11], a[160:163], v[64:67]
ds_read_b64_tr_b16 a[74:75], v16 offset:59648
v_mfma_f32_16x16x32_bf16 v[68:71], a[8:11], a[164:167], v[68:71]
v_mfma_f32_16x16x32_bf16 v[72:75], a[8:11], a[168:171], v[72:75]
ds_read_b64_tr_b16 a[76:77], v16 offset:59168
v_mfma_f32_16x16x32_bf16 v[76:79], a[8:11], a[172:175], v[76:79]
ds_read_b64_tr_b16 a[78:79], v16 offset:59680
v_mfma_f32_16x16x32_bf16 v[80:83], a[12:15], a[160:163], v[80:83]
ds_read_b64_tr_b16 a[80:81], v16 offset:50752
s_waitcnt vmcnt(10)
ds_read_b128 v[20:23], v2
v_mfma_f32_16x16x32_bf16 v[84:87], a[12:15], a[164:167], v[84:87]
ds_read_b128 v[28:31], v2 offset:1024
v_mfma_f32_16x16x32_bf16 v[88:91], a[12:15], a[168:171], v[88:91]
buffer_load_dwordx4 v13, s[32:35], s54 offen offset:1056 lds
v_mfma_f32_16x16x32_bf16 v[92:95], a[12:15], a[172:175], v[92:95]
ds_read_b64_tr_b16 a[82:83], v16 offset:51264
v_mfma_f32_16x16x32_bf16 v[96:99], a[16:19], a[160:163], v[96:99]
ds_read_b64_tr_b16 a[84:85], v16 offset:50784
v_mfma_f32_16x16x32_bf16 v[100:103], a[16:19], a[164:167], v[100:103]
ds_read_b64_tr_b16 a[86:87], v16 offset:51296
ds_read_b128 v[24:27], v2 offset:2048
v_mfma_f32_16x16x32_bf16 v[104:107], a[16:19], a[168:171], v[104:107]
v_mfma_f32_16x16x32_bf16 v[108:111], a[16:19], a[172:175], v[108:111]
ds_read_b64_tr_b16 a[88:89], v16 offset:59200
s_waitcnt lgkmcnt(5)
v_add_f32 v20, v20, v28
v_mfma_f32_16x16x32_bf16 v[112:115], a[20:23], a[160:163], v[112:115]
ds_read_b64_tr_b16 a[90:91], v16 offset:59712
v_mfma_f32_16x16x32_bf16 v[116:119], a[20:23], a[164:167], v[116:119]
buffer_load_dwordx4 a[148:151], v10, s[16:19], s52 offen offset:1024 sc1
v_mfma_f32_16x16x32_bf16 v[120:123], a[20:23], a[168:171], v[120:123]
ds_read_b64_tr_b16 a[92:93], v16 offset:59232
v_add_f32 v21, v21, v29
v_mfma_f32_16x16x32_bf16 v[124:127], a[20:23], a[172:175], v[124:127]
v_mfma_f32_16x16x32_bf16 v[128:131], a[24:27], a[160:163], v[128:131]
ds_read_b64_tr_b16 a[94:95], v16 offset:59744
v_add_f32 v22, v22, v30
v_mfma_f32_16x16x32_bf16 v[132:135], a[24:27], a[164:167], v[132:135]
ds_read_b64_tr_b16 a[96:97], v16 offset:50816
v_mfma_f32_16x16x32_bf16 v[136:139], a[24:27], a[168:171], v[136:139]
ds_read_b64_tr_b16 a[98:99], v16 offset:51328
v_mfma_f32_16x16x32_bf16 v[140:143], a[24:27], a[172:175], v[140:143]
v_add_f32 v23, v23, v31
v_mfma_f32_16x16x32_bf16 v[144:147], a[28:31], a[160:163], v[144:147]
buffer_load_dwordx4 v14, s[32:35], s54 offen offset:2112 lds
v_mfma_f32_16x16x32_bf16 v[148:151], a[28:31], a[164:167], v[148:151]
ds_read_b64_tr_b16 a[100:101], v16 offset:50848
v_mfma_f32_16x16x32_bf16 v[152:155], a[28:31], a[168:171], v[152:155]
ds_read_b64_tr_b16 a[102:103], v16 offset:51360
.Lpad25:
s_cbranch_execz .Lpad28
ds_read_b128 v[28:31], v2 offset:3072
v_mfma_f32_16x16x32_bf16 v[156:159], a[28:31], a[172:175], v[156:159]
ds_read_b64_tr_b16 a[104:105], v16 offset:59264
v_mfma_f32_16x16x32_bf16 v[160:163], a[32:35], a[160:163], v[160:163]
s_waitcnt lgkmcnt(10)
v_add_f32 v20, v20, v24
v_mfma_f32_16x16x32_bf16 v[164:167], a[32:35], a[164:167], v[164:167]
ds_read_b64_tr_b16 a[106:107], v16 offset:59776
v_mfma_f32_16x16x32_bf16 v[168:171], a[32:35], a[168:171], v[168:171]
buffer_load_dwordx4 a[152:155], v11, s[16:19], s52 offen sc1
v_mfma_f32_16x16x32_bf16 v[172:175], a[32:35], a[172:175], v[172:175]
ds_read_b64_tr_b16 a[108:109], v16 offset:59296
v_add_f32 v21, v21, v25
v_mfma_f32_16x16x32_bf16 v[176:179], a[36:39], a[160:163], v[176:179]
ds_read_b64_tr_b16 a[110:111], v16 offset:59808
v_mfma_f32_16x16x32_bf16 v[180:183], a[36:39], a[164:167], v[180:183]
v_add_f32 v22, v22, v26
v_mfma_f32_16x16x32_bf16 v[184:187], a[36:39], a[168:171], v[184:187]
ds_read_b64_tr_b16 a[112:113], v17 offset:50688
v_mfma_f32_16x16x32_bf16 v[188:191], a[36:39], a[172:175], v[188:191]
ds_read_b64_tr_b16 a[114:115], v17 offset:51200
v_add_f32 v23, v23, v27
v_mfma_f32_16x16x32_bf16 v[192:195], a[40:43], a[160:163], v[192:195]
ds_read_b64_tr_b16 a[116:117], v17 offset:50720
v_mfma_f32_16x16x32_bf16 v[196:199], a[40:43], a[164:167], v[196:199]
buffer_load_dwordx4 v15, s[32:35], s54 offen offset:3168 lds
v_mfma_f32_16x16x32_bf16 v[200:203], a[40:43], a[168:171], v[200:203]
s_add_u32 s54, s54, 229376
ds_read_b128 v[24:27], v2 offset:4096
v_mfma_f32_16x16x32_bf16 v[204:207], a[40:43], a[172:175], v[204:207]
ds_read_b64_tr_b16 a[118:119], v17 offset:51232
v_mfma_f32_16x16x32_bf16 v[208:211], a[44:47], a[160:163], v[208:211]
ds_read_b64_tr_b16 a[120:121], v17 offset:59136
v_mfma_f32_16x16x32_bf16 v[212:215], a[44:47], a[164:167], v[212:215]
ds_read_b64_tr_b16 a[122:123], v17 offset:59648
s_waitcnt lgkmcnt(11)
v_add_f32 v20, v20, v28
v_mfma_f32_16x16x32_bf16 v[216:219], a[44:47], a[168:171], v[216:219]
v_mfma_f32_16x16x32_bf16 v[220:223], a[44:47], a[172:175], v[220:223]
ds_read_b64_tr_b16 a[124:125], v17 offset:59168
v_add_f32 v21, v21, v29
v_mfma_f32_16x16x32_bf16 v[224:227], a[48:51], a[160:163], v[224:227]
buffer_load_dwordx4 a[156:159], v11, s[16:19], s52 offen offset:1024 sc1
v_mfma_f32_16x16x32_bf16 v[228:231], a[48:51], a[164:167], v[228:231]
ds_read_b64_tr_b16 a[126:127], v17 offset:59680
s_add_u32 s52, s52, 0x20000
v_mfma_f32_16x16x32_bf16 v[232:235], a[52:55], a[160:163], v[232:235]
v_add_f32 v22, v22, v30
v_mfma_f32_16x16x32_bf16 v[236:239], a[52:55], a[164:167], v[236:239]
v_mfma_f32_16x16x32_bf16 v[240:243], a[56:59], a[160:163], v[240:243]
v_add_f32 v23, v23, v31
v_mfma_f32_16x16x32_bf16 v[244:247], a[56:59], a[164:167], v[244:247]
ds_read_b128 v[28:31], v2 offset:5120
v_mfma_f32_16x16x32_bf16 v[248:251], a[60:63], a[160:163], v[248:251]
v_mfma_f32_16x16x32_bf16 v[252:255], a[60:63], a[164:167], v[252:255]
s_waitcnt lgkmcnt(0)
s_barrier
v_mfma_f32_16x16x32_bf16 v[32:35], a[64:67], a[176:179], v[32:35]
ds_read_b64_tr_b16 a[0:1], v16
s_add_u32 m0, s55, 133888
v_mfma_f32_16x16x32_bf16 v[36:39], a[64:67], a[180:183], v[36:39]
buffer_load_dwordx4 v12, s[32:35], s54 offen lds
v_mfma_f32_16x16x32_bf16 v[40:43], a[64:67], a[184:187], v[40:43]
ds_read_b64_tr_b16 a[2:3], v16 offset:512
v_add_f32 v20, v20, v24
v_mfma_f32_16x16x32_bf16 v[44:47], a[64:67], a[188:191], v[44:47]
ds_read_b64_tr_b16 a[4:5], v16 offset:32
v_add_f32 v21, v21, v25
v_mfma_f32_16x16x32_bf16 v[48:51], a[68:71], a[176:179], v[48:51]
v_add_f32 v22, v22, v26
v_mfma_f32_16x16x32_bf16 v[52:55], a[68:71], a[180:183], v[52:55]
ds_read_b64_tr_b16 a[6:7], v16 offset:544
v_add_f32 v23, v23, v27
v_mfma_f32_16x16x32_bf16 v[56:59], a[68:71], a[184:187], v[56:59]
ds_read_b64_tr_b16 a[8:9], v16 offset:8448
v_mfma_f32_16x16x32_bf16 v[60:63], a[68:71], a[188:191], v[60:63]
buffer_load_dwordx4 a[160:163], v10, s[16:19], s52 offen sc1
v_mfma_f32_16x16x32_bf16 v[64:67], a[72:75], a[176:179], v[64:67]
ds_read_b64_tr_b16 a[10:11], v16 offset:8960
ds_read_b128 v[24:27], v2 offset:6144
v_mfma_f32_16x16x32_bf16 v[68:71], a[72:75], a[180:183], v[68:71]
v_add_f32 v20, v20, v28
v_mfma_f32_16x16x32_bf16 v[72:75], a[72:75], a[184:187], v[72:75]
ds_read_b64_tr_b16 a[12:13], v16 offset:8480
v_add_f32 v21, v21, v29
v_mfma_f32_16x16x32_bf16 v[76:79], a[72:75], a[188:191], v[76:79]
ds_read_b64_tr_b16 a[14:15], v16 offset:8992
v_mfma_f32_16x16x32_bf16 v[80:83], a[76:79], a[176:179], v[80:83]
ds_read_b64_tr_b16 a[16:17], v16 offset:64
v_add_f32 v22, v22, v30
v_mfma_f32_16x16x32_bf16 v[84:87], a[76:79], a[180:183], v[84:87]
v_add_f32 v23, v23, v31
v_mfma_f32_16x16x32_bf16 v[88:91], a[76:79], a[184:187], v[88:91]
buffer_load_dwordx4 v13, s[32:35], s54 offen offset:1056 lds
v_mfma_f32_16x16x32_bf16 v[92:95], a[76:79], a[188:191], v[92:95]
ds_read_b64_tr_b16 a[18:19], v16 offset:576
ds_read_b128 v[28:31], v2 offset:7168
v_mfma_f32_16x16x32_bf16 v[96:99], a[80:83], a[176:179], v[96:99]
ds_read_b64_tr_b16 a[20:21], v16 offset:96
v_mfma_f32_16x16x32_bf16 v[100:103], a[80:83], a[180:183], v[100:103]
ds_read_b64_tr_b16 a[22:23], v16 offset:608
s_waitcnt lgkmcnt(7)
v_add_f32 v20, v20, v24
v_mfma_f32_16x16x32_bf16 v[104:107], a[80:83], a[184:187], v[104:107]
v_add_f32 v21, v21, v25
v_mfma_f32_16x16x32_bf16 v[108:111], a[80:83], a[188:191], v[108:111]
ds_read_b64_tr_b16 a[24:25], v16 offset:8512
v_add_f32 v22, v22, v26
v_mfma_f32_16x16x32_bf16 v[112:115], a[84:87], a[176:179], v[112:115]
ds_read_b64_tr_b16 a[26:27], v16 offset:9024
v_mfma_f32_16x16x32_bf16 v[116:119], a[84:87], a[180:183], v[116:119]
buffer_load_dwordx4 a[164:167], v10, s[16:19], s52 offen offset:1024 sc1
v_mfma_f32_16x16x32_bf16 v[120:123], a[84:87], a[184:187], v[120:123]
ds_read_b64_tr_b16 a[28:29], v16 offset:8544
v_add_f32 v23, v23, v27
v_mfma_f32_16x16x32_bf16 v[124:127], a[84:87], a[188:191], v[124:127]
s_waitcnt lgkmcnt(5)
v_add_f32 v20, v20, v28
v_mfma_f32_16x16x32_bf16 v[128:131], a[88:91], a[176:179], v[128:131]
ds_read_b64_tr_b16 a[30:31], v16 offset:9056
v_add_f32 v21, v21, v29
v_mfma_f32_16x16x32_bf16 v[132:135], a[88:91], a[180:183], v[132:135]
ds_read_b64_tr_b16 a[32:33], v16 offset:128
v_add_f32 v22, v22, v30
v_mfma_f32_16x16x32_bf16 v[136:139], a[88:91], a[184:187], v[136:139]
ds_read_b64_tr_b16 a[34:35], v16 offset:640
v_mfma_f32_16x16x32_bf16 v[140:143], a[88:91], a[188:191], v[140:143]
v_add_f32 v23, v23, v31
v_mfma_f32_16x16x32_bf16 v[144:147], a[92:95], a[176:179], v[144:147]
buffer_load_dwordx4 v14, s[32:35], s54 offen offset:2112 lds
v_mfma_f32_16x16x32_bf16 v[148:151], a[92:95], a[180:183], v[148:151]
ds_read_b64_tr_b16 a[36:37], v16 offset:160
v_permlane32_swap_b32 v20, v22
v_mfma_f32_16x16x32_bf16 v[152:155], a[92:95], a[184:187], v[152:155]
ds_read_b64_tr_b16 a[38:39], v16 offset:672
v_permlane32_swap_b32 v21, v23
v_mfma_f32_16x16x32_bf16 v[156:159], a[92:95], a[188:191], v[156:159]
ds_read_b64_tr_b16 a[40:41], v16 offset:8576
v_mfma_f32_16x16x32_bf16 v[160:163], a[96:99], a[176:179], v[160:163]
v_add_f32 v20, v20, v22
v_mfma_f32_16x16x32_bf16 v[164:167], a[96:99], a[180:183], v[164:167]
ds_read_b64_tr_b16 a[42:43], v16 offset:9088
v_add_f32 v21, v21, v23
v_mfma_f32_16x16x32_bf16 v[168:171], a[96:99], a[184:187], v[168:171]
buffer_load_dwordx4 a[168:171], v11, s[16:19], s52 offen sc1
v_mfma_f32_16x16x32_bf16 v[172:175], a[96:99], a[188:191], v[172:175]
ds_read_b64_tr_b16 a[44:45], v16 offset:8608
v_mul_f32 v20, 0xba800000, v20
v_mfma_f32_16x16x32_bf16 v[176:179], a[100:103], a[176:179], v[176:179]
ds_read_b64_tr_b16 a[46:47], v16 offset:9120
v_mfma_f32_16x16x32_bf16 v[180:183], a[100:103], a[180:183], v[180:183]
v_mul_f32 v21, 0x3a800000, v21
v_fma_f32 v21, -v20, v20, v21
v_mfma_f32_16x16x32_bf16 v[184:187], a[100:103], a[184:187], v[184:187]
ds_read_b64_tr_b16 a[48:49], v17
v_mfma_f32_16x16x32_bf16 v[188:191], a[100:103], a[188:191], v[188:191]
ds_read_b64_tr_b16 a[50:51], v17 offset:512
v_max_f32 v21, 0, v21
v_mfma_f32_16x16x32_bf16 v[192:195], a[104:107], a[176:179], v[192:195]
ds_read_b64_tr_b16 a[52:53], v17 offset:32
v_mfma_f32_16x16x32_bf16 v[196:199], a[104:107], a[180:183], v[196:199]
buffer_load_dwordx4 v15, s[32:35], s54 offen offset:3168 lds
v_mfma_f32_16x16x32_bf16 v[200:203], a[104:107], a[184:187], v[200:203]
s_add_u32 s54, s54, 229376
v_add_f32 v21, 0x3727c5ac, v21
v_rsq_f32 v22, v21
v_mfma_f32_16x16x32_bf16 v[204:207], a[104:107], a[188:191], v[204:207]
ds_read_b64_tr_b16 a[54:55], v17 offset:544
v_mfma_f32_16x16x32_bf16 v[208:211], a[108:111], a[176:179], v[208:211]
ds_read_b64_tr_b16 a[56:57], v17 offset:8448
v_and_b32 v24, 31, v1
v_mfma_f32_16x16x32_bf16 v[212:215], a[108:111], a[180:183], v[212:215]
ds_read_b64_tr_b16 a[58:59], v17 offset:8960
v_mfma_f32_16x16x32_bf16 v[216:219], a[108:111], a[184:187], v[216:219]
v_lshrrev_b32 v25, 5, v1
v_lshl_add_u32 v24, v24, 1, v25
v_mfma_f32_16x16x32_bf16 v[220:223], a[108:111], a[188:191], v[220:223]
ds_read_b64_tr_b16 a[60:61], v17 offset:8480
v_mfma_f32_16x16x32_bf16 v[224:227], a[112:115], a[176:179], v[224:227]
buffer_load_dwordx4 a[172:175], v11, s[16:19], s52 offen offset:1024 sc1
v_mfma_f32_16x16x32_bf16 v[228:231], a[112:115], a[180:183], v[228:231]
ds_read_b64_tr_b16 a[62:63], v17 offset:8992
s_add_u32 s52, s52, 0x20000
v_mfma_f32_16x16x32_bf16 v[232:235], a[116:119], a[176:179], v[232:235]
v_and_b32 v25, 0xc0, v0
v_add_u32 v24, v24, v25
v_mfma_f32_16x16x32_bf16 v[236:239], a[116:119], a[180:183], v[236:239]
v_lshlrev_b32 v24, 4, v24
v_mfma_f32_16x16x32_bf16 v[240:243], a[120:123], a[176:179], v[240:243]
v_add_u32 v24, 151552, v24
v_mfma_f32_16x16x32_bf16 v[244:247], a[120:123], a[180:183], v[244:247]
v_mul_f32 v22, 0xbfb8aa3b, v22
v_mfma_f32_16x16x32_bf16 v[248:251], a[124:127], a[176:179], v[248:251]
ds_write_b128 v24, v[20:23]
v_mfma_f32_16x16x32_bf16 v[252:255], a[124:127], a[180:183], v[252:255]
s_mov_b32 s58, 0
s_mov_b32 s67, s59
s_add_u32 s74, s59, 74880
s_mov_b32 s15, 6
.p2align 6
.Lk43:
s_waitcnt vmcnt(17) lgkmcnt(0)
s_barrier
v_mfma_f32_16x16x32_bf16 v[32:35], a[0:3], a[128:131], v[32:35]
ds_read_b64_tr_b16 a[64:65], v16 offset:16896
s_add_u32 m0, s55, 83200
v_mfma_f32_16x16x32_bf16 v[36:39], a[0:3], a[132:135], v[36:39]
buffer_load_dwordx4 v12, s[32:35], s54 offen lds
v_mfma_f32_16x16x32_bf16 v[40:43], a[0:3], a[136:139], v[40:43]
ds_read_b64_tr_b16 a[66:67], v16 offset:17408
s_waitcnt vmcnt(17)
v_mfma_f32_16x16x32_bf16 v[44:47], a[0:3], a[140:143], v[44:47]
ds_read_b64_tr_b16 a[68:69], v16 offset:16928
v_mfma_f32_16x16x32_bf16 v[48:51], a[4:7], a[128:131], v[48:51]
ds_read_b64_tr_b16 a[70:71], v16 offset:17440
v_mfma_f32_16x16x32_bf16 v[52:55], a[4:7], a[132:135], v[52:55]
v_mfma_f32_16x16x32_bf16 v[56:59], a[4:7], a[136:139], v[56:59]
ds_read_b64_tr_b16 a[72:73], v16 offset:25344
v_mfma_f32_16x16x32_bf16 v[60:63], a[4:7], a[140:143], v[60:63]
buffer_load_dwordx4 a[176:179], v10, s[16:19], s52 offen sc1
v_mfma_f32_16x16x32_bf16 v[64:67], a[8:11], a[128:131], v[64:67]
ds_read_b64_tr_b16 a[74:75], v16 offset:25856
v_mfma_f32_16x16x32_bf16 v[68:71], a[8:11], a[132:135], v[68:71]
ds_read_b64_tr_b16 a[76:77], v16 offset:25376
v_mfma_f32_16x16x32_bf16 v[72:75], a[8:11], a[136:139], v[72:75]
v_mfma_f32_16x16x32_bf16 v[76:79], a[8:11], a[140:143], v[76:79]
ds_read_b64_tr_b16 a[78:79], v16 offset:25888
v_mfma_f32_16x16x32_bf16 v[80:83], a[12:15], a[128:131], v[80:83]
ds_read_b64_tr_b16 a[80:81], v16 offset:16960
v_mfma_f32_16x16x32_bf16 v[84:87], a[12:15], a[132:135], v[84:87]
buffer_load_dwordx4 v13, s[32:35], s54 offen offset:1056 lds
v_mfma_f32_16x16x32_bf16 v[88:91], a[12:15], a[136:139], v[88:91]
ds_read_b64_tr_b16 a[82:83], v16 offset:17472
v_mfma_f32_16x16x32_bf16 v[92:95], a[12:15], a[140:143], v[92:95]
v_mfma_f32_16x16x32_bf16 v[96:99], a[16:19], a[128:131], v[96:99]
ds_read_b64_tr_b16 a[84:85], v16 offset:16992
v_mfma_f32_16x16x32_bf16 v[100:103], a[16:19], a[132:135], v[100:103]
ds_read_b64_tr_b16 a[86:87], v16 offset:17504
v_mfma_f32_16x16x32_bf16 v[104:107], a[16:19], a[136:139], v[104:107]
ds_read_b64_tr_b16 a[88:89], v16 offset:25408
v_mfma_f32_16x16x32_bf16 v[108:111], a[16:19], a[140:143], v[108:111]
buffer_load_dwordx4 a[180:183], v10, s[16:19], s52 offen offset:1024 sc1
v_mfma_f32_16x16x32_bf16 v[112:115], a[20:23], a[128:131], v[112:115]
v_mfma_f32_16x16x32_bf16 v[116:119], a[20:23], a[132:135], v[116:119]
ds_read_b64_tr_b16 a[90:91], v16 offset:25920
v_mfma_f32_16x16x32_bf16 v[120:123], a[20:23], a[136:139], v[120:123]
ds_read_b64_tr_b16 a[92:93], v16 offset:25440
v_mfma_f32_16x16x32_bf16 v[124:127], a[20:23], a[140:143], v[124:127]
ds_read_b64_tr_b16 a[94:95], v16 offset:25952
v_mfma_f32_16x16x32_bf16 v[128:131], a[24:27], a[128:131], v[128:131]
v_mfma_f32_16x16x32_bf16 v[132:135], a[24:27], a[132:135], v[132:135]
buffer_load_dwordx4 v14, s[32:35], s54 offen offset:2112 lds
v_mfma_f32_16x16x32_bf16 v[136:139], a[24:27], a[136:139], v[136:139]
ds_read_b64_tr_b16 a[96:97], v16 offset:17024
v_mfma_f32_16x16x32_bf16 v[140:143], a[24:27], a[140:143], v[140:143]
ds_read_b64_tr_b16 a[98:99], v16 offset:17536
v_mfma_f32_16x16x32_bf16 v[144:147], a[28:31], a[128:131], v[144:147]
ds_read_b64_tr_b16 a[100:101], v16 offset:17056
v_mfma_f32_16x16x32_bf16 v[148:151], a[28:31], a[132:135], v[148:151]
ds_read_b64_tr_b16 a[102:103], v16 offset:17568
v_mfma_f32_16x16x32_bf16 v[152:155], a[28:31], a[136:139], v[152:155]
v_mfma_f32_16x16x32_bf16 v[156:159], a[28:31], a[140:143], v[156:159]
buffer_load_dwordx4 a[184:187], v11, s[16:19], s52 offen sc1
v_mfma_f32_16x16x32_bf16 v[160:163], a[32:35], a[128:131], v[160:163]
ds_read_b64_tr_b16 a[104:105], v16 offset:25472
v_mfma_f32_16x16x32_bf16 v[164:167], a[32:35], a[132:135], v[164:167]
ds_read_b64_tr_b16 a[106:107], v16 offset:25984
v_mfma_f32_16x16x32_bf16 v[168:171], a[32:35], a[136:139], v[168:171]
ds_read_b64_tr_b16 a[108:109], v16 offset:25504
v_mfma_f32_16x16x32_bf16 v[172:175], a[32:35], a[140:143], v[172:175]
v_mfma_f32_16x16x32_bf16 v[176:179], a[36:39], a[128:131], v[176:179]
ds_read_b64_tr_b16 a[110:111], v16 offset:26016
v_mfma_f32_16x16x32_bf16 v[180:183], a[36:39], a[132:135], v[180:183]
buffer_load_dwordx4 v15, s[32:35], s54 offen offset:3168 lds
v_mfma_f32_16x16x32_bf16 v[184:187], a[36:39], a[136:139], v[184:187]
ds_read_b64_tr_b16 a[112:113], v17 offset:16896
s_add_u32 s54, s54, 229376
v_mfma_f32_16x16x32_bf16 v[188:191], a[36:39], a[140:143], v[188:191]
ds_read_b64_tr_b16 a[114:115], v17 offset:17408
v_mfma_f32_16x16x32_bf16 v[192:195], a[40:43], a[128:131], v[192:195]
v_mfma_f32_16x16x32_bf16 v[196:199], a[40:43], a[132:135], v[196:199]
ds_read_b64_tr_b16 a[116:117], v17 offset:16928
v_mfma_f32_16x16x32_bf16 v[200:203], a[40:43], a[136:139], v[200:203]
ds_read_b64_tr_b16 a[118:119], v17 offset:17440
v_mfma_f32_16x16x32_bf16 v[204:207], a[40:43], a[140:143], v[204:207]
buffer_load_dwordx4 a[188:191], v11, s[16:19], s52 offen offset:1024 sc1
v_mfma_f32_16x16x32_bf16 v[208:211], a[44:47], a[128:131], v[208:211]
ds_read_b64_tr_b16 a[120:121], v17 offset:25344
s_add_u32 s52, s52, 0x20000
v_mfma_f32_16x16x32_bf16 v[212:215], a[44:47], a[132:135], v[212:215]
v_mfma_f32_16x16x32_bf16 v[216:219], a[44:47], a[136:139], v[216:219]
ds_read_b64_tr_b16 a[122:123], v17 offset:25856
v_mfma_f32_16x16x32_bf16 v[220:223], a[44:47], a[140:143], v[220:223]
ds_read_b64_tr_b16 a[124:125], v17 offset:25376
v_mfma_f32_16x16x32_bf16 v[224:227], a[48:51], a[128:131], v[224:227]
ds_read_b64_tr_b16 a[126:127], v17 offset:25888
s_mov_b32 m0, s67
v_mfma_f32_16x16x32_bf16 v[228:231], a[48:51], a[132:135], v[228:231]
buffer_load_dwordx4 v5, s[28:31], s58 offen lds
v_mfma_f32_16x16x32_bf16 v[232:235], a[52:55], a[128:131], v[232:235]
v_mfma_f32_16x16x32_bf16 v[236:239], a[52:55], a[132:135], v[236:239]
v_mfma_f32_16x16x32_bf16 v[240:243], a[56:59], a[128:131], v[240:243]
v_mfma_f32_16x16x32_bf16 v[244:247], a[56:59], a[132:135], v[244:247]
v_mfma_f32_16x16x32_bf16 v[248:251], a[60:63], a[128:131], v[248:251]
v_mfma_f32_16x16x32_bf16 v[252:255], a[60:63], a[132:135], v[252:255]
s_waitcnt vmcnt(18) lgkmcnt(0)
s_barrier
v_mfma_f32_16x16x32_bf16 v[32:35], a[64:67], a[144:147], v[32:35]
ds_read_b64_tr_b16 a[0:1], v16 offset:33792
s_add_u32 m0, s55, 100096
v_mfma_f32_16x16x32_bf16 v[36:39], a[64:67], a[148:151], v[36:39]
buffer_load_dwordx4 v12, s[32:35], s54 offen lds
v_mfma_f32_16x16x32_bf16 v[40:43], a[64:67], a[152:155], v[40:43]
ds_read_b64_tr_b16 a[2:3], v16 offset:34304
s_waitcnt vmcnt(18)
v_mfma_f32_16x16x32_bf16 v[44:47], a[64:67], a[156:159], v[44:47]
ds_read_b64_tr_b16 a[4:5], v16 offset:33824
v_mfma_f32_16x16x32_bf16 v[48:51], a[68:71], a[144:147], v[48:51]
ds_read_b64_tr_b16 a[6:7], v16 offset:34336
v_mfma_f32_16x16x32_bf16 v[52:55], a[68:71], a[148:151], v[52:55]
v_mfma_f32_16x16x32_bf16 v[56:59], a[68:71], a[152:155], v[56:59]
ds_read_b64_tr_b16 a[8:9], v16 offset:42240
v_mfma_f32_16x16x32_bf16 v[60:63], a[68:71], a[156:159], v[60:63]
buffer_load_dwordx4 a[128:131], v10, s[16:19], s52 offen sc1
v_mfma_f32_16x16x32_bf16 v[64:67], a[72:75], a[144:147], v[64:67]
ds_read_b64_tr_b16 a[10:11], v16 offset:42752
v_mfma_f32_16x16x32_bf16 v[68:71], a[72:75], a[148:151], v[68:71]
ds_read_b64_tr_b16 a[12:13], v16 offset:42272
v_mfma_f32_16x16x32_bf16 v[72:75], a[72:75], a[152:155], v[72:75]
ds_read_b64_tr_b16 a[14:15], v16 offset:42784
v_mfma_f32_16x16x32_bf16 v[76:79], a[72:75], a[156:159], v[76:79]
v_mfma_f32_16x16x32_bf16 v[80:83], a[76:79], a[144:147], v[80:83]
ds_read_b64_tr_b16 a[16:17], v16 offset:33856
v_mfma_f32_16x16x32_bf16 v[84:87], a[76:79], a[148:151], v[84:87]
buffer_load_dwordx4 v13, s[32:35], s54 offen offset:1056 lds
v_mfma_f32_16x16x32_bf16 v[88:91], a[76:79], a[152:155], v[88:91]
ds_read_b64_tr_b16 a[18:19], v16 offset:34368
v_mfma_f32_16x16x32_bf16 v[92:95], a[76:79], a[156:159], v[92:95]
ds_read_b64_tr_b16 a[20:21], v16 offset:33888
v_mfma_f32_16x16x32_bf16 v[96:99], a[80:83], a[144:147], v[96:99]
v_mfma_f32_16x16x32_bf16 v[100:103], a[80:83], a[148:151], v[100:103]
ds_read_b64_tr_b16 a[22:23], v16 offset:34400
v_mfma_f32_16x16x32_bf16 v[104:107], a[80:83], a[152:155], v[104:107]
ds_read_b64_tr_b16 a[24:25], v16 offset:42304
v_mfma_f32_16x16x32_bf16 v[108:111], a[80:83], a[156:159], v[108:111]
buffer_load_dwordx4 a[132:135], v10, s[16:19], s52 offen offset:1024 sc1
v_mfma_f32_16x16x32_bf16 v[112:115], a[84:87], a[144:147], v[112:115]
ds_read_b64_tr_b16 a[26:27], v16 offset:42816
v_mfma_f32_16x16x32_bf16 v[116:119], a[84:87], a[148:151], v[116:119]
ds_read_b64_tr_b16 a[28:29], v16 offset:42336
v_mfma_f32_16x16x32_bf16 v[120:123], a[84:87], a[152:155], v[120:123]
v_mfma_f32_16x16x32_bf16 v[124:127], a[84:87], a[156:159], v[124:127]
ds_read_b64_tr_b16 a[30:31], v16 offset:42848
v_mfma_f32_16x16x32_bf16 v[128:131], a[88:91], a[144:147], v[128:131]
ds_read_b64_tr_b16 a[32:33], v16 offset:33920
v_mfma_f32_16x16x32_bf16 v[132:135], a[88:91], a[148:151], v[132:135]
buffer_load_dwordx4 v14, s[32:35], s54 offen offset:2112 lds
v_mfma_f32_16x16x32_bf16 v[136:139], a[88:91], a[152:155], v[136:139]
ds_read_b64_tr_b16 a[34:35], v16 offset:34432
v_mfma_f32_16x16x32_bf16 v[140:143], a[88:91], a[156:159], v[140:143]
v_mfma_f32_16x16x32_bf16 v[144:147], a[92:95], a[144:147], v[144:147]
ds_read_b64_tr_b16 a[36:37], v16 offset:33952
v_mfma_f32_16x16x32_bf16 v[148:151], a[92:95], a[148:151], v[148:151]
ds_read_b64_tr_b16 a[38:39], v16 offset:34464
v_mfma_f32_16x16x32_bf16 v[152:155], a[92:95], a[152:155], v[152:155]
ds_read_b64_tr_b16 a[40:41], v16 offset:42368
v_mfma_f32_16x16x32_bf16 v[156:159], a[92:95], a[156:159], v[156:159]
buffer_load_dwordx4 a[136:139], v11, s[16:19], s52 offen sc1
v_mfma_f32_16x16x32_bf16 v[160:163], a[96:99], a[144:147], v[160:163]
ds_read_b64_tr_b16 a[42:43], v16 offset:42880
v_mfma_f32_16x16x32_bf16 v[164:167], a[96:99], a[148:151], v[164:167]
v_mfma_f32_16x16x32_bf16 v[168:171], a[96:99], a[152:155], v[168:171]
ds_read_b64_tr_b16 a[44:45], v16 offset:42400
v_mfma_f32_16x16x32_bf16 v[172:175], a[96:99], a[156:159], v[172:175]
ds_read_b64_tr_b16 a[46:47], v16 offset:42912
v_mfma_f32_16x16x32_bf16 v[176:179], a[100:103], a[144:147], v[176:179]
ds_read_b64_tr_b16 a[48:49], v17 offset:33792
v_mfma_f32_16x16x32_bf16 v[180:183], a[100:103], a[148:151], v[180:183]
buffer_load_dwordx4 v15, s[32:35], s54 offen offset:3168 lds
v_mfma_f32_16x16x32_bf16 v[184:187], a[100:103], a[152:155], v[184:187]
s_add_u32 s54, s54, 229376
v_mfma_f32_16x16x32_bf16 v[188:191], a[100:103], a[156:159], v[188:191]
ds_read_b64_tr_b16 a[50:51], v17 offset:34304
v_mfma_f32_16x16x32_bf16 v[192:195], a[104:107], a[144:147], v[192:195]
ds_read_b64_tr_b16 a[52:53], v17 offset:33824
v_mfma_f32_16x16x32_bf16 v[196:199], a[104:107], a[148:151], v[196:199]
ds_read_b64_tr_b16 a[54:55], v17 offset:34336
v_mfma_f32_16x16x32_bf16 v[200:203], a[104:107], a[152:155], v[200:203]
ds_read_b64_tr_b16 a[56:57], v17 offset:42240
v_mfma_f32_16x16x32_bf16 v[204:207], a[104:107], a[156:159], v[204:207]
buffer_load_dwordx4 a[140:143], v11, s[16:19], s52 offen offset:1024 sc1
v_mfma_f32_16x16x32_bf16 v[208:211], a[108:111], a[144:147], v[208:211]
s_add_u32 s52, s52, 0x20000
v_mfma_f32_16x16x32_bf16 v[212:215], a[108:111], a[148:151], v[212:215]
ds_read_b64_tr_b16 a[58:59], v17 offset:42752
v_mfma_f32_16x16x32_bf16 v[216:219], a[108:111], a[152:155], v[216:219]
ds_read_b64_tr_b16 a[60:61], v17 offset:42272
v_mfma_f32_16x16x32_bf16 v[220:223], a[108:111], a[156:159], v[220:223]
ds_read_b64_tr_b16 a[62:63], v17 offset:42784
v_mfma_f32_16x16x32_bf16 v[224:227], a[112:115], a[144:147], v[224:227]
s_mov_b32 m0, s67
v_mfma_f32_16x16x32_bf16 v[228:231], a[112:115], a[148:151], v[228:231]
buffer_load_dwordx4 v6, s[28:31], s58 offen offset:1024 lds
v_mfma_f32_16x16x32_bf16 v[232:235], a[116:119], a[144:147], v[232:235]
s_add_u32 s67, s67, 8320
s_min_u32 s67, s67, s74
s_add_u32 s58, s58, 0x20000
s_min_u32 s58, s58, 1179648
v_mfma_f32_16x16x32_bf16 v[236:239], a[116:119], a[148:151], v[236:239]
v_mfma_f32_16x16x32_bf16 v[240:243], a[120:123], a[144:147], v[240:243]
v_mfma_f32_16x16x32_bf16 v[244:247], a[120:123], a[148:151], v[244:247]
v_mfma_f32_16x16x32_bf16 v[248:251], a[124:127], a[144:147], v[248:251]
v_mfma_f32_16x16x32_bf16 v[252:255], a[124:127], a[148:151], v[252:255]
s_waitcnt vmcnt(19) lgkmcnt(0)
s_barrier
v_mfma_f32_16x16x32_bf16 v[32:35], a[0:3], a[160:163], v[32:35]
ds_read_b64_tr_b16 a[64:65], v16 offset:50688
s_add_u32 m0, s55, 116992
v_mfma_f32_16x16x32_bf16 v[36:39], a[0:3], a[164:167], v[36:39]
buffer_load_dwordx4 v12, s[32:35], s54 offen lds
v_mfma_f32_16x16x32_bf16 v[40:43], a[0:3], a[168:171], v[40:43]
ds_read_b64_tr_b16 a[66:67], v16 offset:51200
s_waitcnt vmcnt(19)
v_mfma_f32_16x16x32_bf16 v[44:47], a[0:3], a[172:175], v[44:47]
ds_read_b64_tr_b16 a[68:69], v16 offset:50720
v_mfma_f32_16x16x32_bf16 v[48:51], a[4:7], a[160:163], v[48:51]
ds_read_b64_tr_b16 a[70:71], v16 offset:51232
v_mfma_f32_16x16x32_bf16 v[52:55], a[4:7], a[164:167], v[52:55]
v_mfma_f32_16x16x32_bf16 v[56:59], a[4:7], a[168:171], v[56:59]
ds_read_b64_tr_b16 a[72:73], v16 offset:59136
v_mfma_f32_16x16x32_bf16 v[60:63], a[4:7], a[172:175], v[60:63]
buffer_load_dwordx4 a[144:147], v10, s[16:19], s52 offen sc1
v_mfma_f32_16x16x32_bf16 v[64:67], a[8:11], a[160:163], v[64:67]
ds_read_b64_tr_b16 a[74:75], v16 offset:59648
v_mfma_f32_16x16x32_bf16 v[68:71], a[8:11], a[164:167], v[68:71]
ds_read_b64_tr_b16 a[76:77], v16 offset:59168
v_mfma_f32_16x16x32_bf16 v[72:75], a[8:11], a[168:171], v[72:75]
v_mfma_f32_16x16x32_bf16 v[76:79], a[8:11], a[172:175], v[76:79]
ds_read_b64_tr_b16 a[78:79], v16 offset:59680
v_mfma_f32_16x16x32_bf16 v[80:83], a[12:15], a[160:163], v[80:83]
ds_read_b64_tr_b16 a[80:81], v16 offset:50752
v_mfma_f32_16x16x32_bf16 v[84:87], a[12:15], a[164:167], v[84:87]
buffer_load_dwordx4 v13, s[32:35], s54 offen offset:1056 lds
v_mfma_f32_16x16x32_bf16 v[88:91], a[12:15], a[168:171], v[88:91]
ds_read_b64_tr_b16 a[82:83], v16 offset:51264
v_mfma_f32_16x16x32_bf16 v[92:95], a[12:15], a[172:175], v[92:95]
v_mfma_f32_16x16x32_bf16 v[96:99], a[16:19], a[160:163], v[96:99]
ds_read_b64_tr_b16 a[84:85], v16 offset:50784
v_mfma_f32_16x16x32_bf16 v[100:103], a[16:19], a[164:167], v[100:103]
ds_read_b64_tr_b16 a[86:87], v16 offset:51296
v_mfma_f32_16x16x32_bf16 v[104:107], a[16:19], a[168:171], v[104:107]
ds_read_b64_tr_b16 a[88:89], v16 offset:59200
v_mfma_f32_16x16x32_bf16 v[108:111], a[16:19], a[172:175], v[108:111]
buffer_load_dwordx4 a[148:151], v10, s[16:19], s52 offen offset:1024 sc1
v_mfma_f32_16x16x32_bf16 v[112:115], a[20:23], a[160:163], v[112:115]
v_mfma_f32_16x16x32_bf16 v[116:119], a[20:23], a[164:167], v[116:119]
ds_read_b64_tr_b16 a[90:91], v16 offset:59712
v_mfma_f32_16x16x32_bf16 v[120:123], a[20:23], a[168:171], v[120:123]
ds_read_b64_tr_b16 a[92:93], v16 offset:59232
v_mfma_f32_16x16x32_bf16 v[124:127], a[20:23], a[172:175], v[124:127]
ds_read_b64_tr_b16 a[94:95], v16 offset:59744
v_mfma_f32_16x16x32_bf16 v[128:131], a[24:27], a[160:163], v[128:131]
v_mfma_f32_16x16x32_bf16 v[132:135], a[24:27], a[164:167], v[132:135]
buffer_load_dwordx4 v14, s[32:35], s54 offen offset:2112 lds
v_mfma_f32_16x16x32_bf16 v[136:139], a[24:27], a[168:171], v[136:139]
ds_read_b64_tr_b16 a[96:97], v16 offset:50816
v_mfma_f32_16x16x32_bf16 v[140:143], a[24:27], a[172:175], v[140:143]
ds_read_b64_tr_b16 a[98:99], v16 offset:51328
v_mfma_f32_16x16x32_bf16 v[144:147], a[28:31], a[160:163], v[144:147]
ds_read_b64_tr_b16 a[100:101], v16 offset:50848
v_mfma_f32_16x16x32_bf16 v[148:151], a[28:31], a[164:167], v[148:151]
ds_read_b64_tr_b16 a[102:103], v16 offset:51360
v_mfma_f32_16x16x32_bf16 v[152:155], a[28:31], a[168:171], v[152:155]
v_mfma_f32_16x16x32_bf16 v[156:159], a[28:31], a[172:175], v[156:159]
buffer_load_dwordx4 a[152:155], v11, s[16:19], s52 offen sc1
v_mfma_f32_16x16x32_bf16 v[160:163], a[32:35], a[160:163], v[160:163]
ds_read_b64_tr_b16 a[104:105], v16 offset:59264
v_mfma_f32_16x16x32_bf16 v[164:167], a[32:35], a[164:167], v[164:167]
ds_read_b64_tr_b16 a[106:107], v16 offset:59776
v_mfma_f32_16x16x32_bf16 v[168:171], a[32:35], a[168:171], v[168:171]
ds_read_b64_tr_b16 a[108:109], v16 offset:59296
v_mfma_f32_16x16x32_bf16 v[172:175], a[32:35], a[172:175], v[172:175]
v_mfma_f32_16x16x32_bf16 v[176:179], a[36:39], a[160:163], v[176:179]
ds_read_b64_tr_b16 a[110:111], v16 offset:59808
v_mfma_f32_16x16x32_bf16 v[180:183], a[36:39], a[164:167], v[180:183]
buffer_load_dwordx4 v15, s[32:35], s54 offen offset:3168 lds
v_mfma_f32_16x16x32_bf16 v[184:187], a[36:39], a[168:171], v[184:187]
ds_read_b64_tr_b16 a[112:113], v17 offset:50688
s_add_u32 s54, s54, 229376
v_mfma_f32_16x16x32_bf16 v[188:191], a[36:39], a[172:175], v[188:191]
ds_read_b64_tr_b16 a[114:115], v17 offset:51200
v_mfma_f32_16x16x32_bf16 v[192:195], a[40:43], a[160:163], v[192:195]
v_mfma_f32_16x16x32_bf16 v[196:199], a[40:43], a[164:167], v[196:199]
ds_read_b64_tr_b16 a[116:117], v17 offset:50720
v_mfma_f32_16x16x32_bf16 v[200:203], a[40:43], a[168:171], v[200:203]
ds_read_b64_tr_b16 a[118:119], v17 offset:51232
v_mfma_f32_16x16x32_bf16 v[204:207], a[40:43], a[172:175], v[204:207]
buffer_load_dwordx4 a[156:159], v11, s[16:19], s52 offen offset:1024 sc1
v_mfma_f32_16x16x32_bf16 v[208:211], a[44:47], a[160:163], v[208:211]
ds_read_b64_tr_b16 a[120:121], v17 offset:59136
s_add_u32 s52, s52, 0x20000
v_mfma_f32_16x16x32_bf16 v[212:215], a[44:47], a[164:167], v[212:215]
v_mfma_f32_16x16x32_bf16 v[216:219], a[44:47], a[168:171], v[216:219]
ds_read_b64_tr_b16 a[122:123], v17 offset:59648
v_mfma_f32_16x16x32_bf16 v[220:223], a[44:47], a[172:175], v[220:223]
ds_read_b64_tr_b16 a[124:125], v17 offset:59168
v_mfma_f32_16x16x32_bf16 v[224:227], a[48:51], a[160:163], v[224:227]
ds_read_b64_tr_b16 a[126:127], v17 offset:59680
s_mov_b32 m0, s67
v_mfma_f32_16x16x32_bf16 v[228:231], a[48:51], a[164:167], v[228:231]
buffer_load_dwordx4 v5, s[28:31], s58 offen lds
v_mfma_f32_16x16x32_bf16 v[232:235], a[52:55], a[160:163], v[232:235]
v_mfma_f32_16x16x32_bf16 v[236:239], a[52:55], a[164:167], v[236:239]
v_mfma_f32_16x16x32_bf16 v[240:243], a[56:59], a[160:163], v[240:243]
v_mfma_f32_16x16x32_bf16 v[244:247], a[56:59], a[164:167], v[244:247]
v_mfma_f32_16x16x32_bf16 v[248:251], a[60:63], a[160:163], v[248:251]
v_mfma_f32_16x16x32_bf16 v[252:255], a[60:63], a[164:167], v[252:255]
s_waitcnt vmcnt(20) lgkmcnt(0)
s_barrier
v_mfma_f32_16x16x32_bf16 v[32:35], a[64:67], a[176:179], v[32:35]
ds_read_b64_tr_b16 a[0:1], v16
s_add_u32 m0, s55, 133888
v_mfma_f32_16x16x32_bf16 v[36:39], a[64:67], a[180:183], v[36:39]
buffer_load_dwordx4 v12, s[32:35], s54 offen lds
v_mfma_f32_16x16x32_bf16 v[40:43], a[64:67], a[184:187], v[40:43]
ds_read_b64_tr_b16 a[2:3], v16 offset:512
s_waitcnt vmcnt(20)
v_mfma_f32_16x16x32_bf16 v[44:47], a[64:67], a[188:191], v[44:47]
ds_read_b64_tr_b16 a[4:5], v16 offset:32
v_mfma_f32_16x16x32_bf16 v[48:51], a[68:71], a[176:179], v[48:51]
ds_read_b64_tr_b16 a[6:7], v16 offset:544
v_mfma_f32_16x16x32_bf16 v[52:55], a[68:71], a[180:183], v[52:55]
v_mfma_f32_16x16x32_bf16 v[56:59], a[68:71], a[184:187], v[56:59]
ds_read_b64_tr_b16 a[8:9], v16 offset:8448
v_mfma_f32_16x16x32_bf16 v[60:63], a[68:71], a[188:191], v[60:63]
buffer_load_dwordx4 a[160:163], v10, s[16:19], s52 offen sc1
v_mfma_f32_16x16x32_bf16 v[64:67], a[72:75], a[176:179], v[64:67]
.Lpad26:
s_cbranch_execz .Lnopoll42r
ds_read_b64_tr_b16 a[10:11], v16 offset:8960
v_mfma_f32_16x16x32_bf16 v[68:71], a[72:75], a[180:183], v[68:71]
ds_read_b64_tr_b16 a[12:13], v16 offset:8480
v_mfma_f32_16x16x32_bf16 v[72:75], a[72:75], a[184:187], v[72:75]
ds_read_b64_tr_b16 a[14:15], v16 offset:8992
v_mfma_f32_16x16x32_bf16 v[76:79], a[72:75], a[188:191], v[76:79]
v_mfma_f32_16x16x32_bf16 v[80:83], a[76:79], a[176:179], v[80:83]
ds_read_b64_tr_b16 a[16:17], v16 offset:64
v_mfma_f32_16x16x32_bf16 v[84:87], a[76:79], a[180:183], v[84:87]
buffer_load_dwordx4 v13, s[32:35], s54 offen offset:1056 lds
v_mfma_f32_16x16x32_bf16 v[88:91], a[76:79], a[184:187], v[88:91]
ds_read_b64_tr_b16 a[18:19], v16 offset:576
v_mfma_f32_16x16x32_bf16 v[92:95], a[76:79], a[188:191], v[92:95]
ds_read_b64_tr_b16 a[20:21], v16 offset:96
v_mfma_f32_16x16x32_bf16 v[96:99], a[80:83], a[176:179], v[96:99]
v_mfma_f32_16x16x32_bf16 v[100:103], a[80:83], a[180:183], v[100:103]
ds_read_b64_tr_b16 a[22:23], v16 offset:608
v_mfma_f32_16x16x32_bf16 v[104:107], a[80:83], a[184:187], v[104:107]
ds_read_b64_tr_b16 a[24:25], v16 offset:8512
v_mfma_f32_16x16x32_bf16 v[108:111], a[80:83], a[188:191], v[108:111]
buffer_load_dwordx4 a[164:167], v10, s[16:19], s52 offen offset:1024 sc1
v_mfma_f32_16x16x32_bf16 v[112:115], a[84:87], a[176:179], v[112:115]
ds_read_b64_tr_b16 a[26:27], v16 offset:9024
v_mfma_f32_16x16x32_bf16 v[116:119], a[84:87], a[180:183], v[116:119]
ds_read_b64_tr_b16 a[28:29], v16 offset:8544
v_mfma_f32_16x16x32_bf16 v[120:123], a[84:87], a[184:187], v[120:123]
v_mfma_f32_16x16x32_bf16 v[124:127], a[84:87], a[188:191], v[124:127]
ds_read_b64_tr_b16 a[30:31], v16 offset:9056
v_mfma_f32_16x16x32_bf16 v[128:131], a[88:91], a[176:179], v[128:131]
ds_read_b64_tr_b16 a[32:33], v16 offset:128
v_mfma_f32_16x16x32_bf16 v[132:135], a[88:91], a[180:183], v[132:135]
buffer_load_dwordx4 v14, s[32:35], s54 offen offset:2112 lds
v_mfma_f32_16x16x32_bf16 v[136:139], a[88:91], a[184:187], v[136:139]
ds_read_b64_tr_b16 a[34:35], v16 offset:640
v_mfma_f32_16x16x32_bf16 v[140:143], a[88:91], a[188:191], v[140:143]
v_mfma_f32_16x16x32_bf16 v[144:147], a[92:95], a[176:179], v[144:147]
ds_read_b64_tr_b16 a[36:37], v16 offset:160
v_mfma_f32_16x16x32_bf16 v[148:151], a[92:95], a[180:183], v[148:151]
ds_read_b64_tr_b16 a[38:39], v16 offset:672
v_mfma_f32_16x16x32_bf16 v[152:155], a[92:95], a[184:187], v[152:155]
ds_read_b64_tr_b16 a[40:41], v16 offset:8576
v_mfma_f32_16x16x32_bf16 v[156:159], a[92:95], a[188:191], v[156:159]
buffer_load_dwordx4 a[168:171], v11, s[16:19], s52 offen sc1
v_mfma_f32_16x16x32_bf16 v[160:163], a[96:99], a[176:179], v[160:163]
ds_read_b64_tr_b16 a[42:43], v16 offset:9088
v_mfma_f32_16x16x32_bf16 v[164:167], a[96:99], a[180:183], v[164:167]
v_mfma_f32_16x16x32_bf16 v[168:171], a[96:99], a[184:187], v[168:171]
ds_read_b64_tr_b16 a[44:45], v16 offset:8608
v_mfma_f32_16x16x32_bf16 v[172:175], a[96:99], a[188:191], v[172:175]
ds_read_b64_tr_b16 a[46:47], v16 offset:9120
v_mfma_f32_16x16x32_bf16 v[176:179], a[100:103], a[176:179], v[176:179]
ds_read_b64_tr_b16 a[48:49], v17
v_mfma_f32_16x16x32_bf16 v[180:183], a[100:103], a[180:183], v[180:183]
buffer_load_dwordx4 v15, s[32:35], s54 offen offset:3168 lds
v_mfma_f32_16x16x32_bf16 v[184:187], a[100:103], a[184:187], v[184:187]
s_add_u32 s54, s54, 229376
v_mfma_f32_16x16x32_bf16 v[188:191], a[100:103], a[188:191], v[188:191]
ds_read_b64_tr_b16 a[50:51], v17 offset:512
v_mfma_f32_16x16x32_bf16 v[192:195], a[104:107], a[176:179], v[192:195]
ds_read_b64_tr_b16 a[52:53], v17 offset:32
v_mfma_f32_16x16x32_bf16 v[196:199], a[104:107], a[180:183], v[196:199]
ds_read_b64_tr_b16 a[54:55], v17 offset:544
v_mfma_f32_16x16x32_bf16 v[200:203], a[104:107], a[184:187], v[200:203]
ds_read_b64_tr_b16 a[56:57], v17 offset:8448
v_mfma_f32_16x16x32_bf16 v[204:207], a[104:107], a[188:191], v[204:207]
buffer_load_dwordx4 a[172:175], v11, s[16:19], s52 offen offset:1024 sc1
v_mfma_f32_16x16x32_bf16 v[208:211], a[108:111], a[176:179], v[208:211]
s_add_u32 s52, s52, 0x20000
v_mfma_f32_16x16x32_bf16 v[212:215], a[108:111], a[180:183], v[212:215]
ds_read_b64_tr_b16 a[58:59], v17 offset:8960
v_mfma_f32_16x16x32_bf16 v[216:219], a[108:111], a[184:187], v[216:219]
ds_read_b64_tr_b16 a[60:61], v17 offset:8480
v_mfma_f32_16x16x32_bf16 v[220:223], a[108:111], a[188:191], v[220:223]
ds_read_b64_tr_b16 a[62:63], v17 offset:8992
v_mfma_f32_16x16x32_bf16 v[224:227], a[112:115], a[176:179], v[224:227]
s_mov_b32 m0, s67
v_mfma_f32_16x16x32_bf16 v[228:231], a[112:115], a[180:183], v[228:231]
buffer_load_dwordx4 v6, s[28:31], s58 offen offset:1024 lds
v_mfma_f32_16x16x32_bf16 v[232:235], a[116:119], a[176:179], v[232:235]
s_add_u32 s67, s67, 8320
s_min_u32 s67, s67, s74
s_add_u32 s58, s58, 0x20000
s_min_u32 s58, s58, 1179648
v_mfma_f32_16x16x32_bf16 v[236:239], a[116:119], a[180:183], v[236:239]
v_mfma_f32_16x16x32_bf16 v[240:243], a[120:123], a[176:179], v[240:243]
v_mfma_f32_16x16x32_bf16 v[244:247], a[120:123], a[180:183], v[244:247]
v_mfma_f32_16x16x32_bf16 v[248:251], a[124:127], a[176:179], v[248:251]
v_mfma_f32_16x16x32_bf16 v[252:255], a[124:127], a[180:183], v[252:255]
s_sub_u32 s15, s15, 1
s_cmp_lg_u32 s15, 0
s_cbranch_scc1 .Lk43
s_waitcnt vmcnt(11) lgkmcnt(0)
s_barrier
v_mfma_f32_16x16x32_bf16 v[32:35], a[0:3], a[128:131], v[32:35]
buffer_load_dwordx4 a[176:179], v10, s[16:19], s52 offen sc1
v_mfma_f32_16x16x32_bf16 v[36:39], a[0:3], a[132:135], v[36:39]
s_lshl_b32 s74, s3, 10
v_mov_b32 v18, v5
v_mov_b32 v19, v6
v_mfma_f32_16x16x32_bf16 v[40:43], a[0:3], a[136:139], v[40:43]
s_lshl_b32 s75, s12, 9
s_add_u32 s74, s74, s75
s_add_u32 s74, s74, 151552
v_mfma_f32_16x16x32_bf16 v[44:47], a[0:3], a[140:143], v[44:47]
s_xor_b32 s75, s12, 1
v_and_b32 v2, 15, v1
v_lshl_add_u32 v2, v2, 4, s74
v_mfma_f32_16x16x32_bf16 v[48:51], a[4:7], a[128:131], v[48:51]
buffer_load_dwordx4 a[180:183], v10, s[16:19], s52 offen offset:1024 sc1
v_mfma_f32_16x16x32_bf16 v[52:55], a[4:7], a[132:135], v[52:55]
ds_read_b64 v[20:21], v2
v_xor_b32 v8, 512, v2
v_mfma_f32_16x16x32_bf16 v[56:59], a[4:7], a[136:139], v[56:59]
ds_read_b64 v[22:23], v2 offset:256
s_lshl_b32 s74, s12, 7
v_mfma_f32_16x16x32_bf16 v[60:63], a[4:7], a[140:143], v[60:63]
ds_read_b64 v[24:25], v8
s_add_u32 s74, s74, 160512
v_mfma_f32_16x16x32_bf16 v[64:67], a[8:11], a[128:131], v[64:67]
buffer_load_dwordx4 a[184:187], v11, s[16:19], s52 offen sc1
v_mfma_f32_16x16x32_bf16 v[68:71], a[8:11], a[132:135], v[68:71]
ds_read_b64 v[26:27], v8 offset:256
s_mul_i32 s75, s75, 384
v_mfma_f32_16x16x32_bf16 v[72:75], a[8:11], a[136:139], v[72:75]
ds_read_b32 v28, v2 offset:8
s_add_u32 s75, s75, 160512
v_mfma_f32_16x16x32_bf16 v[76:79], a[8:11], a[140:143], v[76:79]
ds_read_b32 v29, v2 offset:264
v_lshrrev_b32 v9, 4, v1
v_mfma_f32_16x16x32_bf16 v[80:83], a[12:15], a[128:131], v[80:83]
buffer_load_dwordx4 a[188:191], v11, s[16:19], s52 offen offset:1024 sc1
v_mfma_f32_16x16x32_bf16 v[84:87], a[12:15], a[132:135], v[84:87]
s_add_u32 s52, s52, 0x20000
ds_read_b32 v30, v8 offset:8
v_mfma_f32_16x16x32_bf16 v[88:91], a[12:15], a[136:139], v[88:91]
ds_read_b32 v31, v8 offset:264
v_lshlrev_b32 v9, 4, v9
v_mfma_f32_16x16x32_bf16 v[92:95], a[12:15], a[140:143], v[92:95]
s_mul_i32 s66, s13, 917504
v_add_u32 v8, s75, v9
v_add_u32 v9, s74, v9
v_mfma_f32_16x16x32_bf16 v[96:99], a[16:19], a[128:131], v[96:99]
ds_read_b128 v[12:15], v9
s_add_u32 s66, s66, 46137344
v_mfma_f32_16x16x32_bf16 v[100:103], a[16:19], a[132:135], v[100:103]
ds_read_b128 v[4:7], v9 offset:64
s_add_u32 s65, s66, 393216
v_mfma_f32_16x16x32_bf16 v[104:107], a[16:19], a[136:139], v[104:107]
s_lshl_b32 s62, s12, 19
s_add_u32 s62, s62, s66
s_add_u32 s63, s62, 0x20000
v_mfma_f32_16x16x32_bf16 v[108:111], a[16:19], a[140:143], v[108:111]
s_add_u32 s64, s62, 0x40000
ds_read_b64_tr_b16 a[64:65], v16 offset:16896
v_mfma_f32_16x16x32_bf16 v[112:115], a[20:23], a[128:131], v[112:115]
ds_read_b64_tr_b16 a[66:67], v16 offset:17408
s_mov_b32 s58, 1310720
v_mfma_f32_16x16x32_bf16 v[116:119], a[20:23], a[132:135], v[116:119]
ds_read_b64_tr_b16 a[68:69], v16 offset:16928
v_mfma_f32_16x16x32_bf16 v[120:123], a[20:23], a[136:139], v[120:123]
ds_read_b64_tr_b16 a[70:71], v16 offset:17440
v_mfma_f32_16x16x32_bf16 v[124:127], a[20:23], a[140:143], v[124:127]
ds_read_b64_tr_b16 a[72:73], v16 offset:25344
v_mfma_f32_16x16x32_bf16 v[128:131], a[24:27], a[128:131], v[128:131]
ds_read_b64_tr_b16 a[74:75], v16 offset:25856
s_waitcnt lgkmcnt(7)
v_fmac_f32 v32, v12, v20
v_mfma_f32_16x16x32_bf16 v[132:135], a[24:27], a[132:135], v[132:135]
ds_read_b64_tr_b16 a[76:77], v16 offset:25376
v_fmac_f32 v33, v13, v20
v_mfma_f32_16x16x32_bf16 v[136:139], a[24:27], a[136:139], v[136:139]
ds_read_b64_tr_b16 a[78:79], v16 offset:25888
v_fmac_f32 v34, v14, v20
v_mfma_f32_16x16x32_bf16 v[140:143], a[24:27], a[140:143], v[140:143]
ds_read_b64_tr_b16 a[80:81], v16 offset:33792
v_fmac_f32 v35, v15, v20
v_mfma_f32_16x16x32_bf16 v[144:147], a[28:31], a[128:131], v[144:147]
ds_read_b64_tr_b16 a[82:83], v16 offset:34304
v_fmac_f32 v36, v12, v22
v_mfma_f32_16x16x32_bf16 v[148:151], a[28:31], a[132:135], v[148:151]
ds_read_b64_tr_b16 a[84:85], v16 offset:33824
v_fmac_f32 v37, v13, v22
v_mfma_f32_16x16x32_bf16 v[152:155], a[28:31], a[136:139], v[152:155]
ds_read_b64_tr_b16 a[86:87], v16 offset:34336
v_fmac_f32 v38, v14, v22
v_mfma_f32_16x16x32_bf16 v[156:159], a[28:31], a[140:143], v[156:159]
ds_read_b64_tr_b16 a[88:89], v16 offset:42240
v_fmac_f32 v39, v15, v22
s_waitcnt lgkmcnt(11)
v_mfma_f32_16x16x32_bf16 v[32:35], a[64:67], a[144:147], v[32:35]
ds_read_b64_tr_b16 a[90:91], v16 offset:42752
v_fmac_f32 v40, v12, v24
v_mfma_f32_16x16x32_bf16 v[36:39], a[64:67], a[148:151], v[36:39]
ds_read_b64_tr_b16 a[92:93], v16 offset:42272
v_fmac_f32 v41, v13, v24
s_waitcnt lgkmcnt(9)
v_mfma_f32_16x16x32_bf16 v[64:67], a[72:75], a[144:147], v[64:67]
ds_read_b64_tr_b16 a[94:95], v16 offset:42784
v_fmac_f32 v42, v14, v24
v_mfma_f32_16x16x32_bf16 v[68:71], a[72:75], a[148:151], v[68:71]
ds_read_b64_tr_b16 a[16:17], v16 offset:16960
v_fmac_f32 v43, v15, v24
v_mfma_f32_16x16x32_bf16 v[72:75], a[72:75], a[152:155], v[72:75]
ds_read_b64_tr_b16 a[18:19], v16 offset:17472
v_fmac_f32 v44, v12, v26
v_mfma_f32_16x16x32_bf16 v[40:43], a[64:67], a[152:155], v[40:43]
ds_read_b64_tr_b16 a[20:21], v16 offset:16992
s_waitcnt vmcnt(6)
s_barrier
v_mfma_f32_16x16x32_bf16 v[76:79], a[72:75], a[156:159], v[76:79]
ds_read_b64_tr_b16 a[0:1], v16 offset:50688
v_fmac_f32 v45, v13, v26
s_waitcnt lgkmcnt(12)
v_mfma_f32_16x16x32_bf16 v[80:83], a[76:79], a[144:147], v[80:83]
ds_read_b64_tr_b16 a[2:3], v16 offset:51200
v_fmac_f32 v46, v14, v26
v_mfma_f32_16x16x32_bf16 v[84:87], a[76:79], a[148:151], v[84:87]
ds_read_b64_tr_b16 a[4:5], v16 offset:50720
v_fmac_f32 v47, v15, v26
v_mfma_f32_16x16x32_bf16 v[88:91], a[76:79], a[152:155], v[88:91]
ds_read_b128 v[12:15], v9 offset:512
v_fmac_f32 v48, v4, v20
v_mfma_f32_16x16x32_bf16 v[44:47], a[64:67], a[156:159], v[44:47]
ds_read_b64_tr_b16 a[6:7], v16 offset:51232
v_fmac_f32 v49, v5, v20
v_mfma_f32_16x16x32_bf16 v[92:95], a[76:79], a[156:159], v[92:95]
ds_read_b64_tr_b16 a[8:9], v16 offset:59136
v_fmac_f32 v50, v6, v20
s_waitcnt lgkmcnt(15)
v_mfma_f32_16x16x32_bf16 v[32:35], a[80:83], a[160:163], v[32:35]
ds_read_b64_tr_b16 a[10:11], v16 offset:59648
v_fmac_f32 v51, v7, v20
v_mfma_f32_16x16x32_bf16 v[36:39], a[80:83], a[164:167], v[36:39]
ds_read_b64_tr_b16 a[12:13], v16 offset:59168
v_fmac_f32 v52, v4, v22
v_mfma_f32_16x16x32_bf16 v[48:51], a[68:71], a[144:147], v[48:51]
ds_read_b64_tr_b16 a[14:15], v16 offset:59680
v_fmac_f32 v53, v5, v22
v_mfma_f32_16x16x32_bf16 v[40:43], a[80:83], a[168:171], v[40:43]
ds_read_b64_tr_b16 a[22:23], v16 offset:17504
v_fmac_f32 v54, v6, v22
s_waitcnt vmcnt(5)
v_mfma_f32_16x16x32_bf16 v[44:47], a[80:83], a[172:175], v[44:47]
ds_read_b64_tr_b16 a[24:25], v16 offset:25408
v_fmac_f32 v55, v7, v22
s_waitcnt lgkmcnt(15)
v_mfma_f32_16x16x32_bf16 v[48:51], a[84:87], a[160:163], v[48:51]
ds_read_b64_tr_b16 a[26:27], v16 offset:25920
v_fmac_f32 v56, v4, v24
v_mfma_f32_16x16x32_bf16 v[52:55], a[68:71], a[148:151], v[52:55]
ds_read_b64_tr_b16 a[28:29], v16 offset:25440
v_fmac_f32 v57, v5, v24
v_mfma_f32_16x16x32_bf16 v[52:55], a[84:87], a[164:167], v[52:55]
ds_read_b64_tr_b16 a[30:31], v16 offset:25952
v_fmac_f32 v58, v6, v24
s_waitcnt lgkmcnt(15)
v_mfma_f32_16x16x32_bf16 v[80:83], a[92:95], a[160:163], v[80:83]
ds_read_b64_tr_b16 a[64:65], v16 offset:33856
v_fmac_f32 v59, v7, v24
v_mfma_f32_16x16x32_bf16 v[84:87], a[92:95], a[164:167], v[84:87]
ds_read_b64_tr_b16 a[66:67], v16 offset:34368
v_fmac_f32 v60, v4, v26
v_mfma_f32_16x16x32_bf16 v[56:59], a[68:71], a[152:155], v[56:59]
ds_read_b64_tr_b16 a[72:73], v16 offset:42304
v_fmac_f32 v61, v5, v26
v_mfma_f32_16x16x32_bf16 v[56:59], a[84:87], a[168:171], v[56:59]
ds_read_b64_tr_b16 a[74:75], v16 offset:42816
v_fmac_f32 v62, v6, v26
v_mfma_f32_16x16x32_bf16 v[88:91], a[92:95], a[168:171], v[88:91]
ds_read_b64_tr_b16 a[76:77], v16 offset:42336
v_fmac_f32 v63, v7, v26
v_mfma_f32_16x16x32_bf16 v[92:95], a[92:95], a[172:175], v[92:95]
ds_read_b128 v[4:7], v9 offset:576
s_waitcnt lgkmcnt(15)
v_fmac_f32 v64, v12, v20
v_mfma_f32_16x16x32_bf16 v[60:63], a[68:71], a[156:159], v[60:63]
ds_read_b64_tr_b16 a[68:69], v16 offset:33888
v_fmac_f32 v65, v13, v20
v_mfma_f32_16x16x32_bf16 v[60:63], a[84:87], a[172:175], v[60:63]
ds_read_b64_tr_b16 a[70:71], v16 offset:34400
v_fmac_f32 v66, v14, v20
s_waitcnt vmcnt(3)
v_mfma_f32_16x16x32_bf16 v[32:35], a[0:3], a[176:179], v[32:35]
ds_read_b64_tr_b16 a[78:79], v16 offset:42848
v_fmac_f32 v67, v15, v20
s_waitcnt vmcnt(2)
v_mfma_f32_16x16x32_bf16 v[36:39], a[0:3], a[180:183], v[36:39]
ds_read_b64_tr_b16 a[80:81], v16 offset:50752
v_fmac_f32 v68, v12, v22
v_mfma_f32_16x16x32_bf16 v[64:67], a[88:91], a[160:163], v[64:67]
ds_read_b64_tr_b16 a[82:83], v16 offset:51264
v_fmac_f32 v69, v13, v22
v_mfma_f32_16x16x32_bf16 v[48:51], a[4:7], a[176:179], v[48:51]
ds_read_b64_tr_b16 a[84:85], v16 offset:50784
v_fmac_f32 v70, v14, v22
v_mfma_f32_16x16x32_bf16 v[52:55], a[4:7], a[180:183], v[52:55]
ds_read_b64_tr_b16 a[86:87], v16 offset:51296
v_fmac_f32 v71, v15, v22
s_waitcnt vmcnt(1)
v_mfma_f32_16x16x32_bf16 v[40:43], a[0:3], a[184:187], v[40:43]
ds_read_b64_tr_b16 a[92:93], v16 offset:59232
v_fmac_f32 v72, v12, v24
v_mfma_f32_16x16x32_bf16 v[68:71], a[88:91], a[164:167], v[68:71]
ds_read_b64_tr_b16 a[94:95], v16 offset:59744
v_fmac_f32 v73, v13, v24
v_mfma_f32_16x16x32_bf16 v[56:59], a[4:7], a[184:187], v[56:59]
v_fmac_f32 v74, v14, v24
v_fmac_f32 v75, v15, v24
s_waitcnt lgkmcnt(15)
v_mfma_f32_16x16x32_bf16 v[64:67], a[8:11], a[176:179], v[64:67]
v_fmac_f32 v76, v12, v26
v_fmac_f32 v77, v13, v26
v_mfma_f32_16x16x32_bf16 v[72:75], a[88:91], a[168:171], v[72:75]
v_fmac_f32 v78, v14, v26
v_fmac_f32 v79, v15, v26
s_waitcnt vmcnt(0)
v_mfma_f32_16x16x32_bf16 v[44:47], a[0:3], a[188:191], v[44:47]
ds_read_b128 v[12:15], v9 offset:128
s_waitcnt lgkmcnt(10)
v_fmac_f32 v80, v4, v20
v_mfma_f32_16x16x32_bf16 v[76:79], a[88:91], a[172:175], v[76:79]
ds_read_b64_tr_b16 a[88:89], v16 offset:59200
v_fmac_f32 v81, v5, v20
v_mfma_f32_16x16x32_bf16 v[60:63], a[4:7], a[188:191], v[60:63]
ds_read_b64_tr_b16 a[90:91], v16 offset:59712
v_fmac_f32 v82, v6, v20
v_mfma_f32_16x16x32_bf16 v[68:71], a[8:11], a[180:183], v[68:71]
ds_read_b64_tr_b16 a[0:1], v16 offset:17024
v_fmac_f32 v83, v7, v20
v_mfma_f32_16x16x32_bf16 v[72:75], a[8:11], a[184:187], v[72:75]
ds_read_b64_tr_b16 a[2:3], v16 offset:17536
v_fmac_f32 v84, v4, v22
v_mfma_f32_16x16x32_bf16 v[76:79], a[8:11], a[188:191], v[76:79]
ds_read_b64_tr_b16 a[4:5], v16 offset:17056
v_fmac_f32 v85, v5, v22
v_mfma_f32_16x16x32_bf16 v[80:83], a[12:15], a[176:179], v[80:83]
ds_read_b64_tr_b16 a[6:7], v16 offset:17568
v_fmac_f32 v86, v6, v22
v_mfma_f32_16x16x32_bf16 v[128:131], a[24:27], a[144:147], v[128:131]
ds_read_b64_tr_b16 a[8:9], v16 offset:25472
v_fmac_f32 v87, v7, v22
v_mfma_f32_16x16x32_bf16 v[132:135], a[24:27], a[148:151], v[132:135]
ds_read_b64_tr_b16 a[10:11], v16 offset:25984
v_fmac_f32 v88, v4, v24
v_mfma_f32_16x16x32_bf16 v[84:87], a[12:15], a[180:183], v[84:87]
v_fmac_f32 v89, v5, v24
v_fmac_f32 v90, v6, v24
v_mfma_f32_16x16x32_bf16 v[136:139], a[24:27], a[152:155], v[136:139]
v_fmac_f32 v91, v7, v24
v_fmac_f32 v92, v4, v26
v_mfma_f32_16x16x32_bf16 v[140:143], a[24:27], a[156:159], v[140:143]
ds_read_b64_tr_b16 a[24:25], v16 offset:42368
v_fmac_f32 v93, v5, v26
v_mfma_f32_16x16x32_bf16 v[88:91], a[12:15], a[184:187], v[88:91]
ds_read_b64_tr_b16 a[26:27], v16 offset:42880
v_fmac_f32 v94, v6, v26
v_mfma_f32_16x16x32_bf16 v[144:147], a[28:31], a[144:147], v[144:147]
v_fmac_f32 v95, v7, v26
s_waitcnt lgkmcnt(10)
v_fmac_f32 v96, v12, v20
v_mfma_f32_16x16x32_bf16 v[148:151], a[28:31], a[148:151], v[148:151]
ds_read_b128 v[4:7], v9 offset:192
v_fmac_f32 v97, v13, v20
v_mfma_f32_16x16x32_bf16 v[92:95], a[12:15], a[188:191], v[92:95]
ds_read_b64_tr_b16 a[12:13], v16 offset:25504
ds_read_b64_tr_b16 a[14:15], v16 offset:26016
v_pk_mul_f32 v[64:65], v[64:65], v[32:33]
v_pk_mul_f32 v[32:33], v[32:33], v[28:29] op_sel_hi:[1,0]
v_exp_f32 v32, v32
v_pk_mul_f32 v[66:67], v[66:67], v[34:35]
v_exp_f32 v33, v33
v_pk_mul_f32 v[34:35], v[34:35], v[28:29] op_sel_hi:[1,0]
v_exp_f32 v34, v34
v_pk_mul_f32 v[80:81], v[80:81], v[48:49]
v_exp_f32 v35, v35
v_pk_mul_f32 v[48:49], v[48:49], v[28:29] op_sel_hi:[1,0]
v_exp_f32 v48, v48
v_pk_mul_f32 v[82:83], v[82:83], v[50:51]
v_exp_f32 v49, v49
v_pk_mul_f32 v[50:51], v[50:51], v[28:29] op_sel_hi:[1,0]
v_exp_f32 v50, v50
v_pk_fma_f32 v[32:33], v[32:33], v[20:21], v[20:21] op_sel:[0,1,1] op_sel_hi:[1,1,1]
v_exp_f32 v51, v51
v_pk_fma_f32 v[34:35], v[34:35], v[20:21], v[20:21] op_sel:[0,1,1] op_sel_hi:[1,1,1]
v_rcp_f32 v32, v32
v_pk_fma_f32 v[48:49], v[48:49], v[20:21], v[20:21] op_sel:[0,1,1] op_sel_hi:[1,1,1]
v_rcp_f32 v33, v33
v_pk_fma_f32 v[50:51], v[50:51], v[20:21], v[20:21] op_sel:[0,1,1] op_sel_hi:[1,1,1]
v_rcp_f32 v34, v34
v_pk_mul_f32 v[64:65], v[64:65], v[32:33]
v_rcp_f32 v35, v35
v_cvt_pk_bf16_f32 v32, v64, v65
v_rcp_f32 v48, v48
v_pk_mul_f32 v[66:67], v[66:67], v[34:35]
v_rcp_f32 v49, v49
v_cvt_pk_bf16_f32 v33, v66, v67
v_rcp_f32 v50, v50
v_pk_mul_f32 v[80:81], v[80:81], v[48:49]
v_rcp_f32 v51, v51
v_cvt_pk_bf16_f32 v34, v80, v81
v_pk_mul_f32 v[68:69], v[68:69], v[36:37]
v_pk_mul_f32 v[82:83], v[82:83], v[50:51]
v_cvt_pk_bf16_f32 v35, v82, v83
buffer_store_dwordx4 v[32:35], v10, s[16:19], s62 offen sc1
v_pk_mul_f32 v[36:37], v[36:37], v[28:29] op_sel:[0,1] op_sel_hi:[1,1]
v_exp_f32 v36, v36
v_pk_mul_f32 v[70:71], v[70:71], v[38:39]
v_exp_f32 v37, v37
v_pk_mul_f32 v[38:39], v[38:39], v[28:29] op_sel:[0,1] op_sel_hi:[1,1]
v_exp_f32 v38, v38
v_pk_mul_f32 v[84:85], v[84:85], v[52:53]
v_exp_f32 v39, v39
v_pk_mul_f32 v[52:53], v[52:53], v[28:29] op_sel:[0,1] op_sel_hi:[1,1]
v_exp_f32 v52, v52
v_pk_mul_f32 v[86:87], v[86:87], v[54:55]
v_exp_f32 v53, v53
v_pk_mul_f32 v[54:55], v[54:55], v[28:29] op_sel:[0,1] op_sel_hi:[1,1]
v_exp_f32 v54, v54
v_pk_fma_f32 v[36:37], v[36:37], v[22:23], v[22:23] op_sel:[0,1,1] op_sel_hi:[1,1,1]
v_exp_f32 v55, v55
v_pk_fma_f32 v[38:39], v[38:39], v[22:23], v[22:23] op_sel:[0,1,1] op_sel_hi:[1,1,1]
v_rcp_f32 v36, v36
v_pk_fma_f32 v[52:53], v[52:53], v[22:23], v[22:23] op_sel:[0,1,1] op_sel_hi:[1,1,1]
v_rcp_f32 v37, v37
v_pk_fma_f32 v[54:55], v[54:55], v[22:23], v[22:23] op_sel:[0,1,1] op_sel_hi:[1,1,1]
v_rcp_f32 v38, v38
v_pk_mul_f32 v[68:69], v[68:69], v[36:37]
v_rcp_f32 v39, v39
v_cvt_pk_bf16_f32 v36, v68, v69
v_rcp_f32 v52, v52
v_pk_mul_f32 v[70:71], v[70:71], v[38:39]
v_rcp_f32 v53, v53
v_cvt_pk_bf16_f32 v37, v70, v71
v_rcp_f32 v54, v54
v_pk_mul_f32 v[84:85], v[84:85], v[52:53]
v_rcp_f32 v55, v55
v_cvt_pk_bf16_f32 v38, v84, v85
v_pk_mul_f32 v[72:73], v[72:73], v[40:41]
v_pk_mul_f32 v[86:87], v[86:87], v[54:55]
v_cvt_pk_bf16_f32 v39, v86, v87
buffer_store_dwordx4 v[36:39], v10, s[16:19], s62 offen offset:1024 sc1
v_pk_mul_f32 v[40:41], v[40:41], v[30:31] op_sel_hi:[1,0]
v_exp_f32 v40, v40
v_pk_mul_f32 v[74:75], v[74:75], v[42:43]
v_exp_f32 v41, v41
v_pk_mul_f32 v[42:43], v[42:43], v[30:31] op_sel_hi:[1,0]
v_exp_f32 v42, v42
v_pk_mul_f32 v[88:89], v[88:89], v[56:57]
v_exp_f32 v43, v43
v_pk_mul_f32 v[56:57], v[56:57], v[30:31] op_sel_hi:[1,0]
v_exp_f32 v56, v56
v_pk_mul_f32 v[90:91], v[90:91], v[58:59]
v_exp_f32 v57, v57
v_pk_mul_f32 v[58:59], v[58:59], v[30:31] op_sel_hi:[1,0]
v_exp_f32 v58, v58
v_pk_fma_f32 v[40:41], v[40:41], v[24:25], v[24:25] op_sel:[0,1,1] op_sel_hi:[1,1,1]
v_exp_f32 v59, v59
v_pk_fma_f32 v[42:43], v[42:43], v[24:25], v[24:25] op_sel:[0,1,1] op_sel_hi:[1,1,1]
v_rcp_f32 v40, v40
v_pk_fma_f32 v[56:57], v[56:57], v[24:25], v[24:25] op_sel:[0,1,1] op_sel_hi:[1,1,1]
v_rcp_f32 v41, v41
v_pk_fma_f32 v[58:59], v[58:59], v[24:25], v[24:25] op_sel:[0,1,1] op_sel_hi:[1,1,1]
v_rcp_f32 v42, v42
v_pk_mul_f32 v[72:73], v[72:73], v[40:41]
v_rcp_f32 v43, v43
v_cvt_pk_bf16_f32 v40, v72, v73
v_rcp_f32 v56, v56
v_pk_mul_f32 v[74:75], v[74:75], v[42:43]
v_rcp_f32 v57, v57
v_cvt_pk_bf16_f32 v41, v74, v75
v_rcp_f32 v58, v58
v_pk_mul_f32 v[88:89], v[88:89], v[56:57]
v_rcp_f32 v59, v59
v_cvt_pk_bf16_f32 v42, v88, v89
v_pk_mul_f32 v[76:77], v[76:77], v[44:45]
v_pk_mul_f32 v[90:91], v[90:91], v[58:59]
v_cvt_pk_bf16_f32 v43, v90, v91
buffer_store_dwordx4 v[40:43], v11, s[16:19], s62 offen sc1
v_pk_mul_f32 v[44:45], v[44:45], v[30:31] op_sel:[0,1] op_sel_hi:[1,1]
v_exp_f32 v44, v44
v_pk_mul_f32 v[78:79], v[78:79], v[46:47]
v_exp_f32 v45, v45
v_pk_mul_f32 v[46:47], v[46:47], v[30:31] op_sel:[0,1] op_sel_hi:[1,1]
v_exp_f32 v46, v46
v_pk_mul_f32 v[92:93], v[92:93], v[60:61]
v_exp_f32 v47, v47
v_pk_mul_f32 v[60:61], v[60:61], v[30:31] op_sel:[0,1] op_sel_hi:[1,1]
v_exp_f32 v60, v60
v_pk_mul_f32 v[94:95], v[94:95], v[62:63]
v_exp_f32 v61, v61
v_pk_mul_f32 v[62:63], v[62:63], v[30:31] op_sel:[0,1] op_sel_hi:[1,1]
v_exp_f32 v62, v62
v_pk_fma_f32 v[44:45], v[44:45], v[26:27], v[26:27] op_sel:[0,1,1] op_sel_hi:[1,1,1]
v_exp_f32 v63, v63
v_pk_fma_f32 v[46:47], v[46:47], v[26:27], v[26:27] op_sel:[0,1,1] op_sel_hi:[1,1,1]
v_rcp_f32 v44, v44
v_pk_fma_f32 v[60:61], v[60:61], v[26:27], v[26:27] op_sel:[0,1,1] op_sel_hi:[1,1,1]
v_rcp_f32 v45, v45
v_pk_fma_f32 v[62:63], v[62:63], v[26:27], v[26:27] op_sel:[0,1,1] op_sel_hi:[1,1,1]
v_rcp_f32 v46, v46
v_pk_mul_f32 v[76:77], v[76:77], v[44:45]
v_rcp_f32 v47, v47
v_cvt_pk_bf16_f32 v44, v76, v77
v_rcp_f32 v60, v60
v_pk_mul_f32 v[78:79], v[78:79], v[46:47]
v_rcp_f32 v61, v61
v_cvt_pk_bf16_f32 v45, v78, v79
v_rcp_f32 v62, v62
v_pk_mul_f32 v[92:93], v[92:93], v[60:61]
v_rcp_f32 v63, v63
v_cvt_pk_bf16_f32 v46, v92, v93
v_pk_mul_f32 v[94:95], v[94:95], v[62:63]
s_nop 1
v_mfma_f32_16x16x32_bf16 v[152:155], a[28:31], a[152:155], v[152:155]
v_fmac_f32 v98, v14, v20
v_fmac_f32 v99, v15, v20
v_mfma_f32_16x16x32_bf16 v[156:159], a[28:31], a[156:159], v[156:159]
ds_read_b64_tr_b16 a[28:29], v16 offset:42400
v_fmac_f32 v100, v12, v22
v_mfma_f32_16x16x32_bf16 v[96:99], a[16:19], a[144:147], v[96:99]
ds_read_b64_tr_b16 a[30:31], v16 offset:42912
v_fmac_f32 v101, v13, v22
v_mfma_f32_16x16x32_bf16 v[96:99], a[64:67], a[160:163], v[96:99]
v_fmac_f32 v102, v14, v22
v_fmac_f32 v103, v15, v22
v_mfma_f32_16x16x32_bf16 v[144:147], a[76:79], a[160:163], v[144:147]
v_fmac_f32 v104, v12, v24
v_fmac_f32 v105, v13, v24
v_mfma_f32_16x16x32_bf16 v[100:103], a[16:19], a[148:151], v[100:103]
v_fmac_f32 v106, v14, v24
v_fmac_f32 v107, v15, v24
v_mfma_f32_16x16x32_bf16 v[100:103], a[64:67], a[164:167], v[100:103]
v_fmac_f32 v108, v12, v26
v_fmac_f32 v109, v13, v26
v_mfma_f32_16x16x32_bf16 v[104:107], a[16:19], a[152:155], v[104:107]
v_fmac_f32 v110, v14, v26
v_fmac_f32 v111, v15, v26
v_mfma_f32_16x16x32_bf16 v[104:107], a[64:67], a[168:171], v[104:107]
ds_read_b128 v[12:15], v9 offset:640
s_waitcnt lgkmcnt(5)
v_fmac_f32 v112, v4, v20
v_mfma_f32_16x16x32_bf16 v[108:111], a[16:19], a[156:159], v[108:111]
ds_read_b64_tr_b16 a[16:17], v16 offset:33920
v_fmac_f32 v113, v5, v20
v_mfma_f32_16x16x32_bf16 v[108:111], a[64:67], a[172:175], v[108:111]
ds_read_b64_tr_b16 a[18:19], v16 offset:34432
v_fmac_f32 v114, v6, v20
v_mfma_f32_16x16x32_bf16 v[148:151], a[76:79], a[164:167], v[148:151]
ds_read_b64_tr_b16 a[64:65], v16 offset:50816
v_fmac_f32 v115, v7, v20
v_mfma_f32_16x16x32_bf16 v[152:155], a[76:79], a[168:171], v[152:155]
ds_read_b64_tr_b16 a[66:67], v16 offset:51328
v_fmac_f32 v116, v4, v22
v_mfma_f32_16x16x32_bf16 v[112:115], a[20:23], a[144:147], v[112:115]
v_fmac_f32 v117, v5, v22
v_fmac_f32 v118, v6, v22
v_mfma_f32_16x16x32_bf16 v[112:115], a[68:71], a[160:163], v[112:115]
v_fmac_f32 v119, v7, v22
v_fmac_f32 v120, v4, v24
v_mfma_f32_16x16x32_bf16 v[156:159], a[76:79], a[172:175], v[156:159]
ds_read_b64_tr_b16 a[76:77], v16 offset:59296
v_fmac_f32 v121, v5, v24
v_mfma_f32_16x16x32_bf16 v[116:119], a[20:23], a[148:151], v[116:119]
ds_read_b64_tr_b16 a[78:79], v16 offset:59808
v_fmac_f32 v122, v6, v24
v_mfma_f32_16x16x32_bf16 v[116:119], a[68:71], a[164:167], v[116:119]
v_fmac_f32 v123, v7, v24
v_fmac_f32 v124, v4, v26
v_mfma_f32_16x16x32_bf16 v[96:99], a[80:83], a[176:179], v[96:99]
v_fmac_f32 v125, v5, v26
v_fmac_f32 v126, v6, v26
v_mfma_f32_16x16x32_bf16 v[120:123], a[20:23], a[152:155], v[120:123]
v_fmac_f32 v127, v7, v26
s_waitcnt lgkmcnt(6)
v_fmac_f32 v128, v12, v20
v_mfma_f32_16x16x32_bf16 v[120:123], a[68:71], a[168:171], v[120:123]
ds_read_b128 v[4:7], v9 offset:704
v_fmac_f32 v129, v13, v20
v_mfma_f32_16x16x32_bf16 v[124:127], a[20:23], a[156:159], v[124:127]
ds_read_b64_tr_b16 a[20:21], v16 offset:33952
v_fmac_f32 v130, v14, v20
v_mfma_f32_16x16x32_bf16 v[124:127], a[68:71], a[172:175], v[124:127]
ds_read_b64_tr_b16 a[22:23], v16 offset:34464
v_fmac_f32 v131, v15, v20
v_mfma_f32_16x16x32_bf16 v[100:103], a[80:83], a[180:183], v[100:103]
ds_read_b64_tr_b16 a[68:69], v16 offset:50848
v_fmac_f32 v132, v12, v22
v_mfma_f32_16x16x32_bf16 v[128:131], a[72:75], a[160:163], v[128:131]
ds_read_b64_tr_b16 a[70:71], v16 offset:51360
v_fmac_f32 v133, v13, v22
v_mfma_f32_16x16x32_bf16 v[104:107], a[80:83], a[184:187], v[104:107]
v_fmac_f32 v134, v14, v22
v_fmac_f32 v135, v15, v22
v_mfma_f32_16x16x32_bf16 v[108:111], a[80:83], a[188:191], v[108:111]
ds_read_b64_tr_b16 a[80:81], v17 offset:16896
v_fmac_f32 v136, v12, v24
v_mfma_f32_16x16x32_bf16 v[132:135], a[72:75], a[164:167], v[132:135]
ds_read_b64_tr_b16 a[82:83], v17 offset:17408
v_fmac_f32 v137, v13, v24
v_mfma_f32_16x16x32_bf16 v[112:115], a[84:87], a[176:179], v[112:115]
v_fmac_f32 v138, v14, v24
v_fmac_f32 v139, v15, v24
v_mfma_f32_16x16x32_bf16 v[116:119], a[84:87], a[180:183], v[116:119]
v_fmac_f32 v140, v12, v26
v_fmac_f32 v141, v13, v26
v_mfma_f32_16x16x32_bf16 v[136:139], a[72:75], a[168:171], v[136:139]
v_fmac_f32 v142, v14, v26
v_fmac_f32 v143, v15, v26
v_mfma_f32_16x16x32_bf16 v[120:123], a[84:87], a[184:187], v[120:123]
ds_read_b128 v[12:15], v9 offset:256
s_waitcnt lgkmcnt(7)
v_fmac_f32 v144, v4, v20
v_mfma_f32_16x16x32_bf16 v[140:143], a[72:75], a[172:175], v[140:143]
ds_read_b64_tr_b16 a[72:73], v16 offset:59264
v_fmac_f32 v145, v5, v20
v_mfma_f32_16x16x32_bf16 v[124:127], a[84:87], a[188:191], v[124:127]
ds_read_b64_tr_b16 a[74:75], v16 offset:59776
v_fmac_f32 v146, v6, v20
v_mfma_f32_16x16x32_bf16 v[128:131], a[88:91], a[176:179], v[128:131]
ds_read_b64_tr_b16 a[84:85], v17 offset:16928
v_fmac_f32 v147, v7, v20
v_mfma_f32_16x16x32_bf16 v[132:135], a[88:91], a[180:183], v[132:135]
ds_read_b64_tr_b16 a[86:87], v17 offset:17440
.Lpad27:
s_cbranch_execz .Lnopoll42r
v_fmac_f32 v148, v4, v22
v_mfma_f32_16x16x32_bf16 v[136:139], a[88:91], a[184:187], v[136:139]
v_fmac_f32 v149, v5, v22
v_fmac_f32 v150, v6, v22
v_mfma_f32_16x16x32_bf16 v[140:143], a[88:91], a[188:191], v[140:143]
ds_read_b64_tr_b16 a[88:89], v17 offset:25344
v_fmac_f32 v151, v7, v22
v_mfma_f32_16x16x32_bf16 v[144:147], a[92:95], a[176:179], v[144:147]
ds_read_b64_tr_b16 a[90:91], v17 offset:25856
v_fmac_f32 v152, v4, v24
v_mfma_f32_16x16x32_bf16 v[148:151], a[92:95], a[180:183], v[148:151]
v_fmac_f32 v153, v5, v24
v_fmac_f32 v154, v6, v24
v_mfma_f32_16x16x32_bf16 v[160:163], a[32:35], a[128:131], v[160:163]
v_fmac_f32 v155, v7, v24
v_fmac_f32 v156, v4, v26
v_mfma_f32_16x16x32_bf16 v[164:167], a[32:35], a[132:135], v[164:167]
v_fmac_f32 v157, v5, v26
v_fmac_f32 v158, v6, v26
v_mfma_f32_16x16x32_bf16 v[152:155], a[92:95], a[184:187], v[152:155]
v_fmac_f32 v159, v7, v26
s_waitcnt lgkmcnt(6)
v_fmac_f32 v160, v12, v20
v_mfma_f32_16x16x32_bf16 v[168:171], a[32:35], a[136:139], v[168:171]
ds_read_b128 v[4:7], v9 offset:320
v_fmac_f32 v161, v13, v20
v_mfma_f32_16x16x32_bf16 v[156:159], a[92:95], a[188:191], v[156:159]
ds_read_b64_tr_b16 a[92:93], v17 offset:25376
ds_read_b64_tr_b16 a[94:95], v17 offset:25888
v_cvt_pk_bf16_f32 v47, v94, v95
buffer_store_dwordx4 v[44:47], v11, s[16:19], s62 offen offset:1024 sc1
v_pk_mul_f32 v[128:129], v[128:129], v[96:97]
v_pk_mul_f32 v[96:97], v[96:97], v[28:29] op_sel_hi:[1,0]
v_exp_f32 v96, v96
v_pk_mul_f32 v[130:131], v[130:131], v[98:99]
v_exp_f32 v97, v97
v_pk_mul_f32 v[98:99], v[98:99], v[28:29] op_sel_hi:[1,0]
v_exp_f32 v98, v98
v_pk_mul_f32 v[144:145], v[144:145], v[112:113]
v_exp_f32 v99, v99
v_pk_mul_f32 v[112:113], v[112:113], v[28:29] op_sel_hi:[1,0]
v_exp_f32 v112, v112
v_pk_mul_f32 v[146:147], v[146:147], v[114:115]
v_exp_f32 v113, v113
v_pk_mul_f32 v[114:115], v[114:115], v[28:29] op_sel_hi:[1,0]
v_exp_f32 v114, v114
v_pk_fma_f32 v[96:97], v[96:97], v[20:21], v[20:21] op_sel:[0,1,1] op_sel_hi:[1,1,1]
v_exp_f32 v115, v115
v_pk_fma_f32 v[98:99], v[98:99], v[20:21], v[20:21] op_sel:[0,1,1] op_sel_hi:[1,1,1]
v_rcp_f32 v96, v96
v_pk_fma_f32 v[112:113], v[112:113], v[20:21], v[20:21] op_sel:[0,1,1] op_sel_hi:[1,1,1]
v_rcp_f32 v97, v97
v_pk_fma_f32 v[114:115], v[114:115], v[20:21], v[20:21] op_sel:[0,1,1] op_sel_hi:[1,1,1]
v_rcp_f32 v98, v98
v_pk_mul_f32 v[128:129], v[128:129], v[96:97]
v_rcp_f32 v99, v99
v_cvt_pk_bf16_f32 v96, v128, v129
v_rcp_f32 v112, v112
v_pk_mul_f32 v[130:131], v[130:131], v[98:99]
v_rcp_f32 v113, v113
v_cvt_pk_bf16_f32 v97, v130, v131
v_rcp_f32 v114, v114
v_pk_mul_f32 v[144:145], v[144:145], v[112:113]
v_rcp_f32 v115, v115
v_cvt_pk_bf16_f32 v98, v144, v145
v_pk_mul_f32 v[132:133], v[132:133], v[100:101]
v_pk_mul_f32 v[146:147], v[146:147], v[114:115]
v_cvt_pk_bf16_f32 v99, v146, v147
buffer_store_dwordx4 v[96:99], v10, s[16:19], s63 offen sc1
v_pk_mul_f32 v[100:101], v[100:101], v[28:29] op_sel:[0,1] op_sel_hi:[1,1]
v_exp_f32 v100, v100
v_pk_mul_f32 v[134:135], v[134:135], v[102:103]
v_exp_f32 v101, v101
v_pk_mul_f32 v[102:103], v[102:103], v[28:29] op_sel:[0,1] op_sel_hi:[1,1]
v_exp_f32 v102, v102
v_pk_mul_f32 v[148:149], v[148:149], v[116:117]
v_exp_f32 v103, v103
v_pk_mul_f32 v[116:117], v[116:117], v[28:29] op_sel:[0,1] op_sel_hi:[1,1]
v_exp_f32 v116, v116
v_pk_mul_f32 v[150:151], v[150:151], v[118:119]
v_exp_f32 v117, v117
v_pk_mul_f32 v[118:119], v[118:119], v[28:29] op_sel:[0,1] op_sel_hi:[1,1]
v_exp_f32 v118, v118
v_pk_fma_f32 v[100:101], v[100:101], v[22:23], v[22:23] op_sel:[0,1,1] op_sel_hi:[1,1,1]
v_exp_f32 v119, v119
v_pk_fma_f32 v[102:103], v[102:103], v[22:23], v[22:23] op_sel:[0,1,1] op_sel_hi:[1,1,1]
v_rcp_f32 v100, v100
v_pk_fma_f32 v[116:117], v[116:117], v[22:23], v[22:23] op_sel:[0,1,1] op_sel_hi:[1,1,1]
v_rcp_f32 v101, v101
v_pk_fma_f32 v[118:119], v[118:119], v[22:23], v[22:23] op_sel:[0,1,1] op_sel_hi:[1,1,1]
v_rcp_f32 v102, v102
v_pk_mul_f32 v[132:133], v[132:133], v[100:101]
v_rcp_f32 v103, v103
v_cvt_pk_bf16_f32 v100, v132, v133
v_rcp_f32 v116, v116
v_pk_mul_f32 v[134:135], v[134:135], v[102:103]
v_rcp_f32 v117, v117
v_cvt_pk_bf16_f32 v101, v134, v135
v_rcp_f32 v118, v118
v_pk_mul_f32 v[148:149], v[148:149], v[116:117]
v_rcp_f32 v119, v119
v_cvt_pk_bf16_f32 v102, v148, v149
v_pk_mul_f32 v[136:137], v[136:137], v[104:105]
v_pk_mul_f32 v[150:151], v[150:151], v[118:119]
v_cvt_pk_bf16_f32 v103, v150, v151
buffer_store_dwordx4 v[100:103], v10, s[16:19], s63 offen offset:1024 sc1
v_pk_mul_f32 v[104:105], v[104:105], v[30:31] op_sel_hi:[1,0]
v_exp_f32 v104, v104
v_pk_mul_f32 v[138:139], v[138:139], v[106:107]
v_exp_f32 v105, v105
v_pk_mul_f32 v[106:107], v[106:107], v[30:31] op_sel_hi:[1,0]
v_exp_f32 v106, v106
v_pk_mul_f32 v[152:153], v[152:153], v[120:121]
v_exp_f32 v107, v107
v_pk_mul_f32 v[120:121], v[120:121], v[30:31] op_sel_hi:[1,0]
v_exp_f32 v120, v120
v_pk_mul_f32 v[154:155], v[154:155], v[122:123]
v_exp_f32 v121, v121
v_pk_mul_f32 v[122:123], v[122:123], v[30:31] op_sel_hi:[1,0]
v_exp_f32 v122, v122
v_pk_fma_f32 v[104:105], v[104:105], v[24:25], v[24:25] op_sel:[0,1,1] op_sel_hi:[1,1,1]
v_exp_f32 v123, v123
v_pk_fma_f32 v[106:107], v[106:107], v[24:25], v[24:25] op_sel:[0,1,1] op_sel_hi:[1,1,1]
v_rcp_f32 v104, v104
v_pk_fma_f32 v[120:121], v[120:121], v[24:25], v[24:25] op_sel:[0,1,1] op_sel_hi:[1,1,1]
v_rcp_f32 v105, v105
v_pk_fma_f32 v[122:123], v[122:123], v[24:25], v[24:25] op_sel:[0,1,1] op_sel_hi:[1,1,1]
v_rcp_f32 v106, v106
v_pk_mul_f32 v[136:137], v[136:137], v[104:105]
v_rcp_f32 v107, v107
v_cvt_pk_bf16_f32 v104, v136, v137
v_rcp_f32 v120, v120
v_pk_mul_f32 v[138:139], v[138:139], v[106:107]
v_rcp_f32 v121, v121
v_cvt_pk_bf16_f32 v105, v138, v139
v_rcp_f32 v122, v122
v_pk_mul_f32 v[152:153], v[152:153], v[120:121]
v_rcp_f32 v123, v123
v_cvt_pk_bf16_f32 v106, v152, v153
v_pk_mul_f32 v[140:141], v[140:141], v[108:109]
v_pk_mul_f32 v[154:155], v[154:155], v[122:123]
v_cvt_pk_bf16_f32 v107, v154, v155
buffer_store_dwordx4 v[104:107], v11, s[16:19], s63 offen sc1
v_pk_mul_f32 v[108:109], v[108:109], v[30:31] op_sel:[0,1] op_sel_hi:[1,1]
v_exp_f32 v108, v108
v_pk_mul_f32 v[142:143], v[142:143], v[110:111]
v_exp_f32 v109, v109
v_pk_mul_f32 v[110:111], v[110:111], v[30:31] op_sel:[0,1] op_sel_hi:[1,1]
v_exp_f32 v110, v110
v_pk_mul_f32 v[156:157], v[156:157], v[124:125]
v_exp_f32 v111, v111
v_pk_mul_f32 v[124:125], v[124:125], v[30:31] op_sel:[0,1] op_sel_hi:[1,1]
v_exp_f32 v124, v124
v_pk_mul_f32 v[158:159], v[158:159], v[126:127]
v_exp_f32 v125, v125
v_pk_mul_f32 v[126:127], v[126:127], v[30:31] op_sel:[0,1] op_sel_hi:[1,1]
v_exp_f32 v126, v126
v_pk_fma_f32 v[108:109], v[108:109], v[26:27], v[26:27] op_sel:[0,1,1] op_sel_hi:[1,1,1]
v_exp_f32 v127, v127
v_pk_fma_f32 v[110:111], v[110:111], v[26:27], v[26:27] op_sel:[0,1,1] op_sel_hi:[1,1,1]
v_rcp_f32 v108, v108
v_pk_fma_f32 v[124:125], v[124:125], v[26:27], v[26:27] op_sel:[0,1,1] op_sel_hi:[1,1,1]
v_rcp_f32 v109, v109
v_pk_fma_f32 v[126:127], v[126:127], v[26:27], v[26:27] op_sel:[0,1,1] op_sel_hi:[1,1,1]
v_rcp_f32 v110, v110
v_pk_mul_f32 v[140:141], v[140:141], v[108:109]
v_rcp_f32 v111, v111
v_cvt_pk_bf16_f32 v108, v140, v141
v_rcp_f32 v124, v124
v_pk_mul_f32 v[142:143], v[142:143], v[110:111]
v_rcp_f32 v125, v125
v_cvt_pk_bf16_f32 v109, v142, v143
v_rcp_f32 v126, v126
v_pk_mul_f32 v[156:157], v[156:157], v[124:125]
v_rcp_f32 v127, v127
v_cvt_pk_bf16_f32 v110, v156, v157
v_pk_mul_f32 v[158:159], v[158:159], v[126:127]
s_nop 1
v_mfma_f32_16x16x32_bf16 v[172:175], a[32:35], a[140:143], v[172:175]
ds_read_b64_tr_b16 a[32:33], v17 offset:33792
v_fmac_f32 v162, v14, v20
v_mfma_f32_16x16x32_bf16 v[176:179], a[36:39], a[128:131], v[176:179]
ds_read_b64_tr_b16 a[34:35], v17 offset:34304
v_fmac_f32 v163, v15, v20
v_mfma_f32_16x16x32_bf16 v[180:183], a[36:39], a[132:135], v[180:183]
v_fmac_f32 v164, v12, v22
v_fmac_f32 v165, v13, v22
v_mfma_f32_16x16x32_bf16 v[184:187], a[36:39], a[136:139], v[184:187]
v_fmac_f32 v166, v14, v22
v_fmac_f32 v167, v15, v22
v_mfma_f32_16x16x32_bf16 v[188:191], a[36:39], a[140:143], v[188:191]
ds_read_b64_tr_b16 a[36:37], v17 offset:33824
v_fmac_f32 v168, v12, v24
v_mfma_f32_16x16x32_bf16 v[192:195], a[40:43], a[128:131], v[192:195]
ds_read_b64_tr_b16 a[38:39], v17 offset:34336
v_fmac_f32 v169, v13, v24
v_mfma_f32_16x16x32_bf16 v[196:199], a[40:43], a[132:135], v[196:199]
v_fmac_f32 v170, v14, v24
v_fmac_f32 v171, v15, v24
v_mfma_f32_16x16x32_bf16 v[200:203], a[40:43], a[136:139], v[200:203]
v_fmac_f32 v172, v12, v26
v_fmac_f32 v173, v13, v26
v_mfma_f32_16x16x32_bf16 v[204:207], a[40:43], a[140:143], v[204:207]
ds_read_b64_tr_b16 a[40:41], v17 offset:42240
v_fmac_f32 v174, v14, v26
v_mfma_f32_16x16x32_bf16 v[208:211], a[44:47], a[128:131], v[208:211]
ds_read_b64_tr_b16 a[42:43], v17 offset:42752
v_fmac_f32 v175, v15, v26
v_mfma_f32_16x16x32_bf16 v[212:215], a[44:47], a[132:135], v[212:215]
ds_read_b128 v[12:15], v9 offset:768
s_waitcnt lgkmcnt(9)
v_fmac_f32 v176, v4, v20
v_mfma_f32_16x16x32_bf16 v[216:219], a[44:47], a[136:139], v[216:219]
v_fmac_f32 v177, v5, v20
v_fmac_f32 v178, v6, v20
v_mfma_f32_16x16x32_bf16 v[220:223], a[44:47], a[140:143], v[220:223]
ds_read_b64_tr_b16 a[44:45], v17 offset:42272
v_fmac_f32 v179, v7, v20
v_mfma_f32_16x16x32_bf16 v[160:163], a[0:3], a[144:147], v[160:163]
ds_read_b64_tr_b16 a[46:47], v17 offset:42784
v_fmac_f32 v180, v4, v22
v_mfma_f32_16x16x32_bf16 v[164:167], a[0:3], a[148:151], v[164:167]
v_fmac_f32 v181, v5, v22
v_fmac_f32 v182, v6, v22
v_mfma_f32_16x16x32_bf16 v[168:171], a[0:3], a[152:155], v[168:171]
v_fmac_f32 v183, v7, v22
v_fmac_f32 v184, v4, v24
v_mfma_f32_16x16x32_bf16 v[172:175], a[0:3], a[156:159], v[172:175]
ds_read_b64_tr_b16 a[0:1], v17 offset:50688
v_fmac_f32 v185, v5, v24
v_mfma_f32_16x16x32_bf16 v[176:179], a[4:7], a[144:147], v[176:179]
ds_read_b64_tr_b16 a[2:3], v17 offset:51200
v_fmac_f32 v186, v6, v24
v_mfma_f32_16x16x32_bf16 v[180:183], a[4:7], a[148:151], v[180:183]
v_fmac_f32 v187, v7, v24
v_fmac_f32 v188, v4, v26
v_mfma_f32_16x16x32_bf16 v[192:195], a[8:11], a[144:147], v[192:195]
v_fmac_f32 v189, v5, v26
v_fmac_f32 v190, v6, v26
v_mfma_f32_16x16x32_bf16 v[184:187], a[4:7], a[152:155], v[184:187]
v_fmac_f32 v191, v7, v26
v_cvt_pk_bf16_f32 v111, v158, v159
v_mfma_f32_16x16x32_bf16 v[196:199], a[8:11], a[148:151], v[196:199]
ds_read_b128 v[4:7], v9 offset:832
s_waitcnt lgkmcnt(5)
v_fmac_f32 v192, v12, v20
v_mfma_f32_16x16x32_bf16 v[188:191], a[4:7], a[156:159], v[188:191]
ds_read_b64_tr_b16 a[4:5], v17 offset:50720
v_fmac_f32 v193, v13, v20
v_mfma_f32_16x16x32_bf16 v[200:203], a[8:11], a[152:155], v[200:203]
ds_read_b64_tr_b16 a[6:7], v17 offset:51232
v_fmac_f32 v194, v14, v20
v_mfma_f32_16x16x32_bf16 v[204:207], a[8:11], a[156:159], v[204:207]
ds_read_b64_tr_b16 a[8:9], v17 offset:59136
v_fmac_f32 v195, v15, v20
v_mfma_f32_16x16x32_bf16 v[208:211], a[12:15], a[144:147], v[208:211]
ds_read_b64_tr_b16 a[10:11], v17 offset:59648
v_fmac_f32 v196, v12, v22
v_mfma_f32_16x16x32_bf16 v[212:215], a[12:15], a[148:151], v[212:215]
buffer_store_dwordx4 v[108:111], v11, s[16:19], s63 offen offset:1024 sc1
v_mfma_f32_16x16x32_bf16 v[216:219], a[12:15], a[152:155], v[216:219]
v_fmac_f32 v197, v13, v22
v_fmac_f32 v198, v14, v22
v_mfma_f32_16x16x32_bf16 v[220:223], a[12:15], a[156:159], v[220:223]
ds_read_b64_tr_b16 a[12:13], v17 offset:59168
v_fmac_f32 v199, v15, v22
v_mfma_f32_16x16x32_bf16 v[160:163], a[16:19], a[160:163], v[160:163]
ds_read_b64_tr_b16 a[14:15], v17 offset:59680
v_fmac_f32 v200, v12, v24
v_mfma_f32_16x16x32_bf16 v[164:167], a[16:19], a[164:167], v[164:167]
v_fmac_f32 v201, v13, v24
v_fmac_f32 v202, v14, v24
v_mfma_f32_16x16x32_bf16 v[168:171], a[16:19], a[168:171], v[168:171]
v_fmac_f32 v203, v15, v24
v_fmac_f32 v204, v12, v26
v_mfma_f32_16x16x32_bf16 v[172:175], a[16:19], a[172:175], v[172:175]
v_fmac_f32 v205, v13, v26
v_fmac_f32 v206, v14, v26
v_mfma_f32_16x16x32_bf16 v[176:179], a[20:23], a[160:163], v[176:179]
v_fmac_f32 v207, v15, v26
v_mfma_f32_16x16x32_bf16 v[180:183], a[20:23], a[164:167], v[180:183]
ds_read_b128 v[12:15], v8
v_mfma_f32_16x16x32_bf16 v[184:187], a[20:23], a[168:171], v[184:187]
v_mfma_f32_16x16x32_bf16 v[188:191], a[20:23], a[172:175], v[188:191]
v_mfma_f32_16x16x32_bf16 v[192:195], a[24:27], a[160:163], v[192:195]
s_waitcnt lgkmcnt(1)
s_barrier
s_add_u32 m0, s59, 83200
v_mfma_f32_16x16x32_bf16 v[196:199], a[24:27], a[164:167], v[196:199]
buffer_load_dwordx4 v18, s[28:31], s58 offen lds
v_mfma_f32_16x16x32_bf16 v[200:203], a[24:27], a[168:171], v[200:203]
v_mfma_f32_16x16x32_bf16 v[204:207], a[24:27], a[172:175], v[204:207]
v_mfma_f32_16x16x32_bf16 v[208:211], a[28:31], a[160:163], v[208:211]
v_mfma_f32_16x16x32_bf16 v[212:215], a[28:31], a[164:167], v[212:215]
buffer_load_dwordx4 v19, s[28:31], s58 offen offset:1024 lds
v_mfma_f32_16x16x32_bf16 v[216:219], a[28:31], a[168:171], v[216:219]
s_add_u32 m0, s59, 91520
s_nop 3
v_fmac_f32 v208, v4, v20
v_fmac_f32 v209, v5, v20
v_mfma_f32_16x16x32_bf16 v[220:223], a[28:31], a[172:175], v[220:223]
s_mov_b32 s58, 1441792
v_fmac_f32 v210, v6, v20
v_fmac_f32 v211, v7, v20
v_mfma_f32_16x16x32_bf16 v[160:163], a[64:67], a[176:179], v[160:163]
v_fmac_f32 v212, v4, v22
v_fmac_f32 v213, v5, v22
v_mfma_f32_16x16x32_bf16 v[164:167], a[64:67], a[180:183], v[164:167]
buffer_load_dwordx4 v18, s[28:31], s58 offen lds
v_mfma_f32_16x16x32_bf16 v[168:171], a[64:67], a[184:187], v[168:171]
v_fmac_f32 v214, v6, v22
v_fmac_f32 v215, v7, v22
v_mfma_f32_16x16x32_bf16 v[172:175], a[64:67], a[188:191], v[172:175]
v_fmac_f32 v216, v4, v24
v_fmac_f32 v217, v5, v24
v_mfma_f32_16x16x32_bf16 v[176:179], a[68:71], a[176:179], v[176:179]
v_fmac_f32 v218, v6, v24
v_fmac_f32 v219, v7, v24
v_mfma_f32_16x16x32_bf16 v[180:183], a[68:71], a[180:183], v[180:183]
buffer_load_dwordx4 v19, s[28:31], s58 offen offset:1024 lds
v_mfma_f32_16x16x32_bf16 v[184:187], a[68:71], a[184:187], v[184:187]
s_add_u32 m0, s59, 99840
v_fmac_f32 v220, v4, v26
v_fmac_f32 v221, v5, v26
v_mfma_f32_16x16x32_bf16 v[188:191], a[68:71], a[188:191], v[188:191]
s_mov_b32 s58, 1572864
v_fmac_f32 v222, v6, v26
v_fmac_f32 v223, v7, v26
v_mfma_f32_16x16x32_bf16 v[192:195], a[72:75], a[176:179], v[192:195]
ds_read_b128 v[4:7], v8 offset:64
v_mfma_f32_16x16x32_bf16 v[196:199], a[72:75], a[180:183], v[196:199]
buffer_load_dwordx4 v18, s[28:31], s58 offen lds
v_mfma_f32_16x16x32_bf16 v[200:203], a[72:75], a[184:187], v[200:203]
v_mfma_f32_16x16x32_bf16 v[204:207], a[72:75], a[188:191], v[204:207]
v_mfma_f32_16x16x32_bf16 v[208:211], a[76:79], a[176:179], v[208:211]
v_mfma_f32_16x16x32_bf16 v[212:215], a[76:79], a[180:183], v[212:215]
buffer_load_dwordx4 v19, s[28:31], s58 offen offset:1024 lds
v_mfma_f32_16x16x32_bf16 v[216:219], a[76:79], a[184:187], v[216:219]
s_add_u32 m0, s59, 108160
s_mov_b32 s58, 1703936
v_mfma_f32_16x16x32_bf16 v[220:223], a[76:79], a[188:191], v[220:223]
v_mfma_f32_16x16x32_bf16 v[224:227], a[48:51], a[128:131], v[224:227]
buffer_load_dwordx4 v18, s[28:31], s58 offen lds
v_pk_mul_f32 v[192:193], v[192:193], v[160:161]
v_pk_mul_f32 v[160:161], v[160:161], v[28:29] op_sel_hi:[1,0]
v_exp_f32 v160, v160
v_pk_mul_f32 v[194:195], v[194:195], v[162:163]
v_exp_f32 v161, v161
v_pk_mul_f32 v[162:163], v[162:163], v[28:29] op_sel_hi:[1,0]
v_exp_f32 v162, v162
v_pk_mul_f32 v[208:209], v[208:209], v[176:177]
v_exp_f32 v163, v163
v_pk_mul_f32 v[176:177], v[176:177], v[28:29] op_sel_hi:[1,0]
v_exp_f32 v176, v176
v_pk_mul_f32 v[210:211], v[210:211], v[178:179]
v_exp_f32 v177, v177
v_pk_mul_f32 v[178:179], v[178:179], v[28:29] op_sel_hi:[1,0]
v_exp_f32 v178, v178
v_pk_fma_f32 v[160:161], v[160:161], v[20:21], v[20:21] op_sel:[0,1,1] op_sel_hi:[1,1,1]
v_exp_f32 v179, v179
v_pk_fma_f32 v[162:163], v[162:163], v[20:21], v[20:21] op_sel:[0,1,1] op_sel_hi:[1,1,1]
v_rcp_f32 v160, v160
v_pk_fma_f32 v[176:177], v[176:177], v[20:21], v[20:21] op_sel:[0,1,1] op_sel_hi:[1,1,1]
v_rcp_f32 v161, v161
v_pk_fma_f32 v[178:179], v[178:179], v[20:21], v[20:21] op_sel:[0,1,1] op_sel_hi:[1,1,1]
v_rcp_f32 v162, v162
v_pk_mul_f32 v[192:193], v[192:193], v[160:161]
v_rcp_f32 v163, v163
v_cvt_pk_bf16_f32 v160, v192, v193
v_rcp_f32 v176, v176
v_pk_mul_f32 v[194:195], v[194:195], v[162:163]
v_rcp_f32 v177, v177
v_cvt_pk_bf16_f32 v161, v194, v195
v_rcp_f32 v178, v178
v_pk_mul_f32 v[208:209], v[208:209], v[176:177]
v_rcp_f32 v179, v179
v_cvt_pk_bf16_f32 v162, v208, v209
v_pk_mul_f32 v[196:197], v[196:197], v[164:165]
v_pk_mul_f32 v[210:211], v[210:211], v[178:179]
v_cvt_pk_bf16_f32 v163, v210, v211
buffer_store_dwordx4 v[160:163], v10, s[16:19], s64 offen sc1
v_pk_mul_f32 v[164:165], v[164:165], v[28:29] op_sel:[0,1] op_sel_hi:[1,1]
v_exp_f32 v164, v164
v_pk_mul_f32 v[198:199], v[198:199], v[166:167]
v_exp_f32 v165, v165
v_pk_mul_f32 v[166:167], v[166:167], v[28:29] op_sel:[0,1] op_sel_hi:[1,1]
v_exp_f32 v166, v166
v_pk_mul_f32 v[212:213], v[212:213], v[180:181]
v_exp_f32 v167, v167
v_pk_mul_f32 v[180:181], v[180:181], v[28:29] op_sel:[0,1] op_sel_hi:[1,1]
v_exp_f32 v180, v180
v_pk_mul_f32 v[214:215], v[214:215], v[182:183]
v_exp_f32 v181, v181
v_pk_mul_f32 v[182:183], v[182:183], v[28:29] op_sel:[0,1] op_sel_hi:[1,1]
v_exp_f32 v182, v182
v_pk_fma_f32 v[164:165], v[164:165], v[22:23], v[22:23] op_sel:[0,1,1] op_sel_hi:[1,1,1]
v_exp_f32 v183, v183
v_pk_fma_f32 v[166:167], v[166:167], v[22:23], v[22:23] op_sel:[0,1,1] op_sel_hi:[1,1,1]
v_rcp_f32 v164, v164
v_pk_fma_f32 v[180:181], v[180:181], v[22:23], v[22:23] op_sel:[0,1,1] op_sel_hi:[1,1,1]
v_rcp_f32 v165, v165
v_pk_fma_f32 v[182:183], v[182:183], v[22:23], v[22:23] op_sel:[0,1,1] op_sel_hi:[1,1,1]
v_rcp_f32 v166, v166
v_pk_mul_f32 v[196:197], v[196:197], v[164:165]
v_rcp_f32 v167, v167
v_cvt_pk_bf16_f32 v164, v196, v197
v_rcp_f32 v180, v180
v_pk_mul_f32 v[198:199], v[198:199], v[166:167]
v_rcp_f32 v181, v181
v_cvt_pk_bf16_f32 v165, v198, v199
v_rcp_f32 v182, v182
v_pk_mul_f32 v[212:213], v[212:213], v[180:181]
v_rcp_f32 v183, v183
v_cvt_pk_bf16_f32 v166, v212, v213
v_pk_mul_f32 v[200:201], v[200:201], v[168:169]
v_pk_mul_f32 v[214:215], v[214:215], v[182:183]
v_cvt_pk_bf16_f32 v167, v214, v215
buffer_store_dwordx4 v[164:167], v10, s[16:19], s64 offen offset:1024 sc1
v_pk_mul_f32 v[168:169], v[168:169], v[30:31] op_sel_hi:[1,0]
v_exp_f32 v168, v168
v_pk_mul_f32 v[202:203], v[202:203], v[170:171]
v_exp_f32 v169, v169
v_pk_mul_f32 v[170:171], v[170:171], v[30:31] op_sel_hi:[1,0]
v_exp_f32 v170, v170
v_pk_mul_f32 v[216:217], v[216:217], v[184:185]
v_exp_f32 v171, v171
v_pk_mul_f32 v[184:185], v[184:185], v[30:31] op_sel_hi:[1,0]
v_exp_f32 v184, v184
v_pk_mul_f32 v[218:219], v[218:219], v[186:187]
v_exp_f32 v185, v185
v_pk_mul_f32 v[186:187], v[186:187], v[30:31] op_sel_hi:[1,0]
v_exp_f32 v186, v186
v_pk_fma_f32 v[168:169], v[168:169], v[24:25], v[24:25] op_sel:[0,1,1] op_sel_hi:[1,1,1]
v_exp_f32 v187, v187
v_pk_fma_f32 v[170:171], v[170:171], v[24:25], v[24:25] op_sel:[0,1,1] op_sel_hi:[1,1,1]
v_rcp_f32 v168, v168
v_pk_fma_f32 v[184:185], v[184:185], v[24:25], v[24:25] op_sel:[0,1,1] op_sel_hi:[1,1,1]
v_rcp_f32 v169, v169
v_pk_fma_f32 v[186:187], v[186:187], v[24:25], v[24:25] op_sel:[0,1,1] op_sel_hi:[1,1,1]
v_rcp_f32 v170, v170
v_pk_mul_f32 v[200:201], v[200:201], v[168:169]
v_rcp_f32 v171, v171
v_cvt_pk_bf16_f32 v168, v200, v201
v_rcp_f32 v184, v184
v_pk_mul_f32 v[202:203], v[202:203], v[170:171]
v_rcp_f32 v185, v185
v_cvt_pk_bf16_f32 v169, v202, v203
v_rcp_f32 v186, v186
v_pk_mul_f32 v[216:217], v[216:217], v[184:185]
v_rcp_f32 v187, v187
v_cvt_pk_bf16_f32 v170, v216, v217
v_pk_mul_f32 v[204:205], v[204:205], v[172:173]
v_pk_mul_f32 v[218:219], v[218:219], v[186:187]
v_cvt_pk_bf16_f32 v171, v218, v219
buffer_store_dwordx4 v[168:171], v11, s[16:19], s64 offen sc1
v_pk_mul_f32 v[172:173], v[172:173], v[30:31] op_sel:[0,1] op_sel_hi:[1,1]
v_exp_f32 v172, v172
v_pk_mul_f32 v[206:207], v[206:207], v[174:175]
v_exp_f32 v173, v173
v_pk_mul_f32 v[174:175], v[174:175], v[30:31] op_sel:[0,1] op_sel_hi:[1,1]
v_exp_f32 v174, v174
v_pk_mul_f32 v[220:221], v[220:221], v[188:189]
v_exp_f32 v175, v175
v_pk_mul_f32 v[188:189], v[188:189], v[30:31] op_sel:[0,1] op_sel_hi:[1,1]
v_exp_f32 v188, v188
v_pk_mul_f32 v[222:223], v[222:223], v[190:191]
v_exp_f32 v189, v189
v_pk_mul_f32 v[190:191], v[190:191], v[30:31] op_sel:[0,1] op_sel_hi:[1,1]
v_exp_f32 v190, v190
v_pk_fma_f32 v[172:173], v[172:173], v[26:27], v[26:27] op_sel:[0,1,1] op_sel_hi:[1,1,1]
v_exp_f32 v191, v191
v_pk_fma_f32 v[174:175], v[174:175], v[26:27], v[26:27] op_sel:[0,1,1] op_sel_hi:[1,1,1]
v_rcp_f32 v172, v172
v_pk_fma_f32 v[188:189], v[188:189], v[26:27], v[26:27] op_sel:[0,1,1] op_sel_hi:[1,1,1]
v_rcp_f32 v173, v173
v_pk_fma_f32 v[190:191], v[190:191], v[26:27], v[26:27] op_sel:[0,1,1] op_sel_hi:[1,1,1]
v_rcp_f32 v174, v174
v_pk_mul_f32 v[204:205], v[204:205], v[172:173]
v_rcp_f32 v175, v175
v_cvt_pk_bf16_f32 v172, v204, v205
v_rcp_f32 v188, v188
v_pk_mul_f32 v[206:207], v[206:207], v[174:175]
v_rcp_f32 v189, v189
v_cvt_pk_bf16_f32 v173, v206, v207
v_rcp_f32 v190, v190
v_pk_mul_f32 v[220:221], v[220:221], v[188:189]
v_rcp_f32 v191, v191
v_cvt_pk_bf16_f32 v174, v220, v221
v_pk_mul_f32 v[222:223], v[222:223], v[190:191]
s_nop 1
v_mfma_f32_16x16x32_bf16 v[228:231], a[48:51], a[132:135], v[228:231]
buffer_load_dwordx4 v19, s[28:31], s58 offen offset:1024 lds
v_mfma_f32_16x16x32_bf16 v[232:235], a[52:55], a[128:131], v[232:235]
s_add_u32 m0, s59, 116480
s_waitcnt lgkmcnt(1)
v_fmac_f32 v224, v12, v20
v_fmac_f32 v225, v13, v20
v_mfma_f32_16x16x32_bf16 v[236:239], a[52:55], a[132:135], v[236:239]
s_mov_b32 s58, 1835008
v_fmac_f32 v226, v14, v20
v_fmac_f32 v227, v15, v20
v_mfma_f32_16x16x32_bf16 v[240:243], a[56:59], a[128:131], v[240:243]
v_fmac_f32 v228, v12, v22
v_fmac_f32 v229, v13, v22
v_mfma_f32_16x16x32_bf16 v[244:247], a[56:59], a[132:135], v[244:247]
buffer_load_dwordx4 v18, s[28:31], s58 offen lds
v_mfma_f32_16x16x32_bf16 v[248:251], a[60:63], a[128:131], v[248:251]
v_fmac_f32 v230, v14, v22
v_fmac_f32 v231, v15, v22
v_mfma_f32_16x16x32_bf16 v[252:255], a[60:63], a[132:135], v[252:255]
ds_read_b128 v[12:15], v8 offset:512
s_waitcnt lgkmcnt(1)
v_fmac_f32 v232, v4, v20
v_mfma_f32_16x16x32_bf16 v[224:227], a[80:83], a[144:147], v[224:227]
v_fmac_f32 v233, v5, v20
v_fmac_f32 v234, v6, v20
v_mfma_f32_16x16x32_bf16 v[228:231], a[80:83], a[148:151], v[228:231]
buffer_load_dwordx4 v19, s[28:31], s58 offen offset:1024 lds
v_mfma_f32_16x16x32_bf16 v[240:243], a[88:91], a[144:147], v[240:243]
s_add_u32 m0, s59, 124800
v_fmac_f32 v235, v7, v20
v_fmac_f32 v236, v4, v22
v_mfma_f32_16x16x32_bf16 v[244:247], a[88:91], a[148:151], v[244:247]
s_mov_b32 s58, 1966080
v_fmac_f32 v237, v5, v22
v_fmac_f32 v238, v6, v22
v_mfma_f32_16x16x32_bf16 v[232:235], a[84:87], a[144:147], v[232:235]
v_fmac_f32 v239, v7, v22
v_cvt_pk_bf16_f32 v175, v222, v223
v_mfma_f32_16x16x32_bf16 v[248:251], a[92:95], a[144:147], v[248:251]
ds_read_b128 v[4:7], v8 offset:576
v_mfma_f32_16x16x32_bf16 v[236:239], a[84:87], a[148:151], v[236:239]
buffer_store_dwordx4 v[172:175], v11, s[16:19], s64 offen offset:1024 sc1
v_mfma_f32_16x16x32_bf16 v[252:255], a[92:95], a[148:151], v[252:255]
s_waitcnt lgkmcnt(1)
v_fmac_f32 v240, v12, v20
v_fmac_f32 v241, v13, v20
v_mfma_f32_16x16x32_bf16 v[224:227], a[32:35], a[160:163], v[224:227]
v_fmac_f32 v242, v14, v20
v_fmac_f32 v243, v15, v20
v_mfma_f32_16x16x32_bf16 v[228:231], a[32:35], a[164:167], v[228:231]
v_fmac_f32 v244, v12, v22
v_fmac_f32 v245, v13, v22
v_mfma_f32_16x16x32_bf16 v[232:235], a[36:39], a[160:163], v[232:235]
buffer_load_dwordx4 v18, s[28:31], s58 offen lds
v_mfma_f32_16x16x32_bf16 v[236:239], a[36:39], a[164:167], v[236:239]
v_fmac_f32 v246, v14, v22
v_fmac_f32 v247, v15, v22
v_mfma_f32_16x16x32_bf16 v[240:243], a[40:43], a[160:163], v[240:243]
s_nop 0
v_mfma_f32_16x16x32_bf16 v[244:247], a[40:43], a[164:167], v[244:247]
v_mfma_f32_16x16x32_bf16 v[248:251], a[44:47], a[160:163], v[248:251]
buffer_load_dwordx4 v19, s[28:31], s58 offen offset:1024 lds
v_mfma_f32_16x16x32_bf16 v[252:255], a[44:47], a[164:167], v[252:255]
v_mfma_f32_16x16x32_bf16 v[224:227], a[0:3], a[176:179], v[224:227]
s_nop 3
s_waitcnt lgkmcnt(0)
v_fmac_f32 v248, v4, v20
v_fmac_f32 v249, v5, v20
v_mfma_f32_16x16x32_bf16 v[228:231], a[0:3], a[180:183], v[228:231]
v_fmac_f32 v250, v6, v20
v_fmac_f32 v251, v7, v20
v_mfma_f32_16x16x32_bf16 v[232:235], a[4:7], a[176:179], v[232:235]
v_fmac_f32 v252, v4, v22
v_fmac_f32 v253, v5, v22
v_mfma_f32_16x16x32_bf16 v[236:239], a[4:7], a[180:183], v[236:239]
v_fmac_f32 v254, v6, v22
v_fmac_f32 v255, v7, v22
v_mfma_f32_16x16x32_bf16 v[240:243], a[8:11], a[176:179], v[240:243]
v_mfma_f32_16x16x32_bf16 v[244:247], a[8:11], a[180:183], v[244:247]
v_mfma_f32_16x16x32_bf16 v[248:251], a[12:15], a[176:179], v[248:251]
v_mfma_f32_16x16x32_bf16 v[252:255], a[12:15], a[180:183], v[252:255]
s_nop 4
v_pk_mul_f32 v[240:241], v[240:241], v[224:225]
v_pk_mul_f32 v[224:225], v[224:225], v[28:29] op_sel_hi:[1,0]
v_exp_f32 v224, v224
v_pk_mul_f32 v[242:243], v[242:243], v[226:227]
v_exp_f32 v225, v225
v_pk_mul_f32 v[226:227], v[226:227], v[28:29] op_sel_hi:[1,0]
v_exp_f32 v226, v226
v_pk_mul_f32 v[248:249], v[248:249], v[232:233]
v_exp_f32 v227, v227
v_pk_mul_f32 v[232:233], v[232:233], v[28:29] op_sel_hi:[1,0]
v_exp_f32 v232, v232
v_pk_mul_f32 v[250:251], v[250:251], v[234:235]
v_exp_f32 v233, v233
v_pk_mul_f32 v[234:235], v[234:235], v[28:29] op_sel_hi:[1,0]
v_exp_f32 v234, v234
v_pk_fma_f32 v[224:225], v[224:225], v[20:21], v[20:21] op_sel:[0,1,1] op_sel_hi:[1,1,1]
v_exp_f32 v235, v235
v_pk_fma_f32 v[226:227], v[226:227], v[20:21], v[20:21] op_sel:[0,1,1] op_sel_hi:[1,1,1]
v_rcp_f32 v224, v224
v_pk_fma_f32 v[232:233], v[232:233], v[20:21], v[20:21] op_sel:[0,1,1] op_sel_hi:[1,1,1]
v_rcp_f32 v225, v225
v_pk_fma_f32 v[234:235], v[234:235], v[20:21], v[20:21] op_sel:[0,1,1] op_sel_hi:[1,1,1]
v_rcp_f32 v226, v226
v_pk_mul_f32 v[240:241], v[240:241], v[224:225]
v_rcp_f32 v227, v227
v_cvt_pk_bf16_f32 v224, v240, v241
v_rcp_f32 v232, v232
v_pk_mul_f32 v[242:243], v[242:243], v[226:227]
v_rcp_f32 v233, v233
v_cvt_pk_bf16_f32 v225, v242, v243
v_rcp_f32 v234, v234
v_pk_mul_f32 v[248:249], v[248:249], v[232:233]
v_rcp_f32 v235, v235
v_cvt_pk_bf16_f32 v226, v248, v249
v_pk_mul_f32 v[244:245], v[244:245], v[228:229]
v_pk_mul_f32 v[250:251], v[250:251], v[234:235]
v_cvt_pk_bf16_f32 v227, v250, v251
buffer_store_dwordx4 v[224:227], v10, s[16:19], s65 offen sc1
v_pk_mul_f32 v[228:229], v[228:229], v[28:29] op_sel:[0,1] op_sel_hi:[1,1]
v_exp_f32 v228, v228
v_pk_mul_f32 v[246:247], v[246:247], v[230:231]
v_exp_f32 v229, v229
v_pk_mul_f32 v[230:231], v[230:231], v[28:29] op_sel:[0,1] op_sel_hi:[1,1]
v_exp_f32 v230, v230
v_pk_mul_f32 v[252:253], v[252:253], v[236:237]
v_exp_f32 v231, v231
v_pk_mul_f32 v[236:237], v[236:237], v[28:29] op_sel:[0,1] op_sel_hi:[1,1]
v_exp_f32 v236, v236
v_pk_mul_f32 v[254:255], v[254:255], v[238:239]
v_exp_f32 v237, v237
v_pk_mul_f32 v[238:239], v[238:239], v[28:29] op_sel:[0,1] op_sel_hi:[1,1]
v_exp_f32 v238, v238
v_pk_fma_f32 v[228:229], v[228:229], v[22:23], v[22:23] op_sel:[0,1,1] op_sel_hi:[1,1,1]
v_exp_f32 v239, v239
v_pk_fma_f32 v[230:231], v[230:231], v[22:23], v[22:23] op_sel:[0,1,1] op_sel_hi:[1,1,1]
v_rcp_f32 v228, v228
v_pk_fma_f32 v[236:237], v[236:237], v[22:23], v[22:23] op_sel:[0,1,1] op_sel_hi:[1,1,1]
v_rcp_f32 v229, v229
v_pk_fma_f32 v[238:239], v[238:239], v[22:23], v[22:23] op_sel:[0,1,1] op_sel_hi:[1,1,1]
v_rcp_f32 v230, v230
v_pk_mul_f32 v[244:245], v[244:245], v[228:229]
v_rcp_f32 v231, v231
v_cvt_pk_bf16_f32 v228, v244, v245
v_rcp_f32 v236, v236
v_pk_mul_f32 v[246:247], v[246:247], v[230:231]
v_rcp_f32 v237, v237
v_cvt_pk_bf16_f32 v229, v246, v247
v_rcp_f32 v238, v238
v_pk_mul_f32 v[252:253], v[252:253], v[236:237]
v_rcp_f32 v239, v239
v_cvt_pk_bf16_f32 v230, v252, v253
v_pk_mul_f32 v[254:255], v[254:255], v[238:239]
v_cvt_pk_bf16_f32 v231, v254, v255
buffer_store_dwordx4 v[228:231], v10, s[16:19], s65 offen offset:1024 sc1
s_nop 1
s_lshl_b32 s62, s5, 2
s_add_u32 s62, s62, s3
s_lshl_b32 s62, s62, 13
s_and_b32 s63, s7, 8
s_lshl_b32 s63, s63, 7
s_add_u32 s62, s62, s63
s_lshr_b32 s63, s28, 7
s_sub_u32 s63, 3, s63
s_and_b32 s63, s63, 7
s_lshl_b32 s63, s63, 7
s_add_u32 s62, s62, s63
.Lpad28:
s_cbranch_execz .Lnopoll42r
v_lshrrev_b32 v9, 4, v1
v_lshl_add_u32 v9, v9, 11, s62
s_mov_b32 s44, 2097152
buffer_load_dword v27, v9, s[28:31], s44 offen
s_add_u32 s44, s44, 0x100000
s_lshl_b32 s62, s6, 13
s_lshl_b32 s63, s3, 11
s_add_u32 s62, s62, s63
v_lshl_add_u32 v4, v1, 4, s62
v_lshrrev_b32 v2, 3, v1
v_cmp_eq_u32 vcc, 3, v2
v_add_u32 v2, 67108480, v4
s_nop 0
v_cndmask_b32 v4, v4, v2, vcc
v_bfe_u32 v5, v1, 3, 1
v_lshrrev_b32 v2, 4, v1
v_lshl_add_u32 v5, v2, 3, v5
s_lshl_b32 s62, s3, 1
v_add_u32 v5, s62, v5
v_mul_u32_u24 v5, 2048, v5
v_and_b32 v2, 7, v1
v_lshl_add_u32 v5, v2, 4, v5
s_lshl_b32 s62, s7, 7
v_add_u32 v5, s62, v5
v_add_u32 v6, 64512, v5
v_bfe_u32 v8, v1, 3, 2
v_mul_u32_u24 v8, 2080, v8
v_bfe_u32 v2, v1, 2, 1
v_lshl_add_u32 v8, v2, 7, v8
v_bfe_u32 v2, v1, 5, 1
v_lshl_add_u32 v8, v2, 8, v8
v_and_b32 v2, 3, v1
v_lshl_add_u32 v8, v2, 3, v8
s_mov_b32 s57, 0
v_add_u32 v7, s57, v8
s_mov_b32 s52, 46137344
s_mov_b32 s53, 46268416
s_mov_b32 s54, 2097152
s_mul_i32 s56, s3, 2080
v_accvgpr_read_b32 v32, a224
v_accvgpr_read_b32 v33, a225
v_accvgpr_read_b32 v34, a226
v_accvgpr_read_b32 v35, a227
v_accvgpr_read_b32 v36, a228
v_accvgpr_read_b32 v37, a229
v_accvgpr_read_b32 v38, a230
v_accvgpr_read_b32 v39, a231
v_accvgpr_read_b32 v40, a232
v_accvgpr_read_b32 v41, a233
v_accvgpr_read_b32 v42, a234
v_accvgpr_read_b32 v43, a235
v_accvgpr_read_b32 v44, a236
v_accvgpr_read_b32 v45, a237
v_accvgpr_read_b32 v46, a238
v_accvgpr_read_b32 v47, a239
v_accvgpr_read_b32 v48, a240
v_accvgpr_read_b32 v49, a241
v_accvgpr_read_b32 v50, a242
v_accvgpr_read_b32 v51, a243
v_accvgpr_read_b32 v52, a244
v_accvgpr_read_b32 v53, a245
v_accvgpr_read_b32 v54, a246
v_accvgpr_read_b32 v55, a247
v_accvgpr_read_b32 v56, a248
v_accvgpr_read_b32 v57, a249
v_accvgpr_read_b32 v58, a250
v_accvgpr_read_b32 v59, a251
v_accvgpr_read_b32 v60, a252
v_accvgpr_read_b32 v61, a253
v_accvgpr_read_b32 v62, a254
v_accvgpr_read_b32 v63, a255
s_lshr_b32 s62, s6, 1
s_lshl_b32 s62, s62, 8
s_and_b32 s63, s6, 1
s_add_u32 s62, s62, s63
s_lshl_b32 s63, s3, 6
s_add_u32 s62, s62, s63
s_lshl_b32 s62, s62, 11
s_lshl_b32 s63, s7, 7
s_add_u32 s62, s62, s63
v_and_b32 v160, 15, v1
v_lshlrev_b32 v160, 12, v160
v_bfe_u32 v2, v1, 4, 1
v_lshl_add_u32 v160, v2, 5, v160
v_bfe_u32 v2, v1, 5, 1
v_lshl_add_u32 v160, v2, 4, v160
v_add_u32 v160, s62, v160
v_add_u32 v161, 0x10000, v160
s_lshl_b32 s62, s10, 1
s_add_u32 s62, s62, s12
s_lshl_b32 s62, s62, 7
s_add_u32 s62, s62, 30423040
s_and_b32 s64, s6, 14
s_lshl_b32 s64, s64, 7
s_add_u32 s64, s64, 30423040
s_add_u32 s65, s64, 128
v_mov_b32 v252, s62
v_mov_b32 v253, s64
v_writelane_b32 v253, s65, 1
s_waitcnt vmcnt(0) lgkmcnt(0)
s_barrier
s_cmp_lg_u32 s3, 0
s_cbranch_scc1 .Lnosig44
v_mov_b32 v255, 1
s_mov_b64 exec, 1
buffer_atomic_add v255, v252, s[16:19], 0 offen
s_mov_b64 exec, -1
.Lnosig44:
ds_read_b64_tr_b16 a[0:1], v7
ds_read_b64_tr_b16 a[2:3], v7 offset:512
ds_read_b64_tr_b16 a[4:5], v7 offset:32
ds_read_b64_tr_b16 a[6:7], v7 offset:544
ds_read_b64_tr_b16 a[8:9], v7 offset:64
ds_read_b64_tr_b16 a[10:11], v7 offset:576
ds_read_b64_tr_b16 a[12:13], v7 offset:96
ds_read_b64_tr_b16 a[14:15], v7 offset:608
ds_read_b64_tr_b16 a[16:17], v7 offset:1024
ds_read_b64_tr_b16 a[18:19], v7 offset:1536
ds_read_b64_tr_b16 a[20:21], v7 offset:1056
ds_read_b64_tr_b16 a[22:23], v7 offset:1568
ds_read_b64_tr_b16 a[24:25], v7 offset:1088
ds_read_b64_tr_b16 a[26:27], v7 offset:1600
ds_read_b64_tr_b16 a[28:29], v7 offset:1120
ds_read_b64_tr_b16 a[30:31], v7 offset:1632
s_waitcnt lgkmcnt(0)
s_cmp_lg_u32 s3, 1
s_cbranch_scc1 .Lnopoll47
s_mov_b64 exec, 3
s_mov_b32 s15, 0
.Lpoll45:
buffer_load_dword v255, v253, s[16:19], 0 offen sc1
s_add_u32 s15, s15, 1
s_cmp_gt_u32 s15, 100000
s_cbranch_scc1 .Lgot46
s_waitcnt vmcnt(0)
v_cmp_ne_u32 vcc, 16, v255
s_nop 0
s_cbranch_vccnz .Lpoll45
.Lgot46:
s_waitcnt vmcnt(0)
s_branch .Lnopoll47r
.Lnopoll47:
s_mov_b64 exec, 0
s_cmp_eq_u32 s3, 2
s_cbranch_scc1 .Lpad29
s_cmp_eq_u32 s3, 3
s_cbranch_scc1 .Lpad30
s_branch .Lnopoll47r
.Lnopoll47r:
s_mov_b64 exec, -1
s_barrier
buffer_load_dwordx4 v[64:67], v4, s[16:19], s52 offen sc1
buffer_load_dwordx4 v[68:71], v4, s[16:19], s52 offen offset:1024 sc1
s_add_u32 s52, s52, 0x40000
buffer_load_dwordx4 v[72:75], v4, s[16:19], s53 offen sc1
buffer_load_dwordx4 v[76:79], v4, s[16:19], s53 offen offset:1024 sc1
s_add_u32 s53, s53, 0x40000
buffer_load_dwordx4 v[80:83], v4, s[16:19], s52 offen sc1
buffer_load_dwordx4 v[84:87], v4, s[16:19], s52 offen offset:1024 sc1
s_add_u32 s52, s52, 0x40000
buffer_load_dwordx4 v[88:91], v4, s[16:19], s53 offen sc1
buffer_load_dwordx4 v[92:95], v4, s[16:19], s53 offen offset:1024 sc1
s_add_u32 s53, s53, 0x40000
buffer_load_dwordx4 v[96:99], v4, s[16:19], s52 offen sc1
buffer_load_dwordx4 v[100:103], v4, s[16:19], s52 offen offset:1024 sc1
s_add_u32 s52, s52, 0x40000
buffer_load_dwordx4 v[104:107], v4, s[16:19], s53 offen sc1
buffer_load_dwordx4 v[108:111], v4, s[16:19], s53 offen offset:1024 sc1
s_add_u32 s53, s53, 0x40000
s_mov_b32 s15, 5
.p2align 6
.Lk48:
s_waitcnt lgkmcnt(0)
s_barrier
s_add_u32 s55, s56, s57
s_waitcnt vmcnt(11)
v_mfma_f32_16x16x32_bf16 v[32:35], a[0:3], v[64:67], v[32:35]
ds_read_b64_tr_b16 a[32:33], v7 offset:8320
ds_read_b64_tr_b16 a[34:35], v7 offset:8832
s_add_u32 m0, s55, 0
s_waitcnt vmcnt(10)
v_mfma_f32_16x16x32_bf16 v[48:51], a[0:3], v[68:71], v[48:51]
ds_read_b64_tr_b16 a[36:37], v7 offset:8352
buffer_load_dwordx4 v5, s[28:31], s54 offen lds
v_mfma_f32_16x16x32_bf16 v[36:39], a[4:7], v[64:67], v[36:39]
ds_read_b64_tr_b16 a[38:39], v7 offset:8864
ds_read_b64_tr_b16 a[40:41], v7 offset:8384
v_mfma_f32_16x16x32_bf16 v[52:55], a[4:7], v[68:71], v[52:55]
ds_read_b64_tr_b16 a[42:43], v7 offset:8896
buffer_load_dwordx4 v[112:115], v4, s[16:19], s52 offen sc1
v_mfma_f32_16x16x32_bf16 v[40:43], a[8:11], v[64:67], v[40:43]
ds_read_b64_tr_b16 a[44:45], v7 offset:8416
ds_read_b64_tr_b16 a[46:47], v7 offset:8928
v_mfma_f32_16x16x32_bf16 v[56:59], a[8:11], v[68:71], v[56:59]
ds_read_b64_tr_b16 a[48:49], v7 offset:9344
buffer_load_dwordx4 v[116:119], v4, s[16:19], s52 offen offset:1024 sc1
v_mfma_f32_16x16x32_bf16 v[44:47], a[12:15], v[64:67], v[44:47]
ds_read_b64_tr_b16 a[50:51], v7 offset:9856
ds_read_b64_tr_b16 a[52:53], v7 offset:9376
s_add_u32 s52, s52, 0x40000
v_mfma_f32_16x16x32_bf16 v[60:63], a[12:15], v[68:71], v[60:63]
ds_read_b64_tr_b16 a[54:55], v7 offset:9888
ds_read_b64_tr_b16 a[56:57], v7 offset:9408
s_waitcnt vmcnt(12)
v_mfma_f32_16x16x32_bf16 v[32:35], a[16:19], v[72:75], v[32:35]
ds_read_b64_tr_b16 a[58:59], v7 offset:9920
buffer_load_dwordx4 v6, s[28:31], s54 offen offset:1024 lds
s_waitcnt vmcnt(12)
v_mfma_f32_16x16x32_bf16 v[48:51], a[16:19], v[76:79], v[48:51]
ds_read_b64_tr_b16 a[60:61], v7 offset:9440
ds_read_b64_tr_b16 a[62:63], v7 offset:9952
s_add_u32 s54, s54, 0x20000
v_mfma_f32_16x16x32_bf16 v[36:39], a[20:23], v[72:75], v[36:39]
buffer_load_dwordx4 v[120:123], v4, s[16:19], s53 offen sc1
v_mfma_f32_16x16x32_bf16 v[52:55], a[20:23], v[76:79], v[52:55]
v_mfma_f32_16x16x32_bf16 v[40:43], a[24:27], v[72:75], v[40:43]
buffer_load_dwordx4 v[124:127], v4, s[16:19], s53 offen offset:1024 sc1
v_mfma_f32_16x16x32_bf16 v[56:59], a[24:27], v[76:79], v[56:59]
s_add_u32 s53, s53, 0x40000
v_mfma_f32_16x16x32_bf16 v[44:47], a[28:31], v[72:75], v[44:47]
v_mfma_f32_16x16x32_bf16 v[60:63], a[28:31], v[76:79], v[60:63]
s_waitcnt lgkmcnt(0)
s_barrier
s_waitcnt vmcnt(13)
v_mfma_f32_16x16x32_bf16 v[32:35], a[32:35], v[80:83], v[32:35]
ds_read_b64_tr_b16 a[0:1], v7 offset:16640
ds_read_b64_tr_b16 a[2:3], v7 offset:17152
s_add_u32 m0, s55, 8320
s_waitcnt vmcnt(12)
v_mfma_f32_16x16x32_bf16 v[48:51], a[32:35], v[84:87], v[48:51]
ds_read_b64_tr_b16 a[4:5], v7 offset:16672
buffer_load_dwordx4 v5, s[28:31], s54 offen lds
v_mfma_f32_16x16x32_bf16 v[36:39], a[36:39], v[80:83], v[36:39]
ds_read_b64_tr_b16 a[6:7], v7 offset:17184
ds_read_b64_tr_b16 a[8:9], v7 offset:16704
v_mfma_f32_16x16x32_bf16 v[52:55], a[36:39], v[84:87], v[52:55]
ds_read_b64_tr_b16 a[10:11], v7 offset:17216
buffer_load_dwordx4 v[64:67], v4, s[16:19], s52 offen sc1
v_mfma_f32_16x16x32_bf16 v[40:43], a[40:43], v[80:83], v[40:43]
ds_read_b64_tr_b16 a[12:13], v7 offset:16736
ds_read_b64_tr_b16 a[14:15], v7 offset:17248
v_mfma_f32_16x16x32_bf16 v[56:59], a[40:43], v[84:87], v[56:59]
ds_read_b64_tr_b16 a[16:17], v7 offset:17664
buffer_load_dwordx4 v[68:71], v4, s[16:19], s52 offen offset:1024 sc1
v_mfma_f32_16x16x32_bf16 v[44:47], a[44:47], v[80:83], v[44:47]
ds_read_b64_tr_b16 a[18:19], v7 offset:18176
ds_read_b64_tr_b16 a[20:21], v7 offset:17696
s_add_u32 s52, s52, 0x40000
v_mfma_f32_16x16x32_bf16 v[60:63], a[44:47], v[84:87], v[60:63]
ds_read_b64_tr_b16 a[22:23], v7 offset:18208
buffer_load_dwordx4 v6, s[28:31], s54 offen offset:1024 lds
s_waitcnt vmcnt(15)
v_mfma_f32_16x16x32_bf16 v[32:35], a[48:51], v[88:91], v[32:35]
ds_read_b64_tr_b16 a[24:25], v7 offset:17728
ds_read_b64_tr_b16 a[26:27], v7 offset:18240
s_add_u32 s54, s54, 0x20000
s_waitcnt vmcnt(14)
v_mfma_f32_16x16x32_bf16 v[48:51], a[48:51], v[92:95], v[48:51]
ds_read_b64_tr_b16 a[28:29], v7 offset:17760
buffer_load_dwordx4 v[72:75], v4, s[16:19], s53 offen sc1
v_mfma_f32_16x16x32_bf16 v[36:39], a[52:55], v[88:91], v[36:39]
ds_read_b64_tr_b16 a[30:31], v7 offset:18272
v_mfma_f32_16x16x32_bf16 v[52:55], a[52:55], v[92:95], v[52:55]
buffer_load_dwordx4 v[76:79], v4, s[16:19], s53 offen offset:1024 sc1
v_mfma_f32_16x16x32_bf16 v[40:43], a[56:59], v[88:91], v[40:43]
s_add_u32 s53, s53, 0x40000
v_mfma_f32_16x16x32_bf16 v[56:59], a[56:59], v[92:95], v[56:59]
buffer_load_dword v27, v9, s[28:31], s44 offen
v_mfma_f32_16x16x32_bf16 v[44:47], a[60:63], v[88:91], v[44:47]
s_add_u32 s44, s44, 0x100000
v_mfma_f32_16x16x32_bf16 v[60:63], a[60:63], v[92:95], v[60:63]
s_waitcnt lgkmcnt(0)
s_barrier
s_waitcnt vmcnt(16)
v_mfma_f32_16x16x32_bf16 v[32:35], a[0:3], v[96:99], v[32:35]
ds_read_b64_tr_b16 a[32:33], v7 offset:24960
ds_read_b64_tr_b16 a[34:35], v7 offset:25472
s_add_u32 m0, s55, 16640
s_waitcnt vmcnt(15)
v_mfma_f32_16x16x32_bf16 v[48:51], a[0:3], v[100:103], v[48:51]
ds_read_b64_tr_b16 a[36:37], v7 offset:24992
buffer_load_dwordx4 v5, s[28:31], s54 offen lds
v_mfma_f32_16x16x32_bf16 v[36:39], a[4:7], v[96:99], v[36:39]
ds_read_b64_tr_b16 a[38:39], v7 offset:25504
ds_read_b64_tr_b16 a[40:41], v7 offset:25024
v_mfma_f32_16x16x32_bf16 v[52:55], a[4:7], v[100:103], v[52:55]
ds_read_b64_tr_b16 a[42:43], v7 offset:25536
buffer_load_dwordx4 v[80:83], v4, s[16:19], s52 offen sc1
v_mfma_f32_16x16x32_bf16 v[40:43], a[8:11], v[96:99], v[40:43]
ds_read_b64_tr_b16 a[44:45], v7 offset:25056
ds_read_b64_tr_b16 a[46:47], v7 offset:25568
v_mfma_f32_16x16x32_bf16 v[56:59], a[8:11], v[100:103], v[56:59]
ds_read_b64_tr_b16 a[48:49], v7 offset:25984
buffer_load_dwordx4 v[84:87], v4, s[16:19], s52 offen offset:1024 sc1
v_mfma_f32_16x16x32_bf16 v[44:47], a[12:15], v[96:99], v[44:47]
ds_read_b64_tr_b16 a[50:51], v7 offset:26496
ds_read_b64_tr_b16 a[52:53], v7 offset:26016
s_add_u32 s52, s52, 0x40000
v_mfma_f32_16x16x32_bf16 v[60:63], a[12:15], v[100:103], v[60:63]
ds_read_b64_tr_b16 a[54:55], v7 offset:26528
ds_read_b64_tr_b16 a[56:57], v7 offset:26048
s_waitcnt vmcnt(17)
v_mfma_f32_16x16x32_bf16 v[32:35], a[16:19], v[104:107], v[32:35]
ds_read_b64_tr_b16 a[58:59], v7 offset:26560
buffer_load_dwordx4 v6, s[28:31], s54 offen offset:1024 lds
s_waitcnt vmcnt(17)
v_mfma_f32_16x16x32_bf16 v[48:51], a[16:19], v[108:111], v[48:51]
ds_read_b64_tr_b16 a[60:61], v7 offset:26080
ds_read_b64_tr_b16 a[62:63], v7 offset:26592
s_add_u32 s54, s54, 0x20000
v_mfma_f32_16x16x32_bf16 v[36:39], a[20:23], v[104:107], v[36:39]
buffer_load_dwordx4 v[88:91], v4, s[16:19], s53 offen sc1
v_mfma_f32_16x16x32_bf16 v[52:55], a[20:23], v[108:111], v[52:55]
v_mfma_f32_16x16x32_bf16 v[40:43], a[24:27], v[104:107], v[40:43]
buffer_load_dwordx4 v[92:95], v4, s[16:19], s53 offen offset:1024 sc1
v_mfma_f32_16x16x32_bf16 v[56:59], a[24:27], v[108:111], v[56:59]
s_add_u32 s53, s53, 0x40000
v_mfma_f32_16x16x32_bf16 v[44:47], a[28:31], v[104:107], v[44:47]
v_mfma_f32_16x16x32_bf16 v[60:63], a[28:31], v[108:111], v[60:63]
s_waitcnt lgkmcnt(0)
s_barrier
s_waitcnt vmcnt(17)
v_mfma_f32_16x16x32_bf16 v[32:35], a[32:35], v[112:115], v[32:35]
ds_read_b64_tr_b16 a[0:1], v7 offset:33280
ds_read_b64_tr_b16 a[2:3], v7 offset:33792
s_add_u32 m0, s55, 24960
s_waitcnt vmcnt(16)
v_mfma_f32_16x16x32_bf16 v[48:51], a[32:35], v[116:119], v[48:51]
ds_read_b64_tr_b16 a[4:5], v7 offset:33312
buffer_load_dwordx4 v5, s[28:31], s54 offen lds
v_mfma_f32_16x16x32_bf16 v[36:39], a[36:39], v[112:115], v[36:39]
ds_read_b64_tr_b16 a[6:7], v7 offset:33824
ds_read_b64_tr_b16 a[8:9], v7 offset:33344
v_mfma_f32_16x16x32_bf16 v[52:55], a[36:39], v[116:119], v[52:55]
ds_read_b64_tr_b16 a[10:11], v7 offset:33856
buffer_load_dwordx4 v[96:99], v4, s[16:19], s52 offen sc1
v_mfma_f32_16x16x32_bf16 v[40:43], a[40:43], v[112:115], v[40:43]
ds_read_b64_tr_b16 a[12:13], v7 offset:33376
ds_read_b64_tr_b16 a[14:15], v7 offset:33888
v_mfma_f32_16x16x32_bf16 v[56:59], a[40:43], v[116:119], v[56:59]
ds_read_b64_tr_b16 a[16:17], v7 offset:34304
buffer_load_dwordx4 v[100:103], v4, s[16:19], s52 offen offset:1024 sc1
v_mfma_f32_16x16x32_bf16 v[44:47], a[44:47], v[112:115], v[44:47]
ds_read_b64_tr_b16 a[18:19], v7 offset:34816
ds_read_b64_tr_b16 a[20:21], v7 offset:34336
s_add_u32 s52, s52, 0x40000
v_mfma_f32_16x16x32_bf16 v[60:63], a[44:47], v[116:119], v[60:63]
ds_read_b64_tr_b16 a[22:23], v7 offset:34848
ds_read_b64_tr_b16 a[24:25], v7 offset:34368
s_waitcnt vmcnt(17)
v_mfma_f32_16x16x32_bf16 v[32:35], a[48:51], v[120:123], v[32:35]
ds_read_b64_tr_b16 a[26:27], v7 offset:34880
buffer_load_dwordx4 v6, s[28:31], s54 offen offset:1024 lds
s_waitcnt vmcnt(17)
v_mfma_f32_16x16x32_bf16 v[48:51], a[48:51], v[124:127], v[48:51]
ds_read_b64_tr_b16 a[28:29], v7 offset:34400
ds_read_b64_tr_b16 a[30:31], v7 offset:34912
s_add_u32 s54, s54, 0x20000
v_mfma_f32_16x16x32_bf16 v[36:39], a[52:55], v[120:123], v[36:39]
buffer_load_dwordx4 v[104:107], v4, s[16:19], s53 offen sc1
v_mfma_f32_16x16x32_bf16 v[52:55], a[52:55], v[124:127], v[52:55]
v_mfma_f32_16x16x32_bf16 v[40:43], a[56:59], v[120:123], v[40:43]
buffer_load_dwordx4 v[108:111], v4, s[16:19], s53 offen offset:1024 sc1
v_mfma_f32_16x16x32_bf16 v[56:59], a[56:59], v[124:127], v[56:59]
s_add_u32 s53, s53, 0x40000
v_mfma_f32_16x16x32_bf16 v[44:47], a[60:63], v[120:123], v[44:47]
v_mfma_f32_16x16x32_bf16 v[60:63], a[60:63], v[124:127], v[60:63]
s_waitcnt lgkmcnt(0)
s_barrier
s_waitcnt vmcnt(17)
v_mfma_f32_16x16x32_bf16 v[32:35], a[0:3], v[64:67], v[32:35]
ds_read_b64_tr_b16 a[32:33], v7 offset:41600
ds_read_b64_tr_b16 a[34:35], v7 offset:42112
s_add_u32 m0, s55, 33280
s_waitcnt vmcnt(16)
v_mfma_f32_16x16x32_bf16 v[48:51], a[0:3], v[68:71], v[48:51]
ds_read_b64_tr_b16 a[36:37], v7 offset:41632
buffer_load_dwordx4 v5, s[28:31], s54 offen lds
v_mfma_f32_16x16x32_bf16 v[36:39], a[4:7], v[64:67], v[36:39]
ds_read_b64_tr_b16 a[38:39], v7 offset:42144
ds_read_b64_tr_b16 a[40:41], v7 offset:41664
v_mfma_f32_16x16x32_bf16 v[52:55], a[4:7], v[68:71], v[52:55]
ds_read_b64_tr_b16 a[42:43], v7 offset:42176
buffer_load_dwordx4 v[112:115], v4, s[16:19], s52 offen sc1
v_mfma_f32_16x16x32_bf16 v[40:43], a[8:11], v[64:67], v[40:43]
ds_read_b64_tr_b16 a[44:45], v7 offset:41696
ds_read_b64_tr_b16 a[46:47], v7 offset:42208
v_mfma_f32_16x16x32_bf16 v[56:59], a[8:11], v[68:71], v[56:59]
ds_read_b64_tr_b16 a[48:49], v7 offset:42624
buffer_load_dwordx4 v[116:119], v4, s[16:19], s52 offen offset:1024 sc1
v_mfma_f32_16x16x32_bf16 v[44:47], a[12:15], v[64:67], v[44:47]
ds_read_b64_tr_b16 a[50:51], v7 offset:43136
ds_read_b64_tr_b16 a[52:53], v7 offset:42656
s_add_u32 s52, s52, 0x40000
v_mfma_f32_16x16x32_bf16 v[60:63], a[12:15], v[68:71], v[60:63]
ds_read_b64_tr_b16 a[54:55], v7 offset:43168
ds_read_b64_tr_b16 a[56:57], v7 offset:42688
s_waitcnt vmcnt(17)
v_mfma_f32_16x16x32_bf16 v[32:35], a[16:19], v[72:75], v[32:35]
ds_read_b64_tr_b16 a[58:59], v7 offset:43200
buffer_load_dwordx4 v6, s[28:31], s54 offen offset:1024 lds
s_waitcnt vmcnt(17)
v_mfma_f32_16x16x32_bf16 v[48:51], a[16:19], v[76:79], v[48:51]
ds_read_b64_tr_b16 a[60:61], v7 offset:42720
ds_read_b64_tr_b16 a[62:63], v7 offset:43232
s_add_u32 s54, s54, 0x20000
v_mfma_f32_16x16x32_bf16 v[36:39], a[20:23], v[72:75], v[36:39]
buffer_load_dwordx4 v[120:123], v4, s[16:19], s53 offen sc1
v_mfma_f32_16x16x32_bf16 v[52:55], a[20:23], v[76:79], v[52:55]
v_mfma_f32_16x16x32_bf16 v[40:43], a[24:27], v[72:75], v[40:43]
buffer_load_dwordx4 v[124:127], v4, s[16:19], s53 offen offset:1024 sc1
v_mfma_f32_16x16x32_bf16 v[56:59], a[24:27], v[76:79], v[56:59]
s_add_u32 s53, s53, 0x40000
v_mfma_f32_16x16x32_bf16 v[44:47], a[28:31], v[72:75], v[44:47]
v_mfma_f32_16x16x32_bf16 v[60:63], a[28:31], v[76:79], v[60:63]
s_waitcnt lgkmcnt(0)
s_barrier
s_waitcnt vmcnt(16)
v_mfma_f32_16x16x32_bf16 v[32:35], a[32:35], v[80:83], v[32:35]
ds_read_b64_tr_b16 a[0:1], v7 offset:49920
ds_read_b64_tr_b16 a[2:3], v7 offset:50432
s_add_u32 m0, s55, 41600
s_waitcnt vmcnt(15)
v_mfma_f32_16x16x32_bf16 v[48:51], a[32:35], v[84:87], v[48:51]
ds_read_b64_tr_b16 a[4:5], v7 offset:49952
buffer_load_dwordx4 v5, s[28:31], s54 offen lds
v_mfma_f32_16x16x32_bf16 v[36:39], a[36:39], v[80:83], v[36:39]
ds_read_b64_tr_b16 a[6:7], v7 offset:50464
ds_read_b64_tr_b16 a[8:9], v7 offset:49984
v_mfma_f32_16x16x32_bf16 v[52:55], a[36:39], v[84:87], v[52:55]
ds_read_b64_tr_b16 a[10:11], v7 offset:50496
buffer_load_dwordx4 v[64:67], v4, s[16:19], s52 offen sc1
v_mfma_f32_16x16x32_bf16 v[40:43], a[40:43], v[80:83], v[40:43]
ds_read_b64_tr_b16 a[12:13], v7 offset:50016
ds_read_b64_tr_b16 a[14:15], v7 offset:50528
v_mfma_f32_16x16x32_bf16 v[56:59], a[40:43], v[84:87], v[56:59]
ds_read_b64_tr_b16 a[16:17], v7 offset:50944
buffer_load_dwordx4 v[68:71], v4, s[16:19], s52 offen offset:1024 sc1
v_mfma_f32_16x16x32_bf16 v[44:47], a[44:47], v[80:83], v[44:47]
ds_read_b64_tr_b16 a[18:19], v7 offset:51456
ds_read_b64_tr_b16 a[20:21], v7 offset:50976
s_add_u32 s52, s52, 0x40000
v_mfma_f32_16x16x32_bf16 v[60:63], a[44:47], v[84:87], v[60:63]
ds_read_b64_tr_b16 a[22:23], v7 offset:51488
ds_read_b64_tr_b16 a[24:25], v7 offset:51008
s_waitcnt vmcnt(16)
v_mfma_f32_16x16x32_bf16 v[32:35], a[48:51], v[88:91], v[32:35]
ds_read_b64_tr_b16 a[26:27], v7 offset:51520
buffer_load_dwordx4 v6, s[28:31], s54 offen offset:1024 lds
s_waitcnt vmcnt(16)
v_mfma_f32_16x16x32_bf16 v[48:51], a[48:51], v[92:95], v[48:51]
ds_read_b64_tr_b16 a[28:29], v7 offset:51040
ds_read_b64_tr_b16 a[30:31], v7 offset:51552
s_add_u32 s54, s54, 0x20000
v_mfma_f32_16x16x32_bf16 v[36:39], a[52:55], v[88:91], v[36:39]
buffer_load_dwordx4 v[72:75], v4, s[16:19], s53 offen sc1
v_mfma_f32_16x16x32_bf16 v[52:55], a[52:55], v[92:95], v[52:55]
v_mfma_f32_16x16x32_bf16 v[40:43], a[56:59], v[88:91], v[40:43]
buffer_load_dwordx4 v[76:79], v4, s[16:19], s53 offen offset:1024 sc1
v_mfma_f32_16x16x32_bf16 v[56:59], a[56:59], v[92:95], v[56:59]
s_add_u32 s53, s53, 0x40000
v_mfma_f32_16x16x32_bf16 v[44:47], a[60:63], v[88:91], v[44:47]
v_mfma_f32_16x16x32_bf16 v[60:63], a[60:63], v[92:95], v[60:63]
s_waitcnt lgkmcnt(0)
s_barrier
s_waitcnt vmcnt(16)
v_mfma_f32_16x16x32_bf16 v[32:35], a[0:3], v[96:99], v[32:35]
ds_read_b64_tr_b16 a[32:33], v7 offset:58240
ds_read_b64_tr_b16 a[34:35], v7 offset:58752
s_add_u32 m0, s55, 49920
s_waitcnt vmcnt(15)
v_mfma_f32_16x16x32_bf16 v[48:51], a[0:3], v[100:103], v[48:51]
ds_read_b64_tr_b16 a[36:37], v7 offset:58272
buffer_load_dwordx4 v5, s[28:31], s54 offen lds
v_mfma_f32_16x16x32_bf16 v[36:39], a[4:7], v[96:99], v[36:39]
ds_read_b64_tr_b16 a[38:39], v7 offset:58784
ds_read_b64_tr_b16 a[40:41], v7 offset:58304
v_mfma_f32_16x16x32_bf16 v[52:55], a[4:7], v[100:103], v[52:55]
ds_read_b64_tr_b16 a[42:43], v7 offset:58816
buffer_load_dwordx4 v[80:83], v4, s[16:19], s52 offen sc1
v_mfma_f32_16x16x32_bf16 v[40:43], a[8:11], v[96:99], v[40:43]
ds_read_b64_tr_b16 a[44:45], v7 offset:58336
ds_read_b64_tr_b16 a[46:47], v7 offset:58848
v_mfma_f32_16x16x32_bf16 v[56:59], a[8:11], v[100:103], v[56:59]
ds_read_b64_tr_b16 a[48:49], v7 offset:59264
buffer_load_dwordx4 v[84:87], v4, s[16:19], s52 offen offset:1024 sc1
v_mfma_f32_16x16x32_bf16 v[44:47], a[12:15], v[96:99], v[44:47]
ds_read_b64_tr_b16 a[50:51], v7 offset:59776
ds_read_b64_tr_b16 a[52:53], v7 offset:59296
s_add_u32 s52, s52, 0x40000
v_mfma_f32_16x16x32_bf16 v[60:63], a[12:15], v[100:103], v[60:63]
ds_read_b64_tr_b16 a[54:55], v7 offset:59808
ds_read_b64_tr_b16 a[56:57], v7 offset:59328
s_waitcnt vmcnt(16)
v_mfma_f32_16x16x32_bf16 v[32:35], a[16:19], v[104:107], v[32:35]
ds_read_b64_tr_b16 a[58:59], v7 offset:59840
buffer_load_dwordx4 v6, s[28:31], s54 offen offset:1024 lds
s_waitcnt vmcnt(16)
v_mfma_f32_16x16x32_bf16 v[48:51], a[16:19], v[108:111], v[48:51]
ds_read_b64_tr_b16 a[60:61], v7 offset:59360
ds_read_b64_tr_b16 a[62:63], v7 offset:59872
s_add_u32 s54, s54, 0x20000
v_mfma_f32_16x16x32_bf16 v[36:39], a[20:23], v[104:107], v[36:39]
buffer_load_dwordx4 v[88:91], v4, s[16:19], s53 offen sc1
v_mfma_f32_16x16x32_bf16 v[52:55], a[20:23], v[108:111], v[52:55]
v_mfma_f32_16x16x32_bf16 v[40:43], a[24:27], v[104:107], v[40:43]
buffer_load_dwordx4 v[92:95], v4, s[16:19], s53 offen offset:1024 sc1
v_mfma_f32_16x16x32_bf16 v[56:59], a[24:27], v[108:111], v[56:59]
s_add_u32 s53, s53, 0x40000
v_mfma_f32_16x16x32_bf16 v[44:47], a[28:31], v[104:107], v[44:47]
v_mfma_f32_16x16x32_bf16 v[60:63], a[28:31], v[108:111], v[60:63]
s_waitcnt lgkmcnt(0)
s_barrier
s_xor_b32 s57, s57, 66560
v_add_u32 v7, s57, v8
s_waitcnt vmcnt(16)
v_mfma_f32_16x16x32_bf16 v[32:35], a[32:35], v[112:115], v[32:35]
ds_read_b64_tr_b16 a[0:1], v7
ds_read_b64_tr_b16 a[2:3], v7 offset:512
s_add_u32 m0, s55, 58240
s_waitcnt vmcnt(15)
v_mfma_f32_16x16x32_bf16 v[48:51], a[32:35], v[116:119], v[48:51]
ds_read_b64_tr_b16 a[4:5], v7 offset:32
buffer_load_dwordx4 v5, s[28:31], s54 offen lds
v_mfma_f32_16x16x32_bf16 v[36:39], a[36:39], v[112:115], v[36:39]
ds_read_b64_tr_b16 a[6:7], v7 offset:544
ds_read_b64_tr_b16 a[8:9], v7 offset:64
v_mfma_f32_16x16x32_bf16 v[52:55], a[36:39], v[116:119], v[52:55]
ds_read_b64_tr_b16 a[10:11], v7 offset:576
buffer_load_dwordx4 v[96:99], v4, s[16:19], s52 offen sc1
v_mfma_f32_16x16x32_bf16 v[40:43], a[40:43], v[112:115], v[40:43]
ds_read_b64_tr_b16 a[12:13], v7 offset:96
ds_read_b64_tr_b16 a[14:15], v7 offset:608
v_mfma_f32_16x16x32_bf16 v[56:59], a[40:43], v[116:119], v[56:59]
ds_read_b64_tr_b16 a[16:17], v7 offset:1024
buffer_load_dwordx4 v[100:103], v4, s[16:19], s52 offen offset:1024 sc1
v_mfma_f32_16x16x32_bf16 v[44:47], a[44:47], v[112:115], v[44:47]
ds_read_b64_tr_b16 a[18:19], v7 offset:1536
ds_read_b64_tr_b16 a[20:21], v7 offset:1056
s_add_u32 s52, s52, 0x40000
v_mfma_f32_16x16x32_bf16 v[60:63], a[44:47], v[116:119], v[60:63]
ds_read_b64_tr_b16 a[22:23], v7 offset:1568
ds_read_b64_tr_b16 a[24:25], v7 offset:1088
s_waitcnt vmcnt(16)
v_mfma_f32_16x16x32_bf16 v[32:35], a[48:51], v[120:123], v[32:35]
ds_read_b64_tr_b16 a[26:27], v7 offset:1600
buffer_load_dwordx4 v6, s[28:31], s54 offen offset:1024 lds
s_waitcnt vmcnt(16)
v_mfma_f32_16x16x32_bf16 v[48:51], a[48:51], v[124:127], v[48:51]
ds_read_b64_tr_b16 a[28:29], v7 offset:1120
ds_read_b64_tr_b16 a[30:31], v7 offset:1632
s_add_u32 s54, s54, 0x20000
v_mfma_f32_16x16x32_bf16 v[36:39], a[52:55], v[120:123], v[36:39]
buffer_load_dwordx4 v[104:107], v4, s[16:19], s53 offen sc1
v_mfma_f32_16x16x32_bf16 v[52:55], a[52:55], v[124:127], v[52:55]
v_mfma_f32_16x16x32_bf16 v[40:43], a[56:59], v[120:123], v[40:43]
buffer_load_dwordx4 v[108:111], v4, s[16:19], s53 offen offset:1024 sc1
v_mfma_f32_16x16x32_bf16 v[56:59], a[56:59], v[124:127], v[56:59]
s_add_u32 s53, s53, 0x40000
v_mfma_f32_16x16x32_bf16 v[44:47], a[60:63], v[120:123], v[44:47]
v_mfma_f32_16x16x32_bf16 v[60:63], a[60:63], v[124:127], v[60:63]
s_sub_u32 s15, s15, 1
s_cmp_lg_u32 s15, 0
s_cbranch_scc1 .Lk48
s_waitcnt vmcnt(16) lgkmcnt(14)
v_mfma_f32_16x16x32_bf16 v[32:35], a[0:3], v[64:67], v[32:35]
ds_read_b64_tr_b16 a[32:33], v7 offset:8320
ds_read_b64_tr_b16 a[34:35], v7 offset:8832
s_waitcnt vmcnt(15)
v_mfma_f32_16x16x32_bf16 v[48:51], a[0:3], v[68:71], v[48:51]
buffer_load_dwordx4 v[112:115], v4, s[16:19], s52 offen sc1
s_waitcnt lgkmcnt(14)
v_mfma_f32_16x16x32_bf16 v[36:39], a[4:7], v[64:67], v[36:39]
ds_read_b64_tr_b16 a[36:37], v7 offset:8352
ds_read_b64_tr_b16 a[38:39], v7 offset:8864
v_mfma_f32_16x16x32_bf16 v[52:55], a[4:7], v[68:71], v[52:55]
ds_read_b64_tr_b16 a[40:41], v7 offset:8384
.Lpad29:
s_cbranch_execz .Lnopoll47r
ds_read_b64_tr_b16 a[42:43], v7 offset:8896
s_waitcnt lgkmcnt(15)
v_mfma_f32_16x16x32_bf16 v[40:43], a[8:11], v[64:67], v[40:43]
buffer_load_dwordx4 v[116:119], v4, s[16:19], s52 offen offset:1024 sc1
v_mfma_f32_16x16x32_bf16 v[56:59], a[8:11], v[68:71], v[56:59]
ds_read_b64_tr_b16 a[44:45], v7 offset:8416
s_add_u32 s52, s52, 0x40000
s_waitcnt lgkmcnt(15)
v_mfma_f32_16x16x32_bf16 v[44:47], a[12:15], v[64:67], v[44:47]
ds_read_b64_tr_b16 a[46:47], v7 offset:8928
v_mfma_f32_16x16x32_bf16 v[60:63], a[12:15], v[68:71], v[60:63]
ds_read_b64_tr_b16 a[48:49], v7 offset:9344
ds_read_b64_tr_b16 a[50:51], v7 offset:9856
s_waitcnt vmcnt(15) lgkmcnt(15)
v_mfma_f32_16x16x32_bf16 v[32:35], a[16:19], v[72:75], v[32:35]
buffer_load_dwordx4 v[120:123], v4, s[16:19], s53 offen sc1
s_waitcnt vmcnt(15)
v_mfma_f32_16x16x32_bf16 v[48:51], a[16:19], v[76:79], v[48:51]
ds_read_b64_tr_b16 a[52:53], v7 offset:9376
ds_read_b64_tr_b16 a[54:55], v7 offset:9888
s_waitcnt lgkmcnt(15)
v_mfma_f32_16x16x32_bf16 v[36:39], a[20:23], v[72:75], v[36:39]
ds_read_b64_tr_b16 a[56:57], v7 offset:9408
ds_read_b64_tr_b16 a[58:59], v7 offset:9920
v_mfma_f32_16x16x32_bf16 v[52:55], a[20:23], v[76:79], v[52:55]
buffer_load_dwordx4 v[124:127], v4, s[16:19], s53 offen offset:1024 sc1
s_waitcnt lgkmcnt(15)
v_mfma_f32_16x16x32_bf16 v[40:43], a[24:27], v[72:75], v[40:43]
ds_read_b64_tr_b16 a[60:61], v7 offset:9440
s_add_u32 s53, s53, 0x40000
v_mfma_f32_16x16x32_bf16 v[56:59], a[24:27], v[76:79], v[56:59]
ds_read_b64_tr_b16 a[62:63], v7 offset:9952
s_waitcnt lgkmcnt(15)
v_mfma_f32_16x16x32_bf16 v[44:47], a[28:31], v[72:75], v[44:47]
v_mfma_f32_16x16x32_bf16 v[60:63], a[28:31], v[76:79], v[60:63]
s_waitcnt vmcnt(14) lgkmcnt(14)
v_mfma_f32_16x16x32_bf16 v[32:35], a[32:35], v[80:83], v[32:35]
ds_read_b64_tr_b16 a[0:1], v7 offset:16640
ds_read_b64_tr_b16 a[2:3], v7 offset:17152
s_waitcnt vmcnt(13)
v_mfma_f32_16x16x32_bf16 v[48:51], a[32:35], v[84:87], v[48:51]
buffer_load_dwordx4 v[64:67], v4, s[16:19], s52 offen sc1
s_waitcnt lgkmcnt(14)
v_mfma_f32_16x16x32_bf16 v[36:39], a[36:39], v[80:83], v[36:39]
ds_read_b64_tr_b16 a[4:5], v7 offset:16672
ds_read_b64_tr_b16 a[6:7], v7 offset:17184
v_mfma_f32_16x16x32_bf16 v[52:55], a[36:39], v[84:87], v[52:55]
ds_read_b64_tr_b16 a[8:9], v7 offset:16704
ds_read_b64_tr_b16 a[10:11], v7 offset:17216
s_waitcnt lgkmcnt(15)
v_mfma_f32_16x16x32_bf16 v[40:43], a[40:43], v[80:83], v[40:43]
buffer_load_dwordx4 v[68:71], v4, s[16:19], s52 offen offset:1024 sc1
v_mfma_f32_16x16x32_bf16 v[56:59], a[40:43], v[84:87], v[56:59]
ds_read_b64_tr_b16 a[12:13], v7 offset:16736
s_add_u32 s52, s52, 0x40000
s_waitcnt lgkmcnt(15)
v_mfma_f32_16x16x32_bf16 v[44:47], a[44:47], v[80:83], v[44:47]
ds_read_b64_tr_b16 a[14:15], v7 offset:17248
v_mfma_f32_16x16x32_bf16 v[60:63], a[44:47], v[84:87], v[60:63]
ds_read_b64_tr_b16 a[16:17], v7 offset:17664
ds_read_b64_tr_b16 a[18:19], v7 offset:18176
s_waitcnt vmcnt(13) lgkmcnt(15)
v_mfma_f32_16x16x32_bf16 v[32:35], a[48:51], v[88:91], v[32:35]
buffer_load_dwordx4 v[72:75], v4, s[16:19], s53 offen sc1
s_waitcnt vmcnt(13)
v_mfma_f32_16x16x32_bf16 v[48:51], a[48:51], v[92:95], v[48:51]
ds_read_b64_tr_b16 a[20:21], v7 offset:17696
ds_read_b64_tr_b16 a[22:23], v7 offset:18208
s_waitcnt lgkmcnt(15)
v_mfma_f32_16x16x32_bf16 v[36:39], a[52:55], v[88:91], v[36:39]
ds_read_b64_tr_b16 a[24:25], v7 offset:17728
ds_read_b64_tr_b16 a[26:27], v7 offset:18240
v_mfma_f32_16x16x32_bf16 v[52:55], a[52:55], v[92:95], v[52:55]
buffer_load_dwordx4 v[76:79], v4, s[16:19], s53 offen offset:1024 sc1
s_waitcnt lgkmcnt(15)
v_mfma_f32_16x16x32_bf16 v[40:43], a[56:59], v[88:91], v[40:43]
ds_read_b64_tr_b16 a[28:29], v7 offset:17760
s_add_u32 s53, s53, 0x40000
v_mfma_f32_16x16x32_bf16 v[56:59], a[56:59], v[92:95], v[56:59]
ds_read_b64_tr_b16 a[30:31], v7 offset:18272
s_waitcnt lgkmcnt(15)
v_mfma_f32_16x16x32_bf16 v[44:47], a[60:63], v[88:91], v[44:47]
v_mfma_f32_16x16x32_bf16 v[60:63], a[60:63], v[92:95], v[60:63]
s_waitcnt vmcnt(12) lgkmcnt(14)
v_mfma_f32_16x16x32_bf16 v[32:35], a[0:3], v[96:99], v[32:35]
ds_read_b64_tr_b16 a[32:33], v7 offset:24960
ds_read_b64_tr_b16 a[34:35], v7 offset:25472
s_waitcnt vmcnt(11)
v_mfma_f32_16x16x32_bf16 v[48:51], a[0:3], v[100:103], v[48:51]
buffer_load_dwordx4 v[80:83], v4, s[16:19], s52 offen sc1
s_waitcnt lgkmcnt(14)
v_mfma_f32_16x16x32_bf16 v[36:39], a[4:7], v[96:99], v[36:39]
ds_read_b64_tr_b16 a[36:37], v7 offset:24992
ds_read_b64_tr_b16 a[38:39], v7 offset:25504
v_mfma_f32_16x16x32_bf16 v[52:55], a[4:7], v[100:103], v[52:55]
ds_read_b64_tr_b16 a[40:41], v7 offset:25024
ds_read_b64_tr_b16 a[42:43], v7 offset:25536
s_waitcnt lgkmcnt(15)
v_mfma_f32_16x16x32_bf16 v[40:43], a[8:11], v[96:99], v[40:43]
buffer_load_dwordx4 v[84:87], v4, s[16:19], s52 offen offset:1024 sc1
v_mfma_f32_16x16x32_bf16 v[56:59], a[8:11], v[100:103], v[56:59]
ds_read_b64_tr_b16 a[44:45], v7 offset:25056
s_add_u32 s52, s52, 0x40000
s_waitcnt lgkmcnt(15)
v_mfma_f32_16x16x32_bf16 v[44:47], a[12:15], v[96:99], v[44:47]
ds_read_b64_tr_b16 a[46:47], v7 offset:25568
v_mfma_f32_16x16x32_bf16 v[60:63], a[12:15], v[100:103], v[60:63]
ds_read_b64_tr_b16 a[48:49], v7 offset:25984
ds_read_b64_tr_b16 a[50:51], v7 offset:26496
s_waitcnt vmcnt(11) lgkmcnt(15)
v_mfma_f32_16x16x32_bf16 v[32:35], a[16:19], v[104:107], v[32:35]
buffer_load_dwordx4 v[88:91], v4, s[16:19], s53 offen sc1
s_waitcnt vmcnt(11)
v_mfma_f32_16x16x32_bf16 v[48:51], a[16:19], v[108:111], v[48:51]
ds_read_b64_tr_b16 a[52:53], v7 offset:26016
ds_read_b64_tr_b16 a[54:55], v7 offset:26528
s_waitcnt lgkmcnt(15)
v_mfma_f32_16x16x32_bf16 v[36:39], a[20:23], v[104:107], v[36:39]
ds_read_b64_tr_b16 a[56:57], v7 offset:26048
ds_read_b64_tr_b16 a[58:59], v7 offset:26560
v_mfma_f32_16x16x32_bf16 v[52:55], a[20:23], v[108:111], v[52:55]
buffer_load_dwordx4 v[92:95], v4, s[16:19], s53 offen offset:1024 sc1
s_waitcnt lgkmcnt(15)
v_mfma_f32_16x16x32_bf16 v[40:43], a[24:27], v[104:107], v[40:43]
ds_read_b64_tr_b16 a[60:61], v7 offset:26080
s_add_u32 s53, s53, 0x40000
v_mfma_f32_16x16x32_bf16 v[56:59], a[24:27], v[108:111], v[56:59]
ds_read_b64_tr_b16 a[62:63], v7 offset:26592
s_waitcnt lgkmcnt(15)
v_mfma_f32_16x16x32_bf16 v[44:47], a[28:31], v[104:107], v[44:47]
v_mfma_f32_16x16x32_bf16 v[60:63], a[28:31], v[108:111], v[60:63]
s_waitcnt vmcnt(11) lgkmcnt(14)
v_mfma_f32_16x16x32_bf16 v[32:35], a[32:35], v[112:115], v[32:35]
ds_read_b64_tr_b16 a[0:1], v7 offset:33280
ds_read_b64_tr_b16 a[2:3], v7 offset:33792
s_waitcnt vmcnt(10)
v_mfma_f32_16x16x32_bf16 v[48:51], a[32:35], v[116:119], v[48:51]
buffer_load_dwordx4 v[96:99], v4, s[16:19], s52 offen sc1
s_waitcnt lgkmcnt(14)
v_mfma_f32_16x16x32_bf16 v[36:39], a[36:39], v[112:115], v[36:39]
ds_read_b64_tr_b16 a[4:5], v7 offset:33312
ds_read_b64_tr_b16 a[6:7], v7 offset:33824
v_mfma_f32_16x16x32_bf16 v[52:55], a[36:39], v[116:119], v[52:55]
ds_read_b64_tr_b16 a[8:9], v7 offset:33344
ds_read_b64_tr_b16 a[10:11], v7 offset:33856
s_waitcnt lgkmcnt(15)
v_mfma_f32_16x16x32_bf16 v[40:43], a[40:43], v[112:115], v[40:43]
buffer_load_dwordx4 v[100:103], v4, s[16:19], s52 offen offset:1024 sc1
v_mfma_f32_16x16x32_bf16 v[56:59], a[40:43], v[116:119], v[56:59]
ds_read_b64_tr_b16 a[12:13], v7 offset:33376
s_add_u32 s52, s52, 0x40000
s_waitcnt lgkmcnt(15)
v_mfma_f32_16x16x32_bf16 v[44:47], a[44:47], v[112:115], v[44:47]
ds_read_b64_tr_b16 a[14:15], v7 offset:33888
v_mfma_f32_16x16x32_bf16 v[60:63], a[44:47], v[116:119], v[60:63]
ds_read_b64_tr_b16 a[16:17], v7 offset:34304
ds_read_b64_tr_b16 a[18:19], v7 offset:34816
s_waitcnt vmcnt(11) lgkmcnt(15)
v_mfma_f32_16x16x32_bf16 v[32:35], a[48:51], v[120:123], v[32:35]
buffer_load_dwordx4 v[104:107], v4, s[16:19], s53 offen sc1
s_waitcnt vmcnt(11)
v_mfma_f32_16x16x32_bf16 v[48:51], a[48:51], v[124:127], v[48:51]
ds_read_b64_tr_b16 a[20:21], v7 offset:34336
ds_read_b64_tr_b16 a[22:23], v7 offset:34848
s_waitcnt lgkmcnt(15)
v_mfma_f32_16x16x32_bf16 v[36:39], a[52:55], v[120:123], v[36:39]
ds_read_b64_tr_b16 a[24:25], v7 offset:34368
ds_read_b64_tr_b16 a[26:27], v7 offset:34880
v_mfma_f32_16x16x32_bf16 v[52:55], a[52:55], v[124:127], v[52:55]
buffer_load_dwordx4 v[108:111], v4, s[16:19], s53 offen offset:1024 sc1
s_waitcnt lgkmcnt(15)
v_mfma_f32_16x16x32_bf16 v[40:43], a[56:59], v[120:123], v[40:43]
ds_read_b64_tr_b16 a[28:29], v7 offset:34400
s_add_u32 s53, s53, 0x40000
v_mfma_f32_16x16x32_bf16 v[56:59], a[56:59], v[124:127], v[56:59]
ds_read_b64_tr_b16 a[30:31], v7 offset:34912
s_waitcnt lgkmcnt(15)
v_mfma_f32_16x16x32_bf16 v[44:47], a[60:63], v[120:123], v[44:47]
v_mfma_f32_16x16x32_bf16 v[60:63], a[60:63], v[124:127], v[60:63]
s_waitcnt lgkmcnt(0)
s_barrier
s_waitcnt vmcnt(11)
v_mfma_f32_16x16x32_bf16 v[32:35], a[0:3], v[64:67], v[32:35]
ds_read_b64_tr_b16 a[32:33], v7 offset:41600
ds_read_b64_tr_b16 a[34:35], v7 offset:42112
s_waitcnt vmcnt(10)
v_mfma_f32_16x16x32_bf16 v[48:51], a[0:3], v[68:71], v[48:51]
ds_read_b64_tr_b16 a[36:37], v7 offset:41632
buffer_load_dwordx4 v[112:115], v4, s[16:19], s52 offen sc1
v_mfma_f32_16x16x32_bf16 v[36:39], a[4:7], v[64:67], v[36:39]
ds_read_b64_tr_b16 a[38:39], v7 offset:42144
ds_read_b64_tr_b16 a[40:41], v7 offset:41664
v_mfma_f32_16x16x32_bf16 v[52:55], a[4:7], v[68:71], v[52:55]
ds_read_b64_tr_b16 a[42:43], v7 offset:42176
v_mfma_f32_16x16x32_bf16 v[40:43], a[8:11], v[64:67], v[40:43]
ds_read_b64_tr_b16 a[44:45], v7 offset:41696
buffer_load_dwordx4 v[116:119], v4, s[16:19], s52 offen offset:1024 sc1
v_mfma_f32_16x16x32_bf16 v[56:59], a[8:11], v[68:71], v[56:59]
ds_read_b64_tr_b16 a[46:47], v7 offset:42208
ds_read_b64_tr_b16 a[48:49], v7 offset:42624
s_add_u32 s52, s52, 0x40000
v_mfma_f32_16x16x32_bf16 v[44:47], a[12:15], v[64:67], v[44:47]
ds_read_b64_tr_b16 a[50:51], v7 offset:43136
ds_read_b64_tr_b16 a[52:53], v7 offset:42656
v_mfma_f32_16x16x32_bf16 v[60:63], a[12:15], v[68:71], v[60:63]
ds_read_b64_tr_b16 a[54:55], v7 offset:43168
s_waitcnt vmcnt(11)
v_mfma_f32_16x16x32_bf16 v[32:35], a[16:19], v[72:75], v[32:35]
ds_read_b64_tr_b16 a[56:57], v7 offset:42688
buffer_load_dwordx4 v[120:123], v4, s[16:19], s53 offen sc1
s_waitcnt vmcnt(11)
v_mfma_f32_16x16x32_bf16 v[48:51], a[16:19], v[76:79], v[48:51]
ds_read_b64_tr_b16 a[58:59], v7 offset:43200
ds_read_b64_tr_b16 a[60:61], v7 offset:42720
v_mfma_f32_16x16x32_bf16 v[36:39], a[20:23], v[72:75], v[36:39]
ds_read_b64_tr_b16 a[62:63], v7 offset:43232
v_mfma_f32_16x16x32_bf16 v[52:55], a[20:23], v[76:79], v[52:55]
buffer_load_dwordx4 v[124:127], v4, s[16:19], s53 offen offset:1024 sc1
v_mfma_f32_16x16x32_bf16 v[40:43], a[24:27], v[72:75], v[40:43]
s_add_u32 s53, s53, 0x40000
v_mfma_f32_16x16x32_bf16 v[56:59], a[24:27], v[76:79], v[56:59]
v_mfma_f32_16x16x32_bf16 v[44:47], a[28:31], v[72:75], v[44:47]
v_mfma_f32_16x16x32_bf16 v[60:63], a[28:31], v[76:79], v[60:63]
s_waitcnt vmcnt(11) lgkmcnt(14)
v_mfma_f32_16x16x32_bf16 v[32:35], a[32:35], v[80:83], v[32:35]
ds_read_b64_tr_b16 a[0:1], v7 offset:49920
ds_read_b64_tr_b16 a[2:3], v7 offset:50432
s_waitcnt vmcnt(10)
v_mfma_f32_16x16x32_bf16 v[48:51], a[32:35], v[84:87], v[48:51]
buffer_load_dwordx4 v[64:67], v4, s[16:19], s52 offen sc1
s_waitcnt lgkmcnt(14)
v_mfma_f32_16x16x32_bf16 v[36:39], a[36:39], v[80:83], v[36:39]
ds_read_b64_tr_b16 a[4:5], v7 offset:49952
ds_read_b64_tr_b16 a[6:7], v7 offset:50464
v_mfma_f32_16x16x32_bf16 v[52:55], a[36:39], v[84:87], v[52:55]
ds_read_b64_tr_b16 a[8:9], v7 offset:49984
ds_read_b64_tr_b16 a[10:11], v7 offset:50496
s_waitcnt lgkmcnt(15)
v_mfma_f32_16x16x32_bf16 v[40:43], a[40:43], v[80:83], v[40:43]
buffer_load_dwordx4 v[68:71], v4, s[16:19], s52 offen offset:1024 sc1
v_mfma_f32_16x16x32_bf16 v[56:59], a[40:43], v[84:87], v[56:59]
ds_read_b64_tr_b16 a[12:13], v7 offset:50016
s_add_u32 s52, s52, 0x40000
s_waitcnt lgkmcnt(15)
v_mfma_f32_16x16x32_bf16 v[44:47], a[44:47], v[80:83], v[44:47]
ds_read_b64_tr_b16 a[14:15], v7 offset:50528
v_mfma_f32_16x16x32_bf16 v[60:63], a[44:47], v[84:87], v[60:63]
ds_read_b64_tr_b16 a[16:17], v7 offset:50944
ds_read_b64_tr_b16 a[18:19], v7 offset:51456
s_waitcnt vmcnt(11) lgkmcnt(15)
v_mfma_f32_16x16x32_bf16 v[32:35], a[48:51], v[88:91], v[32:35]
buffer_load_dwordx4 v[72:75], v4, s[16:19], s53 offen sc1
s_waitcnt vmcnt(11)
v_mfma_f32_16x16x32_bf16 v[48:51], a[48:51], v[92:95], v[48:51]
ds_read_b64_tr_b16 a[20:21], v7 offset:50976
ds_read_b64_tr_b16 a[22:23], v7 offset:51488
s_waitcnt lgkmcnt(15)
v_mfma_f32_16x16x32_bf16 v[36:39], a[52:55], v[88:91], v[36:39]
ds_read_b64_tr_b16 a[24:25], v7 offset:51008
ds_read_b64_tr_b16 a[26:27], v7 offset:51520
v_mfma_f32_16x16x32_bf16 v[52:55], a[52:55], v[92:95], v[52:55]
buffer_load_dwordx4 v[76:79], v4, s[16:19], s53 offen offset:1024 sc1
s_waitcnt lgkmcnt(15)
v_mfma_f32_16x16x32_bf16 v[40:43], a[56:59], v[88:91], v[40:43]
ds_read_b64_tr_b16 a[28:29], v7 offset:51040
s_add_u32 s53, s53, 0x40000
v_mfma_f32_16x16x32_bf16 v[56:59], a[56:59], v[92:95], v[56:59]
ds_read_b64_tr_b16 a[30:31], v7 offset:51552
s_waitcnt lgkmcnt(15)
v_mfma_f32_16x16x32_bf16 v[44:47], a[60:63], v[88:91], v[44:47]
v_mfma_f32_16x16x32_bf16 v[60:63], a[60:63], v[92:95], v[60:63]
s_waitcnt vmcnt(11) lgkmcnt(14)
v_mfma_f32_16x16x32_bf16 v[32:35], a[0:3], v[96:99], v[32:35]
ds_read_b64_tr_b16 a[32:33], v7 offset:58240
ds_read_b64_tr_b16 a[34:35], v7 offset:58752
s_waitcnt vmcnt(10)
v_mfma_f32_16x16x32_bf16 v[48:51], a[0:3], v[100:103], v[48:51]
buffer_load_dwordx4 v[80:83], v4, s[16:19], s52 offen sc1
s_waitcnt lgkmcnt(14)
v_mfma_f32_16x16x32_bf16 v[36:39], a[4:7], v[96:99], v[36:39]
ds_read_b64_tr_b16 a[36:37], v7 offset:58272
ds_read_b64_tr_b16 a[38:39], v7 offset:58784
v_mfma_f32_16x16x32_bf16 v[52:55], a[4:7], v[100:103], v[52:55]
ds_read_b64_tr_b16 a[40:41], v7 offset:58304
ds_read_b64_tr_b16 a[42:43], v7 offset:58816
s_waitcnt lgkmcnt(15)
v_mfma_f32_16x16x32_bf16 v[40:43], a[8:11], v[96:99], v[40:43]
buffer_load_dwordx4 v[84:87], v4, s[16:19], s52 offen offset:1024 sc1
v_mfma_f32_16x16x32_bf16 v[56:59], a[8:11], v[100:103], v[56:59]
ds_read_b64_tr_b16 a[44:45], v7 offset:58336
s_add_u32 s52, s52, 0x40000
s_waitcnt lgkmcnt(15)
v_mfma_f32_16x16x32_bf16 v[44:47], a[12:15], v[96:99], v[44:47]
ds_read_b64_tr_b16 a[46:47], v7 offset:58848
v_mfma_f32_16x16x32_bf16 v[60:63], a[12:15], v[100:103], v[60:63]
ds_read_b64_tr_b16 a[48:49], v7 offset:59264
ds_read_b64_tr_b16 a[50:51], v7 offset:59776
s_waitcnt vmcnt(11) lgkmcnt(15)
v_mfma_f32_16x16x32_bf16 v[32:35], a[16:19], v[104:107], v[32:35]
buffer_load_dwordx4 v[88:91], v4, s[16:19], s53 offen sc1
s_waitcnt vmcnt(11)
v_mfma_f32_16x16x32_bf16 v[48:51], a[16:19], v[108:111], v[48:51]
ds_read_b64_tr_b16 a[52:53], v7 offset:59296
ds_read_b64_tr_b16 a[54:55], v7 offset:59808
s_waitcnt lgkmcnt(15)
v_mfma_f32_16x16x32_bf16 v[36:39], a[20:23], v[104:107], v[36:39]
ds_read_b64_tr_b16 a[56:57], v7 offset:59328
ds_read_b64_tr_b16 a[58:59], v7 offset:59840
v_mfma_f32_16x16x32_bf16 v[52:55], a[20:23], v[108:111], v[52:55]
buffer_load_dwordx4 v[92:95], v4, s[16:19], s53 offen offset:1024 sc1
s_waitcnt lgkmcnt(15)
v_mfma_f32_16x16x32_bf16 v[40:43], a[24:27], v[104:107], v[40:43]
ds_read_b64_tr_b16 a[60:61], v7 offset:59360
s_add_u32 s53, s53, 0x40000
v_mfma_f32_16x16x32_bf16 v[56:59], a[24:27], v[108:111], v[56:59]
ds_read_b64_tr_b16 a[62:63], v7 offset:59872
s_waitcnt lgkmcnt(15)
v_mfma_f32_16x16x32_bf16 v[44:47], a[28:31], v[104:107], v[44:47]
v_mfma_f32_16x16x32_bf16 v[60:63], a[28:31], v[108:111], v[60:63]
s_xor_b32 s57, s57, 66560
v_add_u32 v7, s57, v8
s_waitcnt vmcnt(11) lgkmcnt(14)
v_mfma_f32_16x16x32_bf16 v[32:35], a[32:35], v[112:115], v[32:35]
ds_read_b64_tr_b16 a[0:1], v7
ds_read_b64_tr_b16 a[2:3], v7 offset:512
s_waitcnt vmcnt(10)
v_mfma_f32_16x16x32_bf16 v[48:51], a[32:35], v[116:119], v[48:51]
buffer_load_dwordx4 v[96:99], v4, s[16:19], s52 offen sc1
s_waitcnt lgkmcnt(14)
v_mfma_f32_16x16x32_bf16 v[36:39], a[36:39], v[112:115], v[36:39]
ds_read_b64_tr_b16 a[4:5], v7 offset:32
ds_read_b64_tr_b16 a[6:7], v7 offset:544
v_mfma_f32_16x16x32_bf16 v[52:55], a[36:39], v[116:119], v[52:55]
ds_read_b64_tr_b16 a[8:9], v7 offset:64
ds_read_b64_tr_b16 a[10:11], v7 offset:576
s_waitcnt lgkmcnt(15)
v_mfma_f32_16x16x32_bf16 v[40:43], a[40:43], v[112:115], v[40:43]
buffer_load_dwordx4 v[100:103], v4, s[16:19], s52 offen offset:1024 sc1
v_mfma_f32_16x16x32_bf16 v[56:59], a[40:43], v[116:119], v[56:59]
ds_read_b64_tr_b16 a[12:13], v7 offset:96
s_add_u32 s52, s52, 0x40000
s_waitcnt lgkmcnt(15)
v_mfma_f32_16x16x32_bf16 v[44:47], a[44:47], v[112:115], v[44:47]
ds_read_b64_tr_b16 a[14:15], v7 offset:608
v_mfma_f32_16x16x32_bf16 v[60:63], a[44:47], v[116:119], v[60:63]
ds_read_b64_tr_b16 a[16:17], v7 offset:1024
ds_read_b64_tr_b16 a[18:19], v7 offset:1536
s_waitcnt vmcnt(11) lgkmcnt(15)
v_mfma_f32_16x16x32_bf16 v[32:35], a[48:51], v[120:123], v[32:35]
buffer_load_dwordx4 v[104:107], v4, s[16:19], s53 offen sc1
s_waitcnt vmcnt(11)
v_mfma_f32_16x16x32_bf16 v[48:51], a[48:51], v[124:127], v[48:51]
ds_read_b64_tr_b16 a[20:21], v7 offset:1056
ds_read_b64_tr_b16 a[22:23], v7 offset:1568
s_waitcnt lgkmcnt(15)
v_mfma_f32_16x16x32_bf16 v[36:39], a[52:55], v[120:123], v[36:39]
ds_read_b64_tr_b16 a[24:25], v7 offset:1088
ds_read_b64_tr_b16 a[26:27], v7 offset:1600
v_mfma_f32_16x16x32_bf16 v[52:55], a[52:55], v[124:127], v[52:55]
buffer_load_dwordx4 v[108:111], v4, s[16:19], s53 offen offset:1024 sc1
s_waitcnt lgkmcnt(15)
v_mfma_f32_16x16x32_bf16 v[40:43], a[56:59], v[120:123], v[40:43]
ds_read_b64_tr_b16 a[28:29], v7 offset:1120
s_add_u32 s53, s53, 0x40000
v_mfma_f32_16x16x32_bf16 v[56:59], a[56:59], v[124:127], v[56:59]
ds_read_b64_tr_b16 a[30:31], v7 offset:1632
s_waitcnt lgkmcnt(15)
v_mfma_f32_16x16x32_bf16 v[44:47], a[60:63], v[120:123], v[44:47]
v_mfma_f32_16x16x32_bf16 v[60:63], a[60:63], v[124:127], v[60:63]
s_waitcnt vmcnt(11) lgkmcnt(14)
v_mfma_f32_16x16x32_bf16 v[32:35], a[0:3], v[64:67], v[32:35]
ds_read_b64_tr_b16 a[32:33], v7 offset:8320
ds_read_b64_tr_b16 a[34:35], v7 offset:8832
s_waitcnt vmcnt(10)
v_mfma_f32_16x16x32_bf16 v[48:51], a[0:3], v[68:71], v[48:51]
buffer_load_dwordx4 v[112:115], v4, s[16:19], s52 offen sc1
s_waitcnt lgkmcnt(14)
v_mfma_f32_16x16x32_bf16 v[36:39], a[4:7], v[64:67], v[36:39]
ds_read_b64_tr_b16 a[36:37], v7 offset:8352
ds_read_b64_tr_b16 a[38:39], v7 offset:8864
v_mfma_f32_16x16x32_bf16 v[52:55], a[4:7], v[68:71], v[52:55]
ds_read_b64_tr_b16 a[40:41], v7 offset:8384
ds_read_b64_tr_b16 a[42:43], v7 offset:8896
s_waitcnt lgkmcnt(15)
v_mfma_f32_16x16x32_bf16 v[40:43], a[8:11], v[64:67], v[40:43]
buffer_load_dwordx4 v[116:119], v4, s[16:19], s52 offen offset:1024 sc1
v_mfma_f32_16x16x32_bf16 v[56:59], a[8:11], v[68:71], v[56:59]
ds_read_b64_tr_b16 a[44:45], v7 offset:8416
s_add_u32 s52, s52, 0x40000
s_waitcnt lgkmcnt(15)
v_mfma_f32_16x16x32_bf16 v[44:47], a[12:15], v[64:67], v[44:47]
ds_read_b64_tr_b16 a[46:47], v7 offset:8928
v_mfma_f32_16x16x32_bf16 v[60:63], a[12:15], v[68:71], v[60:63]
ds_read_b64_tr_b16 a[48:49], v7 offset:9344
ds_read_b64_tr_b16 a[50:51], v7 offset:9856
s_waitcnt vmcnt(11) lgkmcnt(15)
v_mfma_f32_16x16x32_bf16 v[32:35], a[16:19], v[72:75], v[32:35]
buffer_load_dwordx4 v[120:123], v4, s[16:19], s53 offen sc1
s_waitcnt vmcnt(11)
v_mfma_f32_16x16x32_bf16 v[48:51], a[16:19], v[76:79], v[48:51]
ds_read_b64_tr_b16 a[52:53], v7 offset:9376
ds_read_b64_tr_b16 a[54:55], v7 offset:9888
s_waitcnt lgkmcnt(15)
v_mfma_f32_16x16x32_bf16 v[36:39], a[20:23], v[72:75], v[36:39]
ds_read_b64_tr_b16 a[56:57], v7 offset:9408
ds_read_b64_tr_b16 a[58:59], v7 offset:9920
v_mfma_f32_16x16x32_bf16 v[52:55], a[20:23], v[76:79], v[52:55]
buffer_load_dwordx4 v[124:127], v4, s[16:19], s53 offen offset:1024 sc1
s_waitcnt lgkmcnt(15)
v_mfma_f32_16x16x32_bf16 v[40:43], a[24:27], v[72:75], v[40:43]
ds_read_b64_tr_b16 a[60:61], v7 offset:9440
s_add_u32 s53, s53, 0x40000
v_mfma_f32_16x16x32_bf16 v[56:59], a[24:27], v[76:79], v[56:59]
ds_read_b64_tr_b16 a[62:63], v7 offset:9952
s_waitcnt lgkmcnt(15)
v_mfma_f32_16x16x32_bf16 v[44:47], a[28:31], v[72:75], v[44:47]
v_mfma_f32_16x16x32_bf16 v[60:63], a[28:31], v[76:79], v[60:63]
s_waitcnt vmcnt(11) lgkmcnt(14)
v_mfma_f32_16x16x32_bf16 v[32:35], a[32:35], v[80:83], v[32:35]
ds_read_b64_tr_b16 a[0:1], v7 offset:16640
ds_read_b64_tr_b16 a[2:3], v7 offset:17152
s_waitcnt vmcnt(10)
v_mfma_f32_16x16x32_bf16 v[48:51], a[32:35], v[84:87], v[48:51]
buffer_load_dwordx4 v[64:67], v4, s[16:19], s52 offen sc1
s_waitcnt lgkmcnt(14)
v_mfma_f32_16x16x32_bf16 v[36:39], a[36:39], v[80:83], v[36:39]
ds_read_b64_tr_b16 a[4:5], v7 offset:16672
ds_read_b64_tr_b16 a[6:7], v7 offset:17184
v_mfma_f32_16x16x32_bf16 v[52:55], a[36:39], v[84:87], v[52:55]
ds_read_b64_tr_b16 a[8:9], v7 offset:16704
ds_read_b64_tr_b16 a[10:11], v7 offset:17216
s_waitcnt lgkmcnt(15)
v_mfma_f32_16x16x32_bf16 v[40:43], a[40:43], v[80:83], v[40:43]
buffer_load_dwordx4 v[68:71], v4, s[16:19], s52 offen offset:1024 sc1
v_mfma_f32_16x16x32_bf16 v[56:59], a[40:43], v[84:87], v[56:59]
ds_read_b64_tr_b16 a[12:13], v7 offset:16736
s_add_u32 s52, s52, 0x40000
s_waitcnt lgkmcnt(15)
v_mfma_f32_16x16x32_bf16 v[44:47], a[44:47], v[80:83], v[44:47]
ds_read_b64_tr_b16 a[14:15], v7 offset:17248
v_mfma_f32_16x16x32_bf16 v[60:63], a[44:47], v[84:87], v[60:63]
ds_read_b64_tr_b16 a[16:17], v7 offset:17664
ds_read_b64_tr_b16 a[18:19], v7 offset:18176
s_waitcnt vmcnt(11) lgkmcnt(15)
v_mfma_f32_16x16x32_bf16 v[32:35], a[48:51], v[88:91], v[32:35]
buffer_load_dwordx4 v[72:75], v4, s[16:19], s53 offen sc1
s_waitcnt vmcnt(11)
v_mfma_f32_16x16x32_bf16 v[48:51], a[48:51], v[92:95], v[48:51]
ds_read_b64_tr_b16 a[20:21], v7 offset:17696
ds_read_b64_tr_b16 a[22:23], v7 offset:18208
s_waitcnt lgkmcnt(15)
v_mfma_f32_16x16x32_bf16 v[36:39], a[52:55], v[88:91], v[36:39]
ds_read_b64_tr_b16 a[24:25], v7 offset:17728
ds_read_b64_tr_b16 a[26:27], v7 offset:18240
v_mfma_f32_16x16x32_bf16 v[52:55], a[52:55], v[92:95], v[52:55]
buffer_load_dwordx4 v[76:79], v4, s[16:19], s53 offen offset:1024 sc1
s_waitcnt lgkmcnt(15)
v_mfma_f32_16x16x32_bf16 v[40:43], a[56:59], v[88:91], v[40:43]
ds_read_b64_tr_b16 a[28:29], v7 offset:17760
s_add_u32 s53, s53, 0x40000
v_mfma_f32_16x16x32_bf16 v[56:59], a[56:59], v[92:95], v[56:59]
ds_read_b64_tr_b16 a[30:31], v7 offset:18272
s_waitcnt lgkmcnt(15)
v_mfma_f32_16x16x32_bf16 v[44:47], a[60:63], v[88:91], v[44:47]
v_mfma_f32_16x16x32_bf16 v[60:63], a[60:63], v[92:95], v[60:63]
s_waitcnt vmcnt(11) lgkmcnt(14)
v_mfma_f32_16x16x32_bf16 v[32:35], a[0:3], v[96:99], v[32:35]
ds_read_b64_tr_b16 a[32:33], v7 offset:24960
ds_read_b64_tr_b16 a[34:35], v7 offset:25472
s_waitcnt vmcnt(10)
v_mfma_f32_16x16x32_bf16 v[48:51], a[0:3], v[100:103], v[48:51]
buffer_load_dwordx4 v[80:83], v4, s[16:19], s52 offen sc1
s_waitcnt lgkmcnt(14)
v_mfma_f32_16x16x32_bf16 v[36:39], a[4:7], v[96:99], v[36:39]
ds_read_b64_tr_b16 a[36:37], v7 offset:24992
ds_read_b64_tr_b16 a[38:39], v7 offset:25504
v_mfma_f32_16x16x32_bf16 v[52:55], a[4:7], v[100:103], v[52:55]
ds_read_b64_tr_b16 a[40:41], v7 offset:25024
ds_read_b64_tr_b16 a[42:43], v7 offset:25536
s_waitcnt lgkmcnt(15)
v_mfma_f32_16x16x32_bf16 v[40:43], a[8:11], v[96:99], v[40:43]
buffer_load_dwordx4 v[84:87], v4, s[16:19], s52 offen offset:1024 sc1
v_mfma_f32_16x16x32_bf16 v[56:59], a[8:11], v[100:103], v[56:59]
ds_read_b64_tr_b16 a[44:45], v7 offset:25056
s_add_u32 s52, s52, 0x40000
s_waitcnt lgkmcnt(15)
v_mfma_f32_16x16x32_bf16 v[44:47], a[12:15], v[96:99], v[44:47]
ds_read_b64_tr_b16 a[46:47], v7 offset:25568
v_mfma_f32_16x16x32_bf16 v[60:63], a[12:15], v[100:103], v[60:63]
ds_read_b64_tr_b16 a[48:49], v7 offset:25984
ds_read_b64_tr_b16 a[50:51], v7 offset:26496
s_waitcnt vmcnt(11) lgkmcnt(15)
v_mfma_f32_16x16x32_bf16 v[32:35], a[16:19], v[104:107], v[32:35]
buffer_load_dwordx4 v[88:91], v4, s[16:19], s53 offen sc1
s_waitcnt vmcnt(11)
v_mfma_f32_16x16x32_bf16 v[48:51], a[16:19], v[108:111], v[48:51]
ds_read_b64_tr_b16 a[52:53], v7 offset:26016
ds_read_b64_tr_b16 a[54:55], v7 offset:26528
s_waitcnt lgkmcnt(15)
v_mfma_f32_16x16x32_bf16 v[36:39], a[20:23], v[104:107], v[36:39]
ds_read_b64_tr_b16 a[56:57], v7 offset:26048
ds_read_b64_tr_b16 a[58:59], v7 offset:26560
v_mfma_f32_16x16x32_bf16 v[52:55], a[20:23], v[108:111], v[52:55]
buffer_load_dwordx4 v[92:95], v4, s[16:19], s53 offen offset:1024 sc1
s_waitcnt lgkmcnt(15)
v_mfma_f32_16x16x32_bf16 v[40:43], a[24:27], v[104:107], v[40:43]
ds_read_b64_tr_b16 a[60:61], v7 offset:26080
s_add_u32 s53, s53, 0x40000
v_mfma_f32_16x16x32_bf16 v[56:59], a[24:27], v[108:111], v[56:59]
ds_read_b64_tr_b16 a[62:63], v7 offset:26592
s_waitcnt lgkmcnt(15)
v_mfma_f32_16x16x32_bf16 v[44:47], a[28:31], v[104:107], v[44:47]
v_mfma_f32_16x16x32_bf16 v[60:63], a[28:31], v[108:111], v[60:63]
s_waitcnt lgkmcnt(0)
s_barrier
s_waitcnt vmcnt(11)
v_mfma_f32_16x16x32_bf16 v[32:35], a[32:35], v[112:115], v[32:35]
ds_read_b64_tr_b16 a[0:1], v7 offset:33280
ds_read_b64_tr_b16 a[2:3], v7 offset:33792
s_waitcnt vmcnt(10)
v_mfma_f32_16x16x32_bf16 v[48:51], a[32:35], v[116:119], v[48:51]
ds_read_b64_tr_b16 a[4:5], v7 offset:33312
buffer_load_dwordx4 v[96:99], v4, s[16:19], s52 offen sc1
v_mfma_f32_16x16x32_bf16 v[36:39], a[36:39], v[112:115], v[36:39]
ds_read_b64_tr_b16 a[6:7], v7 offset:33824
ds_read_b64_tr_b16 a[8:9], v7 offset:33344
v_mfma_f32_16x16x32_bf16 v[52:55], a[36:39], v[116:119], v[52:55]
ds_read_b64_tr_b16 a[10:11], v7 offset:33856
v_mfma_f32_16x16x32_bf16 v[40:43], a[40:43], v[112:115], v[40:43]
ds_read_b64_tr_b16 a[12:13], v7 offset:33376
buffer_load_dwordx4 v[100:103], v4, s[16:19], s52 offen offset:1024 sc1
v_mfma_f32_16x16x32_bf16 v[56:59], a[40:43], v[116:119], v[56:59]
ds_read_b64_tr_b16 a[14:15], v7 offset:33888
ds_read_b64_tr_b16 a[16:17], v7 offset:34304
s_add_u32 s52, s52, 0x40000
v_mfma_f32_16x16x32_bf16 v[44:47], a[44:47], v[112:115], v[44:47]
ds_read_b64_tr_b16 a[18:19], v7 offset:34816
ds_read_b64_tr_b16 a[20:21], v7 offset:34336
v_mfma_f32_16x16x32_bf16 v[60:63], a[44:47], v[116:119], v[60:63]
ds_read_b64_tr_b16 a[22:23], v7 offset:34848
s_waitcnt vmcnt(11)
v_mfma_f32_16x16x32_bf16 v[32:35], a[48:51], v[120:123], v[32:35]
ds_read_b64_tr_b16 a[24:25], v7 offset:34368
buffer_load_dwordx4 v[104:107], v4, s[16:19], s53 offen sc1
s_waitcnt vmcnt(11)
v_mfma_f32_16x16x32_bf16 v[48:51], a[48:51], v[124:127], v[48:51]
ds_read_b64_tr_b16 a[26:27], v7 offset:34880
ds_read_b64_tr_b16 a[28:29], v7 offset:34400
v_mfma_f32_16x16x32_bf16 v[36:39], a[52:55], v[120:123], v[36:39]
ds_read_b64_tr_b16 a[30:31], v7 offset:34912
v_mfma_f32_16x16x32_bf16 v[52:55], a[52:55], v[124:127], v[52:55]
buffer_load_dwordx4 v[108:111], v4, s[16:19], s53 offen offset:1024 sc1
v_mfma_f32_16x16x32_bf16 v[40:43], a[56:59], v[120:123], v[40:43]
s_add_u32 s53, s53, 0x40000
v_mfma_f32_16x16x32_bf16 v[56:59], a[56:59], v[124:127], v[56:59]
v_mfma_f32_16x16x32_bf16 v[44:47], a[60:63], v[120:123], v[44:47]
v_mfma_f32_16x16x32_bf16 v[60:63], a[60:63], v[124:127], v[60:63]
s_waitcnt vmcnt(11) lgkmcnt(14)
v_mfma_f32_16x16x32_bf16 v[32:35], a[0:3], v[64:67], v[32:35]
ds_read_b64_tr_b16 a[32:33], v7 offset:41600
ds_read_b64_tr_b16 a[34:35], v7 offset:42112
s_waitcnt vmcnt(10)
v_mfma_f32_16x16x32_bf16 v[48:51], a[0:3], v[68:71], v[48:51]
buffer_load_dwordx4 v[112:115], v4, s[16:19], s52 offen sc1
s_waitcnt lgkmcnt(14)
v_mfma_f32_16x16x32_bf16 v[36:39], a[4:7], v[64:67], v[36:39]
ds_read_b64_tr_b16 a[36:37], v7 offset:41632
ds_read_b64_tr_b16 a[38:39], v7 offset:42144
.Lpad30:
s_cbranch_execz .Lnopoll47r
v_mfma_f32_16x16x32_bf16 v[52:55], a[4:7], v[68:71], v[52:55]
ds_read_b64_tr_b16 a[40:41], v7 offset:41664
ds_read_b64_tr_b16 a[42:43], v7 offset:42176
s_waitcnt lgkmcnt(15)
v_mfma_f32_16x16x32_bf16 v[40:43], a[8:11], v[64:67], v[40:43]
buffer_load_dwordx4 v[116:119], v4, s[16:19], s52 offen offset:1024 sc1
v_mfma_f32_16x16x32_bf16 v[56:59], a[8:11], v[68:71], v[56:59]
ds_read_b64_tr_b16 a[44:45], v7 offset:41696
s_add_u32 s52, s52, 0x40000
s_waitcnt lgkmcnt(15)
v_mfma_f32_16x16x32_bf16 v[44:47], a[12:15], v[64:67], v[44:47]
ds_read_b64_tr_b16 a[46:47], v7 offset:42208
v_mfma_f32_16x16x32_bf16 v[60:63], a[12:15], v[68:71], v[60:63]
ds_read_b64_tr_b16 a[48:49], v7 offset:42624
ds_read_b64_tr_b16 a[50:51], v7 offset:43136
s_waitcnt vmcnt(11) lgkmcnt(15)
v_mfma_f32_16x16x32_bf16 v[32:35], a[16:19], v[72:75], v[32:35]
buffer_load_dwordx4 v[120:123], v4, s[16:19], s53 offen sc1
s_waitcnt vmcnt(11)
v_mfma_f32_16x16x32_bf16 v[48:51], a[16:19], v[76:79], v[48:51]
ds_read_b64_tr_b16 a[52:53], v7 offset:42656
ds_read_b64_tr_b16 a[54:55], v7 offset:43168
s_waitcnt lgkmcnt(15)
v_mfma_f32_16x16x32_bf16 v[36:39], a[20:23], v[72:75], v[36:39]
ds_read_b64_tr_b16 a[56:57], v7 offset:42688
ds_read_b64_tr_b16 a[58:59], v7 offset:43200
v_mfma_f32_16x16x32_bf16 v[52:55], a[20:23], v[76:79], v[52:55]
buffer_load_dwordx4 v[124:127], v4, s[16:19], s53 offen offset:1024 sc1
s_waitcnt lgkmcnt(15)
v_mfma_f32_16x16x32_bf16 v[40:43], a[24:27], v[72:75], v[40:43]
ds_read_b64_tr_b16 a[60:61], v7 offset:42720
s_add_u32 s53, s53, 0x40000
v_mfma_f32_16x16x32_bf16 v[56:59], a[24:27], v[76:79], v[56:59]
ds_read_b64_tr_b16 a[62:63], v7 offset:43232
s_waitcnt lgkmcnt(15)
v_mfma_f32_16x16x32_bf16 v[44:47], a[28:31], v[72:75], v[44:47]
v_mfma_f32_16x16x32_bf16 v[60:63], a[28:31], v[76:79], v[60:63]
s_waitcnt vmcnt(11) lgkmcnt(14)
v_mfma_f32_16x16x32_bf16 v[32:35], a[32:35], v[80:83], v[32:35]
ds_read_b64_tr_b16 a[0:1], v7 offset:49920
ds_read_b64_tr_b16 a[2:3], v7 offset:50432
s_waitcnt vmcnt(10)
v_mfma_f32_16x16x32_bf16 v[48:51], a[32:35], v[84:87], v[48:51]
ds_read_b64_tr_b16 a[4:5], v7 offset:49952
s_waitcnt lgkmcnt(15)
v_mfma_f32_16x16x32_bf16 v[36:39], a[36:39], v[80:83], v[36:39]
ds_read_b64_tr_b16 a[6:7], v7 offset:50464
v_mfma_f32_16x16x32_bf16 v[52:55], a[36:39], v[84:87], v[52:55]
ds_read_b64_tr_b16 a[8:9], v7 offset:49984
s_waitcnt lgkmcnt(15)
v_mfma_f32_16x16x32_bf16 v[40:43], a[40:43], v[80:83], v[40:43]
ds_read_b64_tr_b16 a[10:11], v7 offset:50496
v_mfma_f32_16x16x32_bf16 v[56:59], a[40:43], v[84:87], v[56:59]
ds_read_b64_tr_b16 a[12:13], v7 offset:50016
s_waitcnt lgkmcnt(15)
v_mfma_f32_16x16x32_bf16 v[44:47], a[44:47], v[80:83], v[44:47]
ds_read_b64_tr_b16 a[14:15], v7 offset:50528
v_mfma_f32_16x16x32_bf16 v[60:63], a[44:47], v[84:87], v[60:63]
ds_read_b64_tr_b16 a[16:17], v7 offset:50944
ds_read_b64_tr_b16 a[18:19], v7 offset:51456
s_waitcnt vmcnt(9) lgkmcnt(15)
v_mfma_f32_16x16x32_bf16 v[32:35], a[48:51], v[88:91], v[32:35]
ds_read_b64_tr_b16 a[20:21], v7 offset:50976
s_waitcnt vmcnt(8)
v_mfma_f32_16x16x32_bf16 v[48:51], a[48:51], v[92:95], v[48:51]
ds_read_b64_tr_b16 a[22:23], v7 offset:51488
s_waitcnt lgkmcnt(15)
v_mfma_f32_16x16x32_bf16 v[36:39], a[52:55], v[88:91], v[36:39]
ds_read_b64_tr_b16 a[24:25], v7 offset:51008
v_mfma_f32_16x16x32_bf16 v[52:55], a[52:55], v[92:95], v[52:55]
ds_read_b64_tr_b16 a[26:27], v7 offset:51520
s_waitcnt lgkmcnt(15)
v_mfma_f32_16x16x32_bf16 v[40:43], a[56:59], v[88:91], v[40:43]
ds_read_b64_tr_b16 a[28:29], v7 offset:51040
v_mfma_f32_16x16x32_bf16 v[56:59], a[56:59], v[92:95], v[56:59]
ds_read_b64_tr_b16 a[30:31], v7 offset:51552
s_waitcnt lgkmcnt(15)
v_mfma_f32_16x16x32_bf16 v[44:47], a[60:63], v[88:91], v[44:47]
v_mfma_f32_16x16x32_bf16 v[60:63], a[60:63], v[92:95], v[60:63]
s_waitcnt vmcnt(7) lgkmcnt(14)
v_mfma_f32_16x16x32_bf16 v[32:35], a[0:3], v[96:99], v[32:35]
ds_read_b64_tr_b16 a[32:33], v7 offset:58240
ds_read_b64_tr_b16 a[34:35], v7 offset:58752
s_waitcnt vmcnt(6)
v_mfma_f32_16x16x32_bf16 v[48:51], a[0:3], v[100:103], v[48:51]
ds_read_b64_tr_b16 a[36:37], v7 offset:58272
s_waitcnt lgkmcnt(15)
v_mfma_f32_16x16x32_bf16 v[36:39], a[4:7], v[96:99], v[36:39]
ds_read_b64_tr_b16 a[38:39], v7 offset:58784
v_mfma_f32_16x16x32_bf16 v[52:55], a[4:7], v[100:103], v[52:55]
ds_read_b64_tr_b16 a[40:41], v7 offset:58304
s_waitcnt lgkmcnt(15)
v_mfma_f32_16x16x32_bf16 v[40:43], a[8:11], v[96:99], v[40:43]
ds_read_b64_tr_b16 a[42:43], v7 offset:58816
v_mfma_f32_16x16x32_bf16 v[56:59], a[8:11], v[100:103], v[56:59]
ds_read_b64_tr_b16 a[44:45], v7 offset:58336
s_waitcnt lgkmcnt(15)
v_mfma_f32_16x16x32_bf16 v[44:47], a[12:15], v[96:99], v[44:47]
ds_read_b64_tr_b16 a[46:47], v7 offset:58848
v_mfma_f32_16x16x32_bf16 v[60:63], a[12:15], v[100:103], v[60:63]
ds_read_b64_tr_b16 a[48:49], v7 offset:59264
ds_read_b64_tr_b16 a[50:51], v7 offset:59776
s_waitcnt vmcnt(5) lgkmcnt(15)
v_mfma_f32_16x16x32_bf16 v[32:35], a[16:19], v[104:107], v[32:35]
ds_read_b64_tr_b16 a[52:53], v7 offset:59296
s_waitcnt vmcnt(4)
v_mfma_f32_16x16x32_bf16 v[48:51], a[16:19], v[108:111], v[48:51]
ds_read_b64_tr_b16 a[54:55], v7 offset:59808
s_waitcnt lgkmcnt(15)
v_mfma_f32_16x16x32_bf16 v[36:39], a[20:23], v[104:107], v[36:39]
ds_read_b64_tr_b16 a[56:57], v7 offset:59328
v_mfma_f32_16x16x32_bf16 v[52:55], a[20:23], v[108:111], v[52:55]
ds_read_b64_tr_b16 a[58:59], v7 offset:59840
s_waitcnt lgkmcnt(15)
v_mfma_f32_16x16x32_bf16 v[40:43], a[24:27], v[104:107], v[40:43]
ds_read_b64_tr_b16 a[60:61], v7 offset:59360
v_mfma_f32_16x16x32_bf16 v[56:59], a[24:27], v[108:111], v[56:59]
ds_read_b64_tr_b16 a[62:63], v7 offset:59872
s_waitcnt lgkmcnt(15)
v_mfma_f32_16x16x32_bf16 v[44:47], a[28:31], v[104:107], v[44:47]
v_mfma_f32_16x16x32_bf16 v[60:63], a[28:31], v[108:111], v[60:63]
s_waitcnt vmcnt(3) lgkmcnt(14)
v_mfma_f32_16x16x32_bf16 v[32:35], a[32:35], v[112:115], v[32:35]
s_waitcnt vmcnt(2)
v_mfma_f32_16x16x32_bf16 v[48:51], a[32:35], v[116:119], v[48:51]
s_waitcnt lgkmcnt(12)
v_mfma_f32_16x16x32_bf16 v[36:39], a[36:39], v[112:115], v[36:39]
v_mfma_f32_16x16x32_bf16 v[52:55], a[36:39], v[116:119], v[52:55]
s_waitcnt lgkmcnt(10)
v_mfma_f32_16x16x32_bf16 v[40:43], a[40:43], v[112:115], v[40:43]
v_mfma_f32_16x16x32_bf16 v[56:59], a[40:43], v[116:119], v[56:59]
s_waitcnt lgkmcnt(8)
v_mfma_f32_16x16x32_bf16 v[44:47], a[44:47], v[112:115], v[44:47]
v_mfma_f32_16x16x32_bf16 v[60:63], a[44:47], v[116:119], v[60:63]
s_waitcnt vmcnt(1) lgkmcnt(6)
v_mfma_f32_16x16x32_bf16 v[32:35], a[48:51], v[120:123], v[32:35]
s_waitcnt vmcnt(0)
v_mfma_f32_16x16x32_bf16 v[48:51], a[48:51], v[124:127], v[48:51]
s_waitcnt lgkmcnt(4)
v_mfma_f32_16x16x32_bf16 v[36:39], a[52:55], v[120:123], v[36:39]
s_nop 3
v_cvt_pk_bf16_f32 v128, v32, v33
v_cvt_pk_bf16_f32 v129, v34, v35
v_mfma_f32_16x16x32_bf16 v[52:55], a[52:55], v[124:127], v[52:55]
v_cvt_pk_bf16_f32 v136, v48, v49
v_cvt_pk_bf16_f32 v137, v50, v51
s_waitcnt lgkmcnt(2)
v_mfma_f32_16x16x32_bf16 v[40:43], a[56:59], v[120:123], v[40:43]
v_cvt_pk_bf16_f32 v130, v36, v37
v_cvt_pk_bf16_f32 v131, v38, v39
v_mfma_f32_16x16x32_bf16 v[56:59], a[56:59], v[124:127], v[56:59]
v_permlane16_swap_b32 v128, v130
v_cvt_pk_bf16_f32 v138, v52, v53
s_waitcnt lgkmcnt(0)
v_mfma_f32_16x16x32_bf16 v[44:47], a[60:63], v[120:123], v[44:47]
v_permlane16_swap_b32 v129, v131
v_cvt_pk_bf16_f32 v132, v40, v41
v_mfma_f32_16x16x32_bf16 v[60:63], a[60:63], v[124:127], v[60:63]
buffer_store_dwordx4 v[128:131], v160, s[36:39], 0 offen
v_permlane16_swap_b32 v136, v138
v_cvt_pk_bf16_f32 v133, v42, v43
s_nop 1
v_cvt_pk_bf16_f32 v134, v44, v45
v_cvt_pk_bf16_f32 v135, v46, v47
v_cvt_pk_bf16_f32 v139, v54, v55
v_permlane16_swap_b32 v132, v134
v_cvt_pk_bf16_f32 v140, v56, v57
v_permlane16_swap_b32 v133, v135
v_cvt_pk_bf16_f32 v141, v58, v59
v_permlane16_swap_b32 v137, v139
v_cvt_pk_bf16_f32 v142, v60, v61
v_cvt_pk_bf16_f32 v143, v62, v63
buffer_store_dwordx4 v[132:135], v160, s[36:39], 0 offen offset:64
v_permlane16_swap_b32 v140, v142
v_permlane16_swap_b32 v141, v143
buffer_store_dwordx4 v[136:139], v161, s[36:39], 0 offen
buffer_store_dwordx4 v[140:143], v161, s[36:39], 0 offen offset:64
s_nop 1
.Lend:
s_endpgm
.section .rodata,"a"
.p2align 6
.amdhsa_kernel interleave_layers__sliding_local_dilated__swiglu_ffn__prompt_kernel
  .amdhsa_next_free_vgpr 512
  .amdhsa_next_free_sgpr 102
  .amdhsa_accum_offset 256
  .amdhsa_group_segment_fixed_size 0
  .amdhsa_kernarg_size 80
  .amdhsa_user_sgpr_count 2
  .amdhsa_user_sgpr_kernarg_segment_ptr 1
  .amdhsa_system_sgpr_workgroup_id_x 1
  .amdhsa_float_denorm_mode_32 3
.end_amdhsa_kernel
```

```asm
; @launch grid=(256,1,1) block=(256,1,1) lds=161536
.amdgcn_target "amdgcn-amd-amdhsa--gfx950"
.text
.globl interleave_layers__sliding_local_dilated__swiglu_ffn__prompt_kernel
.p2align 8
.type interleave_layers__sliding_local_dilated__swiglu_ffn__prompt_kernel,@function
interleave_layers__sliding_local_dilated__swiglu_ffn__prompt_kernel:
s_load_dwordx4 s[68:71], s[0:1], 0
s_load_dwordx2 s[72:73], s[0:1], 16
s_load_dwordx8 s[76:83], s[0:1], 32
s_load_dwordx4 s[84:87], s[0:1], 64
s_cmp_lt_u32 s2, 256
s_cbranch_scc1 .Lgo
s_endpgm
.p2align 12
.Lgo:
v_lshrrev_b32 v2, 6, v0
v_and_b32 v1, 63, v0
v_readfirstlane_b32 s3, v2
s_and_b32 s4, s2, 7
s_lshr_b32 s5, s2, 3
s_lshr_b32 s6, s4, 1
s_lshl_b32 s6, s6, 2
s_and_b32 s62, s5, 3
s_add_u32 s6, s6, s62
s_and_b32 s7, s4, 1
s_lshl_b32 s7, s7, 3
s_lshr_b32 s62, s5, 2
s_add_u32 s7, s7, s62
s_lshr_b32 s8, s4, 2
s_lshl_b32 s8, s8, 3
s_and_b32 s62, s5, 7
s_add_u32 s8, s8, s62
s_and_b32 s9, s4, 3
s_lshl_b32 s9, s9, 2
s_lshr_b32 s62, s5, 3
s_add_u32 s9, s9, s62
s_lshr_b32 s62, s6, 1
s_lshl_b32 s62, s62, 8
s_and_b32 s63, s6, 1
s_add_u32 s62, s62, s63
s_lshl_b32 s63, s3, 6
s_add_u32 s62, s62, s63
s_lshl_b32 s62, s62, 11
s_lshl_b32 s63, s7, 7
s_add_u32 s62, s62, s63
v_and_b32 v160, 15, v1
v_lshlrev_b32 v160, 12, v160
v_bfe_u32 v2, v1, 4, 1
v_lshl_add_u32 v160, v2, 5, v160
v_bfe_u32 v2, v1, 5, 1
v_lshl_add_u32 v160, v2, 4, v160
v_add_u32 v160, s62, v160
v_add_u32 v161, 0x10000, v160
s_sub_u32 s64, s3, 1
s_max_i32 s64, s64, 0
s_lshl_b32 s64, s64, 11
s_lshl_b32 s66, s9, 7
s_add_u32 s66, s66, s64
s_cmp_eq_u32 s3, 1
s_cselect_b32 s66, 8388608, s66
s_mul_i32 s65, s8, 122880
s_add_u32 s65, s65, s66
v_lshrrev_b32 v9, 1, v1
v_min_u32 v9, 19, v9
v_mul_u32_u24 v9, 6144, v9
s_waitcnt lgkmcnt(0)
s_mov_b32 s36, s68
s_mov_b32 s37, s69
s_mov_b32 s38, 4194304
s_mov_b32 s39, 0x20000
s_mov_b32 s16, s86
s_mov_b32 s17, s87
s_mov_b32 s18, 268435456
s_mov_b32 s19, 0x20000
s_lshl_b32 s67, s2, 2
s_add_u32 s67, s67, s3
v_mov_b32 v28, 0
s_cmp_lg_u32 s67, 3
s_cbranch_scc1 .Lz1
v_lshlrev_b32 v27, 7, v1
s_mov_b32 s62, 30408704
buffer_store_dword v28, v27, s[16:19], s62 offen sc1
s_mov_b32 s62, 30416896
buffer_store_dword v28, v27, s[16:19], s62 offen sc1
v_mov_b32 v64, 0x3f803f80
v_mov_b32 v65, 0x3f803f80
v_mov_b32 v66, 0x3f803f80
v_mov_b32 v67, 0x3f803f80
v_lshlrev_b32 v27, 17, v1
s_mov_b32 s62, 134217728
buffer_store_dwordx4 v[64:67], v27, s[16:19], s62 offen sc1
.Lz1:
buffer_load_dwordx4 v[128:131], v160, s[36:39], 0 offen nt
buffer_load_dwordx4 v[132:135], v160, s[36:39], 0 offen offset:64 nt
buffer_load_dwordx4 v[136:139], v161, s[36:39], 0 offen nt
buffer_load_dwordx4 v[140:143], v161, s[36:39], 0 offen offset:64 nt
s_mov_b32 s20, s70
s_mov_b32 s21, s71
s_mov_b32 s22, 6291456
s_mov_b32 s23, 0x20000
buffer_load_dword v30, v9, s[20:23], s65 offen
s_mov_b32 s40, s84
s_mov_b32 s41, s85
s_mov_b32 s42, 256
s_mov_b32 s43, 0x20000
v_mov_b32 v29, 1
s_cmp_lg_u32 s67, 3
s_cbranch_scc1 .Lz2
s_waitcnt vmcnt(5)
s_mov_b64 exec, 1
buffer_store_dword v29, v28, s[40:43], 0 offen sc1
s_mov_b64 exec, -1
.Lz2:
s_getpc_b64 s[62:63]
.Lpc:
s_lshl_b32 s64, s5, 12
v_lshrrev_b32 v31, 3, v0
v_lshl_add_u32 v31, v31, 7, s64
v_min_u32 v31, .Lend-.Lpc, v31
global_load_dword v31, v31, s[62:63]
s_mov_b32 s24, s72
s_mov_b32 s25, s73
s_mov_b32 s26, 2097152
s_mov_b32 s27, 0x20000
s_mov_b32 s28, s80
s_mov_b32 s29, s81
s_mov_b32 s30, 7340032
s_mov_b32 s31, 0x20000
s_cmp_lt_u32 s3, 2
s_cselect_b32 s32, s76, s78
s_cselect_b32 s33, s77, s79
s_mov_b32 s34, 7340032
s_mov_b32 s35, 0x20000
s_mov_b32 s36, s82
s_mov_b32 s37, s83
s_lshr_b32 s10, s4, 2
s_lshl_b32 s10, s10, 2
s_and_b32 s62, s5, 3
s_add_u32 s10, s10, s62
s_and_b32 s11, s4, 3
s_lshl_b32 s11, s11, 3
s_lshr_b32 s62, s5, 2
s_add_u32 s11, s11, s62
s_and_b32 s12, s11, 1
s_lshr_b32 s13, s11, 1
s_mul_i32 s51, s13, 448
s_mul_i32 s62, s12, 192
s_add_u32 s51, s51, s62
s_and_b32 s48, s3, 1
s_lshr_b32 s49, s3, 1
s_lshl_b32 s50, s8, 3
s_sub_u32 s50, s50, 9
s_cmp_lt_u32 s8, 2
s_cselect_b32 s50, 7, s50
s_mul_i32 s62, s8, 393216
s_add_u32 s62, s62, s66
v_mul_u32_u24 v14, 6144, v1
v_add_u32 v14, s62, v14
s_lshl_b32 s62, s8, 4
s_add_u32 s62, s62, s9
s_lshl_b32 s62, s62, 2
s_add_u32 s62, s62, s3
s_mul_i32 s62, s62, 6656
v_min_u32 v15, 51, v1
v_lshl_add_u32 v15, v15, 7, s62
s_sub_u32 s63, s8, 4
s_lshl_b32 s64, s8, 1
s_add_u32 s64, s64, 1
s_cmp_lt_u32 s8, 5
s_cselect_b64 vcc, -1, 0
s_cselect_b32 s46, s64, s63
v_cndmask_b32 v14, v14, v15, vcc
s_lshl_b32 s62, s2, 1
s_add_u32 s62, s62, s48
s_mul_i32 s62, s62, 5376
v_min_u32 v16, 41, v1
v_lshl_add_u32 v16, v16, 7, s62
s_cmp_lt_u32 s46, 6
s_cselect_b64 vcc, -1, 0
v_cndmask_b32 v15, v14, v16, vcc
v_cndmask_b32 v14, v16, v14, vcc
v_bfe_u32 v18, v1, 3, 1
v_lshrrev_b32 v2, 4, v1
v_lshl_add_u32 v18, v2, 3, v18
s_lshl_b32 s62, s3, 1
v_add_u32 v18, s62, v18
v_mul_u32_u24 v18, 6144, v18
v_and_b32 v2, 7, v1
v_lshl_add_u32 v18, v2, 4, v18
s_lshl_b32 s62, s9, 7
v_add_u32 v18, s62, v18
v_add_u32 v19, 1024, v18
v_add_u32 v20, 2048, v18
s_mul_i32 s59, s3, 3104
s_mov_b32 s58, 0
s_lshl_b32 s62, s6, 13
s_lshl_b32 s63, s3, 11
s_add_u32 s62, s62, s63
v_lshl_add_u32 v4, v1, 4, s62
v_lshrrev_b32 v2, 3, v1
v_cmp_eq_u32 vcc, 3, v2
v_add_u32 v2, 67108480, v4
s_nop 0
v_cndmask_b32 v4, v4, v2, vcc
s_lshl_b32 s64, s6, 14
s_lshl_b32 s65, s49, 13
s_add_u32 s64, s64, s65
s_lshl_b32 s65, s7, 9
s_add_u32 s64, s64, s65
s_lshl_b32 s65, s48, 8
s_add_u32 s64, s64, s65
s_add_u32 s64, s64, 29360128
v_and_b32 v152, 31, v1
v_lshlrev_b32 v152, 3, v152
v_lshrrev_b32 v153, 5, v1
v_lshl_add_u32 v152, v153, 2, v152
s_lshl_b32 s62, s7, 18
s_add_u32 s62, s62, 0
s_add_u32 s63, s62, 0x20000
s_waitcnt vmcnt(5)
v_permlane16_swap_b32 v128, v130
v_permlane16_swap_b32 v129, v131
s_waitcnt vmcnt(4)
v_permlane16_swap_b32 v132, v134
v_permlane16_swap_b32 v133, v135
s_waitcnt vmcnt(3)
v_permlane16_swap_b32 v136, v138
v_permlane16_swap_b32 v137, v139
s_waitcnt vmcnt(2)
v_permlane16_swap_b32 v140, v142
v_permlane16_swap_b32 v141, v143
buffer_store_dwordx4 v[128:131], v4, s[16:19], s62 offen sc1
buffer_store_dwordx4 v[132:135], v4, s[16:19], s63 offen sc1
buffer_store_dwordx4 v[136:139], v4, s[16:19], s62 offen offset:1024 sc1
buffer_store_dwordx4 v[140:143], v4, s[16:19], s63 offen offset:1024 sc1
v_lshlrev_b32 v32, 16, v128
v_and_b32 v33, 0xffff0000, v128
v_lshlrev_b32 v34, 16, v129
v_and_b32 v35, 0xffff0000, v129
v_lshlrev_b32 v36, 16, v130
v_and_b32 v37, 0xffff0000, v130
v_lshlrev_b32 v38, 16, v131
v_and_b32 v39, 0xffff0000, v131
v_lshlrev_b32 v40, 16, v132
v_and_b32 v41, 0xffff0000, v132
v_lshlrev_b32 v42, 16, v133
v_and_b32 v43, 0xffff0000, v133
v_lshlrev_b32 v44, 16, v134
v_and_b32 v45, 0xffff0000, v134
v_lshlrev_b32 v46, 16, v135
v_and_b32 v47, 0xffff0000, v135
v_lshlrev_b32 v48, 16, v136
v_and_b32 v49, 0xffff0000, v136
v_lshlrev_b32 v50, 16, v137
v_and_b32 v51, 0xffff0000, v137
v_lshlrev_b32 v52, 16, v138
v_and_b32 v53, 0xffff0000, v138
v_lshlrev_b32 v54, 16, v139
v_and_b32 v55, 0xffff0000, v139
v_lshlrev_b32 v56, 16, v140
v_and_b32 v57, 0xffff0000, v140
v_lshlrev_b32 v58, 16, v141
v_and_b32 v59, 0xffff0000, v141
v_lshlrev_b32 v60, 16, v142
v_and_b32 v61, 0xffff0000, v142
v_lshlrev_b32 v62, 16, v143
v_and_b32 v63, 0xffff0000, v143
v_pk_mul_f32 v[146:147], v[32:33], v[32:33]
v_pk_mul_f32 v[150:151], v[48:49], v[48:49]
v_pk_fma_f32 v[146:147], v[34:35], v[34:35], v[146:147]
v_pk_add_f32 v[144:145], v[32:33], v[34:35]
v_pk_fma_f32 v[150:151], v[50:51], v[50:51], v[150:151]
v_pk_add_f32 v[148:149], v[48:49], v[50:51]
v_pk_fma_f32 v[146:147], v[36:37], v[36:37], v[146:147]
v_pk_add_f32 v[144:145], v[144:145], v[36:37]
v_pk_fma_f32 v[150:151], v[52:53], v[52:53], v[150:151]
v_pk_add_f32 v[148:149], v[148:149], v[52:53]
v_pk_fma_f32 v[146:147], v[38:39], v[38:39], v[146:147]
v_pk_add_f32 v[144:145], v[144:145], v[38:39]
v_pk_fma_f32 v[150:151], v[54:55], v[54:55], v[150:151]
v_pk_add_f32 v[148:149], v[148:149], v[54:55]
v_pk_fma_f32 v[146:147], v[40:41], v[40:41], v[146:147]
v_pk_add_f32 v[144:145], v[144:145], v[40:41]
v_pk_fma_f32 v[150:151], v[56:57], v[56:57], v[150:151]
v_pk_add_f32 v[148:149], v[148:149], v[56:57]
v_pk_fma_f32 v[146:147], v[42:43], v[42:43], v[146:147]
v_pk_add_f32 v[144:145], v[144:145], v[42:43]
v_pk_fma_f32 v[150:151], v[58:59], v[58:59], v[150:151]
v_pk_add_f32 v[148:149], v[148:149], v[58:59]
v_pk_fma_f32 v[146:147], v[44:45], v[44:45], v[146:147]
v_pk_add_f32 v[144:145], v[144:145], v[44:45]
v_pk_fma_f32 v[150:151], v[60:61], v[60:61], v[150:151]
v_pk_add_f32 v[148:149], v[148:149], v[60:61]
v_pk_fma_f32 v[146:147], v[46:47], v[46:47], v[146:147]
v_pk_add_f32 v[144:145], v[144:145], v[46:47]
v_pk_fma_f32 v[150:151], v[62:63], v[62:63], v[150:151]
v_pk_add_f32 v[148:149], v[148:149], v[62:63]
v_add_f32 v144, v144, v145
v_add_f32 v146, v146, v147
v_add_f32 v148, v148, v149
v_add_f32 v150, v150, v151
s_nop 0
v_permlane16_swap_b32 v144, v148
v_permlane16_swap_b32 v146, v150
v_add_f32 v144, v144, v148
v_add_f32 v146, v146, v150
s_nop 1
v_permlane32_swap_b32 v144, v146
v_add_f32 v144, v144, v146
buffer_store_dword v144, v152, s[16:19], s64 offen sc1
buffer_load_dword v255, v28, s[40:43], 0 offen sc1
s_add_u32 m0, s59, 66560
s_nop 0
buffer_load_dwordx4 v18, s[20:23], s58 offen lds
buffer_load_dwordx4 v19, s[20:23], s58 offen offset:1024 lds
buffer_load_dwordx4 v20, s[20:23], s58 offen offset:2048 lds
s_add_u32 s58, s58, 196608
s_add_u32 m0, s59, 78976
s_nop 0
buffer_load_dwordx4 v18, s[20:23], s58 offen lds
buffer_load_dwordx4 v19, s[20:23], s58 offen offset:1024 lds
buffer_load_dwordx4 v20, s[20:23], s58 offen offset:2048 lds
s_add_u32 s58, s58, 196608
s_add_u32 m0, s59, 91392
s_nop 0
buffer_load_dwordx4 v18, s[20:23], s58 offen lds
buffer_load_dwordx4 v19, s[20:23], s58 offen offset:1024 lds
buffer_load_dwordx4 v20, s[20:23], s58 offen offset:2048 lds
s_add_u32 s58, s58, 196608
s_add_u32 m0, s59, 103808
s_nop 0
buffer_load_dwordx4 v18, s[20:23], s58 offen lds
buffer_load_dwordx4 v19, s[20:23], s58 offen offset:1024 lds
buffer_load_dwordx4 v20, s[20:23], s58 offen offset:2048 lds
s_add_u32 s58, s58, 196608
s_add_u32 m0, s59, 116224
s_nop 0
buffer_load_dwordx4 v18, s[20:23], s58 offen lds
buffer_load_dwordx4 v19, s[20:23], s58 offen offset:1024 lds
buffer_load_dwordx4 v20, s[20:23], s58 offen offset:2048 lds
s_add_u32 s58, s58, 196608
s_nop 1
v_accvgpr_write_b32 a224, v32
v_accvgpr_write_b32 a225, v33
v_accvgpr_write_b32 a226, v34
v_accvgpr_write_b32 a227, v35
v_accvgpr_write_b32 a228, v36
v_accvgpr_write_b32 a229, v37
v_accvgpr_write_b32 a230, v38
v_accvgpr_write_b32 a231, v39
v_accvgpr_write_b32 a232, v40
v_accvgpr_write_b32 a233, v41
v_accvgpr_write_b32 a234, v42
v_accvgpr_write_b32 a235, v43
v_accvgpr_write_b32 a236, v44
v_accvgpr_write_b32 a237, v45
v_accvgpr_write_b32 a238, v46
v_accvgpr_write_b32 a239, v47
v_accvgpr_write_b32 a240, v48
v_accvgpr_write_b32 a241, v49
v_accvgpr_write_b32 a242, v50
v_accvgpr_write_b32 a243, v51
v_accvgpr_write_b32 a244, v52
v_accvgpr_write_b32 a245, v53
v_accvgpr_write_b32 a246, v54
v_accvgpr_write_b32 a247, v55
v_accvgpr_write_b32 a248, v56
v_accvgpr_write_b32 a249, v57
v_accvgpr_write_b32 a250, v58
v_accvgpr_write_b32 a251, v59
v_accvgpr_write_b32 a252, v60
v_accvgpr_write_b32 a253, v61
v_accvgpr_write_b32 a254, v62
v_accvgpr_write_b32 a255, v63
s_lshl_b32 s62, s8, 13
s_lshl_b32 s63, s3, 11
s_add_u32 s62, s62, s63
v_lshl_add_u32 v21, v1, 4, s62
v_lshrrev_b32 v2, 3, v1
v_cmp_eq_u32 vcc, 3, v2
v_add_u32 v2, 67108480, v21
s_nop 0
v_cndmask_b32 v21, v21, v2, vcc
s_lshl_b32 s62, s50, 10
s_sub_u32 s62, s62, 2048
v_lshl_add_u32 v22, v0, 2, s62
v_lshrrev_b32 v2, 5, v0
v_cmp_eq_u32 vcc, 3, v2
v_add_u32 v2, 67108480, v22
s_nop 0
v_cndmask_b32 v22, v22, v2, vcc
v_lshlrev_b32 v2, 2, v1
v_add_u32 v2, 134215680, v2
v_cmp_gt_u32 vcc, 4, v1
s_nop 1
v_cndmask_b32 v22, v22, v2, vcc
s_mul_i32 s62, s48, 4608
v_lshl_add_u32 v23, v1, 4, s62
v_lshrrev_b32 v24, 4, v1
v_mul_u32_u24 v24, 2304, v24
v_and_b32 v2, 15, v1
v_lshl_add_u32 v24, v2, 4, v24
v_bfe_u32 v25, v1, 3, 2
v_mul_u32_u24 v25, 3104, v25
v_bfe_u32 v2, v1, 2, 1
v_lshl_add_u32 v25, v2, 7, v25
v_bfe_u32 v2, v1, 5, 1
v_lshl_add_u32 v25, v2, 8, v25
v_and_b32 v2, 3, v1
v_lshl_add_u32 v25, v2, 3, v25
s_lshl_b32 s62, s49, 6
s_add_u32 s62, s62, 66560
v_add_u32 v25, s62, v25
s_lshl_b32 s62, s8, 1
s_add_u32 s62, s62, s3
s_lshr_b32 s63, s50, 2
s_cmp_lt_u32 s3, 2
s_cselect_b32 s62, s62, s63
s_lshl_b32 s62, s62, 13
s_cmp_eq_u32 s3, 3
s_cselect_b32 s62, 268435456, s62
v_lshl_add_u32 v26, v1, 4, s62
s_mov_b32 s52, 0
s_mov_b32 s54, s58
s_mov_b32 s56, s59
s_mul_i32 s55, s3, 2304
s_mul_i32 s59, s3, 2080
v_bfe_u32 v5, v1, 3, 1
v_lshrrev_b32 v2, 4, v1
v_lshl_add_u32 v5, v2, 3, v5
s_lshl_b32 s62, s3, 1
v_add_u32 v5, s62, v5
v_mul_u32_u24 v5, 2048, v5
v_and_b32 v2, 7, v1
v_lshl_add_u32 v5, v2, 4, v5
s_lshl_b32 s62, s7, 7
v_add_u32 v5, s62, v5
v_add_u32 v6, 64512, v5
s_lshl_b32 s62, s6, 7
s_add_u32 s62, s62, 30408704
s_lshl_b32 s64, s8, 7
s_add_u32 s64, s64, 30408704
s_lshr_b32 s65, s50, 3
s_lshl_b32 s65, s65, 7
s_add_u32 s65, s65, 30408704
v_mov_b32 v252, s62
v_mov_b32 v253, s64
v_writelane_b32 v253, s65, 1
s_waitcnt vmcnt(15) lgkmcnt(0)
s_cmp_lg_u32 s3, 1
s_cbranch_scc1 .Lrdyok4
s_mov_b32 s15, 0
v_mov_b32 v2, 0
.Lrdy3:
v_cmp_ne_u32 vcc, 0, v255
s_add_u32 s15, s15, 1
s_cbranch_vccnz .Lrdyok4
s_cmp_gt_u32 s15, 100000
s_cbranch_scc1 .Lrdyok4
buffer_load_dword v255, v2, s[40:43], 0 offen sc1
s_waitcnt vmcnt(0)
s_branch .Lrdy3
.Lrdyok4:
s_barrier
s_cmp_lg_u32 s3, 1
s_cbranch_scc1 .Lnosig5
v_mov_b32 v255, 1
s_mov_b64 exec, 1
buffer_atomic_add v255, v252, s[16:19], 0 offen
s_mov_b64 exec, -1
.Lnosig5:
s_cmp_lt_u32 s8, 5
s_cselect_b32 s62, s24, s20
s_cselect_b32 s63, s25, s21
s_cselect_b32 s64, s26, s22
s_sub_u32 s47, s46, 6
s_cmp_lt_u32 s46, 6
s_cselect_b32 s47, s46, s47
s_cselect_b32 s40, s62, s32
s_cselect_b32 s98, s32, s62
s_cselect_b32 s41, s63, s33
s_cselect_b32 s99, s33, s63
s_cselect_b32 s42, s64, s34
s_cselect_b32 s100, s34, s64
v_lshrrev_b32 v2, 4, v1
v_lshlrev_b32 v2, 2, v2
v_and_b32 v13, 15, v1
v_sub_u32 v2, v13, v2
v_mov_b32 v13, 0xff61b1e6
v_subrev_u32 v54, 0, v2
v_cmp_gt_u32 vcc, 8, v54
s_nop 1
v_cndmask_b32 v50, v13, 0, vcc
v_cmp_gt_i32 vcc, -8, v54
s_nop 1
v_cndmask_b32 v46, v13, 0, vcc
v_subrev_u32 v54, 1, v2
v_cmp_gt_u32 vcc, 8, v54
s_nop 1
v_cndmask_b32 v51, v13, 0, vcc
v_cmp_gt_i32 vcc, -8, v54
s_nop 1
v_cndmask_b32 v47, v13, 0, vcc
v_subrev_u32 v54, 2, v2
v_cmp_gt_u32 vcc, 8, v54
s_nop 1
v_cndmask_b32 v52, v13, 0, vcc
v_cmp_gt_i32 vcc, -8, v54
s_nop 1
v_cndmask_b32 v48, v13, 0, vcc
v_subrev_u32 v54, 3, v2
v_cmp_gt_u32 vcc, 8, v54
s_nop 1
v_cndmask_b32 v53, v13, 0, vcc
v_cmp_gt_i32 vcc, -8, v54
s_nop 1
v_cndmask_b32 v49, v13, 0, vcc
s_cmp_lt_u32 s8, 2
s_cselect_b64 vcc, -1, 0
v_cndmask_b32 v54, v46, v13, vcc
v_cndmask_b32 v55, v47, v13, vcc
v_cndmask_b32 v56, v48, v13, vcc
v_cndmask_b32 v57, v49, v13, vcc
v_mov_b64 v[60:61], 0
v_mov_b64 v[62:63], 0
v_mov_b64 v[64:65], 0
v_mov_b64 v[66:67], 0
v_mov_b64 v[68:69], 0
v_mov_b64 v[70:71], 0
v_mov_b64 v[72:73], 0
v_mov_b64 v[74:75], 0
v_mov_b64 v[76:77], 0
v_mov_b64 v[78:79], 0
v_mov_b64 v[80:81], 0
v_mov_b64 v[82:83], 0
v_mov_b64 v[84:85], 0
v_mov_b64 v[86:87], 0
v_mov_b64 v[88:89], 0
v_mov_b64 v[90:91], 0
v_mov_b64 v[92:93], 0
v_mov_b64 v[94:95], 0
v_mov_b64 v[96:97], 0
v_mov_b64 v[98:99], 0
v_mov_b64 v[100:101], 0
v_mov_b64 v[102:103], 0
v_mov_b64 v[104:105], 0
v_mov_b64 v[106:107], 0
v_mov_b64 v[108:109], 0
v_mov_b64 v[110:111], 0
v_mov_b64 v[112:113], 0
v_mov_b64 v[114:115], 0
v_mov_b64 v[116:117], 0
v_mov_b64 v[118:119], 0
v_mov_b64 v[120:121], 0
v_mov_b64 v[122:123], 0
v_mov_b64 v[124:125], 0
v_mov_b64 v[126:127], 0
v_mov_b64 v[128:129], 0
v_mov_b64 v[130:131], 0
v_mov_b64 v[132:133], 0
v_mov_b64 v[134:135], 0
v_mov_b64 v[136:137], 0
v_mov_b64 v[138:139], 0
v_mov_b64 v[140:141], 0
v_mov_b64 v[142:143], 0
v_mov_b64 v[144:145], 0
v_mov_b64 v[146:147], 0
v_mov_b64 v[148:149], 0
v_mov_b64 v[150:151], 0
v_mov_b64 v[152:153], 0
v_mov_b64 v[154:155], 0
v_mov_b64 v[156:157], 0
v_mov_b64 v[158:159], 0
v_mov_b64 v[160:161], 0
v_mov_b64 v[162:163], 0
v_mov_b64 v[164:165], 0
v_mov_b64 v[166:167], 0
v_mov_b64 v[168:169], 0
v_mov_b64 v[170:171], 0
v_mov_b64 v[172:173], 0
v_mov_b64 v[174:175], 0
v_mov_b64 v[244:245], 0
v_mov_b64 v[246:247], 0
s_mov_b32 s75, 29360128
v_and_b32 v10, 15, v1
v_lshlrev_b32 v12, 2, v10
v_lshlrev_b32 v10, 4, v10
v_add_u32 v10, 151552, v10
v_lshrrev_b32 v11, 4, v1
v_lshlrev_b32 v11, 4, v11
s_lshl_b32 s62, s49, 7
s_add_u32 s62, s62, 157696
v_add_u32 v12, s62, v12
v_add_u32 v13, s62, v11
v_add_u32 v11, 155648, v11
s_lshl_b32 s62, s3, 11
s_add_u32 s62, s62, 143360
v_lshl_add_u32 v8, v1, 4, s62
v_xor_b32 v9, 2048, v8
v_mov_b32 v248, 0x3f803f80
v_mov_b32 v249, 0x3f803f80
v_mov_b32 v250, 0x3f803f80
v_mov_b32 v251, 0x3f803f80
v_and_b32 v7, 31, v1
v_lshrrev_b32 v2, 5, v1
v_lshl_add_u32 v7, v7, 1, v2
v_and_b32 v2, 0xc0, v0
v_add_u32 v7, v7, v2
v_lshlrev_b32 v17, 2, v7
v_add_u32 v17, 155648, v17
v_lshlrev_b32 v7, 4, v7
v_add_u32 v7, 151552, v7
s_lshl_b32 s74, s9, 1
s_add_u32 s74, s74, s49
s_lshl_b32 s74, s74, 17
s_lshl_b32 s63, s8, 13
s_add_u32 s74, s74, s63
s_lshl_b32 s63, s48, 12
s_add_u32 s74, s74, s63
s_add_u32 s74, s74, 4194304
s_mov_b32 s62, 0
v_lshl_add_u32 v4, v1, 4, s62
v_lshrrev_b32 v2, 3, v1
v_cmp_eq_u32 vcc, 3, v2
v_add_u32 v2, 67108480, v4
s_nop 0
v_cndmask_b32 v4, v4, v2, vcc
s_waitcnt lgkmcnt(0)
s_cmp_lg_u32 s3, 1
s_cbranch_scc1 .Lnopoll8
s_mov_b64 exec, 3
s_mov_b32 s15, 0
.Lpoll6:
buffer_load_dword v255, v253, s[16:19], 0 offen sc1
s_add_u32 s15, s15, 1
s_cmp_gt_u32 s15, 100000
s_cbranch_scc1 .Lgot7
s_waitcnt vmcnt(0)
v_cmp_ne_u32 vcc, 16, v255
s_nop 0
s_cbranch_vccnz .Lpoll6
.Lgot7:
s_waitcnt vmcnt(0)
s_branch .Lnopoll8r
.Lnopoll8:
s_mov_b64 exec, 0
s_cmp_eq_u32 s3, 2
s_cbranch_scc1 .Lpad1
s_cmp_eq_u32 s3, 3
s_cbranch_scc1 .Lpad2
s_branch .Lpad3
.Lnopoll8r:
s_mov_b64 exec, -1
s_barrier
s_cmp_eq_u32 s48, 1
s_cbranch_scc1 .Lqkv9
s_add_u32 m0, s55, 0
s_nop 0
buffer_load_dwordx4 v21, s[16:19], s52 offen sc1 lds
buffer_load_dwordx4 v21, s[16:19], s52 offen offset:1024 sc1 lds
buffer_load_dword v22, s[16:19], s52 offen offset:2048 sc1 lds
s_add_u32 s52, s52, 0x20000
s_add_u32 m0, s55, 9216
s_nop 0
buffer_load_dwordx4 v21, s[16:19], s52 offen sc1 lds
buffer_load_dwordx4 v21, s[16:19], s52 offen offset:1024 sc1 lds
buffer_load_dword v22, s[16:19], s52 offen offset:2048 sc1 lds
s_add_u32 s52, s52, 0x20000
s_add_u32 m0, s55, 18432
s_nop 0
buffer_load_dwordx4 v21, s[16:19], s52 offen sc1 lds
buffer_load_dwordx4 v21, s[16:19], s52 offen offset:1024 sc1 lds
buffer_load_dword v22, s[16:19], s52 offen offset:2048 sc1 lds
s_add_u32 s52, s52, 0x20000
s_add_u32 m0, s55, 27648
s_nop 0
buffer_load_dwordx4 v21, s[16:19], s52 offen sc1 lds
buffer_load_dwordx4 v21, s[16:19], s52 offen offset:1024 sc1 lds
buffer_load_dword v22, s[16:19], s52 offen offset:2048 sc1 lds
s_add_u32 s52, s52, 0x20000
s_add_u32 m0, s55, 36864
s_nop 0
buffer_load_dwordx4 v21, s[16:19], s52 offen sc1 lds
buffer_load_dwordx4 v21, s[16:19], s52 offen offset:1024 sc1 lds
buffer_load_dword v22, s[16:19], s52 offen offset:2048 sc1 lds
s_add_u32 s52, s52, 0x20000
s_waitcnt vmcnt(12)
s_barrier
ds_read_b128 a[0:3], v23
ds_read_b128 a[4:7], v23 offset:1024
ds_read_b128 a[8:11], v23 offset:2304
ds_read_b128 a[12:15], v23 offset:3328
ds_read_b64_tr_b16 a[20:21], v25
ds_read_b64_tr_b16 a[22:23], v25 offset:512
ds_read_b64_tr_b16 a[24:25], v25 offset:32
ds_read_b64_tr_b16 a[26:27], v25 offset:544
ds_read_b128 a[16:19], v24 offset:2048
ds_read_b64_tr_b16 a[28:29], v25 offset:1024
ds_read_b64_tr_b16 a[30:31], v25 offset:1536
ds_read_b64_tr_b16 a[32:33], v25 offset:1056
ds_read_b64_tr_b16 a[34:35], v25 offset:1568
ds_read_b64_tr_b16 a[36:37], v25 offset:2048
ds_read_b64_tr_b16 a[38:39], v25 offset:2560
ds_read_b64_tr_b16 a[40:41], v25 offset:2080
ds_read_b64_tr_b16 a[42:43], v25 offset:2592
s_waitcnt lgkmcnt(0)
s_mov_b32 s15, -4
.p2align 6
.Lk11:
s_waitcnt vmcnt(9) lgkmcnt(6)
s_barrier
v_mfma_f32_16x16x32_bf16 v[60:63], a[20:23], a[0:3], v[60:63]
ds_read_b128 a[44:47], v23 offset:9216
s_add_u32 m0, s56, 128640
v_mfma_f32_16x16x32_bf16 v[64:67], a[20:23], a[4:7], v[64:67]
buffer_load_dwordx4 v18, s[20:23], s54 offen lds
v_mfma_f32_16x16x32_bf16 v[68:71], a[20:23], a[8:11], v[68:71]
s_sub_u32 s47, s47, 1
s_cbranch_scc1 .Lx12
.Lx12b:
v_mfma_f32_16x16x32_bf16 v[72:75], a[20:23], a[12:15], v[72:75]
ds_read_b128 a[48:51], v23 offset:10240
v_add_f32 v164, v164, v168
v_mfma_f32_16x16x32_bf16 v[244:247], a[20:23], a[16:19], v[244:247]
ds_read_b128 a[52:55], v23 offset:11520
v_mfma_f32_16x16x32_bf16 v[76:79], a[24:27], a[0:3], v[76:79]
buffer_load_dwordx4 v19, s[20:23], s54 offen offset:1024 lds
v_mfma_f32_16x16x32_bf16 v[80:83], a[24:27], a[4:7], v[80:83]
ds_read_b128 a[56:59], v23 offset:12544
v_mfma_f32_16x16x32_bf16 v[84:87], a[24:27], a[8:11], v[84:87]
ds_read_b64_tr_b16 a[64:65], v25 offset:12416
v_mfma_f32_16x16x32_bf16 v[88:91], a[24:27], a[12:15], v[88:91]
ds_read_b64_tr_b16 a[66:67], v25 offset:12928
v_add_f32 v165, v165, v169
v_mfma_f32_16x16x32_bf16 v[92:95], a[28:31], a[0:3], v[92:95]
buffer_load_dwordx4 v20, s[20:23], s54 offen offset:2048 lds
v_mfma_f32_16x16x32_bf16 v[96:99], a[28:31], a[4:7], v[96:99]
s_add_u32 s54, s54, 196608
s_waitcnt lgkmcnt(6)
v_mfma_f32_16x16x32_bf16 v[100:103], a[28:31], a[8:11], v[100:103]
ds_read_b64_tr_b16 a[68:69], v25 offset:12448
v_mfma_f32_16x16x32_bf16 v[104:107], a[28:31], a[12:15], v[104:107]
ds_read_b64_tr_b16 a[70:71], v25 offset:12960
s_add_u32 m0, s55, 46080
v_mfma_f32_16x16x32_bf16 v[156:159], a[28:31], a[16:19], v[156:159]
buffer_load_dwordx4 v21, s[16:19], s52 offen sc1 lds
.Lpad1:
s_cbranch_execz .Lpad4
v_mfma_f32_16x16x32_bf16 v[108:111], a[32:35], a[0:3], v[108:111]
ds_read_b128 a[60:63], v24 offset:11264
v_mfma_f32_16x16x32_bf16 v[112:115], a[32:35], a[4:7], v[112:115]
ds_read_b64_tr_b16 a[72:73], v25 offset:13440
v_add_f32 v166, v166, v170
v_mfma_f32_16x16x32_bf16 v[116:119], a[32:35], a[8:11], v[116:119]
ds_read_b64_tr_b16 a[74:75], v25 offset:13952
v_mfma_f32_16x16x32_bf16 v[120:123], a[32:35], a[12:15], v[120:123]
buffer_load_dwordx4 v21, s[16:19], s52 offen offset:1024 sc1 lds
v_mfma_f32_16x16x32_bf16 v[160:163], a[32:35], a[16:19], v[160:163]
ds_read_b64_tr_b16 a[76:77], v25 offset:13472
v_mfma_f32_16x16x32_bf16 v[124:127], a[0:3], a[36:39], v[124:127]
ds_read_b64_tr_b16 a[78:79], v25 offset:13984
v_mfma_f32_16x16x32_bf16 v[128:131], a[4:7], a[36:39], v[128:131]
ds_read_b64_tr_b16 a[80:81], v25 offset:14464
v_add_f32 v167, v167, v171
v_mfma_f32_16x16x32_bf16 v[132:135], a[8:11], a[36:39], v[132:135]
buffer_load_dword v22, s[16:19], s52 offen offset:2048 sc1 lds
v_mfma_f32_16x16x32_bf16 v[136:139], a[12:15], a[36:39], v[136:139]
ds_read_b64_tr_b16 a[82:83], v25 offset:14976
s_add_u32 s52, s52, 0x20000
v_mfma_f32_16x16x32_bf16 v[140:143], a[0:3], a[40:43], v[140:143]
ds_read_b64_tr_b16 a[84:85], v25 offset:14496
v_mfma_f32_16x16x32_bf16 v[144:147], a[4:7], a[40:43], v[144:147]
ds_read_b64_tr_b16 a[86:87], v25 offset:15008
v_mfma_f32_16x16x32_bf16 v[148:151], a[8:11], a[40:43], v[148:151]
v_mfma_f32_16x16x32_bf16 v[152:155], a[12:15], a[40:43], v[152:155]
s_waitcnt vmcnt(12) lgkmcnt(6)
s_barrier
v_mfma_f32_16x16x32_bf16 v[60:63], a[64:67], a[44:47], v[60:63]
ds_read_b128 a[0:3], v23 offset:18432
s_add_u32 m0, s56, 66560
v_mfma_f32_16x16x32_bf16 v[64:67], a[64:67], a[48:51], v[64:67]
buffer_load_dwordx4 v18, s[20:23], s54 offen lds
v_mfma_f32_16x16x32_bf16 v[68:71], a[64:67], a[52:55], v[68:71]
ds_read_b128 a[4:7], v23 offset:19456
v_mfma_f32_16x16x32_bf16 v[72:75], a[64:67], a[56:59], v[72:75]
ds_read_b128 a[8:11], v23 offset:20736
v_mfma_f32_16x16x32_bf16 v[244:247], a[64:67], a[60:63], v[244:247]
buffer_load_dwordx4 v19, s[20:23], s54 offen offset:1024 lds
v_mfma_f32_16x16x32_bf16 v[76:79], a[68:71], a[44:47], v[76:79]
ds_read_b128 a[12:15], v23 offset:21760
v_mfma_f32_16x16x32_bf16 v[80:83], a[68:71], a[48:51], v[80:83]
ds_read_b64_tr_b16 a[20:21], v25 offset:24832
v_mfma_f32_16x16x32_bf16 v[84:87], a[68:71], a[52:55], v[84:87]
ds_read_b64_tr_b16 a[22:23], v25 offset:25344
v_mfma_f32_16x16x32_bf16 v[88:91], a[68:71], a[56:59], v[88:91]
buffer_load_dwordx4 v20, s[20:23], s54 offen offset:2048 lds
v_mfma_f32_16x16x32_bf16 v[92:95], a[72:75], a[44:47], v[92:95]
ds_read_b64_tr_b16 a[24:25], v25 offset:24864
s_add_u32 s54, s54, 196608
v_mfma_f32_16x16x32_bf16 v[96:99], a[72:75], a[48:51], v[96:99]
s_add_u32 m0, s55, 0
s_waitcnt lgkmcnt(7)
v_mfma_f32_16x16x32_bf16 v[100:103], a[72:75], a[52:55], v[100:103]
buffer_load_dwordx4 v21, s[16:19], s52 offen sc1 lds
v_mfma_f32_16x16x32_bf16 v[104:107], a[72:75], a[56:59], v[104:107]
ds_read_b64_tr_b16 a[26:27], v25 offset:25376
v_mfma_f32_16x16x32_bf16 v[156:159], a[72:75], a[60:63], v[156:159]
ds_read_b128 a[16:19], v24 offset:20480
v_mfma_f32_16x16x32_bf16 v[108:111], a[76:79], a[44:47], v[108:111]
ds_read_b64_tr_b16 a[28:29], v25 offset:25856
v_mfma_f32_16x16x32_bf16 v[112:115], a[76:79], a[48:51], v[112:115]
buffer_load_dwordx4 v21, s[16:19], s52 offen offset:1024 sc1 lds
v_mfma_f32_16x16x32_bf16 v[116:119], a[76:79], a[52:55], v[116:119]
ds_read_b64_tr_b16 a[30:31], v25 offset:26368
v_mfma_f32_16x16x32_bf16 v[120:123], a[76:79], a[56:59], v[120:123]
ds_read_b64_tr_b16 a[32:33], v25 offset:25888
v_mfma_f32_16x16x32_bf16 v[160:163], a[76:79], a[60:63], v[160:163]
buffer_load_dword v22, s[16:19], s52 offen offset:2048 sc1 lds
v_mfma_f32_16x16x32_bf16 v[124:127], a[44:47], a[80:83], v[124:127]
ds_read_b64_tr_b16 a[34:35], v25 offset:26400
s_add_u32 s52, s52, 0x20000
v_mfma_f32_16x16x32_bf16 v[128:131], a[48:51], a[80:83], v[128:131]
ds_read_b64_tr_b16 a[36:37], v25 offset:26880
v_mfma_f32_16x16x32_bf16 v[132:135], a[52:55], a[80:83], v[132:135]
ds_read_b64_tr_b16 a[38:39], v25 offset:27392
v_mfma_f32_16x16x32_bf16 v[136:139], a[56:59], a[80:83], v[136:139]
buffer_load_dwordx4 v[168:171], v26, s[16:19], s75 offen sc1
v_mfma_f32_16x16x32_bf16 v[140:143], a[44:47], a[84:87], v[140:143]
ds_read_b64_tr_b16 a[40:41], v25 offset:26912
v_mfma_f32_16x16x32_bf16 v[144:147], a[48:51], a[84:87], v[144:147]
ds_read_b64_tr_b16 a[42:43], v25 offset:27424
v_mfma_f32_16x16x32_bf16 v[148:151], a[52:55], a[84:87], v[148:151]
v_mfma_f32_16x16x32_bf16 v[152:155], a[56:59], a[84:87], v[152:155]
s_waitcnt vmcnt(16) lgkmcnt(6)
s_barrier
v_mfma_f32_16x16x32_bf16 v[60:63], a[20:23], a[0:3], v[60:63]
ds_read_b128 a[44:47], v23 offset:27648
s_add_u32 m0, s56, 78976
v_mfma_f32_16x16x32_bf16 v[64:67], a[20:23], a[4:7], v[64:67]
buffer_load_dwordx4 v18, s[20:23], s54 offen lds
v_mfma_f32_16x16x32_bf16 v[68:71], a[20:23], a[8:11], v[68:71]
s_sub_u32 s47, s47, 1
s_cbranch_scc1 .Lx13
.Lx13b:
v_mfma_f32_16x16x32_bf16 v[72:75], a[20:23], a[12:15], v[72:75]
ds_read_b128 a[48:51], v23 offset:28672
v_mfma_f32_16x16x32_bf16 v[244:247], a[20:23], a[16:19], v[244:247]
ds_read_b128 a[52:55], v23 offset:29952
v_mfma_f32_16x16x32_bf16 v[76:79], a[24:27], a[0:3], v[76:79]
buffer_load_dwordx4 v19, s[20:23], s54 offen offset:1024 lds
v_mfma_f32_16x16x32_bf16 v[80:83], a[24:27], a[4:7], v[80:83]
ds_read_b128 a[56:59], v23 offset:30976
v_mfma_f32_16x16x32_bf16 v[84:87], a[24:27], a[8:11], v[84:87]
ds_read_b64_tr_b16 a[64:65], v25 offset:37248
v_mfma_f32_16x16x32_bf16 v[88:91], a[24:27], a[12:15], v[88:91]
ds_read_b64_tr_b16 a[66:67], v25 offset:37760
v_mfma_f32_16x16x32_bf16 v[92:95], a[28:31], a[0:3], v[92:95]
buffer_load_dwordx4 v20, s[20:23], s54 offen offset:2048 lds
v_mfma_f32_16x16x32_bf16 v[96:99], a[28:31], a[4:7], v[96:99]
s_add_u32 s54, s54, 196608
s_waitcnt lgkmcnt(6)
v_mfma_f32_16x16x32_bf16 v[100:103], a[28:31], a[8:11], v[100:103]
ds_read_b64_tr_b16 a[68:69], v25 offset:37280
v_mfma_f32_16x16x32_bf16 v[104:107], a[28:31], a[12:15], v[104:107]
ds_read_b64_tr_b16 a[70:71], v25 offset:37792
s_add_u32 m0, s55, 9216
v_mfma_f32_16x16x32_bf16 v[156:159], a[28:31], a[16:19], v[156:159]
buffer_load_dwordx4 v21, s[16:19], s52 offen sc1 lds
v_mfma_f32_16x16x32_bf16 v[108:111], a[32:35], a[0:3], v[108:111]
ds_read_b128 a[60:63], v24 offset:29696
v_mfma_f32_16x16x32_bf16 v[112:115], a[32:35], a[4:7], v[112:115]
ds_read_b64_tr_b16 a[72:73], v25 offset:38272
v_mfma_f32_16x16x32_bf16 v[116:119], a[32:35], a[8:11], v[116:119]
ds_read_b64_tr_b16 a[74:75], v25 offset:38784
v_mfma_f32_16x16x32_bf16 v[120:123], a[32:35], a[12:15], v[120:123]
buffer_load_dwordx4 v21, s[16:19], s52 offen offset:1024 sc1 lds
v_mfma_f32_16x16x32_bf16 v[160:163], a[32:35], a[16:19], v[160:163]
ds_read_b64_tr_b16 a[76:77], v25 offset:38304
v_mfma_f32_16x16x32_bf16 v[124:127], a[0:3], a[36:39], v[124:127]
ds_read_b64_tr_b16 a[78:79], v25 offset:38816
v_mfma_f32_16x16x32_bf16 v[128:131], a[4:7], a[36:39], v[128:131]
ds_read_b64_tr_b16 a[80:81], v25 offset:39296
v_mfma_f32_16x16x32_bf16 v[132:135], a[8:11], a[36:39], v[132:135]
buffer_load_dword v22, s[16:19], s52 offen offset:2048 sc1 lds
v_mfma_f32_16x16x32_bf16 v[136:139], a[12:15], a[36:39], v[136:139]
ds_read_b64_tr_b16 a[82:83], v25 offset:39808
s_add_u32 s52, s52, 0x20000
v_mfma_f32_16x16x32_bf16 v[140:143], a[0:3], a[40:43], v[140:143]
ds_read_b64_tr_b16 a[84:85], v25 offset:39328
v_mfma_f32_16x16x32_bf16 v[144:147], a[4:7], a[40:43], v[144:147]
ds_read_b64_tr_b16 a[86:87], v25 offset:39840
v_mfma_f32_16x16x32_bf16 v[148:151], a[8:11], a[40:43], v[148:151]
v_mfma_f32_16x16x32_bf16 v[152:155], a[12:15], a[40:43], v[152:155]
s_waitcnt vmcnt(19) lgkmcnt(6)
s_barrier
v_mfma_f32_16x16x32_bf16 v[60:63], a[64:67], a[44:47], v[60:63]
ds_read_b128 a[0:3], v23 offset:36864
s_add_u32 m0, s56, 91392
v_mfma_f32_16x16x32_bf16 v[64:67], a[64:67], a[48:51], v[64:67]
buffer_load_dwordx4 v18, s[20:23], s54 offen lds
v_mfma_f32_16x16x32_bf16 v[68:71], a[64:67], a[52:55], v[68:71]
ds_read_b128 a[4:7], v23 offset:37888
v_add_f32 v164, v164, v172
v_mfma_f32_16x16x32_bf16 v[72:75], a[64:67], a[56:59], v[72:75]
ds_read_b128 a[8:11], v23 offset:39168
v_mfma_f32_16x16x32_bf16 v[244:247], a[64:67], a[60:63], v[244:247]
ds_read_b128 a[12:15], v23 offset:40192
v_mfma_f32_16x16x32_bf16 v[76:79], a[68:71], a[44:47], v[76:79]
buffer_load_dwordx4 v19, s[20:23], s54 offen offset:1024 lds
v_mfma_f32_16x16x32_bf16 v[80:83], a[68:71], a[48:51], v[80:83]
ds_read_b64_tr_b16 a[20:21], v25 offset:49664
v_mfma_f32_16x16x32_bf16 v[84:87], a[68:71], a[52:55], v[84:87]
ds_read_b64_tr_b16 a[22:23], v25 offset:50176
v_add_f32 v165, v165, v173
v_mfma_f32_16x16x32_bf16 v[88:91], a[68:71], a[56:59], v[88:91]
ds_read_b64_tr_b16 a[24:25], v25 offset:49696
v_mfma_f32_16x16x32_bf16 v[92:95], a[72:75], a[44:47], v[92:95]
buffer_load_dwordx4 v20, s[20:23], s54 offen offset:2048 lds
v_mfma_f32_16x16x32_bf16 v[96:99], a[72:75], a[48:51], v[96:99]
s_add_u32 s54, s54, 196608
s_waitcnt lgkmcnt(7)
v_mfma_f32_16x16x32_bf16 v[100:103], a[72:75], a[52:55], v[100:103]
ds_read_b64_tr_b16 a[26:27], v25 offset:50208
v_mfma_f32_16x16x32_bf16 v[104:107], a[72:75], a[56:59], v[104:107]
ds_read_b128 a[16:19], v24 offset:38912
s_add_u32 m0, s55, 18432
v_mfma_f32_16x16x32_bf16 v[156:159], a[72:75], a[60:63], v[156:159]
buffer_load_dwordx4 v21, s[16:19], s52 offen sc1 lds
v_mfma_f32_16x16x32_bf16 v[108:111], a[76:79], a[44:47], v[108:111]
v_add_f32 v166, v166, v174
v_mfma_f32_16x16x32_bf16 v[112:115], a[76:79], a[48:51], v[112:115]
ds_read_b64_tr_b16 a[28:29], v25 offset:50688
v_mfma_f32_16x16x32_bf16 v[116:119], a[76:79], a[52:55], v[116:119]
ds_read_b64_tr_b16 a[30:31], v25 offset:51200
v_mfma_f32_16x16x32_bf16 v[120:123], a[76:79], a[56:59], v[120:123]
buffer_load_dwordx4 v21, s[16:19], s52 offen offset:1024 sc1 lds
v_mfma_f32_16x16x32_bf16 v[160:163], a[76:79], a[60:63], v[160:163]
ds_read_b64_tr_b16 a[32:33], v25 offset:50720
v_mfma_f32_16x16x32_bf16 v[124:127], a[44:47], a[80:83], v[124:127]
ds_read_b64_tr_b16 a[34:35], v25 offset:51232
v_mfma_f32_16x16x32_bf16 v[128:131], a[48:51], a[80:83], v[128:131]
ds_read_b64_tr_b16 a[36:37], v25 offset:51712
v_add_f32 v167, v167, v175
v_mfma_f32_16x16x32_bf16 v[132:135], a[52:55], a[80:83], v[132:135]
buffer_load_dword v22, s[16:19], s52 offen offset:2048 sc1 lds
v_mfma_f32_16x16x32_bf16 v[136:139], a[56:59], a[80:83], v[136:139]
ds_read_b64_tr_b16 a[38:39], v25 offset:52224
s_add_u32 s52, s52, 0x20000
v_mfma_f32_16x16x32_bf16 v[140:143], a[44:47], a[84:87], v[140:143]
ds_read_b64_tr_b16 a[40:41], v25 offset:51744
v_mfma_f32_16x16x32_bf16 v[144:147], a[48:51], a[84:87], v[144:147]
ds_read_b64_tr_b16 a[42:43], v25 offset:52256
v_mfma_f32_16x16x32_bf16 v[148:151], a[52:55], a[84:87], v[148:151]
v_mfma_f32_16x16x32_bf16 v[152:155], a[56:59], a[84:87], v[152:155]
s_waitcnt vmcnt(19) lgkmcnt(6)
s_barrier
v_mfma_f32_16x16x32_bf16 v[60:63], a[20:23], a[0:3], v[60:63]
ds_read_b128 a[44:47], v23 offset:46080
s_add_u32 m0, s56, 103808
v_mfma_f32_16x16x32_bf16 v[64:67], a[20:23], a[4:7], v[64:67]
buffer_load_dwordx4 v18, s[20:23], s54 offen lds
v_mfma_f32_16x16x32_bf16 v[68:71], a[20:23], a[8:11], v[68:71]
s_sub_u32 s47, s47, 1
s_cbranch_scc1 .Lx14
.Lx14b:
v_mfma_f32_16x16x32_bf16 v[72:75], a[20:23], a[12:15], v[72:75]
ds_read_b128 a[48:51], v23 offset:47104
v_mfma_f32_16x16x32_bf16 v[244:247], a[20:23], a[16:19], v[244:247]
buffer_load_dwordx4 v19, s[20:23], s54 offen offset:1024 lds
v_mfma_f32_16x16x32_bf16 v[76:79], a[24:27], a[0:3], v[76:79]
ds_read_b128 a[52:55], v23 offset:48384
v_mfma_f32_16x16x32_bf16 v[80:83], a[24:27], a[4:7], v[80:83]
ds_read_b128 a[56:59], v23 offset:49408
v_mfma_f32_16x16x32_bf16 v[84:87], a[24:27], a[8:11], v[84:87]
ds_read_b64_tr_b16 a[64:65], v25 offset:62080
v_mfma_f32_16x16x32_bf16 v[88:91], a[24:27], a[12:15], v[88:91]
buffer_load_dwordx4 v20, s[20:23], s54 offen offset:2048 lds
v_mfma_f32_16x16x32_bf16 v[92:95], a[28:31], a[0:3], v[92:95]
ds_read_b64_tr_b16 a[66:67], v25 offset:62592
s_add_u32 s54, s54, 196608
v_mfma_f32_16x16x32_bf16 v[96:99], a[28:31], a[4:7], v[96:99]
s_add_u32 m0, s55, 27648
s_waitcnt lgkmcnt(6)
v_mfma_f32_16x16x32_bf16 v[100:103], a[28:31], a[8:11], v[100:103]
buffer_load_dwordx4 v21, s[16:19], s52 offen sc1 lds
v_mfma_f32_16x16x32_bf16 v[104:107], a[28:31], a[12:15], v[104:107]
ds_read_b64_tr_b16 a[68:69], v25 offset:62112
v_mfma_f32_16x16x32_bf16 v[156:159], a[28:31], a[16:19], v[156:159]
ds_read_b64_tr_b16 a[70:71], v25 offset:62624
v_mfma_f32_16x16x32_bf16 v[108:111], a[32:35], a[0:3], v[108:111]
ds_read_b128 a[60:63], v24 offset:48128
v_mfma_f32_16x16x32_bf16 v[112:115], a[32:35], a[4:7], v[112:115]
buffer_load_dwordx4 v21, s[16:19], s52 offen offset:1024 sc1 lds
v_mfma_f32_16x16x32_bf16 v[116:119], a[32:35], a[8:11], v[116:119]
ds_read_b64_tr_b16 a[72:73], v25 offset:63104
v_mfma_f32_16x16x32_bf16 v[120:123], a[32:35], a[12:15], v[120:123]
ds_read_b64_tr_b16 a[74:75], v25 offset:63616
v_mfma_f32_16x16x32_bf16 v[160:163], a[32:35], a[16:19], v[160:163]
buffer_load_dword v22, s[16:19], s52 offen offset:2048 sc1 lds
v_mfma_f32_16x16x32_bf16 v[124:127], a[0:3], a[36:39], v[124:127]
ds_read_b64_tr_b16 a[76:77], v25 offset:63136
s_add_u32 s52, s52, 0x20000
v_mfma_f32_16x16x32_bf16 v[128:131], a[4:7], a[36:39], v[128:131]
ds_read_b64_tr_b16 a[78:79], v25 offset:63648
v_mfma_f32_16x16x32_bf16 v[132:135], a[8:11], a[36:39], v[132:135]
ds_read_b64_tr_b16 a[80:81], v25 offset:64128
v_mfma_f32_16x16x32_bf16 v[136:139], a[12:15], a[36:39], v[136:139]
buffer_load_dwordx4 v[172:175], v26, s[16:19], s75 offen offset:1024 sc1
v_mfma_f32_16x16x32_bf16 v[140:143], a[0:3], a[40:43], v[140:143]
ds_read_b64_tr_b16 a[82:83], v25 offset:64640
s_add_u32 s75, s75, 2048
v_mfma_f32_16x16x32_bf16 v[144:147], a[4:7], a[40:43], v[144:147]
ds_read_b64_tr_b16 a[84:85], v25 offset:64160
v_mfma_f32_16x16x32_bf16 v[148:151], a[8:11], a[40:43], v[148:151]
ds_read_b64_tr_b16 a[86:87], v25 offset:64672
v_mfma_f32_16x16x32_bf16 v[152:155], a[12:15], a[40:43], v[152:155]
s_waitcnt vmcnt(20) lgkmcnt(6)
s_barrier
v_mfma_f32_16x16x32_bf16 v[60:63], a[64:67], a[44:47], v[60:63]
ds_read_b128 a[0:3], v23
s_add_u32 m0, s56, 116224
v_mfma_f32_16x16x32_bf16 v[64:67], a[64:67], a[48:51], v[64:67]
buffer_load_dwordx4 v18, s[20:23], s54 offen lds
v_mfma_f32_16x16x32_bf16 v[68:71], a[64:67], a[52:55], v[68:71]
ds_read_b128 a[4:7], v23 offset:1024
v_mfma_f32_16x16x32_bf16 v[72:75], a[64:67], a[56:59], v[72:75]
ds_read_b128 a[8:11], v23 offset:2304
v_mfma_f32_16x16x32_bf16 v[244:247], a[64:67], a[60:63], v[244:247]
ds_read_b128 a[12:15], v23 offset:3328
v_mfma_f32_16x16x32_bf16 v[76:79], a[68:71], a[44:47], v[76:79]
buffer_load_dwordx4 v19, s[20:23], s54 offen offset:1024 lds
v_mfma_f32_16x16x32_bf16 v[80:83], a[68:71], a[48:51], v[80:83]
ds_read_b64_tr_b16 a[20:21], v25
v_mfma_f32_16x16x32_bf16 v[84:87], a[68:71], a[52:55], v[84:87]
ds_read_b64_tr_b16 a[22:23], v25 offset:512
v_mfma_f32_16x16x32_bf16 v[88:91], a[68:71], a[56:59], v[88:91]
ds_read_b64_tr_b16 a[24:25], v25 offset:32
v_mfma_f32_16x16x32_bf16 v[92:95], a[72:75], a[44:47], v[92:95]
buffer_load_dwordx4 v20, s[20:23], s54 offen offset:2048 lds
v_mfma_f32_16x16x32_bf16 v[96:99], a[72:75], a[48:51], v[96:99]
s_add_u32 s54, s54, 196608
s_waitcnt lgkmcnt(7)
v_mfma_f32_16x16x32_bf16 v[100:103], a[72:75], a[52:55], v[100:103]
ds_read_b64_tr_b16 a[26:27], v25 offset:544
v_mfma_f32_16x16x32_bf16 v[104:107], a[72:75], a[56:59], v[104:107]
ds_read_b128 a[16:19], v24 offset:2048
s_add_u32 m0, s55, 36864
v_mfma_f32_16x16x32_bf16 v[156:159], a[72:75], a[60:63], v[156:159]
buffer_load_dwordx4 v21, s[16:19], s52 offen sc1 lds
v_mfma_f32_16x16x32_bf16 v[108:111], a[76:79], a[44:47], v[108:111]
v_mfma_f32_16x16x32_bf16 v[112:115], a[76:79], a[48:51], v[112:115]
ds_read_b64_tr_b16 a[28:29], v25 offset:1024
v_mfma_f32_16x16x32_bf16 v[116:119], a[76:79], a[52:55], v[116:119]
ds_read_b64_tr_b16 a[30:31], v25 offset:1536
v_mfma_f32_16x16x32_bf16 v[120:123], a[76:79], a[56:59], v[120:123]
buffer_load_dwordx4 v21, s[16:19], s52 offen offset:1024 sc1 lds
v_mfma_f32_16x16x32_bf16 v[160:163], a[76:79], a[60:63], v[160:163]
ds_read_b64_tr_b16 a[32:33], v25 offset:1056
v_mfma_f32_16x16x32_bf16 v[124:127], a[44:47], a[80:83], v[124:127]
ds_read_b64_tr_b16 a[34:35], v25 offset:1568
v_mfma_f32_16x16x32_bf16 v[128:131], a[48:51], a[80:83], v[128:131]
ds_read_b64_tr_b16 a[36:37], v25 offset:2048
v_mfma_f32_16x16x32_bf16 v[132:135], a[52:55], a[80:83], v[132:135]
buffer_load_dword v22, s[16:19], s52 offen offset:2048 sc1 lds
v_mfma_f32_16x16x32_bf16 v[136:139], a[56:59], a[80:83], v[136:139]
ds_read_b64_tr_b16 a[38:39], v25 offset:2560
s_add_u32 s52, s52, 0x20000
v_mfma_f32_16x16x32_bf16 v[140:143], a[44:47], a[84:87], v[140:143]
ds_read_b64_tr_b16 a[40:41], v25 offset:2080
v_mfma_f32_16x16x32_bf16 v[144:147], a[48:51], a[84:87], v[144:147]
ds_read_b64_tr_b16 a[42:43], v25 offset:2592
v_mfma_f32_16x16x32_bf16 v[148:151], a[52:55], a[84:87], v[148:151]
s_add_u32 s15, s15, 1
v_mfma_f32_16x16x32_bf16 v[152:155], a[56:59], a[84:87], v[152:155]
s_cbranch_scc0 .Lk11
s_waitcnt vmcnt(19) lgkmcnt(6)
s_barrier
v_mfma_f32_16x16x32_bf16 v[60:63], a[20:23], a[0:3], v[60:63]
ds_read_b128 a[44:47], v23 offset:9216
s_add_u32 m0, s56, 128640
v_mfma_f32_16x16x32_bf16 v[64:67], a[20:23], a[4:7], v[64:67]
buffer_load_dwordx4 v18, s[20:23], s54 offen lds
v_mfma_f32_16x16x32_bf16 v[68:71], a[20:23], a[8:11], v[68:71]
ds_read_b128 a[48:51], v23 offset:10240
v_add_f32 v164, v164, v168
v_mfma_f32_16x16x32_bf16 v[72:75], a[20:23], a[12:15], v[72:75]
ds_read_b128 a[52:55], v23 offset:11520
v_mfma_f32_16x16x32_bf16 v[244:247], a[20:23], a[16:19], v[244:247]
ds_read_b128 a[56:59], v23 offset:12544
v_mfma_f32_16x16x32_bf16 v[76:79], a[24:27], a[0:3], v[76:79]
buffer_load_dwordx4 v19, s[20:23], s54 offen offset:1024 lds
v_mfma_f32_16x16x32_bf16 v[80:83], a[24:27], a[4:7], v[80:83]
ds_read_b64_tr_b16 a[64:65], v25 offset:12416
v_mfma_f32_16x16x32_bf16 v[84:87], a[24:27], a[8:11], v[84:87]
ds_read_b64_tr_b16 a[66:67], v25 offset:12928
v_add_f32 v165, v165, v169
v_mfma_f32_16x16x32_bf16 v[88:91], a[24:27], a[12:15], v[88:91]
ds_read_b64_tr_b16 a[68:69], v25 offset:12448
v_mfma_f32_16x16x32_bf16 v[92:95], a[28:31], a[0:3], v[92:95]
buffer_load_dwordx4 v20, s[20:23], s54 offen offset:2048 lds
v_mfma_f32_16x16x32_bf16 v[96:99], a[28:31], a[4:7], v[96:99]
s_add_u32 s54, s54, 196608
s_waitcnt lgkmcnt(7)
v_mfma_f32_16x16x32_bf16 v[100:103], a[28:31], a[8:11], v[100:103]
ds_read_b64_tr_b16 a[70:71], v25 offset:12960
v_mfma_f32_16x16x32_bf16 v[104:107], a[28:31], a[12:15], v[104:107]
ds_read_b128 a[60:63], v24 offset:11264
s_add_u32 m0, s55, 46080
v_mfma_f32_16x16x32_bf16 v[156:159], a[28:31], a[16:19], v[156:159]
buffer_load_dwordx4 v21, s[16:19], s52 offen sc1 lds
v_mfma_f32_16x16x32_bf16 v[108:111], a[32:35], a[0:3], v[108:111]
v_add_f32 v166, v166, v170
v_mfma_f32_16x16x32_bf16 v[112:115], a[32:35], a[4:7], v[112:115]
ds_read_b64_tr_b16 a[72:73], v25 offset:13440
v_mfma_f32_16x16x32_bf16 v[116:119], a[32:35], a[8:11], v[116:119]
ds_read_b64_tr_b16 a[74:75], v25 offset:13952
v_mfma_f32_16x16x32_bf16 v[120:123], a[32:35], a[12:15], v[120:123]
buffer_load_dwordx4 v21, s[16:19], s52 offen offset:1024 sc1 lds
v_mfma_f32_16x16x32_bf16 v[160:163], a[32:35], a[16:19], v[160:163]
ds_read_b64_tr_b16 a[76:77], v25 offset:13472
v_mfma_f32_16x16x32_bf16 v[124:127], a[0:3], a[36:39], v[124:127]
ds_read_b64_tr_b16 a[78:79], v25 offset:13984
v_mfma_f32_16x16x32_bf16 v[128:131], a[4:7], a[36:39], v[128:131]
ds_read_b64_tr_b16 a[80:81], v25 offset:14464
v_add_f32 v167, v167, v171
v_mfma_f32_16x16x32_bf16 v[132:135], a[8:11], a[36:39], v[132:135]
buffer_load_dword v22, s[16:19], s52 offen offset:2048 sc1 lds
v_mfma_f32_16x16x32_bf16 v[136:139], a[12:15], a[36:39], v[136:139]
ds_read_b64_tr_b16 a[82:83], v25 offset:14976
s_add_u32 s52, s52, 0x20000
v_mfma_f32_16x16x32_bf16 v[140:143], a[0:3], a[40:43], v[140:143]
ds_read_b64_tr_b16 a[84:85], v25 offset:14496
v_mfma_f32_16x16x32_bf16 v[144:147], a[4:7], a[40:43], v[144:147]
ds_read_b64_tr_b16 a[86:87], v25 offset:15008
v_mfma_f32_16x16x32_bf16 v[148:151], a[8:11], a[40:43], v[148:151]
v_mfma_f32_16x16x32_bf16 v[152:155], a[12:15], a[40:43], v[152:155]
s_waitcnt vmcnt(19) lgkmcnt(6)
s_barrier
v_mfma_f32_16x16x32_bf16 v[60:63], a[64:67], a[44:47], v[60:63]
ds_read_b128 a[0:3], v23 offset:18432
s_add_u32 m0, s56, 66560
v_mfma_f32_16x16x32_bf16 v[64:67], a[64:67], a[48:51], v[64:67]
buffer_load_dwordx4 v18, s[20:23], s54 offen lds
v_mfma_f32_16x16x32_bf16 v[68:71], a[64:67], a[52:55], v[68:71]
ds_read_b128 a[4:7], v23 offset:19456
v_mfma_f32_16x16x32_bf16 v[72:75], a[64:67], a[56:59], v[72:75]
ds_read_b128 a[8:11], v23 offset:20736
v_mfma_f32_16x16x32_bf16 v[244:247], a[64:67], a[60:63], v[244:247]
ds_read_b128 a[12:15], v23 offset:21760
v_mfma_f32_16x16x32_bf16 v[76:79], a[68:71], a[44:47], v[76:79]
buffer_load_dwordx4 v19, s[20:23], s54 offen offset:1024 lds
v_mfma_f32_16x16x32_bf16 v[80:83], a[68:71], a[48:51], v[80:83]
ds_read_b64_tr_b16 a[20:21], v25 offset:24832
v_mfma_f32_16x16x32_bf16 v[84:87], a[68:71], a[52:55], v[84:87]
ds_read_b64_tr_b16 a[22:23], v25 offset:25344
v_mfma_f32_16x16x32_bf16 v[88:91], a[68:71], a[56:59], v[88:91]
ds_read_b64_tr_b16 a[24:25], v25 offset:24864
v_mfma_f32_16x16x32_bf16 v[92:95], a[72:75], a[44:47], v[92:95]
buffer_load_dwordx4 v20, s[20:23], s54 offen offset:2048 lds
v_mfma_f32_16x16x32_bf16 v[96:99], a[72:75], a[48:51], v[96:99]
s_add_u32 s54, s54, 196608
s_waitcnt lgkmcnt(7)
v_mfma_f32_16x16x32_bf16 v[100:103], a[72:75], a[52:55], v[100:103]
ds_read_b64_tr_b16 a[26:27], v25 offset:25376
v_mfma_f32_16x16x32_bf16 v[104:107], a[72:75], a[56:59], v[104:107]
ds_read_b128 a[16:19], v24 offset:20480
s_add_u32 m0, s55, 0
v_mfma_f32_16x16x32_bf16 v[156:159], a[72:75], a[60:63], v[156:159]
buffer_load_dwordx4 v21, s[16:19], s52 offen sc1 lds
v_mfma_f32_16x16x32_bf16 v[108:111], a[76:79], a[44:47], v[108:111]
v_mfma_f32_16x16x32_bf16 v[112:115], a[76:79], a[48:51], v[112:115]
ds_read_b64_tr_b16 a[28:29], v25 offset:25856
v_mfma_f32_16x16x32_bf16 v[116:119], a[76:79], a[52:55], v[116:119]
ds_read_b64_tr_b16 a[30:31], v25 offset:26368
v_mfma_f32_16x16x32_bf16 v[120:123], a[76:79], a[56:59], v[120:123]
buffer_load_dwordx4 v21, s[16:19], s52 offen offset:1024 sc1 lds
v_mfma_f32_16x16x32_bf16 v[160:163], a[76:79], a[60:63], v[160:163]
ds_read_b64_tr_b16 a[32:33], v25 offset:25888
v_mfma_f32_16x16x32_bf16 v[124:127], a[44:47], a[80:83], v[124:127]
ds_read_b64_tr_b16 a[34:35], v25 offset:26400
v_mfma_f32_16x16x32_bf16 v[128:131], a[48:51], a[80:83], v[128:131]
ds_read_b64_tr_b16 a[36:37], v25 offset:26880
v_mfma_f32_16x16x32_bf16 v[132:135], a[52:55], a[80:83], v[132:135]
buffer_load_dword v22, s[16:19], s52 offen offset:2048 sc1 lds
v_mfma_f32_16x16x32_bf16 v[136:139], a[56:59], a[80:83], v[136:139]
ds_read_b64_tr_b16 a[38:39], v25 offset:27392
s_add_u32 s52, s52, 0x20000
v_mfma_f32_16x16x32_bf16 v[140:143], a[44:47], a[84:87], v[140:143]
ds_read_b64_tr_b16 a[40:41], v25 offset:26912
v_mfma_f32_16x16x32_bf16 v[144:147], a[48:51], a[84:87], v[144:147]
ds_read_b64_tr_b16 a[42:43], v25 offset:27424
v_mfma_f32_16x16x32_bf16 v[148:151], a[52:55], a[84:87], v[148:151]
v_mfma_f32_16x16x32_bf16 v[152:155], a[56:59], a[84:87], v[152:155]
s_waitcnt vmcnt(19) lgkmcnt(6)
s_barrier
v_mfma_f32_16x16x32_bf16 v[60:63], a[20:23], a[0:3], v[60:63]
ds_read_b128 a[44:47], v23 offset:27648
s_add_u32 m0, s56, 78976
v_mfma_f32_16x16x32_bf16 v[64:67], a[20:23], a[4:7], v[64:67]
buffer_load_dwordx4 v18, s[20:23], s54 offen lds
v_mfma_f32_16x16x32_bf16 v[68:71], a[20:23], a[8:11], v[68:71]
ds_read_b128 a[48:51], v23 offset:28672
s_waitcnt vmcnt(19)
v_add_f32 v164, v164, v172
v_mfma_f32_16x16x32_bf16 v[72:75], a[20:23], a[12:15], v[72:75]
ds_read_b128 a[52:55], v23 offset:29952
v_mfma_f32_16x16x32_bf16 v[244:247], a[20:23], a[16:19], v[244:247]
ds_read_b128 a[56:59], v23 offset:30976
v_mfma_f32_16x16x32_bf16 v[76:79], a[24:27], a[0:3], v[76:79]
buffer_load_dwordx4 v19, s[20:23], s54 offen offset:1024 lds
v_mfma_f32_16x16x32_bf16 v[80:83], a[24:27], a[4:7], v[80:83]
ds_read_b64_tr_b16 a[64:65], v25 offset:37248
v_mfma_f32_16x16x32_bf16 v[84:87], a[24:27], a[8:11], v[84:87]
ds_read_b64_tr_b16 a[66:67], v25 offset:37760
v_add_f32 v165, v165, v173
v_mfma_f32_16x16x32_bf16 v[88:91], a[24:27], a[12:15], v[88:91]
ds_read_b64_tr_b16 a[68:69], v25 offset:37280
v_mfma_f32_16x16x32_bf16 v[92:95], a[28:31], a[0:3], v[92:95]
buffer_load_dwordx4 v20, s[20:23], s54 offen offset:2048 lds
v_mfma_f32_16x16x32_bf16 v[96:99], a[28:31], a[4:7], v[96:99]
s_add_u32 s54, s54, 196608
s_waitcnt lgkmcnt(7)
v_mfma_f32_16x16x32_bf16 v[100:103], a[28:31], a[8:11], v[100:103]
ds_read_b64_tr_b16 a[70:71], v25 offset:37792
v_mfma_f32_16x16x32_bf16 v[104:107], a[28:31], a[12:15], v[104:107]
ds_read_b128 a[60:63], v24 offset:29696
s_add_u32 m0, s55, 9216
v_mfma_f32_16x16x32_bf16 v[156:159], a[28:31], a[16:19], v[156:159]
buffer_load_dwordx4 v21, s[16:19], s52 offen sc1 lds
v_mfma_f32_16x16x32_bf16 v[108:111], a[32:35], a[0:3], v[108:111]
v_add_f32 v166, v166, v174
v_mfma_f32_16x16x32_bf16 v[112:115], a[32:35], a[4:7], v[112:115]
ds_read_b64_tr_b16 a[72:73], v25 offset:38272
v_mfma_f32_16x16x32_bf16 v[116:119], a[32:35], a[8:11], v[116:119]
ds_read_b64_tr_b16 a[74:75], v25 offset:38784
v_mfma_f32_16x16x32_bf16 v[120:123], a[32:35], a[12:15], v[120:123]
buffer_load_dwordx4 v21, s[16:19], s52 offen offset:1024 sc1 lds
v_mfma_f32_16x16x32_bf16 v[160:163], a[32:35], a[16:19], v[160:163]
ds_read_b64_tr_b16 a[76:77], v25 offset:38304
v_mfma_f32_16x16x32_bf16 v[124:127], a[0:3], a[36:39], v[124:127]
ds_read_b64_tr_b16 a[78:79], v25 offset:38816
v_mfma_f32_16x16x32_bf16 v[128:131], a[4:7], a[36:39], v[128:131]
ds_read_b64_tr_b16 a[80:81], v25 offset:39296
v_add_f32 v167, v167, v175
v_mfma_f32_16x16x32_bf16 v[132:135], a[8:11], a[36:39], v[132:135]
buffer_load_dword v22, s[16:19], s52 offen offset:2048 sc1 lds
v_mfma_f32_16x16x32_bf16 v[136:139], a[12:15], a[36:39], v[136:139]
ds_read_b64_tr_b16 a[82:83], v25 offset:39808
s_add_u32 s52, s52, 0x20000
v_mfma_f32_16x16x32_bf16 v[140:143], a[0:3], a[40:43], v[140:143]
ds_read_b64_tr_b16 a[84:85], v25 offset:39328
v_mfma_f32_16x16x32_bf16 v[144:147], a[4:7], a[40:43], v[144:147]
ds_read_b64_tr_b16 a[86:87], v25 offset:39840
v_mfma_f32_16x16x32_bf16 v[148:151], a[8:11], a[40:43], v[148:151]
v_mfma_f32_16x16x32_bf16 v[152:155], a[12:15], a[40:43], v[152:155]
s_waitcnt vmcnt(18) lgkmcnt(6)
s_barrier
v_mfma_f32_16x16x32_bf16 v[60:63], a[64:67], a[44:47], v[60:63]
s_add_u32 m0, s59, 58240
s_mov_b32 s58, 1966080
v_permlane32_swap_b32 v164, v166
v_mfma_f32_16x16x32_bf16 v[64:67], a[64:67], a[48:51], v[64:67]
buffer_load_dwordx4 v5, s[24:27], s58 offen lds
v_mfma_f32_16x16x32_bf16 v[68:71], a[64:67], a[52:55], v[68:71]
ds_read_b128 a[0:3], v23 offset:36864
v_mfma_f32_16x16x32_bf16 v[72:75], a[64:67], a[56:59], v[72:75]
ds_read_b128 a[4:7], v23 offset:37888
v_mfma_f32_16x16x32_bf16 v[244:247], a[64:67], a[60:63], v[244:247]
ds_read_b128 a[8:11], v23 offset:39168
v_permlane32_swap_b32 v165, v167
v_mfma_f32_16x16x32_bf16 v[76:79], a[68:71], a[44:47], v[76:79]
ds_read_b128 a[12:15], v23 offset:40192
v_mfma_f32_16x16x32_bf16 v[80:83], a[68:71], a[48:51], v[80:83]
ds_read_b64_tr_b16 a[20:21], v25 offset:49664
v_mfma_f32_16x16x32_bf16 v[84:87], a[68:71], a[52:55], v[84:87]
buffer_load_dwordx4 v6, s[24:27], s58 offen offset:1024 lds
v_mfma_f32_16x16x32_bf16 v[88:91], a[68:71], a[56:59], v[88:91]
ds_read_b64_tr_b16 a[22:23], v25 offset:50176
v_add_f32 v164, v164, v166
v_mfma_f32_16x16x32_bf16 v[92:95], a[72:75], a[44:47], v[92:95]
v_mfma_f32_16x16x32_bf16 v[96:99], a[72:75], a[48:51], v[96:99]
ds_read_b64_tr_b16 a[24:25], v25 offset:49696
s_waitcnt lgkmcnt(7)
v_mfma_f32_16x16x32_bf16 v[100:103], a[72:75], a[52:55], v[100:103]
ds_read_b64_tr_b16 a[26:27], v25 offset:50208
v_add_f32 v165, v165, v167
v_mfma_f32_16x16x32_bf16 v[104:107], a[72:75], a[56:59], v[104:107]
s_add_u32 m0, s59, 91520
.Lpad2:
s_cbranch_execz .Lpad5
s_mov_b32 s58, 393216
v_mfma_f32_16x16x32_bf16 v[156:159], a[72:75], a[60:63], v[156:159]
buffer_load_dwordx4 v5, s[24:27], s58 offen lds
v_mfma_f32_16x16x32_bf16 v[108:111], a[76:79], a[44:47], v[108:111]
ds_read_b128 a[16:19], v24 offset:38912
v_mfma_f32_16x16x32_bf16 v[112:115], a[76:79], a[48:51], v[112:115]
ds_read_b64_tr_b16 a[28:29], v25 offset:50688
v_mul_f32 v164, 0xba800000, v164
v_mfma_f32_16x16x32_bf16 v[116:119], a[76:79], a[52:55], v[116:119]
ds_read_b64_tr_b16 a[30:31], v25 offset:51200
v_mfma_f32_16x16x32_bf16 v[120:123], a[76:79], a[56:59], v[120:123]
ds_read_b64_tr_b16 a[32:33], v25 offset:50720
v_mfma_f32_16x16x32_bf16 v[160:163], a[76:79], a[60:63], v[160:163]
v_mul_f32 v165, 0x3a800000, v165
v_mfma_f32_16x16x32_bf16 v[124:127], a[44:47], a[80:83], v[124:127]
buffer_load_dwordx4 v6, s[24:27], s58 offen offset:1024 lds
v_mfma_f32_16x16x32_bf16 v[128:131], a[48:51], a[80:83], v[128:131]
ds_read_b64_tr_b16 a[34:35], v25 offset:51232
v_mfma_f32_16x16x32_bf16 v[132:135], a[52:55], a[80:83], v[132:135]
ds_read_b64_tr_b16 a[36:37], v25 offset:51712
v_fma_f32 v165, -v164, v164, v165
v_mfma_f32_16x16x32_bf16 v[136:139], a[56:59], a[80:83], v[136:139]
ds_read_b64_tr_b16 a[38:39], v25 offset:52224
v_mfma_f32_16x16x32_bf16 v[140:143], a[44:47], a[84:87], v[140:143]
ds_read_b64_tr_b16 a[40:41], v25 offset:51744
v_mfma_f32_16x16x32_bf16 v[144:147], a[48:51], a[84:87], v[144:147]
ds_read_b64_tr_b16 a[42:43], v25 offset:52256
v_max_f32 v165, 0, v165
v_mfma_f32_16x16x32_bf16 v[148:151], a[52:55], a[84:87], v[148:151]
v_mfma_f32_16x16x32_bf16 v[152:155], a[56:59], a[84:87], v[152:155]
s_waitcnt vmcnt(16) lgkmcnt(6)
s_barrier
v_mfma_f32_16x16x32_bf16 v[60:63], a[20:23], a[0:3], v[60:63]
s_add_u32 m0, s59, 24960
s_mov_b32 s58, 1441792
v_add_f32 v165, 0x3727c5ac, v165
v_mfma_f32_16x16x32_bf16 v[64:67], a[20:23], a[4:7], v[64:67]
buffer_load_dwordx4 v5, s[24:27], s58 offen lds
v_mfma_f32_16x16x32_bf16 v[68:71], a[20:23], a[8:11], v[68:71]
ds_read_b128 a[44:47], v23 offset:46080
v_mfma_f32_16x16x32_bf16 v[72:75], a[20:23], a[12:15], v[72:75]
ds_read_b128 a[48:51], v23 offset:47104
v_mfma_f32_16x16x32_bf16 v[244:247], a[20:23], a[16:19], v[244:247]
ds_read_b128 a[52:55], v23 offset:48384
v_rsq_f32 v166, v165
v_mfma_f32_16x16x32_bf16 v[76:79], a[24:27], a[0:3], v[76:79]
ds_read_b128 a[56:59], v23 offset:49408
v_mfma_f32_16x16x32_bf16 v[80:83], a[24:27], a[4:7], v[80:83]
ds_read_b64_tr_b16 a[64:65], v25 offset:62080
v_mfma_f32_16x16x32_bf16 v[84:87], a[24:27], a[8:11], v[84:87]
buffer_load_dwordx4 v6, s[24:27], s58 offen offset:1024 lds
v_mfma_f32_16x16x32_bf16 v[88:91], a[24:27], a[12:15], v[88:91]
ds_read_b64_tr_b16 a[66:67], v25 offset:62592
v_mov_b32 v165, v166
v_mfma_f32_16x16x32_bf16 v[92:95], a[28:31], a[0:3], v[92:95]
v_mfma_f32_16x16x32_bf16 v[96:99], a[28:31], a[4:7], v[96:99]
ds_read_b64_tr_b16 a[68:69], v25 offset:62112
s_waitcnt lgkmcnt(7)
v_mfma_f32_16x16x32_bf16 v[100:103], a[28:31], a[8:11], v[100:103]
ds_read_b64_tr_b16 a[70:71], v25 offset:62624
v_mfma_f32_16x16x32_bf16 v[104:107], a[28:31], a[12:15], v[104:107]
s_add_u32 m0, s59, 99840
s_mov_b32 s58, 524288
v_mul_f32 v166, 0x3e8293ee, v166
v_mfma_f32_16x16x32_bf16 v[156:159], a[28:31], a[16:19], v[156:159]
buffer_load_dwordx4 v5, s[24:27], s58 offen lds
v_mfma_f32_16x16x32_bf16 v[108:111], a[32:35], a[0:3], v[108:111]
ds_read_b128 a[60:63], v24 offset:48128
v_mfma_f32_16x16x32_bf16 v[112:115], a[32:35], a[4:7], v[112:115]
ds_read_b64_tr_b16 a[72:73], v25 offset:63104
v_mfma_f32_16x16x32_bf16 v[116:119], a[32:35], a[8:11], v[116:119]
ds_read_b64_tr_b16 a[74:75], v25 offset:63616
ds_write_b128 v7, v[164:167]
v_mfma_f32_16x16x32_bf16 v[120:123], a[32:35], a[12:15], v[120:123]
ds_read_b64_tr_b16 a[76:77], v25 offset:63136
v_mfma_f32_16x16x32_bf16 v[160:163], a[32:35], a[16:19], v[160:163]
v_mfma_f32_16x16x32_bf16 v[124:127], a[0:3], a[36:39], v[124:127]
buffer_load_dwordx4 v6, s[24:27], s58 offen offset:1024 lds
v_mfma_f32_16x16x32_bf16 v[128:131], a[4:7], a[36:39], v[128:131]
ds_read_b64_tr_b16 a[78:79], v25 offset:63648
ds_write_b32 v17, v164
v_mfma_f32_16x16x32_bf16 v[132:135], a[8:11], a[36:39], v[132:135]
ds_read_b64_tr_b16 a[80:81], v25 offset:64128
v_mfma_f32_16x16x32_bf16 v[136:139], a[12:15], a[36:39], v[136:139]
ds_read_b64_tr_b16 a[82:83], v25 offset:64640
v_mfma_f32_16x16x32_bf16 v[140:143], a[0:3], a[40:43], v[140:143]
ds_read_b64_tr_b16 a[84:85], v25 offset:64160
ds_write_b32 v17, v165 offset:1024
v_mfma_f32_16x16x32_bf16 v[144:147], a[4:7], a[40:43], v[144:147]
ds_read_b64_tr_b16 a[86:87], v25 offset:64672
v_mfma_f32_16x16x32_bf16 v[148:151], a[8:11], a[40:43], v[148:151]
v_mfma_f32_16x16x32_bf16 v[152:155], a[12:15], a[40:43], v[152:155]
s_waitcnt vmcnt(14) lgkmcnt(9)
s_barrier
v_mfma_f32_16x16x32_bf16 v[60:63], a[64:67], a[44:47], v[60:63]
s_add_u32 m0, s59, 33280
s_mov_b32 s58, 1572864
v_mfma_f32_16x16x32_bf16 v[64:67], a[64:67], a[48:51], v[64:67]
buffer_load_dwordx4 v5, s[24:27], s58 offen lds
v_mfma_f32_16x16x32_bf16 v[68:71], a[64:67], a[52:55], v[68:71]
ds_read_b128 a[0:3], v23
v_mfma_f32_16x16x32_bf16 v[72:75], a[64:67], a[56:59], v[72:75]
ds_read_b128 a[4:7], v23 offset:1024
v_mfma_f32_16x16x32_bf16 v[244:247], a[64:67], a[60:63], v[244:247]
ds_read_b128 a[8:11], v23 offset:2304
v_mfma_f32_16x16x32_bf16 v[76:79], a[68:71], a[44:47], v[76:79]
buffer_load_dwordx4 v6, s[24:27], s58 offen offset:1024 lds
v_mfma_f32_16x16x32_bf16 v[80:83], a[68:71], a[48:51], v[80:83]
ds_read_b128 a[12:15], v23 offset:3328
v_mfma_f32_16x16x32_bf16 v[84:87], a[68:71], a[52:55], v[84:87]
ds_read_b64_tr_b16 a[20:21], v25
v_mfma_f32_16x16x32_bf16 v[88:91], a[68:71], a[56:59], v[88:91]
s_add_u32 m0, s59, 108160
s_mov_b32 s58, 655360
v_mfma_f32_16x16x32_bf16 v[92:95], a[72:75], a[44:47], v[92:95]
buffer_load_dwordx4 v5, s[24:27], s58 offen lds
v_mfma_f32_16x16x32_bf16 v[96:99], a[72:75], a[48:51], v[96:99]
ds_read_b64_tr_b16 a[22:23], v25 offset:512
s_waitcnt lgkmcnt(6)
v_mfma_f32_16x16x32_bf16 v[100:103], a[72:75], a[52:55], v[100:103]
ds_read_b64_tr_b16 a[24:25], v25 offset:32
v_mfma_f32_16x16x32_bf16 v[104:107], a[72:75], a[56:59], v[104:107]
ds_read_b64_tr_b16 a[26:27], v25 offset:544
v_mfma_f32_16x16x32_bf16 v[156:159], a[72:75], a[60:63], v[156:159]
buffer_load_dwordx4 v6, s[24:27], s58 offen offset:1024 lds
v_mfma_f32_16x16x32_bf16 v[108:111], a[76:79], a[44:47], v[108:111]
ds_read_b128 a[16:19], v24 offset:2048
v_mfma_f32_16x16x32_bf16 v[112:115], a[76:79], a[48:51], v[112:115]
ds_read_b64_tr_b16 a[28:29], v25 offset:1024
v_mfma_f32_16x16x32_bf16 v[116:119], a[76:79], a[52:55], v[116:119]
s_add_u32 m0, s59, 116480
s_mov_b32 s58, 786432
v_mfma_f32_16x16x32_bf16 v[120:123], a[76:79], a[56:59], v[120:123]
buffer_load_dwordx4 v5, s[24:27], s58 offen lds
v_mfma_f32_16x16x32_bf16 v[160:163], a[76:79], a[60:63], v[160:163]
ds_read_b64_tr_b16 a[30:31], v25 offset:1536
v_mfma_f32_16x16x32_bf16 v[124:127], a[44:47], a[80:83], v[124:127]
ds_read_b64_tr_b16 a[32:33], v25 offset:1056
v_mfma_f32_16x16x32_bf16 v[128:131], a[48:51], a[80:83], v[128:131]
ds_read_b64_tr_b16 a[34:35], v25 offset:1568
v_mfma_f32_16x16x32_bf16 v[132:135], a[52:55], a[80:83], v[132:135]
buffer_load_dwordx4 v6, s[24:27], s58 offen offset:1024 lds
v_mfma_f32_16x16x32_bf16 v[136:139], a[56:59], a[80:83], v[136:139]
ds_read_b64_tr_b16 a[36:37], v25 offset:2048
v_mfma_f32_16x16x32_bf16 v[140:143], a[44:47], a[84:87], v[140:143]
ds_read_b64_tr_b16 a[38:39], v25 offset:2560
v_mfma_f32_16x16x32_bf16 v[144:147], a[48:51], a[84:87], v[144:147]
ds_read_b64_tr_b16 a[40:41], v25 offset:2080
v_mfma_f32_16x16x32_bf16 v[148:151], a[52:55], a[84:87], v[148:151]
ds_read_b64_tr_b16 a[42:43], v25 offset:2592
v_mfma_f32_16x16x32_bf16 v[152:155], a[56:59], a[84:87], v[152:155]
s_waitcnt vmcnt(14) lgkmcnt(6)
s_barrier
v_mfma_f32_16x16x32_bf16 v[60:63], a[20:23], a[0:3], v[60:63]
s_add_u32 m0, s59, 41600
s_mov_b32 s58, 1703936
v_mfma_f32_16x16x32_bf16 v[64:67], a[20:23], a[4:7], v[64:67]
buffer_load_dwordx4 v5, s[24:27], s58 offen lds
v_mfma_f32_16x16x32_bf16 v[68:71], a[20:23], a[8:11], v[68:71]
ds_read_b128 a[44:47], v23 offset:9216
v_mfma_f32_16x16x32_bf16 v[72:75], a[20:23], a[12:15], v[72:75]
ds_read_b128 a[48:51], v23 offset:10240
v_mfma_f32_16x16x32_bf16 v[244:247], a[20:23], a[16:19], v[244:247]
ds_read_b128 a[52:55], v23 offset:11520
v_mfma_f32_16x16x32_bf16 v[76:79], a[24:27], a[0:3], v[76:79]
buffer_load_dwordx4 v6, s[24:27], s58 offen offset:1024 lds
v_mfma_f32_16x16x32_bf16 v[80:83], a[24:27], a[4:7], v[80:83]
ds_read_b128 a[56:59], v23 offset:12544
v_mfma_f32_16x16x32_bf16 v[84:87], a[24:27], a[8:11], v[84:87]
ds_read_b64_tr_b16 a[64:65], v25 offset:12416
v_mfma_f32_16x16x32_bf16 v[88:91], a[24:27], a[12:15], v[88:91]
s_add_u32 m0, s59, 49920
s_mov_b32 s58, 1835008
v_mfma_f32_16x16x32_bf16 v[92:95], a[28:31], a[0:3], v[92:95]
buffer_load_dwordx4 v5, s[24:27], s58 offen lds
v_mfma_f32_16x16x32_bf16 v[96:99], a[28:31], a[4:7], v[96:99]
ds_read_b64_tr_b16 a[66:67], v25 offset:12928
s_waitcnt lgkmcnt(6)
v_mfma_f32_16x16x32_bf16 v[100:103], a[28:31], a[8:11], v[100:103]
ds_read_b64_tr_b16 a[68:69], v25 offset:12448
v_mfma_f32_16x16x32_bf16 v[104:107], a[28:31], a[12:15], v[104:107]
ds_read_b64_tr_b16 a[70:71], v25 offset:12960
v_mfma_f32_16x16x32_bf16 v[156:159], a[28:31], a[16:19], v[156:159]
buffer_load_dwordx4 v6, s[24:27], s58 offen offset:1024 lds
v_mfma_f32_16x16x32_bf16 v[108:111], a[32:35], a[0:3], v[108:111]
ds_read_b128 a[60:63], v24 offset:11264
v_mfma_f32_16x16x32_bf16 v[112:115], a[32:35], a[4:7], v[112:115]
ds_read_b64_tr_b16 a[72:73], v25 offset:13440
v_mfma_f32_16x16x32_bf16 v[116:119], a[32:35], a[8:11], v[116:119]
s_add_u32 m0, s59, 124800
s_mov_b32 s58, 917504
v_mfma_f32_16x16x32_bf16 v[120:123], a[32:35], a[12:15], v[120:123]
buffer_load_dwordx4 v5, s[24:27], s58 offen lds
v_mfma_f32_16x16x32_bf16 v[160:163], a[32:35], a[16:19], v[160:163]
ds_read_b64_tr_b16 a[74:75], v25 offset:13952
v_mfma_f32_16x16x32_bf16 v[124:127], a[0:3], a[36:39], v[124:127]
ds_read_b64_tr_b16 a[76:77], v25 offset:13472
v_mfma_f32_16x16x32_bf16 v[128:131], a[4:7], a[36:39], v[128:131]
ds_read_b64_tr_b16 a[78:79], v25 offset:13984
v_mfma_f32_16x16x32_bf16 v[132:135], a[8:11], a[36:39], v[132:135]
buffer_load_dwordx4 v6, s[24:27], s58 offen offset:1024 lds
v_mfma_f32_16x16x32_bf16 v[136:139], a[12:15], a[36:39], v[136:139]
ds_read_b64_tr_b16 a[80:81], v25 offset:14464
v_mfma_f32_16x16x32_bf16 v[140:143], a[0:3], a[40:43], v[140:143]
ds_read_b64_tr_b16 a[82:83], v25 offset:14976
v_mfma_f32_16x16x32_bf16 v[144:147], a[4:7], a[40:43], v[144:147]
ds_read_b64_tr_b16 a[84:85], v25 offset:14496
v_mfma_f32_16x16x32_bf16 v[148:151], a[8:11], a[40:43], v[148:151]
ds_read_b64_tr_b16 a[86:87], v25 offset:15008
v_mfma_f32_16x16x32_bf16 v[152:155], a[12:15], a[40:43], v[152:155]
s_waitcnt lgkmcnt(0)
s_barrier
v_mfma_f32_16x16x32_bf16 v[244:247], a[64:67], a[60:63], v[244:247]
ds_read_b128 v[232:235], v10 offset:768
v_mfma_f32_16x16x32_bf16 v[156:159], a[72:75], a[60:63], v[156:159]
ds_read_b128 v[236:239], v10 offset:2816
v_mfma_f32_16x16x32_bf16 v[160:163], a[76:79], a[60:63], v[160:163]
ds_read_b128 v[228:231], v10 offset:512
v_mfma_f32_16x16x32_bf16 v[104:107], a[72:75], a[56:59], v[104:107]
ds_read_b128 v[224:227], v10 offset:256
v_mfma_f32_16x16x32_bf16 v[120:123], a[76:79], a[56:59], v[120:123]
ds_read_b128 v[220:223], v10
v_mfma_f32_16x16x32_bf16 v[136:139], a[56:59], a[80:83], v[136:139]
v_mfma_f32_16x16x32_bf16 v[152:155], a[56:59], a[84:87], v[152:155]
v_mfma_f32_16x16x32_bf16 v[100:103], a[72:75], a[52:55], v[100:103]
v_mfma_f32_16x16x32_bf16 v[116:119], a[76:79], a[52:55], v[116:119]
s_mov_b32 exec_lo, 0x10001
s_mov_b32 exec_hi, 0x10001
ds_write_b128 v13, v[244:247]
ds_write_b128 v13, v[156:159] offset:256
ds_write_b128 v13, v[160:163] offset:320
s_mov_b64 exec, -1
v_mfma_f32_16x16x32_bf16 v[96:99], a[72:75], a[48:51], v[96:99]
v_mfma_f32_16x16x32_bf16 v[112:115], a[76:79], a[48:51], v[112:115]
v_mfma_f32_16x16x32_bf16 v[92:95], a[72:75], a[44:47], v[92:95]
v_mfma_f32_16x16x32_bf16 v[108:111], a[76:79], a[44:47], v[108:111]
v_mfma_f32_16x16x32_bf16 v[72:75], a[64:67], a[56:59], v[72:75]
v_mfma_f32_16x16x32_bf16 v[88:91], a[68:71], a[56:59], v[88:91]
s_waitcnt lgkmcnt(0)
s_barrier
v_mfma_f32_16x16x32_bf16 v[132:135], a[52:55], a[80:83], v[132:135]
ds_read_b128 v[28:31], v13
s_add_u32 m0, s59, 66560
v_mfma_f32_16x16x32_bf16 v[148:151], a[52:55], a[84:87], v[148:151]
ds_read_b128 v[32:35], v13 offset:64
s_mov_b32 s58, 0
v_mfma_f32_16x16x32_bf16 v[68:71], a[64:67], a[52:55], v[68:71]
ds_read_b128 v[36:39], v13 offset:256
v_mfma_f32_16x16x32_bf16 v[84:87], a[68:71], a[52:55], v[84:87]
ds_read_b128 v[40:43], v13 offset:320
v_mfma_f32_16x16x32_bf16 v[128:131], a[48:51], a[80:83], v[128:131]
ds_read_b32 v44, v12 offset:512
v_mfma_f32_16x16x32_bf16 v[144:147], a[48:51], a[84:87], v[144:147]
ds_read_b32 v45, v12 offset:576
v_mfma_f32_16x16x32_bf16 v[64:67], a[64:67], a[48:51], v[64:67]
ds_read_b128 v[240:243], v11 offset:192
v_mfma_f32_16x16x32_bf16 v[80:83], a[68:71], a[48:51], v[80:83]
ds_read_b128 v[244:247], v11 offset:1216
v_mfma_f32_16x16x32_bf16 v[124:127], a[44:47], a[80:83], v[124:127]
buffer_load_dwordx4 v5, s[24:27], s58 offen lds
ds_read_b128 v[18:21], v11 offset:128
s_waitcnt lgkmcnt(8)
v_pk_fma_f32 v[72:73], v[28:29], v[232:233], v[72:73] op_sel_hi:[1,0,1]
v_pk_fma_f32 v[74:75], v[30:31], v[232:233], v[74:75] op_sel_hi:[1,0,1]
s_waitcnt lgkmcnt(6)
v_pk_fma_f32 v[104:105], v[36:37], v[232:233], v[104:105] op_sel_hi:[1,0,1]
v_pk_mul_f32 v[104:105], v[104:105], v[232:233] op_sel:[0,1] op_sel_hi:[1,1]
v_pk_fma_f32 v[106:107], v[38:39], v[232:233], v[106:107] op_sel_hi:[1,0,1]
v_pk_mul_f32 v[106:107], v[106:107], v[232:233] op_sel:[0,1] op_sel_hi:[1,1]
s_waitcnt lgkmcnt(5)
v_pk_fma_f32 v[120:121], v[40:41], v[232:233], v[120:121] op_sel_hi:[1,0,1]
v_pk_mul_f32 v[120:121], v[120:121], v[232:233] op_sel:[0,1] op_sel_hi:[1,1]
v_pk_fma_f32 v[122:123], v[42:43], v[232:233], v[122:123] op_sel_hi:[1,0,1]
v_pk_mul_f32 v[122:123], v[122:123], v[232:233] op_sel:[0,1] op_sel_hi:[1,1]
v_pk_fma_f32 v[100:101], v[36:37], v[228:229], v[100:101] op_sel_hi:[1,0,1]
v_pk_mul_f32 v[100:101], v[100:101], v[228:229] op_sel:[0,1] op_sel_hi:[1,1]
v_pk_fma_f32 v[102:103], v[38:39], v[228:229], v[102:103] op_sel_hi:[1,0,1]
v_pk_mul_f32 v[102:103], v[102:103], v[228:229] op_sel:[0,1] op_sel_hi:[1,1]
v_pk_fma_f32 v[116:117], v[40:41], v[228:229], v[116:117] op_sel_hi:[1,0,1]
v_pk_mul_f32 v[116:117], v[116:117], v[228:229] op_sel:[0,1] op_sel_hi:[1,1]
v_pk_fma_f32 v[118:119], v[42:43], v[228:229], v[118:119] op_sel_hi:[1,0,1]
v_pk_mul_f32 v[118:119], v[118:119], v[228:229] op_sel:[0,1] op_sel_hi:[1,1]
s_waitcnt lgkmcnt(2)
v_pk_fma_f32 v[136:137], v[240:241], v[44:45], v[136:137] op_sel_hi:[1,0,1]
v_pk_fma_f32 v[138:139], v[242:243], v[44:45], v[138:139] op_sel_hi:[1,0,1]
v_pk_fma_f32 v[152:153], v[240:241], v[44:45], v[152:153] op_sel:[0,1,0] op_sel_hi:[1,1,1]
v_pk_fma_f32 v[154:155], v[242:243], v[44:45], v[154:155] op_sel:[0,1,0] op_sel_hi:[1,1,1]
s_waitcnt lgkmcnt(1)
v_pk_mul_f32 v[136:137], v[136:137], v[244:245]
v_pk_mul_f32 v[138:139], v[138:139], v[246:247]
v_pk_mul_f32 v[152:153], v[152:153], v[244:245]
v_pk_mul_f32 v[154:155], v[154:155], v[246:247]
v_pk_fma_f32 v[88:89], v[32:33], v[232:233], v[88:89] op_sel_hi:[1,0,1]
v_pk_fma_f32 v[90:91], v[34:35], v[232:233], v[90:91] op_sel_hi:[1,0,1]
v_pk_fma_f32 v[96:97], v[36:37], v[224:225], v[96:97] op_sel_hi:[1,0,1]
s_waitcnt lgkmcnt(0)
v_pk_fma_f32 v[132:133], v[18:19], v[44:45], v[132:133] op_sel_hi:[1,0,1]
v_pk_fma_f32 v[134:135], v[20:21], v[44:45], v[134:135] op_sel_hi:[1,0,1]
v_pk_fma_f32 v[148:149], v[18:19], v[44:45], v[148:149] op_sel:[0,1,0] op_sel_hi:[1,1,1]
v_pk_fma_f32 v[150:151], v[20:21], v[44:45], v[150:151] op_sel:[0,1,0] op_sel_hi:[1,1,1]
v_pk_mul_f32 v[96:97], v[96:97], v[224:225] op_sel:[0,1] op_sel_hi:[1,1]
v_pk_fma_f32 v[98:99], v[38:39], v[224:225], v[98:99] op_sel_hi:[1,0,1]
v_pk_mul_f32 v[98:99], v[98:99], v[224:225] op_sel:[0,1] op_sel_hi:[1,1]
v_pk_fma_f32 v[112:113], v[40:41], v[224:225], v[112:113] op_sel_hi:[1,0,1]
v_pk_mul_f32 v[112:113], v[112:113], v[224:225] op_sel:[0,1] op_sel_hi:[1,1]
v_pk_fma_f32 v[114:115], v[42:43], v[224:225], v[114:115] op_sel_hi:[1,0,1]
v_pk_mul_f32 v[114:115], v[114:115], v[224:225] op_sel:[0,1] op_sel_hi:[1,1]
v_pk_fma_f32 v[68:69], v[28:29], v[228:229], v[68:69] op_sel_hi:[1,0,1]
v_pk_fma_f32 v[70:71], v[30:31], v[228:229], v[70:71] op_sel_hi:[1,0,1]
v_pk_fma_f32 v[84:85], v[32:33], v[228:229], v[84:85] op_sel_hi:[1,0,1]
v_pk_fma_f32 v[86:87], v[34:35], v[228:229], v[86:87] op_sel_hi:[1,0,1]
v_pk_fma_f32 v[92:93], v[36:37], v[220:221], v[92:93] op_sel_hi:[1,0,1]
v_pk_mul_f32 v[92:93], v[92:93], v[220:221] op_sel:[0,1] op_sel_hi:[1,1]
v_pk_fma_f32 v[94:95], v[38:39], v[220:221], v[94:95] op_sel_hi:[1,0,1]
v_pk_mul_f32 v[94:95], v[94:95], v[220:221] op_sel:[0,1] op_sel_hi:[1,1]
v_pk_fma_f32 v[108:109], v[40:41], v[220:221], v[108:109] op_sel_hi:[1,0,1]
v_pk_mul_f32 v[108:109], v[108:109], v[220:221] op_sel:[0,1] op_sel_hi:[1,1]
v_pk_fma_f32 v[110:111], v[42:43], v[220:221], v[110:111] op_sel_hi:[1,0,1]
v_pk_mul_f32 v[110:111], v[110:111], v[220:221] op_sel:[0,1] op_sel_hi:[1,1]
v_pk_fma_f32 v[64:65], v[28:29], v[224:225], v[64:65] op_sel_hi:[1,0,1]
v_pk_fma_f32 v[66:67], v[30:31], v[224:225], v[66:67] op_sel_hi:[1,0,1]
v_pk_fma_f32 v[80:81], v[32:33], v[224:225], v[80:81] op_sel_hi:[1,0,1]
v_pk_fma_f32 v[82:83], v[34:35], v[224:225], v[82:83] op_sel_hi:[1,0,1]
v_pk_fma_f32 v[156:157], v[36:37], v[236:237], v[156:157] op_sel_hi:[1,0,1]
v_pk_mul_f32 v[156:157], v[156:157], v[236:237] op_sel:[0,1] op_sel_hi:[1,1]
v_pk_fma_f32 v[158:159], v[38:39], v[236:237], v[158:159] op_sel_hi:[1,0,1]
v_pk_mul_f32 v[158:159], v[158:159], v[236:237] op_sel:[0,1] op_sel_hi:[1,1]
v_pk_fma_f32 v[160:161], v[40:41], v[236:237], v[160:161] op_sel_hi:[1,0,1]
v_pk_mul_f32 v[160:161], v[160:161], v[236:237] op_sel:[0,1] op_sel_hi:[1,1]
v_pk_fma_f32 v[162:163], v[42:43], v[236:237], v[162:163] op_sel_hi:[1,0,1]
v_pk_mul_f32 v[162:163], v[162:163], v[236:237] op_sel:[0,1] op_sel_hi:[1,1]
v_cvt_pk_bf16_f32 v196, v104, v105
v_cvt_pk_bf16_f32 v197, v106, v107
v_mfma_f32_16x16x32_bf16 v[140:143], a[44:47], a[84:87], v[140:143]
buffer_load_dwordx4 v6, s[24:27], s58 offen offset:1024 lds
v_mfma_f32_16x16x32_bf16 v[60:63], a[64:67], a[44:47], v[60:63]
s_add_u32 m0, s59, 0
v_cvt_pk_bf16_f32 v198, v120, v121
v_cvt_pk_bf16_f32 v199, v122, v123
v_mfma_f32_16x16x32_bf16 v[76:79], a[68:71], a[44:47], v[76:79]
ds_write_b128 v8, v[196:199]
v_cvt_pk_bf16_f32 v208, v136, v137
v_cvt_pk_bf16_f32 v209, v138, v139
v_cvt_pk_bf16_f32 v218, v152, v153
v_cvt_pk_bf16_f32 v219, v154, v155
ds_write_b64 v8, v[208:209] offset:1024
ds_write_b64 v8, v[218:219] offset:1032
s_mov_b32 s58, 1048576
buffer_load_dwordx4 v5, s[24:27], s58 offen lds
v_cvt_pk_bf16_f32 v192, v100, v101
v_cvt_pk_bf16_f32 v193, v102, v103
v_cvt_pk_bf16_f32 v194, v116, v117
v_cvt_pk_bf16_f32 v195, v118, v119
v_cvt_pk_bf16_f32 v176, v72, v73
v_cvt_pk_bf16_f32 v177, v74, v75
v_cvt_pk_bf16_f32 v178, v88, v89
v_cvt_pk_bf16_f32 v179, v90, v91
v_pk_fma_f32 v[60:61], v[28:29], v[220:221], v[60:61] op_sel_hi:[1,0,1]
v_pk_fma_f32 v[62:63], v[30:31], v[220:221], v[62:63] op_sel_hi:[1,0,1]
v_pk_fma_f32 v[76:77], v[32:33], v[220:221], v[76:77] op_sel_hi:[1,0,1]
v_pk_fma_f32 v[78:79], v[34:35], v[220:221], v[78:79] op_sel_hi:[1,0,1]
ds_read_b128 v[22:25], v11 offset:1152
s_nop 0
v_mfma_f32_16x16x32_bf16 v[104:107], v[192:195], v[176:179], v[46:49]
buffer_load_dwordx4 v6, s[24:27], s58 offen offset:1024 lds
v_mfma_f32_16x16x32_bf16 v[120:123], v[196:199], v[176:179], v[50:53]
s_add_u32 m0, s59, 8320
s_mov_b32 s58, 1179648
v_cvt_pk_bf16_f32 v188, v96, v97
v_cvt_pk_bf16_f32 v189, v98, v99
s_nop 1
v_max3_f32 v88, v104, v105, v106
v_cvt_pk_bf16_f32 v190, v112, v113
v_cvt_pk_bf16_f32 v191, v114, v115
s_waitcnt lgkmcnt(1)
s_barrier
ds_read_b64 v[200:201], v9 offset:1024
ds_read_b64 v[210:211], v9 offset:1032
buffer_load_dwordx4 v5, s[24:27], s58 offen lds
v_max3_f32 v89, v107, v120, v121
v_max3_f32 v88, v88, v122, v123
v_max_f32 v90, v88, v89
v_max_f32 v89, v88, v89
v_cvt_pk_bf16_f32 v172, v68, v69
v_cvt_pk_bf16_f32 v173, v70, v71
v_permlane16_swap_b32 v90, v89
v_cvt_pk_bf16_f32 v174, v84, v85
v_max_f32 v88, v90, v89
s_waitcnt lgkmcnt(2)
v_pk_mul_f32 v[132:133], v[132:133], v[22:23]
v_cvt_pk_bf16_f32 v206, v132, v133
v_pk_mul_f32 v[134:135], v[134:135], v[24:25]
buffer_load_dwordx4 v6, s[24:27], s58 offen offset:1024 lds
s_add_u32 m0, s59, 16640
s_mov_b32 s58, 1310720
v_cvt_pk_bf16_f32 v207, v134, v135
v_pk_mul_f32 v[148:149], v[148:149], v[22:23]
v_cvt_pk_bf16_f32 v216, v148, v149
v_pk_mul_f32 v[150:151], v[150:151], v[24:25]
v_cvt_pk_bf16_f32 v217, v150, v151
v_max_f32 v89, v90, v89
v_cvt_pk_bf16_f32 v175, v86, v87
ds_read_b128 v[240:243], v11 offset:64
s_nop 0
v_mfma_f32_16x16x32_bf16 v[100:103], v[188:191], v[172:175], v[46:49]
ds_read_b128 v[244:247], v11 offset:1088
v_permlane32_swap_b32 v88, v89
v_mfma_f32_16x16x32_bf16 v[116:119], v[192:195], v[172:175], v[50:53]
buffer_load_dwordx4 v5, s[24:27], s58 offen lds
v_max_f32 v88, v88, v89
v_mul_f32 v88, v88, v234
s_nop 1
v_max3_f32 v84, v100, v101, v102
v_pk_fma_f32 v[104:105], v[104:105], v[234:235], v[88:89] op_sel_hi:[1,0,0] neg_lo:[0,0,1] neg_hi:[0,0,1]
v_pk_fma_f32 v[106:107], v[106:107], v[234:235], v[88:89] op_sel_hi:[1,0,0] neg_lo:[0,0,1] neg_hi:[0,0,1]
v_pk_fma_f32 v[120:121], v[120:121], v[234:235], v[88:89] op_sel_hi:[1,0,0] neg_lo:[0,0,1] neg_hi:[0,0,1]
v_pk_fma_f32 v[122:123], v[122:123], v[234:235], v[88:89] op_sel_hi:[1,0,0] neg_lo:[0,0,1] neg_hi:[0,0,1]
v_exp_f32 v104, v104
v_exp_f32 v105, v105
v_exp_f32 v106, v106
v_exp_f32 v107, v107
v_exp_f32 v120, v120
v_exp_f32 v121, v121
v_exp_f32 v122, v122
v_exp_f32 v123, v123
v_cvt_pk_bf16_f32 v72, v104, v105
buffer_load_dwordx4 v6, s[24:27], s58 offen offset:1024 lds
s_add_u32 m0, s59, 74880
s_mov_b32 s58, 131072
v_cvt_pk_bf16_f32 v73, v106, v107
v_cvt_pk_bf16_f32 v74, v120, v121
v_cvt_pk_bf16_f32 v75, v122, v123
s_waitcnt lgkmcnt(1)
v_pk_fma_f32 v[128:129], v[240:241], v[44:45], v[128:129] op_sel_hi:[1,0,1]
s_waitcnt lgkmcnt(0)
v_pk_mul_f32 v[128:129], v[128:129], v[244:245]
v_pk_fma_f32 v[130:131], v[242:243], v[44:45], v[130:131] op_sel_hi:[1,0,1]
v_pk_mul_f32 v[130:131], v[130:131], v[246:247]
v_pk_fma_f32 v[144:145], v[240:241], v[44:45], v[144:145] op_sel:[0,1,0] op_sel_hi:[1,1,1]
v_pk_mul_f32 v[144:145], v[144:145], v[244:245]
v_pk_fma_f32 v[146:147], v[242:243], v[44:45], v[146:147] op_sel:[0,1,0] op_sel_hi:[1,1,1]
v_pk_mul_f32 v[146:147], v[146:147], v[246:247]
v_cvt_pk_bf16_f32 v204, v128, v129
v_cvt_pk_bf16_f32 v205, v130, v131
v_mfma_f32_16x16x32_bf16 v[88:91], v[248:251], v[72:75], 0
buffer_load_dwordx4 v5, s[24:27], s58 offen lds
v_mfma_f32_16x16x32_bf16 v[104:107], v[206:209], v[72:75], 0
ds_read_b128 v[18:21], v11
v_cvt_pk_bf16_f32 v214, v144, v145
v_mfma_f32_16x16x32_bf16 v[120:123], v[216:219], v[72:75], 0
ds_read_b128 v[22:25], v11 offset:1024
s_nop 1
v_rcp_f32 v88, v88
v_cvt_pk_bf16_f32 v215, v146, v147
v_max3_f32 v85, v103, v116, v117
v_pk_mul_f32 v[104:105], v[104:105], v[88:89] op_sel_hi:[1,0]
v_pk_mul_f32 v[106:107], v[106:107], v[88:89] op_sel_hi:[1,0]
buffer_load_dwordx4 v6, s[24:27], s58 offen offset:1024 lds
s_add_u32 m0, s59, 83200
s_mov_b32 s58, 262144
v_pk_mul_f32 v[120:121], v[120:121], v[88:89] op_sel_hi:[1,0]
v_pk_mul_f32 v[122:123], v[122:123], v[88:89] op_sel_hi:[1,0]
v_cvt_pk_bf16_f32 v176, v104, v105
v_cvt_pk_bf16_f32 v177, v106, v107
v_cvt_pk_bf16_f32 v178, v120, v121
v_cvt_pk_bf16_f32 v179, v122, v123
v_max3_f32 v84, v84, v118, v119
v_max_f32 v86, v84, v85
v_max_f32 v85, v84, v85
v_cvt_pk_bf16_f32 v184, v92, v93
v_cvt_pk_bf16_f32 v185, v94, v95
buffer_load_dwordx4 v5, s[24:27], s58 offen lds
v_permlane16_swap_b32 v86, v85
v_cvt_pk_bf16_f32 v186, v108, v109
v_max_f32 v84, v86, v85
v_max_f32 v85, v86, v85
v_cvt_pk_bf16_f32 v187, v110, v111
v_cvt_pk_bf16_f32 v168, v64, v65
v_permlane32_swap_b32 v84, v85
v_cvt_pk_bf16_f32 v169, v66, v67
v_max_f32 v84, v84, v85
v_mul_f32 v84, v84, v230
v_pk_fma_f32 v[100:101], v[100:101], v[230:231], v[84:85] op_sel_hi:[1,0,0] neg_lo:[0,0,1] neg_hi:[0,0,1]
buffer_load_dwordx4 v6, s[24:27], s58 offen offset:1024 lds
v_pk_fma_f32 v[102:103], v[102:103], v[230:231], v[84:85] op_sel_hi:[1,0,0] neg_lo:[0,0,1] neg_hi:[0,0,1]
v_pk_fma_f32 v[116:117], v[116:117], v[230:231], v[84:85] op_sel_hi:[1,0,0] neg_lo:[0,0,1] neg_hi:[0,0,1]
v_pk_fma_f32 v[118:119], v[118:119], v[230:231], v[84:85] op_sel_hi:[1,0,0] neg_lo:[0,0,1] neg_hi:[0,0,1]
v_exp_f32 v100, v100
v_exp_f32 v101, v101
v_exp_f32 v102, v102
v_exp_f32 v103, v103
v_exp_f32 v116, v116
v_exp_f32 v117, v117
v_exp_f32 v118, v118
v_exp_f32 v119, v119
v_cvt_pk_bf16_f32 v68, v100, v101
buffer_store_dwordx4 v[176:179], v4, s[16:19], s74 offen offset:3072 sc1
v_cvt_pk_bf16_f32 v69, v102, v103
v_cvt_pk_bf16_f32 v70, v116, v117
v_cvt_pk_bf16_f32 v71, v118, v119
s_waitcnt lgkmcnt(1)
v_pk_fma_f32 v[124:125], v[18:19], v[44:45], v[124:125] op_sel_hi:[1,0,1]
s_waitcnt lgkmcnt(0)
v_pk_mul_f32 v[124:125], v[124:125], v[22:23]
v_pk_fma_f32 v[126:127], v[20:21], v[44:45], v[126:127] op_sel_hi:[1,0,1]
v_pk_mul_f32 v[126:127], v[126:127], v[24:25]
v_pk_fma_f32 v[140:141], v[18:19], v[44:45], v[140:141] op_sel:[0,1,0] op_sel_hi:[1,1,1]
v_pk_mul_f32 v[140:141], v[140:141], v[22:23]
v_pk_fma_f32 v[142:143], v[20:21], v[44:45], v[142:143] op_sel:[0,1,0] op_sel_hi:[1,1,1]
v_pk_mul_f32 v[142:143], v[142:143], v[24:25]
v_cvt_pk_bf16_f32 v170, v80, v81
v_cvt_pk_bf16_f32 v171, v82, v83
v_mfma_f32_16x16x32_bf16 v[84:87], v[248:251], v[68:71], 0
v_cvt_pk_bf16_f32 v202, v124, v125
v_cvt_pk_bf16_f32 v203, v126, v127
v_mfma_f32_16x16x32_bf16 v[100:103], v[204:207], v[68:71], 0
v_cvt_pk_bf16_f32 v212, v140, v141
v_cvt_pk_bf16_f32 v213, v142, v143
v_mfma_f32_16x16x32_bf16 v[116:119], v[214:217], v[68:71], 0
s_nop 1
v_rcp_f32 v84, v84
v_mfma_f32_16x16x32_bf16 v[96:99], v[184:187], v[168:171], v[46:49]
v_cvt_pk_bf16_f32 v180, v156, v157
v_cvt_pk_bf16_f32 v181, v158, v159
v_mfma_f32_16x16x32_bf16 v[112:115], v[188:191], v[168:171], v[50:53]
v_cvt_pk_bf16_f32 v182, v160, v161
v_cvt_pk_bf16_f32 v183, v162, v163
v_cvt_pk_bf16_f32 v164, v60, v61
s_nop 1
v_max3_f32 v80, v96, v97, v98
v_cvt_pk_bf16_f32 v165, v62, v63
v_pk_mul_f32 v[100:101], v[100:101], v[84:85] op_sel_hi:[1,0]
v_pk_mul_f32 v[102:103], v[102:103], v[84:85] op_sel_hi:[1,0]
v_pk_mul_f32 v[116:117], v[116:117], v[84:85] op_sel_hi:[1,0]
v_pk_mul_f32 v[118:119], v[118:119], v[84:85] op_sel_hi:[1,0]
v_cvt_pk_bf16_f32 v172, v100, v101
v_cvt_pk_bf16_f32 v173, v102, v103
v_cvt_pk_bf16_f32 v174, v116, v117
v_cvt_pk_bf16_f32 v175, v118, v119
buffer_store_dwordx4 v[172:175], v4, s[16:19], s74 offen offset:2048 sc1
v_max3_f32 v81, v99, v112, v113
v_max3_f32 v80, v80, v114, v115
v_max_f32 v82, v80, v81
v_max_f32 v81, v80, v81
v_cvt_pk_bf16_f32 v166, v76, v77
v_cvt_pk_bf16_f32 v167, v78, v79
v_permlane16_swap_b32 v82, v81
s_nop 0
v_mfma_f32_16x16x32_bf16 v[92:95], v[180:183], v[164:167], v[54:57]
v_max_f32 v80, v82, v81
v_max_f32 v81, v82, v81
.Lpad3:
s_cbranch_execz .Lpad6
v_mfma_f32_16x16x32_bf16 v[108:111], v[184:187], v[164:167], v[50:53]
s_nop 0
v_permlane32_swap_b32 v80, v81
v_max_f32 v80, v80, v81
v_mul_f32 v80, v80, v226
v_pk_fma_f32 v[96:97], v[96:97], v[226:227], v[80:81] op_sel_hi:[1,0,0] neg_lo:[0,0,1] neg_hi:[0,0,1]
v_pk_fma_f32 v[98:99], v[98:99], v[226:227], v[80:81] op_sel_hi:[1,0,0] neg_lo:[0,0,1] neg_hi:[0,0,1]
v_pk_fma_f32 v[112:113], v[112:113], v[226:227], v[80:81] op_sel_hi:[1,0,0] neg_lo:[0,0,1] neg_hi:[0,0,1]
v_pk_fma_f32 v[114:115], v[114:115], v[226:227], v[80:81] op_sel_hi:[1,0,0] neg_lo:[0,0,1] neg_hi:[0,0,1]
v_exp_f32 v96, v96
v_exp_f32 v97, v97
v_exp_f32 v98, v98
v_exp_f32 v99, v99
v_exp_f32 v112, v112
v_exp_f32 v113, v113
v_exp_f32 v114, v114
v_exp_f32 v115, v115
v_cvt_pk_bf16_f32 v64, v96, v97
v_cvt_pk_bf16_f32 v65, v98, v99
v_cvt_pk_bf16_f32 v66, v112, v113
v_cvt_pk_bf16_f32 v67, v114, v115
v_max3_f32 v76, v92, v93, v94
v_max3_f32 v77, v95, v108, v109
v_mfma_f32_16x16x32_bf16 v[80:83], v[248:251], v[64:67], 0
v_max3_f32 v76, v76, v110, v111
v_max_f32 v78, v76, v77
v_mfma_f32_16x16x32_bf16 v[96:99], v[202:205], v[64:67], 0
v_max_f32 v77, v76, v77
v_mfma_f32_16x16x32_bf16 v[112:115], v[212:215], v[64:67], 0
s_nop 2
v_rcp_f32 v80, v80
v_permlane16_swap_b32 v78, v77
s_nop 0
v_pk_mul_f32 v[96:97], v[96:97], v[80:81] op_sel_hi:[1,0]
v_pk_mul_f32 v[98:99], v[98:99], v[80:81] op_sel_hi:[1,0]
v_pk_mul_f32 v[112:113], v[112:113], v[80:81] op_sel_hi:[1,0]
v_pk_mul_f32 v[114:115], v[114:115], v[80:81] op_sel_hi:[1,0]
v_cvt_pk_bf16_f32 v168, v96, v97
v_cvt_pk_bf16_f32 v169, v98, v99
v_cvt_pk_bf16_f32 v170, v112, v113
v_cvt_pk_bf16_f32 v171, v114, v115
buffer_store_dwordx4 v[168:171], v4, s[16:19], s74 offen offset:1024 sc1
v_max_f32 v76, v78, v77
v_max_f32 v77, v78, v77
s_nop 1
v_permlane32_swap_b32 v76, v77
v_max_f32 v76, v76, v77
v_mul_f32 v76, v76, v222
v_pk_fma_f32 v[92:93], v[92:93], v[222:223], v[76:77] op_sel_hi:[1,0,0] neg_lo:[0,0,1] neg_hi:[0,0,1]
v_pk_fma_f32 v[94:95], v[94:95], v[222:223], v[76:77] op_sel_hi:[1,0,0] neg_lo:[0,0,1] neg_hi:[0,0,1]
v_pk_fma_f32 v[108:109], v[108:109], v[222:223], v[76:77] op_sel_hi:[1,0,0] neg_lo:[0,0,1] neg_hi:[0,0,1]
v_pk_fma_f32 v[110:111], v[110:111], v[222:223], v[76:77] op_sel_hi:[1,0,0] neg_lo:[0,0,1] neg_hi:[0,0,1]
v_exp_f32 v92, v92
v_exp_f32 v93, v93
v_exp_f32 v94, v94
v_exp_f32 v95, v95
v_exp_f32 v108, v108
v_exp_f32 v109, v109
v_exp_f32 v110, v110
v_exp_f32 v111, v111
v_cvt_pk_bf16_f32 v60, v92, v93
v_cvt_pk_bf16_f32 v61, v94, v95
v_cvt_pk_bf16_f32 v62, v108, v109
v_cvt_pk_bf16_f32 v63, v110, v111
s_nop 1
v_mfma_f32_16x16x32_bf16 v[76:79], v[248:251], v[60:63], 0
v_mfma_f32_16x16x32_bf16 v[92:95], v[200:203], v[60:63], 0
v_mfma_f32_16x16x32_bf16 v[108:111], v[210:213], v[60:63], 0
s_nop 5
v_rcp_f32 v76, v76
s_nop 0
v_pk_mul_f32 v[92:93], v[92:93], v[76:77] op_sel_hi:[1,0]
v_pk_mul_f32 v[94:95], v[94:95], v[76:77] op_sel_hi:[1,0]
v_pk_mul_f32 v[108:109], v[108:109], v[76:77] op_sel_hi:[1,0]
v_pk_mul_f32 v[110:111], v[110:111], v[76:77] op_sel_hi:[1,0]
v_cvt_pk_bf16_f32 v164, v92, v93
v_cvt_pk_bf16_f32 v165, v94, v95
v_cvt_pk_bf16_f32 v166, v108, v109
v_cvt_pk_bf16_f32 v167, v110, v111
buffer_store_dwordx4 v[164:167], v4, s[16:19], s74 offen sc1
s_nop 1
s_branch .Lqkve10
.Lpad4:
s_cbranch_execz .Lpad7
.Lx12:
buffer_load_dword v27, v14, s[40:43], 0 offen
s_mov_b32 s40, s98
s_mov_b32 s41, s99
s_mov_b32 s42, s100
v_mov_b32 v14, v15
s_mov_b32 s47, 5
s_branch .Lx12b
.Lx13:
buffer_load_dword v27, v14, s[40:43], 0 offen
s_mov_b32 s40, s98
s_mov_b32 s41, s99
s_mov_b32 s42, s100
v_mov_b32 v14, v15
s_mov_b32 s47, 5
s_branch .Lx13b
.Lx14:
buffer_load_dword v27, v14, s[40:43], 0 offen
s_mov_b32 s40, s98
s_mov_b32 s41, s99
s_mov_b32 s42, s100
v_mov_b32 v14, v15
s_mov_b32 s47, 5
s_branch .Lx14b
.Lx16:
buffer_load_dword v27, v14, s[40:43], 0 offen
s_mov_b32 s40, s98
s_mov_b32 s41, s99
s_mov_b32 s42, s100
v_mov_b32 v14, v15
s_mov_b32 s47, 5
s_branch .Lx16b
.Lx17:
buffer_load_dword v27, v14, s[40:43], 0 offen
s_mov_b32 s40, s98
s_mov_b32 s41, s99
s_mov_b32 s42, s100
v_mov_b32 v14, v15
s_mov_b32 s47, 5
s_branch .Lx17b
.Lx18:
buffer_load_dword v27, v14, s[40:43], 0 offen
s_mov_b32 s40, s98
s_mov_b32 s41, s99
s_mov_b32 s42, s100
v_mov_b32 v14, v15
s_mov_b32 s47, 5
s_branch .Lx18b
.Lqkv9:
.Lpad5:
s_cbranch_execz .Lpad8
s_add_u32 m0, s55, 0
s_nop 0
buffer_load_dwordx4 v21, s[16:19], s52 offen sc1 lds
buffer_load_dwordx4 v21, s[16:19], s52 offen offset:1024 sc1 lds
buffer_load_dword v22, s[16:19], s52 offen offset:2048 sc1 lds
s_add_u32 s52, s52, 0x20000
s_add_u32 m0, s55, 9216
s_nop 0
buffer_load_dwordx4 v21, s[16:19], s52 offen sc1 lds
buffer_load_dwordx4 v21, s[16:19], s52 offen offset:1024 sc1 lds
buffer_load_dword v22, s[16:19], s52 offen offset:2048 sc1 lds
s_add_u32 s52, s52, 0x20000
s_add_u32 m0, s55, 18432
s_nop 0
buffer_load_dwordx4 v21, s[16:19], s52 offen sc1 lds
buffer_load_dwordx4 v21, s[16:19], s52 offen offset:1024 sc1 lds
buffer_load_dword v22, s[16:19], s52 offen offset:2048 sc1 lds
s_add_u32 s52, s52, 0x20000
s_add_u32 m0, s55, 27648
s_nop 0
buffer_load_dwordx4 v21, s[16:19], s52 offen sc1 lds
buffer_load_dwordx4 v21, s[16:19], s52 offen offset:1024 sc1 lds
buffer_load_dword v22, s[16:19], s52 offen offset:2048 sc1 lds
s_add_u32 s52, s52, 0x20000
s_add_u32 m0, s55, 36864
s_nop 0
buffer_load_dwordx4 v21, s[16:19], s52 offen sc1 lds
buffer_load_dwordx4 v21, s[16:19], s52 offen offset:1024 sc1 lds
buffer_load_dword v22, s[16:19], s52 offen offset:2048 sc1 lds
s_add_u32 s52, s52, 0x20000
s_waitcnt vmcnt(12)
s_barrier
ds_read_b128 a[0:3], v23
ds_read_b128 a[4:7], v23 offset:1024
ds_read_b128 a[8:11], v23 offset:2304
ds_read_b128 a[12:15], v23 offset:3328
ds_read_b64_tr_b16 a[20:21], v25
ds_read_b64_tr_b16 a[22:23], v25 offset:512
ds_read_b64_tr_b16 a[24:25], v25 offset:32
ds_read_b64_tr_b16 a[26:27], v25 offset:544
ds_read_b128 a[16:19], v24 offset:2048
ds_read_b64_tr_b16 a[28:29], v25 offset:1024
ds_read_b64_tr_b16 a[30:31], v25 offset:1536
ds_read_b64_tr_b16 a[32:33], v25 offset:1056
ds_read_b64_tr_b16 a[34:35], v25 offset:1568
ds_read_b64_tr_b16 a[36:37], v25 offset:2048
ds_read_b64_tr_b16 a[38:39], v25 offset:2560
ds_read_b64_tr_b16 a[40:41], v25 offset:2080
ds_read_b64_tr_b16 a[42:43], v25 offset:2592
s_waitcnt lgkmcnt(0)
s_mov_b32 s15, -4
.p2align 6
.Lk15:
s_waitcnt vmcnt(9) lgkmcnt(6)
s_barrier
v_mfma_f32_16x16x32_bf16 v[60:63], a[20:23], a[0:3], v[60:63]
ds_read_b128 a[44:47], v23 offset:9216
s_add_u32 m0, s56, 128640
v_mfma_f32_16x16x32_bf16 v[64:67], a[20:23], a[4:7], v[64:67]
buffer_load_dwordx4 v18, s[20:23], s54 offen lds
v_mfma_f32_16x16x32_bf16 v[68:71], a[20:23], a[8:11], v[68:71]
s_sub_u32 s47, s47, 1
s_cbranch_scc1 .Lx16
.Lx16b:
v_mfma_f32_16x16x32_bf16 v[72:75], a[20:23], a[12:15], v[72:75]
ds_read_b128 a[48:51], v23 offset:10240
v_add_f32 v164, v164, v168
v_mfma_f32_16x16x32_bf16 v[76:79], a[24:27], a[0:3], v[76:79]
ds_read_b128 a[52:55], v23 offset:11520
v_mfma_f32_16x16x32_bf16 v[80:83], a[24:27], a[4:7], v[80:83]
buffer_load_dwordx4 v19, s[20:23], s54 offen offset:1024 lds
v_mfma_f32_16x16x32_bf16 v[84:87], a[24:27], a[8:11], v[84:87]
ds_read_b128 a[56:59], v23 offset:12544
v_mfma_f32_16x16x32_bf16 v[88:91], a[24:27], a[12:15], v[88:91]
ds_read_b64_tr_b16 a[64:65], v25 offset:12416
v_mfma_f32_16x16x32_bf16 v[244:247], a[24:27], a[16:19], v[244:247]
ds_read_b64_tr_b16 a[66:67], v25 offset:12928
v_add_f32 v165, v165, v169
v_mfma_f32_16x16x32_bf16 v[92:95], a[28:31], a[0:3], v[92:95]
buffer_load_dwordx4 v20, s[20:23], s54 offen offset:2048 lds
v_mfma_f32_16x16x32_bf16 v[96:99], a[28:31], a[4:7], v[96:99]
s_add_u32 s54, s54, 196608
s_waitcnt lgkmcnt(6)
v_mfma_f32_16x16x32_bf16 v[100:103], a[28:31], a[8:11], v[100:103]
ds_read_b64_tr_b16 a[68:69], v25 offset:12448
v_mfma_f32_16x16x32_bf16 v[104:107], a[28:31], a[12:15], v[104:107]
ds_read_b64_tr_b16 a[70:71], v25 offset:12960
s_add_u32 m0, s55, 46080
v_mfma_f32_16x16x32_bf16 v[108:111], a[32:35], a[0:3], v[108:111]
buffer_load_dwordx4 v21, s[16:19], s52 offen sc1 lds
v_mfma_f32_16x16x32_bf16 v[112:115], a[32:35], a[4:7], v[112:115]
ds_read_b128 a[60:63], v24 offset:11264
v_mfma_f32_16x16x32_bf16 v[116:119], a[32:35], a[8:11], v[116:119]
ds_read_b64_tr_b16 a[72:73], v25 offset:13440
v_add_f32 v166, v166, v170
v_mfma_f32_16x16x32_bf16 v[120:123], a[32:35], a[12:15], v[120:123]
ds_read_b64_tr_b16 a[74:75], v25 offset:13952
v_mfma_f32_16x16x32_bf16 v[124:127], a[0:3], a[36:39], v[124:127]
buffer_load_dwordx4 v21, s[16:19], s52 offen offset:1024 sc1 lds
v_mfma_f32_16x16x32_bf16 v[128:131], a[4:7], a[36:39], v[128:131]
ds_read_b64_tr_b16 a[76:77], v25 offset:13472
v_mfma_f32_16x16x32_bf16 v[132:135], a[8:11], a[36:39], v[132:135]
ds_read_b64_tr_b16 a[78:79], v25 offset:13984
v_mfma_f32_16x16x32_bf16 v[136:139], a[12:15], a[36:39], v[136:139]
ds_read_b64_tr_b16 a[80:81], v25 offset:14464
v_add_f32 v167, v167, v171
v_mfma_f32_16x16x32_bf16 v[156:159], a[16:19], a[36:39], v[156:159]
buffer_load_dword v22, s[16:19], s52 offen offset:2048 sc1 lds
v_mfma_f32_16x16x32_bf16 v[140:143], a[0:3], a[40:43], v[140:143]
ds_read_b64_tr_b16 a[82:83], v25 offset:14976
s_add_u32 s52, s52, 0x20000
v_mfma_f32_16x16x32_bf16 v[144:147], a[4:7], a[40:43], v[144:147]
ds_read_b64_tr_b16 a[84:85], v25 offset:14496
v_mfma_f32_16x16x32_bf16 v[148:151], a[8:11], a[40:43], v[148:151]
ds_read_b64_tr_b16 a[86:87], v25 offset:15008
v_mfma_f32_16x16x32_bf16 v[152:155], a[12:15], a[40:43], v[152:155]
v_mfma_f32_16x16x32_bf16 v[160:163], a[16:19], a[40:43], v[160:163]
s_waitcnt vmcnt(12) lgkmcnt(6)
s_barrier
v_mfma_f32_16x16x32_bf16 v[60:63], a[64:67], a[44:47], v[60:63]
ds_read_b128 a[0:3], v23 offset:18432
s_add_u32 m0, s56, 66560
v_mfma_f32_16x16x32_bf16 v[64:67], a[64:67], a[48:51], v[64:67]
buffer_load_dwordx4 v18, s[20:23], s54 offen lds
v_mfma_f32_16x16x32_bf16 v[68:71], a[64:67], a[52:55], v[68:71]
ds_read_b128 a[4:7], v23 offset:19456
v_mfma_f32_16x16x32_bf16 v[72:75], a[64:67], a[56:59], v[72:75]
ds_read_b128 a[8:11], v23 offset:20736
v_mfma_f32_16x16x32_bf16 v[76:79], a[68:71], a[44:47], v[76:79]
buffer_load_dwordx4 v19, s[20:23], s54 offen offset:1024 lds
v_mfma_f32_16x16x32_bf16 v[80:83], a[68:71], a[48:51], v[80:83]
ds_read_b128 a[12:15], v23 offset:21760
v_mfma_f32_16x16x32_bf16 v[84:87], a[68:71], a[52:55], v[84:87]
ds_read_b64_tr_b16 a[20:21], v25 offset:24832
v_mfma_f32_16x16x32_bf16 v[88:91], a[68:71], a[56:59], v[88:91]
ds_read_b64_tr_b16 a[22:23], v25 offset:25344
v_mfma_f32_16x16x32_bf16 v[244:247], a[68:71], a[60:63], v[244:247]
buffer_load_dwordx4 v20, s[20:23], s54 offen offset:2048 lds
v_mfma_f32_16x16x32_bf16 v[92:95], a[72:75], a[44:47], v[92:95]
ds_read_b64_tr_b16 a[24:25], v25 offset:24864
s_add_u32 s54, s54, 196608
v_mfma_f32_16x16x32_bf16 v[96:99], a[72:75], a[48:51], v[96:99]
s_add_u32 m0, s55, 0
s_waitcnt lgkmcnt(7)
v_mfma_f32_16x16x32_bf16 v[100:103], a[72:75], a[52:55], v[100:103]
buffer_load_dwordx4 v21, s[16:19], s52 offen sc1 lds
v_mfma_f32_16x16x32_bf16 v[104:107], a[72:75], a[56:59], v[104:107]
ds_read_b64_tr_b16 a[26:27], v25 offset:25376
v_mfma_f32_16x16x32_bf16 v[108:111], a[76:79], a[44:47], v[108:111]
ds_read_b128 a[16:19], v24 offset:20480
v_mfma_f32_16x16x32_bf16 v[112:115], a[76:79], a[48:51], v[112:115]
ds_read_b64_tr_b16 a[28:29], v25 offset:25856
v_mfma_f32_16x16x32_bf16 v[116:119], a[76:79], a[52:55], v[116:119]
buffer_load_dwordx4 v21, s[16:19], s52 offen offset:1024 sc1 lds
v_mfma_f32_16x16x32_bf16 v[120:123], a[76:79], a[56:59], v[120:123]
ds_read_b64_tr_b16 a[30:31], v25 offset:26368
v_mfma_f32_16x16x32_bf16 v[124:127], a[44:47], a[80:83], v[124:127]
ds_read_b64_tr_b16 a[32:33], v25 offset:25888
v_mfma_f32_16x16x32_bf16 v[128:131], a[48:51], a[80:83], v[128:131]
buffer_load_dword v22, s[16:19], s52 offen offset:2048 sc1 lds
v_mfma_f32_16x16x32_bf16 v[132:135], a[52:55], a[80:83], v[132:135]
ds_read_b64_tr_b16 a[34:35], v25 offset:26400
s_add_u32 s52, s52, 0x20000
v_mfma_f32_16x16x32_bf16 v[136:139], a[56:59], a[80:83], v[136:139]
ds_read_b64_tr_b16 a[36:37], v25 offset:26880
v_mfma_f32_16x16x32_bf16 v[156:159], a[60:63], a[80:83], v[156:159]
ds_read_b64_tr_b16 a[38:39], v25 offset:27392
v_mfma_f32_16x16x32_bf16 v[140:143], a[44:47], a[84:87], v[140:143]
buffer_load_dwordx4 v[168:171], v26, s[16:19], s75 offen sc1
v_mfma_f32_16x16x32_bf16 v[144:147], a[48:51], a[84:87], v[144:147]
ds_read_b64_tr_b16 a[40:41], v25 offset:26912
v_mfma_f32_16x16x32_bf16 v[148:151], a[52:55], a[84:87], v[148:151]
ds_read_b64_tr_b16 a[42:43], v25 offset:27424
v_mfma_f32_16x16x32_bf16 v[152:155], a[56:59], a[84:87], v[152:155]
v_mfma_f32_16x16x32_bf16 v[160:163], a[60:63], a[84:87], v[160:163]
s_waitcnt vmcnt(16) lgkmcnt(6)
s_barrier
v_mfma_f32_16x16x32_bf16 v[60:63], a[20:23], a[0:3], v[60:63]
ds_read_b128 a[44:47], v23 offset:27648
s_add_u32 m0, s56, 78976
v_mfma_f32_16x16x32_bf16 v[64:67], a[20:23], a[4:7], v[64:67]
buffer_load_dwordx4 v18, s[20:23], s54 offen lds
v_mfma_f32_16x16x32_bf16 v[68:71], a[20:23], a[8:11], v[68:71]
s_sub_u32 s47, s47, 1
s_cbranch_scc1 .Lx17
.Lx17b:
v_mfma_f32_16x16x32_bf16 v[72:75], a[20:23], a[12:15], v[72:75]
ds_read_b128 a[48:51], v23 offset:28672
v_mfma_f32_16x16x32_bf16 v[76:79], a[24:27], a[0:3], v[76:79]
ds_read_b128 a[52:55], v23 offset:29952
v_mfma_f32_16x16x32_bf16 v[80:83], a[24:27], a[4:7], v[80:83]
buffer_load_dwordx4 v19, s[20:23], s54 offen offset:1024 lds
v_mfma_f32_16x16x32_bf16 v[84:87], a[24:27], a[8:11], v[84:87]
ds_read_b128 a[56:59], v23 offset:30976
v_mfma_f32_16x16x32_bf16 v[88:91], a[24:27], a[12:15], v[88:91]
ds_read_b64_tr_b16 a[64:65], v25 offset:37248
v_mfma_f32_16x16x32_bf16 v[244:247], a[24:27], a[16:19], v[244:247]
ds_read_b64_tr_b16 a[66:67], v25 offset:37760
v_mfma_f32_16x16x32_bf16 v[92:95], a[28:31], a[0:3], v[92:95]
buffer_load_dwordx4 v20, s[20:23], s54 offen offset:2048 lds
v_mfma_f32_16x16x32_bf16 v[96:99], a[28:31], a[4:7], v[96:99]
s_add_u32 s54, s54, 196608
s_waitcnt lgkmcnt(6)
v_mfma_f32_16x16x32_bf16 v[100:103], a[28:31], a[8:11], v[100:103]
ds_read_b64_tr_b16 a[68:69], v25 offset:37280
v_mfma_f32_16x16x32_bf16 v[104:107], a[28:31], a[12:15], v[104:107]
ds_read_b64_tr_b16 a[70:71], v25 offset:37792
s_add_u32 m0, s55, 9216
v_mfma_f32_16x16x32_bf16 v[108:111], a[32:35], a[0:3], v[108:111]
buffer_load_dwordx4 v21, s[16:19], s52 offen sc1 lds
v_mfma_f32_16x16x32_bf16 v[112:115], a[32:35], a[4:7], v[112:115]
ds_read_b128 a[60:63], v24 offset:29696
v_mfma_f32_16x16x32_bf16 v[116:119], a[32:35], a[8:11], v[116:119]
ds_read_b64_tr_b16 a[72:73], v25 offset:38272
v_mfma_f32_16x16x32_bf16 v[120:123], a[32:35], a[12:15], v[120:123]
ds_read_b64_tr_b16 a[74:75], v25 offset:38784
v_mfma_f32_16x16x32_bf16 v[124:127], a[0:3], a[36:39], v[124:127]
buffer_load_dwordx4 v21, s[16:19], s52 offen offset:1024 sc1 lds
v_mfma_f32_16x16x32_bf16 v[128:131], a[4:7], a[36:39], v[128:131]
ds_read_b64_tr_b16 a[76:77], v25 offset:38304
v_mfma_f32_16x16x32_bf16 v[132:135], a[8:11], a[36:39], v[132:135]
ds_read_b64_tr_b16 a[78:79], v25 offset:38816
v_mfma_f32_16x16x32_bf16 v[136:139], a[12:15], a[36:39], v[136:139]
ds_read_b64_tr_b16 a[80:81], v25 offset:39296
v_mfma_f32_16x16x32_bf16 v[156:159], a[16:19], a[36:39], v[156:159]
buffer_load_dword v22, s[16:19], s52 offen offset:2048 sc1 lds
v_mfma_f32_16x16x32_bf16 v[140:143], a[0:3], a[40:43], v[140:143]
ds_read_b64_tr_b16 a[82:83], v25 offset:39808
s_add_u32 s52, s52, 0x20000
v_mfma_f32_16x16x32_bf16 v[144:147], a[4:7], a[40:43], v[144:147]
ds_read_b64_tr_b16 a[84:85], v25 offset:39328
v_mfma_f32_16x16x32_bf16 v[148:151], a[8:11], a[40:43], v[148:151]
ds_read_b64_tr_b16 a[86:87], v25 offset:39840
v_mfma_f32_16x16x32_bf16 v[152:155], a[12:15], a[40:43], v[152:155]
v_mfma_f32_16x16x32_bf16 v[160:163], a[16:19], a[40:43], v[160:163]
s_waitcnt vmcnt(19) lgkmcnt(6)
s_barrier
v_mfma_f32_16x16x32_bf16 v[60:63], a[64:67], a[44:47], v[60:63]
ds_read_b128 a[0:3], v23 offset:36864
s_add_u32 m0, s56, 91392
v_mfma_f32_16x16x32_bf16 v[64:67], a[64:67], a[48:51], v[64:67]
buffer_load_dwordx4 v18, s[20:23], s54 offen lds
v_mfma_f32_16x16x32_bf16 v[68:71], a[64:67], a[52:55], v[68:71]
ds_read_b128 a[4:7], v23 offset:37888
v_add_f32 v164, v164, v172
v_mfma_f32_16x16x32_bf16 v[72:75], a[64:67], a[56:59], v[72:75]
ds_read_b128 a[8:11], v23 offset:39168
v_mfma_f32_16x16x32_bf16 v[76:79], a[68:71], a[44:47], v[76:79]
ds_read_b128 a[12:15], v23 offset:40192
v_mfma_f32_16x16x32_bf16 v[80:83], a[68:71], a[48:51], v[80:83]
buffer_load_dwordx4 v19, s[20:23], s54 offen offset:1024 lds
v_mfma_f32_16x16x32_bf16 v[84:87], a[68:71], a[52:55], v[84:87]
ds_read_b64_tr_b16 a[20:21], v25 offset:49664
v_mfma_f32_16x16x32_bf16 v[88:91], a[68:71], a[56:59], v[88:91]
ds_read_b64_tr_b16 a[22:23], v25 offset:50176
v_add_f32 v165, v165, v173
v_mfma_f32_16x16x32_bf16 v[244:247], a[68:71], a[60:63], v[244:247]
ds_read_b64_tr_b16 a[24:25], v25 offset:49696
v_mfma_f32_16x16x32_bf16 v[92:95], a[72:75], a[44:47], v[92:95]
buffer_load_dwordx4 v20, s[20:23], s54 offen offset:2048 lds
v_mfma_f32_16x16x32_bf16 v[96:99], a[72:75], a[48:51], v[96:99]
s_add_u32 s54, s54, 196608
s_waitcnt lgkmcnt(7)
v_mfma_f32_16x16x32_bf16 v[100:103], a[72:75], a[52:55], v[100:103]
ds_read_b64_tr_b16 a[26:27], v25 offset:50208
v_mfma_f32_16x16x32_bf16 v[104:107], a[72:75], a[56:59], v[104:107]
ds_read_b128 a[16:19], v24 offset:38912
s_add_u32 m0, s55, 18432
v_mfma_f32_16x16x32_bf16 v[108:111], a[76:79], a[44:47], v[108:111]
buffer_load_dwordx4 v21, s[16:19], s52 offen sc1 lds
v_mfma_f32_16x16x32_bf16 v[112:115], a[76:79], a[48:51], v[112:115]
v_add_f32 v166, v166, v174
v_mfma_f32_16x16x32_bf16 v[116:119], a[76:79], a[52:55], v[116:119]
ds_read_b64_tr_b16 a[28:29], v25 offset:50688
v_mfma_f32_16x16x32_bf16 v[120:123], a[76:79], a[56:59], v[120:123]
ds_read_b64_tr_b16 a[30:31], v25 offset:51200
v_mfma_f32_16x16x32_bf16 v[124:127], a[44:47], a[80:83], v[124:127]
buffer_load_dwordx4 v21, s[16:19], s52 offen offset:1024 sc1 lds
v_mfma_f32_16x16x32_bf16 v[128:131], a[48:51], a[80:83], v[128:131]
ds_read_b64_tr_b16 a[32:33], v25 offset:50720
v_mfma_f32_16x16x32_bf16 v[132:135], a[52:55], a[80:83], v[132:135]
ds_read_b64_tr_b16 a[34:35], v25 offset:51232
v_mfma_f32_16x16x32_bf16 v[136:139], a[56:59], a[80:83], v[136:139]
ds_read_b64_tr_b16 a[36:37], v25 offset:51712
v_add_f32 v167, v167, v175
v_mfma_f32_16x16x32_bf16 v[156:159], a[60:63], a[80:83], v[156:159]
buffer_load_dword v22, s[16:19], s52 offen offset:2048 sc1 lds
v_mfma_f32_16x16x32_bf16 v[140:143], a[44:47], a[84:87], v[140:143]
ds_read_b64_tr_b16 a[38:39], v25 offset:52224
s_add_u32 s52, s52, 0x20000
v_mfma_f32_16x16x32_bf16 v[144:147], a[48:51], a[84:87], v[144:147]
ds_read_b64_tr_b16 a[40:41], v25 offset:51744
v_mfma_f32_16x16x32_bf16 v[148:151], a[52:55], a[84:87], v[148:151]
ds_read_b64_tr_b16 a[42:43], v25 offset:52256
v_mfma_f32_16x16x32_bf16 v[152:155], a[56:59], a[84:87], v[152:155]
v_mfma_f32_16x16x32_bf16 v[160:163], a[60:63], a[84:87], v[160:163]
s_waitcnt vmcnt(19) lgkmcnt(6)
s_barrier
v_mfma_f32_16x16x32_bf16 v[60:63], a[20:23], a[0:3], v[60:63]
ds_read_b128 a[44:47], v23 offset:46080
s_add_u32 m0, s56, 103808
v_mfma_f32_16x16x32_bf16 v[64:67], a[20:23], a[4:7], v[64:67]
buffer_load_dwordx4 v18, s[20:23], s54 offen lds
v_mfma_f32_16x16x32_bf16 v[68:71], a[20:23], a[8:11], v[68:71]
s_sub_u32 s47, s47, 1
s_cbranch_scc1 .Lx18
.Lx18b:
v_mfma_f32_16x16x32_bf16 v[72:75], a[20:23], a[12:15], v[72:75]
ds_read_b128 a[48:51], v23 offset:47104
v_mfma_f32_16x16x32_bf16 v[76:79], a[24:27], a[0:3], v[76:79]
buffer_load_dwordx4 v19, s[20:23], s54 offen offset:1024 lds
v_mfma_f32_16x16x32_bf16 v[80:83], a[24:27], a[4:7], v[80:83]
ds_read_b128 a[52:55], v23 offset:48384
v_mfma_f32_16x16x32_bf16 v[84:87], a[24:27], a[8:11], v[84:87]
ds_read_b128 a[56:59], v23 offset:49408
v_mfma_f32_16x16x32_bf16 v[88:91], a[24:27], a[12:15], v[88:91]
ds_read_b64_tr_b16 a[64:65], v25 offset:62080
v_mfma_f32_16x16x32_bf16 v[244:247], a[24:27], a[16:19], v[244:247]
buffer_load_dwordx4 v20, s[20:23], s54 offen offset:2048 lds
v_mfma_f32_16x16x32_bf16 v[92:95], a[28:31], a[0:3], v[92:95]
ds_read_b64_tr_b16 a[66:67], v25 offset:62592
s_add_u32 s54, s54, 196608
v_mfma_f32_16x16x32_bf16 v[96:99], a[28:31], a[4:7], v[96:99]
s_add_u32 m0, s55, 27648
s_waitcnt lgkmcnt(6)
v_mfma_f32_16x16x32_bf16 v[100:103], a[28:31], a[8:11], v[100:103]
buffer_load_dwordx4 v21, s[16:19], s52 offen sc1 lds
v_mfma_f32_16x16x32_bf16 v[104:107], a[28:31], a[12:15], v[104:107]
ds_read_b64_tr_b16 a[68:69], v25 offset:62112
v_mfma_f32_16x16x32_bf16 v[108:111], a[32:35], a[0:3], v[108:111]
ds_read_b64_tr_b16 a[70:71], v25 offset:62624
v_mfma_f32_16x16x32_bf16 v[112:115], a[32:35], a[4:7], v[112:115]
ds_read_b128 a[60:63], v24 offset:48128
v_mfma_f32_16x16x32_bf16 v[116:119], a[32:35], a[8:11], v[116:119]
buffer_load_dwordx4 v21, s[16:19], s52 offen offset:1024 sc1 lds
v_mfma_f32_16x16x32_bf16 v[120:123], a[32:35], a[12:15], v[120:123]
ds_read_b64_tr_b16 a[72:73], v25 offset:63104
v_mfma_f32_16x16x32_bf16 v[124:127], a[0:3], a[36:39], v[124:127]
ds_read_b64_tr_b16 a[74:75], v25 offset:63616
v_mfma_f32_16x16x32_bf16 v[128:131], a[4:7], a[36:39], v[128:131]
buffer_load_dword v22, s[16:19], s52 offen offset:2048 sc1 lds
v_mfma_f32_16x16x32_bf16 v[132:135], a[8:11], a[36:39], v[132:135]
ds_read_b64_tr_b16 a[76:77], v25 offset:63136
s_add_u32 s52, s52, 0x20000
v_mfma_f32_16x16x32_bf16 v[136:139], a[12:15], a[36:39], v[136:139]
ds_read_b64_tr_b16 a[78:79], v25 offset:63648
v_mfma_f32_16x16x32_bf16 v[156:159], a[16:19], a[36:39], v[156:159]
ds_read_b64_tr_b16 a[80:81], v25 offset:64128
v_mfma_f32_16x16x32_bf16 v[140:143], a[0:3], a[40:43], v[140:143]
buffer_load_dwordx4 v[172:175], v26, s[16:19], s75 offen offset:1024 sc1
v_mfma_f32_16x16x32_bf16 v[144:147], a[4:7], a[40:43], v[144:147]
ds_read_b64_tr_b16 a[82:83], v25 offset:64640
s_add_u32 s75, s75, 2048
v_mfma_f32_16x16x32_bf16 v[148:151], a[8:11], a[40:43], v[148:151]
ds_read_b64_tr_b16 a[84:85], v25 offset:64160
v_mfma_f32_16x16x32_bf16 v[152:155], a[12:15], a[40:43], v[152:155]
ds_read_b64_tr_b16 a[86:87], v25 offset:64672
v_mfma_f32_16x16x32_bf16 v[160:163], a[16:19], a[40:43], v[160:163]
s_waitcnt vmcnt(20) lgkmcnt(6)
s_barrier
v_mfma_f32_16x16x32_bf16 v[60:63], a[64:67], a[44:47], v[60:63]
ds_read_b128 a[0:3], v23
s_add_u32 m0, s56, 116224
v_mfma_f32_16x16x32_bf16 v[64:67], a[64:67], a[48:51], v[64:67]
buffer_load_dwordx4 v18, s[20:23], s54 offen lds
v_mfma_f32_16x16x32_bf16 v[68:71], a[64:67], a[52:55], v[68:71]
ds_read_b128 a[4:7], v23 offset:1024
v_mfma_f32_16x16x32_bf16 v[72:75], a[64:67], a[56:59], v[72:75]
ds_read_b128 a[8:11], v23 offset:2304
v_mfma_f32_16x16x32_bf16 v[76:79], a[68:71], a[44:47], v[76:79]
ds_read_b128 a[12:15], v23 offset:3328
v_mfma_f32_16x16x32_bf16 v[80:83], a[68:71], a[48:51], v[80:83]
buffer_load_dwordx4 v19, s[20:23], s54 offen offset:1024 lds
v_mfma_f32_16x16x32_bf16 v[84:87], a[68:71], a[52:55], v[84:87]
ds_read_b64_tr_b16 a[20:21], v25
v_mfma_f32_16x16x32_bf16 v[88:91], a[68:71], a[56:59], v[88:91]
ds_read_b64_tr_b16 a[22:23], v25 offset:512
v_mfma_f32_16x16x32_bf16 v[244:247], a[68:71], a[60:63], v[244:247]
ds_read_b64_tr_b16 a[24:25], v25 offset:32
v_mfma_f32_16x16x32_bf16 v[92:95], a[72:75], a[44:47], v[92:95]
buffer_load_dwordx4 v20, s[20:23], s54 offen offset:2048 lds
v_mfma_f32_16x16x32_bf16 v[96:99], a[72:75], a[48:51], v[96:99]
s_add_u32 s54, s54, 196608
s_waitcnt lgkmcnt(7)
v_mfma_f32_16x16x32_bf16 v[100:103], a[72:75], a[52:55], v[100:103]
ds_read_b64_tr_b16 a[26:27], v25 offset:544
v_mfma_f32_16x16x32_bf16 v[104:107], a[72:75], a[56:59], v[104:107]
ds_read_b128 a[16:19], v24 offset:2048
s_add_u32 m0, s55, 36864
v_mfma_f32_16x16x32_bf16 v[108:111], a[76:79], a[44:47], v[108:111]
buffer_load_dwordx4 v21, s[16:19], s52 offen sc1 lds
v_mfma_f32_16x16x32_bf16 v[112:115], a[76:79], a[48:51], v[112:115]
v_mfma_f32_16x16x32_bf16 v[116:119], a[76:79], a[52:55], v[116:119]
ds_read_b64_tr_b16 a[28:29], v25 offset:1024
v_mfma_f32_16x16x32_bf16 v[120:123], a[76:79], a[56:59], v[120:123]
ds_read_b64_tr_b16 a[30:31], v25 offset:1536
v_mfma_f32_16x16x32_bf16 v[124:127], a[44:47], a[80:83], v[124:127]
buffer_load_dwordx4 v21, s[16:19], s52 offen offset:1024 sc1 lds
v_mfma_f32_16x16x32_bf16 v[128:131], a[48:51], a[80:83], v[128:131]
ds_read_b64_tr_b16 a[32:33], v25 offset:1056
v_mfma_f32_16x16x32_bf16 v[132:135], a[52:55], a[80:83], v[132:135]
ds_read_b64_tr_b16 a[34:35], v25 offset:1568
v_mfma_f32_16x16x32_bf16 v[136:139], a[56:59], a[80:83], v[136:139]
ds_read_b64_tr_b16 a[36:37], v25 offset:2048
v_mfma_f32_16x16x32_bf16 v[156:159], a[60:63], a[80:83], v[156:159]
buffer_load_dword v22, s[16:19], s52 offen offset:2048 sc1 lds
v_mfma_f32_16x16x32_bf16 v[140:143], a[44:47], a[84:87], v[140:143]
ds_read_b64_tr_b16 a[38:39], v25 offset:2560
s_add_u32 s52, s52, 0x20000
v_mfma_f32_16x16x32_bf16 v[144:147], a[48:51], a[84:87], v[144:147]
ds_read_b64_tr_b16 a[40:41], v25 offset:2080
v_mfma_f32_16x16x32_bf16 v[148:151], a[52:55], a[84:87], v[148:151]
ds_read_b64_tr_b16 a[42:43], v25 offset:2592
v_mfma_f32_16x16x32_bf16 v[152:155], a[56:59], a[84:87], v[152:155]
s_add_u32 s15, s15, 1
v_mfma_f32_16x16x32_bf16 v[160:163], a[60:63], a[84:87], v[160:163]
s_cbranch_scc0 .Lk15
s_waitcnt vmcnt(19) lgkmcnt(6)
s_barrier
v_mfma_f32_16x16x32_bf16 v[60:63], a[20:23], a[0:3], v[60:63]
ds_read_b128 a[44:47], v23 offset:9216
s_add_u32 m0, s56, 128640
v_mfma_f32_16x16x32_bf16 v[64:67], a[20:23], a[4:7], v[64:67]
buffer_load_dwordx4 v18, s[20:23], s54 offen lds
v_mfma_f32_16x16x32_bf16 v[68:71], a[20:23], a[8:11], v[68:71]
ds_read_b128 a[48:51], v23 offset:10240
v_add_f32 v164, v164, v168
v_mfma_f32_16x16x32_bf16 v[72:75], a[20:23], a[12:15], v[72:75]
ds_read_b128 a[52:55], v23 offset:11520
v_mfma_f32_16x16x32_bf16 v[76:79], a[24:27], a[0:3], v[76:79]
ds_read_b128 a[56:59], v23 offset:12544
v_mfma_f32_16x16x32_bf16 v[80:83], a[24:27], a[4:7], v[80:83]
buffer_load_dwordx4 v19, s[20:23], s54 offen offset:1024 lds
v_mfma_f32_16x16x32_bf16 v[84:87], a[24:27], a[8:11], v[84:87]
ds_read_b64_tr_b16 a[64:65], v25 offset:12416
v_mfma_f32_16x16x32_bf16 v[88:91], a[24:27], a[12:15], v[88:91]
ds_read_b64_tr_b16 a[66:67], v25 offset:12928
v_add_f32 v165, v165, v169
v_mfma_f32_16x16x32_bf16 v[244:247], a[24:27], a[16:19], v[244:247]
ds_read_b64_tr_b16 a[68:69], v25 offset:12448
v_mfma_f32_16x16x32_bf16 v[92:95], a[28:31], a[0:3], v[92:95]
buffer_load_dwordx4 v20, s[20:23], s54 offen offset:2048 lds
v_mfma_f32_16x16x32_bf16 v[96:99], a[28:31], a[4:7], v[96:99]
s_add_u32 s54, s54, 196608
s_waitcnt lgkmcnt(7)
v_mfma_f32_16x16x32_bf16 v[100:103], a[28:31], a[8:11], v[100:103]
ds_read_b64_tr_b16 a[70:71], v25 offset:12960
v_mfma_f32_16x16x32_bf16 v[104:107], a[28:31], a[12:15], v[104:107]
ds_read_b128 a[60:63], v24 offset:11264
s_add_u32 m0, s55, 46080
v_mfma_f32_16x16x32_bf16 v[108:111], a[32:35], a[0:3], v[108:111]
buffer_load_dwordx4 v21, s[16:19], s52 offen sc1 lds
.Lpad6:
s_cbranch_execz .Lnopoll8r
v_mfma_f32_16x16x32_bf16 v[112:115], a[32:35], a[4:7], v[112:115]
v_add_f32 v166, v166, v170
v_mfma_f32_16x16x32_bf16 v[116:119], a[32:35], a[8:11], v[116:119]
ds_read_b64_tr_b16 a[72:73], v25 offset:13440
v_mfma_f32_16x16x32_bf16 v[120:123], a[32:35], a[12:15], v[120:123]
ds_read_b64_tr_b16 a[74:75], v25 offset:13952
v_mfma_f32_16x16x32_bf16 v[124:127], a[0:3], a[36:39], v[124:127]
buffer_load_dwordx4 v21, s[16:19], s52 offen offset:1024 sc1 lds
v_mfma_f32_16x16x32_bf16 v[128:131], a[4:7], a[36:39], v[128:131]
ds_read_b64_tr_b16 a[76:77], v25 offset:13472
v_mfma_f32_16x16x32_bf16 v[132:135], a[8:11], a[36:39], v[132:135]
ds_read_b64_tr_b16 a[78:79], v25 offset:13984
v_mfma_f32_16x16x32_bf16 v[136:139], a[12:15], a[36:39], v[136:139]
ds_read_b64_tr_b16 a[80:81], v25 offset:14464
v_add_f32 v167, v167, v171
v_mfma_f32_16x16x32_bf16 v[156:159], a[16:19], a[36:39], v[156:159]
buffer_load_dword v22, s[16:19], s52 offen offset:2048 sc1 lds
v_mfma_f32_16x16x32_bf16 v[140:143], a[0:3], a[40:43], v[140:143]
ds_read_b64_tr_b16 a[82:83], v25 offset:14976
s_add_u32 s52, s52, 0x20000
v_mfma_f32_16x16x32_bf16 v[144:147], a[4:7], a[40:43], v[144:147]
ds_read_b64_tr_b16 a[84:85], v25 offset:14496
v_mfma_f32_16x16x32_bf16 v[148:151], a[8:11], a[40:43], v[148:151]
ds_read_b64_tr_b16 a[86:87], v25 offset:15008
v_mfma_f32_16x16x32_bf16 v[152:155], a[12:15], a[40:43], v[152:155]
v_mfma_f32_16x16x32_bf16 v[160:163], a[16:19], a[40:43], v[160:163]
s_waitcnt vmcnt(19) lgkmcnt(6)
s_barrier
v_mfma_f32_16x16x32_bf16 v[60:63], a[64:67], a[44:47], v[60:63]
ds_read_b128 a[0:3], v23 offset:18432
s_add_u32 m0, s56, 66560
v_mfma_f32_16x16x32_bf16 v[64:67], a[64:67], a[48:51], v[64:67]
buffer_load_dwordx4 v18, s[20:23], s54 offen lds
v_mfma_f32_16x16x32_bf16 v[68:71], a[64:67], a[52:55], v[68:71]
ds_read_b128 a[4:7], v23 offset:19456
v_mfma_f32_16x16x32_bf16 v[72:75], a[64:67], a[56:59], v[72:75]
ds_read_b128 a[8:11], v23 offset:20736
v_mfma_f32_16x16x32_bf16 v[76:79], a[68:71], a[44:47], v[76:79]
ds_read_b128 a[12:15], v23 offset:21760
v_mfma_f32_16x16x32_bf16 v[80:83], a[68:71], a[48:51], v[80:83]
buffer_load_dwordx4 v19, s[20:23], s54 offen offset:1024 lds
v_mfma_f32_16x16x32_bf16 v[84:87], a[68:71], a[52:55], v[84:87]
ds_read_b64_tr_b16 a[20:21], v25 offset:24832
v_mfma_f32_16x16x32_bf16 v[88:91], a[68:71], a[56:59], v[88:91]
ds_read_b64_tr_b16 a[22:23], v25 offset:25344
v_mfma_f32_16x16x32_bf16 v[244:247], a[68:71], a[60:63], v[244:247]
ds_read_b64_tr_b16 a[24:25], v25 offset:24864
v_mfma_f32_16x16x32_bf16 v[92:95], a[72:75], a[44:47], v[92:95]
buffer_load_dwordx4 v20, s[20:23], s54 offen offset:2048 lds
v_mfma_f32_16x16x32_bf16 v[96:99], a[72:75], a[48:51], v[96:99]
s_add_u32 s54, s54, 196608
s_waitcnt lgkmcnt(7)
v_mfma_f32_16x16x32_bf16 v[100:103], a[72:75], a[52:55], v[100:103]
ds_read_b64_tr_b16 a[26:27], v25 offset:25376
v_mfma_f32_16x16x32_bf16 v[104:107], a[72:75], a[56:59], v[104:107]
ds_read_b128 a[16:19], v24 offset:20480
s_add_u32 m0, s55, 0
v_mfma_f32_16x16x32_bf16 v[108:111], a[76:79], a[44:47], v[108:111]
buffer_load_dwordx4 v21, s[16:19], s52 offen sc1 lds
v_mfma_f32_16x16x32_bf16 v[112:115], a[76:79], a[48:51], v[112:115]
v_mfma_f32_16x16x32_bf16 v[116:119], a[76:79], a[52:55], v[116:119]
ds_read_b64_tr_b16 a[28:29], v25 offset:25856
v_mfma_f32_16x16x32_bf16 v[120:123], a[76:79], a[56:59], v[120:123]
ds_read_b64_tr_b16 a[30:31], v25 offset:26368
v_mfma_f32_16x16x32_bf16 v[124:127], a[44:47], a[80:83], v[124:127]
buffer_load_dwordx4 v21, s[16:19], s52 offen offset:1024 sc1 lds
v_mfma_f32_16x16x32_bf16 v[128:131], a[48:51], a[80:83], v[128:131]
ds_read_b64_tr_b16 a[32:33], v25 offset:25888
v_mfma_f32_16x16x32_bf16 v[132:135], a[52:55], a[80:83], v[132:135]
ds_read_b64_tr_b16 a[34:35], v25 offset:26400
v_mfma_f32_16x16x32_bf16 v[136:139], a[56:59], a[80:83], v[136:139]
ds_read_b64_tr_b16 a[36:37], v25 offset:26880
v_mfma_f32_16x16x32_bf16 v[156:159], a[60:63], a[80:83], v[156:159]
buffer_load_dword v22, s[16:19], s52 offen offset:2048 sc1 lds
v_mfma_f32_16x16x32_bf16 v[140:143], a[44:47], a[84:87], v[140:143]
ds_read_b64_tr_b16 a[38:39], v25 offset:27392
s_add_u32 s52, s52, 0x20000
v_mfma_f32_16x16x32_bf16 v[144:147], a[48:51], a[84:87], v[144:147]
ds_read_b64_tr_b16 a[40:41], v25 offset:26912
v_mfma_f32_16x16x32_bf16 v[148:151], a[52:55], a[84:87], v[148:151]
ds_read_b64_tr_b16 a[42:43], v25 offset:27424
v_mfma_f32_16x16x32_bf16 v[152:155], a[56:59], a[84:87], v[152:155]
v_mfma_f32_16x16x32_bf16 v[160:163], a[60:63], a[84:87], v[160:163]
s_waitcnt vmcnt(19) lgkmcnt(6)
s_barrier
v_mfma_f32_16x16x32_bf16 v[60:63], a[20:23], a[0:3], v[60:63]
ds_read_b128 a[44:47], v23 offset:27648
s_add_u32 m0, s56, 78976
v_mfma_f32_16x16x32_bf16 v[64:67], a[20:23], a[4:7], v[64:67]
buffer_load_dwordx4 v18, s[20:23], s54 offen lds
v_mfma_f32_16x16x32_bf16 v[68:71], a[20:23], a[8:11], v[68:71]
ds_read_b128 a[48:51], v23 offset:28672
s_waitcnt vmcnt(19)
v_add_f32 v164, v164, v172
v_mfma_f32_16x16x32_bf16 v[72:75], a[20:23], a[12:15], v[72:75]
ds_read_b128 a[52:55], v23 offset:29952
v_mfma_f32_16x16x32_bf16 v[76:79], a[24:27], a[0:3], v[76:79]
ds_read_b128 a[56:59], v23 offset:30976
v_mfma_f32_16x16x32_bf16 v[80:83], a[24:27], a[4:7], v[80:83]
buffer_load_dwordx4 v19, s[20:23], s54 offen offset:1024 lds
v_mfma_f32_16x16x32_bf16 v[84:87], a[24:27], a[8:11], v[84:87]
ds_read_b64_tr_b16 a[64:65], v25 offset:37248
v_mfma_f32_16x16x32_bf16 v[88:91], a[24:27], a[12:15], v[88:91]
ds_read_b64_tr_b16 a[66:67], v25 offset:37760
v_add_f32 v165, v165, v173
v_mfma_f32_16x16x32_bf16 v[244:247], a[24:27], a[16:19], v[244:247]
ds_read_b64_tr_b16 a[68:69], v25 offset:37280
v_mfma_f32_16x16x32_bf16 v[92:95], a[28:31], a[0:3], v[92:95]
buffer_load_dwordx4 v20, s[20:23], s54 offen offset:2048 lds
v_mfma_f32_16x16x32_bf16 v[96:99], a[28:31], a[4:7], v[96:99]
s_add_u32 s54, s54, 196608
s_waitcnt lgkmcnt(7)
v_mfma_f32_16x16x32_bf16 v[100:103], a[28:31], a[8:11], v[100:103]
ds_read_b64_tr_b16 a[70:71], v25 offset:37792
v_mfma_f32_16x16x32_bf16 v[104:107], a[28:31], a[12:15], v[104:107]
ds_read_b128 a[60:63], v24 offset:29696
s_add_u32 m0, s55, 9216
v_mfma_f32_16x16x32_bf16 v[108:111], a[32:35], a[0:3], v[108:111]
buffer_load_dwordx4 v21, s[16:19], s52 offen sc1 lds
v_mfma_f32_16x16x32_bf16 v[112:115], a[32:35], a[4:7], v[112:115]
v_add_f32 v166, v166, v174
v_mfma_f32_16x16x32_bf16 v[116:119], a[32:35], a[8:11], v[116:119]
ds_read_b64_tr_b16 a[72:73], v25 offset:38272
v_mfma_f32_16x16x32_bf16 v[120:123], a[32:35], a[12:15], v[120:123]
ds_read_b64_tr_b16 a[74:75], v25 offset:38784
v_mfma_f32_16x16x32_bf16 v[124:127], a[0:3], a[36:39], v[124:127]
buffer_load_dwordx4 v21, s[16:19], s52 offen offset:1024 sc1 lds
v_mfma_f32_16x16x32_bf16 v[128:131], a[4:7], a[36:39], v[128:131]
ds_read_b64_tr_b16 a[76:77], v25 offset:38304
v_mfma_f32_16x16x32_bf16 v[132:135], a[8:11], a[36:39], v[132:135]
ds_read_b64_tr_b16 a[78:79], v25 offset:38816
v_mfma_f32_16x16x32_bf16 v[136:139], a[12:15], a[36:39], v[136:139]
ds_read_b64_tr_b16 a[80:81], v25 offset:39296
v_add_f32 v167, v167, v175
v_mfma_f32_16x16x32_bf16 v[156:159], a[16:19], a[36:39], v[156:159]
buffer_load_dword v22, s[16:19], s52 offen offset:2048 sc1 lds
v_mfma_f32_16x16x32_bf16 v[140:143], a[0:3], a[40:43], v[140:143]
ds_read_b64_tr_b16 a[82:83], v25 offset:39808
s_add_u32 s52, s52, 0x20000
v_mfma_f32_16x16x32_bf16 v[144:147], a[4:7], a[40:43], v[144:147]
ds_read_b64_tr_b16 a[84:85], v25 offset:39328
v_mfma_f32_16x16x32_bf16 v[148:151], a[8:11], a[40:43], v[148:151]
ds_read_b64_tr_b16 a[86:87], v25 offset:39840
v_mfma_f32_16x16x32_bf16 v[152:155], a[12:15], a[40:43], v[152:155]
v_mfma_f32_16x16x32_bf16 v[160:163], a[16:19], a[40:43], v[160:163]
s_waitcnt vmcnt(18) lgkmcnt(6)
s_barrier
v_mfma_f32_16x16x32_bf16 v[60:63], a[64:67], a[44:47], v[60:63]
s_add_u32 m0, s59, 58240
s_mov_b32 s58, 1966080
v_permlane32_swap_b32 v164, v166
v_mfma_f32_16x16x32_bf16 v[64:67], a[64:67], a[48:51], v[64:67]
buffer_load_dwordx4 v5, s[24:27], s58 offen lds
v_mfma_f32_16x16x32_bf16 v[68:71], a[64:67], a[52:55], v[68:71]
ds_read_b128 a[0:3], v23 offset:36864
v_mfma_f32_16x16x32_bf16 v[72:75], a[64:67], a[56:59], v[72:75]
ds_read_b128 a[4:7], v23 offset:37888
v_mfma_f32_16x16x32_bf16 v[76:79], a[68:71], a[44:47], v[76:79]
ds_read_b128 a[8:11], v23 offset:39168
v_permlane32_swap_b32 v165, v167
v_mfma_f32_16x16x32_bf16 v[80:83], a[68:71], a[48:51], v[80:83]
ds_read_b128 a[12:15], v23 offset:40192
v_mfma_f32_16x16x32_bf16 v[84:87], a[68:71], a[52:55], v[84:87]
ds_read_b64_tr_b16 a[20:21], v25 offset:49664
v_mfma_f32_16x16x32_bf16 v[88:91], a[68:71], a[56:59], v[88:91]
buffer_load_dwordx4 v6, s[24:27], s58 offen offset:1024 lds
v_mfma_f32_16x16x32_bf16 v[244:247], a[68:71], a[60:63], v[244:247]
ds_read_b64_tr_b16 a[22:23], v25 offset:50176
v_add_f32 v164, v164, v166
v_mfma_f32_16x16x32_bf16 v[92:95], a[72:75], a[44:47], v[92:95]
v_mfma_f32_16x16x32_bf16 v[96:99], a[72:75], a[48:51], v[96:99]
ds_read_b64_tr_b16 a[24:25], v25 offset:49696
s_waitcnt lgkmcnt(7)
v_mfma_f32_16x16x32_bf16 v[100:103], a[72:75], a[52:55], v[100:103]
ds_read_b64_tr_b16 a[26:27], v25 offset:50208
v_add_f32 v165, v165, v167
v_mfma_f32_16x16x32_bf16 v[104:107], a[72:75], a[56:59], v[104:107]
s_add_u32 m0, s59, 91520
s_mov_b32 s58, 393216
v_mfma_f32_16x16x32_bf16 v[108:111], a[76:79], a[44:47], v[108:111]
buffer_load_dwordx4 v5, s[24:27], s58 offen lds
v_mfma_f32_16x16x32_bf16 v[112:115], a[76:79], a[48:51], v[112:115]
ds_read_b128 a[16:19], v24 offset:38912
v_mfma_f32_16x16x32_bf16 v[116:119], a[76:79], a[52:55], v[116:119]
ds_read_b64_tr_b16 a[28:29], v25 offset:50688
v_mul_f32 v164, 0xba800000, v164
v_mfma_f32_16x16x32_bf16 v[120:123], a[76:79], a[56:59], v[120:123]
ds_read_b64_tr_b16 a[30:31], v25 offset:51200
v_mfma_f32_16x16x32_bf16 v[124:127], a[44:47], a[80:83], v[124:127]
ds_read_b64_tr_b16 a[32:33], v25 offset:50720
v_mfma_f32_16x16x32_bf16 v[128:131], a[48:51], a[80:83], v[128:131]
v_mul_f32 v165, 0x3a800000, v165
v_mfma_f32_16x16x32_bf16 v[132:135], a[52:55], a[80:83], v[132:135]
buffer_load_dwordx4 v6, s[24:27], s58 offen offset:1024 lds
v_mfma_f32_16x16x32_bf16 v[136:139], a[56:59], a[80:83], v[136:139]
ds_read_b64_tr_b16 a[34:35], v25 offset:51232
v_mfma_f32_16x16x32_bf16 v[156:159], a[60:63], a[80:83], v[156:159]
ds_read_b64_tr_b16 a[36:37], v25 offset:51712
v_fma_f32 v165, -v164, v164, v165
v_mfma_f32_16x16x32_bf16 v[140:143], a[44:47], a[84:87], v[140:143]
ds_read_b64_tr_b16 a[38:39], v25 offset:52224
v_mfma_f32_16x16x32_bf16 v[144:147], a[48:51], a[84:87], v[144:147]
ds_read_b64_tr_b16 a[40:41], v25 offset:51744
v_mfma_f32_16x16x32_bf16 v[148:151], a[52:55], a[84:87], v[148:151]
ds_read_b64_tr_b16 a[42:43], v25 offset:52256
v_max_f32 v165, 0, v165
v_mfma_f32_16x16x32_bf16 v[152:155], a[56:59], a[84:87], v[152:155]
v_mfma_f32_16x16x32_bf16 v[160:163], a[60:63], a[84:87], v[160:163]
s_waitcnt vmcnt(16) lgkmcnt(6)
s_barrier
v_mfma_f32_16x16x32_bf16 v[60:63], a[20:23], a[0:3], v[60:63]
s_add_u32 m0, s59, 24960
s_mov_b32 s58, 1441792
v_add_f32 v165, 0x3727c5ac, v165
v_mfma_f32_16x16x32_bf16 v[64:67], a[20:23], a[4:7], v[64:67]
buffer_load_dwordx4 v5, s[24:27], s58 offen lds
v_mfma_f32_16x16x32_bf16 v[68:71], a[20:23], a[8:11], v[68:71]
ds_read_b128 a[44:47], v23 offset:46080
v_mfma_f32_16x16x32_bf16 v[72:75], a[20:23], a[12:15], v[72:75]
ds_read_b128 a[48:51], v23 offset:47104
v_mfma_f32_16x16x32_bf16 v[76:79], a[24:27], a[0:3], v[76:79]
ds_read_b128 a[52:55], v23 offset:48384
v_rsq_f32 v166, v165
v_mfma_f32_16x16x32_bf16 v[80:83], a[24:27], a[4:7], v[80:83]
ds_read_b128 a[56:59], v23 offset:49408
v_mfma_f32_16x16x32_bf16 v[84:87], a[24:27], a[8:11], v[84:87]
ds_read_b64_tr_b16 a[64:65], v25 offset:62080
v_mfma_f32_16x16x32_bf16 v[88:91], a[24:27], a[12:15], v[88:91]
buffer_load_dwordx4 v6, s[24:27], s58 offen offset:1024 lds
v_mfma_f32_16x16x32_bf16 v[244:247], a[24:27], a[16:19], v[244:247]
ds_read_b64_tr_b16 a[66:67], v25 offset:62592
v_mov_b32 v165, v166
v_mfma_f32_16x16x32_bf16 v[92:95], a[28:31], a[0:3], v[92:95]
v_mfma_f32_16x16x32_bf16 v[96:99], a[28:31], a[4:7], v[96:99]
ds_read_b64_tr_b16 a[68:69], v25 offset:62112
s_waitcnt lgkmcnt(7)
v_mfma_f32_16x16x32_bf16 v[100:103], a[28:31], a[8:11], v[100:103]
ds_read_b64_tr_b16 a[70:71], v25 offset:62624
v_mfma_f32_16x16x32_bf16 v[104:107], a[28:31], a[12:15], v[104:107]
s_add_u32 m0, s59, 99840
s_mov_b32 s58, 524288
v_mul_f32 v166, 0x3e8293ee, v166
v_mfma_f32_16x16x32_bf16 v[108:111], a[32:35], a[0:3], v[108:111]
buffer_load_dwordx4 v5, s[24:27], s58 offen lds
v_mfma_f32_16x16x32_bf16 v[112:115], a[32:35], a[4:7], v[112:115]
ds_read_b128 a[60:63], v24 offset:48128
v_mfma_f32_16x16x32_bf16 v[116:119], a[32:35], a[8:11], v[116:119]
ds_read_b64_tr_b16 a[72:73], v25 offset:63104
v_mfma_f32_16x16x32_bf16 v[120:123], a[32:35], a[12:15], v[120:123]
ds_read_b64_tr_b16 a[74:75], v25 offset:63616
ds_write_b128 v7, v[164:167]
v_mfma_f32_16x16x32_bf16 v[124:127], a[0:3], a[36:39], v[124:127]
ds_read_b64_tr_b16 a[76:77], v25 offset:63136
v_mfma_f32_16x16x32_bf16 v[128:131], a[4:7], a[36:39], v[128:131]
v_mfma_f32_16x16x32_bf16 v[132:135], a[8:11], a[36:39], v[132:135]
buffer_load_dwordx4 v6, s[24:27], s58 offen offset:1024 lds
v_mfma_f32_16x16x32_bf16 v[136:139], a[12:15], a[36:39], v[136:139]
ds_read_b64_tr_b16 a[78:79], v25 offset:63648
ds_write_b32 v17, v164
v_mfma_f32_16x16x32_bf16 v[156:159], a[16:19], a[36:39], v[156:159]
ds_read_b64_tr_b16 a[80:81], v25 offset:64128
v_mfma_f32_16x16x32_bf16 v[140:143], a[0:3], a[40:43], v[140:143]
ds_read_b64_tr_b16 a[82:83], v25 offset:64640
v_mfma_f32_16x16x32_bf16 v[144:147], a[4:7], a[40:43], v[144:147]
ds_read_b64_tr_b16 a[84:85], v25 offset:64160
ds_write_b32 v17, v165 offset:1024
v_mfma_f32_16x16x32_bf16 v[148:151], a[8:11], a[40:43], v[148:151]
ds_read_b64_tr_b16 a[86:87], v25 offset:64672
v_mfma_f32_16x16x32_bf16 v[152:155], a[12:15], a[40:43], v[152:155]
v_mfma_f32_16x16x32_bf16 v[160:163], a[16:19], a[40:43], v[160:163]
s_waitcnt vmcnt(14) lgkmcnt(9)
s_barrier
v_mfma_f32_16x16x32_bf16 v[60:63], a[64:67], a[44:47], v[60:63]
s_add_u32 m0, s59, 33280
s_mov_b32 s58, 1572864
v_mfma_f32_16x16x32_bf16 v[64:67], a[64:67], a[48:51], v[64:67]
buffer_load_dwordx4 v5, s[24:27], s58 offen lds
v_mfma_f32_16x16x32_bf16 v[68:71], a[64:67], a[52:55], v[68:71]
ds_read_b128 a[0:3], v23
v_mfma_f32_16x16x32_bf16 v[72:75], a[64:67], a[56:59], v[72:75]
ds_read_b128 a[4:7], v23 offset:1024
v_mfma_f32_16x16x32_bf16 v[76:79], a[68:71], a[44:47], v[76:79]
ds_read_b128 a[8:11], v23 offset:2304
v_mfma_f32_16x16x32_bf16 v[80:83], a[68:71], a[48:51], v[80:83]
buffer_load_dwordx4 v6, s[24:27], s58 offen offset:1024 lds
v_mfma_f32_16x16x32_bf16 v[84:87], a[68:71], a[52:55], v[84:87]
ds_read_b128 a[12:15], v23 offset:3328
v_mfma_f32_16x16x32_bf16 v[88:91], a[68:71], a[56:59], v[88:91]
ds_read_b64_tr_b16 a[20:21], v25
v_mfma_f32_16x16x32_bf16 v[244:247], a[68:71], a[60:63], v[244:247]
s_add_u32 m0, s59, 108160
s_mov_b32 s58, 655360
v_mfma_f32_16x16x32_bf16 v[92:95], a[72:75], a[44:47], v[92:95]
buffer_load_dwordx4 v5, s[24:27], s58 offen lds
v_mfma_f32_16x16x32_bf16 v[96:99], a[72:75], a[48:51], v[96:99]
ds_read_b64_tr_b16 a[22:23], v25 offset:512
s_waitcnt lgkmcnt(6)
v_mfma_f32_16x16x32_bf16 v[100:103], a[72:75], a[52:55], v[100:103]
ds_read_b64_tr_b16 a[24:25], v25 offset:32
v_mfma_f32_16x16x32_bf16 v[104:107], a[72:75], a[56:59], v[104:107]
ds_read_b64_tr_b16 a[26:27], v25 offset:544
v_mfma_f32_16x16x32_bf16 v[108:111], a[76:79], a[44:47], v[108:111]
buffer_load_dwordx4 v6, s[24:27], s58 offen offset:1024 lds
v_mfma_f32_16x16x32_bf16 v[112:115], a[76:79], a[48:51], v[112:115]
ds_read_b128 a[16:19], v24 offset:2048
v_mfma_f32_16x16x32_bf16 v[116:119], a[76:79], a[52:55], v[116:119]
ds_read_b64_tr_b16 a[28:29], v25 offset:1024
v_mfma_f32_16x16x32_bf16 v[120:123], a[76:79], a[56:59], v[120:123]
s_add_u32 m0, s59, 116480
s_mov_b32 s58, 786432
v_mfma_f32_16x16x32_bf16 v[124:127], a[44:47], a[80:83], v[124:127]
buffer_load_dwordx4 v5, s[24:27], s58 offen lds
v_mfma_f32_16x16x32_bf16 v[128:131], a[48:51], a[80:83], v[128:131]
ds_read_b64_tr_b16 a[30:31], v25 offset:1536
v_mfma_f32_16x16x32_bf16 v[132:135], a[52:55], a[80:83], v[132:135]
ds_read_b64_tr_b16 a[32:33], v25 offset:1056
v_mfma_f32_16x16x32_bf16 v[136:139], a[56:59], a[80:83], v[136:139]
ds_read_b64_tr_b16 a[34:35], v25 offset:1568
v_mfma_f32_16x16x32_bf16 v[156:159], a[60:63], a[80:83], v[156:159]
buffer_load_dwordx4 v6, s[24:27], s58 offen offset:1024 lds
v_mfma_f32_16x16x32_bf16 v[140:143], a[44:47], a[84:87], v[140:143]
ds_read_b64_tr_b16 a[36:37], v25 offset:2048
v_mfma_f32_16x16x32_bf16 v[144:147], a[48:51], a[84:87], v[144:147]
ds_read_b64_tr_b16 a[38:39], v25 offset:2560
v_mfma_f32_16x16x32_bf16 v[148:151], a[52:55], a[84:87], v[148:151]
ds_read_b64_tr_b16 a[40:41], v25 offset:2080
v_mfma_f32_16x16x32_bf16 v[152:155], a[56:59], a[84:87], v[152:155]
ds_read_b64_tr_b16 a[42:43], v25 offset:2592
v_mfma_f32_16x16x32_bf16 v[160:163], a[60:63], a[84:87], v[160:163]
s_waitcnt vmcnt(14) lgkmcnt(6)
s_barrier
v_mfma_f32_16x16x32_bf16 v[60:63], a[20:23], a[0:3], v[60:63]
s_add_u32 m0, s59, 41600
s_mov_b32 s58, 1703936
v_mfma_f32_16x16x32_bf16 v[64:67], a[20:23], a[4:7], v[64:67]
buffer_load_dwordx4 v5, s[24:27], s58 offen lds
v_mfma_f32_16x16x32_bf16 v[68:71], a[20:23], a[8:11], v[68:71]
ds_read_b128 a[44:47], v23 offset:9216
v_mfma_f32_16x16x32_bf16 v[72:75], a[20:23], a[12:15], v[72:75]
ds_read_b128 a[48:51], v23 offset:10240
v_mfma_f32_16x16x32_bf16 v[76:79], a[24:27], a[0:3], v[76:79]
ds_read_b128 a[52:55], v23 offset:11520
v_mfma_f32_16x16x32_bf16 v[80:83], a[24:27], a[4:7], v[80:83]
buffer_load_dwordx4 v6, s[24:27], s58 offen offset:1024 lds
v_mfma_f32_16x16x32_bf16 v[84:87], a[24:27], a[8:11], v[84:87]
ds_read_b128 a[56:59], v23 offset:12544
v_mfma_f32_16x16x32_bf16 v[88:91], a[24:27], a[12:15], v[88:91]
ds_read_b64_tr_b16 a[64:65], v25 offset:12416
v_mfma_f32_16x16x32_bf16 v[244:247], a[24:27], a[16:19], v[244:247]
s_add_u32 m0, s59, 49920
s_mov_b32 s58, 1835008
v_mfma_f32_16x16x32_bf16 v[92:95], a[28:31], a[0:3], v[92:95]
buffer_load_dwordx4 v5, s[24:27], s58 offen lds
v_mfma_f32_16x16x32_bf16 v[96:99], a[28:31], a[4:7], v[96:99]
ds_read_b64_tr_b16 a[66:67], v25 offset:12928
s_waitcnt lgkmcnt(6)
v_mfma_f32_16x16x32_bf16 v[100:103], a[28:31], a[8:11], v[100:103]
ds_read_b64_tr_b16 a[68:69], v25 offset:12448
v_mfma_f32_16x16x32_bf16 v[104:107], a[28:31], a[12:15], v[104:107]
ds_read_b64_tr_b16 a[70:71], v25 offset:12960
v_mfma_f32_16x16x32_bf16 v[108:111], a[32:35], a[0:3], v[108:111]
buffer_load_dwordx4 v6, s[24:27], s58 offen offset:1024 lds
v_mfma_f32_16x16x32_bf16 v[112:115], a[32:35], a[4:7], v[112:115]
ds_read_b128 a[60:63], v24 offset:11264
v_mfma_f32_16x16x32_bf16 v[116:119], a[32:35], a[8:11], v[116:119]
ds_read_b64_tr_b16 a[72:73], v25 offset:13440
v_mfma_f32_16x16x32_bf16 v[120:123], a[32:35], a[12:15], v[120:123]
s_add_u32 m0, s59, 124800
s_mov_b32 s58, 917504
v_mfma_f32_16x16x32_bf16 v[124:127], a[0:3], a[36:39], v[124:127]
buffer_load_dwordx4 v5, s[24:27], s58 offen lds
v_mfma_f32_16x16x32_bf16 v[128:131], a[4:7], a[36:39], v[128:131]
ds_read_b64_tr_b16 a[74:75], v25 offset:13952
v_mfma_f32_16x16x32_bf16 v[132:135], a[8:11], a[36:39], v[132:135]
ds_read_b64_tr_b16 a[76:77], v25 offset:13472
v_mfma_f32_16x16x32_bf16 v[136:139], a[12:15], a[36:39], v[136:139]
ds_read_b64_tr_b16 a[78:79], v25 offset:13984
v_mfma_f32_16x16x32_bf16 v[156:159], a[16:19], a[36:39], v[156:159]
buffer_load_dwordx4 v6, s[24:27], s58 offen offset:1024 lds
v_mfma_f32_16x16x32_bf16 v[140:143], a[0:3], a[40:43], v[140:143]
ds_read_b64_tr_b16 a[80:81], v25 offset:14464
v_mfma_f32_16x16x32_bf16 v[144:147], a[4:7], a[40:43], v[144:147]
ds_read_b64_tr_b16 a[82:83], v25 offset:14976
v_mfma_f32_16x16x32_bf16 v[148:151], a[8:11], a[40:43], v[148:151]
ds_read_b64_tr_b16 a[84:85], v25 offset:14496
v_mfma_f32_16x16x32_bf16 v[152:155], a[12:15], a[40:43], v[152:155]
ds_read_b64_tr_b16 a[86:87], v25 offset:15008
v_mfma_f32_16x16x32_bf16 v[160:163], a[16:19], a[40:43], v[160:163]
s_waitcnt lgkmcnt(0)
s_barrier
v_mfma_f32_16x16x32_bf16 v[244:247], a[68:71], a[60:63], v[244:247]
ds_read_b128 v[232:235], v10 offset:1792
v_mfma_f32_16x16x32_bf16 v[156:159], a[60:63], a[80:83], v[156:159]
ds_read_b128 v[228:231], v10 offset:1536
v_mfma_f32_16x16x32_bf16 v[160:163], a[60:63], a[84:87], v[160:163]
ds_read_b128 v[224:227], v10 offset:1280
v_mfma_f32_16x16x32_bf16 v[104:107], a[72:75], a[56:59], v[104:107]
ds_read_b128 v[220:223], v10 offset:1024
v_mfma_f32_16x16x32_bf16 v[120:123], a[76:79], a[56:59], v[120:123]
v_mfma_f32_16x16x32_bf16 v[136:139], a[56:59], a[80:83], v[136:139]
v_mfma_f32_16x16x32_bf16 v[152:155], a[56:59], a[84:87], v[152:155]
v_mfma_f32_16x16x32_bf16 v[100:103], a[72:75], a[52:55], v[100:103]
v_mfma_f32_16x16x32_bf16 v[116:119], a[76:79], a[52:55], v[116:119]
s_mov_b32 exec_lo, 0x10001
s_mov_b32 exec_hi, 0x10001
ds_write_b128 v13, v[244:247] offset:64
s_mov_b64 exec, 0xffff
ds_write_b32 v12, v156 offset:512
ds_write_b32 v12, v160 offset:576
s_mov_b64 exec, -1
v_mfma_f32_16x16x32_bf16 v[96:99], a[72:75], a[48:51], v[96:99]
v_mfma_f32_16x16x32_bf16 v[112:115], a[76:79], a[48:51], v[112:115]
v_mfma_f32_16x16x32_bf16 v[92:95], a[72:75], a[44:47], v[92:95]
v_mfma_f32_16x16x32_bf16 v[108:111], a[76:79], a[44:47], v[108:111]
v_mfma_f32_16x16x32_bf16 v[72:75], a[64:67], a[56:59], v[72:75]
v_mfma_f32_16x16x32_bf16 v[88:91], a[68:71], a[56:59], v[88:91]
s_waitcnt lgkmcnt(0)
s_barrier
v_mfma_f32_16x16x32_bf16 v[132:135], a[52:55], a[80:83], v[132:135]
ds_read_b128 v[28:31], v13
s_add_u32 m0, s59, 66560
v_mfma_f32_16x16x32_bf16 v[148:151], a[52:55], a[84:87], v[148:151]
ds_read_b128 v[32:35], v13 offset:64
s_mov_b32 s58, 0
v_mfma_f32_16x16x32_bf16 v[68:71], a[64:67], a[52:55], v[68:71]
ds_read_b128 v[36:39], v13 offset:256
v_mfma_f32_16x16x32_bf16 v[84:87], a[68:71], a[52:55], v[84:87]
ds_read_b128 v[40:43], v13 offset:320
v_mfma_f32_16x16x32_bf16 v[128:131], a[48:51], a[80:83], v[128:131]
ds_read_b32 v44, v12 offset:512
v_mfma_f32_16x16x32_bf16 v[144:147], a[48:51], a[84:87], v[144:147]
ds_read_b32 v45, v12 offset:576
v_mfma_f32_16x16x32_bf16 v[64:67], a[64:67], a[48:51], v[64:67]
ds_read_b128 v[240:243], v11 offset:704
v_mfma_f32_16x16x32_bf16 v[80:83], a[68:71], a[48:51], v[80:83]
ds_read_b128 v[244:247], v11 offset:1728
v_mfma_f32_16x16x32_bf16 v[124:127], a[44:47], a[80:83], v[124:127]
buffer_load_dwordx4 v5, s[24:27], s58 offen lds
ds_read_b128 v[18:21], v11 offset:448
s_waitcnt lgkmcnt(8)
v_pk_fma_f32 v[72:73], v[28:29], v[232:233], v[72:73] op_sel_hi:[1,0,1]
v_pk_fma_f32 v[74:75], v[30:31], v[232:233], v[74:75] op_sel_hi:[1,0,1]
s_waitcnt lgkmcnt(6)
v_pk_fma_f32 v[104:105], v[36:37], v[232:233], v[104:105] op_sel_hi:[1,0,1]
v_pk_mul_f32 v[104:105], v[104:105], v[232:233] op_sel:[0,1] op_sel_hi:[1,1]
v_pk_fma_f32 v[106:107], v[38:39], v[232:233], v[106:107] op_sel_hi:[1,0,1]
v_pk_mul_f32 v[106:107], v[106:107], v[232:233] op_sel:[0,1] op_sel_hi:[1,1]
s_waitcnt lgkmcnt(5)
v_pk_fma_f32 v[120:121], v[40:41], v[232:233], v[120:121] op_sel_hi:[1,0,1]
v_pk_mul_f32 v[120:121], v[120:121], v[232:233] op_sel:[0,1] op_sel_hi:[1,1]
v_pk_fma_f32 v[122:123], v[42:43], v[232:233], v[122:123] op_sel_hi:[1,0,1]
v_pk_mul_f32 v[122:123], v[122:123], v[232:233] op_sel:[0,1] op_sel_hi:[1,1]
v_pk_fma_f32 v[100:101], v[36:37], v[228:229], v[100:101] op_sel_hi:[1,0,1]
v_pk_mul_f32 v[100:101], v[100:101], v[228:229] op_sel:[0,1] op_sel_hi:[1,1]
v_pk_fma_f32 v[102:103], v[38:39], v[228:229], v[102:103] op_sel_hi:[1,0,1]
v_pk_mul_f32 v[102:103], v[102:103], v[228:229] op_sel:[0,1] op_sel_hi:[1,1]
v_pk_fma_f32 v[116:117], v[40:41], v[228:229], v[116:117] op_sel_hi:[1,0,1]
v_pk_mul_f32 v[116:117], v[116:117], v[228:229] op_sel:[0,1] op_sel_hi:[1,1]
v_pk_fma_f32 v[118:119], v[42:43], v[228:229], v[118:119] op_sel_hi:[1,0,1]
v_pk_mul_f32 v[118:119], v[118:119], v[228:229] op_sel:[0,1] op_sel_hi:[1,1]
s_waitcnt lgkmcnt(2)
v_pk_fma_f32 v[156:157], v[240:241], v[44:45], v[156:157] op_sel_hi:[1,0,1]
v_pk_fma_f32 v[158:159], v[242:243], v[44:45], v[158:159] op_sel_hi:[1,0,1]
v_pk_fma_f32 v[160:161], v[240:241], v[44:45], v[160:161] op_sel:[0,1,0] op_sel_hi:[1,1,1]
v_pk_fma_f32 v[162:163], v[242:243], v[44:45], v[162:163] op_sel:[0,1,0] op_sel_hi:[1,1,1]
s_waitcnt lgkmcnt(1)
v_pk_mul_f32 v[156:157], v[156:157], v[244:245]
v_pk_mul_f32 v[158:159], v[158:159], v[246:247]
v_pk_mul_f32 v[160:161], v[160:161], v[244:245]
v_pk_mul_f32 v[162:163], v[162:163], v[246:247]
v_pk_fma_f32 v[88:89], v[32:33], v[232:233], v[88:89] op_sel_hi:[1,0,1]
v_pk_fma_f32 v[90:91], v[34:35], v[232:233], v[90:91] op_sel_hi:[1,0,1]
v_pk_fma_f32 v[96:97], v[36:37], v[224:225], v[96:97] op_sel_hi:[1,0,1]
s_waitcnt lgkmcnt(0)
v_pk_fma_f32 v[136:137], v[18:19], v[44:45], v[136:137] op_sel_hi:[1,0,1]
v_pk_fma_f32 v[138:139], v[20:21], v[44:45], v[138:139] op_sel_hi:[1,0,1]
v_pk_fma_f32 v[152:153], v[18:19], v[44:45], v[152:153] op_sel:[0,1,0] op_sel_hi:[1,1,1]
v_pk_fma_f32 v[154:155], v[20:21], v[44:45], v[154:155] op_sel:[0,1,0] op_sel_hi:[1,1,1]
v_pk_mul_f32 v[96:97], v[96:97], v[224:225] op_sel:[0,1] op_sel_hi:[1,1]
v_pk_fma_f32 v[98:99], v[38:39], v[224:225], v[98:99] op_sel_hi:[1,0,1]
v_pk_mul_f32 v[98:99], v[98:99], v[224:225] op_sel:[0,1] op_sel_hi:[1,1]
v_pk_fma_f32 v[112:113], v[40:41], v[224:225], v[112:113] op_sel_hi:[1,0,1]
v_pk_mul_f32 v[112:113], v[112:113], v[224:225] op_sel:[0,1] op_sel_hi:[1,1]
v_pk_fma_f32 v[114:115], v[42:43], v[224:225], v[114:115] op_sel_hi:[1,0,1]
v_pk_mul_f32 v[114:115], v[114:115], v[224:225] op_sel:[0,1] op_sel_hi:[1,1]
v_pk_fma_f32 v[68:69], v[28:29], v[228:229], v[68:69] op_sel_hi:[1,0,1]
v_pk_fma_f32 v[70:71], v[30:31], v[228:229], v[70:71] op_sel_hi:[1,0,1]
v_pk_fma_f32 v[84:85], v[32:33], v[228:229], v[84:85] op_sel_hi:[1,0,1]
v_pk_fma_f32 v[86:87], v[34:35], v[228:229], v[86:87] op_sel_hi:[1,0,1]
v_pk_fma_f32 v[92:93], v[36:37], v[220:221], v[92:93] op_sel_hi:[1,0,1]
v_pk_mul_f32 v[92:93], v[92:93], v[220:221] op_sel:[0,1] op_sel_hi:[1,1]
v_pk_fma_f32 v[94:95], v[38:39], v[220:221], v[94:95] op_sel_hi:[1,0,1]
v_pk_mul_f32 v[94:95], v[94:95], v[220:221] op_sel:[0,1] op_sel_hi:[1,1]
v_pk_fma_f32 v[108:109], v[40:41], v[220:221], v[108:109] op_sel_hi:[1,0,1]
v_pk_mul_f32 v[108:109], v[108:109], v[220:221] op_sel:[0,1] op_sel_hi:[1,1]
v_pk_fma_f32 v[110:111], v[42:43], v[220:221], v[110:111] op_sel_hi:[1,0,1]
v_pk_mul_f32 v[110:111], v[110:111], v[220:221] op_sel:[0,1] op_sel_hi:[1,1]
v_pk_fma_f32 v[64:65], v[28:29], v[224:225], v[64:65] op_sel_hi:[1,0,1]
v_pk_fma_f32 v[66:67], v[30:31], v[224:225], v[66:67] op_sel_hi:[1,0,1]
v_pk_fma_f32 v[80:81], v[32:33], v[224:225], v[80:81] op_sel_hi:[1,0,1]
v_pk_fma_f32 v[82:83], v[34:35], v[224:225], v[82:83] op_sel_hi:[1,0,1]
v_cvt_pk_bf16_f32 v236, v156, v157
v_cvt_pk_bf16_f32 v237, v158, v159
v_mfma_f32_16x16x32_bf16 v[140:143], a[44:47], a[84:87], v[140:143]
buffer_load_dwordx4 v6, s[24:27], s58 offen offset:1024 lds
v_mfma_f32_16x16x32_bf16 v[60:63], a[64:67], a[44:47], v[60:63]
s_add_u32 m0, s59, 0
v_cvt_pk_bf16_f32 v238, v160, v161
v_cvt_pk_bf16_f32 v239, v162, v163
v_mfma_f32_16x16x32_bf16 v[76:79], a[68:71], a[44:47], v[76:79]
ds_write_b128 v8, v[236:239] offset:1024
s_mov_b32 s58, 1048576
v_cvt_pk_bf16_f32 v196, v104, v105
v_cvt_pk_bf16_f32 v197, v106, v107
v_cvt_pk_bf16_f32 v198, v120, v121
v_cvt_pk_bf16_f32 v199, v122, v123
ds_read_b128 v[22:25], v11 offset:1472
buffer_load_dwordx4 v5, s[24:27], s58 offen lds
v_cvt_pk_bf16_f32 v192, v100, v101
v_cvt_pk_bf16_f32 v193, v102, v103
v_cvt_pk_bf16_f32 v194, v116, v117
v_cvt_pk_bf16_f32 v195, v118, v119
v_cvt_pk_bf16_f32 v176, v72, v73
v_cvt_pk_bf16_f32 v177, v74, v75
v_cvt_pk_bf16_f32 v178, v88, v89
v_cvt_pk_bf16_f32 v179, v90, v91
v_pk_fma_f32 v[60:61], v[28:29], v[220:221], v[60:61] op_sel_hi:[1,0,1]
v_pk_fma_f32 v[62:63], v[30:31], v[220:221], v[62:63] op_sel_hi:[1,0,1]
v_pk_fma_f32 v[76:77], v[32:33], v[220:221], v[76:77] op_sel_hi:[1,0,1]
v_pk_fma_f32 v[78:79], v[34:35], v[220:221], v[78:79] op_sel_hi:[1,0,1]
ds_read_b128 v[240:243], v11 offset:384
s_nop 0
v_mfma_f32_16x16x32_bf16 v[104:107], v[192:195], v[176:179], v[46:49]
buffer_load_dwordx4 v6, s[24:27], s58 offen offset:1024 lds
v_mfma_f32_16x16x32_bf16 v[120:123], v[196:199], v[176:179], v[50:53]
.Lpad7:
s_cbranch_execz .Lnopoll8r
s_add_u32 m0, s59, 8320
s_waitcnt lgkmcnt(2)
s_barrier
ds_read_b128 v[180:183], v9
ds_read_b64 v[200:201], v9 offset:1024
ds_read_b64 v[210:211], v9 offset:1032
s_mov_b32 s58, 1179648
s_waitcnt lgkmcnt(4)
v_pk_mul_f32 v[136:137], v[136:137], v[22:23]
v_cvt_pk_bf16_f32 v208, v136, v137
v_pk_mul_f32 v[138:139], v[138:139], v[24:25]
buffer_load_dwordx4 v5, s[24:27], s58 offen lds
v_cvt_pk_bf16_f32 v209, v138, v139
v_pk_mul_f32 v[152:153], v[152:153], v[22:23]
v_cvt_pk_bf16_f32 v218, v152, v153
v_pk_mul_f32 v[154:155], v[154:155], v[24:25]
v_cvt_pk_bf16_f32 v219, v154, v155
ds_read_b128 v[244:247], v11 offset:1408
v_max3_f32 v88, v104, v105, v106
v_max3_f32 v89, v107, v120, v121
v_max3_f32 v88, v88, v122, v123
s_waitcnt lgkmcnt(4)
v_pk_fma_f32 v[132:133], v[240:241], v[44:45], v[132:133] op_sel_hi:[1,0,1]
v_pk_fma_f32 v[134:135], v[242:243], v[44:45], v[134:135] op_sel_hi:[1,0,1]
v_pk_fma_f32 v[148:149], v[240:241], v[44:45], v[148:149] op_sel:[0,1,0] op_sel_hi:[1,1,1]
buffer_load_dwordx4 v6, s[24:27], s58 offen offset:1024 lds
s_add_u32 m0, s59, 16640
s_mov_b32 s58, 1310720
v_pk_fma_f32 v[150:151], v[242:243], v[44:45], v[150:151] op_sel:[0,1,0] op_sel_hi:[1,1,1]
v_max_f32 v90, v88, v89
v_max_f32 v89, v88, v89
v_cvt_pk_bf16_f32 v188, v96, v97
v_cvt_pk_bf16_f32 v189, v98, v99
v_permlane16_swap_b32 v90, v89
v_cvt_pk_bf16_f32 v190, v112, v113
v_max_f32 v88, v90, v89
v_max_f32 v89, v90, v89
v_cvt_pk_bf16_f32 v191, v114, v115
buffer_load_dwordx4 v5, s[24:27], s58 offen lds
v_permlane32_swap_b32 v88, v89
v_cvt_pk_bf16_f32 v172, v68, v69
v_max_f32 v88, v88, v89
v_mul_f32 v88, v88, v234
s_waitcnt lgkmcnt(0)
v_pk_mul_f32 v[132:133], v[132:133], v[244:245]
v_cvt_pk_bf16_f32 v206, v132, v133
v_pk_mul_f32 v[134:135], v[134:135], v[246:247]
v_cvt_pk_bf16_f32 v207, v134, v135
v_pk_mul_f32 v[148:149], v[148:149], v[244:245]
v_cvt_pk_bf16_f32 v216, v148, v149
v_pk_mul_f32 v[150:151], v[150:151], v[246:247]
v_cvt_pk_bf16_f32 v217, v150, v151
buffer_load_dwordx4 v6, s[24:27], s58 offen offset:1024 lds
s_add_u32 m0, s59, 74880
s_mov_b32 s58, 131072
v_pk_fma_f32 v[104:105], v[104:105], v[234:235], v[88:89] op_sel_hi:[1,0,0] neg_lo:[0,0,1] neg_hi:[0,0,1]
v_pk_fma_f32 v[106:107], v[106:107], v[234:235], v[88:89] op_sel_hi:[1,0,0] neg_lo:[0,0,1] neg_hi:[0,0,1]
v_pk_fma_f32 v[120:121], v[120:121], v[234:235], v[88:89] op_sel_hi:[1,0,0] neg_lo:[0,0,1] neg_hi:[0,0,1]
v_pk_fma_f32 v[122:123], v[122:123], v[234:235], v[88:89] op_sel_hi:[1,0,0] neg_lo:[0,0,1] neg_hi:[0,0,1]
v_exp_f32 v104, v104
v_exp_f32 v105, v105
v_exp_f32 v106, v106
v_exp_f32 v107, v107
v_exp_f32 v120, v120
v_exp_f32 v121, v121
v_exp_f32 v122, v122
v_exp_f32 v123, v123
v_cvt_pk_bf16_f32 v72, v104, v105
buffer_load_dwordx4 v5, s[24:27], s58 offen lds
v_cvt_pk_bf16_f32 v73, v106, v107
v_cvt_pk_bf16_f32 v74, v120, v121
v_cvt_pk_bf16_f32 v75, v122, v123
v_cvt_pk_bf16_f32 v173, v70, v71
v_cvt_pk_bf16_f32 v174, v84, v85
v_mfma_f32_16x16x32_bf16 v[88:91], v[248:251], v[72:75], 0
ds_read_b128 v[18:21], v11 offset:320
v_cvt_pk_bf16_f32 v175, v86, v87
v_mfma_f32_16x16x32_bf16 v[104:107], v[206:209], v[72:75], 0
ds_read_b128 v[22:25], v11 offset:1344
v_cvt_pk_bf16_f32 v184, v92, v93
v_mfma_f32_16x16x32_bf16 v[120:123], v[216:219], v[72:75], 0
buffer_load_dwordx4 v6, s[24:27], s58 offen offset:1024 lds
v_mfma_f32_16x16x32_bf16 v[100:103], v[188:191], v[172:175], v[46:49]
s_add_u32 m0, s59, 83200
s_mov_b32 s58, 262144
v_rcp_f32 v88, v88
v_mfma_f32_16x16x32_bf16 v[116:119], v[192:195], v[172:175], v[50:53]
ds_read_b128 v[240:243], v11 offset:256
v_cvt_pk_bf16_f32 v185, v94, v95
s_nop 1
v_max3_f32 v84, v100, v101, v102
v_cvt_pk_bf16_f32 v186, v108, v109
v_cvt_pk_bf16_f32 v187, v110, v111
v_pk_mul_f32 v[104:105], v[104:105], v[88:89] op_sel_hi:[1,0]
buffer_load_dwordx4 v5, s[24:27], s58 offen lds
v_pk_mul_f32 v[106:107], v[106:107], v[88:89] op_sel_hi:[1,0]
v_pk_mul_f32 v[120:121], v[120:121], v[88:89] op_sel_hi:[1,0]
v_pk_mul_f32 v[122:123], v[122:123], v[88:89] op_sel_hi:[1,0]
v_cvt_pk_bf16_f32 v176, v104, v105
v_cvt_pk_bf16_f32 v177, v106, v107
v_cvt_pk_bf16_f32 v178, v120, v121
v_cvt_pk_bf16_f32 v179, v122, v123
s_waitcnt lgkmcnt(2)
v_pk_fma_f32 v[128:129], v[18:19], v[44:45], v[128:129] op_sel_hi:[1,0,1]
v_pk_fma_f32 v[130:131], v[20:21], v[44:45], v[130:131] op_sel_hi:[1,0,1]
s_waitcnt lgkmcnt(1)
v_pk_mul_f32 v[128:129], v[128:129], v[22:23]
v_cvt_pk_bf16_f32 v204, v128, v129
v_pk_mul_f32 v[130:131], v[130:131], v[24:25]
v_cvt_pk_bf16_f32 v205, v130, v131
buffer_load_dwordx4 v6, s[24:27], s58 offen offset:1024 lds
v_pk_fma_f32 v[144:145], v[18:19], v[44:45], v[144:145] op_sel:[0,1,0] op_sel_hi:[1,1,1]
v_pk_mul_f32 v[144:145], v[144:145], v[22:23]
v_cvt_pk_bf16_f32 v214, v144, v145
v_pk_fma_f32 v[146:147], v[20:21], v[44:45], v[146:147] op_sel:[0,1,0] op_sel_hi:[1,1,1]
v_pk_mul_f32 v[146:147], v[146:147], v[24:25]
v_cvt_pk_bf16_f32 v215, v146, v147
v_max3_f32 v85, v103, v116, v117
v_max3_f32 v84, v84, v118, v119
v_max_f32 v86, v84, v85
v_max_f32 v85, v84, v85
v_cvt_pk_bf16_f32 v168, v64, v65
v_cvt_pk_bf16_f32 v169, v66, v67
v_permlane16_swap_b32 v86, v85
v_cvt_pk_bf16_f32 v170, v80, v81
buffer_store_dwordx4 v[176:179], v4, s[16:19], s74 offen offset:3072 sc1
v_max_f32 v84, v86, v85
v_max_f32 v85, v86, v85
v_cvt_pk_bf16_f32 v171, v82, v83
s_waitcnt lgkmcnt(0)
v_pk_fma_f32 v[124:125], v[240:241], v[44:45], v[124:125] op_sel_hi:[1,0,1]
v_pk_fma_f32 v[126:127], v[242:243], v[44:45], v[126:127] op_sel_hi:[1,0,1]
v_pk_fma_f32 v[140:141], v[240:241], v[44:45], v[140:141] op_sel:[0,1,0] op_sel_hi:[1,1,1]
v_pk_fma_f32 v[142:143], v[242:243], v[44:45], v[142:143] op_sel:[0,1,0] op_sel_hi:[1,1,1]
v_permlane32_swap_b32 v84, v85
s_nop 0
v_mfma_f32_16x16x32_bf16 v[96:99], v[184:187], v[168:171], v[46:49]
ds_read_b128 v[244:247], v11 offset:1280
v_max_f32 v84, v84, v85
v_mfma_f32_16x16x32_bf16 v[112:115], v[188:191], v[168:171], v[50:53]
v_mul_f32 v84, v84, v230
v_cvt_pk_bf16_f32 v164, v60, v61
v_cvt_pk_bf16_f32 v165, v62, v63
s_nop 1
v_max3_f32 v80, v96, v97, v98
v_cvt_pk_bf16_f32 v166, v76, v77
v_pk_fma_f32 v[100:101], v[100:101], v[230:231], v[84:85] op_sel_hi:[1,0,0] neg_lo:[0,0,1] neg_hi:[0,0,1]
v_pk_fma_f32 v[102:103], v[102:103], v[230:231], v[84:85] op_sel_hi:[1,0,0] neg_lo:[0,0,1] neg_hi:[0,0,1]
v_pk_fma_f32 v[116:117], v[116:117], v[230:231], v[84:85] op_sel_hi:[1,0,0] neg_lo:[0,0,1] neg_hi:[0,0,1]
v_pk_fma_f32 v[118:119], v[118:119], v[230:231], v[84:85] op_sel_hi:[1,0,0] neg_lo:[0,0,1] neg_hi:[0,0,1]
v_exp_f32 v100, v100
v_exp_f32 v101, v101
v_exp_f32 v102, v102
v_exp_f32 v103, v103
v_exp_f32 v116, v116
v_exp_f32 v117, v117
v_exp_f32 v118, v118
v_exp_f32 v119, v119
v_cvt_pk_bf16_f32 v68, v100, v101
v_cvt_pk_bf16_f32 v69, v102, v103
v_cvt_pk_bf16_f32 v70, v116, v117
v_cvt_pk_bf16_f32 v71, v118, v119
s_waitcnt lgkmcnt(0)
v_pk_mul_f32 v[124:125], v[124:125], v[244:245]
v_pk_mul_f32 v[126:127], v[126:127], v[246:247]
v_pk_mul_f32 v[140:141], v[140:141], v[244:245]
v_pk_mul_f32 v[142:143], v[142:143], v[246:247]
v_cvt_pk_bf16_f32 v202, v124, v125
v_cvt_pk_bf16_f32 v203, v126, v127
v_mfma_f32_16x16x32_bf16 v[84:87], v[248:251], v[68:71], 0
v_cvt_pk_bf16_f32 v212, v140, v141
v_cvt_pk_bf16_f32 v213, v142, v143
v_mfma_f32_16x16x32_bf16 v[100:103], v[204:207], v[68:71], 0
v_max3_f32 v81, v99, v112, v113
v_max3_f32 v80, v80, v114, v115
v_mfma_f32_16x16x32_bf16 v[116:119], v[214:217], v[68:71], 0
s_nop 1
v_rcp_f32 v84, v84
v_max_f32 v82, v80, v81
v_max_f32 v81, v80, v81
v_cvt_pk_bf16_f32 v167, v78, v79
v_pk_mul_f32 v[100:101], v[100:101], v[84:85] op_sel_hi:[1,0]
v_pk_mul_f32 v[102:103], v[102:103], v[84:85] op_sel_hi:[1,0]
v_pk_mul_f32 v[116:117], v[116:117], v[84:85] op_sel_hi:[1,0]
v_pk_mul_f32 v[118:119], v[118:119], v[84:85] op_sel_hi:[1,0]
v_permlane16_swap_b32 v82, v81
s_nop 0
v_mfma_f32_16x16x32_bf16 v[92:95], v[180:183], v[164:167], v[46:49]
v_cvt_pk_bf16_f32 v172, v100, v101
v_cvt_pk_bf16_f32 v173, v102, v103
v_mfma_f32_16x16x32_bf16 v[108:111], v[184:187], v[164:167], v[50:53]
v_cvt_pk_bf16_f32 v174, v116, v117
v_cvt_pk_bf16_f32 v175, v118, v119
buffer_store_dwordx4 v[172:175], v4, s[16:19], s74 offen offset:2048 sc1
v_max_f32 v80, v82, v81
v_max_f32 v81, v82, v81
v_max3_f32 v76, v92, v93, v94
s_nop 1
v_max3_f32 v77, v95, v108, v109
v_permlane32_swap_b32 v80, v81
v_max3_f32 v76, v76, v110, v111
v_max_f32 v80, v80, v81
v_mul_f32 v80, v80, v226
v_pk_fma_f32 v[96:97], v[96:97], v[226:227], v[80:81] op_sel_hi:[1,0,0] neg_lo:[0,0,1] neg_hi:[0,0,1]
v_pk_fma_f32 v[98:99], v[98:99], v[226:227], v[80:81] op_sel_hi:[1,0,0] neg_lo:[0,0,1] neg_hi:[0,0,1]
v_pk_fma_f32 v[112:113], v[112:113], v[226:227], v[80:81] op_sel_hi:[1,0,0] neg_lo:[0,0,1] neg_hi:[0,0,1]
v_pk_fma_f32 v[114:115], v[114:115], v[226:227], v[80:81] op_sel_hi:[1,0,0] neg_lo:[0,0,1] neg_hi:[0,0,1]
v_exp_f32 v96, v96
v_exp_f32 v97, v97
v_exp_f32 v98, v98
v_exp_f32 v99, v99
v_exp_f32 v112, v112
v_exp_f32 v113, v113
v_exp_f32 v114, v114
v_exp_f32 v115, v115
v_cvt_pk_bf16_f32 v64, v96, v97
v_cvt_pk_bf16_f32 v65, v98, v99
v_cvt_pk_bf16_f32 v66, v112, v113
v_cvt_pk_bf16_f32 v67, v114, v115
v_max_f32 v78, v76, v77
v_max_f32 v77, v76, v77
v_mfma_f32_16x16x32_bf16 v[80:83], v[248:251], v[64:67], 0
s_nop 0
v_permlane16_swap_b32 v78, v77
v_mfma_f32_16x16x32_bf16 v[96:99], v[202:205], v[64:67], 0
v_max_f32 v76, v78, v77
v_max_f32 v77, v78, v77
v_mfma_f32_16x16x32_bf16 v[112:115], v[212:215], v[64:67], 0
s_nop 1
v_rcp_f32 v80, v80
v_permlane32_swap_b32 v76, v77
s_nop 0
v_pk_mul_f32 v[96:97], v[96:97], v[80:81] op_sel_hi:[1,0]
v_pk_mul_f32 v[98:99], v[98:99], v[80:81] op_sel_hi:[1,0]
s_nop 0
v_pk_mul_f32 v[112:113], v[112:113], v[80:81] op_sel_hi:[1,0]
v_pk_mul_f32 v[114:115], v[114:115], v[80:81] op_sel_hi:[1,0]
v_cvt_pk_bf16_f32 v168, v96, v97
v_cvt_pk_bf16_f32 v169, v98, v99
v_cvt_pk_bf16_f32 v170, v112, v113
v_cvt_pk_bf16_f32 v171, v114, v115
buffer_store_dwordx4 v[168:171], v4, s[16:19], s74 offen offset:1024 sc1
v_max_f32 v76, v76, v77
v_mul_f32 v76, v76, v222
v_pk_fma_f32 v[92:93], v[92:93], v[222:223], v[76:77] op_sel_hi:[1,0,0] neg_lo:[0,0,1] neg_hi:[0,0,1]
v_pk_fma_f32 v[94:95], v[94:95], v[222:223], v[76:77] op_sel_hi:[1,0,0] neg_lo:[0,0,1] neg_hi:[0,0,1]
v_pk_fma_f32 v[108:109], v[108:109], v[222:223], v[76:77] op_sel_hi:[1,0,0] neg_lo:[0,0,1] neg_hi:[0,0,1]
v_pk_fma_f32 v[110:111], v[110:111], v[222:223], v[76:77] op_sel_hi:[1,0,0] neg_lo:[0,0,1] neg_hi:[0,0,1]
v_exp_f32 v92, v92
v_exp_f32 v93, v93
v_exp_f32 v94, v94
v_exp_f32 v95, v95
v_exp_f32 v108, v108
v_exp_f32 v109, v109
v_exp_f32 v110, v110
v_exp_f32 v111, v111
v_cvt_pk_bf16_f32 v60, v92, v93
v_cvt_pk_bf16_f32 v61, v94, v95
v_cvt_pk_bf16_f32 v62, v108, v109
v_cvt_pk_bf16_f32 v63, v110, v111
s_nop 1
v_mfma_f32_16x16x32_bf16 v[76:79], v[248:251], v[60:63], 0
v_mfma_f32_16x16x32_bf16 v[92:95], v[200:203], v[60:63], 0
v_mfma_f32_16x16x32_bf16 v[108:111], v[210:213], v[60:63], 0
s_nop 5
v_rcp_f32 v76, v76
s_nop 0
v_pk_mul_f32 v[92:93], v[92:93], v[76:77] op_sel_hi:[1,0]
v_pk_mul_f32 v[94:95], v[94:95], v[76:77] op_sel_hi:[1,0]
v_pk_mul_f32 v[108:109], v[108:109], v[76:77] op_sel_hi:[1,0]
v_pk_mul_f32 v[110:111], v[110:111], v[76:77] op_sel_hi:[1,0]
v_cvt_pk_bf16_f32 v164, v92, v93
v_cvt_pk_bf16_f32 v165, v94, v95
v_cvt_pk_bf16_f32 v166, v108, v109
v_cvt_pk_bf16_f32 v167, v110, v111
buffer_store_dwordx4 v[164:167], v4, s[16:19], s74 offen sc1
s_nop 1
.Lqkve10:
.Lpad8:
s_cbranch_execz .Lnopoll8r
s_lshl_b32 s62, s6, 13
s_lshl_b32 s63, s3, 11
s_add_u32 s62, s62, s63
v_lshl_add_u32 v4, v1, 4, s62
v_lshrrev_b32 v2, 3, v1
v_cmp_eq_u32 vcc, 3, v2
v_add_u32 v2, 67108480, v4
s_nop 0
v_cndmask_b32 v4, v4, v2, vcc
v_bfe_u32 v5, v1, 3, 1
v_lshrrev_b32 v2, 4, v1
v_lshl_add_u32 v5, v2, 3, v5
s_lshl_b32 s62, s3, 1
v_add_u32 v5, s62, v5
v_mul_u32_u24 v5, 2048, v5
v_and_b32 v2, 7, v1
v_lshl_add_u32 v5, v2, 4, v5
s_lshl_b32 s62, s7, 7
v_add_u32 v5, s62, v5
v_add_u32 v6, 64512, v5
v_bfe_u32 v8, v1, 3, 2
v_mul_u32_u24 v8, 2080, v8
v_bfe_u32 v2, v1, 2, 1
v_lshl_add_u32 v8, v2, 7, v8
v_bfe_u32 v2, v1, 5, 1
v_lshl_add_u32 v8, v2, 8, v8
v_and_b32 v2, 3, v1
v_lshl_add_u32 v8, v2, 3, v8
s_mov_b32 s57, 66560
v_add_u32 v7, s57, v8
s_mov_b32 s52, 4194304
s_mov_b32 s53, 4325376
s_mov_b32 s54, 2097152
s_mul_i32 s56, s3, 2080
v_accvgpr_read_b32 v32, a224
v_accvgpr_read_b32 v33, a225
v_accvgpr_read_b32 v34, a226
v_accvgpr_read_b32 v35, a227
v_accvgpr_read_b32 v36, a228
v_accvgpr_read_b32 v37, a229
v_accvgpr_read_b32 v38, a230
v_accvgpr_read_b32 v39, a231
v_accvgpr_read_b32 v40, a232
v_accvgpr_read_b32 v41, a233
v_accvgpr_read_b32 v42, a234
v_accvgpr_read_b32 v43, a235
v_accvgpr_read_b32 v44, a236
v_accvgpr_read_b32 v45, a237
v_accvgpr_read_b32 v46, a238
v_accvgpr_read_b32 v47, a239
v_accvgpr_read_b32 v48, a240
v_accvgpr_read_b32 v49, a241
v_accvgpr_read_b32 v50, a242
v_accvgpr_read_b32 v51, a243
v_accvgpr_read_b32 v52, a244
v_accvgpr_read_b32 v53, a245
v_accvgpr_read_b32 v54, a246
v_accvgpr_read_b32 v55, a247
v_accvgpr_read_b32 v56, a248
v_accvgpr_read_b32 v57, a249
v_accvgpr_read_b32 v58, a250
v_accvgpr_read_b32 v59, a251
v_accvgpr_read_b32 v60, a252
v_accvgpr_read_b32 v61, a253
v_accvgpr_read_b32 v62, a254
v_accvgpr_read_b32 v63, a255
s_and_b32 s62, s3, 1
s_mul_i32 s62, s62, 28672
s_add_u32 s62, s62, s51
v_lshrrev_b32 v12, 4, v1
v_mul_u32_u24 v12, 57344, v12
v_and_b32 v2, 15, v1
v_lshl_add_u32 v12, v2, 4, v12
v_add_u32 v12, s62, v12
v_add_u32 v13, 6112, v12
v_add_u32 v14, 12224, v12
v_add_u32 v15, 18336, v12
s_mul_i32 s59, s3, 4224
s_mov_b32 s58, 0
s_lshl_b32 s62, s8, 7
s_add_u32 s62, s62, 30410752
s_lshl_b32 s64, s6, 7
s_add_u32 s64, s64, 30410752
v_mov_b32 v252, s62
v_mov_b32 v253, s64
s_waitcnt vmcnt(0) lgkmcnt(0)
s_barrier
s_cmp_lg_u32 s3, 0
s_cbranch_scc1 .Lnosig19
v_mov_b32 v255, 1
s_mov_b64 exec, 1
buffer_atomic_add v255, v252, s[16:19], 0 offen
s_mov_b64 exec, -1
.Lnosig19:
ds_read_b64_tr_b16 a[0:1], v7
ds_read_b64_tr_b16 a[2:3], v7 offset:512
ds_read_b64_tr_b16 a[4:5], v7 offset:32
ds_read_b64_tr_b16 a[6:7], v7 offset:544
ds_read_b64_tr_b16 a[8:9], v7 offset:64
ds_read_b64_tr_b16 a[10:11], v7 offset:576
ds_read_b64_tr_b16 a[12:13], v7 offset:96
ds_read_b64_tr_b16 a[14:15], v7 offset:608
ds_read_b64_tr_b16 a[16:17], v7 offset:1024
ds_read_b64_tr_b16 a[18:19], v7 offset:1536
ds_read_b64_tr_b16 a[20:21], v7 offset:1056
ds_read_b64_tr_b16 a[22:23], v7 offset:1568
ds_read_b64_tr_b16 a[24:25], v7 offset:1088
ds_read_b64_tr_b16 a[26:27], v7 offset:1600
ds_read_b64_tr_b16 a[28:29], v7 offset:1120
ds_read_b64_tr_b16 a[30:31], v7 offset:1632
s_waitcnt lgkmcnt(0)
s_cmp_lg_u32 s3, 1
s_cbranch_scc1 .Lnopoll22
s_mov_b64 exec, 1
s_mov_b32 s15, 0
.Lpoll20:
buffer_load_dword v255, v253, s[16:19], 0 offen sc1
s_add_u32 s15, s15, 1
s_cmp_gt_u32 s15, 100000
s_cbranch_scc1 .Lgot21
s_waitcnt vmcnt(0)
v_cmp_ne_u32 vcc, 16, v255
s_nop 0
s_cbranch_vccnz .Lpoll20
.Lgot21:
s_waitcnt vmcnt(0)
s_branch .Lnopoll22r
.Lnopoll22:
s_mov_b64 exec, 0
s_cmp_eq_u32 s3, 2
s_cbranch_scc1 .Lpad9
s_cmp_eq_u32 s3, 3
s_cbranch_scc1 .Lpad10
s_branch .Lnopoll22r
.Lnopoll22r:
s_mov_b64 exec, -1
s_barrier
buffer_load_dwordx4 v[64:67], v4, s[16:19], s52 offen sc1
buffer_load_dwordx4 v[68:71], v4, s[16:19], s52 offen offset:1024 sc1
s_add_u32 s52, s52, 0x40000
buffer_load_dwordx4 v[72:75], v4, s[16:19], s53 offen sc1
buffer_load_dwordx4 v[76:79], v4, s[16:19], s53 offen offset:1024 sc1
s_add_u32 s53, s53, 0x40000
buffer_load_dwordx4 v[80:83], v4, s[16:19], s52 offen sc1
buffer_load_dwordx4 v[84:87], v4, s[16:19], s52 offen offset:1024 sc1
s_add_u32 s52, s52, 0x40000
buffer_load_dwordx4 v[88:91], v4, s[16:19], s53 offen sc1
buffer_load_dwordx4 v[92:95], v4, s[16:19], s53 offen offset:1024 sc1
s_add_u32 s53, s53, 0x40000
buffer_load_dwordx4 v[96:99], v4, s[16:19], s52 offen sc1
buffer_load_dwordx4 v[100:103], v4, s[16:19], s52 offen offset:1024 sc1
s_add_u32 s52, s52, 0x40000
buffer_load_dwordx4 v[104:107], v4, s[16:19], s53 offen sc1
buffer_load_dwordx4 v[108:111], v4, s[16:19], s53 offen offset:1024 sc1
s_add_u32 s53, s53, 0x40000
s_waitcnt vmcnt(11)
v_mfma_f32_16x16x32_bf16 v[32:35], a[0:3], v[64:67], v[32:35]
ds_read_b64_tr_b16 a[32:33], v7 offset:8320
ds_read_b64_tr_b16 a[34:35], v7 offset:8832
s_waitcnt vmcnt(10)
v_mfma_f32_16x16x32_bf16 v[48:51], a[0:3], v[68:71], v[48:51]
buffer_load_dwordx4 v[112:115], v4, s[16:19], s52 offen sc1
v_mfma_f32_16x16x32_bf16 v[36:39], a[4:7], v[64:67], v[36:39]
ds_read_b64_tr_b16 a[36:37], v7 offset:8352
ds_read_b64_tr_b16 a[38:39], v7 offset:8864
v_mfma_f32_16x16x32_bf16 v[52:55], a[4:7], v[68:71], v[52:55]
ds_read_b64_tr_b16 a[40:41], v7 offset:8384
ds_read_b64_tr_b16 a[42:43], v7 offset:8896
v_mfma_f32_16x16x32_bf16 v[40:43], a[8:11], v[64:67], v[40:43]
buffer_load_dwordx4 v[116:119], v4, s[16:19], s52 offen offset:1024 sc1
v_mfma_f32_16x16x32_bf16 v[56:59], a[8:11], v[68:71], v[56:59]
ds_read_b64_tr_b16 a[44:45], v7 offset:8416
s_add_u32 s52, s52, 0x40000
v_mfma_f32_16x16x32_bf16 v[44:47], a[12:15], v[64:67], v[44:47]
ds_read_b64_tr_b16 a[46:47], v7 offset:8928
v_mfma_f32_16x16x32_bf16 v[60:63], a[12:15], v[68:71], v[60:63]
ds_read_b64_tr_b16 a[48:49], v7 offset:9344
ds_read_b64_tr_b16 a[50:51], v7 offset:9856
s_waitcnt vmcnt(11)
v_mfma_f32_16x16x32_bf16 v[32:35], a[16:19], v[72:75], v[32:35]
buffer_load_dwordx4 v[120:123], v4, s[16:19], s53 offen sc1
s_waitcnt vmcnt(11)
v_mfma_f32_16x16x32_bf16 v[48:51], a[16:19], v[76:79], v[48:51]
ds_read_b64_tr_b16 a[52:53], v7 offset:9376
ds_read_b64_tr_b16 a[54:55], v7 offset:9888
v_mfma_f32_16x16x32_bf16 v[36:39], a[20:23], v[72:75], v[36:39]
ds_read_b64_tr_b16 a[56:57], v7 offset:9408
ds_read_b64_tr_b16 a[58:59], v7 offset:9920
v_mfma_f32_16x16x32_bf16 v[52:55], a[20:23], v[76:79], v[52:55]
buffer_load_dwordx4 v[124:127], v4, s[16:19], s53 offen offset:1024 sc1
v_mfma_f32_16x16x32_bf16 v[40:43], a[24:27], v[72:75], v[40:43]
ds_read_b64_tr_b16 a[60:61], v7 offset:9440
s_add_u32 s53, s53, 0x40000
v_mfma_f32_16x16x32_bf16 v[56:59], a[24:27], v[76:79], v[56:59]
ds_read_b64_tr_b16 a[62:63], v7 offset:9952
v_mfma_f32_16x16x32_bf16 v[44:47], a[28:31], v[72:75], v[44:47]
v_mfma_f32_16x16x32_bf16 v[60:63], a[28:31], v[76:79], v[60:63]
s_waitcnt vmcnt(11) lgkmcnt(14)
v_mfma_f32_16x16x32_bf16 v[32:35], a[32:35], v[80:83], v[32:35]
ds_read_b64_tr_b16 a[0:1], v7 offset:16640
ds_read_b64_tr_b16 a[2:3], v7 offset:17152
s_waitcnt vmcnt(10)
v_mfma_f32_16x16x32_bf16 v[48:51], a[32:35], v[84:87], v[48:51]
buffer_load_dwordx4 v[64:67], v4, s[16:19], s52 offen sc1
s_waitcnt lgkmcnt(14)
v_mfma_f32_16x16x32_bf16 v[36:39], a[36:39], v[80:83], v[36:39]
ds_read_b64_tr_b16 a[4:5], v7 offset:16672
ds_read_b64_tr_b16 a[6:7], v7 offset:17184
v_mfma_f32_16x16x32_bf16 v[52:55], a[36:39], v[84:87], v[52:55]
ds_read_b64_tr_b16 a[8:9], v7 offset:16704
ds_read_b64_tr_b16 a[10:11], v7 offset:17216
s_waitcnt lgkmcnt(15)
v_mfma_f32_16x16x32_bf16 v[40:43], a[40:43], v[80:83], v[40:43]
buffer_load_dwordx4 v[68:71], v4, s[16:19], s52 offen offset:1024 sc1
v_mfma_f32_16x16x32_bf16 v[56:59], a[40:43], v[84:87], v[56:59]
ds_read_b64_tr_b16 a[12:13], v7 offset:16736
s_add_u32 s52, s52, 0x40000
s_waitcnt lgkmcnt(15)
v_mfma_f32_16x16x32_bf16 v[44:47], a[44:47], v[80:83], v[44:47]
ds_read_b64_tr_b16 a[14:15], v7 offset:17248
v_mfma_f32_16x16x32_bf16 v[60:63], a[44:47], v[84:87], v[60:63]
ds_read_b64_tr_b16 a[16:17], v7 offset:17664
ds_read_b64_tr_b16 a[18:19], v7 offset:18176
s_waitcnt vmcnt(11) lgkmcnt(15)
v_mfma_f32_16x16x32_bf16 v[32:35], a[48:51], v[88:91], v[32:35]
buffer_load_dwordx4 v[72:75], v4, s[16:19], s53 offen sc1
s_waitcnt vmcnt(11)
v_mfma_f32_16x16x32_bf16 v[48:51], a[48:51], v[92:95], v[48:51]
ds_read_b64_tr_b16 a[20:21], v7 offset:17696
ds_read_b64_tr_b16 a[22:23], v7 offset:18208
s_waitcnt lgkmcnt(15)
v_mfma_f32_16x16x32_bf16 v[36:39], a[52:55], v[88:91], v[36:39]
ds_read_b64_tr_b16 a[24:25], v7 offset:17728
ds_read_b64_tr_b16 a[26:27], v7 offset:18240
v_mfma_f32_16x16x32_bf16 v[52:55], a[52:55], v[92:95], v[52:55]
buffer_load_dwordx4 v[76:79], v4, s[16:19], s53 offen offset:1024 sc1
s_waitcnt lgkmcnt(15)
v_mfma_f32_16x16x32_bf16 v[40:43], a[56:59], v[88:91], v[40:43]
ds_read_b64_tr_b16 a[28:29], v7 offset:17760
s_add_u32 s53, s53, 0x40000
v_mfma_f32_16x16x32_bf16 v[56:59], a[56:59], v[92:95], v[56:59]
ds_read_b64_tr_b16 a[30:31], v7 offset:18272
s_waitcnt lgkmcnt(15)
v_mfma_f32_16x16x32_bf16 v[44:47], a[60:63], v[88:91], v[44:47]
v_mfma_f32_16x16x32_bf16 v[60:63], a[60:63], v[92:95], v[60:63]
s_waitcnt vmcnt(11) lgkmcnt(14)
v_mfma_f32_16x16x32_bf16 v[32:35], a[0:3], v[96:99], v[32:35]
ds_read_b64_tr_b16 a[32:33], v7 offset:24960
ds_read_b64_tr_b16 a[34:35], v7 offset:25472
s_waitcnt vmcnt(10)
v_mfma_f32_16x16x32_bf16 v[48:51], a[0:3], v[100:103], v[48:51]
buffer_load_dwordx4 v[80:83], v4, s[16:19], s52 offen sc1
s_waitcnt lgkmcnt(14)
v_mfma_f32_16x16x32_bf16 v[36:39], a[4:7], v[96:99], v[36:39]
ds_read_b64_tr_b16 a[36:37], v7 offset:24992
ds_read_b64_tr_b16 a[38:39], v7 offset:25504
v_mfma_f32_16x16x32_bf16 v[52:55], a[4:7], v[100:103], v[52:55]
ds_read_b64_tr_b16 a[40:41], v7 offset:25024
ds_read_b64_tr_b16 a[42:43], v7 offset:25536
s_waitcnt lgkmcnt(15)
v_mfma_f32_16x16x32_bf16 v[40:43], a[8:11], v[96:99], v[40:43]
buffer_load_dwordx4 v[84:87], v4, s[16:19], s52 offen offset:1024 sc1
v_mfma_f32_16x16x32_bf16 v[56:59], a[8:11], v[100:103], v[56:59]
ds_read_b64_tr_b16 a[44:45], v7 offset:25056
s_add_u32 s52, s52, 0x40000
s_waitcnt lgkmcnt(15)
v_mfma_f32_16x16x32_bf16 v[44:47], a[12:15], v[96:99], v[44:47]
ds_read_b64_tr_b16 a[46:47], v7 offset:25568
v_mfma_f32_16x16x32_bf16 v[60:63], a[12:15], v[100:103], v[60:63]
ds_read_b64_tr_b16 a[48:49], v7 offset:25984
ds_read_b64_tr_b16 a[50:51], v7 offset:26496
s_waitcnt vmcnt(11) lgkmcnt(15)
v_mfma_f32_16x16x32_bf16 v[32:35], a[16:19], v[104:107], v[32:35]
buffer_load_dwordx4 v[88:91], v4, s[16:19], s53 offen sc1
s_waitcnt vmcnt(11)
v_mfma_f32_16x16x32_bf16 v[48:51], a[16:19], v[108:111], v[48:51]
ds_read_b64_tr_b16 a[52:53], v7 offset:26016
ds_read_b64_tr_b16 a[54:55], v7 offset:26528
s_waitcnt lgkmcnt(15)
v_mfma_f32_16x16x32_bf16 v[36:39], a[20:23], v[104:107], v[36:39]
ds_read_b64_tr_b16 a[56:57], v7 offset:26048
ds_read_b64_tr_b16 a[58:59], v7 offset:26560
v_mfma_f32_16x16x32_bf16 v[52:55], a[20:23], v[108:111], v[52:55]
buffer_load_dwordx4 v[92:95], v4, s[16:19], s53 offen offset:1024 sc1
s_waitcnt lgkmcnt(15)
v_mfma_f32_16x16x32_bf16 v[40:43], a[24:27], v[104:107], v[40:43]
ds_read_b64_tr_b16 a[60:61], v7 offset:26080
s_add_u32 s53, s53, 0x40000
v_mfma_f32_16x16x32_bf16 v[56:59], a[24:27], v[108:111], v[56:59]
ds_read_b64_tr_b16 a[62:63], v7 offset:26592
s_waitcnt lgkmcnt(15)
v_mfma_f32_16x16x32_bf16 v[44:47], a[28:31], v[104:107], v[44:47]
v_mfma_f32_16x16x32_bf16 v[60:63], a[28:31], v[108:111], v[60:63]
s_waitcnt vmcnt(11) lgkmcnt(14)
v_mfma_f32_16x16x32_bf16 v[32:35], a[32:35], v[112:115], v[32:35]
ds_read_b64_tr_b16 a[0:1], v7 offset:33280
ds_read_b64_tr_b16 a[2:3], v7 offset:33792
s_waitcnt vmcnt(10)
v_mfma_f32_16x16x32_bf16 v[48:51], a[32:35], v[116:119], v[48:51]
buffer_load_dwordx4 v[96:99], v4, s[16:19], s52 offen sc1
s_waitcnt lgkmcnt(14)
v_mfma_f32_16x16x32_bf16 v[36:39], a[36:39], v[112:115], v[36:39]
ds_read_b64_tr_b16 a[4:5], v7 offset:33312
ds_read_b64_tr_b16 a[6:7], v7 offset:33824
v_mfma_f32_16x16x32_bf16 v[52:55], a[36:39], v[116:119], v[52:55]
ds_read_b64_tr_b16 a[8:9], v7 offset:33344
ds_read_b64_tr_b16 a[10:11], v7 offset:33856
s_waitcnt lgkmcnt(15)
v_mfma_f32_16x16x32_bf16 v[40:43], a[40:43], v[112:115], v[40:43]
buffer_load_dwordx4 v[100:103], v4, s[16:19], s52 offen offset:1024 sc1
v_mfma_f32_16x16x32_bf16 v[56:59], a[40:43], v[116:119], v[56:59]
ds_read_b64_tr_b16 a[12:13], v7 offset:33376
s_add_u32 s52, s52, 0x40000
s_waitcnt lgkmcnt(15)
v_mfma_f32_16x16x32_bf16 v[44:47], a[44:47], v[112:115], v[44:47]
ds_read_b64_tr_b16 a[14:15], v7 offset:33888
v_mfma_f32_16x16x32_bf16 v[60:63], a[44:47], v[116:119], v[60:63]
ds_read_b64_tr_b16 a[16:17], v7 offset:34304
ds_read_b64_tr_b16 a[18:19], v7 offset:34816
s_waitcnt vmcnt(11) lgkmcnt(15)
v_mfma_f32_16x16x32_bf16 v[32:35], a[48:51], v[120:123], v[32:35]
buffer_load_dwordx4 v[104:107], v4, s[16:19], s53 offen sc1
s_waitcnt vmcnt(11)
v_mfma_f32_16x16x32_bf16 v[48:51], a[48:51], v[124:127], v[48:51]
ds_read_b64_tr_b16 a[20:21], v7 offset:34336
ds_read_b64_tr_b16 a[22:23], v7 offset:34848
s_waitcnt lgkmcnt(15)
.Lpad9:
s_cbranch_execz .Lnopoll22r
v_mfma_f32_16x16x32_bf16 v[36:39], a[52:55], v[120:123], v[36:39]
ds_read_b64_tr_b16 a[24:25], v7 offset:34368
ds_read_b64_tr_b16 a[26:27], v7 offset:34880
v_mfma_f32_16x16x32_bf16 v[52:55], a[52:55], v[124:127], v[52:55]
buffer_load_dwordx4 v[108:111], v4, s[16:19], s53 offen offset:1024 sc1
s_waitcnt lgkmcnt(15)
v_mfma_f32_16x16x32_bf16 v[40:43], a[56:59], v[120:123], v[40:43]
ds_read_b64_tr_b16 a[28:29], v7 offset:34400
s_add_u32 s53, s53, 0x40000
v_mfma_f32_16x16x32_bf16 v[56:59], a[56:59], v[124:127], v[56:59]
ds_read_b64_tr_b16 a[30:31], v7 offset:34912
s_waitcnt lgkmcnt(15)
v_mfma_f32_16x16x32_bf16 v[44:47], a[60:63], v[120:123], v[44:47]
v_mfma_f32_16x16x32_bf16 v[60:63], a[60:63], v[124:127], v[60:63]
s_waitcnt vmcnt(11) lgkmcnt(14)
v_mfma_f32_16x16x32_bf16 v[32:35], a[0:3], v[64:67], v[32:35]
ds_read_b64_tr_b16 a[32:33], v7 offset:41600
ds_read_b64_tr_b16 a[34:35], v7 offset:42112
s_waitcnt vmcnt(10)
v_mfma_f32_16x16x32_bf16 v[48:51], a[0:3], v[68:71], v[48:51]
buffer_load_dwordx4 v[112:115], v4, s[16:19], s52 offen sc1
s_waitcnt lgkmcnt(14)
v_mfma_f32_16x16x32_bf16 v[36:39], a[4:7], v[64:67], v[36:39]
ds_read_b64_tr_b16 a[36:37], v7 offset:41632
ds_read_b64_tr_b16 a[38:39], v7 offset:42144
v_mfma_f32_16x16x32_bf16 v[52:55], a[4:7], v[68:71], v[52:55]
ds_read_b64_tr_b16 a[40:41], v7 offset:41664
ds_read_b64_tr_b16 a[42:43], v7 offset:42176
s_waitcnt lgkmcnt(15)
v_mfma_f32_16x16x32_bf16 v[40:43], a[8:11], v[64:67], v[40:43]
buffer_load_dwordx4 v[116:119], v4, s[16:19], s52 offen offset:1024 sc1
v_mfma_f32_16x16x32_bf16 v[56:59], a[8:11], v[68:71], v[56:59]
ds_read_b64_tr_b16 a[44:45], v7 offset:41696
s_add_u32 s52, s52, 0x40000
s_waitcnt lgkmcnt(15)
v_mfma_f32_16x16x32_bf16 v[44:47], a[12:15], v[64:67], v[44:47]
ds_read_b64_tr_b16 a[46:47], v7 offset:42208
v_mfma_f32_16x16x32_bf16 v[60:63], a[12:15], v[68:71], v[60:63]
ds_read_b64_tr_b16 a[48:49], v7 offset:42624
ds_read_b64_tr_b16 a[50:51], v7 offset:43136
s_waitcnt vmcnt(11) lgkmcnt(15)
v_mfma_f32_16x16x32_bf16 v[32:35], a[16:19], v[72:75], v[32:35]
buffer_load_dwordx4 v[120:123], v4, s[16:19], s53 offen sc1
s_waitcnt vmcnt(11)
v_mfma_f32_16x16x32_bf16 v[48:51], a[16:19], v[76:79], v[48:51]
ds_read_b64_tr_b16 a[52:53], v7 offset:42656
ds_read_b64_tr_b16 a[54:55], v7 offset:43168
s_waitcnt lgkmcnt(15)
v_mfma_f32_16x16x32_bf16 v[36:39], a[20:23], v[72:75], v[36:39]
ds_read_b64_tr_b16 a[56:57], v7 offset:42688
ds_read_b64_tr_b16 a[58:59], v7 offset:43200
v_mfma_f32_16x16x32_bf16 v[52:55], a[20:23], v[76:79], v[52:55]
buffer_load_dwordx4 v[124:127], v4, s[16:19], s53 offen offset:1024 sc1
s_waitcnt lgkmcnt(15)
v_mfma_f32_16x16x32_bf16 v[40:43], a[24:27], v[72:75], v[40:43]
ds_read_b64_tr_b16 a[60:61], v7 offset:42720
s_add_u32 s53, s53, 0x40000
v_mfma_f32_16x16x32_bf16 v[56:59], a[24:27], v[76:79], v[56:59]
ds_read_b64_tr_b16 a[62:63], v7 offset:43232
s_waitcnt lgkmcnt(15)
v_mfma_f32_16x16x32_bf16 v[44:47], a[28:31], v[72:75], v[44:47]
v_mfma_f32_16x16x32_bf16 v[60:63], a[28:31], v[76:79], v[60:63]
s_waitcnt vmcnt(11) lgkmcnt(14)
v_mfma_f32_16x16x32_bf16 v[32:35], a[32:35], v[80:83], v[32:35]
ds_read_b64_tr_b16 a[0:1], v7 offset:49920
ds_read_b64_tr_b16 a[2:3], v7 offset:50432
s_waitcnt vmcnt(10)
v_mfma_f32_16x16x32_bf16 v[48:51], a[32:35], v[84:87], v[48:51]
buffer_load_dwordx4 v[64:67], v4, s[16:19], s52 offen sc1
s_waitcnt lgkmcnt(14)
v_mfma_f32_16x16x32_bf16 v[36:39], a[36:39], v[80:83], v[36:39]
ds_read_b64_tr_b16 a[4:5], v7 offset:49952
ds_read_b64_tr_b16 a[6:7], v7 offset:50464
v_mfma_f32_16x16x32_bf16 v[52:55], a[36:39], v[84:87], v[52:55]
ds_read_b64_tr_b16 a[8:9], v7 offset:49984
ds_read_b64_tr_b16 a[10:11], v7 offset:50496
s_waitcnt lgkmcnt(15)
v_mfma_f32_16x16x32_bf16 v[40:43], a[40:43], v[80:83], v[40:43]
buffer_load_dwordx4 v[68:71], v4, s[16:19], s52 offen offset:1024 sc1
v_mfma_f32_16x16x32_bf16 v[56:59], a[40:43], v[84:87], v[56:59]
ds_read_b64_tr_b16 a[12:13], v7 offset:50016
s_add_u32 s52, s52, 0x40000
s_waitcnt lgkmcnt(15)
v_mfma_f32_16x16x32_bf16 v[44:47], a[44:47], v[80:83], v[44:47]
ds_read_b64_tr_b16 a[14:15], v7 offset:50528
v_mfma_f32_16x16x32_bf16 v[60:63], a[44:47], v[84:87], v[60:63]
ds_read_b64_tr_b16 a[16:17], v7 offset:50944
ds_read_b64_tr_b16 a[18:19], v7 offset:51456
s_waitcnt vmcnt(11) lgkmcnt(15)
v_mfma_f32_16x16x32_bf16 v[32:35], a[48:51], v[88:91], v[32:35]
buffer_load_dwordx4 v[72:75], v4, s[16:19], s53 offen sc1
s_waitcnt vmcnt(11)
v_mfma_f32_16x16x32_bf16 v[48:51], a[48:51], v[92:95], v[48:51]
ds_read_b64_tr_b16 a[20:21], v7 offset:50976
ds_read_b64_tr_b16 a[22:23], v7 offset:51488
s_waitcnt lgkmcnt(15)
v_mfma_f32_16x16x32_bf16 v[36:39], a[52:55], v[88:91], v[36:39]
ds_read_b64_tr_b16 a[24:25], v7 offset:51008
ds_read_b64_tr_b16 a[26:27], v7 offset:51520
v_mfma_f32_16x16x32_bf16 v[52:55], a[52:55], v[92:95], v[52:55]
buffer_load_dwordx4 v[76:79], v4, s[16:19], s53 offen offset:1024 sc1
s_waitcnt lgkmcnt(15)
v_mfma_f32_16x16x32_bf16 v[40:43], a[56:59], v[88:91], v[40:43]
ds_read_b64_tr_b16 a[28:29], v7 offset:51040
s_add_u32 s53, s53, 0x40000
v_mfma_f32_16x16x32_bf16 v[56:59], a[56:59], v[92:95], v[56:59]
ds_read_b64_tr_b16 a[30:31], v7 offset:51552
s_waitcnt lgkmcnt(15)
v_mfma_f32_16x16x32_bf16 v[44:47], a[60:63], v[88:91], v[44:47]
v_mfma_f32_16x16x32_bf16 v[60:63], a[60:63], v[92:95], v[60:63]
s_waitcnt vmcnt(11) lgkmcnt(14)
v_mfma_f32_16x16x32_bf16 v[32:35], a[0:3], v[96:99], v[32:35]
ds_read_b64_tr_b16 a[32:33], v7 offset:58240
ds_read_b64_tr_b16 a[34:35], v7 offset:58752
s_waitcnt vmcnt(10)
v_mfma_f32_16x16x32_bf16 v[48:51], a[0:3], v[100:103], v[48:51]
buffer_load_dwordx4 v[80:83], v4, s[16:19], s52 offen sc1
s_waitcnt lgkmcnt(14)
v_mfma_f32_16x16x32_bf16 v[36:39], a[4:7], v[96:99], v[36:39]
ds_read_b64_tr_b16 a[36:37], v7 offset:58272
ds_read_b64_tr_b16 a[38:39], v7 offset:58784
v_mfma_f32_16x16x32_bf16 v[52:55], a[4:7], v[100:103], v[52:55]
ds_read_b64_tr_b16 a[40:41], v7 offset:58304
ds_read_b64_tr_b16 a[42:43], v7 offset:58816
s_waitcnt lgkmcnt(15)
v_mfma_f32_16x16x32_bf16 v[40:43], a[8:11], v[96:99], v[40:43]
buffer_load_dwordx4 v[84:87], v4, s[16:19], s52 offen offset:1024 sc1
v_mfma_f32_16x16x32_bf16 v[56:59], a[8:11], v[100:103], v[56:59]
ds_read_b64_tr_b16 a[44:45], v7 offset:58336
s_add_u32 s52, s52, 0x40000
s_waitcnt lgkmcnt(15)
v_mfma_f32_16x16x32_bf16 v[44:47], a[12:15], v[96:99], v[44:47]
ds_read_b64_tr_b16 a[46:47], v7 offset:58848
v_mfma_f32_16x16x32_bf16 v[60:63], a[12:15], v[100:103], v[60:63]
ds_read_b64_tr_b16 a[48:49], v7 offset:59264
ds_read_b64_tr_b16 a[50:51], v7 offset:59776
s_waitcnt vmcnt(11) lgkmcnt(15)
v_mfma_f32_16x16x32_bf16 v[32:35], a[16:19], v[104:107], v[32:35]
buffer_load_dwordx4 v[88:91], v4, s[16:19], s53 offen sc1
s_waitcnt vmcnt(11)
v_mfma_f32_16x16x32_bf16 v[48:51], a[16:19], v[108:111], v[48:51]
ds_read_b64_tr_b16 a[52:53], v7 offset:59296
ds_read_b64_tr_b16 a[54:55], v7 offset:59808
s_waitcnt lgkmcnt(15)
v_mfma_f32_16x16x32_bf16 v[36:39], a[20:23], v[104:107], v[36:39]
ds_read_b64_tr_b16 a[56:57], v7 offset:59328
ds_read_b64_tr_b16 a[58:59], v7 offset:59840
v_mfma_f32_16x16x32_bf16 v[52:55], a[20:23], v[108:111], v[52:55]
buffer_load_dwordx4 v[92:95], v4, s[16:19], s53 offen offset:1024 sc1
s_waitcnt lgkmcnt(15)
v_mfma_f32_16x16x32_bf16 v[40:43], a[24:27], v[104:107], v[40:43]
ds_read_b64_tr_b16 a[60:61], v7 offset:59360
s_add_u32 s53, s53, 0x40000
v_mfma_f32_16x16x32_bf16 v[56:59], a[24:27], v[108:111], v[56:59]
ds_read_b64_tr_b16 a[62:63], v7 offset:59872
s_waitcnt lgkmcnt(15)
v_mfma_f32_16x16x32_bf16 v[44:47], a[28:31], v[104:107], v[44:47]
v_mfma_f32_16x16x32_bf16 v[60:63], a[28:31], v[108:111], v[60:63]
s_xor_b32 s57, s57, 66560
v_add_u32 v7, s57, v8
s_waitcnt vmcnt(11) lgkmcnt(14)
v_mfma_f32_16x16x32_bf16 v[32:35], a[32:35], v[112:115], v[32:35]
ds_read_b64_tr_b16 a[0:1], v7
ds_read_b64_tr_b16 a[2:3], v7 offset:512
s_waitcnt vmcnt(10)
v_mfma_f32_16x16x32_bf16 v[48:51], a[32:35], v[116:119], v[48:51]
buffer_load_dwordx4 v[96:99], v4, s[16:19], s52 offen sc1
s_waitcnt lgkmcnt(14)
v_mfma_f32_16x16x32_bf16 v[36:39], a[36:39], v[112:115], v[36:39]
ds_read_b64_tr_b16 a[4:5], v7 offset:32
ds_read_b64_tr_b16 a[6:7], v7 offset:544
v_mfma_f32_16x16x32_bf16 v[52:55], a[36:39], v[116:119], v[52:55]
ds_read_b64_tr_b16 a[8:9], v7 offset:64
ds_read_b64_tr_b16 a[10:11], v7 offset:576
s_waitcnt lgkmcnt(15)
v_mfma_f32_16x16x32_bf16 v[40:43], a[40:43], v[112:115], v[40:43]
buffer_load_dwordx4 v[100:103], v4, s[16:19], s52 offen offset:1024 sc1
v_mfma_f32_16x16x32_bf16 v[56:59], a[40:43], v[116:119], v[56:59]
ds_read_b64_tr_b16 a[12:13], v7 offset:96
s_add_u32 s52, s52, 0x40000
s_waitcnt lgkmcnt(15)
v_mfma_f32_16x16x32_bf16 v[44:47], a[44:47], v[112:115], v[44:47]
ds_read_b64_tr_b16 a[14:15], v7 offset:608
v_mfma_f32_16x16x32_bf16 v[60:63], a[44:47], v[116:119], v[60:63]
ds_read_b64_tr_b16 a[16:17], v7 offset:1024
ds_read_b64_tr_b16 a[18:19], v7 offset:1536
s_waitcnt vmcnt(11) lgkmcnt(15)
v_mfma_f32_16x16x32_bf16 v[32:35], a[48:51], v[120:123], v[32:35]
buffer_load_dwordx4 v[104:107], v4, s[16:19], s53 offen sc1
s_waitcnt vmcnt(11)
v_mfma_f32_16x16x32_bf16 v[48:51], a[48:51], v[124:127], v[48:51]
ds_read_b64_tr_b16 a[20:21], v7 offset:1056
ds_read_b64_tr_b16 a[22:23], v7 offset:1568
s_waitcnt lgkmcnt(15)
v_mfma_f32_16x16x32_bf16 v[36:39], a[52:55], v[120:123], v[36:39]
ds_read_b64_tr_b16 a[24:25], v7 offset:1088
ds_read_b64_tr_b16 a[26:27], v7 offset:1600
v_mfma_f32_16x16x32_bf16 v[52:55], a[52:55], v[124:127], v[52:55]
buffer_load_dwordx4 v[108:111], v4, s[16:19], s53 offen offset:1024 sc1
s_waitcnt lgkmcnt(15)
v_mfma_f32_16x16x32_bf16 v[40:43], a[56:59], v[120:123], v[40:43]
ds_read_b64_tr_b16 a[28:29], v7 offset:1120
s_add_u32 s53, s53, 0x40000
v_mfma_f32_16x16x32_bf16 v[56:59], a[56:59], v[124:127], v[56:59]
ds_read_b64_tr_b16 a[30:31], v7 offset:1632
s_waitcnt lgkmcnt(15)
v_mfma_f32_16x16x32_bf16 v[44:47], a[60:63], v[120:123], v[44:47]
v_mfma_f32_16x16x32_bf16 v[60:63], a[60:63], v[124:127], v[60:63]
s_waitcnt vmcnt(11) lgkmcnt(14)
v_mfma_f32_16x16x32_bf16 v[32:35], a[0:3], v[64:67], v[32:35]
ds_read_b64_tr_b16 a[32:33], v7 offset:8320
ds_read_b64_tr_b16 a[34:35], v7 offset:8832
s_waitcnt vmcnt(10)
v_mfma_f32_16x16x32_bf16 v[48:51], a[0:3], v[68:71], v[48:51]
buffer_load_dwordx4 v[112:115], v4, s[16:19], s52 offen sc1
s_waitcnt lgkmcnt(14)
v_mfma_f32_16x16x32_bf16 v[36:39], a[4:7], v[64:67], v[36:39]
ds_read_b64_tr_b16 a[36:37], v7 offset:8352
ds_read_b64_tr_b16 a[38:39], v7 offset:8864
v_mfma_f32_16x16x32_bf16 v[52:55], a[4:7], v[68:71], v[52:55]
ds_read_b64_tr_b16 a[40:41], v7 offset:8384
ds_read_b64_tr_b16 a[42:43], v7 offset:8896
s_waitcnt lgkmcnt(15)
v_mfma_f32_16x16x32_bf16 v[40:43], a[8:11], v[64:67], v[40:43]
buffer_load_dwordx4 v[116:119], v4, s[16:19], s52 offen offset:1024 sc1
v_mfma_f32_16x16x32_bf16 v[56:59], a[8:11], v[68:71], v[56:59]
ds_read_b64_tr_b16 a[44:45], v7 offset:8416
s_add_u32 s52, s52, 0x40000
s_waitcnt lgkmcnt(15)
v_mfma_f32_16x16x32_bf16 v[44:47], a[12:15], v[64:67], v[44:47]
ds_read_b64_tr_b16 a[46:47], v7 offset:8928
v_mfma_f32_16x16x32_bf16 v[60:63], a[12:15], v[68:71], v[60:63]
ds_read_b64_tr_b16 a[48:49], v7 offset:9344
ds_read_b64_tr_b16 a[50:51], v7 offset:9856
s_waitcnt vmcnt(11) lgkmcnt(15)
v_mfma_f32_16x16x32_bf16 v[32:35], a[16:19], v[72:75], v[32:35]
buffer_load_dwordx4 v[120:123], v4, s[16:19], s53 offen sc1
s_waitcnt vmcnt(11)
v_mfma_f32_16x16x32_bf16 v[48:51], a[16:19], v[76:79], v[48:51]
ds_read_b64_tr_b16 a[52:53], v7 offset:9376
ds_read_b64_tr_b16 a[54:55], v7 offset:9888
s_waitcnt lgkmcnt(15)
v_mfma_f32_16x16x32_bf16 v[36:39], a[20:23], v[72:75], v[36:39]
ds_read_b64_tr_b16 a[56:57], v7 offset:9408
ds_read_b64_tr_b16 a[58:59], v7 offset:9920
v_mfma_f32_16x16x32_bf16 v[52:55], a[20:23], v[76:79], v[52:55]
buffer_load_dwordx4 v[124:127], v4, s[16:19], s53 offen offset:1024 sc1
s_waitcnt lgkmcnt(15)
v_mfma_f32_16x16x32_bf16 v[40:43], a[24:27], v[72:75], v[40:43]
ds_read_b64_tr_b16 a[60:61], v7 offset:9440
s_add_u32 s53, s53, 0x40000
v_mfma_f32_16x16x32_bf16 v[56:59], a[24:27], v[76:79], v[56:59]
ds_read_b64_tr_b16 a[62:63], v7 offset:9952
s_waitcnt lgkmcnt(15)
v_mfma_f32_16x16x32_bf16 v[44:47], a[28:31], v[72:75], v[44:47]
v_mfma_f32_16x16x32_bf16 v[60:63], a[28:31], v[76:79], v[60:63]
s_waitcnt vmcnt(11) lgkmcnt(14)
v_mfma_f32_16x16x32_bf16 v[32:35], a[32:35], v[80:83], v[32:35]
ds_read_b64_tr_b16 a[0:1], v7 offset:16640
ds_read_b64_tr_b16 a[2:3], v7 offset:17152
s_waitcnt vmcnt(10)
v_mfma_f32_16x16x32_bf16 v[48:51], a[32:35], v[84:87], v[48:51]
buffer_load_dwordx4 v[64:67], v4, s[16:19], s52 offen sc1
s_waitcnt lgkmcnt(14)
v_mfma_f32_16x16x32_bf16 v[36:39], a[36:39], v[80:83], v[36:39]
ds_read_b64_tr_b16 a[4:5], v7 offset:16672
ds_read_b64_tr_b16 a[6:7], v7 offset:17184
v_mfma_f32_16x16x32_bf16 v[52:55], a[36:39], v[84:87], v[52:55]
ds_read_b64_tr_b16 a[8:9], v7 offset:16704
ds_read_b64_tr_b16 a[10:11], v7 offset:17216
s_waitcnt lgkmcnt(15)
v_mfma_f32_16x16x32_bf16 v[40:43], a[40:43], v[80:83], v[40:43]
buffer_load_dwordx4 v[68:71], v4, s[16:19], s52 offen offset:1024 sc1
v_mfma_f32_16x16x32_bf16 v[56:59], a[40:43], v[84:87], v[56:59]
ds_read_b64_tr_b16 a[12:13], v7 offset:16736
s_add_u32 s52, s52, 0x40000
s_waitcnt lgkmcnt(15)
v_mfma_f32_16x16x32_bf16 v[44:47], a[44:47], v[80:83], v[44:47]
ds_read_b64_tr_b16 a[14:15], v7 offset:17248
v_mfma_f32_16x16x32_bf16 v[60:63], a[44:47], v[84:87], v[60:63]
ds_read_b64_tr_b16 a[16:17], v7 offset:17664
ds_read_b64_tr_b16 a[18:19], v7 offset:18176
s_waitcnt vmcnt(11) lgkmcnt(15)
v_mfma_f32_16x16x32_bf16 v[32:35], a[48:51], v[88:91], v[32:35]
buffer_load_dwordx4 v[72:75], v4, s[16:19], s53 offen sc1
s_waitcnt vmcnt(11)
v_mfma_f32_16x16x32_bf16 v[48:51], a[48:51], v[92:95], v[48:51]
ds_read_b64_tr_b16 a[20:21], v7 offset:17696
ds_read_b64_tr_b16 a[22:23], v7 offset:18208
s_waitcnt lgkmcnt(15)
v_mfma_f32_16x16x32_bf16 v[36:39], a[52:55], v[88:91], v[36:39]
ds_read_b64_tr_b16 a[24:25], v7 offset:17728
ds_read_b64_tr_b16 a[26:27], v7 offset:18240
v_mfma_f32_16x16x32_bf16 v[52:55], a[52:55], v[92:95], v[52:55]
buffer_load_dwordx4 v[76:79], v4, s[16:19], s53 offen offset:1024 sc1
s_waitcnt lgkmcnt(15)
v_mfma_f32_16x16x32_bf16 v[40:43], a[56:59], v[88:91], v[40:43]
ds_read_b64_tr_b16 a[28:29], v7 offset:17760
s_add_u32 s53, s53, 0x40000
v_mfma_f32_16x16x32_bf16 v[56:59], a[56:59], v[92:95], v[56:59]
ds_read_b64_tr_b16 a[30:31], v7 offset:18272
s_waitcnt lgkmcnt(15)
v_mfma_f32_16x16x32_bf16 v[44:47], a[60:63], v[88:91], v[44:47]
v_mfma_f32_16x16x32_bf16 v[60:63], a[60:63], v[92:95], v[60:63]
s_waitcnt vmcnt(11) lgkmcnt(14)
v_mfma_f32_16x16x32_bf16 v[32:35], a[0:3], v[96:99], v[32:35]
ds_read_b64_tr_b16 a[32:33], v7 offset:24960
ds_read_b64_tr_b16 a[34:35], v7 offset:25472
s_waitcnt vmcnt(10)
v_mfma_f32_16x16x32_bf16 v[48:51], a[0:3], v[100:103], v[48:51]
buffer_load_dwordx4 v[80:83], v4, s[16:19], s52 offen sc1
s_waitcnt lgkmcnt(14)
v_mfma_f32_16x16x32_bf16 v[36:39], a[4:7], v[96:99], v[36:39]
ds_read_b64_tr_b16 a[36:37], v7 offset:24992
ds_read_b64_tr_b16 a[38:39], v7 offset:25504
v_mfma_f32_16x16x32_bf16 v[52:55], a[4:7], v[100:103], v[52:55]
ds_read_b64_tr_b16 a[40:41], v7 offset:25024
ds_read_b64_tr_b16 a[42:43], v7 offset:25536
s_waitcnt lgkmcnt(15)
v_mfma_f32_16x16x32_bf16 v[40:43], a[8:11], v[96:99], v[40:43]
buffer_load_dwordx4 v[84:87], v4, s[16:19], s52 offen offset:1024 sc1
v_mfma_f32_16x16x32_bf16 v[56:59], a[8:11], v[100:103], v[56:59]
ds_read_b64_tr_b16 a[44:45], v7 offset:25056
s_add_u32 s52, s52, 0x40000
s_waitcnt lgkmcnt(15)
v_mfma_f32_16x16x32_bf16 v[44:47], a[12:15], v[96:99], v[44:47]
ds_read_b64_tr_b16 a[46:47], v7 offset:25568
v_mfma_f32_16x16x32_bf16 v[60:63], a[12:15], v[100:103], v[60:63]
ds_read_b64_tr_b16 a[48:49], v7 offset:25984
ds_read_b64_tr_b16 a[50:51], v7 offset:26496
s_waitcnt vmcnt(11) lgkmcnt(15)
v_mfma_f32_16x16x32_bf16 v[32:35], a[16:19], v[104:107], v[32:35]
buffer_load_dwordx4 v[88:91], v4, s[16:19], s53 offen sc1
s_waitcnt vmcnt(11)
v_mfma_f32_16x16x32_bf16 v[48:51], a[16:19], v[108:111], v[48:51]
ds_read_b64_tr_b16 a[52:53], v7 offset:26016
ds_read_b64_tr_b16 a[54:55], v7 offset:26528
s_waitcnt lgkmcnt(15)
v_mfma_f32_16x16x32_bf16 v[36:39], a[20:23], v[104:107], v[36:39]
ds_read_b64_tr_b16 a[56:57], v7 offset:26048
ds_read_b64_tr_b16 a[58:59], v7 offset:26560
v_mfma_f32_16x16x32_bf16 v[52:55], a[20:23], v[108:111], v[52:55]
buffer_load_dwordx4 v[92:95], v4, s[16:19], s53 offen offset:1024 sc1
s_waitcnt lgkmcnt(15)
v_mfma_f32_16x16x32_bf16 v[40:43], a[24:27], v[104:107], v[40:43]
ds_read_b64_tr_b16 a[60:61], v7 offset:26080
s_add_u32 s53, s53, 0x40000
v_mfma_f32_16x16x32_bf16 v[56:59], a[24:27], v[108:111], v[56:59]
ds_read_b64_tr_b16 a[62:63], v7 offset:26592
s_waitcnt lgkmcnt(15)
v_mfma_f32_16x16x32_bf16 v[44:47], a[28:31], v[104:107], v[44:47]
v_mfma_f32_16x16x32_bf16 v[60:63], a[28:31], v[108:111], v[60:63]
s_waitcnt lgkmcnt(0)
s_barrier
s_waitcnt vmcnt(11)
v_mfma_f32_16x16x32_bf16 v[32:35], a[32:35], v[112:115], v[32:35]
ds_read_b64_tr_b16 a[0:1], v7 offset:33280
ds_read_b64_tr_b16 a[2:3], v7 offset:33792
ds_read_b64_tr_b16 a[4:5], v7 offset:33312
s_waitcnt vmcnt(10)
v_mfma_f32_16x16x32_bf16 v[48:51], a[32:35], v[116:119], v[48:51]
ds_read_b64_tr_b16 a[6:7], v7 offset:33824
buffer_load_dwordx4 v[96:99], v4, s[16:19], s52 offen sc1
v_mfma_f32_16x16x32_bf16 v[36:39], a[36:39], v[112:115], v[36:39]
ds_read_b64_tr_b16 a[8:9], v7 offset:33344
buffer_load_dwordx4 v[100:103], v4, s[16:19], s52 offen offset:1024 sc1
v_mfma_f32_16x16x32_bf16 v[52:55], a[36:39], v[116:119], v[52:55]
ds_read_b64_tr_b16 a[10:11], v7 offset:33856
s_add_u32 s52, s52, 0x40000
v_mfma_f32_16x16x32_bf16 v[40:43], a[40:43], v[112:115], v[40:43]
ds_read_b64_tr_b16 a[12:13], v7 offset:33376
buffer_load_dwordx4 v[104:107], v4, s[16:19], s53 offen sc1
v_mfma_f32_16x16x32_bf16 v[56:59], a[40:43], v[116:119], v[56:59]
ds_read_b64_tr_b16 a[14:15], v7 offset:33888
ds_read_b64_tr_b16 a[16:17], v7 offset:34304
ds_read_b64_tr_b16 a[18:19], v7 offset:34816
v_mfma_f32_16x16x32_bf16 v[44:47], a[44:47], v[112:115], v[44:47]
ds_read_b64_tr_b16 a[20:21], v7 offset:34336
buffer_load_dwordx4 v[108:111], v4, s[16:19], s53 offen offset:1024 sc1
v_mfma_f32_16x16x32_bf16 v[60:63], a[44:47], v[116:119], v[60:63]
ds_read_b64_tr_b16 a[22:23], v7 offset:34848
s_add_u32 s53, s53, 0x40000
s_add_u32 m0, s59, 83200
s_waitcnt vmcnt(13)
v_mfma_f32_16x16x32_bf16 v[32:35], a[48:51], v[120:123], v[32:35]
ds_read_b64_tr_b16 a[24:25], v7 offset:34368
buffer_load_dwordx4 v12, s[32:35], s58 offen lds
s_waitcnt vmcnt(13)
v_mfma_f32_16x16x32_bf16 v[48:51], a[48:51], v[124:127], v[48:51]
ds_read_b64_tr_b16 a[26:27], v7 offset:34880
buffer_load_dwordx4 v13, s[32:35], s58 offen offset:1056 lds
v_mfma_f32_16x16x32_bf16 v[36:39], a[52:55], v[120:123], v[36:39]
ds_read_b64_tr_b16 a[28:29], v7 offset:34400
ds_read_b64_tr_b16 a[30:31], v7 offset:34912
v_mfma_f32_16x16x32_bf16 v[52:55], a[52:55], v[124:127], v[52:55]
buffer_load_dwordx4 v14, s[32:35], s58 offen offset:2112 lds
v_mfma_f32_16x16x32_bf16 v[40:43], a[56:59], v[120:123], v[40:43]
v_mfma_f32_16x16x32_bf16 v[56:59], a[56:59], v[124:127], v[56:59]
buffer_load_dwordx4 v15, s[32:35], s58 offen offset:3168 lds
v_mfma_f32_16x16x32_bf16 v[44:47], a[60:63], v[120:123], v[44:47]
s_add_u32 s58, s58, 229376
v_mfma_f32_16x16x32_bf16 v[60:63], a[60:63], v[124:127], v[60:63]
s_waitcnt vmcnt(15) lgkmcnt(14)
v_mfma_f32_16x16x32_bf16 v[32:35], a[0:3], v[64:67], v[32:35]
ds_read_b64_tr_b16 a[32:33], v7 offset:41600
ds_read_b64_tr_b16 a[34:35], v7 offset:42112
s_waitcnt vmcnt(14)
v_mfma_f32_16x16x32_bf16 v[48:51], a[0:3], v[68:71], v[48:51]
ds_read_b64_tr_b16 a[36:37], v7 offset:41632
buffer_load_dwordx4 v[112:115], v4, s[16:19], s52 offen sc1
s_waitcnt lgkmcnt(15)
v_mfma_f32_16x16x32_bf16 v[36:39], a[4:7], v[64:67], v[36:39]
ds_read_b64_tr_b16 a[38:39], v7 offset:42144
buffer_load_dwordx4 v[116:119], v4, s[16:19], s52 offen offset:1024 sc1
v_mfma_f32_16x16x32_bf16 v[52:55], a[4:7], v[68:71], v[52:55]
ds_read_b64_tr_b16 a[40:41], v7 offset:41664
ds_read_b64_tr_b16 a[42:43], v7 offset:42176
s_add_u32 s52, s52, 0x40000
s_waitcnt lgkmcnt(15)
v_mfma_f32_16x16x32_bf16 v[40:43], a[8:11], v[64:67], v[40:43]
buffer_load_dwordx4 v[120:123], v4, s[16:19], s53 offen sc1
v_mfma_f32_16x16x32_bf16 v[56:59], a[8:11], v[68:71], v[56:59]
ds_read_b64_tr_b16 a[44:45], v7 offset:41696
ds_read_b64_tr_b16 a[46:47], v7 offset:42208
s_waitcnt lgkmcnt(15)
v_mfma_f32_16x16x32_bf16 v[44:47], a[12:15], v[64:67], v[44:47]
ds_read_b64_tr_b16 a[48:49], v7 offset:42624
buffer_load_dwordx4 v[124:127], v4, s[16:19], s53 offen offset:1024 sc1
v_mfma_f32_16x16x32_bf16 v[60:63], a[12:15], v[68:71], v[60:63]
ds_read_b64_tr_b16 a[50:51], v7 offset:43136
s_add_u32 s53, s53, 0x40000
s_add_u32 m0, s59, 100096
s_waitcnt vmcnt(17) lgkmcnt(15)
v_mfma_f32_16x16x32_bf16 v[32:35], a[16:19], v[72:75], v[32:35]
ds_read_b64_tr_b16 a[52:53], v7 offset:42656
buffer_load_dwordx4 v12, s[32:35], s58 offen lds
s_waitcnt vmcnt(17)
v_mfma_f32_16x16x32_bf16 v[48:51], a[16:19], v[76:79], v[48:51]
buffer_load_dwordx4 v13, s[32:35], s58 offen offset:1056 lds
s_waitcnt lgkmcnt(15)
v_mfma_f32_16x16x32_bf16 v[36:39], a[20:23], v[72:75], v[36:39]
ds_read_b64_tr_b16 a[54:55], v7 offset:43168
ds_read_b64_tr_b16 a[56:57], v7 offset:42688
v_mfma_f32_16x16x32_bf16 v[52:55], a[20:23], v[76:79], v[52:55]
ds_read_b64_tr_b16 a[58:59], v7 offset:43200
buffer_load_dwordx4 v14, s[32:35], s58 offen offset:2112 lds
s_waitcnt lgkmcnt(15)
v_mfma_f32_16x16x32_bf16 v[40:43], a[24:27], v[72:75], v[40:43]
ds_read_b64_tr_b16 a[60:61], v7 offset:42720
ds_read_b64_tr_b16 a[62:63], v7 offset:43232
v_mfma_f32_16x16x32_bf16 v[56:59], a[24:27], v[76:79], v[56:59]
buffer_load_dwordx4 v15, s[32:35], s58 offen offset:3168 lds
s_waitcnt lgkmcnt(15)
v_mfma_f32_16x16x32_bf16 v[44:47], a[28:31], v[72:75], v[44:47]
s_add_u32 s58, s58, 229376
v_mfma_f32_16x16x32_bf16 v[60:63], a[28:31], v[76:79], v[60:63]
s_waitcnt vmcnt(19) lgkmcnt(14)
v_mfma_f32_16x16x32_bf16 v[32:35], a[32:35], v[80:83], v[32:35]
ds_read_b64_tr_b16 a[0:1], v7 offset:49920
s_add_u32 m0, s59, 116992
s_waitcnt vmcnt(18)
v_mfma_f32_16x16x32_bf16 v[48:51], a[32:35], v[84:87], v[48:51]
buffer_load_dwordx4 v12, s[32:35], s58 offen lds
s_waitcnt lgkmcnt(13)
v_mfma_f32_16x16x32_bf16 v[36:39], a[36:39], v[80:83], v[36:39]
ds_read_b64_tr_b16 a[2:3], v7 offset:50432
ds_read_b64_tr_b16 a[4:5], v7 offset:49952
v_mfma_f32_16x16x32_bf16 v[52:55], a[36:39], v[84:87], v[52:55]
ds_read_b64_tr_b16 a[6:7], v7 offset:50464
ds_read_b64_tr_b16 a[8:9], v7 offset:49984
s_waitcnt lgkmcnt(15)
v_mfma_f32_16x16x32_bf16 v[40:43], a[40:43], v[80:83], v[40:43]
buffer_load_dwordx4 v13, s[32:35], s58 offen offset:1056 lds
v_mfma_f32_16x16x32_bf16 v[56:59], a[40:43], v[84:87], v[56:59]
ds_read_b64_tr_b16 a[10:11], v7 offset:50496
ds_read_b64_tr_b16 a[12:13], v7 offset:50016
s_waitcnt lgkmcnt(15)
v_mfma_f32_16x16x32_bf16 v[44:47], a[44:47], v[80:83], v[44:47]
ds_read_b64_tr_b16 a[14:15], v7 offset:50528
v_mfma_f32_16x16x32_bf16 v[60:63], a[44:47], v[84:87], v[60:63]
ds_read_b64_tr_b16 a[16:17], v7 offset:50944
ds_read_b64_tr_b16 a[18:19], v7 offset:51456
s_waitcnt vmcnt(19) lgkmcnt(15)
v_mfma_f32_16x16x32_bf16 v[32:35], a[48:51], v[88:91], v[32:35]
buffer_load_dwordx4 v14, s[32:35], s58 offen offset:2112 lds
s_waitcnt vmcnt(19)
v_mfma_f32_16x16x32_bf16 v[48:51], a[48:51], v[92:95], v[48:51]
ds_read_b64_tr_b16 a[20:21], v7 offset:50976
ds_read_b64_tr_b16 a[22:23], v7 offset:51488
s_waitcnt lgkmcnt(15)
v_mfma_f32_16x16x32_bf16 v[36:39], a[52:55], v[88:91], v[36:39]
ds_read_b64_tr_b16 a[24:25], v7 offset:51008
ds_read_b64_tr_b16 a[26:27], v7 offset:51520
v_mfma_f32_16x16x32_bf16 v[52:55], a[52:55], v[92:95], v[52:55]
buffer_load_dwordx4 v15, s[32:35], s58 offen offset:3168 lds
s_waitcnt lgkmcnt(15)
v_mfma_f32_16x16x32_bf16 v[40:43], a[56:59], v[88:91], v[40:43]
ds_read_b64_tr_b16 a[28:29], v7 offset:51040
s_add_u32 s58, s58, 229376
v_mfma_f32_16x16x32_bf16 v[56:59], a[56:59], v[92:95], v[56:59]
ds_read_b64_tr_b16 a[30:31], v7 offset:51552
s_waitcnt lgkmcnt(15)
v_mfma_f32_16x16x32_bf16 v[44:47], a[60:63], v[88:91], v[44:47]
v_mfma_f32_16x16x32_bf16 v[60:63], a[60:63], v[92:95], v[60:63]
s_waitcnt vmcnt(19) lgkmcnt(14)
v_mfma_f32_16x16x32_bf16 v[32:35], a[0:3], v[96:99], v[32:35]
ds_read_b64_tr_b16 a[32:33], v7 offset:58240
s_add_u32 m0, s59, 133888
s_waitcnt vmcnt(18)
v_mfma_f32_16x16x32_bf16 v[48:51], a[0:3], v[100:103], v[48:51]
buffer_load_dwordx4 v12, s[32:35], s58 offen lds
s_waitcnt lgkmcnt(13)
v_mfma_f32_16x16x32_bf16 v[36:39], a[4:7], v[96:99], v[36:39]
ds_read_b64_tr_b16 a[34:35], v7 offset:58752
ds_read_b64_tr_b16 a[36:37], v7 offset:58272
v_mfma_f32_16x16x32_bf16 v[52:55], a[4:7], v[100:103], v[52:55]
ds_read_b64_tr_b16 a[38:39], v7 offset:58784
ds_read_b64_tr_b16 a[40:41], v7 offset:58304
s_waitcnt lgkmcnt(15)
v_mfma_f32_16x16x32_bf16 v[40:43], a[8:11], v[96:99], v[40:43]
buffer_load_dwordx4 v13, s[32:35], s58 offen offset:1056 lds
v_mfma_f32_16x16x32_bf16 v[56:59], a[8:11], v[100:103], v[56:59]
ds_read_b64_tr_b16 a[42:43], v7 offset:58816
ds_read_b64_tr_b16 a[44:45], v7 offset:58336
s_waitcnt lgkmcnt(15)
v_mfma_f32_16x16x32_bf16 v[44:47], a[12:15], v[96:99], v[44:47]
ds_read_b64_tr_b16 a[46:47], v7 offset:58848
v_mfma_f32_16x16x32_bf16 v[60:63], a[12:15], v[100:103], v[60:63]
ds_read_b64_tr_b16 a[48:49], v7 offset:59264
ds_read_b64_tr_b16 a[50:51], v7 offset:59776
s_waitcnt vmcnt(19) lgkmcnt(15)
v_mfma_f32_16x16x32_bf16 v[32:35], a[16:19], v[104:107], v[32:35]
buffer_load_dwordx4 v14, s[32:35], s58 offen offset:2112 lds
s_waitcnt vmcnt(19)
v_mfma_f32_16x16x32_bf16 v[48:51], a[16:19], v[108:111], v[48:51]
ds_read_b64_tr_b16 a[52:53], v7 offset:59296
ds_read_b64_tr_b16 a[54:55], v7 offset:59808
s_waitcnt lgkmcnt(15)
v_mfma_f32_16x16x32_bf16 v[36:39], a[20:23], v[104:107], v[36:39]
ds_read_b64_tr_b16 a[56:57], v7 offset:59328
ds_read_b64_tr_b16 a[58:59], v7 offset:59840
v_mfma_f32_16x16x32_bf16 v[52:55], a[20:23], v[108:111], v[52:55]
buffer_load_dwordx4 v15, s[32:35], s58 offen offset:3168 lds
s_waitcnt lgkmcnt(15)
v_mfma_f32_16x16x32_bf16 v[40:43], a[24:27], v[104:107], v[40:43]
ds_read_b64_tr_b16 a[60:61], v7 offset:59360
s_add_u32 s58, s58, 229376
v_mfma_f32_16x16x32_bf16 v[56:59], a[24:27], v[108:111], v[56:59]
ds_read_b64_tr_b16 a[62:63], v7 offset:59872
s_waitcnt lgkmcnt(15)
v_mfma_f32_16x16x32_bf16 v[44:47], a[28:31], v[104:107], v[44:47]
v_mfma_f32_16x16x32_bf16 v[60:63], a[28:31], v[108:111], v[60:63]
s_waitcnt vmcnt(15) lgkmcnt(14)
v_mfma_f32_16x16x32_bf16 v[32:35], a[32:35], v[112:115], v[32:35]
s_lshl_b32 s64, s6, 14
s_lshl_b32 s65, s49, 13
s_add_u32 s64, s64, s65
s_waitcnt vmcnt(14)
v_mfma_f32_16x16x32_bf16 v[48:51], a[32:35], v[116:119], v[48:51]
s_lshl_b32 s65, s7, 9
s_add_u32 s64, s64, s65
s_lshl_b32 s65, s48, 8
s_waitcnt lgkmcnt(12)
v_mfma_f32_16x16x32_bf16 v[36:39], a[36:39], v[112:115], v[36:39]
s_add_u32 s64, s64, s65
s_add_u32 s64, s64, 29622272
v_and_b32 v152, 31, v1
v_mfma_f32_16x16x32_bf16 v[52:55], a[36:39], v[116:119], v[52:55]
s_lshl_b32 s62, s7, 18
v_lshlrev_b32 v152, 3, v152
v_lshrrev_b32 v153, 5, v1
s_waitcnt lgkmcnt(10)
v_mfma_f32_16x16x32_bf16 v[40:43], a[40:43], v[112:115], v[40:43]
s_add_u32 s62, s62, 8388608
.Lpad10:
s_cbranch_execz .Lnopoll22r
v_lshl_add_u32 v152, v153, 2, v152
s_add_u32 s63, s62, 0x20000
v_mfma_f32_16x16x32_bf16 v[56:59], a[40:43], v[116:119], v[56:59]
s_waitcnt lgkmcnt(8)
v_mfma_f32_16x16x32_bf16 v[44:47], a[44:47], v[112:115], v[44:47]
v_mfma_f32_16x16x32_bf16 v[60:63], a[44:47], v[116:119], v[60:63]
s_waitcnt vmcnt(13) lgkmcnt(6)
v_mfma_f32_16x16x32_bf16 v[32:35], a[48:51], v[120:123], v[32:35]
s_waitcnt vmcnt(12)
v_mfma_f32_16x16x32_bf16 v[48:51], a[48:51], v[124:127], v[48:51]
s_waitcnt lgkmcnt(4)
v_mfma_f32_16x16x32_bf16 v[36:39], a[52:55], v[120:123], v[36:39]
s_nop 3
v_cvt_pk_bf16_f32 v128, v32, v33
v_cvt_pk_bf16_f32 v129, v34, v35
v_mfma_f32_16x16x32_bf16 v[52:55], a[52:55], v[124:127], v[52:55]
v_cvt_pk_bf16_f32 v136, v48, v49
v_cvt_pk_bf16_f32 v137, v50, v51
s_waitcnt lgkmcnt(2)
v_mfma_f32_16x16x32_bf16 v[40:43], a[56:59], v[120:123], v[40:43]
v_cvt_pk_bf16_f32 v130, v36, v37
v_cvt_pk_bf16_f32 v131, v38, v39
v_mfma_f32_16x16x32_bf16 v[56:59], a[56:59], v[124:127], v[56:59]
buffer_store_dwordx4 v[128:131], v4, s[16:19], s62 offen sc1
s_waitcnt lgkmcnt(0)
v_mfma_f32_16x16x32_bf16 v[44:47], a[60:63], v[120:123], v[44:47]
s_nop 1
v_cvt_pk_bf16_f32 v132, v40, v41
v_cvt_pk_bf16_f32 v133, v42, v43
v_mfma_f32_16x16x32_bf16 v[60:63], a[60:63], v[124:127], v[60:63]
v_cvt_pk_bf16_f32 v138, v52, v53
v_cvt_pk_bf16_f32 v139, v54, v55
v_cvt_pk_bf16_f32 v140, v56, v57
v_cvt_pk_bf16_f32 v134, v44, v45
v_cvt_pk_bf16_f32 v135, v46, v47
v_cvt_pk_bf16_f32 v141, v58, v59
v_pk_mul_f32 v[146:147], v[32:33], v[32:33]
buffer_store_dwordx4 v[132:135], v4, s[16:19], s63 offen sc1
v_cvt_pk_bf16_f32 v142, v60, v61
v_cvt_pk_bf16_f32 v143, v62, v63
v_pk_mul_f32 v[150:151], v[48:49], v[48:49]
v_pk_fma_f32 v[146:147], v[34:35], v[34:35], v[146:147]
v_pk_add_f32 v[144:145], v[32:33], v[34:35]
v_pk_fma_f32 v[150:151], v[50:51], v[50:51], v[150:151]
v_pk_add_f32 v[148:149], v[48:49], v[50:51]
v_pk_fma_f32 v[146:147], v[36:37], v[36:37], v[146:147]
v_pk_add_f32 v[144:145], v[144:145], v[36:37]
v_pk_fma_f32 v[150:151], v[52:53], v[52:53], v[150:151]
v_pk_add_f32 v[148:149], v[148:149], v[52:53]
v_pk_fma_f32 v[146:147], v[38:39], v[38:39], v[146:147]
v_pk_add_f32 v[144:145], v[144:145], v[38:39]
buffer_store_dwordx4 v[136:139], v4, s[16:19], s62 offen offset:1024 sc1
v_pk_fma_f32 v[150:151], v[54:55], v[54:55], v[150:151]
v_pk_add_f32 v[148:149], v[148:149], v[54:55]
v_pk_fma_f32 v[146:147], v[40:41], v[40:41], v[146:147]
v_pk_add_f32 v[144:145], v[144:145], v[40:41]
v_pk_fma_f32 v[150:151], v[56:57], v[56:57], v[150:151]
v_pk_add_f32 v[148:149], v[148:149], v[56:57]
v_pk_fma_f32 v[146:147], v[42:43], v[42:43], v[146:147]
v_pk_add_f32 v[144:145], v[144:145], v[42:43]
v_pk_fma_f32 v[150:151], v[58:59], v[58:59], v[150:151]
v_pk_add_f32 v[148:149], v[148:149], v[58:59]
v_pk_fma_f32 v[146:147], v[44:45], v[44:45], v[146:147]
v_pk_add_f32 v[144:145], v[144:145], v[44:45]
v_pk_fma_f32 v[150:151], v[60:61], v[60:61], v[150:151]
buffer_store_dwordx4 v[140:143], v4, s[16:19], s63 offen offset:1024 sc1
v_pk_add_f32 v[148:149], v[148:149], v[60:61]
v_pk_fma_f32 v[146:147], v[46:47], v[46:47], v[146:147]
v_pk_add_f32 v[144:145], v[144:145], v[46:47]
v_pk_fma_f32 v[150:151], v[62:63], v[62:63], v[150:151]
v_pk_add_f32 v[148:149], v[148:149], v[62:63]
v_add_f32 v144, v144, v145
v_add_f32 v146, v146, v147
v_add_f32 v148, v148, v149
v_add_f32 v150, v150, v151
s_nop 0
v_permlane16_swap_b32 v144, v148
v_permlane16_swap_b32 v146, v150
v_add_f32 v144, v144, v148
v_add_f32 v146, v146, v150
s_nop 1
v_permlane32_swap_b32 v144, v146
v_add_f32 v144, v144, v146
buffer_store_dword v144, v152, s[16:19], s64 offen sc1
s_nop 1
v_accvgpr_write_b32 a224, v32
v_accvgpr_write_b32 a225, v33
v_accvgpr_write_b32 a226, v34
v_accvgpr_write_b32 a227, v35
v_accvgpr_write_b32 a228, v36
v_accvgpr_write_b32 a229, v37
v_accvgpr_write_b32 a230, v38
v_accvgpr_write_b32 a231, v39
v_accvgpr_write_b32 a232, v40
v_accvgpr_write_b32 a233, v41
v_accvgpr_write_b32 a234, v42
v_accvgpr_write_b32 a235, v43
v_accvgpr_write_b32 a236, v44
v_accvgpr_write_b32 a237, v45
v_accvgpr_write_b32 a238, v46
v_accvgpr_write_b32 a239, v47
v_accvgpr_write_b32 a240, v48
v_accvgpr_write_b32 a241, v49
v_accvgpr_write_b32 a242, v50
v_accvgpr_write_b32 a243, v51
v_accvgpr_write_b32 a244, v52
v_accvgpr_write_b32 a245, v53
v_accvgpr_write_b32 a246, v54
v_accvgpr_write_b32 a247, v55
v_accvgpr_write_b32 a248, v56
v_accvgpr_write_b32 a249, v57
v_accvgpr_write_b32 a250, v58
v_accvgpr_write_b32 a251, v59
v_accvgpr_write_b32 a252, v60
v_accvgpr_write_b32 a253, v61
v_accvgpr_write_b32 a254, v62
v_accvgpr_write_b32 a255, v63
s_lshl_b32 s62, s10, 14
s_lshl_b32 s63, s3, 12
s_add_u32 s62, s62, s63
s_lshl_b32 s63, s12, 11
s_add_u32 s62, s62, s63
v_lshl_add_u32 v10, v1, 4, s62
v_lshrrev_b32 v2, 3, v1
v_cmp_eq_u32 vcc, 3, v2
v_add_u32 v2, 67108480, v10
s_nop 0
v_cndmask_b32 v10, v10, v2, vcc
v_xor_b32 v11, 2048, v10
v_bfe_u32 v16, v1, 2, 3
v_mul_u32_u24 v16, 1056, v16
v_bfe_u32 v2, v1, 5, 1
v_lshl_add_u32 v16, v2, 8, v16
v_and_b32 v2, 3, v1
v_lshl_add_u32 v16, v2, 3, v16
s_lshl_b32 s62, s12, 6
s_add_u32 s62, s62, 83200
s_xor_b32 s63, s12, 1
s_mul_i32 s63, s63, 192
s_add_u32 s63, s63, 83200
v_add_u32 v17, s63, v16
v_add_u32 v16, s62, v16
s_mov_b32 s52, 8388608
s_mov_b32 s54, s58
s_mov_b32 s55, s59
s_mul_i32 s59, s3, 2080
s_lshl_b32 s62, s10, 15
s_lshl_b32 s63, s3, 13
s_add_u32 s62, s62, s63
v_lshl_add_u32 v4, v1, 4, s62
s_and_b32 s47, s5, 3
s_lshr_b32 s63, s5, 2
s_lshl_b32 s63, s63, 3
s_add_u32 s63, s63, s4
s_lshl_b32 s62, s63, 1
s_add_u32 s62, s62, s48
s_mul_i32 s62, s62, 1792
v_lshrrev_b32 v7, 2, v1
v_min_u32 v8, 13, v7
v_lshl_add_u32 v8, v8, 7, s62
s_lshl_b32 s62, s63, 2
s_add_u32 s62, s62, s3
s_mul_i32 s62, s62, 1280
v_min_u32 v7, 9, v7
v_lshl_add_u32 v7, v7, 7, s62
s_mul_i32 s44, s47, 327680
s_add_u32 s45, s47, 12
s_mul_i32 s45, s45, 229376
v_and_b32 v2, 1, v1
v_lshlrev_b32 v2, 4, v2
v_mov_b32 v9, 0x3f80
v_lshlrev_b32 v2, v2, v9
v_bfe_u32 v9, v1, 1, 3
v_cmp_eq_u32 vcc, 0, v9
s_nop 1
v_cndmask_b32 v20, 0, v2, vcc
v_cmp_eq_u32 vcc, 1, v9
s_nop 1
v_cndmask_b32 v21, 0, v2, vcc
v_cmp_eq_u32 vcc, 2, v9
s_nop 1
v_cndmask_b32 v22, 0, v2, vcc
v_cmp_eq_u32 vcc, 3, v9
s_nop 1
v_cndmask_b32 v23, 0, v2, vcc
s_add_u32 s62, s55, 83200
v_lshl_add_u32 v9, v1, 4, s62
v_mov_b64 v[24:25], 0
v_mov_b64 v[26:27], 0
s_lshl_b32 s62, s6, 7
s_add_u32 s62, s62, 30412800
s_lshl_b32 s64, s10, 1
s_lshl_b32 s64, s64, 7
s_add_u32 s64, s64, 30412800
s_add_u32 s65, s64, 128
v_mov_b32 v252, s62
v_mov_b32 v253, s64
v_writelane_b32 v253, s65, 1
s_waitcnt vmcnt(0) lgkmcnt(0)
s_barrier
s_cmp_lg_u32 s3, 0
s_cbranch_scc1 .Lnosig23
v_mov_b32 v255, 1
s_mov_b64 exec, 1
buffer_atomic_add v255, v252, s[16:19], 0 offen
s_mov_b64 exec, -1
.Lnosig23:
ds_read_b64_tr_b16 a[0:1], v16
ds_read_b64_tr_b16 a[2:3], v16 offset:512
ds_read_b64_tr_b16 a[4:5], v16 offset:32
ds_read_b64_tr_b16 a[6:7], v16 offset:544
ds_read_b64_tr_b16 a[8:9], v16 offset:8448
ds_read_b64_tr_b16 a[10:11], v16 offset:8960
ds_read_b64_tr_b16 a[12:13], v16 offset:8480
ds_read_b64_tr_b16 a[14:15], v16 offset:8992
ds_read_b64_tr_b16 a[16:17], v16 offset:64
ds_read_b64_tr_b16 a[18:19], v16 offset:576
ds_read_b64_tr_b16 a[20:21], v16 offset:96
ds_read_b64_tr_b16 a[22:23], v16 offset:608
ds_read_b64_tr_b16 a[24:25], v16 offset:8512
ds_read_b64_tr_b16 a[26:27], v16 offset:9024
ds_read_b64_tr_b16 a[28:29], v16 offset:8544
ds_read_b64_tr_b16 a[30:31], v16 offset:9056
ds_read_b64_tr_b16 a[32:33], v16 offset:128
ds_read_b64_tr_b16 a[34:35], v16 offset:640
ds_read_b64_tr_b16 a[36:37], v16 offset:160
ds_read_b64_tr_b16 a[38:39], v16 offset:672
ds_read_b64_tr_b16 a[40:41], v16 offset:8576
ds_read_b64_tr_b16 a[42:43], v16 offset:9088
ds_read_b64_tr_b16 a[44:45], v16 offset:8608
ds_read_b64_tr_b16 a[46:47], v16 offset:9120
ds_read_b64_tr_b16 a[48:49], v17
ds_read_b64_tr_b16 a[50:51], v17 offset:512
ds_read_b64_tr_b16 a[52:53], v17 offset:32
ds_read_b64_tr_b16 a[54:55], v17 offset:544
ds_read_b64_tr_b16 a[56:57], v17 offset:8448
ds_read_b64_tr_b16 a[58:59], v17 offset:8960
ds_read_b64_tr_b16 a[60:61], v17 offset:8480
ds_read_b64_tr_b16 a[62:63], v17 offset:8992
ds_read_b128 a[192:195], v9
ds_read_b128 a[196:199], v9 offset:1056
ds_read_b128 a[200:203], v9 offset:2112
ds_read_b128 a[204:207], v9 offset:3168
s_waitcnt lgkmcnt(0)
s_cmp_lg_u32 s3, 1
s_cbranch_scc1 .Lnopoll26
s_mov_b64 exec, 3
s_mov_b32 s15, 0
.Lpoll24:
buffer_load_dword v255, v253, s[16:19], 0 offen sc1
s_add_u32 s15, s15, 1
s_cmp_gt_u32 s15, 100000
s_cbranch_scc1 .Lgot25
s_waitcnt vmcnt(0)
v_cmp_ne_u32 vcc, 16, v255
s_nop 0
s_cbranch_vccnz .Lpoll24
.Lgot25:
s_waitcnt vmcnt(0)
s_branch .Lnopoll26r
.Lnopoll26:
s_mov_b64 exec, 0
s_cmp_eq_u32 s3, 2
s_cbranch_scc1 .Lpad11
s_cmp_eq_u32 s3, 3
s_cbranch_scc1 .Lpad12
s_branch .Lpad13
.Lnopoll26r:
s_mov_b64 exec, -1
s_barrier
buffer_load_dwordx4 a[128:131], v10, s[16:19], s52 offen sc1
buffer_load_dwordx4 a[132:135], v10, s[16:19], s52 offen offset:1024 sc1
buffer_load_dwordx4 a[136:139], v11, s[16:19], s52 offen sc1
buffer_load_dwordx4 a[140:143], v11, s[16:19], s52 offen offset:1024 sc1
s_add_u32 s52, s52, 0x20000
buffer_load_dwordx4 a[144:147], v10, s[16:19], s52 offen sc1
buffer_load_dwordx4 a[148:151], v10, s[16:19], s52 offen offset:1024 sc1
buffer_load_dwordx4 a[152:155], v11, s[16:19], s52 offen sc1
buffer_load_dwordx4 a[156:159], v11, s[16:19], s52 offen offset:1024 sc1
s_add_u32 s52, s52, 0x20000
s_lshl_b32 s74, s3, 13
s_add_u32 s74, s74, 49920
v_lshl_add_u32 v2, v1, 4, s74
s_waitcnt vmcnt(7)
v_mfma_f32_16x16x32_bf16 v[32:35], a[0:3], a[128:131], 0
ds_read_b64_tr_b16 a[64:65], v16 offset:16896
s_waitcnt vmcnt(6)
v_mfma_f32_16x16x32_bf16 v[36:39], a[0:3], a[132:135], 0
buffer_load_dwordx4 a[160:163], v10, s[16:19], s52 offen sc1
s_waitcnt vmcnt(6)
v_mfma_f32_16x16x32_bf16 v[40:43], a[0:3], a[136:139], 0
ds_read_b64_tr_b16 a[66:67], v16 offset:17408
s_waitcnt vmcnt(5)
v_mfma_f32_16x16x32_bf16 v[44:47], a[0:3], a[140:143], 0
ds_read_b64_tr_b16 a[68:69], v16 offset:16928
v_mfma_f32_16x16x32_bf16 v[48:51], a[4:7], a[128:131], 0
ds_read_b64_tr_b16 a[70:71], v16 offset:17440
v_mfma_f32_16x16x32_bf16 v[52:55], a[4:7], a[132:135], 0
buffer_load_dwordx4 a[164:167], v10, s[16:19], s52 offen offset:1024 sc1
v_mfma_f32_16x16x32_bf16 v[24:27], v[20:23], a[192:195], v[24:27]
ds_read_b64_tr_b16 a[72:73], v16 offset:25344
v_mfma_f32_16x16x32_bf16 v[56:59], a[4:7], a[136:139], 0
ds_read_b64_tr_b16 a[74:75], v16 offset:25856
v_mfma_f32_16x16x32_bf16 v[60:63], a[4:7], a[140:143], 0
v_mfma_f32_16x16x32_bf16 v[64:67], a[8:11], a[128:131], 0
ds_read_b64_tr_b16 a[76:77], v16 offset:25376
v_mfma_f32_16x16x32_bf16 v[68:71], a[8:11], a[132:135], 0
buffer_load_dwordx4 a[168:171], v11, s[16:19], s52 offen sc1
v_mfma_f32_16x16x32_bf16 v[72:75], a[8:11], a[136:139], 0
ds_read_b64_tr_b16 a[78:79], v16 offset:25888
v_mfma_f32_16x16x32_bf16 v[76:79], a[8:11], a[140:143], 0
ds_read_b64_tr_b16 a[80:81], v16 offset:16960
v_mfma_f32_16x16x32_bf16 v[80:83], a[12:15], a[128:131], 0
ds_read_b64_tr_b16 a[82:83], v16 offset:17472
v_mfma_f32_16x16x32_bf16 v[84:87], a[12:15], a[132:135], 0
ds_read_b64_tr_b16 a[84:85], v16 offset:16992
v_mfma_f32_16x16x32_bf16 v[88:91], a[12:15], a[136:139], 0
buffer_load_dwordx4 a[172:175], v11, s[16:19], s52 offen offset:1024 sc1
v_mfma_f32_16x16x32_bf16 v[92:95], a[12:15], a[140:143], 0
s_add_u32 s52, s52, 0x20000
v_mfma_f32_16x16x32_bf16 v[96:99], a[16:19], a[128:131], 0
ds_read_b64_tr_b16 a[86:87], v16 offset:17504
v_mfma_f32_16x16x32_bf16 v[100:103], a[16:19], a[132:135], 0
ds_read_b64_tr_b16 a[88:89], v16 offset:25408
v_mfma_f32_16x16x32_bf16 v[24:27], v[20:23], a[196:199], v[24:27]
ds_read_b64_tr_b16 a[90:91], v16 offset:25920
s_add_u32 m0, s55, 83200
v_mfma_f32_16x16x32_bf16 v[104:107], a[16:19], a[136:139], 0
buffer_load_dwordx4 v12, s[32:35], s54 offen lds
v_mfma_f32_16x16x32_bf16 v[108:111], a[16:19], a[140:143], 0
ds_read_b64_tr_b16 a[92:93], v16 offset:25440
v_mfma_f32_16x16x32_bf16 v[112:115], a[20:23], a[128:131], 0
ds_read_b64_tr_b16 a[94:95], v16 offset:25952
v_mfma_f32_16x16x32_bf16 v[116:119], a[20:23], a[132:135], 0
v_mfma_f32_16x16x32_bf16 v[120:123], a[20:23], a[136:139], 0
ds_read_b64_tr_b16 a[96:97], v16 offset:17024
v_mfma_f32_16x16x32_bf16 v[124:127], a[20:23], a[140:143], 0
buffer_load_dwordx4 a[176:179], v10, s[16:19], s52 offen sc1
v_mfma_f32_16x16x32_bf16 v[128:131], a[24:27], a[128:131], 0
ds_read_b64_tr_b16 a[98:99], v16 offset:17536
v_mfma_f32_16x16x32_bf16 v[132:135], a[24:27], a[132:135], 0
ds_read_b64_tr_b16 a[100:101], v16 offset:17056
v_mfma_f32_16x16x32_bf16 v[136:139], a[24:27], a[136:139], 0
ds_read_b64_tr_b16 a[102:103], v16 offset:17568
v_mfma_f32_16x16x32_bf16 v[140:143], a[24:27], a[140:143], 0
ds_read_b64_tr_b16 a[104:105], v16 offset:25472
v_mfma_f32_16x16x32_bf16 v[144:147], a[28:31], a[128:131], 0
buffer_load_dwordx4 v13, s[32:35], s54 offen offset:1056 lds
v_mfma_f32_16x16x32_bf16 v[148:151], a[28:31], a[132:135], 0
v_mfma_f32_16x16x32_bf16 v[24:27], v[20:23], a[200:203], v[24:27]
ds_read_b64_tr_b16 a[106:107], v16 offset:25984
v_mfma_f32_16x16x32_bf16 v[152:155], a[28:31], a[136:139], 0
ds_read_b64_tr_b16 a[108:109], v16 offset:25504
v_mfma_f32_16x16x32_bf16 v[156:159], a[28:31], a[140:143], 0
buffer_load_dwordx4 a[180:183], v10, s[16:19], s52 offen offset:1024 sc1
v_mfma_f32_16x16x32_bf16 v[160:163], a[32:35], a[128:131], 0
ds_read_b64_tr_b16 a[110:111], v16 offset:26016
v_mfma_f32_16x16x32_bf16 v[164:167], a[32:35], a[132:135], 0
ds_read_b64_tr_b16 a[112:113], v17 offset:16896
v_mfma_f32_16x16x32_bf16 v[168:171], a[32:35], a[136:139], 0
ds_read_b64_tr_b16 a[114:115], v17 offset:17408
v_mfma_f32_16x16x32_bf16 v[172:175], a[32:35], a[140:143], 0
v_mfma_f32_16x16x32_bf16 v[176:179], a[36:39], a[128:131], 0
buffer_load_dwordx4 v14, s[32:35], s54 offen offset:2112 lds
v_mfma_f32_16x16x32_bf16 v[180:183], a[36:39], a[132:135], 0
ds_read_b64_tr_b16 a[116:117], v17 offset:16928
v_mfma_f32_16x16x32_bf16 v[184:187], a[36:39], a[136:139], 0
ds_read_b64_tr_b16 a[118:119], v17 offset:17440
v_mfma_f32_16x16x32_bf16 v[188:191], a[36:39], a[140:143], 0
ds_read_b64_tr_b16 a[120:121], v17 offset:25344
v_mfma_f32_16x16x32_bf16 v[192:195], a[40:43], a[128:131], 0
ds_read_b64_tr_b16 a[122:123], v17 offset:25856
v_mfma_f32_16x16x32_bf16 v[196:199], a[40:43], a[132:135], 0
buffer_load_dwordx4 a[184:187], v11, s[16:19], s52 offen sc1
v_mfma_f32_16x16x32_bf16 v[24:27], v[20:23], a[204:207], v[24:27]
ds_read_b64_tr_b16 a[124:125], v17 offset:25376
v_mfma_f32_16x16x32_bf16 v[200:203], a[40:43], a[136:139], 0
v_mfma_f32_16x16x32_bf16 v[204:207], a[40:43], a[140:143], 0
ds_read_b64_tr_b16 a[126:127], v17 offset:25888
v_mfma_f32_16x16x32_bf16 v[208:211], a[44:47], a[128:131], 0
ds_read_b128 a[208:211], v9 offset:16896
v_mfma_f32_16x16x32_bf16 v[212:215], a[44:47], a[132:135], 0
buffer_load_dwordx4 v15, s[32:35], s54 offen offset:3168 lds
v_mfma_f32_16x16x32_bf16 v[216:219], a[44:47], a[136:139], 0
ds_read_b128 a[212:215], v9 offset:17952
s_add_u32 s54, s54, 229376
v_mfma_f32_16x16x32_bf16 v[220:223], a[44:47], a[140:143], 0
ds_read_b128 a[216:219], v9 offset:19008
v_mfma_f32_16x16x32_bf16 v[224:227], a[48:51], a[128:131], 0
ds_read_b128 a[220:223], v9 offset:20064
v_mfma_f32_16x16x32_bf16 v[228:231], a[48:51], a[132:135], 0
v_mfma_f32_16x16x32_bf16 v[232:235], a[52:55], a[128:131], 0
buffer_load_dwordx4 a[188:191], v11, s[16:19], s52 offen offset:1024 sc1
v_mfma_f32_16x16x32_bf16 v[236:239], a[52:55], a[132:135], 0
s_add_u32 s52, s52, 0x20000
v_mfma_f32_16x16x32_bf16 v[240:243], a[56:59], a[128:131], 0
v_mfma_f32_16x16x32_bf16 v[244:247], a[56:59], a[132:135], 0
v_mfma_f32_16x16x32_bf16 v[248:251], a[60:63], a[128:131], 0
v_mfma_f32_16x16x32_bf16 v[252:255], a[60:63], a[132:135], 0
s_waitcnt lgkmcnt(0)
s_barrier
s_waitcnt vmcnt(15)
v_mfma_f32_16x16x32_bf16 v[32:35], a[64:67], a[144:147], v[32:35]
s_add_u32 m0, s74, 0
s_mov_b32 s67, 29622272
s_waitcnt vmcnt(14)
v_mfma_f32_16x16x32_bf16 v[36:39], a[64:67], a[148:151], v[36:39]
buffer_load_dwordx4 v4, s[16:19], s67 offen sc1 lds
s_waitcnt vmcnt(14)
v_mfma_f32_16x16x32_bf16 v[40:43], a[64:67], a[152:155], v[40:43]
ds_read_b64_tr_b16 a[0:1], v16 offset:33792
s_waitcnt vmcnt(13)
v_mfma_f32_16x16x32_bf16 v[44:47], a[64:67], a[156:159], v[44:47]
ds_read_b64_tr_b16 a[2:3], v16 offset:34304
v_mfma_f32_16x16x32_bf16 v[48:51], a[68:71], a[144:147], v[48:51]
buffer_load_dwordx4 v4, s[16:19], s67 offen offset:1024 sc1 lds
v_mfma_f32_16x16x32_bf16 v[52:55], a[68:71], a[148:151], v[52:55]
ds_read_b64_tr_b16 a[4:5], v16 offset:33824
v_mfma_f32_16x16x32_bf16 v[24:27], v[20:23], a[208:211], v[24:27]
ds_read_b64_tr_b16 a[6:7], v16 offset:34336
v_mfma_f32_16x16x32_bf16 v[56:59], a[68:71], a[152:155], v[56:59]
ds_read_b64_tr_b16 a[8:9], v16 offset:42240
v_mfma_f32_16x16x32_bf16 v[60:63], a[68:71], a[156:159], v[60:63]
buffer_load_dwordx4 v4, s[16:19], s67 offen offset:2048 sc1 lds
v_mfma_f32_16x16x32_bf16 v[64:67], a[72:75], a[144:147], v[64:67]
ds_read_b64_tr_b16 a[10:11], v16 offset:42752
v_mfma_f32_16x16x32_bf16 v[68:71], a[72:75], a[148:151], v[68:71]
ds_read_b64_tr_b16 a[12:13], v16 offset:42272
v_mfma_f32_16x16x32_bf16 v[72:75], a[72:75], a[152:155], v[72:75]
buffer_load_dwordx4 v4, s[16:19], s67 offen offset:3072 sc1 lds
v_mfma_f32_16x16x32_bf16 v[76:79], a[72:75], a[156:159], v[76:79]
ds_read_b64_tr_b16 a[14:15], v16 offset:42784
v_mfma_f32_16x16x32_bf16 v[80:83], a[76:79], a[144:147], v[80:83]
ds_read_b64_tr_b16 a[16:17], v16 offset:33856
v_mfma_f32_16x16x32_bf16 v[84:87], a[76:79], a[148:151], v[84:87]
s_add_u32 m0, s74, 4096
s_mov_b32 s67, 29626368
v_mfma_f32_16x16x32_bf16 v[88:91], a[76:79], a[152:155], v[88:91]
buffer_load_dwordx4 v4, s[16:19], s67 offen sc1 lds
v_mfma_f32_16x16x32_bf16 v[92:95], a[76:79], a[156:159], v[92:95]
ds_read_b64_tr_b16 a[18:19], v16 offset:34368
v_mfma_f32_16x16x32_bf16 v[96:99], a[80:83], a[144:147], v[96:99]
ds_read_b64_tr_b16 a[20:21], v16 offset:33888
v_mfma_f32_16x16x32_bf16 v[100:103], a[80:83], a[148:151], v[100:103]
ds_read_b64_tr_b16 a[22:23], v16 offset:34400
v_mfma_f32_16x16x32_bf16 v[24:27], v[20:23], a[212:215], v[24:27]
buffer_load_dwordx4 v4, s[16:19], s67 offen offset:1024 sc1 lds
v_mfma_f32_16x16x32_bf16 v[104:107], a[80:83], a[152:155], v[104:107]
ds_read_b64_tr_b16 a[24:25], v16 offset:42304
v_mfma_f32_16x16x32_bf16 v[108:111], a[80:83], a[156:159], v[108:111]
ds_read_b64_tr_b16 a[26:27], v16 offset:42816
v_mfma_f32_16x16x32_bf16 v[112:115], a[84:87], a[144:147], v[112:115]
buffer_load_dwordx4 v4, s[16:19], s67 offen offset:2048 sc1 lds
v_mfma_f32_16x16x32_bf16 v[116:119], a[84:87], a[148:151], v[116:119]
ds_read_b64_tr_b16 a[28:29], v16 offset:42336
v_mfma_f32_16x16x32_bf16 v[120:123], a[84:87], a[152:155], v[120:123]
ds_read_b64_tr_b16 a[30:31], v16 offset:42848
v_mfma_f32_16x16x32_bf16 v[124:127], a[84:87], a[156:159], v[124:127]
ds_read_b64_tr_b16 a[32:33], v16 offset:33920
v_mfma_f32_16x16x32_bf16 v[128:131], a[88:91], a[144:147], v[128:131]
buffer_load_dwordx4 v4, s[16:19], s67 offen offset:3072 sc1 lds
v_mfma_f32_16x16x32_bf16 v[132:135], a[88:91], a[148:151], v[132:135]
ds_read_b64_tr_b16 a[34:35], v16 offset:34432
v_mfma_f32_16x16x32_bf16 v[136:139], a[88:91], a[152:155], v[136:139]
v_mfma_f32_16x16x32_bf16 v[140:143], a[88:91], a[156:159], v[140:143]
ds_read_b64_tr_b16 a[36:37], v16 offset:33952
s_add_u32 m0, s55, 100096
v_mfma_f32_16x16x32_bf16 v[144:147], a[92:95], a[144:147], v[144:147]
buffer_load_dwordx4 v12, s[32:35], s54 offen lds
v_mfma_f32_16x16x32_bf16 v[148:151], a[92:95], a[148:151], v[148:151]
ds_read_b64_tr_b16 a[38:39], v16 offset:34464
v_mfma_f32_16x16x32_bf16 v[24:27], v[20:23], a[216:219], v[24:27]
ds_read_b64_tr_b16 a[40:41], v16 offset:42368
v_mfma_f32_16x16x32_bf16 v[152:155], a[92:95], a[152:155], v[152:155]
buffer_load_dwordx4 a[128:131], v10, s[16:19], s52 offen sc1
v_mfma_f32_16x16x32_bf16 v[156:159], a[92:95], a[156:159], v[156:159]
ds_read_b64_tr_b16 a[42:43], v16 offset:42880
v_mfma_f32_16x16x32_bf16 v[160:163], a[96:99], a[144:147], v[160:163]
ds_read_b64_tr_b16 a[44:45], v16 offset:42400
v_mfma_f32_16x16x32_bf16 v[164:167], a[96:99], a[148:151], v[164:167]
ds_read_b64_tr_b16 a[46:47], v16 offset:42912
v_mfma_f32_16x16x32_bf16 v[168:171], a[96:99], a[152:155], v[168:171]
buffer_load_dwordx4 v13, s[32:35], s54 offen offset:1056 lds
v_mfma_f32_16x16x32_bf16 v[172:175], a[96:99], a[156:159], v[172:175]
ds_read_b64_tr_b16 a[48:49], v17 offset:33792
v_mfma_f32_16x16x32_bf16 v[176:179], a[100:103], a[144:147], v[176:179]
ds_read_b64_tr_b16 a[50:51], v17 offset:34304
v_mfma_f32_16x16x32_bf16 v[180:183], a[100:103], a[148:151], v[180:183]
buffer_load_dwordx4 a[132:135], v10, s[16:19], s52 offen offset:1024 sc1
v_mfma_f32_16x16x32_bf16 v[184:187], a[100:103], a[152:155], v[184:187]
ds_read_b64_tr_b16 a[52:53], v17 offset:33824
v_mfma_f32_16x16x32_bf16 v[188:191], a[100:103], a[156:159], v[188:191]
ds_read_b64_tr_b16 a[54:55], v17 offset:34336
v_mfma_f32_16x16x32_bf16 v[192:195], a[104:107], a[144:147], v[192:195]
ds_read_b64_tr_b16 a[56:57], v17 offset:42240
v_mfma_f32_16x16x32_bf16 v[196:199], a[104:107], a[148:151], v[196:199]
buffer_load_dwordx4 v14, s[32:35], s54 offen offset:2112 lds
v_mfma_f32_16x16x32_bf16 v[24:27], v[20:23], a[220:223], v[24:27]
ds_read_b64_tr_b16 a[58:59], v17 offset:42752
v_mfma_f32_16x16x32_bf16 v[200:203], a[104:107], a[152:155], v[200:203]
ds_read_b64_tr_b16 a[60:61], v17 offset:42272
v_mfma_f32_16x16x32_bf16 v[204:207], a[104:107], a[156:159], v[204:207]
ds_read_b64_tr_b16 a[62:63], v17 offset:42784
v_mfma_f32_16x16x32_bf16 v[208:211], a[108:111], a[144:147], v[208:211]
buffer_load_dwordx4 a[136:139], v11, s[16:19], s52 offen sc1
v_mfma_f32_16x16x32_bf16 v[212:215], a[108:111], a[148:151], v[212:215]
ds_read_b128 a[192:195], v9 offset:33792
v_mfma_f32_16x16x32_bf16 v[216:219], a[108:111], a[152:155], v[216:219]
ds_read_b128 a[196:199], v9 offset:34848
v_mfma_f32_16x16x32_bf16 v[220:223], a[108:111], a[156:159], v[220:223]
buffer_load_dwordx4 v15, s[32:35], s54 offen offset:3168 lds
v_mfma_f32_16x16x32_bf16 v[224:227], a[112:115], a[144:147], v[224:227]
ds_read_b128 a[200:203], v9 offset:35904
s_add_u32 s54, s54, 229376
v_mfma_f32_16x16x32_bf16 v[228:231], a[112:115], a[148:151], v[228:231]
ds_read_b128 a[204:207], v9 offset:36960
v_mfma_f32_16x16x32_bf16 v[232:235], a[116:119], a[144:147], v[232:235]
v_mfma_f32_16x16x32_bf16 v[236:239], a[116:119], a[148:151], v[236:239]
buffer_load_dwordx4 a[140:143], v11, s[16:19], s52 offen offset:1024 sc1
v_mfma_f32_16x16x32_bf16 v[240:243], a[120:123], a[144:147], v[240:243]
s_add_u32 s52, s52, 0x20000
v_mfma_f32_16x16x32_bf16 v[244:247], a[120:123], a[148:151], v[244:247]
v_mfma_f32_16x16x32_bf16 v[248:251], a[124:127], a[144:147], v[248:251]
v_mfma_f32_16x16x32_bf16 v[252:255], a[124:127], a[148:151], v[252:255]
s_waitcnt lgkmcnt(0)
s_barrier
s_waitcnt vmcnt(27)
v_mfma_f32_16x16x32_bf16 v[32:35], a[0:3], a[160:163], v[32:35]
ds_read_b64_tr_b16 a[64:65], v16 offset:50688
s_add_u32 m0, s55, 116992
s_waitcnt vmcnt(26)
v_mfma_f32_16x16x32_bf16 v[36:39], a[0:3], a[164:167], v[36:39]
buffer_load_dwordx4 v12, s[32:35], s54 offen lds
s_waitcnt vmcnt(26)
v_mfma_f32_16x16x32_bf16 v[40:43], a[0:3], a[168:171], v[40:43]
ds_read_b64_tr_b16 a[66:67], v16 offset:51200
s_waitcnt vmcnt(25)
v_mfma_f32_16x16x32_bf16 v[44:47], a[0:3], a[172:175], v[44:47]
ds_read_b64_tr_b16 a[68:69], v16 offset:50720
v_mfma_f32_16x16x32_bf16 v[48:51], a[4:7], a[160:163], v[48:51]
ds_read_b64_tr_b16 a[70:71], v16 offset:51232
v_mfma_f32_16x16x32_bf16 v[52:55], a[4:7], a[164:167], v[52:55]
v_mfma_f32_16x16x32_bf16 v[24:27], v[20:23], a[192:195], v[24:27]
ds_read_b64_tr_b16 a[72:73], v16 offset:59136
v_mfma_f32_16x16x32_bf16 v[56:59], a[4:7], a[168:171], v[56:59]
ds_read_b64_tr_b16 a[74:75], v16 offset:59648
v_mfma_f32_16x16x32_bf16 v[60:63], a[4:7], a[172:175], v[60:63]
buffer_load_dwordx4 a[144:147], v10, s[16:19], s52 offen sc1
v_mfma_f32_16x16x32_bf16 v[64:67], a[8:11], a[160:163], v[64:67]
ds_read_b64_tr_b16 a[76:77], v16 offset:59168
v_mfma_f32_16x16x32_bf16 v[68:71], a[8:11], a[164:167], v[68:71]
v_mfma_f32_16x16x32_bf16 v[72:75], a[8:11], a[168:171], v[72:75]
ds_read_b64_tr_b16 a[78:79], v16 offset:59680
v_mfma_f32_16x16x32_bf16 v[76:79], a[8:11], a[172:175], v[76:79]
ds_read_b64_tr_b16 a[80:81], v16 offset:50752
v_lshrrev_b32 v2, 1, v2
v_mfma_f32_16x16x32_bf16 v[80:83], a[12:15], a[160:163], v[80:83]
ds_read_b64_tr_b16 a[82:83], v16 offset:51264
v_mfma_f32_16x16x32_bf16 v[84:87], a[12:15], a[164:167], v[84:87]
s_lshr_b32 s67, s74, 1
v_mfma_f32_16x16x32_bf16 v[88:91], a[12:15], a[168:171], v[88:91]
buffer_load_dwordx4 v13, s[32:35], s54 offen offset:1056 lds
v_mfma_f32_16x16x32_bf16 v[92:95], a[12:15], a[172:175], v[92:95]
ds_read_b64_tr_b16 a[84:85], v16 offset:50784
v_add_u32 v2, s67, v2
v_mfma_f32_16x16x32_bf16 v[96:99], a[16:19], a[160:163], v[96:99]
ds_read_b64_tr_b16 a[86:87], v16 offset:51296
v_mfma_f32_16x16x32_bf16 v[100:103], a[16:19], a[164:167], v[100:103]
ds_read_b64_tr_b16 a[88:89], v16 offset:59200
s_waitcnt vmcnt(11)
ds_read_b64 v[28:29], v2
v_mfma_f32_16x16x32_bf16 v[24:27], v[20:23], a[196:199], v[24:27]
ds_read_b64_tr_b16 a[90:91], v16 offset:59712
v_mfma_f32_16x16x32_bf16 v[104:107], a[16:19], a[168:171], v[104:107]
ds_read_b64 v[30:31], v2 offset:512
v_mfma_f32_16x16x32_bf16 v[108:111], a[16:19], a[172:175], v[108:111]
ds_read_b64_tr_b16 a[92:93], v16 offset:59232
v_mfma_f32_16x16x32_bf16 v[112:115], a[20:23], a[160:163], v[112:115]
.Lpad11:
s_cbranch_execz .Lpad14
buffer_load_dwordx4 a[148:151], v10, s[16:19], s52 offen offset:1024 sc1
v_mfma_f32_16x16x32_bf16 v[116:119], a[20:23], a[164:167], v[116:119]
ds_read_b64_tr_b16 a[94:95], v16 offset:59744
ds_read_b64 v[18:19], v2 offset:1024
v_mfma_f32_16x16x32_bf16 v[120:123], a[20:23], a[168:171], v[120:123]
ds_read_b64_tr_b16 a[96:97], v16 offset:50816
v_mfma_f32_16x16x32_bf16 v[124:127], a[20:23], a[172:175], v[124:127]
s_waitcnt lgkmcnt(4)
v_add_f32 v28, v28, v30
v_mfma_f32_16x16x32_bf16 v[128:131], a[24:27], a[160:163], v[128:131]
ds_read_b64_tr_b16 a[98:99], v16 offset:51328
v_add_f32 v29, v29, v31
v_mfma_f32_16x16x32_bf16 v[132:135], a[24:27], a[164:167], v[132:135]
ds_read_b64_tr_b16 a[100:101], v16 offset:50848
v_mfma_f32_16x16x32_bf16 v[136:139], a[24:27], a[168:171], v[136:139]
ds_read_b64_tr_b16 a[102:103], v16 offset:51360
ds_read_b64 v[30:31], v2 offset:1536
v_mfma_f32_16x16x32_bf16 v[140:143], a[24:27], a[172:175], v[140:143]
s_waitcnt lgkmcnt(5)
v_add_f32 v28, v28, v18
v_mfma_f32_16x16x32_bf16 v[144:147], a[28:31], a[160:163], v[144:147]
buffer_load_dwordx4 v14, s[32:35], s54 offen offset:2112 lds
v_mfma_f32_16x16x32_bf16 v[148:151], a[28:31], a[164:167], v[148:151]
ds_read_b64_tr_b16 a[104:105], v16 offset:59264
v_mfma_f32_16x16x32_bf16 v[24:27], v[20:23], a[200:203], v[24:27]
ds_read_b64_tr_b16 a[106:107], v16 offset:59776
v_mfma_f32_16x16x32_bf16 v[152:155], a[28:31], a[168:171], v[152:155]
ds_read_b64_tr_b16 a[108:109], v16 offset:59296
v_add_f32 v29, v29, v19
v_mfma_f32_16x16x32_bf16 v[156:159], a[28:31], a[172:175], v[156:159]
ds_read_b64 v[18:19], v2 offset:2048
v_mfma_f32_16x16x32_bf16 v[160:163], a[32:35], a[160:163], v[160:163]
ds_read_b64_tr_b16 a[110:111], v16 offset:59808
v_mfma_f32_16x16x32_bf16 v[164:167], a[32:35], a[164:167], v[164:167]
ds_read_b64_tr_b16 a[112:113], v17 offset:50688
s_waitcnt lgkmcnt(6)
v_add_f32 v28, v28, v30
v_mfma_f32_16x16x32_bf16 v[168:171], a[32:35], a[168:171], v[168:171]
buffer_load_dwordx4 a[152:155], v11, s[16:19], s52 offen sc1
v_mfma_f32_16x16x32_bf16 v[172:175], a[32:35], a[172:175], v[172:175]
ds_read_b64_tr_b16 a[114:115], v17 offset:51200
v_mfma_f32_16x16x32_bf16 v[176:179], a[36:39], a[160:163], v[176:179]
ds_read_b64_tr_b16 a[116:117], v17 offset:50720
v_add_f32 v29, v29, v31
v_mfma_f32_16x16x32_bf16 v[180:183], a[36:39], a[164:167], v[180:183]
ds_read_b64 v[30:31], v2 offset:2560
v_mfma_f32_16x16x32_bf16 v[184:187], a[36:39], a[168:171], v[184:187]
ds_read_b64_tr_b16 a[118:119], v17 offset:51232
v_mfma_f32_16x16x32_bf16 v[188:191], a[36:39], a[172:175], v[188:191]
ds_read_b64_tr_b16 a[120:121], v17 offset:59136
v_mfma_f32_16x16x32_bf16 v[192:195], a[40:43], a[160:163], v[192:195]
ds_read_b64_tr_b16 a[122:123], v17 offset:59648
s_waitcnt lgkmcnt(8)
v_add_f32 v28, v28, v18
v_mfma_f32_16x16x32_bf16 v[196:199], a[40:43], a[164:167], v[196:199]
buffer_load_dwordx4 v15, s[32:35], s54 offen offset:3168 lds
v_mfma_f32_16x16x32_bf16 v[24:27], v[20:23], a[204:207], v[24:27]
s_add_u32 s54, s54, 229376
v_add_f32 v29, v29, v19
v_mfma_f32_16x16x32_bf16 v[200:203], a[40:43], a[168:171], v[200:203]
ds_read_b64_tr_b16 a[124:125], v17 offset:59168
v_mfma_f32_16x16x32_bf16 v[204:207], a[40:43], a[172:175], v[204:207]
ds_read_b64_tr_b16 a[126:127], v17 offset:59680
ds_read_b64 v[18:19], v2 offset:3072
v_mfma_f32_16x16x32_bf16 v[208:211], a[44:47], a[160:163], v[208:211]
ds_read_b128 a[208:211], v9 offset:50688
v_mfma_f32_16x16x32_bf16 v[212:215], a[44:47], a[164:167], v[212:215]
s_waitcnt lgkmcnt(7)
v_add_f32 v28, v28, v30
v_mfma_f32_16x16x32_bf16 v[216:219], a[44:47], a[168:171], v[216:219]
ds_read_b128 a[212:215], v9 offset:51744
v_add_f32 v29, v29, v31
v_mfma_f32_16x16x32_bf16 v[220:223], a[44:47], a[172:175], v[220:223]
buffer_load_dwordx4 a[156:159], v11, s[16:19], s52 offen offset:1024 sc1
v_mfma_f32_16x16x32_bf16 v[224:227], a[48:51], a[160:163], v[224:227]
ds_read_b128 a[216:219], v9 offset:52800
s_add_u32 s52, s52, 0x20000
v_mfma_f32_16x16x32_bf16 v[228:231], a[48:51], a[164:167], v[228:231]
ds_read_b128 a[220:223], v9 offset:53856
v_mfma_f32_16x16x32_bf16 v[232:235], a[52:55], a[160:163], v[232:235]
ds_read_b64 v[30:31], v2 offset:3584
v_mfma_f32_16x16x32_bf16 v[236:239], a[52:55], a[164:167], v[236:239]
s_waitcnt lgkmcnt(5)
v_add_f32 v28, v28, v18
v_mfma_f32_16x16x32_bf16 v[240:243], a[56:59], a[160:163], v[240:243]
v_add_f32 v29, v29, v19
v_mfma_f32_16x16x32_bf16 v[244:247], a[56:59], a[164:167], v[244:247]
ds_read_b64 v[18:19], v2 offset:4096
v_mfma_f32_16x16x32_bf16 v[248:251], a[60:63], a[160:163], v[248:251]
v_mfma_f32_16x16x32_bf16 v[252:255], a[60:63], a[164:167], v[252:255]
s_waitcnt lgkmcnt(0)
s_barrier
v_mfma_f32_16x16x32_bf16 v[32:35], a[64:67], a[176:179], v[32:35]
ds_read_b64_tr_b16 a[0:1], v16
s_add_u32 m0, s55, 133888
v_mfma_f32_16x16x32_bf16 v[36:39], a[64:67], a[180:183], v[36:39]
buffer_load_dwordx4 v12, s[32:35], s54 offen lds
v_mfma_f32_16x16x32_bf16 v[40:43], a[64:67], a[184:187], v[40:43]
ds_read_b64_tr_b16 a[2:3], v16 offset:512
v_add_f32 v28, v28, v30
v_mfma_f32_16x16x32_bf16 v[44:47], a[64:67], a[188:191], v[44:47]
ds_read_b64_tr_b16 a[4:5], v16 offset:32
v_add_f32 v29, v29, v31
v_mfma_f32_16x16x32_bf16 v[48:51], a[68:71], a[176:179], v[48:51]
ds_read_b64_tr_b16 a[6:7], v16 offset:544
v_mfma_f32_16x16x32_bf16 v[52:55], a[68:71], a[180:183], v[52:55]
ds_read_b64 v[30:31], v2 offset:4608
v_mfma_f32_16x16x32_bf16 v[24:27], v[20:23], a[208:211], v[24:27]
ds_read_b64_tr_b16 a[8:9], v16 offset:8448
v_add_f32 v28, v28, v18
v_mfma_f32_16x16x32_bf16 v[56:59], a[68:71], a[184:187], v[56:59]
ds_read_b64_tr_b16 a[10:11], v16 offset:8960
v_mfma_f32_16x16x32_bf16 v[60:63], a[68:71], a[188:191], v[60:63]
buffer_load_dwordx4 a[160:163], v10, s[16:19], s52 offen sc1
v_mfma_f32_16x16x32_bf16 v[64:67], a[72:75], a[176:179], v[64:67]
ds_read_b64_tr_b16 a[12:13], v16 offset:8480
v_add_f32 v29, v29, v19
v_mfma_f32_16x16x32_bf16 v[68:71], a[72:75], a[180:183], v[68:71]
ds_read_b64 v[18:19], v2 offset:5120
v_mfma_f32_16x16x32_bf16 v[72:75], a[72:75], a[184:187], v[72:75]
ds_read_b64_tr_b16 a[14:15], v16 offset:8992
s_waitcnt lgkmcnt(5)
v_add_f32 v28, v28, v30
v_mfma_f32_16x16x32_bf16 v[76:79], a[72:75], a[188:191], v[76:79]
ds_read_b64_tr_b16 a[16:17], v16 offset:64
v_mfma_f32_16x16x32_bf16 v[80:83], a[76:79], a[176:179], v[80:83]
ds_read_b64_tr_b16 a[18:19], v16 offset:576
v_add_f32 v29, v29, v31
v_mfma_f32_16x16x32_bf16 v[84:87], a[76:79], a[180:183], v[84:87]
ds_read_b64 v[30:31], v2 offset:5632
v_mfma_f32_16x16x32_bf16 v[88:91], a[76:79], a[184:187], v[88:91]
buffer_load_dwordx4 v13, s[32:35], s54 offen offset:1056 lds
v_mfma_f32_16x16x32_bf16 v[92:95], a[76:79], a[188:191], v[92:95]
ds_read_b64_tr_b16 a[20:21], v16 offset:96
v_mfma_f32_16x16x32_bf16 v[96:99], a[80:83], a[176:179], v[96:99]
ds_read_b64_tr_b16 a[22:23], v16 offset:608
s_waitcnt lgkmcnt(6)
v_add_f32 v28, v28, v18
v_mfma_f32_16x16x32_bf16 v[100:103], a[80:83], a[180:183], v[100:103]
ds_read_b64_tr_b16 a[24:25], v16 offset:8512
v_mfma_f32_16x16x32_bf16 v[24:27], v[20:23], a[212:215], v[24:27]
ds_read_b64_tr_b16 a[26:27], v16 offset:9024
v_add_f32 v29, v29, v19
v_mfma_f32_16x16x32_bf16 v[104:107], a[80:83], a[184:187], v[104:107]
ds_read_b64 v[18:19], v2 offset:6144
v_mfma_f32_16x16x32_bf16 v[108:111], a[80:83], a[188:191], v[108:111]
ds_read_b64_tr_b16 a[28:29], v16 offset:8544
s_waitcnt lgkmcnt(6)
v_add_f32 v28, v28, v30
v_mfma_f32_16x16x32_bf16 v[112:115], a[84:87], a[176:179], v[112:115]
buffer_load_dwordx4 a[164:167], v10, s[16:19], s52 offen offset:1024 sc1
v_mfma_f32_16x16x32_bf16 v[116:119], a[84:87], a[180:183], v[116:119]
ds_read_b64_tr_b16 a[30:31], v16 offset:9056
v_mfma_f32_16x16x32_bf16 v[120:123], a[84:87], a[184:187], v[120:123]
ds_read_b64_tr_b16 a[32:33], v16 offset:128
v_add_f32 v29, v29, v31
v_mfma_f32_16x16x32_bf16 v[124:127], a[84:87], a[188:191], v[124:127]
ds_read_b64 v[30:31], v2 offset:6656
v_mfma_f32_16x16x32_bf16 v[128:131], a[88:91], a[176:179], v[128:131]
ds_read_b64_tr_b16 a[34:35], v16 offset:640
v_mfma_f32_16x16x32_bf16 v[132:135], a[88:91], a[180:183], v[132:135]
ds_read_b64_tr_b16 a[36:37], v16 offset:160
s_waitcnt lgkmcnt(6)
v_add_f32 v28, v28, v18
v_mfma_f32_16x16x32_bf16 v[136:139], a[88:91], a[184:187], v[136:139]
ds_read_b64_tr_b16 a[38:39], v16 offset:672
v_mfma_f32_16x16x32_bf16 v[140:143], a[88:91], a[188:191], v[140:143]
v_add_f32 v29, v29, v19
v_mfma_f32_16x16x32_bf16 v[144:147], a[92:95], a[176:179], v[144:147]
buffer_load_dwordx4 v14, s[32:35], s54 offen offset:2112 lds
v_mfma_f32_16x16x32_bf16 v[148:151], a[92:95], a[180:183], v[148:151]
ds_read_b64_tr_b16 a[40:41], v16 offset:8576
ds_read_b64 v[18:19], v2 offset:7168
v_mfma_f32_16x16x32_bf16 v[24:27], v[20:23], a[216:219], v[24:27]
ds_read_b64_tr_b16 a[42:43], v16 offset:9088
s_waitcnt lgkmcnt(6)
v_add_f32 v28, v28, v30
v_mfma_f32_16x16x32_bf16 v[152:155], a[92:95], a[184:187], v[152:155]
ds_read_b64_tr_b16 a[44:45], v16 offset:8608
v_mfma_f32_16x16x32_bf16 v[156:159], a[92:95], a[188:191], v[156:159]
v_add_f32 v29, v29, v31
v_mfma_f32_16x16x32_bf16 v[160:163], a[96:99], a[176:179], v[160:163]
ds_read_b64_tr_b16 a[46:47], v16 offset:9120
ds_read_b64 v[30:31], v2 offset:7680
v_mfma_f32_16x16x32_bf16 v[164:167], a[96:99], a[180:183], v[164:167]
ds_read_b64_tr_b16 a[48:49], v17
v_mfma_f32_16x16x32_bf16 v[168:171], a[96:99], a[184:187], v[168:171]
buffer_load_dwordx4 a[168:171], v11, s[16:19], s52 offen sc1
v_mfma_f32_16x16x32_bf16 v[172:175], a[96:99], a[188:191], v[172:175]
ds_read_b64_tr_b16 a[50:51], v17 offset:512
s_waitcnt lgkmcnt(6)
v_add_f32 v28, v28, v18
v_mfma_f32_16x16x32_bf16 v[176:179], a[100:103], a[176:179], v[176:179]
ds_read_b64_tr_b16 a[52:53], v17 offset:32
v_mfma_f32_16x16x32_bf16 v[180:183], a[100:103], a[180:183], v[180:183]
v_add_f32 v29, v29, v19
v_mfma_f32_16x16x32_bf16 v[184:187], a[100:103], a[184:187], v[184:187]
ds_read_b64_tr_b16 a[54:55], v17 offset:544
s_waitcnt lgkmcnt(4)
v_add_f32 v28, v28, v30
v_mfma_f32_16x16x32_bf16 v[188:191], a[100:103], a[188:191], v[188:191]
ds_read_b64_tr_b16 a[56:57], v17 offset:8448
v_add_f32 v29, v29, v31
v_mfma_f32_16x16x32_bf16 v[192:195], a[104:107], a[176:179], v[192:195]
ds_read_b64_tr_b16 a[58:59], v17 offset:8960
v_mfma_f32_16x16x32_bf16 v[196:199], a[104:107], a[180:183], v[196:199]
buffer_load_dwordx4 v15, s[32:35], s54 offen offset:3168 lds
v_mfma_f32_16x16x32_bf16 v[24:27], v[20:23], a[220:223], v[24:27]
s_add_u32 s54, s54, 229376
v_mul_f32 v28, 0xba800000, v28
v_mfma_f32_16x16x32_bf16 v[200:203], a[104:107], a[184:187], v[200:203]
ds_read_b64_tr_b16 a[60:61], v17 offset:8480
v_mul_f32 v29, 0x3a800000, v29
v_mfma_f32_16x16x32_bf16 v[204:207], a[104:107], a[188:191], v[204:207]
ds_read_b64_tr_b16 a[62:63], v17 offset:8992
v_mfma_f32_16x16x32_bf16 v[208:211], a[108:111], a[176:179], v[208:211]
ds_read_b128 a[192:195], v9
v_fma_f32 v29, -v28, v28, v29
v_mfma_f32_16x16x32_bf16 v[212:215], a[108:111], a[180:183], v[212:215]
v_max_f32 v29, 0, v29
v_mfma_f32_16x16x32_bf16 v[216:219], a[108:111], a[184:187], v[216:219]
ds_read_b128 a[196:199], v9 offset:1056
v_mfma_f32_16x16x32_bf16 v[220:223], a[108:111], a[188:191], v[220:223]
buffer_load_dwordx4 a[172:175], v11, s[16:19], s52 offen offset:1024 sc1
v_mfma_f32_16x16x32_bf16 v[224:227], a[112:115], a[176:179], v[224:227]
ds_read_b128 a[200:203], v9 offset:2112
s_add_u32 s52, s52, 0x20000
v_mfma_f32_16x16x32_bf16 v[228:231], a[112:115], a[180:183], v[228:231]
ds_read_b128 a[204:207], v9 offset:3168
v_add_f32 v29, 0x3727c5ac, v29
v_mfma_f32_16x16x32_bf16 v[232:235], a[116:119], a[176:179], v[232:235]
v_rsq_f32 v30, v29
v_mfma_f32_16x16x32_bf16 v[236:239], a[116:119], a[180:183], v[236:239]
v_lshlrev_b32 v18, 4, v0
v_mfma_f32_16x16x32_bf16 v[240:243], a[120:123], a[176:179], v[240:243]
v_add_u32 v18, 151552, v18
v_mfma_f32_16x16x32_bf16 v[244:247], a[120:123], a[180:183], v[244:247]
v_mul_f32 v30, 0xbfb8aa3b, v30
v_mfma_f32_16x16x32_bf16 v[248:251], a[124:127], a[176:179], v[248:251]
ds_write_b128 v18, v[28:31]
v_mfma_f32_16x16x32_bf16 v[252:255], a[124:127], a[180:183], v[252:255]
s_mov_b32 s58, -262144
s_sub_u32 s67, s59, 16640
s_mov_b32 s15, -6
.p2align 6
.Lk27:
s_waitcnt vmcnt(17) lgkmcnt(0)
s_barrier
v_mfma_f32_16x16x32_bf16 v[32:35], a[0:3], a[128:131], v[32:35]
ds_read_b64_tr_b16 a[64:65], v16 offset:16896
s_add_u32 m0, s55, 83200
v_mfma_f32_16x16x32_bf16 v[36:39], a[0:3], a[132:135], v[36:39]
buffer_load_dwordx4 v12, s[32:35], s54 offen lds
v_mfma_f32_16x16x32_bf16 v[40:43], a[0:3], a[136:139], v[40:43]
s_sub_u32 s47, s47, 1
s_cbranch_scc1 .Lx28
.Lx28b:
s_waitcnt vmcnt(17)
v_mfma_f32_16x16x32_bf16 v[44:47], a[0:3], a[140:143], v[44:47]
ds_read_b64_tr_b16 a[66:67], v16 offset:17408
v_mfma_f32_16x16x32_bf16 v[48:51], a[4:7], a[128:131], v[48:51]
ds_read_b64_tr_b16 a[68:69], v16 offset:16928
v_mfma_f32_16x16x32_bf16 v[52:55], a[4:7], a[132:135], v[52:55]
ds_read_b64_tr_b16 a[70:71], v16 offset:17440
v_mfma_f32_16x16x32_bf16 v[24:27], v[20:23], a[192:195], v[24:27]
v_mfma_f32_16x16x32_bf16 v[56:59], a[4:7], a[136:139], v[56:59]
buffer_load_dwordx4 a[176:179], v10, s[16:19], s52 offen sc1
v_mfma_f32_16x16x32_bf16 v[60:63], a[4:7], a[140:143], v[60:63]
ds_read_b64_tr_b16 a[72:73], v16 offset:25344
v_mfma_f32_16x16x32_bf16 v[64:67], a[8:11], a[128:131], v[64:67]
ds_read_b64_tr_b16 a[74:75], v16 offset:25856
v_mfma_f32_16x16x32_bf16 v[68:71], a[8:11], a[132:135], v[68:71]
ds_read_b64_tr_b16 a[76:77], v16 offset:25376
v_mfma_f32_16x16x32_bf16 v[72:75], a[8:11], a[136:139], v[72:75]
ds_read_b64_tr_b16 a[78:79], v16 offset:25888
v_mfma_f32_16x16x32_bf16 v[76:79], a[8:11], a[140:143], v[76:79]
v_mfma_f32_16x16x32_bf16 v[80:83], a[12:15], a[128:131], v[80:83]
buffer_load_dwordx4 v13, s[32:35], s54 offen offset:1056 lds
v_mfma_f32_16x16x32_bf16 v[84:87], a[12:15], a[132:135], v[84:87]
ds_read_b64_tr_b16 a[80:81], v16 offset:16960
v_mfma_f32_16x16x32_bf16 v[88:91], a[12:15], a[136:139], v[88:91]
ds_read_b64_tr_b16 a[82:83], v16 offset:17472
v_mfma_f32_16x16x32_bf16 v[92:95], a[12:15], a[140:143], v[92:95]
ds_read_b64_tr_b16 a[84:85], v16 offset:16992
v_mfma_f32_16x16x32_bf16 v[96:99], a[16:19], a[128:131], v[96:99]
ds_read_b64_tr_b16 a[86:87], v16 offset:17504
v_mfma_f32_16x16x32_bf16 v[100:103], a[16:19], a[132:135], v[100:103]
v_mfma_f32_16x16x32_bf16 v[24:27], v[20:23], a[196:199], v[24:27]
ds_read_b64_tr_b16 a[88:89], v16 offset:25408
v_mfma_f32_16x16x32_bf16 v[104:107], a[16:19], a[136:139], v[104:107]
buffer_load_dwordx4 a[180:183], v10, s[16:19], s52 offen offset:1024 sc1
v_mfma_f32_16x16x32_bf16 v[108:111], a[16:19], a[140:143], v[108:111]
ds_read_b64_tr_b16 a[90:91], v16 offset:25920
v_mfma_f32_16x16x32_bf16 v[112:115], a[20:23], a[128:131], v[112:115]
ds_read_b64_tr_b16 a[92:93], v16 offset:25440
v_mfma_f32_16x16x32_bf16 v[116:119], a[20:23], a[132:135], v[116:119]
ds_read_b64_tr_b16 a[94:95], v16 offset:25952
v_mfma_f32_16x16x32_bf16 v[120:123], a[20:23], a[136:139], v[120:123]
v_mfma_f32_16x16x32_bf16 v[124:127], a[20:23], a[140:143], v[124:127]
ds_read_b64_tr_b16 a[96:97], v16 offset:17024
v_mfma_f32_16x16x32_bf16 v[128:131], a[24:27], a[128:131], v[128:131]
buffer_load_dwordx4 v14, s[32:35], s54 offen offset:2112 lds
v_mfma_f32_16x16x32_bf16 v[132:135], a[24:27], a[132:135], v[132:135]
ds_read_b64_tr_b16 a[98:99], v16 offset:17536
v_mfma_f32_16x16x32_bf16 v[136:139], a[24:27], a[136:139], v[136:139]
ds_read_b64_tr_b16 a[100:101], v16 offset:17056
v_mfma_f32_16x16x32_bf16 v[140:143], a[24:27], a[140:143], v[140:143]
ds_read_b64_tr_b16 a[102:103], v16 offset:17568
v_mfma_f32_16x16x32_bf16 v[144:147], a[28:31], a[128:131], v[144:147]
v_mfma_f32_16x16x32_bf16 v[148:151], a[28:31], a[132:135], v[148:151]
ds_read_b64_tr_b16 a[104:105], v16 offset:25472
v_mfma_f32_16x16x32_bf16 v[24:27], v[20:23], a[200:203], v[24:27]
ds_read_b64_tr_b16 a[106:107], v16 offset:25984
v_mfma_f32_16x16x32_bf16 v[152:155], a[28:31], a[136:139], v[152:155]
buffer_load_dwordx4 a[184:187], v11, s[16:19], s52 offen sc1
v_mfma_f32_16x16x32_bf16 v[156:159], a[28:31], a[140:143], v[156:159]
ds_read_b64_tr_b16 a[108:109], v16 offset:25504
v_mfma_f32_16x16x32_bf16 v[160:163], a[32:35], a[128:131], v[160:163]
ds_read_b64_tr_b16 a[110:111], v16 offset:26016
v_mfma_f32_16x16x32_bf16 v[164:167], a[32:35], a[132:135], v[164:167]
v_mfma_f32_16x16x32_bf16 v[168:171], a[32:35], a[136:139], v[168:171]
ds_read_b64_tr_b16 a[112:113], v17 offset:16896
v_mfma_f32_16x16x32_bf16 v[172:175], a[32:35], a[140:143], v[172:175]
ds_read_b64_tr_b16 a[114:115], v17 offset:17408
v_mfma_f32_16x16x32_bf16 v[176:179], a[36:39], a[128:131], v[176:179]
buffer_load_dwordx4 v15, s[32:35], s54 offen offset:3168 lds
v_mfma_f32_16x16x32_bf16 v[180:183], a[36:39], a[132:135], v[180:183]
ds_read_b64_tr_b16 a[116:117], v17 offset:16928
s_add_u32 s54, s54, 229376
v_mfma_f32_16x16x32_bf16 v[184:187], a[36:39], a[136:139], v[184:187]
ds_read_b64_tr_b16 a[118:119], v17 offset:17440
v_mfma_f32_16x16x32_bf16 v[188:191], a[36:39], a[140:143], v[188:191]
v_mfma_f32_16x16x32_bf16 v[192:195], a[40:43], a[128:131], v[192:195]
ds_read_b64_tr_b16 a[120:121], v17 offset:25344
v_mfma_f32_16x16x32_bf16 v[196:199], a[40:43], a[132:135], v[196:199]
ds_read_b64_tr_b16 a[122:123], v17 offset:25856
v_mfma_f32_16x16x32_bf16 v[24:27], v[20:23], a[204:207], v[24:27]
ds_read_b64_tr_b16 a[124:125], v17 offset:25376
v_mfma_f32_16x16x32_bf16 v[200:203], a[40:43], a[136:139], v[200:203]
buffer_load_dwordx4 a[188:191], v11, s[16:19], s52 offen offset:1024 sc1
v_mfma_f32_16x16x32_bf16 v[204:207], a[40:43], a[140:143], v[204:207]
ds_read_b64_tr_b16 a[126:127], v17 offset:25888
s_add_u32 s52, s52, 0x20000
v_mfma_f32_16x16x32_bf16 v[208:211], a[44:47], a[128:131], v[208:211]
v_mfma_f32_16x16x32_bf16 v[212:215], a[44:47], a[132:135], v[212:215]
ds_read_b128 a[208:211], v9 offset:16896
v_mfma_f32_16x16x32_bf16 v[216:219], a[44:47], a[136:139], v[216:219]
ds_read_b128 a[212:215], v9 offset:17952
v_mfma_f32_16x16x32_bf16 v[220:223], a[44:47], a[140:143], v[220:223]
ds_read_b128 a[216:219], v9 offset:19008
s_max_i32 m0, s67, s59
v_mfma_f32_16x16x32_bf16 v[224:227], a[48:51], a[128:131], v[224:227]
buffer_load_dwordx4 v5, s[28:31], s58 offen lds
v_mfma_f32_16x16x32_bf16 v[228:231], a[48:51], a[132:135], v[228:231]
ds_read_b128 a[220:223], v9 offset:20064
v_mfma_f32_16x16x32_bf16 v[232:235], a[52:55], a[128:131], v[232:235]
v_mfma_f32_16x16x32_bf16 v[236:239], a[52:55], a[132:135], v[236:239]
v_mfma_f32_16x16x32_bf16 v[240:243], a[56:59], a[128:131], v[240:243]
v_mfma_f32_16x16x32_bf16 v[244:247], a[56:59], a[132:135], v[244:247]
v_mfma_f32_16x16x32_bf16 v[248:251], a[60:63], a[128:131], v[248:251]
v_mfma_f32_16x16x32_bf16 v[252:255], a[60:63], a[132:135], v[252:255]
s_waitcnt vmcnt(18) lgkmcnt(0)
s_barrier
v_mfma_f32_16x16x32_bf16 v[32:35], a[64:67], a[144:147], v[32:35]
ds_read_b64_tr_b16 a[0:1], v16 offset:33792
s_add_u32 m0, s55, 100096
v_mfma_f32_16x16x32_bf16 v[36:39], a[64:67], a[148:151], v[36:39]
buffer_load_dwordx4 v12, s[32:35], s54 offen lds
v_mfma_f32_16x16x32_bf16 v[40:43], a[64:67], a[152:155], v[40:43]
s_sub_u32 s47, s47, 1
s_cbranch_scc1 .Lx29
.Lx29b:
s_waitcnt vmcnt(18)
v_mfma_f32_16x16x32_bf16 v[44:47], a[64:67], a[156:159], v[44:47]
ds_read_b64_tr_b16 a[2:3], v16 offset:34304
v_mfma_f32_16x16x32_bf16 v[48:51], a[68:71], a[144:147], v[48:51]
ds_read_b64_tr_b16 a[4:5], v16 offset:33824
v_mfma_f32_16x16x32_bf16 v[52:55], a[68:71], a[148:151], v[52:55]
ds_read_b64_tr_b16 a[6:7], v16 offset:34336
v_mfma_f32_16x16x32_bf16 v[24:27], v[20:23], a[208:211], v[24:27]
ds_read_b64_tr_b16 a[8:9], v16 offset:42240
v_mfma_f32_16x16x32_bf16 v[56:59], a[68:71], a[152:155], v[56:59]
buffer_load_dwordx4 a[128:131], v10, s[16:19], s52 offen sc1
v_mfma_f32_16x16x32_bf16 v[60:63], a[68:71], a[156:159], v[60:63]
v_mfma_f32_16x16x32_bf16 v[64:67], a[72:75], a[144:147], v[64:67]
ds_read_b64_tr_b16 a[10:11], v16 offset:42752
v_mfma_f32_16x16x32_bf16 v[68:71], a[72:75], a[148:151], v[68:71]
ds_read_b64_tr_b16 a[12:13], v16 offset:42272
v_mfma_f32_16x16x32_bf16 v[72:75], a[72:75], a[152:155], v[72:75]
ds_read_b64_tr_b16 a[14:15], v16 offset:42784
v_mfma_f32_16x16x32_bf16 v[76:79], a[72:75], a[156:159], v[76:79]
ds_read_b64_tr_b16 a[16:17], v16 offset:33856
v_mfma_f32_16x16x32_bf16 v[80:83], a[76:79], a[144:147], v[80:83]
buffer_load_dwordx4 v13, s[32:35], s54 offen offset:1056 lds
v_mfma_f32_16x16x32_bf16 v[84:87], a[76:79], a[148:151], v[84:87]
v_mfma_f32_16x16x32_bf16 v[88:91], a[76:79], a[152:155], v[88:91]
ds_read_b64_tr_b16 a[18:19], v16 offset:34368
v_mfma_f32_16x16x32_bf16 v[92:95], a[76:79], a[156:159], v[92:95]
ds_read_b64_tr_b16 a[20:21], v16 offset:33888
v_mfma_f32_16x16x32_bf16 v[96:99], a[80:83], a[144:147], v[96:99]
ds_read_b64_tr_b16 a[22:23], v16 offset:34400
v_mfma_f32_16x16x32_bf16 v[100:103], a[80:83], a[148:151], v[100:103]
ds_read_b64_tr_b16 a[24:25], v16 offset:42304
v_mfma_f32_16x16x32_bf16 v[24:27], v[20:23], a[212:215], v[24:27]
ds_read_b64_tr_b16 a[26:27], v16 offset:42816
v_mfma_f32_16x16x32_bf16 v[104:107], a[80:83], a[152:155], v[104:107]
buffer_load_dwordx4 a[132:135], v10, s[16:19], s52 offen offset:1024 sc1
v_mfma_f32_16x16x32_bf16 v[108:111], a[80:83], a[156:159], v[108:111]
v_mfma_f32_16x16x32_bf16 v[112:115], a[84:87], a[144:147], v[112:115]
ds_read_b64_tr_b16 a[28:29], v16 offset:42336
v_mfma_f32_16x16x32_bf16 v[116:119], a[84:87], a[148:151], v[116:119]
ds_read_b64_tr_b16 a[30:31], v16 offset:42848
v_mfma_f32_16x16x32_bf16 v[120:123], a[84:87], a[152:155], v[120:123]
ds_read_b64_tr_b16 a[32:33], v16 offset:33920
v_mfma_f32_16x16x32_bf16 v[124:127], a[84:87], a[156:159], v[124:127]
ds_read_b64_tr_b16 a[34:35], v16 offset:34432
v_mfma_f32_16x16x32_bf16 v[128:131], a[88:91], a[144:147], v[128:131]
buffer_load_dwordx4 v14, s[32:35], s54 offen offset:2112 lds
v_mfma_f32_16x16x32_bf16 v[132:135], a[88:91], a[148:151], v[132:135]
v_mfma_f32_16x16x32_bf16 v[136:139], a[88:91], a[152:155], v[136:139]
ds_read_b64_tr_b16 a[36:37], v16 offset:33952
v_mfma_f32_16x16x32_bf16 v[140:143], a[88:91], a[156:159], v[140:143]
ds_read_b64_tr_b16 a[38:39], v16 offset:34464
v_mfma_f32_16x16x32_bf16 v[144:147], a[92:95], a[144:147], v[144:147]
ds_read_b64_tr_b16 a[40:41], v16 offset:42368
v_mfma_f32_16x16x32_bf16 v[148:151], a[92:95], a[148:151], v[148:151]
ds_read_b64_tr_b16 a[42:43], v16 offset:42880
v_mfma_f32_16x16x32_bf16 v[24:27], v[20:23], a[216:219], v[24:27]
ds_read_b64_tr_b16 a[44:45], v16 offset:42400
v_mfma_f32_16x16x32_bf16 v[152:155], a[92:95], a[152:155], v[152:155]
buffer_load_dwordx4 a[136:139], v11, s[16:19], s52 offen sc1
v_mfma_f32_16x16x32_bf16 v[156:159], a[92:95], a[156:159], v[156:159]
v_mfma_f32_16x16x32_bf16 v[160:163], a[96:99], a[144:147], v[160:163]
ds_read_b64_tr_b16 a[46:47], v16 offset:42912
v_mfma_f32_16x16x32_bf16 v[164:167], a[96:99], a[148:151], v[164:167]
ds_read_b64_tr_b16 a[48:49], v17 offset:33792
v_mfma_f32_16x16x32_bf16 v[168:171], a[96:99], a[152:155], v[168:171]
ds_read_b64_tr_b16 a[50:51], v17 offset:34304
v_mfma_f32_16x16x32_bf16 v[172:175], a[96:99], a[156:159], v[172:175]
ds_read_b64_tr_b16 a[52:53], v17 offset:33824
v_mfma_f32_16x16x32_bf16 v[176:179], a[100:103], a[144:147], v[176:179]
buffer_load_dwordx4 v15, s[32:35], s54 offen offset:3168 lds
v_mfma_f32_16x16x32_bf16 v[180:183], a[100:103], a[148:151], v[180:183]
s_add_u32 s54, s54, 229376
v_mfma_f32_16x16x32_bf16 v[184:187], a[100:103], a[152:155], v[184:187]
ds_read_b64_tr_b16 a[54:55], v17 offset:34336
v_mfma_f32_16x16x32_bf16 v[188:191], a[100:103], a[156:159], v[188:191]
ds_read_b64_tr_b16 a[56:57], v17 offset:42240
v_mfma_f32_16x16x32_bf16 v[192:195], a[104:107], a[144:147], v[192:195]
ds_read_b64_tr_b16 a[58:59], v17 offset:42752
v_mfma_f32_16x16x32_bf16 v[196:199], a[104:107], a[148:151], v[196:199]
ds_read_b64_tr_b16 a[60:61], v17 offset:42272
v_mfma_f32_16x16x32_bf16 v[24:27], v[20:23], a[220:223], v[24:27]
ds_read_b64_tr_b16 a[62:63], v17 offset:42784
v_mfma_f32_16x16x32_bf16 v[200:203], a[104:107], a[152:155], v[200:203]
buffer_load_dwordx4 a[140:143], v11, s[16:19], s52 offen offset:1024 sc1
v_mfma_f32_16x16x32_bf16 v[204:207], a[104:107], a[156:159], v[204:207]
s_add_u32 s52, s52, 0x20000
v_mfma_f32_16x16x32_bf16 v[208:211], a[108:111], a[144:147], v[208:211]
ds_read_b128 a[192:195], v9 offset:33792
v_mfma_f32_16x16x32_bf16 v[212:215], a[108:111], a[148:151], v[212:215]
ds_read_b128 a[196:199], v9 offset:34848
v_mfma_f32_16x16x32_bf16 v[216:219], a[108:111], a[152:155], v[216:219]
ds_read_b128 a[200:203], v9 offset:35904
v_mfma_f32_16x16x32_bf16 v[220:223], a[108:111], a[156:159], v[220:223]
ds_read_b128 a[204:207], v9 offset:36960
s_max_i32 m0, s67, s59
v_mfma_f32_16x16x32_bf16 v[224:227], a[112:115], a[144:147], v[224:227]
buffer_load_dwordx4 v6, s[28:31], s58 offen offset:1024 lds
v_mfma_f32_16x16x32_bf16 v[228:231], a[112:115], a[148:151], v[228:231]
s_add_u32 s67, s67, 8320
s_add_u32 s58, s58, 0x20000
v_mfma_f32_16x16x32_bf16 v[232:235], a[116:119], a[144:147], v[232:235]
v_mfma_f32_16x16x32_bf16 v[236:239], a[116:119], a[148:151], v[236:239]
v_mfma_f32_16x16x32_bf16 v[240:243], a[120:123], a[144:147], v[240:243]
v_mfma_f32_16x16x32_bf16 v[244:247], a[120:123], a[148:151], v[244:247]
v_mfma_f32_16x16x32_bf16 v[248:251], a[124:127], a[144:147], v[248:251]
v_mfma_f32_16x16x32_bf16 v[252:255], a[124:127], a[148:151], v[252:255]
s_waitcnt vmcnt(19) lgkmcnt(0)
s_barrier
v_mfma_f32_16x16x32_bf16 v[32:35], a[0:3], a[160:163], v[32:35]
ds_read_b64_tr_b16 a[64:65], v16 offset:50688
s_add_u32 m0, s55, 116992
v_mfma_f32_16x16x32_bf16 v[36:39], a[0:3], a[164:167], v[36:39]
buffer_load_dwordx4 v12, s[32:35], s54 offen lds
v_mfma_f32_16x16x32_bf16 v[40:43], a[0:3], a[168:171], v[40:43]
s_sub_u32 s47, s47, 1
s_cbranch_scc1 .Lx30
.Lx30b:
s_waitcnt vmcnt(19)
v_mfma_f32_16x16x32_bf16 v[44:47], a[0:3], a[172:175], v[44:47]
ds_read_b64_tr_b16 a[66:67], v16 offset:51200
v_mfma_f32_16x16x32_bf16 v[48:51], a[4:7], a[160:163], v[48:51]
ds_read_b64_tr_b16 a[68:69], v16 offset:50720
v_mfma_f32_16x16x32_bf16 v[52:55], a[4:7], a[164:167], v[52:55]
ds_read_b64_tr_b16 a[70:71], v16 offset:51232
v_mfma_f32_16x16x32_bf16 v[24:27], v[20:23], a[192:195], v[24:27]
v_mfma_f32_16x16x32_bf16 v[56:59], a[4:7], a[168:171], v[56:59]
buffer_load_dwordx4 a[144:147], v10, s[16:19], s52 offen sc1
v_mfma_f32_16x16x32_bf16 v[60:63], a[4:7], a[172:175], v[60:63]
ds_read_b64_tr_b16 a[72:73], v16 offset:59136
v_mfma_f32_16x16x32_bf16 v[64:67], a[8:11], a[160:163], v[64:67]
ds_read_b64_tr_b16 a[74:75], v16 offset:59648
v_mfma_f32_16x16x32_bf16 v[68:71], a[8:11], a[164:167], v[68:71]
ds_read_b64_tr_b16 a[76:77], v16 offset:59168
v_mfma_f32_16x16x32_bf16 v[72:75], a[8:11], a[168:171], v[72:75]
ds_read_b64_tr_b16 a[78:79], v16 offset:59680
v_mfma_f32_16x16x32_bf16 v[76:79], a[8:11], a[172:175], v[76:79]
v_mfma_f32_16x16x32_bf16 v[80:83], a[12:15], a[160:163], v[80:83]
buffer_load_dwordx4 v13, s[32:35], s54 offen offset:1056 lds
v_mfma_f32_16x16x32_bf16 v[84:87], a[12:15], a[164:167], v[84:87]
ds_read_b64_tr_b16 a[80:81], v16 offset:50752
v_mfma_f32_16x16x32_bf16 v[88:91], a[12:15], a[168:171], v[88:91]
ds_read_b64_tr_b16 a[82:83], v16 offset:51264
v_mfma_f32_16x16x32_bf16 v[92:95], a[12:15], a[172:175], v[92:95]
ds_read_b64_tr_b16 a[84:85], v16 offset:50784
v_mfma_f32_16x16x32_bf16 v[96:99], a[16:19], a[160:163], v[96:99]
ds_read_b64_tr_b16 a[86:87], v16 offset:51296
v_mfma_f32_16x16x32_bf16 v[100:103], a[16:19], a[164:167], v[100:103]
v_mfma_f32_16x16x32_bf16 v[24:27], v[20:23], a[196:199], v[24:27]
ds_read_b64_tr_b16 a[88:89], v16 offset:59200
v_mfma_f32_16x16x32_bf16 v[104:107], a[16:19], a[168:171], v[104:107]
buffer_load_dwordx4 a[148:151], v10, s[16:19], s52 offen offset:1024 sc1
v_mfma_f32_16x16x32_bf16 v[108:111], a[16:19], a[172:175], v[108:111]
ds_read_b64_tr_b16 a[90:91], v16 offset:59712
v_mfma_f32_16x16x32_bf16 v[112:115], a[20:23], a[160:163], v[112:115]
ds_read_b64_tr_b16 a[92:93], v16 offset:59232
v_mfma_f32_16x16x32_bf16 v[116:119], a[20:23], a[164:167], v[116:119]
ds_read_b64_tr_b16 a[94:95], v16 offset:59744
v_mfma_f32_16x16x32_bf16 v[120:123], a[20:23], a[168:171], v[120:123]
v_mfma_f32_16x16x32_bf16 v[124:127], a[20:23], a[172:175], v[124:127]
ds_read_b64_tr_b16 a[96:97], v16 offset:50816
v_mfma_f32_16x16x32_bf16 v[128:131], a[24:27], a[160:163], v[128:131]
buffer_load_dwordx4 v14, s[32:35], s54 offen offset:2112 lds
v_mfma_f32_16x16x32_bf16 v[132:135], a[24:27], a[164:167], v[132:135]
ds_read_b64_tr_b16 a[98:99], v16 offset:51328
v_mfma_f32_16x16x32_bf16 v[136:139], a[24:27], a[168:171], v[136:139]
ds_read_b64_tr_b16 a[100:101], v16 offset:50848
v_mfma_f32_16x16x32_bf16 v[140:143], a[24:27], a[172:175], v[140:143]
ds_read_b64_tr_b16 a[102:103], v16 offset:51360
v_mfma_f32_16x16x32_bf16 v[144:147], a[28:31], a[160:163], v[144:147]
v_mfma_f32_16x16x32_bf16 v[148:151], a[28:31], a[164:167], v[148:151]
ds_read_b64_tr_b16 a[104:105], v16 offset:59264
v_mfma_f32_16x16x32_bf16 v[24:27], v[20:23], a[200:203], v[24:27]
ds_read_b64_tr_b16 a[106:107], v16 offset:59776
v_mfma_f32_16x16x32_bf16 v[152:155], a[28:31], a[168:171], v[152:155]
.Lpad12:
s_cbranch_execz .Lpad15
buffer_load_dwordx4 a[152:155], v11, s[16:19], s52 offen sc1
v_mfma_f32_16x16x32_bf16 v[156:159], a[28:31], a[172:175], v[156:159]
ds_read_b64_tr_b16 a[108:109], v16 offset:59296
v_mfma_f32_16x16x32_bf16 v[160:163], a[32:35], a[160:163], v[160:163]
ds_read_b64_tr_b16 a[110:111], v16 offset:59808
v_mfma_f32_16x16x32_bf16 v[164:167], a[32:35], a[164:167], v[164:167]
v_mfma_f32_16x16x32_bf16 v[168:171], a[32:35], a[168:171], v[168:171]
ds_read_b64_tr_b16 a[112:113], v17 offset:50688
v_mfma_f32_16x16x32_bf16 v[172:175], a[32:35], a[172:175], v[172:175]
ds_read_b64_tr_b16 a[114:115], v17 offset:51200
v_mfma_f32_16x16x32_bf16 v[176:179], a[36:39], a[160:163], v[176:179]
buffer_load_dwordx4 v15, s[32:35], s54 offen offset:3168 lds
v_mfma_f32_16x16x32_bf16 v[180:183], a[36:39], a[164:167], v[180:183]
ds_read_b64_tr_b16 a[116:117], v17 offset:50720
s_add_u32 s54, s54, 229376
v_mfma_f32_16x16x32_bf16 v[184:187], a[36:39], a[168:171], v[184:187]
ds_read_b64_tr_b16 a[118:119], v17 offset:51232
v_mfma_f32_16x16x32_bf16 v[188:191], a[36:39], a[172:175], v[188:191]
v_mfma_f32_16x16x32_bf16 v[192:195], a[40:43], a[160:163], v[192:195]
ds_read_b64_tr_b16 a[120:121], v17 offset:59136
v_mfma_f32_16x16x32_bf16 v[196:199], a[40:43], a[164:167], v[196:199]
ds_read_b64_tr_b16 a[122:123], v17 offset:59648
v_mfma_f32_16x16x32_bf16 v[24:27], v[20:23], a[204:207], v[24:27]
ds_read_b64_tr_b16 a[124:125], v17 offset:59168
v_mfma_f32_16x16x32_bf16 v[200:203], a[40:43], a[168:171], v[200:203]
buffer_load_dwordx4 a[156:159], v11, s[16:19], s52 offen offset:1024 sc1
v_mfma_f32_16x16x32_bf16 v[204:207], a[40:43], a[172:175], v[204:207]
ds_read_b64_tr_b16 a[126:127], v17 offset:59680
s_add_u32 s52, s52, 0x20000
v_mfma_f32_16x16x32_bf16 v[208:211], a[44:47], a[160:163], v[208:211]
v_mfma_f32_16x16x32_bf16 v[212:215], a[44:47], a[164:167], v[212:215]
ds_read_b128 a[208:211], v9 offset:50688
v_mfma_f32_16x16x32_bf16 v[216:219], a[44:47], a[168:171], v[216:219]
ds_read_b128 a[212:215], v9 offset:51744
v_mfma_f32_16x16x32_bf16 v[220:223], a[44:47], a[172:175], v[220:223]
ds_read_b128 a[216:219], v9 offset:52800
s_max_i32 m0, s67, s59
v_mfma_f32_16x16x32_bf16 v[224:227], a[48:51], a[160:163], v[224:227]
buffer_load_dwordx4 v5, s[28:31], s58 offen lds
v_mfma_f32_16x16x32_bf16 v[228:231], a[48:51], a[164:167], v[228:231]
ds_read_b128 a[220:223], v9 offset:53856
v_mfma_f32_16x16x32_bf16 v[232:235], a[52:55], a[160:163], v[232:235]
v_mfma_f32_16x16x32_bf16 v[236:239], a[52:55], a[164:167], v[236:239]
v_mfma_f32_16x16x32_bf16 v[240:243], a[56:59], a[160:163], v[240:243]
v_mfma_f32_16x16x32_bf16 v[244:247], a[56:59], a[164:167], v[244:247]
v_mfma_f32_16x16x32_bf16 v[248:251], a[60:63], a[160:163], v[248:251]
v_mfma_f32_16x16x32_bf16 v[252:255], a[60:63], a[164:167], v[252:255]
s_waitcnt vmcnt(20) lgkmcnt(0)
s_barrier
v_mfma_f32_16x16x32_bf16 v[32:35], a[64:67], a[176:179], v[32:35]
ds_read_b64_tr_b16 a[0:1], v16
s_add_u32 m0, s55, 133888
v_mfma_f32_16x16x32_bf16 v[36:39], a[64:67], a[180:183], v[36:39]
buffer_load_dwordx4 v12, s[32:35], s54 offen lds
v_mfma_f32_16x16x32_bf16 v[40:43], a[64:67], a[184:187], v[40:43]
s_sub_u32 s47, s47, 1
s_cbranch_scc1 .Lx31
.Lx31b:
s_waitcnt vmcnt(20)
v_mfma_f32_16x16x32_bf16 v[44:47], a[64:67], a[188:191], v[44:47]
ds_read_b64_tr_b16 a[2:3], v16 offset:512
v_mfma_f32_16x16x32_bf16 v[48:51], a[68:71], a[176:179], v[48:51]
ds_read_b64_tr_b16 a[4:5], v16 offset:32
v_mfma_f32_16x16x32_bf16 v[52:55], a[68:71], a[180:183], v[52:55]
ds_read_b64_tr_b16 a[6:7], v16 offset:544
v_mfma_f32_16x16x32_bf16 v[24:27], v[20:23], a[208:211], v[24:27]
ds_read_b64_tr_b16 a[8:9], v16 offset:8448
v_mfma_f32_16x16x32_bf16 v[56:59], a[68:71], a[184:187], v[56:59]
buffer_load_dwordx4 a[160:163], v10, s[16:19], s52 offen sc1
v_mfma_f32_16x16x32_bf16 v[60:63], a[68:71], a[188:191], v[60:63]
v_mfma_f32_16x16x32_bf16 v[64:67], a[72:75], a[176:179], v[64:67]
ds_read_b64_tr_b16 a[10:11], v16 offset:8960
v_mfma_f32_16x16x32_bf16 v[68:71], a[72:75], a[180:183], v[68:71]
ds_read_b64_tr_b16 a[12:13], v16 offset:8480
v_mfma_f32_16x16x32_bf16 v[72:75], a[72:75], a[184:187], v[72:75]
ds_read_b64_tr_b16 a[14:15], v16 offset:8992
v_mfma_f32_16x16x32_bf16 v[76:79], a[72:75], a[188:191], v[76:79]
ds_read_b64_tr_b16 a[16:17], v16 offset:64
v_mfma_f32_16x16x32_bf16 v[80:83], a[76:79], a[176:179], v[80:83]
buffer_load_dwordx4 v13, s[32:35], s54 offen offset:1056 lds
v_mfma_f32_16x16x32_bf16 v[84:87], a[76:79], a[180:183], v[84:87]
v_mfma_f32_16x16x32_bf16 v[88:91], a[76:79], a[184:187], v[88:91]
ds_read_b64_tr_b16 a[18:19], v16 offset:576
v_mfma_f32_16x16x32_bf16 v[92:95], a[76:79], a[188:191], v[92:95]
ds_read_b64_tr_b16 a[20:21], v16 offset:96
v_mfma_f32_16x16x32_bf16 v[96:99], a[80:83], a[176:179], v[96:99]
ds_read_b64_tr_b16 a[22:23], v16 offset:608
v_mfma_f32_16x16x32_bf16 v[100:103], a[80:83], a[180:183], v[100:103]
ds_read_b64_tr_b16 a[24:25], v16 offset:8512
v_mfma_f32_16x16x32_bf16 v[24:27], v[20:23], a[212:215], v[24:27]
ds_read_b64_tr_b16 a[26:27], v16 offset:9024
v_mfma_f32_16x16x32_bf16 v[104:107], a[80:83], a[184:187], v[104:107]
buffer_load_dwordx4 a[164:167], v10, s[16:19], s52 offen offset:1024 sc1
v_mfma_f32_16x16x32_bf16 v[108:111], a[80:83], a[188:191], v[108:111]
v_mfma_f32_16x16x32_bf16 v[112:115], a[84:87], a[176:179], v[112:115]
ds_read_b64_tr_b16 a[28:29], v16 offset:8544
v_mfma_f32_16x16x32_bf16 v[116:119], a[84:87], a[180:183], v[116:119]
ds_read_b64_tr_b16 a[30:31], v16 offset:9056
v_mfma_f32_16x16x32_bf16 v[120:123], a[84:87], a[184:187], v[120:123]
ds_read_b64_tr_b16 a[32:33], v16 offset:128
v_mfma_f32_16x16x32_bf16 v[124:127], a[84:87], a[188:191], v[124:127]
ds_read_b64_tr_b16 a[34:35], v16 offset:640
v_mfma_f32_16x16x32_bf16 v[128:131], a[88:91], a[176:179], v[128:131]
buffer_load_dwordx4 v14, s[32:35], s54 offen offset:2112 lds
v_mfma_f32_16x16x32_bf16 v[132:135], a[88:91], a[180:183], v[132:135]
v_mfma_f32_16x16x32_bf16 v[136:139], a[88:91], a[184:187], v[136:139]
ds_read_b64_tr_b16 a[36:37], v16 offset:160
v_mfma_f32_16x16x32_bf16 v[140:143], a[88:91], a[188:191], v[140:143]
ds_read_b64_tr_b16 a[38:39], v16 offset:672
v_mfma_f32_16x16x32_bf16 v[144:147], a[92:95], a[176:179], v[144:147]
ds_read_b64_tr_b16 a[40:41], v16 offset:8576
v_mfma_f32_16x16x32_bf16 v[148:151], a[92:95], a[180:183], v[148:151]
ds_read_b64_tr_b16 a[42:43], v16 offset:9088
v_mfma_f32_16x16x32_bf16 v[24:27], v[20:23], a[216:219], v[24:27]
ds_read_b64_tr_b16 a[44:45], v16 offset:8608
v_mfma_f32_16x16x32_bf16 v[152:155], a[92:95], a[184:187], v[152:155]
buffer_load_dwordx4 a[168:171], v11, s[16:19], s52 offen sc1
v_mfma_f32_16x16x32_bf16 v[156:159], a[92:95], a[188:191], v[156:159]
v_mfma_f32_16x16x32_bf16 v[160:163], a[96:99], a[176:179], v[160:163]
ds_read_b64_tr_b16 a[46:47], v16 offset:9120
v_mfma_f32_16x16x32_bf16 v[164:167], a[96:99], a[180:183], v[164:167]
ds_read_b64_tr_b16 a[48:49], v17
v_mfma_f32_16x16x32_bf16 v[168:171], a[96:99], a[184:187], v[168:171]
ds_read_b64_tr_b16 a[50:51], v17 offset:512
v_mfma_f32_16x16x32_bf16 v[172:175], a[96:99], a[188:191], v[172:175]
ds_read_b64_tr_b16 a[52:53], v17 offset:32
v_mfma_f32_16x16x32_bf16 v[176:179], a[100:103], a[176:179], v[176:179]
buffer_load_dwordx4 v15, s[32:35], s54 offen offset:3168 lds
v_mfma_f32_16x16x32_bf16 v[180:183], a[100:103], a[180:183], v[180:183]
s_add_u32 s54, s54, 229376
v_mfma_f32_16x16x32_bf16 v[184:187], a[100:103], a[184:187], v[184:187]
ds_read_b64_tr_b16 a[54:55], v17 offset:544
v_mfma_f32_16x16x32_bf16 v[188:191], a[100:103], a[188:191], v[188:191]
ds_read_b64_tr_b16 a[56:57], v17 offset:8448
v_mfma_f32_16x16x32_bf16 v[192:195], a[104:107], a[176:179], v[192:195]
ds_read_b64_tr_b16 a[58:59], v17 offset:8960
v_mfma_f32_16x16x32_bf16 v[196:199], a[104:107], a[180:183], v[196:199]
ds_read_b64_tr_b16 a[60:61], v17 offset:8480
v_mfma_f32_16x16x32_bf16 v[24:27], v[20:23], a[220:223], v[24:27]
ds_read_b64_tr_b16 a[62:63], v17 offset:8992
v_mfma_f32_16x16x32_bf16 v[200:203], a[104:107], a[184:187], v[200:203]
buffer_load_dwordx4 a[172:175], v11, s[16:19], s52 offen offset:1024 sc1
v_mfma_f32_16x16x32_bf16 v[204:207], a[104:107], a[188:191], v[204:207]
s_add_u32 s52, s52, 0x20000
v_mfma_f32_16x16x32_bf16 v[208:211], a[108:111], a[176:179], v[208:211]
ds_read_b128 a[192:195], v9
v_mfma_f32_16x16x32_bf16 v[212:215], a[108:111], a[180:183], v[212:215]
ds_read_b128 a[196:199], v9 offset:1056
v_mfma_f32_16x16x32_bf16 v[216:219], a[108:111], a[184:187], v[216:219]
ds_read_b128 a[200:203], v9 offset:2112
v_mfma_f32_16x16x32_bf16 v[220:223], a[108:111], a[188:191], v[220:223]
ds_read_b128 a[204:207], v9 offset:3168
s_max_i32 m0, s67, s59
v_mfma_f32_16x16x32_bf16 v[224:227], a[112:115], a[176:179], v[224:227]
buffer_load_dwordx4 v6, s[28:31], s58 offen offset:1024 lds
v_mfma_f32_16x16x32_bf16 v[228:231], a[112:115], a[180:183], v[228:231]
s_add_u32 s67, s67, 8320
s_add_u32 s58, s58, 0x20000
v_mfma_f32_16x16x32_bf16 v[232:235], a[116:119], a[176:179], v[232:235]
v_mfma_f32_16x16x32_bf16 v[236:239], a[116:119], a[180:183], v[236:239]
v_mfma_f32_16x16x32_bf16 v[240:243], a[120:123], a[176:179], v[240:243]
v_mfma_f32_16x16x32_bf16 v[244:247], a[120:123], a[180:183], v[244:247]
v_mfma_f32_16x16x32_bf16 v[248:251], a[124:127], a[176:179], v[248:251]
s_add_u32 s15, s15, 1
v_mfma_f32_16x16x32_bf16 v[252:255], a[124:127], a[180:183], v[252:255]
s_cbranch_scc0 .Lk27
s_waitcnt vmcnt(11) lgkmcnt(0)
s_barrier
v_mfma_f32_16x16x32_bf16 v[24:27], v[20:23], a[192:195], v[24:27]
buffer_load_dwordx4 a[176:179], v10, s[16:19], s52 offen sc1
v_mfma_f32_16x16x32_bf16 v[24:27], v[20:23], a[196:199], v[24:27]
ds_read_b64_tr_b16 a[64:65], v16 offset:16896
v_mov_b32 v18, v5
v_mfma_f32_16x16x32_bf16 v[24:27], v[20:23], a[200:203], v[24:27]
ds_read_b64_tr_b16 a[66:67], v16 offset:17408
v_mov_b32 v19, v6
v_mfma_f32_16x16x32_bf16 v[24:27], v[20:23], a[204:207], v[24:27]
ds_read_b64_tr_b16 a[68:69], v16 offset:16928
s_lshl_b32 s74, s48, 10
v_mfma_f32_16x16x32_bf16 v[32:35], a[0:3], a[128:131], v[32:35]
buffer_load_dwordx4 a[180:183], v10, s[16:19], s52 offen offset:1024 sc1
v_mfma_f32_16x16x32_bf16 v[48:51], a[4:7], a[128:131], v[48:51]
ds_read_b64_tr_b16 a[70:71], v16 offset:17440
s_lshl_b32 s75, s49, 9
v_mfma_f32_16x16x32_bf16 v[64:67], a[8:11], a[128:131], v[64:67]
ds_read_b64_tr_b16 a[72:73], v16 offset:25344
s_add_u32 s74, s74, s75
v_mfma_f32_16x16x32_bf16 v[80:83], a[12:15], a[128:131], v[80:83]
ds_read_b64_tr_b16 a[74:75], v16 offset:25856
s_add_u32 s74, s74, 158464
v_mfma_f32_16x16x32_bf16 v[36:39], a[0:3], a[132:135], v[36:39]
buffer_load_dwordx4 a[184:187], v11, s[16:19], s52 offen sc1
v_mfma_f32_16x16x32_bf16 v[52:55], a[4:7], a[132:135], v[52:55]
ds_read_b64_tr_b16 a[76:77], v16 offset:25376
v_bfe_u32 v2, v1, 4, 1
v_mfma_f32_16x16x32_bf16 v[68:71], a[8:11], a[132:135], v[68:71]
ds_read_b64_tr_b16 a[78:79], v16 offset:25888
s_lshl_b32 s75, s12, 9
v_mfma_f32_16x16x32_bf16 v[84:87], a[12:15], a[132:135], v[84:87]
ds_read_b64_tr_b16 a[80:81], v16 offset:33792
s_mul_i32 s66, s13, 917504
v_mfma_f32_16x16x32_bf16 v[40:43], a[0:3], a[136:139], v[40:43]
buffer_load_dwordx4 a[188:191], v11, s[16:19], s52 offen offset:1024 sc1
v_mfma_f32_16x16x32_bf16 v[56:59], a[4:7], a[136:139], v[56:59]
s_add_u32 s52, s52, 0x20000
ds_read_b64_tr_b16 a[82:83], v16 offset:34304
v_mfma_f32_16x16x32_bf16 v[72:75], a[8:11], a[136:139], v[72:75]
ds_read_b64_tr_b16 a[84:85], v16 offset:33824
s_add_u32 s66, s66, 12582912
v_mfma_f32_16x16x32_bf16 v[88:91], a[12:15], a[136:139], v[88:91]
ds_read_b64_tr_b16 a[86:87], v16 offset:34336
s_add_u32 s65, s66, 393216
v_mfma_f32_16x16x32_bf16 v[44:47], a[0:3], a[140:143], v[44:47]
ds_read_b64_tr_b16 a[88:89], v16 offset:42240
s_lshl_b32 s62, s12, 19
v_mfma_f32_16x16x32_bf16 v[60:63], a[4:7], a[140:143], v[60:63]
ds_read_b64_tr_b16 a[90:91], v16 offset:42752
s_add_u32 s62, s62, s66
v_mfma_f32_16x16x32_bf16 v[76:79], a[8:11], a[140:143], v[76:79]
ds_read_b64_tr_b16 a[92:93], v16 offset:42272
s_add_u32 s63, s62, 0x20000
v_mfma_f32_16x16x32_bf16 v[92:95], a[12:15], a[140:143], v[92:95]
ds_read_b64_tr_b16 a[94:95], v16 offset:42784
s_add_u32 s64, s62, 0x40000
v_mfma_f32_16x16x32_bf16 v[96:99], a[16:19], a[128:131], v[96:99]
ds_read_b64_tr_b16 a[112:113], v16 offset:16960
s_mov_b32 s58, 1310720
v_mfma_f32_16x16x32_bf16 v[112:115], a[20:23], a[128:131], v[112:115]
ds_read_b64_tr_b16 a[114:115], v16 offset:17472
v_mfma_f32_16x16x32_bf16 v[128:131], a[24:27], a[128:131], v[128:131]
ds_read_b64_tr_b16 a[116:117], v16 offset:16992
v_mfma_f32_16x16x32_bf16 v[144:147], a[28:31], a[128:131], v[144:147]
ds_read_b64_tr_b16 a[118:119], v16 offset:17504
v_mfma_f32_16x16x32_bf16 v[100:103], a[16:19], a[132:135], v[100:103]
ds_read_b64_tr_b16 a[120:121], v16 offset:25408
v_mfma_f32_16x16x32_bf16 v[116:119], a[20:23], a[132:135], v[116:119]
ds_read_b64_tr_b16 a[122:123], v16 offset:25920
v_mfma_f32_16x16x32_bf16 v[132:135], a[24:27], a[132:135], v[132:135]
ds_read_b64_tr_b16 a[124:125], v16 offset:25440
v_mfma_f32_16x16x32_bf16 v[148:151], a[28:31], a[132:135], v[148:151]
ds_read_b64_tr_b16 a[126:127], v16 offset:25952
v_mfma_f32_16x16x32_bf16 v[104:107], a[16:19], a[136:139], v[104:107]
ds_read_b128 a[208:211], v9 offset:16896
v_mfma_f32_16x16x32_bf16 v[120:123], a[20:23], a[136:139], v[120:123]
ds_read_b128 a[212:215], v9 offset:17952
v_mfma_f32_16x16x32_bf16 v[136:139], a[24:27], a[136:139], v[136:139]
ds_read_b128 a[216:219], v9 offset:19008
v_mfma_f32_16x16x32_bf16 v[152:155], a[28:31], a[136:139], v[152:155]
ds_read_b128 a[220:223], v9 offset:20064
v_mfma_f32_16x16x32_bf16 v[108:111], a[16:19], a[140:143], v[108:111]
ds_read_b128 a[192:195], v9 offset:33792
v_mfma_f32_16x16x32_bf16 v[124:127], a[20:23], a[140:143], v[124:127]
ds_read_b128 a[196:199], v9 offset:34848
v_mfma_f32_16x16x32_bf16 v[140:143], a[24:27], a[140:143], v[140:143]
ds_read_b128 a[200:203], v9 offset:35904
v_mfma_f32_16x16x32_bf16 v[156:159], a[28:31], a[140:143], v[156:159]
ds_read_b128 a[204:207], v9 offset:36960
v_mfma_f32_16x16x32_bf16 v[160:163], a[32:35], a[128:131], v[160:163]
ds_read_b64_tr_b16 a[0:1], v16 offset:33856
s_waitcnt lgkmcnt(8)
v_mfma_f32_16x16x32_bf16 v[24:27], v[20:23], a[208:211], v[24:27]
ds_read_b64_tr_b16 a[2:3], v16 offset:34368
s_waitcnt vmcnt(6)
s_barrier
s_waitcnt lgkmcnt(8)
v_mfma_f32_16x16x32_bf16 v[24:27], v[20:23], a[212:215], v[24:27]
ds_read_b64_tr_b16 a[96:97], v16 offset:50688
s_waitcnt lgkmcnt(8)
v_mfma_f32_16x16x32_bf16 v[24:27], v[20:23], a[216:219], v[24:27]
ds_read_b64_tr_b16 a[98:99], v16 offset:51200
s_waitcnt lgkmcnt(8)
v_mfma_f32_16x16x32_bf16 v[24:27], v[20:23], a[220:223], v[24:27]
ds_read_b64_tr_b16 a[100:101], v16 offset:50720
s_waitcnt lgkmcnt(8)
v_mfma_f32_16x16x32_bf16 v[24:27], v[20:23], a[192:195], v[24:27]
ds_read_b64_tr_b16 a[102:103], v16 offset:51232
s_waitcnt lgkmcnt(8)
v_mfma_f32_16x16x32_bf16 v[24:27], v[20:23], a[196:199], v[24:27]
ds_read_b64_tr_b16 a[104:105], v16 offset:59136
s_waitcnt lgkmcnt(8)
v_mfma_f32_16x16x32_bf16 v[24:27], v[20:23], a[200:203], v[24:27]
ds_read_b64_tr_b16 a[106:107], v16 offset:59648
s_waitcnt lgkmcnt(8)
v_mfma_f32_16x16x32_bf16 v[24:27], v[20:23], a[204:207], v[24:27]
ds_read_b64_tr_b16 a[108:109], v16 offset:59168
v_mfma_f32_16x16x32_bf16 v[176:179], a[36:39], a[128:131], v[176:179]
ds_read_b64_tr_b16 a[110:111], v16 offset:59680
v_mfma_f32_16x16x32_bf16 v[192:195], a[40:43], a[128:131], v[192:195]
ds_read_b128 a[208:211], v9 offset:50688
v_mfma_f32_16x16x32_bf16 v[208:211], a[44:47], a[128:131], v[208:211]
ds_read_b128 a[212:215], v9 offset:51744
v_mfma_f32_16x16x32_bf16 v[164:167], a[32:35], a[132:135], v[164:167]
ds_read_b128 a[216:219], v9 offset:52800
v_mfma_f32_16x16x32_bf16 v[180:183], a[36:39], a[132:135], v[180:183]
ds_read_b128 a[220:223], v9 offset:53856
v_and_b32 v9, 15, v1
v_mfma_f32_16x16x32_bf16 v[196:199], a[40:43], a[132:135], v[196:199]
ds_read_b64_tr_b16 a[4:5], v16 offset:33888
v_lshl_add_u32 v9, v9, 5, s74
v_mfma_f32_16x16x32_bf16 v[212:215], a[44:47], a[132:135], v[212:215]
s_lshl_b32 s74, s3, 10
v_lshl_add_u32 v9, v2, 4, v9
v_bfe_u32 v2, v1, 5, 1
v_mfma_f32_16x16x32_bf16 v[168:171], a[32:35], a[136:139], v[168:171]
s_add_u32 s74, s74, s75
v_mul_u32_u24 v2, 2816, v2
v_sub_u32 v9, v9, v2
v_mfma_f32_16x16x32_bf16 v[184:187], a[36:39], a[136:139], v[184:187]
s_add_u32 s74, s74, 151552
v_and_b32 v2, 15, v1
v_lshl_add_u32 v2, v2, 4, s74
v_mfma_f32_16x16x32_bf16 v[200:203], a[40:43], a[136:139], v[200:203]
ds_read_b32 v28, v2 offset:8
v_xor_b32 v8, 512, v2
s_waitcnt lgkmcnt(5)
v_mfma_f32_16x16x32_bf16 v[24:27], v[20:23], a[208:211], v[24:27]
ds_read_b32 v29, v2 offset:264
s_lshl_b32 s74, s12, 7
s_waitcnt lgkmcnt(5)
v_mfma_f32_16x16x32_bf16 v[24:27], v[20:23], a[212:215], v[24:27]
ds_read_b32 v30, v8 offset:8
s_add_u32 s74, s74, 160512
s_waitcnt lgkmcnt(5)
v_mfma_f32_16x16x32_bf16 v[24:27], v[20:23], a[216:219], v[24:27]
ds_read_b32 v31, v8 offset:264
s_xor_b32 s75, s12, 1
s_waitcnt lgkmcnt(5)
v_mfma_f32_16x16x32_bf16 v[24:27], v[20:23], a[220:223], v[24:27]
s_mul_i32 s75, s75, 384
s_add_u32 s75, s75, 160512
v_mfma_f32_16x16x32_bf16 v[216:219], a[44:47], a[136:139], v[216:219]
ds_read_b64_tr_b16 a[6:7], v16 offset:34400
v_mfma_f32_16x16x32_bf16 v[172:175], a[32:35], a[140:143], v[172:175]
s_nop 2
ds_write_b128 v9, v[24:27]
v_lshlrev_b32 v9, 4, v1
v_mfma_f32_16x16x32_bf16 v[188:191], a[36:39], a[140:143], v[188:191]
ds_read_b64_tr_b16 a[8:9], v16 offset:42304
v_add_u32 v9, 158464, v9
v_mfma_f32_16x16x32_bf16 v[204:207], a[40:43], a[140:143], v[204:207]
ds_read_b64_tr_b16 a[10:11], v16 offset:42816
v_mfma_f32_16x16x32_bf16 v[220:223], a[44:47], a[140:143], v[220:223]
ds_read_b64_tr_b16 a[12:13], v16 offset:42336
v_mfma_f32_16x16x32_bf16 v[224:227], a[48:51], a[128:131], v[224:227]
ds_read_b64_tr_b16 a[14:15], v16 offset:42848
v_mfma_f32_16x16x32_bf16 v[232:235], a[52:55], a[128:131], v[232:235]
ds_read_b64_tr_b16 a[16:17], v16 offset:50752
v_mfma_f32_16x16x32_bf16 v[240:243], a[56:59], a[128:131], v[240:243]
ds_read_b64_tr_b16 a[18:19], v16 offset:51264
v_mfma_f32_16x16x32_bf16 v[248:251], a[60:63], a[128:131], v[248:251]
ds_read_b64_tr_b16 a[20:21], v16 offset:50784
v_mfma_f32_16x16x32_bf16 v[228:231], a[48:51], a[132:135], v[228:231]
s_waitcnt lgkmcnt(7)
s_barrier
ds_read_b128 v[20:23], v9
v_mfma_f32_16x16x32_bf16 v[236:239], a[52:55], a[132:135], v[236:239]
ds_read_b128 v[24:27], v9 offset:1024
v_mfma_f32_16x16x32_bf16 v[244:247], a[56:59], a[132:135], v[244:247]
ds_read_b64_tr_b16 a[22:23], v16 offset:51296
v_mfma_f32_16x16x32_bf16 v[252:255], a[60:63], a[132:135], v[252:255]
ds_read_b64_tr_b16 a[24:25], v16 offset:59200
v_mfma_f32_16x16x32_bf16 v[32:35], a[64:67], a[144:147], v[32:35]
ds_read_b64_tr_b16 a[26:27], v16 offset:59712
v_mfma_f32_16x16x32_bf16 v[48:51], a[68:71], a[144:147], v[48:51]
ds_read_b64_tr_b16 a[28:29], v16 offset:59232
v_mfma_f32_16x16x32_bf16 v[64:67], a[72:75], a[144:147], v[64:67]
ds_read_b64_tr_b16 a[30:31], v16 offset:59744
v_mfma_f32_16x16x32_bf16 v[80:83], a[76:79], a[144:147], v[80:83]
ds_read_b64_tr_b16 a[32:33], v16 offset:17024
v_mfma_f32_16x16x32_bf16 v[32:35], a[80:83], a[160:163], v[32:35]
ds_read_b64_tr_b16 a[34:35], v16 offset:17536
v_mfma_f32_16x16x32_bf16 v[48:51], a[84:87], a[160:163], v[48:51]
ds_read_b64_tr_b16 a[36:37], v16 offset:17056
s_waitcnt lgkmcnt(8)
v_add_f32 v20, v20, v24
v_mfma_f32_16x16x32_bf16 v[64:67], a[88:91], a[160:163], v[64:67]
ds_read_b64_tr_b16 a[38:39], v16 offset:17568
v_add_f32 v21, v21, v25
v_mfma_f32_16x16x32_bf16 v[80:83], a[92:95], a[160:163], v[80:83]
ds_read_b64 v[24:25], v8
v_add_f32 v22, v22, v26
s_waitcnt vmcnt(3)
v_mfma_f32_16x16x32_bf16 v[32:35], a[96:99], a[176:179], v[32:35]
ds_read_b64_tr_b16 a[40:41], v16 offset:25472
v_add_f32 v23, v23, v27
v_mfma_f32_16x16x32_bf16 v[48:51], a[100:103], a[176:179], v[48:51]
ds_write_b128 v9, v[20:23] offset:2048
v_lshrrev_b32 v9, 4, v1
v_mfma_f32_16x16x32_bf16 v[64:67], a[104:107], a[176:179], v[64:67]
ds_read_b64 v[20:21], v2
v_lshlrev_b32 v9, 4, v9
v_mfma_f32_16x16x32_bf16 v[80:83], a[108:111], a[176:179], v[80:83]
ds_read_b64 v[22:23], v2 offset:256
ds_read_b64 v[26:27], v8 offset:256
v_add_u32 v8, s75, v9
v_add_u32 v9, s74, v9
ds_read_b128 v[12:15], v9
ds_read_b128 v[4:7], v9 offset:64
ds_read_b64_tr_b16 a[42:43], v16 offset:25984
ds_read_b64_tr_b16 a[44:45], v16 offset:25504
ds_read_b64_tr_b16 a[46:47], v16 offset:26016
ds_read_b64_tr_b16 a[48:49], v16 offset:33920
ds_read_b64_tr_b16 a[50:51], v16 offset:34432
ds_read_b64_tr_b16 a[52:53], v16 offset:33952
ds_read_b64_tr_b16 a[54:55], v16 offset:34464
ds_read_b64_tr_b16 a[56:57], v16 offset:42368
ds_read_b64_tr_b16 a[58:59], v16 offset:42880
ds_read_b64_tr_b16 a[60:61], v16 offset:42400
ds_read_b64_tr_b16 a[62:63], v16 offset:42912
s_waitcnt lgkmcnt(12)
v_pk_fma_f32 v[32:33], v[12:13], v[20:21], v[32:33] op_sel_hi:[1,0,1]
v_pk_fma_f32 v[34:35], v[14:15], v[20:21], v[34:35] op_sel_hi:[1,0,1]
v_pk_fma_f32 v[36:37], v[12:13], v[22:23], v[36:37] op_sel_hi:[1,0,1]
v_pk_fma_f32 v[38:39], v[14:15], v[22:23], v[38:39] op_sel_hi:[1,0,1]
v_pk_fma_f32 v[40:41], v[12:13], v[24:25], v[40:41] op_sel_hi:[1,0,1]
v_pk_fma_f32 v[42:43], v[14:15], v[24:25], v[42:43] op_sel_hi:[1,0,1]
v_pk_fma_f32 v[44:45], v[12:13], v[26:27], v[44:45] op_sel_hi:[1,0,1]
v_pk_fma_f32 v[46:47], v[14:15], v[26:27], v[46:47] op_sel_hi:[1,0,1]
ds_read_b128 v[12:15], v9 offset:512
s_waitcnt lgkmcnt(12)
v_pk_fma_f32 v[48:49], v[4:5], v[20:21], v[48:49] op_sel_hi:[1,0,1]
v_pk_fma_f32 v[50:51], v[6:7], v[20:21], v[50:51] op_sel_hi:[1,0,1]
v_pk_fma_f32 v[52:53], v[4:5], v[22:23], v[52:53] op_sel_hi:[1,0,1]
v_pk_fma_f32 v[54:55], v[6:7], v[22:23], v[54:55] op_sel_hi:[1,0,1]
v_pk_fma_f32 v[56:57], v[4:5], v[24:25], v[56:57] op_sel_hi:[1,0,1]
v_pk_fma_f32 v[58:59], v[6:7], v[24:25], v[58:59] op_sel_hi:[1,0,1]
v_pk_fma_f32 v[60:61], v[4:5], v[26:27], v[60:61] op_sel_hi:[1,0,1]
v_pk_fma_f32 v[62:63], v[6:7], v[26:27], v[62:63] op_sel_hi:[1,0,1]
ds_read_b128 v[4:7], v9 offset:576
s_waitcnt lgkmcnt(1)
v_pk_fma_f32 v[64:65], v[12:13], v[20:21], v[64:65] op_sel_hi:[1,0,1]
v_pk_fma_f32 v[66:67], v[14:15], v[20:21], v[66:67] op_sel_hi:[1,0,1]
v_pk_fma_f32 v[68:69], v[12:13], v[22:23], v[68:69] op_sel_hi:[1,0,1]
v_pk_fma_f32 v[70:71], v[14:15], v[22:23], v[70:71] op_sel_hi:[1,0,1]
v_pk_fma_f32 v[72:73], v[12:13], v[24:25], v[72:73] op_sel_hi:[1,0,1]
v_pk_fma_f32 v[74:75], v[14:15], v[24:25], v[74:75] op_sel_hi:[1,0,1]
v_pk_fma_f32 v[76:77], v[12:13], v[26:27], v[76:77] op_sel_hi:[1,0,1]
v_pk_fma_f32 v[78:79], v[14:15], v[26:27], v[78:79] op_sel_hi:[1,0,1]
ds_read_b128 v[12:15], v9 offset:832
s_waitcnt lgkmcnt(1)
v_pk_fma_f32 v[80:81], v[4:5], v[20:21], v[80:81] op_sel_hi:[1,0,1]
v_pk_fma_f32 v[82:83], v[6:7], v[20:21], v[82:83] op_sel_hi:[1,0,1]
v_pk_fma_f32 v[84:85], v[4:5], v[22:23], v[84:85] op_sel_hi:[1,0,1]
v_pk_fma_f32 v[86:87], v[6:7], v[22:23], v[86:87] op_sel_hi:[1,0,1]
v_pk_fma_f32 v[88:89], v[4:5], v[24:25], v[88:89] op_sel_hi:[1,0,1]
v_pk_fma_f32 v[90:91], v[6:7], v[24:25], v[90:91] op_sel_hi:[1,0,1]
v_pk_fma_f32 v[92:93], v[4:5], v[26:27], v[92:93] op_sel_hi:[1,0,1]
v_pk_fma_f32 v[94:95], v[6:7], v[26:27], v[94:95] op_sel_hi:[1,0,1]
ds_read_b128 v[4:7], v9 offset:704
v_pk_mul_f32 v[64:65], v[64:65], v[32:33]
v_pk_mul_f32 v[32:33], v[32:33], v[28:29] op_sel_hi:[1,0]
v_pk_mul_f32 v[66:67], v[66:67], v[34:35]
v_pk_mul_f32 v[34:35], v[34:35], v[28:29] op_sel_hi:[1,0]
v_pk_mul_f32 v[80:81], v[80:81], v[48:49]
v_pk_mul_f32 v[48:49], v[48:49], v[28:29] op_sel_hi:[1,0]
v_pk_mul_f32 v[82:83], v[82:83], v[50:51]
v_pk_mul_f32 v[50:51], v[50:51], v[28:29] op_sel_hi:[1,0]
v_exp_f32 v32, v32
s_nop 0
v_mfma_f32_16x16x32_bf16 v[36:39], a[64:67], a[148:151], v[36:39]
v_exp_f32 v33, v33
v_mfma_f32_16x16x32_bf16 v[52:55], a[68:71], a[148:151], v[52:55]
v_exp_f32 v34, v34
v_mfma_f32_16x16x32_bf16 v[68:71], a[72:75], a[148:151], v[68:71]
v_exp_f32 v35, v35
v_mfma_f32_16x16x32_bf16 v[84:87], a[76:79], a[148:151], v[84:87]
v_exp_f32 v48, v48
v_mfma_f32_16x16x32_bf16 v[36:39], a[80:83], a[164:167], v[36:39]
v_exp_f32 v49, v49
v_mfma_f32_16x16x32_bf16 v[52:55], a[84:87], a[164:167], v[52:55]
v_exp_f32 v50, v50
v_mfma_f32_16x16x32_bf16 v[68:71], a[88:91], a[164:167], v[68:71]
v_exp_f32 v51, v51
v_mfma_f32_16x16x32_bf16 v[84:87], a[92:95], a[164:167], v[84:87]
s_waitcnt vmcnt(2)
v_mfma_f32_16x16x32_bf16 v[36:39], a[96:99], a[180:183], v[36:39]
v_mfma_f32_16x16x32_bf16 v[52:55], a[100:103], a[180:183], v[52:55]
v_mfma_f32_16x16x32_bf16 v[68:71], a[104:107], a[180:183], v[68:71]
v_mfma_f32_16x16x32_bf16 v[84:87], a[108:111], a[180:183], v[84:87]
s_nop 6
v_pk_mul_f32 v[68:69], v[68:69], v[36:37]
v_pk_mul_f32 v[36:37], v[36:37], v[28:29] op_sel:[0,1] op_sel_hi:[1,1]
v_pk_mul_f32 v[70:71], v[70:71], v[38:39]
v_pk_mul_f32 v[38:39], v[38:39], v[28:29] op_sel:[0,1] op_sel_hi:[1,1]
v_pk_mul_f32 v[84:85], v[84:85], v[52:53]
v_pk_mul_f32 v[52:53], v[52:53], v[28:29] op_sel:[0,1] op_sel_hi:[1,1]
v_pk_mul_f32 v[86:87], v[86:87], v[54:55]
v_pk_mul_f32 v[54:55], v[54:55], v[28:29] op_sel:[0,1] op_sel_hi:[1,1]
v_pk_fma_f32 v[32:33], v[32:33], v[20:21], v[20:21] op_sel:[0,1,1] op_sel_hi:[1,1,1]
v_pk_fma_f32 v[34:35], v[34:35], v[20:21], v[20:21] op_sel:[0,1,1] op_sel_hi:[1,1,1]
v_pk_fma_f32 v[48:49], v[48:49], v[20:21], v[20:21] op_sel:[0,1,1] op_sel_hi:[1,1,1]
v_pk_fma_f32 v[50:51], v[50:51], v[20:21], v[20:21] op_sel:[0,1,1] op_sel_hi:[1,1,1]
v_rcp_f32 v32, v32
s_nop 0
v_mfma_f32_16x16x32_bf16 v[40:43], a[64:67], a[152:155], v[40:43]
v_rcp_f32 v33, v33
v_mfma_f32_16x16x32_bf16 v[56:59], a[68:71], a[152:155], v[56:59]
v_rcp_f32 v34, v34
v_mfma_f32_16x16x32_bf16 v[72:75], a[72:75], a[152:155], v[72:75]
v_rcp_f32 v35, v35
v_mfma_f32_16x16x32_bf16 v[88:91], a[76:79], a[152:155], v[88:91]
v_rcp_f32 v48, v48
v_mfma_f32_16x16x32_bf16 v[40:43], a[80:83], a[168:171], v[40:43]
v_rcp_f32 v49, v49
v_mfma_f32_16x16x32_bf16 v[56:59], a[84:87], a[168:171], v[56:59]
v_rcp_f32 v50, v50
v_mfma_f32_16x16x32_bf16 v[72:75], a[88:91], a[168:171], v[72:75]
v_rcp_f32 v51, v51
v_mfma_f32_16x16x32_bf16 v[88:91], a[92:95], a[168:171], v[88:91]
v_exp_f32 v36, v36
s_waitcnt vmcnt(1)
v_mfma_f32_16x16x32_bf16 v[40:43], a[96:99], a[184:187], v[40:43]
v_exp_f32 v37, v37
v_mfma_f32_16x16x32_bf16 v[56:59], a[100:103], a[184:187], v[56:59]
v_exp_f32 v38, v38
v_mfma_f32_16x16x32_bf16 v[72:75], a[104:107], a[184:187], v[72:75]
v_exp_f32 v39, v39
v_mfma_f32_16x16x32_bf16 v[88:91], a[108:111], a[184:187], v[88:91]
v_exp_f32 v52, v52
v_exp_f32 v53, v53
v_exp_f32 v54, v54
v_exp_f32 v55, v55
v_pk_mul_f32 v[64:65], v[64:65], v[32:33]
v_pk_mul_f32 v[66:67], v[66:67], v[34:35]
v_pk_mul_f32 v[80:81], v[80:81], v[48:49]
v_pk_mul_f32 v[82:83], v[82:83], v[50:51]
ds_read_b128 v[48:51], v9 offset:128
v_pk_mul_f32 v[72:73], v[72:73], v[40:41]
v_pk_mul_f32 v[40:41], v[40:41], v[30:31] op_sel_hi:[1,0]
v_pk_mul_f32 v[74:75], v[74:75], v[42:43]
v_pk_mul_f32 v[42:43], v[42:43], v[30:31] op_sel_hi:[1,0]
v_pk_mul_f32 v[88:89], v[88:89], v[56:57]
v_pk_mul_f32 v[56:57], v[56:57], v[30:31] op_sel_hi:[1,0]
v_pk_mul_f32 v[90:91], v[90:91], v[58:59]
v_pk_mul_f32 v[58:59], v[58:59], v[30:31] op_sel_hi:[1,0]
v_pk_fma_f32 v[36:37], v[36:37], v[22:23], v[22:23] op_sel:[0,1,1] op_sel_hi:[1,1,1]
v_pk_fma_f32 v[38:39], v[38:39], v[22:23], v[22:23] op_sel:[0,1,1] op_sel_hi:[1,1,1]
v_pk_fma_f32 v[52:53], v[52:53], v[22:23], v[22:23] op_sel:[0,1,1] op_sel_hi:[1,1,1]
v_pk_fma_f32 v[54:55], v[54:55], v[22:23], v[22:23] op_sel:[0,1,1] op_sel_hi:[1,1,1]
v_cvt_pk_bf16_f32 v32, v64, v65
v_cvt_pk_bf16_f32 v33, v66, v67
ds_read_b128 v[64:67], v9 offset:192
v_cvt_pk_bf16_f32 v34, v80, v81
v_cvt_pk_bf16_f32 v35, v82, v83
v_mfma_f32_16x16x32_bf16 v[44:47], a[64:67], a[156:159], v[44:47]
buffer_store_dwordx4 v[32:35], v10, s[16:19], s62 offen sc1
v_mfma_f32_16x16x32_bf16 v[60:63], a[68:71], a[156:159], v[60:63]
ds_read_b128 v[80:83], v9 offset:640
v_rcp_f32 v36, v36
v_mfma_f32_16x16x32_bf16 v[76:79], a[72:75], a[156:159], v[76:79]
ds_read_b64_tr_b16 a[64:65], v16 offset:50816
v_rcp_f32 v37, v37
v_mfma_f32_16x16x32_bf16 v[92:95], a[76:79], a[156:159], v[92:95]
ds_read_b64_tr_b16 a[66:67], v16 offset:51328
v_rcp_f32 v38, v38
v_mfma_f32_16x16x32_bf16 v[44:47], a[80:83], a[172:175], v[44:47]
ds_read_b64_tr_b16 a[68:69], v16 offset:50848
.Lpad13:
s_cbranch_execz .Lnopoll26r
v_rcp_f32 v39, v39
v_mfma_f32_16x16x32_bf16 v[60:63], a[84:87], a[172:175], v[60:63]
ds_read_b64_tr_b16 a[70:71], v16 offset:51360
v_rcp_f32 v52, v52
v_mfma_f32_16x16x32_bf16 v[76:79], a[88:91], a[172:175], v[76:79]
ds_read_b64_tr_b16 a[72:73], v16 offset:59264
v_rcp_f32 v53, v53
v_mfma_f32_16x16x32_bf16 v[92:95], a[92:95], a[172:175], v[92:95]
ds_read_b64_tr_b16 a[74:75], v16 offset:59776
v_rcp_f32 v54, v54
s_waitcnt vmcnt(1)
v_mfma_f32_16x16x32_bf16 v[44:47], a[96:99], a[188:191], v[44:47]
ds_read_b64_tr_b16 a[76:77], v16 offset:59296
v_rcp_f32 v55, v55
v_mfma_f32_16x16x32_bf16 v[60:63], a[100:103], a[188:191], v[60:63]
ds_read_b64_tr_b16 a[78:79], v16 offset:59808
v_exp_f32 v40, v40
v_mfma_f32_16x16x32_bf16 v[76:79], a[104:107], a[188:191], v[76:79]
ds_read_b64_tr_b16 a[80:81], v17 offset:16896
v_exp_f32 v41, v41
v_mfma_f32_16x16x32_bf16 v[92:95], a[108:111], a[188:191], v[92:95]
ds_read_b64_tr_b16 a[82:83], v17 offset:17408
v_exp_f32 v42, v42
v_exp_f32 v43, v43
v_exp_f32 v56, v56
v_exp_f32 v57, v57
v_exp_f32 v58, v58
v_exp_f32 v59, v59
v_pk_mul_f32 v[68:69], v[68:69], v[36:37]
v_pk_mul_f32 v[70:71], v[70:71], v[38:39]
v_pk_mul_f32 v[84:85], v[84:85], v[52:53]
v_pk_mul_f32 v[86:87], v[86:87], v[54:55]
v_pk_mul_f32 v[76:77], v[76:77], v[44:45]
v_pk_mul_f32 v[44:45], v[44:45], v[30:31] op_sel:[0,1] op_sel_hi:[1,1]
v_pk_mul_f32 v[78:79], v[78:79], v[46:47]
v_pk_mul_f32 v[46:47], v[46:47], v[30:31] op_sel:[0,1] op_sel_hi:[1,1]
v_pk_mul_f32 v[92:93], v[92:93], v[60:61]
v_pk_mul_f32 v[60:61], v[60:61], v[30:31] op_sel:[0,1] op_sel_hi:[1,1]
v_pk_mul_f32 v[94:95], v[94:95], v[62:63]
v_pk_mul_f32 v[62:63], v[62:63], v[30:31] op_sel:[0,1] op_sel_hi:[1,1]
v_pk_fma_f32 v[40:41], v[40:41], v[24:25], v[24:25] op_sel:[0,1,1] op_sel_hi:[1,1,1]
v_pk_fma_f32 v[42:43], v[42:43], v[24:25], v[24:25] op_sel:[0,1,1] op_sel_hi:[1,1,1]
v_pk_fma_f32 v[56:57], v[56:57], v[24:25], v[24:25] op_sel:[0,1,1] op_sel_hi:[1,1,1]
v_pk_fma_f32 v[58:59], v[58:59], v[24:25], v[24:25] op_sel:[0,1,1] op_sel_hi:[1,1,1]
v_cvt_pk_bf16_f32 v36, v68, v69
v_cvt_pk_bf16_f32 v37, v70, v71
v_cvt_pk_bf16_f32 v38, v84, v85
v_cvt_pk_bf16_f32 v39, v86, v87
v_mfma_f32_16x16x32_bf16 v[96:99], a[112:115], a[144:147], v[96:99]
buffer_store_dwordx4 v[36:39], v10, s[16:19], s62 offen offset:1024 sc1
v_mfma_f32_16x16x32_bf16 v[112:115], a[116:119], a[144:147], v[112:115]
ds_read_b64_tr_b16 a[84:85], v17 offset:16928
v_rcp_f32 v40, v40
v_mfma_f32_16x16x32_bf16 v[128:131], a[120:123], a[144:147], v[128:131]
ds_read_b64_tr_b16 a[86:87], v17 offset:17440
v_rcp_f32 v41, v41
v_mfma_f32_16x16x32_bf16 v[144:147], a[124:127], a[144:147], v[144:147]
ds_read_b64_tr_b16 a[88:89], v17 offset:25344
v_rcp_f32 v42, v42
v_mfma_f32_16x16x32_bf16 v[96:99], a[0:3], a[160:163], v[96:99]
ds_read_b64_tr_b16 a[90:91], v17 offset:25856
v_rcp_f32 v43, v43
v_mfma_f32_16x16x32_bf16 v[112:115], a[4:7], a[160:163], v[112:115]
ds_read_b64_tr_b16 a[92:93], v17 offset:25376
v_rcp_f32 v56, v56
v_mfma_f32_16x16x32_bf16 v[128:131], a[8:11], a[160:163], v[128:131]
ds_read_b64_tr_b16 a[94:95], v17 offset:25888
v_rcp_f32 v57, v57
v_mfma_f32_16x16x32_bf16 v[144:147], a[12:15], a[160:163], v[144:147]
ds_read_b64_tr_b16 a[96:97], v17 offset:33792
v_rcp_f32 v58, v58
v_mfma_f32_16x16x32_bf16 v[96:99], a[16:19], a[176:179], v[96:99]
ds_read_b64_tr_b16 a[98:99], v17 offset:34304
v_rcp_f32 v59, v59
v_mfma_f32_16x16x32_bf16 v[112:115], a[20:23], a[176:179], v[112:115]
ds_read_b64_tr_b16 a[100:101], v17 offset:33824
v_exp_f32 v44, v44
v_mfma_f32_16x16x32_bf16 v[128:131], a[24:27], a[176:179], v[128:131]
ds_read_b64_tr_b16 a[102:103], v17 offset:34336
v_exp_f32 v45, v45
v_mfma_f32_16x16x32_bf16 v[144:147], a[28:31], a[176:179], v[144:147]
ds_read_b64_tr_b16 a[104:105], v17 offset:42240
v_exp_f32 v46, v46
v_exp_f32 v47, v47
v_exp_f32 v60, v60
v_exp_f32 v61, v61
v_exp_f32 v62, v62
v_exp_f32 v63, v63
v_pk_mul_f32 v[72:73], v[72:73], v[40:41]
v_pk_mul_f32 v[74:75], v[74:75], v[42:43]
v_pk_mul_f32 v[88:89], v[88:89], v[56:57]
v_pk_mul_f32 v[90:91], v[90:91], v[58:59]
s_waitcnt lgkmcnt(15)
v_pk_fma_f32 v[96:97], v[48:49], v[20:21], v[96:97] op_sel_hi:[1,0,1]
v_pk_fma_f32 v[98:99], v[50:51], v[20:21], v[98:99] op_sel_hi:[1,0,1]
v_pk_fma_f32 v[112:113], v[64:65], v[20:21], v[112:113] op_sel_hi:[1,0,1]
v_pk_fma_f32 v[114:115], v[66:67], v[20:21], v[114:115] op_sel_hi:[1,0,1]
v_pk_fma_f32 v[128:129], v[80:81], v[20:21], v[128:129] op_sel_hi:[1,0,1]
v_pk_fma_f32 v[130:131], v[82:83], v[20:21], v[130:131] op_sel_hi:[1,0,1]
v_pk_fma_f32 v[144:145], v[4:5], v[20:21], v[144:145] op_sel_hi:[1,0,1]
v_pk_fma_f32 v[146:147], v[6:7], v[20:21], v[146:147] op_sel_hi:[1,0,1]
v_pk_mul_f32 v[128:129], v[128:129], v[96:97]
v_pk_mul_f32 v[96:97], v[96:97], v[28:29] op_sel_hi:[1,0]
v_pk_mul_f32 v[130:131], v[130:131], v[98:99]
v_pk_mul_f32 v[98:99], v[98:99], v[28:29] op_sel_hi:[1,0]
v_pk_mul_f32 v[144:145], v[144:145], v[112:113]
v_pk_mul_f32 v[112:113], v[112:113], v[28:29] op_sel_hi:[1,0]
v_pk_mul_f32 v[146:147], v[146:147], v[114:115]
v_pk_mul_f32 v[114:115], v[114:115], v[28:29] op_sel_hi:[1,0]
v_pk_fma_f32 v[44:45], v[44:45], v[26:27], v[26:27] op_sel:[0,1,1] op_sel_hi:[1,1,1]
v_pk_fma_f32 v[46:47], v[46:47], v[26:27], v[26:27] op_sel:[0,1,1] op_sel_hi:[1,1,1]
v_pk_fma_f32 v[60:61], v[60:61], v[26:27], v[26:27] op_sel:[0,1,1] op_sel_hi:[1,1,1]
v_pk_fma_f32 v[62:63], v[62:63], v[26:27], v[26:27] op_sel:[0,1,1] op_sel_hi:[1,1,1]
v_cvt_pk_bf16_f32 v40, v72, v73
v_cvt_pk_bf16_f32 v41, v74, v75
v_cvt_pk_bf16_f32 v42, v88, v89
v_cvt_pk_bf16_f32 v43, v90, v91
v_mfma_f32_16x16x32_bf16 v[100:103], a[112:115], a[148:151], v[100:103]
buffer_store_dwordx4 v[40:43], v11, s[16:19], s62 offen sc1
v_mfma_f32_16x16x32_bf16 v[116:119], a[116:119], a[148:151], v[116:119]
ds_read_b64_tr_b16 a[106:107], v17 offset:42752
v_rcp_f32 v44, v44
v_mfma_f32_16x16x32_bf16 v[132:135], a[120:123], a[148:151], v[132:135]
ds_read_b64_tr_b16 a[108:109], v17 offset:42272
v_rcp_f32 v45, v45
v_mfma_f32_16x16x32_bf16 v[148:151], a[124:127], a[148:151], v[148:151]
ds_read_b64_tr_b16 a[110:111], v17 offset:42784
v_rcp_f32 v46, v46
v_mfma_f32_16x16x32_bf16 v[100:103], a[0:3], a[164:167], v[100:103]
v_rcp_f32 v47, v47
v_mfma_f32_16x16x32_bf16 v[116:119], a[4:7], a[164:167], v[116:119]
v_rcp_f32 v60, v60
v_mfma_f32_16x16x32_bf16 v[132:135], a[8:11], a[164:167], v[132:135]
v_rcp_f32 v61, v61
v_mfma_f32_16x16x32_bf16 v[148:151], a[12:15], a[164:167], v[148:151]
v_rcp_f32 v62, v62
v_mfma_f32_16x16x32_bf16 v[100:103], a[16:19], a[180:183], v[100:103]
v_rcp_f32 v63, v63
v_mfma_f32_16x16x32_bf16 v[116:119], a[20:23], a[180:183], v[116:119]
v_exp_f32 v96, v96
v_mfma_f32_16x16x32_bf16 v[132:135], a[24:27], a[180:183], v[132:135]
v_exp_f32 v97, v97
v_mfma_f32_16x16x32_bf16 v[148:151], a[28:31], a[180:183], v[148:151]
v_exp_f32 v98, v98
v_exp_f32 v99, v99
v_exp_f32 v112, v112
v_exp_f32 v113, v113
v_exp_f32 v114, v114
v_exp_f32 v115, v115
v_pk_mul_f32 v[76:77], v[76:77], v[44:45]
v_pk_mul_f32 v[78:79], v[78:79], v[46:47]
v_pk_mul_f32 v[92:93], v[92:93], v[60:61]
v_pk_mul_f32 v[94:95], v[94:95], v[62:63]
v_pk_fma_f32 v[100:101], v[48:49], v[22:23], v[100:101] op_sel_hi:[1,0,1]
v_pk_fma_f32 v[102:103], v[50:51], v[22:23], v[102:103] op_sel_hi:[1,0,1]
v_pk_fma_f32 v[116:117], v[64:65], v[22:23], v[116:117] op_sel_hi:[1,0,1]
v_pk_fma_f32 v[118:119], v[66:67], v[22:23], v[118:119] op_sel_hi:[1,0,1]
v_pk_fma_f32 v[132:133], v[80:81], v[22:23], v[132:133] op_sel_hi:[1,0,1]
v_pk_fma_f32 v[134:135], v[82:83], v[22:23], v[134:135] op_sel_hi:[1,0,1]
v_pk_fma_f32 v[148:149], v[4:5], v[22:23], v[148:149] op_sel_hi:[1,0,1]
v_pk_fma_f32 v[150:151], v[6:7], v[22:23], v[150:151] op_sel_hi:[1,0,1]
v_pk_mul_f32 v[132:133], v[132:133], v[100:101]
v_pk_mul_f32 v[100:101], v[100:101], v[28:29] op_sel:[0,1] op_sel_hi:[1,1]
v_pk_mul_f32 v[134:135], v[134:135], v[102:103]
v_pk_mul_f32 v[102:103], v[102:103], v[28:29] op_sel:[0,1] op_sel_hi:[1,1]
v_pk_mul_f32 v[148:149], v[148:149], v[116:117]
v_pk_mul_f32 v[116:117], v[116:117], v[28:29] op_sel:[0,1] op_sel_hi:[1,1]
v_pk_mul_f32 v[150:151], v[150:151], v[118:119]
v_pk_mul_f32 v[118:119], v[118:119], v[28:29] op_sel:[0,1] op_sel_hi:[1,1]
v_pk_fma_f32 v[96:97], v[96:97], v[20:21], v[20:21] op_sel:[0,1,1] op_sel_hi:[1,1,1]
v_pk_fma_f32 v[98:99], v[98:99], v[20:21], v[20:21] op_sel:[0,1,1] op_sel_hi:[1,1,1]
v_pk_fma_f32 v[112:113], v[112:113], v[20:21], v[20:21] op_sel:[0,1,1] op_sel_hi:[1,1,1]
v_pk_fma_f32 v[114:115], v[114:115], v[20:21], v[20:21] op_sel:[0,1,1] op_sel_hi:[1,1,1]
v_cvt_pk_bf16_f32 v44, v76, v77
v_cvt_pk_bf16_f32 v45, v78, v79
v_cvt_pk_bf16_f32 v46, v92, v93
v_cvt_pk_bf16_f32 v47, v94, v95
v_mfma_f32_16x16x32_bf16 v[104:107], a[112:115], a[152:155], v[104:107]
buffer_store_dwordx4 v[44:47], v11, s[16:19], s62 offen offset:1024 sc1
v_mfma_f32_16x16x32_bf16 v[120:123], a[116:119], a[152:155], v[120:123]
v_rcp_f32 v96, v96
v_mfma_f32_16x16x32_bf16 v[136:139], a[120:123], a[152:155], v[136:139]
v_rcp_f32 v97, v97
v_mfma_f32_16x16x32_bf16 v[152:155], a[124:127], a[152:155], v[152:155]
v_rcp_f32 v98, v98
v_mfma_f32_16x16x32_bf16 v[104:107], a[0:3], a[168:171], v[104:107]
v_rcp_f32 v99, v99
v_mfma_f32_16x16x32_bf16 v[120:123], a[4:7], a[168:171], v[120:123]
v_rcp_f32 v112, v112
v_mfma_f32_16x16x32_bf16 v[136:139], a[8:11], a[168:171], v[136:139]
v_rcp_f32 v113, v113
v_mfma_f32_16x16x32_bf16 v[152:155], a[12:15], a[168:171], v[152:155]
v_rcp_f32 v114, v114
v_mfma_f32_16x16x32_bf16 v[104:107], a[16:19], a[184:187], v[104:107]
v_rcp_f32 v115, v115
v_mfma_f32_16x16x32_bf16 v[120:123], a[20:23], a[184:187], v[120:123]
v_exp_f32 v100, v100
v_mfma_f32_16x16x32_bf16 v[136:139], a[24:27], a[184:187], v[136:139]
v_exp_f32 v101, v101
v_mfma_f32_16x16x32_bf16 v[152:155], a[28:31], a[184:187], v[152:155]
v_exp_f32 v102, v102
v_exp_f32 v103, v103
v_exp_f32 v116, v116
v_exp_f32 v117, v117
v_exp_f32 v118, v118
v_exp_f32 v119, v119
v_pk_mul_f32 v[128:129], v[128:129], v[96:97]
v_pk_mul_f32 v[130:131], v[130:131], v[98:99]
v_pk_mul_f32 v[144:145], v[144:145], v[112:113]
v_pk_mul_f32 v[146:147], v[146:147], v[114:115]
ds_read_b128 v[112:115], v9 offset:256
v_pk_fma_f32 v[104:105], v[48:49], v[24:25], v[104:105] op_sel_hi:[1,0,1]
v_pk_fma_f32 v[106:107], v[50:51], v[24:25], v[106:107] op_sel_hi:[1,0,1]
v_pk_fma_f32 v[120:121], v[64:65], v[24:25], v[120:121] op_sel_hi:[1,0,1]
v_pk_fma_f32 v[122:123], v[66:67], v[24:25], v[122:123] op_sel_hi:[1,0,1]
v_pk_fma_f32 v[136:137], v[80:81], v[24:25], v[136:137] op_sel_hi:[1,0,1]
v_pk_fma_f32 v[138:139], v[82:83], v[24:25], v[138:139] op_sel_hi:[1,0,1]
v_pk_fma_f32 v[152:153], v[4:5], v[24:25], v[152:153] op_sel_hi:[1,0,1]
v_pk_fma_f32 v[154:155], v[6:7], v[24:25], v[154:155] op_sel_hi:[1,0,1]
v_pk_mul_f32 v[136:137], v[136:137], v[104:105]
v_pk_mul_f32 v[104:105], v[104:105], v[30:31] op_sel_hi:[1,0]
v_pk_mul_f32 v[138:139], v[138:139], v[106:107]
v_pk_mul_f32 v[106:107], v[106:107], v[30:31] op_sel_hi:[1,0]
v_pk_mul_f32 v[152:153], v[152:153], v[120:121]
v_pk_mul_f32 v[120:121], v[120:121], v[30:31] op_sel_hi:[1,0]
v_pk_mul_f32 v[154:155], v[154:155], v[122:123]
v_pk_mul_f32 v[122:123], v[122:123], v[30:31] op_sel_hi:[1,0]
v_pk_fma_f32 v[100:101], v[100:101], v[22:23], v[22:23] op_sel:[0,1,1] op_sel_hi:[1,1,1]
v_pk_fma_f32 v[102:103], v[102:103], v[22:23], v[22:23] op_sel:[0,1,1] op_sel_hi:[1,1,1]
v_pk_fma_f32 v[116:117], v[116:117], v[22:23], v[22:23] op_sel:[0,1,1] op_sel_hi:[1,1,1]
v_pk_fma_f32 v[118:119], v[118:119], v[22:23], v[22:23] op_sel:[0,1,1] op_sel_hi:[1,1,1]
v_cvt_pk_bf16_f32 v96, v128, v129
v_cvt_pk_bf16_f32 v97, v130, v131
ds_read_b128 v[128:131], v9 offset:320
v_cvt_pk_bf16_f32 v98, v144, v145
v_cvt_pk_bf16_f32 v99, v146, v147
v_mfma_f32_16x16x32_bf16 v[108:111], a[112:115], a[156:159], v[108:111]
buffer_store_dwordx4 v[96:99], v10, s[16:19], s63 offen sc1
v_mfma_f32_16x16x32_bf16 v[124:127], a[116:119], a[156:159], v[124:127]
ds_read_b128 v[144:147], v9 offset:768
v_rcp_f32 v100, v100
v_mfma_f32_16x16x32_bf16 v[140:143], a[120:123], a[156:159], v[140:143]
ds_read_b64_tr_b16 a[112:113], v17 offset:50688
v_rcp_f32 v101, v101
v_mfma_f32_16x16x32_bf16 v[156:159], a[124:127], a[156:159], v[156:159]
ds_read_b64_tr_b16 a[114:115], v17 offset:51200
v_rcp_f32 v102, v102
v_mfma_f32_16x16x32_bf16 v[108:111], a[0:3], a[172:175], v[108:111]
ds_read_b64_tr_b16 a[116:117], v17 offset:50720
v_rcp_f32 v103, v103
v_mfma_f32_16x16x32_bf16 v[124:127], a[4:7], a[172:175], v[124:127]
ds_read_b64_tr_b16 a[118:119], v17 offset:51232
v_rcp_f32 v116, v116
v_mfma_f32_16x16x32_bf16 v[140:143], a[8:11], a[172:175], v[140:143]
ds_read_b64_tr_b16 a[120:121], v17 offset:59136
v_rcp_f32 v117, v117
v_mfma_f32_16x16x32_bf16 v[156:159], a[12:15], a[172:175], v[156:159]
ds_read_b64_tr_b16 a[122:123], v17 offset:59648
v_rcp_f32 v118, v118
v_mfma_f32_16x16x32_bf16 v[108:111], a[16:19], a[188:191], v[108:111]
ds_read_b64_tr_b16 a[124:125], v17 offset:59168
v_rcp_f32 v119, v119
v_mfma_f32_16x16x32_bf16 v[124:127], a[20:23], a[188:191], v[124:127]
ds_read_b64_tr_b16 a[126:127], v17 offset:59680
v_exp_f32 v104, v104
v_mfma_f32_16x16x32_bf16 v[140:143], a[24:27], a[188:191], v[140:143]
v_exp_f32 v105, v105
v_mfma_f32_16x16x32_bf16 v[156:159], a[28:31], a[188:191], v[156:159]
v_exp_f32 v106, v106
v_exp_f32 v107, v107
v_exp_f32 v120, v120
v_exp_f32 v121, v121
v_exp_f32 v122, v122
v_exp_f32 v123, v123
v_pk_mul_f32 v[132:133], v[132:133], v[100:101]
v_pk_mul_f32 v[134:135], v[134:135], v[102:103]
v_pk_mul_f32 v[148:149], v[148:149], v[116:117]
v_pk_mul_f32 v[150:151], v[150:151], v[118:119]
v_pk_fma_f32 v[108:109], v[48:49], v[26:27], v[108:109] op_sel_hi:[1,0,1]
v_pk_fma_f32 v[110:111], v[50:51], v[26:27], v[110:111] op_sel_hi:[1,0,1]
v_pk_fma_f32 v[124:125], v[64:65], v[26:27], v[124:125] op_sel_hi:[1,0,1]
v_pk_fma_f32 v[126:127], v[66:67], v[26:27], v[126:127] op_sel_hi:[1,0,1]
v_pk_fma_f32 v[140:141], v[80:81], v[26:27], v[140:141] op_sel_hi:[1,0,1]
v_pk_fma_f32 v[142:143], v[82:83], v[26:27], v[142:143] op_sel_hi:[1,0,1]
s_waitcnt lgkmcnt(0)
s_barrier
v_pk_fma_f32 v[156:157], v[4:5], v[26:27], v[156:157] op_sel_hi:[1,0,1]
v_pk_fma_f32 v[158:159], v[6:7], v[26:27], v[158:159] op_sel_hi:[1,0,1]
ds_read_b128 v[4:7], v8 offset:576
v_pk_mul_f32 v[140:141], v[140:141], v[108:109]
v_pk_mul_f32 v[108:109], v[108:109], v[30:31] op_sel:[0,1] op_sel_hi:[1,1]
v_pk_mul_f32 v[142:143], v[142:143], v[110:111]
v_pk_mul_f32 v[110:111], v[110:111], v[30:31] op_sel:[0,1] op_sel_hi:[1,1]
v_pk_mul_f32 v[156:157], v[156:157], v[124:125]
v_pk_mul_f32 v[124:125], v[124:125], v[30:31] op_sel:[0,1] op_sel_hi:[1,1]
v_pk_mul_f32 v[158:159], v[158:159], v[126:127]
v_pk_mul_f32 v[126:127], v[126:127], v[30:31] op_sel:[0,1] op_sel_hi:[1,1]
v_pk_fma_f32 v[104:105], v[104:105], v[24:25], v[24:25] op_sel:[0,1,1] op_sel_hi:[1,1,1]
v_pk_fma_f32 v[106:107], v[106:107], v[24:25], v[24:25] op_sel:[0,1,1] op_sel_hi:[1,1,1]
v_pk_fma_f32 v[120:121], v[120:121], v[24:25], v[24:25] op_sel:[0,1,1] op_sel_hi:[1,1,1]
v_pk_fma_f32 v[122:123], v[122:123], v[24:25], v[24:25] op_sel:[0,1,1] op_sel_hi:[1,1,1]
v_cvt_pk_bf16_f32 v100, v132, v133
v_cvt_pk_bf16_f32 v101, v134, v135
v_cvt_pk_bf16_f32 v102, v148, v149
v_cvt_pk_bf16_f32 v103, v150, v151
v_mfma_f32_16x16x32_bf16 v[160:163], a[32:35], a[144:147], v[160:163]
buffer_store_dwordx4 v[100:103], v10, s[16:19], s63 offen offset:1024 sc1
v_mfma_f32_16x16x32_bf16 v[176:179], a[36:39], a[144:147], v[176:179]
s_add_u32 m0, s59, 83200
v_rcp_f32 v104, v104
v_mfma_f32_16x16x32_bf16 v[192:195], a[40:43], a[144:147], v[192:195]
v_rcp_f32 v105, v105
v_mfma_f32_16x16x32_bf16 v[208:211], a[44:47], a[144:147], v[208:211]
v_rcp_f32 v106, v106
v_mfma_f32_16x16x32_bf16 v[160:163], a[48:51], a[160:163], v[160:163]
buffer_load_dwordx4 v18, s[28:31], s58 offen lds
v_mfma_f32_16x16x32_bf16 v[176:179], a[52:55], a[160:163], v[176:179]
v_rcp_f32 v107, v107
v_mfma_f32_16x16x32_bf16 v[192:195], a[56:59], a[160:163], v[192:195]
v_rcp_f32 v120, v120
v_mfma_f32_16x16x32_bf16 v[208:211], a[60:63], a[160:163], v[208:211]
v_rcp_f32 v121, v121
v_mfma_f32_16x16x32_bf16 v[160:163], a[64:67], a[176:179], v[160:163]
buffer_load_dwordx4 v19, s[28:31], s58 offen offset:1024 lds
v_mfma_f32_16x16x32_bf16 v[176:179], a[68:71], a[176:179], v[176:179]
s_add_u32 m0, s59, 91520
s_mov_b32 s58, 1441792
v_rcp_f32 v122, v122
v_mfma_f32_16x16x32_bf16 v[192:195], a[72:75], a[176:179], v[192:195]
v_rcp_f32 v123, v123
v_mfma_f32_16x16x32_bf16 v[208:211], a[76:79], a[176:179], v[208:211]
v_exp_f32 v108, v108
v_exp_f32 v109, v109
v_exp_f32 v110, v110
v_exp_f32 v111, v111
v_exp_f32 v124, v124
v_exp_f32 v125, v125
v_exp_f32 v126, v126
v_exp_f32 v127, v127
v_pk_mul_f32 v[136:137], v[136:137], v[104:105]
v_pk_mul_f32 v[138:139], v[138:139], v[106:107]
v_pk_mul_f32 v[152:153], v[152:153], v[120:121]
v_pk_mul_f32 v[154:155], v[154:155], v[122:123]
v_pk_fma_f32 v[160:161], v[112:113], v[20:21], v[160:161] op_sel_hi:[1,0,1]
v_pk_fma_f32 v[162:163], v[114:115], v[20:21], v[162:163] op_sel_hi:[1,0,1]
v_pk_fma_f32 v[176:177], v[128:129], v[20:21], v[176:177] op_sel_hi:[1,0,1]
v_pk_fma_f32 v[178:179], v[130:131], v[20:21], v[178:179] op_sel_hi:[1,0,1]
v_pk_fma_f32 v[192:193], v[144:145], v[20:21], v[192:193] op_sel_hi:[1,0,1]
v_pk_fma_f32 v[194:195], v[146:147], v[20:21], v[194:195] op_sel_hi:[1,0,1]
v_pk_fma_f32 v[208:209], v[12:13], v[20:21], v[208:209] op_sel_hi:[1,0,1]
v_pk_fma_f32 v[210:211], v[14:15], v[20:21], v[210:211] op_sel_hi:[1,0,1]
v_pk_mul_f32 v[192:193], v[192:193], v[160:161]
v_pk_mul_f32 v[160:161], v[160:161], v[28:29] op_sel_hi:[1,0]
v_pk_mul_f32 v[194:195], v[194:195], v[162:163]
v_pk_mul_f32 v[162:163], v[162:163], v[28:29] op_sel_hi:[1,0]
v_pk_mul_f32 v[208:209], v[208:209], v[176:177]
v_pk_mul_f32 v[176:177], v[176:177], v[28:29] op_sel_hi:[1,0]
v_pk_mul_f32 v[210:211], v[210:211], v[178:179]
v_pk_mul_f32 v[178:179], v[178:179], v[28:29] op_sel_hi:[1,0]
v_pk_fma_f32 v[108:109], v[108:109], v[26:27], v[26:27] op_sel:[0,1,1] op_sel_hi:[1,1,1]
v_pk_fma_f32 v[110:111], v[110:111], v[26:27], v[26:27] op_sel:[0,1,1] op_sel_hi:[1,1,1]
v_pk_fma_f32 v[124:125], v[124:125], v[26:27], v[26:27] op_sel:[0,1,1] op_sel_hi:[1,1,1]
v_pk_fma_f32 v[126:127], v[126:127], v[26:27], v[26:27] op_sel:[0,1,1] op_sel_hi:[1,1,1]
v_cvt_pk_bf16_f32 v104, v136, v137
v_cvt_pk_bf16_f32 v105, v138, v139
v_cvt_pk_bf16_f32 v106, v152, v153
v_cvt_pk_bf16_f32 v107, v154, v155
v_mfma_f32_16x16x32_bf16 v[164:167], a[32:35], a[148:151], v[164:167]
buffer_store_dwordx4 v[104:107], v11, s[16:19], s63 offen sc1
v_mfma_f32_16x16x32_bf16 v[180:183], a[36:39], a[148:151], v[180:183]
v_rcp_f32 v108, v108
v_mfma_f32_16x16x32_bf16 v[196:199], a[40:43], a[148:151], v[196:199]
v_rcp_f32 v109, v109
v_mfma_f32_16x16x32_bf16 v[212:215], a[44:47], a[148:151], v[212:215]
v_rcp_f32 v110, v110
v_mfma_f32_16x16x32_bf16 v[164:167], a[48:51], a[164:167], v[164:167]
buffer_load_dwordx4 v18, s[28:31], s58 offen lds
v_mfma_f32_16x16x32_bf16 v[180:183], a[52:55], a[164:167], v[180:183]
v_rcp_f32 v111, v111
v_mfma_f32_16x16x32_bf16 v[196:199], a[56:59], a[164:167], v[196:199]
v_rcp_f32 v124, v124
v_mfma_f32_16x16x32_bf16 v[212:215], a[60:63], a[164:167], v[212:215]
v_rcp_f32 v125, v125
v_mfma_f32_16x16x32_bf16 v[164:167], a[64:67], a[180:183], v[164:167]
buffer_load_dwordx4 v19, s[28:31], s58 offen offset:1024 lds
v_mfma_f32_16x16x32_bf16 v[180:183], a[68:71], a[180:183], v[180:183]
s_add_u32 m0, s59, 99840
s_mov_b32 s58, 1572864
v_rcp_f32 v126, v126
v_mfma_f32_16x16x32_bf16 v[196:199], a[72:75], a[180:183], v[196:199]
v_rcp_f32 v127, v127
v_mfma_f32_16x16x32_bf16 v[212:215], a[76:79], a[180:183], v[212:215]
v_exp_f32 v160, v160
v_exp_f32 v161, v161
v_exp_f32 v162, v162
v_exp_f32 v163, v163
v_exp_f32 v176, v176
v_exp_f32 v177, v177
v_exp_f32 v178, v178
v_exp_f32 v179, v179
v_pk_mul_f32 v[140:141], v[140:141], v[108:109]
v_pk_mul_f32 v[142:143], v[142:143], v[110:111]
v_pk_mul_f32 v[156:157], v[156:157], v[124:125]
v_pk_mul_f32 v[158:159], v[158:159], v[126:127]
v_pk_fma_f32 v[164:165], v[112:113], v[22:23], v[164:165] op_sel_hi:[1,0,1]
v_pk_fma_f32 v[166:167], v[114:115], v[22:23], v[166:167] op_sel_hi:[1,0,1]
v_pk_fma_f32 v[180:181], v[128:129], v[22:23], v[180:181] op_sel_hi:[1,0,1]
v_pk_fma_f32 v[182:183], v[130:131], v[22:23], v[182:183] op_sel_hi:[1,0,1]
v_pk_fma_f32 v[196:197], v[144:145], v[22:23], v[196:197] op_sel_hi:[1,0,1]
v_pk_fma_f32 v[198:199], v[146:147], v[22:23], v[198:199] op_sel_hi:[1,0,1]
v_pk_fma_f32 v[212:213], v[12:13], v[22:23], v[212:213] op_sel_hi:[1,0,1]
v_pk_fma_f32 v[214:215], v[14:15], v[22:23], v[214:215] op_sel_hi:[1,0,1]
v_pk_mul_f32 v[196:197], v[196:197], v[164:165]
v_pk_mul_f32 v[164:165], v[164:165], v[28:29] op_sel:[0,1] op_sel_hi:[1,1]
v_pk_mul_f32 v[198:199], v[198:199], v[166:167]
v_pk_mul_f32 v[166:167], v[166:167], v[28:29] op_sel:[0,1] op_sel_hi:[1,1]
v_pk_mul_f32 v[212:213], v[212:213], v[180:181]
v_pk_mul_f32 v[180:181], v[180:181], v[28:29] op_sel:[0,1] op_sel_hi:[1,1]
v_pk_mul_f32 v[214:215], v[214:215], v[182:183]
v_pk_mul_f32 v[182:183], v[182:183], v[28:29] op_sel:[0,1] op_sel_hi:[1,1]
v_pk_fma_f32 v[160:161], v[160:161], v[20:21], v[20:21] op_sel:[0,1,1] op_sel_hi:[1,1,1]
v_pk_fma_f32 v[162:163], v[162:163], v[20:21], v[20:21] op_sel:[0,1,1] op_sel_hi:[1,1,1]
v_pk_fma_f32 v[176:177], v[176:177], v[20:21], v[20:21] op_sel:[0,1,1] op_sel_hi:[1,1,1]
v_pk_fma_f32 v[178:179], v[178:179], v[20:21], v[20:21] op_sel:[0,1,1] op_sel_hi:[1,1,1]
v_cvt_pk_bf16_f32 v108, v140, v141
v_cvt_pk_bf16_f32 v109, v142, v143
v_cvt_pk_bf16_f32 v110, v156, v157
v_cvt_pk_bf16_f32 v111, v158, v159
v_mfma_f32_16x16x32_bf16 v[168:171], a[32:35], a[152:155], v[168:171]
buffer_store_dwordx4 v[108:111], v11, s[16:19], s63 offen offset:1024 sc1
v_mfma_f32_16x16x32_bf16 v[184:187], a[36:39], a[152:155], v[184:187]
v_rcp_f32 v160, v160
v_mfma_f32_16x16x32_bf16 v[200:203], a[40:43], a[152:155], v[200:203]
v_rcp_f32 v161, v161
v_mfma_f32_16x16x32_bf16 v[216:219], a[44:47], a[152:155], v[216:219]
v_rcp_f32 v162, v162
v_mfma_f32_16x16x32_bf16 v[168:171], a[48:51], a[168:171], v[168:171]
buffer_load_dwordx4 v18, s[28:31], s58 offen lds
v_mfma_f32_16x16x32_bf16 v[184:187], a[52:55], a[168:171], v[184:187]
v_rcp_f32 v163, v163
v_mfma_f32_16x16x32_bf16 v[200:203], a[56:59], a[168:171], v[200:203]
v_rcp_f32 v176, v176
v_mfma_f32_16x16x32_bf16 v[216:219], a[60:63], a[168:171], v[216:219]
v_rcp_f32 v177, v177
v_mfma_f32_16x16x32_bf16 v[168:171], a[64:67], a[184:187], v[168:171]
buffer_load_dwordx4 v19, s[28:31], s58 offen offset:1024 lds
v_mfma_f32_16x16x32_bf16 v[184:187], a[68:71], a[184:187], v[184:187]
s_add_u32 m0, s59, 108160
s_mov_b32 s58, 1703936
v_rcp_f32 v178, v178
v_mfma_f32_16x16x32_bf16 v[200:203], a[72:75], a[184:187], v[200:203]
v_rcp_f32 v179, v179
v_mfma_f32_16x16x32_bf16 v[216:219], a[76:79], a[184:187], v[216:219]
v_exp_f32 v164, v164
v_exp_f32 v165, v165
v_exp_f32 v166, v166
v_exp_f32 v167, v167
v_exp_f32 v180, v180
v_exp_f32 v181, v181
v_exp_f32 v182, v182
v_exp_f32 v183, v183
v_pk_mul_f32 v[192:193], v[192:193], v[160:161]
v_pk_mul_f32 v[194:195], v[194:195], v[162:163]
v_pk_mul_f32 v[208:209], v[208:209], v[176:177]
v_pk_mul_f32 v[210:211], v[210:211], v[178:179]
ds_read_b128 v[176:179], v8
v_pk_fma_f32 v[168:169], v[112:113], v[24:25], v[168:169] op_sel_hi:[1,0,1]
v_pk_fma_f32 v[170:171], v[114:115], v[24:25], v[170:171] op_sel_hi:[1,0,1]
v_pk_fma_f32 v[184:185], v[128:129], v[24:25], v[184:185] op_sel_hi:[1,0,1]
v_pk_fma_f32 v[186:187], v[130:131], v[24:25], v[186:187] op_sel_hi:[1,0,1]
v_pk_fma_f32 v[200:201], v[144:145], v[24:25], v[200:201] op_sel_hi:[1,0,1]
v_pk_fma_f32 v[202:203], v[146:147], v[24:25], v[202:203] op_sel_hi:[1,0,1]
v_pk_fma_f32 v[216:217], v[12:13], v[24:25], v[216:217] op_sel_hi:[1,0,1]
v_pk_fma_f32 v[218:219], v[14:15], v[24:25], v[218:219] op_sel_hi:[1,0,1]
v_pk_mul_f32 v[200:201], v[200:201], v[168:169]
v_pk_mul_f32 v[168:169], v[168:169], v[30:31] op_sel_hi:[1,0]
v_pk_mul_f32 v[202:203], v[202:203], v[170:171]
v_pk_mul_f32 v[170:171], v[170:171], v[30:31] op_sel_hi:[1,0]
v_pk_mul_f32 v[216:217], v[216:217], v[184:185]
v_pk_mul_f32 v[184:185], v[184:185], v[30:31] op_sel_hi:[1,0]
v_pk_mul_f32 v[218:219], v[218:219], v[186:187]
v_pk_mul_f32 v[186:187], v[186:187], v[30:31] op_sel_hi:[1,0]
v_pk_fma_f32 v[164:165], v[164:165], v[22:23], v[22:23] op_sel:[0,1,1] op_sel_hi:[1,1,1]
v_pk_fma_f32 v[166:167], v[166:167], v[22:23], v[22:23] op_sel:[0,1,1] op_sel_hi:[1,1,1]
v_pk_fma_f32 v[180:181], v[180:181], v[22:23], v[22:23] op_sel:[0,1,1] op_sel_hi:[1,1,1]
v_pk_fma_f32 v[182:183], v[182:183], v[22:23], v[22:23] op_sel:[0,1,1] op_sel_hi:[1,1,1]
v_cvt_pk_bf16_f32 v160, v192, v193
v_cvt_pk_bf16_f32 v161, v194, v195
ds_read_b128 v[192:195], v8 offset:64
v_cvt_pk_bf16_f32 v162, v208, v209
v_cvt_pk_bf16_f32 v163, v210, v211
v_mfma_f32_16x16x32_bf16 v[172:175], a[32:35], a[156:159], v[172:175]
buffer_store_dwordx4 v[160:163], v10, s[16:19], s64 offen sc1
v_mfma_f32_16x16x32_bf16 v[188:191], a[36:39], a[156:159], v[188:191]
ds_read_b128 v[208:211], v8 offset:512
v_rcp_f32 v164, v164
v_mfma_f32_16x16x32_bf16 v[204:207], a[40:43], a[156:159], v[204:207]
v_rcp_f32 v165, v165
v_mfma_f32_16x16x32_bf16 v[220:223], a[44:47], a[156:159], v[220:223]
v_rcp_f32 v166, v166
v_mfma_f32_16x16x32_bf16 v[172:175], a[48:51], a[172:175], v[172:175]
buffer_load_dwordx4 v18, s[28:31], s58 offen lds
v_mfma_f32_16x16x32_bf16 v[188:191], a[52:55], a[172:175], v[188:191]
v_rcp_f32 v167, v167
v_mfma_f32_16x16x32_bf16 v[204:207], a[56:59], a[172:175], v[204:207]
v_rcp_f32 v180, v180
v_mfma_f32_16x16x32_bf16 v[220:223], a[60:63], a[172:175], v[220:223]
v_rcp_f32 v181, v181
v_mfma_f32_16x16x32_bf16 v[172:175], a[64:67], a[188:191], v[172:175]
buffer_load_dwordx4 v19, s[28:31], s58 offen offset:1024 lds
v_mfma_f32_16x16x32_bf16 v[188:191], a[68:71], a[188:191], v[188:191]
s_add_u32 m0, s59, 116480
s_mov_b32 s58, 1835008
v_rcp_f32 v182, v182
v_mfma_f32_16x16x32_bf16 v[204:207], a[72:75], a[188:191], v[204:207]
v_rcp_f32 v183, v183
v_mfma_f32_16x16x32_bf16 v[220:223], a[76:79], a[188:191], v[220:223]
v_exp_f32 v168, v168
v_exp_f32 v169, v169
v_exp_f32 v170, v170
v_exp_f32 v171, v171
v_exp_f32 v184, v184
v_exp_f32 v185, v185
v_exp_f32 v186, v186
v_exp_f32 v187, v187
v_pk_mul_f32 v[196:197], v[196:197], v[164:165]
v_pk_mul_f32 v[198:199], v[198:199], v[166:167]
v_pk_mul_f32 v[212:213], v[212:213], v[180:181]
v_pk_mul_f32 v[214:215], v[214:215], v[182:183]
v_pk_fma_f32 v[172:173], v[112:113], v[26:27], v[172:173] op_sel_hi:[1,0,1]
v_pk_fma_f32 v[174:175], v[114:115], v[26:27], v[174:175] op_sel_hi:[1,0,1]
v_pk_fma_f32 v[188:189], v[128:129], v[26:27], v[188:189] op_sel_hi:[1,0,1]
v_pk_fma_f32 v[190:191], v[130:131], v[26:27], v[190:191] op_sel_hi:[1,0,1]
v_pk_fma_f32 v[204:205], v[144:145], v[26:27], v[204:205] op_sel_hi:[1,0,1]
v_pk_fma_f32 v[206:207], v[146:147], v[26:27], v[206:207] op_sel_hi:[1,0,1]
v_pk_fma_f32 v[220:221], v[12:13], v[26:27], v[220:221] op_sel_hi:[1,0,1]
v_pk_fma_f32 v[222:223], v[14:15], v[26:27], v[222:223] op_sel_hi:[1,0,1]
v_pk_mul_f32 v[204:205], v[204:205], v[172:173]
v_pk_mul_f32 v[172:173], v[172:173], v[30:31] op_sel:[0,1] op_sel_hi:[1,1]
v_pk_mul_f32 v[206:207], v[206:207], v[174:175]
v_pk_mul_f32 v[174:175], v[174:175], v[30:31] op_sel:[0,1] op_sel_hi:[1,1]
v_pk_mul_f32 v[220:221], v[220:221], v[188:189]
v_pk_mul_f32 v[188:189], v[188:189], v[30:31] op_sel:[0,1] op_sel_hi:[1,1]
v_pk_mul_f32 v[222:223], v[222:223], v[190:191]
v_pk_mul_f32 v[190:191], v[190:191], v[30:31] op_sel:[0,1] op_sel_hi:[1,1]
v_pk_fma_f32 v[168:169], v[168:169], v[24:25], v[24:25] op_sel:[0,1,1] op_sel_hi:[1,1,1]
v_pk_fma_f32 v[170:171], v[170:171], v[24:25], v[24:25] op_sel:[0,1,1] op_sel_hi:[1,1,1]
v_pk_fma_f32 v[184:185], v[184:185], v[24:25], v[24:25] op_sel:[0,1,1] op_sel_hi:[1,1,1]
v_pk_fma_f32 v[186:187], v[186:187], v[24:25], v[24:25] op_sel:[0,1,1] op_sel_hi:[1,1,1]
v_cvt_pk_bf16_f32 v164, v196, v197
v_cvt_pk_bf16_f32 v165, v198, v199
v_cvt_pk_bf16_f32 v166, v212, v213
v_cvt_pk_bf16_f32 v167, v214, v215
v_mfma_f32_16x16x32_bf16 v[224:227], a[80:83], a[144:147], v[224:227]
buffer_store_dwordx4 v[164:167], v10, s[16:19], s64 offen offset:1024 sc1
v_mfma_f32_16x16x32_bf16 v[232:235], a[84:87], a[144:147], v[232:235]
v_rcp_f32 v168, v168
v_mfma_f32_16x16x32_bf16 v[240:243], a[88:91], a[144:147], v[240:243]
v_rcp_f32 v169, v169
v_mfma_f32_16x16x32_bf16 v[248:251], a[92:95], a[144:147], v[248:251]
v_rcp_f32 v170, v170
v_mfma_f32_16x16x32_bf16 v[224:227], a[96:99], a[160:163], v[224:227]
buffer_load_dwordx4 v18, s[28:31], s58 offen lds
v_mfma_f32_16x16x32_bf16 v[232:235], a[100:103], a[160:163], v[232:235]
v_rcp_f32 v171, v171
v_mfma_f32_16x16x32_bf16 v[240:243], a[104:107], a[160:163], v[240:243]
v_rcp_f32 v184, v184
v_mfma_f32_16x16x32_bf16 v[248:251], a[108:111], a[160:163], v[248:251]
v_rcp_f32 v185, v185
v_mfma_f32_16x16x32_bf16 v[224:227], a[112:115], a[176:179], v[224:227]
buffer_load_dwordx4 v19, s[28:31], s58 offen offset:1024 lds
v_mfma_f32_16x16x32_bf16 v[232:235], a[116:119], a[176:179], v[232:235]
s_add_u32 m0, s59, 124800
s_mov_b32 s58, 1966080
v_rcp_f32 v186, v186
v_mfma_f32_16x16x32_bf16 v[240:243], a[120:123], a[176:179], v[240:243]
v_rcp_f32 v187, v187
v_mfma_f32_16x16x32_bf16 v[248:251], a[124:127], a[176:179], v[248:251]
v_exp_f32 v172, v172
v_exp_f32 v173, v173
v_exp_f32 v174, v174
v_exp_f32 v175, v175
v_exp_f32 v188, v188
v_exp_f32 v189, v189
v_exp_f32 v190, v190
v_exp_f32 v191, v191
v_pk_mul_f32 v[200:201], v[200:201], v[168:169]
v_pk_mul_f32 v[202:203], v[202:203], v[170:171]
v_pk_mul_f32 v[216:217], v[216:217], v[184:185]
v_pk_mul_f32 v[218:219], v[218:219], v[186:187]
s_waitcnt lgkmcnt(2)
v_pk_fma_f32 v[224:225], v[176:177], v[20:21], v[224:225] op_sel_hi:[1,0,1]
v_pk_fma_f32 v[226:227], v[178:179], v[20:21], v[226:227] op_sel_hi:[1,0,1]
.Lpad14:
s_cbranch_execz .Lnopoll26r
s_waitcnt lgkmcnt(1)
v_pk_fma_f32 v[232:233], v[192:193], v[20:21], v[232:233] op_sel_hi:[1,0,1]
v_pk_fma_f32 v[234:235], v[194:195], v[20:21], v[234:235] op_sel_hi:[1,0,1]
s_waitcnt lgkmcnt(0)
v_pk_fma_f32 v[240:241], v[208:209], v[20:21], v[240:241] op_sel_hi:[1,0,1]
v_pk_fma_f32 v[242:243], v[210:211], v[20:21], v[242:243] op_sel_hi:[1,0,1]
v_pk_fma_f32 v[248:249], v[4:5], v[20:21], v[248:249] op_sel_hi:[1,0,1]
v_pk_fma_f32 v[250:251], v[6:7], v[20:21], v[250:251] op_sel_hi:[1,0,1]
v_pk_mul_f32 v[240:241], v[240:241], v[224:225]
v_pk_mul_f32 v[224:225], v[224:225], v[28:29] op_sel_hi:[1,0]
v_pk_mul_f32 v[242:243], v[242:243], v[226:227]
v_pk_mul_f32 v[226:227], v[226:227], v[28:29] op_sel_hi:[1,0]
v_pk_mul_f32 v[248:249], v[248:249], v[232:233]
v_pk_mul_f32 v[232:233], v[232:233], v[28:29] op_sel_hi:[1,0]
v_pk_mul_f32 v[250:251], v[250:251], v[234:235]
v_pk_mul_f32 v[234:235], v[234:235], v[28:29] op_sel_hi:[1,0]
v_pk_fma_f32 v[172:173], v[172:173], v[26:27], v[26:27] op_sel:[0,1,1] op_sel_hi:[1,1,1]
v_pk_fma_f32 v[174:175], v[174:175], v[26:27], v[26:27] op_sel:[0,1,1] op_sel_hi:[1,1,1]
v_pk_fma_f32 v[188:189], v[188:189], v[26:27], v[26:27] op_sel:[0,1,1] op_sel_hi:[1,1,1]
v_pk_fma_f32 v[190:191], v[190:191], v[26:27], v[26:27] op_sel:[0,1,1] op_sel_hi:[1,1,1]
v_cvt_pk_bf16_f32 v168, v200, v201
v_cvt_pk_bf16_f32 v169, v202, v203
v_cvt_pk_bf16_f32 v170, v216, v217
v_cvt_pk_bf16_f32 v171, v218, v219
v_mfma_f32_16x16x32_bf16 v[228:231], a[80:83], a[148:151], v[228:231]
buffer_store_dwordx4 v[168:171], v11, s[16:19], s64 offen sc1
v_mfma_f32_16x16x32_bf16 v[236:239], a[84:87], a[148:151], v[236:239]
v_rcp_f32 v172, v172
v_mfma_f32_16x16x32_bf16 v[244:247], a[88:91], a[148:151], v[244:247]
v_rcp_f32 v173, v173
v_mfma_f32_16x16x32_bf16 v[252:255], a[92:95], a[148:151], v[252:255]
v_rcp_f32 v174, v174
v_mfma_f32_16x16x32_bf16 v[228:231], a[96:99], a[164:167], v[228:231]
buffer_load_dwordx4 v18, s[28:31], s58 offen lds
v_mfma_f32_16x16x32_bf16 v[236:239], a[100:103], a[164:167], v[236:239]
v_rcp_f32 v175, v175
v_mfma_f32_16x16x32_bf16 v[244:247], a[104:107], a[164:167], v[244:247]
v_rcp_f32 v188, v188
v_mfma_f32_16x16x32_bf16 v[252:255], a[108:111], a[164:167], v[252:255]
v_rcp_f32 v189, v189
v_mfma_f32_16x16x32_bf16 v[228:231], a[112:115], a[180:183], v[228:231]
buffer_load_dwordx4 v19, s[28:31], s58 offen offset:1024 lds
v_mfma_f32_16x16x32_bf16 v[236:239], a[116:119], a[180:183], v[236:239]
v_rcp_f32 v190, v190
v_mfma_f32_16x16x32_bf16 v[244:247], a[120:123], a[180:183], v[244:247]
v_rcp_f32 v191, v191
v_mfma_f32_16x16x32_bf16 v[252:255], a[124:127], a[180:183], v[252:255]
v_exp_f32 v224, v224
v_exp_f32 v225, v225
v_exp_f32 v226, v226
v_exp_f32 v227, v227
v_exp_f32 v232, v232
v_exp_f32 v233, v233
v_exp_f32 v234, v234
v_exp_f32 v235, v235
v_pk_mul_f32 v[204:205], v[204:205], v[172:173]
v_pk_mul_f32 v[206:207], v[206:207], v[174:175]
v_pk_mul_f32 v[220:221], v[220:221], v[188:189]
v_pk_mul_f32 v[222:223], v[222:223], v[190:191]
v_pk_fma_f32 v[228:229], v[176:177], v[22:23], v[228:229] op_sel_hi:[1,0,1]
v_pk_fma_f32 v[230:231], v[178:179], v[22:23], v[230:231] op_sel_hi:[1,0,1]
v_pk_fma_f32 v[236:237], v[192:193], v[22:23], v[236:237] op_sel_hi:[1,0,1]
v_pk_fma_f32 v[238:239], v[194:195], v[22:23], v[238:239] op_sel_hi:[1,0,1]
v_pk_fma_f32 v[244:245], v[208:209], v[22:23], v[244:245] op_sel_hi:[1,0,1]
v_pk_fma_f32 v[246:247], v[210:211], v[22:23], v[246:247] op_sel_hi:[1,0,1]
v_pk_fma_f32 v[252:253], v[4:5], v[22:23], v[252:253] op_sel_hi:[1,0,1]
v_pk_fma_f32 v[254:255], v[6:7], v[22:23], v[254:255] op_sel_hi:[1,0,1]
v_pk_mul_f32 v[244:245], v[244:245], v[228:229]
v_pk_mul_f32 v[228:229], v[228:229], v[28:29] op_sel:[0,1] op_sel_hi:[1,1]
v_pk_mul_f32 v[246:247], v[246:247], v[230:231]
v_pk_mul_f32 v[230:231], v[230:231], v[28:29] op_sel:[0,1] op_sel_hi:[1,1]
v_pk_mul_f32 v[252:253], v[252:253], v[236:237]
v_pk_mul_f32 v[236:237], v[236:237], v[28:29] op_sel:[0,1] op_sel_hi:[1,1]
v_pk_mul_f32 v[254:255], v[254:255], v[238:239]
v_pk_mul_f32 v[238:239], v[238:239], v[28:29] op_sel:[0,1] op_sel_hi:[1,1]
v_pk_fma_f32 v[224:225], v[224:225], v[20:21], v[20:21] op_sel:[0,1,1] op_sel_hi:[1,1,1]
v_pk_fma_f32 v[226:227], v[226:227], v[20:21], v[20:21] op_sel:[0,1,1] op_sel_hi:[1,1,1]
v_pk_fma_f32 v[232:233], v[232:233], v[20:21], v[20:21] op_sel:[0,1,1] op_sel_hi:[1,1,1]
v_pk_fma_f32 v[234:235], v[234:235], v[20:21], v[20:21] op_sel:[0,1,1] op_sel_hi:[1,1,1]
v_cvt_pk_bf16_f32 v172, v204, v205
v_cvt_pk_bf16_f32 v173, v206, v207
v_cvt_pk_bf16_f32 v174, v220, v221
v_cvt_pk_bf16_f32 v175, v222, v223
buffer_store_dwordx4 v[172:175], v11, s[16:19], s64 offen offset:1024 sc1
v_rcp_f32 v224, v224
v_rcp_f32 v225, v225
v_rcp_f32 v226, v226
v_rcp_f32 v227, v227
v_rcp_f32 v232, v232
v_rcp_f32 v233, v233
v_rcp_f32 v234, v234
v_rcp_f32 v235, v235
v_exp_f32 v228, v228
v_exp_f32 v229, v229
v_exp_f32 v230, v230
v_exp_f32 v231, v231
v_exp_f32 v236, v236
v_exp_f32 v237, v237
v_exp_f32 v238, v238
v_exp_f32 v239, v239
v_pk_mul_f32 v[240:241], v[240:241], v[224:225]
v_pk_mul_f32 v[242:243], v[242:243], v[226:227]
v_pk_mul_f32 v[248:249], v[248:249], v[232:233]
v_pk_mul_f32 v[250:251], v[250:251], v[234:235]
v_pk_fma_f32 v[228:229], v[228:229], v[22:23], v[22:23] op_sel:[0,1,1] op_sel_hi:[1,1,1]
v_pk_fma_f32 v[230:231], v[230:231], v[22:23], v[22:23] op_sel:[0,1,1] op_sel_hi:[1,1,1]
v_pk_fma_f32 v[236:237], v[236:237], v[22:23], v[22:23] op_sel:[0,1,1] op_sel_hi:[1,1,1]
v_pk_fma_f32 v[238:239], v[238:239], v[22:23], v[22:23] op_sel:[0,1,1] op_sel_hi:[1,1,1]
v_cvt_pk_bf16_f32 v224, v240, v241
v_cvt_pk_bf16_f32 v225, v242, v243
v_cvt_pk_bf16_f32 v226, v248, v249
v_cvt_pk_bf16_f32 v227, v250, v251
buffer_store_dwordx4 v[224:227], v10, s[16:19], s65 offen sc1
v_rcp_f32 v228, v228
v_rcp_f32 v229, v229
v_rcp_f32 v230, v230
v_rcp_f32 v231, v231
v_rcp_f32 v236, v236
v_rcp_f32 v237, v237
v_rcp_f32 v238, v238
v_rcp_f32 v239, v239
v_pk_mul_f32 v[244:245], v[244:245], v[228:229]
v_pk_mul_f32 v[246:247], v[246:247], v[230:231]
v_pk_mul_f32 v[252:253], v[252:253], v[236:237]
v_pk_mul_f32 v[254:255], v[254:255], v[238:239]
v_cvt_pk_bf16_f32 v228, v244, v245
v_cvt_pk_bf16_f32 v229, v246, v247
v_cvt_pk_bf16_f32 v230, v252, v253
v_cvt_pk_bf16_f32 v231, v254, v255
buffer_store_dwordx4 v[228:231], v10, s[16:19], s65 offen offset:1024 sc1
s_nop 1
s_branch .Lj32
.Lpad15:
s_cbranch_execz .Lnopoll26r
.Lx28:
buffer_load_dword v28, v8, s[32:35], s45 offen
buffer_load_dword v29, v7, s[28:31], s44 offen
s_add_u32 s44, s44, 1310720
s_add_u32 s45, s45, 917504
s_mov_b32 s47, 3
s_branch .Lx28b
.Lx29:
buffer_load_dword v28, v8, s[32:35], s45 offen
buffer_load_dword v29, v7, s[28:31], s44 offen
s_add_u32 s44, s44, 1310720
s_add_u32 s45, s45, 917504
s_mov_b32 s47, 3
s_branch .Lx29b
.Lx30:
buffer_load_dword v28, v8, s[32:35], s45 offen
buffer_load_dword v29, v7, s[28:31], s44 offen
s_add_u32 s44, s44, 1310720
s_add_u32 s45, s45, 917504
s_mov_b32 s47, 3
s_branch .Lx30b
.Lx31:
buffer_load_dword v28, v8, s[32:35], s45 offen
buffer_load_dword v29, v7, s[28:31], s44 offen
s_add_u32 s44, s44, 1310720
s_add_u32 s45, s45, 917504
s_mov_b32 s47, 3
s_branch .Lx31b
.Lj32:
s_lshl_b32 s62, s5, 2
s_add_u32 s62, s62, s3
s_lshl_b32 s62, s62, 13
s_and_b32 s63, s7, 8
s_lshl_b32 s63, s63, 7
s_add_u32 s62, s62, s63
s_lshr_b32 s63, s28, 7
s_sub_u32 s63, 3, s63
s_and_b32 s63, s63, 7
s_lshl_b32 s63, s63, 7
s_add_u32 s62, s62, s63
v_lshrrev_b32 v9, 4, v1
v_lshl_add_u32 v9, v9, 11, s62
s_mov_b32 s44, 2097152
buffer_load_dword v27, v9, s[28:31], s44 offen
s_add_u32 s44, s44, 0x100000
s_lshl_b32 s62, s6, 13
s_lshl_b32 s63, s3, 11
s_add_u32 s62, s62, s63
v_lshl_add_u32 v4, v1, 4, s62
v_lshrrev_b32 v2, 3, v1
v_cmp_eq_u32 vcc, 3, v2
v_add_u32 v2, 67108480, v4
s_nop 0
v_cndmask_b32 v4, v4, v2, vcc
v_bfe_u32 v5, v1, 3, 1
v_lshrrev_b32 v2, 4, v1
v_lshl_add_u32 v5, v2, 3, v5
s_lshl_b32 s62, s3, 1
v_add_u32 v5, s62, v5
v_mul_u32_u24 v5, 2048, v5
v_and_b32 v2, 7, v1
v_lshl_add_u32 v5, v2, 4, v5
s_lshl_b32 s62, s7, 7
v_add_u32 v5, s62, v5
v_add_u32 v6, 64512, v5
v_bfe_u32 v8, v1, 3, 2
v_mul_u32_u24 v8, 2080, v8
v_bfe_u32 v2, v1, 2, 1
v_lshl_add_u32 v8, v2, 7, v8
v_bfe_u32 v2, v1, 5, 1
v_lshl_add_u32 v8, v2, 8, v8
v_and_b32 v2, 3, v1
v_lshl_add_u32 v8, v2, 3, v8
s_mov_b32 s57, 0
v_add_u32 v7, s57, v8
s_mov_b32 s52, 12582912
s_mov_b32 s53, 12713984
s_mov_b32 s54, 2097152
s_mul_i32 s56, s3, 2080
v_accvgpr_read_b32 v32, a224
v_accvgpr_read_b32 v33, a225
v_accvgpr_read_b32 v34, a226
v_accvgpr_read_b32 v35, a227
v_accvgpr_read_b32 v36, a228
v_accvgpr_read_b32 v37, a229
v_accvgpr_read_b32 v38, a230
v_accvgpr_read_b32 v39, a231
v_accvgpr_read_b32 v40, a232
v_accvgpr_read_b32 v41, a233
v_accvgpr_read_b32 v42, a234
v_accvgpr_read_b32 v43, a235
v_accvgpr_read_b32 v44, a236
v_accvgpr_read_b32 v45, a237
v_accvgpr_read_b32 v46, a238
v_accvgpr_read_b32 v47, a239
v_accvgpr_read_b32 v48, a240
v_accvgpr_read_b32 v49, a241
v_accvgpr_read_b32 v50, a242
v_accvgpr_read_b32 v51, a243
v_accvgpr_read_b32 v52, a244
v_accvgpr_read_b32 v53, a245
v_accvgpr_read_b32 v54, a246
v_accvgpr_read_b32 v55, a247
v_accvgpr_read_b32 v56, a248
v_accvgpr_read_b32 v57, a249
v_accvgpr_read_b32 v58, a250
v_accvgpr_read_b32 v59, a251
v_accvgpr_read_b32 v60, a252
v_accvgpr_read_b32 v61, a253
v_accvgpr_read_b32 v62, a254
v_accvgpr_read_b32 v63, a255
v_bfe_u32 v18, v1, 3, 1
v_lshrrev_b32 v2, 4, v1
v_lshl_add_u32 v18, v2, 3, v18
s_lshl_b32 s62, s3, 1
v_add_u32 v18, s62, v18
v_mul_u32_u24 v18, 6144, v18
v_and_b32 v2, 7, v1
v_lshl_add_u32 v18, v2, 4, v18
s_lshl_b32 s62, s9, 7
v_add_u32 v18, s62, v18
v_add_u32 v19, 1024, v18
v_add_u32 v20, 2048, v18
s_mul_i32 s59, s3, 3104
s_mov_b32 s58, 0
s_lshl_b32 s62, s10, 1
s_add_u32 s62, s62, s12
s_lshl_b32 s62, s62, 7
s_add_u32 s62, s62, 30414848
s_and_b32 s64, s6, 14
s_lshl_b32 s64, s64, 7
s_add_u32 s64, s64, 30414848
s_add_u32 s65, s64, 128
v_mov_b32 v252, s62
v_mov_b32 v253, s64
v_writelane_b32 v253, s65, 1
s_waitcnt vmcnt(0) lgkmcnt(0)
s_barrier
s_cmp_lg_u32 s3, 0
s_cbranch_scc1 .Lnosig33
v_mov_b32 v255, 1
s_mov_b64 exec, 1
buffer_atomic_add v255, v252, s[16:19], 0 offen
s_mov_b64 exec, -1
.Lnosig33:
ds_read_b64_tr_b16 a[0:1], v7
ds_read_b64_tr_b16 a[2:3], v7 offset:512
ds_read_b64_tr_b16 a[4:5], v7 offset:32
ds_read_b64_tr_b16 a[6:7], v7 offset:544
ds_read_b64_tr_b16 a[8:9], v7 offset:64
ds_read_b64_tr_b16 a[10:11], v7 offset:576
ds_read_b64_tr_b16 a[12:13], v7 offset:96
ds_read_b64_tr_b16 a[14:15], v7 offset:608
ds_read_b64_tr_b16 a[16:17], v7 offset:1024
ds_read_b64_tr_b16 a[18:19], v7 offset:1536
ds_read_b64_tr_b16 a[20:21], v7 offset:1056
ds_read_b64_tr_b16 a[22:23], v7 offset:1568
ds_read_b64_tr_b16 a[24:25], v7 offset:1088
ds_read_b64_tr_b16 a[26:27], v7 offset:1600
ds_read_b64_tr_b16 a[28:29], v7 offset:1120
ds_read_b64_tr_b16 a[30:31], v7 offset:1632
s_waitcnt lgkmcnt(0)
s_cmp_lg_u32 s3, 1
s_cbranch_scc1 .Lnopoll36
s_mov_b64 exec, 3
s_mov_b32 s15, 0
.Lpoll34:
buffer_load_dword v255, v253, s[16:19], 0 offen sc1
s_add_u32 s15, s15, 1
s_cmp_gt_u32 s15, 100000
s_cbranch_scc1 .Lgot35
s_waitcnt vmcnt(0)
v_cmp_ne_u32 vcc, 16, v255
s_nop 0
s_cbranch_vccnz .Lpoll34
.Lgot35:
s_waitcnt vmcnt(0)
s_branch .Lnopoll36r
.Lnopoll36:
s_mov_b64 exec, 0
s_cmp_eq_u32 s3, 2
s_cbranch_scc1 .Lpad16
s_cmp_eq_u32 s3, 3
s_cbranch_scc1 .Lpad17
s_branch .Lpad18
.Lnopoll36r:
s_mov_b64 exec, -1
s_barrier
buffer_load_dwordx4 v[64:67], v4, s[16:19], s52 offen sc1
buffer_load_dwordx4 v[68:71], v4, s[16:19], s52 offen offset:1024 sc1
s_add_u32 s52, s52, 0x40000
buffer_load_dwordx4 v[72:75], v4, s[16:19], s53 offen sc1
buffer_load_dwordx4 v[76:79], v4, s[16:19], s53 offen offset:1024 sc1
s_add_u32 s53, s53, 0x40000
buffer_load_dwordx4 v[80:83], v4, s[16:19], s52 offen sc1
buffer_load_dwordx4 v[84:87], v4, s[16:19], s52 offen offset:1024 sc1
s_add_u32 s52, s52, 0x40000
buffer_load_dwordx4 v[88:91], v4, s[16:19], s53 offen sc1
buffer_load_dwordx4 v[92:95], v4, s[16:19], s53 offen offset:1024 sc1
s_add_u32 s53, s53, 0x40000
buffer_load_dwordx4 v[96:99], v4, s[16:19], s52 offen sc1
buffer_load_dwordx4 v[100:103], v4, s[16:19], s52 offen offset:1024 sc1
s_add_u32 s52, s52, 0x40000
buffer_load_dwordx4 v[104:107], v4, s[16:19], s53 offen sc1
buffer_load_dwordx4 v[108:111], v4, s[16:19], s53 offen offset:1024 sc1
s_add_u32 s53, s53, 0x40000
s_mov_b32 s15, -5
.p2align 6
.Lk37:
s_waitcnt lgkmcnt(0)
s_barrier
s_add_u32 s55, s56, s57
s_waitcnt vmcnt(11)
v_mfma_f32_16x16x32_bf16 v[32:35], a[0:3], v[64:67], v[32:35]
ds_read_b64_tr_b16 a[32:33], v7 offset:8320
ds_read_b64_tr_b16 a[34:35], v7 offset:8832
s_add_u32 m0, s55, 0
s_waitcnt vmcnt(10)
v_mfma_f32_16x16x32_bf16 v[48:51], a[0:3], v[68:71], v[48:51]
ds_read_b64_tr_b16 a[36:37], v7 offset:8352
buffer_load_dwordx4 v5, s[28:31], s54 offen lds
v_mfma_f32_16x16x32_bf16 v[36:39], a[4:7], v[64:67], v[36:39]
ds_read_b64_tr_b16 a[38:39], v7 offset:8864
ds_read_b64_tr_b16 a[40:41], v7 offset:8384
v_mfma_f32_16x16x32_bf16 v[52:55], a[4:7], v[68:71], v[52:55]
ds_read_b64_tr_b16 a[42:43], v7 offset:8896
buffer_load_dwordx4 v[112:115], v4, s[16:19], s52 offen sc1
v_mfma_f32_16x16x32_bf16 v[40:43], a[8:11], v[64:67], v[40:43]
ds_read_b64_tr_b16 a[44:45], v7 offset:8416
ds_read_b64_tr_b16 a[46:47], v7 offset:8928
v_mfma_f32_16x16x32_bf16 v[56:59], a[8:11], v[68:71], v[56:59]
ds_read_b64_tr_b16 a[48:49], v7 offset:9344
buffer_load_dwordx4 v[116:119], v4, s[16:19], s52 offen offset:1024 sc1
v_mfma_f32_16x16x32_bf16 v[44:47], a[12:15], v[64:67], v[44:47]
ds_read_b64_tr_b16 a[50:51], v7 offset:9856
ds_read_b64_tr_b16 a[52:53], v7 offset:9376
s_add_u32 s52, s52, 0x40000
v_mfma_f32_16x16x32_bf16 v[60:63], a[12:15], v[68:71], v[60:63]
ds_read_b64_tr_b16 a[54:55], v7 offset:9888
ds_read_b64_tr_b16 a[56:57], v7 offset:9408
s_waitcnt vmcnt(12)
v_mfma_f32_16x16x32_bf16 v[32:35], a[16:19], v[72:75], v[32:35]
ds_read_b64_tr_b16 a[58:59], v7 offset:9920
buffer_load_dwordx4 v6, s[28:31], s54 offen offset:1024 lds
s_waitcnt vmcnt(12)
v_mfma_f32_16x16x32_bf16 v[48:51], a[16:19], v[76:79], v[48:51]
ds_read_b64_tr_b16 a[60:61], v7 offset:9440
ds_read_b64_tr_b16 a[62:63], v7 offset:9952
s_add_u32 s54, s54, 0x20000
v_mfma_f32_16x16x32_bf16 v[36:39], a[20:23], v[72:75], v[36:39]
buffer_load_dwordx4 v[120:123], v4, s[16:19], s53 offen sc1
v_mfma_f32_16x16x32_bf16 v[52:55], a[20:23], v[76:79], v[52:55]
v_mfma_f32_16x16x32_bf16 v[40:43], a[24:27], v[72:75], v[40:43]
buffer_load_dwordx4 v[124:127], v4, s[16:19], s53 offen offset:1024 sc1
v_mfma_f32_16x16x32_bf16 v[56:59], a[24:27], v[76:79], v[56:59]
s_add_u32 s53, s53, 0x40000
v_mfma_f32_16x16x32_bf16 v[44:47], a[28:31], v[72:75], v[44:47]
v_mfma_f32_16x16x32_bf16 v[60:63], a[28:31], v[76:79], v[60:63]
s_waitcnt lgkmcnt(0)
s_barrier
s_waitcnt vmcnt(13)
v_mfma_f32_16x16x32_bf16 v[32:35], a[32:35], v[80:83], v[32:35]
ds_read_b64_tr_b16 a[0:1], v7 offset:16640
ds_read_b64_tr_b16 a[2:3], v7 offset:17152
s_add_u32 m0, s55, 8320
s_waitcnt vmcnt(12)
v_mfma_f32_16x16x32_bf16 v[48:51], a[32:35], v[84:87], v[48:51]
ds_read_b64_tr_b16 a[4:5], v7 offset:16672
buffer_load_dwordx4 v5, s[28:31], s54 offen lds
v_mfma_f32_16x16x32_bf16 v[36:39], a[36:39], v[80:83], v[36:39]
ds_read_b64_tr_b16 a[6:7], v7 offset:17184
ds_read_b64_tr_b16 a[8:9], v7 offset:16704
v_mfma_f32_16x16x32_bf16 v[52:55], a[36:39], v[84:87], v[52:55]
ds_read_b64_tr_b16 a[10:11], v7 offset:17216
buffer_load_dwordx4 v[64:67], v4, s[16:19], s52 offen sc1
v_mfma_f32_16x16x32_bf16 v[40:43], a[40:43], v[80:83], v[40:43]
ds_read_b64_tr_b16 a[12:13], v7 offset:16736
ds_read_b64_tr_b16 a[14:15], v7 offset:17248
v_mfma_f32_16x16x32_bf16 v[56:59], a[40:43], v[84:87], v[56:59]
ds_read_b64_tr_b16 a[16:17], v7 offset:17664
buffer_load_dwordx4 v[68:71], v4, s[16:19], s52 offen offset:1024 sc1
v_mfma_f32_16x16x32_bf16 v[44:47], a[44:47], v[80:83], v[44:47]
ds_read_b64_tr_b16 a[18:19], v7 offset:18176
ds_read_b64_tr_b16 a[20:21], v7 offset:17696
s_add_u32 s52, s52, 0x40000
v_mfma_f32_16x16x32_bf16 v[60:63], a[44:47], v[84:87], v[60:63]
ds_read_b64_tr_b16 a[22:23], v7 offset:18208
buffer_load_dwordx4 v6, s[28:31], s54 offen offset:1024 lds
s_waitcnt vmcnt(15)
v_mfma_f32_16x16x32_bf16 v[32:35], a[48:51], v[88:91], v[32:35]
ds_read_b64_tr_b16 a[24:25], v7 offset:17728
ds_read_b64_tr_b16 a[26:27], v7 offset:18240
s_add_u32 s54, s54, 0x20000
s_waitcnt vmcnt(14)
v_mfma_f32_16x16x32_bf16 v[48:51], a[48:51], v[92:95], v[48:51]
ds_read_b64_tr_b16 a[28:29], v7 offset:17760
buffer_load_dwordx4 v[72:75], v4, s[16:19], s53 offen sc1
v_mfma_f32_16x16x32_bf16 v[36:39], a[52:55], v[88:91], v[36:39]
ds_read_b64_tr_b16 a[30:31], v7 offset:18272
v_mfma_f32_16x16x32_bf16 v[52:55], a[52:55], v[92:95], v[52:55]
buffer_load_dwordx4 v[76:79], v4, s[16:19], s53 offen offset:1024 sc1
v_mfma_f32_16x16x32_bf16 v[40:43], a[56:59], v[88:91], v[40:43]
s_add_u32 s53, s53, 0x40000
v_mfma_f32_16x16x32_bf16 v[56:59], a[56:59], v[92:95], v[56:59]
buffer_load_dword v27, v9, s[28:31], s44 offen
v_mfma_f32_16x16x32_bf16 v[44:47], a[60:63], v[88:91], v[44:47]
s_add_u32 s44, s44, 0x100000
v_mfma_f32_16x16x32_bf16 v[60:63], a[60:63], v[92:95], v[60:63]
s_waitcnt lgkmcnt(0)
s_barrier
s_waitcnt vmcnt(16)
v_mfma_f32_16x16x32_bf16 v[32:35], a[0:3], v[96:99], v[32:35]
ds_read_b64_tr_b16 a[32:33], v7 offset:24960
ds_read_b64_tr_b16 a[34:35], v7 offset:25472
s_add_u32 m0, s55, 16640
s_waitcnt vmcnt(15)
v_mfma_f32_16x16x32_bf16 v[48:51], a[0:3], v[100:103], v[48:51]
ds_read_b64_tr_b16 a[36:37], v7 offset:24992
buffer_load_dwordx4 v5, s[28:31], s54 offen lds
v_mfma_f32_16x16x32_bf16 v[36:39], a[4:7], v[96:99], v[36:39]
ds_read_b64_tr_b16 a[38:39], v7 offset:25504
ds_read_b64_tr_b16 a[40:41], v7 offset:25024
v_mfma_f32_16x16x32_bf16 v[52:55], a[4:7], v[100:103], v[52:55]
ds_read_b64_tr_b16 a[42:43], v7 offset:25536
buffer_load_dwordx4 v[80:83], v4, s[16:19], s52 offen sc1
v_mfma_f32_16x16x32_bf16 v[40:43], a[8:11], v[96:99], v[40:43]
ds_read_b64_tr_b16 a[44:45], v7 offset:25056
ds_read_b64_tr_b16 a[46:47], v7 offset:25568
v_mfma_f32_16x16x32_bf16 v[56:59], a[8:11], v[100:103], v[56:59]
ds_read_b64_tr_b16 a[48:49], v7 offset:25984
buffer_load_dwordx4 v[84:87], v4, s[16:19], s52 offen offset:1024 sc1
v_mfma_f32_16x16x32_bf16 v[44:47], a[12:15], v[96:99], v[44:47]
ds_read_b64_tr_b16 a[50:51], v7 offset:26496
ds_read_b64_tr_b16 a[52:53], v7 offset:26016
s_add_u32 s52, s52, 0x40000
v_mfma_f32_16x16x32_bf16 v[60:63], a[12:15], v[100:103], v[60:63]
ds_read_b64_tr_b16 a[54:55], v7 offset:26528
ds_read_b64_tr_b16 a[56:57], v7 offset:26048
s_waitcnt vmcnt(17)
v_mfma_f32_16x16x32_bf16 v[32:35], a[16:19], v[104:107], v[32:35]
ds_read_b64_tr_b16 a[58:59], v7 offset:26560
buffer_load_dwordx4 v6, s[28:31], s54 offen offset:1024 lds
s_waitcnt vmcnt(17)
v_mfma_f32_16x16x32_bf16 v[48:51], a[16:19], v[108:111], v[48:51]
ds_read_b64_tr_b16 a[60:61], v7 offset:26080
ds_read_b64_tr_b16 a[62:63], v7 offset:26592
s_add_u32 s54, s54, 0x20000
v_mfma_f32_16x16x32_bf16 v[36:39], a[20:23], v[104:107], v[36:39]
buffer_load_dwordx4 v[88:91], v4, s[16:19], s53 offen sc1
v_mfma_f32_16x16x32_bf16 v[52:55], a[20:23], v[108:111], v[52:55]
v_mfma_f32_16x16x32_bf16 v[40:43], a[24:27], v[104:107], v[40:43]
buffer_load_dwordx4 v[92:95], v4, s[16:19], s53 offen offset:1024 sc1
v_mfma_f32_16x16x32_bf16 v[56:59], a[24:27], v[108:111], v[56:59]
s_add_u32 s53, s53, 0x40000
v_mfma_f32_16x16x32_bf16 v[44:47], a[28:31], v[104:107], v[44:47]
v_mfma_f32_16x16x32_bf16 v[60:63], a[28:31], v[108:111], v[60:63]
s_waitcnt lgkmcnt(0)
s_barrier
s_waitcnt vmcnt(17)
v_mfma_f32_16x16x32_bf16 v[32:35], a[32:35], v[112:115], v[32:35]
ds_read_b64_tr_b16 a[0:1], v7 offset:33280
ds_read_b64_tr_b16 a[2:3], v7 offset:33792
s_add_u32 m0, s55, 24960
s_waitcnt vmcnt(16)
v_mfma_f32_16x16x32_bf16 v[48:51], a[32:35], v[116:119], v[48:51]
ds_read_b64_tr_b16 a[4:5], v7 offset:33312
buffer_load_dwordx4 v5, s[28:31], s54 offen lds
v_mfma_f32_16x16x32_bf16 v[36:39], a[36:39], v[112:115], v[36:39]
ds_read_b64_tr_b16 a[6:7], v7 offset:33824
ds_read_b64_tr_b16 a[8:9], v7 offset:33344
v_mfma_f32_16x16x32_bf16 v[52:55], a[36:39], v[116:119], v[52:55]
ds_read_b64_tr_b16 a[10:11], v7 offset:33856
buffer_load_dwordx4 v[96:99], v4, s[16:19], s52 offen sc1
v_mfma_f32_16x16x32_bf16 v[40:43], a[40:43], v[112:115], v[40:43]
ds_read_b64_tr_b16 a[12:13], v7 offset:33376
ds_read_b64_tr_b16 a[14:15], v7 offset:33888
v_mfma_f32_16x16x32_bf16 v[56:59], a[40:43], v[116:119], v[56:59]
ds_read_b64_tr_b16 a[16:17], v7 offset:34304
buffer_load_dwordx4 v[100:103], v4, s[16:19], s52 offen offset:1024 sc1
v_mfma_f32_16x16x32_bf16 v[44:47], a[44:47], v[112:115], v[44:47]
ds_read_b64_tr_b16 a[18:19], v7 offset:34816
ds_read_b64_tr_b16 a[20:21], v7 offset:34336
s_add_u32 s52, s52, 0x40000
v_mfma_f32_16x16x32_bf16 v[60:63], a[44:47], v[116:119], v[60:63]
ds_read_b64_tr_b16 a[22:23], v7 offset:34848
ds_read_b64_tr_b16 a[24:25], v7 offset:34368
s_waitcnt vmcnt(17)
v_mfma_f32_16x16x32_bf16 v[32:35], a[48:51], v[120:123], v[32:35]
ds_read_b64_tr_b16 a[26:27], v7 offset:34880
buffer_load_dwordx4 v6, s[28:31], s54 offen offset:1024 lds
s_waitcnt vmcnt(17)
v_mfma_f32_16x16x32_bf16 v[48:51], a[48:51], v[124:127], v[48:51]
ds_read_b64_tr_b16 a[28:29], v7 offset:34400
ds_read_b64_tr_b16 a[30:31], v7 offset:34912
s_add_u32 s54, s54, 0x20000
v_mfma_f32_16x16x32_bf16 v[36:39], a[52:55], v[120:123], v[36:39]
buffer_load_dwordx4 v[104:107], v4, s[16:19], s53 offen sc1
v_mfma_f32_16x16x32_bf16 v[52:55], a[52:55], v[124:127], v[52:55]
v_mfma_f32_16x16x32_bf16 v[40:43], a[56:59], v[120:123], v[40:43]
buffer_load_dwordx4 v[108:111], v4, s[16:19], s53 offen offset:1024 sc1
v_mfma_f32_16x16x32_bf16 v[56:59], a[56:59], v[124:127], v[56:59]
s_add_u32 s53, s53, 0x40000
v_mfma_f32_16x16x32_bf16 v[44:47], a[60:63], v[120:123], v[44:47]
v_mfma_f32_16x16x32_bf16 v[60:63], a[60:63], v[124:127], v[60:63]
s_waitcnt lgkmcnt(0)
s_barrier
s_waitcnt vmcnt(17)
v_mfma_f32_16x16x32_bf16 v[32:35], a[0:3], v[64:67], v[32:35]
ds_read_b64_tr_b16 a[32:33], v7 offset:41600
ds_read_b64_tr_b16 a[34:35], v7 offset:42112
s_add_u32 m0, s55, 33280
s_waitcnt vmcnt(16)
v_mfma_f32_16x16x32_bf16 v[48:51], a[0:3], v[68:71], v[48:51]
ds_read_b64_tr_b16 a[36:37], v7 offset:41632
buffer_load_dwordx4 v5, s[28:31], s54 offen lds
v_mfma_f32_16x16x32_bf16 v[36:39], a[4:7], v[64:67], v[36:39]
ds_read_b64_tr_b16 a[38:39], v7 offset:42144
ds_read_b64_tr_b16 a[40:41], v7 offset:41664
v_mfma_f32_16x16x32_bf16 v[52:55], a[4:7], v[68:71], v[52:55]
ds_read_b64_tr_b16 a[42:43], v7 offset:42176
buffer_load_dwordx4 v[112:115], v4, s[16:19], s52 offen sc1
v_mfma_f32_16x16x32_bf16 v[40:43], a[8:11], v[64:67], v[40:43]
ds_read_b64_tr_b16 a[44:45], v7 offset:41696
ds_read_b64_tr_b16 a[46:47], v7 offset:42208
v_mfma_f32_16x16x32_bf16 v[56:59], a[8:11], v[68:71], v[56:59]
ds_read_b64_tr_b16 a[48:49], v7 offset:42624
buffer_load_dwordx4 v[116:119], v4, s[16:19], s52 offen offset:1024 sc1
v_mfma_f32_16x16x32_bf16 v[44:47], a[12:15], v[64:67], v[44:47]
ds_read_b64_tr_b16 a[50:51], v7 offset:43136
ds_read_b64_tr_b16 a[52:53], v7 offset:42656
s_add_u32 s52, s52, 0x40000
v_mfma_f32_16x16x32_bf16 v[60:63], a[12:15], v[68:71], v[60:63]
ds_read_b64_tr_b16 a[54:55], v7 offset:43168
ds_read_b64_tr_b16 a[56:57], v7 offset:42688
s_waitcnt vmcnt(17)
v_mfma_f32_16x16x32_bf16 v[32:35], a[16:19], v[72:75], v[32:35]
ds_read_b64_tr_b16 a[58:59], v7 offset:43200
buffer_load_dwordx4 v6, s[28:31], s54 offen offset:1024 lds
s_waitcnt vmcnt(17)
v_mfma_f32_16x16x32_bf16 v[48:51], a[16:19], v[76:79], v[48:51]
ds_read_b64_tr_b16 a[60:61], v7 offset:42720
ds_read_b64_tr_b16 a[62:63], v7 offset:43232
s_add_u32 s54, s54, 0x20000
v_mfma_f32_16x16x32_bf16 v[36:39], a[20:23], v[72:75], v[36:39]
buffer_load_dwordx4 v[120:123], v4, s[16:19], s53 offen sc1
v_mfma_f32_16x16x32_bf16 v[52:55], a[20:23], v[76:79], v[52:55]
v_mfma_f32_16x16x32_bf16 v[40:43], a[24:27], v[72:75], v[40:43]
buffer_load_dwordx4 v[124:127], v4, s[16:19], s53 offen offset:1024 sc1
v_mfma_f32_16x16x32_bf16 v[56:59], a[24:27], v[76:79], v[56:59]
s_add_u32 s53, s53, 0x40000
v_mfma_f32_16x16x32_bf16 v[44:47], a[28:31], v[72:75], v[44:47]
v_mfma_f32_16x16x32_bf16 v[60:63], a[28:31], v[76:79], v[60:63]
s_waitcnt lgkmcnt(0)
s_barrier
s_waitcnt vmcnt(16)
v_mfma_f32_16x16x32_bf16 v[32:35], a[32:35], v[80:83], v[32:35]
ds_read_b64_tr_b16 a[0:1], v7 offset:49920
ds_read_b64_tr_b16 a[2:3], v7 offset:50432
s_add_u32 m0, s55, 41600
s_waitcnt vmcnt(15)
v_mfma_f32_16x16x32_bf16 v[48:51], a[32:35], v[84:87], v[48:51]
ds_read_b64_tr_b16 a[4:5], v7 offset:49952
buffer_load_dwordx4 v5, s[28:31], s54 offen lds
v_mfma_f32_16x16x32_bf16 v[36:39], a[36:39], v[80:83], v[36:39]
ds_read_b64_tr_b16 a[6:7], v7 offset:50464
ds_read_b64_tr_b16 a[8:9], v7 offset:49984
v_mfma_f32_16x16x32_bf16 v[52:55], a[36:39], v[84:87], v[52:55]
.Lpad16:
s_cbranch_execz .Lnopoll36r
ds_read_b64_tr_b16 a[10:11], v7 offset:50496
buffer_load_dwordx4 v[64:67], v4, s[16:19], s52 offen sc1
v_mfma_f32_16x16x32_bf16 v[40:43], a[40:43], v[80:83], v[40:43]
ds_read_b64_tr_b16 a[12:13], v7 offset:50016
ds_read_b64_tr_b16 a[14:15], v7 offset:50528
v_mfma_f32_16x16x32_bf16 v[56:59], a[40:43], v[84:87], v[56:59]
ds_read_b64_tr_b16 a[16:17], v7 offset:50944
buffer_load_dwordx4 v[68:71], v4, s[16:19], s52 offen offset:1024 sc1
v_mfma_f32_16x16x32_bf16 v[44:47], a[44:47], v[80:83], v[44:47]
ds_read_b64_tr_b16 a[18:19], v7 offset:51456
ds_read_b64_tr_b16 a[20:21], v7 offset:50976
s_add_u32 s52, s52, 0x40000
v_mfma_f32_16x16x32_bf16 v[60:63], a[44:47], v[84:87], v[60:63]
ds_read_b64_tr_b16 a[22:23], v7 offset:51488
ds_read_b64_tr_b16 a[24:25], v7 offset:51008
s_waitcnt vmcnt(16)
v_mfma_f32_16x16x32_bf16 v[32:35], a[48:51], v[88:91], v[32:35]
ds_read_b64_tr_b16 a[26:27], v7 offset:51520
buffer_load_dwordx4 v6, s[28:31], s54 offen offset:1024 lds
s_waitcnt vmcnt(16)
v_mfma_f32_16x16x32_bf16 v[48:51], a[48:51], v[92:95], v[48:51]
ds_read_b64_tr_b16 a[28:29], v7 offset:51040
ds_read_b64_tr_b16 a[30:31], v7 offset:51552
s_add_u32 s54, s54, 0x20000
v_mfma_f32_16x16x32_bf16 v[36:39], a[52:55], v[88:91], v[36:39]
buffer_load_dwordx4 v[72:75], v4, s[16:19], s53 offen sc1
v_mfma_f32_16x16x32_bf16 v[52:55], a[52:55], v[92:95], v[52:55]
v_mfma_f32_16x16x32_bf16 v[40:43], a[56:59], v[88:91], v[40:43]
buffer_load_dwordx4 v[76:79], v4, s[16:19], s53 offen offset:1024 sc1
v_mfma_f32_16x16x32_bf16 v[56:59], a[56:59], v[92:95], v[56:59]
s_add_u32 s53, s53, 0x40000
v_mfma_f32_16x16x32_bf16 v[44:47], a[60:63], v[88:91], v[44:47]
v_mfma_f32_16x16x32_bf16 v[60:63], a[60:63], v[92:95], v[60:63]
s_waitcnt lgkmcnt(0)
s_barrier
s_waitcnt vmcnt(16)
v_mfma_f32_16x16x32_bf16 v[32:35], a[0:3], v[96:99], v[32:35]
ds_read_b64_tr_b16 a[32:33], v7 offset:58240
ds_read_b64_tr_b16 a[34:35], v7 offset:58752
s_add_u32 m0, s55, 49920
s_waitcnt vmcnt(15)
v_mfma_f32_16x16x32_bf16 v[48:51], a[0:3], v[100:103], v[48:51]
ds_read_b64_tr_b16 a[36:37], v7 offset:58272
buffer_load_dwordx4 v5, s[28:31], s54 offen lds
v_mfma_f32_16x16x32_bf16 v[36:39], a[4:7], v[96:99], v[36:39]
ds_read_b64_tr_b16 a[38:39], v7 offset:58784
ds_read_b64_tr_b16 a[40:41], v7 offset:58304
v_mfma_f32_16x16x32_bf16 v[52:55], a[4:7], v[100:103], v[52:55]
ds_read_b64_tr_b16 a[42:43], v7 offset:58816
buffer_load_dwordx4 v[80:83], v4, s[16:19], s52 offen sc1
v_mfma_f32_16x16x32_bf16 v[40:43], a[8:11], v[96:99], v[40:43]
ds_read_b64_tr_b16 a[44:45], v7 offset:58336
ds_read_b64_tr_b16 a[46:47], v7 offset:58848
v_mfma_f32_16x16x32_bf16 v[56:59], a[8:11], v[100:103], v[56:59]
ds_read_b64_tr_b16 a[48:49], v7 offset:59264
buffer_load_dwordx4 v[84:87], v4, s[16:19], s52 offen offset:1024 sc1
v_mfma_f32_16x16x32_bf16 v[44:47], a[12:15], v[96:99], v[44:47]
ds_read_b64_tr_b16 a[50:51], v7 offset:59776
ds_read_b64_tr_b16 a[52:53], v7 offset:59296
s_add_u32 s52, s52, 0x40000
v_mfma_f32_16x16x32_bf16 v[60:63], a[12:15], v[100:103], v[60:63]
ds_read_b64_tr_b16 a[54:55], v7 offset:59808
ds_read_b64_tr_b16 a[56:57], v7 offset:59328
s_waitcnt vmcnt(16)
v_mfma_f32_16x16x32_bf16 v[32:35], a[16:19], v[104:107], v[32:35]
ds_read_b64_tr_b16 a[58:59], v7 offset:59840
buffer_load_dwordx4 v6, s[28:31], s54 offen offset:1024 lds
s_waitcnt vmcnt(16)
v_mfma_f32_16x16x32_bf16 v[48:51], a[16:19], v[108:111], v[48:51]
ds_read_b64_tr_b16 a[60:61], v7 offset:59360
ds_read_b64_tr_b16 a[62:63], v7 offset:59872
s_add_u32 s54, s54, 0x20000
v_mfma_f32_16x16x32_bf16 v[36:39], a[20:23], v[104:107], v[36:39]
buffer_load_dwordx4 v[88:91], v4, s[16:19], s53 offen sc1
v_mfma_f32_16x16x32_bf16 v[52:55], a[20:23], v[108:111], v[52:55]
v_mfma_f32_16x16x32_bf16 v[40:43], a[24:27], v[104:107], v[40:43]
buffer_load_dwordx4 v[92:95], v4, s[16:19], s53 offen offset:1024 sc1
v_mfma_f32_16x16x32_bf16 v[56:59], a[24:27], v[108:111], v[56:59]
s_add_u32 s53, s53, 0x40000
v_mfma_f32_16x16x32_bf16 v[44:47], a[28:31], v[104:107], v[44:47]
v_mfma_f32_16x16x32_bf16 v[60:63], a[28:31], v[108:111], v[60:63]
s_waitcnt lgkmcnt(0)
s_barrier
s_xor_b32 s57, s57, 66560
v_add_u32 v7, s57, v8
s_waitcnt vmcnt(16)
v_mfma_f32_16x16x32_bf16 v[32:35], a[32:35], v[112:115], v[32:35]
ds_read_b64_tr_b16 a[0:1], v7
ds_read_b64_tr_b16 a[2:3], v7 offset:512
s_add_u32 m0, s55, 58240
s_waitcnt vmcnt(15)
v_mfma_f32_16x16x32_bf16 v[48:51], a[32:35], v[116:119], v[48:51]
ds_read_b64_tr_b16 a[4:5], v7 offset:32
buffer_load_dwordx4 v5, s[28:31], s54 offen lds
v_mfma_f32_16x16x32_bf16 v[36:39], a[36:39], v[112:115], v[36:39]
ds_read_b64_tr_b16 a[6:7], v7 offset:544
ds_read_b64_tr_b16 a[8:9], v7 offset:64
v_mfma_f32_16x16x32_bf16 v[52:55], a[36:39], v[116:119], v[52:55]
ds_read_b64_tr_b16 a[10:11], v7 offset:576
buffer_load_dwordx4 v[96:99], v4, s[16:19], s52 offen sc1
v_mfma_f32_16x16x32_bf16 v[40:43], a[40:43], v[112:115], v[40:43]
ds_read_b64_tr_b16 a[12:13], v7 offset:96
ds_read_b64_tr_b16 a[14:15], v7 offset:608
v_mfma_f32_16x16x32_bf16 v[56:59], a[40:43], v[116:119], v[56:59]
ds_read_b64_tr_b16 a[16:17], v7 offset:1024
buffer_load_dwordx4 v[100:103], v4, s[16:19], s52 offen offset:1024 sc1
v_mfma_f32_16x16x32_bf16 v[44:47], a[44:47], v[112:115], v[44:47]
ds_read_b64_tr_b16 a[18:19], v7 offset:1536
ds_read_b64_tr_b16 a[20:21], v7 offset:1056
s_add_u32 s52, s52, 0x40000
v_mfma_f32_16x16x32_bf16 v[60:63], a[44:47], v[116:119], v[60:63]
ds_read_b64_tr_b16 a[22:23], v7 offset:1568
ds_read_b64_tr_b16 a[24:25], v7 offset:1088
s_waitcnt vmcnt(16)
v_mfma_f32_16x16x32_bf16 v[32:35], a[48:51], v[120:123], v[32:35]
ds_read_b64_tr_b16 a[26:27], v7 offset:1600
buffer_load_dwordx4 v6, s[28:31], s54 offen offset:1024 lds
s_waitcnt vmcnt(16)
v_mfma_f32_16x16x32_bf16 v[48:51], a[48:51], v[124:127], v[48:51]
ds_read_b64_tr_b16 a[28:29], v7 offset:1120
ds_read_b64_tr_b16 a[30:31], v7 offset:1632
s_add_u32 s54, s54, 0x20000
v_mfma_f32_16x16x32_bf16 v[36:39], a[52:55], v[120:123], v[36:39]
buffer_load_dwordx4 v[104:107], v4, s[16:19], s53 offen sc1
v_mfma_f32_16x16x32_bf16 v[52:55], a[52:55], v[124:127], v[52:55]
v_mfma_f32_16x16x32_bf16 v[40:43], a[56:59], v[120:123], v[40:43]
buffer_load_dwordx4 v[108:111], v4, s[16:19], s53 offen offset:1024 sc1
v_mfma_f32_16x16x32_bf16 v[56:59], a[56:59], v[124:127], v[56:59]
s_add_u32 s53, s53, 0x40000
v_mfma_f32_16x16x32_bf16 v[44:47], a[60:63], v[120:123], v[44:47]
s_add_u32 s15, s15, 1
v_mfma_f32_16x16x32_bf16 v[60:63], a[60:63], v[124:127], v[60:63]
s_cbranch_scc0 .Lk37
s_waitcnt vmcnt(16) lgkmcnt(14)
v_mfma_f32_16x16x32_bf16 v[32:35], a[0:3], v[64:67], v[32:35]
ds_read_b64_tr_b16 a[32:33], v7 offset:8320
ds_read_b64_tr_b16 a[34:35], v7 offset:8832
s_waitcnt vmcnt(15)
v_mfma_f32_16x16x32_bf16 v[48:51], a[0:3], v[68:71], v[48:51]
buffer_load_dwordx4 v[112:115], v4, s[16:19], s52 offen sc1
s_waitcnt lgkmcnt(14)
v_mfma_f32_16x16x32_bf16 v[36:39], a[4:7], v[64:67], v[36:39]
ds_read_b64_tr_b16 a[36:37], v7 offset:8352
ds_read_b64_tr_b16 a[38:39], v7 offset:8864
v_mfma_f32_16x16x32_bf16 v[52:55], a[4:7], v[68:71], v[52:55]
ds_read_b64_tr_b16 a[40:41], v7 offset:8384
ds_read_b64_tr_b16 a[42:43], v7 offset:8896
s_waitcnt lgkmcnt(15)
v_mfma_f32_16x16x32_bf16 v[40:43], a[8:11], v[64:67], v[40:43]
buffer_load_dwordx4 v[116:119], v4, s[16:19], s52 offen offset:1024 sc1
v_mfma_f32_16x16x32_bf16 v[56:59], a[8:11], v[68:71], v[56:59]
ds_read_b64_tr_b16 a[44:45], v7 offset:8416
s_add_u32 s52, s52, 0x40000
s_waitcnt lgkmcnt(15)
v_mfma_f32_16x16x32_bf16 v[44:47], a[12:15], v[64:67], v[44:47]
ds_read_b64_tr_b16 a[46:47], v7 offset:8928
v_mfma_f32_16x16x32_bf16 v[60:63], a[12:15], v[68:71], v[60:63]
ds_read_b64_tr_b16 a[48:49], v7 offset:9344
ds_read_b64_tr_b16 a[50:51], v7 offset:9856
s_waitcnt vmcnt(15) lgkmcnt(15)
v_mfma_f32_16x16x32_bf16 v[32:35], a[16:19], v[72:75], v[32:35]
buffer_load_dwordx4 v[120:123], v4, s[16:19], s53 offen sc1
s_waitcnt vmcnt(15)
v_mfma_f32_16x16x32_bf16 v[48:51], a[16:19], v[76:79], v[48:51]
ds_read_b64_tr_b16 a[52:53], v7 offset:9376
ds_read_b64_tr_b16 a[54:55], v7 offset:9888
s_waitcnt lgkmcnt(15)
v_mfma_f32_16x16x32_bf16 v[36:39], a[20:23], v[72:75], v[36:39]
ds_read_b64_tr_b16 a[56:57], v7 offset:9408
ds_read_b64_tr_b16 a[58:59], v7 offset:9920
v_mfma_f32_16x16x32_bf16 v[52:55], a[20:23], v[76:79], v[52:55]
buffer_load_dwordx4 v[124:127], v4, s[16:19], s53 offen offset:1024 sc1
s_waitcnt lgkmcnt(15)
v_mfma_f32_16x16x32_bf16 v[40:43], a[24:27], v[72:75], v[40:43]
ds_read_b64_tr_b16 a[60:61], v7 offset:9440
s_add_u32 s53, s53, 0x40000
v_mfma_f32_16x16x32_bf16 v[56:59], a[24:27], v[76:79], v[56:59]
ds_read_b64_tr_b16 a[62:63], v7 offset:9952
s_waitcnt lgkmcnt(15)
v_mfma_f32_16x16x32_bf16 v[44:47], a[28:31], v[72:75], v[44:47]
v_mfma_f32_16x16x32_bf16 v[60:63], a[28:31], v[76:79], v[60:63]
s_waitcnt vmcnt(14) lgkmcnt(14)
v_mfma_f32_16x16x32_bf16 v[32:35], a[32:35], v[80:83], v[32:35]
ds_read_b64_tr_b16 a[0:1], v7 offset:16640
ds_read_b64_tr_b16 a[2:3], v7 offset:17152
s_waitcnt vmcnt(13)
v_mfma_f32_16x16x32_bf16 v[48:51], a[32:35], v[84:87], v[48:51]
buffer_load_dwordx4 v[64:67], v4, s[16:19], s52 offen sc1
s_waitcnt lgkmcnt(14)
v_mfma_f32_16x16x32_bf16 v[36:39], a[36:39], v[80:83], v[36:39]
ds_read_b64_tr_b16 a[4:5], v7 offset:16672
ds_read_b64_tr_b16 a[6:7], v7 offset:17184
v_mfma_f32_16x16x32_bf16 v[52:55], a[36:39], v[84:87], v[52:55]
ds_read_b64_tr_b16 a[8:9], v7 offset:16704
ds_read_b64_tr_b16 a[10:11], v7 offset:17216
s_waitcnt lgkmcnt(15)
v_mfma_f32_16x16x32_bf16 v[40:43], a[40:43], v[80:83], v[40:43]
buffer_load_dwordx4 v[68:71], v4, s[16:19], s52 offen offset:1024 sc1
v_mfma_f32_16x16x32_bf16 v[56:59], a[40:43], v[84:87], v[56:59]
ds_read_b64_tr_b16 a[12:13], v7 offset:16736
s_add_u32 s52, s52, 0x40000
s_waitcnt lgkmcnt(15)
v_mfma_f32_16x16x32_bf16 v[44:47], a[44:47], v[80:83], v[44:47]
ds_read_b64_tr_b16 a[14:15], v7 offset:17248
v_mfma_f32_16x16x32_bf16 v[60:63], a[44:47], v[84:87], v[60:63]
ds_read_b64_tr_b16 a[16:17], v7 offset:17664
ds_read_b64_tr_b16 a[18:19], v7 offset:18176
s_waitcnt vmcnt(13) lgkmcnt(15)
v_mfma_f32_16x16x32_bf16 v[32:35], a[48:51], v[88:91], v[32:35]
buffer_load_dwordx4 v[72:75], v4, s[16:19], s53 offen sc1
s_waitcnt vmcnt(13)
v_mfma_f32_16x16x32_bf16 v[48:51], a[48:51], v[92:95], v[48:51]
ds_read_b64_tr_b16 a[20:21], v7 offset:17696
ds_read_b64_tr_b16 a[22:23], v7 offset:18208
s_waitcnt lgkmcnt(15)
v_mfma_f32_16x16x32_bf16 v[36:39], a[52:55], v[88:91], v[36:39]
ds_read_b64_tr_b16 a[24:25], v7 offset:17728
ds_read_b64_tr_b16 a[26:27], v7 offset:18240
v_mfma_f32_16x16x32_bf16 v[52:55], a[52:55], v[92:95], v[52:55]
buffer_load_dwordx4 v[76:79], v4, s[16:19], s53 offen offset:1024 sc1
s_waitcnt lgkmcnt(15)
v_mfma_f32_16x16x32_bf16 v[40:43], a[56:59], v[88:91], v[40:43]
ds_read_b64_tr_b16 a[28:29], v7 offset:17760
s_add_u32 s53, s53, 0x40000
v_mfma_f32_16x16x32_bf16 v[56:59], a[56:59], v[92:95], v[56:59]
ds_read_b64_tr_b16 a[30:31], v7 offset:18272
s_waitcnt lgkmcnt(15)
v_mfma_f32_16x16x32_bf16 v[44:47], a[60:63], v[88:91], v[44:47]
v_mfma_f32_16x16x32_bf16 v[60:63], a[60:63], v[92:95], v[60:63]
s_waitcnt vmcnt(12) lgkmcnt(14)
v_mfma_f32_16x16x32_bf16 v[32:35], a[0:3], v[96:99], v[32:35]
ds_read_b64_tr_b16 a[32:33], v7 offset:24960
ds_read_b64_tr_b16 a[34:35], v7 offset:25472
s_waitcnt vmcnt(11)
v_mfma_f32_16x16x32_bf16 v[48:51], a[0:3], v[100:103], v[48:51]
buffer_load_dwordx4 v[80:83], v4, s[16:19], s52 offen sc1
s_waitcnt lgkmcnt(14)
v_mfma_f32_16x16x32_bf16 v[36:39], a[4:7], v[96:99], v[36:39]
ds_read_b64_tr_b16 a[36:37], v7 offset:24992
ds_read_b64_tr_b16 a[38:39], v7 offset:25504
v_mfma_f32_16x16x32_bf16 v[52:55], a[4:7], v[100:103], v[52:55]
ds_read_b64_tr_b16 a[40:41], v7 offset:25024
ds_read_b64_tr_b16 a[42:43], v7 offset:25536
s_waitcnt lgkmcnt(15)
v_mfma_f32_16x16x32_bf16 v[40:43], a[8:11], v[96:99], v[40:43]
buffer_load_dwordx4 v[84:87], v4, s[16:19], s52 offen offset:1024 sc1
v_mfma_f32_16x16x32_bf16 v[56:59], a[8:11], v[100:103], v[56:59]
ds_read_b64_tr_b16 a[44:45], v7 offset:25056
s_add_u32 s52, s52, 0x40000
s_waitcnt lgkmcnt(15)
v_mfma_f32_16x16x32_bf16 v[44:47], a[12:15], v[96:99], v[44:47]
ds_read_b64_tr_b16 a[46:47], v7 offset:25568
v_mfma_f32_16x16x32_bf16 v[60:63], a[12:15], v[100:103], v[60:63]
ds_read_b64_tr_b16 a[48:49], v7 offset:25984
ds_read_b64_tr_b16 a[50:51], v7 offset:26496
s_waitcnt vmcnt(11) lgkmcnt(15)
v_mfma_f32_16x16x32_bf16 v[32:35], a[16:19], v[104:107], v[32:35]
buffer_load_dwordx4 v[88:91], v4, s[16:19], s53 offen sc1
s_waitcnt vmcnt(11)
v_mfma_f32_16x16x32_bf16 v[48:51], a[16:19], v[108:111], v[48:51]
ds_read_b64_tr_b16 a[52:53], v7 offset:26016
ds_read_b64_tr_b16 a[54:55], v7 offset:26528
s_waitcnt lgkmcnt(15)
v_mfma_f32_16x16x32_bf16 v[36:39], a[20:23], v[104:107], v[36:39]
ds_read_b64_tr_b16 a[56:57], v7 offset:26048
ds_read_b64_tr_b16 a[58:59], v7 offset:26560
v_mfma_f32_16x16x32_bf16 v[52:55], a[20:23], v[108:111], v[52:55]
buffer_load_dwordx4 v[92:95], v4, s[16:19], s53 offen offset:1024 sc1
s_waitcnt lgkmcnt(15)
v_mfma_f32_16x16x32_bf16 v[40:43], a[24:27], v[104:107], v[40:43]
ds_read_b64_tr_b16 a[60:61], v7 offset:26080
s_add_u32 s53, s53, 0x40000
v_mfma_f32_16x16x32_bf16 v[56:59], a[24:27], v[108:111], v[56:59]
ds_read_b64_tr_b16 a[62:63], v7 offset:26592
s_waitcnt lgkmcnt(15)
v_mfma_f32_16x16x32_bf16 v[44:47], a[28:31], v[104:107], v[44:47]
v_mfma_f32_16x16x32_bf16 v[60:63], a[28:31], v[108:111], v[60:63]
s_waitcnt vmcnt(11) lgkmcnt(14)
v_mfma_f32_16x16x32_bf16 v[32:35], a[32:35], v[112:115], v[32:35]
ds_read_b64_tr_b16 a[0:1], v7 offset:33280
ds_read_b64_tr_b16 a[2:3], v7 offset:33792
s_waitcnt vmcnt(10)
v_mfma_f32_16x16x32_bf16 v[48:51], a[32:35], v[116:119], v[48:51]
buffer_load_dwordx4 v[96:99], v4, s[16:19], s52 offen sc1
s_waitcnt lgkmcnt(14)
v_mfma_f32_16x16x32_bf16 v[36:39], a[36:39], v[112:115], v[36:39]
ds_read_b64_tr_b16 a[4:5], v7 offset:33312
ds_read_b64_tr_b16 a[6:7], v7 offset:33824
v_mfma_f32_16x16x32_bf16 v[52:55], a[36:39], v[116:119], v[52:55]
ds_read_b64_tr_b16 a[8:9], v7 offset:33344
ds_read_b64_tr_b16 a[10:11], v7 offset:33856
s_waitcnt lgkmcnt(15)
v_mfma_f32_16x16x32_bf16 v[40:43], a[40:43], v[112:115], v[40:43]
buffer_load_dwordx4 v[100:103], v4, s[16:19], s52 offen offset:1024 sc1
v_mfma_f32_16x16x32_bf16 v[56:59], a[40:43], v[116:119], v[56:59]
ds_read_b64_tr_b16 a[12:13], v7 offset:33376
s_add_u32 s52, s52, 0x40000
s_waitcnt lgkmcnt(15)
v_mfma_f32_16x16x32_bf16 v[44:47], a[44:47], v[112:115], v[44:47]
ds_read_b64_tr_b16 a[14:15], v7 offset:33888
v_mfma_f32_16x16x32_bf16 v[60:63], a[44:47], v[116:119], v[60:63]
ds_read_b64_tr_b16 a[16:17], v7 offset:34304
ds_read_b64_tr_b16 a[18:19], v7 offset:34816
s_waitcnt vmcnt(11) lgkmcnt(15)
v_mfma_f32_16x16x32_bf16 v[32:35], a[48:51], v[120:123], v[32:35]
buffer_load_dwordx4 v[104:107], v4, s[16:19], s53 offen sc1
s_waitcnt vmcnt(11)
v_mfma_f32_16x16x32_bf16 v[48:51], a[48:51], v[124:127], v[48:51]
ds_read_b64_tr_b16 a[20:21], v7 offset:34336
ds_read_b64_tr_b16 a[22:23], v7 offset:34848
s_waitcnt lgkmcnt(15)
v_mfma_f32_16x16x32_bf16 v[36:39], a[52:55], v[120:123], v[36:39]
ds_read_b64_tr_b16 a[24:25], v7 offset:34368
ds_read_b64_tr_b16 a[26:27], v7 offset:34880
v_mfma_f32_16x16x32_bf16 v[52:55], a[52:55], v[124:127], v[52:55]
buffer_load_dwordx4 v[108:111], v4, s[16:19], s53 offen offset:1024 sc1
s_waitcnt lgkmcnt(15)
v_mfma_f32_16x16x32_bf16 v[40:43], a[56:59], v[120:123], v[40:43]
ds_read_b64_tr_b16 a[28:29], v7 offset:34400
s_add_u32 s53, s53, 0x40000
v_mfma_f32_16x16x32_bf16 v[56:59], a[56:59], v[124:127], v[56:59]
ds_read_b64_tr_b16 a[30:31], v7 offset:34912
s_waitcnt lgkmcnt(15)
v_mfma_f32_16x16x32_bf16 v[44:47], a[60:63], v[120:123], v[44:47]
v_mfma_f32_16x16x32_bf16 v[60:63], a[60:63], v[124:127], v[60:63]
s_waitcnt lgkmcnt(0)
s_barrier
s_waitcnt vmcnt(11)
v_mfma_f32_16x16x32_bf16 v[32:35], a[0:3], v[64:67], v[32:35]
ds_read_b64_tr_b16 a[32:33], v7 offset:41600
ds_read_b64_tr_b16 a[34:35], v7 offset:42112
s_waitcnt vmcnt(10)
v_mfma_f32_16x16x32_bf16 v[48:51], a[0:3], v[68:71], v[48:51]
ds_read_b64_tr_b16 a[36:37], v7 offset:41632
buffer_load_dwordx4 v[112:115], v4, s[16:19], s52 offen sc1
v_mfma_f32_16x16x32_bf16 v[36:39], a[4:7], v[64:67], v[36:39]
ds_read_b64_tr_b16 a[38:39], v7 offset:42144
ds_read_b64_tr_b16 a[40:41], v7 offset:41664
v_mfma_f32_16x16x32_bf16 v[52:55], a[4:7], v[68:71], v[52:55]
ds_read_b64_tr_b16 a[42:43], v7 offset:42176
v_mfma_f32_16x16x32_bf16 v[40:43], a[8:11], v[64:67], v[40:43]
ds_read_b64_tr_b16 a[44:45], v7 offset:41696
buffer_load_dwordx4 v[116:119], v4, s[16:19], s52 offen offset:1024 sc1
v_mfma_f32_16x16x32_bf16 v[56:59], a[8:11], v[68:71], v[56:59]
ds_read_b64_tr_b16 a[46:47], v7 offset:42208
ds_read_b64_tr_b16 a[48:49], v7 offset:42624
s_add_u32 s52, s52, 0x40000
v_mfma_f32_16x16x32_bf16 v[44:47], a[12:15], v[64:67], v[44:47]
ds_read_b64_tr_b16 a[50:51], v7 offset:43136
ds_read_b64_tr_b16 a[52:53], v7 offset:42656
v_mfma_f32_16x16x32_bf16 v[60:63], a[12:15], v[68:71], v[60:63]
ds_read_b64_tr_b16 a[54:55], v7 offset:43168
s_waitcnt vmcnt(11)
v_mfma_f32_16x16x32_bf16 v[32:35], a[16:19], v[72:75], v[32:35]
ds_read_b64_tr_b16 a[56:57], v7 offset:42688
buffer_load_dwordx4 v[120:123], v4, s[16:19], s53 offen sc1
s_waitcnt vmcnt(11)
v_mfma_f32_16x16x32_bf16 v[48:51], a[16:19], v[76:79], v[48:51]
ds_read_b64_tr_b16 a[58:59], v7 offset:43200
ds_read_b64_tr_b16 a[60:61], v7 offset:42720
v_mfma_f32_16x16x32_bf16 v[36:39], a[20:23], v[72:75], v[36:39]
ds_read_b64_tr_b16 a[62:63], v7 offset:43232
v_mfma_f32_16x16x32_bf16 v[52:55], a[20:23], v[76:79], v[52:55]
buffer_load_dwordx4 v[124:127], v4, s[16:19], s53 offen offset:1024 sc1
v_mfma_f32_16x16x32_bf16 v[40:43], a[24:27], v[72:75], v[40:43]
s_add_u32 s53, s53, 0x40000
v_mfma_f32_16x16x32_bf16 v[56:59], a[24:27], v[76:79], v[56:59]
v_mfma_f32_16x16x32_bf16 v[44:47], a[28:31], v[72:75], v[44:47]
v_mfma_f32_16x16x32_bf16 v[60:63], a[28:31], v[76:79], v[60:63]
s_waitcnt vmcnt(11) lgkmcnt(14)
v_mfma_f32_16x16x32_bf16 v[32:35], a[32:35], v[80:83], v[32:35]
ds_read_b64_tr_b16 a[0:1], v7 offset:49920
ds_read_b64_tr_b16 a[2:3], v7 offset:50432
s_waitcnt vmcnt(10)
v_mfma_f32_16x16x32_bf16 v[48:51], a[32:35], v[84:87], v[48:51]
buffer_load_dwordx4 v[64:67], v4, s[16:19], s52 offen sc1
s_waitcnt lgkmcnt(14)
v_mfma_f32_16x16x32_bf16 v[36:39], a[36:39], v[80:83], v[36:39]
ds_read_b64_tr_b16 a[4:5], v7 offset:49952
ds_read_b64_tr_b16 a[6:7], v7 offset:50464
v_mfma_f32_16x16x32_bf16 v[52:55], a[36:39], v[84:87], v[52:55]
ds_read_b64_tr_b16 a[8:9], v7 offset:49984
ds_read_b64_tr_b16 a[10:11], v7 offset:50496
s_waitcnt lgkmcnt(15)
v_mfma_f32_16x16x32_bf16 v[40:43], a[40:43], v[80:83], v[40:43]
buffer_load_dwordx4 v[68:71], v4, s[16:19], s52 offen offset:1024 sc1
v_mfma_f32_16x16x32_bf16 v[56:59], a[40:43], v[84:87], v[56:59]
ds_read_b64_tr_b16 a[12:13], v7 offset:50016
s_add_u32 s52, s52, 0x40000
s_waitcnt lgkmcnt(15)
v_mfma_f32_16x16x32_bf16 v[44:47], a[44:47], v[80:83], v[44:47]
ds_read_b64_tr_b16 a[14:15], v7 offset:50528
v_mfma_f32_16x16x32_bf16 v[60:63], a[44:47], v[84:87], v[60:63]
ds_read_b64_tr_b16 a[16:17], v7 offset:50944
ds_read_b64_tr_b16 a[18:19], v7 offset:51456
s_waitcnt vmcnt(11) lgkmcnt(15)
v_mfma_f32_16x16x32_bf16 v[32:35], a[48:51], v[88:91], v[32:35]
buffer_load_dwordx4 v[72:75], v4, s[16:19], s53 offen sc1
s_waitcnt vmcnt(11)
v_mfma_f32_16x16x32_bf16 v[48:51], a[48:51], v[92:95], v[48:51]
ds_read_b64_tr_b16 a[20:21], v7 offset:50976
ds_read_b64_tr_b16 a[22:23], v7 offset:51488
s_waitcnt lgkmcnt(15)
v_mfma_f32_16x16x32_bf16 v[36:39], a[52:55], v[88:91], v[36:39]
ds_read_b64_tr_b16 a[24:25], v7 offset:51008
ds_read_b64_tr_b16 a[26:27], v7 offset:51520
v_mfma_f32_16x16x32_bf16 v[52:55], a[52:55], v[92:95], v[52:55]
buffer_load_dwordx4 v[76:79], v4, s[16:19], s53 offen offset:1024 sc1
s_waitcnt lgkmcnt(15)
v_mfma_f32_16x16x32_bf16 v[40:43], a[56:59], v[88:91], v[40:43]
ds_read_b64_tr_b16 a[28:29], v7 offset:51040
s_add_u32 s53, s53, 0x40000
v_mfma_f32_16x16x32_bf16 v[56:59], a[56:59], v[92:95], v[56:59]
ds_read_b64_tr_b16 a[30:31], v7 offset:51552
s_waitcnt lgkmcnt(15)
v_mfma_f32_16x16x32_bf16 v[44:47], a[60:63], v[88:91], v[44:47]
v_mfma_f32_16x16x32_bf16 v[60:63], a[60:63], v[92:95], v[60:63]
s_waitcnt vmcnt(11) lgkmcnt(14)
v_mfma_f32_16x16x32_bf16 v[32:35], a[0:3], v[96:99], v[32:35]
ds_read_b64_tr_b16 a[32:33], v7 offset:58240
ds_read_b64_tr_b16 a[34:35], v7 offset:58752
s_waitcnt vmcnt(10)
v_mfma_f32_16x16x32_bf16 v[48:51], a[0:3], v[100:103], v[48:51]
buffer_load_dwordx4 v[80:83], v4, s[16:19], s52 offen sc1
s_waitcnt lgkmcnt(14)
v_mfma_f32_16x16x32_bf16 v[36:39], a[4:7], v[96:99], v[36:39]
ds_read_b64_tr_b16 a[36:37], v7 offset:58272
ds_read_b64_tr_b16 a[38:39], v7 offset:58784
v_mfma_f32_16x16x32_bf16 v[52:55], a[4:7], v[100:103], v[52:55]
ds_read_b64_tr_b16 a[40:41], v7 offset:58304
ds_read_b64_tr_b16 a[42:43], v7 offset:58816
s_waitcnt lgkmcnt(15)
v_mfma_f32_16x16x32_bf16 v[40:43], a[8:11], v[96:99], v[40:43]
buffer_load_dwordx4 v[84:87], v4, s[16:19], s52 offen offset:1024 sc1
v_mfma_f32_16x16x32_bf16 v[56:59], a[8:11], v[100:103], v[56:59]
ds_read_b64_tr_b16 a[44:45], v7 offset:58336
s_add_u32 s52, s52, 0x40000
s_waitcnt lgkmcnt(15)
v_mfma_f32_16x16x32_bf16 v[44:47], a[12:15], v[96:99], v[44:47]
ds_read_b64_tr_b16 a[46:47], v7 offset:58848
v_mfma_f32_16x16x32_bf16 v[60:63], a[12:15], v[100:103], v[60:63]
ds_read_b64_tr_b16 a[48:49], v7 offset:59264
ds_read_b64_tr_b16 a[50:51], v7 offset:59776
s_waitcnt vmcnt(11) lgkmcnt(15)
v_mfma_f32_16x16x32_bf16 v[32:35], a[16:19], v[104:107], v[32:35]
buffer_load_dwordx4 v[88:91], v4, s[16:19], s53 offen sc1
s_waitcnt vmcnt(11)
v_mfma_f32_16x16x32_bf16 v[48:51], a[16:19], v[108:111], v[48:51]
ds_read_b64_tr_b16 a[52:53], v7 offset:59296
ds_read_b64_tr_b16 a[54:55], v7 offset:59808
s_waitcnt lgkmcnt(15)
v_mfma_f32_16x16x32_bf16 v[36:39], a[20:23], v[104:107], v[36:39]
ds_read_b64_tr_b16 a[56:57], v7 offset:59328
ds_read_b64_tr_b16 a[58:59], v7 offset:59840
v_mfma_f32_16x16x32_bf16 v[52:55], a[20:23], v[108:111], v[52:55]
buffer_load_dwordx4 v[92:95], v4, s[16:19], s53 offen offset:1024 sc1
s_waitcnt lgkmcnt(15)
v_mfma_f32_16x16x32_bf16 v[40:43], a[24:27], v[104:107], v[40:43]
ds_read_b64_tr_b16 a[60:61], v7 offset:59360
s_add_u32 s53, s53, 0x40000
v_mfma_f32_16x16x32_bf16 v[56:59], a[24:27], v[108:111], v[56:59]
ds_read_b64_tr_b16 a[62:63], v7 offset:59872
s_waitcnt lgkmcnt(15)
v_mfma_f32_16x16x32_bf16 v[44:47], a[28:31], v[104:107], v[44:47]
v_mfma_f32_16x16x32_bf16 v[60:63], a[28:31], v[108:111], v[60:63]
s_xor_b32 s57, s57, 66560
v_add_u32 v7, s57, v8
s_waitcnt vmcnt(11) lgkmcnt(14)
v_mfma_f32_16x16x32_bf16 v[32:35], a[32:35], v[112:115], v[32:35]
ds_read_b64_tr_b16 a[0:1], v7
ds_read_b64_tr_b16 a[2:3], v7 offset:512
s_waitcnt vmcnt(10)
v_mfma_f32_16x16x32_bf16 v[48:51], a[32:35], v[116:119], v[48:51]
buffer_load_dwordx4 v[96:99], v4, s[16:19], s52 offen sc1
s_waitcnt lgkmcnt(14)
v_mfma_f32_16x16x32_bf16 v[36:39], a[36:39], v[112:115], v[36:39]
ds_read_b64_tr_b16 a[4:5], v7 offset:32
ds_read_b64_tr_b16 a[6:7], v7 offset:544
v_mfma_f32_16x16x32_bf16 v[52:55], a[36:39], v[116:119], v[52:55]
ds_read_b64_tr_b16 a[8:9], v7 offset:64
ds_read_b64_tr_b16 a[10:11], v7 offset:576
s_waitcnt lgkmcnt(15)
v_mfma_f32_16x16x32_bf16 v[40:43], a[40:43], v[112:115], v[40:43]
buffer_load_dwordx4 v[100:103], v4, s[16:19], s52 offen offset:1024 sc1
v_mfma_f32_16x16x32_bf16 v[56:59], a[40:43], v[116:119], v[56:59]
ds_read_b64_tr_b16 a[12:13], v7 offset:96
s_add_u32 s52, s52, 0x40000
s_waitcnt lgkmcnt(15)
v_mfma_f32_16x16x32_bf16 v[44:47], a[44:47], v[112:115], v[44:47]
ds_read_b64_tr_b16 a[14:15], v7 offset:608
v_mfma_f32_16x16x32_bf16 v[60:63], a[44:47], v[116:119], v[60:63]
ds_read_b64_tr_b16 a[16:17], v7 offset:1024
ds_read_b64_tr_b16 a[18:19], v7 offset:1536
s_waitcnt vmcnt(11) lgkmcnt(15)
v_mfma_f32_16x16x32_bf16 v[32:35], a[48:51], v[120:123], v[32:35]
buffer_load_dwordx4 v[104:107], v4, s[16:19], s53 offen sc1
s_waitcnt vmcnt(11)
v_mfma_f32_16x16x32_bf16 v[48:51], a[48:51], v[124:127], v[48:51]
ds_read_b64_tr_b16 a[20:21], v7 offset:1056
ds_read_b64_tr_b16 a[22:23], v7 offset:1568
s_waitcnt lgkmcnt(15)
v_mfma_f32_16x16x32_bf16 v[36:39], a[52:55], v[120:123], v[36:39]
ds_read_b64_tr_b16 a[24:25], v7 offset:1088
ds_read_b64_tr_b16 a[26:27], v7 offset:1600
v_mfma_f32_16x16x32_bf16 v[52:55], a[52:55], v[124:127], v[52:55]
buffer_load_dwordx4 v[108:111], v4, s[16:19], s53 offen offset:1024 sc1
s_waitcnt lgkmcnt(15)
v_mfma_f32_16x16x32_bf16 v[40:43], a[56:59], v[120:123], v[40:43]
ds_read_b64_tr_b16 a[28:29], v7 offset:1120
s_add_u32 s53, s53, 0x40000
v_mfma_f32_16x16x32_bf16 v[56:59], a[56:59], v[124:127], v[56:59]
ds_read_b64_tr_b16 a[30:31], v7 offset:1632
s_waitcnt lgkmcnt(15)
v_mfma_f32_16x16x32_bf16 v[44:47], a[60:63], v[120:123], v[44:47]
v_mfma_f32_16x16x32_bf16 v[60:63], a[60:63], v[124:127], v[60:63]
s_waitcnt vmcnt(11) lgkmcnt(14)
v_mfma_f32_16x16x32_bf16 v[32:35], a[0:3], v[64:67], v[32:35]
ds_read_b64_tr_b16 a[32:33], v7 offset:8320
ds_read_b64_tr_b16 a[34:35], v7 offset:8832
s_waitcnt vmcnt(10)
v_mfma_f32_16x16x32_bf16 v[48:51], a[0:3], v[68:71], v[48:51]
buffer_load_dwordx4 v[112:115], v4, s[16:19], s52 offen sc1
s_waitcnt lgkmcnt(14)
v_mfma_f32_16x16x32_bf16 v[36:39], a[4:7], v[64:67], v[36:39]
ds_read_b64_tr_b16 a[36:37], v7 offset:8352
ds_read_b64_tr_b16 a[38:39], v7 offset:8864
v_mfma_f32_16x16x32_bf16 v[52:55], a[4:7], v[68:71], v[52:55]
ds_read_b64_tr_b16 a[40:41], v7 offset:8384
ds_read_b64_tr_b16 a[42:43], v7 offset:8896
s_waitcnt lgkmcnt(15)
v_mfma_f32_16x16x32_bf16 v[40:43], a[8:11], v[64:67], v[40:43]
buffer_load_dwordx4 v[116:119], v4, s[16:19], s52 offen offset:1024 sc1
v_mfma_f32_16x16x32_bf16 v[56:59], a[8:11], v[68:71], v[56:59]
ds_read_b64_tr_b16 a[44:45], v7 offset:8416
s_add_u32 s52, s52, 0x40000
s_waitcnt lgkmcnt(15)
v_mfma_f32_16x16x32_bf16 v[44:47], a[12:15], v[64:67], v[44:47]
ds_read_b64_tr_b16 a[46:47], v7 offset:8928
v_mfma_f32_16x16x32_bf16 v[60:63], a[12:15], v[68:71], v[60:63]
ds_read_b64_tr_b16 a[48:49], v7 offset:9344
ds_read_b64_tr_b16 a[50:51], v7 offset:9856
s_waitcnt vmcnt(11) lgkmcnt(15)
v_mfma_f32_16x16x32_bf16 v[32:35], a[16:19], v[72:75], v[32:35]
buffer_load_dwordx4 v[120:123], v4, s[16:19], s53 offen sc1
s_waitcnt vmcnt(11)
v_mfma_f32_16x16x32_bf16 v[48:51], a[16:19], v[76:79], v[48:51]
ds_read_b64_tr_b16 a[52:53], v7 offset:9376
ds_read_b64_tr_b16 a[54:55], v7 offset:9888
s_waitcnt lgkmcnt(15)
v_mfma_f32_16x16x32_bf16 v[36:39], a[20:23], v[72:75], v[36:39]
ds_read_b64_tr_b16 a[56:57], v7 offset:9408
ds_read_b64_tr_b16 a[58:59], v7 offset:9920
v_mfma_f32_16x16x32_bf16 v[52:55], a[20:23], v[76:79], v[52:55]
buffer_load_dwordx4 v[124:127], v4, s[16:19], s53 offen offset:1024 sc1
s_waitcnt lgkmcnt(15)
v_mfma_f32_16x16x32_bf16 v[40:43], a[24:27], v[72:75], v[40:43]
ds_read_b64_tr_b16 a[60:61], v7 offset:9440
s_add_u32 s53, s53, 0x40000
v_mfma_f32_16x16x32_bf16 v[56:59], a[24:27], v[76:79], v[56:59]
ds_read_b64_tr_b16 a[62:63], v7 offset:9952
s_waitcnt lgkmcnt(15)
v_mfma_f32_16x16x32_bf16 v[44:47], a[28:31], v[72:75], v[44:47]
v_mfma_f32_16x16x32_bf16 v[60:63], a[28:31], v[76:79], v[60:63]
s_waitcnt vmcnt(11) lgkmcnt(14)
.Lpad17:
s_cbranch_execz .Lnopoll36r
v_mfma_f32_16x16x32_bf16 v[32:35], a[32:35], v[80:83], v[32:35]
ds_read_b64_tr_b16 a[0:1], v7 offset:16640
ds_read_b64_tr_b16 a[2:3], v7 offset:17152
s_waitcnt vmcnt(10)
v_mfma_f32_16x16x32_bf16 v[48:51], a[32:35], v[84:87], v[48:51]
buffer_load_dwordx4 v[64:67], v4, s[16:19], s52 offen sc1
s_waitcnt lgkmcnt(14)
v_mfma_f32_16x16x32_bf16 v[36:39], a[36:39], v[80:83], v[36:39]
ds_read_b64_tr_b16 a[4:5], v7 offset:16672
ds_read_b64_tr_b16 a[6:7], v7 offset:17184
v_mfma_f32_16x16x32_bf16 v[52:55], a[36:39], v[84:87], v[52:55]
ds_read_b64_tr_b16 a[8:9], v7 offset:16704
ds_read_b64_tr_b16 a[10:11], v7 offset:17216
s_waitcnt lgkmcnt(15)
v_mfma_f32_16x16x32_bf16 v[40:43], a[40:43], v[80:83], v[40:43]
buffer_load_dwordx4 v[68:71], v4, s[16:19], s52 offen offset:1024 sc1
v_mfma_f32_16x16x32_bf16 v[56:59], a[40:43], v[84:87], v[56:59]
ds_read_b64_tr_b16 a[12:13], v7 offset:16736
s_add_u32 s52, s52, 0x40000
s_waitcnt lgkmcnt(15)
v_mfma_f32_16x16x32_bf16 v[44:47], a[44:47], v[80:83], v[44:47]
ds_read_b64_tr_b16 a[14:15], v7 offset:17248
v_mfma_f32_16x16x32_bf16 v[60:63], a[44:47], v[84:87], v[60:63]
ds_read_b64_tr_b16 a[16:17], v7 offset:17664
ds_read_b64_tr_b16 a[18:19], v7 offset:18176
s_waitcnt vmcnt(11) lgkmcnt(15)
v_mfma_f32_16x16x32_bf16 v[32:35], a[48:51], v[88:91], v[32:35]
buffer_load_dwordx4 v[72:75], v4, s[16:19], s53 offen sc1
s_waitcnt vmcnt(11)
v_mfma_f32_16x16x32_bf16 v[48:51], a[48:51], v[92:95], v[48:51]
ds_read_b64_tr_b16 a[20:21], v7 offset:17696
ds_read_b64_tr_b16 a[22:23], v7 offset:18208
s_waitcnt lgkmcnt(15)
v_mfma_f32_16x16x32_bf16 v[36:39], a[52:55], v[88:91], v[36:39]
ds_read_b64_tr_b16 a[24:25], v7 offset:17728
ds_read_b64_tr_b16 a[26:27], v7 offset:18240
v_mfma_f32_16x16x32_bf16 v[52:55], a[52:55], v[92:95], v[52:55]
buffer_load_dwordx4 v[76:79], v4, s[16:19], s53 offen offset:1024 sc1
s_waitcnt lgkmcnt(15)
v_mfma_f32_16x16x32_bf16 v[40:43], a[56:59], v[88:91], v[40:43]
ds_read_b64_tr_b16 a[28:29], v7 offset:17760
s_add_u32 s53, s53, 0x40000
v_mfma_f32_16x16x32_bf16 v[56:59], a[56:59], v[92:95], v[56:59]
ds_read_b64_tr_b16 a[30:31], v7 offset:18272
s_waitcnt lgkmcnt(15)
v_mfma_f32_16x16x32_bf16 v[44:47], a[60:63], v[88:91], v[44:47]
v_mfma_f32_16x16x32_bf16 v[60:63], a[60:63], v[92:95], v[60:63]
s_waitcnt vmcnt(11) lgkmcnt(14)
v_mfma_f32_16x16x32_bf16 v[32:35], a[0:3], v[96:99], v[32:35]
ds_read_b64_tr_b16 a[32:33], v7 offset:24960
ds_read_b64_tr_b16 a[34:35], v7 offset:25472
s_waitcnt vmcnt(10)
v_mfma_f32_16x16x32_bf16 v[48:51], a[0:3], v[100:103], v[48:51]
buffer_load_dwordx4 v[80:83], v4, s[16:19], s52 offen sc1
s_waitcnt lgkmcnt(14)
v_mfma_f32_16x16x32_bf16 v[36:39], a[4:7], v[96:99], v[36:39]
ds_read_b64_tr_b16 a[36:37], v7 offset:24992
ds_read_b64_tr_b16 a[38:39], v7 offset:25504
v_mfma_f32_16x16x32_bf16 v[52:55], a[4:7], v[100:103], v[52:55]
ds_read_b64_tr_b16 a[40:41], v7 offset:25024
ds_read_b64_tr_b16 a[42:43], v7 offset:25536
s_waitcnt lgkmcnt(15)
v_mfma_f32_16x16x32_bf16 v[40:43], a[8:11], v[96:99], v[40:43]
buffer_load_dwordx4 v[84:87], v4, s[16:19], s52 offen offset:1024 sc1
v_mfma_f32_16x16x32_bf16 v[56:59], a[8:11], v[100:103], v[56:59]
ds_read_b64_tr_b16 a[44:45], v7 offset:25056
s_add_u32 s52, s52, 0x40000
s_waitcnt lgkmcnt(15)
v_mfma_f32_16x16x32_bf16 v[44:47], a[12:15], v[96:99], v[44:47]
ds_read_b64_tr_b16 a[46:47], v7 offset:25568
v_mfma_f32_16x16x32_bf16 v[60:63], a[12:15], v[100:103], v[60:63]
ds_read_b64_tr_b16 a[48:49], v7 offset:25984
ds_read_b64_tr_b16 a[50:51], v7 offset:26496
s_waitcnt vmcnt(11) lgkmcnt(15)
v_mfma_f32_16x16x32_bf16 v[32:35], a[16:19], v[104:107], v[32:35]
buffer_load_dwordx4 v[88:91], v4, s[16:19], s53 offen sc1
s_waitcnt vmcnt(11)
v_mfma_f32_16x16x32_bf16 v[48:51], a[16:19], v[108:111], v[48:51]
ds_read_b64_tr_b16 a[52:53], v7 offset:26016
ds_read_b64_tr_b16 a[54:55], v7 offset:26528
s_waitcnt lgkmcnt(15)
v_mfma_f32_16x16x32_bf16 v[36:39], a[20:23], v[104:107], v[36:39]
ds_read_b64_tr_b16 a[56:57], v7 offset:26048
ds_read_b64_tr_b16 a[58:59], v7 offset:26560
v_mfma_f32_16x16x32_bf16 v[52:55], a[20:23], v[108:111], v[52:55]
buffer_load_dwordx4 v[92:95], v4, s[16:19], s53 offen offset:1024 sc1
s_waitcnt lgkmcnt(15)
v_mfma_f32_16x16x32_bf16 v[40:43], a[24:27], v[104:107], v[40:43]
ds_read_b64_tr_b16 a[60:61], v7 offset:26080
s_add_u32 s53, s53, 0x40000
v_mfma_f32_16x16x32_bf16 v[56:59], a[24:27], v[108:111], v[56:59]
ds_read_b64_tr_b16 a[62:63], v7 offset:26592
s_waitcnt lgkmcnt(15)
v_mfma_f32_16x16x32_bf16 v[44:47], a[28:31], v[104:107], v[44:47]
v_mfma_f32_16x16x32_bf16 v[60:63], a[28:31], v[108:111], v[60:63]
s_waitcnt lgkmcnt(0)
s_barrier
s_waitcnt vmcnt(11)
v_mfma_f32_16x16x32_bf16 v[32:35], a[32:35], v[112:115], v[32:35]
ds_read_b64_tr_b16 a[0:1], v7 offset:33280
ds_read_b64_tr_b16 a[2:3], v7 offset:33792
ds_read_b64_tr_b16 a[4:5], v7 offset:33312
s_waitcnt vmcnt(10)
v_mfma_f32_16x16x32_bf16 v[48:51], a[32:35], v[116:119], v[48:51]
ds_read_b64_tr_b16 a[6:7], v7 offset:33824
buffer_load_dwordx4 v[96:99], v4, s[16:19], s52 offen sc1
v_mfma_f32_16x16x32_bf16 v[36:39], a[36:39], v[112:115], v[36:39]
ds_read_b64_tr_b16 a[8:9], v7 offset:33344
buffer_load_dwordx4 v[100:103], v4, s[16:19], s52 offen offset:1024 sc1
v_mfma_f32_16x16x32_bf16 v[52:55], a[36:39], v[116:119], v[52:55]
ds_read_b64_tr_b16 a[10:11], v7 offset:33856
s_add_u32 s52, s52, 0x40000
v_mfma_f32_16x16x32_bf16 v[40:43], a[40:43], v[112:115], v[40:43]
ds_read_b64_tr_b16 a[12:13], v7 offset:33376
buffer_load_dwordx4 v[104:107], v4, s[16:19], s53 offen sc1
v_mfma_f32_16x16x32_bf16 v[56:59], a[40:43], v[116:119], v[56:59]
ds_read_b64_tr_b16 a[14:15], v7 offset:33888
ds_read_b64_tr_b16 a[16:17], v7 offset:34304
ds_read_b64_tr_b16 a[18:19], v7 offset:34816
v_mfma_f32_16x16x32_bf16 v[44:47], a[44:47], v[112:115], v[44:47]
ds_read_b64_tr_b16 a[20:21], v7 offset:34336
buffer_load_dwordx4 v[108:111], v4, s[16:19], s53 offen offset:1024 sc1
v_mfma_f32_16x16x32_bf16 v[60:63], a[44:47], v[116:119], v[60:63]
ds_read_b64_tr_b16 a[22:23], v7 offset:34848
s_add_u32 s53, s53, 0x40000
s_add_u32 m0, s59, 66560
s_waitcnt vmcnt(13)
v_mfma_f32_16x16x32_bf16 v[32:35], a[48:51], v[120:123], v[32:35]
ds_read_b64_tr_b16 a[24:25], v7 offset:34368
buffer_load_dwordx4 v18, s[20:23], s58 offen lds
s_waitcnt vmcnt(13)
v_mfma_f32_16x16x32_bf16 v[48:51], a[48:51], v[124:127], v[48:51]
ds_read_b64_tr_b16 a[26:27], v7 offset:34880
buffer_load_dwordx4 v19, s[20:23], s58 offen offset:1024 lds
v_mfma_f32_16x16x32_bf16 v[36:39], a[52:55], v[120:123], v[36:39]
ds_read_b64_tr_b16 a[28:29], v7 offset:34400
ds_read_b64_tr_b16 a[30:31], v7 offset:34912
v_mfma_f32_16x16x32_bf16 v[52:55], a[52:55], v[124:127], v[52:55]
buffer_load_dwordx4 v20, s[20:23], s58 offen offset:2048 lds
v_mfma_f32_16x16x32_bf16 v[40:43], a[56:59], v[120:123], v[40:43]
s_add_u32 s58, s58, 196608
s_add_u32 m0, s59, 78976
v_mfma_f32_16x16x32_bf16 v[56:59], a[56:59], v[124:127], v[56:59]
buffer_load_dwordx4 v18, s[20:23], s58 offen lds
v_mfma_f32_16x16x32_bf16 v[44:47], a[60:63], v[120:123], v[44:47]
v_mfma_f32_16x16x32_bf16 v[60:63], a[60:63], v[124:127], v[60:63]
s_waitcnt vmcnt(15) lgkmcnt(14)
v_mfma_f32_16x16x32_bf16 v[32:35], a[0:3], v[64:67], v[32:35]
ds_read_b64_tr_b16 a[32:33], v7 offset:41600
ds_read_b64_tr_b16 a[34:35], v7 offset:42112
s_waitcnt vmcnt(14)
v_mfma_f32_16x16x32_bf16 v[48:51], a[0:3], v[68:71], v[48:51]
ds_read_b64_tr_b16 a[36:37], v7 offset:41632
buffer_load_dwordx4 v[112:115], v4, s[16:19], s52 offen sc1
s_waitcnt lgkmcnt(15)
v_mfma_f32_16x16x32_bf16 v[36:39], a[4:7], v[64:67], v[36:39]
ds_read_b64_tr_b16 a[38:39], v7 offset:42144
buffer_load_dwordx4 v[116:119], v4, s[16:19], s52 offen offset:1024 sc1
v_mfma_f32_16x16x32_bf16 v[52:55], a[4:7], v[68:71], v[52:55]
ds_read_b64_tr_b16 a[40:41], v7 offset:41664
ds_read_b64_tr_b16 a[42:43], v7 offset:42176
s_add_u32 s52, s52, 0x40000
s_waitcnt lgkmcnt(15)
v_mfma_f32_16x16x32_bf16 v[40:43], a[8:11], v[64:67], v[40:43]
buffer_load_dwordx4 v[120:123], v4, s[16:19], s53 offen sc1
v_mfma_f32_16x16x32_bf16 v[56:59], a[8:11], v[68:71], v[56:59]
ds_read_b64_tr_b16 a[44:45], v7 offset:41696
ds_read_b64_tr_b16 a[46:47], v7 offset:42208
s_waitcnt lgkmcnt(15)
v_mfma_f32_16x16x32_bf16 v[44:47], a[12:15], v[64:67], v[44:47]
ds_read_b64_tr_b16 a[48:49], v7 offset:42624
buffer_load_dwordx4 v[124:127], v4, s[16:19], s53 offen offset:1024 sc1
v_mfma_f32_16x16x32_bf16 v[60:63], a[12:15], v[68:71], v[60:63]
ds_read_b64_tr_b16 a[50:51], v7 offset:43136
ds_read_b64_tr_b16 a[52:53], v7 offset:42656
s_add_u32 s53, s53, 0x40000
s_waitcnt vmcnt(17) lgkmcnt(15)
v_mfma_f32_16x16x32_bf16 v[32:35], a[16:19], v[72:75], v[32:35]
buffer_load_dwordx4 v19, s[20:23], s58 offen offset:1024 lds
s_waitcnt vmcnt(17)
v_mfma_f32_16x16x32_bf16 v[48:51], a[16:19], v[76:79], v[48:51]
ds_read_b64_tr_b16 a[54:55], v7 offset:43168
buffer_load_dwordx4 v20, s[20:23], s58 offen offset:2048 lds
v_mfma_f32_16x16x32_bf16 v[36:39], a[20:23], v[72:75], v[36:39]
ds_read_b64_tr_b16 a[56:57], v7 offset:42688
s_add_u32 s58, s58, 196608
s_add_u32 m0, s59, 91392
v_mfma_f32_16x16x32_bf16 v[52:55], a[20:23], v[76:79], v[52:55]
ds_read_b64_tr_b16 a[58:59], v7 offset:43200
buffer_load_dwordx4 v18, s[20:23], s58 offen lds
s_waitcnt lgkmcnt(15)
v_mfma_f32_16x16x32_bf16 v[40:43], a[24:27], v[72:75], v[40:43]
ds_read_b64_tr_b16 a[60:61], v7 offset:42720
ds_read_b64_tr_b16 a[62:63], v7 offset:43232
v_mfma_f32_16x16x32_bf16 v[56:59], a[24:27], v[76:79], v[56:59]
buffer_load_dwordx4 v19, s[20:23], s58 offen offset:1024 lds
s_waitcnt lgkmcnt(15)
v_mfma_f32_16x16x32_bf16 v[44:47], a[28:31], v[72:75], v[44:47]
v_mfma_f32_16x16x32_bf16 v[60:63], a[28:31], v[76:79], v[60:63]
s_waitcnt vmcnt(19) lgkmcnt(14)
v_mfma_f32_16x16x32_bf16 v[32:35], a[32:35], v[80:83], v[32:35]
ds_read_b64_tr_b16 a[0:1], v7 offset:49920
ds_read_b64_tr_b16 a[2:3], v7 offset:50432
s_waitcnt vmcnt(18)
v_mfma_f32_16x16x32_bf16 v[48:51], a[32:35], v[84:87], v[48:51]
buffer_load_dwordx4 v20, s[20:23], s58 offen offset:2048 lds
s_waitcnt lgkmcnt(14)
v_mfma_f32_16x16x32_bf16 v[36:39], a[36:39], v[80:83], v[36:39]
ds_read_b64_tr_b16 a[4:5], v7 offset:49952
s_add_u32 s58, s58, 196608
v_mfma_f32_16x16x32_bf16 v[52:55], a[36:39], v[84:87], v[52:55]
ds_read_b64_tr_b16 a[6:7], v7 offset:50464
s_add_u32 m0, s59, 103808
s_waitcnt lgkmcnt(14)
v_mfma_f32_16x16x32_bf16 v[40:43], a[40:43], v[80:83], v[40:43]
buffer_load_dwordx4 v18, s[20:23], s58 offen lds
v_mfma_f32_16x16x32_bf16 v[56:59], a[40:43], v[84:87], v[56:59]
ds_read_b64_tr_b16 a[8:9], v7 offset:49984
ds_read_b64_tr_b16 a[10:11], v7 offset:50496
s_waitcnt lgkmcnt(14)
v_mfma_f32_16x16x32_bf16 v[44:47], a[44:47], v[80:83], v[44:47]
ds_read_b64_tr_b16 a[12:13], v7 offset:50016
ds_read_b64_tr_b16 a[14:15], v7 offset:50528
v_mfma_f32_16x16x32_bf16 v[60:63], a[44:47], v[84:87], v[60:63]
ds_read_b64_tr_b16 a[16:17], v7 offset:50944
ds_read_b64_tr_b16 a[18:19], v7 offset:51456
s_waitcnt vmcnt(19) lgkmcnt(15)
v_mfma_f32_16x16x32_bf16 v[32:35], a[48:51], v[88:91], v[32:35]
buffer_load_dwordx4 v19, s[20:23], s58 offen offset:1024 lds
s_waitcnt vmcnt(19)
v_mfma_f32_16x16x32_bf16 v[48:51], a[48:51], v[92:95], v[48:51]
ds_read_b64_tr_b16 a[20:21], v7 offset:50976
ds_read_b64_tr_b16 a[22:23], v7 offset:51488
s_waitcnt lgkmcnt(15)
v_mfma_f32_16x16x32_bf16 v[36:39], a[52:55], v[88:91], v[36:39]
ds_read_b64_tr_b16 a[24:25], v7 offset:51008
ds_read_b64_tr_b16 a[26:27], v7 offset:51520
v_mfma_f32_16x16x32_bf16 v[52:55], a[52:55], v[92:95], v[52:55]
buffer_load_dwordx4 v20, s[20:23], s58 offen offset:2048 lds
s_waitcnt lgkmcnt(15)
v_mfma_f32_16x16x32_bf16 v[40:43], a[56:59], v[88:91], v[40:43]
ds_read_b64_tr_b16 a[28:29], v7 offset:51040
s_add_u32 s58, s58, 196608
v_mfma_f32_16x16x32_bf16 v[56:59], a[56:59], v[92:95], v[56:59]
ds_read_b64_tr_b16 a[30:31], v7 offset:51552
s_waitcnt lgkmcnt(15)
v_mfma_f32_16x16x32_bf16 v[44:47], a[60:63], v[88:91], v[44:47]
v_mfma_f32_16x16x32_bf16 v[60:63], a[60:63], v[92:95], v[60:63]
s_waitcnt vmcnt(19) lgkmcnt(14)
v_mfma_f32_16x16x32_bf16 v[32:35], a[0:3], v[96:99], v[32:35]
ds_read_b64_tr_b16 a[32:33], v7 offset:58240
s_add_u32 m0, s59, 116224
s_waitcnt vmcnt(18)
v_mfma_f32_16x16x32_bf16 v[48:51], a[0:3], v[100:103], v[48:51]
buffer_load_dwordx4 v18, s[20:23], s58 offen lds
s_waitcnt lgkmcnt(13)
v_mfma_f32_16x16x32_bf16 v[36:39], a[4:7], v[96:99], v[36:39]
ds_read_b64_tr_b16 a[34:35], v7 offset:58752
ds_read_b64_tr_b16 a[36:37], v7 offset:58272
v_mfma_f32_16x16x32_bf16 v[52:55], a[4:7], v[100:103], v[52:55]
ds_read_b64_tr_b16 a[38:39], v7 offset:58784
s_waitcnt lgkmcnt(14)
v_mfma_f32_16x16x32_bf16 v[40:43], a[8:11], v[96:99], v[40:43]
ds_read_b64_tr_b16 a[40:41], v7 offset:58304
ds_read_b64_tr_b16 a[42:43], v7 offset:58816
v_mfma_f32_16x16x32_bf16 v[56:59], a[8:11], v[100:103], v[56:59]
buffer_load_dwordx4 v19, s[20:23], s58 offen offset:1024 lds
s_waitcnt lgkmcnt(14)
v_mfma_f32_16x16x32_bf16 v[44:47], a[12:15], v[96:99], v[44:47]
ds_read_b64_tr_b16 a[44:45], v7 offset:58336
ds_read_b64_tr_b16 a[46:47], v7 offset:58848
v_mfma_f32_16x16x32_bf16 v[60:63], a[12:15], v[100:103], v[60:63]
ds_read_b64_tr_b16 a[48:49], v7 offset:59264
s_waitcnt vmcnt(19) lgkmcnt(15)
v_mfma_f32_16x16x32_bf16 v[32:35], a[16:19], v[104:107], v[32:35]
ds_read_b64_tr_b16 a[50:51], v7 offset:59776
ds_read_b64_tr_b16 a[52:53], v7 offset:59296
s_waitcnt vmcnt(18)
v_mfma_f32_16x16x32_bf16 v[48:51], a[16:19], v[108:111], v[48:51]
ds_read_b64_tr_b16 a[54:55], v7 offset:59808
s_waitcnt lgkmcnt(15)
v_mfma_f32_16x16x32_bf16 v[36:39], a[20:23], v[104:107], v[36:39]
buffer_load_dwordx4 v20, s[20:23], s58 offen offset:2048 lds
v_mfma_f32_16x16x32_bf16 v[52:55], a[20:23], v[108:111], v[52:55]
ds_read_b64_tr_b16 a[56:57], v7 offset:59328
s_add_u32 s58, s58, 196608
s_waitcnt lgkmcnt(15)
v_mfma_f32_16x16x32_bf16 v[40:43], a[24:27], v[104:107], v[40:43]
ds_read_b64_tr_b16 a[58:59], v7 offset:59840
ds_read_b64_tr_b16 a[60:61], v7 offset:59360
v_mfma_f32_16x16x32_bf16 v[56:59], a[24:27], v[108:111], v[56:59]
ds_read_b64_tr_b16 a[62:63], v7 offset:59872
s_waitcnt lgkmcnt(15)
v_mfma_f32_16x16x32_bf16 v[44:47], a[28:31], v[104:107], v[44:47]
v_mfma_f32_16x16x32_bf16 v[60:63], a[28:31], v[108:111], v[60:63]
s_waitcnt vmcnt(14) lgkmcnt(14)
v_mfma_f32_16x16x32_bf16 v[32:35], a[32:35], v[112:115], v[32:35]
s_lshl_b32 s64, s6, 14
s_lshl_b32 s65, s49, 13
s_add_u32 s64, s64, s65
s_waitcnt vmcnt(13)
v_mfma_f32_16x16x32_bf16 v[48:51], a[32:35], v[116:119], v[48:51]
s_lshl_b32 s65, s7, 9
s_add_u32 s64, s64, s65
s_lshl_b32 s65, s48, 8
s_waitcnt lgkmcnt(12)
v_mfma_f32_16x16x32_bf16 v[36:39], a[36:39], v[112:115], v[36:39]
s_add_u32 s64, s64, s65
s_add_u32 s64, s64, 62914560
v_and_b32 v152, 31, v1
v_mfma_f32_16x16x32_bf16 v[52:55], a[36:39], v[116:119], v[52:55]
s_lshl_b32 s62, s7, 18
v_lshlrev_b32 v152, 3, v152
v_lshrrev_b32 v153, 5, v1
s_waitcnt lgkmcnt(10)
v_mfma_f32_16x16x32_bf16 v[40:43], a[40:43], v[112:115], v[40:43]
s_add_u32 s62, s62, 33554432
v_lshl_add_u32 v152, v153, 2, v152
s_add_u32 s63, s62, 0x20000
v_mfma_f32_16x16x32_bf16 v[56:59], a[40:43], v[116:119], v[56:59]
s_waitcnt lgkmcnt(8)
v_mfma_f32_16x16x32_bf16 v[44:47], a[44:47], v[112:115], v[44:47]
v_mfma_f32_16x16x32_bf16 v[60:63], a[44:47], v[116:119], v[60:63]
s_waitcnt vmcnt(12) lgkmcnt(6)
v_mfma_f32_16x16x32_bf16 v[32:35], a[48:51], v[120:123], v[32:35]
s_waitcnt vmcnt(11)
v_mfma_f32_16x16x32_bf16 v[48:51], a[48:51], v[124:127], v[48:51]
s_waitcnt lgkmcnt(4)
v_mfma_f32_16x16x32_bf16 v[36:39], a[52:55], v[120:123], v[36:39]
s_nop 3
v_cvt_pk_bf16_f32 v128, v32, v33
v_cvt_pk_bf16_f32 v129, v34, v35
v_mfma_f32_16x16x32_bf16 v[52:55], a[52:55], v[124:127], v[52:55]
v_cvt_pk_bf16_f32 v136, v48, v49
v_cvt_pk_bf16_f32 v137, v50, v51
s_waitcnt lgkmcnt(2)
v_mfma_f32_16x16x32_bf16 v[40:43], a[56:59], v[120:123], v[40:43]
v_cvt_pk_bf16_f32 v130, v36, v37
v_cvt_pk_bf16_f32 v131, v38, v39
v_mfma_f32_16x16x32_bf16 v[56:59], a[56:59], v[124:127], v[56:59]
buffer_store_dwordx4 v[128:131], v4, s[16:19], s62 offen sc1
s_waitcnt lgkmcnt(0)
v_mfma_f32_16x16x32_bf16 v[44:47], a[60:63], v[120:123], v[44:47]
s_nop 1
v_cvt_pk_bf16_f32 v132, v40, v41
v_cvt_pk_bf16_f32 v133, v42, v43
v_mfma_f32_16x16x32_bf16 v[60:63], a[60:63], v[124:127], v[60:63]
v_cvt_pk_bf16_f32 v138, v52, v53
v_cvt_pk_bf16_f32 v139, v54, v55
v_cvt_pk_bf16_f32 v140, v56, v57
v_cvt_pk_bf16_f32 v134, v44, v45
v_cvt_pk_bf16_f32 v135, v46, v47
v_cvt_pk_bf16_f32 v141, v58, v59
v_pk_mul_f32 v[146:147], v[32:33], v[32:33]
buffer_store_dwordx4 v[132:135], v4, s[16:19], s63 offen sc1
v_cvt_pk_bf16_f32 v142, v60, v61
v_cvt_pk_bf16_f32 v143, v62, v63
v_pk_mul_f32 v[150:151], v[48:49], v[48:49]
v_pk_fma_f32 v[146:147], v[34:35], v[34:35], v[146:147]
v_pk_add_f32 v[144:145], v[32:33], v[34:35]
v_pk_fma_f32 v[150:151], v[50:51], v[50:51], v[150:151]
v_pk_add_f32 v[148:149], v[48:49], v[50:51]
v_pk_fma_f32 v[146:147], v[36:37], v[36:37], v[146:147]
v_pk_add_f32 v[144:145], v[144:145], v[36:37]
v_pk_fma_f32 v[150:151], v[52:53], v[52:53], v[150:151]
v_pk_add_f32 v[148:149], v[148:149], v[52:53]
v_pk_fma_f32 v[146:147], v[38:39], v[38:39], v[146:147]
v_pk_add_f32 v[144:145], v[144:145], v[38:39]
buffer_store_dwordx4 v[136:139], v4, s[16:19], s62 offen offset:1024 sc1
v_pk_fma_f32 v[150:151], v[54:55], v[54:55], v[150:151]
v_pk_add_f32 v[148:149], v[148:149], v[54:55]
v_pk_fma_f32 v[146:147], v[40:41], v[40:41], v[146:147]
v_pk_add_f32 v[144:145], v[144:145], v[40:41]
v_pk_fma_f32 v[150:151], v[56:57], v[56:57], v[150:151]
v_pk_add_f32 v[148:149], v[148:149], v[56:57]
v_pk_fma_f32 v[146:147], v[42:43], v[42:43], v[146:147]
v_pk_add_f32 v[144:145], v[144:145], v[42:43]
v_pk_fma_f32 v[150:151], v[58:59], v[58:59], v[150:151]
v_pk_add_f32 v[148:149], v[148:149], v[58:59]
v_pk_fma_f32 v[146:147], v[44:45], v[44:45], v[146:147]
v_pk_add_f32 v[144:145], v[144:145], v[44:45]
v_pk_fma_f32 v[150:151], v[60:61], v[60:61], v[150:151]
buffer_store_dwordx4 v[140:143], v4, s[16:19], s63 offen offset:1024 sc1
v_pk_add_f32 v[148:149], v[148:149], v[60:61]
v_pk_fma_f32 v[146:147], v[46:47], v[46:47], v[146:147]
v_pk_add_f32 v[144:145], v[144:145], v[46:47]
v_pk_fma_f32 v[150:151], v[62:63], v[62:63], v[150:151]
v_pk_add_f32 v[148:149], v[148:149], v[62:63]
v_add_f32 v144, v144, v145
v_add_f32 v146, v146, v147
v_add_f32 v148, v148, v149
v_add_f32 v150, v150, v151
s_nop 0
v_permlane16_swap_b32 v144, v148
v_permlane16_swap_b32 v146, v150
v_add_f32 v144, v144, v148
v_add_f32 v146, v146, v150
s_nop 1
v_permlane32_swap_b32 v144, v146
v_add_f32 v144, v144, v146
buffer_store_dword v144, v152, s[16:19], s64 offen sc1
s_nop 1
v_accvgpr_write_b32 a224, v32
v_accvgpr_write_b32 a225, v33
v_accvgpr_write_b32 a226, v34
v_accvgpr_write_b32 a227, v35
v_accvgpr_write_b32 a228, v36
v_accvgpr_write_b32 a229, v37
v_accvgpr_write_b32 a230, v38
v_accvgpr_write_b32 a231, v39
v_accvgpr_write_b32 a232, v40
v_accvgpr_write_b32 a233, v41
v_accvgpr_write_b32 a234, v42
v_accvgpr_write_b32 a235, v43
v_accvgpr_write_b32 a236, v44
v_accvgpr_write_b32 a237, v45
v_accvgpr_write_b32 a238, v46
v_accvgpr_write_b32 a239, v47
v_accvgpr_write_b32 a240, v48
v_accvgpr_write_b32 a241, v49
v_accvgpr_write_b32 a242, v50
v_accvgpr_write_b32 a243, v51
v_accvgpr_write_b32 a244, v52
v_accvgpr_write_b32 a245, v53
v_accvgpr_write_b32 a246, v54
v_accvgpr_write_b32 a247, v55
v_accvgpr_write_b32 a248, v56
v_accvgpr_write_b32 a249, v57
v_accvgpr_write_b32 a250, v58
v_accvgpr_write_b32 a251, v59
v_accvgpr_write_b32 a252, v60
v_accvgpr_write_b32 a253, v61
v_accvgpr_write_b32 a254, v62
v_accvgpr_write_b32 a255, v63
s_lshl_b32 s62, s8, 13
s_lshl_b32 s63, s3, 11
s_add_u32 s62, s62, s63
v_lshl_add_u32 v21, v1, 4, s62
v_lshrrev_b32 v2, 3, v1
v_cmp_eq_u32 vcc, 3, v2
v_add_u32 v2, 67108480, v21
s_nop 0
v_cndmask_b32 v21, v21, v2, vcc
s_lshl_b32 s62, s50, 10
s_sub_u32 s62, s62, 2048
v_lshl_add_u32 v22, v0, 2, s62
v_lshrrev_b32 v2, 5, v0
v_cmp_eq_u32 vcc, 3, v2
v_add_u32 v2, 67108480, v22
s_nop 0
v_cndmask_b32 v22, v22, v2, vcc
s_mul_i32 s62, s48, 4608
v_lshl_add_u32 v23, v1, 4, s62
v_lshrrev_b32 v24, 4, v1
v_mul_u32_u24 v24, 2304, v24
v_and_b32 v2, 15, v1
v_lshl_add_u32 v24, v2, 4, v24
v_bfe_u32 v25, v1, 3, 2
v_mul_u32_u24 v25, 3104, v25
v_bfe_u32 v2, v1, 2, 1
v_lshl_add_u32 v25, v2, 7, v25
v_bfe_u32 v2, v1, 5, 1
v_lshl_add_u32 v25, v2, 8, v25
v_and_b32 v2, 3, v1
v_lshl_add_u32 v25, v2, 3, v25
s_lshl_b32 s62, s49, 6
s_add_u32 s62, s62, 66560
v_add_u32 v25, s62, v25
s_lshl_b32 s62, s8, 1
s_add_u32 s62, s62, s3
s_lshr_b32 s63, s50, 2
s_cmp_lt_u32 s3, 2
s_cselect_b32 s62, s62, s63
s_lshl_b32 s62, s62, 13
s_cmp_eq_u32 s3, 3
s_cselect_b32 s62, 268435456, s62
v_lshl_add_u32 v26, v1, 4, s62
s_lshr_b32 s63, s20, 7
s_sub_u32 s63, 3, s63
s_and_b32 s63, s63, 7
s_and_b32 s62, s9, 8
s_add_u32 s63, s63, s62
s_lshl_b32 s62, s5, 2
s_add_u32 s62, s62, s3
s_mul_i32 s62, s62, 12288
s_lshl_b32 s64, s63, 7
s_add_u32 s62, s62, s64
s_xor_b32 s63, s63, s9
s_cmp_lt_u32 s63, 4
s_cselect_b32 s62, s62, 16777216
v_lshrrev_b32 v14, 3, v1
v_min_u32 v14, 5, v14
v_lshl_add_u32 v14, v14, 11, s62
s_mov_b32 s44, 983040
buffer_load_dword v27, v14, s[20:23], s44 offen
s_mov_b32 s44, 2555904
s_mov_b32 s52, 33554432
s_mov_b32 s54, s58
s_mov_b32 s56, s59
s_mul_i32 s55, s3, 2304
s_mul_i32 s59, s3, 2080
v_bfe_u32 v5, v1, 3, 1
v_lshrrev_b32 v2, 4, v1
v_lshl_add_u32 v5, v2, 3, v5
s_lshl_b32 s62, s3, 1
v_add_u32 v5, s62, v5
v_mul_u32_u24 v5, 2048, v5
v_and_b32 v2, 7, v1
v_lshl_add_u32 v5, v2, 4, v5
s_lshl_b32 s62, s7, 7
v_add_u32 v5, s62, v5
v_add_u32 v6, 64512, v5
s_lshl_b32 s62, s6, 7
s_add_u32 s62, s62, 30416896
s_lshl_b32 s64, s8, 7
s_add_u32 s64, s64, 30416896
s_lshr_b32 s65, s50, 3
s_lshl_b32 s65, s65, 7
s_add_u32 s65, s65, 30416896
v_mov_b32 v252, s62
v_mov_b32 v253, s64
v_writelane_b32 v253, s65, 1
s_waitcnt vmcnt(0) lgkmcnt(0)
s_barrier
s_cmp_lg_u32 s3, 0
s_cbranch_scc1 .Lnosig38
v_mov_b32 v255, 1
s_mov_b64 exec, 1
buffer_atomic_add v255, v252, s[16:19], 0 offen
s_mov_b64 exec, -1
.Lnosig38:
ds_read_b64_tr_b16 a[20:21], v25
ds_read_b64_tr_b16 a[22:23], v25 offset:512
ds_read_b64_tr_b16 a[24:25], v25 offset:32
ds_read_b64_tr_b16 a[26:27], v25 offset:544
ds_read_b64_tr_b16 a[28:29], v25 offset:1024
ds_read_b64_tr_b16 a[30:31], v25 offset:1536
ds_read_b64_tr_b16 a[32:33], v25 offset:1056
ds_read_b64_tr_b16 a[34:35], v25 offset:1568
ds_read_b64_tr_b16 a[36:37], v25 offset:2048
ds_read_b64_tr_b16 a[38:39], v25 offset:2560
ds_read_b64_tr_b16 a[40:41], v25 offset:2080
ds_read_b64_tr_b16 a[42:43], v25 offset:2592
v_lshrrev_b32 v2, 4, v1
v_lshlrev_b32 v2, 2, v2
v_and_b32 v13, 15, v1
v_sub_u32 v2, v13, v2
v_mov_b32 v13, 0xff61b1e6
v_subrev_u32 v54, 0, v2
v_cmp_gt_u32 vcc, 8, v54
s_nop 1
v_cndmask_b32 v50, v13, 0, vcc
v_cmp_gt_i32 vcc, -8, v54
s_nop 1
v_cndmask_b32 v46, v13, 0, vcc
v_subrev_u32 v54, 1, v2
v_cmp_gt_u32 vcc, 8, v54
s_nop 1
v_cndmask_b32 v51, v13, 0, vcc
v_cmp_gt_i32 vcc, -8, v54
s_nop 1
v_cndmask_b32 v47, v13, 0, vcc
v_subrev_u32 v54, 2, v2
v_cmp_gt_u32 vcc, 8, v54
s_nop 1
v_cndmask_b32 v52, v13, 0, vcc
v_cmp_gt_i32 vcc, -8, v54
s_nop 1
v_cndmask_b32 v48, v13, 0, vcc
v_subrev_u32 v54, 3, v2
v_cmp_gt_u32 vcc, 8, v54
s_nop 1
v_cndmask_b32 v53, v13, 0, vcc
v_cmp_gt_i32 vcc, -8, v54
s_nop 1
v_cndmask_b32 v49, v13, 0, vcc
s_cmp_lt_u32 s8, 2
s_cselect_b64 vcc, -1, 0
v_cndmask_b32 v54, v46, v13, vcc
v_cndmask_b32 v55, v47, v13, vcc
v_cndmask_b32 v56, v48, v13, vcc
v_cndmask_b32 v57, v49, v13, vcc
v_mov_b64 v[60:61], 0
v_mov_b64 v[62:63], 0
v_mov_b64 v[64:65], 0
v_mov_b64 v[66:67], 0
v_mov_b64 v[68:69], 0
v_mov_b64 v[70:71], 0
v_mov_b64 v[72:73], 0
v_mov_b64 v[74:75], 0
v_mov_b64 v[76:77], 0
v_mov_b64 v[78:79], 0
v_mov_b64 v[80:81], 0
v_mov_b64 v[82:83], 0
v_mov_b64 v[84:85], 0
v_mov_b64 v[86:87], 0
v_mov_b64 v[88:89], 0
v_mov_b64 v[90:91], 0
v_mov_b64 v[92:93], 0
v_mov_b64 v[94:95], 0
v_mov_b64 v[96:97], 0
v_mov_b64 v[98:99], 0
v_mov_b64 v[100:101], 0
v_mov_b64 v[102:103], 0
v_mov_b64 v[104:105], 0
v_mov_b64 v[106:107], 0
v_mov_b64 v[108:109], 0
v_mov_b64 v[110:111], 0
v_mov_b64 v[112:113], 0
v_mov_b64 v[114:115], 0
v_mov_b64 v[116:117], 0
v_mov_b64 v[118:119], 0
v_mov_b64 v[120:121], 0
v_mov_b64 v[122:123], 0
v_mov_b64 v[124:125], 0
v_mov_b64 v[126:127], 0
v_mov_b64 v[128:129], 0
v_mov_b64 v[130:131], 0
v_mov_b64 v[132:133], 0
v_mov_b64 v[134:135], 0
v_mov_b64 v[136:137], 0
.Lpad18:
s_cbranch_execz .Lnopoll36r
v_mov_b64 v[138:139], 0
v_mov_b64 v[140:141], 0
v_mov_b64 v[142:143], 0
v_mov_b64 v[144:145], 0
v_mov_b64 v[146:147], 0
v_mov_b64 v[148:149], 0
v_mov_b64 v[150:151], 0
v_mov_b64 v[152:153], 0
v_mov_b64 v[154:155], 0
v_mov_b64 v[156:157], 0
v_mov_b64 v[158:159], 0
v_mov_b64 v[160:161], 0
v_mov_b64 v[162:163], 0
v_mov_b64 v[164:165], 0
v_mov_b64 v[166:167], 0
v_mov_b64 v[168:169], 0
v_mov_b64 v[170:171], 0
v_mov_b64 v[172:173], 0
v_mov_b64 v[174:175], 0
s_mov_b32 s75, 62914560
v_and_b32 v10, 15, v1
v_lshlrev_b32 v12, 2, v10
v_lshlrev_b32 v10, 4, v10
v_add_u32 v10, 151552, v10
v_lshrrev_b32 v11, 4, v1
v_lshlrev_b32 v11, 4, v11
s_lshl_b32 s62, s49, 7
s_add_u32 s62, s62, 157696
v_add_u32 v12, s62, v12
v_add_u32 v13, s62, v11
v_add_u32 v11, 155648, v11
s_lshl_b32 s62, s3, 11
s_add_u32 s62, s62, 143360
v_lshl_add_u32 v8, v1, 4, s62
v_xor_b32 v9, 2048, v8
v_mov_b32 v248, 0x3f803f80
v_mov_b32 v249, 0x3f803f80
v_mov_b32 v250, 0x3f803f80
v_mov_b32 v251, 0x3f803f80
v_and_b32 v7, 31, v1
v_lshrrev_b32 v2, 5, v1
v_lshl_add_u32 v7, v7, 1, v2
v_and_b32 v2, 0xc0, v0
v_add_u32 v7, v7, v2
v_lshlrev_b32 v17, 2, v7
v_add_u32 v17, 155648, v17
v_lshlrev_b32 v7, 4, v7
v_add_u32 v7, 151552, v7
s_lshl_b32 s74, s9, 1
s_add_u32 s74, s74, s49
s_lshl_b32 s74, s74, 17
s_lshl_b32 s63, s8, 13
s_add_u32 s74, s74, s63
s_lshl_b32 s63, s48, 12
s_add_u32 s74, s74, s63
s_add_u32 s74, s74, 37748736
s_mov_b32 s62, 0
v_lshl_add_u32 v4, v1, 4, s62
v_lshrrev_b32 v2, 3, v1
v_cmp_eq_u32 vcc, 3, v2
v_add_u32 v2, 67108480, v4
s_nop 0
v_cndmask_b32 v4, v4, v2, vcc
ds_read_b128 v[28:31], v13
ds_read_b128 v[32:35], v13 offset:64
ds_read_b128 v[36:39], v13 offset:256
ds_read_b128 v[40:43], v13 offset:320
ds_read_b32 v44, v12 offset:512
ds_read_b32 v45, v12 offset:576
s_waitcnt lgkmcnt(0)
s_cmp_lg_u32 s3, 1
s_cbranch_scc1 .Lnopoll41
s_mov_b64 exec, 3
s_mov_b32 s15, 0
.Lpoll39:
buffer_load_dword v255, v253, s[16:19], 0 offen sc1
s_add_u32 s15, s15, 1
s_cmp_gt_u32 s15, 100000
s_cbranch_scc1 .Lgot40
s_waitcnt vmcnt(0)
v_cmp_ne_u32 vcc, 16, v255
s_nop 0
s_cbranch_vccnz .Lpoll39
.Lgot40:
s_waitcnt vmcnt(0)
s_branch .Lnopoll41r
.Lnopoll41:
s_mov_b64 exec, 0
s_cmp_eq_u32 s3, 2
s_cbranch_scc1 .Lpad19
s_cmp_eq_u32 s3, 3
s_cbranch_scc1 .Lpad20
s_branch .Lpad21
.Lnopoll41r:
s_mov_b64 exec, -1
s_barrier
s_cmp_eq_u32 s48, 1
s_cbranch_scc1 .Lqkv42
s_add_u32 m0, s55, 0
s_nop 0
buffer_load_dwordx4 v21, s[16:19], s52 offen sc1 lds
buffer_load_dwordx4 v21, s[16:19], s52 offen offset:1024 sc1 lds
buffer_load_dword v22, s[16:19], s52 offen offset:2048 sc1 lds
s_add_u32 s52, s52, 0x20000
s_add_u32 m0, s55, 9216
s_nop 0
buffer_load_dwordx4 v21, s[16:19], s52 offen sc1 lds
buffer_load_dwordx4 v21, s[16:19], s52 offen offset:1024 sc1 lds
buffer_load_dword v22, s[16:19], s52 offen offset:2048 sc1 lds
s_add_u32 s52, s52, 0x20000
s_add_u32 m0, s55, 18432
s_nop 0
buffer_load_dwordx4 v21, s[16:19], s52 offen sc1 lds
buffer_load_dwordx4 v21, s[16:19], s52 offen offset:1024 sc1 lds
buffer_load_dword v22, s[16:19], s52 offen offset:2048 sc1 lds
s_add_u32 s52, s52, 0x20000
s_add_u32 m0, s55, 27648
s_nop 0
buffer_load_dwordx4 v21, s[16:19], s52 offen sc1 lds
buffer_load_dwordx4 v21, s[16:19], s52 offen offset:1024 sc1 lds
buffer_load_dword v22, s[16:19], s52 offen offset:2048 sc1 lds
s_add_u32 s52, s52, 0x20000
s_add_u32 m0, s55, 36864
s_nop 0
buffer_load_dwordx4 v21, s[16:19], s52 offen sc1 lds
buffer_load_dwordx4 v21, s[16:19], s52 offen offset:1024 sc1 lds
buffer_load_dword v22, s[16:19], s52 offen offset:2048 sc1 lds
s_add_u32 s52, s52, 0x20000
s_waitcnt vmcnt(12)
s_barrier
ds_read_b128 a[0:3], v23
ds_read_b128 a[4:7], v23 offset:1024
ds_read_b128 a[8:11], v23 offset:2304
ds_read_b128 a[12:15], v23 offset:3328
ds_read_b128 a[16:19], v24 offset:2048
s_waitcnt lgkmcnt(0)
s_mov_b32 s15, -4
.p2align 6
.Lk44:
s_waitcnt vmcnt(9) lgkmcnt(6)
s_barrier
v_mfma_f32_16x16x32_bf16 v[60:63], a[20:23], a[0:3], v[60:63]
ds_read_b128 a[44:47], v23 offset:9216
s_add_u32 m0, s56, 128640
v_mfma_f32_16x16x32_bf16 v[64:67], a[20:23], a[4:7], v[64:67]
buffer_load_dwordx4 v18, s[20:23], s54 offen lds
v_mfma_f32_16x16x32_bf16 v[68:71], a[20:23], a[8:11], v[68:71]
ds_read_b128 a[48:51], v23 offset:10240
v_add_f32 v164, v164, v168
v_mfma_f32_16x16x32_bf16 v[72:75], a[20:23], a[12:15], v[72:75]
ds_read_b128 a[52:55], v23 offset:11520
v_mfma_f32_16x16x32_bf16 v[76:79], a[24:27], a[0:3], v[76:79]
buffer_load_dwordx4 v19, s[20:23], s54 offen offset:1024 lds
v_mfma_f32_16x16x32_bf16 v[80:83], a[24:27], a[4:7], v[80:83]
ds_read_b128 a[56:59], v23 offset:12544
v_mfma_f32_16x16x32_bf16 v[84:87], a[24:27], a[8:11], v[84:87]
ds_read_b64_tr_b16 a[64:65], v25 offset:12416
v_add_f32 v165, v165, v169
v_mfma_f32_16x16x32_bf16 v[88:91], a[24:27], a[12:15], v[88:91]
buffer_load_dwordx4 v20, s[20:23], s54 offen offset:2048 lds
v_mfma_f32_16x16x32_bf16 v[92:95], a[28:31], a[0:3], v[92:95]
ds_read_b64_tr_b16 a[66:67], v25 offset:12928
s_add_u32 s54, s54, 196608
v_mfma_f32_16x16x32_bf16 v[96:99], a[28:31], a[4:7], v[96:99]
ds_read_b64_tr_b16 a[68:69], v25 offset:12448
v_mfma_f32_16x16x32_bf16 v[100:103], a[28:31], a[8:11], v[100:103]
s_add_u32 m0, s55, 46080
s_waitcnt lgkmcnt(7)
v_mfma_f32_16x16x32_bf16 v[104:107], a[28:31], a[12:15], v[104:107]
buffer_load_dwordx4 v21, s[16:19], s52 offen sc1 lds
v_mfma_f32_16x16x32_bf16 v[156:159], a[28:31], a[16:19], v[156:159]
ds_read_b64_tr_b16 a[70:71], v25 offset:12960
v_mfma_f32_16x16x32_bf16 v[108:111], a[32:35], a[0:3], v[108:111]
ds_read_b128 a[60:63], v24 offset:11264
v_add_f32 v166, v166, v170
v_mfma_f32_16x16x32_bf16 v[112:115], a[32:35], a[4:7], v[112:115]
buffer_load_dwordx4 v21, s[16:19], s52 offen offset:1024 sc1 lds
v_mfma_f32_16x16x32_bf16 v[116:119], a[32:35], a[8:11], v[116:119]
ds_read_b64_tr_b16 a[72:73], v25 offset:13440
v_mfma_f32_16x16x32_bf16 v[120:123], a[32:35], a[12:15], v[120:123]
ds_read_b64_tr_b16 a[74:75], v25 offset:13952
v_mfma_f32_16x16x32_bf16 v[160:163], a[32:35], a[16:19], v[160:163]
ds_read_b64_tr_b16 a[76:77], v25 offset:13472
v_add_f32 v167, v167, v171
v_mfma_f32_16x16x32_bf16 v[124:127], a[0:3], a[36:39], v[124:127]
buffer_load_dword v22, s[16:19], s52 offen offset:2048 sc1 lds
v_mfma_f32_16x16x32_bf16 v[128:131], a[4:7], a[36:39], v[128:131]
ds_read_b64_tr_b16 a[78:79], v25 offset:13984
s_add_u32 s52, s52, 0x20000
v_mfma_f32_16x16x32_bf16 v[132:135], a[8:11], a[36:39], v[132:135]
ds_read_b64_tr_b16 a[80:81], v25 offset:14464
v_mfma_f32_16x16x32_bf16 v[136:139], a[12:15], a[36:39], v[136:139]
buffer_load_dword v27, v14, s[20:23], s44 offen
v_mfma_f32_16x16x32_bf16 v[140:143], a[0:3], a[40:43], v[140:143]
ds_read_b64_tr_b16 a[82:83], v25 offset:14976
s_add_u32 s44, s44, 1572864
v_mfma_f32_16x16x32_bf16 v[144:147], a[4:7], a[40:43], v[144:147]
ds_read_b64_tr_b16 a[84:85], v25 offset:14496
v_mfma_f32_16x16x32_bf16 v[148:151], a[8:11], a[40:43], v[148:151]
ds_read_b64_tr_b16 a[86:87], v25 offset:15008
v_mfma_f32_16x16x32_bf16 v[152:155], a[12:15], a[40:43], v[152:155]
s_waitcnt vmcnt(13) lgkmcnt(6)
s_barrier
v_mfma_f32_16x16x32_bf16 v[60:63], a[64:67], a[44:47], v[60:63]
ds_read_b128 a[0:3], v23 offset:18432
s_add_u32 m0, s56, 66560
v_mfma_f32_16x16x32_bf16 v[64:67], a[64:67], a[48:51], v[64:67]
buffer_load_dwordx4 v18, s[20:23], s54 offen lds
v_mfma_f32_16x16x32_bf16 v[68:71], a[64:67], a[52:55], v[68:71]
ds_read_b128 a[4:7], v23 offset:19456
v_mfma_f32_16x16x32_bf16 v[72:75], a[64:67], a[56:59], v[72:75]
ds_read_b128 a[8:11], v23 offset:20736
v_mfma_f32_16x16x32_bf16 v[76:79], a[68:71], a[44:47], v[76:79]
buffer_load_dwordx4 v19, s[20:23], s54 offen offset:1024 lds
v_mfma_f32_16x16x32_bf16 v[80:83], a[68:71], a[48:51], v[80:83]
ds_read_b128 a[12:15], v23 offset:21760
v_mfma_f32_16x16x32_bf16 v[84:87], a[68:71], a[52:55], v[84:87]
ds_read_b64_tr_b16 a[20:21], v25 offset:24832
v_mfma_f32_16x16x32_bf16 v[88:91], a[68:71], a[56:59], v[88:91]
buffer_load_dwordx4 v20, s[20:23], s54 offen offset:2048 lds
v_mfma_f32_16x16x32_bf16 v[92:95], a[72:75], a[44:47], v[92:95]
ds_read_b64_tr_b16 a[22:23], v25 offset:25344
s_add_u32 s54, s54, 196608
v_mfma_f32_16x16x32_bf16 v[96:99], a[72:75], a[48:51], v[96:99]
ds_read_b64_tr_b16 a[24:25], v25 offset:24864
v_mfma_f32_16x16x32_bf16 v[100:103], a[72:75], a[52:55], v[100:103]
s_add_u32 m0, s55, 0
s_waitcnt lgkmcnt(7)
v_mfma_f32_16x16x32_bf16 v[104:107], a[72:75], a[56:59], v[104:107]
buffer_load_dwordx4 v21, s[16:19], s52 offen sc1 lds
v_mfma_f32_16x16x32_bf16 v[156:159], a[72:75], a[60:63], v[156:159]
ds_read_b64_tr_b16 a[26:27], v25 offset:25376
v_mfma_f32_16x16x32_bf16 v[108:111], a[76:79], a[44:47], v[108:111]
ds_read_b128 a[16:19], v24 offset:20480
v_mfma_f32_16x16x32_bf16 v[112:115], a[76:79], a[48:51], v[112:115]
buffer_load_dwordx4 v21, s[16:19], s52 offen offset:1024 sc1 lds
v_mfma_f32_16x16x32_bf16 v[116:119], a[76:79], a[52:55], v[116:119]
ds_read_b64_tr_b16 a[28:29], v25 offset:25856
v_mfma_f32_16x16x32_bf16 v[120:123], a[76:79], a[56:59], v[120:123]
ds_read_b64_tr_b16 a[30:31], v25 offset:26368
v_mfma_f32_16x16x32_bf16 v[160:163], a[76:79], a[60:63], v[160:163]
ds_read_b64_tr_b16 a[32:33], v25 offset:25888
v_mfma_f32_16x16x32_bf16 v[124:127], a[44:47], a[80:83], v[124:127]
buffer_load_dword v22, s[16:19], s52 offen offset:2048 sc1 lds
v_mfma_f32_16x16x32_bf16 v[128:131], a[48:51], a[80:83], v[128:131]
ds_read_b64_tr_b16 a[34:35], v25 offset:26400
s_add_u32 s52, s52, 0x20000
v_mfma_f32_16x16x32_bf16 v[132:135], a[52:55], a[80:83], v[132:135]
ds_read_b64_tr_b16 a[36:37], v25 offset:26880
v_mfma_f32_16x16x32_bf16 v[136:139], a[56:59], a[80:83], v[136:139]
buffer_load_dwordx4 v[168:171], v26, s[16:19], s75 offen sc1
v_mfma_f32_16x16x32_bf16 v[140:143], a[44:47], a[84:87], v[140:143]
ds_read_b64_tr_b16 a[38:39], v25 offset:27392
v_mfma_f32_16x16x32_bf16 v[144:147], a[48:51], a[84:87], v[144:147]
ds_read_b64_tr_b16 a[40:41], v25 offset:26912
v_mfma_f32_16x16x32_bf16 v[148:151], a[52:55], a[84:87], v[148:151]
ds_read_b64_tr_b16 a[42:43], v25 offset:27424
v_mfma_f32_16x16x32_bf16 v[152:155], a[56:59], a[84:87], v[152:155]
s_waitcnt vmcnt(17) lgkmcnt(6)
s_barrier
v_mfma_f32_16x16x32_bf16 v[60:63], a[20:23], a[0:3], v[60:63]
ds_read_b128 a[44:47], v23 offset:27648
s_add_u32 m0, s56, 78976
v_mfma_f32_16x16x32_bf16 v[64:67], a[20:23], a[4:7], v[64:67]
buffer_load_dwordx4 v18, s[20:23], s54 offen lds
v_mfma_f32_16x16x32_bf16 v[68:71], a[20:23], a[8:11], v[68:71]
ds_read_b128 a[48:51], v23 offset:28672
v_mfma_f32_16x16x32_bf16 v[72:75], a[20:23], a[12:15], v[72:75]
ds_read_b128 a[52:55], v23 offset:29952
v_mfma_f32_16x16x32_bf16 v[76:79], a[24:27], a[0:3], v[76:79]
ds_read_b128 a[56:59], v23 offset:30976
v_mfma_f32_16x16x32_bf16 v[80:83], a[24:27], a[4:7], v[80:83]
buffer_load_dwordx4 v19, s[20:23], s54 offen offset:1024 lds
v_mfma_f32_16x16x32_bf16 v[84:87], a[24:27], a[8:11], v[84:87]
ds_read_b64_tr_b16 a[64:65], v25 offset:37248
v_mfma_f32_16x16x32_bf16 v[88:91], a[24:27], a[12:15], v[88:91]
ds_read_b64_tr_b16 a[66:67], v25 offset:37760
v_mfma_f32_16x16x32_bf16 v[92:95], a[28:31], a[0:3], v[92:95]
ds_read_b64_tr_b16 a[68:69], v25 offset:37280
v_mfma_f32_16x16x32_bf16 v[96:99], a[28:31], a[4:7], v[96:99]
buffer_load_dwordx4 v20, s[20:23], s54 offen offset:2048 lds
v_mfma_f32_16x16x32_bf16 v[100:103], a[28:31], a[8:11], v[100:103]
s_add_u32 s54, s54, 196608
s_waitcnt lgkmcnt(7)
v_mfma_f32_16x16x32_bf16 v[104:107], a[28:31], a[12:15], v[104:107]
ds_read_b64_tr_b16 a[70:71], v25 offset:37792
v_mfma_f32_16x16x32_bf16 v[156:159], a[28:31], a[16:19], v[156:159]
ds_read_b128 a[60:63], v24 offset:29696
s_add_u32 m0, s55, 9216
v_mfma_f32_16x16x32_bf16 v[108:111], a[32:35], a[0:3], v[108:111]
buffer_load_dwordx4 v21, s[16:19], s52 offen sc1 lds
v_mfma_f32_16x16x32_bf16 v[112:115], a[32:35], a[4:7], v[112:115]
ds_read_b64_tr_b16 a[72:73], v25 offset:38272
v_mfma_f32_16x16x32_bf16 v[116:119], a[32:35], a[8:11], v[116:119]
ds_read_b64_tr_b16 a[74:75], v25 offset:38784
v_mfma_f32_16x16x32_bf16 v[120:123], a[32:35], a[12:15], v[120:123]
ds_read_b64_tr_b16 a[76:77], v25 offset:38304
v_mfma_f32_16x16x32_bf16 v[160:163], a[32:35], a[16:19], v[160:163]
buffer_load_dwordx4 v21, s[16:19], s52 offen offset:1024 sc1 lds
v_mfma_f32_16x16x32_bf16 v[124:127], a[0:3], a[36:39], v[124:127]
ds_read_b64_tr_b16 a[78:79], v25 offset:38816
v_mfma_f32_16x16x32_bf16 v[128:131], a[4:7], a[36:39], v[128:131]
ds_read_b64_tr_b16 a[80:81], v25 offset:39296
v_mfma_f32_16x16x32_bf16 v[132:135], a[8:11], a[36:39], v[132:135]
ds_read_b64_tr_b16 a[82:83], v25 offset:39808
v_mfma_f32_16x16x32_bf16 v[136:139], a[12:15], a[36:39], v[136:139]
buffer_load_dword v22, s[16:19], s52 offen offset:2048 sc1 lds
v_mfma_f32_16x16x32_bf16 v[140:143], a[0:3], a[40:43], v[140:143]
ds_read_b64_tr_b16 a[84:85], v25 offset:39328
s_add_u32 s52, s52, 0x20000
v_mfma_f32_16x16x32_bf16 v[144:147], a[4:7], a[40:43], v[144:147]
ds_read_b64_tr_b16 a[86:87], v25 offset:39840
v_mfma_f32_16x16x32_bf16 v[148:151], a[8:11], a[40:43], v[148:151]
v_mfma_f32_16x16x32_bf16 v[152:155], a[12:15], a[40:43], v[152:155]
s_waitcnt vmcnt(20) lgkmcnt(6)
s_barrier
v_mfma_f32_16x16x32_bf16 v[60:63], a[64:67], a[44:47], v[60:63]
ds_read_b128 a[0:3], v23 offset:36864
s_add_u32 m0, s56, 91392
v_mfma_f32_16x16x32_bf16 v[64:67], a[64:67], a[48:51], v[64:67]
buffer_load_dwordx4 v18, s[20:23], s54 offen lds
v_mfma_f32_16x16x32_bf16 v[68:71], a[64:67], a[52:55], v[68:71]
ds_read_b128 a[4:7], v23 offset:37888
v_add_f32 v164, v164, v172
v_mfma_f32_16x16x32_bf16 v[72:75], a[64:67], a[56:59], v[72:75]
ds_read_b128 a[8:11], v23 offset:39168
v_mfma_f32_16x16x32_bf16 v[76:79], a[68:71], a[44:47], v[76:79]
ds_read_b128 a[12:15], v23 offset:40192
v_mfma_f32_16x16x32_bf16 v[80:83], a[68:71], a[48:51], v[80:83]
buffer_load_dwordx4 v19, s[20:23], s54 offen offset:1024 lds
v_mfma_f32_16x16x32_bf16 v[84:87], a[68:71], a[52:55], v[84:87]
ds_read_b64_tr_b16 a[20:21], v25 offset:49664
v_mfma_f32_16x16x32_bf16 v[88:91], a[68:71], a[56:59], v[88:91]
ds_read_b64_tr_b16 a[22:23], v25 offset:50176
v_add_f32 v165, v165, v173
v_mfma_f32_16x16x32_bf16 v[92:95], a[72:75], a[44:47], v[92:95]
ds_read_b64_tr_b16 a[24:25], v25 offset:49696
v_mfma_f32_16x16x32_bf16 v[96:99], a[72:75], a[48:51], v[96:99]
buffer_load_dwordx4 v20, s[20:23], s54 offen offset:2048 lds
v_mfma_f32_16x16x32_bf16 v[100:103], a[72:75], a[52:55], v[100:103]
s_add_u32 s54, s54, 196608
s_waitcnt lgkmcnt(7)
v_mfma_f32_16x16x32_bf16 v[104:107], a[72:75], a[56:59], v[104:107]
ds_read_b64_tr_b16 a[26:27], v25 offset:50208
v_mfma_f32_16x16x32_bf16 v[156:159], a[72:75], a[60:63], v[156:159]
ds_read_b128 a[16:19], v24 offset:38912
s_add_u32 m0, s55, 18432
v_mfma_f32_16x16x32_bf16 v[108:111], a[76:79], a[44:47], v[108:111]
buffer_load_dwordx4 v21, s[16:19], s52 offen sc1 lds
v_mfma_f32_16x16x32_bf16 v[112:115], a[76:79], a[48:51], v[112:115]
ds_read_b64_tr_b16 a[28:29], v25 offset:50688
v_add_f32 v166, v166, v174
v_mfma_f32_16x16x32_bf16 v[116:119], a[76:79], a[52:55], v[116:119]
ds_read_b64_tr_b16 a[30:31], v25 offset:51200
v_mfma_f32_16x16x32_bf16 v[120:123], a[76:79], a[56:59], v[120:123]
ds_read_b64_tr_b16 a[32:33], v25 offset:50720
v_mfma_f32_16x16x32_bf16 v[160:163], a[76:79], a[60:63], v[160:163]
buffer_load_dwordx4 v21, s[16:19], s52 offen offset:1024 sc1 lds
v_mfma_f32_16x16x32_bf16 v[124:127], a[44:47], a[80:83], v[124:127]
ds_read_b64_tr_b16 a[34:35], v25 offset:51232
v_mfma_f32_16x16x32_bf16 v[128:131], a[48:51], a[80:83], v[128:131]
ds_read_b64_tr_b16 a[36:37], v25 offset:51712
v_add_f32 v167, v167, v175
v_mfma_f32_16x16x32_bf16 v[132:135], a[52:55], a[80:83], v[132:135]
ds_read_b64_tr_b16 a[38:39], v25 offset:52224
v_mfma_f32_16x16x32_bf16 v[136:139], a[56:59], a[80:83], v[136:139]
buffer_load_dword v22, s[16:19], s52 offen offset:2048 sc1 lds
v_mfma_f32_16x16x32_bf16 v[140:143], a[44:47], a[84:87], v[140:143]
ds_read_b64_tr_b16 a[40:41], v25 offset:51744
s_add_u32 s52, s52, 0x20000
v_mfma_f32_16x16x32_bf16 v[144:147], a[48:51], a[84:87], v[144:147]
ds_read_b64_tr_b16 a[42:43], v25 offset:52256
v_mfma_f32_16x16x32_bf16 v[148:151], a[52:55], a[84:87], v[148:151]
v_mfma_f32_16x16x32_bf16 v[152:155], a[56:59], a[84:87], v[152:155]
s_waitcnt vmcnt(20) lgkmcnt(6)
s_barrier
v_mfma_f32_16x16x32_bf16 v[60:63], a[20:23], a[0:3], v[60:63]
ds_read_b128 a[44:47], v23 offset:46080
s_add_u32 m0, s56, 103808
v_mfma_f32_16x16x32_bf16 v[64:67], a[20:23], a[4:7], v[64:67]
buffer_load_dwordx4 v18, s[20:23], s54 offen lds
v_mfma_f32_16x16x32_bf16 v[68:71], a[20:23], a[8:11], v[68:71]
ds_read_b128 a[48:51], v23 offset:47104
v_mfma_f32_16x16x32_bf16 v[72:75], a[20:23], a[12:15], v[72:75]
ds_read_b128 a[52:55], v23 offset:48384
v_mfma_f32_16x16x32_bf16 v[76:79], a[24:27], a[0:3], v[76:79]
buffer_load_dwordx4 v19, s[20:23], s54 offen offset:1024 lds
v_mfma_f32_16x16x32_bf16 v[80:83], a[24:27], a[4:7], v[80:83]
ds_read_b128 a[56:59], v23 offset:49408
v_mfma_f32_16x16x32_bf16 v[84:87], a[24:27], a[8:11], v[84:87]
ds_read_b64_tr_b16 a[64:65], v25 offset:62080
v_mfma_f32_16x16x32_bf16 v[88:91], a[24:27], a[12:15], v[88:91]
buffer_load_dwordx4 v20, s[20:23], s54 offen offset:2048 lds
v_mfma_f32_16x16x32_bf16 v[92:95], a[28:31], a[0:3], v[92:95]
ds_read_b64_tr_b16 a[66:67], v25 offset:62592
s_add_u32 s54, s54, 196608
v_mfma_f32_16x16x32_bf16 v[96:99], a[28:31], a[4:7], v[96:99]
ds_read_b64_tr_b16 a[68:69], v25 offset:62112
v_mfma_f32_16x16x32_bf16 v[100:103], a[28:31], a[8:11], v[100:103]
s_add_u32 m0, s55, 27648
s_waitcnt lgkmcnt(7)
v_mfma_f32_16x16x32_bf16 v[104:107], a[28:31], a[12:15], v[104:107]
buffer_load_dwordx4 v21, s[16:19], s52 offen sc1 lds
v_mfma_f32_16x16x32_bf16 v[156:159], a[28:31], a[16:19], v[156:159]
ds_read_b64_tr_b16 a[70:71], v25 offset:62624
v_mfma_f32_16x16x32_bf16 v[108:111], a[32:35], a[0:3], v[108:111]
ds_read_b128 a[60:63], v24 offset:48128
v_mfma_f32_16x16x32_bf16 v[112:115], a[32:35], a[4:7], v[112:115]
buffer_load_dwordx4 v21, s[16:19], s52 offen offset:1024 sc1 lds
v_mfma_f32_16x16x32_bf16 v[116:119], a[32:35], a[8:11], v[116:119]
ds_read_b64_tr_b16 a[72:73], v25 offset:63104
v_mfma_f32_16x16x32_bf16 v[120:123], a[32:35], a[12:15], v[120:123]
ds_read_b64_tr_b16 a[74:75], v25 offset:63616
v_mfma_f32_16x16x32_bf16 v[160:163], a[32:35], a[16:19], v[160:163]
ds_read_b64_tr_b16 a[76:77], v25 offset:63136
v_mfma_f32_16x16x32_bf16 v[124:127], a[0:3], a[36:39], v[124:127]
buffer_load_dword v22, s[16:19], s52 offen offset:2048 sc1 lds
v_mfma_f32_16x16x32_bf16 v[128:131], a[4:7], a[36:39], v[128:131]
ds_read_b64_tr_b16 a[78:79], v25 offset:63648
s_add_u32 s52, s52, 0x20000
v_mfma_f32_16x16x32_bf16 v[132:135], a[8:11], a[36:39], v[132:135]
ds_read_b64_tr_b16 a[80:81], v25 offset:64128
v_mfma_f32_16x16x32_bf16 v[136:139], a[12:15], a[36:39], v[136:139]
buffer_load_dwordx4 v[172:175], v26, s[16:19], s75 offen offset:1024 sc1
v_mfma_f32_16x16x32_bf16 v[140:143], a[0:3], a[40:43], v[140:143]
ds_read_b64_tr_b16 a[82:83], v25 offset:64640
s_add_u32 s75, s75, 2048
v_mfma_f32_16x16x32_bf16 v[144:147], a[4:7], a[40:43], v[144:147]
ds_read_b64_tr_b16 a[84:85], v25 offset:64160
v_mfma_f32_16x16x32_bf16 v[148:151], a[8:11], a[40:43], v[148:151]
ds_read_b64_tr_b16 a[86:87], v25 offset:64672
v_mfma_f32_16x16x32_bf16 v[152:155], a[12:15], a[40:43], v[152:155]
s_waitcnt vmcnt(20) lgkmcnt(6)
s_barrier
v_mfma_f32_16x16x32_bf16 v[60:63], a[64:67], a[44:47], v[60:63]
ds_read_b128 a[0:3], v23
s_add_u32 m0, s56, 116224
v_mfma_f32_16x16x32_bf16 v[64:67], a[64:67], a[48:51], v[64:67]
buffer_load_dwordx4 v18, s[20:23], s54 offen lds
v_mfma_f32_16x16x32_bf16 v[68:71], a[64:67], a[52:55], v[68:71]
ds_read_b128 a[4:7], v23 offset:1024
v_mfma_f32_16x16x32_bf16 v[72:75], a[64:67], a[56:59], v[72:75]
ds_read_b128 a[8:11], v23 offset:2304
v_mfma_f32_16x16x32_bf16 v[76:79], a[68:71], a[44:47], v[76:79]
ds_read_b128 a[12:15], v23 offset:3328
v_mfma_f32_16x16x32_bf16 v[80:83], a[68:71], a[48:51], v[80:83]
buffer_load_dwordx4 v19, s[20:23], s54 offen offset:1024 lds
v_mfma_f32_16x16x32_bf16 v[84:87], a[68:71], a[52:55], v[84:87]
ds_read_b64_tr_b16 a[20:21], v25
v_mfma_f32_16x16x32_bf16 v[88:91], a[68:71], a[56:59], v[88:91]
ds_read_b64_tr_b16 a[22:23], v25 offset:512
v_mfma_f32_16x16x32_bf16 v[92:95], a[72:75], a[44:47], v[92:95]
ds_read_b64_tr_b16 a[24:25], v25 offset:32
v_mfma_f32_16x16x32_bf16 v[96:99], a[72:75], a[48:51], v[96:99]
buffer_load_dwordx4 v20, s[20:23], s54 offen offset:2048 lds
v_mfma_f32_16x16x32_bf16 v[100:103], a[72:75], a[52:55], v[100:103]
s_add_u32 s54, s54, 196608
s_waitcnt lgkmcnt(7)
v_mfma_f32_16x16x32_bf16 v[104:107], a[72:75], a[56:59], v[104:107]
ds_read_b64_tr_b16 a[26:27], v25 offset:544
v_mfma_f32_16x16x32_bf16 v[156:159], a[72:75], a[60:63], v[156:159]
ds_read_b128 a[16:19], v24 offset:2048
s_add_u32 m0, s55, 36864
v_mfma_f32_16x16x32_bf16 v[108:111], a[76:79], a[44:47], v[108:111]
buffer_load_dwordx4 v21, s[16:19], s52 offen sc1 lds
v_mfma_f32_16x16x32_bf16 v[112:115], a[76:79], a[48:51], v[112:115]
ds_read_b64_tr_b16 a[28:29], v25 offset:1024
v_mfma_f32_16x16x32_bf16 v[116:119], a[76:79], a[52:55], v[116:119]
ds_read_b64_tr_b16 a[30:31], v25 offset:1536
v_mfma_f32_16x16x32_bf16 v[120:123], a[76:79], a[56:59], v[120:123]
ds_read_b64_tr_b16 a[32:33], v25 offset:1056
v_mfma_f32_16x16x32_bf16 v[160:163], a[76:79], a[60:63], v[160:163]
buffer_load_dwordx4 v21, s[16:19], s52 offen offset:1024 sc1 lds
v_mfma_f32_16x16x32_bf16 v[124:127], a[44:47], a[80:83], v[124:127]
ds_read_b64_tr_b16 a[34:35], v25 offset:1568
v_mfma_f32_16x16x32_bf16 v[128:131], a[48:51], a[80:83], v[128:131]
ds_read_b64_tr_b16 a[36:37], v25 offset:2048
v_mfma_f32_16x16x32_bf16 v[132:135], a[52:55], a[80:83], v[132:135]
ds_read_b64_tr_b16 a[38:39], v25 offset:2560
v_mfma_f32_16x16x32_bf16 v[136:139], a[56:59], a[80:83], v[136:139]
buffer_load_dword v22, s[16:19], s52 offen offset:2048 sc1 lds
v_mfma_f32_16x16x32_bf16 v[140:143], a[44:47], a[84:87], v[140:143]
ds_read_b64_tr_b16 a[40:41], v25 offset:2080
s_add_u32 s52, s52, 0x20000
v_mfma_f32_16x16x32_bf16 v[144:147], a[48:51], a[84:87], v[144:147]
ds_read_b64_tr_b16 a[42:43], v25 offset:2592
v_mfma_f32_16x16x32_bf16 v[148:151], a[52:55], a[84:87], v[148:151]
s_add_u32 s15, s15, 1
v_mfma_f32_16x16x32_bf16 v[152:155], a[56:59], a[84:87], v[152:155]
s_cbranch_scc0 .Lk44
s_waitcnt vmcnt(19) lgkmcnt(6)
s_barrier
v_mfma_f32_16x16x32_bf16 v[60:63], a[20:23], a[0:3], v[60:63]
ds_read_b128 a[44:47], v23 offset:9216
s_add_u32 m0, s56, 128640
v_mfma_f32_16x16x32_bf16 v[64:67], a[20:23], a[4:7], v[64:67]
buffer_load_dwordx4 v18, s[20:23], s54 offen lds
v_mfma_f32_16x16x32_bf16 v[68:71], a[20:23], a[8:11], v[68:71]
ds_read_b128 a[48:51], v23 offset:10240
v_add_f32 v164, v164, v168
v_mfma_f32_16x16x32_bf16 v[72:75], a[20:23], a[12:15], v[72:75]
ds_read_b128 a[52:55], v23 offset:11520
v_mfma_f32_16x16x32_bf16 v[76:79], a[24:27], a[0:3], v[76:79]
ds_read_b128 a[56:59], v23 offset:12544
v_mfma_f32_16x16x32_bf16 v[80:83], a[24:27], a[4:7], v[80:83]
buffer_load_dwordx4 v19, s[20:23], s54 offen offset:1024 lds
v_mfma_f32_16x16x32_bf16 v[84:87], a[24:27], a[8:11], v[84:87]
ds_read_b64_tr_b16 a[64:65], v25 offset:12416
v_mfma_f32_16x16x32_bf16 v[88:91], a[24:27], a[12:15], v[88:91]
ds_read_b64_tr_b16 a[66:67], v25 offset:12928
v_add_f32 v165, v165, v169
v_mfma_f32_16x16x32_bf16 v[92:95], a[28:31], a[0:3], v[92:95]
ds_read_b64_tr_b16 a[68:69], v25 offset:12448
v_mfma_f32_16x16x32_bf16 v[96:99], a[28:31], a[4:7], v[96:99]
buffer_load_dwordx4 v20, s[20:23], s54 offen offset:2048 lds
v_mfma_f32_16x16x32_bf16 v[100:103], a[28:31], a[8:11], v[100:103]
s_add_u32 s54, s54, 196608
s_waitcnt lgkmcnt(7)
v_mfma_f32_16x16x32_bf16 v[104:107], a[28:31], a[12:15], v[104:107]
ds_read_b64_tr_b16 a[70:71], v25 offset:12960
v_mfma_f32_16x16x32_bf16 v[156:159], a[28:31], a[16:19], v[156:159]
ds_read_b128 a[60:63], v24 offset:11264
s_add_u32 m0, s55, 46080
v_mfma_f32_16x16x32_bf16 v[108:111], a[32:35], a[0:3], v[108:111]
buffer_load_dwordx4 v21, s[16:19], s52 offen sc1 lds
v_mfma_f32_16x16x32_bf16 v[112:115], a[32:35], a[4:7], v[112:115]
ds_read_b64_tr_b16 a[72:73], v25 offset:13440
v_add_f32 v166, v166, v170
v_mfma_f32_16x16x32_bf16 v[116:119], a[32:35], a[8:11], v[116:119]
ds_read_b64_tr_b16 a[74:75], v25 offset:13952
v_mfma_f32_16x16x32_bf16 v[120:123], a[32:35], a[12:15], v[120:123]
ds_read_b64_tr_b16 a[76:77], v25 offset:13472
v_mfma_f32_16x16x32_bf16 v[160:163], a[32:35], a[16:19], v[160:163]
buffer_load_dwordx4 v21, s[16:19], s52 offen offset:1024 sc1 lds
v_mfma_f32_16x16x32_bf16 v[124:127], a[0:3], a[36:39], v[124:127]
ds_read_b64_tr_b16 a[78:79], v25 offset:13984
v_mfma_f32_16x16x32_bf16 v[128:131], a[4:7], a[36:39], v[128:131]
ds_read_b64_tr_b16 a[80:81], v25 offset:14464
v_add_f32 v167, v167, v171
v_mfma_f32_16x16x32_bf16 v[132:135], a[8:11], a[36:39], v[132:135]
ds_read_b64_tr_b16 a[82:83], v25 offset:14976
v_mfma_f32_16x16x32_bf16 v[136:139], a[12:15], a[36:39], v[136:139]
buffer_load_dword v22, s[16:19], s52 offen offset:2048 sc1 lds
v_mfma_f32_16x16x32_bf16 v[140:143], a[0:3], a[40:43], v[140:143]
ds_read_b64_tr_b16 a[84:85], v25 offset:14496
s_add_u32 s52, s52, 0x20000
v_mfma_f32_16x16x32_bf16 v[144:147], a[4:7], a[40:43], v[144:147]
ds_read_b64_tr_b16 a[86:87], v25 offset:15008
v_mfma_f32_16x16x32_bf16 v[148:151], a[8:11], a[40:43], v[148:151]
v_mfma_f32_16x16x32_bf16 v[152:155], a[12:15], a[40:43], v[152:155]
s_waitcnt vmcnt(19) lgkmcnt(6)
s_barrier
v_mfma_f32_16x16x32_bf16 v[60:63], a[64:67], a[44:47], v[60:63]
ds_read_b128 a[0:3], v23 offset:18432
s_add_u32 m0, s56, 66560
v_mfma_f32_16x16x32_bf16 v[64:67], a[64:67], a[48:51], v[64:67]
buffer_load_dwordx4 v18, s[20:23], s54 offen lds
v_mfma_f32_16x16x32_bf16 v[68:71], a[64:67], a[52:55], v[68:71]
ds_read_b128 a[4:7], v23 offset:19456
v_mfma_f32_16x16x32_bf16 v[72:75], a[64:67], a[56:59], v[72:75]
ds_read_b128 a[8:11], v23 offset:20736
v_mfma_f32_16x16x32_bf16 v[76:79], a[68:71], a[44:47], v[76:79]
ds_read_b128 a[12:15], v23 offset:21760
v_mfma_f32_16x16x32_bf16 v[80:83], a[68:71], a[48:51], v[80:83]
buffer_load_dwordx4 v19, s[20:23], s54 offen offset:1024 lds
v_mfma_f32_16x16x32_bf16 v[84:87], a[68:71], a[52:55], v[84:87]
ds_read_b64_tr_b16 a[20:21], v25 offset:24832
v_mfma_f32_16x16x32_bf16 v[88:91], a[68:71], a[56:59], v[88:91]
ds_read_b64_tr_b16 a[22:23], v25 offset:25344
v_mfma_f32_16x16x32_bf16 v[92:95], a[72:75], a[44:47], v[92:95]
ds_read_b64_tr_b16 a[24:25], v25 offset:24864
v_mfma_f32_16x16x32_bf16 v[96:99], a[72:75], a[48:51], v[96:99]
buffer_load_dwordx4 v20, s[20:23], s54 offen offset:2048 lds
v_mfma_f32_16x16x32_bf16 v[100:103], a[72:75], a[52:55], v[100:103]
.Lpad19:
s_cbranch_execz .Lpad22
s_add_u32 s54, s54, 196608
s_waitcnt lgkmcnt(7)
v_mfma_f32_16x16x32_bf16 v[104:107], a[72:75], a[56:59], v[104:107]
ds_read_b64_tr_b16 a[26:27], v25 offset:25376
v_mfma_f32_16x16x32_bf16 v[156:159], a[72:75], a[60:63], v[156:159]
ds_read_b128 a[16:19], v24 offset:20480
s_add_u32 m0, s55, 0
v_mfma_f32_16x16x32_bf16 v[108:111], a[76:79], a[44:47], v[108:111]
buffer_load_dwordx4 v21, s[16:19], s52 offen sc1 lds
v_mfma_f32_16x16x32_bf16 v[112:115], a[76:79], a[48:51], v[112:115]
ds_read_b64_tr_b16 a[28:29], v25 offset:25856
v_mfma_f32_16x16x32_bf16 v[116:119], a[76:79], a[52:55], v[116:119]
ds_read_b64_tr_b16 a[30:31], v25 offset:26368
v_mfma_f32_16x16x32_bf16 v[120:123], a[76:79], a[56:59], v[120:123]
ds_read_b64_tr_b16 a[32:33], v25 offset:25888
v_mfma_f32_16x16x32_bf16 v[160:163], a[76:79], a[60:63], v[160:163]
buffer_load_dwordx4 v21, s[16:19], s52 offen offset:1024 sc1 lds
v_mfma_f32_16x16x32_bf16 v[124:127], a[44:47], a[80:83], v[124:127]
ds_read_b64_tr_b16 a[34:35], v25 offset:26400
v_mfma_f32_16x16x32_bf16 v[128:131], a[48:51], a[80:83], v[128:131]
ds_read_b64_tr_b16 a[36:37], v25 offset:26880
v_mfma_f32_16x16x32_bf16 v[132:135], a[52:55], a[80:83], v[132:135]
ds_read_b64_tr_b16 a[38:39], v25 offset:27392
v_mfma_f32_16x16x32_bf16 v[136:139], a[56:59], a[80:83], v[136:139]
buffer_load_dword v22, s[16:19], s52 offen offset:2048 sc1 lds
v_mfma_f32_16x16x32_bf16 v[140:143], a[44:47], a[84:87], v[140:143]
ds_read_b64_tr_b16 a[40:41], v25 offset:26912
s_add_u32 s52, s52, 0x20000
v_mfma_f32_16x16x32_bf16 v[144:147], a[48:51], a[84:87], v[144:147]
ds_read_b64_tr_b16 a[42:43], v25 offset:27424
v_mfma_f32_16x16x32_bf16 v[148:151], a[52:55], a[84:87], v[148:151]
v_mfma_f32_16x16x32_bf16 v[152:155], a[56:59], a[84:87], v[152:155]
s_waitcnt vmcnt(19) lgkmcnt(6)
s_barrier
v_mfma_f32_16x16x32_bf16 v[60:63], a[20:23], a[0:3], v[60:63]
ds_read_b128 a[44:47], v23 offset:27648
s_add_u32 m0, s56, 78976
v_mfma_f32_16x16x32_bf16 v[64:67], a[20:23], a[4:7], v[64:67]
buffer_load_dwordx4 v18, s[20:23], s54 offen lds
v_mfma_f32_16x16x32_bf16 v[68:71], a[20:23], a[8:11], v[68:71]
ds_read_b128 a[48:51], v23 offset:28672
s_waitcnt vmcnt(19)
v_add_f32 v164, v164, v172
v_mfma_f32_16x16x32_bf16 v[72:75], a[20:23], a[12:15], v[72:75]
ds_read_b128 a[52:55], v23 offset:29952
v_mfma_f32_16x16x32_bf16 v[76:79], a[24:27], a[0:3], v[76:79]
ds_read_b128 a[56:59], v23 offset:30976
v_mfma_f32_16x16x32_bf16 v[80:83], a[24:27], a[4:7], v[80:83]
buffer_load_dwordx4 v19, s[20:23], s54 offen offset:1024 lds
v_mfma_f32_16x16x32_bf16 v[84:87], a[24:27], a[8:11], v[84:87]
ds_read_b64_tr_b16 a[64:65], v25 offset:37248
v_mfma_f32_16x16x32_bf16 v[88:91], a[24:27], a[12:15], v[88:91]
ds_read_b64_tr_b16 a[66:67], v25 offset:37760
v_add_f32 v165, v165, v173
v_mfma_f32_16x16x32_bf16 v[92:95], a[28:31], a[0:3], v[92:95]
ds_read_b64_tr_b16 a[68:69], v25 offset:37280
v_mfma_f32_16x16x32_bf16 v[96:99], a[28:31], a[4:7], v[96:99]
buffer_load_dwordx4 v20, s[20:23], s54 offen offset:2048 lds
v_mfma_f32_16x16x32_bf16 v[100:103], a[28:31], a[8:11], v[100:103]
s_add_u32 s54, s54, 196608
s_waitcnt lgkmcnt(7)
v_mfma_f32_16x16x32_bf16 v[104:107], a[28:31], a[12:15], v[104:107]
ds_read_b64_tr_b16 a[70:71], v25 offset:37792
v_mfma_f32_16x16x32_bf16 v[156:159], a[28:31], a[16:19], v[156:159]
ds_read_b128 a[60:63], v24 offset:29696
s_add_u32 m0, s55, 9216
v_mfma_f32_16x16x32_bf16 v[108:111], a[32:35], a[0:3], v[108:111]
buffer_load_dwordx4 v21, s[16:19], s52 offen sc1 lds
v_mfma_f32_16x16x32_bf16 v[112:115], a[32:35], a[4:7], v[112:115]
ds_read_b64_tr_b16 a[72:73], v25 offset:38272
v_add_f32 v166, v166, v174
v_mfma_f32_16x16x32_bf16 v[116:119], a[32:35], a[8:11], v[116:119]
ds_read_b64_tr_b16 a[74:75], v25 offset:38784
v_mfma_f32_16x16x32_bf16 v[120:123], a[32:35], a[12:15], v[120:123]
ds_read_b64_tr_b16 a[76:77], v25 offset:38304
v_mfma_f32_16x16x32_bf16 v[160:163], a[32:35], a[16:19], v[160:163]
buffer_load_dwordx4 v21, s[16:19], s52 offen offset:1024 sc1 lds
v_mfma_f32_16x16x32_bf16 v[124:127], a[0:3], a[36:39], v[124:127]
ds_read_b64_tr_b16 a[78:79], v25 offset:38816
v_mfma_f32_16x16x32_bf16 v[128:131], a[4:7], a[36:39], v[128:131]
ds_read_b64_tr_b16 a[80:81], v25 offset:39296
v_add_f32 v167, v167, v175
v_mfma_f32_16x16x32_bf16 v[132:135], a[8:11], a[36:39], v[132:135]
ds_read_b64_tr_b16 a[82:83], v25 offset:39808
v_mfma_f32_16x16x32_bf16 v[136:139], a[12:15], a[36:39], v[136:139]
buffer_load_dword v22, s[16:19], s52 offen offset:2048 sc1 lds
v_mfma_f32_16x16x32_bf16 v[140:143], a[0:3], a[40:43], v[140:143]
ds_read_b64_tr_b16 a[84:85], v25 offset:39328
s_add_u32 s52, s52, 0x20000
v_mfma_f32_16x16x32_bf16 v[144:147], a[4:7], a[40:43], v[144:147]
ds_read_b64_tr_b16 a[86:87], v25 offset:39840
v_mfma_f32_16x16x32_bf16 v[148:151], a[8:11], a[40:43], v[148:151]
v_mfma_f32_16x16x32_bf16 v[152:155], a[12:15], a[40:43], v[152:155]
s_waitcnt vmcnt(18) lgkmcnt(6)
s_barrier
v_mfma_f32_16x16x32_bf16 v[60:63], a[64:67], a[44:47], v[60:63]
s_add_u32 m0, s59, 58240
s_mov_b32 s58, 1966080
v_permlane32_swap_b32 v164, v166
v_mfma_f32_16x16x32_bf16 v[64:67], a[64:67], a[48:51], v[64:67]
buffer_load_dwordx4 v5, s[24:27], s58 offen lds
v_mfma_f32_16x16x32_bf16 v[68:71], a[64:67], a[52:55], v[68:71]
ds_read_b128 a[0:3], v23 offset:36864
v_mfma_f32_16x16x32_bf16 v[72:75], a[64:67], a[56:59], v[72:75]
ds_read_b128 a[4:7], v23 offset:37888
v_permlane32_swap_b32 v165, v167
v_mfma_f32_16x16x32_bf16 v[76:79], a[68:71], a[44:47], v[76:79]
ds_read_b128 a[8:11], v23 offset:39168
v_mfma_f32_16x16x32_bf16 v[80:83], a[68:71], a[48:51], v[80:83]
ds_read_b128 a[12:15], v23 offset:40192
v_mfma_f32_16x16x32_bf16 v[84:87], a[68:71], a[52:55], v[84:87]
ds_read_b64_tr_b16 a[20:21], v25 offset:49664
v_add_f32 v164, v164, v166
v_mfma_f32_16x16x32_bf16 v[88:91], a[68:71], a[56:59], v[88:91]
buffer_load_dwordx4 v6, s[24:27], s58 offen offset:1024 lds
v_mfma_f32_16x16x32_bf16 v[92:95], a[72:75], a[44:47], v[92:95]
ds_read_b64_tr_b16 a[22:23], v25 offset:50176
v_mfma_f32_16x16x32_bf16 v[96:99], a[72:75], a[48:51], v[96:99]
ds_read_b64_tr_b16 a[24:25], v25 offset:49696
v_mfma_f32_16x16x32_bf16 v[100:103], a[72:75], a[52:55], v[100:103]
ds_read_b64_tr_b16 a[26:27], v25 offset:50208
s_waitcnt lgkmcnt(8)
v_mfma_f32_16x16x32_bf16 v[104:107], a[72:75], a[56:59], v[104:107]
ds_read_b128 a[16:19], v24 offset:38912
v_add_f32 v165, v165, v167
v_mfma_f32_16x16x32_bf16 v[156:159], a[72:75], a[60:63], v[156:159]
s_add_u32 m0, s59, 91520
s_mov_b32 s58, 393216
v_mfma_f32_16x16x32_bf16 v[108:111], a[76:79], a[44:47], v[108:111]
buffer_load_dwordx4 v5, s[24:27], s58 offen lds
v_mfma_f32_16x16x32_bf16 v[112:115], a[76:79], a[48:51], v[112:115]
v_mul_f32 v164, 0xba800000, v164
v_mfma_f32_16x16x32_bf16 v[116:119], a[76:79], a[52:55], v[116:119]
ds_read_b64_tr_b16 a[28:29], v25 offset:50688
v_mfma_f32_16x16x32_bf16 v[120:123], a[76:79], a[56:59], v[120:123]
ds_read_b64_tr_b16 a[30:31], v25 offset:51200
v_mul_f32 v165, 0x3a800000, v165
v_mfma_f32_16x16x32_bf16 v[160:163], a[76:79], a[60:63], v[160:163]
ds_read_b64_tr_b16 a[32:33], v25 offset:50720
v_mfma_f32_16x16x32_bf16 v[124:127], a[44:47], a[80:83], v[124:127]
ds_read_b64_tr_b16 a[34:35], v25 offset:51232
v_mfma_f32_16x16x32_bf16 v[128:131], a[48:51], a[80:83], v[128:131]
buffer_load_dwordx4 v6, s[24:27], s58 offen offset:1024 lds
v_mfma_f32_16x16x32_bf16 v[132:135], a[52:55], a[80:83], v[132:135]
ds_read_b64_tr_b16 a[36:37], v25 offset:51712
v_fma_f32 v165, -v164, v164, v165
v_mfma_f32_16x16x32_bf16 v[136:139], a[56:59], a[80:83], v[136:139]
ds_read_b64_tr_b16 a[38:39], v25 offset:52224
v_mfma_f32_16x16x32_bf16 v[140:143], a[44:47], a[84:87], v[140:143]
ds_read_b64_tr_b16 a[40:41], v25 offset:51744
v_mfma_f32_16x16x32_bf16 v[144:147], a[48:51], a[84:87], v[144:147]
ds_read_b64_tr_b16 a[42:43], v25 offset:52256
v_max_f32 v165, 0, v165
v_mfma_f32_16x16x32_bf16 v[148:151], a[52:55], a[84:87], v[148:151]
v_mfma_f32_16x16x32_bf16 v[152:155], a[56:59], a[84:87], v[152:155]
s_waitcnt vmcnt(16) lgkmcnt(6)
s_barrier
v_mfma_f32_16x16x32_bf16 v[60:63], a[20:23], a[0:3], v[60:63]
s_add_u32 m0, s59, 24960
s_mov_b32 s58, 1441792
v_add_f32 v165, 0x3727c5ac, v165
v_mfma_f32_16x16x32_bf16 v[64:67], a[20:23], a[4:7], v[64:67]
buffer_load_dwordx4 v5, s[24:27], s58 offen lds
v_mfma_f32_16x16x32_bf16 v[68:71], a[20:23], a[8:11], v[68:71]
ds_read_b128 a[44:47], v23 offset:46080
v_mfma_f32_16x16x32_bf16 v[72:75], a[20:23], a[12:15], v[72:75]
ds_read_b128 a[48:51], v23 offset:47104
v_mfma_f32_16x16x32_bf16 v[76:79], a[24:27], a[0:3], v[76:79]
ds_read_b128 a[52:55], v23 offset:48384
v_rsq_f32 v166, v165
v_mfma_f32_16x16x32_bf16 v[80:83], a[24:27], a[4:7], v[80:83]
ds_read_b128 a[56:59], v23 offset:49408
v_mfma_f32_16x16x32_bf16 v[84:87], a[24:27], a[8:11], v[84:87]
ds_read_b64_tr_b16 a[64:65], v25 offset:62080
v_mfma_f32_16x16x32_bf16 v[88:91], a[24:27], a[12:15], v[88:91]
buffer_load_dwordx4 v6, s[24:27], s58 offen offset:1024 lds
v_mfma_f32_16x16x32_bf16 v[92:95], a[28:31], a[0:3], v[92:95]
ds_read_b64_tr_b16 a[66:67], v25 offset:62592
v_mov_b32 v165, v166
v_mfma_f32_16x16x32_bf16 v[96:99], a[28:31], a[4:7], v[96:99]
ds_read_b64_tr_b16 a[68:69], v25 offset:62112
v_mfma_f32_16x16x32_bf16 v[100:103], a[28:31], a[8:11], v[100:103]
ds_read_b64_tr_b16 a[70:71], v25 offset:62624
s_waitcnt lgkmcnt(8)
v_mfma_f32_16x16x32_bf16 v[104:107], a[28:31], a[12:15], v[104:107]
ds_read_b128 a[60:63], v24 offset:48128
v_mfma_f32_16x16x32_bf16 v[156:159], a[28:31], a[16:19], v[156:159]
s_add_u32 m0, s59, 99840
s_mov_b32 s58, 524288
v_mul_f32 v166, 0x3e8293ee, v166
v_mfma_f32_16x16x32_bf16 v[108:111], a[32:35], a[0:3], v[108:111]
buffer_load_dwordx4 v5, s[24:27], s58 offen lds
v_mfma_f32_16x16x32_bf16 v[112:115], a[32:35], a[4:7], v[112:115]
v_mfma_f32_16x16x32_bf16 v[116:119], a[32:35], a[8:11], v[116:119]
ds_read_b64_tr_b16 a[72:73], v25 offset:63104
ds_write_b128 v7, v[164:167]
v_mfma_f32_16x16x32_bf16 v[120:123], a[32:35], a[12:15], v[120:123]
ds_read_b64_tr_b16 a[74:75], v25 offset:63616
v_mfma_f32_16x16x32_bf16 v[160:163], a[32:35], a[16:19], v[160:163]
ds_read_b64_tr_b16 a[76:77], v25 offset:63136
v_mfma_f32_16x16x32_bf16 v[124:127], a[0:3], a[36:39], v[124:127]
ds_read_b64_tr_b16 a[78:79], v25 offset:63648
ds_write_b32 v17, v164
v_mfma_f32_16x16x32_bf16 v[128:131], a[4:7], a[36:39], v[128:131]
buffer_load_dwordx4 v6, s[24:27], s58 offen offset:1024 lds
v_mfma_f32_16x16x32_bf16 v[132:135], a[8:11], a[36:39], v[132:135]
ds_read_b64_tr_b16 a[80:81], v25 offset:64128
v_mfma_f32_16x16x32_bf16 v[136:139], a[12:15], a[36:39], v[136:139]
ds_read_b64_tr_b16 a[82:83], v25 offset:64640
v_mfma_f32_16x16x32_bf16 v[140:143], a[0:3], a[40:43], v[140:143]
ds_read_b64_tr_b16 a[84:85], v25 offset:64160
ds_write_b32 v17, v165 offset:1024
v_mfma_f32_16x16x32_bf16 v[144:147], a[4:7], a[40:43], v[144:147]
ds_read_b64_tr_b16 a[86:87], v25 offset:64672
v_mfma_f32_16x16x32_bf16 v[148:151], a[8:11], a[40:43], v[148:151]
v_mfma_f32_16x16x32_bf16 v[152:155], a[12:15], a[40:43], v[152:155]
s_waitcnt vmcnt(14) lgkmcnt(8)
s_barrier
v_mfma_f32_16x16x32_bf16 v[60:63], a[64:67], a[44:47], v[60:63]
ds_read_b128 a[0:3], v23
s_add_u32 m0, s59, 33280
s_mov_b32 s58, 1572864
v_mfma_f32_16x16x32_bf16 v[64:67], a[64:67], a[48:51], v[64:67]
buffer_load_dwordx4 v5, s[24:27], s58 offen lds
v_mfma_f32_16x16x32_bf16 v[68:71], a[64:67], a[52:55], v[68:71]
ds_read_b128 a[4:7], v23 offset:1024
v_mfma_f32_16x16x32_bf16 v[72:75], a[64:67], a[56:59], v[72:75]
ds_read_b128 a[8:11], v23 offset:2304
v_mfma_f32_16x16x32_bf16 v[76:79], a[68:71], a[44:47], v[76:79]
ds_read_b128 a[12:15], v23 offset:3328
v_mfma_f32_16x16x32_bf16 v[80:83], a[68:71], a[48:51], v[80:83]
buffer_load_dwordx4 v6, s[24:27], s58 offen offset:1024 lds
v_mfma_f32_16x16x32_bf16 v[84:87], a[68:71], a[52:55], v[84:87]
ds_read_b64_tr_b16 a[20:21], v25
v_mfma_f32_16x16x32_bf16 v[88:91], a[68:71], a[56:59], v[88:91]
ds_read_b64_tr_b16 a[22:23], v25 offset:512
v_mfma_f32_16x16x32_bf16 v[92:95], a[72:75], a[44:47], v[92:95]
s_add_u32 m0, s59, 108160
s_mov_b32 s58, 655360
v_mfma_f32_16x16x32_bf16 v[96:99], a[72:75], a[48:51], v[96:99]
buffer_load_dwordx4 v5, s[24:27], s58 offen lds
v_mfma_f32_16x16x32_bf16 v[100:103], a[72:75], a[52:55], v[100:103]
ds_read_b64_tr_b16 a[24:25], v25 offset:32
s_waitcnt lgkmcnt(7)
v_mfma_f32_16x16x32_bf16 v[104:107], a[72:75], a[56:59], v[104:107]
ds_read_b64_tr_b16 a[26:27], v25 offset:544
v_mfma_f32_16x16x32_bf16 v[156:159], a[72:75], a[60:63], v[156:159]
ds_read_b128 a[16:19], v24 offset:2048
v_mfma_f32_16x16x32_bf16 v[108:111], a[76:79], a[44:47], v[108:111]
buffer_load_dwordx4 v6, s[24:27], s58 offen offset:1024 lds
v_mfma_f32_16x16x32_bf16 v[112:115], a[76:79], a[48:51], v[112:115]
ds_read_b64_tr_b16 a[28:29], v25 offset:1024
v_mfma_f32_16x16x32_bf16 v[116:119], a[76:79], a[52:55], v[116:119]
ds_read_b64_tr_b16 a[30:31], v25 offset:1536
v_mfma_f32_16x16x32_bf16 v[120:123], a[76:79], a[56:59], v[120:123]
s_add_u32 m0, s59, 116480
s_mov_b32 s58, 786432
v_mfma_f32_16x16x32_bf16 v[160:163], a[76:79], a[60:63], v[160:163]
buffer_load_dwordx4 v5, s[24:27], s58 offen lds
v_mfma_f32_16x16x32_bf16 v[124:127], a[44:47], a[80:83], v[124:127]
ds_read_b64_tr_b16 a[32:33], v25 offset:1056
v_mfma_f32_16x16x32_bf16 v[128:131], a[48:51], a[80:83], v[128:131]
ds_read_b64_tr_b16 a[34:35], v25 offset:1568
v_mfma_f32_16x16x32_bf16 v[132:135], a[52:55], a[80:83], v[132:135]
ds_read_b64_tr_b16 a[36:37], v25 offset:2048
v_mfma_f32_16x16x32_bf16 v[136:139], a[56:59], a[80:83], v[136:139]
buffer_load_dwordx4 v6, s[24:27], s58 offen offset:1024 lds
v_mfma_f32_16x16x32_bf16 v[140:143], a[44:47], a[84:87], v[140:143]
ds_read_b64_tr_b16 a[38:39], v25 offset:2560
v_mfma_f32_16x16x32_bf16 v[144:147], a[48:51], a[84:87], v[144:147]
ds_read_b64_tr_b16 a[40:41], v25 offset:2080
v_mfma_f32_16x16x32_bf16 v[148:151], a[52:55], a[84:87], v[148:151]
ds_read_b64_tr_b16 a[42:43], v25 offset:2592
v_mfma_f32_16x16x32_bf16 v[152:155], a[56:59], a[84:87], v[152:155]
s_waitcnt vmcnt(14) lgkmcnt(6)
s_barrier
v_mfma_f32_16x16x32_bf16 v[60:63], a[20:23], a[0:3], v[60:63]
ds_read_b128 a[44:47], v23 offset:9216
s_add_u32 m0, s59, 41600
s_mov_b32 s58, 1703936
v_mfma_f32_16x16x32_bf16 v[64:67], a[20:23], a[4:7], v[64:67]
buffer_load_dwordx4 v5, s[24:27], s58 offen lds
v_mfma_f32_16x16x32_bf16 v[68:71], a[20:23], a[8:11], v[68:71]
ds_read_b128 a[48:51], v23 offset:10240
v_mfma_f32_16x16x32_bf16 v[72:75], a[20:23], a[12:15], v[72:75]
ds_read_b128 a[52:55], v23 offset:11520
v_mfma_f32_16x16x32_bf16 v[76:79], a[24:27], a[0:3], v[76:79]
ds_read_b128 a[56:59], v23 offset:12544
v_mfma_f32_16x16x32_bf16 v[80:83], a[24:27], a[4:7], v[80:83]
buffer_load_dwordx4 v6, s[24:27], s58 offen offset:1024 lds
v_mfma_f32_16x16x32_bf16 v[84:87], a[24:27], a[8:11], v[84:87]
ds_read_b64_tr_b16 a[64:65], v25 offset:12416
v_mfma_f32_16x16x32_bf16 v[88:91], a[24:27], a[12:15], v[88:91]
ds_read_b64_tr_b16 a[66:67], v25 offset:12928
v_mfma_f32_16x16x32_bf16 v[92:95], a[28:31], a[0:3], v[92:95]
s_add_u32 m0, s59, 49920
s_mov_b32 s58, 1835008
v_mfma_f32_16x16x32_bf16 v[96:99], a[28:31], a[4:7], v[96:99]
buffer_load_dwordx4 v5, s[24:27], s58 offen lds
v_mfma_f32_16x16x32_bf16 v[100:103], a[28:31], a[8:11], v[100:103]
ds_read_b64_tr_b16 a[68:69], v25 offset:12448
s_waitcnt lgkmcnt(7)
v_mfma_f32_16x16x32_bf16 v[104:107], a[28:31], a[12:15], v[104:107]
ds_read_b64_tr_b16 a[70:71], v25 offset:12960
v_mfma_f32_16x16x32_bf16 v[156:159], a[28:31], a[16:19], v[156:159]
ds_read_b128 a[60:63], v24 offset:11264
v_mfma_f32_16x16x32_bf16 v[108:111], a[32:35], a[0:3], v[108:111]
buffer_load_dwordx4 v6, s[24:27], s58 offen offset:1024 lds
v_mfma_f32_16x16x32_bf16 v[112:115], a[32:35], a[4:7], v[112:115]
ds_read_b64_tr_b16 a[72:73], v25 offset:13440
v_mfma_f32_16x16x32_bf16 v[116:119], a[32:35], a[8:11], v[116:119]
ds_read_b64_tr_b16 a[74:75], v25 offset:13952
v_mfma_f32_16x16x32_bf16 v[120:123], a[32:35], a[12:15], v[120:123]
s_add_u32 m0, s59, 124800
s_mov_b32 s58, 917504
v_mfma_f32_16x16x32_bf16 v[160:163], a[32:35], a[16:19], v[160:163]
buffer_load_dwordx4 v5, s[24:27], s58 offen lds
v_mfma_f32_16x16x32_bf16 v[124:127], a[0:3], a[36:39], v[124:127]
ds_read_b64_tr_b16 a[76:77], v25 offset:13472
v_mfma_f32_16x16x32_bf16 v[128:131], a[4:7], a[36:39], v[128:131]
ds_read_b64_tr_b16 a[78:79], v25 offset:13984
v_mfma_f32_16x16x32_bf16 v[132:135], a[8:11], a[36:39], v[132:135]
ds_read_b64_tr_b16 a[80:81], v25 offset:14464
v_mfma_f32_16x16x32_bf16 v[136:139], a[12:15], a[36:39], v[136:139]
buffer_load_dwordx4 v6, s[24:27], s58 offen offset:1024 lds
v_mfma_f32_16x16x32_bf16 v[140:143], a[0:3], a[40:43], v[140:143]
ds_read_b64_tr_b16 a[82:83], v25 offset:14976
v_mfma_f32_16x16x32_bf16 v[144:147], a[4:7], a[40:43], v[144:147]
ds_read_b64_tr_b16 a[84:85], v25 offset:14496
v_mfma_f32_16x16x32_bf16 v[148:151], a[8:11], a[40:43], v[148:151]
ds_read_b64_tr_b16 a[86:87], v25 offset:15008
v_mfma_f32_16x16x32_bf16 v[152:155], a[12:15], a[40:43], v[152:155]
s_waitcnt lgkmcnt(0)
s_barrier
v_mfma_f32_16x16x32_bf16 v[156:159], a[72:75], a[60:63], v[156:159]
ds_read_b128 v[232:235], v10 offset:768
s_add_u32 m0, s59, 66560
v_mfma_f32_16x16x32_bf16 v[160:163], a[76:79], a[60:63], v[160:163]
ds_read_b128 v[236:239], v10 offset:2816
s_mov_b32 s58, 0
v_mfma_f32_16x16x32_bf16 v[104:107], a[72:75], a[56:59], v[104:107]
ds_read_b128 v[228:231], v10 offset:512
v_mfma_f32_16x16x32_bf16 v[120:123], a[76:79], a[56:59], v[120:123]
ds_read_b128 v[224:227], v10 offset:256
v_mfma_f32_16x16x32_bf16 v[136:139], a[56:59], a[80:83], v[136:139]
ds_read_b128 v[220:223], v10
v_mfma_f32_16x16x32_bf16 v[152:155], a[56:59], a[84:87], v[152:155]
ds_read_b128 v[240:243], v11 offset:192
v_mfma_f32_16x16x32_bf16 v[100:103], a[72:75], a[52:55], v[100:103]
ds_read_b128 v[244:247], v11 offset:1216
v_mfma_f32_16x16x32_bf16 v[116:119], a[76:79], a[52:55], v[116:119]
buffer_load_dwordx4 v5, s[24:27], s58 offen lds
v_mfma_f32_16x16x32_bf16 v[96:99], a[72:75], a[48:51], v[96:99]
ds_read_b128 v[18:21], v11 offset:128
ds_read_b128 v[22:25], v11 offset:1152
s_waitcnt lgkmcnt(8)
v_pk_fma_f32 v[104:105], v[36:37], v[232:233], v[104:105] op_sel_hi:[1,0,1]
v_pk_mul_f32 v[104:105], v[104:105], v[232:233] op_sel:[0,1] op_sel_hi:[1,1]
v_pk_fma_f32 v[106:107], v[38:39], v[232:233], v[106:107] op_sel_hi:[1,0,1]
v_pk_mul_f32 v[106:107], v[106:107], v[232:233] op_sel:[0,1] op_sel_hi:[1,1]
v_pk_fma_f32 v[120:121], v[40:41], v[232:233], v[120:121] op_sel_hi:[1,0,1]
v_pk_mul_f32 v[120:121], v[120:121], v[232:233] op_sel:[0,1] op_sel_hi:[1,1]
v_pk_fma_f32 v[122:123], v[42:43], v[232:233], v[122:123] op_sel_hi:[1,0,1]
v_pk_mul_f32 v[122:123], v[122:123], v[232:233] op_sel:[0,1] op_sel_hi:[1,1]
s_waitcnt lgkmcnt(6)
v_pk_fma_f32 v[100:101], v[36:37], v[228:229], v[100:101] op_sel_hi:[1,0,1]
v_pk_mul_f32 v[100:101], v[100:101], v[228:229] op_sel:[0,1] op_sel_hi:[1,1]
v_pk_fma_f32 v[102:103], v[38:39], v[228:229], v[102:103] op_sel_hi:[1,0,1]
v_pk_mul_f32 v[102:103], v[102:103], v[228:229] op_sel:[0,1] op_sel_hi:[1,1]
v_pk_fma_f32 v[116:117], v[40:41], v[228:229], v[116:117] op_sel_hi:[1,0,1]
v_pk_mul_f32 v[116:117], v[116:117], v[228:229] op_sel:[0,1] op_sel_hi:[1,1]
s_waitcnt lgkmcnt(3)
v_pk_fma_f32 v[136:137], v[240:241], v[44:45], v[136:137] op_sel_hi:[1,0,1]
v_pk_fma_f32 v[138:139], v[242:243], v[44:45], v[138:139] op_sel_hi:[1,0,1]
v_pk_fma_f32 v[152:153], v[240:241], v[44:45], v[152:153] op_sel:[0,1,0] op_sel_hi:[1,1,1]
v_pk_fma_f32 v[154:155], v[242:243], v[44:45], v[154:155] op_sel:[0,1,0] op_sel_hi:[1,1,1]
s_waitcnt lgkmcnt(2)
v_pk_mul_f32 v[136:137], v[136:137], v[244:245]
v_pk_mul_f32 v[138:139], v[138:139], v[246:247]
v_pk_mul_f32 v[152:153], v[152:153], v[244:245]
v_pk_mul_f32 v[154:155], v[154:155], v[246:247]
v_pk_fma_f32 v[118:119], v[42:43], v[228:229], v[118:119] op_sel_hi:[1,0,1]
v_pk_mul_f32 v[118:119], v[118:119], v[228:229] op_sel:[0,1] op_sel_hi:[1,1]
v_pk_fma_f32 v[96:97], v[36:37], v[224:225], v[96:97] op_sel_hi:[1,0,1]
v_pk_mul_f32 v[96:97], v[96:97], v[224:225] op_sel:[0,1] op_sel_hi:[1,1]
v_pk_fma_f32 v[98:99], v[38:39], v[224:225], v[98:99] op_sel_hi:[1,0,1]
v_pk_mul_f32 v[98:99], v[98:99], v[224:225] op_sel:[0,1] op_sel_hi:[1,1]
v_pk_fma_f32 v[156:157], v[36:37], v[236:237], v[156:157] op_sel_hi:[1,0,1]
v_pk_mul_f32 v[156:157], v[156:157], v[236:237] op_sel:[0,1] op_sel_hi:[1,1]
v_pk_fma_f32 v[158:159], v[38:39], v[236:237], v[158:159] op_sel_hi:[1,0,1]
v_pk_mul_f32 v[158:159], v[158:159], v[236:237] op_sel:[0,1] op_sel_hi:[1,1]
v_pk_fma_f32 v[160:161], v[40:41], v[236:237], v[160:161] op_sel_hi:[1,0,1]
v_pk_mul_f32 v[160:161], v[160:161], v[236:237] op_sel:[0,1] op_sel_hi:[1,1]
v_pk_fma_f32 v[162:163], v[42:43], v[236:237], v[162:163] op_sel_hi:[1,0,1]
v_pk_mul_f32 v[162:163], v[162:163], v[236:237] op_sel:[0,1] op_sel_hi:[1,1]
v_cvt_pk_bf16_f32 v196, v104, v105
v_cvt_pk_bf16_f32 v197, v106, v107
v_mfma_f32_16x16x32_bf16 v[112:115], a[76:79], a[48:51], v[112:115]
buffer_load_dwordx4 v6, s[24:27], s58 offen offset:1024 lds
v_mfma_f32_16x16x32_bf16 v[92:95], a[72:75], a[44:47], v[92:95]
s_add_u32 m0, s59, 0
v_cvt_pk_bf16_f32 v198, v120, v121
v_cvt_pk_bf16_f32 v199, v122, v123
v_mfma_f32_16x16x32_bf16 v[108:111], a[76:79], a[44:47], v[108:111]
ds_write_b128 v8, v[196:199]
v_cvt_pk_bf16_f32 v208, v136, v137
v_mfma_f32_16x16x32_bf16 v[72:75], a[64:67], a[56:59], v[72:75]
s_mov_b32 s58, 1048576
v_cvt_pk_bf16_f32 v209, v138, v139
v_cvt_pk_bf16_f32 v218, v152, v153
v_mfma_f32_16x16x32_bf16 v[88:91], a[68:71], a[56:59], v[88:91]
ds_write_b64 v8, v[208:209] offset:1024
v_cvt_pk_bf16_f32 v219, v154, v155
ds_write_b64 v8, v[218:219] offset:1032
v_cvt_pk_bf16_f32 v192, v100, v101
v_pk_fma_f32 v[72:73], v[28:29], v[232:233], v[72:73] op_sel_hi:[1,0,1]
v_pk_fma_f32 v[74:75], v[30:31], v[232:233], v[74:75] op_sel_hi:[1,0,1]
s_nop 1
v_pk_fma_f32 v[88:89], v[32:33], v[232:233], v[88:89] op_sel_hi:[1,0,1]
v_pk_fma_f32 v[90:91], v[34:35], v[232:233], v[90:91] op_sel_hi:[1,0,1]
v_pk_fma_f32 v[112:113], v[40:41], v[224:225], v[112:113] op_sel_hi:[1,0,1]
v_pk_mul_f32 v[112:113], v[112:113], v[224:225] op_sel:[0,1] op_sel_hi:[1,1]
v_pk_fma_f32 v[114:115], v[42:43], v[224:225], v[114:115] op_sel_hi:[1,0,1]
v_pk_mul_f32 v[114:115], v[114:115], v[224:225] op_sel:[0,1] op_sel_hi:[1,1]
v_pk_fma_f32 v[92:93], v[36:37], v[220:221], v[92:93] op_sel_hi:[1,0,1]
v_pk_mul_f32 v[92:93], v[92:93], v[220:221] op_sel:[0,1] op_sel_hi:[1,1]
v_pk_fma_f32 v[94:95], v[38:39], v[220:221], v[94:95] op_sel_hi:[1,0,1]
v_pk_mul_f32 v[94:95], v[94:95], v[220:221] op_sel:[0,1] op_sel_hi:[1,1]
v_pk_fma_f32 v[108:109], v[40:41], v[220:221], v[108:109] op_sel_hi:[1,0,1]
v_pk_mul_f32 v[108:109], v[108:109], v[220:221] op_sel:[0,1] op_sel_hi:[1,1]
v_pk_fma_f32 v[110:111], v[42:43], v[220:221], v[110:111] op_sel_hi:[1,0,1]
v_pk_mul_f32 v[110:111], v[110:111], v[220:221] op_sel:[0,1] op_sel_hi:[1,1]
v_cvt_pk_bf16_f32 v193, v102, v103
v_cvt_pk_bf16_f32 v194, v116, v117
v_mfma_f32_16x16x32_bf16 v[132:135], a[52:55], a[80:83], v[132:135]
buffer_load_dwordx4 v5, s[24:27], s58 offen lds
v_mfma_f32_16x16x32_bf16 v[148:151], a[52:55], a[84:87], v[148:151]
ds_read_b128 v[240:243], v11 offset:64
v_cvt_pk_bf16_f32 v195, v118, v119
v_mfma_f32_16x16x32_bf16 v[68:71], a[64:67], a[52:55], v[68:71]
ds_read_b128 v[244:247], v11 offset:1088
s_waitcnt lgkmcnt(2)
s_barrier
v_mfma_f32_16x16x32_bf16 v[84:87], a[68:71], a[52:55], v[84:87]
ds_read_b64 v[200:201], v9 offset:1024
v_cvt_pk_bf16_f32 v176, v72, v73
v_mfma_f32_16x16x32_bf16 v[128:131], a[48:51], a[80:83], v[128:131]
ds_read_b64 v[210:211], v9 offset:1032
buffer_load_dwordx4 v6, s[24:27], s58 offen offset:1024 lds
s_add_u32 m0, s59, 8320
v_pk_fma_f32 v[132:133], v[18:19], v[44:45], v[132:133] op_sel_hi:[1,0,1]
v_pk_mul_f32 v[132:133], v[132:133], v[22:23]
v_pk_fma_f32 v[134:135], v[20:21], v[44:45], v[134:135] op_sel_hi:[1,0,1]
v_pk_mul_f32 v[134:135], v[134:135], v[24:25]
v_pk_fma_f32 v[148:149], v[18:19], v[44:45], v[148:149] op_sel:[0,1,0] op_sel_hi:[1,1,1]
v_pk_mul_f32 v[148:149], v[148:149], v[22:23]
v_pk_fma_f32 v[150:151], v[20:21], v[44:45], v[150:151] op_sel:[0,1,0] op_sel_hi:[1,1,1]
v_pk_mul_f32 v[150:151], v[150:151], v[24:25]
v_pk_fma_f32 v[68:69], v[28:29], v[228:229], v[68:69] op_sel_hi:[1,0,1]
v_pk_fma_f32 v[70:71], v[30:31], v[228:229], v[70:71] op_sel_hi:[1,0,1]
v_pk_fma_f32 v[84:85], v[32:33], v[228:229], v[84:85] op_sel_hi:[1,0,1]
v_pk_fma_f32 v[86:87], v[34:35], v[228:229], v[86:87] op_sel_hi:[1,0,1]
s_mov_b32 s58, 1179648
v_cvt_pk_bf16_f32 v177, v74, v75
v_mfma_f32_16x16x32_bf16 v[144:147], a[48:51], a[84:87], v[144:147]
buffer_load_dwordx4 v5, s[24:27], s58 offen lds
v_mfma_f32_16x16x32_bf16 v[64:67], a[64:67], a[48:51], v[64:67]
ds_read_b128 v[18:21], v11
v_cvt_pk_bf16_f32 v178, v88, v89
v_mfma_f32_16x16x32_bf16 v[80:83], a[68:71], a[48:51], v[80:83]
ds_read_b128 v[22:25], v11 offset:1024
v_cvt_pk_bf16_f32 v179, v90, v91
v_mfma_f32_16x16x32_bf16 v[124:127], a[44:47], a[80:83], v[124:127]
v_cvt_pk_bf16_f32 v206, v132, v133
v_cvt_pk_bf16_f32 v207, v134, v135
v_cvt_pk_bf16_f32 v216, v148, v149
v_cvt_pk_bf16_f32 v217, v150, v151
v_cvt_pk_bf16_f32 v188, v96, v97
s_waitcnt lgkmcnt(5)
v_pk_fma_f32 v[128:129], v[240:241], v[44:45], v[128:129] op_sel_hi:[1,0,1]
s_waitcnt lgkmcnt(4)
v_pk_mul_f32 v[128:129], v[128:129], v[244:245]
v_pk_fma_f32 v[130:131], v[242:243], v[44:45], v[130:131] op_sel_hi:[1,0,1]
v_pk_mul_f32 v[130:131], v[130:131], v[246:247]
v_pk_fma_f32 v[144:145], v[240:241], v[44:45], v[144:145] op_sel:[0,1,0] op_sel_hi:[1,1,1]
v_pk_mul_f32 v[144:145], v[144:145], v[244:245]
v_pk_fma_f32 v[146:147], v[242:243], v[44:45], v[146:147] op_sel:[0,1,0] op_sel_hi:[1,1,1]
v_pk_mul_f32 v[146:147], v[146:147], v[246:247]
v_pk_fma_f32 v[64:65], v[28:29], v[224:225], v[64:65] op_sel_hi:[1,0,1]
v_pk_fma_f32 v[66:67], v[30:31], v[224:225], v[66:67] op_sel_hi:[1,0,1]
v_pk_fma_f32 v[80:81], v[32:33], v[224:225], v[80:81] op_sel_hi:[1,0,1]
v_pk_fma_f32 v[82:83], v[34:35], v[224:225], v[82:83] op_sel_hi:[1,0,1]
v_cvt_pk_bf16_f32 v189, v98, v99
v_cvt_pk_bf16_f32 v190, v112, v113
v_mfma_f32_16x16x32_bf16 v[140:143], a[44:47], a[84:87], v[140:143]
buffer_load_dwordx4 v6, s[24:27], s58 offen offset:1024 lds
v_mfma_f32_16x16x32_bf16 v[60:63], a[64:67], a[44:47], v[60:63]
s_add_u32 m0, s59, 16640
s_mov_b32 s58, 1310720
v_cvt_pk_bf16_f32 v191, v114, v115
v_mfma_f32_16x16x32_bf16 v[76:79], a[68:71], a[44:47], v[76:79]
v_cvt_pk_bf16_f32 v172, v68, v69
v_cvt_pk_bf16_f32 v173, v70, v71
v_mfma_f32_16x16x32_bf16 v[104:107], v[192:195], v[176:179], v[46:49]
v_cvt_pk_bf16_f32 v174, v84, v85
v_cvt_pk_bf16_f32 v175, v86, v87
v_cvt_pk_bf16_f32 v204, v128, v129
v_cvt_pk_bf16_f32 v205, v130, v131
v_cvt_pk_bf16_f32 v214, v144, v145
s_waitcnt lgkmcnt(1)
v_pk_fma_f32 v[124:125], v[18:19], v[44:45], v[124:125] op_sel_hi:[1,0,1]
s_waitcnt lgkmcnt(0)
v_pk_mul_f32 v[124:125], v[124:125], v[22:23]
v_pk_fma_f32 v[126:127], v[20:21], v[44:45], v[126:127] op_sel_hi:[1,0,1]
v_pk_mul_f32 v[126:127], v[126:127], v[24:25]
v_pk_fma_f32 v[140:141], v[18:19], v[44:45], v[140:141] op_sel:[0,1,0] op_sel_hi:[1,1,1]
v_pk_mul_f32 v[140:141], v[140:141], v[22:23]
v_pk_fma_f32 v[142:143], v[20:21], v[44:45], v[142:143] op_sel:[0,1,0] op_sel_hi:[1,1,1]
v_pk_mul_f32 v[142:143], v[142:143], v[24:25]
v_pk_fma_f32 v[60:61], v[28:29], v[220:221], v[60:61] op_sel_hi:[1,0,1]
v_pk_fma_f32 v[62:63], v[30:31], v[220:221], v[62:63] op_sel_hi:[1,0,1]
v_pk_fma_f32 v[76:77], v[32:33], v[220:221], v[76:77] op_sel_hi:[1,0,1]
v_pk_fma_f32 v[78:79], v[34:35], v[220:221], v[78:79] op_sel_hi:[1,0,1]
v_max3_f32 v88, v104, v105, v106
v_cvt_pk_bf16_f32 v215, v146, v147
v_mfma_f32_16x16x32_bf16 v[120:123], v[196:199], v[176:179], v[50:53]
buffer_load_dwordx4 v5, s[24:27], s58 offen lds
v_mfma_f32_16x16x32_bf16 v[100:103], v[188:191], v[172:175], v[46:49]
v_cvt_pk_bf16_f32 v184, v92, v93
v_cvt_pk_bf16_f32 v185, v94, v95
v_mfma_f32_16x16x32_bf16 v[116:119], v[192:195], v[172:175], v[50:53]
s_nop 2
v_max3_f32 v89, v107, v120, v121
v_max3_f32 v88, v88, v122, v123
.Lpad20:
s_cbranch_execz .Lpad23
v_max_f32 v90, v88, v89
v_max_f32 v89, v88, v89
v_max3_f32 v84, v100, v101, v102
v_cvt_pk_bf16_f32 v186, v108, v109
v_permlane16_swap_b32 v90, v89
v_max3_f32 v85, v103, v116, v117
buffer_load_dwordx4 v6, s[24:27], s58 offen offset:1024 lds
s_add_u32 m0, s59, 74880
s_mov_b32 s58, 131072
v_max_f32 v88, v90, v89
v_max_f32 v89, v90, v89
v_max3_f32 v84, v84, v118, v119
v_max_f32 v86, v84, v85
v_permlane32_swap_b32 v88, v89
v_max_f32 v85, v84, v85
v_max_f32 v88, v88, v89
v_mul_f32 v88, v88, v234
v_pk_fma_f32 v[104:105], v[104:105], v[234:235], v[88:89] op_sel_hi:[1,0,0] neg_lo:[0,0,1] neg_hi:[0,0,1]
v_pk_fma_f32 v[106:107], v[106:107], v[234:235], v[88:89] op_sel_hi:[1,0,0] neg_lo:[0,0,1] neg_hi:[0,0,1]
buffer_load_dwordx4 v5, s[24:27], s58 offen lds
v_pk_fma_f32 v[120:121], v[120:121], v[234:235], v[88:89] op_sel_hi:[1,0,0] neg_lo:[0,0,1] neg_hi:[0,0,1]
v_pk_fma_f32 v[122:123], v[122:123], v[234:235], v[88:89] op_sel_hi:[1,0,0] neg_lo:[0,0,1] neg_hi:[0,0,1]
v_exp_f32 v104, v104
v_exp_f32 v105, v105
v_exp_f32 v106, v106
v_exp_f32 v107, v107
v_exp_f32 v120, v120
v_exp_f32 v121, v121
v_exp_f32 v122, v122
v_exp_f32 v123, v123
v_cvt_pk_bf16_f32 v72, v104, v105
buffer_load_dwordx4 v6, s[24:27], s58 offen offset:1024 lds
s_add_u32 m0, s59, 83200
s_mov_b32 s58, 262144
v_cvt_pk_bf16_f32 v73, v106, v107
v_cvt_pk_bf16_f32 v74, v120, v121
v_cvt_pk_bf16_f32 v75, v122, v123
v_permlane16_swap_b32 v86, v85
s_nop 0
v_mfma_f32_16x16x32_bf16 v[88:91], v[248:251], v[72:75], 0
v_max_f32 v84, v86, v85
v_max_f32 v85, v86, v85
v_mfma_f32_16x16x32_bf16 v[104:107], v[206:209], v[72:75], 0
s_nop 0
v_permlane32_swap_b32 v84, v85
v_mfma_f32_16x16x32_bf16 v[120:123], v[216:219], v[72:75], 0
buffer_load_dwordx4 v5, s[24:27], s58 offen lds
s_nop 0
v_rcp_f32 v88, v88
v_max_f32 v84, v84, v85
s_nop 0
v_pk_mul_f32 v[104:105], v[104:105], v[88:89] op_sel_hi:[1,0]
v_pk_mul_f32 v[106:107], v[106:107], v[88:89] op_sel_hi:[1,0]
s_nop 0
v_pk_mul_f32 v[120:121], v[120:121], v[88:89] op_sel_hi:[1,0]
v_pk_mul_f32 v[122:123], v[122:123], v[88:89] op_sel_hi:[1,0]
v_cvt_pk_bf16_f32 v176, v104, v105
v_cvt_pk_bf16_f32 v177, v106, v107
v_cvt_pk_bf16_f32 v178, v120, v121
v_cvt_pk_bf16_f32 v179, v122, v123
v_mul_f32 v84, v84, v230
v_pk_fma_f32 v[100:101], v[100:101], v[230:231], v[84:85] op_sel_hi:[1,0,0] neg_lo:[0,0,1] neg_hi:[0,0,1]
buffer_load_dwordx4 v6, s[24:27], s58 offen offset:1024 lds
v_pk_fma_f32 v[102:103], v[102:103], v[230:231], v[84:85] op_sel_hi:[1,0,0] neg_lo:[0,0,1] neg_hi:[0,0,1]
v_pk_fma_f32 v[116:117], v[116:117], v[230:231], v[84:85] op_sel_hi:[1,0,0] neg_lo:[0,0,1] neg_hi:[0,0,1]
v_pk_fma_f32 v[118:119], v[118:119], v[230:231], v[84:85] op_sel_hi:[1,0,0] neg_lo:[0,0,1] neg_hi:[0,0,1]
v_exp_f32 v100, v100
v_exp_f32 v101, v101
v_exp_f32 v102, v102
v_exp_f32 v103, v103
v_exp_f32 v116, v116
v_exp_f32 v117, v117
v_exp_f32 v118, v118
v_exp_f32 v119, v119
v_cvt_pk_bf16_f32 v68, v100, v101
buffer_store_dwordx4 v[176:179], v4, s[16:19], s74 offen offset:3072 sc1
v_cvt_pk_bf16_f32 v69, v102, v103
v_cvt_pk_bf16_f32 v70, v116, v117
v_cvt_pk_bf16_f32 v71, v118, v119
v_cvt_pk_bf16_f32 v187, v110, v111
v_cvt_pk_bf16_f32 v168, v64, v65
v_mfma_f32_16x16x32_bf16 v[84:87], v[248:251], v[68:71], 0
v_cvt_pk_bf16_f32 v169, v66, v67
v_cvt_pk_bf16_f32 v170, v80, v81
v_mfma_f32_16x16x32_bf16 v[100:103], v[204:207], v[68:71], 0
v_cvt_pk_bf16_f32 v171, v82, v83
v_cvt_pk_bf16_f32 v202, v124, v125
v_mfma_f32_16x16x32_bf16 v[116:119], v[214:217], v[68:71], 0
s_nop 1
v_rcp_f32 v84, v84
v_mfma_f32_16x16x32_bf16 v[96:99], v[184:187], v[168:171], v[46:49]
v_cvt_pk_bf16_f32 v203, v126, v127
v_cvt_pk_bf16_f32 v212, v140, v141
v_mfma_f32_16x16x32_bf16 v[112:115], v[188:191], v[168:171], v[50:53]
v_cvt_pk_bf16_f32 v213, v142, v143
v_cvt_pk_bf16_f32 v180, v156, v157
v_cvt_pk_bf16_f32 v181, v158, v159
s_nop 1
v_max3_f32 v80, v96, v97, v98
v_cvt_pk_bf16_f32 v182, v160, v161
v_pk_mul_f32 v[100:101], v[100:101], v[84:85] op_sel_hi:[1,0]
v_pk_mul_f32 v[102:103], v[102:103], v[84:85] op_sel_hi:[1,0]
v_pk_mul_f32 v[116:117], v[116:117], v[84:85] op_sel_hi:[1,0]
v_pk_mul_f32 v[118:119], v[118:119], v[84:85] op_sel_hi:[1,0]
v_cvt_pk_bf16_f32 v172, v100, v101
v_cvt_pk_bf16_f32 v173, v102, v103
v_cvt_pk_bf16_f32 v174, v116, v117
v_cvt_pk_bf16_f32 v175, v118, v119
buffer_store_dwordx4 v[172:175], v4, s[16:19], s74 offen offset:2048 sc1
v_max3_f32 v81, v99, v112, v113
v_max3_f32 v80, v80, v114, v115
v_max_f32 v82, v80, v81
v_max_f32 v81, v80, v81
v_cvt_pk_bf16_f32 v183, v162, v163
v_cvt_pk_bf16_f32 v164, v60, v61
v_permlane16_swap_b32 v82, v81
v_cvt_pk_bf16_f32 v165, v62, v63
v_max_f32 v80, v82, v81
v_max_f32 v81, v82, v81
v_cvt_pk_bf16_f32 v166, v76, v77
v_cvt_pk_bf16_f32 v167, v78, v79
v_permlane32_swap_b32 v80, v81
s_nop 0
v_mfma_f32_16x16x32_bf16 v[92:95], v[180:183], v[164:167], v[54:57]
v_max_f32 v80, v80, v81
v_mul_f32 v80, v80, v226
v_mfma_f32_16x16x32_bf16 v[108:111], v[184:187], v[164:167], v[50:53]
s_nop 4
v_max3_f32 v76, v92, v93, v94
v_pk_fma_f32 v[96:97], v[96:97], v[226:227], v[80:81] op_sel_hi:[1,0,0] neg_lo:[0,0,1] neg_hi:[0,0,1]
v_pk_fma_f32 v[98:99], v[98:99], v[226:227], v[80:81] op_sel_hi:[1,0,0] neg_lo:[0,0,1] neg_hi:[0,0,1]
v_pk_fma_f32 v[112:113], v[112:113], v[226:227], v[80:81] op_sel_hi:[1,0,0] neg_lo:[0,0,1] neg_hi:[0,0,1]
v_pk_fma_f32 v[114:115], v[114:115], v[226:227], v[80:81] op_sel_hi:[1,0,0] neg_lo:[0,0,1] neg_hi:[0,0,1]
v_exp_f32 v96, v96
v_exp_f32 v97, v97
v_exp_f32 v98, v98
v_exp_f32 v99, v99
v_exp_f32 v112, v112
v_exp_f32 v113, v113
v_exp_f32 v114, v114
v_exp_f32 v115, v115
v_cvt_pk_bf16_f32 v64, v96, v97
v_cvt_pk_bf16_f32 v65, v98, v99
v_cvt_pk_bf16_f32 v66, v112, v113
v_cvt_pk_bf16_f32 v67, v114, v115
v_max3_f32 v77, v95, v108, v109
v_max3_f32 v76, v76, v110, v111
v_mfma_f32_16x16x32_bf16 v[80:83], v[248:251], v[64:67], 0
v_max_f32 v78, v76, v77
v_max_f32 v77, v76, v77
v_mfma_f32_16x16x32_bf16 v[96:99], v[202:205], v[64:67], 0
s_nop 0
v_permlane16_swap_b32 v78, v77
v_mfma_f32_16x16x32_bf16 v[112:115], v[212:215], v[64:67], 0
s_nop 1
v_rcp_f32 v80, v80
v_max_f32 v76, v78, v77
v_max_f32 v77, v78, v77
v_pk_mul_f32 v[96:97], v[96:97], v[80:81] op_sel_hi:[1,0]
v_pk_mul_f32 v[98:99], v[98:99], v[80:81] op_sel_hi:[1,0]
s_nop 0
v_pk_mul_f32 v[112:113], v[112:113], v[80:81] op_sel_hi:[1,0]
v_pk_mul_f32 v[114:115], v[114:115], v[80:81] op_sel_hi:[1,0]
v_cvt_pk_bf16_f32 v168, v96, v97
v_cvt_pk_bf16_f32 v169, v98, v99
v_cvt_pk_bf16_f32 v170, v112, v113
v_cvt_pk_bf16_f32 v171, v114, v115
buffer_store_dwordx4 v[168:171], v4, s[16:19], s74 offen offset:1024 sc1
v_permlane32_swap_b32 v76, v77
v_max_f32 v76, v76, v77
v_mul_f32 v76, v76, v222
v_pk_fma_f32 v[92:93], v[92:93], v[222:223], v[76:77] op_sel_hi:[1,0,0] neg_lo:[0,0,1] neg_hi:[0,0,1]
v_pk_fma_f32 v[94:95], v[94:95], v[222:223], v[76:77] op_sel_hi:[1,0,0] neg_lo:[0,0,1] neg_hi:[0,0,1]
v_pk_fma_f32 v[108:109], v[108:109], v[222:223], v[76:77] op_sel_hi:[1,0,0] neg_lo:[0,0,1] neg_hi:[0,0,1]
v_pk_fma_f32 v[110:111], v[110:111], v[222:223], v[76:77] op_sel_hi:[1,0,0] neg_lo:[0,0,1] neg_hi:[0,0,1]
v_exp_f32 v92, v92
v_exp_f32 v93, v93
v_exp_f32 v94, v94
v_exp_f32 v95, v95
v_exp_f32 v108, v108
v_exp_f32 v109, v109
v_exp_f32 v110, v110
v_exp_f32 v111, v111
v_cvt_pk_bf16_f32 v60, v92, v93
v_cvt_pk_bf16_f32 v61, v94, v95
v_cvt_pk_bf16_f32 v62, v108, v109
v_cvt_pk_bf16_f32 v63, v110, v111
s_nop 1
v_mfma_f32_16x16x32_bf16 v[76:79], v[248:251], v[60:63], 0
v_mfma_f32_16x16x32_bf16 v[92:95], v[200:203], v[60:63], 0
v_mfma_f32_16x16x32_bf16 v[108:111], v[210:213], v[60:63], 0
s_nop 5
v_rcp_f32 v76, v76
s_nop 0
v_pk_mul_f32 v[92:93], v[92:93], v[76:77] op_sel_hi:[1,0]
v_pk_mul_f32 v[94:95], v[94:95], v[76:77] op_sel_hi:[1,0]
v_pk_mul_f32 v[108:109], v[108:109], v[76:77] op_sel_hi:[1,0]
v_pk_mul_f32 v[110:111], v[110:111], v[76:77] op_sel_hi:[1,0]
v_cvt_pk_bf16_f32 v164, v92, v93
v_cvt_pk_bf16_f32 v165, v94, v95
v_cvt_pk_bf16_f32 v166, v108, v109
v_cvt_pk_bf16_f32 v167, v110, v111
buffer_store_dwordx4 v[164:167], v4, s[16:19], s74 offen sc1
s_nop 1
s_branch .Lqkve43
.Lqkv42:
.Lpad21:
s_cbranch_execz .Lpad24
s_add_u32 m0, s55, 0
s_nop 0
buffer_load_dwordx4 v21, s[16:19], s52 offen sc1 lds
buffer_load_dwordx4 v21, s[16:19], s52 offen offset:1024 sc1 lds
buffer_load_dword v22, s[16:19], s52 offen offset:2048 sc1 lds
s_add_u32 s52, s52, 0x20000
s_add_u32 m0, s55, 9216
s_nop 0
buffer_load_dwordx4 v21, s[16:19], s52 offen sc1 lds
buffer_load_dwordx4 v21, s[16:19], s52 offen offset:1024 sc1 lds
buffer_load_dword v22, s[16:19], s52 offen offset:2048 sc1 lds
s_add_u32 s52, s52, 0x20000
s_add_u32 m0, s55, 18432
s_nop 0
buffer_load_dwordx4 v21, s[16:19], s52 offen sc1 lds
buffer_load_dwordx4 v21, s[16:19], s52 offen offset:1024 sc1 lds
buffer_load_dword v22, s[16:19], s52 offen offset:2048 sc1 lds
s_add_u32 s52, s52, 0x20000
s_add_u32 m0, s55, 27648
s_nop 0
buffer_load_dwordx4 v21, s[16:19], s52 offen sc1 lds
buffer_load_dwordx4 v21, s[16:19], s52 offen offset:1024 sc1 lds
buffer_load_dword v22, s[16:19], s52 offen offset:2048 sc1 lds
s_add_u32 s52, s52, 0x20000
s_add_u32 m0, s55, 36864
s_nop 0
buffer_load_dwordx4 v21, s[16:19], s52 offen sc1 lds
buffer_load_dwordx4 v21, s[16:19], s52 offen offset:1024 sc1 lds
buffer_load_dword v22, s[16:19], s52 offen offset:2048 sc1 lds
s_add_u32 s52, s52, 0x20000
s_waitcnt vmcnt(12)
s_barrier
ds_read_b128 a[0:3], v23
ds_read_b128 a[4:7], v23 offset:1024
ds_read_b128 a[8:11], v23 offset:2304
ds_read_b128 a[12:15], v23 offset:3328
ds_read_b128 a[16:19], v24 offset:2048
s_waitcnt lgkmcnt(0)
s_mov_b32 s15, -4
.p2align 6
.Lk45:
s_waitcnt vmcnt(9) lgkmcnt(6)
s_barrier
v_mfma_f32_16x16x32_bf16 v[60:63], a[20:23], a[0:3], v[60:63]
ds_read_b128 a[44:47], v23 offset:9216
s_add_u32 m0, s56, 128640
v_mfma_f32_16x16x32_bf16 v[64:67], a[20:23], a[4:7], v[64:67]
buffer_load_dwordx4 v18, s[20:23], s54 offen lds
v_mfma_f32_16x16x32_bf16 v[68:71], a[20:23], a[8:11], v[68:71]
ds_read_b128 a[48:51], v23 offset:10240
v_add_f32 v164, v164, v168
v_mfma_f32_16x16x32_bf16 v[72:75], a[20:23], a[12:15], v[72:75]
ds_read_b128 a[52:55], v23 offset:11520
v_mfma_f32_16x16x32_bf16 v[76:79], a[24:27], a[0:3], v[76:79]
buffer_load_dwordx4 v19, s[20:23], s54 offen offset:1024 lds
v_mfma_f32_16x16x32_bf16 v[80:83], a[24:27], a[4:7], v[80:83]
ds_read_b128 a[56:59], v23 offset:12544
v_mfma_f32_16x16x32_bf16 v[84:87], a[24:27], a[8:11], v[84:87]
ds_read_b64_tr_b16 a[64:65], v25 offset:12416
v_add_f32 v165, v165, v169
v_mfma_f32_16x16x32_bf16 v[88:91], a[24:27], a[12:15], v[88:91]
buffer_load_dwordx4 v20, s[20:23], s54 offen offset:2048 lds
v_mfma_f32_16x16x32_bf16 v[92:95], a[28:31], a[0:3], v[92:95]
ds_read_b64_tr_b16 a[66:67], v25 offset:12928
s_add_u32 s54, s54, 196608
v_mfma_f32_16x16x32_bf16 v[96:99], a[28:31], a[4:7], v[96:99]
ds_read_b64_tr_b16 a[68:69], v25 offset:12448
v_mfma_f32_16x16x32_bf16 v[100:103], a[28:31], a[8:11], v[100:103]
s_add_u32 m0, s55, 46080
s_waitcnt lgkmcnt(7)
v_mfma_f32_16x16x32_bf16 v[104:107], a[28:31], a[12:15], v[104:107]
buffer_load_dwordx4 v21, s[16:19], s52 offen sc1 lds
v_mfma_f32_16x16x32_bf16 v[108:111], a[32:35], a[0:3], v[108:111]
ds_read_b64_tr_b16 a[70:71], v25 offset:12960
v_mfma_f32_16x16x32_bf16 v[112:115], a[32:35], a[4:7], v[112:115]
ds_read_b128 a[60:63], v24 offset:11264
v_add_f32 v166, v166, v170
v_mfma_f32_16x16x32_bf16 v[116:119], a[32:35], a[8:11], v[116:119]
buffer_load_dwordx4 v21, s[16:19], s52 offen offset:1024 sc1 lds
v_mfma_f32_16x16x32_bf16 v[120:123], a[32:35], a[12:15], v[120:123]
ds_read_b64_tr_b16 a[72:73], v25 offset:13440
v_mfma_f32_16x16x32_bf16 v[124:127], a[0:3], a[36:39], v[124:127]
ds_read_b64_tr_b16 a[74:75], v25 offset:13952
v_mfma_f32_16x16x32_bf16 v[128:131], a[4:7], a[36:39], v[128:131]
ds_read_b64_tr_b16 a[76:77], v25 offset:13472
v_add_f32 v167, v167, v171
v_mfma_f32_16x16x32_bf16 v[132:135], a[8:11], a[36:39], v[132:135]
buffer_load_dword v22, s[16:19], s52 offen offset:2048 sc1 lds
v_mfma_f32_16x16x32_bf16 v[136:139], a[12:15], a[36:39], v[136:139]
ds_read_b64_tr_b16 a[78:79], v25 offset:13984
s_add_u32 s52, s52, 0x20000
v_mfma_f32_16x16x32_bf16 v[156:159], a[16:19], a[36:39], v[156:159]
ds_read_b64_tr_b16 a[80:81], v25 offset:14464
v_mfma_f32_16x16x32_bf16 v[140:143], a[0:3], a[40:43], v[140:143]
buffer_load_dword v27, v14, s[20:23], s44 offen
v_mfma_f32_16x16x32_bf16 v[144:147], a[4:7], a[40:43], v[144:147]
ds_read_b64_tr_b16 a[82:83], v25 offset:14976
s_add_u32 s44, s44, 1572864
v_mfma_f32_16x16x32_bf16 v[148:151], a[8:11], a[40:43], v[148:151]
ds_read_b64_tr_b16 a[84:85], v25 offset:14496
v_mfma_f32_16x16x32_bf16 v[152:155], a[12:15], a[40:43], v[152:155]
ds_read_b64_tr_b16 a[86:87], v25 offset:15008
v_mfma_f32_16x16x32_bf16 v[160:163], a[16:19], a[40:43], v[160:163]
s_waitcnt vmcnt(13) lgkmcnt(6)
s_barrier
v_mfma_f32_16x16x32_bf16 v[60:63], a[64:67], a[44:47], v[60:63]
ds_read_b128 a[0:3], v23 offset:18432
s_add_u32 m0, s56, 66560
v_mfma_f32_16x16x32_bf16 v[64:67], a[64:67], a[48:51], v[64:67]
buffer_load_dwordx4 v18, s[20:23], s54 offen lds
v_mfma_f32_16x16x32_bf16 v[68:71], a[64:67], a[52:55], v[68:71]
ds_read_b128 a[4:7], v23 offset:19456
v_mfma_f32_16x16x32_bf16 v[72:75], a[64:67], a[56:59], v[72:75]
ds_read_b128 a[8:11], v23 offset:20736
v_mfma_f32_16x16x32_bf16 v[76:79], a[68:71], a[44:47], v[76:79]
buffer_load_dwordx4 v19, s[20:23], s54 offen offset:1024 lds
v_mfma_f32_16x16x32_bf16 v[80:83], a[68:71], a[48:51], v[80:83]
ds_read_b128 a[12:15], v23 offset:21760
v_mfma_f32_16x16x32_bf16 v[84:87], a[68:71], a[52:55], v[84:87]
ds_read_b64_tr_b16 a[20:21], v25 offset:24832
v_mfma_f32_16x16x32_bf16 v[88:91], a[68:71], a[56:59], v[88:91]
buffer_load_dwordx4 v20, s[20:23], s54 offen offset:2048 lds
v_mfma_f32_16x16x32_bf16 v[92:95], a[72:75], a[44:47], v[92:95]
ds_read_b64_tr_b16 a[22:23], v25 offset:25344
s_add_u32 s54, s54, 196608
v_mfma_f32_16x16x32_bf16 v[96:99], a[72:75], a[48:51], v[96:99]
ds_read_b64_tr_b16 a[24:25], v25 offset:24864
v_mfma_f32_16x16x32_bf16 v[100:103], a[72:75], a[52:55], v[100:103]
s_add_u32 m0, s55, 0
s_waitcnt lgkmcnt(7)
v_mfma_f32_16x16x32_bf16 v[104:107], a[72:75], a[56:59], v[104:107]
buffer_load_dwordx4 v21, s[16:19], s52 offen sc1 lds
v_mfma_f32_16x16x32_bf16 v[108:111], a[76:79], a[44:47], v[108:111]
ds_read_b64_tr_b16 a[26:27], v25 offset:25376
v_mfma_f32_16x16x32_bf16 v[112:115], a[76:79], a[48:51], v[112:115]
ds_read_b128 a[16:19], v24 offset:20480
v_mfma_f32_16x16x32_bf16 v[116:119], a[76:79], a[52:55], v[116:119]
buffer_load_dwordx4 v21, s[16:19], s52 offen offset:1024 sc1 lds
v_mfma_f32_16x16x32_bf16 v[120:123], a[76:79], a[56:59], v[120:123]
ds_read_b64_tr_b16 a[28:29], v25 offset:25856
v_mfma_f32_16x16x32_bf16 v[124:127], a[44:47], a[80:83], v[124:127]
ds_read_b64_tr_b16 a[30:31], v25 offset:26368
v_mfma_f32_16x16x32_bf16 v[128:131], a[48:51], a[80:83], v[128:131]
ds_read_b64_tr_b16 a[32:33], v25 offset:25888
v_mfma_f32_16x16x32_bf16 v[132:135], a[52:55], a[80:83], v[132:135]
buffer_load_dword v22, s[16:19], s52 offen offset:2048 sc1 lds
v_mfma_f32_16x16x32_bf16 v[136:139], a[56:59], a[80:83], v[136:139]
ds_read_b64_tr_b16 a[34:35], v25 offset:26400
s_add_u32 s52, s52, 0x20000
v_mfma_f32_16x16x32_bf16 v[156:159], a[60:63], a[80:83], v[156:159]
ds_read_b64_tr_b16 a[36:37], v25 offset:26880
v_mfma_f32_16x16x32_bf16 v[140:143], a[44:47], a[84:87], v[140:143]
buffer_load_dwordx4 v[168:171], v26, s[16:19], s75 offen sc1
v_mfma_f32_16x16x32_bf16 v[144:147], a[48:51], a[84:87], v[144:147]
ds_read_b64_tr_b16 a[38:39], v25 offset:27392
v_mfma_f32_16x16x32_bf16 v[148:151], a[52:55], a[84:87], v[148:151]
ds_read_b64_tr_b16 a[40:41], v25 offset:26912
v_mfma_f32_16x16x32_bf16 v[152:155], a[56:59], a[84:87], v[152:155]
ds_read_b64_tr_b16 a[42:43], v25 offset:27424
v_mfma_f32_16x16x32_bf16 v[160:163], a[60:63], a[84:87], v[160:163]
s_waitcnt vmcnt(17) lgkmcnt(6)
s_barrier
v_mfma_f32_16x16x32_bf16 v[60:63], a[20:23], a[0:3], v[60:63]
ds_read_b128 a[44:47], v23 offset:27648
s_add_u32 m0, s56, 78976
v_mfma_f32_16x16x32_bf16 v[64:67], a[20:23], a[4:7], v[64:67]
buffer_load_dwordx4 v18, s[20:23], s54 offen lds
v_mfma_f32_16x16x32_bf16 v[68:71], a[20:23], a[8:11], v[68:71]
ds_read_b128 a[48:51], v23 offset:28672
v_mfma_f32_16x16x32_bf16 v[72:75], a[20:23], a[12:15], v[72:75]
ds_read_b128 a[52:55], v23 offset:29952
v_mfma_f32_16x16x32_bf16 v[76:79], a[24:27], a[0:3], v[76:79]
ds_read_b128 a[56:59], v23 offset:30976
v_mfma_f32_16x16x32_bf16 v[80:83], a[24:27], a[4:7], v[80:83]
buffer_load_dwordx4 v19, s[20:23], s54 offen offset:1024 lds
v_mfma_f32_16x16x32_bf16 v[84:87], a[24:27], a[8:11], v[84:87]
ds_read_b64_tr_b16 a[64:65], v25 offset:37248
v_mfma_f32_16x16x32_bf16 v[88:91], a[24:27], a[12:15], v[88:91]
ds_read_b64_tr_b16 a[66:67], v25 offset:37760
v_mfma_f32_16x16x32_bf16 v[92:95], a[28:31], a[0:3], v[92:95]
ds_read_b64_tr_b16 a[68:69], v25 offset:37280
v_mfma_f32_16x16x32_bf16 v[96:99], a[28:31], a[4:7], v[96:99]
buffer_load_dwordx4 v20, s[20:23], s54 offen offset:2048 lds
v_mfma_f32_16x16x32_bf16 v[100:103], a[28:31], a[8:11], v[100:103]
s_add_u32 s54, s54, 196608
s_waitcnt lgkmcnt(7)
v_mfma_f32_16x16x32_bf16 v[104:107], a[28:31], a[12:15], v[104:107]
ds_read_b64_tr_b16 a[70:71], v25 offset:37792
v_mfma_f32_16x16x32_bf16 v[108:111], a[32:35], a[0:3], v[108:111]
ds_read_b128 a[60:63], v24 offset:29696
s_add_u32 m0, s55, 9216
v_mfma_f32_16x16x32_bf16 v[112:115], a[32:35], a[4:7], v[112:115]
buffer_load_dwordx4 v21, s[16:19], s52 offen sc1 lds
v_mfma_f32_16x16x32_bf16 v[116:119], a[32:35], a[8:11], v[116:119]
ds_read_b64_tr_b16 a[72:73], v25 offset:38272
v_mfma_f32_16x16x32_bf16 v[120:123], a[32:35], a[12:15], v[120:123]
ds_read_b64_tr_b16 a[74:75], v25 offset:38784
v_mfma_f32_16x16x32_bf16 v[124:127], a[0:3], a[36:39], v[124:127]
ds_read_b64_tr_b16 a[76:77], v25 offset:38304
v_mfma_f32_16x16x32_bf16 v[128:131], a[4:7], a[36:39], v[128:131]
buffer_load_dwordx4 v21, s[16:19], s52 offen offset:1024 sc1 lds
v_mfma_f32_16x16x32_bf16 v[132:135], a[8:11], a[36:39], v[132:135]
ds_read_b64_tr_b16 a[78:79], v25 offset:38816
v_mfma_f32_16x16x32_bf16 v[136:139], a[12:15], a[36:39], v[136:139]
ds_read_b64_tr_b16 a[80:81], v25 offset:39296
v_mfma_f32_16x16x32_bf16 v[156:159], a[16:19], a[36:39], v[156:159]
ds_read_b64_tr_b16 a[82:83], v25 offset:39808
v_mfma_f32_16x16x32_bf16 v[140:143], a[0:3], a[40:43], v[140:143]
buffer_load_dword v22, s[16:19], s52 offen offset:2048 sc1 lds
v_mfma_f32_16x16x32_bf16 v[144:147], a[4:7], a[40:43], v[144:147]
ds_read_b64_tr_b16 a[84:85], v25 offset:39328
s_add_u32 s52, s52, 0x20000
v_mfma_f32_16x16x32_bf16 v[148:151], a[8:11], a[40:43], v[148:151]
ds_read_b64_tr_b16 a[86:87], v25 offset:39840
v_mfma_f32_16x16x32_bf16 v[152:155], a[12:15], a[40:43], v[152:155]
v_mfma_f32_16x16x32_bf16 v[160:163], a[16:19], a[40:43], v[160:163]
s_waitcnt vmcnt(20) lgkmcnt(6)
s_barrier
v_mfma_f32_16x16x32_bf16 v[60:63], a[64:67], a[44:47], v[60:63]
ds_read_b128 a[0:3], v23 offset:36864
s_add_u32 m0, s56, 91392
v_mfma_f32_16x16x32_bf16 v[64:67], a[64:67], a[48:51], v[64:67]
buffer_load_dwordx4 v18, s[20:23], s54 offen lds
v_mfma_f32_16x16x32_bf16 v[68:71], a[64:67], a[52:55], v[68:71]
ds_read_b128 a[4:7], v23 offset:37888
v_add_f32 v164, v164, v172
v_mfma_f32_16x16x32_bf16 v[72:75], a[64:67], a[56:59], v[72:75]
ds_read_b128 a[8:11], v23 offset:39168
v_mfma_f32_16x16x32_bf16 v[76:79], a[68:71], a[44:47], v[76:79]
ds_read_b128 a[12:15], v23 offset:40192
v_mfma_f32_16x16x32_bf16 v[80:83], a[68:71], a[48:51], v[80:83]
buffer_load_dwordx4 v19, s[20:23], s54 offen offset:1024 lds
v_mfma_f32_16x16x32_bf16 v[84:87], a[68:71], a[52:55], v[84:87]
ds_read_b64_tr_b16 a[20:21], v25 offset:49664
v_mfma_f32_16x16x32_bf16 v[88:91], a[68:71], a[56:59], v[88:91]
ds_read_b64_tr_b16 a[22:23], v25 offset:50176
v_add_f32 v165, v165, v173
v_mfma_f32_16x16x32_bf16 v[92:95], a[72:75], a[44:47], v[92:95]
ds_read_b64_tr_b16 a[24:25], v25 offset:49696
v_mfma_f32_16x16x32_bf16 v[96:99], a[72:75], a[48:51], v[96:99]
buffer_load_dwordx4 v20, s[20:23], s54 offen offset:2048 lds
v_mfma_f32_16x16x32_bf16 v[100:103], a[72:75], a[52:55], v[100:103]
s_add_u32 s54, s54, 196608
s_waitcnt lgkmcnt(7)
v_mfma_f32_16x16x32_bf16 v[104:107], a[72:75], a[56:59], v[104:107]
ds_read_b64_tr_b16 a[26:27], v25 offset:50208
v_mfma_f32_16x16x32_bf16 v[108:111], a[76:79], a[44:47], v[108:111]
ds_read_b128 a[16:19], v24 offset:38912
s_add_u32 m0, s55, 18432
v_mfma_f32_16x16x32_bf16 v[112:115], a[76:79], a[48:51], v[112:115]
buffer_load_dwordx4 v21, s[16:19], s52 offen sc1 lds
v_mfma_f32_16x16x32_bf16 v[116:119], a[76:79], a[52:55], v[116:119]
ds_read_b64_tr_b16 a[28:29], v25 offset:50688
v_add_f32 v166, v166, v174
v_mfma_f32_16x16x32_bf16 v[120:123], a[76:79], a[56:59], v[120:123]
ds_read_b64_tr_b16 a[30:31], v25 offset:51200
v_mfma_f32_16x16x32_bf16 v[124:127], a[44:47], a[80:83], v[124:127]
ds_read_b64_tr_b16 a[32:33], v25 offset:50720
v_mfma_f32_16x16x32_bf16 v[128:131], a[48:51], a[80:83], v[128:131]
buffer_load_dwordx4 v21, s[16:19], s52 offen offset:1024 sc1 lds
v_mfma_f32_16x16x32_bf16 v[132:135], a[52:55], a[80:83], v[132:135]
ds_read_b64_tr_b16 a[34:35], v25 offset:51232
v_mfma_f32_16x16x32_bf16 v[136:139], a[56:59], a[80:83], v[136:139]
ds_read_b64_tr_b16 a[36:37], v25 offset:51712
v_add_f32 v167, v167, v175
v_mfma_f32_16x16x32_bf16 v[156:159], a[60:63], a[80:83], v[156:159]
ds_read_b64_tr_b16 a[38:39], v25 offset:52224
v_mfma_f32_16x16x32_bf16 v[140:143], a[44:47], a[84:87], v[140:143]
buffer_load_dword v22, s[16:19], s52 offen offset:2048 sc1 lds
v_mfma_f32_16x16x32_bf16 v[144:147], a[48:51], a[84:87], v[144:147]
ds_read_b64_tr_b16 a[40:41], v25 offset:51744
s_add_u32 s52, s52, 0x20000
v_mfma_f32_16x16x32_bf16 v[148:151], a[52:55], a[84:87], v[148:151]
ds_read_b64_tr_b16 a[42:43], v25 offset:52256
v_mfma_f32_16x16x32_bf16 v[152:155], a[56:59], a[84:87], v[152:155]
v_mfma_f32_16x16x32_bf16 v[160:163], a[60:63], a[84:87], v[160:163]
s_waitcnt vmcnt(20) lgkmcnt(6)
s_barrier
v_mfma_f32_16x16x32_bf16 v[60:63], a[20:23], a[0:3], v[60:63]
ds_read_b128 a[44:47], v23 offset:46080
s_add_u32 m0, s56, 103808
v_mfma_f32_16x16x32_bf16 v[64:67], a[20:23], a[4:7], v[64:67]
buffer_load_dwordx4 v18, s[20:23], s54 offen lds
v_mfma_f32_16x16x32_bf16 v[68:71], a[20:23], a[8:11], v[68:71]
ds_read_b128 a[48:51], v23 offset:47104
v_mfma_f32_16x16x32_bf16 v[72:75], a[20:23], a[12:15], v[72:75]
ds_read_b128 a[52:55], v23 offset:48384
v_mfma_f32_16x16x32_bf16 v[76:79], a[24:27], a[0:3], v[76:79]
buffer_load_dwordx4 v19, s[20:23], s54 offen offset:1024 lds
v_mfma_f32_16x16x32_bf16 v[80:83], a[24:27], a[4:7], v[80:83]
ds_read_b128 a[56:59], v23 offset:49408
v_mfma_f32_16x16x32_bf16 v[84:87], a[24:27], a[8:11], v[84:87]
ds_read_b64_tr_b16 a[64:65], v25 offset:62080
v_mfma_f32_16x16x32_bf16 v[88:91], a[24:27], a[12:15], v[88:91]
buffer_load_dwordx4 v20, s[20:23], s54 offen offset:2048 lds
v_mfma_f32_16x16x32_bf16 v[92:95], a[28:31], a[0:3], v[92:95]
ds_read_b64_tr_b16 a[66:67], v25 offset:62592
s_add_u32 s54, s54, 196608
v_mfma_f32_16x16x32_bf16 v[96:99], a[28:31], a[4:7], v[96:99]
ds_read_b64_tr_b16 a[68:69], v25 offset:62112
v_mfma_f32_16x16x32_bf16 v[100:103], a[28:31], a[8:11], v[100:103]
s_add_u32 m0, s55, 27648
s_waitcnt lgkmcnt(7)
v_mfma_f32_16x16x32_bf16 v[104:107], a[28:31], a[12:15], v[104:107]
buffer_load_dwordx4 v21, s[16:19], s52 offen sc1 lds
v_mfma_f32_16x16x32_bf16 v[108:111], a[32:35], a[0:3], v[108:111]
ds_read_b64_tr_b16 a[70:71], v25 offset:62624
v_mfma_f32_16x16x32_bf16 v[112:115], a[32:35], a[4:7], v[112:115]
ds_read_b128 a[60:63], v24 offset:48128
v_mfma_f32_16x16x32_bf16 v[116:119], a[32:35], a[8:11], v[116:119]
buffer_load_dwordx4 v21, s[16:19], s52 offen offset:1024 sc1 lds
v_mfma_f32_16x16x32_bf16 v[120:123], a[32:35], a[12:15], v[120:123]
ds_read_b64_tr_b16 a[72:73], v25 offset:63104
v_mfma_f32_16x16x32_bf16 v[124:127], a[0:3], a[36:39], v[124:127]
ds_read_b64_tr_b16 a[74:75], v25 offset:63616
v_mfma_f32_16x16x32_bf16 v[128:131], a[4:7], a[36:39], v[128:131]
ds_read_b64_tr_b16 a[76:77], v25 offset:63136
v_mfma_f32_16x16x32_bf16 v[132:135], a[8:11], a[36:39], v[132:135]
buffer_load_dword v22, s[16:19], s52 offen offset:2048 sc1 lds
v_mfma_f32_16x16x32_bf16 v[136:139], a[12:15], a[36:39], v[136:139]
ds_read_b64_tr_b16 a[78:79], v25 offset:63648
s_add_u32 s52, s52, 0x20000
v_mfma_f32_16x16x32_bf16 v[156:159], a[16:19], a[36:39], v[156:159]
ds_read_b64_tr_b16 a[80:81], v25 offset:64128
v_mfma_f32_16x16x32_bf16 v[140:143], a[0:3], a[40:43], v[140:143]
buffer_load_dwordx4 v[172:175], v26, s[16:19], s75 offen offset:1024 sc1
v_mfma_f32_16x16x32_bf16 v[144:147], a[4:7], a[40:43], v[144:147]
ds_read_b64_tr_b16 a[82:83], v25 offset:64640
s_add_u32 s75, s75, 2048
v_mfma_f32_16x16x32_bf16 v[148:151], a[8:11], a[40:43], v[148:151]
ds_read_b64_tr_b16 a[84:85], v25 offset:64160
v_mfma_f32_16x16x32_bf16 v[152:155], a[12:15], a[40:43], v[152:155]
ds_read_b64_tr_b16 a[86:87], v25 offset:64672
v_mfma_f32_16x16x32_bf16 v[160:163], a[16:19], a[40:43], v[160:163]
s_waitcnt vmcnt(20) lgkmcnt(6)
s_barrier
v_mfma_f32_16x16x32_bf16 v[60:63], a[64:67], a[44:47], v[60:63]
ds_read_b128 a[0:3], v23
s_add_u32 m0, s56, 116224
v_mfma_f32_16x16x32_bf16 v[64:67], a[64:67], a[48:51], v[64:67]
buffer_load_dwordx4 v18, s[20:23], s54 offen lds
v_mfma_f32_16x16x32_bf16 v[68:71], a[64:67], a[52:55], v[68:71]
ds_read_b128 a[4:7], v23 offset:1024
v_mfma_f32_16x16x32_bf16 v[72:75], a[64:67], a[56:59], v[72:75]
ds_read_b128 a[8:11], v23 offset:2304
v_mfma_f32_16x16x32_bf16 v[76:79], a[68:71], a[44:47], v[76:79]
ds_read_b128 a[12:15], v23 offset:3328
v_mfma_f32_16x16x32_bf16 v[80:83], a[68:71], a[48:51], v[80:83]
buffer_load_dwordx4 v19, s[20:23], s54 offen offset:1024 lds
v_mfma_f32_16x16x32_bf16 v[84:87], a[68:71], a[52:55], v[84:87]
ds_read_b64_tr_b16 a[20:21], v25
v_mfma_f32_16x16x32_bf16 v[88:91], a[68:71], a[56:59], v[88:91]
ds_read_b64_tr_b16 a[22:23], v25 offset:512
v_mfma_f32_16x16x32_bf16 v[92:95], a[72:75], a[44:47], v[92:95]
ds_read_b64_tr_b16 a[24:25], v25 offset:32
v_mfma_f32_16x16x32_bf16 v[96:99], a[72:75], a[48:51], v[96:99]
buffer_load_dwordx4 v20, s[20:23], s54 offen offset:2048 lds
v_mfma_f32_16x16x32_bf16 v[100:103], a[72:75], a[52:55], v[100:103]
s_add_u32 s54, s54, 196608
s_waitcnt lgkmcnt(7)
v_mfma_f32_16x16x32_bf16 v[104:107], a[72:75], a[56:59], v[104:107]
ds_read_b64_tr_b16 a[26:27], v25 offset:544
v_mfma_f32_16x16x32_bf16 v[108:111], a[76:79], a[44:47], v[108:111]
ds_read_b128 a[16:19], v24 offset:2048
s_add_u32 m0, s55, 36864
v_mfma_f32_16x16x32_bf16 v[112:115], a[76:79], a[48:51], v[112:115]
buffer_load_dwordx4 v21, s[16:19], s52 offen sc1 lds
.Lpad22:
s_cbranch_execz .Lnopoll41r
v_mfma_f32_16x16x32_bf16 v[116:119], a[76:79], a[52:55], v[116:119]
ds_read_b64_tr_b16 a[28:29], v25 offset:1024
v_mfma_f32_16x16x32_bf16 v[120:123], a[76:79], a[56:59], v[120:123]
ds_read_b64_tr_b16 a[30:31], v25 offset:1536
v_mfma_f32_16x16x32_bf16 v[124:127], a[44:47], a[80:83], v[124:127]
ds_read_b64_tr_b16 a[32:33], v25 offset:1056
v_mfma_f32_16x16x32_bf16 v[128:131], a[48:51], a[80:83], v[128:131]
buffer_load_dwordx4 v21, s[16:19], s52 offen offset:1024 sc1 lds
v_mfma_f32_16x16x32_bf16 v[132:135], a[52:55], a[80:83], v[132:135]
ds_read_b64_tr_b16 a[34:35], v25 offset:1568
v_mfma_f32_16x16x32_bf16 v[136:139], a[56:59], a[80:83], v[136:139]
ds_read_b64_tr_b16 a[36:37], v25 offset:2048
v_mfma_f32_16x16x32_bf16 v[156:159], a[60:63], a[80:83], v[156:159]
ds_read_b64_tr_b16 a[38:39], v25 offset:2560
v_mfma_f32_16x16x32_bf16 v[140:143], a[44:47], a[84:87], v[140:143]
buffer_load_dword v22, s[16:19], s52 offen offset:2048 sc1 lds
v_mfma_f32_16x16x32_bf16 v[144:147], a[48:51], a[84:87], v[144:147]
ds_read_b64_tr_b16 a[40:41], v25 offset:2080
s_add_u32 s52, s52, 0x20000
v_mfma_f32_16x16x32_bf16 v[148:151], a[52:55], a[84:87], v[148:151]
ds_read_b64_tr_b16 a[42:43], v25 offset:2592
v_mfma_f32_16x16x32_bf16 v[152:155], a[56:59], a[84:87], v[152:155]
s_add_u32 s15, s15, 1
v_mfma_f32_16x16x32_bf16 v[160:163], a[60:63], a[84:87], v[160:163]
s_cbranch_scc0 .Lk45
s_waitcnt vmcnt(19) lgkmcnt(6)
s_barrier
v_mfma_f32_16x16x32_bf16 v[60:63], a[20:23], a[0:3], v[60:63]
ds_read_b128 a[44:47], v23 offset:9216
s_add_u32 m0, s56, 128640
v_mfma_f32_16x16x32_bf16 v[64:67], a[20:23], a[4:7], v[64:67]
buffer_load_dwordx4 v18, s[20:23], s54 offen lds
v_mfma_f32_16x16x32_bf16 v[68:71], a[20:23], a[8:11], v[68:71]
ds_read_b128 a[48:51], v23 offset:10240
v_add_f32 v164, v164, v168
v_mfma_f32_16x16x32_bf16 v[72:75], a[20:23], a[12:15], v[72:75]
ds_read_b128 a[52:55], v23 offset:11520
v_mfma_f32_16x16x32_bf16 v[76:79], a[24:27], a[0:3], v[76:79]
ds_read_b128 a[56:59], v23 offset:12544
v_mfma_f32_16x16x32_bf16 v[80:83], a[24:27], a[4:7], v[80:83]
buffer_load_dwordx4 v19, s[20:23], s54 offen offset:1024 lds
v_mfma_f32_16x16x32_bf16 v[84:87], a[24:27], a[8:11], v[84:87]
ds_read_b64_tr_b16 a[64:65], v25 offset:12416
v_mfma_f32_16x16x32_bf16 v[88:91], a[24:27], a[12:15], v[88:91]
ds_read_b64_tr_b16 a[66:67], v25 offset:12928
v_add_f32 v165, v165, v169
v_mfma_f32_16x16x32_bf16 v[92:95], a[28:31], a[0:3], v[92:95]
ds_read_b64_tr_b16 a[68:69], v25 offset:12448
v_mfma_f32_16x16x32_bf16 v[96:99], a[28:31], a[4:7], v[96:99]
buffer_load_dwordx4 v20, s[20:23], s54 offen offset:2048 lds
v_mfma_f32_16x16x32_bf16 v[100:103], a[28:31], a[8:11], v[100:103]
s_add_u32 s54, s54, 196608
s_waitcnt lgkmcnt(7)
v_mfma_f32_16x16x32_bf16 v[104:107], a[28:31], a[12:15], v[104:107]
ds_read_b64_tr_b16 a[70:71], v25 offset:12960
v_mfma_f32_16x16x32_bf16 v[108:111], a[32:35], a[0:3], v[108:111]
ds_read_b128 a[60:63], v24 offset:11264
s_add_u32 m0, s55, 46080
v_mfma_f32_16x16x32_bf16 v[112:115], a[32:35], a[4:7], v[112:115]
buffer_load_dwordx4 v21, s[16:19], s52 offen sc1 lds
v_mfma_f32_16x16x32_bf16 v[116:119], a[32:35], a[8:11], v[116:119]
ds_read_b64_tr_b16 a[72:73], v25 offset:13440
v_add_f32 v166, v166, v170
v_mfma_f32_16x16x32_bf16 v[120:123], a[32:35], a[12:15], v[120:123]
ds_read_b64_tr_b16 a[74:75], v25 offset:13952
v_mfma_f32_16x16x32_bf16 v[124:127], a[0:3], a[36:39], v[124:127]
ds_read_b64_tr_b16 a[76:77], v25 offset:13472
v_mfma_f32_16x16x32_bf16 v[128:131], a[4:7], a[36:39], v[128:131]
buffer_load_dwordx4 v21, s[16:19], s52 offen offset:1024 sc1 lds
v_mfma_f32_16x16x32_bf16 v[132:135], a[8:11], a[36:39], v[132:135]
ds_read_b64_tr_b16 a[78:79], v25 offset:13984
v_mfma_f32_16x16x32_bf16 v[136:139], a[12:15], a[36:39], v[136:139]
ds_read_b64_tr_b16 a[80:81], v25 offset:14464
v_add_f32 v167, v167, v171
v_mfma_f32_16x16x32_bf16 v[156:159], a[16:19], a[36:39], v[156:159]
ds_read_b64_tr_b16 a[82:83], v25 offset:14976
v_mfma_f32_16x16x32_bf16 v[140:143], a[0:3], a[40:43], v[140:143]
buffer_load_dword v22, s[16:19], s52 offen offset:2048 sc1 lds
v_mfma_f32_16x16x32_bf16 v[144:147], a[4:7], a[40:43], v[144:147]
ds_read_b64_tr_b16 a[84:85], v25 offset:14496
s_add_u32 s52, s52, 0x20000
v_mfma_f32_16x16x32_bf16 v[148:151], a[8:11], a[40:43], v[148:151]
ds_read_b64_tr_b16 a[86:87], v25 offset:15008
v_mfma_f32_16x16x32_bf16 v[152:155], a[12:15], a[40:43], v[152:155]
v_mfma_f32_16x16x32_bf16 v[160:163], a[16:19], a[40:43], v[160:163]
s_waitcnt vmcnt(19) lgkmcnt(6)
s_barrier
v_mfma_f32_16x16x32_bf16 v[60:63], a[64:67], a[44:47], v[60:63]
ds_read_b128 a[0:3], v23 offset:18432
s_add_u32 m0, s56, 66560
v_mfma_f32_16x16x32_bf16 v[64:67], a[64:67], a[48:51], v[64:67]
buffer_load_dwordx4 v18, s[20:23], s54 offen lds
v_mfma_f32_16x16x32_bf16 v[68:71], a[64:67], a[52:55], v[68:71]
ds_read_b128 a[4:7], v23 offset:19456
v_mfma_f32_16x16x32_bf16 v[72:75], a[64:67], a[56:59], v[72:75]
ds_read_b128 a[8:11], v23 offset:20736
v_mfma_f32_16x16x32_bf16 v[76:79], a[68:71], a[44:47], v[76:79]
ds_read_b128 a[12:15], v23 offset:21760
v_mfma_f32_16x16x32_bf16 v[80:83], a[68:71], a[48:51], v[80:83]
buffer_load_dwordx4 v19, s[20:23], s54 offen offset:1024 lds
v_mfma_f32_16x16x32_bf16 v[84:87], a[68:71], a[52:55], v[84:87]
ds_read_b64_tr_b16 a[20:21], v25 offset:24832
v_mfma_f32_16x16x32_bf16 v[88:91], a[68:71], a[56:59], v[88:91]
ds_read_b64_tr_b16 a[22:23], v25 offset:25344
v_mfma_f32_16x16x32_bf16 v[92:95], a[72:75], a[44:47], v[92:95]
ds_read_b64_tr_b16 a[24:25], v25 offset:24864
v_mfma_f32_16x16x32_bf16 v[96:99], a[72:75], a[48:51], v[96:99]
buffer_load_dwordx4 v20, s[20:23], s54 offen offset:2048 lds
v_mfma_f32_16x16x32_bf16 v[100:103], a[72:75], a[52:55], v[100:103]
s_add_u32 s54, s54, 196608
s_waitcnt lgkmcnt(7)
v_mfma_f32_16x16x32_bf16 v[104:107], a[72:75], a[56:59], v[104:107]
ds_read_b64_tr_b16 a[26:27], v25 offset:25376
v_mfma_f32_16x16x32_bf16 v[108:111], a[76:79], a[44:47], v[108:111]
ds_read_b128 a[16:19], v24 offset:20480
s_add_u32 m0, s55, 0
v_mfma_f32_16x16x32_bf16 v[112:115], a[76:79], a[48:51], v[112:115]
buffer_load_dwordx4 v21, s[16:19], s52 offen sc1 lds
v_mfma_f32_16x16x32_bf16 v[116:119], a[76:79], a[52:55], v[116:119]
ds_read_b64_tr_b16 a[28:29], v25 offset:25856
v_mfma_f32_16x16x32_bf16 v[120:123], a[76:79], a[56:59], v[120:123]
ds_read_b64_tr_b16 a[30:31], v25 offset:26368
v_mfma_f32_16x16x32_bf16 v[124:127], a[44:47], a[80:83], v[124:127]
ds_read_b64_tr_b16 a[32:33], v25 offset:25888
v_mfma_f32_16x16x32_bf16 v[128:131], a[48:51], a[80:83], v[128:131]
buffer_load_dwordx4 v21, s[16:19], s52 offen offset:1024 sc1 lds
v_mfma_f32_16x16x32_bf16 v[132:135], a[52:55], a[80:83], v[132:135]
ds_read_b64_tr_b16 a[34:35], v25 offset:26400
v_mfma_f32_16x16x32_bf16 v[136:139], a[56:59], a[80:83], v[136:139]
ds_read_b64_tr_b16 a[36:37], v25 offset:26880
v_mfma_f32_16x16x32_bf16 v[156:159], a[60:63], a[80:83], v[156:159]
ds_read_b64_tr_b16 a[38:39], v25 offset:27392
v_mfma_f32_16x16x32_bf16 v[140:143], a[44:47], a[84:87], v[140:143]
buffer_load_dword v22, s[16:19], s52 offen offset:2048 sc1 lds
v_mfma_f32_16x16x32_bf16 v[144:147], a[48:51], a[84:87], v[144:147]
ds_read_b64_tr_b16 a[40:41], v25 offset:26912
s_add_u32 s52, s52, 0x20000
v_mfma_f32_16x16x32_bf16 v[148:151], a[52:55], a[84:87], v[148:151]
ds_read_b64_tr_b16 a[42:43], v25 offset:27424
v_mfma_f32_16x16x32_bf16 v[152:155], a[56:59], a[84:87], v[152:155]
v_mfma_f32_16x16x32_bf16 v[160:163], a[60:63], a[84:87], v[160:163]
s_waitcnt vmcnt(19) lgkmcnt(6)
s_barrier
v_mfma_f32_16x16x32_bf16 v[60:63], a[20:23], a[0:3], v[60:63]
ds_read_b128 a[44:47], v23 offset:27648
s_add_u32 m0, s56, 78976
v_mfma_f32_16x16x32_bf16 v[64:67], a[20:23], a[4:7], v[64:67]
buffer_load_dwordx4 v18, s[20:23], s54 offen lds
v_mfma_f32_16x16x32_bf16 v[68:71], a[20:23], a[8:11], v[68:71]
ds_read_b128 a[48:51], v23 offset:28672
s_waitcnt vmcnt(19)
v_add_f32 v164, v164, v172
v_mfma_f32_16x16x32_bf16 v[72:75], a[20:23], a[12:15], v[72:75]
ds_read_b128 a[52:55], v23 offset:29952
v_mfma_f32_16x16x32_bf16 v[76:79], a[24:27], a[0:3], v[76:79]
ds_read_b128 a[56:59], v23 offset:30976
v_mfma_f32_16x16x32_bf16 v[80:83], a[24:27], a[4:7], v[80:83]
buffer_load_dwordx4 v19, s[20:23], s54 offen offset:1024 lds
v_mfma_f32_16x16x32_bf16 v[84:87], a[24:27], a[8:11], v[84:87]
ds_read_b64_tr_b16 a[64:65], v25 offset:37248
v_mfma_f32_16x16x32_bf16 v[88:91], a[24:27], a[12:15], v[88:91]
ds_read_b64_tr_b16 a[66:67], v25 offset:37760
v_add_f32 v165, v165, v173
v_mfma_f32_16x16x32_bf16 v[92:95], a[28:31], a[0:3], v[92:95]
ds_read_b64_tr_b16 a[68:69], v25 offset:37280
v_mfma_f32_16x16x32_bf16 v[96:99], a[28:31], a[4:7], v[96:99]
buffer_load_dwordx4 v20, s[20:23], s54 offen offset:2048 lds
v_mfma_f32_16x16x32_bf16 v[100:103], a[28:31], a[8:11], v[100:103]
s_add_u32 s54, s54, 196608
s_waitcnt lgkmcnt(7)
v_mfma_f32_16x16x32_bf16 v[104:107], a[28:31], a[12:15], v[104:107]
ds_read_b64_tr_b16 a[70:71], v25 offset:37792
v_mfma_f32_16x16x32_bf16 v[108:111], a[32:35], a[0:3], v[108:111]
ds_read_b128 a[60:63], v24 offset:29696
s_add_u32 m0, s55, 9216
v_mfma_f32_16x16x32_bf16 v[112:115], a[32:35], a[4:7], v[112:115]
buffer_load_dwordx4 v21, s[16:19], s52 offen sc1 lds
v_mfma_f32_16x16x32_bf16 v[116:119], a[32:35], a[8:11], v[116:119]
ds_read_b64_tr_b16 a[72:73], v25 offset:38272
v_add_f32 v166, v166, v174
v_mfma_f32_16x16x32_bf16 v[120:123], a[32:35], a[12:15], v[120:123]
ds_read_b64_tr_b16 a[74:75], v25 offset:38784
v_mfma_f32_16x16x32_bf16 v[124:127], a[0:3], a[36:39], v[124:127]
ds_read_b64_tr_b16 a[76:77], v25 offset:38304
v_mfma_f32_16x16x32_bf16 v[128:131], a[4:7], a[36:39], v[128:131]
buffer_load_dwordx4 v21, s[16:19], s52 offen offset:1024 sc1 lds
v_mfma_f32_16x16x32_bf16 v[132:135], a[8:11], a[36:39], v[132:135]
ds_read_b64_tr_b16 a[78:79], v25 offset:38816
v_mfma_f32_16x16x32_bf16 v[136:139], a[12:15], a[36:39], v[136:139]
ds_read_b64_tr_b16 a[80:81], v25 offset:39296
v_add_f32 v167, v167, v175
v_mfma_f32_16x16x32_bf16 v[156:159], a[16:19], a[36:39], v[156:159]
ds_read_b64_tr_b16 a[82:83], v25 offset:39808
v_mfma_f32_16x16x32_bf16 v[140:143], a[0:3], a[40:43], v[140:143]
buffer_load_dword v22, s[16:19], s52 offen offset:2048 sc1 lds
v_mfma_f32_16x16x32_bf16 v[144:147], a[4:7], a[40:43], v[144:147]
ds_read_b64_tr_b16 a[84:85], v25 offset:39328
s_add_u32 s52, s52, 0x20000
v_mfma_f32_16x16x32_bf16 v[148:151], a[8:11], a[40:43], v[148:151]
ds_read_b64_tr_b16 a[86:87], v25 offset:39840
v_mfma_f32_16x16x32_bf16 v[152:155], a[12:15], a[40:43], v[152:155]
v_mfma_f32_16x16x32_bf16 v[160:163], a[16:19], a[40:43], v[160:163]
s_waitcnt vmcnt(18) lgkmcnt(6)
s_barrier
v_mfma_f32_16x16x32_bf16 v[60:63], a[64:67], a[44:47], v[60:63]
s_add_u32 m0, s59, 58240
s_mov_b32 s58, 1966080
v_permlane32_swap_b32 v164, v166
v_mfma_f32_16x16x32_bf16 v[64:67], a[64:67], a[48:51], v[64:67]
buffer_load_dwordx4 v5, s[24:27], s58 offen lds
v_mfma_f32_16x16x32_bf16 v[68:71], a[64:67], a[52:55], v[68:71]
ds_read_b128 a[0:3], v23 offset:36864
v_mfma_f32_16x16x32_bf16 v[72:75], a[64:67], a[56:59], v[72:75]
ds_read_b128 a[4:7], v23 offset:37888
v_permlane32_swap_b32 v165, v167
v_mfma_f32_16x16x32_bf16 v[76:79], a[68:71], a[44:47], v[76:79]
ds_read_b128 a[8:11], v23 offset:39168
v_mfma_f32_16x16x32_bf16 v[80:83], a[68:71], a[48:51], v[80:83]
ds_read_b128 a[12:15], v23 offset:40192
v_mfma_f32_16x16x32_bf16 v[84:87], a[68:71], a[52:55], v[84:87]
ds_read_b64_tr_b16 a[20:21], v25 offset:49664
v_add_f32 v164, v164, v166
v_mfma_f32_16x16x32_bf16 v[88:91], a[68:71], a[56:59], v[88:91]
buffer_load_dwordx4 v6, s[24:27], s58 offen offset:1024 lds
v_mfma_f32_16x16x32_bf16 v[92:95], a[72:75], a[44:47], v[92:95]
ds_read_b64_tr_b16 a[22:23], v25 offset:50176
v_mfma_f32_16x16x32_bf16 v[96:99], a[72:75], a[48:51], v[96:99]
ds_read_b64_tr_b16 a[24:25], v25 offset:49696
v_mfma_f32_16x16x32_bf16 v[100:103], a[72:75], a[52:55], v[100:103]
ds_read_b64_tr_b16 a[26:27], v25 offset:50208
s_waitcnt lgkmcnt(8)
v_mfma_f32_16x16x32_bf16 v[104:107], a[72:75], a[56:59], v[104:107]
ds_read_b128 a[16:19], v24 offset:38912
v_add_f32 v165, v165, v167
v_mfma_f32_16x16x32_bf16 v[108:111], a[76:79], a[44:47], v[108:111]
s_add_u32 m0, s59, 91520
s_mov_b32 s58, 393216
v_mfma_f32_16x16x32_bf16 v[112:115], a[76:79], a[48:51], v[112:115]
buffer_load_dwordx4 v5, s[24:27], s58 offen lds
v_mfma_f32_16x16x32_bf16 v[116:119], a[76:79], a[52:55], v[116:119]
v_mul_f32 v164, 0xba800000, v164
v_mfma_f32_16x16x32_bf16 v[120:123], a[76:79], a[56:59], v[120:123]
ds_read_b64_tr_b16 a[28:29], v25 offset:50688
v_mfma_f32_16x16x32_bf16 v[124:127], a[44:47], a[80:83], v[124:127]
ds_read_b64_tr_b16 a[30:31], v25 offset:51200
v_mul_f32 v165, 0x3a800000, v165
v_mfma_f32_16x16x32_bf16 v[128:131], a[48:51], a[80:83], v[128:131]
ds_read_b64_tr_b16 a[32:33], v25 offset:50720
v_mfma_f32_16x16x32_bf16 v[132:135], a[52:55], a[80:83], v[132:135]
ds_read_b64_tr_b16 a[34:35], v25 offset:51232
v_mfma_f32_16x16x32_bf16 v[136:139], a[56:59], a[80:83], v[136:139]
buffer_load_dwordx4 v6, s[24:27], s58 offen offset:1024 lds
v_mfma_f32_16x16x32_bf16 v[156:159], a[60:63], a[80:83], v[156:159]
ds_read_b64_tr_b16 a[36:37], v25 offset:51712
v_fma_f32 v165, -v164, v164, v165
v_mfma_f32_16x16x32_bf16 v[140:143], a[44:47], a[84:87], v[140:143]
ds_read_b64_tr_b16 a[38:39], v25 offset:52224
v_mfma_f32_16x16x32_bf16 v[144:147], a[48:51], a[84:87], v[144:147]
ds_read_b64_tr_b16 a[40:41], v25 offset:51744
v_mfma_f32_16x16x32_bf16 v[148:151], a[52:55], a[84:87], v[148:151]
ds_read_b64_tr_b16 a[42:43], v25 offset:52256
v_max_f32 v165, 0, v165
v_mfma_f32_16x16x32_bf16 v[152:155], a[56:59], a[84:87], v[152:155]
v_mfma_f32_16x16x32_bf16 v[160:163], a[60:63], a[84:87], v[160:163]
s_waitcnt vmcnt(16) lgkmcnt(6)
s_barrier
v_mfma_f32_16x16x32_bf16 v[60:63], a[20:23], a[0:3], v[60:63]
s_add_u32 m0, s59, 24960
s_mov_b32 s58, 1441792
v_add_f32 v165, 0x3727c5ac, v165
v_mfma_f32_16x16x32_bf16 v[64:67], a[20:23], a[4:7], v[64:67]
buffer_load_dwordx4 v5, s[24:27], s58 offen lds
v_mfma_f32_16x16x32_bf16 v[68:71], a[20:23], a[8:11], v[68:71]
ds_read_b128 a[44:47], v23 offset:46080
v_mfma_f32_16x16x32_bf16 v[72:75], a[20:23], a[12:15], v[72:75]
ds_read_b128 a[48:51], v23 offset:47104
v_mfma_f32_16x16x32_bf16 v[76:79], a[24:27], a[0:3], v[76:79]
ds_read_b128 a[52:55], v23 offset:48384
v_rsq_f32 v166, v165
v_mfma_f32_16x16x32_bf16 v[80:83], a[24:27], a[4:7], v[80:83]
ds_read_b128 a[56:59], v23 offset:49408
v_mfma_f32_16x16x32_bf16 v[84:87], a[24:27], a[8:11], v[84:87]
ds_read_b64_tr_b16 a[64:65], v25 offset:62080
v_mfma_f32_16x16x32_bf16 v[88:91], a[24:27], a[12:15], v[88:91]
buffer_load_dwordx4 v6, s[24:27], s58 offen offset:1024 lds
v_mfma_f32_16x16x32_bf16 v[92:95], a[28:31], a[0:3], v[92:95]
ds_read_b64_tr_b16 a[66:67], v25 offset:62592
v_mov_b32 v165, v166
v_mfma_f32_16x16x32_bf16 v[96:99], a[28:31], a[4:7], v[96:99]
ds_read_b64_tr_b16 a[68:69], v25 offset:62112
v_mfma_f32_16x16x32_bf16 v[100:103], a[28:31], a[8:11], v[100:103]
ds_read_b64_tr_b16 a[70:71], v25 offset:62624
s_waitcnt lgkmcnt(8)
v_mfma_f32_16x16x32_bf16 v[104:107], a[28:31], a[12:15], v[104:107]
ds_read_b128 a[60:63], v24 offset:48128
v_mfma_f32_16x16x32_bf16 v[108:111], a[32:35], a[0:3], v[108:111]
s_add_u32 m0, s59, 99840
s_mov_b32 s58, 524288
v_mul_f32 v166, 0x3e8293ee, v166
v_mfma_f32_16x16x32_bf16 v[112:115], a[32:35], a[4:7], v[112:115]
buffer_load_dwordx4 v5, s[24:27], s58 offen lds
v_mfma_f32_16x16x32_bf16 v[116:119], a[32:35], a[8:11], v[116:119]
v_mfma_f32_16x16x32_bf16 v[120:123], a[32:35], a[12:15], v[120:123]
ds_read_b64_tr_b16 a[72:73], v25 offset:63104
ds_write_b128 v7, v[164:167]
v_mfma_f32_16x16x32_bf16 v[124:127], a[0:3], a[36:39], v[124:127]
ds_read_b64_tr_b16 a[74:75], v25 offset:63616
v_mfma_f32_16x16x32_bf16 v[128:131], a[4:7], a[36:39], v[128:131]
ds_read_b64_tr_b16 a[76:77], v25 offset:63136
v_mfma_f32_16x16x32_bf16 v[132:135], a[8:11], a[36:39], v[132:135]
ds_read_b64_tr_b16 a[78:79], v25 offset:63648
ds_write_b32 v17, v164
v_mfma_f32_16x16x32_bf16 v[136:139], a[12:15], a[36:39], v[136:139]
buffer_load_dwordx4 v6, s[24:27], s58 offen offset:1024 lds
v_mfma_f32_16x16x32_bf16 v[156:159], a[16:19], a[36:39], v[156:159]
ds_read_b64_tr_b16 a[80:81], v25 offset:64128
v_mfma_f32_16x16x32_bf16 v[140:143], a[0:3], a[40:43], v[140:143]
ds_read_b64_tr_b16 a[82:83], v25 offset:64640
v_mfma_f32_16x16x32_bf16 v[144:147], a[4:7], a[40:43], v[144:147]
ds_read_b64_tr_b16 a[84:85], v25 offset:64160
ds_write_b32 v17, v165 offset:1024
v_mfma_f32_16x16x32_bf16 v[148:151], a[8:11], a[40:43], v[148:151]
ds_read_b64_tr_b16 a[86:87], v25 offset:64672
v_mfma_f32_16x16x32_bf16 v[152:155], a[12:15], a[40:43], v[152:155]
v_mfma_f32_16x16x32_bf16 v[160:163], a[16:19], a[40:43], v[160:163]
s_waitcnt vmcnt(14) lgkmcnt(8)
s_barrier
v_mfma_f32_16x16x32_bf16 v[60:63], a[64:67], a[44:47], v[60:63]
ds_read_b128 a[0:3], v23
s_add_u32 m0, s59, 33280
s_mov_b32 s58, 1572864
v_mfma_f32_16x16x32_bf16 v[64:67], a[64:67], a[48:51], v[64:67]
buffer_load_dwordx4 v5, s[24:27], s58 offen lds
v_mfma_f32_16x16x32_bf16 v[68:71], a[64:67], a[52:55], v[68:71]
ds_read_b128 a[4:7], v23 offset:1024
v_mfma_f32_16x16x32_bf16 v[72:75], a[64:67], a[56:59], v[72:75]
ds_read_b128 a[8:11], v23 offset:2304
v_mfma_f32_16x16x32_bf16 v[76:79], a[68:71], a[44:47], v[76:79]
ds_read_b128 a[12:15], v23 offset:3328
v_mfma_f32_16x16x32_bf16 v[80:83], a[68:71], a[48:51], v[80:83]
buffer_load_dwordx4 v6, s[24:27], s58 offen offset:1024 lds
v_mfma_f32_16x16x32_bf16 v[84:87], a[68:71], a[52:55], v[84:87]
ds_read_b64_tr_b16 a[20:21], v25
v_mfma_f32_16x16x32_bf16 v[88:91], a[68:71], a[56:59], v[88:91]
ds_read_b64_tr_b16 a[22:23], v25 offset:512
v_mfma_f32_16x16x32_bf16 v[92:95], a[72:75], a[44:47], v[92:95]
s_add_u32 m0, s59, 108160
s_mov_b32 s58, 655360
v_mfma_f32_16x16x32_bf16 v[96:99], a[72:75], a[48:51], v[96:99]
buffer_load_dwordx4 v5, s[24:27], s58 offen lds
v_mfma_f32_16x16x32_bf16 v[100:103], a[72:75], a[52:55], v[100:103]
ds_read_b64_tr_b16 a[24:25], v25 offset:32
s_waitcnt lgkmcnt(7)
v_mfma_f32_16x16x32_bf16 v[104:107], a[72:75], a[56:59], v[104:107]
ds_read_b64_tr_b16 a[26:27], v25 offset:544
v_mfma_f32_16x16x32_bf16 v[108:111], a[76:79], a[44:47], v[108:111]
ds_read_b128 a[16:19], v24 offset:2048
v_mfma_f32_16x16x32_bf16 v[112:115], a[76:79], a[48:51], v[112:115]
buffer_load_dwordx4 v6, s[24:27], s58 offen offset:1024 lds
v_mfma_f32_16x16x32_bf16 v[116:119], a[76:79], a[52:55], v[116:119]
ds_read_b64_tr_b16 a[28:29], v25 offset:1024
v_mfma_f32_16x16x32_bf16 v[120:123], a[76:79], a[56:59], v[120:123]
ds_read_b64_tr_b16 a[30:31], v25 offset:1536
v_mfma_f32_16x16x32_bf16 v[124:127], a[44:47], a[80:83], v[124:127]
s_add_u32 m0, s59, 116480
s_mov_b32 s58, 786432
v_mfma_f32_16x16x32_bf16 v[128:131], a[48:51], a[80:83], v[128:131]
buffer_load_dwordx4 v5, s[24:27], s58 offen lds
v_mfma_f32_16x16x32_bf16 v[132:135], a[52:55], a[80:83], v[132:135]
ds_read_b64_tr_b16 a[32:33], v25 offset:1056
v_mfma_f32_16x16x32_bf16 v[136:139], a[56:59], a[80:83], v[136:139]
ds_read_b64_tr_b16 a[34:35], v25 offset:1568
v_mfma_f32_16x16x32_bf16 v[156:159], a[60:63], a[80:83], v[156:159]
ds_read_b64_tr_b16 a[36:37], v25 offset:2048
v_mfma_f32_16x16x32_bf16 v[140:143], a[44:47], a[84:87], v[140:143]
buffer_load_dwordx4 v6, s[24:27], s58 offen offset:1024 lds
v_mfma_f32_16x16x32_bf16 v[144:147], a[48:51], a[84:87], v[144:147]
ds_read_b64_tr_b16 a[38:39], v25 offset:2560
v_mfma_f32_16x16x32_bf16 v[148:151], a[52:55], a[84:87], v[148:151]
ds_read_b64_tr_b16 a[40:41], v25 offset:2080
v_mfma_f32_16x16x32_bf16 v[152:155], a[56:59], a[84:87], v[152:155]
ds_read_b64_tr_b16 a[42:43], v25 offset:2592
v_mfma_f32_16x16x32_bf16 v[160:163], a[60:63], a[84:87], v[160:163]
s_waitcnt vmcnt(14) lgkmcnt(6)
s_barrier
v_mfma_f32_16x16x32_bf16 v[60:63], a[20:23], a[0:3], v[60:63]
ds_read_b128 a[44:47], v23 offset:9216
s_add_u32 m0, s59, 41600
s_mov_b32 s58, 1703936
v_mfma_f32_16x16x32_bf16 v[64:67], a[20:23], a[4:7], v[64:67]
buffer_load_dwordx4 v5, s[24:27], s58 offen lds
v_mfma_f32_16x16x32_bf16 v[68:71], a[20:23], a[8:11], v[68:71]
ds_read_b128 a[48:51], v23 offset:10240
v_mfma_f32_16x16x32_bf16 v[72:75], a[20:23], a[12:15], v[72:75]
ds_read_b128 a[52:55], v23 offset:11520
v_mfma_f32_16x16x32_bf16 v[76:79], a[24:27], a[0:3], v[76:79]
ds_read_b128 a[56:59], v23 offset:12544
v_mfma_f32_16x16x32_bf16 v[80:83], a[24:27], a[4:7], v[80:83]
buffer_load_dwordx4 v6, s[24:27], s58 offen offset:1024 lds
v_mfma_f32_16x16x32_bf16 v[84:87], a[24:27], a[8:11], v[84:87]
ds_read_b64_tr_b16 a[64:65], v25 offset:12416
v_mfma_f32_16x16x32_bf16 v[88:91], a[24:27], a[12:15], v[88:91]
ds_read_b64_tr_b16 a[66:67], v25 offset:12928
v_mfma_f32_16x16x32_bf16 v[92:95], a[28:31], a[0:3], v[92:95]
s_add_u32 m0, s59, 49920
s_mov_b32 s58, 1835008
v_mfma_f32_16x16x32_bf16 v[96:99], a[28:31], a[4:7], v[96:99]
buffer_load_dwordx4 v5, s[24:27], s58 offen lds
v_mfma_f32_16x16x32_bf16 v[100:103], a[28:31], a[8:11], v[100:103]
ds_read_b64_tr_b16 a[68:69], v25 offset:12448
s_waitcnt lgkmcnt(7)
v_mfma_f32_16x16x32_bf16 v[104:107], a[28:31], a[12:15], v[104:107]
ds_read_b64_tr_b16 a[70:71], v25 offset:12960
v_mfma_f32_16x16x32_bf16 v[108:111], a[32:35], a[0:3], v[108:111]
ds_read_b128 a[60:63], v24 offset:11264
v_mfma_f32_16x16x32_bf16 v[112:115], a[32:35], a[4:7], v[112:115]
buffer_load_dwordx4 v6, s[24:27], s58 offen offset:1024 lds
v_mfma_f32_16x16x32_bf16 v[116:119], a[32:35], a[8:11], v[116:119]
ds_read_b64_tr_b16 a[72:73], v25 offset:13440
v_mfma_f32_16x16x32_bf16 v[120:123], a[32:35], a[12:15], v[120:123]
ds_read_b64_tr_b16 a[74:75], v25 offset:13952
v_mfma_f32_16x16x32_bf16 v[124:127], a[0:3], a[36:39], v[124:127]
s_add_u32 m0, s59, 124800
s_mov_b32 s58, 917504
v_mfma_f32_16x16x32_bf16 v[128:131], a[4:7], a[36:39], v[128:131]
buffer_load_dwordx4 v5, s[24:27], s58 offen lds
v_mfma_f32_16x16x32_bf16 v[132:135], a[8:11], a[36:39], v[132:135]
ds_read_b64_tr_b16 a[76:77], v25 offset:13472
v_mfma_f32_16x16x32_bf16 v[136:139], a[12:15], a[36:39], v[136:139]
ds_read_b64_tr_b16 a[78:79], v25 offset:13984
v_mfma_f32_16x16x32_bf16 v[156:159], a[16:19], a[36:39], v[156:159]
ds_read_b64_tr_b16 a[80:81], v25 offset:14464
v_mfma_f32_16x16x32_bf16 v[140:143], a[0:3], a[40:43], v[140:143]
buffer_load_dwordx4 v6, s[24:27], s58 offen offset:1024 lds
v_mfma_f32_16x16x32_bf16 v[144:147], a[4:7], a[40:43], v[144:147]
ds_read_b64_tr_b16 a[82:83], v25 offset:14976
v_mfma_f32_16x16x32_bf16 v[148:151], a[8:11], a[40:43], v[148:151]
ds_read_b64_tr_b16 a[84:85], v25 offset:14496
v_mfma_f32_16x16x32_bf16 v[152:155], a[12:15], a[40:43], v[152:155]
ds_read_b64_tr_b16 a[86:87], v25 offset:15008
v_mfma_f32_16x16x32_bf16 v[160:163], a[16:19], a[40:43], v[160:163]
s_waitcnt lgkmcnt(0)
s_barrier
v_mfma_f32_16x16x32_bf16 v[156:159], a[60:63], a[80:83], v[156:159]
ds_read_b128 v[232:235], v10 offset:1792
s_add_u32 m0, s59, 66560
v_mfma_f32_16x16x32_bf16 v[160:163], a[60:63], a[84:87], v[160:163]
ds_read_b128 v[228:231], v10 offset:1536
s_mov_b32 s58, 0
v_mfma_f32_16x16x32_bf16 v[104:107], a[72:75], a[56:59], v[104:107]
ds_read_b128 v[224:227], v10 offset:1280
v_mfma_f32_16x16x32_bf16 v[120:123], a[76:79], a[56:59], v[120:123]
ds_read_b128 v[220:223], v10 offset:1024
v_mfma_f32_16x16x32_bf16 v[136:139], a[56:59], a[80:83], v[136:139]
ds_read_b128 v[240:243], v11 offset:704
v_mfma_f32_16x16x32_bf16 v[152:155], a[56:59], a[84:87], v[152:155]
ds_read_b128 v[244:247], v11 offset:1728
v_mfma_f32_16x16x32_bf16 v[100:103], a[72:75], a[52:55], v[100:103]
buffer_load_dwordx4 v5, s[24:27], s58 offen lds
v_mfma_f32_16x16x32_bf16 v[116:119], a[76:79], a[52:55], v[116:119]
ds_read_b128 v[18:21], v11 offset:448
v_mfma_f32_16x16x32_bf16 v[96:99], a[72:75], a[48:51], v[96:99]
ds_read_b128 v[22:25], v11 offset:1472
s_waitcnt lgkmcnt(7)
v_pk_fma_f32 v[104:105], v[36:37], v[232:233], v[104:105] op_sel_hi:[1,0,1]
v_pk_mul_f32 v[104:105], v[104:105], v[232:233] op_sel:[0,1] op_sel_hi:[1,1]
v_pk_fma_f32 v[106:107], v[38:39], v[232:233], v[106:107] op_sel_hi:[1,0,1]
v_pk_mul_f32 v[106:107], v[106:107], v[232:233] op_sel:[0,1] op_sel_hi:[1,1]
v_pk_fma_f32 v[120:121], v[40:41], v[232:233], v[120:121] op_sel_hi:[1,0,1]
v_pk_mul_f32 v[120:121], v[120:121], v[232:233] op_sel:[0,1] op_sel_hi:[1,1]
v_pk_fma_f32 v[122:123], v[42:43], v[232:233], v[122:123] op_sel_hi:[1,0,1]
v_pk_mul_f32 v[122:123], v[122:123], v[232:233] op_sel:[0,1] op_sel_hi:[1,1]
s_waitcnt lgkmcnt(6)
v_pk_fma_f32 v[100:101], v[36:37], v[228:229], v[100:101] op_sel_hi:[1,0,1]
v_pk_mul_f32 v[100:101], v[100:101], v[228:229] op_sel:[0,1] op_sel_hi:[1,1]
s_waitcnt lgkmcnt(3)
v_pk_fma_f32 v[156:157], v[240:241], v[44:45], v[156:157] op_sel_hi:[1,0,1]
v_pk_fma_f32 v[158:159], v[242:243], v[44:45], v[158:159] op_sel_hi:[1,0,1]
v_pk_fma_f32 v[160:161], v[240:241], v[44:45], v[160:161] op_sel:[0,1,0] op_sel_hi:[1,1,1]
v_pk_fma_f32 v[162:163], v[242:243], v[44:45], v[162:163] op_sel:[0,1,0] op_sel_hi:[1,1,1]
s_waitcnt lgkmcnt(2)
v_pk_mul_f32 v[156:157], v[156:157], v[244:245]
v_pk_mul_f32 v[158:159], v[158:159], v[246:247]
v_pk_mul_f32 v[160:161], v[160:161], v[244:245]
v_pk_mul_f32 v[162:163], v[162:163], v[246:247]
v_pk_fma_f32 v[102:103], v[38:39], v[228:229], v[102:103] op_sel_hi:[1,0,1]
v_pk_mul_f32 v[102:103], v[102:103], v[228:229] op_sel:[0,1] op_sel_hi:[1,1]
v_pk_fma_f32 v[116:117], v[40:41], v[228:229], v[116:117] op_sel_hi:[1,0,1]
v_pk_mul_f32 v[116:117], v[116:117], v[228:229] op_sel:[0,1] op_sel_hi:[1,1]
s_waitcnt lgkmcnt(1)
v_pk_fma_f32 v[136:137], v[18:19], v[44:45], v[136:137] op_sel_hi:[1,0,1]
v_pk_fma_f32 v[138:139], v[20:21], v[44:45], v[138:139] op_sel_hi:[1,0,1]
v_pk_fma_f32 v[152:153], v[18:19], v[44:45], v[152:153] op_sel:[0,1,0] op_sel_hi:[1,1,1]
v_pk_fma_f32 v[154:155], v[20:21], v[44:45], v[154:155] op_sel:[0,1,0] op_sel_hi:[1,1,1]
s_waitcnt lgkmcnt(0)
v_pk_mul_f32 v[136:137], v[136:137], v[22:23]
v_pk_mul_f32 v[138:139], v[138:139], v[24:25]
v_pk_mul_f32 v[152:153], v[152:153], v[22:23]
v_pk_mul_f32 v[154:155], v[154:155], v[24:25]
v_pk_fma_f32 v[118:119], v[42:43], v[228:229], v[118:119] op_sel_hi:[1,0,1]
v_pk_mul_f32 v[118:119], v[118:119], v[228:229] op_sel:[0,1] op_sel_hi:[1,1]
v_pk_fma_f32 v[96:97], v[36:37], v[224:225], v[96:97] op_sel_hi:[1,0,1]
v_pk_mul_f32 v[96:97], v[96:97], v[224:225] op_sel:[0,1] op_sel_hi:[1,1]
v_pk_fma_f32 v[98:99], v[38:39], v[224:225], v[98:99] op_sel_hi:[1,0,1]
v_pk_mul_f32 v[98:99], v[98:99], v[224:225] op_sel:[0,1] op_sel_hi:[1,1]
v_cvt_pk_bf16_f32 v236, v156, v157
v_cvt_pk_bf16_f32 v237, v158, v159
v_mfma_f32_16x16x32_bf16 v[112:115], a[76:79], a[48:51], v[112:115]
buffer_load_dwordx4 v6, s[24:27], s58 offen offset:1024 lds
v_mfma_f32_16x16x32_bf16 v[92:95], a[72:75], a[44:47], v[92:95]
s_add_u32 m0, s59, 0
v_cvt_pk_bf16_f32 v238, v160, v161
v_cvt_pk_bf16_f32 v239, v162, v163
v_mfma_f32_16x16x32_bf16 v[108:111], a[76:79], a[44:47], v[108:111]
ds_write_b128 v8, v[236:239] offset:1024
s_mov_b32 s58, 1048576
v_mfma_f32_16x16x32_bf16 v[72:75], a[64:67], a[56:59], v[72:75]
ds_read_b128 v[240:243], v11 offset:384
v_cvt_pk_bf16_f32 v196, v104, v105
v_mfma_f32_16x16x32_bf16 v[88:91], a[68:71], a[56:59], v[88:91]
buffer_load_dwordx4 v5, s[24:27], s58 offen lds
v_cvt_pk_bf16_f32 v197, v106, v107
v_cvt_pk_bf16_f32 v198, v120, v121
v_cvt_pk_bf16_f32 v199, v122, v123
s_nop 0
v_pk_fma_f32 v[72:73], v[28:29], v[232:233], v[72:73] op_sel_hi:[1,0,1]
v_pk_fma_f32 v[74:75], v[30:31], v[232:233], v[74:75] op_sel_hi:[1,0,1]
s_nop 0
v_pk_fma_f32 v[88:89], v[32:33], v[232:233], v[88:89] op_sel_hi:[1,0,1]
v_pk_fma_f32 v[90:91], v[34:35], v[232:233], v[90:91] op_sel_hi:[1,0,1]
v_pk_fma_f32 v[112:113], v[40:41], v[224:225], v[112:113] op_sel_hi:[1,0,1]
v_pk_mul_f32 v[112:113], v[112:113], v[224:225] op_sel:[0,1] op_sel_hi:[1,1]
v_pk_fma_f32 v[114:115], v[42:43], v[224:225], v[114:115] op_sel_hi:[1,0,1]
v_pk_mul_f32 v[114:115], v[114:115], v[224:225] op_sel:[0,1] op_sel_hi:[1,1]
v_pk_fma_f32 v[92:93], v[36:37], v[220:221], v[92:93] op_sel_hi:[1,0,1]
v_pk_mul_f32 v[92:93], v[92:93], v[220:221] op_sel:[0,1] op_sel_hi:[1,1]
v_pk_fma_f32 v[94:95], v[38:39], v[220:221], v[94:95] op_sel_hi:[1,0,1]
.Lpad23:
s_cbranch_execz .Lnopoll41r
v_pk_mul_f32 v[94:95], v[94:95], v[220:221] op_sel:[0,1] op_sel_hi:[1,1]
v_pk_fma_f32 v[108:109], v[40:41], v[220:221], v[108:109] op_sel_hi:[1,0,1]
v_pk_mul_f32 v[108:109], v[108:109], v[220:221] op_sel:[0,1] op_sel_hi:[1,1]
v_pk_fma_f32 v[110:111], v[42:43], v[220:221], v[110:111] op_sel_hi:[1,0,1]
v_pk_mul_f32 v[110:111], v[110:111], v[220:221] op_sel:[0,1] op_sel_hi:[1,1]
v_cvt_pk_bf16_f32 v208, v136, v137
v_cvt_pk_bf16_f32 v209, v138, v139
v_mfma_f32_16x16x32_bf16 v[132:135], a[52:55], a[80:83], v[132:135]
s_waitcnt lgkmcnt(1)
s_barrier
ds_read_b128 v[180:183], v9
v_mfma_f32_16x16x32_bf16 v[148:151], a[52:55], a[84:87], v[148:151]
ds_read_b64 v[200:201], v9 offset:1024
v_cvt_pk_bf16_f32 v218, v152, v153
v_mfma_f32_16x16x32_bf16 v[68:71], a[64:67], a[52:55], v[68:71]
ds_read_b64 v[210:211], v9 offset:1032
v_cvt_pk_bf16_f32 v219, v154, v155
v_mfma_f32_16x16x32_bf16 v[84:87], a[68:71], a[52:55], v[84:87]
buffer_load_dwordx4 v6, s[24:27], s58 offen offset:1024 lds
v_mfma_f32_16x16x32_bf16 v[128:131], a[48:51], a[80:83], v[128:131]
s_add_u32 m0, s59, 8320
s_mov_b32 s58, 1179648
v_cvt_pk_bf16_f32 v192, v100, v101
v_cvt_pk_bf16_f32 v193, v102, v103
v_cvt_pk_bf16_f32 v194, v116, v117
v_cvt_pk_bf16_f32 v195, v118, v119
s_waitcnt lgkmcnt(3)
v_pk_fma_f32 v[132:133], v[240:241], v[44:45], v[132:133] op_sel_hi:[1,0,1]
v_pk_fma_f32 v[134:135], v[242:243], v[44:45], v[134:135] op_sel_hi:[1,0,1]
v_pk_fma_f32 v[148:149], v[240:241], v[44:45], v[148:149] op_sel:[0,1,0] op_sel_hi:[1,1,1]
v_pk_fma_f32 v[150:151], v[242:243], v[44:45], v[150:151] op_sel:[0,1,0] op_sel_hi:[1,1,1]
v_pk_fma_f32 v[68:69], v[28:29], v[228:229], v[68:69] op_sel_hi:[1,0,1]
v_pk_fma_f32 v[70:71], v[30:31], v[228:229], v[70:71] op_sel_hi:[1,0,1]
v_pk_fma_f32 v[84:85], v[32:33], v[228:229], v[84:85] op_sel_hi:[1,0,1]
v_pk_fma_f32 v[86:87], v[34:35], v[228:229], v[86:87] op_sel_hi:[1,0,1]
v_cvt_pk_bf16_f32 v176, v72, v73
v_cvt_pk_bf16_f32 v177, v74, v75
v_mfma_f32_16x16x32_bf16 v[144:147], a[48:51], a[84:87], v[144:147]
buffer_load_dwordx4 v5, s[24:27], s58 offen lds
v_mfma_f32_16x16x32_bf16 v[64:67], a[64:67], a[48:51], v[64:67]
ds_read_b128 v[244:247], v11 offset:1408
v_cvt_pk_bf16_f32 v178, v88, v89
v_mfma_f32_16x16x32_bf16 v[80:83], a[68:71], a[48:51], v[80:83]
ds_read_b128 v[18:21], v11 offset:320
v_cvt_pk_bf16_f32 v179, v90, v91
v_mfma_f32_16x16x32_bf16 v[124:127], a[44:47], a[80:83], v[124:127]
ds_read_b128 v[22:25], v11 offset:1344
v_cvt_pk_bf16_f32 v188, v96, v97
v_mfma_f32_16x16x32_bf16 v[140:143], a[44:47], a[84:87], v[140:143]
buffer_load_dwordx4 v6, s[24:27], s58 offen offset:1024 lds
v_mfma_f32_16x16x32_bf16 v[60:63], a[64:67], a[44:47], v[60:63]
s_add_u32 m0, s59, 16640
s_mov_b32 s58, 1310720
v_cvt_pk_bf16_f32 v189, v98, v99
v_mfma_f32_16x16x32_bf16 v[76:79], a[68:71], a[44:47], v[76:79]
ds_read_b128 v[240:243], v11 offset:256
v_cvt_pk_bf16_f32 v190, v112, v113
v_mfma_f32_16x16x32_bf16 v[104:107], v[192:195], v[176:179], v[46:49]
v_cvt_pk_bf16_f32 v191, v114, v115
v_cvt_pk_bf16_f32 v172, v68, v69
v_cvt_pk_bf16_f32 v173, v70, v71
v_cvt_pk_bf16_f32 v174, v84, v85
v_cvt_pk_bf16_f32 v175, v86, v87
v_pk_fma_f32 v[64:65], v[28:29], v[224:225], v[64:65] op_sel_hi:[1,0,1]
v_pk_fma_f32 v[66:67], v[30:31], v[224:225], v[66:67] op_sel_hi:[1,0,1]
s_waitcnt lgkmcnt(3)
v_pk_mul_f32 v[132:133], v[132:133], v[244:245]
v_pk_mul_f32 v[134:135], v[134:135], v[246:247]
v_pk_mul_f32 v[148:149], v[148:149], v[244:245]
v_pk_mul_f32 v[150:151], v[150:151], v[246:247]
s_waitcnt lgkmcnt(2)
v_pk_fma_f32 v[128:129], v[18:19], v[44:45], v[128:129] op_sel_hi:[1,0,1]
v_pk_fma_f32 v[130:131], v[20:21], v[44:45], v[130:131] op_sel_hi:[1,0,1]
v_pk_fma_f32 v[144:145], v[18:19], v[44:45], v[144:145] op_sel:[0,1,0] op_sel_hi:[1,1,1]
v_pk_fma_f32 v[146:147], v[20:21], v[44:45], v[146:147] op_sel:[0,1,0] op_sel_hi:[1,1,1]
s_waitcnt lgkmcnt(1)
v_pk_mul_f32 v[128:129], v[128:129], v[22:23]
v_pk_mul_f32 v[130:131], v[130:131], v[24:25]
v_pk_mul_f32 v[144:145], v[144:145], v[22:23]
v_pk_mul_f32 v[146:147], v[146:147], v[24:25]
v_pk_fma_f32 v[80:81], v[32:33], v[224:225], v[80:81] op_sel_hi:[1,0,1]
v_pk_fma_f32 v[82:83], v[34:35], v[224:225], v[82:83] op_sel_hi:[1,0,1]
v_pk_fma_f32 v[60:61], v[28:29], v[220:221], v[60:61] op_sel_hi:[1,0,1]
v_pk_fma_f32 v[62:63], v[30:31], v[220:221], v[62:63] op_sel_hi:[1,0,1]
v_pk_fma_f32 v[76:77], v[32:33], v[220:221], v[76:77] op_sel_hi:[1,0,1]
v_pk_fma_f32 v[78:79], v[34:35], v[220:221], v[78:79] op_sel_hi:[1,0,1]
v_cvt_pk_bf16_f32 v206, v132, v133
v_cvt_pk_bf16_f32 v207, v134, v135
v_mfma_f32_16x16x32_bf16 v[120:123], v[196:199], v[176:179], v[50:53]
buffer_load_dwordx4 v5, s[24:27], s58 offen lds
v_mfma_f32_16x16x32_bf16 v[100:103], v[188:191], v[172:175], v[46:49]
ds_read_b128 v[244:247], v11 offset:1280
v_cvt_pk_bf16_f32 v216, v148, v149
v_mfma_f32_16x16x32_bf16 v[116:119], v[192:195], v[172:175], v[50:53]
v_cvt_pk_bf16_f32 v217, v150, v151
v_max3_f32 v88, v104, v105, v106
s_nop 0
v_max3_f32 v89, v107, v120, v121
v_max3_f32 v88, v88, v122, v123
v_max_f32 v90, v88, v89
v_max_f32 v89, v88, v89
v_cvt_pk_bf16_f32 v204, v128, v129
buffer_load_dwordx4 v6, s[24:27], s58 offen offset:1024 lds
s_add_u32 m0, s59, 74880
s_mov_b32 s58, 131072
v_permlane16_swap_b32 v90, v89
v_cvt_pk_bf16_f32 v205, v130, v131
v_max_f32 v88, v90, v89
v_max_f32 v89, v90, v89
v_cvt_pk_bf16_f32 v214, v144, v145
v_cvt_pk_bf16_f32 v215, v146, v147
v_permlane32_swap_b32 v88, v89
v_max3_f32 v84, v100, v101, v102
v_max_f32 v88, v88, v89
buffer_load_dwordx4 v5, s[24:27], s58 offen lds
v_mul_f32 v88, v88, v234
v_pk_fma_f32 v[104:105], v[104:105], v[234:235], v[88:89] op_sel_hi:[1,0,0] neg_lo:[0,0,1] neg_hi:[0,0,1]
v_pk_fma_f32 v[106:107], v[106:107], v[234:235], v[88:89] op_sel_hi:[1,0,0] neg_lo:[0,0,1] neg_hi:[0,0,1]
v_pk_fma_f32 v[120:121], v[120:121], v[234:235], v[88:89] op_sel_hi:[1,0,0] neg_lo:[0,0,1] neg_hi:[0,0,1]
v_pk_fma_f32 v[122:123], v[122:123], v[234:235], v[88:89] op_sel_hi:[1,0,0] neg_lo:[0,0,1] neg_hi:[0,0,1]
v_exp_f32 v104, v104
v_exp_f32 v105, v105
v_exp_f32 v106, v106
v_exp_f32 v107, v107
v_exp_f32 v120, v120
v_exp_f32 v121, v121
v_exp_f32 v122, v122
v_exp_f32 v123, v123
v_cvt_pk_bf16_f32 v72, v104, v105
buffer_load_dwordx4 v6, s[24:27], s58 offen offset:1024 lds
s_add_u32 m0, s59, 83200
s_mov_b32 s58, 262144
v_cvt_pk_bf16_f32 v73, v106, v107
v_cvt_pk_bf16_f32 v74, v120, v121
v_cvt_pk_bf16_f32 v75, v122, v123
s_waitcnt lgkmcnt(1)
v_pk_fma_f32 v[124:125], v[240:241], v[44:45], v[124:125] op_sel_hi:[1,0,1]
s_waitcnt lgkmcnt(0)
v_pk_mul_f32 v[124:125], v[124:125], v[244:245]
v_pk_fma_f32 v[126:127], v[242:243], v[44:45], v[126:127] op_sel_hi:[1,0,1]
v_pk_mul_f32 v[126:127], v[126:127], v[246:247]
v_pk_fma_f32 v[140:141], v[240:241], v[44:45], v[140:141] op_sel:[0,1,0] op_sel_hi:[1,1,1]
v_pk_mul_f32 v[140:141], v[140:141], v[244:245]
v_pk_fma_f32 v[142:143], v[242:243], v[44:45], v[142:143] op_sel:[0,1,0] op_sel_hi:[1,1,1]
v_pk_mul_f32 v[142:143], v[142:143], v[246:247]
v_max3_f32 v85, v103, v116, v117
v_max3_f32 v84, v84, v118, v119
v_mfma_f32_16x16x32_bf16 v[88:91], v[248:251], v[72:75], 0
buffer_load_dwordx4 v5, s[24:27], s58 offen lds
v_mfma_f32_16x16x32_bf16 v[104:107], v[206:209], v[72:75], 0
v_max_f32 v86, v84, v85
v_max_f32 v85, v84, v85
v_mfma_f32_16x16x32_bf16 v[120:123], v[216:219], v[72:75], 0
s_nop 2
v_rcp_f32 v88, v88
v_permlane16_swap_b32 v86, v85
v_cvt_pk_bf16_f32 v184, v92, v93
v_pk_mul_f32 v[104:105], v[104:105], v[88:89] op_sel_hi:[1,0]
v_pk_mul_f32 v[106:107], v[106:107], v[88:89] op_sel_hi:[1,0]
buffer_load_dwordx4 v6, s[24:27], s58 offen offset:1024 lds
v_pk_mul_f32 v[120:121], v[120:121], v[88:89] op_sel_hi:[1,0]
v_pk_mul_f32 v[122:123], v[122:123], v[88:89] op_sel_hi:[1,0]
v_cvt_pk_bf16_f32 v176, v104, v105
v_cvt_pk_bf16_f32 v177, v106, v107
v_cvt_pk_bf16_f32 v178, v120, v121
v_cvt_pk_bf16_f32 v179, v122, v123
v_max_f32 v84, v86, v85
v_max_f32 v85, v86, v85
v_cvt_pk_bf16_f32 v185, v94, v95
v_cvt_pk_bf16_f32 v186, v108, v109
v_permlane32_swap_b32 v84, v85
v_cvt_pk_bf16_f32 v187, v110, v111
buffer_store_dwordx4 v[176:179], v4, s[16:19], s74 offen offset:3072 sc1
v_max_f32 v84, v84, v85
v_mul_f32 v84, v84, v230
v_pk_fma_f32 v[100:101], v[100:101], v[230:231], v[84:85] op_sel_hi:[1,0,0] neg_lo:[0,0,1] neg_hi:[0,0,1]
v_pk_fma_f32 v[102:103], v[102:103], v[230:231], v[84:85] op_sel_hi:[1,0,0] neg_lo:[0,0,1] neg_hi:[0,0,1]
v_pk_fma_f32 v[116:117], v[116:117], v[230:231], v[84:85] op_sel_hi:[1,0,0] neg_lo:[0,0,1] neg_hi:[0,0,1]
v_pk_fma_f32 v[118:119], v[118:119], v[230:231], v[84:85] op_sel_hi:[1,0,0] neg_lo:[0,0,1] neg_hi:[0,0,1]
v_exp_f32 v100, v100
v_exp_f32 v101, v101
v_exp_f32 v102, v102
v_exp_f32 v103, v103
v_exp_f32 v116, v116
v_exp_f32 v117, v117
v_exp_f32 v118, v118
v_exp_f32 v119, v119
v_cvt_pk_bf16_f32 v68, v100, v101
v_cvt_pk_bf16_f32 v69, v102, v103
v_cvt_pk_bf16_f32 v70, v116, v117
v_cvt_pk_bf16_f32 v71, v118, v119
v_cvt_pk_bf16_f32 v168, v64, v65
v_cvt_pk_bf16_f32 v169, v66, v67
v_mfma_f32_16x16x32_bf16 v[84:87], v[248:251], v[68:71], 0
v_cvt_pk_bf16_f32 v170, v80, v81
v_cvt_pk_bf16_f32 v171, v82, v83
v_mfma_f32_16x16x32_bf16 v[100:103], v[204:207], v[68:71], 0
v_cvt_pk_bf16_f32 v202, v124, v125
v_cvt_pk_bf16_f32 v203, v126, v127
v_mfma_f32_16x16x32_bf16 v[116:119], v[214:217], v[68:71], 0
s_nop 1
v_rcp_f32 v84, v84
v_mfma_f32_16x16x32_bf16 v[96:99], v[184:187], v[168:171], v[46:49]
v_cvt_pk_bf16_f32 v212, v140, v141
v_cvt_pk_bf16_f32 v213, v142, v143
v_mfma_f32_16x16x32_bf16 v[112:115], v[188:191], v[168:171], v[50:53]
v_cvt_pk_bf16_f32 v164, v60, v61
v_cvt_pk_bf16_f32 v165, v62, v63
v_cvt_pk_bf16_f32 v166, v76, v77
s_nop 1
v_max3_f32 v80, v96, v97, v98
v_cvt_pk_bf16_f32 v167, v78, v79
v_pk_mul_f32 v[100:101], v[100:101], v[84:85] op_sel_hi:[1,0]
v_pk_mul_f32 v[102:103], v[102:103], v[84:85] op_sel_hi:[1,0]
v_pk_mul_f32 v[116:117], v[116:117], v[84:85] op_sel_hi:[1,0]
v_pk_mul_f32 v[118:119], v[118:119], v[84:85] op_sel_hi:[1,0]
v_cvt_pk_bf16_f32 v172, v100, v101
v_cvt_pk_bf16_f32 v173, v102, v103
v_mfma_f32_16x16x32_bf16 v[92:95], v[180:183], v[164:167], v[46:49]
v_cvt_pk_bf16_f32 v174, v116, v117
v_cvt_pk_bf16_f32 v175, v118, v119
v_mfma_f32_16x16x32_bf16 v[108:111], v[184:187], v[164:167], v[50:53]
buffer_store_dwordx4 v[172:175], v4, s[16:19], s74 offen offset:2048 sc1
v_max3_f32 v81, v99, v112, v113
v_max3_f32 v80, v80, v114, v115
v_max_f32 v82, v80, v81
v_max_f32 v81, v80, v81
v_max3_f32 v76, v92, v93, v94
s_nop 1
v_max3_f32 v77, v95, v108, v109
v_permlane16_swap_b32 v82, v81
v_max3_f32 v76, v76, v110, v111
v_max_f32 v80, v82, v81
v_max_f32 v81, v82, v81
v_max_f32 v78, v76, v77
v_max_f32 v77, v76, v77
v_permlane32_swap_b32 v80, v81
s_nop 0
v_permlane16_swap_b32 v78, v77
v_max_f32 v80, v80, v81
v_mul_f32 v80, v80, v226
v_pk_fma_f32 v[96:97], v[96:97], v[226:227], v[80:81] op_sel_hi:[1,0,0] neg_lo:[0,0,1] neg_hi:[0,0,1]
v_pk_fma_f32 v[98:99], v[98:99], v[226:227], v[80:81] op_sel_hi:[1,0,0] neg_lo:[0,0,1] neg_hi:[0,0,1]
v_pk_fma_f32 v[112:113], v[112:113], v[226:227], v[80:81] op_sel_hi:[1,0,0] neg_lo:[0,0,1] neg_hi:[0,0,1]
v_pk_fma_f32 v[114:115], v[114:115], v[226:227], v[80:81] op_sel_hi:[1,0,0] neg_lo:[0,0,1] neg_hi:[0,0,1]
v_exp_f32 v96, v96
v_exp_f32 v97, v97
v_exp_f32 v98, v98
v_exp_f32 v99, v99
v_exp_f32 v112, v112
v_exp_f32 v113, v113
v_exp_f32 v114, v114
v_exp_f32 v115, v115
v_cvt_pk_bf16_f32 v64, v96, v97
v_cvt_pk_bf16_f32 v65, v98, v99
v_cvt_pk_bf16_f32 v66, v112, v113
v_cvt_pk_bf16_f32 v67, v114, v115
v_max_f32 v76, v78, v77
v_max_f32 v77, v78, v77
v_mfma_f32_16x16x32_bf16 v[80:83], v[248:251], v[64:67], 0
s_nop 0
v_permlane32_swap_b32 v76, v77
v_mfma_f32_16x16x32_bf16 v[96:99], v[202:205], v[64:67], 0
v_max_f32 v76, v76, v77
v_mul_f32 v76, v76, v222
v_mfma_f32_16x16x32_bf16 v[112:115], v[212:215], v[64:67], 0
s_nop 1
v_rcp_f32 v80, v80
s_nop 1
v_pk_mul_f32 v[96:97], v[96:97], v[80:81] op_sel_hi:[1,0]
v_pk_mul_f32 v[98:99], v[98:99], v[80:81] op_sel_hi:[1,0]
s_nop 0
v_pk_mul_f32 v[112:113], v[112:113], v[80:81] op_sel_hi:[1,0]
v_pk_mul_f32 v[114:115], v[114:115], v[80:81] op_sel_hi:[1,0]
v_cvt_pk_bf16_f32 v168, v96, v97
v_cvt_pk_bf16_f32 v169, v98, v99
v_cvt_pk_bf16_f32 v170, v112, v113
v_cvt_pk_bf16_f32 v171, v114, v115
buffer_store_dwordx4 v[168:171], v4, s[16:19], s74 offen offset:1024 sc1
v_pk_fma_f32 v[92:93], v[92:93], v[222:223], v[76:77] op_sel_hi:[1,0,0] neg_lo:[0,0,1] neg_hi:[0,0,1]
v_pk_fma_f32 v[94:95], v[94:95], v[222:223], v[76:77] op_sel_hi:[1,0,0] neg_lo:[0,0,1] neg_hi:[0,0,1]
v_pk_fma_f32 v[108:109], v[108:109], v[222:223], v[76:77] op_sel_hi:[1,0,0] neg_lo:[0,0,1] neg_hi:[0,0,1]
v_pk_fma_f32 v[110:111], v[110:111], v[222:223], v[76:77] op_sel_hi:[1,0,0] neg_lo:[0,0,1] neg_hi:[0,0,1]
v_exp_f32 v92, v92
v_exp_f32 v93, v93
v_exp_f32 v94, v94
v_exp_f32 v95, v95
v_exp_f32 v108, v108
v_exp_f32 v109, v109
v_exp_f32 v110, v110
v_exp_f32 v111, v111
v_cvt_pk_bf16_f32 v60, v92, v93
v_cvt_pk_bf16_f32 v61, v94, v95
v_cvt_pk_bf16_f32 v62, v108, v109
v_cvt_pk_bf16_f32 v63, v110, v111
s_nop 1
v_mfma_f32_16x16x32_bf16 v[76:79], v[248:251], v[60:63], 0
v_mfma_f32_16x16x32_bf16 v[92:95], v[200:203], v[60:63], 0
v_mfma_f32_16x16x32_bf16 v[108:111], v[210:213], v[60:63], 0
s_nop 5
v_rcp_f32 v76, v76
s_nop 0
v_pk_mul_f32 v[92:93], v[92:93], v[76:77] op_sel_hi:[1,0]
v_pk_mul_f32 v[94:95], v[94:95], v[76:77] op_sel_hi:[1,0]
v_pk_mul_f32 v[108:109], v[108:109], v[76:77] op_sel_hi:[1,0]
v_pk_mul_f32 v[110:111], v[110:111], v[76:77] op_sel_hi:[1,0]
v_cvt_pk_bf16_f32 v164, v92, v93
v_cvt_pk_bf16_f32 v165, v94, v95
v_cvt_pk_bf16_f32 v166, v108, v109
v_cvt_pk_bf16_f32 v167, v110, v111
buffer_store_dwordx4 v[164:167], v4, s[16:19], s74 offen sc1
s_nop 1
.Lqkve43:
.Lpad24:
s_cbranch_execz .Lnopoll41r
s_lshl_b32 s62, s6, 13
s_lshl_b32 s63, s3, 11
s_add_u32 s62, s62, s63
v_lshl_add_u32 v4, v1, 4, s62
v_lshrrev_b32 v2, 3, v1
v_cmp_eq_u32 vcc, 3, v2
v_add_u32 v2, 67108480, v4
s_nop 0
v_cndmask_b32 v4, v4, v2, vcc
v_bfe_u32 v5, v1, 3, 1
v_lshrrev_b32 v2, 4, v1
v_lshl_add_u32 v5, v2, 3, v5
s_lshl_b32 s62, s3, 1
v_add_u32 v5, s62, v5
v_mul_u32_u24 v5, 2048, v5
v_and_b32 v2, 7, v1
v_lshl_add_u32 v5, v2, 4, v5
s_lshl_b32 s62, s7, 7
v_add_u32 v5, s62, v5
v_add_u32 v6, 64512, v5
v_bfe_u32 v8, v1, 3, 2
v_mul_u32_u24 v8, 2080, v8
v_bfe_u32 v2, v1, 2, 1
v_lshl_add_u32 v8, v2, 7, v8
v_bfe_u32 v2, v1, 5, 1
v_lshl_add_u32 v8, v2, 8, v8
v_and_b32 v2, 3, v1
v_lshl_add_u32 v8, v2, 3, v8
s_mov_b32 s57, 66560
v_add_u32 v7, s57, v8
s_mov_b32 s52, 37748736
s_mov_b32 s53, 37879808
s_mov_b32 s54, 2097152
s_mul_i32 s56, s3, 2080
v_accvgpr_read_b32 v32, a224
v_accvgpr_read_b32 v33, a225
v_accvgpr_read_b32 v34, a226
v_accvgpr_read_b32 v35, a227
v_accvgpr_read_b32 v36, a228
v_accvgpr_read_b32 v37, a229
v_accvgpr_read_b32 v38, a230
v_accvgpr_read_b32 v39, a231
v_accvgpr_read_b32 v40, a232
v_accvgpr_read_b32 v41, a233
v_accvgpr_read_b32 v42, a234
v_accvgpr_read_b32 v43, a235
v_accvgpr_read_b32 v44, a236
v_accvgpr_read_b32 v45, a237
v_accvgpr_read_b32 v46, a238
v_accvgpr_read_b32 v47, a239
v_accvgpr_read_b32 v48, a240
v_accvgpr_read_b32 v49, a241
v_accvgpr_read_b32 v50, a242
v_accvgpr_read_b32 v51, a243
v_accvgpr_read_b32 v52, a244
v_accvgpr_read_b32 v53, a245
v_accvgpr_read_b32 v54, a246
v_accvgpr_read_b32 v55, a247
v_accvgpr_read_b32 v56, a248
v_accvgpr_read_b32 v57, a249
v_accvgpr_read_b32 v58, a250
v_accvgpr_read_b32 v59, a251
v_accvgpr_read_b32 v60, a252
v_accvgpr_read_b32 v61, a253
v_accvgpr_read_b32 v62, a254
v_accvgpr_read_b32 v63, a255
s_and_b32 s62, s3, 1
s_mul_i32 s62, s62, 28672
s_add_u32 s62, s62, s51
v_lshrrev_b32 v12, 4, v1
v_mul_u32_u24 v12, 57344, v12
v_and_b32 v2, 15, v1
v_lshl_add_u32 v12, v2, 4, v12
v_add_u32 v12, s62, v12
v_add_u32 v13, 6112, v12
v_add_u32 v14, 12224, v12
v_add_u32 v15, 18336, v12
s_mul_i32 s59, s3, 4224
s_mov_b32 s58, 0
s_lshl_b32 s62, s8, 7
s_add_u32 s62, s62, 30418944
s_lshl_b32 s64, s6, 7
s_add_u32 s64, s64, 30418944
v_mov_b32 v252, s62
v_mov_b32 v253, s64
s_waitcnt vmcnt(0) lgkmcnt(0)
s_barrier
s_cmp_lg_u32 s3, 0
s_cbranch_scc1 .Lnosig46
v_mov_b32 v255, 1
s_mov_b64 exec, 1
buffer_atomic_add v255, v252, s[16:19], 0 offen
s_mov_b64 exec, -1
.Lnosig46:
ds_read_b64_tr_b16 a[0:1], v7
ds_read_b64_tr_b16 a[2:3], v7 offset:512
ds_read_b64_tr_b16 a[4:5], v7 offset:32
ds_read_b64_tr_b16 a[6:7], v7 offset:544
ds_read_b64_tr_b16 a[8:9], v7 offset:64
ds_read_b64_tr_b16 a[10:11], v7 offset:576
ds_read_b64_tr_b16 a[12:13], v7 offset:96
ds_read_b64_tr_b16 a[14:15], v7 offset:608
ds_read_b64_tr_b16 a[16:17], v7 offset:1024
ds_read_b64_tr_b16 a[18:19], v7 offset:1536
ds_read_b64_tr_b16 a[20:21], v7 offset:1056
ds_read_b64_tr_b16 a[22:23], v7 offset:1568
ds_read_b64_tr_b16 a[24:25], v7 offset:1088
ds_read_b64_tr_b16 a[26:27], v7 offset:1600
ds_read_b64_tr_b16 a[28:29], v7 offset:1120
ds_read_b64_tr_b16 a[30:31], v7 offset:1632
s_waitcnt lgkmcnt(0)
s_cmp_lg_u32 s3, 1
s_cbranch_scc1 .Lnopoll49
s_mov_b64 exec, 1
s_mov_b32 s15, 0
.Lpoll47:
buffer_load_dword v255, v253, s[16:19], 0 offen sc1
s_add_u32 s15, s15, 1
s_cmp_gt_u32 s15, 100000
s_cbranch_scc1 .Lgot48
s_waitcnt vmcnt(0)
v_cmp_ne_u32 vcc, 16, v255
s_nop 0
s_cbranch_vccnz .Lpoll47
.Lgot48:
s_waitcnt vmcnt(0)
s_branch .Lnopoll49r
.Lnopoll49:
s_mov_b64 exec, 0
s_cmp_eq_u32 s3, 2
s_cbranch_scc1 .Lpad25
s_cmp_eq_u32 s3, 3
s_cbranch_scc1 .Lpad26
s_branch .Lnopoll49r
.Lnopoll49r:
s_mov_b64 exec, -1
s_barrier
buffer_load_dwordx4 v[64:67], v4, s[16:19], s52 offen sc1
buffer_load_dwordx4 v[68:71], v4, s[16:19], s52 offen offset:1024 sc1
s_add_u32 s52, s52, 0x40000
buffer_load_dwordx4 v[72:75], v4, s[16:19], s53 offen sc1
buffer_load_dwordx4 v[76:79], v4, s[16:19], s53 offen offset:1024 sc1
s_add_u32 s53, s53, 0x40000
buffer_load_dwordx4 v[80:83], v4, s[16:19], s52 offen sc1
buffer_load_dwordx4 v[84:87], v4, s[16:19], s52 offen offset:1024 sc1
s_add_u32 s52, s52, 0x40000
buffer_load_dwordx4 v[88:91], v4, s[16:19], s53 offen sc1
buffer_load_dwordx4 v[92:95], v4, s[16:19], s53 offen offset:1024 sc1
s_add_u32 s53, s53, 0x40000
buffer_load_dwordx4 v[96:99], v4, s[16:19], s52 offen sc1
buffer_load_dwordx4 v[100:103], v4, s[16:19], s52 offen offset:1024 sc1
s_add_u32 s52, s52, 0x40000
buffer_load_dwordx4 v[104:107], v4, s[16:19], s53 offen sc1
buffer_load_dwordx4 v[108:111], v4, s[16:19], s53 offen offset:1024 sc1
s_add_u32 s53, s53, 0x40000
s_waitcnt vmcnt(11)
v_mfma_f32_16x16x32_bf16 v[32:35], a[0:3], v[64:67], v[32:35]
ds_read_b64_tr_b16 a[32:33], v7 offset:8320
ds_read_b64_tr_b16 a[34:35], v7 offset:8832
s_waitcnt vmcnt(10)
v_mfma_f32_16x16x32_bf16 v[48:51], a[0:3], v[68:71], v[48:51]
buffer_load_dwordx4 v[112:115], v4, s[16:19], s52 offen sc1
v_mfma_f32_16x16x32_bf16 v[36:39], a[4:7], v[64:67], v[36:39]
ds_read_b64_tr_b16 a[36:37], v7 offset:8352
ds_read_b64_tr_b16 a[38:39], v7 offset:8864
v_mfma_f32_16x16x32_bf16 v[52:55], a[4:7], v[68:71], v[52:55]
ds_read_b64_tr_b16 a[40:41], v7 offset:8384
ds_read_b64_tr_b16 a[42:43], v7 offset:8896
v_mfma_f32_16x16x32_bf16 v[40:43], a[8:11], v[64:67], v[40:43]
buffer_load_dwordx4 v[116:119], v4, s[16:19], s52 offen offset:1024 sc1
v_mfma_f32_16x16x32_bf16 v[56:59], a[8:11], v[68:71], v[56:59]
ds_read_b64_tr_b16 a[44:45], v7 offset:8416
s_add_u32 s52, s52, 0x40000
v_mfma_f32_16x16x32_bf16 v[44:47], a[12:15], v[64:67], v[44:47]
ds_read_b64_tr_b16 a[46:47], v7 offset:8928
v_mfma_f32_16x16x32_bf16 v[60:63], a[12:15], v[68:71], v[60:63]
ds_read_b64_tr_b16 a[48:49], v7 offset:9344
ds_read_b64_tr_b16 a[50:51], v7 offset:9856
s_waitcnt vmcnt(11)
v_mfma_f32_16x16x32_bf16 v[32:35], a[16:19], v[72:75], v[32:35]
buffer_load_dwordx4 v[120:123], v4, s[16:19], s53 offen sc1
s_waitcnt vmcnt(11)
v_mfma_f32_16x16x32_bf16 v[48:51], a[16:19], v[76:79], v[48:51]
ds_read_b64_tr_b16 a[52:53], v7 offset:9376
ds_read_b64_tr_b16 a[54:55], v7 offset:9888
v_mfma_f32_16x16x32_bf16 v[36:39], a[20:23], v[72:75], v[36:39]
ds_read_b64_tr_b16 a[56:57], v7 offset:9408
ds_read_b64_tr_b16 a[58:59], v7 offset:9920
v_mfma_f32_16x16x32_bf16 v[52:55], a[20:23], v[76:79], v[52:55]
buffer_load_dwordx4 v[124:127], v4, s[16:19], s53 offen offset:1024 sc1
v_mfma_f32_16x16x32_bf16 v[40:43], a[24:27], v[72:75], v[40:43]
ds_read_b64_tr_b16 a[60:61], v7 offset:9440
s_add_u32 s53, s53, 0x40000
v_mfma_f32_16x16x32_bf16 v[56:59], a[24:27], v[76:79], v[56:59]
ds_read_b64_tr_b16 a[62:63], v7 offset:9952
v_mfma_f32_16x16x32_bf16 v[44:47], a[28:31], v[72:75], v[44:47]
v_mfma_f32_16x16x32_bf16 v[60:63], a[28:31], v[76:79], v[60:63]
s_waitcnt vmcnt(11) lgkmcnt(14)
v_mfma_f32_16x16x32_bf16 v[32:35], a[32:35], v[80:83], v[32:35]
ds_read_b64_tr_b16 a[0:1], v7 offset:16640
ds_read_b64_tr_b16 a[2:3], v7 offset:17152
s_waitcnt vmcnt(10)
v_mfma_f32_16x16x32_bf16 v[48:51], a[32:35], v[84:87], v[48:51]
buffer_load_dwordx4 v[64:67], v4, s[16:19], s52 offen sc1
s_waitcnt lgkmcnt(14)
v_mfma_f32_16x16x32_bf16 v[36:39], a[36:39], v[80:83], v[36:39]
ds_read_b64_tr_b16 a[4:5], v7 offset:16672
ds_read_b64_tr_b16 a[6:7], v7 offset:17184
v_mfma_f32_16x16x32_bf16 v[52:55], a[36:39], v[84:87], v[52:55]
ds_read_b64_tr_b16 a[8:9], v7 offset:16704
ds_read_b64_tr_b16 a[10:11], v7 offset:17216
s_waitcnt lgkmcnt(15)
v_mfma_f32_16x16x32_bf16 v[40:43], a[40:43], v[80:83], v[40:43]
buffer_load_dwordx4 v[68:71], v4, s[16:19], s52 offen offset:1024 sc1
v_mfma_f32_16x16x32_bf16 v[56:59], a[40:43], v[84:87], v[56:59]
ds_read_b64_tr_b16 a[12:13], v7 offset:16736
s_add_u32 s52, s52, 0x40000
s_waitcnt lgkmcnt(15)
v_mfma_f32_16x16x32_bf16 v[44:47], a[44:47], v[80:83], v[44:47]
ds_read_b64_tr_b16 a[14:15], v7 offset:17248
v_mfma_f32_16x16x32_bf16 v[60:63], a[44:47], v[84:87], v[60:63]
ds_read_b64_tr_b16 a[16:17], v7 offset:17664
ds_read_b64_tr_b16 a[18:19], v7 offset:18176
s_waitcnt vmcnt(11) lgkmcnt(15)
v_mfma_f32_16x16x32_bf16 v[32:35], a[48:51], v[88:91], v[32:35]
buffer_load_dwordx4 v[72:75], v4, s[16:19], s53 offen sc1
s_waitcnt vmcnt(11)
v_mfma_f32_16x16x32_bf16 v[48:51], a[48:51], v[92:95], v[48:51]
ds_read_b64_tr_b16 a[20:21], v7 offset:17696
ds_read_b64_tr_b16 a[22:23], v7 offset:18208
s_waitcnt lgkmcnt(15)
v_mfma_f32_16x16x32_bf16 v[36:39], a[52:55], v[88:91], v[36:39]
ds_read_b64_tr_b16 a[24:25], v7 offset:17728
ds_read_b64_tr_b16 a[26:27], v7 offset:18240
v_mfma_f32_16x16x32_bf16 v[52:55], a[52:55], v[92:95], v[52:55]
buffer_load_dwordx4 v[76:79], v4, s[16:19], s53 offen offset:1024 sc1
s_waitcnt lgkmcnt(15)
v_mfma_f32_16x16x32_bf16 v[40:43], a[56:59], v[88:91], v[40:43]
ds_read_b64_tr_b16 a[28:29], v7 offset:17760
s_add_u32 s53, s53, 0x40000
v_mfma_f32_16x16x32_bf16 v[56:59], a[56:59], v[92:95], v[56:59]
ds_read_b64_tr_b16 a[30:31], v7 offset:18272
s_waitcnt lgkmcnt(15)
v_mfma_f32_16x16x32_bf16 v[44:47], a[60:63], v[88:91], v[44:47]
v_mfma_f32_16x16x32_bf16 v[60:63], a[60:63], v[92:95], v[60:63]
s_waitcnt vmcnt(11) lgkmcnt(14)
v_mfma_f32_16x16x32_bf16 v[32:35], a[0:3], v[96:99], v[32:35]
ds_read_b64_tr_b16 a[32:33], v7 offset:24960
ds_read_b64_tr_b16 a[34:35], v7 offset:25472
s_waitcnt vmcnt(10)
v_mfma_f32_16x16x32_bf16 v[48:51], a[0:3], v[100:103], v[48:51]
buffer_load_dwordx4 v[80:83], v4, s[16:19], s52 offen sc1
s_waitcnt lgkmcnt(14)
v_mfma_f32_16x16x32_bf16 v[36:39], a[4:7], v[96:99], v[36:39]
ds_read_b64_tr_b16 a[36:37], v7 offset:24992
ds_read_b64_tr_b16 a[38:39], v7 offset:25504
v_mfma_f32_16x16x32_bf16 v[52:55], a[4:7], v[100:103], v[52:55]
ds_read_b64_tr_b16 a[40:41], v7 offset:25024
ds_read_b64_tr_b16 a[42:43], v7 offset:25536
s_waitcnt lgkmcnt(15)
v_mfma_f32_16x16x32_bf16 v[40:43], a[8:11], v[96:99], v[40:43]
buffer_load_dwordx4 v[84:87], v4, s[16:19], s52 offen offset:1024 sc1
v_mfma_f32_16x16x32_bf16 v[56:59], a[8:11], v[100:103], v[56:59]
ds_read_b64_tr_b16 a[44:45], v7 offset:25056
s_add_u32 s52, s52, 0x40000
s_waitcnt lgkmcnt(15)
v_mfma_f32_16x16x32_bf16 v[44:47], a[12:15], v[96:99], v[44:47]
ds_read_b64_tr_b16 a[46:47], v7 offset:25568
v_mfma_f32_16x16x32_bf16 v[60:63], a[12:15], v[100:103], v[60:63]
ds_read_b64_tr_b16 a[48:49], v7 offset:25984
ds_read_b64_tr_b16 a[50:51], v7 offset:26496
s_waitcnt vmcnt(11) lgkmcnt(15)
v_mfma_f32_16x16x32_bf16 v[32:35], a[16:19], v[104:107], v[32:35]
buffer_load_dwordx4 v[88:91], v4, s[16:19], s53 offen sc1
s_waitcnt vmcnt(11)
v_mfma_f32_16x16x32_bf16 v[48:51], a[16:19], v[108:111], v[48:51]
ds_read_b64_tr_b16 a[52:53], v7 offset:26016
ds_read_b64_tr_b16 a[54:55], v7 offset:26528
s_waitcnt lgkmcnt(15)
v_mfma_f32_16x16x32_bf16 v[36:39], a[20:23], v[104:107], v[36:39]
ds_read_b64_tr_b16 a[56:57], v7 offset:26048
ds_read_b64_tr_b16 a[58:59], v7 offset:26560
v_mfma_f32_16x16x32_bf16 v[52:55], a[20:23], v[108:111], v[52:55]
buffer_load_dwordx4 v[92:95], v4, s[16:19], s53 offen offset:1024 sc1
s_waitcnt lgkmcnt(15)
v_mfma_f32_16x16x32_bf16 v[40:43], a[24:27], v[104:107], v[40:43]
ds_read_b64_tr_b16 a[60:61], v7 offset:26080
.Lpad25:
s_cbranch_execz .Lnopoll49r
s_add_u32 s53, s53, 0x40000
v_mfma_f32_16x16x32_bf16 v[56:59], a[24:27], v[108:111], v[56:59]
ds_read_b64_tr_b16 a[62:63], v7 offset:26592
s_waitcnt lgkmcnt(15)
v_mfma_f32_16x16x32_bf16 v[44:47], a[28:31], v[104:107], v[44:47]
v_mfma_f32_16x16x32_bf16 v[60:63], a[28:31], v[108:111], v[60:63]
s_waitcnt vmcnt(11) lgkmcnt(14)
v_mfma_f32_16x16x32_bf16 v[32:35], a[32:35], v[112:115], v[32:35]
ds_read_b64_tr_b16 a[0:1], v7 offset:33280
ds_read_b64_tr_b16 a[2:3], v7 offset:33792
s_waitcnt vmcnt(10)
v_mfma_f32_16x16x32_bf16 v[48:51], a[32:35], v[116:119], v[48:51]
buffer_load_dwordx4 v[96:99], v4, s[16:19], s52 offen sc1
s_waitcnt lgkmcnt(14)
v_mfma_f32_16x16x32_bf16 v[36:39], a[36:39], v[112:115], v[36:39]
ds_read_b64_tr_b16 a[4:5], v7 offset:33312
ds_read_b64_tr_b16 a[6:7], v7 offset:33824
v_mfma_f32_16x16x32_bf16 v[52:55], a[36:39], v[116:119], v[52:55]
ds_read_b64_tr_b16 a[8:9], v7 offset:33344
ds_read_b64_tr_b16 a[10:11], v7 offset:33856
s_waitcnt lgkmcnt(15)
v_mfma_f32_16x16x32_bf16 v[40:43], a[40:43], v[112:115], v[40:43]
buffer_load_dwordx4 v[100:103], v4, s[16:19], s52 offen offset:1024 sc1
v_mfma_f32_16x16x32_bf16 v[56:59], a[40:43], v[116:119], v[56:59]
ds_read_b64_tr_b16 a[12:13], v7 offset:33376
s_add_u32 s52, s52, 0x40000
s_waitcnt lgkmcnt(15)
v_mfma_f32_16x16x32_bf16 v[44:47], a[44:47], v[112:115], v[44:47]
ds_read_b64_tr_b16 a[14:15], v7 offset:33888
v_mfma_f32_16x16x32_bf16 v[60:63], a[44:47], v[116:119], v[60:63]
ds_read_b64_tr_b16 a[16:17], v7 offset:34304
ds_read_b64_tr_b16 a[18:19], v7 offset:34816
s_waitcnt vmcnt(11) lgkmcnt(15)
v_mfma_f32_16x16x32_bf16 v[32:35], a[48:51], v[120:123], v[32:35]
buffer_load_dwordx4 v[104:107], v4, s[16:19], s53 offen sc1
s_waitcnt vmcnt(11)
v_mfma_f32_16x16x32_bf16 v[48:51], a[48:51], v[124:127], v[48:51]
ds_read_b64_tr_b16 a[20:21], v7 offset:34336
ds_read_b64_tr_b16 a[22:23], v7 offset:34848
s_waitcnt lgkmcnt(15)
v_mfma_f32_16x16x32_bf16 v[36:39], a[52:55], v[120:123], v[36:39]
ds_read_b64_tr_b16 a[24:25], v7 offset:34368
ds_read_b64_tr_b16 a[26:27], v7 offset:34880
v_mfma_f32_16x16x32_bf16 v[52:55], a[52:55], v[124:127], v[52:55]
buffer_load_dwordx4 v[108:111], v4, s[16:19], s53 offen offset:1024 sc1
s_waitcnt lgkmcnt(15)
v_mfma_f32_16x16x32_bf16 v[40:43], a[56:59], v[120:123], v[40:43]
ds_read_b64_tr_b16 a[28:29], v7 offset:34400
s_add_u32 s53, s53, 0x40000
v_mfma_f32_16x16x32_bf16 v[56:59], a[56:59], v[124:127], v[56:59]
ds_read_b64_tr_b16 a[30:31], v7 offset:34912
s_waitcnt lgkmcnt(15)
v_mfma_f32_16x16x32_bf16 v[44:47], a[60:63], v[120:123], v[44:47]
v_mfma_f32_16x16x32_bf16 v[60:63], a[60:63], v[124:127], v[60:63]
s_waitcnt vmcnt(11) lgkmcnt(14)
v_mfma_f32_16x16x32_bf16 v[32:35], a[0:3], v[64:67], v[32:35]
ds_read_b64_tr_b16 a[32:33], v7 offset:41600
ds_read_b64_tr_b16 a[34:35], v7 offset:42112
s_waitcnt vmcnt(10)
v_mfma_f32_16x16x32_bf16 v[48:51], a[0:3], v[68:71], v[48:51]
buffer_load_dwordx4 v[112:115], v4, s[16:19], s52 offen sc1
s_waitcnt lgkmcnt(14)
v_mfma_f32_16x16x32_bf16 v[36:39], a[4:7], v[64:67], v[36:39]
ds_read_b64_tr_b16 a[36:37], v7 offset:41632
ds_read_b64_tr_b16 a[38:39], v7 offset:42144
v_mfma_f32_16x16x32_bf16 v[52:55], a[4:7], v[68:71], v[52:55]
ds_read_b64_tr_b16 a[40:41], v7 offset:41664
ds_read_b64_tr_b16 a[42:43], v7 offset:42176
s_waitcnt lgkmcnt(15)
v_mfma_f32_16x16x32_bf16 v[40:43], a[8:11], v[64:67], v[40:43]
buffer_load_dwordx4 v[116:119], v4, s[16:19], s52 offen offset:1024 sc1
v_mfma_f32_16x16x32_bf16 v[56:59], a[8:11], v[68:71], v[56:59]
ds_read_b64_tr_b16 a[44:45], v7 offset:41696
s_add_u32 s52, s52, 0x40000
s_waitcnt lgkmcnt(15)
v_mfma_f32_16x16x32_bf16 v[44:47], a[12:15], v[64:67], v[44:47]
ds_read_b64_tr_b16 a[46:47], v7 offset:42208
v_mfma_f32_16x16x32_bf16 v[60:63], a[12:15], v[68:71], v[60:63]
ds_read_b64_tr_b16 a[48:49], v7 offset:42624
ds_read_b64_tr_b16 a[50:51], v7 offset:43136
s_waitcnt vmcnt(11) lgkmcnt(15)
v_mfma_f32_16x16x32_bf16 v[32:35], a[16:19], v[72:75], v[32:35]
buffer_load_dwordx4 v[120:123], v4, s[16:19], s53 offen sc1
s_waitcnt vmcnt(11)
v_mfma_f32_16x16x32_bf16 v[48:51], a[16:19], v[76:79], v[48:51]
ds_read_b64_tr_b16 a[52:53], v7 offset:42656
ds_read_b64_tr_b16 a[54:55], v7 offset:43168
s_waitcnt lgkmcnt(15)
v_mfma_f32_16x16x32_bf16 v[36:39], a[20:23], v[72:75], v[36:39]
ds_read_b64_tr_b16 a[56:57], v7 offset:42688
ds_read_b64_tr_b16 a[58:59], v7 offset:43200
v_mfma_f32_16x16x32_bf16 v[52:55], a[20:23], v[76:79], v[52:55]
buffer_load_dwordx4 v[124:127], v4, s[16:19], s53 offen offset:1024 sc1
s_waitcnt lgkmcnt(15)
v_mfma_f32_16x16x32_bf16 v[40:43], a[24:27], v[72:75], v[40:43]
ds_read_b64_tr_b16 a[60:61], v7 offset:42720
s_add_u32 s53, s53, 0x40000
v_mfma_f32_16x16x32_bf16 v[56:59], a[24:27], v[76:79], v[56:59]
ds_read_b64_tr_b16 a[62:63], v7 offset:43232
s_waitcnt lgkmcnt(15)
v_mfma_f32_16x16x32_bf16 v[44:47], a[28:31], v[72:75], v[44:47]
v_mfma_f32_16x16x32_bf16 v[60:63], a[28:31], v[76:79], v[60:63]
s_waitcnt vmcnt(11) lgkmcnt(14)
v_mfma_f32_16x16x32_bf16 v[32:35], a[32:35], v[80:83], v[32:35]
ds_read_b64_tr_b16 a[0:1], v7 offset:49920
ds_read_b64_tr_b16 a[2:3], v7 offset:50432
s_waitcnt vmcnt(10)
v_mfma_f32_16x16x32_bf16 v[48:51], a[32:35], v[84:87], v[48:51]
buffer_load_dwordx4 v[64:67], v4, s[16:19], s52 offen sc1
s_waitcnt lgkmcnt(14)
v_mfma_f32_16x16x32_bf16 v[36:39], a[36:39], v[80:83], v[36:39]
ds_read_b64_tr_b16 a[4:5], v7 offset:49952
ds_read_b64_tr_b16 a[6:7], v7 offset:50464
v_mfma_f32_16x16x32_bf16 v[52:55], a[36:39], v[84:87], v[52:55]
ds_read_b64_tr_b16 a[8:9], v7 offset:49984
ds_read_b64_tr_b16 a[10:11], v7 offset:50496
s_waitcnt lgkmcnt(15)
v_mfma_f32_16x16x32_bf16 v[40:43], a[40:43], v[80:83], v[40:43]
buffer_load_dwordx4 v[68:71], v4, s[16:19], s52 offen offset:1024 sc1
v_mfma_f32_16x16x32_bf16 v[56:59], a[40:43], v[84:87], v[56:59]
ds_read_b64_tr_b16 a[12:13], v7 offset:50016
s_add_u32 s52, s52, 0x40000
s_waitcnt lgkmcnt(15)
v_mfma_f32_16x16x32_bf16 v[44:47], a[44:47], v[80:83], v[44:47]
ds_read_b64_tr_b16 a[14:15], v7 offset:50528
v_mfma_f32_16x16x32_bf16 v[60:63], a[44:47], v[84:87], v[60:63]
ds_read_b64_tr_b16 a[16:17], v7 offset:50944
ds_read_b64_tr_b16 a[18:19], v7 offset:51456
s_waitcnt vmcnt(11) lgkmcnt(15)
v_mfma_f32_16x16x32_bf16 v[32:35], a[48:51], v[88:91], v[32:35]
buffer_load_dwordx4 v[72:75], v4, s[16:19], s53 offen sc1
s_waitcnt vmcnt(11)
v_mfma_f32_16x16x32_bf16 v[48:51], a[48:51], v[92:95], v[48:51]
ds_read_b64_tr_b16 a[20:21], v7 offset:50976
ds_read_b64_tr_b16 a[22:23], v7 offset:51488
s_waitcnt lgkmcnt(15)
v_mfma_f32_16x16x32_bf16 v[36:39], a[52:55], v[88:91], v[36:39]
ds_read_b64_tr_b16 a[24:25], v7 offset:51008
ds_read_b64_tr_b16 a[26:27], v7 offset:51520
v_mfma_f32_16x16x32_bf16 v[52:55], a[52:55], v[92:95], v[52:55]
buffer_load_dwordx4 v[76:79], v4, s[16:19], s53 offen offset:1024 sc1
s_waitcnt lgkmcnt(15)
v_mfma_f32_16x16x32_bf16 v[40:43], a[56:59], v[88:91], v[40:43]
ds_read_b64_tr_b16 a[28:29], v7 offset:51040
s_add_u32 s53, s53, 0x40000
v_mfma_f32_16x16x32_bf16 v[56:59], a[56:59], v[92:95], v[56:59]
ds_read_b64_tr_b16 a[30:31], v7 offset:51552
s_waitcnt lgkmcnt(15)
v_mfma_f32_16x16x32_bf16 v[44:47], a[60:63], v[88:91], v[44:47]
v_mfma_f32_16x16x32_bf16 v[60:63], a[60:63], v[92:95], v[60:63]
s_waitcnt vmcnt(11) lgkmcnt(14)
v_mfma_f32_16x16x32_bf16 v[32:35], a[0:3], v[96:99], v[32:35]
ds_read_b64_tr_b16 a[32:33], v7 offset:58240
ds_read_b64_tr_b16 a[34:35], v7 offset:58752
s_waitcnt vmcnt(10)
v_mfma_f32_16x16x32_bf16 v[48:51], a[0:3], v[100:103], v[48:51]
buffer_load_dwordx4 v[80:83], v4, s[16:19], s52 offen sc1
s_waitcnt lgkmcnt(14)
v_mfma_f32_16x16x32_bf16 v[36:39], a[4:7], v[96:99], v[36:39]
ds_read_b64_tr_b16 a[36:37], v7 offset:58272
ds_read_b64_tr_b16 a[38:39], v7 offset:58784
v_mfma_f32_16x16x32_bf16 v[52:55], a[4:7], v[100:103], v[52:55]
ds_read_b64_tr_b16 a[40:41], v7 offset:58304
ds_read_b64_tr_b16 a[42:43], v7 offset:58816
s_waitcnt lgkmcnt(15)
v_mfma_f32_16x16x32_bf16 v[40:43], a[8:11], v[96:99], v[40:43]
buffer_load_dwordx4 v[84:87], v4, s[16:19], s52 offen offset:1024 sc1
v_mfma_f32_16x16x32_bf16 v[56:59], a[8:11], v[100:103], v[56:59]
ds_read_b64_tr_b16 a[44:45], v7 offset:58336
s_add_u32 s52, s52, 0x40000
s_waitcnt lgkmcnt(15)
v_mfma_f32_16x16x32_bf16 v[44:47], a[12:15], v[96:99], v[44:47]
ds_read_b64_tr_b16 a[46:47], v7 offset:58848
v_mfma_f32_16x16x32_bf16 v[60:63], a[12:15], v[100:103], v[60:63]
ds_read_b64_tr_b16 a[48:49], v7 offset:59264
ds_read_b64_tr_b16 a[50:51], v7 offset:59776
s_waitcnt vmcnt(11) lgkmcnt(15)
v_mfma_f32_16x16x32_bf16 v[32:35], a[16:19], v[104:107], v[32:35]
buffer_load_dwordx4 v[88:91], v4, s[16:19], s53 offen sc1
s_waitcnt vmcnt(11)
v_mfma_f32_16x16x32_bf16 v[48:51], a[16:19], v[108:111], v[48:51]
ds_read_b64_tr_b16 a[52:53], v7 offset:59296
ds_read_b64_tr_b16 a[54:55], v7 offset:59808
s_waitcnt lgkmcnt(15)
v_mfma_f32_16x16x32_bf16 v[36:39], a[20:23], v[104:107], v[36:39]
ds_read_b64_tr_b16 a[56:57], v7 offset:59328
ds_read_b64_tr_b16 a[58:59], v7 offset:59840
v_mfma_f32_16x16x32_bf16 v[52:55], a[20:23], v[108:111], v[52:55]
buffer_load_dwordx4 v[92:95], v4, s[16:19], s53 offen offset:1024 sc1
s_waitcnt lgkmcnt(15)
v_mfma_f32_16x16x32_bf16 v[40:43], a[24:27], v[104:107], v[40:43]
ds_read_b64_tr_b16 a[60:61], v7 offset:59360
s_add_u32 s53, s53, 0x40000
v_mfma_f32_16x16x32_bf16 v[56:59], a[24:27], v[108:111], v[56:59]
ds_read_b64_tr_b16 a[62:63], v7 offset:59872
s_waitcnt lgkmcnt(15)
v_mfma_f32_16x16x32_bf16 v[44:47], a[28:31], v[104:107], v[44:47]
v_mfma_f32_16x16x32_bf16 v[60:63], a[28:31], v[108:111], v[60:63]
s_xor_b32 s57, s57, 66560
v_add_u32 v7, s57, v8
s_waitcnt vmcnt(11) lgkmcnt(14)
v_mfma_f32_16x16x32_bf16 v[32:35], a[32:35], v[112:115], v[32:35]
ds_read_b64_tr_b16 a[0:1], v7
ds_read_b64_tr_b16 a[2:3], v7 offset:512
s_waitcnt vmcnt(10)
v_mfma_f32_16x16x32_bf16 v[48:51], a[32:35], v[116:119], v[48:51]
buffer_load_dwordx4 v[96:99], v4, s[16:19], s52 offen sc1
s_waitcnt lgkmcnt(14)
v_mfma_f32_16x16x32_bf16 v[36:39], a[36:39], v[112:115], v[36:39]
ds_read_b64_tr_b16 a[4:5], v7 offset:32
ds_read_b64_tr_b16 a[6:7], v7 offset:544
v_mfma_f32_16x16x32_bf16 v[52:55], a[36:39], v[116:119], v[52:55]
ds_read_b64_tr_b16 a[8:9], v7 offset:64
ds_read_b64_tr_b16 a[10:11], v7 offset:576
s_waitcnt lgkmcnt(15)
v_mfma_f32_16x16x32_bf16 v[40:43], a[40:43], v[112:115], v[40:43]
buffer_load_dwordx4 v[100:103], v4, s[16:19], s52 offen offset:1024 sc1
v_mfma_f32_16x16x32_bf16 v[56:59], a[40:43], v[116:119], v[56:59]
ds_read_b64_tr_b16 a[12:13], v7 offset:96
s_add_u32 s52, s52, 0x40000
s_waitcnt lgkmcnt(15)
v_mfma_f32_16x16x32_bf16 v[44:47], a[44:47], v[112:115], v[44:47]
ds_read_b64_tr_b16 a[14:15], v7 offset:608
v_mfma_f32_16x16x32_bf16 v[60:63], a[44:47], v[116:119], v[60:63]
ds_read_b64_tr_b16 a[16:17], v7 offset:1024
ds_read_b64_tr_b16 a[18:19], v7 offset:1536
s_waitcnt vmcnt(11) lgkmcnt(15)
v_mfma_f32_16x16x32_bf16 v[32:35], a[48:51], v[120:123], v[32:35]
buffer_load_dwordx4 v[104:107], v4, s[16:19], s53 offen sc1
s_waitcnt vmcnt(11)
v_mfma_f32_16x16x32_bf16 v[48:51], a[48:51], v[124:127], v[48:51]
ds_read_b64_tr_b16 a[20:21], v7 offset:1056
ds_read_b64_tr_b16 a[22:23], v7 offset:1568
s_waitcnt lgkmcnt(15)
v_mfma_f32_16x16x32_bf16 v[36:39], a[52:55], v[120:123], v[36:39]
ds_read_b64_tr_b16 a[24:25], v7 offset:1088
ds_read_b64_tr_b16 a[26:27], v7 offset:1600
v_mfma_f32_16x16x32_bf16 v[52:55], a[52:55], v[124:127], v[52:55]
buffer_load_dwordx4 v[108:111], v4, s[16:19], s53 offen offset:1024 sc1
s_waitcnt lgkmcnt(15)
v_mfma_f32_16x16x32_bf16 v[40:43], a[56:59], v[120:123], v[40:43]
ds_read_b64_tr_b16 a[28:29], v7 offset:1120
s_add_u32 s53, s53, 0x40000
v_mfma_f32_16x16x32_bf16 v[56:59], a[56:59], v[124:127], v[56:59]
ds_read_b64_tr_b16 a[30:31], v7 offset:1632
s_waitcnt lgkmcnt(15)
v_mfma_f32_16x16x32_bf16 v[44:47], a[60:63], v[120:123], v[44:47]
v_mfma_f32_16x16x32_bf16 v[60:63], a[60:63], v[124:127], v[60:63]
s_waitcnt vmcnt(11) lgkmcnt(14)
v_mfma_f32_16x16x32_bf16 v[32:35], a[0:3], v[64:67], v[32:35]
ds_read_b64_tr_b16 a[32:33], v7 offset:8320
ds_read_b64_tr_b16 a[34:35], v7 offset:8832
s_waitcnt vmcnt(10)
v_mfma_f32_16x16x32_bf16 v[48:51], a[0:3], v[68:71], v[48:51]
buffer_load_dwordx4 v[112:115], v4, s[16:19], s52 offen sc1
s_waitcnt lgkmcnt(14)
v_mfma_f32_16x16x32_bf16 v[36:39], a[4:7], v[64:67], v[36:39]
ds_read_b64_tr_b16 a[36:37], v7 offset:8352
ds_read_b64_tr_b16 a[38:39], v7 offset:8864
v_mfma_f32_16x16x32_bf16 v[52:55], a[4:7], v[68:71], v[52:55]
ds_read_b64_tr_b16 a[40:41], v7 offset:8384
ds_read_b64_tr_b16 a[42:43], v7 offset:8896
s_waitcnt lgkmcnt(15)
v_mfma_f32_16x16x32_bf16 v[40:43], a[8:11], v[64:67], v[40:43]
buffer_load_dwordx4 v[116:119], v4, s[16:19], s52 offen offset:1024 sc1
v_mfma_f32_16x16x32_bf16 v[56:59], a[8:11], v[68:71], v[56:59]
ds_read_b64_tr_b16 a[44:45], v7 offset:8416
s_add_u32 s52, s52, 0x40000
s_waitcnt lgkmcnt(15)
v_mfma_f32_16x16x32_bf16 v[44:47], a[12:15], v[64:67], v[44:47]
ds_read_b64_tr_b16 a[46:47], v7 offset:8928
v_mfma_f32_16x16x32_bf16 v[60:63], a[12:15], v[68:71], v[60:63]
ds_read_b64_tr_b16 a[48:49], v7 offset:9344
ds_read_b64_tr_b16 a[50:51], v7 offset:9856
s_waitcnt vmcnt(11) lgkmcnt(15)
v_mfma_f32_16x16x32_bf16 v[32:35], a[16:19], v[72:75], v[32:35]
buffer_load_dwordx4 v[120:123], v4, s[16:19], s53 offen sc1
s_waitcnt vmcnt(11)
v_mfma_f32_16x16x32_bf16 v[48:51], a[16:19], v[76:79], v[48:51]
ds_read_b64_tr_b16 a[52:53], v7 offset:9376
ds_read_b64_tr_b16 a[54:55], v7 offset:9888
s_waitcnt lgkmcnt(15)
v_mfma_f32_16x16x32_bf16 v[36:39], a[20:23], v[72:75], v[36:39]
ds_read_b64_tr_b16 a[56:57], v7 offset:9408
ds_read_b64_tr_b16 a[58:59], v7 offset:9920
v_mfma_f32_16x16x32_bf16 v[52:55], a[20:23], v[76:79], v[52:55]
buffer_load_dwordx4 v[124:127], v4, s[16:19], s53 offen offset:1024 sc1
s_waitcnt lgkmcnt(15)
v_mfma_f32_16x16x32_bf16 v[40:43], a[24:27], v[72:75], v[40:43]
ds_read_b64_tr_b16 a[60:61], v7 offset:9440
s_add_u32 s53, s53, 0x40000
v_mfma_f32_16x16x32_bf16 v[56:59], a[24:27], v[76:79], v[56:59]
ds_read_b64_tr_b16 a[62:63], v7 offset:9952
s_waitcnt lgkmcnt(15)
v_mfma_f32_16x16x32_bf16 v[44:47], a[28:31], v[72:75], v[44:47]
v_mfma_f32_16x16x32_bf16 v[60:63], a[28:31], v[76:79], v[60:63]
s_waitcnt vmcnt(11) lgkmcnt(14)
v_mfma_f32_16x16x32_bf16 v[32:35], a[32:35], v[80:83], v[32:35]
ds_read_b64_tr_b16 a[0:1], v7 offset:16640
ds_read_b64_tr_b16 a[2:3], v7 offset:17152
s_waitcnt vmcnt(10)
v_mfma_f32_16x16x32_bf16 v[48:51], a[32:35], v[84:87], v[48:51]
buffer_load_dwordx4 v[64:67], v4, s[16:19], s52 offen sc1
s_waitcnt lgkmcnt(14)
v_mfma_f32_16x16x32_bf16 v[36:39], a[36:39], v[80:83], v[36:39]
ds_read_b64_tr_b16 a[4:5], v7 offset:16672
ds_read_b64_tr_b16 a[6:7], v7 offset:17184
v_mfma_f32_16x16x32_bf16 v[52:55], a[36:39], v[84:87], v[52:55]
ds_read_b64_tr_b16 a[8:9], v7 offset:16704
ds_read_b64_tr_b16 a[10:11], v7 offset:17216
s_waitcnt lgkmcnt(15)
v_mfma_f32_16x16x32_bf16 v[40:43], a[40:43], v[80:83], v[40:43]
buffer_load_dwordx4 v[68:71], v4, s[16:19], s52 offen offset:1024 sc1
v_mfma_f32_16x16x32_bf16 v[56:59], a[40:43], v[84:87], v[56:59]
ds_read_b64_tr_b16 a[12:13], v7 offset:16736
s_add_u32 s52, s52, 0x40000
s_waitcnt lgkmcnt(15)
v_mfma_f32_16x16x32_bf16 v[44:47], a[44:47], v[80:83], v[44:47]
ds_read_b64_tr_b16 a[14:15], v7 offset:17248
v_mfma_f32_16x16x32_bf16 v[60:63], a[44:47], v[84:87], v[60:63]
ds_read_b64_tr_b16 a[16:17], v7 offset:17664
ds_read_b64_tr_b16 a[18:19], v7 offset:18176
s_waitcnt vmcnt(11) lgkmcnt(15)
v_mfma_f32_16x16x32_bf16 v[32:35], a[48:51], v[88:91], v[32:35]
buffer_load_dwordx4 v[72:75], v4, s[16:19], s53 offen sc1
s_waitcnt vmcnt(11)
v_mfma_f32_16x16x32_bf16 v[48:51], a[48:51], v[92:95], v[48:51]
ds_read_b64_tr_b16 a[20:21], v7 offset:17696
ds_read_b64_tr_b16 a[22:23], v7 offset:18208
s_waitcnt lgkmcnt(15)
v_mfma_f32_16x16x32_bf16 v[36:39], a[52:55], v[88:91], v[36:39]
ds_read_b64_tr_b16 a[24:25], v7 offset:17728
ds_read_b64_tr_b16 a[26:27], v7 offset:18240
v_mfma_f32_16x16x32_bf16 v[52:55], a[52:55], v[92:95], v[52:55]
buffer_load_dwordx4 v[76:79], v4, s[16:19], s53 offen offset:1024 sc1
s_waitcnt lgkmcnt(15)
v_mfma_f32_16x16x32_bf16 v[40:43], a[56:59], v[88:91], v[40:43]
ds_read_b64_tr_b16 a[28:29], v7 offset:17760
s_add_u32 s53, s53, 0x40000
v_mfma_f32_16x16x32_bf16 v[56:59], a[56:59], v[92:95], v[56:59]
ds_read_b64_tr_b16 a[30:31], v7 offset:18272
s_waitcnt lgkmcnt(15)
v_mfma_f32_16x16x32_bf16 v[44:47], a[60:63], v[88:91], v[44:47]
v_mfma_f32_16x16x32_bf16 v[60:63], a[60:63], v[92:95], v[60:63]
s_waitcnt vmcnt(11) lgkmcnt(14)
v_mfma_f32_16x16x32_bf16 v[32:35], a[0:3], v[96:99], v[32:35]
ds_read_b64_tr_b16 a[32:33], v7 offset:24960
ds_read_b64_tr_b16 a[34:35], v7 offset:25472
s_waitcnt vmcnt(10)
v_mfma_f32_16x16x32_bf16 v[48:51], a[0:3], v[100:103], v[48:51]
buffer_load_dwordx4 v[80:83], v4, s[16:19], s52 offen sc1
s_waitcnt lgkmcnt(14)
v_mfma_f32_16x16x32_bf16 v[36:39], a[4:7], v[96:99], v[36:39]
ds_read_b64_tr_b16 a[36:37], v7 offset:24992
ds_read_b64_tr_b16 a[38:39], v7 offset:25504
v_mfma_f32_16x16x32_bf16 v[52:55], a[4:7], v[100:103], v[52:55]
ds_read_b64_tr_b16 a[40:41], v7 offset:25024
ds_read_b64_tr_b16 a[42:43], v7 offset:25536
s_waitcnt lgkmcnt(15)
v_mfma_f32_16x16x32_bf16 v[40:43], a[8:11], v[96:99], v[40:43]
buffer_load_dwordx4 v[84:87], v4, s[16:19], s52 offen offset:1024 sc1
v_mfma_f32_16x16x32_bf16 v[56:59], a[8:11], v[100:103], v[56:59]
ds_read_b64_tr_b16 a[44:45], v7 offset:25056
s_add_u32 s52, s52, 0x40000
s_waitcnt lgkmcnt(15)
v_mfma_f32_16x16x32_bf16 v[44:47], a[12:15], v[96:99], v[44:47]
ds_read_b64_tr_b16 a[46:47], v7 offset:25568
v_mfma_f32_16x16x32_bf16 v[60:63], a[12:15], v[100:103], v[60:63]
ds_read_b64_tr_b16 a[48:49], v7 offset:25984
ds_read_b64_tr_b16 a[50:51], v7 offset:26496
s_waitcnt vmcnt(11) lgkmcnt(15)
v_mfma_f32_16x16x32_bf16 v[32:35], a[16:19], v[104:107], v[32:35]
buffer_load_dwordx4 v[88:91], v4, s[16:19], s53 offen sc1
s_waitcnt vmcnt(11)
v_mfma_f32_16x16x32_bf16 v[48:51], a[16:19], v[108:111], v[48:51]
ds_read_b64_tr_b16 a[52:53], v7 offset:26016
ds_read_b64_tr_b16 a[54:55], v7 offset:26528
s_waitcnt lgkmcnt(15)
v_mfma_f32_16x16x32_bf16 v[36:39], a[20:23], v[104:107], v[36:39]
ds_read_b64_tr_b16 a[56:57], v7 offset:26048
ds_read_b64_tr_b16 a[58:59], v7 offset:26560
v_mfma_f32_16x16x32_bf16 v[52:55], a[20:23], v[108:111], v[52:55]
buffer_load_dwordx4 v[92:95], v4, s[16:19], s53 offen offset:1024 sc1
s_waitcnt lgkmcnt(15)
v_mfma_f32_16x16x32_bf16 v[40:43], a[24:27], v[104:107], v[40:43]
ds_read_b64_tr_b16 a[60:61], v7 offset:26080
s_add_u32 s53, s53, 0x40000
v_mfma_f32_16x16x32_bf16 v[56:59], a[24:27], v[108:111], v[56:59]
ds_read_b64_tr_b16 a[62:63], v7 offset:26592
s_waitcnt lgkmcnt(15)
v_mfma_f32_16x16x32_bf16 v[44:47], a[28:31], v[104:107], v[44:47]
v_mfma_f32_16x16x32_bf16 v[60:63], a[28:31], v[108:111], v[60:63]
s_waitcnt lgkmcnt(0)
s_barrier
s_waitcnt vmcnt(11)
v_mfma_f32_16x16x32_bf16 v[32:35], a[32:35], v[112:115], v[32:35]
ds_read_b64_tr_b16 a[0:1], v7 offset:33280
ds_read_b64_tr_b16 a[2:3], v7 offset:33792
ds_read_b64_tr_b16 a[4:5], v7 offset:33312
s_waitcnt vmcnt(10)
v_mfma_f32_16x16x32_bf16 v[48:51], a[32:35], v[116:119], v[48:51]
ds_read_b64_tr_b16 a[6:7], v7 offset:33824
buffer_load_dwordx4 v[96:99], v4, s[16:19], s52 offen sc1
v_mfma_f32_16x16x32_bf16 v[36:39], a[36:39], v[112:115], v[36:39]
ds_read_b64_tr_b16 a[8:9], v7 offset:33344
buffer_load_dwordx4 v[100:103], v4, s[16:19], s52 offen offset:1024 sc1
v_mfma_f32_16x16x32_bf16 v[52:55], a[36:39], v[116:119], v[52:55]
ds_read_b64_tr_b16 a[10:11], v7 offset:33856
s_add_u32 s52, s52, 0x40000
v_mfma_f32_16x16x32_bf16 v[40:43], a[40:43], v[112:115], v[40:43]
ds_read_b64_tr_b16 a[12:13], v7 offset:33376
buffer_load_dwordx4 v[104:107], v4, s[16:19], s53 offen sc1
v_mfma_f32_16x16x32_bf16 v[56:59], a[40:43], v[116:119], v[56:59]
ds_read_b64_tr_b16 a[14:15], v7 offset:33888
ds_read_b64_tr_b16 a[16:17], v7 offset:34304
ds_read_b64_tr_b16 a[18:19], v7 offset:34816
v_mfma_f32_16x16x32_bf16 v[44:47], a[44:47], v[112:115], v[44:47]
ds_read_b64_tr_b16 a[20:21], v7 offset:34336
buffer_load_dwordx4 v[108:111], v4, s[16:19], s53 offen offset:1024 sc1
v_mfma_f32_16x16x32_bf16 v[60:63], a[44:47], v[116:119], v[60:63]
ds_read_b64_tr_b16 a[22:23], v7 offset:34848
s_add_u32 s53, s53, 0x40000
s_add_u32 m0, s59, 83200
s_waitcnt vmcnt(13)
v_mfma_f32_16x16x32_bf16 v[32:35], a[48:51], v[120:123], v[32:35]
ds_read_b64_tr_b16 a[24:25], v7 offset:34368
buffer_load_dwordx4 v12, s[32:35], s58 offen lds
s_waitcnt vmcnt(13)
v_mfma_f32_16x16x32_bf16 v[48:51], a[48:51], v[124:127], v[48:51]
ds_read_b64_tr_b16 a[26:27], v7 offset:34880
buffer_load_dwordx4 v13, s[32:35], s58 offen offset:1056 lds
v_mfma_f32_16x16x32_bf16 v[36:39], a[52:55], v[120:123], v[36:39]
ds_read_b64_tr_b16 a[28:29], v7 offset:34400
ds_read_b64_tr_b16 a[30:31], v7 offset:34912
v_mfma_f32_16x16x32_bf16 v[52:55], a[52:55], v[124:127], v[52:55]
buffer_load_dwordx4 v14, s[32:35], s58 offen offset:2112 lds
v_mfma_f32_16x16x32_bf16 v[40:43], a[56:59], v[120:123], v[40:43]
v_mfma_f32_16x16x32_bf16 v[56:59], a[56:59], v[124:127], v[56:59]
buffer_load_dwordx4 v15, s[32:35], s58 offen offset:3168 lds
v_mfma_f32_16x16x32_bf16 v[44:47], a[60:63], v[120:123], v[44:47]
s_add_u32 s58, s58, 229376
v_mfma_f32_16x16x32_bf16 v[60:63], a[60:63], v[124:127], v[60:63]
s_waitcnt vmcnt(15) lgkmcnt(14)
v_mfma_f32_16x16x32_bf16 v[32:35], a[0:3], v[64:67], v[32:35]
ds_read_b64_tr_b16 a[32:33], v7 offset:41600
ds_read_b64_tr_b16 a[34:35], v7 offset:42112
s_waitcnt vmcnt(14)
v_mfma_f32_16x16x32_bf16 v[48:51], a[0:3], v[68:71], v[48:51]
ds_read_b64_tr_b16 a[36:37], v7 offset:41632
buffer_load_dwordx4 v[112:115], v4, s[16:19], s52 offen sc1
s_waitcnt lgkmcnt(15)
v_mfma_f32_16x16x32_bf16 v[36:39], a[4:7], v[64:67], v[36:39]
ds_read_b64_tr_b16 a[38:39], v7 offset:42144
buffer_load_dwordx4 v[116:119], v4, s[16:19], s52 offen offset:1024 sc1
v_mfma_f32_16x16x32_bf16 v[52:55], a[4:7], v[68:71], v[52:55]
ds_read_b64_tr_b16 a[40:41], v7 offset:41664
ds_read_b64_tr_b16 a[42:43], v7 offset:42176
s_add_u32 s52, s52, 0x40000
s_waitcnt lgkmcnt(15)
v_mfma_f32_16x16x32_bf16 v[40:43], a[8:11], v[64:67], v[40:43]
buffer_load_dwordx4 v[120:123], v4, s[16:19], s53 offen sc1
v_mfma_f32_16x16x32_bf16 v[56:59], a[8:11], v[68:71], v[56:59]
ds_read_b64_tr_b16 a[44:45], v7 offset:41696
ds_read_b64_tr_b16 a[46:47], v7 offset:42208
s_waitcnt lgkmcnt(15)
v_mfma_f32_16x16x32_bf16 v[44:47], a[12:15], v[64:67], v[44:47]
ds_read_b64_tr_b16 a[48:49], v7 offset:42624
buffer_load_dwordx4 v[124:127], v4, s[16:19], s53 offen offset:1024 sc1
v_mfma_f32_16x16x32_bf16 v[60:63], a[12:15], v[68:71], v[60:63]
ds_read_b64_tr_b16 a[50:51], v7 offset:43136
s_add_u32 s53, s53, 0x40000
s_add_u32 m0, s59, 100096
s_waitcnt vmcnt(17) lgkmcnt(15)
v_mfma_f32_16x16x32_bf16 v[32:35], a[16:19], v[72:75], v[32:35]
ds_read_b64_tr_b16 a[52:53], v7 offset:42656
buffer_load_dwordx4 v12, s[32:35], s58 offen lds
s_waitcnt vmcnt(17)
v_mfma_f32_16x16x32_bf16 v[48:51], a[16:19], v[76:79], v[48:51]
buffer_load_dwordx4 v13, s[32:35], s58 offen offset:1056 lds
s_waitcnt lgkmcnt(15)
v_mfma_f32_16x16x32_bf16 v[36:39], a[20:23], v[72:75], v[36:39]
ds_read_b64_tr_b16 a[54:55], v7 offset:43168
ds_read_b64_tr_b16 a[56:57], v7 offset:42688
v_mfma_f32_16x16x32_bf16 v[52:55], a[20:23], v[76:79], v[52:55]
ds_read_b64_tr_b16 a[58:59], v7 offset:43200
buffer_load_dwordx4 v14, s[32:35], s58 offen offset:2112 lds
s_waitcnt lgkmcnt(15)
v_mfma_f32_16x16x32_bf16 v[40:43], a[24:27], v[72:75], v[40:43]
ds_read_b64_tr_b16 a[60:61], v7 offset:42720
ds_read_b64_tr_b16 a[62:63], v7 offset:43232
v_mfma_f32_16x16x32_bf16 v[56:59], a[24:27], v[76:79], v[56:59]
buffer_load_dwordx4 v15, s[32:35], s58 offen offset:3168 lds
s_waitcnt lgkmcnt(15)
v_mfma_f32_16x16x32_bf16 v[44:47], a[28:31], v[72:75], v[44:47]
s_add_u32 s58, s58, 229376
v_mfma_f32_16x16x32_bf16 v[60:63], a[28:31], v[76:79], v[60:63]
s_waitcnt vmcnt(19) lgkmcnt(14)
v_mfma_f32_16x16x32_bf16 v[32:35], a[32:35], v[80:83], v[32:35]
ds_read_b64_tr_b16 a[0:1], v7 offset:49920
s_add_u32 m0, s59, 116992
s_waitcnt vmcnt(18)
v_mfma_f32_16x16x32_bf16 v[48:51], a[32:35], v[84:87], v[48:51]
buffer_load_dwordx4 v12, s[32:35], s58 offen lds
s_waitcnt lgkmcnt(13)
v_mfma_f32_16x16x32_bf16 v[36:39], a[36:39], v[80:83], v[36:39]
ds_read_b64_tr_b16 a[2:3], v7 offset:50432
ds_read_b64_tr_b16 a[4:5], v7 offset:49952
v_mfma_f32_16x16x32_bf16 v[52:55], a[36:39], v[84:87], v[52:55]
ds_read_b64_tr_b16 a[6:7], v7 offset:50464
ds_read_b64_tr_b16 a[8:9], v7 offset:49984
s_waitcnt lgkmcnt(15)
v_mfma_f32_16x16x32_bf16 v[40:43], a[40:43], v[80:83], v[40:43]
buffer_load_dwordx4 v13, s[32:35], s58 offen offset:1056 lds
v_mfma_f32_16x16x32_bf16 v[56:59], a[40:43], v[84:87], v[56:59]
ds_read_b64_tr_b16 a[10:11], v7 offset:50496
ds_read_b64_tr_b16 a[12:13], v7 offset:50016
s_waitcnt lgkmcnt(15)
v_mfma_f32_16x16x32_bf16 v[44:47], a[44:47], v[80:83], v[44:47]
ds_read_b64_tr_b16 a[14:15], v7 offset:50528
v_mfma_f32_16x16x32_bf16 v[60:63], a[44:47], v[84:87], v[60:63]
ds_read_b64_tr_b16 a[16:17], v7 offset:50944
ds_read_b64_tr_b16 a[18:19], v7 offset:51456
s_waitcnt vmcnt(19) lgkmcnt(15)
v_mfma_f32_16x16x32_bf16 v[32:35], a[48:51], v[88:91], v[32:35]
buffer_load_dwordx4 v14, s[32:35], s58 offen offset:2112 lds
s_waitcnt vmcnt(19)
v_mfma_f32_16x16x32_bf16 v[48:51], a[48:51], v[92:95], v[48:51]
ds_read_b64_tr_b16 a[20:21], v7 offset:50976
ds_read_b64_tr_b16 a[22:23], v7 offset:51488
s_waitcnt lgkmcnt(15)
v_mfma_f32_16x16x32_bf16 v[36:39], a[52:55], v[88:91], v[36:39]
ds_read_b64_tr_b16 a[24:25], v7 offset:51008
ds_read_b64_tr_b16 a[26:27], v7 offset:51520
v_mfma_f32_16x16x32_bf16 v[52:55], a[52:55], v[92:95], v[52:55]
buffer_load_dwordx4 v15, s[32:35], s58 offen offset:3168 lds
s_waitcnt lgkmcnt(15)
v_mfma_f32_16x16x32_bf16 v[40:43], a[56:59], v[88:91], v[40:43]
ds_read_b64_tr_b16 a[28:29], v7 offset:51040
s_add_u32 s58, s58, 229376
v_mfma_f32_16x16x32_bf16 v[56:59], a[56:59], v[92:95], v[56:59]
ds_read_b64_tr_b16 a[30:31], v7 offset:51552
s_waitcnt lgkmcnt(15)
v_mfma_f32_16x16x32_bf16 v[44:47], a[60:63], v[88:91], v[44:47]
v_mfma_f32_16x16x32_bf16 v[60:63], a[60:63], v[92:95], v[60:63]
s_waitcnt vmcnt(19) lgkmcnt(14)
v_mfma_f32_16x16x32_bf16 v[32:35], a[0:3], v[96:99], v[32:35]
ds_read_b64_tr_b16 a[32:33], v7 offset:58240
s_add_u32 m0, s59, 133888
s_waitcnt vmcnt(18)
v_mfma_f32_16x16x32_bf16 v[48:51], a[0:3], v[100:103], v[48:51]
buffer_load_dwordx4 v12, s[32:35], s58 offen lds
s_waitcnt lgkmcnt(13)
v_mfma_f32_16x16x32_bf16 v[36:39], a[4:7], v[96:99], v[36:39]
ds_read_b64_tr_b16 a[34:35], v7 offset:58752
ds_read_b64_tr_b16 a[36:37], v7 offset:58272
v_mfma_f32_16x16x32_bf16 v[52:55], a[4:7], v[100:103], v[52:55]
ds_read_b64_tr_b16 a[38:39], v7 offset:58784
ds_read_b64_tr_b16 a[40:41], v7 offset:58304
s_waitcnt lgkmcnt(15)
v_mfma_f32_16x16x32_bf16 v[40:43], a[8:11], v[96:99], v[40:43]
buffer_load_dwordx4 v13, s[32:35], s58 offen offset:1056 lds
v_mfma_f32_16x16x32_bf16 v[56:59], a[8:11], v[100:103], v[56:59]
ds_read_b64_tr_b16 a[42:43], v7 offset:58816
ds_read_b64_tr_b16 a[44:45], v7 offset:58336
s_waitcnt lgkmcnt(15)
v_mfma_f32_16x16x32_bf16 v[44:47], a[12:15], v[96:99], v[44:47]
ds_read_b64_tr_b16 a[46:47], v7 offset:58848
v_mfma_f32_16x16x32_bf16 v[60:63], a[12:15], v[100:103], v[60:63]
.Lpad26:
s_cbranch_execz .Lnopoll49r
ds_read_b64_tr_b16 a[48:49], v7 offset:59264
ds_read_b64_tr_b16 a[50:51], v7 offset:59776
s_waitcnt vmcnt(19) lgkmcnt(15)
v_mfma_f32_16x16x32_bf16 v[32:35], a[16:19], v[104:107], v[32:35]
buffer_load_dwordx4 v14, s[32:35], s58 offen offset:2112 lds
s_waitcnt vmcnt(19)
v_mfma_f32_16x16x32_bf16 v[48:51], a[16:19], v[108:111], v[48:51]
ds_read_b64_tr_b16 a[52:53], v7 offset:59296
ds_read_b64_tr_b16 a[54:55], v7 offset:59808
s_waitcnt lgkmcnt(15)
v_mfma_f32_16x16x32_bf16 v[36:39], a[20:23], v[104:107], v[36:39]
ds_read_b64_tr_b16 a[56:57], v7 offset:59328
ds_read_b64_tr_b16 a[58:59], v7 offset:59840
v_mfma_f32_16x16x32_bf16 v[52:55], a[20:23], v[108:111], v[52:55]
buffer_load_dwordx4 v15, s[32:35], s58 offen offset:3168 lds
s_waitcnt lgkmcnt(15)
v_mfma_f32_16x16x32_bf16 v[40:43], a[24:27], v[104:107], v[40:43]
ds_read_b64_tr_b16 a[60:61], v7 offset:59360
s_add_u32 s58, s58, 229376
v_mfma_f32_16x16x32_bf16 v[56:59], a[24:27], v[108:111], v[56:59]
ds_read_b64_tr_b16 a[62:63], v7 offset:59872
s_waitcnt lgkmcnt(15)
v_mfma_f32_16x16x32_bf16 v[44:47], a[28:31], v[104:107], v[44:47]
v_mfma_f32_16x16x32_bf16 v[60:63], a[28:31], v[108:111], v[60:63]
s_waitcnt vmcnt(15) lgkmcnt(14)
v_mfma_f32_16x16x32_bf16 v[32:35], a[32:35], v[112:115], v[32:35]
s_lshl_b32 s64, s6, 14
s_lshl_b32 s65, s49, 13
s_add_u32 s64, s64, s65
s_waitcnt vmcnt(14)
v_mfma_f32_16x16x32_bf16 v[48:51], a[32:35], v[116:119], v[48:51]
s_lshl_b32 s65, s7, 9
s_add_u32 s64, s64, s65
s_lshl_b32 s65, s48, 8
s_waitcnt lgkmcnt(12)
v_mfma_f32_16x16x32_bf16 v[36:39], a[36:39], v[112:115], v[36:39]
s_add_u32 s64, s64, s65
s_add_u32 s64, s64, 63176704
v_and_b32 v152, 31, v1
v_mfma_f32_16x16x32_bf16 v[52:55], a[36:39], v[116:119], v[52:55]
s_lshl_b32 s62, s7, 18
v_lshlrev_b32 v152, 3, v152
v_lshrrev_b32 v153, 5, v1
s_waitcnt lgkmcnt(10)
v_mfma_f32_16x16x32_bf16 v[40:43], a[40:43], v[112:115], v[40:43]
s_add_u32 s62, s62, 41943040
v_lshl_add_u32 v152, v153, 2, v152
s_add_u32 s63, s62, 0x20000
v_mfma_f32_16x16x32_bf16 v[56:59], a[40:43], v[116:119], v[56:59]
s_waitcnt lgkmcnt(8)
v_mfma_f32_16x16x32_bf16 v[44:47], a[44:47], v[112:115], v[44:47]
v_mfma_f32_16x16x32_bf16 v[60:63], a[44:47], v[116:119], v[60:63]
s_waitcnt vmcnt(13) lgkmcnt(6)
v_mfma_f32_16x16x32_bf16 v[32:35], a[48:51], v[120:123], v[32:35]
s_waitcnt vmcnt(12)
v_mfma_f32_16x16x32_bf16 v[48:51], a[48:51], v[124:127], v[48:51]
s_waitcnt lgkmcnt(4)
v_mfma_f32_16x16x32_bf16 v[36:39], a[52:55], v[120:123], v[36:39]
s_nop 3
v_cvt_pk_bf16_f32 v128, v32, v33
v_cvt_pk_bf16_f32 v129, v34, v35
v_mfma_f32_16x16x32_bf16 v[52:55], a[52:55], v[124:127], v[52:55]
v_cvt_pk_bf16_f32 v136, v48, v49
v_cvt_pk_bf16_f32 v137, v50, v51
s_waitcnt lgkmcnt(2)
v_mfma_f32_16x16x32_bf16 v[40:43], a[56:59], v[120:123], v[40:43]
v_cvt_pk_bf16_f32 v130, v36, v37
v_cvt_pk_bf16_f32 v131, v38, v39
v_mfma_f32_16x16x32_bf16 v[56:59], a[56:59], v[124:127], v[56:59]
buffer_store_dwordx4 v[128:131], v4, s[16:19], s62 offen sc1
s_waitcnt lgkmcnt(0)
v_mfma_f32_16x16x32_bf16 v[44:47], a[60:63], v[120:123], v[44:47]
s_nop 1
v_cvt_pk_bf16_f32 v132, v40, v41
v_cvt_pk_bf16_f32 v133, v42, v43
v_mfma_f32_16x16x32_bf16 v[60:63], a[60:63], v[124:127], v[60:63]
v_cvt_pk_bf16_f32 v138, v52, v53
v_cvt_pk_bf16_f32 v139, v54, v55
v_cvt_pk_bf16_f32 v140, v56, v57
v_cvt_pk_bf16_f32 v134, v44, v45
v_cvt_pk_bf16_f32 v135, v46, v47
v_cvt_pk_bf16_f32 v141, v58, v59
v_pk_mul_f32 v[146:147], v[32:33], v[32:33]
buffer_store_dwordx4 v[132:135], v4, s[16:19], s63 offen sc1
v_cvt_pk_bf16_f32 v142, v60, v61
v_cvt_pk_bf16_f32 v143, v62, v63
v_pk_mul_f32 v[150:151], v[48:49], v[48:49]
v_pk_fma_f32 v[146:147], v[34:35], v[34:35], v[146:147]
v_pk_add_f32 v[144:145], v[32:33], v[34:35]
v_pk_fma_f32 v[150:151], v[50:51], v[50:51], v[150:151]
v_pk_add_f32 v[148:149], v[48:49], v[50:51]
v_pk_fma_f32 v[146:147], v[36:37], v[36:37], v[146:147]
v_pk_add_f32 v[144:145], v[144:145], v[36:37]
v_pk_fma_f32 v[150:151], v[52:53], v[52:53], v[150:151]
v_pk_add_f32 v[148:149], v[148:149], v[52:53]
v_pk_fma_f32 v[146:147], v[38:39], v[38:39], v[146:147]
v_pk_add_f32 v[144:145], v[144:145], v[38:39]
buffer_store_dwordx4 v[136:139], v4, s[16:19], s62 offen offset:1024 sc1
v_pk_fma_f32 v[150:151], v[54:55], v[54:55], v[150:151]
v_pk_add_f32 v[148:149], v[148:149], v[54:55]
v_pk_fma_f32 v[146:147], v[40:41], v[40:41], v[146:147]
v_pk_add_f32 v[144:145], v[144:145], v[40:41]
v_pk_fma_f32 v[150:151], v[56:57], v[56:57], v[150:151]
v_pk_add_f32 v[148:149], v[148:149], v[56:57]
v_pk_fma_f32 v[146:147], v[42:43], v[42:43], v[146:147]
v_pk_add_f32 v[144:145], v[144:145], v[42:43]
v_pk_fma_f32 v[150:151], v[58:59], v[58:59], v[150:151]
v_pk_add_f32 v[148:149], v[148:149], v[58:59]
v_pk_fma_f32 v[146:147], v[44:45], v[44:45], v[146:147]
v_pk_add_f32 v[144:145], v[144:145], v[44:45]
v_pk_fma_f32 v[150:151], v[60:61], v[60:61], v[150:151]
buffer_store_dwordx4 v[140:143], v4, s[16:19], s63 offen offset:1024 sc1
v_pk_add_f32 v[148:149], v[148:149], v[60:61]
v_pk_fma_f32 v[146:147], v[46:47], v[46:47], v[146:147]
v_pk_add_f32 v[144:145], v[144:145], v[46:47]
v_pk_fma_f32 v[150:151], v[62:63], v[62:63], v[150:151]
v_pk_add_f32 v[148:149], v[148:149], v[62:63]
v_add_f32 v144, v144, v145
v_add_f32 v146, v146, v147
v_add_f32 v148, v148, v149
v_add_f32 v150, v150, v151
s_nop 0
v_permlane16_swap_b32 v144, v148
v_permlane16_swap_b32 v146, v150
v_add_f32 v144, v144, v148
v_add_f32 v146, v146, v150
s_nop 1
v_permlane32_swap_b32 v144, v146
v_add_f32 v144, v144, v146
buffer_store_dword v144, v152, s[16:19], s64 offen sc1
s_nop 1
v_accvgpr_write_b32 a224, v32
v_accvgpr_write_b32 a225, v33
v_accvgpr_write_b32 a226, v34
v_accvgpr_write_b32 a227, v35
v_accvgpr_write_b32 a228, v36
v_accvgpr_write_b32 a229, v37
v_accvgpr_write_b32 a230, v38
v_accvgpr_write_b32 a231, v39
v_accvgpr_write_b32 a232, v40
v_accvgpr_write_b32 a233, v41
v_accvgpr_write_b32 a234, v42
v_accvgpr_write_b32 a235, v43
v_accvgpr_write_b32 a236, v44
v_accvgpr_write_b32 a237, v45
v_accvgpr_write_b32 a238, v46
v_accvgpr_write_b32 a239, v47
v_accvgpr_write_b32 a240, v48
v_accvgpr_write_b32 a241, v49
v_accvgpr_write_b32 a242, v50
v_accvgpr_write_b32 a243, v51
v_accvgpr_write_b32 a244, v52
v_accvgpr_write_b32 a245, v53
v_accvgpr_write_b32 a246, v54
v_accvgpr_write_b32 a247, v55
v_accvgpr_write_b32 a248, v56
v_accvgpr_write_b32 a249, v57
v_accvgpr_write_b32 a250, v58
v_accvgpr_write_b32 a251, v59
v_accvgpr_write_b32 a252, v60
v_accvgpr_write_b32 a253, v61
v_accvgpr_write_b32 a254, v62
v_accvgpr_write_b32 a255, v63
s_lshl_b32 s62, s10, 14
s_lshl_b32 s63, s3, 12
s_add_u32 s62, s62, s63
s_lshl_b32 s63, s12, 11
s_add_u32 s62, s62, s63
v_lshl_add_u32 v10, v1, 4, s62
v_lshrrev_b32 v2, 3, v1
v_cmp_eq_u32 vcc, 3, v2
v_add_u32 v2, 67108480, v10
s_nop 0
v_cndmask_b32 v10, v10, v2, vcc
v_xor_b32 v11, 2048, v10
v_bfe_u32 v16, v1, 2, 3
v_mul_u32_u24 v16, 1056, v16
v_bfe_u32 v2, v1, 5, 1
v_lshl_add_u32 v16, v2, 8, v16
v_and_b32 v2, 3, v1
v_lshl_add_u32 v16, v2, 3, v16
s_lshl_b32 s62, s12, 6
s_add_u32 s62, s62, 83200
s_xor_b32 s63, s12, 1
s_mul_i32 s63, s63, 192
s_add_u32 s63, s63, 83200
v_add_u32 v17, s63, v16
v_add_u32 v16, s62, v16
s_mov_b32 s52, 41943040
s_mov_b32 s54, s58
s_mov_b32 s55, s59
s_mul_i32 s59, s3, 2080
s_lshl_b32 s62, s10, 15
s_lshl_b32 s63, s3, 13
s_add_u32 s62, s62, s63
v_lshl_add_u32 v4, v1, 4, s62
s_lshl_b32 s62, s6, 7
s_add_u32 s62, s62, 30420992
s_lshl_b32 s64, s10, 1
s_lshl_b32 s64, s64, 7
s_add_u32 s64, s64, 30420992
s_add_u32 s65, s64, 128
v_mov_b32 v252, s62
v_mov_b32 v253, s64
v_writelane_b32 v253, s65, 1
s_waitcnt vmcnt(0) lgkmcnt(0)
s_barrier
s_cmp_lg_u32 s3, 0
s_cbranch_scc1 .Lnosig50
v_mov_b32 v255, 1
s_mov_b64 exec, 1
buffer_atomic_add v255, v252, s[16:19], 0 offen
s_mov_b64 exec, -1
.Lnosig50:
ds_read_b64_tr_b16 a[0:1], v16
ds_read_b64_tr_b16 a[2:3], v16 offset:512
ds_read_b64_tr_b16 a[4:5], v16 offset:32
ds_read_b64_tr_b16 a[6:7], v16 offset:544
ds_read_b64_tr_b16 a[8:9], v16 offset:8448
ds_read_b64_tr_b16 a[10:11], v16 offset:8960
ds_read_b64_tr_b16 a[12:13], v16 offset:8480
ds_read_b64_tr_b16 a[14:15], v16 offset:8992
ds_read_b64_tr_b16 a[16:17], v16 offset:64
ds_read_b64_tr_b16 a[18:19], v16 offset:576
ds_read_b64_tr_b16 a[20:21], v16 offset:96
ds_read_b64_tr_b16 a[22:23], v16 offset:608
ds_read_b64_tr_b16 a[24:25], v16 offset:8512
ds_read_b64_tr_b16 a[26:27], v16 offset:9024
ds_read_b64_tr_b16 a[28:29], v16 offset:8544
ds_read_b64_tr_b16 a[30:31], v16 offset:9056
ds_read_b64_tr_b16 a[32:33], v16 offset:128
ds_read_b64_tr_b16 a[34:35], v16 offset:640
ds_read_b64_tr_b16 a[36:37], v16 offset:160
ds_read_b64_tr_b16 a[38:39], v16 offset:672
ds_read_b64_tr_b16 a[40:41], v16 offset:8576
ds_read_b64_tr_b16 a[42:43], v16 offset:9088
ds_read_b64_tr_b16 a[44:45], v16 offset:8608
ds_read_b64_tr_b16 a[46:47], v16 offset:9120
ds_read_b64_tr_b16 a[48:49], v17
ds_read_b64_tr_b16 a[50:51], v17 offset:512
ds_read_b64_tr_b16 a[52:53], v17 offset:32
ds_read_b64_tr_b16 a[54:55], v17 offset:544
ds_read_b64_tr_b16 a[56:57], v17 offset:8448
ds_read_b64_tr_b16 a[58:59], v17 offset:8960
ds_read_b64_tr_b16 a[60:61], v17 offset:8480
ds_read_b64_tr_b16 a[62:63], v17 offset:8992
s_waitcnt lgkmcnt(0)
s_cmp_lg_u32 s3, 1
s_cbranch_scc1 .Lnopoll53
s_mov_b64 exec, 3
s_mov_b32 s15, 0
.Lpoll51:
buffer_load_dword v255, v253, s[16:19], 0 offen sc1
s_add_u32 s15, s15, 1
s_cmp_gt_u32 s15, 100000
s_cbranch_scc1 .Lgot52
s_waitcnt vmcnt(0)
v_cmp_ne_u32 vcc, 16, v255
s_nop 0
s_cbranch_vccnz .Lpoll51
.Lgot52:
s_waitcnt vmcnt(0)
s_branch .Lnopoll53r
.Lnopoll53:
s_mov_b64 exec, 0
s_cmp_eq_u32 s3, 2
s_cbranch_scc1 .Lpad27
s_cmp_eq_u32 s3, 3
s_cbranch_scc1 .Lpad28
s_branch .Lpad29
.Lnopoll53r:
s_mov_b64 exec, -1
s_barrier
buffer_load_dwordx4 a[128:131], v10, s[16:19], s52 offen sc1
buffer_load_dwordx4 a[132:135], v10, s[16:19], s52 offen offset:1024 sc1
buffer_load_dwordx4 a[136:139], v11, s[16:19], s52 offen sc1
buffer_load_dwordx4 a[140:143], v11, s[16:19], s52 offen offset:1024 sc1
s_add_u32 s52, s52, 0x20000
buffer_load_dwordx4 a[144:147], v10, s[16:19], s52 offen sc1
buffer_load_dwordx4 a[148:151], v10, s[16:19], s52 offen offset:1024 sc1
buffer_load_dwordx4 a[152:155], v11, s[16:19], s52 offen sc1
buffer_load_dwordx4 a[156:159], v11, s[16:19], s52 offen offset:1024 sc1
s_add_u32 s52, s52, 0x20000
s_lshl_b32 s74, s3, 13
s_add_u32 s74, s74, 49920
v_lshl_add_u32 v2, v1, 4, s74
s_waitcnt vmcnt(7)
v_mfma_f32_16x16x32_bf16 v[32:35], a[0:3], a[128:131], 0
ds_read_b64_tr_b16 a[64:65], v16 offset:16896
s_waitcnt vmcnt(6)
v_mfma_f32_16x16x32_bf16 v[36:39], a[0:3], a[132:135], 0
buffer_load_dwordx4 a[160:163], v10, s[16:19], s52 offen sc1
s_waitcnt vmcnt(6)
v_mfma_f32_16x16x32_bf16 v[40:43], a[0:3], a[136:139], 0
ds_read_b64_tr_b16 a[66:67], v16 offset:17408
s_waitcnt vmcnt(5)
v_mfma_f32_16x16x32_bf16 v[44:47], a[0:3], a[140:143], 0
ds_read_b64_tr_b16 a[68:69], v16 offset:16928
v_mfma_f32_16x16x32_bf16 v[48:51], a[4:7], a[128:131], 0
ds_read_b64_tr_b16 a[70:71], v16 offset:17440
v_mfma_f32_16x16x32_bf16 v[52:55], a[4:7], a[132:135], 0
buffer_load_dwordx4 a[164:167], v10, s[16:19], s52 offen offset:1024 sc1
v_mfma_f32_16x16x32_bf16 v[56:59], a[4:7], a[136:139], 0
ds_read_b64_tr_b16 a[72:73], v16 offset:25344
v_mfma_f32_16x16x32_bf16 v[60:63], a[4:7], a[140:143], 0
v_mfma_f32_16x16x32_bf16 v[64:67], a[8:11], a[128:131], 0
ds_read_b64_tr_b16 a[74:75], v16 offset:25856
v_mfma_f32_16x16x32_bf16 v[68:71], a[8:11], a[132:135], 0
ds_read_b64_tr_b16 a[76:77], v16 offset:25376
v_mfma_f32_16x16x32_bf16 v[72:75], a[8:11], a[136:139], 0
buffer_load_dwordx4 a[168:171], v11, s[16:19], s52 offen sc1
v_mfma_f32_16x16x32_bf16 v[76:79], a[8:11], a[140:143], 0
ds_read_b64_tr_b16 a[78:79], v16 offset:25888
v_mfma_f32_16x16x32_bf16 v[80:83], a[12:15], a[128:131], 0
ds_read_b64_tr_b16 a[80:81], v16 offset:16960
v_mfma_f32_16x16x32_bf16 v[84:87], a[12:15], a[132:135], 0
ds_read_b64_tr_b16 a[82:83], v16 offset:17472
v_mfma_f32_16x16x32_bf16 v[88:91], a[12:15], a[136:139], 0
buffer_load_dwordx4 a[172:175], v11, s[16:19], s52 offen offset:1024 sc1
v_mfma_f32_16x16x32_bf16 v[92:95], a[12:15], a[140:143], 0
s_add_u32 s52, s52, 0x20000
v_mfma_f32_16x16x32_bf16 v[96:99], a[16:19], a[128:131], 0
ds_read_b64_tr_b16 a[84:85], v16 offset:16992
v_mfma_f32_16x16x32_bf16 v[100:103], a[16:19], a[132:135], 0
ds_read_b64_tr_b16 a[86:87], v16 offset:17504
v_mfma_f32_16x16x32_bf16 v[104:107], a[16:19], a[136:139], 0
ds_read_b64_tr_b16 a[88:89], v16 offset:25408
s_add_u32 m0, s55, 83200
v_mfma_f32_16x16x32_bf16 v[108:111], a[16:19], a[140:143], 0
buffer_load_dwordx4 v12, s[32:35], s54 offen lds
v_mfma_f32_16x16x32_bf16 v[112:115], a[20:23], a[128:131], 0
ds_read_b64_tr_b16 a[90:91], v16 offset:25920
v_mfma_f32_16x16x32_bf16 v[116:119], a[20:23], a[132:135], 0
v_mfma_f32_16x16x32_bf16 v[120:123], a[20:23], a[136:139], 0
ds_read_b64_tr_b16 a[92:93], v16 offset:25440
v_mfma_f32_16x16x32_bf16 v[124:127], a[20:23], a[140:143], 0
buffer_load_dwordx4 a[176:179], v10, s[16:19], s52 offen sc1
v_mfma_f32_16x16x32_bf16 v[128:131], a[24:27], a[128:131], 0
ds_read_b64_tr_b16 a[94:95], v16 offset:25952
v_mfma_f32_16x16x32_bf16 v[132:135], a[24:27], a[132:135], 0
ds_read_b64_tr_b16 a[96:97], v16 offset:17024
v_mfma_f32_16x16x32_bf16 v[136:139], a[24:27], a[136:139], 0
ds_read_b64_tr_b16 a[98:99], v16 offset:17536
v_mfma_f32_16x16x32_bf16 v[140:143], a[24:27], a[140:143], 0
ds_read_b64_tr_b16 a[100:101], v16 offset:17056
v_mfma_f32_16x16x32_bf16 v[144:147], a[28:31], a[128:131], 0
buffer_load_dwordx4 v13, s[32:35], s54 offen offset:1056 lds
v_mfma_f32_16x16x32_bf16 v[148:151], a[28:31], a[132:135], 0
v_mfma_f32_16x16x32_bf16 v[152:155], a[28:31], a[136:139], 0
ds_read_b64_tr_b16 a[102:103], v16 offset:17568
v_mfma_f32_16x16x32_bf16 v[156:159], a[28:31], a[140:143], 0
ds_read_b64_tr_b16 a[104:105], v16 offset:25472
v_mfma_f32_16x16x32_bf16 v[160:163], a[32:35], a[128:131], 0
buffer_load_dwordx4 a[180:183], v10, s[16:19], s52 offen offset:1024 sc1
v_mfma_f32_16x16x32_bf16 v[164:167], a[32:35], a[132:135], 0
ds_read_b64_tr_b16 a[106:107], v16 offset:25984
v_mfma_f32_16x16x32_bf16 v[168:171], a[32:35], a[136:139], 0
ds_read_b64_tr_b16 a[108:109], v16 offset:25504
v_mfma_f32_16x16x32_bf16 v[172:175], a[32:35], a[140:143], 0
v_mfma_f32_16x16x32_bf16 v[176:179], a[36:39], a[128:131], 0
ds_read_b64_tr_b16 a[110:111], v16 offset:26016
v_mfma_f32_16x16x32_bf16 v[180:183], a[36:39], a[132:135], 0
buffer_load_dwordx4 v14, s[32:35], s54 offen offset:2112 lds
v_mfma_f32_16x16x32_bf16 v[184:187], a[36:39], a[136:139], 0
ds_read_b64_tr_b16 a[112:113], v17 offset:16896
v_mfma_f32_16x16x32_bf16 v[188:191], a[36:39], a[140:143], 0
ds_read_b64_tr_b16 a[114:115], v17 offset:17408
v_mfma_f32_16x16x32_bf16 v[192:195], a[40:43], a[128:131], 0
ds_read_b64_tr_b16 a[116:117], v17 offset:16928
v_mfma_f32_16x16x32_bf16 v[196:199], a[40:43], a[132:135], 0
buffer_load_dwordx4 a[184:187], v11, s[16:19], s52 offen sc1
v_mfma_f32_16x16x32_bf16 v[200:203], a[40:43], a[136:139], 0
ds_read_b64_tr_b16 a[118:119], v17 offset:17440
v_mfma_f32_16x16x32_bf16 v[204:207], a[40:43], a[140:143], 0
v_mfma_f32_16x16x32_bf16 v[208:211], a[44:47], a[128:131], 0
ds_read_b64_tr_b16 a[120:121], v17 offset:25344
v_mfma_f32_16x16x32_bf16 v[212:215], a[44:47], a[132:135], 0
ds_read_b64_tr_b16 a[122:123], v17 offset:25856
v_mfma_f32_16x16x32_bf16 v[216:219], a[44:47], a[136:139], 0
buffer_load_dwordx4 v15, s[32:35], s54 offen offset:3168 lds
v_mfma_f32_16x16x32_bf16 v[220:223], a[44:47], a[140:143], 0
ds_read_b64_tr_b16 a[124:125], v17 offset:25376
s_add_u32 s54, s54, 229376
v_mfma_f32_16x16x32_bf16 v[224:227], a[48:51], a[128:131], 0
ds_read_b64_tr_b16 a[126:127], v17 offset:25888
v_mfma_f32_16x16x32_bf16 v[228:231], a[48:51], a[132:135], 0
v_mfma_f32_16x16x32_bf16 v[232:235], a[52:55], a[128:131], 0
buffer_load_dwordx4 a[188:191], v11, s[16:19], s52 offen offset:1024 sc1
v_mfma_f32_16x16x32_bf16 v[236:239], a[52:55], a[132:135], 0
s_add_u32 s52, s52, 0x20000
v_mfma_f32_16x16x32_bf16 v[240:243], a[56:59], a[128:131], 0
v_mfma_f32_16x16x32_bf16 v[244:247], a[56:59], a[132:135], 0
v_mfma_f32_16x16x32_bf16 v[248:251], a[60:63], a[128:131], 0
v_mfma_f32_16x16x32_bf16 v[252:255], a[60:63], a[132:135], 0
s_waitcnt lgkmcnt(0)
s_barrier
s_waitcnt vmcnt(15)
v_mfma_f32_16x16x32_bf16 v[32:35], a[64:67], a[144:147], v[32:35]
s_add_u32 m0, s74, 0
s_mov_b32 s67, 63176704
s_waitcnt vmcnt(14)
v_mfma_f32_16x16x32_bf16 v[36:39], a[64:67], a[148:151], v[36:39]
buffer_load_dwordx4 v4, s[16:19], s67 offen sc1 lds
s_waitcnt vmcnt(14)
v_mfma_f32_16x16x32_bf16 v[40:43], a[64:67], a[152:155], v[40:43]
ds_read_b64_tr_b16 a[0:1], v16 offset:33792
s_waitcnt vmcnt(13)
v_mfma_f32_16x16x32_bf16 v[44:47], a[64:67], a[156:159], v[44:47]
ds_read_b64_tr_b16 a[2:3], v16 offset:34304
v_mfma_f32_16x16x32_bf16 v[48:51], a[68:71], a[144:147], v[48:51]
buffer_load_dwordx4 v4, s[16:19], s67 offen offset:1024 sc1 lds
v_mfma_f32_16x16x32_bf16 v[52:55], a[68:71], a[148:151], v[52:55]
ds_read_b64_tr_b16 a[4:5], v16 offset:33824
v_mfma_f32_16x16x32_bf16 v[56:59], a[68:71], a[152:155], v[56:59]
ds_read_b64_tr_b16 a[6:7], v16 offset:34336
v_mfma_f32_16x16x32_bf16 v[60:63], a[68:71], a[156:159], v[60:63]
buffer_load_dwordx4 v4, s[16:19], s67 offen offset:2048 sc1 lds
v_mfma_f32_16x16x32_bf16 v[64:67], a[72:75], a[144:147], v[64:67]
ds_read_b64_tr_b16 a[8:9], v16 offset:42240
v_mfma_f32_16x16x32_bf16 v[68:71], a[72:75], a[148:151], v[68:71]
ds_read_b64_tr_b16 a[10:11], v16 offset:42752
v_mfma_f32_16x16x32_bf16 v[72:75], a[72:75], a[152:155], v[72:75]
ds_read_b64_tr_b16 a[12:13], v16 offset:42272
v_mfma_f32_16x16x32_bf16 v[76:79], a[72:75], a[156:159], v[76:79]
buffer_load_dwordx4 v4, s[16:19], s67 offen offset:3072 sc1 lds
v_mfma_f32_16x16x32_bf16 v[80:83], a[76:79], a[144:147], v[80:83]
ds_read_b64_tr_b16 a[14:15], v16 offset:42784
v_mfma_f32_16x16x32_bf16 v[84:87], a[76:79], a[148:151], v[84:87]
s_add_u32 m0, s74, 4096
s_mov_b32 s67, 63180800
v_mfma_f32_16x16x32_bf16 v[88:91], a[76:79], a[152:155], v[88:91]
buffer_load_dwordx4 v4, s[16:19], s67 offen sc1 lds
v_mfma_f32_16x16x32_bf16 v[92:95], a[76:79], a[156:159], v[92:95]
ds_read_b64_tr_b16 a[16:17], v16 offset:33856
v_mfma_f32_16x16x32_bf16 v[96:99], a[80:83], a[144:147], v[96:99]
ds_read_b64_tr_b16 a[18:19], v16 offset:34368
v_mfma_f32_16x16x32_bf16 v[100:103], a[80:83], a[148:151], v[100:103]
buffer_load_dwordx4 v4, s[16:19], s67 offen offset:1024 sc1 lds
v_mfma_f32_16x16x32_bf16 v[104:107], a[80:83], a[152:155], v[104:107]
ds_read_b64_tr_b16 a[20:21], v16 offset:33888
v_mfma_f32_16x16x32_bf16 v[108:111], a[80:83], a[156:159], v[108:111]
ds_read_b64_tr_b16 a[22:23], v16 offset:34400
v_mfma_f32_16x16x32_bf16 v[112:115], a[84:87], a[144:147], v[112:115]
ds_read_b64_tr_b16 a[24:25], v16 offset:42304
v_mfma_f32_16x16x32_bf16 v[116:119], a[84:87], a[148:151], v[116:119]
buffer_load_dwordx4 v4, s[16:19], s67 offen offset:2048 sc1 lds
v_mfma_f32_16x16x32_bf16 v[120:123], a[84:87], a[152:155], v[120:123]
ds_read_b64_tr_b16 a[26:27], v16 offset:42816
v_mfma_f32_16x16x32_bf16 v[124:127], a[84:87], a[156:159], v[124:127]
ds_read_b64_tr_b16 a[28:29], v16 offset:42336
v_mfma_f32_16x16x32_bf16 v[128:131], a[88:91], a[144:147], v[128:131]
buffer_load_dwordx4 v4, s[16:19], s67 offen offset:3072 sc1 lds
v_mfma_f32_16x16x32_bf16 v[132:135], a[88:91], a[148:151], v[132:135]
ds_read_b64_tr_b16 a[30:31], v16 offset:42848
v_mfma_f32_16x16x32_bf16 v[136:139], a[88:91], a[152:155], v[136:139]
v_mfma_f32_16x16x32_bf16 v[140:143], a[88:91], a[156:159], v[140:143]
ds_read_b64_tr_b16 a[32:33], v16 offset:33920
s_add_u32 m0, s55, 100096
v_mfma_f32_16x16x32_bf16 v[144:147], a[92:95], a[144:147], v[144:147]
buffer_load_dwordx4 v12, s[32:35], s54 offen lds
v_mfma_f32_16x16x32_bf16 v[148:151], a[92:95], a[148:151], v[148:151]
ds_read_b64_tr_b16 a[34:35], v16 offset:34432
v_mfma_f32_16x16x32_bf16 v[152:155], a[92:95], a[152:155], v[152:155]
ds_read_b64_tr_b16 a[36:37], v16 offset:33952
v_mfma_f32_16x16x32_bf16 v[156:159], a[92:95], a[156:159], v[156:159]
buffer_load_dwordx4 a[128:131], v10, s[16:19], s52 offen sc1
v_mfma_f32_16x16x32_bf16 v[160:163], a[96:99], a[144:147], v[160:163]
ds_read_b64_tr_b16 a[38:39], v16 offset:34464
v_mfma_f32_16x16x32_bf16 v[164:167], a[96:99], a[148:151], v[164:167]
ds_read_b64_tr_b16 a[40:41], v16 offset:42368
v_mfma_f32_16x16x32_bf16 v[168:171], a[96:99], a[152:155], v[168:171]
buffer_load_dwordx4 v13, s[32:35], s54 offen offset:1056 lds
v_mfma_f32_16x16x32_bf16 v[172:175], a[96:99], a[156:159], v[172:175]
ds_read_b64_tr_b16 a[42:43], v16 offset:42880
v_mfma_f32_16x16x32_bf16 v[176:179], a[100:103], a[144:147], v[176:179]
ds_read_b64_tr_b16 a[44:45], v16 offset:42400
v_mfma_f32_16x16x32_bf16 v[180:183], a[100:103], a[148:151], v[180:183]
ds_read_b64_tr_b16 a[46:47], v16 offset:42912
v_mfma_f32_16x16x32_bf16 v[184:187], a[100:103], a[152:155], v[184:187]
buffer_load_dwordx4 a[132:135], v10, s[16:19], s52 offen offset:1024 sc1
v_mfma_f32_16x16x32_bf16 v[188:191], a[100:103], a[156:159], v[188:191]
ds_read_b64_tr_b16 a[48:49], v17 offset:33792
v_mfma_f32_16x16x32_bf16 v[192:195], a[104:107], a[144:147], v[192:195]
ds_read_b64_tr_b16 a[50:51], v17 offset:34304
v_mfma_f32_16x16x32_bf16 v[196:199], a[104:107], a[148:151], v[196:199]
buffer_load_dwordx4 v14, s[32:35], s54 offen offset:2112 lds
v_mfma_f32_16x16x32_bf16 v[200:203], a[104:107], a[152:155], v[200:203]
ds_read_b64_tr_b16 a[52:53], v17 offset:33824
v_mfma_f32_16x16x32_bf16 v[204:207], a[104:107], a[156:159], v[204:207]
ds_read_b64_tr_b16 a[54:55], v17 offset:34336
v_mfma_f32_16x16x32_bf16 v[208:211], a[108:111], a[144:147], v[208:211]
buffer_load_dwordx4 a[136:139], v11, s[16:19], s52 offen sc1
v_mfma_f32_16x16x32_bf16 v[212:215], a[108:111], a[148:151], v[212:215]
ds_read_b64_tr_b16 a[56:57], v17 offset:42240
v_mfma_f32_16x16x32_bf16 v[216:219], a[108:111], a[152:155], v[216:219]
ds_read_b64_tr_b16 a[58:59], v17 offset:42752
v_mfma_f32_16x16x32_bf16 v[220:223], a[108:111], a[156:159], v[220:223]
ds_read_b64_tr_b16 a[60:61], v17 offset:42272
v_mfma_f32_16x16x32_bf16 v[224:227], a[112:115], a[144:147], v[224:227]
buffer_load_dwordx4 v15, s[32:35], s54 offen offset:3168 lds
v_mfma_f32_16x16x32_bf16 v[228:231], a[112:115], a[148:151], v[228:231]
ds_read_b64_tr_b16 a[62:63], v17 offset:42784
s_add_u32 s54, s54, 229376
v_mfma_f32_16x16x32_bf16 v[232:235], a[116:119], a[144:147], v[232:235]
v_mfma_f32_16x16x32_bf16 v[236:239], a[116:119], a[148:151], v[236:239]
buffer_load_dwordx4 a[140:143], v11, s[16:19], s52 offen offset:1024 sc1
v_mfma_f32_16x16x32_bf16 v[240:243], a[120:123], a[144:147], v[240:243]
s_add_u32 s52, s52, 0x20000
v_mfma_f32_16x16x32_bf16 v[244:247], a[120:123], a[148:151], v[244:247]
v_mfma_f32_16x16x32_bf16 v[248:251], a[124:127], a[144:147], v[248:251]
v_mfma_f32_16x16x32_bf16 v[252:255], a[124:127], a[148:151], v[252:255]
s_waitcnt lgkmcnt(0)
s_barrier
s_waitcnt vmcnt(27)
v_mfma_f32_16x16x32_bf16 v[32:35], a[0:3], a[160:163], v[32:35]
ds_read_b64_tr_b16 a[64:65], v16 offset:50688
s_add_u32 m0, s55, 116992
s_waitcnt vmcnt(26)
v_mfma_f32_16x16x32_bf16 v[36:39], a[0:3], a[164:167], v[36:39]
buffer_load_dwordx4 v12, s[32:35], s54 offen lds
s_waitcnt vmcnt(26)
v_mfma_f32_16x16x32_bf16 v[40:43], a[0:3], a[168:171], v[40:43]
ds_read_b64_tr_b16 a[66:67], v16 offset:51200
s_waitcnt vmcnt(25)
v_mfma_f32_16x16x32_bf16 v[44:47], a[0:3], a[172:175], v[44:47]
ds_read_b64_tr_b16 a[68:69], v16 offset:50720
v_mfma_f32_16x16x32_bf16 v[48:51], a[4:7], a[160:163], v[48:51]
v_mfma_f32_16x16x32_bf16 v[52:55], a[4:7], a[164:167], v[52:55]
ds_read_b64_tr_b16 a[70:71], v16 offset:51232
v_mfma_f32_16x16x32_bf16 v[56:59], a[4:7], a[168:171], v[56:59]
ds_read_b64_tr_b16 a[72:73], v16 offset:59136
v_mfma_f32_16x16x32_bf16 v[60:63], a[4:7], a[172:175], v[60:63]
buffer_load_dwordx4 a[144:147], v10, s[16:19], s52 offen sc1
v_mfma_f32_16x16x32_bf16 v[64:67], a[8:11], a[160:163], v[64:67]
ds_read_b64_tr_b16 a[74:75], v16 offset:59648
v_mfma_f32_16x16x32_bf16 v[68:71], a[8:11], a[164:167], v[68:71]
v_mfma_f32_16x16x32_bf16 v[72:75], a[8:11], a[168:171], v[72:75]
ds_read_b64_tr_b16 a[76:77], v16 offset:59168
v_mfma_f32_16x16x32_bf16 v[76:79], a[8:11], a[172:175], v[76:79]
ds_read_b64_tr_b16 a[78:79], v16 offset:59680
v_mfma_f32_16x16x32_bf16 v[80:83], a[12:15], a[160:163], v[80:83]
ds_read_b64_tr_b16 a[80:81], v16 offset:50752
s_waitcnt vmcnt(10)
ds_read_b128 v[20:23], v2
v_mfma_f32_16x16x32_bf16 v[84:87], a[12:15], a[164:167], v[84:87]
ds_read_b128 v[28:31], v2 offset:1024
v_mfma_f32_16x16x32_bf16 v[88:91], a[12:15], a[168:171], v[88:91]
buffer_load_dwordx4 v13, s[32:35], s54 offen offset:1056 lds
v_mfma_f32_16x16x32_bf16 v[92:95], a[12:15], a[172:175], v[92:95]
ds_read_b64_tr_b16 a[82:83], v16 offset:51264
v_mfma_f32_16x16x32_bf16 v[96:99], a[16:19], a[160:163], v[96:99]
ds_read_b64_tr_b16 a[84:85], v16 offset:50784
v_mfma_f32_16x16x32_bf16 v[100:103], a[16:19], a[164:167], v[100:103]
ds_read_b64_tr_b16 a[86:87], v16 offset:51296
ds_read_b128 v[24:27], v2 offset:2048
v_mfma_f32_16x16x32_bf16 v[104:107], a[16:19], a[168:171], v[104:107]
v_mfma_f32_16x16x32_bf16 v[108:111], a[16:19], a[172:175], v[108:111]
ds_read_b64_tr_b16 a[88:89], v16 offset:59200
s_waitcnt lgkmcnt(5)
v_add_f32 v20, v20, v28
v_mfma_f32_16x16x32_bf16 v[112:115], a[20:23], a[160:163], v[112:115]
ds_read_b64_tr_b16 a[90:91], v16 offset:59712
v_mfma_f32_16x16x32_bf16 v[116:119], a[20:23], a[164:167], v[116:119]
buffer_load_dwordx4 a[148:151], v10, s[16:19], s52 offen offset:1024 sc1
v_mfma_f32_16x16x32_bf16 v[120:123], a[20:23], a[168:171], v[120:123]
ds_read_b64_tr_b16 a[92:93], v16 offset:59232
v_add_f32 v21, v21, v29
v_mfma_f32_16x16x32_bf16 v[124:127], a[20:23], a[172:175], v[124:127]
v_mfma_f32_16x16x32_bf16 v[128:131], a[24:27], a[160:163], v[128:131]
ds_read_b64_tr_b16 a[94:95], v16 offset:59744
v_add_f32 v22, v22, v30
v_mfma_f32_16x16x32_bf16 v[132:135], a[24:27], a[164:167], v[132:135]
ds_read_b64_tr_b16 a[96:97], v16 offset:50816
v_mfma_f32_16x16x32_bf16 v[136:139], a[24:27], a[168:171], v[136:139]
ds_read_b64_tr_b16 a[98:99], v16 offset:51328
.Lpad27:
s_cbranch_execz .Lpad30
v_mfma_f32_16x16x32_bf16 v[140:143], a[24:27], a[172:175], v[140:143]
v_add_f32 v23, v23, v31
v_mfma_f32_16x16x32_bf16 v[144:147], a[28:31], a[160:163], v[144:147]
buffer_load_dwordx4 v14, s[32:35], s54 offen offset:2112 lds
v_mfma_f32_16x16x32_bf16 v[148:151], a[28:31], a[164:167], v[148:151]
ds_read_b64_tr_b16 a[100:101], v16 offset:50848
v_mfma_f32_16x16x32_bf16 v[152:155], a[28:31], a[168:171], v[152:155]
ds_read_b64_tr_b16 a[102:103], v16 offset:51360
ds_read_b128 v[28:31], v2 offset:3072
v_mfma_f32_16x16x32_bf16 v[156:159], a[28:31], a[172:175], v[156:159]
ds_read_b64_tr_b16 a[104:105], v16 offset:59264
v_mfma_f32_16x16x32_bf16 v[160:163], a[32:35], a[160:163], v[160:163]
s_waitcnt lgkmcnt(10)
v_add_f32 v20, v20, v24
v_mfma_f32_16x16x32_bf16 v[164:167], a[32:35], a[164:167], v[164:167]
ds_read_b64_tr_b16 a[106:107], v16 offset:59776
v_mfma_f32_16x16x32_bf16 v[168:171], a[32:35], a[168:171], v[168:171]
buffer_load_dwordx4 a[152:155], v11, s[16:19], s52 offen sc1
v_mfma_f32_16x16x32_bf16 v[172:175], a[32:35], a[172:175], v[172:175]
ds_read_b64_tr_b16 a[108:109], v16 offset:59296
v_add_f32 v21, v21, v25
v_mfma_f32_16x16x32_bf16 v[176:179], a[36:39], a[160:163], v[176:179]
ds_read_b64_tr_b16 a[110:111], v16 offset:59808
v_mfma_f32_16x16x32_bf16 v[180:183], a[36:39], a[164:167], v[180:183]
v_add_f32 v22, v22, v26
v_mfma_f32_16x16x32_bf16 v[184:187], a[36:39], a[168:171], v[184:187]
ds_read_b64_tr_b16 a[112:113], v17 offset:50688
v_mfma_f32_16x16x32_bf16 v[188:191], a[36:39], a[172:175], v[188:191]
ds_read_b64_tr_b16 a[114:115], v17 offset:51200
v_add_f32 v23, v23, v27
v_mfma_f32_16x16x32_bf16 v[192:195], a[40:43], a[160:163], v[192:195]
ds_read_b64_tr_b16 a[116:117], v17 offset:50720
v_mfma_f32_16x16x32_bf16 v[196:199], a[40:43], a[164:167], v[196:199]
buffer_load_dwordx4 v15, s[32:35], s54 offen offset:3168 lds
v_mfma_f32_16x16x32_bf16 v[200:203], a[40:43], a[168:171], v[200:203]
s_add_u32 s54, s54, 229376
ds_read_b128 v[24:27], v2 offset:4096
v_mfma_f32_16x16x32_bf16 v[204:207], a[40:43], a[172:175], v[204:207]
ds_read_b64_tr_b16 a[118:119], v17 offset:51232
v_mfma_f32_16x16x32_bf16 v[208:211], a[44:47], a[160:163], v[208:211]
ds_read_b64_tr_b16 a[120:121], v17 offset:59136
v_mfma_f32_16x16x32_bf16 v[212:215], a[44:47], a[164:167], v[212:215]
ds_read_b64_tr_b16 a[122:123], v17 offset:59648
s_waitcnt lgkmcnt(11)
v_add_f32 v20, v20, v28
v_mfma_f32_16x16x32_bf16 v[216:219], a[44:47], a[168:171], v[216:219]
v_mfma_f32_16x16x32_bf16 v[220:223], a[44:47], a[172:175], v[220:223]
ds_read_b64_tr_b16 a[124:125], v17 offset:59168
v_add_f32 v21, v21, v29
v_mfma_f32_16x16x32_bf16 v[224:227], a[48:51], a[160:163], v[224:227]
buffer_load_dwordx4 a[156:159], v11, s[16:19], s52 offen offset:1024 sc1
v_mfma_f32_16x16x32_bf16 v[228:231], a[48:51], a[164:167], v[228:231]
ds_read_b64_tr_b16 a[126:127], v17 offset:59680
s_add_u32 s52, s52, 0x20000
v_mfma_f32_16x16x32_bf16 v[232:235], a[52:55], a[160:163], v[232:235]
v_add_f32 v22, v22, v30
v_mfma_f32_16x16x32_bf16 v[236:239], a[52:55], a[164:167], v[236:239]
v_mfma_f32_16x16x32_bf16 v[240:243], a[56:59], a[160:163], v[240:243]
v_add_f32 v23, v23, v31
v_mfma_f32_16x16x32_bf16 v[244:247], a[56:59], a[164:167], v[244:247]
ds_read_b128 v[28:31], v2 offset:5120
v_mfma_f32_16x16x32_bf16 v[248:251], a[60:63], a[160:163], v[248:251]
v_mfma_f32_16x16x32_bf16 v[252:255], a[60:63], a[164:167], v[252:255]
s_waitcnt lgkmcnt(0)
s_barrier
v_mfma_f32_16x16x32_bf16 v[32:35], a[64:67], a[176:179], v[32:35]
ds_read_b64_tr_b16 a[0:1], v16
s_add_u32 m0, s55, 133888
v_mfma_f32_16x16x32_bf16 v[36:39], a[64:67], a[180:183], v[36:39]
buffer_load_dwordx4 v12, s[32:35], s54 offen lds
v_mfma_f32_16x16x32_bf16 v[40:43], a[64:67], a[184:187], v[40:43]
ds_read_b64_tr_b16 a[2:3], v16 offset:512
v_add_f32 v20, v20, v24
v_mfma_f32_16x16x32_bf16 v[44:47], a[64:67], a[188:191], v[44:47]
ds_read_b64_tr_b16 a[4:5], v16 offset:32
v_add_f32 v21, v21, v25
v_mfma_f32_16x16x32_bf16 v[48:51], a[68:71], a[176:179], v[48:51]
v_add_f32 v22, v22, v26
v_mfma_f32_16x16x32_bf16 v[52:55], a[68:71], a[180:183], v[52:55]
ds_read_b64_tr_b16 a[6:7], v16 offset:544
v_add_f32 v23, v23, v27
v_mfma_f32_16x16x32_bf16 v[56:59], a[68:71], a[184:187], v[56:59]
ds_read_b64_tr_b16 a[8:9], v16 offset:8448
v_mfma_f32_16x16x32_bf16 v[60:63], a[68:71], a[188:191], v[60:63]
buffer_load_dwordx4 a[160:163], v10, s[16:19], s52 offen sc1
v_mfma_f32_16x16x32_bf16 v[64:67], a[72:75], a[176:179], v[64:67]
ds_read_b64_tr_b16 a[10:11], v16 offset:8960
ds_read_b128 v[24:27], v2 offset:6144
v_mfma_f32_16x16x32_bf16 v[68:71], a[72:75], a[180:183], v[68:71]
v_add_f32 v20, v20, v28
v_mfma_f32_16x16x32_bf16 v[72:75], a[72:75], a[184:187], v[72:75]
ds_read_b64_tr_b16 a[12:13], v16 offset:8480
v_add_f32 v21, v21, v29
v_mfma_f32_16x16x32_bf16 v[76:79], a[72:75], a[188:191], v[76:79]
ds_read_b64_tr_b16 a[14:15], v16 offset:8992
v_mfma_f32_16x16x32_bf16 v[80:83], a[76:79], a[176:179], v[80:83]
ds_read_b64_tr_b16 a[16:17], v16 offset:64
v_add_f32 v22, v22, v30
v_mfma_f32_16x16x32_bf16 v[84:87], a[76:79], a[180:183], v[84:87]
v_add_f32 v23, v23, v31
v_mfma_f32_16x16x32_bf16 v[88:91], a[76:79], a[184:187], v[88:91]
buffer_load_dwordx4 v13, s[32:35], s54 offen offset:1056 lds
v_mfma_f32_16x16x32_bf16 v[92:95], a[76:79], a[188:191], v[92:95]
ds_read_b64_tr_b16 a[18:19], v16 offset:576
ds_read_b128 v[28:31], v2 offset:7168
v_mfma_f32_16x16x32_bf16 v[96:99], a[80:83], a[176:179], v[96:99]
ds_read_b64_tr_b16 a[20:21], v16 offset:96
v_mfma_f32_16x16x32_bf16 v[100:103], a[80:83], a[180:183], v[100:103]
ds_read_b64_tr_b16 a[22:23], v16 offset:608
s_waitcnt lgkmcnt(7)
v_add_f32 v20, v20, v24
v_mfma_f32_16x16x32_bf16 v[104:107], a[80:83], a[184:187], v[104:107]
v_add_f32 v21, v21, v25
v_mfma_f32_16x16x32_bf16 v[108:111], a[80:83], a[188:191], v[108:111]
ds_read_b64_tr_b16 a[24:25], v16 offset:8512
v_add_f32 v22, v22, v26
v_mfma_f32_16x16x32_bf16 v[112:115], a[84:87], a[176:179], v[112:115]
ds_read_b64_tr_b16 a[26:27], v16 offset:9024
v_mfma_f32_16x16x32_bf16 v[116:119], a[84:87], a[180:183], v[116:119]
buffer_load_dwordx4 a[164:167], v10, s[16:19], s52 offen offset:1024 sc1
v_mfma_f32_16x16x32_bf16 v[120:123], a[84:87], a[184:187], v[120:123]
ds_read_b64_tr_b16 a[28:29], v16 offset:8544
v_add_f32 v23, v23, v27
v_mfma_f32_16x16x32_bf16 v[124:127], a[84:87], a[188:191], v[124:127]
s_waitcnt lgkmcnt(5)
v_add_f32 v20, v20, v28
v_mfma_f32_16x16x32_bf16 v[128:131], a[88:91], a[176:179], v[128:131]
ds_read_b64_tr_b16 a[30:31], v16 offset:9056
v_add_f32 v21, v21, v29
v_mfma_f32_16x16x32_bf16 v[132:135], a[88:91], a[180:183], v[132:135]
ds_read_b64_tr_b16 a[32:33], v16 offset:128
v_add_f32 v22, v22, v30
v_mfma_f32_16x16x32_bf16 v[136:139], a[88:91], a[184:187], v[136:139]
ds_read_b64_tr_b16 a[34:35], v16 offset:640
v_mfma_f32_16x16x32_bf16 v[140:143], a[88:91], a[188:191], v[140:143]
v_add_f32 v23, v23, v31
v_mfma_f32_16x16x32_bf16 v[144:147], a[92:95], a[176:179], v[144:147]
buffer_load_dwordx4 v14, s[32:35], s54 offen offset:2112 lds
v_mfma_f32_16x16x32_bf16 v[148:151], a[92:95], a[180:183], v[148:151]
ds_read_b64_tr_b16 a[36:37], v16 offset:160
v_permlane32_swap_b32 v20, v22
v_mfma_f32_16x16x32_bf16 v[152:155], a[92:95], a[184:187], v[152:155]
ds_read_b64_tr_b16 a[38:39], v16 offset:672
v_permlane32_swap_b32 v21, v23
v_mfma_f32_16x16x32_bf16 v[156:159], a[92:95], a[188:191], v[156:159]
ds_read_b64_tr_b16 a[40:41], v16 offset:8576
v_mfma_f32_16x16x32_bf16 v[160:163], a[96:99], a[176:179], v[160:163]
v_add_f32 v20, v20, v22
v_mfma_f32_16x16x32_bf16 v[164:167], a[96:99], a[180:183], v[164:167]
ds_read_b64_tr_b16 a[42:43], v16 offset:9088
v_add_f32 v21, v21, v23
v_mfma_f32_16x16x32_bf16 v[168:171], a[96:99], a[184:187], v[168:171]
buffer_load_dwordx4 a[168:171], v11, s[16:19], s52 offen sc1
v_mfma_f32_16x16x32_bf16 v[172:175], a[96:99], a[188:191], v[172:175]
ds_read_b64_tr_b16 a[44:45], v16 offset:8608
v_mul_f32 v20, 0xba800000, v20
v_mfma_f32_16x16x32_bf16 v[176:179], a[100:103], a[176:179], v[176:179]
ds_read_b64_tr_b16 a[46:47], v16 offset:9120
v_mfma_f32_16x16x32_bf16 v[180:183], a[100:103], a[180:183], v[180:183]
v_mul_f32 v21, 0x3a800000, v21
v_fma_f32 v21, -v20, v20, v21
v_mfma_f32_16x16x32_bf16 v[184:187], a[100:103], a[184:187], v[184:187]
ds_read_b64_tr_b16 a[48:49], v17
v_mfma_f32_16x16x32_bf16 v[188:191], a[100:103], a[188:191], v[188:191]
ds_read_b64_tr_b16 a[50:51], v17 offset:512
v_max_f32 v21, 0, v21
v_mfma_f32_16x16x32_bf16 v[192:195], a[104:107], a[176:179], v[192:195]
ds_read_b64_tr_b16 a[52:53], v17 offset:32
v_mfma_f32_16x16x32_bf16 v[196:199], a[104:107], a[180:183], v[196:199]
buffer_load_dwordx4 v15, s[32:35], s54 offen offset:3168 lds
v_mfma_f32_16x16x32_bf16 v[200:203], a[104:107], a[184:187], v[200:203]
s_add_u32 s54, s54, 229376
v_add_f32 v21, 0x3727c5ac, v21
v_rsq_f32 v22, v21
v_mfma_f32_16x16x32_bf16 v[204:207], a[104:107], a[188:191], v[204:207]
ds_read_b64_tr_b16 a[54:55], v17 offset:544
v_mfma_f32_16x16x32_bf16 v[208:211], a[108:111], a[176:179], v[208:211]
ds_read_b64_tr_b16 a[56:57], v17 offset:8448
v_and_b32 v24, 31, v1
v_mfma_f32_16x16x32_bf16 v[212:215], a[108:111], a[180:183], v[212:215]
ds_read_b64_tr_b16 a[58:59], v17 offset:8960
v_mfma_f32_16x16x32_bf16 v[216:219], a[108:111], a[184:187], v[216:219]
v_lshrrev_b32 v25, 5, v1
v_lshl_add_u32 v24, v24, 1, v25
v_mfma_f32_16x16x32_bf16 v[220:223], a[108:111], a[188:191], v[220:223]
ds_read_b64_tr_b16 a[60:61], v17 offset:8480
v_mfma_f32_16x16x32_bf16 v[224:227], a[112:115], a[176:179], v[224:227]
buffer_load_dwordx4 a[172:175], v11, s[16:19], s52 offen offset:1024 sc1
v_mfma_f32_16x16x32_bf16 v[228:231], a[112:115], a[180:183], v[228:231]
ds_read_b64_tr_b16 a[62:63], v17 offset:8992
s_add_u32 s52, s52, 0x20000
v_mfma_f32_16x16x32_bf16 v[232:235], a[116:119], a[176:179], v[232:235]
v_and_b32 v25, 0xc0, v0
v_add_u32 v24, v24, v25
v_mfma_f32_16x16x32_bf16 v[236:239], a[116:119], a[180:183], v[236:239]
v_lshlrev_b32 v24, 4, v24
v_mfma_f32_16x16x32_bf16 v[240:243], a[120:123], a[176:179], v[240:243]
v_add_u32 v24, 151552, v24
v_mfma_f32_16x16x32_bf16 v[244:247], a[120:123], a[180:183], v[244:247]
v_mul_f32 v22, 0xbfb8aa3b, v22
v_mfma_f32_16x16x32_bf16 v[248:251], a[124:127], a[176:179], v[248:251]
ds_write_b128 v24, v[20:23]
v_mfma_f32_16x16x32_bf16 v[252:255], a[124:127], a[180:183], v[252:255]
s_lshl_b32 s74, s3, 10
s_lshl_b32 s75, s12, 9
s_add_u32 s74, s74, s75
s_add_u32 s74, s74, 151552
v_and_b32 v2, 15, v1
v_lshl_add_u32 v2, v2, 4, s74
v_xor_b32 v8, 512, v2
ds_read_b64 v[20:21], v2
ds_read_b64 v[22:23], v2 offset:256
ds_read_b64 v[24:25], v8
ds_read_b64 v[26:27], v8 offset:256
ds_read_b32 v28, v2 offset:8
ds_read_b32 v29, v2 offset:264
ds_read_b32 v30, v8 offset:8
ds_read_b32 v31, v8 offset:264
s_lshl_b32 s74, s12, 7
s_add_u32 s74, s74, 160512
s_xor_b32 s75, s12, 1
s_mul_i32 s75, s75, 384
s_add_u32 s75, s75, 160512
v_lshrrev_b32 v9, 4, v1
v_lshlrev_b32 v9, 4, v9
v_add_u32 v8, s75, v9
v_add_u32 v9, s74, v9
s_mul_i32 s66, s13, 917504
s_add_u32 s66, s66, 46137344
s_add_u32 s65, s66, 393216
s_lshl_b32 s62, s12, 19
s_add_u32 s62, s62, s66
s_add_u32 s63, s62, 0x20000
s_add_u32 s64, s62, 0x40000
s_mov_b32 s58, -262144
s_sub_u32 s67, s59, 16640
s_mov_b32 s15, -6
.p2align 6
.Lk54:
s_waitcnt vmcnt(17) lgkmcnt(0)
s_barrier
v_mfma_f32_16x16x32_bf16 v[32:35], a[0:3], a[128:131], v[32:35]
ds_read_b64_tr_b16 a[64:65], v16 offset:16896
s_add_u32 m0, s55, 83200
v_mfma_f32_16x16x32_bf16 v[36:39], a[0:3], a[132:135], v[36:39]
buffer_load_dwordx4 v12, s[32:35], s54 offen lds
v_mfma_f32_16x16x32_bf16 v[40:43], a[0:3], a[136:139], v[40:43]
ds_read_b64_tr_b16 a[66:67], v16 offset:17408
s_waitcnt vmcnt(17)
v_mfma_f32_16x16x32_bf16 v[44:47], a[0:3], a[140:143], v[44:47]
ds_read_b64_tr_b16 a[68:69], v16 offset:16928
v_mfma_f32_16x16x32_bf16 v[48:51], a[4:7], a[128:131], v[48:51]
ds_read_b64_tr_b16 a[70:71], v16 offset:17440
v_mfma_f32_16x16x32_bf16 v[52:55], a[4:7], a[132:135], v[52:55]
v_mfma_f32_16x16x32_bf16 v[56:59], a[4:7], a[136:139], v[56:59]
ds_read_b64_tr_b16 a[72:73], v16 offset:25344
v_mfma_f32_16x16x32_bf16 v[60:63], a[4:7], a[140:143], v[60:63]
buffer_load_dwordx4 a[176:179], v10, s[16:19], s52 offen sc1
v_mfma_f32_16x16x32_bf16 v[64:67], a[8:11], a[128:131], v[64:67]
ds_read_b64_tr_b16 a[74:75], v16 offset:25856
v_mfma_f32_16x16x32_bf16 v[68:71], a[8:11], a[132:135], v[68:71]
ds_read_b64_tr_b16 a[76:77], v16 offset:25376
v_mfma_f32_16x16x32_bf16 v[72:75], a[8:11], a[136:139], v[72:75]
v_mfma_f32_16x16x32_bf16 v[76:79], a[8:11], a[140:143], v[76:79]
ds_read_b64_tr_b16 a[78:79], v16 offset:25888
v_mfma_f32_16x16x32_bf16 v[80:83], a[12:15], a[128:131], v[80:83]
ds_read_b64_tr_b16 a[80:81], v16 offset:16960
v_mfma_f32_16x16x32_bf16 v[84:87], a[12:15], a[132:135], v[84:87]
buffer_load_dwordx4 v13, s[32:35], s54 offen offset:1056 lds
v_mfma_f32_16x16x32_bf16 v[88:91], a[12:15], a[136:139], v[88:91]
ds_read_b64_tr_b16 a[82:83], v16 offset:17472
v_mfma_f32_16x16x32_bf16 v[92:95], a[12:15], a[140:143], v[92:95]
v_mfma_f32_16x16x32_bf16 v[96:99], a[16:19], a[128:131], v[96:99]
ds_read_b64_tr_b16 a[84:85], v16 offset:16992
v_mfma_f32_16x16x32_bf16 v[100:103], a[16:19], a[132:135], v[100:103]
ds_read_b64_tr_b16 a[86:87], v16 offset:17504
v_mfma_f32_16x16x32_bf16 v[104:107], a[16:19], a[136:139], v[104:107]
ds_read_b64_tr_b16 a[88:89], v16 offset:25408
v_mfma_f32_16x16x32_bf16 v[108:111], a[16:19], a[140:143], v[108:111]
buffer_load_dwordx4 a[180:183], v10, s[16:19], s52 offen offset:1024 sc1
v_mfma_f32_16x16x32_bf16 v[112:115], a[20:23], a[128:131], v[112:115]
v_mfma_f32_16x16x32_bf16 v[116:119], a[20:23], a[132:135], v[116:119]
ds_read_b64_tr_b16 a[90:91], v16 offset:25920
v_mfma_f32_16x16x32_bf16 v[120:123], a[20:23], a[136:139], v[120:123]
ds_read_b64_tr_b16 a[92:93], v16 offset:25440
v_mfma_f32_16x16x32_bf16 v[124:127], a[20:23], a[140:143], v[124:127]
ds_read_b64_tr_b16 a[94:95], v16 offset:25952
v_mfma_f32_16x16x32_bf16 v[128:131], a[24:27], a[128:131], v[128:131]
v_mfma_f32_16x16x32_bf16 v[132:135], a[24:27], a[132:135], v[132:135]
buffer_load_dwordx4 v14, s[32:35], s54 offen offset:2112 lds
v_mfma_f32_16x16x32_bf16 v[136:139], a[24:27], a[136:139], v[136:139]
ds_read_b64_tr_b16 a[96:97], v16 offset:17024
v_mfma_f32_16x16x32_bf16 v[140:143], a[24:27], a[140:143], v[140:143]
ds_read_b64_tr_b16 a[98:99], v16 offset:17536
v_mfma_f32_16x16x32_bf16 v[144:147], a[28:31], a[128:131], v[144:147]
ds_read_b64_tr_b16 a[100:101], v16 offset:17056
v_mfma_f32_16x16x32_bf16 v[148:151], a[28:31], a[132:135], v[148:151]
ds_read_b64_tr_b16 a[102:103], v16 offset:17568
v_mfma_f32_16x16x32_bf16 v[152:155], a[28:31], a[136:139], v[152:155]
v_mfma_f32_16x16x32_bf16 v[156:159], a[28:31], a[140:143], v[156:159]
buffer_load_dwordx4 a[184:187], v11, s[16:19], s52 offen sc1
v_mfma_f32_16x16x32_bf16 v[160:163], a[32:35], a[128:131], v[160:163]
ds_read_b64_tr_b16 a[104:105], v16 offset:25472
v_mfma_f32_16x16x32_bf16 v[164:167], a[32:35], a[132:135], v[164:167]
ds_read_b64_tr_b16 a[106:107], v16 offset:25984
v_mfma_f32_16x16x32_bf16 v[168:171], a[32:35], a[136:139], v[168:171]
ds_read_b64_tr_b16 a[108:109], v16 offset:25504
v_mfma_f32_16x16x32_bf16 v[172:175], a[32:35], a[140:143], v[172:175]
v_mfma_f32_16x16x32_bf16 v[176:179], a[36:39], a[128:131], v[176:179]
ds_read_b64_tr_b16 a[110:111], v16 offset:26016
v_mfma_f32_16x16x32_bf16 v[180:183], a[36:39], a[132:135], v[180:183]
buffer_load_dwordx4 v15, s[32:35], s54 offen offset:3168 lds
v_mfma_f32_16x16x32_bf16 v[184:187], a[36:39], a[136:139], v[184:187]
ds_read_b64_tr_b16 a[112:113], v17 offset:16896
s_add_u32 s54, s54, 229376
v_mfma_f32_16x16x32_bf16 v[188:191], a[36:39], a[140:143], v[188:191]
ds_read_b64_tr_b16 a[114:115], v17 offset:17408
v_mfma_f32_16x16x32_bf16 v[192:195], a[40:43], a[128:131], v[192:195]
v_mfma_f32_16x16x32_bf16 v[196:199], a[40:43], a[132:135], v[196:199]
ds_read_b64_tr_b16 a[116:117], v17 offset:16928
v_mfma_f32_16x16x32_bf16 v[200:203], a[40:43], a[136:139], v[200:203]
ds_read_b64_tr_b16 a[118:119], v17 offset:17440
v_mfma_f32_16x16x32_bf16 v[204:207], a[40:43], a[140:143], v[204:207]
buffer_load_dwordx4 a[188:191], v11, s[16:19], s52 offen offset:1024 sc1
v_mfma_f32_16x16x32_bf16 v[208:211], a[44:47], a[128:131], v[208:211]
ds_read_b64_tr_b16 a[120:121], v17 offset:25344
s_add_u32 s52, s52, 0x20000
v_mfma_f32_16x16x32_bf16 v[212:215], a[44:47], a[132:135], v[212:215]
v_mfma_f32_16x16x32_bf16 v[216:219], a[44:47], a[136:139], v[216:219]
ds_read_b64_tr_b16 a[122:123], v17 offset:25856
v_mfma_f32_16x16x32_bf16 v[220:223], a[44:47], a[140:143], v[220:223]
ds_read_b64_tr_b16 a[124:125], v17 offset:25376
v_mfma_f32_16x16x32_bf16 v[224:227], a[48:51], a[128:131], v[224:227]
ds_read_b64_tr_b16 a[126:127], v17 offset:25888
s_max_i32 m0, s67, s59
v_mfma_f32_16x16x32_bf16 v[228:231], a[48:51], a[132:135], v[228:231]
buffer_load_dwordx4 v5, s[28:31], s58 offen lds
v_mfma_f32_16x16x32_bf16 v[232:235], a[52:55], a[128:131], v[232:235]
v_mfma_f32_16x16x32_bf16 v[236:239], a[52:55], a[132:135], v[236:239]
v_mfma_f32_16x16x32_bf16 v[240:243], a[56:59], a[128:131], v[240:243]
v_mfma_f32_16x16x32_bf16 v[244:247], a[56:59], a[132:135], v[244:247]
v_mfma_f32_16x16x32_bf16 v[248:251], a[60:63], a[128:131], v[248:251]
v_mfma_f32_16x16x32_bf16 v[252:255], a[60:63], a[132:135], v[252:255]
s_waitcnt vmcnt(18) lgkmcnt(0)
s_barrier
v_mfma_f32_16x16x32_bf16 v[32:35], a[64:67], a[144:147], v[32:35]
ds_read_b64_tr_b16 a[0:1], v16 offset:33792
s_add_u32 m0, s55, 100096
v_mfma_f32_16x16x32_bf16 v[36:39], a[64:67], a[148:151], v[36:39]
buffer_load_dwordx4 v12, s[32:35], s54 offen lds
v_mfma_f32_16x16x32_bf16 v[40:43], a[64:67], a[152:155], v[40:43]
ds_read_b64_tr_b16 a[2:3], v16 offset:34304
s_waitcnt vmcnt(18)
v_mfma_f32_16x16x32_bf16 v[44:47], a[64:67], a[156:159], v[44:47]
ds_read_b64_tr_b16 a[4:5], v16 offset:33824
v_mfma_f32_16x16x32_bf16 v[48:51], a[68:71], a[144:147], v[48:51]
ds_read_b64_tr_b16 a[6:7], v16 offset:34336
v_mfma_f32_16x16x32_bf16 v[52:55], a[68:71], a[148:151], v[52:55]
v_mfma_f32_16x16x32_bf16 v[56:59], a[68:71], a[152:155], v[56:59]
ds_read_b64_tr_b16 a[8:9], v16 offset:42240
v_mfma_f32_16x16x32_bf16 v[60:63], a[68:71], a[156:159], v[60:63]
buffer_load_dwordx4 a[128:131], v10, s[16:19], s52 offen sc1
v_mfma_f32_16x16x32_bf16 v[64:67], a[72:75], a[144:147], v[64:67]
ds_read_b64_tr_b16 a[10:11], v16 offset:42752
v_mfma_f32_16x16x32_bf16 v[68:71], a[72:75], a[148:151], v[68:71]
ds_read_b64_tr_b16 a[12:13], v16 offset:42272
v_mfma_f32_16x16x32_bf16 v[72:75], a[72:75], a[152:155], v[72:75]
ds_read_b64_tr_b16 a[14:15], v16 offset:42784
v_mfma_f32_16x16x32_bf16 v[76:79], a[72:75], a[156:159], v[76:79]
v_mfma_f32_16x16x32_bf16 v[80:83], a[76:79], a[144:147], v[80:83]
ds_read_b64_tr_b16 a[16:17], v16 offset:33856
v_mfma_f32_16x16x32_bf16 v[84:87], a[76:79], a[148:151], v[84:87]
buffer_load_dwordx4 v13, s[32:35], s54 offen offset:1056 lds
v_mfma_f32_16x16x32_bf16 v[88:91], a[76:79], a[152:155], v[88:91]
ds_read_b64_tr_b16 a[18:19], v16 offset:34368
v_mfma_f32_16x16x32_bf16 v[92:95], a[76:79], a[156:159], v[92:95]
ds_read_b64_tr_b16 a[20:21], v16 offset:33888
v_mfma_f32_16x16x32_bf16 v[96:99], a[80:83], a[144:147], v[96:99]
v_mfma_f32_16x16x32_bf16 v[100:103], a[80:83], a[148:151], v[100:103]
ds_read_b64_tr_b16 a[22:23], v16 offset:34400
v_mfma_f32_16x16x32_bf16 v[104:107], a[80:83], a[152:155], v[104:107]
ds_read_b64_tr_b16 a[24:25], v16 offset:42304
v_mfma_f32_16x16x32_bf16 v[108:111], a[80:83], a[156:159], v[108:111]
buffer_load_dwordx4 a[132:135], v10, s[16:19], s52 offen offset:1024 sc1
v_mfma_f32_16x16x32_bf16 v[112:115], a[84:87], a[144:147], v[112:115]
ds_read_b64_tr_b16 a[26:27], v16 offset:42816
v_mfma_f32_16x16x32_bf16 v[116:119], a[84:87], a[148:151], v[116:119]
ds_read_b64_tr_b16 a[28:29], v16 offset:42336
v_mfma_f32_16x16x32_bf16 v[120:123], a[84:87], a[152:155], v[120:123]
v_mfma_f32_16x16x32_bf16 v[124:127], a[84:87], a[156:159], v[124:127]
ds_read_b64_tr_b16 a[30:31], v16 offset:42848
v_mfma_f32_16x16x32_bf16 v[128:131], a[88:91], a[144:147], v[128:131]
ds_read_b64_tr_b16 a[32:33], v16 offset:33920
v_mfma_f32_16x16x32_bf16 v[132:135], a[88:91], a[148:151], v[132:135]
buffer_load_dwordx4 v14, s[32:35], s54 offen offset:2112 lds
v_mfma_f32_16x16x32_bf16 v[136:139], a[88:91], a[152:155], v[136:139]
ds_read_b64_tr_b16 a[34:35], v16 offset:34432
v_mfma_f32_16x16x32_bf16 v[140:143], a[88:91], a[156:159], v[140:143]
v_mfma_f32_16x16x32_bf16 v[144:147], a[92:95], a[144:147], v[144:147]
ds_read_b64_tr_b16 a[36:37], v16 offset:33952
v_mfma_f32_16x16x32_bf16 v[148:151], a[92:95], a[148:151], v[148:151]
ds_read_b64_tr_b16 a[38:39], v16 offset:34464
v_mfma_f32_16x16x32_bf16 v[152:155], a[92:95], a[152:155], v[152:155]
ds_read_b64_tr_b16 a[40:41], v16 offset:42368
v_mfma_f32_16x16x32_bf16 v[156:159], a[92:95], a[156:159], v[156:159]
buffer_load_dwordx4 a[136:139], v11, s[16:19], s52 offen sc1
v_mfma_f32_16x16x32_bf16 v[160:163], a[96:99], a[144:147], v[160:163]
ds_read_b64_tr_b16 a[42:43], v16 offset:42880
v_mfma_f32_16x16x32_bf16 v[164:167], a[96:99], a[148:151], v[164:167]
v_mfma_f32_16x16x32_bf16 v[168:171], a[96:99], a[152:155], v[168:171]
ds_read_b64_tr_b16 a[44:45], v16 offset:42400
v_mfma_f32_16x16x32_bf16 v[172:175], a[96:99], a[156:159], v[172:175]
ds_read_b64_tr_b16 a[46:47], v16 offset:42912
v_mfma_f32_16x16x32_bf16 v[176:179], a[100:103], a[144:147], v[176:179]
ds_read_b64_tr_b16 a[48:49], v17 offset:33792
v_mfma_f32_16x16x32_bf16 v[180:183], a[100:103], a[148:151], v[180:183]
buffer_load_dwordx4 v15, s[32:35], s54 offen offset:3168 lds
v_mfma_f32_16x16x32_bf16 v[184:187], a[100:103], a[152:155], v[184:187]
s_add_u32 s54, s54, 229376
v_mfma_f32_16x16x32_bf16 v[188:191], a[100:103], a[156:159], v[188:191]
ds_read_b64_tr_b16 a[50:51], v17 offset:34304
v_mfma_f32_16x16x32_bf16 v[192:195], a[104:107], a[144:147], v[192:195]
ds_read_b64_tr_b16 a[52:53], v17 offset:33824
v_mfma_f32_16x16x32_bf16 v[196:199], a[104:107], a[148:151], v[196:199]
ds_read_b64_tr_b16 a[54:55], v17 offset:34336
v_mfma_f32_16x16x32_bf16 v[200:203], a[104:107], a[152:155], v[200:203]
ds_read_b64_tr_b16 a[56:57], v17 offset:42240
v_mfma_f32_16x16x32_bf16 v[204:207], a[104:107], a[156:159], v[204:207]
buffer_load_dwordx4 a[140:143], v11, s[16:19], s52 offen offset:1024 sc1
v_mfma_f32_16x16x32_bf16 v[208:211], a[108:111], a[144:147], v[208:211]
s_add_u32 s52, s52, 0x20000
v_mfma_f32_16x16x32_bf16 v[212:215], a[108:111], a[148:151], v[212:215]
ds_read_b64_tr_b16 a[58:59], v17 offset:42752
v_mfma_f32_16x16x32_bf16 v[216:219], a[108:111], a[152:155], v[216:219]
ds_read_b64_tr_b16 a[60:61], v17 offset:42272
v_mfma_f32_16x16x32_bf16 v[220:223], a[108:111], a[156:159], v[220:223]
ds_read_b64_tr_b16 a[62:63], v17 offset:42784
v_mfma_f32_16x16x32_bf16 v[224:227], a[112:115], a[144:147], v[224:227]
s_max_i32 m0, s67, s59
v_mfma_f32_16x16x32_bf16 v[228:231], a[112:115], a[148:151], v[228:231]
buffer_load_dwordx4 v6, s[28:31], s58 offen offset:1024 lds
v_mfma_f32_16x16x32_bf16 v[232:235], a[116:119], a[144:147], v[232:235]
s_add_u32 s67, s67, 8320
s_add_u32 s58, s58, 0x20000
v_mfma_f32_16x16x32_bf16 v[236:239], a[116:119], a[148:151], v[236:239]
v_mfma_f32_16x16x32_bf16 v[240:243], a[120:123], a[144:147], v[240:243]
v_mfma_f32_16x16x32_bf16 v[244:247], a[120:123], a[148:151], v[244:247]
v_mfma_f32_16x16x32_bf16 v[248:251], a[124:127], a[144:147], v[248:251]
v_mfma_f32_16x16x32_bf16 v[252:255], a[124:127], a[148:151], v[252:255]
s_waitcnt vmcnt(19) lgkmcnt(0)
s_barrier
v_mfma_f32_16x16x32_bf16 v[32:35], a[0:3], a[160:163], v[32:35]
ds_read_b64_tr_b16 a[64:65], v16 offset:50688
s_add_u32 m0, s55, 116992
v_mfma_f32_16x16x32_bf16 v[36:39], a[0:3], a[164:167], v[36:39]
buffer_load_dwordx4 v12, s[32:35], s54 offen lds
v_mfma_f32_16x16x32_bf16 v[40:43], a[0:3], a[168:171], v[40:43]
ds_read_b64_tr_b16 a[66:67], v16 offset:51200
s_waitcnt vmcnt(19)
v_mfma_f32_16x16x32_bf16 v[44:47], a[0:3], a[172:175], v[44:47]
ds_read_b64_tr_b16 a[68:69], v16 offset:50720
v_mfma_f32_16x16x32_bf16 v[48:51], a[4:7], a[160:163], v[48:51]
ds_read_b64_tr_b16 a[70:71], v16 offset:51232
v_mfma_f32_16x16x32_bf16 v[52:55], a[4:7], a[164:167], v[52:55]
v_mfma_f32_16x16x32_bf16 v[56:59], a[4:7], a[168:171], v[56:59]
ds_read_b64_tr_b16 a[72:73], v16 offset:59136
v_mfma_f32_16x16x32_bf16 v[60:63], a[4:7], a[172:175], v[60:63]
buffer_load_dwordx4 a[144:147], v10, s[16:19], s52 offen sc1
v_mfma_f32_16x16x32_bf16 v[64:67], a[8:11], a[160:163], v[64:67]
ds_read_b64_tr_b16 a[74:75], v16 offset:59648
v_mfma_f32_16x16x32_bf16 v[68:71], a[8:11], a[164:167], v[68:71]
ds_read_b64_tr_b16 a[76:77], v16 offset:59168
v_mfma_f32_16x16x32_bf16 v[72:75], a[8:11], a[168:171], v[72:75]
v_mfma_f32_16x16x32_bf16 v[76:79], a[8:11], a[172:175], v[76:79]
ds_read_b64_tr_b16 a[78:79], v16 offset:59680
v_mfma_f32_16x16x32_bf16 v[80:83], a[12:15], a[160:163], v[80:83]
ds_read_b64_tr_b16 a[80:81], v16 offset:50752
v_mfma_f32_16x16x32_bf16 v[84:87], a[12:15], a[164:167], v[84:87]
buffer_load_dwordx4 v13, s[32:35], s54 offen offset:1056 lds
v_mfma_f32_16x16x32_bf16 v[88:91], a[12:15], a[168:171], v[88:91]
ds_read_b64_tr_b16 a[82:83], v16 offset:51264
v_mfma_f32_16x16x32_bf16 v[92:95], a[12:15], a[172:175], v[92:95]
v_mfma_f32_16x16x32_bf16 v[96:99], a[16:19], a[160:163], v[96:99]
ds_read_b64_tr_b16 a[84:85], v16 offset:50784
v_mfma_f32_16x16x32_bf16 v[100:103], a[16:19], a[164:167], v[100:103]
ds_read_b64_tr_b16 a[86:87], v16 offset:51296
v_mfma_f32_16x16x32_bf16 v[104:107], a[16:19], a[168:171], v[104:107]
ds_read_b64_tr_b16 a[88:89], v16 offset:59200
v_mfma_f32_16x16x32_bf16 v[108:111], a[16:19], a[172:175], v[108:111]
buffer_load_dwordx4 a[148:151], v10, s[16:19], s52 offen offset:1024 sc1
v_mfma_f32_16x16x32_bf16 v[112:115], a[20:23], a[160:163], v[112:115]
v_mfma_f32_16x16x32_bf16 v[116:119], a[20:23], a[164:167], v[116:119]
ds_read_b64_tr_b16 a[90:91], v16 offset:59712
v_mfma_f32_16x16x32_bf16 v[120:123], a[20:23], a[168:171], v[120:123]
ds_read_b64_tr_b16 a[92:93], v16 offset:59232
v_mfma_f32_16x16x32_bf16 v[124:127], a[20:23], a[172:175], v[124:127]
ds_read_b64_tr_b16 a[94:95], v16 offset:59744
v_mfma_f32_16x16x32_bf16 v[128:131], a[24:27], a[160:163], v[128:131]
v_mfma_f32_16x16x32_bf16 v[132:135], a[24:27], a[164:167], v[132:135]
buffer_load_dwordx4 v14, s[32:35], s54 offen offset:2112 lds
v_mfma_f32_16x16x32_bf16 v[136:139], a[24:27], a[168:171], v[136:139]
ds_read_b64_tr_b16 a[96:97], v16 offset:50816
v_mfma_f32_16x16x32_bf16 v[140:143], a[24:27], a[172:175], v[140:143]
ds_read_b64_tr_b16 a[98:99], v16 offset:51328
v_mfma_f32_16x16x32_bf16 v[144:147], a[28:31], a[160:163], v[144:147]
ds_read_b64_tr_b16 a[100:101], v16 offset:50848
v_mfma_f32_16x16x32_bf16 v[148:151], a[28:31], a[164:167], v[148:151]
ds_read_b64_tr_b16 a[102:103], v16 offset:51360
v_mfma_f32_16x16x32_bf16 v[152:155], a[28:31], a[168:171], v[152:155]
v_mfma_f32_16x16x32_bf16 v[156:159], a[28:31], a[172:175], v[156:159]
buffer_load_dwordx4 a[152:155], v11, s[16:19], s52 offen sc1
v_mfma_f32_16x16x32_bf16 v[160:163], a[32:35], a[160:163], v[160:163]
ds_read_b64_tr_b16 a[104:105], v16 offset:59264
v_mfma_f32_16x16x32_bf16 v[164:167], a[32:35], a[164:167], v[164:167]
ds_read_b64_tr_b16 a[106:107], v16 offset:59776
v_mfma_f32_16x16x32_bf16 v[168:171], a[32:35], a[168:171], v[168:171]
ds_read_b64_tr_b16 a[108:109], v16 offset:59296
v_mfma_f32_16x16x32_bf16 v[172:175], a[32:35], a[172:175], v[172:175]
v_mfma_f32_16x16x32_bf16 v[176:179], a[36:39], a[160:163], v[176:179]
ds_read_b64_tr_b16 a[110:111], v16 offset:59808
v_mfma_f32_16x16x32_bf16 v[180:183], a[36:39], a[164:167], v[180:183]
buffer_load_dwordx4 v15, s[32:35], s54 offen offset:3168 lds
v_mfma_f32_16x16x32_bf16 v[184:187], a[36:39], a[168:171], v[184:187]
ds_read_b64_tr_b16 a[112:113], v17 offset:50688
s_add_u32 s54, s54, 229376
v_mfma_f32_16x16x32_bf16 v[188:191], a[36:39], a[172:175], v[188:191]
ds_read_b64_tr_b16 a[114:115], v17 offset:51200
v_mfma_f32_16x16x32_bf16 v[192:195], a[40:43], a[160:163], v[192:195]
v_mfma_f32_16x16x32_bf16 v[196:199], a[40:43], a[164:167], v[196:199]
ds_read_b64_tr_b16 a[116:117], v17 offset:50720
v_mfma_f32_16x16x32_bf16 v[200:203], a[40:43], a[168:171], v[200:203]
ds_read_b64_tr_b16 a[118:119], v17 offset:51232
v_mfma_f32_16x16x32_bf16 v[204:207], a[40:43], a[172:175], v[204:207]
buffer_load_dwordx4 a[156:159], v11, s[16:19], s52 offen offset:1024 sc1
v_mfma_f32_16x16x32_bf16 v[208:211], a[44:47], a[160:163], v[208:211]
ds_read_b64_tr_b16 a[120:121], v17 offset:59136
s_add_u32 s52, s52, 0x20000
v_mfma_f32_16x16x32_bf16 v[212:215], a[44:47], a[164:167], v[212:215]
v_mfma_f32_16x16x32_bf16 v[216:219], a[44:47], a[168:171], v[216:219]
ds_read_b64_tr_b16 a[122:123], v17 offset:59648
v_mfma_f32_16x16x32_bf16 v[220:223], a[44:47], a[172:175], v[220:223]
.Lpad28:
s_cbranch_execz .Lnopoll53r
ds_read_b64_tr_b16 a[124:125], v17 offset:59168
v_mfma_f32_16x16x32_bf16 v[224:227], a[48:51], a[160:163], v[224:227]
ds_read_b64_tr_b16 a[126:127], v17 offset:59680
s_max_i32 m0, s67, s59
v_mfma_f32_16x16x32_bf16 v[228:231], a[48:51], a[164:167], v[228:231]
buffer_load_dwordx4 v5, s[28:31], s58 offen lds
v_mfma_f32_16x16x32_bf16 v[232:235], a[52:55], a[160:163], v[232:235]
v_mfma_f32_16x16x32_bf16 v[236:239], a[52:55], a[164:167], v[236:239]
v_mfma_f32_16x16x32_bf16 v[240:243], a[56:59], a[160:163], v[240:243]
v_mfma_f32_16x16x32_bf16 v[244:247], a[56:59], a[164:167], v[244:247]
v_mfma_f32_16x16x32_bf16 v[248:251], a[60:63], a[160:163], v[248:251]
v_mfma_f32_16x16x32_bf16 v[252:255], a[60:63], a[164:167], v[252:255]
s_waitcnt vmcnt(20) lgkmcnt(0)
s_barrier
v_mfma_f32_16x16x32_bf16 v[32:35], a[64:67], a[176:179], v[32:35]
ds_read_b64_tr_b16 a[0:1], v16
s_add_u32 m0, s55, 133888
v_mfma_f32_16x16x32_bf16 v[36:39], a[64:67], a[180:183], v[36:39]
buffer_load_dwordx4 v12, s[32:35], s54 offen lds
v_mfma_f32_16x16x32_bf16 v[40:43], a[64:67], a[184:187], v[40:43]
ds_read_b64_tr_b16 a[2:3], v16 offset:512
s_waitcnt vmcnt(20)
v_mfma_f32_16x16x32_bf16 v[44:47], a[64:67], a[188:191], v[44:47]
ds_read_b64_tr_b16 a[4:5], v16 offset:32
v_mfma_f32_16x16x32_bf16 v[48:51], a[68:71], a[176:179], v[48:51]
ds_read_b64_tr_b16 a[6:7], v16 offset:544
v_mfma_f32_16x16x32_bf16 v[52:55], a[68:71], a[180:183], v[52:55]
v_mfma_f32_16x16x32_bf16 v[56:59], a[68:71], a[184:187], v[56:59]
ds_read_b64_tr_b16 a[8:9], v16 offset:8448
v_mfma_f32_16x16x32_bf16 v[60:63], a[68:71], a[188:191], v[60:63]
buffer_load_dwordx4 a[160:163], v10, s[16:19], s52 offen sc1
v_mfma_f32_16x16x32_bf16 v[64:67], a[72:75], a[176:179], v[64:67]
ds_read_b64_tr_b16 a[10:11], v16 offset:8960
v_mfma_f32_16x16x32_bf16 v[68:71], a[72:75], a[180:183], v[68:71]
ds_read_b64_tr_b16 a[12:13], v16 offset:8480
v_mfma_f32_16x16x32_bf16 v[72:75], a[72:75], a[184:187], v[72:75]
ds_read_b64_tr_b16 a[14:15], v16 offset:8992
v_mfma_f32_16x16x32_bf16 v[76:79], a[72:75], a[188:191], v[76:79]
v_mfma_f32_16x16x32_bf16 v[80:83], a[76:79], a[176:179], v[80:83]
ds_read_b64_tr_b16 a[16:17], v16 offset:64
v_mfma_f32_16x16x32_bf16 v[84:87], a[76:79], a[180:183], v[84:87]
buffer_load_dwordx4 v13, s[32:35], s54 offen offset:1056 lds
v_mfma_f32_16x16x32_bf16 v[88:91], a[76:79], a[184:187], v[88:91]
ds_read_b64_tr_b16 a[18:19], v16 offset:576
v_mfma_f32_16x16x32_bf16 v[92:95], a[76:79], a[188:191], v[92:95]
ds_read_b64_tr_b16 a[20:21], v16 offset:96
v_mfma_f32_16x16x32_bf16 v[96:99], a[80:83], a[176:179], v[96:99]
v_mfma_f32_16x16x32_bf16 v[100:103], a[80:83], a[180:183], v[100:103]
ds_read_b64_tr_b16 a[22:23], v16 offset:608
v_mfma_f32_16x16x32_bf16 v[104:107], a[80:83], a[184:187], v[104:107]
ds_read_b64_tr_b16 a[24:25], v16 offset:8512
v_mfma_f32_16x16x32_bf16 v[108:111], a[80:83], a[188:191], v[108:111]
buffer_load_dwordx4 a[164:167], v10, s[16:19], s52 offen offset:1024 sc1
v_mfma_f32_16x16x32_bf16 v[112:115], a[84:87], a[176:179], v[112:115]
ds_read_b64_tr_b16 a[26:27], v16 offset:9024
v_mfma_f32_16x16x32_bf16 v[116:119], a[84:87], a[180:183], v[116:119]
ds_read_b64_tr_b16 a[28:29], v16 offset:8544
v_mfma_f32_16x16x32_bf16 v[120:123], a[84:87], a[184:187], v[120:123]
v_mfma_f32_16x16x32_bf16 v[124:127], a[84:87], a[188:191], v[124:127]
ds_read_b64_tr_b16 a[30:31], v16 offset:9056
v_mfma_f32_16x16x32_bf16 v[128:131], a[88:91], a[176:179], v[128:131]
ds_read_b64_tr_b16 a[32:33], v16 offset:128
v_mfma_f32_16x16x32_bf16 v[132:135], a[88:91], a[180:183], v[132:135]
buffer_load_dwordx4 v14, s[32:35], s54 offen offset:2112 lds
v_mfma_f32_16x16x32_bf16 v[136:139], a[88:91], a[184:187], v[136:139]
ds_read_b64_tr_b16 a[34:35], v16 offset:640
v_mfma_f32_16x16x32_bf16 v[140:143], a[88:91], a[188:191], v[140:143]
v_mfma_f32_16x16x32_bf16 v[144:147], a[92:95], a[176:179], v[144:147]
ds_read_b64_tr_b16 a[36:37], v16 offset:160
v_mfma_f32_16x16x32_bf16 v[148:151], a[92:95], a[180:183], v[148:151]
ds_read_b64_tr_b16 a[38:39], v16 offset:672
v_mfma_f32_16x16x32_bf16 v[152:155], a[92:95], a[184:187], v[152:155]
ds_read_b64_tr_b16 a[40:41], v16 offset:8576
v_mfma_f32_16x16x32_bf16 v[156:159], a[92:95], a[188:191], v[156:159]
buffer_load_dwordx4 a[168:171], v11, s[16:19], s52 offen sc1
v_mfma_f32_16x16x32_bf16 v[160:163], a[96:99], a[176:179], v[160:163]
ds_read_b64_tr_b16 a[42:43], v16 offset:9088
v_mfma_f32_16x16x32_bf16 v[164:167], a[96:99], a[180:183], v[164:167]
v_mfma_f32_16x16x32_bf16 v[168:171], a[96:99], a[184:187], v[168:171]
ds_read_b64_tr_b16 a[44:45], v16 offset:8608
v_mfma_f32_16x16x32_bf16 v[172:175], a[96:99], a[188:191], v[172:175]
ds_read_b64_tr_b16 a[46:47], v16 offset:9120
v_mfma_f32_16x16x32_bf16 v[176:179], a[100:103], a[176:179], v[176:179]
ds_read_b64_tr_b16 a[48:49], v17
v_mfma_f32_16x16x32_bf16 v[180:183], a[100:103], a[180:183], v[180:183]
buffer_load_dwordx4 v15, s[32:35], s54 offen offset:3168 lds
v_mfma_f32_16x16x32_bf16 v[184:187], a[100:103], a[184:187], v[184:187]
s_add_u32 s54, s54, 229376
v_mfma_f32_16x16x32_bf16 v[188:191], a[100:103], a[188:191], v[188:191]
ds_read_b64_tr_b16 a[50:51], v17 offset:512
v_mfma_f32_16x16x32_bf16 v[192:195], a[104:107], a[176:179], v[192:195]
ds_read_b64_tr_b16 a[52:53], v17 offset:32
v_mfma_f32_16x16x32_bf16 v[196:199], a[104:107], a[180:183], v[196:199]
ds_read_b64_tr_b16 a[54:55], v17 offset:544
v_mfma_f32_16x16x32_bf16 v[200:203], a[104:107], a[184:187], v[200:203]
ds_read_b64_tr_b16 a[56:57], v17 offset:8448
v_mfma_f32_16x16x32_bf16 v[204:207], a[104:107], a[188:191], v[204:207]
buffer_load_dwordx4 a[172:175], v11, s[16:19], s52 offen offset:1024 sc1
v_mfma_f32_16x16x32_bf16 v[208:211], a[108:111], a[176:179], v[208:211]
s_add_u32 s52, s52, 0x20000
v_mfma_f32_16x16x32_bf16 v[212:215], a[108:111], a[180:183], v[212:215]
ds_read_b64_tr_b16 a[58:59], v17 offset:8960
v_mfma_f32_16x16x32_bf16 v[216:219], a[108:111], a[184:187], v[216:219]
ds_read_b64_tr_b16 a[60:61], v17 offset:8480
v_mfma_f32_16x16x32_bf16 v[220:223], a[108:111], a[188:191], v[220:223]
ds_read_b64_tr_b16 a[62:63], v17 offset:8992
v_mfma_f32_16x16x32_bf16 v[224:227], a[112:115], a[176:179], v[224:227]
s_max_i32 m0, s67, s59
v_mfma_f32_16x16x32_bf16 v[228:231], a[112:115], a[180:183], v[228:231]
buffer_load_dwordx4 v6, s[28:31], s58 offen offset:1024 lds
v_mfma_f32_16x16x32_bf16 v[232:235], a[116:119], a[176:179], v[232:235]
s_add_u32 s67, s67, 8320
s_add_u32 s58, s58, 0x20000
v_mfma_f32_16x16x32_bf16 v[236:239], a[116:119], a[180:183], v[236:239]
v_mfma_f32_16x16x32_bf16 v[240:243], a[120:123], a[176:179], v[240:243]
v_mfma_f32_16x16x32_bf16 v[244:247], a[120:123], a[180:183], v[244:247]
v_mfma_f32_16x16x32_bf16 v[248:251], a[124:127], a[176:179], v[248:251]
s_add_u32 s15, s15, 1
v_mfma_f32_16x16x32_bf16 v[252:255], a[124:127], a[180:183], v[252:255]
s_cbranch_scc0 .Lk54
s_waitcnt vmcnt(11) lgkmcnt(0)
s_barrier
v_mfma_f32_16x16x32_bf16 v[32:35], a[0:3], a[128:131], v[32:35]
ds_read_b128 v[12:15], v9
v_mov_b32 v18, v5
v_mfma_f32_16x16x32_bf16 v[48:51], a[4:7], a[128:131], v[48:51]
buffer_load_dwordx4 a[176:179], v10, s[16:19], s52 offen sc1
v_mfma_f32_16x16x32_bf16 v[64:67], a[8:11], a[128:131], v[64:67]
ds_read_b64_tr_b16 a[64:65], v16 offset:16896
v_mov_b32 v19, v6
v_mfma_f32_16x16x32_bf16 v[80:83], a[12:15], a[128:131], v[80:83]
ds_read_b128 v[4:7], v9 offset:64
s_mov_b32 s58, 1310720
v_mfma_f32_16x16x32_bf16 v[36:39], a[0:3], a[132:135], v[36:39]
ds_read_b64_tr_b16 a[66:67], v16 offset:17408
v_mfma_f32_16x16x32_bf16 v[52:55], a[4:7], a[132:135], v[52:55]
buffer_load_dwordx4 a[180:183], v10, s[16:19], s52 offen offset:1024 sc1
v_mfma_f32_16x16x32_bf16 v[68:71], a[8:11], a[132:135], v[68:71]
ds_read_b64_tr_b16 a[68:69], v16 offset:16928
v_mfma_f32_16x16x32_bf16 v[84:87], a[12:15], a[132:135], v[84:87]
ds_read_b64_tr_b16 a[70:71], v16 offset:17440
v_mfma_f32_16x16x32_bf16 v[40:43], a[0:3], a[136:139], v[40:43]
ds_read_b64_tr_b16 a[72:73], v16 offset:25344
s_waitcnt lgkmcnt(6)
v_fmac_f32 v32, v12, v20
v_mfma_f32_16x16x32_bf16 v[56:59], a[4:7], a[136:139], v[56:59]
buffer_load_dwordx4 a[184:187], v11, s[16:19], s52 offen sc1
v_mfma_f32_16x16x32_bf16 v[72:75], a[8:11], a[136:139], v[72:75]
ds_read_b64_tr_b16 a[74:75], v16 offset:25856
v_fmac_f32 v33, v13, v20
v_mfma_f32_16x16x32_bf16 v[88:91], a[12:15], a[136:139], v[88:91]
ds_read_b64_tr_b16 a[76:77], v16 offset:25376
v_fmac_f32 v34, v14, v20
v_mfma_f32_16x16x32_bf16 v[44:47], a[0:3], a[140:143], v[44:47]
ds_read_b64_tr_b16 a[78:79], v16 offset:25888
v_fmac_f32 v35, v15, v20
v_mfma_f32_16x16x32_bf16 v[60:63], a[4:7], a[140:143], v[60:63]
buffer_load_dwordx4 a[188:191], v11, s[16:19], s52 offen offset:1024 sc1
v_mfma_f32_16x16x32_bf16 v[76:79], a[8:11], a[140:143], v[76:79]
s_add_u32 s52, s52, 0x20000
ds_read_b64_tr_b16 a[80:81], v16 offset:33792
v_mfma_f32_16x16x32_bf16 v[92:95], a[12:15], a[140:143], v[92:95]
ds_read_b64_tr_b16 a[82:83], v16 offset:34304
v_fmac_f32 v36, v12, v22
v_mfma_f32_16x16x32_bf16 v[96:99], a[16:19], a[128:131], v[96:99]
ds_read_b64_tr_b16 a[84:85], v16 offset:33824
v_fmac_f32 v37, v13, v22
v_mfma_f32_16x16x32_bf16 v[112:115], a[20:23], a[128:131], v[112:115]
ds_read_b64_tr_b16 a[86:87], v16 offset:34336
v_fmac_f32 v38, v14, v22
v_mfma_f32_16x16x32_bf16 v[128:131], a[24:27], a[128:131], v[128:131]
ds_read_b64_tr_b16 a[88:89], v16 offset:42240
v_fmac_f32 v39, v15, v22
v_mfma_f32_16x16x32_bf16 v[144:147], a[28:31], a[128:131], v[144:147]
ds_read_b64_tr_b16 a[90:91], v16 offset:42752
v_fmac_f32 v40, v12, v24
v_mfma_f32_16x16x32_bf16 v[100:103], a[16:19], a[132:135], v[100:103]
ds_read_b64_tr_b16 a[92:93], v16 offset:42272
v_fmac_f32 v41, v13, v24
v_mfma_f32_16x16x32_bf16 v[116:119], a[20:23], a[132:135], v[116:119]
ds_read_b64_tr_b16 a[94:95], v16 offset:42784
v_fmac_f32 v42, v14, v24
v_mfma_f32_16x16x32_bf16 v[132:135], a[24:27], a[132:135], v[132:135]
ds_read_b64_tr_b16 a[112:113], v16 offset:16960
v_fmac_f32 v43, v15, v24
v_mfma_f32_16x16x32_bf16 v[148:151], a[28:31], a[132:135], v[148:151]
ds_read_b64_tr_b16 a[114:115], v16 offset:17472
v_fmac_f32 v44, v12, v26
v_mfma_f32_16x16x32_bf16 v[104:107], a[16:19], a[136:139], v[104:107]
ds_read_b64_tr_b16 a[116:117], v16 offset:16992
v_fmac_f32 v45, v13, v26
v_mfma_f32_16x16x32_bf16 v[120:123], a[20:23], a[136:139], v[120:123]
ds_read_b64_tr_b16 a[118:119], v16 offset:17504
v_fmac_f32 v46, v14, v26
v_mfma_f32_16x16x32_bf16 v[136:139], a[24:27], a[136:139], v[136:139]
ds_read_b64_tr_b16 a[120:121], v16 offset:25408
v_fmac_f32 v47, v15, v26
v_mfma_f32_16x16x32_bf16 v[152:155], a[28:31], a[136:139], v[152:155]
ds_read_b128 v[12:15], v9 offset:512
s_waitcnt lgkmcnt(15)
v_fmac_f32 v48, v4, v20
v_mfma_f32_16x16x32_bf16 v[108:111], a[16:19], a[140:143], v[108:111]
ds_read_b64_tr_b16 a[122:123], v16 offset:25920
v_fmac_f32 v49, v5, v20
v_mfma_f32_16x16x32_bf16 v[124:127], a[20:23], a[140:143], v[124:127]
ds_read_b64_tr_b16 a[124:125], v16 offset:25440
v_fmac_f32 v50, v6, v20
v_mfma_f32_16x16x32_bf16 v[140:143], a[24:27], a[140:143], v[140:143]
ds_read_b64_tr_b16 a[126:127], v16 offset:25952
v_fmac_f32 v51, v7, v20
v_mfma_f32_16x16x32_bf16 v[156:159], a[28:31], a[140:143], v[156:159]
ds_read_b64_tr_b16 a[192:193], v16 offset:33856
v_fmac_f32 v52, v4, v22
v_mfma_f32_16x16x32_bf16 v[160:163], a[32:35], a[128:131], v[160:163]
ds_read_b64_tr_b16 a[194:195], v16 offset:34368
v_fmac_f32 v53, v5, v22
v_mfma_f32_16x16x32_bf16 v[176:179], a[36:39], a[128:131], v[176:179]
ds_read_b64_tr_b16 a[196:197], v16 offset:33888
v_fmac_f32 v54, v6, v22
v_mfma_f32_16x16x32_bf16 v[192:195], a[40:43], a[128:131], v[192:195]
ds_read_b64_tr_b16 a[198:199], v16 offset:34400
v_fmac_f32 v55, v7, v22
v_mfma_f32_16x16x32_bf16 v[208:211], a[44:47], a[128:131], v[208:211]
ds_read_b64_tr_b16 a[200:201], v16 offset:42304
v_fmac_f32 v56, v4, v24
v_mfma_f32_16x16x32_bf16 v[164:167], a[32:35], a[132:135], v[164:167]
ds_read_b64_tr_b16 a[202:203], v16 offset:42816
v_fmac_f32 v57, v5, v24
v_mfma_f32_16x16x32_bf16 v[180:183], a[36:39], a[132:135], v[180:183]
ds_read_b64_tr_b16 a[204:205], v16 offset:42336
s_waitcnt vmcnt(6)
s_barrier
v_mfma_f32_16x16x32_bf16 v[196:199], a[40:43], a[132:135], v[196:199]
ds_read_b64_tr_b16 a[96:97], v16 offset:50688
v_fmac_f32 v58, v6, v24
v_mfma_f32_16x16x32_bf16 v[212:215], a[44:47], a[132:135], v[212:215]
ds_read_b64_tr_b16 a[98:99], v16 offset:51200
v_fmac_f32 v59, v7, v24
v_mfma_f32_16x16x32_bf16 v[168:171], a[32:35], a[136:139], v[168:171]
ds_read_b64_tr_b16 a[100:101], v16 offset:50720
v_fmac_f32 v60, v4, v26
v_mfma_f32_16x16x32_bf16 v[184:187], a[36:39], a[136:139], v[184:187]
ds_read_b64_tr_b16 a[102:103], v16 offset:51232
v_fmac_f32 v61, v5, v26
v_mfma_f32_16x16x32_bf16 v[200:203], a[40:43], a[136:139], v[200:203]
ds_read_b64_tr_b16 a[104:105], v16 offset:59136
v_fmac_f32 v62, v6, v26
v_mfma_f32_16x16x32_bf16 v[216:219], a[44:47], a[136:139], v[216:219]
ds_read_b64_tr_b16 a[106:107], v16 offset:59648
v_fmac_f32 v63, v7, v26
v_mfma_f32_16x16x32_bf16 v[172:175], a[32:35], a[140:143], v[172:175]
ds_read_b128 v[4:7], v9 offset:576
s_waitcnt lgkmcnt(15)
v_fmac_f32 v64, v12, v20
v_mfma_f32_16x16x32_bf16 v[188:191], a[36:39], a[140:143], v[188:191]
ds_read_b64_tr_b16 a[108:109], v16 offset:59168
v_fmac_f32 v65, v13, v20
v_mfma_f32_16x16x32_bf16 v[204:207], a[40:43], a[140:143], v[204:207]
ds_read_b64_tr_b16 a[110:111], v16 offset:59680
v_fmac_f32 v66, v14, v20
v_mfma_f32_16x16x32_bf16 v[220:223], a[44:47], a[140:143], v[220:223]
ds_read_b64_tr_b16 a[206:207], v16 offset:42848
v_fmac_f32 v67, v15, v20
v_mfma_f32_16x16x32_bf16 v[224:227], a[48:51], a[128:131], v[224:227]
ds_read_b64_tr_b16 a[208:209], v16 offset:50752
v_fmac_f32 v68, v12, v22
v_mfma_f32_16x16x32_bf16 v[232:235], a[52:55], a[128:131], v[232:235]
ds_read_b64_tr_b16 a[210:211], v16 offset:51264
v_fmac_f32 v69, v13, v22
v_mfma_f32_16x16x32_bf16 v[240:243], a[56:59], a[128:131], v[240:243]
ds_read_b64_tr_b16 a[212:213], v16 offset:50784
v_fmac_f32 v70, v14, v22
v_mfma_f32_16x16x32_bf16 v[248:251], a[60:63], a[128:131], v[248:251]
ds_read_b64_tr_b16 a[214:215], v16 offset:51296
v_fmac_f32 v71, v15, v22
v_mfma_f32_16x16x32_bf16 v[228:231], a[48:51], a[132:135], v[228:231]
ds_read_b64_tr_b16 a[216:217], v16 offset:59200
v_fmac_f32 v72, v12, v24
v_mfma_f32_16x16x32_bf16 v[236:239], a[52:55], a[132:135], v[236:239]
ds_read_b64_tr_b16 a[218:219], v16 offset:59712
v_fmac_f32 v73, v13, v24
v_mfma_f32_16x16x32_bf16 v[244:247], a[56:59], a[132:135], v[244:247]
ds_read_b64_tr_b16 a[220:221], v16 offset:59232
v_fmac_f32 v74, v14, v24
v_mfma_f32_16x16x32_bf16 v[252:255], a[60:63], a[132:135], v[252:255]
ds_read_b64_tr_b16 a[222:223], v16 offset:59744
v_fmac_f32 v75, v15, v24
v_mfma_f32_16x16x32_bf16 v[32:35], a[64:67], a[144:147], v[32:35]
ds_read_b64_tr_b16 a[0:1], v16 offset:17024
v_fmac_f32 v76, v12, v26
v_mfma_f32_16x16x32_bf16 v[48:51], a[68:71], a[144:147], v[48:51]
ds_read_b64_tr_b16 a[2:3], v16 offset:17536
v_fmac_f32 v77, v13, v26
v_mfma_f32_16x16x32_bf16 v[64:67], a[72:75], a[144:147], v[64:67]
ds_read_b64_tr_b16 a[4:5], v16 offset:17056
v_fmac_f32 v78, v14, v26
v_fmac_f32 v79, v15, v26
ds_read_b128 v[12:15], v9 offset:832
s_waitcnt lgkmcnt(15)
v_fmac_f32 v80, v4, v20
v_fmac_f32 v81, v5, v20
v_fmac_f32 v82, v6, v20
v_fmac_f32 v83, v7, v20
v_fmac_f32 v84, v4, v22
v_fmac_f32 v85, v5, v22
v_mfma_f32_16x16x32_bf16 v[80:83], a[76:79], a[144:147], v[80:83]
ds_read_b64_tr_b16 a[6:7], v16 offset:17568
v_fmac_f32 v86, v6, v22
v_mfma_f32_16x16x32_bf16 v[32:35], a[80:83], a[160:163], v[32:35]
ds_read_b64_tr_b16 a[8:9], v16 offset:25472
v_fmac_f32 v87, v7, v22
v_mfma_f32_16x16x32_bf16 v[48:51], a[84:87], a[160:163], v[48:51]
ds_read_b64_tr_b16 a[10:11], v16 offset:25984
v_fmac_f32 v88, v4, v24
v_mfma_f32_16x16x32_bf16 v[64:67], a[88:91], a[160:163], v[64:67]
ds_read_b64_tr_b16 a[12:13], v16 offset:25504
v_fmac_f32 v89, v5, v24
v_mfma_f32_16x16x32_bf16 v[80:83], a[92:95], a[160:163], v[80:83]
ds_read_b64_tr_b16 a[14:15], v16 offset:26016
v_fmac_f32 v90, v6, v24
s_waitcnt vmcnt(3)
v_mfma_f32_16x16x32_bf16 v[32:35], a[96:99], a[176:179], v[32:35]
ds_read_b64_tr_b16 a[16:17], v16 offset:33920
v_fmac_f32 v91, v7, v24
v_mfma_f32_16x16x32_bf16 v[48:51], a[100:103], a[176:179], v[48:51]
ds_read_b64_tr_b16 a[18:19], v16 offset:34432
v_fmac_f32 v92, v4, v26
v_mfma_f32_16x16x32_bf16 v[64:67], a[104:107], a[176:179], v[64:67]
ds_read_b64_tr_b16 a[20:21], v16 offset:33952
v_fmac_f32 v93, v5, v26
s_waitcnt lgkmcnt(15)
v_mfma_f32_16x16x32_bf16 v[80:83], a[108:111], a[176:179], v[80:83]
ds_read_b64_tr_b16 a[22:23], v16 offset:34464
v_fmac_f32 v94, v6, v26
v_fmac_f32 v95, v7, v26
ds_read_b128 v[4:7], v9 offset:704
v_pk_mul_f32 v[64:65], v[64:65], v[32:33]
v_pk_mul_f32 v[32:33], v[32:33], v[28:29] op_sel_hi:[1,0]
v_pk_mul_f32 v[66:67], v[66:67], v[34:35]
v_pk_mul_f32 v[34:35], v[34:35], v[28:29] op_sel_hi:[1,0]
v_pk_mul_f32 v[80:81], v[80:81], v[48:49]
v_pk_mul_f32 v[48:49], v[48:49], v[28:29] op_sel_hi:[1,0]
v_pk_mul_f32 v[82:83], v[82:83], v[50:51]
v_pk_mul_f32 v[50:51], v[50:51], v[28:29] op_sel_hi:[1,0]
v_exp_f32 v32, v32
s_nop 0
v_mfma_f32_16x16x32_bf16 v[36:39], a[64:67], a[148:151], v[36:39]
ds_read_b64_tr_b16 a[24:25], v16 offset:42368
v_exp_f32 v33, v33
v_mfma_f32_16x16x32_bf16 v[52:55], a[68:71], a[148:151], v[52:55]
ds_read_b64_tr_b16 a[26:27], v16 offset:42880
v_exp_f32 v34, v34
v_mfma_f32_16x16x32_bf16 v[68:71], a[72:75], a[148:151], v[68:71]
ds_read_b64_tr_b16 a[28:29], v16 offset:42400
v_exp_f32 v35, v35
v_mfma_f32_16x16x32_bf16 v[84:87], a[76:79], a[148:151], v[84:87]
ds_read_b64_tr_b16 a[30:31], v16 offset:42912
v_exp_f32 v48, v48
v_mfma_f32_16x16x32_bf16 v[36:39], a[80:83], a[164:167], v[36:39]
ds_read_b64_tr_b16 a[32:33], v16 offset:50816
v_exp_f32 v49, v49
v_mfma_f32_16x16x32_bf16 v[52:55], a[84:87], a[164:167], v[52:55]
ds_read_b64_tr_b16 a[34:35], v16 offset:51328
v_exp_f32 v50, v50
v_mfma_f32_16x16x32_bf16 v[68:71], a[88:91], a[164:167], v[68:71]
ds_read_b64_tr_b16 a[36:37], v16 offset:50848
v_exp_f32 v51, v51
v_mfma_f32_16x16x32_bf16 v[84:87], a[92:95], a[164:167], v[84:87]
ds_read_b64_tr_b16 a[38:39], v16 offset:51360
s_waitcnt vmcnt(2)
v_mfma_f32_16x16x32_bf16 v[36:39], a[96:99], a[180:183], v[36:39]
ds_read_b64_tr_b16 a[40:41], v16 offset:59264
v_mfma_f32_16x16x32_bf16 v[52:55], a[100:103], a[180:183], v[52:55]
ds_read_b64_tr_b16 a[42:43], v16 offset:59776
v_mfma_f32_16x16x32_bf16 v[68:71], a[104:107], a[180:183], v[68:71]
ds_read_b64_tr_b16 a[44:45], v16 offset:59296
v_mfma_f32_16x16x32_bf16 v[84:87], a[108:111], a[180:183], v[84:87]
ds_read_b64_tr_b16 a[46:47], v16 offset:59808
s_nop 4
v_pk_mul_f32 v[68:69], v[68:69], v[36:37]
v_pk_mul_f32 v[36:37], v[36:37], v[28:29] op_sel:[0,1] op_sel_hi:[1,1]
v_pk_mul_f32 v[70:71], v[70:71], v[38:39]
v_pk_mul_f32 v[38:39], v[38:39], v[28:29] op_sel:[0,1] op_sel_hi:[1,1]
v_pk_mul_f32 v[84:85], v[84:85], v[52:53]
v_pk_mul_f32 v[52:53], v[52:53], v[28:29] op_sel:[0,1] op_sel_hi:[1,1]
v_pk_mul_f32 v[86:87], v[86:87], v[54:55]
v_pk_mul_f32 v[54:55], v[54:55], v[28:29] op_sel:[0,1] op_sel_hi:[1,1]
v_pk_fma_f32 v[32:33], v[32:33], v[20:21], v[20:21] op_sel:[0,1,1] op_sel_hi:[1,1,1]
v_pk_fma_f32 v[34:35], v[34:35], v[20:21], v[20:21] op_sel:[0,1,1] op_sel_hi:[1,1,1]
v_pk_fma_f32 v[48:49], v[48:49], v[20:21], v[20:21] op_sel:[0,1,1] op_sel_hi:[1,1,1]
v_pk_fma_f32 v[50:51], v[50:51], v[20:21], v[20:21] op_sel:[0,1,1] op_sel_hi:[1,1,1]
v_rcp_f32 v32, v32
s_nop 0
v_mfma_f32_16x16x32_bf16 v[40:43], a[64:67], a[152:155], v[40:43]
ds_read_b64_tr_b16 a[48:49], v17 offset:16896
v_rcp_f32 v33, v33
v_mfma_f32_16x16x32_bf16 v[56:59], a[68:71], a[152:155], v[56:59]
ds_read_b64_tr_b16 a[50:51], v17 offset:17408
v_rcp_f32 v34, v34
v_mfma_f32_16x16x32_bf16 v[72:75], a[72:75], a[152:155], v[72:75]
ds_read_b64_tr_b16 a[52:53], v17 offset:16928
v_rcp_f32 v35, v35
v_mfma_f32_16x16x32_bf16 v[88:91], a[76:79], a[152:155], v[88:91]
ds_read_b64_tr_b16 a[54:55], v17 offset:17440
v_rcp_f32 v48, v48
v_mfma_f32_16x16x32_bf16 v[40:43], a[80:83], a[168:171], v[40:43]
ds_read_b64_tr_b16 a[56:57], v17 offset:25344
v_rcp_f32 v49, v49
v_mfma_f32_16x16x32_bf16 v[56:59], a[84:87], a[168:171], v[56:59]
ds_read_b64_tr_b16 a[58:59], v17 offset:25856
v_rcp_f32 v50, v50
v_mfma_f32_16x16x32_bf16 v[72:75], a[88:91], a[168:171], v[72:75]
ds_read_b64_tr_b16 a[60:61], v17 offset:25376
v_rcp_f32 v51, v51
v_mfma_f32_16x16x32_bf16 v[88:91], a[92:95], a[168:171], v[88:91]
ds_read_b64_tr_b16 a[62:63], v17 offset:25888
v_exp_f32 v36, v36
s_waitcnt vmcnt(1)
v_mfma_f32_16x16x32_bf16 v[40:43], a[96:99], a[184:187], v[40:43]
v_exp_f32 v37, v37
v_mfma_f32_16x16x32_bf16 v[56:59], a[100:103], a[184:187], v[56:59]
v_exp_f32 v38, v38
v_mfma_f32_16x16x32_bf16 v[72:75], a[104:107], a[184:187], v[72:75]
v_exp_f32 v39, v39
v_mfma_f32_16x16x32_bf16 v[88:91], a[108:111], a[184:187], v[88:91]
v_exp_f32 v52, v52
v_exp_f32 v53, v53
v_exp_f32 v54, v54
v_exp_f32 v55, v55
v_pk_mul_f32 v[64:65], v[64:65], v[32:33]
v_pk_mul_f32 v[66:67], v[66:67], v[34:35]
v_pk_mul_f32 v[80:81], v[80:81], v[48:49]
v_pk_mul_f32 v[82:83], v[82:83], v[50:51]
ds_read_b128 v[48:51], v9 offset:128
v_pk_mul_f32 v[72:73], v[72:73], v[40:41]
v_pk_mul_f32 v[40:41], v[40:41], v[30:31] op_sel_hi:[1,0]
v_pk_mul_f32 v[74:75], v[74:75], v[42:43]
v_pk_mul_f32 v[42:43], v[42:43], v[30:31] op_sel_hi:[1,0]
v_pk_mul_f32 v[88:89], v[88:89], v[56:57]
v_pk_mul_f32 v[56:57], v[56:57], v[30:31] op_sel_hi:[1,0]
v_pk_mul_f32 v[90:91], v[90:91], v[58:59]
v_pk_mul_f32 v[58:59], v[58:59], v[30:31] op_sel_hi:[1,0]
v_pk_fma_f32 v[36:37], v[36:37], v[22:23], v[22:23] op_sel:[0,1,1] op_sel_hi:[1,1,1]
v_pk_fma_f32 v[38:39], v[38:39], v[22:23], v[22:23] op_sel:[0,1,1] op_sel_hi:[1,1,1]
v_pk_fma_f32 v[52:53], v[52:53], v[22:23], v[22:23] op_sel:[0,1,1] op_sel_hi:[1,1,1]
v_pk_fma_f32 v[54:55], v[54:55], v[22:23], v[22:23] op_sel:[0,1,1] op_sel_hi:[1,1,1]
v_cvt_pk_bf16_f32 v32, v64, v65
v_cvt_pk_bf16_f32 v33, v66, v67
ds_read_b128 v[64:67], v9 offset:192
v_cvt_pk_bf16_f32 v34, v80, v81
v_cvt_pk_bf16_f32 v35, v82, v83
v_mfma_f32_16x16x32_bf16 v[44:47], a[64:67], a[156:159], v[44:47]
buffer_store_dwordx4 v[32:35], v10, s[16:19], s62 offen sc1
v_mfma_f32_16x16x32_bf16 v[60:63], a[68:71], a[156:159], v[60:63]
ds_read_b128 v[80:83], v9 offset:640
v_rcp_f32 v36, v36
v_mfma_f32_16x16x32_bf16 v[76:79], a[72:75], a[156:159], v[76:79]
ds_read_b64_tr_b16 a[64:65], v17 offset:33792
v_rcp_f32 v37, v37
v_mfma_f32_16x16x32_bf16 v[92:95], a[76:79], a[156:159], v[92:95]
ds_read_b64_tr_b16 a[66:67], v17 offset:34304
v_rcp_f32 v38, v38
v_mfma_f32_16x16x32_bf16 v[44:47], a[80:83], a[172:175], v[44:47]
ds_read_b64_tr_b16 a[68:69], v17 offset:33824
v_rcp_f32 v39, v39
v_mfma_f32_16x16x32_bf16 v[60:63], a[84:87], a[172:175], v[60:63]
ds_read_b64_tr_b16 a[70:71], v17 offset:34336
v_rcp_f32 v52, v52
v_mfma_f32_16x16x32_bf16 v[76:79], a[88:91], a[172:175], v[76:79]
ds_read_b64_tr_b16 a[72:73], v17 offset:42240
v_rcp_f32 v53, v53
v_mfma_f32_16x16x32_bf16 v[92:95], a[92:95], a[172:175], v[92:95]
ds_read_b64_tr_b16 a[74:75], v17 offset:42752
v_rcp_f32 v54, v54
s_waitcnt vmcnt(1)
v_mfma_f32_16x16x32_bf16 v[44:47], a[96:99], a[188:191], v[44:47]
ds_read_b64_tr_b16 a[76:77], v17 offset:42272
v_rcp_f32 v55, v55
v_mfma_f32_16x16x32_bf16 v[60:63], a[100:103], a[188:191], v[60:63]
ds_read_b64_tr_b16 a[78:79], v17 offset:42784
v_exp_f32 v40, v40
v_mfma_f32_16x16x32_bf16 v[76:79], a[104:107], a[188:191], v[76:79]
ds_read_b64_tr_b16 a[80:81], v17 offset:50688
v_exp_f32 v41, v41
v_mfma_f32_16x16x32_bf16 v[92:95], a[108:111], a[188:191], v[92:95]
ds_read_b64_tr_b16 a[82:83], v17 offset:51200
v_exp_f32 v42, v42
v_exp_f32 v43, v43
v_exp_f32 v56, v56
v_exp_f32 v57, v57
v_exp_f32 v58, v58
v_exp_f32 v59, v59
v_pk_mul_f32 v[68:69], v[68:69], v[36:37]
v_pk_mul_f32 v[70:71], v[70:71], v[38:39]
v_pk_mul_f32 v[84:85], v[84:85], v[52:53]
v_pk_mul_f32 v[86:87], v[86:87], v[54:55]
v_pk_mul_f32 v[76:77], v[76:77], v[44:45]
v_pk_mul_f32 v[44:45], v[44:45], v[30:31] op_sel:[0,1] op_sel_hi:[1,1]
v_pk_mul_f32 v[78:79], v[78:79], v[46:47]
v_pk_mul_f32 v[46:47], v[46:47], v[30:31] op_sel:[0,1] op_sel_hi:[1,1]
v_pk_mul_f32 v[92:93], v[92:93], v[60:61]
v_pk_mul_f32 v[60:61], v[60:61], v[30:31] op_sel:[0,1] op_sel_hi:[1,1]
v_pk_mul_f32 v[94:95], v[94:95], v[62:63]
v_pk_mul_f32 v[62:63], v[62:63], v[30:31] op_sel:[0,1] op_sel_hi:[1,1]
v_pk_fma_f32 v[40:41], v[40:41], v[24:25], v[24:25] op_sel:[0,1,1] op_sel_hi:[1,1,1]
v_pk_fma_f32 v[42:43], v[42:43], v[24:25], v[24:25] op_sel:[0,1,1] op_sel_hi:[1,1,1]
v_pk_fma_f32 v[56:57], v[56:57], v[24:25], v[24:25] op_sel:[0,1,1] op_sel_hi:[1,1,1]
v_pk_fma_f32 v[58:59], v[58:59], v[24:25], v[24:25] op_sel:[0,1,1] op_sel_hi:[1,1,1]
v_cvt_pk_bf16_f32 v36, v68, v69
v_cvt_pk_bf16_f32 v37, v70, v71
v_cvt_pk_bf16_f32 v38, v84, v85
v_cvt_pk_bf16_f32 v39, v86, v87
v_mfma_f32_16x16x32_bf16 v[96:99], a[112:115], a[144:147], v[96:99]
buffer_store_dwordx4 v[36:39], v10, s[16:19], s62 offen offset:1024 sc1
v_mfma_f32_16x16x32_bf16 v[112:115], a[116:119], a[144:147], v[112:115]
ds_read_b64_tr_b16 a[84:85], v17 offset:50720
v_rcp_f32 v40, v40
v_mfma_f32_16x16x32_bf16 v[128:131], a[120:123], a[144:147], v[128:131]
ds_read_b64_tr_b16 a[86:87], v17 offset:51232
v_rcp_f32 v41, v41
v_mfma_f32_16x16x32_bf16 v[144:147], a[124:127], a[144:147], v[144:147]
ds_read_b64_tr_b16 a[88:89], v17 offset:59136
v_rcp_f32 v42, v42
v_mfma_f32_16x16x32_bf16 v[96:99], a[192:195], a[160:163], v[96:99]
ds_read_b64_tr_b16 a[90:91], v17 offset:59648
v_rcp_f32 v43, v43
v_mfma_f32_16x16x32_bf16 v[112:115], a[196:199], a[160:163], v[112:115]
ds_read_b64_tr_b16 a[92:93], v17 offset:59168
v_rcp_f32 v56, v56
v_mfma_f32_16x16x32_bf16 v[128:131], a[200:203], a[160:163], v[128:131]
ds_read_b64_tr_b16 a[94:95], v17 offset:59680
v_rcp_f32 v57, v57
v_mfma_f32_16x16x32_bf16 v[144:147], a[204:207], a[160:163], v[144:147]
v_rcp_f32 v58, v58
v_mfma_f32_16x16x32_bf16 v[96:99], a[208:211], a[176:179], v[96:99]
v_rcp_f32 v59, v59
v_mfma_f32_16x16x32_bf16 v[112:115], a[212:215], a[176:179], v[112:115]
v_exp_f32 v44, v44
s_waitcnt lgkmcnt(15)
v_mfma_f32_16x16x32_bf16 v[128:131], a[216:219], a[176:179], v[128:131]
v_exp_f32 v45, v45
v_mfma_f32_16x16x32_bf16 v[144:147], a[220:223], a[176:179], v[144:147]
v_exp_f32 v46, v46
v_exp_f32 v47, v47
v_exp_f32 v60, v60
v_exp_f32 v61, v61
v_exp_f32 v62, v62
s_waitcnt lgkmcnt(0)
s_barrier
v_exp_f32 v63, v63
v_pk_mul_f32 v[72:73], v[72:73], v[40:41]
v_pk_mul_f32 v[74:75], v[74:75], v[42:43]
v_pk_mul_f32 v[88:89], v[88:89], v[56:57]
v_pk_mul_f32 v[90:91], v[90:91], v[58:59]
v_pk_fma_f32 v[96:97], v[48:49], v[20:21], v[96:97] op_sel_hi:[1,0,1]
v_pk_fma_f32 v[98:99], v[50:51], v[20:21], v[98:99] op_sel_hi:[1,0,1]
v_pk_fma_f32 v[112:113], v[64:65], v[20:21], v[112:113] op_sel_hi:[1,0,1]
v_pk_fma_f32 v[114:115], v[66:67], v[20:21], v[114:115] op_sel_hi:[1,0,1]
v_pk_fma_f32 v[128:129], v[80:81], v[20:21], v[128:129] op_sel_hi:[1,0,1]
v_pk_fma_f32 v[130:131], v[82:83], v[20:21], v[130:131] op_sel_hi:[1,0,1]
v_pk_fma_f32 v[144:145], v[4:5], v[20:21], v[144:145] op_sel_hi:[1,0,1]
v_pk_fma_f32 v[146:147], v[6:7], v[20:21], v[146:147] op_sel_hi:[1,0,1]
v_pk_mul_f32 v[128:129], v[128:129], v[96:97]
v_pk_mul_f32 v[96:97], v[96:97], v[28:29] op_sel_hi:[1,0]
v_pk_mul_f32 v[130:131], v[130:131], v[98:99]
v_pk_mul_f32 v[98:99], v[98:99], v[28:29] op_sel_hi:[1,0]
v_pk_mul_f32 v[144:145], v[144:145], v[112:113]
v_pk_mul_f32 v[112:113], v[112:113], v[28:29] op_sel_hi:[1,0]
v_pk_mul_f32 v[146:147], v[146:147], v[114:115]
v_pk_mul_f32 v[114:115], v[114:115], v[28:29] op_sel_hi:[1,0]
v_pk_fma_f32 v[44:45], v[44:45], v[26:27], v[26:27] op_sel:[0,1,1] op_sel_hi:[1,1,1]
v_pk_fma_f32 v[46:47], v[46:47], v[26:27], v[26:27] op_sel:[0,1,1] op_sel_hi:[1,1,1]
v_pk_fma_f32 v[60:61], v[60:61], v[26:27], v[26:27] op_sel:[0,1,1] op_sel_hi:[1,1,1]
v_pk_fma_f32 v[62:63], v[62:63], v[26:27], v[26:27] op_sel:[0,1,1] op_sel_hi:[1,1,1]
v_cvt_pk_bf16_f32 v40, v72, v73
v_cvt_pk_bf16_f32 v41, v74, v75
v_cvt_pk_bf16_f32 v42, v88, v89
v_cvt_pk_bf16_f32 v43, v90, v91
v_mfma_f32_16x16x32_bf16 v[100:103], a[112:115], a[148:151], v[100:103]
buffer_store_dwordx4 v[40:43], v11, s[16:19], s62 offen sc1
v_mfma_f32_16x16x32_bf16 v[116:119], a[116:119], a[148:151], v[116:119]
s_add_u32 m0, s59, 83200
v_rcp_f32 v44, v44
v_mfma_f32_16x16x32_bf16 v[132:135], a[120:123], a[148:151], v[132:135]
v_rcp_f32 v45, v45
v_mfma_f32_16x16x32_bf16 v[148:151], a[124:127], a[148:151], v[148:151]
.Lpad29:
s_cbranch_execz .Lnopoll53r
v_rcp_f32 v46, v46
v_mfma_f32_16x16x32_bf16 v[100:103], a[192:195], a[164:167], v[100:103]
buffer_load_dwordx4 v18, s[28:31], s58 offen lds
v_mfma_f32_16x16x32_bf16 v[116:119], a[196:199], a[164:167], v[116:119]
v_rcp_f32 v47, v47
v_mfma_f32_16x16x32_bf16 v[132:135], a[200:203], a[164:167], v[132:135]
v_rcp_f32 v60, v60
v_mfma_f32_16x16x32_bf16 v[148:151], a[204:207], a[164:167], v[148:151]
v_rcp_f32 v61, v61
v_mfma_f32_16x16x32_bf16 v[100:103], a[208:211], a[180:183], v[100:103]
buffer_load_dwordx4 v19, s[28:31], s58 offen offset:1024 lds
v_mfma_f32_16x16x32_bf16 v[116:119], a[212:215], a[180:183], v[116:119]
s_add_u32 m0, s59, 91520
s_mov_b32 s58, 1441792
v_rcp_f32 v62, v62
v_mfma_f32_16x16x32_bf16 v[132:135], a[216:219], a[180:183], v[132:135]
v_rcp_f32 v63, v63
v_mfma_f32_16x16x32_bf16 v[148:151], a[220:223], a[180:183], v[148:151]
v_exp_f32 v96, v96
v_exp_f32 v97, v97
v_exp_f32 v98, v98
v_exp_f32 v99, v99
v_exp_f32 v112, v112
v_exp_f32 v113, v113
v_exp_f32 v114, v114
v_exp_f32 v115, v115
v_pk_mul_f32 v[76:77], v[76:77], v[44:45]
v_pk_mul_f32 v[78:79], v[78:79], v[46:47]
v_pk_mul_f32 v[92:93], v[92:93], v[60:61]
v_pk_mul_f32 v[94:95], v[94:95], v[62:63]
v_pk_fma_f32 v[100:101], v[48:49], v[22:23], v[100:101] op_sel_hi:[1,0,1]
v_pk_fma_f32 v[102:103], v[50:51], v[22:23], v[102:103] op_sel_hi:[1,0,1]
v_pk_fma_f32 v[116:117], v[64:65], v[22:23], v[116:117] op_sel_hi:[1,0,1]
v_pk_fma_f32 v[118:119], v[66:67], v[22:23], v[118:119] op_sel_hi:[1,0,1]
v_pk_fma_f32 v[132:133], v[80:81], v[22:23], v[132:133] op_sel_hi:[1,0,1]
v_pk_fma_f32 v[134:135], v[82:83], v[22:23], v[134:135] op_sel_hi:[1,0,1]
v_pk_fma_f32 v[148:149], v[4:5], v[22:23], v[148:149] op_sel_hi:[1,0,1]
v_pk_fma_f32 v[150:151], v[6:7], v[22:23], v[150:151] op_sel_hi:[1,0,1]
v_pk_mul_f32 v[132:133], v[132:133], v[100:101]
v_pk_mul_f32 v[100:101], v[100:101], v[28:29] op_sel:[0,1] op_sel_hi:[1,1]
v_pk_mul_f32 v[134:135], v[134:135], v[102:103]
v_pk_mul_f32 v[102:103], v[102:103], v[28:29] op_sel:[0,1] op_sel_hi:[1,1]
v_pk_mul_f32 v[148:149], v[148:149], v[116:117]
v_pk_mul_f32 v[116:117], v[116:117], v[28:29] op_sel:[0,1] op_sel_hi:[1,1]
v_pk_mul_f32 v[150:151], v[150:151], v[118:119]
v_pk_mul_f32 v[118:119], v[118:119], v[28:29] op_sel:[0,1] op_sel_hi:[1,1]
v_pk_fma_f32 v[96:97], v[96:97], v[20:21], v[20:21] op_sel:[0,1,1] op_sel_hi:[1,1,1]
v_pk_fma_f32 v[98:99], v[98:99], v[20:21], v[20:21] op_sel:[0,1,1] op_sel_hi:[1,1,1]
v_pk_fma_f32 v[112:113], v[112:113], v[20:21], v[20:21] op_sel:[0,1,1] op_sel_hi:[1,1,1]
v_pk_fma_f32 v[114:115], v[114:115], v[20:21], v[20:21] op_sel:[0,1,1] op_sel_hi:[1,1,1]
v_cvt_pk_bf16_f32 v44, v76, v77
v_cvt_pk_bf16_f32 v45, v78, v79
v_cvt_pk_bf16_f32 v46, v92, v93
v_cvt_pk_bf16_f32 v47, v94, v95
v_mfma_f32_16x16x32_bf16 v[104:107], a[112:115], a[152:155], v[104:107]
buffer_store_dwordx4 v[44:47], v11, s[16:19], s62 offen offset:1024 sc1
v_mfma_f32_16x16x32_bf16 v[120:123], a[116:119], a[152:155], v[120:123]
v_rcp_f32 v96, v96
v_mfma_f32_16x16x32_bf16 v[136:139], a[120:123], a[152:155], v[136:139]
v_rcp_f32 v97, v97
v_mfma_f32_16x16x32_bf16 v[152:155], a[124:127], a[152:155], v[152:155]
v_rcp_f32 v98, v98
v_mfma_f32_16x16x32_bf16 v[104:107], a[192:195], a[168:171], v[104:107]
buffer_load_dwordx4 v18, s[28:31], s58 offen lds
v_mfma_f32_16x16x32_bf16 v[120:123], a[196:199], a[168:171], v[120:123]
v_rcp_f32 v99, v99
v_mfma_f32_16x16x32_bf16 v[136:139], a[200:203], a[168:171], v[136:139]
v_rcp_f32 v112, v112
v_mfma_f32_16x16x32_bf16 v[152:155], a[204:207], a[168:171], v[152:155]
v_rcp_f32 v113, v113
v_mfma_f32_16x16x32_bf16 v[104:107], a[208:211], a[184:187], v[104:107]
buffer_load_dwordx4 v19, s[28:31], s58 offen offset:1024 lds
v_mfma_f32_16x16x32_bf16 v[120:123], a[212:215], a[184:187], v[120:123]
s_add_u32 m0, s59, 99840
s_mov_b32 s58, 1572864
v_rcp_f32 v114, v114
v_mfma_f32_16x16x32_bf16 v[136:139], a[216:219], a[184:187], v[136:139]
v_rcp_f32 v115, v115
v_mfma_f32_16x16x32_bf16 v[152:155], a[220:223], a[184:187], v[152:155]
v_exp_f32 v100, v100
v_exp_f32 v101, v101
v_exp_f32 v102, v102
v_exp_f32 v103, v103
v_exp_f32 v116, v116
v_exp_f32 v117, v117
v_exp_f32 v118, v118
v_exp_f32 v119, v119
v_pk_mul_f32 v[128:129], v[128:129], v[96:97]
v_pk_mul_f32 v[130:131], v[130:131], v[98:99]
v_pk_mul_f32 v[144:145], v[144:145], v[112:113]
v_pk_mul_f32 v[146:147], v[146:147], v[114:115]
ds_read_b128 v[112:115], v9 offset:256
v_pk_fma_f32 v[104:105], v[48:49], v[24:25], v[104:105] op_sel_hi:[1,0,1]
v_pk_fma_f32 v[106:107], v[50:51], v[24:25], v[106:107] op_sel_hi:[1,0,1]
v_pk_fma_f32 v[120:121], v[64:65], v[24:25], v[120:121] op_sel_hi:[1,0,1]
v_pk_fma_f32 v[122:123], v[66:67], v[24:25], v[122:123] op_sel_hi:[1,0,1]
v_pk_fma_f32 v[136:137], v[80:81], v[24:25], v[136:137] op_sel_hi:[1,0,1]
v_pk_fma_f32 v[138:139], v[82:83], v[24:25], v[138:139] op_sel_hi:[1,0,1]
v_pk_fma_f32 v[152:153], v[4:5], v[24:25], v[152:153] op_sel_hi:[1,0,1]
v_pk_fma_f32 v[154:155], v[6:7], v[24:25], v[154:155] op_sel_hi:[1,0,1]
v_pk_mul_f32 v[136:137], v[136:137], v[104:105]
v_pk_mul_f32 v[104:105], v[104:105], v[30:31] op_sel_hi:[1,0]
v_pk_mul_f32 v[138:139], v[138:139], v[106:107]
v_pk_mul_f32 v[106:107], v[106:107], v[30:31] op_sel_hi:[1,0]
v_pk_mul_f32 v[152:153], v[152:153], v[120:121]
v_pk_mul_f32 v[120:121], v[120:121], v[30:31] op_sel_hi:[1,0]
v_pk_mul_f32 v[154:155], v[154:155], v[122:123]
v_pk_mul_f32 v[122:123], v[122:123], v[30:31] op_sel_hi:[1,0]
v_pk_fma_f32 v[100:101], v[100:101], v[22:23], v[22:23] op_sel:[0,1,1] op_sel_hi:[1,1,1]
v_pk_fma_f32 v[102:103], v[102:103], v[22:23], v[22:23] op_sel:[0,1,1] op_sel_hi:[1,1,1]
v_pk_fma_f32 v[116:117], v[116:117], v[22:23], v[22:23] op_sel:[0,1,1] op_sel_hi:[1,1,1]
v_pk_fma_f32 v[118:119], v[118:119], v[22:23], v[22:23] op_sel:[0,1,1] op_sel_hi:[1,1,1]
v_cvt_pk_bf16_f32 v96, v128, v129
v_cvt_pk_bf16_f32 v97, v130, v131
ds_read_b128 v[128:131], v9 offset:320
v_cvt_pk_bf16_f32 v98, v144, v145
v_cvt_pk_bf16_f32 v99, v146, v147
v_mfma_f32_16x16x32_bf16 v[108:111], a[112:115], a[156:159], v[108:111]
buffer_store_dwordx4 v[96:99], v10, s[16:19], s63 offen sc1
v_mfma_f32_16x16x32_bf16 v[124:127], a[116:119], a[156:159], v[124:127]
ds_read_b128 v[144:147], v9 offset:768
v_rcp_f32 v100, v100
v_mfma_f32_16x16x32_bf16 v[140:143], a[120:123], a[156:159], v[140:143]
v_rcp_f32 v101, v101
v_mfma_f32_16x16x32_bf16 v[156:159], a[124:127], a[156:159], v[156:159]
v_rcp_f32 v102, v102
v_mfma_f32_16x16x32_bf16 v[108:111], a[192:195], a[172:175], v[108:111]
buffer_load_dwordx4 v18, s[28:31], s58 offen lds
v_mfma_f32_16x16x32_bf16 v[124:127], a[196:199], a[172:175], v[124:127]
v_rcp_f32 v103, v103
v_mfma_f32_16x16x32_bf16 v[140:143], a[200:203], a[172:175], v[140:143]
v_rcp_f32 v116, v116
v_mfma_f32_16x16x32_bf16 v[156:159], a[204:207], a[172:175], v[156:159]
v_rcp_f32 v117, v117
v_mfma_f32_16x16x32_bf16 v[108:111], a[208:211], a[188:191], v[108:111]
buffer_load_dwordx4 v19, s[28:31], s58 offen offset:1024 lds
v_mfma_f32_16x16x32_bf16 v[124:127], a[212:215], a[188:191], v[124:127]
s_add_u32 m0, s59, 108160
s_mov_b32 s58, 1703936
v_rcp_f32 v118, v118
v_mfma_f32_16x16x32_bf16 v[140:143], a[216:219], a[188:191], v[140:143]
v_rcp_f32 v119, v119
v_mfma_f32_16x16x32_bf16 v[156:159], a[220:223], a[188:191], v[156:159]
v_exp_f32 v104, v104
v_exp_f32 v105, v105
v_exp_f32 v106, v106
v_exp_f32 v107, v107
v_exp_f32 v120, v120
v_exp_f32 v121, v121
v_exp_f32 v122, v122
v_exp_f32 v123, v123
v_pk_mul_f32 v[132:133], v[132:133], v[100:101]
v_pk_mul_f32 v[134:135], v[134:135], v[102:103]
v_pk_mul_f32 v[148:149], v[148:149], v[116:117]
v_pk_mul_f32 v[150:151], v[150:151], v[118:119]
v_pk_fma_f32 v[108:109], v[48:49], v[26:27], v[108:109] op_sel_hi:[1,0,1]
v_pk_fma_f32 v[110:111], v[50:51], v[26:27], v[110:111] op_sel_hi:[1,0,1]
v_pk_fma_f32 v[124:125], v[64:65], v[26:27], v[124:125] op_sel_hi:[1,0,1]
v_pk_fma_f32 v[126:127], v[66:67], v[26:27], v[126:127] op_sel_hi:[1,0,1]
v_pk_fma_f32 v[140:141], v[80:81], v[26:27], v[140:141] op_sel_hi:[1,0,1]
v_pk_fma_f32 v[142:143], v[82:83], v[26:27], v[142:143] op_sel_hi:[1,0,1]
v_pk_fma_f32 v[156:157], v[4:5], v[26:27], v[156:157] op_sel_hi:[1,0,1]
v_pk_fma_f32 v[158:159], v[6:7], v[26:27], v[158:159] op_sel_hi:[1,0,1]
ds_read_b128 v[4:7], v8 offset:576
v_pk_mul_f32 v[140:141], v[140:141], v[108:109]
v_pk_mul_f32 v[108:109], v[108:109], v[30:31] op_sel:[0,1] op_sel_hi:[1,1]
v_pk_mul_f32 v[142:143], v[142:143], v[110:111]
v_pk_mul_f32 v[110:111], v[110:111], v[30:31] op_sel:[0,1] op_sel_hi:[1,1]
v_pk_mul_f32 v[156:157], v[156:157], v[124:125]
v_pk_mul_f32 v[124:125], v[124:125], v[30:31] op_sel:[0,1] op_sel_hi:[1,1]
v_pk_mul_f32 v[158:159], v[158:159], v[126:127]
v_pk_mul_f32 v[126:127], v[126:127], v[30:31] op_sel:[0,1] op_sel_hi:[1,1]
v_pk_fma_f32 v[104:105], v[104:105], v[24:25], v[24:25] op_sel:[0,1,1] op_sel_hi:[1,1,1]
v_pk_fma_f32 v[106:107], v[106:107], v[24:25], v[24:25] op_sel:[0,1,1] op_sel_hi:[1,1,1]
v_pk_fma_f32 v[120:121], v[120:121], v[24:25], v[24:25] op_sel:[0,1,1] op_sel_hi:[1,1,1]
v_pk_fma_f32 v[122:123], v[122:123], v[24:25], v[24:25] op_sel:[0,1,1] op_sel_hi:[1,1,1]
v_cvt_pk_bf16_f32 v100, v132, v133
v_cvt_pk_bf16_f32 v101, v134, v135
v_cvt_pk_bf16_f32 v102, v148, v149
v_cvt_pk_bf16_f32 v103, v150, v151
v_mfma_f32_16x16x32_bf16 v[160:163], a[0:3], a[144:147], v[160:163]
buffer_store_dwordx4 v[100:103], v10, s[16:19], s63 offen offset:1024 sc1
v_mfma_f32_16x16x32_bf16 v[176:179], a[4:7], a[144:147], v[176:179]
v_rcp_f32 v104, v104
v_mfma_f32_16x16x32_bf16 v[192:195], a[8:11], a[144:147], v[192:195]
v_rcp_f32 v105, v105
v_mfma_f32_16x16x32_bf16 v[208:211], a[12:15], a[144:147], v[208:211]
v_rcp_f32 v106, v106
v_mfma_f32_16x16x32_bf16 v[160:163], a[16:19], a[160:163], v[160:163]
buffer_load_dwordx4 v18, s[28:31], s58 offen lds
v_mfma_f32_16x16x32_bf16 v[176:179], a[20:23], a[160:163], v[176:179]
v_rcp_f32 v107, v107
v_mfma_f32_16x16x32_bf16 v[192:195], a[24:27], a[160:163], v[192:195]
v_rcp_f32 v120, v120
v_mfma_f32_16x16x32_bf16 v[208:211], a[28:31], a[160:163], v[208:211]
v_rcp_f32 v121, v121
v_mfma_f32_16x16x32_bf16 v[160:163], a[32:35], a[176:179], v[160:163]
buffer_load_dwordx4 v19, s[28:31], s58 offen offset:1024 lds
v_mfma_f32_16x16x32_bf16 v[176:179], a[36:39], a[176:179], v[176:179]
s_add_u32 m0, s59, 116480
s_mov_b32 s58, 1835008
v_rcp_f32 v122, v122
v_mfma_f32_16x16x32_bf16 v[192:195], a[40:43], a[176:179], v[192:195]
v_rcp_f32 v123, v123
v_mfma_f32_16x16x32_bf16 v[208:211], a[44:47], a[176:179], v[208:211]
v_exp_f32 v108, v108
v_exp_f32 v109, v109
v_exp_f32 v110, v110
v_exp_f32 v111, v111
v_exp_f32 v124, v124
v_exp_f32 v125, v125
v_exp_f32 v126, v126
v_exp_f32 v127, v127
v_pk_mul_f32 v[136:137], v[136:137], v[104:105]
v_pk_mul_f32 v[138:139], v[138:139], v[106:107]
v_pk_mul_f32 v[152:153], v[152:153], v[120:121]
v_pk_mul_f32 v[154:155], v[154:155], v[122:123]
s_waitcnt lgkmcnt(3)
v_pk_fma_f32 v[160:161], v[112:113], v[20:21], v[160:161] op_sel_hi:[1,0,1]
v_pk_fma_f32 v[162:163], v[114:115], v[20:21], v[162:163] op_sel_hi:[1,0,1]
s_waitcnt lgkmcnt(2)
v_pk_fma_f32 v[176:177], v[128:129], v[20:21], v[176:177] op_sel_hi:[1,0,1]
v_pk_fma_f32 v[178:179], v[130:131], v[20:21], v[178:179] op_sel_hi:[1,0,1]
s_waitcnt lgkmcnt(1)
v_pk_fma_f32 v[192:193], v[144:145], v[20:21], v[192:193] op_sel_hi:[1,0,1]
v_pk_fma_f32 v[194:195], v[146:147], v[20:21], v[194:195] op_sel_hi:[1,0,1]
v_pk_fma_f32 v[208:209], v[12:13], v[20:21], v[208:209] op_sel_hi:[1,0,1]
v_pk_fma_f32 v[210:211], v[14:15], v[20:21], v[210:211] op_sel_hi:[1,0,1]
v_pk_mul_f32 v[192:193], v[192:193], v[160:161]
v_pk_mul_f32 v[160:161], v[160:161], v[28:29] op_sel_hi:[1,0]
v_pk_mul_f32 v[194:195], v[194:195], v[162:163]
v_pk_mul_f32 v[162:163], v[162:163], v[28:29] op_sel_hi:[1,0]
v_pk_mul_f32 v[208:209], v[208:209], v[176:177]
v_pk_mul_f32 v[176:177], v[176:177], v[28:29] op_sel_hi:[1,0]
v_pk_mul_f32 v[210:211], v[210:211], v[178:179]
v_pk_mul_f32 v[178:179], v[178:179], v[28:29] op_sel_hi:[1,0]
v_pk_fma_f32 v[108:109], v[108:109], v[26:27], v[26:27] op_sel:[0,1,1] op_sel_hi:[1,1,1]
v_pk_fma_f32 v[110:111], v[110:111], v[26:27], v[26:27] op_sel:[0,1,1] op_sel_hi:[1,1,1]
v_pk_fma_f32 v[124:125], v[124:125], v[26:27], v[26:27] op_sel:[0,1,1] op_sel_hi:[1,1,1]
v_pk_fma_f32 v[126:127], v[126:127], v[26:27], v[26:27] op_sel:[0,1,1] op_sel_hi:[1,1,1]
v_cvt_pk_bf16_f32 v104, v136, v137
v_cvt_pk_bf16_f32 v105, v138, v139
v_cvt_pk_bf16_f32 v106, v152, v153
v_cvt_pk_bf16_f32 v107, v154, v155
v_mfma_f32_16x16x32_bf16 v[164:167], a[0:3], a[148:151], v[164:167]
buffer_store_dwordx4 v[104:107], v11, s[16:19], s63 offen sc1
v_mfma_f32_16x16x32_bf16 v[180:183], a[4:7], a[148:151], v[180:183]
v_rcp_f32 v108, v108
v_mfma_f32_16x16x32_bf16 v[196:199], a[8:11], a[148:151], v[196:199]
v_rcp_f32 v109, v109
v_mfma_f32_16x16x32_bf16 v[212:215], a[12:15], a[148:151], v[212:215]
v_rcp_f32 v110, v110
v_mfma_f32_16x16x32_bf16 v[164:167], a[16:19], a[164:167], v[164:167]
buffer_load_dwordx4 v18, s[28:31], s58 offen lds
v_mfma_f32_16x16x32_bf16 v[180:183], a[20:23], a[164:167], v[180:183]
v_rcp_f32 v111, v111
v_mfma_f32_16x16x32_bf16 v[196:199], a[24:27], a[164:167], v[196:199]
v_rcp_f32 v124, v124
v_mfma_f32_16x16x32_bf16 v[212:215], a[28:31], a[164:167], v[212:215]
v_rcp_f32 v125, v125
v_mfma_f32_16x16x32_bf16 v[164:167], a[32:35], a[180:183], v[164:167]
buffer_load_dwordx4 v19, s[28:31], s58 offen offset:1024 lds
v_mfma_f32_16x16x32_bf16 v[180:183], a[36:39], a[180:183], v[180:183]
s_add_u32 m0, s59, 124800
s_mov_b32 s58, 1966080
v_rcp_f32 v126, v126
v_mfma_f32_16x16x32_bf16 v[196:199], a[40:43], a[180:183], v[196:199]
v_rcp_f32 v127, v127
v_mfma_f32_16x16x32_bf16 v[212:215], a[44:47], a[180:183], v[212:215]
v_exp_f32 v160, v160
v_exp_f32 v161, v161
v_exp_f32 v162, v162
v_exp_f32 v163, v163
v_exp_f32 v176, v176
v_exp_f32 v177, v177
v_exp_f32 v178, v178
v_exp_f32 v179, v179
v_pk_mul_f32 v[140:141], v[140:141], v[108:109]
v_pk_mul_f32 v[142:143], v[142:143], v[110:111]
v_pk_mul_f32 v[156:157], v[156:157], v[124:125]
v_pk_mul_f32 v[158:159], v[158:159], v[126:127]
v_pk_fma_f32 v[164:165], v[112:113], v[22:23], v[164:165] op_sel_hi:[1,0,1]
v_pk_fma_f32 v[166:167], v[114:115], v[22:23], v[166:167] op_sel_hi:[1,0,1]
v_pk_fma_f32 v[180:181], v[128:129], v[22:23], v[180:181] op_sel_hi:[1,0,1]
v_pk_fma_f32 v[182:183], v[130:131], v[22:23], v[182:183] op_sel_hi:[1,0,1]
v_pk_fma_f32 v[196:197], v[144:145], v[22:23], v[196:197] op_sel_hi:[1,0,1]
v_pk_fma_f32 v[198:199], v[146:147], v[22:23], v[198:199] op_sel_hi:[1,0,1]
v_pk_fma_f32 v[212:213], v[12:13], v[22:23], v[212:213] op_sel_hi:[1,0,1]
v_pk_fma_f32 v[214:215], v[14:15], v[22:23], v[214:215] op_sel_hi:[1,0,1]
v_pk_mul_f32 v[196:197], v[196:197], v[164:165]
v_pk_mul_f32 v[164:165], v[164:165], v[28:29] op_sel:[0,1] op_sel_hi:[1,1]
v_pk_mul_f32 v[198:199], v[198:199], v[166:167]
v_pk_mul_f32 v[166:167], v[166:167], v[28:29] op_sel:[0,1] op_sel_hi:[1,1]
v_pk_mul_f32 v[212:213], v[212:213], v[180:181]
v_pk_mul_f32 v[180:181], v[180:181], v[28:29] op_sel:[0,1] op_sel_hi:[1,1]
v_pk_mul_f32 v[214:215], v[214:215], v[182:183]
v_pk_mul_f32 v[182:183], v[182:183], v[28:29] op_sel:[0,1] op_sel_hi:[1,1]
v_pk_fma_f32 v[160:161], v[160:161], v[20:21], v[20:21] op_sel:[0,1,1] op_sel_hi:[1,1,1]
v_pk_fma_f32 v[162:163], v[162:163], v[20:21], v[20:21] op_sel:[0,1,1] op_sel_hi:[1,1,1]
v_pk_fma_f32 v[176:177], v[176:177], v[20:21], v[20:21] op_sel:[0,1,1] op_sel_hi:[1,1,1]
v_pk_fma_f32 v[178:179], v[178:179], v[20:21], v[20:21] op_sel:[0,1,1] op_sel_hi:[1,1,1]
v_cvt_pk_bf16_f32 v108, v140, v141
v_cvt_pk_bf16_f32 v109, v142, v143
v_cvt_pk_bf16_f32 v110, v156, v157
v_cvt_pk_bf16_f32 v111, v158, v159
v_mfma_f32_16x16x32_bf16 v[168:171], a[0:3], a[152:155], v[168:171]
buffer_store_dwordx4 v[108:111], v11, s[16:19], s63 offen offset:1024 sc1
v_mfma_f32_16x16x32_bf16 v[184:187], a[4:7], a[152:155], v[184:187]
v_rcp_f32 v160, v160
v_mfma_f32_16x16x32_bf16 v[200:203], a[8:11], a[152:155], v[200:203]
v_rcp_f32 v161, v161
v_mfma_f32_16x16x32_bf16 v[216:219], a[12:15], a[152:155], v[216:219]
v_rcp_f32 v162, v162
v_mfma_f32_16x16x32_bf16 v[168:171], a[16:19], a[168:171], v[168:171]
buffer_load_dwordx4 v18, s[28:31], s58 offen lds
v_mfma_f32_16x16x32_bf16 v[184:187], a[20:23], a[168:171], v[184:187]
v_rcp_f32 v163, v163
v_mfma_f32_16x16x32_bf16 v[200:203], a[24:27], a[168:171], v[200:203]
v_rcp_f32 v176, v176
v_mfma_f32_16x16x32_bf16 v[216:219], a[28:31], a[168:171], v[216:219]
v_rcp_f32 v177, v177
v_mfma_f32_16x16x32_bf16 v[168:171], a[32:35], a[184:187], v[168:171]
buffer_load_dwordx4 v19, s[28:31], s58 offen offset:1024 lds
v_mfma_f32_16x16x32_bf16 v[184:187], a[36:39], a[184:187], v[184:187]
v_rcp_f32 v178, v178
v_mfma_f32_16x16x32_bf16 v[200:203], a[40:43], a[184:187], v[200:203]
v_rcp_f32 v179, v179
v_mfma_f32_16x16x32_bf16 v[216:219], a[44:47], a[184:187], v[216:219]
v_exp_f32 v164, v164
v_exp_f32 v165, v165
v_exp_f32 v166, v166
v_exp_f32 v167, v167
v_exp_f32 v180, v180
v_exp_f32 v181, v181
v_exp_f32 v182, v182
v_exp_f32 v183, v183
v_pk_mul_f32 v[192:193], v[192:193], v[160:161]
v_pk_mul_f32 v[194:195], v[194:195], v[162:163]
v_pk_mul_f32 v[208:209], v[208:209], v[176:177]
v_pk_mul_f32 v[210:211], v[210:211], v[178:179]
ds_read_b128 v[176:179], v8
v_pk_fma_f32 v[168:169], v[112:113], v[24:25], v[168:169] op_sel_hi:[1,0,1]
v_pk_fma_f32 v[170:171], v[114:115], v[24:25], v[170:171] op_sel_hi:[1,0,1]
v_pk_fma_f32 v[184:185], v[128:129], v[24:25], v[184:185] op_sel_hi:[1,0,1]
v_pk_fma_f32 v[186:187], v[130:131], v[24:25], v[186:187] op_sel_hi:[1,0,1]
v_pk_fma_f32 v[200:201], v[144:145], v[24:25], v[200:201] op_sel_hi:[1,0,1]
v_pk_fma_f32 v[202:203], v[146:147], v[24:25], v[202:203] op_sel_hi:[1,0,1]
v_pk_fma_f32 v[216:217], v[12:13], v[24:25], v[216:217] op_sel_hi:[1,0,1]
v_pk_fma_f32 v[218:219], v[14:15], v[24:25], v[218:219] op_sel_hi:[1,0,1]
v_pk_mul_f32 v[200:201], v[200:201], v[168:169]
v_pk_mul_f32 v[168:169], v[168:169], v[30:31] op_sel_hi:[1,0]
v_pk_mul_f32 v[202:203], v[202:203], v[170:171]
v_pk_mul_f32 v[170:171], v[170:171], v[30:31] op_sel_hi:[1,0]
v_pk_mul_f32 v[216:217], v[216:217], v[184:185]
v_pk_mul_f32 v[184:185], v[184:185], v[30:31] op_sel_hi:[1,0]
v_pk_mul_f32 v[218:219], v[218:219], v[186:187]
v_pk_mul_f32 v[186:187], v[186:187], v[30:31] op_sel_hi:[1,0]
v_pk_fma_f32 v[164:165], v[164:165], v[22:23], v[22:23] op_sel:[0,1,1] op_sel_hi:[1,1,1]
v_pk_fma_f32 v[166:167], v[166:167], v[22:23], v[22:23] op_sel:[0,1,1] op_sel_hi:[1,1,1]
v_pk_fma_f32 v[180:181], v[180:181], v[22:23], v[22:23] op_sel:[0,1,1] op_sel_hi:[1,1,1]
v_pk_fma_f32 v[182:183], v[182:183], v[22:23], v[22:23] op_sel:[0,1,1] op_sel_hi:[1,1,1]
v_cvt_pk_bf16_f32 v160, v192, v193
v_cvt_pk_bf16_f32 v161, v194, v195
ds_read_b128 v[192:195], v8 offset:64
v_cvt_pk_bf16_f32 v162, v208, v209
v_cvt_pk_bf16_f32 v163, v210, v211
v_mfma_f32_16x16x32_bf16 v[172:175], a[0:3], a[156:159], v[172:175]
buffer_store_dwordx4 v[160:163], v10, s[16:19], s64 offen sc1
v_mfma_f32_16x16x32_bf16 v[188:191], a[4:7], a[156:159], v[188:191]
ds_read_b128 v[208:211], v8 offset:512
v_rcp_f32 v164, v164
v_mfma_f32_16x16x32_bf16 v[204:207], a[8:11], a[156:159], v[204:207]
v_rcp_f32 v165, v165
v_mfma_f32_16x16x32_bf16 v[220:223], a[12:15], a[156:159], v[220:223]
v_rcp_f32 v166, v166
v_mfma_f32_16x16x32_bf16 v[172:175], a[16:19], a[172:175], v[172:175]
v_rcp_f32 v167, v167
v_mfma_f32_16x16x32_bf16 v[188:191], a[20:23], a[172:175], v[188:191]
v_rcp_f32 v180, v180
v_mfma_f32_16x16x32_bf16 v[204:207], a[24:27], a[172:175], v[204:207]
v_rcp_f32 v181, v181
v_mfma_f32_16x16x32_bf16 v[220:223], a[28:31], a[172:175], v[220:223]
v_rcp_f32 v182, v182
v_mfma_f32_16x16x32_bf16 v[172:175], a[32:35], a[188:191], v[172:175]
v_rcp_f32 v183, v183
v_mfma_f32_16x16x32_bf16 v[188:191], a[36:39], a[188:191], v[188:191]
v_exp_f32 v168, v168
v_mfma_f32_16x16x32_bf16 v[204:207], a[40:43], a[188:191], v[204:207]
v_exp_f32 v169, v169
v_mfma_f32_16x16x32_bf16 v[220:223], a[44:47], a[188:191], v[220:223]
v_exp_f32 v170, v170
v_exp_f32 v171, v171
v_exp_f32 v184, v184
v_exp_f32 v185, v185
v_exp_f32 v186, v186
v_exp_f32 v187, v187
v_pk_mul_f32 v[196:197], v[196:197], v[164:165]
v_pk_mul_f32 v[198:199], v[198:199], v[166:167]
v_pk_mul_f32 v[212:213], v[212:213], v[180:181]
v_pk_mul_f32 v[214:215], v[214:215], v[182:183]
v_pk_fma_f32 v[172:173], v[112:113], v[26:27], v[172:173] op_sel_hi:[1,0,1]
v_pk_fma_f32 v[174:175], v[114:115], v[26:27], v[174:175] op_sel_hi:[1,0,1]
v_pk_fma_f32 v[188:189], v[128:129], v[26:27], v[188:189] op_sel_hi:[1,0,1]
v_pk_fma_f32 v[190:191], v[130:131], v[26:27], v[190:191] op_sel_hi:[1,0,1]
v_pk_fma_f32 v[204:205], v[144:145], v[26:27], v[204:205] op_sel_hi:[1,0,1]
v_pk_fma_f32 v[206:207], v[146:147], v[26:27], v[206:207] op_sel_hi:[1,0,1]
v_pk_fma_f32 v[220:221], v[12:13], v[26:27], v[220:221] op_sel_hi:[1,0,1]
v_pk_fma_f32 v[222:223], v[14:15], v[26:27], v[222:223] op_sel_hi:[1,0,1]
v_pk_mul_f32 v[204:205], v[204:205], v[172:173]
v_pk_mul_f32 v[172:173], v[172:173], v[30:31] op_sel:[0,1] op_sel_hi:[1,1]
v_pk_mul_f32 v[206:207], v[206:207], v[174:175]
v_pk_mul_f32 v[174:175], v[174:175], v[30:31] op_sel:[0,1] op_sel_hi:[1,1]
v_pk_mul_f32 v[220:221], v[220:221], v[188:189]
v_pk_mul_f32 v[188:189], v[188:189], v[30:31] op_sel:[0,1] op_sel_hi:[1,1]
v_pk_mul_f32 v[222:223], v[222:223], v[190:191]
v_pk_mul_f32 v[190:191], v[190:191], v[30:31] op_sel:[0,1] op_sel_hi:[1,1]
v_pk_fma_f32 v[168:169], v[168:169], v[24:25], v[24:25] op_sel:[0,1,1] op_sel_hi:[1,1,1]
v_pk_fma_f32 v[170:171], v[170:171], v[24:25], v[24:25] op_sel:[0,1,1] op_sel_hi:[1,1,1]
v_pk_fma_f32 v[184:185], v[184:185], v[24:25], v[24:25] op_sel:[0,1,1] op_sel_hi:[1,1,1]
v_pk_fma_f32 v[186:187], v[186:187], v[24:25], v[24:25] op_sel:[0,1,1] op_sel_hi:[1,1,1]
v_cvt_pk_bf16_f32 v164, v196, v197
v_cvt_pk_bf16_f32 v165, v198, v199
v_cvt_pk_bf16_f32 v166, v212, v213
v_cvt_pk_bf16_f32 v167, v214, v215
v_mfma_f32_16x16x32_bf16 v[224:227], a[48:51], a[144:147], v[224:227]
buffer_store_dwordx4 v[164:167], v10, s[16:19], s64 offen offset:1024 sc1
v_mfma_f32_16x16x32_bf16 v[232:235], a[52:55], a[144:147], v[232:235]
v_rcp_f32 v168, v168
v_mfma_f32_16x16x32_bf16 v[240:243], a[56:59], a[144:147], v[240:243]
v_rcp_f32 v169, v169
v_mfma_f32_16x16x32_bf16 v[248:251], a[60:63], a[144:147], v[248:251]
v_rcp_f32 v170, v170
v_mfma_f32_16x16x32_bf16 v[224:227], a[64:67], a[160:163], v[224:227]
v_rcp_f32 v171, v171
v_mfma_f32_16x16x32_bf16 v[232:235], a[68:71], a[160:163], v[232:235]
v_rcp_f32 v184, v184
v_mfma_f32_16x16x32_bf16 v[240:243], a[72:75], a[160:163], v[240:243]
v_rcp_f32 v185, v185
v_mfma_f32_16x16x32_bf16 v[248:251], a[76:79], a[160:163], v[248:251]
v_rcp_f32 v186, v186
v_mfma_f32_16x16x32_bf16 v[224:227], a[80:83], a[176:179], v[224:227]
v_rcp_f32 v187, v187
v_mfma_f32_16x16x32_bf16 v[232:235], a[84:87], a[176:179], v[232:235]
v_exp_f32 v172, v172
v_mfma_f32_16x16x32_bf16 v[240:243], a[88:91], a[176:179], v[240:243]
v_exp_f32 v173, v173
v_mfma_f32_16x16x32_bf16 v[248:251], a[92:95], a[176:179], v[248:251]
v_exp_f32 v174, v174
v_exp_f32 v175, v175
v_exp_f32 v188, v188
v_exp_f32 v189, v189
v_exp_f32 v190, v190
v_exp_f32 v191, v191
v_pk_mul_f32 v[200:201], v[200:201], v[168:169]
v_pk_mul_f32 v[202:203], v[202:203], v[170:171]
v_pk_mul_f32 v[216:217], v[216:217], v[184:185]
v_pk_mul_f32 v[218:219], v[218:219], v[186:187]
s_waitcnt lgkmcnt(2)
v_pk_fma_f32 v[224:225], v[176:177], v[20:21], v[224:225] op_sel_hi:[1,0,1]
v_pk_fma_f32 v[226:227], v[178:179], v[20:21], v[226:227] op_sel_hi:[1,0,1]
s_waitcnt lgkmcnt(1)
v_pk_fma_f32 v[232:233], v[192:193], v[20:21], v[232:233] op_sel_hi:[1,0,1]
v_pk_fma_f32 v[234:235], v[194:195], v[20:21], v[234:235] op_sel_hi:[1,0,1]
s_waitcnt lgkmcnt(0)
v_pk_fma_f32 v[240:241], v[208:209], v[20:21], v[240:241] op_sel_hi:[1,0,1]
v_pk_fma_f32 v[242:243], v[210:211], v[20:21], v[242:243] op_sel_hi:[1,0,1]
v_pk_fma_f32 v[248:249], v[4:5], v[20:21], v[248:249] op_sel_hi:[1,0,1]
v_pk_fma_f32 v[250:251], v[6:7], v[20:21], v[250:251] op_sel_hi:[1,0,1]
v_pk_mul_f32 v[240:241], v[240:241], v[224:225]
v_pk_mul_f32 v[224:225], v[224:225], v[28:29] op_sel_hi:[1,0]
v_pk_mul_f32 v[242:243], v[242:243], v[226:227]
v_pk_mul_f32 v[226:227], v[226:227], v[28:29] op_sel_hi:[1,0]
v_pk_mul_f32 v[248:249], v[248:249], v[232:233]
v_pk_mul_f32 v[232:233], v[232:233], v[28:29] op_sel_hi:[1,0]
v_pk_mul_f32 v[250:251], v[250:251], v[234:235]
v_pk_mul_f32 v[234:235], v[234:235], v[28:29] op_sel_hi:[1,0]
v_pk_fma_f32 v[172:173], v[172:173], v[26:27], v[26:27] op_sel:[0,1,1] op_sel_hi:[1,1,1]
v_pk_fma_f32 v[174:175], v[174:175], v[26:27], v[26:27] op_sel:[0,1,1] op_sel_hi:[1,1,1]
v_pk_fma_f32 v[188:189], v[188:189], v[26:27], v[26:27] op_sel:[0,1,1] op_sel_hi:[1,1,1]
v_pk_fma_f32 v[190:191], v[190:191], v[26:27], v[26:27] op_sel:[0,1,1] op_sel_hi:[1,1,1]
v_cvt_pk_bf16_f32 v168, v200, v201
v_cvt_pk_bf16_f32 v169, v202, v203
v_cvt_pk_bf16_f32 v170, v216, v217
v_cvt_pk_bf16_f32 v171, v218, v219
v_mfma_f32_16x16x32_bf16 v[228:231], a[48:51], a[148:151], v[228:231]
buffer_store_dwordx4 v[168:171], v11, s[16:19], s64 offen sc1
v_mfma_f32_16x16x32_bf16 v[236:239], a[52:55], a[148:151], v[236:239]
v_rcp_f32 v172, v172
v_mfma_f32_16x16x32_bf16 v[244:247], a[56:59], a[148:151], v[244:247]
v_rcp_f32 v173, v173
v_mfma_f32_16x16x32_bf16 v[252:255], a[60:63], a[148:151], v[252:255]
v_rcp_f32 v174, v174
v_mfma_f32_16x16x32_bf16 v[228:231], a[64:67], a[164:167], v[228:231]
v_rcp_f32 v175, v175
v_mfma_f32_16x16x32_bf16 v[236:239], a[68:71], a[164:167], v[236:239]
v_rcp_f32 v188, v188
v_mfma_f32_16x16x32_bf16 v[244:247], a[72:75], a[164:167], v[244:247]
v_rcp_f32 v189, v189
v_mfma_f32_16x16x32_bf16 v[252:255], a[76:79], a[164:167], v[252:255]
v_rcp_f32 v190, v190
v_mfma_f32_16x16x32_bf16 v[228:231], a[80:83], a[180:183], v[228:231]
v_rcp_f32 v191, v191
v_mfma_f32_16x16x32_bf16 v[236:239], a[84:87], a[180:183], v[236:239]
v_exp_f32 v224, v224
v_mfma_f32_16x16x32_bf16 v[244:247], a[88:91], a[180:183], v[244:247]
v_exp_f32 v225, v225
v_mfma_f32_16x16x32_bf16 v[252:255], a[92:95], a[180:183], v[252:255]
v_exp_f32 v226, v226
v_exp_f32 v227, v227
v_exp_f32 v232, v232
v_exp_f32 v233, v233
v_exp_f32 v234, v234
v_exp_f32 v235, v235
v_pk_mul_f32 v[204:205], v[204:205], v[172:173]
v_pk_mul_f32 v[206:207], v[206:207], v[174:175]
v_pk_mul_f32 v[220:221], v[220:221], v[188:189]
v_pk_mul_f32 v[222:223], v[222:223], v[190:191]
v_pk_fma_f32 v[228:229], v[176:177], v[22:23], v[228:229] op_sel_hi:[1,0,1]
v_pk_fma_f32 v[230:231], v[178:179], v[22:23], v[230:231] op_sel_hi:[1,0,1]
v_pk_fma_f32 v[236:237], v[192:193], v[22:23], v[236:237] op_sel_hi:[1,0,1]
v_pk_fma_f32 v[238:239], v[194:195], v[22:23], v[238:239] op_sel_hi:[1,0,1]
v_pk_fma_f32 v[244:245], v[208:209], v[22:23], v[244:245] op_sel_hi:[1,0,1]
v_pk_fma_f32 v[246:247], v[210:211], v[22:23], v[246:247] op_sel_hi:[1,0,1]
v_pk_fma_f32 v[252:253], v[4:5], v[22:23], v[252:253] op_sel_hi:[1,0,1]
v_pk_fma_f32 v[254:255], v[6:7], v[22:23], v[254:255] op_sel_hi:[1,0,1]
v_pk_mul_f32 v[244:245], v[244:245], v[228:229]
v_pk_mul_f32 v[228:229], v[228:229], v[28:29] op_sel:[0,1] op_sel_hi:[1,1]
v_pk_mul_f32 v[246:247], v[246:247], v[230:231]
v_pk_mul_f32 v[230:231], v[230:231], v[28:29] op_sel:[0,1] op_sel_hi:[1,1]
v_pk_mul_f32 v[252:253], v[252:253], v[236:237]
v_pk_mul_f32 v[236:237], v[236:237], v[28:29] op_sel:[0,1] op_sel_hi:[1,1]
v_pk_mul_f32 v[254:255], v[254:255], v[238:239]
v_pk_mul_f32 v[238:239], v[238:239], v[28:29] op_sel:[0,1] op_sel_hi:[1,1]
v_pk_fma_f32 v[224:225], v[224:225], v[20:21], v[20:21] op_sel:[0,1,1] op_sel_hi:[1,1,1]
v_pk_fma_f32 v[226:227], v[226:227], v[20:21], v[20:21] op_sel:[0,1,1] op_sel_hi:[1,1,1]
v_pk_fma_f32 v[232:233], v[232:233], v[20:21], v[20:21] op_sel:[0,1,1] op_sel_hi:[1,1,1]
v_pk_fma_f32 v[234:235], v[234:235], v[20:21], v[20:21] op_sel:[0,1,1] op_sel_hi:[1,1,1]
v_cvt_pk_bf16_f32 v172, v204, v205
v_cvt_pk_bf16_f32 v173, v206, v207
v_cvt_pk_bf16_f32 v174, v220, v221
v_cvt_pk_bf16_f32 v175, v222, v223
buffer_store_dwordx4 v[172:175], v11, s[16:19], s64 offen offset:1024 sc1
v_rcp_f32 v224, v224
v_rcp_f32 v225, v225
v_rcp_f32 v226, v226
v_rcp_f32 v227, v227
v_rcp_f32 v232, v232
v_rcp_f32 v233, v233
v_rcp_f32 v234, v234
v_rcp_f32 v235, v235
v_exp_f32 v228, v228
v_exp_f32 v229, v229
v_exp_f32 v230, v230
v_exp_f32 v231, v231
v_exp_f32 v236, v236
v_exp_f32 v237, v237
v_exp_f32 v238, v238
v_exp_f32 v239, v239
v_pk_mul_f32 v[240:241], v[240:241], v[224:225]
v_pk_mul_f32 v[242:243], v[242:243], v[226:227]
v_pk_mul_f32 v[248:249], v[248:249], v[232:233]
v_pk_mul_f32 v[250:251], v[250:251], v[234:235]
v_pk_fma_f32 v[228:229], v[228:229], v[22:23], v[22:23] op_sel:[0,1,1] op_sel_hi:[1,1,1]
v_pk_fma_f32 v[230:231], v[230:231], v[22:23], v[22:23] op_sel:[0,1,1] op_sel_hi:[1,1,1]
v_pk_fma_f32 v[236:237], v[236:237], v[22:23], v[22:23] op_sel:[0,1,1] op_sel_hi:[1,1,1]
v_pk_fma_f32 v[238:239], v[238:239], v[22:23], v[22:23] op_sel:[0,1,1] op_sel_hi:[1,1,1]
v_cvt_pk_bf16_f32 v224, v240, v241
v_cvt_pk_bf16_f32 v225, v242, v243
v_cvt_pk_bf16_f32 v226, v248, v249
v_cvt_pk_bf16_f32 v227, v250, v251
buffer_store_dwordx4 v[224:227], v10, s[16:19], s65 offen sc1
v_rcp_f32 v228, v228
v_rcp_f32 v229, v229
v_rcp_f32 v230, v230
v_rcp_f32 v231, v231
v_rcp_f32 v236, v236
v_rcp_f32 v237, v237
v_rcp_f32 v238, v238
v_rcp_f32 v239, v239
v_pk_mul_f32 v[244:245], v[244:245], v[228:229]
v_pk_mul_f32 v[246:247], v[246:247], v[230:231]
v_pk_mul_f32 v[252:253], v[252:253], v[236:237]
v_pk_mul_f32 v[254:255], v[254:255], v[238:239]
v_cvt_pk_bf16_f32 v228, v244, v245
v_cvt_pk_bf16_f32 v229, v246, v247
v_cvt_pk_bf16_f32 v230, v252, v253
v_cvt_pk_bf16_f32 v231, v254, v255
buffer_store_dwordx4 v[228:231], v10, s[16:19], s65 offen offset:1024 sc1
s_nop 1
s_lshl_b32 s62, s5, 2
s_add_u32 s62, s62, s3
s_lshl_b32 s62, s62, 13
s_and_b32 s63, s7, 8
s_lshl_b32 s63, s63, 7
s_add_u32 s62, s62, s63
s_lshr_b32 s63, s28, 7
s_sub_u32 s63, 3, s63
s_and_b32 s63, s63, 7
s_lshl_b32 s63, s63, 7
s_add_u32 s62, s62, s63
v_lshrrev_b32 v9, 4, v1
v_lshl_add_u32 v9, v9, 11, s62
s_mov_b32 s44, 2097152
buffer_load_dword v27, v9, s[28:31], s44 offen
.Lpad30:
s_cbranch_execz .Lnopoll53r
s_add_u32 s44, s44, 0x100000
s_lshl_b32 s62, s6, 13
s_lshl_b32 s63, s3, 11
s_add_u32 s62, s62, s63
v_lshl_add_u32 v4, v1, 4, s62
v_lshrrev_b32 v2, 3, v1
v_cmp_eq_u32 vcc, 3, v2
v_add_u32 v2, 67108480, v4
s_nop 0
v_cndmask_b32 v4, v4, v2, vcc
v_bfe_u32 v5, v1, 3, 1
v_lshrrev_b32 v2, 4, v1
v_lshl_add_u32 v5, v2, 3, v5
s_lshl_b32 s62, s3, 1
v_add_u32 v5, s62, v5
v_mul_u32_u24 v5, 2048, v5
v_and_b32 v2, 7, v1
v_lshl_add_u32 v5, v2, 4, v5
s_lshl_b32 s62, s7, 7
v_add_u32 v5, s62, v5
v_add_u32 v6, 64512, v5
v_bfe_u32 v8, v1, 3, 2
v_mul_u32_u24 v8, 2080, v8
v_bfe_u32 v2, v1, 2, 1
v_lshl_add_u32 v8, v2, 7, v8
v_bfe_u32 v2, v1, 5, 1
v_lshl_add_u32 v8, v2, 8, v8
v_and_b32 v2, 3, v1
v_lshl_add_u32 v8, v2, 3, v8
s_mov_b32 s57, 0
v_add_u32 v7, s57, v8
s_mov_b32 s52, 46137344
s_mov_b32 s53, 46268416
s_mov_b32 s54, 2097152
s_mul_i32 s56, s3, 2080
v_accvgpr_read_b32 v32, a224
v_accvgpr_read_b32 v33, a225
v_accvgpr_read_b32 v34, a226
v_accvgpr_read_b32 v35, a227
v_accvgpr_read_b32 v36, a228
v_accvgpr_read_b32 v37, a229
v_accvgpr_read_b32 v38, a230
v_accvgpr_read_b32 v39, a231
v_accvgpr_read_b32 v40, a232
v_accvgpr_read_b32 v41, a233
v_accvgpr_read_b32 v42, a234
v_accvgpr_read_b32 v43, a235
v_accvgpr_read_b32 v44, a236
v_accvgpr_read_b32 v45, a237
v_accvgpr_read_b32 v46, a238
v_accvgpr_read_b32 v47, a239
v_accvgpr_read_b32 v48, a240
v_accvgpr_read_b32 v49, a241
v_accvgpr_read_b32 v50, a242
v_accvgpr_read_b32 v51, a243
v_accvgpr_read_b32 v52, a244
v_accvgpr_read_b32 v53, a245
v_accvgpr_read_b32 v54, a246
v_accvgpr_read_b32 v55, a247
v_accvgpr_read_b32 v56, a248
v_accvgpr_read_b32 v57, a249
v_accvgpr_read_b32 v58, a250
v_accvgpr_read_b32 v59, a251
v_accvgpr_read_b32 v60, a252
v_accvgpr_read_b32 v61, a253
v_accvgpr_read_b32 v62, a254
v_accvgpr_read_b32 v63, a255
s_lshr_b32 s62, s6, 1
s_lshl_b32 s62, s62, 8
s_and_b32 s63, s6, 1
s_add_u32 s62, s62, s63
s_lshl_b32 s63, s3, 6
s_add_u32 s62, s62, s63
s_lshl_b32 s62, s62, 11
s_lshl_b32 s63, s7, 7
s_add_u32 s62, s62, s63
v_and_b32 v160, 15, v1
v_lshlrev_b32 v160, 12, v160
v_bfe_u32 v2, v1, 4, 1
v_lshl_add_u32 v160, v2, 5, v160
v_bfe_u32 v2, v1, 5, 1
v_lshl_add_u32 v160, v2, 4, v160
v_add_u32 v160, s62, v160
v_add_u32 v161, 0x10000, v160
s_lshl_b32 s62, s10, 1
s_add_u32 s62, s62, s12
s_lshl_b32 s62, s62, 7
s_add_u32 s62, s62, 30423040
s_and_b32 s64, s6, 14
s_lshl_b32 s64, s64, 7
s_add_u32 s64, s64, 30423040
s_add_u32 s65, s64, 128
v_mov_b32 v252, s62
v_mov_b32 v253, s64
v_writelane_b32 v253, s65, 1
s_waitcnt vmcnt(0) lgkmcnt(0)
s_barrier
s_cmp_lg_u32 s3, 0
s_cbranch_scc1 .Lnosig55
v_mov_b32 v255, 1
s_mov_b64 exec, 1
buffer_atomic_add v255, v252, s[16:19], 0 offen
s_mov_b64 exec, -1
.Lnosig55:
ds_read_b64_tr_b16 a[0:1], v7
ds_read_b64_tr_b16 a[2:3], v7 offset:512
ds_read_b64_tr_b16 a[4:5], v7 offset:32
ds_read_b64_tr_b16 a[6:7], v7 offset:544
ds_read_b64_tr_b16 a[8:9], v7 offset:64
ds_read_b64_tr_b16 a[10:11], v7 offset:576
ds_read_b64_tr_b16 a[12:13], v7 offset:96
ds_read_b64_tr_b16 a[14:15], v7 offset:608
ds_read_b64_tr_b16 a[16:17], v7 offset:1024
ds_read_b64_tr_b16 a[18:19], v7 offset:1536
ds_read_b64_tr_b16 a[20:21], v7 offset:1056
ds_read_b64_tr_b16 a[22:23], v7 offset:1568
ds_read_b64_tr_b16 a[24:25], v7 offset:1088
ds_read_b64_tr_b16 a[26:27], v7 offset:1600
ds_read_b64_tr_b16 a[28:29], v7 offset:1120
ds_read_b64_tr_b16 a[30:31], v7 offset:1632
s_waitcnt lgkmcnt(0)
s_cmp_lg_u32 s3, 1
s_cbranch_scc1 .Lnopoll58
s_mov_b64 exec, 3
s_mov_b32 s15, 0
.Lpoll56:
buffer_load_dword v255, v253, s[16:19], 0 offen sc1
s_add_u32 s15, s15, 1
s_cmp_gt_u32 s15, 100000
s_cbranch_scc1 .Lgot57
s_waitcnt vmcnt(0)
v_cmp_ne_u32 vcc, 16, v255
s_nop 0
s_cbranch_vccnz .Lpoll56
.Lgot57:
s_waitcnt vmcnt(0)
s_branch .Lnopoll58r
.Lnopoll58:
s_mov_b64 exec, 0
s_cmp_eq_u32 s3, 2
s_cbranch_scc1 .Lpad31
s_cmp_eq_u32 s3, 3
s_cbranch_scc1 .Lpad32
s_branch .Lnopoll58r
.Lnopoll58r:
s_mov_b64 exec, -1
s_barrier
buffer_load_dwordx4 v[64:67], v4, s[16:19], s52 offen sc1
buffer_load_dwordx4 v[68:71], v4, s[16:19], s52 offen offset:1024 sc1
s_add_u32 s52, s52, 0x40000
buffer_load_dwordx4 v[72:75], v4, s[16:19], s53 offen sc1
buffer_load_dwordx4 v[76:79], v4, s[16:19], s53 offen offset:1024 sc1
s_add_u32 s53, s53, 0x40000
buffer_load_dwordx4 v[80:83], v4, s[16:19], s52 offen sc1
buffer_load_dwordx4 v[84:87], v4, s[16:19], s52 offen offset:1024 sc1
s_add_u32 s52, s52, 0x40000
buffer_load_dwordx4 v[88:91], v4, s[16:19], s53 offen sc1
buffer_load_dwordx4 v[92:95], v4, s[16:19], s53 offen offset:1024 sc1
s_add_u32 s53, s53, 0x40000
buffer_load_dwordx4 v[96:99], v4, s[16:19], s52 offen sc1
buffer_load_dwordx4 v[100:103], v4, s[16:19], s52 offen offset:1024 sc1
s_add_u32 s52, s52, 0x40000
buffer_load_dwordx4 v[104:107], v4, s[16:19], s53 offen sc1
buffer_load_dwordx4 v[108:111], v4, s[16:19], s53 offen offset:1024 sc1
s_add_u32 s53, s53, 0x40000
s_mov_b32 s15, -5
.p2align 6
.Lk59:
s_waitcnt lgkmcnt(0)
s_barrier
s_add_u32 s55, s56, s57
s_waitcnt vmcnt(11)
v_mfma_f32_16x16x32_bf16 v[32:35], a[0:3], v[64:67], v[32:35]
ds_read_b64_tr_b16 a[32:33], v7 offset:8320
ds_read_b64_tr_b16 a[34:35], v7 offset:8832
s_add_u32 m0, s55, 0
s_waitcnt vmcnt(10)
v_mfma_f32_16x16x32_bf16 v[48:51], a[0:3], v[68:71], v[48:51]
ds_read_b64_tr_b16 a[36:37], v7 offset:8352
buffer_load_dwordx4 v5, s[28:31], s54 offen lds
v_mfma_f32_16x16x32_bf16 v[36:39], a[4:7], v[64:67], v[36:39]
ds_read_b64_tr_b16 a[38:39], v7 offset:8864
ds_read_b64_tr_b16 a[40:41], v7 offset:8384
v_mfma_f32_16x16x32_bf16 v[52:55], a[4:7], v[68:71], v[52:55]
ds_read_b64_tr_b16 a[42:43], v7 offset:8896
buffer_load_dwordx4 v[112:115], v4, s[16:19], s52 offen sc1
v_mfma_f32_16x16x32_bf16 v[40:43], a[8:11], v[64:67], v[40:43]
ds_read_b64_tr_b16 a[44:45], v7 offset:8416
ds_read_b64_tr_b16 a[46:47], v7 offset:8928
v_mfma_f32_16x16x32_bf16 v[56:59], a[8:11], v[68:71], v[56:59]
ds_read_b64_tr_b16 a[48:49], v7 offset:9344
buffer_load_dwordx4 v[116:119], v4, s[16:19], s52 offen offset:1024 sc1
v_mfma_f32_16x16x32_bf16 v[44:47], a[12:15], v[64:67], v[44:47]
ds_read_b64_tr_b16 a[50:51], v7 offset:9856
ds_read_b64_tr_b16 a[52:53], v7 offset:9376
s_add_u32 s52, s52, 0x40000
v_mfma_f32_16x16x32_bf16 v[60:63], a[12:15], v[68:71], v[60:63]
ds_read_b64_tr_b16 a[54:55], v7 offset:9888
ds_read_b64_tr_b16 a[56:57], v7 offset:9408
s_waitcnt vmcnt(12)
v_mfma_f32_16x16x32_bf16 v[32:35], a[16:19], v[72:75], v[32:35]
ds_read_b64_tr_b16 a[58:59], v7 offset:9920
buffer_load_dwordx4 v6, s[28:31], s54 offen offset:1024 lds
s_waitcnt vmcnt(12)
v_mfma_f32_16x16x32_bf16 v[48:51], a[16:19], v[76:79], v[48:51]
ds_read_b64_tr_b16 a[60:61], v7 offset:9440
ds_read_b64_tr_b16 a[62:63], v7 offset:9952
s_add_u32 s54, s54, 0x20000
v_mfma_f32_16x16x32_bf16 v[36:39], a[20:23], v[72:75], v[36:39]
buffer_load_dwordx4 v[120:123], v4, s[16:19], s53 offen sc1
v_mfma_f32_16x16x32_bf16 v[52:55], a[20:23], v[76:79], v[52:55]
v_mfma_f32_16x16x32_bf16 v[40:43], a[24:27], v[72:75], v[40:43]
buffer_load_dwordx4 v[124:127], v4, s[16:19], s53 offen offset:1024 sc1
v_mfma_f32_16x16x32_bf16 v[56:59], a[24:27], v[76:79], v[56:59]
s_add_u32 s53, s53, 0x40000
v_mfma_f32_16x16x32_bf16 v[44:47], a[28:31], v[72:75], v[44:47]
v_mfma_f32_16x16x32_bf16 v[60:63], a[28:31], v[76:79], v[60:63]
s_waitcnt lgkmcnt(0)
s_barrier
s_waitcnt vmcnt(13)
v_mfma_f32_16x16x32_bf16 v[32:35], a[32:35], v[80:83], v[32:35]
ds_read_b64_tr_b16 a[0:1], v7 offset:16640
ds_read_b64_tr_b16 a[2:3], v7 offset:17152
s_add_u32 m0, s55, 8320
s_waitcnt vmcnt(12)
v_mfma_f32_16x16x32_bf16 v[48:51], a[32:35], v[84:87], v[48:51]
ds_read_b64_tr_b16 a[4:5], v7 offset:16672
buffer_load_dwordx4 v5, s[28:31], s54 offen lds
v_mfma_f32_16x16x32_bf16 v[36:39], a[36:39], v[80:83], v[36:39]
ds_read_b64_tr_b16 a[6:7], v7 offset:17184
ds_read_b64_tr_b16 a[8:9], v7 offset:16704
v_mfma_f32_16x16x32_bf16 v[52:55], a[36:39], v[84:87], v[52:55]
ds_read_b64_tr_b16 a[10:11], v7 offset:17216
buffer_load_dwordx4 v[64:67], v4, s[16:19], s52 offen sc1
v_mfma_f32_16x16x32_bf16 v[40:43], a[40:43], v[80:83], v[40:43]
ds_read_b64_tr_b16 a[12:13], v7 offset:16736
ds_read_b64_tr_b16 a[14:15], v7 offset:17248
v_mfma_f32_16x16x32_bf16 v[56:59], a[40:43], v[84:87], v[56:59]
ds_read_b64_tr_b16 a[16:17], v7 offset:17664
buffer_load_dwordx4 v[68:71], v4, s[16:19], s52 offen offset:1024 sc1
v_mfma_f32_16x16x32_bf16 v[44:47], a[44:47], v[80:83], v[44:47]
ds_read_b64_tr_b16 a[18:19], v7 offset:18176
ds_read_b64_tr_b16 a[20:21], v7 offset:17696
s_add_u32 s52, s52, 0x40000
v_mfma_f32_16x16x32_bf16 v[60:63], a[44:47], v[84:87], v[60:63]
ds_read_b64_tr_b16 a[22:23], v7 offset:18208
buffer_load_dwordx4 v6, s[28:31], s54 offen offset:1024 lds
s_waitcnt vmcnt(15)
v_mfma_f32_16x16x32_bf16 v[32:35], a[48:51], v[88:91], v[32:35]
ds_read_b64_tr_b16 a[24:25], v7 offset:17728
ds_read_b64_tr_b16 a[26:27], v7 offset:18240
s_add_u32 s54, s54, 0x20000
s_waitcnt vmcnt(14)
v_mfma_f32_16x16x32_bf16 v[48:51], a[48:51], v[92:95], v[48:51]
ds_read_b64_tr_b16 a[28:29], v7 offset:17760
buffer_load_dwordx4 v[72:75], v4, s[16:19], s53 offen sc1
v_mfma_f32_16x16x32_bf16 v[36:39], a[52:55], v[88:91], v[36:39]
ds_read_b64_tr_b16 a[30:31], v7 offset:18272
v_mfma_f32_16x16x32_bf16 v[52:55], a[52:55], v[92:95], v[52:55]
buffer_load_dwordx4 v[76:79], v4, s[16:19], s53 offen offset:1024 sc1
v_mfma_f32_16x16x32_bf16 v[40:43], a[56:59], v[88:91], v[40:43]
s_add_u32 s53, s53, 0x40000
v_mfma_f32_16x16x32_bf16 v[56:59], a[56:59], v[92:95], v[56:59]
buffer_load_dword v27, v9, s[28:31], s44 offen
v_mfma_f32_16x16x32_bf16 v[44:47], a[60:63], v[88:91], v[44:47]
s_add_u32 s44, s44, 0x100000
v_mfma_f32_16x16x32_bf16 v[60:63], a[60:63], v[92:95], v[60:63]
s_waitcnt lgkmcnt(0)
s_barrier
s_waitcnt vmcnt(16)
v_mfma_f32_16x16x32_bf16 v[32:35], a[0:3], v[96:99], v[32:35]
ds_read_b64_tr_b16 a[32:33], v7 offset:24960
ds_read_b64_tr_b16 a[34:35], v7 offset:25472
s_add_u32 m0, s55, 16640
s_waitcnt vmcnt(15)
v_mfma_f32_16x16x32_bf16 v[48:51], a[0:3], v[100:103], v[48:51]
ds_read_b64_tr_b16 a[36:37], v7 offset:24992
buffer_load_dwordx4 v5, s[28:31], s54 offen lds
v_mfma_f32_16x16x32_bf16 v[36:39], a[4:7], v[96:99], v[36:39]
ds_read_b64_tr_b16 a[38:39], v7 offset:25504
ds_read_b64_tr_b16 a[40:41], v7 offset:25024
v_mfma_f32_16x16x32_bf16 v[52:55], a[4:7], v[100:103], v[52:55]
ds_read_b64_tr_b16 a[42:43], v7 offset:25536
buffer_load_dwordx4 v[80:83], v4, s[16:19], s52 offen sc1
v_mfma_f32_16x16x32_bf16 v[40:43], a[8:11], v[96:99], v[40:43]
ds_read_b64_tr_b16 a[44:45], v7 offset:25056
ds_read_b64_tr_b16 a[46:47], v7 offset:25568
v_mfma_f32_16x16x32_bf16 v[56:59], a[8:11], v[100:103], v[56:59]
ds_read_b64_tr_b16 a[48:49], v7 offset:25984
buffer_load_dwordx4 v[84:87], v4, s[16:19], s52 offen offset:1024 sc1
v_mfma_f32_16x16x32_bf16 v[44:47], a[12:15], v[96:99], v[44:47]
ds_read_b64_tr_b16 a[50:51], v7 offset:26496
ds_read_b64_tr_b16 a[52:53], v7 offset:26016
s_add_u32 s52, s52, 0x40000
v_mfma_f32_16x16x32_bf16 v[60:63], a[12:15], v[100:103], v[60:63]
ds_read_b64_tr_b16 a[54:55], v7 offset:26528
ds_read_b64_tr_b16 a[56:57], v7 offset:26048
s_waitcnt vmcnt(17)
v_mfma_f32_16x16x32_bf16 v[32:35], a[16:19], v[104:107], v[32:35]
ds_read_b64_tr_b16 a[58:59], v7 offset:26560
buffer_load_dwordx4 v6, s[28:31], s54 offen offset:1024 lds
s_waitcnt vmcnt(17)
v_mfma_f32_16x16x32_bf16 v[48:51], a[16:19], v[108:111], v[48:51]
ds_read_b64_tr_b16 a[60:61], v7 offset:26080
ds_read_b64_tr_b16 a[62:63], v7 offset:26592
s_add_u32 s54, s54, 0x20000
v_mfma_f32_16x16x32_bf16 v[36:39], a[20:23], v[104:107], v[36:39]
buffer_load_dwordx4 v[88:91], v4, s[16:19], s53 offen sc1
v_mfma_f32_16x16x32_bf16 v[52:55], a[20:23], v[108:111], v[52:55]
v_mfma_f32_16x16x32_bf16 v[40:43], a[24:27], v[104:107], v[40:43]
buffer_load_dwordx4 v[92:95], v4, s[16:19], s53 offen offset:1024 sc1
v_mfma_f32_16x16x32_bf16 v[56:59], a[24:27], v[108:111], v[56:59]
s_add_u32 s53, s53, 0x40000
v_mfma_f32_16x16x32_bf16 v[44:47], a[28:31], v[104:107], v[44:47]
v_mfma_f32_16x16x32_bf16 v[60:63], a[28:31], v[108:111], v[60:63]
s_waitcnt lgkmcnt(0)
s_barrier
s_waitcnt vmcnt(17)
v_mfma_f32_16x16x32_bf16 v[32:35], a[32:35], v[112:115], v[32:35]
ds_read_b64_tr_b16 a[0:1], v7 offset:33280
ds_read_b64_tr_b16 a[2:3], v7 offset:33792
s_add_u32 m0, s55, 24960
s_waitcnt vmcnt(16)
v_mfma_f32_16x16x32_bf16 v[48:51], a[32:35], v[116:119], v[48:51]
ds_read_b64_tr_b16 a[4:5], v7 offset:33312
buffer_load_dwordx4 v5, s[28:31], s54 offen lds
v_mfma_f32_16x16x32_bf16 v[36:39], a[36:39], v[112:115], v[36:39]
ds_read_b64_tr_b16 a[6:7], v7 offset:33824
ds_read_b64_tr_b16 a[8:9], v7 offset:33344
v_mfma_f32_16x16x32_bf16 v[52:55], a[36:39], v[116:119], v[52:55]
ds_read_b64_tr_b16 a[10:11], v7 offset:33856
buffer_load_dwordx4 v[96:99], v4, s[16:19], s52 offen sc1
v_mfma_f32_16x16x32_bf16 v[40:43], a[40:43], v[112:115], v[40:43]
ds_read_b64_tr_b16 a[12:13], v7 offset:33376
ds_read_b64_tr_b16 a[14:15], v7 offset:33888
v_mfma_f32_16x16x32_bf16 v[56:59], a[40:43], v[116:119], v[56:59]
ds_read_b64_tr_b16 a[16:17], v7 offset:34304
buffer_load_dwordx4 v[100:103], v4, s[16:19], s52 offen offset:1024 sc1
v_mfma_f32_16x16x32_bf16 v[44:47], a[44:47], v[112:115], v[44:47]
ds_read_b64_tr_b16 a[18:19], v7 offset:34816
ds_read_b64_tr_b16 a[20:21], v7 offset:34336
s_add_u32 s52, s52, 0x40000
v_mfma_f32_16x16x32_bf16 v[60:63], a[44:47], v[116:119], v[60:63]
ds_read_b64_tr_b16 a[22:23], v7 offset:34848
ds_read_b64_tr_b16 a[24:25], v7 offset:34368
s_waitcnt vmcnt(17)
v_mfma_f32_16x16x32_bf16 v[32:35], a[48:51], v[120:123], v[32:35]
ds_read_b64_tr_b16 a[26:27], v7 offset:34880
buffer_load_dwordx4 v6, s[28:31], s54 offen offset:1024 lds
s_waitcnt vmcnt(17)
v_mfma_f32_16x16x32_bf16 v[48:51], a[48:51], v[124:127], v[48:51]
ds_read_b64_tr_b16 a[28:29], v7 offset:34400
ds_read_b64_tr_b16 a[30:31], v7 offset:34912
s_add_u32 s54, s54, 0x20000
v_mfma_f32_16x16x32_bf16 v[36:39], a[52:55], v[120:123], v[36:39]
buffer_load_dwordx4 v[104:107], v4, s[16:19], s53 offen sc1
v_mfma_f32_16x16x32_bf16 v[52:55], a[52:55], v[124:127], v[52:55]
v_mfma_f32_16x16x32_bf16 v[40:43], a[56:59], v[120:123], v[40:43]
buffer_load_dwordx4 v[108:111], v4, s[16:19], s53 offen offset:1024 sc1
v_mfma_f32_16x16x32_bf16 v[56:59], a[56:59], v[124:127], v[56:59]
s_add_u32 s53, s53, 0x40000
v_mfma_f32_16x16x32_bf16 v[44:47], a[60:63], v[120:123], v[44:47]
v_mfma_f32_16x16x32_bf16 v[60:63], a[60:63], v[124:127], v[60:63]
s_waitcnt lgkmcnt(0)
s_barrier
s_waitcnt vmcnt(17)
v_mfma_f32_16x16x32_bf16 v[32:35], a[0:3], v[64:67], v[32:35]
ds_read_b64_tr_b16 a[32:33], v7 offset:41600
ds_read_b64_tr_b16 a[34:35], v7 offset:42112
s_add_u32 m0, s55, 33280
s_waitcnt vmcnt(16)
v_mfma_f32_16x16x32_bf16 v[48:51], a[0:3], v[68:71], v[48:51]
ds_read_b64_tr_b16 a[36:37], v7 offset:41632
buffer_load_dwordx4 v5, s[28:31], s54 offen lds
v_mfma_f32_16x16x32_bf16 v[36:39], a[4:7], v[64:67], v[36:39]
ds_read_b64_tr_b16 a[38:39], v7 offset:42144
ds_read_b64_tr_b16 a[40:41], v7 offset:41664
v_mfma_f32_16x16x32_bf16 v[52:55], a[4:7], v[68:71], v[52:55]
ds_read_b64_tr_b16 a[42:43], v7 offset:42176
buffer_load_dwordx4 v[112:115], v4, s[16:19], s52 offen sc1
v_mfma_f32_16x16x32_bf16 v[40:43], a[8:11], v[64:67], v[40:43]
ds_read_b64_tr_b16 a[44:45], v7 offset:41696
ds_read_b64_tr_b16 a[46:47], v7 offset:42208
v_mfma_f32_16x16x32_bf16 v[56:59], a[8:11], v[68:71], v[56:59]
ds_read_b64_tr_b16 a[48:49], v7 offset:42624
buffer_load_dwordx4 v[116:119], v4, s[16:19], s52 offen offset:1024 sc1
v_mfma_f32_16x16x32_bf16 v[44:47], a[12:15], v[64:67], v[44:47]
ds_read_b64_tr_b16 a[50:51], v7 offset:43136
ds_read_b64_tr_b16 a[52:53], v7 offset:42656
s_add_u32 s52, s52, 0x40000
v_mfma_f32_16x16x32_bf16 v[60:63], a[12:15], v[68:71], v[60:63]
ds_read_b64_tr_b16 a[54:55], v7 offset:43168
ds_read_b64_tr_b16 a[56:57], v7 offset:42688
s_waitcnt vmcnt(17)
v_mfma_f32_16x16x32_bf16 v[32:35], a[16:19], v[72:75], v[32:35]
ds_read_b64_tr_b16 a[58:59], v7 offset:43200
buffer_load_dwordx4 v6, s[28:31], s54 offen offset:1024 lds
s_waitcnt vmcnt(17)
v_mfma_f32_16x16x32_bf16 v[48:51], a[16:19], v[76:79], v[48:51]
ds_read_b64_tr_b16 a[60:61], v7 offset:42720
ds_read_b64_tr_b16 a[62:63], v7 offset:43232
s_add_u32 s54, s54, 0x20000
v_mfma_f32_16x16x32_bf16 v[36:39], a[20:23], v[72:75], v[36:39]
buffer_load_dwordx4 v[120:123], v4, s[16:19], s53 offen sc1
v_mfma_f32_16x16x32_bf16 v[52:55], a[20:23], v[76:79], v[52:55]
v_mfma_f32_16x16x32_bf16 v[40:43], a[24:27], v[72:75], v[40:43]
buffer_load_dwordx4 v[124:127], v4, s[16:19], s53 offen offset:1024 sc1
v_mfma_f32_16x16x32_bf16 v[56:59], a[24:27], v[76:79], v[56:59]
s_add_u32 s53, s53, 0x40000
v_mfma_f32_16x16x32_bf16 v[44:47], a[28:31], v[72:75], v[44:47]
v_mfma_f32_16x16x32_bf16 v[60:63], a[28:31], v[76:79], v[60:63]
s_waitcnt lgkmcnt(0)
s_barrier
s_waitcnt vmcnt(16)
v_mfma_f32_16x16x32_bf16 v[32:35], a[32:35], v[80:83], v[32:35]
ds_read_b64_tr_b16 a[0:1], v7 offset:49920
ds_read_b64_tr_b16 a[2:3], v7 offset:50432
s_add_u32 m0, s55, 41600
s_waitcnt vmcnt(15)
v_mfma_f32_16x16x32_bf16 v[48:51], a[32:35], v[84:87], v[48:51]
ds_read_b64_tr_b16 a[4:5], v7 offset:49952
buffer_load_dwordx4 v5, s[28:31], s54 offen lds
v_mfma_f32_16x16x32_bf16 v[36:39], a[36:39], v[80:83], v[36:39]
ds_read_b64_tr_b16 a[6:7], v7 offset:50464
ds_read_b64_tr_b16 a[8:9], v7 offset:49984
v_mfma_f32_16x16x32_bf16 v[52:55], a[36:39], v[84:87], v[52:55]
ds_read_b64_tr_b16 a[10:11], v7 offset:50496
buffer_load_dwordx4 v[64:67], v4, s[16:19], s52 offen sc1
v_mfma_f32_16x16x32_bf16 v[40:43], a[40:43], v[80:83], v[40:43]
ds_read_b64_tr_b16 a[12:13], v7 offset:50016
ds_read_b64_tr_b16 a[14:15], v7 offset:50528
v_mfma_f32_16x16x32_bf16 v[56:59], a[40:43], v[84:87], v[56:59]
ds_read_b64_tr_b16 a[16:17], v7 offset:50944
buffer_load_dwordx4 v[68:71], v4, s[16:19], s52 offen offset:1024 sc1
v_mfma_f32_16x16x32_bf16 v[44:47], a[44:47], v[80:83], v[44:47]
ds_read_b64_tr_b16 a[18:19], v7 offset:51456
ds_read_b64_tr_b16 a[20:21], v7 offset:50976
s_add_u32 s52, s52, 0x40000
v_mfma_f32_16x16x32_bf16 v[60:63], a[44:47], v[84:87], v[60:63]
ds_read_b64_tr_b16 a[22:23], v7 offset:51488
ds_read_b64_tr_b16 a[24:25], v7 offset:51008
s_waitcnt vmcnt(16)
v_mfma_f32_16x16x32_bf16 v[32:35], a[48:51], v[88:91], v[32:35]
ds_read_b64_tr_b16 a[26:27], v7 offset:51520
buffer_load_dwordx4 v6, s[28:31], s54 offen offset:1024 lds
s_waitcnt vmcnt(16)
v_mfma_f32_16x16x32_bf16 v[48:51], a[48:51], v[92:95], v[48:51]
ds_read_b64_tr_b16 a[28:29], v7 offset:51040
ds_read_b64_tr_b16 a[30:31], v7 offset:51552
s_add_u32 s54, s54, 0x20000
v_mfma_f32_16x16x32_bf16 v[36:39], a[52:55], v[88:91], v[36:39]
buffer_load_dwordx4 v[72:75], v4, s[16:19], s53 offen sc1
v_mfma_f32_16x16x32_bf16 v[52:55], a[52:55], v[92:95], v[52:55]
v_mfma_f32_16x16x32_bf16 v[40:43], a[56:59], v[88:91], v[40:43]
buffer_load_dwordx4 v[76:79], v4, s[16:19], s53 offen offset:1024 sc1
v_mfma_f32_16x16x32_bf16 v[56:59], a[56:59], v[92:95], v[56:59]
s_add_u32 s53, s53, 0x40000
v_mfma_f32_16x16x32_bf16 v[44:47], a[60:63], v[88:91], v[44:47]
v_mfma_f32_16x16x32_bf16 v[60:63], a[60:63], v[92:95], v[60:63]
s_waitcnt lgkmcnt(0)
s_barrier
s_waitcnt vmcnt(16)
v_mfma_f32_16x16x32_bf16 v[32:35], a[0:3], v[96:99], v[32:35]
ds_read_b64_tr_b16 a[32:33], v7 offset:58240
ds_read_b64_tr_b16 a[34:35], v7 offset:58752
s_add_u32 m0, s55, 49920
s_waitcnt vmcnt(15)
v_mfma_f32_16x16x32_bf16 v[48:51], a[0:3], v[100:103], v[48:51]
ds_read_b64_tr_b16 a[36:37], v7 offset:58272
buffer_load_dwordx4 v5, s[28:31], s54 offen lds
v_mfma_f32_16x16x32_bf16 v[36:39], a[4:7], v[96:99], v[36:39]
ds_read_b64_tr_b16 a[38:39], v7 offset:58784
ds_read_b64_tr_b16 a[40:41], v7 offset:58304
v_mfma_f32_16x16x32_bf16 v[52:55], a[4:7], v[100:103], v[52:55]
ds_read_b64_tr_b16 a[42:43], v7 offset:58816
buffer_load_dwordx4 v[80:83], v4, s[16:19], s52 offen sc1
v_mfma_f32_16x16x32_bf16 v[40:43], a[8:11], v[96:99], v[40:43]
ds_read_b64_tr_b16 a[44:45], v7 offset:58336
ds_read_b64_tr_b16 a[46:47], v7 offset:58848
v_mfma_f32_16x16x32_bf16 v[56:59], a[8:11], v[100:103], v[56:59]
ds_read_b64_tr_b16 a[48:49], v7 offset:59264
buffer_load_dwordx4 v[84:87], v4, s[16:19], s52 offen offset:1024 sc1
v_mfma_f32_16x16x32_bf16 v[44:47], a[12:15], v[96:99], v[44:47]
ds_read_b64_tr_b16 a[50:51], v7 offset:59776
ds_read_b64_tr_b16 a[52:53], v7 offset:59296
s_add_u32 s52, s52, 0x40000
v_mfma_f32_16x16x32_bf16 v[60:63], a[12:15], v[100:103], v[60:63]
ds_read_b64_tr_b16 a[54:55], v7 offset:59808
ds_read_b64_tr_b16 a[56:57], v7 offset:59328
s_waitcnt vmcnt(16)
v_mfma_f32_16x16x32_bf16 v[32:35], a[16:19], v[104:107], v[32:35]
ds_read_b64_tr_b16 a[58:59], v7 offset:59840
buffer_load_dwordx4 v6, s[28:31], s54 offen offset:1024 lds
s_waitcnt vmcnt(16)
v_mfma_f32_16x16x32_bf16 v[48:51], a[16:19], v[108:111], v[48:51]
ds_read_b64_tr_b16 a[60:61], v7 offset:59360
ds_read_b64_tr_b16 a[62:63], v7 offset:59872
s_add_u32 s54, s54, 0x20000
v_mfma_f32_16x16x32_bf16 v[36:39], a[20:23], v[104:107], v[36:39]
buffer_load_dwordx4 v[88:91], v4, s[16:19], s53 offen sc1
v_mfma_f32_16x16x32_bf16 v[52:55], a[20:23], v[108:111], v[52:55]
v_mfma_f32_16x16x32_bf16 v[40:43], a[24:27], v[104:107], v[40:43]
buffer_load_dwordx4 v[92:95], v4, s[16:19], s53 offen offset:1024 sc1
v_mfma_f32_16x16x32_bf16 v[56:59], a[24:27], v[108:111], v[56:59]
s_add_u32 s53, s53, 0x40000
v_mfma_f32_16x16x32_bf16 v[44:47], a[28:31], v[104:107], v[44:47]
v_mfma_f32_16x16x32_bf16 v[60:63], a[28:31], v[108:111], v[60:63]
s_waitcnt lgkmcnt(0)
s_barrier
s_xor_b32 s57, s57, 66560
v_add_u32 v7, s57, v8
s_waitcnt vmcnt(16)
v_mfma_f32_16x16x32_bf16 v[32:35], a[32:35], v[112:115], v[32:35]
ds_read_b64_tr_b16 a[0:1], v7
ds_read_b64_tr_b16 a[2:3], v7 offset:512
s_add_u32 m0, s55, 58240
s_waitcnt vmcnt(15)
v_mfma_f32_16x16x32_bf16 v[48:51], a[32:35], v[116:119], v[48:51]
ds_read_b64_tr_b16 a[4:5], v7 offset:32
buffer_load_dwordx4 v5, s[28:31], s54 offen lds
v_mfma_f32_16x16x32_bf16 v[36:39], a[36:39], v[112:115], v[36:39]
ds_read_b64_tr_b16 a[6:7], v7 offset:544
ds_read_b64_tr_b16 a[8:9], v7 offset:64
v_mfma_f32_16x16x32_bf16 v[52:55], a[36:39], v[116:119], v[52:55]
ds_read_b64_tr_b16 a[10:11], v7 offset:576
buffer_load_dwordx4 v[96:99], v4, s[16:19], s52 offen sc1
v_mfma_f32_16x16x32_bf16 v[40:43], a[40:43], v[112:115], v[40:43]
ds_read_b64_tr_b16 a[12:13], v7 offset:96
ds_read_b64_tr_b16 a[14:15], v7 offset:608
v_mfma_f32_16x16x32_bf16 v[56:59], a[40:43], v[116:119], v[56:59]
ds_read_b64_tr_b16 a[16:17], v7 offset:1024
buffer_load_dwordx4 v[100:103], v4, s[16:19], s52 offen offset:1024 sc1
v_mfma_f32_16x16x32_bf16 v[44:47], a[44:47], v[112:115], v[44:47]
ds_read_b64_tr_b16 a[18:19], v7 offset:1536
ds_read_b64_tr_b16 a[20:21], v7 offset:1056
s_add_u32 s52, s52, 0x40000
v_mfma_f32_16x16x32_bf16 v[60:63], a[44:47], v[116:119], v[60:63]
ds_read_b64_tr_b16 a[22:23], v7 offset:1568
ds_read_b64_tr_b16 a[24:25], v7 offset:1088
s_waitcnt vmcnt(16)
v_mfma_f32_16x16x32_bf16 v[32:35], a[48:51], v[120:123], v[32:35]
ds_read_b64_tr_b16 a[26:27], v7 offset:1600
buffer_load_dwordx4 v6, s[28:31], s54 offen offset:1024 lds
s_waitcnt vmcnt(16)
v_mfma_f32_16x16x32_bf16 v[48:51], a[48:51], v[124:127], v[48:51]
ds_read_b64_tr_b16 a[28:29], v7 offset:1120
ds_read_b64_tr_b16 a[30:31], v7 offset:1632
s_add_u32 s54, s54, 0x20000
v_mfma_f32_16x16x32_bf16 v[36:39], a[52:55], v[120:123], v[36:39]
buffer_load_dwordx4 v[104:107], v4, s[16:19], s53 offen sc1
v_mfma_f32_16x16x32_bf16 v[52:55], a[52:55], v[124:127], v[52:55]
v_mfma_f32_16x16x32_bf16 v[40:43], a[56:59], v[120:123], v[40:43]
buffer_load_dwordx4 v[108:111], v4, s[16:19], s53 offen offset:1024 sc1
v_mfma_f32_16x16x32_bf16 v[56:59], a[56:59], v[124:127], v[56:59]
s_add_u32 s53, s53, 0x40000
v_mfma_f32_16x16x32_bf16 v[44:47], a[60:63], v[120:123], v[44:47]
s_add_u32 s15, s15, 1
v_mfma_f32_16x16x32_bf16 v[60:63], a[60:63], v[124:127], v[60:63]
s_cbranch_scc0 .Lk59
s_waitcnt vmcnt(16) lgkmcnt(14)
v_mfma_f32_16x16x32_bf16 v[32:35], a[0:3], v[64:67], v[32:35]
ds_read_b64_tr_b16 a[32:33], v7 offset:8320
ds_read_b64_tr_b16 a[34:35], v7 offset:8832
s_waitcnt vmcnt(15)
v_mfma_f32_16x16x32_bf16 v[48:51], a[0:3], v[68:71], v[48:51]
buffer_load_dwordx4 v[112:115], v4, s[16:19], s52 offen sc1
s_waitcnt lgkmcnt(14)
v_mfma_f32_16x16x32_bf16 v[36:39], a[4:7], v[64:67], v[36:39]
ds_read_b64_tr_b16 a[36:37], v7 offset:8352
ds_read_b64_tr_b16 a[38:39], v7 offset:8864
v_mfma_f32_16x16x32_bf16 v[52:55], a[4:7], v[68:71], v[52:55]
ds_read_b64_tr_b16 a[40:41], v7 offset:8384
.Lpad31:
s_cbranch_execz .Lnopoll58r
ds_read_b64_tr_b16 a[42:43], v7 offset:8896
s_waitcnt lgkmcnt(15)
v_mfma_f32_16x16x32_bf16 v[40:43], a[8:11], v[64:67], v[40:43]
buffer_load_dwordx4 v[116:119], v4, s[16:19], s52 offen offset:1024 sc1
v_mfma_f32_16x16x32_bf16 v[56:59], a[8:11], v[68:71], v[56:59]
ds_read_b64_tr_b16 a[44:45], v7 offset:8416
s_add_u32 s52, s52, 0x40000
s_waitcnt lgkmcnt(15)
v_mfma_f32_16x16x32_bf16 v[44:47], a[12:15], v[64:67], v[44:47]
ds_read_b64_tr_b16 a[46:47], v7 offset:8928
v_mfma_f32_16x16x32_bf16 v[60:63], a[12:15], v[68:71], v[60:63]
ds_read_b64_tr_b16 a[48:49], v7 offset:9344
ds_read_b64_tr_b16 a[50:51], v7 offset:9856
s_waitcnt vmcnt(15) lgkmcnt(15)
v_mfma_f32_16x16x32_bf16 v[32:35], a[16:19], v[72:75], v[32:35]
buffer_load_dwordx4 v[120:123], v4, s[16:19], s53 offen sc1
s_waitcnt vmcnt(15)
v_mfma_f32_16x16x32_bf16 v[48:51], a[16:19], v[76:79], v[48:51]
ds_read_b64_tr_b16 a[52:53], v7 offset:9376
ds_read_b64_tr_b16 a[54:55], v7 offset:9888
s_waitcnt lgkmcnt(15)
v_mfma_f32_16x16x32_bf16 v[36:39], a[20:23], v[72:75], v[36:39]
ds_read_b64_tr_b16 a[56:57], v7 offset:9408
ds_read_b64_tr_b16 a[58:59], v7 offset:9920
v_mfma_f32_16x16x32_bf16 v[52:55], a[20:23], v[76:79], v[52:55]
buffer_load_dwordx4 v[124:127], v4, s[16:19], s53 offen offset:1024 sc1
s_waitcnt lgkmcnt(15)
v_mfma_f32_16x16x32_bf16 v[40:43], a[24:27], v[72:75], v[40:43]
ds_read_b64_tr_b16 a[60:61], v7 offset:9440
s_add_u32 s53, s53, 0x40000
v_mfma_f32_16x16x32_bf16 v[56:59], a[24:27], v[76:79], v[56:59]
ds_read_b64_tr_b16 a[62:63], v7 offset:9952
s_waitcnt lgkmcnt(15)
v_mfma_f32_16x16x32_bf16 v[44:47], a[28:31], v[72:75], v[44:47]
v_mfma_f32_16x16x32_bf16 v[60:63], a[28:31], v[76:79], v[60:63]
s_waitcnt vmcnt(14) lgkmcnt(14)
v_mfma_f32_16x16x32_bf16 v[32:35], a[32:35], v[80:83], v[32:35]
ds_read_b64_tr_b16 a[0:1], v7 offset:16640
ds_read_b64_tr_b16 a[2:3], v7 offset:17152
s_waitcnt vmcnt(13)
v_mfma_f32_16x16x32_bf16 v[48:51], a[32:35], v[84:87], v[48:51]
buffer_load_dwordx4 v[64:67], v4, s[16:19], s52 offen sc1
s_waitcnt lgkmcnt(14)
v_mfma_f32_16x16x32_bf16 v[36:39], a[36:39], v[80:83], v[36:39]
ds_read_b64_tr_b16 a[4:5], v7 offset:16672
ds_read_b64_tr_b16 a[6:7], v7 offset:17184
v_mfma_f32_16x16x32_bf16 v[52:55], a[36:39], v[84:87], v[52:55]
ds_read_b64_tr_b16 a[8:9], v7 offset:16704
ds_read_b64_tr_b16 a[10:11], v7 offset:17216
s_waitcnt lgkmcnt(15)
v_mfma_f32_16x16x32_bf16 v[40:43], a[40:43], v[80:83], v[40:43]
buffer_load_dwordx4 v[68:71], v4, s[16:19], s52 offen offset:1024 sc1
v_mfma_f32_16x16x32_bf16 v[56:59], a[40:43], v[84:87], v[56:59]
ds_read_b64_tr_b16 a[12:13], v7 offset:16736
s_add_u32 s52, s52, 0x40000
s_waitcnt lgkmcnt(15)
v_mfma_f32_16x16x32_bf16 v[44:47], a[44:47], v[80:83], v[44:47]
ds_read_b64_tr_b16 a[14:15], v7 offset:17248
v_mfma_f32_16x16x32_bf16 v[60:63], a[44:47], v[84:87], v[60:63]
ds_read_b64_tr_b16 a[16:17], v7 offset:17664
ds_read_b64_tr_b16 a[18:19], v7 offset:18176
s_waitcnt vmcnt(13) lgkmcnt(15)
v_mfma_f32_16x16x32_bf16 v[32:35], a[48:51], v[88:91], v[32:35]
buffer_load_dwordx4 v[72:75], v4, s[16:19], s53 offen sc1
s_waitcnt vmcnt(13)
v_mfma_f32_16x16x32_bf16 v[48:51], a[48:51], v[92:95], v[48:51]
ds_read_b64_tr_b16 a[20:21], v7 offset:17696
ds_read_b64_tr_b16 a[22:23], v7 offset:18208
s_waitcnt lgkmcnt(15)
v_mfma_f32_16x16x32_bf16 v[36:39], a[52:55], v[88:91], v[36:39]
ds_read_b64_tr_b16 a[24:25], v7 offset:17728
ds_read_b64_tr_b16 a[26:27], v7 offset:18240
v_mfma_f32_16x16x32_bf16 v[52:55], a[52:55], v[92:95], v[52:55]
buffer_load_dwordx4 v[76:79], v4, s[16:19], s53 offen offset:1024 sc1
s_waitcnt lgkmcnt(15)
v_mfma_f32_16x16x32_bf16 v[40:43], a[56:59], v[88:91], v[40:43]
ds_read_b64_tr_b16 a[28:29], v7 offset:17760
s_add_u32 s53, s53, 0x40000
v_mfma_f32_16x16x32_bf16 v[56:59], a[56:59], v[92:95], v[56:59]
ds_read_b64_tr_b16 a[30:31], v7 offset:18272
s_waitcnt lgkmcnt(15)
v_mfma_f32_16x16x32_bf16 v[44:47], a[60:63], v[88:91], v[44:47]
v_mfma_f32_16x16x32_bf16 v[60:63], a[60:63], v[92:95], v[60:63]
s_waitcnt vmcnt(12) lgkmcnt(14)
v_mfma_f32_16x16x32_bf16 v[32:35], a[0:3], v[96:99], v[32:35]
ds_read_b64_tr_b16 a[32:33], v7 offset:24960
ds_read_b64_tr_b16 a[34:35], v7 offset:25472
s_waitcnt vmcnt(11)
v_mfma_f32_16x16x32_bf16 v[48:51], a[0:3], v[100:103], v[48:51]
buffer_load_dwordx4 v[80:83], v4, s[16:19], s52 offen sc1
s_waitcnt lgkmcnt(14)
v_mfma_f32_16x16x32_bf16 v[36:39], a[4:7], v[96:99], v[36:39]
ds_read_b64_tr_b16 a[36:37], v7 offset:24992
ds_read_b64_tr_b16 a[38:39], v7 offset:25504
v_mfma_f32_16x16x32_bf16 v[52:55], a[4:7], v[100:103], v[52:55]
ds_read_b64_tr_b16 a[40:41], v7 offset:25024
ds_read_b64_tr_b16 a[42:43], v7 offset:25536
s_waitcnt lgkmcnt(15)
v_mfma_f32_16x16x32_bf16 v[40:43], a[8:11], v[96:99], v[40:43]
buffer_load_dwordx4 v[84:87], v4, s[16:19], s52 offen offset:1024 sc1
v_mfma_f32_16x16x32_bf16 v[56:59], a[8:11], v[100:103], v[56:59]
ds_read_b64_tr_b16 a[44:45], v7 offset:25056
s_add_u32 s52, s52, 0x40000
s_waitcnt lgkmcnt(15)
v_mfma_f32_16x16x32_bf16 v[44:47], a[12:15], v[96:99], v[44:47]
ds_read_b64_tr_b16 a[46:47], v7 offset:25568
v_mfma_f32_16x16x32_bf16 v[60:63], a[12:15], v[100:103], v[60:63]
ds_read_b64_tr_b16 a[48:49], v7 offset:25984
ds_read_b64_tr_b16 a[50:51], v7 offset:26496
s_waitcnt vmcnt(11) lgkmcnt(15)
v_mfma_f32_16x16x32_bf16 v[32:35], a[16:19], v[104:107], v[32:35]
buffer_load_dwordx4 v[88:91], v4, s[16:19], s53 offen sc1
s_waitcnt vmcnt(11)
v_mfma_f32_16x16x32_bf16 v[48:51], a[16:19], v[108:111], v[48:51]
ds_read_b64_tr_b16 a[52:53], v7 offset:26016
ds_read_b64_tr_b16 a[54:55], v7 offset:26528
s_waitcnt lgkmcnt(15)
v_mfma_f32_16x16x32_bf16 v[36:39], a[20:23], v[104:107], v[36:39]
ds_read_b64_tr_b16 a[56:57], v7 offset:26048
ds_read_b64_tr_b16 a[58:59], v7 offset:26560
v_mfma_f32_16x16x32_bf16 v[52:55], a[20:23], v[108:111], v[52:55]
buffer_load_dwordx4 v[92:95], v4, s[16:19], s53 offen offset:1024 sc1
s_waitcnt lgkmcnt(15)
v_mfma_f32_16x16x32_bf16 v[40:43], a[24:27], v[104:107], v[40:43]
ds_read_b64_tr_b16 a[60:61], v7 offset:26080
s_add_u32 s53, s53, 0x40000
v_mfma_f32_16x16x32_bf16 v[56:59], a[24:27], v[108:111], v[56:59]
ds_read_b64_tr_b16 a[62:63], v7 offset:26592
s_waitcnt lgkmcnt(15)
v_mfma_f32_16x16x32_bf16 v[44:47], a[28:31], v[104:107], v[44:47]
v_mfma_f32_16x16x32_bf16 v[60:63], a[28:31], v[108:111], v[60:63]
s_waitcnt vmcnt(11) lgkmcnt(14)
v_mfma_f32_16x16x32_bf16 v[32:35], a[32:35], v[112:115], v[32:35]
ds_read_b64_tr_b16 a[0:1], v7 offset:33280
ds_read_b64_tr_b16 a[2:3], v7 offset:33792
s_waitcnt vmcnt(10)
v_mfma_f32_16x16x32_bf16 v[48:51], a[32:35], v[116:119], v[48:51]
buffer_load_dwordx4 v[96:99], v4, s[16:19], s52 offen sc1
s_waitcnt lgkmcnt(14)
v_mfma_f32_16x16x32_bf16 v[36:39], a[36:39], v[112:115], v[36:39]
ds_read_b64_tr_b16 a[4:5], v7 offset:33312
ds_read_b64_tr_b16 a[6:7], v7 offset:33824
v_mfma_f32_16x16x32_bf16 v[52:55], a[36:39], v[116:119], v[52:55]
ds_read_b64_tr_b16 a[8:9], v7 offset:33344
ds_read_b64_tr_b16 a[10:11], v7 offset:33856
s_waitcnt lgkmcnt(15)
v_mfma_f32_16x16x32_bf16 v[40:43], a[40:43], v[112:115], v[40:43]
buffer_load_dwordx4 v[100:103], v4, s[16:19], s52 offen offset:1024 sc1
v_mfma_f32_16x16x32_bf16 v[56:59], a[40:43], v[116:119], v[56:59]
ds_read_b64_tr_b16 a[12:13], v7 offset:33376
s_add_u32 s52, s52, 0x40000
s_waitcnt lgkmcnt(15)
v_mfma_f32_16x16x32_bf16 v[44:47], a[44:47], v[112:115], v[44:47]
ds_read_b64_tr_b16 a[14:15], v7 offset:33888
v_mfma_f32_16x16x32_bf16 v[60:63], a[44:47], v[116:119], v[60:63]
ds_read_b64_tr_b16 a[16:17], v7 offset:34304
ds_read_b64_tr_b16 a[18:19], v7 offset:34816
s_waitcnt vmcnt(11) lgkmcnt(15)
v_mfma_f32_16x16x32_bf16 v[32:35], a[48:51], v[120:123], v[32:35]
buffer_load_dwordx4 v[104:107], v4, s[16:19], s53 offen sc1
s_waitcnt vmcnt(11)
v_mfma_f32_16x16x32_bf16 v[48:51], a[48:51], v[124:127], v[48:51]
ds_read_b64_tr_b16 a[20:21], v7 offset:34336
ds_read_b64_tr_b16 a[22:23], v7 offset:34848
s_waitcnt lgkmcnt(15)
v_mfma_f32_16x16x32_bf16 v[36:39], a[52:55], v[120:123], v[36:39]
ds_read_b64_tr_b16 a[24:25], v7 offset:34368
ds_read_b64_tr_b16 a[26:27], v7 offset:34880
v_mfma_f32_16x16x32_bf16 v[52:55], a[52:55], v[124:127], v[52:55]
buffer_load_dwordx4 v[108:111], v4, s[16:19], s53 offen offset:1024 sc1
s_waitcnt lgkmcnt(15)
v_mfma_f32_16x16x32_bf16 v[40:43], a[56:59], v[120:123], v[40:43]
ds_read_b64_tr_b16 a[28:29], v7 offset:34400
s_add_u32 s53, s53, 0x40000
v_mfma_f32_16x16x32_bf16 v[56:59], a[56:59], v[124:127], v[56:59]
ds_read_b64_tr_b16 a[30:31], v7 offset:34912
s_waitcnt lgkmcnt(15)
v_mfma_f32_16x16x32_bf16 v[44:47], a[60:63], v[120:123], v[44:47]
v_mfma_f32_16x16x32_bf16 v[60:63], a[60:63], v[124:127], v[60:63]
s_waitcnt lgkmcnt(0)
s_barrier
s_waitcnt vmcnt(11)
v_mfma_f32_16x16x32_bf16 v[32:35], a[0:3], v[64:67], v[32:35]
ds_read_b64_tr_b16 a[32:33], v7 offset:41600
ds_read_b64_tr_b16 a[34:35], v7 offset:42112
s_waitcnt vmcnt(10)
v_mfma_f32_16x16x32_bf16 v[48:51], a[0:3], v[68:71], v[48:51]
ds_read_b64_tr_b16 a[36:37], v7 offset:41632
buffer_load_dwordx4 v[112:115], v4, s[16:19], s52 offen sc1
v_mfma_f32_16x16x32_bf16 v[36:39], a[4:7], v[64:67], v[36:39]
ds_read_b64_tr_b16 a[38:39], v7 offset:42144
ds_read_b64_tr_b16 a[40:41], v7 offset:41664
v_mfma_f32_16x16x32_bf16 v[52:55], a[4:7], v[68:71], v[52:55]
ds_read_b64_tr_b16 a[42:43], v7 offset:42176
v_mfma_f32_16x16x32_bf16 v[40:43], a[8:11], v[64:67], v[40:43]
ds_read_b64_tr_b16 a[44:45], v7 offset:41696
buffer_load_dwordx4 v[116:119], v4, s[16:19], s52 offen offset:1024 sc1
v_mfma_f32_16x16x32_bf16 v[56:59], a[8:11], v[68:71], v[56:59]
ds_read_b64_tr_b16 a[46:47], v7 offset:42208
ds_read_b64_tr_b16 a[48:49], v7 offset:42624
s_add_u32 s52, s52, 0x40000
v_mfma_f32_16x16x32_bf16 v[44:47], a[12:15], v[64:67], v[44:47]
ds_read_b64_tr_b16 a[50:51], v7 offset:43136
ds_read_b64_tr_b16 a[52:53], v7 offset:42656
v_mfma_f32_16x16x32_bf16 v[60:63], a[12:15], v[68:71], v[60:63]
ds_read_b64_tr_b16 a[54:55], v7 offset:43168
s_waitcnt vmcnt(11)
v_mfma_f32_16x16x32_bf16 v[32:35], a[16:19], v[72:75], v[32:35]
ds_read_b64_tr_b16 a[56:57], v7 offset:42688
buffer_load_dwordx4 v[120:123], v4, s[16:19], s53 offen sc1
s_waitcnt vmcnt(11)
v_mfma_f32_16x16x32_bf16 v[48:51], a[16:19], v[76:79], v[48:51]
ds_read_b64_tr_b16 a[58:59], v7 offset:43200
ds_read_b64_tr_b16 a[60:61], v7 offset:42720
v_mfma_f32_16x16x32_bf16 v[36:39], a[20:23], v[72:75], v[36:39]
ds_read_b64_tr_b16 a[62:63], v7 offset:43232
v_mfma_f32_16x16x32_bf16 v[52:55], a[20:23], v[76:79], v[52:55]
buffer_load_dwordx4 v[124:127], v4, s[16:19], s53 offen offset:1024 sc1
v_mfma_f32_16x16x32_bf16 v[40:43], a[24:27], v[72:75], v[40:43]
s_add_u32 s53, s53, 0x40000
v_mfma_f32_16x16x32_bf16 v[56:59], a[24:27], v[76:79], v[56:59]
v_mfma_f32_16x16x32_bf16 v[44:47], a[28:31], v[72:75], v[44:47]
v_mfma_f32_16x16x32_bf16 v[60:63], a[28:31], v[76:79], v[60:63]
s_waitcnt vmcnt(11) lgkmcnt(14)
v_mfma_f32_16x16x32_bf16 v[32:35], a[32:35], v[80:83], v[32:35]
ds_read_b64_tr_b16 a[0:1], v7 offset:49920
ds_read_b64_tr_b16 a[2:3], v7 offset:50432
s_waitcnt vmcnt(10)
v_mfma_f32_16x16x32_bf16 v[48:51], a[32:35], v[84:87], v[48:51]
buffer_load_dwordx4 v[64:67], v4, s[16:19], s52 offen sc1
s_waitcnt lgkmcnt(14)
v_mfma_f32_16x16x32_bf16 v[36:39], a[36:39], v[80:83], v[36:39]
ds_read_b64_tr_b16 a[4:5], v7 offset:49952
ds_read_b64_tr_b16 a[6:7], v7 offset:50464
v_mfma_f32_16x16x32_bf16 v[52:55], a[36:39], v[84:87], v[52:55]
ds_read_b64_tr_b16 a[8:9], v7 offset:49984
ds_read_b64_tr_b16 a[10:11], v7 offset:50496
s_waitcnt lgkmcnt(15)
v_mfma_f32_16x16x32_bf16 v[40:43], a[40:43], v[80:83], v[40:43]
buffer_load_dwordx4 v[68:71], v4, s[16:19], s52 offen offset:1024 sc1
v_mfma_f32_16x16x32_bf16 v[56:59], a[40:43], v[84:87], v[56:59]
ds_read_b64_tr_b16 a[12:13], v7 offset:50016
s_add_u32 s52, s52, 0x40000
s_waitcnt lgkmcnt(15)
v_mfma_f32_16x16x32_bf16 v[44:47], a[44:47], v[80:83], v[44:47]
ds_read_b64_tr_b16 a[14:15], v7 offset:50528
v_mfma_f32_16x16x32_bf16 v[60:63], a[44:47], v[84:87], v[60:63]
ds_read_b64_tr_b16 a[16:17], v7 offset:50944
ds_read_b64_tr_b16 a[18:19], v7 offset:51456
s_waitcnt vmcnt(11) lgkmcnt(15)
v_mfma_f32_16x16x32_bf16 v[32:35], a[48:51], v[88:91], v[32:35]
buffer_load_dwordx4 v[72:75], v4, s[16:19], s53 offen sc1
s_waitcnt vmcnt(11)
v_mfma_f32_16x16x32_bf16 v[48:51], a[48:51], v[92:95], v[48:51]
ds_read_b64_tr_b16 a[20:21], v7 offset:50976
ds_read_b64_tr_b16 a[22:23], v7 offset:51488
s_waitcnt lgkmcnt(15)
v_mfma_f32_16x16x32_bf16 v[36:39], a[52:55], v[88:91], v[36:39]
ds_read_b64_tr_b16 a[24:25], v7 offset:51008
ds_read_b64_tr_b16 a[26:27], v7 offset:51520
v_mfma_f32_16x16x32_bf16 v[52:55], a[52:55], v[92:95], v[52:55]
buffer_load_dwordx4 v[76:79], v4, s[16:19], s53 offen offset:1024 sc1
s_waitcnt lgkmcnt(15)
v_mfma_f32_16x16x32_bf16 v[40:43], a[56:59], v[88:91], v[40:43]
ds_read_b64_tr_b16 a[28:29], v7 offset:51040
s_add_u32 s53, s53, 0x40000
v_mfma_f32_16x16x32_bf16 v[56:59], a[56:59], v[92:95], v[56:59]
ds_read_b64_tr_b16 a[30:31], v7 offset:51552
s_waitcnt lgkmcnt(15)
v_mfma_f32_16x16x32_bf16 v[44:47], a[60:63], v[88:91], v[44:47]
v_mfma_f32_16x16x32_bf16 v[60:63], a[60:63], v[92:95], v[60:63]
s_waitcnt vmcnt(11) lgkmcnt(14)
v_mfma_f32_16x16x32_bf16 v[32:35], a[0:3], v[96:99], v[32:35]
ds_read_b64_tr_b16 a[32:33], v7 offset:58240
ds_read_b64_tr_b16 a[34:35], v7 offset:58752
s_waitcnt vmcnt(10)
v_mfma_f32_16x16x32_bf16 v[48:51], a[0:3], v[100:103], v[48:51]
buffer_load_dwordx4 v[80:83], v4, s[16:19], s52 offen sc1
s_waitcnt lgkmcnt(14)
v_mfma_f32_16x16x32_bf16 v[36:39], a[4:7], v[96:99], v[36:39]
ds_read_b64_tr_b16 a[36:37], v7 offset:58272
ds_read_b64_tr_b16 a[38:39], v7 offset:58784
v_mfma_f32_16x16x32_bf16 v[52:55], a[4:7], v[100:103], v[52:55]
ds_read_b64_tr_b16 a[40:41], v7 offset:58304
ds_read_b64_tr_b16 a[42:43], v7 offset:58816
s_waitcnt lgkmcnt(15)
v_mfma_f32_16x16x32_bf16 v[40:43], a[8:11], v[96:99], v[40:43]
buffer_load_dwordx4 v[84:87], v4, s[16:19], s52 offen offset:1024 sc1
v_mfma_f32_16x16x32_bf16 v[56:59], a[8:11], v[100:103], v[56:59]
ds_read_b64_tr_b16 a[44:45], v7 offset:58336
s_add_u32 s52, s52, 0x40000
s_waitcnt lgkmcnt(15)
v_mfma_f32_16x16x32_bf16 v[44:47], a[12:15], v[96:99], v[44:47]
ds_read_b64_tr_b16 a[46:47], v7 offset:58848
v_mfma_f32_16x16x32_bf16 v[60:63], a[12:15], v[100:103], v[60:63]
ds_read_b64_tr_b16 a[48:49], v7 offset:59264
ds_read_b64_tr_b16 a[50:51], v7 offset:59776
s_waitcnt vmcnt(11) lgkmcnt(15)
v_mfma_f32_16x16x32_bf16 v[32:35], a[16:19], v[104:107], v[32:35]
buffer_load_dwordx4 v[88:91], v4, s[16:19], s53 offen sc1
s_waitcnt vmcnt(11)
v_mfma_f32_16x16x32_bf16 v[48:51], a[16:19], v[108:111], v[48:51]
ds_read_b64_tr_b16 a[52:53], v7 offset:59296
ds_read_b64_tr_b16 a[54:55], v7 offset:59808
s_waitcnt lgkmcnt(15)
v_mfma_f32_16x16x32_bf16 v[36:39], a[20:23], v[104:107], v[36:39]
ds_read_b64_tr_b16 a[56:57], v7 offset:59328
ds_read_b64_tr_b16 a[58:59], v7 offset:59840
v_mfma_f32_16x16x32_bf16 v[52:55], a[20:23], v[108:111], v[52:55]
buffer_load_dwordx4 v[92:95], v4, s[16:19], s53 offen offset:1024 sc1
s_waitcnt lgkmcnt(15)
v_mfma_f32_16x16x32_bf16 v[40:43], a[24:27], v[104:107], v[40:43]
ds_read_b64_tr_b16 a[60:61], v7 offset:59360
s_add_u32 s53, s53, 0x40000
v_mfma_f32_16x16x32_bf16 v[56:59], a[24:27], v[108:111], v[56:59]
ds_read_b64_tr_b16 a[62:63], v7 offset:59872
s_waitcnt lgkmcnt(15)
v_mfma_f32_16x16x32_bf16 v[44:47], a[28:31], v[104:107], v[44:47]
v_mfma_f32_16x16x32_bf16 v[60:63], a[28:31], v[108:111], v[60:63]
s_xor_b32 s57, s57, 66560
v_add_u32 v7, s57, v8
s_waitcnt vmcnt(11) lgkmcnt(14)
v_mfma_f32_16x16x32_bf16 v[32:35], a[32:35], v[112:115], v[32:35]
ds_read_b64_tr_b16 a[0:1], v7
ds_read_b64_tr_b16 a[2:3], v7 offset:512
s_waitcnt vmcnt(10)
v_mfma_f32_16x16x32_bf16 v[48:51], a[32:35], v[116:119], v[48:51]
buffer_load_dwordx4 v[96:99], v4, s[16:19], s52 offen sc1
s_waitcnt lgkmcnt(14)
v_mfma_f32_16x16x32_bf16 v[36:39], a[36:39], v[112:115], v[36:39]
ds_read_b64_tr_b16 a[4:5], v7 offset:32
ds_read_b64_tr_b16 a[6:7], v7 offset:544
v_mfma_f32_16x16x32_bf16 v[52:55], a[36:39], v[116:119], v[52:55]
ds_read_b64_tr_b16 a[8:9], v7 offset:64
ds_read_b64_tr_b16 a[10:11], v7 offset:576
s_waitcnt lgkmcnt(15)
v_mfma_f32_16x16x32_bf16 v[40:43], a[40:43], v[112:115], v[40:43]
buffer_load_dwordx4 v[100:103], v4, s[16:19], s52 offen offset:1024 sc1
v_mfma_f32_16x16x32_bf16 v[56:59], a[40:43], v[116:119], v[56:59]
ds_read_b64_tr_b16 a[12:13], v7 offset:96
s_add_u32 s52, s52, 0x40000
s_waitcnt lgkmcnt(15)
v_mfma_f32_16x16x32_bf16 v[44:47], a[44:47], v[112:115], v[44:47]
ds_read_b64_tr_b16 a[14:15], v7 offset:608
v_mfma_f32_16x16x32_bf16 v[60:63], a[44:47], v[116:119], v[60:63]
ds_read_b64_tr_b16 a[16:17], v7 offset:1024
ds_read_b64_tr_b16 a[18:19], v7 offset:1536
s_waitcnt vmcnt(11) lgkmcnt(15)
v_mfma_f32_16x16x32_bf16 v[32:35], a[48:51], v[120:123], v[32:35]
buffer_load_dwordx4 v[104:107], v4, s[16:19], s53 offen sc1
s_waitcnt vmcnt(11)
v_mfma_f32_16x16x32_bf16 v[48:51], a[48:51], v[124:127], v[48:51]
ds_read_b64_tr_b16 a[20:21], v7 offset:1056
ds_read_b64_tr_b16 a[22:23], v7 offset:1568
s_waitcnt lgkmcnt(15)
v_mfma_f32_16x16x32_bf16 v[36:39], a[52:55], v[120:123], v[36:39]
ds_read_b64_tr_b16 a[24:25], v7 offset:1088
ds_read_b64_tr_b16 a[26:27], v7 offset:1600
v_mfma_f32_16x16x32_bf16 v[52:55], a[52:55], v[124:127], v[52:55]
buffer_load_dwordx4 v[108:111], v4, s[16:19], s53 offen offset:1024 sc1
s_waitcnt lgkmcnt(15)
v_mfma_f32_16x16x32_bf16 v[40:43], a[56:59], v[120:123], v[40:43]
ds_read_b64_tr_b16 a[28:29], v7 offset:1120
s_add_u32 s53, s53, 0x40000
v_mfma_f32_16x16x32_bf16 v[56:59], a[56:59], v[124:127], v[56:59]
ds_read_b64_tr_b16 a[30:31], v7 offset:1632
s_waitcnt lgkmcnt(15)
v_mfma_f32_16x16x32_bf16 v[44:47], a[60:63], v[120:123], v[44:47]
v_mfma_f32_16x16x32_bf16 v[60:63], a[60:63], v[124:127], v[60:63]
s_waitcnt vmcnt(11) lgkmcnt(14)
v_mfma_f32_16x16x32_bf16 v[32:35], a[0:3], v[64:67], v[32:35]
ds_read_b64_tr_b16 a[32:33], v7 offset:8320
ds_read_b64_tr_b16 a[34:35], v7 offset:8832
s_waitcnt vmcnt(10)
v_mfma_f32_16x16x32_bf16 v[48:51], a[0:3], v[68:71], v[48:51]
buffer_load_dwordx4 v[112:115], v4, s[16:19], s52 offen sc1
s_waitcnt lgkmcnt(14)
v_mfma_f32_16x16x32_bf16 v[36:39], a[4:7], v[64:67], v[36:39]
ds_read_b64_tr_b16 a[36:37], v7 offset:8352
ds_read_b64_tr_b16 a[38:39], v7 offset:8864
v_mfma_f32_16x16x32_bf16 v[52:55], a[4:7], v[68:71], v[52:55]
ds_read_b64_tr_b16 a[40:41], v7 offset:8384
ds_read_b64_tr_b16 a[42:43], v7 offset:8896
s_waitcnt lgkmcnt(15)
v_mfma_f32_16x16x32_bf16 v[40:43], a[8:11], v[64:67], v[40:43]
buffer_load_dwordx4 v[116:119], v4, s[16:19], s52 offen offset:1024 sc1
v_mfma_f32_16x16x32_bf16 v[56:59], a[8:11], v[68:71], v[56:59]
ds_read_b64_tr_b16 a[44:45], v7 offset:8416
s_add_u32 s52, s52, 0x40000
s_waitcnt lgkmcnt(15)
v_mfma_f32_16x16x32_bf16 v[44:47], a[12:15], v[64:67], v[44:47]
ds_read_b64_tr_b16 a[46:47], v7 offset:8928
v_mfma_f32_16x16x32_bf16 v[60:63], a[12:15], v[68:71], v[60:63]
ds_read_b64_tr_b16 a[48:49], v7 offset:9344
ds_read_b64_tr_b16 a[50:51], v7 offset:9856
s_waitcnt vmcnt(11) lgkmcnt(15)
v_mfma_f32_16x16x32_bf16 v[32:35], a[16:19], v[72:75], v[32:35]
buffer_load_dwordx4 v[120:123], v4, s[16:19], s53 offen sc1
s_waitcnt vmcnt(11)
v_mfma_f32_16x16x32_bf16 v[48:51], a[16:19], v[76:79], v[48:51]
ds_read_b64_tr_b16 a[52:53], v7 offset:9376
ds_read_b64_tr_b16 a[54:55], v7 offset:9888
s_waitcnt lgkmcnt(15)
v_mfma_f32_16x16x32_bf16 v[36:39], a[20:23], v[72:75], v[36:39]
ds_read_b64_tr_b16 a[56:57], v7 offset:9408
ds_read_b64_tr_b16 a[58:59], v7 offset:9920
v_mfma_f32_16x16x32_bf16 v[52:55], a[20:23], v[76:79], v[52:55]
buffer_load_dwordx4 v[124:127], v4, s[16:19], s53 offen offset:1024 sc1
s_waitcnt lgkmcnt(15)
v_mfma_f32_16x16x32_bf16 v[40:43], a[24:27], v[72:75], v[40:43]
ds_read_b64_tr_b16 a[60:61], v7 offset:9440
s_add_u32 s53, s53, 0x40000
v_mfma_f32_16x16x32_bf16 v[56:59], a[24:27], v[76:79], v[56:59]
ds_read_b64_tr_b16 a[62:63], v7 offset:9952
s_waitcnt lgkmcnt(15)
v_mfma_f32_16x16x32_bf16 v[44:47], a[28:31], v[72:75], v[44:47]
v_mfma_f32_16x16x32_bf16 v[60:63], a[28:31], v[76:79], v[60:63]
s_waitcnt vmcnt(11) lgkmcnt(14)
v_mfma_f32_16x16x32_bf16 v[32:35], a[32:35], v[80:83], v[32:35]
ds_read_b64_tr_b16 a[0:1], v7 offset:16640
ds_read_b64_tr_b16 a[2:3], v7 offset:17152
s_waitcnt vmcnt(10)
v_mfma_f32_16x16x32_bf16 v[48:51], a[32:35], v[84:87], v[48:51]
buffer_load_dwordx4 v[64:67], v4, s[16:19], s52 offen sc1
s_waitcnt lgkmcnt(14)
v_mfma_f32_16x16x32_bf16 v[36:39], a[36:39], v[80:83], v[36:39]
ds_read_b64_tr_b16 a[4:5], v7 offset:16672
ds_read_b64_tr_b16 a[6:7], v7 offset:17184
v_mfma_f32_16x16x32_bf16 v[52:55], a[36:39], v[84:87], v[52:55]
ds_read_b64_tr_b16 a[8:9], v7 offset:16704
ds_read_b64_tr_b16 a[10:11], v7 offset:17216
s_waitcnt lgkmcnt(15)
v_mfma_f32_16x16x32_bf16 v[40:43], a[40:43], v[80:83], v[40:43]
buffer_load_dwordx4 v[68:71], v4, s[16:19], s52 offen offset:1024 sc1
v_mfma_f32_16x16x32_bf16 v[56:59], a[40:43], v[84:87], v[56:59]
ds_read_b64_tr_b16 a[12:13], v7 offset:16736
s_add_u32 s52, s52, 0x40000
s_waitcnt lgkmcnt(15)
v_mfma_f32_16x16x32_bf16 v[44:47], a[44:47], v[80:83], v[44:47]
ds_read_b64_tr_b16 a[14:15], v7 offset:17248
v_mfma_f32_16x16x32_bf16 v[60:63], a[44:47], v[84:87], v[60:63]
ds_read_b64_tr_b16 a[16:17], v7 offset:17664
ds_read_b64_tr_b16 a[18:19], v7 offset:18176
s_waitcnt vmcnt(11) lgkmcnt(15)
v_mfma_f32_16x16x32_bf16 v[32:35], a[48:51], v[88:91], v[32:35]
buffer_load_dwordx4 v[72:75], v4, s[16:19], s53 offen sc1
s_waitcnt vmcnt(11)
v_mfma_f32_16x16x32_bf16 v[48:51], a[48:51], v[92:95], v[48:51]
ds_read_b64_tr_b16 a[20:21], v7 offset:17696
ds_read_b64_tr_b16 a[22:23], v7 offset:18208
s_waitcnt lgkmcnt(15)
v_mfma_f32_16x16x32_bf16 v[36:39], a[52:55], v[88:91], v[36:39]
ds_read_b64_tr_b16 a[24:25], v7 offset:17728
ds_read_b64_tr_b16 a[26:27], v7 offset:18240
v_mfma_f32_16x16x32_bf16 v[52:55], a[52:55], v[92:95], v[52:55]
buffer_load_dwordx4 v[76:79], v4, s[16:19], s53 offen offset:1024 sc1
s_waitcnt lgkmcnt(15)
v_mfma_f32_16x16x32_bf16 v[40:43], a[56:59], v[88:91], v[40:43]
ds_read_b64_tr_b16 a[28:29], v7 offset:17760
s_add_u32 s53, s53, 0x40000
v_mfma_f32_16x16x32_bf16 v[56:59], a[56:59], v[92:95], v[56:59]
ds_read_b64_tr_b16 a[30:31], v7 offset:18272
s_waitcnt lgkmcnt(15)
v_mfma_f32_16x16x32_bf16 v[44:47], a[60:63], v[88:91], v[44:47]
v_mfma_f32_16x16x32_bf16 v[60:63], a[60:63], v[92:95], v[60:63]
s_waitcnt vmcnt(11) lgkmcnt(14)
v_mfma_f32_16x16x32_bf16 v[32:35], a[0:3], v[96:99], v[32:35]
ds_read_b64_tr_b16 a[32:33], v7 offset:24960
ds_read_b64_tr_b16 a[34:35], v7 offset:25472
s_waitcnt vmcnt(10)
v_mfma_f32_16x16x32_bf16 v[48:51], a[0:3], v[100:103], v[48:51]
buffer_load_dwordx4 v[80:83], v4, s[16:19], s52 offen sc1
s_waitcnt lgkmcnt(14)
v_mfma_f32_16x16x32_bf16 v[36:39], a[4:7], v[96:99], v[36:39]
ds_read_b64_tr_b16 a[36:37], v7 offset:24992
ds_read_b64_tr_b16 a[38:39], v7 offset:25504
v_mfma_f32_16x16x32_bf16 v[52:55], a[4:7], v[100:103], v[52:55]
ds_read_b64_tr_b16 a[40:41], v7 offset:25024
ds_read_b64_tr_b16 a[42:43], v7 offset:25536
s_waitcnt lgkmcnt(15)
v_mfma_f32_16x16x32_bf16 v[40:43], a[8:11], v[96:99], v[40:43]
buffer_load_dwordx4 v[84:87], v4, s[16:19], s52 offen offset:1024 sc1
v_mfma_f32_16x16x32_bf16 v[56:59], a[8:11], v[100:103], v[56:59]
ds_read_b64_tr_b16 a[44:45], v7 offset:25056
s_add_u32 s52, s52, 0x40000
s_waitcnt lgkmcnt(15)
v_mfma_f32_16x16x32_bf16 v[44:47], a[12:15], v[96:99], v[44:47]
ds_read_b64_tr_b16 a[46:47], v7 offset:25568
v_mfma_f32_16x16x32_bf16 v[60:63], a[12:15], v[100:103], v[60:63]
ds_read_b64_tr_b16 a[48:49], v7 offset:25984
ds_read_b64_tr_b16 a[50:51], v7 offset:26496
s_waitcnt vmcnt(11) lgkmcnt(15)
v_mfma_f32_16x16x32_bf16 v[32:35], a[16:19], v[104:107], v[32:35]
buffer_load_dwordx4 v[88:91], v4, s[16:19], s53 offen sc1
s_waitcnt vmcnt(11)
v_mfma_f32_16x16x32_bf16 v[48:51], a[16:19], v[108:111], v[48:51]
ds_read_b64_tr_b16 a[52:53], v7 offset:26016
ds_read_b64_tr_b16 a[54:55], v7 offset:26528
s_waitcnt lgkmcnt(15)
v_mfma_f32_16x16x32_bf16 v[36:39], a[20:23], v[104:107], v[36:39]
ds_read_b64_tr_b16 a[56:57], v7 offset:26048
ds_read_b64_tr_b16 a[58:59], v7 offset:26560
v_mfma_f32_16x16x32_bf16 v[52:55], a[20:23], v[108:111], v[52:55]
buffer_load_dwordx4 v[92:95], v4, s[16:19], s53 offen offset:1024 sc1
s_waitcnt lgkmcnt(15)
v_mfma_f32_16x16x32_bf16 v[40:43], a[24:27], v[104:107], v[40:43]
ds_read_b64_tr_b16 a[60:61], v7 offset:26080
s_add_u32 s53, s53, 0x40000
v_mfma_f32_16x16x32_bf16 v[56:59], a[24:27], v[108:111], v[56:59]
ds_read_b64_tr_b16 a[62:63], v7 offset:26592
s_waitcnt lgkmcnt(15)
v_mfma_f32_16x16x32_bf16 v[44:47], a[28:31], v[104:107], v[44:47]
v_mfma_f32_16x16x32_bf16 v[60:63], a[28:31], v[108:111], v[60:63]
s_waitcnt lgkmcnt(0)
s_barrier
s_waitcnt vmcnt(11)
v_mfma_f32_16x16x32_bf16 v[32:35], a[32:35], v[112:115], v[32:35]
ds_read_b64_tr_b16 a[0:1], v7 offset:33280
ds_read_b64_tr_b16 a[2:3], v7 offset:33792
s_waitcnt vmcnt(10)
v_mfma_f32_16x16x32_bf16 v[48:51], a[32:35], v[116:119], v[48:51]
ds_read_b64_tr_b16 a[4:5], v7 offset:33312
buffer_load_dwordx4 v[96:99], v4, s[16:19], s52 offen sc1
v_mfma_f32_16x16x32_bf16 v[36:39], a[36:39], v[112:115], v[36:39]
ds_read_b64_tr_b16 a[6:7], v7 offset:33824
ds_read_b64_tr_b16 a[8:9], v7 offset:33344
v_mfma_f32_16x16x32_bf16 v[52:55], a[36:39], v[116:119], v[52:55]
ds_read_b64_tr_b16 a[10:11], v7 offset:33856
v_mfma_f32_16x16x32_bf16 v[40:43], a[40:43], v[112:115], v[40:43]
ds_read_b64_tr_b16 a[12:13], v7 offset:33376
buffer_load_dwordx4 v[100:103], v4, s[16:19], s52 offen offset:1024 sc1
v_mfma_f32_16x16x32_bf16 v[56:59], a[40:43], v[116:119], v[56:59]
ds_read_b64_tr_b16 a[14:15], v7 offset:33888
ds_read_b64_tr_b16 a[16:17], v7 offset:34304
s_add_u32 s52, s52, 0x40000
v_mfma_f32_16x16x32_bf16 v[44:47], a[44:47], v[112:115], v[44:47]
ds_read_b64_tr_b16 a[18:19], v7 offset:34816
ds_read_b64_tr_b16 a[20:21], v7 offset:34336
v_mfma_f32_16x16x32_bf16 v[60:63], a[44:47], v[116:119], v[60:63]
ds_read_b64_tr_b16 a[22:23], v7 offset:34848
s_waitcnt vmcnt(11)
v_mfma_f32_16x16x32_bf16 v[32:35], a[48:51], v[120:123], v[32:35]
ds_read_b64_tr_b16 a[24:25], v7 offset:34368
buffer_load_dwordx4 v[104:107], v4, s[16:19], s53 offen sc1
s_waitcnt vmcnt(11)
v_mfma_f32_16x16x32_bf16 v[48:51], a[48:51], v[124:127], v[48:51]
ds_read_b64_tr_b16 a[26:27], v7 offset:34880
ds_read_b64_tr_b16 a[28:29], v7 offset:34400
v_mfma_f32_16x16x32_bf16 v[36:39], a[52:55], v[120:123], v[36:39]
ds_read_b64_tr_b16 a[30:31], v7 offset:34912
v_mfma_f32_16x16x32_bf16 v[52:55], a[52:55], v[124:127], v[52:55]
buffer_load_dwordx4 v[108:111], v4, s[16:19], s53 offen offset:1024 sc1
v_mfma_f32_16x16x32_bf16 v[40:43], a[56:59], v[120:123], v[40:43]
s_add_u32 s53, s53, 0x40000
v_mfma_f32_16x16x32_bf16 v[56:59], a[56:59], v[124:127], v[56:59]
v_mfma_f32_16x16x32_bf16 v[44:47], a[60:63], v[120:123], v[44:47]
v_mfma_f32_16x16x32_bf16 v[60:63], a[60:63], v[124:127], v[60:63]
s_waitcnt vmcnt(11) lgkmcnt(14)
v_mfma_f32_16x16x32_bf16 v[32:35], a[0:3], v[64:67], v[32:35]
ds_read_b64_tr_b16 a[32:33], v7 offset:41600
ds_read_b64_tr_b16 a[34:35], v7 offset:42112
s_waitcnt vmcnt(10)
v_mfma_f32_16x16x32_bf16 v[48:51], a[0:3], v[68:71], v[48:51]
buffer_load_dwordx4 v[112:115], v4, s[16:19], s52 offen sc1
s_waitcnt lgkmcnt(14)
v_mfma_f32_16x16x32_bf16 v[36:39], a[4:7], v[64:67], v[36:39]
ds_read_b64_tr_b16 a[36:37], v7 offset:41632
ds_read_b64_tr_b16 a[38:39], v7 offset:42144
.Lpad32:
s_cbranch_execz .Lnopoll58r
v_mfma_f32_16x16x32_bf16 v[52:55], a[4:7], v[68:71], v[52:55]
ds_read_b64_tr_b16 a[40:41], v7 offset:41664
ds_read_b64_tr_b16 a[42:43], v7 offset:42176
s_waitcnt lgkmcnt(15)
v_mfma_f32_16x16x32_bf16 v[40:43], a[8:11], v[64:67], v[40:43]
buffer_load_dwordx4 v[116:119], v4, s[16:19], s52 offen offset:1024 sc1
v_mfma_f32_16x16x32_bf16 v[56:59], a[8:11], v[68:71], v[56:59]
ds_read_b64_tr_b16 a[44:45], v7 offset:41696
s_add_u32 s52, s52, 0x40000
s_waitcnt lgkmcnt(15)
v_mfma_f32_16x16x32_bf16 v[44:47], a[12:15], v[64:67], v[44:47]
ds_read_b64_tr_b16 a[46:47], v7 offset:42208
v_mfma_f32_16x16x32_bf16 v[60:63], a[12:15], v[68:71], v[60:63]
ds_read_b64_tr_b16 a[48:49], v7 offset:42624
ds_read_b64_tr_b16 a[50:51], v7 offset:43136
s_waitcnt vmcnt(11) lgkmcnt(15)
v_mfma_f32_16x16x32_bf16 v[32:35], a[16:19], v[72:75], v[32:35]
buffer_load_dwordx4 v[120:123], v4, s[16:19], s53 offen sc1
s_waitcnt vmcnt(11)
v_mfma_f32_16x16x32_bf16 v[48:51], a[16:19], v[76:79], v[48:51]
ds_read_b64_tr_b16 a[52:53], v7 offset:42656
ds_read_b64_tr_b16 a[54:55], v7 offset:43168
s_waitcnt lgkmcnt(15)
v_mfma_f32_16x16x32_bf16 v[36:39], a[20:23], v[72:75], v[36:39]
ds_read_b64_tr_b16 a[56:57], v7 offset:42688
ds_read_b64_tr_b16 a[58:59], v7 offset:43200
v_mfma_f32_16x16x32_bf16 v[52:55], a[20:23], v[76:79], v[52:55]
buffer_load_dwordx4 v[124:127], v4, s[16:19], s53 offen offset:1024 sc1
s_waitcnt lgkmcnt(15)
v_mfma_f32_16x16x32_bf16 v[40:43], a[24:27], v[72:75], v[40:43]
ds_read_b64_tr_b16 a[60:61], v7 offset:42720
s_add_u32 s53, s53, 0x40000
v_mfma_f32_16x16x32_bf16 v[56:59], a[24:27], v[76:79], v[56:59]
ds_read_b64_tr_b16 a[62:63], v7 offset:43232
s_waitcnt lgkmcnt(15)
v_mfma_f32_16x16x32_bf16 v[44:47], a[28:31], v[72:75], v[44:47]
v_mfma_f32_16x16x32_bf16 v[60:63], a[28:31], v[76:79], v[60:63]
s_waitcnt vmcnt(11) lgkmcnt(14)
v_mfma_f32_16x16x32_bf16 v[32:35], a[32:35], v[80:83], v[32:35]
ds_read_b64_tr_b16 a[0:1], v7 offset:49920
ds_read_b64_tr_b16 a[2:3], v7 offset:50432
s_waitcnt vmcnt(10)
v_mfma_f32_16x16x32_bf16 v[48:51], a[32:35], v[84:87], v[48:51]
ds_read_b64_tr_b16 a[4:5], v7 offset:49952
s_waitcnt lgkmcnt(15)
v_mfma_f32_16x16x32_bf16 v[36:39], a[36:39], v[80:83], v[36:39]
ds_read_b64_tr_b16 a[6:7], v7 offset:50464
v_mfma_f32_16x16x32_bf16 v[52:55], a[36:39], v[84:87], v[52:55]
ds_read_b64_tr_b16 a[8:9], v7 offset:49984
s_waitcnt lgkmcnt(15)
v_mfma_f32_16x16x32_bf16 v[40:43], a[40:43], v[80:83], v[40:43]
ds_read_b64_tr_b16 a[10:11], v7 offset:50496
v_mfma_f32_16x16x32_bf16 v[56:59], a[40:43], v[84:87], v[56:59]
ds_read_b64_tr_b16 a[12:13], v7 offset:50016
s_waitcnt lgkmcnt(15)
v_mfma_f32_16x16x32_bf16 v[44:47], a[44:47], v[80:83], v[44:47]
ds_read_b64_tr_b16 a[14:15], v7 offset:50528
v_mfma_f32_16x16x32_bf16 v[60:63], a[44:47], v[84:87], v[60:63]
ds_read_b64_tr_b16 a[16:17], v7 offset:50944
ds_read_b64_tr_b16 a[18:19], v7 offset:51456
s_waitcnt vmcnt(9) lgkmcnt(15)
v_mfma_f32_16x16x32_bf16 v[32:35], a[48:51], v[88:91], v[32:35]
ds_read_b64_tr_b16 a[20:21], v7 offset:50976
s_waitcnt vmcnt(8)
v_mfma_f32_16x16x32_bf16 v[48:51], a[48:51], v[92:95], v[48:51]
ds_read_b64_tr_b16 a[22:23], v7 offset:51488
s_waitcnt lgkmcnt(15)
v_mfma_f32_16x16x32_bf16 v[36:39], a[52:55], v[88:91], v[36:39]
ds_read_b64_tr_b16 a[24:25], v7 offset:51008
v_mfma_f32_16x16x32_bf16 v[52:55], a[52:55], v[92:95], v[52:55]
ds_read_b64_tr_b16 a[26:27], v7 offset:51520
s_waitcnt lgkmcnt(15)
v_mfma_f32_16x16x32_bf16 v[40:43], a[56:59], v[88:91], v[40:43]
ds_read_b64_tr_b16 a[28:29], v7 offset:51040
v_mfma_f32_16x16x32_bf16 v[56:59], a[56:59], v[92:95], v[56:59]
ds_read_b64_tr_b16 a[30:31], v7 offset:51552
s_waitcnt lgkmcnt(15)
v_mfma_f32_16x16x32_bf16 v[44:47], a[60:63], v[88:91], v[44:47]
v_mfma_f32_16x16x32_bf16 v[60:63], a[60:63], v[92:95], v[60:63]
s_waitcnt vmcnt(7) lgkmcnt(14)
v_mfma_f32_16x16x32_bf16 v[32:35], a[0:3], v[96:99], v[32:35]
ds_read_b64_tr_b16 a[32:33], v7 offset:58240
ds_read_b64_tr_b16 a[34:35], v7 offset:58752
s_waitcnt vmcnt(6)
v_mfma_f32_16x16x32_bf16 v[48:51], a[0:3], v[100:103], v[48:51]
ds_read_b64_tr_b16 a[36:37], v7 offset:58272
s_waitcnt lgkmcnt(15)
v_mfma_f32_16x16x32_bf16 v[36:39], a[4:7], v[96:99], v[36:39]
ds_read_b64_tr_b16 a[38:39], v7 offset:58784
v_mfma_f32_16x16x32_bf16 v[52:55], a[4:7], v[100:103], v[52:55]
ds_read_b64_tr_b16 a[40:41], v7 offset:58304
s_waitcnt lgkmcnt(15)
v_mfma_f32_16x16x32_bf16 v[40:43], a[8:11], v[96:99], v[40:43]
ds_read_b64_tr_b16 a[42:43], v7 offset:58816
v_mfma_f32_16x16x32_bf16 v[56:59], a[8:11], v[100:103], v[56:59]
ds_read_b64_tr_b16 a[44:45], v7 offset:58336
s_waitcnt lgkmcnt(15)
v_mfma_f32_16x16x32_bf16 v[44:47], a[12:15], v[96:99], v[44:47]
ds_read_b64_tr_b16 a[46:47], v7 offset:58848
v_mfma_f32_16x16x32_bf16 v[60:63], a[12:15], v[100:103], v[60:63]
ds_read_b64_tr_b16 a[48:49], v7 offset:59264
ds_read_b64_tr_b16 a[50:51], v7 offset:59776
s_waitcnt vmcnt(5) lgkmcnt(15)
v_mfma_f32_16x16x32_bf16 v[32:35], a[16:19], v[104:107], v[32:35]
ds_read_b64_tr_b16 a[52:53], v7 offset:59296
s_waitcnt vmcnt(4)
v_mfma_f32_16x16x32_bf16 v[48:51], a[16:19], v[108:111], v[48:51]
ds_read_b64_tr_b16 a[54:55], v7 offset:59808
s_waitcnt lgkmcnt(15)
v_mfma_f32_16x16x32_bf16 v[36:39], a[20:23], v[104:107], v[36:39]
ds_read_b64_tr_b16 a[56:57], v7 offset:59328
v_mfma_f32_16x16x32_bf16 v[52:55], a[20:23], v[108:111], v[52:55]
ds_read_b64_tr_b16 a[58:59], v7 offset:59840
s_waitcnt lgkmcnt(15)
v_mfma_f32_16x16x32_bf16 v[40:43], a[24:27], v[104:107], v[40:43]
ds_read_b64_tr_b16 a[60:61], v7 offset:59360
v_mfma_f32_16x16x32_bf16 v[56:59], a[24:27], v[108:111], v[56:59]
ds_read_b64_tr_b16 a[62:63], v7 offset:59872
s_waitcnt lgkmcnt(15)
v_mfma_f32_16x16x32_bf16 v[44:47], a[28:31], v[104:107], v[44:47]
v_mfma_f32_16x16x32_bf16 v[60:63], a[28:31], v[108:111], v[60:63]
s_waitcnt vmcnt(3) lgkmcnt(14)
v_mfma_f32_16x16x32_bf16 v[32:35], a[32:35], v[112:115], v[32:35]
s_waitcnt vmcnt(2)
v_mfma_f32_16x16x32_bf16 v[48:51], a[32:35], v[116:119], v[48:51]
s_waitcnt lgkmcnt(12)
v_mfma_f32_16x16x32_bf16 v[36:39], a[36:39], v[112:115], v[36:39]
v_mfma_f32_16x16x32_bf16 v[52:55], a[36:39], v[116:119], v[52:55]
s_waitcnt lgkmcnt(10)
v_mfma_f32_16x16x32_bf16 v[40:43], a[40:43], v[112:115], v[40:43]
v_mfma_f32_16x16x32_bf16 v[56:59], a[40:43], v[116:119], v[56:59]
s_waitcnt lgkmcnt(8)
v_mfma_f32_16x16x32_bf16 v[44:47], a[44:47], v[112:115], v[44:47]
v_mfma_f32_16x16x32_bf16 v[60:63], a[44:47], v[116:119], v[60:63]
s_waitcnt vmcnt(1) lgkmcnt(6)
v_mfma_f32_16x16x32_bf16 v[32:35], a[48:51], v[120:123], v[32:35]
s_waitcnt vmcnt(0)
v_mfma_f32_16x16x32_bf16 v[48:51], a[48:51], v[124:127], v[48:51]
s_waitcnt lgkmcnt(4)
v_mfma_f32_16x16x32_bf16 v[36:39], a[52:55], v[120:123], v[36:39]
s_nop 3
v_cvt_pk_bf16_f32 v128, v32, v33
v_cvt_pk_bf16_f32 v129, v34, v35
v_mfma_f32_16x16x32_bf16 v[52:55], a[52:55], v[124:127], v[52:55]
v_cvt_pk_bf16_f32 v136, v48, v49
v_cvt_pk_bf16_f32 v137, v50, v51
s_waitcnt lgkmcnt(2)
v_mfma_f32_16x16x32_bf16 v[40:43], a[56:59], v[120:123], v[40:43]
v_cvt_pk_bf16_f32 v130, v36, v37
v_cvt_pk_bf16_f32 v131, v38, v39
v_mfma_f32_16x16x32_bf16 v[56:59], a[56:59], v[124:127], v[56:59]
v_permlane16_swap_b32 v128, v130
s_waitcnt lgkmcnt(0)
v_mfma_f32_16x16x32_bf16 v[44:47], a[60:63], v[120:123], v[44:47]
v_permlane16_swap_b32 v129, v131
v_mfma_f32_16x16x32_bf16 v[60:63], a[60:63], v[124:127], v[60:63]
buffer_store_dwordx4 v[128:131], v160, s[36:39], 0 offen sc1
v_cvt_pk_bf16_f32 v132, v40, v41
v_cvt_pk_bf16_f32 v133, v42, v43
s_nop 2
v_cvt_pk_bf16_f32 v134, v44, v45
v_cvt_pk_bf16_f32 v135, v46, v47
v_cvt_pk_bf16_f32 v138, v52, v53
v_permlane16_swap_b32 v132, v134
v_permlane16_swap_b32 v133, v135
v_cvt_pk_bf16_f32 v139, v54, v55
v_permlane16_swap_b32 v136, v138
s_nop 0
v_permlane16_swap_b32 v137, v139
v_cvt_pk_bf16_f32 v140, v56, v57
buffer_store_dwordx4 v[132:135], v160, s[36:39], 0 offen offset:64 sc1
v_cvt_pk_bf16_f32 v141, v58, v59
v_cvt_pk_bf16_f32 v142, v60, v61
v_cvt_pk_bf16_f32 v143, v62, v63
s_nop 0
v_permlane16_swap_b32 v140, v142
v_permlane16_swap_b32 v141, v143
buffer_store_dwordx4 v[136:139], v161, s[36:39], 0 offen sc1
buffer_store_dwordx4 v[140:143], v161, s[36:39], 0 offen offset:64 sc1
s_nop 1
.Lend:
s_endpgm
.section .rodata,"a"
.p2align 6
.amdhsa_kernel interleave_layers__sliding_local_dilated__swiglu_ffn__prompt_kernel
  .amdhsa_next_free_vgpr 512
  .amdhsa_next_free_sgpr 102
  .amdhsa_accum_offset 256
  .amdhsa_group_segment_fixed_size 0
  .amdhsa_kernarg_size 80
  .amdhsa_user_sgpr_count 2
  .amdhsa_user_sgpr_kernarg_segment_ptr 1
  .amdhsa_system_sgpr_workgroup_id_x 1
  .amdhsa_float_denorm_mode_32 3
.end_amdhsa_kernel
```

```asm
; @launch grid=(256,1,1) block=(256,1,1) lds=162560
.amdgcn_target "amdgcn-amd-amdhsa--gfx950"
.text
.globl interleave_layers__sliding_local_dilated__swiglu_ffn__prompt_kernel
.p2align 8
.type interleave_layers__sliding_local_dilated__swiglu_ffn__prompt_kernel,@function
interleave_layers__sliding_local_dilated__swiglu_ffn__prompt_kernel:
s_load_dwordx4 s[68:71], s[0:1], 0
s_load_dwordx2 s[72:73], s[0:1], 16
s_load_dwordx8 s[76:83], s[0:1], 32
s_load_dwordx4 s[84:87], s[0:1], 64
s_cmp_lt_u32 s2, 256
s_cbranch_scc1 .Lgo
s_endpgm
.p2align 12
.Lgo:
v_lshrrev_b32 v2, 6, v0
v_and_b32 v1, 63, v0
v_readfirstlane_b32 s3, v2
s_and_b32 s4, s2, 7
s_lshr_b32 s5, s2, 3
s_lshr_b32 s6, s4, 1
s_lshl_b32 s6, s6, 2
s_and_b32 s62, s5, 3
s_add_u32 s6, s6, s62
s_and_b32 s7, s4, 1
s_lshl_b32 s7, s7, 3
s_lshr_b32 s62, s5, 2
s_add_u32 s7, s7, s62
s_lshr_b32 s8, s4, 2
s_lshl_b32 s8, s8, 3
s_and_b32 s62, s5, 7
s_add_u32 s8, s8, s62
s_and_b32 s9, s4, 3
s_lshl_b32 s9, s9, 2
s_lshr_b32 s62, s5, 3
s_add_u32 s9, s9, s62
s_lshr_b32 s62, s6, 1
s_lshl_b32 s62, s62, 8
s_and_b32 s63, s6, 1
s_add_u32 s62, s62, s63
s_lshl_b32 s63, s3, 6
s_add_u32 s62, s62, s63
s_lshl_b32 s62, s62, 11
s_lshl_b32 s63, s7, 7
s_add_u32 s62, s62, s63
v_and_b32 v160, 15, v1
v_lshlrev_b32 v160, 12, v160
v_bfe_u32 v2, v1, 4, 1
v_lshl_add_u32 v160, v2, 5, v160
v_bfe_u32 v2, v1, 5, 1
v_lshl_add_u32 v160, v2, 4, v160
v_add_u32 v160, s62, v160
v_add_u32 v161, 0x10000, v160
s_sub_u32 s64, s3, 1
s_max_i32 s64, s64, 0
s_lshl_b32 s64, s64, 11
s_lshl_b32 s66, s9, 7
s_add_u32 s66, s66, s64
s_cmp_eq_u32 s3, 1
s_cselect_b32 s66, 8388608, s66
s_mul_i32 s65, s8, 122880
s_add_u32 s65, s65, s66
v_lshrrev_b32 v9, 1, v1
v_min_u32 v9, 19, v9
v_mul_u32_u24 v9, 6144, v9
s_waitcnt lgkmcnt(0)
s_mov_b32 s36, s68
s_mov_b32 s37, s69
s_mov_b32 s38, 4194304
s_mov_b32 s39, 0x20000
s_mov_b32 s16, s86
s_mov_b32 s17, s87
s_mov_b32 s18, 268435456
s_mov_b32 s19, 0x20000
s_lshl_b32 s67, s2, 2
s_add_u32 s67, s67, s3
v_mov_b32 v28, 0
s_cmp_lg_u32 s67, 3
s_cbranch_scc1 .Lz1
v_lshlrev_b32 v27, 4, v1
v_mov_b64 v[68:69], 0
v_mov_b64 v[70:71], 0
s_mov_b32 s62, 30408704
buffer_store_dwordx4 v[68:71], v27, s[16:19], s62 offen sc1
buffer_store_dwordx4 v[68:71], v27, s[16:19], s62 offen offset:1024 sc1
buffer_store_dwordx4 v[68:71], v27, s[16:19], s62 offen offset:2048 sc1
buffer_store_dwordx4 v[68:71], v27, s[16:19], s62 offen offset:3072 sc1
s_mov_b32 s62, 30412800
buffer_store_dwordx4 v[68:71], v27, s[16:19], s62 offen sc1
buffer_store_dwordx4 v[68:71], v27, s[16:19], s62 offen offset:1024 sc1
buffer_store_dwordx4 v[68:71], v27, s[16:19], s62 offen offset:2048 sc1
buffer_store_dwordx4 v[68:71], v27, s[16:19], s62 offen offset:3072 sc1
s_mov_b32 s62, 30416896
buffer_store_dwordx4 v[68:71], v27, s[16:19], s62 offen sc1
buffer_store_dwordx4 v[68:71], v27, s[16:19], s62 offen offset:1024 sc1
buffer_store_dwordx4 v[68:71], v27, s[16:19], s62 offen offset:2048 sc1
buffer_store_dwordx4 v[68:71], v27, s[16:19], s62 offen offset:3072 sc1
s_mov_b32 s62, 30420992
buffer_store_dwordx4 v[68:71], v27, s[16:19], s62 offen sc1
buffer_store_dwordx4 v[68:71], v27, s[16:19], s62 offen offset:1024 sc1
buffer_store_dwordx4 v[68:71], v27, s[16:19], s62 offen offset:2048 sc1
buffer_store_dwordx4 v[68:71], v27, s[16:19], s62 offen offset:3072 sc1
v_mov_b32 v64, 0x3f803f80
v_mov_b32 v65, 0x3f803f80
v_mov_b32 v66, 0x3f803f80
v_mov_b32 v67, 0x3f803f80
v_lshrrev_b32 v27, 3, v1
v_lshlrev_b32 v27, 17, v27
v_and_b32 v2, 7, v1
v_lshl_add_u32 v27, v2, 4, v27
s_mov_b32 s62, 134217728
buffer_store_dwordx4 v[64:67], v27, s[16:19], s62 offen sc1
s_mov_b32 s62, 135266304
buffer_store_dwordx4 v[64:67], v27, s[16:19], s62 offen sc1
s_mov_b32 s62, 136314880
buffer_store_dwordx4 v[64:67], v27, s[16:19], s62 offen sc1
s_mov_b32 s62, 137363456
buffer_store_dwordx4 v[64:67], v27, s[16:19], s62 offen sc1
.Lz1:
buffer_load_dwordx4 v[128:131], v160, s[36:39], 0 offen nt
buffer_load_dwordx4 v[132:135], v160, s[36:39], 0 offen offset:64 nt
buffer_load_dwordx4 v[136:139], v161, s[36:39], 0 offen nt
buffer_load_dwordx4 v[140:143], v161, s[36:39], 0 offen offset:64 nt
s_mov_b32 s20, s70
s_mov_b32 s21, s71
s_mov_b32 s22, 6291456
s_mov_b32 s23, 0x20000
buffer_load_dword v30, v9, s[20:23], s65 offen
s_mov_b32 s40, s84
s_mov_b32 s41, s85
s_mov_b32 s42, 256
s_mov_b32 s43, 0x20000
v_mov_b32 v29, 1
s_cmp_lg_u32 s67, 3
s_cbranch_scc1 .Lz2
s_waitcnt vmcnt(5)
s_mov_b64 exec, 1
buffer_store_dword v29, v28, s[40:43], 0 offen sc1
s_mov_b64 exec, -1
.Lz2:
s_getpc_b64 s[62:63]
.Lpc:
s_lshl_b32 s64, s5, 12
v_lshrrev_b32 v31, 3, v0
v_lshl_add_u32 v31, v31, 7, s64
v_min_u32 v31, .Lend-.Lpc, v31
global_load_dword v31, v31, s[62:63]
s_mov_b32 s24, s72
s_mov_b32 s25, s73
s_mov_b32 s26, 2097152
s_mov_b32 s27, 0x20000
s_mov_b32 s28, s80
s_mov_b32 s29, s81
s_mov_b32 s30, 7340032
s_mov_b32 s31, 0x20000
s_cmp_lt_u32 s3, 2
s_cselect_b32 s32, s76, s78
s_cselect_b32 s33, s77, s79
s_mov_b32 s34, 7340032
s_mov_b32 s35, 0x20000
s_mov_b32 s36, s82
s_mov_b32 s37, s83
s_lshr_b32 s10, s4, 2
s_lshl_b32 s10, s10, 2
s_and_b32 s62, s5, 3
s_add_u32 s10, s10, s62
s_and_b32 s11, s4, 3
s_lshl_b32 s11, s11, 3
s_lshr_b32 s62, s5, 2
s_add_u32 s11, s11, s62
s_and_b32 s12, s11, 1
s_lshr_b32 s13, s11, 1
s_mul_i32 s51, s13, 448
s_mul_i32 s62, s12, 192
s_add_u32 s51, s51, s62
s_and_b32 s48, s3, 1
s_lshr_b32 s49, s3, 1
s_lshl_b32 s50, s8, 3
s_sub_u32 s50, s50, 9
s_cmp_lt_u32 s8, 2
s_cselect_b32 s50, 7, s50
s_mul_i32 s62, s8, 393216
s_add_u32 s62, s62, s66
v_mul_u32_u24 v14, 6144, v1
v_add_u32 v14, s62, v14
s_lshl_b32 s62, s8, 4
s_add_u32 s62, s62, s9
s_lshl_b32 s62, s62, 2
s_add_u32 s62, s62, s3
s_mul_i32 s62, s62, 6656
v_min_u32 v15, 51, v1
v_lshl_add_u32 v15, v15, 7, s62
s_sub_u32 s63, s8, 4
s_lshl_b32 s64, s8, 1
s_add_u32 s64, s64, 1
s_cmp_lt_u32 s8, 5
s_cselect_b64 vcc, -1, 0
s_cselect_b32 s46, s64, s63
v_cndmask_b32 v14, v14, v15, vcc
s_lshl_b32 s62, s2, 1
s_add_u32 s62, s62, s48
s_mul_i32 s62, s62, 5376
v_min_u32 v16, 41, v1
v_lshl_add_u32 v16, v16, 7, s62
s_cmp_lt_u32 s46, 6
s_cselect_b64 vcc, -1, 0
v_cndmask_b32 v15, v14, v16, vcc
v_cndmask_b32 v14, v16, v14, vcc
v_bfe_u32 v18, v1, 3, 1
v_lshrrev_b32 v2, 4, v1
v_lshl_add_u32 v18, v2, 3, v18
s_lshl_b32 s62, s3, 1
v_add_u32 v18, s62, v18
v_mul_u32_u24 v18, 6144, v18
v_and_b32 v2, 7, v1
v_lshl_add_u32 v18, v2, 4, v18
s_lshl_b32 s62, s9, 7
v_add_u32 v18, s62, v18
v_add_u32 v19, 1024, v18
v_add_u32 v20, 2048, v18
s_mul_i32 s59, s3, 3104
s_mov_b32 s58, 0
s_lshl_b32 s62, s6, 13
s_lshl_b32 s63, s3, 11
s_add_u32 s62, s62, s63
v_lshl_add_u32 v4, v1, 4, s62
v_lshrrev_b32 v2, 3, v1
v_cmp_eq_u32 vcc, 3, v2
v_add_u32 v2, 67108480, v4
s_nop 0
v_cndmask_b32 v4, v4, v2, vcc
s_lshl_b32 s64, s6, 14
s_lshl_b32 s65, s49, 13
s_add_u32 s64, s64, s65
s_lshl_b32 s65, s7, 9
s_add_u32 s64, s64, s65
s_lshl_b32 s65, s48, 8
s_add_u32 s64, s64, s65
s_add_u32 s64, s64, 29360128
v_and_b32 v152, 31, v1
v_lshlrev_b32 v152, 3, v152
v_lshrrev_b32 v153, 5, v1
v_lshl_add_u32 v152, v153, 28, v152
s_lshl_b32 s62, s7, 18
s_add_u32 s62, s62, 0
s_add_u32 s63, s62, 0x20000
s_waitcnt vmcnt(5)
v_permlane16_swap_b32 v128, v130
v_permlane16_swap_b32 v129, v131
s_waitcnt vmcnt(4)
v_permlane16_swap_b32 v132, v134
v_permlane16_swap_b32 v133, v135
s_waitcnt vmcnt(3)
v_permlane16_swap_b32 v136, v138
v_permlane16_swap_b32 v137, v139
s_waitcnt vmcnt(2)
v_permlane16_swap_b32 v140, v142
v_permlane16_swap_b32 v141, v143
buffer_store_dwordx4 v[128:131], v4, s[16:19], s62 offen sc1
buffer_store_dwordx4 v[132:135], v4, s[16:19], s63 offen sc1
buffer_store_dwordx4 v[136:139], v4, s[16:19], s62 offen offset:1024 sc1
buffer_store_dwordx4 v[140:143], v4, s[16:19], s63 offen offset:1024 sc1
v_lshlrev_b32 v32, 16, v128
v_and_b32 v33, 0xffff0000, v128
v_lshlrev_b32 v34, 16, v129
v_and_b32 v35, 0xffff0000, v129
v_lshlrev_b32 v36, 16, v130
v_and_b32 v37, 0xffff0000, v130
v_lshlrev_b32 v38, 16, v131
v_and_b32 v39, 0xffff0000, v131
v_lshlrev_b32 v40, 16, v132
v_and_b32 v41, 0xffff0000, v132
v_lshlrev_b32 v42, 16, v133
v_and_b32 v43, 0xffff0000, v133
v_lshlrev_b32 v44, 16, v134
v_and_b32 v45, 0xffff0000, v134
v_lshlrev_b32 v46, 16, v135
v_and_b32 v47, 0xffff0000, v135
v_lshlrev_b32 v48, 16, v136
v_and_b32 v49, 0xffff0000, v136
v_lshlrev_b32 v50, 16, v137
v_and_b32 v51, 0xffff0000, v137
v_lshlrev_b32 v52, 16, v138
v_and_b32 v53, 0xffff0000, v138
v_lshlrev_b32 v54, 16, v139
v_and_b32 v55, 0xffff0000, v139
v_lshlrev_b32 v56, 16, v140
v_and_b32 v57, 0xffff0000, v140
v_lshlrev_b32 v58, 16, v141
v_and_b32 v59, 0xffff0000, v141
v_lshlrev_b32 v60, 16, v142
v_and_b32 v61, 0xffff0000, v142
v_lshlrev_b32 v62, 16, v143
v_and_b32 v63, 0xffff0000, v143
v_pk_mul_f32 v[146:147], v[32:33], v[32:33]
v_pk_mul_f32 v[150:151], v[48:49], v[48:49]
v_pk_fma_f32 v[146:147], v[34:35], v[34:35], v[146:147]
v_pk_add_f32 v[144:145], v[32:33], v[34:35]
v_pk_fma_f32 v[150:151], v[50:51], v[50:51], v[150:151]
v_pk_add_f32 v[148:149], v[48:49], v[50:51]
v_pk_fma_f32 v[146:147], v[36:37], v[36:37], v[146:147]
v_pk_add_f32 v[144:145], v[144:145], v[36:37]
v_pk_fma_f32 v[150:151], v[52:53], v[52:53], v[150:151]
v_pk_add_f32 v[148:149], v[148:149], v[52:53]
v_pk_fma_f32 v[146:147], v[38:39], v[38:39], v[146:147]
v_pk_add_f32 v[144:145], v[144:145], v[38:39]
v_pk_fma_f32 v[150:151], v[54:55], v[54:55], v[150:151]
v_pk_add_f32 v[148:149], v[148:149], v[54:55]
v_pk_fma_f32 v[146:147], v[40:41], v[40:41], v[146:147]
v_pk_add_f32 v[144:145], v[144:145], v[40:41]
v_pk_fma_f32 v[150:151], v[56:57], v[56:57], v[150:151]
v_pk_add_f32 v[148:149], v[148:149], v[56:57]
v_pk_fma_f32 v[146:147], v[42:43], v[42:43], v[146:147]
v_pk_add_f32 v[144:145], v[144:145], v[42:43]
v_pk_fma_f32 v[150:151], v[58:59], v[58:59], v[150:151]
v_pk_add_f32 v[148:149], v[148:149], v[58:59]
v_pk_fma_f32 v[146:147], v[44:45], v[44:45], v[146:147]
v_pk_add_f32 v[144:145], v[144:145], v[44:45]
v_pk_fma_f32 v[150:151], v[60:61], v[60:61], v[150:151]
v_pk_add_f32 v[148:149], v[148:149], v[60:61]
v_pk_fma_f32 v[146:147], v[46:47], v[46:47], v[146:147]
v_pk_add_f32 v[144:145], v[144:145], v[46:47]
v_pk_fma_f32 v[150:151], v[62:63], v[62:63], v[150:151]
v_pk_add_f32 v[148:149], v[148:149], v[62:63]
v_add_f32 v144, v144, v145
v_add_f32 v146, v146, v147
v_add_f32 v148, v148, v149
v_add_f32 v150, v150, v151
s_nop 0
v_permlane16_swap_b32 v144, v148
v_permlane16_swap_b32 v146, v150
v_add_f32 v144, v144, v148
v_add_f32 v146, v146, v150
s_nop 1
v_permlane32_swap_b32 v144, v146
v_add_f32 v144, v144, v146
s_nop 1
v_permlane32_swap_b32 v144, v145
buffer_store_dwordx2 v[144:145], v152, s[16:19], s64 offen sc1
s_lshl_b32 s62, s2, 10
s_add_u32 s62, s62, 31457280
s_cmp_eq_u32 s3, 0
s_cselect_b32 s62, s62, 268435456
v_lshlrev_b32 v2, 4, v1
v_mov_b64 v[68:69], 0
v_mov_b64 v[70:71], 0
buffer_store_dwordx4 v[68:71], v2, s[16:19], s62 offen sc1
buffer_load_dword v255, v28, s[40:43], 0 offen sc1
s_add_u32 m0, s59, 117248
s_nop 0
buffer_load_dwordx4 v18, s[20:23], s58 offen lds
buffer_load_dwordx4 v19, s[20:23], s58 offen offset:1024 lds
buffer_load_dwordx4 v20, s[20:23], s58 offen offset:2048 lds
s_add_u32 s58, s58, 196608
s_add_u32 m0, s59, 129664
s_nop 0
buffer_load_dwordx4 v18, s[20:23], s58 offen lds
buffer_load_dwordx4 v19, s[20:23], s58 offen offset:1024 lds
buffer_load_dwordx4 v20, s[20:23], s58 offen offset:2048 lds
s_add_u32 s58, s58, 196608
s_add_u32 m0, s59, 67584
s_nop 0
buffer_load_dwordx4 v18, s[20:23], s58 offen lds
buffer_load_dwordx4 v19, s[20:23], s58 offen offset:1024 lds
buffer_load_dwordx4 v20, s[20:23], s58 offen offset:2048 lds
s_add_u32 s58, s58, 196608
s_add_u32 m0, s59, 80000
s_nop 0
buffer_load_dwordx4 v18, s[20:23], s58 offen lds
buffer_load_dwordx4 v19, s[20:23], s58 offen offset:1024 lds
buffer_load_dwordx4 v20, s[20:23], s58 offen offset:2048 lds
s_add_u32 s58, s58, 196608
s_add_u32 m0, s59, 92416
s_nop 0
buffer_load_dwordx4 v18, s[20:23], s58 offen lds
buffer_load_dwordx4 v19, s[20:23], s58 offen offset:1024 lds
buffer_load_dwordx4 v20, s[20:23], s58 offen offset:2048 lds
s_add_u32 s58, s58, 196608
s_nop 1
v_accvgpr_write_b32 a224, v32
v_accvgpr_write_b32 a225, v33
v_accvgpr_write_b32 a226, v34
v_accvgpr_write_b32 a227, v35
v_accvgpr_write_b32 a228, v36
v_accvgpr_write_b32 a229, v37
v_accvgpr_write_b32 a230, v38
v_accvgpr_write_b32 a231, v39
v_accvgpr_write_b32 a232, v40
v_accvgpr_write_b32 a233, v41
v_accvgpr_write_b32 a234, v42
v_accvgpr_write_b32 a235, v43
v_accvgpr_write_b32 a236, v44
v_accvgpr_write_b32 a237, v45
v_accvgpr_write_b32 a238, v46
v_accvgpr_write_b32 a239, v47
v_accvgpr_write_b32 a240, v48
v_accvgpr_write_b32 a241, v49
v_accvgpr_write_b32 a242, v50
v_accvgpr_write_b32 a243, v51
v_accvgpr_write_b32 a244, v52
v_accvgpr_write_b32 a245, v53
v_accvgpr_write_b32 a246, v54
v_accvgpr_write_b32 a247, v55
v_accvgpr_write_b32 a248, v56
v_accvgpr_write_b32 a249, v57
v_accvgpr_write_b32 a250, v58
v_accvgpr_write_b32 a251, v59
v_accvgpr_write_b32 a252, v60
v_accvgpr_write_b32 a253, v61
v_accvgpr_write_b32 a254, v62
v_accvgpr_write_b32 a255, v63
s_lshl_b32 s62, s8, 13
s_lshl_b32 s63, s3, 11
s_add_u32 s62, s62, s63
v_lshl_add_u32 v21, v1, 4, s62
v_lshrrev_b32 v2, 3, v1
v_cmp_eq_u32 vcc, 3, v2
v_add_u32 v2, 67108480, v21
s_nop 0
v_cndmask_b32 v21, v21, v2, vcc
s_lshl_b32 s62, s50, 10
s_sub_u32 s62, s62, 2048
v_lshl_add_u32 v22, v0, 2, s62
v_lshrrev_b32 v2, 5, v0
v_cmp_eq_u32 vcc, 3, v2
v_add_u32 v2, 67108480, v22
s_nop 0
v_cndmask_b32 v22, v22, v2, vcc
v_lshlrev_b32 v2, 2, v1
v_add_u32 v2, 134215680, v2
v_cmp_gt_u32 vcc, 4, v1
s_nop 1
v_cndmask_b32 v22, v22, v2, vcc
s_mul_i32 s62, s48, 4608
v_lshl_add_u32 v23, v1, 4, s62
v_lshrrev_b32 v24, 4, v1
v_mul_u32_u24 v24, 2304, v24
v_and_b32 v2, 15, v1
v_lshl_add_u32 v24, v2, 4, v24
v_bfe_u32 v25, v1, 3, 2
v_mul_u32_u24 v25, 3104, v25
v_bfe_u32 v2, v1, 2, 1
v_lshl_add_u32 v25, v2, 7, v25
v_bfe_u32 v2, v1, 5, 1
v_lshl_add_u32 v25, v2, 8, v25
v_and_b32 v2, 3, v1
v_lshl_add_u32 v25, v2, 3, v25
s_lshl_b32 s62, s49, 6
s_add_u32 s62, s62, 67584
v_add_u32 v25, s62, v25
s_lshl_b32 s62, s8, 1
s_add_u32 s62, s62, s3
s_lshr_b32 s63, s50, 2
s_cmp_lt_u32 s3, 2
s_cselect_b32 s62, s62, s63
s_lshl_b32 s62, s62, 13
s_cmp_eq_u32 s3, 3
s_cselect_b32 s62, 268435456, s62
v_lshl_add_u32 v26, v1, 4, s62
s_mov_b32 s52, 0
s_mov_b32 s54, s58
s_mov_b32 s56, s59
s_mul_i32 s55, s3, 2304
s_mul_i32 s59, s3, 2080
v_bfe_u32 v5, v1, 3, 1
v_lshrrev_b32 v2, 4, v1
v_lshl_add_u32 v5, v2, 3, v5
s_lshl_b32 s62, s3, 1
v_add_u32 v5, s62, v5
v_mul_u32_u24 v5, 2048, v5
v_and_b32 v2, 7, v1
v_lshl_add_u32 v5, v2, 4, v5
s_lshl_b32 s62, s7, 7
v_add_u32 v5, s62, v5
v_add_u32 v6, 64512, v5
s_lshl_b32 s62, s6, 7
s_add_u32 s62, s62, 30408704
s_lshl_b32 s64, s8, 7
s_add_u32 s64, s64, 30408704
s_lshr_b32 s65, s50, 3
s_lshl_b32 s65, s65, 7
s_add_u32 s65, s65, 30408704
v_mov_b32 v252, s62
v_mov_b32 v253, s64
v_writelane_b32 v253, s65, 1
s_waitcnt vmcnt(15) lgkmcnt(0)
s_cmp_lg_u32 s3, 1
s_cbranch_scc1 .Lrdyok4
s_mov_b32 s15, 0
v_mov_b32 v2, 0
.Lrdy3:
v_cmp_ne_u32 vcc, 0, v255
s_add_u32 s15, s15, 1
s_cbranch_vccnz .Lrdyok4
s_cmp_gt_u32 s15, 100000
s_cbranch_scc1 .Lrdyok4
buffer_load_dword v255, v2, s[40:43], 0 offen sc1
s_waitcnt vmcnt(0)
s_branch .Lrdy3
.Lrdyok4:
s_barrier
s_cmp_lg_u32 s3, 1
s_cbranch_scc1 .Lnosig5
v_mov_b32 v255, 1
s_mov_b64 exec, 1
buffer_atomic_add v255, v252, s[16:19], 0 offen
s_mov_b64 exec, -1
.Lnosig5:
s_cmp_lg_u32 s3, 1
s_cbranch_scc1 .Lfirst9
s_mov_b64 exec, 3
v_mov_b32 v254, 0
buffer_atomic_add v254, v253, s[16:19], 0 offen sc0
s_mov_b64 exec, -1
.Lfirst9:
s_cmp_lt_u32 s8, 5
s_cselect_b32 s62, s24, s20
s_cselect_b32 s63, s25, s21
s_cselect_b32 s64, s26, s22
s_sub_u32 s47, s46, 6
s_cmp_lt_u32 s46, 6
s_cselect_b32 s47, s46, s47
s_cselect_b32 s40, s62, s32
s_cselect_b32 s98, s32, s62
s_cselect_b32 s41, s63, s33
s_cselect_b32 s99, s33, s63
s_cselect_b32 s42, s64, s34
s_cselect_b32 s100, s34, s64
v_lshrrev_b32 v2, 4, v1
v_lshlrev_b32 v2, 2, v2
v_and_b32 v13, 15, v1
v_sub_u32 v2, v13, v2
v_mov_b32 v13, 0xff61b1e6
v_subrev_u32 v54, 0, v2
v_cmp_gt_u32 vcc, 8, v54
s_nop 1
v_cndmask_b32 v50, v13, 0, vcc
v_cmp_gt_i32 vcc, -8, v54
s_nop 1
v_cndmask_b32 v46, v13, 0, vcc
v_subrev_u32 v54, 1, v2
v_cmp_gt_u32 vcc, 8, v54
s_nop 1
v_cndmask_b32 v51, v13, 0, vcc
v_cmp_gt_i32 vcc, -8, v54
s_nop 1
v_cndmask_b32 v47, v13, 0, vcc
v_subrev_u32 v54, 2, v2
v_cmp_gt_u32 vcc, 8, v54
s_nop 1
v_cndmask_b32 v52, v13, 0, vcc
v_cmp_gt_i32 vcc, -8, v54
s_nop 1
v_cndmask_b32 v48, v13, 0, vcc
v_subrev_u32 v54, 3, v2
v_cmp_gt_u32 vcc, 8, v54
s_nop 1
v_cndmask_b32 v53, v13, 0, vcc
v_cmp_gt_i32 vcc, -8, v54
s_nop 1
v_cndmask_b32 v49, v13, 0, vcc
s_cmp_lt_u32 s8, 2
s_cselect_b64 vcc, -1, 0
v_cndmask_b32 v54, v46, v13, vcc
v_cndmask_b32 v55, v47, v13, vcc
v_cndmask_b32 v56, v48, v13, vcc
v_cndmask_b32 v57, v49, v13, vcc
v_mov_b64 v[60:61], 0
v_mov_b64 v[62:63], 0
v_mov_b64 v[64:65], 0
v_mov_b64 v[66:67], 0
v_mov_b64 v[68:69], 0
v_mov_b64 v[70:71], 0
v_mov_b64 v[72:73], 0
v_mov_b64 v[74:75], 0
v_mov_b64 v[76:77], 0
v_mov_b64 v[78:79], 0
v_mov_b64 v[80:81], 0
v_mov_b64 v[82:83], 0
v_mov_b64 v[84:85], 0
v_mov_b64 v[86:87], 0
v_mov_b64 v[88:89], 0
v_mov_b64 v[90:91], 0
v_mov_b64 v[92:93], 0
v_mov_b64 v[94:95], 0
v_mov_b64 v[96:97], 0
v_mov_b64 v[98:99], 0
v_mov_b64 v[100:101], 0
v_mov_b64 v[102:103], 0
v_mov_b64 v[104:105], 0
v_mov_b64 v[106:107], 0
v_mov_b64 v[108:109], 0
v_mov_b64 v[110:111], 0
v_mov_b64 v[112:113], 0
v_mov_b64 v[114:115], 0
v_mov_b64 v[116:117], 0
v_mov_b64 v[118:119], 0
v_mov_b64 v[120:121], 0
v_mov_b64 v[122:123], 0
v_mov_b64 v[124:125], 0
v_mov_b64 v[126:127], 0
v_mov_b64 v[128:129], 0
v_mov_b64 v[130:131], 0
v_mov_b64 v[132:133], 0
v_mov_b64 v[134:135], 0
v_mov_b64 v[136:137], 0
v_mov_b64 v[138:139], 0
v_mov_b64 v[140:141], 0
v_mov_b64 v[142:143], 0
v_mov_b64 v[144:145], 0
v_mov_b64 v[146:147], 0
v_mov_b64 v[148:149], 0
v_mov_b64 v[150:151], 0
v_mov_b64 v[152:153], 0
v_mov_b64 v[154:155], 0
v_mov_b64 v[156:157], 0
v_mov_b64 v[158:159], 0
v_mov_b64 v[160:161], 0
v_mov_b64 v[162:163], 0
v_mov_b64 v[164:165], 0
v_mov_b64 v[166:167], 0
v_mov_b64 v[168:169], 0
v_mov_b64 v[170:171], 0
v_mov_b64 v[172:173], 0
v_mov_b64 v[174:175], 0
v_mov_b64 v[244:245], 0
v_mov_b64 v[246:247], 0
s_mov_b32 s75, 29360128
v_and_b32 v10, 15, v1
v_lshlrev_b32 v12, 2, v10
v_lshlrev_b32 v10, 4, v10
v_add_u32 v10, 152576, v10
v_lshrrev_b32 v11, 4, v1
v_lshlrev_b32 v11, 4, v11
s_lshl_b32 s62, s49, 7
s_add_u32 s62, s62, 158720
v_add_u32 v12, s62, v12
v_add_u32 v13, s62, v11
v_add_u32 v11, 156672, v11
s_lshl_b32 s62, s3, 11
s_add_u32 s62, s62, 143360
v_lshl_add_u32 v8, v1, 4, s62
v_xor_b32 v9, 2048, v8
v_mov_b32 v248, 0x3f803f80
v_mov_b32 v249, 0x3f803f80
v_mov_b32 v250, 0x3f803f80
v_mov_b32 v251, 0x3f803f80
v_and_b32 v7, 31, v1
v_lshrrev_b32 v2, 5, v1
v_lshl_add_u32 v7, v7, 1, v2
v_and_b32 v2, 0xc0, v0
v_add_u32 v7, v7, v2
v_lshlrev_b32 v17, 2, v7
v_add_u32 v17, 156672, v17
v_lshlrev_b32 v7, 4, v7
v_add_u32 v7, 152576, v7
s_lshl_b32 s74, s9, 1
s_add_u32 s74, s74, s49
s_lshl_b32 s74, s74, 17
s_lshl_b32 s63, s8, 13
s_add_u32 s74, s74, s63
s_lshl_b32 s63, s48, 12
s_add_u32 s74, s74, s63
s_add_u32 s74, s74, 4194304
s_mov_b32 s62, 0
v_lshl_add_u32 v4, v1, 4, s62
v_lshrrev_b32 v2, 3, v1
v_cmp_eq_u32 vcc, 3, v2
v_add_u32 v2, 67108480, v4
s_nop 0
v_cndmask_b32 v4, v4, v2, vcc
s_waitcnt lgkmcnt(0)
s_cmp_lg_u32 s3, 1
s_cbranch_scc1 .Lnopoll8
s_mov_b64 exec, 3
s_mov_b32 s15, 0
.Lpoll6:
s_waitcnt vmcnt(0)
v_cmp_ne_u32 vcc, 16, v254
s_add_u32 s15, s15, 1
s_cbranch_vccz .Lnopoll8r
s_sleep 2
s_mov_b64 exec, 3
v_mov_b32 v254, 0
buffer_atomic_add v254, v253, s[16:19], 0 offen sc0
s_cmp_le_u32 s15, 100000
s_cbranch_scc1 .Lpoll6
.Lgot7:
s_waitcnt vmcnt(0)
s_branch .Lnopoll8r
.Lnopoll8:
s_mov_b64 exec, 0
s_cmp_eq_u32 s3, 2
s_cbranch_scc1 .Lpad1
s_cmp_eq_u32 s3, 3
s_cbranch_scc1 .Lpad2
s_branch .Lpad3
.Lnopoll8r:
s_mov_b64 exec, -1
s_barrier
s_cmp_eq_u32 s48, 1
s_cbranch_scc1 .Lqkv10
s_add_u32 m0, s55, 36864
s_nop 0
buffer_load_dwordx4 v21, s[16:19], s52 offen sc1 lds
buffer_load_dwordx4 v21, s[16:19], s52 offen offset:1024 sc1 lds
buffer_load_dword v22, s[16:19], s52 offen offset:2048 sc1 lds
s_add_u32 s52, s52, 0x20000
s_add_u32 m0, s55, 46080
s_nop 0
buffer_load_dwordx4 v21, s[16:19], s52 offen sc1 lds
buffer_load_dwordx4 v21, s[16:19], s52 offen offset:1024 sc1 lds
buffer_load_dword v22, s[16:19], s52 offen offset:2048 sc1 lds
s_add_u32 s52, s52, 0x20000
s_add_u32 m0, s55, 0
s_nop 0
buffer_load_dwordx4 v21, s[16:19], s52 offen sc1 lds
buffer_load_dwordx4 v21, s[16:19], s52 offen offset:1024 sc1 lds
buffer_load_dword v22, s[16:19], s52 offen offset:2048 sc1 lds
s_add_u32 s52, s52, 0x20000
s_add_u32 m0, s55, 9216
s_nop 0
buffer_load_dwordx4 v21, s[16:19], s52 offen sc1 lds
buffer_load_dwordx4 v21, s[16:19], s52 offen offset:1024 sc1 lds
buffer_load_dword v22, s[16:19], s52 offen offset:2048 sc1 lds
s_add_u32 s52, s52, 0x20000
s_add_u32 m0, s55, 18432
s_nop 0
buffer_load_dwordx4 v21, s[16:19], s52 offen sc1 lds
buffer_load_dwordx4 v21, s[16:19], s52 offen offset:1024 sc1 lds
buffer_load_dword v22, s[16:19], s52 offen offset:2048 sc1 lds
s_add_u32 s52, s52, 0x20000
s_waitcnt vmcnt(12)
s_barrier
ds_read_b128 a[0:3], v23 offset:36864
ds_read_b128 a[4:7], v23 offset:37888
ds_read_b128 a[8:11], v23 offset:39168
ds_read_b128 a[12:15], v23 offset:40192
ds_read_b64_tr_b16 a[20:21], v25 offset:49664
ds_read_b64_tr_b16 a[22:23], v25 offset:50176
ds_read_b64_tr_b16 a[24:25], v25 offset:49696
ds_read_b64_tr_b16 a[26:27], v25 offset:50208
ds_read_b128 a[16:19], v24 offset:38912
ds_read_b64_tr_b16 a[28:29], v25 offset:50688
ds_read_b64_tr_b16 a[30:31], v25 offset:51200
ds_read_b64_tr_b16 a[32:33], v25 offset:50720
ds_read_b64_tr_b16 a[34:35], v25 offset:51232
ds_read_b64_tr_b16 a[36:37], v25 offset:51712
ds_read_b64_tr_b16 a[38:39], v25 offset:52224
ds_read_b64_tr_b16 a[40:41], v25 offset:51744
.Lpad1:
s_cbranch_execz .Lpad4
ds_read_b64_tr_b16 a[42:43], v25 offset:52256
s_waitcnt lgkmcnt(0)
s_mov_b32 s15, -4
.p2align 6
.Lk12:
s_waitcnt vmcnt(9) lgkmcnt(6)
s_barrier
v_mfma_f32_16x16x32_bf16 v[60:63], a[20:23], a[0:3], v[60:63]
ds_read_b128 a[44:47], v23 offset:46080
s_add_u32 m0, s56, 104832
v_mfma_f32_16x16x32_bf16 v[64:67], a[20:23], a[4:7], v[64:67]
buffer_load_dwordx4 v18, s[20:23], s54 offen lds
v_mfma_f32_16x16x32_bf16 v[68:71], a[20:23], a[8:11], v[68:71]
s_sub_u32 s47, s47, 1
s_cbranch_scc1 .Lx13
.Lx13b:
v_mfma_f32_16x16x32_bf16 v[72:75], a[20:23], a[12:15], v[72:75]
ds_read_b128 a[48:51], v23 offset:47104
v_add_f32 v164, v164, v168
v_mfma_f32_16x16x32_bf16 v[244:247], a[20:23], a[16:19], v[244:247]
ds_read_b128 a[52:55], v23 offset:48384
v_mfma_f32_16x16x32_bf16 v[76:79], a[24:27], a[0:3], v[76:79]
buffer_load_dwordx4 v19, s[20:23], s54 offen offset:1024 lds
v_mfma_f32_16x16x32_bf16 v[80:83], a[24:27], a[4:7], v[80:83]
ds_read_b128 a[56:59], v23 offset:49408
v_mfma_f32_16x16x32_bf16 v[84:87], a[24:27], a[8:11], v[84:87]
ds_read_b64_tr_b16 a[64:65], v25 offset:62080
v_mfma_f32_16x16x32_bf16 v[88:91], a[24:27], a[12:15], v[88:91]
ds_read_b64_tr_b16 a[66:67], v25 offset:62592
v_add_f32 v165, v165, v169
v_mfma_f32_16x16x32_bf16 v[92:95], a[28:31], a[0:3], v[92:95]
buffer_load_dwordx4 v20, s[20:23], s54 offen offset:2048 lds
v_mfma_f32_16x16x32_bf16 v[96:99], a[28:31], a[4:7], v[96:99]
s_add_u32 s54, s54, 196608
s_waitcnt lgkmcnt(6)
v_mfma_f32_16x16x32_bf16 v[100:103], a[28:31], a[8:11], v[100:103]
ds_read_b64_tr_b16 a[68:69], v25 offset:62112
v_mfma_f32_16x16x32_bf16 v[104:107], a[28:31], a[12:15], v[104:107]
ds_read_b64_tr_b16 a[70:71], v25 offset:62624
s_add_u32 m0, s55, 27648
v_mfma_f32_16x16x32_bf16 v[156:159], a[28:31], a[16:19], v[156:159]
buffer_load_dwordx4 v21, s[16:19], s52 offen sc1 lds
v_mfma_f32_16x16x32_bf16 v[108:111], a[32:35], a[0:3], v[108:111]
ds_read_b128 a[60:63], v24 offset:48128
v_mfma_f32_16x16x32_bf16 v[112:115], a[32:35], a[4:7], v[112:115]
ds_read_b64_tr_b16 a[72:73], v25 offset:63104
v_add_f32 v166, v166, v170
v_mfma_f32_16x16x32_bf16 v[116:119], a[32:35], a[8:11], v[116:119]
ds_read_b64_tr_b16 a[74:75], v25 offset:63616
v_mfma_f32_16x16x32_bf16 v[120:123], a[32:35], a[12:15], v[120:123]
buffer_load_dwordx4 v21, s[16:19], s52 offen offset:1024 sc1 lds
v_mfma_f32_16x16x32_bf16 v[160:163], a[32:35], a[16:19], v[160:163]
ds_read_b64_tr_b16 a[76:77], v25 offset:63136
v_mfma_f32_16x16x32_bf16 v[124:127], a[0:3], a[36:39], v[124:127]
ds_read_b64_tr_b16 a[78:79], v25 offset:63648
v_mfma_f32_16x16x32_bf16 v[128:131], a[4:7], a[36:39], v[128:131]
ds_read_b64_tr_b16 a[80:81], v25 offset:64128
v_add_f32 v167, v167, v171
v_mfma_f32_16x16x32_bf16 v[132:135], a[8:11], a[36:39], v[132:135]
buffer_load_dword v22, s[16:19], s52 offen offset:2048 sc1 lds
v_mfma_f32_16x16x32_bf16 v[136:139], a[12:15], a[36:39], v[136:139]
ds_read_b64_tr_b16 a[82:83], v25 offset:64640
s_add_u32 s52, s52, 0x20000
v_mfma_f32_16x16x32_bf16 v[140:143], a[0:3], a[40:43], v[140:143]
ds_read_b64_tr_b16 a[84:85], v25 offset:64160
v_mfma_f32_16x16x32_bf16 v[144:147], a[4:7], a[40:43], v[144:147]
ds_read_b64_tr_b16 a[86:87], v25 offset:64672
v_mfma_f32_16x16x32_bf16 v[148:151], a[8:11], a[40:43], v[148:151]
v_mfma_f32_16x16x32_bf16 v[152:155], a[12:15], a[40:43], v[152:155]
s_waitcnt vmcnt(12) lgkmcnt(6)
s_barrier
v_mfma_f32_16x16x32_bf16 v[60:63], a[64:67], a[44:47], v[60:63]
ds_read_b128 a[0:3], v23
s_add_u32 m0, s56, 117248
v_mfma_f32_16x16x32_bf16 v[64:67], a[64:67], a[48:51], v[64:67]
buffer_load_dwordx4 v18, s[20:23], s54 offen lds
v_mfma_f32_16x16x32_bf16 v[68:71], a[64:67], a[52:55], v[68:71]
ds_read_b128 a[4:7], v23 offset:1024
v_mfma_f32_16x16x32_bf16 v[72:75], a[64:67], a[56:59], v[72:75]
ds_read_b128 a[8:11], v23 offset:2304
v_mfma_f32_16x16x32_bf16 v[244:247], a[64:67], a[60:63], v[244:247]
buffer_load_dwordx4 v19, s[20:23], s54 offen offset:1024 lds
v_mfma_f32_16x16x32_bf16 v[76:79], a[68:71], a[44:47], v[76:79]
ds_read_b128 a[12:15], v23 offset:3328
v_mfma_f32_16x16x32_bf16 v[80:83], a[68:71], a[48:51], v[80:83]
ds_read_b64_tr_b16 a[20:21], v25
v_mfma_f32_16x16x32_bf16 v[84:87], a[68:71], a[52:55], v[84:87]
ds_read_b64_tr_b16 a[22:23], v25 offset:512
v_mfma_f32_16x16x32_bf16 v[88:91], a[68:71], a[56:59], v[88:91]
buffer_load_dwordx4 v20, s[20:23], s54 offen offset:2048 lds
v_mfma_f32_16x16x32_bf16 v[92:95], a[72:75], a[44:47], v[92:95]
ds_read_b64_tr_b16 a[24:25], v25 offset:32
s_add_u32 s54, s54, 196608
v_mfma_f32_16x16x32_bf16 v[96:99], a[72:75], a[48:51], v[96:99]
s_add_u32 m0, s55, 36864
s_waitcnt lgkmcnt(7)
v_mfma_f32_16x16x32_bf16 v[100:103], a[72:75], a[52:55], v[100:103]
buffer_load_dwordx4 v21, s[16:19], s52 offen sc1 lds
v_mfma_f32_16x16x32_bf16 v[104:107], a[72:75], a[56:59], v[104:107]
ds_read_b64_tr_b16 a[26:27], v25 offset:544
v_mfma_f32_16x16x32_bf16 v[156:159], a[72:75], a[60:63], v[156:159]
ds_read_b128 a[16:19], v24 offset:2048
v_mfma_f32_16x16x32_bf16 v[108:111], a[76:79], a[44:47], v[108:111]
ds_read_b64_tr_b16 a[28:29], v25 offset:1024
v_mfma_f32_16x16x32_bf16 v[112:115], a[76:79], a[48:51], v[112:115]
buffer_load_dwordx4 v21, s[16:19], s52 offen offset:1024 sc1 lds
v_mfma_f32_16x16x32_bf16 v[116:119], a[76:79], a[52:55], v[116:119]
ds_read_b64_tr_b16 a[30:31], v25 offset:1536
v_mfma_f32_16x16x32_bf16 v[120:123], a[76:79], a[56:59], v[120:123]
ds_read_b64_tr_b16 a[32:33], v25 offset:1056
v_mfma_f32_16x16x32_bf16 v[160:163], a[76:79], a[60:63], v[160:163]
buffer_load_dword v22, s[16:19], s52 offen offset:2048 sc1 lds
v_mfma_f32_16x16x32_bf16 v[124:127], a[44:47], a[80:83], v[124:127]
ds_read_b64_tr_b16 a[34:35], v25 offset:1568
s_add_u32 s52, s52, 0x20000
v_mfma_f32_16x16x32_bf16 v[128:131], a[48:51], a[80:83], v[128:131]
ds_read_b64_tr_b16 a[36:37], v25 offset:2048
v_mfma_f32_16x16x32_bf16 v[132:135], a[52:55], a[80:83], v[132:135]
ds_read_b64_tr_b16 a[38:39], v25 offset:2560
v_mfma_f32_16x16x32_bf16 v[136:139], a[56:59], a[80:83], v[136:139]
buffer_load_dwordx4 v[168:171], v26, s[16:19], s75 offen sc1
v_mfma_f32_16x16x32_bf16 v[140:143], a[44:47], a[84:87], v[140:143]
ds_read_b64_tr_b16 a[40:41], v25 offset:2080
v_mfma_f32_16x16x32_bf16 v[144:147], a[48:51], a[84:87], v[144:147]
ds_read_b64_tr_b16 a[42:43], v25 offset:2592
v_mfma_f32_16x16x32_bf16 v[148:151], a[52:55], a[84:87], v[148:151]
v_mfma_f32_16x16x32_bf16 v[152:155], a[56:59], a[84:87], v[152:155]
s_waitcnt vmcnt(16) lgkmcnt(6)
s_barrier
v_mfma_f32_16x16x32_bf16 v[60:63], a[20:23], a[0:3], v[60:63]
ds_read_b128 a[44:47], v23 offset:9216
s_add_u32 m0, s56, 129664
v_mfma_f32_16x16x32_bf16 v[64:67], a[20:23], a[4:7], v[64:67]
buffer_load_dwordx4 v18, s[20:23], s54 offen lds
v_mfma_f32_16x16x32_bf16 v[68:71], a[20:23], a[8:11], v[68:71]
s_sub_u32 s47, s47, 1
s_cbranch_scc1 .Lx14
.Lx14b:
v_mfma_f32_16x16x32_bf16 v[72:75], a[20:23], a[12:15], v[72:75]
ds_read_b128 a[48:51], v23 offset:10240
v_mfma_f32_16x16x32_bf16 v[244:247], a[20:23], a[16:19], v[244:247]
ds_read_b128 a[52:55], v23 offset:11520
v_mfma_f32_16x16x32_bf16 v[76:79], a[24:27], a[0:3], v[76:79]
buffer_load_dwordx4 v19, s[20:23], s54 offen offset:1024 lds
v_mfma_f32_16x16x32_bf16 v[80:83], a[24:27], a[4:7], v[80:83]
ds_read_b128 a[56:59], v23 offset:12544
v_mfma_f32_16x16x32_bf16 v[84:87], a[24:27], a[8:11], v[84:87]
ds_read_b64_tr_b16 a[64:65], v25 offset:12416
v_mfma_f32_16x16x32_bf16 v[88:91], a[24:27], a[12:15], v[88:91]
ds_read_b64_tr_b16 a[66:67], v25 offset:12928
v_mfma_f32_16x16x32_bf16 v[92:95], a[28:31], a[0:3], v[92:95]
buffer_load_dwordx4 v20, s[20:23], s54 offen offset:2048 lds
v_mfma_f32_16x16x32_bf16 v[96:99], a[28:31], a[4:7], v[96:99]
s_add_u32 s54, s54, 196608
s_waitcnt lgkmcnt(6)
v_mfma_f32_16x16x32_bf16 v[100:103], a[28:31], a[8:11], v[100:103]
ds_read_b64_tr_b16 a[68:69], v25 offset:12448
v_mfma_f32_16x16x32_bf16 v[104:107], a[28:31], a[12:15], v[104:107]
ds_read_b64_tr_b16 a[70:71], v25 offset:12960
s_add_u32 m0, s55, 46080
v_mfma_f32_16x16x32_bf16 v[156:159], a[28:31], a[16:19], v[156:159]
buffer_load_dwordx4 v21, s[16:19], s52 offen sc1 lds
v_mfma_f32_16x16x32_bf16 v[108:111], a[32:35], a[0:3], v[108:111]
ds_read_b128 a[60:63], v24 offset:11264
v_mfma_f32_16x16x32_bf16 v[112:115], a[32:35], a[4:7], v[112:115]
ds_read_b64_tr_b16 a[72:73], v25 offset:13440
v_mfma_f32_16x16x32_bf16 v[116:119], a[32:35], a[8:11], v[116:119]
ds_read_b64_tr_b16 a[74:75], v25 offset:13952
v_mfma_f32_16x16x32_bf16 v[120:123], a[32:35], a[12:15], v[120:123]
buffer_load_dwordx4 v21, s[16:19], s52 offen offset:1024 sc1 lds
v_mfma_f32_16x16x32_bf16 v[160:163], a[32:35], a[16:19], v[160:163]
ds_read_b64_tr_b16 a[76:77], v25 offset:13472
v_mfma_f32_16x16x32_bf16 v[124:127], a[0:3], a[36:39], v[124:127]
ds_read_b64_tr_b16 a[78:79], v25 offset:13984
v_mfma_f32_16x16x32_bf16 v[128:131], a[4:7], a[36:39], v[128:131]
ds_read_b64_tr_b16 a[80:81], v25 offset:14464
v_mfma_f32_16x16x32_bf16 v[132:135], a[8:11], a[36:39], v[132:135]
buffer_load_dword v22, s[16:19], s52 offen offset:2048 sc1 lds
v_mfma_f32_16x16x32_bf16 v[136:139], a[12:15], a[36:39], v[136:139]
ds_read_b64_tr_b16 a[82:83], v25 offset:14976
s_add_u32 s52, s52, 0x20000
v_mfma_f32_16x16x32_bf16 v[140:143], a[0:3], a[40:43], v[140:143]
ds_read_b64_tr_b16 a[84:85], v25 offset:14496
v_mfma_f32_16x16x32_bf16 v[144:147], a[4:7], a[40:43], v[144:147]
ds_read_b64_tr_b16 a[86:87], v25 offset:15008
v_mfma_f32_16x16x32_bf16 v[148:151], a[8:11], a[40:43], v[148:151]
v_mfma_f32_16x16x32_bf16 v[152:155], a[12:15], a[40:43], v[152:155]
s_waitcnt vmcnt(19) lgkmcnt(6)
s_barrier
v_mfma_f32_16x16x32_bf16 v[60:63], a[64:67], a[44:47], v[60:63]
ds_read_b128 a[0:3], v23 offset:18432
s_add_u32 m0, s56, 67584
v_mfma_f32_16x16x32_bf16 v[64:67], a[64:67], a[48:51], v[64:67]
buffer_load_dwordx4 v18, s[20:23], s54 offen lds
v_mfma_f32_16x16x32_bf16 v[68:71], a[64:67], a[52:55], v[68:71]
ds_read_b128 a[4:7], v23 offset:19456
v_add_f32 v164, v164, v172
v_mfma_f32_16x16x32_bf16 v[72:75], a[64:67], a[56:59], v[72:75]
ds_read_b128 a[8:11], v23 offset:20736
v_mfma_f32_16x16x32_bf16 v[244:247], a[64:67], a[60:63], v[244:247]
ds_read_b128 a[12:15], v23 offset:21760
v_mfma_f32_16x16x32_bf16 v[76:79], a[68:71], a[44:47], v[76:79]
buffer_load_dwordx4 v19, s[20:23], s54 offen offset:1024 lds
v_mfma_f32_16x16x32_bf16 v[80:83], a[68:71], a[48:51], v[80:83]
ds_read_b64_tr_b16 a[20:21], v25 offset:24832
v_mfma_f32_16x16x32_bf16 v[84:87], a[68:71], a[52:55], v[84:87]
ds_read_b64_tr_b16 a[22:23], v25 offset:25344
v_add_f32 v165, v165, v173
v_mfma_f32_16x16x32_bf16 v[88:91], a[68:71], a[56:59], v[88:91]
ds_read_b64_tr_b16 a[24:25], v25 offset:24864
v_mfma_f32_16x16x32_bf16 v[92:95], a[72:75], a[44:47], v[92:95]
buffer_load_dwordx4 v20, s[20:23], s54 offen offset:2048 lds
v_mfma_f32_16x16x32_bf16 v[96:99], a[72:75], a[48:51], v[96:99]
s_add_u32 s54, s54, 196608
s_waitcnt lgkmcnt(7)
v_mfma_f32_16x16x32_bf16 v[100:103], a[72:75], a[52:55], v[100:103]
ds_read_b64_tr_b16 a[26:27], v25 offset:25376
v_mfma_f32_16x16x32_bf16 v[104:107], a[72:75], a[56:59], v[104:107]
ds_read_b128 a[16:19], v24 offset:20480
s_add_u32 m0, s55, 0
v_mfma_f32_16x16x32_bf16 v[156:159], a[72:75], a[60:63], v[156:159]
buffer_load_dwordx4 v21, s[16:19], s52 offen sc1 lds
v_mfma_f32_16x16x32_bf16 v[108:111], a[76:79], a[44:47], v[108:111]
v_add_f32 v166, v166, v174
v_mfma_f32_16x16x32_bf16 v[112:115], a[76:79], a[48:51], v[112:115]
ds_read_b64_tr_b16 a[28:29], v25 offset:25856
v_mfma_f32_16x16x32_bf16 v[116:119], a[76:79], a[52:55], v[116:119]
ds_read_b64_tr_b16 a[30:31], v25 offset:26368
v_mfma_f32_16x16x32_bf16 v[120:123], a[76:79], a[56:59], v[120:123]
buffer_load_dwordx4 v21, s[16:19], s52 offen offset:1024 sc1 lds
v_mfma_f32_16x16x32_bf16 v[160:163], a[76:79], a[60:63], v[160:163]
ds_read_b64_tr_b16 a[32:33], v25 offset:25888
v_mfma_f32_16x16x32_bf16 v[124:127], a[44:47], a[80:83], v[124:127]
ds_read_b64_tr_b16 a[34:35], v25 offset:26400
v_mfma_f32_16x16x32_bf16 v[128:131], a[48:51], a[80:83], v[128:131]
ds_read_b64_tr_b16 a[36:37], v25 offset:26880
v_add_f32 v167, v167, v175
v_mfma_f32_16x16x32_bf16 v[132:135], a[52:55], a[80:83], v[132:135]
buffer_load_dword v22, s[16:19], s52 offen offset:2048 sc1 lds
v_mfma_f32_16x16x32_bf16 v[136:139], a[56:59], a[80:83], v[136:139]
ds_read_b64_tr_b16 a[38:39], v25 offset:27392
s_add_u32 s52, s52, 0x20000
v_mfma_f32_16x16x32_bf16 v[140:143], a[44:47], a[84:87], v[140:143]
ds_read_b64_tr_b16 a[40:41], v25 offset:26912
v_mfma_f32_16x16x32_bf16 v[144:147], a[48:51], a[84:87], v[144:147]
ds_read_b64_tr_b16 a[42:43], v25 offset:27424
v_mfma_f32_16x16x32_bf16 v[148:151], a[52:55], a[84:87], v[148:151]
v_mfma_f32_16x16x32_bf16 v[152:155], a[56:59], a[84:87], v[152:155]
s_waitcnt vmcnt(19) lgkmcnt(6)
s_barrier
v_mfma_f32_16x16x32_bf16 v[60:63], a[20:23], a[0:3], v[60:63]
ds_read_b128 a[44:47], v23 offset:27648
s_add_u32 m0, s56, 80000
v_mfma_f32_16x16x32_bf16 v[64:67], a[20:23], a[4:7], v[64:67]
buffer_load_dwordx4 v18, s[20:23], s54 offen lds
v_mfma_f32_16x16x32_bf16 v[68:71], a[20:23], a[8:11], v[68:71]
s_sub_u32 s47, s47, 1
s_cbranch_scc1 .Lx15
.Lx15b:
v_mfma_f32_16x16x32_bf16 v[72:75], a[20:23], a[12:15], v[72:75]
ds_read_b128 a[48:51], v23 offset:28672
v_mfma_f32_16x16x32_bf16 v[244:247], a[20:23], a[16:19], v[244:247]
buffer_load_dwordx4 v19, s[20:23], s54 offen offset:1024 lds
v_mfma_f32_16x16x32_bf16 v[76:79], a[24:27], a[0:3], v[76:79]
ds_read_b128 a[52:55], v23 offset:29952
v_mfma_f32_16x16x32_bf16 v[80:83], a[24:27], a[4:7], v[80:83]
ds_read_b128 a[56:59], v23 offset:30976
v_mfma_f32_16x16x32_bf16 v[84:87], a[24:27], a[8:11], v[84:87]
ds_read_b64_tr_b16 a[64:65], v25 offset:37248
v_mfma_f32_16x16x32_bf16 v[88:91], a[24:27], a[12:15], v[88:91]
buffer_load_dwordx4 v20, s[20:23], s54 offen offset:2048 lds
v_mfma_f32_16x16x32_bf16 v[92:95], a[28:31], a[0:3], v[92:95]
ds_read_b64_tr_b16 a[66:67], v25 offset:37760
s_add_u32 s54, s54, 196608
v_mfma_f32_16x16x32_bf16 v[96:99], a[28:31], a[4:7], v[96:99]
s_add_u32 m0, s55, 9216
s_waitcnt lgkmcnt(6)
v_mfma_f32_16x16x32_bf16 v[100:103], a[28:31], a[8:11], v[100:103]
buffer_load_dwordx4 v21, s[16:19], s52 offen sc1 lds
v_mfma_f32_16x16x32_bf16 v[104:107], a[28:31], a[12:15], v[104:107]
ds_read_b64_tr_b16 a[68:69], v25 offset:37280
v_mfma_f32_16x16x32_bf16 v[156:159], a[28:31], a[16:19], v[156:159]
ds_read_b64_tr_b16 a[70:71], v25 offset:37792
v_mfma_f32_16x16x32_bf16 v[108:111], a[32:35], a[0:3], v[108:111]
ds_read_b128 a[60:63], v24 offset:29696
v_mfma_f32_16x16x32_bf16 v[112:115], a[32:35], a[4:7], v[112:115]
buffer_load_dwordx4 v21, s[16:19], s52 offen offset:1024 sc1 lds
v_mfma_f32_16x16x32_bf16 v[116:119], a[32:35], a[8:11], v[116:119]
ds_read_b64_tr_b16 a[72:73], v25 offset:38272
v_mfma_f32_16x16x32_bf16 v[120:123], a[32:35], a[12:15], v[120:123]
ds_read_b64_tr_b16 a[74:75], v25 offset:38784
v_mfma_f32_16x16x32_bf16 v[160:163], a[32:35], a[16:19], v[160:163]
buffer_load_dword v22, s[16:19], s52 offen offset:2048 sc1 lds
v_mfma_f32_16x16x32_bf16 v[124:127], a[0:3], a[36:39], v[124:127]
ds_read_b64_tr_b16 a[76:77], v25 offset:38304
s_add_u32 s52, s52, 0x20000
v_mfma_f32_16x16x32_bf16 v[128:131], a[4:7], a[36:39], v[128:131]
ds_read_b64_tr_b16 a[78:79], v25 offset:38816
v_mfma_f32_16x16x32_bf16 v[132:135], a[8:11], a[36:39], v[132:135]
ds_read_b64_tr_b16 a[80:81], v25 offset:39296
v_mfma_f32_16x16x32_bf16 v[136:139], a[12:15], a[36:39], v[136:139]
buffer_load_dwordx4 v[172:175], v26, s[16:19], s75 offen offset:1024 sc1
v_mfma_f32_16x16x32_bf16 v[140:143], a[0:3], a[40:43], v[140:143]
ds_read_b64_tr_b16 a[82:83], v25 offset:39808
s_add_u32 s75, s75, 2048
v_mfma_f32_16x16x32_bf16 v[144:147], a[4:7], a[40:43], v[144:147]
ds_read_b64_tr_b16 a[84:85], v25 offset:39328
v_mfma_f32_16x16x32_bf16 v[148:151], a[8:11], a[40:43], v[148:151]
ds_read_b64_tr_b16 a[86:87], v25 offset:39840
v_mfma_f32_16x16x32_bf16 v[152:155], a[12:15], a[40:43], v[152:155]
s_waitcnt vmcnt(20) lgkmcnt(6)
s_barrier
v_mfma_f32_16x16x32_bf16 v[60:63], a[64:67], a[44:47], v[60:63]
ds_read_b128 a[0:3], v23 offset:36864
s_add_u32 m0, s56, 92416
v_mfma_f32_16x16x32_bf16 v[64:67], a[64:67], a[48:51], v[64:67]
buffer_load_dwordx4 v18, s[20:23], s54 offen lds
v_mfma_f32_16x16x32_bf16 v[68:71], a[64:67], a[52:55], v[68:71]
ds_read_b128 a[4:7], v23 offset:37888
v_mfma_f32_16x16x32_bf16 v[72:75], a[64:67], a[56:59], v[72:75]
ds_read_b128 a[8:11], v23 offset:39168
v_mfma_f32_16x16x32_bf16 v[244:247], a[64:67], a[60:63], v[244:247]
ds_read_b128 a[12:15], v23 offset:40192
v_mfma_f32_16x16x32_bf16 v[76:79], a[68:71], a[44:47], v[76:79]
buffer_load_dwordx4 v19, s[20:23], s54 offen offset:1024 lds
v_mfma_f32_16x16x32_bf16 v[80:83], a[68:71], a[48:51], v[80:83]
ds_read_b64_tr_b16 a[20:21], v25 offset:49664
v_mfma_f32_16x16x32_bf16 v[84:87], a[68:71], a[52:55], v[84:87]
ds_read_b64_tr_b16 a[22:23], v25 offset:50176
v_mfma_f32_16x16x32_bf16 v[88:91], a[68:71], a[56:59], v[88:91]
ds_read_b64_tr_b16 a[24:25], v25 offset:49696
v_mfma_f32_16x16x32_bf16 v[92:95], a[72:75], a[44:47], v[92:95]
buffer_load_dwordx4 v20, s[20:23], s54 offen offset:2048 lds
v_mfma_f32_16x16x32_bf16 v[96:99], a[72:75], a[48:51], v[96:99]
s_add_u32 s54, s54, 196608
s_waitcnt lgkmcnt(7)
v_mfma_f32_16x16x32_bf16 v[100:103], a[72:75], a[52:55], v[100:103]
ds_read_b64_tr_b16 a[26:27], v25 offset:50208
v_mfma_f32_16x16x32_bf16 v[104:107], a[72:75], a[56:59], v[104:107]
ds_read_b128 a[16:19], v24 offset:38912
s_add_u32 m0, s55, 18432
v_mfma_f32_16x16x32_bf16 v[156:159], a[72:75], a[60:63], v[156:159]
buffer_load_dwordx4 v21, s[16:19], s52 offen sc1 lds
v_mfma_f32_16x16x32_bf16 v[108:111], a[76:79], a[44:47], v[108:111]
v_mfma_f32_16x16x32_bf16 v[112:115], a[76:79], a[48:51], v[112:115]
ds_read_b64_tr_b16 a[28:29], v25 offset:50688
v_mfma_f32_16x16x32_bf16 v[116:119], a[76:79], a[52:55], v[116:119]
ds_read_b64_tr_b16 a[30:31], v25 offset:51200
v_mfma_f32_16x16x32_bf16 v[120:123], a[76:79], a[56:59], v[120:123]
buffer_load_dwordx4 v21, s[16:19], s52 offen offset:1024 sc1 lds
v_mfma_f32_16x16x32_bf16 v[160:163], a[76:79], a[60:63], v[160:163]
ds_read_b64_tr_b16 a[32:33], v25 offset:50720
v_mfma_f32_16x16x32_bf16 v[124:127], a[44:47], a[80:83], v[124:127]
ds_read_b64_tr_b16 a[34:35], v25 offset:51232
v_mfma_f32_16x16x32_bf16 v[128:131], a[48:51], a[80:83], v[128:131]
ds_read_b64_tr_b16 a[36:37], v25 offset:51712
v_mfma_f32_16x16x32_bf16 v[132:135], a[52:55], a[80:83], v[132:135]
buffer_load_dword v22, s[16:19], s52 offen offset:2048 sc1 lds
v_mfma_f32_16x16x32_bf16 v[136:139], a[56:59], a[80:83], v[136:139]
ds_read_b64_tr_b16 a[38:39], v25 offset:52224
s_add_u32 s52, s52, 0x20000
v_mfma_f32_16x16x32_bf16 v[140:143], a[44:47], a[84:87], v[140:143]
ds_read_b64_tr_b16 a[40:41], v25 offset:51744
v_mfma_f32_16x16x32_bf16 v[144:147], a[48:51], a[84:87], v[144:147]
ds_read_b64_tr_b16 a[42:43], v25 offset:52256
v_mfma_f32_16x16x32_bf16 v[148:151], a[52:55], a[84:87], v[148:151]
s_add_u32 s15, s15, 1
v_mfma_f32_16x16x32_bf16 v[152:155], a[56:59], a[84:87], v[152:155]
s_cbranch_scc0 .Lk12
s_waitcnt vmcnt(19) lgkmcnt(6)
s_barrier
v_mfma_f32_16x16x32_bf16 v[60:63], a[20:23], a[0:3], v[60:63]
ds_read_b128 a[44:47], v23 offset:46080
s_add_u32 m0, s56, 104832
v_mfma_f32_16x16x32_bf16 v[64:67], a[20:23], a[4:7], v[64:67]
buffer_load_dwordx4 v18, s[20:23], s54 offen lds
v_mfma_f32_16x16x32_bf16 v[68:71], a[20:23], a[8:11], v[68:71]
ds_read_b128 a[48:51], v23 offset:47104
v_add_f32 v164, v164, v168
v_mfma_f32_16x16x32_bf16 v[72:75], a[20:23], a[12:15], v[72:75]
ds_read_b128 a[52:55], v23 offset:48384
v_mfma_f32_16x16x32_bf16 v[244:247], a[20:23], a[16:19], v[244:247]
ds_read_b128 a[56:59], v23 offset:49408
v_mfma_f32_16x16x32_bf16 v[76:79], a[24:27], a[0:3], v[76:79]
buffer_load_dwordx4 v19, s[20:23], s54 offen offset:1024 lds
v_mfma_f32_16x16x32_bf16 v[80:83], a[24:27], a[4:7], v[80:83]
ds_read_b64_tr_b16 a[64:65], v25 offset:62080
v_mfma_f32_16x16x32_bf16 v[84:87], a[24:27], a[8:11], v[84:87]
ds_read_b64_tr_b16 a[66:67], v25 offset:62592
v_add_f32 v165, v165, v169
v_mfma_f32_16x16x32_bf16 v[88:91], a[24:27], a[12:15], v[88:91]
ds_read_b64_tr_b16 a[68:69], v25 offset:62112
v_mfma_f32_16x16x32_bf16 v[92:95], a[28:31], a[0:3], v[92:95]
buffer_load_dwordx4 v20, s[20:23], s54 offen offset:2048 lds
v_mfma_f32_16x16x32_bf16 v[96:99], a[28:31], a[4:7], v[96:99]
s_add_u32 s54, s54, 196608
s_waitcnt lgkmcnt(7)
v_mfma_f32_16x16x32_bf16 v[100:103], a[28:31], a[8:11], v[100:103]
ds_read_b64_tr_b16 a[70:71], v25 offset:62624
v_mfma_f32_16x16x32_bf16 v[104:107], a[28:31], a[12:15], v[104:107]
ds_read_b128 a[60:63], v24 offset:48128
s_add_u32 m0, s55, 27648
v_mfma_f32_16x16x32_bf16 v[156:159], a[28:31], a[16:19], v[156:159]
buffer_load_dwordx4 v21, s[16:19], s52 offen sc1 lds
v_mfma_f32_16x16x32_bf16 v[108:111], a[32:35], a[0:3], v[108:111]
v_add_f32 v166, v166, v170
v_mfma_f32_16x16x32_bf16 v[112:115], a[32:35], a[4:7], v[112:115]
ds_read_b64_tr_b16 a[72:73], v25 offset:63104
v_mfma_f32_16x16x32_bf16 v[116:119], a[32:35], a[8:11], v[116:119]
ds_read_b64_tr_b16 a[74:75], v25 offset:63616
v_mfma_f32_16x16x32_bf16 v[120:123], a[32:35], a[12:15], v[120:123]
buffer_load_dwordx4 v21, s[16:19], s52 offen offset:1024 sc1 lds
v_mfma_f32_16x16x32_bf16 v[160:163], a[32:35], a[16:19], v[160:163]
ds_read_b64_tr_b16 a[76:77], v25 offset:63136
v_mfma_f32_16x16x32_bf16 v[124:127], a[0:3], a[36:39], v[124:127]
ds_read_b64_tr_b16 a[78:79], v25 offset:63648
v_mfma_f32_16x16x32_bf16 v[128:131], a[4:7], a[36:39], v[128:131]
ds_read_b64_tr_b16 a[80:81], v25 offset:64128
v_add_f32 v167, v167, v171
v_mfma_f32_16x16x32_bf16 v[132:135], a[8:11], a[36:39], v[132:135]
buffer_load_dword v22, s[16:19], s52 offen offset:2048 sc1 lds
v_mfma_f32_16x16x32_bf16 v[136:139], a[12:15], a[36:39], v[136:139]
ds_read_b64_tr_b16 a[82:83], v25 offset:64640
s_add_u32 s52, s52, 0x20000
v_mfma_f32_16x16x32_bf16 v[140:143], a[0:3], a[40:43], v[140:143]
ds_read_b64_tr_b16 a[84:85], v25 offset:64160
v_mfma_f32_16x16x32_bf16 v[144:147], a[4:7], a[40:43], v[144:147]
ds_read_b64_tr_b16 a[86:87], v25 offset:64672
v_mfma_f32_16x16x32_bf16 v[148:151], a[8:11], a[40:43], v[148:151]
v_mfma_f32_16x16x32_bf16 v[152:155], a[12:15], a[40:43], v[152:155]
s_waitcnt vmcnt(19) lgkmcnt(6)
s_barrier
v_mfma_f32_16x16x32_bf16 v[60:63], a[64:67], a[44:47], v[60:63]
ds_read_b128 a[0:3], v23
s_add_u32 m0, s56, 117248
v_mfma_f32_16x16x32_bf16 v[64:67], a[64:67], a[48:51], v[64:67]
buffer_load_dwordx4 v18, s[20:23], s54 offen lds
v_mfma_f32_16x16x32_bf16 v[68:71], a[64:67], a[52:55], v[68:71]
ds_read_b128 a[4:7], v23 offset:1024
v_mfma_f32_16x16x32_bf16 v[72:75], a[64:67], a[56:59], v[72:75]
ds_read_b128 a[8:11], v23 offset:2304
v_mfma_f32_16x16x32_bf16 v[244:247], a[64:67], a[60:63], v[244:247]
ds_read_b128 a[12:15], v23 offset:3328
v_mfma_f32_16x16x32_bf16 v[76:79], a[68:71], a[44:47], v[76:79]
buffer_load_dwordx4 v19, s[20:23], s54 offen offset:1024 lds
v_mfma_f32_16x16x32_bf16 v[80:83], a[68:71], a[48:51], v[80:83]
ds_read_b64_tr_b16 a[20:21], v25
v_mfma_f32_16x16x32_bf16 v[84:87], a[68:71], a[52:55], v[84:87]
ds_read_b64_tr_b16 a[22:23], v25 offset:512
v_mfma_f32_16x16x32_bf16 v[88:91], a[68:71], a[56:59], v[88:91]
ds_read_b64_tr_b16 a[24:25], v25 offset:32
v_mfma_f32_16x16x32_bf16 v[92:95], a[72:75], a[44:47], v[92:95]
buffer_load_dwordx4 v20, s[20:23], s54 offen offset:2048 lds
v_mfma_f32_16x16x32_bf16 v[96:99], a[72:75], a[48:51], v[96:99]
s_add_u32 s54, s54, 196608
s_waitcnt lgkmcnt(7)
v_mfma_f32_16x16x32_bf16 v[100:103], a[72:75], a[52:55], v[100:103]
ds_read_b64_tr_b16 a[26:27], v25 offset:544
v_mfma_f32_16x16x32_bf16 v[104:107], a[72:75], a[56:59], v[104:107]
ds_read_b128 a[16:19], v24 offset:2048
s_add_u32 m0, s55, 36864
v_mfma_f32_16x16x32_bf16 v[156:159], a[72:75], a[60:63], v[156:159]
buffer_load_dwordx4 v21, s[16:19], s52 offen sc1 lds
v_mfma_f32_16x16x32_bf16 v[108:111], a[76:79], a[44:47], v[108:111]
v_mfma_f32_16x16x32_bf16 v[112:115], a[76:79], a[48:51], v[112:115]
ds_read_b64_tr_b16 a[28:29], v25 offset:1024
v_mfma_f32_16x16x32_bf16 v[116:119], a[76:79], a[52:55], v[116:119]
ds_read_b64_tr_b16 a[30:31], v25 offset:1536
v_mfma_f32_16x16x32_bf16 v[120:123], a[76:79], a[56:59], v[120:123]
buffer_load_dwordx4 v21, s[16:19], s52 offen offset:1024 sc1 lds
v_mfma_f32_16x16x32_bf16 v[160:163], a[76:79], a[60:63], v[160:163]
ds_read_b64_tr_b16 a[32:33], v25 offset:1056
v_mfma_f32_16x16x32_bf16 v[124:127], a[44:47], a[80:83], v[124:127]
ds_read_b64_tr_b16 a[34:35], v25 offset:1568
v_mfma_f32_16x16x32_bf16 v[128:131], a[48:51], a[80:83], v[128:131]
ds_read_b64_tr_b16 a[36:37], v25 offset:2048
v_mfma_f32_16x16x32_bf16 v[132:135], a[52:55], a[80:83], v[132:135]
buffer_load_dword v22, s[16:19], s52 offen offset:2048 sc1 lds
v_mfma_f32_16x16x32_bf16 v[136:139], a[56:59], a[80:83], v[136:139]
ds_read_b64_tr_b16 a[38:39], v25 offset:2560
s_add_u32 s52, s52, 0x20000
v_mfma_f32_16x16x32_bf16 v[140:143], a[44:47], a[84:87], v[140:143]
ds_read_b64_tr_b16 a[40:41], v25 offset:2080
v_mfma_f32_16x16x32_bf16 v[144:147], a[48:51], a[84:87], v[144:147]
ds_read_b64_tr_b16 a[42:43], v25 offset:2592
v_mfma_f32_16x16x32_bf16 v[148:151], a[52:55], a[84:87], v[148:151]
v_mfma_f32_16x16x32_bf16 v[152:155], a[56:59], a[84:87], v[152:155]
s_waitcnt vmcnt(19) lgkmcnt(6)
s_barrier
v_mfma_f32_16x16x32_bf16 v[60:63], a[20:23], a[0:3], v[60:63]
ds_read_b128 a[44:47], v23 offset:9216
s_add_u32 m0, s56, 129664
v_mfma_f32_16x16x32_bf16 v[64:67], a[20:23], a[4:7], v[64:67]
buffer_load_dwordx4 v18, s[20:23], s54 offen lds
v_mfma_f32_16x16x32_bf16 v[68:71], a[20:23], a[8:11], v[68:71]
ds_read_b128 a[48:51], v23 offset:10240
s_waitcnt vmcnt(19)
v_add_f32 v164, v164, v172
v_mfma_f32_16x16x32_bf16 v[72:75], a[20:23], a[12:15], v[72:75]
ds_read_b128 a[52:55], v23 offset:11520
v_mfma_f32_16x16x32_bf16 v[244:247], a[20:23], a[16:19], v[244:247]
ds_read_b128 a[56:59], v23 offset:12544
v_mfma_f32_16x16x32_bf16 v[76:79], a[24:27], a[0:3], v[76:79]
buffer_load_dwordx4 v19, s[20:23], s54 offen offset:1024 lds
v_mfma_f32_16x16x32_bf16 v[80:83], a[24:27], a[4:7], v[80:83]
ds_read_b64_tr_b16 a[64:65], v25 offset:12416
v_mfma_f32_16x16x32_bf16 v[84:87], a[24:27], a[8:11], v[84:87]
ds_read_b64_tr_b16 a[66:67], v25 offset:12928
v_add_f32 v165, v165, v173
v_mfma_f32_16x16x32_bf16 v[88:91], a[24:27], a[12:15], v[88:91]
ds_read_b64_tr_b16 a[68:69], v25 offset:12448
v_mfma_f32_16x16x32_bf16 v[92:95], a[28:31], a[0:3], v[92:95]
buffer_load_dwordx4 v20, s[20:23], s54 offen offset:2048 lds
v_mfma_f32_16x16x32_bf16 v[96:99], a[28:31], a[4:7], v[96:99]
s_add_u32 s54, s54, 196608
s_waitcnt lgkmcnt(7)
v_mfma_f32_16x16x32_bf16 v[100:103], a[28:31], a[8:11], v[100:103]
ds_read_b64_tr_b16 a[70:71], v25 offset:12960
v_mfma_f32_16x16x32_bf16 v[104:107], a[28:31], a[12:15], v[104:107]
ds_read_b128 a[60:63], v24 offset:11264
s_add_u32 m0, s55, 46080
v_mfma_f32_16x16x32_bf16 v[156:159], a[28:31], a[16:19], v[156:159]
buffer_load_dwordx4 v21, s[16:19], s52 offen sc1 lds
v_mfma_f32_16x16x32_bf16 v[108:111], a[32:35], a[0:3], v[108:111]
v_add_f32 v166, v166, v174
v_mfma_f32_16x16x32_bf16 v[112:115], a[32:35], a[4:7], v[112:115]
ds_read_b64_tr_b16 a[72:73], v25 offset:13440
v_mfma_f32_16x16x32_bf16 v[116:119], a[32:35], a[8:11], v[116:119]
ds_read_b64_tr_b16 a[74:75], v25 offset:13952
v_mfma_f32_16x16x32_bf16 v[120:123], a[32:35], a[12:15], v[120:123]
buffer_load_dwordx4 v21, s[16:19], s52 offen offset:1024 sc1 lds
v_mfma_f32_16x16x32_bf16 v[160:163], a[32:35], a[16:19], v[160:163]
ds_read_b64_tr_b16 a[76:77], v25 offset:13472
v_mfma_f32_16x16x32_bf16 v[124:127], a[0:3], a[36:39], v[124:127]
ds_read_b64_tr_b16 a[78:79], v25 offset:13984
v_mfma_f32_16x16x32_bf16 v[128:131], a[4:7], a[36:39], v[128:131]
ds_read_b64_tr_b16 a[80:81], v25 offset:14464
v_add_f32 v167, v167, v175
v_mfma_f32_16x16x32_bf16 v[132:135], a[8:11], a[36:39], v[132:135]
.Lpad2:
s_cbranch_execz .Lpad5
buffer_load_dword v22, s[16:19], s52 offen offset:2048 sc1 lds
v_mfma_f32_16x16x32_bf16 v[136:139], a[12:15], a[36:39], v[136:139]
ds_read_b64_tr_b16 a[82:83], v25 offset:14976
s_add_u32 s52, s52, 0x20000
v_mfma_f32_16x16x32_bf16 v[140:143], a[0:3], a[40:43], v[140:143]
ds_read_b64_tr_b16 a[84:85], v25 offset:14496
v_mfma_f32_16x16x32_bf16 v[144:147], a[4:7], a[40:43], v[144:147]
ds_read_b64_tr_b16 a[86:87], v25 offset:15008
v_mfma_f32_16x16x32_bf16 v[148:151], a[8:11], a[40:43], v[148:151]
v_mfma_f32_16x16x32_bf16 v[152:155], a[12:15], a[40:43], v[152:155]
s_waitcnt vmcnt(18) lgkmcnt(6)
s_barrier
v_mfma_f32_16x16x32_bf16 v[60:63], a[64:67], a[44:47], v[60:63]
s_add_u32 m0, s59, 0
s_mov_b32 s58, 1048576
v_permlane32_swap_b32 v164, v166
v_mfma_f32_16x16x32_bf16 v[64:67], a[64:67], a[48:51], v[64:67]
buffer_load_dwordx4 v5, s[24:27], s58 offen lds
v_mfma_f32_16x16x32_bf16 v[68:71], a[64:67], a[52:55], v[68:71]
ds_read_b128 a[0:3], v23 offset:18432
v_mfma_f32_16x16x32_bf16 v[72:75], a[64:67], a[56:59], v[72:75]
ds_read_b128 a[4:7], v23 offset:19456
v_permlane32_swap_b32 v165, v167
v_mfma_f32_16x16x32_bf16 v[244:247], a[64:67], a[60:63], v[244:247]
ds_read_b128 a[8:11], v23 offset:20736
v_mfma_f32_16x16x32_bf16 v[76:79], a[68:71], a[44:47], v[76:79]
buffer_load_dwordx4 v6, s[24:27], s58 offen offset:1024 lds
v_mfma_f32_16x16x32_bf16 v[80:83], a[68:71], a[48:51], v[80:83]
ds_read_b128 a[12:15], v23 offset:21760
v_add_f32 v164, v164, v166
v_mfma_f32_16x16x32_bf16 v[84:87], a[68:71], a[52:55], v[84:87]
ds_read_b64_tr_b16 a[20:21], v25 offset:24832
v_mfma_f32_16x16x32_bf16 v[88:91], a[68:71], a[56:59], v[88:91]
s_add_u32 m0, s59, 58240
s_mov_b32 s58, 1966080
v_mfma_f32_16x16x32_bf16 v[92:95], a[72:75], a[44:47], v[92:95]
buffer_load_dwordx4 v5, s[24:27], s58 offen lds
v_mfma_f32_16x16x32_bf16 v[96:99], a[72:75], a[48:51], v[96:99]
ds_read_b64_tr_b16 a[22:23], v25 offset:25344
s_waitcnt lgkmcnt(6)
v_mfma_f32_16x16x32_bf16 v[100:103], a[72:75], a[52:55], v[100:103]
ds_read_b64_tr_b16 a[24:25], v25 offset:24864
v_add_f32 v165, v165, v167
v_mfma_f32_16x16x32_bf16 v[104:107], a[72:75], a[56:59], v[104:107]
ds_read_b64_tr_b16 a[26:27], v25 offset:25376
v_mfma_f32_16x16x32_bf16 v[156:159], a[72:75], a[60:63], v[156:159]
buffer_load_dwordx4 v6, s[24:27], s58 offen offset:1024 lds
v_mfma_f32_16x16x32_bf16 v[108:111], a[76:79], a[44:47], v[108:111]
ds_read_b128 a[16:19], v24 offset:20480
v_mul_f32 v164, 0xba800000, v164
v_mfma_f32_16x16x32_bf16 v[112:115], a[76:79], a[48:51], v[112:115]
ds_read_b64_tr_b16 a[28:29], v25 offset:25856
v_mfma_f32_16x16x32_bf16 v[116:119], a[76:79], a[52:55], v[116:119]
s_add_u32 m0, s59, 66560
s_mov_b32 s58, 0
v_mul_f32 v165, 0x3a800000, v165
v_mfma_f32_16x16x32_bf16 v[120:123], a[76:79], a[56:59], v[120:123]
buffer_load_dwordx4 v5, s[24:27], s58 offen lds
v_mfma_f32_16x16x32_bf16 v[160:163], a[76:79], a[60:63], v[160:163]
ds_read_b64_tr_b16 a[30:31], v25 offset:26368
v_mfma_f32_16x16x32_bf16 v[124:127], a[44:47], a[80:83], v[124:127]
ds_read_b64_tr_b16 a[32:33], v25 offset:25888
v_mfma_f32_16x16x32_bf16 v[128:131], a[48:51], a[80:83], v[128:131]
ds_read_b64_tr_b16 a[34:35], v25 offset:26400
v_fma_f32 v165, -v164, v164, v165
v_mfma_f32_16x16x32_bf16 v[132:135], a[52:55], a[80:83], v[132:135]
buffer_load_dwordx4 v6, s[24:27], s58 offen offset:1024 lds
v_mfma_f32_16x16x32_bf16 v[136:139], a[56:59], a[80:83], v[136:139]
ds_read_b64_tr_b16 a[36:37], v25 offset:26880
v_mfma_f32_16x16x32_bf16 v[140:143], a[44:47], a[84:87], v[140:143]
ds_read_b64_tr_b16 a[38:39], v25 offset:27392
v_max_f32 v165, 0, v165
v_mfma_f32_16x16x32_bf16 v[144:147], a[48:51], a[84:87], v[144:147]
ds_read_b64_tr_b16 a[40:41], v25 offset:26912
v_mfma_f32_16x16x32_bf16 v[148:151], a[52:55], a[84:87], v[148:151]
ds_read_b64_tr_b16 a[42:43], v25 offset:27424
v_mfma_f32_16x16x32_bf16 v[152:155], a[56:59], a[84:87], v[152:155]
s_waitcnt vmcnt(18) lgkmcnt(6)
s_barrier
v_mfma_f32_16x16x32_bf16 v[60:63], a[20:23], a[0:3], v[60:63]
s_add_u32 m0, s59, 8320
s_mov_b32 s58, 1179648
v_add_f32 v165, 0x3727c5ac, v165
v_mfma_f32_16x16x32_bf16 v[64:67], a[20:23], a[4:7], v[64:67]
buffer_load_dwordx4 v5, s[24:27], s58 offen lds
v_mfma_f32_16x16x32_bf16 v[68:71], a[20:23], a[8:11], v[68:71]
ds_read_b128 a[44:47], v23 offset:27648
v_mfma_f32_16x16x32_bf16 v[72:75], a[20:23], a[12:15], v[72:75]
ds_read_b128 a[48:51], v23 offset:28672
v_mfma_f32_16x16x32_bf16 v[244:247], a[20:23], a[16:19], v[244:247]
ds_read_b128 a[52:55], v23 offset:29952
v_mfma_f32_16x16x32_bf16 v[76:79], a[24:27], a[0:3], v[76:79]
buffer_load_dwordx4 v6, s[24:27], s58 offen offset:1024 lds
v_mfma_f32_16x16x32_bf16 v[80:83], a[24:27], a[4:7], v[80:83]
ds_read_b128 a[56:59], v23 offset:30976
v_rsq_f32 v166, v165
v_mfma_f32_16x16x32_bf16 v[84:87], a[24:27], a[8:11], v[84:87]
ds_read_b64_tr_b16 a[64:65], v25 offset:37248
v_mfma_f32_16x16x32_bf16 v[88:91], a[24:27], a[12:15], v[88:91]
s_add_u32 m0, s59, 74880
s_mov_b32 s58, 131072
v_mfma_f32_16x16x32_bf16 v[92:95], a[28:31], a[0:3], v[92:95]
buffer_load_dwordx4 v5, s[24:27], s58 offen lds
v_mfma_f32_16x16x32_bf16 v[96:99], a[28:31], a[4:7], v[96:99]
ds_read_b64_tr_b16 a[66:67], v25 offset:37760
s_waitcnt lgkmcnt(6)
v_mfma_f32_16x16x32_bf16 v[100:103], a[28:31], a[8:11], v[100:103]
ds_read_b64_tr_b16 a[68:69], v25 offset:37280
v_mfma_f32_16x16x32_bf16 v[104:107], a[28:31], a[12:15], v[104:107]
ds_read_b64_tr_b16 a[70:71], v25 offset:37792
v_mfma_f32_16x16x32_bf16 v[156:159], a[28:31], a[16:19], v[156:159]
buffer_load_dwordx4 v6, s[24:27], s58 offen offset:1024 lds
v_mfma_f32_16x16x32_bf16 v[108:111], a[32:35], a[0:3], v[108:111]
ds_read_b128 a[60:63], v24 offset:29696
v_mov_b32 v165, v166
v_mfma_f32_16x16x32_bf16 v[112:115], a[32:35], a[4:7], v[112:115]
ds_read_b64_tr_b16 a[72:73], v25 offset:38272
v_mfma_f32_16x16x32_bf16 v[116:119], a[32:35], a[8:11], v[116:119]
s_add_u32 m0, s59, 83200
s_mov_b32 s58, 262144
v_mfma_f32_16x16x32_bf16 v[120:123], a[32:35], a[12:15], v[120:123]
buffer_load_dwordx4 v5, s[24:27], s58 offen lds
v_mfma_f32_16x16x32_bf16 v[160:163], a[32:35], a[16:19], v[160:163]
ds_read_b64_tr_b16 a[74:75], v25 offset:38784
v_mfma_f32_16x16x32_bf16 v[124:127], a[0:3], a[36:39], v[124:127]
ds_read_b64_tr_b16 a[76:77], v25 offset:38304
v_mfma_f32_16x16x32_bf16 v[128:131], a[4:7], a[36:39], v[128:131]
ds_read_b64_tr_b16 a[78:79], v25 offset:38816
v_mul_f32 v166, 0x3e8293ee, v166
v_mfma_f32_16x16x32_bf16 v[132:135], a[8:11], a[36:39], v[132:135]
buffer_load_dwordx4 v6, s[24:27], s58 offen offset:1024 lds
v_mfma_f32_16x16x32_bf16 v[136:139], a[12:15], a[36:39], v[136:139]
ds_read_b64_tr_b16 a[80:81], v25 offset:39296
v_mfma_f32_16x16x32_bf16 v[140:143], a[0:3], a[40:43], v[140:143]
ds_read_b64_tr_b16 a[82:83], v25 offset:39808
v_mfma_f32_16x16x32_bf16 v[144:147], a[4:7], a[40:43], v[144:147]
ds_read_b64_tr_b16 a[84:85], v25 offset:39328
v_mfma_f32_16x16x32_bf16 v[148:151], a[8:11], a[40:43], v[148:151]
ds_read_b64_tr_b16 a[86:87], v25 offset:39840
v_mfma_f32_16x16x32_bf16 v[152:155], a[12:15], a[40:43], v[152:155]
s_waitcnt vmcnt(18) lgkmcnt(6)
s_barrier
v_mfma_f32_16x16x32_bf16 v[60:63], a[64:67], a[44:47], v[60:63]
s_add_u32 m0, s59, 16640
s_mov_b32 s58, 1310720
ds_write_b128 v7, v[164:167]
v_mfma_f32_16x16x32_bf16 v[64:67], a[64:67], a[48:51], v[64:67]
buffer_load_dwordx4 v5, s[24:27], s58 offen lds
v_mfma_f32_16x16x32_bf16 v[68:71], a[64:67], a[52:55], v[68:71]
ds_read_b128 a[0:3], v23 offset:36864
v_mfma_f32_16x16x32_bf16 v[72:75], a[64:67], a[56:59], v[72:75]
ds_read_b128 a[4:7], v23 offset:37888
v_mfma_f32_16x16x32_bf16 v[244:247], a[64:67], a[60:63], v[244:247]
ds_read_b128 a[8:11], v23 offset:39168
v_mfma_f32_16x16x32_bf16 v[76:79], a[68:71], a[44:47], v[76:79]
ds_read_b128 a[12:15], v23 offset:40192
v_mfma_f32_16x16x32_bf16 v[80:83], a[68:71], a[48:51], v[80:83]
ds_read_b64_tr_b16 a[20:21], v25 offset:49664
v_mfma_f32_16x16x32_bf16 v[84:87], a[68:71], a[52:55], v[84:87]
buffer_load_dwordx4 v6, s[24:27], s58 offen offset:1024 lds
v_mfma_f32_16x16x32_bf16 v[88:91], a[68:71], a[56:59], v[88:91]
ds_read_b64_tr_b16 a[22:23], v25 offset:50176
v_mfma_f32_16x16x32_bf16 v[92:95], a[72:75], a[44:47], v[92:95]
ds_write_b32 v17, v164
v_mfma_f32_16x16x32_bf16 v[96:99], a[72:75], a[48:51], v[96:99]
ds_read_b64_tr_b16 a[24:25], v25 offset:49696
s_waitcnt lgkmcnt(9)
v_mfma_f32_16x16x32_bf16 v[100:103], a[72:75], a[52:55], v[100:103]
ds_read_b64_tr_b16 a[26:27], v25 offset:50208
v_mfma_f32_16x16x32_bf16 v[104:107], a[72:75], a[56:59], v[104:107]
s_add_u32 m0, s59, 91520
s_mov_b32 s58, 393216
v_mfma_f32_16x16x32_bf16 v[156:159], a[72:75], a[60:63], v[156:159]
buffer_load_dwordx4 v5, s[24:27], s58 offen lds
v_mfma_f32_16x16x32_bf16 v[108:111], a[76:79], a[44:47], v[108:111]
ds_read_b128 a[16:19], v24 offset:38912
v_mfma_f32_16x16x32_bf16 v[112:115], a[76:79], a[48:51], v[112:115]
ds_read_b64_tr_b16 a[28:29], v25 offset:50688
v_mfma_f32_16x16x32_bf16 v[116:119], a[76:79], a[52:55], v[116:119]
ds_read_b64_tr_b16 a[30:31], v25 offset:51200
v_mfma_f32_16x16x32_bf16 v[120:123], a[76:79], a[56:59], v[120:123]
ds_read_b64_tr_b16 a[32:33], v25 offset:50720
v_mfma_f32_16x16x32_bf16 v[160:163], a[76:79], a[60:63], v[160:163]
ds_write_b32 v17, v165 offset:1024
v_mfma_f32_16x16x32_bf16 v[124:127], a[44:47], a[80:83], v[124:127]
buffer_load_dwordx4 v6, s[24:27], s58 offen offset:1024 lds
v_mfma_f32_16x16x32_bf16 v[128:131], a[48:51], a[80:83], v[128:131]
ds_read_b64_tr_b16 a[34:35], v25 offset:51232
v_mfma_f32_16x16x32_bf16 v[132:135], a[52:55], a[80:83], v[132:135]
ds_read_b64_tr_b16 a[36:37], v25 offset:51712
v_mfma_f32_16x16x32_bf16 v[136:139], a[56:59], a[80:83], v[136:139]
ds_read_b64_tr_b16 a[38:39], v25 offset:52224
v_mfma_f32_16x16x32_bf16 v[140:143], a[44:47], a[84:87], v[140:143]
ds_read_b64_tr_b16 a[40:41], v25 offset:51744
v_mfma_f32_16x16x32_bf16 v[144:147], a[48:51], a[84:87], v[144:147]
ds_read_b64_tr_b16 a[42:43], v25 offset:52256
v_mfma_f32_16x16x32_bf16 v[148:151], a[52:55], a[84:87], v[148:151]
v_mfma_f32_16x16x32_bf16 v[152:155], a[56:59], a[84:87], v[152:155]
s_waitcnt vmcnt(16) lgkmcnt(7)
s_barrier
v_mfma_f32_16x16x32_bf16 v[60:63], a[20:23], a[0:3], v[60:63]
s_add_u32 m0, s59, 24960
s_mov_b32 s58, 1441792
v_mfma_f32_16x16x32_bf16 v[64:67], a[20:23], a[4:7], v[64:67]
buffer_load_dwordx4 v5, s[24:27], s58 offen lds
v_mfma_f32_16x16x32_bf16 v[68:71], a[20:23], a[8:11], v[68:71]
ds_read_b128 a[44:47], v23 offset:46080
v_mfma_f32_16x16x32_bf16 v[72:75], a[20:23], a[12:15], v[72:75]
ds_read_b128 a[48:51], v23 offset:47104
v_mfma_f32_16x16x32_bf16 v[244:247], a[20:23], a[16:19], v[244:247]
ds_read_b128 a[52:55], v23 offset:48384
v_mfma_f32_16x16x32_bf16 v[76:79], a[24:27], a[0:3], v[76:79]
buffer_load_dwordx4 v6, s[24:27], s58 offen offset:1024 lds
v_mfma_f32_16x16x32_bf16 v[80:83], a[24:27], a[4:7], v[80:83]
ds_read_b128 a[56:59], v23 offset:49408
v_mfma_f32_16x16x32_bf16 v[84:87], a[24:27], a[8:11], v[84:87]
ds_read_b64_tr_b16 a[64:65], v25 offset:62080
v_mfma_f32_16x16x32_bf16 v[88:91], a[24:27], a[12:15], v[88:91]
s_add_u32 m0, s59, 99840
s_mov_b32 s58, 524288
v_mfma_f32_16x16x32_bf16 v[92:95], a[28:31], a[0:3], v[92:95]
buffer_load_dwordx4 v5, s[24:27], s58 offen lds
v_mfma_f32_16x16x32_bf16 v[96:99], a[28:31], a[4:7], v[96:99]
ds_read_b64_tr_b16 a[66:67], v25 offset:62592
s_waitcnt lgkmcnt(6)
v_mfma_f32_16x16x32_bf16 v[100:103], a[28:31], a[8:11], v[100:103]
ds_read_b64_tr_b16 a[68:69], v25 offset:62112
v_mfma_f32_16x16x32_bf16 v[104:107], a[28:31], a[12:15], v[104:107]
ds_read_b64_tr_b16 a[70:71], v25 offset:62624
v_mfma_f32_16x16x32_bf16 v[156:159], a[28:31], a[16:19], v[156:159]
buffer_load_dwordx4 v6, s[24:27], s58 offen offset:1024 lds
v_mfma_f32_16x16x32_bf16 v[108:111], a[32:35], a[0:3], v[108:111]
ds_read_b128 a[60:63], v24 offset:48128
v_mfma_f32_16x16x32_bf16 v[112:115], a[32:35], a[4:7], v[112:115]
ds_read_b64_tr_b16 a[72:73], v25 offset:63104
v_mfma_f32_16x16x32_bf16 v[116:119], a[32:35], a[8:11], v[116:119]
s_add_u32 m0, s59, 108160
s_mov_b32 s58, 655360
v_mfma_f32_16x16x32_bf16 v[120:123], a[32:35], a[12:15], v[120:123]
buffer_load_dwordx4 v5, s[24:27], s58 offen lds
v_mfma_f32_16x16x32_bf16 v[160:163], a[32:35], a[16:19], v[160:163]
ds_read_b64_tr_b16 a[74:75], v25 offset:63616
v_mfma_f32_16x16x32_bf16 v[124:127], a[0:3], a[36:39], v[124:127]
ds_read_b64_tr_b16 a[76:77], v25 offset:63136
v_mfma_f32_16x16x32_bf16 v[128:131], a[4:7], a[36:39], v[128:131]
ds_read_b64_tr_b16 a[78:79], v25 offset:63648
v_mfma_f32_16x16x32_bf16 v[132:135], a[8:11], a[36:39], v[132:135]
buffer_load_dwordx4 v6, s[24:27], s58 offen offset:1024 lds
v_mfma_f32_16x16x32_bf16 v[136:139], a[12:15], a[36:39], v[136:139]
ds_read_b64_tr_b16 a[80:81], v25 offset:64128
v_mfma_f32_16x16x32_bf16 v[140:143], a[0:3], a[40:43], v[140:143]
ds_read_b64_tr_b16 a[82:83], v25 offset:64640
v_mfma_f32_16x16x32_bf16 v[144:147], a[4:7], a[40:43], v[144:147]
ds_read_b64_tr_b16 a[84:85], v25 offset:64160
v_mfma_f32_16x16x32_bf16 v[148:151], a[8:11], a[40:43], v[148:151]
ds_read_b64_tr_b16 a[86:87], v25 offset:64672
v_mfma_f32_16x16x32_bf16 v[152:155], a[12:15], a[40:43], v[152:155]
s_waitcnt lgkmcnt(0)
s_barrier
v_mfma_f32_16x16x32_bf16 v[244:247], a[64:67], a[60:63], v[244:247]
ds_read_b128 v[232:235], v10 offset:768
v_mfma_f32_16x16x32_bf16 v[156:159], a[72:75], a[60:63], v[156:159]
ds_read_b128 v[236:239], v10 offset:2816
v_mfma_f32_16x16x32_bf16 v[160:163], a[76:79], a[60:63], v[160:163]
ds_read_b128 v[228:231], v10 offset:512
v_mfma_f32_16x16x32_bf16 v[104:107], a[72:75], a[56:59], v[104:107]
ds_read_b128 v[224:227], v10 offset:256
v_mfma_f32_16x16x32_bf16 v[120:123], a[76:79], a[56:59], v[120:123]
ds_read_b128 v[220:223], v10
v_mfma_f32_16x16x32_bf16 v[136:139], a[56:59], a[80:83], v[136:139]
v_mfma_f32_16x16x32_bf16 v[152:155], a[56:59], a[84:87], v[152:155]
v_mfma_f32_16x16x32_bf16 v[100:103], a[72:75], a[52:55], v[100:103]
v_mfma_f32_16x16x32_bf16 v[116:119], a[76:79], a[52:55], v[116:119]
s_mov_b32 exec_lo, 0x10001
s_mov_b32 exec_hi, 0x10001
ds_write_b128 v13, v[244:247]
ds_write_b128 v13, v[156:159] offset:256
ds_write_b128 v13, v[160:163] offset:320
s_mov_b64 exec, -1
v_mfma_f32_16x16x32_bf16 v[96:99], a[72:75], a[48:51], v[96:99]
v_mfma_f32_16x16x32_bf16 v[112:115], a[76:79], a[48:51], v[112:115]
v_mfma_f32_16x16x32_bf16 v[92:95], a[72:75], a[44:47], v[92:95]
v_mfma_f32_16x16x32_bf16 v[108:111], a[76:79], a[44:47], v[108:111]
v_mfma_f32_16x16x32_bf16 v[72:75], a[64:67], a[56:59], v[72:75]
v_mfma_f32_16x16x32_bf16 v[88:91], a[68:71], a[56:59], v[88:91]
s_waitcnt lgkmcnt(0)
s_barrier
v_mfma_f32_16x16x32_bf16 v[132:135], a[52:55], a[80:83], v[132:135]
ds_read_b128 v[28:31], v13
s_add_u32 m0, s59, 33280
v_mfma_f32_16x16x32_bf16 v[148:151], a[52:55], a[84:87], v[148:151]
ds_read_b128 v[32:35], v13 offset:64
s_mov_b32 s58, 1572864
v_mfma_f32_16x16x32_bf16 v[68:71], a[64:67], a[52:55], v[68:71]
ds_read_b128 v[36:39], v13 offset:256
v_mfma_f32_16x16x32_bf16 v[84:87], a[68:71], a[52:55], v[84:87]
ds_read_b128 v[40:43], v13 offset:320
v_mfma_f32_16x16x32_bf16 v[128:131], a[48:51], a[80:83], v[128:131]
ds_read_b32 v44, v12 offset:512
v_mfma_f32_16x16x32_bf16 v[144:147], a[48:51], a[84:87], v[144:147]
ds_read_b32 v45, v12 offset:576
v_mfma_f32_16x16x32_bf16 v[64:67], a[64:67], a[48:51], v[64:67]
ds_read_b128 v[240:243], v11 offset:192
v_mfma_f32_16x16x32_bf16 v[80:83], a[68:71], a[48:51], v[80:83]
ds_read_b128 v[244:247], v11 offset:1216
v_mfma_f32_16x16x32_bf16 v[124:127], a[44:47], a[80:83], v[124:127]
buffer_load_dwordx4 v5, s[24:27], s58 offen lds
ds_read_b128 v[18:21], v11 offset:128
s_waitcnt lgkmcnt(8)
v_pk_fma_f32 v[72:73], v[28:29], v[232:233], v[72:73] op_sel_hi:[1,0,1]
v_pk_fma_f32 v[74:75], v[30:31], v[232:233], v[74:75] op_sel_hi:[1,0,1]
s_waitcnt lgkmcnt(6)
v_pk_fma_f32 v[104:105], v[36:37], v[232:233], v[104:105] op_sel_hi:[1,0,1]
v_pk_mul_f32 v[104:105], v[104:105], v[232:233] op_sel:[0,1] op_sel_hi:[1,1]
v_pk_fma_f32 v[106:107], v[38:39], v[232:233], v[106:107] op_sel_hi:[1,0,1]
v_pk_mul_f32 v[106:107], v[106:107], v[232:233] op_sel:[0,1] op_sel_hi:[1,1]
s_waitcnt lgkmcnt(5)
v_pk_fma_f32 v[120:121], v[40:41], v[232:233], v[120:121] op_sel_hi:[1,0,1]
v_pk_mul_f32 v[120:121], v[120:121], v[232:233] op_sel:[0,1] op_sel_hi:[1,1]
v_pk_fma_f32 v[122:123], v[42:43], v[232:233], v[122:123] op_sel_hi:[1,0,1]
v_pk_mul_f32 v[122:123], v[122:123], v[232:233] op_sel:[0,1] op_sel_hi:[1,1]
v_pk_fma_f32 v[100:101], v[36:37], v[228:229], v[100:101] op_sel_hi:[1,0,1]
v_pk_mul_f32 v[100:101], v[100:101], v[228:229] op_sel:[0,1] op_sel_hi:[1,1]
v_pk_fma_f32 v[102:103], v[38:39], v[228:229], v[102:103] op_sel_hi:[1,0,1]
v_pk_mul_f32 v[102:103], v[102:103], v[228:229] op_sel:[0,1] op_sel_hi:[1,1]
v_pk_fma_f32 v[116:117], v[40:41], v[228:229], v[116:117] op_sel_hi:[1,0,1]
v_pk_mul_f32 v[116:117], v[116:117], v[228:229] op_sel:[0,1] op_sel_hi:[1,1]
v_pk_fma_f32 v[118:119], v[42:43], v[228:229], v[118:119] op_sel_hi:[1,0,1]
v_pk_mul_f32 v[118:119], v[118:119], v[228:229] op_sel:[0,1] op_sel_hi:[1,1]
s_waitcnt lgkmcnt(2)
v_pk_fma_f32 v[136:137], v[240:241], v[44:45], v[136:137] op_sel_hi:[1,0,1]
v_pk_fma_f32 v[138:139], v[242:243], v[44:45], v[138:139] op_sel_hi:[1,0,1]
v_pk_fma_f32 v[152:153], v[240:241], v[44:45], v[152:153] op_sel:[0,1,0] op_sel_hi:[1,1,1]
v_pk_fma_f32 v[154:155], v[242:243], v[44:45], v[154:155] op_sel:[0,1,0] op_sel_hi:[1,1,1]
s_waitcnt lgkmcnt(1)
v_pk_mul_f32 v[136:137], v[136:137], v[244:245]
v_pk_mul_f32 v[138:139], v[138:139], v[246:247]
v_pk_mul_f32 v[152:153], v[152:153], v[244:245]
v_pk_mul_f32 v[154:155], v[154:155], v[246:247]
v_pk_fma_f32 v[88:89], v[32:33], v[232:233], v[88:89] op_sel_hi:[1,0,1]
v_pk_fma_f32 v[90:91], v[34:35], v[232:233], v[90:91] op_sel_hi:[1,0,1]
v_pk_fma_f32 v[96:97], v[36:37], v[224:225], v[96:97] op_sel_hi:[1,0,1]
s_waitcnt lgkmcnt(0)
v_pk_fma_f32 v[132:133], v[18:19], v[44:45], v[132:133] op_sel_hi:[1,0,1]
v_pk_fma_f32 v[134:135], v[20:21], v[44:45], v[134:135] op_sel_hi:[1,0,1]
v_pk_fma_f32 v[148:149], v[18:19], v[44:45], v[148:149] op_sel:[0,1,0] op_sel_hi:[1,1,1]
v_pk_fma_f32 v[150:151], v[20:21], v[44:45], v[150:151] op_sel:[0,1,0] op_sel_hi:[1,1,1]
v_pk_mul_f32 v[96:97], v[96:97], v[224:225] op_sel:[0,1] op_sel_hi:[1,1]
v_pk_fma_f32 v[98:99], v[38:39], v[224:225], v[98:99] op_sel_hi:[1,0,1]
v_pk_mul_f32 v[98:99], v[98:99], v[224:225] op_sel:[0,1] op_sel_hi:[1,1]
v_pk_fma_f32 v[112:113], v[40:41], v[224:225], v[112:113] op_sel_hi:[1,0,1]
v_pk_mul_f32 v[112:113], v[112:113], v[224:225] op_sel:[0,1] op_sel_hi:[1,1]
v_pk_fma_f32 v[114:115], v[42:43], v[224:225], v[114:115] op_sel_hi:[1,0,1]
v_pk_mul_f32 v[114:115], v[114:115], v[224:225] op_sel:[0,1] op_sel_hi:[1,1]
v_pk_fma_f32 v[68:69], v[28:29], v[228:229], v[68:69] op_sel_hi:[1,0,1]
v_pk_fma_f32 v[70:71], v[30:31], v[228:229], v[70:71] op_sel_hi:[1,0,1]
v_pk_fma_f32 v[84:85], v[32:33], v[228:229], v[84:85] op_sel_hi:[1,0,1]
v_pk_fma_f32 v[86:87], v[34:35], v[228:229], v[86:87] op_sel_hi:[1,0,1]
v_pk_fma_f32 v[92:93], v[36:37], v[220:221], v[92:93] op_sel_hi:[1,0,1]
v_pk_mul_f32 v[92:93], v[92:93], v[220:221] op_sel:[0,1] op_sel_hi:[1,1]
v_pk_fma_f32 v[94:95], v[38:39], v[220:221], v[94:95] op_sel_hi:[1,0,1]
v_pk_mul_f32 v[94:95], v[94:95], v[220:221] op_sel:[0,1] op_sel_hi:[1,1]
v_pk_fma_f32 v[108:109], v[40:41], v[220:221], v[108:109] op_sel_hi:[1,0,1]
v_pk_mul_f32 v[108:109], v[108:109], v[220:221] op_sel:[0,1] op_sel_hi:[1,1]
v_pk_fma_f32 v[110:111], v[42:43], v[220:221], v[110:111] op_sel_hi:[1,0,1]
v_pk_mul_f32 v[110:111], v[110:111], v[220:221] op_sel:[0,1] op_sel_hi:[1,1]
v_pk_fma_f32 v[64:65], v[28:29], v[224:225], v[64:65] op_sel_hi:[1,0,1]
v_pk_fma_f32 v[66:67], v[30:31], v[224:225], v[66:67] op_sel_hi:[1,0,1]
v_pk_fma_f32 v[80:81], v[32:33], v[224:225], v[80:81] op_sel_hi:[1,0,1]
v_pk_fma_f32 v[82:83], v[34:35], v[224:225], v[82:83] op_sel_hi:[1,0,1]
v_pk_fma_f32 v[156:157], v[36:37], v[236:237], v[156:157] op_sel_hi:[1,0,1]
v_pk_mul_f32 v[156:157], v[156:157], v[236:237] op_sel:[0,1] op_sel_hi:[1,1]
v_pk_fma_f32 v[158:159], v[38:39], v[236:237], v[158:159] op_sel_hi:[1,0,1]
v_pk_mul_f32 v[158:159], v[158:159], v[236:237] op_sel:[0,1] op_sel_hi:[1,1]
v_pk_fma_f32 v[160:161], v[40:41], v[236:237], v[160:161] op_sel_hi:[1,0,1]
v_pk_mul_f32 v[160:161], v[160:161], v[236:237] op_sel:[0,1] op_sel_hi:[1,1]
v_pk_fma_f32 v[162:163], v[42:43], v[236:237], v[162:163] op_sel_hi:[1,0,1]
v_pk_mul_f32 v[162:163], v[162:163], v[236:237] op_sel:[0,1] op_sel_hi:[1,1]
v_cvt_pk_bf16_f32 v196, v104, v105
v_cvt_pk_bf16_f32 v197, v106, v107
v_mfma_f32_16x16x32_bf16 v[140:143], a[44:47], a[84:87], v[140:143]
buffer_load_dwordx4 v6, s[24:27], s58 offen offset:1024 lds
v_mfma_f32_16x16x32_bf16 v[60:63], a[64:67], a[44:47], v[60:63]
s_add_u32 m0, s59, 41600
v_cvt_pk_bf16_f32 v198, v120, v121
v_cvt_pk_bf16_f32 v199, v122, v123
v_mfma_f32_16x16x32_bf16 v[76:79], a[68:71], a[44:47], v[76:79]
ds_write_b128 v8, v[196:199]
v_cvt_pk_bf16_f32 v208, v136, v137
v_cvt_pk_bf16_f32 v209, v138, v139
v_cvt_pk_bf16_f32 v218, v152, v153
v_cvt_pk_bf16_f32 v219, v154, v155
ds_write_b64 v8, v[208:209] offset:1024
ds_write_b64 v8, v[218:219] offset:1032
s_mov_b32 s58, 1703936
buffer_load_dwordx4 v5, s[24:27], s58 offen lds
v_cvt_pk_bf16_f32 v192, v100, v101
v_cvt_pk_bf16_f32 v193, v102, v103
v_cvt_pk_bf16_f32 v194, v116, v117
v_cvt_pk_bf16_f32 v195, v118, v119
v_cvt_pk_bf16_f32 v176, v72, v73
v_cvt_pk_bf16_f32 v177, v74, v75
v_cvt_pk_bf16_f32 v178, v88, v89
v_cvt_pk_bf16_f32 v179, v90, v91
v_pk_fma_f32 v[60:61], v[28:29], v[220:221], v[60:61] op_sel_hi:[1,0,1]
v_pk_fma_f32 v[62:63], v[30:31], v[220:221], v[62:63] op_sel_hi:[1,0,1]
v_pk_fma_f32 v[76:77], v[32:33], v[220:221], v[76:77] op_sel_hi:[1,0,1]
v_pk_fma_f32 v[78:79], v[34:35], v[220:221], v[78:79] op_sel_hi:[1,0,1]
ds_read_b128 v[22:25], v11 offset:1152
s_nop 0
v_mfma_f32_16x16x32_bf16 v[104:107], v[192:195], v[176:179], v[46:49]
buffer_load_dwordx4 v6, s[24:27], s58 offen offset:1024 lds
v_mfma_f32_16x16x32_bf16 v[120:123], v[196:199], v[176:179], v[50:53]
s_add_u32 m0, s59, 49920
s_mov_b32 s58, 1835008
v_cvt_pk_bf16_f32 v188, v96, v97
v_cvt_pk_bf16_f32 v189, v98, v99
s_nop 1
v_max3_f32 v88, v104, v105, v106
v_cvt_pk_bf16_f32 v190, v112, v113
v_cvt_pk_bf16_f32 v191, v114, v115
s_waitcnt lgkmcnt(1)
s_barrier
ds_read_b64 v[200:201], v9 offset:1024
ds_read_b64 v[210:211], v9 offset:1032
buffer_load_dwordx4 v5, s[24:27], s58 offen lds
v_max3_f32 v89, v107, v120, v121
v_max3_f32 v88, v88, v122, v123
v_max_f32 v90, v88, v89
v_max_f32 v89, v88, v89
v_cvt_pk_bf16_f32 v172, v68, v69
v_cvt_pk_bf16_f32 v173, v70, v71
v_permlane16_swap_b32 v90, v89
v_cvt_pk_bf16_f32 v174, v84, v85
v_max_f32 v88, v90, v89
s_waitcnt lgkmcnt(2)
v_pk_mul_f32 v[132:133], v[132:133], v[22:23]
v_cvt_pk_bf16_f32 v206, v132, v133
v_pk_mul_f32 v[134:135], v[134:135], v[24:25]
buffer_load_dwordx4 v6, s[24:27], s58 offen offset:1024 lds
s_add_u32 m0, s59, 116480
s_mov_b32 s58, 786432
v_cvt_pk_bf16_f32 v207, v134, v135
v_pk_mul_f32 v[148:149], v[148:149], v[22:23]
v_cvt_pk_bf16_f32 v216, v148, v149
v_pk_mul_f32 v[150:151], v[150:151], v[24:25]
v_cvt_pk_bf16_f32 v217, v150, v151
v_max_f32 v89, v90, v89
v_cvt_pk_bf16_f32 v175, v86, v87
ds_read_b128 v[240:243], v11 offset:64
s_nop 0
v_mfma_f32_16x16x32_bf16 v[100:103], v[188:191], v[172:175], v[46:49]
ds_read_b128 v[244:247], v11 offset:1088
v_permlane32_swap_b32 v88, v89
v_mfma_f32_16x16x32_bf16 v[116:119], v[192:195], v[172:175], v[50:53]
buffer_load_dwordx4 v5, s[24:27], s58 offen lds
v_max_f32 v88, v88, v89
v_mul_f32 v88, v88, v234
s_nop 1
v_max3_f32 v84, v100, v101, v102
v_pk_fma_f32 v[104:105], v[104:105], v[234:235], v[88:89] op_sel_hi:[1,0,0] neg_lo:[0,0,1] neg_hi:[0,0,1]
v_pk_fma_f32 v[106:107], v[106:107], v[234:235], v[88:89] op_sel_hi:[1,0,0] neg_lo:[0,0,1] neg_hi:[0,0,1]
v_pk_fma_f32 v[120:121], v[120:121], v[234:235], v[88:89] op_sel_hi:[1,0,0] neg_lo:[0,0,1] neg_hi:[0,0,1]
v_pk_fma_f32 v[122:123], v[122:123], v[234:235], v[88:89] op_sel_hi:[1,0,0] neg_lo:[0,0,1] neg_hi:[0,0,1]
v_exp_f32 v104, v104
v_exp_f32 v105, v105
v_exp_f32 v106, v106
v_exp_f32 v107, v107
v_exp_f32 v120, v120
v_exp_f32 v121, v121
v_exp_f32 v122, v122
v_exp_f32 v123, v123
v_cvt_pk_bf16_f32 v72, v104, v105
buffer_load_dwordx4 v6, s[24:27], s58 offen offset:1024 lds
s_add_u32 m0, s59, 124800
s_mov_b32 s58, 917504
v_cvt_pk_bf16_f32 v73, v106, v107
v_cvt_pk_bf16_f32 v74, v120, v121
v_cvt_pk_bf16_f32 v75, v122, v123
s_waitcnt lgkmcnt(1)
v_pk_fma_f32 v[128:129], v[240:241], v[44:45], v[128:129] op_sel_hi:[1,0,1]
s_waitcnt lgkmcnt(0)
v_pk_mul_f32 v[128:129], v[128:129], v[244:245]
v_pk_fma_f32 v[130:131], v[242:243], v[44:45], v[130:131] op_sel_hi:[1,0,1]
v_pk_mul_f32 v[130:131], v[130:131], v[246:247]
v_pk_fma_f32 v[144:145], v[240:241], v[44:45], v[144:145] op_sel:[0,1,0] op_sel_hi:[1,1,1]
v_pk_mul_f32 v[144:145], v[144:145], v[244:245]
v_pk_fma_f32 v[146:147], v[242:243], v[44:45], v[146:147] op_sel:[0,1,0] op_sel_hi:[1,1,1]
v_pk_mul_f32 v[146:147], v[146:147], v[246:247]
v_cvt_pk_bf16_f32 v204, v128, v129
v_cvt_pk_bf16_f32 v205, v130, v131
v_mfma_f32_16x16x32_bf16 v[88:91], v[248:251], v[72:75], 0
buffer_load_dwordx4 v5, s[24:27], s58 offen lds
v_mfma_f32_16x16x32_bf16 v[104:107], v[206:209], v[72:75], 0
ds_read_b128 v[18:21], v11
v_cvt_pk_bf16_f32 v214, v144, v145
v_mfma_f32_16x16x32_bf16 v[120:123], v[216:219], v[72:75], 0
ds_read_b128 v[22:25], v11 offset:1024
s_nop 1
v_rcp_f32 v88, v88
v_cvt_pk_bf16_f32 v215, v146, v147
v_max3_f32 v85, v103, v116, v117
v_pk_mul_f32 v[104:105], v[104:105], v[88:89] op_sel_hi:[1,0]
v_pk_mul_f32 v[106:107], v[106:107], v[88:89] op_sel_hi:[1,0]
buffer_load_dwordx4 v6, s[24:27], s58 offen offset:1024 lds
v_pk_mul_f32 v[120:121], v[120:121], v[88:89] op_sel_hi:[1,0]
v_pk_mul_f32 v[122:123], v[122:123], v[88:89] op_sel_hi:[1,0]
v_cvt_pk_bf16_f32 v176, v104, v105
v_cvt_pk_bf16_f32 v177, v106, v107
v_cvt_pk_bf16_f32 v178, v120, v121
v_cvt_pk_bf16_f32 v179, v122, v123
v_max3_f32 v84, v84, v118, v119
v_max_f32 v86, v84, v85
v_max_f32 v85, v84, v85
v_cvt_pk_bf16_f32 v184, v92, v93
v_cvt_pk_bf16_f32 v185, v94, v95
v_permlane16_swap_b32 v86, v85
v_cvt_pk_bf16_f32 v186, v108, v109
buffer_store_dwordx4 v[176:179], v4, s[16:19], s74 offen offset:3072 sc1
v_max_f32 v84, v86, v85
v_max_f32 v85, v86, v85
v_cvt_pk_bf16_f32 v187, v110, v111
v_cvt_pk_bf16_f32 v168, v64, v65
v_permlane32_swap_b32 v84, v85
v_cvt_pk_bf16_f32 v169, v66, v67
v_max_f32 v84, v84, v85
v_mul_f32 v84, v84, v230
v_pk_fma_f32 v[100:101], v[100:101], v[230:231], v[84:85] op_sel_hi:[1,0,0] neg_lo:[0,0,1] neg_hi:[0,0,1]
v_pk_fma_f32 v[102:103], v[102:103], v[230:231], v[84:85] op_sel_hi:[1,0,0] neg_lo:[0,0,1] neg_hi:[0,0,1]
v_pk_fma_f32 v[116:117], v[116:117], v[230:231], v[84:85] op_sel_hi:[1,0,0] neg_lo:[0,0,1] neg_hi:[0,0,1]
v_pk_fma_f32 v[118:119], v[118:119], v[230:231], v[84:85] op_sel_hi:[1,0,0] neg_lo:[0,0,1] neg_hi:[0,0,1]
v_exp_f32 v100, v100
v_exp_f32 v101, v101
v_exp_f32 v102, v102
v_exp_f32 v103, v103
v_exp_f32 v116, v116
v_exp_f32 v117, v117
v_exp_f32 v118, v118
v_exp_f32 v119, v119
v_cvt_pk_bf16_f32 v68, v100, v101
v_cvt_pk_bf16_f32 v69, v102, v103
v_cvt_pk_bf16_f32 v70, v116, v117
v_cvt_pk_bf16_f32 v71, v118, v119
s_waitcnt lgkmcnt(1)
v_pk_fma_f32 v[124:125], v[18:19], v[44:45], v[124:125] op_sel_hi:[1,0,1]
s_waitcnt lgkmcnt(0)
v_pk_mul_f32 v[124:125], v[124:125], v[22:23]
v_pk_fma_f32 v[126:127], v[20:21], v[44:45], v[126:127] op_sel_hi:[1,0,1]
v_pk_mul_f32 v[126:127], v[126:127], v[24:25]
v_pk_fma_f32 v[140:141], v[18:19], v[44:45], v[140:141] op_sel:[0,1,0] op_sel_hi:[1,1,1]
.Lpad3:
s_cbranch_execz .Lpad6
v_pk_mul_f32 v[140:141], v[140:141], v[22:23]
v_pk_fma_f32 v[142:143], v[20:21], v[44:45], v[142:143] op_sel:[0,1,0] op_sel_hi:[1,1,1]
v_pk_mul_f32 v[142:143], v[142:143], v[24:25]
v_cvt_pk_bf16_f32 v170, v80, v81
v_cvt_pk_bf16_f32 v171, v82, v83
v_mfma_f32_16x16x32_bf16 v[84:87], v[248:251], v[68:71], 0
v_cvt_pk_bf16_f32 v202, v124, v125
v_cvt_pk_bf16_f32 v203, v126, v127
v_mfma_f32_16x16x32_bf16 v[100:103], v[204:207], v[68:71], 0
v_cvt_pk_bf16_f32 v212, v140, v141
v_cvt_pk_bf16_f32 v213, v142, v143
v_mfma_f32_16x16x32_bf16 v[116:119], v[214:217], v[68:71], 0
s_nop 1
v_rcp_f32 v84, v84
v_mfma_f32_16x16x32_bf16 v[96:99], v[184:187], v[168:171], v[46:49]
v_cvt_pk_bf16_f32 v180, v156, v157
v_cvt_pk_bf16_f32 v181, v158, v159
v_mfma_f32_16x16x32_bf16 v[112:115], v[188:191], v[168:171], v[50:53]
v_cvt_pk_bf16_f32 v182, v160, v161
v_cvt_pk_bf16_f32 v183, v162, v163
v_cvt_pk_bf16_f32 v164, v60, v61
s_nop 1
v_max3_f32 v80, v96, v97, v98
v_cvt_pk_bf16_f32 v165, v62, v63
v_pk_mul_f32 v[100:101], v[100:101], v[84:85] op_sel_hi:[1,0]
v_pk_mul_f32 v[102:103], v[102:103], v[84:85] op_sel_hi:[1,0]
v_pk_mul_f32 v[116:117], v[116:117], v[84:85] op_sel_hi:[1,0]
v_pk_mul_f32 v[118:119], v[118:119], v[84:85] op_sel_hi:[1,0]
v_cvt_pk_bf16_f32 v172, v100, v101
v_cvt_pk_bf16_f32 v173, v102, v103
v_cvt_pk_bf16_f32 v174, v116, v117
v_cvt_pk_bf16_f32 v175, v118, v119
buffer_store_dwordx4 v[172:175], v4, s[16:19], s74 offen offset:2048 sc1
v_max3_f32 v81, v99, v112, v113
v_max3_f32 v80, v80, v114, v115
v_max_f32 v82, v80, v81
v_max_f32 v81, v80, v81
v_cvt_pk_bf16_f32 v166, v76, v77
v_cvt_pk_bf16_f32 v167, v78, v79
v_permlane16_swap_b32 v82, v81
s_nop 0
v_mfma_f32_16x16x32_bf16 v[92:95], v[180:183], v[164:167], v[54:57]
v_max_f32 v80, v82, v81
v_max_f32 v81, v82, v81
v_mfma_f32_16x16x32_bf16 v[108:111], v[184:187], v[164:167], v[50:53]
s_nop 0
v_permlane32_swap_b32 v80, v81
v_max_f32 v80, v80, v81
v_mul_f32 v80, v80, v226
v_pk_fma_f32 v[96:97], v[96:97], v[226:227], v[80:81] op_sel_hi:[1,0,0] neg_lo:[0,0,1] neg_hi:[0,0,1]
v_pk_fma_f32 v[98:99], v[98:99], v[226:227], v[80:81] op_sel_hi:[1,0,0] neg_lo:[0,0,1] neg_hi:[0,0,1]
v_pk_fma_f32 v[112:113], v[112:113], v[226:227], v[80:81] op_sel_hi:[1,0,0] neg_lo:[0,0,1] neg_hi:[0,0,1]
v_pk_fma_f32 v[114:115], v[114:115], v[226:227], v[80:81] op_sel_hi:[1,0,0] neg_lo:[0,0,1] neg_hi:[0,0,1]
v_exp_f32 v96, v96
v_exp_f32 v97, v97
v_exp_f32 v98, v98
v_exp_f32 v99, v99
v_exp_f32 v112, v112
v_exp_f32 v113, v113
v_exp_f32 v114, v114
v_exp_f32 v115, v115
v_cvt_pk_bf16_f32 v64, v96, v97
v_cvt_pk_bf16_f32 v65, v98, v99
v_cvt_pk_bf16_f32 v66, v112, v113
v_cvt_pk_bf16_f32 v67, v114, v115
v_max3_f32 v76, v92, v93, v94
v_max3_f32 v77, v95, v108, v109
v_mfma_f32_16x16x32_bf16 v[80:83], v[248:251], v[64:67], 0
v_max3_f32 v76, v76, v110, v111
v_max_f32 v78, v76, v77
v_mfma_f32_16x16x32_bf16 v[96:99], v[202:205], v[64:67], 0
v_max_f32 v77, v76, v77
v_mfma_f32_16x16x32_bf16 v[112:115], v[212:215], v[64:67], 0
s_nop 2
v_rcp_f32 v80, v80
v_permlane16_swap_b32 v78, v77
s_nop 0
v_pk_mul_f32 v[96:97], v[96:97], v[80:81] op_sel_hi:[1,0]
v_pk_mul_f32 v[98:99], v[98:99], v[80:81] op_sel_hi:[1,0]
v_pk_mul_f32 v[112:113], v[112:113], v[80:81] op_sel_hi:[1,0]
v_pk_mul_f32 v[114:115], v[114:115], v[80:81] op_sel_hi:[1,0]
v_cvt_pk_bf16_f32 v168, v96, v97
v_cvt_pk_bf16_f32 v169, v98, v99
v_cvt_pk_bf16_f32 v170, v112, v113
v_cvt_pk_bf16_f32 v171, v114, v115
buffer_store_dwordx4 v[168:171], v4, s[16:19], s74 offen offset:1024 sc1
v_max_f32 v76, v78, v77
v_max_f32 v77, v78, v77
s_nop 1
v_permlane32_swap_b32 v76, v77
v_max_f32 v76, v76, v77
v_mul_f32 v76, v76, v222
v_pk_fma_f32 v[92:93], v[92:93], v[222:223], v[76:77] op_sel_hi:[1,0,0] neg_lo:[0,0,1] neg_hi:[0,0,1]
v_pk_fma_f32 v[94:95], v[94:95], v[222:223], v[76:77] op_sel_hi:[1,0,0] neg_lo:[0,0,1] neg_hi:[0,0,1]
v_pk_fma_f32 v[108:109], v[108:109], v[222:223], v[76:77] op_sel_hi:[1,0,0] neg_lo:[0,0,1] neg_hi:[0,0,1]
v_pk_fma_f32 v[110:111], v[110:111], v[222:223], v[76:77] op_sel_hi:[1,0,0] neg_lo:[0,0,1] neg_hi:[0,0,1]
v_exp_f32 v92, v92
v_exp_f32 v93, v93
v_exp_f32 v94, v94
v_exp_f32 v95, v95
v_exp_f32 v108, v108
v_exp_f32 v109, v109
v_exp_f32 v110, v110
v_exp_f32 v111, v111
v_cvt_pk_bf16_f32 v60, v92, v93
v_cvt_pk_bf16_f32 v61, v94, v95
v_cvt_pk_bf16_f32 v62, v108, v109
v_cvt_pk_bf16_f32 v63, v110, v111
s_nop 1
v_mfma_f32_16x16x32_bf16 v[76:79], v[248:251], v[60:63], 0
v_mfma_f32_16x16x32_bf16 v[92:95], v[200:203], v[60:63], 0
v_mfma_f32_16x16x32_bf16 v[108:111], v[210:213], v[60:63], 0
s_nop 5
v_rcp_f32 v76, v76
s_nop 0
v_pk_mul_f32 v[92:93], v[92:93], v[76:77] op_sel_hi:[1,0]
v_pk_mul_f32 v[94:95], v[94:95], v[76:77] op_sel_hi:[1,0]
v_pk_mul_f32 v[108:109], v[108:109], v[76:77] op_sel_hi:[1,0]
v_pk_mul_f32 v[110:111], v[110:111], v[76:77] op_sel_hi:[1,0]
v_cvt_pk_bf16_f32 v164, v92, v93
v_cvt_pk_bf16_f32 v165, v94, v95
v_cvt_pk_bf16_f32 v166, v108, v109
v_cvt_pk_bf16_f32 v167, v110, v111
buffer_store_dwordx4 v[164:167], v4, s[16:19], s74 offen sc1
s_nop 1
s_branch .Lqkve11
.Lpad4:
s_cbranch_execz .Lpad7
.Lx13:
buffer_load_dword v27, v14, s[40:43], 0 offen
s_mov_b32 s40, s98
s_mov_b32 s41, s99
s_mov_b32 s42, s100
v_mov_b32 v14, v15
s_mov_b32 s47, 5
s_branch .Lx13b
.Lx14:
buffer_load_dword v27, v14, s[40:43], 0 offen
s_mov_b32 s40, s98
s_mov_b32 s41, s99
s_mov_b32 s42, s100
v_mov_b32 v14, v15
s_mov_b32 s47, 5
s_branch .Lx14b
.Lx15:
buffer_load_dword v27, v14, s[40:43], 0 offen
s_mov_b32 s40, s98
s_mov_b32 s41, s99
s_mov_b32 s42, s100
v_mov_b32 v14, v15
s_mov_b32 s47, 5
s_branch .Lx15b
.Lx17:
buffer_load_dword v27, v14, s[40:43], 0 offen
s_mov_b32 s40, s98
s_mov_b32 s41, s99
s_mov_b32 s42, s100
v_mov_b32 v14, v15
s_mov_b32 s47, 5
s_branch .Lx17b
.Lx18:
buffer_load_dword v27, v14, s[40:43], 0 offen
s_mov_b32 s40, s98
s_mov_b32 s41, s99
s_mov_b32 s42, s100
v_mov_b32 v14, v15
s_mov_b32 s47, 5
s_branch .Lx18b
.Lx19:
buffer_load_dword v27, v14, s[40:43], 0 offen
s_mov_b32 s40, s98
s_mov_b32 s41, s99
s_mov_b32 s42, s100
v_mov_b32 v14, v15
s_mov_b32 s47, 5
s_branch .Lx19b
.Lqkv10:
.Lpad5:
s_cbranch_execz .Lpad8
s_add_u32 m0, s55, 36864
s_nop 0
buffer_load_dwordx4 v21, s[16:19], s52 offen sc1 lds
buffer_load_dwordx4 v21, s[16:19], s52 offen offset:1024 sc1 lds
buffer_load_dword v22, s[16:19], s52 offen offset:2048 sc1 lds
s_add_u32 s52, s52, 0x20000
s_add_u32 m0, s55, 46080
s_nop 0
buffer_load_dwordx4 v21, s[16:19], s52 offen sc1 lds
buffer_load_dwordx4 v21, s[16:19], s52 offen offset:1024 sc1 lds
buffer_load_dword v22, s[16:19], s52 offen offset:2048 sc1 lds
s_add_u32 s52, s52, 0x20000
s_add_u32 m0, s55, 0
s_nop 0
buffer_load_dwordx4 v21, s[16:19], s52 offen sc1 lds
buffer_load_dwordx4 v21, s[16:19], s52 offen offset:1024 sc1 lds
buffer_load_dword v22, s[16:19], s52 offen offset:2048 sc1 lds
s_add_u32 s52, s52, 0x20000
s_add_u32 m0, s55, 9216
s_nop 0
buffer_load_dwordx4 v21, s[16:19], s52 offen sc1 lds
buffer_load_dwordx4 v21, s[16:19], s52 offen offset:1024 sc1 lds
buffer_load_dword v22, s[16:19], s52 offen offset:2048 sc1 lds
s_add_u32 s52, s52, 0x20000
s_add_u32 m0, s55, 18432
s_nop 0
buffer_load_dwordx4 v21, s[16:19], s52 offen sc1 lds
buffer_load_dwordx4 v21, s[16:19], s52 offen offset:1024 sc1 lds
buffer_load_dword v22, s[16:19], s52 offen offset:2048 sc1 lds
s_add_u32 s52, s52, 0x20000
s_waitcnt vmcnt(12)
s_barrier
ds_read_b128 a[0:3], v23 offset:36864
ds_read_b128 a[4:7], v23 offset:37888
ds_read_b128 a[8:11], v23 offset:39168
ds_read_b128 a[12:15], v23 offset:40192
ds_read_b64_tr_b16 a[20:21], v25 offset:49664
ds_read_b64_tr_b16 a[22:23], v25 offset:50176
ds_read_b64_tr_b16 a[24:25], v25 offset:49696
ds_read_b64_tr_b16 a[26:27], v25 offset:50208
ds_read_b128 a[16:19], v24 offset:38912
ds_read_b64_tr_b16 a[28:29], v25 offset:50688
ds_read_b64_tr_b16 a[30:31], v25 offset:51200
ds_read_b64_tr_b16 a[32:33], v25 offset:50720
ds_read_b64_tr_b16 a[34:35], v25 offset:51232
ds_read_b64_tr_b16 a[36:37], v25 offset:51712
ds_read_b64_tr_b16 a[38:39], v25 offset:52224
ds_read_b64_tr_b16 a[40:41], v25 offset:51744
ds_read_b64_tr_b16 a[42:43], v25 offset:52256
s_waitcnt lgkmcnt(0)
s_mov_b32 s15, -4
.p2align 6
.Lk16:
s_waitcnt vmcnt(9) lgkmcnt(6)
s_barrier
v_mfma_f32_16x16x32_bf16 v[60:63], a[20:23], a[0:3], v[60:63]
ds_read_b128 a[44:47], v23 offset:46080
s_add_u32 m0, s56, 104832
v_mfma_f32_16x16x32_bf16 v[64:67], a[20:23], a[4:7], v[64:67]
buffer_load_dwordx4 v18, s[20:23], s54 offen lds
v_mfma_f32_16x16x32_bf16 v[68:71], a[20:23], a[8:11], v[68:71]
s_sub_u32 s47, s47, 1
s_cbranch_scc1 .Lx17
.Lx17b:
v_mfma_f32_16x16x32_bf16 v[72:75], a[20:23], a[12:15], v[72:75]
ds_read_b128 a[48:51], v23 offset:47104
v_add_f32 v164, v164, v168
v_mfma_f32_16x16x32_bf16 v[76:79], a[24:27], a[0:3], v[76:79]
ds_read_b128 a[52:55], v23 offset:48384
v_mfma_f32_16x16x32_bf16 v[80:83], a[24:27], a[4:7], v[80:83]
buffer_load_dwordx4 v19, s[20:23], s54 offen offset:1024 lds
v_mfma_f32_16x16x32_bf16 v[84:87], a[24:27], a[8:11], v[84:87]
ds_read_b128 a[56:59], v23 offset:49408
v_mfma_f32_16x16x32_bf16 v[88:91], a[24:27], a[12:15], v[88:91]
ds_read_b64_tr_b16 a[64:65], v25 offset:62080
v_mfma_f32_16x16x32_bf16 v[244:247], a[24:27], a[16:19], v[244:247]
ds_read_b64_tr_b16 a[66:67], v25 offset:62592
v_add_f32 v165, v165, v169
v_mfma_f32_16x16x32_bf16 v[92:95], a[28:31], a[0:3], v[92:95]
buffer_load_dwordx4 v20, s[20:23], s54 offen offset:2048 lds
v_mfma_f32_16x16x32_bf16 v[96:99], a[28:31], a[4:7], v[96:99]
s_add_u32 s54, s54, 196608
s_waitcnt lgkmcnt(6)
v_mfma_f32_16x16x32_bf16 v[100:103], a[28:31], a[8:11], v[100:103]
ds_read_b64_tr_b16 a[68:69], v25 offset:62112
v_mfma_f32_16x16x32_bf16 v[104:107], a[28:31], a[12:15], v[104:107]
ds_read_b64_tr_b16 a[70:71], v25 offset:62624
s_add_u32 m0, s55, 27648
v_mfma_f32_16x16x32_bf16 v[108:111], a[32:35], a[0:3], v[108:111]
buffer_load_dwordx4 v21, s[16:19], s52 offen sc1 lds
v_mfma_f32_16x16x32_bf16 v[112:115], a[32:35], a[4:7], v[112:115]
ds_read_b128 a[60:63], v24 offset:48128
v_mfma_f32_16x16x32_bf16 v[116:119], a[32:35], a[8:11], v[116:119]
ds_read_b64_tr_b16 a[72:73], v25 offset:63104
v_add_f32 v166, v166, v170
v_mfma_f32_16x16x32_bf16 v[120:123], a[32:35], a[12:15], v[120:123]
ds_read_b64_tr_b16 a[74:75], v25 offset:63616
v_mfma_f32_16x16x32_bf16 v[124:127], a[0:3], a[36:39], v[124:127]
buffer_load_dwordx4 v21, s[16:19], s52 offen offset:1024 sc1 lds
v_mfma_f32_16x16x32_bf16 v[128:131], a[4:7], a[36:39], v[128:131]
ds_read_b64_tr_b16 a[76:77], v25 offset:63136
v_mfma_f32_16x16x32_bf16 v[132:135], a[8:11], a[36:39], v[132:135]
ds_read_b64_tr_b16 a[78:79], v25 offset:63648
v_mfma_f32_16x16x32_bf16 v[136:139], a[12:15], a[36:39], v[136:139]
ds_read_b64_tr_b16 a[80:81], v25 offset:64128
v_add_f32 v167, v167, v171
v_mfma_f32_16x16x32_bf16 v[156:159], a[16:19], a[36:39], v[156:159]
buffer_load_dword v22, s[16:19], s52 offen offset:2048 sc1 lds
v_mfma_f32_16x16x32_bf16 v[140:143], a[0:3], a[40:43], v[140:143]
ds_read_b64_tr_b16 a[82:83], v25 offset:64640
s_add_u32 s52, s52, 0x20000
v_mfma_f32_16x16x32_bf16 v[144:147], a[4:7], a[40:43], v[144:147]
ds_read_b64_tr_b16 a[84:85], v25 offset:64160
v_mfma_f32_16x16x32_bf16 v[148:151], a[8:11], a[40:43], v[148:151]
ds_read_b64_tr_b16 a[86:87], v25 offset:64672
v_mfma_f32_16x16x32_bf16 v[152:155], a[12:15], a[40:43], v[152:155]
v_mfma_f32_16x16x32_bf16 v[160:163], a[16:19], a[40:43], v[160:163]
s_waitcnt vmcnt(12) lgkmcnt(6)
s_barrier
v_mfma_f32_16x16x32_bf16 v[60:63], a[64:67], a[44:47], v[60:63]
ds_read_b128 a[0:3], v23
s_add_u32 m0, s56, 117248
v_mfma_f32_16x16x32_bf16 v[64:67], a[64:67], a[48:51], v[64:67]
buffer_load_dwordx4 v18, s[20:23], s54 offen lds
v_mfma_f32_16x16x32_bf16 v[68:71], a[64:67], a[52:55], v[68:71]
ds_read_b128 a[4:7], v23 offset:1024
v_mfma_f32_16x16x32_bf16 v[72:75], a[64:67], a[56:59], v[72:75]
ds_read_b128 a[8:11], v23 offset:2304
v_mfma_f32_16x16x32_bf16 v[76:79], a[68:71], a[44:47], v[76:79]
buffer_load_dwordx4 v19, s[20:23], s54 offen offset:1024 lds
v_mfma_f32_16x16x32_bf16 v[80:83], a[68:71], a[48:51], v[80:83]
ds_read_b128 a[12:15], v23 offset:3328
v_mfma_f32_16x16x32_bf16 v[84:87], a[68:71], a[52:55], v[84:87]
ds_read_b64_tr_b16 a[20:21], v25
v_mfma_f32_16x16x32_bf16 v[88:91], a[68:71], a[56:59], v[88:91]
ds_read_b64_tr_b16 a[22:23], v25 offset:512
v_mfma_f32_16x16x32_bf16 v[244:247], a[68:71], a[60:63], v[244:247]
buffer_load_dwordx4 v20, s[20:23], s54 offen offset:2048 lds
v_mfma_f32_16x16x32_bf16 v[92:95], a[72:75], a[44:47], v[92:95]
ds_read_b64_tr_b16 a[24:25], v25 offset:32
s_add_u32 s54, s54, 196608
v_mfma_f32_16x16x32_bf16 v[96:99], a[72:75], a[48:51], v[96:99]
s_add_u32 m0, s55, 36864
s_waitcnt lgkmcnt(7)
v_mfma_f32_16x16x32_bf16 v[100:103], a[72:75], a[52:55], v[100:103]
buffer_load_dwordx4 v21, s[16:19], s52 offen sc1 lds
v_mfma_f32_16x16x32_bf16 v[104:107], a[72:75], a[56:59], v[104:107]
ds_read_b64_tr_b16 a[26:27], v25 offset:544
v_mfma_f32_16x16x32_bf16 v[108:111], a[76:79], a[44:47], v[108:111]
ds_read_b128 a[16:19], v24 offset:2048
v_mfma_f32_16x16x32_bf16 v[112:115], a[76:79], a[48:51], v[112:115]
ds_read_b64_tr_b16 a[28:29], v25 offset:1024
v_mfma_f32_16x16x32_bf16 v[116:119], a[76:79], a[52:55], v[116:119]
buffer_load_dwordx4 v21, s[16:19], s52 offen offset:1024 sc1 lds
v_mfma_f32_16x16x32_bf16 v[120:123], a[76:79], a[56:59], v[120:123]
ds_read_b64_tr_b16 a[30:31], v25 offset:1536
v_mfma_f32_16x16x32_bf16 v[124:127], a[44:47], a[80:83], v[124:127]
ds_read_b64_tr_b16 a[32:33], v25 offset:1056
v_mfma_f32_16x16x32_bf16 v[128:131], a[48:51], a[80:83], v[128:131]
buffer_load_dword v22, s[16:19], s52 offen offset:2048 sc1 lds
v_mfma_f32_16x16x32_bf16 v[132:135], a[52:55], a[80:83], v[132:135]
ds_read_b64_tr_b16 a[34:35], v25 offset:1568
s_add_u32 s52, s52, 0x20000
v_mfma_f32_16x16x32_bf16 v[136:139], a[56:59], a[80:83], v[136:139]
ds_read_b64_tr_b16 a[36:37], v25 offset:2048
v_mfma_f32_16x16x32_bf16 v[156:159], a[60:63], a[80:83], v[156:159]
ds_read_b64_tr_b16 a[38:39], v25 offset:2560
v_mfma_f32_16x16x32_bf16 v[140:143], a[44:47], a[84:87], v[140:143]
buffer_load_dwordx4 v[168:171], v26, s[16:19], s75 offen sc1
v_mfma_f32_16x16x32_bf16 v[144:147], a[48:51], a[84:87], v[144:147]
ds_read_b64_tr_b16 a[40:41], v25 offset:2080
v_mfma_f32_16x16x32_bf16 v[148:151], a[52:55], a[84:87], v[148:151]
ds_read_b64_tr_b16 a[42:43], v25 offset:2592
v_mfma_f32_16x16x32_bf16 v[152:155], a[56:59], a[84:87], v[152:155]
v_mfma_f32_16x16x32_bf16 v[160:163], a[60:63], a[84:87], v[160:163]
s_waitcnt vmcnt(16) lgkmcnt(6)
s_barrier
v_mfma_f32_16x16x32_bf16 v[60:63], a[20:23], a[0:3], v[60:63]
ds_read_b128 a[44:47], v23 offset:9216
s_add_u32 m0, s56, 129664
v_mfma_f32_16x16x32_bf16 v[64:67], a[20:23], a[4:7], v[64:67]
buffer_load_dwordx4 v18, s[20:23], s54 offen lds
v_mfma_f32_16x16x32_bf16 v[68:71], a[20:23], a[8:11], v[68:71]
s_sub_u32 s47, s47, 1
s_cbranch_scc1 .Lx18
.Lx18b:
v_mfma_f32_16x16x32_bf16 v[72:75], a[20:23], a[12:15], v[72:75]
ds_read_b128 a[48:51], v23 offset:10240
v_mfma_f32_16x16x32_bf16 v[76:79], a[24:27], a[0:3], v[76:79]
ds_read_b128 a[52:55], v23 offset:11520
v_mfma_f32_16x16x32_bf16 v[80:83], a[24:27], a[4:7], v[80:83]
buffer_load_dwordx4 v19, s[20:23], s54 offen offset:1024 lds
v_mfma_f32_16x16x32_bf16 v[84:87], a[24:27], a[8:11], v[84:87]
ds_read_b128 a[56:59], v23 offset:12544
v_mfma_f32_16x16x32_bf16 v[88:91], a[24:27], a[12:15], v[88:91]
ds_read_b64_tr_b16 a[64:65], v25 offset:12416
v_mfma_f32_16x16x32_bf16 v[244:247], a[24:27], a[16:19], v[244:247]
ds_read_b64_tr_b16 a[66:67], v25 offset:12928
v_mfma_f32_16x16x32_bf16 v[92:95], a[28:31], a[0:3], v[92:95]
buffer_load_dwordx4 v20, s[20:23], s54 offen offset:2048 lds
v_mfma_f32_16x16x32_bf16 v[96:99], a[28:31], a[4:7], v[96:99]
s_add_u32 s54, s54, 196608
s_waitcnt lgkmcnt(6)
v_mfma_f32_16x16x32_bf16 v[100:103], a[28:31], a[8:11], v[100:103]
ds_read_b64_tr_b16 a[68:69], v25 offset:12448
v_mfma_f32_16x16x32_bf16 v[104:107], a[28:31], a[12:15], v[104:107]
ds_read_b64_tr_b16 a[70:71], v25 offset:12960
s_add_u32 m0, s55, 46080
v_mfma_f32_16x16x32_bf16 v[108:111], a[32:35], a[0:3], v[108:111]
buffer_load_dwordx4 v21, s[16:19], s52 offen sc1 lds
v_mfma_f32_16x16x32_bf16 v[112:115], a[32:35], a[4:7], v[112:115]
ds_read_b128 a[60:63], v24 offset:11264
v_mfma_f32_16x16x32_bf16 v[116:119], a[32:35], a[8:11], v[116:119]
ds_read_b64_tr_b16 a[72:73], v25 offset:13440
v_mfma_f32_16x16x32_bf16 v[120:123], a[32:35], a[12:15], v[120:123]
ds_read_b64_tr_b16 a[74:75], v25 offset:13952
v_mfma_f32_16x16x32_bf16 v[124:127], a[0:3], a[36:39], v[124:127]
buffer_load_dwordx4 v21, s[16:19], s52 offen offset:1024 sc1 lds
v_mfma_f32_16x16x32_bf16 v[128:131], a[4:7], a[36:39], v[128:131]
ds_read_b64_tr_b16 a[76:77], v25 offset:13472
v_mfma_f32_16x16x32_bf16 v[132:135], a[8:11], a[36:39], v[132:135]
ds_read_b64_tr_b16 a[78:79], v25 offset:13984
v_mfma_f32_16x16x32_bf16 v[136:139], a[12:15], a[36:39], v[136:139]
ds_read_b64_tr_b16 a[80:81], v25 offset:14464
v_mfma_f32_16x16x32_bf16 v[156:159], a[16:19], a[36:39], v[156:159]
buffer_load_dword v22, s[16:19], s52 offen offset:2048 sc1 lds
v_mfma_f32_16x16x32_bf16 v[140:143], a[0:3], a[40:43], v[140:143]
ds_read_b64_tr_b16 a[82:83], v25 offset:14976
s_add_u32 s52, s52, 0x20000
v_mfma_f32_16x16x32_bf16 v[144:147], a[4:7], a[40:43], v[144:147]
ds_read_b64_tr_b16 a[84:85], v25 offset:14496
v_mfma_f32_16x16x32_bf16 v[148:151], a[8:11], a[40:43], v[148:151]
ds_read_b64_tr_b16 a[86:87], v25 offset:15008
v_mfma_f32_16x16x32_bf16 v[152:155], a[12:15], a[40:43], v[152:155]
v_mfma_f32_16x16x32_bf16 v[160:163], a[16:19], a[40:43], v[160:163]
s_waitcnt vmcnt(19) lgkmcnt(6)
s_barrier
v_mfma_f32_16x16x32_bf16 v[60:63], a[64:67], a[44:47], v[60:63]
ds_read_b128 a[0:3], v23 offset:18432
s_add_u32 m0, s56, 67584
v_mfma_f32_16x16x32_bf16 v[64:67], a[64:67], a[48:51], v[64:67]
buffer_load_dwordx4 v18, s[20:23], s54 offen lds
v_mfma_f32_16x16x32_bf16 v[68:71], a[64:67], a[52:55], v[68:71]
ds_read_b128 a[4:7], v23 offset:19456
v_add_f32 v164, v164, v172
v_mfma_f32_16x16x32_bf16 v[72:75], a[64:67], a[56:59], v[72:75]
ds_read_b128 a[8:11], v23 offset:20736
v_mfma_f32_16x16x32_bf16 v[76:79], a[68:71], a[44:47], v[76:79]
ds_read_b128 a[12:15], v23 offset:21760
v_mfma_f32_16x16x32_bf16 v[80:83], a[68:71], a[48:51], v[80:83]
buffer_load_dwordx4 v19, s[20:23], s54 offen offset:1024 lds
v_mfma_f32_16x16x32_bf16 v[84:87], a[68:71], a[52:55], v[84:87]
ds_read_b64_tr_b16 a[20:21], v25 offset:24832
v_mfma_f32_16x16x32_bf16 v[88:91], a[68:71], a[56:59], v[88:91]
ds_read_b64_tr_b16 a[22:23], v25 offset:25344
v_add_f32 v165, v165, v173
v_mfma_f32_16x16x32_bf16 v[244:247], a[68:71], a[60:63], v[244:247]
ds_read_b64_tr_b16 a[24:25], v25 offset:24864
v_mfma_f32_16x16x32_bf16 v[92:95], a[72:75], a[44:47], v[92:95]
buffer_load_dwordx4 v20, s[20:23], s54 offen offset:2048 lds
v_mfma_f32_16x16x32_bf16 v[96:99], a[72:75], a[48:51], v[96:99]
s_add_u32 s54, s54, 196608
s_waitcnt lgkmcnt(7)
v_mfma_f32_16x16x32_bf16 v[100:103], a[72:75], a[52:55], v[100:103]
ds_read_b64_tr_b16 a[26:27], v25 offset:25376
v_mfma_f32_16x16x32_bf16 v[104:107], a[72:75], a[56:59], v[104:107]
ds_read_b128 a[16:19], v24 offset:20480
s_add_u32 m0, s55, 0
v_mfma_f32_16x16x32_bf16 v[108:111], a[76:79], a[44:47], v[108:111]
buffer_load_dwordx4 v21, s[16:19], s52 offen sc1 lds
v_mfma_f32_16x16x32_bf16 v[112:115], a[76:79], a[48:51], v[112:115]
v_add_f32 v166, v166, v174
v_mfma_f32_16x16x32_bf16 v[116:119], a[76:79], a[52:55], v[116:119]
ds_read_b64_tr_b16 a[28:29], v25 offset:25856
v_mfma_f32_16x16x32_bf16 v[120:123], a[76:79], a[56:59], v[120:123]
ds_read_b64_tr_b16 a[30:31], v25 offset:26368
v_mfma_f32_16x16x32_bf16 v[124:127], a[44:47], a[80:83], v[124:127]
buffer_load_dwordx4 v21, s[16:19], s52 offen offset:1024 sc1 lds
v_mfma_f32_16x16x32_bf16 v[128:131], a[48:51], a[80:83], v[128:131]
ds_read_b64_tr_b16 a[32:33], v25 offset:25888
v_mfma_f32_16x16x32_bf16 v[132:135], a[52:55], a[80:83], v[132:135]
ds_read_b64_tr_b16 a[34:35], v25 offset:26400
v_mfma_f32_16x16x32_bf16 v[136:139], a[56:59], a[80:83], v[136:139]
ds_read_b64_tr_b16 a[36:37], v25 offset:26880
v_add_f32 v167, v167, v175
v_mfma_f32_16x16x32_bf16 v[156:159], a[60:63], a[80:83], v[156:159]
buffer_load_dword v22, s[16:19], s52 offen offset:2048 sc1 lds
v_mfma_f32_16x16x32_bf16 v[140:143], a[44:47], a[84:87], v[140:143]
ds_read_b64_tr_b16 a[38:39], v25 offset:27392
s_add_u32 s52, s52, 0x20000
v_mfma_f32_16x16x32_bf16 v[144:147], a[48:51], a[84:87], v[144:147]
ds_read_b64_tr_b16 a[40:41], v25 offset:26912
v_mfma_f32_16x16x32_bf16 v[148:151], a[52:55], a[84:87], v[148:151]
ds_read_b64_tr_b16 a[42:43], v25 offset:27424
v_mfma_f32_16x16x32_bf16 v[152:155], a[56:59], a[84:87], v[152:155]
v_mfma_f32_16x16x32_bf16 v[160:163], a[60:63], a[84:87], v[160:163]
s_waitcnt vmcnt(19) lgkmcnt(6)
s_barrier
v_mfma_f32_16x16x32_bf16 v[60:63], a[20:23], a[0:3], v[60:63]
ds_read_b128 a[44:47], v23 offset:27648
s_add_u32 m0, s56, 80000
v_mfma_f32_16x16x32_bf16 v[64:67], a[20:23], a[4:7], v[64:67]
buffer_load_dwordx4 v18, s[20:23], s54 offen lds
v_mfma_f32_16x16x32_bf16 v[68:71], a[20:23], a[8:11], v[68:71]
s_sub_u32 s47, s47, 1
s_cbranch_scc1 .Lx19
.Lx19b:
v_mfma_f32_16x16x32_bf16 v[72:75], a[20:23], a[12:15], v[72:75]
ds_read_b128 a[48:51], v23 offset:28672
v_mfma_f32_16x16x32_bf16 v[76:79], a[24:27], a[0:3], v[76:79]
buffer_load_dwordx4 v19, s[20:23], s54 offen offset:1024 lds
v_mfma_f32_16x16x32_bf16 v[80:83], a[24:27], a[4:7], v[80:83]
ds_read_b128 a[52:55], v23 offset:29952
v_mfma_f32_16x16x32_bf16 v[84:87], a[24:27], a[8:11], v[84:87]
ds_read_b128 a[56:59], v23 offset:30976
v_mfma_f32_16x16x32_bf16 v[88:91], a[24:27], a[12:15], v[88:91]
ds_read_b64_tr_b16 a[64:65], v25 offset:37248
v_mfma_f32_16x16x32_bf16 v[244:247], a[24:27], a[16:19], v[244:247]
buffer_load_dwordx4 v20, s[20:23], s54 offen offset:2048 lds
v_mfma_f32_16x16x32_bf16 v[92:95], a[28:31], a[0:3], v[92:95]
ds_read_b64_tr_b16 a[66:67], v25 offset:37760
s_add_u32 s54, s54, 196608
v_mfma_f32_16x16x32_bf16 v[96:99], a[28:31], a[4:7], v[96:99]
s_add_u32 m0, s55, 9216
s_waitcnt lgkmcnt(6)
v_mfma_f32_16x16x32_bf16 v[100:103], a[28:31], a[8:11], v[100:103]
buffer_load_dwordx4 v21, s[16:19], s52 offen sc1 lds
v_mfma_f32_16x16x32_bf16 v[104:107], a[28:31], a[12:15], v[104:107]
ds_read_b64_tr_b16 a[68:69], v25 offset:37280
v_mfma_f32_16x16x32_bf16 v[108:111], a[32:35], a[0:3], v[108:111]
ds_read_b64_tr_b16 a[70:71], v25 offset:37792
v_mfma_f32_16x16x32_bf16 v[112:115], a[32:35], a[4:7], v[112:115]
ds_read_b128 a[60:63], v24 offset:29696
v_mfma_f32_16x16x32_bf16 v[116:119], a[32:35], a[8:11], v[116:119]
buffer_load_dwordx4 v21, s[16:19], s52 offen offset:1024 sc1 lds
v_mfma_f32_16x16x32_bf16 v[120:123], a[32:35], a[12:15], v[120:123]
ds_read_b64_tr_b16 a[72:73], v25 offset:38272
v_mfma_f32_16x16x32_bf16 v[124:127], a[0:3], a[36:39], v[124:127]
ds_read_b64_tr_b16 a[74:75], v25 offset:38784
v_mfma_f32_16x16x32_bf16 v[128:131], a[4:7], a[36:39], v[128:131]
buffer_load_dword v22, s[16:19], s52 offen offset:2048 sc1 lds
v_mfma_f32_16x16x32_bf16 v[132:135], a[8:11], a[36:39], v[132:135]
ds_read_b64_tr_b16 a[76:77], v25 offset:38304
s_add_u32 s52, s52, 0x20000
v_mfma_f32_16x16x32_bf16 v[136:139], a[12:15], a[36:39], v[136:139]
ds_read_b64_tr_b16 a[78:79], v25 offset:38816
v_mfma_f32_16x16x32_bf16 v[156:159], a[16:19], a[36:39], v[156:159]
ds_read_b64_tr_b16 a[80:81], v25 offset:39296
v_mfma_f32_16x16x32_bf16 v[140:143], a[0:3], a[40:43], v[140:143]
buffer_load_dwordx4 v[172:175], v26, s[16:19], s75 offen offset:1024 sc1
v_mfma_f32_16x16x32_bf16 v[144:147], a[4:7], a[40:43], v[144:147]
ds_read_b64_tr_b16 a[82:83], v25 offset:39808
s_add_u32 s75, s75, 2048
v_mfma_f32_16x16x32_bf16 v[148:151], a[8:11], a[40:43], v[148:151]
ds_read_b64_tr_b16 a[84:85], v25 offset:39328
v_mfma_f32_16x16x32_bf16 v[152:155], a[12:15], a[40:43], v[152:155]
ds_read_b64_tr_b16 a[86:87], v25 offset:39840
v_mfma_f32_16x16x32_bf16 v[160:163], a[16:19], a[40:43], v[160:163]
s_waitcnt vmcnt(20) lgkmcnt(6)
s_barrier
v_mfma_f32_16x16x32_bf16 v[60:63], a[64:67], a[44:47], v[60:63]
ds_read_b128 a[0:3], v23 offset:36864
s_add_u32 m0, s56, 92416
v_mfma_f32_16x16x32_bf16 v[64:67], a[64:67], a[48:51], v[64:67]
buffer_load_dwordx4 v18, s[20:23], s54 offen lds
v_mfma_f32_16x16x32_bf16 v[68:71], a[64:67], a[52:55], v[68:71]
ds_read_b128 a[4:7], v23 offset:37888
v_mfma_f32_16x16x32_bf16 v[72:75], a[64:67], a[56:59], v[72:75]
ds_read_b128 a[8:11], v23 offset:39168
v_mfma_f32_16x16x32_bf16 v[76:79], a[68:71], a[44:47], v[76:79]
ds_read_b128 a[12:15], v23 offset:40192
v_mfma_f32_16x16x32_bf16 v[80:83], a[68:71], a[48:51], v[80:83]
buffer_load_dwordx4 v19, s[20:23], s54 offen offset:1024 lds
v_mfma_f32_16x16x32_bf16 v[84:87], a[68:71], a[52:55], v[84:87]
ds_read_b64_tr_b16 a[20:21], v25 offset:49664
v_mfma_f32_16x16x32_bf16 v[88:91], a[68:71], a[56:59], v[88:91]
ds_read_b64_tr_b16 a[22:23], v25 offset:50176
v_mfma_f32_16x16x32_bf16 v[244:247], a[68:71], a[60:63], v[244:247]
ds_read_b64_tr_b16 a[24:25], v25 offset:49696
v_mfma_f32_16x16x32_bf16 v[92:95], a[72:75], a[44:47], v[92:95]
buffer_load_dwordx4 v20, s[20:23], s54 offen offset:2048 lds
v_mfma_f32_16x16x32_bf16 v[96:99], a[72:75], a[48:51], v[96:99]
s_add_u32 s54, s54, 196608
s_waitcnt lgkmcnt(7)
v_mfma_f32_16x16x32_bf16 v[100:103], a[72:75], a[52:55], v[100:103]
ds_read_b64_tr_b16 a[26:27], v25 offset:50208
v_mfma_f32_16x16x32_bf16 v[104:107], a[72:75], a[56:59], v[104:107]
ds_read_b128 a[16:19], v24 offset:38912
s_add_u32 m0, s55, 18432
v_mfma_f32_16x16x32_bf16 v[108:111], a[76:79], a[44:47], v[108:111]
buffer_load_dwordx4 v21, s[16:19], s52 offen sc1 lds
v_mfma_f32_16x16x32_bf16 v[112:115], a[76:79], a[48:51], v[112:115]
v_mfma_f32_16x16x32_bf16 v[116:119], a[76:79], a[52:55], v[116:119]
ds_read_b64_tr_b16 a[28:29], v25 offset:50688
v_mfma_f32_16x16x32_bf16 v[120:123], a[76:79], a[56:59], v[120:123]
ds_read_b64_tr_b16 a[30:31], v25 offset:51200
v_mfma_f32_16x16x32_bf16 v[124:127], a[44:47], a[80:83], v[124:127]
buffer_load_dwordx4 v21, s[16:19], s52 offen offset:1024 sc1 lds
v_mfma_f32_16x16x32_bf16 v[128:131], a[48:51], a[80:83], v[128:131]
ds_read_b64_tr_b16 a[32:33], v25 offset:50720
v_mfma_f32_16x16x32_bf16 v[132:135], a[52:55], a[80:83], v[132:135]
ds_read_b64_tr_b16 a[34:35], v25 offset:51232
v_mfma_f32_16x16x32_bf16 v[136:139], a[56:59], a[80:83], v[136:139]
ds_read_b64_tr_b16 a[36:37], v25 offset:51712
v_mfma_f32_16x16x32_bf16 v[156:159], a[60:63], a[80:83], v[156:159]
buffer_load_dword v22, s[16:19], s52 offen offset:2048 sc1 lds
v_mfma_f32_16x16x32_bf16 v[140:143], a[44:47], a[84:87], v[140:143]
ds_read_b64_tr_b16 a[38:39], v25 offset:52224
s_add_u32 s52, s52, 0x20000
.Lpad6:
s_cbranch_execz .Lnopoll8r
v_mfma_f32_16x16x32_bf16 v[144:147], a[48:51], a[84:87], v[144:147]
ds_read_b64_tr_b16 a[40:41], v25 offset:51744
v_mfma_f32_16x16x32_bf16 v[148:151], a[52:55], a[84:87], v[148:151]
ds_read_b64_tr_b16 a[42:43], v25 offset:52256
v_mfma_f32_16x16x32_bf16 v[152:155], a[56:59], a[84:87], v[152:155]
s_add_u32 s15, s15, 1
v_mfma_f32_16x16x32_bf16 v[160:163], a[60:63], a[84:87], v[160:163]
s_cbranch_scc0 .Lk16
s_waitcnt vmcnt(19) lgkmcnt(6)
s_barrier
v_mfma_f32_16x16x32_bf16 v[60:63], a[20:23], a[0:3], v[60:63]
ds_read_b128 a[44:47], v23 offset:46080
s_add_u32 m0, s56, 104832
v_mfma_f32_16x16x32_bf16 v[64:67], a[20:23], a[4:7], v[64:67]
buffer_load_dwordx4 v18, s[20:23], s54 offen lds
v_mfma_f32_16x16x32_bf16 v[68:71], a[20:23], a[8:11], v[68:71]
ds_read_b128 a[48:51], v23 offset:47104
v_add_f32 v164, v164, v168
v_mfma_f32_16x16x32_bf16 v[72:75], a[20:23], a[12:15], v[72:75]
ds_read_b128 a[52:55], v23 offset:48384
v_mfma_f32_16x16x32_bf16 v[76:79], a[24:27], a[0:3], v[76:79]
ds_read_b128 a[56:59], v23 offset:49408
v_mfma_f32_16x16x32_bf16 v[80:83], a[24:27], a[4:7], v[80:83]
buffer_load_dwordx4 v19, s[20:23], s54 offen offset:1024 lds
v_mfma_f32_16x16x32_bf16 v[84:87], a[24:27], a[8:11], v[84:87]
ds_read_b64_tr_b16 a[64:65], v25 offset:62080
v_mfma_f32_16x16x32_bf16 v[88:91], a[24:27], a[12:15], v[88:91]
ds_read_b64_tr_b16 a[66:67], v25 offset:62592
v_add_f32 v165, v165, v169
v_mfma_f32_16x16x32_bf16 v[244:247], a[24:27], a[16:19], v[244:247]
ds_read_b64_tr_b16 a[68:69], v25 offset:62112
v_mfma_f32_16x16x32_bf16 v[92:95], a[28:31], a[0:3], v[92:95]
buffer_load_dwordx4 v20, s[20:23], s54 offen offset:2048 lds
v_mfma_f32_16x16x32_bf16 v[96:99], a[28:31], a[4:7], v[96:99]
s_add_u32 s54, s54, 196608
s_waitcnt lgkmcnt(7)
v_mfma_f32_16x16x32_bf16 v[100:103], a[28:31], a[8:11], v[100:103]
ds_read_b64_tr_b16 a[70:71], v25 offset:62624
v_mfma_f32_16x16x32_bf16 v[104:107], a[28:31], a[12:15], v[104:107]
ds_read_b128 a[60:63], v24 offset:48128
s_add_u32 m0, s55, 27648
v_mfma_f32_16x16x32_bf16 v[108:111], a[32:35], a[0:3], v[108:111]
buffer_load_dwordx4 v21, s[16:19], s52 offen sc1 lds
v_mfma_f32_16x16x32_bf16 v[112:115], a[32:35], a[4:7], v[112:115]
v_add_f32 v166, v166, v170
v_mfma_f32_16x16x32_bf16 v[116:119], a[32:35], a[8:11], v[116:119]
ds_read_b64_tr_b16 a[72:73], v25 offset:63104
v_mfma_f32_16x16x32_bf16 v[120:123], a[32:35], a[12:15], v[120:123]
ds_read_b64_tr_b16 a[74:75], v25 offset:63616
v_mfma_f32_16x16x32_bf16 v[124:127], a[0:3], a[36:39], v[124:127]
buffer_load_dwordx4 v21, s[16:19], s52 offen offset:1024 sc1 lds
v_mfma_f32_16x16x32_bf16 v[128:131], a[4:7], a[36:39], v[128:131]
ds_read_b64_tr_b16 a[76:77], v25 offset:63136
v_mfma_f32_16x16x32_bf16 v[132:135], a[8:11], a[36:39], v[132:135]
ds_read_b64_tr_b16 a[78:79], v25 offset:63648
v_mfma_f32_16x16x32_bf16 v[136:139], a[12:15], a[36:39], v[136:139]
ds_read_b64_tr_b16 a[80:81], v25 offset:64128
v_add_f32 v167, v167, v171
v_mfma_f32_16x16x32_bf16 v[156:159], a[16:19], a[36:39], v[156:159]
buffer_load_dword v22, s[16:19], s52 offen offset:2048 sc1 lds
v_mfma_f32_16x16x32_bf16 v[140:143], a[0:3], a[40:43], v[140:143]
ds_read_b64_tr_b16 a[82:83], v25 offset:64640
s_add_u32 s52, s52, 0x20000
v_mfma_f32_16x16x32_bf16 v[144:147], a[4:7], a[40:43], v[144:147]
ds_read_b64_tr_b16 a[84:85], v25 offset:64160
v_mfma_f32_16x16x32_bf16 v[148:151], a[8:11], a[40:43], v[148:151]
ds_read_b64_tr_b16 a[86:87], v25 offset:64672
v_mfma_f32_16x16x32_bf16 v[152:155], a[12:15], a[40:43], v[152:155]
v_mfma_f32_16x16x32_bf16 v[160:163], a[16:19], a[40:43], v[160:163]
s_waitcnt vmcnt(19) lgkmcnt(6)
s_barrier
v_mfma_f32_16x16x32_bf16 v[60:63], a[64:67], a[44:47], v[60:63]
ds_read_b128 a[0:3], v23
s_add_u32 m0, s56, 117248
v_mfma_f32_16x16x32_bf16 v[64:67], a[64:67], a[48:51], v[64:67]
buffer_load_dwordx4 v18, s[20:23], s54 offen lds
v_mfma_f32_16x16x32_bf16 v[68:71], a[64:67], a[52:55], v[68:71]
ds_read_b128 a[4:7], v23 offset:1024
v_mfma_f32_16x16x32_bf16 v[72:75], a[64:67], a[56:59], v[72:75]
ds_read_b128 a[8:11], v23 offset:2304
v_mfma_f32_16x16x32_bf16 v[76:79], a[68:71], a[44:47], v[76:79]
ds_read_b128 a[12:15], v23 offset:3328
v_mfma_f32_16x16x32_bf16 v[80:83], a[68:71], a[48:51], v[80:83]
buffer_load_dwordx4 v19, s[20:23], s54 offen offset:1024 lds
v_mfma_f32_16x16x32_bf16 v[84:87], a[68:71], a[52:55], v[84:87]
ds_read_b64_tr_b16 a[20:21], v25
v_mfma_f32_16x16x32_bf16 v[88:91], a[68:71], a[56:59], v[88:91]
ds_read_b64_tr_b16 a[22:23], v25 offset:512
v_mfma_f32_16x16x32_bf16 v[244:247], a[68:71], a[60:63], v[244:247]
ds_read_b64_tr_b16 a[24:25], v25 offset:32
v_mfma_f32_16x16x32_bf16 v[92:95], a[72:75], a[44:47], v[92:95]
buffer_load_dwordx4 v20, s[20:23], s54 offen offset:2048 lds
v_mfma_f32_16x16x32_bf16 v[96:99], a[72:75], a[48:51], v[96:99]
s_add_u32 s54, s54, 196608
s_waitcnt lgkmcnt(7)
v_mfma_f32_16x16x32_bf16 v[100:103], a[72:75], a[52:55], v[100:103]
ds_read_b64_tr_b16 a[26:27], v25 offset:544
v_mfma_f32_16x16x32_bf16 v[104:107], a[72:75], a[56:59], v[104:107]
ds_read_b128 a[16:19], v24 offset:2048
s_add_u32 m0, s55, 36864
v_mfma_f32_16x16x32_bf16 v[108:111], a[76:79], a[44:47], v[108:111]
buffer_load_dwordx4 v21, s[16:19], s52 offen sc1 lds
v_mfma_f32_16x16x32_bf16 v[112:115], a[76:79], a[48:51], v[112:115]
v_mfma_f32_16x16x32_bf16 v[116:119], a[76:79], a[52:55], v[116:119]
ds_read_b64_tr_b16 a[28:29], v25 offset:1024
v_mfma_f32_16x16x32_bf16 v[120:123], a[76:79], a[56:59], v[120:123]
ds_read_b64_tr_b16 a[30:31], v25 offset:1536
v_mfma_f32_16x16x32_bf16 v[124:127], a[44:47], a[80:83], v[124:127]
buffer_load_dwordx4 v21, s[16:19], s52 offen offset:1024 sc1 lds
v_mfma_f32_16x16x32_bf16 v[128:131], a[48:51], a[80:83], v[128:131]
ds_read_b64_tr_b16 a[32:33], v25 offset:1056
v_mfma_f32_16x16x32_bf16 v[132:135], a[52:55], a[80:83], v[132:135]
ds_read_b64_tr_b16 a[34:35], v25 offset:1568
v_mfma_f32_16x16x32_bf16 v[136:139], a[56:59], a[80:83], v[136:139]
ds_read_b64_tr_b16 a[36:37], v25 offset:2048
v_mfma_f32_16x16x32_bf16 v[156:159], a[60:63], a[80:83], v[156:159]
buffer_load_dword v22, s[16:19], s52 offen offset:2048 sc1 lds
v_mfma_f32_16x16x32_bf16 v[140:143], a[44:47], a[84:87], v[140:143]
ds_read_b64_tr_b16 a[38:39], v25 offset:2560
s_add_u32 s52, s52, 0x20000
v_mfma_f32_16x16x32_bf16 v[144:147], a[48:51], a[84:87], v[144:147]
ds_read_b64_tr_b16 a[40:41], v25 offset:2080
v_mfma_f32_16x16x32_bf16 v[148:151], a[52:55], a[84:87], v[148:151]
ds_read_b64_tr_b16 a[42:43], v25 offset:2592
v_mfma_f32_16x16x32_bf16 v[152:155], a[56:59], a[84:87], v[152:155]
v_mfma_f32_16x16x32_bf16 v[160:163], a[60:63], a[84:87], v[160:163]
s_waitcnt vmcnt(19) lgkmcnt(6)
s_barrier
v_mfma_f32_16x16x32_bf16 v[60:63], a[20:23], a[0:3], v[60:63]
ds_read_b128 a[44:47], v23 offset:9216
s_add_u32 m0, s56, 129664
v_mfma_f32_16x16x32_bf16 v[64:67], a[20:23], a[4:7], v[64:67]
buffer_load_dwordx4 v18, s[20:23], s54 offen lds
v_mfma_f32_16x16x32_bf16 v[68:71], a[20:23], a[8:11], v[68:71]
ds_read_b128 a[48:51], v23 offset:10240
s_waitcnt vmcnt(19)
v_add_f32 v164, v164, v172
v_mfma_f32_16x16x32_bf16 v[72:75], a[20:23], a[12:15], v[72:75]
ds_read_b128 a[52:55], v23 offset:11520
v_mfma_f32_16x16x32_bf16 v[76:79], a[24:27], a[0:3], v[76:79]
ds_read_b128 a[56:59], v23 offset:12544
v_mfma_f32_16x16x32_bf16 v[80:83], a[24:27], a[4:7], v[80:83]
buffer_load_dwordx4 v19, s[20:23], s54 offen offset:1024 lds
v_mfma_f32_16x16x32_bf16 v[84:87], a[24:27], a[8:11], v[84:87]
ds_read_b64_tr_b16 a[64:65], v25 offset:12416
v_mfma_f32_16x16x32_bf16 v[88:91], a[24:27], a[12:15], v[88:91]
ds_read_b64_tr_b16 a[66:67], v25 offset:12928
v_add_f32 v165, v165, v173
v_mfma_f32_16x16x32_bf16 v[244:247], a[24:27], a[16:19], v[244:247]
ds_read_b64_tr_b16 a[68:69], v25 offset:12448
v_mfma_f32_16x16x32_bf16 v[92:95], a[28:31], a[0:3], v[92:95]
buffer_load_dwordx4 v20, s[20:23], s54 offen offset:2048 lds
v_mfma_f32_16x16x32_bf16 v[96:99], a[28:31], a[4:7], v[96:99]
s_add_u32 s54, s54, 196608
s_waitcnt lgkmcnt(7)
v_mfma_f32_16x16x32_bf16 v[100:103], a[28:31], a[8:11], v[100:103]
ds_read_b64_tr_b16 a[70:71], v25 offset:12960
v_mfma_f32_16x16x32_bf16 v[104:107], a[28:31], a[12:15], v[104:107]
ds_read_b128 a[60:63], v24 offset:11264
s_add_u32 m0, s55, 46080
v_mfma_f32_16x16x32_bf16 v[108:111], a[32:35], a[0:3], v[108:111]
buffer_load_dwordx4 v21, s[16:19], s52 offen sc1 lds
v_mfma_f32_16x16x32_bf16 v[112:115], a[32:35], a[4:7], v[112:115]
v_add_f32 v166, v166, v174
v_mfma_f32_16x16x32_bf16 v[116:119], a[32:35], a[8:11], v[116:119]
ds_read_b64_tr_b16 a[72:73], v25 offset:13440
v_mfma_f32_16x16x32_bf16 v[120:123], a[32:35], a[12:15], v[120:123]
ds_read_b64_tr_b16 a[74:75], v25 offset:13952
v_mfma_f32_16x16x32_bf16 v[124:127], a[0:3], a[36:39], v[124:127]
buffer_load_dwordx4 v21, s[16:19], s52 offen offset:1024 sc1 lds
v_mfma_f32_16x16x32_bf16 v[128:131], a[4:7], a[36:39], v[128:131]
ds_read_b64_tr_b16 a[76:77], v25 offset:13472
v_mfma_f32_16x16x32_bf16 v[132:135], a[8:11], a[36:39], v[132:135]
ds_read_b64_tr_b16 a[78:79], v25 offset:13984
v_mfma_f32_16x16x32_bf16 v[136:139], a[12:15], a[36:39], v[136:139]
ds_read_b64_tr_b16 a[80:81], v25 offset:14464
v_add_f32 v167, v167, v175
v_mfma_f32_16x16x32_bf16 v[156:159], a[16:19], a[36:39], v[156:159]
buffer_load_dword v22, s[16:19], s52 offen offset:2048 sc1 lds
v_mfma_f32_16x16x32_bf16 v[140:143], a[0:3], a[40:43], v[140:143]
ds_read_b64_tr_b16 a[82:83], v25 offset:14976
s_add_u32 s52, s52, 0x20000
v_mfma_f32_16x16x32_bf16 v[144:147], a[4:7], a[40:43], v[144:147]
ds_read_b64_tr_b16 a[84:85], v25 offset:14496
v_mfma_f32_16x16x32_bf16 v[148:151], a[8:11], a[40:43], v[148:151]
ds_read_b64_tr_b16 a[86:87], v25 offset:15008
v_mfma_f32_16x16x32_bf16 v[152:155], a[12:15], a[40:43], v[152:155]
v_mfma_f32_16x16x32_bf16 v[160:163], a[16:19], a[40:43], v[160:163]
s_waitcnt vmcnt(18) lgkmcnt(6)
s_barrier
v_mfma_f32_16x16x32_bf16 v[60:63], a[64:67], a[44:47], v[60:63]
s_add_u32 m0, s59, 0
s_mov_b32 s58, 1048576
v_permlane32_swap_b32 v164, v166
v_mfma_f32_16x16x32_bf16 v[64:67], a[64:67], a[48:51], v[64:67]
buffer_load_dwordx4 v5, s[24:27], s58 offen lds
v_mfma_f32_16x16x32_bf16 v[68:71], a[64:67], a[52:55], v[68:71]
ds_read_b128 a[0:3], v23 offset:18432
v_mfma_f32_16x16x32_bf16 v[72:75], a[64:67], a[56:59], v[72:75]
ds_read_b128 a[4:7], v23 offset:19456
v_permlane32_swap_b32 v165, v167
v_mfma_f32_16x16x32_bf16 v[76:79], a[68:71], a[44:47], v[76:79]
ds_read_b128 a[8:11], v23 offset:20736
v_mfma_f32_16x16x32_bf16 v[80:83], a[68:71], a[48:51], v[80:83]
buffer_load_dwordx4 v6, s[24:27], s58 offen offset:1024 lds
v_mfma_f32_16x16x32_bf16 v[84:87], a[68:71], a[52:55], v[84:87]
ds_read_b128 a[12:15], v23 offset:21760
v_add_f32 v164, v164, v166
v_mfma_f32_16x16x32_bf16 v[88:91], a[68:71], a[56:59], v[88:91]
ds_read_b64_tr_b16 a[20:21], v25 offset:24832
v_mfma_f32_16x16x32_bf16 v[244:247], a[68:71], a[60:63], v[244:247]
s_add_u32 m0, s59, 58240
s_mov_b32 s58, 1966080
v_mfma_f32_16x16x32_bf16 v[92:95], a[72:75], a[44:47], v[92:95]
buffer_load_dwordx4 v5, s[24:27], s58 offen lds
v_mfma_f32_16x16x32_bf16 v[96:99], a[72:75], a[48:51], v[96:99]
ds_read_b64_tr_b16 a[22:23], v25 offset:25344
s_waitcnt lgkmcnt(6)
v_mfma_f32_16x16x32_bf16 v[100:103], a[72:75], a[52:55], v[100:103]
ds_read_b64_tr_b16 a[24:25], v25 offset:24864
v_add_f32 v165, v165, v167
v_mfma_f32_16x16x32_bf16 v[104:107], a[72:75], a[56:59], v[104:107]
ds_read_b64_tr_b16 a[26:27], v25 offset:25376
v_mfma_f32_16x16x32_bf16 v[108:111], a[76:79], a[44:47], v[108:111]
buffer_load_dwordx4 v6, s[24:27], s58 offen offset:1024 lds
v_mfma_f32_16x16x32_bf16 v[112:115], a[76:79], a[48:51], v[112:115]
ds_read_b128 a[16:19], v24 offset:20480
v_mul_f32 v164, 0xba800000, v164
v_mfma_f32_16x16x32_bf16 v[116:119], a[76:79], a[52:55], v[116:119]
ds_read_b64_tr_b16 a[28:29], v25 offset:25856
v_mfma_f32_16x16x32_bf16 v[120:123], a[76:79], a[56:59], v[120:123]
s_add_u32 m0, s59, 66560
s_mov_b32 s58, 0
v_mul_f32 v165, 0x3a800000, v165
v_mfma_f32_16x16x32_bf16 v[124:127], a[44:47], a[80:83], v[124:127]
buffer_load_dwordx4 v5, s[24:27], s58 offen lds
v_mfma_f32_16x16x32_bf16 v[128:131], a[48:51], a[80:83], v[128:131]
ds_read_b64_tr_b16 a[30:31], v25 offset:26368
v_mfma_f32_16x16x32_bf16 v[132:135], a[52:55], a[80:83], v[132:135]
ds_read_b64_tr_b16 a[32:33], v25 offset:25888
v_mfma_f32_16x16x32_bf16 v[136:139], a[56:59], a[80:83], v[136:139]
ds_read_b64_tr_b16 a[34:35], v25 offset:26400
v_fma_f32 v165, -v164, v164, v165
v_mfma_f32_16x16x32_bf16 v[156:159], a[60:63], a[80:83], v[156:159]
buffer_load_dwordx4 v6, s[24:27], s58 offen offset:1024 lds
v_mfma_f32_16x16x32_bf16 v[140:143], a[44:47], a[84:87], v[140:143]
ds_read_b64_tr_b16 a[36:37], v25 offset:26880
v_mfma_f32_16x16x32_bf16 v[144:147], a[48:51], a[84:87], v[144:147]
ds_read_b64_tr_b16 a[38:39], v25 offset:27392
v_max_f32 v165, 0, v165
v_mfma_f32_16x16x32_bf16 v[148:151], a[52:55], a[84:87], v[148:151]
ds_read_b64_tr_b16 a[40:41], v25 offset:26912
v_mfma_f32_16x16x32_bf16 v[152:155], a[56:59], a[84:87], v[152:155]
ds_read_b64_tr_b16 a[42:43], v25 offset:27424
v_mfma_f32_16x16x32_bf16 v[160:163], a[60:63], a[84:87], v[160:163]
s_waitcnt vmcnt(18) lgkmcnt(6)
s_barrier
v_mfma_f32_16x16x32_bf16 v[60:63], a[20:23], a[0:3], v[60:63]
s_add_u32 m0, s59, 8320
s_mov_b32 s58, 1179648
v_add_f32 v165, 0x3727c5ac, v165
v_mfma_f32_16x16x32_bf16 v[64:67], a[20:23], a[4:7], v[64:67]
buffer_load_dwordx4 v5, s[24:27], s58 offen lds
v_mfma_f32_16x16x32_bf16 v[68:71], a[20:23], a[8:11], v[68:71]
ds_read_b128 a[44:47], v23 offset:27648
v_mfma_f32_16x16x32_bf16 v[72:75], a[20:23], a[12:15], v[72:75]
ds_read_b128 a[48:51], v23 offset:28672
v_mfma_f32_16x16x32_bf16 v[76:79], a[24:27], a[0:3], v[76:79]
ds_read_b128 a[52:55], v23 offset:29952
v_mfma_f32_16x16x32_bf16 v[80:83], a[24:27], a[4:7], v[80:83]
buffer_load_dwordx4 v6, s[24:27], s58 offen offset:1024 lds
v_mfma_f32_16x16x32_bf16 v[84:87], a[24:27], a[8:11], v[84:87]
ds_read_b128 a[56:59], v23 offset:30976
v_rsq_f32 v166, v165
v_mfma_f32_16x16x32_bf16 v[88:91], a[24:27], a[12:15], v[88:91]
ds_read_b64_tr_b16 a[64:65], v25 offset:37248
v_mfma_f32_16x16x32_bf16 v[244:247], a[24:27], a[16:19], v[244:247]
s_add_u32 m0, s59, 74880
s_mov_b32 s58, 131072
v_mfma_f32_16x16x32_bf16 v[92:95], a[28:31], a[0:3], v[92:95]
buffer_load_dwordx4 v5, s[24:27], s58 offen lds
v_mfma_f32_16x16x32_bf16 v[96:99], a[28:31], a[4:7], v[96:99]
ds_read_b64_tr_b16 a[66:67], v25 offset:37760
s_waitcnt lgkmcnt(6)
v_mfma_f32_16x16x32_bf16 v[100:103], a[28:31], a[8:11], v[100:103]
ds_read_b64_tr_b16 a[68:69], v25 offset:37280
v_mfma_f32_16x16x32_bf16 v[104:107], a[28:31], a[12:15], v[104:107]
ds_read_b64_tr_b16 a[70:71], v25 offset:37792
v_mfma_f32_16x16x32_bf16 v[108:111], a[32:35], a[0:3], v[108:111]
buffer_load_dwordx4 v6, s[24:27], s58 offen offset:1024 lds
v_mfma_f32_16x16x32_bf16 v[112:115], a[32:35], a[4:7], v[112:115]
ds_read_b128 a[60:63], v24 offset:29696
v_mov_b32 v165, v166
v_mfma_f32_16x16x32_bf16 v[116:119], a[32:35], a[8:11], v[116:119]
ds_read_b64_tr_b16 a[72:73], v25 offset:38272
v_mfma_f32_16x16x32_bf16 v[120:123], a[32:35], a[12:15], v[120:123]
s_add_u32 m0, s59, 83200
s_mov_b32 s58, 262144
v_mfma_f32_16x16x32_bf16 v[124:127], a[0:3], a[36:39], v[124:127]
buffer_load_dwordx4 v5, s[24:27], s58 offen lds
v_mfma_f32_16x16x32_bf16 v[128:131], a[4:7], a[36:39], v[128:131]
ds_read_b64_tr_b16 a[74:75], v25 offset:38784
v_mfma_f32_16x16x32_bf16 v[132:135], a[8:11], a[36:39], v[132:135]
ds_read_b64_tr_b16 a[76:77], v25 offset:38304
v_mfma_f32_16x16x32_bf16 v[136:139], a[12:15], a[36:39], v[136:139]
ds_read_b64_tr_b16 a[78:79], v25 offset:38816
v_mul_f32 v166, 0x3e8293ee, v166
v_mfma_f32_16x16x32_bf16 v[156:159], a[16:19], a[36:39], v[156:159]
buffer_load_dwordx4 v6, s[24:27], s58 offen offset:1024 lds
v_mfma_f32_16x16x32_bf16 v[140:143], a[0:3], a[40:43], v[140:143]
ds_read_b64_tr_b16 a[80:81], v25 offset:39296
v_mfma_f32_16x16x32_bf16 v[144:147], a[4:7], a[40:43], v[144:147]
ds_read_b64_tr_b16 a[82:83], v25 offset:39808
v_mfma_f32_16x16x32_bf16 v[148:151], a[8:11], a[40:43], v[148:151]
ds_read_b64_tr_b16 a[84:85], v25 offset:39328
v_mfma_f32_16x16x32_bf16 v[152:155], a[12:15], a[40:43], v[152:155]
ds_read_b64_tr_b16 a[86:87], v25 offset:39840
v_mfma_f32_16x16x32_bf16 v[160:163], a[16:19], a[40:43], v[160:163]
s_waitcnt vmcnt(18) lgkmcnt(6)
s_barrier
v_mfma_f32_16x16x32_bf16 v[60:63], a[64:67], a[44:47], v[60:63]
s_add_u32 m0, s59, 16640
s_mov_b32 s58, 1310720
ds_write_b128 v7, v[164:167]
v_mfma_f32_16x16x32_bf16 v[64:67], a[64:67], a[48:51], v[64:67]
buffer_load_dwordx4 v5, s[24:27], s58 offen lds
v_mfma_f32_16x16x32_bf16 v[68:71], a[64:67], a[52:55], v[68:71]
ds_read_b128 a[0:3], v23 offset:36864
v_mfma_f32_16x16x32_bf16 v[72:75], a[64:67], a[56:59], v[72:75]
ds_read_b128 a[4:7], v23 offset:37888
v_mfma_f32_16x16x32_bf16 v[76:79], a[68:71], a[44:47], v[76:79]
ds_read_b128 a[8:11], v23 offset:39168
v_mfma_f32_16x16x32_bf16 v[80:83], a[68:71], a[48:51], v[80:83]
ds_read_b128 a[12:15], v23 offset:40192
v_mfma_f32_16x16x32_bf16 v[84:87], a[68:71], a[52:55], v[84:87]
ds_read_b64_tr_b16 a[20:21], v25 offset:49664
v_mfma_f32_16x16x32_bf16 v[88:91], a[68:71], a[56:59], v[88:91]
buffer_load_dwordx4 v6, s[24:27], s58 offen offset:1024 lds
v_mfma_f32_16x16x32_bf16 v[244:247], a[68:71], a[60:63], v[244:247]
ds_read_b64_tr_b16 a[22:23], v25 offset:50176
v_mfma_f32_16x16x32_bf16 v[92:95], a[72:75], a[44:47], v[92:95]
ds_write_b32 v17, v164
v_mfma_f32_16x16x32_bf16 v[96:99], a[72:75], a[48:51], v[96:99]
ds_read_b64_tr_b16 a[24:25], v25 offset:49696
s_waitcnt lgkmcnt(9)
v_mfma_f32_16x16x32_bf16 v[100:103], a[72:75], a[52:55], v[100:103]
ds_read_b64_tr_b16 a[26:27], v25 offset:50208
v_mfma_f32_16x16x32_bf16 v[104:107], a[72:75], a[56:59], v[104:107]
s_add_u32 m0, s59, 91520
s_mov_b32 s58, 393216
v_mfma_f32_16x16x32_bf16 v[108:111], a[76:79], a[44:47], v[108:111]
buffer_load_dwordx4 v5, s[24:27], s58 offen lds
v_mfma_f32_16x16x32_bf16 v[112:115], a[76:79], a[48:51], v[112:115]
ds_read_b128 a[16:19], v24 offset:38912
v_mfma_f32_16x16x32_bf16 v[116:119], a[76:79], a[52:55], v[116:119]
ds_read_b64_tr_b16 a[28:29], v25 offset:50688
v_mfma_f32_16x16x32_bf16 v[120:123], a[76:79], a[56:59], v[120:123]
ds_read_b64_tr_b16 a[30:31], v25 offset:51200
v_mfma_f32_16x16x32_bf16 v[124:127], a[44:47], a[80:83], v[124:127]
ds_read_b64_tr_b16 a[32:33], v25 offset:50720
v_mfma_f32_16x16x32_bf16 v[128:131], a[48:51], a[80:83], v[128:131]
ds_write_b32 v17, v165 offset:1024
v_mfma_f32_16x16x32_bf16 v[132:135], a[52:55], a[80:83], v[132:135]
buffer_load_dwordx4 v6, s[24:27], s58 offen offset:1024 lds
v_mfma_f32_16x16x32_bf16 v[136:139], a[56:59], a[80:83], v[136:139]
ds_read_b64_tr_b16 a[34:35], v25 offset:51232
v_mfma_f32_16x16x32_bf16 v[156:159], a[60:63], a[80:83], v[156:159]
ds_read_b64_tr_b16 a[36:37], v25 offset:51712
v_mfma_f32_16x16x32_bf16 v[140:143], a[44:47], a[84:87], v[140:143]
ds_read_b64_tr_b16 a[38:39], v25 offset:52224
v_mfma_f32_16x16x32_bf16 v[144:147], a[48:51], a[84:87], v[144:147]
ds_read_b64_tr_b16 a[40:41], v25 offset:51744
v_mfma_f32_16x16x32_bf16 v[148:151], a[52:55], a[84:87], v[148:151]
ds_read_b64_tr_b16 a[42:43], v25 offset:52256
v_mfma_f32_16x16x32_bf16 v[152:155], a[56:59], a[84:87], v[152:155]
v_mfma_f32_16x16x32_bf16 v[160:163], a[60:63], a[84:87], v[160:163]
s_waitcnt vmcnt(16) lgkmcnt(7)
s_barrier
v_mfma_f32_16x16x32_bf16 v[60:63], a[20:23], a[0:3], v[60:63]
s_add_u32 m0, s59, 24960
s_mov_b32 s58, 1441792
v_mfma_f32_16x16x32_bf16 v[64:67], a[20:23], a[4:7], v[64:67]
buffer_load_dwordx4 v5, s[24:27], s58 offen lds
v_mfma_f32_16x16x32_bf16 v[68:71], a[20:23], a[8:11], v[68:71]
ds_read_b128 a[44:47], v23 offset:46080
v_mfma_f32_16x16x32_bf16 v[72:75], a[20:23], a[12:15], v[72:75]
ds_read_b128 a[48:51], v23 offset:47104
v_mfma_f32_16x16x32_bf16 v[76:79], a[24:27], a[0:3], v[76:79]
ds_read_b128 a[52:55], v23 offset:48384
v_mfma_f32_16x16x32_bf16 v[80:83], a[24:27], a[4:7], v[80:83]
buffer_load_dwordx4 v6, s[24:27], s58 offen offset:1024 lds
v_mfma_f32_16x16x32_bf16 v[84:87], a[24:27], a[8:11], v[84:87]
ds_read_b128 a[56:59], v23 offset:49408
v_mfma_f32_16x16x32_bf16 v[88:91], a[24:27], a[12:15], v[88:91]
ds_read_b64_tr_b16 a[64:65], v25 offset:62080
v_mfma_f32_16x16x32_bf16 v[244:247], a[24:27], a[16:19], v[244:247]
s_add_u32 m0, s59, 99840
s_mov_b32 s58, 524288
v_mfma_f32_16x16x32_bf16 v[92:95], a[28:31], a[0:3], v[92:95]
buffer_load_dwordx4 v5, s[24:27], s58 offen lds
v_mfma_f32_16x16x32_bf16 v[96:99], a[28:31], a[4:7], v[96:99]
ds_read_b64_tr_b16 a[66:67], v25 offset:62592
s_waitcnt lgkmcnt(6)
v_mfma_f32_16x16x32_bf16 v[100:103], a[28:31], a[8:11], v[100:103]
ds_read_b64_tr_b16 a[68:69], v25 offset:62112
v_mfma_f32_16x16x32_bf16 v[104:107], a[28:31], a[12:15], v[104:107]
ds_read_b64_tr_b16 a[70:71], v25 offset:62624
v_mfma_f32_16x16x32_bf16 v[108:111], a[32:35], a[0:3], v[108:111]
buffer_load_dwordx4 v6, s[24:27], s58 offen offset:1024 lds
v_mfma_f32_16x16x32_bf16 v[112:115], a[32:35], a[4:7], v[112:115]
ds_read_b128 a[60:63], v24 offset:48128
v_mfma_f32_16x16x32_bf16 v[116:119], a[32:35], a[8:11], v[116:119]
ds_read_b64_tr_b16 a[72:73], v25 offset:63104
v_mfma_f32_16x16x32_bf16 v[120:123], a[32:35], a[12:15], v[120:123]
s_add_u32 m0, s59, 108160
s_mov_b32 s58, 655360
v_mfma_f32_16x16x32_bf16 v[124:127], a[0:3], a[36:39], v[124:127]
buffer_load_dwordx4 v5, s[24:27], s58 offen lds
v_mfma_f32_16x16x32_bf16 v[128:131], a[4:7], a[36:39], v[128:131]
ds_read_b64_tr_b16 a[74:75], v25 offset:63616
v_mfma_f32_16x16x32_bf16 v[132:135], a[8:11], a[36:39], v[132:135]
ds_read_b64_tr_b16 a[76:77], v25 offset:63136
v_mfma_f32_16x16x32_bf16 v[136:139], a[12:15], a[36:39], v[136:139]
ds_read_b64_tr_b16 a[78:79], v25 offset:63648
v_mfma_f32_16x16x32_bf16 v[156:159], a[16:19], a[36:39], v[156:159]
buffer_load_dwordx4 v6, s[24:27], s58 offen offset:1024 lds
v_mfma_f32_16x16x32_bf16 v[140:143], a[0:3], a[40:43], v[140:143]
ds_read_b64_tr_b16 a[80:81], v25 offset:64128
v_mfma_f32_16x16x32_bf16 v[144:147], a[4:7], a[40:43], v[144:147]
ds_read_b64_tr_b16 a[82:83], v25 offset:64640
v_mfma_f32_16x16x32_bf16 v[148:151], a[8:11], a[40:43], v[148:151]
ds_read_b64_tr_b16 a[84:85], v25 offset:64160
v_mfma_f32_16x16x32_bf16 v[152:155], a[12:15], a[40:43], v[152:155]
ds_read_b64_tr_b16 a[86:87], v25 offset:64672
v_mfma_f32_16x16x32_bf16 v[160:163], a[16:19], a[40:43], v[160:163]
s_waitcnt lgkmcnt(0)
s_barrier
v_mfma_f32_16x16x32_bf16 v[244:247], a[68:71], a[60:63], v[244:247]
ds_read_b128 v[232:235], v10 offset:1792
v_mfma_f32_16x16x32_bf16 v[156:159], a[60:63], a[80:83], v[156:159]
ds_read_b128 v[228:231], v10 offset:1536
v_mfma_f32_16x16x32_bf16 v[160:163], a[60:63], a[84:87], v[160:163]
ds_read_b128 v[224:227], v10 offset:1280
v_mfma_f32_16x16x32_bf16 v[104:107], a[72:75], a[56:59], v[104:107]
ds_read_b128 v[220:223], v10 offset:1024
v_mfma_f32_16x16x32_bf16 v[120:123], a[76:79], a[56:59], v[120:123]
v_mfma_f32_16x16x32_bf16 v[136:139], a[56:59], a[80:83], v[136:139]
v_mfma_f32_16x16x32_bf16 v[152:155], a[56:59], a[84:87], v[152:155]
v_mfma_f32_16x16x32_bf16 v[100:103], a[72:75], a[52:55], v[100:103]
v_mfma_f32_16x16x32_bf16 v[116:119], a[76:79], a[52:55], v[116:119]
s_mov_b32 exec_lo, 0x10001
s_mov_b32 exec_hi, 0x10001
ds_write_b128 v13, v[244:247] offset:64
s_mov_b64 exec, 0xffff
ds_write_b32 v12, v156 offset:512
ds_write_b32 v12, v160 offset:576
s_mov_b64 exec, -1
v_mfma_f32_16x16x32_bf16 v[96:99], a[72:75], a[48:51], v[96:99]
v_mfma_f32_16x16x32_bf16 v[112:115], a[76:79], a[48:51], v[112:115]
v_mfma_f32_16x16x32_bf16 v[92:95], a[72:75], a[44:47], v[92:95]
v_mfma_f32_16x16x32_bf16 v[108:111], a[76:79], a[44:47], v[108:111]
v_mfma_f32_16x16x32_bf16 v[72:75], a[64:67], a[56:59], v[72:75]
v_mfma_f32_16x16x32_bf16 v[88:91], a[68:71], a[56:59], v[88:91]
s_waitcnt lgkmcnt(0)
s_barrier
v_mfma_f32_16x16x32_bf16 v[132:135], a[52:55], a[80:83], v[132:135]
ds_read_b128 v[28:31], v13
s_add_u32 m0, s59, 33280
v_mfma_f32_16x16x32_bf16 v[148:151], a[52:55], a[84:87], v[148:151]
ds_read_b128 v[32:35], v13 offset:64
s_mov_b32 s58, 1572864
v_mfma_f32_16x16x32_bf16 v[68:71], a[64:67], a[52:55], v[68:71]
ds_read_b128 v[36:39], v13 offset:256
v_mfma_f32_16x16x32_bf16 v[84:87], a[68:71], a[52:55], v[84:87]
ds_read_b128 v[40:43], v13 offset:320
v_mfma_f32_16x16x32_bf16 v[128:131], a[48:51], a[80:83], v[128:131]
ds_read_b32 v44, v12 offset:512
v_mfma_f32_16x16x32_bf16 v[144:147], a[48:51], a[84:87], v[144:147]
ds_read_b32 v45, v12 offset:576
v_mfma_f32_16x16x32_bf16 v[64:67], a[64:67], a[48:51], v[64:67]
ds_read_b128 v[240:243], v11 offset:704
v_mfma_f32_16x16x32_bf16 v[80:83], a[68:71], a[48:51], v[80:83]
ds_read_b128 v[244:247], v11 offset:1728
v_mfma_f32_16x16x32_bf16 v[124:127], a[44:47], a[80:83], v[124:127]
buffer_load_dwordx4 v5, s[24:27], s58 offen lds
ds_read_b128 v[18:21], v11 offset:448
s_waitcnt lgkmcnt(8)
v_pk_fma_f32 v[72:73], v[28:29], v[232:233], v[72:73] op_sel_hi:[1,0,1]
v_pk_fma_f32 v[74:75], v[30:31], v[232:233], v[74:75] op_sel_hi:[1,0,1]
s_waitcnt lgkmcnt(6)
v_pk_fma_f32 v[104:105], v[36:37], v[232:233], v[104:105] op_sel_hi:[1,0,1]
v_pk_mul_f32 v[104:105], v[104:105], v[232:233] op_sel:[0,1] op_sel_hi:[1,1]
v_pk_fma_f32 v[106:107], v[38:39], v[232:233], v[106:107] op_sel_hi:[1,0,1]
v_pk_mul_f32 v[106:107], v[106:107], v[232:233] op_sel:[0,1] op_sel_hi:[1,1]
s_waitcnt lgkmcnt(5)
v_pk_fma_f32 v[120:121], v[40:41], v[232:233], v[120:121] op_sel_hi:[1,0,1]
v_pk_mul_f32 v[120:121], v[120:121], v[232:233] op_sel:[0,1] op_sel_hi:[1,1]
v_pk_fma_f32 v[122:123], v[42:43], v[232:233], v[122:123] op_sel_hi:[1,0,1]
v_pk_mul_f32 v[122:123], v[122:123], v[232:233] op_sel:[0,1] op_sel_hi:[1,1]
v_pk_fma_f32 v[100:101], v[36:37], v[228:229], v[100:101] op_sel_hi:[1,0,1]
v_pk_mul_f32 v[100:101], v[100:101], v[228:229] op_sel:[0,1] op_sel_hi:[1,1]
v_pk_fma_f32 v[102:103], v[38:39], v[228:229], v[102:103] op_sel_hi:[1,0,1]
v_pk_mul_f32 v[102:103], v[102:103], v[228:229] op_sel:[0,1] op_sel_hi:[1,1]
v_pk_fma_f32 v[116:117], v[40:41], v[228:229], v[116:117] op_sel_hi:[1,0,1]
v_pk_mul_f32 v[116:117], v[116:117], v[228:229] op_sel:[0,1] op_sel_hi:[1,1]
v_pk_fma_f32 v[118:119], v[42:43], v[228:229], v[118:119] op_sel_hi:[1,0,1]
v_pk_mul_f32 v[118:119], v[118:119], v[228:229] op_sel:[0,1] op_sel_hi:[1,1]
s_waitcnt lgkmcnt(2)
v_pk_fma_f32 v[156:157], v[240:241], v[44:45], v[156:157] op_sel_hi:[1,0,1]
v_pk_fma_f32 v[158:159], v[242:243], v[44:45], v[158:159] op_sel_hi:[1,0,1]
v_pk_fma_f32 v[160:161], v[240:241], v[44:45], v[160:161] op_sel:[0,1,0] op_sel_hi:[1,1,1]
v_pk_fma_f32 v[162:163], v[242:243], v[44:45], v[162:163] op_sel:[0,1,0] op_sel_hi:[1,1,1]
s_waitcnt lgkmcnt(1)
v_pk_mul_f32 v[156:157], v[156:157], v[244:245]
v_pk_mul_f32 v[158:159], v[158:159], v[246:247]
v_pk_mul_f32 v[160:161], v[160:161], v[244:245]
v_pk_mul_f32 v[162:163], v[162:163], v[246:247]
v_pk_fma_f32 v[88:89], v[32:33], v[232:233], v[88:89] op_sel_hi:[1,0,1]
v_pk_fma_f32 v[90:91], v[34:35], v[232:233], v[90:91] op_sel_hi:[1,0,1]
v_pk_fma_f32 v[96:97], v[36:37], v[224:225], v[96:97] op_sel_hi:[1,0,1]
s_waitcnt lgkmcnt(0)
v_pk_fma_f32 v[136:137], v[18:19], v[44:45], v[136:137] op_sel_hi:[1,0,1]
v_pk_fma_f32 v[138:139], v[20:21], v[44:45], v[138:139] op_sel_hi:[1,0,1]
v_pk_fma_f32 v[152:153], v[18:19], v[44:45], v[152:153] op_sel:[0,1,0] op_sel_hi:[1,1,1]
v_pk_fma_f32 v[154:155], v[20:21], v[44:45], v[154:155] op_sel:[0,1,0] op_sel_hi:[1,1,1]
v_pk_mul_f32 v[96:97], v[96:97], v[224:225] op_sel:[0,1] op_sel_hi:[1,1]
v_pk_fma_f32 v[98:99], v[38:39], v[224:225], v[98:99] op_sel_hi:[1,0,1]
v_pk_mul_f32 v[98:99], v[98:99], v[224:225] op_sel:[0,1] op_sel_hi:[1,1]
v_pk_fma_f32 v[112:113], v[40:41], v[224:225], v[112:113] op_sel_hi:[1,0,1]
v_pk_mul_f32 v[112:113], v[112:113], v[224:225] op_sel:[0,1] op_sel_hi:[1,1]
v_pk_fma_f32 v[114:115], v[42:43], v[224:225], v[114:115] op_sel_hi:[1,0,1]
v_pk_mul_f32 v[114:115], v[114:115], v[224:225] op_sel:[0,1] op_sel_hi:[1,1]
v_pk_fma_f32 v[68:69], v[28:29], v[228:229], v[68:69] op_sel_hi:[1,0,1]
v_pk_fma_f32 v[70:71], v[30:31], v[228:229], v[70:71] op_sel_hi:[1,0,1]
v_pk_fma_f32 v[84:85], v[32:33], v[228:229], v[84:85] op_sel_hi:[1,0,1]
v_pk_fma_f32 v[86:87], v[34:35], v[228:229], v[86:87] op_sel_hi:[1,0,1]
v_pk_fma_f32 v[92:93], v[36:37], v[220:221], v[92:93] op_sel_hi:[1,0,1]
.Lpad7:
s_cbranch_execz .Lnopoll8r
v_pk_mul_f32 v[92:93], v[92:93], v[220:221] op_sel:[0,1] op_sel_hi:[1,1]
v_pk_fma_f32 v[94:95], v[38:39], v[220:221], v[94:95] op_sel_hi:[1,0,1]
v_pk_mul_f32 v[94:95], v[94:95], v[220:221] op_sel:[0,1] op_sel_hi:[1,1]
v_pk_fma_f32 v[108:109], v[40:41], v[220:221], v[108:109] op_sel_hi:[1,0,1]
v_pk_mul_f32 v[108:109], v[108:109], v[220:221] op_sel:[0,1] op_sel_hi:[1,1]
v_pk_fma_f32 v[110:111], v[42:43], v[220:221], v[110:111] op_sel_hi:[1,0,1]
v_pk_mul_f32 v[110:111], v[110:111], v[220:221] op_sel:[0,1] op_sel_hi:[1,1]
v_pk_fma_f32 v[64:65], v[28:29], v[224:225], v[64:65] op_sel_hi:[1,0,1]
v_pk_fma_f32 v[66:67], v[30:31], v[224:225], v[66:67] op_sel_hi:[1,0,1]
v_pk_fma_f32 v[80:81], v[32:33], v[224:225], v[80:81] op_sel_hi:[1,0,1]
v_pk_fma_f32 v[82:83], v[34:35], v[224:225], v[82:83] op_sel_hi:[1,0,1]
v_cvt_pk_bf16_f32 v236, v156, v157
v_cvt_pk_bf16_f32 v237, v158, v159
v_mfma_f32_16x16x32_bf16 v[140:143], a[44:47], a[84:87], v[140:143]
buffer_load_dwordx4 v6, s[24:27], s58 offen offset:1024 lds
v_mfma_f32_16x16x32_bf16 v[60:63], a[64:67], a[44:47], v[60:63]
s_add_u32 m0, s59, 41600
v_cvt_pk_bf16_f32 v238, v160, v161
v_cvt_pk_bf16_f32 v239, v162, v163
v_mfma_f32_16x16x32_bf16 v[76:79], a[68:71], a[44:47], v[76:79]
ds_write_b128 v8, v[236:239] offset:1024
s_mov_b32 s58, 1703936
v_cvt_pk_bf16_f32 v196, v104, v105
v_cvt_pk_bf16_f32 v197, v106, v107
v_cvt_pk_bf16_f32 v198, v120, v121
v_cvt_pk_bf16_f32 v199, v122, v123
ds_read_b128 v[22:25], v11 offset:1472
buffer_load_dwordx4 v5, s[24:27], s58 offen lds
v_cvt_pk_bf16_f32 v192, v100, v101
v_cvt_pk_bf16_f32 v193, v102, v103
v_cvt_pk_bf16_f32 v194, v116, v117
v_cvt_pk_bf16_f32 v195, v118, v119
v_cvt_pk_bf16_f32 v176, v72, v73
v_cvt_pk_bf16_f32 v177, v74, v75
v_cvt_pk_bf16_f32 v178, v88, v89
v_cvt_pk_bf16_f32 v179, v90, v91
v_pk_fma_f32 v[60:61], v[28:29], v[220:221], v[60:61] op_sel_hi:[1,0,1]
v_pk_fma_f32 v[62:63], v[30:31], v[220:221], v[62:63] op_sel_hi:[1,0,1]
v_pk_fma_f32 v[76:77], v[32:33], v[220:221], v[76:77] op_sel_hi:[1,0,1]
v_pk_fma_f32 v[78:79], v[34:35], v[220:221], v[78:79] op_sel_hi:[1,0,1]
ds_read_b128 v[240:243], v11 offset:384
s_nop 0
v_mfma_f32_16x16x32_bf16 v[104:107], v[192:195], v[176:179], v[46:49]
buffer_load_dwordx4 v6, s[24:27], s58 offen offset:1024 lds
v_mfma_f32_16x16x32_bf16 v[120:123], v[196:199], v[176:179], v[50:53]
s_add_u32 m0, s59, 49920
s_waitcnt lgkmcnt(2)
s_barrier
ds_read_b128 v[180:183], v9
ds_read_b64 v[200:201], v9 offset:1024
ds_read_b64 v[210:211], v9 offset:1032
s_mov_b32 s58, 1835008
s_waitcnt lgkmcnt(4)
v_pk_mul_f32 v[136:137], v[136:137], v[22:23]
v_cvt_pk_bf16_f32 v208, v136, v137
v_pk_mul_f32 v[138:139], v[138:139], v[24:25]
buffer_load_dwordx4 v5, s[24:27], s58 offen lds
v_cvt_pk_bf16_f32 v209, v138, v139
v_pk_mul_f32 v[152:153], v[152:153], v[22:23]
v_cvt_pk_bf16_f32 v218, v152, v153
v_pk_mul_f32 v[154:155], v[154:155], v[24:25]
v_cvt_pk_bf16_f32 v219, v154, v155
ds_read_b128 v[244:247], v11 offset:1408
v_max3_f32 v88, v104, v105, v106
v_max3_f32 v89, v107, v120, v121
v_max3_f32 v88, v88, v122, v123
s_waitcnt lgkmcnt(4)
v_pk_fma_f32 v[132:133], v[240:241], v[44:45], v[132:133] op_sel_hi:[1,0,1]
v_pk_fma_f32 v[134:135], v[242:243], v[44:45], v[134:135] op_sel_hi:[1,0,1]
v_pk_fma_f32 v[148:149], v[240:241], v[44:45], v[148:149] op_sel:[0,1,0] op_sel_hi:[1,1,1]
buffer_load_dwordx4 v6, s[24:27], s58 offen offset:1024 lds
s_add_u32 m0, s59, 116480
s_mov_b32 s58, 786432
v_pk_fma_f32 v[150:151], v[242:243], v[44:45], v[150:151] op_sel:[0,1,0] op_sel_hi:[1,1,1]
v_max_f32 v90, v88, v89
v_max_f32 v89, v88, v89
v_cvt_pk_bf16_f32 v188, v96, v97
v_cvt_pk_bf16_f32 v189, v98, v99
v_permlane16_swap_b32 v90, v89
v_cvt_pk_bf16_f32 v190, v112, v113
v_max_f32 v88, v90, v89
v_max_f32 v89, v90, v89
v_cvt_pk_bf16_f32 v191, v114, v115
buffer_load_dwordx4 v5, s[24:27], s58 offen lds
v_permlane32_swap_b32 v88, v89
v_cvt_pk_bf16_f32 v172, v68, v69
v_max_f32 v88, v88, v89
v_mul_f32 v88, v88, v234
s_waitcnt lgkmcnt(0)
v_pk_mul_f32 v[132:133], v[132:133], v[244:245]
v_cvt_pk_bf16_f32 v206, v132, v133
v_pk_mul_f32 v[134:135], v[134:135], v[246:247]
v_cvt_pk_bf16_f32 v207, v134, v135
v_pk_mul_f32 v[148:149], v[148:149], v[244:245]
v_cvt_pk_bf16_f32 v216, v148, v149
v_pk_mul_f32 v[150:151], v[150:151], v[246:247]
v_cvt_pk_bf16_f32 v217, v150, v151
buffer_load_dwordx4 v6, s[24:27], s58 offen offset:1024 lds
s_add_u32 m0, s59, 124800
s_mov_b32 s58, 917504
v_pk_fma_f32 v[104:105], v[104:105], v[234:235], v[88:89] op_sel_hi:[1,0,0] neg_lo:[0,0,1] neg_hi:[0,0,1]
v_pk_fma_f32 v[106:107], v[106:107], v[234:235], v[88:89] op_sel_hi:[1,0,0] neg_lo:[0,0,1] neg_hi:[0,0,1]
v_pk_fma_f32 v[120:121], v[120:121], v[234:235], v[88:89] op_sel_hi:[1,0,0] neg_lo:[0,0,1] neg_hi:[0,0,1]
v_pk_fma_f32 v[122:123], v[122:123], v[234:235], v[88:89] op_sel_hi:[1,0,0] neg_lo:[0,0,1] neg_hi:[0,0,1]
v_exp_f32 v104, v104
v_exp_f32 v105, v105
v_exp_f32 v106, v106
v_exp_f32 v107, v107
v_exp_f32 v120, v120
v_exp_f32 v121, v121
v_exp_f32 v122, v122
v_exp_f32 v123, v123
v_cvt_pk_bf16_f32 v72, v104, v105
buffer_load_dwordx4 v5, s[24:27], s58 offen lds
v_cvt_pk_bf16_f32 v73, v106, v107
v_cvt_pk_bf16_f32 v74, v120, v121
v_cvt_pk_bf16_f32 v75, v122, v123
v_cvt_pk_bf16_f32 v173, v70, v71
v_cvt_pk_bf16_f32 v174, v84, v85
v_mfma_f32_16x16x32_bf16 v[88:91], v[248:251], v[72:75], 0
ds_read_b128 v[18:21], v11 offset:320
v_cvt_pk_bf16_f32 v175, v86, v87
v_mfma_f32_16x16x32_bf16 v[104:107], v[206:209], v[72:75], 0
ds_read_b128 v[22:25], v11 offset:1344
v_cvt_pk_bf16_f32 v184, v92, v93
v_mfma_f32_16x16x32_bf16 v[120:123], v[216:219], v[72:75], 0
buffer_load_dwordx4 v6, s[24:27], s58 offen offset:1024 lds
v_mfma_f32_16x16x32_bf16 v[100:103], v[188:191], v[172:175], v[46:49]
ds_read_b128 v[240:243], v11 offset:256
v_rcp_f32 v88, v88
v_mfma_f32_16x16x32_bf16 v[116:119], v[192:195], v[172:175], v[50:53]
ds_read_b128 v[244:247], v11 offset:1280
v_cvt_pk_bf16_f32 v185, v94, v95
s_nop 2
v_max3_f32 v84, v100, v101, v102
v_cvt_pk_bf16_f32 v186, v108, v109
v_cvt_pk_bf16_f32 v187, v110, v111
v_pk_mul_f32 v[104:105], v[104:105], v[88:89] op_sel_hi:[1,0]
v_pk_mul_f32 v[106:107], v[106:107], v[88:89] op_sel_hi:[1,0]
v_pk_mul_f32 v[120:121], v[120:121], v[88:89] op_sel_hi:[1,0]
v_pk_mul_f32 v[122:123], v[122:123], v[88:89] op_sel_hi:[1,0]
v_cvt_pk_bf16_f32 v176, v104, v105
v_cvt_pk_bf16_f32 v177, v106, v107
v_cvt_pk_bf16_f32 v178, v120, v121
v_cvt_pk_bf16_f32 v179, v122, v123
buffer_store_dwordx4 v[176:179], v4, s[16:19], s74 offen offset:3072 sc1
s_waitcnt lgkmcnt(3)
v_pk_fma_f32 v[128:129], v[18:19], v[44:45], v[128:129] op_sel_hi:[1,0,1]
v_pk_fma_f32 v[130:131], v[20:21], v[44:45], v[130:131] op_sel_hi:[1,0,1]
s_waitcnt lgkmcnt(2)
v_pk_mul_f32 v[128:129], v[128:129], v[22:23]
v_cvt_pk_bf16_f32 v204, v128, v129
v_pk_mul_f32 v[130:131], v[130:131], v[24:25]
v_cvt_pk_bf16_f32 v205, v130, v131
v_pk_fma_f32 v[144:145], v[18:19], v[44:45], v[144:145] op_sel:[0,1,0] op_sel_hi:[1,1,1]
v_pk_mul_f32 v[144:145], v[144:145], v[22:23]
v_cvt_pk_bf16_f32 v214, v144, v145
v_pk_fma_f32 v[146:147], v[20:21], v[44:45], v[146:147] op_sel:[0,1,0] op_sel_hi:[1,1,1]
v_pk_mul_f32 v[146:147], v[146:147], v[24:25]
v_cvt_pk_bf16_f32 v215, v146, v147
v_max3_f32 v85, v103, v116, v117
v_max3_f32 v84, v84, v118, v119
v_max_f32 v86, v84, v85
v_max_f32 v85, v84, v85
v_cvt_pk_bf16_f32 v168, v64, v65
v_cvt_pk_bf16_f32 v169, v66, v67
v_permlane16_swap_b32 v86, v85
v_cvt_pk_bf16_f32 v170, v80, v81
v_max_f32 v84, v86, v85
v_max_f32 v85, v86, v85
v_cvt_pk_bf16_f32 v171, v82, v83
s_waitcnt lgkmcnt(1)
v_pk_fma_f32 v[124:125], v[240:241], v[44:45], v[124:125] op_sel_hi:[1,0,1]
s_waitcnt lgkmcnt(0)
v_pk_mul_f32 v[124:125], v[124:125], v[244:245]
v_pk_fma_f32 v[126:127], v[242:243], v[44:45], v[126:127] op_sel_hi:[1,0,1]
v_pk_mul_f32 v[126:127], v[126:127], v[246:247]
v_pk_fma_f32 v[140:141], v[240:241], v[44:45], v[140:141] op_sel:[0,1,0] op_sel_hi:[1,1,1]
v_pk_mul_f32 v[140:141], v[140:141], v[244:245]
v_pk_fma_f32 v[142:143], v[242:243], v[44:45], v[142:143] op_sel:[0,1,0] op_sel_hi:[1,1,1]
v_pk_mul_f32 v[142:143], v[142:143], v[246:247]
v_permlane32_swap_b32 v84, v85
s_nop 0
v_mfma_f32_16x16x32_bf16 v[96:99], v[184:187], v[168:171], v[46:49]
v_max_f32 v84, v84, v85
v_mul_f32 v84, v84, v230
v_mfma_f32_16x16x32_bf16 v[112:115], v[188:191], v[168:171], v[50:53]
v_cvt_pk_bf16_f32 v202, v124, v125
v_cvt_pk_bf16_f32 v203, v126, v127
v_cvt_pk_bf16_f32 v212, v140, v141
v_cvt_pk_bf16_f32 v213, v142, v143
s_nop 0
v_max3_f32 v80, v96, v97, v98
v_pk_fma_f32 v[100:101], v[100:101], v[230:231], v[84:85] op_sel_hi:[1,0,0] neg_lo:[0,0,1] neg_hi:[0,0,1]
v_pk_fma_f32 v[102:103], v[102:103], v[230:231], v[84:85] op_sel_hi:[1,0,0] neg_lo:[0,0,1] neg_hi:[0,0,1]
v_pk_fma_f32 v[116:117], v[116:117], v[230:231], v[84:85] op_sel_hi:[1,0,0] neg_lo:[0,0,1] neg_hi:[0,0,1]
v_pk_fma_f32 v[118:119], v[118:119], v[230:231], v[84:85] op_sel_hi:[1,0,0] neg_lo:[0,0,1] neg_hi:[0,0,1]
v_exp_f32 v100, v100
v_exp_f32 v101, v101
v_exp_f32 v102, v102
v_exp_f32 v103, v103
v_exp_f32 v116, v116
v_exp_f32 v117, v117
v_exp_f32 v118, v118
v_exp_f32 v119, v119
v_cvt_pk_bf16_f32 v68, v100, v101
v_cvt_pk_bf16_f32 v69, v102, v103
v_cvt_pk_bf16_f32 v70, v116, v117
v_cvt_pk_bf16_f32 v71, v118, v119
v_max3_f32 v81, v99, v112, v113
v_max3_f32 v80, v80, v114, v115
v_mfma_f32_16x16x32_bf16 v[84:87], v[248:251], v[68:71], 0
v_max_f32 v82, v80, v81
v_max_f32 v81, v80, v81
v_mfma_f32_16x16x32_bf16 v[100:103], v[204:207], v[68:71], 0
s_nop 0
v_permlane16_swap_b32 v82, v81
v_mfma_f32_16x16x32_bf16 v[116:119], v[214:217], v[68:71], 0
s_nop 1
v_rcp_f32 v84, v84
v_max_f32 v80, v82, v81
v_max_f32 v81, v82, v81
v_cvt_pk_bf16_f32 v164, v60, v61
v_pk_mul_f32 v[100:101], v[100:101], v[84:85] op_sel_hi:[1,0]
v_pk_mul_f32 v[102:103], v[102:103], v[84:85] op_sel_hi:[1,0]
v_pk_mul_f32 v[116:117], v[116:117], v[84:85] op_sel_hi:[1,0]
v_pk_mul_f32 v[118:119], v[118:119], v[84:85] op_sel_hi:[1,0]
v_cvt_pk_bf16_f32 v172, v100, v101
v_cvt_pk_bf16_f32 v173, v102, v103
v_cvt_pk_bf16_f32 v174, v116, v117
v_cvt_pk_bf16_f32 v175, v118, v119
buffer_store_dwordx4 v[172:175], v4, s[16:19], s74 offen offset:2048 sc1
v_permlane32_swap_b32 v80, v81
v_cvt_pk_bf16_f32 v165, v62, v63
v_max_f32 v80, v80, v81
v_mul_f32 v80, v80, v226
v_pk_fma_f32 v[96:97], v[96:97], v[226:227], v[80:81] op_sel_hi:[1,0,0] neg_lo:[0,0,1] neg_hi:[0,0,1]
v_pk_fma_f32 v[98:99], v[98:99], v[226:227], v[80:81] op_sel_hi:[1,0,0] neg_lo:[0,0,1] neg_hi:[0,0,1]
v_pk_fma_f32 v[112:113], v[112:113], v[226:227], v[80:81] op_sel_hi:[1,0,0] neg_lo:[0,0,1] neg_hi:[0,0,1]
v_pk_fma_f32 v[114:115], v[114:115], v[226:227], v[80:81] op_sel_hi:[1,0,0] neg_lo:[0,0,1] neg_hi:[0,0,1]
v_exp_f32 v96, v96
v_exp_f32 v97, v97
v_exp_f32 v98, v98
v_exp_f32 v99, v99
v_exp_f32 v112, v112
v_exp_f32 v113, v113
v_exp_f32 v114, v114
v_exp_f32 v115, v115
v_cvt_pk_bf16_f32 v64, v96, v97
v_cvt_pk_bf16_f32 v65, v98, v99
v_cvt_pk_bf16_f32 v66, v112, v113
v_cvt_pk_bf16_f32 v67, v114, v115
v_cvt_pk_bf16_f32 v166, v76, v77
v_cvt_pk_bf16_f32 v167, v78, v79
v_mfma_f32_16x16x32_bf16 v[80:83], v[248:251], v[64:67], 0
v_mfma_f32_16x16x32_bf16 v[96:99], v[202:205], v[64:67], 0
v_mfma_f32_16x16x32_bf16 v[112:115], v[212:215], v[64:67], 0
s_nop 5
v_rcp_f32 v80, v80
v_mfma_f32_16x16x32_bf16 v[92:95], v[180:183], v[164:167], v[46:49]
v_mfma_f32_16x16x32_bf16 v[108:111], v[184:187], v[164:167], v[50:53]
s_nop 6
v_max3_f32 v76, v92, v93, v94
v_pk_mul_f32 v[96:97], v[96:97], v[80:81] op_sel_hi:[1,0]
v_pk_mul_f32 v[98:99], v[98:99], v[80:81] op_sel_hi:[1,0]
v_pk_mul_f32 v[112:113], v[112:113], v[80:81] op_sel_hi:[1,0]
v_pk_mul_f32 v[114:115], v[114:115], v[80:81] op_sel_hi:[1,0]
v_cvt_pk_bf16_f32 v168, v96, v97
v_cvt_pk_bf16_f32 v169, v98, v99
v_cvt_pk_bf16_f32 v170, v112, v113
v_cvt_pk_bf16_f32 v171, v114, v115
buffer_store_dwordx4 v[168:171], v4, s[16:19], s74 offen offset:1024 sc1
v_max3_f32 v77, v95, v108, v109
v_max3_f32 v76, v76, v110, v111
v_max_f32 v78, v76, v77
v_max_f32 v77, v76, v77
s_nop 1
v_permlane16_swap_b32 v78, v77
v_max_f32 v76, v78, v77
v_max_f32 v77, v78, v77
s_nop 1
v_permlane32_swap_b32 v76, v77
v_max_f32 v76, v76, v77
v_mul_f32 v76, v76, v222
v_pk_fma_f32 v[92:93], v[92:93], v[222:223], v[76:77] op_sel_hi:[1,0,0] neg_lo:[0,0,1] neg_hi:[0,0,1]
v_pk_fma_f32 v[94:95], v[94:95], v[222:223], v[76:77] op_sel_hi:[1,0,0] neg_lo:[0,0,1] neg_hi:[0,0,1]
v_pk_fma_f32 v[108:109], v[108:109], v[222:223], v[76:77] op_sel_hi:[1,0,0] neg_lo:[0,0,1] neg_hi:[0,0,1]
v_pk_fma_f32 v[110:111], v[110:111], v[222:223], v[76:77] op_sel_hi:[1,0,0] neg_lo:[0,0,1] neg_hi:[0,0,1]
v_exp_f32 v92, v92
v_exp_f32 v93, v93
v_exp_f32 v94, v94
v_exp_f32 v95, v95
v_exp_f32 v108, v108
v_exp_f32 v109, v109
v_exp_f32 v110, v110
v_exp_f32 v111, v111
v_cvt_pk_bf16_f32 v60, v92, v93
v_cvt_pk_bf16_f32 v61, v94, v95
v_cvt_pk_bf16_f32 v62, v108, v109
v_cvt_pk_bf16_f32 v63, v110, v111
s_nop 1
v_mfma_f32_16x16x32_bf16 v[76:79], v[248:251], v[60:63], 0
v_mfma_f32_16x16x32_bf16 v[92:95], v[200:203], v[60:63], 0
v_mfma_f32_16x16x32_bf16 v[108:111], v[210:213], v[60:63], 0
s_nop 5
v_rcp_f32 v76, v76
s_nop 0
v_pk_mul_f32 v[92:93], v[92:93], v[76:77] op_sel_hi:[1,0]
v_pk_mul_f32 v[94:95], v[94:95], v[76:77] op_sel_hi:[1,0]
v_pk_mul_f32 v[108:109], v[108:109], v[76:77] op_sel_hi:[1,0]
v_pk_mul_f32 v[110:111], v[110:111], v[76:77] op_sel_hi:[1,0]
v_cvt_pk_bf16_f32 v164, v92, v93
v_cvt_pk_bf16_f32 v165, v94, v95
v_cvt_pk_bf16_f32 v166, v108, v109
v_cvt_pk_bf16_f32 v167, v110, v111
buffer_store_dwordx4 v[164:167], v4, s[16:19], s74 offen sc1
s_nop 1
.Lqkve11:
.Lpad8:
s_cbranch_execz .Lnopoll8r
s_lshl_b32 s62, s6, 13
s_lshl_b32 s63, s3, 11
s_add_u32 s62, s62, s63
v_lshl_add_u32 v4, v1, 4, s62
v_lshrrev_b32 v2, 3, v1
v_cmp_eq_u32 vcc, 3, v2
v_add_u32 v2, 67108480, v4
s_nop 0
v_cndmask_b32 v4, v4, v2, vcc
v_bfe_u32 v5, v1, 3, 1
v_lshrrev_b32 v2, 4, v1
v_lshl_add_u32 v5, v2, 3, v5
s_lshl_b32 s62, s3, 1
v_add_u32 v5, s62, v5
v_mul_u32_u24 v5, 2048, v5
v_and_b32 v2, 7, v1
v_lshl_add_u32 v5, v2, 4, v5
s_lshl_b32 s62, s7, 7
v_add_u32 v5, s62, v5
v_add_u32 v6, 64512, v5
v_bfe_u32 v8, v1, 3, 2
v_mul_u32_u24 v8, 2080, v8
v_bfe_u32 v2, v1, 2, 1
v_lshl_add_u32 v8, v2, 7, v8
v_bfe_u32 v2, v1, 5, 1
v_lshl_add_u32 v8, v2, 8, v8
v_and_b32 v2, 3, v1
v_lshl_add_u32 v8, v2, 3, v8
s_mov_b32 s57, 66560
v_add_u32 v7, s57, v8
s_mov_b32 s52, 4194304
s_mov_b32 s53, 4325376
s_mov_b32 s54, 2097152
s_mul_i32 s56, s3, 2080
v_accvgpr_read_b32 v32, a224
v_accvgpr_read_b32 v33, a225
v_accvgpr_read_b32 v34, a226
v_accvgpr_read_b32 v35, a227
v_accvgpr_read_b32 v36, a228
v_accvgpr_read_b32 v37, a229
v_accvgpr_read_b32 v38, a230
v_accvgpr_read_b32 v39, a231
v_accvgpr_read_b32 v40, a232
v_accvgpr_read_b32 v41, a233
v_accvgpr_read_b32 v42, a234
v_accvgpr_read_b32 v43, a235
v_accvgpr_read_b32 v44, a236
v_accvgpr_read_b32 v45, a237
v_accvgpr_read_b32 v46, a238
v_accvgpr_read_b32 v47, a239
v_accvgpr_read_b32 v48, a240
v_accvgpr_read_b32 v49, a241
v_accvgpr_read_b32 v50, a242
v_accvgpr_read_b32 v51, a243
v_accvgpr_read_b32 v52, a244
v_accvgpr_read_b32 v53, a245
v_accvgpr_read_b32 v54, a246
v_accvgpr_read_b32 v55, a247
v_accvgpr_read_b32 v56, a248
v_accvgpr_read_b32 v57, a249
v_accvgpr_read_b32 v58, a250
v_accvgpr_read_b32 v59, a251
v_accvgpr_read_b32 v60, a252
v_accvgpr_read_b32 v61, a253
v_accvgpr_read_b32 v62, a254
v_accvgpr_read_b32 v63, a255
s_and_b32 s62, s3, 1
s_mul_i32 s62, s62, 28672
s_add_u32 s62, s62, s51
v_lshrrev_b32 v12, 4, v1
v_mul_u32_u24 v12, 57344, v12
v_and_b32 v2, 15, v1
v_lshl_add_u32 v12, v2, 4, v12
v_add_u32 v12, s62, v12
v_add_u32 v13, 6112, v12
v_add_u32 v14, 12224, v12
v_add_u32 v15, 18336, v12
s_mul_i32 s59, s3, 4224
s_mov_b32 s58, 0
s_lshl_b32 s62, s8, 7
s_add_u32 s62, s62, 30410752
s_lshl_b32 s64, s6, 7
s_add_u32 s64, s64, 30410752
v_mov_b32 v252, s62
v_mov_b32 v253, s64
s_waitcnt vmcnt(0) lgkmcnt(0)
s_barrier
s_cmp_lg_u32 s3, 0
s_cbranch_scc1 .Lnosig20
v_mov_b32 v255, 1
s_mov_b64 exec, 1
buffer_atomic_add v255, v252, s[16:19], 0 offen
s_mov_b64 exec, -1
.Lnosig20:
s_cmp_lg_u32 s3, 1
s_cbranch_scc1 .Lnopoll23
s_mov_b64 exec, 1
s_mov_b32 s15, 0
s_mov_b64 exec, 1
v_mov_b32 v254, 0
buffer_atomic_add v254, v253, s[16:19], 0 offen sc0
.Lpoll21:
s_waitcnt vmcnt(0)
v_cmp_ne_u32 vcc, 16, v254
s_add_u32 s15, s15, 1
s_cbranch_vccz .Lnopoll23r
s_sleep 2
s_mov_b64 exec, 1
v_mov_b32 v254, 0
buffer_atomic_add v254, v253, s[16:19], 0 offen sc0
s_cmp_le_u32 s15, 100000
s_cbranch_scc1 .Lpoll21
.Lgot22:
s_waitcnt vmcnt(0)
s_branch .Lnopoll23r
.Lnopoll23:
s_mov_b64 exec, 0
s_cmp_eq_u32 s3, 2
s_cbranch_scc1 .Lpad9
s_cmp_eq_u32 s3, 3
s_cbranch_scc1 .Lpad10
s_branch .Lnopoll23r
.Lnopoll23r:
s_mov_b64 exec, -1
s_barrier
buffer_load_dwordx4 v[64:67], v4, s[16:19], s52 offen sc1
buffer_load_dwordx4 v[68:71], v4, s[16:19], s52 offen offset:1024 sc1
s_add_u32 s52, s52, 0x40000
buffer_load_dwordx4 v[72:75], v4, s[16:19], s53 offen sc1
buffer_load_dwordx4 v[76:79], v4, s[16:19], s53 offen offset:1024 sc1
s_add_u32 s53, s53, 0x40000
buffer_load_dwordx4 v[80:83], v4, s[16:19], s52 offen sc1
buffer_load_dwordx4 v[84:87], v4, s[16:19], s52 offen offset:1024 sc1
s_add_u32 s52, s52, 0x40000
buffer_load_dwordx4 v[88:91], v4, s[16:19], s53 offen sc1
buffer_load_dwordx4 v[92:95], v4, s[16:19], s53 offen offset:1024 sc1
s_add_u32 s53, s53, 0x40000
buffer_load_dwordx4 v[96:99], v4, s[16:19], s52 offen sc1
buffer_load_dwordx4 v[100:103], v4, s[16:19], s52 offen offset:1024 sc1
s_add_u32 s52, s52, 0x40000
buffer_load_dwordx4 v[104:107], v4, s[16:19], s53 offen sc1
buffer_load_dwordx4 v[108:111], v4, s[16:19], s53 offen offset:1024 sc1
s_add_u32 s53, s53, 0x40000
ds_read_b64_tr_b16 a[0:1], v7
ds_read_b64_tr_b16 a[2:3], v7 offset:512
ds_read_b64_tr_b16 a[4:5], v7 offset:32
ds_read_b64_tr_b16 a[6:7], v7 offset:544
ds_read_b64_tr_b16 a[8:9], v7 offset:64
ds_read_b64_tr_b16 a[10:11], v7 offset:576
ds_read_b64_tr_b16 a[12:13], v7 offset:96
ds_read_b64_tr_b16 a[14:15], v7 offset:608
ds_read_b64_tr_b16 a[16:17], v7 offset:1024
ds_read_b64_tr_b16 a[18:19], v7 offset:1536
ds_read_b64_tr_b16 a[20:21], v7 offset:1056
ds_read_b64_tr_b16 a[22:23], v7 offset:1568
ds_read_b64_tr_b16 a[24:25], v7 offset:1088
ds_read_b64_tr_b16 a[26:27], v7 offset:1600
ds_read_b64_tr_b16 a[28:29], v7 offset:1120
ds_read_b64_tr_b16 a[30:31], v7 offset:1632
s_waitcnt vmcnt(11) lgkmcnt(14)
v_mfma_f32_16x16x32_bf16 v[32:35], a[0:3], v[64:67], v[32:35]
ds_read_b64_tr_b16 a[32:33], v7 offset:8320
ds_read_b64_tr_b16 a[34:35], v7 offset:8832
s_waitcnt vmcnt(10)
v_mfma_f32_16x16x32_bf16 v[48:51], a[0:3], v[68:71], v[48:51]
buffer_load_dwordx4 v[112:115], v4, s[16:19], s52 offen sc1
s_waitcnt lgkmcnt(14)
v_mfma_f32_16x16x32_bf16 v[36:39], a[4:7], v[64:67], v[36:39]
ds_read_b64_tr_b16 a[36:37], v7 offset:8352
ds_read_b64_tr_b16 a[38:39], v7 offset:8864
v_mfma_f32_16x16x32_bf16 v[52:55], a[4:7], v[68:71], v[52:55]
ds_read_b64_tr_b16 a[40:41], v7 offset:8384
ds_read_b64_tr_b16 a[42:43], v7 offset:8896
s_waitcnt lgkmcnt(15)
v_mfma_f32_16x16x32_bf16 v[40:43], a[8:11], v[64:67], v[40:43]
buffer_load_dwordx4 v[116:119], v4, s[16:19], s52 offen offset:1024 sc1
v_mfma_f32_16x16x32_bf16 v[56:59], a[8:11], v[68:71], v[56:59]
ds_read_b64_tr_b16 a[44:45], v7 offset:8416
s_add_u32 s52, s52, 0x40000
s_waitcnt lgkmcnt(15)
v_mfma_f32_16x16x32_bf16 v[44:47], a[12:15], v[64:67], v[44:47]
ds_read_b64_tr_b16 a[46:47], v7 offset:8928
v_mfma_f32_16x16x32_bf16 v[60:63], a[12:15], v[68:71], v[60:63]
ds_read_b64_tr_b16 a[48:49], v7 offset:9344
ds_read_b64_tr_b16 a[50:51], v7 offset:9856
s_waitcnt vmcnt(11) lgkmcnt(15)
v_mfma_f32_16x16x32_bf16 v[32:35], a[16:19], v[72:75], v[32:35]
buffer_load_dwordx4 v[120:123], v4, s[16:19], s53 offen sc1
s_waitcnt vmcnt(11)
v_mfma_f32_16x16x32_bf16 v[48:51], a[16:19], v[76:79], v[48:51]
ds_read_b64_tr_b16 a[52:53], v7 offset:9376
ds_read_b64_tr_b16 a[54:55], v7 offset:9888
s_waitcnt lgkmcnt(15)
v_mfma_f32_16x16x32_bf16 v[36:39], a[20:23], v[72:75], v[36:39]
ds_read_b64_tr_b16 a[56:57], v7 offset:9408
ds_read_b64_tr_b16 a[58:59], v7 offset:9920
v_mfma_f32_16x16x32_bf16 v[52:55], a[20:23], v[76:79], v[52:55]
buffer_load_dwordx4 v[124:127], v4, s[16:19], s53 offen offset:1024 sc1
s_waitcnt lgkmcnt(15)
v_mfma_f32_16x16x32_bf16 v[40:43], a[24:27], v[72:75], v[40:43]
ds_read_b64_tr_b16 a[60:61], v7 offset:9440
s_add_u32 s53, s53, 0x40000
v_mfma_f32_16x16x32_bf16 v[56:59], a[24:27], v[76:79], v[56:59]
ds_read_b64_tr_b16 a[62:63], v7 offset:9952
s_waitcnt lgkmcnt(15)
v_mfma_f32_16x16x32_bf16 v[44:47], a[28:31], v[72:75], v[44:47]
v_mfma_f32_16x16x32_bf16 v[60:63], a[28:31], v[76:79], v[60:63]
s_waitcnt vmcnt(11) lgkmcnt(14)
v_mfma_f32_16x16x32_bf16 v[32:35], a[32:35], v[80:83], v[32:35]
ds_read_b64_tr_b16 a[0:1], v7 offset:16640
ds_read_b64_tr_b16 a[2:3], v7 offset:17152
s_waitcnt vmcnt(10)
v_mfma_f32_16x16x32_bf16 v[48:51], a[32:35], v[84:87], v[48:51]
buffer_load_dwordx4 v[64:67], v4, s[16:19], s52 offen sc1
s_waitcnt lgkmcnt(14)
v_mfma_f32_16x16x32_bf16 v[36:39], a[36:39], v[80:83], v[36:39]
ds_read_b64_tr_b16 a[4:5], v7 offset:16672
ds_read_b64_tr_b16 a[6:7], v7 offset:17184
v_mfma_f32_16x16x32_bf16 v[52:55], a[36:39], v[84:87], v[52:55]
ds_read_b64_tr_b16 a[8:9], v7 offset:16704
ds_read_b64_tr_b16 a[10:11], v7 offset:17216
s_waitcnt lgkmcnt(15)
v_mfma_f32_16x16x32_bf16 v[40:43], a[40:43], v[80:83], v[40:43]
buffer_load_dwordx4 v[68:71], v4, s[16:19], s52 offen offset:1024 sc1
v_mfma_f32_16x16x32_bf16 v[56:59], a[40:43], v[84:87], v[56:59]
ds_read_b64_tr_b16 a[12:13], v7 offset:16736
s_add_u32 s52, s52, 0x40000
s_waitcnt lgkmcnt(15)
v_mfma_f32_16x16x32_bf16 v[44:47], a[44:47], v[80:83], v[44:47]
ds_read_b64_tr_b16 a[14:15], v7 offset:17248
v_mfma_f32_16x16x32_bf16 v[60:63], a[44:47], v[84:87], v[60:63]
ds_read_b64_tr_b16 a[16:17], v7 offset:17664
ds_read_b64_tr_b16 a[18:19], v7 offset:18176
s_waitcnt vmcnt(11) lgkmcnt(15)
v_mfma_f32_16x16x32_bf16 v[32:35], a[48:51], v[88:91], v[32:35]
buffer_load_dwordx4 v[72:75], v4, s[16:19], s53 offen sc1
s_waitcnt vmcnt(11)
v_mfma_f32_16x16x32_bf16 v[48:51], a[48:51], v[92:95], v[48:51]
ds_read_b64_tr_b16 a[20:21], v7 offset:17696
ds_read_b64_tr_b16 a[22:23], v7 offset:18208
s_waitcnt lgkmcnt(15)
v_mfma_f32_16x16x32_bf16 v[36:39], a[52:55], v[88:91], v[36:39]
ds_read_b64_tr_b16 a[24:25], v7 offset:17728
ds_read_b64_tr_b16 a[26:27], v7 offset:18240
v_mfma_f32_16x16x32_bf16 v[52:55], a[52:55], v[92:95], v[52:55]
buffer_load_dwordx4 v[76:79], v4, s[16:19], s53 offen offset:1024 sc1
s_waitcnt lgkmcnt(15)
v_mfma_f32_16x16x32_bf16 v[40:43], a[56:59], v[88:91], v[40:43]
ds_read_b64_tr_b16 a[28:29], v7 offset:17760
s_add_u32 s53, s53, 0x40000
v_mfma_f32_16x16x32_bf16 v[56:59], a[56:59], v[92:95], v[56:59]
ds_read_b64_tr_b16 a[30:31], v7 offset:18272
s_waitcnt lgkmcnt(15)
v_mfma_f32_16x16x32_bf16 v[44:47], a[60:63], v[88:91], v[44:47]
v_mfma_f32_16x16x32_bf16 v[60:63], a[60:63], v[92:95], v[60:63]
s_waitcnt vmcnt(11) lgkmcnt(14)
v_mfma_f32_16x16x32_bf16 v[32:35], a[0:3], v[96:99], v[32:35]
ds_read_b64_tr_b16 a[32:33], v7 offset:24960
ds_read_b64_tr_b16 a[34:35], v7 offset:25472
s_waitcnt vmcnt(10)
v_mfma_f32_16x16x32_bf16 v[48:51], a[0:3], v[100:103], v[48:51]
buffer_load_dwordx4 v[80:83], v4, s[16:19], s52 offen sc1
s_waitcnt lgkmcnt(14)
v_mfma_f32_16x16x32_bf16 v[36:39], a[4:7], v[96:99], v[36:39]
ds_read_b64_tr_b16 a[36:37], v7 offset:24992
ds_read_b64_tr_b16 a[38:39], v7 offset:25504
v_mfma_f32_16x16x32_bf16 v[52:55], a[4:7], v[100:103], v[52:55]
ds_read_b64_tr_b16 a[40:41], v7 offset:25024
ds_read_b64_tr_b16 a[42:43], v7 offset:25536
s_waitcnt lgkmcnt(15)
v_mfma_f32_16x16x32_bf16 v[40:43], a[8:11], v[96:99], v[40:43]
buffer_load_dwordx4 v[84:87], v4, s[16:19], s52 offen offset:1024 sc1
v_mfma_f32_16x16x32_bf16 v[56:59], a[8:11], v[100:103], v[56:59]
ds_read_b64_tr_b16 a[44:45], v7 offset:25056
s_add_u32 s52, s52, 0x40000
s_waitcnt lgkmcnt(15)
v_mfma_f32_16x16x32_bf16 v[44:47], a[12:15], v[96:99], v[44:47]
ds_read_b64_tr_b16 a[46:47], v7 offset:25568
v_mfma_f32_16x16x32_bf16 v[60:63], a[12:15], v[100:103], v[60:63]
ds_read_b64_tr_b16 a[48:49], v7 offset:25984
ds_read_b64_tr_b16 a[50:51], v7 offset:26496
s_waitcnt vmcnt(11) lgkmcnt(15)
v_mfma_f32_16x16x32_bf16 v[32:35], a[16:19], v[104:107], v[32:35]
buffer_load_dwordx4 v[88:91], v4, s[16:19], s53 offen sc1
s_waitcnt vmcnt(11)
v_mfma_f32_16x16x32_bf16 v[48:51], a[16:19], v[108:111], v[48:51]
.Lpad9:
s_cbranch_execz .Lnopoll23r
ds_read_b64_tr_b16 a[52:53], v7 offset:26016
ds_read_b64_tr_b16 a[54:55], v7 offset:26528
s_waitcnt lgkmcnt(15)
v_mfma_f32_16x16x32_bf16 v[36:39], a[20:23], v[104:107], v[36:39]
ds_read_b64_tr_b16 a[56:57], v7 offset:26048
ds_read_b64_tr_b16 a[58:59], v7 offset:26560
v_mfma_f32_16x16x32_bf16 v[52:55], a[20:23], v[108:111], v[52:55]
buffer_load_dwordx4 v[92:95], v4, s[16:19], s53 offen offset:1024 sc1
s_waitcnt lgkmcnt(15)
v_mfma_f32_16x16x32_bf16 v[40:43], a[24:27], v[104:107], v[40:43]
ds_read_b64_tr_b16 a[60:61], v7 offset:26080
s_add_u32 s53, s53, 0x40000
v_mfma_f32_16x16x32_bf16 v[56:59], a[24:27], v[108:111], v[56:59]
ds_read_b64_tr_b16 a[62:63], v7 offset:26592
s_waitcnt lgkmcnt(15)
v_mfma_f32_16x16x32_bf16 v[44:47], a[28:31], v[104:107], v[44:47]
v_mfma_f32_16x16x32_bf16 v[60:63], a[28:31], v[108:111], v[60:63]
s_waitcnt vmcnt(11) lgkmcnt(14)
v_mfma_f32_16x16x32_bf16 v[32:35], a[32:35], v[112:115], v[32:35]
ds_read_b64_tr_b16 a[0:1], v7 offset:33280
ds_read_b64_tr_b16 a[2:3], v7 offset:33792
s_waitcnt vmcnt(10)
v_mfma_f32_16x16x32_bf16 v[48:51], a[32:35], v[116:119], v[48:51]
buffer_load_dwordx4 v[96:99], v4, s[16:19], s52 offen sc1
s_waitcnt lgkmcnt(14)
v_mfma_f32_16x16x32_bf16 v[36:39], a[36:39], v[112:115], v[36:39]
ds_read_b64_tr_b16 a[4:5], v7 offset:33312
ds_read_b64_tr_b16 a[6:7], v7 offset:33824
v_mfma_f32_16x16x32_bf16 v[52:55], a[36:39], v[116:119], v[52:55]
ds_read_b64_tr_b16 a[8:9], v7 offset:33344
ds_read_b64_tr_b16 a[10:11], v7 offset:33856
s_waitcnt lgkmcnt(15)
v_mfma_f32_16x16x32_bf16 v[40:43], a[40:43], v[112:115], v[40:43]
buffer_load_dwordx4 v[100:103], v4, s[16:19], s52 offen offset:1024 sc1
v_mfma_f32_16x16x32_bf16 v[56:59], a[40:43], v[116:119], v[56:59]
ds_read_b64_tr_b16 a[12:13], v7 offset:33376
s_add_u32 s52, s52, 0x40000
s_waitcnt lgkmcnt(15)
v_mfma_f32_16x16x32_bf16 v[44:47], a[44:47], v[112:115], v[44:47]
ds_read_b64_tr_b16 a[14:15], v7 offset:33888
v_mfma_f32_16x16x32_bf16 v[60:63], a[44:47], v[116:119], v[60:63]
ds_read_b64_tr_b16 a[16:17], v7 offset:34304
ds_read_b64_tr_b16 a[18:19], v7 offset:34816
s_waitcnt vmcnt(11) lgkmcnt(15)
v_mfma_f32_16x16x32_bf16 v[32:35], a[48:51], v[120:123], v[32:35]
buffer_load_dwordx4 v[104:107], v4, s[16:19], s53 offen sc1
s_waitcnt vmcnt(11)
v_mfma_f32_16x16x32_bf16 v[48:51], a[48:51], v[124:127], v[48:51]
ds_read_b64_tr_b16 a[20:21], v7 offset:34336
ds_read_b64_tr_b16 a[22:23], v7 offset:34848
s_waitcnt lgkmcnt(15)
v_mfma_f32_16x16x32_bf16 v[36:39], a[52:55], v[120:123], v[36:39]
ds_read_b64_tr_b16 a[24:25], v7 offset:34368
ds_read_b64_tr_b16 a[26:27], v7 offset:34880
v_mfma_f32_16x16x32_bf16 v[52:55], a[52:55], v[124:127], v[52:55]
buffer_load_dwordx4 v[108:111], v4, s[16:19], s53 offen offset:1024 sc1
s_waitcnt lgkmcnt(15)
v_mfma_f32_16x16x32_bf16 v[40:43], a[56:59], v[120:123], v[40:43]
ds_read_b64_tr_b16 a[28:29], v7 offset:34400
s_add_u32 s53, s53, 0x40000
v_mfma_f32_16x16x32_bf16 v[56:59], a[56:59], v[124:127], v[56:59]
ds_read_b64_tr_b16 a[30:31], v7 offset:34912
s_waitcnt lgkmcnt(15)
v_mfma_f32_16x16x32_bf16 v[44:47], a[60:63], v[120:123], v[44:47]
v_mfma_f32_16x16x32_bf16 v[60:63], a[60:63], v[124:127], v[60:63]
s_waitcnt vmcnt(11) lgkmcnt(14)
v_mfma_f32_16x16x32_bf16 v[32:35], a[0:3], v[64:67], v[32:35]
ds_read_b64_tr_b16 a[32:33], v7 offset:41600
ds_read_b64_tr_b16 a[34:35], v7 offset:42112
s_waitcnt vmcnt(10)
v_mfma_f32_16x16x32_bf16 v[48:51], a[0:3], v[68:71], v[48:51]
buffer_load_dwordx4 v[112:115], v4, s[16:19], s52 offen sc1
s_waitcnt lgkmcnt(14)
v_mfma_f32_16x16x32_bf16 v[36:39], a[4:7], v[64:67], v[36:39]
ds_read_b64_tr_b16 a[36:37], v7 offset:41632
ds_read_b64_tr_b16 a[38:39], v7 offset:42144
v_mfma_f32_16x16x32_bf16 v[52:55], a[4:7], v[68:71], v[52:55]
ds_read_b64_tr_b16 a[40:41], v7 offset:41664
ds_read_b64_tr_b16 a[42:43], v7 offset:42176
s_waitcnt lgkmcnt(15)
v_mfma_f32_16x16x32_bf16 v[40:43], a[8:11], v[64:67], v[40:43]
buffer_load_dwordx4 v[116:119], v4, s[16:19], s52 offen offset:1024 sc1
v_mfma_f32_16x16x32_bf16 v[56:59], a[8:11], v[68:71], v[56:59]
ds_read_b64_tr_b16 a[44:45], v7 offset:41696
s_add_u32 s52, s52, 0x40000
s_waitcnt lgkmcnt(15)
v_mfma_f32_16x16x32_bf16 v[44:47], a[12:15], v[64:67], v[44:47]
ds_read_b64_tr_b16 a[46:47], v7 offset:42208
v_mfma_f32_16x16x32_bf16 v[60:63], a[12:15], v[68:71], v[60:63]
ds_read_b64_tr_b16 a[48:49], v7 offset:42624
ds_read_b64_tr_b16 a[50:51], v7 offset:43136
s_waitcnt vmcnt(11) lgkmcnt(15)
v_mfma_f32_16x16x32_bf16 v[32:35], a[16:19], v[72:75], v[32:35]
buffer_load_dwordx4 v[120:123], v4, s[16:19], s53 offen sc1
s_waitcnt vmcnt(11)
v_mfma_f32_16x16x32_bf16 v[48:51], a[16:19], v[76:79], v[48:51]
ds_read_b64_tr_b16 a[52:53], v7 offset:42656
ds_read_b64_tr_b16 a[54:55], v7 offset:43168
s_waitcnt lgkmcnt(15)
v_mfma_f32_16x16x32_bf16 v[36:39], a[20:23], v[72:75], v[36:39]
ds_read_b64_tr_b16 a[56:57], v7 offset:42688
ds_read_b64_tr_b16 a[58:59], v7 offset:43200
v_mfma_f32_16x16x32_bf16 v[52:55], a[20:23], v[76:79], v[52:55]
buffer_load_dwordx4 v[124:127], v4, s[16:19], s53 offen offset:1024 sc1
s_waitcnt lgkmcnt(15)
v_mfma_f32_16x16x32_bf16 v[40:43], a[24:27], v[72:75], v[40:43]
ds_read_b64_tr_b16 a[60:61], v7 offset:42720
s_add_u32 s53, s53, 0x40000
v_mfma_f32_16x16x32_bf16 v[56:59], a[24:27], v[76:79], v[56:59]
ds_read_b64_tr_b16 a[62:63], v7 offset:43232
s_waitcnt lgkmcnt(15)
v_mfma_f32_16x16x32_bf16 v[44:47], a[28:31], v[72:75], v[44:47]
v_mfma_f32_16x16x32_bf16 v[60:63], a[28:31], v[76:79], v[60:63]
s_waitcnt vmcnt(11) lgkmcnt(14)
v_mfma_f32_16x16x32_bf16 v[32:35], a[32:35], v[80:83], v[32:35]
ds_read_b64_tr_b16 a[0:1], v7 offset:49920
ds_read_b64_tr_b16 a[2:3], v7 offset:50432
s_waitcnt vmcnt(10)
v_mfma_f32_16x16x32_bf16 v[48:51], a[32:35], v[84:87], v[48:51]
buffer_load_dwordx4 v[64:67], v4, s[16:19], s52 offen sc1
s_waitcnt lgkmcnt(14)
v_mfma_f32_16x16x32_bf16 v[36:39], a[36:39], v[80:83], v[36:39]
ds_read_b64_tr_b16 a[4:5], v7 offset:49952
ds_read_b64_tr_b16 a[6:7], v7 offset:50464
v_mfma_f32_16x16x32_bf16 v[52:55], a[36:39], v[84:87], v[52:55]
ds_read_b64_tr_b16 a[8:9], v7 offset:49984
ds_read_b64_tr_b16 a[10:11], v7 offset:50496
s_waitcnt lgkmcnt(15)
v_mfma_f32_16x16x32_bf16 v[40:43], a[40:43], v[80:83], v[40:43]
buffer_load_dwordx4 v[68:71], v4, s[16:19], s52 offen offset:1024 sc1
v_mfma_f32_16x16x32_bf16 v[56:59], a[40:43], v[84:87], v[56:59]
ds_read_b64_tr_b16 a[12:13], v7 offset:50016
s_add_u32 s52, s52, 0x40000
s_waitcnt lgkmcnt(15)
v_mfma_f32_16x16x32_bf16 v[44:47], a[44:47], v[80:83], v[44:47]
ds_read_b64_tr_b16 a[14:15], v7 offset:50528
v_mfma_f32_16x16x32_bf16 v[60:63], a[44:47], v[84:87], v[60:63]
ds_read_b64_tr_b16 a[16:17], v7 offset:50944
ds_read_b64_tr_b16 a[18:19], v7 offset:51456
s_waitcnt vmcnt(11) lgkmcnt(15)
v_mfma_f32_16x16x32_bf16 v[32:35], a[48:51], v[88:91], v[32:35]
buffer_load_dwordx4 v[72:75], v4, s[16:19], s53 offen sc1
s_waitcnt vmcnt(11)
v_mfma_f32_16x16x32_bf16 v[48:51], a[48:51], v[92:95], v[48:51]
ds_read_b64_tr_b16 a[20:21], v7 offset:50976
ds_read_b64_tr_b16 a[22:23], v7 offset:51488
s_waitcnt lgkmcnt(15)
v_mfma_f32_16x16x32_bf16 v[36:39], a[52:55], v[88:91], v[36:39]
ds_read_b64_tr_b16 a[24:25], v7 offset:51008
ds_read_b64_tr_b16 a[26:27], v7 offset:51520
v_mfma_f32_16x16x32_bf16 v[52:55], a[52:55], v[92:95], v[52:55]
buffer_load_dwordx4 v[76:79], v4, s[16:19], s53 offen offset:1024 sc1
s_waitcnt lgkmcnt(15)
v_mfma_f32_16x16x32_bf16 v[40:43], a[56:59], v[88:91], v[40:43]
ds_read_b64_tr_b16 a[28:29], v7 offset:51040
s_add_u32 s53, s53, 0x40000
v_mfma_f32_16x16x32_bf16 v[56:59], a[56:59], v[92:95], v[56:59]
ds_read_b64_tr_b16 a[30:31], v7 offset:51552
s_waitcnt lgkmcnt(15)
v_mfma_f32_16x16x32_bf16 v[44:47], a[60:63], v[88:91], v[44:47]
v_mfma_f32_16x16x32_bf16 v[60:63], a[60:63], v[92:95], v[60:63]
s_waitcnt vmcnt(11) lgkmcnt(14)
v_mfma_f32_16x16x32_bf16 v[32:35], a[0:3], v[96:99], v[32:35]
ds_read_b64_tr_b16 a[32:33], v7 offset:58240
ds_read_b64_tr_b16 a[34:35], v7 offset:58752
s_waitcnt vmcnt(10)
v_mfma_f32_16x16x32_bf16 v[48:51], a[0:3], v[100:103], v[48:51]
buffer_load_dwordx4 v[80:83], v4, s[16:19], s52 offen sc1
s_waitcnt lgkmcnt(14)
v_mfma_f32_16x16x32_bf16 v[36:39], a[4:7], v[96:99], v[36:39]
ds_read_b64_tr_b16 a[36:37], v7 offset:58272
ds_read_b64_tr_b16 a[38:39], v7 offset:58784
v_mfma_f32_16x16x32_bf16 v[52:55], a[4:7], v[100:103], v[52:55]
ds_read_b64_tr_b16 a[40:41], v7 offset:58304
ds_read_b64_tr_b16 a[42:43], v7 offset:58816
s_waitcnt lgkmcnt(15)
v_mfma_f32_16x16x32_bf16 v[40:43], a[8:11], v[96:99], v[40:43]
buffer_load_dwordx4 v[84:87], v4, s[16:19], s52 offen offset:1024 sc1
v_mfma_f32_16x16x32_bf16 v[56:59], a[8:11], v[100:103], v[56:59]
ds_read_b64_tr_b16 a[44:45], v7 offset:58336
s_add_u32 s52, s52, 0x40000
s_waitcnt lgkmcnt(15)
v_mfma_f32_16x16x32_bf16 v[44:47], a[12:15], v[96:99], v[44:47]
ds_read_b64_tr_b16 a[46:47], v7 offset:58848
v_mfma_f32_16x16x32_bf16 v[60:63], a[12:15], v[100:103], v[60:63]
ds_read_b64_tr_b16 a[48:49], v7 offset:59264
ds_read_b64_tr_b16 a[50:51], v7 offset:59776
s_waitcnt vmcnt(11) lgkmcnt(15)
v_mfma_f32_16x16x32_bf16 v[32:35], a[16:19], v[104:107], v[32:35]
buffer_load_dwordx4 v[88:91], v4, s[16:19], s53 offen sc1
s_waitcnt vmcnt(11)
v_mfma_f32_16x16x32_bf16 v[48:51], a[16:19], v[108:111], v[48:51]
ds_read_b64_tr_b16 a[52:53], v7 offset:59296
ds_read_b64_tr_b16 a[54:55], v7 offset:59808
s_waitcnt lgkmcnt(15)
v_mfma_f32_16x16x32_bf16 v[36:39], a[20:23], v[104:107], v[36:39]
ds_read_b64_tr_b16 a[56:57], v7 offset:59328
ds_read_b64_tr_b16 a[58:59], v7 offset:59840
v_mfma_f32_16x16x32_bf16 v[52:55], a[20:23], v[108:111], v[52:55]
buffer_load_dwordx4 v[92:95], v4, s[16:19], s53 offen offset:1024 sc1
s_waitcnt lgkmcnt(15)
v_mfma_f32_16x16x32_bf16 v[40:43], a[24:27], v[104:107], v[40:43]
ds_read_b64_tr_b16 a[60:61], v7 offset:59360
s_add_u32 s53, s53, 0x40000
v_mfma_f32_16x16x32_bf16 v[56:59], a[24:27], v[108:111], v[56:59]
ds_read_b64_tr_b16 a[62:63], v7 offset:59872
s_waitcnt lgkmcnt(15)
v_mfma_f32_16x16x32_bf16 v[44:47], a[28:31], v[104:107], v[44:47]
v_mfma_f32_16x16x32_bf16 v[60:63], a[28:31], v[108:111], v[60:63]
s_xor_b32 s57, s57, 66560
v_add_u32 v7, s57, v8
s_waitcnt vmcnt(11) lgkmcnt(14)
v_mfma_f32_16x16x32_bf16 v[32:35], a[32:35], v[112:115], v[32:35]
ds_read_b64_tr_b16 a[0:1], v7
ds_read_b64_tr_b16 a[2:3], v7 offset:512
s_waitcnt vmcnt(10)
v_mfma_f32_16x16x32_bf16 v[48:51], a[32:35], v[116:119], v[48:51]
buffer_load_dwordx4 v[96:99], v4, s[16:19], s52 offen sc1
s_waitcnt lgkmcnt(14)
v_mfma_f32_16x16x32_bf16 v[36:39], a[36:39], v[112:115], v[36:39]
ds_read_b64_tr_b16 a[4:5], v7 offset:32
ds_read_b64_tr_b16 a[6:7], v7 offset:544
v_mfma_f32_16x16x32_bf16 v[52:55], a[36:39], v[116:119], v[52:55]
ds_read_b64_tr_b16 a[8:9], v7 offset:64
ds_read_b64_tr_b16 a[10:11], v7 offset:576
s_waitcnt lgkmcnt(15)
v_mfma_f32_16x16x32_bf16 v[40:43], a[40:43], v[112:115], v[40:43]
buffer_load_dwordx4 v[100:103], v4, s[16:19], s52 offen offset:1024 sc1
v_mfma_f32_16x16x32_bf16 v[56:59], a[40:43], v[116:119], v[56:59]
ds_read_b64_tr_b16 a[12:13], v7 offset:96
s_add_u32 s52, s52, 0x40000
s_waitcnt lgkmcnt(15)
v_mfma_f32_16x16x32_bf16 v[44:47], a[44:47], v[112:115], v[44:47]
ds_read_b64_tr_b16 a[14:15], v7 offset:608
v_mfma_f32_16x16x32_bf16 v[60:63], a[44:47], v[116:119], v[60:63]
ds_read_b64_tr_b16 a[16:17], v7 offset:1024
ds_read_b64_tr_b16 a[18:19], v7 offset:1536
s_waitcnt vmcnt(11) lgkmcnt(15)
v_mfma_f32_16x16x32_bf16 v[32:35], a[48:51], v[120:123], v[32:35]
buffer_load_dwordx4 v[104:107], v4, s[16:19], s53 offen sc1
s_waitcnt vmcnt(11)
v_mfma_f32_16x16x32_bf16 v[48:51], a[48:51], v[124:127], v[48:51]
ds_read_b64_tr_b16 a[20:21], v7 offset:1056
ds_read_b64_tr_b16 a[22:23], v7 offset:1568
s_waitcnt lgkmcnt(15)
v_mfma_f32_16x16x32_bf16 v[36:39], a[52:55], v[120:123], v[36:39]
ds_read_b64_tr_b16 a[24:25], v7 offset:1088
ds_read_b64_tr_b16 a[26:27], v7 offset:1600
v_mfma_f32_16x16x32_bf16 v[52:55], a[52:55], v[124:127], v[52:55]
buffer_load_dwordx4 v[108:111], v4, s[16:19], s53 offen offset:1024 sc1
s_waitcnt lgkmcnt(15)
v_mfma_f32_16x16x32_bf16 v[40:43], a[56:59], v[120:123], v[40:43]
ds_read_b64_tr_b16 a[28:29], v7 offset:1120
s_add_u32 s53, s53, 0x40000
v_mfma_f32_16x16x32_bf16 v[56:59], a[56:59], v[124:127], v[56:59]
ds_read_b64_tr_b16 a[30:31], v7 offset:1632
s_waitcnt lgkmcnt(15)
v_mfma_f32_16x16x32_bf16 v[44:47], a[60:63], v[120:123], v[44:47]
v_mfma_f32_16x16x32_bf16 v[60:63], a[60:63], v[124:127], v[60:63]
s_waitcnt vmcnt(11) lgkmcnt(14)
v_mfma_f32_16x16x32_bf16 v[32:35], a[0:3], v[64:67], v[32:35]
ds_read_b64_tr_b16 a[32:33], v7 offset:8320
ds_read_b64_tr_b16 a[34:35], v7 offset:8832
s_waitcnt vmcnt(10)
v_mfma_f32_16x16x32_bf16 v[48:51], a[0:3], v[68:71], v[48:51]
buffer_load_dwordx4 v[112:115], v4, s[16:19], s52 offen sc1
s_waitcnt lgkmcnt(14)
v_mfma_f32_16x16x32_bf16 v[36:39], a[4:7], v[64:67], v[36:39]
ds_read_b64_tr_b16 a[36:37], v7 offset:8352
ds_read_b64_tr_b16 a[38:39], v7 offset:8864
v_mfma_f32_16x16x32_bf16 v[52:55], a[4:7], v[68:71], v[52:55]
ds_read_b64_tr_b16 a[40:41], v7 offset:8384
ds_read_b64_tr_b16 a[42:43], v7 offset:8896
s_waitcnt lgkmcnt(15)
v_mfma_f32_16x16x32_bf16 v[40:43], a[8:11], v[64:67], v[40:43]
buffer_load_dwordx4 v[116:119], v4, s[16:19], s52 offen offset:1024 sc1
v_mfma_f32_16x16x32_bf16 v[56:59], a[8:11], v[68:71], v[56:59]
ds_read_b64_tr_b16 a[44:45], v7 offset:8416
s_add_u32 s52, s52, 0x40000
s_waitcnt lgkmcnt(15)
v_mfma_f32_16x16x32_bf16 v[44:47], a[12:15], v[64:67], v[44:47]
ds_read_b64_tr_b16 a[46:47], v7 offset:8928
v_mfma_f32_16x16x32_bf16 v[60:63], a[12:15], v[68:71], v[60:63]
ds_read_b64_tr_b16 a[48:49], v7 offset:9344
ds_read_b64_tr_b16 a[50:51], v7 offset:9856
s_waitcnt vmcnt(11) lgkmcnt(15)
v_mfma_f32_16x16x32_bf16 v[32:35], a[16:19], v[72:75], v[32:35]
buffer_load_dwordx4 v[120:123], v4, s[16:19], s53 offen sc1
s_waitcnt vmcnt(11)
v_mfma_f32_16x16x32_bf16 v[48:51], a[16:19], v[76:79], v[48:51]
ds_read_b64_tr_b16 a[52:53], v7 offset:9376
ds_read_b64_tr_b16 a[54:55], v7 offset:9888
s_waitcnt lgkmcnt(15)
v_mfma_f32_16x16x32_bf16 v[36:39], a[20:23], v[72:75], v[36:39]
ds_read_b64_tr_b16 a[56:57], v7 offset:9408
ds_read_b64_tr_b16 a[58:59], v7 offset:9920
v_mfma_f32_16x16x32_bf16 v[52:55], a[20:23], v[76:79], v[52:55]
buffer_load_dwordx4 v[124:127], v4, s[16:19], s53 offen offset:1024 sc1
s_waitcnt lgkmcnt(15)
v_mfma_f32_16x16x32_bf16 v[40:43], a[24:27], v[72:75], v[40:43]
ds_read_b64_tr_b16 a[60:61], v7 offset:9440
s_add_u32 s53, s53, 0x40000
v_mfma_f32_16x16x32_bf16 v[56:59], a[24:27], v[76:79], v[56:59]
ds_read_b64_tr_b16 a[62:63], v7 offset:9952
s_waitcnt lgkmcnt(15)
v_mfma_f32_16x16x32_bf16 v[44:47], a[28:31], v[72:75], v[44:47]
v_mfma_f32_16x16x32_bf16 v[60:63], a[28:31], v[76:79], v[60:63]
s_waitcnt vmcnt(11) lgkmcnt(14)
v_mfma_f32_16x16x32_bf16 v[32:35], a[32:35], v[80:83], v[32:35]
ds_read_b64_tr_b16 a[0:1], v7 offset:16640
ds_read_b64_tr_b16 a[2:3], v7 offset:17152
s_waitcnt vmcnt(10)
v_mfma_f32_16x16x32_bf16 v[48:51], a[32:35], v[84:87], v[48:51]
buffer_load_dwordx4 v[64:67], v4, s[16:19], s52 offen sc1
s_waitcnt lgkmcnt(14)
v_mfma_f32_16x16x32_bf16 v[36:39], a[36:39], v[80:83], v[36:39]
ds_read_b64_tr_b16 a[4:5], v7 offset:16672
ds_read_b64_tr_b16 a[6:7], v7 offset:17184
v_mfma_f32_16x16x32_bf16 v[52:55], a[36:39], v[84:87], v[52:55]
ds_read_b64_tr_b16 a[8:9], v7 offset:16704
ds_read_b64_tr_b16 a[10:11], v7 offset:17216
s_waitcnt lgkmcnt(15)
v_mfma_f32_16x16x32_bf16 v[40:43], a[40:43], v[80:83], v[40:43]
buffer_load_dwordx4 v[68:71], v4, s[16:19], s52 offen offset:1024 sc1
v_mfma_f32_16x16x32_bf16 v[56:59], a[40:43], v[84:87], v[56:59]
ds_read_b64_tr_b16 a[12:13], v7 offset:16736
s_add_u32 s52, s52, 0x40000
s_waitcnt lgkmcnt(15)
v_mfma_f32_16x16x32_bf16 v[44:47], a[44:47], v[80:83], v[44:47]
ds_read_b64_tr_b16 a[14:15], v7 offset:17248
v_mfma_f32_16x16x32_bf16 v[60:63], a[44:47], v[84:87], v[60:63]
ds_read_b64_tr_b16 a[16:17], v7 offset:17664
ds_read_b64_tr_b16 a[18:19], v7 offset:18176
s_waitcnt vmcnt(11) lgkmcnt(15)
v_mfma_f32_16x16x32_bf16 v[32:35], a[48:51], v[88:91], v[32:35]
buffer_load_dwordx4 v[72:75], v4, s[16:19], s53 offen sc1
s_waitcnt vmcnt(11)
v_mfma_f32_16x16x32_bf16 v[48:51], a[48:51], v[92:95], v[48:51]
ds_read_b64_tr_b16 a[20:21], v7 offset:17696
ds_read_b64_tr_b16 a[22:23], v7 offset:18208
s_waitcnt lgkmcnt(15)
v_mfma_f32_16x16x32_bf16 v[36:39], a[52:55], v[88:91], v[36:39]
ds_read_b64_tr_b16 a[24:25], v7 offset:17728
ds_read_b64_tr_b16 a[26:27], v7 offset:18240
v_mfma_f32_16x16x32_bf16 v[52:55], a[52:55], v[92:95], v[52:55]
buffer_load_dwordx4 v[76:79], v4, s[16:19], s53 offen offset:1024 sc1
s_waitcnt lgkmcnt(15)
v_mfma_f32_16x16x32_bf16 v[40:43], a[56:59], v[88:91], v[40:43]
ds_read_b64_tr_b16 a[28:29], v7 offset:17760
s_add_u32 s53, s53, 0x40000
v_mfma_f32_16x16x32_bf16 v[56:59], a[56:59], v[92:95], v[56:59]
ds_read_b64_tr_b16 a[30:31], v7 offset:18272
s_waitcnt lgkmcnt(15)
v_mfma_f32_16x16x32_bf16 v[44:47], a[60:63], v[88:91], v[44:47]
v_mfma_f32_16x16x32_bf16 v[60:63], a[60:63], v[92:95], v[60:63]
s_waitcnt vmcnt(11) lgkmcnt(14)
v_mfma_f32_16x16x32_bf16 v[32:35], a[0:3], v[96:99], v[32:35]
ds_read_b64_tr_b16 a[32:33], v7 offset:24960
ds_read_b64_tr_b16 a[34:35], v7 offset:25472
s_waitcnt vmcnt(10)
v_mfma_f32_16x16x32_bf16 v[48:51], a[0:3], v[100:103], v[48:51]
buffer_load_dwordx4 v[80:83], v4, s[16:19], s52 offen sc1
s_waitcnt lgkmcnt(14)
v_mfma_f32_16x16x32_bf16 v[36:39], a[4:7], v[96:99], v[36:39]
ds_read_b64_tr_b16 a[36:37], v7 offset:24992
ds_read_b64_tr_b16 a[38:39], v7 offset:25504
v_mfma_f32_16x16x32_bf16 v[52:55], a[4:7], v[100:103], v[52:55]
ds_read_b64_tr_b16 a[40:41], v7 offset:25024
ds_read_b64_tr_b16 a[42:43], v7 offset:25536
s_waitcnt lgkmcnt(15)
v_mfma_f32_16x16x32_bf16 v[40:43], a[8:11], v[96:99], v[40:43]
buffer_load_dwordx4 v[84:87], v4, s[16:19], s52 offen offset:1024 sc1
v_mfma_f32_16x16x32_bf16 v[56:59], a[8:11], v[100:103], v[56:59]
ds_read_b64_tr_b16 a[44:45], v7 offset:25056
s_add_u32 s52, s52, 0x40000
s_waitcnt lgkmcnt(15)
v_mfma_f32_16x16x32_bf16 v[44:47], a[12:15], v[96:99], v[44:47]
ds_read_b64_tr_b16 a[46:47], v7 offset:25568
v_mfma_f32_16x16x32_bf16 v[60:63], a[12:15], v[100:103], v[60:63]
ds_read_b64_tr_b16 a[48:49], v7 offset:25984
ds_read_b64_tr_b16 a[50:51], v7 offset:26496
s_waitcnt vmcnt(11) lgkmcnt(15)
v_mfma_f32_16x16x32_bf16 v[32:35], a[16:19], v[104:107], v[32:35]
buffer_load_dwordx4 v[88:91], v4, s[16:19], s53 offen sc1
s_waitcnt vmcnt(11)
v_mfma_f32_16x16x32_bf16 v[48:51], a[16:19], v[108:111], v[48:51]
ds_read_b64_tr_b16 a[52:53], v7 offset:26016
ds_read_b64_tr_b16 a[54:55], v7 offset:26528
s_waitcnt lgkmcnt(15)
v_mfma_f32_16x16x32_bf16 v[36:39], a[20:23], v[104:107], v[36:39]
ds_read_b64_tr_b16 a[56:57], v7 offset:26048
ds_read_b64_tr_b16 a[58:59], v7 offset:26560
v_mfma_f32_16x16x32_bf16 v[52:55], a[20:23], v[108:111], v[52:55]
buffer_load_dwordx4 v[92:95], v4, s[16:19], s53 offen offset:1024 sc1
s_waitcnt lgkmcnt(15)
v_mfma_f32_16x16x32_bf16 v[40:43], a[24:27], v[104:107], v[40:43]
ds_read_b64_tr_b16 a[60:61], v7 offset:26080
s_add_u32 s53, s53, 0x40000
v_mfma_f32_16x16x32_bf16 v[56:59], a[24:27], v[108:111], v[56:59]
ds_read_b64_tr_b16 a[62:63], v7 offset:26592
s_waitcnt lgkmcnt(15)
v_mfma_f32_16x16x32_bf16 v[44:47], a[28:31], v[104:107], v[44:47]
v_mfma_f32_16x16x32_bf16 v[60:63], a[28:31], v[108:111], v[60:63]
s_waitcnt vmcnt(11) lgkmcnt(14)
v_mfma_f32_16x16x32_bf16 v[32:35], a[32:35], v[112:115], v[32:35]
ds_read_b64_tr_b16 a[0:1], v7 offset:33280
ds_read_b64_tr_b16 a[2:3], v7 offset:33792
s_waitcnt vmcnt(10)
v_mfma_f32_16x16x32_bf16 v[48:51], a[32:35], v[116:119], v[48:51]
buffer_load_dwordx4 v[96:99], v4, s[16:19], s52 offen sc1
s_waitcnt lgkmcnt(14)
v_mfma_f32_16x16x32_bf16 v[36:39], a[36:39], v[112:115], v[36:39]
ds_read_b64_tr_b16 a[4:5], v7 offset:33312
ds_read_b64_tr_b16 a[6:7], v7 offset:33824
v_mfma_f32_16x16x32_bf16 v[52:55], a[36:39], v[116:119], v[52:55]
ds_read_b64_tr_b16 a[8:9], v7 offset:33344
ds_read_b64_tr_b16 a[10:11], v7 offset:33856
s_waitcnt lgkmcnt(15)
v_mfma_f32_16x16x32_bf16 v[40:43], a[40:43], v[112:115], v[40:43]
buffer_load_dwordx4 v[100:103], v4, s[16:19], s52 offen offset:1024 sc1
v_mfma_f32_16x16x32_bf16 v[56:59], a[40:43], v[116:119], v[56:59]
ds_read_b64_tr_b16 a[12:13], v7 offset:33376
s_add_u32 s52, s52, 0x40000
s_waitcnt lgkmcnt(15)
v_mfma_f32_16x16x32_bf16 v[44:47], a[44:47], v[112:115], v[44:47]
ds_read_b64_tr_b16 a[14:15], v7 offset:33888
v_mfma_f32_16x16x32_bf16 v[60:63], a[44:47], v[116:119], v[60:63]
ds_read_b64_tr_b16 a[16:17], v7 offset:34304
ds_read_b64_tr_b16 a[18:19], v7 offset:34816
s_waitcnt vmcnt(11) lgkmcnt(15)
v_mfma_f32_16x16x32_bf16 v[32:35], a[48:51], v[120:123], v[32:35]
buffer_load_dwordx4 v[104:107], v4, s[16:19], s53 offen sc1
s_waitcnt vmcnt(11)
v_mfma_f32_16x16x32_bf16 v[48:51], a[48:51], v[124:127], v[48:51]
ds_read_b64_tr_b16 a[20:21], v7 offset:34336
ds_read_b64_tr_b16 a[22:23], v7 offset:34848
s_waitcnt lgkmcnt(15)
v_mfma_f32_16x16x32_bf16 v[36:39], a[52:55], v[120:123], v[36:39]
ds_read_b64_tr_b16 a[24:25], v7 offset:34368
ds_read_b64_tr_b16 a[26:27], v7 offset:34880
v_mfma_f32_16x16x32_bf16 v[52:55], a[52:55], v[124:127], v[52:55]
buffer_load_dwordx4 v[108:111], v4, s[16:19], s53 offen offset:1024 sc1
s_waitcnt lgkmcnt(15)
v_mfma_f32_16x16x32_bf16 v[40:43], a[56:59], v[120:123], v[40:43]
ds_read_b64_tr_b16 a[28:29], v7 offset:34400
s_add_u32 s53, s53, 0x40000
v_mfma_f32_16x16x32_bf16 v[56:59], a[56:59], v[124:127], v[56:59]
ds_read_b64_tr_b16 a[30:31], v7 offset:34912
s_waitcnt lgkmcnt(15)
v_mfma_f32_16x16x32_bf16 v[44:47], a[60:63], v[120:123], v[44:47]
v_mfma_f32_16x16x32_bf16 v[60:63], a[60:63], v[124:127], v[60:63]
s_waitcnt vmcnt(11) lgkmcnt(14)
v_mfma_f32_16x16x32_bf16 v[32:35], a[0:3], v[64:67], v[32:35]
ds_read_b64_tr_b16 a[32:33], v7 offset:41600
ds_read_b64_tr_b16 a[34:35], v7 offset:42112
s_waitcnt vmcnt(10)
v_mfma_f32_16x16x32_bf16 v[48:51], a[0:3], v[68:71], v[48:51]
buffer_load_dwordx4 v[112:115], v4, s[16:19], s52 offen sc1
s_waitcnt lgkmcnt(14)
v_mfma_f32_16x16x32_bf16 v[36:39], a[4:7], v[64:67], v[36:39]
ds_read_b64_tr_b16 a[36:37], v7 offset:41632
ds_read_b64_tr_b16 a[38:39], v7 offset:42144
v_mfma_f32_16x16x32_bf16 v[52:55], a[4:7], v[68:71], v[52:55]
ds_read_b64_tr_b16 a[40:41], v7 offset:41664
ds_read_b64_tr_b16 a[42:43], v7 offset:42176
s_waitcnt lgkmcnt(15)
v_mfma_f32_16x16x32_bf16 v[40:43], a[8:11], v[64:67], v[40:43]
buffer_load_dwordx4 v[116:119], v4, s[16:19], s52 offen offset:1024 sc1
v_mfma_f32_16x16x32_bf16 v[56:59], a[8:11], v[68:71], v[56:59]
ds_read_b64_tr_b16 a[44:45], v7 offset:41696
s_add_u32 s52, s52, 0x40000
s_waitcnt lgkmcnt(15)
v_mfma_f32_16x16x32_bf16 v[44:47], a[12:15], v[64:67], v[44:47]
ds_read_b64_tr_b16 a[46:47], v7 offset:42208
v_mfma_f32_16x16x32_bf16 v[60:63], a[12:15], v[68:71], v[60:63]
ds_read_b64_tr_b16 a[48:49], v7 offset:42624
ds_read_b64_tr_b16 a[50:51], v7 offset:43136
s_waitcnt vmcnt(11) lgkmcnt(15)
v_mfma_f32_16x16x32_bf16 v[32:35], a[16:19], v[72:75], v[32:35]
buffer_load_dwordx4 v[120:123], v4, s[16:19], s53 offen sc1
s_waitcnt vmcnt(11)
v_mfma_f32_16x16x32_bf16 v[48:51], a[16:19], v[76:79], v[48:51]
ds_read_b64_tr_b16 a[52:53], v7 offset:42656
ds_read_b64_tr_b16 a[54:55], v7 offset:43168
s_waitcnt lgkmcnt(15)
v_mfma_f32_16x16x32_bf16 v[36:39], a[20:23], v[72:75], v[36:39]
ds_read_b64_tr_b16 a[56:57], v7 offset:42688
ds_read_b64_tr_b16 a[58:59], v7 offset:43200
v_mfma_f32_16x16x32_bf16 v[52:55], a[20:23], v[76:79], v[52:55]
buffer_load_dwordx4 v[124:127], v4, s[16:19], s53 offen offset:1024 sc1
s_waitcnt lgkmcnt(15)
v_mfma_f32_16x16x32_bf16 v[40:43], a[24:27], v[72:75], v[40:43]
ds_read_b64_tr_b16 a[60:61], v7 offset:42720
s_add_u32 s53, s53, 0x40000
v_mfma_f32_16x16x32_bf16 v[56:59], a[24:27], v[76:79], v[56:59]
ds_read_b64_tr_b16 a[62:63], v7 offset:43232
s_waitcnt lgkmcnt(15)
v_mfma_f32_16x16x32_bf16 v[44:47], a[28:31], v[72:75], v[44:47]
v_mfma_f32_16x16x32_bf16 v[60:63], a[28:31], v[76:79], v[60:63]
s_waitcnt lgkmcnt(0)
s_barrier
s_waitcnt vmcnt(11)
v_mfma_f32_16x16x32_bf16 v[32:35], a[32:35], v[80:83], v[32:35]
ds_read_b64_tr_b16 a[0:1], v7 offset:49920
ds_read_b64_tr_b16 a[2:3], v7 offset:50432
s_add_u32 m0, s59, 84480
s_waitcnt vmcnt(10)
v_mfma_f32_16x16x32_bf16 v[48:51], a[32:35], v[84:87], v[48:51]
ds_read_b64_tr_b16 a[4:5], v7 offset:49952
buffer_load_dwordx4 v12, s[32:35], s58 offen lds
v_mfma_f32_16x16x32_bf16 v[36:39], a[36:39], v[80:83], v[36:39]
ds_read_b64_tr_b16 a[6:7], v7 offset:50464
ds_read_b64_tr_b16 a[8:9], v7 offset:49984
v_mfma_f32_16x16x32_bf16 v[52:55], a[36:39], v[84:87], v[52:55]
ds_read_b64_tr_b16 a[10:11], v7 offset:50496
v_mfma_f32_16x16x32_bf16 v[40:43], a[40:43], v[80:83], v[40:43]
ds_read_b64_tr_b16 a[12:13], v7 offset:50016
buffer_load_dwordx4 v13, s[32:35], s58 offen offset:1056 lds
v_mfma_f32_16x16x32_bf16 v[56:59], a[40:43], v[84:87], v[56:59]
ds_read_b64_tr_b16 a[14:15], v7 offset:50528
ds_read_b64_tr_b16 a[16:17], v7 offset:50944
v_mfma_f32_16x16x32_bf16 v[44:47], a[44:47], v[80:83], v[44:47]
ds_read_b64_tr_b16 a[18:19], v7 offset:51456
ds_read_b64_tr_b16 a[20:21], v7 offset:50976
v_mfma_f32_16x16x32_bf16 v[60:63], a[44:47], v[84:87], v[60:63]
ds_read_b64_tr_b16 a[22:23], v7 offset:51488
s_waitcnt vmcnt(11)
v_mfma_f32_16x16x32_bf16 v[32:35], a[48:51], v[88:91], v[32:35]
ds_read_b64_tr_b16 a[24:25], v7 offset:51008
buffer_load_dwordx4 v14, s[32:35], s58 offen offset:2112 lds
s_waitcnt vmcnt(11)
v_mfma_f32_16x16x32_bf16 v[48:51], a[48:51], v[92:95], v[48:51]
ds_read_b64_tr_b16 a[26:27], v7 offset:51520
ds_read_b64_tr_b16 a[28:29], v7 offset:51040
v_mfma_f32_16x16x32_bf16 v[36:39], a[52:55], v[88:91], v[36:39]
ds_read_b64_tr_b16 a[30:31], v7 offset:51552
v_mfma_f32_16x16x32_bf16 v[52:55], a[52:55], v[92:95], v[52:55]
buffer_load_dwordx4 v15, s[32:35], s58 offen offset:3168 lds
v_mfma_f32_16x16x32_bf16 v[40:43], a[56:59], v[88:91], v[40:43]
s_add_u32 s58, s58, 229376
v_mfma_f32_16x16x32_bf16 v[56:59], a[56:59], v[92:95], v[56:59]
v_mfma_f32_16x16x32_bf16 v[44:47], a[60:63], v[88:91], v[44:47]
v_mfma_f32_16x16x32_bf16 v[60:63], a[60:63], v[92:95], v[60:63]
s_waitcnt vmcnt(11) lgkmcnt(14)
v_mfma_f32_16x16x32_bf16 v[32:35], a[0:3], v[96:99], v[32:35]
ds_read_b64_tr_b16 a[32:33], v7 offset:58240
s_add_u32 m0, s59, 101376
s_waitcnt vmcnt(10)
v_mfma_f32_16x16x32_bf16 v[48:51], a[0:3], v[100:103], v[48:51]
buffer_load_dwordx4 v12, s[32:35], s58 offen lds
s_waitcnt lgkmcnt(13)
v_mfma_f32_16x16x32_bf16 v[36:39], a[4:7], v[96:99], v[36:39]
ds_read_b64_tr_b16 a[34:35], v7 offset:58752
ds_read_b64_tr_b16 a[36:37], v7 offset:58272
v_mfma_f32_16x16x32_bf16 v[52:55], a[4:7], v[100:103], v[52:55]
ds_read_b64_tr_b16 a[38:39], v7 offset:58784
ds_read_b64_tr_b16 a[40:41], v7 offset:58304
s_waitcnt lgkmcnt(15)
v_mfma_f32_16x16x32_bf16 v[40:43], a[8:11], v[96:99], v[40:43]
buffer_load_dwordx4 v13, s[32:35], s58 offen offset:1056 lds
v_mfma_f32_16x16x32_bf16 v[56:59], a[8:11], v[100:103], v[56:59]
ds_read_b64_tr_b16 a[42:43], v7 offset:58816
ds_read_b64_tr_b16 a[44:45], v7 offset:58336
s_waitcnt lgkmcnt(15)
v_mfma_f32_16x16x32_bf16 v[44:47], a[12:15], v[96:99], v[44:47]
ds_read_b64_tr_b16 a[46:47], v7 offset:58848
v_mfma_f32_16x16x32_bf16 v[60:63], a[12:15], v[100:103], v[60:63]
ds_read_b64_tr_b16 a[48:49], v7 offset:59264
ds_read_b64_tr_b16 a[50:51], v7 offset:59776
.Lpad10:
s_cbranch_execz .Lnopoll23r
s_waitcnt vmcnt(11) lgkmcnt(15)
v_mfma_f32_16x16x32_bf16 v[32:35], a[16:19], v[104:107], v[32:35]
buffer_load_dwordx4 v14, s[32:35], s58 offen offset:2112 lds
s_waitcnt vmcnt(11)
v_mfma_f32_16x16x32_bf16 v[48:51], a[16:19], v[108:111], v[48:51]
ds_read_b64_tr_b16 a[52:53], v7 offset:59296
ds_read_b64_tr_b16 a[54:55], v7 offset:59808
s_waitcnt lgkmcnt(15)
v_mfma_f32_16x16x32_bf16 v[36:39], a[20:23], v[104:107], v[36:39]
ds_read_b64_tr_b16 a[56:57], v7 offset:59328
ds_read_b64_tr_b16 a[58:59], v7 offset:59840
v_mfma_f32_16x16x32_bf16 v[52:55], a[20:23], v[108:111], v[52:55]
buffer_load_dwordx4 v15, s[32:35], s58 offen offset:3168 lds
s_waitcnt lgkmcnt(15)
v_mfma_f32_16x16x32_bf16 v[40:43], a[24:27], v[104:107], v[40:43]
ds_read_b64_tr_b16 a[60:61], v7 offset:59360
s_add_u32 s58, s58, 229376
v_mfma_f32_16x16x32_bf16 v[56:59], a[24:27], v[108:111], v[56:59]
ds_read_b64_tr_b16 a[62:63], v7 offset:59872
s_waitcnt lgkmcnt(15)
v_mfma_f32_16x16x32_bf16 v[44:47], a[28:31], v[104:107], v[44:47]
v_mfma_f32_16x16x32_bf16 v[60:63], a[28:31], v[108:111], v[60:63]
s_waitcnt vmcnt(11) lgkmcnt(14)
v_mfma_f32_16x16x32_bf16 v[32:35], a[32:35], v[112:115], v[32:35]
s_add_u32 m0, s59, 118272
s_lshl_b32 s64, s6, 14
s_lshl_b32 s65, s49, 13
s_waitcnt vmcnt(10)
v_mfma_f32_16x16x32_bf16 v[48:51], a[32:35], v[116:119], v[48:51]
buffer_load_dwordx4 v12, s[32:35], s58 offen lds
s_waitcnt lgkmcnt(12)
v_mfma_f32_16x16x32_bf16 v[36:39], a[36:39], v[112:115], v[36:39]
s_add_u32 s64, s64, s65
s_lshl_b32 s65, s7, 9
s_add_u32 s64, s64, s65
v_mfma_f32_16x16x32_bf16 v[52:55], a[36:39], v[116:119], v[52:55]
s_lshl_b32 s65, s48, 8
s_add_u32 s64, s64, s65
s_add_u32 s64, s64, 29622272
s_waitcnt lgkmcnt(10)
v_mfma_f32_16x16x32_bf16 v[40:43], a[40:43], v[112:115], v[40:43]
s_lshl_b32 s62, s7, 18
v_and_b32 v152, 31, v1
v_lshlrev_b32 v152, 3, v152
v_mfma_f32_16x16x32_bf16 v[56:59], a[40:43], v[116:119], v[56:59]
buffer_load_dwordx4 v13, s[32:35], s58 offen offset:1056 lds
s_waitcnt lgkmcnt(8)
v_mfma_f32_16x16x32_bf16 v[44:47], a[44:47], v[112:115], v[44:47]
s_add_u32 s62, s62, 8388608
v_lshrrev_b32 v153, 5, v1
v_lshl_add_u32 v152, v153, 28, v152
v_mfma_f32_16x16x32_bf16 v[60:63], a[44:47], v[116:119], v[60:63]
s_add_u32 s63, s62, 0x20000
s_waitcnt vmcnt(11) lgkmcnt(6)
v_mfma_f32_16x16x32_bf16 v[32:35], a[48:51], v[120:123], v[32:35]
s_waitcnt vmcnt(10)
v_mfma_f32_16x16x32_bf16 v[48:51], a[48:51], v[124:127], v[48:51]
buffer_load_dwordx4 v14, s[32:35], s58 offen offset:2112 lds
s_waitcnt lgkmcnt(4)
v_mfma_f32_16x16x32_bf16 v[36:39], a[52:55], v[120:123], v[36:39]
s_nop 2
v_cvt_pk_bf16_f32 v128, v32, v33
v_cvt_pk_bf16_f32 v129, v34, v35
v_mfma_f32_16x16x32_bf16 v[52:55], a[52:55], v[124:127], v[52:55]
v_cvt_pk_bf16_f32 v136, v48, v49
v_cvt_pk_bf16_f32 v137, v50, v51
s_waitcnt lgkmcnt(2)
v_mfma_f32_16x16x32_bf16 v[40:43], a[56:59], v[120:123], v[40:43]
v_cvt_pk_bf16_f32 v130, v36, v37
v_cvt_pk_bf16_f32 v131, v38, v39
v_mfma_f32_16x16x32_bf16 v[56:59], a[56:59], v[124:127], v[56:59]
buffer_load_dwordx4 v15, s[32:35], s58 offen offset:3168 lds
s_waitcnt lgkmcnt(0)
v_mfma_f32_16x16x32_bf16 v[44:47], a[60:63], v[120:123], v[44:47]
s_add_u32 s58, s58, 229376
s_nop 0
v_cvt_pk_bf16_f32 v132, v40, v41
v_cvt_pk_bf16_f32 v133, v42, v43
v_mfma_f32_16x16x32_bf16 v[60:63], a[60:63], v[124:127], v[60:63]
v_cvt_pk_bf16_f32 v138, v52, v53
v_cvt_pk_bf16_f32 v139, v54, v55
v_cvt_pk_bf16_f32 v140, v56, v57
v_cvt_pk_bf16_f32 v134, v44, v45
v_cvt_pk_bf16_f32 v135, v46, v47
v_cvt_pk_bf16_f32 v141, v58, v59
v_pk_mul_f32 v[146:147], v[32:33], v[32:33]
buffer_store_dwordx4 v[128:131], v4, s[16:19], s62 offen sc1
v_cvt_pk_bf16_f32 v142, v60, v61
v_cvt_pk_bf16_f32 v143, v62, v63
v_pk_mul_f32 v[150:151], v[48:49], v[48:49]
v_pk_fma_f32 v[146:147], v[34:35], v[34:35], v[146:147]
v_pk_add_f32 v[144:145], v[32:33], v[34:35]
v_pk_fma_f32 v[150:151], v[50:51], v[50:51], v[150:151]
v_pk_add_f32 v[148:149], v[48:49], v[50:51]
v_pk_fma_f32 v[146:147], v[36:37], v[36:37], v[146:147]
v_pk_add_f32 v[144:145], v[144:145], v[36:37]
v_pk_fma_f32 v[150:151], v[52:53], v[52:53], v[150:151]
v_pk_add_f32 v[148:149], v[148:149], v[52:53]
v_pk_fma_f32 v[146:147], v[38:39], v[38:39], v[146:147]
v_pk_add_f32 v[144:145], v[144:145], v[38:39]
buffer_store_dwordx4 v[132:135], v4, s[16:19], s63 offen sc1
v_pk_fma_f32 v[150:151], v[54:55], v[54:55], v[150:151]
v_pk_add_f32 v[148:149], v[148:149], v[54:55]
v_pk_fma_f32 v[146:147], v[40:41], v[40:41], v[146:147]
v_pk_add_f32 v[144:145], v[144:145], v[40:41]
v_pk_fma_f32 v[150:151], v[56:57], v[56:57], v[150:151]
v_pk_add_f32 v[148:149], v[148:149], v[56:57]
v_pk_fma_f32 v[146:147], v[42:43], v[42:43], v[146:147]
v_pk_add_f32 v[144:145], v[144:145], v[42:43]
v_pk_fma_f32 v[150:151], v[58:59], v[58:59], v[150:151]
v_pk_add_f32 v[148:149], v[148:149], v[58:59]
v_pk_fma_f32 v[146:147], v[44:45], v[44:45], v[146:147]
v_pk_add_f32 v[144:145], v[144:145], v[44:45]
v_pk_fma_f32 v[150:151], v[60:61], v[60:61], v[150:151]
buffer_store_dwordx4 v[136:139], v4, s[16:19], s62 offen offset:1024 sc1
v_pk_add_f32 v[148:149], v[148:149], v[60:61]
v_pk_fma_f32 v[146:147], v[46:47], v[46:47], v[146:147]
v_pk_add_f32 v[144:145], v[144:145], v[46:47]
v_pk_fma_f32 v[150:151], v[62:63], v[62:63], v[150:151]
v_pk_add_f32 v[148:149], v[148:149], v[62:63]
v_add_f32 v144, v144, v145
v_add_f32 v146, v146, v147
v_add_f32 v148, v148, v149
v_add_f32 v150, v150, v151
s_nop 0
v_permlane16_swap_b32 v144, v148
v_permlane16_swap_b32 v146, v150
v_add_f32 v144, v144, v148
buffer_store_dwordx4 v[140:143], v4, s[16:19], s63 offen offset:1024 sc1
v_add_f32 v146, v146, v150
s_nop 1
v_permlane32_swap_b32 v144, v146
v_add_f32 v144, v144, v146
s_nop 1
v_permlane32_swap_b32 v144, v145
buffer_store_dwordx2 v[144:145], v152, s[16:19], s64 offen sc1
s_nop 1
v_accvgpr_write_b32 a224, v32
v_accvgpr_write_b32 a225, v33
v_accvgpr_write_b32 a226, v34
v_accvgpr_write_b32 a227, v35
v_accvgpr_write_b32 a228, v36
v_accvgpr_write_b32 a229, v37
v_accvgpr_write_b32 a230, v38
v_accvgpr_write_b32 a231, v39
v_accvgpr_write_b32 a232, v40
v_accvgpr_write_b32 a233, v41
v_accvgpr_write_b32 a234, v42
v_accvgpr_write_b32 a235, v43
v_accvgpr_write_b32 a236, v44
v_accvgpr_write_b32 a237, v45
v_accvgpr_write_b32 a238, v46
v_accvgpr_write_b32 a239, v47
v_accvgpr_write_b32 a240, v48
v_accvgpr_write_b32 a241, v49
v_accvgpr_write_b32 a242, v50
v_accvgpr_write_b32 a243, v51
v_accvgpr_write_b32 a244, v52
v_accvgpr_write_b32 a245, v53
v_accvgpr_write_b32 a246, v54
v_accvgpr_write_b32 a247, v55
v_accvgpr_write_b32 a248, v56
v_accvgpr_write_b32 a249, v57
v_accvgpr_write_b32 a250, v58
v_accvgpr_write_b32 a251, v59
v_accvgpr_write_b32 a252, v60
v_accvgpr_write_b32 a253, v61
v_accvgpr_write_b32 a254, v62
v_accvgpr_write_b32 a255, v63
s_lshl_b32 s62, s10, 14
s_lshl_b32 s63, s3, 12
s_add_u32 s62, s62, s63
s_lshl_b32 s63, s12, 11
s_add_u32 s62, s62, s63
v_lshl_add_u32 v10, v1, 4, s62
v_lshrrev_b32 v2, 3, v1
v_cmp_eq_u32 vcc, 3, v2
v_add_u32 v2, 67108480, v10
s_nop 0
v_cndmask_b32 v10, v10, v2, vcc
v_xor_b32 v11, 2048, v10
v_bfe_u32 v16, v1, 2, 3
v_mul_u32_u24 v16, 1056, v16
v_bfe_u32 v2, v1, 5, 1
v_lshl_add_u32 v16, v2, 8, v16
v_and_b32 v2, 3, v1
v_lshl_add_u32 v16, v2, 3, v16
s_lshl_b32 s62, s12, 6
s_add_u32 s62, s62, 84480
s_xor_b32 s63, s12, 1
s_mul_i32 s63, s63, 192
s_add_u32 s63, s63, 84480
v_add_u32 v17, s63, v16
v_add_u32 v16, s62, v16
s_mov_b32 s52, 8388608
s_mov_b32 s54, s58
s_mov_b32 s55, s59
s_mul_i32 s59, s3, 2112
s_and_b32 s62, s7, 1
s_mul_i32 s62, s62, 3670016
s_lshr_b32 s63, s7, 1
s_lshl_b32 s63, s63, 8
s_add_u32 s62, s62, s63
s_lshl_b32 s63, s3, 12
s_add_u32 s62, s62, s63
v_lshrrev_b32 v5, 4, v1
v_lshlrev_b32 v5, 14, v5
v_and_b32 v2, 15, v1
v_lshl_add_u32 v5, v2, 4, v5
v_add_u32 v5, s62, v5
v_add_u32 v6, 992, v5
s_lshl_b32 s62, s10, 15
s_lshl_b32 s63, s3, 13
s_add_u32 s62, s62, s63
v_lshl_add_u32 v4, v1, 4, s62
s_and_b32 s47, s5, 3
s_lshr_b32 s63, s5, 2
s_lshl_b32 s63, s63, 3
s_add_u32 s63, s63, s4
s_lshl_b32 s62, s63, 1
s_add_u32 s62, s62, s48
s_mul_i32 s62, s62, 1792
v_lshrrev_b32 v7, 2, v1
v_min_u32 v8, 13, v7
v_lshl_add_u32 v8, v8, 7, s62
s_lshl_b32 s62, s63, 2
s_add_u32 s62, s62, s3
s_mul_i32 s62, s62, 640
v_and_b32 v7, 7, v7
v_min_u32 v7, 4, v7
v_lshl_add_u32 v7, v7, 7, s62
v_lshrrev_b32 v2, 5, v1
v_mul_u32_u24 v2, 3670016, v2
v_add_u32 v7, v7, v2
s_mul_i32 s44, s47, 163840
s_add_u32 s45, s47, 12
s_mul_i32 s45, s45, 229376
v_and_b32 v2, 1, v1
v_lshlrev_b32 v2, 4, v2
v_mov_b32 v9, 0x3f80
v_lshlrev_b32 v2, v2, v9
v_bfe_u32 v9, v1, 1, 3
v_cmp_eq_u32 vcc, 0, v9
s_nop 1
v_cndmask_b32 v20, 0, v2, vcc
v_cmp_eq_u32 vcc, 1, v9
s_nop 1
v_cndmask_b32 v21, 0, v2, vcc
v_cmp_eq_u32 vcc, 2, v9
s_nop 1
v_cndmask_b32 v22, 0, v2, vcc
v_cmp_eq_u32 vcc, 3, v9
s_nop 1
v_cndmask_b32 v23, 0, v2, vcc
s_add_u32 s62, s55, 84480
v_lshl_add_u32 v9, v1, 4, s62
v_mov_b64 v[24:25], 0
v_mov_b64 v[26:27], 0
s_lshl_b32 s62, s6, 7
s_add_u32 s62, s62, 30412800
s_lshl_b32 s64, s10, 1
s_lshl_b32 s64, s64, 7
s_add_u32 s64, s64, 30412800
s_add_u32 s65, s64, 128
v_mov_b32 v252, s62
v_mov_b32 v253, s64
v_writelane_b32 v253, s65, 1
s_waitcnt vmcnt(0) lgkmcnt(0)
s_barrier
s_cmp_lg_u32 s3, 0
s_cbranch_scc1 .Lnosig25
v_mov_b32 v255, 1
s_mov_b64 exec, 1
buffer_atomic_add v255, v252, s[16:19], 0 offen
s_mov_b64 exec, -1
.Lnosig25:
s_cmp_lg_u32 s3, 1
s_cbranch_scc1 .Lnopoll28
s_mov_b64 exec, 3
s_mov_b32 s15, 0
s_mov_b64 exec, 3
v_mov_b32 v254, 0
buffer_atomic_add v254, v253, s[16:19], 0 offen sc0
.Lpoll26:
s_waitcnt vmcnt(0)
v_cmp_ne_u32 vcc, 16, v254
s_add_u32 s15, s15, 1
s_cbranch_vccz .Lnopoll28r
s_sleep 2
s_mov_b64 exec, 3
v_mov_b32 v254, 0
buffer_atomic_add v254, v253, s[16:19], 0 offen sc0
s_cmp_le_u32 s15, 100000
s_cbranch_scc1 .Lpoll26
.Lgot27:
s_waitcnt vmcnt(0)
s_branch .Lnopoll28r
.Lnopoll28:
s_mov_b64 exec, 0
s_cmp_eq_u32 s3, 2
s_cbranch_scc1 .Lpad11
s_cmp_eq_u32 s3, 3
s_cbranch_scc1 .Lpad12
s_branch .Lpad13
.Lnopoll28r:
s_mov_b64 exec, -1
s_barrier
buffer_load_dwordx4 a[128:131], v10, s[16:19], s52 offen sc1
buffer_load_dwordx4 a[132:135], v10, s[16:19], s52 offen offset:1024 sc1
buffer_load_dwordx4 a[136:139], v11, s[16:19], s52 offen sc1
buffer_load_dwordx4 a[140:143], v11, s[16:19], s52 offen offset:1024 sc1
s_add_u32 s52, s52, 0x20000
buffer_load_dwordx4 a[144:147], v10, s[16:19], s52 offen sc1
buffer_load_dwordx4 a[148:151], v10, s[16:19], s52 offen offset:1024 sc1
buffer_load_dwordx4 a[152:155], v11, s[16:19], s52 offen sc1
buffer_load_dwordx4 a[156:159], v11, s[16:19], s52 offen offset:1024 sc1
s_add_u32 s52, s52, 0x20000
ds_read_b64_tr_b16 a[0:1], v16
ds_read_b64_tr_b16 a[2:3], v16 offset:512
ds_read_b64_tr_b16 a[4:5], v16 offset:32
ds_read_b64_tr_b16 a[6:7], v16 offset:544
ds_read_b64_tr_b16 a[8:9], v16 offset:8448
ds_read_b64_tr_b16 a[10:11], v16 offset:8960
ds_read_b64_tr_b16 a[12:13], v16 offset:8480
ds_read_b64_tr_b16 a[14:15], v16 offset:8992
ds_read_b64_tr_b16 a[16:17], v16 offset:64
ds_read_b64_tr_b16 a[18:19], v16 offset:576
ds_read_b64_tr_b16 a[20:21], v16 offset:96
ds_read_b64_tr_b16 a[22:23], v16 offset:608
ds_read_b64_tr_b16 a[24:25], v16 offset:8512
ds_read_b64_tr_b16 a[26:27], v16 offset:9024
ds_read_b64_tr_b16 a[28:29], v16 offset:8544
ds_read_b64_tr_b16 a[30:31], v16 offset:9056
ds_read_b64_tr_b16 a[32:33], v16 offset:128
ds_read_b64_tr_b16 a[34:35], v16 offset:640
ds_read_b64_tr_b16 a[36:37], v16 offset:160
ds_read_b64_tr_b16 a[38:39], v16 offset:672
ds_read_b64_tr_b16 a[40:41], v16 offset:8576
ds_read_b64_tr_b16 a[42:43], v16 offset:9088
ds_read_b64_tr_b16 a[44:45], v16 offset:8608
ds_read_b64_tr_b16 a[46:47], v16 offset:9120
ds_read_b64_tr_b16 a[48:49], v17
ds_read_b64_tr_b16 a[50:51], v17 offset:512
ds_read_b64_tr_b16 a[52:53], v17 offset:32
ds_read_b64_tr_b16 a[54:55], v17 offset:544
ds_read_b64_tr_b16 a[56:57], v17 offset:8448
ds_read_b64_tr_b16 a[58:59], v17 offset:8960
ds_read_b64_tr_b16 a[60:61], v17 offset:8480
ds_read_b64_tr_b16 a[62:63], v17 offset:8992
ds_read_b128 a[192:195], v9
ds_read_b128 a[196:199], v9 offset:1056
ds_read_b128 a[200:203], v9 offset:2112
ds_read_b128 a[204:207], v9 offset:3168
s_add_u32 m0, s55, 135168
s_nop 0
buffer_load_dwordx4 v12, s[32:35], s54 offen lds
buffer_load_dwordx4 v13, s[32:35], s54 offen offset:1056 lds
buffer_load_dwordx4 v14, s[32:35], s54 offen offset:2112 lds
buffer_load_dwordx4 v15, s[32:35], s54 offen offset:3168 lds
s_add_u32 s54, s54, 229376
s_waitcnt lgkmcnt(0)
s_barrier
s_lshl_b32 s74, s3, 13
s_add_u32 s74, s74, 49920
v_lshl_add_u32 v2, v1, 4, s74
s_waitcnt vmcnt(11)
v_mfma_f32_16x16x32_bf16 v[32:35], a[0:3], a[128:131], 0
ds_read_b64_tr_b16 a[64:65], v16 offset:16896
s_waitcnt vmcnt(10)
v_mfma_f32_16x16x32_bf16 v[36:39], a[0:3], a[132:135], 0
buffer_load_dwordx4 a[160:163], v10, s[16:19], s52 offen sc1
s_waitcnt vmcnt(10)
v_mfma_f32_16x16x32_bf16 v[40:43], a[0:3], a[136:139], 0
ds_read_b64_tr_b16 a[66:67], v16 offset:17408
s_waitcnt vmcnt(9)
v_mfma_f32_16x16x32_bf16 v[44:47], a[0:3], a[140:143], 0
ds_read_b64_tr_b16 a[68:69], v16 offset:16928
v_mfma_f32_16x16x32_bf16 v[48:51], a[4:7], a[128:131], 0
ds_read_b64_tr_b16 a[70:71], v16 offset:17440
v_mfma_f32_16x16x32_bf16 v[52:55], a[4:7], a[132:135], 0
buffer_load_dwordx4 a[164:167], v10, s[16:19], s52 offen offset:1024 sc1
v_mfma_f32_16x16x32_bf16 v[24:27], v[20:23], a[192:195], v[24:27]
ds_read_b64_tr_b16 a[72:73], v16 offset:25344
v_mfma_f32_16x16x32_bf16 v[56:59], a[4:7], a[136:139], 0
ds_read_b64_tr_b16 a[74:75], v16 offset:25856
v_mfma_f32_16x16x32_bf16 v[60:63], a[4:7], a[140:143], 0
v_mfma_f32_16x16x32_bf16 v[64:67], a[8:11], a[128:131], 0
ds_read_b64_tr_b16 a[76:77], v16 offset:25376
v_mfma_f32_16x16x32_bf16 v[68:71], a[8:11], a[132:135], 0
buffer_load_dwordx4 a[168:171], v11, s[16:19], s52 offen sc1
v_mfma_f32_16x16x32_bf16 v[72:75], a[8:11], a[136:139], 0
ds_read_b64_tr_b16 a[78:79], v16 offset:25888
v_mfma_f32_16x16x32_bf16 v[76:79], a[8:11], a[140:143], 0
ds_read_b64_tr_b16 a[80:81], v16 offset:16960
v_mfma_f32_16x16x32_bf16 v[80:83], a[12:15], a[128:131], 0
ds_read_b64_tr_b16 a[82:83], v16 offset:17472
v_mfma_f32_16x16x32_bf16 v[84:87], a[12:15], a[132:135], 0
ds_read_b64_tr_b16 a[84:85], v16 offset:16992
v_mfma_f32_16x16x32_bf16 v[88:91], a[12:15], a[136:139], 0
buffer_load_dwordx4 a[172:175], v11, s[16:19], s52 offen offset:1024 sc1
v_mfma_f32_16x16x32_bf16 v[92:95], a[12:15], a[140:143], 0
s_add_u32 s52, s52, 0x20000
v_mfma_f32_16x16x32_bf16 v[96:99], a[16:19], a[128:131], 0
ds_read_b64_tr_b16 a[86:87], v16 offset:17504
v_mfma_f32_16x16x32_bf16 v[100:103], a[16:19], a[132:135], 0
ds_read_b64_tr_b16 a[88:89], v16 offset:25408
v_mfma_f32_16x16x32_bf16 v[24:27], v[20:23], a[196:199], v[24:27]
ds_read_b64_tr_b16 a[90:91], v16 offset:25920
s_add_u32 m0, s55, 84480
v_mfma_f32_16x16x32_bf16 v[104:107], a[16:19], a[136:139], 0
buffer_load_dwordx4 v12, s[32:35], s54 offen lds
v_mfma_f32_16x16x32_bf16 v[108:111], a[16:19], a[140:143], 0
ds_read_b64_tr_b16 a[92:93], v16 offset:25440
v_mfma_f32_16x16x32_bf16 v[112:115], a[20:23], a[128:131], 0
ds_read_b64_tr_b16 a[94:95], v16 offset:25952
v_mfma_f32_16x16x32_bf16 v[116:119], a[20:23], a[132:135], 0
v_mfma_f32_16x16x32_bf16 v[120:123], a[20:23], a[136:139], 0
ds_read_b64_tr_b16 a[96:97], v16 offset:17024
v_mfma_f32_16x16x32_bf16 v[124:127], a[20:23], a[140:143], 0
buffer_load_dwordx4 a[176:179], v10, s[16:19], s52 offen sc1
v_mfma_f32_16x16x32_bf16 v[128:131], a[24:27], a[128:131], 0
ds_read_b64_tr_b16 a[98:99], v16 offset:17536
v_mfma_f32_16x16x32_bf16 v[132:135], a[24:27], a[132:135], 0
ds_read_b64_tr_b16 a[100:101], v16 offset:17056
v_mfma_f32_16x16x32_bf16 v[136:139], a[24:27], a[136:139], 0
ds_read_b64_tr_b16 a[102:103], v16 offset:17568
v_mfma_f32_16x16x32_bf16 v[140:143], a[24:27], a[140:143], 0
ds_read_b64_tr_b16 a[104:105], v16 offset:25472
v_mfma_f32_16x16x32_bf16 v[144:147], a[28:31], a[128:131], 0
buffer_load_dwordx4 v13, s[32:35], s54 offen offset:1056 lds
v_mfma_f32_16x16x32_bf16 v[148:151], a[28:31], a[132:135], 0
v_mfma_f32_16x16x32_bf16 v[24:27], v[20:23], a[200:203], v[24:27]
ds_read_b64_tr_b16 a[106:107], v16 offset:25984
v_mfma_f32_16x16x32_bf16 v[152:155], a[28:31], a[136:139], 0
ds_read_b64_tr_b16 a[108:109], v16 offset:25504
v_mfma_f32_16x16x32_bf16 v[156:159], a[28:31], a[140:143], 0
buffer_load_dwordx4 a[180:183], v10, s[16:19], s52 offen offset:1024 sc1
v_mfma_f32_16x16x32_bf16 v[160:163], a[32:35], a[128:131], 0
ds_read_b64_tr_b16 a[110:111], v16 offset:26016
v_mfma_f32_16x16x32_bf16 v[164:167], a[32:35], a[132:135], 0
ds_read_b64_tr_b16 a[112:113], v17 offset:16896
v_mfma_f32_16x16x32_bf16 v[168:171], a[32:35], a[136:139], 0
ds_read_b64_tr_b16 a[114:115], v17 offset:17408
v_mfma_f32_16x16x32_bf16 v[172:175], a[32:35], a[140:143], 0
v_mfma_f32_16x16x32_bf16 v[176:179], a[36:39], a[128:131], 0
buffer_load_dwordx4 v14, s[32:35], s54 offen offset:2112 lds
v_mfma_f32_16x16x32_bf16 v[180:183], a[36:39], a[132:135], 0
ds_read_b64_tr_b16 a[116:117], v17 offset:16928
v_mfma_f32_16x16x32_bf16 v[184:187], a[36:39], a[136:139], 0
ds_read_b64_tr_b16 a[118:119], v17 offset:17440
v_mfma_f32_16x16x32_bf16 v[188:191], a[36:39], a[140:143], 0
ds_read_b64_tr_b16 a[120:121], v17 offset:25344
v_mfma_f32_16x16x32_bf16 v[192:195], a[40:43], a[128:131], 0
ds_read_b64_tr_b16 a[122:123], v17 offset:25856
v_mfma_f32_16x16x32_bf16 v[196:199], a[40:43], a[132:135], 0
buffer_load_dwordx4 a[184:187], v11, s[16:19], s52 offen sc1
v_mfma_f32_16x16x32_bf16 v[24:27], v[20:23], a[204:207], v[24:27]
ds_read_b64_tr_b16 a[124:125], v17 offset:25376
v_mfma_f32_16x16x32_bf16 v[200:203], a[40:43], a[136:139], 0
v_mfma_f32_16x16x32_bf16 v[204:207], a[40:43], a[140:143], 0
ds_read_b64_tr_b16 a[126:127], v17 offset:25888
v_mfma_f32_16x16x32_bf16 v[208:211], a[44:47], a[128:131], 0
ds_read_b128 a[208:211], v9 offset:16896
v_mfma_f32_16x16x32_bf16 v[212:215], a[44:47], a[132:135], 0
buffer_load_dwordx4 v15, s[32:35], s54 offen offset:3168 lds
v_mfma_f32_16x16x32_bf16 v[216:219], a[44:47], a[136:139], 0
ds_read_b128 a[212:215], v9 offset:17952
s_add_u32 s54, s54, 229376
v_mfma_f32_16x16x32_bf16 v[220:223], a[44:47], a[140:143], 0
ds_read_b128 a[216:219], v9 offset:19008
v_mfma_f32_16x16x32_bf16 v[224:227], a[48:51], a[128:131], 0
ds_read_b128 a[220:223], v9 offset:20064
v_mfma_f32_16x16x32_bf16 v[228:231], a[48:51], a[132:135], 0
v_mfma_f32_16x16x32_bf16 v[232:235], a[52:55], a[128:131], 0
buffer_load_dwordx4 a[188:191], v11, s[16:19], s52 offen offset:1024 sc1
v_mfma_f32_16x16x32_bf16 v[236:239], a[52:55], a[132:135], 0
s_add_u32 s52, s52, 0x20000
v_mfma_f32_16x16x32_bf16 v[240:243], a[56:59], a[128:131], 0
v_mfma_f32_16x16x32_bf16 v[244:247], a[56:59], a[132:135], 0
v_mfma_f32_16x16x32_bf16 v[248:251], a[60:63], a[128:131], 0
v_mfma_f32_16x16x32_bf16 v[252:255], a[60:63], a[132:135], 0
s_waitcnt lgkmcnt(0)
s_barrier
s_waitcnt vmcnt(19)
v_mfma_f32_16x16x32_bf16 v[32:35], a[64:67], a[144:147], v[32:35]
s_add_u32 m0, s74, 0
s_mov_b32 s67, 29622272
s_waitcnt vmcnt(18)
v_mfma_f32_16x16x32_bf16 v[36:39], a[64:67], a[148:151], v[36:39]
buffer_load_dwordx4 v4, s[16:19], s67 offen sc1 lds
s_waitcnt vmcnt(18)
v_mfma_f32_16x16x32_bf16 v[40:43], a[64:67], a[152:155], v[40:43]
ds_read_b64_tr_b16 a[0:1], v16 offset:33792
s_waitcnt vmcnt(17)
v_mfma_f32_16x16x32_bf16 v[44:47], a[64:67], a[156:159], v[44:47]
ds_read_b64_tr_b16 a[2:3], v16 offset:34304
v_mfma_f32_16x16x32_bf16 v[48:51], a[68:71], a[144:147], v[48:51]
buffer_load_dwordx4 v4, s[16:19], s67 offen offset:1024 sc1 lds
v_mfma_f32_16x16x32_bf16 v[52:55], a[68:71], a[148:151], v[52:55]
ds_read_b64_tr_b16 a[4:5], v16 offset:33824
v_mfma_f32_16x16x32_bf16 v[24:27], v[20:23], a[208:211], v[24:27]
ds_read_b64_tr_b16 a[6:7], v16 offset:34336
v_mfma_f32_16x16x32_bf16 v[56:59], a[68:71], a[152:155], v[56:59]
ds_read_b64_tr_b16 a[8:9], v16 offset:42240
v_mfma_f32_16x16x32_bf16 v[60:63], a[68:71], a[156:159], v[60:63]
buffer_load_dwordx4 v4, s[16:19], s67 offen offset:2048 sc1 lds
v_mfma_f32_16x16x32_bf16 v[64:67], a[72:75], a[144:147], v[64:67]
ds_read_b64_tr_b16 a[10:11], v16 offset:42752
v_mfma_f32_16x16x32_bf16 v[68:71], a[72:75], a[148:151], v[68:71]
ds_read_b64_tr_b16 a[12:13], v16 offset:42272
v_mfma_f32_16x16x32_bf16 v[72:75], a[72:75], a[152:155], v[72:75]
buffer_load_dwordx4 v4, s[16:19], s67 offen offset:3072 sc1 lds
v_mfma_f32_16x16x32_bf16 v[76:79], a[72:75], a[156:159], v[76:79]
ds_read_b64_tr_b16 a[14:15], v16 offset:42784
v_mfma_f32_16x16x32_bf16 v[80:83], a[76:79], a[144:147], v[80:83]
ds_read_b64_tr_b16 a[16:17], v16 offset:33856
v_mfma_f32_16x16x32_bf16 v[84:87], a[76:79], a[148:151], v[84:87]
s_add_u32 m0, s74, 4096
s_mov_b32 s67, 29626368
v_mfma_f32_16x16x32_bf16 v[88:91], a[76:79], a[152:155], v[88:91]
buffer_load_dwordx4 v4, s[16:19], s67 offen sc1 lds
v_mfma_f32_16x16x32_bf16 v[92:95], a[76:79], a[156:159], v[92:95]
ds_read_b64_tr_b16 a[18:19], v16 offset:34368
v_mfma_f32_16x16x32_bf16 v[96:99], a[80:83], a[144:147], v[96:99]
ds_read_b64_tr_b16 a[20:21], v16 offset:33888
v_mfma_f32_16x16x32_bf16 v[100:103], a[80:83], a[148:151], v[100:103]
ds_read_b64_tr_b16 a[22:23], v16 offset:34400
v_mfma_f32_16x16x32_bf16 v[24:27], v[20:23], a[212:215], v[24:27]
buffer_load_dwordx4 v4, s[16:19], s67 offen offset:1024 sc1 lds
v_mfma_f32_16x16x32_bf16 v[104:107], a[80:83], a[152:155], v[104:107]
ds_read_b64_tr_b16 a[24:25], v16 offset:42304
v_mfma_f32_16x16x32_bf16 v[108:111], a[80:83], a[156:159], v[108:111]
ds_read_b64_tr_b16 a[26:27], v16 offset:42816
v_mfma_f32_16x16x32_bf16 v[112:115], a[84:87], a[144:147], v[112:115]
buffer_load_dwordx4 v4, s[16:19], s67 offen offset:2048 sc1 lds
v_mfma_f32_16x16x32_bf16 v[116:119], a[84:87], a[148:151], v[116:119]
ds_read_b64_tr_b16 a[28:29], v16 offset:42336
v_mfma_f32_16x16x32_bf16 v[120:123], a[84:87], a[152:155], v[120:123]
ds_read_b64_tr_b16 a[30:31], v16 offset:42848
v_mfma_f32_16x16x32_bf16 v[124:127], a[84:87], a[156:159], v[124:127]
ds_read_b64_tr_b16 a[32:33], v16 offset:33920
v_mfma_f32_16x16x32_bf16 v[128:131], a[88:91], a[144:147], v[128:131]
buffer_load_dwordx4 v4, s[16:19], s67 offen offset:3072 sc1 lds
v_mfma_f32_16x16x32_bf16 v[132:135], a[88:91], a[148:151], v[132:135]
ds_read_b64_tr_b16 a[34:35], v16 offset:34432
v_mfma_f32_16x16x32_bf16 v[136:139], a[88:91], a[152:155], v[136:139]
v_mfma_f32_16x16x32_bf16 v[140:143], a[88:91], a[156:159], v[140:143]
ds_read_b64_tr_b16 a[36:37], v16 offset:33952
s_add_u32 m0, s55, 101376
v_mfma_f32_16x16x32_bf16 v[144:147], a[92:95], a[144:147], v[144:147]
buffer_load_dwordx4 v12, s[32:35], s54 offen lds
v_mfma_f32_16x16x32_bf16 v[148:151], a[92:95], a[148:151], v[148:151]
ds_read_b64_tr_b16 a[38:39], v16 offset:34464
v_mfma_f32_16x16x32_bf16 v[24:27], v[20:23], a[216:219], v[24:27]
ds_read_b64_tr_b16 a[40:41], v16 offset:42368
v_mfma_f32_16x16x32_bf16 v[152:155], a[92:95], a[152:155], v[152:155]
buffer_load_dwordx4 a[128:131], v10, s[16:19], s52 offen sc1
v_mfma_f32_16x16x32_bf16 v[156:159], a[92:95], a[156:159], v[156:159]
ds_read_b64_tr_b16 a[42:43], v16 offset:42880
v_mfma_f32_16x16x32_bf16 v[160:163], a[96:99], a[144:147], v[160:163]
ds_read_b64_tr_b16 a[44:45], v16 offset:42400
v_mfma_f32_16x16x32_bf16 v[164:167], a[96:99], a[148:151], v[164:167]
ds_read_b64_tr_b16 a[46:47], v16 offset:42912
v_mfma_f32_16x16x32_bf16 v[168:171], a[96:99], a[152:155], v[168:171]
buffer_load_dwordx4 v13, s[32:35], s54 offen offset:1056 lds
v_mfma_f32_16x16x32_bf16 v[172:175], a[96:99], a[156:159], v[172:175]
ds_read_b64_tr_b16 a[48:49], v17 offset:33792
v_mfma_f32_16x16x32_bf16 v[176:179], a[100:103], a[144:147], v[176:179]
ds_read_b64_tr_b16 a[50:51], v17 offset:34304
v_mfma_f32_16x16x32_bf16 v[180:183], a[100:103], a[148:151], v[180:183]
buffer_load_dwordx4 a[132:135], v10, s[16:19], s52 offen offset:1024 sc1
v_mfma_f32_16x16x32_bf16 v[184:187], a[100:103], a[152:155], v[184:187]
ds_read_b64_tr_b16 a[52:53], v17 offset:33824
v_mfma_f32_16x16x32_bf16 v[188:191], a[100:103], a[156:159], v[188:191]
ds_read_b64_tr_b16 a[54:55], v17 offset:34336
v_mfma_f32_16x16x32_bf16 v[192:195], a[104:107], a[144:147], v[192:195]
ds_read_b64_tr_b16 a[56:57], v17 offset:42240
v_mfma_f32_16x16x32_bf16 v[196:199], a[104:107], a[148:151], v[196:199]
buffer_load_dwordx4 v14, s[32:35], s54 offen offset:2112 lds
v_mfma_f32_16x16x32_bf16 v[24:27], v[20:23], a[220:223], v[24:27]
ds_read_b64_tr_b16 a[58:59], v17 offset:42752
v_mfma_f32_16x16x32_bf16 v[200:203], a[104:107], a[152:155], v[200:203]
ds_read_b64_tr_b16 a[60:61], v17 offset:42272
v_mfma_f32_16x16x32_bf16 v[204:207], a[104:107], a[156:159], v[204:207]
ds_read_b64_tr_b16 a[62:63], v17 offset:42784
v_mfma_f32_16x16x32_bf16 v[208:211], a[108:111], a[144:147], v[208:211]
buffer_load_dwordx4 a[136:139], v11, s[16:19], s52 offen sc1
v_mfma_f32_16x16x32_bf16 v[212:215], a[108:111], a[148:151], v[212:215]
ds_read_b128 a[192:195], v9 offset:33792
v_mfma_f32_16x16x32_bf16 v[216:219], a[108:111], a[152:155], v[216:219]
ds_read_b128 a[196:199], v9 offset:34848
v_mfma_f32_16x16x32_bf16 v[220:223], a[108:111], a[156:159], v[220:223]
buffer_load_dwordx4 v15, s[32:35], s54 offen offset:3168 lds
v_mfma_f32_16x16x32_bf16 v[224:227], a[112:115], a[144:147], v[224:227]
.Lpad11:
s_cbranch_execz .Lpad14
ds_read_b128 a[200:203], v9 offset:35904
s_add_u32 s54, s54, 229376
v_mfma_f32_16x16x32_bf16 v[228:231], a[112:115], a[148:151], v[228:231]
ds_read_b128 a[204:207], v9 offset:36960
v_mfma_f32_16x16x32_bf16 v[232:235], a[116:119], a[144:147], v[232:235]
v_mfma_f32_16x16x32_bf16 v[236:239], a[116:119], a[148:151], v[236:239]
buffer_load_dwordx4 a[140:143], v11, s[16:19], s52 offen offset:1024 sc1
v_mfma_f32_16x16x32_bf16 v[240:243], a[120:123], a[144:147], v[240:243]
s_add_u32 s52, s52, 0x20000
v_mfma_f32_16x16x32_bf16 v[244:247], a[120:123], a[148:151], v[244:247]
v_mfma_f32_16x16x32_bf16 v[248:251], a[124:127], a[144:147], v[248:251]
v_mfma_f32_16x16x32_bf16 v[252:255], a[124:127], a[148:151], v[252:255]
s_waitcnt vmcnt(28) lgkmcnt(0)
s_barrier
s_waitcnt vmcnt(27)
v_mfma_f32_16x16x32_bf16 v[32:35], a[0:3], a[160:163], v[32:35]
ds_read_b64_tr_b16 a[64:65], v16 offset:50688
s_add_u32 m0, s55, 118272
s_waitcnt vmcnt(26)
v_mfma_f32_16x16x32_bf16 v[36:39], a[0:3], a[164:167], v[36:39]
buffer_load_dwordx4 v12, s[32:35], s54 offen lds
s_waitcnt vmcnt(26)
v_mfma_f32_16x16x32_bf16 v[40:43], a[0:3], a[168:171], v[40:43]
ds_read_b64_tr_b16 a[66:67], v16 offset:51200
s_waitcnt vmcnt(25)
v_mfma_f32_16x16x32_bf16 v[44:47], a[0:3], a[172:175], v[44:47]
ds_read_b64_tr_b16 a[68:69], v16 offset:50720
v_mfma_f32_16x16x32_bf16 v[48:51], a[4:7], a[160:163], v[48:51]
ds_read_b64_tr_b16 a[70:71], v16 offset:51232
v_mfma_f32_16x16x32_bf16 v[52:55], a[4:7], a[164:167], v[52:55]
v_mfma_f32_16x16x32_bf16 v[24:27], v[20:23], a[192:195], v[24:27]
ds_read_b64_tr_b16 a[72:73], v16 offset:59136
v_mfma_f32_16x16x32_bf16 v[56:59], a[4:7], a[168:171], v[56:59]
ds_read_b64_tr_b16 a[74:75], v16 offset:59648
v_mfma_f32_16x16x32_bf16 v[60:63], a[4:7], a[172:175], v[60:63]
buffer_load_dwordx4 a[144:147], v10, s[16:19], s52 offen sc1
v_mfma_f32_16x16x32_bf16 v[64:67], a[8:11], a[160:163], v[64:67]
ds_read_b64_tr_b16 a[76:77], v16 offset:59168
v_mfma_f32_16x16x32_bf16 v[68:71], a[8:11], a[164:167], v[68:71]
v_mfma_f32_16x16x32_bf16 v[72:75], a[8:11], a[168:171], v[72:75]
ds_read_b64_tr_b16 a[78:79], v16 offset:59680
v_mfma_f32_16x16x32_bf16 v[76:79], a[8:11], a[172:175], v[76:79]
ds_read_b64_tr_b16 a[80:81], v16 offset:50752
v_lshrrev_b32 v2, 1, v2
v_mfma_f32_16x16x32_bf16 v[80:83], a[12:15], a[160:163], v[80:83]
ds_read_b64_tr_b16 a[82:83], v16 offset:51264
v_mfma_f32_16x16x32_bf16 v[84:87], a[12:15], a[164:167], v[84:87]
s_lshr_b32 s67, s74, 1
v_mfma_f32_16x16x32_bf16 v[88:91], a[12:15], a[168:171], v[88:91]
buffer_load_dwordx4 v13, s[32:35], s54 offen offset:1056 lds
v_mfma_f32_16x16x32_bf16 v[92:95], a[12:15], a[172:175], v[92:95]
ds_read_b64_tr_b16 a[84:85], v16 offset:50784
v_add_u32 v2, s67, v2
v_mfma_f32_16x16x32_bf16 v[96:99], a[16:19], a[160:163], v[96:99]
ds_read_b64_tr_b16 a[86:87], v16 offset:51296
v_mfma_f32_16x16x32_bf16 v[100:103], a[16:19], a[164:167], v[100:103]
ds_read_b64_tr_b16 a[88:89], v16 offset:59200
s_waitcnt vmcnt(11)
ds_read_b64 v[28:29], v2
v_mfma_f32_16x16x32_bf16 v[24:27], v[20:23], a[196:199], v[24:27]
ds_read_b64_tr_b16 a[90:91], v16 offset:59712
v_mfma_f32_16x16x32_bf16 v[104:107], a[16:19], a[168:171], v[104:107]
ds_read_b64 v[30:31], v2 offset:512
v_mfma_f32_16x16x32_bf16 v[108:111], a[16:19], a[172:175], v[108:111]
ds_read_b64_tr_b16 a[92:93], v16 offset:59232
v_mfma_f32_16x16x32_bf16 v[112:115], a[20:23], a[160:163], v[112:115]
buffer_load_dwordx4 a[148:151], v10, s[16:19], s52 offen offset:1024 sc1
v_mfma_f32_16x16x32_bf16 v[116:119], a[20:23], a[164:167], v[116:119]
ds_read_b64_tr_b16 a[94:95], v16 offset:59744
ds_read_b64 v[18:19], v2 offset:1024
v_mfma_f32_16x16x32_bf16 v[120:123], a[20:23], a[168:171], v[120:123]
ds_read_b64_tr_b16 a[96:97], v16 offset:50816
v_mfma_f32_16x16x32_bf16 v[124:127], a[20:23], a[172:175], v[124:127]
s_waitcnt lgkmcnt(4)
v_add_f32 v28, v28, v30
v_mfma_f32_16x16x32_bf16 v[128:131], a[24:27], a[160:163], v[128:131]
ds_read_b64_tr_b16 a[98:99], v16 offset:51328
v_add_f32 v29, v29, v31
v_mfma_f32_16x16x32_bf16 v[132:135], a[24:27], a[164:167], v[132:135]
ds_read_b64_tr_b16 a[100:101], v16 offset:50848
v_mfma_f32_16x16x32_bf16 v[136:139], a[24:27], a[168:171], v[136:139]
ds_read_b64_tr_b16 a[102:103], v16 offset:51360
ds_read_b64 v[30:31], v2 offset:1536
v_mfma_f32_16x16x32_bf16 v[140:143], a[24:27], a[172:175], v[140:143]
s_waitcnt lgkmcnt(5)
v_add_f32 v28, v28, v18
v_mfma_f32_16x16x32_bf16 v[144:147], a[28:31], a[160:163], v[144:147]
buffer_load_dwordx4 v14, s[32:35], s54 offen offset:2112 lds
v_mfma_f32_16x16x32_bf16 v[148:151], a[28:31], a[164:167], v[148:151]
ds_read_b64_tr_b16 a[104:105], v16 offset:59264
v_mfma_f32_16x16x32_bf16 v[24:27], v[20:23], a[200:203], v[24:27]
ds_read_b64_tr_b16 a[106:107], v16 offset:59776
v_mfma_f32_16x16x32_bf16 v[152:155], a[28:31], a[168:171], v[152:155]
ds_read_b64_tr_b16 a[108:109], v16 offset:59296
v_add_f32 v29, v29, v19
v_mfma_f32_16x16x32_bf16 v[156:159], a[28:31], a[172:175], v[156:159]
ds_read_b64 v[18:19], v2 offset:2048
v_mfma_f32_16x16x32_bf16 v[160:163], a[32:35], a[160:163], v[160:163]
ds_read_b64_tr_b16 a[110:111], v16 offset:59808
v_mfma_f32_16x16x32_bf16 v[164:167], a[32:35], a[164:167], v[164:167]
ds_read_b64_tr_b16 a[112:113], v17 offset:50688
s_waitcnt lgkmcnt(6)
v_add_f32 v28, v28, v30
v_mfma_f32_16x16x32_bf16 v[168:171], a[32:35], a[168:171], v[168:171]
buffer_load_dwordx4 a[152:155], v11, s[16:19], s52 offen sc1
v_mfma_f32_16x16x32_bf16 v[172:175], a[32:35], a[172:175], v[172:175]
ds_read_b64_tr_b16 a[114:115], v17 offset:51200
v_mfma_f32_16x16x32_bf16 v[176:179], a[36:39], a[160:163], v[176:179]
ds_read_b64_tr_b16 a[116:117], v17 offset:50720
v_add_f32 v29, v29, v31
v_mfma_f32_16x16x32_bf16 v[180:183], a[36:39], a[164:167], v[180:183]
ds_read_b64 v[30:31], v2 offset:2560
v_mfma_f32_16x16x32_bf16 v[184:187], a[36:39], a[168:171], v[184:187]
ds_read_b64_tr_b16 a[118:119], v17 offset:51232
v_mfma_f32_16x16x32_bf16 v[188:191], a[36:39], a[172:175], v[188:191]
ds_read_b64_tr_b16 a[120:121], v17 offset:59136
v_mfma_f32_16x16x32_bf16 v[192:195], a[40:43], a[160:163], v[192:195]
ds_read_b64_tr_b16 a[122:123], v17 offset:59648
s_waitcnt lgkmcnt(8)
v_add_f32 v28, v28, v18
v_mfma_f32_16x16x32_bf16 v[196:199], a[40:43], a[164:167], v[196:199]
buffer_load_dwordx4 v15, s[32:35], s54 offen offset:3168 lds
v_mfma_f32_16x16x32_bf16 v[24:27], v[20:23], a[204:207], v[24:27]
s_add_u32 s54, s54, 229376
v_add_f32 v29, v29, v19
v_mfma_f32_16x16x32_bf16 v[200:203], a[40:43], a[168:171], v[200:203]
ds_read_b64_tr_b16 a[124:125], v17 offset:59168
v_mfma_f32_16x16x32_bf16 v[204:207], a[40:43], a[172:175], v[204:207]
ds_read_b64_tr_b16 a[126:127], v17 offset:59680
ds_read_b64 v[18:19], v2 offset:3072
v_mfma_f32_16x16x32_bf16 v[208:211], a[44:47], a[160:163], v[208:211]
ds_read_b128 a[208:211], v9 offset:50688
v_mfma_f32_16x16x32_bf16 v[212:215], a[44:47], a[164:167], v[212:215]
s_waitcnt lgkmcnt(7)
v_add_f32 v28, v28, v30
v_mfma_f32_16x16x32_bf16 v[216:219], a[44:47], a[168:171], v[216:219]
ds_read_b128 a[212:215], v9 offset:51744
v_add_f32 v29, v29, v31
v_mfma_f32_16x16x32_bf16 v[220:223], a[44:47], a[172:175], v[220:223]
buffer_load_dwordx4 a[156:159], v11, s[16:19], s52 offen offset:1024 sc1
v_mfma_f32_16x16x32_bf16 v[224:227], a[48:51], a[160:163], v[224:227]
ds_read_b128 a[216:219], v9 offset:52800
s_add_u32 s52, s52, 0x20000
v_mfma_f32_16x16x32_bf16 v[228:231], a[48:51], a[164:167], v[228:231]
ds_read_b128 a[220:223], v9 offset:53856
v_mfma_f32_16x16x32_bf16 v[232:235], a[52:55], a[160:163], v[232:235]
ds_read_b64 v[30:31], v2 offset:3584
v_mfma_f32_16x16x32_bf16 v[236:239], a[52:55], a[164:167], v[236:239]
s_waitcnt lgkmcnt(5)
v_add_f32 v28, v28, v18
v_mfma_f32_16x16x32_bf16 v[240:243], a[56:59], a[160:163], v[240:243]
v_add_f32 v29, v29, v19
v_mfma_f32_16x16x32_bf16 v[244:247], a[56:59], a[164:167], v[244:247]
ds_read_b64 v[18:19], v2 offset:4096
v_mfma_f32_16x16x32_bf16 v[248:251], a[60:63], a[160:163], v[248:251]
v_mfma_f32_16x16x32_bf16 v[252:255], a[60:63], a[164:167], v[252:255]
s_waitcnt lgkmcnt(0)
s_barrier
v_mfma_f32_16x16x32_bf16 v[32:35], a[64:67], a[176:179], v[32:35]
ds_read_b64_tr_b16 a[0:1], v16
s_add_u32 m0, s55, 135168
v_mfma_f32_16x16x32_bf16 v[36:39], a[64:67], a[180:183], v[36:39]
buffer_load_dwordx4 v12, s[32:35], s54 offen lds
v_mfma_f32_16x16x32_bf16 v[40:43], a[64:67], a[184:187], v[40:43]
ds_read_b64_tr_b16 a[2:3], v16 offset:512
v_add_f32 v28, v28, v30
v_mfma_f32_16x16x32_bf16 v[44:47], a[64:67], a[188:191], v[44:47]
ds_read_b64_tr_b16 a[4:5], v16 offset:32
v_add_f32 v29, v29, v31
v_mfma_f32_16x16x32_bf16 v[48:51], a[68:71], a[176:179], v[48:51]
ds_read_b64_tr_b16 a[6:7], v16 offset:544
v_mfma_f32_16x16x32_bf16 v[52:55], a[68:71], a[180:183], v[52:55]
ds_read_b64 v[30:31], v2 offset:4608
v_mfma_f32_16x16x32_bf16 v[24:27], v[20:23], a[208:211], v[24:27]
ds_read_b64_tr_b16 a[8:9], v16 offset:8448
v_add_f32 v28, v28, v18
v_mfma_f32_16x16x32_bf16 v[56:59], a[68:71], a[184:187], v[56:59]
ds_read_b64_tr_b16 a[10:11], v16 offset:8960
v_mfma_f32_16x16x32_bf16 v[60:63], a[68:71], a[188:191], v[60:63]
buffer_load_dwordx4 a[160:163], v10, s[16:19], s52 offen sc1
v_mfma_f32_16x16x32_bf16 v[64:67], a[72:75], a[176:179], v[64:67]
ds_read_b64_tr_b16 a[12:13], v16 offset:8480
v_add_f32 v29, v29, v19
v_mfma_f32_16x16x32_bf16 v[68:71], a[72:75], a[180:183], v[68:71]
ds_read_b64 v[18:19], v2 offset:5120
v_mfma_f32_16x16x32_bf16 v[72:75], a[72:75], a[184:187], v[72:75]
ds_read_b64_tr_b16 a[14:15], v16 offset:8992
s_waitcnt lgkmcnt(5)
v_add_f32 v28, v28, v30
v_mfma_f32_16x16x32_bf16 v[76:79], a[72:75], a[188:191], v[76:79]
ds_read_b64_tr_b16 a[16:17], v16 offset:64
v_mfma_f32_16x16x32_bf16 v[80:83], a[76:79], a[176:179], v[80:83]
ds_read_b64_tr_b16 a[18:19], v16 offset:576
v_add_f32 v29, v29, v31
v_mfma_f32_16x16x32_bf16 v[84:87], a[76:79], a[180:183], v[84:87]
ds_read_b64 v[30:31], v2 offset:5632
v_mfma_f32_16x16x32_bf16 v[88:91], a[76:79], a[184:187], v[88:91]
buffer_load_dwordx4 v13, s[32:35], s54 offen offset:1056 lds
v_mfma_f32_16x16x32_bf16 v[92:95], a[76:79], a[188:191], v[92:95]
ds_read_b64_tr_b16 a[20:21], v16 offset:96
v_mfma_f32_16x16x32_bf16 v[96:99], a[80:83], a[176:179], v[96:99]
ds_read_b64_tr_b16 a[22:23], v16 offset:608
s_waitcnt lgkmcnt(6)
v_add_f32 v28, v28, v18
v_mfma_f32_16x16x32_bf16 v[100:103], a[80:83], a[180:183], v[100:103]
ds_read_b64_tr_b16 a[24:25], v16 offset:8512
v_mfma_f32_16x16x32_bf16 v[24:27], v[20:23], a[212:215], v[24:27]
ds_read_b64_tr_b16 a[26:27], v16 offset:9024
v_add_f32 v29, v29, v19
v_mfma_f32_16x16x32_bf16 v[104:107], a[80:83], a[184:187], v[104:107]
ds_read_b64 v[18:19], v2 offset:6144
v_mfma_f32_16x16x32_bf16 v[108:111], a[80:83], a[188:191], v[108:111]
ds_read_b64_tr_b16 a[28:29], v16 offset:8544
s_waitcnt lgkmcnt(6)
v_add_f32 v28, v28, v30
v_mfma_f32_16x16x32_bf16 v[112:115], a[84:87], a[176:179], v[112:115]
buffer_load_dwordx4 a[164:167], v10, s[16:19], s52 offen offset:1024 sc1
v_mfma_f32_16x16x32_bf16 v[116:119], a[84:87], a[180:183], v[116:119]
ds_read_b64_tr_b16 a[30:31], v16 offset:9056
v_mfma_f32_16x16x32_bf16 v[120:123], a[84:87], a[184:187], v[120:123]
ds_read_b64_tr_b16 a[32:33], v16 offset:128
v_add_f32 v29, v29, v31
v_mfma_f32_16x16x32_bf16 v[124:127], a[84:87], a[188:191], v[124:127]
ds_read_b64 v[30:31], v2 offset:6656
v_mfma_f32_16x16x32_bf16 v[128:131], a[88:91], a[176:179], v[128:131]
ds_read_b64_tr_b16 a[34:35], v16 offset:640
v_mfma_f32_16x16x32_bf16 v[132:135], a[88:91], a[180:183], v[132:135]
ds_read_b64_tr_b16 a[36:37], v16 offset:160
s_waitcnt lgkmcnt(6)
v_add_f32 v28, v28, v18
v_mfma_f32_16x16x32_bf16 v[136:139], a[88:91], a[184:187], v[136:139]
ds_read_b64_tr_b16 a[38:39], v16 offset:672
v_mfma_f32_16x16x32_bf16 v[140:143], a[88:91], a[188:191], v[140:143]
v_add_f32 v29, v29, v19
v_mfma_f32_16x16x32_bf16 v[144:147], a[92:95], a[176:179], v[144:147]
buffer_load_dwordx4 v14, s[32:35], s54 offen offset:2112 lds
v_mfma_f32_16x16x32_bf16 v[148:151], a[92:95], a[180:183], v[148:151]
ds_read_b64_tr_b16 a[40:41], v16 offset:8576
ds_read_b64 v[18:19], v2 offset:7168
v_mfma_f32_16x16x32_bf16 v[24:27], v[20:23], a[216:219], v[24:27]
ds_read_b64_tr_b16 a[42:43], v16 offset:9088
s_waitcnt lgkmcnt(6)
v_add_f32 v28, v28, v30
v_mfma_f32_16x16x32_bf16 v[152:155], a[92:95], a[184:187], v[152:155]
ds_read_b64_tr_b16 a[44:45], v16 offset:8608
v_mfma_f32_16x16x32_bf16 v[156:159], a[92:95], a[188:191], v[156:159]
v_add_f32 v29, v29, v31
v_mfma_f32_16x16x32_bf16 v[160:163], a[96:99], a[176:179], v[160:163]
ds_read_b64_tr_b16 a[46:47], v16 offset:9120
ds_read_b64 v[30:31], v2 offset:7680
v_mfma_f32_16x16x32_bf16 v[164:167], a[96:99], a[180:183], v[164:167]
ds_read_b64_tr_b16 a[48:49], v17
v_mfma_f32_16x16x32_bf16 v[168:171], a[96:99], a[184:187], v[168:171]
buffer_load_dwordx4 a[168:171], v11, s[16:19], s52 offen sc1
v_mfma_f32_16x16x32_bf16 v[172:175], a[96:99], a[188:191], v[172:175]
ds_read_b64_tr_b16 a[50:51], v17 offset:512
s_waitcnt lgkmcnt(6)
v_add_f32 v28, v28, v18
v_mfma_f32_16x16x32_bf16 v[176:179], a[100:103], a[176:179], v[176:179]
ds_read_b64_tr_b16 a[52:53], v17 offset:32
v_mfma_f32_16x16x32_bf16 v[180:183], a[100:103], a[180:183], v[180:183]
v_add_f32 v29, v29, v19
v_mfma_f32_16x16x32_bf16 v[184:187], a[100:103], a[184:187], v[184:187]
ds_read_b64_tr_b16 a[54:55], v17 offset:544
s_waitcnt lgkmcnt(4)
v_add_f32 v28, v28, v30
v_mfma_f32_16x16x32_bf16 v[188:191], a[100:103], a[188:191], v[188:191]
ds_read_b64_tr_b16 a[56:57], v17 offset:8448
v_add_f32 v29, v29, v31
v_mfma_f32_16x16x32_bf16 v[192:195], a[104:107], a[176:179], v[192:195]
ds_read_b64_tr_b16 a[58:59], v17 offset:8960
v_mfma_f32_16x16x32_bf16 v[196:199], a[104:107], a[180:183], v[196:199]
buffer_load_dwordx4 v15, s[32:35], s54 offen offset:3168 lds
v_mfma_f32_16x16x32_bf16 v[24:27], v[20:23], a[220:223], v[24:27]
s_add_u32 s54, s54, 229376
v_mul_f32 v28, 0xba800000, v28
v_mfma_f32_16x16x32_bf16 v[200:203], a[104:107], a[184:187], v[200:203]
ds_read_b64_tr_b16 a[60:61], v17 offset:8480
v_mul_f32 v29, 0x3a800000, v29
v_mfma_f32_16x16x32_bf16 v[204:207], a[104:107], a[188:191], v[204:207]
ds_read_b64_tr_b16 a[62:63], v17 offset:8992
v_mfma_f32_16x16x32_bf16 v[208:211], a[108:111], a[176:179], v[208:211]
ds_read_b128 a[192:195], v9
v_fma_f32 v29, -v28, v28, v29
v_mfma_f32_16x16x32_bf16 v[212:215], a[108:111], a[180:183], v[212:215]
v_max_f32 v29, 0, v29
v_mfma_f32_16x16x32_bf16 v[216:219], a[108:111], a[184:187], v[216:219]
ds_read_b128 a[196:199], v9 offset:1056
v_mfma_f32_16x16x32_bf16 v[220:223], a[108:111], a[188:191], v[220:223]
buffer_load_dwordx4 a[172:175], v11, s[16:19], s52 offen offset:1024 sc1
v_mfma_f32_16x16x32_bf16 v[224:227], a[112:115], a[176:179], v[224:227]
ds_read_b128 a[200:203], v9 offset:2112
s_add_u32 s52, s52, 0x20000
v_mfma_f32_16x16x32_bf16 v[228:231], a[112:115], a[180:183], v[228:231]
ds_read_b128 a[204:207], v9 offset:3168
v_add_f32 v29, 0x3727c5ac, v29
v_mfma_f32_16x16x32_bf16 v[232:235], a[116:119], a[176:179], v[232:235]
v_rsq_f32 v30, v29
v_mfma_f32_16x16x32_bf16 v[236:239], a[116:119], a[180:183], v[236:239]
v_lshlrev_b32 v18, 4, v0
v_mfma_f32_16x16x32_bf16 v[240:243], a[120:123], a[176:179], v[240:243]
v_add_u32 v18, 152576, v18
v_mfma_f32_16x16x32_bf16 v[244:247], a[120:123], a[180:183], v[244:247]
v_mul_f32 v30, 0xbfb8aa3b, v30
v_mfma_f32_16x16x32_bf16 v[248:251], a[124:127], a[176:179], v[248:251]
ds_write_b128 v18, v[28:31]
v_mfma_f32_16x16x32_bf16 v[252:255], a[124:127], a[180:183], v[252:255]
s_mov_b32 s58, -131072
s_sub_u32 s67, s59, 16896
s_mov_b32 s15, -6
.p2align 6
.Lk30:
s_waitcnt vmcnt(17) lgkmcnt(0)
s_barrier
v_mfma_f32_16x16x32_bf16 v[32:35], a[0:3], a[128:131], v[32:35]
ds_read_b64_tr_b16 a[64:65], v16 offset:16896
s_add_u32 m0, s55, 84480
v_mfma_f32_16x16x32_bf16 v[36:39], a[0:3], a[132:135], v[36:39]
buffer_load_dwordx4 v12, s[32:35], s54 offen lds
v_mfma_f32_16x16x32_bf16 v[40:43], a[0:3], a[136:139], v[40:43]
s_sub_u32 s47, s47, 1
s_cbranch_scc1 .Lx31
.Lx31b:
s_waitcnt vmcnt(17)
v_mfma_f32_16x16x32_bf16 v[44:47], a[0:3], a[140:143], v[44:47]
ds_read_b64_tr_b16 a[66:67], v16 offset:17408
v_mfma_f32_16x16x32_bf16 v[48:51], a[4:7], a[128:131], v[48:51]
ds_read_b64_tr_b16 a[68:69], v16 offset:16928
v_mfma_f32_16x16x32_bf16 v[52:55], a[4:7], a[132:135], v[52:55]
ds_read_b64_tr_b16 a[70:71], v16 offset:17440
v_mfma_f32_16x16x32_bf16 v[24:27], v[20:23], a[192:195], v[24:27]
v_mfma_f32_16x16x32_bf16 v[56:59], a[4:7], a[136:139], v[56:59]
buffer_load_dwordx4 a[176:179], v10, s[16:19], s52 offen sc1
v_mfma_f32_16x16x32_bf16 v[60:63], a[4:7], a[140:143], v[60:63]
ds_read_b64_tr_b16 a[72:73], v16 offset:25344
v_mfma_f32_16x16x32_bf16 v[64:67], a[8:11], a[128:131], v[64:67]
ds_read_b64_tr_b16 a[74:75], v16 offset:25856
v_mfma_f32_16x16x32_bf16 v[68:71], a[8:11], a[132:135], v[68:71]
ds_read_b64_tr_b16 a[76:77], v16 offset:25376
v_mfma_f32_16x16x32_bf16 v[72:75], a[8:11], a[136:139], v[72:75]
ds_read_b64_tr_b16 a[78:79], v16 offset:25888
v_mfma_f32_16x16x32_bf16 v[76:79], a[8:11], a[140:143], v[76:79]
v_mfma_f32_16x16x32_bf16 v[80:83], a[12:15], a[128:131], v[80:83]
buffer_load_dwordx4 v13, s[32:35], s54 offen offset:1056 lds
v_mfma_f32_16x16x32_bf16 v[84:87], a[12:15], a[132:135], v[84:87]
ds_read_b64_tr_b16 a[80:81], v16 offset:16960
v_mfma_f32_16x16x32_bf16 v[88:91], a[12:15], a[136:139], v[88:91]
ds_read_b64_tr_b16 a[82:83], v16 offset:17472
v_mfma_f32_16x16x32_bf16 v[92:95], a[12:15], a[140:143], v[92:95]
ds_read_b64_tr_b16 a[84:85], v16 offset:16992
v_mfma_f32_16x16x32_bf16 v[96:99], a[16:19], a[128:131], v[96:99]
ds_read_b64_tr_b16 a[86:87], v16 offset:17504
v_mfma_f32_16x16x32_bf16 v[100:103], a[16:19], a[132:135], v[100:103]
v_mfma_f32_16x16x32_bf16 v[24:27], v[20:23], a[196:199], v[24:27]
ds_read_b64_tr_b16 a[88:89], v16 offset:25408
v_mfma_f32_16x16x32_bf16 v[104:107], a[16:19], a[136:139], v[104:107]
buffer_load_dwordx4 a[180:183], v10, s[16:19], s52 offen offset:1024 sc1
v_mfma_f32_16x16x32_bf16 v[108:111], a[16:19], a[140:143], v[108:111]
ds_read_b64_tr_b16 a[90:91], v16 offset:25920
v_mfma_f32_16x16x32_bf16 v[112:115], a[20:23], a[128:131], v[112:115]
ds_read_b64_tr_b16 a[92:93], v16 offset:25440
v_mfma_f32_16x16x32_bf16 v[116:119], a[20:23], a[132:135], v[116:119]
ds_read_b64_tr_b16 a[94:95], v16 offset:25952
v_mfma_f32_16x16x32_bf16 v[120:123], a[20:23], a[136:139], v[120:123]
v_mfma_f32_16x16x32_bf16 v[124:127], a[20:23], a[140:143], v[124:127]
ds_read_b64_tr_b16 a[96:97], v16 offset:17024
v_mfma_f32_16x16x32_bf16 v[128:131], a[24:27], a[128:131], v[128:131]
buffer_load_dwordx4 v14, s[32:35], s54 offen offset:2112 lds
v_mfma_f32_16x16x32_bf16 v[132:135], a[24:27], a[132:135], v[132:135]
ds_read_b64_tr_b16 a[98:99], v16 offset:17536
v_mfma_f32_16x16x32_bf16 v[136:139], a[24:27], a[136:139], v[136:139]
ds_read_b64_tr_b16 a[100:101], v16 offset:17056
v_mfma_f32_16x16x32_bf16 v[140:143], a[24:27], a[140:143], v[140:143]
ds_read_b64_tr_b16 a[102:103], v16 offset:17568
v_mfma_f32_16x16x32_bf16 v[144:147], a[28:31], a[128:131], v[144:147]
v_mfma_f32_16x16x32_bf16 v[148:151], a[28:31], a[132:135], v[148:151]
ds_read_b64_tr_b16 a[104:105], v16 offset:25472
v_mfma_f32_16x16x32_bf16 v[24:27], v[20:23], a[200:203], v[24:27]
ds_read_b64_tr_b16 a[106:107], v16 offset:25984
v_mfma_f32_16x16x32_bf16 v[152:155], a[28:31], a[136:139], v[152:155]
buffer_load_dwordx4 a[184:187], v11, s[16:19], s52 offen sc1
v_mfma_f32_16x16x32_bf16 v[156:159], a[28:31], a[140:143], v[156:159]
ds_read_b64_tr_b16 a[108:109], v16 offset:25504
v_mfma_f32_16x16x32_bf16 v[160:163], a[32:35], a[128:131], v[160:163]
ds_read_b64_tr_b16 a[110:111], v16 offset:26016
v_mfma_f32_16x16x32_bf16 v[164:167], a[32:35], a[132:135], v[164:167]
v_mfma_f32_16x16x32_bf16 v[168:171], a[32:35], a[136:139], v[168:171]
ds_read_b64_tr_b16 a[112:113], v17 offset:16896
v_mfma_f32_16x16x32_bf16 v[172:175], a[32:35], a[140:143], v[172:175]
ds_read_b64_tr_b16 a[114:115], v17 offset:17408
v_mfma_f32_16x16x32_bf16 v[176:179], a[36:39], a[128:131], v[176:179]
buffer_load_dwordx4 v15, s[32:35], s54 offen offset:3168 lds
v_mfma_f32_16x16x32_bf16 v[180:183], a[36:39], a[132:135], v[180:183]
ds_read_b64_tr_b16 a[116:117], v17 offset:16928
s_add_u32 s54, s54, 229376
v_mfma_f32_16x16x32_bf16 v[184:187], a[36:39], a[136:139], v[184:187]
ds_read_b64_tr_b16 a[118:119], v17 offset:17440
v_mfma_f32_16x16x32_bf16 v[188:191], a[36:39], a[140:143], v[188:191]
v_mfma_f32_16x16x32_bf16 v[192:195], a[40:43], a[128:131], v[192:195]
ds_read_b64_tr_b16 a[120:121], v17 offset:25344
v_mfma_f32_16x16x32_bf16 v[196:199], a[40:43], a[132:135], v[196:199]
ds_read_b64_tr_b16 a[122:123], v17 offset:25856
v_mfma_f32_16x16x32_bf16 v[24:27], v[20:23], a[204:207], v[24:27]
ds_read_b64_tr_b16 a[124:125], v17 offset:25376
v_mfma_f32_16x16x32_bf16 v[200:203], a[40:43], a[136:139], v[200:203]
buffer_load_dwordx4 a[188:191], v11, s[16:19], s52 offen offset:1024 sc1
v_mfma_f32_16x16x32_bf16 v[204:207], a[40:43], a[140:143], v[204:207]
ds_read_b64_tr_b16 a[126:127], v17 offset:25888
s_add_u32 s52, s52, 0x20000
v_mfma_f32_16x16x32_bf16 v[208:211], a[44:47], a[128:131], v[208:211]
v_mfma_f32_16x16x32_bf16 v[212:215], a[44:47], a[132:135], v[212:215]
ds_read_b128 a[208:211], v9 offset:16896
v_mfma_f32_16x16x32_bf16 v[216:219], a[44:47], a[136:139], v[216:219]
ds_read_b128 a[212:215], v9 offset:17952
v_mfma_f32_16x16x32_bf16 v[220:223], a[44:47], a[140:143], v[220:223]
ds_read_b128 a[216:219], v9 offset:19008
s_max_i32 m0, s67, s59
v_mfma_f32_16x16x32_bf16 v[224:227], a[48:51], a[128:131], v[224:227]
buffer_load_dwordx4 v5, s[28:31], s58 offen lds
v_mfma_f32_16x16x32_bf16 v[228:231], a[48:51], a[132:135], v[228:231]
ds_read_b128 a[220:223], v9 offset:20064
v_mfma_f32_16x16x32_bf16 v[232:235], a[52:55], a[128:131], v[232:235]
v_mfma_f32_16x16x32_bf16 v[236:239], a[52:55], a[132:135], v[236:239]
v_mfma_f32_16x16x32_bf16 v[240:243], a[56:59], a[128:131], v[240:243]
v_mfma_f32_16x16x32_bf16 v[244:247], a[56:59], a[132:135], v[244:247]
v_mfma_f32_16x16x32_bf16 v[248:251], a[60:63], a[128:131], v[248:251]
v_mfma_f32_16x16x32_bf16 v[252:255], a[60:63], a[132:135], v[252:255]
s_waitcnt vmcnt(18) lgkmcnt(0)
s_barrier
v_mfma_f32_16x16x32_bf16 v[32:35], a[64:67], a[144:147], v[32:35]
ds_read_b64_tr_b16 a[0:1], v16 offset:33792
s_add_u32 m0, s55, 101376
v_mfma_f32_16x16x32_bf16 v[36:39], a[64:67], a[148:151], v[36:39]
buffer_load_dwordx4 v12, s[32:35], s54 offen lds
v_mfma_f32_16x16x32_bf16 v[40:43], a[64:67], a[152:155], v[40:43]
s_sub_u32 s47, s47, 1
s_cbranch_scc1 .Lx32
.Lx32b:
s_waitcnt vmcnt(18)
v_mfma_f32_16x16x32_bf16 v[44:47], a[64:67], a[156:159], v[44:47]
ds_read_b64_tr_b16 a[2:3], v16 offset:34304
v_mfma_f32_16x16x32_bf16 v[48:51], a[68:71], a[144:147], v[48:51]
ds_read_b64_tr_b16 a[4:5], v16 offset:33824
v_mfma_f32_16x16x32_bf16 v[52:55], a[68:71], a[148:151], v[52:55]
ds_read_b64_tr_b16 a[6:7], v16 offset:34336
v_mfma_f32_16x16x32_bf16 v[24:27], v[20:23], a[208:211], v[24:27]
ds_read_b64_tr_b16 a[8:9], v16 offset:42240
v_mfma_f32_16x16x32_bf16 v[56:59], a[68:71], a[152:155], v[56:59]
buffer_load_dwordx4 a[128:131], v10, s[16:19], s52 offen sc1
v_mfma_f32_16x16x32_bf16 v[60:63], a[68:71], a[156:159], v[60:63]
v_mfma_f32_16x16x32_bf16 v[64:67], a[72:75], a[144:147], v[64:67]
ds_read_b64_tr_b16 a[10:11], v16 offset:42752
v_mfma_f32_16x16x32_bf16 v[68:71], a[72:75], a[148:151], v[68:71]
ds_read_b64_tr_b16 a[12:13], v16 offset:42272
v_mfma_f32_16x16x32_bf16 v[72:75], a[72:75], a[152:155], v[72:75]
ds_read_b64_tr_b16 a[14:15], v16 offset:42784
v_mfma_f32_16x16x32_bf16 v[76:79], a[72:75], a[156:159], v[76:79]
ds_read_b64_tr_b16 a[16:17], v16 offset:33856
v_mfma_f32_16x16x32_bf16 v[80:83], a[76:79], a[144:147], v[80:83]
buffer_load_dwordx4 v13, s[32:35], s54 offen offset:1056 lds
v_mfma_f32_16x16x32_bf16 v[84:87], a[76:79], a[148:151], v[84:87]
v_mfma_f32_16x16x32_bf16 v[88:91], a[76:79], a[152:155], v[88:91]
ds_read_b64_tr_b16 a[18:19], v16 offset:34368
v_mfma_f32_16x16x32_bf16 v[92:95], a[76:79], a[156:159], v[92:95]
ds_read_b64_tr_b16 a[20:21], v16 offset:33888
v_mfma_f32_16x16x32_bf16 v[96:99], a[80:83], a[144:147], v[96:99]
ds_read_b64_tr_b16 a[22:23], v16 offset:34400
v_mfma_f32_16x16x32_bf16 v[100:103], a[80:83], a[148:151], v[100:103]
ds_read_b64_tr_b16 a[24:25], v16 offset:42304
v_mfma_f32_16x16x32_bf16 v[24:27], v[20:23], a[212:215], v[24:27]
ds_read_b64_tr_b16 a[26:27], v16 offset:42816
v_mfma_f32_16x16x32_bf16 v[104:107], a[80:83], a[152:155], v[104:107]
buffer_load_dwordx4 a[132:135], v10, s[16:19], s52 offen offset:1024 sc1
v_mfma_f32_16x16x32_bf16 v[108:111], a[80:83], a[156:159], v[108:111]
v_mfma_f32_16x16x32_bf16 v[112:115], a[84:87], a[144:147], v[112:115]
ds_read_b64_tr_b16 a[28:29], v16 offset:42336
v_mfma_f32_16x16x32_bf16 v[116:119], a[84:87], a[148:151], v[116:119]
ds_read_b64_tr_b16 a[30:31], v16 offset:42848
v_mfma_f32_16x16x32_bf16 v[120:123], a[84:87], a[152:155], v[120:123]
ds_read_b64_tr_b16 a[32:33], v16 offset:33920
v_mfma_f32_16x16x32_bf16 v[124:127], a[84:87], a[156:159], v[124:127]
ds_read_b64_tr_b16 a[34:35], v16 offset:34432
v_mfma_f32_16x16x32_bf16 v[128:131], a[88:91], a[144:147], v[128:131]
buffer_load_dwordx4 v14, s[32:35], s54 offen offset:2112 lds
v_mfma_f32_16x16x32_bf16 v[132:135], a[88:91], a[148:151], v[132:135]
v_mfma_f32_16x16x32_bf16 v[136:139], a[88:91], a[152:155], v[136:139]
ds_read_b64_tr_b16 a[36:37], v16 offset:33952
v_mfma_f32_16x16x32_bf16 v[140:143], a[88:91], a[156:159], v[140:143]
ds_read_b64_tr_b16 a[38:39], v16 offset:34464
v_mfma_f32_16x16x32_bf16 v[144:147], a[92:95], a[144:147], v[144:147]
ds_read_b64_tr_b16 a[40:41], v16 offset:42368
v_mfma_f32_16x16x32_bf16 v[148:151], a[92:95], a[148:151], v[148:151]
ds_read_b64_tr_b16 a[42:43], v16 offset:42880
v_mfma_f32_16x16x32_bf16 v[24:27], v[20:23], a[216:219], v[24:27]
ds_read_b64_tr_b16 a[44:45], v16 offset:42400
v_mfma_f32_16x16x32_bf16 v[152:155], a[92:95], a[152:155], v[152:155]
buffer_load_dwordx4 a[136:139], v11, s[16:19], s52 offen sc1
v_mfma_f32_16x16x32_bf16 v[156:159], a[92:95], a[156:159], v[156:159]
v_mfma_f32_16x16x32_bf16 v[160:163], a[96:99], a[144:147], v[160:163]
ds_read_b64_tr_b16 a[46:47], v16 offset:42912
v_mfma_f32_16x16x32_bf16 v[164:167], a[96:99], a[148:151], v[164:167]
ds_read_b64_tr_b16 a[48:49], v17 offset:33792
v_mfma_f32_16x16x32_bf16 v[168:171], a[96:99], a[152:155], v[168:171]
ds_read_b64_tr_b16 a[50:51], v17 offset:34304
v_mfma_f32_16x16x32_bf16 v[172:175], a[96:99], a[156:159], v[172:175]
ds_read_b64_tr_b16 a[52:53], v17 offset:33824
v_mfma_f32_16x16x32_bf16 v[176:179], a[100:103], a[144:147], v[176:179]
buffer_load_dwordx4 v15, s[32:35], s54 offen offset:3168 lds
v_mfma_f32_16x16x32_bf16 v[180:183], a[100:103], a[148:151], v[180:183]
s_add_u32 s54, s54, 229376
v_mfma_f32_16x16x32_bf16 v[184:187], a[100:103], a[152:155], v[184:187]
ds_read_b64_tr_b16 a[54:55], v17 offset:34336
v_mfma_f32_16x16x32_bf16 v[188:191], a[100:103], a[156:159], v[188:191]
ds_read_b64_tr_b16 a[56:57], v17 offset:42240
v_mfma_f32_16x16x32_bf16 v[192:195], a[104:107], a[144:147], v[192:195]
ds_read_b64_tr_b16 a[58:59], v17 offset:42752
v_mfma_f32_16x16x32_bf16 v[196:199], a[104:107], a[148:151], v[196:199]
ds_read_b64_tr_b16 a[60:61], v17 offset:42272
v_mfma_f32_16x16x32_bf16 v[24:27], v[20:23], a[220:223], v[24:27]
ds_read_b64_tr_b16 a[62:63], v17 offset:42784
v_mfma_f32_16x16x32_bf16 v[200:203], a[104:107], a[152:155], v[200:203]
buffer_load_dwordx4 a[140:143], v11, s[16:19], s52 offen offset:1024 sc1
v_mfma_f32_16x16x32_bf16 v[204:207], a[104:107], a[156:159], v[204:207]
s_add_u32 s52, s52, 0x20000
v_mfma_f32_16x16x32_bf16 v[208:211], a[108:111], a[144:147], v[208:211]
ds_read_b128 a[192:195], v9 offset:33792
v_mfma_f32_16x16x32_bf16 v[212:215], a[108:111], a[148:151], v[212:215]
ds_read_b128 a[196:199], v9 offset:34848
v_mfma_f32_16x16x32_bf16 v[216:219], a[108:111], a[152:155], v[216:219]
ds_read_b128 a[200:203], v9 offset:35904
v_mfma_f32_16x16x32_bf16 v[220:223], a[108:111], a[156:159], v[220:223]
ds_read_b128 a[204:207], v9 offset:36960
s_max_i32 m0, s67, s59
v_mfma_f32_16x16x32_bf16 v[224:227], a[112:115], a[144:147], v[224:227]
buffer_load_dwordx4 v6, s[28:31], s58 offen offset:1056 lds
v_mfma_f32_16x16x32_bf16 v[228:231], a[112:115], a[148:151], v[228:231]
s_add_u32 s67, s67, 8448
s_add_u32 s58, s58, 0x10000
v_mfma_f32_16x16x32_bf16 v[232:235], a[116:119], a[144:147], v[232:235]
v_mfma_f32_16x16x32_bf16 v[236:239], a[116:119], a[148:151], v[236:239]
v_mfma_f32_16x16x32_bf16 v[240:243], a[120:123], a[144:147], v[240:243]
v_mfma_f32_16x16x32_bf16 v[244:247], a[120:123], a[148:151], v[244:247]
v_mfma_f32_16x16x32_bf16 v[248:251], a[124:127], a[144:147], v[248:251]
v_mfma_f32_16x16x32_bf16 v[252:255], a[124:127], a[148:151], v[252:255]
.Lpad12:
s_cbranch_execz .Lpad15
s_waitcnt vmcnt(19) lgkmcnt(0)
s_barrier
v_mfma_f32_16x16x32_bf16 v[32:35], a[0:3], a[160:163], v[32:35]
ds_read_b64_tr_b16 a[64:65], v16 offset:50688
s_add_u32 m0, s55, 118272
v_mfma_f32_16x16x32_bf16 v[36:39], a[0:3], a[164:167], v[36:39]
buffer_load_dwordx4 v12, s[32:35], s54 offen lds
v_mfma_f32_16x16x32_bf16 v[40:43], a[0:3], a[168:171], v[40:43]
s_sub_u32 s47, s47, 1
s_cbranch_scc1 .Lx33
.Lx33b:
s_waitcnt vmcnt(19)
v_mfma_f32_16x16x32_bf16 v[44:47], a[0:3], a[172:175], v[44:47]
ds_read_b64_tr_b16 a[66:67], v16 offset:51200
v_mfma_f32_16x16x32_bf16 v[48:51], a[4:7], a[160:163], v[48:51]
ds_read_b64_tr_b16 a[68:69], v16 offset:50720
v_mfma_f32_16x16x32_bf16 v[52:55], a[4:7], a[164:167], v[52:55]
ds_read_b64_tr_b16 a[70:71], v16 offset:51232
v_mfma_f32_16x16x32_bf16 v[24:27], v[20:23], a[192:195], v[24:27]
v_mfma_f32_16x16x32_bf16 v[56:59], a[4:7], a[168:171], v[56:59]
buffer_load_dwordx4 a[144:147], v10, s[16:19], s52 offen sc1
v_mfma_f32_16x16x32_bf16 v[60:63], a[4:7], a[172:175], v[60:63]
ds_read_b64_tr_b16 a[72:73], v16 offset:59136
v_mfma_f32_16x16x32_bf16 v[64:67], a[8:11], a[160:163], v[64:67]
ds_read_b64_tr_b16 a[74:75], v16 offset:59648
v_mfma_f32_16x16x32_bf16 v[68:71], a[8:11], a[164:167], v[68:71]
ds_read_b64_tr_b16 a[76:77], v16 offset:59168
v_mfma_f32_16x16x32_bf16 v[72:75], a[8:11], a[168:171], v[72:75]
ds_read_b64_tr_b16 a[78:79], v16 offset:59680
v_mfma_f32_16x16x32_bf16 v[76:79], a[8:11], a[172:175], v[76:79]
v_mfma_f32_16x16x32_bf16 v[80:83], a[12:15], a[160:163], v[80:83]
buffer_load_dwordx4 v13, s[32:35], s54 offen offset:1056 lds
v_mfma_f32_16x16x32_bf16 v[84:87], a[12:15], a[164:167], v[84:87]
ds_read_b64_tr_b16 a[80:81], v16 offset:50752
v_mfma_f32_16x16x32_bf16 v[88:91], a[12:15], a[168:171], v[88:91]
ds_read_b64_tr_b16 a[82:83], v16 offset:51264
v_mfma_f32_16x16x32_bf16 v[92:95], a[12:15], a[172:175], v[92:95]
ds_read_b64_tr_b16 a[84:85], v16 offset:50784
v_mfma_f32_16x16x32_bf16 v[96:99], a[16:19], a[160:163], v[96:99]
ds_read_b64_tr_b16 a[86:87], v16 offset:51296
v_mfma_f32_16x16x32_bf16 v[100:103], a[16:19], a[164:167], v[100:103]
v_mfma_f32_16x16x32_bf16 v[24:27], v[20:23], a[196:199], v[24:27]
ds_read_b64_tr_b16 a[88:89], v16 offset:59200
v_mfma_f32_16x16x32_bf16 v[104:107], a[16:19], a[168:171], v[104:107]
buffer_load_dwordx4 a[148:151], v10, s[16:19], s52 offen offset:1024 sc1
v_mfma_f32_16x16x32_bf16 v[108:111], a[16:19], a[172:175], v[108:111]
ds_read_b64_tr_b16 a[90:91], v16 offset:59712
v_mfma_f32_16x16x32_bf16 v[112:115], a[20:23], a[160:163], v[112:115]
ds_read_b64_tr_b16 a[92:93], v16 offset:59232
v_mfma_f32_16x16x32_bf16 v[116:119], a[20:23], a[164:167], v[116:119]
ds_read_b64_tr_b16 a[94:95], v16 offset:59744
v_mfma_f32_16x16x32_bf16 v[120:123], a[20:23], a[168:171], v[120:123]
v_mfma_f32_16x16x32_bf16 v[124:127], a[20:23], a[172:175], v[124:127]
ds_read_b64_tr_b16 a[96:97], v16 offset:50816
v_mfma_f32_16x16x32_bf16 v[128:131], a[24:27], a[160:163], v[128:131]
buffer_load_dwordx4 v14, s[32:35], s54 offen offset:2112 lds
v_mfma_f32_16x16x32_bf16 v[132:135], a[24:27], a[164:167], v[132:135]
ds_read_b64_tr_b16 a[98:99], v16 offset:51328
v_mfma_f32_16x16x32_bf16 v[136:139], a[24:27], a[168:171], v[136:139]
ds_read_b64_tr_b16 a[100:101], v16 offset:50848
v_mfma_f32_16x16x32_bf16 v[140:143], a[24:27], a[172:175], v[140:143]
ds_read_b64_tr_b16 a[102:103], v16 offset:51360
v_mfma_f32_16x16x32_bf16 v[144:147], a[28:31], a[160:163], v[144:147]
v_mfma_f32_16x16x32_bf16 v[148:151], a[28:31], a[164:167], v[148:151]
ds_read_b64_tr_b16 a[104:105], v16 offset:59264
v_mfma_f32_16x16x32_bf16 v[24:27], v[20:23], a[200:203], v[24:27]
ds_read_b64_tr_b16 a[106:107], v16 offset:59776
v_mfma_f32_16x16x32_bf16 v[152:155], a[28:31], a[168:171], v[152:155]
buffer_load_dwordx4 a[152:155], v11, s[16:19], s52 offen sc1
v_mfma_f32_16x16x32_bf16 v[156:159], a[28:31], a[172:175], v[156:159]
ds_read_b64_tr_b16 a[108:109], v16 offset:59296
v_mfma_f32_16x16x32_bf16 v[160:163], a[32:35], a[160:163], v[160:163]
ds_read_b64_tr_b16 a[110:111], v16 offset:59808
v_mfma_f32_16x16x32_bf16 v[164:167], a[32:35], a[164:167], v[164:167]
v_mfma_f32_16x16x32_bf16 v[168:171], a[32:35], a[168:171], v[168:171]
ds_read_b64_tr_b16 a[112:113], v17 offset:50688
v_mfma_f32_16x16x32_bf16 v[172:175], a[32:35], a[172:175], v[172:175]
ds_read_b64_tr_b16 a[114:115], v17 offset:51200
v_mfma_f32_16x16x32_bf16 v[176:179], a[36:39], a[160:163], v[176:179]
buffer_load_dwordx4 v15, s[32:35], s54 offen offset:3168 lds
v_mfma_f32_16x16x32_bf16 v[180:183], a[36:39], a[164:167], v[180:183]
ds_read_b64_tr_b16 a[116:117], v17 offset:50720
s_add_u32 s54, s54, 229376
v_mfma_f32_16x16x32_bf16 v[184:187], a[36:39], a[168:171], v[184:187]
ds_read_b64_tr_b16 a[118:119], v17 offset:51232
v_mfma_f32_16x16x32_bf16 v[188:191], a[36:39], a[172:175], v[188:191]
v_mfma_f32_16x16x32_bf16 v[192:195], a[40:43], a[160:163], v[192:195]
ds_read_b64_tr_b16 a[120:121], v17 offset:59136
v_mfma_f32_16x16x32_bf16 v[196:199], a[40:43], a[164:167], v[196:199]
ds_read_b64_tr_b16 a[122:123], v17 offset:59648
v_mfma_f32_16x16x32_bf16 v[24:27], v[20:23], a[204:207], v[24:27]
ds_read_b64_tr_b16 a[124:125], v17 offset:59168
v_mfma_f32_16x16x32_bf16 v[200:203], a[40:43], a[168:171], v[200:203]
buffer_load_dwordx4 a[156:159], v11, s[16:19], s52 offen offset:1024 sc1
v_mfma_f32_16x16x32_bf16 v[204:207], a[40:43], a[172:175], v[204:207]
ds_read_b64_tr_b16 a[126:127], v17 offset:59680
s_add_u32 s52, s52, 0x20000
v_mfma_f32_16x16x32_bf16 v[208:211], a[44:47], a[160:163], v[208:211]
v_mfma_f32_16x16x32_bf16 v[212:215], a[44:47], a[164:167], v[212:215]
ds_read_b128 a[208:211], v9 offset:50688
v_mfma_f32_16x16x32_bf16 v[216:219], a[44:47], a[168:171], v[216:219]
ds_read_b128 a[212:215], v9 offset:51744
v_mfma_f32_16x16x32_bf16 v[220:223], a[44:47], a[172:175], v[220:223]
ds_read_b128 a[216:219], v9 offset:52800
s_max_i32 m0, s67, s59
v_mfma_f32_16x16x32_bf16 v[224:227], a[48:51], a[160:163], v[224:227]
buffer_load_dwordx4 v5, s[28:31], s58 offen lds
v_mfma_f32_16x16x32_bf16 v[228:231], a[48:51], a[164:167], v[228:231]
ds_read_b128 a[220:223], v9 offset:53856
v_mfma_f32_16x16x32_bf16 v[232:235], a[52:55], a[160:163], v[232:235]
v_mfma_f32_16x16x32_bf16 v[236:239], a[52:55], a[164:167], v[236:239]
v_mfma_f32_16x16x32_bf16 v[240:243], a[56:59], a[160:163], v[240:243]
v_mfma_f32_16x16x32_bf16 v[244:247], a[56:59], a[164:167], v[244:247]
v_mfma_f32_16x16x32_bf16 v[248:251], a[60:63], a[160:163], v[248:251]
v_mfma_f32_16x16x32_bf16 v[252:255], a[60:63], a[164:167], v[252:255]
s_waitcnt vmcnt(20) lgkmcnt(0)
s_barrier
v_mfma_f32_16x16x32_bf16 v[32:35], a[64:67], a[176:179], v[32:35]
ds_read_b64_tr_b16 a[0:1], v16
s_add_u32 m0, s55, 135168
v_mfma_f32_16x16x32_bf16 v[36:39], a[64:67], a[180:183], v[36:39]
buffer_load_dwordx4 v12, s[32:35], s54 offen lds
v_mfma_f32_16x16x32_bf16 v[40:43], a[64:67], a[184:187], v[40:43]
s_sub_u32 s47, s47, 1
s_cbranch_scc1 .Lx34
.Lx34b:
s_waitcnt vmcnt(20)
v_mfma_f32_16x16x32_bf16 v[44:47], a[64:67], a[188:191], v[44:47]
ds_read_b64_tr_b16 a[2:3], v16 offset:512
v_mfma_f32_16x16x32_bf16 v[48:51], a[68:71], a[176:179], v[48:51]
ds_read_b64_tr_b16 a[4:5], v16 offset:32
v_mfma_f32_16x16x32_bf16 v[52:55], a[68:71], a[180:183], v[52:55]
ds_read_b64_tr_b16 a[6:7], v16 offset:544
v_mfma_f32_16x16x32_bf16 v[24:27], v[20:23], a[208:211], v[24:27]
ds_read_b64_tr_b16 a[8:9], v16 offset:8448
v_mfma_f32_16x16x32_bf16 v[56:59], a[68:71], a[184:187], v[56:59]
buffer_load_dwordx4 a[160:163], v10, s[16:19], s52 offen sc1
v_mfma_f32_16x16x32_bf16 v[60:63], a[68:71], a[188:191], v[60:63]
v_mfma_f32_16x16x32_bf16 v[64:67], a[72:75], a[176:179], v[64:67]
ds_read_b64_tr_b16 a[10:11], v16 offset:8960
v_mfma_f32_16x16x32_bf16 v[68:71], a[72:75], a[180:183], v[68:71]
ds_read_b64_tr_b16 a[12:13], v16 offset:8480
v_mfma_f32_16x16x32_bf16 v[72:75], a[72:75], a[184:187], v[72:75]
ds_read_b64_tr_b16 a[14:15], v16 offset:8992
v_mfma_f32_16x16x32_bf16 v[76:79], a[72:75], a[188:191], v[76:79]
ds_read_b64_tr_b16 a[16:17], v16 offset:64
v_mfma_f32_16x16x32_bf16 v[80:83], a[76:79], a[176:179], v[80:83]
buffer_load_dwordx4 v13, s[32:35], s54 offen offset:1056 lds
v_mfma_f32_16x16x32_bf16 v[84:87], a[76:79], a[180:183], v[84:87]
v_mfma_f32_16x16x32_bf16 v[88:91], a[76:79], a[184:187], v[88:91]
ds_read_b64_tr_b16 a[18:19], v16 offset:576
v_mfma_f32_16x16x32_bf16 v[92:95], a[76:79], a[188:191], v[92:95]
ds_read_b64_tr_b16 a[20:21], v16 offset:96
v_mfma_f32_16x16x32_bf16 v[96:99], a[80:83], a[176:179], v[96:99]
ds_read_b64_tr_b16 a[22:23], v16 offset:608
v_mfma_f32_16x16x32_bf16 v[100:103], a[80:83], a[180:183], v[100:103]
ds_read_b64_tr_b16 a[24:25], v16 offset:8512
v_mfma_f32_16x16x32_bf16 v[24:27], v[20:23], a[212:215], v[24:27]
ds_read_b64_tr_b16 a[26:27], v16 offset:9024
v_mfma_f32_16x16x32_bf16 v[104:107], a[80:83], a[184:187], v[104:107]
buffer_load_dwordx4 a[164:167], v10, s[16:19], s52 offen offset:1024 sc1
v_mfma_f32_16x16x32_bf16 v[108:111], a[80:83], a[188:191], v[108:111]
v_mfma_f32_16x16x32_bf16 v[112:115], a[84:87], a[176:179], v[112:115]
ds_read_b64_tr_b16 a[28:29], v16 offset:8544
v_mfma_f32_16x16x32_bf16 v[116:119], a[84:87], a[180:183], v[116:119]
ds_read_b64_tr_b16 a[30:31], v16 offset:9056
v_mfma_f32_16x16x32_bf16 v[120:123], a[84:87], a[184:187], v[120:123]
ds_read_b64_tr_b16 a[32:33], v16 offset:128
v_mfma_f32_16x16x32_bf16 v[124:127], a[84:87], a[188:191], v[124:127]
ds_read_b64_tr_b16 a[34:35], v16 offset:640
v_mfma_f32_16x16x32_bf16 v[128:131], a[88:91], a[176:179], v[128:131]
buffer_load_dwordx4 v14, s[32:35], s54 offen offset:2112 lds
v_mfma_f32_16x16x32_bf16 v[132:135], a[88:91], a[180:183], v[132:135]
v_mfma_f32_16x16x32_bf16 v[136:139], a[88:91], a[184:187], v[136:139]
ds_read_b64_tr_b16 a[36:37], v16 offset:160
v_mfma_f32_16x16x32_bf16 v[140:143], a[88:91], a[188:191], v[140:143]
ds_read_b64_tr_b16 a[38:39], v16 offset:672
v_mfma_f32_16x16x32_bf16 v[144:147], a[92:95], a[176:179], v[144:147]
ds_read_b64_tr_b16 a[40:41], v16 offset:8576
v_mfma_f32_16x16x32_bf16 v[148:151], a[92:95], a[180:183], v[148:151]
ds_read_b64_tr_b16 a[42:43], v16 offset:9088
v_mfma_f32_16x16x32_bf16 v[24:27], v[20:23], a[216:219], v[24:27]
ds_read_b64_tr_b16 a[44:45], v16 offset:8608
v_mfma_f32_16x16x32_bf16 v[152:155], a[92:95], a[184:187], v[152:155]
buffer_load_dwordx4 a[168:171], v11, s[16:19], s52 offen sc1
v_mfma_f32_16x16x32_bf16 v[156:159], a[92:95], a[188:191], v[156:159]
v_mfma_f32_16x16x32_bf16 v[160:163], a[96:99], a[176:179], v[160:163]
ds_read_b64_tr_b16 a[46:47], v16 offset:9120
v_mfma_f32_16x16x32_bf16 v[164:167], a[96:99], a[180:183], v[164:167]
ds_read_b64_tr_b16 a[48:49], v17
v_mfma_f32_16x16x32_bf16 v[168:171], a[96:99], a[184:187], v[168:171]
ds_read_b64_tr_b16 a[50:51], v17 offset:512
v_mfma_f32_16x16x32_bf16 v[172:175], a[96:99], a[188:191], v[172:175]
ds_read_b64_tr_b16 a[52:53], v17 offset:32
v_mfma_f32_16x16x32_bf16 v[176:179], a[100:103], a[176:179], v[176:179]
buffer_load_dwordx4 v15, s[32:35], s54 offen offset:3168 lds
v_mfma_f32_16x16x32_bf16 v[180:183], a[100:103], a[180:183], v[180:183]
s_add_u32 s54, s54, 229376
v_mfma_f32_16x16x32_bf16 v[184:187], a[100:103], a[184:187], v[184:187]
ds_read_b64_tr_b16 a[54:55], v17 offset:544
v_mfma_f32_16x16x32_bf16 v[188:191], a[100:103], a[188:191], v[188:191]
ds_read_b64_tr_b16 a[56:57], v17 offset:8448
v_mfma_f32_16x16x32_bf16 v[192:195], a[104:107], a[176:179], v[192:195]
ds_read_b64_tr_b16 a[58:59], v17 offset:8960
v_mfma_f32_16x16x32_bf16 v[196:199], a[104:107], a[180:183], v[196:199]
ds_read_b64_tr_b16 a[60:61], v17 offset:8480
v_mfma_f32_16x16x32_bf16 v[24:27], v[20:23], a[220:223], v[24:27]
ds_read_b64_tr_b16 a[62:63], v17 offset:8992
v_mfma_f32_16x16x32_bf16 v[200:203], a[104:107], a[184:187], v[200:203]
buffer_load_dwordx4 a[172:175], v11, s[16:19], s52 offen offset:1024 sc1
v_mfma_f32_16x16x32_bf16 v[204:207], a[104:107], a[188:191], v[204:207]
s_add_u32 s52, s52, 0x20000
v_mfma_f32_16x16x32_bf16 v[208:211], a[108:111], a[176:179], v[208:211]
ds_read_b128 a[192:195], v9
v_mfma_f32_16x16x32_bf16 v[212:215], a[108:111], a[180:183], v[212:215]
ds_read_b128 a[196:199], v9 offset:1056
v_mfma_f32_16x16x32_bf16 v[216:219], a[108:111], a[184:187], v[216:219]
ds_read_b128 a[200:203], v9 offset:2112
v_mfma_f32_16x16x32_bf16 v[220:223], a[108:111], a[188:191], v[220:223]
ds_read_b128 a[204:207], v9 offset:3168
s_max_i32 m0, s67, s59
v_mfma_f32_16x16x32_bf16 v[224:227], a[112:115], a[176:179], v[224:227]
buffer_load_dwordx4 v6, s[28:31], s58 offen offset:1056 lds
v_mfma_f32_16x16x32_bf16 v[228:231], a[112:115], a[180:183], v[228:231]
s_add_u32 s67, s67, 8448
s_add_u32 s58, s58, 0x10000
v_mfma_f32_16x16x32_bf16 v[232:235], a[116:119], a[176:179], v[232:235]
v_mfma_f32_16x16x32_bf16 v[236:239], a[116:119], a[180:183], v[236:239]
v_mfma_f32_16x16x32_bf16 v[240:243], a[120:123], a[176:179], v[240:243]
v_mfma_f32_16x16x32_bf16 v[244:247], a[120:123], a[180:183], v[244:247]
v_mfma_f32_16x16x32_bf16 v[248:251], a[124:127], a[176:179], v[248:251]
s_add_u32 s15, s15, 1
v_mfma_f32_16x16x32_bf16 v[252:255], a[124:127], a[180:183], v[252:255]
s_cbranch_scc0 .Lk30
s_waitcnt vmcnt(11) lgkmcnt(0)
s_barrier
v_mfma_f32_16x16x32_bf16 v[24:27], v[20:23], a[192:195], v[24:27]
buffer_load_dwordx4 a[176:179], v10, s[16:19], s52 offen sc1
v_mfma_f32_16x16x32_bf16 v[24:27], v[20:23], a[196:199], v[24:27]
ds_read_b64_tr_b16 a[64:65], v16 offset:16896
v_mov_b32 v18, v5
v_mfma_f32_16x16x32_bf16 v[24:27], v[20:23], a[200:203], v[24:27]
ds_read_b64_tr_b16 a[66:67], v16 offset:17408
v_mov_b32 v19, v6
v_mfma_f32_16x16x32_bf16 v[24:27], v[20:23], a[204:207], v[24:27]
ds_read_b64_tr_b16 a[68:69], v16 offset:16928
s_lshl_b32 s74, s48, 10
v_mfma_f32_16x16x32_bf16 v[32:35], a[0:3], a[128:131], v[32:35]
buffer_load_dwordx4 a[180:183], v10, s[16:19], s52 offen offset:1024 sc1
v_mfma_f32_16x16x32_bf16 v[48:51], a[4:7], a[128:131], v[48:51]
ds_read_b64_tr_b16 a[70:71], v16 offset:17440
s_lshl_b32 s75, s49, 9
v_mfma_f32_16x16x32_bf16 v[64:67], a[8:11], a[128:131], v[64:67]
ds_read_b64_tr_b16 a[72:73], v16 offset:25344
s_add_u32 s74, s74, s75
v_mfma_f32_16x16x32_bf16 v[80:83], a[12:15], a[128:131], v[80:83]
ds_read_b64_tr_b16 a[74:75], v16 offset:25856
s_add_u32 s74, s74, 159488
v_mfma_f32_16x16x32_bf16 v[36:39], a[0:3], a[132:135], v[36:39]
buffer_load_dwordx4 a[184:187], v11, s[16:19], s52 offen sc1
v_mfma_f32_16x16x32_bf16 v[52:55], a[4:7], a[132:135], v[52:55]
ds_read_b64_tr_b16 a[76:77], v16 offset:25376
v_bfe_u32 v2, v1, 4, 1
v_mfma_f32_16x16x32_bf16 v[68:71], a[8:11], a[132:135], v[68:71]
ds_read_b64_tr_b16 a[78:79], v16 offset:25888
s_lshl_b32 s75, s12, 9
v_mfma_f32_16x16x32_bf16 v[84:87], a[12:15], a[132:135], v[84:87]
ds_read_b64_tr_b16 a[80:81], v16 offset:33792
s_mul_i32 s66, s13, 917504
v_mfma_f32_16x16x32_bf16 v[40:43], a[0:3], a[136:139], v[40:43]
buffer_load_dwordx4 a[188:191], v11, s[16:19], s52 offen offset:1024 sc1
v_mfma_f32_16x16x32_bf16 v[56:59], a[4:7], a[136:139], v[56:59]
s_add_u32 s52, s52, 0x20000
ds_read_b64_tr_b16 a[82:83], v16 offset:34304
v_mfma_f32_16x16x32_bf16 v[72:75], a[8:11], a[136:139], v[72:75]
ds_read_b64_tr_b16 a[84:85], v16 offset:33824
s_add_u32 s66, s66, 12582912
v_mfma_f32_16x16x32_bf16 v[88:91], a[12:15], a[136:139], v[88:91]
ds_read_b64_tr_b16 a[86:87], v16 offset:34336
s_add_u32 s65, s66, 393216
v_mfma_f32_16x16x32_bf16 v[44:47], a[0:3], a[140:143], v[44:47]
ds_read_b64_tr_b16 a[88:89], v16 offset:42240
s_lshl_b32 s62, s12, 19
v_mfma_f32_16x16x32_bf16 v[60:63], a[4:7], a[140:143], v[60:63]
ds_read_b64_tr_b16 a[90:91], v16 offset:42752
s_add_u32 s62, s62, s66
v_mfma_f32_16x16x32_bf16 v[76:79], a[8:11], a[140:143], v[76:79]
ds_read_b64_tr_b16 a[92:93], v16 offset:42272
s_add_u32 s63, s62, 0x20000
v_mfma_f32_16x16x32_bf16 v[92:95], a[12:15], a[140:143], v[92:95]
ds_read_b64_tr_b16 a[94:95], v16 offset:42784
s_add_u32 s64, s62, 0x40000
v_mfma_f32_16x16x32_bf16 v[96:99], a[16:19], a[128:131], v[96:99]
ds_read_b64_tr_b16 a[112:113], v16 offset:16960
s_mov_b32 s58, 655360
v_mfma_f32_16x16x32_bf16 v[112:115], a[20:23], a[128:131], v[112:115]
ds_read_b64_tr_b16 a[114:115], v16 offset:17472
v_mfma_f32_16x16x32_bf16 v[128:131], a[24:27], a[128:131], v[128:131]
ds_read_b64_tr_b16 a[116:117], v16 offset:16992
v_mfma_f32_16x16x32_bf16 v[144:147], a[28:31], a[128:131], v[144:147]
ds_read_b64_tr_b16 a[118:119], v16 offset:17504
v_mfma_f32_16x16x32_bf16 v[100:103], a[16:19], a[132:135], v[100:103]
ds_read_b64_tr_b16 a[120:121], v16 offset:25408
v_mfma_f32_16x16x32_bf16 v[116:119], a[20:23], a[132:135], v[116:119]
ds_read_b64_tr_b16 a[122:123], v16 offset:25920
v_mfma_f32_16x16x32_bf16 v[132:135], a[24:27], a[132:135], v[132:135]
ds_read_b64_tr_b16 a[124:125], v16 offset:25440
v_mfma_f32_16x16x32_bf16 v[148:151], a[28:31], a[132:135], v[148:151]
ds_read_b64_tr_b16 a[126:127], v16 offset:25952
v_mfma_f32_16x16x32_bf16 v[104:107], a[16:19], a[136:139], v[104:107]
ds_read_b128 a[208:211], v9 offset:16896
v_mfma_f32_16x16x32_bf16 v[120:123], a[20:23], a[136:139], v[120:123]
ds_read_b128 a[212:215], v9 offset:17952
v_mfma_f32_16x16x32_bf16 v[136:139], a[24:27], a[136:139], v[136:139]
ds_read_b128 a[216:219], v9 offset:19008
v_mfma_f32_16x16x32_bf16 v[152:155], a[28:31], a[136:139], v[152:155]
ds_read_b128 a[220:223], v9 offset:20064
v_mfma_f32_16x16x32_bf16 v[108:111], a[16:19], a[140:143], v[108:111]
ds_read_b128 a[192:195], v9 offset:33792
v_mfma_f32_16x16x32_bf16 v[124:127], a[20:23], a[140:143], v[124:127]
ds_read_b128 a[196:199], v9 offset:34848
v_mfma_f32_16x16x32_bf16 v[140:143], a[24:27], a[140:143], v[140:143]
ds_read_b128 a[200:203], v9 offset:35904
v_mfma_f32_16x16x32_bf16 v[156:159], a[28:31], a[140:143], v[156:159]
ds_read_b128 a[204:207], v9 offset:36960
v_mfma_f32_16x16x32_bf16 v[160:163], a[32:35], a[128:131], v[160:163]
ds_read_b64_tr_b16 a[0:1], v16 offset:33856
s_waitcnt lgkmcnt(8)
v_mfma_f32_16x16x32_bf16 v[24:27], v[20:23], a[208:211], v[24:27]
ds_read_b64_tr_b16 a[2:3], v16 offset:34368
s_waitcnt vmcnt(6)
s_barrier
s_waitcnt lgkmcnt(8)
v_mfma_f32_16x16x32_bf16 v[24:27], v[20:23], a[212:215], v[24:27]
ds_read_b64_tr_b16 a[96:97], v16 offset:50688
s_waitcnt lgkmcnt(8)
v_mfma_f32_16x16x32_bf16 v[24:27], v[20:23], a[216:219], v[24:27]
ds_read_b64_tr_b16 a[98:99], v16 offset:51200
s_waitcnt lgkmcnt(8)
v_mfma_f32_16x16x32_bf16 v[24:27], v[20:23], a[220:223], v[24:27]
ds_read_b64_tr_b16 a[100:101], v16 offset:50720
s_waitcnt lgkmcnt(8)
v_mfma_f32_16x16x32_bf16 v[24:27], v[20:23], a[192:195], v[24:27]
ds_read_b64_tr_b16 a[102:103], v16 offset:51232
s_waitcnt lgkmcnt(8)
v_mfma_f32_16x16x32_bf16 v[24:27], v[20:23], a[196:199], v[24:27]
ds_read_b64_tr_b16 a[104:105], v16 offset:59136
s_waitcnt lgkmcnt(8)
v_mfma_f32_16x16x32_bf16 v[24:27], v[20:23], a[200:203], v[24:27]
ds_read_b64_tr_b16 a[106:107], v16 offset:59648
s_waitcnt lgkmcnt(8)
v_mfma_f32_16x16x32_bf16 v[24:27], v[20:23], a[204:207], v[24:27]
ds_read_b64_tr_b16 a[108:109], v16 offset:59168
v_mfma_f32_16x16x32_bf16 v[176:179], a[36:39], a[128:131], v[176:179]
ds_read_b64_tr_b16 a[110:111], v16 offset:59680
v_mfma_f32_16x16x32_bf16 v[192:195], a[40:43], a[128:131], v[192:195]
ds_read_b128 a[208:211], v9 offset:50688
v_mfma_f32_16x16x32_bf16 v[208:211], a[44:47], a[128:131], v[208:211]
ds_read_b128 a[212:215], v9 offset:51744
v_mfma_f32_16x16x32_bf16 v[164:167], a[32:35], a[132:135], v[164:167]
ds_read_b128 a[216:219], v9 offset:52800
v_mfma_f32_16x16x32_bf16 v[180:183], a[36:39], a[132:135], v[180:183]
ds_read_b128 a[220:223], v9 offset:53856
v_and_b32 v9, 15, v1
v_mfma_f32_16x16x32_bf16 v[196:199], a[40:43], a[132:135], v[196:199]
ds_read_b64_tr_b16 a[4:5], v16 offset:33888
v_lshl_add_u32 v9, v9, 5, s74
v_mfma_f32_16x16x32_bf16 v[212:215], a[44:47], a[132:135], v[212:215]
s_lshl_b32 s74, s3, 10
v_lshl_add_u32 v9, v2, 4, v9
v_bfe_u32 v2, v1, 5, 1
v_mfma_f32_16x16x32_bf16 v[168:171], a[32:35], a[136:139], v[168:171]
s_add_u32 s74, s74, s75
v_mul_u32_u24 v2, 2816, v2
v_sub_u32 v9, v9, v2
v_mfma_f32_16x16x32_bf16 v[184:187], a[36:39], a[136:139], v[184:187]
s_add_u32 s74, s74, 152576
v_and_b32 v2, 15, v1
v_lshl_add_u32 v2, v2, 4, s74
v_mfma_f32_16x16x32_bf16 v[200:203], a[40:43], a[136:139], v[200:203]
ds_read_b32 v28, v2 offset:8
v_xor_b32 v8, 512, v2
s_waitcnt lgkmcnt(5)
v_mfma_f32_16x16x32_bf16 v[24:27], v[20:23], a[208:211], v[24:27]
ds_read_b32 v29, v2 offset:264
s_lshl_b32 s74, s12, 7
s_waitcnt lgkmcnt(5)
v_mfma_f32_16x16x32_bf16 v[24:27], v[20:23], a[212:215], v[24:27]
ds_read_b32 v30, v8 offset:8
s_add_u32 s74, s74, 161536
s_waitcnt lgkmcnt(5)
v_mfma_f32_16x16x32_bf16 v[24:27], v[20:23], a[216:219], v[24:27]
ds_read_b32 v31, v8 offset:264
s_xor_b32 s75, s12, 1
s_waitcnt lgkmcnt(5)
v_mfma_f32_16x16x32_bf16 v[24:27], v[20:23], a[220:223], v[24:27]
s_mul_i32 s75, s75, 384
s_add_u32 s75, s75, 161536
v_mfma_f32_16x16x32_bf16 v[216:219], a[44:47], a[136:139], v[216:219]
ds_read_b64_tr_b16 a[6:7], v16 offset:34400
v_mfma_f32_16x16x32_bf16 v[172:175], a[32:35], a[140:143], v[172:175]
s_nop 2
ds_write_b128 v9, v[24:27]
v_lshlrev_b32 v9, 4, v1
v_mfma_f32_16x16x32_bf16 v[188:191], a[36:39], a[140:143], v[188:191]
ds_read_b64_tr_b16 a[8:9], v16 offset:42304
v_add_u32 v9, 159488, v9
v_mfma_f32_16x16x32_bf16 v[204:207], a[40:43], a[140:143], v[204:207]
ds_read_b64_tr_b16 a[10:11], v16 offset:42816
v_mfma_f32_16x16x32_bf16 v[220:223], a[44:47], a[140:143], v[220:223]
ds_read_b64_tr_b16 a[12:13], v16 offset:42336
v_mfma_f32_16x16x32_bf16 v[224:227], a[48:51], a[128:131], v[224:227]
ds_read_b64_tr_b16 a[14:15], v16 offset:42848
v_mfma_f32_16x16x32_bf16 v[232:235], a[52:55], a[128:131], v[232:235]
ds_read_b64_tr_b16 a[16:17], v16 offset:50752
v_mfma_f32_16x16x32_bf16 v[240:243], a[56:59], a[128:131], v[240:243]
ds_read_b64_tr_b16 a[18:19], v16 offset:51264
v_mfma_f32_16x16x32_bf16 v[248:251], a[60:63], a[128:131], v[248:251]
ds_read_b64_tr_b16 a[20:21], v16 offset:50784
v_mfma_f32_16x16x32_bf16 v[228:231], a[48:51], a[132:135], v[228:231]
s_waitcnt lgkmcnt(7)
s_barrier
ds_read_b128 v[20:23], v9
v_mfma_f32_16x16x32_bf16 v[236:239], a[52:55], a[132:135], v[236:239]
ds_read_b128 v[24:27], v9 offset:1024
v_mfma_f32_16x16x32_bf16 v[244:247], a[56:59], a[132:135], v[244:247]
ds_read_b64_tr_b16 a[22:23], v16 offset:51296
v_mfma_f32_16x16x32_bf16 v[252:255], a[60:63], a[132:135], v[252:255]
ds_read_b64_tr_b16 a[24:25], v16 offset:59200
v_mfma_f32_16x16x32_bf16 v[32:35], a[64:67], a[144:147], v[32:35]
ds_read_b64_tr_b16 a[26:27], v16 offset:59712
v_mfma_f32_16x16x32_bf16 v[48:51], a[68:71], a[144:147], v[48:51]
ds_read_b64_tr_b16 a[28:29], v16 offset:59232
v_mfma_f32_16x16x32_bf16 v[64:67], a[72:75], a[144:147], v[64:67]
ds_read_b64_tr_b16 a[30:31], v16 offset:59744
v_mfma_f32_16x16x32_bf16 v[80:83], a[76:79], a[144:147], v[80:83]
ds_read_b64_tr_b16 a[32:33], v16 offset:17024
v_mfma_f32_16x16x32_bf16 v[32:35], a[80:83], a[160:163], v[32:35]
ds_read_b64_tr_b16 a[34:35], v16 offset:17536
v_mfma_f32_16x16x32_bf16 v[48:51], a[84:87], a[160:163], v[48:51]
ds_read_b64_tr_b16 a[36:37], v16 offset:17056
s_waitcnt lgkmcnt(8)
v_add_f32 v20, v20, v24
v_mfma_f32_16x16x32_bf16 v[64:67], a[88:91], a[160:163], v[64:67]
ds_read_b64_tr_b16 a[38:39], v16 offset:17568
v_add_f32 v21, v21, v25
v_mfma_f32_16x16x32_bf16 v[80:83], a[92:95], a[160:163], v[80:83]
ds_read_b64 v[24:25], v8
v_add_f32 v22, v22, v26
s_waitcnt vmcnt(3)
v_mfma_f32_16x16x32_bf16 v[32:35], a[96:99], a[176:179], v[32:35]
ds_read_b64_tr_b16 a[40:41], v16 offset:25472
v_add_f32 v23, v23, v27
v_mfma_f32_16x16x32_bf16 v[48:51], a[100:103], a[176:179], v[48:51]
ds_write_b128 v9, v[20:23] offset:2048
v_lshrrev_b32 v9, 4, v1
v_mfma_f32_16x16x32_bf16 v[64:67], a[104:107], a[176:179], v[64:67]
ds_read_b64 v[20:21], v2
v_lshlrev_b32 v9, 4, v9
v_mfma_f32_16x16x32_bf16 v[80:83], a[108:111], a[176:179], v[80:83]
ds_read_b64 v[22:23], v2 offset:256
ds_read_b64 v[26:27], v8 offset:256
v_add_u32 v8, s75, v9
v_add_u32 v9, s74, v9
ds_read_b128 v[12:15], v9
ds_read_b128 v[4:7], v9 offset:64
ds_read_b64_tr_b16 a[42:43], v16 offset:25984
ds_read_b64_tr_b16 a[44:45], v16 offset:25504
ds_read_b64_tr_b16 a[46:47], v16 offset:26016
ds_read_b64_tr_b16 a[48:49], v16 offset:33920
ds_read_b64_tr_b16 a[50:51], v16 offset:34432
ds_read_b64_tr_b16 a[52:53], v16 offset:33952
ds_read_b64_tr_b16 a[54:55], v16 offset:34464
ds_read_b64_tr_b16 a[56:57], v16 offset:42368
ds_read_b64_tr_b16 a[58:59], v16 offset:42880
ds_read_b64_tr_b16 a[60:61], v16 offset:42400
ds_read_b64_tr_b16 a[62:63], v16 offset:42912
s_waitcnt lgkmcnt(12)
v_pk_fma_f32 v[32:33], v[12:13], v[20:21], v[32:33] op_sel_hi:[1,0,1]
v_pk_fma_f32 v[34:35], v[14:15], v[20:21], v[34:35] op_sel_hi:[1,0,1]
v_pk_fma_f32 v[36:37], v[12:13], v[22:23], v[36:37] op_sel_hi:[1,0,1]
v_pk_fma_f32 v[38:39], v[14:15], v[22:23], v[38:39] op_sel_hi:[1,0,1]
v_pk_fma_f32 v[40:41], v[12:13], v[24:25], v[40:41] op_sel_hi:[1,0,1]
v_pk_fma_f32 v[42:43], v[14:15], v[24:25], v[42:43] op_sel_hi:[1,0,1]
v_pk_fma_f32 v[44:45], v[12:13], v[26:27], v[44:45] op_sel_hi:[1,0,1]
v_pk_fma_f32 v[46:47], v[14:15], v[26:27], v[46:47] op_sel_hi:[1,0,1]
ds_read_b128 v[12:15], v9 offset:512
s_waitcnt lgkmcnt(12)
v_pk_fma_f32 v[48:49], v[4:5], v[20:21], v[48:49] op_sel_hi:[1,0,1]
v_pk_fma_f32 v[50:51], v[6:7], v[20:21], v[50:51] op_sel_hi:[1,0,1]
v_pk_fma_f32 v[52:53], v[4:5], v[22:23], v[52:53] op_sel_hi:[1,0,1]
v_pk_fma_f32 v[54:55], v[6:7], v[22:23], v[54:55] op_sel_hi:[1,0,1]
v_pk_fma_f32 v[56:57], v[4:5], v[24:25], v[56:57] op_sel_hi:[1,0,1]
v_pk_fma_f32 v[58:59], v[6:7], v[24:25], v[58:59] op_sel_hi:[1,0,1]
v_pk_fma_f32 v[60:61], v[4:5], v[26:27], v[60:61] op_sel_hi:[1,0,1]
v_pk_fma_f32 v[62:63], v[6:7], v[26:27], v[62:63] op_sel_hi:[1,0,1]
ds_read_b128 v[4:7], v9 offset:576
s_waitcnt lgkmcnt(1)
v_pk_fma_f32 v[64:65], v[12:13], v[20:21], v[64:65] op_sel_hi:[1,0,1]
v_pk_fma_f32 v[66:67], v[14:15], v[20:21], v[66:67] op_sel_hi:[1,0,1]
v_pk_fma_f32 v[68:69], v[12:13], v[22:23], v[68:69] op_sel_hi:[1,0,1]
v_pk_fma_f32 v[70:71], v[14:15], v[22:23], v[70:71] op_sel_hi:[1,0,1]
v_pk_fma_f32 v[72:73], v[12:13], v[24:25], v[72:73] op_sel_hi:[1,0,1]
v_pk_fma_f32 v[74:75], v[14:15], v[24:25], v[74:75] op_sel_hi:[1,0,1]
v_pk_fma_f32 v[76:77], v[12:13], v[26:27], v[76:77] op_sel_hi:[1,0,1]
v_pk_fma_f32 v[78:79], v[14:15], v[26:27], v[78:79] op_sel_hi:[1,0,1]
ds_read_b128 v[12:15], v9 offset:832
s_waitcnt lgkmcnt(1)
v_pk_fma_f32 v[80:81], v[4:5], v[20:21], v[80:81] op_sel_hi:[1,0,1]
v_pk_fma_f32 v[82:83], v[6:7], v[20:21], v[82:83] op_sel_hi:[1,0,1]
v_pk_fma_f32 v[84:85], v[4:5], v[22:23], v[84:85] op_sel_hi:[1,0,1]
v_pk_fma_f32 v[86:87], v[6:7], v[22:23], v[86:87] op_sel_hi:[1,0,1]
v_pk_fma_f32 v[88:89], v[4:5], v[24:25], v[88:89] op_sel_hi:[1,0,1]
v_pk_fma_f32 v[90:91], v[6:7], v[24:25], v[90:91] op_sel_hi:[1,0,1]
v_pk_fma_f32 v[92:93], v[4:5], v[26:27], v[92:93] op_sel_hi:[1,0,1]
v_pk_fma_f32 v[94:95], v[6:7], v[26:27], v[94:95] op_sel_hi:[1,0,1]
ds_read_b128 v[4:7], v9 offset:704
v_pk_mul_f32 v[64:65], v[64:65], v[32:33]
v_pk_mul_f32 v[32:33], v[32:33], v[28:29] op_sel_hi:[1,0]
v_pk_mul_f32 v[66:67], v[66:67], v[34:35]
v_pk_mul_f32 v[34:35], v[34:35], v[28:29] op_sel_hi:[1,0]
v_pk_mul_f32 v[80:81], v[80:81], v[48:49]
v_pk_mul_f32 v[48:49], v[48:49], v[28:29] op_sel_hi:[1,0]
v_pk_mul_f32 v[82:83], v[82:83], v[50:51]
v_pk_mul_f32 v[50:51], v[50:51], v[28:29] op_sel_hi:[1,0]
v_exp_f32 v32, v32
s_nop 0
v_mfma_f32_16x16x32_bf16 v[36:39], a[64:67], a[148:151], v[36:39]
v_exp_f32 v33, v33
v_mfma_f32_16x16x32_bf16 v[52:55], a[68:71], a[148:151], v[52:55]
v_exp_f32 v34, v34
v_mfma_f32_16x16x32_bf16 v[68:71], a[72:75], a[148:151], v[68:71]
v_exp_f32 v35, v35
v_mfma_f32_16x16x32_bf16 v[84:87], a[76:79], a[148:151], v[84:87]
v_exp_f32 v48, v48
v_mfma_f32_16x16x32_bf16 v[36:39], a[80:83], a[164:167], v[36:39]
v_exp_f32 v49, v49
v_mfma_f32_16x16x32_bf16 v[52:55], a[84:87], a[164:167], v[52:55]
v_exp_f32 v50, v50
v_mfma_f32_16x16x32_bf16 v[68:71], a[88:91], a[164:167], v[68:71]
v_exp_f32 v51, v51
v_mfma_f32_16x16x32_bf16 v[84:87], a[92:95], a[164:167], v[84:87]
s_waitcnt vmcnt(2)
v_mfma_f32_16x16x32_bf16 v[36:39], a[96:99], a[180:183], v[36:39]
v_mfma_f32_16x16x32_bf16 v[52:55], a[100:103], a[180:183], v[52:55]
v_mfma_f32_16x16x32_bf16 v[68:71], a[104:107], a[180:183], v[68:71]
v_mfma_f32_16x16x32_bf16 v[84:87], a[108:111], a[180:183], v[84:87]
s_nop 6
v_pk_mul_f32 v[68:69], v[68:69], v[36:37]
v_pk_mul_f32 v[36:37], v[36:37], v[28:29] op_sel:[0,1] op_sel_hi:[1,1]
v_pk_mul_f32 v[70:71], v[70:71], v[38:39]
.Lpad13:
s_cbranch_execz .Lnopoll28r
v_pk_mul_f32 v[38:39], v[38:39], v[28:29] op_sel:[0,1] op_sel_hi:[1,1]
v_pk_mul_f32 v[84:85], v[84:85], v[52:53]
v_pk_mul_f32 v[52:53], v[52:53], v[28:29] op_sel:[0,1] op_sel_hi:[1,1]
v_pk_mul_f32 v[86:87], v[86:87], v[54:55]
v_pk_mul_f32 v[54:55], v[54:55], v[28:29] op_sel:[0,1] op_sel_hi:[1,1]
v_pk_fma_f32 v[32:33], v[32:33], v[20:21], v[20:21] op_sel:[0,1,1] op_sel_hi:[1,1,1]
v_pk_fma_f32 v[34:35], v[34:35], v[20:21], v[20:21] op_sel:[0,1,1] op_sel_hi:[1,1,1]
v_pk_fma_f32 v[48:49], v[48:49], v[20:21], v[20:21] op_sel:[0,1,1] op_sel_hi:[1,1,1]
v_pk_fma_f32 v[50:51], v[50:51], v[20:21], v[20:21] op_sel:[0,1,1] op_sel_hi:[1,1,1]
v_rcp_f32 v32, v32
s_nop 0
v_mfma_f32_16x16x32_bf16 v[40:43], a[64:67], a[152:155], v[40:43]
v_rcp_f32 v33, v33
v_mfma_f32_16x16x32_bf16 v[56:59], a[68:71], a[152:155], v[56:59]
v_rcp_f32 v34, v34
v_mfma_f32_16x16x32_bf16 v[72:75], a[72:75], a[152:155], v[72:75]
v_rcp_f32 v35, v35
v_mfma_f32_16x16x32_bf16 v[88:91], a[76:79], a[152:155], v[88:91]
v_rcp_f32 v48, v48
v_mfma_f32_16x16x32_bf16 v[40:43], a[80:83], a[168:171], v[40:43]
v_rcp_f32 v49, v49
v_mfma_f32_16x16x32_bf16 v[56:59], a[84:87], a[168:171], v[56:59]
v_rcp_f32 v50, v50
v_mfma_f32_16x16x32_bf16 v[72:75], a[88:91], a[168:171], v[72:75]
v_rcp_f32 v51, v51
v_mfma_f32_16x16x32_bf16 v[88:91], a[92:95], a[168:171], v[88:91]
v_exp_f32 v36, v36
s_waitcnt vmcnt(1)
v_mfma_f32_16x16x32_bf16 v[40:43], a[96:99], a[184:187], v[40:43]
v_exp_f32 v37, v37
v_mfma_f32_16x16x32_bf16 v[56:59], a[100:103], a[184:187], v[56:59]
v_exp_f32 v38, v38
v_mfma_f32_16x16x32_bf16 v[72:75], a[104:107], a[184:187], v[72:75]
v_exp_f32 v39, v39
v_mfma_f32_16x16x32_bf16 v[88:91], a[108:111], a[184:187], v[88:91]
v_exp_f32 v52, v52
v_exp_f32 v53, v53
v_exp_f32 v54, v54
v_exp_f32 v55, v55
v_pk_mul_f32 v[64:65], v[64:65], v[32:33]
v_pk_mul_f32 v[66:67], v[66:67], v[34:35]
v_pk_mul_f32 v[80:81], v[80:81], v[48:49]
v_pk_mul_f32 v[82:83], v[82:83], v[50:51]
ds_read_b128 v[48:51], v9 offset:128
v_pk_mul_f32 v[72:73], v[72:73], v[40:41]
v_pk_mul_f32 v[40:41], v[40:41], v[30:31] op_sel_hi:[1,0]
v_pk_mul_f32 v[74:75], v[74:75], v[42:43]
v_pk_mul_f32 v[42:43], v[42:43], v[30:31] op_sel_hi:[1,0]
v_pk_mul_f32 v[88:89], v[88:89], v[56:57]
v_pk_mul_f32 v[56:57], v[56:57], v[30:31] op_sel_hi:[1,0]
v_pk_mul_f32 v[90:91], v[90:91], v[58:59]
v_pk_mul_f32 v[58:59], v[58:59], v[30:31] op_sel_hi:[1,0]
v_pk_fma_f32 v[36:37], v[36:37], v[22:23], v[22:23] op_sel:[0,1,1] op_sel_hi:[1,1,1]
v_pk_fma_f32 v[38:39], v[38:39], v[22:23], v[22:23] op_sel:[0,1,1] op_sel_hi:[1,1,1]
v_pk_fma_f32 v[52:53], v[52:53], v[22:23], v[22:23] op_sel:[0,1,1] op_sel_hi:[1,1,1]
v_pk_fma_f32 v[54:55], v[54:55], v[22:23], v[22:23] op_sel:[0,1,1] op_sel_hi:[1,1,1]
v_cvt_pk_bf16_f32 v32, v64, v65
v_cvt_pk_bf16_f32 v33, v66, v67
ds_read_b128 v[64:67], v9 offset:192
v_cvt_pk_bf16_f32 v34, v80, v81
v_cvt_pk_bf16_f32 v35, v82, v83
v_mfma_f32_16x16x32_bf16 v[44:47], a[64:67], a[156:159], v[44:47]
buffer_store_dwordx4 v[32:35], v10, s[16:19], s62 offen sc1
v_mfma_f32_16x16x32_bf16 v[60:63], a[68:71], a[156:159], v[60:63]
ds_read_b128 v[80:83], v9 offset:640
v_rcp_f32 v36, v36
v_mfma_f32_16x16x32_bf16 v[76:79], a[72:75], a[156:159], v[76:79]
ds_read_b64_tr_b16 a[64:65], v16 offset:50816
v_rcp_f32 v37, v37
v_mfma_f32_16x16x32_bf16 v[92:95], a[76:79], a[156:159], v[92:95]
ds_read_b64_tr_b16 a[66:67], v16 offset:51328
v_rcp_f32 v38, v38
v_mfma_f32_16x16x32_bf16 v[44:47], a[80:83], a[172:175], v[44:47]
ds_read_b64_tr_b16 a[68:69], v16 offset:50848
v_rcp_f32 v39, v39
v_mfma_f32_16x16x32_bf16 v[60:63], a[84:87], a[172:175], v[60:63]
ds_read_b64_tr_b16 a[70:71], v16 offset:51360
v_rcp_f32 v52, v52
v_mfma_f32_16x16x32_bf16 v[76:79], a[88:91], a[172:175], v[76:79]
ds_read_b64_tr_b16 a[72:73], v16 offset:59264
v_rcp_f32 v53, v53
v_mfma_f32_16x16x32_bf16 v[92:95], a[92:95], a[172:175], v[92:95]
ds_read_b64_tr_b16 a[74:75], v16 offset:59776
v_rcp_f32 v54, v54
s_waitcnt vmcnt(1)
v_mfma_f32_16x16x32_bf16 v[44:47], a[96:99], a[188:191], v[44:47]
ds_read_b64_tr_b16 a[76:77], v16 offset:59296
v_rcp_f32 v55, v55
v_mfma_f32_16x16x32_bf16 v[60:63], a[100:103], a[188:191], v[60:63]
ds_read_b64_tr_b16 a[78:79], v16 offset:59808
v_exp_f32 v40, v40
v_mfma_f32_16x16x32_bf16 v[76:79], a[104:107], a[188:191], v[76:79]
ds_read_b64_tr_b16 a[80:81], v17 offset:16896
v_exp_f32 v41, v41
v_mfma_f32_16x16x32_bf16 v[92:95], a[108:111], a[188:191], v[92:95]
ds_read_b64_tr_b16 a[82:83], v17 offset:17408
v_exp_f32 v42, v42
v_exp_f32 v43, v43
v_exp_f32 v56, v56
v_exp_f32 v57, v57
v_exp_f32 v58, v58
v_exp_f32 v59, v59
v_pk_mul_f32 v[68:69], v[68:69], v[36:37]
v_pk_mul_f32 v[70:71], v[70:71], v[38:39]
v_pk_mul_f32 v[84:85], v[84:85], v[52:53]
v_pk_mul_f32 v[86:87], v[86:87], v[54:55]
v_pk_mul_f32 v[76:77], v[76:77], v[44:45]
v_pk_mul_f32 v[44:45], v[44:45], v[30:31] op_sel:[0,1] op_sel_hi:[1,1]
v_pk_mul_f32 v[78:79], v[78:79], v[46:47]
v_pk_mul_f32 v[46:47], v[46:47], v[30:31] op_sel:[0,1] op_sel_hi:[1,1]
v_pk_mul_f32 v[92:93], v[92:93], v[60:61]
v_pk_mul_f32 v[60:61], v[60:61], v[30:31] op_sel:[0,1] op_sel_hi:[1,1]
v_pk_mul_f32 v[94:95], v[94:95], v[62:63]
v_pk_mul_f32 v[62:63], v[62:63], v[30:31] op_sel:[0,1] op_sel_hi:[1,1]
v_pk_fma_f32 v[40:41], v[40:41], v[24:25], v[24:25] op_sel:[0,1,1] op_sel_hi:[1,1,1]
v_pk_fma_f32 v[42:43], v[42:43], v[24:25], v[24:25] op_sel:[0,1,1] op_sel_hi:[1,1,1]
v_pk_fma_f32 v[56:57], v[56:57], v[24:25], v[24:25] op_sel:[0,1,1] op_sel_hi:[1,1,1]
v_pk_fma_f32 v[58:59], v[58:59], v[24:25], v[24:25] op_sel:[0,1,1] op_sel_hi:[1,1,1]
v_cvt_pk_bf16_f32 v36, v68, v69
v_cvt_pk_bf16_f32 v37, v70, v71
v_cvt_pk_bf16_f32 v38, v84, v85
v_cvt_pk_bf16_f32 v39, v86, v87
v_mfma_f32_16x16x32_bf16 v[96:99], a[112:115], a[144:147], v[96:99]
buffer_store_dwordx4 v[36:39], v10, s[16:19], s62 offen offset:1024 sc1
v_mfma_f32_16x16x32_bf16 v[112:115], a[116:119], a[144:147], v[112:115]
ds_read_b64_tr_b16 a[84:85], v17 offset:16928
v_rcp_f32 v40, v40
v_mfma_f32_16x16x32_bf16 v[128:131], a[120:123], a[144:147], v[128:131]
ds_read_b64_tr_b16 a[86:87], v17 offset:17440
v_rcp_f32 v41, v41
v_mfma_f32_16x16x32_bf16 v[144:147], a[124:127], a[144:147], v[144:147]
ds_read_b64_tr_b16 a[88:89], v17 offset:25344
v_rcp_f32 v42, v42
v_mfma_f32_16x16x32_bf16 v[96:99], a[0:3], a[160:163], v[96:99]
ds_read_b64_tr_b16 a[90:91], v17 offset:25856
v_rcp_f32 v43, v43
v_mfma_f32_16x16x32_bf16 v[112:115], a[4:7], a[160:163], v[112:115]
ds_read_b64_tr_b16 a[92:93], v17 offset:25376
v_rcp_f32 v56, v56
v_mfma_f32_16x16x32_bf16 v[128:131], a[8:11], a[160:163], v[128:131]
ds_read_b64_tr_b16 a[94:95], v17 offset:25888
v_rcp_f32 v57, v57
v_mfma_f32_16x16x32_bf16 v[144:147], a[12:15], a[160:163], v[144:147]
ds_read_b64_tr_b16 a[96:97], v17 offset:33792
v_rcp_f32 v58, v58
v_mfma_f32_16x16x32_bf16 v[96:99], a[16:19], a[176:179], v[96:99]
ds_read_b64_tr_b16 a[98:99], v17 offset:34304
v_rcp_f32 v59, v59
v_mfma_f32_16x16x32_bf16 v[112:115], a[20:23], a[176:179], v[112:115]
ds_read_b64_tr_b16 a[100:101], v17 offset:33824
v_exp_f32 v44, v44
v_mfma_f32_16x16x32_bf16 v[128:131], a[24:27], a[176:179], v[128:131]
ds_read_b64_tr_b16 a[102:103], v17 offset:34336
v_exp_f32 v45, v45
v_mfma_f32_16x16x32_bf16 v[144:147], a[28:31], a[176:179], v[144:147]
ds_read_b64_tr_b16 a[104:105], v17 offset:42240
v_exp_f32 v46, v46
v_exp_f32 v47, v47
v_exp_f32 v60, v60
v_exp_f32 v61, v61
v_exp_f32 v62, v62
v_exp_f32 v63, v63
v_pk_mul_f32 v[72:73], v[72:73], v[40:41]
v_pk_mul_f32 v[74:75], v[74:75], v[42:43]
v_pk_mul_f32 v[88:89], v[88:89], v[56:57]
v_pk_mul_f32 v[90:91], v[90:91], v[58:59]
s_waitcnt lgkmcnt(15)
v_pk_fma_f32 v[96:97], v[48:49], v[20:21], v[96:97] op_sel_hi:[1,0,1]
v_pk_fma_f32 v[98:99], v[50:51], v[20:21], v[98:99] op_sel_hi:[1,0,1]
v_pk_fma_f32 v[112:113], v[64:65], v[20:21], v[112:113] op_sel_hi:[1,0,1]
v_pk_fma_f32 v[114:115], v[66:67], v[20:21], v[114:115] op_sel_hi:[1,0,1]
v_pk_fma_f32 v[128:129], v[80:81], v[20:21], v[128:129] op_sel_hi:[1,0,1]
v_pk_fma_f32 v[130:131], v[82:83], v[20:21], v[130:131] op_sel_hi:[1,0,1]
v_pk_fma_f32 v[144:145], v[4:5], v[20:21], v[144:145] op_sel_hi:[1,0,1]
v_pk_fma_f32 v[146:147], v[6:7], v[20:21], v[146:147] op_sel_hi:[1,0,1]
v_pk_mul_f32 v[128:129], v[128:129], v[96:97]
v_pk_mul_f32 v[96:97], v[96:97], v[28:29] op_sel_hi:[1,0]
v_pk_mul_f32 v[130:131], v[130:131], v[98:99]
v_pk_mul_f32 v[98:99], v[98:99], v[28:29] op_sel_hi:[1,0]
v_pk_mul_f32 v[144:145], v[144:145], v[112:113]
v_pk_mul_f32 v[112:113], v[112:113], v[28:29] op_sel_hi:[1,0]
v_pk_mul_f32 v[146:147], v[146:147], v[114:115]
v_pk_mul_f32 v[114:115], v[114:115], v[28:29] op_sel_hi:[1,0]
v_pk_fma_f32 v[44:45], v[44:45], v[26:27], v[26:27] op_sel:[0,1,1] op_sel_hi:[1,1,1]
v_pk_fma_f32 v[46:47], v[46:47], v[26:27], v[26:27] op_sel:[0,1,1] op_sel_hi:[1,1,1]
v_pk_fma_f32 v[60:61], v[60:61], v[26:27], v[26:27] op_sel:[0,1,1] op_sel_hi:[1,1,1]
v_pk_fma_f32 v[62:63], v[62:63], v[26:27], v[26:27] op_sel:[0,1,1] op_sel_hi:[1,1,1]
v_cvt_pk_bf16_f32 v40, v72, v73
v_cvt_pk_bf16_f32 v41, v74, v75
v_cvt_pk_bf16_f32 v42, v88, v89
v_cvt_pk_bf16_f32 v43, v90, v91
v_mfma_f32_16x16x32_bf16 v[100:103], a[112:115], a[148:151], v[100:103]
buffer_store_dwordx4 v[40:43], v11, s[16:19], s62 offen sc1
v_mfma_f32_16x16x32_bf16 v[116:119], a[116:119], a[148:151], v[116:119]
ds_read_b64_tr_b16 a[106:107], v17 offset:42752
v_rcp_f32 v44, v44
v_mfma_f32_16x16x32_bf16 v[132:135], a[120:123], a[148:151], v[132:135]
ds_read_b64_tr_b16 a[108:109], v17 offset:42272
v_rcp_f32 v45, v45
v_mfma_f32_16x16x32_bf16 v[148:151], a[124:127], a[148:151], v[148:151]
ds_read_b64_tr_b16 a[110:111], v17 offset:42784
v_rcp_f32 v46, v46
v_mfma_f32_16x16x32_bf16 v[100:103], a[0:3], a[164:167], v[100:103]
v_rcp_f32 v47, v47
v_mfma_f32_16x16x32_bf16 v[116:119], a[4:7], a[164:167], v[116:119]
v_rcp_f32 v60, v60
v_mfma_f32_16x16x32_bf16 v[132:135], a[8:11], a[164:167], v[132:135]
v_rcp_f32 v61, v61
v_mfma_f32_16x16x32_bf16 v[148:151], a[12:15], a[164:167], v[148:151]
v_rcp_f32 v62, v62
v_mfma_f32_16x16x32_bf16 v[100:103], a[16:19], a[180:183], v[100:103]
v_rcp_f32 v63, v63
v_mfma_f32_16x16x32_bf16 v[116:119], a[20:23], a[180:183], v[116:119]
v_exp_f32 v96, v96
v_mfma_f32_16x16x32_bf16 v[132:135], a[24:27], a[180:183], v[132:135]
v_exp_f32 v97, v97
v_mfma_f32_16x16x32_bf16 v[148:151], a[28:31], a[180:183], v[148:151]
v_exp_f32 v98, v98
v_exp_f32 v99, v99
v_exp_f32 v112, v112
v_exp_f32 v113, v113
v_exp_f32 v114, v114
v_exp_f32 v115, v115
v_pk_mul_f32 v[76:77], v[76:77], v[44:45]
v_pk_mul_f32 v[78:79], v[78:79], v[46:47]
v_pk_mul_f32 v[92:93], v[92:93], v[60:61]
v_pk_mul_f32 v[94:95], v[94:95], v[62:63]
v_pk_fma_f32 v[100:101], v[48:49], v[22:23], v[100:101] op_sel_hi:[1,0,1]
v_pk_fma_f32 v[102:103], v[50:51], v[22:23], v[102:103] op_sel_hi:[1,0,1]
v_pk_fma_f32 v[116:117], v[64:65], v[22:23], v[116:117] op_sel_hi:[1,0,1]
v_pk_fma_f32 v[118:119], v[66:67], v[22:23], v[118:119] op_sel_hi:[1,0,1]
v_pk_fma_f32 v[132:133], v[80:81], v[22:23], v[132:133] op_sel_hi:[1,0,1]
v_pk_fma_f32 v[134:135], v[82:83], v[22:23], v[134:135] op_sel_hi:[1,0,1]
v_pk_fma_f32 v[148:149], v[4:5], v[22:23], v[148:149] op_sel_hi:[1,0,1]
v_pk_fma_f32 v[150:151], v[6:7], v[22:23], v[150:151] op_sel_hi:[1,0,1]
v_pk_mul_f32 v[132:133], v[132:133], v[100:101]
v_pk_mul_f32 v[100:101], v[100:101], v[28:29] op_sel:[0,1] op_sel_hi:[1,1]
v_pk_mul_f32 v[134:135], v[134:135], v[102:103]
v_pk_mul_f32 v[102:103], v[102:103], v[28:29] op_sel:[0,1] op_sel_hi:[1,1]
v_pk_mul_f32 v[148:149], v[148:149], v[116:117]
v_pk_mul_f32 v[116:117], v[116:117], v[28:29] op_sel:[0,1] op_sel_hi:[1,1]
v_pk_mul_f32 v[150:151], v[150:151], v[118:119]
v_pk_mul_f32 v[118:119], v[118:119], v[28:29] op_sel:[0,1] op_sel_hi:[1,1]
v_pk_fma_f32 v[96:97], v[96:97], v[20:21], v[20:21] op_sel:[0,1,1] op_sel_hi:[1,1,1]
v_pk_fma_f32 v[98:99], v[98:99], v[20:21], v[20:21] op_sel:[0,1,1] op_sel_hi:[1,1,1]
v_pk_fma_f32 v[112:113], v[112:113], v[20:21], v[20:21] op_sel:[0,1,1] op_sel_hi:[1,1,1]
v_pk_fma_f32 v[114:115], v[114:115], v[20:21], v[20:21] op_sel:[0,1,1] op_sel_hi:[1,1,1]
v_cvt_pk_bf16_f32 v44, v76, v77
v_cvt_pk_bf16_f32 v45, v78, v79
v_cvt_pk_bf16_f32 v46, v92, v93
v_cvt_pk_bf16_f32 v47, v94, v95
v_mfma_f32_16x16x32_bf16 v[104:107], a[112:115], a[152:155], v[104:107]
buffer_store_dwordx4 v[44:47], v11, s[16:19], s62 offen offset:1024 sc1
v_mfma_f32_16x16x32_bf16 v[120:123], a[116:119], a[152:155], v[120:123]
v_rcp_f32 v96, v96
v_mfma_f32_16x16x32_bf16 v[136:139], a[120:123], a[152:155], v[136:139]
v_rcp_f32 v97, v97
v_mfma_f32_16x16x32_bf16 v[152:155], a[124:127], a[152:155], v[152:155]
v_rcp_f32 v98, v98
v_mfma_f32_16x16x32_bf16 v[104:107], a[0:3], a[168:171], v[104:107]
v_rcp_f32 v99, v99
v_mfma_f32_16x16x32_bf16 v[120:123], a[4:7], a[168:171], v[120:123]
v_rcp_f32 v112, v112
v_mfma_f32_16x16x32_bf16 v[136:139], a[8:11], a[168:171], v[136:139]
v_rcp_f32 v113, v113
v_mfma_f32_16x16x32_bf16 v[152:155], a[12:15], a[168:171], v[152:155]
v_rcp_f32 v114, v114
v_mfma_f32_16x16x32_bf16 v[104:107], a[16:19], a[184:187], v[104:107]
v_rcp_f32 v115, v115
v_mfma_f32_16x16x32_bf16 v[120:123], a[20:23], a[184:187], v[120:123]
v_exp_f32 v100, v100
v_mfma_f32_16x16x32_bf16 v[136:139], a[24:27], a[184:187], v[136:139]
v_exp_f32 v101, v101
v_mfma_f32_16x16x32_bf16 v[152:155], a[28:31], a[184:187], v[152:155]
v_exp_f32 v102, v102
v_exp_f32 v103, v103
v_exp_f32 v116, v116
v_exp_f32 v117, v117
v_exp_f32 v118, v118
v_exp_f32 v119, v119
v_pk_mul_f32 v[128:129], v[128:129], v[96:97]
v_pk_mul_f32 v[130:131], v[130:131], v[98:99]
v_pk_mul_f32 v[144:145], v[144:145], v[112:113]
v_pk_mul_f32 v[146:147], v[146:147], v[114:115]
ds_read_b128 v[112:115], v9 offset:256
v_pk_fma_f32 v[104:105], v[48:49], v[24:25], v[104:105] op_sel_hi:[1,0,1]
v_pk_fma_f32 v[106:107], v[50:51], v[24:25], v[106:107] op_sel_hi:[1,0,1]
v_pk_fma_f32 v[120:121], v[64:65], v[24:25], v[120:121] op_sel_hi:[1,0,1]
v_pk_fma_f32 v[122:123], v[66:67], v[24:25], v[122:123] op_sel_hi:[1,0,1]
v_pk_fma_f32 v[136:137], v[80:81], v[24:25], v[136:137] op_sel_hi:[1,0,1]
v_pk_fma_f32 v[138:139], v[82:83], v[24:25], v[138:139] op_sel_hi:[1,0,1]
v_pk_fma_f32 v[152:153], v[4:5], v[24:25], v[152:153] op_sel_hi:[1,0,1]
v_pk_fma_f32 v[154:155], v[6:7], v[24:25], v[154:155] op_sel_hi:[1,0,1]
v_pk_mul_f32 v[136:137], v[136:137], v[104:105]
v_pk_mul_f32 v[104:105], v[104:105], v[30:31] op_sel_hi:[1,0]
v_pk_mul_f32 v[138:139], v[138:139], v[106:107]
v_pk_mul_f32 v[106:107], v[106:107], v[30:31] op_sel_hi:[1,0]
v_pk_mul_f32 v[152:153], v[152:153], v[120:121]
v_pk_mul_f32 v[120:121], v[120:121], v[30:31] op_sel_hi:[1,0]
v_pk_mul_f32 v[154:155], v[154:155], v[122:123]
v_pk_mul_f32 v[122:123], v[122:123], v[30:31] op_sel_hi:[1,0]
v_pk_fma_f32 v[100:101], v[100:101], v[22:23], v[22:23] op_sel:[0,1,1] op_sel_hi:[1,1,1]
v_pk_fma_f32 v[102:103], v[102:103], v[22:23], v[22:23] op_sel:[0,1,1] op_sel_hi:[1,1,1]
v_pk_fma_f32 v[116:117], v[116:117], v[22:23], v[22:23] op_sel:[0,1,1] op_sel_hi:[1,1,1]
v_pk_fma_f32 v[118:119], v[118:119], v[22:23], v[22:23] op_sel:[0,1,1] op_sel_hi:[1,1,1]
v_cvt_pk_bf16_f32 v96, v128, v129
v_cvt_pk_bf16_f32 v97, v130, v131
ds_read_b128 v[128:131], v9 offset:320
v_cvt_pk_bf16_f32 v98, v144, v145
v_cvt_pk_bf16_f32 v99, v146, v147
v_mfma_f32_16x16x32_bf16 v[108:111], a[112:115], a[156:159], v[108:111]
buffer_store_dwordx4 v[96:99], v10, s[16:19], s63 offen sc1
v_mfma_f32_16x16x32_bf16 v[124:127], a[116:119], a[156:159], v[124:127]
ds_read_b128 v[144:147], v9 offset:768
v_rcp_f32 v100, v100
v_mfma_f32_16x16x32_bf16 v[140:143], a[120:123], a[156:159], v[140:143]
ds_read_b64_tr_b16 a[112:113], v17 offset:50688
v_rcp_f32 v101, v101
v_mfma_f32_16x16x32_bf16 v[156:159], a[124:127], a[156:159], v[156:159]
ds_read_b64_tr_b16 a[114:115], v17 offset:51200
v_rcp_f32 v102, v102
v_mfma_f32_16x16x32_bf16 v[108:111], a[0:3], a[172:175], v[108:111]
ds_read_b64_tr_b16 a[116:117], v17 offset:50720
v_rcp_f32 v103, v103
v_mfma_f32_16x16x32_bf16 v[124:127], a[4:7], a[172:175], v[124:127]
ds_read_b64_tr_b16 a[118:119], v17 offset:51232
v_rcp_f32 v116, v116
v_mfma_f32_16x16x32_bf16 v[140:143], a[8:11], a[172:175], v[140:143]
ds_read_b64_tr_b16 a[120:121], v17 offset:59136
v_rcp_f32 v117, v117
v_mfma_f32_16x16x32_bf16 v[156:159], a[12:15], a[172:175], v[156:159]
ds_read_b64_tr_b16 a[122:123], v17 offset:59648
v_rcp_f32 v118, v118
v_mfma_f32_16x16x32_bf16 v[108:111], a[16:19], a[188:191], v[108:111]
ds_read_b64_tr_b16 a[124:125], v17 offset:59168
v_rcp_f32 v119, v119
v_mfma_f32_16x16x32_bf16 v[124:127], a[20:23], a[188:191], v[124:127]
ds_read_b64_tr_b16 a[126:127], v17 offset:59680
v_exp_f32 v104, v104
v_mfma_f32_16x16x32_bf16 v[140:143], a[24:27], a[188:191], v[140:143]
v_exp_f32 v105, v105
v_mfma_f32_16x16x32_bf16 v[156:159], a[28:31], a[188:191], v[156:159]
v_exp_f32 v106, v106
v_exp_f32 v107, v107
v_exp_f32 v120, v120
v_exp_f32 v121, v121
v_exp_f32 v122, v122
v_exp_f32 v123, v123
v_pk_mul_f32 v[132:133], v[132:133], v[100:101]
v_pk_mul_f32 v[134:135], v[134:135], v[102:103]
v_pk_mul_f32 v[148:149], v[148:149], v[116:117]
v_pk_mul_f32 v[150:151], v[150:151], v[118:119]
v_pk_fma_f32 v[108:109], v[48:49], v[26:27], v[108:109] op_sel_hi:[1,0,1]
v_pk_fma_f32 v[110:111], v[50:51], v[26:27], v[110:111] op_sel_hi:[1,0,1]
v_pk_fma_f32 v[124:125], v[64:65], v[26:27], v[124:125] op_sel_hi:[1,0,1]
v_pk_fma_f32 v[126:127], v[66:67], v[26:27], v[126:127] op_sel_hi:[1,0,1]
v_pk_fma_f32 v[140:141], v[80:81], v[26:27], v[140:141] op_sel_hi:[1,0,1]
v_pk_fma_f32 v[142:143], v[82:83], v[26:27], v[142:143] op_sel_hi:[1,0,1]
s_waitcnt lgkmcnt(0)
s_barrier
v_pk_fma_f32 v[156:157], v[4:5], v[26:27], v[156:157] op_sel_hi:[1,0,1]
v_pk_fma_f32 v[158:159], v[6:7], v[26:27], v[158:159] op_sel_hi:[1,0,1]
ds_read_b128 v[4:7], v8 offset:576
v_pk_mul_f32 v[140:141], v[140:141], v[108:109]
v_pk_mul_f32 v[108:109], v[108:109], v[30:31] op_sel:[0,1] op_sel_hi:[1,1]
v_pk_mul_f32 v[142:143], v[142:143], v[110:111]
v_pk_mul_f32 v[110:111], v[110:111], v[30:31] op_sel:[0,1] op_sel_hi:[1,1]
v_pk_mul_f32 v[156:157], v[156:157], v[124:125]
v_pk_mul_f32 v[124:125], v[124:125], v[30:31] op_sel:[0,1] op_sel_hi:[1,1]
v_pk_mul_f32 v[158:159], v[158:159], v[126:127]
v_pk_mul_f32 v[126:127], v[126:127], v[30:31] op_sel:[0,1] op_sel_hi:[1,1]
v_pk_fma_f32 v[104:105], v[104:105], v[24:25], v[24:25] op_sel:[0,1,1] op_sel_hi:[1,1,1]
v_pk_fma_f32 v[106:107], v[106:107], v[24:25], v[24:25] op_sel:[0,1,1] op_sel_hi:[1,1,1]
v_pk_fma_f32 v[120:121], v[120:121], v[24:25], v[24:25] op_sel:[0,1,1] op_sel_hi:[1,1,1]
v_pk_fma_f32 v[122:123], v[122:123], v[24:25], v[24:25] op_sel:[0,1,1] op_sel_hi:[1,1,1]
v_cvt_pk_bf16_f32 v100, v132, v133
v_cvt_pk_bf16_f32 v101, v134, v135
v_cvt_pk_bf16_f32 v102, v148, v149
v_cvt_pk_bf16_f32 v103, v150, v151
v_mfma_f32_16x16x32_bf16 v[160:163], a[32:35], a[144:147], v[160:163]
buffer_store_dwordx4 v[100:103], v10, s[16:19], s63 offen offset:1024 sc1
v_mfma_f32_16x16x32_bf16 v[176:179], a[36:39], a[144:147], v[176:179]
s_add_u32 m0, s59, 84480
v_rcp_f32 v104, v104
v_mfma_f32_16x16x32_bf16 v[192:195], a[40:43], a[144:147], v[192:195]
v_rcp_f32 v105, v105
v_mfma_f32_16x16x32_bf16 v[208:211], a[44:47], a[144:147], v[208:211]
v_rcp_f32 v106, v106
v_mfma_f32_16x16x32_bf16 v[160:163], a[48:51], a[160:163], v[160:163]
buffer_load_dwordx4 v18, s[28:31], s58 offen lds
v_mfma_f32_16x16x32_bf16 v[176:179], a[52:55], a[160:163], v[176:179]
v_rcp_f32 v107, v107
v_mfma_f32_16x16x32_bf16 v[192:195], a[56:59], a[160:163], v[192:195]
v_rcp_f32 v120, v120
v_mfma_f32_16x16x32_bf16 v[208:211], a[60:63], a[160:163], v[208:211]
v_rcp_f32 v121, v121
v_mfma_f32_16x16x32_bf16 v[160:163], a[64:67], a[176:179], v[160:163]
buffer_load_dwordx4 v19, s[28:31], s58 offen offset:1056 lds
v_mfma_f32_16x16x32_bf16 v[176:179], a[68:71], a[176:179], v[176:179]
s_add_u32 m0, s59, 92928
s_mov_b32 s58, 720896
v_rcp_f32 v122, v122
v_mfma_f32_16x16x32_bf16 v[192:195], a[72:75], a[176:179], v[192:195]
v_rcp_f32 v123, v123
v_mfma_f32_16x16x32_bf16 v[208:211], a[76:79], a[176:179], v[208:211]
v_exp_f32 v108, v108
v_exp_f32 v109, v109
v_exp_f32 v110, v110
v_exp_f32 v111, v111
v_exp_f32 v124, v124
v_exp_f32 v125, v125
v_exp_f32 v126, v126
v_exp_f32 v127, v127
v_pk_mul_f32 v[136:137], v[136:137], v[104:105]
v_pk_mul_f32 v[138:139], v[138:139], v[106:107]
v_pk_mul_f32 v[152:153], v[152:153], v[120:121]
v_pk_mul_f32 v[154:155], v[154:155], v[122:123]
v_pk_fma_f32 v[160:161], v[112:113], v[20:21], v[160:161] op_sel_hi:[1,0,1]
v_pk_fma_f32 v[162:163], v[114:115], v[20:21], v[162:163] op_sel_hi:[1,0,1]
v_pk_fma_f32 v[176:177], v[128:129], v[20:21], v[176:177] op_sel_hi:[1,0,1]
v_pk_fma_f32 v[178:179], v[130:131], v[20:21], v[178:179] op_sel_hi:[1,0,1]
v_pk_fma_f32 v[192:193], v[144:145], v[20:21], v[192:193] op_sel_hi:[1,0,1]
v_pk_fma_f32 v[194:195], v[146:147], v[20:21], v[194:195] op_sel_hi:[1,0,1]
v_pk_fma_f32 v[208:209], v[12:13], v[20:21], v[208:209] op_sel_hi:[1,0,1]
v_pk_fma_f32 v[210:211], v[14:15], v[20:21], v[210:211] op_sel_hi:[1,0,1]
v_pk_mul_f32 v[192:193], v[192:193], v[160:161]
v_pk_mul_f32 v[160:161], v[160:161], v[28:29] op_sel_hi:[1,0]
v_pk_mul_f32 v[194:195], v[194:195], v[162:163]
v_pk_mul_f32 v[162:163], v[162:163], v[28:29] op_sel_hi:[1,0]
v_pk_mul_f32 v[208:209], v[208:209], v[176:177]
v_pk_mul_f32 v[176:177], v[176:177], v[28:29] op_sel_hi:[1,0]
v_pk_mul_f32 v[210:211], v[210:211], v[178:179]
v_pk_mul_f32 v[178:179], v[178:179], v[28:29] op_sel_hi:[1,0]
v_pk_fma_f32 v[108:109], v[108:109], v[26:27], v[26:27] op_sel:[0,1,1] op_sel_hi:[1,1,1]
v_pk_fma_f32 v[110:111], v[110:111], v[26:27], v[26:27] op_sel:[0,1,1] op_sel_hi:[1,1,1]
v_pk_fma_f32 v[124:125], v[124:125], v[26:27], v[26:27] op_sel:[0,1,1] op_sel_hi:[1,1,1]
v_pk_fma_f32 v[126:127], v[126:127], v[26:27], v[26:27] op_sel:[0,1,1] op_sel_hi:[1,1,1]
v_cvt_pk_bf16_f32 v104, v136, v137
v_cvt_pk_bf16_f32 v105, v138, v139
v_cvt_pk_bf16_f32 v106, v152, v153
v_cvt_pk_bf16_f32 v107, v154, v155
v_mfma_f32_16x16x32_bf16 v[164:167], a[32:35], a[148:151], v[164:167]
buffer_store_dwordx4 v[104:107], v11, s[16:19], s63 offen sc1
v_mfma_f32_16x16x32_bf16 v[180:183], a[36:39], a[148:151], v[180:183]
v_rcp_f32 v108, v108
v_mfma_f32_16x16x32_bf16 v[196:199], a[40:43], a[148:151], v[196:199]
v_rcp_f32 v109, v109
v_mfma_f32_16x16x32_bf16 v[212:215], a[44:47], a[148:151], v[212:215]
v_rcp_f32 v110, v110
v_mfma_f32_16x16x32_bf16 v[164:167], a[48:51], a[164:167], v[164:167]
buffer_load_dwordx4 v18, s[28:31], s58 offen lds
v_mfma_f32_16x16x32_bf16 v[180:183], a[52:55], a[164:167], v[180:183]
v_rcp_f32 v111, v111
v_mfma_f32_16x16x32_bf16 v[196:199], a[56:59], a[164:167], v[196:199]
v_rcp_f32 v124, v124
v_mfma_f32_16x16x32_bf16 v[212:215], a[60:63], a[164:167], v[212:215]
v_rcp_f32 v125, v125
v_mfma_f32_16x16x32_bf16 v[164:167], a[64:67], a[180:183], v[164:167]
buffer_load_dwordx4 v19, s[28:31], s58 offen offset:1056 lds
v_mfma_f32_16x16x32_bf16 v[180:183], a[68:71], a[180:183], v[180:183]
s_add_u32 m0, s59, 101376
s_mov_b32 s58, 786432
v_rcp_f32 v126, v126
v_mfma_f32_16x16x32_bf16 v[196:199], a[72:75], a[180:183], v[196:199]
v_rcp_f32 v127, v127
v_mfma_f32_16x16x32_bf16 v[212:215], a[76:79], a[180:183], v[212:215]
v_exp_f32 v160, v160
v_exp_f32 v161, v161
v_exp_f32 v162, v162
v_exp_f32 v163, v163
v_exp_f32 v176, v176
v_exp_f32 v177, v177
v_exp_f32 v178, v178
v_exp_f32 v179, v179
v_pk_mul_f32 v[140:141], v[140:141], v[108:109]
v_pk_mul_f32 v[142:143], v[142:143], v[110:111]
v_pk_mul_f32 v[156:157], v[156:157], v[124:125]
v_pk_mul_f32 v[158:159], v[158:159], v[126:127]
v_pk_fma_f32 v[164:165], v[112:113], v[22:23], v[164:165] op_sel_hi:[1,0,1]
v_pk_fma_f32 v[166:167], v[114:115], v[22:23], v[166:167] op_sel_hi:[1,0,1]
v_pk_fma_f32 v[180:181], v[128:129], v[22:23], v[180:181] op_sel_hi:[1,0,1]
v_pk_fma_f32 v[182:183], v[130:131], v[22:23], v[182:183] op_sel_hi:[1,0,1]
v_pk_fma_f32 v[196:197], v[144:145], v[22:23], v[196:197] op_sel_hi:[1,0,1]
v_pk_fma_f32 v[198:199], v[146:147], v[22:23], v[198:199] op_sel_hi:[1,0,1]
v_pk_fma_f32 v[212:213], v[12:13], v[22:23], v[212:213] op_sel_hi:[1,0,1]
v_pk_fma_f32 v[214:215], v[14:15], v[22:23], v[214:215] op_sel_hi:[1,0,1]
v_pk_mul_f32 v[196:197], v[196:197], v[164:165]
v_pk_mul_f32 v[164:165], v[164:165], v[28:29] op_sel:[0,1] op_sel_hi:[1,1]
v_pk_mul_f32 v[198:199], v[198:199], v[166:167]
v_pk_mul_f32 v[166:167], v[166:167], v[28:29] op_sel:[0,1] op_sel_hi:[1,1]
v_pk_mul_f32 v[212:213], v[212:213], v[180:181]
v_pk_mul_f32 v[180:181], v[180:181], v[28:29] op_sel:[0,1] op_sel_hi:[1,1]
v_pk_mul_f32 v[214:215], v[214:215], v[182:183]
v_pk_mul_f32 v[182:183], v[182:183], v[28:29] op_sel:[0,1] op_sel_hi:[1,1]
v_pk_fma_f32 v[160:161], v[160:161], v[20:21], v[20:21] op_sel:[0,1,1] op_sel_hi:[1,1,1]
v_pk_fma_f32 v[162:163], v[162:163], v[20:21], v[20:21] op_sel:[0,1,1] op_sel_hi:[1,1,1]
v_pk_fma_f32 v[176:177], v[176:177], v[20:21], v[20:21] op_sel:[0,1,1] op_sel_hi:[1,1,1]
v_pk_fma_f32 v[178:179], v[178:179], v[20:21], v[20:21] op_sel:[0,1,1] op_sel_hi:[1,1,1]
v_cvt_pk_bf16_f32 v108, v140, v141
v_cvt_pk_bf16_f32 v109, v142, v143
v_cvt_pk_bf16_f32 v110, v156, v157
v_cvt_pk_bf16_f32 v111, v158, v159
v_mfma_f32_16x16x32_bf16 v[168:171], a[32:35], a[152:155], v[168:171]
buffer_store_dwordx4 v[108:111], v11, s[16:19], s63 offen offset:1024 sc1
v_mfma_f32_16x16x32_bf16 v[184:187], a[36:39], a[152:155], v[184:187]
v_rcp_f32 v160, v160
v_mfma_f32_16x16x32_bf16 v[200:203], a[40:43], a[152:155], v[200:203]
v_rcp_f32 v161, v161
v_mfma_f32_16x16x32_bf16 v[216:219], a[44:47], a[152:155], v[216:219]
v_rcp_f32 v162, v162
v_mfma_f32_16x16x32_bf16 v[168:171], a[48:51], a[168:171], v[168:171]
buffer_load_dwordx4 v18, s[28:31], s58 offen lds
v_mfma_f32_16x16x32_bf16 v[184:187], a[52:55], a[168:171], v[184:187]
v_rcp_f32 v163, v163
v_mfma_f32_16x16x32_bf16 v[200:203], a[56:59], a[168:171], v[200:203]
v_rcp_f32 v176, v176
v_mfma_f32_16x16x32_bf16 v[216:219], a[60:63], a[168:171], v[216:219]
v_rcp_f32 v177, v177
v_mfma_f32_16x16x32_bf16 v[168:171], a[64:67], a[184:187], v[168:171]
buffer_load_dwordx4 v19, s[28:31], s58 offen offset:1056 lds
v_mfma_f32_16x16x32_bf16 v[184:187], a[68:71], a[184:187], v[184:187]
s_add_u32 m0, s59, 109824
s_mov_b32 s58, 851968
v_rcp_f32 v178, v178
v_mfma_f32_16x16x32_bf16 v[200:203], a[72:75], a[184:187], v[200:203]
v_rcp_f32 v179, v179
v_mfma_f32_16x16x32_bf16 v[216:219], a[76:79], a[184:187], v[216:219]
v_exp_f32 v164, v164
v_exp_f32 v165, v165
v_exp_f32 v166, v166
v_exp_f32 v167, v167
v_exp_f32 v180, v180
v_exp_f32 v181, v181
v_exp_f32 v182, v182
v_exp_f32 v183, v183
v_pk_mul_f32 v[192:193], v[192:193], v[160:161]
v_pk_mul_f32 v[194:195], v[194:195], v[162:163]
v_pk_mul_f32 v[208:209], v[208:209], v[176:177]
v_pk_mul_f32 v[210:211], v[210:211], v[178:179]
ds_read_b128 v[176:179], v8
v_pk_fma_f32 v[168:169], v[112:113], v[24:25], v[168:169] op_sel_hi:[1,0,1]
v_pk_fma_f32 v[170:171], v[114:115], v[24:25], v[170:171] op_sel_hi:[1,0,1]
v_pk_fma_f32 v[184:185], v[128:129], v[24:25], v[184:185] op_sel_hi:[1,0,1]
v_pk_fma_f32 v[186:187], v[130:131], v[24:25], v[186:187] op_sel_hi:[1,0,1]
v_pk_fma_f32 v[200:201], v[144:145], v[24:25], v[200:201] op_sel_hi:[1,0,1]
v_pk_fma_f32 v[202:203], v[146:147], v[24:25], v[202:203] op_sel_hi:[1,0,1]
v_pk_fma_f32 v[216:217], v[12:13], v[24:25], v[216:217] op_sel_hi:[1,0,1]
v_pk_fma_f32 v[218:219], v[14:15], v[24:25], v[218:219] op_sel_hi:[1,0,1]
v_pk_mul_f32 v[200:201], v[200:201], v[168:169]
v_pk_mul_f32 v[168:169], v[168:169], v[30:31] op_sel_hi:[1,0]
v_pk_mul_f32 v[202:203], v[202:203], v[170:171]
v_pk_mul_f32 v[170:171], v[170:171], v[30:31] op_sel_hi:[1,0]
v_pk_mul_f32 v[216:217], v[216:217], v[184:185]
v_pk_mul_f32 v[184:185], v[184:185], v[30:31] op_sel_hi:[1,0]
v_pk_mul_f32 v[218:219], v[218:219], v[186:187]
v_pk_mul_f32 v[186:187], v[186:187], v[30:31] op_sel_hi:[1,0]
v_pk_fma_f32 v[164:165], v[164:165], v[22:23], v[22:23] op_sel:[0,1,1] op_sel_hi:[1,1,1]
v_pk_fma_f32 v[166:167], v[166:167], v[22:23], v[22:23] op_sel:[0,1,1] op_sel_hi:[1,1,1]
v_pk_fma_f32 v[180:181], v[180:181], v[22:23], v[22:23] op_sel:[0,1,1] op_sel_hi:[1,1,1]
v_pk_fma_f32 v[182:183], v[182:183], v[22:23], v[22:23] op_sel:[0,1,1] op_sel_hi:[1,1,1]
v_cvt_pk_bf16_f32 v160, v192, v193
v_cvt_pk_bf16_f32 v161, v194, v195
ds_read_b128 v[192:195], v8 offset:64
v_cvt_pk_bf16_f32 v162, v208, v209
v_cvt_pk_bf16_f32 v163, v210, v211
v_mfma_f32_16x16x32_bf16 v[172:175], a[32:35], a[156:159], v[172:175]
buffer_store_dwordx4 v[160:163], v10, s[16:19], s64 offen sc1
v_mfma_f32_16x16x32_bf16 v[188:191], a[36:39], a[156:159], v[188:191]
ds_read_b128 v[208:211], v8 offset:512
v_rcp_f32 v164, v164
v_mfma_f32_16x16x32_bf16 v[204:207], a[40:43], a[156:159], v[204:207]
v_rcp_f32 v165, v165
v_mfma_f32_16x16x32_bf16 v[220:223], a[44:47], a[156:159], v[220:223]
v_rcp_f32 v166, v166
v_mfma_f32_16x16x32_bf16 v[172:175], a[48:51], a[172:175], v[172:175]
buffer_load_dwordx4 v18, s[28:31], s58 offen lds
v_mfma_f32_16x16x32_bf16 v[188:191], a[52:55], a[172:175], v[188:191]
v_rcp_f32 v167, v167
v_mfma_f32_16x16x32_bf16 v[204:207], a[56:59], a[172:175], v[204:207]
v_rcp_f32 v180, v180
v_mfma_f32_16x16x32_bf16 v[220:223], a[60:63], a[172:175], v[220:223]
v_rcp_f32 v181, v181
v_mfma_f32_16x16x32_bf16 v[172:175], a[64:67], a[188:191], v[172:175]
buffer_load_dwordx4 v19, s[28:31], s58 offen offset:1056 lds
v_mfma_f32_16x16x32_bf16 v[188:191], a[68:71], a[188:191], v[188:191]
v_rcp_f32 v182, v182
v_mfma_f32_16x16x32_bf16 v[204:207], a[72:75], a[188:191], v[204:207]
v_rcp_f32 v183, v183
v_mfma_f32_16x16x32_bf16 v[220:223], a[76:79], a[188:191], v[220:223]
v_exp_f32 v168, v168
v_exp_f32 v169, v169
.Lpad14:
s_cbranch_execz .Lnopoll28r
v_exp_f32 v170, v170
v_exp_f32 v171, v171
v_exp_f32 v184, v184
v_exp_f32 v185, v185
v_exp_f32 v186, v186
v_exp_f32 v187, v187
v_pk_mul_f32 v[196:197], v[196:197], v[164:165]
v_pk_mul_f32 v[198:199], v[198:199], v[166:167]
v_pk_mul_f32 v[212:213], v[212:213], v[180:181]
v_pk_mul_f32 v[214:215], v[214:215], v[182:183]
v_pk_fma_f32 v[172:173], v[112:113], v[26:27], v[172:173] op_sel_hi:[1,0,1]
v_pk_fma_f32 v[174:175], v[114:115], v[26:27], v[174:175] op_sel_hi:[1,0,1]
v_pk_fma_f32 v[188:189], v[128:129], v[26:27], v[188:189] op_sel_hi:[1,0,1]
v_pk_fma_f32 v[190:191], v[130:131], v[26:27], v[190:191] op_sel_hi:[1,0,1]
v_pk_fma_f32 v[204:205], v[144:145], v[26:27], v[204:205] op_sel_hi:[1,0,1]
v_pk_fma_f32 v[206:207], v[146:147], v[26:27], v[206:207] op_sel_hi:[1,0,1]
v_pk_fma_f32 v[220:221], v[12:13], v[26:27], v[220:221] op_sel_hi:[1,0,1]
v_pk_fma_f32 v[222:223], v[14:15], v[26:27], v[222:223] op_sel_hi:[1,0,1]
v_pk_mul_f32 v[204:205], v[204:205], v[172:173]
v_pk_mul_f32 v[172:173], v[172:173], v[30:31] op_sel:[0,1] op_sel_hi:[1,1]
v_pk_mul_f32 v[206:207], v[206:207], v[174:175]
v_pk_mul_f32 v[174:175], v[174:175], v[30:31] op_sel:[0,1] op_sel_hi:[1,1]
v_pk_mul_f32 v[220:221], v[220:221], v[188:189]
v_pk_mul_f32 v[188:189], v[188:189], v[30:31] op_sel:[0,1] op_sel_hi:[1,1]
v_pk_mul_f32 v[222:223], v[222:223], v[190:191]
v_pk_mul_f32 v[190:191], v[190:191], v[30:31] op_sel:[0,1] op_sel_hi:[1,1]
v_pk_fma_f32 v[168:169], v[168:169], v[24:25], v[24:25] op_sel:[0,1,1] op_sel_hi:[1,1,1]
v_pk_fma_f32 v[170:171], v[170:171], v[24:25], v[24:25] op_sel:[0,1,1] op_sel_hi:[1,1,1]
v_pk_fma_f32 v[184:185], v[184:185], v[24:25], v[24:25] op_sel:[0,1,1] op_sel_hi:[1,1,1]
v_pk_fma_f32 v[186:187], v[186:187], v[24:25], v[24:25] op_sel:[0,1,1] op_sel_hi:[1,1,1]
v_cvt_pk_bf16_f32 v164, v196, v197
v_cvt_pk_bf16_f32 v165, v198, v199
v_cvt_pk_bf16_f32 v166, v212, v213
v_cvt_pk_bf16_f32 v167, v214, v215
v_mfma_f32_16x16x32_bf16 v[224:227], a[80:83], a[144:147], v[224:227]
buffer_store_dwordx4 v[164:167], v10, s[16:19], s64 offen offset:1024 sc1
v_mfma_f32_16x16x32_bf16 v[232:235], a[84:87], a[144:147], v[232:235]
v_rcp_f32 v168, v168
v_mfma_f32_16x16x32_bf16 v[240:243], a[88:91], a[144:147], v[240:243]
v_rcp_f32 v169, v169
v_mfma_f32_16x16x32_bf16 v[248:251], a[92:95], a[144:147], v[248:251]
v_rcp_f32 v170, v170
v_mfma_f32_16x16x32_bf16 v[224:227], a[96:99], a[160:163], v[224:227]
v_rcp_f32 v171, v171
v_mfma_f32_16x16x32_bf16 v[232:235], a[100:103], a[160:163], v[232:235]
v_rcp_f32 v184, v184
v_mfma_f32_16x16x32_bf16 v[240:243], a[104:107], a[160:163], v[240:243]
v_rcp_f32 v185, v185
v_mfma_f32_16x16x32_bf16 v[248:251], a[108:111], a[160:163], v[248:251]
v_rcp_f32 v186, v186
v_mfma_f32_16x16x32_bf16 v[224:227], a[112:115], a[176:179], v[224:227]
v_rcp_f32 v187, v187
v_mfma_f32_16x16x32_bf16 v[232:235], a[116:119], a[176:179], v[232:235]
v_exp_f32 v172, v172
v_mfma_f32_16x16x32_bf16 v[240:243], a[120:123], a[176:179], v[240:243]
v_exp_f32 v173, v173
v_mfma_f32_16x16x32_bf16 v[248:251], a[124:127], a[176:179], v[248:251]
v_exp_f32 v174, v174
v_exp_f32 v175, v175
v_exp_f32 v188, v188
v_exp_f32 v189, v189
v_exp_f32 v190, v190
v_exp_f32 v191, v191
v_pk_mul_f32 v[200:201], v[200:201], v[168:169]
v_pk_mul_f32 v[202:203], v[202:203], v[170:171]
v_pk_mul_f32 v[216:217], v[216:217], v[184:185]
v_pk_mul_f32 v[218:219], v[218:219], v[186:187]
s_waitcnt lgkmcnt(2)
v_pk_fma_f32 v[224:225], v[176:177], v[20:21], v[224:225] op_sel_hi:[1,0,1]
v_pk_fma_f32 v[226:227], v[178:179], v[20:21], v[226:227] op_sel_hi:[1,0,1]
s_waitcnt lgkmcnt(1)
v_pk_fma_f32 v[232:233], v[192:193], v[20:21], v[232:233] op_sel_hi:[1,0,1]
v_pk_fma_f32 v[234:235], v[194:195], v[20:21], v[234:235] op_sel_hi:[1,0,1]
s_waitcnt lgkmcnt(0)
v_pk_fma_f32 v[240:241], v[208:209], v[20:21], v[240:241] op_sel_hi:[1,0,1]
v_pk_fma_f32 v[242:243], v[210:211], v[20:21], v[242:243] op_sel_hi:[1,0,1]
v_pk_fma_f32 v[248:249], v[4:5], v[20:21], v[248:249] op_sel_hi:[1,0,1]
v_pk_fma_f32 v[250:251], v[6:7], v[20:21], v[250:251] op_sel_hi:[1,0,1]
v_pk_mul_f32 v[240:241], v[240:241], v[224:225]
v_pk_mul_f32 v[224:225], v[224:225], v[28:29] op_sel_hi:[1,0]
v_pk_mul_f32 v[242:243], v[242:243], v[226:227]
v_pk_mul_f32 v[226:227], v[226:227], v[28:29] op_sel_hi:[1,0]
v_pk_mul_f32 v[248:249], v[248:249], v[232:233]
v_pk_mul_f32 v[232:233], v[232:233], v[28:29] op_sel_hi:[1,0]
v_pk_mul_f32 v[250:251], v[250:251], v[234:235]
v_pk_mul_f32 v[234:235], v[234:235], v[28:29] op_sel_hi:[1,0]
v_pk_fma_f32 v[172:173], v[172:173], v[26:27], v[26:27] op_sel:[0,1,1] op_sel_hi:[1,1,1]
v_pk_fma_f32 v[174:175], v[174:175], v[26:27], v[26:27] op_sel:[0,1,1] op_sel_hi:[1,1,1]
v_pk_fma_f32 v[188:189], v[188:189], v[26:27], v[26:27] op_sel:[0,1,1] op_sel_hi:[1,1,1]
v_pk_fma_f32 v[190:191], v[190:191], v[26:27], v[26:27] op_sel:[0,1,1] op_sel_hi:[1,1,1]
v_cvt_pk_bf16_f32 v168, v200, v201
v_cvt_pk_bf16_f32 v169, v202, v203
v_cvt_pk_bf16_f32 v170, v216, v217
v_cvt_pk_bf16_f32 v171, v218, v219
v_mfma_f32_16x16x32_bf16 v[228:231], a[80:83], a[148:151], v[228:231]
buffer_store_dwordx4 v[168:171], v11, s[16:19], s64 offen sc1
v_mfma_f32_16x16x32_bf16 v[236:239], a[84:87], a[148:151], v[236:239]
v_rcp_f32 v172, v172
v_mfma_f32_16x16x32_bf16 v[244:247], a[88:91], a[148:151], v[244:247]
v_rcp_f32 v173, v173
v_mfma_f32_16x16x32_bf16 v[252:255], a[92:95], a[148:151], v[252:255]
v_rcp_f32 v174, v174
v_mfma_f32_16x16x32_bf16 v[228:231], a[96:99], a[164:167], v[228:231]
v_rcp_f32 v175, v175
v_mfma_f32_16x16x32_bf16 v[236:239], a[100:103], a[164:167], v[236:239]
v_rcp_f32 v188, v188
v_mfma_f32_16x16x32_bf16 v[244:247], a[104:107], a[164:167], v[244:247]
v_rcp_f32 v189, v189
v_mfma_f32_16x16x32_bf16 v[252:255], a[108:111], a[164:167], v[252:255]
v_rcp_f32 v190, v190
v_mfma_f32_16x16x32_bf16 v[228:231], a[112:115], a[180:183], v[228:231]
v_rcp_f32 v191, v191
v_mfma_f32_16x16x32_bf16 v[236:239], a[116:119], a[180:183], v[236:239]
v_exp_f32 v224, v224
v_mfma_f32_16x16x32_bf16 v[244:247], a[120:123], a[180:183], v[244:247]
v_exp_f32 v225, v225
v_mfma_f32_16x16x32_bf16 v[252:255], a[124:127], a[180:183], v[252:255]
v_exp_f32 v226, v226
v_exp_f32 v227, v227
v_exp_f32 v232, v232
v_exp_f32 v233, v233
v_exp_f32 v234, v234
v_exp_f32 v235, v235
v_pk_mul_f32 v[204:205], v[204:205], v[172:173]
v_pk_mul_f32 v[206:207], v[206:207], v[174:175]
v_pk_mul_f32 v[220:221], v[220:221], v[188:189]
v_pk_mul_f32 v[222:223], v[222:223], v[190:191]
v_pk_fma_f32 v[228:229], v[176:177], v[22:23], v[228:229] op_sel_hi:[1,0,1]
v_pk_fma_f32 v[230:231], v[178:179], v[22:23], v[230:231] op_sel_hi:[1,0,1]
v_pk_fma_f32 v[236:237], v[192:193], v[22:23], v[236:237] op_sel_hi:[1,0,1]
v_pk_fma_f32 v[238:239], v[194:195], v[22:23], v[238:239] op_sel_hi:[1,0,1]
v_pk_fma_f32 v[244:245], v[208:209], v[22:23], v[244:245] op_sel_hi:[1,0,1]
v_pk_fma_f32 v[246:247], v[210:211], v[22:23], v[246:247] op_sel_hi:[1,0,1]
v_pk_fma_f32 v[252:253], v[4:5], v[22:23], v[252:253] op_sel_hi:[1,0,1]
v_pk_fma_f32 v[254:255], v[6:7], v[22:23], v[254:255] op_sel_hi:[1,0,1]
v_pk_mul_f32 v[244:245], v[244:245], v[228:229]
v_pk_mul_f32 v[228:229], v[228:229], v[28:29] op_sel:[0,1] op_sel_hi:[1,1]
v_pk_mul_f32 v[246:247], v[246:247], v[230:231]
v_pk_mul_f32 v[230:231], v[230:231], v[28:29] op_sel:[0,1] op_sel_hi:[1,1]
v_pk_mul_f32 v[252:253], v[252:253], v[236:237]
v_pk_mul_f32 v[236:237], v[236:237], v[28:29] op_sel:[0,1] op_sel_hi:[1,1]
v_pk_mul_f32 v[254:255], v[254:255], v[238:239]
v_pk_mul_f32 v[238:239], v[238:239], v[28:29] op_sel:[0,1] op_sel_hi:[1,1]
v_pk_fma_f32 v[224:225], v[224:225], v[20:21], v[20:21] op_sel:[0,1,1] op_sel_hi:[1,1,1]
v_pk_fma_f32 v[226:227], v[226:227], v[20:21], v[20:21] op_sel:[0,1,1] op_sel_hi:[1,1,1]
v_pk_fma_f32 v[232:233], v[232:233], v[20:21], v[20:21] op_sel:[0,1,1] op_sel_hi:[1,1,1]
v_pk_fma_f32 v[234:235], v[234:235], v[20:21], v[20:21] op_sel:[0,1,1] op_sel_hi:[1,1,1]
v_cvt_pk_bf16_f32 v172, v204, v205
v_cvt_pk_bf16_f32 v173, v206, v207
v_cvt_pk_bf16_f32 v174, v220, v221
v_cvt_pk_bf16_f32 v175, v222, v223
buffer_store_dwordx4 v[172:175], v11, s[16:19], s64 offen offset:1024 sc1
v_rcp_f32 v224, v224
v_rcp_f32 v225, v225
v_rcp_f32 v226, v226
v_rcp_f32 v227, v227
v_rcp_f32 v232, v232
v_rcp_f32 v233, v233
v_rcp_f32 v234, v234
v_rcp_f32 v235, v235
v_exp_f32 v228, v228
v_exp_f32 v229, v229
v_exp_f32 v230, v230
v_exp_f32 v231, v231
v_exp_f32 v236, v236
v_exp_f32 v237, v237
v_exp_f32 v238, v238
v_exp_f32 v239, v239
v_pk_mul_f32 v[240:241], v[240:241], v[224:225]
v_pk_mul_f32 v[242:243], v[242:243], v[226:227]
v_pk_mul_f32 v[248:249], v[248:249], v[232:233]
v_pk_mul_f32 v[250:251], v[250:251], v[234:235]
v_pk_fma_f32 v[228:229], v[228:229], v[22:23], v[22:23] op_sel:[0,1,1] op_sel_hi:[1,1,1]
v_pk_fma_f32 v[230:231], v[230:231], v[22:23], v[22:23] op_sel:[0,1,1] op_sel_hi:[1,1,1]
v_pk_fma_f32 v[236:237], v[236:237], v[22:23], v[22:23] op_sel:[0,1,1] op_sel_hi:[1,1,1]
v_pk_fma_f32 v[238:239], v[238:239], v[22:23], v[22:23] op_sel:[0,1,1] op_sel_hi:[1,1,1]
v_cvt_pk_bf16_f32 v224, v240, v241
v_cvt_pk_bf16_f32 v225, v242, v243
v_cvt_pk_bf16_f32 v226, v248, v249
v_cvt_pk_bf16_f32 v227, v250, v251
buffer_store_dwordx4 v[224:227], v10, s[16:19], s65 offen sc1
v_rcp_f32 v228, v228
v_rcp_f32 v229, v229
v_rcp_f32 v230, v230
v_rcp_f32 v231, v231
v_rcp_f32 v236, v236
v_rcp_f32 v237, v237
v_rcp_f32 v238, v238
v_rcp_f32 v239, v239
v_pk_mul_f32 v[244:245], v[244:245], v[228:229]
v_pk_mul_f32 v[246:247], v[246:247], v[230:231]
v_pk_mul_f32 v[252:253], v[252:253], v[236:237]
v_pk_mul_f32 v[254:255], v[254:255], v[238:239]
v_cvt_pk_bf16_f32 v228, v244, v245
v_cvt_pk_bf16_f32 v229, v246, v247
v_cvt_pk_bf16_f32 v230, v252, v253
v_cvt_pk_bf16_f32 v231, v254, v255
buffer_store_dwordx4 v[228:231], v10, s[16:19], s65 offen offset:1024 sc1
s_nop 1
s_branch .Lj35
.Lpad15:
s_cbranch_execz .Lnopoll28r
.Lx31:
buffer_load_dword v4, v8, s[32:35], s45 offen
buffer_load_dword v4, v7, s[28:31], s44 offen
s_add_u32 s44, s44, 655360
s_add_u32 s45, s45, 917504
s_mov_b32 s47, 3
s_branch .Lx31b
.Lx32:
buffer_load_dword v4, v8, s[32:35], s45 offen
buffer_load_dword v4, v7, s[28:31], s44 offen
s_add_u32 s44, s44, 655360
s_add_u32 s45, s45, 917504
s_mov_b32 s47, 3
s_branch .Lx32b
.Lx33:
buffer_load_dword v4, v8, s[32:35], s45 offen
buffer_load_dword v4, v7, s[28:31], s44 offen
s_add_u32 s44, s44, 655360
s_add_u32 s45, s45, 917504
s_mov_b32 s47, 3
s_branch .Lx33b
.Lx34:
buffer_load_dword v4, v8, s[32:35], s45 offen
buffer_load_dword v4, v7, s[28:31], s44 offen
s_add_u32 s44, s44, 655360
s_add_u32 s45, s45, 917504
s_mov_b32 s47, 3
s_branch .Lx34b
.Lj35:
s_lshl_b32 s62, s5, 2
s_add_u32 s62, s62, s3
s_lshl_b32 s62, s62, 12
s_and_b32 s63, s7, 8
s_lshl_b32 s63, s63, 7
s_add_u32 s62, s62, s63
s_lshr_b32 s63, s28, 7
s_sub_u32 s63, 3, s63
s_and_b32 s63, s63, 7
s_lshl_b32 s63, s63, 7
s_add_u32 s62, s62, s63
v_lshrrev_b32 v2, 5, v1
v_mul_u32_u24 v2, 3670016, v2
v_bfe_u32 v9, v1, 4, 1
v_lshl_add_u32 v9, v9, 11, v2
v_add_u32 v9, s62, v9
s_mov_b32 s44, 917504
buffer_load_dword v27, v9, s[28:31], s44 offen
s_add_u32 s44, s44, 0x80000
s_lshl_b32 s62, s6, 13
s_lshl_b32 s63, s3, 11
s_add_u32 s62, s62, s63
v_lshl_add_u32 v4, v1, 4, s62
v_lshrrev_b32 v2, 3, v1
v_cmp_eq_u32 vcc, 3, v2
v_add_u32 v2, 67108480, v4
s_nop 0
v_cndmask_b32 v4, v4, v2, vcc
s_and_b32 s62, s7, 1
s_mul_i32 s62, s62, 3670016
s_lshr_b32 s63, s7, 1
s_lshl_b32 s63, s63, 8
s_add_u32 s62, s62, s63
s_lshl_b32 s63, s3, 12
s_add_u32 s62, s62, s63
v_lshrrev_b32 v5, 4, v1
v_lshlrev_b32 v5, 14, v5
v_and_b32 v2, 15, v1
v_lshl_add_u32 v5, v2, 4, v5
v_add_u32 v5, s62, v5
v_add_u32 v6, 992, v5
v_bfe_u32 v8, v1, 2, 3
v_mul_u32_u24 v8, 1056, v8
v_bfe_u32 v2, v1, 5, 1
v_lshl_add_u32 v8, v2, 8, v8
v_and_b32 v2, 3, v1
v_lshl_add_u32 v8, v2, 3, v8
s_and_b32 s62, s7, 1
s_lshl_b32 s63, s62, 7
s_xor_b32 s64, s63, 128
v_add_u32 v7, s63, v8
v_add_u32 v10, s64, v8
s_mul_i32 s52, s62, 7340032
s_add_u32 s52, s52, 12582912
s_mov_b32 s54, 917504
s_mul_i32 s55, s3, 2112
s_add_u32 s56, s55, 67584
s_mov_b32 s57, 67584
s_lshl_b32 s70, s2, 10
s_lshl_b32 s62, s3, 7
s_add_u32 s70, s70, s62
s_add_u32 s70, s70, 31457280
s_xor_b32 s71, s70, 32768
v_min_u32 v12, 1, v1
v_lshlrev_b32 v12, 28, v12
v_mov_b32 v13, 1
v_mov_b32 v15, 0
s_lshl_b32 s68, s7, 18
s_add_u32 s68, s68, 33554432
s_xor_b32 s69, s68, 262144
v_mov_b32 v11, v4
v_and_b32 v2, 1, v1
v_lshlrev_b32 v2, 4, v2
v_mov_b32 v224, 0x3f80
v_lshlrev_b32 v2, v2, v224
v_bfe_u32 v224, v1, 2, 2
v_lshrrev_b32 v225, 4, v1
v_cmp_eq_u32 vcc, v224, v225
s_nop 1
v_cndmask_b32 v2, 0, v2, vcc
v_and_b32 v224, 2, v1
v_cmp_eq_u32 vcc, 0, v224
s_nop 1
v_cndmask_b32 v226, 0, v2, vcc
v_cndmask_b32 v227, v2, 0, vcc
v_mov_b64 v[224:225], 0
v_mov_b64 v[228:229], 0
v_mov_b64 v[64:65], 0
v_mov_b64 v[66:67], 0
v_mov_b64 v[68:69], 0
v_mov_b64 v[70:71], 0
v_mov_b64 v[72:73], 0
v_mov_b64 v[74:75], 0
v_mov_b64 v[76:77], 0
v_mov_b64 v[78:79], 0
v_mov_b64 v[80:81], 0
v_mov_b64 v[82:83], 0
v_mov_b64 v[84:85], 0
v_mov_b64 v[86:87], 0
v_mov_b64 v[88:89], 0
v_mov_b64 v[90:91], 0
v_mov_b64 v[92:93], 0
v_mov_b64 v[94:95], 0
v_accvgpr_read_b32 v32, a224
v_accvgpr_read_b32 v33, a225
v_accvgpr_read_b32 v34, a226
v_accvgpr_read_b32 v35, a227
v_accvgpr_read_b32 v36, a228
v_accvgpr_read_b32 v37, a229
v_accvgpr_read_b32 v38, a230
v_accvgpr_read_b32 v39, a231
v_accvgpr_read_b32 v40, a232
v_accvgpr_read_b32 v41, a233
v_accvgpr_read_b32 v42, a234
v_accvgpr_read_b32 v43, a235
v_accvgpr_read_b32 v44, a236
v_accvgpr_read_b32 v45, a237
v_accvgpr_read_b32 v46, a238
v_accvgpr_read_b32 v47, a239
v_accvgpr_read_b32 v48, a240
v_accvgpr_read_b32 v49, a241
v_accvgpr_read_b32 v50, a242
v_accvgpr_read_b32 v51, a243
v_accvgpr_read_b32 v52, a244
v_accvgpr_read_b32 v53, a245
v_accvgpr_read_b32 v54, a246
v_accvgpr_read_b32 v55, a247
v_accvgpr_read_b32 v56, a248
v_accvgpr_read_b32 v57, a249
v_accvgpr_read_b32 v58, a250
v_accvgpr_read_b32 v59, a251
v_accvgpr_read_b32 v60, a252
v_accvgpr_read_b32 v61, a253
v_accvgpr_read_b32 v62, a254
v_accvgpr_read_b32 v63, a255
v_bfe_u32 v18, v1, 3, 1
v_lshrrev_b32 v2, 4, v1
v_lshl_add_u32 v18, v2, 3, v18
s_lshl_b32 s62, s3, 1
v_add_u32 v18, s62, v18
v_mul_u32_u24 v18, 6144, v18
v_and_b32 v2, 7, v1
v_lshl_add_u32 v18, v2, 4, v18
s_lshl_b32 s62, s9, 7
v_add_u32 v18, s62, v18
v_add_u32 v19, 1024, v18
v_add_u32 v20, 2048, v18
s_mul_i32 s59, s3, 3104
s_mov_b32 s58, 0
s_lshl_b32 s62, s10, 1
s_lshr_b32 s63, s11, 4
s_add_u32 s62, s62, s63
s_lshl_b32 s62, s62, 7
s_add_u32 s62, s62, 30414848
s_and_b32 s64, s6, 14
s_and_b32 s63, s7, 1
s_add_u32 s64, s64, s63
s_lshl_b32 s64, s64, 7
s_add_u32 s64, s64, 30414848
v_mov_b32 v252, s62
v_mov_b32 v253, s64
s_waitcnt vmcnt(0) lgkmcnt(0)
s_barrier
s_cmp_lg_u32 s3, 0
s_cbranch_scc1 .Lnosig36
v_mov_b32 v255, 1
s_mov_b64 exec, 1
buffer_atomic_add v255, v252, s[16:19], 0 offen
s_mov_b64 exec, -1
.Lnosig36:
s_cmp_lg_u32 s3, 1
s_cbranch_scc1 .Lnopoll39
s_mov_b64 exec, 1
s_mov_b32 s15, 0
s_mov_b64 exec, 1
v_mov_b32 v254, 0
buffer_atomic_add v254, v253, s[16:19], 0 offen sc0
.Lpoll37:
s_waitcnt vmcnt(0)
v_cmp_ne_u32 vcc, 16, v254
s_add_u32 s15, s15, 1
s_cbranch_vccz .Lnopoll39r
s_sleep 2
s_mov_b64 exec, 1
v_mov_b32 v254, 0
buffer_atomic_add v254, v253, s[16:19], 0 offen sc0
s_cmp_le_u32 s15, 100000
s_cbranch_scc1 .Lpoll37
.Lgot38:
s_waitcnt vmcnt(0)
s_branch .Lnopoll39r
.Lnopoll39:
s_mov_b64 exec, 0
s_cmp_eq_u32 s3, 2
s_cbranch_scc1 .Lpad16
s_cmp_eq_u32 s3, 3
s_cbranch_scc1 .Lpad17
s_branch .Lpad18
.Lnopoll39r:
s_mov_b64 exec, -1
s_barrier
buffer_load_dwordx4 v[96:99], v4, s[16:19], s52 offen sc1
buffer_load_dwordx4 v[100:103], v4, s[16:19], s52 offen offset:1024 sc1
s_add_u32 s52, s52, 0x20000
buffer_load_dwordx4 v[104:107], v4, s[16:19], s52 offen sc1
buffer_load_dwordx4 v[108:111], v4, s[16:19], s52 offen offset:1024 sc1
s_add_u32 s52, s52, 0x20000
buffer_load_dwordx4 v[112:115], v4, s[16:19], s52 offen sc1
buffer_load_dwordx4 v[116:119], v4, s[16:19], s52 offen offset:1024 sc1
s_add_u32 s52, s52, 0x20000
buffer_load_dwordx4 v[120:123], v4, s[16:19], s52 offen sc1
buffer_load_dwordx4 v[124:127], v4, s[16:19], s52 offen offset:1024 sc1
s_add_u32 s52, s52, 0x20000
buffer_load_dwordx4 v[128:131], v4, s[16:19], s52 offen sc1
buffer_load_dwordx4 v[132:135], v4, s[16:19], s52 offen offset:1024 sc1
s_add_u32 s52, s52, 0x20000
buffer_load_dwordx4 v[136:139], v4, s[16:19], s52 offen sc1
buffer_load_dwordx4 v[140:143], v4, s[16:19], s52 offen offset:1024 sc1
s_add_u32 s52, s52, 0x20000
ds_read_b64_tr_b16 a[0:1], v7
ds_read_b64_tr_b16 a[2:3], v7 offset:512
ds_read_b64_tr_b16 a[4:5], v7 offset:32
ds_read_b64_tr_b16 a[6:7], v7 offset:544
ds_read_b64_tr_b16 a[8:9], v7 offset:64
ds_read_b64_tr_b16 a[10:11], v7 offset:576
ds_read_b64_tr_b16 a[12:13], v7 offset:96
ds_read_b64_tr_b16 a[14:15], v7 offset:608
ds_read_b64_tr_b16 a[16:17], v10
ds_read_b64_tr_b16 a[18:19], v10 offset:512
ds_read_b64_tr_b16 a[20:21], v10 offset:32
ds_read_b64_tr_b16 a[22:23], v10 offset:544
ds_read_b64_tr_b16 a[24:25], v10 offset:64
ds_read_b64_tr_b16 a[26:27], v10 offset:576
ds_read_b64_tr_b16 a[28:29], v10 offset:96
ds_read_b64_tr_b16 a[30:31], v10 offset:608
s_waitcnt lgkmcnt(0)
s_mov_b32 s15, -4
.p2align 6
.Lk41:
s_waitcnt vmcnt(10) lgkmcnt(8)
s_barrier
v_mfma_f32_16x16x32_bf16 v[32:35], a[0:3], v[96:99], v[32:35]
ds_read_b64_tr_b16 a[32:33], v7 offset:8448
s_add_u32 m0, s56, 50688
v_mfma_f32_16x16x32_bf16 v[48:51], a[0:3], v[100:103], v[48:51]
buffer_load_dwordx4 v5, s[28:31], s54 offen lds
v_mfma_f32_16x16x32_bf16 v[36:39], a[4:7], v[96:99], v[36:39]
ds_read_b64_tr_b16 a[34:35], v7 offset:8960
ds_read_b64_tr_b16 a[36:37], v7 offset:8480
v_mfma_f32_16x16x32_bf16 v[52:55], a[4:7], v[100:103], v[52:55]
ds_read_b64_tr_b16 a[38:39], v7 offset:8992
v_mfma_f32_16x16x32_bf16 v[40:43], a[8:11], v[96:99], v[40:43]
buffer_load_dwordx4 v[144:147], v4, s[16:19], s52 offen sc1
v_mfma_f32_16x16x32_bf16 v[56:59], a[8:11], v[100:103], v[56:59]
ds_read_b64_tr_b16 a[40:41], v7 offset:8512
ds_read_b64_tr_b16 a[42:43], v7 offset:9024
v_mfma_f32_16x16x32_bf16 v[44:47], a[12:15], v[96:99], v[44:47]
ds_read_b64_tr_b16 a[44:45], v7 offset:8544
ds_read_b64_tr_b16 a[46:47], v7 offset:9056
v_mfma_f32_16x16x32_bf16 v[60:63], a[12:15], v[100:103], v[60:63]
s_waitcnt lgkmcnt(8)
v_mfma_f32_16x16x32_bf16 v[64:67], a[16:19], v[96:99], v[64:67]
buffer_load_dwordx4 v6, s[28:31], s54 offen offset:1056 lds
v_mfma_f32_16x16x32_bf16 v[80:83], a[16:19], v[100:103], v[80:83]
ds_read_b64_tr_b16 a[48:49], v10 offset:8448
s_add_u32 s54, s54, 0x10000
v_mfma_f32_16x16x32_bf16 v[68:71], a[20:23], v[96:99], v[68:71]
ds_read_b64_tr_b16 a[50:51], v10 offset:8960
ds_read_b64_tr_b16 a[52:53], v10 offset:8480
v_mfma_f32_16x16x32_bf16 v[84:87], a[20:23], v[100:103], v[84:87]
ds_read_b64_tr_b16 a[54:55], v10 offset:8992
v_mfma_f32_16x16x32_bf16 v[72:75], a[24:27], v[96:99], v[72:75]
buffer_load_dwordx4 v[148:151], v4, s[16:19], s52 offen offset:1024 sc1
v_mfma_f32_16x16x32_bf16 v[88:91], a[24:27], v[100:103], v[88:91]
ds_read_b64_tr_b16 a[56:57], v10 offset:8512
s_add_u32 s52, s52, 0x20000
v_mfma_f32_16x16x32_bf16 v[76:79], a[28:31], v[96:99], v[76:79]
ds_read_b64_tr_b16 a[58:59], v10 offset:9024
ds_read_b64_tr_b16 a[60:61], v10 offset:8544
v_mfma_f32_16x16x32_bf16 v[92:95], a[28:31], v[100:103], v[92:95]
ds_read_b64_tr_b16 a[62:63], v10 offset:9056
s_waitcnt vmcnt(12) lgkmcnt(8)
v_mfma_f32_16x16x32_bf16 v[32:35], a[32:35], v[104:107], v[32:35]
ds_read_b64_tr_b16 a[0:1], v7 offset:16896
s_add_u32 m0, s56, 59136
v_mfma_f32_16x16x32_bf16 v[48:51], a[32:35], v[108:111], v[48:51]
buffer_load_dwordx4 v5, s[28:31], s54 offen lds
v_mfma_f32_16x16x32_bf16 v[36:39], a[36:39], v[104:107], v[36:39]
ds_read_b64_tr_b16 a[2:3], v7 offset:17408
ds_read_b64_tr_b16 a[4:5], v7 offset:16928
v_mfma_f32_16x16x32_bf16 v[52:55], a[36:39], v[108:111], v[52:55]
ds_read_b64_tr_b16 a[6:7], v7 offset:17440
v_mfma_f32_16x16x32_bf16 v[40:43], a[40:43], v[104:107], v[40:43]
buffer_load_dwordx4 v[152:155], v4, s[16:19], s52 offen sc1
v_mfma_f32_16x16x32_bf16 v[56:59], a[40:43], v[108:111], v[56:59]
ds_read_b64_tr_b16 a[8:9], v7 offset:16960
ds_read_b64_tr_b16 a[10:11], v7 offset:17472
v_mfma_f32_16x16x32_bf16 v[44:47], a[44:47], v[104:107], v[44:47]
ds_read_b64_tr_b16 a[12:13], v7 offset:16992
ds_read_b64_tr_b16 a[14:15], v7 offset:17504
v_mfma_f32_16x16x32_bf16 v[60:63], a[44:47], v[108:111], v[60:63]
s_waitcnt lgkmcnt(8)
v_mfma_f32_16x16x32_bf16 v[64:67], a[48:51], v[104:107], v[64:67]
buffer_load_dwordx4 v6, s[28:31], s54 offen offset:1056 lds
v_mfma_f32_16x16x32_bf16 v[80:83], a[48:51], v[108:111], v[80:83]
ds_read_b64_tr_b16 a[16:17], v10 offset:16896
s_add_u32 s54, s54, 0x10000
v_mfma_f32_16x16x32_bf16 v[68:71], a[52:55], v[104:107], v[68:71]
ds_read_b64_tr_b16 a[18:19], v10 offset:17408
ds_read_b64_tr_b16 a[20:21], v10 offset:16928
v_mfma_f32_16x16x32_bf16 v[84:87], a[52:55], v[108:111], v[84:87]
ds_read_b64_tr_b16 a[22:23], v10 offset:17440
v_mfma_f32_16x16x32_bf16 v[72:75], a[56:59], v[104:107], v[72:75]
buffer_load_dwordx4 v[156:159], v4, s[16:19], s52 offen offset:1024 sc1
v_mfma_f32_16x16x32_bf16 v[88:91], a[56:59], v[108:111], v[88:91]
ds_read_b64_tr_b16 a[24:25], v10 offset:16960
s_add_u32 s52, s52, 0x20000
v_mfma_f32_16x16x32_bf16 v[76:79], a[60:63], v[104:107], v[76:79]
ds_read_b64_tr_b16 a[26:27], v10 offset:17472
ds_read_b64_tr_b16 a[28:29], v10 offset:16992
v_mfma_f32_16x16x32_bf16 v[92:95], a[60:63], v[108:111], v[92:95]
ds_read_b64_tr_b16 a[30:31], v10 offset:17504
s_waitcnt vmcnt(14) lgkmcnt(8)
s_barrier
v_mfma_f32_16x16x32_bf16 v[32:35], a[0:3], v[112:115], v[32:35]
ds_read_b64_tr_b16 a[32:33], v7 offset:25344
s_add_u32 m0, s55, 0
v_mfma_f32_16x16x32_bf16 v[48:51], a[0:3], v[116:119], v[48:51]
buffer_load_dwordx4 v5, s[28:31], s54 offen lds
v_mfma_f32_16x16x32_bf16 v[36:39], a[4:7], v[112:115], v[36:39]
ds_read_b64_tr_b16 a[34:35], v7 offset:25856
ds_read_b64_tr_b16 a[36:37], v7 offset:25376
v_mfma_f32_16x16x32_bf16 v[52:55], a[4:7], v[116:119], v[52:55]
ds_read_b64_tr_b16 a[38:39], v7 offset:25888
v_mfma_f32_16x16x32_bf16 v[40:43], a[8:11], v[112:115], v[40:43]
buffer_load_dwordx4 v[96:99], v4, s[16:19], s52 offen sc1
v_mfma_f32_16x16x32_bf16 v[56:59], a[8:11], v[116:119], v[56:59]
ds_read_b64_tr_b16 a[40:41], v7 offset:25408
ds_read_b64_tr_b16 a[42:43], v7 offset:25920
v_mfma_f32_16x16x32_bf16 v[44:47], a[12:15], v[112:115], v[44:47]
ds_read_b64_tr_b16 a[44:45], v7 offset:25440
ds_read_b64_tr_b16 a[46:47], v7 offset:25952
v_mfma_f32_16x16x32_bf16 v[60:63], a[12:15], v[116:119], v[60:63]
s_waitcnt lgkmcnt(8)
v_mfma_f32_16x16x32_bf16 v[64:67], a[16:19], v[112:115], v[64:67]
buffer_load_dwordx4 v6, s[28:31], s54 offen offset:1056 lds
v_mfma_f32_16x16x32_bf16 v[80:83], a[16:19], v[116:119], v[80:83]
ds_read_b64_tr_b16 a[48:49], v10 offset:25344
s_add_u32 s54, s54, 0x10000
v_mfma_f32_16x16x32_bf16 v[68:71], a[20:23], v[112:115], v[68:71]
ds_read_b64_tr_b16 a[50:51], v10 offset:25856
ds_read_b64_tr_b16 a[52:53], v10 offset:25376
v_mfma_f32_16x16x32_bf16 v[84:87], a[20:23], v[116:119], v[84:87]
ds_read_b64_tr_b16 a[54:55], v10 offset:25888
v_mfma_f32_16x16x32_bf16 v[72:75], a[24:27], v[112:115], v[72:75]
buffer_load_dwordx4 v[100:103], v4, s[16:19], s52 offen offset:1024 sc1
v_mfma_f32_16x16x32_bf16 v[88:91], a[24:27], v[116:119], v[88:91]
ds_read_b64_tr_b16 a[56:57], v10 offset:25408
s_add_u32 s52, s52, 0x20000
v_mfma_f32_16x16x32_bf16 v[76:79], a[28:31], v[112:115], v[76:79]
ds_read_b64_tr_b16 a[58:59], v10 offset:25920
ds_read_b64_tr_b16 a[60:61], v10 offset:25440
v_mfma_f32_16x16x32_bf16 v[92:95], a[28:31], v[116:119], v[92:95]
ds_read_b64_tr_b16 a[62:63], v10 offset:25952
s_waitcnt vmcnt(16) lgkmcnt(8)
v_mfma_f32_16x16x32_bf16 v[32:35], a[32:35], v[120:123], v[32:35]
ds_read_b64_tr_b16 a[0:1], v7 offset:33792
s_add_u32 m0, s55, 8448
v_mfma_f32_16x16x32_bf16 v[48:51], a[32:35], v[124:127], v[48:51]
buffer_load_dwordx4 v5, s[28:31], s54 offen lds
v_mfma_f32_16x16x32_bf16 v[36:39], a[36:39], v[120:123], v[36:39]
ds_read_b64_tr_b16 a[2:3], v7 offset:34304
ds_read_b64_tr_b16 a[4:5], v7 offset:33824
v_mfma_f32_16x16x32_bf16 v[52:55], a[36:39], v[124:127], v[52:55]
ds_read_b64_tr_b16 a[6:7], v7 offset:34336
ds_read_b64_tr_b16 a[8:9], v7 offset:33856
v_mfma_f32_16x16x32_bf16 v[40:43], a[40:43], v[120:123], v[40:43]
buffer_load_dwordx4 v[104:107], v4, s[16:19], s52 offen sc1
v_mfma_f32_16x16x32_bf16 v[56:59], a[40:43], v[124:127], v[56:59]
ds_read_b64_tr_b16 a[10:11], v7 offset:34368
ds_read_b64_tr_b16 a[12:13], v7 offset:33888
v_mfma_f32_16x16x32_bf16 v[44:47], a[44:47], v[120:123], v[44:47]
ds_read_b64_tr_b16 a[14:15], v7 offset:34400
ds_read_b64_tr_b16 a[16:17], v10 offset:33792
v_mfma_f32_16x16x32_bf16 v[60:63], a[44:47], v[124:127], v[60:63]
ds_read_b64_tr_b16 a[18:19], v10 offset:34304
s_waitcnt lgkmcnt(10)
v_mfma_f32_16x16x32_bf16 v[64:67], a[48:51], v[120:123], v[64:67]
buffer_load_dwordx4 v6, s[28:31], s54 offen offset:1056 lds
v_mfma_f32_16x16x32_bf16 v[80:83], a[48:51], v[124:127], v[80:83]
ds_read_b64_tr_b16 a[20:21], v10 offset:33824
s_add_u32 s54, s54, 0x10000
v_mfma_f32_16x16x32_bf16 v[68:71], a[52:55], v[120:123], v[68:71]
buffer_load_dwordx4 v[108:111], v4, s[16:19], s52 offen offset:1024 sc1
v_mfma_f32_16x16x32_bf16 v[84:87], a[52:55], v[124:127], v[84:87]
ds_read_b64_tr_b16 a[22:23], v10 offset:34336
s_add_u32 s52, s52, 0x20000
.Lpad16:
s_cbranch_execz .Lnopoll39r
v_mfma_f32_16x16x32_bf16 v[72:75], a[56:59], v[120:123], v[72:75]
ds_read_b64_tr_b16 a[24:25], v10 offset:33856
ds_read_b64_tr_b16 a[26:27], v10 offset:34368
v_mfma_f32_16x16x32_bf16 v[88:91], a[56:59], v[124:127], v[88:91]
buffer_load_dword v27, v9, s[28:31], s44 offen
v_mfma_f32_16x16x32_bf16 v[76:79], a[60:63], v[120:123], v[76:79]
ds_read_b64_tr_b16 a[28:29], v10 offset:33888
s_add_u32 s44, s44, 0x80000
v_mfma_f32_16x16x32_bf16 v[92:95], a[60:63], v[124:127], v[92:95]
ds_read_b64_tr_b16 a[30:31], v10 offset:34400
s_waitcnt vmcnt(19) lgkmcnt(8)
s_barrier
v_mfma_f32_16x16x32_bf16 v[32:35], a[0:3], v[128:131], v[32:35]
ds_read_b64_tr_b16 a[32:33], v7 offset:42240
s_add_u32 m0, s55, 16896
v_mfma_f32_16x16x32_bf16 v[48:51], a[0:3], v[132:135], v[48:51]
buffer_load_dwordx4 v5, s[28:31], s54 offen lds
v_mfma_f32_16x16x32_bf16 v[36:39], a[4:7], v[128:131], v[36:39]
ds_read_b64_tr_b16 a[34:35], v7 offset:42752
ds_read_b64_tr_b16 a[36:37], v7 offset:42272
v_mfma_f32_16x16x32_bf16 v[52:55], a[4:7], v[132:135], v[52:55]
ds_read_b64_tr_b16 a[38:39], v7 offset:42784
v_mfma_f32_16x16x32_bf16 v[40:43], a[8:11], v[128:131], v[40:43]
buffer_load_dwordx4 v[112:115], v4, s[16:19], s52 offen sc1
v_mfma_f32_16x16x32_bf16 v[56:59], a[8:11], v[132:135], v[56:59]
ds_read_b64_tr_b16 a[40:41], v7 offset:42304
ds_read_b64_tr_b16 a[42:43], v7 offset:42816
v_mfma_f32_16x16x32_bf16 v[44:47], a[12:15], v[128:131], v[44:47]
ds_read_b64_tr_b16 a[44:45], v7 offset:42336
ds_read_b64_tr_b16 a[46:47], v7 offset:42848
v_mfma_f32_16x16x32_bf16 v[60:63], a[12:15], v[132:135], v[60:63]
s_waitcnt lgkmcnt(8)
v_mfma_f32_16x16x32_bf16 v[64:67], a[16:19], v[128:131], v[64:67]
buffer_load_dwordx4 v6, s[28:31], s54 offen offset:1056 lds
v_mfma_f32_16x16x32_bf16 v[80:83], a[16:19], v[132:135], v[80:83]
ds_read_b64_tr_b16 a[48:49], v10 offset:42240
s_add_u32 s54, s54, 0x10000
v_mfma_f32_16x16x32_bf16 v[68:71], a[20:23], v[128:131], v[68:71]
ds_read_b64_tr_b16 a[50:51], v10 offset:42752
ds_read_b64_tr_b16 a[52:53], v10 offset:42272
v_mfma_f32_16x16x32_bf16 v[84:87], a[20:23], v[132:135], v[84:87]
ds_read_b64_tr_b16 a[54:55], v10 offset:42784
v_mfma_f32_16x16x32_bf16 v[72:75], a[24:27], v[128:131], v[72:75]
buffer_load_dwordx4 v[116:119], v4, s[16:19], s52 offen offset:1024 sc1
v_mfma_f32_16x16x32_bf16 v[88:91], a[24:27], v[132:135], v[88:91]
ds_read_b64_tr_b16 a[56:57], v10 offset:42304
s_add_u32 s52, s52, 0x20000
v_mfma_f32_16x16x32_bf16 v[76:79], a[28:31], v[128:131], v[76:79]
ds_read_b64_tr_b16 a[58:59], v10 offset:42816
ds_read_b64_tr_b16 a[60:61], v10 offset:42336
v_mfma_f32_16x16x32_bf16 v[92:95], a[28:31], v[132:135], v[92:95]
ds_read_b64_tr_b16 a[62:63], v10 offset:42848
s_waitcnt vmcnt(21) lgkmcnt(8)
v_mfma_f32_16x16x32_bf16 v[32:35], a[32:35], v[136:139], v[32:35]
ds_read_b64_tr_b16 a[0:1], v7 offset:50688
s_add_u32 m0, s55, 25344
v_mfma_f32_16x16x32_bf16 v[48:51], a[32:35], v[140:143], v[48:51]
buffer_load_dwordx4 v5, s[28:31], s54 offen lds
v_mfma_f32_16x16x32_bf16 v[36:39], a[36:39], v[136:139], v[36:39]
ds_read_b64_tr_b16 a[2:3], v7 offset:51200
ds_read_b64_tr_b16 a[4:5], v7 offset:50720
v_mfma_f32_16x16x32_bf16 v[52:55], a[36:39], v[140:143], v[52:55]
ds_read_b64_tr_b16 a[6:7], v7 offset:51232
v_mfma_f32_16x16x32_bf16 v[40:43], a[40:43], v[136:139], v[40:43]
buffer_load_dwordx4 v[120:123], v4, s[16:19], s52 offen sc1
v_mfma_f32_16x16x32_bf16 v[56:59], a[40:43], v[140:143], v[56:59]
ds_read_b64_tr_b16 a[8:9], v7 offset:50752
ds_read_b64_tr_b16 a[10:11], v7 offset:51264
v_mfma_f32_16x16x32_bf16 v[44:47], a[44:47], v[136:139], v[44:47]
ds_read_b64_tr_b16 a[12:13], v7 offset:50784
ds_read_b64_tr_b16 a[14:15], v7 offset:51296
v_mfma_f32_16x16x32_bf16 v[60:63], a[44:47], v[140:143], v[60:63]
s_waitcnt lgkmcnt(8)
v_mfma_f32_16x16x32_bf16 v[64:67], a[48:51], v[136:139], v[64:67]
buffer_load_dwordx4 v6, s[28:31], s54 offen offset:1056 lds
v_mfma_f32_16x16x32_bf16 v[80:83], a[48:51], v[140:143], v[80:83]
ds_read_b64_tr_b16 a[16:17], v10 offset:50688
s_add_u32 s54, s54, 0x10000
v_mfma_f32_16x16x32_bf16 v[68:71], a[52:55], v[136:139], v[68:71]
ds_read_b64_tr_b16 a[18:19], v10 offset:51200
ds_read_b64_tr_b16 a[20:21], v10 offset:50720
v_mfma_f32_16x16x32_bf16 v[84:87], a[52:55], v[140:143], v[84:87]
ds_read_b64_tr_b16 a[22:23], v10 offset:51232
v_mfma_f32_16x16x32_bf16 v[72:75], a[56:59], v[136:139], v[72:75]
buffer_load_dwordx4 v[124:127], v4, s[16:19], s52 offen offset:1024 sc1
v_mfma_f32_16x16x32_bf16 v[88:91], a[56:59], v[140:143], v[88:91]
ds_read_b64_tr_b16 a[24:25], v10 offset:50752
s_add_u32 s52, s52, 0x20000
v_mfma_f32_16x16x32_bf16 v[76:79], a[60:63], v[136:139], v[76:79]
ds_read_b64_tr_b16 a[26:27], v10 offset:51264
ds_read_b64_tr_b16 a[28:29], v10 offset:50784
v_mfma_f32_16x16x32_bf16 v[92:95], a[60:63], v[140:143], v[92:95]
ds_read_b64_tr_b16 a[30:31], v10 offset:51296
s_waitcnt vmcnt(21) lgkmcnt(8)
s_barrier
v_mfma_f32_16x16x32_bf16 v[32:35], a[0:3], v[144:147], v[32:35]
ds_read_b64_tr_b16 a[32:33], v7 offset:59136
s_add_u32 m0, s55, 33792
v_mfma_f32_16x16x32_bf16 v[48:51], a[0:3], v[148:151], v[48:51]
buffer_load_dwordx4 v5, s[28:31], s54 offen lds
v_mfma_f32_16x16x32_bf16 v[36:39], a[4:7], v[144:147], v[36:39]
ds_read_b64_tr_b16 a[34:35], v7 offset:59648
ds_read_b64_tr_b16 a[36:37], v7 offset:59168
v_mfma_f32_16x16x32_bf16 v[52:55], a[4:7], v[148:151], v[52:55]
ds_read_b64_tr_b16 a[38:39], v7 offset:59680
v_mfma_f32_16x16x32_bf16 v[40:43], a[8:11], v[144:147], v[40:43]
buffer_load_dwordx4 v[128:131], v4, s[16:19], s52 offen sc1
v_mfma_f32_16x16x32_bf16 v[56:59], a[8:11], v[148:151], v[56:59]
ds_read_b64_tr_b16 a[40:41], v7 offset:59200
ds_read_b64_tr_b16 a[42:43], v7 offset:59712
v_mfma_f32_16x16x32_bf16 v[44:47], a[12:15], v[144:147], v[44:47]
ds_read_b64_tr_b16 a[44:45], v7 offset:59232
ds_read_b64_tr_b16 a[46:47], v7 offset:59744
v_mfma_f32_16x16x32_bf16 v[60:63], a[12:15], v[148:151], v[60:63]
s_waitcnt lgkmcnt(8)
v_mfma_f32_16x16x32_bf16 v[64:67], a[16:19], v[144:147], v[64:67]
buffer_load_dwordx4 v6, s[28:31], s54 offen offset:1056 lds
v_mfma_f32_16x16x32_bf16 v[80:83], a[16:19], v[148:151], v[80:83]
ds_read_b64_tr_b16 a[48:49], v10 offset:59136
s_add_u32 s54, s54, 0x10000
v_mfma_f32_16x16x32_bf16 v[68:71], a[20:23], v[144:147], v[68:71]
ds_read_b64_tr_b16 a[50:51], v10 offset:59648
ds_read_b64_tr_b16 a[52:53], v10 offset:59168
v_mfma_f32_16x16x32_bf16 v[84:87], a[20:23], v[148:151], v[84:87]
ds_read_b64_tr_b16 a[54:55], v10 offset:59680
v_mfma_f32_16x16x32_bf16 v[72:75], a[24:27], v[144:147], v[72:75]
buffer_load_dwordx4 v[132:135], v4, s[16:19], s52 offen offset:1024 sc1
v_mfma_f32_16x16x32_bf16 v[88:91], a[24:27], v[148:151], v[88:91]
ds_read_b64_tr_b16 a[56:57], v10 offset:59200
s_add_u32 s52, s52, 0x20000
v_mfma_f32_16x16x32_bf16 v[76:79], a[28:31], v[144:147], v[76:79]
ds_read_b64_tr_b16 a[58:59], v10 offset:59712
ds_read_b64_tr_b16 a[60:61], v10 offset:59232
v_mfma_f32_16x16x32_bf16 v[92:95], a[28:31], v[148:151], v[92:95]
ds_read_b64_tr_b16 a[62:63], v10 offset:59744
v_add_u32 v7, s57, v7
v_add_u32 v10, s57, v10
s_sub_u32 s57, 0, s57
s_waitcnt vmcnt(21) lgkmcnt(8)
v_mfma_f32_16x16x32_bf16 v[32:35], a[32:35], v[152:155], v[32:35]
ds_read_b64_tr_b16 a[0:1], v7
s_add_u32 m0, s55, 42240
v_mfma_f32_16x16x32_bf16 v[48:51], a[32:35], v[156:159], v[48:51]
buffer_load_dwordx4 v5, s[28:31], s54 offen lds
v_mfma_f32_16x16x32_bf16 v[36:39], a[36:39], v[152:155], v[36:39]
ds_read_b64_tr_b16 a[2:3], v7 offset:512
ds_read_b64_tr_b16 a[4:5], v7 offset:32
v_mfma_f32_16x16x32_bf16 v[52:55], a[36:39], v[156:159], v[52:55]
ds_read_b64_tr_b16 a[6:7], v7 offset:544
v_mfma_f32_16x16x32_bf16 v[40:43], a[40:43], v[152:155], v[40:43]
buffer_load_dwordx4 v[136:139], v4, s[16:19], s52 offen sc1
v_mfma_f32_16x16x32_bf16 v[56:59], a[40:43], v[156:159], v[56:59]
ds_read_b64_tr_b16 a[8:9], v7 offset:64
ds_read_b64_tr_b16 a[10:11], v7 offset:576
v_mfma_f32_16x16x32_bf16 v[44:47], a[44:47], v[152:155], v[44:47]
ds_read_b64_tr_b16 a[12:13], v7 offset:96
ds_read_b64_tr_b16 a[14:15], v7 offset:608
v_mfma_f32_16x16x32_bf16 v[60:63], a[44:47], v[156:159], v[60:63]
s_waitcnt lgkmcnt(8)
v_mfma_f32_16x16x32_bf16 v[64:67], a[48:51], v[152:155], v[64:67]
buffer_load_dwordx4 v6, s[28:31], s54 offen offset:1056 lds
v_mfma_f32_16x16x32_bf16 v[80:83], a[48:51], v[156:159], v[80:83]
ds_read_b64_tr_b16 a[16:17], v10
s_add_u32 s54, s54, 0x10000
v_mfma_f32_16x16x32_bf16 v[68:71], a[52:55], v[152:155], v[68:71]
ds_read_b64_tr_b16 a[18:19], v10 offset:512
ds_read_b64_tr_b16 a[20:21], v10 offset:32
v_mfma_f32_16x16x32_bf16 v[84:87], a[52:55], v[156:159], v[84:87]
ds_read_b64_tr_b16 a[22:23], v10 offset:544
v_mfma_f32_16x16x32_bf16 v[72:75], a[56:59], v[152:155], v[72:75]
buffer_load_dwordx4 v[140:143], v4, s[16:19], s52 offen offset:1024 sc1
v_mfma_f32_16x16x32_bf16 v[88:91], a[56:59], v[156:159], v[88:91]
ds_read_b64_tr_b16 a[24:25], v10 offset:64
s_add_u32 s52, s52, 0x20000
v_mfma_f32_16x16x32_bf16 v[76:79], a[60:63], v[152:155], v[76:79]
ds_read_b64_tr_b16 a[26:27], v10 offset:576
ds_read_b64_tr_b16 a[28:29], v10 offset:96
v_mfma_f32_16x16x32_bf16 v[92:95], a[60:63], v[156:159], v[92:95]
ds_read_b64_tr_b16 a[30:31], v10 offset:608
s_mov_b32 s62, s55
s_mov_b32 s55, s56
s_mov_b32 s56, s62
s_add_u32 s15, s15, 1
s_cbranch_scc0 .Lk41
s_waitcnt vmcnt(21) lgkmcnt(8)
s_barrier
v_mfma_f32_16x16x32_bf16 v[32:35], a[0:3], v[96:99], v[32:35]
ds_read_b64_tr_b16 a[32:33], v7 offset:8448
s_add_u32 m0, s56, 50688
v_mfma_f32_16x16x32_bf16 v[48:51], a[0:3], v[100:103], v[48:51]
buffer_load_dwordx4 v5, s[28:31], s54 offen lds
v_mfma_f32_16x16x32_bf16 v[36:39], a[4:7], v[96:99], v[36:39]
ds_read_b64_tr_b16 a[34:35], v7 offset:8960
ds_read_b64_tr_b16 a[36:37], v7 offset:8480
v_mfma_f32_16x16x32_bf16 v[52:55], a[4:7], v[100:103], v[52:55]
ds_read_b64_tr_b16 a[38:39], v7 offset:8992
v_mfma_f32_16x16x32_bf16 v[40:43], a[8:11], v[96:99], v[40:43]
buffer_load_dwordx4 v[144:147], v4, s[16:19], s52 offen sc1
v_mfma_f32_16x16x32_bf16 v[56:59], a[8:11], v[100:103], v[56:59]
ds_read_b64_tr_b16 a[40:41], v7 offset:8512
ds_read_b64_tr_b16 a[42:43], v7 offset:9024
v_mfma_f32_16x16x32_bf16 v[44:47], a[12:15], v[96:99], v[44:47]
ds_read_b64_tr_b16 a[44:45], v7 offset:8544
ds_read_b64_tr_b16 a[46:47], v7 offset:9056
v_mfma_f32_16x16x32_bf16 v[60:63], a[12:15], v[100:103], v[60:63]
s_waitcnt lgkmcnt(8)
v_mfma_f32_16x16x32_bf16 v[64:67], a[16:19], v[96:99], v[64:67]
buffer_load_dwordx4 v6, s[28:31], s54 offen offset:1056 lds
v_mfma_f32_16x16x32_bf16 v[80:83], a[16:19], v[100:103], v[80:83]
ds_read_b64_tr_b16 a[48:49], v10 offset:8448
s_add_u32 s54, s54, 0x10000
v_mfma_f32_16x16x32_bf16 v[68:71], a[20:23], v[96:99], v[68:71]
ds_read_b64_tr_b16 a[50:51], v10 offset:8960
ds_read_b64_tr_b16 a[52:53], v10 offset:8480
v_mfma_f32_16x16x32_bf16 v[84:87], a[20:23], v[100:103], v[84:87]
ds_read_b64_tr_b16 a[54:55], v10 offset:8992
v_mfma_f32_16x16x32_bf16 v[72:75], a[24:27], v[96:99], v[72:75]
buffer_load_dwordx4 v[148:151], v4, s[16:19], s52 offen offset:1024 sc1
v_mfma_f32_16x16x32_bf16 v[88:91], a[24:27], v[100:103], v[88:91]
ds_read_b64_tr_b16 a[56:57], v10 offset:8512
s_add_u32 s52, s52, 0x20000
v_mfma_f32_16x16x32_bf16 v[76:79], a[28:31], v[96:99], v[76:79]
ds_read_b64_tr_b16 a[58:59], v10 offset:9024
ds_read_b64_tr_b16 a[60:61], v10 offset:8544
v_mfma_f32_16x16x32_bf16 v[92:95], a[28:31], v[100:103], v[92:95]
ds_read_b64_tr_b16 a[62:63], v10 offset:9056
s_waitcnt vmcnt(21) lgkmcnt(8)
v_mfma_f32_16x16x32_bf16 v[32:35], a[32:35], v[104:107], v[32:35]
ds_read_b64_tr_b16 a[0:1], v7 offset:16896
s_add_u32 m0, s56, 59136
v_mfma_f32_16x16x32_bf16 v[48:51], a[32:35], v[108:111], v[48:51]
buffer_load_dwordx4 v5, s[28:31], s54 offen lds
v_mfma_f32_16x16x32_bf16 v[36:39], a[36:39], v[104:107], v[36:39]
ds_read_b64_tr_b16 a[2:3], v7 offset:17408
ds_read_b64_tr_b16 a[4:5], v7 offset:16928
v_mfma_f32_16x16x32_bf16 v[52:55], a[36:39], v[108:111], v[52:55]
ds_read_b64_tr_b16 a[6:7], v7 offset:17440
v_mfma_f32_16x16x32_bf16 v[40:43], a[40:43], v[104:107], v[40:43]
buffer_load_dwordx4 v[152:155], v4, s[16:19], s52 offen sc1
v_mfma_f32_16x16x32_bf16 v[56:59], a[40:43], v[108:111], v[56:59]
ds_read_b64_tr_b16 a[8:9], v7 offset:16960
ds_read_b64_tr_b16 a[10:11], v7 offset:17472
v_mfma_f32_16x16x32_bf16 v[44:47], a[44:47], v[104:107], v[44:47]
ds_read_b64_tr_b16 a[12:13], v7 offset:16992
ds_read_b64_tr_b16 a[14:15], v7 offset:17504
v_mfma_f32_16x16x32_bf16 v[60:63], a[44:47], v[108:111], v[60:63]
s_waitcnt lgkmcnt(8)
v_mfma_f32_16x16x32_bf16 v[64:67], a[48:51], v[104:107], v[64:67]
buffer_load_dwordx4 v6, s[28:31], s54 offen offset:1056 lds
v_mfma_f32_16x16x32_bf16 v[80:83], a[48:51], v[108:111], v[80:83]
ds_read_b64_tr_b16 a[16:17], v10 offset:16896
s_add_u32 s54, s54, 0x10000
v_mfma_f32_16x16x32_bf16 v[68:71], a[52:55], v[104:107], v[68:71]
ds_read_b64_tr_b16 a[18:19], v10 offset:17408
ds_read_b64_tr_b16 a[20:21], v10 offset:16928
v_mfma_f32_16x16x32_bf16 v[84:87], a[52:55], v[108:111], v[84:87]
ds_read_b64_tr_b16 a[22:23], v10 offset:17440
v_mfma_f32_16x16x32_bf16 v[72:75], a[56:59], v[104:107], v[72:75]
buffer_load_dwordx4 v[156:159], v4, s[16:19], s52 offen offset:1024 sc1
v_mfma_f32_16x16x32_bf16 v[88:91], a[56:59], v[108:111], v[88:91]
ds_read_b64_tr_b16 a[24:25], v10 offset:16960
s_add_u32 s52, s52, 0x20000
v_mfma_f32_16x16x32_bf16 v[76:79], a[60:63], v[104:107], v[76:79]
ds_read_b64_tr_b16 a[26:27], v10 offset:17472
ds_read_b64_tr_b16 a[28:29], v10 offset:16992
v_mfma_f32_16x16x32_bf16 v[92:95], a[60:63], v[108:111], v[92:95]
ds_read_b64_tr_b16 a[30:31], v10 offset:17504
s_waitcnt vmcnt(20) lgkmcnt(8)
s_barrier
v_mfma_f32_16x16x32_bf16 v[32:35], a[0:3], v[112:115], v[32:35]
ds_read_b64_tr_b16 a[32:33], v7 offset:25344
s_add_u32 m0, s55, 0
v_mfma_f32_16x16x32_bf16 v[48:51], a[0:3], v[116:119], v[48:51]
buffer_load_dwordx4 v5, s[28:31], s54 offen lds
v_mfma_f32_16x16x32_bf16 v[36:39], a[4:7], v[112:115], v[36:39]
ds_read_b64_tr_b16 a[34:35], v7 offset:25856
ds_read_b64_tr_b16 a[36:37], v7 offset:25376
v_mfma_f32_16x16x32_bf16 v[52:55], a[4:7], v[116:119], v[52:55]
ds_read_b64_tr_b16 a[38:39], v7 offset:25888
v_mfma_f32_16x16x32_bf16 v[40:43], a[8:11], v[112:115], v[40:43]
buffer_load_dwordx4 v[96:99], v4, s[16:19], s52 offen sc1
v_mfma_f32_16x16x32_bf16 v[56:59], a[8:11], v[116:119], v[56:59]
ds_read_b64_tr_b16 a[40:41], v7 offset:25408
ds_read_b64_tr_b16 a[42:43], v7 offset:25920
v_mfma_f32_16x16x32_bf16 v[44:47], a[12:15], v[112:115], v[44:47]
ds_read_b64_tr_b16 a[44:45], v7 offset:25440
ds_read_b64_tr_b16 a[46:47], v7 offset:25952
v_mfma_f32_16x16x32_bf16 v[60:63], a[12:15], v[116:119], v[60:63]
s_waitcnt lgkmcnt(8)
v_mfma_f32_16x16x32_bf16 v[64:67], a[16:19], v[112:115], v[64:67]
buffer_load_dwordx4 v6, s[28:31], s54 offen offset:1056 lds
v_mfma_f32_16x16x32_bf16 v[80:83], a[16:19], v[116:119], v[80:83]
ds_read_b64_tr_b16 a[48:49], v10 offset:25344
s_add_u32 s54, s54, 0x10000
v_mfma_f32_16x16x32_bf16 v[68:71], a[20:23], v[112:115], v[68:71]
ds_read_b64_tr_b16 a[50:51], v10 offset:25856
ds_read_b64_tr_b16 a[52:53], v10 offset:25376
v_mfma_f32_16x16x32_bf16 v[84:87], a[20:23], v[116:119], v[84:87]
ds_read_b64_tr_b16 a[54:55], v10 offset:25888
v_mfma_f32_16x16x32_bf16 v[72:75], a[24:27], v[112:115], v[72:75]
buffer_load_dwordx4 v[100:103], v4, s[16:19], s52 offen offset:1024 sc1
v_mfma_f32_16x16x32_bf16 v[88:91], a[24:27], v[116:119], v[88:91]
ds_read_b64_tr_b16 a[56:57], v10 offset:25408
s_add_u32 s52, s52, 0x20000
v_mfma_f32_16x16x32_bf16 v[76:79], a[28:31], v[112:115], v[76:79]
ds_read_b64_tr_b16 a[58:59], v10 offset:25920
ds_read_b64_tr_b16 a[60:61], v10 offset:25440
v_mfma_f32_16x16x32_bf16 v[92:95], a[28:31], v[116:119], v[92:95]
ds_read_b64_tr_b16 a[62:63], v10 offset:25952
s_waitcnt vmcnt(20) lgkmcnt(8)
v_mfma_f32_16x16x32_bf16 v[32:35], a[32:35], v[120:123], v[32:35]
ds_read_b64_tr_b16 a[0:1], v7 offset:33792
s_add_u32 m0, s55, 8448
v_mfma_f32_16x16x32_bf16 v[48:51], a[32:35], v[124:127], v[48:51]
buffer_load_dwordx4 v5, s[28:31], s54 offen lds
v_mfma_f32_16x16x32_bf16 v[36:39], a[36:39], v[120:123], v[36:39]
ds_read_b64_tr_b16 a[2:3], v7 offset:34304
ds_read_b64_tr_b16 a[4:5], v7 offset:33824
v_mfma_f32_16x16x32_bf16 v[52:55], a[36:39], v[124:127], v[52:55]
ds_read_b64_tr_b16 a[6:7], v7 offset:34336
ds_read_b64_tr_b16 a[8:9], v7 offset:33856
v_mfma_f32_16x16x32_bf16 v[40:43], a[40:43], v[120:123], v[40:43]
buffer_load_dwordx4 v[104:107], v4, s[16:19], s52 offen sc1
v_mfma_f32_16x16x32_bf16 v[56:59], a[40:43], v[124:127], v[56:59]
ds_read_b64_tr_b16 a[10:11], v7 offset:34368
ds_read_b64_tr_b16 a[12:13], v7 offset:33888
v_mfma_f32_16x16x32_bf16 v[44:47], a[44:47], v[120:123], v[44:47]
ds_read_b64_tr_b16 a[14:15], v7 offset:34400
ds_read_b64_tr_b16 a[16:17], v10 offset:33792
v_mfma_f32_16x16x32_bf16 v[60:63], a[44:47], v[124:127], v[60:63]
ds_read_b64_tr_b16 a[18:19], v10 offset:34304
s_waitcnt lgkmcnt(10)
v_mfma_f32_16x16x32_bf16 v[64:67], a[48:51], v[120:123], v[64:67]
buffer_load_dwordx4 v6, s[28:31], s54 offen offset:1056 lds
v_mfma_f32_16x16x32_bf16 v[80:83], a[48:51], v[124:127], v[80:83]
ds_read_b64_tr_b16 a[20:21], v10 offset:33824
s_add_u32 s54, s54, 0x10000
v_mfma_f32_16x16x32_bf16 v[68:71], a[52:55], v[120:123], v[68:71]
buffer_load_dwordx4 v[108:111], v4, s[16:19], s52 offen offset:1024 sc1
v_mfma_f32_16x16x32_bf16 v[84:87], a[52:55], v[124:127], v[84:87]
ds_read_b64_tr_b16 a[22:23], v10 offset:34336
s_add_u32 s52, s52, 0x20000
v_mfma_f32_16x16x32_bf16 v[72:75], a[56:59], v[120:123], v[72:75]
ds_read_b64_tr_b16 a[24:25], v10 offset:33856
ds_read_b64_tr_b16 a[26:27], v10 offset:34368
v_mfma_f32_16x16x32_bf16 v[88:91], a[56:59], v[124:127], v[88:91]
buffer_load_dword v27, v9, s[28:31], s44 offen
v_mfma_f32_16x16x32_bf16 v[76:79], a[60:63], v[120:123], v[76:79]
ds_read_b64_tr_b16 a[28:29], v10 offset:33888
s_add_u32 s44, s44, 0x80000
v_mfma_f32_16x16x32_bf16 v[92:95], a[60:63], v[124:127], v[92:95]
ds_read_b64_tr_b16 a[30:31], v10 offset:34400
s_waitcnt vmcnt(21) lgkmcnt(8)
s_barrier
v_mfma_f32_16x16x32_bf16 v[32:35], a[0:3], v[128:131], v[32:35]
ds_read_b64_tr_b16 a[32:33], v7 offset:42240
s_add_u32 m0, s55, 16896
v_mfma_f32_16x16x32_bf16 v[48:51], a[0:3], v[132:135], v[48:51]
buffer_load_dwordx4 v5, s[28:31], s54 offen lds
v_mfma_f32_16x16x32_bf16 v[36:39], a[4:7], v[128:131], v[36:39]
ds_read_b64_tr_b16 a[34:35], v7 offset:42752
ds_read_b64_tr_b16 a[36:37], v7 offset:42272
v_mfma_f32_16x16x32_bf16 v[52:55], a[4:7], v[132:135], v[52:55]
ds_read_b64_tr_b16 a[38:39], v7 offset:42784
v_mfma_f32_16x16x32_bf16 v[40:43], a[8:11], v[128:131], v[40:43]
buffer_load_dwordx4 v[112:115], v4, s[16:19], s52 offen sc1
v_mfma_f32_16x16x32_bf16 v[56:59], a[8:11], v[132:135], v[56:59]
ds_read_b64_tr_b16 a[40:41], v7 offset:42304
ds_read_b64_tr_b16 a[42:43], v7 offset:42816
v_mfma_f32_16x16x32_bf16 v[44:47], a[12:15], v[128:131], v[44:47]
ds_read_b64_tr_b16 a[44:45], v7 offset:42336
ds_read_b64_tr_b16 a[46:47], v7 offset:42848
v_mfma_f32_16x16x32_bf16 v[60:63], a[12:15], v[132:135], v[60:63]
s_waitcnt lgkmcnt(8)
v_mfma_f32_16x16x32_bf16 v[64:67], a[16:19], v[128:131], v[64:67]
buffer_load_dwordx4 v6, s[28:31], s54 offen offset:1056 lds
v_mfma_f32_16x16x32_bf16 v[80:83], a[16:19], v[132:135], v[80:83]
ds_read_b64_tr_b16 a[48:49], v10 offset:42240
s_add_u32 s54, s54, 0x10000
v_mfma_f32_16x16x32_bf16 v[68:71], a[20:23], v[128:131], v[68:71]
ds_read_b64_tr_b16 a[50:51], v10 offset:42752
ds_read_b64_tr_b16 a[52:53], v10 offset:42272
v_mfma_f32_16x16x32_bf16 v[84:87], a[20:23], v[132:135], v[84:87]
ds_read_b64_tr_b16 a[54:55], v10 offset:42784
v_mfma_f32_16x16x32_bf16 v[72:75], a[24:27], v[128:131], v[72:75]
buffer_load_dwordx4 v[116:119], v4, s[16:19], s52 offen offset:1024 sc1
v_mfma_f32_16x16x32_bf16 v[88:91], a[24:27], v[132:135], v[88:91]
ds_read_b64_tr_b16 a[56:57], v10 offset:42304
s_add_u32 s52, s52, 0x20000
v_mfma_f32_16x16x32_bf16 v[76:79], a[28:31], v[128:131], v[76:79]
ds_read_b64_tr_b16 a[58:59], v10 offset:42816
ds_read_b64_tr_b16 a[60:61], v10 offset:42336
v_mfma_f32_16x16x32_bf16 v[92:95], a[28:31], v[132:135], v[92:95]
ds_read_b64_tr_b16 a[62:63], v10 offset:42848
s_waitcnt vmcnt(21) lgkmcnt(8)
v_mfma_f32_16x16x32_bf16 v[32:35], a[32:35], v[136:139], v[32:35]
ds_read_b64_tr_b16 a[0:1], v7 offset:50688
s_add_u32 m0, s55, 25344
v_mfma_f32_16x16x32_bf16 v[48:51], a[32:35], v[140:143], v[48:51]
buffer_load_dwordx4 v5, s[28:31], s54 offen lds
v_mfma_f32_16x16x32_bf16 v[36:39], a[36:39], v[136:139], v[36:39]
ds_read_b64_tr_b16 a[2:3], v7 offset:51200
ds_read_b64_tr_b16 a[4:5], v7 offset:50720
v_mfma_f32_16x16x32_bf16 v[52:55], a[36:39], v[140:143], v[52:55]
ds_read_b64_tr_b16 a[6:7], v7 offset:51232
v_mfma_f32_16x16x32_bf16 v[40:43], a[40:43], v[136:139], v[40:43]
buffer_load_dwordx4 v[120:123], v4, s[16:19], s52 offen sc1
v_mfma_f32_16x16x32_bf16 v[56:59], a[40:43], v[140:143], v[56:59]
ds_read_b64_tr_b16 a[8:9], v7 offset:50752
ds_read_b64_tr_b16 a[10:11], v7 offset:51264
v_mfma_f32_16x16x32_bf16 v[44:47], a[44:47], v[136:139], v[44:47]
ds_read_b64_tr_b16 a[12:13], v7 offset:50784
ds_read_b64_tr_b16 a[14:15], v7 offset:51296
v_mfma_f32_16x16x32_bf16 v[60:63], a[44:47], v[140:143], v[60:63]
s_waitcnt lgkmcnt(8)
v_mfma_f32_16x16x32_bf16 v[64:67], a[48:51], v[136:139], v[64:67]
buffer_load_dwordx4 v6, s[28:31], s54 offen offset:1056 lds
v_mfma_f32_16x16x32_bf16 v[80:83], a[48:51], v[140:143], v[80:83]
ds_read_b64_tr_b16 a[16:17], v10 offset:50688
s_add_u32 s54, s54, 0x10000
v_mfma_f32_16x16x32_bf16 v[68:71], a[52:55], v[136:139], v[68:71]
ds_read_b64_tr_b16 a[18:19], v10 offset:51200
ds_read_b64_tr_b16 a[20:21], v10 offset:50720
v_mfma_f32_16x16x32_bf16 v[84:87], a[52:55], v[140:143], v[84:87]
ds_read_b64_tr_b16 a[22:23], v10 offset:51232
v_mfma_f32_16x16x32_bf16 v[72:75], a[56:59], v[136:139], v[72:75]
buffer_load_dwordx4 v[124:127], v4, s[16:19], s52 offen offset:1024 sc1
v_mfma_f32_16x16x32_bf16 v[88:91], a[56:59], v[140:143], v[88:91]
ds_read_b64_tr_b16 a[24:25], v10 offset:50752
s_add_u32 s52, s52, 0x20000
v_mfma_f32_16x16x32_bf16 v[76:79], a[60:63], v[136:139], v[76:79]
ds_read_b64_tr_b16 a[26:27], v10 offset:51264
ds_read_b64_tr_b16 a[28:29], v10 offset:50784
v_mfma_f32_16x16x32_bf16 v[92:95], a[60:63], v[140:143], v[92:95]
ds_read_b64_tr_b16 a[30:31], v10 offset:51296
s_waitcnt vmcnt(21) lgkmcnt(8)
s_barrier
v_mfma_f32_16x16x32_bf16 v[32:35], a[0:3], v[144:147], v[32:35]
ds_read_b64_tr_b16 a[32:33], v7 offset:59136
s_add_u32 m0, s55, 33792
v_mfma_f32_16x16x32_bf16 v[48:51], a[0:3], v[148:151], v[48:51]
buffer_load_dwordx4 v5, s[28:31], s54 offen lds
v_mfma_f32_16x16x32_bf16 v[36:39], a[4:7], v[144:147], v[36:39]
ds_read_b64_tr_b16 a[34:35], v7 offset:59648
ds_read_b64_tr_b16 a[36:37], v7 offset:59168
v_mfma_f32_16x16x32_bf16 v[52:55], a[4:7], v[148:151], v[52:55]
ds_read_b64_tr_b16 a[38:39], v7 offset:59680
v_mfma_f32_16x16x32_bf16 v[40:43], a[8:11], v[144:147], v[40:43]
buffer_load_dwordx4 v[128:131], v4, s[16:19], s52 offen sc1
v_mfma_f32_16x16x32_bf16 v[56:59], a[8:11], v[148:151], v[56:59]
ds_read_b64_tr_b16 a[40:41], v7 offset:59200
ds_read_b64_tr_b16 a[42:43], v7 offset:59712
v_mfma_f32_16x16x32_bf16 v[44:47], a[12:15], v[144:147], v[44:47]
ds_read_b64_tr_b16 a[44:45], v7 offset:59232
ds_read_b64_tr_b16 a[46:47], v7 offset:59744
v_mfma_f32_16x16x32_bf16 v[60:63], a[12:15], v[148:151], v[60:63]
s_waitcnt lgkmcnt(8)
v_mfma_f32_16x16x32_bf16 v[64:67], a[16:19], v[144:147], v[64:67]
buffer_load_dwordx4 v6, s[28:31], s54 offen offset:1056 lds
v_mfma_f32_16x16x32_bf16 v[80:83], a[16:19], v[148:151], v[80:83]
ds_read_b64_tr_b16 a[48:49], v10 offset:59136
s_add_u32 s54, s54, 0x10000
v_mfma_f32_16x16x32_bf16 v[68:71], a[20:23], v[144:147], v[68:71]
ds_read_b64_tr_b16 a[50:51], v10 offset:59648
ds_read_b64_tr_b16 a[52:53], v10 offset:59168
v_mfma_f32_16x16x32_bf16 v[84:87], a[20:23], v[148:151], v[84:87]
ds_read_b64_tr_b16 a[54:55], v10 offset:59680
v_mfma_f32_16x16x32_bf16 v[72:75], a[24:27], v[144:147], v[72:75]
buffer_load_dwordx4 v[132:135], v4, s[16:19], s52 offen offset:1024 sc1
v_mfma_f32_16x16x32_bf16 v[88:91], a[24:27], v[148:151], v[88:91]
ds_read_b64_tr_b16 a[56:57], v10 offset:59200
s_add_u32 s52, s52, 0x20000
v_mfma_f32_16x16x32_bf16 v[76:79], a[28:31], v[144:147], v[76:79]
ds_read_b64_tr_b16 a[58:59], v10 offset:59712
ds_read_b64_tr_b16 a[60:61], v10 offset:59232
v_mfma_f32_16x16x32_bf16 v[92:95], a[28:31], v[148:151], v[92:95]
ds_read_b64_tr_b16 a[62:63], v10 offset:59744
v_add_u32 v7, s57, v7
v_add_u32 v10, s57, v10
s_sub_u32 s57, 0, s57
s_waitcnt vmcnt(21) lgkmcnt(8)
v_mfma_f32_16x16x32_bf16 v[32:35], a[32:35], v[152:155], v[32:35]
ds_read_b64_tr_b16 a[0:1], v10
s_add_u32 m0, s55, 42240
v_mfma_f32_16x16x32_bf16 v[48:51], a[32:35], v[156:159], v[48:51]
buffer_load_dwordx4 v5, s[28:31], s54 offen lds
v_mfma_f32_16x16x32_bf16 v[36:39], a[36:39], v[152:155], v[36:39]
ds_read_b64_tr_b16 a[2:3], v10 offset:512
ds_read_b64_tr_b16 a[4:5], v10 offset:32
v_mfma_f32_16x16x32_bf16 v[52:55], a[36:39], v[156:159], v[52:55]
ds_read_b64_tr_b16 a[6:7], v10 offset:544
v_mfma_f32_16x16x32_bf16 v[40:43], a[40:43], v[152:155], v[40:43]
buffer_load_dwordx4 v[136:139], v4, s[16:19], s52 offen sc1
v_mfma_f32_16x16x32_bf16 v[56:59], a[40:43], v[156:159], v[56:59]
ds_read_b64_tr_b16 a[8:9], v10 offset:64
ds_read_b64_tr_b16 a[10:11], v10 offset:576
v_mfma_f32_16x16x32_bf16 v[44:47], a[44:47], v[152:155], v[44:47]
ds_read_b64_tr_b16 a[12:13], v10 offset:96
ds_read_b64_tr_b16 a[14:15], v10 offset:608
v_mfma_f32_16x16x32_bf16 v[60:63], a[44:47], v[156:159], v[60:63]
s_waitcnt lgkmcnt(8)
v_mfma_f32_16x16x32_bf16 v[64:67], a[48:51], v[152:155], v[64:67]
buffer_load_dwordx4 v6, s[28:31], s54 offen offset:1056 lds
v_mfma_f32_16x16x32_bf16 v[80:83], a[48:51], v[156:159], v[80:83]
ds_read_b64_tr_b16 a[16:17], v10 offset:8448
s_add_u32 s54, s54, 0x10000
v_mfma_f32_16x16x32_bf16 v[68:71], a[52:55], v[152:155], v[68:71]
ds_read_b64_tr_b16 a[18:19], v10 offset:8960
ds_read_b64_tr_b16 a[20:21], v10 offset:8480
v_mfma_f32_16x16x32_bf16 v[84:87], a[52:55], v[156:159], v[84:87]
ds_read_b64_tr_b16 a[22:23], v10 offset:8992
v_mfma_f32_16x16x32_bf16 v[72:75], a[56:59], v[152:155], v[72:75]
buffer_load_dwordx4 v[140:143], v4, s[16:19], s52 offen offset:1024 sc1
v_mfma_f32_16x16x32_bf16 v[88:91], a[56:59], v[156:159], v[88:91]
ds_read_b64_tr_b16 a[24:25], v10 offset:8512
s_add_u32 s52, s52, 0x20000
v_mfma_f32_16x16x32_bf16 v[76:79], a[60:63], v[152:155], v[76:79]
ds_read_b64_tr_b16 a[26:27], v10 offset:9024
ds_read_b64_tr_b16 a[28:29], v10 offset:8544
v_mfma_f32_16x16x32_bf16 v[92:95], a[60:63], v[156:159], v[92:95]
ds_read_b64_tr_b16 a[30:31], v10 offset:9056
s_mov_b32 s62, s55
s_mov_b32 s55, s56
s_mov_b32 s56, s62
s_waitcnt vmcnt(21) lgkmcnt(8)
s_barrier
v_mfma_f32_16x16x32_bf16 v[64:67], a[0:3], v[96:99], v[64:67]
ds_read_b64_tr_b16 a[32:33], v10 offset:16896
ds_read_b64_tr_b16 a[34:35], v10 offset:17408
s_add_u32 m0, s56, 50688
v_mfma_f32_16x16x32_bf16 v[80:83], a[0:3], v[100:103], v[80:83]
ds_read_b64_tr_b16 a[36:37], v10 offset:16928
buffer_load_dwordx4 v5, s[28:31], s54 offen lds
v_mfma_f32_16x16x32_bf16 v[68:71], a[4:7], v[96:99], v[68:71]
buffer_load_dwordx4 v6, s[28:31], s54 offen offset:1056 lds
.Lpad17:
s_cbranch_execz .Lnopoll39r
v_mfma_f32_16x16x32_bf16 v[84:87], a[4:7], v[100:103], v[84:87]
ds_read_b64_tr_b16 a[38:39], v10 offset:17440
ds_read_b64_tr_b16 a[40:41], v10 offset:16960
s_add_u32 s54, s54, 0x10000
v_mfma_f32_16x16x32_bf16 v[72:75], a[8:11], v[96:99], v[72:75]
buffer_load_dwordx4 v[144:147], v4, s[16:19], s52 offen sc1
v_mfma_f32_16x16x32_bf16 v[88:91], a[8:11], v[100:103], v[88:91]
ds_read_b64_tr_b16 a[42:43], v10 offset:17472
ds_read_b64_tr_b16 a[44:45], v10 offset:16992
v_mfma_f32_16x16x32_bf16 v[76:79], a[12:15], v[96:99], v[76:79]
buffer_load_dwordx4 v[148:151], v4, s[16:19], s52 offen offset:1024 sc1
v_mfma_f32_16x16x32_bf16 v[92:95], a[12:15], v[100:103], v[92:95]
ds_read_b64_tr_b16 a[46:47], v10 offset:17504
s_add_u32 s52, s52, 0x20000
s_add_u32 m0, s56, 59136
s_waitcnt vmcnt(21) lgkmcnt(8)
v_mfma_f32_16x16x32_bf16 v[64:67], a[16:19], v[104:107], v[64:67]
ds_read_b64_tr_b16 a[48:49], v10 offset:25344
buffer_load_dwordx4 v5, s[28:31], s54 offen lds
v_mfma_f32_16x16x32_bf16 v[80:83], a[16:19], v[108:111], v[80:83]
ds_read_b64_tr_b16 a[50:51], v10 offset:25856
v_mfma_f32_16x16x32_bf16 v[68:71], a[20:23], v[104:107], v[68:71]
ds_read_b64_tr_b16 a[52:53], v10 offset:25376
buffer_load_dwordx4 v6, s[28:31], s54 offen offset:1056 lds
v_mfma_f32_16x16x32_bf16 v[84:87], a[20:23], v[108:111], v[84:87]
ds_read_b64_tr_b16 a[54:55], v10 offset:25888
s_add_u32 s54, s54, 0x10000
v_mfma_f32_16x16x32_bf16 v[72:75], a[24:27], v[104:107], v[72:75]
ds_read_b64_tr_b16 a[56:57], v10 offset:25408
buffer_load_dwordx4 v[152:155], v4, s[16:19], s52 offen sc1
v_mfma_f32_16x16x32_bf16 v[88:91], a[24:27], v[108:111], v[88:91]
ds_read_b64_tr_b16 a[58:59], v10 offset:25920
v_mfma_f32_16x16x32_bf16 v[76:79], a[28:31], v[104:107], v[76:79]
ds_read_b64_tr_b16 a[60:61], v10 offset:25440
buffer_load_dwordx4 v[156:159], v4, s[16:19], s52 offen offset:1024 sc1
v_mfma_f32_16x16x32_bf16 v[92:95], a[28:31], v[108:111], v[92:95]
ds_read_b64_tr_b16 a[62:63], v10 offset:25952
s_add_u32 s52, s52, 0x20000
s_waitcnt vmcnt(20) lgkmcnt(8)
v_mfma_f32_16x16x32_bf16 v[64:67], a[32:35], v[112:115], v[64:67]
ds_read_b64_tr_b16 a[0:1], v10 offset:33792
ds_read_b64_tr_b16 a[2:3], v10 offset:34304
v_mfma_f32_16x16x32_bf16 v[80:83], a[32:35], v[116:119], v[80:83]
buffer_load_dwordx4 v[160:163], v4, s[16:19], s52 offen sc1
v_mfma_f32_16x16x32_bf16 v[68:71], a[36:39], v[112:115], v[68:71]
ds_read_b64_tr_b16 a[4:5], v10 offset:33824
ds_read_b64_tr_b16 a[6:7], v10 offset:34336
v_mfma_f32_16x16x32_bf16 v[84:87], a[36:39], v[116:119], v[84:87]
ds_read_b64_tr_b16 a[8:9], v10 offset:33856
v_mfma_f32_16x16x32_bf16 v[72:75], a[40:43], v[112:115], v[72:75]
buffer_load_dwordx4 v[164:167], v4, s[16:19], s52 offen offset:1024 sc1
v_mfma_f32_16x16x32_bf16 v[88:91], a[40:43], v[116:119], v[88:91]
ds_read_b64_tr_b16 a[10:11], v10 offset:34368
s_add_u32 s52, s52, 0x20000
v_mfma_f32_16x16x32_bf16 v[76:79], a[44:47], v[112:115], v[76:79]
ds_read_b64_tr_b16 a[12:13], v10 offset:33888
v_mfma_f32_16x16x32_bf16 v[92:95], a[44:47], v[116:119], v[92:95]
ds_read_b64_tr_b16 a[14:15], v10 offset:34400
s_waitcnt vmcnt(18) lgkmcnt(8)
v_mfma_f32_16x16x32_bf16 v[64:67], a[48:51], v[120:123], v[64:67]
buffer_load_dwordx4 v[168:171], v4, s[16:19], s52 offen sc1
v_mfma_f32_16x16x32_bf16 v[80:83], a[48:51], v[124:127], v[80:83]
ds_read_b64_tr_b16 a[16:17], v10 offset:42240
ds_read_b64_tr_b16 a[18:19], v10 offset:42752
v_mfma_f32_16x16x32_bf16 v[68:71], a[52:55], v[120:123], v[68:71]
ds_read_b64_tr_b16 a[20:21], v10 offset:42272
v_mfma_f32_16x16x32_bf16 v[84:87], a[52:55], v[124:127], v[84:87]
ds_read_b64_tr_b16 a[22:23], v10 offset:42784
ds_read_b64_tr_b16 a[24:25], v10 offset:42304
v_mfma_f32_16x16x32_bf16 v[72:75], a[56:59], v[120:123], v[72:75]
buffer_load_dwordx4 v[172:175], v4, s[16:19], s52 offen offset:1024 sc1
v_mfma_f32_16x16x32_bf16 v[88:91], a[56:59], v[124:127], v[88:91]
s_add_u32 s52, s52, 0x20000
v_mfma_f32_16x16x32_bf16 v[76:79], a[60:63], v[120:123], v[76:79]
ds_read_b64_tr_b16 a[26:27], v10 offset:42816
ds_read_b64_tr_b16 a[28:29], v10 offset:42336
v_mfma_f32_16x16x32_bf16 v[92:95], a[60:63], v[124:127], v[92:95]
ds_read_b64_tr_b16 a[30:31], v10 offset:42848
s_waitcnt vmcnt(16) lgkmcnt(8)
v_mfma_f32_16x16x32_bf16 v[64:67], a[0:3], v[128:131], v[64:67]
ds_read_b64_tr_b16 a[32:33], v10 offset:50688
ds_read_b64_tr_b16 a[34:35], v10 offset:51200
v_mfma_f32_16x16x32_bf16 v[80:83], a[0:3], v[132:135], v[80:83]
buffer_load_dwordx4 v[176:179], v4, s[16:19], s52 offen sc1
v_mfma_f32_16x16x32_bf16 v[68:71], a[4:7], v[128:131], v[68:71]
ds_read_b64_tr_b16 a[36:37], v10 offset:50720
ds_read_b64_tr_b16 a[38:39], v10 offset:51232
v_mfma_f32_16x16x32_bf16 v[84:87], a[4:7], v[132:135], v[84:87]
ds_read_b64_tr_b16 a[40:41], v10 offset:50752
v_mfma_f32_16x16x32_bf16 v[72:75], a[8:11], v[128:131], v[72:75]
buffer_load_dwordx4 v[180:183], v4, s[16:19], s52 offen offset:1024 sc1
v_mfma_f32_16x16x32_bf16 v[88:91], a[8:11], v[132:135], v[88:91]
ds_read_b64_tr_b16 a[42:43], v10 offset:51264
s_add_u32 s52, s52, 0x20000
v_mfma_f32_16x16x32_bf16 v[76:79], a[12:15], v[128:131], v[76:79]
ds_read_b64_tr_b16 a[44:45], v10 offset:50784
v_mfma_f32_16x16x32_bf16 v[92:95], a[12:15], v[132:135], v[92:95]
ds_read_b64_tr_b16 a[46:47], v10 offset:51296
s_waitcnt vmcnt(14) lgkmcnt(8)
v_mfma_f32_16x16x32_bf16 v[64:67], a[16:19], v[136:139], v[64:67]
buffer_load_dwordx4 v[184:187], v4, s[16:19], s52 offen sc1
v_mfma_f32_16x16x32_bf16 v[80:83], a[16:19], v[140:143], v[80:83]
ds_read_b64_tr_b16 a[48:49], v10 offset:59136
ds_read_b64_tr_b16 a[50:51], v10 offset:59648
v_mfma_f32_16x16x32_bf16 v[68:71], a[20:23], v[136:139], v[68:71]
ds_read_b64_tr_b16 a[52:53], v10 offset:59168
v_mfma_f32_16x16x32_bf16 v[84:87], a[20:23], v[140:143], v[84:87]
ds_read_b64_tr_b16 a[54:55], v10 offset:59680
ds_read_b64_tr_b16 a[56:57], v10 offset:59200
v_mfma_f32_16x16x32_bf16 v[72:75], a[24:27], v[136:139], v[72:75]
buffer_load_dwordx4 v[188:191], v4, s[16:19], s52 offen offset:1024 sc1
v_mfma_f32_16x16x32_bf16 v[88:91], a[24:27], v[140:143], v[88:91]
s_add_u32 s52, s52, 0x20000
v_mfma_f32_16x16x32_bf16 v[76:79], a[28:31], v[136:139], v[76:79]
ds_read_b64_tr_b16 a[58:59], v10 offset:59712
ds_read_b64_tr_b16 a[60:61], v10 offset:59232
v_mfma_f32_16x16x32_bf16 v[92:95], a[28:31], v[140:143], v[92:95]
ds_read_b64_tr_b16 a[62:63], v10 offset:59744
s_waitcnt vmcnt(10) lgkmcnt(8)
s_barrier
v_add_u32 v10, s57, v10
v_mfma_f32_16x16x32_bf16 v[64:67], a[32:35], v[144:147], v[64:67]
ds_read_b64_tr_b16 a[0:1], v10
ds_read_b64_tr_b16 a[2:3], v10 offset:512
v_mfma_f32_16x16x32_bf16 v[80:83], a[32:35], v[148:151], v[80:83]
buffer_load_dwordx4 v[192:195], v4, s[16:19], s52 offen sc1
v_mfma_f32_16x16x32_bf16 v[68:71], a[36:39], v[144:147], v[68:71]
ds_read_b64_tr_b16 a[4:5], v10 offset:32
ds_read_b64_tr_b16 a[6:7], v10 offset:544
v_mfma_f32_16x16x32_bf16 v[84:87], a[36:39], v[148:151], v[84:87]
ds_read_b64_tr_b16 a[8:9], v10 offset:64
v_mfma_f32_16x16x32_bf16 v[72:75], a[40:43], v[144:147], v[72:75]
buffer_load_dwordx4 v[196:199], v4, s[16:19], s52 offen offset:1024 sc1
v_mfma_f32_16x16x32_bf16 v[88:91], a[40:43], v[148:151], v[88:91]
ds_read_b64_tr_b16 a[10:11], v10 offset:576
s_add_u32 s52, s52, 0x20000
v_mfma_f32_16x16x32_bf16 v[76:79], a[44:47], v[144:147], v[76:79]
ds_read_b64_tr_b16 a[12:13], v10 offset:96
v_mfma_f32_16x16x32_bf16 v[92:95], a[44:47], v[148:151], v[92:95]
ds_read_b64_tr_b16 a[14:15], v10 offset:608
s_waitcnt vmcnt(10) lgkmcnt(8)
v_mfma_f32_16x16x32_bf16 v[64:67], a[48:51], v[152:155], v[64:67]
buffer_load_dwordx4 v[200:203], v4, s[16:19], s52 offen sc1
v_mfma_f32_16x16x32_bf16 v[80:83], a[48:51], v[156:159], v[80:83]
ds_read_b64_tr_b16 a[16:17], v10 offset:8448
ds_read_b64_tr_b16 a[18:19], v10 offset:8960
v_mfma_f32_16x16x32_bf16 v[68:71], a[52:55], v[152:155], v[68:71]
ds_read_b64_tr_b16 a[20:21], v10 offset:8480
v_mfma_f32_16x16x32_bf16 v[84:87], a[52:55], v[156:159], v[84:87]
ds_read_b64_tr_b16 a[22:23], v10 offset:8992
ds_read_b64_tr_b16 a[24:25], v10 offset:8512
v_mfma_f32_16x16x32_bf16 v[72:75], a[56:59], v[152:155], v[72:75]
buffer_load_dwordx4 v[204:207], v4, s[16:19], s52 offen offset:1024 sc1
v_mfma_f32_16x16x32_bf16 v[88:91], a[56:59], v[156:159], v[88:91]
s_add_u32 s52, s52, 0x20000
v_mfma_f32_16x16x32_bf16 v[76:79], a[60:63], v[152:155], v[76:79]
ds_read_b64_tr_b16 a[26:27], v10 offset:9024
ds_read_b64_tr_b16 a[28:29], v10 offset:8544
v_mfma_f32_16x16x32_bf16 v[92:95], a[60:63], v[156:159], v[92:95]
ds_read_b64_tr_b16 a[30:31], v10 offset:9056
s_waitcnt vmcnt(10) lgkmcnt(8)
v_mfma_f32_16x16x32_bf16 v[64:67], a[0:3], v[160:163], v[64:67]
ds_read_b64_tr_b16 a[32:33], v10 offset:16896
ds_read_b64_tr_b16 a[34:35], v10 offset:17408
v_mfma_f32_16x16x32_bf16 v[80:83], a[0:3], v[164:167], v[80:83]
buffer_load_dwordx4 v[208:211], v4, s[16:19], s52 offen sc1
v_mfma_f32_16x16x32_bf16 v[68:71], a[4:7], v[160:163], v[68:71]
ds_read_b64_tr_b16 a[36:37], v10 offset:16928
ds_read_b64_tr_b16 a[38:39], v10 offset:17440
v_mfma_f32_16x16x32_bf16 v[84:87], a[4:7], v[164:167], v[84:87]
ds_read_b64_tr_b16 a[40:41], v10 offset:16960
v_mfma_f32_16x16x32_bf16 v[72:75], a[8:11], v[160:163], v[72:75]
buffer_load_dwordx4 v[212:215], v4, s[16:19], s52 offen offset:1024 sc1
v_mfma_f32_16x16x32_bf16 v[88:91], a[8:11], v[164:167], v[88:91]
ds_read_b64_tr_b16 a[42:43], v10 offset:17472
s_add_u32 s52, s52, 0x20000
v_mfma_f32_16x16x32_bf16 v[76:79], a[12:15], v[160:163], v[76:79]
ds_read_b64_tr_b16 a[44:45], v10 offset:16992
v_mfma_f32_16x16x32_bf16 v[92:95], a[12:15], v[164:167], v[92:95]
ds_read_b64_tr_b16 a[46:47], v10 offset:17504
s_waitcnt vmcnt(10) lgkmcnt(8)
v_mfma_f32_16x16x32_bf16 v[64:67], a[16:19], v[168:171], v[64:67]
buffer_load_dwordx4 v[216:219], v4, s[16:19], s52 offen sc1
v_mfma_f32_16x16x32_bf16 v[80:83], a[16:19], v[172:175], v[80:83]
ds_read_b64_tr_b16 a[48:49], v10 offset:25344
ds_read_b64_tr_b16 a[50:51], v10 offset:25856
v_mfma_f32_16x16x32_bf16 v[68:71], a[20:23], v[168:171], v[68:71]
ds_read_b64_tr_b16 a[52:53], v10 offset:25376
v_mfma_f32_16x16x32_bf16 v[84:87], a[20:23], v[172:175], v[84:87]
ds_read_b64_tr_b16 a[54:55], v10 offset:25888
ds_read_b64_tr_b16 a[56:57], v10 offset:25408
v_mfma_f32_16x16x32_bf16 v[72:75], a[24:27], v[168:171], v[72:75]
buffer_load_dwordx4 v[220:223], v4, s[16:19], s52 offen offset:1024 sc1
v_mfma_f32_16x16x32_bf16 v[88:91], a[24:27], v[172:175], v[88:91]
s_add_u32 s52, s52, 0x20000
v_mfma_f32_16x16x32_bf16 v[76:79], a[28:31], v[168:171], v[76:79]
ds_read_b64_tr_b16 a[58:59], v10 offset:25920
ds_read_b64_tr_b16 a[60:61], v10 offset:25440
v_mfma_f32_16x16x32_bf16 v[92:95], a[28:31], v[172:175], v[92:95]
ds_read_b64_tr_b16 a[62:63], v10 offset:25952
s_waitcnt vmcnt(10) lgkmcnt(8)
v_mfma_f32_16x16x32_bf16 v[64:67], a[32:35], v[176:179], v[64:67]
ds_read_b64_tr_b16 a[0:1], v10 offset:33792
v_mfma_f32_16x16x32_bf16 v[80:83], a[32:35], v[180:183], v[80:83]
ds_read_b64_tr_b16 a[2:3], v10 offset:34304
v_mfma_f32_16x16x32_bf16 v[68:71], a[36:39], v[176:179], v[68:71]
ds_read_b64_tr_b16 a[4:5], v10 offset:33824
v_mfma_f32_16x16x32_bf16 v[84:87], a[36:39], v[180:183], v[84:87]
ds_read_b64_tr_b16 a[6:7], v10 offset:34336
v_mfma_f32_16x16x32_bf16 v[72:75], a[40:43], v[176:179], v[72:75]
ds_read_b64_tr_b16 a[8:9], v10 offset:33856
v_mfma_f32_16x16x32_bf16 v[88:91], a[40:43], v[180:183], v[88:91]
ds_read_b64_tr_b16 a[10:11], v10 offset:34368
v_mfma_f32_16x16x32_bf16 v[76:79], a[44:47], v[176:179], v[76:79]
ds_read_b64_tr_b16 a[12:13], v10 offset:33888
v_mfma_f32_16x16x32_bf16 v[92:95], a[44:47], v[180:183], v[92:95]
ds_read_b64_tr_b16 a[14:15], v10 offset:34400
s_waitcnt vmcnt(8) lgkmcnt(8)
v_mfma_f32_16x16x32_bf16 v[64:67], a[48:51], v[184:187], v[64:67]
ds_read_b64_tr_b16 a[16:17], v10 offset:42240
v_mfma_f32_16x16x32_bf16 v[80:83], a[48:51], v[188:191], v[80:83]
ds_read_b64_tr_b16 a[18:19], v10 offset:42752
v_mfma_f32_16x16x32_bf16 v[68:71], a[52:55], v[184:187], v[68:71]
ds_read_b64_tr_b16 a[20:21], v10 offset:42272
v_mfma_f32_16x16x32_bf16 v[84:87], a[52:55], v[188:191], v[84:87]
ds_read_b64_tr_b16 a[22:23], v10 offset:42784
v_mfma_f32_16x16x32_bf16 v[72:75], a[56:59], v[184:187], v[72:75]
ds_read_b64_tr_b16 a[24:25], v10 offset:42304
v_mfma_f32_16x16x32_bf16 v[88:91], a[56:59], v[188:191], v[88:91]
ds_read_b64_tr_b16 a[26:27], v10 offset:42816
v_mfma_f32_16x16x32_bf16 v[76:79], a[60:63], v[184:187], v[76:79]
ds_read_b64_tr_b16 a[28:29], v10 offset:42336
v_mfma_f32_16x16x32_bf16 v[92:95], a[60:63], v[188:191], v[92:95]
ds_read_b64_tr_b16 a[30:31], v10 offset:42848
s_waitcnt vmcnt(6) lgkmcnt(8)
v_mfma_f32_16x16x32_bf16 v[64:67], a[0:3], v[192:195], v[64:67]
ds_read_b64_tr_b16 a[32:33], v10 offset:50688
v_mfma_f32_16x16x32_bf16 v[80:83], a[0:3], v[196:199], v[80:83]
ds_read_b64_tr_b16 a[34:35], v10 offset:51200
v_mfma_f32_16x16x32_bf16 v[68:71], a[4:7], v[192:195], v[68:71]
ds_read_b64_tr_b16 a[36:37], v10 offset:50720
v_mfma_f32_16x16x32_bf16 v[84:87], a[4:7], v[196:199], v[84:87]
ds_read_b64_tr_b16 a[38:39], v10 offset:51232
v_mfma_f32_16x16x32_bf16 v[72:75], a[8:11], v[192:195], v[72:75]
ds_read_b64_tr_b16 a[40:41], v10 offset:50752
v_mfma_f32_16x16x32_bf16 v[88:91], a[8:11], v[196:199], v[88:91]
ds_read_b64_tr_b16 a[42:43], v10 offset:51264
v_mfma_f32_16x16x32_bf16 v[76:79], a[12:15], v[192:195], v[76:79]
ds_read_b64_tr_b16 a[44:45], v10 offset:50784
v_mfma_f32_16x16x32_bf16 v[92:95], a[12:15], v[196:199], v[92:95]
ds_read_b64_tr_b16 a[46:47], v10 offset:51296
s_waitcnt vmcnt(4) lgkmcnt(8)
v_mfma_f32_16x16x32_bf16 v[64:67], a[16:19], v[200:203], v[64:67]
ds_read_b64_tr_b16 a[48:49], v10 offset:59136
v_mfma_f32_16x16x32_bf16 v[80:83], a[16:19], v[204:207], v[80:83]
ds_read_b64_tr_b16 a[50:51], v10 offset:59648
v_mfma_f32_16x16x32_bf16 v[68:71], a[20:23], v[200:203], v[68:71]
ds_read_b64_tr_b16 a[52:53], v10 offset:59168
v_mfma_f32_16x16x32_bf16 v[84:87], a[20:23], v[204:207], v[84:87]
ds_read_b64_tr_b16 a[54:55], v10 offset:59680
v_mfma_f32_16x16x32_bf16 v[72:75], a[24:27], v[200:203], v[72:75]
ds_read_b64_tr_b16 a[56:57], v10 offset:59200
v_mfma_f32_16x16x32_bf16 v[88:91], a[24:27], v[204:207], v[88:91]
ds_read_b64_tr_b16 a[58:59], v10 offset:59712
v_mfma_f32_16x16x32_bf16 v[76:79], a[28:31], v[200:203], v[76:79]
ds_read_b64_tr_b16 a[60:61], v10 offset:59232
v_mfma_f32_16x16x32_bf16 v[92:95], a[28:31], v[204:207], v[92:95]
ds_read_b64_tr_b16 a[62:63], v10 offset:59744
s_waitcnt vmcnt(2) lgkmcnt(8)
v_mfma_f32_16x16x32_bf16 v[64:67], a[32:35], v[208:211], v[64:67]
ds_read_b64_tr_b16 a[0:1], v7
v_mfma_f32_16x16x32_bf16 v[80:83], a[32:35], v[212:215], v[80:83]
ds_read_b64_tr_b16 a[2:3], v7 offset:512
v_mfma_f32_16x16x32_bf16 v[68:71], a[36:39], v[208:211], v[68:71]
ds_read_b64_tr_b16 a[4:5], v7 offset:32
v_mfma_f32_16x16x32_bf16 v[84:87], a[36:39], v[212:215], v[84:87]
ds_read_b64_tr_b16 a[6:7], v7 offset:544
v_mfma_f32_16x16x32_bf16 v[72:75], a[40:43], v[208:211], v[72:75]
ds_read_b64_tr_b16 a[8:9], v7 offset:64
v_mfma_f32_16x16x32_bf16 v[88:91], a[40:43], v[212:215], v[88:91]
ds_read_b64_tr_b16 a[10:11], v7 offset:576
v_mfma_f32_16x16x32_bf16 v[76:79], a[44:47], v[208:211], v[76:79]
ds_read_b64_tr_b16 a[12:13], v7 offset:96
v_mfma_f32_16x16x32_bf16 v[92:95], a[44:47], v[212:215], v[92:95]
ds_read_b64_tr_b16 a[14:15], v7 offset:608
s_waitcnt vmcnt(0) lgkmcnt(8)
v_mfma_f32_16x16x32_bf16 v[64:67], a[48:51], v[216:219], v[64:67]
ds_read_b64_tr_b16 a[16:17], v7 offset:8448
v_mfma_f32_16x16x32_bf16 v[80:83], a[48:51], v[220:223], v[80:83]
ds_read_b64_tr_b16 a[18:19], v7 offset:8960
v_mfma_f32_16x16x32_bf16 v[68:71], a[52:55], v[216:219], v[68:71]
ds_read_b64_tr_b16 a[20:21], v7 offset:8480
v_mfma_f32_16x16x32_bf16 v[84:87], a[52:55], v[220:223], v[84:87]
ds_read_b64_tr_b16 a[22:23], v7 offset:8992
v_mfma_f32_16x16x32_bf16 v[72:75], a[56:59], v[216:219], v[72:75]
ds_read_b64_tr_b16 a[24:25], v7 offset:8512
v_mfma_f32_16x16x32_bf16 v[88:91], a[56:59], v[220:223], v[88:91]
ds_read_b64_tr_b16 a[26:27], v7 offset:9024
v_mfma_f32_16x16x32_bf16 v[76:79], a[60:63], v[216:219], v[76:79]
ds_read_b64_tr_b16 a[28:29], v7 offset:8544
v_mfma_f32_16x16x32_bf16 v[92:95], a[60:63], v[220:223], v[92:95]
ds_read_b64_tr_b16 a[30:31], v7 offset:9056
s_waitcnt lgkmcnt(8)
v_mfma_f32_16x16x32_bf16 v[32:35], a[0:3], v[96:99], v[32:35]
ds_read_b64_tr_b16 a[32:33], v7 offset:16896
v_cvt_pk_bf16_f32 v232, v64, v65
v_cvt_pk_bf16_f32 v233, v66, v67
v_mfma_f32_16x16x32_bf16 v[48:51], a[0:3], v[100:103], v[48:51]
ds_read_b64_tr_b16 a[34:35], v7 offset:17408
v_cvt_pk_bf16_f32 v234, v68, v69
v_mfma_f32_16x16x32_bf16 v[36:39], a[4:7], v[96:99], v[36:39]
ds_read_b64_tr_b16 a[36:37], v7 offset:16928
v_cvt_pk_bf16_f32 v235, v70, v71
buffer_store_dwordx4 v[232:235], v11, s[16:19], s69 offen sc1
v_mfma_f32_16x16x32_bf16 v[52:55], a[4:7], v[100:103], v[52:55]
ds_read_b64_tr_b16 a[38:39], v7 offset:17440
s_add_u32 s69, s69, 131072
v_mfma_f32_16x16x32_bf16 v[40:43], a[8:11], v[96:99], v[40:43]
ds_read_b64_tr_b16 a[40:41], v7 offset:16960
v_cvt_pk_bf16_f32 v236, v72, v73
v_cvt_pk_bf16_f32 v237, v74, v75
v_mfma_f32_16x16x32_bf16 v[56:59], a[8:11], v[100:103], v[56:59]
ds_read_b64_tr_b16 a[42:43], v7 offset:17472
v_cvt_pk_bf16_f32 v238, v76, v77
v_mfma_f32_16x16x32_bf16 v[44:47], a[12:15], v[96:99], v[44:47]
ds_read_b64_tr_b16 a[44:45], v7 offset:16992
v_cvt_pk_bf16_f32 v239, v78, v79
buffer_store_dwordx4 v[236:239], v11, s[16:19], s69 offen sc1
v_mfma_f32_16x16x32_bf16 v[60:63], a[12:15], v[100:103], v[60:63]
ds_read_b64_tr_b16 a[46:47], v7 offset:17504
s_add_u32 s69, s69, -130048
s_waitcnt lgkmcnt(8)
v_mfma_f32_16x16x32_bf16 v[32:35], a[16:19], v[104:107], v[32:35]
ds_read_b64_tr_b16 a[48:49], v7 offset:25344
v_cvt_pk_bf16_f32 v240, v80, v81
v_mfma_f32_16x16x32_bf16 v[48:51], a[16:19], v[108:111], v[48:51]
ds_read_b64_tr_b16 a[50:51], v7 offset:25856
v_cvt_pk_bf16_f32 v241, v82, v83
v_cvt_pk_bf16_f32 v242, v84, v85
v_mfma_f32_16x16x32_bf16 v[36:39], a[20:23], v[104:107], v[36:39]
ds_read_b64_tr_b16 a[52:53], v7 offset:25376
v_cvt_pk_bf16_f32 v243, v86, v87
v_mfma_f32_16x16x32_bf16 v[52:55], a[20:23], v[108:111], v[52:55]
ds_read_b64_tr_b16 a[54:55], v7 offset:25888
buffer_store_dwordx4 v[240:243], v11, s[16:19], s69 offen sc1
s_add_u32 s69, s69, 131072
v_mfma_f32_16x16x32_bf16 v[40:43], a[24:27], v[104:107], v[40:43]
ds_read_b64_tr_b16 a[56:57], v7 offset:25408
v_cvt_pk_bf16_f32 v244, v88, v89
v_mfma_f32_16x16x32_bf16 v[56:59], a[24:27], v[108:111], v[56:59]
ds_read_b64_tr_b16 a[58:59], v7 offset:25920
v_cvt_pk_bf16_f32 v245, v90, v91
v_cvt_pk_bf16_f32 v246, v92, v93
v_mfma_f32_16x16x32_bf16 v[44:47], a[28:31], v[104:107], v[44:47]
ds_read_b64_tr_b16 a[60:61], v7 offset:25440
v_cvt_pk_bf16_f32 v247, v94, v95
v_mfma_f32_16x16x32_bf16 v[60:63], a[28:31], v[108:111], v[60:63]
ds_read_b64_tr_b16 a[62:63], v7 offset:25952
buffer_store_dwordx4 v[244:247], v11, s[16:19], s69 offen sc1
s_waitcnt lgkmcnt(8)
v_mfma_f32_16x16x32_bf16 v[32:35], a[32:35], v[112:115], v[32:35]
ds_read_b64_tr_b16 a[0:1], v7 offset:33792
v_mfma_f32_16x16x32_bf16 v[48:51], a[32:35], v[116:119], v[48:51]
ds_read_b64_tr_b16 a[2:3], v7 offset:34304
v_mfma_f32_16x16x32_bf16 v[36:39], a[36:39], v[112:115], v[36:39]
ds_read_b64_tr_b16 a[4:5], v7 offset:33824
v_mfma_f32_16x16x32_bf16 v[52:55], a[36:39], v[116:119], v[52:55]
ds_read_b64_tr_b16 a[6:7], v7 offset:34336
v_mfma_f32_16x16x32_bf16 v[40:43], a[40:43], v[112:115], v[40:43]
ds_read_b64_tr_b16 a[8:9], v7 offset:33856
v_mfma_f32_16x16x32_bf16 v[56:59], a[40:43], v[116:119], v[56:59]
ds_read_b64_tr_b16 a[10:11], v7 offset:34368
v_mfma_f32_16x16x32_bf16 v[44:47], a[44:47], v[112:115], v[44:47]
ds_read_b64_tr_b16 a[12:13], v7 offset:33888
v_mfma_f32_16x16x32_bf16 v[60:63], a[44:47], v[116:119], v[60:63]
ds_read_b64_tr_b16 a[14:15], v7 offset:34400
s_waitcnt lgkmcnt(8)
v_mfma_f32_16x16x32_bf16 v[32:35], a[48:51], v[120:123], v[32:35]
ds_read_b64_tr_b16 a[16:17], v7 offset:42240
v_mfma_f32_16x16x32_bf16 v[48:51], a[48:51], v[124:127], v[48:51]
ds_read_b64_tr_b16 a[18:19], v7 offset:42752
v_mfma_f32_16x16x32_bf16 v[36:39], a[52:55], v[120:123], v[36:39]
ds_read_b64_tr_b16 a[20:21], v7 offset:42272
v_mfma_f32_16x16x32_bf16 v[52:55], a[52:55], v[124:127], v[52:55]
ds_read_b64_tr_b16 a[22:23], v7 offset:42784
v_mfma_f32_16x16x32_bf16 v[40:43], a[56:59], v[120:123], v[40:43]
ds_read_b64_tr_b16 a[24:25], v7 offset:42304
v_mfma_f32_16x16x32_bf16 v[56:59], a[56:59], v[124:127], v[56:59]
ds_read_b64_tr_b16 a[26:27], v7 offset:42816
v_mfma_f32_16x16x32_bf16 v[44:47], a[60:63], v[120:123], v[44:47]
ds_read_b64_tr_b16 a[28:29], v7 offset:42336
v_mfma_f32_16x16x32_bf16 v[60:63], a[60:63], v[124:127], v[60:63]
ds_read_b64_tr_b16 a[30:31], v7 offset:42848
s_waitcnt lgkmcnt(8)
v_mfma_f32_16x16x32_bf16 v[32:35], a[0:3], v[128:131], v[32:35]
ds_read_b64_tr_b16 a[32:33], v7 offset:50688
v_mfma_f32_16x16x32_bf16 v[48:51], a[0:3], v[132:135], v[48:51]
ds_read_b64_tr_b16 a[34:35], v7 offset:51200
v_mfma_f32_16x16x32_bf16 v[36:39], a[4:7], v[128:131], v[36:39]
ds_read_b64_tr_b16 a[36:37], v7 offset:50720
v_mfma_f32_16x16x32_bf16 v[52:55], a[4:7], v[132:135], v[52:55]
ds_read_b64_tr_b16 a[38:39], v7 offset:51232
v_mfma_f32_16x16x32_bf16 v[40:43], a[8:11], v[128:131], v[40:43]
ds_read_b64_tr_b16 a[40:41], v7 offset:50752
v_mfma_f32_16x16x32_bf16 v[56:59], a[8:11], v[132:135], v[56:59]
ds_read_b64_tr_b16 a[42:43], v7 offset:51264
v_mfma_f32_16x16x32_bf16 v[44:47], a[12:15], v[128:131], v[44:47]
ds_read_b64_tr_b16 a[44:45], v7 offset:50784
v_mfma_f32_16x16x32_bf16 v[60:63], a[12:15], v[132:135], v[60:63]
ds_read_b64_tr_b16 a[46:47], v7 offset:51296
s_waitcnt lgkmcnt(8)
v_mfma_f32_16x16x32_bf16 v[32:35], a[16:19], v[136:139], v[32:35]
ds_read_b64_tr_b16 a[48:49], v7 offset:59136
v_mfma_f32_16x16x32_bf16 v[48:51], a[16:19], v[140:143], v[48:51]
ds_read_b64_tr_b16 a[50:51], v7 offset:59648
v_mfma_f32_16x16x32_bf16 v[36:39], a[20:23], v[136:139], v[36:39]
ds_read_b64_tr_b16 a[52:53], v7 offset:59168
v_mfma_f32_16x16x32_bf16 v[52:55], a[20:23], v[140:143], v[52:55]
ds_read_b64_tr_b16 a[54:55], v7 offset:59680
v_mfma_f32_16x16x32_bf16 v[40:43], a[24:27], v[136:139], v[40:43]
ds_read_b64_tr_b16 a[56:57], v7 offset:59200
v_mfma_f32_16x16x32_bf16 v[56:59], a[24:27], v[140:143], v[56:59]
ds_read_b64_tr_b16 a[58:59], v7 offset:59712
v_mfma_f32_16x16x32_bf16 v[44:47], a[28:31], v[136:139], v[44:47]
ds_read_b64_tr_b16 a[60:61], v7 offset:59232
v_mfma_f32_16x16x32_bf16 v[60:63], a[28:31], v[140:143], v[60:63]
ds_read_b64_tr_b16 a[62:63], v7 offset:59744
v_add_u32 v7, s57, v7
s_waitcnt lgkmcnt(8)
v_mfma_f32_16x16x32_bf16 v[32:35], a[32:35], v[144:147], v[32:35]
ds_read_b64_tr_b16 a[0:1], v7
v_mfma_f32_16x16x32_bf16 v[48:51], a[32:35], v[148:151], v[48:51]
ds_read_b64_tr_b16 a[2:3], v7 offset:512
v_mfma_f32_16x16x32_bf16 v[36:39], a[36:39], v[144:147], v[36:39]
ds_read_b64_tr_b16 a[4:5], v7 offset:32
v_mfma_f32_16x16x32_bf16 v[52:55], a[36:39], v[148:151], v[52:55]
ds_read_b64_tr_b16 a[6:7], v7 offset:544
v_mfma_f32_16x16x32_bf16 v[40:43], a[40:43], v[144:147], v[40:43]
ds_read_b64_tr_b16 a[8:9], v7 offset:64
v_mfma_f32_16x16x32_bf16 v[56:59], a[40:43], v[148:151], v[56:59]
ds_read_b64_tr_b16 a[10:11], v7 offset:576
v_mfma_f32_16x16x32_bf16 v[44:47], a[44:47], v[144:147], v[44:47]
ds_read_b64_tr_b16 a[12:13], v7 offset:96
v_mfma_f32_16x16x32_bf16 v[60:63], a[44:47], v[148:151], v[60:63]
ds_read_b64_tr_b16 a[14:15], v7 offset:608
s_waitcnt lgkmcnt(8)
v_mfma_f32_16x16x32_bf16 v[32:35], a[48:51], v[152:155], v[32:35]
ds_read_b64_tr_b16 a[16:17], v7 offset:8448
v_mfma_f32_16x16x32_bf16 v[48:51], a[48:51], v[156:159], v[48:51]
ds_read_b64_tr_b16 a[18:19], v7 offset:8960
v_mfma_f32_16x16x32_bf16 v[36:39], a[52:55], v[152:155], v[36:39]
ds_read_b64_tr_b16 a[20:21], v7 offset:8480
v_mfma_f32_16x16x32_bf16 v[52:55], a[52:55], v[156:159], v[52:55]
ds_read_b64_tr_b16 a[22:23], v7 offset:8992
v_mfma_f32_16x16x32_bf16 v[40:43], a[56:59], v[152:155], v[40:43]
ds_read_b64_tr_b16 a[24:25], v7 offset:8512
v_mfma_f32_16x16x32_bf16 v[56:59], a[56:59], v[156:159], v[56:59]
ds_read_b64_tr_b16 a[26:27], v7 offset:9024
v_mfma_f32_16x16x32_bf16 v[44:47], a[60:63], v[152:155], v[44:47]
ds_read_b64_tr_b16 a[28:29], v7 offset:8544
v_mfma_f32_16x16x32_bf16 v[60:63], a[60:63], v[156:159], v[60:63]
ds_read_b64_tr_b16 a[30:31], v7 offset:9056
s_waitcnt lgkmcnt(8)
s_barrier
v_mfma_f32_16x16x32_bf16 v[32:35], a[0:3], v[160:163], v[32:35]
ds_read_b64_tr_b16 a[32:33], v7 offset:16896
ds_read_b64_tr_b16 a[34:35], v7 offset:17408
v_mfma_f32_16x16x32_bf16 v[48:51], a[0:3], v[164:167], v[48:51]
s_waitcnt vmcnt(0)
buffer_atomic_add v13, v12, s[16:19], s71 offen
v_mfma_f32_16x16x32_bf16 v[36:39], a[4:7], v[160:163], v[36:39]
ds_read_b64_tr_b16 a[36:37], v7 offset:16928
ds_read_b64_tr_b16 a[38:39], v7 offset:17440
v_mfma_f32_16x16x32_bf16 v[52:55], a[4:7], v[164:167], v[52:55]
ds_read_b64_tr_b16 a[40:41], v7 offset:16960
s_add_u32 m0, s59, 117248
v_mfma_f32_16x16x32_bf16 v[40:43], a[8:11], v[160:163], v[40:43]
buffer_load_dwordx4 v18, s[20:23], s58 offen lds
v_mfma_f32_16x16x32_bf16 v[56:59], a[8:11], v[164:167], v[56:59]
ds_read_b64_tr_b16 a[42:43], v7 offset:17472
ds_read_b64_tr_b16 a[44:45], v7 offset:16992
v_mfma_f32_16x16x32_bf16 v[44:47], a[12:15], v[160:163], v[44:47]
ds_read_b64_tr_b16 a[46:47], v7 offset:17504
v_mfma_f32_16x16x32_bf16 v[60:63], a[12:15], v[164:167], v[60:63]
ds_read_b64_tr_b16 a[48:49], v7 offset:25344
s_waitcnt lgkmcnt(9)
v_mfma_f32_16x16x32_bf16 v[32:35], a[16:19], v[168:171], v[32:35]
buffer_load_dwordx4 v19, s[20:23], s58 offen offset:1024 lds
v_mfma_f32_16x16x32_bf16 v[48:51], a[16:19], v[172:175], v[48:51]
ds_read_b64_tr_b16 a[50:51], v7 offset:25856
ds_read_b64_tr_b16 a[52:53], v7 offset:25376
v_mfma_f32_16x16x32_bf16 v[36:39], a[20:23], v[168:171], v[36:39]
buffer_load_dwordx4 v20, s[20:23], s58 offen offset:2048 lds
v_mfma_f32_16x16x32_bf16 v[52:55], a[20:23], v[172:175], v[52:55]
ds_read_b64_tr_b16 a[54:55], v7 offset:25888
s_add_u32 s58, s58, 196608
v_mfma_f32_16x16x32_bf16 v[40:43], a[24:27], v[168:171], v[40:43]
ds_read_b64_tr_b16 a[56:57], v7 offset:25408
s_add_u32 m0, s59, 129664
v_mfma_f32_16x16x32_bf16 v[56:59], a[24:27], v[172:175], v[56:59]
buffer_load_dwordx4 v18, s[20:23], s58 offen lds
v_mfma_f32_16x16x32_bf16 v[44:47], a[28:31], v[168:171], v[44:47]
ds_read_b64_tr_b16 a[58:59], v7 offset:25920
ds_read_b64_tr_b16 a[60:61], v7 offset:25440
v_mfma_f32_16x16x32_bf16 v[60:63], a[28:31], v[172:175], v[60:63]
ds_read_b64_tr_b16 a[62:63], v7 offset:25952
s_waitcnt lgkmcnt(8)
v_mfma_f32_16x16x32_bf16 v[32:35], a[32:35], v[176:179], v[32:35]
ds_read_b64_tr_b16 a[0:1], v7 offset:33792
ds_read_b64_tr_b16 a[2:3], v7 offset:34304
v_mfma_f32_16x16x32_bf16 v[48:51], a[32:35], v[180:183], v[48:51]
buffer_load_dwordx4 v19, s[20:23], s58 offen offset:1024 lds
v_mfma_f32_16x16x32_bf16 v[36:39], a[36:39], v[176:179], v[36:39]
ds_read_b64_tr_b16 a[4:5], v7 offset:33824
v_mfma_f32_16x16x32_bf16 v[52:55], a[36:39], v[180:183], v[52:55]
ds_read_b64_tr_b16 a[6:7], v7 offset:34336
ds_read_b64_tr_b16 a[8:9], v7 offset:33856
v_mfma_f32_16x16x32_bf16 v[40:43], a[40:43], v[176:179], v[40:43]
buffer_load_dwordx4 v20, s[20:23], s58 offen offset:2048 lds
v_mfma_f32_16x16x32_bf16 v[56:59], a[40:43], v[180:183], v[56:59]
ds_read_b64_tr_b16 a[10:11], v7 offset:34368
s_add_u32 s58, s58, 196608
v_mfma_f32_16x16x32_bf16 v[44:47], a[44:47], v[176:179], v[44:47]
ds_read_b64_tr_b16 a[12:13], v7 offset:33888
v_mfma_f32_16x16x32_bf16 v[60:63], a[44:47], v[180:183], v[60:63]
ds_read_b64_tr_b16 a[14:15], v7 offset:34400
s_add_u32 m0, s59, 67584
.Lpad18:
s_cbranch_execz .Lnopoll39r
s_waitcnt lgkmcnt(8)
v_mfma_f32_16x16x32_bf16 v[32:35], a[48:51], v[184:187], v[32:35]
buffer_load_dwordx4 v18, s[20:23], s58 offen lds
v_mfma_f32_16x16x32_bf16 v[48:51], a[48:51], v[188:191], v[48:51]
ds_read_b64_tr_b16 a[16:17], v7 offset:42240
v_mfma_f32_16x16x32_bf16 v[36:39], a[52:55], v[184:187], v[36:39]
ds_read_b64_tr_b16 a[18:19], v7 offset:42752
ds_read_b64_tr_b16 a[20:21], v7 offset:42272
v_mfma_f32_16x16x32_bf16 v[52:55], a[52:55], v[188:191], v[52:55]
ds_read_b64_tr_b16 a[22:23], v7 offset:42784
v_mfma_f32_16x16x32_bf16 v[40:43], a[56:59], v[184:187], v[40:43]
buffer_load_dwordx4 v19, s[20:23], s58 offen offset:1024 lds
v_mfma_f32_16x16x32_bf16 v[56:59], a[56:59], v[188:191], v[56:59]
ds_read_b64_tr_b16 a[24:25], v7 offset:42304
ds_read_b64_tr_b16 a[26:27], v7 offset:42816
v_mfma_f32_16x16x32_bf16 v[44:47], a[60:63], v[184:187], v[44:47]
ds_read_b64_tr_b16 a[28:29], v7 offset:42336
v_mfma_f32_16x16x32_bf16 v[60:63], a[60:63], v[188:191], v[60:63]
ds_read_b64_tr_b16 a[30:31], v7 offset:42848
s_waitcnt lgkmcnt(8)
v_mfma_f32_16x16x32_bf16 v[32:35], a[0:3], v[192:195], v[32:35]
ds_read_b64_tr_b16 a[32:33], v7 offset:50688
ds_read_b64_tr_b16 a[34:35], v7 offset:51200
v_mfma_f32_16x16x32_bf16 v[48:51], a[0:3], v[196:199], v[48:51]
buffer_atomic_add v15, v12, s[16:19], s70 offen sc0
v_mfma_f32_16x16x32_bf16 v[36:39], a[4:7], v[192:195], v[36:39]
ds_read_b64_tr_b16 a[36:37], v7 offset:50720
ds_read_b64_tr_b16 a[38:39], v7 offset:51232
v_mfma_f32_16x16x32_bf16 v[52:55], a[4:7], v[196:199], v[52:55]
ds_read_b64_tr_b16 a[40:41], v7 offset:50752
ds_read_b64_tr_b16 a[42:43], v7 offset:51264
v_mfma_f32_16x16x32_bf16 v[40:43], a[8:11], v[192:195], v[40:43]
buffer_load_dwordx4 v20, s[20:23], s58 offen offset:2048 lds
v_mfma_f32_16x16x32_bf16 v[56:59], a[8:11], v[196:199], v[56:59]
s_add_u32 s58, s58, 196608
v_mfma_f32_16x16x32_bf16 v[44:47], a[12:15], v[192:195], v[44:47]
ds_read_b64_tr_b16 a[44:45], v7 offset:50784
ds_read_b64_tr_b16 a[46:47], v7 offset:51296
v_mfma_f32_16x16x32_bf16 v[60:63], a[12:15], v[196:199], v[60:63]
ds_read_b64_tr_b16 a[48:49], v7 offset:59136
s_add_u32 m0, s59, 80000
s_waitcnt lgkmcnt(9)
v_mfma_f32_16x16x32_bf16 v[32:35], a[16:19], v[200:203], v[32:35]
buffer_load_dwordx4 v18, s[20:23], s58 offen lds
v_mfma_f32_16x16x32_bf16 v[48:51], a[16:19], v[204:207], v[48:51]
ds_read_b64_tr_b16 a[50:51], v7 offset:59648
ds_read_b64_tr_b16 a[52:53], v7 offset:59168
v_mfma_f32_16x16x32_bf16 v[36:39], a[20:23], v[200:203], v[36:39]
buffer_load_dwordx4 v19, s[20:23], s58 offen offset:1024 lds
v_mfma_f32_16x16x32_bf16 v[52:55], a[20:23], v[204:207], v[52:55]
ds_read_b64_tr_b16 a[54:55], v7 offset:59680
v_mfma_f32_16x16x32_bf16 v[40:43], a[24:27], v[200:203], v[40:43]
ds_read_b64_tr_b16 a[56:57], v7 offset:59200
ds_read_b64_tr_b16 a[58:59], v7 offset:59712
v_mfma_f32_16x16x32_bf16 v[56:59], a[24:27], v[204:207], v[56:59]
buffer_load_dwordx4 v20, s[20:23], s58 offen offset:2048 lds
v_mfma_f32_16x16x32_bf16 v[44:47], a[28:31], v[200:203], v[44:47]
ds_read_b64_tr_b16 a[60:61], v7 offset:59232
s_add_u32 s58, s58, 196608
v_mfma_f32_16x16x32_bf16 v[60:63], a[28:31], v[204:207], v[60:63]
ds_read_b64_tr_b16 a[62:63], v7 offset:59744
s_waitcnt lgkmcnt(8)
v_mfma_f32_16x16x32_bf16 v[32:35], a[32:35], v[208:211], v[32:35]
s_add_u32 m0, s59, 92416
v_mfma_f32_16x16x32_bf16 v[48:51], a[32:35], v[212:215], v[48:51]
buffer_load_dwordx4 v18, s[20:23], s58 offen lds
v_mfma_f32_16x16x32_bf16 v[36:39], a[36:39], v[208:211], v[36:39]
v_mfma_f32_16x16x32_bf16 v[52:55], a[36:39], v[212:215], v[52:55]
v_mfma_f32_16x16x32_bf16 v[40:43], a[40:43], v[208:211], v[40:43]
v_mfma_f32_16x16x32_bf16 v[56:59], a[40:43], v[212:215], v[56:59]
v_mfma_f32_16x16x32_bf16 v[44:47], a[44:47], v[208:211], v[44:47]
buffer_load_dwordx4 v19, s[20:23], s58 offen offset:1024 lds
v_mfma_f32_16x16x32_bf16 v[60:63], a[44:47], v[212:215], v[60:63]
s_waitcnt lgkmcnt(0)
v_mfma_f32_16x16x32_bf16 v[32:35], a[48:51], v[216:219], v[32:35]
v_mfma_f32_16x16x32_bf16 v[48:51], a[48:51], v[220:223], v[48:51]
v_mfma_f32_16x16x32_bf16 v[36:39], a[52:55], v[216:219], v[36:39]
v_mfma_f32_16x16x32_bf16 v[52:55], a[52:55], v[220:223], v[52:55]
buffer_load_dwordx4 v20, s[20:23], s58 offen offset:2048 lds
v_mfma_f32_16x16x32_bf16 v[40:43], a[56:59], v[216:219], v[40:43]
s_add_u32 s58, s58, 196608
v_mfma_f32_16x16x32_bf16 v[56:59], a[56:59], v[220:223], v[56:59]
v_mfma_f32_16x16x32_bf16 v[44:47], a[60:63], v[216:219], v[44:47]
v_mfma_f32_16x16x32_bf16 v[60:63], a[60:63], v[220:223], v[60:63]
s_waitcnt vmcnt(7)
v_cmp_ne_u32 vcc, 0, v15
s_nop 0
s_cbranch_vccz .Lxs42
.Lxs42b:
buffer_load_dwordx4 v[232:235], v11, s[16:19], s68 offen sc1
s_add_u32 s68, s68, 131072
buffer_load_dwordx4 v[236:239], v11, s[16:19], s68 offen sc1
s_add_u32 s68, s68, -130048
buffer_load_dwordx4 v[240:243], v11, s[16:19], s68 offen sc1
s_add_u32 s68, s68, 131072
buffer_load_dwordx4 v[244:247], v11, s[16:19], s68 offen sc1
s_waitcnt vmcnt(3)
v_mfma_f32_16x16x32_bf16 v[32:35], v[226:229], v[232:235], v[32:35]
s_lshl_b32 s64, s6, 14
s_lshl_b32 s65, s49, 13
s_add_u32 s64, s64, s65
v_mfma_f32_16x16x32_bf16 v[36:39], v[224:227], v[232:235], v[36:39]
s_lshl_b32 s65, s7, 9
s_add_u32 s64, s64, s65
s_lshl_b32 s65, s48, 8
s_waitcnt vmcnt(2)
v_mfma_f32_16x16x32_bf16 v[40:43], v[226:229], v[236:239], v[40:43]
s_add_u32 s64, s64, s65
s_add_u32 s64, s64, 62914560
v_and_b32 v152, 31, v1
v_mfma_f32_16x16x32_bf16 v[44:47], v[224:227], v[236:239], v[44:47]
s_lshl_b32 s62, s7, 18
v_lshlrev_b32 v152, 3, v152
v_lshrrev_b32 v153, 5, v1
s_waitcnt vmcnt(1)
v_mfma_f32_16x16x32_bf16 v[48:51], v[226:229], v[240:243], v[48:51]
s_add_u32 s62, s62, 33554432
v_lshl_add_u32 v152, v153, 28, v152
s_add_u32 s63, s62, 0x20000
v_mfma_f32_16x16x32_bf16 v[52:55], v[224:227], v[240:243], v[52:55]
v_cvt_pk_bf16_f32 v128, v32, v33
v_cvt_pk_bf16_f32 v129, v34, v35
s_waitcnt vmcnt(0)
v_mfma_f32_16x16x32_bf16 v[56:59], v[226:229], v[244:247], v[56:59]
v_cvt_pk_bf16_f32 v130, v36, v37
v_cvt_pk_bf16_f32 v131, v38, v39
v_mfma_f32_16x16x32_bf16 v[60:63], v[224:227], v[244:247], v[60:63]
buffer_store_dwordx4 v[128:131], v4, s[16:19], s62 offen sc1
v_cvt_pk_bf16_f32 v132, v40, v41
v_cvt_pk_bf16_f32 v133, v42, v43
v_cvt_pk_bf16_f32 v134, v44, v45
v_cvt_pk_bf16_f32 v135, v46, v47
v_cvt_pk_bf16_f32 v136, v48, v49
v_cvt_pk_bf16_f32 v137, v50, v51
v_cvt_pk_bf16_f32 v138, v52, v53
v_cvt_pk_bf16_f32 v139, v54, v55
v_cvt_pk_bf16_f32 v140, v56, v57
v_cvt_pk_bf16_f32 v141, v58, v59
v_cvt_pk_bf16_f32 v142, v60, v61
v_cvt_pk_bf16_f32 v143, v62, v63
v_pk_mul_f32 v[146:147], v[32:33], v[32:33]
buffer_store_dwordx4 v[132:135], v4, s[16:19], s63 offen sc1
v_pk_mul_f32 v[150:151], v[48:49], v[48:49]
v_pk_fma_f32 v[146:147], v[34:35], v[34:35], v[146:147]
v_pk_add_f32 v[144:145], v[32:33], v[34:35]
v_pk_fma_f32 v[150:151], v[50:51], v[50:51], v[150:151]
v_pk_add_f32 v[148:149], v[48:49], v[50:51]
v_pk_fma_f32 v[146:147], v[36:37], v[36:37], v[146:147]
v_pk_add_f32 v[144:145], v[144:145], v[36:37]
v_pk_fma_f32 v[150:151], v[52:53], v[52:53], v[150:151]
v_pk_add_f32 v[148:149], v[148:149], v[52:53]
v_pk_fma_f32 v[146:147], v[38:39], v[38:39], v[146:147]
v_pk_add_f32 v[144:145], v[144:145], v[38:39]
v_pk_fma_f32 v[150:151], v[54:55], v[54:55], v[150:151]
v_pk_add_f32 v[148:149], v[148:149], v[54:55]
buffer_store_dwordx4 v[136:139], v4, s[16:19], s62 offen offset:1024 sc1
v_pk_fma_f32 v[146:147], v[40:41], v[40:41], v[146:147]
v_pk_add_f32 v[144:145], v[144:145], v[40:41]
v_pk_fma_f32 v[150:151], v[56:57], v[56:57], v[150:151]
v_pk_add_f32 v[148:149], v[148:149], v[56:57]
v_pk_fma_f32 v[146:147], v[42:43], v[42:43], v[146:147]
v_pk_add_f32 v[144:145], v[144:145], v[42:43]
v_pk_fma_f32 v[150:151], v[58:59], v[58:59], v[150:151]
v_pk_add_f32 v[148:149], v[148:149], v[58:59]
v_pk_fma_f32 v[146:147], v[44:45], v[44:45], v[146:147]
v_pk_add_f32 v[144:145], v[144:145], v[44:45]
v_pk_fma_f32 v[150:151], v[60:61], v[60:61], v[150:151]
v_pk_add_f32 v[148:149], v[148:149], v[60:61]
v_pk_fma_f32 v[146:147], v[46:47], v[46:47], v[146:147]
buffer_store_dwordx4 v[140:143], v4, s[16:19], s63 offen offset:1024 sc1
v_pk_add_f32 v[144:145], v[144:145], v[46:47]
v_pk_fma_f32 v[150:151], v[62:63], v[62:63], v[150:151]
v_pk_add_f32 v[148:149], v[148:149], v[62:63]
v_add_f32 v144, v144, v145
v_add_f32 v146, v146, v147
v_add_f32 v148, v148, v149
v_add_f32 v150, v150, v151
s_nop 0
v_permlane16_swap_b32 v144, v148
v_permlane16_swap_b32 v146, v150
v_add_f32 v144, v144, v148
v_add_f32 v146, v146, v150
s_nop 1
v_permlane32_swap_b32 v144, v146
v_add_f32 v144, v144, v146
s_nop 1
v_permlane32_swap_b32 v144, v145
buffer_store_dwordx2 v[144:145], v152, s[16:19], s64 offen sc1
s_nop 1
v_accvgpr_write_b32 a224, v32
v_accvgpr_write_b32 a225, v33
v_accvgpr_write_b32 a226, v34
v_accvgpr_write_b32 a227, v35
v_accvgpr_write_b32 a228, v36
v_accvgpr_write_b32 a229, v37
v_accvgpr_write_b32 a230, v38
v_accvgpr_write_b32 a231, v39
v_accvgpr_write_b32 a232, v40
v_accvgpr_write_b32 a233, v41
v_accvgpr_write_b32 a234, v42
v_accvgpr_write_b32 a235, v43
v_accvgpr_write_b32 a236, v44
v_accvgpr_write_b32 a237, v45
v_accvgpr_write_b32 a238, v46
v_accvgpr_write_b32 a239, v47
v_accvgpr_write_b32 a240, v48
v_accvgpr_write_b32 a241, v49
v_accvgpr_write_b32 a242, v50
v_accvgpr_write_b32 a243, v51
v_accvgpr_write_b32 a244, v52
v_accvgpr_write_b32 a245, v53
v_accvgpr_write_b32 a246, v54
v_accvgpr_write_b32 a247, v55
v_accvgpr_write_b32 a248, v56
v_accvgpr_write_b32 a249, v57
v_accvgpr_write_b32 a250, v58
v_accvgpr_write_b32 a251, v59
v_accvgpr_write_b32 a252, v60
v_accvgpr_write_b32 a253, v61
v_accvgpr_write_b32 a254, v62
v_accvgpr_write_b32 a255, v63
s_lshl_b32 s62, s8, 13
s_lshl_b32 s63, s3, 11
s_add_u32 s62, s62, s63
v_lshl_add_u32 v21, v1, 4, s62
v_lshrrev_b32 v2, 3, v1
v_cmp_eq_u32 vcc, 3, v2
v_add_u32 v2, 67108480, v21
s_nop 0
v_cndmask_b32 v21, v21, v2, vcc
s_lshl_b32 s62, s50, 10
s_sub_u32 s62, s62, 2048
v_lshl_add_u32 v22, v0, 2, s62
v_lshrrev_b32 v2, 5, v0
v_cmp_eq_u32 vcc, 3, v2
v_add_u32 v2, 67108480, v22
s_nop 0
v_cndmask_b32 v22, v22, v2, vcc
s_mul_i32 s62, s48, 4608
v_lshl_add_u32 v23, v1, 4, s62
v_lshrrev_b32 v24, 4, v1
v_mul_u32_u24 v24, 2304, v24
v_and_b32 v2, 15, v1
v_lshl_add_u32 v24, v2, 4, v24
v_bfe_u32 v25, v1, 3, 2
v_mul_u32_u24 v25, 3104, v25
v_bfe_u32 v2, v1, 2, 1
v_lshl_add_u32 v25, v2, 7, v25
v_bfe_u32 v2, v1, 5, 1
v_lshl_add_u32 v25, v2, 8, v25
v_and_b32 v2, 3, v1
v_lshl_add_u32 v25, v2, 3, v25
s_lshl_b32 s62, s49, 6
s_add_u32 s62, s62, 67584
v_add_u32 v25, s62, v25
s_lshl_b32 s62, s8, 1
s_add_u32 s62, s62, s3
s_lshr_b32 s63, s50, 2
s_cmp_lt_u32 s3, 2
s_cselect_b32 s62, s62, s63
s_lshl_b32 s62, s62, 13
s_cmp_eq_u32 s3, 3
s_cselect_b32 s62, 268435456, s62
v_lshl_add_u32 v26, v1, 4, s62
s_lshr_b32 s63, s20, 7
s_sub_u32 s63, 3, s63
s_and_b32 s63, s63, 7
s_and_b32 s62, s9, 8
s_add_u32 s63, s63, s62
s_lshl_b32 s62, s5, 2
s_add_u32 s62, s62, s3
s_mul_i32 s62, s62, 12288
s_lshl_b32 s64, s63, 7
s_add_u32 s62, s62, s64
s_xor_b32 s63, s63, s9
s_cmp_lt_u32 s63, 4
s_cselect_b32 s62, s62, 16777216
v_lshrrev_b32 v14, 3, v1
v_min_u32 v14, 5, v14
v_lshl_add_u32 v14, v14, 11, s62
s_mov_b32 s44, 983040
buffer_load_dword v27, v14, s[20:23], s44 offen
s_mov_b32 s44, 2555904
s_mov_b32 s52, 33554432
s_mov_b32 s54, s58
s_mov_b32 s56, s59
s_mul_i32 s55, s3, 2304
s_mul_i32 s59, s3, 2080
v_bfe_u32 v5, v1, 3, 1
v_lshrrev_b32 v2, 4, v1
v_lshl_add_u32 v5, v2, 3, v5
s_lshl_b32 s62, s3, 1
v_add_u32 v5, s62, v5
v_mul_u32_u24 v5, 2048, v5
v_and_b32 v2, 7, v1
v_lshl_add_u32 v5, v2, 4, v5
s_lshl_b32 s62, s7, 7
v_add_u32 v5, s62, v5
v_add_u32 v6, 64512, v5
s_lshl_b32 s62, s6, 7
s_add_u32 s62, s62, 30416896
s_lshl_b32 s64, s8, 7
s_add_u32 s64, s64, 30416896
s_lshr_b32 s65, s50, 3
s_lshl_b32 s65, s65, 7
s_add_u32 s65, s65, 30416896
v_mov_b32 v252, s62
v_mov_b32 v253, s64
v_writelane_b32 v253, s65, 1
s_waitcnt vmcnt(1) lgkmcnt(0)
s_barrier
s_cmp_lg_u32 s3, 0
s_cbranch_scc1 .Lnosig43
v_mov_b32 v255, 1
s_mov_b64 exec, 1
buffer_atomic_add v255, v252, s[16:19], 0 offen
s_mov_b64 exec, -1
.Lnosig43:
s_cmp_lg_u32 s3, 1
s_cbranch_scc1 .Lfirst47
s_mov_b64 exec, 3
v_mov_b32 v254, 0
buffer_atomic_add v254, v253, s[16:19], 0 offen sc0
s_mov_b64 exec, -1
.Lfirst47:
ds_read_b64_tr_b16 a[20:21], v25 offset:49664
ds_read_b64_tr_b16 a[22:23], v25 offset:50176
ds_read_b64_tr_b16 a[24:25], v25 offset:49696
ds_read_b64_tr_b16 a[26:27], v25 offset:50208
ds_read_b64_tr_b16 a[28:29], v25 offset:50688
ds_read_b64_tr_b16 a[30:31], v25 offset:51200
ds_read_b64_tr_b16 a[32:33], v25 offset:50720
ds_read_b64_tr_b16 a[34:35], v25 offset:51232
ds_read_b64_tr_b16 a[36:37], v25 offset:51712
ds_read_b64_tr_b16 a[38:39], v25 offset:52224
ds_read_b64_tr_b16 a[40:41], v25 offset:51744
ds_read_b64_tr_b16 a[42:43], v25 offset:52256
v_lshrrev_b32 v2, 4, v1
v_lshlrev_b32 v2, 2, v2
v_and_b32 v13, 15, v1
v_sub_u32 v2, v13, v2
v_mov_b32 v13, 0xff61b1e6
v_subrev_u32 v54, 0, v2
v_cmp_gt_u32 vcc, 8, v54
s_nop 1
v_cndmask_b32 v50, v13, 0, vcc
v_cmp_gt_i32 vcc, -8, v54
s_nop 1
v_cndmask_b32 v46, v13, 0, vcc
v_subrev_u32 v54, 1, v2
v_cmp_gt_u32 vcc, 8, v54
s_nop 1
v_cndmask_b32 v51, v13, 0, vcc
v_cmp_gt_i32 vcc, -8, v54
s_nop 1
v_cndmask_b32 v47, v13, 0, vcc
v_subrev_u32 v54, 2, v2
v_cmp_gt_u32 vcc, 8, v54
s_nop 1
v_cndmask_b32 v52, v13, 0, vcc
v_cmp_gt_i32 vcc, -8, v54
s_nop 1
v_cndmask_b32 v48, v13, 0, vcc
v_subrev_u32 v54, 3, v2
v_cmp_gt_u32 vcc, 8, v54
s_nop 1
v_cndmask_b32 v53, v13, 0, vcc
v_cmp_gt_i32 vcc, -8, v54
s_nop 1
v_cndmask_b32 v49, v13, 0, vcc
s_cmp_lt_u32 s8, 2
s_cselect_b64 vcc, -1, 0
v_cndmask_b32 v54, v46, v13, vcc
v_cndmask_b32 v55, v47, v13, vcc
v_cndmask_b32 v56, v48, v13, vcc
v_cndmask_b32 v57, v49, v13, vcc
v_mov_b64 v[60:61], 0
v_mov_b64 v[62:63], 0
v_mov_b64 v[64:65], 0
v_mov_b64 v[66:67], 0
v_mov_b64 v[68:69], 0
v_mov_b64 v[70:71], 0
v_mov_b64 v[72:73], 0
v_mov_b64 v[74:75], 0
v_mov_b64 v[76:77], 0
v_mov_b64 v[78:79], 0
v_mov_b64 v[80:81], 0
v_mov_b64 v[82:83], 0
v_mov_b64 v[84:85], 0
v_mov_b64 v[86:87], 0
v_mov_b64 v[88:89], 0
v_mov_b64 v[90:91], 0
v_mov_b64 v[92:93], 0
v_mov_b64 v[94:95], 0
v_mov_b64 v[96:97], 0
v_mov_b64 v[98:99], 0
v_mov_b64 v[100:101], 0
v_mov_b64 v[102:103], 0
v_mov_b64 v[104:105], 0
v_mov_b64 v[106:107], 0
v_mov_b64 v[108:109], 0
v_mov_b64 v[110:111], 0
v_mov_b64 v[112:113], 0
v_mov_b64 v[114:115], 0
v_mov_b64 v[116:117], 0
v_mov_b64 v[118:119], 0
v_mov_b64 v[120:121], 0
v_mov_b64 v[122:123], 0
v_mov_b64 v[124:125], 0
v_mov_b64 v[126:127], 0
v_mov_b64 v[128:129], 0
v_mov_b64 v[130:131], 0
v_mov_b64 v[132:133], 0
v_mov_b64 v[134:135], 0
v_mov_b64 v[136:137], 0
v_mov_b64 v[138:139], 0
v_mov_b64 v[140:141], 0
v_mov_b64 v[142:143], 0
v_mov_b64 v[144:145], 0
v_mov_b64 v[146:147], 0
v_mov_b64 v[148:149], 0
v_mov_b64 v[150:151], 0
v_mov_b64 v[152:153], 0
v_mov_b64 v[154:155], 0
v_mov_b64 v[156:157], 0
v_mov_b64 v[158:159], 0
v_mov_b64 v[160:161], 0
v_mov_b64 v[162:163], 0
v_mov_b64 v[164:165], 0
v_mov_b64 v[166:167], 0
v_mov_b64 v[168:169], 0
v_mov_b64 v[170:171], 0
v_mov_b64 v[172:173], 0
v_mov_b64 v[174:175], 0
s_mov_b32 s75, 62914560
v_and_b32 v10, 15, v1
v_lshlrev_b32 v12, 2, v10
v_lshlrev_b32 v10, 4, v10
v_add_u32 v10, 152576, v10
v_lshrrev_b32 v11, 4, v1
v_lshlrev_b32 v11, 4, v11
s_lshl_b32 s62, s49, 7
s_add_u32 s62, s62, 158720
v_add_u32 v12, s62, v12
v_add_u32 v13, s62, v11
v_add_u32 v11, 156672, v11
s_lshl_b32 s62, s3, 11
s_add_u32 s62, s62, 143360
v_lshl_add_u32 v8, v1, 4, s62
v_xor_b32 v9, 2048, v8
v_mov_b32 v248, 0x3f803f80
v_mov_b32 v249, 0x3f803f80
v_mov_b32 v250, 0x3f803f80
v_mov_b32 v251, 0x3f803f80
v_and_b32 v7, 31, v1
v_lshrrev_b32 v2, 5, v1
v_lshl_add_u32 v7, v7, 1, v2
v_and_b32 v2, 0xc0, v0
v_add_u32 v7, v7, v2
v_lshlrev_b32 v17, 2, v7
v_add_u32 v17, 156672, v17
v_lshlrev_b32 v7, 4, v7
v_add_u32 v7, 152576, v7
s_lshl_b32 s74, s9, 1
s_add_u32 s74, s74, s49
s_lshl_b32 s74, s74, 17
s_lshl_b32 s63, s8, 13
s_add_u32 s74, s74, s63
s_lshl_b32 s63, s48, 12
s_add_u32 s74, s74, s63
s_add_u32 s74, s74, 37748736
s_mov_b32 s62, 0
v_lshl_add_u32 v4, v1, 4, s62
v_lshrrev_b32 v2, 3, v1
v_cmp_eq_u32 vcc, 3, v2
v_add_u32 v2, 67108480, v4
s_nop 0
v_cndmask_b32 v4, v4, v2, vcc
ds_read_b128 v[28:31], v13
ds_read_b128 v[32:35], v13 offset:64
ds_read_b128 v[36:39], v13 offset:256
ds_read_b128 v[40:43], v13 offset:320
ds_read_b32 v44, v12 offset:512
ds_read_b32 v45, v12 offset:576
s_waitcnt lgkmcnt(0)
s_cmp_lg_u32 s3, 1
s_cbranch_scc1 .Lnopoll46
s_mov_b64 exec, 3
s_mov_b32 s15, 0
.Lpoll44:
s_waitcnt vmcnt(0)
v_cmp_ne_u32 vcc, 16, v254
s_add_u32 s15, s15, 1
s_cbranch_vccz .Lnopoll46r
s_sleep 2
s_mov_b64 exec, 3
v_mov_b32 v254, 0
buffer_atomic_add v254, v253, s[16:19], 0 offen sc0
s_cmp_le_u32 s15, 100000
s_cbranch_scc1 .Lpoll44
.Lgot45:
s_waitcnt vmcnt(0)
s_branch .Lnopoll46r
.Lnopoll46:
s_mov_b64 exec, 0
s_cmp_eq_u32 s3, 2
s_cbranch_scc1 .Lpad19
s_cmp_eq_u32 s3, 3
s_cbranch_scc1 .Lpad20
s_branch .Lpad21
.Lnopoll46r:
s_mov_b64 exec, -1
s_barrier
s_cmp_eq_u32 s48, 1
s_cbranch_scc1 .Lqkv48
s_add_u32 m0, s55, 36864
s_nop 0
buffer_load_dwordx4 v21, s[16:19], s52 offen sc1 lds
buffer_load_dwordx4 v21, s[16:19], s52 offen offset:1024 sc1 lds
buffer_load_dword v22, s[16:19], s52 offen offset:2048 sc1 lds
s_add_u32 s52, s52, 0x20000
s_add_u32 m0, s55, 46080
s_nop 0
buffer_load_dwordx4 v21, s[16:19], s52 offen sc1 lds
buffer_load_dwordx4 v21, s[16:19], s52 offen offset:1024 sc1 lds
buffer_load_dword v22, s[16:19], s52 offen offset:2048 sc1 lds
s_add_u32 s52, s52, 0x20000
s_add_u32 m0, s55, 0
s_nop 0
buffer_load_dwordx4 v21, s[16:19], s52 offen sc1 lds
buffer_load_dwordx4 v21, s[16:19], s52 offen offset:1024 sc1 lds
buffer_load_dword v22, s[16:19], s52 offen offset:2048 sc1 lds
s_add_u32 s52, s52, 0x20000
s_add_u32 m0, s55, 9216
s_nop 0
buffer_load_dwordx4 v21, s[16:19], s52 offen sc1 lds
buffer_load_dwordx4 v21, s[16:19], s52 offen offset:1024 sc1 lds
buffer_load_dword v22, s[16:19], s52 offen offset:2048 sc1 lds
s_add_u32 s52, s52, 0x20000
s_add_u32 m0, s55, 18432
s_nop 0
buffer_load_dwordx4 v21, s[16:19], s52 offen sc1 lds
buffer_load_dwordx4 v21, s[16:19], s52 offen offset:1024 sc1 lds
buffer_load_dword v22, s[16:19], s52 offen offset:2048 sc1 lds
s_add_u32 s52, s52, 0x20000
s_waitcnt vmcnt(12)
s_barrier
ds_read_b128 a[0:3], v23 offset:36864
ds_read_b128 a[4:7], v23 offset:37888
ds_read_b128 a[8:11], v23 offset:39168
ds_read_b128 a[12:15], v23 offset:40192
ds_read_b128 a[16:19], v24 offset:38912
s_waitcnt lgkmcnt(0)
s_mov_b32 s15, -4
.p2align 6
.Lk50:
s_waitcnt vmcnt(9) lgkmcnt(6)
s_barrier
v_mfma_f32_16x16x32_bf16 v[60:63], a[20:23], a[0:3], v[60:63]
ds_read_b128 a[44:47], v23 offset:46080
s_add_u32 m0, s56, 104832
v_mfma_f32_16x16x32_bf16 v[64:67], a[20:23], a[4:7], v[64:67]
buffer_load_dwordx4 v18, s[20:23], s54 offen lds
v_mfma_f32_16x16x32_bf16 v[68:71], a[20:23], a[8:11], v[68:71]
ds_read_b128 a[48:51], v23 offset:47104
v_add_f32 v164, v164, v168
v_mfma_f32_16x16x32_bf16 v[72:75], a[20:23], a[12:15], v[72:75]
ds_read_b128 a[52:55], v23 offset:48384
v_mfma_f32_16x16x32_bf16 v[76:79], a[24:27], a[0:3], v[76:79]
buffer_load_dwordx4 v19, s[20:23], s54 offen offset:1024 lds
v_mfma_f32_16x16x32_bf16 v[80:83], a[24:27], a[4:7], v[80:83]
ds_read_b128 a[56:59], v23 offset:49408
v_mfma_f32_16x16x32_bf16 v[84:87], a[24:27], a[8:11], v[84:87]
ds_read_b64_tr_b16 a[64:65], v25 offset:62080
v_add_f32 v165, v165, v169
v_mfma_f32_16x16x32_bf16 v[88:91], a[24:27], a[12:15], v[88:91]
buffer_load_dwordx4 v20, s[20:23], s54 offen offset:2048 lds
v_mfma_f32_16x16x32_bf16 v[92:95], a[28:31], a[0:3], v[92:95]
ds_read_b64_tr_b16 a[66:67], v25 offset:62592
s_add_u32 s54, s54, 196608
v_mfma_f32_16x16x32_bf16 v[96:99], a[28:31], a[4:7], v[96:99]
ds_read_b64_tr_b16 a[68:69], v25 offset:62112
v_mfma_f32_16x16x32_bf16 v[100:103], a[28:31], a[8:11], v[100:103]
s_add_u32 m0, s55, 27648
s_waitcnt lgkmcnt(7)
v_mfma_f32_16x16x32_bf16 v[104:107], a[28:31], a[12:15], v[104:107]
buffer_load_dwordx4 v21, s[16:19], s52 offen sc1 lds
v_mfma_f32_16x16x32_bf16 v[156:159], a[28:31], a[16:19], v[156:159]
ds_read_b64_tr_b16 a[70:71], v25 offset:62624
v_mfma_f32_16x16x32_bf16 v[108:111], a[32:35], a[0:3], v[108:111]
ds_read_b128 a[60:63], v24 offset:48128
v_add_f32 v166, v166, v170
v_mfma_f32_16x16x32_bf16 v[112:115], a[32:35], a[4:7], v[112:115]
buffer_load_dwordx4 v21, s[16:19], s52 offen offset:1024 sc1 lds
v_mfma_f32_16x16x32_bf16 v[116:119], a[32:35], a[8:11], v[116:119]
ds_read_b64_tr_b16 a[72:73], v25 offset:63104
v_mfma_f32_16x16x32_bf16 v[120:123], a[32:35], a[12:15], v[120:123]
ds_read_b64_tr_b16 a[74:75], v25 offset:63616
v_mfma_f32_16x16x32_bf16 v[160:163], a[32:35], a[16:19], v[160:163]
ds_read_b64_tr_b16 a[76:77], v25 offset:63136
v_add_f32 v167, v167, v171
v_mfma_f32_16x16x32_bf16 v[124:127], a[0:3], a[36:39], v[124:127]
buffer_load_dword v22, s[16:19], s52 offen offset:2048 sc1 lds
v_mfma_f32_16x16x32_bf16 v[128:131], a[4:7], a[36:39], v[128:131]
ds_read_b64_tr_b16 a[78:79], v25 offset:63648
s_add_u32 s52, s52, 0x20000
v_mfma_f32_16x16x32_bf16 v[132:135], a[8:11], a[36:39], v[132:135]
ds_read_b64_tr_b16 a[80:81], v25 offset:64128
v_mfma_f32_16x16x32_bf16 v[136:139], a[12:15], a[36:39], v[136:139]
buffer_load_dword v27, v14, s[20:23], s44 offen
v_mfma_f32_16x16x32_bf16 v[140:143], a[0:3], a[40:43], v[140:143]
ds_read_b64_tr_b16 a[82:83], v25 offset:64640
s_add_u32 s44, s44, 1572864
v_mfma_f32_16x16x32_bf16 v[144:147], a[4:7], a[40:43], v[144:147]
ds_read_b64_tr_b16 a[84:85], v25 offset:64160
v_mfma_f32_16x16x32_bf16 v[148:151], a[8:11], a[40:43], v[148:151]
ds_read_b64_tr_b16 a[86:87], v25 offset:64672
v_mfma_f32_16x16x32_bf16 v[152:155], a[12:15], a[40:43], v[152:155]
s_waitcnt vmcnt(13) lgkmcnt(6)
s_barrier
v_mfma_f32_16x16x32_bf16 v[60:63], a[64:67], a[44:47], v[60:63]
ds_read_b128 a[0:3], v23
s_add_u32 m0, s56, 117248
v_mfma_f32_16x16x32_bf16 v[64:67], a[64:67], a[48:51], v[64:67]
buffer_load_dwordx4 v18, s[20:23], s54 offen lds
v_mfma_f32_16x16x32_bf16 v[68:71], a[64:67], a[52:55], v[68:71]
ds_read_b128 a[4:7], v23 offset:1024
v_mfma_f32_16x16x32_bf16 v[72:75], a[64:67], a[56:59], v[72:75]
ds_read_b128 a[8:11], v23 offset:2304
v_mfma_f32_16x16x32_bf16 v[76:79], a[68:71], a[44:47], v[76:79]
buffer_load_dwordx4 v19, s[20:23], s54 offen offset:1024 lds
v_mfma_f32_16x16x32_bf16 v[80:83], a[68:71], a[48:51], v[80:83]
ds_read_b128 a[12:15], v23 offset:3328
v_mfma_f32_16x16x32_bf16 v[84:87], a[68:71], a[52:55], v[84:87]
ds_read_b64_tr_b16 a[20:21], v25
v_mfma_f32_16x16x32_bf16 v[88:91], a[68:71], a[56:59], v[88:91]
buffer_load_dwordx4 v20, s[20:23], s54 offen offset:2048 lds
v_mfma_f32_16x16x32_bf16 v[92:95], a[72:75], a[44:47], v[92:95]
ds_read_b64_tr_b16 a[22:23], v25 offset:512
s_add_u32 s54, s54, 196608
v_mfma_f32_16x16x32_bf16 v[96:99], a[72:75], a[48:51], v[96:99]
ds_read_b64_tr_b16 a[24:25], v25 offset:32
v_mfma_f32_16x16x32_bf16 v[100:103], a[72:75], a[52:55], v[100:103]
s_add_u32 m0, s55, 36864
s_waitcnt lgkmcnt(7)
v_mfma_f32_16x16x32_bf16 v[104:107], a[72:75], a[56:59], v[104:107]
buffer_load_dwordx4 v21, s[16:19], s52 offen sc1 lds
v_mfma_f32_16x16x32_bf16 v[156:159], a[72:75], a[60:63], v[156:159]
ds_read_b64_tr_b16 a[26:27], v25 offset:544
.Lpad19:
s_cbranch_execz .Lpad22
v_mfma_f32_16x16x32_bf16 v[108:111], a[76:79], a[44:47], v[108:111]
ds_read_b128 a[16:19], v24 offset:2048
v_mfma_f32_16x16x32_bf16 v[112:115], a[76:79], a[48:51], v[112:115]
buffer_load_dwordx4 v21, s[16:19], s52 offen offset:1024 sc1 lds
v_mfma_f32_16x16x32_bf16 v[116:119], a[76:79], a[52:55], v[116:119]
ds_read_b64_tr_b16 a[28:29], v25 offset:1024
v_mfma_f32_16x16x32_bf16 v[120:123], a[76:79], a[56:59], v[120:123]
ds_read_b64_tr_b16 a[30:31], v25 offset:1536
v_mfma_f32_16x16x32_bf16 v[160:163], a[76:79], a[60:63], v[160:163]
ds_read_b64_tr_b16 a[32:33], v25 offset:1056
v_mfma_f32_16x16x32_bf16 v[124:127], a[44:47], a[80:83], v[124:127]
buffer_load_dword v22, s[16:19], s52 offen offset:2048 sc1 lds
v_mfma_f32_16x16x32_bf16 v[128:131], a[48:51], a[80:83], v[128:131]
ds_read_b64_tr_b16 a[34:35], v25 offset:1568
s_add_u32 s52, s52, 0x20000
v_mfma_f32_16x16x32_bf16 v[132:135], a[52:55], a[80:83], v[132:135]
ds_read_b64_tr_b16 a[36:37], v25 offset:2048
v_mfma_f32_16x16x32_bf16 v[136:139], a[56:59], a[80:83], v[136:139]
buffer_load_dwordx4 v[168:171], v26, s[16:19], s75 offen sc1
v_mfma_f32_16x16x32_bf16 v[140:143], a[44:47], a[84:87], v[140:143]
ds_read_b64_tr_b16 a[38:39], v25 offset:2560
v_mfma_f32_16x16x32_bf16 v[144:147], a[48:51], a[84:87], v[144:147]
ds_read_b64_tr_b16 a[40:41], v25 offset:2080
v_mfma_f32_16x16x32_bf16 v[148:151], a[52:55], a[84:87], v[148:151]
ds_read_b64_tr_b16 a[42:43], v25 offset:2592
v_mfma_f32_16x16x32_bf16 v[152:155], a[56:59], a[84:87], v[152:155]
s_waitcnt vmcnt(17) lgkmcnt(6)
s_barrier
v_mfma_f32_16x16x32_bf16 v[60:63], a[20:23], a[0:3], v[60:63]
ds_read_b128 a[44:47], v23 offset:9216
s_add_u32 m0, s56, 129664
v_mfma_f32_16x16x32_bf16 v[64:67], a[20:23], a[4:7], v[64:67]
buffer_load_dwordx4 v18, s[20:23], s54 offen lds
v_mfma_f32_16x16x32_bf16 v[68:71], a[20:23], a[8:11], v[68:71]
ds_read_b128 a[48:51], v23 offset:10240
v_mfma_f32_16x16x32_bf16 v[72:75], a[20:23], a[12:15], v[72:75]
ds_read_b128 a[52:55], v23 offset:11520
v_mfma_f32_16x16x32_bf16 v[76:79], a[24:27], a[0:3], v[76:79]
ds_read_b128 a[56:59], v23 offset:12544
v_mfma_f32_16x16x32_bf16 v[80:83], a[24:27], a[4:7], v[80:83]
buffer_load_dwordx4 v19, s[20:23], s54 offen offset:1024 lds
v_mfma_f32_16x16x32_bf16 v[84:87], a[24:27], a[8:11], v[84:87]
ds_read_b64_tr_b16 a[64:65], v25 offset:12416
v_mfma_f32_16x16x32_bf16 v[88:91], a[24:27], a[12:15], v[88:91]
ds_read_b64_tr_b16 a[66:67], v25 offset:12928
v_mfma_f32_16x16x32_bf16 v[92:95], a[28:31], a[0:3], v[92:95]
ds_read_b64_tr_b16 a[68:69], v25 offset:12448
v_mfma_f32_16x16x32_bf16 v[96:99], a[28:31], a[4:7], v[96:99]
buffer_load_dwordx4 v20, s[20:23], s54 offen offset:2048 lds
v_mfma_f32_16x16x32_bf16 v[100:103], a[28:31], a[8:11], v[100:103]
s_add_u32 s54, s54, 196608
s_waitcnt lgkmcnt(7)
v_mfma_f32_16x16x32_bf16 v[104:107], a[28:31], a[12:15], v[104:107]
ds_read_b64_tr_b16 a[70:71], v25 offset:12960
v_mfma_f32_16x16x32_bf16 v[156:159], a[28:31], a[16:19], v[156:159]
ds_read_b128 a[60:63], v24 offset:11264
s_add_u32 m0, s55, 46080
v_mfma_f32_16x16x32_bf16 v[108:111], a[32:35], a[0:3], v[108:111]
buffer_load_dwordx4 v21, s[16:19], s52 offen sc1 lds
v_mfma_f32_16x16x32_bf16 v[112:115], a[32:35], a[4:7], v[112:115]
ds_read_b64_tr_b16 a[72:73], v25 offset:13440
v_mfma_f32_16x16x32_bf16 v[116:119], a[32:35], a[8:11], v[116:119]
ds_read_b64_tr_b16 a[74:75], v25 offset:13952
v_mfma_f32_16x16x32_bf16 v[120:123], a[32:35], a[12:15], v[120:123]
ds_read_b64_tr_b16 a[76:77], v25 offset:13472
v_mfma_f32_16x16x32_bf16 v[160:163], a[32:35], a[16:19], v[160:163]
buffer_load_dwordx4 v21, s[16:19], s52 offen offset:1024 sc1 lds
v_mfma_f32_16x16x32_bf16 v[124:127], a[0:3], a[36:39], v[124:127]
ds_read_b64_tr_b16 a[78:79], v25 offset:13984
v_mfma_f32_16x16x32_bf16 v[128:131], a[4:7], a[36:39], v[128:131]
ds_read_b64_tr_b16 a[80:81], v25 offset:14464
v_mfma_f32_16x16x32_bf16 v[132:135], a[8:11], a[36:39], v[132:135]
ds_read_b64_tr_b16 a[82:83], v25 offset:14976
v_mfma_f32_16x16x32_bf16 v[136:139], a[12:15], a[36:39], v[136:139]
buffer_load_dword v22, s[16:19], s52 offen offset:2048 sc1 lds
v_mfma_f32_16x16x32_bf16 v[140:143], a[0:3], a[40:43], v[140:143]
ds_read_b64_tr_b16 a[84:85], v25 offset:14496
s_add_u32 s52, s52, 0x20000
v_mfma_f32_16x16x32_bf16 v[144:147], a[4:7], a[40:43], v[144:147]
ds_read_b64_tr_b16 a[86:87], v25 offset:15008
v_mfma_f32_16x16x32_bf16 v[148:151], a[8:11], a[40:43], v[148:151]
v_mfma_f32_16x16x32_bf16 v[152:155], a[12:15], a[40:43], v[152:155]
s_waitcnt vmcnt(20) lgkmcnt(6)
s_barrier
v_mfma_f32_16x16x32_bf16 v[60:63], a[64:67], a[44:47], v[60:63]
ds_read_b128 a[0:3], v23 offset:18432
s_add_u32 m0, s56, 67584
v_mfma_f32_16x16x32_bf16 v[64:67], a[64:67], a[48:51], v[64:67]
buffer_load_dwordx4 v18, s[20:23], s54 offen lds
v_mfma_f32_16x16x32_bf16 v[68:71], a[64:67], a[52:55], v[68:71]
ds_read_b128 a[4:7], v23 offset:19456
v_add_f32 v164, v164, v172
v_mfma_f32_16x16x32_bf16 v[72:75], a[64:67], a[56:59], v[72:75]
ds_read_b128 a[8:11], v23 offset:20736
v_mfma_f32_16x16x32_bf16 v[76:79], a[68:71], a[44:47], v[76:79]
ds_read_b128 a[12:15], v23 offset:21760
v_mfma_f32_16x16x32_bf16 v[80:83], a[68:71], a[48:51], v[80:83]
buffer_load_dwordx4 v19, s[20:23], s54 offen offset:1024 lds
v_mfma_f32_16x16x32_bf16 v[84:87], a[68:71], a[52:55], v[84:87]
ds_read_b64_tr_b16 a[20:21], v25 offset:24832
v_mfma_f32_16x16x32_bf16 v[88:91], a[68:71], a[56:59], v[88:91]
ds_read_b64_tr_b16 a[22:23], v25 offset:25344
v_add_f32 v165, v165, v173
v_mfma_f32_16x16x32_bf16 v[92:95], a[72:75], a[44:47], v[92:95]
ds_read_b64_tr_b16 a[24:25], v25 offset:24864
v_mfma_f32_16x16x32_bf16 v[96:99], a[72:75], a[48:51], v[96:99]
buffer_load_dwordx4 v20, s[20:23], s54 offen offset:2048 lds
v_mfma_f32_16x16x32_bf16 v[100:103], a[72:75], a[52:55], v[100:103]
s_add_u32 s54, s54, 196608
s_waitcnt lgkmcnt(7)
v_mfma_f32_16x16x32_bf16 v[104:107], a[72:75], a[56:59], v[104:107]
ds_read_b64_tr_b16 a[26:27], v25 offset:25376
v_mfma_f32_16x16x32_bf16 v[156:159], a[72:75], a[60:63], v[156:159]
ds_read_b128 a[16:19], v24 offset:20480
s_add_u32 m0, s55, 0
v_mfma_f32_16x16x32_bf16 v[108:111], a[76:79], a[44:47], v[108:111]
buffer_load_dwordx4 v21, s[16:19], s52 offen sc1 lds
v_mfma_f32_16x16x32_bf16 v[112:115], a[76:79], a[48:51], v[112:115]
ds_read_b64_tr_b16 a[28:29], v25 offset:25856
v_add_f32 v166, v166, v174
v_mfma_f32_16x16x32_bf16 v[116:119], a[76:79], a[52:55], v[116:119]
ds_read_b64_tr_b16 a[30:31], v25 offset:26368
v_mfma_f32_16x16x32_bf16 v[120:123], a[76:79], a[56:59], v[120:123]
ds_read_b64_tr_b16 a[32:33], v25 offset:25888
v_mfma_f32_16x16x32_bf16 v[160:163], a[76:79], a[60:63], v[160:163]
buffer_load_dwordx4 v21, s[16:19], s52 offen offset:1024 sc1 lds
v_mfma_f32_16x16x32_bf16 v[124:127], a[44:47], a[80:83], v[124:127]
ds_read_b64_tr_b16 a[34:35], v25 offset:26400
v_mfma_f32_16x16x32_bf16 v[128:131], a[48:51], a[80:83], v[128:131]
ds_read_b64_tr_b16 a[36:37], v25 offset:26880
v_add_f32 v167, v167, v175
v_mfma_f32_16x16x32_bf16 v[132:135], a[52:55], a[80:83], v[132:135]
ds_read_b64_tr_b16 a[38:39], v25 offset:27392
v_mfma_f32_16x16x32_bf16 v[136:139], a[56:59], a[80:83], v[136:139]
buffer_load_dword v22, s[16:19], s52 offen offset:2048 sc1 lds
v_mfma_f32_16x16x32_bf16 v[140:143], a[44:47], a[84:87], v[140:143]
ds_read_b64_tr_b16 a[40:41], v25 offset:26912
s_add_u32 s52, s52, 0x20000
v_mfma_f32_16x16x32_bf16 v[144:147], a[48:51], a[84:87], v[144:147]
ds_read_b64_tr_b16 a[42:43], v25 offset:27424
v_mfma_f32_16x16x32_bf16 v[148:151], a[52:55], a[84:87], v[148:151]
v_mfma_f32_16x16x32_bf16 v[152:155], a[56:59], a[84:87], v[152:155]
s_waitcnt vmcnt(20) lgkmcnt(6)
s_barrier
v_mfma_f32_16x16x32_bf16 v[60:63], a[20:23], a[0:3], v[60:63]
ds_read_b128 a[44:47], v23 offset:27648
s_add_u32 m0, s56, 80000
v_mfma_f32_16x16x32_bf16 v[64:67], a[20:23], a[4:7], v[64:67]
buffer_load_dwordx4 v18, s[20:23], s54 offen lds
v_mfma_f32_16x16x32_bf16 v[68:71], a[20:23], a[8:11], v[68:71]
ds_read_b128 a[48:51], v23 offset:28672
v_mfma_f32_16x16x32_bf16 v[72:75], a[20:23], a[12:15], v[72:75]
ds_read_b128 a[52:55], v23 offset:29952
v_mfma_f32_16x16x32_bf16 v[76:79], a[24:27], a[0:3], v[76:79]
buffer_load_dwordx4 v19, s[20:23], s54 offen offset:1024 lds
v_mfma_f32_16x16x32_bf16 v[80:83], a[24:27], a[4:7], v[80:83]
ds_read_b128 a[56:59], v23 offset:30976
v_mfma_f32_16x16x32_bf16 v[84:87], a[24:27], a[8:11], v[84:87]
ds_read_b64_tr_b16 a[64:65], v25 offset:37248
v_mfma_f32_16x16x32_bf16 v[88:91], a[24:27], a[12:15], v[88:91]
buffer_load_dwordx4 v20, s[20:23], s54 offen offset:2048 lds
v_mfma_f32_16x16x32_bf16 v[92:95], a[28:31], a[0:3], v[92:95]
ds_read_b64_tr_b16 a[66:67], v25 offset:37760
s_add_u32 s54, s54, 196608
v_mfma_f32_16x16x32_bf16 v[96:99], a[28:31], a[4:7], v[96:99]
ds_read_b64_tr_b16 a[68:69], v25 offset:37280
v_mfma_f32_16x16x32_bf16 v[100:103], a[28:31], a[8:11], v[100:103]
s_add_u32 m0, s55, 9216
s_waitcnt lgkmcnt(7)
v_mfma_f32_16x16x32_bf16 v[104:107], a[28:31], a[12:15], v[104:107]
buffer_load_dwordx4 v21, s[16:19], s52 offen sc1 lds
v_mfma_f32_16x16x32_bf16 v[156:159], a[28:31], a[16:19], v[156:159]
ds_read_b64_tr_b16 a[70:71], v25 offset:37792
v_mfma_f32_16x16x32_bf16 v[108:111], a[32:35], a[0:3], v[108:111]
ds_read_b128 a[60:63], v24 offset:29696
v_mfma_f32_16x16x32_bf16 v[112:115], a[32:35], a[4:7], v[112:115]
buffer_load_dwordx4 v21, s[16:19], s52 offen offset:1024 sc1 lds
v_mfma_f32_16x16x32_bf16 v[116:119], a[32:35], a[8:11], v[116:119]
ds_read_b64_tr_b16 a[72:73], v25 offset:38272
v_mfma_f32_16x16x32_bf16 v[120:123], a[32:35], a[12:15], v[120:123]
ds_read_b64_tr_b16 a[74:75], v25 offset:38784
v_mfma_f32_16x16x32_bf16 v[160:163], a[32:35], a[16:19], v[160:163]
ds_read_b64_tr_b16 a[76:77], v25 offset:38304
v_mfma_f32_16x16x32_bf16 v[124:127], a[0:3], a[36:39], v[124:127]
buffer_load_dword v22, s[16:19], s52 offen offset:2048 sc1 lds
v_mfma_f32_16x16x32_bf16 v[128:131], a[4:7], a[36:39], v[128:131]
ds_read_b64_tr_b16 a[78:79], v25 offset:38816
s_add_u32 s52, s52, 0x20000
v_mfma_f32_16x16x32_bf16 v[132:135], a[8:11], a[36:39], v[132:135]
ds_read_b64_tr_b16 a[80:81], v25 offset:39296
v_mfma_f32_16x16x32_bf16 v[136:139], a[12:15], a[36:39], v[136:139]
buffer_load_dwordx4 v[172:175], v26, s[16:19], s75 offen offset:1024 sc1
v_mfma_f32_16x16x32_bf16 v[140:143], a[0:3], a[40:43], v[140:143]
ds_read_b64_tr_b16 a[82:83], v25 offset:39808
s_add_u32 s75, s75, 2048
v_mfma_f32_16x16x32_bf16 v[144:147], a[4:7], a[40:43], v[144:147]
ds_read_b64_tr_b16 a[84:85], v25 offset:39328
v_mfma_f32_16x16x32_bf16 v[148:151], a[8:11], a[40:43], v[148:151]
ds_read_b64_tr_b16 a[86:87], v25 offset:39840
v_mfma_f32_16x16x32_bf16 v[152:155], a[12:15], a[40:43], v[152:155]
s_waitcnt vmcnt(20) lgkmcnt(6)
s_barrier
v_mfma_f32_16x16x32_bf16 v[60:63], a[64:67], a[44:47], v[60:63]
ds_read_b128 a[0:3], v23 offset:36864
s_add_u32 m0, s56, 92416
v_mfma_f32_16x16x32_bf16 v[64:67], a[64:67], a[48:51], v[64:67]
buffer_load_dwordx4 v18, s[20:23], s54 offen lds
v_mfma_f32_16x16x32_bf16 v[68:71], a[64:67], a[52:55], v[68:71]
ds_read_b128 a[4:7], v23 offset:37888
v_mfma_f32_16x16x32_bf16 v[72:75], a[64:67], a[56:59], v[72:75]
ds_read_b128 a[8:11], v23 offset:39168
v_mfma_f32_16x16x32_bf16 v[76:79], a[68:71], a[44:47], v[76:79]
ds_read_b128 a[12:15], v23 offset:40192
v_mfma_f32_16x16x32_bf16 v[80:83], a[68:71], a[48:51], v[80:83]
buffer_load_dwordx4 v19, s[20:23], s54 offen offset:1024 lds
v_mfma_f32_16x16x32_bf16 v[84:87], a[68:71], a[52:55], v[84:87]
ds_read_b64_tr_b16 a[20:21], v25 offset:49664
v_mfma_f32_16x16x32_bf16 v[88:91], a[68:71], a[56:59], v[88:91]
ds_read_b64_tr_b16 a[22:23], v25 offset:50176
v_mfma_f32_16x16x32_bf16 v[92:95], a[72:75], a[44:47], v[92:95]
ds_read_b64_tr_b16 a[24:25], v25 offset:49696
v_mfma_f32_16x16x32_bf16 v[96:99], a[72:75], a[48:51], v[96:99]
buffer_load_dwordx4 v20, s[20:23], s54 offen offset:2048 lds
v_mfma_f32_16x16x32_bf16 v[100:103], a[72:75], a[52:55], v[100:103]
s_add_u32 s54, s54, 196608
s_waitcnt lgkmcnt(7)
v_mfma_f32_16x16x32_bf16 v[104:107], a[72:75], a[56:59], v[104:107]
ds_read_b64_tr_b16 a[26:27], v25 offset:50208
v_mfma_f32_16x16x32_bf16 v[156:159], a[72:75], a[60:63], v[156:159]
ds_read_b128 a[16:19], v24 offset:38912
s_add_u32 m0, s55, 18432
v_mfma_f32_16x16x32_bf16 v[108:111], a[76:79], a[44:47], v[108:111]
buffer_load_dwordx4 v21, s[16:19], s52 offen sc1 lds
v_mfma_f32_16x16x32_bf16 v[112:115], a[76:79], a[48:51], v[112:115]
ds_read_b64_tr_b16 a[28:29], v25 offset:50688
v_mfma_f32_16x16x32_bf16 v[116:119], a[76:79], a[52:55], v[116:119]
ds_read_b64_tr_b16 a[30:31], v25 offset:51200
v_mfma_f32_16x16x32_bf16 v[120:123], a[76:79], a[56:59], v[120:123]
ds_read_b64_tr_b16 a[32:33], v25 offset:50720
v_mfma_f32_16x16x32_bf16 v[160:163], a[76:79], a[60:63], v[160:163]
buffer_load_dwordx4 v21, s[16:19], s52 offen offset:1024 sc1 lds
v_mfma_f32_16x16x32_bf16 v[124:127], a[44:47], a[80:83], v[124:127]
ds_read_b64_tr_b16 a[34:35], v25 offset:51232
v_mfma_f32_16x16x32_bf16 v[128:131], a[48:51], a[80:83], v[128:131]
ds_read_b64_tr_b16 a[36:37], v25 offset:51712
v_mfma_f32_16x16x32_bf16 v[132:135], a[52:55], a[80:83], v[132:135]
ds_read_b64_tr_b16 a[38:39], v25 offset:52224
v_mfma_f32_16x16x32_bf16 v[136:139], a[56:59], a[80:83], v[136:139]
buffer_load_dword v22, s[16:19], s52 offen offset:2048 sc1 lds
v_mfma_f32_16x16x32_bf16 v[140:143], a[44:47], a[84:87], v[140:143]
ds_read_b64_tr_b16 a[40:41], v25 offset:51744
s_add_u32 s52, s52, 0x20000
v_mfma_f32_16x16x32_bf16 v[144:147], a[48:51], a[84:87], v[144:147]
ds_read_b64_tr_b16 a[42:43], v25 offset:52256
v_mfma_f32_16x16x32_bf16 v[148:151], a[52:55], a[84:87], v[148:151]
s_add_u32 s15, s15, 1
v_mfma_f32_16x16x32_bf16 v[152:155], a[56:59], a[84:87], v[152:155]
s_cbranch_scc0 .Lk50
s_waitcnt vmcnt(19) lgkmcnt(6)
s_barrier
v_mfma_f32_16x16x32_bf16 v[60:63], a[20:23], a[0:3], v[60:63]
ds_read_b128 a[44:47], v23 offset:46080
s_add_u32 m0, s56, 104832
v_mfma_f32_16x16x32_bf16 v[64:67], a[20:23], a[4:7], v[64:67]
buffer_load_dwordx4 v18, s[20:23], s54 offen lds
v_mfma_f32_16x16x32_bf16 v[68:71], a[20:23], a[8:11], v[68:71]
ds_read_b128 a[48:51], v23 offset:47104
v_add_f32 v164, v164, v168
v_mfma_f32_16x16x32_bf16 v[72:75], a[20:23], a[12:15], v[72:75]
ds_read_b128 a[52:55], v23 offset:48384
v_mfma_f32_16x16x32_bf16 v[76:79], a[24:27], a[0:3], v[76:79]
ds_read_b128 a[56:59], v23 offset:49408
v_mfma_f32_16x16x32_bf16 v[80:83], a[24:27], a[4:7], v[80:83]
buffer_load_dwordx4 v19, s[20:23], s54 offen offset:1024 lds
v_mfma_f32_16x16x32_bf16 v[84:87], a[24:27], a[8:11], v[84:87]
ds_read_b64_tr_b16 a[64:65], v25 offset:62080
v_mfma_f32_16x16x32_bf16 v[88:91], a[24:27], a[12:15], v[88:91]
ds_read_b64_tr_b16 a[66:67], v25 offset:62592
v_add_f32 v165, v165, v169
v_mfma_f32_16x16x32_bf16 v[92:95], a[28:31], a[0:3], v[92:95]
ds_read_b64_tr_b16 a[68:69], v25 offset:62112
v_mfma_f32_16x16x32_bf16 v[96:99], a[28:31], a[4:7], v[96:99]
buffer_load_dwordx4 v20, s[20:23], s54 offen offset:2048 lds
v_mfma_f32_16x16x32_bf16 v[100:103], a[28:31], a[8:11], v[100:103]
s_add_u32 s54, s54, 196608
s_waitcnt lgkmcnt(7)
v_mfma_f32_16x16x32_bf16 v[104:107], a[28:31], a[12:15], v[104:107]
ds_read_b64_tr_b16 a[70:71], v25 offset:62624
v_mfma_f32_16x16x32_bf16 v[156:159], a[28:31], a[16:19], v[156:159]
ds_read_b128 a[60:63], v24 offset:48128
s_add_u32 m0, s55, 27648
v_mfma_f32_16x16x32_bf16 v[108:111], a[32:35], a[0:3], v[108:111]
buffer_load_dwordx4 v21, s[16:19], s52 offen sc1 lds
v_mfma_f32_16x16x32_bf16 v[112:115], a[32:35], a[4:7], v[112:115]
ds_read_b64_tr_b16 a[72:73], v25 offset:63104
v_add_f32 v166, v166, v170
v_mfma_f32_16x16x32_bf16 v[116:119], a[32:35], a[8:11], v[116:119]
ds_read_b64_tr_b16 a[74:75], v25 offset:63616
v_mfma_f32_16x16x32_bf16 v[120:123], a[32:35], a[12:15], v[120:123]
ds_read_b64_tr_b16 a[76:77], v25 offset:63136
v_mfma_f32_16x16x32_bf16 v[160:163], a[32:35], a[16:19], v[160:163]
buffer_load_dwordx4 v21, s[16:19], s52 offen offset:1024 sc1 lds
v_mfma_f32_16x16x32_bf16 v[124:127], a[0:3], a[36:39], v[124:127]
ds_read_b64_tr_b16 a[78:79], v25 offset:63648
v_mfma_f32_16x16x32_bf16 v[128:131], a[4:7], a[36:39], v[128:131]
ds_read_b64_tr_b16 a[80:81], v25 offset:64128
v_add_f32 v167, v167, v171
v_mfma_f32_16x16x32_bf16 v[132:135], a[8:11], a[36:39], v[132:135]
ds_read_b64_tr_b16 a[82:83], v25 offset:64640
v_mfma_f32_16x16x32_bf16 v[136:139], a[12:15], a[36:39], v[136:139]
buffer_load_dword v22, s[16:19], s52 offen offset:2048 sc1 lds
v_mfma_f32_16x16x32_bf16 v[140:143], a[0:3], a[40:43], v[140:143]
ds_read_b64_tr_b16 a[84:85], v25 offset:64160
s_add_u32 s52, s52, 0x20000
v_mfma_f32_16x16x32_bf16 v[144:147], a[4:7], a[40:43], v[144:147]
ds_read_b64_tr_b16 a[86:87], v25 offset:64672
v_mfma_f32_16x16x32_bf16 v[148:151], a[8:11], a[40:43], v[148:151]
v_mfma_f32_16x16x32_bf16 v[152:155], a[12:15], a[40:43], v[152:155]
s_waitcnt vmcnt(19) lgkmcnt(6)
s_barrier
v_mfma_f32_16x16x32_bf16 v[60:63], a[64:67], a[44:47], v[60:63]
ds_read_b128 a[0:3], v23
s_add_u32 m0, s56, 117248
v_mfma_f32_16x16x32_bf16 v[64:67], a[64:67], a[48:51], v[64:67]
buffer_load_dwordx4 v18, s[20:23], s54 offen lds
v_mfma_f32_16x16x32_bf16 v[68:71], a[64:67], a[52:55], v[68:71]
ds_read_b128 a[4:7], v23 offset:1024
v_mfma_f32_16x16x32_bf16 v[72:75], a[64:67], a[56:59], v[72:75]
ds_read_b128 a[8:11], v23 offset:2304
v_mfma_f32_16x16x32_bf16 v[76:79], a[68:71], a[44:47], v[76:79]
ds_read_b128 a[12:15], v23 offset:3328
v_mfma_f32_16x16x32_bf16 v[80:83], a[68:71], a[48:51], v[80:83]
buffer_load_dwordx4 v19, s[20:23], s54 offen offset:1024 lds
v_mfma_f32_16x16x32_bf16 v[84:87], a[68:71], a[52:55], v[84:87]
ds_read_b64_tr_b16 a[20:21], v25
v_mfma_f32_16x16x32_bf16 v[88:91], a[68:71], a[56:59], v[88:91]
ds_read_b64_tr_b16 a[22:23], v25 offset:512
v_mfma_f32_16x16x32_bf16 v[92:95], a[72:75], a[44:47], v[92:95]
ds_read_b64_tr_b16 a[24:25], v25 offset:32
v_mfma_f32_16x16x32_bf16 v[96:99], a[72:75], a[48:51], v[96:99]
buffer_load_dwordx4 v20, s[20:23], s54 offen offset:2048 lds
v_mfma_f32_16x16x32_bf16 v[100:103], a[72:75], a[52:55], v[100:103]
s_add_u32 s54, s54, 196608
s_waitcnt lgkmcnt(7)
v_mfma_f32_16x16x32_bf16 v[104:107], a[72:75], a[56:59], v[104:107]
ds_read_b64_tr_b16 a[26:27], v25 offset:544
v_mfma_f32_16x16x32_bf16 v[156:159], a[72:75], a[60:63], v[156:159]
ds_read_b128 a[16:19], v24 offset:2048
s_add_u32 m0, s55, 36864
v_mfma_f32_16x16x32_bf16 v[108:111], a[76:79], a[44:47], v[108:111]
buffer_load_dwordx4 v21, s[16:19], s52 offen sc1 lds
v_mfma_f32_16x16x32_bf16 v[112:115], a[76:79], a[48:51], v[112:115]
ds_read_b64_tr_b16 a[28:29], v25 offset:1024
v_mfma_f32_16x16x32_bf16 v[116:119], a[76:79], a[52:55], v[116:119]
ds_read_b64_tr_b16 a[30:31], v25 offset:1536
v_mfma_f32_16x16x32_bf16 v[120:123], a[76:79], a[56:59], v[120:123]
ds_read_b64_tr_b16 a[32:33], v25 offset:1056
v_mfma_f32_16x16x32_bf16 v[160:163], a[76:79], a[60:63], v[160:163]
buffer_load_dwordx4 v21, s[16:19], s52 offen offset:1024 sc1 lds
v_mfma_f32_16x16x32_bf16 v[124:127], a[44:47], a[80:83], v[124:127]
ds_read_b64_tr_b16 a[34:35], v25 offset:1568
v_mfma_f32_16x16x32_bf16 v[128:131], a[48:51], a[80:83], v[128:131]
ds_read_b64_tr_b16 a[36:37], v25 offset:2048
v_mfma_f32_16x16x32_bf16 v[132:135], a[52:55], a[80:83], v[132:135]
ds_read_b64_tr_b16 a[38:39], v25 offset:2560
v_mfma_f32_16x16x32_bf16 v[136:139], a[56:59], a[80:83], v[136:139]
buffer_load_dword v22, s[16:19], s52 offen offset:2048 sc1 lds
v_mfma_f32_16x16x32_bf16 v[140:143], a[44:47], a[84:87], v[140:143]
ds_read_b64_tr_b16 a[40:41], v25 offset:2080
s_add_u32 s52, s52, 0x20000
v_mfma_f32_16x16x32_bf16 v[144:147], a[48:51], a[84:87], v[144:147]
ds_read_b64_tr_b16 a[42:43], v25 offset:2592
v_mfma_f32_16x16x32_bf16 v[148:151], a[52:55], a[84:87], v[148:151]
v_mfma_f32_16x16x32_bf16 v[152:155], a[56:59], a[84:87], v[152:155]
s_waitcnt vmcnt(19) lgkmcnt(6)
s_barrier
v_mfma_f32_16x16x32_bf16 v[60:63], a[20:23], a[0:3], v[60:63]
ds_read_b128 a[44:47], v23 offset:9216
s_add_u32 m0, s56, 129664
v_mfma_f32_16x16x32_bf16 v[64:67], a[20:23], a[4:7], v[64:67]
buffer_load_dwordx4 v18, s[20:23], s54 offen lds
v_mfma_f32_16x16x32_bf16 v[68:71], a[20:23], a[8:11], v[68:71]
ds_read_b128 a[48:51], v23 offset:10240
s_waitcnt vmcnt(19)
v_add_f32 v164, v164, v172
v_mfma_f32_16x16x32_bf16 v[72:75], a[20:23], a[12:15], v[72:75]
ds_read_b128 a[52:55], v23 offset:11520
v_mfma_f32_16x16x32_bf16 v[76:79], a[24:27], a[0:3], v[76:79]
ds_read_b128 a[56:59], v23 offset:12544
v_mfma_f32_16x16x32_bf16 v[80:83], a[24:27], a[4:7], v[80:83]
buffer_load_dwordx4 v19, s[20:23], s54 offen offset:1024 lds
v_mfma_f32_16x16x32_bf16 v[84:87], a[24:27], a[8:11], v[84:87]
ds_read_b64_tr_b16 a[64:65], v25 offset:12416
v_mfma_f32_16x16x32_bf16 v[88:91], a[24:27], a[12:15], v[88:91]
ds_read_b64_tr_b16 a[66:67], v25 offset:12928
v_add_f32 v165, v165, v173
v_mfma_f32_16x16x32_bf16 v[92:95], a[28:31], a[0:3], v[92:95]
ds_read_b64_tr_b16 a[68:69], v25 offset:12448
v_mfma_f32_16x16x32_bf16 v[96:99], a[28:31], a[4:7], v[96:99]
buffer_load_dwordx4 v20, s[20:23], s54 offen offset:2048 lds
v_mfma_f32_16x16x32_bf16 v[100:103], a[28:31], a[8:11], v[100:103]
s_add_u32 s54, s54, 196608
s_waitcnt lgkmcnt(7)
v_mfma_f32_16x16x32_bf16 v[104:107], a[28:31], a[12:15], v[104:107]
ds_read_b64_tr_b16 a[70:71], v25 offset:12960
v_mfma_f32_16x16x32_bf16 v[156:159], a[28:31], a[16:19], v[156:159]
ds_read_b128 a[60:63], v24 offset:11264
s_add_u32 m0, s55, 46080
v_mfma_f32_16x16x32_bf16 v[108:111], a[32:35], a[0:3], v[108:111]
buffer_load_dwordx4 v21, s[16:19], s52 offen sc1 lds
v_mfma_f32_16x16x32_bf16 v[112:115], a[32:35], a[4:7], v[112:115]
ds_read_b64_tr_b16 a[72:73], v25 offset:13440
v_add_f32 v166, v166, v174
v_mfma_f32_16x16x32_bf16 v[116:119], a[32:35], a[8:11], v[116:119]
ds_read_b64_tr_b16 a[74:75], v25 offset:13952
v_mfma_f32_16x16x32_bf16 v[120:123], a[32:35], a[12:15], v[120:123]
ds_read_b64_tr_b16 a[76:77], v25 offset:13472
v_mfma_f32_16x16x32_bf16 v[160:163], a[32:35], a[16:19], v[160:163]
buffer_load_dwordx4 v21, s[16:19], s52 offen offset:1024 sc1 lds
v_mfma_f32_16x16x32_bf16 v[124:127], a[0:3], a[36:39], v[124:127]
ds_read_b64_tr_b16 a[78:79], v25 offset:13984
v_mfma_f32_16x16x32_bf16 v[128:131], a[4:7], a[36:39], v[128:131]
ds_read_b64_tr_b16 a[80:81], v25 offset:14464
v_add_f32 v167, v167, v175
v_mfma_f32_16x16x32_bf16 v[132:135], a[8:11], a[36:39], v[132:135]
ds_read_b64_tr_b16 a[82:83], v25 offset:14976
v_mfma_f32_16x16x32_bf16 v[136:139], a[12:15], a[36:39], v[136:139]
buffer_load_dword v22, s[16:19], s52 offen offset:2048 sc1 lds
v_mfma_f32_16x16x32_bf16 v[140:143], a[0:3], a[40:43], v[140:143]
ds_read_b64_tr_b16 a[84:85], v25 offset:14496
s_add_u32 s52, s52, 0x20000
v_mfma_f32_16x16x32_bf16 v[144:147], a[4:7], a[40:43], v[144:147]
ds_read_b64_tr_b16 a[86:87], v25 offset:15008
v_mfma_f32_16x16x32_bf16 v[148:151], a[8:11], a[40:43], v[148:151]
v_mfma_f32_16x16x32_bf16 v[152:155], a[12:15], a[40:43], v[152:155]
s_waitcnt vmcnt(18) lgkmcnt(6)
s_barrier
v_mfma_f32_16x16x32_bf16 v[60:63], a[64:67], a[44:47], v[60:63]
ds_read_b128 a[0:3], v23 offset:18432
s_add_u32 m0, s59, 0
s_mov_b32 s58, 1048576
v_mfma_f32_16x16x32_bf16 v[64:67], a[64:67], a[48:51], v[64:67]
buffer_load_dwordx4 v5, s[24:27], s58 offen lds
v_mfma_f32_16x16x32_bf16 v[68:71], a[64:67], a[52:55], v[68:71]
ds_read_b128 a[4:7], v23 offset:19456
v_permlane32_swap_b32 v164, v166
v_mfma_f32_16x16x32_bf16 v[72:75], a[64:67], a[56:59], v[72:75]
ds_read_b128 a[8:11], v23 offset:20736
v_mfma_f32_16x16x32_bf16 v[76:79], a[68:71], a[44:47], v[76:79]
ds_read_b128 a[12:15], v23 offset:21760
v_permlane32_swap_b32 v165, v167
v_mfma_f32_16x16x32_bf16 v[80:83], a[68:71], a[48:51], v[80:83]
buffer_load_dwordx4 v6, s[24:27], s58 offen offset:1024 lds
v_mfma_f32_16x16x32_bf16 v[84:87], a[68:71], a[52:55], v[84:87]
ds_read_b64_tr_b16 a[20:21], v25 offset:24832
v_mfma_f32_16x16x32_bf16 v[88:91], a[68:71], a[56:59], v[88:91]
ds_read_b64_tr_b16 a[22:23], v25 offset:25344
v_add_f32 v164, v164, v166
v_mfma_f32_16x16x32_bf16 v[92:95], a[72:75], a[44:47], v[92:95]
s_add_u32 m0, s59, 58240
s_mov_b32 s58, 1966080
v_mfma_f32_16x16x32_bf16 v[96:99], a[72:75], a[48:51], v[96:99]
buffer_load_dwordx4 v5, s[24:27], s58 offen lds
v_mfma_f32_16x16x32_bf16 v[100:103], a[72:75], a[52:55], v[100:103]
ds_read_b64_tr_b16 a[24:25], v25 offset:24864
s_waitcnt lgkmcnt(7)
v_mfma_f32_16x16x32_bf16 v[104:107], a[72:75], a[56:59], v[104:107]
ds_read_b64_tr_b16 a[26:27], v25 offset:25376
v_add_f32 v165, v165, v167
v_mfma_f32_16x16x32_bf16 v[156:159], a[72:75], a[60:63], v[156:159]
ds_read_b128 a[16:19], v24 offset:20480
v_mfma_f32_16x16x32_bf16 v[108:111], a[76:79], a[44:47], v[108:111]
buffer_load_dwordx4 v6, s[24:27], s58 offen offset:1024 lds
v_mfma_f32_16x16x32_bf16 v[112:115], a[76:79], a[48:51], v[112:115]
ds_read_b64_tr_b16 a[28:29], v25 offset:25856
v_mul_f32 v164, 0xba800000, v164
v_mfma_f32_16x16x32_bf16 v[116:119], a[76:79], a[52:55], v[116:119]
ds_read_b64_tr_b16 a[30:31], v25 offset:26368
v_mfma_f32_16x16x32_bf16 v[120:123], a[76:79], a[56:59], v[120:123]
s_add_u32 m0, s59, 66560
s_mov_b32 s58, 0
v_mul_f32 v165, 0x3a800000, v165
v_mfma_f32_16x16x32_bf16 v[160:163], a[76:79], a[60:63], v[160:163]
buffer_load_dwordx4 v5, s[24:27], s58 offen lds
v_mfma_f32_16x16x32_bf16 v[124:127], a[44:47], a[80:83], v[124:127]
ds_read_b64_tr_b16 a[32:33], v25 offset:25888
v_mfma_f32_16x16x32_bf16 v[128:131], a[48:51], a[80:83], v[128:131]
ds_read_b64_tr_b16 a[34:35], v25 offset:26400
v_fma_f32 v165, -v164, v164, v165
v_mfma_f32_16x16x32_bf16 v[132:135], a[52:55], a[80:83], v[132:135]
ds_read_b64_tr_b16 a[36:37], v25 offset:26880
v_mfma_f32_16x16x32_bf16 v[136:139], a[56:59], a[80:83], v[136:139]
buffer_load_dwordx4 v6, s[24:27], s58 offen offset:1024 lds
v_mfma_f32_16x16x32_bf16 v[140:143], a[44:47], a[84:87], v[140:143]
ds_read_b64_tr_b16 a[38:39], v25 offset:27392
v_max_f32 v165, 0, v165
v_mfma_f32_16x16x32_bf16 v[144:147], a[48:51], a[84:87], v[144:147]
ds_read_b64_tr_b16 a[40:41], v25 offset:26912
v_mfma_f32_16x16x32_bf16 v[148:151], a[52:55], a[84:87], v[148:151]
ds_read_b64_tr_b16 a[42:43], v25 offset:27424
v_mfma_f32_16x16x32_bf16 v[152:155], a[56:59], a[84:87], v[152:155]
s_waitcnt vmcnt(18) lgkmcnt(6)
s_barrier
v_mfma_f32_16x16x32_bf16 v[60:63], a[20:23], a[0:3], v[60:63]
ds_read_b128 a[44:47], v23 offset:27648
s_add_u32 m0, s59, 8320
s_mov_b32 s58, 1179648
v_mfma_f32_16x16x32_bf16 v[64:67], a[20:23], a[4:7], v[64:67]
buffer_load_dwordx4 v5, s[24:27], s58 offen lds
v_mfma_f32_16x16x32_bf16 v[68:71], a[20:23], a[8:11], v[68:71]
ds_read_b128 a[48:51], v23 offset:28672
v_add_f32 v165, 0x3727c5ac, v165
v_mfma_f32_16x16x32_bf16 v[72:75], a[20:23], a[12:15], v[72:75]
ds_read_b128 a[52:55], v23 offset:29952
v_mfma_f32_16x16x32_bf16 v[76:79], a[24:27], a[0:3], v[76:79]
ds_read_b128 a[56:59], v23 offset:30976
v_mfma_f32_16x16x32_bf16 v[80:83], a[24:27], a[4:7], v[80:83]
buffer_load_dwordx4 v6, s[24:27], s58 offen offset:1024 lds
v_mfma_f32_16x16x32_bf16 v[84:87], a[24:27], a[8:11], v[84:87]
ds_read_b64_tr_b16 a[64:65], v25 offset:37248
v_mfma_f32_16x16x32_bf16 v[88:91], a[24:27], a[12:15], v[88:91]
ds_read_b64_tr_b16 a[66:67], v25 offset:37760
v_rsq_f32 v166, v165
v_mfma_f32_16x16x32_bf16 v[92:95], a[28:31], a[0:3], v[92:95]
s_add_u32 m0, s59, 74880
s_mov_b32 s58, 131072
v_mfma_f32_16x16x32_bf16 v[96:99], a[28:31], a[4:7], v[96:99]
buffer_load_dwordx4 v5, s[24:27], s58 offen lds
v_mfma_f32_16x16x32_bf16 v[100:103], a[28:31], a[8:11], v[100:103]
ds_read_b64_tr_b16 a[68:69], v25 offset:37280
s_waitcnt lgkmcnt(7)
v_mfma_f32_16x16x32_bf16 v[104:107], a[28:31], a[12:15], v[104:107]
ds_read_b64_tr_b16 a[70:71], v25 offset:37792
v_mfma_f32_16x16x32_bf16 v[156:159], a[28:31], a[16:19], v[156:159]
ds_read_b128 a[60:63], v24 offset:29696
v_mfma_f32_16x16x32_bf16 v[108:111], a[32:35], a[0:3], v[108:111]
buffer_load_dwordx4 v6, s[24:27], s58 offen offset:1024 lds
.Lpad20:
s_cbranch_execz .Lpad23
v_mfma_f32_16x16x32_bf16 v[112:115], a[32:35], a[4:7], v[112:115]
ds_read_b64_tr_b16 a[72:73], v25 offset:38272
v_mov_b32 v165, v166
v_mfma_f32_16x16x32_bf16 v[116:119], a[32:35], a[8:11], v[116:119]
ds_read_b64_tr_b16 a[74:75], v25 offset:38784
v_mfma_f32_16x16x32_bf16 v[120:123], a[32:35], a[12:15], v[120:123]
s_add_u32 m0, s59, 83200
s_mov_b32 s58, 262144
v_mfma_f32_16x16x32_bf16 v[160:163], a[32:35], a[16:19], v[160:163]
buffer_load_dwordx4 v5, s[24:27], s58 offen lds
v_mfma_f32_16x16x32_bf16 v[124:127], a[0:3], a[36:39], v[124:127]
ds_read_b64_tr_b16 a[76:77], v25 offset:38304
v_mfma_f32_16x16x32_bf16 v[128:131], a[4:7], a[36:39], v[128:131]
ds_read_b64_tr_b16 a[78:79], v25 offset:38816
v_mul_f32 v166, 0x3e8293ee, v166
v_mfma_f32_16x16x32_bf16 v[132:135], a[8:11], a[36:39], v[132:135]
ds_read_b64_tr_b16 a[80:81], v25 offset:39296
v_mfma_f32_16x16x32_bf16 v[136:139], a[12:15], a[36:39], v[136:139]
buffer_load_dwordx4 v6, s[24:27], s58 offen offset:1024 lds
v_mfma_f32_16x16x32_bf16 v[140:143], a[0:3], a[40:43], v[140:143]
ds_read_b64_tr_b16 a[82:83], v25 offset:39808
v_mfma_f32_16x16x32_bf16 v[144:147], a[4:7], a[40:43], v[144:147]
ds_read_b64_tr_b16 a[84:85], v25 offset:39328
v_mfma_f32_16x16x32_bf16 v[148:151], a[8:11], a[40:43], v[148:151]
ds_read_b64_tr_b16 a[86:87], v25 offset:39840
v_mfma_f32_16x16x32_bf16 v[152:155], a[12:15], a[40:43], v[152:155]
s_waitcnt vmcnt(18) lgkmcnt(6)
s_barrier
v_mfma_f32_16x16x32_bf16 v[60:63], a[64:67], a[44:47], v[60:63]
s_add_u32 m0, s59, 16640
s_mov_b32 s58, 1310720
ds_write_b128 v7, v[164:167]
v_mfma_f32_16x16x32_bf16 v[64:67], a[64:67], a[48:51], v[64:67]
buffer_load_dwordx4 v5, s[24:27], s58 offen lds
v_mfma_f32_16x16x32_bf16 v[68:71], a[64:67], a[52:55], v[68:71]
ds_read_b128 a[0:3], v23 offset:36864
v_mfma_f32_16x16x32_bf16 v[72:75], a[64:67], a[56:59], v[72:75]
ds_read_b128 a[4:7], v23 offset:37888
v_mfma_f32_16x16x32_bf16 v[76:79], a[68:71], a[44:47], v[76:79]
ds_read_b128 a[8:11], v23 offset:39168
v_mfma_f32_16x16x32_bf16 v[80:83], a[68:71], a[48:51], v[80:83]
ds_read_b128 a[12:15], v23 offset:40192
v_mfma_f32_16x16x32_bf16 v[84:87], a[68:71], a[52:55], v[84:87]
ds_read_b64_tr_b16 a[20:21], v25 offset:49664
v_mfma_f32_16x16x32_bf16 v[88:91], a[68:71], a[56:59], v[88:91]
buffer_load_dwordx4 v6, s[24:27], s58 offen offset:1024 lds
v_mfma_f32_16x16x32_bf16 v[92:95], a[72:75], a[44:47], v[92:95]
ds_read_b64_tr_b16 a[22:23], v25 offset:50176
v_mfma_f32_16x16x32_bf16 v[96:99], a[72:75], a[48:51], v[96:99]
ds_read_b64_tr_b16 a[24:25], v25 offset:49696
ds_write_b32 v17, v164
v_mfma_f32_16x16x32_bf16 v[100:103], a[72:75], a[52:55], v[100:103]
ds_read_b64_tr_b16 a[26:27], v25 offset:50208
s_waitcnt lgkmcnt(10)
v_mfma_f32_16x16x32_bf16 v[104:107], a[72:75], a[56:59], v[104:107]
ds_read_b128 a[16:19], v24 offset:38912
v_mfma_f32_16x16x32_bf16 v[156:159], a[72:75], a[60:63], v[156:159]
s_add_u32 m0, s59, 91520
s_mov_b32 s58, 393216
v_mfma_f32_16x16x32_bf16 v[108:111], a[76:79], a[44:47], v[108:111]
buffer_load_dwordx4 v5, s[24:27], s58 offen lds
v_mfma_f32_16x16x32_bf16 v[112:115], a[76:79], a[48:51], v[112:115]
v_mfma_f32_16x16x32_bf16 v[116:119], a[76:79], a[52:55], v[116:119]
ds_read_b64_tr_b16 a[28:29], v25 offset:50688
v_mfma_f32_16x16x32_bf16 v[120:123], a[76:79], a[56:59], v[120:123]
ds_read_b64_tr_b16 a[30:31], v25 offset:51200
v_mfma_f32_16x16x32_bf16 v[160:163], a[76:79], a[60:63], v[160:163]
ds_read_b64_tr_b16 a[32:33], v25 offset:50720
ds_write_b32 v17, v165 offset:1024
v_mfma_f32_16x16x32_bf16 v[124:127], a[44:47], a[80:83], v[124:127]
ds_read_b64_tr_b16 a[34:35], v25 offset:51232
v_mfma_f32_16x16x32_bf16 v[128:131], a[48:51], a[80:83], v[128:131]
buffer_load_dwordx4 v6, s[24:27], s58 offen offset:1024 lds
v_mfma_f32_16x16x32_bf16 v[132:135], a[52:55], a[80:83], v[132:135]
ds_read_b64_tr_b16 a[36:37], v25 offset:51712
v_mfma_f32_16x16x32_bf16 v[136:139], a[56:59], a[80:83], v[136:139]
ds_read_b64_tr_b16 a[38:39], v25 offset:52224
v_mfma_f32_16x16x32_bf16 v[140:143], a[44:47], a[84:87], v[140:143]
ds_read_b64_tr_b16 a[40:41], v25 offset:51744
v_mfma_f32_16x16x32_bf16 v[144:147], a[48:51], a[84:87], v[144:147]
ds_read_b64_tr_b16 a[42:43], v25 offset:52256
v_mfma_f32_16x16x32_bf16 v[148:151], a[52:55], a[84:87], v[148:151]
v_mfma_f32_16x16x32_bf16 v[152:155], a[56:59], a[84:87], v[152:155]
s_waitcnt vmcnt(16) lgkmcnt(7)
s_barrier
v_mfma_f32_16x16x32_bf16 v[60:63], a[20:23], a[0:3], v[60:63]
ds_read_b128 a[44:47], v23 offset:46080
s_add_u32 m0, s59, 24960
s_mov_b32 s58, 1441792
v_mfma_f32_16x16x32_bf16 v[64:67], a[20:23], a[4:7], v[64:67]
buffer_load_dwordx4 v5, s[24:27], s58 offen lds
v_mfma_f32_16x16x32_bf16 v[68:71], a[20:23], a[8:11], v[68:71]
ds_read_b128 a[48:51], v23 offset:47104
v_mfma_f32_16x16x32_bf16 v[72:75], a[20:23], a[12:15], v[72:75]
ds_read_b128 a[52:55], v23 offset:48384
v_mfma_f32_16x16x32_bf16 v[76:79], a[24:27], a[0:3], v[76:79]
ds_read_b128 a[56:59], v23 offset:49408
v_mfma_f32_16x16x32_bf16 v[80:83], a[24:27], a[4:7], v[80:83]
buffer_load_dwordx4 v6, s[24:27], s58 offen offset:1024 lds
v_mfma_f32_16x16x32_bf16 v[84:87], a[24:27], a[8:11], v[84:87]
ds_read_b64_tr_b16 a[64:65], v25 offset:62080
v_mfma_f32_16x16x32_bf16 v[88:91], a[24:27], a[12:15], v[88:91]
ds_read_b64_tr_b16 a[66:67], v25 offset:62592
v_mfma_f32_16x16x32_bf16 v[92:95], a[28:31], a[0:3], v[92:95]
s_add_u32 m0, s59, 99840
s_mov_b32 s58, 524288
v_mfma_f32_16x16x32_bf16 v[96:99], a[28:31], a[4:7], v[96:99]
buffer_load_dwordx4 v5, s[24:27], s58 offen lds
v_mfma_f32_16x16x32_bf16 v[100:103], a[28:31], a[8:11], v[100:103]
ds_read_b64_tr_b16 a[68:69], v25 offset:62112
s_waitcnt lgkmcnt(7)
v_mfma_f32_16x16x32_bf16 v[104:107], a[28:31], a[12:15], v[104:107]
ds_read_b64_tr_b16 a[70:71], v25 offset:62624
v_mfma_f32_16x16x32_bf16 v[156:159], a[28:31], a[16:19], v[156:159]
ds_read_b128 a[60:63], v24 offset:48128
v_mfma_f32_16x16x32_bf16 v[108:111], a[32:35], a[0:3], v[108:111]
buffer_load_dwordx4 v6, s[24:27], s58 offen offset:1024 lds
v_mfma_f32_16x16x32_bf16 v[112:115], a[32:35], a[4:7], v[112:115]
ds_read_b64_tr_b16 a[72:73], v25 offset:63104
v_mfma_f32_16x16x32_bf16 v[116:119], a[32:35], a[8:11], v[116:119]
ds_read_b64_tr_b16 a[74:75], v25 offset:63616
v_mfma_f32_16x16x32_bf16 v[120:123], a[32:35], a[12:15], v[120:123]
s_add_u32 m0, s59, 108160
s_mov_b32 s58, 655360
v_mfma_f32_16x16x32_bf16 v[160:163], a[32:35], a[16:19], v[160:163]
buffer_load_dwordx4 v5, s[24:27], s58 offen lds
v_mfma_f32_16x16x32_bf16 v[124:127], a[0:3], a[36:39], v[124:127]
ds_read_b64_tr_b16 a[76:77], v25 offset:63136
v_mfma_f32_16x16x32_bf16 v[128:131], a[4:7], a[36:39], v[128:131]
ds_read_b64_tr_b16 a[78:79], v25 offset:63648
v_mfma_f32_16x16x32_bf16 v[132:135], a[8:11], a[36:39], v[132:135]
ds_read_b64_tr_b16 a[80:81], v25 offset:64128
v_mfma_f32_16x16x32_bf16 v[136:139], a[12:15], a[36:39], v[136:139]
buffer_load_dwordx4 v6, s[24:27], s58 offen offset:1024 lds
v_mfma_f32_16x16x32_bf16 v[140:143], a[0:3], a[40:43], v[140:143]
ds_read_b64_tr_b16 a[82:83], v25 offset:64640
v_mfma_f32_16x16x32_bf16 v[144:147], a[4:7], a[40:43], v[144:147]
ds_read_b64_tr_b16 a[84:85], v25 offset:64160
v_mfma_f32_16x16x32_bf16 v[148:151], a[8:11], a[40:43], v[148:151]
ds_read_b64_tr_b16 a[86:87], v25 offset:64672
v_mfma_f32_16x16x32_bf16 v[152:155], a[12:15], a[40:43], v[152:155]
s_waitcnt lgkmcnt(0)
s_barrier
v_mfma_f32_16x16x32_bf16 v[156:159], a[72:75], a[60:63], v[156:159]
ds_read_b128 v[232:235], v10 offset:768
s_add_u32 m0, s59, 33280
v_mfma_f32_16x16x32_bf16 v[160:163], a[76:79], a[60:63], v[160:163]
ds_read_b128 v[236:239], v10 offset:2816
s_mov_b32 s58, 1572864
v_mfma_f32_16x16x32_bf16 v[104:107], a[72:75], a[56:59], v[104:107]
ds_read_b128 v[228:231], v10 offset:512
v_mfma_f32_16x16x32_bf16 v[120:123], a[76:79], a[56:59], v[120:123]
ds_read_b128 v[224:227], v10 offset:256
v_mfma_f32_16x16x32_bf16 v[136:139], a[56:59], a[80:83], v[136:139]
ds_read_b128 v[220:223], v10
v_mfma_f32_16x16x32_bf16 v[152:155], a[56:59], a[84:87], v[152:155]
ds_read_b128 v[240:243], v11 offset:192
v_mfma_f32_16x16x32_bf16 v[100:103], a[72:75], a[52:55], v[100:103]
ds_read_b128 v[244:247], v11 offset:1216
v_mfma_f32_16x16x32_bf16 v[116:119], a[76:79], a[52:55], v[116:119]
buffer_load_dwordx4 v5, s[24:27], s58 offen lds
v_mfma_f32_16x16x32_bf16 v[96:99], a[72:75], a[48:51], v[96:99]
ds_read_b128 v[18:21], v11 offset:128
ds_read_b128 v[22:25], v11 offset:1152
s_waitcnt lgkmcnt(8)
v_pk_fma_f32 v[104:105], v[36:37], v[232:233], v[104:105] op_sel_hi:[1,0,1]
v_pk_mul_f32 v[104:105], v[104:105], v[232:233] op_sel:[0,1] op_sel_hi:[1,1]
v_pk_fma_f32 v[106:107], v[38:39], v[232:233], v[106:107] op_sel_hi:[1,0,1]
v_pk_mul_f32 v[106:107], v[106:107], v[232:233] op_sel:[0,1] op_sel_hi:[1,1]
v_pk_fma_f32 v[120:121], v[40:41], v[232:233], v[120:121] op_sel_hi:[1,0,1]
v_pk_mul_f32 v[120:121], v[120:121], v[232:233] op_sel:[0,1] op_sel_hi:[1,1]
v_pk_fma_f32 v[122:123], v[42:43], v[232:233], v[122:123] op_sel_hi:[1,0,1]
v_pk_mul_f32 v[122:123], v[122:123], v[232:233] op_sel:[0,1] op_sel_hi:[1,1]
s_waitcnt lgkmcnt(6)
v_pk_fma_f32 v[100:101], v[36:37], v[228:229], v[100:101] op_sel_hi:[1,0,1]
v_pk_mul_f32 v[100:101], v[100:101], v[228:229] op_sel:[0,1] op_sel_hi:[1,1]
v_pk_fma_f32 v[102:103], v[38:39], v[228:229], v[102:103] op_sel_hi:[1,0,1]
v_pk_mul_f32 v[102:103], v[102:103], v[228:229] op_sel:[0,1] op_sel_hi:[1,1]
v_pk_fma_f32 v[116:117], v[40:41], v[228:229], v[116:117] op_sel_hi:[1,0,1]
v_pk_mul_f32 v[116:117], v[116:117], v[228:229] op_sel:[0,1] op_sel_hi:[1,1]
s_waitcnt lgkmcnt(3)
v_pk_fma_f32 v[136:137], v[240:241], v[44:45], v[136:137] op_sel_hi:[1,0,1]
v_pk_fma_f32 v[138:139], v[242:243], v[44:45], v[138:139] op_sel_hi:[1,0,1]
v_pk_fma_f32 v[152:153], v[240:241], v[44:45], v[152:153] op_sel:[0,1,0] op_sel_hi:[1,1,1]
v_pk_fma_f32 v[154:155], v[242:243], v[44:45], v[154:155] op_sel:[0,1,0] op_sel_hi:[1,1,1]
s_waitcnt lgkmcnt(2)
v_pk_mul_f32 v[136:137], v[136:137], v[244:245]
v_pk_mul_f32 v[138:139], v[138:139], v[246:247]
v_pk_mul_f32 v[152:153], v[152:153], v[244:245]
v_pk_mul_f32 v[154:155], v[154:155], v[246:247]
v_pk_fma_f32 v[118:119], v[42:43], v[228:229], v[118:119] op_sel_hi:[1,0,1]
v_pk_mul_f32 v[118:119], v[118:119], v[228:229] op_sel:[0,1] op_sel_hi:[1,1]
v_pk_fma_f32 v[96:97], v[36:37], v[224:225], v[96:97] op_sel_hi:[1,0,1]
v_pk_mul_f32 v[96:97], v[96:97], v[224:225] op_sel:[0,1] op_sel_hi:[1,1]
v_pk_fma_f32 v[98:99], v[38:39], v[224:225], v[98:99] op_sel_hi:[1,0,1]
v_pk_mul_f32 v[98:99], v[98:99], v[224:225] op_sel:[0,1] op_sel_hi:[1,1]
v_pk_fma_f32 v[156:157], v[36:37], v[236:237], v[156:157] op_sel_hi:[1,0,1]
v_pk_mul_f32 v[156:157], v[156:157], v[236:237] op_sel:[0,1] op_sel_hi:[1,1]
v_pk_fma_f32 v[158:159], v[38:39], v[236:237], v[158:159] op_sel_hi:[1,0,1]
v_pk_mul_f32 v[158:159], v[158:159], v[236:237] op_sel:[0,1] op_sel_hi:[1,1]
v_pk_fma_f32 v[160:161], v[40:41], v[236:237], v[160:161] op_sel_hi:[1,0,1]
v_pk_mul_f32 v[160:161], v[160:161], v[236:237] op_sel:[0,1] op_sel_hi:[1,1]
v_pk_fma_f32 v[162:163], v[42:43], v[236:237], v[162:163] op_sel_hi:[1,0,1]
v_pk_mul_f32 v[162:163], v[162:163], v[236:237] op_sel:[0,1] op_sel_hi:[1,1]
v_cvt_pk_bf16_f32 v196, v104, v105
v_cvt_pk_bf16_f32 v197, v106, v107
v_mfma_f32_16x16x32_bf16 v[112:115], a[76:79], a[48:51], v[112:115]
buffer_load_dwordx4 v6, s[24:27], s58 offen offset:1024 lds
v_mfma_f32_16x16x32_bf16 v[92:95], a[72:75], a[44:47], v[92:95]
s_add_u32 m0, s59, 41600
v_cvt_pk_bf16_f32 v198, v120, v121
v_cvt_pk_bf16_f32 v199, v122, v123
v_mfma_f32_16x16x32_bf16 v[108:111], a[76:79], a[44:47], v[108:111]
ds_write_b128 v8, v[196:199]
v_cvt_pk_bf16_f32 v208, v136, v137
v_mfma_f32_16x16x32_bf16 v[72:75], a[64:67], a[56:59], v[72:75]
s_mov_b32 s58, 1703936
v_cvt_pk_bf16_f32 v209, v138, v139
v_cvt_pk_bf16_f32 v218, v152, v153
v_mfma_f32_16x16x32_bf16 v[88:91], a[68:71], a[56:59], v[88:91]
ds_write_b64 v8, v[208:209] offset:1024
v_cvt_pk_bf16_f32 v219, v154, v155
ds_write_b64 v8, v[218:219] offset:1032
v_cvt_pk_bf16_f32 v192, v100, v101
v_pk_fma_f32 v[72:73], v[28:29], v[232:233], v[72:73] op_sel_hi:[1,0,1]
v_pk_fma_f32 v[74:75], v[30:31], v[232:233], v[74:75] op_sel_hi:[1,0,1]
s_nop 1
v_pk_fma_f32 v[88:89], v[32:33], v[232:233], v[88:89] op_sel_hi:[1,0,1]
v_pk_fma_f32 v[90:91], v[34:35], v[232:233], v[90:91] op_sel_hi:[1,0,1]
v_pk_fma_f32 v[112:113], v[40:41], v[224:225], v[112:113] op_sel_hi:[1,0,1]
v_pk_mul_f32 v[112:113], v[112:113], v[224:225] op_sel:[0,1] op_sel_hi:[1,1]
v_pk_fma_f32 v[114:115], v[42:43], v[224:225], v[114:115] op_sel_hi:[1,0,1]
v_pk_mul_f32 v[114:115], v[114:115], v[224:225] op_sel:[0,1] op_sel_hi:[1,1]
v_pk_fma_f32 v[92:93], v[36:37], v[220:221], v[92:93] op_sel_hi:[1,0,1]
v_pk_mul_f32 v[92:93], v[92:93], v[220:221] op_sel:[0,1] op_sel_hi:[1,1]
v_pk_fma_f32 v[94:95], v[38:39], v[220:221], v[94:95] op_sel_hi:[1,0,1]
v_pk_mul_f32 v[94:95], v[94:95], v[220:221] op_sel:[0,1] op_sel_hi:[1,1]
v_pk_fma_f32 v[108:109], v[40:41], v[220:221], v[108:109] op_sel_hi:[1,0,1]
v_pk_mul_f32 v[108:109], v[108:109], v[220:221] op_sel:[0,1] op_sel_hi:[1,1]
v_pk_fma_f32 v[110:111], v[42:43], v[220:221], v[110:111] op_sel_hi:[1,0,1]
v_pk_mul_f32 v[110:111], v[110:111], v[220:221] op_sel:[0,1] op_sel_hi:[1,1]
v_cvt_pk_bf16_f32 v193, v102, v103
v_cvt_pk_bf16_f32 v194, v116, v117
v_mfma_f32_16x16x32_bf16 v[132:135], a[52:55], a[80:83], v[132:135]
buffer_load_dwordx4 v5, s[24:27], s58 offen lds
v_mfma_f32_16x16x32_bf16 v[148:151], a[52:55], a[84:87], v[148:151]
ds_read_b128 v[240:243], v11 offset:64
v_cvt_pk_bf16_f32 v195, v118, v119
v_mfma_f32_16x16x32_bf16 v[68:71], a[64:67], a[52:55], v[68:71]
ds_read_b128 v[244:247], v11 offset:1088
s_waitcnt lgkmcnt(2)
s_barrier
v_mfma_f32_16x16x32_bf16 v[84:87], a[68:71], a[52:55], v[84:87]
ds_read_b64 v[200:201], v9 offset:1024
v_cvt_pk_bf16_f32 v176, v72, v73
v_mfma_f32_16x16x32_bf16 v[128:131], a[48:51], a[80:83], v[128:131]
ds_read_b64 v[210:211], v9 offset:1032
buffer_load_dwordx4 v6, s[24:27], s58 offen offset:1024 lds
s_add_u32 m0, s59, 49920
v_pk_fma_f32 v[132:133], v[18:19], v[44:45], v[132:133] op_sel_hi:[1,0,1]
v_pk_mul_f32 v[132:133], v[132:133], v[22:23]
v_pk_fma_f32 v[134:135], v[20:21], v[44:45], v[134:135] op_sel_hi:[1,0,1]
v_pk_mul_f32 v[134:135], v[134:135], v[24:25]
v_pk_fma_f32 v[148:149], v[18:19], v[44:45], v[148:149] op_sel:[0,1,0] op_sel_hi:[1,1,1]
v_pk_mul_f32 v[148:149], v[148:149], v[22:23]
v_pk_fma_f32 v[150:151], v[20:21], v[44:45], v[150:151] op_sel:[0,1,0] op_sel_hi:[1,1,1]
v_pk_mul_f32 v[150:151], v[150:151], v[24:25]
v_pk_fma_f32 v[68:69], v[28:29], v[228:229], v[68:69] op_sel_hi:[1,0,1]
v_pk_fma_f32 v[70:71], v[30:31], v[228:229], v[70:71] op_sel_hi:[1,0,1]
v_pk_fma_f32 v[84:85], v[32:33], v[228:229], v[84:85] op_sel_hi:[1,0,1]
v_pk_fma_f32 v[86:87], v[34:35], v[228:229], v[86:87] op_sel_hi:[1,0,1]
s_mov_b32 s58, 1835008
v_cvt_pk_bf16_f32 v177, v74, v75
v_mfma_f32_16x16x32_bf16 v[144:147], a[48:51], a[84:87], v[144:147]
buffer_load_dwordx4 v5, s[24:27], s58 offen lds
v_mfma_f32_16x16x32_bf16 v[64:67], a[64:67], a[48:51], v[64:67]
ds_read_b128 v[18:21], v11
v_cvt_pk_bf16_f32 v178, v88, v89
v_mfma_f32_16x16x32_bf16 v[80:83], a[68:71], a[48:51], v[80:83]
ds_read_b128 v[22:25], v11 offset:1024
v_cvt_pk_bf16_f32 v179, v90, v91
v_mfma_f32_16x16x32_bf16 v[124:127], a[44:47], a[80:83], v[124:127]
v_cvt_pk_bf16_f32 v206, v132, v133
v_cvt_pk_bf16_f32 v207, v134, v135
v_cvt_pk_bf16_f32 v216, v148, v149
v_cvt_pk_bf16_f32 v217, v150, v151
v_cvt_pk_bf16_f32 v188, v96, v97
s_waitcnt lgkmcnt(5)
v_pk_fma_f32 v[128:129], v[240:241], v[44:45], v[128:129] op_sel_hi:[1,0,1]
s_waitcnt lgkmcnt(4)
v_pk_mul_f32 v[128:129], v[128:129], v[244:245]
v_pk_fma_f32 v[130:131], v[242:243], v[44:45], v[130:131] op_sel_hi:[1,0,1]
v_pk_mul_f32 v[130:131], v[130:131], v[246:247]
v_pk_fma_f32 v[144:145], v[240:241], v[44:45], v[144:145] op_sel:[0,1,0] op_sel_hi:[1,1,1]
v_pk_mul_f32 v[144:145], v[144:145], v[244:245]
v_pk_fma_f32 v[146:147], v[242:243], v[44:45], v[146:147] op_sel:[0,1,0] op_sel_hi:[1,1,1]
v_pk_mul_f32 v[146:147], v[146:147], v[246:247]
v_pk_fma_f32 v[64:65], v[28:29], v[224:225], v[64:65] op_sel_hi:[1,0,1]
v_pk_fma_f32 v[66:67], v[30:31], v[224:225], v[66:67] op_sel_hi:[1,0,1]
v_pk_fma_f32 v[80:81], v[32:33], v[224:225], v[80:81] op_sel_hi:[1,0,1]
v_pk_fma_f32 v[82:83], v[34:35], v[224:225], v[82:83] op_sel_hi:[1,0,1]
v_cvt_pk_bf16_f32 v189, v98, v99
v_cvt_pk_bf16_f32 v190, v112, v113
v_mfma_f32_16x16x32_bf16 v[140:143], a[44:47], a[84:87], v[140:143]
buffer_load_dwordx4 v6, s[24:27], s58 offen offset:1024 lds
v_mfma_f32_16x16x32_bf16 v[60:63], a[64:67], a[44:47], v[60:63]
s_add_u32 m0, s59, 116480
s_mov_b32 s58, 786432
v_cvt_pk_bf16_f32 v191, v114, v115
v_mfma_f32_16x16x32_bf16 v[76:79], a[68:71], a[44:47], v[76:79]
v_cvt_pk_bf16_f32 v172, v68, v69
v_cvt_pk_bf16_f32 v173, v70, v71
v_mfma_f32_16x16x32_bf16 v[104:107], v[192:195], v[176:179], v[46:49]
v_cvt_pk_bf16_f32 v174, v84, v85
v_cvt_pk_bf16_f32 v175, v86, v87
v_cvt_pk_bf16_f32 v204, v128, v129
v_cvt_pk_bf16_f32 v205, v130, v131
v_cvt_pk_bf16_f32 v214, v144, v145
s_waitcnt lgkmcnt(1)
v_pk_fma_f32 v[124:125], v[18:19], v[44:45], v[124:125] op_sel_hi:[1,0,1]
s_waitcnt lgkmcnt(0)
v_pk_mul_f32 v[124:125], v[124:125], v[22:23]
v_pk_fma_f32 v[126:127], v[20:21], v[44:45], v[126:127] op_sel_hi:[1,0,1]
v_pk_mul_f32 v[126:127], v[126:127], v[24:25]
v_pk_fma_f32 v[140:141], v[18:19], v[44:45], v[140:141] op_sel:[0,1,0] op_sel_hi:[1,1,1]
v_pk_mul_f32 v[140:141], v[140:141], v[22:23]
v_pk_fma_f32 v[142:143], v[20:21], v[44:45], v[142:143] op_sel:[0,1,0] op_sel_hi:[1,1,1]
v_pk_mul_f32 v[142:143], v[142:143], v[24:25]
v_pk_fma_f32 v[60:61], v[28:29], v[220:221], v[60:61] op_sel_hi:[1,0,1]
v_pk_fma_f32 v[62:63], v[30:31], v[220:221], v[62:63] op_sel_hi:[1,0,1]
v_pk_fma_f32 v[76:77], v[32:33], v[220:221], v[76:77] op_sel_hi:[1,0,1]
v_pk_fma_f32 v[78:79], v[34:35], v[220:221], v[78:79] op_sel_hi:[1,0,1]
v_max3_f32 v88, v104, v105, v106
v_cvt_pk_bf16_f32 v215, v146, v147
v_mfma_f32_16x16x32_bf16 v[120:123], v[196:199], v[176:179], v[50:53]
buffer_load_dwordx4 v5, s[24:27], s58 offen lds
v_mfma_f32_16x16x32_bf16 v[100:103], v[188:191], v[172:175], v[46:49]
v_cvt_pk_bf16_f32 v184, v92, v93
v_cvt_pk_bf16_f32 v185, v94, v95
v_mfma_f32_16x16x32_bf16 v[116:119], v[192:195], v[172:175], v[50:53]
s_nop 2
v_max3_f32 v89, v107, v120, v121
v_max3_f32 v88, v88, v122, v123
v_max_f32 v90, v88, v89
v_max_f32 v89, v88, v89
v_max3_f32 v84, v100, v101, v102
v_cvt_pk_bf16_f32 v186, v108, v109
v_permlane16_swap_b32 v90, v89
v_max3_f32 v85, v103, v116, v117
buffer_load_dwordx4 v6, s[24:27], s58 offen offset:1024 lds
s_add_u32 m0, s59, 124800
s_mov_b32 s58, 917504
v_max_f32 v88, v90, v89
v_max_f32 v89, v90, v89
v_max3_f32 v84, v84, v118, v119
v_max_f32 v86, v84, v85
v_permlane32_swap_b32 v88, v89
v_max_f32 v85, v84, v85
v_max_f32 v88, v88, v89
v_mul_f32 v88, v88, v234
v_pk_fma_f32 v[104:105], v[104:105], v[234:235], v[88:89] op_sel_hi:[1,0,0] neg_lo:[0,0,1] neg_hi:[0,0,1]
v_pk_fma_f32 v[106:107], v[106:107], v[234:235], v[88:89] op_sel_hi:[1,0,0] neg_lo:[0,0,1] neg_hi:[0,0,1]
buffer_load_dwordx4 v5, s[24:27], s58 offen lds
v_pk_fma_f32 v[120:121], v[120:121], v[234:235], v[88:89] op_sel_hi:[1,0,0] neg_lo:[0,0,1] neg_hi:[0,0,1]
v_pk_fma_f32 v[122:123], v[122:123], v[234:235], v[88:89] op_sel_hi:[1,0,0] neg_lo:[0,0,1] neg_hi:[0,0,1]
v_exp_f32 v104, v104
v_exp_f32 v105, v105
v_exp_f32 v106, v106
v_exp_f32 v107, v107
v_exp_f32 v120, v120
v_exp_f32 v121, v121
v_exp_f32 v122, v122
v_exp_f32 v123, v123
v_cvt_pk_bf16_f32 v72, v104, v105
buffer_load_dwordx4 v6, s[24:27], s58 offen offset:1024 lds
v_cvt_pk_bf16_f32 v73, v106, v107
v_cvt_pk_bf16_f32 v74, v120, v121
v_cvt_pk_bf16_f32 v75, v122, v123
v_permlane16_swap_b32 v86, v85
s_nop 0
v_mfma_f32_16x16x32_bf16 v[88:91], v[248:251], v[72:75], 0
v_max_f32 v84, v86, v85
v_max_f32 v85, v86, v85
v_mfma_f32_16x16x32_bf16 v[104:107], v[206:209], v[72:75], 0
s_nop 0
v_permlane32_swap_b32 v84, v85
v_mfma_f32_16x16x32_bf16 v[120:123], v[216:219], v[72:75], 0
s_nop 1
v_rcp_f32 v88, v88
v_max_f32 v84, v84, v85
v_mul_f32 v84, v84, v230
v_cvt_pk_bf16_f32 v187, v110, v111
v_pk_mul_f32 v[104:105], v[104:105], v[88:89] op_sel_hi:[1,0]
v_pk_mul_f32 v[106:107], v[106:107], v[88:89] op_sel_hi:[1,0]
v_pk_mul_f32 v[120:121], v[120:121], v[88:89] op_sel_hi:[1,0]
v_pk_mul_f32 v[122:123], v[122:123], v[88:89] op_sel_hi:[1,0]
v_cvt_pk_bf16_f32 v176, v104, v105
v_cvt_pk_bf16_f32 v177, v106, v107
v_cvt_pk_bf16_f32 v178, v120, v121
v_cvt_pk_bf16_f32 v179, v122, v123
buffer_store_dwordx4 v[176:179], v4, s[16:19], s74 offen offset:3072 sc1
v_pk_fma_f32 v[100:101], v[100:101], v[230:231], v[84:85] op_sel_hi:[1,0,0] neg_lo:[0,0,1] neg_hi:[0,0,1]
v_pk_fma_f32 v[102:103], v[102:103], v[230:231], v[84:85] op_sel_hi:[1,0,0] neg_lo:[0,0,1] neg_hi:[0,0,1]
v_pk_fma_f32 v[116:117], v[116:117], v[230:231], v[84:85] op_sel_hi:[1,0,0] neg_lo:[0,0,1] neg_hi:[0,0,1]
v_pk_fma_f32 v[118:119], v[118:119], v[230:231], v[84:85] op_sel_hi:[1,0,0] neg_lo:[0,0,1] neg_hi:[0,0,1]
v_exp_f32 v100, v100
v_exp_f32 v101, v101
v_exp_f32 v102, v102
v_exp_f32 v103, v103
v_exp_f32 v116, v116
v_exp_f32 v117, v117
v_exp_f32 v118, v118
v_exp_f32 v119, v119
v_cvt_pk_bf16_f32 v68, v100, v101
v_cvt_pk_bf16_f32 v69, v102, v103
v_cvt_pk_bf16_f32 v70, v116, v117
v_cvt_pk_bf16_f32 v71, v118, v119
v_cvt_pk_bf16_f32 v168, v64, v65
v_cvt_pk_bf16_f32 v169, v66, v67
v_mfma_f32_16x16x32_bf16 v[84:87], v[248:251], v[68:71], 0
v_cvt_pk_bf16_f32 v170, v80, v81
v_cvt_pk_bf16_f32 v171, v82, v83
v_mfma_f32_16x16x32_bf16 v[100:103], v[204:207], v[68:71], 0
v_cvt_pk_bf16_f32 v202, v124, v125
v_cvt_pk_bf16_f32 v203, v126, v127
v_mfma_f32_16x16x32_bf16 v[116:119], v[214:217], v[68:71], 0
s_nop 1
v_rcp_f32 v84, v84
v_mfma_f32_16x16x32_bf16 v[96:99], v[184:187], v[168:171], v[46:49]
v_cvt_pk_bf16_f32 v212, v140, v141
v_cvt_pk_bf16_f32 v213, v142, v143
v_mfma_f32_16x16x32_bf16 v[112:115], v[188:191], v[168:171], v[50:53]
v_cvt_pk_bf16_f32 v180, v156, v157
v_cvt_pk_bf16_f32 v181, v158, v159
v_cvt_pk_bf16_f32 v182, v160, v161
s_nop 1
v_max3_f32 v80, v96, v97, v98
v_cvt_pk_bf16_f32 v183, v162, v163
v_pk_mul_f32 v[100:101], v[100:101], v[84:85] op_sel_hi:[1,0]
v_pk_mul_f32 v[102:103], v[102:103], v[84:85] op_sel_hi:[1,0]
v_pk_mul_f32 v[116:117], v[116:117], v[84:85] op_sel_hi:[1,0]
v_pk_mul_f32 v[118:119], v[118:119], v[84:85] op_sel_hi:[1,0]
v_cvt_pk_bf16_f32 v172, v100, v101
v_cvt_pk_bf16_f32 v173, v102, v103
v_cvt_pk_bf16_f32 v174, v116, v117
v_cvt_pk_bf16_f32 v175, v118, v119
buffer_store_dwordx4 v[172:175], v4, s[16:19], s74 offen offset:2048 sc1
v_max3_f32 v81, v99, v112, v113
v_max3_f32 v80, v80, v114, v115
v_max_f32 v82, v80, v81
v_max_f32 v81, v80, v81
v_cvt_pk_bf16_f32 v164, v60, v61
v_cvt_pk_bf16_f32 v165, v62, v63
v_permlane16_swap_b32 v82, v81
v_cvt_pk_bf16_f32 v166, v76, v77
v_max_f32 v80, v82, v81
v_max_f32 v81, v82, v81
v_cvt_pk_bf16_f32 v167, v78, v79
s_nop 0
v_permlane32_swap_b32 v80, v81
v_mfma_f32_16x16x32_bf16 v[92:95], v[180:183], v[164:167], v[54:57]
v_max_f32 v80, v80, v81
v_mul_f32 v80, v80, v226
v_mfma_f32_16x16x32_bf16 v[108:111], v[184:187], v[164:167], v[50:53]
s_nop 4
v_max3_f32 v76, v92, v93, v94
v_pk_fma_f32 v[96:97], v[96:97], v[226:227], v[80:81] op_sel_hi:[1,0,0] neg_lo:[0,0,1] neg_hi:[0,0,1]
v_pk_fma_f32 v[98:99], v[98:99], v[226:227], v[80:81] op_sel_hi:[1,0,0] neg_lo:[0,0,1] neg_hi:[0,0,1]
v_pk_fma_f32 v[112:113], v[112:113], v[226:227], v[80:81] op_sel_hi:[1,0,0] neg_lo:[0,0,1] neg_hi:[0,0,1]
v_pk_fma_f32 v[114:115], v[114:115], v[226:227], v[80:81] op_sel_hi:[1,0,0] neg_lo:[0,0,1] neg_hi:[0,0,1]
v_exp_f32 v96, v96
v_exp_f32 v97, v97
v_exp_f32 v98, v98
v_exp_f32 v99, v99
v_exp_f32 v112, v112
v_exp_f32 v113, v113
v_exp_f32 v114, v114
v_exp_f32 v115, v115
v_cvt_pk_bf16_f32 v64, v96, v97
v_cvt_pk_bf16_f32 v65, v98, v99
v_cvt_pk_bf16_f32 v66, v112, v113
v_cvt_pk_bf16_f32 v67, v114, v115
v_max3_f32 v77, v95, v108, v109
v_max3_f32 v76, v76, v110, v111
v_mfma_f32_16x16x32_bf16 v[80:83], v[248:251], v[64:67], 0
v_max_f32 v78, v76, v77
v_max_f32 v77, v76, v77
v_mfma_f32_16x16x32_bf16 v[96:99], v[202:205], v[64:67], 0
s_nop 0
v_permlane16_swap_b32 v78, v77
v_mfma_f32_16x16x32_bf16 v[112:115], v[212:215], v[64:67], 0
s_nop 1
v_rcp_f32 v80, v80
v_max_f32 v76, v78, v77
v_max_f32 v77, v78, v77
v_pk_mul_f32 v[96:97], v[96:97], v[80:81] op_sel_hi:[1,0]
v_pk_mul_f32 v[98:99], v[98:99], v[80:81] op_sel_hi:[1,0]
s_nop 0
v_pk_mul_f32 v[112:113], v[112:113], v[80:81] op_sel_hi:[1,0]
v_pk_mul_f32 v[114:115], v[114:115], v[80:81] op_sel_hi:[1,0]
v_cvt_pk_bf16_f32 v168, v96, v97
v_cvt_pk_bf16_f32 v169, v98, v99
v_cvt_pk_bf16_f32 v170, v112, v113
v_cvt_pk_bf16_f32 v171, v114, v115
buffer_store_dwordx4 v[168:171], v4, s[16:19], s74 offen offset:1024 sc1
v_permlane32_swap_b32 v76, v77
v_max_f32 v76, v76, v77
v_mul_f32 v76, v76, v222
v_pk_fma_f32 v[92:93], v[92:93], v[222:223], v[76:77] op_sel_hi:[1,0,0] neg_lo:[0,0,1] neg_hi:[0,0,1]
v_pk_fma_f32 v[94:95], v[94:95], v[222:223], v[76:77] op_sel_hi:[1,0,0] neg_lo:[0,0,1] neg_hi:[0,0,1]
v_pk_fma_f32 v[108:109], v[108:109], v[222:223], v[76:77] op_sel_hi:[1,0,0] neg_lo:[0,0,1] neg_hi:[0,0,1]
v_pk_fma_f32 v[110:111], v[110:111], v[222:223], v[76:77] op_sel_hi:[1,0,0] neg_lo:[0,0,1] neg_hi:[0,0,1]
v_exp_f32 v92, v92
v_exp_f32 v93, v93
v_exp_f32 v94, v94
v_exp_f32 v95, v95
v_exp_f32 v108, v108
v_exp_f32 v109, v109
v_exp_f32 v110, v110
v_exp_f32 v111, v111
v_cvt_pk_bf16_f32 v60, v92, v93
v_cvt_pk_bf16_f32 v61, v94, v95
v_cvt_pk_bf16_f32 v62, v108, v109
v_cvt_pk_bf16_f32 v63, v110, v111
s_nop 1
v_mfma_f32_16x16x32_bf16 v[76:79], v[248:251], v[60:63], 0
v_mfma_f32_16x16x32_bf16 v[92:95], v[200:203], v[60:63], 0
v_mfma_f32_16x16x32_bf16 v[108:111], v[210:213], v[60:63], 0
s_nop 5
v_rcp_f32 v76, v76
s_nop 0
v_pk_mul_f32 v[92:93], v[92:93], v[76:77] op_sel_hi:[1,0]
v_pk_mul_f32 v[94:95], v[94:95], v[76:77] op_sel_hi:[1,0]
v_pk_mul_f32 v[108:109], v[108:109], v[76:77] op_sel_hi:[1,0]
v_pk_mul_f32 v[110:111], v[110:111], v[76:77] op_sel_hi:[1,0]
v_cvt_pk_bf16_f32 v164, v92, v93
v_cvt_pk_bf16_f32 v165, v94, v95
v_cvt_pk_bf16_f32 v166, v108, v109
v_cvt_pk_bf16_f32 v167, v110, v111
buffer_store_dwordx4 v[164:167], v4, s[16:19], s74 offen sc1
s_nop 1
s_branch .Lqkve49
.Lpad21:
s_cbranch_execz .Lpad24
.Lxs42:
s_mov_b32 s15, 0
.Lxs42l:
v_mov_b32 v15, 0
buffer_atomic_add v15, v12, s[16:19], s70 offen sc0
s_add_u32 s15, s15, 1
s_cmp_gt_u32 s15, 100000
s_waitcnt vmcnt(0)
s_cbranch_scc1 .Lxs42b
v_cmp_ne_u32 vcc, 0, v15
s_nop 0
s_cbranch_vccz .Lxs42l
s_branch .Lxs42b
.Lqkv48:
.Lpad22:
s_cbranch_execz .Lpad25
s_add_u32 m0, s55, 36864
s_nop 0
buffer_load_dwordx4 v21, s[16:19], s52 offen sc1 lds
buffer_load_dwordx4 v21, s[16:19], s52 offen offset:1024 sc1 lds
buffer_load_dword v22, s[16:19], s52 offen offset:2048 sc1 lds
s_add_u32 s52, s52, 0x20000
s_add_u32 m0, s55, 46080
s_nop 0
buffer_load_dwordx4 v21, s[16:19], s52 offen sc1 lds
buffer_load_dwordx4 v21, s[16:19], s52 offen offset:1024 sc1 lds
buffer_load_dword v22, s[16:19], s52 offen offset:2048 sc1 lds
s_add_u32 s52, s52, 0x20000
s_add_u32 m0, s55, 0
s_nop 0
buffer_load_dwordx4 v21, s[16:19], s52 offen sc1 lds
buffer_load_dwordx4 v21, s[16:19], s52 offen offset:1024 sc1 lds
.Lpad23:
s_cbranch_execz .Lpad26
buffer_load_dword v22, s[16:19], s52 offen offset:2048 sc1 lds
s_add_u32 s52, s52, 0x20000
s_add_u32 m0, s55, 9216
s_nop 0
buffer_load_dwordx4 v21, s[16:19], s52 offen sc1 lds
buffer_load_dwordx4 v21, s[16:19], s52 offen offset:1024 sc1 lds
buffer_load_dword v22, s[16:19], s52 offen offset:2048 sc1 lds
s_add_u32 s52, s52, 0x20000
s_add_u32 m0, s55, 18432
s_nop 0
buffer_load_dwordx4 v21, s[16:19], s52 offen sc1 lds
buffer_load_dwordx4 v21, s[16:19], s52 offen offset:1024 sc1 lds
buffer_load_dword v22, s[16:19], s52 offen offset:2048 sc1 lds
s_add_u32 s52, s52, 0x20000
s_waitcnt vmcnt(12)
s_barrier
ds_read_b128 a[0:3], v23 offset:36864
ds_read_b128 a[4:7], v23 offset:37888
ds_read_b128 a[8:11], v23 offset:39168
ds_read_b128 a[12:15], v23 offset:40192
ds_read_b128 a[16:19], v24 offset:38912
s_waitcnt lgkmcnt(0)
s_mov_b32 s15, -4
.p2align 6
.Lk51:
s_waitcnt vmcnt(9) lgkmcnt(6)
s_barrier
v_mfma_f32_16x16x32_bf16 v[60:63], a[20:23], a[0:3], v[60:63]
ds_read_b128 a[44:47], v23 offset:46080
s_add_u32 m0, s56, 104832
v_mfma_f32_16x16x32_bf16 v[64:67], a[20:23], a[4:7], v[64:67]
buffer_load_dwordx4 v18, s[20:23], s54 offen lds
v_mfma_f32_16x16x32_bf16 v[68:71], a[20:23], a[8:11], v[68:71]
ds_read_b128 a[48:51], v23 offset:47104
v_add_f32 v164, v164, v168
v_mfma_f32_16x16x32_bf16 v[72:75], a[20:23], a[12:15], v[72:75]
ds_read_b128 a[52:55], v23 offset:48384
v_mfma_f32_16x16x32_bf16 v[76:79], a[24:27], a[0:3], v[76:79]
buffer_load_dwordx4 v19, s[20:23], s54 offen offset:1024 lds
v_mfma_f32_16x16x32_bf16 v[80:83], a[24:27], a[4:7], v[80:83]
ds_read_b128 a[56:59], v23 offset:49408
v_mfma_f32_16x16x32_bf16 v[84:87], a[24:27], a[8:11], v[84:87]
ds_read_b64_tr_b16 a[64:65], v25 offset:62080
v_add_f32 v165, v165, v169
v_mfma_f32_16x16x32_bf16 v[88:91], a[24:27], a[12:15], v[88:91]
buffer_load_dwordx4 v20, s[20:23], s54 offen offset:2048 lds
v_mfma_f32_16x16x32_bf16 v[92:95], a[28:31], a[0:3], v[92:95]
ds_read_b64_tr_b16 a[66:67], v25 offset:62592
s_add_u32 s54, s54, 196608
v_mfma_f32_16x16x32_bf16 v[96:99], a[28:31], a[4:7], v[96:99]
ds_read_b64_tr_b16 a[68:69], v25 offset:62112
v_mfma_f32_16x16x32_bf16 v[100:103], a[28:31], a[8:11], v[100:103]
s_add_u32 m0, s55, 27648
s_waitcnt lgkmcnt(7)
v_mfma_f32_16x16x32_bf16 v[104:107], a[28:31], a[12:15], v[104:107]
buffer_load_dwordx4 v21, s[16:19], s52 offen sc1 lds
v_mfma_f32_16x16x32_bf16 v[108:111], a[32:35], a[0:3], v[108:111]
ds_read_b64_tr_b16 a[70:71], v25 offset:62624
v_mfma_f32_16x16x32_bf16 v[112:115], a[32:35], a[4:7], v[112:115]
ds_read_b128 a[60:63], v24 offset:48128
v_add_f32 v166, v166, v170
v_mfma_f32_16x16x32_bf16 v[116:119], a[32:35], a[8:11], v[116:119]
buffer_load_dwordx4 v21, s[16:19], s52 offen offset:1024 sc1 lds
v_mfma_f32_16x16x32_bf16 v[120:123], a[32:35], a[12:15], v[120:123]
ds_read_b64_tr_b16 a[72:73], v25 offset:63104
v_mfma_f32_16x16x32_bf16 v[124:127], a[0:3], a[36:39], v[124:127]
ds_read_b64_tr_b16 a[74:75], v25 offset:63616
v_mfma_f32_16x16x32_bf16 v[128:131], a[4:7], a[36:39], v[128:131]
ds_read_b64_tr_b16 a[76:77], v25 offset:63136
v_add_f32 v167, v167, v171
v_mfma_f32_16x16x32_bf16 v[132:135], a[8:11], a[36:39], v[132:135]
buffer_load_dword v22, s[16:19], s52 offen offset:2048 sc1 lds
v_mfma_f32_16x16x32_bf16 v[136:139], a[12:15], a[36:39], v[136:139]
ds_read_b64_tr_b16 a[78:79], v25 offset:63648
s_add_u32 s52, s52, 0x20000
v_mfma_f32_16x16x32_bf16 v[156:159], a[16:19], a[36:39], v[156:159]
ds_read_b64_tr_b16 a[80:81], v25 offset:64128
v_mfma_f32_16x16x32_bf16 v[140:143], a[0:3], a[40:43], v[140:143]
buffer_load_dword v27, v14, s[20:23], s44 offen
v_mfma_f32_16x16x32_bf16 v[144:147], a[4:7], a[40:43], v[144:147]
ds_read_b64_tr_b16 a[82:83], v25 offset:64640
s_add_u32 s44, s44, 1572864
v_mfma_f32_16x16x32_bf16 v[148:151], a[8:11], a[40:43], v[148:151]
ds_read_b64_tr_b16 a[84:85], v25 offset:64160
v_mfma_f32_16x16x32_bf16 v[152:155], a[12:15], a[40:43], v[152:155]
ds_read_b64_tr_b16 a[86:87], v25 offset:64672
v_mfma_f32_16x16x32_bf16 v[160:163], a[16:19], a[40:43], v[160:163]
s_waitcnt vmcnt(13) lgkmcnt(6)
s_barrier
v_mfma_f32_16x16x32_bf16 v[60:63], a[64:67], a[44:47], v[60:63]
ds_read_b128 a[0:3], v23
s_add_u32 m0, s56, 117248
v_mfma_f32_16x16x32_bf16 v[64:67], a[64:67], a[48:51], v[64:67]
buffer_load_dwordx4 v18, s[20:23], s54 offen lds
v_mfma_f32_16x16x32_bf16 v[68:71], a[64:67], a[52:55], v[68:71]
ds_read_b128 a[4:7], v23 offset:1024
v_mfma_f32_16x16x32_bf16 v[72:75], a[64:67], a[56:59], v[72:75]
ds_read_b128 a[8:11], v23 offset:2304
v_mfma_f32_16x16x32_bf16 v[76:79], a[68:71], a[44:47], v[76:79]
buffer_load_dwordx4 v19, s[20:23], s54 offen offset:1024 lds
v_mfma_f32_16x16x32_bf16 v[80:83], a[68:71], a[48:51], v[80:83]
ds_read_b128 a[12:15], v23 offset:3328
v_mfma_f32_16x16x32_bf16 v[84:87], a[68:71], a[52:55], v[84:87]
ds_read_b64_tr_b16 a[20:21], v25
v_mfma_f32_16x16x32_bf16 v[88:91], a[68:71], a[56:59], v[88:91]
buffer_load_dwordx4 v20, s[20:23], s54 offen offset:2048 lds
v_mfma_f32_16x16x32_bf16 v[92:95], a[72:75], a[44:47], v[92:95]
ds_read_b64_tr_b16 a[22:23], v25 offset:512
s_add_u32 s54, s54, 196608
v_mfma_f32_16x16x32_bf16 v[96:99], a[72:75], a[48:51], v[96:99]
ds_read_b64_tr_b16 a[24:25], v25 offset:32
v_mfma_f32_16x16x32_bf16 v[100:103], a[72:75], a[52:55], v[100:103]
s_add_u32 m0, s55, 36864
s_waitcnt lgkmcnt(7)
v_mfma_f32_16x16x32_bf16 v[104:107], a[72:75], a[56:59], v[104:107]
buffer_load_dwordx4 v21, s[16:19], s52 offen sc1 lds
v_mfma_f32_16x16x32_bf16 v[108:111], a[76:79], a[44:47], v[108:111]
ds_read_b64_tr_b16 a[26:27], v25 offset:544
v_mfma_f32_16x16x32_bf16 v[112:115], a[76:79], a[48:51], v[112:115]
ds_read_b128 a[16:19], v24 offset:2048
v_mfma_f32_16x16x32_bf16 v[116:119], a[76:79], a[52:55], v[116:119]
buffer_load_dwordx4 v21, s[16:19], s52 offen offset:1024 sc1 lds
v_mfma_f32_16x16x32_bf16 v[120:123], a[76:79], a[56:59], v[120:123]
ds_read_b64_tr_b16 a[28:29], v25 offset:1024
v_mfma_f32_16x16x32_bf16 v[124:127], a[44:47], a[80:83], v[124:127]
ds_read_b64_tr_b16 a[30:31], v25 offset:1536
v_mfma_f32_16x16x32_bf16 v[128:131], a[48:51], a[80:83], v[128:131]
ds_read_b64_tr_b16 a[32:33], v25 offset:1056
v_mfma_f32_16x16x32_bf16 v[132:135], a[52:55], a[80:83], v[132:135]
buffer_load_dword v22, s[16:19], s52 offen offset:2048 sc1 lds
v_mfma_f32_16x16x32_bf16 v[136:139], a[56:59], a[80:83], v[136:139]
ds_read_b64_tr_b16 a[34:35], v25 offset:1568
s_add_u32 s52, s52, 0x20000
v_mfma_f32_16x16x32_bf16 v[156:159], a[60:63], a[80:83], v[156:159]
ds_read_b64_tr_b16 a[36:37], v25 offset:2048
v_mfma_f32_16x16x32_bf16 v[140:143], a[44:47], a[84:87], v[140:143]
buffer_load_dwordx4 v[168:171], v26, s[16:19], s75 offen sc1
v_mfma_f32_16x16x32_bf16 v[144:147], a[48:51], a[84:87], v[144:147]
ds_read_b64_tr_b16 a[38:39], v25 offset:2560
v_mfma_f32_16x16x32_bf16 v[148:151], a[52:55], a[84:87], v[148:151]
ds_read_b64_tr_b16 a[40:41], v25 offset:2080
v_mfma_f32_16x16x32_bf16 v[152:155], a[56:59], a[84:87], v[152:155]
ds_read_b64_tr_b16 a[42:43], v25 offset:2592
v_mfma_f32_16x16x32_bf16 v[160:163], a[60:63], a[84:87], v[160:163]
s_waitcnt vmcnt(17) lgkmcnt(6)
s_barrier
v_mfma_f32_16x16x32_bf16 v[60:63], a[20:23], a[0:3], v[60:63]
ds_read_b128 a[44:47], v23 offset:9216
s_add_u32 m0, s56, 129664
v_mfma_f32_16x16x32_bf16 v[64:67], a[20:23], a[4:7], v[64:67]
buffer_load_dwordx4 v18, s[20:23], s54 offen lds
v_mfma_f32_16x16x32_bf16 v[68:71], a[20:23], a[8:11], v[68:71]
ds_read_b128 a[48:51], v23 offset:10240
v_mfma_f32_16x16x32_bf16 v[72:75], a[20:23], a[12:15], v[72:75]
ds_read_b128 a[52:55], v23 offset:11520
v_mfma_f32_16x16x32_bf16 v[76:79], a[24:27], a[0:3], v[76:79]
ds_read_b128 a[56:59], v23 offset:12544
v_mfma_f32_16x16x32_bf16 v[80:83], a[24:27], a[4:7], v[80:83]
buffer_load_dwordx4 v19, s[20:23], s54 offen offset:1024 lds
v_mfma_f32_16x16x32_bf16 v[84:87], a[24:27], a[8:11], v[84:87]
ds_read_b64_tr_b16 a[64:65], v25 offset:12416
v_mfma_f32_16x16x32_bf16 v[88:91], a[24:27], a[12:15], v[88:91]
ds_read_b64_tr_b16 a[66:67], v25 offset:12928
v_mfma_f32_16x16x32_bf16 v[92:95], a[28:31], a[0:3], v[92:95]
ds_read_b64_tr_b16 a[68:69], v25 offset:12448
v_mfma_f32_16x16x32_bf16 v[96:99], a[28:31], a[4:7], v[96:99]
buffer_load_dwordx4 v20, s[20:23], s54 offen offset:2048 lds
v_mfma_f32_16x16x32_bf16 v[100:103], a[28:31], a[8:11], v[100:103]
s_add_u32 s54, s54, 196608
s_waitcnt lgkmcnt(7)
v_mfma_f32_16x16x32_bf16 v[104:107], a[28:31], a[12:15], v[104:107]
ds_read_b64_tr_b16 a[70:71], v25 offset:12960
v_mfma_f32_16x16x32_bf16 v[108:111], a[32:35], a[0:3], v[108:111]
ds_read_b128 a[60:63], v24 offset:11264
s_add_u32 m0, s55, 46080
v_mfma_f32_16x16x32_bf16 v[112:115], a[32:35], a[4:7], v[112:115]
buffer_load_dwordx4 v21, s[16:19], s52 offen sc1 lds
v_mfma_f32_16x16x32_bf16 v[116:119], a[32:35], a[8:11], v[116:119]
ds_read_b64_tr_b16 a[72:73], v25 offset:13440
v_mfma_f32_16x16x32_bf16 v[120:123], a[32:35], a[12:15], v[120:123]
ds_read_b64_tr_b16 a[74:75], v25 offset:13952
v_mfma_f32_16x16x32_bf16 v[124:127], a[0:3], a[36:39], v[124:127]
ds_read_b64_tr_b16 a[76:77], v25 offset:13472
v_mfma_f32_16x16x32_bf16 v[128:131], a[4:7], a[36:39], v[128:131]
buffer_load_dwordx4 v21, s[16:19], s52 offen offset:1024 sc1 lds
v_mfma_f32_16x16x32_bf16 v[132:135], a[8:11], a[36:39], v[132:135]
ds_read_b64_tr_b16 a[78:79], v25 offset:13984
v_mfma_f32_16x16x32_bf16 v[136:139], a[12:15], a[36:39], v[136:139]
ds_read_b64_tr_b16 a[80:81], v25 offset:14464
v_mfma_f32_16x16x32_bf16 v[156:159], a[16:19], a[36:39], v[156:159]
ds_read_b64_tr_b16 a[82:83], v25 offset:14976
v_mfma_f32_16x16x32_bf16 v[140:143], a[0:3], a[40:43], v[140:143]
buffer_load_dword v22, s[16:19], s52 offen offset:2048 sc1 lds
v_mfma_f32_16x16x32_bf16 v[144:147], a[4:7], a[40:43], v[144:147]
ds_read_b64_tr_b16 a[84:85], v25 offset:14496
s_add_u32 s52, s52, 0x20000
v_mfma_f32_16x16x32_bf16 v[148:151], a[8:11], a[40:43], v[148:151]
ds_read_b64_tr_b16 a[86:87], v25 offset:15008
v_mfma_f32_16x16x32_bf16 v[152:155], a[12:15], a[40:43], v[152:155]
v_mfma_f32_16x16x32_bf16 v[160:163], a[16:19], a[40:43], v[160:163]
s_waitcnt vmcnt(20) lgkmcnt(6)
s_barrier
v_mfma_f32_16x16x32_bf16 v[60:63], a[64:67], a[44:47], v[60:63]
ds_read_b128 a[0:3], v23 offset:18432
s_add_u32 m0, s56, 67584
v_mfma_f32_16x16x32_bf16 v[64:67], a[64:67], a[48:51], v[64:67]
buffer_load_dwordx4 v18, s[20:23], s54 offen lds
v_mfma_f32_16x16x32_bf16 v[68:71], a[64:67], a[52:55], v[68:71]
ds_read_b128 a[4:7], v23 offset:19456
v_add_f32 v164, v164, v172
v_mfma_f32_16x16x32_bf16 v[72:75], a[64:67], a[56:59], v[72:75]
ds_read_b128 a[8:11], v23 offset:20736
v_mfma_f32_16x16x32_bf16 v[76:79], a[68:71], a[44:47], v[76:79]
ds_read_b128 a[12:15], v23 offset:21760
v_mfma_f32_16x16x32_bf16 v[80:83], a[68:71], a[48:51], v[80:83]
buffer_load_dwordx4 v19, s[20:23], s54 offen offset:1024 lds
v_mfma_f32_16x16x32_bf16 v[84:87], a[68:71], a[52:55], v[84:87]
ds_read_b64_tr_b16 a[20:21], v25 offset:24832
v_mfma_f32_16x16x32_bf16 v[88:91], a[68:71], a[56:59], v[88:91]
ds_read_b64_tr_b16 a[22:23], v25 offset:25344
v_add_f32 v165, v165, v173
v_mfma_f32_16x16x32_bf16 v[92:95], a[72:75], a[44:47], v[92:95]
ds_read_b64_tr_b16 a[24:25], v25 offset:24864
v_mfma_f32_16x16x32_bf16 v[96:99], a[72:75], a[48:51], v[96:99]
buffer_load_dwordx4 v20, s[20:23], s54 offen offset:2048 lds
v_mfma_f32_16x16x32_bf16 v[100:103], a[72:75], a[52:55], v[100:103]
s_add_u32 s54, s54, 196608
s_waitcnt lgkmcnt(7)
v_mfma_f32_16x16x32_bf16 v[104:107], a[72:75], a[56:59], v[104:107]
ds_read_b64_tr_b16 a[26:27], v25 offset:25376
v_mfma_f32_16x16x32_bf16 v[108:111], a[76:79], a[44:47], v[108:111]
ds_read_b128 a[16:19], v24 offset:20480
s_add_u32 m0, s55, 0
v_mfma_f32_16x16x32_bf16 v[112:115], a[76:79], a[48:51], v[112:115]
buffer_load_dwordx4 v21, s[16:19], s52 offen sc1 lds
v_mfma_f32_16x16x32_bf16 v[116:119], a[76:79], a[52:55], v[116:119]
ds_read_b64_tr_b16 a[28:29], v25 offset:25856
v_add_f32 v166, v166, v174
v_mfma_f32_16x16x32_bf16 v[120:123], a[76:79], a[56:59], v[120:123]
ds_read_b64_tr_b16 a[30:31], v25 offset:26368
v_mfma_f32_16x16x32_bf16 v[124:127], a[44:47], a[80:83], v[124:127]
ds_read_b64_tr_b16 a[32:33], v25 offset:25888
v_mfma_f32_16x16x32_bf16 v[128:131], a[48:51], a[80:83], v[128:131]
buffer_load_dwordx4 v21, s[16:19], s52 offen offset:1024 sc1 lds
v_mfma_f32_16x16x32_bf16 v[132:135], a[52:55], a[80:83], v[132:135]
ds_read_b64_tr_b16 a[34:35], v25 offset:26400
v_mfma_f32_16x16x32_bf16 v[136:139], a[56:59], a[80:83], v[136:139]
ds_read_b64_tr_b16 a[36:37], v25 offset:26880
v_add_f32 v167, v167, v175
v_mfma_f32_16x16x32_bf16 v[156:159], a[60:63], a[80:83], v[156:159]
ds_read_b64_tr_b16 a[38:39], v25 offset:27392
v_mfma_f32_16x16x32_bf16 v[140:143], a[44:47], a[84:87], v[140:143]
buffer_load_dword v22, s[16:19], s52 offen offset:2048 sc1 lds
v_mfma_f32_16x16x32_bf16 v[144:147], a[48:51], a[84:87], v[144:147]
ds_read_b64_tr_b16 a[40:41], v25 offset:26912
s_add_u32 s52, s52, 0x20000
v_mfma_f32_16x16x32_bf16 v[148:151], a[52:55], a[84:87], v[148:151]
ds_read_b64_tr_b16 a[42:43], v25 offset:27424
v_mfma_f32_16x16x32_bf16 v[152:155], a[56:59], a[84:87], v[152:155]
v_mfma_f32_16x16x32_bf16 v[160:163], a[60:63], a[84:87], v[160:163]
s_waitcnt vmcnt(20) lgkmcnt(6)
s_barrier
v_mfma_f32_16x16x32_bf16 v[60:63], a[20:23], a[0:3], v[60:63]
ds_read_b128 a[44:47], v23 offset:27648
s_add_u32 m0, s56, 80000
v_mfma_f32_16x16x32_bf16 v[64:67], a[20:23], a[4:7], v[64:67]
buffer_load_dwordx4 v18, s[20:23], s54 offen lds
v_mfma_f32_16x16x32_bf16 v[68:71], a[20:23], a[8:11], v[68:71]
ds_read_b128 a[48:51], v23 offset:28672
v_mfma_f32_16x16x32_bf16 v[72:75], a[20:23], a[12:15], v[72:75]
ds_read_b128 a[52:55], v23 offset:29952
v_mfma_f32_16x16x32_bf16 v[76:79], a[24:27], a[0:3], v[76:79]
buffer_load_dwordx4 v19, s[20:23], s54 offen offset:1024 lds
v_mfma_f32_16x16x32_bf16 v[80:83], a[24:27], a[4:7], v[80:83]
ds_read_b128 a[56:59], v23 offset:30976
v_mfma_f32_16x16x32_bf16 v[84:87], a[24:27], a[8:11], v[84:87]
ds_read_b64_tr_b16 a[64:65], v25 offset:37248
v_mfma_f32_16x16x32_bf16 v[88:91], a[24:27], a[12:15], v[88:91]
buffer_load_dwordx4 v20, s[20:23], s54 offen offset:2048 lds
v_mfma_f32_16x16x32_bf16 v[92:95], a[28:31], a[0:3], v[92:95]
ds_read_b64_tr_b16 a[66:67], v25 offset:37760
s_add_u32 s54, s54, 196608
v_mfma_f32_16x16x32_bf16 v[96:99], a[28:31], a[4:7], v[96:99]
ds_read_b64_tr_b16 a[68:69], v25 offset:37280
v_mfma_f32_16x16x32_bf16 v[100:103], a[28:31], a[8:11], v[100:103]
s_add_u32 m0, s55, 9216
s_waitcnt lgkmcnt(7)
v_mfma_f32_16x16x32_bf16 v[104:107], a[28:31], a[12:15], v[104:107]
buffer_load_dwordx4 v21, s[16:19], s52 offen sc1 lds
v_mfma_f32_16x16x32_bf16 v[108:111], a[32:35], a[0:3], v[108:111]
ds_read_b64_tr_b16 a[70:71], v25 offset:37792
v_mfma_f32_16x16x32_bf16 v[112:115], a[32:35], a[4:7], v[112:115]
ds_read_b128 a[60:63], v24 offset:29696
v_mfma_f32_16x16x32_bf16 v[116:119], a[32:35], a[8:11], v[116:119]
buffer_load_dwordx4 v21, s[16:19], s52 offen offset:1024 sc1 lds
v_mfma_f32_16x16x32_bf16 v[120:123], a[32:35], a[12:15], v[120:123]
ds_read_b64_tr_b16 a[72:73], v25 offset:38272
v_mfma_f32_16x16x32_bf16 v[124:127], a[0:3], a[36:39], v[124:127]
ds_read_b64_tr_b16 a[74:75], v25 offset:38784
v_mfma_f32_16x16x32_bf16 v[128:131], a[4:7], a[36:39], v[128:131]
ds_read_b64_tr_b16 a[76:77], v25 offset:38304
v_mfma_f32_16x16x32_bf16 v[132:135], a[8:11], a[36:39], v[132:135]
buffer_load_dword v22, s[16:19], s52 offen offset:2048 sc1 lds
v_mfma_f32_16x16x32_bf16 v[136:139], a[12:15], a[36:39], v[136:139]
ds_read_b64_tr_b16 a[78:79], v25 offset:38816
s_add_u32 s52, s52, 0x20000
v_mfma_f32_16x16x32_bf16 v[156:159], a[16:19], a[36:39], v[156:159]
ds_read_b64_tr_b16 a[80:81], v25 offset:39296
v_mfma_f32_16x16x32_bf16 v[140:143], a[0:3], a[40:43], v[140:143]
buffer_load_dwordx4 v[172:175], v26, s[16:19], s75 offen offset:1024 sc1
v_mfma_f32_16x16x32_bf16 v[144:147], a[4:7], a[40:43], v[144:147]
ds_read_b64_tr_b16 a[82:83], v25 offset:39808
s_add_u32 s75, s75, 2048
v_mfma_f32_16x16x32_bf16 v[148:151], a[8:11], a[40:43], v[148:151]
ds_read_b64_tr_b16 a[84:85], v25 offset:39328
v_mfma_f32_16x16x32_bf16 v[152:155], a[12:15], a[40:43], v[152:155]
ds_read_b64_tr_b16 a[86:87], v25 offset:39840
v_mfma_f32_16x16x32_bf16 v[160:163], a[16:19], a[40:43], v[160:163]
s_waitcnt vmcnt(20) lgkmcnt(6)
s_barrier
v_mfma_f32_16x16x32_bf16 v[60:63], a[64:67], a[44:47], v[60:63]
ds_read_b128 a[0:3], v23 offset:36864
s_add_u32 m0, s56, 92416
v_mfma_f32_16x16x32_bf16 v[64:67], a[64:67], a[48:51], v[64:67]
buffer_load_dwordx4 v18, s[20:23], s54 offen lds
v_mfma_f32_16x16x32_bf16 v[68:71], a[64:67], a[52:55], v[68:71]
ds_read_b128 a[4:7], v23 offset:37888
v_mfma_f32_16x16x32_bf16 v[72:75], a[64:67], a[56:59], v[72:75]
ds_read_b128 a[8:11], v23 offset:39168
v_mfma_f32_16x16x32_bf16 v[76:79], a[68:71], a[44:47], v[76:79]
ds_read_b128 a[12:15], v23 offset:40192
v_mfma_f32_16x16x32_bf16 v[80:83], a[68:71], a[48:51], v[80:83]
buffer_load_dwordx4 v19, s[20:23], s54 offen offset:1024 lds
v_mfma_f32_16x16x32_bf16 v[84:87], a[68:71], a[52:55], v[84:87]
ds_read_b64_tr_b16 a[20:21], v25 offset:49664
v_mfma_f32_16x16x32_bf16 v[88:91], a[68:71], a[56:59], v[88:91]
ds_read_b64_tr_b16 a[22:23], v25 offset:50176
v_mfma_f32_16x16x32_bf16 v[92:95], a[72:75], a[44:47], v[92:95]
ds_read_b64_tr_b16 a[24:25], v25 offset:49696
v_mfma_f32_16x16x32_bf16 v[96:99], a[72:75], a[48:51], v[96:99]
buffer_load_dwordx4 v20, s[20:23], s54 offen offset:2048 lds
v_mfma_f32_16x16x32_bf16 v[100:103], a[72:75], a[52:55], v[100:103]
s_add_u32 s54, s54, 196608
s_waitcnt lgkmcnt(7)
v_mfma_f32_16x16x32_bf16 v[104:107], a[72:75], a[56:59], v[104:107]
ds_read_b64_tr_b16 a[26:27], v25 offset:50208
v_mfma_f32_16x16x32_bf16 v[108:111], a[76:79], a[44:47], v[108:111]
ds_read_b128 a[16:19], v24 offset:38912
s_add_u32 m0, s55, 18432
v_mfma_f32_16x16x32_bf16 v[112:115], a[76:79], a[48:51], v[112:115]
buffer_load_dwordx4 v21, s[16:19], s52 offen sc1 lds
v_mfma_f32_16x16x32_bf16 v[116:119], a[76:79], a[52:55], v[116:119]
ds_read_b64_tr_b16 a[28:29], v25 offset:50688
v_mfma_f32_16x16x32_bf16 v[120:123], a[76:79], a[56:59], v[120:123]
ds_read_b64_tr_b16 a[30:31], v25 offset:51200
v_mfma_f32_16x16x32_bf16 v[124:127], a[44:47], a[80:83], v[124:127]
ds_read_b64_tr_b16 a[32:33], v25 offset:50720
v_mfma_f32_16x16x32_bf16 v[128:131], a[48:51], a[80:83], v[128:131]
buffer_load_dwordx4 v21, s[16:19], s52 offen offset:1024 sc1 lds
v_mfma_f32_16x16x32_bf16 v[132:135], a[52:55], a[80:83], v[132:135]
ds_read_b64_tr_b16 a[34:35], v25 offset:51232
v_mfma_f32_16x16x32_bf16 v[136:139], a[56:59], a[80:83], v[136:139]
ds_read_b64_tr_b16 a[36:37], v25 offset:51712
v_mfma_f32_16x16x32_bf16 v[156:159], a[60:63], a[80:83], v[156:159]
ds_read_b64_tr_b16 a[38:39], v25 offset:52224
v_mfma_f32_16x16x32_bf16 v[140:143], a[44:47], a[84:87], v[140:143]
buffer_load_dword v22, s[16:19], s52 offen offset:2048 sc1 lds
v_mfma_f32_16x16x32_bf16 v[144:147], a[48:51], a[84:87], v[144:147]
ds_read_b64_tr_b16 a[40:41], v25 offset:51744
s_add_u32 s52, s52, 0x20000
v_mfma_f32_16x16x32_bf16 v[148:151], a[52:55], a[84:87], v[148:151]
ds_read_b64_tr_b16 a[42:43], v25 offset:52256
v_mfma_f32_16x16x32_bf16 v[152:155], a[56:59], a[84:87], v[152:155]
s_add_u32 s15, s15, 1
v_mfma_f32_16x16x32_bf16 v[160:163], a[60:63], a[84:87], v[160:163]
s_cbranch_scc0 .Lk51
s_waitcnt vmcnt(19) lgkmcnt(6)
s_barrier
v_mfma_f32_16x16x32_bf16 v[60:63], a[20:23], a[0:3], v[60:63]
ds_read_b128 a[44:47], v23 offset:46080
s_add_u32 m0, s56, 104832
v_mfma_f32_16x16x32_bf16 v[64:67], a[20:23], a[4:7], v[64:67]
buffer_load_dwordx4 v18, s[20:23], s54 offen lds
v_mfma_f32_16x16x32_bf16 v[68:71], a[20:23], a[8:11], v[68:71]
ds_read_b128 a[48:51], v23 offset:47104
v_add_f32 v164, v164, v168
v_mfma_f32_16x16x32_bf16 v[72:75], a[20:23], a[12:15], v[72:75]
ds_read_b128 a[52:55], v23 offset:48384
v_mfma_f32_16x16x32_bf16 v[76:79], a[24:27], a[0:3], v[76:79]
ds_read_b128 a[56:59], v23 offset:49408
v_mfma_f32_16x16x32_bf16 v[80:83], a[24:27], a[4:7], v[80:83]
buffer_load_dwordx4 v19, s[20:23], s54 offen offset:1024 lds
v_mfma_f32_16x16x32_bf16 v[84:87], a[24:27], a[8:11], v[84:87]
ds_read_b64_tr_b16 a[64:65], v25 offset:62080
v_mfma_f32_16x16x32_bf16 v[88:91], a[24:27], a[12:15], v[88:91]
ds_read_b64_tr_b16 a[66:67], v25 offset:62592
v_add_f32 v165, v165, v169
v_mfma_f32_16x16x32_bf16 v[92:95], a[28:31], a[0:3], v[92:95]
ds_read_b64_tr_b16 a[68:69], v25 offset:62112
v_mfma_f32_16x16x32_bf16 v[96:99], a[28:31], a[4:7], v[96:99]
buffer_load_dwordx4 v20, s[20:23], s54 offen offset:2048 lds
v_mfma_f32_16x16x32_bf16 v[100:103], a[28:31], a[8:11], v[100:103]
s_add_u32 s54, s54, 196608
s_waitcnt lgkmcnt(7)
v_mfma_f32_16x16x32_bf16 v[104:107], a[28:31], a[12:15], v[104:107]
ds_read_b64_tr_b16 a[70:71], v25 offset:62624
v_mfma_f32_16x16x32_bf16 v[108:111], a[32:35], a[0:3], v[108:111]
ds_read_b128 a[60:63], v24 offset:48128
s_add_u32 m0, s55, 27648
v_mfma_f32_16x16x32_bf16 v[112:115], a[32:35], a[4:7], v[112:115]
buffer_load_dwordx4 v21, s[16:19], s52 offen sc1 lds
v_mfma_f32_16x16x32_bf16 v[116:119], a[32:35], a[8:11], v[116:119]
ds_read_b64_tr_b16 a[72:73], v25 offset:63104
v_add_f32 v166, v166, v170
v_mfma_f32_16x16x32_bf16 v[120:123], a[32:35], a[12:15], v[120:123]
ds_read_b64_tr_b16 a[74:75], v25 offset:63616
v_mfma_f32_16x16x32_bf16 v[124:127], a[0:3], a[36:39], v[124:127]
ds_read_b64_tr_b16 a[76:77], v25 offset:63136
v_mfma_f32_16x16x32_bf16 v[128:131], a[4:7], a[36:39], v[128:131]
buffer_load_dwordx4 v21, s[16:19], s52 offen offset:1024 sc1 lds
v_mfma_f32_16x16x32_bf16 v[132:135], a[8:11], a[36:39], v[132:135]
ds_read_b64_tr_b16 a[78:79], v25 offset:63648
v_mfma_f32_16x16x32_bf16 v[136:139], a[12:15], a[36:39], v[136:139]
ds_read_b64_tr_b16 a[80:81], v25 offset:64128
v_add_f32 v167, v167, v171
v_mfma_f32_16x16x32_bf16 v[156:159], a[16:19], a[36:39], v[156:159]
ds_read_b64_tr_b16 a[82:83], v25 offset:64640
v_mfma_f32_16x16x32_bf16 v[140:143], a[0:3], a[40:43], v[140:143]
buffer_load_dword v22, s[16:19], s52 offen offset:2048 sc1 lds
v_mfma_f32_16x16x32_bf16 v[144:147], a[4:7], a[40:43], v[144:147]
ds_read_b64_tr_b16 a[84:85], v25 offset:64160
s_add_u32 s52, s52, 0x20000
v_mfma_f32_16x16x32_bf16 v[148:151], a[8:11], a[40:43], v[148:151]
ds_read_b64_tr_b16 a[86:87], v25 offset:64672
v_mfma_f32_16x16x32_bf16 v[152:155], a[12:15], a[40:43], v[152:155]
v_mfma_f32_16x16x32_bf16 v[160:163], a[16:19], a[40:43], v[160:163]
s_waitcnt vmcnt(19) lgkmcnt(6)
s_barrier
v_mfma_f32_16x16x32_bf16 v[60:63], a[64:67], a[44:47], v[60:63]
ds_read_b128 a[0:3], v23
s_add_u32 m0, s56, 117248
v_mfma_f32_16x16x32_bf16 v[64:67], a[64:67], a[48:51], v[64:67]
buffer_load_dwordx4 v18, s[20:23], s54 offen lds
v_mfma_f32_16x16x32_bf16 v[68:71], a[64:67], a[52:55], v[68:71]
ds_read_b128 a[4:7], v23 offset:1024
v_mfma_f32_16x16x32_bf16 v[72:75], a[64:67], a[56:59], v[72:75]
ds_read_b128 a[8:11], v23 offset:2304
v_mfma_f32_16x16x32_bf16 v[76:79], a[68:71], a[44:47], v[76:79]
ds_read_b128 a[12:15], v23 offset:3328
v_mfma_f32_16x16x32_bf16 v[80:83], a[68:71], a[48:51], v[80:83]
buffer_load_dwordx4 v19, s[20:23], s54 offen offset:1024 lds
v_mfma_f32_16x16x32_bf16 v[84:87], a[68:71], a[52:55], v[84:87]
ds_read_b64_tr_b16 a[20:21], v25
v_mfma_f32_16x16x32_bf16 v[88:91], a[68:71], a[56:59], v[88:91]
ds_read_b64_tr_b16 a[22:23], v25 offset:512
v_mfma_f32_16x16x32_bf16 v[92:95], a[72:75], a[44:47], v[92:95]
ds_read_b64_tr_b16 a[24:25], v25 offset:32
v_mfma_f32_16x16x32_bf16 v[96:99], a[72:75], a[48:51], v[96:99]
buffer_load_dwordx4 v20, s[20:23], s54 offen offset:2048 lds
v_mfma_f32_16x16x32_bf16 v[100:103], a[72:75], a[52:55], v[100:103]
s_add_u32 s54, s54, 196608
s_waitcnt lgkmcnt(7)
v_mfma_f32_16x16x32_bf16 v[104:107], a[72:75], a[56:59], v[104:107]
ds_read_b64_tr_b16 a[26:27], v25 offset:544
v_mfma_f32_16x16x32_bf16 v[108:111], a[76:79], a[44:47], v[108:111]
ds_read_b128 a[16:19], v24 offset:2048
s_add_u32 m0, s55, 36864
v_mfma_f32_16x16x32_bf16 v[112:115], a[76:79], a[48:51], v[112:115]
buffer_load_dwordx4 v21, s[16:19], s52 offen sc1 lds
v_mfma_f32_16x16x32_bf16 v[116:119], a[76:79], a[52:55], v[116:119]
ds_read_b64_tr_b16 a[28:29], v25 offset:1024
v_mfma_f32_16x16x32_bf16 v[120:123], a[76:79], a[56:59], v[120:123]
ds_read_b64_tr_b16 a[30:31], v25 offset:1536
v_mfma_f32_16x16x32_bf16 v[124:127], a[44:47], a[80:83], v[124:127]
ds_read_b64_tr_b16 a[32:33], v25 offset:1056
v_mfma_f32_16x16x32_bf16 v[128:131], a[48:51], a[80:83], v[128:131]
buffer_load_dwordx4 v21, s[16:19], s52 offen offset:1024 sc1 lds
v_mfma_f32_16x16x32_bf16 v[132:135], a[52:55], a[80:83], v[132:135]
ds_read_b64_tr_b16 a[34:35], v25 offset:1568
v_mfma_f32_16x16x32_bf16 v[136:139], a[56:59], a[80:83], v[136:139]
ds_read_b64_tr_b16 a[36:37], v25 offset:2048
v_mfma_f32_16x16x32_bf16 v[156:159], a[60:63], a[80:83], v[156:159]
ds_read_b64_tr_b16 a[38:39], v25 offset:2560
v_mfma_f32_16x16x32_bf16 v[140:143], a[44:47], a[84:87], v[140:143]
buffer_load_dword v22, s[16:19], s52 offen offset:2048 sc1 lds
v_mfma_f32_16x16x32_bf16 v[144:147], a[48:51], a[84:87], v[144:147]
ds_read_b64_tr_b16 a[40:41], v25 offset:2080
s_add_u32 s52, s52, 0x20000
v_mfma_f32_16x16x32_bf16 v[148:151], a[52:55], a[84:87], v[148:151]
ds_read_b64_tr_b16 a[42:43], v25 offset:2592
v_mfma_f32_16x16x32_bf16 v[152:155], a[56:59], a[84:87], v[152:155]
v_mfma_f32_16x16x32_bf16 v[160:163], a[60:63], a[84:87], v[160:163]
s_waitcnt vmcnt(19) lgkmcnt(6)
s_barrier
v_mfma_f32_16x16x32_bf16 v[60:63], a[20:23], a[0:3], v[60:63]
ds_read_b128 a[44:47], v23 offset:9216
s_add_u32 m0, s56, 129664
v_mfma_f32_16x16x32_bf16 v[64:67], a[20:23], a[4:7], v[64:67]
buffer_load_dwordx4 v18, s[20:23], s54 offen lds
v_mfma_f32_16x16x32_bf16 v[68:71], a[20:23], a[8:11], v[68:71]
ds_read_b128 a[48:51], v23 offset:10240
s_waitcnt vmcnt(19)
v_add_f32 v164, v164, v172
v_mfma_f32_16x16x32_bf16 v[72:75], a[20:23], a[12:15], v[72:75]
ds_read_b128 a[52:55], v23 offset:11520
v_mfma_f32_16x16x32_bf16 v[76:79], a[24:27], a[0:3], v[76:79]
ds_read_b128 a[56:59], v23 offset:12544
v_mfma_f32_16x16x32_bf16 v[80:83], a[24:27], a[4:7], v[80:83]
buffer_load_dwordx4 v19, s[20:23], s54 offen offset:1024 lds
v_mfma_f32_16x16x32_bf16 v[84:87], a[24:27], a[8:11], v[84:87]
ds_read_b64_tr_b16 a[64:65], v25 offset:12416
v_mfma_f32_16x16x32_bf16 v[88:91], a[24:27], a[12:15], v[88:91]
ds_read_b64_tr_b16 a[66:67], v25 offset:12928
v_add_f32 v165, v165, v173
v_mfma_f32_16x16x32_bf16 v[92:95], a[28:31], a[0:3], v[92:95]
ds_read_b64_tr_b16 a[68:69], v25 offset:12448
v_mfma_f32_16x16x32_bf16 v[96:99], a[28:31], a[4:7], v[96:99]
buffer_load_dwordx4 v20, s[20:23], s54 offen offset:2048 lds
v_mfma_f32_16x16x32_bf16 v[100:103], a[28:31], a[8:11], v[100:103]
s_add_u32 s54, s54, 196608
s_waitcnt lgkmcnt(7)
v_mfma_f32_16x16x32_bf16 v[104:107], a[28:31], a[12:15], v[104:107]
ds_read_b64_tr_b16 a[70:71], v25 offset:12960
v_mfma_f32_16x16x32_bf16 v[108:111], a[32:35], a[0:3], v[108:111]
ds_read_b128 a[60:63], v24 offset:11264
s_add_u32 m0, s55, 46080
v_mfma_f32_16x16x32_bf16 v[112:115], a[32:35], a[4:7], v[112:115]
buffer_load_dwordx4 v21, s[16:19], s52 offen sc1 lds
v_mfma_f32_16x16x32_bf16 v[116:119], a[32:35], a[8:11], v[116:119]
ds_read_b64_tr_b16 a[72:73], v25 offset:13440
v_add_f32 v166, v166, v174
v_mfma_f32_16x16x32_bf16 v[120:123], a[32:35], a[12:15], v[120:123]
ds_read_b64_tr_b16 a[74:75], v25 offset:13952
v_mfma_f32_16x16x32_bf16 v[124:127], a[0:3], a[36:39], v[124:127]
ds_read_b64_tr_b16 a[76:77], v25 offset:13472
v_mfma_f32_16x16x32_bf16 v[128:131], a[4:7], a[36:39], v[128:131]
.Lpad24:
s_cbranch_execz .Lnopoll46r
buffer_load_dwordx4 v21, s[16:19], s52 offen offset:1024 sc1 lds
v_mfma_f32_16x16x32_bf16 v[132:135], a[8:11], a[36:39], v[132:135]
ds_read_b64_tr_b16 a[78:79], v25 offset:13984
v_mfma_f32_16x16x32_bf16 v[136:139], a[12:15], a[36:39], v[136:139]
ds_read_b64_tr_b16 a[80:81], v25 offset:14464
v_add_f32 v167, v167, v175
v_mfma_f32_16x16x32_bf16 v[156:159], a[16:19], a[36:39], v[156:159]
ds_read_b64_tr_b16 a[82:83], v25 offset:14976
v_mfma_f32_16x16x32_bf16 v[140:143], a[0:3], a[40:43], v[140:143]
buffer_load_dword v22, s[16:19], s52 offen offset:2048 sc1 lds
v_mfma_f32_16x16x32_bf16 v[144:147], a[4:7], a[40:43], v[144:147]
ds_read_b64_tr_b16 a[84:85], v25 offset:14496
s_add_u32 s52, s52, 0x20000
v_mfma_f32_16x16x32_bf16 v[148:151], a[8:11], a[40:43], v[148:151]
ds_read_b64_tr_b16 a[86:87], v25 offset:15008
v_mfma_f32_16x16x32_bf16 v[152:155], a[12:15], a[40:43], v[152:155]
v_mfma_f32_16x16x32_bf16 v[160:163], a[16:19], a[40:43], v[160:163]
s_waitcnt vmcnt(18) lgkmcnt(6)
s_barrier
v_mfma_f32_16x16x32_bf16 v[60:63], a[64:67], a[44:47], v[60:63]
ds_read_b128 a[0:3], v23 offset:18432
s_add_u32 m0, s59, 0
s_mov_b32 s58, 1048576
v_mfma_f32_16x16x32_bf16 v[64:67], a[64:67], a[48:51], v[64:67]
buffer_load_dwordx4 v5, s[24:27], s58 offen lds
v_mfma_f32_16x16x32_bf16 v[68:71], a[64:67], a[52:55], v[68:71]
ds_read_b128 a[4:7], v23 offset:19456
v_permlane32_swap_b32 v164, v166
v_mfma_f32_16x16x32_bf16 v[72:75], a[64:67], a[56:59], v[72:75]
ds_read_b128 a[8:11], v23 offset:20736
v_mfma_f32_16x16x32_bf16 v[76:79], a[68:71], a[44:47], v[76:79]
ds_read_b128 a[12:15], v23 offset:21760
v_permlane32_swap_b32 v165, v167
v_mfma_f32_16x16x32_bf16 v[80:83], a[68:71], a[48:51], v[80:83]
buffer_load_dwordx4 v6, s[24:27], s58 offen offset:1024 lds
v_mfma_f32_16x16x32_bf16 v[84:87], a[68:71], a[52:55], v[84:87]
ds_read_b64_tr_b16 a[20:21], v25 offset:24832
v_mfma_f32_16x16x32_bf16 v[88:91], a[68:71], a[56:59], v[88:91]
ds_read_b64_tr_b16 a[22:23], v25 offset:25344
v_add_f32 v164, v164, v166
v_mfma_f32_16x16x32_bf16 v[92:95], a[72:75], a[44:47], v[92:95]
s_add_u32 m0, s59, 58240
s_mov_b32 s58, 1966080
v_mfma_f32_16x16x32_bf16 v[96:99], a[72:75], a[48:51], v[96:99]
buffer_load_dwordx4 v5, s[24:27], s58 offen lds
v_mfma_f32_16x16x32_bf16 v[100:103], a[72:75], a[52:55], v[100:103]
ds_read_b64_tr_b16 a[24:25], v25 offset:24864
s_waitcnt lgkmcnt(7)
v_mfma_f32_16x16x32_bf16 v[104:107], a[72:75], a[56:59], v[104:107]
ds_read_b64_tr_b16 a[26:27], v25 offset:25376
v_add_f32 v165, v165, v167
v_mfma_f32_16x16x32_bf16 v[108:111], a[76:79], a[44:47], v[108:111]
ds_read_b128 a[16:19], v24 offset:20480
v_mfma_f32_16x16x32_bf16 v[112:115], a[76:79], a[48:51], v[112:115]
buffer_load_dwordx4 v6, s[24:27], s58 offen offset:1024 lds
v_mfma_f32_16x16x32_bf16 v[116:119], a[76:79], a[52:55], v[116:119]
ds_read_b64_tr_b16 a[28:29], v25 offset:25856
v_mul_f32 v164, 0xba800000, v164
v_mfma_f32_16x16x32_bf16 v[120:123], a[76:79], a[56:59], v[120:123]
ds_read_b64_tr_b16 a[30:31], v25 offset:26368
v_mfma_f32_16x16x32_bf16 v[124:127], a[44:47], a[80:83], v[124:127]
s_add_u32 m0, s59, 66560
s_mov_b32 s58, 0
v_mul_f32 v165, 0x3a800000, v165
v_mfma_f32_16x16x32_bf16 v[128:131], a[48:51], a[80:83], v[128:131]
buffer_load_dwordx4 v5, s[24:27], s58 offen lds
v_mfma_f32_16x16x32_bf16 v[132:135], a[52:55], a[80:83], v[132:135]
ds_read_b64_tr_b16 a[32:33], v25 offset:25888
v_mfma_f32_16x16x32_bf16 v[136:139], a[56:59], a[80:83], v[136:139]
ds_read_b64_tr_b16 a[34:35], v25 offset:26400
v_fma_f32 v165, -v164, v164, v165
v_mfma_f32_16x16x32_bf16 v[156:159], a[60:63], a[80:83], v[156:159]
ds_read_b64_tr_b16 a[36:37], v25 offset:26880
v_mfma_f32_16x16x32_bf16 v[140:143], a[44:47], a[84:87], v[140:143]
buffer_load_dwordx4 v6, s[24:27], s58 offen offset:1024 lds
v_mfma_f32_16x16x32_bf16 v[144:147], a[48:51], a[84:87], v[144:147]
ds_read_b64_tr_b16 a[38:39], v25 offset:27392
v_max_f32 v165, 0, v165
v_mfma_f32_16x16x32_bf16 v[148:151], a[52:55], a[84:87], v[148:151]
ds_read_b64_tr_b16 a[40:41], v25 offset:26912
v_mfma_f32_16x16x32_bf16 v[152:155], a[56:59], a[84:87], v[152:155]
ds_read_b64_tr_b16 a[42:43], v25 offset:27424
v_mfma_f32_16x16x32_bf16 v[160:163], a[60:63], a[84:87], v[160:163]
s_waitcnt vmcnt(18) lgkmcnt(6)
s_barrier
v_mfma_f32_16x16x32_bf16 v[60:63], a[20:23], a[0:3], v[60:63]
ds_read_b128 a[44:47], v23 offset:27648
s_add_u32 m0, s59, 8320
s_mov_b32 s58, 1179648
v_mfma_f32_16x16x32_bf16 v[64:67], a[20:23], a[4:7], v[64:67]
buffer_load_dwordx4 v5, s[24:27], s58 offen lds
v_mfma_f32_16x16x32_bf16 v[68:71], a[20:23], a[8:11], v[68:71]
ds_read_b128 a[48:51], v23 offset:28672
v_add_f32 v165, 0x3727c5ac, v165
v_mfma_f32_16x16x32_bf16 v[72:75], a[20:23], a[12:15], v[72:75]
ds_read_b128 a[52:55], v23 offset:29952
v_mfma_f32_16x16x32_bf16 v[76:79], a[24:27], a[0:3], v[76:79]
ds_read_b128 a[56:59], v23 offset:30976
v_mfma_f32_16x16x32_bf16 v[80:83], a[24:27], a[4:7], v[80:83]
buffer_load_dwordx4 v6, s[24:27], s58 offen offset:1024 lds
v_mfma_f32_16x16x32_bf16 v[84:87], a[24:27], a[8:11], v[84:87]
ds_read_b64_tr_b16 a[64:65], v25 offset:37248
v_mfma_f32_16x16x32_bf16 v[88:91], a[24:27], a[12:15], v[88:91]
ds_read_b64_tr_b16 a[66:67], v25 offset:37760
v_rsq_f32 v166, v165
v_mfma_f32_16x16x32_bf16 v[92:95], a[28:31], a[0:3], v[92:95]
s_add_u32 m0, s59, 74880
s_mov_b32 s58, 131072
v_mfma_f32_16x16x32_bf16 v[96:99], a[28:31], a[4:7], v[96:99]
buffer_load_dwordx4 v5, s[24:27], s58 offen lds
v_mfma_f32_16x16x32_bf16 v[100:103], a[28:31], a[8:11], v[100:103]
ds_read_b64_tr_b16 a[68:69], v25 offset:37280
s_waitcnt lgkmcnt(7)
v_mfma_f32_16x16x32_bf16 v[104:107], a[28:31], a[12:15], v[104:107]
ds_read_b64_tr_b16 a[70:71], v25 offset:37792
v_mfma_f32_16x16x32_bf16 v[108:111], a[32:35], a[0:3], v[108:111]
ds_read_b128 a[60:63], v24 offset:29696
v_mfma_f32_16x16x32_bf16 v[112:115], a[32:35], a[4:7], v[112:115]
buffer_load_dwordx4 v6, s[24:27], s58 offen offset:1024 lds
v_mfma_f32_16x16x32_bf16 v[116:119], a[32:35], a[8:11], v[116:119]
ds_read_b64_tr_b16 a[72:73], v25 offset:38272
v_mov_b32 v165, v166
v_mfma_f32_16x16x32_bf16 v[120:123], a[32:35], a[12:15], v[120:123]
ds_read_b64_tr_b16 a[74:75], v25 offset:38784
v_mfma_f32_16x16x32_bf16 v[124:127], a[0:3], a[36:39], v[124:127]
s_add_u32 m0, s59, 83200
s_mov_b32 s58, 262144
v_mfma_f32_16x16x32_bf16 v[128:131], a[4:7], a[36:39], v[128:131]
buffer_load_dwordx4 v5, s[24:27], s58 offen lds
v_mfma_f32_16x16x32_bf16 v[132:135], a[8:11], a[36:39], v[132:135]
ds_read_b64_tr_b16 a[76:77], v25 offset:38304
v_mfma_f32_16x16x32_bf16 v[136:139], a[12:15], a[36:39], v[136:139]
ds_read_b64_tr_b16 a[78:79], v25 offset:38816
v_mul_f32 v166, 0x3e8293ee, v166
v_mfma_f32_16x16x32_bf16 v[156:159], a[16:19], a[36:39], v[156:159]
ds_read_b64_tr_b16 a[80:81], v25 offset:39296
v_mfma_f32_16x16x32_bf16 v[140:143], a[0:3], a[40:43], v[140:143]
buffer_load_dwordx4 v6, s[24:27], s58 offen offset:1024 lds
v_mfma_f32_16x16x32_bf16 v[144:147], a[4:7], a[40:43], v[144:147]
ds_read_b64_tr_b16 a[82:83], v25 offset:39808
v_mfma_f32_16x16x32_bf16 v[148:151], a[8:11], a[40:43], v[148:151]
ds_read_b64_tr_b16 a[84:85], v25 offset:39328
v_mfma_f32_16x16x32_bf16 v[152:155], a[12:15], a[40:43], v[152:155]
ds_read_b64_tr_b16 a[86:87], v25 offset:39840
v_mfma_f32_16x16x32_bf16 v[160:163], a[16:19], a[40:43], v[160:163]
s_waitcnt vmcnt(18) lgkmcnt(6)
s_barrier
v_mfma_f32_16x16x32_bf16 v[60:63], a[64:67], a[44:47], v[60:63]
s_add_u32 m0, s59, 16640
s_mov_b32 s58, 1310720
ds_write_b128 v7, v[164:167]
v_mfma_f32_16x16x32_bf16 v[64:67], a[64:67], a[48:51], v[64:67]
buffer_load_dwordx4 v5, s[24:27], s58 offen lds
v_mfma_f32_16x16x32_bf16 v[68:71], a[64:67], a[52:55], v[68:71]
ds_read_b128 a[0:3], v23 offset:36864
v_mfma_f32_16x16x32_bf16 v[72:75], a[64:67], a[56:59], v[72:75]
ds_read_b128 a[4:7], v23 offset:37888
v_mfma_f32_16x16x32_bf16 v[76:79], a[68:71], a[44:47], v[76:79]
ds_read_b128 a[8:11], v23 offset:39168
v_mfma_f32_16x16x32_bf16 v[80:83], a[68:71], a[48:51], v[80:83]
ds_read_b128 a[12:15], v23 offset:40192
v_mfma_f32_16x16x32_bf16 v[84:87], a[68:71], a[52:55], v[84:87]
ds_read_b64_tr_b16 a[20:21], v25 offset:49664
v_mfma_f32_16x16x32_bf16 v[88:91], a[68:71], a[56:59], v[88:91]
buffer_load_dwordx4 v6, s[24:27], s58 offen offset:1024 lds
v_mfma_f32_16x16x32_bf16 v[92:95], a[72:75], a[44:47], v[92:95]
ds_read_b64_tr_b16 a[22:23], v25 offset:50176
v_mfma_f32_16x16x32_bf16 v[96:99], a[72:75], a[48:51], v[96:99]
ds_read_b64_tr_b16 a[24:25], v25 offset:49696
ds_write_b32 v17, v164
v_mfma_f32_16x16x32_bf16 v[100:103], a[72:75], a[52:55], v[100:103]
ds_read_b64_tr_b16 a[26:27], v25 offset:50208
s_waitcnt lgkmcnt(10)
v_mfma_f32_16x16x32_bf16 v[104:107], a[72:75], a[56:59], v[104:107]
ds_read_b128 a[16:19], v24 offset:38912
v_mfma_f32_16x16x32_bf16 v[108:111], a[76:79], a[44:47], v[108:111]
s_add_u32 m0, s59, 91520
s_mov_b32 s58, 393216
v_mfma_f32_16x16x32_bf16 v[112:115], a[76:79], a[48:51], v[112:115]
buffer_load_dwordx4 v5, s[24:27], s58 offen lds
v_mfma_f32_16x16x32_bf16 v[116:119], a[76:79], a[52:55], v[116:119]
v_mfma_f32_16x16x32_bf16 v[120:123], a[76:79], a[56:59], v[120:123]
ds_read_b64_tr_b16 a[28:29], v25 offset:50688
v_mfma_f32_16x16x32_bf16 v[124:127], a[44:47], a[80:83], v[124:127]
ds_read_b64_tr_b16 a[30:31], v25 offset:51200
v_mfma_f32_16x16x32_bf16 v[128:131], a[48:51], a[80:83], v[128:131]
ds_read_b64_tr_b16 a[32:33], v25 offset:50720
ds_write_b32 v17, v165 offset:1024
v_mfma_f32_16x16x32_bf16 v[132:135], a[52:55], a[80:83], v[132:135]
ds_read_b64_tr_b16 a[34:35], v25 offset:51232
v_mfma_f32_16x16x32_bf16 v[136:139], a[56:59], a[80:83], v[136:139]
buffer_load_dwordx4 v6, s[24:27], s58 offen offset:1024 lds
v_mfma_f32_16x16x32_bf16 v[156:159], a[60:63], a[80:83], v[156:159]
ds_read_b64_tr_b16 a[36:37], v25 offset:51712
v_mfma_f32_16x16x32_bf16 v[140:143], a[44:47], a[84:87], v[140:143]
ds_read_b64_tr_b16 a[38:39], v25 offset:52224
v_mfma_f32_16x16x32_bf16 v[144:147], a[48:51], a[84:87], v[144:147]
ds_read_b64_tr_b16 a[40:41], v25 offset:51744
v_mfma_f32_16x16x32_bf16 v[148:151], a[52:55], a[84:87], v[148:151]
ds_read_b64_tr_b16 a[42:43], v25 offset:52256
v_mfma_f32_16x16x32_bf16 v[152:155], a[56:59], a[84:87], v[152:155]
v_mfma_f32_16x16x32_bf16 v[160:163], a[60:63], a[84:87], v[160:163]
s_waitcnt vmcnt(16) lgkmcnt(7)
s_barrier
v_mfma_f32_16x16x32_bf16 v[60:63], a[20:23], a[0:3], v[60:63]
ds_read_b128 a[44:47], v23 offset:46080
s_add_u32 m0, s59, 24960
s_mov_b32 s58, 1441792
v_mfma_f32_16x16x32_bf16 v[64:67], a[20:23], a[4:7], v[64:67]
buffer_load_dwordx4 v5, s[24:27], s58 offen lds
v_mfma_f32_16x16x32_bf16 v[68:71], a[20:23], a[8:11], v[68:71]
ds_read_b128 a[48:51], v23 offset:47104
v_mfma_f32_16x16x32_bf16 v[72:75], a[20:23], a[12:15], v[72:75]
ds_read_b128 a[52:55], v23 offset:48384
v_mfma_f32_16x16x32_bf16 v[76:79], a[24:27], a[0:3], v[76:79]
ds_read_b128 a[56:59], v23 offset:49408
v_mfma_f32_16x16x32_bf16 v[80:83], a[24:27], a[4:7], v[80:83]
buffer_load_dwordx4 v6, s[24:27], s58 offen offset:1024 lds
v_mfma_f32_16x16x32_bf16 v[84:87], a[24:27], a[8:11], v[84:87]
ds_read_b64_tr_b16 a[64:65], v25 offset:62080
v_mfma_f32_16x16x32_bf16 v[88:91], a[24:27], a[12:15], v[88:91]
ds_read_b64_tr_b16 a[66:67], v25 offset:62592
v_mfma_f32_16x16x32_bf16 v[92:95], a[28:31], a[0:3], v[92:95]
s_add_u32 m0, s59, 99840
s_mov_b32 s58, 524288
v_mfma_f32_16x16x32_bf16 v[96:99], a[28:31], a[4:7], v[96:99]
buffer_load_dwordx4 v5, s[24:27], s58 offen lds
v_mfma_f32_16x16x32_bf16 v[100:103], a[28:31], a[8:11], v[100:103]
ds_read_b64_tr_b16 a[68:69], v25 offset:62112
s_waitcnt lgkmcnt(7)
v_mfma_f32_16x16x32_bf16 v[104:107], a[28:31], a[12:15], v[104:107]
ds_read_b64_tr_b16 a[70:71], v25 offset:62624
v_mfma_f32_16x16x32_bf16 v[108:111], a[32:35], a[0:3], v[108:111]
ds_read_b128 a[60:63], v24 offset:48128
v_mfma_f32_16x16x32_bf16 v[112:115], a[32:35], a[4:7], v[112:115]
buffer_load_dwordx4 v6, s[24:27], s58 offen offset:1024 lds
v_mfma_f32_16x16x32_bf16 v[116:119], a[32:35], a[8:11], v[116:119]
ds_read_b64_tr_b16 a[72:73], v25 offset:63104
v_mfma_f32_16x16x32_bf16 v[120:123], a[32:35], a[12:15], v[120:123]
ds_read_b64_tr_b16 a[74:75], v25 offset:63616
v_mfma_f32_16x16x32_bf16 v[124:127], a[0:3], a[36:39], v[124:127]
s_add_u32 m0, s59, 108160
s_mov_b32 s58, 655360
v_mfma_f32_16x16x32_bf16 v[128:131], a[4:7], a[36:39], v[128:131]
buffer_load_dwordx4 v5, s[24:27], s58 offen lds
v_mfma_f32_16x16x32_bf16 v[132:135], a[8:11], a[36:39], v[132:135]
ds_read_b64_tr_b16 a[76:77], v25 offset:63136
v_mfma_f32_16x16x32_bf16 v[136:139], a[12:15], a[36:39], v[136:139]
ds_read_b64_tr_b16 a[78:79], v25 offset:63648
v_mfma_f32_16x16x32_bf16 v[156:159], a[16:19], a[36:39], v[156:159]
ds_read_b64_tr_b16 a[80:81], v25 offset:64128
v_mfma_f32_16x16x32_bf16 v[140:143], a[0:3], a[40:43], v[140:143]
buffer_load_dwordx4 v6, s[24:27], s58 offen offset:1024 lds
v_mfma_f32_16x16x32_bf16 v[144:147], a[4:7], a[40:43], v[144:147]
ds_read_b64_tr_b16 a[82:83], v25 offset:64640
v_mfma_f32_16x16x32_bf16 v[148:151], a[8:11], a[40:43], v[148:151]
ds_read_b64_tr_b16 a[84:85], v25 offset:64160
v_mfma_f32_16x16x32_bf16 v[152:155], a[12:15], a[40:43], v[152:155]
ds_read_b64_tr_b16 a[86:87], v25 offset:64672
v_mfma_f32_16x16x32_bf16 v[160:163], a[16:19], a[40:43], v[160:163]
s_waitcnt lgkmcnt(0)
s_barrier
v_mfma_f32_16x16x32_bf16 v[156:159], a[60:63], a[80:83], v[156:159]
ds_read_b128 v[232:235], v10 offset:1792
s_add_u32 m0, s59, 33280
v_mfma_f32_16x16x32_bf16 v[160:163], a[60:63], a[84:87], v[160:163]
ds_read_b128 v[228:231], v10 offset:1536
s_mov_b32 s58, 1572864
v_mfma_f32_16x16x32_bf16 v[104:107], a[72:75], a[56:59], v[104:107]
ds_read_b128 v[224:227], v10 offset:1280
v_mfma_f32_16x16x32_bf16 v[120:123], a[76:79], a[56:59], v[120:123]
ds_read_b128 v[220:223], v10 offset:1024
v_mfma_f32_16x16x32_bf16 v[136:139], a[56:59], a[80:83], v[136:139]
ds_read_b128 v[240:243], v11 offset:704
v_mfma_f32_16x16x32_bf16 v[152:155], a[56:59], a[84:87], v[152:155]
ds_read_b128 v[244:247], v11 offset:1728
v_mfma_f32_16x16x32_bf16 v[100:103], a[72:75], a[52:55], v[100:103]
buffer_load_dwordx4 v5, s[24:27], s58 offen lds
v_mfma_f32_16x16x32_bf16 v[116:119], a[76:79], a[52:55], v[116:119]
ds_read_b128 v[18:21], v11 offset:448
v_mfma_f32_16x16x32_bf16 v[96:99], a[72:75], a[48:51], v[96:99]
ds_read_b128 v[22:25], v11 offset:1472
s_waitcnt lgkmcnt(7)
v_pk_fma_f32 v[104:105], v[36:37], v[232:233], v[104:105] op_sel_hi:[1,0,1]
v_pk_mul_f32 v[104:105], v[104:105], v[232:233] op_sel:[0,1] op_sel_hi:[1,1]
v_pk_fma_f32 v[106:107], v[38:39], v[232:233], v[106:107] op_sel_hi:[1,0,1]
v_pk_mul_f32 v[106:107], v[106:107], v[232:233] op_sel:[0,1] op_sel_hi:[1,1]
v_pk_fma_f32 v[120:121], v[40:41], v[232:233], v[120:121] op_sel_hi:[1,0,1]
v_pk_mul_f32 v[120:121], v[120:121], v[232:233] op_sel:[0,1] op_sel_hi:[1,1]
v_pk_fma_f32 v[122:123], v[42:43], v[232:233], v[122:123] op_sel_hi:[1,0,1]
v_pk_mul_f32 v[122:123], v[122:123], v[232:233] op_sel:[0,1] op_sel_hi:[1,1]
s_waitcnt lgkmcnt(6)
v_pk_fma_f32 v[100:101], v[36:37], v[228:229], v[100:101] op_sel_hi:[1,0,1]
v_pk_mul_f32 v[100:101], v[100:101], v[228:229] op_sel:[0,1] op_sel_hi:[1,1]
s_waitcnt lgkmcnt(3)
v_pk_fma_f32 v[156:157], v[240:241], v[44:45], v[156:157] op_sel_hi:[1,0,1]
v_pk_fma_f32 v[158:159], v[242:243], v[44:45], v[158:159] op_sel_hi:[1,0,1]
v_pk_fma_f32 v[160:161], v[240:241], v[44:45], v[160:161] op_sel:[0,1,0] op_sel_hi:[1,1,1]
v_pk_fma_f32 v[162:163], v[242:243], v[44:45], v[162:163] op_sel:[0,1,0] op_sel_hi:[1,1,1]
s_waitcnt lgkmcnt(2)
v_pk_mul_f32 v[156:157], v[156:157], v[244:245]
v_pk_mul_f32 v[158:159], v[158:159], v[246:247]
v_pk_mul_f32 v[160:161], v[160:161], v[244:245]
v_pk_mul_f32 v[162:163], v[162:163], v[246:247]
v_pk_fma_f32 v[102:103], v[38:39], v[228:229], v[102:103] op_sel_hi:[1,0,1]
v_pk_mul_f32 v[102:103], v[102:103], v[228:229] op_sel:[0,1] op_sel_hi:[1,1]
v_pk_fma_f32 v[116:117], v[40:41], v[228:229], v[116:117] op_sel_hi:[1,0,1]
v_pk_mul_f32 v[116:117], v[116:117], v[228:229] op_sel:[0,1] op_sel_hi:[1,1]
s_waitcnt lgkmcnt(1)
v_pk_fma_f32 v[136:137], v[18:19], v[44:45], v[136:137] op_sel_hi:[1,0,1]
v_pk_fma_f32 v[138:139], v[20:21], v[44:45], v[138:139] op_sel_hi:[1,0,1]
v_pk_fma_f32 v[152:153], v[18:19], v[44:45], v[152:153] op_sel:[0,1,0] op_sel_hi:[1,1,1]
v_pk_fma_f32 v[154:155], v[20:21], v[44:45], v[154:155] op_sel:[0,1,0] op_sel_hi:[1,1,1]
s_waitcnt lgkmcnt(0)
v_pk_mul_f32 v[136:137], v[136:137], v[22:23]
v_pk_mul_f32 v[138:139], v[138:139], v[24:25]
v_pk_mul_f32 v[152:153], v[152:153], v[22:23]
v_pk_mul_f32 v[154:155], v[154:155], v[24:25]
v_pk_fma_f32 v[118:119], v[42:43], v[228:229], v[118:119] op_sel_hi:[1,0,1]
v_pk_mul_f32 v[118:119], v[118:119], v[228:229] op_sel:[0,1] op_sel_hi:[1,1]
v_pk_fma_f32 v[96:97], v[36:37], v[224:225], v[96:97] op_sel_hi:[1,0,1]
v_pk_mul_f32 v[96:97], v[96:97], v[224:225] op_sel:[0,1] op_sel_hi:[1,1]
v_pk_fma_f32 v[98:99], v[38:39], v[224:225], v[98:99] op_sel_hi:[1,0,1]
v_pk_mul_f32 v[98:99], v[98:99], v[224:225] op_sel:[0,1] op_sel_hi:[1,1]
v_cvt_pk_bf16_f32 v236, v156, v157
v_cvt_pk_bf16_f32 v237, v158, v159
v_mfma_f32_16x16x32_bf16 v[112:115], a[76:79], a[48:51], v[112:115]
buffer_load_dwordx4 v6, s[24:27], s58 offen offset:1024 lds
v_mfma_f32_16x16x32_bf16 v[92:95], a[72:75], a[44:47], v[92:95]
s_add_u32 m0, s59, 41600
v_cvt_pk_bf16_f32 v238, v160, v161
v_cvt_pk_bf16_f32 v239, v162, v163
v_mfma_f32_16x16x32_bf16 v[108:111], a[76:79], a[44:47], v[108:111]
ds_write_b128 v8, v[236:239] offset:1024
s_mov_b32 s58, 1703936
v_mfma_f32_16x16x32_bf16 v[72:75], a[64:67], a[56:59], v[72:75]
ds_read_b128 v[240:243], v11 offset:384
v_cvt_pk_bf16_f32 v196, v104, v105
v_mfma_f32_16x16x32_bf16 v[88:91], a[68:71], a[56:59], v[88:91]
buffer_load_dwordx4 v5, s[24:27], s58 offen lds
v_cvt_pk_bf16_f32 v197, v106, v107
v_cvt_pk_bf16_f32 v198, v120, v121
v_cvt_pk_bf16_f32 v199, v122, v123
s_nop 0
v_pk_fma_f32 v[72:73], v[28:29], v[232:233], v[72:73] op_sel_hi:[1,0,1]
v_pk_fma_f32 v[74:75], v[30:31], v[232:233], v[74:75] op_sel_hi:[1,0,1]
s_nop 0
v_pk_fma_f32 v[88:89], v[32:33], v[232:233], v[88:89] op_sel_hi:[1,0,1]
v_pk_fma_f32 v[90:91], v[34:35], v[232:233], v[90:91] op_sel_hi:[1,0,1]
v_pk_fma_f32 v[112:113], v[40:41], v[224:225], v[112:113] op_sel_hi:[1,0,1]
v_pk_mul_f32 v[112:113], v[112:113], v[224:225] op_sel:[0,1] op_sel_hi:[1,1]
v_pk_fma_f32 v[114:115], v[42:43], v[224:225], v[114:115] op_sel_hi:[1,0,1]
v_pk_mul_f32 v[114:115], v[114:115], v[224:225] op_sel:[0,1] op_sel_hi:[1,1]
v_pk_fma_f32 v[92:93], v[36:37], v[220:221], v[92:93] op_sel_hi:[1,0,1]
v_pk_mul_f32 v[92:93], v[92:93], v[220:221] op_sel:[0,1] op_sel_hi:[1,1]
v_pk_fma_f32 v[94:95], v[38:39], v[220:221], v[94:95] op_sel_hi:[1,0,1]
v_pk_mul_f32 v[94:95], v[94:95], v[220:221] op_sel:[0,1] op_sel_hi:[1,1]
v_pk_fma_f32 v[108:109], v[40:41], v[220:221], v[108:109] op_sel_hi:[1,0,1]
v_pk_mul_f32 v[108:109], v[108:109], v[220:221] op_sel:[0,1] op_sel_hi:[1,1]
v_pk_fma_f32 v[110:111], v[42:43], v[220:221], v[110:111] op_sel_hi:[1,0,1]
v_pk_mul_f32 v[110:111], v[110:111], v[220:221] op_sel:[0,1] op_sel_hi:[1,1]
v_cvt_pk_bf16_f32 v208, v136, v137
v_cvt_pk_bf16_f32 v209, v138, v139
v_mfma_f32_16x16x32_bf16 v[132:135], a[52:55], a[80:83], v[132:135]
s_waitcnt lgkmcnt(1)
s_barrier
ds_read_b128 v[180:183], v9
v_mfma_f32_16x16x32_bf16 v[148:151], a[52:55], a[84:87], v[148:151]
ds_read_b64 v[200:201], v9 offset:1024
v_cvt_pk_bf16_f32 v218, v152, v153
v_mfma_f32_16x16x32_bf16 v[68:71], a[64:67], a[52:55], v[68:71]
ds_read_b64 v[210:211], v9 offset:1032
v_cvt_pk_bf16_f32 v219, v154, v155
v_mfma_f32_16x16x32_bf16 v[84:87], a[68:71], a[52:55], v[84:87]
buffer_load_dwordx4 v6, s[24:27], s58 offen offset:1024 lds
v_mfma_f32_16x16x32_bf16 v[128:131], a[48:51], a[80:83], v[128:131]
s_add_u32 m0, s59, 49920
s_mov_b32 s58, 1835008
v_cvt_pk_bf16_f32 v192, v100, v101
v_cvt_pk_bf16_f32 v193, v102, v103
v_cvt_pk_bf16_f32 v194, v116, v117
v_cvt_pk_bf16_f32 v195, v118, v119
s_waitcnt lgkmcnt(3)
v_pk_fma_f32 v[132:133], v[240:241], v[44:45], v[132:133] op_sel_hi:[1,0,1]
v_pk_fma_f32 v[134:135], v[242:243], v[44:45], v[134:135] op_sel_hi:[1,0,1]
v_pk_fma_f32 v[148:149], v[240:241], v[44:45], v[148:149] op_sel:[0,1,0] op_sel_hi:[1,1,1]
v_pk_fma_f32 v[150:151], v[242:243], v[44:45], v[150:151] op_sel:[0,1,0] op_sel_hi:[1,1,1]
v_pk_fma_f32 v[68:69], v[28:29], v[228:229], v[68:69] op_sel_hi:[1,0,1]
v_pk_fma_f32 v[70:71], v[30:31], v[228:229], v[70:71] op_sel_hi:[1,0,1]
v_pk_fma_f32 v[84:85], v[32:33], v[228:229], v[84:85] op_sel_hi:[1,0,1]
v_pk_fma_f32 v[86:87], v[34:35], v[228:229], v[86:87] op_sel_hi:[1,0,1]
v_cvt_pk_bf16_f32 v176, v72, v73
v_cvt_pk_bf16_f32 v177, v74, v75
v_mfma_f32_16x16x32_bf16 v[144:147], a[48:51], a[84:87], v[144:147]
buffer_load_dwordx4 v5, s[24:27], s58 offen lds
v_mfma_f32_16x16x32_bf16 v[64:67], a[64:67], a[48:51], v[64:67]
ds_read_b128 v[244:247], v11 offset:1408
v_cvt_pk_bf16_f32 v178, v88, v89
v_mfma_f32_16x16x32_bf16 v[80:83], a[68:71], a[48:51], v[80:83]
ds_read_b128 v[18:21], v11 offset:320
v_cvt_pk_bf16_f32 v179, v90, v91
v_mfma_f32_16x16x32_bf16 v[124:127], a[44:47], a[80:83], v[124:127]
ds_read_b128 v[22:25], v11 offset:1344
v_cvt_pk_bf16_f32 v188, v96, v97
v_mfma_f32_16x16x32_bf16 v[140:143], a[44:47], a[84:87], v[140:143]
buffer_load_dwordx4 v6, s[24:27], s58 offen offset:1024 lds
v_mfma_f32_16x16x32_bf16 v[60:63], a[64:67], a[44:47], v[60:63]
s_add_u32 m0, s59, 116480
s_mov_b32 s58, 786432
v_cvt_pk_bf16_f32 v189, v98, v99
v_mfma_f32_16x16x32_bf16 v[76:79], a[68:71], a[44:47], v[76:79]
ds_read_b128 v[240:243], v11 offset:256
v_cvt_pk_bf16_f32 v190, v112, v113
v_mfma_f32_16x16x32_bf16 v[104:107], v[192:195], v[176:179], v[46:49]
v_cvt_pk_bf16_f32 v191, v114, v115
v_cvt_pk_bf16_f32 v172, v68, v69
v_cvt_pk_bf16_f32 v173, v70, v71
v_cvt_pk_bf16_f32 v174, v84, v85
v_cvt_pk_bf16_f32 v175, v86, v87
v_pk_fma_f32 v[64:65], v[28:29], v[224:225], v[64:65] op_sel_hi:[1,0,1]
v_pk_fma_f32 v[66:67], v[30:31], v[224:225], v[66:67] op_sel_hi:[1,0,1]
s_waitcnt lgkmcnt(3)
v_pk_mul_f32 v[132:133], v[132:133], v[244:245]
v_pk_mul_f32 v[134:135], v[134:135], v[246:247]
v_pk_mul_f32 v[148:149], v[148:149], v[244:245]
v_pk_mul_f32 v[150:151], v[150:151], v[246:247]
s_waitcnt lgkmcnt(2)
v_pk_fma_f32 v[128:129], v[18:19], v[44:45], v[128:129] op_sel_hi:[1,0,1]
v_pk_fma_f32 v[130:131], v[20:21], v[44:45], v[130:131] op_sel_hi:[1,0,1]
v_pk_fma_f32 v[144:145], v[18:19], v[44:45], v[144:145] op_sel:[0,1,0] op_sel_hi:[1,1,1]
v_pk_fma_f32 v[146:147], v[20:21], v[44:45], v[146:147] op_sel:[0,1,0] op_sel_hi:[1,1,1]
s_waitcnt lgkmcnt(1)
v_pk_mul_f32 v[128:129], v[128:129], v[22:23]
v_pk_mul_f32 v[130:131], v[130:131], v[24:25]
v_pk_mul_f32 v[144:145], v[144:145], v[22:23]
v_pk_mul_f32 v[146:147], v[146:147], v[24:25]
v_pk_fma_f32 v[80:81], v[32:33], v[224:225], v[80:81] op_sel_hi:[1,0,1]
v_pk_fma_f32 v[82:83], v[34:35], v[224:225], v[82:83] op_sel_hi:[1,0,1]
v_pk_fma_f32 v[60:61], v[28:29], v[220:221], v[60:61] op_sel_hi:[1,0,1]
v_pk_fma_f32 v[62:63], v[30:31], v[220:221], v[62:63] op_sel_hi:[1,0,1]
v_pk_fma_f32 v[76:77], v[32:33], v[220:221], v[76:77] op_sel_hi:[1,0,1]
v_pk_fma_f32 v[78:79], v[34:35], v[220:221], v[78:79] op_sel_hi:[1,0,1]
v_cvt_pk_bf16_f32 v206, v132, v133
v_cvt_pk_bf16_f32 v207, v134, v135
v_mfma_f32_16x16x32_bf16 v[120:123], v[196:199], v[176:179], v[50:53]
buffer_load_dwordx4 v5, s[24:27], s58 offen lds
v_mfma_f32_16x16x32_bf16 v[100:103], v[188:191], v[172:175], v[46:49]
ds_read_b128 v[244:247], v11 offset:1280
v_cvt_pk_bf16_f32 v216, v148, v149
v_mfma_f32_16x16x32_bf16 v[116:119], v[192:195], v[172:175], v[50:53]
v_cvt_pk_bf16_f32 v217, v150, v151
v_max3_f32 v88, v104, v105, v106
s_nop 0
v_max3_f32 v89, v107, v120, v121
v_max3_f32 v88, v88, v122, v123
v_max_f32 v90, v88, v89
v_max_f32 v89, v88, v89
v_cvt_pk_bf16_f32 v204, v128, v129
buffer_load_dwordx4 v6, s[24:27], s58 offen offset:1024 lds
s_add_u32 m0, s59, 124800
s_mov_b32 s58, 917504
v_permlane16_swap_b32 v90, v89
v_cvt_pk_bf16_f32 v205, v130, v131
v_max_f32 v88, v90, v89
v_max_f32 v89, v90, v89
v_cvt_pk_bf16_f32 v214, v144, v145
v_cvt_pk_bf16_f32 v215, v146, v147
v_permlane32_swap_b32 v88, v89
v_max3_f32 v84, v100, v101, v102
v_max_f32 v88, v88, v89
buffer_load_dwordx4 v5, s[24:27], s58 offen lds
v_mul_f32 v88, v88, v234
v_pk_fma_f32 v[104:105], v[104:105], v[234:235], v[88:89] op_sel_hi:[1,0,0] neg_lo:[0,0,1] neg_hi:[0,0,1]
v_pk_fma_f32 v[106:107], v[106:107], v[234:235], v[88:89] op_sel_hi:[1,0,0] neg_lo:[0,0,1] neg_hi:[0,0,1]
v_pk_fma_f32 v[120:121], v[120:121], v[234:235], v[88:89] op_sel_hi:[1,0,0] neg_lo:[0,0,1] neg_hi:[0,0,1]
v_pk_fma_f32 v[122:123], v[122:123], v[234:235], v[88:89] op_sel_hi:[1,0,0] neg_lo:[0,0,1] neg_hi:[0,0,1]
v_exp_f32 v104, v104
v_exp_f32 v105, v105
v_exp_f32 v106, v106
v_exp_f32 v107, v107
v_exp_f32 v120, v120
v_exp_f32 v121, v121
v_exp_f32 v122, v122
v_exp_f32 v123, v123
v_cvt_pk_bf16_f32 v72, v104, v105
buffer_load_dwordx4 v6, s[24:27], s58 offen offset:1024 lds
v_cvt_pk_bf16_f32 v73, v106, v107
v_cvt_pk_bf16_f32 v74, v120, v121
v_cvt_pk_bf16_f32 v75, v122, v123
s_waitcnt lgkmcnt(1)
v_pk_fma_f32 v[124:125], v[240:241], v[44:45], v[124:125] op_sel_hi:[1,0,1]
s_waitcnt lgkmcnt(0)
v_pk_mul_f32 v[124:125], v[124:125], v[244:245]
v_pk_fma_f32 v[126:127], v[242:243], v[44:45], v[126:127] op_sel_hi:[1,0,1]
v_pk_mul_f32 v[126:127], v[126:127], v[246:247]
v_pk_fma_f32 v[140:141], v[240:241], v[44:45], v[140:141] op_sel:[0,1,0] op_sel_hi:[1,1,1]
v_pk_mul_f32 v[140:141], v[140:141], v[244:245]
v_pk_fma_f32 v[142:143], v[242:243], v[44:45], v[142:143] op_sel:[0,1,0] op_sel_hi:[1,1,1]
v_pk_mul_f32 v[142:143], v[142:143], v[246:247]
v_max3_f32 v85, v103, v116, v117
v_max3_f32 v84, v84, v118, v119
v_mfma_f32_16x16x32_bf16 v[88:91], v[248:251], v[72:75], 0
v_max_f32 v86, v84, v85
v_max_f32 v85, v84, v85
v_mfma_f32_16x16x32_bf16 v[104:107], v[206:209], v[72:75], 0
s_nop 0
v_permlane16_swap_b32 v86, v85
v_mfma_f32_16x16x32_bf16 v[120:123], v[216:219], v[72:75], 0
s_nop 1
v_rcp_f32 v88, v88
v_max_f32 v84, v86, v85
v_max_f32 v85, v86, v85
v_cvt_pk_bf16_f32 v184, v92, v93
v_pk_mul_f32 v[104:105], v[104:105], v[88:89] op_sel_hi:[1,0]
v_pk_mul_f32 v[106:107], v[106:107], v[88:89] op_sel_hi:[1,0]
v_pk_mul_f32 v[120:121], v[120:121], v[88:89] op_sel_hi:[1,0]
v_pk_mul_f32 v[122:123], v[122:123], v[88:89] op_sel_hi:[1,0]
v_cvt_pk_bf16_f32 v176, v104, v105
v_cvt_pk_bf16_f32 v177, v106, v107
v_cvt_pk_bf16_f32 v178, v120, v121
v_cvt_pk_bf16_f32 v179, v122, v123
buffer_store_dwordx4 v[176:179], v4, s[16:19], s74 offen offset:3072 sc1
v_permlane32_swap_b32 v84, v85
v_cvt_pk_bf16_f32 v185, v94, v95
v_max_f32 v84, v84, v85
v_mul_f32 v84, v84, v230
v_pk_fma_f32 v[100:101], v[100:101], v[230:231], v[84:85] op_sel_hi:[1,0,0] neg_lo:[0,0,1] neg_hi:[0,0,1]
v_pk_fma_f32 v[102:103], v[102:103], v[230:231], v[84:85] op_sel_hi:[1,0,0] neg_lo:[0,0,1] neg_hi:[0,0,1]
v_pk_fma_f32 v[116:117], v[116:117], v[230:231], v[84:85] op_sel_hi:[1,0,0] neg_lo:[0,0,1] neg_hi:[0,0,1]
v_pk_fma_f32 v[118:119], v[118:119], v[230:231], v[84:85] op_sel_hi:[1,0,0] neg_lo:[0,0,1] neg_hi:[0,0,1]
v_exp_f32 v100, v100
v_exp_f32 v101, v101
v_exp_f32 v102, v102
v_exp_f32 v103, v103
v_exp_f32 v116, v116
v_exp_f32 v117, v117
v_exp_f32 v118, v118
v_exp_f32 v119, v119
v_cvt_pk_bf16_f32 v68, v100, v101
v_cvt_pk_bf16_f32 v69, v102, v103
v_cvt_pk_bf16_f32 v70, v116, v117
v_cvt_pk_bf16_f32 v71, v118, v119
v_cvt_pk_bf16_f32 v186, v108, v109
v_cvt_pk_bf16_f32 v187, v110, v111
v_mfma_f32_16x16x32_bf16 v[84:87], v[248:251], v[68:71], 0
v_cvt_pk_bf16_f32 v168, v64, v65
v_cvt_pk_bf16_f32 v169, v66, v67
v_mfma_f32_16x16x32_bf16 v[100:103], v[204:207], v[68:71], 0
v_cvt_pk_bf16_f32 v170, v80, v81
v_cvt_pk_bf16_f32 v171, v82, v83
.Lpad25:
s_cbranch_execz .Lnopoll46r
v_mfma_f32_16x16x32_bf16 v[116:119], v[214:217], v[68:71], 0
s_nop 1
v_rcp_f32 v84, v84
v_mfma_f32_16x16x32_bf16 v[96:99], v[184:187], v[168:171], v[46:49]
v_cvt_pk_bf16_f32 v202, v124, v125
v_cvt_pk_bf16_f32 v203, v126, v127
v_mfma_f32_16x16x32_bf16 v[112:115], v[188:191], v[168:171], v[50:53]
v_cvt_pk_bf16_f32 v212, v140, v141
v_cvt_pk_bf16_f32 v213, v142, v143
v_cvt_pk_bf16_f32 v164, v60, v61
s_nop 1
v_max3_f32 v80, v96, v97, v98
v_cvt_pk_bf16_f32 v165, v62, v63
v_pk_mul_f32 v[100:101], v[100:101], v[84:85] op_sel_hi:[1,0]
v_pk_mul_f32 v[102:103], v[102:103], v[84:85] op_sel_hi:[1,0]
v_pk_mul_f32 v[116:117], v[116:117], v[84:85] op_sel_hi:[1,0]
v_pk_mul_f32 v[118:119], v[118:119], v[84:85] op_sel_hi:[1,0]
v_cvt_pk_bf16_f32 v172, v100, v101
v_cvt_pk_bf16_f32 v173, v102, v103
v_cvt_pk_bf16_f32 v174, v116, v117
v_cvt_pk_bf16_f32 v175, v118, v119
buffer_store_dwordx4 v[172:175], v4, s[16:19], s74 offen offset:2048 sc1
v_max3_f32 v81, v99, v112, v113
v_max3_f32 v80, v80, v114, v115
v_max_f32 v82, v80, v81
v_max_f32 v81, v80, v81
v_cvt_pk_bf16_f32 v166, v76, v77
v_cvt_pk_bf16_f32 v167, v78, v79
v_permlane16_swap_b32 v82, v81
s_nop 0
v_mfma_f32_16x16x32_bf16 v[92:95], v[180:183], v[164:167], v[46:49]
v_max_f32 v80, v82, v81
v_max_f32 v81, v82, v81
v_mfma_f32_16x16x32_bf16 v[108:111], v[184:187], v[164:167], v[50:53]
s_nop 0
v_permlane32_swap_b32 v80, v81
v_max_f32 v80, v80, v81
v_mul_f32 v80, v80, v226
v_pk_fma_f32 v[96:97], v[96:97], v[226:227], v[80:81] op_sel_hi:[1,0,0] neg_lo:[0,0,1] neg_hi:[0,0,1]
v_pk_fma_f32 v[98:99], v[98:99], v[226:227], v[80:81] op_sel_hi:[1,0,0] neg_lo:[0,0,1] neg_hi:[0,0,1]
v_pk_fma_f32 v[112:113], v[112:113], v[226:227], v[80:81] op_sel_hi:[1,0,0] neg_lo:[0,0,1] neg_hi:[0,0,1]
v_pk_fma_f32 v[114:115], v[114:115], v[226:227], v[80:81] op_sel_hi:[1,0,0] neg_lo:[0,0,1] neg_hi:[0,0,1]
v_exp_f32 v96, v96
v_exp_f32 v97, v97
v_exp_f32 v98, v98
v_exp_f32 v99, v99
v_exp_f32 v112, v112
v_exp_f32 v113, v113
v_exp_f32 v114, v114
v_exp_f32 v115, v115
v_cvt_pk_bf16_f32 v64, v96, v97
v_cvt_pk_bf16_f32 v65, v98, v99
v_cvt_pk_bf16_f32 v66, v112, v113
v_cvt_pk_bf16_f32 v67, v114, v115
v_max3_f32 v76, v92, v93, v94
v_max3_f32 v77, v95, v108, v109
v_mfma_f32_16x16x32_bf16 v[80:83], v[248:251], v[64:67], 0
v_max3_f32 v76, v76, v110, v111
v_max_f32 v78, v76, v77
v_mfma_f32_16x16x32_bf16 v[96:99], v[202:205], v[64:67], 0
v_max_f32 v77, v76, v77
v_mfma_f32_16x16x32_bf16 v[112:115], v[212:215], v[64:67], 0
s_nop 2
v_rcp_f32 v80, v80
v_permlane16_swap_b32 v78, v77
s_nop 0
v_pk_mul_f32 v[96:97], v[96:97], v[80:81] op_sel_hi:[1,0]
v_pk_mul_f32 v[98:99], v[98:99], v[80:81] op_sel_hi:[1,0]
v_pk_mul_f32 v[112:113], v[112:113], v[80:81] op_sel_hi:[1,0]
v_pk_mul_f32 v[114:115], v[114:115], v[80:81] op_sel_hi:[1,0]
v_cvt_pk_bf16_f32 v168, v96, v97
v_cvt_pk_bf16_f32 v169, v98, v99
v_cvt_pk_bf16_f32 v170, v112, v113
v_cvt_pk_bf16_f32 v171, v114, v115
buffer_store_dwordx4 v[168:171], v4, s[16:19], s74 offen offset:1024 sc1
v_max_f32 v76, v78, v77
v_max_f32 v77, v78, v77
s_nop 1
v_permlane32_swap_b32 v76, v77
v_max_f32 v76, v76, v77
v_mul_f32 v76, v76, v222
v_pk_fma_f32 v[92:93], v[92:93], v[222:223], v[76:77] op_sel_hi:[1,0,0] neg_lo:[0,0,1] neg_hi:[0,0,1]
v_pk_fma_f32 v[94:95], v[94:95], v[222:223], v[76:77] op_sel_hi:[1,0,0] neg_lo:[0,0,1] neg_hi:[0,0,1]
v_pk_fma_f32 v[108:109], v[108:109], v[222:223], v[76:77] op_sel_hi:[1,0,0] neg_lo:[0,0,1] neg_hi:[0,0,1]
v_pk_fma_f32 v[110:111], v[110:111], v[222:223], v[76:77] op_sel_hi:[1,0,0] neg_lo:[0,0,1] neg_hi:[0,0,1]
v_exp_f32 v92, v92
v_exp_f32 v93, v93
v_exp_f32 v94, v94
v_exp_f32 v95, v95
v_exp_f32 v108, v108
v_exp_f32 v109, v109
v_exp_f32 v110, v110
v_exp_f32 v111, v111
v_cvt_pk_bf16_f32 v60, v92, v93
v_cvt_pk_bf16_f32 v61, v94, v95
v_cvt_pk_bf16_f32 v62, v108, v109
v_cvt_pk_bf16_f32 v63, v110, v111
s_nop 1
v_mfma_f32_16x16x32_bf16 v[76:79], v[248:251], v[60:63], 0
v_mfma_f32_16x16x32_bf16 v[92:95], v[200:203], v[60:63], 0
v_mfma_f32_16x16x32_bf16 v[108:111], v[210:213], v[60:63], 0
s_nop 5
v_rcp_f32 v76, v76
s_nop 0
v_pk_mul_f32 v[92:93], v[92:93], v[76:77] op_sel_hi:[1,0]
v_pk_mul_f32 v[94:95], v[94:95], v[76:77] op_sel_hi:[1,0]
v_pk_mul_f32 v[108:109], v[108:109], v[76:77] op_sel_hi:[1,0]
v_pk_mul_f32 v[110:111], v[110:111], v[76:77] op_sel_hi:[1,0]
v_cvt_pk_bf16_f32 v164, v92, v93
v_cvt_pk_bf16_f32 v165, v94, v95
v_cvt_pk_bf16_f32 v166, v108, v109
v_cvt_pk_bf16_f32 v167, v110, v111
buffer_store_dwordx4 v[164:167], v4, s[16:19], s74 offen sc1
s_nop 1
.Lqkve49:
.Lpad26:
s_cbranch_execz .Lnopoll46r
s_lshl_b32 s62, s6, 13
s_lshl_b32 s63, s3, 11
s_add_u32 s62, s62, s63
v_lshl_add_u32 v4, v1, 4, s62
v_lshrrev_b32 v2, 3, v1
v_cmp_eq_u32 vcc, 3, v2
v_add_u32 v2, 67108480, v4
s_nop 0
v_cndmask_b32 v4, v4, v2, vcc
v_bfe_u32 v5, v1, 3, 1
v_lshrrev_b32 v2, 4, v1
v_lshl_add_u32 v5, v2, 3, v5
s_lshl_b32 s62, s3, 1
v_add_u32 v5, s62, v5
v_mul_u32_u24 v5, 2048, v5
v_and_b32 v2, 7, v1
v_lshl_add_u32 v5, v2, 4, v5
s_lshl_b32 s62, s7, 7
v_add_u32 v5, s62, v5
v_add_u32 v6, 64512, v5
v_bfe_u32 v8, v1, 3, 2
v_mul_u32_u24 v8, 2080, v8
v_bfe_u32 v2, v1, 2, 1
v_lshl_add_u32 v8, v2, 7, v8
v_bfe_u32 v2, v1, 5, 1
v_lshl_add_u32 v8, v2, 8, v8
v_and_b32 v2, 3, v1
v_lshl_add_u32 v8, v2, 3, v8
s_mov_b32 s57, 66560
v_add_u32 v7, s57, v8
s_mov_b32 s52, 37748736
s_mov_b32 s53, 37879808
s_mov_b32 s54, 2097152
s_mul_i32 s56, s3, 2080
v_accvgpr_read_b32 v32, a224
v_accvgpr_read_b32 v33, a225
v_accvgpr_read_b32 v34, a226
v_accvgpr_read_b32 v35, a227
v_accvgpr_read_b32 v36, a228
v_accvgpr_read_b32 v37, a229
v_accvgpr_read_b32 v38, a230
v_accvgpr_read_b32 v39, a231
v_accvgpr_read_b32 v40, a232
v_accvgpr_read_b32 v41, a233
v_accvgpr_read_b32 v42, a234
v_accvgpr_read_b32 v43, a235
v_accvgpr_read_b32 v44, a236
v_accvgpr_read_b32 v45, a237
v_accvgpr_read_b32 v46, a238
v_accvgpr_read_b32 v47, a239
v_accvgpr_read_b32 v48, a240
v_accvgpr_read_b32 v49, a241
v_accvgpr_read_b32 v50, a242
v_accvgpr_read_b32 v51, a243
v_accvgpr_read_b32 v52, a244
v_accvgpr_read_b32 v53, a245
v_accvgpr_read_b32 v54, a246
v_accvgpr_read_b32 v55, a247
v_accvgpr_read_b32 v56, a248
v_accvgpr_read_b32 v57, a249
v_accvgpr_read_b32 v58, a250
v_accvgpr_read_b32 v59, a251
v_accvgpr_read_b32 v60, a252
v_accvgpr_read_b32 v61, a253
v_accvgpr_read_b32 v62, a254
v_accvgpr_read_b32 v63, a255
s_and_b32 s62, s3, 1
s_mul_i32 s62, s62, 28672
s_add_u32 s62, s62, s51
v_lshrrev_b32 v12, 4, v1
v_mul_u32_u24 v12, 57344, v12
v_and_b32 v2, 15, v1
v_lshl_add_u32 v12, v2, 4, v12
v_add_u32 v12, s62, v12
v_add_u32 v13, 6112, v12
v_add_u32 v14, 12224, v12
v_add_u32 v15, 18336, v12
s_mul_i32 s59, s3, 4224
s_mov_b32 s58, 0
s_lshl_b32 s62, s8, 7
s_add_u32 s62, s62, 30418944
s_lshl_b32 s64, s6, 7
s_add_u32 s64, s64, 30418944
v_mov_b32 v252, s62
v_mov_b32 v253, s64
s_waitcnt vmcnt(0) lgkmcnt(0)
s_barrier
s_cmp_lg_u32 s3, 0
s_cbranch_scc1 .Lnosig52
v_mov_b32 v255, 1
s_mov_b64 exec, 1
buffer_atomic_add v255, v252, s[16:19], 0 offen
s_mov_b64 exec, -1
.Lnosig52:
s_cmp_lg_u32 s3, 1
s_cbranch_scc1 .Lnopoll55
s_mov_b64 exec, 1
s_mov_b32 s15, 0
s_mov_b64 exec, 1
v_mov_b32 v254, 0
buffer_atomic_add v254, v253, s[16:19], 0 offen sc0
.Lpoll53:
s_waitcnt vmcnt(0)
v_cmp_ne_u32 vcc, 16, v254
s_add_u32 s15, s15, 1
s_cbranch_vccz .Lnopoll55r
s_sleep 2
s_mov_b64 exec, 1
v_mov_b32 v254, 0
buffer_atomic_add v254, v253, s[16:19], 0 offen sc0
s_cmp_le_u32 s15, 100000
s_cbranch_scc1 .Lpoll53
.Lgot54:
s_waitcnt vmcnt(0)
s_branch .Lnopoll55r
.Lnopoll55:
s_mov_b64 exec, 0
s_cmp_eq_u32 s3, 2
s_cbranch_scc1 .Lpad27
s_cmp_eq_u32 s3, 3
s_cbranch_scc1 .Lpad28
s_branch .Lnopoll55r
.Lnopoll55r:
s_mov_b64 exec, -1
s_barrier
buffer_load_dwordx4 v[64:67], v4, s[16:19], s52 offen sc1
buffer_load_dwordx4 v[68:71], v4, s[16:19], s52 offen offset:1024 sc1
s_add_u32 s52, s52, 0x40000
buffer_load_dwordx4 v[72:75], v4, s[16:19], s53 offen sc1
buffer_load_dwordx4 v[76:79], v4, s[16:19], s53 offen offset:1024 sc1
s_add_u32 s53, s53, 0x40000
buffer_load_dwordx4 v[80:83], v4, s[16:19], s52 offen sc1
buffer_load_dwordx4 v[84:87], v4, s[16:19], s52 offen offset:1024 sc1
s_add_u32 s52, s52, 0x40000
buffer_load_dwordx4 v[88:91], v4, s[16:19], s53 offen sc1
buffer_load_dwordx4 v[92:95], v4, s[16:19], s53 offen offset:1024 sc1
s_add_u32 s53, s53, 0x40000
buffer_load_dwordx4 v[96:99], v4, s[16:19], s52 offen sc1
buffer_load_dwordx4 v[100:103], v4, s[16:19], s52 offen offset:1024 sc1
s_add_u32 s52, s52, 0x40000
buffer_load_dwordx4 v[104:107], v4, s[16:19], s53 offen sc1
buffer_load_dwordx4 v[108:111], v4, s[16:19], s53 offen offset:1024 sc1
s_add_u32 s53, s53, 0x40000
ds_read_b64_tr_b16 a[0:1], v7
ds_read_b64_tr_b16 a[2:3], v7 offset:512
ds_read_b64_tr_b16 a[4:5], v7 offset:32
ds_read_b64_tr_b16 a[6:7], v7 offset:544
ds_read_b64_tr_b16 a[8:9], v7 offset:64
ds_read_b64_tr_b16 a[10:11], v7 offset:576
ds_read_b64_tr_b16 a[12:13], v7 offset:96
ds_read_b64_tr_b16 a[14:15], v7 offset:608
ds_read_b64_tr_b16 a[16:17], v7 offset:1024
ds_read_b64_tr_b16 a[18:19], v7 offset:1536
ds_read_b64_tr_b16 a[20:21], v7 offset:1056
ds_read_b64_tr_b16 a[22:23], v7 offset:1568
ds_read_b64_tr_b16 a[24:25], v7 offset:1088
ds_read_b64_tr_b16 a[26:27], v7 offset:1600
ds_read_b64_tr_b16 a[28:29], v7 offset:1120
ds_read_b64_tr_b16 a[30:31], v7 offset:1632
s_waitcnt vmcnt(11) lgkmcnt(14)
v_mfma_f32_16x16x32_bf16 v[32:35], a[0:3], v[64:67], v[32:35]
ds_read_b64_tr_b16 a[32:33], v7 offset:8320
ds_read_b64_tr_b16 a[34:35], v7 offset:8832
s_waitcnt vmcnt(10)
v_mfma_f32_16x16x32_bf16 v[48:51], a[0:3], v[68:71], v[48:51]
buffer_load_dwordx4 v[112:115], v4, s[16:19], s52 offen sc1
s_waitcnt lgkmcnt(14)
v_mfma_f32_16x16x32_bf16 v[36:39], a[4:7], v[64:67], v[36:39]
ds_read_b64_tr_b16 a[36:37], v7 offset:8352
ds_read_b64_tr_b16 a[38:39], v7 offset:8864
v_mfma_f32_16x16x32_bf16 v[52:55], a[4:7], v[68:71], v[52:55]
ds_read_b64_tr_b16 a[40:41], v7 offset:8384
ds_read_b64_tr_b16 a[42:43], v7 offset:8896
s_waitcnt lgkmcnt(15)
v_mfma_f32_16x16x32_bf16 v[40:43], a[8:11], v[64:67], v[40:43]
buffer_load_dwordx4 v[116:119], v4, s[16:19], s52 offen offset:1024 sc1
v_mfma_f32_16x16x32_bf16 v[56:59], a[8:11], v[68:71], v[56:59]
ds_read_b64_tr_b16 a[44:45], v7 offset:8416
s_add_u32 s52, s52, 0x40000
s_waitcnt lgkmcnt(15)
v_mfma_f32_16x16x32_bf16 v[44:47], a[12:15], v[64:67], v[44:47]
ds_read_b64_tr_b16 a[46:47], v7 offset:8928
v_mfma_f32_16x16x32_bf16 v[60:63], a[12:15], v[68:71], v[60:63]
ds_read_b64_tr_b16 a[48:49], v7 offset:9344
ds_read_b64_tr_b16 a[50:51], v7 offset:9856
s_waitcnt vmcnt(11) lgkmcnt(15)
v_mfma_f32_16x16x32_bf16 v[32:35], a[16:19], v[72:75], v[32:35]
buffer_load_dwordx4 v[120:123], v4, s[16:19], s53 offen sc1
s_waitcnt vmcnt(11)
v_mfma_f32_16x16x32_bf16 v[48:51], a[16:19], v[76:79], v[48:51]
ds_read_b64_tr_b16 a[52:53], v7 offset:9376
ds_read_b64_tr_b16 a[54:55], v7 offset:9888
s_waitcnt lgkmcnt(15)
v_mfma_f32_16x16x32_bf16 v[36:39], a[20:23], v[72:75], v[36:39]
ds_read_b64_tr_b16 a[56:57], v7 offset:9408
ds_read_b64_tr_b16 a[58:59], v7 offset:9920
v_mfma_f32_16x16x32_bf16 v[52:55], a[20:23], v[76:79], v[52:55]
buffer_load_dwordx4 v[124:127], v4, s[16:19], s53 offen offset:1024 sc1
s_waitcnt lgkmcnt(15)
v_mfma_f32_16x16x32_bf16 v[40:43], a[24:27], v[72:75], v[40:43]
ds_read_b64_tr_b16 a[60:61], v7 offset:9440
s_add_u32 s53, s53, 0x40000
v_mfma_f32_16x16x32_bf16 v[56:59], a[24:27], v[76:79], v[56:59]
ds_read_b64_tr_b16 a[62:63], v7 offset:9952
s_waitcnt lgkmcnt(15)
v_mfma_f32_16x16x32_bf16 v[44:47], a[28:31], v[72:75], v[44:47]
v_mfma_f32_16x16x32_bf16 v[60:63], a[28:31], v[76:79], v[60:63]
s_waitcnt vmcnt(11) lgkmcnt(14)
v_mfma_f32_16x16x32_bf16 v[32:35], a[32:35], v[80:83], v[32:35]
ds_read_b64_tr_b16 a[0:1], v7 offset:16640
ds_read_b64_tr_b16 a[2:3], v7 offset:17152
s_waitcnt vmcnt(10)
v_mfma_f32_16x16x32_bf16 v[48:51], a[32:35], v[84:87], v[48:51]
buffer_load_dwordx4 v[64:67], v4, s[16:19], s52 offen sc1
s_waitcnt lgkmcnt(14)
v_mfma_f32_16x16x32_bf16 v[36:39], a[36:39], v[80:83], v[36:39]
ds_read_b64_tr_b16 a[4:5], v7 offset:16672
ds_read_b64_tr_b16 a[6:7], v7 offset:17184
v_mfma_f32_16x16x32_bf16 v[52:55], a[36:39], v[84:87], v[52:55]
ds_read_b64_tr_b16 a[8:9], v7 offset:16704
ds_read_b64_tr_b16 a[10:11], v7 offset:17216
s_waitcnt lgkmcnt(15)
v_mfma_f32_16x16x32_bf16 v[40:43], a[40:43], v[80:83], v[40:43]
buffer_load_dwordx4 v[68:71], v4, s[16:19], s52 offen offset:1024 sc1
v_mfma_f32_16x16x32_bf16 v[56:59], a[40:43], v[84:87], v[56:59]
ds_read_b64_tr_b16 a[12:13], v7 offset:16736
s_add_u32 s52, s52, 0x40000
s_waitcnt lgkmcnt(15)
v_mfma_f32_16x16x32_bf16 v[44:47], a[44:47], v[80:83], v[44:47]
ds_read_b64_tr_b16 a[14:15], v7 offset:17248
v_mfma_f32_16x16x32_bf16 v[60:63], a[44:47], v[84:87], v[60:63]
ds_read_b64_tr_b16 a[16:17], v7 offset:17664
ds_read_b64_tr_b16 a[18:19], v7 offset:18176
s_waitcnt vmcnt(11) lgkmcnt(15)
v_mfma_f32_16x16x32_bf16 v[32:35], a[48:51], v[88:91], v[32:35]
buffer_load_dwordx4 v[72:75], v4, s[16:19], s53 offen sc1
s_waitcnt vmcnt(11)
v_mfma_f32_16x16x32_bf16 v[48:51], a[48:51], v[92:95], v[48:51]
ds_read_b64_tr_b16 a[20:21], v7 offset:17696
ds_read_b64_tr_b16 a[22:23], v7 offset:18208
s_waitcnt lgkmcnt(15)
v_mfma_f32_16x16x32_bf16 v[36:39], a[52:55], v[88:91], v[36:39]
ds_read_b64_tr_b16 a[24:25], v7 offset:17728
ds_read_b64_tr_b16 a[26:27], v7 offset:18240
v_mfma_f32_16x16x32_bf16 v[52:55], a[52:55], v[92:95], v[52:55]
buffer_load_dwordx4 v[76:79], v4, s[16:19], s53 offen offset:1024 sc1
s_waitcnt lgkmcnt(15)
v_mfma_f32_16x16x32_bf16 v[40:43], a[56:59], v[88:91], v[40:43]
ds_read_b64_tr_b16 a[28:29], v7 offset:17760
s_add_u32 s53, s53, 0x40000
v_mfma_f32_16x16x32_bf16 v[56:59], a[56:59], v[92:95], v[56:59]
ds_read_b64_tr_b16 a[30:31], v7 offset:18272
s_waitcnt lgkmcnt(15)
v_mfma_f32_16x16x32_bf16 v[44:47], a[60:63], v[88:91], v[44:47]
v_mfma_f32_16x16x32_bf16 v[60:63], a[60:63], v[92:95], v[60:63]
s_waitcnt vmcnt(11) lgkmcnt(14)
v_mfma_f32_16x16x32_bf16 v[32:35], a[0:3], v[96:99], v[32:35]
ds_read_b64_tr_b16 a[32:33], v7 offset:24960
ds_read_b64_tr_b16 a[34:35], v7 offset:25472
s_waitcnt vmcnt(10)
v_mfma_f32_16x16x32_bf16 v[48:51], a[0:3], v[100:103], v[48:51]
buffer_load_dwordx4 v[80:83], v4, s[16:19], s52 offen sc1
s_waitcnt lgkmcnt(14)
v_mfma_f32_16x16x32_bf16 v[36:39], a[4:7], v[96:99], v[36:39]
ds_read_b64_tr_b16 a[36:37], v7 offset:24992
ds_read_b64_tr_b16 a[38:39], v7 offset:25504
v_mfma_f32_16x16x32_bf16 v[52:55], a[4:7], v[100:103], v[52:55]
ds_read_b64_tr_b16 a[40:41], v7 offset:25024
ds_read_b64_tr_b16 a[42:43], v7 offset:25536
s_waitcnt lgkmcnt(15)
v_mfma_f32_16x16x32_bf16 v[40:43], a[8:11], v[96:99], v[40:43]
buffer_load_dwordx4 v[84:87], v4, s[16:19], s52 offen offset:1024 sc1
v_mfma_f32_16x16x32_bf16 v[56:59], a[8:11], v[100:103], v[56:59]
ds_read_b64_tr_b16 a[44:45], v7 offset:25056
s_add_u32 s52, s52, 0x40000
s_waitcnt lgkmcnt(15)
v_mfma_f32_16x16x32_bf16 v[44:47], a[12:15], v[96:99], v[44:47]
ds_read_b64_tr_b16 a[46:47], v7 offset:25568
v_mfma_f32_16x16x32_bf16 v[60:63], a[12:15], v[100:103], v[60:63]
ds_read_b64_tr_b16 a[48:49], v7 offset:25984
ds_read_b64_tr_b16 a[50:51], v7 offset:26496
s_waitcnt vmcnt(11) lgkmcnt(15)
v_mfma_f32_16x16x32_bf16 v[32:35], a[16:19], v[104:107], v[32:35]
buffer_load_dwordx4 v[88:91], v4, s[16:19], s53 offen sc1
s_waitcnt vmcnt(11)
v_mfma_f32_16x16x32_bf16 v[48:51], a[16:19], v[108:111], v[48:51]
ds_read_b64_tr_b16 a[52:53], v7 offset:26016
ds_read_b64_tr_b16 a[54:55], v7 offset:26528
s_waitcnt lgkmcnt(15)
v_mfma_f32_16x16x32_bf16 v[36:39], a[20:23], v[104:107], v[36:39]
ds_read_b64_tr_b16 a[56:57], v7 offset:26048
ds_read_b64_tr_b16 a[58:59], v7 offset:26560
v_mfma_f32_16x16x32_bf16 v[52:55], a[20:23], v[108:111], v[52:55]
buffer_load_dwordx4 v[92:95], v4, s[16:19], s53 offen offset:1024 sc1
s_waitcnt lgkmcnt(15)
v_mfma_f32_16x16x32_bf16 v[40:43], a[24:27], v[104:107], v[40:43]
ds_read_b64_tr_b16 a[60:61], v7 offset:26080
s_add_u32 s53, s53, 0x40000
v_mfma_f32_16x16x32_bf16 v[56:59], a[24:27], v[108:111], v[56:59]
ds_read_b64_tr_b16 a[62:63], v7 offset:26592
s_waitcnt lgkmcnt(15)
v_mfma_f32_16x16x32_bf16 v[44:47], a[28:31], v[104:107], v[44:47]
v_mfma_f32_16x16x32_bf16 v[60:63], a[28:31], v[108:111], v[60:63]
s_waitcnt vmcnt(11) lgkmcnt(14)
v_mfma_f32_16x16x32_bf16 v[32:35], a[32:35], v[112:115], v[32:35]
ds_read_b64_tr_b16 a[0:1], v7 offset:33280
ds_read_b64_tr_b16 a[2:3], v7 offset:33792
s_waitcnt vmcnt(10)
v_mfma_f32_16x16x32_bf16 v[48:51], a[32:35], v[116:119], v[48:51]
buffer_load_dwordx4 v[96:99], v4, s[16:19], s52 offen sc1
s_waitcnt lgkmcnt(14)
v_mfma_f32_16x16x32_bf16 v[36:39], a[36:39], v[112:115], v[36:39]
ds_read_b64_tr_b16 a[4:5], v7 offset:33312
ds_read_b64_tr_b16 a[6:7], v7 offset:33824
v_mfma_f32_16x16x32_bf16 v[52:55], a[36:39], v[116:119], v[52:55]
ds_read_b64_tr_b16 a[8:9], v7 offset:33344
ds_read_b64_tr_b16 a[10:11], v7 offset:33856
s_waitcnt lgkmcnt(15)
v_mfma_f32_16x16x32_bf16 v[40:43], a[40:43], v[112:115], v[40:43]
buffer_load_dwordx4 v[100:103], v4, s[16:19], s52 offen offset:1024 sc1
v_mfma_f32_16x16x32_bf16 v[56:59], a[40:43], v[116:119], v[56:59]
ds_read_b64_tr_b16 a[12:13], v7 offset:33376
s_add_u32 s52, s52, 0x40000
s_waitcnt lgkmcnt(15)
v_mfma_f32_16x16x32_bf16 v[44:47], a[44:47], v[112:115], v[44:47]
ds_read_b64_tr_b16 a[14:15], v7 offset:33888
v_mfma_f32_16x16x32_bf16 v[60:63], a[44:47], v[116:119], v[60:63]
ds_read_b64_tr_b16 a[16:17], v7 offset:34304
ds_read_b64_tr_b16 a[18:19], v7 offset:34816
s_waitcnt vmcnt(11) lgkmcnt(15)
v_mfma_f32_16x16x32_bf16 v[32:35], a[48:51], v[120:123], v[32:35]
buffer_load_dwordx4 v[104:107], v4, s[16:19], s53 offen sc1
s_waitcnt vmcnt(11)
v_mfma_f32_16x16x32_bf16 v[48:51], a[48:51], v[124:127], v[48:51]
ds_read_b64_tr_b16 a[20:21], v7 offset:34336
ds_read_b64_tr_b16 a[22:23], v7 offset:34848
s_waitcnt lgkmcnt(15)
v_mfma_f32_16x16x32_bf16 v[36:39], a[52:55], v[120:123], v[36:39]
ds_read_b64_tr_b16 a[24:25], v7 offset:34368
ds_read_b64_tr_b16 a[26:27], v7 offset:34880
v_mfma_f32_16x16x32_bf16 v[52:55], a[52:55], v[124:127], v[52:55]
buffer_load_dwordx4 v[108:111], v4, s[16:19], s53 offen offset:1024 sc1
s_waitcnt lgkmcnt(15)
v_mfma_f32_16x16x32_bf16 v[40:43], a[56:59], v[120:123], v[40:43]
ds_read_b64_tr_b16 a[28:29], v7 offset:34400
s_add_u32 s53, s53, 0x40000
v_mfma_f32_16x16x32_bf16 v[56:59], a[56:59], v[124:127], v[56:59]
ds_read_b64_tr_b16 a[30:31], v7 offset:34912
s_waitcnt lgkmcnt(15)
v_mfma_f32_16x16x32_bf16 v[44:47], a[60:63], v[120:123], v[44:47]
v_mfma_f32_16x16x32_bf16 v[60:63], a[60:63], v[124:127], v[60:63]
s_waitcnt vmcnt(11) lgkmcnt(14)
v_mfma_f32_16x16x32_bf16 v[32:35], a[0:3], v[64:67], v[32:35]
ds_read_b64_tr_b16 a[32:33], v7 offset:41600
ds_read_b64_tr_b16 a[34:35], v7 offset:42112
s_waitcnt vmcnt(10)
v_mfma_f32_16x16x32_bf16 v[48:51], a[0:3], v[68:71], v[48:51]
buffer_load_dwordx4 v[112:115], v4, s[16:19], s52 offen sc1
s_waitcnt lgkmcnt(14)
v_mfma_f32_16x16x32_bf16 v[36:39], a[4:7], v[64:67], v[36:39]
ds_read_b64_tr_b16 a[36:37], v7 offset:41632
ds_read_b64_tr_b16 a[38:39], v7 offset:42144
v_mfma_f32_16x16x32_bf16 v[52:55], a[4:7], v[68:71], v[52:55]
ds_read_b64_tr_b16 a[40:41], v7 offset:41664
ds_read_b64_tr_b16 a[42:43], v7 offset:42176
s_waitcnt lgkmcnt(15)
v_mfma_f32_16x16x32_bf16 v[40:43], a[8:11], v[64:67], v[40:43]
buffer_load_dwordx4 v[116:119], v4, s[16:19], s52 offen offset:1024 sc1
v_mfma_f32_16x16x32_bf16 v[56:59], a[8:11], v[68:71], v[56:59]
ds_read_b64_tr_b16 a[44:45], v7 offset:41696
s_add_u32 s52, s52, 0x40000
s_waitcnt lgkmcnt(15)
v_mfma_f32_16x16x32_bf16 v[44:47], a[12:15], v[64:67], v[44:47]
ds_read_b64_tr_b16 a[46:47], v7 offset:42208
v_mfma_f32_16x16x32_bf16 v[60:63], a[12:15], v[68:71], v[60:63]
ds_read_b64_tr_b16 a[48:49], v7 offset:42624
ds_read_b64_tr_b16 a[50:51], v7 offset:43136
s_waitcnt vmcnt(11) lgkmcnt(15)
v_mfma_f32_16x16x32_bf16 v[32:35], a[16:19], v[72:75], v[32:35]
buffer_load_dwordx4 v[120:123], v4, s[16:19], s53 offen sc1
s_waitcnt vmcnt(11)
v_mfma_f32_16x16x32_bf16 v[48:51], a[16:19], v[76:79], v[48:51]
ds_read_b64_tr_b16 a[52:53], v7 offset:42656
ds_read_b64_tr_b16 a[54:55], v7 offset:43168
s_waitcnt lgkmcnt(15)
v_mfma_f32_16x16x32_bf16 v[36:39], a[20:23], v[72:75], v[36:39]
ds_read_b64_tr_b16 a[56:57], v7 offset:42688
ds_read_b64_tr_b16 a[58:59], v7 offset:43200
v_mfma_f32_16x16x32_bf16 v[52:55], a[20:23], v[76:79], v[52:55]
buffer_load_dwordx4 v[124:127], v4, s[16:19], s53 offen offset:1024 sc1
s_waitcnt lgkmcnt(15)
v_mfma_f32_16x16x32_bf16 v[40:43], a[24:27], v[72:75], v[40:43]
ds_read_b64_tr_b16 a[60:61], v7 offset:42720
s_add_u32 s53, s53, 0x40000
v_mfma_f32_16x16x32_bf16 v[56:59], a[24:27], v[76:79], v[56:59]
ds_read_b64_tr_b16 a[62:63], v7 offset:43232
s_waitcnt lgkmcnt(15)
v_mfma_f32_16x16x32_bf16 v[44:47], a[28:31], v[72:75], v[44:47]
v_mfma_f32_16x16x32_bf16 v[60:63], a[28:31], v[76:79], v[60:63]
s_waitcnt vmcnt(11) lgkmcnt(14)
v_mfma_f32_16x16x32_bf16 v[32:35], a[32:35], v[80:83], v[32:35]
ds_read_b64_tr_b16 a[0:1], v7 offset:49920
ds_read_b64_tr_b16 a[2:3], v7 offset:50432
s_waitcnt vmcnt(10)
v_mfma_f32_16x16x32_bf16 v[48:51], a[32:35], v[84:87], v[48:51]
buffer_load_dwordx4 v[64:67], v4, s[16:19], s52 offen sc1
s_waitcnt lgkmcnt(14)
v_mfma_f32_16x16x32_bf16 v[36:39], a[36:39], v[80:83], v[36:39]
ds_read_b64_tr_b16 a[4:5], v7 offset:49952
ds_read_b64_tr_b16 a[6:7], v7 offset:50464
v_mfma_f32_16x16x32_bf16 v[52:55], a[36:39], v[84:87], v[52:55]
ds_read_b64_tr_b16 a[8:9], v7 offset:49984
ds_read_b64_tr_b16 a[10:11], v7 offset:50496
s_waitcnt lgkmcnt(15)
v_mfma_f32_16x16x32_bf16 v[40:43], a[40:43], v[80:83], v[40:43]
buffer_load_dwordx4 v[68:71], v4, s[16:19], s52 offen offset:1024 sc1
v_mfma_f32_16x16x32_bf16 v[56:59], a[40:43], v[84:87], v[56:59]
ds_read_b64_tr_b16 a[12:13], v7 offset:50016
s_add_u32 s52, s52, 0x40000
s_waitcnt lgkmcnt(15)
v_mfma_f32_16x16x32_bf16 v[44:47], a[44:47], v[80:83], v[44:47]
ds_read_b64_tr_b16 a[14:15], v7 offset:50528
v_mfma_f32_16x16x32_bf16 v[60:63], a[44:47], v[84:87], v[60:63]
ds_read_b64_tr_b16 a[16:17], v7 offset:50944
ds_read_b64_tr_b16 a[18:19], v7 offset:51456
s_waitcnt vmcnt(11) lgkmcnt(15)
v_mfma_f32_16x16x32_bf16 v[32:35], a[48:51], v[88:91], v[32:35]
buffer_load_dwordx4 v[72:75], v4, s[16:19], s53 offen sc1
s_waitcnt vmcnt(11)
v_mfma_f32_16x16x32_bf16 v[48:51], a[48:51], v[92:95], v[48:51]
ds_read_b64_tr_b16 a[20:21], v7 offset:50976
ds_read_b64_tr_b16 a[22:23], v7 offset:51488
s_waitcnt lgkmcnt(15)
v_mfma_f32_16x16x32_bf16 v[36:39], a[52:55], v[88:91], v[36:39]
ds_read_b64_tr_b16 a[24:25], v7 offset:51008
ds_read_b64_tr_b16 a[26:27], v7 offset:51520
v_mfma_f32_16x16x32_bf16 v[52:55], a[52:55], v[92:95], v[52:55]
buffer_load_dwordx4 v[76:79], v4, s[16:19], s53 offen offset:1024 sc1
s_waitcnt lgkmcnt(15)
v_mfma_f32_16x16x32_bf16 v[40:43], a[56:59], v[88:91], v[40:43]
ds_read_b64_tr_b16 a[28:29], v7 offset:51040
s_add_u32 s53, s53, 0x40000
v_mfma_f32_16x16x32_bf16 v[56:59], a[56:59], v[92:95], v[56:59]
ds_read_b64_tr_b16 a[30:31], v7 offset:51552
s_waitcnt lgkmcnt(15)
v_mfma_f32_16x16x32_bf16 v[44:47], a[60:63], v[88:91], v[44:47]
v_mfma_f32_16x16x32_bf16 v[60:63], a[60:63], v[92:95], v[60:63]
s_waitcnt vmcnt(11) lgkmcnt(14)
v_mfma_f32_16x16x32_bf16 v[32:35], a[0:3], v[96:99], v[32:35]
ds_read_b64_tr_b16 a[32:33], v7 offset:58240
ds_read_b64_tr_b16 a[34:35], v7 offset:58752
s_waitcnt vmcnt(10)
v_mfma_f32_16x16x32_bf16 v[48:51], a[0:3], v[100:103], v[48:51]
buffer_load_dwordx4 v[80:83], v4, s[16:19], s52 offen sc1
s_waitcnt lgkmcnt(14)
v_mfma_f32_16x16x32_bf16 v[36:39], a[4:7], v[96:99], v[36:39]
ds_read_b64_tr_b16 a[36:37], v7 offset:58272
ds_read_b64_tr_b16 a[38:39], v7 offset:58784
v_mfma_f32_16x16x32_bf16 v[52:55], a[4:7], v[100:103], v[52:55]
ds_read_b64_tr_b16 a[40:41], v7 offset:58304
ds_read_b64_tr_b16 a[42:43], v7 offset:58816
s_waitcnt lgkmcnt(15)
v_mfma_f32_16x16x32_bf16 v[40:43], a[8:11], v[96:99], v[40:43]
buffer_load_dwordx4 v[84:87], v4, s[16:19], s52 offen offset:1024 sc1
v_mfma_f32_16x16x32_bf16 v[56:59], a[8:11], v[100:103], v[56:59]
ds_read_b64_tr_b16 a[44:45], v7 offset:58336
s_add_u32 s52, s52, 0x40000
s_waitcnt lgkmcnt(15)
v_mfma_f32_16x16x32_bf16 v[44:47], a[12:15], v[96:99], v[44:47]
ds_read_b64_tr_b16 a[46:47], v7 offset:58848
v_mfma_f32_16x16x32_bf16 v[60:63], a[12:15], v[100:103], v[60:63]
ds_read_b64_tr_b16 a[48:49], v7 offset:59264
ds_read_b64_tr_b16 a[50:51], v7 offset:59776
s_waitcnt vmcnt(11) lgkmcnt(15)
v_mfma_f32_16x16x32_bf16 v[32:35], a[16:19], v[104:107], v[32:35]
buffer_load_dwordx4 v[88:91], v4, s[16:19], s53 offen sc1
s_waitcnt vmcnt(11)
v_mfma_f32_16x16x32_bf16 v[48:51], a[16:19], v[108:111], v[48:51]
ds_read_b64_tr_b16 a[52:53], v7 offset:59296
ds_read_b64_tr_b16 a[54:55], v7 offset:59808
s_waitcnt lgkmcnt(15)
v_mfma_f32_16x16x32_bf16 v[36:39], a[20:23], v[104:107], v[36:39]
ds_read_b64_tr_b16 a[56:57], v7 offset:59328
ds_read_b64_tr_b16 a[58:59], v7 offset:59840
v_mfma_f32_16x16x32_bf16 v[52:55], a[20:23], v[108:111], v[52:55]
buffer_load_dwordx4 v[92:95], v4, s[16:19], s53 offen offset:1024 sc1
s_waitcnt lgkmcnt(15)
.Lpad27:
s_cbranch_execz .Lnopoll55r
v_mfma_f32_16x16x32_bf16 v[40:43], a[24:27], v[104:107], v[40:43]
ds_read_b64_tr_b16 a[60:61], v7 offset:59360
s_add_u32 s53, s53, 0x40000
v_mfma_f32_16x16x32_bf16 v[56:59], a[24:27], v[108:111], v[56:59]
ds_read_b64_tr_b16 a[62:63], v7 offset:59872
s_waitcnt lgkmcnt(15)
v_mfma_f32_16x16x32_bf16 v[44:47], a[28:31], v[104:107], v[44:47]
v_mfma_f32_16x16x32_bf16 v[60:63], a[28:31], v[108:111], v[60:63]
s_xor_b32 s57, s57, 66560
v_add_u32 v7, s57, v8
s_waitcnt vmcnt(11) lgkmcnt(14)
v_mfma_f32_16x16x32_bf16 v[32:35], a[32:35], v[112:115], v[32:35]
ds_read_b64_tr_b16 a[0:1], v7
ds_read_b64_tr_b16 a[2:3], v7 offset:512
s_waitcnt vmcnt(10)
v_mfma_f32_16x16x32_bf16 v[48:51], a[32:35], v[116:119], v[48:51]
buffer_load_dwordx4 v[96:99], v4, s[16:19], s52 offen sc1
s_waitcnt lgkmcnt(14)
v_mfma_f32_16x16x32_bf16 v[36:39], a[36:39], v[112:115], v[36:39]
ds_read_b64_tr_b16 a[4:5], v7 offset:32
ds_read_b64_tr_b16 a[6:7], v7 offset:544
v_mfma_f32_16x16x32_bf16 v[52:55], a[36:39], v[116:119], v[52:55]
ds_read_b64_tr_b16 a[8:9], v7 offset:64
ds_read_b64_tr_b16 a[10:11], v7 offset:576
s_waitcnt lgkmcnt(15)
v_mfma_f32_16x16x32_bf16 v[40:43], a[40:43], v[112:115], v[40:43]
buffer_load_dwordx4 v[100:103], v4, s[16:19], s52 offen offset:1024 sc1
v_mfma_f32_16x16x32_bf16 v[56:59], a[40:43], v[116:119], v[56:59]
ds_read_b64_tr_b16 a[12:13], v7 offset:96
s_add_u32 s52, s52, 0x40000
s_waitcnt lgkmcnt(15)
v_mfma_f32_16x16x32_bf16 v[44:47], a[44:47], v[112:115], v[44:47]
ds_read_b64_tr_b16 a[14:15], v7 offset:608
v_mfma_f32_16x16x32_bf16 v[60:63], a[44:47], v[116:119], v[60:63]
ds_read_b64_tr_b16 a[16:17], v7 offset:1024
ds_read_b64_tr_b16 a[18:19], v7 offset:1536
s_waitcnt vmcnt(11) lgkmcnt(15)
v_mfma_f32_16x16x32_bf16 v[32:35], a[48:51], v[120:123], v[32:35]
buffer_load_dwordx4 v[104:107], v4, s[16:19], s53 offen sc1
s_waitcnt vmcnt(11)
v_mfma_f32_16x16x32_bf16 v[48:51], a[48:51], v[124:127], v[48:51]
ds_read_b64_tr_b16 a[20:21], v7 offset:1056
ds_read_b64_tr_b16 a[22:23], v7 offset:1568
s_waitcnt lgkmcnt(15)
v_mfma_f32_16x16x32_bf16 v[36:39], a[52:55], v[120:123], v[36:39]
ds_read_b64_tr_b16 a[24:25], v7 offset:1088
ds_read_b64_tr_b16 a[26:27], v7 offset:1600
v_mfma_f32_16x16x32_bf16 v[52:55], a[52:55], v[124:127], v[52:55]
buffer_load_dwordx4 v[108:111], v4, s[16:19], s53 offen offset:1024 sc1
s_waitcnt lgkmcnt(15)
v_mfma_f32_16x16x32_bf16 v[40:43], a[56:59], v[120:123], v[40:43]
ds_read_b64_tr_b16 a[28:29], v7 offset:1120
s_add_u32 s53, s53, 0x40000
v_mfma_f32_16x16x32_bf16 v[56:59], a[56:59], v[124:127], v[56:59]
ds_read_b64_tr_b16 a[30:31], v7 offset:1632
s_waitcnt lgkmcnt(15)
v_mfma_f32_16x16x32_bf16 v[44:47], a[60:63], v[120:123], v[44:47]
v_mfma_f32_16x16x32_bf16 v[60:63], a[60:63], v[124:127], v[60:63]
s_waitcnt vmcnt(11) lgkmcnt(14)
v_mfma_f32_16x16x32_bf16 v[32:35], a[0:3], v[64:67], v[32:35]
ds_read_b64_tr_b16 a[32:33], v7 offset:8320
ds_read_b64_tr_b16 a[34:35], v7 offset:8832
s_waitcnt vmcnt(10)
v_mfma_f32_16x16x32_bf16 v[48:51], a[0:3], v[68:71], v[48:51]
buffer_load_dwordx4 v[112:115], v4, s[16:19], s52 offen sc1
s_waitcnt lgkmcnt(14)
v_mfma_f32_16x16x32_bf16 v[36:39], a[4:7], v[64:67], v[36:39]
ds_read_b64_tr_b16 a[36:37], v7 offset:8352
ds_read_b64_tr_b16 a[38:39], v7 offset:8864
v_mfma_f32_16x16x32_bf16 v[52:55], a[4:7], v[68:71], v[52:55]
ds_read_b64_tr_b16 a[40:41], v7 offset:8384
ds_read_b64_tr_b16 a[42:43], v7 offset:8896
s_waitcnt lgkmcnt(15)
v_mfma_f32_16x16x32_bf16 v[40:43], a[8:11], v[64:67], v[40:43]
buffer_load_dwordx4 v[116:119], v4, s[16:19], s52 offen offset:1024 sc1
v_mfma_f32_16x16x32_bf16 v[56:59], a[8:11], v[68:71], v[56:59]
ds_read_b64_tr_b16 a[44:45], v7 offset:8416
s_add_u32 s52, s52, 0x40000
s_waitcnt lgkmcnt(15)
v_mfma_f32_16x16x32_bf16 v[44:47], a[12:15], v[64:67], v[44:47]
ds_read_b64_tr_b16 a[46:47], v7 offset:8928
v_mfma_f32_16x16x32_bf16 v[60:63], a[12:15], v[68:71], v[60:63]
ds_read_b64_tr_b16 a[48:49], v7 offset:9344
ds_read_b64_tr_b16 a[50:51], v7 offset:9856
s_waitcnt vmcnt(11) lgkmcnt(15)
v_mfma_f32_16x16x32_bf16 v[32:35], a[16:19], v[72:75], v[32:35]
buffer_load_dwordx4 v[120:123], v4, s[16:19], s53 offen sc1
s_waitcnt vmcnt(11)
v_mfma_f32_16x16x32_bf16 v[48:51], a[16:19], v[76:79], v[48:51]
ds_read_b64_tr_b16 a[52:53], v7 offset:9376
ds_read_b64_tr_b16 a[54:55], v7 offset:9888
s_waitcnt lgkmcnt(15)
v_mfma_f32_16x16x32_bf16 v[36:39], a[20:23], v[72:75], v[36:39]
ds_read_b64_tr_b16 a[56:57], v7 offset:9408
ds_read_b64_tr_b16 a[58:59], v7 offset:9920
v_mfma_f32_16x16x32_bf16 v[52:55], a[20:23], v[76:79], v[52:55]
buffer_load_dwordx4 v[124:127], v4, s[16:19], s53 offen offset:1024 sc1
s_waitcnt lgkmcnt(15)
v_mfma_f32_16x16x32_bf16 v[40:43], a[24:27], v[72:75], v[40:43]
ds_read_b64_tr_b16 a[60:61], v7 offset:9440
s_add_u32 s53, s53, 0x40000
v_mfma_f32_16x16x32_bf16 v[56:59], a[24:27], v[76:79], v[56:59]
ds_read_b64_tr_b16 a[62:63], v7 offset:9952
s_waitcnt lgkmcnt(15)
v_mfma_f32_16x16x32_bf16 v[44:47], a[28:31], v[72:75], v[44:47]
v_mfma_f32_16x16x32_bf16 v[60:63], a[28:31], v[76:79], v[60:63]
s_waitcnt vmcnt(11) lgkmcnt(14)
v_mfma_f32_16x16x32_bf16 v[32:35], a[32:35], v[80:83], v[32:35]
ds_read_b64_tr_b16 a[0:1], v7 offset:16640
ds_read_b64_tr_b16 a[2:3], v7 offset:17152
s_waitcnt vmcnt(10)
v_mfma_f32_16x16x32_bf16 v[48:51], a[32:35], v[84:87], v[48:51]
buffer_load_dwordx4 v[64:67], v4, s[16:19], s52 offen sc1
s_waitcnt lgkmcnt(14)
v_mfma_f32_16x16x32_bf16 v[36:39], a[36:39], v[80:83], v[36:39]
ds_read_b64_tr_b16 a[4:5], v7 offset:16672
ds_read_b64_tr_b16 a[6:7], v7 offset:17184
v_mfma_f32_16x16x32_bf16 v[52:55], a[36:39], v[84:87], v[52:55]
ds_read_b64_tr_b16 a[8:9], v7 offset:16704
ds_read_b64_tr_b16 a[10:11], v7 offset:17216
s_waitcnt lgkmcnt(15)
v_mfma_f32_16x16x32_bf16 v[40:43], a[40:43], v[80:83], v[40:43]
buffer_load_dwordx4 v[68:71], v4, s[16:19], s52 offen offset:1024 sc1
v_mfma_f32_16x16x32_bf16 v[56:59], a[40:43], v[84:87], v[56:59]
ds_read_b64_tr_b16 a[12:13], v7 offset:16736
s_add_u32 s52, s52, 0x40000
s_waitcnt lgkmcnt(15)
v_mfma_f32_16x16x32_bf16 v[44:47], a[44:47], v[80:83], v[44:47]
ds_read_b64_tr_b16 a[14:15], v7 offset:17248
v_mfma_f32_16x16x32_bf16 v[60:63], a[44:47], v[84:87], v[60:63]
ds_read_b64_tr_b16 a[16:17], v7 offset:17664
ds_read_b64_tr_b16 a[18:19], v7 offset:18176
s_waitcnt vmcnt(11) lgkmcnt(15)
v_mfma_f32_16x16x32_bf16 v[32:35], a[48:51], v[88:91], v[32:35]
buffer_load_dwordx4 v[72:75], v4, s[16:19], s53 offen sc1
s_waitcnt vmcnt(11)
v_mfma_f32_16x16x32_bf16 v[48:51], a[48:51], v[92:95], v[48:51]
ds_read_b64_tr_b16 a[20:21], v7 offset:17696
ds_read_b64_tr_b16 a[22:23], v7 offset:18208
s_waitcnt lgkmcnt(15)
v_mfma_f32_16x16x32_bf16 v[36:39], a[52:55], v[88:91], v[36:39]
ds_read_b64_tr_b16 a[24:25], v7 offset:17728
ds_read_b64_tr_b16 a[26:27], v7 offset:18240
v_mfma_f32_16x16x32_bf16 v[52:55], a[52:55], v[92:95], v[52:55]
buffer_load_dwordx4 v[76:79], v4, s[16:19], s53 offen offset:1024 sc1
s_waitcnt lgkmcnt(15)
v_mfma_f32_16x16x32_bf16 v[40:43], a[56:59], v[88:91], v[40:43]
ds_read_b64_tr_b16 a[28:29], v7 offset:17760
s_add_u32 s53, s53, 0x40000
v_mfma_f32_16x16x32_bf16 v[56:59], a[56:59], v[92:95], v[56:59]
ds_read_b64_tr_b16 a[30:31], v7 offset:18272
s_waitcnt lgkmcnt(15)
v_mfma_f32_16x16x32_bf16 v[44:47], a[60:63], v[88:91], v[44:47]
v_mfma_f32_16x16x32_bf16 v[60:63], a[60:63], v[92:95], v[60:63]
s_waitcnt vmcnt(11) lgkmcnt(14)
v_mfma_f32_16x16x32_bf16 v[32:35], a[0:3], v[96:99], v[32:35]
ds_read_b64_tr_b16 a[32:33], v7 offset:24960
ds_read_b64_tr_b16 a[34:35], v7 offset:25472
s_waitcnt vmcnt(10)
v_mfma_f32_16x16x32_bf16 v[48:51], a[0:3], v[100:103], v[48:51]
buffer_load_dwordx4 v[80:83], v4, s[16:19], s52 offen sc1
s_waitcnt lgkmcnt(14)
v_mfma_f32_16x16x32_bf16 v[36:39], a[4:7], v[96:99], v[36:39]
ds_read_b64_tr_b16 a[36:37], v7 offset:24992
ds_read_b64_tr_b16 a[38:39], v7 offset:25504
v_mfma_f32_16x16x32_bf16 v[52:55], a[4:7], v[100:103], v[52:55]
ds_read_b64_tr_b16 a[40:41], v7 offset:25024
ds_read_b64_tr_b16 a[42:43], v7 offset:25536
s_waitcnt lgkmcnt(15)
v_mfma_f32_16x16x32_bf16 v[40:43], a[8:11], v[96:99], v[40:43]
buffer_load_dwordx4 v[84:87], v4, s[16:19], s52 offen offset:1024 sc1
v_mfma_f32_16x16x32_bf16 v[56:59], a[8:11], v[100:103], v[56:59]
ds_read_b64_tr_b16 a[44:45], v7 offset:25056
s_add_u32 s52, s52, 0x40000
s_waitcnt lgkmcnt(15)
v_mfma_f32_16x16x32_bf16 v[44:47], a[12:15], v[96:99], v[44:47]
ds_read_b64_tr_b16 a[46:47], v7 offset:25568
v_mfma_f32_16x16x32_bf16 v[60:63], a[12:15], v[100:103], v[60:63]
ds_read_b64_tr_b16 a[48:49], v7 offset:25984
ds_read_b64_tr_b16 a[50:51], v7 offset:26496
s_waitcnt vmcnt(11) lgkmcnt(15)
v_mfma_f32_16x16x32_bf16 v[32:35], a[16:19], v[104:107], v[32:35]
buffer_load_dwordx4 v[88:91], v4, s[16:19], s53 offen sc1
s_waitcnt vmcnt(11)
v_mfma_f32_16x16x32_bf16 v[48:51], a[16:19], v[108:111], v[48:51]
ds_read_b64_tr_b16 a[52:53], v7 offset:26016
ds_read_b64_tr_b16 a[54:55], v7 offset:26528
s_waitcnt lgkmcnt(15)
v_mfma_f32_16x16x32_bf16 v[36:39], a[20:23], v[104:107], v[36:39]
ds_read_b64_tr_b16 a[56:57], v7 offset:26048
ds_read_b64_tr_b16 a[58:59], v7 offset:26560
v_mfma_f32_16x16x32_bf16 v[52:55], a[20:23], v[108:111], v[52:55]
buffer_load_dwordx4 v[92:95], v4, s[16:19], s53 offen offset:1024 sc1
s_waitcnt lgkmcnt(15)
v_mfma_f32_16x16x32_bf16 v[40:43], a[24:27], v[104:107], v[40:43]
ds_read_b64_tr_b16 a[60:61], v7 offset:26080
s_add_u32 s53, s53, 0x40000
v_mfma_f32_16x16x32_bf16 v[56:59], a[24:27], v[108:111], v[56:59]
ds_read_b64_tr_b16 a[62:63], v7 offset:26592
s_waitcnt lgkmcnt(15)
v_mfma_f32_16x16x32_bf16 v[44:47], a[28:31], v[104:107], v[44:47]
v_mfma_f32_16x16x32_bf16 v[60:63], a[28:31], v[108:111], v[60:63]
s_waitcnt vmcnt(11) lgkmcnt(14)
v_mfma_f32_16x16x32_bf16 v[32:35], a[32:35], v[112:115], v[32:35]
ds_read_b64_tr_b16 a[0:1], v7 offset:33280
ds_read_b64_tr_b16 a[2:3], v7 offset:33792
s_waitcnt vmcnt(10)
v_mfma_f32_16x16x32_bf16 v[48:51], a[32:35], v[116:119], v[48:51]
buffer_load_dwordx4 v[96:99], v4, s[16:19], s52 offen sc1
s_waitcnt lgkmcnt(14)
v_mfma_f32_16x16x32_bf16 v[36:39], a[36:39], v[112:115], v[36:39]
ds_read_b64_tr_b16 a[4:5], v7 offset:33312
ds_read_b64_tr_b16 a[6:7], v7 offset:33824
v_mfma_f32_16x16x32_bf16 v[52:55], a[36:39], v[116:119], v[52:55]
ds_read_b64_tr_b16 a[8:9], v7 offset:33344
ds_read_b64_tr_b16 a[10:11], v7 offset:33856
s_waitcnt lgkmcnt(15)
v_mfma_f32_16x16x32_bf16 v[40:43], a[40:43], v[112:115], v[40:43]
buffer_load_dwordx4 v[100:103], v4, s[16:19], s52 offen offset:1024 sc1
v_mfma_f32_16x16x32_bf16 v[56:59], a[40:43], v[116:119], v[56:59]
ds_read_b64_tr_b16 a[12:13], v7 offset:33376
s_add_u32 s52, s52, 0x40000
s_waitcnt lgkmcnt(15)
v_mfma_f32_16x16x32_bf16 v[44:47], a[44:47], v[112:115], v[44:47]
ds_read_b64_tr_b16 a[14:15], v7 offset:33888
v_mfma_f32_16x16x32_bf16 v[60:63], a[44:47], v[116:119], v[60:63]
ds_read_b64_tr_b16 a[16:17], v7 offset:34304
ds_read_b64_tr_b16 a[18:19], v7 offset:34816
s_waitcnt vmcnt(11) lgkmcnt(15)
v_mfma_f32_16x16x32_bf16 v[32:35], a[48:51], v[120:123], v[32:35]
buffer_load_dwordx4 v[104:107], v4, s[16:19], s53 offen sc1
s_waitcnt vmcnt(11)
v_mfma_f32_16x16x32_bf16 v[48:51], a[48:51], v[124:127], v[48:51]
ds_read_b64_tr_b16 a[20:21], v7 offset:34336
ds_read_b64_tr_b16 a[22:23], v7 offset:34848
s_waitcnt lgkmcnt(15)
v_mfma_f32_16x16x32_bf16 v[36:39], a[52:55], v[120:123], v[36:39]
ds_read_b64_tr_b16 a[24:25], v7 offset:34368
ds_read_b64_tr_b16 a[26:27], v7 offset:34880
v_mfma_f32_16x16x32_bf16 v[52:55], a[52:55], v[124:127], v[52:55]
buffer_load_dwordx4 v[108:111], v4, s[16:19], s53 offen offset:1024 sc1
s_waitcnt lgkmcnt(15)
v_mfma_f32_16x16x32_bf16 v[40:43], a[56:59], v[120:123], v[40:43]
ds_read_b64_tr_b16 a[28:29], v7 offset:34400
s_add_u32 s53, s53, 0x40000
v_mfma_f32_16x16x32_bf16 v[56:59], a[56:59], v[124:127], v[56:59]
ds_read_b64_tr_b16 a[30:31], v7 offset:34912
s_waitcnt lgkmcnt(15)
v_mfma_f32_16x16x32_bf16 v[44:47], a[60:63], v[120:123], v[44:47]
v_mfma_f32_16x16x32_bf16 v[60:63], a[60:63], v[124:127], v[60:63]
s_waitcnt vmcnt(11) lgkmcnt(14)
v_mfma_f32_16x16x32_bf16 v[32:35], a[0:3], v[64:67], v[32:35]
ds_read_b64_tr_b16 a[32:33], v7 offset:41600
ds_read_b64_tr_b16 a[34:35], v7 offset:42112
s_waitcnt vmcnt(10)
v_mfma_f32_16x16x32_bf16 v[48:51], a[0:3], v[68:71], v[48:51]
buffer_load_dwordx4 v[112:115], v4, s[16:19], s52 offen sc1
s_waitcnt lgkmcnt(14)
v_mfma_f32_16x16x32_bf16 v[36:39], a[4:7], v[64:67], v[36:39]
ds_read_b64_tr_b16 a[36:37], v7 offset:41632
ds_read_b64_tr_b16 a[38:39], v7 offset:42144
v_mfma_f32_16x16x32_bf16 v[52:55], a[4:7], v[68:71], v[52:55]
ds_read_b64_tr_b16 a[40:41], v7 offset:41664
ds_read_b64_tr_b16 a[42:43], v7 offset:42176
s_waitcnt lgkmcnt(15)
v_mfma_f32_16x16x32_bf16 v[40:43], a[8:11], v[64:67], v[40:43]
buffer_load_dwordx4 v[116:119], v4, s[16:19], s52 offen offset:1024 sc1
v_mfma_f32_16x16x32_bf16 v[56:59], a[8:11], v[68:71], v[56:59]
ds_read_b64_tr_b16 a[44:45], v7 offset:41696
s_add_u32 s52, s52, 0x40000
s_waitcnt lgkmcnt(15)
v_mfma_f32_16x16x32_bf16 v[44:47], a[12:15], v[64:67], v[44:47]
ds_read_b64_tr_b16 a[46:47], v7 offset:42208
v_mfma_f32_16x16x32_bf16 v[60:63], a[12:15], v[68:71], v[60:63]
ds_read_b64_tr_b16 a[48:49], v7 offset:42624
ds_read_b64_tr_b16 a[50:51], v7 offset:43136
s_waitcnt vmcnt(11) lgkmcnt(15)
v_mfma_f32_16x16x32_bf16 v[32:35], a[16:19], v[72:75], v[32:35]
buffer_load_dwordx4 v[120:123], v4, s[16:19], s53 offen sc1
s_waitcnt vmcnt(11)
v_mfma_f32_16x16x32_bf16 v[48:51], a[16:19], v[76:79], v[48:51]
ds_read_b64_tr_b16 a[52:53], v7 offset:42656
ds_read_b64_tr_b16 a[54:55], v7 offset:43168
s_waitcnt lgkmcnt(15)
v_mfma_f32_16x16x32_bf16 v[36:39], a[20:23], v[72:75], v[36:39]
ds_read_b64_tr_b16 a[56:57], v7 offset:42688
ds_read_b64_tr_b16 a[58:59], v7 offset:43200
v_mfma_f32_16x16x32_bf16 v[52:55], a[20:23], v[76:79], v[52:55]
buffer_load_dwordx4 v[124:127], v4, s[16:19], s53 offen offset:1024 sc1
s_waitcnt lgkmcnt(15)
v_mfma_f32_16x16x32_bf16 v[40:43], a[24:27], v[72:75], v[40:43]
ds_read_b64_tr_b16 a[60:61], v7 offset:42720
s_add_u32 s53, s53, 0x40000
v_mfma_f32_16x16x32_bf16 v[56:59], a[24:27], v[76:79], v[56:59]
ds_read_b64_tr_b16 a[62:63], v7 offset:43232
s_waitcnt lgkmcnt(15)
v_mfma_f32_16x16x32_bf16 v[44:47], a[28:31], v[72:75], v[44:47]
v_mfma_f32_16x16x32_bf16 v[60:63], a[28:31], v[76:79], v[60:63]
s_waitcnt lgkmcnt(0)
s_barrier
s_waitcnt vmcnt(11)
v_mfma_f32_16x16x32_bf16 v[32:35], a[32:35], v[80:83], v[32:35]
ds_read_b64_tr_b16 a[0:1], v7 offset:49920
ds_read_b64_tr_b16 a[2:3], v7 offset:50432
s_add_u32 m0, s59, 84480
s_waitcnt vmcnt(10)
v_mfma_f32_16x16x32_bf16 v[48:51], a[32:35], v[84:87], v[48:51]
ds_read_b64_tr_b16 a[4:5], v7 offset:49952
buffer_load_dwordx4 v12, s[32:35], s58 offen lds
v_mfma_f32_16x16x32_bf16 v[36:39], a[36:39], v[80:83], v[36:39]
ds_read_b64_tr_b16 a[6:7], v7 offset:50464
ds_read_b64_tr_b16 a[8:9], v7 offset:49984
v_mfma_f32_16x16x32_bf16 v[52:55], a[36:39], v[84:87], v[52:55]
ds_read_b64_tr_b16 a[10:11], v7 offset:50496
v_mfma_f32_16x16x32_bf16 v[40:43], a[40:43], v[80:83], v[40:43]
ds_read_b64_tr_b16 a[12:13], v7 offset:50016
buffer_load_dwordx4 v13, s[32:35], s58 offen offset:1056 lds
v_mfma_f32_16x16x32_bf16 v[56:59], a[40:43], v[84:87], v[56:59]
ds_read_b64_tr_b16 a[14:15], v7 offset:50528
ds_read_b64_tr_b16 a[16:17], v7 offset:50944
v_mfma_f32_16x16x32_bf16 v[44:47], a[44:47], v[80:83], v[44:47]
ds_read_b64_tr_b16 a[18:19], v7 offset:51456
ds_read_b64_tr_b16 a[20:21], v7 offset:50976
v_mfma_f32_16x16x32_bf16 v[60:63], a[44:47], v[84:87], v[60:63]
ds_read_b64_tr_b16 a[22:23], v7 offset:51488
s_waitcnt vmcnt(11)
v_mfma_f32_16x16x32_bf16 v[32:35], a[48:51], v[88:91], v[32:35]
ds_read_b64_tr_b16 a[24:25], v7 offset:51008
buffer_load_dwordx4 v14, s[32:35], s58 offen offset:2112 lds
s_waitcnt vmcnt(11)
v_mfma_f32_16x16x32_bf16 v[48:51], a[48:51], v[92:95], v[48:51]
ds_read_b64_tr_b16 a[26:27], v7 offset:51520
ds_read_b64_tr_b16 a[28:29], v7 offset:51040
v_mfma_f32_16x16x32_bf16 v[36:39], a[52:55], v[88:91], v[36:39]
ds_read_b64_tr_b16 a[30:31], v7 offset:51552
v_mfma_f32_16x16x32_bf16 v[52:55], a[52:55], v[92:95], v[52:55]
buffer_load_dwordx4 v15, s[32:35], s58 offen offset:3168 lds
v_mfma_f32_16x16x32_bf16 v[40:43], a[56:59], v[88:91], v[40:43]
s_add_u32 s58, s58, 229376
v_mfma_f32_16x16x32_bf16 v[56:59], a[56:59], v[92:95], v[56:59]
v_mfma_f32_16x16x32_bf16 v[44:47], a[60:63], v[88:91], v[44:47]
v_mfma_f32_16x16x32_bf16 v[60:63], a[60:63], v[92:95], v[60:63]
s_waitcnt vmcnt(11) lgkmcnt(14)
v_mfma_f32_16x16x32_bf16 v[32:35], a[0:3], v[96:99], v[32:35]
ds_read_b64_tr_b16 a[32:33], v7 offset:58240
s_add_u32 m0, s59, 101376
s_waitcnt vmcnt(10)
v_mfma_f32_16x16x32_bf16 v[48:51], a[0:3], v[100:103], v[48:51]
buffer_load_dwordx4 v12, s[32:35], s58 offen lds
s_waitcnt lgkmcnt(13)
v_mfma_f32_16x16x32_bf16 v[36:39], a[4:7], v[96:99], v[36:39]
ds_read_b64_tr_b16 a[34:35], v7 offset:58752
ds_read_b64_tr_b16 a[36:37], v7 offset:58272
v_mfma_f32_16x16x32_bf16 v[52:55], a[4:7], v[100:103], v[52:55]
ds_read_b64_tr_b16 a[38:39], v7 offset:58784
ds_read_b64_tr_b16 a[40:41], v7 offset:58304
s_waitcnt lgkmcnt(15)
v_mfma_f32_16x16x32_bf16 v[40:43], a[8:11], v[96:99], v[40:43]
buffer_load_dwordx4 v13, s[32:35], s58 offen offset:1056 lds
v_mfma_f32_16x16x32_bf16 v[56:59], a[8:11], v[100:103], v[56:59]
ds_read_b64_tr_b16 a[42:43], v7 offset:58816
ds_read_b64_tr_b16 a[44:45], v7 offset:58336
s_waitcnt lgkmcnt(15)
v_mfma_f32_16x16x32_bf16 v[44:47], a[12:15], v[96:99], v[44:47]
ds_read_b64_tr_b16 a[46:47], v7 offset:58848
v_mfma_f32_16x16x32_bf16 v[60:63], a[12:15], v[100:103], v[60:63]
ds_read_b64_tr_b16 a[48:49], v7 offset:59264
ds_read_b64_tr_b16 a[50:51], v7 offset:59776
s_waitcnt vmcnt(11) lgkmcnt(15)
v_mfma_f32_16x16x32_bf16 v[32:35], a[16:19], v[104:107], v[32:35]
buffer_load_dwordx4 v14, s[32:35], s58 offen offset:2112 lds
s_waitcnt vmcnt(11)
v_mfma_f32_16x16x32_bf16 v[48:51], a[16:19], v[108:111], v[48:51]
ds_read_b64_tr_b16 a[52:53], v7 offset:59296
ds_read_b64_tr_b16 a[54:55], v7 offset:59808
s_waitcnt lgkmcnt(15)
v_mfma_f32_16x16x32_bf16 v[36:39], a[20:23], v[104:107], v[36:39]
ds_read_b64_tr_b16 a[56:57], v7 offset:59328
ds_read_b64_tr_b16 a[58:59], v7 offset:59840
v_mfma_f32_16x16x32_bf16 v[52:55], a[20:23], v[108:111], v[52:55]
buffer_load_dwordx4 v15, s[32:35], s58 offen offset:3168 lds
s_waitcnt lgkmcnt(15)
v_mfma_f32_16x16x32_bf16 v[40:43], a[24:27], v[104:107], v[40:43]
ds_read_b64_tr_b16 a[60:61], v7 offset:59360
s_add_u32 s58, s58, 229376
v_mfma_f32_16x16x32_bf16 v[56:59], a[24:27], v[108:111], v[56:59]
ds_read_b64_tr_b16 a[62:63], v7 offset:59872
s_waitcnt lgkmcnt(15)
v_mfma_f32_16x16x32_bf16 v[44:47], a[28:31], v[104:107], v[44:47]
v_mfma_f32_16x16x32_bf16 v[60:63], a[28:31], v[108:111], v[60:63]
s_waitcnt vmcnt(11) lgkmcnt(14)
v_mfma_f32_16x16x32_bf16 v[32:35], a[32:35], v[112:115], v[32:35]
s_add_u32 m0, s59, 118272
s_lshl_b32 s64, s6, 14
s_lshl_b32 s65, s49, 13
s_waitcnt vmcnt(10)
v_mfma_f32_16x16x32_bf16 v[48:51], a[32:35], v[116:119], v[48:51]
buffer_load_dwordx4 v12, s[32:35], s58 offen lds
s_waitcnt lgkmcnt(12)
v_mfma_f32_16x16x32_bf16 v[36:39], a[36:39], v[112:115], v[36:39]
s_add_u32 s64, s64, s65
s_lshl_b32 s65, s7, 9
s_add_u32 s64, s64, s65
v_mfma_f32_16x16x32_bf16 v[52:55], a[36:39], v[116:119], v[52:55]
s_lshl_b32 s65, s48, 8
s_add_u32 s64, s64, s65
s_add_u32 s64, s64, 63176704
s_waitcnt lgkmcnt(10)
v_mfma_f32_16x16x32_bf16 v[40:43], a[40:43], v[112:115], v[40:43]
s_lshl_b32 s62, s7, 18
v_and_b32 v152, 31, v1
v_lshlrev_b32 v152, 3, v152
v_mfma_f32_16x16x32_bf16 v[56:59], a[40:43], v[116:119], v[56:59]
buffer_load_dwordx4 v13, s[32:35], s58 offen offset:1056 lds
s_waitcnt lgkmcnt(8)
v_mfma_f32_16x16x32_bf16 v[44:47], a[44:47], v[112:115], v[44:47]
s_add_u32 s62, s62, 41943040
v_lshrrev_b32 v153, 5, v1
v_lshl_add_u32 v152, v153, 28, v152
v_mfma_f32_16x16x32_bf16 v[60:63], a[44:47], v[116:119], v[60:63]
s_add_u32 s63, s62, 0x20000
s_waitcnt vmcnt(11) lgkmcnt(6)
v_mfma_f32_16x16x32_bf16 v[32:35], a[48:51], v[120:123], v[32:35]
s_waitcnt vmcnt(10)
v_mfma_f32_16x16x32_bf16 v[48:51], a[48:51], v[124:127], v[48:51]
buffer_load_dwordx4 v14, s[32:35], s58 offen offset:2112 lds
s_waitcnt lgkmcnt(4)
v_mfma_f32_16x16x32_bf16 v[36:39], a[52:55], v[120:123], v[36:39]
s_nop 2
v_cvt_pk_bf16_f32 v128, v32, v33
v_cvt_pk_bf16_f32 v129, v34, v35
v_mfma_f32_16x16x32_bf16 v[52:55], a[52:55], v[124:127], v[52:55]
v_cvt_pk_bf16_f32 v136, v48, v49
v_cvt_pk_bf16_f32 v137, v50, v51
s_waitcnt lgkmcnt(2)
v_mfma_f32_16x16x32_bf16 v[40:43], a[56:59], v[120:123], v[40:43]
v_cvt_pk_bf16_f32 v130, v36, v37
v_cvt_pk_bf16_f32 v131, v38, v39
v_mfma_f32_16x16x32_bf16 v[56:59], a[56:59], v[124:127], v[56:59]
buffer_load_dwordx4 v15, s[32:35], s58 offen offset:3168 lds
s_waitcnt lgkmcnt(0)
v_mfma_f32_16x16x32_bf16 v[44:47], a[60:63], v[120:123], v[44:47]
s_add_u32 s58, s58, 229376
s_nop 0
v_cvt_pk_bf16_f32 v132, v40, v41
v_cvt_pk_bf16_f32 v133, v42, v43
v_mfma_f32_16x16x32_bf16 v[60:63], a[60:63], v[124:127], v[60:63]
v_cvt_pk_bf16_f32 v138, v52, v53
v_cvt_pk_bf16_f32 v139, v54, v55
v_cvt_pk_bf16_f32 v140, v56, v57
v_cvt_pk_bf16_f32 v134, v44, v45
v_cvt_pk_bf16_f32 v135, v46, v47
v_cvt_pk_bf16_f32 v141, v58, v59
v_pk_mul_f32 v[146:147], v[32:33], v[32:33]
buffer_store_dwordx4 v[128:131], v4, s[16:19], s62 offen sc1
v_cvt_pk_bf16_f32 v142, v60, v61
v_cvt_pk_bf16_f32 v143, v62, v63
v_pk_mul_f32 v[150:151], v[48:49], v[48:49]
v_pk_fma_f32 v[146:147], v[34:35], v[34:35], v[146:147]
v_pk_add_f32 v[144:145], v[32:33], v[34:35]
v_pk_fma_f32 v[150:151], v[50:51], v[50:51], v[150:151]
v_pk_add_f32 v[148:149], v[48:49], v[50:51]
v_pk_fma_f32 v[146:147], v[36:37], v[36:37], v[146:147]
v_pk_add_f32 v[144:145], v[144:145], v[36:37]
v_pk_fma_f32 v[150:151], v[52:53], v[52:53], v[150:151]
v_pk_add_f32 v[148:149], v[148:149], v[52:53]
v_pk_fma_f32 v[146:147], v[38:39], v[38:39], v[146:147]
v_pk_add_f32 v[144:145], v[144:145], v[38:39]
buffer_store_dwordx4 v[132:135], v4, s[16:19], s63 offen sc1
v_pk_fma_f32 v[150:151], v[54:55], v[54:55], v[150:151]
v_pk_add_f32 v[148:149], v[148:149], v[54:55]
v_pk_fma_f32 v[146:147], v[40:41], v[40:41], v[146:147]
v_pk_add_f32 v[144:145], v[144:145], v[40:41]
v_pk_fma_f32 v[150:151], v[56:57], v[56:57], v[150:151]
v_pk_add_f32 v[148:149], v[148:149], v[56:57]
v_pk_fma_f32 v[146:147], v[42:43], v[42:43], v[146:147]
v_pk_add_f32 v[144:145], v[144:145], v[42:43]
v_pk_fma_f32 v[150:151], v[58:59], v[58:59], v[150:151]
v_pk_add_f32 v[148:149], v[148:149], v[58:59]
v_pk_fma_f32 v[146:147], v[44:45], v[44:45], v[146:147]
v_pk_add_f32 v[144:145], v[144:145], v[44:45]
v_pk_fma_f32 v[150:151], v[60:61], v[60:61], v[150:151]
buffer_store_dwordx4 v[136:139], v4, s[16:19], s62 offen offset:1024 sc1
v_pk_add_f32 v[148:149], v[148:149], v[60:61]
v_pk_fma_f32 v[146:147], v[46:47], v[46:47], v[146:147]
v_pk_add_f32 v[144:145], v[144:145], v[46:47]
v_pk_fma_f32 v[150:151], v[62:63], v[62:63], v[150:151]
v_pk_add_f32 v[148:149], v[148:149], v[62:63]
v_add_f32 v144, v144, v145
v_add_f32 v146, v146, v147
v_add_f32 v148, v148, v149
v_add_f32 v150, v150, v151
s_nop 0
v_permlane16_swap_b32 v144, v148
v_permlane16_swap_b32 v146, v150
v_add_f32 v144, v144, v148
buffer_store_dwordx4 v[140:143], v4, s[16:19], s63 offen offset:1024 sc1
v_add_f32 v146, v146, v150
s_nop 1
v_permlane32_swap_b32 v144, v146
v_add_f32 v144, v144, v146
s_nop 1
v_permlane32_swap_b32 v144, v145
buffer_store_dwordx2 v[144:145], v152, s[16:19], s64 offen sc1
s_nop 1
v_accvgpr_write_b32 a224, v32
v_accvgpr_write_b32 a225, v33
v_accvgpr_write_b32 a226, v34
v_accvgpr_write_b32 a227, v35
v_accvgpr_write_b32 a228, v36
v_accvgpr_write_b32 a229, v37
v_accvgpr_write_b32 a230, v38
v_accvgpr_write_b32 a231, v39
v_accvgpr_write_b32 a232, v40
v_accvgpr_write_b32 a233, v41
v_accvgpr_write_b32 a234, v42
v_accvgpr_write_b32 a235, v43
v_accvgpr_write_b32 a236, v44
v_accvgpr_write_b32 a237, v45
v_accvgpr_write_b32 a238, v46
v_accvgpr_write_b32 a239, v47
v_accvgpr_write_b32 a240, v48
v_accvgpr_write_b32 a241, v49
v_accvgpr_write_b32 a242, v50
v_accvgpr_write_b32 a243, v51
v_accvgpr_write_b32 a244, v52
v_accvgpr_write_b32 a245, v53
v_accvgpr_write_b32 a246, v54
v_accvgpr_write_b32 a247, v55
v_accvgpr_write_b32 a248, v56
v_accvgpr_write_b32 a249, v57
v_accvgpr_write_b32 a250, v58
v_accvgpr_write_b32 a251, v59
v_accvgpr_write_b32 a252, v60
v_accvgpr_write_b32 a253, v61
v_accvgpr_write_b32 a254, v62
v_accvgpr_write_b32 a255, v63
s_lshl_b32 s62, s10, 14
s_lshl_b32 s63, s3, 12
s_add_u32 s62, s62, s63
s_lshl_b32 s63, s12, 11
s_add_u32 s62, s62, s63
v_lshl_add_u32 v10, v1, 4, s62
v_lshrrev_b32 v2, 3, v1
v_cmp_eq_u32 vcc, 3, v2
v_add_u32 v2, 67108480, v10
s_nop 0
v_cndmask_b32 v10, v10, v2, vcc
v_xor_b32 v11, 2048, v10
v_bfe_u32 v16, v1, 2, 3
v_mul_u32_u24 v16, 1056, v16
v_bfe_u32 v2, v1, 5, 1
v_lshl_add_u32 v16, v2, 8, v16
v_and_b32 v2, 3, v1
v_lshl_add_u32 v16, v2, 3, v16
s_lshl_b32 s62, s12, 6
s_add_u32 s62, s62, 84480
s_xor_b32 s63, s12, 1
s_mul_i32 s63, s63, 192
s_add_u32 s63, s63, 84480
v_add_u32 v17, s63, v16
v_add_u32 v16, s62, v16
s_mov_b32 s52, 41943040
s_mov_b32 s54, s58
s_mov_b32 s55, s59
s_mul_i32 s59, s3, 2112
s_and_b32 s62, s7, 1
s_mul_i32 s62, s62, 3670016
s_lshr_b32 s63, s7, 1
s_lshl_b32 s63, s63, 8
s_add_u32 s62, s62, s63
s_lshl_b32 s63, s3, 12
s_add_u32 s62, s62, s63
v_lshrrev_b32 v5, 4, v1
v_lshlrev_b32 v5, 14, v5
v_and_b32 v2, 15, v1
v_lshl_add_u32 v5, v2, 4, v5
v_add_u32 v5, s62, v5
v_add_u32 v6, 992, v5
s_lshl_b32 s62, s10, 15
s_lshl_b32 s63, s3, 13
s_add_u32 s62, s62, s63
v_lshl_add_u32 v4, v1, 4, s62
s_lshl_b32 s62, s6, 7
s_add_u32 s62, s62, 30420992
.Lpad28:
s_cbranch_execz .Lnopoll55r
s_lshl_b32 s64, s10, 1
s_lshl_b32 s64, s64, 7
s_add_u32 s64, s64, 30420992
s_add_u32 s65, s64, 128
v_mov_b32 v252, s62
v_mov_b32 v253, s64
v_writelane_b32 v253, s65, 1
s_waitcnt vmcnt(0) lgkmcnt(0)
s_barrier
s_cmp_lg_u32 s3, 0
s_cbranch_scc1 .Lnosig57
v_mov_b32 v255, 1
s_mov_b64 exec, 1
buffer_atomic_add v255, v252, s[16:19], 0 offen
s_mov_b64 exec, -1
.Lnosig57:
s_cmp_lg_u32 s3, 1
s_cbranch_scc1 .Lnopoll60
s_mov_b64 exec, 3
s_mov_b32 s15, 0
s_mov_b64 exec, 3
v_mov_b32 v254, 0
buffer_atomic_add v254, v253, s[16:19], 0 offen sc0
.Lpoll58:
s_waitcnt vmcnt(0)
v_cmp_ne_u32 vcc, 16, v254
s_add_u32 s15, s15, 1
s_cbranch_vccz .Lnopoll60r
s_sleep 2
s_mov_b64 exec, 3
v_mov_b32 v254, 0
buffer_atomic_add v254, v253, s[16:19], 0 offen sc0
s_cmp_le_u32 s15, 100000
s_cbranch_scc1 .Lpoll58
.Lgot59:
s_waitcnt vmcnt(0)
s_branch .Lnopoll60r
.Lnopoll60:
s_mov_b64 exec, 0
s_cmp_eq_u32 s3, 2
s_cbranch_scc1 .Lpad29
s_cmp_eq_u32 s3, 3
s_cbranch_scc1 .Lpad30
s_branch .Lpad31
.Lnopoll60r:
s_mov_b64 exec, -1
s_barrier
buffer_load_dwordx4 a[128:131], v10, s[16:19], s52 offen sc1
buffer_load_dwordx4 a[132:135], v10, s[16:19], s52 offen offset:1024 sc1
buffer_load_dwordx4 a[136:139], v11, s[16:19], s52 offen sc1
buffer_load_dwordx4 a[140:143], v11, s[16:19], s52 offen offset:1024 sc1
s_add_u32 s52, s52, 0x20000
buffer_load_dwordx4 a[144:147], v10, s[16:19], s52 offen sc1
buffer_load_dwordx4 a[148:151], v10, s[16:19], s52 offen offset:1024 sc1
buffer_load_dwordx4 a[152:155], v11, s[16:19], s52 offen sc1
buffer_load_dwordx4 a[156:159], v11, s[16:19], s52 offen offset:1024 sc1
s_add_u32 s52, s52, 0x20000
ds_read_b64_tr_b16 a[0:1], v16
ds_read_b64_tr_b16 a[2:3], v16 offset:512
ds_read_b64_tr_b16 a[4:5], v16 offset:32
ds_read_b64_tr_b16 a[6:7], v16 offset:544
ds_read_b64_tr_b16 a[8:9], v16 offset:8448
ds_read_b64_tr_b16 a[10:11], v16 offset:8960
ds_read_b64_tr_b16 a[12:13], v16 offset:8480
ds_read_b64_tr_b16 a[14:15], v16 offset:8992
ds_read_b64_tr_b16 a[16:17], v16 offset:64
ds_read_b64_tr_b16 a[18:19], v16 offset:576
ds_read_b64_tr_b16 a[20:21], v16 offset:96
ds_read_b64_tr_b16 a[22:23], v16 offset:608
ds_read_b64_tr_b16 a[24:25], v16 offset:8512
ds_read_b64_tr_b16 a[26:27], v16 offset:9024
ds_read_b64_tr_b16 a[28:29], v16 offset:8544
ds_read_b64_tr_b16 a[30:31], v16 offset:9056
ds_read_b64_tr_b16 a[32:33], v16 offset:128
ds_read_b64_tr_b16 a[34:35], v16 offset:640
ds_read_b64_tr_b16 a[36:37], v16 offset:160
ds_read_b64_tr_b16 a[38:39], v16 offset:672
ds_read_b64_tr_b16 a[40:41], v16 offset:8576
ds_read_b64_tr_b16 a[42:43], v16 offset:9088
ds_read_b64_tr_b16 a[44:45], v16 offset:8608
ds_read_b64_tr_b16 a[46:47], v16 offset:9120
ds_read_b64_tr_b16 a[48:49], v17
ds_read_b64_tr_b16 a[50:51], v17 offset:512
ds_read_b64_tr_b16 a[52:53], v17 offset:32
ds_read_b64_tr_b16 a[54:55], v17 offset:544
ds_read_b64_tr_b16 a[56:57], v17 offset:8448
ds_read_b64_tr_b16 a[58:59], v17 offset:8960
ds_read_b64_tr_b16 a[60:61], v17 offset:8480
ds_read_b64_tr_b16 a[62:63], v17 offset:8992
s_add_u32 m0, s55, 135168
s_nop 0
buffer_load_dwordx4 v12, s[32:35], s54 offen lds
buffer_load_dwordx4 v13, s[32:35], s54 offen offset:1056 lds
buffer_load_dwordx4 v14, s[32:35], s54 offen offset:2112 lds
buffer_load_dwordx4 v15, s[32:35], s54 offen offset:3168 lds
s_add_u32 s54, s54, 229376
s_waitcnt lgkmcnt(0)
s_barrier
s_lshl_b32 s74, s3, 13
s_add_u32 s74, s74, 49920
v_lshl_add_u32 v2, v1, 4, s74
s_waitcnt vmcnt(11)
v_mfma_f32_16x16x32_bf16 v[32:35], a[0:3], a[128:131], 0
ds_read_b64_tr_b16 a[64:65], v16 offset:16896
s_waitcnt vmcnt(10)
v_mfma_f32_16x16x32_bf16 v[36:39], a[0:3], a[132:135], 0
buffer_load_dwordx4 a[160:163], v10, s[16:19], s52 offen sc1
s_waitcnt vmcnt(10)
v_mfma_f32_16x16x32_bf16 v[40:43], a[0:3], a[136:139], 0
ds_read_b64_tr_b16 a[66:67], v16 offset:17408
s_waitcnt vmcnt(9)
v_mfma_f32_16x16x32_bf16 v[44:47], a[0:3], a[140:143], 0
ds_read_b64_tr_b16 a[68:69], v16 offset:16928
v_mfma_f32_16x16x32_bf16 v[48:51], a[4:7], a[128:131], 0
ds_read_b64_tr_b16 a[70:71], v16 offset:17440
v_mfma_f32_16x16x32_bf16 v[52:55], a[4:7], a[132:135], 0
buffer_load_dwordx4 a[164:167], v10, s[16:19], s52 offen offset:1024 sc1
v_mfma_f32_16x16x32_bf16 v[56:59], a[4:7], a[136:139], 0
ds_read_b64_tr_b16 a[72:73], v16 offset:25344
v_mfma_f32_16x16x32_bf16 v[60:63], a[4:7], a[140:143], 0
v_mfma_f32_16x16x32_bf16 v[64:67], a[8:11], a[128:131], 0
ds_read_b64_tr_b16 a[74:75], v16 offset:25856
v_mfma_f32_16x16x32_bf16 v[68:71], a[8:11], a[132:135], 0
ds_read_b64_tr_b16 a[76:77], v16 offset:25376
v_mfma_f32_16x16x32_bf16 v[72:75], a[8:11], a[136:139], 0
buffer_load_dwordx4 a[168:171], v11, s[16:19], s52 offen sc1
v_mfma_f32_16x16x32_bf16 v[76:79], a[8:11], a[140:143], 0
ds_read_b64_tr_b16 a[78:79], v16 offset:25888
v_mfma_f32_16x16x32_bf16 v[80:83], a[12:15], a[128:131], 0
ds_read_b64_tr_b16 a[80:81], v16 offset:16960
v_mfma_f32_16x16x32_bf16 v[84:87], a[12:15], a[132:135], 0
ds_read_b64_tr_b16 a[82:83], v16 offset:17472
v_mfma_f32_16x16x32_bf16 v[88:91], a[12:15], a[136:139], 0
buffer_load_dwordx4 a[172:175], v11, s[16:19], s52 offen offset:1024 sc1
v_mfma_f32_16x16x32_bf16 v[92:95], a[12:15], a[140:143], 0
s_add_u32 s52, s52, 0x20000
v_mfma_f32_16x16x32_bf16 v[96:99], a[16:19], a[128:131], 0
ds_read_b64_tr_b16 a[84:85], v16 offset:16992
v_mfma_f32_16x16x32_bf16 v[100:103], a[16:19], a[132:135], 0
ds_read_b64_tr_b16 a[86:87], v16 offset:17504
v_mfma_f32_16x16x32_bf16 v[104:107], a[16:19], a[136:139], 0
ds_read_b64_tr_b16 a[88:89], v16 offset:25408
s_add_u32 m0, s55, 84480
v_mfma_f32_16x16x32_bf16 v[108:111], a[16:19], a[140:143], 0
buffer_load_dwordx4 v12, s[32:35], s54 offen lds
v_mfma_f32_16x16x32_bf16 v[112:115], a[20:23], a[128:131], 0
ds_read_b64_tr_b16 a[90:91], v16 offset:25920
v_mfma_f32_16x16x32_bf16 v[116:119], a[20:23], a[132:135], 0
v_mfma_f32_16x16x32_bf16 v[120:123], a[20:23], a[136:139], 0
ds_read_b64_tr_b16 a[92:93], v16 offset:25440
v_mfma_f32_16x16x32_bf16 v[124:127], a[20:23], a[140:143], 0
buffer_load_dwordx4 a[176:179], v10, s[16:19], s52 offen sc1
v_mfma_f32_16x16x32_bf16 v[128:131], a[24:27], a[128:131], 0
ds_read_b64_tr_b16 a[94:95], v16 offset:25952
v_mfma_f32_16x16x32_bf16 v[132:135], a[24:27], a[132:135], 0
ds_read_b64_tr_b16 a[96:97], v16 offset:17024
v_mfma_f32_16x16x32_bf16 v[136:139], a[24:27], a[136:139], 0
ds_read_b64_tr_b16 a[98:99], v16 offset:17536
v_mfma_f32_16x16x32_bf16 v[140:143], a[24:27], a[140:143], 0
ds_read_b64_tr_b16 a[100:101], v16 offset:17056
v_mfma_f32_16x16x32_bf16 v[144:147], a[28:31], a[128:131], 0
buffer_load_dwordx4 v13, s[32:35], s54 offen offset:1056 lds
v_mfma_f32_16x16x32_bf16 v[148:151], a[28:31], a[132:135], 0
v_mfma_f32_16x16x32_bf16 v[152:155], a[28:31], a[136:139], 0
ds_read_b64_tr_b16 a[102:103], v16 offset:17568
v_mfma_f32_16x16x32_bf16 v[156:159], a[28:31], a[140:143], 0
ds_read_b64_tr_b16 a[104:105], v16 offset:25472
v_mfma_f32_16x16x32_bf16 v[160:163], a[32:35], a[128:131], 0
buffer_load_dwordx4 a[180:183], v10, s[16:19], s52 offen offset:1024 sc1
v_mfma_f32_16x16x32_bf16 v[164:167], a[32:35], a[132:135], 0
ds_read_b64_tr_b16 a[106:107], v16 offset:25984
v_mfma_f32_16x16x32_bf16 v[168:171], a[32:35], a[136:139], 0
ds_read_b64_tr_b16 a[108:109], v16 offset:25504
v_mfma_f32_16x16x32_bf16 v[172:175], a[32:35], a[140:143], 0
v_mfma_f32_16x16x32_bf16 v[176:179], a[36:39], a[128:131], 0
ds_read_b64_tr_b16 a[110:111], v16 offset:26016
v_mfma_f32_16x16x32_bf16 v[180:183], a[36:39], a[132:135], 0
buffer_load_dwordx4 v14, s[32:35], s54 offen offset:2112 lds
v_mfma_f32_16x16x32_bf16 v[184:187], a[36:39], a[136:139], 0
ds_read_b64_tr_b16 a[112:113], v17 offset:16896
v_mfma_f32_16x16x32_bf16 v[188:191], a[36:39], a[140:143], 0
ds_read_b64_tr_b16 a[114:115], v17 offset:17408
v_mfma_f32_16x16x32_bf16 v[192:195], a[40:43], a[128:131], 0
ds_read_b64_tr_b16 a[116:117], v17 offset:16928
v_mfma_f32_16x16x32_bf16 v[196:199], a[40:43], a[132:135], 0
buffer_load_dwordx4 a[184:187], v11, s[16:19], s52 offen sc1
v_mfma_f32_16x16x32_bf16 v[200:203], a[40:43], a[136:139], 0
ds_read_b64_tr_b16 a[118:119], v17 offset:17440
v_mfma_f32_16x16x32_bf16 v[204:207], a[40:43], a[140:143], 0
v_mfma_f32_16x16x32_bf16 v[208:211], a[44:47], a[128:131], 0
ds_read_b64_tr_b16 a[120:121], v17 offset:25344
v_mfma_f32_16x16x32_bf16 v[212:215], a[44:47], a[132:135], 0
ds_read_b64_tr_b16 a[122:123], v17 offset:25856
v_mfma_f32_16x16x32_bf16 v[216:219], a[44:47], a[136:139], 0
buffer_load_dwordx4 v15, s[32:35], s54 offen offset:3168 lds
v_mfma_f32_16x16x32_bf16 v[220:223], a[44:47], a[140:143], 0
ds_read_b64_tr_b16 a[124:125], v17 offset:25376
s_add_u32 s54, s54, 229376
v_mfma_f32_16x16x32_bf16 v[224:227], a[48:51], a[128:131], 0
ds_read_b64_tr_b16 a[126:127], v17 offset:25888
v_mfma_f32_16x16x32_bf16 v[228:231], a[48:51], a[132:135], 0
v_mfma_f32_16x16x32_bf16 v[232:235], a[52:55], a[128:131], 0
buffer_load_dwordx4 a[188:191], v11, s[16:19], s52 offen offset:1024 sc1
v_mfma_f32_16x16x32_bf16 v[236:239], a[52:55], a[132:135], 0
s_add_u32 s52, s52, 0x20000
v_mfma_f32_16x16x32_bf16 v[240:243], a[56:59], a[128:131], 0
v_mfma_f32_16x16x32_bf16 v[244:247], a[56:59], a[132:135], 0
v_mfma_f32_16x16x32_bf16 v[248:251], a[60:63], a[128:131], 0
v_mfma_f32_16x16x32_bf16 v[252:255], a[60:63], a[132:135], 0
s_waitcnt lgkmcnt(0)
s_barrier
s_waitcnt vmcnt(19)
v_mfma_f32_16x16x32_bf16 v[32:35], a[64:67], a[144:147], v[32:35]
s_add_u32 m0, s74, 0
s_mov_b32 s67, 63176704
s_waitcnt vmcnt(18)
v_mfma_f32_16x16x32_bf16 v[36:39], a[64:67], a[148:151], v[36:39]
buffer_load_dwordx4 v4, s[16:19], s67 offen sc1 lds
s_waitcnt vmcnt(18)
v_mfma_f32_16x16x32_bf16 v[40:43], a[64:67], a[152:155], v[40:43]
ds_read_b64_tr_b16 a[0:1], v16 offset:33792
s_waitcnt vmcnt(17)
v_mfma_f32_16x16x32_bf16 v[44:47], a[64:67], a[156:159], v[44:47]
ds_read_b64_tr_b16 a[2:3], v16 offset:34304
v_mfma_f32_16x16x32_bf16 v[48:51], a[68:71], a[144:147], v[48:51]
buffer_load_dwordx4 v4, s[16:19], s67 offen offset:1024 sc1 lds
v_mfma_f32_16x16x32_bf16 v[52:55], a[68:71], a[148:151], v[52:55]
ds_read_b64_tr_b16 a[4:5], v16 offset:33824
v_mfma_f32_16x16x32_bf16 v[56:59], a[68:71], a[152:155], v[56:59]
ds_read_b64_tr_b16 a[6:7], v16 offset:34336
v_mfma_f32_16x16x32_bf16 v[60:63], a[68:71], a[156:159], v[60:63]
buffer_load_dwordx4 v4, s[16:19], s67 offen offset:2048 sc1 lds
v_mfma_f32_16x16x32_bf16 v[64:67], a[72:75], a[144:147], v[64:67]
ds_read_b64_tr_b16 a[8:9], v16 offset:42240
v_mfma_f32_16x16x32_bf16 v[68:71], a[72:75], a[148:151], v[68:71]
ds_read_b64_tr_b16 a[10:11], v16 offset:42752
v_mfma_f32_16x16x32_bf16 v[72:75], a[72:75], a[152:155], v[72:75]
ds_read_b64_tr_b16 a[12:13], v16 offset:42272
v_mfma_f32_16x16x32_bf16 v[76:79], a[72:75], a[156:159], v[76:79]
buffer_load_dwordx4 v4, s[16:19], s67 offen offset:3072 sc1 lds
v_mfma_f32_16x16x32_bf16 v[80:83], a[76:79], a[144:147], v[80:83]
ds_read_b64_tr_b16 a[14:15], v16 offset:42784
v_mfma_f32_16x16x32_bf16 v[84:87], a[76:79], a[148:151], v[84:87]
s_add_u32 m0, s74, 4096
s_mov_b32 s67, 63180800
v_mfma_f32_16x16x32_bf16 v[88:91], a[76:79], a[152:155], v[88:91]
buffer_load_dwordx4 v4, s[16:19], s67 offen sc1 lds
v_mfma_f32_16x16x32_bf16 v[92:95], a[76:79], a[156:159], v[92:95]
ds_read_b64_tr_b16 a[16:17], v16 offset:33856
v_mfma_f32_16x16x32_bf16 v[96:99], a[80:83], a[144:147], v[96:99]
ds_read_b64_tr_b16 a[18:19], v16 offset:34368
v_mfma_f32_16x16x32_bf16 v[100:103], a[80:83], a[148:151], v[100:103]
buffer_load_dwordx4 v4, s[16:19], s67 offen offset:1024 sc1 lds
v_mfma_f32_16x16x32_bf16 v[104:107], a[80:83], a[152:155], v[104:107]
ds_read_b64_tr_b16 a[20:21], v16 offset:33888
v_mfma_f32_16x16x32_bf16 v[108:111], a[80:83], a[156:159], v[108:111]
ds_read_b64_tr_b16 a[22:23], v16 offset:34400
v_mfma_f32_16x16x32_bf16 v[112:115], a[84:87], a[144:147], v[112:115]
ds_read_b64_tr_b16 a[24:25], v16 offset:42304
v_mfma_f32_16x16x32_bf16 v[116:119], a[84:87], a[148:151], v[116:119]
buffer_load_dwordx4 v4, s[16:19], s67 offen offset:2048 sc1 lds
v_mfma_f32_16x16x32_bf16 v[120:123], a[84:87], a[152:155], v[120:123]
ds_read_b64_tr_b16 a[26:27], v16 offset:42816
v_mfma_f32_16x16x32_bf16 v[124:127], a[84:87], a[156:159], v[124:127]
ds_read_b64_tr_b16 a[28:29], v16 offset:42336
v_mfma_f32_16x16x32_bf16 v[128:131], a[88:91], a[144:147], v[128:131]
buffer_load_dwordx4 v4, s[16:19], s67 offen offset:3072 sc1 lds
v_mfma_f32_16x16x32_bf16 v[132:135], a[88:91], a[148:151], v[132:135]
ds_read_b64_tr_b16 a[30:31], v16 offset:42848
v_mfma_f32_16x16x32_bf16 v[136:139], a[88:91], a[152:155], v[136:139]
v_mfma_f32_16x16x32_bf16 v[140:143], a[88:91], a[156:159], v[140:143]
ds_read_b64_tr_b16 a[32:33], v16 offset:33920
s_add_u32 m0, s55, 101376
v_mfma_f32_16x16x32_bf16 v[144:147], a[92:95], a[144:147], v[144:147]
buffer_load_dwordx4 v12, s[32:35], s54 offen lds
v_mfma_f32_16x16x32_bf16 v[148:151], a[92:95], a[148:151], v[148:151]
ds_read_b64_tr_b16 a[34:35], v16 offset:34432
v_mfma_f32_16x16x32_bf16 v[152:155], a[92:95], a[152:155], v[152:155]
ds_read_b64_tr_b16 a[36:37], v16 offset:33952
v_mfma_f32_16x16x32_bf16 v[156:159], a[92:95], a[156:159], v[156:159]
buffer_load_dwordx4 a[128:131], v10, s[16:19], s52 offen sc1
v_mfma_f32_16x16x32_bf16 v[160:163], a[96:99], a[144:147], v[160:163]
ds_read_b64_tr_b16 a[38:39], v16 offset:34464
v_mfma_f32_16x16x32_bf16 v[164:167], a[96:99], a[148:151], v[164:167]
ds_read_b64_tr_b16 a[40:41], v16 offset:42368
v_mfma_f32_16x16x32_bf16 v[168:171], a[96:99], a[152:155], v[168:171]
buffer_load_dwordx4 v13, s[32:35], s54 offen offset:1056 lds
v_mfma_f32_16x16x32_bf16 v[172:175], a[96:99], a[156:159], v[172:175]
ds_read_b64_tr_b16 a[42:43], v16 offset:42880
v_mfma_f32_16x16x32_bf16 v[176:179], a[100:103], a[144:147], v[176:179]
ds_read_b64_tr_b16 a[44:45], v16 offset:42400
v_mfma_f32_16x16x32_bf16 v[180:183], a[100:103], a[148:151], v[180:183]
ds_read_b64_tr_b16 a[46:47], v16 offset:42912
v_mfma_f32_16x16x32_bf16 v[184:187], a[100:103], a[152:155], v[184:187]
buffer_load_dwordx4 a[132:135], v10, s[16:19], s52 offen offset:1024 sc1
v_mfma_f32_16x16x32_bf16 v[188:191], a[100:103], a[156:159], v[188:191]
ds_read_b64_tr_b16 a[48:49], v17 offset:33792
v_mfma_f32_16x16x32_bf16 v[192:195], a[104:107], a[144:147], v[192:195]
ds_read_b64_tr_b16 a[50:51], v17 offset:34304
v_mfma_f32_16x16x32_bf16 v[196:199], a[104:107], a[148:151], v[196:199]
buffer_load_dwordx4 v14, s[32:35], s54 offen offset:2112 lds
v_mfma_f32_16x16x32_bf16 v[200:203], a[104:107], a[152:155], v[200:203]
ds_read_b64_tr_b16 a[52:53], v17 offset:33824
v_mfma_f32_16x16x32_bf16 v[204:207], a[104:107], a[156:159], v[204:207]
ds_read_b64_tr_b16 a[54:55], v17 offset:34336
v_mfma_f32_16x16x32_bf16 v[208:211], a[108:111], a[144:147], v[208:211]
buffer_load_dwordx4 a[136:139], v11, s[16:19], s52 offen sc1
v_mfma_f32_16x16x32_bf16 v[212:215], a[108:111], a[148:151], v[212:215]
ds_read_b64_tr_b16 a[56:57], v17 offset:42240
v_mfma_f32_16x16x32_bf16 v[216:219], a[108:111], a[152:155], v[216:219]
ds_read_b64_tr_b16 a[58:59], v17 offset:42752
v_mfma_f32_16x16x32_bf16 v[220:223], a[108:111], a[156:159], v[220:223]
ds_read_b64_tr_b16 a[60:61], v17 offset:42272
v_mfma_f32_16x16x32_bf16 v[224:227], a[112:115], a[144:147], v[224:227]
buffer_load_dwordx4 v15, s[32:35], s54 offen offset:3168 lds
v_mfma_f32_16x16x32_bf16 v[228:231], a[112:115], a[148:151], v[228:231]
ds_read_b64_tr_b16 a[62:63], v17 offset:42784
s_add_u32 s54, s54, 229376
v_mfma_f32_16x16x32_bf16 v[232:235], a[116:119], a[144:147], v[232:235]
v_mfma_f32_16x16x32_bf16 v[236:239], a[116:119], a[148:151], v[236:239]
buffer_load_dwordx4 a[140:143], v11, s[16:19], s52 offen offset:1024 sc1
v_mfma_f32_16x16x32_bf16 v[240:243], a[120:123], a[144:147], v[240:243]
s_add_u32 s52, s52, 0x20000
v_mfma_f32_16x16x32_bf16 v[244:247], a[120:123], a[148:151], v[244:247]
v_mfma_f32_16x16x32_bf16 v[248:251], a[124:127], a[144:147], v[248:251]
v_mfma_f32_16x16x32_bf16 v[252:255], a[124:127], a[148:151], v[252:255]
s_waitcnt vmcnt(28) lgkmcnt(0)
s_barrier
s_waitcnt vmcnt(27)
v_mfma_f32_16x16x32_bf16 v[32:35], a[0:3], a[160:163], v[32:35]
ds_read_b64_tr_b16 a[64:65], v16 offset:50688
s_add_u32 m0, s55, 118272
s_waitcnt vmcnt(26)
v_mfma_f32_16x16x32_bf16 v[36:39], a[0:3], a[164:167], v[36:39]
buffer_load_dwordx4 v12, s[32:35], s54 offen lds
s_waitcnt vmcnt(26)
v_mfma_f32_16x16x32_bf16 v[40:43], a[0:3], a[168:171], v[40:43]
ds_read_b64_tr_b16 a[66:67], v16 offset:51200
s_waitcnt vmcnt(25)
v_mfma_f32_16x16x32_bf16 v[44:47], a[0:3], a[172:175], v[44:47]
ds_read_b64_tr_b16 a[68:69], v16 offset:50720
v_mfma_f32_16x16x32_bf16 v[48:51], a[4:7], a[160:163], v[48:51]
v_mfma_f32_16x16x32_bf16 v[52:55], a[4:7], a[164:167], v[52:55]
ds_read_b64_tr_b16 a[70:71], v16 offset:51232
v_mfma_f32_16x16x32_bf16 v[56:59], a[4:7], a[168:171], v[56:59]
ds_read_b64_tr_b16 a[72:73], v16 offset:59136
v_mfma_f32_16x16x32_bf16 v[60:63], a[4:7], a[172:175], v[60:63]
buffer_load_dwordx4 a[144:147], v10, s[16:19], s52 offen sc1
v_mfma_f32_16x16x32_bf16 v[64:67], a[8:11], a[160:163], v[64:67]
ds_read_b64_tr_b16 a[74:75], v16 offset:59648
v_mfma_f32_16x16x32_bf16 v[68:71], a[8:11], a[164:167], v[68:71]
v_mfma_f32_16x16x32_bf16 v[72:75], a[8:11], a[168:171], v[72:75]
ds_read_b64_tr_b16 a[76:77], v16 offset:59168
v_mfma_f32_16x16x32_bf16 v[76:79], a[8:11], a[172:175], v[76:79]
ds_read_b64_tr_b16 a[78:79], v16 offset:59680
v_mfma_f32_16x16x32_bf16 v[80:83], a[12:15], a[160:163], v[80:83]
ds_read_b64_tr_b16 a[80:81], v16 offset:50752
s_waitcnt vmcnt(10)
ds_read_b128 v[20:23], v2
v_mfma_f32_16x16x32_bf16 v[84:87], a[12:15], a[164:167], v[84:87]
ds_read_b128 v[28:31], v2 offset:1024
v_mfma_f32_16x16x32_bf16 v[88:91], a[12:15], a[168:171], v[88:91]
buffer_load_dwordx4 v13, s[32:35], s54 offen offset:1056 lds
v_mfma_f32_16x16x32_bf16 v[92:95], a[12:15], a[172:175], v[92:95]
ds_read_b64_tr_b16 a[82:83], v16 offset:51264
v_mfma_f32_16x16x32_bf16 v[96:99], a[16:19], a[160:163], v[96:99]
ds_read_b64_tr_b16 a[84:85], v16 offset:50784
v_mfma_f32_16x16x32_bf16 v[100:103], a[16:19], a[164:167], v[100:103]
ds_read_b64_tr_b16 a[86:87], v16 offset:51296
ds_read_b128 v[24:27], v2 offset:2048
v_mfma_f32_16x16x32_bf16 v[104:107], a[16:19], a[168:171], v[104:107]
v_mfma_f32_16x16x32_bf16 v[108:111], a[16:19], a[172:175], v[108:111]
ds_read_b64_tr_b16 a[88:89], v16 offset:59200
s_waitcnt lgkmcnt(5)
v_add_f32 v20, v20, v28
v_mfma_f32_16x16x32_bf16 v[112:115], a[20:23], a[160:163], v[112:115]
ds_read_b64_tr_b16 a[90:91], v16 offset:59712
v_mfma_f32_16x16x32_bf16 v[116:119], a[20:23], a[164:167], v[116:119]
buffer_load_dwordx4 a[148:151], v10, s[16:19], s52 offen offset:1024 sc1
v_mfma_f32_16x16x32_bf16 v[120:123], a[20:23], a[168:171], v[120:123]
ds_read_b64_tr_b16 a[92:93], v16 offset:59232
v_add_f32 v21, v21, v29
v_mfma_f32_16x16x32_bf16 v[124:127], a[20:23], a[172:175], v[124:127]
v_mfma_f32_16x16x32_bf16 v[128:131], a[24:27], a[160:163], v[128:131]
ds_read_b64_tr_b16 a[94:95], v16 offset:59744
v_add_f32 v22, v22, v30
v_mfma_f32_16x16x32_bf16 v[132:135], a[24:27], a[164:167], v[132:135]
ds_read_b64_tr_b16 a[96:97], v16 offset:50816
v_mfma_f32_16x16x32_bf16 v[136:139], a[24:27], a[168:171], v[136:139]
ds_read_b64_tr_b16 a[98:99], v16 offset:51328
v_mfma_f32_16x16x32_bf16 v[140:143], a[24:27], a[172:175], v[140:143]
v_add_f32 v23, v23, v31
v_mfma_f32_16x16x32_bf16 v[144:147], a[28:31], a[160:163], v[144:147]
buffer_load_dwordx4 v14, s[32:35], s54 offen offset:2112 lds
v_mfma_f32_16x16x32_bf16 v[148:151], a[28:31], a[164:167], v[148:151]
ds_read_b64_tr_b16 a[100:101], v16 offset:50848
v_mfma_f32_16x16x32_bf16 v[152:155], a[28:31], a[168:171], v[152:155]
ds_read_b64_tr_b16 a[102:103], v16 offset:51360
ds_read_b128 v[28:31], v2 offset:3072
v_mfma_f32_16x16x32_bf16 v[156:159], a[28:31], a[172:175], v[156:159]
ds_read_b64_tr_b16 a[104:105], v16 offset:59264
v_mfma_f32_16x16x32_bf16 v[160:163], a[32:35], a[160:163], v[160:163]
s_waitcnt lgkmcnt(10)
v_add_f32 v20, v20, v24
v_mfma_f32_16x16x32_bf16 v[164:167], a[32:35], a[164:167], v[164:167]
ds_read_b64_tr_b16 a[106:107], v16 offset:59776
v_mfma_f32_16x16x32_bf16 v[168:171], a[32:35], a[168:171], v[168:171]
buffer_load_dwordx4 a[152:155], v11, s[16:19], s52 offen sc1
v_mfma_f32_16x16x32_bf16 v[172:175], a[32:35], a[172:175], v[172:175]
ds_read_b64_tr_b16 a[108:109], v16 offset:59296
v_add_f32 v21, v21, v25
v_mfma_f32_16x16x32_bf16 v[176:179], a[36:39], a[160:163], v[176:179]
ds_read_b64_tr_b16 a[110:111], v16 offset:59808
v_mfma_f32_16x16x32_bf16 v[180:183], a[36:39], a[164:167], v[180:183]
v_add_f32 v22, v22, v26
v_mfma_f32_16x16x32_bf16 v[184:187], a[36:39], a[168:171], v[184:187]
ds_read_b64_tr_b16 a[112:113], v17 offset:50688
v_mfma_f32_16x16x32_bf16 v[188:191], a[36:39], a[172:175], v[188:191]
ds_read_b64_tr_b16 a[114:115], v17 offset:51200
v_add_f32 v23, v23, v27
v_mfma_f32_16x16x32_bf16 v[192:195], a[40:43], a[160:163], v[192:195]
ds_read_b64_tr_b16 a[116:117], v17 offset:50720
v_mfma_f32_16x16x32_bf16 v[196:199], a[40:43], a[164:167], v[196:199]
buffer_load_dwordx4 v15, s[32:35], s54 offen offset:3168 lds
v_mfma_f32_16x16x32_bf16 v[200:203], a[40:43], a[168:171], v[200:203]
s_add_u32 s54, s54, 229376
ds_read_b128 v[24:27], v2 offset:4096
v_mfma_f32_16x16x32_bf16 v[204:207], a[40:43], a[172:175], v[204:207]
ds_read_b64_tr_b16 a[118:119], v17 offset:51232
v_mfma_f32_16x16x32_bf16 v[208:211], a[44:47], a[160:163], v[208:211]
ds_read_b64_tr_b16 a[120:121], v17 offset:59136
v_mfma_f32_16x16x32_bf16 v[212:215], a[44:47], a[164:167], v[212:215]
ds_read_b64_tr_b16 a[122:123], v17 offset:59648
s_waitcnt lgkmcnt(11)
v_add_f32 v20, v20, v28
v_mfma_f32_16x16x32_bf16 v[216:219], a[44:47], a[168:171], v[216:219]
v_mfma_f32_16x16x32_bf16 v[220:223], a[44:47], a[172:175], v[220:223]
ds_read_b64_tr_b16 a[124:125], v17 offset:59168
v_add_f32 v21, v21, v29
v_mfma_f32_16x16x32_bf16 v[224:227], a[48:51], a[160:163], v[224:227]
buffer_load_dwordx4 a[156:159], v11, s[16:19], s52 offen offset:1024 sc1
v_mfma_f32_16x16x32_bf16 v[228:231], a[48:51], a[164:167], v[228:231]
ds_read_b64_tr_b16 a[126:127], v17 offset:59680
s_add_u32 s52, s52, 0x20000
v_mfma_f32_16x16x32_bf16 v[232:235], a[52:55], a[160:163], v[232:235]
v_add_f32 v22, v22, v30
v_mfma_f32_16x16x32_bf16 v[236:239], a[52:55], a[164:167], v[236:239]
v_mfma_f32_16x16x32_bf16 v[240:243], a[56:59], a[160:163], v[240:243]
v_add_f32 v23, v23, v31
v_mfma_f32_16x16x32_bf16 v[244:247], a[56:59], a[164:167], v[244:247]
ds_read_b128 v[28:31], v2 offset:5120
v_mfma_f32_16x16x32_bf16 v[248:251], a[60:63], a[160:163], v[248:251]
v_mfma_f32_16x16x32_bf16 v[252:255], a[60:63], a[164:167], v[252:255]
s_waitcnt lgkmcnt(0)
s_barrier
v_mfma_f32_16x16x32_bf16 v[32:35], a[64:67], a[176:179], v[32:35]
ds_read_b64_tr_b16 a[0:1], v16
s_add_u32 m0, s55, 135168
v_mfma_f32_16x16x32_bf16 v[36:39], a[64:67], a[180:183], v[36:39]
buffer_load_dwordx4 v12, s[32:35], s54 offen lds
v_mfma_f32_16x16x32_bf16 v[40:43], a[64:67], a[184:187], v[40:43]
ds_read_b64_tr_b16 a[2:3], v16 offset:512
v_add_f32 v20, v20, v24
v_mfma_f32_16x16x32_bf16 v[44:47], a[64:67], a[188:191], v[44:47]
ds_read_b64_tr_b16 a[4:5], v16 offset:32
v_add_f32 v21, v21, v25
v_mfma_f32_16x16x32_bf16 v[48:51], a[68:71], a[176:179], v[48:51]
v_add_f32 v22, v22, v26
v_mfma_f32_16x16x32_bf16 v[52:55], a[68:71], a[180:183], v[52:55]
ds_read_b64_tr_b16 a[6:7], v16 offset:544
v_add_f32 v23, v23, v27
v_mfma_f32_16x16x32_bf16 v[56:59], a[68:71], a[184:187], v[56:59]
ds_read_b64_tr_b16 a[8:9], v16 offset:8448
v_mfma_f32_16x16x32_bf16 v[60:63], a[68:71], a[188:191], v[60:63]
buffer_load_dwordx4 a[160:163], v10, s[16:19], s52 offen sc1
v_mfma_f32_16x16x32_bf16 v[64:67], a[72:75], a[176:179], v[64:67]
ds_read_b64_tr_b16 a[10:11], v16 offset:8960
ds_read_b128 v[24:27], v2 offset:6144
v_mfma_f32_16x16x32_bf16 v[68:71], a[72:75], a[180:183], v[68:71]
v_add_f32 v20, v20, v28
v_mfma_f32_16x16x32_bf16 v[72:75], a[72:75], a[184:187], v[72:75]
ds_read_b64_tr_b16 a[12:13], v16 offset:8480
v_add_f32 v21, v21, v29
v_mfma_f32_16x16x32_bf16 v[76:79], a[72:75], a[188:191], v[76:79]
ds_read_b64_tr_b16 a[14:15], v16 offset:8992
v_mfma_f32_16x16x32_bf16 v[80:83], a[76:79], a[176:179], v[80:83]
ds_read_b64_tr_b16 a[16:17], v16 offset:64
v_add_f32 v22, v22, v30
v_mfma_f32_16x16x32_bf16 v[84:87], a[76:79], a[180:183], v[84:87]
v_add_f32 v23, v23, v31
v_mfma_f32_16x16x32_bf16 v[88:91], a[76:79], a[184:187], v[88:91]
buffer_load_dwordx4 v13, s[32:35], s54 offen offset:1056 lds
v_mfma_f32_16x16x32_bf16 v[92:95], a[76:79], a[188:191], v[92:95]
ds_read_b64_tr_b16 a[18:19], v16 offset:576
ds_read_b128 v[28:31], v2 offset:7168
v_mfma_f32_16x16x32_bf16 v[96:99], a[80:83], a[176:179], v[96:99]
ds_read_b64_tr_b16 a[20:21], v16 offset:96
v_mfma_f32_16x16x32_bf16 v[100:103], a[80:83], a[180:183], v[100:103]
ds_read_b64_tr_b16 a[22:23], v16 offset:608
s_waitcnt lgkmcnt(7)
v_add_f32 v20, v20, v24
v_mfma_f32_16x16x32_bf16 v[104:107], a[80:83], a[184:187], v[104:107]
v_add_f32 v21, v21, v25
v_mfma_f32_16x16x32_bf16 v[108:111], a[80:83], a[188:191], v[108:111]
ds_read_b64_tr_b16 a[24:25], v16 offset:8512
v_add_f32 v22, v22, v26
v_mfma_f32_16x16x32_bf16 v[112:115], a[84:87], a[176:179], v[112:115]
ds_read_b64_tr_b16 a[26:27], v16 offset:9024
v_mfma_f32_16x16x32_bf16 v[116:119], a[84:87], a[180:183], v[116:119]
buffer_load_dwordx4 a[164:167], v10, s[16:19], s52 offen offset:1024 sc1
v_mfma_f32_16x16x32_bf16 v[120:123], a[84:87], a[184:187], v[120:123]
ds_read_b64_tr_b16 a[28:29], v16 offset:8544
v_add_f32 v23, v23, v27
v_mfma_f32_16x16x32_bf16 v[124:127], a[84:87], a[188:191], v[124:127]
s_waitcnt lgkmcnt(5)
v_add_f32 v20, v20, v28
v_mfma_f32_16x16x32_bf16 v[128:131], a[88:91], a[176:179], v[128:131]
ds_read_b64_tr_b16 a[30:31], v16 offset:9056
v_add_f32 v21, v21, v29
v_mfma_f32_16x16x32_bf16 v[132:135], a[88:91], a[180:183], v[132:135]
ds_read_b64_tr_b16 a[32:33], v16 offset:128
v_add_f32 v22, v22, v30
v_mfma_f32_16x16x32_bf16 v[136:139], a[88:91], a[184:187], v[136:139]
ds_read_b64_tr_b16 a[34:35], v16 offset:640
v_mfma_f32_16x16x32_bf16 v[140:143], a[88:91], a[188:191], v[140:143]
v_add_f32 v23, v23, v31
v_mfma_f32_16x16x32_bf16 v[144:147], a[92:95], a[176:179], v[144:147]
buffer_load_dwordx4 v14, s[32:35], s54 offen offset:2112 lds
v_mfma_f32_16x16x32_bf16 v[148:151], a[92:95], a[180:183], v[148:151]
ds_read_b64_tr_b16 a[36:37], v16 offset:160
v_permlane32_swap_b32 v20, v22
v_mfma_f32_16x16x32_bf16 v[152:155], a[92:95], a[184:187], v[152:155]
ds_read_b64_tr_b16 a[38:39], v16 offset:672
v_permlane32_swap_b32 v21, v23
v_mfma_f32_16x16x32_bf16 v[156:159], a[92:95], a[188:191], v[156:159]
ds_read_b64_tr_b16 a[40:41], v16 offset:8576
v_mfma_f32_16x16x32_bf16 v[160:163], a[96:99], a[176:179], v[160:163]
v_add_f32 v20, v20, v22
v_mfma_f32_16x16x32_bf16 v[164:167], a[96:99], a[180:183], v[164:167]
ds_read_b64_tr_b16 a[42:43], v16 offset:9088
v_add_f32 v21, v21, v23
v_mfma_f32_16x16x32_bf16 v[168:171], a[96:99], a[184:187], v[168:171]
buffer_load_dwordx4 a[168:171], v11, s[16:19], s52 offen sc1
v_mfma_f32_16x16x32_bf16 v[172:175], a[96:99], a[188:191], v[172:175]
ds_read_b64_tr_b16 a[44:45], v16 offset:8608
v_mul_f32 v20, 0xba800000, v20
v_mfma_f32_16x16x32_bf16 v[176:179], a[100:103], a[176:179], v[176:179]
ds_read_b64_tr_b16 a[46:47], v16 offset:9120
v_mfma_f32_16x16x32_bf16 v[180:183], a[100:103], a[180:183], v[180:183]
v_mul_f32 v21, 0x3a800000, v21
v_fma_f32 v21, -v20, v20, v21
v_mfma_f32_16x16x32_bf16 v[184:187], a[100:103], a[184:187], v[184:187]
ds_read_b64_tr_b16 a[48:49], v17
v_mfma_f32_16x16x32_bf16 v[188:191], a[100:103], a[188:191], v[188:191]
ds_read_b64_tr_b16 a[50:51], v17 offset:512
v_max_f32 v21, 0, v21
v_mfma_f32_16x16x32_bf16 v[192:195], a[104:107], a[176:179], v[192:195]
ds_read_b64_tr_b16 a[52:53], v17 offset:32
v_mfma_f32_16x16x32_bf16 v[196:199], a[104:107], a[180:183], v[196:199]
buffer_load_dwordx4 v15, s[32:35], s54 offen offset:3168 lds
v_mfma_f32_16x16x32_bf16 v[200:203], a[104:107], a[184:187], v[200:203]
s_add_u32 s54, s54, 229376
v_add_f32 v21, 0x3727c5ac, v21
v_rsq_f32 v22, v21
v_mfma_f32_16x16x32_bf16 v[204:207], a[104:107], a[188:191], v[204:207]
.Lpad29:
s_cbranch_execz .Lnopoll60r
ds_read_b64_tr_b16 a[54:55], v17 offset:544
v_mfma_f32_16x16x32_bf16 v[208:211], a[108:111], a[176:179], v[208:211]
ds_read_b64_tr_b16 a[56:57], v17 offset:8448
v_and_b32 v24, 31, v1
v_mfma_f32_16x16x32_bf16 v[212:215], a[108:111], a[180:183], v[212:215]
ds_read_b64_tr_b16 a[58:59], v17 offset:8960
v_mfma_f32_16x16x32_bf16 v[216:219], a[108:111], a[184:187], v[216:219]
v_lshrrev_b32 v25, 5, v1
v_lshl_add_u32 v24, v24, 1, v25
v_mfma_f32_16x16x32_bf16 v[220:223], a[108:111], a[188:191], v[220:223]
ds_read_b64_tr_b16 a[60:61], v17 offset:8480
v_mfma_f32_16x16x32_bf16 v[224:227], a[112:115], a[176:179], v[224:227]
buffer_load_dwordx4 a[172:175], v11, s[16:19], s52 offen offset:1024 sc1
v_mfma_f32_16x16x32_bf16 v[228:231], a[112:115], a[180:183], v[228:231]
ds_read_b64_tr_b16 a[62:63], v17 offset:8992
s_add_u32 s52, s52, 0x20000
v_mfma_f32_16x16x32_bf16 v[232:235], a[116:119], a[176:179], v[232:235]
v_and_b32 v25, 0xc0, v0
v_add_u32 v24, v24, v25
v_mfma_f32_16x16x32_bf16 v[236:239], a[116:119], a[180:183], v[236:239]
v_lshlrev_b32 v24, 4, v24
v_mfma_f32_16x16x32_bf16 v[240:243], a[120:123], a[176:179], v[240:243]
v_add_u32 v24, 152576, v24
v_mfma_f32_16x16x32_bf16 v[244:247], a[120:123], a[180:183], v[244:247]
v_mul_f32 v22, 0xbfb8aa3b, v22
v_mfma_f32_16x16x32_bf16 v[248:251], a[124:127], a[176:179], v[248:251]
ds_write_b128 v24, v[20:23]
v_mfma_f32_16x16x32_bf16 v[252:255], a[124:127], a[180:183], v[252:255]
s_lshl_b32 s74, s3, 10
s_lshl_b32 s75, s12, 9
s_add_u32 s74, s74, s75
s_add_u32 s74, s74, 152576
v_and_b32 v2, 15, v1
v_lshl_add_u32 v2, v2, 4, s74
v_xor_b32 v8, 512, v2
ds_read_b64 v[20:21], v2
ds_read_b64 v[22:23], v2 offset:256
ds_read_b64 v[24:25], v8
ds_read_b64 v[26:27], v8 offset:256
ds_read_b32 v28, v2 offset:8
ds_read_b32 v29, v2 offset:264
ds_read_b32 v30, v8 offset:8
ds_read_b32 v31, v8 offset:264
s_lshl_b32 s74, s12, 7
s_add_u32 s74, s74, 161536
s_xor_b32 s75, s12, 1
s_mul_i32 s75, s75, 384
s_add_u32 s75, s75, 161536
v_lshrrev_b32 v9, 4, v1
v_lshlrev_b32 v9, 4, v9
v_add_u32 v8, s75, v9
v_add_u32 v9, s74, v9
s_mul_i32 s66, s13, 917504
s_add_u32 s66, s66, 46137344
s_add_u32 s65, s66, 393216
s_lshl_b32 s62, s12, 19
s_add_u32 s62, s62, s66
s_add_u32 s63, s62, 0x20000
s_add_u32 s64, s62, 0x40000
s_mov_b32 s58, -131072
s_sub_u32 s67, s59, 16896
s_mov_b32 s15, -6
.p2align 6
.Lk62:
s_waitcnt vmcnt(17) lgkmcnt(0)
s_barrier
v_mfma_f32_16x16x32_bf16 v[32:35], a[0:3], a[128:131], v[32:35]
ds_read_b64_tr_b16 a[64:65], v16 offset:16896
s_add_u32 m0, s55, 84480
v_mfma_f32_16x16x32_bf16 v[36:39], a[0:3], a[132:135], v[36:39]
buffer_load_dwordx4 v12, s[32:35], s54 offen lds
v_mfma_f32_16x16x32_bf16 v[40:43], a[0:3], a[136:139], v[40:43]
ds_read_b64_tr_b16 a[66:67], v16 offset:17408
s_waitcnt vmcnt(17)
v_mfma_f32_16x16x32_bf16 v[44:47], a[0:3], a[140:143], v[44:47]
ds_read_b64_tr_b16 a[68:69], v16 offset:16928
v_mfma_f32_16x16x32_bf16 v[48:51], a[4:7], a[128:131], v[48:51]
ds_read_b64_tr_b16 a[70:71], v16 offset:17440
v_mfma_f32_16x16x32_bf16 v[52:55], a[4:7], a[132:135], v[52:55]
v_mfma_f32_16x16x32_bf16 v[56:59], a[4:7], a[136:139], v[56:59]
ds_read_b64_tr_b16 a[72:73], v16 offset:25344
v_mfma_f32_16x16x32_bf16 v[60:63], a[4:7], a[140:143], v[60:63]
buffer_load_dwordx4 a[176:179], v10, s[16:19], s52 offen sc1
v_mfma_f32_16x16x32_bf16 v[64:67], a[8:11], a[128:131], v[64:67]
ds_read_b64_tr_b16 a[74:75], v16 offset:25856
v_mfma_f32_16x16x32_bf16 v[68:71], a[8:11], a[132:135], v[68:71]
ds_read_b64_tr_b16 a[76:77], v16 offset:25376
v_mfma_f32_16x16x32_bf16 v[72:75], a[8:11], a[136:139], v[72:75]
v_mfma_f32_16x16x32_bf16 v[76:79], a[8:11], a[140:143], v[76:79]
ds_read_b64_tr_b16 a[78:79], v16 offset:25888
v_mfma_f32_16x16x32_bf16 v[80:83], a[12:15], a[128:131], v[80:83]
ds_read_b64_tr_b16 a[80:81], v16 offset:16960
v_mfma_f32_16x16x32_bf16 v[84:87], a[12:15], a[132:135], v[84:87]
buffer_load_dwordx4 v13, s[32:35], s54 offen offset:1056 lds
v_mfma_f32_16x16x32_bf16 v[88:91], a[12:15], a[136:139], v[88:91]
ds_read_b64_tr_b16 a[82:83], v16 offset:17472
v_mfma_f32_16x16x32_bf16 v[92:95], a[12:15], a[140:143], v[92:95]
v_mfma_f32_16x16x32_bf16 v[96:99], a[16:19], a[128:131], v[96:99]
ds_read_b64_tr_b16 a[84:85], v16 offset:16992
v_mfma_f32_16x16x32_bf16 v[100:103], a[16:19], a[132:135], v[100:103]
ds_read_b64_tr_b16 a[86:87], v16 offset:17504
v_mfma_f32_16x16x32_bf16 v[104:107], a[16:19], a[136:139], v[104:107]
ds_read_b64_tr_b16 a[88:89], v16 offset:25408
v_mfma_f32_16x16x32_bf16 v[108:111], a[16:19], a[140:143], v[108:111]
buffer_load_dwordx4 a[180:183], v10, s[16:19], s52 offen offset:1024 sc1
v_mfma_f32_16x16x32_bf16 v[112:115], a[20:23], a[128:131], v[112:115]
v_mfma_f32_16x16x32_bf16 v[116:119], a[20:23], a[132:135], v[116:119]
ds_read_b64_tr_b16 a[90:91], v16 offset:25920
v_mfma_f32_16x16x32_bf16 v[120:123], a[20:23], a[136:139], v[120:123]
ds_read_b64_tr_b16 a[92:93], v16 offset:25440
v_mfma_f32_16x16x32_bf16 v[124:127], a[20:23], a[140:143], v[124:127]
ds_read_b64_tr_b16 a[94:95], v16 offset:25952
v_mfma_f32_16x16x32_bf16 v[128:131], a[24:27], a[128:131], v[128:131]
v_mfma_f32_16x16x32_bf16 v[132:135], a[24:27], a[132:135], v[132:135]
buffer_load_dwordx4 v14, s[32:35], s54 offen offset:2112 lds
v_mfma_f32_16x16x32_bf16 v[136:139], a[24:27], a[136:139], v[136:139]
ds_read_b64_tr_b16 a[96:97], v16 offset:17024
v_mfma_f32_16x16x32_bf16 v[140:143], a[24:27], a[140:143], v[140:143]
ds_read_b64_tr_b16 a[98:99], v16 offset:17536
v_mfma_f32_16x16x32_bf16 v[144:147], a[28:31], a[128:131], v[144:147]
ds_read_b64_tr_b16 a[100:101], v16 offset:17056
v_mfma_f32_16x16x32_bf16 v[148:151], a[28:31], a[132:135], v[148:151]
ds_read_b64_tr_b16 a[102:103], v16 offset:17568
v_mfma_f32_16x16x32_bf16 v[152:155], a[28:31], a[136:139], v[152:155]
v_mfma_f32_16x16x32_bf16 v[156:159], a[28:31], a[140:143], v[156:159]
buffer_load_dwordx4 a[184:187], v11, s[16:19], s52 offen sc1
v_mfma_f32_16x16x32_bf16 v[160:163], a[32:35], a[128:131], v[160:163]
ds_read_b64_tr_b16 a[104:105], v16 offset:25472
v_mfma_f32_16x16x32_bf16 v[164:167], a[32:35], a[132:135], v[164:167]
ds_read_b64_tr_b16 a[106:107], v16 offset:25984
v_mfma_f32_16x16x32_bf16 v[168:171], a[32:35], a[136:139], v[168:171]
ds_read_b64_tr_b16 a[108:109], v16 offset:25504
v_mfma_f32_16x16x32_bf16 v[172:175], a[32:35], a[140:143], v[172:175]
v_mfma_f32_16x16x32_bf16 v[176:179], a[36:39], a[128:131], v[176:179]
ds_read_b64_tr_b16 a[110:111], v16 offset:26016
v_mfma_f32_16x16x32_bf16 v[180:183], a[36:39], a[132:135], v[180:183]
buffer_load_dwordx4 v15, s[32:35], s54 offen offset:3168 lds
v_mfma_f32_16x16x32_bf16 v[184:187], a[36:39], a[136:139], v[184:187]
ds_read_b64_tr_b16 a[112:113], v17 offset:16896
s_add_u32 s54, s54, 229376
v_mfma_f32_16x16x32_bf16 v[188:191], a[36:39], a[140:143], v[188:191]
ds_read_b64_tr_b16 a[114:115], v17 offset:17408
v_mfma_f32_16x16x32_bf16 v[192:195], a[40:43], a[128:131], v[192:195]
v_mfma_f32_16x16x32_bf16 v[196:199], a[40:43], a[132:135], v[196:199]
ds_read_b64_tr_b16 a[116:117], v17 offset:16928
v_mfma_f32_16x16x32_bf16 v[200:203], a[40:43], a[136:139], v[200:203]
ds_read_b64_tr_b16 a[118:119], v17 offset:17440
v_mfma_f32_16x16x32_bf16 v[204:207], a[40:43], a[140:143], v[204:207]
buffer_load_dwordx4 a[188:191], v11, s[16:19], s52 offen offset:1024 sc1
v_mfma_f32_16x16x32_bf16 v[208:211], a[44:47], a[128:131], v[208:211]
ds_read_b64_tr_b16 a[120:121], v17 offset:25344
s_add_u32 s52, s52, 0x20000
v_mfma_f32_16x16x32_bf16 v[212:215], a[44:47], a[132:135], v[212:215]
v_mfma_f32_16x16x32_bf16 v[216:219], a[44:47], a[136:139], v[216:219]
ds_read_b64_tr_b16 a[122:123], v17 offset:25856
v_mfma_f32_16x16x32_bf16 v[220:223], a[44:47], a[140:143], v[220:223]
ds_read_b64_tr_b16 a[124:125], v17 offset:25376
v_mfma_f32_16x16x32_bf16 v[224:227], a[48:51], a[128:131], v[224:227]
ds_read_b64_tr_b16 a[126:127], v17 offset:25888
s_max_i32 m0, s67, s59
v_mfma_f32_16x16x32_bf16 v[228:231], a[48:51], a[132:135], v[228:231]
buffer_load_dwordx4 v5, s[28:31], s58 offen lds
v_mfma_f32_16x16x32_bf16 v[232:235], a[52:55], a[128:131], v[232:235]
v_mfma_f32_16x16x32_bf16 v[236:239], a[52:55], a[132:135], v[236:239]
v_mfma_f32_16x16x32_bf16 v[240:243], a[56:59], a[128:131], v[240:243]
v_mfma_f32_16x16x32_bf16 v[244:247], a[56:59], a[132:135], v[244:247]
v_mfma_f32_16x16x32_bf16 v[248:251], a[60:63], a[128:131], v[248:251]
v_mfma_f32_16x16x32_bf16 v[252:255], a[60:63], a[132:135], v[252:255]
s_waitcnt vmcnt(18) lgkmcnt(0)
s_barrier
v_mfma_f32_16x16x32_bf16 v[32:35], a[64:67], a[144:147], v[32:35]
ds_read_b64_tr_b16 a[0:1], v16 offset:33792
s_add_u32 m0, s55, 101376
v_mfma_f32_16x16x32_bf16 v[36:39], a[64:67], a[148:151], v[36:39]
buffer_load_dwordx4 v12, s[32:35], s54 offen lds
v_mfma_f32_16x16x32_bf16 v[40:43], a[64:67], a[152:155], v[40:43]
ds_read_b64_tr_b16 a[2:3], v16 offset:34304
s_waitcnt vmcnt(18)
v_mfma_f32_16x16x32_bf16 v[44:47], a[64:67], a[156:159], v[44:47]
ds_read_b64_tr_b16 a[4:5], v16 offset:33824
v_mfma_f32_16x16x32_bf16 v[48:51], a[68:71], a[144:147], v[48:51]
ds_read_b64_tr_b16 a[6:7], v16 offset:34336
v_mfma_f32_16x16x32_bf16 v[52:55], a[68:71], a[148:151], v[52:55]
v_mfma_f32_16x16x32_bf16 v[56:59], a[68:71], a[152:155], v[56:59]
ds_read_b64_tr_b16 a[8:9], v16 offset:42240
v_mfma_f32_16x16x32_bf16 v[60:63], a[68:71], a[156:159], v[60:63]
buffer_load_dwordx4 a[128:131], v10, s[16:19], s52 offen sc1
v_mfma_f32_16x16x32_bf16 v[64:67], a[72:75], a[144:147], v[64:67]
ds_read_b64_tr_b16 a[10:11], v16 offset:42752
v_mfma_f32_16x16x32_bf16 v[68:71], a[72:75], a[148:151], v[68:71]
ds_read_b64_tr_b16 a[12:13], v16 offset:42272
v_mfma_f32_16x16x32_bf16 v[72:75], a[72:75], a[152:155], v[72:75]
ds_read_b64_tr_b16 a[14:15], v16 offset:42784
v_mfma_f32_16x16x32_bf16 v[76:79], a[72:75], a[156:159], v[76:79]
v_mfma_f32_16x16x32_bf16 v[80:83], a[76:79], a[144:147], v[80:83]
ds_read_b64_tr_b16 a[16:17], v16 offset:33856
v_mfma_f32_16x16x32_bf16 v[84:87], a[76:79], a[148:151], v[84:87]
buffer_load_dwordx4 v13, s[32:35], s54 offen offset:1056 lds
v_mfma_f32_16x16x32_bf16 v[88:91], a[76:79], a[152:155], v[88:91]
ds_read_b64_tr_b16 a[18:19], v16 offset:34368
v_mfma_f32_16x16x32_bf16 v[92:95], a[76:79], a[156:159], v[92:95]
ds_read_b64_tr_b16 a[20:21], v16 offset:33888
v_mfma_f32_16x16x32_bf16 v[96:99], a[80:83], a[144:147], v[96:99]
v_mfma_f32_16x16x32_bf16 v[100:103], a[80:83], a[148:151], v[100:103]
ds_read_b64_tr_b16 a[22:23], v16 offset:34400
v_mfma_f32_16x16x32_bf16 v[104:107], a[80:83], a[152:155], v[104:107]
ds_read_b64_tr_b16 a[24:25], v16 offset:42304
v_mfma_f32_16x16x32_bf16 v[108:111], a[80:83], a[156:159], v[108:111]
buffer_load_dwordx4 a[132:135], v10, s[16:19], s52 offen offset:1024 sc1
v_mfma_f32_16x16x32_bf16 v[112:115], a[84:87], a[144:147], v[112:115]
ds_read_b64_tr_b16 a[26:27], v16 offset:42816
v_mfma_f32_16x16x32_bf16 v[116:119], a[84:87], a[148:151], v[116:119]
ds_read_b64_tr_b16 a[28:29], v16 offset:42336
v_mfma_f32_16x16x32_bf16 v[120:123], a[84:87], a[152:155], v[120:123]
v_mfma_f32_16x16x32_bf16 v[124:127], a[84:87], a[156:159], v[124:127]
ds_read_b64_tr_b16 a[30:31], v16 offset:42848
v_mfma_f32_16x16x32_bf16 v[128:131], a[88:91], a[144:147], v[128:131]
ds_read_b64_tr_b16 a[32:33], v16 offset:33920
v_mfma_f32_16x16x32_bf16 v[132:135], a[88:91], a[148:151], v[132:135]
buffer_load_dwordx4 v14, s[32:35], s54 offen offset:2112 lds
v_mfma_f32_16x16x32_bf16 v[136:139], a[88:91], a[152:155], v[136:139]
ds_read_b64_tr_b16 a[34:35], v16 offset:34432
v_mfma_f32_16x16x32_bf16 v[140:143], a[88:91], a[156:159], v[140:143]
v_mfma_f32_16x16x32_bf16 v[144:147], a[92:95], a[144:147], v[144:147]
ds_read_b64_tr_b16 a[36:37], v16 offset:33952
v_mfma_f32_16x16x32_bf16 v[148:151], a[92:95], a[148:151], v[148:151]
ds_read_b64_tr_b16 a[38:39], v16 offset:34464
v_mfma_f32_16x16x32_bf16 v[152:155], a[92:95], a[152:155], v[152:155]
ds_read_b64_tr_b16 a[40:41], v16 offset:42368
v_mfma_f32_16x16x32_bf16 v[156:159], a[92:95], a[156:159], v[156:159]
buffer_load_dwordx4 a[136:139], v11, s[16:19], s52 offen sc1
v_mfma_f32_16x16x32_bf16 v[160:163], a[96:99], a[144:147], v[160:163]
ds_read_b64_tr_b16 a[42:43], v16 offset:42880
v_mfma_f32_16x16x32_bf16 v[164:167], a[96:99], a[148:151], v[164:167]
v_mfma_f32_16x16x32_bf16 v[168:171], a[96:99], a[152:155], v[168:171]
ds_read_b64_tr_b16 a[44:45], v16 offset:42400
v_mfma_f32_16x16x32_bf16 v[172:175], a[96:99], a[156:159], v[172:175]
ds_read_b64_tr_b16 a[46:47], v16 offset:42912
v_mfma_f32_16x16x32_bf16 v[176:179], a[100:103], a[144:147], v[176:179]
ds_read_b64_tr_b16 a[48:49], v17 offset:33792
v_mfma_f32_16x16x32_bf16 v[180:183], a[100:103], a[148:151], v[180:183]
buffer_load_dwordx4 v15, s[32:35], s54 offen offset:3168 lds
v_mfma_f32_16x16x32_bf16 v[184:187], a[100:103], a[152:155], v[184:187]
s_add_u32 s54, s54, 229376
v_mfma_f32_16x16x32_bf16 v[188:191], a[100:103], a[156:159], v[188:191]
ds_read_b64_tr_b16 a[50:51], v17 offset:34304
v_mfma_f32_16x16x32_bf16 v[192:195], a[104:107], a[144:147], v[192:195]
ds_read_b64_tr_b16 a[52:53], v17 offset:33824
v_mfma_f32_16x16x32_bf16 v[196:199], a[104:107], a[148:151], v[196:199]
ds_read_b64_tr_b16 a[54:55], v17 offset:34336
v_mfma_f32_16x16x32_bf16 v[200:203], a[104:107], a[152:155], v[200:203]
ds_read_b64_tr_b16 a[56:57], v17 offset:42240
v_mfma_f32_16x16x32_bf16 v[204:207], a[104:107], a[156:159], v[204:207]
buffer_load_dwordx4 a[140:143], v11, s[16:19], s52 offen offset:1024 sc1
v_mfma_f32_16x16x32_bf16 v[208:211], a[108:111], a[144:147], v[208:211]
s_add_u32 s52, s52, 0x20000
v_mfma_f32_16x16x32_bf16 v[212:215], a[108:111], a[148:151], v[212:215]
ds_read_b64_tr_b16 a[58:59], v17 offset:42752
v_mfma_f32_16x16x32_bf16 v[216:219], a[108:111], a[152:155], v[216:219]
ds_read_b64_tr_b16 a[60:61], v17 offset:42272
v_mfma_f32_16x16x32_bf16 v[220:223], a[108:111], a[156:159], v[220:223]
ds_read_b64_tr_b16 a[62:63], v17 offset:42784
v_mfma_f32_16x16x32_bf16 v[224:227], a[112:115], a[144:147], v[224:227]
s_max_i32 m0, s67, s59
v_mfma_f32_16x16x32_bf16 v[228:231], a[112:115], a[148:151], v[228:231]
buffer_load_dwordx4 v6, s[28:31], s58 offen offset:1056 lds
v_mfma_f32_16x16x32_bf16 v[232:235], a[116:119], a[144:147], v[232:235]
s_add_u32 s67, s67, 8448
s_add_u32 s58, s58, 0x10000
v_mfma_f32_16x16x32_bf16 v[236:239], a[116:119], a[148:151], v[236:239]
v_mfma_f32_16x16x32_bf16 v[240:243], a[120:123], a[144:147], v[240:243]
v_mfma_f32_16x16x32_bf16 v[244:247], a[120:123], a[148:151], v[244:247]
v_mfma_f32_16x16x32_bf16 v[248:251], a[124:127], a[144:147], v[248:251]
v_mfma_f32_16x16x32_bf16 v[252:255], a[124:127], a[148:151], v[252:255]
s_waitcnt vmcnt(19) lgkmcnt(0)
s_barrier
v_mfma_f32_16x16x32_bf16 v[32:35], a[0:3], a[160:163], v[32:35]
ds_read_b64_tr_b16 a[64:65], v16 offset:50688
s_add_u32 m0, s55, 118272
v_mfma_f32_16x16x32_bf16 v[36:39], a[0:3], a[164:167], v[36:39]
buffer_load_dwordx4 v12, s[32:35], s54 offen lds
v_mfma_f32_16x16x32_bf16 v[40:43], a[0:3], a[168:171], v[40:43]
ds_read_b64_tr_b16 a[66:67], v16 offset:51200
s_waitcnt vmcnt(19)
v_mfma_f32_16x16x32_bf16 v[44:47], a[0:3], a[172:175], v[44:47]
ds_read_b64_tr_b16 a[68:69], v16 offset:50720
v_mfma_f32_16x16x32_bf16 v[48:51], a[4:7], a[160:163], v[48:51]
ds_read_b64_tr_b16 a[70:71], v16 offset:51232
v_mfma_f32_16x16x32_bf16 v[52:55], a[4:7], a[164:167], v[52:55]
v_mfma_f32_16x16x32_bf16 v[56:59], a[4:7], a[168:171], v[56:59]
ds_read_b64_tr_b16 a[72:73], v16 offset:59136
v_mfma_f32_16x16x32_bf16 v[60:63], a[4:7], a[172:175], v[60:63]
buffer_load_dwordx4 a[144:147], v10, s[16:19], s52 offen sc1
v_mfma_f32_16x16x32_bf16 v[64:67], a[8:11], a[160:163], v[64:67]
ds_read_b64_tr_b16 a[74:75], v16 offset:59648
v_mfma_f32_16x16x32_bf16 v[68:71], a[8:11], a[164:167], v[68:71]
ds_read_b64_tr_b16 a[76:77], v16 offset:59168
v_mfma_f32_16x16x32_bf16 v[72:75], a[8:11], a[168:171], v[72:75]
v_mfma_f32_16x16x32_bf16 v[76:79], a[8:11], a[172:175], v[76:79]
ds_read_b64_tr_b16 a[78:79], v16 offset:59680
v_mfma_f32_16x16x32_bf16 v[80:83], a[12:15], a[160:163], v[80:83]
ds_read_b64_tr_b16 a[80:81], v16 offset:50752
v_mfma_f32_16x16x32_bf16 v[84:87], a[12:15], a[164:167], v[84:87]
buffer_load_dwordx4 v13, s[32:35], s54 offen offset:1056 lds
v_mfma_f32_16x16x32_bf16 v[88:91], a[12:15], a[168:171], v[88:91]
ds_read_b64_tr_b16 a[82:83], v16 offset:51264
v_mfma_f32_16x16x32_bf16 v[92:95], a[12:15], a[172:175], v[92:95]
v_mfma_f32_16x16x32_bf16 v[96:99], a[16:19], a[160:163], v[96:99]
ds_read_b64_tr_b16 a[84:85], v16 offset:50784
v_mfma_f32_16x16x32_bf16 v[100:103], a[16:19], a[164:167], v[100:103]
ds_read_b64_tr_b16 a[86:87], v16 offset:51296
v_mfma_f32_16x16x32_bf16 v[104:107], a[16:19], a[168:171], v[104:107]
ds_read_b64_tr_b16 a[88:89], v16 offset:59200
v_mfma_f32_16x16x32_bf16 v[108:111], a[16:19], a[172:175], v[108:111]
buffer_load_dwordx4 a[148:151], v10, s[16:19], s52 offen offset:1024 sc1
v_mfma_f32_16x16x32_bf16 v[112:115], a[20:23], a[160:163], v[112:115]
v_mfma_f32_16x16x32_bf16 v[116:119], a[20:23], a[164:167], v[116:119]
ds_read_b64_tr_b16 a[90:91], v16 offset:59712
v_mfma_f32_16x16x32_bf16 v[120:123], a[20:23], a[168:171], v[120:123]
ds_read_b64_tr_b16 a[92:93], v16 offset:59232
v_mfma_f32_16x16x32_bf16 v[124:127], a[20:23], a[172:175], v[124:127]
ds_read_b64_tr_b16 a[94:95], v16 offset:59744
v_mfma_f32_16x16x32_bf16 v[128:131], a[24:27], a[160:163], v[128:131]
v_mfma_f32_16x16x32_bf16 v[132:135], a[24:27], a[164:167], v[132:135]
buffer_load_dwordx4 v14, s[32:35], s54 offen offset:2112 lds
v_mfma_f32_16x16x32_bf16 v[136:139], a[24:27], a[168:171], v[136:139]
ds_read_b64_tr_b16 a[96:97], v16 offset:50816
v_mfma_f32_16x16x32_bf16 v[140:143], a[24:27], a[172:175], v[140:143]
ds_read_b64_tr_b16 a[98:99], v16 offset:51328
v_mfma_f32_16x16x32_bf16 v[144:147], a[28:31], a[160:163], v[144:147]
ds_read_b64_tr_b16 a[100:101], v16 offset:50848
v_mfma_f32_16x16x32_bf16 v[148:151], a[28:31], a[164:167], v[148:151]
ds_read_b64_tr_b16 a[102:103], v16 offset:51360
v_mfma_f32_16x16x32_bf16 v[152:155], a[28:31], a[168:171], v[152:155]
v_mfma_f32_16x16x32_bf16 v[156:159], a[28:31], a[172:175], v[156:159]
buffer_load_dwordx4 a[152:155], v11, s[16:19], s52 offen sc1
v_mfma_f32_16x16x32_bf16 v[160:163], a[32:35], a[160:163], v[160:163]
ds_read_b64_tr_b16 a[104:105], v16 offset:59264
v_mfma_f32_16x16x32_bf16 v[164:167], a[32:35], a[164:167], v[164:167]
ds_read_b64_tr_b16 a[106:107], v16 offset:59776
v_mfma_f32_16x16x32_bf16 v[168:171], a[32:35], a[168:171], v[168:171]
ds_read_b64_tr_b16 a[108:109], v16 offset:59296
v_mfma_f32_16x16x32_bf16 v[172:175], a[32:35], a[172:175], v[172:175]
v_mfma_f32_16x16x32_bf16 v[176:179], a[36:39], a[160:163], v[176:179]
ds_read_b64_tr_b16 a[110:111], v16 offset:59808
v_mfma_f32_16x16x32_bf16 v[180:183], a[36:39], a[164:167], v[180:183]
buffer_load_dwordx4 v15, s[32:35], s54 offen offset:3168 lds
v_mfma_f32_16x16x32_bf16 v[184:187], a[36:39], a[168:171], v[184:187]
ds_read_b64_tr_b16 a[112:113], v17 offset:50688
s_add_u32 s54, s54, 229376
v_mfma_f32_16x16x32_bf16 v[188:191], a[36:39], a[172:175], v[188:191]
ds_read_b64_tr_b16 a[114:115], v17 offset:51200
v_mfma_f32_16x16x32_bf16 v[192:195], a[40:43], a[160:163], v[192:195]
v_mfma_f32_16x16x32_bf16 v[196:199], a[40:43], a[164:167], v[196:199]
ds_read_b64_tr_b16 a[116:117], v17 offset:50720
v_mfma_f32_16x16x32_bf16 v[200:203], a[40:43], a[168:171], v[200:203]
ds_read_b64_tr_b16 a[118:119], v17 offset:51232
v_mfma_f32_16x16x32_bf16 v[204:207], a[40:43], a[172:175], v[204:207]
buffer_load_dwordx4 a[156:159], v11, s[16:19], s52 offen offset:1024 sc1
v_mfma_f32_16x16x32_bf16 v[208:211], a[44:47], a[160:163], v[208:211]
ds_read_b64_tr_b16 a[120:121], v17 offset:59136
s_add_u32 s52, s52, 0x20000
v_mfma_f32_16x16x32_bf16 v[212:215], a[44:47], a[164:167], v[212:215]
v_mfma_f32_16x16x32_bf16 v[216:219], a[44:47], a[168:171], v[216:219]
ds_read_b64_tr_b16 a[122:123], v17 offset:59648
v_mfma_f32_16x16x32_bf16 v[220:223], a[44:47], a[172:175], v[220:223]
ds_read_b64_tr_b16 a[124:125], v17 offset:59168
v_mfma_f32_16x16x32_bf16 v[224:227], a[48:51], a[160:163], v[224:227]
ds_read_b64_tr_b16 a[126:127], v17 offset:59680
s_max_i32 m0, s67, s59
v_mfma_f32_16x16x32_bf16 v[228:231], a[48:51], a[164:167], v[228:231]
buffer_load_dwordx4 v5, s[28:31], s58 offen lds
v_mfma_f32_16x16x32_bf16 v[232:235], a[52:55], a[160:163], v[232:235]
v_mfma_f32_16x16x32_bf16 v[236:239], a[52:55], a[164:167], v[236:239]
v_mfma_f32_16x16x32_bf16 v[240:243], a[56:59], a[160:163], v[240:243]
v_mfma_f32_16x16x32_bf16 v[244:247], a[56:59], a[164:167], v[244:247]
v_mfma_f32_16x16x32_bf16 v[248:251], a[60:63], a[160:163], v[248:251]
v_mfma_f32_16x16x32_bf16 v[252:255], a[60:63], a[164:167], v[252:255]
s_waitcnt vmcnt(20) lgkmcnt(0)
s_barrier
v_mfma_f32_16x16x32_bf16 v[32:35], a[64:67], a[176:179], v[32:35]
ds_read_b64_tr_b16 a[0:1], v16
s_add_u32 m0, s55, 135168
v_mfma_f32_16x16x32_bf16 v[36:39], a[64:67], a[180:183], v[36:39]
buffer_load_dwordx4 v12, s[32:35], s54 offen lds
v_mfma_f32_16x16x32_bf16 v[40:43], a[64:67], a[184:187], v[40:43]
ds_read_b64_tr_b16 a[2:3], v16 offset:512
s_waitcnt vmcnt(20)
v_mfma_f32_16x16x32_bf16 v[44:47], a[64:67], a[188:191], v[44:47]
ds_read_b64_tr_b16 a[4:5], v16 offset:32
v_mfma_f32_16x16x32_bf16 v[48:51], a[68:71], a[176:179], v[48:51]
ds_read_b64_tr_b16 a[6:7], v16 offset:544
v_mfma_f32_16x16x32_bf16 v[52:55], a[68:71], a[180:183], v[52:55]
v_mfma_f32_16x16x32_bf16 v[56:59], a[68:71], a[184:187], v[56:59]
ds_read_b64_tr_b16 a[8:9], v16 offset:8448
v_mfma_f32_16x16x32_bf16 v[60:63], a[68:71], a[188:191], v[60:63]
buffer_load_dwordx4 a[160:163], v10, s[16:19], s52 offen sc1
v_mfma_f32_16x16x32_bf16 v[64:67], a[72:75], a[176:179], v[64:67]
ds_read_b64_tr_b16 a[10:11], v16 offset:8960
v_mfma_f32_16x16x32_bf16 v[68:71], a[72:75], a[180:183], v[68:71]
ds_read_b64_tr_b16 a[12:13], v16 offset:8480
v_mfma_f32_16x16x32_bf16 v[72:75], a[72:75], a[184:187], v[72:75]
ds_read_b64_tr_b16 a[14:15], v16 offset:8992
v_mfma_f32_16x16x32_bf16 v[76:79], a[72:75], a[188:191], v[76:79]
v_mfma_f32_16x16x32_bf16 v[80:83], a[76:79], a[176:179], v[80:83]
ds_read_b64_tr_b16 a[16:17], v16 offset:64
v_mfma_f32_16x16x32_bf16 v[84:87], a[76:79], a[180:183], v[84:87]
buffer_load_dwordx4 v13, s[32:35], s54 offen offset:1056 lds
v_mfma_f32_16x16x32_bf16 v[88:91], a[76:79], a[184:187], v[88:91]
ds_read_b64_tr_b16 a[18:19], v16 offset:576
v_mfma_f32_16x16x32_bf16 v[92:95], a[76:79], a[188:191], v[92:95]
ds_read_b64_tr_b16 a[20:21], v16 offset:96
v_mfma_f32_16x16x32_bf16 v[96:99], a[80:83], a[176:179], v[96:99]
v_mfma_f32_16x16x32_bf16 v[100:103], a[80:83], a[180:183], v[100:103]
ds_read_b64_tr_b16 a[22:23], v16 offset:608
v_mfma_f32_16x16x32_bf16 v[104:107], a[80:83], a[184:187], v[104:107]
ds_read_b64_tr_b16 a[24:25], v16 offset:8512
v_mfma_f32_16x16x32_bf16 v[108:111], a[80:83], a[188:191], v[108:111]
buffer_load_dwordx4 a[164:167], v10, s[16:19], s52 offen offset:1024 sc1
v_mfma_f32_16x16x32_bf16 v[112:115], a[84:87], a[176:179], v[112:115]
ds_read_b64_tr_b16 a[26:27], v16 offset:9024
v_mfma_f32_16x16x32_bf16 v[116:119], a[84:87], a[180:183], v[116:119]
ds_read_b64_tr_b16 a[28:29], v16 offset:8544
v_mfma_f32_16x16x32_bf16 v[120:123], a[84:87], a[184:187], v[120:123]
v_mfma_f32_16x16x32_bf16 v[124:127], a[84:87], a[188:191], v[124:127]
ds_read_b64_tr_b16 a[30:31], v16 offset:9056
v_mfma_f32_16x16x32_bf16 v[128:131], a[88:91], a[176:179], v[128:131]
ds_read_b64_tr_b16 a[32:33], v16 offset:128
v_mfma_f32_16x16x32_bf16 v[132:135], a[88:91], a[180:183], v[132:135]
buffer_load_dwordx4 v14, s[32:35], s54 offen offset:2112 lds
v_mfma_f32_16x16x32_bf16 v[136:139], a[88:91], a[184:187], v[136:139]
ds_read_b64_tr_b16 a[34:35], v16 offset:640
v_mfma_f32_16x16x32_bf16 v[140:143], a[88:91], a[188:191], v[140:143]
v_mfma_f32_16x16x32_bf16 v[144:147], a[92:95], a[176:179], v[144:147]
ds_read_b64_tr_b16 a[36:37], v16 offset:160
v_mfma_f32_16x16x32_bf16 v[148:151], a[92:95], a[180:183], v[148:151]
ds_read_b64_tr_b16 a[38:39], v16 offset:672
v_mfma_f32_16x16x32_bf16 v[152:155], a[92:95], a[184:187], v[152:155]
ds_read_b64_tr_b16 a[40:41], v16 offset:8576
v_mfma_f32_16x16x32_bf16 v[156:159], a[92:95], a[188:191], v[156:159]
buffer_load_dwordx4 a[168:171], v11, s[16:19], s52 offen sc1
v_mfma_f32_16x16x32_bf16 v[160:163], a[96:99], a[176:179], v[160:163]
ds_read_b64_tr_b16 a[42:43], v16 offset:9088
v_mfma_f32_16x16x32_bf16 v[164:167], a[96:99], a[180:183], v[164:167]
v_mfma_f32_16x16x32_bf16 v[168:171], a[96:99], a[184:187], v[168:171]
ds_read_b64_tr_b16 a[44:45], v16 offset:8608
v_mfma_f32_16x16x32_bf16 v[172:175], a[96:99], a[188:191], v[172:175]
ds_read_b64_tr_b16 a[46:47], v16 offset:9120
v_mfma_f32_16x16x32_bf16 v[176:179], a[100:103], a[176:179], v[176:179]
ds_read_b64_tr_b16 a[48:49], v17
v_mfma_f32_16x16x32_bf16 v[180:183], a[100:103], a[180:183], v[180:183]
buffer_load_dwordx4 v15, s[32:35], s54 offen offset:3168 lds
v_mfma_f32_16x16x32_bf16 v[184:187], a[100:103], a[184:187], v[184:187]
s_add_u32 s54, s54, 229376
v_mfma_f32_16x16x32_bf16 v[188:191], a[100:103], a[188:191], v[188:191]
ds_read_b64_tr_b16 a[50:51], v17 offset:512
v_mfma_f32_16x16x32_bf16 v[192:195], a[104:107], a[176:179], v[192:195]
ds_read_b64_tr_b16 a[52:53], v17 offset:32
v_mfma_f32_16x16x32_bf16 v[196:199], a[104:107], a[180:183], v[196:199]
ds_read_b64_tr_b16 a[54:55], v17 offset:544
v_mfma_f32_16x16x32_bf16 v[200:203], a[104:107], a[184:187], v[200:203]
ds_read_b64_tr_b16 a[56:57], v17 offset:8448
v_mfma_f32_16x16x32_bf16 v[204:207], a[104:107], a[188:191], v[204:207]
buffer_load_dwordx4 a[172:175], v11, s[16:19], s52 offen offset:1024 sc1
v_mfma_f32_16x16x32_bf16 v[208:211], a[108:111], a[176:179], v[208:211]
s_add_u32 s52, s52, 0x20000
v_mfma_f32_16x16x32_bf16 v[212:215], a[108:111], a[180:183], v[212:215]
ds_read_b64_tr_b16 a[58:59], v17 offset:8960
v_mfma_f32_16x16x32_bf16 v[216:219], a[108:111], a[184:187], v[216:219]
ds_read_b64_tr_b16 a[60:61], v17 offset:8480
v_mfma_f32_16x16x32_bf16 v[220:223], a[108:111], a[188:191], v[220:223]
ds_read_b64_tr_b16 a[62:63], v17 offset:8992
v_mfma_f32_16x16x32_bf16 v[224:227], a[112:115], a[176:179], v[224:227]
s_max_i32 m0, s67, s59
v_mfma_f32_16x16x32_bf16 v[228:231], a[112:115], a[180:183], v[228:231]
buffer_load_dwordx4 v6, s[28:31], s58 offen offset:1056 lds
v_mfma_f32_16x16x32_bf16 v[232:235], a[116:119], a[176:179], v[232:235]
s_add_u32 s67, s67, 8448
s_add_u32 s58, s58, 0x10000
v_mfma_f32_16x16x32_bf16 v[236:239], a[116:119], a[180:183], v[236:239]
v_mfma_f32_16x16x32_bf16 v[240:243], a[120:123], a[176:179], v[240:243]
v_mfma_f32_16x16x32_bf16 v[244:247], a[120:123], a[180:183], v[244:247]
v_mfma_f32_16x16x32_bf16 v[248:251], a[124:127], a[176:179], v[248:251]
s_add_u32 s15, s15, 1
v_mfma_f32_16x16x32_bf16 v[252:255], a[124:127], a[180:183], v[252:255]
s_cbranch_scc0 .Lk62
s_waitcnt vmcnt(11) lgkmcnt(0)
s_barrier
v_mfma_f32_16x16x32_bf16 v[32:35], a[0:3], a[128:131], v[32:35]
ds_read_b128 v[12:15], v9
v_mov_b32 v18, v5
v_mfma_f32_16x16x32_bf16 v[48:51], a[4:7], a[128:131], v[48:51]
buffer_load_dwordx4 a[176:179], v10, s[16:19], s52 offen sc1
v_mfma_f32_16x16x32_bf16 v[64:67], a[8:11], a[128:131], v[64:67]
ds_read_b64_tr_b16 a[64:65], v16 offset:16896
v_mov_b32 v19, v6
v_mfma_f32_16x16x32_bf16 v[80:83], a[12:15], a[128:131], v[80:83]
ds_read_b128 v[4:7], v9 offset:64
s_mov_b32 s58, 655360
v_mfma_f32_16x16x32_bf16 v[36:39], a[0:3], a[132:135], v[36:39]
ds_read_b64_tr_b16 a[66:67], v16 offset:17408
v_mfma_f32_16x16x32_bf16 v[52:55], a[4:7], a[132:135], v[52:55]
buffer_load_dwordx4 a[180:183], v10, s[16:19], s52 offen offset:1024 sc1
v_mfma_f32_16x16x32_bf16 v[68:71], a[8:11], a[132:135], v[68:71]
ds_read_b64_tr_b16 a[68:69], v16 offset:16928
v_mfma_f32_16x16x32_bf16 v[84:87], a[12:15], a[132:135], v[84:87]
ds_read_b64_tr_b16 a[70:71], v16 offset:17440
v_mfma_f32_16x16x32_bf16 v[40:43], a[0:3], a[136:139], v[40:43]
ds_read_b64_tr_b16 a[72:73], v16 offset:25344
s_waitcnt lgkmcnt(6)
v_fmac_f32 v32, v12, v20
v_mfma_f32_16x16x32_bf16 v[56:59], a[4:7], a[136:139], v[56:59]
buffer_load_dwordx4 a[184:187], v11, s[16:19], s52 offen sc1
v_mfma_f32_16x16x32_bf16 v[72:75], a[8:11], a[136:139], v[72:75]
ds_read_b64_tr_b16 a[74:75], v16 offset:25856
v_fmac_f32 v33, v13, v20
v_mfma_f32_16x16x32_bf16 v[88:91], a[12:15], a[136:139], v[88:91]
ds_read_b64_tr_b16 a[76:77], v16 offset:25376
v_fmac_f32 v34, v14, v20
v_mfma_f32_16x16x32_bf16 v[44:47], a[0:3], a[140:143], v[44:47]
ds_read_b64_tr_b16 a[78:79], v16 offset:25888
v_fmac_f32 v35, v15, v20
v_mfma_f32_16x16x32_bf16 v[60:63], a[4:7], a[140:143], v[60:63]
buffer_load_dwordx4 a[188:191], v11, s[16:19], s52 offen offset:1024 sc1
v_mfma_f32_16x16x32_bf16 v[76:79], a[8:11], a[140:143], v[76:79]
s_add_u32 s52, s52, 0x20000
ds_read_b64_tr_b16 a[80:81], v16 offset:33792
v_mfma_f32_16x16x32_bf16 v[92:95], a[12:15], a[140:143], v[92:95]
ds_read_b64_tr_b16 a[82:83], v16 offset:34304
v_fmac_f32 v36, v12, v22
v_mfma_f32_16x16x32_bf16 v[96:99], a[16:19], a[128:131], v[96:99]
ds_read_b64_tr_b16 a[84:85], v16 offset:33824
v_fmac_f32 v37, v13, v22
v_mfma_f32_16x16x32_bf16 v[112:115], a[20:23], a[128:131], v[112:115]
ds_read_b64_tr_b16 a[86:87], v16 offset:34336
.Lpad30:
s_cbranch_execz .Lnopoll60r
v_fmac_f32 v38, v14, v22
v_mfma_f32_16x16x32_bf16 v[128:131], a[24:27], a[128:131], v[128:131]
ds_read_b64_tr_b16 a[88:89], v16 offset:42240
v_fmac_f32 v39, v15, v22
v_mfma_f32_16x16x32_bf16 v[144:147], a[28:31], a[128:131], v[144:147]
ds_read_b64_tr_b16 a[90:91], v16 offset:42752
v_fmac_f32 v40, v12, v24
v_mfma_f32_16x16x32_bf16 v[100:103], a[16:19], a[132:135], v[100:103]
ds_read_b64_tr_b16 a[92:93], v16 offset:42272
v_fmac_f32 v41, v13, v24
v_mfma_f32_16x16x32_bf16 v[116:119], a[20:23], a[132:135], v[116:119]
ds_read_b64_tr_b16 a[94:95], v16 offset:42784
v_fmac_f32 v42, v14, v24
v_mfma_f32_16x16x32_bf16 v[132:135], a[24:27], a[132:135], v[132:135]
ds_read_b64_tr_b16 a[112:113], v16 offset:16960
v_fmac_f32 v43, v15, v24
v_mfma_f32_16x16x32_bf16 v[148:151], a[28:31], a[132:135], v[148:151]
ds_read_b64_tr_b16 a[114:115], v16 offset:17472
v_fmac_f32 v44, v12, v26
v_mfma_f32_16x16x32_bf16 v[104:107], a[16:19], a[136:139], v[104:107]
ds_read_b64_tr_b16 a[116:117], v16 offset:16992
v_fmac_f32 v45, v13, v26
v_mfma_f32_16x16x32_bf16 v[120:123], a[20:23], a[136:139], v[120:123]
ds_read_b64_tr_b16 a[118:119], v16 offset:17504
v_fmac_f32 v46, v14, v26
v_mfma_f32_16x16x32_bf16 v[136:139], a[24:27], a[136:139], v[136:139]
ds_read_b64_tr_b16 a[120:121], v16 offset:25408
v_fmac_f32 v47, v15, v26
v_mfma_f32_16x16x32_bf16 v[152:155], a[28:31], a[136:139], v[152:155]
ds_read_b128 v[12:15], v9 offset:512
s_waitcnt lgkmcnt(15)
v_fmac_f32 v48, v4, v20
v_mfma_f32_16x16x32_bf16 v[108:111], a[16:19], a[140:143], v[108:111]
ds_read_b64_tr_b16 a[122:123], v16 offset:25920
v_fmac_f32 v49, v5, v20
v_mfma_f32_16x16x32_bf16 v[124:127], a[20:23], a[140:143], v[124:127]
ds_read_b64_tr_b16 a[124:125], v16 offset:25440
v_fmac_f32 v50, v6, v20
v_mfma_f32_16x16x32_bf16 v[140:143], a[24:27], a[140:143], v[140:143]
ds_read_b64_tr_b16 a[126:127], v16 offset:25952
v_fmac_f32 v51, v7, v20
v_mfma_f32_16x16x32_bf16 v[156:159], a[28:31], a[140:143], v[156:159]
ds_read_b64_tr_b16 a[192:193], v16 offset:33856
v_fmac_f32 v52, v4, v22
v_mfma_f32_16x16x32_bf16 v[160:163], a[32:35], a[128:131], v[160:163]
ds_read_b64_tr_b16 a[194:195], v16 offset:34368
v_fmac_f32 v53, v5, v22
v_mfma_f32_16x16x32_bf16 v[176:179], a[36:39], a[128:131], v[176:179]
ds_read_b64_tr_b16 a[196:197], v16 offset:33888
v_fmac_f32 v54, v6, v22
v_mfma_f32_16x16x32_bf16 v[192:195], a[40:43], a[128:131], v[192:195]
ds_read_b64_tr_b16 a[198:199], v16 offset:34400
v_fmac_f32 v55, v7, v22
v_mfma_f32_16x16x32_bf16 v[208:211], a[44:47], a[128:131], v[208:211]
ds_read_b64_tr_b16 a[200:201], v16 offset:42304
v_fmac_f32 v56, v4, v24
v_mfma_f32_16x16x32_bf16 v[164:167], a[32:35], a[132:135], v[164:167]
ds_read_b64_tr_b16 a[202:203], v16 offset:42816
v_fmac_f32 v57, v5, v24
v_mfma_f32_16x16x32_bf16 v[180:183], a[36:39], a[132:135], v[180:183]
ds_read_b64_tr_b16 a[204:205], v16 offset:42336
s_waitcnt vmcnt(6)
s_barrier
v_mfma_f32_16x16x32_bf16 v[196:199], a[40:43], a[132:135], v[196:199]
ds_read_b64_tr_b16 a[96:97], v16 offset:50688
v_fmac_f32 v58, v6, v24
v_mfma_f32_16x16x32_bf16 v[212:215], a[44:47], a[132:135], v[212:215]
ds_read_b64_tr_b16 a[98:99], v16 offset:51200
v_fmac_f32 v59, v7, v24
v_mfma_f32_16x16x32_bf16 v[168:171], a[32:35], a[136:139], v[168:171]
ds_read_b64_tr_b16 a[100:101], v16 offset:50720
v_fmac_f32 v60, v4, v26
v_mfma_f32_16x16x32_bf16 v[184:187], a[36:39], a[136:139], v[184:187]
ds_read_b64_tr_b16 a[102:103], v16 offset:51232
v_fmac_f32 v61, v5, v26
v_mfma_f32_16x16x32_bf16 v[200:203], a[40:43], a[136:139], v[200:203]
ds_read_b64_tr_b16 a[104:105], v16 offset:59136
v_fmac_f32 v62, v6, v26
v_mfma_f32_16x16x32_bf16 v[216:219], a[44:47], a[136:139], v[216:219]
ds_read_b64_tr_b16 a[106:107], v16 offset:59648
v_fmac_f32 v63, v7, v26
v_mfma_f32_16x16x32_bf16 v[172:175], a[32:35], a[140:143], v[172:175]
ds_read_b128 v[4:7], v9 offset:576
s_waitcnt lgkmcnt(15)
v_fmac_f32 v64, v12, v20
v_mfma_f32_16x16x32_bf16 v[188:191], a[36:39], a[140:143], v[188:191]
ds_read_b64_tr_b16 a[108:109], v16 offset:59168
v_fmac_f32 v65, v13, v20
v_mfma_f32_16x16x32_bf16 v[204:207], a[40:43], a[140:143], v[204:207]
ds_read_b64_tr_b16 a[110:111], v16 offset:59680
v_fmac_f32 v66, v14, v20
v_mfma_f32_16x16x32_bf16 v[220:223], a[44:47], a[140:143], v[220:223]
ds_read_b64_tr_b16 a[206:207], v16 offset:42848
v_fmac_f32 v67, v15, v20
v_mfma_f32_16x16x32_bf16 v[224:227], a[48:51], a[128:131], v[224:227]
ds_read_b64_tr_b16 a[208:209], v16 offset:50752
v_fmac_f32 v68, v12, v22
v_mfma_f32_16x16x32_bf16 v[232:235], a[52:55], a[128:131], v[232:235]
ds_read_b64_tr_b16 a[210:211], v16 offset:51264
v_fmac_f32 v69, v13, v22
v_mfma_f32_16x16x32_bf16 v[240:243], a[56:59], a[128:131], v[240:243]
ds_read_b64_tr_b16 a[212:213], v16 offset:50784
v_fmac_f32 v70, v14, v22
v_mfma_f32_16x16x32_bf16 v[248:251], a[60:63], a[128:131], v[248:251]
ds_read_b64_tr_b16 a[214:215], v16 offset:51296
v_fmac_f32 v71, v15, v22
v_mfma_f32_16x16x32_bf16 v[228:231], a[48:51], a[132:135], v[228:231]
ds_read_b64_tr_b16 a[216:217], v16 offset:59200
v_fmac_f32 v72, v12, v24
v_mfma_f32_16x16x32_bf16 v[236:239], a[52:55], a[132:135], v[236:239]
ds_read_b64_tr_b16 a[218:219], v16 offset:59712
v_fmac_f32 v73, v13, v24
v_mfma_f32_16x16x32_bf16 v[244:247], a[56:59], a[132:135], v[244:247]
ds_read_b64_tr_b16 a[220:221], v16 offset:59232
v_fmac_f32 v74, v14, v24
v_mfma_f32_16x16x32_bf16 v[252:255], a[60:63], a[132:135], v[252:255]
ds_read_b64_tr_b16 a[222:223], v16 offset:59744
v_fmac_f32 v75, v15, v24
v_mfma_f32_16x16x32_bf16 v[32:35], a[64:67], a[144:147], v[32:35]
ds_read_b64_tr_b16 a[0:1], v16 offset:17024
v_fmac_f32 v76, v12, v26
v_mfma_f32_16x16x32_bf16 v[48:51], a[68:71], a[144:147], v[48:51]
ds_read_b64_tr_b16 a[2:3], v16 offset:17536
v_fmac_f32 v77, v13, v26
v_mfma_f32_16x16x32_bf16 v[64:67], a[72:75], a[144:147], v[64:67]
ds_read_b64_tr_b16 a[4:5], v16 offset:17056
v_fmac_f32 v78, v14, v26
v_fmac_f32 v79, v15, v26
ds_read_b128 v[12:15], v9 offset:832
s_waitcnt lgkmcnt(15)
v_fmac_f32 v80, v4, v20
v_fmac_f32 v81, v5, v20
v_fmac_f32 v82, v6, v20
v_fmac_f32 v83, v7, v20
v_fmac_f32 v84, v4, v22
v_fmac_f32 v85, v5, v22
v_mfma_f32_16x16x32_bf16 v[80:83], a[76:79], a[144:147], v[80:83]
ds_read_b64_tr_b16 a[6:7], v16 offset:17568
v_fmac_f32 v86, v6, v22
v_mfma_f32_16x16x32_bf16 v[32:35], a[80:83], a[160:163], v[32:35]
ds_read_b64_tr_b16 a[8:9], v16 offset:25472
v_fmac_f32 v87, v7, v22
v_mfma_f32_16x16x32_bf16 v[48:51], a[84:87], a[160:163], v[48:51]
ds_read_b64_tr_b16 a[10:11], v16 offset:25984
v_fmac_f32 v88, v4, v24
v_mfma_f32_16x16x32_bf16 v[64:67], a[88:91], a[160:163], v[64:67]
ds_read_b64_tr_b16 a[12:13], v16 offset:25504
v_fmac_f32 v89, v5, v24
v_mfma_f32_16x16x32_bf16 v[80:83], a[92:95], a[160:163], v[80:83]
ds_read_b64_tr_b16 a[14:15], v16 offset:26016
v_fmac_f32 v90, v6, v24
s_waitcnt vmcnt(3)
v_mfma_f32_16x16x32_bf16 v[32:35], a[96:99], a[176:179], v[32:35]
ds_read_b64_tr_b16 a[16:17], v16 offset:33920
v_fmac_f32 v91, v7, v24
v_mfma_f32_16x16x32_bf16 v[48:51], a[100:103], a[176:179], v[48:51]
ds_read_b64_tr_b16 a[18:19], v16 offset:34432
v_fmac_f32 v92, v4, v26
v_mfma_f32_16x16x32_bf16 v[64:67], a[104:107], a[176:179], v[64:67]
ds_read_b64_tr_b16 a[20:21], v16 offset:33952
v_fmac_f32 v93, v5, v26
s_waitcnt lgkmcnt(15)
v_mfma_f32_16x16x32_bf16 v[80:83], a[108:111], a[176:179], v[80:83]
ds_read_b64_tr_b16 a[22:23], v16 offset:34464
v_fmac_f32 v94, v6, v26
v_fmac_f32 v95, v7, v26
ds_read_b128 v[4:7], v9 offset:704
v_pk_mul_f32 v[64:65], v[64:65], v[32:33]
v_pk_mul_f32 v[32:33], v[32:33], v[28:29] op_sel_hi:[1,0]
v_pk_mul_f32 v[66:67], v[66:67], v[34:35]
v_pk_mul_f32 v[34:35], v[34:35], v[28:29] op_sel_hi:[1,0]
v_pk_mul_f32 v[80:81], v[80:81], v[48:49]
v_pk_mul_f32 v[48:49], v[48:49], v[28:29] op_sel_hi:[1,0]
v_pk_mul_f32 v[82:83], v[82:83], v[50:51]
v_pk_mul_f32 v[50:51], v[50:51], v[28:29] op_sel_hi:[1,0]
v_exp_f32 v32, v32
s_nop 0
v_mfma_f32_16x16x32_bf16 v[36:39], a[64:67], a[148:151], v[36:39]
ds_read_b64_tr_b16 a[24:25], v16 offset:42368
v_exp_f32 v33, v33
v_mfma_f32_16x16x32_bf16 v[52:55], a[68:71], a[148:151], v[52:55]
ds_read_b64_tr_b16 a[26:27], v16 offset:42880
v_exp_f32 v34, v34
v_mfma_f32_16x16x32_bf16 v[68:71], a[72:75], a[148:151], v[68:71]
ds_read_b64_tr_b16 a[28:29], v16 offset:42400
v_exp_f32 v35, v35
v_mfma_f32_16x16x32_bf16 v[84:87], a[76:79], a[148:151], v[84:87]
ds_read_b64_tr_b16 a[30:31], v16 offset:42912
v_exp_f32 v48, v48
v_mfma_f32_16x16x32_bf16 v[36:39], a[80:83], a[164:167], v[36:39]
ds_read_b64_tr_b16 a[32:33], v16 offset:50816
v_exp_f32 v49, v49
v_mfma_f32_16x16x32_bf16 v[52:55], a[84:87], a[164:167], v[52:55]
ds_read_b64_tr_b16 a[34:35], v16 offset:51328
v_exp_f32 v50, v50
v_mfma_f32_16x16x32_bf16 v[68:71], a[88:91], a[164:167], v[68:71]
ds_read_b64_tr_b16 a[36:37], v16 offset:50848
v_exp_f32 v51, v51
v_mfma_f32_16x16x32_bf16 v[84:87], a[92:95], a[164:167], v[84:87]
ds_read_b64_tr_b16 a[38:39], v16 offset:51360
s_waitcnt vmcnt(2)
v_mfma_f32_16x16x32_bf16 v[36:39], a[96:99], a[180:183], v[36:39]
ds_read_b64_tr_b16 a[40:41], v16 offset:59264
v_mfma_f32_16x16x32_bf16 v[52:55], a[100:103], a[180:183], v[52:55]
ds_read_b64_tr_b16 a[42:43], v16 offset:59776
v_mfma_f32_16x16x32_bf16 v[68:71], a[104:107], a[180:183], v[68:71]
ds_read_b64_tr_b16 a[44:45], v16 offset:59296
v_mfma_f32_16x16x32_bf16 v[84:87], a[108:111], a[180:183], v[84:87]
ds_read_b64_tr_b16 a[46:47], v16 offset:59808
s_nop 4
v_pk_mul_f32 v[68:69], v[68:69], v[36:37]
v_pk_mul_f32 v[36:37], v[36:37], v[28:29] op_sel:[0,1] op_sel_hi:[1,1]
v_pk_mul_f32 v[70:71], v[70:71], v[38:39]
v_pk_mul_f32 v[38:39], v[38:39], v[28:29] op_sel:[0,1] op_sel_hi:[1,1]
v_pk_mul_f32 v[84:85], v[84:85], v[52:53]
v_pk_mul_f32 v[52:53], v[52:53], v[28:29] op_sel:[0,1] op_sel_hi:[1,1]
v_pk_mul_f32 v[86:87], v[86:87], v[54:55]
v_pk_mul_f32 v[54:55], v[54:55], v[28:29] op_sel:[0,1] op_sel_hi:[1,1]
v_pk_fma_f32 v[32:33], v[32:33], v[20:21], v[20:21] op_sel:[0,1,1] op_sel_hi:[1,1,1]
v_pk_fma_f32 v[34:35], v[34:35], v[20:21], v[20:21] op_sel:[0,1,1] op_sel_hi:[1,1,1]
v_pk_fma_f32 v[48:49], v[48:49], v[20:21], v[20:21] op_sel:[0,1,1] op_sel_hi:[1,1,1]
v_pk_fma_f32 v[50:51], v[50:51], v[20:21], v[20:21] op_sel:[0,1,1] op_sel_hi:[1,1,1]
v_rcp_f32 v32, v32
s_nop 0
v_mfma_f32_16x16x32_bf16 v[40:43], a[64:67], a[152:155], v[40:43]
ds_read_b64_tr_b16 a[48:49], v17 offset:16896
v_rcp_f32 v33, v33
v_mfma_f32_16x16x32_bf16 v[56:59], a[68:71], a[152:155], v[56:59]
ds_read_b64_tr_b16 a[50:51], v17 offset:17408
v_rcp_f32 v34, v34
v_mfma_f32_16x16x32_bf16 v[72:75], a[72:75], a[152:155], v[72:75]
ds_read_b64_tr_b16 a[52:53], v17 offset:16928
v_rcp_f32 v35, v35
v_mfma_f32_16x16x32_bf16 v[88:91], a[76:79], a[152:155], v[88:91]
ds_read_b64_tr_b16 a[54:55], v17 offset:17440
v_rcp_f32 v48, v48
v_mfma_f32_16x16x32_bf16 v[40:43], a[80:83], a[168:171], v[40:43]
ds_read_b64_tr_b16 a[56:57], v17 offset:25344
v_rcp_f32 v49, v49
v_mfma_f32_16x16x32_bf16 v[56:59], a[84:87], a[168:171], v[56:59]
ds_read_b64_tr_b16 a[58:59], v17 offset:25856
v_rcp_f32 v50, v50
v_mfma_f32_16x16x32_bf16 v[72:75], a[88:91], a[168:171], v[72:75]
ds_read_b64_tr_b16 a[60:61], v17 offset:25376
v_rcp_f32 v51, v51
v_mfma_f32_16x16x32_bf16 v[88:91], a[92:95], a[168:171], v[88:91]
ds_read_b64_tr_b16 a[62:63], v17 offset:25888
v_exp_f32 v36, v36
s_waitcnt vmcnt(1)
v_mfma_f32_16x16x32_bf16 v[40:43], a[96:99], a[184:187], v[40:43]
v_exp_f32 v37, v37
v_mfma_f32_16x16x32_bf16 v[56:59], a[100:103], a[184:187], v[56:59]
v_exp_f32 v38, v38
v_mfma_f32_16x16x32_bf16 v[72:75], a[104:107], a[184:187], v[72:75]
v_exp_f32 v39, v39
v_mfma_f32_16x16x32_bf16 v[88:91], a[108:111], a[184:187], v[88:91]
v_exp_f32 v52, v52
v_exp_f32 v53, v53
v_exp_f32 v54, v54
v_exp_f32 v55, v55
v_pk_mul_f32 v[64:65], v[64:65], v[32:33]
v_pk_mul_f32 v[66:67], v[66:67], v[34:35]
v_pk_mul_f32 v[80:81], v[80:81], v[48:49]
v_pk_mul_f32 v[82:83], v[82:83], v[50:51]
ds_read_b128 v[48:51], v9 offset:128
v_pk_mul_f32 v[72:73], v[72:73], v[40:41]
v_pk_mul_f32 v[40:41], v[40:41], v[30:31] op_sel_hi:[1,0]
v_pk_mul_f32 v[74:75], v[74:75], v[42:43]
v_pk_mul_f32 v[42:43], v[42:43], v[30:31] op_sel_hi:[1,0]
v_pk_mul_f32 v[88:89], v[88:89], v[56:57]
v_pk_mul_f32 v[56:57], v[56:57], v[30:31] op_sel_hi:[1,0]
v_pk_mul_f32 v[90:91], v[90:91], v[58:59]
v_pk_mul_f32 v[58:59], v[58:59], v[30:31] op_sel_hi:[1,0]
v_pk_fma_f32 v[36:37], v[36:37], v[22:23], v[22:23] op_sel:[0,1,1] op_sel_hi:[1,1,1]
v_pk_fma_f32 v[38:39], v[38:39], v[22:23], v[22:23] op_sel:[0,1,1] op_sel_hi:[1,1,1]
v_pk_fma_f32 v[52:53], v[52:53], v[22:23], v[22:23] op_sel:[0,1,1] op_sel_hi:[1,1,1]
v_pk_fma_f32 v[54:55], v[54:55], v[22:23], v[22:23] op_sel:[0,1,1] op_sel_hi:[1,1,1]
v_cvt_pk_bf16_f32 v32, v64, v65
v_cvt_pk_bf16_f32 v33, v66, v67
ds_read_b128 v[64:67], v9 offset:192
v_cvt_pk_bf16_f32 v34, v80, v81
v_cvt_pk_bf16_f32 v35, v82, v83
v_mfma_f32_16x16x32_bf16 v[44:47], a[64:67], a[156:159], v[44:47]
buffer_store_dwordx4 v[32:35], v10, s[16:19], s62 offen sc1
v_mfma_f32_16x16x32_bf16 v[60:63], a[68:71], a[156:159], v[60:63]
ds_read_b128 v[80:83], v9 offset:640
v_rcp_f32 v36, v36
v_mfma_f32_16x16x32_bf16 v[76:79], a[72:75], a[156:159], v[76:79]
ds_read_b64_tr_b16 a[64:65], v17 offset:33792
v_rcp_f32 v37, v37
v_mfma_f32_16x16x32_bf16 v[92:95], a[76:79], a[156:159], v[92:95]
ds_read_b64_tr_b16 a[66:67], v17 offset:34304
v_rcp_f32 v38, v38
v_mfma_f32_16x16x32_bf16 v[44:47], a[80:83], a[172:175], v[44:47]
ds_read_b64_tr_b16 a[68:69], v17 offset:33824
v_rcp_f32 v39, v39
v_mfma_f32_16x16x32_bf16 v[60:63], a[84:87], a[172:175], v[60:63]
ds_read_b64_tr_b16 a[70:71], v17 offset:34336
v_rcp_f32 v52, v52
v_mfma_f32_16x16x32_bf16 v[76:79], a[88:91], a[172:175], v[76:79]
ds_read_b64_tr_b16 a[72:73], v17 offset:42240
v_rcp_f32 v53, v53
v_mfma_f32_16x16x32_bf16 v[92:95], a[92:95], a[172:175], v[92:95]
ds_read_b64_tr_b16 a[74:75], v17 offset:42752
v_rcp_f32 v54, v54
s_waitcnt vmcnt(1)
v_mfma_f32_16x16x32_bf16 v[44:47], a[96:99], a[188:191], v[44:47]
ds_read_b64_tr_b16 a[76:77], v17 offset:42272
v_rcp_f32 v55, v55
v_mfma_f32_16x16x32_bf16 v[60:63], a[100:103], a[188:191], v[60:63]
ds_read_b64_tr_b16 a[78:79], v17 offset:42784
v_exp_f32 v40, v40
v_mfma_f32_16x16x32_bf16 v[76:79], a[104:107], a[188:191], v[76:79]
ds_read_b64_tr_b16 a[80:81], v17 offset:50688
v_exp_f32 v41, v41
v_mfma_f32_16x16x32_bf16 v[92:95], a[108:111], a[188:191], v[92:95]
ds_read_b64_tr_b16 a[82:83], v17 offset:51200
v_exp_f32 v42, v42
v_exp_f32 v43, v43
v_exp_f32 v56, v56
v_exp_f32 v57, v57
v_exp_f32 v58, v58
v_exp_f32 v59, v59
v_pk_mul_f32 v[68:69], v[68:69], v[36:37]
v_pk_mul_f32 v[70:71], v[70:71], v[38:39]
v_pk_mul_f32 v[84:85], v[84:85], v[52:53]
v_pk_mul_f32 v[86:87], v[86:87], v[54:55]
v_pk_mul_f32 v[76:77], v[76:77], v[44:45]
v_pk_mul_f32 v[44:45], v[44:45], v[30:31] op_sel:[0,1] op_sel_hi:[1,1]
v_pk_mul_f32 v[78:79], v[78:79], v[46:47]
v_pk_mul_f32 v[46:47], v[46:47], v[30:31] op_sel:[0,1] op_sel_hi:[1,1]
v_pk_mul_f32 v[92:93], v[92:93], v[60:61]
v_pk_mul_f32 v[60:61], v[60:61], v[30:31] op_sel:[0,1] op_sel_hi:[1,1]
v_pk_mul_f32 v[94:95], v[94:95], v[62:63]
v_pk_mul_f32 v[62:63], v[62:63], v[30:31] op_sel:[0,1] op_sel_hi:[1,1]
v_pk_fma_f32 v[40:41], v[40:41], v[24:25], v[24:25] op_sel:[0,1,1] op_sel_hi:[1,1,1]
v_pk_fma_f32 v[42:43], v[42:43], v[24:25], v[24:25] op_sel:[0,1,1] op_sel_hi:[1,1,1]
v_pk_fma_f32 v[56:57], v[56:57], v[24:25], v[24:25] op_sel:[0,1,1] op_sel_hi:[1,1,1]
v_pk_fma_f32 v[58:59], v[58:59], v[24:25], v[24:25] op_sel:[0,1,1] op_sel_hi:[1,1,1]
v_cvt_pk_bf16_f32 v36, v68, v69
v_cvt_pk_bf16_f32 v37, v70, v71
v_cvt_pk_bf16_f32 v38, v84, v85
v_cvt_pk_bf16_f32 v39, v86, v87
v_mfma_f32_16x16x32_bf16 v[96:99], a[112:115], a[144:147], v[96:99]
buffer_store_dwordx4 v[36:39], v10, s[16:19], s62 offen offset:1024 sc1
v_mfma_f32_16x16x32_bf16 v[112:115], a[116:119], a[144:147], v[112:115]
ds_read_b64_tr_b16 a[84:85], v17 offset:50720
v_rcp_f32 v40, v40
v_mfma_f32_16x16x32_bf16 v[128:131], a[120:123], a[144:147], v[128:131]
ds_read_b64_tr_b16 a[86:87], v17 offset:51232
v_rcp_f32 v41, v41
v_mfma_f32_16x16x32_bf16 v[144:147], a[124:127], a[144:147], v[144:147]
ds_read_b64_tr_b16 a[88:89], v17 offset:59136
v_rcp_f32 v42, v42
v_mfma_f32_16x16x32_bf16 v[96:99], a[192:195], a[160:163], v[96:99]
ds_read_b64_tr_b16 a[90:91], v17 offset:59648
v_rcp_f32 v43, v43
v_mfma_f32_16x16x32_bf16 v[112:115], a[196:199], a[160:163], v[112:115]
ds_read_b64_tr_b16 a[92:93], v17 offset:59168
v_rcp_f32 v56, v56
v_mfma_f32_16x16x32_bf16 v[128:131], a[200:203], a[160:163], v[128:131]
ds_read_b64_tr_b16 a[94:95], v17 offset:59680
v_rcp_f32 v57, v57
v_mfma_f32_16x16x32_bf16 v[144:147], a[204:207], a[160:163], v[144:147]
v_rcp_f32 v58, v58
v_mfma_f32_16x16x32_bf16 v[96:99], a[208:211], a[176:179], v[96:99]
v_rcp_f32 v59, v59
v_mfma_f32_16x16x32_bf16 v[112:115], a[212:215], a[176:179], v[112:115]
v_exp_f32 v44, v44
s_waitcnt lgkmcnt(15)
v_mfma_f32_16x16x32_bf16 v[128:131], a[216:219], a[176:179], v[128:131]
v_exp_f32 v45, v45
v_mfma_f32_16x16x32_bf16 v[144:147], a[220:223], a[176:179], v[144:147]
v_exp_f32 v46, v46
v_exp_f32 v47, v47
v_exp_f32 v60, v60
v_exp_f32 v61, v61
v_exp_f32 v62, v62
s_waitcnt lgkmcnt(0)
s_barrier
v_exp_f32 v63, v63
v_pk_mul_f32 v[72:73], v[72:73], v[40:41]
v_pk_mul_f32 v[74:75], v[74:75], v[42:43]
v_pk_mul_f32 v[88:89], v[88:89], v[56:57]
v_pk_mul_f32 v[90:91], v[90:91], v[58:59]
v_pk_fma_f32 v[96:97], v[48:49], v[20:21], v[96:97] op_sel_hi:[1,0,1]
v_pk_fma_f32 v[98:99], v[50:51], v[20:21], v[98:99] op_sel_hi:[1,0,1]
v_pk_fma_f32 v[112:113], v[64:65], v[20:21], v[112:113] op_sel_hi:[1,0,1]
v_pk_fma_f32 v[114:115], v[66:67], v[20:21], v[114:115] op_sel_hi:[1,0,1]
v_pk_fma_f32 v[128:129], v[80:81], v[20:21], v[128:129] op_sel_hi:[1,0,1]
v_pk_fma_f32 v[130:131], v[82:83], v[20:21], v[130:131] op_sel_hi:[1,0,1]
v_pk_fma_f32 v[144:145], v[4:5], v[20:21], v[144:145] op_sel_hi:[1,0,1]
v_pk_fma_f32 v[146:147], v[6:7], v[20:21], v[146:147] op_sel_hi:[1,0,1]
v_pk_mul_f32 v[128:129], v[128:129], v[96:97]
v_pk_mul_f32 v[96:97], v[96:97], v[28:29] op_sel_hi:[1,0]
v_pk_mul_f32 v[130:131], v[130:131], v[98:99]
v_pk_mul_f32 v[98:99], v[98:99], v[28:29] op_sel_hi:[1,0]
v_pk_mul_f32 v[144:145], v[144:145], v[112:113]
v_pk_mul_f32 v[112:113], v[112:113], v[28:29] op_sel_hi:[1,0]
v_pk_mul_f32 v[146:147], v[146:147], v[114:115]
v_pk_mul_f32 v[114:115], v[114:115], v[28:29] op_sel_hi:[1,0]
v_pk_fma_f32 v[44:45], v[44:45], v[26:27], v[26:27] op_sel:[0,1,1] op_sel_hi:[1,1,1]
v_pk_fma_f32 v[46:47], v[46:47], v[26:27], v[26:27] op_sel:[0,1,1] op_sel_hi:[1,1,1]
v_pk_fma_f32 v[60:61], v[60:61], v[26:27], v[26:27] op_sel:[0,1,1] op_sel_hi:[1,1,1]
v_pk_fma_f32 v[62:63], v[62:63], v[26:27], v[26:27] op_sel:[0,1,1] op_sel_hi:[1,1,1]
v_cvt_pk_bf16_f32 v40, v72, v73
v_cvt_pk_bf16_f32 v41, v74, v75
v_cvt_pk_bf16_f32 v42, v88, v89
v_cvt_pk_bf16_f32 v43, v90, v91
v_mfma_f32_16x16x32_bf16 v[100:103], a[112:115], a[148:151], v[100:103]
buffer_store_dwordx4 v[40:43], v11, s[16:19], s62 offen sc1
v_mfma_f32_16x16x32_bf16 v[116:119], a[116:119], a[148:151], v[116:119]
s_add_u32 m0, s59, 84480
v_rcp_f32 v44, v44
v_mfma_f32_16x16x32_bf16 v[132:135], a[120:123], a[148:151], v[132:135]
v_rcp_f32 v45, v45
v_mfma_f32_16x16x32_bf16 v[148:151], a[124:127], a[148:151], v[148:151]
v_rcp_f32 v46, v46
v_mfma_f32_16x16x32_bf16 v[100:103], a[192:195], a[164:167], v[100:103]
buffer_load_dwordx4 v18, s[28:31], s58 offen lds
v_mfma_f32_16x16x32_bf16 v[116:119], a[196:199], a[164:167], v[116:119]
v_rcp_f32 v47, v47
v_mfma_f32_16x16x32_bf16 v[132:135], a[200:203], a[164:167], v[132:135]
v_rcp_f32 v60, v60
v_mfma_f32_16x16x32_bf16 v[148:151], a[204:207], a[164:167], v[148:151]
v_rcp_f32 v61, v61
v_mfma_f32_16x16x32_bf16 v[100:103], a[208:211], a[180:183], v[100:103]
buffer_load_dwordx4 v19, s[28:31], s58 offen offset:1056 lds
v_mfma_f32_16x16x32_bf16 v[116:119], a[212:215], a[180:183], v[116:119]
s_add_u32 m0, s59, 92928
s_mov_b32 s58, 720896
v_rcp_f32 v62, v62
v_mfma_f32_16x16x32_bf16 v[132:135], a[216:219], a[180:183], v[132:135]
v_rcp_f32 v63, v63
v_mfma_f32_16x16x32_bf16 v[148:151], a[220:223], a[180:183], v[148:151]
v_exp_f32 v96, v96
v_exp_f32 v97, v97
v_exp_f32 v98, v98
v_exp_f32 v99, v99
v_exp_f32 v112, v112
v_exp_f32 v113, v113
v_exp_f32 v114, v114
v_exp_f32 v115, v115
v_pk_mul_f32 v[76:77], v[76:77], v[44:45]
v_pk_mul_f32 v[78:79], v[78:79], v[46:47]
v_pk_mul_f32 v[92:93], v[92:93], v[60:61]
v_pk_mul_f32 v[94:95], v[94:95], v[62:63]
v_pk_fma_f32 v[100:101], v[48:49], v[22:23], v[100:101] op_sel_hi:[1,0,1]
v_pk_fma_f32 v[102:103], v[50:51], v[22:23], v[102:103] op_sel_hi:[1,0,1]
v_pk_fma_f32 v[116:117], v[64:65], v[22:23], v[116:117] op_sel_hi:[1,0,1]
v_pk_fma_f32 v[118:119], v[66:67], v[22:23], v[118:119] op_sel_hi:[1,0,1]
v_pk_fma_f32 v[132:133], v[80:81], v[22:23], v[132:133] op_sel_hi:[1,0,1]
v_pk_fma_f32 v[134:135], v[82:83], v[22:23], v[134:135] op_sel_hi:[1,0,1]
v_pk_fma_f32 v[148:149], v[4:5], v[22:23], v[148:149] op_sel_hi:[1,0,1]
v_pk_fma_f32 v[150:151], v[6:7], v[22:23], v[150:151] op_sel_hi:[1,0,1]
v_pk_mul_f32 v[132:133], v[132:133], v[100:101]
v_pk_mul_f32 v[100:101], v[100:101], v[28:29] op_sel:[0,1] op_sel_hi:[1,1]
v_pk_mul_f32 v[134:135], v[134:135], v[102:103]
v_pk_mul_f32 v[102:103], v[102:103], v[28:29] op_sel:[0,1] op_sel_hi:[1,1]
v_pk_mul_f32 v[148:149], v[148:149], v[116:117]
v_pk_mul_f32 v[116:117], v[116:117], v[28:29] op_sel:[0,1] op_sel_hi:[1,1]
v_pk_mul_f32 v[150:151], v[150:151], v[118:119]
v_pk_mul_f32 v[118:119], v[118:119], v[28:29] op_sel:[0,1] op_sel_hi:[1,1]
v_pk_fma_f32 v[96:97], v[96:97], v[20:21], v[20:21] op_sel:[0,1,1] op_sel_hi:[1,1,1]
v_pk_fma_f32 v[98:99], v[98:99], v[20:21], v[20:21] op_sel:[0,1,1] op_sel_hi:[1,1,1]
v_pk_fma_f32 v[112:113], v[112:113], v[20:21], v[20:21] op_sel:[0,1,1] op_sel_hi:[1,1,1]
v_pk_fma_f32 v[114:115], v[114:115], v[20:21], v[20:21] op_sel:[0,1,1] op_sel_hi:[1,1,1]
v_cvt_pk_bf16_f32 v44, v76, v77
v_cvt_pk_bf16_f32 v45, v78, v79
v_cvt_pk_bf16_f32 v46, v92, v93
v_cvt_pk_bf16_f32 v47, v94, v95
v_mfma_f32_16x16x32_bf16 v[104:107], a[112:115], a[152:155], v[104:107]
buffer_store_dwordx4 v[44:47], v11, s[16:19], s62 offen offset:1024 sc1
v_mfma_f32_16x16x32_bf16 v[120:123], a[116:119], a[152:155], v[120:123]
v_rcp_f32 v96, v96
v_mfma_f32_16x16x32_bf16 v[136:139], a[120:123], a[152:155], v[136:139]
v_rcp_f32 v97, v97
v_mfma_f32_16x16x32_bf16 v[152:155], a[124:127], a[152:155], v[152:155]
v_rcp_f32 v98, v98
v_mfma_f32_16x16x32_bf16 v[104:107], a[192:195], a[168:171], v[104:107]
buffer_load_dwordx4 v18, s[28:31], s58 offen lds
v_mfma_f32_16x16x32_bf16 v[120:123], a[196:199], a[168:171], v[120:123]
v_rcp_f32 v99, v99
v_mfma_f32_16x16x32_bf16 v[136:139], a[200:203], a[168:171], v[136:139]
v_rcp_f32 v112, v112
v_mfma_f32_16x16x32_bf16 v[152:155], a[204:207], a[168:171], v[152:155]
v_rcp_f32 v113, v113
v_mfma_f32_16x16x32_bf16 v[104:107], a[208:211], a[184:187], v[104:107]
buffer_load_dwordx4 v19, s[28:31], s58 offen offset:1056 lds
v_mfma_f32_16x16x32_bf16 v[120:123], a[212:215], a[184:187], v[120:123]
s_add_u32 m0, s59, 101376
s_mov_b32 s58, 786432
v_rcp_f32 v114, v114
v_mfma_f32_16x16x32_bf16 v[136:139], a[216:219], a[184:187], v[136:139]
v_rcp_f32 v115, v115
v_mfma_f32_16x16x32_bf16 v[152:155], a[220:223], a[184:187], v[152:155]
v_exp_f32 v100, v100
v_exp_f32 v101, v101
v_exp_f32 v102, v102
v_exp_f32 v103, v103
v_exp_f32 v116, v116
v_exp_f32 v117, v117
v_exp_f32 v118, v118
v_exp_f32 v119, v119
v_pk_mul_f32 v[128:129], v[128:129], v[96:97]
v_pk_mul_f32 v[130:131], v[130:131], v[98:99]
v_pk_mul_f32 v[144:145], v[144:145], v[112:113]
v_pk_mul_f32 v[146:147], v[146:147], v[114:115]
ds_read_b128 v[112:115], v9 offset:256
v_pk_fma_f32 v[104:105], v[48:49], v[24:25], v[104:105] op_sel_hi:[1,0,1]
v_pk_fma_f32 v[106:107], v[50:51], v[24:25], v[106:107] op_sel_hi:[1,0,1]
v_pk_fma_f32 v[120:121], v[64:65], v[24:25], v[120:121] op_sel_hi:[1,0,1]
v_pk_fma_f32 v[122:123], v[66:67], v[24:25], v[122:123] op_sel_hi:[1,0,1]
v_pk_fma_f32 v[136:137], v[80:81], v[24:25], v[136:137] op_sel_hi:[1,0,1]
v_pk_fma_f32 v[138:139], v[82:83], v[24:25], v[138:139] op_sel_hi:[1,0,1]
v_pk_fma_f32 v[152:153], v[4:5], v[24:25], v[152:153] op_sel_hi:[1,0,1]
v_pk_fma_f32 v[154:155], v[6:7], v[24:25], v[154:155] op_sel_hi:[1,0,1]
v_pk_mul_f32 v[136:137], v[136:137], v[104:105]
v_pk_mul_f32 v[104:105], v[104:105], v[30:31] op_sel_hi:[1,0]
v_pk_mul_f32 v[138:139], v[138:139], v[106:107]
v_pk_mul_f32 v[106:107], v[106:107], v[30:31] op_sel_hi:[1,0]
v_pk_mul_f32 v[152:153], v[152:153], v[120:121]
v_pk_mul_f32 v[120:121], v[120:121], v[30:31] op_sel_hi:[1,0]
v_pk_mul_f32 v[154:155], v[154:155], v[122:123]
v_pk_mul_f32 v[122:123], v[122:123], v[30:31] op_sel_hi:[1,0]
v_pk_fma_f32 v[100:101], v[100:101], v[22:23], v[22:23] op_sel:[0,1,1] op_sel_hi:[1,1,1]
v_pk_fma_f32 v[102:103], v[102:103], v[22:23], v[22:23] op_sel:[0,1,1] op_sel_hi:[1,1,1]
v_pk_fma_f32 v[116:117], v[116:117], v[22:23], v[22:23] op_sel:[0,1,1] op_sel_hi:[1,1,1]
v_pk_fma_f32 v[118:119], v[118:119], v[22:23], v[22:23] op_sel:[0,1,1] op_sel_hi:[1,1,1]
v_cvt_pk_bf16_f32 v96, v128, v129
v_cvt_pk_bf16_f32 v97, v130, v131
ds_read_b128 v[128:131], v9 offset:320
v_cvt_pk_bf16_f32 v98, v144, v145
v_cvt_pk_bf16_f32 v99, v146, v147
v_mfma_f32_16x16x32_bf16 v[108:111], a[112:115], a[156:159], v[108:111]
buffer_store_dwordx4 v[96:99], v10, s[16:19], s63 offen sc1
v_mfma_f32_16x16x32_bf16 v[124:127], a[116:119], a[156:159], v[124:127]
ds_read_b128 v[144:147], v9 offset:768
v_rcp_f32 v100, v100
v_mfma_f32_16x16x32_bf16 v[140:143], a[120:123], a[156:159], v[140:143]
v_rcp_f32 v101, v101
v_mfma_f32_16x16x32_bf16 v[156:159], a[124:127], a[156:159], v[156:159]
v_rcp_f32 v102, v102
v_mfma_f32_16x16x32_bf16 v[108:111], a[192:195], a[172:175], v[108:111]
buffer_load_dwordx4 v18, s[28:31], s58 offen lds
v_mfma_f32_16x16x32_bf16 v[124:127], a[196:199], a[172:175], v[124:127]
v_rcp_f32 v103, v103
v_mfma_f32_16x16x32_bf16 v[140:143], a[200:203], a[172:175], v[140:143]
v_rcp_f32 v116, v116
v_mfma_f32_16x16x32_bf16 v[156:159], a[204:207], a[172:175], v[156:159]
v_rcp_f32 v117, v117
v_mfma_f32_16x16x32_bf16 v[108:111], a[208:211], a[188:191], v[108:111]
buffer_load_dwordx4 v19, s[28:31], s58 offen offset:1056 lds
v_mfma_f32_16x16x32_bf16 v[124:127], a[212:215], a[188:191], v[124:127]
s_add_u32 m0, s59, 109824
s_mov_b32 s58, 851968
v_rcp_f32 v118, v118
v_mfma_f32_16x16x32_bf16 v[140:143], a[216:219], a[188:191], v[140:143]
v_rcp_f32 v119, v119
v_mfma_f32_16x16x32_bf16 v[156:159], a[220:223], a[188:191], v[156:159]
v_exp_f32 v104, v104
v_exp_f32 v105, v105
v_exp_f32 v106, v106
v_exp_f32 v107, v107
v_exp_f32 v120, v120
v_exp_f32 v121, v121
v_exp_f32 v122, v122
v_exp_f32 v123, v123
v_pk_mul_f32 v[132:133], v[132:133], v[100:101]
v_pk_mul_f32 v[134:135], v[134:135], v[102:103]
v_pk_mul_f32 v[148:149], v[148:149], v[116:117]
v_pk_mul_f32 v[150:151], v[150:151], v[118:119]
v_pk_fma_f32 v[108:109], v[48:49], v[26:27], v[108:109] op_sel_hi:[1,0,1]
v_pk_fma_f32 v[110:111], v[50:51], v[26:27], v[110:111] op_sel_hi:[1,0,1]
v_pk_fma_f32 v[124:125], v[64:65], v[26:27], v[124:125] op_sel_hi:[1,0,1]
v_pk_fma_f32 v[126:127], v[66:67], v[26:27], v[126:127] op_sel_hi:[1,0,1]
v_pk_fma_f32 v[140:141], v[80:81], v[26:27], v[140:141] op_sel_hi:[1,0,1]
v_pk_fma_f32 v[142:143], v[82:83], v[26:27], v[142:143] op_sel_hi:[1,0,1]
v_pk_fma_f32 v[156:157], v[4:5], v[26:27], v[156:157] op_sel_hi:[1,0,1]
v_pk_fma_f32 v[158:159], v[6:7], v[26:27], v[158:159] op_sel_hi:[1,0,1]
ds_read_b128 v[4:7], v8 offset:576
v_pk_mul_f32 v[140:141], v[140:141], v[108:109]
v_pk_mul_f32 v[108:109], v[108:109], v[30:31] op_sel:[0,1] op_sel_hi:[1,1]
v_pk_mul_f32 v[142:143], v[142:143], v[110:111]
v_pk_mul_f32 v[110:111], v[110:111], v[30:31] op_sel:[0,1] op_sel_hi:[1,1]
v_pk_mul_f32 v[156:157], v[156:157], v[124:125]
v_pk_mul_f32 v[124:125], v[124:125], v[30:31] op_sel:[0,1] op_sel_hi:[1,1]
v_pk_mul_f32 v[158:159], v[158:159], v[126:127]
v_pk_mul_f32 v[126:127], v[126:127], v[30:31] op_sel:[0,1] op_sel_hi:[1,1]
v_pk_fma_f32 v[104:105], v[104:105], v[24:25], v[24:25] op_sel:[0,1,1] op_sel_hi:[1,1,1]
v_pk_fma_f32 v[106:107], v[106:107], v[24:25], v[24:25] op_sel:[0,1,1] op_sel_hi:[1,1,1]
v_pk_fma_f32 v[120:121], v[120:121], v[24:25], v[24:25] op_sel:[0,1,1] op_sel_hi:[1,1,1]
v_pk_fma_f32 v[122:123], v[122:123], v[24:25], v[24:25] op_sel:[0,1,1] op_sel_hi:[1,1,1]
v_cvt_pk_bf16_f32 v100, v132, v133
v_cvt_pk_bf16_f32 v101, v134, v135
v_cvt_pk_bf16_f32 v102, v148, v149
v_cvt_pk_bf16_f32 v103, v150, v151
v_mfma_f32_16x16x32_bf16 v[160:163], a[0:3], a[144:147], v[160:163]
buffer_store_dwordx4 v[100:103], v10, s[16:19], s63 offen offset:1024 sc1
v_mfma_f32_16x16x32_bf16 v[176:179], a[4:7], a[144:147], v[176:179]
.Lpad31:
s_cbranch_execz .Lnopoll60r
v_rcp_f32 v104, v104
v_mfma_f32_16x16x32_bf16 v[192:195], a[8:11], a[144:147], v[192:195]
v_rcp_f32 v105, v105
v_mfma_f32_16x16x32_bf16 v[208:211], a[12:15], a[144:147], v[208:211]
v_rcp_f32 v106, v106
v_mfma_f32_16x16x32_bf16 v[160:163], a[16:19], a[160:163], v[160:163]
buffer_load_dwordx4 v18, s[28:31], s58 offen lds
v_mfma_f32_16x16x32_bf16 v[176:179], a[20:23], a[160:163], v[176:179]
v_rcp_f32 v107, v107
v_mfma_f32_16x16x32_bf16 v[192:195], a[24:27], a[160:163], v[192:195]
v_rcp_f32 v120, v120
v_mfma_f32_16x16x32_bf16 v[208:211], a[28:31], a[160:163], v[208:211]
v_rcp_f32 v121, v121
v_mfma_f32_16x16x32_bf16 v[160:163], a[32:35], a[176:179], v[160:163]
buffer_load_dwordx4 v19, s[28:31], s58 offen offset:1056 lds
v_mfma_f32_16x16x32_bf16 v[176:179], a[36:39], a[176:179], v[176:179]
v_rcp_f32 v122, v122
v_mfma_f32_16x16x32_bf16 v[192:195], a[40:43], a[176:179], v[192:195]
v_rcp_f32 v123, v123
v_mfma_f32_16x16x32_bf16 v[208:211], a[44:47], a[176:179], v[208:211]
v_exp_f32 v108, v108
v_exp_f32 v109, v109
v_exp_f32 v110, v110
v_exp_f32 v111, v111
v_exp_f32 v124, v124
v_exp_f32 v125, v125
v_exp_f32 v126, v126
v_exp_f32 v127, v127
v_pk_mul_f32 v[136:137], v[136:137], v[104:105]
v_pk_mul_f32 v[138:139], v[138:139], v[106:107]
v_pk_mul_f32 v[152:153], v[152:153], v[120:121]
v_pk_mul_f32 v[154:155], v[154:155], v[122:123]
s_waitcnt lgkmcnt(3)
v_pk_fma_f32 v[160:161], v[112:113], v[20:21], v[160:161] op_sel_hi:[1,0,1]
v_pk_fma_f32 v[162:163], v[114:115], v[20:21], v[162:163] op_sel_hi:[1,0,1]
s_waitcnt lgkmcnt(2)
v_pk_fma_f32 v[176:177], v[128:129], v[20:21], v[176:177] op_sel_hi:[1,0,1]
v_pk_fma_f32 v[178:179], v[130:131], v[20:21], v[178:179] op_sel_hi:[1,0,1]
s_waitcnt lgkmcnt(1)
v_pk_fma_f32 v[192:193], v[144:145], v[20:21], v[192:193] op_sel_hi:[1,0,1]
v_pk_fma_f32 v[194:195], v[146:147], v[20:21], v[194:195] op_sel_hi:[1,0,1]
v_pk_fma_f32 v[208:209], v[12:13], v[20:21], v[208:209] op_sel_hi:[1,0,1]
v_pk_fma_f32 v[210:211], v[14:15], v[20:21], v[210:211] op_sel_hi:[1,0,1]
v_pk_mul_f32 v[192:193], v[192:193], v[160:161]
v_pk_mul_f32 v[160:161], v[160:161], v[28:29] op_sel_hi:[1,0]
v_pk_mul_f32 v[194:195], v[194:195], v[162:163]
v_pk_mul_f32 v[162:163], v[162:163], v[28:29] op_sel_hi:[1,0]
v_pk_mul_f32 v[208:209], v[208:209], v[176:177]
v_pk_mul_f32 v[176:177], v[176:177], v[28:29] op_sel_hi:[1,0]
v_pk_mul_f32 v[210:211], v[210:211], v[178:179]
v_pk_mul_f32 v[178:179], v[178:179], v[28:29] op_sel_hi:[1,0]
v_pk_fma_f32 v[108:109], v[108:109], v[26:27], v[26:27] op_sel:[0,1,1] op_sel_hi:[1,1,1]
v_pk_fma_f32 v[110:111], v[110:111], v[26:27], v[26:27] op_sel:[0,1,1] op_sel_hi:[1,1,1]
v_pk_fma_f32 v[124:125], v[124:125], v[26:27], v[26:27] op_sel:[0,1,1] op_sel_hi:[1,1,1]
v_pk_fma_f32 v[126:127], v[126:127], v[26:27], v[26:27] op_sel:[0,1,1] op_sel_hi:[1,1,1]
v_cvt_pk_bf16_f32 v104, v136, v137
v_cvt_pk_bf16_f32 v105, v138, v139
v_cvt_pk_bf16_f32 v106, v152, v153
v_cvt_pk_bf16_f32 v107, v154, v155
v_mfma_f32_16x16x32_bf16 v[164:167], a[0:3], a[148:151], v[164:167]
buffer_store_dwordx4 v[104:107], v11, s[16:19], s63 offen sc1
v_mfma_f32_16x16x32_bf16 v[180:183], a[4:7], a[148:151], v[180:183]
v_rcp_f32 v108, v108
v_mfma_f32_16x16x32_bf16 v[196:199], a[8:11], a[148:151], v[196:199]
v_rcp_f32 v109, v109
v_mfma_f32_16x16x32_bf16 v[212:215], a[12:15], a[148:151], v[212:215]
v_rcp_f32 v110, v110
v_mfma_f32_16x16x32_bf16 v[164:167], a[16:19], a[164:167], v[164:167]
v_rcp_f32 v111, v111
v_mfma_f32_16x16x32_bf16 v[180:183], a[20:23], a[164:167], v[180:183]
v_rcp_f32 v124, v124
v_mfma_f32_16x16x32_bf16 v[196:199], a[24:27], a[164:167], v[196:199]
v_rcp_f32 v125, v125
v_mfma_f32_16x16x32_bf16 v[212:215], a[28:31], a[164:167], v[212:215]
v_rcp_f32 v126, v126
v_mfma_f32_16x16x32_bf16 v[164:167], a[32:35], a[180:183], v[164:167]
v_rcp_f32 v127, v127
v_mfma_f32_16x16x32_bf16 v[180:183], a[36:39], a[180:183], v[180:183]
v_exp_f32 v160, v160
v_mfma_f32_16x16x32_bf16 v[196:199], a[40:43], a[180:183], v[196:199]
v_exp_f32 v161, v161
v_mfma_f32_16x16x32_bf16 v[212:215], a[44:47], a[180:183], v[212:215]
v_exp_f32 v162, v162
v_exp_f32 v163, v163
v_exp_f32 v176, v176
v_exp_f32 v177, v177
v_exp_f32 v178, v178
v_exp_f32 v179, v179
v_pk_mul_f32 v[140:141], v[140:141], v[108:109]
v_pk_mul_f32 v[142:143], v[142:143], v[110:111]
v_pk_mul_f32 v[156:157], v[156:157], v[124:125]
v_pk_mul_f32 v[158:159], v[158:159], v[126:127]
v_pk_fma_f32 v[164:165], v[112:113], v[22:23], v[164:165] op_sel_hi:[1,0,1]
v_pk_fma_f32 v[166:167], v[114:115], v[22:23], v[166:167] op_sel_hi:[1,0,1]
v_pk_fma_f32 v[180:181], v[128:129], v[22:23], v[180:181] op_sel_hi:[1,0,1]
v_pk_fma_f32 v[182:183], v[130:131], v[22:23], v[182:183] op_sel_hi:[1,0,1]
v_pk_fma_f32 v[196:197], v[144:145], v[22:23], v[196:197] op_sel_hi:[1,0,1]
v_pk_fma_f32 v[198:199], v[146:147], v[22:23], v[198:199] op_sel_hi:[1,0,1]
v_pk_fma_f32 v[212:213], v[12:13], v[22:23], v[212:213] op_sel_hi:[1,0,1]
v_pk_fma_f32 v[214:215], v[14:15], v[22:23], v[214:215] op_sel_hi:[1,0,1]
v_pk_mul_f32 v[196:197], v[196:197], v[164:165]
v_pk_mul_f32 v[164:165], v[164:165], v[28:29] op_sel:[0,1] op_sel_hi:[1,1]
v_pk_mul_f32 v[198:199], v[198:199], v[166:167]
v_pk_mul_f32 v[166:167], v[166:167], v[28:29] op_sel:[0,1] op_sel_hi:[1,1]
v_pk_mul_f32 v[212:213], v[212:213], v[180:181]
v_pk_mul_f32 v[180:181], v[180:181], v[28:29] op_sel:[0,1] op_sel_hi:[1,1]
v_pk_mul_f32 v[214:215], v[214:215], v[182:183]
v_pk_mul_f32 v[182:183], v[182:183], v[28:29] op_sel:[0,1] op_sel_hi:[1,1]
v_pk_fma_f32 v[160:161], v[160:161], v[20:21], v[20:21] op_sel:[0,1,1] op_sel_hi:[1,1,1]
v_pk_fma_f32 v[162:163], v[162:163], v[20:21], v[20:21] op_sel:[0,1,1] op_sel_hi:[1,1,1]
v_pk_fma_f32 v[176:177], v[176:177], v[20:21], v[20:21] op_sel:[0,1,1] op_sel_hi:[1,1,1]
v_pk_fma_f32 v[178:179], v[178:179], v[20:21], v[20:21] op_sel:[0,1,1] op_sel_hi:[1,1,1]
v_cvt_pk_bf16_f32 v108, v140, v141
v_cvt_pk_bf16_f32 v109, v142, v143
v_cvt_pk_bf16_f32 v110, v156, v157
v_cvt_pk_bf16_f32 v111, v158, v159
v_mfma_f32_16x16x32_bf16 v[168:171], a[0:3], a[152:155], v[168:171]
buffer_store_dwordx4 v[108:111], v11, s[16:19], s63 offen offset:1024 sc1
v_mfma_f32_16x16x32_bf16 v[184:187], a[4:7], a[152:155], v[184:187]
v_rcp_f32 v160, v160
v_mfma_f32_16x16x32_bf16 v[200:203], a[8:11], a[152:155], v[200:203]
v_rcp_f32 v161, v161
v_mfma_f32_16x16x32_bf16 v[216:219], a[12:15], a[152:155], v[216:219]
v_rcp_f32 v162, v162
v_mfma_f32_16x16x32_bf16 v[168:171], a[16:19], a[168:171], v[168:171]
v_rcp_f32 v163, v163
v_mfma_f32_16x16x32_bf16 v[184:187], a[20:23], a[168:171], v[184:187]
v_rcp_f32 v176, v176
v_mfma_f32_16x16x32_bf16 v[200:203], a[24:27], a[168:171], v[200:203]
v_rcp_f32 v177, v177
v_mfma_f32_16x16x32_bf16 v[216:219], a[28:31], a[168:171], v[216:219]
v_rcp_f32 v178, v178
v_mfma_f32_16x16x32_bf16 v[168:171], a[32:35], a[184:187], v[168:171]
v_rcp_f32 v179, v179
v_mfma_f32_16x16x32_bf16 v[184:187], a[36:39], a[184:187], v[184:187]
v_exp_f32 v164, v164
v_mfma_f32_16x16x32_bf16 v[200:203], a[40:43], a[184:187], v[200:203]
v_exp_f32 v165, v165
v_mfma_f32_16x16x32_bf16 v[216:219], a[44:47], a[184:187], v[216:219]
v_exp_f32 v166, v166
v_exp_f32 v167, v167
v_exp_f32 v180, v180
v_exp_f32 v181, v181
v_exp_f32 v182, v182
v_exp_f32 v183, v183
v_pk_mul_f32 v[192:193], v[192:193], v[160:161]
v_pk_mul_f32 v[194:195], v[194:195], v[162:163]
v_pk_mul_f32 v[208:209], v[208:209], v[176:177]
v_pk_mul_f32 v[210:211], v[210:211], v[178:179]
ds_read_b128 v[176:179], v8
v_pk_fma_f32 v[168:169], v[112:113], v[24:25], v[168:169] op_sel_hi:[1,0,1]
v_pk_fma_f32 v[170:171], v[114:115], v[24:25], v[170:171] op_sel_hi:[1,0,1]
v_pk_fma_f32 v[184:185], v[128:129], v[24:25], v[184:185] op_sel_hi:[1,0,1]
v_pk_fma_f32 v[186:187], v[130:131], v[24:25], v[186:187] op_sel_hi:[1,0,1]
v_pk_fma_f32 v[200:201], v[144:145], v[24:25], v[200:201] op_sel_hi:[1,0,1]
v_pk_fma_f32 v[202:203], v[146:147], v[24:25], v[202:203] op_sel_hi:[1,0,1]
v_pk_fma_f32 v[216:217], v[12:13], v[24:25], v[216:217] op_sel_hi:[1,0,1]
v_pk_fma_f32 v[218:219], v[14:15], v[24:25], v[218:219] op_sel_hi:[1,0,1]
v_pk_mul_f32 v[200:201], v[200:201], v[168:169]
v_pk_mul_f32 v[168:169], v[168:169], v[30:31] op_sel_hi:[1,0]
v_pk_mul_f32 v[202:203], v[202:203], v[170:171]
v_pk_mul_f32 v[170:171], v[170:171], v[30:31] op_sel_hi:[1,0]
v_pk_mul_f32 v[216:217], v[216:217], v[184:185]
v_pk_mul_f32 v[184:185], v[184:185], v[30:31] op_sel_hi:[1,0]
v_pk_mul_f32 v[218:219], v[218:219], v[186:187]
v_pk_mul_f32 v[186:187], v[186:187], v[30:31] op_sel_hi:[1,0]
v_pk_fma_f32 v[164:165], v[164:165], v[22:23], v[22:23] op_sel:[0,1,1] op_sel_hi:[1,1,1]
v_pk_fma_f32 v[166:167], v[166:167], v[22:23], v[22:23] op_sel:[0,1,1] op_sel_hi:[1,1,1]
v_pk_fma_f32 v[180:181], v[180:181], v[22:23], v[22:23] op_sel:[0,1,1] op_sel_hi:[1,1,1]
v_pk_fma_f32 v[182:183], v[182:183], v[22:23], v[22:23] op_sel:[0,1,1] op_sel_hi:[1,1,1]
v_cvt_pk_bf16_f32 v160, v192, v193
v_cvt_pk_bf16_f32 v161, v194, v195
ds_read_b128 v[192:195], v8 offset:64
v_cvt_pk_bf16_f32 v162, v208, v209
v_cvt_pk_bf16_f32 v163, v210, v211
v_mfma_f32_16x16x32_bf16 v[172:175], a[0:3], a[156:159], v[172:175]
buffer_store_dwordx4 v[160:163], v10, s[16:19], s64 offen sc1
v_mfma_f32_16x16x32_bf16 v[188:191], a[4:7], a[156:159], v[188:191]
ds_read_b128 v[208:211], v8 offset:512
v_rcp_f32 v164, v164
v_mfma_f32_16x16x32_bf16 v[204:207], a[8:11], a[156:159], v[204:207]
v_rcp_f32 v165, v165
v_mfma_f32_16x16x32_bf16 v[220:223], a[12:15], a[156:159], v[220:223]
v_rcp_f32 v166, v166
v_mfma_f32_16x16x32_bf16 v[172:175], a[16:19], a[172:175], v[172:175]
v_rcp_f32 v167, v167
v_mfma_f32_16x16x32_bf16 v[188:191], a[20:23], a[172:175], v[188:191]
v_rcp_f32 v180, v180
v_mfma_f32_16x16x32_bf16 v[204:207], a[24:27], a[172:175], v[204:207]
v_rcp_f32 v181, v181
v_mfma_f32_16x16x32_bf16 v[220:223], a[28:31], a[172:175], v[220:223]
v_rcp_f32 v182, v182
v_mfma_f32_16x16x32_bf16 v[172:175], a[32:35], a[188:191], v[172:175]
v_rcp_f32 v183, v183
v_mfma_f32_16x16x32_bf16 v[188:191], a[36:39], a[188:191], v[188:191]
v_exp_f32 v168, v168
v_mfma_f32_16x16x32_bf16 v[204:207], a[40:43], a[188:191], v[204:207]
v_exp_f32 v169, v169
v_mfma_f32_16x16x32_bf16 v[220:223], a[44:47], a[188:191], v[220:223]
v_exp_f32 v170, v170
v_exp_f32 v171, v171
v_exp_f32 v184, v184
v_exp_f32 v185, v185
v_exp_f32 v186, v186
v_exp_f32 v187, v187
v_pk_mul_f32 v[196:197], v[196:197], v[164:165]
v_pk_mul_f32 v[198:199], v[198:199], v[166:167]
v_pk_mul_f32 v[212:213], v[212:213], v[180:181]
v_pk_mul_f32 v[214:215], v[214:215], v[182:183]
v_pk_fma_f32 v[172:173], v[112:113], v[26:27], v[172:173] op_sel_hi:[1,0,1]
v_pk_fma_f32 v[174:175], v[114:115], v[26:27], v[174:175] op_sel_hi:[1,0,1]
v_pk_fma_f32 v[188:189], v[128:129], v[26:27], v[188:189] op_sel_hi:[1,0,1]
v_pk_fma_f32 v[190:191], v[130:131], v[26:27], v[190:191] op_sel_hi:[1,0,1]
v_pk_fma_f32 v[204:205], v[144:145], v[26:27], v[204:205] op_sel_hi:[1,0,1]
v_pk_fma_f32 v[206:207], v[146:147], v[26:27], v[206:207] op_sel_hi:[1,0,1]
v_pk_fma_f32 v[220:221], v[12:13], v[26:27], v[220:221] op_sel_hi:[1,0,1]
v_pk_fma_f32 v[222:223], v[14:15], v[26:27], v[222:223] op_sel_hi:[1,0,1]
v_pk_mul_f32 v[204:205], v[204:205], v[172:173]
v_pk_mul_f32 v[172:173], v[172:173], v[30:31] op_sel:[0,1] op_sel_hi:[1,1]
v_pk_mul_f32 v[206:207], v[206:207], v[174:175]
v_pk_mul_f32 v[174:175], v[174:175], v[30:31] op_sel:[0,1] op_sel_hi:[1,1]
v_pk_mul_f32 v[220:221], v[220:221], v[188:189]
v_pk_mul_f32 v[188:189], v[188:189], v[30:31] op_sel:[0,1] op_sel_hi:[1,1]
v_pk_mul_f32 v[222:223], v[222:223], v[190:191]
v_pk_mul_f32 v[190:191], v[190:191], v[30:31] op_sel:[0,1] op_sel_hi:[1,1]
v_pk_fma_f32 v[168:169], v[168:169], v[24:25], v[24:25] op_sel:[0,1,1] op_sel_hi:[1,1,1]
v_pk_fma_f32 v[170:171], v[170:171], v[24:25], v[24:25] op_sel:[0,1,1] op_sel_hi:[1,1,1]
v_pk_fma_f32 v[184:185], v[184:185], v[24:25], v[24:25] op_sel:[0,1,1] op_sel_hi:[1,1,1]
v_pk_fma_f32 v[186:187], v[186:187], v[24:25], v[24:25] op_sel:[0,1,1] op_sel_hi:[1,1,1]
v_cvt_pk_bf16_f32 v164, v196, v197
v_cvt_pk_bf16_f32 v165, v198, v199
v_cvt_pk_bf16_f32 v166, v212, v213
v_cvt_pk_bf16_f32 v167, v214, v215
v_mfma_f32_16x16x32_bf16 v[224:227], a[48:51], a[144:147], v[224:227]
buffer_store_dwordx4 v[164:167], v10, s[16:19], s64 offen offset:1024 sc1
v_mfma_f32_16x16x32_bf16 v[232:235], a[52:55], a[144:147], v[232:235]
v_rcp_f32 v168, v168
v_mfma_f32_16x16x32_bf16 v[240:243], a[56:59], a[144:147], v[240:243]
v_rcp_f32 v169, v169
v_mfma_f32_16x16x32_bf16 v[248:251], a[60:63], a[144:147], v[248:251]
v_rcp_f32 v170, v170
v_mfma_f32_16x16x32_bf16 v[224:227], a[64:67], a[160:163], v[224:227]
v_rcp_f32 v171, v171
v_mfma_f32_16x16x32_bf16 v[232:235], a[68:71], a[160:163], v[232:235]
v_rcp_f32 v184, v184
v_mfma_f32_16x16x32_bf16 v[240:243], a[72:75], a[160:163], v[240:243]
v_rcp_f32 v185, v185
v_mfma_f32_16x16x32_bf16 v[248:251], a[76:79], a[160:163], v[248:251]
v_rcp_f32 v186, v186
v_mfma_f32_16x16x32_bf16 v[224:227], a[80:83], a[176:179], v[224:227]
v_rcp_f32 v187, v187
v_mfma_f32_16x16x32_bf16 v[232:235], a[84:87], a[176:179], v[232:235]
v_exp_f32 v172, v172
v_mfma_f32_16x16x32_bf16 v[240:243], a[88:91], a[176:179], v[240:243]
v_exp_f32 v173, v173
v_mfma_f32_16x16x32_bf16 v[248:251], a[92:95], a[176:179], v[248:251]
v_exp_f32 v174, v174
v_exp_f32 v175, v175
v_exp_f32 v188, v188
v_exp_f32 v189, v189
v_exp_f32 v190, v190
v_exp_f32 v191, v191
v_pk_mul_f32 v[200:201], v[200:201], v[168:169]
v_pk_mul_f32 v[202:203], v[202:203], v[170:171]
v_pk_mul_f32 v[216:217], v[216:217], v[184:185]
v_pk_mul_f32 v[218:219], v[218:219], v[186:187]
s_waitcnt lgkmcnt(2)
v_pk_fma_f32 v[224:225], v[176:177], v[20:21], v[224:225] op_sel_hi:[1,0,1]
v_pk_fma_f32 v[226:227], v[178:179], v[20:21], v[226:227] op_sel_hi:[1,0,1]
s_waitcnt lgkmcnt(1)
v_pk_fma_f32 v[232:233], v[192:193], v[20:21], v[232:233] op_sel_hi:[1,0,1]
v_pk_fma_f32 v[234:235], v[194:195], v[20:21], v[234:235] op_sel_hi:[1,0,1]
s_waitcnt lgkmcnt(0)
v_pk_fma_f32 v[240:241], v[208:209], v[20:21], v[240:241] op_sel_hi:[1,0,1]
v_pk_fma_f32 v[242:243], v[210:211], v[20:21], v[242:243] op_sel_hi:[1,0,1]
v_pk_fma_f32 v[248:249], v[4:5], v[20:21], v[248:249] op_sel_hi:[1,0,1]
v_pk_fma_f32 v[250:251], v[6:7], v[20:21], v[250:251] op_sel_hi:[1,0,1]
v_pk_mul_f32 v[240:241], v[240:241], v[224:225]
v_pk_mul_f32 v[224:225], v[224:225], v[28:29] op_sel_hi:[1,0]
v_pk_mul_f32 v[242:243], v[242:243], v[226:227]
v_pk_mul_f32 v[226:227], v[226:227], v[28:29] op_sel_hi:[1,0]
v_pk_mul_f32 v[248:249], v[248:249], v[232:233]
v_pk_mul_f32 v[232:233], v[232:233], v[28:29] op_sel_hi:[1,0]
v_pk_mul_f32 v[250:251], v[250:251], v[234:235]
v_pk_mul_f32 v[234:235], v[234:235], v[28:29] op_sel_hi:[1,0]
v_pk_fma_f32 v[172:173], v[172:173], v[26:27], v[26:27] op_sel:[0,1,1] op_sel_hi:[1,1,1]
v_pk_fma_f32 v[174:175], v[174:175], v[26:27], v[26:27] op_sel:[0,1,1] op_sel_hi:[1,1,1]
v_pk_fma_f32 v[188:189], v[188:189], v[26:27], v[26:27] op_sel:[0,1,1] op_sel_hi:[1,1,1]
v_pk_fma_f32 v[190:191], v[190:191], v[26:27], v[26:27] op_sel:[0,1,1] op_sel_hi:[1,1,1]
v_cvt_pk_bf16_f32 v168, v200, v201
v_cvt_pk_bf16_f32 v169, v202, v203
v_cvt_pk_bf16_f32 v170, v216, v217
v_cvt_pk_bf16_f32 v171, v218, v219
v_mfma_f32_16x16x32_bf16 v[228:231], a[48:51], a[148:151], v[228:231]
buffer_store_dwordx4 v[168:171], v11, s[16:19], s64 offen sc1
v_mfma_f32_16x16x32_bf16 v[236:239], a[52:55], a[148:151], v[236:239]
v_rcp_f32 v172, v172
v_mfma_f32_16x16x32_bf16 v[244:247], a[56:59], a[148:151], v[244:247]
v_rcp_f32 v173, v173
v_mfma_f32_16x16x32_bf16 v[252:255], a[60:63], a[148:151], v[252:255]
v_rcp_f32 v174, v174
v_mfma_f32_16x16x32_bf16 v[228:231], a[64:67], a[164:167], v[228:231]
v_rcp_f32 v175, v175
v_mfma_f32_16x16x32_bf16 v[236:239], a[68:71], a[164:167], v[236:239]
v_rcp_f32 v188, v188
v_mfma_f32_16x16x32_bf16 v[244:247], a[72:75], a[164:167], v[244:247]
v_rcp_f32 v189, v189
v_mfma_f32_16x16x32_bf16 v[252:255], a[76:79], a[164:167], v[252:255]
v_rcp_f32 v190, v190
v_mfma_f32_16x16x32_bf16 v[228:231], a[80:83], a[180:183], v[228:231]
v_rcp_f32 v191, v191
v_mfma_f32_16x16x32_bf16 v[236:239], a[84:87], a[180:183], v[236:239]
v_exp_f32 v224, v224
v_mfma_f32_16x16x32_bf16 v[244:247], a[88:91], a[180:183], v[244:247]
v_exp_f32 v225, v225
v_mfma_f32_16x16x32_bf16 v[252:255], a[92:95], a[180:183], v[252:255]
v_exp_f32 v226, v226
v_exp_f32 v227, v227
v_exp_f32 v232, v232
v_exp_f32 v233, v233
v_exp_f32 v234, v234
v_exp_f32 v235, v235
v_pk_mul_f32 v[204:205], v[204:205], v[172:173]
v_pk_mul_f32 v[206:207], v[206:207], v[174:175]
v_pk_mul_f32 v[220:221], v[220:221], v[188:189]
v_pk_mul_f32 v[222:223], v[222:223], v[190:191]
v_pk_fma_f32 v[228:229], v[176:177], v[22:23], v[228:229] op_sel_hi:[1,0,1]
v_pk_fma_f32 v[230:231], v[178:179], v[22:23], v[230:231] op_sel_hi:[1,0,1]
v_pk_fma_f32 v[236:237], v[192:193], v[22:23], v[236:237] op_sel_hi:[1,0,1]
v_pk_fma_f32 v[238:239], v[194:195], v[22:23], v[238:239] op_sel_hi:[1,0,1]
v_pk_fma_f32 v[244:245], v[208:209], v[22:23], v[244:245] op_sel_hi:[1,0,1]
v_pk_fma_f32 v[246:247], v[210:211], v[22:23], v[246:247] op_sel_hi:[1,0,1]
v_pk_fma_f32 v[252:253], v[4:5], v[22:23], v[252:253] op_sel_hi:[1,0,1]
v_pk_fma_f32 v[254:255], v[6:7], v[22:23], v[254:255] op_sel_hi:[1,0,1]
v_pk_mul_f32 v[244:245], v[244:245], v[228:229]
v_pk_mul_f32 v[228:229], v[228:229], v[28:29] op_sel:[0,1] op_sel_hi:[1,1]
v_pk_mul_f32 v[246:247], v[246:247], v[230:231]
v_pk_mul_f32 v[230:231], v[230:231], v[28:29] op_sel:[0,1] op_sel_hi:[1,1]
v_pk_mul_f32 v[252:253], v[252:253], v[236:237]
v_pk_mul_f32 v[236:237], v[236:237], v[28:29] op_sel:[0,1] op_sel_hi:[1,1]
v_pk_mul_f32 v[254:255], v[254:255], v[238:239]
v_pk_mul_f32 v[238:239], v[238:239], v[28:29] op_sel:[0,1] op_sel_hi:[1,1]
v_pk_fma_f32 v[224:225], v[224:225], v[20:21], v[20:21] op_sel:[0,1,1] op_sel_hi:[1,1,1]
v_pk_fma_f32 v[226:227], v[226:227], v[20:21], v[20:21] op_sel:[0,1,1] op_sel_hi:[1,1,1]
v_pk_fma_f32 v[232:233], v[232:233], v[20:21], v[20:21] op_sel:[0,1,1] op_sel_hi:[1,1,1]
v_pk_fma_f32 v[234:235], v[234:235], v[20:21], v[20:21] op_sel:[0,1,1] op_sel_hi:[1,1,1]
v_cvt_pk_bf16_f32 v172, v204, v205
v_cvt_pk_bf16_f32 v173, v206, v207
v_cvt_pk_bf16_f32 v174, v220, v221
v_cvt_pk_bf16_f32 v175, v222, v223
buffer_store_dwordx4 v[172:175], v11, s[16:19], s64 offen offset:1024 sc1
v_rcp_f32 v224, v224
v_rcp_f32 v225, v225
v_rcp_f32 v226, v226
v_rcp_f32 v227, v227
v_rcp_f32 v232, v232
v_rcp_f32 v233, v233
v_rcp_f32 v234, v234
v_rcp_f32 v235, v235
v_exp_f32 v228, v228
v_exp_f32 v229, v229
v_exp_f32 v230, v230
v_exp_f32 v231, v231
v_exp_f32 v236, v236
v_exp_f32 v237, v237
v_exp_f32 v238, v238
v_exp_f32 v239, v239
v_pk_mul_f32 v[240:241], v[240:241], v[224:225]
v_pk_mul_f32 v[242:243], v[242:243], v[226:227]
v_pk_mul_f32 v[248:249], v[248:249], v[232:233]
v_pk_mul_f32 v[250:251], v[250:251], v[234:235]
v_pk_fma_f32 v[228:229], v[228:229], v[22:23], v[22:23] op_sel:[0,1,1] op_sel_hi:[1,1,1]
v_pk_fma_f32 v[230:231], v[230:231], v[22:23], v[22:23] op_sel:[0,1,1] op_sel_hi:[1,1,1]
v_pk_fma_f32 v[236:237], v[236:237], v[22:23], v[22:23] op_sel:[0,1,1] op_sel_hi:[1,1,1]
v_pk_fma_f32 v[238:239], v[238:239], v[22:23], v[22:23] op_sel:[0,1,1] op_sel_hi:[1,1,1]
v_cvt_pk_bf16_f32 v224, v240, v241
v_cvt_pk_bf16_f32 v225, v242, v243
v_cvt_pk_bf16_f32 v226, v248, v249
v_cvt_pk_bf16_f32 v227, v250, v251
buffer_store_dwordx4 v[224:227], v10, s[16:19], s65 offen sc1
v_rcp_f32 v228, v228
v_rcp_f32 v229, v229
v_rcp_f32 v230, v230
v_rcp_f32 v231, v231
v_rcp_f32 v236, v236
v_rcp_f32 v237, v237
v_rcp_f32 v238, v238
v_rcp_f32 v239, v239
v_pk_mul_f32 v[244:245], v[244:245], v[228:229]
v_pk_mul_f32 v[246:247], v[246:247], v[230:231]
v_pk_mul_f32 v[252:253], v[252:253], v[236:237]
v_pk_mul_f32 v[254:255], v[254:255], v[238:239]
v_cvt_pk_bf16_f32 v228, v244, v245
v_cvt_pk_bf16_f32 v229, v246, v247
v_cvt_pk_bf16_f32 v230, v252, v253
v_cvt_pk_bf16_f32 v231, v254, v255
buffer_store_dwordx4 v[228:231], v10, s[16:19], s65 offen offset:1024 sc1
s_nop 1
s_lshl_b32 s62, s5, 2
s_add_u32 s62, s62, s3
s_lshl_b32 s62, s62, 12
s_and_b32 s63, s7, 8
s_lshl_b32 s63, s63, 7
s_add_u32 s62, s62, s63
s_lshr_b32 s63, s28, 7
s_sub_u32 s63, 3, s63
s_and_b32 s63, s63, 7
s_lshl_b32 s63, s63, 7
s_add_u32 s62, s62, s63
v_lshrrev_b32 v2, 5, v1
v_mul_u32_u24 v2, 3670016, v2
v_bfe_u32 v9, v1, 4, 1
v_lshl_add_u32 v9, v9, 11, v2
v_add_u32 v9, s62, v9
s_mov_b32 s44, 917504
buffer_load_dword v27, v9, s[28:31], s44 offen
s_add_u32 s44, s44, 0x80000
s_lshl_b32 s62, s6, 13
s_lshl_b32 s63, s3, 11
s_add_u32 s62, s62, s63
v_lshl_add_u32 v4, v1, 4, s62
v_lshrrev_b32 v2, 3, v1
v_cmp_eq_u32 vcc, 3, v2
v_add_u32 v2, 67108480, v4
s_nop 0
v_cndmask_b32 v4, v4, v2, vcc
s_and_b32 s62, s7, 1
s_mul_i32 s62, s62, 3670016
s_lshr_b32 s63, s7, 1
s_lshl_b32 s63, s63, 8
s_add_u32 s62, s62, s63
s_lshl_b32 s63, s3, 12
s_add_u32 s62, s62, s63
v_lshrrev_b32 v5, 4, v1
v_lshlrev_b32 v5, 14, v5
v_and_b32 v2, 15, v1
v_lshl_add_u32 v5, v2, 4, v5
v_add_u32 v5, s62, v5
v_add_u32 v6, 992, v5
v_bfe_u32 v8, v1, 2, 3
v_mul_u32_u24 v8, 1056, v8
v_bfe_u32 v2, v1, 5, 1
v_lshl_add_u32 v8, v2, 8, v8
v_and_b32 v2, 3, v1
v_lshl_add_u32 v8, v2, 3, v8
s_and_b32 s62, s7, 1
s_lshl_b32 s63, s62, 7
s_xor_b32 s64, s63, 128
v_add_u32 v7, s63, v8
v_add_u32 v10, s64, v8
s_mul_i32 s52, s62, 7340032
s_add_u32 s52, s52, 46137344
s_mov_b32 s54, 917504
s_mul_i32 s55, s3, 2112
s_add_u32 s56, s55, 67584
s_mov_b32 s57, 67584
s_lshl_b32 s70, s2, 10
s_lshl_b32 s62, s3, 7
s_add_u32 s70, s70, s62
s_add_u32 s70, s70, 31457792
s_xor_b32 s71, s70, 32768
v_min_u32 v12, 1, v1
v_lshlrev_b32 v12, 28, v12
v_mov_b32 v13, 1
v_mov_b32 v15, 0
s_lshl_b32 s68, s7, 18
s_add_u32 s68, s68, 146800640
s_xor_b32 s69, s68, 262144
v_mov_b32 v11, v4
v_and_b32 v2, 1, v1
v_lshlrev_b32 v2, 4, v2
v_mov_b32 v224, 0x3f80
v_lshlrev_b32 v2, v2, v224
v_bfe_u32 v224, v1, 2, 2
v_lshrrev_b32 v225, 4, v1
v_cmp_eq_u32 vcc, v224, v225
s_nop 1
v_cndmask_b32 v2, 0, v2, vcc
v_and_b32 v224, 2, v1
v_cmp_eq_u32 vcc, 0, v224
s_nop 1
v_cndmask_b32 v226, 0, v2, vcc
v_cndmask_b32 v227, v2, 0, vcc
v_mov_b64 v[224:225], 0
v_mov_b64 v[228:229], 0
v_mov_b64 v[64:65], 0
v_mov_b64 v[66:67], 0
v_mov_b64 v[68:69], 0
v_mov_b64 v[70:71], 0
v_mov_b64 v[72:73], 0
v_mov_b64 v[74:75], 0
v_mov_b64 v[76:77], 0
v_mov_b64 v[78:79], 0
v_mov_b64 v[80:81], 0
v_mov_b64 v[82:83], 0
v_mov_b64 v[84:85], 0
v_mov_b64 v[86:87], 0
v_mov_b64 v[88:89], 0
v_mov_b64 v[90:91], 0
v_mov_b64 v[92:93], 0
v_mov_b64 v[94:95], 0
v_accvgpr_read_b32 v32, a224
v_accvgpr_read_b32 v33, a225
v_accvgpr_read_b32 v34, a226
v_accvgpr_read_b32 v35, a227
v_accvgpr_read_b32 v36, a228
v_accvgpr_read_b32 v37, a229
v_accvgpr_read_b32 v38, a230
v_accvgpr_read_b32 v39, a231
v_accvgpr_read_b32 v40, a232
v_accvgpr_read_b32 v41, a233
v_accvgpr_read_b32 v42, a234
v_accvgpr_read_b32 v43, a235
v_accvgpr_read_b32 v44, a236
v_accvgpr_read_b32 v45, a237
v_accvgpr_read_b32 v46, a238
v_accvgpr_read_b32 v47, a239
v_accvgpr_read_b32 v48, a240
v_accvgpr_read_b32 v49, a241
v_accvgpr_read_b32 v50, a242
v_accvgpr_read_b32 v51, a243
v_accvgpr_read_b32 v52, a244
v_accvgpr_read_b32 v53, a245
v_accvgpr_read_b32 v54, a246
v_accvgpr_read_b32 v55, a247
v_accvgpr_read_b32 v56, a248
v_accvgpr_read_b32 v57, a249
v_accvgpr_read_b32 v58, a250
v_accvgpr_read_b32 v59, a251
v_accvgpr_read_b32 v60, a252
v_accvgpr_read_b32 v61, a253
v_accvgpr_read_b32 v62, a254
v_accvgpr_read_b32 v63, a255
s_lshr_b32 s62, s6, 1
s_lshl_b32 s62, s62, 8
s_and_b32 s63, s6, 1
s_add_u32 s62, s62, s63
s_lshl_b32 s63, s3, 6
s_add_u32 s62, s62, s63
s_lshl_b32 s62, s62, 11
s_lshl_b32 s63, s7, 7
s_add_u32 s62, s62, s63
v_and_b32 v16, 15, v1
v_lshlrev_b32 v16, 12, v16
v_bfe_u32 v2, v1, 4, 1
v_lshl_add_u32 v16, v2, 5, v16
v_bfe_u32 v2, v1, 5, 1
v_lshl_add_u32 v16, v2, 4, v16
v_add_u32 v16, s62, v16
v_add_u32 v17, 0x10000, v16
s_lshl_b32 s62, s10, 1
s_lshr_b32 s63, s11, 4
s_add_u32 s62, s62, s63
s_lshl_b32 s62, s62, 7
s_add_u32 s62, s62, 30423040
s_and_b32 s64, s6, 14
s_and_b32 s63, s7, 1
s_add_u32 s64, s64, s63
s_lshl_b32 s64, s64, 7
s_add_u32 s64, s64, 30423040
v_mov_b32 v252, s62
v_mov_b32 v253, s64
s_waitcnt vmcnt(0) lgkmcnt(0)
s_barrier
s_cmp_lg_u32 s3, 0
s_cbranch_scc1 .Lnosig63
v_mov_b32 v255, 1
s_mov_b64 exec, 1
buffer_atomic_add v255, v252, s[16:19], 0 offen
s_mov_b64 exec, -1
.Lnosig63:
s_cmp_lg_u32 s3, 1
s_cbranch_scc1 .Lnopoll66
s_mov_b64 exec, 1
s_mov_b32 s15, 0
s_mov_b64 exec, 1
v_mov_b32 v254, 0
buffer_atomic_add v254, v253, s[16:19], 0 offen sc0
.Lpoll64:
s_waitcnt vmcnt(0)
v_cmp_ne_u32 vcc, 16, v254
s_add_u32 s15, s15, 1
s_cbranch_vccz .Lnopoll66r
s_sleep 2
s_mov_b64 exec, 1
v_mov_b32 v254, 0
buffer_atomic_add v254, v253, s[16:19], 0 offen sc0
s_cmp_le_u32 s15, 100000
s_cbranch_scc1 .Lpoll64
.Lgot65:
s_waitcnt vmcnt(0)
s_branch .Lnopoll66r
.Lnopoll66:
s_mov_b64 exec, 0
s_cmp_eq_u32 s3, 2
s_cbranch_scc1 .Lpad32
s_cmp_eq_u32 s3, 3
s_cbranch_scc1 .Lpad33
s_branch .Lpad34
.Lnopoll66r:
s_mov_b64 exec, -1
s_barrier
buffer_load_dwordx4 v[96:99], v4, s[16:19], s52 offen sc1
buffer_load_dwordx4 v[100:103], v4, s[16:19], s52 offen offset:1024 sc1
s_add_u32 s52, s52, 0x20000
buffer_load_dwordx4 v[104:107], v4, s[16:19], s52 offen sc1
buffer_load_dwordx4 v[108:111], v4, s[16:19], s52 offen offset:1024 sc1
s_add_u32 s52, s52, 0x20000
buffer_load_dwordx4 v[112:115], v4, s[16:19], s52 offen sc1
buffer_load_dwordx4 v[116:119], v4, s[16:19], s52 offen offset:1024 sc1
s_add_u32 s52, s52, 0x20000
buffer_load_dwordx4 v[120:123], v4, s[16:19], s52 offen sc1
buffer_load_dwordx4 v[124:127], v4, s[16:19], s52 offen offset:1024 sc1
s_add_u32 s52, s52, 0x20000
buffer_load_dwordx4 v[128:131], v4, s[16:19], s52 offen sc1
buffer_load_dwordx4 v[132:135], v4, s[16:19], s52 offen offset:1024 sc1
s_add_u32 s52, s52, 0x20000
buffer_load_dwordx4 v[136:139], v4, s[16:19], s52 offen sc1
buffer_load_dwordx4 v[140:143], v4, s[16:19], s52 offen offset:1024 sc1
s_add_u32 s52, s52, 0x20000
ds_read_b64_tr_b16 a[0:1], v7
ds_read_b64_tr_b16 a[2:3], v7 offset:512
ds_read_b64_tr_b16 a[4:5], v7 offset:32
ds_read_b64_tr_b16 a[6:7], v7 offset:544
ds_read_b64_tr_b16 a[8:9], v7 offset:64
ds_read_b64_tr_b16 a[10:11], v7 offset:576
ds_read_b64_tr_b16 a[12:13], v7 offset:96
ds_read_b64_tr_b16 a[14:15], v7 offset:608
ds_read_b64_tr_b16 a[16:17], v10
ds_read_b64_tr_b16 a[18:19], v10 offset:512
ds_read_b64_tr_b16 a[20:21], v10 offset:32
ds_read_b64_tr_b16 a[22:23], v10 offset:544
ds_read_b64_tr_b16 a[24:25], v10 offset:64
ds_read_b64_tr_b16 a[26:27], v10 offset:576
ds_read_b64_tr_b16 a[28:29], v10 offset:96
ds_read_b64_tr_b16 a[30:31], v10 offset:608
s_waitcnt lgkmcnt(0)
s_mov_b32 s15, -4
.p2align 6
.Lk68:
.Lpad32:
s_cbranch_execz .Lnopoll66r
s_waitcnt vmcnt(10) lgkmcnt(8)
s_barrier
v_mfma_f32_16x16x32_bf16 v[32:35], a[0:3], v[96:99], v[32:35]
ds_read_b64_tr_b16 a[32:33], v7 offset:8448
s_add_u32 m0, s56, 50688
v_mfma_f32_16x16x32_bf16 v[48:51], a[0:3], v[100:103], v[48:51]
buffer_load_dwordx4 v5, s[28:31], s54 offen lds
v_mfma_f32_16x16x32_bf16 v[36:39], a[4:7], v[96:99], v[36:39]
ds_read_b64_tr_b16 a[34:35], v7 offset:8960
ds_read_b64_tr_b16 a[36:37], v7 offset:8480
v_mfma_f32_16x16x32_bf16 v[52:55], a[4:7], v[100:103], v[52:55]
ds_read_b64_tr_b16 a[38:39], v7 offset:8992
v_mfma_f32_16x16x32_bf16 v[40:43], a[8:11], v[96:99], v[40:43]
buffer_load_dwordx4 v[144:147], v4, s[16:19], s52 offen sc1
v_mfma_f32_16x16x32_bf16 v[56:59], a[8:11], v[100:103], v[56:59]
ds_read_b64_tr_b16 a[40:41], v7 offset:8512
ds_read_b64_tr_b16 a[42:43], v7 offset:9024
v_mfma_f32_16x16x32_bf16 v[44:47], a[12:15], v[96:99], v[44:47]
ds_read_b64_tr_b16 a[44:45], v7 offset:8544
ds_read_b64_tr_b16 a[46:47], v7 offset:9056
v_mfma_f32_16x16x32_bf16 v[60:63], a[12:15], v[100:103], v[60:63]
s_waitcnt lgkmcnt(8)
v_mfma_f32_16x16x32_bf16 v[64:67], a[16:19], v[96:99], v[64:67]
buffer_load_dwordx4 v6, s[28:31], s54 offen offset:1056 lds
v_mfma_f32_16x16x32_bf16 v[80:83], a[16:19], v[100:103], v[80:83]
ds_read_b64_tr_b16 a[48:49], v10 offset:8448
s_add_u32 s54, s54, 0x10000
v_mfma_f32_16x16x32_bf16 v[68:71], a[20:23], v[96:99], v[68:71]
ds_read_b64_tr_b16 a[50:51], v10 offset:8960
ds_read_b64_tr_b16 a[52:53], v10 offset:8480
v_mfma_f32_16x16x32_bf16 v[84:87], a[20:23], v[100:103], v[84:87]
ds_read_b64_tr_b16 a[54:55], v10 offset:8992
v_mfma_f32_16x16x32_bf16 v[72:75], a[24:27], v[96:99], v[72:75]
buffer_load_dwordx4 v[148:151], v4, s[16:19], s52 offen offset:1024 sc1
v_mfma_f32_16x16x32_bf16 v[88:91], a[24:27], v[100:103], v[88:91]
ds_read_b64_tr_b16 a[56:57], v10 offset:8512
s_add_u32 s52, s52, 0x20000
v_mfma_f32_16x16x32_bf16 v[76:79], a[28:31], v[96:99], v[76:79]
ds_read_b64_tr_b16 a[58:59], v10 offset:9024
ds_read_b64_tr_b16 a[60:61], v10 offset:8544
v_mfma_f32_16x16x32_bf16 v[92:95], a[28:31], v[100:103], v[92:95]
ds_read_b64_tr_b16 a[62:63], v10 offset:9056
s_waitcnt vmcnt(12) lgkmcnt(8)
v_mfma_f32_16x16x32_bf16 v[32:35], a[32:35], v[104:107], v[32:35]
ds_read_b64_tr_b16 a[0:1], v7 offset:16896
s_add_u32 m0, s56, 59136
v_mfma_f32_16x16x32_bf16 v[48:51], a[32:35], v[108:111], v[48:51]
buffer_load_dwordx4 v5, s[28:31], s54 offen lds
v_mfma_f32_16x16x32_bf16 v[36:39], a[36:39], v[104:107], v[36:39]
ds_read_b64_tr_b16 a[2:3], v7 offset:17408
ds_read_b64_tr_b16 a[4:5], v7 offset:16928
v_mfma_f32_16x16x32_bf16 v[52:55], a[36:39], v[108:111], v[52:55]
ds_read_b64_tr_b16 a[6:7], v7 offset:17440
v_mfma_f32_16x16x32_bf16 v[40:43], a[40:43], v[104:107], v[40:43]
buffer_load_dwordx4 v[152:155], v4, s[16:19], s52 offen sc1
v_mfma_f32_16x16x32_bf16 v[56:59], a[40:43], v[108:111], v[56:59]
ds_read_b64_tr_b16 a[8:9], v7 offset:16960
ds_read_b64_tr_b16 a[10:11], v7 offset:17472
v_mfma_f32_16x16x32_bf16 v[44:47], a[44:47], v[104:107], v[44:47]
ds_read_b64_tr_b16 a[12:13], v7 offset:16992
ds_read_b64_tr_b16 a[14:15], v7 offset:17504
v_mfma_f32_16x16x32_bf16 v[60:63], a[44:47], v[108:111], v[60:63]
s_waitcnt lgkmcnt(8)
v_mfma_f32_16x16x32_bf16 v[64:67], a[48:51], v[104:107], v[64:67]
buffer_load_dwordx4 v6, s[28:31], s54 offen offset:1056 lds
v_mfma_f32_16x16x32_bf16 v[80:83], a[48:51], v[108:111], v[80:83]
ds_read_b64_tr_b16 a[16:17], v10 offset:16896
s_add_u32 s54, s54, 0x10000
v_mfma_f32_16x16x32_bf16 v[68:71], a[52:55], v[104:107], v[68:71]
ds_read_b64_tr_b16 a[18:19], v10 offset:17408
ds_read_b64_tr_b16 a[20:21], v10 offset:16928
v_mfma_f32_16x16x32_bf16 v[84:87], a[52:55], v[108:111], v[84:87]
ds_read_b64_tr_b16 a[22:23], v10 offset:17440
v_mfma_f32_16x16x32_bf16 v[72:75], a[56:59], v[104:107], v[72:75]
buffer_load_dwordx4 v[156:159], v4, s[16:19], s52 offen offset:1024 sc1
v_mfma_f32_16x16x32_bf16 v[88:91], a[56:59], v[108:111], v[88:91]
ds_read_b64_tr_b16 a[24:25], v10 offset:16960
s_add_u32 s52, s52, 0x20000
v_mfma_f32_16x16x32_bf16 v[76:79], a[60:63], v[104:107], v[76:79]
ds_read_b64_tr_b16 a[26:27], v10 offset:17472
ds_read_b64_tr_b16 a[28:29], v10 offset:16992
v_mfma_f32_16x16x32_bf16 v[92:95], a[60:63], v[108:111], v[92:95]
ds_read_b64_tr_b16 a[30:31], v10 offset:17504
s_waitcnt vmcnt(14) lgkmcnt(8)
s_barrier
v_mfma_f32_16x16x32_bf16 v[32:35], a[0:3], v[112:115], v[32:35]
ds_read_b64_tr_b16 a[32:33], v7 offset:25344
s_add_u32 m0, s55, 0
v_mfma_f32_16x16x32_bf16 v[48:51], a[0:3], v[116:119], v[48:51]
buffer_load_dwordx4 v5, s[28:31], s54 offen lds
v_mfma_f32_16x16x32_bf16 v[36:39], a[4:7], v[112:115], v[36:39]
ds_read_b64_tr_b16 a[34:35], v7 offset:25856
ds_read_b64_tr_b16 a[36:37], v7 offset:25376
v_mfma_f32_16x16x32_bf16 v[52:55], a[4:7], v[116:119], v[52:55]
ds_read_b64_tr_b16 a[38:39], v7 offset:25888
v_mfma_f32_16x16x32_bf16 v[40:43], a[8:11], v[112:115], v[40:43]
buffer_load_dwordx4 v[96:99], v4, s[16:19], s52 offen sc1
v_mfma_f32_16x16x32_bf16 v[56:59], a[8:11], v[116:119], v[56:59]
ds_read_b64_tr_b16 a[40:41], v7 offset:25408
ds_read_b64_tr_b16 a[42:43], v7 offset:25920
v_mfma_f32_16x16x32_bf16 v[44:47], a[12:15], v[112:115], v[44:47]
ds_read_b64_tr_b16 a[44:45], v7 offset:25440
ds_read_b64_tr_b16 a[46:47], v7 offset:25952
v_mfma_f32_16x16x32_bf16 v[60:63], a[12:15], v[116:119], v[60:63]
s_waitcnt lgkmcnt(8)
v_mfma_f32_16x16x32_bf16 v[64:67], a[16:19], v[112:115], v[64:67]
buffer_load_dwordx4 v6, s[28:31], s54 offen offset:1056 lds
v_mfma_f32_16x16x32_bf16 v[80:83], a[16:19], v[116:119], v[80:83]
ds_read_b64_tr_b16 a[48:49], v10 offset:25344
s_add_u32 s54, s54, 0x10000
v_mfma_f32_16x16x32_bf16 v[68:71], a[20:23], v[112:115], v[68:71]
ds_read_b64_tr_b16 a[50:51], v10 offset:25856
ds_read_b64_tr_b16 a[52:53], v10 offset:25376
v_mfma_f32_16x16x32_bf16 v[84:87], a[20:23], v[116:119], v[84:87]
ds_read_b64_tr_b16 a[54:55], v10 offset:25888
v_mfma_f32_16x16x32_bf16 v[72:75], a[24:27], v[112:115], v[72:75]
buffer_load_dwordx4 v[100:103], v4, s[16:19], s52 offen offset:1024 sc1
v_mfma_f32_16x16x32_bf16 v[88:91], a[24:27], v[116:119], v[88:91]
ds_read_b64_tr_b16 a[56:57], v10 offset:25408
s_add_u32 s52, s52, 0x20000
v_mfma_f32_16x16x32_bf16 v[76:79], a[28:31], v[112:115], v[76:79]
ds_read_b64_tr_b16 a[58:59], v10 offset:25920
ds_read_b64_tr_b16 a[60:61], v10 offset:25440
v_mfma_f32_16x16x32_bf16 v[92:95], a[28:31], v[116:119], v[92:95]
ds_read_b64_tr_b16 a[62:63], v10 offset:25952
s_waitcnt vmcnt(16) lgkmcnt(8)
v_mfma_f32_16x16x32_bf16 v[32:35], a[32:35], v[120:123], v[32:35]
ds_read_b64_tr_b16 a[0:1], v7 offset:33792
s_add_u32 m0, s55, 8448
v_mfma_f32_16x16x32_bf16 v[48:51], a[32:35], v[124:127], v[48:51]
buffer_load_dwordx4 v5, s[28:31], s54 offen lds
v_mfma_f32_16x16x32_bf16 v[36:39], a[36:39], v[120:123], v[36:39]
ds_read_b64_tr_b16 a[2:3], v7 offset:34304
ds_read_b64_tr_b16 a[4:5], v7 offset:33824
v_mfma_f32_16x16x32_bf16 v[52:55], a[36:39], v[124:127], v[52:55]
ds_read_b64_tr_b16 a[6:7], v7 offset:34336
ds_read_b64_tr_b16 a[8:9], v7 offset:33856
v_mfma_f32_16x16x32_bf16 v[40:43], a[40:43], v[120:123], v[40:43]
buffer_load_dwordx4 v[104:107], v4, s[16:19], s52 offen sc1
v_mfma_f32_16x16x32_bf16 v[56:59], a[40:43], v[124:127], v[56:59]
ds_read_b64_tr_b16 a[10:11], v7 offset:34368
ds_read_b64_tr_b16 a[12:13], v7 offset:33888
v_mfma_f32_16x16x32_bf16 v[44:47], a[44:47], v[120:123], v[44:47]
ds_read_b64_tr_b16 a[14:15], v7 offset:34400
ds_read_b64_tr_b16 a[16:17], v10 offset:33792
v_mfma_f32_16x16x32_bf16 v[60:63], a[44:47], v[124:127], v[60:63]
ds_read_b64_tr_b16 a[18:19], v10 offset:34304
s_waitcnt lgkmcnt(10)
v_mfma_f32_16x16x32_bf16 v[64:67], a[48:51], v[120:123], v[64:67]
buffer_load_dwordx4 v6, s[28:31], s54 offen offset:1056 lds
v_mfma_f32_16x16x32_bf16 v[80:83], a[48:51], v[124:127], v[80:83]
ds_read_b64_tr_b16 a[20:21], v10 offset:33824
s_add_u32 s54, s54, 0x10000
v_mfma_f32_16x16x32_bf16 v[68:71], a[52:55], v[120:123], v[68:71]
buffer_load_dwordx4 v[108:111], v4, s[16:19], s52 offen offset:1024 sc1
v_mfma_f32_16x16x32_bf16 v[84:87], a[52:55], v[124:127], v[84:87]
ds_read_b64_tr_b16 a[22:23], v10 offset:34336
s_add_u32 s52, s52, 0x20000
v_mfma_f32_16x16x32_bf16 v[72:75], a[56:59], v[120:123], v[72:75]
ds_read_b64_tr_b16 a[24:25], v10 offset:33856
ds_read_b64_tr_b16 a[26:27], v10 offset:34368
v_mfma_f32_16x16x32_bf16 v[88:91], a[56:59], v[124:127], v[88:91]
buffer_load_dword v27, v9, s[28:31], s44 offen
v_mfma_f32_16x16x32_bf16 v[76:79], a[60:63], v[120:123], v[76:79]
ds_read_b64_tr_b16 a[28:29], v10 offset:33888
s_add_u32 s44, s44, 0x80000
v_mfma_f32_16x16x32_bf16 v[92:95], a[60:63], v[124:127], v[92:95]
ds_read_b64_tr_b16 a[30:31], v10 offset:34400
s_waitcnt vmcnt(19) lgkmcnt(8)
s_barrier
v_mfma_f32_16x16x32_bf16 v[32:35], a[0:3], v[128:131], v[32:35]
ds_read_b64_tr_b16 a[32:33], v7 offset:42240
s_add_u32 m0, s55, 16896
v_mfma_f32_16x16x32_bf16 v[48:51], a[0:3], v[132:135], v[48:51]
buffer_load_dwordx4 v5, s[28:31], s54 offen lds
v_mfma_f32_16x16x32_bf16 v[36:39], a[4:7], v[128:131], v[36:39]
ds_read_b64_tr_b16 a[34:35], v7 offset:42752
ds_read_b64_tr_b16 a[36:37], v7 offset:42272
v_mfma_f32_16x16x32_bf16 v[52:55], a[4:7], v[132:135], v[52:55]
ds_read_b64_tr_b16 a[38:39], v7 offset:42784
v_mfma_f32_16x16x32_bf16 v[40:43], a[8:11], v[128:131], v[40:43]
buffer_load_dwordx4 v[112:115], v4, s[16:19], s52 offen sc1
v_mfma_f32_16x16x32_bf16 v[56:59], a[8:11], v[132:135], v[56:59]
ds_read_b64_tr_b16 a[40:41], v7 offset:42304
ds_read_b64_tr_b16 a[42:43], v7 offset:42816
v_mfma_f32_16x16x32_bf16 v[44:47], a[12:15], v[128:131], v[44:47]
ds_read_b64_tr_b16 a[44:45], v7 offset:42336
ds_read_b64_tr_b16 a[46:47], v7 offset:42848
v_mfma_f32_16x16x32_bf16 v[60:63], a[12:15], v[132:135], v[60:63]
s_waitcnt lgkmcnt(8)
v_mfma_f32_16x16x32_bf16 v[64:67], a[16:19], v[128:131], v[64:67]
buffer_load_dwordx4 v6, s[28:31], s54 offen offset:1056 lds
v_mfma_f32_16x16x32_bf16 v[80:83], a[16:19], v[132:135], v[80:83]
ds_read_b64_tr_b16 a[48:49], v10 offset:42240
s_add_u32 s54, s54, 0x10000
v_mfma_f32_16x16x32_bf16 v[68:71], a[20:23], v[128:131], v[68:71]
ds_read_b64_tr_b16 a[50:51], v10 offset:42752
ds_read_b64_tr_b16 a[52:53], v10 offset:42272
v_mfma_f32_16x16x32_bf16 v[84:87], a[20:23], v[132:135], v[84:87]
ds_read_b64_tr_b16 a[54:55], v10 offset:42784
v_mfma_f32_16x16x32_bf16 v[72:75], a[24:27], v[128:131], v[72:75]
buffer_load_dwordx4 v[116:119], v4, s[16:19], s52 offen offset:1024 sc1
v_mfma_f32_16x16x32_bf16 v[88:91], a[24:27], v[132:135], v[88:91]
ds_read_b64_tr_b16 a[56:57], v10 offset:42304
s_add_u32 s52, s52, 0x20000
v_mfma_f32_16x16x32_bf16 v[76:79], a[28:31], v[128:131], v[76:79]
ds_read_b64_tr_b16 a[58:59], v10 offset:42816
ds_read_b64_tr_b16 a[60:61], v10 offset:42336
v_mfma_f32_16x16x32_bf16 v[92:95], a[28:31], v[132:135], v[92:95]
ds_read_b64_tr_b16 a[62:63], v10 offset:42848
s_waitcnt vmcnt(21) lgkmcnt(8)
v_mfma_f32_16x16x32_bf16 v[32:35], a[32:35], v[136:139], v[32:35]
ds_read_b64_tr_b16 a[0:1], v7 offset:50688
s_add_u32 m0, s55, 25344
v_mfma_f32_16x16x32_bf16 v[48:51], a[32:35], v[140:143], v[48:51]
buffer_load_dwordx4 v5, s[28:31], s54 offen lds
v_mfma_f32_16x16x32_bf16 v[36:39], a[36:39], v[136:139], v[36:39]
ds_read_b64_tr_b16 a[2:3], v7 offset:51200
ds_read_b64_tr_b16 a[4:5], v7 offset:50720
v_mfma_f32_16x16x32_bf16 v[52:55], a[36:39], v[140:143], v[52:55]
ds_read_b64_tr_b16 a[6:7], v7 offset:51232
v_mfma_f32_16x16x32_bf16 v[40:43], a[40:43], v[136:139], v[40:43]
buffer_load_dwordx4 v[120:123], v4, s[16:19], s52 offen sc1
v_mfma_f32_16x16x32_bf16 v[56:59], a[40:43], v[140:143], v[56:59]
ds_read_b64_tr_b16 a[8:9], v7 offset:50752
ds_read_b64_tr_b16 a[10:11], v7 offset:51264
v_mfma_f32_16x16x32_bf16 v[44:47], a[44:47], v[136:139], v[44:47]
ds_read_b64_tr_b16 a[12:13], v7 offset:50784
ds_read_b64_tr_b16 a[14:15], v7 offset:51296
v_mfma_f32_16x16x32_bf16 v[60:63], a[44:47], v[140:143], v[60:63]
s_waitcnt lgkmcnt(8)
v_mfma_f32_16x16x32_bf16 v[64:67], a[48:51], v[136:139], v[64:67]
buffer_load_dwordx4 v6, s[28:31], s54 offen offset:1056 lds
v_mfma_f32_16x16x32_bf16 v[80:83], a[48:51], v[140:143], v[80:83]
ds_read_b64_tr_b16 a[16:17], v10 offset:50688
s_add_u32 s54, s54, 0x10000
v_mfma_f32_16x16x32_bf16 v[68:71], a[52:55], v[136:139], v[68:71]
ds_read_b64_tr_b16 a[18:19], v10 offset:51200
ds_read_b64_tr_b16 a[20:21], v10 offset:50720
v_mfma_f32_16x16x32_bf16 v[84:87], a[52:55], v[140:143], v[84:87]
ds_read_b64_tr_b16 a[22:23], v10 offset:51232
v_mfma_f32_16x16x32_bf16 v[72:75], a[56:59], v[136:139], v[72:75]
buffer_load_dwordx4 v[124:127], v4, s[16:19], s52 offen offset:1024 sc1
v_mfma_f32_16x16x32_bf16 v[88:91], a[56:59], v[140:143], v[88:91]
ds_read_b64_tr_b16 a[24:25], v10 offset:50752
s_add_u32 s52, s52, 0x20000
v_mfma_f32_16x16x32_bf16 v[76:79], a[60:63], v[136:139], v[76:79]
ds_read_b64_tr_b16 a[26:27], v10 offset:51264
ds_read_b64_tr_b16 a[28:29], v10 offset:50784
v_mfma_f32_16x16x32_bf16 v[92:95], a[60:63], v[140:143], v[92:95]
ds_read_b64_tr_b16 a[30:31], v10 offset:51296
s_waitcnt vmcnt(21) lgkmcnt(8)
s_barrier
v_mfma_f32_16x16x32_bf16 v[32:35], a[0:3], v[144:147], v[32:35]
ds_read_b64_tr_b16 a[32:33], v7 offset:59136
s_add_u32 m0, s55, 33792
v_mfma_f32_16x16x32_bf16 v[48:51], a[0:3], v[148:151], v[48:51]
buffer_load_dwordx4 v5, s[28:31], s54 offen lds
v_mfma_f32_16x16x32_bf16 v[36:39], a[4:7], v[144:147], v[36:39]
ds_read_b64_tr_b16 a[34:35], v7 offset:59648
ds_read_b64_tr_b16 a[36:37], v7 offset:59168
v_mfma_f32_16x16x32_bf16 v[52:55], a[4:7], v[148:151], v[52:55]
ds_read_b64_tr_b16 a[38:39], v7 offset:59680
v_mfma_f32_16x16x32_bf16 v[40:43], a[8:11], v[144:147], v[40:43]
buffer_load_dwordx4 v[128:131], v4, s[16:19], s52 offen sc1
v_mfma_f32_16x16x32_bf16 v[56:59], a[8:11], v[148:151], v[56:59]
ds_read_b64_tr_b16 a[40:41], v7 offset:59200
ds_read_b64_tr_b16 a[42:43], v7 offset:59712
v_mfma_f32_16x16x32_bf16 v[44:47], a[12:15], v[144:147], v[44:47]
ds_read_b64_tr_b16 a[44:45], v7 offset:59232
ds_read_b64_tr_b16 a[46:47], v7 offset:59744
v_mfma_f32_16x16x32_bf16 v[60:63], a[12:15], v[148:151], v[60:63]
s_waitcnt lgkmcnt(8)
v_mfma_f32_16x16x32_bf16 v[64:67], a[16:19], v[144:147], v[64:67]
buffer_load_dwordx4 v6, s[28:31], s54 offen offset:1056 lds
v_mfma_f32_16x16x32_bf16 v[80:83], a[16:19], v[148:151], v[80:83]
ds_read_b64_tr_b16 a[48:49], v10 offset:59136
s_add_u32 s54, s54, 0x10000
v_mfma_f32_16x16x32_bf16 v[68:71], a[20:23], v[144:147], v[68:71]
ds_read_b64_tr_b16 a[50:51], v10 offset:59648
ds_read_b64_tr_b16 a[52:53], v10 offset:59168
v_mfma_f32_16x16x32_bf16 v[84:87], a[20:23], v[148:151], v[84:87]
ds_read_b64_tr_b16 a[54:55], v10 offset:59680
v_mfma_f32_16x16x32_bf16 v[72:75], a[24:27], v[144:147], v[72:75]
buffer_load_dwordx4 v[132:135], v4, s[16:19], s52 offen offset:1024 sc1
v_mfma_f32_16x16x32_bf16 v[88:91], a[24:27], v[148:151], v[88:91]
ds_read_b64_tr_b16 a[56:57], v10 offset:59200
s_add_u32 s52, s52, 0x20000
v_mfma_f32_16x16x32_bf16 v[76:79], a[28:31], v[144:147], v[76:79]
ds_read_b64_tr_b16 a[58:59], v10 offset:59712
ds_read_b64_tr_b16 a[60:61], v10 offset:59232
v_mfma_f32_16x16x32_bf16 v[92:95], a[28:31], v[148:151], v[92:95]
ds_read_b64_tr_b16 a[62:63], v10 offset:59744
v_add_u32 v7, s57, v7
v_add_u32 v10, s57, v10
s_sub_u32 s57, 0, s57
s_waitcnt vmcnt(21) lgkmcnt(8)
v_mfma_f32_16x16x32_bf16 v[32:35], a[32:35], v[152:155], v[32:35]
ds_read_b64_tr_b16 a[0:1], v7
s_add_u32 m0, s55, 42240
v_mfma_f32_16x16x32_bf16 v[48:51], a[32:35], v[156:159], v[48:51]
buffer_load_dwordx4 v5, s[28:31], s54 offen lds
v_mfma_f32_16x16x32_bf16 v[36:39], a[36:39], v[152:155], v[36:39]
ds_read_b64_tr_b16 a[2:3], v7 offset:512
ds_read_b64_tr_b16 a[4:5], v7 offset:32
v_mfma_f32_16x16x32_bf16 v[52:55], a[36:39], v[156:159], v[52:55]
ds_read_b64_tr_b16 a[6:7], v7 offset:544
v_mfma_f32_16x16x32_bf16 v[40:43], a[40:43], v[152:155], v[40:43]
buffer_load_dwordx4 v[136:139], v4, s[16:19], s52 offen sc1
v_mfma_f32_16x16x32_bf16 v[56:59], a[40:43], v[156:159], v[56:59]
ds_read_b64_tr_b16 a[8:9], v7 offset:64
ds_read_b64_tr_b16 a[10:11], v7 offset:576
v_mfma_f32_16x16x32_bf16 v[44:47], a[44:47], v[152:155], v[44:47]
ds_read_b64_tr_b16 a[12:13], v7 offset:96
ds_read_b64_tr_b16 a[14:15], v7 offset:608
v_mfma_f32_16x16x32_bf16 v[60:63], a[44:47], v[156:159], v[60:63]
s_waitcnt lgkmcnt(8)
v_mfma_f32_16x16x32_bf16 v[64:67], a[48:51], v[152:155], v[64:67]
buffer_load_dwordx4 v6, s[28:31], s54 offen offset:1056 lds
v_mfma_f32_16x16x32_bf16 v[80:83], a[48:51], v[156:159], v[80:83]
ds_read_b64_tr_b16 a[16:17], v10
s_add_u32 s54, s54, 0x10000
v_mfma_f32_16x16x32_bf16 v[68:71], a[52:55], v[152:155], v[68:71]
ds_read_b64_tr_b16 a[18:19], v10 offset:512
ds_read_b64_tr_b16 a[20:21], v10 offset:32
v_mfma_f32_16x16x32_bf16 v[84:87], a[52:55], v[156:159], v[84:87]
ds_read_b64_tr_b16 a[22:23], v10 offset:544
v_mfma_f32_16x16x32_bf16 v[72:75], a[56:59], v[152:155], v[72:75]
buffer_load_dwordx4 v[140:143], v4, s[16:19], s52 offen offset:1024 sc1
v_mfma_f32_16x16x32_bf16 v[88:91], a[56:59], v[156:159], v[88:91]
ds_read_b64_tr_b16 a[24:25], v10 offset:64
s_add_u32 s52, s52, 0x20000
v_mfma_f32_16x16x32_bf16 v[76:79], a[60:63], v[152:155], v[76:79]
ds_read_b64_tr_b16 a[26:27], v10 offset:576
ds_read_b64_tr_b16 a[28:29], v10 offset:96
v_mfma_f32_16x16x32_bf16 v[92:95], a[60:63], v[156:159], v[92:95]
ds_read_b64_tr_b16 a[30:31], v10 offset:608
s_mov_b32 s62, s55
s_mov_b32 s55, s56
s_mov_b32 s56, s62
s_add_u32 s15, s15, 1
s_cbranch_scc0 .Lk68
s_waitcnt vmcnt(21) lgkmcnt(8)
s_barrier
v_mfma_f32_16x16x32_bf16 v[32:35], a[0:3], v[96:99], v[32:35]
ds_read_b64_tr_b16 a[32:33], v7 offset:8448
s_add_u32 m0, s56, 50688
v_mfma_f32_16x16x32_bf16 v[48:51], a[0:3], v[100:103], v[48:51]
buffer_load_dwordx4 v5, s[28:31], s54 offen lds
v_mfma_f32_16x16x32_bf16 v[36:39], a[4:7], v[96:99], v[36:39]
ds_read_b64_tr_b16 a[34:35], v7 offset:8960
ds_read_b64_tr_b16 a[36:37], v7 offset:8480
v_mfma_f32_16x16x32_bf16 v[52:55], a[4:7], v[100:103], v[52:55]
ds_read_b64_tr_b16 a[38:39], v7 offset:8992
v_mfma_f32_16x16x32_bf16 v[40:43], a[8:11], v[96:99], v[40:43]
buffer_load_dwordx4 v[144:147], v4, s[16:19], s52 offen sc1
v_mfma_f32_16x16x32_bf16 v[56:59], a[8:11], v[100:103], v[56:59]
ds_read_b64_tr_b16 a[40:41], v7 offset:8512
ds_read_b64_tr_b16 a[42:43], v7 offset:9024
v_mfma_f32_16x16x32_bf16 v[44:47], a[12:15], v[96:99], v[44:47]
ds_read_b64_tr_b16 a[44:45], v7 offset:8544
ds_read_b64_tr_b16 a[46:47], v7 offset:9056
v_mfma_f32_16x16x32_bf16 v[60:63], a[12:15], v[100:103], v[60:63]
s_waitcnt lgkmcnt(8)
v_mfma_f32_16x16x32_bf16 v[64:67], a[16:19], v[96:99], v[64:67]
buffer_load_dwordx4 v6, s[28:31], s54 offen offset:1056 lds
v_mfma_f32_16x16x32_bf16 v[80:83], a[16:19], v[100:103], v[80:83]
ds_read_b64_tr_b16 a[48:49], v10 offset:8448
s_add_u32 s54, s54, 0x10000
v_mfma_f32_16x16x32_bf16 v[68:71], a[20:23], v[96:99], v[68:71]
ds_read_b64_tr_b16 a[50:51], v10 offset:8960
ds_read_b64_tr_b16 a[52:53], v10 offset:8480
v_mfma_f32_16x16x32_bf16 v[84:87], a[20:23], v[100:103], v[84:87]
ds_read_b64_tr_b16 a[54:55], v10 offset:8992
v_mfma_f32_16x16x32_bf16 v[72:75], a[24:27], v[96:99], v[72:75]
buffer_load_dwordx4 v[148:151], v4, s[16:19], s52 offen offset:1024 sc1
v_mfma_f32_16x16x32_bf16 v[88:91], a[24:27], v[100:103], v[88:91]
ds_read_b64_tr_b16 a[56:57], v10 offset:8512
s_add_u32 s52, s52, 0x20000
v_mfma_f32_16x16x32_bf16 v[76:79], a[28:31], v[96:99], v[76:79]
ds_read_b64_tr_b16 a[58:59], v10 offset:9024
ds_read_b64_tr_b16 a[60:61], v10 offset:8544
v_mfma_f32_16x16x32_bf16 v[92:95], a[28:31], v[100:103], v[92:95]
ds_read_b64_tr_b16 a[62:63], v10 offset:9056
s_waitcnt vmcnt(21) lgkmcnt(8)
v_mfma_f32_16x16x32_bf16 v[32:35], a[32:35], v[104:107], v[32:35]
ds_read_b64_tr_b16 a[0:1], v7 offset:16896
s_add_u32 m0, s56, 59136
v_mfma_f32_16x16x32_bf16 v[48:51], a[32:35], v[108:111], v[48:51]
buffer_load_dwordx4 v5, s[28:31], s54 offen lds
v_mfma_f32_16x16x32_bf16 v[36:39], a[36:39], v[104:107], v[36:39]
ds_read_b64_tr_b16 a[2:3], v7 offset:17408
ds_read_b64_tr_b16 a[4:5], v7 offset:16928
v_mfma_f32_16x16x32_bf16 v[52:55], a[36:39], v[108:111], v[52:55]
ds_read_b64_tr_b16 a[6:7], v7 offset:17440
v_mfma_f32_16x16x32_bf16 v[40:43], a[40:43], v[104:107], v[40:43]
buffer_load_dwordx4 v[152:155], v4, s[16:19], s52 offen sc1
v_mfma_f32_16x16x32_bf16 v[56:59], a[40:43], v[108:111], v[56:59]
ds_read_b64_tr_b16 a[8:9], v7 offset:16960
ds_read_b64_tr_b16 a[10:11], v7 offset:17472
v_mfma_f32_16x16x32_bf16 v[44:47], a[44:47], v[104:107], v[44:47]
ds_read_b64_tr_b16 a[12:13], v7 offset:16992
ds_read_b64_tr_b16 a[14:15], v7 offset:17504
v_mfma_f32_16x16x32_bf16 v[60:63], a[44:47], v[108:111], v[60:63]
s_waitcnt lgkmcnt(8)
v_mfma_f32_16x16x32_bf16 v[64:67], a[48:51], v[104:107], v[64:67]
buffer_load_dwordx4 v6, s[28:31], s54 offen offset:1056 lds
v_mfma_f32_16x16x32_bf16 v[80:83], a[48:51], v[108:111], v[80:83]
ds_read_b64_tr_b16 a[16:17], v10 offset:16896
s_add_u32 s54, s54, 0x10000
v_mfma_f32_16x16x32_bf16 v[68:71], a[52:55], v[104:107], v[68:71]
ds_read_b64_tr_b16 a[18:19], v10 offset:17408
ds_read_b64_tr_b16 a[20:21], v10 offset:16928
v_mfma_f32_16x16x32_bf16 v[84:87], a[52:55], v[108:111], v[84:87]
ds_read_b64_tr_b16 a[22:23], v10 offset:17440
v_mfma_f32_16x16x32_bf16 v[72:75], a[56:59], v[104:107], v[72:75]
buffer_load_dwordx4 v[156:159], v4, s[16:19], s52 offen offset:1024 sc1
v_mfma_f32_16x16x32_bf16 v[88:91], a[56:59], v[108:111], v[88:91]
ds_read_b64_tr_b16 a[24:25], v10 offset:16960
s_add_u32 s52, s52, 0x20000
v_mfma_f32_16x16x32_bf16 v[76:79], a[60:63], v[104:107], v[76:79]
ds_read_b64_tr_b16 a[26:27], v10 offset:17472
ds_read_b64_tr_b16 a[28:29], v10 offset:16992
v_mfma_f32_16x16x32_bf16 v[92:95], a[60:63], v[108:111], v[92:95]
ds_read_b64_tr_b16 a[30:31], v10 offset:17504
s_waitcnt vmcnt(20) lgkmcnt(8)
s_barrier
v_mfma_f32_16x16x32_bf16 v[32:35], a[0:3], v[112:115], v[32:35]
ds_read_b64_tr_b16 a[32:33], v7 offset:25344
s_add_u32 m0, s55, 0
v_mfma_f32_16x16x32_bf16 v[48:51], a[0:3], v[116:119], v[48:51]
buffer_load_dwordx4 v5, s[28:31], s54 offen lds
v_mfma_f32_16x16x32_bf16 v[36:39], a[4:7], v[112:115], v[36:39]
ds_read_b64_tr_b16 a[34:35], v7 offset:25856
ds_read_b64_tr_b16 a[36:37], v7 offset:25376
v_mfma_f32_16x16x32_bf16 v[52:55], a[4:7], v[116:119], v[52:55]
ds_read_b64_tr_b16 a[38:39], v7 offset:25888
v_mfma_f32_16x16x32_bf16 v[40:43], a[8:11], v[112:115], v[40:43]
buffer_load_dwordx4 v[96:99], v4, s[16:19], s52 offen sc1
v_mfma_f32_16x16x32_bf16 v[56:59], a[8:11], v[116:119], v[56:59]
ds_read_b64_tr_b16 a[40:41], v7 offset:25408
ds_read_b64_tr_b16 a[42:43], v7 offset:25920
v_mfma_f32_16x16x32_bf16 v[44:47], a[12:15], v[112:115], v[44:47]
ds_read_b64_tr_b16 a[44:45], v7 offset:25440
ds_read_b64_tr_b16 a[46:47], v7 offset:25952
v_mfma_f32_16x16x32_bf16 v[60:63], a[12:15], v[116:119], v[60:63]
s_waitcnt lgkmcnt(8)
v_mfma_f32_16x16x32_bf16 v[64:67], a[16:19], v[112:115], v[64:67]
buffer_load_dwordx4 v6, s[28:31], s54 offen offset:1056 lds
v_mfma_f32_16x16x32_bf16 v[80:83], a[16:19], v[116:119], v[80:83]
ds_read_b64_tr_b16 a[48:49], v10 offset:25344
s_add_u32 s54, s54, 0x10000
v_mfma_f32_16x16x32_bf16 v[68:71], a[20:23], v[112:115], v[68:71]
ds_read_b64_tr_b16 a[50:51], v10 offset:25856
ds_read_b64_tr_b16 a[52:53], v10 offset:25376
v_mfma_f32_16x16x32_bf16 v[84:87], a[20:23], v[116:119], v[84:87]
ds_read_b64_tr_b16 a[54:55], v10 offset:25888
v_mfma_f32_16x16x32_bf16 v[72:75], a[24:27], v[112:115], v[72:75]
buffer_load_dwordx4 v[100:103], v4, s[16:19], s52 offen offset:1024 sc1
v_mfma_f32_16x16x32_bf16 v[88:91], a[24:27], v[116:119], v[88:91]
ds_read_b64_tr_b16 a[56:57], v10 offset:25408
s_add_u32 s52, s52, 0x20000
v_mfma_f32_16x16x32_bf16 v[76:79], a[28:31], v[112:115], v[76:79]
ds_read_b64_tr_b16 a[58:59], v10 offset:25920
ds_read_b64_tr_b16 a[60:61], v10 offset:25440
v_mfma_f32_16x16x32_bf16 v[92:95], a[28:31], v[116:119], v[92:95]
ds_read_b64_tr_b16 a[62:63], v10 offset:25952
s_waitcnt vmcnt(20) lgkmcnt(8)
v_mfma_f32_16x16x32_bf16 v[32:35], a[32:35], v[120:123], v[32:35]
ds_read_b64_tr_b16 a[0:1], v7 offset:33792
s_add_u32 m0, s55, 8448
v_mfma_f32_16x16x32_bf16 v[48:51], a[32:35], v[124:127], v[48:51]
buffer_load_dwordx4 v5, s[28:31], s54 offen lds
v_mfma_f32_16x16x32_bf16 v[36:39], a[36:39], v[120:123], v[36:39]
ds_read_b64_tr_b16 a[2:3], v7 offset:34304
ds_read_b64_tr_b16 a[4:5], v7 offset:33824
v_mfma_f32_16x16x32_bf16 v[52:55], a[36:39], v[124:127], v[52:55]
ds_read_b64_tr_b16 a[6:7], v7 offset:34336
ds_read_b64_tr_b16 a[8:9], v7 offset:33856
v_mfma_f32_16x16x32_bf16 v[40:43], a[40:43], v[120:123], v[40:43]
buffer_load_dwordx4 v[104:107], v4, s[16:19], s52 offen sc1
v_mfma_f32_16x16x32_bf16 v[56:59], a[40:43], v[124:127], v[56:59]
ds_read_b64_tr_b16 a[10:11], v7 offset:34368
ds_read_b64_tr_b16 a[12:13], v7 offset:33888
v_mfma_f32_16x16x32_bf16 v[44:47], a[44:47], v[120:123], v[44:47]
ds_read_b64_tr_b16 a[14:15], v7 offset:34400
ds_read_b64_tr_b16 a[16:17], v10 offset:33792
v_mfma_f32_16x16x32_bf16 v[60:63], a[44:47], v[124:127], v[60:63]
ds_read_b64_tr_b16 a[18:19], v10 offset:34304
s_waitcnt lgkmcnt(10)
v_mfma_f32_16x16x32_bf16 v[64:67], a[48:51], v[120:123], v[64:67]
buffer_load_dwordx4 v6, s[28:31], s54 offen offset:1056 lds
v_mfma_f32_16x16x32_bf16 v[80:83], a[48:51], v[124:127], v[80:83]
ds_read_b64_tr_b16 a[20:21], v10 offset:33824
s_add_u32 s54, s54, 0x10000
v_mfma_f32_16x16x32_bf16 v[68:71], a[52:55], v[120:123], v[68:71]
buffer_load_dwordx4 v[108:111], v4, s[16:19], s52 offen offset:1024 sc1
v_mfma_f32_16x16x32_bf16 v[84:87], a[52:55], v[124:127], v[84:87]
ds_read_b64_tr_b16 a[22:23], v10 offset:34336
s_add_u32 s52, s52, 0x20000
v_mfma_f32_16x16x32_bf16 v[72:75], a[56:59], v[120:123], v[72:75]
ds_read_b64_tr_b16 a[24:25], v10 offset:33856
ds_read_b64_tr_b16 a[26:27], v10 offset:34368
v_mfma_f32_16x16x32_bf16 v[88:91], a[56:59], v[124:127], v[88:91]
buffer_load_dword v27, v9, s[28:31], s44 offen
v_mfma_f32_16x16x32_bf16 v[76:79], a[60:63], v[120:123], v[76:79]
ds_read_b64_tr_b16 a[28:29], v10 offset:33888
s_add_u32 s44, s44, 0x80000
v_mfma_f32_16x16x32_bf16 v[92:95], a[60:63], v[124:127], v[92:95]
ds_read_b64_tr_b16 a[30:31], v10 offset:34400
s_waitcnt vmcnt(21) lgkmcnt(8)
s_barrier
v_mfma_f32_16x16x32_bf16 v[32:35], a[0:3], v[128:131], v[32:35]
ds_read_b64_tr_b16 a[32:33], v7 offset:42240
s_add_u32 m0, s55, 16896
v_mfma_f32_16x16x32_bf16 v[48:51], a[0:3], v[132:135], v[48:51]
buffer_load_dwordx4 v5, s[28:31], s54 offen lds
v_mfma_f32_16x16x32_bf16 v[36:39], a[4:7], v[128:131], v[36:39]
ds_read_b64_tr_b16 a[34:35], v7 offset:42752
ds_read_b64_tr_b16 a[36:37], v7 offset:42272
v_mfma_f32_16x16x32_bf16 v[52:55], a[4:7], v[132:135], v[52:55]
ds_read_b64_tr_b16 a[38:39], v7 offset:42784
v_mfma_f32_16x16x32_bf16 v[40:43], a[8:11], v[128:131], v[40:43]
buffer_load_dwordx4 v[112:115], v4, s[16:19], s52 offen sc1
v_mfma_f32_16x16x32_bf16 v[56:59], a[8:11], v[132:135], v[56:59]
ds_read_b64_tr_b16 a[40:41], v7 offset:42304
ds_read_b64_tr_b16 a[42:43], v7 offset:42816
v_mfma_f32_16x16x32_bf16 v[44:47], a[12:15], v[128:131], v[44:47]
ds_read_b64_tr_b16 a[44:45], v7 offset:42336
ds_read_b64_tr_b16 a[46:47], v7 offset:42848
v_mfma_f32_16x16x32_bf16 v[60:63], a[12:15], v[132:135], v[60:63]
s_waitcnt lgkmcnt(8)
v_mfma_f32_16x16x32_bf16 v[64:67], a[16:19], v[128:131], v[64:67]
.Lpad33:
s_cbranch_execz .Lnopoll66r
buffer_load_dwordx4 v6, s[28:31], s54 offen offset:1056 lds
v_mfma_f32_16x16x32_bf16 v[80:83], a[16:19], v[132:135], v[80:83]
ds_read_b64_tr_b16 a[48:49], v10 offset:42240
s_add_u32 s54, s54, 0x10000
v_mfma_f32_16x16x32_bf16 v[68:71], a[20:23], v[128:131], v[68:71]
ds_read_b64_tr_b16 a[50:51], v10 offset:42752
ds_read_b64_tr_b16 a[52:53], v10 offset:42272
v_mfma_f32_16x16x32_bf16 v[84:87], a[20:23], v[132:135], v[84:87]
ds_read_b64_tr_b16 a[54:55], v10 offset:42784
v_mfma_f32_16x16x32_bf16 v[72:75], a[24:27], v[128:131], v[72:75]
buffer_load_dwordx4 v[116:119], v4, s[16:19], s52 offen offset:1024 sc1
v_mfma_f32_16x16x32_bf16 v[88:91], a[24:27], v[132:135], v[88:91]
ds_read_b64_tr_b16 a[56:57], v10 offset:42304
s_add_u32 s52, s52, 0x20000
v_mfma_f32_16x16x32_bf16 v[76:79], a[28:31], v[128:131], v[76:79]
ds_read_b64_tr_b16 a[58:59], v10 offset:42816
ds_read_b64_tr_b16 a[60:61], v10 offset:42336
v_mfma_f32_16x16x32_bf16 v[92:95], a[28:31], v[132:135], v[92:95]
ds_read_b64_tr_b16 a[62:63], v10 offset:42848
s_waitcnt vmcnt(21) lgkmcnt(8)
v_mfma_f32_16x16x32_bf16 v[32:35], a[32:35], v[136:139], v[32:35]
ds_read_b64_tr_b16 a[0:1], v7 offset:50688
s_add_u32 m0, s55, 25344
v_mfma_f32_16x16x32_bf16 v[48:51], a[32:35], v[140:143], v[48:51]
buffer_load_dwordx4 v5, s[28:31], s54 offen lds
v_mfma_f32_16x16x32_bf16 v[36:39], a[36:39], v[136:139], v[36:39]
ds_read_b64_tr_b16 a[2:3], v7 offset:51200
ds_read_b64_tr_b16 a[4:5], v7 offset:50720
v_mfma_f32_16x16x32_bf16 v[52:55], a[36:39], v[140:143], v[52:55]
ds_read_b64_tr_b16 a[6:7], v7 offset:51232
v_mfma_f32_16x16x32_bf16 v[40:43], a[40:43], v[136:139], v[40:43]
buffer_load_dwordx4 v[120:123], v4, s[16:19], s52 offen sc1
v_mfma_f32_16x16x32_bf16 v[56:59], a[40:43], v[140:143], v[56:59]
ds_read_b64_tr_b16 a[8:9], v7 offset:50752
ds_read_b64_tr_b16 a[10:11], v7 offset:51264
v_mfma_f32_16x16x32_bf16 v[44:47], a[44:47], v[136:139], v[44:47]
ds_read_b64_tr_b16 a[12:13], v7 offset:50784
ds_read_b64_tr_b16 a[14:15], v7 offset:51296
v_mfma_f32_16x16x32_bf16 v[60:63], a[44:47], v[140:143], v[60:63]
s_waitcnt lgkmcnt(8)
v_mfma_f32_16x16x32_bf16 v[64:67], a[48:51], v[136:139], v[64:67]
buffer_load_dwordx4 v6, s[28:31], s54 offen offset:1056 lds
v_mfma_f32_16x16x32_bf16 v[80:83], a[48:51], v[140:143], v[80:83]
ds_read_b64_tr_b16 a[16:17], v10 offset:50688
s_add_u32 s54, s54, 0x10000
v_mfma_f32_16x16x32_bf16 v[68:71], a[52:55], v[136:139], v[68:71]
ds_read_b64_tr_b16 a[18:19], v10 offset:51200
ds_read_b64_tr_b16 a[20:21], v10 offset:50720
v_mfma_f32_16x16x32_bf16 v[84:87], a[52:55], v[140:143], v[84:87]
ds_read_b64_tr_b16 a[22:23], v10 offset:51232
v_mfma_f32_16x16x32_bf16 v[72:75], a[56:59], v[136:139], v[72:75]
buffer_load_dwordx4 v[124:127], v4, s[16:19], s52 offen offset:1024 sc1
v_mfma_f32_16x16x32_bf16 v[88:91], a[56:59], v[140:143], v[88:91]
ds_read_b64_tr_b16 a[24:25], v10 offset:50752
s_add_u32 s52, s52, 0x20000
v_mfma_f32_16x16x32_bf16 v[76:79], a[60:63], v[136:139], v[76:79]
ds_read_b64_tr_b16 a[26:27], v10 offset:51264
ds_read_b64_tr_b16 a[28:29], v10 offset:50784
v_mfma_f32_16x16x32_bf16 v[92:95], a[60:63], v[140:143], v[92:95]
ds_read_b64_tr_b16 a[30:31], v10 offset:51296
s_waitcnt vmcnt(21) lgkmcnt(8)
s_barrier
v_mfma_f32_16x16x32_bf16 v[32:35], a[0:3], v[144:147], v[32:35]
ds_read_b64_tr_b16 a[32:33], v7 offset:59136
s_add_u32 m0, s55, 33792
v_mfma_f32_16x16x32_bf16 v[48:51], a[0:3], v[148:151], v[48:51]
buffer_load_dwordx4 v5, s[28:31], s54 offen lds
v_mfma_f32_16x16x32_bf16 v[36:39], a[4:7], v[144:147], v[36:39]
ds_read_b64_tr_b16 a[34:35], v7 offset:59648
ds_read_b64_tr_b16 a[36:37], v7 offset:59168
v_mfma_f32_16x16x32_bf16 v[52:55], a[4:7], v[148:151], v[52:55]
ds_read_b64_tr_b16 a[38:39], v7 offset:59680
v_mfma_f32_16x16x32_bf16 v[40:43], a[8:11], v[144:147], v[40:43]
buffer_load_dwordx4 v[128:131], v4, s[16:19], s52 offen sc1
v_mfma_f32_16x16x32_bf16 v[56:59], a[8:11], v[148:151], v[56:59]
ds_read_b64_tr_b16 a[40:41], v7 offset:59200
ds_read_b64_tr_b16 a[42:43], v7 offset:59712
v_mfma_f32_16x16x32_bf16 v[44:47], a[12:15], v[144:147], v[44:47]
ds_read_b64_tr_b16 a[44:45], v7 offset:59232
ds_read_b64_tr_b16 a[46:47], v7 offset:59744
v_mfma_f32_16x16x32_bf16 v[60:63], a[12:15], v[148:151], v[60:63]
s_waitcnt lgkmcnt(8)
v_mfma_f32_16x16x32_bf16 v[64:67], a[16:19], v[144:147], v[64:67]
buffer_load_dwordx4 v6, s[28:31], s54 offen offset:1056 lds
v_mfma_f32_16x16x32_bf16 v[80:83], a[16:19], v[148:151], v[80:83]
ds_read_b64_tr_b16 a[48:49], v10 offset:59136
s_add_u32 s54, s54, 0x10000
v_mfma_f32_16x16x32_bf16 v[68:71], a[20:23], v[144:147], v[68:71]
ds_read_b64_tr_b16 a[50:51], v10 offset:59648
ds_read_b64_tr_b16 a[52:53], v10 offset:59168
v_mfma_f32_16x16x32_bf16 v[84:87], a[20:23], v[148:151], v[84:87]
ds_read_b64_tr_b16 a[54:55], v10 offset:59680
v_mfma_f32_16x16x32_bf16 v[72:75], a[24:27], v[144:147], v[72:75]
buffer_load_dwordx4 v[132:135], v4, s[16:19], s52 offen offset:1024 sc1
v_mfma_f32_16x16x32_bf16 v[88:91], a[24:27], v[148:151], v[88:91]
ds_read_b64_tr_b16 a[56:57], v10 offset:59200
s_add_u32 s52, s52, 0x20000
v_mfma_f32_16x16x32_bf16 v[76:79], a[28:31], v[144:147], v[76:79]
ds_read_b64_tr_b16 a[58:59], v10 offset:59712
ds_read_b64_tr_b16 a[60:61], v10 offset:59232
v_mfma_f32_16x16x32_bf16 v[92:95], a[28:31], v[148:151], v[92:95]
ds_read_b64_tr_b16 a[62:63], v10 offset:59744
v_add_u32 v7, s57, v7
v_add_u32 v10, s57, v10
s_sub_u32 s57, 0, s57
s_waitcnt vmcnt(21) lgkmcnt(8)
v_mfma_f32_16x16x32_bf16 v[32:35], a[32:35], v[152:155], v[32:35]
ds_read_b64_tr_b16 a[0:1], v10
s_add_u32 m0, s55, 42240
v_mfma_f32_16x16x32_bf16 v[48:51], a[32:35], v[156:159], v[48:51]
buffer_load_dwordx4 v5, s[28:31], s54 offen lds
v_mfma_f32_16x16x32_bf16 v[36:39], a[36:39], v[152:155], v[36:39]
ds_read_b64_tr_b16 a[2:3], v10 offset:512
ds_read_b64_tr_b16 a[4:5], v10 offset:32
v_mfma_f32_16x16x32_bf16 v[52:55], a[36:39], v[156:159], v[52:55]
ds_read_b64_tr_b16 a[6:7], v10 offset:544
v_mfma_f32_16x16x32_bf16 v[40:43], a[40:43], v[152:155], v[40:43]
buffer_load_dwordx4 v[136:139], v4, s[16:19], s52 offen sc1
v_mfma_f32_16x16x32_bf16 v[56:59], a[40:43], v[156:159], v[56:59]
ds_read_b64_tr_b16 a[8:9], v10 offset:64
ds_read_b64_tr_b16 a[10:11], v10 offset:576
v_mfma_f32_16x16x32_bf16 v[44:47], a[44:47], v[152:155], v[44:47]
ds_read_b64_tr_b16 a[12:13], v10 offset:96
ds_read_b64_tr_b16 a[14:15], v10 offset:608
v_mfma_f32_16x16x32_bf16 v[60:63], a[44:47], v[156:159], v[60:63]
s_waitcnt lgkmcnt(8)
v_mfma_f32_16x16x32_bf16 v[64:67], a[48:51], v[152:155], v[64:67]
buffer_load_dwordx4 v6, s[28:31], s54 offen offset:1056 lds
v_mfma_f32_16x16x32_bf16 v[80:83], a[48:51], v[156:159], v[80:83]
ds_read_b64_tr_b16 a[16:17], v10 offset:8448
s_add_u32 s54, s54, 0x10000
v_mfma_f32_16x16x32_bf16 v[68:71], a[52:55], v[152:155], v[68:71]
ds_read_b64_tr_b16 a[18:19], v10 offset:8960
ds_read_b64_tr_b16 a[20:21], v10 offset:8480
v_mfma_f32_16x16x32_bf16 v[84:87], a[52:55], v[156:159], v[84:87]
ds_read_b64_tr_b16 a[22:23], v10 offset:8992
v_mfma_f32_16x16x32_bf16 v[72:75], a[56:59], v[152:155], v[72:75]
buffer_load_dwordx4 v[140:143], v4, s[16:19], s52 offen offset:1024 sc1
v_mfma_f32_16x16x32_bf16 v[88:91], a[56:59], v[156:159], v[88:91]
ds_read_b64_tr_b16 a[24:25], v10 offset:8512
s_add_u32 s52, s52, 0x20000
v_mfma_f32_16x16x32_bf16 v[76:79], a[60:63], v[152:155], v[76:79]
ds_read_b64_tr_b16 a[26:27], v10 offset:9024
ds_read_b64_tr_b16 a[28:29], v10 offset:8544
v_mfma_f32_16x16x32_bf16 v[92:95], a[60:63], v[156:159], v[92:95]
ds_read_b64_tr_b16 a[30:31], v10 offset:9056
s_mov_b32 s62, s55
s_mov_b32 s55, s56
s_mov_b32 s56, s62
s_waitcnt vmcnt(21) lgkmcnt(8)
s_barrier
v_mfma_f32_16x16x32_bf16 v[64:67], a[0:3], v[96:99], v[64:67]
ds_read_b64_tr_b16 a[32:33], v10 offset:16896
ds_read_b64_tr_b16 a[34:35], v10 offset:17408
s_add_u32 m0, s56, 50688
v_mfma_f32_16x16x32_bf16 v[80:83], a[0:3], v[100:103], v[80:83]
ds_read_b64_tr_b16 a[36:37], v10 offset:16928
buffer_load_dwordx4 v5, s[28:31], s54 offen lds
v_mfma_f32_16x16x32_bf16 v[68:71], a[4:7], v[96:99], v[68:71]
buffer_load_dwordx4 v6, s[28:31], s54 offen offset:1056 lds
v_mfma_f32_16x16x32_bf16 v[84:87], a[4:7], v[100:103], v[84:87]
ds_read_b64_tr_b16 a[38:39], v10 offset:17440
ds_read_b64_tr_b16 a[40:41], v10 offset:16960
s_add_u32 s54, s54, 0x10000
v_mfma_f32_16x16x32_bf16 v[72:75], a[8:11], v[96:99], v[72:75]
buffer_load_dwordx4 v[144:147], v4, s[16:19], s52 offen sc1
v_mfma_f32_16x16x32_bf16 v[88:91], a[8:11], v[100:103], v[88:91]
ds_read_b64_tr_b16 a[42:43], v10 offset:17472
ds_read_b64_tr_b16 a[44:45], v10 offset:16992
v_mfma_f32_16x16x32_bf16 v[76:79], a[12:15], v[96:99], v[76:79]
buffer_load_dwordx4 v[148:151], v4, s[16:19], s52 offen offset:1024 sc1
v_mfma_f32_16x16x32_bf16 v[92:95], a[12:15], v[100:103], v[92:95]
ds_read_b64_tr_b16 a[46:47], v10 offset:17504
s_add_u32 s52, s52, 0x20000
s_add_u32 m0, s56, 59136
s_waitcnt vmcnt(21) lgkmcnt(8)
v_mfma_f32_16x16x32_bf16 v[64:67], a[16:19], v[104:107], v[64:67]
ds_read_b64_tr_b16 a[48:49], v10 offset:25344
buffer_load_dwordx4 v5, s[28:31], s54 offen lds
v_mfma_f32_16x16x32_bf16 v[80:83], a[16:19], v[108:111], v[80:83]
ds_read_b64_tr_b16 a[50:51], v10 offset:25856
v_mfma_f32_16x16x32_bf16 v[68:71], a[20:23], v[104:107], v[68:71]
ds_read_b64_tr_b16 a[52:53], v10 offset:25376
buffer_load_dwordx4 v6, s[28:31], s54 offen offset:1056 lds
v_mfma_f32_16x16x32_bf16 v[84:87], a[20:23], v[108:111], v[84:87]
ds_read_b64_tr_b16 a[54:55], v10 offset:25888
s_add_u32 s54, s54, 0x10000
v_mfma_f32_16x16x32_bf16 v[72:75], a[24:27], v[104:107], v[72:75]
ds_read_b64_tr_b16 a[56:57], v10 offset:25408
buffer_load_dwordx4 v[152:155], v4, s[16:19], s52 offen sc1
v_mfma_f32_16x16x32_bf16 v[88:91], a[24:27], v[108:111], v[88:91]
ds_read_b64_tr_b16 a[58:59], v10 offset:25920
v_mfma_f32_16x16x32_bf16 v[76:79], a[28:31], v[104:107], v[76:79]
ds_read_b64_tr_b16 a[60:61], v10 offset:25440
buffer_load_dwordx4 v[156:159], v4, s[16:19], s52 offen offset:1024 sc1
v_mfma_f32_16x16x32_bf16 v[92:95], a[28:31], v[108:111], v[92:95]
ds_read_b64_tr_b16 a[62:63], v10 offset:25952
s_add_u32 s52, s52, 0x20000
s_waitcnt vmcnt(20) lgkmcnt(8)
v_mfma_f32_16x16x32_bf16 v[64:67], a[32:35], v[112:115], v[64:67]
ds_read_b64_tr_b16 a[0:1], v10 offset:33792
ds_read_b64_tr_b16 a[2:3], v10 offset:34304
v_mfma_f32_16x16x32_bf16 v[80:83], a[32:35], v[116:119], v[80:83]
buffer_load_dwordx4 v[160:163], v4, s[16:19], s52 offen sc1
v_mfma_f32_16x16x32_bf16 v[68:71], a[36:39], v[112:115], v[68:71]
ds_read_b64_tr_b16 a[4:5], v10 offset:33824
ds_read_b64_tr_b16 a[6:7], v10 offset:34336
v_mfma_f32_16x16x32_bf16 v[84:87], a[36:39], v[116:119], v[84:87]
ds_read_b64_tr_b16 a[8:9], v10 offset:33856
v_mfma_f32_16x16x32_bf16 v[72:75], a[40:43], v[112:115], v[72:75]
buffer_load_dwordx4 v[164:167], v4, s[16:19], s52 offen offset:1024 sc1
v_mfma_f32_16x16x32_bf16 v[88:91], a[40:43], v[116:119], v[88:91]
ds_read_b64_tr_b16 a[10:11], v10 offset:34368
s_add_u32 s52, s52, 0x20000
v_mfma_f32_16x16x32_bf16 v[76:79], a[44:47], v[112:115], v[76:79]
ds_read_b64_tr_b16 a[12:13], v10 offset:33888
v_mfma_f32_16x16x32_bf16 v[92:95], a[44:47], v[116:119], v[92:95]
ds_read_b64_tr_b16 a[14:15], v10 offset:34400
s_waitcnt vmcnt(18) lgkmcnt(8)
v_mfma_f32_16x16x32_bf16 v[64:67], a[48:51], v[120:123], v[64:67]
buffer_load_dwordx4 v[168:171], v4, s[16:19], s52 offen sc1
v_mfma_f32_16x16x32_bf16 v[80:83], a[48:51], v[124:127], v[80:83]
ds_read_b64_tr_b16 a[16:17], v10 offset:42240
ds_read_b64_tr_b16 a[18:19], v10 offset:42752
v_mfma_f32_16x16x32_bf16 v[68:71], a[52:55], v[120:123], v[68:71]
ds_read_b64_tr_b16 a[20:21], v10 offset:42272
v_mfma_f32_16x16x32_bf16 v[84:87], a[52:55], v[124:127], v[84:87]
ds_read_b64_tr_b16 a[22:23], v10 offset:42784
ds_read_b64_tr_b16 a[24:25], v10 offset:42304
v_mfma_f32_16x16x32_bf16 v[72:75], a[56:59], v[120:123], v[72:75]
buffer_load_dwordx4 v[172:175], v4, s[16:19], s52 offen offset:1024 sc1
v_mfma_f32_16x16x32_bf16 v[88:91], a[56:59], v[124:127], v[88:91]
s_add_u32 s52, s52, 0x20000
v_mfma_f32_16x16x32_bf16 v[76:79], a[60:63], v[120:123], v[76:79]
ds_read_b64_tr_b16 a[26:27], v10 offset:42816
ds_read_b64_tr_b16 a[28:29], v10 offset:42336
v_mfma_f32_16x16x32_bf16 v[92:95], a[60:63], v[124:127], v[92:95]
ds_read_b64_tr_b16 a[30:31], v10 offset:42848
s_waitcnt vmcnt(16) lgkmcnt(8)
v_mfma_f32_16x16x32_bf16 v[64:67], a[0:3], v[128:131], v[64:67]
ds_read_b64_tr_b16 a[32:33], v10 offset:50688
ds_read_b64_tr_b16 a[34:35], v10 offset:51200
v_mfma_f32_16x16x32_bf16 v[80:83], a[0:3], v[132:135], v[80:83]
buffer_load_dwordx4 v[176:179], v4, s[16:19], s52 offen sc1
v_mfma_f32_16x16x32_bf16 v[68:71], a[4:7], v[128:131], v[68:71]
ds_read_b64_tr_b16 a[36:37], v10 offset:50720
ds_read_b64_tr_b16 a[38:39], v10 offset:51232
v_mfma_f32_16x16x32_bf16 v[84:87], a[4:7], v[132:135], v[84:87]
ds_read_b64_tr_b16 a[40:41], v10 offset:50752
v_mfma_f32_16x16x32_bf16 v[72:75], a[8:11], v[128:131], v[72:75]
buffer_load_dwordx4 v[180:183], v4, s[16:19], s52 offen offset:1024 sc1
v_mfma_f32_16x16x32_bf16 v[88:91], a[8:11], v[132:135], v[88:91]
ds_read_b64_tr_b16 a[42:43], v10 offset:51264
s_add_u32 s52, s52, 0x20000
v_mfma_f32_16x16x32_bf16 v[76:79], a[12:15], v[128:131], v[76:79]
ds_read_b64_tr_b16 a[44:45], v10 offset:50784
v_mfma_f32_16x16x32_bf16 v[92:95], a[12:15], v[132:135], v[92:95]
ds_read_b64_tr_b16 a[46:47], v10 offset:51296
s_waitcnt vmcnt(14) lgkmcnt(8)
v_mfma_f32_16x16x32_bf16 v[64:67], a[16:19], v[136:139], v[64:67]
buffer_load_dwordx4 v[184:187], v4, s[16:19], s52 offen sc1
v_mfma_f32_16x16x32_bf16 v[80:83], a[16:19], v[140:143], v[80:83]
ds_read_b64_tr_b16 a[48:49], v10 offset:59136
ds_read_b64_tr_b16 a[50:51], v10 offset:59648
v_mfma_f32_16x16x32_bf16 v[68:71], a[20:23], v[136:139], v[68:71]
ds_read_b64_tr_b16 a[52:53], v10 offset:59168
v_mfma_f32_16x16x32_bf16 v[84:87], a[20:23], v[140:143], v[84:87]
ds_read_b64_tr_b16 a[54:55], v10 offset:59680
ds_read_b64_tr_b16 a[56:57], v10 offset:59200
v_mfma_f32_16x16x32_bf16 v[72:75], a[24:27], v[136:139], v[72:75]
buffer_load_dwordx4 v[188:191], v4, s[16:19], s52 offen offset:1024 sc1
v_mfma_f32_16x16x32_bf16 v[88:91], a[24:27], v[140:143], v[88:91]
s_add_u32 s52, s52, 0x20000
v_mfma_f32_16x16x32_bf16 v[76:79], a[28:31], v[136:139], v[76:79]
ds_read_b64_tr_b16 a[58:59], v10 offset:59712
ds_read_b64_tr_b16 a[60:61], v10 offset:59232
v_mfma_f32_16x16x32_bf16 v[92:95], a[28:31], v[140:143], v[92:95]
ds_read_b64_tr_b16 a[62:63], v10 offset:59744
s_waitcnt vmcnt(10) lgkmcnt(8)
s_barrier
v_add_u32 v10, s57, v10
v_mfma_f32_16x16x32_bf16 v[64:67], a[32:35], v[144:147], v[64:67]
ds_read_b64_tr_b16 a[0:1], v10
ds_read_b64_tr_b16 a[2:3], v10 offset:512
v_mfma_f32_16x16x32_bf16 v[80:83], a[32:35], v[148:151], v[80:83]
buffer_load_dwordx4 v[192:195], v4, s[16:19], s52 offen sc1
v_mfma_f32_16x16x32_bf16 v[68:71], a[36:39], v[144:147], v[68:71]
ds_read_b64_tr_b16 a[4:5], v10 offset:32
ds_read_b64_tr_b16 a[6:7], v10 offset:544
v_mfma_f32_16x16x32_bf16 v[84:87], a[36:39], v[148:151], v[84:87]
ds_read_b64_tr_b16 a[8:9], v10 offset:64
v_mfma_f32_16x16x32_bf16 v[72:75], a[40:43], v[144:147], v[72:75]
buffer_load_dwordx4 v[196:199], v4, s[16:19], s52 offen offset:1024 sc1
v_mfma_f32_16x16x32_bf16 v[88:91], a[40:43], v[148:151], v[88:91]
ds_read_b64_tr_b16 a[10:11], v10 offset:576
s_add_u32 s52, s52, 0x20000
v_mfma_f32_16x16x32_bf16 v[76:79], a[44:47], v[144:147], v[76:79]
ds_read_b64_tr_b16 a[12:13], v10 offset:96
v_mfma_f32_16x16x32_bf16 v[92:95], a[44:47], v[148:151], v[92:95]
ds_read_b64_tr_b16 a[14:15], v10 offset:608
s_waitcnt vmcnt(10) lgkmcnt(8)
v_mfma_f32_16x16x32_bf16 v[64:67], a[48:51], v[152:155], v[64:67]
buffer_load_dwordx4 v[200:203], v4, s[16:19], s52 offen sc1
v_mfma_f32_16x16x32_bf16 v[80:83], a[48:51], v[156:159], v[80:83]
ds_read_b64_tr_b16 a[16:17], v10 offset:8448
ds_read_b64_tr_b16 a[18:19], v10 offset:8960
v_mfma_f32_16x16x32_bf16 v[68:71], a[52:55], v[152:155], v[68:71]
ds_read_b64_tr_b16 a[20:21], v10 offset:8480
v_mfma_f32_16x16x32_bf16 v[84:87], a[52:55], v[156:159], v[84:87]
ds_read_b64_tr_b16 a[22:23], v10 offset:8992
ds_read_b64_tr_b16 a[24:25], v10 offset:8512
v_mfma_f32_16x16x32_bf16 v[72:75], a[56:59], v[152:155], v[72:75]
buffer_load_dwordx4 v[204:207], v4, s[16:19], s52 offen offset:1024 sc1
v_mfma_f32_16x16x32_bf16 v[88:91], a[56:59], v[156:159], v[88:91]
s_add_u32 s52, s52, 0x20000
v_mfma_f32_16x16x32_bf16 v[76:79], a[60:63], v[152:155], v[76:79]
ds_read_b64_tr_b16 a[26:27], v10 offset:9024
ds_read_b64_tr_b16 a[28:29], v10 offset:8544
v_mfma_f32_16x16x32_bf16 v[92:95], a[60:63], v[156:159], v[92:95]
ds_read_b64_tr_b16 a[30:31], v10 offset:9056
s_waitcnt vmcnt(10) lgkmcnt(8)
v_mfma_f32_16x16x32_bf16 v[64:67], a[0:3], v[160:163], v[64:67]
ds_read_b64_tr_b16 a[32:33], v10 offset:16896
ds_read_b64_tr_b16 a[34:35], v10 offset:17408
v_mfma_f32_16x16x32_bf16 v[80:83], a[0:3], v[164:167], v[80:83]
buffer_load_dwordx4 v[208:211], v4, s[16:19], s52 offen sc1
v_mfma_f32_16x16x32_bf16 v[68:71], a[4:7], v[160:163], v[68:71]
ds_read_b64_tr_b16 a[36:37], v10 offset:16928
ds_read_b64_tr_b16 a[38:39], v10 offset:17440
v_mfma_f32_16x16x32_bf16 v[84:87], a[4:7], v[164:167], v[84:87]
ds_read_b64_tr_b16 a[40:41], v10 offset:16960
v_mfma_f32_16x16x32_bf16 v[72:75], a[8:11], v[160:163], v[72:75]
buffer_load_dwordx4 v[212:215], v4, s[16:19], s52 offen offset:1024 sc1
v_mfma_f32_16x16x32_bf16 v[88:91], a[8:11], v[164:167], v[88:91]
ds_read_b64_tr_b16 a[42:43], v10 offset:17472
s_add_u32 s52, s52, 0x20000
v_mfma_f32_16x16x32_bf16 v[76:79], a[12:15], v[160:163], v[76:79]
ds_read_b64_tr_b16 a[44:45], v10 offset:16992
v_mfma_f32_16x16x32_bf16 v[92:95], a[12:15], v[164:167], v[92:95]
ds_read_b64_tr_b16 a[46:47], v10 offset:17504
s_waitcnt vmcnt(10) lgkmcnt(8)
v_mfma_f32_16x16x32_bf16 v[64:67], a[16:19], v[168:171], v[64:67]
buffer_load_dwordx4 v[216:219], v4, s[16:19], s52 offen sc1
v_mfma_f32_16x16x32_bf16 v[80:83], a[16:19], v[172:175], v[80:83]
ds_read_b64_tr_b16 a[48:49], v10 offset:25344
ds_read_b64_tr_b16 a[50:51], v10 offset:25856
v_mfma_f32_16x16x32_bf16 v[68:71], a[20:23], v[168:171], v[68:71]
ds_read_b64_tr_b16 a[52:53], v10 offset:25376
v_mfma_f32_16x16x32_bf16 v[84:87], a[20:23], v[172:175], v[84:87]
ds_read_b64_tr_b16 a[54:55], v10 offset:25888
ds_read_b64_tr_b16 a[56:57], v10 offset:25408
v_mfma_f32_16x16x32_bf16 v[72:75], a[24:27], v[168:171], v[72:75]
buffer_load_dwordx4 v[220:223], v4, s[16:19], s52 offen offset:1024 sc1
v_mfma_f32_16x16x32_bf16 v[88:91], a[24:27], v[172:175], v[88:91]
s_add_u32 s52, s52, 0x20000
v_mfma_f32_16x16x32_bf16 v[76:79], a[28:31], v[168:171], v[76:79]
ds_read_b64_tr_b16 a[58:59], v10 offset:25920
ds_read_b64_tr_b16 a[60:61], v10 offset:25440
v_mfma_f32_16x16x32_bf16 v[92:95], a[28:31], v[172:175], v[92:95]
ds_read_b64_tr_b16 a[62:63], v10 offset:25952
s_waitcnt vmcnt(10) lgkmcnt(8)
v_mfma_f32_16x16x32_bf16 v[64:67], a[32:35], v[176:179], v[64:67]
ds_read_b64_tr_b16 a[0:1], v10 offset:33792
v_mfma_f32_16x16x32_bf16 v[80:83], a[32:35], v[180:183], v[80:83]
ds_read_b64_tr_b16 a[2:3], v10 offset:34304
v_mfma_f32_16x16x32_bf16 v[68:71], a[36:39], v[176:179], v[68:71]
ds_read_b64_tr_b16 a[4:5], v10 offset:33824
v_mfma_f32_16x16x32_bf16 v[84:87], a[36:39], v[180:183], v[84:87]
ds_read_b64_tr_b16 a[6:7], v10 offset:34336
v_mfma_f32_16x16x32_bf16 v[72:75], a[40:43], v[176:179], v[72:75]
ds_read_b64_tr_b16 a[8:9], v10 offset:33856
v_mfma_f32_16x16x32_bf16 v[88:91], a[40:43], v[180:183], v[88:91]
ds_read_b64_tr_b16 a[10:11], v10 offset:34368
v_mfma_f32_16x16x32_bf16 v[76:79], a[44:47], v[176:179], v[76:79]
ds_read_b64_tr_b16 a[12:13], v10 offset:33888
v_mfma_f32_16x16x32_bf16 v[92:95], a[44:47], v[180:183], v[92:95]
ds_read_b64_tr_b16 a[14:15], v10 offset:34400
s_waitcnt vmcnt(8) lgkmcnt(8)
v_mfma_f32_16x16x32_bf16 v[64:67], a[48:51], v[184:187], v[64:67]
ds_read_b64_tr_b16 a[16:17], v10 offset:42240
v_mfma_f32_16x16x32_bf16 v[80:83], a[48:51], v[188:191], v[80:83]
ds_read_b64_tr_b16 a[18:19], v10 offset:42752
v_mfma_f32_16x16x32_bf16 v[68:71], a[52:55], v[184:187], v[68:71]
ds_read_b64_tr_b16 a[20:21], v10 offset:42272
v_mfma_f32_16x16x32_bf16 v[84:87], a[52:55], v[188:191], v[84:87]
ds_read_b64_tr_b16 a[22:23], v10 offset:42784
v_mfma_f32_16x16x32_bf16 v[72:75], a[56:59], v[184:187], v[72:75]
ds_read_b64_tr_b16 a[24:25], v10 offset:42304
v_mfma_f32_16x16x32_bf16 v[88:91], a[56:59], v[188:191], v[88:91]
ds_read_b64_tr_b16 a[26:27], v10 offset:42816
v_mfma_f32_16x16x32_bf16 v[76:79], a[60:63], v[184:187], v[76:79]
ds_read_b64_tr_b16 a[28:29], v10 offset:42336
v_mfma_f32_16x16x32_bf16 v[92:95], a[60:63], v[188:191], v[92:95]
ds_read_b64_tr_b16 a[30:31], v10 offset:42848
s_waitcnt vmcnt(6) lgkmcnt(8)
v_mfma_f32_16x16x32_bf16 v[64:67], a[0:3], v[192:195], v[64:67]
ds_read_b64_tr_b16 a[32:33], v10 offset:50688
v_mfma_f32_16x16x32_bf16 v[80:83], a[0:3], v[196:199], v[80:83]
ds_read_b64_tr_b16 a[34:35], v10 offset:51200
v_mfma_f32_16x16x32_bf16 v[68:71], a[4:7], v[192:195], v[68:71]
ds_read_b64_tr_b16 a[36:37], v10 offset:50720
v_mfma_f32_16x16x32_bf16 v[84:87], a[4:7], v[196:199], v[84:87]
ds_read_b64_tr_b16 a[38:39], v10 offset:51232
v_mfma_f32_16x16x32_bf16 v[72:75], a[8:11], v[192:195], v[72:75]
ds_read_b64_tr_b16 a[40:41], v10 offset:50752
v_mfma_f32_16x16x32_bf16 v[88:91], a[8:11], v[196:199], v[88:91]
ds_read_b64_tr_b16 a[42:43], v10 offset:51264
v_mfma_f32_16x16x32_bf16 v[76:79], a[12:15], v[192:195], v[76:79]
ds_read_b64_tr_b16 a[44:45], v10 offset:50784
v_mfma_f32_16x16x32_bf16 v[92:95], a[12:15], v[196:199], v[92:95]
ds_read_b64_tr_b16 a[46:47], v10 offset:51296
s_waitcnt vmcnt(4) lgkmcnt(8)
v_mfma_f32_16x16x32_bf16 v[64:67], a[16:19], v[200:203], v[64:67]
ds_read_b64_tr_b16 a[48:49], v10 offset:59136
v_mfma_f32_16x16x32_bf16 v[80:83], a[16:19], v[204:207], v[80:83]
ds_read_b64_tr_b16 a[50:51], v10 offset:59648
v_mfma_f32_16x16x32_bf16 v[68:71], a[20:23], v[200:203], v[68:71]
ds_read_b64_tr_b16 a[52:53], v10 offset:59168
v_mfma_f32_16x16x32_bf16 v[84:87], a[20:23], v[204:207], v[84:87]
ds_read_b64_tr_b16 a[54:55], v10 offset:59680
v_mfma_f32_16x16x32_bf16 v[72:75], a[24:27], v[200:203], v[72:75]
ds_read_b64_tr_b16 a[56:57], v10 offset:59200
v_mfma_f32_16x16x32_bf16 v[88:91], a[24:27], v[204:207], v[88:91]
ds_read_b64_tr_b16 a[58:59], v10 offset:59712
v_mfma_f32_16x16x32_bf16 v[76:79], a[28:31], v[200:203], v[76:79]
ds_read_b64_tr_b16 a[60:61], v10 offset:59232
v_mfma_f32_16x16x32_bf16 v[92:95], a[28:31], v[204:207], v[92:95]
ds_read_b64_tr_b16 a[62:63], v10 offset:59744
s_waitcnt vmcnt(2) lgkmcnt(8)
v_mfma_f32_16x16x32_bf16 v[64:67], a[32:35], v[208:211], v[64:67]
ds_read_b64_tr_b16 a[0:1], v7
v_mfma_f32_16x16x32_bf16 v[80:83], a[32:35], v[212:215], v[80:83]
ds_read_b64_tr_b16 a[2:3], v7 offset:512
v_mfma_f32_16x16x32_bf16 v[68:71], a[36:39], v[208:211], v[68:71]
ds_read_b64_tr_b16 a[4:5], v7 offset:32
v_mfma_f32_16x16x32_bf16 v[84:87], a[36:39], v[212:215], v[84:87]
ds_read_b64_tr_b16 a[6:7], v7 offset:544
v_mfma_f32_16x16x32_bf16 v[72:75], a[40:43], v[208:211], v[72:75]
ds_read_b64_tr_b16 a[8:9], v7 offset:64
v_mfma_f32_16x16x32_bf16 v[88:91], a[40:43], v[212:215], v[88:91]
ds_read_b64_tr_b16 a[10:11], v7 offset:576
v_mfma_f32_16x16x32_bf16 v[76:79], a[44:47], v[208:211], v[76:79]
ds_read_b64_tr_b16 a[12:13], v7 offset:96
v_mfma_f32_16x16x32_bf16 v[92:95], a[44:47], v[212:215], v[92:95]
ds_read_b64_tr_b16 a[14:15], v7 offset:608
s_waitcnt vmcnt(0) lgkmcnt(8)
v_mfma_f32_16x16x32_bf16 v[64:67], a[48:51], v[216:219], v[64:67]
ds_read_b64_tr_b16 a[16:17], v7 offset:8448
v_mfma_f32_16x16x32_bf16 v[80:83], a[48:51], v[220:223], v[80:83]
ds_read_b64_tr_b16 a[18:19], v7 offset:8960
v_mfma_f32_16x16x32_bf16 v[68:71], a[52:55], v[216:219], v[68:71]
ds_read_b64_tr_b16 a[20:21], v7 offset:8480
v_mfma_f32_16x16x32_bf16 v[84:87], a[52:55], v[220:223], v[84:87]
ds_read_b64_tr_b16 a[22:23], v7 offset:8992
v_mfma_f32_16x16x32_bf16 v[72:75], a[56:59], v[216:219], v[72:75]
ds_read_b64_tr_b16 a[24:25], v7 offset:8512
v_mfma_f32_16x16x32_bf16 v[88:91], a[56:59], v[220:223], v[88:91]
ds_read_b64_tr_b16 a[26:27], v7 offset:9024
v_mfma_f32_16x16x32_bf16 v[76:79], a[60:63], v[216:219], v[76:79]
ds_read_b64_tr_b16 a[28:29], v7 offset:8544
v_mfma_f32_16x16x32_bf16 v[92:95], a[60:63], v[220:223], v[92:95]
ds_read_b64_tr_b16 a[30:31], v7 offset:9056
s_waitcnt lgkmcnt(8)
v_mfma_f32_16x16x32_bf16 v[32:35], a[0:3], v[96:99], v[32:35]
ds_read_b64_tr_b16 a[32:33], v7 offset:16896
v_cvt_pk_bf16_f32 v232, v64, v65
v_cvt_pk_bf16_f32 v233, v66, v67
v_mfma_f32_16x16x32_bf16 v[48:51], a[0:3], v[100:103], v[48:51]
ds_read_b64_tr_b16 a[34:35], v7 offset:17408
v_cvt_pk_bf16_f32 v234, v68, v69
v_mfma_f32_16x16x32_bf16 v[36:39], a[4:7], v[96:99], v[36:39]
ds_read_b64_tr_b16 a[36:37], v7 offset:16928
v_cvt_pk_bf16_f32 v235, v70, v71
buffer_store_dwordx4 v[232:235], v11, s[16:19], s69 offen sc1
v_mfma_f32_16x16x32_bf16 v[52:55], a[4:7], v[100:103], v[52:55]
ds_read_b64_tr_b16 a[38:39], v7 offset:17440
s_add_u32 s69, s69, 131072
v_mfma_f32_16x16x32_bf16 v[40:43], a[8:11], v[96:99], v[40:43]
ds_read_b64_tr_b16 a[40:41], v7 offset:16960
v_cvt_pk_bf16_f32 v236, v72, v73
v_cvt_pk_bf16_f32 v237, v74, v75
v_mfma_f32_16x16x32_bf16 v[56:59], a[8:11], v[100:103], v[56:59]
ds_read_b64_tr_b16 a[42:43], v7 offset:17472
v_cvt_pk_bf16_f32 v238, v76, v77
v_mfma_f32_16x16x32_bf16 v[44:47], a[12:15], v[96:99], v[44:47]
ds_read_b64_tr_b16 a[44:45], v7 offset:16992
v_cvt_pk_bf16_f32 v239, v78, v79
buffer_store_dwordx4 v[236:239], v11, s[16:19], s69 offen sc1
v_mfma_f32_16x16x32_bf16 v[60:63], a[12:15], v[100:103], v[60:63]
ds_read_b64_tr_b16 a[46:47], v7 offset:17504
s_add_u32 s69, s69, -130048
s_waitcnt lgkmcnt(8)
v_mfma_f32_16x16x32_bf16 v[32:35], a[16:19], v[104:107], v[32:35]
ds_read_b64_tr_b16 a[48:49], v7 offset:25344
v_cvt_pk_bf16_f32 v240, v80, v81
v_mfma_f32_16x16x32_bf16 v[48:51], a[16:19], v[108:111], v[48:51]
ds_read_b64_tr_b16 a[50:51], v7 offset:25856
v_cvt_pk_bf16_f32 v241, v82, v83
v_cvt_pk_bf16_f32 v242, v84, v85
v_mfma_f32_16x16x32_bf16 v[36:39], a[20:23], v[104:107], v[36:39]
ds_read_b64_tr_b16 a[52:53], v7 offset:25376
v_cvt_pk_bf16_f32 v243, v86, v87
v_mfma_f32_16x16x32_bf16 v[52:55], a[20:23], v[108:111], v[52:55]
ds_read_b64_tr_b16 a[54:55], v7 offset:25888
buffer_store_dwordx4 v[240:243], v11, s[16:19], s69 offen sc1
s_add_u32 s69, s69, 131072
v_mfma_f32_16x16x32_bf16 v[40:43], a[24:27], v[104:107], v[40:43]
ds_read_b64_tr_b16 a[56:57], v7 offset:25408
v_cvt_pk_bf16_f32 v244, v88, v89
v_mfma_f32_16x16x32_bf16 v[56:59], a[24:27], v[108:111], v[56:59]
ds_read_b64_tr_b16 a[58:59], v7 offset:25920
v_cvt_pk_bf16_f32 v245, v90, v91
v_cvt_pk_bf16_f32 v246, v92, v93
v_mfma_f32_16x16x32_bf16 v[44:47], a[28:31], v[104:107], v[44:47]
ds_read_b64_tr_b16 a[60:61], v7 offset:25440
v_cvt_pk_bf16_f32 v247, v94, v95
v_mfma_f32_16x16x32_bf16 v[60:63], a[28:31], v[108:111], v[60:63]
ds_read_b64_tr_b16 a[62:63], v7 offset:25952
buffer_store_dwordx4 v[244:247], v11, s[16:19], s69 offen sc1
s_waitcnt lgkmcnt(8)
v_mfma_f32_16x16x32_bf16 v[32:35], a[32:35], v[112:115], v[32:35]
ds_read_b64_tr_b16 a[0:1], v7 offset:33792
v_mfma_f32_16x16x32_bf16 v[48:51], a[32:35], v[116:119], v[48:51]
ds_read_b64_tr_b16 a[2:3], v7 offset:34304
v_mfma_f32_16x16x32_bf16 v[36:39], a[36:39], v[112:115], v[36:39]
ds_read_b64_tr_b16 a[4:5], v7 offset:33824
v_mfma_f32_16x16x32_bf16 v[52:55], a[36:39], v[116:119], v[52:55]
ds_read_b64_tr_b16 a[6:7], v7 offset:34336
v_mfma_f32_16x16x32_bf16 v[40:43], a[40:43], v[112:115], v[40:43]
.Lpad34:
s_cbranch_execz .Lnopoll66r
ds_read_b64_tr_b16 a[8:9], v7 offset:33856
v_mfma_f32_16x16x32_bf16 v[56:59], a[40:43], v[116:119], v[56:59]
ds_read_b64_tr_b16 a[10:11], v7 offset:34368
v_mfma_f32_16x16x32_bf16 v[44:47], a[44:47], v[112:115], v[44:47]
ds_read_b64_tr_b16 a[12:13], v7 offset:33888
v_mfma_f32_16x16x32_bf16 v[60:63], a[44:47], v[116:119], v[60:63]
ds_read_b64_tr_b16 a[14:15], v7 offset:34400
s_waitcnt lgkmcnt(8)
v_mfma_f32_16x16x32_bf16 v[32:35], a[48:51], v[120:123], v[32:35]
ds_read_b64_tr_b16 a[16:17], v7 offset:42240
v_mfma_f32_16x16x32_bf16 v[48:51], a[48:51], v[124:127], v[48:51]
ds_read_b64_tr_b16 a[18:19], v7 offset:42752
v_mfma_f32_16x16x32_bf16 v[36:39], a[52:55], v[120:123], v[36:39]
ds_read_b64_tr_b16 a[20:21], v7 offset:42272
v_mfma_f32_16x16x32_bf16 v[52:55], a[52:55], v[124:127], v[52:55]
ds_read_b64_tr_b16 a[22:23], v7 offset:42784
v_mfma_f32_16x16x32_bf16 v[40:43], a[56:59], v[120:123], v[40:43]
ds_read_b64_tr_b16 a[24:25], v7 offset:42304
v_mfma_f32_16x16x32_bf16 v[56:59], a[56:59], v[124:127], v[56:59]
ds_read_b64_tr_b16 a[26:27], v7 offset:42816
v_mfma_f32_16x16x32_bf16 v[44:47], a[60:63], v[120:123], v[44:47]
ds_read_b64_tr_b16 a[28:29], v7 offset:42336
v_mfma_f32_16x16x32_bf16 v[60:63], a[60:63], v[124:127], v[60:63]
ds_read_b64_tr_b16 a[30:31], v7 offset:42848
s_waitcnt lgkmcnt(8)
v_mfma_f32_16x16x32_bf16 v[32:35], a[0:3], v[128:131], v[32:35]
ds_read_b64_tr_b16 a[32:33], v7 offset:50688
v_mfma_f32_16x16x32_bf16 v[48:51], a[0:3], v[132:135], v[48:51]
ds_read_b64_tr_b16 a[34:35], v7 offset:51200
v_mfma_f32_16x16x32_bf16 v[36:39], a[4:7], v[128:131], v[36:39]
ds_read_b64_tr_b16 a[36:37], v7 offset:50720
v_mfma_f32_16x16x32_bf16 v[52:55], a[4:7], v[132:135], v[52:55]
ds_read_b64_tr_b16 a[38:39], v7 offset:51232
v_mfma_f32_16x16x32_bf16 v[40:43], a[8:11], v[128:131], v[40:43]
ds_read_b64_tr_b16 a[40:41], v7 offset:50752
v_mfma_f32_16x16x32_bf16 v[56:59], a[8:11], v[132:135], v[56:59]
ds_read_b64_tr_b16 a[42:43], v7 offset:51264
v_mfma_f32_16x16x32_bf16 v[44:47], a[12:15], v[128:131], v[44:47]
ds_read_b64_tr_b16 a[44:45], v7 offset:50784
v_mfma_f32_16x16x32_bf16 v[60:63], a[12:15], v[132:135], v[60:63]
ds_read_b64_tr_b16 a[46:47], v7 offset:51296
s_waitcnt lgkmcnt(8)
v_mfma_f32_16x16x32_bf16 v[32:35], a[16:19], v[136:139], v[32:35]
ds_read_b64_tr_b16 a[48:49], v7 offset:59136
v_mfma_f32_16x16x32_bf16 v[48:51], a[16:19], v[140:143], v[48:51]
ds_read_b64_tr_b16 a[50:51], v7 offset:59648
v_mfma_f32_16x16x32_bf16 v[36:39], a[20:23], v[136:139], v[36:39]
ds_read_b64_tr_b16 a[52:53], v7 offset:59168
v_mfma_f32_16x16x32_bf16 v[52:55], a[20:23], v[140:143], v[52:55]
ds_read_b64_tr_b16 a[54:55], v7 offset:59680
v_mfma_f32_16x16x32_bf16 v[40:43], a[24:27], v[136:139], v[40:43]
ds_read_b64_tr_b16 a[56:57], v7 offset:59200
v_mfma_f32_16x16x32_bf16 v[56:59], a[24:27], v[140:143], v[56:59]
ds_read_b64_tr_b16 a[58:59], v7 offset:59712
v_mfma_f32_16x16x32_bf16 v[44:47], a[28:31], v[136:139], v[44:47]
ds_read_b64_tr_b16 a[60:61], v7 offset:59232
v_mfma_f32_16x16x32_bf16 v[60:63], a[28:31], v[140:143], v[60:63]
ds_read_b64_tr_b16 a[62:63], v7 offset:59744
v_add_u32 v7, s57, v7
s_waitcnt lgkmcnt(8)
v_mfma_f32_16x16x32_bf16 v[32:35], a[32:35], v[144:147], v[32:35]
ds_read_b64_tr_b16 a[0:1], v7
v_mfma_f32_16x16x32_bf16 v[48:51], a[32:35], v[148:151], v[48:51]
ds_read_b64_tr_b16 a[2:3], v7 offset:512
v_mfma_f32_16x16x32_bf16 v[36:39], a[36:39], v[144:147], v[36:39]
ds_read_b64_tr_b16 a[4:5], v7 offset:32
v_mfma_f32_16x16x32_bf16 v[52:55], a[36:39], v[148:151], v[52:55]
ds_read_b64_tr_b16 a[6:7], v7 offset:544
v_mfma_f32_16x16x32_bf16 v[40:43], a[40:43], v[144:147], v[40:43]
ds_read_b64_tr_b16 a[8:9], v7 offset:64
v_mfma_f32_16x16x32_bf16 v[56:59], a[40:43], v[148:151], v[56:59]
ds_read_b64_tr_b16 a[10:11], v7 offset:576
v_mfma_f32_16x16x32_bf16 v[44:47], a[44:47], v[144:147], v[44:47]
ds_read_b64_tr_b16 a[12:13], v7 offset:96
v_mfma_f32_16x16x32_bf16 v[60:63], a[44:47], v[148:151], v[60:63]
ds_read_b64_tr_b16 a[14:15], v7 offset:608
s_waitcnt lgkmcnt(8)
v_mfma_f32_16x16x32_bf16 v[32:35], a[48:51], v[152:155], v[32:35]
ds_read_b64_tr_b16 a[16:17], v7 offset:8448
v_mfma_f32_16x16x32_bf16 v[48:51], a[48:51], v[156:159], v[48:51]
ds_read_b64_tr_b16 a[18:19], v7 offset:8960
v_mfma_f32_16x16x32_bf16 v[36:39], a[52:55], v[152:155], v[36:39]
ds_read_b64_tr_b16 a[20:21], v7 offset:8480
v_mfma_f32_16x16x32_bf16 v[52:55], a[52:55], v[156:159], v[52:55]
ds_read_b64_tr_b16 a[22:23], v7 offset:8992
v_mfma_f32_16x16x32_bf16 v[40:43], a[56:59], v[152:155], v[40:43]
ds_read_b64_tr_b16 a[24:25], v7 offset:8512
v_mfma_f32_16x16x32_bf16 v[56:59], a[56:59], v[156:159], v[56:59]
ds_read_b64_tr_b16 a[26:27], v7 offset:9024
v_mfma_f32_16x16x32_bf16 v[44:47], a[60:63], v[152:155], v[44:47]
ds_read_b64_tr_b16 a[28:29], v7 offset:8544
v_mfma_f32_16x16x32_bf16 v[60:63], a[60:63], v[156:159], v[60:63]
ds_read_b64_tr_b16 a[30:31], v7 offset:9056
s_waitcnt lgkmcnt(8)
v_mfma_f32_16x16x32_bf16 v[32:35], a[0:3], v[160:163], v[32:35]
ds_read_b64_tr_b16 a[32:33], v7 offset:16896
ds_read_b64_tr_b16 a[34:35], v7 offset:17408
v_mfma_f32_16x16x32_bf16 v[48:51], a[0:3], v[164:167], v[48:51]
s_waitcnt vmcnt(0)
buffer_atomic_add v13, v12, s[16:19], s71 offen
v_mfma_f32_16x16x32_bf16 v[36:39], a[4:7], v[160:163], v[36:39]
ds_read_b64_tr_b16 a[36:37], v7 offset:16928
v_mfma_f32_16x16x32_bf16 v[52:55], a[4:7], v[164:167], v[52:55]
ds_read_b64_tr_b16 a[38:39], v7 offset:17440
v_mfma_f32_16x16x32_bf16 v[40:43], a[8:11], v[160:163], v[40:43]
ds_read_b64_tr_b16 a[40:41], v7 offset:16960
v_mfma_f32_16x16x32_bf16 v[56:59], a[8:11], v[164:167], v[56:59]
ds_read_b64_tr_b16 a[42:43], v7 offset:17472
v_mfma_f32_16x16x32_bf16 v[44:47], a[12:15], v[160:163], v[44:47]
ds_read_b64_tr_b16 a[44:45], v7 offset:16992
v_mfma_f32_16x16x32_bf16 v[60:63], a[12:15], v[164:167], v[60:63]
ds_read_b64_tr_b16 a[46:47], v7 offset:17504
s_waitcnt lgkmcnt(8)
v_mfma_f32_16x16x32_bf16 v[32:35], a[16:19], v[168:171], v[32:35]
ds_read_b64_tr_b16 a[48:49], v7 offset:25344
v_mfma_f32_16x16x32_bf16 v[48:51], a[16:19], v[172:175], v[48:51]
ds_read_b64_tr_b16 a[50:51], v7 offset:25856
v_mfma_f32_16x16x32_bf16 v[36:39], a[20:23], v[168:171], v[36:39]
ds_read_b64_tr_b16 a[52:53], v7 offset:25376
v_mfma_f32_16x16x32_bf16 v[52:55], a[20:23], v[172:175], v[52:55]
ds_read_b64_tr_b16 a[54:55], v7 offset:25888
v_mfma_f32_16x16x32_bf16 v[40:43], a[24:27], v[168:171], v[40:43]
ds_read_b64_tr_b16 a[56:57], v7 offset:25408
v_mfma_f32_16x16x32_bf16 v[56:59], a[24:27], v[172:175], v[56:59]
ds_read_b64_tr_b16 a[58:59], v7 offset:25920
v_mfma_f32_16x16x32_bf16 v[44:47], a[28:31], v[168:171], v[44:47]
ds_read_b64_tr_b16 a[60:61], v7 offset:25440
v_mfma_f32_16x16x32_bf16 v[60:63], a[28:31], v[172:175], v[60:63]
ds_read_b64_tr_b16 a[62:63], v7 offset:25952
s_waitcnt lgkmcnt(8)
v_mfma_f32_16x16x32_bf16 v[32:35], a[32:35], v[176:179], v[32:35]
ds_read_b64_tr_b16 a[0:1], v7 offset:33792
v_mfma_f32_16x16x32_bf16 v[48:51], a[32:35], v[180:183], v[48:51]
ds_read_b64_tr_b16 a[2:3], v7 offset:34304
v_mfma_f32_16x16x32_bf16 v[36:39], a[36:39], v[176:179], v[36:39]
ds_read_b64_tr_b16 a[4:5], v7 offset:33824
v_mfma_f32_16x16x32_bf16 v[52:55], a[36:39], v[180:183], v[52:55]
ds_read_b64_tr_b16 a[6:7], v7 offset:34336
v_mfma_f32_16x16x32_bf16 v[40:43], a[40:43], v[176:179], v[40:43]
ds_read_b64_tr_b16 a[8:9], v7 offset:33856
v_mfma_f32_16x16x32_bf16 v[56:59], a[40:43], v[180:183], v[56:59]
ds_read_b64_tr_b16 a[10:11], v7 offset:34368
v_mfma_f32_16x16x32_bf16 v[44:47], a[44:47], v[176:179], v[44:47]
ds_read_b64_tr_b16 a[12:13], v7 offset:33888
v_mfma_f32_16x16x32_bf16 v[60:63], a[44:47], v[180:183], v[60:63]
ds_read_b64_tr_b16 a[14:15], v7 offset:34400
s_waitcnt lgkmcnt(8)
v_mfma_f32_16x16x32_bf16 v[32:35], a[48:51], v[184:187], v[32:35]
ds_read_b64_tr_b16 a[16:17], v7 offset:42240
v_mfma_f32_16x16x32_bf16 v[48:51], a[48:51], v[188:191], v[48:51]
ds_read_b64_tr_b16 a[18:19], v7 offset:42752
v_mfma_f32_16x16x32_bf16 v[36:39], a[52:55], v[184:187], v[36:39]
ds_read_b64_tr_b16 a[20:21], v7 offset:42272
v_mfma_f32_16x16x32_bf16 v[52:55], a[52:55], v[188:191], v[52:55]
ds_read_b64_tr_b16 a[22:23], v7 offset:42784
v_mfma_f32_16x16x32_bf16 v[40:43], a[56:59], v[184:187], v[40:43]
ds_read_b64_tr_b16 a[24:25], v7 offset:42304
v_mfma_f32_16x16x32_bf16 v[56:59], a[56:59], v[188:191], v[56:59]
ds_read_b64_tr_b16 a[26:27], v7 offset:42816
v_mfma_f32_16x16x32_bf16 v[44:47], a[60:63], v[184:187], v[44:47]
ds_read_b64_tr_b16 a[28:29], v7 offset:42336
v_mfma_f32_16x16x32_bf16 v[60:63], a[60:63], v[188:191], v[60:63]
ds_read_b64_tr_b16 a[30:31], v7 offset:42848
s_waitcnt lgkmcnt(8)
v_mfma_f32_16x16x32_bf16 v[32:35], a[0:3], v[192:195], v[32:35]
ds_read_b64_tr_b16 a[32:33], v7 offset:50688
ds_read_b64_tr_b16 a[34:35], v7 offset:51200
v_mfma_f32_16x16x32_bf16 v[48:51], a[0:3], v[196:199], v[48:51]
buffer_atomic_add v15, v12, s[16:19], s70 offen sc0
v_mfma_f32_16x16x32_bf16 v[36:39], a[4:7], v[192:195], v[36:39]
ds_read_b64_tr_b16 a[36:37], v7 offset:50720
v_mfma_f32_16x16x32_bf16 v[52:55], a[4:7], v[196:199], v[52:55]
ds_read_b64_tr_b16 a[38:39], v7 offset:51232
v_mfma_f32_16x16x32_bf16 v[40:43], a[8:11], v[192:195], v[40:43]
ds_read_b64_tr_b16 a[40:41], v7 offset:50752
v_mfma_f32_16x16x32_bf16 v[56:59], a[8:11], v[196:199], v[56:59]
ds_read_b64_tr_b16 a[42:43], v7 offset:51264
v_mfma_f32_16x16x32_bf16 v[44:47], a[12:15], v[192:195], v[44:47]
ds_read_b64_tr_b16 a[44:45], v7 offset:50784
v_mfma_f32_16x16x32_bf16 v[60:63], a[12:15], v[196:199], v[60:63]
ds_read_b64_tr_b16 a[46:47], v7 offset:51296
s_waitcnt lgkmcnt(8)
v_mfma_f32_16x16x32_bf16 v[32:35], a[16:19], v[200:203], v[32:35]
ds_read_b64_tr_b16 a[48:49], v7 offset:59136
v_mfma_f32_16x16x32_bf16 v[48:51], a[16:19], v[204:207], v[48:51]
ds_read_b64_tr_b16 a[50:51], v7 offset:59648
v_mfma_f32_16x16x32_bf16 v[36:39], a[20:23], v[200:203], v[36:39]
ds_read_b64_tr_b16 a[52:53], v7 offset:59168
v_mfma_f32_16x16x32_bf16 v[52:55], a[20:23], v[204:207], v[52:55]
ds_read_b64_tr_b16 a[54:55], v7 offset:59680
v_mfma_f32_16x16x32_bf16 v[40:43], a[24:27], v[200:203], v[40:43]
ds_read_b64_tr_b16 a[56:57], v7 offset:59200
v_mfma_f32_16x16x32_bf16 v[56:59], a[24:27], v[204:207], v[56:59]
ds_read_b64_tr_b16 a[58:59], v7 offset:59712
v_mfma_f32_16x16x32_bf16 v[44:47], a[28:31], v[200:203], v[44:47]
ds_read_b64_tr_b16 a[60:61], v7 offset:59232
v_mfma_f32_16x16x32_bf16 v[60:63], a[28:31], v[204:207], v[60:63]
ds_read_b64_tr_b16 a[62:63], v7 offset:59744
s_waitcnt lgkmcnt(8)
v_mfma_f32_16x16x32_bf16 v[32:35], a[32:35], v[208:211], v[32:35]
v_mfma_f32_16x16x32_bf16 v[48:51], a[32:35], v[212:215], v[48:51]
v_mfma_f32_16x16x32_bf16 v[36:39], a[36:39], v[208:211], v[36:39]
v_mfma_f32_16x16x32_bf16 v[52:55], a[36:39], v[212:215], v[52:55]
v_mfma_f32_16x16x32_bf16 v[40:43], a[40:43], v[208:211], v[40:43]
v_mfma_f32_16x16x32_bf16 v[56:59], a[40:43], v[212:215], v[56:59]
v_mfma_f32_16x16x32_bf16 v[44:47], a[44:47], v[208:211], v[44:47]
v_mfma_f32_16x16x32_bf16 v[60:63], a[44:47], v[212:215], v[60:63]
s_waitcnt lgkmcnt(0)
v_mfma_f32_16x16x32_bf16 v[32:35], a[48:51], v[216:219], v[32:35]
v_mfma_f32_16x16x32_bf16 v[48:51], a[48:51], v[220:223], v[48:51]
v_mfma_f32_16x16x32_bf16 v[36:39], a[52:55], v[216:219], v[36:39]
v_mfma_f32_16x16x32_bf16 v[52:55], a[52:55], v[220:223], v[52:55]
v_mfma_f32_16x16x32_bf16 v[40:43], a[56:59], v[216:219], v[40:43]
v_mfma_f32_16x16x32_bf16 v[56:59], a[56:59], v[220:223], v[56:59]
v_mfma_f32_16x16x32_bf16 v[44:47], a[60:63], v[216:219], v[44:47]
v_mfma_f32_16x16x32_bf16 v[60:63], a[60:63], v[220:223], v[60:63]
s_waitcnt vmcnt(0)
v_cmp_ne_u32 vcc, 0, v15
s_nop 0
s_cbranch_vccz .Lxs69
.Lxs69b:
buffer_load_dwordx4 v[232:235], v11, s[16:19], s68 offen sc1
s_add_u32 s68, s68, 131072
buffer_load_dwordx4 v[236:239], v11, s[16:19], s68 offen sc1
s_add_u32 s68, s68, -130048
buffer_load_dwordx4 v[240:243], v11, s[16:19], s68 offen sc1
s_add_u32 s68, s68, 131072
buffer_load_dwordx4 v[244:247], v11, s[16:19], s68 offen sc1
s_waitcnt vmcnt(3)
v_mfma_f32_16x16x32_bf16 v[32:35], v[226:229], v[232:235], v[32:35]
v_mfma_f32_16x16x32_bf16 v[36:39], v[224:227], v[232:235], v[36:39]
s_waitcnt vmcnt(2)
v_mfma_f32_16x16x32_bf16 v[40:43], v[226:229], v[236:239], v[40:43]
s_nop 4
v_cvt_pk_bf16_f32 v128, v32, v33
v_cvt_pk_bf16_f32 v129, v34, v35
v_mfma_f32_16x16x32_bf16 v[44:47], v[224:227], v[236:239], v[44:47]
v_cvt_pk_bf16_f32 v130, v36, v37
v_cvt_pk_bf16_f32 v131, v38, v39
s_waitcnt vmcnt(1)
v_mfma_f32_16x16x32_bf16 v[48:51], v[226:229], v[240:243], v[48:51]
v_permlane16_swap_b32 v128, v130
v_mfma_f32_16x16x32_bf16 v[52:55], v[224:227], v[240:243], v[52:55]
v_permlane16_swap_b32 v129, v131
s_waitcnt vmcnt(0)
v_mfma_f32_16x16x32_bf16 v[56:59], v[226:229], v[244:247], v[56:59]
buffer_store_dwordx4 v[128:131], v16, s[36:39], 0 offen sc1
v_mfma_f32_16x16x32_bf16 v[60:63], v[224:227], v[244:247], v[60:63]
v_cvt_pk_bf16_f32 v132, v40, v41
v_cvt_pk_bf16_f32 v133, v42, v43
v_cvt_pk_bf16_f32 v134, v44, v45
v_cvt_pk_bf16_f32 v135, v46, v47
v_cvt_pk_bf16_f32 v136, v48, v49
v_permlane16_swap_b32 v132, v134
v_permlane16_swap_b32 v133, v135
v_cvt_pk_bf16_f32 v137, v50, v51
v_cvt_pk_bf16_f32 v138, v52, v53
buffer_store_dwordx4 v[132:135], v16, s[36:39], 0 offen offset:64 sc1
v_cvt_pk_bf16_f32 v139, v54, v55
v_permlane16_swap_b32 v136, v138
s_nop 0
v_permlane16_swap_b32 v137, v139
v_cvt_pk_bf16_f32 v140, v56, v57
v_cvt_pk_bf16_f32 v141, v58, v59
v_cvt_pk_bf16_f32 v142, v60, v61
v_cvt_pk_bf16_f32 v143, v62, v63
s_nop 0
v_permlane16_swap_b32 v140, v142
v_permlane16_swap_b32 v141, v143
buffer_store_dwordx4 v[136:139], v17, s[36:39], 0 offen sc1
buffer_store_dwordx4 v[140:143], v17, s[36:39], 0 offen offset:64 sc1
s_nop 1
.Lend:
s_endpgm
.Lxs69:
s_mov_b32 s15, 0
.Lxs69l:
v_mov_b32 v15, 0
buffer_atomic_add v15, v12, s[16:19], s70 offen sc0
s_add_u32 s15, s15, 1
s_cmp_gt_u32 s15, 100000
s_waitcnt vmcnt(0)
s_cbranch_scc1 .Lxs69b
v_cmp_ne_u32 vcc, 0, v15
s_nop 0
s_cbranch_vccz .Lxs69l
s_branch .Lxs69b
.section .rodata,"a"
.p2align 6
.amdhsa_kernel interleave_layers__sliding_local_dilated__swiglu_ffn__prompt_kernel
  .amdhsa_next_free_vgpr 512
  .amdhsa_next_free_sgpr 102
  .amdhsa_accum_offset 256
  .amdhsa_group_segment_fixed_size 0
  .amdhsa_kernarg_size 80
  .amdhsa_user_sgpr_count 2
  .amdhsa_user_sgpr_kernarg_segment_ptr 1
  .amdhsa_system_sgpr_workgroup_id_x 1
  .amdhsa_float_denorm_mode_32 3
.end_amdhsa_kernel
```

```asm
; @launch grid=(256,1,1) block=(256,1,1) lds=162560
.amdgcn_target "amdgcn-amd-amdhsa--gfx950"
.text
.globl interleave_layers__sliding_local_dilated__swiglu_ffn__prompt_kernel
.p2align 8
.type interleave_layers__sliding_local_dilated__swiglu_ffn__prompt_kernel,@function
interleave_layers__sliding_local_dilated__swiglu_ffn__prompt_kernel:
s_load_dwordx4 s[68:71], s[0:1], 0
s_load_dwordx2 s[72:73], s[0:1], 16
s_load_dwordx8 s[76:83], s[0:1], 32
s_load_dwordx4 s[84:87], s[0:1], 64
s_cmp_lt_u32 s2, 256
s_cbranch_scc1 .Lgo
s_endpgm
.p2align 12
.Lgo:
v_lshrrev_b32 v2, 6, v0
v_and_b32 v1, 63, v0
v_readfirstlane_b32 s3, v2
s_and_b32 s4, s2, 7
s_lshr_b32 s5, s2, 3
s_lshr_b32 s6, s4, 1
s_lshl_b32 s6, s6, 2
s_and_b32 s62, s5, 3
s_add_u32 s6, s6, s62
s_and_b32 s7, s4, 1
s_lshr_b32 s62, s5, 2
s_lshl_b32 s62, s62, 1
s_add_u32 s7, s7, s62
s_lshr_b32 s8, s4, 2
s_lshl_b32 s8, s8, 3
s_and_b32 s62, s5, 7
s_add_u32 s8, s8, s62
s_and_b32 s9, s4, 3
s_lshl_b32 s9, s9, 2
s_lshr_b32 s62, s5, 3
s_add_u32 s9, s9, s62
s_lshr_b32 s62, s6, 1
s_lshl_b32 s62, s62, 8
s_and_b32 s63, s6, 1
s_add_u32 s62, s62, s63
s_lshl_b32 s63, s3, 6
s_add_u32 s62, s62, s63
s_lshl_b32 s62, s62, 11
s_lshl_b32 s63, s7, 7
s_add_u32 s62, s62, s63
v_and_b32 v160, 15, v1
v_lshlrev_b32 v160, 12, v160
v_bfe_u32 v2, v1, 4, 1
v_lshl_add_u32 v160, v2, 5, v160
v_bfe_u32 v2, v1, 5, 1
v_lshl_add_u32 v160, v2, 4, v160
v_add_u32 v160, s62, v160
v_add_u32 v161, 0x10000, v160
s_sub_u32 s64, s3, 1
s_max_i32 s64, s64, 0
s_lshl_b32 s64, s64, 11
s_lshl_b32 s66, s9, 7
s_add_u32 s66, s66, s64
s_cmp_eq_u32 s3, 1
s_cselect_b32 s66, 8388608, s66
s_mul_i32 s65, s8, 122880
s_add_u32 s65, s65, s66
v_lshrrev_b32 v9, 1, v1
v_min_u32 v9, 19, v9
v_mul_u32_u24 v9, 6144, v9
s_waitcnt lgkmcnt(0)
s_mov_b32 s36, s68
s_mov_b32 s37, s69
s_mov_b32 s38, 4194304
s_mov_b32 s39, 0x20000
s_mov_b32 s16, s86
s_mov_b32 s17, s87
s_mov_b32 s18, 268435456
s_mov_b32 s19, 0x20000
s_lshl_b32 s14, s2, 2
s_add_u32 s14, s14, s3
v_lshlrev_b32 v27, 4, v1
v_mov_b64 v[156:157], 0
v_mov_b64 v[158:159], 0
s_cmp_lg_u32 s14, 3
s_cbranch_scc1 .Lz1
s_mov_b32 s62, 30408704
buffer_store_dwordx4 v[156:159], v27, s[16:19], s62 offen sc1
buffer_store_dwordx4 v[156:159], v27, s[16:19], s62 offen offset:1024 sc1
buffer_store_dwordx4 v[156:159], v27, s[16:19], s62 offen offset:2048 sc1
buffer_store_dwordx4 v[156:159], v27, s[16:19], s62 offen offset:3072 sc1
s_mov_b32 s62, 30412800
buffer_store_dwordx4 v[156:159], v27, s[16:19], s62 offen sc1
buffer_store_dwordx4 v[156:159], v27, s[16:19], s62 offen offset:1024 sc1
buffer_store_dwordx4 v[156:159], v27, s[16:19], s62 offen offset:2048 sc1
buffer_store_dwordx4 v[156:159], v27, s[16:19], s62 offen offset:3072 sc1
s_mov_b32 s62, 30416896
buffer_store_dwordx4 v[156:159], v27, s[16:19], s62 offen sc1
buffer_store_dwordx4 v[156:159], v27, s[16:19], s62 offen offset:1024 sc1
buffer_store_dwordx4 v[156:159], v27, s[16:19], s62 offen offset:2048 sc1
buffer_store_dwordx4 v[156:159], v27, s[16:19], s62 offen offset:3072 sc1
s_mov_b32 s62, 30420992
buffer_store_dwordx4 v[156:159], v27, s[16:19], s62 offen sc1
buffer_store_dwordx4 v[156:159], v27, s[16:19], s62 offen offset:1024 sc1
buffer_store_dwordx4 v[156:159], v27, s[16:19], s62 offen offset:2048 sc1
buffer_store_dwordx4 v[156:159], v27, s[16:19], s62 offen offset:3072 sc1
.Lz1:
buffer_load_dwordx4 v[128:131], v160, s[36:39], 0 offen
buffer_load_dwordx4 v[132:135], v160, s[36:39], 0 offen offset:64
buffer_load_dwordx4 v[136:139], v161, s[36:39], 0 offen
buffer_load_dwordx4 v[140:143], v161, s[36:39], 0 offen offset:64
s_mov_b32 s20, s70
s_mov_b32 s21, s71
s_mov_b32 s22, 6291456
s_mov_b32 s23, 0x20000
buffer_load_dword v58, v9, s[20:23], s65 offen
s_mov_b32 s40, s84
s_mov_b32 s41, s85
s_mov_b32 s42, 256
s_mov_b32 s43, 0x20000
s_getpc_b64 s[62:63]
.Lpc:
s_lshl_b32 s64, s5, 12
v_lshrrev_b32 v59, 3, v0
v_lshl_add_u32 v59, v59, 7, s64
v_add_u32 v2, 0x20000, v59
v_min_u32 v2, .Lend-.Lpc, v2
v_min_u32 v59, .Lend-.Lpc, v59
global_load_dword v59, v59, s[62:63]
global_load_dword v58, v2, s[62:63]
s_mov_b32 s24, s72
s_mov_b32 s25, s73
s_mov_b32 s26, 2097152
s_mov_b32 s27, 0x20000
s_mov_b32 s28, s80
s_mov_b32 s29, s81
s_mov_b32 s30, 7340032
s_mov_b32 s31, 0x20000
s_cmp_lt_u32 s3, 2
s_cselect_b32 s32, s76, s78
s_cselect_b32 s33, s77, s79
s_mov_b32 s34, 7340032
s_mov_b32 s35, 0x20000
s_lshr_b32 s10, s4, 2
s_lshl_b32 s10, s10, 2
s_and_b32 s62, s5, 3
s_add_u32 s10, s10, s62
s_and_b32 s11, s4, 3
s_lshl_b32 s11, s11, 3
s_lshr_b32 s62, s5, 2
s_add_u32 s11, s11, s62
s_and_b32 s12, s11, 1
s_lshr_b32 s13, s11, 1
s_mul_i32 s51, s13, 448
s_mul_i32 s62, s12, 192
s_add_u32 s51, s51, s62
s_and_b32 s48, s3, 1
s_lshr_b32 s49, s3, 1
s_lshl_b32 s50, s8, 3
s_sub_u32 s50, s50, 9
s_cmp_lt_u32 s8, 2
s_cselect_b32 s50, 7, s50
s_mul_i32 s62, s8, 393216
s_add_u32 s62, s62, s66
v_mul_u32_u24 v14, 6144, v1
v_add_u32 v14, s62, v14
s_lshl_b32 s62, s8, 4
s_add_u32 s62, s62, s9
s_lshl_b32 s62, s62, 2
s_add_u32 s62, s62, s3
s_mul_i32 s62, s62, 6656
v_min_u32 v15, 51, v1
v_lshl_add_u32 v15, v15, 7, s62
s_sub_u32 s63, s8, 4
s_lshl_b32 s64, s8, 1
s_add_u32 s64, s64, 1
s_cmp_lt_u32 s8, 5
s_cselect_b64 vcc, -1, 0
s_cselect_b32 s46, s64, s63
v_cndmask_b32 v14, v14, v15, vcc
s_lshl_b32 s62, s2, 1
s_add_u32 s62, s62, s48
s_mul_i32 s62, s62, 5376
v_min_u32 v16, 41, v1
v_lshl_add_u32 v16, v16, 7, s62
s_cmp_lt_u32 s46, 6
s_cselect_b64 vcc, -1, 0
v_cndmask_b32 v15, v14, v16, vcc
v_cndmask_b32 v14, v16, v14, vcc
s_cmp_lt_u32 s8, 5
s_cselect_b32 s62, s24, s20
s_cselect_b32 s63, s25, s21
s_cselect_b32 s64, s26, s22
s_sub_u32 s47, s46, 6
s_cmp_lt_u32 s46, 6
s_cselect_b32 s47, s46, s47
s_cselect_b32 s76, s62, s32
s_cselect_b32 s98, s32, s62
s_cselect_b32 s77, s63, s33
s_cselect_b32 s99, s33, s63
s_cselect_b32 s78, s64, s34
s_cselect_b32 s100, s34, s64
s_mov_b32 s79, 0x20000
v_bfe_u32 v18, v1, 3, 1
v_bfe_u32 v2, v1, 5, 1
v_lshl_add_u32 v18, v2, 2, v18
v_and_b32 v2, 16, v1
v_add_u32 v18, v18, v2
s_lshl_b32 s62, s49, 2
s_add_u32 s62, s62, s48
s_lshl_b32 s62, s62, 1
v_add_u32 v18, s62, v18
v_mul_u32_u24 v18, 6144, v18
v_and_b32 v2, 7, v1
v_lshl_add_u32 v18, v2, 4, v18
s_lshl_b32 s62, s9, 7
v_add_u32 v18, s62, v18
v_add_u32 v19, 1024, v18
v_add_u32 v20, 2048, v18
s_mul_i32 s59, s3, 3104
s_mov_b32 s58, 0
s_lshr_b32 s62, s8, 1
s_lshl_b32 s62, s62, 8
s_and_b32 s67, s8, 1
s_add_u32 s62, s62, s67
s_lshl_b32 s62, s62, 11
s_lshl_b32 s63, s3, 17
s_add_u32 s62, s62, s63
v_lshrrev_b32 v2, 4, v1
v_xor_b32 v2, v2, v1
v_and_b32 v2, 7, v2
v_lshlrev_b32 v2, 4, v2
v_lshrrev_b32 v21, 3, v1
v_lshl_add_u32 v21, v21, 12, v2
v_add_u32 v21, s62, v21
v_xor_b32 v28, 64, v21
v_add_u32 v28, 31744, v28
s_lshr_b32 s63, s50, 3
s_lshr_b32 s62, s63, 1
s_lshl_b32 s62, s62, 8
s_and_b32 s67, s63, 1
s_add_u32 s62, s62, s67
s_lshl_b32 s62, s62, 11
s_lshl_b32 s63, s3, 14
s_add_u32 s62, s62, s63
s_add_u32 s62, s62, 456704
s_lshl_b32 s63, s3, 5
v_and_b32 v2, 31, v1
v_lshlrev_b32 v2, 2, v2
v_xor_b32 v2, s63, v2
v_lshrrev_b32 v22, 5, v1
v_lshl_add_u32 v22, v22, 12, v2
v_add_u32 v22, s62, v22
v_xor_b32 v29, 16, v22
v_add_u32 v29, -57344, v29
s_mov_b32 s52, 0
s_mov_b32 s53, 65536
s_mul_i32 s55, s3, 4608
s_mov_b32 s54, 0
s_mul_i32 s56, s3, 3104
v_bfe_u32 v24, v1, 1, 3
v_lshrrev_b32 v2, 4, v1
v_xor_b32 v2, v2, v24
v_lshlrev_b32 v2, 4, v2
v_and_b32 v23, 15, v1
v_lshl_add_u32 v23, v23, 7, v2
s_mul_i32 s62, s48, 9216
v_add_u32 v23, s62, v23
v_xor_b32 v30, 64, v23
v_mul_u32_u24 v24, 2304, v24
v_add_u32 v24, v24, v2
v_and_b32 v2, 1, v1
v_lshl_add_u32 v24, v2, 7, v24
v_add_u32 v24, 2048, v24
v_xor_b32 v31, 64, v24
v_and_b32 v2, 15, v1
v_cmp_eq_u32 vcc, 0, v2
v_mov_b32 v2, 18432
s_nop 0
v_cndmask_b32 v24, v24, v2, vcc
v_cndmask_b32 v31, v31, v2, vcc
v_bfe_u32 v25, v1, 3, 2
v_mul_u32_u24 v25, 3104, v25
v_bfe_u32 v2, v1, 2, 1
v_lshl_add_u32 v25, v2, 7, v25
v_bfe_u32 v2, v1, 5, 1
v_lshl_add_u32 v25, v2, 8, v25
v_and_b32 v2, 3, v1
v_lshl_add_u32 v25, v2, 3, v25
s_lshl_b32 s62, s49, 6
s_add_u32 s62, s62, 73984
v_add_u32 v25, s62, v25
s_lshl_b32 s62, s8, 1
s_add_u32 s62, s62, s3
s_lshr_b32 s63, s50, 2
s_cmp_lt_u32 s3, 2
s_cselect_b32 s62, s62, s63
s_lshl_b32 s62, s62, 13
s_cmp_eq_u32 s3, 3
s_cselect_b32 s62, 268435456, s62
v_lshl_add_u32 v26, v1, 4, s62
s_mul_i32 s59, s3, 2080
v_bfe_u32 v5, v1, 3, 1
v_lshrrev_b32 v2, 4, v1
v_lshl_add_u32 v5, v2, 3, v5
s_lshl_b32 s62, s3, 1
v_add_u32 v5, s62, v5
v_mul_u32_u24 v5, 2048, v5
v_and_b32 v2, 7, v1
v_lshl_add_u32 v5, v2, 4, v5
s_lshl_b32 s62, s7, 7
v_add_u32 v5, s62, v5
v_add_u32 v6, 64512, v5
s_lshl_b32 s62, s6, 7
s_add_u32 s62, s62, 30408704
s_lshl_b32 s64, s8, 7
s_add_u32 s64, s64, 30408704
s_lshr_b32 s65, s50, 3
s_lshl_b32 s65, s65, 7
s_add_u32 s65, s65, 30408704
v_mov_b32 v2, 268435456
v_cmp_eq_u32 vcc, 65, v0
v_mov_b32 v33, s65
s_nop 0
v_cndmask_b32 v33, v2, v33, vcc
v_cndmask_b32 v36, 0, 16, vcc
v_cmp_eq_u32 vcc, 64, v0
v_mov_b32 v32, s64
s_nop 0
v_cndmask_b32 v33, v33, v32, vcc
v_mov_b32 v32, s62
v_cndmask_b32 v32, v2, v32, vcc
v_cndmask_b32 v34, v2, 0, vcc
v_cndmask_b32 v35, 0, 1, vcc
v_cndmask_b32 v36, v36, 16, vcc
v_lshrrev_b32 v2, 4, v1
v_lshlrev_b32 v2, 2, v2
v_and_b32 v13, 15, v1
v_sub_u32 v2, v13, v2
v_mov_b32 v13, 0xff61b1e6
v_subrev_u32 v54, 0, v2
v_cmp_gt_u32 vcc, 8, v54
s_nop 1
v_cndmask_b32 v50, v13, 0, vcc
v_cmp_gt_i32 vcc, -8, v54
s_nop 1
v_cndmask_b32 v46, v13, 0, vcc
v_subrev_u32 v54, 1, v2
v_cmp_gt_u32 vcc, 8, v54
s_nop 1
v_cndmask_b32 v51, v13, 0, vcc
v_cmp_gt_i32 vcc, -8, v54
s_nop 1
v_cndmask_b32 v47, v13, 0, vcc
v_subrev_u32 v54, 2, v2
v_cmp_gt_u32 vcc, 8, v54
s_nop 1
v_cndmask_b32 v52, v13, 0, vcc
v_cmp_gt_i32 vcc, -8, v54
s_nop 1
v_cndmask_b32 v48, v13, 0, vcc
v_subrev_u32 v54, 3, v2
v_cmp_gt_u32 vcc, 8, v54
s_nop 1
v_cndmask_b32 v53, v13, 0, vcc
v_cmp_gt_i32 vcc, -8, v54
s_nop 1
v_cndmask_b32 v49, v13, 0, vcc
s_cmp_lt_u32 s8, 2
s_cselect_b64 vcc, -1, 0
v_cndmask_b32 v54, v46, v13, vcc
v_cndmask_b32 v55, v47, v13, vcc
v_cndmask_b32 v56, v48, v13, vcc
v_cndmask_b32 v57, v49, v13, vcc
s_mov_b32 s75, 29360128
v_and_b32 v10, 15, v1
v_lshlrev_b32 v12, 2, v10
v_lshlrev_b32 v10, 4, v10
v_add_u32 v10, 152576, v10
v_lshrrev_b32 v11, 4, v1
v_lshlrev_b32 v11, 4, v11
s_lshl_b32 s62, s49, 7
s_add_u32 s62, s62, 158720
v_add_u32 v12, s62, v12
v_add_u32 v13, s62, v11
v_add_u32 v11, 156672, v11
s_lshl_b32 s62, s3, 11
s_add_u32 s62, s62, 143360
v_lshl_add_u32 v8, v1, 4, s62
v_xor_b32 v9, 2048, v8
v_mov_b32 v248, 0x3f803f80
v_mov_b32 v249, 0x3f803f80
v_mov_b32 v250, 0x3f803f80
v_mov_b32 v251, 0x3f803f80
s_mul_i32 s62, s3, 18496
s_add_u32 s62, s62, 18432
v_mov_b32 v2, s62
ds_write_b128 v2, v[248:251]
v_and_b32 v7, 31, v1
v_lshrrev_b32 v2, 5, v1
v_lshl_add_u32 v7, v7, 1, v2
v_and_b32 v2, 0xc0, v0
v_add_u32 v7, v7, v2
v_lshlrev_b32 v17, 2, v7
v_add_u32 v17, 156672, v17
v_lshlrev_b32 v7, 4, v7
v_add_u32 v7, 152576, v7
s_lshl_b32 s74, s9, 1
s_add_u32 s74, s74, s49
s_lshl_b32 s74, s74, 17
s_lshl_b32 s63, s8, 13
s_add_u32 s74, s74, s63
s_lshl_b32 s63, s48, 12
s_add_u32 s74, s74, s63
s_add_u32 s74, s74, 4194304
s_mov_b32 s62, 0
v_lshl_add_u32 v4, v1, 4, s62
s_nop 1
s_cmp_eq_u32 s48, 1
s_cbranch_scc1 .Lqkv2
s_add_u32 m0, s55, 0
s_nop 0
buffer_load_dwordx4 v21, s[36:39], s52 offen lds
buffer_load_dwordx4 v28, s[36:39], s52 offen offset:1024 lds
buffer_load_dword v22, s[36:39], s52 offen offset:2048 lds
s_add_u32 s52, s52, 128
s_add_u32 m0, s55, 2304
s_nop 0
buffer_load_dwordx4 v21, s[36:39], s53 offen lds
buffer_load_dwordx4 v28, s[36:39], s53 offen offset:1024 lds
buffer_load_dword v29, s[36:39], s53 offen offset:2048 lds
s_add_u32 s53, s53, 128
s_add_u32 m0, s56, 123648
s_nop 0
buffer_load_dwordx4 v18, s[20:23], s54 offen lds
buffer_load_dwordx4 v19, s[20:23], s54 offen offset:1024 lds
buffer_load_dwordx4 v20, s[20:23], s54 offen offset:2048 lds
s_add_u32 s54, s54, 196608
s_add_u32 m0, s56, 136064
s_nop 0
buffer_load_dwordx4 v18, s[20:23], s54 offen lds
buffer_load_dwordx4 v19, s[20:23], s54 offen offset:1024 lds
buffer_load_dwordx4 v20, s[20:23], s54 offen offset:2048 lds
s_add_u32 s54, s54, 196608
s_waitcnt vmcnt(12)
s_cmp_eq_u32 s14, 3
s_cselect_b32 s62, 0, 4096
v_mov_b32 v154, 1
v_lshlrev_b32 v155, 8, v1
v_permlane16_swap_b32 v128, v130
v_permlane16_swap_b32 v129, v131
v_permlane16_swap_b32 v132, v134
v_permlane16_swap_b32 v133, v135
v_permlane16_swap_b32 v136, v138
v_permlane16_swap_b32 v137, v139
v_permlane16_swap_b32 v140, v142
v_permlane16_swap_b32 v141, v143
buffer_store_dword v154, v155, s[40:43], s62 offen sc1
v_lshlrev_b32 v64, 16, v128
v_and_b32 v65, 0xffff0000, v128
v_lshlrev_b32 v66, 16, v129
v_and_b32 v67, 0xffff0000, v129
v_lshlrev_b32 v68, 16, v130
v_and_b32 v69, 0xffff0000, v130
v_lshlrev_b32 v70, 16, v131
v_and_b32 v71, 0xffff0000, v131
v_lshlrev_b32 v72, 16, v132
v_and_b32 v73, 0xffff0000, v132
v_lshlrev_b32 v74, 16, v133
v_and_b32 v75, 0xffff0000, v133
v_lshlrev_b32 v76, 16, v134
v_and_b32 v77, 0xffff0000, v134
v_lshlrev_b32 v78, 16, v135
v_and_b32 v79, 0xffff0000, v135
v_lshlrev_b32 v80, 16, v136
v_and_b32 v81, 0xffff0000, v136
v_lshlrev_b32 v82, 16, v137
v_and_b32 v83, 0xffff0000, v137
v_lshlrev_b32 v84, 16, v138
v_and_b32 v85, 0xffff0000, v138
v_lshlrev_b32 v86, 16, v139
v_and_b32 v87, 0xffff0000, v139
v_lshlrev_b32 v88, 16, v140
v_and_b32 v89, 0xffff0000, v140
v_lshlrev_b32 v90, 16, v141
v_and_b32 v91, 0xffff0000, v141
v_lshlrev_b32 v92, 16, v142
v_and_b32 v93, 0xffff0000, v142
v_lshlrev_b32 v94, 16, v143
v_and_b32 v95, 0xffff0000, v143
s_lshl_b32 s64, s6, 14
s_lshl_b32 s65, s49, 13
s_add_u32 s64, s64, s65
s_lshl_b32 s65, s7, 9
s_add_u32 s64, s64, s65
s_lshl_b32 s65, s48, 8
s_add_u32 s64, s64, s65
s_add_u32 s64, s64, 29360128
v_and_b32 v152, 31, v1
v_lshlrev_b32 v152, 3, v152
v_lshrrev_b32 v153, 5, v1
v_lshl_add_u32 v152, v153, 28, v152
s_lshl_b32 s62, s7, 18
s_add_u32 s62, s62, 0
s_add_u32 s63, s62, 0x20000
v_pk_mul_f32 v[146:147], v[64:65], v[64:65]
v_pk_mul_f32 v[150:151], v[80:81], v[80:81]
v_pk_fma_f32 v[146:147], v[66:67], v[66:67], v[146:147]
v_pk_add_f32 v[144:145], v[64:65], v[66:67]
v_pk_fma_f32 v[150:151], v[82:83], v[82:83], v[150:151]
v_pk_add_f32 v[148:149], v[80:81], v[82:83]
v_pk_fma_f32 v[146:147], v[68:69], v[68:69], v[146:147]
v_pk_add_f32 v[144:145], v[144:145], v[68:69]
v_pk_fma_f32 v[150:151], v[84:85], v[84:85], v[150:151]
v_pk_add_f32 v[148:149], v[148:149], v[84:85]
v_pk_fma_f32 v[146:147], v[70:71], v[70:71], v[146:147]
v_pk_add_f32 v[144:145], v[144:145], v[70:71]
v_pk_fma_f32 v[150:151], v[86:87], v[86:87], v[150:151]
v_pk_add_f32 v[148:149], v[148:149], v[86:87]
v_pk_fma_f32 v[146:147], v[72:73], v[72:73], v[146:147]
v_pk_add_f32 v[144:145], v[144:145], v[72:73]
v_pk_fma_f32 v[150:151], v[88:89], v[88:89], v[150:151]
v_pk_add_f32 v[148:149], v[148:149], v[88:89]
v_pk_fma_f32 v[146:147], v[74:75], v[74:75], v[146:147]
v_pk_add_f32 v[144:145], v[144:145], v[74:75]
v_pk_fma_f32 v[150:151], v[90:91], v[90:91], v[150:151]
v_pk_add_f32 v[148:149], v[148:149], v[90:91]
v_pk_fma_f32 v[146:147], v[76:77], v[76:77], v[146:147]
v_pk_add_f32 v[144:145], v[144:145], v[76:77]
v_pk_fma_f32 v[150:151], v[92:93], v[92:93], v[150:151]
v_pk_add_f32 v[148:149], v[148:149], v[92:93]
v_pk_fma_f32 v[146:147], v[78:79], v[78:79], v[146:147]
v_pk_add_f32 v[144:145], v[144:145], v[78:79]
v_pk_fma_f32 v[150:151], v[94:95], v[94:95], v[150:151]
v_pk_add_f32 v[148:149], v[148:149], v[94:95]
v_add_f32 v144, v144, v145
v_add_f32 v146, v146, v147
v_add_f32 v148, v148, v149
v_add_f32 v150, v150, v151
s_nop 0
v_permlane16_swap_b32 v144, v148
v_permlane16_swap_b32 v146, v150
v_add_f32 v144, v144, v148
v_add_f32 v146, v146, v150
s_nop 1
v_permlane32_swap_b32 v144, v146
v_add_f32 v144, v144, v146
s_nop 1
v_permlane32_swap_b32 v144, v145
buffer_store_dwordx2 v[144:145], v152, s[16:19], s64 offen sc1
s_lshl_b32 s62, s2, 10
s_add_u32 s62, s62, 31457280
s_cmp_eq_u32 s3, 0
s_cselect_b32 s62, s62, 268435456
buffer_store_dwordx4 v[156:159], v27, s[16:19], s62 offen sc1
v_accvgpr_write_b32 a224, v64
v_accvgpr_write_b32 a225, v65
v_accvgpr_write_b32 a226, v66
v_accvgpr_write_b32 a227, v67
v_accvgpr_write_b32 a228, v68
v_accvgpr_write_b32 a229, v69
v_accvgpr_write_b32 a230, v70
v_accvgpr_write_b32 a231, v71
v_accvgpr_write_b32 a232, v72
v_accvgpr_write_b32 a233, v73
v_accvgpr_write_b32 a234, v74
v_accvgpr_write_b32 a235, v75
v_accvgpr_write_b32 a236, v76
v_accvgpr_write_b32 a237, v77
v_accvgpr_write_b32 a238, v78
v_accvgpr_write_b32 a239, v79
v_accvgpr_write_b32 a240, v80
v_accvgpr_write_b32 a241, v81
v_accvgpr_write_b32 a242, v82
v_accvgpr_write_b32 a243, v83
v_accvgpr_write_b32 a244, v84
v_accvgpr_write_b32 a245, v85
v_accvgpr_write_b32 a246, v86
v_accvgpr_write_b32 a247, v87
v_accvgpr_write_b32 a248, v88
v_accvgpr_write_b32 a249, v89
v_accvgpr_write_b32 a250, v90
v_accvgpr_write_b32 a251, v91
v_accvgpr_write_b32 a252, v92
v_accvgpr_write_b32 a253, v93
v_accvgpr_write_b32 a254, v94
v_accvgpr_write_b32 a255, v95
s_add_u32 m0, s55, 18496
s_nop 0
buffer_load_dwordx4 v21, s[36:39], s52 offen lds
buffer_load_dwordx4 v28, s[36:39], s52 offen offset:1024 lds
buffer_load_dword v22, s[36:39], s52 offen offset:2048 lds
s_add_u32 s52, s52, 128
s_add_u32 m0, s55, 20800
s_nop 0
buffer_load_dwordx4 v21, s[36:39], s53 offen lds
buffer_load_dwordx4 v28, s[36:39], s53 offen offset:1024 lds
buffer_load_dword v29, s[36:39], s53 offen offset:2048 lds
s_add_u32 s53, s53, 128
s_add_u32 m0, s56, 73984
s_nop 0
buffer_load_dwordx4 v18, s[20:23], s54 offen lds
buffer_load_dwordx4 v19, s[20:23], s54 offen offset:1024 lds
buffer_load_dwordx4 v20, s[20:23], s54 offen offset:2048 lds
s_add_u32 s54, s54, 196608
s_waitcnt vmcnt(15) lgkmcnt(0)
s_barrier
ds_read_b128 a[0:3], v23
ds_read_b128 a[4:7], v23 offset:2304
ds_read_b128 a[8:11], v23 offset:4608
ds_read_b128 a[12:15], v23 offset:6912
ds_read_b64_tr_b16 a[20:21], v25 offset:49664
ds_read_b64_tr_b16 a[22:23], v25 offset:50176
ds_read_b64_tr_b16 a[24:25], v25 offset:49696
ds_read_b64_tr_b16 a[26:27], v25 offset:50208
ds_read_b128 a[16:19], v24
ds_read_b64_tr_b16 a[28:29], v25 offset:50688
ds_read_b64_tr_b16 a[30:31], v25 offset:51200
ds_read_b64_tr_b16 a[32:33], v25 offset:50720
ds_read_b64_tr_b16 a[34:35], v25 offset:51232
ds_read_b64_tr_b16 a[36:37], v25 offset:51712
ds_read_b64_tr_b16 a[38:39], v25 offset:52224
ds_read_b64_tr_b16 a[40:41], v25 offset:51744
ds_read_b64_tr_b16 a[42:43], v25 offset:52256
s_waitcnt vmcnt(12) lgkmcnt(8)
s_barrier
v_mfma_f32_16x16x32_bf16 v[60:63], a[20:23], a[0:3], 0
ds_read_b128 a[44:47], v30
s_add_u32 m0, s56, 86400
v_mfma_f32_16x16x32_bf16 v[76:79], a[24:27], a[0:3], 0
buffer_load_dwordx4 v18, s[20:23], s54 offen lds
v_mfma_f32_16x16x32_bf16 v[80:83], a[24:27], a[4:7], 0
s_sub_u32 s47, s47, 1
s_cbranch_scc1 .Lx4
.Lx4b:
v_mfma_f32_16x16x32_bf16 v[64:67], a[20:23], a[4:7], 0
buffer_load_dwordx4 v19, s[20:23], s54 offen offset:1024 lds
v_mfma_f32_16x16x32_bf16 v[68:71], a[20:23], a[8:11], 0
ds_read_b128 a[48:51], v30 offset:2304
v_mfma_f32_16x16x32_bf16 v[84:87], a[24:27], a[8:11], 0
ds_read_b128 a[52:55], v30 offset:4608
ds_read_b128 a[56:59], v30 offset:6912
v_mfma_f32_16x16x32_bf16 v[88:91], a[24:27], a[12:15], 0
buffer_load_dwordx4 v20, s[20:23], s54 offen offset:2048 lds
v_mfma_f32_16x16x32_bf16 v[72:75], a[20:23], a[12:15], 0
s_add_u32 s54, s54, 196608
s_waitcnt lgkmcnt(4)
v_mfma_f32_16x16x32_bf16 v[244:247], a[20:23], a[16:19], 0
ds_read_b64_tr_b16 a[64:65], v25 offset:62080
s_add_u32 m0, s55, 36992
v_mfma_f32_16x16x32_bf16 v[104:107], a[28:31], a[12:15], 0
buffer_load_dwordx4 v21, s[36:39], s52 offen lds
v_mfma_f32_16x16x32_bf16 v[120:123], a[32:35], a[12:15], 0
ds_read_b64_tr_b16 a[66:67], v25 offset:62592
v_mfma_f32_16x16x32_bf16 v[116:119], a[32:35], a[8:11], 0
ds_read_b64_tr_b16 a[68:69], v25 offset:62112
ds_read_b64_tr_b16 a[70:71], v25 offset:62624
v_mfma_f32_16x16x32_bf16 v[100:103], a[28:31], a[8:11], 0
buffer_load_dwordx4 v28, s[36:39], s52 offen offset:1024 lds
v_mfma_f32_16x16x32_bf16 v[96:99], a[28:31], a[4:7], 0
ds_read_b128 a[60:63], v31
v_mfma_f32_16x16x32_bf16 v[112:115], a[32:35], a[4:7], 0
buffer_load_dword v22, s[36:39], s52 offen offset:2048 lds
v_mfma_f32_16x16x32_bf16 v[108:111], a[32:35], a[0:3], 0
ds_read_b64_tr_b16 a[72:73], v25 offset:63104
s_add_u32 s52, s52, 128
v_mfma_f32_16x16x32_bf16 v[92:95], a[28:31], a[0:3], 0
s_add_u32 m0, s55, 39296
v_mfma_f32_16x16x32_bf16 v[156:159], a[28:31], a[16:19], 0
buffer_load_dwordx4 v21, s[36:39], s53 offen lds
v_mfma_f32_16x16x32_bf16 v[160:163], a[32:35], a[16:19], 0
ds_read_b64_tr_b16 a[74:75], v25 offset:63616
ds_read_b64_tr_b16 a[76:77], v25 offset:63136
v_mfma_f32_16x16x32_bf16 v[124:127], a[0:3], a[36:39], 0
ds_read_b64_tr_b16 a[78:79], v25 offset:63648
v_mfma_f32_16x16x32_bf16 v[140:143], a[0:3], a[40:43], 0
buffer_load_dwordx4 v28, s[36:39], s53 offen offset:1024 lds
v_mfma_f32_16x16x32_bf16 v[144:147], a[4:7], a[40:43], 0
ds_read_b64_tr_b16 a[80:81], v25 offset:64128
v_mfma_f32_16x16x32_bf16 v[128:131], a[4:7], a[36:39], 0
ds_read_b64_tr_b16 a[82:83], v25 offset:64640
ds_read_b64_tr_b16 a[84:85], v25 offset:64160
v_mfma_f32_16x16x32_bf16 v[132:135], a[8:11], a[36:39], 0
buffer_load_dword v29, s[36:39], s53 offen offset:2048 lds
v_mfma_f32_16x16x32_bf16 v[148:151], a[8:11], a[40:43], 0
s_add_u32 s53, s53, 128
v_mfma_f32_16x16x32_bf16 v[152:155], a[12:15], a[40:43], 0
ds_read_b64_tr_b16 a[86:87], v25 offset:64672
v_mfma_f32_16x16x32_bf16 v[136:139], a[12:15], a[36:39], 0
s_waitcnt vmcnt(9) lgkmcnt(8)
s_barrier
v_mfma_f32_16x16x32_bf16 v[60:63], a[64:67], a[44:47], v[60:63]
ds_read_b128 a[0:3], v23 offset:18496
s_add_u32 m0, s56, 98816
v_mfma_f32_16x16x32_bf16 v[76:79], a[68:71], a[44:47], v[76:79]
buffer_load_dwordx4 v18, s[20:23], s54 offen lds
v_mfma_f32_16x16x32_bf16 v[80:83], a[68:71], a[48:51], v[80:83]
ds_read_b128 a[4:7], v23 offset:20800
v_mfma_f32_16x16x32_bf16 v[64:67], a[64:67], a[48:51], v[64:67]
buffer_load_dwordx4 v19, s[20:23], s54 offen offset:1024 lds
v_mfma_f32_16x16x32_bf16 v[68:71], a[64:67], a[52:55], v[68:71]
ds_read_b128 a[8:11], v23 offset:23104
ds_read_b128 a[12:15], v23 offset:25408
v_mfma_f32_16x16x32_bf16 v[84:87], a[68:71], a[52:55], v[84:87]
ds_read_b64_tr_b16 a[20:21], v25
v_mfma_f32_16x16x32_bf16 v[88:91], a[68:71], a[56:59], v[88:91]
buffer_load_dwordx4 v20, s[20:23], s54 offen offset:2048 lds
v_mfma_f32_16x16x32_bf16 v[72:75], a[64:67], a[56:59], v[72:75]
s_add_u32 s54, s54, 196608
s_waitcnt lgkmcnt(5)
v_mfma_f32_16x16x32_bf16 v[244:247], a[64:67], a[60:63], v[244:247]
ds_read_b64_tr_b16 a[22:23], v25 offset:512
s_add_u32 m0, s56, 111232
v_mfma_f32_16x16x32_bf16 v[104:107], a[72:75], a[56:59], v[104:107]
buffer_load_dwordx4 v18, s[20:23], s54 offen lds
v_mfma_f32_16x16x32_bf16 v[120:123], a[76:79], a[56:59], v[120:123]
ds_read_b64_tr_b16 a[24:25], v25 offset:32
v_mfma_f32_16x16x32_bf16 v[116:119], a[76:79], a[52:55], v[116:119]
ds_read_b64_tr_b16 a[26:27], v25 offset:544
v_mfma_f32_16x16x32_bf16 v[100:103], a[72:75], a[52:55], v[100:103]
buffer_load_dwordx4 v19, s[20:23], s54 offen offset:1024 lds
v_mfma_f32_16x16x32_bf16 v[96:99], a[72:75], a[48:51], v[96:99]
ds_read_b128 a[16:19], v24 offset:18496
ds_read_b64_tr_b16 a[28:29], v25 offset:1024
v_mfma_f32_16x16x32_bf16 v[112:115], a[76:79], a[48:51], v[112:115]
buffer_load_dwordx4 v20, s[20:23], s54 offen offset:2048 lds
v_mfma_f32_16x16x32_bf16 v[108:111], a[76:79], a[44:47], v[108:111]
s_add_u32 s54, s54, 196608
v_mfma_f32_16x16x32_bf16 v[92:95], a[72:75], a[44:47], v[92:95]
ds_read_b64_tr_b16 a[30:31], v25 offset:1536
s_add_u32 m0, s55, 55488
v_mfma_f32_16x16x32_bf16 v[156:159], a[72:75], a[60:63], v[156:159]
buffer_load_dwordx4 v21, s[36:39], s52 offen lds
v_mfma_f32_16x16x32_bf16 v[160:163], a[76:79], a[60:63], v[160:163]
ds_read_b64_tr_b16 a[32:33], v25 offset:1056
v_mfma_f32_16x16x32_bf16 v[124:127], a[44:47], a[80:83], v[124:127]
ds_read_b64_tr_b16 a[34:35], v25 offset:1568
v_mfma_f32_16x16x32_bf16 v[140:143], a[44:47], a[84:87], v[140:143]
buffer_load_dwordx4 v28, s[36:39], s52 offen offset:1024 lds
v_mfma_f32_16x16x32_bf16 v[144:147], a[48:51], a[84:87], v[144:147]
ds_read_b64_tr_b16 a[36:37], v25 offset:2048
v_mfma_f32_16x16x32_bf16 v[128:131], a[48:51], a[80:83], v[128:131]
ds_read_b64_tr_b16 a[38:39], v25 offset:2560
ds_read_b64_tr_b16 a[40:41], v25 offset:2080
v_mfma_f32_16x16x32_bf16 v[132:135], a[52:55], a[80:83], v[132:135]
buffer_load_dword v22, s[36:39], s52 offen offset:2048 lds
v_mfma_f32_16x16x32_bf16 v[148:151], a[52:55], a[84:87], v[148:151]
s_add_u32 s52, s52, 128
v_mfma_f32_16x16x32_bf16 v[152:155], a[56:59], a[84:87], v[152:155]
ds_read_b64_tr_b16 a[42:43], v25 offset:2592
v_mfma_f32_16x16x32_bf16 v[136:139], a[56:59], a[80:83], v[136:139]
s_waitcnt vmcnt(15) lgkmcnt(8)
s_barrier
v_mfma_f32_16x16x32_bf16 v[60:63], a[20:23], a[0:3], v[60:63]
ds_read_b128 a[44:47], v30 offset:18496
s_add_u32 m0, s55, 57792
v_mfma_f32_16x16x32_bf16 v[76:79], a[24:27], a[0:3], v[76:79]
buffer_load_dwordx4 v21, s[36:39], s53 offen lds
v_mfma_f32_16x16x32_bf16 v[80:83], a[24:27], a[4:7], v[80:83]
s_sub_u32 s47, s47, 1
s_cbranch_scc1 .Lx5
.Lx5b:
v_mfma_f32_16x16x32_bf16 v[64:67], a[20:23], a[4:7], v[64:67]
buffer_load_dwordx4 v28, s[36:39], s53 offen offset:1024 lds
v_mfma_f32_16x16x32_bf16 v[68:71], a[20:23], a[8:11], v[68:71]
ds_read_b128 a[48:51], v30 offset:20800
v_mfma_f32_16x16x32_bf16 v[84:87], a[24:27], a[8:11], v[84:87]
ds_read_b128 a[52:55], v30 offset:23104
ds_read_b128 a[56:59], v30 offset:25408
v_mfma_f32_16x16x32_bf16 v[88:91], a[24:27], a[12:15], v[88:91]
buffer_load_dword v29, s[36:39], s53 offen offset:2048 lds
v_mfma_f32_16x16x32_bf16 v[72:75], a[20:23], a[12:15], v[72:75]
s_add_u32 s53, s53, 128
s_waitcnt lgkmcnt(4)
v_mfma_f32_16x16x32_bf16 v[244:247], a[20:23], a[16:19], v[244:247]
ds_read_b64_tr_b16 a[64:65], v25 offset:12416
s_add_u32 m0, s56, 123648
v_mfma_f32_16x16x32_bf16 v[104:107], a[28:31], a[12:15], v[104:107]
buffer_load_dwordx4 v18, s[20:23], s54 offen lds
v_mfma_f32_16x16x32_bf16 v[120:123], a[32:35], a[12:15], v[120:123]
ds_read_b64_tr_b16 a[66:67], v25 offset:12928
v_mfma_f32_16x16x32_bf16 v[116:119], a[32:35], a[8:11], v[116:119]
ds_read_b64_tr_b16 a[68:69], v25 offset:12448
ds_read_b64_tr_b16 a[70:71], v25 offset:12960
v_mfma_f32_16x16x32_bf16 v[100:103], a[28:31], a[8:11], v[100:103]
buffer_load_dwordx4 v19, s[20:23], s54 offen offset:1024 lds
v_mfma_f32_16x16x32_bf16 v[96:99], a[28:31], a[4:7], v[96:99]
ds_read_b128 a[60:63], v31 offset:18496
v_mfma_f32_16x16x32_bf16 v[112:115], a[32:35], a[4:7], v[112:115]
buffer_load_dwordx4 v20, s[20:23], s54 offen offset:2048 lds
v_mfma_f32_16x16x32_bf16 v[108:111], a[32:35], a[0:3], v[108:111]
ds_read_b64_tr_b16 a[72:73], v25 offset:13440
s_add_u32 s54, s54, 196608
v_mfma_f32_16x16x32_bf16 v[92:95], a[28:31], a[0:3], v[92:95]
s_add_u32 m0, s56, 136064
v_mfma_f32_16x16x32_bf16 v[156:159], a[28:31], a[16:19], v[156:159]
buffer_load_dwordx4 v18, s[20:23], s54 offen lds
v_mfma_f32_16x16x32_bf16 v[160:163], a[32:35], a[16:19], v[160:163]
ds_read_b64_tr_b16 a[74:75], v25 offset:13952
ds_read_b64_tr_b16 a[76:77], v25 offset:13472
v_mfma_f32_16x16x32_bf16 v[124:127], a[0:3], a[36:39], v[124:127]
ds_read_b64_tr_b16 a[78:79], v25 offset:13984
v_mfma_f32_16x16x32_bf16 v[140:143], a[0:3], a[40:43], v[140:143]
buffer_load_dwordx4 v19, s[20:23], s54 offen offset:1024 lds
v_mfma_f32_16x16x32_bf16 v[144:147], a[4:7], a[40:43], v[144:147]
ds_read_b64_tr_b16 a[80:81], v25 offset:14464
v_mfma_f32_16x16x32_bf16 v[128:131], a[4:7], a[36:39], v[128:131]
ds_read_b64_tr_b16 a[82:83], v25 offset:14976
ds_read_b64_tr_b16 a[84:85], v25 offset:14496
v_mfma_f32_16x16x32_bf16 v[132:135], a[8:11], a[36:39], v[132:135]
buffer_load_dwordx4 v20, s[20:23], s54 offen offset:2048 lds
v_mfma_f32_16x16x32_bf16 v[148:151], a[8:11], a[40:43], v[148:151]
s_add_u32 s54, s54, 196608
v_mfma_f32_16x16x32_bf16 v[152:155], a[12:15], a[40:43], v[152:155]
ds_read_b64_tr_b16 a[86:87], v25 offset:15008
v_mfma_f32_16x16x32_bf16 v[136:139], a[12:15], a[36:39], v[136:139]
s_waitcnt vmcnt(15) lgkmcnt(8)
s_barrier
v_mfma_f32_16x16x32_bf16 v[60:63], a[64:67], a[44:47], v[60:63]
ds_read_b128 a[0:3], v23 offset:36992
s_add_u32 m0, s55, 0
v_mfma_f32_16x16x32_bf16 v[76:79], a[68:71], a[44:47], v[76:79]
buffer_load_dwordx4 v21, s[36:39], s52 offen lds
v_mfma_f32_16x16x32_bf16 v[80:83], a[68:71], a[48:51], v[80:83]
ds_read_b128 a[4:7], v23 offset:39296
v_mfma_f32_16x16x32_bf16 v[64:67], a[64:67], a[48:51], v[64:67]
buffer_load_dwordx4 v28, s[36:39], s52 offen offset:1024 lds
v_mfma_f32_16x16x32_bf16 v[68:71], a[64:67], a[52:55], v[68:71]
ds_read_b128 a[8:11], v23 offset:41600
ds_read_b128 a[12:15], v23 offset:43904
v_mfma_f32_16x16x32_bf16 v[84:87], a[68:71], a[52:55], v[84:87]
ds_read_b64_tr_b16 a[20:21], v25 offset:24832
v_mfma_f32_16x16x32_bf16 v[88:91], a[68:71], a[56:59], v[88:91]
buffer_load_dword v22, s[36:39], s52 offen offset:2048 lds
v_mfma_f32_16x16x32_bf16 v[72:75], a[64:67], a[56:59], v[72:75]
s_add_u32 s52, s52, 128
s_add_u32 m0, s55, 2304
s_waitcnt lgkmcnt(5)
v_mfma_f32_16x16x32_bf16 v[244:247], a[64:67], a[60:63], v[244:247]
buffer_load_dwordx4 v21, s[36:39], s53 offen lds
v_mfma_f32_16x16x32_bf16 v[104:107], a[72:75], a[56:59], v[104:107]
ds_read_b64_tr_b16 a[22:23], v25 offset:25344
v_mfma_f32_16x16x32_bf16 v[120:123], a[76:79], a[56:59], v[120:123]
ds_read_b64_tr_b16 a[24:25], v25 offset:24864
ds_read_b64_tr_b16 a[26:27], v25 offset:25376
v_mfma_f32_16x16x32_bf16 v[116:119], a[76:79], a[52:55], v[116:119]
buffer_load_dwordx4 v28, s[36:39], s53 offen offset:1024 lds
v_mfma_f32_16x16x32_bf16 v[100:103], a[72:75], a[52:55], v[100:103]
ds_read_b128 a[16:19], v24 offset:36992
v_mfma_f32_16x16x32_bf16 v[96:99], a[72:75], a[48:51], v[96:99]
buffer_load_dword v29, s[36:39], s53 offen offset:2048 lds
v_mfma_f32_16x16x32_bf16 v[112:115], a[76:79], a[48:51], v[112:115]
ds_read_b64_tr_b16 a[28:29], v25 offset:25856
s_add_u32 s53, s53, 128
v_mfma_f32_16x16x32_bf16 v[108:111], a[76:79], a[44:47], v[108:111]
s_add_u32 m0, s56, 73984
v_mfma_f32_16x16x32_bf16 v[92:95], a[72:75], a[44:47], v[92:95]
buffer_load_dwordx4 v18, s[20:23], s54 offen lds
v_mfma_f32_16x16x32_bf16 v[156:159], a[72:75], a[60:63], v[156:159]
ds_read_b64_tr_b16 a[30:31], v25 offset:26368
ds_read_b64_tr_b16 a[32:33], v25 offset:25888
v_mfma_f32_16x16x32_bf16 v[160:163], a[76:79], a[60:63], v[160:163]
buffer_load_dwordx4 v19, s[20:23], s54 offen offset:1024 lds
v_mfma_f32_16x16x32_bf16 v[124:127], a[44:47], a[80:83], v[124:127]
ds_read_b64_tr_b16 a[34:35], v25 offset:26400
v_mfma_f32_16x16x32_bf16 v[140:143], a[44:47], a[84:87], v[140:143]
ds_read_b64_tr_b16 a[36:37], v25 offset:26880
v_mfma_f32_16x16x32_bf16 v[144:147], a[48:51], a[84:87], v[144:147]
buffer_load_dwordx4 v20, s[20:23], s54 offen offset:2048 lds
v_mfma_f32_16x16x32_bf16 v[128:131], a[48:51], a[80:83], v[128:131]
ds_read_b64_tr_b16 a[38:39], v25 offset:27392
s_add_u32 s54, s54, 196608
v_mfma_f32_16x16x32_bf16 v[132:135], a[52:55], a[80:83], v[132:135]
buffer_load_dword v37, v34, s[40:43], 0 offen sc1
v_mfma_f32_16x16x32_bf16 v[148:151], a[52:55], a[84:87], v[148:151]
ds_read_b64_tr_b16 a[40:41], v25 offset:26912
v_mfma_f32_16x16x32_bf16 v[152:155], a[56:59], a[84:87], v[152:155]
ds_read_b64_tr_b16 a[42:43], v25 offset:27424
v_mfma_f32_16x16x32_bf16 v[136:139], a[56:59], a[80:83], v[136:139]
s_waitcnt vmcnt(22) lgkmcnt(8)
s_barrier
v_mfma_f32_16x16x32_bf16 v[60:63], a[20:23], a[0:3], v[60:63]
ds_read_b128 a[44:47], v30 offset:36992
s_add_u32 m0, s56, 86400
v_mfma_f32_16x16x32_bf16 v[76:79], a[24:27], a[0:3], v[76:79]
buffer_load_dwordx4 v18, s[20:23], s54 offen lds
v_mfma_f32_16x16x32_bf16 v[80:83], a[24:27], a[4:7], v[80:83]
s_sub_u32 s47, s47, 1
s_cbranch_scc1 .Lx6
.Lx6b:
v_mfma_f32_16x16x32_bf16 v[64:67], a[20:23], a[4:7], v[64:67]
buffer_load_dwordx4 v19, s[20:23], s54 offen offset:1024 lds
v_mfma_f32_16x16x32_bf16 v[68:71], a[20:23], a[8:11], v[68:71]
ds_read_b128 a[48:51], v30 offset:39296
v_mfma_f32_16x16x32_bf16 v[84:87], a[24:27], a[8:11], v[84:87]
ds_read_b128 a[52:55], v30 offset:41600
ds_read_b128 a[56:59], v30 offset:43904
v_mfma_f32_16x16x32_bf16 v[88:91], a[24:27], a[12:15], v[88:91]
buffer_load_dwordx4 v20, s[20:23], s54 offen offset:2048 lds
v_mfma_f32_16x16x32_bf16 v[72:75], a[20:23], a[12:15], v[72:75]
s_add_u32 s54, s54, 196608
s_waitcnt lgkmcnt(4)
v_mfma_f32_16x16x32_bf16 v[244:247], a[20:23], a[16:19], v[244:247]
ds_read_b64_tr_b16 a[64:65], v25 offset:37248
s_add_u32 m0, s55, 18496
v_mfma_f32_16x16x32_bf16 v[104:107], a[28:31], a[12:15], v[104:107]
buffer_load_dwordx4 v21, s[36:39], s52 offen lds
v_mfma_f32_16x16x32_bf16 v[120:123], a[32:35], a[12:15], v[120:123]
ds_read_b64_tr_b16 a[66:67], v25 offset:37760
v_mfma_f32_16x16x32_bf16 v[116:119], a[32:35], a[8:11], v[116:119]
ds_read_b64_tr_b16 a[68:69], v25 offset:37280
ds_read_b64_tr_b16 a[70:71], v25 offset:37792
v_mfma_f32_16x16x32_bf16 v[100:103], a[28:31], a[8:11], v[100:103]
buffer_load_dwordx4 v28, s[36:39], s52 offen offset:1024 lds
v_mfma_f32_16x16x32_bf16 v[96:99], a[28:31], a[4:7], v[96:99]
ds_read_b128 a[60:63], v31 offset:36992
v_mfma_f32_16x16x32_bf16 v[112:115], a[32:35], a[4:7], v[112:115]
buffer_load_dword v22, s[36:39], s52 offen offset:2048 lds
v_mfma_f32_16x16x32_bf16 v[108:111], a[32:35], a[0:3], v[108:111]
ds_read_b64_tr_b16 a[72:73], v25 offset:38272
s_add_u32 s52, s52, 128
v_mfma_f32_16x16x32_bf16 v[92:95], a[28:31], a[0:3], v[92:95]
s_add_u32 m0, s55, 20800
v_mfma_f32_16x16x32_bf16 v[156:159], a[28:31], a[16:19], v[156:159]
buffer_load_dwordx4 v21, s[36:39], s53 offen lds
v_mfma_f32_16x16x32_bf16 v[160:163], a[32:35], a[16:19], v[160:163]
ds_read_b64_tr_b16 a[74:75], v25 offset:38784
ds_read_b64_tr_b16 a[76:77], v25 offset:38304
v_mfma_f32_16x16x32_bf16 v[124:127], a[0:3], a[36:39], v[124:127]
ds_read_b64_tr_b16 a[78:79], v25 offset:38816
v_mfma_f32_16x16x32_bf16 v[140:143], a[0:3], a[40:43], v[140:143]
buffer_load_dwordx4 v28, s[36:39], s53 offen offset:1024 lds
v_mfma_f32_16x16x32_bf16 v[144:147], a[4:7], a[40:43], v[144:147]
ds_read_b64_tr_b16 a[80:81], v25 offset:39296
v_mfma_f32_16x16x32_bf16 v[128:131], a[4:7], a[36:39], v[128:131]
ds_read_b64_tr_b16 a[82:83], v25 offset:39808
ds_read_b64_tr_b16 a[84:85], v25 offset:39328
v_mfma_f32_16x16x32_bf16 v[132:135], a[8:11], a[36:39], v[132:135]
buffer_load_dword v29, s[36:39], s53 offen offset:2048 lds
v_mfma_f32_16x16x32_bf16 v[148:151], a[8:11], a[40:43], v[148:151]
s_add_u32 s53, s53, 128
v_mfma_f32_16x16x32_bf16 v[152:155], a[12:15], a[40:43], v[152:155]
ds_read_b64_tr_b16 a[86:87], v25 offset:39840
v_mfma_f32_16x16x32_bf16 v[136:139], a[12:15], a[36:39], v[136:139]
s_waitcnt vmcnt(22) lgkmcnt(8)
s_barrier
v_mfma_f32_16x16x32_bf16 v[60:63], a[64:67], a[44:47], v[60:63]
ds_read_b128 a[0:3], v23 offset:55488
s_add_u32 m0, s56, 98816
v_mfma_f32_16x16x32_bf16 v[76:79], a[68:71], a[44:47], v[76:79]
buffer_load_dwordx4 v18, s[20:23], s54 offen lds
v_mfma_f32_16x16x32_bf16 v[80:83], a[68:71], a[48:51], v[80:83]
ds_read_b128 a[4:7], v23 offset:57792
v_mfma_f32_16x16x32_bf16 v[64:67], a[64:67], a[48:51], v[64:67]
ds_read_b128 a[8:11], v23 offset:60096
v_mfma_f32_16x16x32_bf16 v[68:71], a[64:67], a[52:55], v[68:71]
ds_read_b128 a[12:15], v23 offset:62400
v_mfma_f32_16x16x32_bf16 v[84:87], a[68:71], a[52:55], v[84:87]
buffer_load_dwordx4 v19, s[20:23], s54 offen offset:1024 lds
v_mfma_f32_16x16x32_bf16 v[88:91], a[68:71], a[56:59], v[88:91]
ds_read_b64_tr_b16 a[20:21], v25 offset:49664
v_mfma_f32_16x16x32_bf16 v[72:75], a[64:67], a[56:59], v[72:75]
ds_read_b64_tr_b16 a[22:23], v25 offset:50176
s_waitcnt lgkmcnt(6)
v_mfma_f32_16x16x32_bf16 v[244:247], a[64:67], a[60:63], v[244:247]
v_mfma_f32_16x16x32_bf16 v[104:107], a[72:75], a[56:59], v[104:107]
buffer_load_dwordx4 v20, s[20:23], s54 offen offset:2048 lds
v_mfma_f32_16x16x32_bf16 v[120:123], a[76:79], a[56:59], v[120:123]
ds_read_b64_tr_b16 a[24:25], v25 offset:49696
s_add_u32 s54, s54, 196608
v_mfma_f32_16x16x32_bf16 v[116:119], a[76:79], a[52:55], v[116:119]
ds_read_b64_tr_b16 a[26:27], v25 offset:50208
v_mfma_f32_16x16x32_bf16 v[100:103], a[72:75], a[52:55], v[100:103]
ds_read_b128 a[16:19], v24 offset:55488
s_add_u32 m0, s55, 36992
v_mfma_f32_16x16x32_bf16 v[96:99], a[72:75], a[48:51], v[96:99]
buffer_load_dwordx4 v21, s[36:39], s52 offen lds
v_mfma_f32_16x16x32_bf16 v[112:115], a[76:79], a[48:51], v[112:115]
ds_read_b64_tr_b16 a[28:29], v25 offset:50688
v_mfma_f32_16x16x32_bf16 v[108:111], a[76:79], a[44:47], v[108:111]
ds_read_b64_tr_b16 a[30:31], v25 offset:51200
v_mfma_f32_16x16x32_bf16 v[92:95], a[72:75], a[44:47], v[92:95]
ds_read_b64_tr_b16 a[32:33], v25 offset:50720
v_mfma_f32_16x16x32_bf16 v[156:159], a[72:75], a[60:63], v[156:159]
buffer_load_dwordx4 v28, s[36:39], s52 offen offset:1024 lds
v_mfma_f32_16x16x32_bf16 v[160:163], a[76:79], a[60:63], v[160:163]
v_mfma_f32_16x16x32_bf16 v[124:127], a[44:47], a[80:83], v[124:127]
ds_read_b64_tr_b16 a[34:35], v25 offset:51232
v_mfma_f32_16x16x32_bf16 v[140:143], a[44:47], a[84:87], v[140:143]
ds_read_b64_tr_b16 a[36:37], v25 offset:51712
v_mfma_f32_16x16x32_bf16 v[144:147], a[48:51], a[84:87], v[144:147]
buffer_load_dword v22, s[36:39], s52 offen offset:2048 lds
v_mfma_f32_16x16x32_bf16 v[128:131], a[48:51], a[80:83], v[128:131]
ds_read_b64_tr_b16 a[38:39], v25 offset:52224
s_add_u32 s52, s52, 128
v_mfma_f32_16x16x32_bf16 v[132:135], a[52:55], a[80:83], v[132:135]
ds_read_b64_tr_b16 a[40:41], v25 offset:51744
v_mfma_f32_16x16x32_bf16 v[148:151], a[52:55], a[84:87], v[148:151]
ds_read_b64_tr_b16 a[42:43], v25 offset:52256
v_mfma_f32_16x16x32_bf16 v[152:155], a[56:59], a[84:87], v[152:155]
v_mfma_f32_16x16x32_bf16 v[136:139], a[56:59], a[80:83], v[136:139]
s_waitcnt vmcnt(25) lgkmcnt(8)
s_barrier
v_mfma_f32_16x16x32_bf16 v[60:63], a[20:23], a[0:3], v[60:63]
ds_read_b128 a[44:47], v30 offset:55488
s_add_u32 m0, s56, 111232
v_mfma_f32_16x16x32_bf16 v[76:79], a[24:27], a[0:3], v[76:79]
buffer_load_dwordx4 v18, s[20:23], s54 offen lds
v_mfma_f32_16x16x32_bf16 v[80:83], a[24:27], a[4:7], v[80:83]
s_sub_u32 s47, s47, 1
s_cbranch_scc1 .Lx7
.Lx7b:
v_mfma_f32_16x16x32_bf16 v[64:67], a[20:23], a[4:7], v[64:67]
ds_read_b128 a[48:51], v30 offset:57792
v_mfma_f32_16x16x32_bf16 v[68:71], a[20:23], a[8:11], v[68:71]
ds_read_b128 a[52:55], v30 offset:60096
v_mfma_f32_16x16x32_bf16 v[84:87], a[24:27], a[8:11], v[84:87]
buffer_load_dwordx4 v19, s[20:23], s54 offen offset:1024 lds
v_mfma_f32_16x16x32_bf16 v[88:91], a[24:27], a[12:15], v[88:91]
ds_read_b128 a[56:59], v30 offset:62400
v_mfma_f32_16x16x32_bf16 v[72:75], a[20:23], a[12:15], v[72:75]
ds_read_b64_tr_b16 a[64:65], v25 offset:62080
s_waitcnt lgkmcnt(5)
v_mfma_f32_16x16x32_bf16 v[244:247], a[20:23], a[16:19], v[244:247]
ds_read_b64_tr_b16 a[66:67], v25 offset:62592
v_mfma_f32_16x16x32_bf16 v[104:107], a[28:31], a[12:15], v[104:107]
buffer_load_dwordx4 v20, s[20:23], s54 offen offset:2048 lds
v_mfma_f32_16x16x32_bf16 v[120:123], a[32:35], a[12:15], v[120:123]
ds_read_b64_tr_b16 a[68:69], v25 offset:62112
s_add_u32 s54, s54, 196608
v_mfma_f32_16x16x32_bf16 v[116:119], a[32:35], a[8:11], v[116:119]
ds_read_b64_tr_b16 a[70:71], v25 offset:62624
v_mfma_f32_16x16x32_bf16 v[100:103], a[28:31], a[8:11], v[100:103]
ds_read_b128 a[60:63], v31 offset:55488
s_add_u32 m0, s55, 39296
v_mfma_f32_16x16x32_bf16 v[96:99], a[28:31], a[4:7], v[96:99]
buffer_load_dwordx4 v21, s[36:39], s53 offen lds
v_mfma_f32_16x16x32_bf16 v[112:115], a[32:35], a[4:7], v[112:115]
v_mfma_f32_16x16x32_bf16 v[108:111], a[32:35], a[0:3], v[108:111]
ds_read_b64_tr_b16 a[72:73], v25 offset:63104
v_mfma_f32_16x16x32_bf16 v[92:95], a[28:31], a[0:3], v[92:95]
ds_read_b64_tr_b16 a[74:75], v25 offset:63616
v_mfma_f32_16x16x32_bf16 v[156:159], a[28:31], a[16:19], v[156:159]
buffer_load_dwordx4 v28, s[36:39], s53 offen offset:1024 lds
v_mfma_f32_16x16x32_bf16 v[160:163], a[32:35], a[16:19], v[160:163]
ds_read_b64_tr_b16 a[76:77], v25 offset:63136
v_mfma_f32_16x16x32_bf16 v[124:127], a[0:3], a[36:39], v[124:127]
ds_read_b64_tr_b16 a[78:79], v25 offset:63648
v_mfma_f32_16x16x32_bf16 v[140:143], a[0:3], a[40:43], v[140:143]
ds_read_b64_tr_b16 a[80:81], v25 offset:64128
v_mfma_f32_16x16x32_bf16 v[144:147], a[4:7], a[40:43], v[144:147]
buffer_load_dword v29, s[36:39], s53 offen offset:2048 lds
v_mfma_f32_16x16x32_bf16 v[128:131], a[4:7], a[36:39], v[128:131]
ds_read_b64_tr_b16 a[82:83], v25 offset:64640
s_add_u32 s53, s53, 128
v_mfma_f32_16x16x32_bf16 v[132:135], a[8:11], a[36:39], v[132:135]
ds_read_b64_tr_b16 a[84:85], v25 offset:64160
v_mfma_f32_16x16x32_bf16 v[148:151], a[8:11], a[40:43], v[148:151]
ds_read_b64_tr_b16 a[86:87], v25 offset:64672
v_mfma_f32_16x16x32_bf16 v[152:155], a[12:15], a[40:43], v[152:155]
v_mfma_f32_16x16x32_bf16 v[136:139], a[12:15], a[36:39], v[136:139]
s_waitcnt vmcnt(22) lgkmcnt(8)
s_barrier
s_waitcnt vmcnt(21)
v_cmp_ne_u32 vcc, v35, v37
s_nop 0
s_cbranch_vccnz .Lsp8
.Lsp8b:
v_mov_b32 v37, 0
v_mfma_f32_16x16x32_bf16 v[60:63], a[64:67], a[44:47], v[60:63]
ds_read_b128 a[0:3], v23
v_mfma_f32_16x16x32_bf16 v[76:79], a[68:71], a[44:47], v[76:79]
buffer_atomic_add v35, v32, s[16:19], 0 offen
v_mfma_f32_16x16x32_bf16 v[80:83], a[68:71], a[48:51], v[80:83]
ds_read_b128 a[4:7], v23 offset:2304
v_mfma_f32_16x16x32_bf16 v[64:67], a[64:67], a[48:51], v[64:67]
ds_read_b128 a[8:11], v23 offset:4608
s_add_u32 m0, s56, 123648
v_mfma_f32_16x16x32_bf16 v[68:71], a[64:67], a[52:55], v[68:71]
buffer_load_dwordx4 v18, s[20:23], s54 offen lds
v_mfma_f32_16x16x32_bf16 v[84:87], a[68:71], a[52:55], v[84:87]
ds_read_b128 a[12:15], v23 offset:6912
v_mfma_f32_16x16x32_bf16 v[88:91], a[68:71], a[56:59], v[88:91]
ds_read_b64_tr_b16 a[20:21], v25
v_mfma_f32_16x16x32_bf16 v[72:75], a[64:67], a[56:59], v[72:75]
ds_read_b64_tr_b16 a[22:23], v25 offset:512
s_waitcnt lgkmcnt(6)
v_mfma_f32_16x16x32_bf16 v[244:247], a[64:67], a[60:63], v[244:247]
buffer_load_dwordx4 v19, s[20:23], s54 offen offset:1024 lds
v_mfma_f32_16x16x32_bf16 v[104:107], a[72:75], a[56:59], v[104:107]
ds_read_b64_tr_b16 a[24:25], v25 offset:32
v_mfma_f32_16x16x32_bf16 v[120:123], a[76:79], a[56:59], v[120:123]
ds_read_b64_tr_b16 a[26:27], v25 offset:544
v_mfma_f32_16x16x32_bf16 v[116:119], a[76:79], a[52:55], v[116:119]
buffer_load_dwordx4 v20, s[20:23], s54 offen offset:2048 lds
v_mfma_f32_16x16x32_bf16 v[100:103], a[72:75], a[52:55], v[100:103]
ds_read_b128 a[16:19], v24
s_add_u32 s54, s54, 196608
v_mfma_f32_16x16x32_bf16 v[96:99], a[72:75], a[48:51], v[96:99]
v_mfma_f32_16x16x32_bf16 v[112:115], a[76:79], a[48:51], v[112:115]
ds_read_b64_tr_b16 a[28:29], v25 offset:1024
s_add_u32 m0, s55, 55488
v_mfma_f32_16x16x32_bf16 v[108:111], a[76:79], a[44:47], v[108:111]
buffer_load_dwordx4 v21, s[36:39], s52 offen lds
v_mfma_f32_16x16x32_bf16 v[92:95], a[72:75], a[44:47], v[92:95]
ds_read_b64_tr_b16 a[30:31], v25 offset:1536
v_mfma_f32_16x16x32_bf16 v[156:159], a[72:75], a[60:63], v[156:159]
ds_read_b64_tr_b16 a[32:33], v25 offset:1056
v_mfma_f32_16x16x32_bf16 v[160:163], a[76:79], a[60:63], v[160:163]
buffer_load_dwordx4 v28, s[36:39], s52 offen offset:1024 lds
v_mfma_f32_16x16x32_bf16 v[124:127], a[44:47], a[80:83], v[124:127]
ds_read_b64_tr_b16 a[34:35], v25 offset:1568
v_mfma_f32_16x16x32_bf16 v[140:143], a[44:47], a[84:87], v[140:143]
ds_read_b64_tr_b16 a[36:37], v25 offset:2048
v_mfma_f32_16x16x32_bf16 v[144:147], a[48:51], a[84:87], v[144:147]
ds_read_b64_tr_b16 a[38:39], v25 offset:2560
v_mfma_f32_16x16x32_bf16 v[128:131], a[48:51], a[80:83], v[128:131]
buffer_load_dword v22, s[36:39], s52 offen offset:2048 lds
v_mfma_f32_16x16x32_bf16 v[132:135], a[52:55], a[80:83], v[132:135]
ds_read_b64_tr_b16 a[40:41], v25 offset:2080
s_add_u32 s52, s52, 128
v_mfma_f32_16x16x32_bf16 v[148:151], a[52:55], a[84:87], v[148:151]
ds_read_b64_tr_b16 a[42:43], v25 offset:2592
v_mfma_f32_16x16x32_bf16 v[152:155], a[56:59], a[84:87], v[152:155]
v_mfma_f32_16x16x32_bf16 v[136:139], a[56:59], a[80:83], v[136:139]
s_waitcnt vmcnt(25) lgkmcnt(8)
s_barrier
v_mfma_f32_16x16x32_bf16 v[60:63], a[20:23], a[0:3], v[60:63]
ds_read_b128 a[44:47], v30
s_add_u32 m0, s56, 136064
v_mfma_f32_16x16x32_bf16 v[76:79], a[24:27], a[0:3], v[76:79]
buffer_load_dwordx4 v18, s[20:23], s54 offen lds
v_mfma_f32_16x16x32_bf16 v[80:83], a[24:27], a[4:7], v[80:83]
s_sub_u32 s47, s47, 1
s_cbranch_scc1 .Lx9
.Lx9b:
v_mfma_f32_16x16x32_bf16 v[64:67], a[20:23], a[4:7], v[64:67]
ds_read_b128 a[48:51], v30 offset:2304
v_mfma_f32_16x16x32_bf16 v[68:71], a[20:23], a[8:11], v[68:71]
ds_read_b128 a[52:55], v30 offset:4608
v_mfma_f32_16x16x32_bf16 v[84:87], a[24:27], a[8:11], v[84:87]
buffer_load_dwordx4 v19, s[20:23], s54 offen offset:1024 lds
v_mfma_f32_16x16x32_bf16 v[88:91], a[24:27], a[12:15], v[88:91]
ds_read_b128 a[56:59], v30 offset:6912
v_mfma_f32_16x16x32_bf16 v[72:75], a[20:23], a[12:15], v[72:75]
ds_read_b64_tr_b16 a[64:65], v25 offset:12416
s_waitcnt lgkmcnt(5)
v_mfma_f32_16x16x32_bf16 v[244:247], a[20:23], a[16:19], v[244:247]
ds_read_b64_tr_b16 a[66:67], v25 offset:12928
v_mfma_f32_16x16x32_bf16 v[104:107], a[28:31], a[12:15], v[104:107]
buffer_load_dwordx4 v20, s[20:23], s54 offen offset:2048 lds
v_mfma_f32_16x16x32_bf16 v[120:123], a[32:35], a[12:15], v[120:123]
ds_read_b64_tr_b16 a[68:69], v25 offset:12448
s_add_u32 s54, s54, 196608
v_mfma_f32_16x16x32_bf16 v[116:119], a[32:35], a[8:11], v[116:119]
ds_read_b64_tr_b16 a[70:71], v25 offset:12960
v_mfma_f32_16x16x32_bf16 v[100:103], a[28:31], a[8:11], v[100:103]
ds_read_b128 a[60:63], v31
s_add_u32 m0, s55, 57792
v_mfma_f32_16x16x32_bf16 v[96:99], a[28:31], a[4:7], v[96:99]
buffer_load_dwordx4 v21, s[36:39], s53 offen lds
v_mfma_f32_16x16x32_bf16 v[112:115], a[32:35], a[4:7], v[112:115]
v_mfma_f32_16x16x32_bf16 v[108:111], a[32:35], a[0:3], v[108:111]
ds_read_b64_tr_b16 a[72:73], v25 offset:13440
v_mfma_f32_16x16x32_bf16 v[92:95], a[28:31], a[0:3], v[92:95]
ds_read_b64_tr_b16 a[74:75], v25 offset:13952
v_mfma_f32_16x16x32_bf16 v[156:159], a[28:31], a[16:19], v[156:159]
buffer_load_dwordx4 v28, s[36:39], s53 offen offset:1024 lds
v_mfma_f32_16x16x32_bf16 v[160:163], a[32:35], a[16:19], v[160:163]
ds_read_b64_tr_b16 a[76:77], v25 offset:13472
v_mfma_f32_16x16x32_bf16 v[124:127], a[0:3], a[36:39], v[124:127]
ds_read_b64_tr_b16 a[78:79], v25 offset:13984
v_mfma_f32_16x16x32_bf16 v[140:143], a[0:3], a[40:43], v[140:143]
ds_read_b64_tr_b16 a[80:81], v25 offset:14464
v_mfma_f32_16x16x32_bf16 v[144:147], a[4:7], a[40:43], v[144:147]
buffer_load_dword v29, s[36:39], s53 offen offset:2048 lds
v_mfma_f32_16x16x32_bf16 v[128:131], a[4:7], a[36:39], v[128:131]
ds_read_b64_tr_b16 a[82:83], v25 offset:14976
s_add_u32 s53, s53, 128
v_mfma_f32_16x16x32_bf16 v[132:135], a[8:11], a[36:39], v[132:135]
ds_read_b64_tr_b16 a[84:85], v25 offset:14496
v_mfma_f32_16x16x32_bf16 v[148:151], a[8:11], a[40:43], v[148:151]
ds_read_b64_tr_b16 a[86:87], v25 offset:15008
v_mfma_f32_16x16x32_bf16 v[152:155], a[12:15], a[40:43], v[152:155]
v_mfma_f32_16x16x32_bf16 v[136:139], a[12:15], a[36:39], v[136:139]
s_waitcnt vmcnt(22) lgkmcnt(8)
s_barrier
v_mfma_f32_16x16x32_bf16 v[60:63], a[64:67], a[44:47], v[60:63]
ds_read_b128 a[0:3], v23 offset:18496
s_add_u32 m0, s56, 73984
v_mfma_f32_16x16x32_bf16 v[76:79], a[68:71], a[44:47], v[76:79]
buffer_load_dwordx4 v18, s[20:23], s54 offen lds
v_mfma_f32_16x16x32_bf16 v[80:83], a[68:71], a[48:51], v[80:83]
ds_read_b128 a[4:7], v23 offset:20800
v_mfma_f32_16x16x32_bf16 v[64:67], a[64:67], a[48:51], v[64:67]
ds_read_b128 a[8:11], v23 offset:23104
v_mfma_f32_16x16x32_bf16 v[68:71], a[64:67], a[52:55], v[68:71]
ds_read_b128 a[12:15], v23 offset:25408
v_mfma_f32_16x16x32_bf16 v[84:87], a[68:71], a[52:55], v[84:87]
buffer_load_dwordx4 v19, s[20:23], s54 offen offset:1024 lds
v_mfma_f32_16x16x32_bf16 v[88:91], a[68:71], a[56:59], v[88:91]
ds_read_b64_tr_b16 a[20:21], v25 offset:24832
v_mfma_f32_16x16x32_bf16 v[72:75], a[64:67], a[56:59], v[72:75]
ds_read_b64_tr_b16 a[22:23], v25 offset:25344
s_waitcnt lgkmcnt(6)
v_mfma_f32_16x16x32_bf16 v[244:247], a[64:67], a[60:63], v[244:247]
v_mfma_f32_16x16x32_bf16 v[104:107], a[72:75], a[56:59], v[104:107]
buffer_load_dwordx4 v20, s[20:23], s54 offen offset:2048 lds
v_mfma_f32_16x16x32_bf16 v[120:123], a[76:79], a[56:59], v[120:123]
ds_read_b64_tr_b16 a[24:25], v25 offset:24864
s_add_u32 s54, s54, 196608
v_mfma_f32_16x16x32_bf16 v[116:119], a[76:79], a[52:55], v[116:119]
ds_read_b64_tr_b16 a[26:27], v25 offset:25376
v_mfma_f32_16x16x32_bf16 v[100:103], a[72:75], a[52:55], v[100:103]
ds_read_b128 a[16:19], v24 offset:18496
s_add_u32 m0, s55, 0
v_mfma_f32_16x16x32_bf16 v[96:99], a[72:75], a[48:51], v[96:99]
buffer_load_dwordx4 v21, s[36:39], s52 offen lds
v_mfma_f32_16x16x32_bf16 v[112:115], a[76:79], a[48:51], v[112:115]
ds_read_b64_tr_b16 a[28:29], v25 offset:25856
v_mfma_f32_16x16x32_bf16 v[108:111], a[76:79], a[44:47], v[108:111]
ds_read_b64_tr_b16 a[30:31], v25 offset:26368
v_mfma_f32_16x16x32_bf16 v[92:95], a[72:75], a[44:47], v[92:95]
ds_read_b64_tr_b16 a[32:33], v25 offset:25888
v_mfma_f32_16x16x32_bf16 v[156:159], a[72:75], a[60:63], v[156:159]
buffer_load_dwordx4 v28, s[36:39], s52 offen offset:1024 lds
v_mfma_f32_16x16x32_bf16 v[160:163], a[76:79], a[60:63], v[160:163]
v_mfma_f32_16x16x32_bf16 v[124:127], a[44:47], a[80:83], v[124:127]
ds_read_b64_tr_b16 a[34:35], v25 offset:26400
v_mfma_f32_16x16x32_bf16 v[140:143], a[44:47], a[84:87], v[140:143]
ds_read_b64_tr_b16 a[36:37], v25 offset:26880
v_mfma_f32_16x16x32_bf16 v[144:147], a[48:51], a[84:87], v[144:147]
buffer_load_dword v22, s[36:39], s52 offen offset:2048 lds
v_mfma_f32_16x16x32_bf16 v[128:131], a[48:51], a[80:83], v[128:131]
ds_read_b64_tr_b16 a[38:39], v25 offset:27392
s_add_u32 s52, s52, 128
v_mfma_f32_16x16x32_bf16 v[132:135], a[52:55], a[80:83], v[132:135]
ds_read_b64_tr_b16 a[40:41], v25 offset:26912
v_mfma_f32_16x16x32_bf16 v[148:151], a[52:55], a[84:87], v[148:151]
ds_read_b64_tr_b16 a[42:43], v25 offset:27424
v_mfma_f32_16x16x32_bf16 v[152:155], a[56:59], a[84:87], v[152:155]
v_mfma_f32_16x16x32_bf16 v[136:139], a[56:59], a[80:83], v[136:139]
s_waitcnt vmcnt(22) lgkmcnt(8)
s_barrier
v_mfma_f32_16x16x32_bf16 v[60:63], a[20:23], a[0:3], v[60:63]
ds_read_b128 a[44:47], v30 offset:18496
s_add_u32 m0, s56, 86400
v_mfma_f32_16x16x32_bf16 v[76:79], a[24:27], a[0:3], v[76:79]
buffer_load_dwordx4 v18, s[20:23], s54 offen lds
v_mfma_f32_16x16x32_bf16 v[80:83], a[24:27], a[4:7], v[80:83]
s_sub_u32 s47, s47, 1
s_cbranch_scc1 .Lx10
.Lx10b:
v_mfma_f32_16x16x32_bf16 v[64:67], a[20:23], a[4:7], v[64:67]
ds_read_b128 a[48:51], v30 offset:20800
v_mfma_f32_16x16x32_bf16 v[68:71], a[20:23], a[8:11], v[68:71]
ds_read_b128 a[52:55], v30 offset:23104
v_mfma_f32_16x16x32_bf16 v[84:87], a[24:27], a[8:11], v[84:87]
buffer_load_dwordx4 v19, s[20:23], s54 offen offset:1024 lds
v_mfma_f32_16x16x32_bf16 v[88:91], a[24:27], a[12:15], v[88:91]
ds_read_b128 a[56:59], v30 offset:25408
v_mfma_f32_16x16x32_bf16 v[72:75], a[20:23], a[12:15], v[72:75]
ds_read_b64_tr_b16 a[64:65], v25 offset:37248
s_waitcnt lgkmcnt(5)
v_mfma_f32_16x16x32_bf16 v[244:247], a[20:23], a[16:19], v[244:247]
ds_read_b64_tr_b16 a[66:67], v25 offset:37760
v_mfma_f32_16x16x32_bf16 v[104:107], a[28:31], a[12:15], v[104:107]
buffer_load_dwordx4 v20, s[20:23], s54 offen offset:2048 lds
v_mfma_f32_16x16x32_bf16 v[120:123], a[32:35], a[12:15], v[120:123]
ds_read_b64_tr_b16 a[68:69], v25 offset:37280
s_add_u32 s54, s54, 196608
v_mfma_f32_16x16x32_bf16 v[116:119], a[32:35], a[8:11], v[116:119]
ds_read_b64_tr_b16 a[70:71], v25 offset:37792
v_mfma_f32_16x16x32_bf16 v[100:103], a[28:31], a[8:11], v[100:103]
ds_read_b128 a[60:63], v31 offset:18496
s_add_u32 m0, s55, 2304
v_mfma_f32_16x16x32_bf16 v[96:99], a[28:31], a[4:7], v[96:99]
buffer_load_dwordx4 v21, s[36:39], s53 offen lds
v_mfma_f32_16x16x32_bf16 v[112:115], a[32:35], a[4:7], v[112:115]
v_mfma_f32_16x16x32_bf16 v[108:111], a[32:35], a[0:3], v[108:111]
ds_read_b64_tr_b16 a[72:73], v25 offset:38272
v_mfma_f32_16x16x32_bf16 v[92:95], a[28:31], a[0:3], v[92:95]
ds_read_b64_tr_b16 a[74:75], v25 offset:38784
v_mfma_f32_16x16x32_bf16 v[156:159], a[28:31], a[16:19], v[156:159]
buffer_load_dwordx4 v28, s[36:39], s53 offen offset:1024 lds
v_mfma_f32_16x16x32_bf16 v[160:163], a[32:35], a[16:19], v[160:163]
ds_read_b64_tr_b16 a[76:77], v25 offset:38304
v_mfma_f32_16x16x32_bf16 v[124:127], a[0:3], a[36:39], v[124:127]
ds_read_b64_tr_b16 a[78:79], v25 offset:38816
v_mfma_f32_16x16x32_bf16 v[140:143], a[0:3], a[40:43], v[140:143]
ds_read_b64_tr_b16 a[80:81], v25 offset:39296
v_mfma_f32_16x16x32_bf16 v[144:147], a[4:7], a[40:43], v[144:147]
buffer_load_dword v29, s[36:39], s53 offen offset:2048 lds
v_mfma_f32_16x16x32_bf16 v[128:131], a[4:7], a[36:39], v[128:131]
ds_read_b64_tr_b16 a[82:83], v25 offset:39808
s_add_u32 s53, s53, 128
v_mfma_f32_16x16x32_bf16 v[132:135], a[8:11], a[36:39], v[132:135]
ds_read_b64_tr_b16 a[84:85], v25 offset:39328
v_mfma_f32_16x16x32_bf16 v[148:151], a[8:11], a[40:43], v[148:151]
ds_read_b64_tr_b16 a[86:87], v25 offset:39840
v_mfma_f32_16x16x32_bf16 v[152:155], a[12:15], a[40:43], v[152:155]
v_mfma_f32_16x16x32_bf16 v[136:139], a[12:15], a[36:39], v[136:139]
s_waitcnt vmcnt(21) lgkmcnt(8)
s_barrier
v_mfma_f32_16x16x32_bf16 v[60:63], a[64:67], a[44:47], v[60:63]
ds_read_b128 a[0:3], v23 offset:36992
s_add_u32 m0, s56, 98816
v_mfma_f32_16x16x32_bf16 v[76:79], a[68:71], a[44:47], v[76:79]
buffer_load_dwordx4 v18, s[20:23], s54 offen lds
v_mfma_f32_16x16x32_bf16 v[80:83], a[68:71], a[48:51], v[80:83]
ds_read_b128 a[4:7], v23 offset:39296
v_mfma_f32_16x16x32_bf16 v[64:67], a[64:67], a[48:51], v[64:67]
ds_read_b128 a[8:11], v23 offset:41600
v_mfma_f32_16x16x32_bf16 v[68:71], a[64:67], a[52:55], v[68:71]
ds_read_b128 a[12:15], v23 offset:43904
v_mfma_f32_16x16x32_bf16 v[84:87], a[68:71], a[52:55], v[84:87]
buffer_load_dwordx4 v19, s[20:23], s54 offen offset:1024 lds
v_mfma_f32_16x16x32_bf16 v[88:91], a[68:71], a[56:59], v[88:91]
ds_read_b64_tr_b16 a[20:21], v25 offset:49664
v_mfma_f32_16x16x32_bf16 v[72:75], a[64:67], a[56:59], v[72:75]
ds_read_b64_tr_b16 a[22:23], v25 offset:50176
s_waitcnt lgkmcnt(6)
v_mfma_f32_16x16x32_bf16 v[244:247], a[64:67], a[60:63], v[244:247]
v_mfma_f32_16x16x32_bf16 v[104:107], a[72:75], a[56:59], v[104:107]
buffer_load_dwordx4 v20, s[20:23], s54 offen offset:2048 lds
v_mfma_f32_16x16x32_bf16 v[120:123], a[76:79], a[56:59], v[120:123]
ds_read_b64_tr_b16 a[24:25], v25 offset:49696
s_add_u32 s54, s54, 196608
v_mfma_f32_16x16x32_bf16 v[116:119], a[76:79], a[52:55], v[116:119]
ds_read_b64_tr_b16 a[26:27], v25 offset:50208
v_mfma_f32_16x16x32_bf16 v[100:103], a[72:75], a[52:55], v[100:103]
ds_read_b128 a[16:19], v24 offset:36992
s_add_u32 m0, s55, 18496
v_mfma_f32_16x16x32_bf16 v[96:99], a[72:75], a[48:51], v[96:99]
buffer_load_dwordx4 v21, s[36:39], s52 offen lds
v_mfma_f32_16x16x32_bf16 v[112:115], a[76:79], a[48:51], v[112:115]
ds_read_b64_tr_b16 a[28:29], v25 offset:50688
v_mfma_f32_16x16x32_bf16 v[108:111], a[76:79], a[44:47], v[108:111]
ds_read_b64_tr_b16 a[30:31], v25 offset:51200
v_mfma_f32_16x16x32_bf16 v[92:95], a[72:75], a[44:47], v[92:95]
ds_read_b64_tr_b16 a[32:33], v25 offset:50720
v_mfma_f32_16x16x32_bf16 v[156:159], a[72:75], a[60:63], v[156:159]
buffer_load_dwordx4 v28, s[36:39], s52 offen offset:1024 lds
v_mfma_f32_16x16x32_bf16 v[160:163], a[76:79], a[60:63], v[160:163]
v_mfma_f32_16x16x32_bf16 v[124:127], a[44:47], a[80:83], v[124:127]
ds_read_b64_tr_b16 a[34:35], v25 offset:51232
v_mfma_f32_16x16x32_bf16 v[140:143], a[44:47], a[84:87], v[140:143]
ds_read_b64_tr_b16 a[36:37], v25 offset:51712
v_mfma_f32_16x16x32_bf16 v[144:147], a[48:51], a[84:87], v[144:147]
buffer_load_dword v22, s[36:39], s52 offen offset:2048 lds
v_mfma_f32_16x16x32_bf16 v[128:131], a[48:51], a[80:83], v[128:131]
ds_read_b64_tr_b16 a[38:39], v25 offset:52224
s_add_u32 s52, s52, 128
v_mfma_f32_16x16x32_bf16 v[132:135], a[52:55], a[80:83], v[132:135]
ds_read_b64_tr_b16 a[40:41], v25 offset:51744
v_mfma_f32_16x16x32_bf16 v[148:151], a[52:55], a[84:87], v[148:151]
ds_read_b64_tr_b16 a[42:43], v25 offset:52256
v_mfma_f32_16x16x32_bf16 v[152:155], a[56:59], a[84:87], v[152:155]
v_mfma_f32_16x16x32_bf16 v[136:139], a[56:59], a[80:83], v[136:139]
s_waitcnt vmcnt(21) lgkmcnt(8)
s_barrier
v_mfma_f32_16x16x32_bf16 v[60:63], a[20:23], a[0:3], v[60:63]
ds_read_b128 a[44:47], v30 offset:36992
s_add_u32 m0, s56, 111232
v_mfma_f32_16x16x32_bf16 v[76:79], a[24:27], a[0:3], v[76:79]
buffer_load_dwordx4 v18, s[20:23], s54 offen lds
v_mfma_f32_16x16x32_bf16 v[80:83], a[24:27], a[4:7], v[80:83]
s_sub_u32 s47, s47, 1
s_cbranch_scc1 .Lx11
.Lx11b:
v_mfma_f32_16x16x32_bf16 v[64:67], a[20:23], a[4:7], v[64:67]
ds_read_b128 a[48:51], v30 offset:39296
v_mfma_f32_16x16x32_bf16 v[68:71], a[20:23], a[8:11], v[68:71]
buffer_load_dwordx4 v19, s[20:23], s54 offen offset:1024 lds
v_mfma_f32_16x16x32_bf16 v[84:87], a[24:27], a[8:11], v[84:87]
ds_read_b128 a[52:55], v30 offset:41600
v_mfma_f32_16x16x32_bf16 v[88:91], a[24:27], a[12:15], v[88:91]
ds_read_b128 a[56:59], v30 offset:43904
v_mfma_f32_16x16x32_bf16 v[72:75], a[20:23], a[12:15], v[72:75]
ds_read_b64_tr_b16 a[64:65], v25 offset:62080
s_waitcnt lgkmcnt(5)
v_mfma_f32_16x16x32_bf16 v[244:247], a[20:23], a[16:19], v[244:247]
buffer_load_dwordx4 v20, s[20:23], s54 offen offset:2048 lds
v_mfma_f32_16x16x32_bf16 v[104:107], a[28:31], a[12:15], v[104:107]
ds_read_b64_tr_b16 a[66:67], v25 offset:62592
s_add_u32 s54, s54, 196608
v_mfma_f32_16x16x32_bf16 v[120:123], a[32:35], a[12:15], v[120:123]
ds_read_b64_tr_b16 a[68:69], v25 offset:62112
s_add_u32 m0, s55, 20800
v_mfma_f32_16x16x32_bf16 v[116:119], a[32:35], a[8:11], v[116:119]
buffer_load_dwordx4 v21, s[36:39], s53 offen lds
v_mfma_f32_16x16x32_bf16 v[100:103], a[28:31], a[8:11], v[100:103]
ds_read_b64_tr_b16 a[70:71], v25 offset:62624
v_mfma_f32_16x16x32_bf16 v[96:99], a[28:31], a[4:7], v[96:99]
ds_read_b128 a[60:63], v31 offset:36992
v_mfma_f32_16x16x32_bf16 v[112:115], a[32:35], a[4:7], v[112:115]
ds_read_b64_tr_b16 a[72:73], v25 offset:63104
v_mfma_f32_16x16x32_bf16 v[108:111], a[32:35], a[0:3], v[108:111]
buffer_load_dwordx4 v28, s[36:39], s53 offen offset:1024 lds
v_mfma_f32_16x16x32_bf16 v[92:95], a[28:31], a[0:3], v[92:95]
ds_read_b64_tr_b16 a[74:75], v25 offset:63616
v_mfma_f32_16x16x32_bf16 v[156:159], a[28:31], a[16:19], v[156:159]
ds_read_b64_tr_b16 a[76:77], v25 offset:63136
v_mfma_f32_16x16x32_bf16 v[160:163], a[32:35], a[16:19], v[160:163]
buffer_load_dword v29, s[36:39], s53 offen offset:2048 lds
v_mfma_f32_16x16x32_bf16 v[124:127], a[0:3], a[36:39], v[124:127]
ds_read_b64_tr_b16 a[78:79], v25 offset:63648
s_add_u32 s53, s53, 128
v_mfma_f32_16x16x32_bf16 v[140:143], a[0:3], a[40:43], v[140:143]
ds_read_b64_tr_b16 a[80:81], v25 offset:64128
v_mfma_f32_16x16x32_bf16 v[144:147], a[4:7], a[40:43], v[144:147]
ds_read_b64_tr_b16 a[82:83], v25 offset:64640
v_mfma_f32_16x16x32_bf16 v[128:131], a[4:7], a[36:39], v[128:131]
buffer_atomic_add v37, v33, s[16:19], 0 offen sc0
v_mfma_f32_16x16x32_bf16 v[132:135], a[8:11], a[36:39], v[132:135]
ds_read_b64_tr_b16 a[84:85], v25 offset:64160
v_mfma_f32_16x16x32_bf16 v[148:151], a[8:11], a[40:43], v[148:151]
ds_read_b64_tr_b16 a[86:87], v25 offset:64672
v_mfma_f32_16x16x32_bf16 v[152:155], a[12:15], a[40:43], v[152:155]
v_mfma_f32_16x16x32_bf16 v[136:139], a[12:15], a[36:39], v[136:139]
s_waitcnt vmcnt(22) lgkmcnt(8)
s_barrier
v_mfma_f32_16x16x32_bf16 v[60:63], a[64:67], a[44:47], v[60:63]
ds_read_b128 a[0:3], v23 offset:55488
s_add_u32 m0, s56, 123648
v_mfma_f32_16x16x32_bf16 v[76:79], a[68:71], a[44:47], v[76:79]
buffer_load_dwordx4 v18, s[20:23], s54 offen lds
v_mfma_f32_16x16x32_bf16 v[80:83], a[68:71], a[48:51], v[80:83]
ds_read_b128 a[4:7], v23 offset:57792
v_mfma_f32_16x16x32_bf16 v[64:67], a[64:67], a[48:51], v[64:67]
ds_read_b128 a[8:11], v23 offset:60096
v_mfma_f32_16x16x32_bf16 v[68:71], a[64:67], a[52:55], v[68:71]
ds_read_b128 a[12:15], v23 offset:62400
v_mfma_f32_16x16x32_bf16 v[84:87], a[68:71], a[52:55], v[84:87]
buffer_load_dwordx4 v19, s[20:23], s54 offen offset:1024 lds
v_mfma_f32_16x16x32_bf16 v[88:91], a[68:71], a[56:59], v[88:91]
ds_read_b64_tr_b16 a[20:21], v25
v_mfma_f32_16x16x32_bf16 v[72:75], a[64:67], a[56:59], v[72:75]
ds_read_b64_tr_b16 a[22:23], v25 offset:512
s_waitcnt lgkmcnt(6)
v_mfma_f32_16x16x32_bf16 v[244:247], a[64:67], a[60:63], v[244:247]
v_mfma_f32_16x16x32_bf16 v[104:107], a[72:75], a[56:59], v[104:107]
buffer_load_dwordx4 v20, s[20:23], s54 offen offset:2048 lds
v_mfma_f32_16x16x32_bf16 v[120:123], a[76:79], a[56:59], v[120:123]
ds_read_b64_tr_b16 a[24:25], v25 offset:32
s_add_u32 s54, s54, 196608
v_mfma_f32_16x16x32_bf16 v[116:119], a[76:79], a[52:55], v[116:119]
ds_read_b64_tr_b16 a[26:27], v25 offset:544
v_mfma_f32_16x16x32_bf16 v[100:103], a[72:75], a[52:55], v[100:103]
ds_read_b128 a[16:19], v24 offset:55488
s_add_u32 m0, s55, 36992
v_mfma_f32_16x16x32_bf16 v[96:99], a[72:75], a[48:51], v[96:99]
buffer_load_dwordx4 v21, s[36:39], s52 offen lds
v_mfma_f32_16x16x32_bf16 v[112:115], a[76:79], a[48:51], v[112:115]
ds_read_b64_tr_b16 a[28:29], v25 offset:1024
v_mfma_f32_16x16x32_bf16 v[108:111], a[76:79], a[44:47], v[108:111]
ds_read_b64_tr_b16 a[30:31], v25 offset:1536
v_mfma_f32_16x16x32_bf16 v[92:95], a[72:75], a[44:47], v[92:95]
ds_read_b64_tr_b16 a[32:33], v25 offset:1056
v_mfma_f32_16x16x32_bf16 v[156:159], a[72:75], a[60:63], v[156:159]
buffer_load_dwordx4 v28, s[36:39], s52 offen offset:1024 lds
v_mfma_f32_16x16x32_bf16 v[160:163], a[76:79], a[60:63], v[160:163]
v_mfma_f32_16x16x32_bf16 v[124:127], a[44:47], a[80:83], v[124:127]
ds_read_b64_tr_b16 a[34:35], v25 offset:1568
v_mfma_f32_16x16x32_bf16 v[140:143], a[44:47], a[84:87], v[140:143]
ds_read_b64_tr_b16 a[36:37], v25 offset:2048
v_mfma_f32_16x16x32_bf16 v[144:147], a[48:51], a[84:87], v[144:147]
buffer_load_dword v22, s[36:39], s52 offen offset:2048 lds
v_mfma_f32_16x16x32_bf16 v[128:131], a[48:51], a[80:83], v[128:131]
ds_read_b64_tr_b16 a[38:39], v25 offset:2560
s_add_u32 s52, s52, 128
v_mfma_f32_16x16x32_bf16 v[132:135], a[52:55], a[80:83], v[132:135]
ds_read_b64_tr_b16 a[40:41], v25 offset:2080
v_mfma_f32_16x16x32_bf16 v[148:151], a[52:55], a[84:87], v[148:151]
ds_read_b64_tr_b16 a[42:43], v25 offset:2592
v_mfma_f32_16x16x32_bf16 v[152:155], a[56:59], a[84:87], v[152:155]
v_mfma_f32_16x16x32_bf16 v[136:139], a[56:59], a[80:83], v[136:139]
s_waitcnt vmcnt(22) lgkmcnt(8)
s_barrier
v_mfma_f32_16x16x32_bf16 v[60:63], a[20:23], a[0:3], v[60:63]
ds_read_b128 a[44:47], v30 offset:55488
s_add_u32 m0, s56, 136064
v_mfma_f32_16x16x32_bf16 v[76:79], a[24:27], a[0:3], v[76:79]
buffer_load_dwordx4 v18, s[20:23], s54 offen lds
v_mfma_f32_16x16x32_bf16 v[80:83], a[24:27], a[4:7], v[80:83]
s_sub_u32 s47, s47, 1
s_cbranch_scc1 .Lx12
.Lx12b:
v_mfma_f32_16x16x32_bf16 v[64:67], a[20:23], a[4:7], v[64:67]
ds_read_b128 a[48:51], v30 offset:57792
v_mfma_f32_16x16x32_bf16 v[68:71], a[20:23], a[8:11], v[68:71]
ds_read_b128 a[52:55], v30 offset:60096
v_mfma_f32_16x16x32_bf16 v[84:87], a[24:27], a[8:11], v[84:87]
buffer_load_dwordx4 v19, s[20:23], s54 offen offset:1024 lds
v_mfma_f32_16x16x32_bf16 v[88:91], a[24:27], a[12:15], v[88:91]
ds_read_b128 a[56:59], v30 offset:62400
v_mfma_f32_16x16x32_bf16 v[72:75], a[20:23], a[12:15], v[72:75]
ds_read_b64_tr_b16 a[64:65], v25 offset:12416
s_waitcnt lgkmcnt(5)
v_mfma_f32_16x16x32_bf16 v[244:247], a[20:23], a[16:19], v[244:247]
ds_read_b64_tr_b16 a[66:67], v25 offset:12928
v_mfma_f32_16x16x32_bf16 v[104:107], a[28:31], a[12:15], v[104:107]
buffer_load_dwordx4 v20, s[20:23], s54 offen offset:2048 lds
v_mfma_f32_16x16x32_bf16 v[120:123], a[32:35], a[12:15], v[120:123]
ds_read_b64_tr_b16 a[68:69], v25 offset:12448
s_add_u32 s54, s54, 196608
v_mfma_f32_16x16x32_bf16 v[116:119], a[32:35], a[8:11], v[116:119]
ds_read_b64_tr_b16 a[70:71], v25 offset:12960
v_mfma_f32_16x16x32_bf16 v[100:103], a[28:31], a[8:11], v[100:103]
ds_read_b128 a[60:63], v31 offset:55488
s_add_u32 m0, s55, 39296
v_mfma_f32_16x16x32_bf16 v[96:99], a[28:31], a[4:7], v[96:99]
buffer_load_dwordx4 v21, s[36:39], s53 offen lds
v_mfma_f32_16x16x32_bf16 v[112:115], a[32:35], a[4:7], v[112:115]
v_mfma_f32_16x16x32_bf16 v[108:111], a[32:35], a[0:3], v[108:111]
ds_read_b64_tr_b16 a[72:73], v25 offset:13440
v_mfma_f32_16x16x32_bf16 v[92:95], a[28:31], a[0:3], v[92:95]
ds_read_b64_tr_b16 a[74:75], v25 offset:13952
v_mfma_f32_16x16x32_bf16 v[156:159], a[28:31], a[16:19], v[156:159]
buffer_load_dwordx4 v28, s[36:39], s53 offen offset:1024 lds
v_mfma_f32_16x16x32_bf16 v[160:163], a[32:35], a[16:19], v[160:163]
ds_read_b64_tr_b16 a[76:77], v25 offset:13472
v_mfma_f32_16x16x32_bf16 v[124:127], a[0:3], a[36:39], v[124:127]
ds_read_b64_tr_b16 a[78:79], v25 offset:13984
v_mfma_f32_16x16x32_bf16 v[140:143], a[0:3], a[40:43], v[140:143]
ds_read_b64_tr_b16 a[80:81], v25 offset:14464
v_mfma_f32_16x16x32_bf16 v[144:147], a[4:7], a[40:43], v[144:147]
buffer_load_dword v29, s[36:39], s53 offen offset:2048 lds
v_mfma_f32_16x16x32_bf16 v[128:131], a[4:7], a[36:39], v[128:131]
ds_read_b64_tr_b16 a[82:83], v25 offset:14976
s_add_u32 s53, s53, 128
v_mfma_f32_16x16x32_bf16 v[132:135], a[8:11], a[36:39], v[132:135]
ds_read_b64_tr_b16 a[84:85], v25 offset:14496
v_mfma_f32_16x16x32_bf16 v[148:151], a[8:11], a[40:43], v[148:151]
ds_read_b64_tr_b16 a[86:87], v25 offset:15008
v_mfma_f32_16x16x32_bf16 v[152:155], a[12:15], a[40:43], v[152:155]
v_mfma_f32_16x16x32_bf16 v[136:139], a[12:15], a[36:39], v[136:139]
s_waitcnt vmcnt(22) lgkmcnt(8)
s_barrier
v_mfma_f32_16x16x32_bf16 v[60:63], a[64:67], a[44:47], v[60:63]
ds_read_b128 a[0:3], v23
s_add_u32 m0, s56, 73984
v_mfma_f32_16x16x32_bf16 v[76:79], a[68:71], a[44:47], v[76:79]
buffer_load_dwordx4 v18, s[20:23], s54 offen lds
v_mfma_f32_16x16x32_bf16 v[80:83], a[68:71], a[48:51], v[80:83]
ds_read_b128 a[4:7], v23 offset:2304
v_mfma_f32_16x16x32_bf16 v[64:67], a[64:67], a[48:51], v[64:67]
ds_read_b128 a[8:11], v23 offset:4608
v_mfma_f32_16x16x32_bf16 v[68:71], a[64:67], a[52:55], v[68:71]
ds_read_b128 a[12:15], v23 offset:6912
v_mfma_f32_16x16x32_bf16 v[84:87], a[68:71], a[52:55], v[84:87]
buffer_load_dwordx4 v19, s[20:23], s54 offen offset:1024 lds
v_mfma_f32_16x16x32_bf16 v[88:91], a[68:71], a[56:59], v[88:91]
ds_read_b64_tr_b16 a[20:21], v25 offset:24832
v_mfma_f32_16x16x32_bf16 v[72:75], a[64:67], a[56:59], v[72:75]
ds_read_b64_tr_b16 a[22:23], v25 offset:25344
s_waitcnt lgkmcnt(6)
v_mfma_f32_16x16x32_bf16 v[244:247], a[64:67], a[60:63], v[244:247]
v_mfma_f32_16x16x32_bf16 v[104:107], a[72:75], a[56:59], v[104:107]
buffer_load_dwordx4 v20, s[20:23], s54 offen offset:2048 lds
v_mfma_f32_16x16x32_bf16 v[120:123], a[76:79], a[56:59], v[120:123]
ds_read_b64_tr_b16 a[24:25], v25 offset:24864
s_add_u32 s54, s54, 196608
v_mfma_f32_16x16x32_bf16 v[116:119], a[76:79], a[52:55], v[116:119]
ds_read_b64_tr_b16 a[26:27], v25 offset:25376
v_mfma_f32_16x16x32_bf16 v[100:103], a[72:75], a[52:55], v[100:103]
ds_read_b128 a[16:19], v24
s_add_u32 m0, s55, 55488
v_mfma_f32_16x16x32_bf16 v[96:99], a[72:75], a[48:51], v[96:99]
buffer_load_dwordx4 v21, s[36:39], s52 offen lds
v_mfma_f32_16x16x32_bf16 v[112:115], a[76:79], a[48:51], v[112:115]
ds_read_b64_tr_b16 a[28:29], v25 offset:25856
v_mfma_f32_16x16x32_bf16 v[108:111], a[76:79], a[44:47], v[108:111]
ds_read_b64_tr_b16 a[30:31], v25 offset:26368
v_mfma_f32_16x16x32_bf16 v[92:95], a[72:75], a[44:47], v[92:95]
ds_read_b64_tr_b16 a[32:33], v25 offset:25888
v_mfma_f32_16x16x32_bf16 v[156:159], a[72:75], a[60:63], v[156:159]
buffer_load_dwordx4 v28, s[36:39], s52 offen offset:1024 lds
v_mfma_f32_16x16x32_bf16 v[160:163], a[76:79], a[60:63], v[160:163]
v_mfma_f32_16x16x32_bf16 v[124:127], a[44:47], a[80:83], v[124:127]
ds_read_b64_tr_b16 a[34:35], v25 offset:26400
v_mfma_f32_16x16x32_bf16 v[140:143], a[44:47], a[84:87], v[140:143]
ds_read_b64_tr_b16 a[36:37], v25 offset:26880
v_mfma_f32_16x16x32_bf16 v[144:147], a[48:51], a[84:87], v[144:147]
buffer_load_dword v22, s[36:39], s52 offen offset:2048 lds
v_mfma_f32_16x16x32_bf16 v[128:131], a[48:51], a[80:83], v[128:131]
ds_read_b64_tr_b16 a[38:39], v25 offset:27392
s_add_u32 s52, s52, 128
v_mfma_f32_16x16x32_bf16 v[132:135], a[52:55], a[80:83], v[132:135]
ds_read_b64_tr_b16 a[40:41], v25 offset:26912
v_mfma_f32_16x16x32_bf16 v[148:151], a[52:55], a[84:87], v[148:151]
ds_read_b64_tr_b16 a[42:43], v25 offset:27424
v_mfma_f32_16x16x32_bf16 v[152:155], a[56:59], a[84:87], v[152:155]
v_mfma_f32_16x16x32_bf16 v[136:139], a[56:59], a[80:83], v[136:139]
s_waitcnt vmcnt(22) lgkmcnt(8)
s_barrier
v_mfma_f32_16x16x32_bf16 v[60:63], a[20:23], a[0:3], v[60:63]
ds_read_b128 a[44:47], v30
s_add_u32 m0, s56, 86400
v_mfma_f32_16x16x32_bf16 v[76:79], a[24:27], a[0:3], v[76:79]
buffer_load_dwordx4 v18, s[20:23], s54 offen lds
v_mfma_f32_16x16x32_bf16 v[80:83], a[24:27], a[4:7], v[80:83]
s_sub_u32 s47, s47, 1
s_cbranch_scc1 .Lx13
.Lx13b:
v_mfma_f32_16x16x32_bf16 v[64:67], a[20:23], a[4:7], v[64:67]
ds_read_b128 a[48:51], v30 offset:2304
v_mfma_f32_16x16x32_bf16 v[68:71], a[20:23], a[8:11], v[68:71]
ds_read_b128 a[52:55], v30 offset:4608
v_mfma_f32_16x16x32_bf16 v[84:87], a[24:27], a[8:11], v[84:87]
buffer_load_dwordx4 v19, s[20:23], s54 offen offset:1024 lds
v_mfma_f32_16x16x32_bf16 v[88:91], a[24:27], a[12:15], v[88:91]
ds_read_b128 a[56:59], v30 offset:6912
v_mfma_f32_16x16x32_bf16 v[72:75], a[20:23], a[12:15], v[72:75]
ds_read_b64_tr_b16 a[64:65], v25 offset:37248
s_waitcnt lgkmcnt(5)
v_mfma_f32_16x16x32_bf16 v[244:247], a[20:23], a[16:19], v[244:247]
ds_read_b64_tr_b16 a[66:67], v25 offset:37760
v_mfma_f32_16x16x32_bf16 v[104:107], a[28:31], a[12:15], v[104:107]
buffer_load_dwordx4 v20, s[20:23], s54 offen offset:2048 lds
v_mfma_f32_16x16x32_bf16 v[120:123], a[32:35], a[12:15], v[120:123]
ds_read_b64_tr_b16 a[68:69], v25 offset:37280
s_add_u32 s54, s54, 196608
v_mfma_f32_16x16x32_bf16 v[116:119], a[32:35], a[8:11], v[116:119]
ds_read_b64_tr_b16 a[70:71], v25 offset:37792
v_mfma_f32_16x16x32_bf16 v[100:103], a[28:31], a[8:11], v[100:103]
ds_read_b128 a[60:63], v31
s_add_u32 m0, s55, 57792
v_mfma_f32_16x16x32_bf16 v[96:99], a[28:31], a[4:7], v[96:99]
buffer_load_dwordx4 v21, s[36:39], s53 offen lds
v_mfma_f32_16x16x32_bf16 v[112:115], a[32:35], a[4:7], v[112:115]
v_mfma_f32_16x16x32_bf16 v[108:111], a[32:35], a[0:3], v[108:111]
ds_read_b64_tr_b16 a[72:73], v25 offset:38272
v_mfma_f32_16x16x32_bf16 v[92:95], a[28:31], a[0:3], v[92:95]
ds_read_b64_tr_b16 a[74:75], v25 offset:38784
v_mfma_f32_16x16x32_bf16 v[156:159], a[28:31], a[16:19], v[156:159]
buffer_load_dwordx4 v28, s[36:39], s53 offen offset:1024 lds
v_mfma_f32_16x16x32_bf16 v[160:163], a[32:35], a[16:19], v[160:163]
ds_read_b64_tr_b16 a[76:77], v25 offset:38304
v_mfma_f32_16x16x32_bf16 v[124:127], a[0:3], a[36:39], v[124:127]
ds_read_b64_tr_b16 a[78:79], v25 offset:38816
v_mfma_f32_16x16x32_bf16 v[140:143], a[0:3], a[40:43], v[140:143]
ds_read_b64_tr_b16 a[80:81], v25 offset:39296
v_mfma_f32_16x16x32_bf16 v[144:147], a[4:7], a[40:43], v[144:147]
buffer_load_dword v29, s[36:39], s53 offen offset:2048 lds
v_mfma_f32_16x16x32_bf16 v[128:131], a[4:7], a[36:39], v[128:131]
ds_read_b64_tr_b16 a[82:83], v25 offset:39808
s_add_u32 s53, s53, 128
v_mfma_f32_16x16x32_bf16 v[132:135], a[8:11], a[36:39], v[132:135]
ds_read_b64_tr_b16 a[84:85], v25 offset:39328
v_mfma_f32_16x16x32_bf16 v[148:151], a[8:11], a[40:43], v[148:151]
ds_read_b64_tr_b16 a[86:87], v25 offset:39840
v_mfma_f32_16x16x32_bf16 v[152:155], a[12:15], a[40:43], v[152:155]
v_mfma_f32_16x16x32_bf16 v[136:139], a[12:15], a[36:39], v[136:139]
s_waitcnt vmcnt(24)
v_cmp_ne_u32 vcc, v36, v37
s_nop 0
s_cbranch_vccnz .Lsp14
.Lsp14b:
s_waitcnt vmcnt(21) lgkmcnt(8)
s_barrier
v_mfma_f32_16x16x32_bf16 v[60:63], a[64:67], a[44:47], v[60:63]
ds_read_b128 a[0:3], v23 offset:18496
s_add_u32 m0, s56, 98816
v_mfma_f32_16x16x32_bf16 v[76:79], a[68:71], a[44:47], v[76:79]
buffer_load_dwordx4 v18, s[20:23], s54 offen lds
v_mfma_f32_16x16x32_bf16 v[80:83], a[68:71], a[48:51], v[80:83]
ds_read_b128 a[4:7], v23 offset:20800
v_mfma_f32_16x16x32_bf16 v[64:67], a[64:67], a[48:51], v[64:67]
ds_read_b128 a[8:11], v23 offset:23104
v_mfma_f32_16x16x32_bf16 v[68:71], a[64:67], a[52:55], v[68:71]
buffer_load_dwordx4 v19, s[20:23], s54 offen offset:1024 lds
v_mfma_f32_16x16x32_bf16 v[84:87], a[68:71], a[52:55], v[84:87]
ds_read_b128 a[12:15], v23 offset:25408
v_mfma_f32_16x16x32_bf16 v[88:91], a[68:71], a[56:59], v[88:91]
ds_read_b64_tr_b16 a[20:21], v25 offset:49664
v_mfma_f32_16x16x32_bf16 v[72:75], a[64:67], a[56:59], v[72:75]
ds_read_b64_tr_b16 a[22:23], v25 offset:50176
s_waitcnt lgkmcnt(6)
v_mfma_f32_16x16x32_bf16 v[244:247], a[64:67], a[60:63], v[244:247]
buffer_load_dwordx4 v20, s[20:23], s54 offen offset:2048 lds
v_mfma_f32_16x16x32_bf16 v[104:107], a[72:75], a[56:59], v[104:107]
ds_read_b64_tr_b16 a[24:25], v25 offset:49696
s_add_u32 s54, s54, 196608
v_mfma_f32_16x16x32_bf16 v[120:123], a[76:79], a[56:59], v[120:123]
ds_read_b64_tr_b16 a[26:27], v25 offset:50208
s_add_u32 m0, s55, 0
v_mfma_f32_16x16x32_bf16 v[116:119], a[76:79], a[52:55], v[116:119]
buffer_load_dwordx4 v21, s[36:39], s52 offen lds
v_mfma_f32_16x16x32_bf16 v[100:103], a[72:75], a[52:55], v[100:103]
ds_read_b128 a[16:19], v24 offset:18496
v_mfma_f32_16x16x32_bf16 v[96:99], a[72:75], a[48:51], v[96:99]
v_mfma_f32_16x16x32_bf16 v[112:115], a[76:79], a[48:51], v[112:115]
ds_read_b64_tr_b16 a[28:29], v25 offset:50688
v_mfma_f32_16x16x32_bf16 v[108:111], a[76:79], a[44:47], v[108:111]
buffer_load_dwordx4 v28, s[36:39], s52 offen offset:1024 lds
v_mfma_f32_16x16x32_bf16 v[92:95], a[72:75], a[44:47], v[92:95]
ds_read_b64_tr_b16 a[30:31], v25 offset:51200
v_mfma_f32_16x16x32_bf16 v[156:159], a[72:75], a[60:63], v[156:159]
ds_read_b64_tr_b16 a[32:33], v25 offset:50720
v_mfma_f32_16x16x32_bf16 v[160:163], a[76:79], a[60:63], v[160:163]
buffer_load_dword v22, s[36:39], s52 offen offset:2048 lds
v_mfma_f32_16x16x32_bf16 v[124:127], a[44:47], a[80:83], v[124:127]
ds_read_b64_tr_b16 a[34:35], v25 offset:51232
s_add_u32 s52, s52, 128
v_mfma_f32_16x16x32_bf16 v[140:143], a[44:47], a[84:87], v[140:143]
ds_read_b64_tr_b16 a[36:37], v25 offset:51712
v_mfma_f32_16x16x32_bf16 v[144:147], a[48:51], a[84:87], v[144:147]
ds_read_b64_tr_b16 a[38:39], v25 offset:52224
v_mfma_f32_16x16x32_bf16 v[128:131], a[48:51], a[80:83], v[128:131]
buffer_load_dwordx4 v[164:167], v26, s[16:19], s75 offen sc1
v_mfma_f32_16x16x32_bf16 v[132:135], a[52:55], a[80:83], v[132:135]
ds_read_b64_tr_b16 a[40:41], v25 offset:51744
v_mfma_f32_16x16x32_bf16 v[148:151], a[52:55], a[84:87], v[148:151]
ds_read_b64_tr_b16 a[42:43], v25 offset:52256
v_mfma_f32_16x16x32_bf16 v[152:155], a[56:59], a[84:87], v[152:155]
v_mfma_f32_16x16x32_bf16 v[136:139], a[56:59], a[80:83], v[136:139]
s_waitcnt vmcnt(22) lgkmcnt(8)
s_barrier
v_mfma_f32_16x16x32_bf16 v[60:63], a[20:23], a[0:3], v[60:63]
ds_read_b128 a[44:47], v30 offset:18496
s_add_u32 m0, s56, 111232
v_mfma_f32_16x16x32_bf16 v[76:79], a[24:27], a[0:3], v[76:79]
buffer_load_dwordx4 v18, s[20:23], s54 offen lds
v_mfma_f32_16x16x32_bf16 v[80:83], a[24:27], a[4:7], v[80:83]
s_sub_u32 s47, s47, 1
s_cbranch_scc1 .Lx15
.Lx15b:
v_mfma_f32_16x16x32_bf16 v[64:67], a[20:23], a[4:7], v[64:67]
ds_read_b128 a[48:51], v30 offset:20800
v_mfma_f32_16x16x32_bf16 v[68:71], a[20:23], a[8:11], v[68:71]
buffer_load_dwordx4 v19, s[20:23], s54 offen offset:1024 lds
v_mfma_f32_16x16x32_bf16 v[84:87], a[24:27], a[8:11], v[84:87]
ds_read_b128 a[52:55], v30 offset:23104
v_mfma_f32_16x16x32_bf16 v[88:91], a[24:27], a[12:15], v[88:91]
ds_read_b128 a[56:59], v30 offset:25408
v_mfma_f32_16x16x32_bf16 v[72:75], a[20:23], a[12:15], v[72:75]
ds_read_b64_tr_b16 a[64:65], v25 offset:62080
s_waitcnt lgkmcnt(5)
v_mfma_f32_16x16x32_bf16 v[244:247], a[20:23], a[16:19], v[244:247]
buffer_load_dwordx4 v20, s[20:23], s54 offen offset:2048 lds
v_mfma_f32_16x16x32_bf16 v[104:107], a[28:31], a[12:15], v[104:107]
ds_read_b64_tr_b16 a[66:67], v25 offset:62592
s_add_u32 s54, s54, 196608
v_mfma_f32_16x16x32_bf16 v[120:123], a[32:35], a[12:15], v[120:123]
ds_read_b64_tr_b16 a[68:69], v25 offset:62112
s_add_u32 m0, s55, 2304
v_mfma_f32_16x16x32_bf16 v[116:119], a[32:35], a[8:11], v[116:119]
buffer_load_dwordx4 v21, s[36:39], s53 offen lds
v_mfma_f32_16x16x32_bf16 v[100:103], a[28:31], a[8:11], v[100:103]
ds_read_b64_tr_b16 a[70:71], v25 offset:62624
v_mfma_f32_16x16x32_bf16 v[96:99], a[28:31], a[4:7], v[96:99]
ds_read_b128 a[60:63], v31 offset:18496
v_mfma_f32_16x16x32_bf16 v[112:115], a[32:35], a[4:7], v[112:115]
ds_read_b64_tr_b16 a[72:73], v25 offset:63104
v_mfma_f32_16x16x32_bf16 v[108:111], a[32:35], a[0:3], v[108:111]
buffer_load_dwordx4 v28, s[36:39], s53 offen offset:1024 lds
v_mfma_f32_16x16x32_bf16 v[92:95], a[28:31], a[0:3], v[92:95]
ds_read_b64_tr_b16 a[74:75], v25 offset:63616
v_mfma_f32_16x16x32_bf16 v[156:159], a[28:31], a[16:19], v[156:159]
ds_read_b64_tr_b16 a[76:77], v25 offset:63136
v_mfma_f32_16x16x32_bf16 v[160:163], a[32:35], a[16:19], v[160:163]
buffer_load_dword v29, s[36:39], s53 offen offset:2048 lds
v_mfma_f32_16x16x32_bf16 v[124:127], a[0:3], a[36:39], v[124:127]
ds_read_b64_tr_b16 a[78:79], v25 offset:63648
s_add_u32 s53, s53, 128
v_mfma_f32_16x16x32_bf16 v[140:143], a[0:3], a[40:43], v[140:143]
ds_read_b64_tr_b16 a[80:81], v25 offset:64128
v_mfma_f32_16x16x32_bf16 v[144:147], a[4:7], a[40:43], v[144:147]
ds_read_b64_tr_b16 a[82:83], v25 offset:64640
v_mfma_f32_16x16x32_bf16 v[128:131], a[4:7], a[36:39], v[128:131]
buffer_load_dwordx4 v[168:171], v26, s[16:19], s75 offen offset:1024 sc1
v_mfma_f32_16x16x32_bf16 v[132:135], a[8:11], a[36:39], v[132:135]
ds_read_b64_tr_b16 a[84:85], v25 offset:64160
v_mfma_f32_16x16x32_bf16 v[148:151], a[8:11], a[40:43], v[148:151]
ds_read_b64_tr_b16 a[86:87], v25 offset:64672
v_mfma_f32_16x16x32_bf16 v[152:155], a[12:15], a[40:43], v[152:155]
v_mfma_f32_16x16x32_bf16 v[136:139], a[12:15], a[36:39], v[136:139]
s_waitcnt vmcnt(23) lgkmcnt(8)
s_barrier
v_mfma_f32_16x16x32_bf16 v[60:63], a[64:67], a[44:47], v[60:63]
ds_read_b128 a[0:3], v23 offset:36992
s_add_u32 m0, s56, 123648
v_mfma_f32_16x16x32_bf16 v[76:79], a[68:71], a[44:47], v[76:79]
buffer_load_dwordx4 v18, s[20:23], s54 offen lds
v_mfma_f32_16x16x32_bf16 v[80:83], a[68:71], a[48:51], v[80:83]
ds_read_b128 a[4:7], v23 offset:39296
v_mfma_f32_16x16x32_bf16 v[64:67], a[64:67], a[48:51], v[64:67]
ds_read_b128 a[8:11], v23 offset:41600
v_mfma_f32_16x16x32_bf16 v[68:71], a[64:67], a[52:55], v[68:71]
buffer_load_dwordx4 v19, s[20:23], s54 offen offset:1024 lds
v_mfma_f32_16x16x32_bf16 v[84:87], a[68:71], a[52:55], v[84:87]
ds_read_b128 a[12:15], v23 offset:43904
v_mfma_f32_16x16x32_bf16 v[88:91], a[68:71], a[56:59], v[88:91]
ds_read_b64_tr_b16 a[20:21], v25
v_mfma_f32_16x16x32_bf16 v[72:75], a[64:67], a[56:59], v[72:75]
ds_read_b64_tr_b16 a[22:23], v25 offset:512
s_waitcnt lgkmcnt(6)
v_mfma_f32_16x16x32_bf16 v[244:247], a[64:67], a[60:63], v[244:247]
buffer_load_dwordx4 v20, s[20:23], s54 offen offset:2048 lds
v_mfma_f32_16x16x32_bf16 v[104:107], a[72:75], a[56:59], v[104:107]
ds_read_b64_tr_b16 a[24:25], v25 offset:32
s_add_u32 s54, s54, 196608
v_mfma_f32_16x16x32_bf16 v[120:123], a[76:79], a[56:59], v[120:123]
ds_read_b64_tr_b16 a[26:27], v25 offset:544
s_add_u32 m0, s55, 18496
v_mfma_f32_16x16x32_bf16 v[116:119], a[76:79], a[52:55], v[116:119]
buffer_load_dwordx4 v21, s[36:39], s52 offen lds
v_mfma_f32_16x16x32_bf16 v[100:103], a[72:75], a[52:55], v[100:103]
ds_read_b128 a[16:19], v24 offset:36992
v_mfma_f32_16x16x32_bf16 v[96:99], a[72:75], a[48:51], v[96:99]
v_mfma_f32_16x16x32_bf16 v[112:115], a[76:79], a[48:51], v[112:115]
ds_read_b64_tr_b16 a[28:29], v25 offset:1024
v_mfma_f32_16x16x32_bf16 v[108:111], a[76:79], a[44:47], v[108:111]
buffer_load_dwordx4 v28, s[36:39], s52 offen offset:1024 lds
v_mfma_f32_16x16x32_bf16 v[92:95], a[72:75], a[44:47], v[92:95]
ds_read_b64_tr_b16 a[30:31], v25 offset:1536
v_mfma_f32_16x16x32_bf16 v[156:159], a[72:75], a[60:63], v[156:159]
ds_read_b64_tr_b16 a[32:33], v25 offset:1056
v_mfma_f32_16x16x32_bf16 v[160:163], a[76:79], a[60:63], v[160:163]
buffer_load_dword v22, s[36:39], s52 offen offset:2048 lds
v_mfma_f32_16x16x32_bf16 v[124:127], a[44:47], a[80:83], v[124:127]
ds_read_b64_tr_b16 a[34:35], v25 offset:1568
s_add_u32 s52, s52, 128
v_mfma_f32_16x16x32_bf16 v[140:143], a[44:47], a[84:87], v[140:143]
ds_read_b64_tr_b16 a[36:37], v25 offset:2048
v_mfma_f32_16x16x32_bf16 v[144:147], a[48:51], a[84:87], v[144:147]
ds_read_b64_tr_b16 a[38:39], v25 offset:2560
v_mfma_f32_16x16x32_bf16 v[128:131], a[48:51], a[80:83], v[128:131]
buffer_load_dwordx4 v[172:175], v26, s[16:19], s75 offen offset:2048 sc1
v_mfma_f32_16x16x32_bf16 v[132:135], a[52:55], a[80:83], v[132:135]
ds_read_b64_tr_b16 a[40:41], v25 offset:2080
v_mfma_f32_16x16x32_bf16 v[148:151], a[52:55], a[84:87], v[148:151]
ds_read_b64_tr_b16 a[42:43], v25 offset:2592
v_mfma_f32_16x16x32_bf16 v[152:155], a[56:59], a[84:87], v[152:155]
v_mfma_f32_16x16x32_bf16 v[136:139], a[56:59], a[80:83], v[136:139]
s_waitcnt vmcnt(24) lgkmcnt(8)
s_barrier
v_mfma_f32_16x16x32_bf16 v[60:63], a[20:23], a[0:3], v[60:63]
ds_read_b128 a[44:47], v30 offset:36992
s_add_u32 m0, s56, 136064
v_mfma_f32_16x16x32_bf16 v[76:79], a[24:27], a[0:3], v[76:79]
buffer_load_dwordx4 v18, s[20:23], s54 offen lds
v_mfma_f32_16x16x32_bf16 v[80:83], a[24:27], a[4:7], v[80:83]
s_sub_u32 s47, s47, 1
s_cbranch_scc1 .Lx16
.Lx16b:
v_mfma_f32_16x16x32_bf16 v[64:67], a[20:23], a[4:7], v[64:67]
ds_read_b128 a[48:51], v30 offset:39296
v_mfma_f32_16x16x32_bf16 v[68:71], a[20:23], a[8:11], v[68:71]
buffer_load_dwordx4 v19, s[20:23], s54 offen offset:1024 lds
v_mfma_f32_16x16x32_bf16 v[84:87], a[24:27], a[8:11], v[84:87]
ds_read_b128 a[52:55], v30 offset:41600
v_mfma_f32_16x16x32_bf16 v[88:91], a[24:27], a[12:15], v[88:91]
ds_read_b128 a[56:59], v30 offset:43904
v_mfma_f32_16x16x32_bf16 v[72:75], a[20:23], a[12:15], v[72:75]
ds_read_b64_tr_b16 a[64:65], v25 offset:12416
s_waitcnt lgkmcnt(5)
v_mfma_f32_16x16x32_bf16 v[244:247], a[20:23], a[16:19], v[244:247]
buffer_load_dwordx4 v20, s[20:23], s54 offen offset:2048 lds
v_mfma_f32_16x16x32_bf16 v[104:107], a[28:31], a[12:15], v[104:107]
ds_read_b64_tr_b16 a[66:67], v25 offset:12928
s_add_u32 s54, s54, 196608
v_mfma_f32_16x16x32_bf16 v[120:123], a[32:35], a[12:15], v[120:123]
ds_read_b64_tr_b16 a[68:69], v25 offset:12448
s_add_u32 m0, s55, 20800
v_mfma_f32_16x16x32_bf16 v[116:119], a[32:35], a[8:11], v[116:119]
buffer_load_dwordx4 v21, s[36:39], s53 offen lds
v_mfma_f32_16x16x32_bf16 v[100:103], a[28:31], a[8:11], v[100:103]
ds_read_b64_tr_b16 a[70:71], v25 offset:12960
v_mfma_f32_16x16x32_bf16 v[96:99], a[28:31], a[4:7], v[96:99]
ds_read_b128 a[60:63], v31 offset:36992
v_mfma_f32_16x16x32_bf16 v[112:115], a[32:35], a[4:7], v[112:115]
ds_read_b64_tr_b16 a[72:73], v25 offset:13440
v_mfma_f32_16x16x32_bf16 v[108:111], a[32:35], a[0:3], v[108:111]
buffer_load_dwordx4 v28, s[36:39], s53 offen offset:1024 lds
v_mfma_f32_16x16x32_bf16 v[92:95], a[28:31], a[0:3], v[92:95]
ds_read_b64_tr_b16 a[74:75], v25 offset:13952
v_mfma_f32_16x16x32_bf16 v[156:159], a[28:31], a[16:19], v[156:159]
ds_read_b64_tr_b16 a[76:77], v25 offset:13472
v_mfma_f32_16x16x32_bf16 v[160:163], a[32:35], a[16:19], v[160:163]
buffer_load_dword v29, s[36:39], s53 offen offset:2048 lds
v_mfma_f32_16x16x32_bf16 v[124:127], a[0:3], a[36:39], v[124:127]
ds_read_b64_tr_b16 a[78:79], v25 offset:13984
s_add_u32 s53, s53, 128
v_mfma_f32_16x16x32_bf16 v[140:143], a[0:3], a[40:43], v[140:143]
ds_read_b64_tr_b16 a[80:81], v25 offset:14464
v_mfma_f32_16x16x32_bf16 v[144:147], a[4:7], a[40:43], v[144:147]
ds_read_b64_tr_b16 a[82:83], v25 offset:14976
v_mfma_f32_16x16x32_bf16 v[128:131], a[4:7], a[36:39], v[128:131]
buffer_load_dwordx4 v[176:179], v26, s[16:19], s75 offen offset:3072 sc1
v_mfma_f32_16x16x32_bf16 v[132:135], a[8:11], a[36:39], v[132:135]
ds_read_b64_tr_b16 a[84:85], v25 offset:14496
s_add_u32 s75, s75, 4096
v_mfma_f32_16x16x32_bf16 v[148:151], a[8:11], a[40:43], v[148:151]
ds_read_b64_tr_b16 a[86:87], v25 offset:15008
v_mfma_f32_16x16x32_bf16 v[152:155], a[12:15], a[40:43], v[152:155]
v_mfma_f32_16x16x32_bf16 v[136:139], a[12:15], a[36:39], v[136:139]
s_waitcnt vmcnt(25) lgkmcnt(8)
s_barrier
v_mfma_f32_16x16x32_bf16 v[60:63], a[64:67], a[44:47], v[60:63]
ds_read_b128 a[0:3], v23 offset:55488
s_add_u32 m0, s56, 73984
v_mfma_f32_16x16x32_bf16 v[76:79], a[68:71], a[44:47], v[76:79]
buffer_load_dwordx4 v18, s[20:23], s54 offen lds
v_mfma_f32_16x16x32_bf16 v[80:83], a[68:71], a[48:51], v[80:83]
ds_read_b128 a[4:7], v23 offset:57792
v_mfma_f32_16x16x32_bf16 v[64:67], a[64:67], a[48:51], v[64:67]
ds_read_b128 a[8:11], v23 offset:60096
v_mfma_f32_16x16x32_bf16 v[68:71], a[64:67], a[52:55], v[68:71]
buffer_load_dwordx4 v19, s[20:23], s54 offen offset:1024 lds
v_mfma_f32_16x16x32_bf16 v[84:87], a[68:71], a[52:55], v[84:87]
ds_read_b128 a[12:15], v23 offset:62400
v_mfma_f32_16x16x32_bf16 v[88:91], a[68:71], a[56:59], v[88:91]
ds_read_b64_tr_b16 a[20:21], v25 offset:24832
v_mfma_f32_16x16x32_bf16 v[72:75], a[64:67], a[56:59], v[72:75]
ds_read_b64_tr_b16 a[22:23], v25 offset:25344
s_waitcnt lgkmcnt(6)
v_mfma_f32_16x16x32_bf16 v[244:247], a[64:67], a[60:63], v[244:247]
buffer_load_dwordx4 v20, s[20:23], s54 offen offset:2048 lds
v_mfma_f32_16x16x32_bf16 v[104:107], a[72:75], a[56:59], v[104:107]
ds_read_b64_tr_b16 a[24:25], v25 offset:24864
s_add_u32 s54, s54, 196608
v_mfma_f32_16x16x32_bf16 v[120:123], a[76:79], a[56:59], v[120:123]
ds_read_b64_tr_b16 a[26:27], v25 offset:25376
s_add_u32 m0, s55, 36992
v_mfma_f32_16x16x32_bf16 v[116:119], a[76:79], a[52:55], v[116:119]
buffer_load_dwordx4 v21, s[36:39], s52 offen lds
v_mfma_f32_16x16x32_bf16 v[100:103], a[72:75], a[52:55], v[100:103]
ds_read_b128 a[16:19], v24 offset:55488
v_mfma_f32_16x16x32_bf16 v[96:99], a[72:75], a[48:51], v[96:99]
v_mfma_f32_16x16x32_bf16 v[112:115], a[76:79], a[48:51], v[112:115]
ds_read_b64_tr_b16 a[28:29], v25 offset:25856
v_mfma_f32_16x16x32_bf16 v[108:111], a[76:79], a[44:47], v[108:111]
buffer_load_dwordx4 v28, s[36:39], s52 offen offset:1024 lds
v_mfma_f32_16x16x32_bf16 v[92:95], a[72:75], a[44:47], v[92:95]
ds_read_b64_tr_b16 a[30:31], v25 offset:26368
v_mfma_f32_16x16x32_bf16 v[156:159], a[72:75], a[60:63], v[156:159]
ds_read_b64_tr_b16 a[32:33], v25 offset:25888
v_mfma_f32_16x16x32_bf16 v[160:163], a[76:79], a[60:63], v[160:163]
buffer_load_dword v22, s[36:39], s52 offen offset:2048 lds
v_mfma_f32_16x16x32_bf16 v[124:127], a[44:47], a[80:83], v[124:127]
ds_read_b64_tr_b16 a[34:35], v25 offset:26400
s_add_u32 s52, s52, 128
v_mfma_f32_16x16x32_bf16 v[140:143], a[44:47], a[84:87], v[140:143]
ds_read_b64_tr_b16 a[36:37], v25 offset:26880
v_mfma_f32_16x16x32_bf16 v[144:147], a[48:51], a[84:87], v[144:147]
ds_read_b64_tr_b16 a[38:39], v25 offset:27392
v_mfma_f32_16x16x32_bf16 v[128:131], a[48:51], a[80:83], v[128:131]
buffer_load_dwordx4 v[180:183], v26, s[16:19], s75 offen sc1
v_mfma_f32_16x16x32_bf16 v[132:135], a[52:55], a[80:83], v[132:135]
ds_read_b64_tr_b16 a[40:41], v25 offset:26912
v_mfma_f32_16x16x32_bf16 v[148:151], a[52:55], a[84:87], v[148:151]
ds_read_b64_tr_b16 a[42:43], v25 offset:27424
v_mfma_f32_16x16x32_bf16 v[152:155], a[56:59], a[84:87], v[152:155]
v_mfma_f32_16x16x32_bf16 v[136:139], a[56:59], a[80:83], v[136:139]
s_waitcnt vmcnt(25) lgkmcnt(8)
s_barrier
v_mfma_f32_16x16x32_bf16 v[60:63], a[20:23], a[0:3], v[60:63]
ds_read_b128 a[44:47], v30 offset:55488
s_add_u32 m0, s56, 86400
v_mfma_f32_16x16x32_bf16 v[76:79], a[24:27], a[0:3], v[76:79]
buffer_load_dwordx4 v18, s[20:23], s54 offen lds
v_mfma_f32_16x16x32_bf16 v[80:83], a[24:27], a[4:7], v[80:83]
s_sub_u32 s47, s47, 1
s_cbranch_scc1 .Lx17
.Lx17b:
v_mfma_f32_16x16x32_bf16 v[64:67], a[20:23], a[4:7], v[64:67]
ds_read_b128 a[48:51], v30 offset:57792
s_waitcnt vmcnt(22)
v_add_f32 v164, v164, v168
v_mfma_f32_16x16x32_bf16 v[68:71], a[20:23], a[8:11], v[68:71]
buffer_load_dwordx4 v19, s[20:23], s54 offen offset:1024 lds
v_mfma_f32_16x16x32_bf16 v[84:87], a[24:27], a[8:11], v[84:87]
ds_read_b128 a[52:55], v30 offset:60096
v_mfma_f32_16x16x32_bf16 v[88:91], a[24:27], a[12:15], v[88:91]
ds_read_b128 a[56:59], v30 offset:62400
v_mfma_f32_16x16x32_bf16 v[72:75], a[20:23], a[12:15], v[72:75]
ds_read_b64_tr_b16 a[64:65], v25 offset:37248
s_waitcnt lgkmcnt(5)
v_mfma_f32_16x16x32_bf16 v[244:247], a[20:23], a[16:19], v[244:247]
buffer_load_dwordx4 v20, s[20:23], s54 offen offset:2048 lds
v_mfma_f32_16x16x32_bf16 v[104:107], a[28:31], a[12:15], v[104:107]
ds_read_b64_tr_b16 a[66:67], v25 offset:37760
s_add_u32 s54, s54, 196608
v_mfma_f32_16x16x32_bf16 v[120:123], a[32:35], a[12:15], v[120:123]
ds_read_b64_tr_b16 a[68:69], v25 offset:37280
s_add_u32 m0, s55, 39296
v_mfma_f32_16x16x32_bf16 v[116:119], a[32:35], a[8:11], v[116:119]
buffer_load_dwordx4 v21, s[36:39], s53 offen lds
v_mfma_f32_16x16x32_bf16 v[100:103], a[28:31], a[8:11], v[100:103]
ds_read_b64_tr_b16 a[70:71], v25 offset:37792
v_add_f32 v165, v165, v169
v_mfma_f32_16x16x32_bf16 v[96:99], a[28:31], a[4:7], v[96:99]
ds_read_b128 a[60:63], v31 offset:55488
v_mfma_f32_16x16x32_bf16 v[112:115], a[32:35], a[4:7], v[112:115]
ds_read_b64_tr_b16 a[72:73], v25 offset:38272
v_mfma_f32_16x16x32_bf16 v[108:111], a[32:35], a[0:3], v[108:111]
buffer_load_dwordx4 v28, s[36:39], s53 offen offset:1024 lds
v_mfma_f32_16x16x32_bf16 v[92:95], a[28:31], a[0:3], v[92:95]
ds_read_b64_tr_b16 a[74:75], v25 offset:38784
v_mfma_f32_16x16x32_bf16 v[156:159], a[28:31], a[16:19], v[156:159]
ds_read_b64_tr_b16 a[76:77], v25 offset:38304
v_add_f32 v166, v166, v170
v_mfma_f32_16x16x32_bf16 v[160:163], a[32:35], a[16:19], v[160:163]
buffer_load_dword v29, s[36:39], s53 offen offset:2048 lds
v_mfma_f32_16x16x32_bf16 v[124:127], a[0:3], a[36:39], v[124:127]
ds_read_b64_tr_b16 a[78:79], v25 offset:38816
s_add_u32 s53, s53, 128
v_mfma_f32_16x16x32_bf16 v[140:143], a[0:3], a[40:43], v[140:143]
ds_read_b64_tr_b16 a[80:81], v25 offset:39296
v_mfma_f32_16x16x32_bf16 v[144:147], a[4:7], a[40:43], v[144:147]
ds_read_b64_tr_b16 a[82:83], v25 offset:39808
v_mfma_f32_16x16x32_bf16 v[128:131], a[4:7], a[36:39], v[128:131]
buffer_load_dwordx4 v[184:187], v26, s[16:19], s75 offen offset:1024 sc1
v_mfma_f32_16x16x32_bf16 v[132:135], a[8:11], a[36:39], v[132:135]
ds_read_b64_tr_b16 a[84:85], v25 offset:39328
v_add_f32 v167, v167, v171
v_mfma_f32_16x16x32_bf16 v[148:151], a[8:11], a[40:43], v[148:151]
ds_read_b64_tr_b16 a[86:87], v25 offset:39840
v_mfma_f32_16x16x32_bf16 v[152:155], a[12:15], a[40:43], v[152:155]
v_mfma_f32_16x16x32_bf16 v[136:139], a[12:15], a[36:39], v[136:139]
s_waitcnt vmcnt(25) lgkmcnt(8)
s_barrier
v_mfma_f32_16x16x32_bf16 v[60:63], a[64:67], a[44:47], v[60:63]
ds_read_b128 a[0:3], v23
s_add_u32 m0, s56, 98816
v_mfma_f32_16x16x32_bf16 v[76:79], a[68:71], a[44:47], v[76:79]
buffer_load_dwordx4 v18, s[20:23], s54 offen lds
v_mfma_f32_16x16x32_bf16 v[80:83], a[68:71], a[48:51], v[80:83]
ds_read_b128 a[4:7], v23 offset:2304
s_waitcnt vmcnt(22)
v_add_f32 v164, v164, v172
v_mfma_f32_16x16x32_bf16 v[64:67], a[64:67], a[48:51], v[64:67]
ds_read_b128 a[8:11], v23 offset:4608
v_mfma_f32_16x16x32_bf16 v[68:71], a[64:67], a[52:55], v[68:71]
buffer_load_dwordx4 v19, s[20:23], s54 offen offset:1024 lds
v_mfma_f32_16x16x32_bf16 v[84:87], a[68:71], a[52:55], v[84:87]
ds_read_b128 a[12:15], v23 offset:6912
v_mfma_f32_16x16x32_bf16 v[88:91], a[68:71], a[56:59], v[88:91]
ds_read_b64_tr_b16 a[20:21], v25 offset:49664
v_mfma_f32_16x16x32_bf16 v[72:75], a[64:67], a[56:59], v[72:75]
ds_read_b64_tr_b16 a[22:23], v25 offset:50176
s_waitcnt lgkmcnt(6)
v_mfma_f32_16x16x32_bf16 v[244:247], a[64:67], a[60:63], v[244:247]
buffer_load_dwordx4 v20, s[20:23], s54 offen offset:2048 lds
v_mfma_f32_16x16x32_bf16 v[104:107], a[72:75], a[56:59], v[104:107]
ds_read_b64_tr_b16 a[24:25], v25 offset:49696
s_add_u32 s54, s54, 196608
v_mfma_f32_16x16x32_bf16 v[120:123], a[76:79], a[56:59], v[120:123]
ds_read_b64_tr_b16 a[26:27], v25 offset:50208
s_add_u32 m0, s55, 55488
v_mfma_f32_16x16x32_bf16 v[116:119], a[76:79], a[52:55], v[116:119]
buffer_load_dwordx4 v21, s[36:39], s52 offen lds
v_mfma_f32_16x16x32_bf16 v[100:103], a[72:75], a[52:55], v[100:103]
ds_read_b128 a[16:19], v24
v_add_f32 v165, v165, v173
v_mfma_f32_16x16x32_bf16 v[96:99], a[72:75], a[48:51], v[96:99]
v_mfma_f32_16x16x32_bf16 v[112:115], a[76:79], a[48:51], v[112:115]
ds_read_b64_tr_b16 a[28:29], v25 offset:50688
v_mfma_f32_16x16x32_bf16 v[108:111], a[76:79], a[44:47], v[108:111]
buffer_load_dwordx4 v28, s[36:39], s52 offen offset:1024 lds
v_mfma_f32_16x16x32_bf16 v[92:95], a[72:75], a[44:47], v[92:95]
ds_read_b64_tr_b16 a[30:31], v25 offset:51200
v_add_f32 v166, v166, v174
v_mfma_f32_16x16x32_bf16 v[156:159], a[72:75], a[60:63], v[156:159]
ds_read_b64_tr_b16 a[32:33], v25 offset:50720
v_mfma_f32_16x16x32_bf16 v[160:163], a[76:79], a[60:63], v[160:163]
buffer_load_dword v22, s[36:39], s52 offen offset:2048 lds
v_mfma_f32_16x16x32_bf16 v[124:127], a[44:47], a[80:83], v[124:127]
ds_read_b64_tr_b16 a[34:35], v25 offset:51232
s_add_u32 s52, s52, 128
v_mfma_f32_16x16x32_bf16 v[140:143], a[44:47], a[84:87], v[140:143]
ds_read_b64_tr_b16 a[36:37], v25 offset:51712
v_mfma_f32_16x16x32_bf16 v[144:147], a[48:51], a[84:87], v[144:147]
ds_read_b64_tr_b16 a[38:39], v25 offset:52224
v_mfma_f32_16x16x32_bf16 v[128:131], a[48:51], a[80:83], v[128:131]
buffer_load_dwordx4 v[188:191], v26, s[16:19], s75 offen offset:2048 sc1
v_mfma_f32_16x16x32_bf16 v[132:135], a[52:55], a[80:83], v[132:135]
ds_read_b64_tr_b16 a[40:41], v25 offset:51744
v_add_f32 v167, v167, v175
v_mfma_f32_16x16x32_bf16 v[148:151], a[52:55], a[84:87], v[148:151]
ds_read_b64_tr_b16 a[42:43], v25 offset:52256
v_mfma_f32_16x16x32_bf16 v[152:155], a[56:59], a[84:87], v[152:155]
v_mfma_f32_16x16x32_bf16 v[136:139], a[56:59], a[80:83], v[136:139]
s_waitcnt vmcnt(25) lgkmcnt(8)
s_barrier
v_mfma_f32_16x16x32_bf16 v[60:63], a[20:23], a[0:3], v[60:63]
ds_read_b128 a[44:47], v30
s_add_u32 m0, s56, 111232
v_mfma_f32_16x16x32_bf16 v[76:79], a[24:27], a[0:3], v[76:79]
buffer_load_dwordx4 v18, s[20:23], s54 offen lds
v_mfma_f32_16x16x32_bf16 v[80:83], a[24:27], a[4:7], v[80:83]
ds_read_b128 a[48:51], v30 offset:2304
s_waitcnt vmcnt(22)
v_add_f32 v164, v164, v176
v_mfma_f32_16x16x32_bf16 v[64:67], a[20:23], a[4:7], v[64:67]
ds_read_b128 a[52:55], v30 offset:4608
v_mfma_f32_16x16x32_bf16 v[68:71], a[20:23], a[8:11], v[68:71]
buffer_load_dwordx4 v19, s[20:23], s54 offen offset:1024 lds
v_mfma_f32_16x16x32_bf16 v[84:87], a[24:27], a[8:11], v[84:87]
ds_read_b128 a[56:59], v30 offset:6912
v_mfma_f32_16x16x32_bf16 v[88:91], a[24:27], a[12:15], v[88:91]
ds_read_b64_tr_b16 a[64:65], v25 offset:62080
v_mfma_f32_16x16x32_bf16 v[72:75], a[20:23], a[12:15], v[72:75]
ds_read_b64_tr_b16 a[66:67], v25 offset:62592
s_waitcnt lgkmcnt(6)
v_mfma_f32_16x16x32_bf16 v[244:247], a[20:23], a[16:19], v[244:247]
buffer_load_dwordx4 v20, s[20:23], s54 offen offset:2048 lds
v_mfma_f32_16x16x32_bf16 v[104:107], a[28:31], a[12:15], v[104:107]
ds_read_b64_tr_b16 a[68:69], v25 offset:62112
s_add_u32 s54, s54, 196608
v_mfma_f32_16x16x32_bf16 v[120:123], a[32:35], a[12:15], v[120:123]
ds_read_b64_tr_b16 a[70:71], v25 offset:62624
s_add_u32 m0, s55, 57792
v_mfma_f32_16x16x32_bf16 v[116:119], a[32:35], a[8:11], v[116:119]
buffer_load_dwordx4 v21, s[36:39], s53 offen lds
v_mfma_f32_16x16x32_bf16 v[100:103], a[28:31], a[8:11], v[100:103]
ds_read_b128 a[60:63], v31
v_add_f32 v165, v165, v177
v_mfma_f32_16x16x32_bf16 v[96:99], a[28:31], a[4:7], v[96:99]
v_mfma_f32_16x16x32_bf16 v[112:115], a[32:35], a[4:7], v[112:115]
ds_read_b64_tr_b16 a[72:73], v25 offset:63104
v_mfma_f32_16x16x32_bf16 v[108:111], a[32:35], a[0:3], v[108:111]
buffer_load_dwordx4 v28, s[36:39], s53 offen offset:1024 lds
v_mfma_f32_16x16x32_bf16 v[92:95], a[28:31], a[0:3], v[92:95]
ds_read_b64_tr_b16 a[74:75], v25 offset:63616
v_add_f32 v166, v166, v178
v_mfma_f32_16x16x32_bf16 v[156:159], a[28:31], a[16:19], v[156:159]
ds_read_b64_tr_b16 a[76:77], v25 offset:63136
v_mfma_f32_16x16x32_bf16 v[160:163], a[32:35], a[16:19], v[160:163]
buffer_load_dword v29, s[36:39], s53 offen offset:2048 lds
v_mfma_f32_16x16x32_bf16 v[124:127], a[0:3], a[36:39], v[124:127]
ds_read_b64_tr_b16 a[78:79], v25 offset:63648
s_add_u32 s53, s53, 128
v_mfma_f32_16x16x32_bf16 v[140:143], a[0:3], a[40:43], v[140:143]
ds_read_b64_tr_b16 a[80:81], v25 offset:64128
v_mfma_f32_16x16x32_bf16 v[144:147], a[4:7], a[40:43], v[144:147]
ds_read_b64_tr_b16 a[82:83], v25 offset:64640
v_mfma_f32_16x16x32_bf16 v[128:131], a[4:7], a[36:39], v[128:131]
buffer_load_dwordx4 v[192:195], v26, s[16:19], s75 offen offset:3072 sc1
v_mfma_f32_16x16x32_bf16 v[132:135], a[8:11], a[36:39], v[132:135]
ds_read_b64_tr_b16 a[84:85], v25 offset:64160
v_add_f32 v167, v167, v179
v_mfma_f32_16x16x32_bf16 v[148:151], a[8:11], a[40:43], v[148:151]
ds_read_b64_tr_b16 a[86:87], v25 offset:64672
v_mfma_f32_16x16x32_bf16 v[152:155], a[12:15], a[40:43], v[152:155]
v_mfma_f32_16x16x32_bf16 v[136:139], a[12:15], a[36:39], v[136:139]
s_waitcnt vmcnt(25) lgkmcnt(8)
s_barrier
v_mfma_f32_16x16x32_bf16 v[60:63], a[64:67], a[44:47], v[60:63]
ds_read_b128 a[0:3], v23 offset:18496
s_add_u32 m0, s56, 123648
v_mfma_f32_16x16x32_bf16 v[76:79], a[68:71], a[44:47], v[76:79]
buffer_load_dwordx4 v18, s[20:23], s54 offen lds
v_mfma_f32_16x16x32_bf16 v[80:83], a[68:71], a[48:51], v[80:83]
ds_read_b128 a[4:7], v23 offset:20800
s_waitcnt vmcnt(22)
v_add_f32 v164, v164, v180
v_mfma_f32_16x16x32_bf16 v[64:67], a[64:67], a[48:51], v[64:67]
ds_read_b128 a[8:11], v23 offset:23104
v_mfma_f32_16x16x32_bf16 v[68:71], a[64:67], a[52:55], v[68:71]
v_mfma_f32_16x16x32_bf16 v[84:87], a[68:71], a[52:55], v[84:87]
ds_read_b128 a[12:15], v23 offset:25408
v_mfma_f32_16x16x32_bf16 v[88:91], a[68:71], a[56:59], v[88:91]
ds_read_b64_tr_b16 a[20:21], v25
v_mfma_f32_16x16x32_bf16 v[72:75], a[64:67], a[56:59], v[72:75]
ds_read_b64_tr_b16 a[22:23], v25 offset:512
s_waitcnt lgkmcnt(6)
v_mfma_f32_16x16x32_bf16 v[244:247], a[64:67], a[60:63], v[244:247]
v_add_f32 v165, v165, v181
v_mfma_f32_16x16x32_bf16 v[104:107], a[72:75], a[56:59], v[104:107]
buffer_load_dwordx4 v19, s[20:23], s54 offen offset:1024 lds
v_mfma_f32_16x16x32_bf16 v[120:123], a[76:79], a[56:59], v[120:123]
ds_read_b64_tr_b16 a[24:25], v25 offset:32
v_mfma_f32_16x16x32_bf16 v[116:119], a[76:79], a[52:55], v[116:119]
ds_read_b64_tr_b16 a[26:27], v25 offset:544
v_mfma_f32_16x16x32_bf16 v[100:103], a[72:75], a[52:55], v[100:103]
ds_read_b128 a[16:19], v24 offset:18496
v_mfma_f32_16x16x32_bf16 v[96:99], a[72:75], a[48:51], v[96:99]
v_mfma_f32_16x16x32_bf16 v[112:115], a[76:79], a[48:51], v[112:115]
ds_read_b64_tr_b16 a[28:29], v25 offset:1024
v_add_f32 v166, v166, v182
v_mfma_f32_16x16x32_bf16 v[108:111], a[76:79], a[44:47], v[108:111]
ds_read_b64_tr_b16 a[30:31], v25 offset:1536
v_mfma_f32_16x16x32_bf16 v[92:95], a[72:75], a[44:47], v[92:95]
ds_read_b64_tr_b16 a[32:33], v25 offset:1056
v_mfma_f32_16x16x32_bf16 v[156:159], a[72:75], a[60:63], v[156:159]
buffer_load_dwordx4 v20, s[20:23], s54 offen offset:2048 lds
v_mfma_f32_16x16x32_bf16 v[160:163], a[76:79], a[60:63], v[160:163]
s_add_u32 s54, s54, 196608
v_mfma_f32_16x16x32_bf16 v[124:127], a[44:47], a[80:83], v[124:127]
ds_read_b64_tr_b16 a[34:35], v25 offset:1568
v_mfma_f32_16x16x32_bf16 v[140:143], a[44:47], a[84:87], v[140:143]
ds_read_b64_tr_b16 a[36:37], v25 offset:2048
v_mfma_f32_16x16x32_bf16 v[144:147], a[48:51], a[84:87], v[144:147]
ds_read_b64_tr_b16 a[38:39], v25 offset:2560
v_add_f32 v167, v167, v183
v_mfma_f32_16x16x32_bf16 v[128:131], a[48:51], a[80:83], v[128:131]
v_mfma_f32_16x16x32_bf16 v[132:135], a[52:55], a[80:83], v[132:135]
ds_read_b64_tr_b16 a[40:41], v25 offset:2080
v_mfma_f32_16x16x32_bf16 v[148:151], a[52:55], a[84:87], v[148:151]
ds_read_b64_tr_b16 a[42:43], v25 offset:2592
v_mfma_f32_16x16x32_bf16 v[152:155], a[56:59], a[84:87], v[152:155]
v_mfma_f32_16x16x32_bf16 v[136:139], a[56:59], a[80:83], v[136:139]
s_waitcnt vmcnt(21) lgkmcnt(8)
s_barrier
v_mfma_f32_16x16x32_bf16 v[60:63], a[20:23], a[0:3], v[60:63]
ds_read_b128 a[44:47], v30 offset:18496
s_add_u32 m0, s56, 136064
v_mfma_f32_16x16x32_bf16 v[76:79], a[24:27], a[0:3], v[76:79]
buffer_load_dwordx4 v18, s[20:23], s54 offen lds
v_mfma_f32_16x16x32_bf16 v[80:83], a[24:27], a[4:7], v[80:83]
ds_read_b128 a[48:51], v30 offset:20800
s_waitcnt vmcnt(18)
v_add_f32 v164, v164, v184
v_mfma_f32_16x16x32_bf16 v[64:67], a[20:23], a[4:7], v[64:67]
ds_read_b128 a[52:55], v30 offset:23104
v_mfma_f32_16x16x32_bf16 v[68:71], a[20:23], a[8:11], v[68:71]
v_mfma_f32_16x16x32_bf16 v[84:87], a[24:27], a[8:11], v[84:87]
ds_read_b128 a[56:59], v30 offset:25408
v_mfma_f32_16x16x32_bf16 v[88:91], a[24:27], a[12:15], v[88:91]
ds_read_b64_tr_b16 a[64:65], v25 offset:12416
v_mfma_f32_16x16x32_bf16 v[72:75], a[20:23], a[12:15], v[72:75]
ds_read_b64_tr_b16 a[66:67], v25 offset:12928
s_waitcnt lgkmcnt(6)
v_mfma_f32_16x16x32_bf16 v[244:247], a[20:23], a[16:19], v[244:247]
v_add_f32 v165, v165, v185
v_mfma_f32_16x16x32_bf16 v[104:107], a[28:31], a[12:15], v[104:107]
buffer_load_dwordx4 v19, s[20:23], s54 offen offset:1024 lds
v_mfma_f32_16x16x32_bf16 v[120:123], a[32:35], a[12:15], v[120:123]
ds_read_b64_tr_b16 a[68:69], v25 offset:12448
v_mfma_f32_16x16x32_bf16 v[116:119], a[32:35], a[8:11], v[116:119]
ds_read_b64_tr_b16 a[70:71], v25 offset:12960
v_mfma_f32_16x16x32_bf16 v[100:103], a[28:31], a[8:11], v[100:103]
ds_read_b128 a[60:63], v31 offset:18496
v_mfma_f32_16x16x32_bf16 v[96:99], a[28:31], a[4:7], v[96:99]
v_mfma_f32_16x16x32_bf16 v[112:115], a[32:35], a[4:7], v[112:115]
ds_read_b64_tr_b16 a[72:73], v25 offset:13440
v_add_f32 v166, v166, v186
v_mfma_f32_16x16x32_bf16 v[108:111], a[32:35], a[0:3], v[108:111]
ds_read_b64_tr_b16 a[74:75], v25 offset:13952
v_mfma_f32_16x16x32_bf16 v[92:95], a[28:31], a[0:3], v[92:95]
ds_read_b64_tr_b16 a[76:77], v25 offset:13472
v_mfma_f32_16x16x32_bf16 v[156:159], a[28:31], a[16:19], v[156:159]
buffer_load_dwordx4 v20, s[20:23], s54 offen offset:2048 lds
v_mfma_f32_16x16x32_bf16 v[160:163], a[32:35], a[16:19], v[160:163]
s_add_u32 s54, s54, 196608
v_mfma_f32_16x16x32_bf16 v[124:127], a[0:3], a[36:39], v[124:127]
ds_read_b64_tr_b16 a[78:79], v25 offset:13984
v_mfma_f32_16x16x32_bf16 v[140:143], a[0:3], a[40:43], v[140:143]
ds_read_b64_tr_b16 a[80:81], v25 offset:14464
v_mfma_f32_16x16x32_bf16 v[144:147], a[4:7], a[40:43], v[144:147]
ds_read_b64_tr_b16 a[82:83], v25 offset:14976
v_add_f32 v167, v167, v187
v_mfma_f32_16x16x32_bf16 v[128:131], a[4:7], a[36:39], v[128:131]
v_mfma_f32_16x16x32_bf16 v[132:135], a[8:11], a[36:39], v[132:135]
ds_read_b64_tr_b16 a[84:85], v25 offset:14496
v_mfma_f32_16x16x32_bf16 v[148:151], a[8:11], a[40:43], v[148:151]
ds_read_b64_tr_b16 a[86:87], v25 offset:15008
v_mfma_f32_16x16x32_bf16 v[152:155], a[12:15], a[40:43], v[152:155]
v_mfma_f32_16x16x32_bf16 v[136:139], a[12:15], a[36:39], v[136:139]
s_waitcnt vmcnt(17) lgkmcnt(8)
s_barrier
v_mfma_f32_16x16x32_bf16 v[60:63], a[64:67], a[44:47], v[60:63]
s_add_u32 m0, s59, 0
s_mov_b32 s58, 1048576
s_waitcnt vmcnt(13)
v_add_f32 v164, v164, v188
v_mfma_f32_16x16x32_bf16 v[76:79], a[68:71], a[44:47], v[76:79]
buffer_load_dwordx4 v5, s[24:27], s58 offen lds
v_mfma_f32_16x16x32_bf16 v[80:83], a[68:71], a[48:51], v[80:83]
ds_read_b128 a[0:3], v23 offset:36992
v_mfma_f32_16x16x32_bf16 v[64:67], a[64:67], a[48:51], v[64:67]
ds_read_b128 a[4:7], v23 offset:39296
v_mfma_f32_16x16x32_bf16 v[68:71], a[64:67], a[52:55], v[68:71]
ds_read_b128 a[8:11], v23 offset:41600
v_mfma_f32_16x16x32_bf16 v[84:87], a[68:71], a[52:55], v[84:87]
buffer_load_dwordx4 v6, s[24:27], s58 offen offset:1024 lds
v_mfma_f32_16x16x32_bf16 v[88:91], a[68:71], a[56:59], v[88:91]
ds_read_b128 a[12:15], v23 offset:43904
v_add_f32 v165, v165, v189
v_mfma_f32_16x16x32_bf16 v[72:75], a[64:67], a[56:59], v[72:75]
ds_read_b64_tr_b16 a[20:21], v25 offset:24832
s_waitcnt lgkmcnt(5)
v_mfma_f32_16x16x32_bf16 v[244:247], a[64:67], a[60:63], v[244:247]
s_add_u32 m0, s59, 8320
s_mov_b32 s58, 1179648
v_mfma_f32_16x16x32_bf16 v[104:107], a[72:75], a[56:59], v[104:107]
buffer_load_dwordx4 v5, s[24:27], s58 offen lds
v_mfma_f32_16x16x32_bf16 v[120:123], a[76:79], a[56:59], v[120:123]
ds_read_b64_tr_b16 a[22:23], v25 offset:25344
v_mfma_f32_16x16x32_bf16 v[116:119], a[76:79], a[52:55], v[116:119]
ds_read_b64_tr_b16 a[24:25], v25 offset:24864
v_mfma_f32_16x16x32_bf16 v[100:103], a[72:75], a[52:55], v[100:103]
ds_read_b64_tr_b16 a[26:27], v25 offset:25376
v_mfma_f32_16x16x32_bf16 v[96:99], a[72:75], a[48:51], v[96:99]
buffer_load_dwordx4 v6, s[24:27], s58 offen offset:1024 lds
v_mfma_f32_16x16x32_bf16 v[112:115], a[76:79], a[48:51], v[112:115]
ds_read_b128 a[16:19], v24 offset:36992
v_add_f32 v166, v166, v190
v_mfma_f32_16x16x32_bf16 v[108:111], a[76:79], a[44:47], v[108:111]
ds_read_b64_tr_b16 a[28:29], v25 offset:25856
v_mfma_f32_16x16x32_bf16 v[92:95], a[72:75], a[44:47], v[92:95]
s_add_u32 m0, s59, 16640
s_mov_b32 s58, 1310720
v_mfma_f32_16x16x32_bf16 v[156:159], a[72:75], a[60:63], v[156:159]
buffer_load_dwordx4 v5, s[24:27], s58 offen lds
v_mfma_f32_16x16x32_bf16 v[160:163], a[76:79], a[60:63], v[160:163]
ds_read_b64_tr_b16 a[30:31], v25 offset:26368
v_mfma_f32_16x16x32_bf16 v[124:127], a[44:47], a[80:83], v[124:127]
ds_read_b64_tr_b16 a[32:33], v25 offset:25888
v_mfma_f32_16x16x32_bf16 v[140:143], a[44:47], a[84:87], v[140:143]
ds_read_b64_tr_b16 a[34:35], v25 offset:26400
v_add_f32 v167, v167, v191
v_mfma_f32_16x16x32_bf16 v[144:147], a[48:51], a[84:87], v[144:147]
buffer_load_dwordx4 v6, s[24:27], s58 offen offset:1024 lds
v_mfma_f32_16x16x32_bf16 v[128:131], a[48:51], a[80:83], v[128:131]
ds_read_b64_tr_b16 a[36:37], v25 offset:26880
v_mfma_f32_16x16x32_bf16 v[132:135], a[52:55], a[80:83], v[132:135]
ds_read_b64_tr_b16 a[38:39], v25 offset:27392
v_mfma_f32_16x16x32_bf16 v[148:151], a[52:55], a[84:87], v[148:151]
ds_read_b64_tr_b16 a[40:41], v25 offset:26912
v_mfma_f32_16x16x32_bf16 v[152:155], a[56:59], a[84:87], v[152:155]
ds_read_b64_tr_b16 a[42:43], v25 offset:27424
v_mfma_f32_16x16x32_bf16 v[136:139], a[56:59], a[80:83], v[136:139]
s_waitcnt vmcnt(16) lgkmcnt(8)
s_barrier
v_mfma_f32_16x16x32_bf16 v[60:63], a[20:23], a[0:3], v[60:63]
s_add_u32 m0, s59, 24960
s_mov_b32 s58, 1441792
s_waitcnt vmcnt(12)
v_add_f32 v164, v164, v192
v_mfma_f32_16x16x32_bf16 v[76:79], a[24:27], a[0:3], v[76:79]
buffer_load_dwordx4 v5, s[24:27], s58 offen lds
v_mfma_f32_16x16x32_bf16 v[80:83], a[24:27], a[4:7], v[80:83]
ds_read_b128 a[44:47], v30 offset:36992
v_mfma_f32_16x16x32_bf16 v[64:67], a[20:23], a[4:7], v[64:67]
ds_read_b128 a[48:51], v30 offset:39296
v_mfma_f32_16x16x32_bf16 v[68:71], a[20:23], a[8:11], v[68:71]
ds_read_b128 a[52:55], v30 offset:41600
v_mfma_f32_16x16x32_bf16 v[84:87], a[24:27], a[8:11], v[84:87]
buffer_load_dwordx4 v6, s[24:27], s58 offen offset:1024 lds
v_mfma_f32_16x16x32_bf16 v[88:91], a[24:27], a[12:15], v[88:91]
ds_read_b128 a[56:59], v30 offset:43904
v_add_f32 v165, v165, v193
v_mfma_f32_16x16x32_bf16 v[72:75], a[20:23], a[12:15], v[72:75]
ds_read_b64_tr_b16 a[64:65], v25 offset:37248
s_waitcnt lgkmcnt(5)
v_mfma_f32_16x16x32_bf16 v[244:247], a[20:23], a[16:19], v[244:247]
s_add_u32 m0, s59, 74880
s_mov_b32 s58, 131072
v_mfma_f32_16x16x32_bf16 v[104:107], a[28:31], a[12:15], v[104:107]
buffer_load_dwordx4 v5, s[24:27], s58 offen lds
v_mfma_f32_16x16x32_bf16 v[120:123], a[32:35], a[12:15], v[120:123]
ds_read_b64_tr_b16 a[66:67], v25 offset:37760
v_mfma_f32_16x16x32_bf16 v[116:119], a[32:35], a[8:11], v[116:119]
ds_read_b64_tr_b16 a[68:69], v25 offset:37280
v_mfma_f32_16x16x32_bf16 v[100:103], a[28:31], a[8:11], v[100:103]
ds_read_b64_tr_b16 a[70:71], v25 offset:37792
v_mfma_f32_16x16x32_bf16 v[96:99], a[28:31], a[4:7], v[96:99]
buffer_load_dwordx4 v6, s[24:27], s58 offen offset:1024 lds
v_mfma_f32_16x16x32_bf16 v[112:115], a[32:35], a[4:7], v[112:115]
ds_read_b128 a[60:63], v31 offset:36992
v_add_f32 v166, v166, v194
v_mfma_f32_16x16x32_bf16 v[108:111], a[32:35], a[0:3], v[108:111]
ds_read_b64_tr_b16 a[72:73], v25 offset:38272
v_mfma_f32_16x16x32_bf16 v[92:95], a[28:31], a[0:3], v[92:95]
s_add_u32 m0, s59, 83200
s_mov_b32 s58, 262144
v_mfma_f32_16x16x32_bf16 v[156:159], a[28:31], a[16:19], v[156:159]
buffer_load_dwordx4 v5, s[24:27], s58 offen lds
v_mfma_f32_16x16x32_bf16 v[160:163], a[32:35], a[16:19], v[160:163]
ds_read_b64_tr_b16 a[74:75], v25 offset:38784
v_mfma_f32_16x16x32_bf16 v[124:127], a[0:3], a[36:39], v[124:127]
ds_read_b64_tr_b16 a[76:77], v25 offset:38304
v_mfma_f32_16x16x32_bf16 v[140:143], a[0:3], a[40:43], v[140:143]
ds_read_b64_tr_b16 a[78:79], v25 offset:38816
v_add_f32 v167, v167, v195
v_mfma_f32_16x16x32_bf16 v[144:147], a[4:7], a[40:43], v[144:147]
buffer_load_dwordx4 v6, s[24:27], s58 offen offset:1024 lds
v_mfma_f32_16x16x32_bf16 v[128:131], a[4:7], a[36:39], v[128:131]
ds_read_b64_tr_b16 a[80:81], v25 offset:39296
v_mfma_f32_16x16x32_bf16 v[132:135], a[8:11], a[36:39], v[132:135]
ds_read_b64_tr_b16 a[82:83], v25 offset:39808
v_mfma_f32_16x16x32_bf16 v[148:151], a[8:11], a[40:43], v[148:151]
ds_read_b64_tr_b16 a[84:85], v25 offset:39328
v_mfma_f32_16x16x32_bf16 v[152:155], a[12:15], a[40:43], v[152:155]
ds_read_b64_tr_b16 a[86:87], v25 offset:39840
v_mfma_f32_16x16x32_bf16 v[136:139], a[12:15], a[36:39], v[136:139]
s_waitcnt vmcnt(15) lgkmcnt(8)
s_barrier
v_mfma_f32_16x16x32_bf16 v[60:63], a[64:67], a[44:47], v[60:63]
s_add_u32 m0, s59, 33280
s_mov_b32 s58, 1572864
v_permlane32_swap_b32 v164, v166
v_mfma_f32_16x16x32_bf16 v[76:79], a[68:71], a[44:47], v[76:79]
buffer_load_dwordx4 v5, s[24:27], s58 offen lds
v_mfma_f32_16x16x32_bf16 v[80:83], a[68:71], a[48:51], v[80:83]
ds_read_b128 a[0:3], v23 offset:55488
v_mfma_f32_16x16x32_bf16 v[64:67], a[64:67], a[48:51], v[64:67]
ds_read_b128 a[4:7], v23 offset:57792
v_permlane32_swap_b32 v165, v167
v_mfma_f32_16x16x32_bf16 v[68:71], a[64:67], a[52:55], v[68:71]
ds_read_b128 a[8:11], v23 offset:60096
v_mfma_f32_16x16x32_bf16 v[84:87], a[68:71], a[52:55], v[84:87]
buffer_load_dwordx4 v6, s[24:27], s58 offen offset:1024 lds
v_mfma_f32_16x16x32_bf16 v[88:91], a[68:71], a[56:59], v[88:91]
ds_read_b128 a[12:15], v23 offset:62400
v_add_f32 v164, v164, v166
v_mfma_f32_16x16x32_bf16 v[72:75], a[64:67], a[56:59], v[72:75]
ds_read_b64_tr_b16 a[20:21], v25 offset:49664
s_waitcnt lgkmcnt(5)
v_mfma_f32_16x16x32_bf16 v[244:247], a[64:67], a[60:63], v[244:247]
s_add_u32 m0, s59, 41600
s_mov_b32 s58, 1703936
v_mfma_f32_16x16x32_bf16 v[104:107], a[72:75], a[56:59], v[104:107]
buffer_load_dwordx4 v5, s[24:27], s58 offen lds
v_mfma_f32_16x16x32_bf16 v[120:123], a[76:79], a[56:59], v[120:123]
ds_read_b64_tr_b16 a[22:23], v25 offset:50176
v_add_f32 v165, v165, v167
v_mfma_f32_16x16x32_bf16 v[116:119], a[76:79], a[52:55], v[116:119]
ds_read_b64_tr_b16 a[24:25], v25 offset:49696
v_mfma_f32_16x16x32_bf16 v[100:103], a[72:75], a[52:55], v[100:103]
ds_read_b64_tr_b16 a[26:27], v25 offset:50208
v_mul_f32 v164, 0xba800000, v164
v_mfma_f32_16x16x32_bf16 v[96:99], a[72:75], a[48:51], v[96:99]
buffer_load_dwordx4 v6, s[24:27], s58 offen offset:1024 lds
v_mfma_f32_16x16x32_bf16 v[112:115], a[76:79], a[48:51], v[112:115]
ds_read_b128 a[16:19], v24 offset:55488
v_mfma_f32_16x16x32_bf16 v[108:111], a[76:79], a[44:47], v[108:111]
ds_read_b64_tr_b16 a[28:29], v25 offset:50688
v_mul_f32 v165, 0x3a800000, v165
v_mfma_f32_16x16x32_bf16 v[92:95], a[72:75], a[44:47], v[92:95]
s_add_u32 m0, s59, 91520
s_mov_b32 s58, 393216
v_mfma_f32_16x16x32_bf16 v[156:159], a[72:75], a[60:63], v[156:159]
buffer_load_dwordx4 v5, s[24:27], s58 offen lds
v_mfma_f32_16x16x32_bf16 v[160:163], a[76:79], a[60:63], v[160:163]
ds_read_b64_tr_b16 a[30:31], v25 offset:51200
v_fma_f32 v165, -v164, v164, v165
v_mfma_f32_16x16x32_bf16 v[124:127], a[44:47], a[80:83], v[124:127]
ds_read_b64_tr_b16 a[32:33], v25 offset:50720
v_mfma_f32_16x16x32_bf16 v[140:143], a[44:47], a[84:87], v[140:143]
ds_read_b64_tr_b16 a[34:35], v25 offset:51232
v_max_f32 v165, 0, v165
v_mfma_f32_16x16x32_bf16 v[144:147], a[48:51], a[84:87], v[144:147]
buffer_load_dwordx4 v6, s[24:27], s58 offen offset:1024 lds
v_mfma_f32_16x16x32_bf16 v[128:131], a[48:51], a[80:83], v[128:131]
ds_read_b64_tr_b16 a[36:37], v25 offset:51712
v_mfma_f32_16x16x32_bf16 v[132:135], a[52:55], a[80:83], v[132:135]
ds_read_b64_tr_b16 a[38:39], v25 offset:52224
v_add_f32 v165, 0x3727c5ac, v165
v_mfma_f32_16x16x32_bf16 v[148:151], a[52:55], a[84:87], v[148:151]
ds_read_b64_tr_b16 a[40:41], v25 offset:51744
v_mfma_f32_16x16x32_bf16 v[152:155], a[56:59], a[84:87], v[152:155]
ds_read_b64_tr_b16 a[42:43], v25 offset:52256
v_mfma_f32_16x16x32_bf16 v[136:139], a[56:59], a[80:83], v[136:139]
s_waitcnt vmcnt(18) lgkmcnt(8)
s_barrier
v_mfma_f32_16x16x32_bf16 v[60:63], a[20:23], a[0:3], v[60:63]
s_add_u32 m0, s59, 99840
s_mov_b32 s58, 524288
v_rsq_f32 v166, v165
v_mfma_f32_16x16x32_bf16 v[76:79], a[24:27], a[0:3], v[76:79]
buffer_load_dwordx4 v5, s[24:27], s58 offen lds
v_mfma_f32_16x16x32_bf16 v[80:83], a[24:27], a[4:7], v[80:83]
ds_read_b128 a[44:47], v30 offset:55488
v_mfma_f32_16x16x32_bf16 v[64:67], a[20:23], a[4:7], v[64:67]
ds_read_b128 a[48:51], v30 offset:57792
v_mfma_f32_16x16x32_bf16 v[68:71], a[20:23], a[8:11], v[68:71]
ds_read_b128 a[52:55], v30 offset:60096
v_mfma_f32_16x16x32_bf16 v[84:87], a[24:27], a[8:11], v[84:87]
ds_read_b128 a[56:59], v30 offset:62400
v_mov_b32 v165, v166
v_mfma_f32_16x16x32_bf16 v[88:91], a[24:27], a[12:15], v[88:91]
ds_read_b64_tr_b16 a[64:65], v25 offset:62080
v_mfma_f32_16x16x32_bf16 v[72:75], a[20:23], a[12:15], v[72:75]
ds_read_b64_tr_b16 a[66:67], v25 offset:62592
s_waitcnt lgkmcnt(6)
v_mfma_f32_16x16x32_bf16 v[244:247], a[20:23], a[16:19], v[244:247]
buffer_load_dwordx4 v6, s[24:27], s58 offen offset:1024 lds
v_mfma_f32_16x16x32_bf16 v[104:107], a[28:31], a[12:15], v[104:107]
v_mfma_f32_16x16x32_bf16 v[120:123], a[32:35], a[12:15], v[120:123]
ds_read_b64_tr_b16 a[68:69], v25 offset:62112
v_mul_f32 v166, 0x3e8293ee, v166
v_mfma_f32_16x16x32_bf16 v[116:119], a[32:35], a[8:11], v[116:119]
ds_read_b64_tr_b16 a[70:71], v25 offset:62624
v_mfma_f32_16x16x32_bf16 v[100:103], a[28:31], a[8:11], v[100:103]
s_add_u32 m0, s59, 108160
s_mov_b32 s58, 655360
v_mfma_f32_16x16x32_bf16 v[96:99], a[28:31], a[4:7], v[96:99]
buffer_load_dwordx4 v5, s[24:27], s58 offen lds
v_mfma_f32_16x16x32_bf16 v[112:115], a[32:35], a[4:7], v[112:115]
ds_read_b128 a[60:63], v31 offset:55488
v_mfma_f32_16x16x32_bf16 v[108:111], a[32:35], a[0:3], v[108:111]
ds_read_b64_tr_b16 a[72:73], v25 offset:63104
ds_write_b128 v7, v[164:167]
v_mfma_f32_16x16x32_bf16 v[92:95], a[28:31], a[0:3], v[92:95]
ds_read_b64_tr_b16 a[74:75], v25 offset:63616
v_mfma_f32_16x16x32_bf16 v[156:159], a[28:31], a[16:19], v[156:159]
ds_read_b64_tr_b16 a[76:77], v25 offset:63136
v_mfma_f32_16x16x32_bf16 v[160:163], a[32:35], a[16:19], v[160:163]
ds_write_b32 v17, v164
v_mfma_f32_16x16x32_bf16 v[124:127], a[0:3], a[36:39], v[124:127]
buffer_load_dwordx4 v6, s[24:27], s58 offen offset:1024 lds
v_mfma_f32_16x16x32_bf16 v[140:143], a[0:3], a[40:43], v[140:143]
ds_read_b64_tr_b16 a[78:79], v25 offset:63648
v_mfma_f32_16x16x32_bf16 v[144:147], a[4:7], a[40:43], v[144:147]
ds_read_b64_tr_b16 a[80:81], v25 offset:64128
v_mfma_f32_16x16x32_bf16 v[128:131], a[4:7], a[36:39], v[128:131]
ds_read_b64_tr_b16 a[82:83], v25 offset:64640
v_mfma_f32_16x16x32_bf16 v[132:135], a[8:11], a[36:39], v[132:135]
ds_read_b64_tr_b16 a[84:85], v25 offset:64160
ds_write_b32 v17, v165 offset:1024
v_mfma_f32_16x16x32_bf16 v[148:151], a[8:11], a[40:43], v[148:151]
ds_read_b64_tr_b16 a[86:87], v25 offset:64672
v_mfma_f32_16x16x32_bf16 v[152:155], a[12:15], a[40:43], v[152:155]
v_mfma_f32_16x16x32_bf16 v[136:139], a[12:15], a[36:39], v[136:139]
s_waitcnt lgkmcnt(0)
s_barrier
v_mfma_f32_16x16x32_bf16 v[244:247], a[64:67], a[60:63], v[244:247]
ds_read_b128 v[232:235], v10 offset:768
v_mfma_f32_16x16x32_bf16 v[156:159], a[72:75], a[60:63], v[156:159]
ds_read_b128 v[236:239], v10 offset:2816
v_mfma_f32_16x16x32_bf16 v[160:163], a[76:79], a[60:63], v[160:163]
ds_read_b128 v[228:231], v10 offset:512
v_mfma_f32_16x16x32_bf16 v[104:107], a[72:75], a[56:59], v[104:107]
ds_read_b128 v[224:227], v10 offset:256
v_mfma_f32_16x16x32_bf16 v[120:123], a[76:79], a[56:59], v[120:123]
ds_read_b128 v[220:223], v10
v_mfma_f32_16x16x32_bf16 v[136:139], a[56:59], a[80:83], v[136:139]
v_mfma_f32_16x16x32_bf16 v[152:155], a[56:59], a[84:87], v[152:155]
v_mfma_f32_16x16x32_bf16 v[100:103], a[72:75], a[52:55], v[100:103]
v_mfma_f32_16x16x32_bf16 v[116:119], a[76:79], a[52:55], v[116:119]
s_mov_b32 exec_lo, 0x10001
s_mov_b32 exec_hi, 0x10001
ds_write_b128 v13, v[244:247]
ds_write_b128 v13, v[156:159] offset:256
ds_write_b128 v13, v[160:163] offset:320
s_mov_b64 exec, -1
v_mfma_f32_16x16x32_bf16 v[96:99], a[72:75], a[48:51], v[96:99]
v_mfma_f32_16x16x32_bf16 v[112:115], a[76:79], a[48:51], v[112:115]
v_mfma_f32_16x16x32_bf16 v[92:95], a[72:75], a[44:47], v[92:95]
v_mfma_f32_16x16x32_bf16 v[108:111], a[76:79], a[44:47], v[108:111]
v_mfma_f32_16x16x32_bf16 v[72:75], a[64:67], a[56:59], v[72:75]
v_mfma_f32_16x16x32_bf16 v[88:91], a[68:71], a[56:59], v[88:91]
s_waitcnt lgkmcnt(0)
s_barrier
v_mfma_f32_16x16x32_bf16 v[132:135], a[52:55], a[80:83], v[132:135]
ds_read_b128 v[28:31], v13
s_add_u32 m0, s59, 49920
v_mfma_f32_16x16x32_bf16 v[148:151], a[52:55], a[84:87], v[148:151]
ds_read_b128 v[32:35], v13 offset:64
s_mov_b32 s58, 1835008
v_mfma_f32_16x16x32_bf16 v[68:71], a[64:67], a[52:55], v[68:71]
ds_read_b128 v[36:39], v13 offset:256
v_mfma_f32_16x16x32_bf16 v[84:87], a[68:71], a[52:55], v[84:87]
ds_read_b128 v[40:43], v13 offset:320
v_mfma_f32_16x16x32_bf16 v[128:131], a[48:51], a[80:83], v[128:131]
ds_read_b32 v44, v12 offset:512
v_mfma_f32_16x16x32_bf16 v[144:147], a[48:51], a[84:87], v[144:147]
ds_read_b32 v45, v12 offset:576
v_mfma_f32_16x16x32_bf16 v[64:67], a[64:67], a[48:51], v[64:67]
ds_read_b128 v[240:243], v11 offset:192
v_mfma_f32_16x16x32_bf16 v[80:83], a[68:71], a[48:51], v[80:83]
ds_read_b128 v[244:247], v11 offset:1216
v_mfma_f32_16x16x32_bf16 v[124:127], a[44:47], a[80:83], v[124:127]
buffer_load_dwordx4 v5, s[24:27], s58 offen lds
ds_read_b128 v[18:21], v11 offset:128
s_waitcnt lgkmcnt(8)
v_pk_fma_f32 v[72:73], v[28:29], v[232:233], v[72:73] op_sel_hi:[1,0,1]
v_pk_fma_f32 v[74:75], v[30:31], v[232:233], v[74:75] op_sel_hi:[1,0,1]
s_waitcnt lgkmcnt(6)
v_pk_fma_f32 v[104:105], v[36:37], v[232:233], v[104:105] op_sel_hi:[1,0,1]
v_pk_mul_f32 v[104:105], v[104:105], v[232:233] op_sel:[0,1] op_sel_hi:[1,1]
v_pk_fma_f32 v[106:107], v[38:39], v[232:233], v[106:107] op_sel_hi:[1,0,1]
v_pk_mul_f32 v[106:107], v[106:107], v[232:233] op_sel:[0,1] op_sel_hi:[1,1]
s_waitcnt lgkmcnt(5)
v_pk_fma_f32 v[120:121], v[40:41], v[232:233], v[120:121] op_sel_hi:[1,0,1]
v_pk_mul_f32 v[120:121], v[120:121], v[232:233] op_sel:[0,1] op_sel_hi:[1,1]
v_pk_fma_f32 v[122:123], v[42:43], v[232:233], v[122:123] op_sel_hi:[1,0,1]
v_pk_mul_f32 v[122:123], v[122:123], v[232:233] op_sel:[0,1] op_sel_hi:[1,1]
v_pk_fma_f32 v[100:101], v[36:37], v[228:229], v[100:101] op_sel_hi:[1,0,1]
v_pk_mul_f32 v[100:101], v[100:101], v[228:229] op_sel:[0,1] op_sel_hi:[1,1]
v_pk_fma_f32 v[102:103], v[38:39], v[228:229], v[102:103] op_sel_hi:[1,0,1]
v_pk_mul_f32 v[102:103], v[102:103], v[228:229] op_sel:[0,1] op_sel_hi:[1,1]
v_pk_fma_f32 v[116:117], v[40:41], v[228:229], v[116:117] op_sel_hi:[1,0,1]
v_pk_mul_f32 v[116:117], v[116:117], v[228:229] op_sel:[0,1] op_sel_hi:[1,1]
v_pk_fma_f32 v[118:119], v[42:43], v[228:229], v[118:119] op_sel_hi:[1,0,1]
v_pk_mul_f32 v[118:119], v[118:119], v[228:229] op_sel:[0,1] op_sel_hi:[1,1]
s_waitcnt lgkmcnt(2)
v_pk_fma_f32 v[136:137], v[240:241], v[44:45], v[136:137] op_sel_hi:[1,0,1]
v_pk_fma_f32 v[138:139], v[242:243], v[44:45], v[138:139] op_sel_hi:[1,0,1]
v_pk_fma_f32 v[152:153], v[240:241], v[44:45], v[152:153] op_sel:[0,1,0] op_sel_hi:[1,1,1]
v_pk_fma_f32 v[154:155], v[242:243], v[44:45], v[154:155] op_sel:[0,1,0] op_sel_hi:[1,1,1]
s_waitcnt lgkmcnt(1)
v_pk_mul_f32 v[136:137], v[136:137], v[244:245]
v_pk_mul_f32 v[138:139], v[138:139], v[246:247]
v_pk_mul_f32 v[152:153], v[152:153], v[244:245]
v_pk_mul_f32 v[154:155], v[154:155], v[246:247]
v_pk_fma_f32 v[88:89], v[32:33], v[232:233], v[88:89] op_sel_hi:[1,0,1]
v_pk_fma_f32 v[90:91], v[34:35], v[232:233], v[90:91] op_sel_hi:[1,0,1]
v_pk_fma_f32 v[96:97], v[36:37], v[224:225], v[96:97] op_sel_hi:[1,0,1]
s_waitcnt lgkmcnt(0)
v_pk_fma_f32 v[132:133], v[18:19], v[44:45], v[132:133] op_sel_hi:[1,0,1]
v_pk_fma_f32 v[134:135], v[20:21], v[44:45], v[134:135] op_sel_hi:[1,0,1]
v_pk_fma_f32 v[148:149], v[18:19], v[44:45], v[148:149] op_sel:[0,1,0] op_sel_hi:[1,1,1]
v_pk_fma_f32 v[150:151], v[20:21], v[44:45], v[150:151] op_sel:[0,1,0] op_sel_hi:[1,1,1]
v_pk_mul_f32 v[96:97], v[96:97], v[224:225] op_sel:[0,1] op_sel_hi:[1,1]
v_pk_fma_f32 v[98:99], v[38:39], v[224:225], v[98:99] op_sel_hi:[1,0,1]
v_pk_mul_f32 v[98:99], v[98:99], v[224:225] op_sel:[0,1] op_sel_hi:[1,1]
v_pk_fma_f32 v[112:113], v[40:41], v[224:225], v[112:113] op_sel_hi:[1,0,1]
v_pk_mul_f32 v[112:113], v[112:113], v[224:225] op_sel:[0,1] op_sel_hi:[1,1]
v_pk_fma_f32 v[114:115], v[42:43], v[224:225], v[114:115] op_sel_hi:[1,0,1]
v_pk_mul_f32 v[114:115], v[114:115], v[224:225] op_sel:[0,1] op_sel_hi:[1,1]
v_pk_fma_f32 v[68:69], v[28:29], v[228:229], v[68:69] op_sel_hi:[1,0,1]
v_pk_fma_f32 v[70:71], v[30:31], v[228:229], v[70:71] op_sel_hi:[1,0,1]
v_pk_fma_f32 v[84:85], v[32:33], v[228:229], v[84:85] op_sel_hi:[1,0,1]
v_pk_fma_f32 v[86:87], v[34:35], v[228:229], v[86:87] op_sel_hi:[1,0,1]
v_pk_fma_f32 v[92:93], v[36:37], v[220:221], v[92:93] op_sel_hi:[1,0,1]
v_pk_mul_f32 v[92:93], v[92:93], v[220:221] op_sel:[0,1] op_sel_hi:[1,1]
v_pk_fma_f32 v[94:95], v[38:39], v[220:221], v[94:95] op_sel_hi:[1,0,1]
v_pk_mul_f32 v[94:95], v[94:95], v[220:221] op_sel:[0,1] op_sel_hi:[1,1]
v_pk_fma_f32 v[108:109], v[40:41], v[220:221], v[108:109] op_sel_hi:[1,0,1]
v_pk_mul_f32 v[108:109], v[108:109], v[220:221] op_sel:[0,1] op_sel_hi:[1,1]
v_pk_fma_f32 v[110:111], v[42:43], v[220:221], v[110:111] op_sel_hi:[1,0,1]
v_pk_mul_f32 v[110:111], v[110:111], v[220:221] op_sel:[0,1] op_sel_hi:[1,1]
v_pk_fma_f32 v[64:65], v[28:29], v[224:225], v[64:65] op_sel_hi:[1,0,1]
v_pk_fma_f32 v[66:67], v[30:31], v[224:225], v[66:67] op_sel_hi:[1,0,1]
v_pk_fma_f32 v[80:81], v[32:33], v[224:225], v[80:81] op_sel_hi:[1,0,1]
v_pk_fma_f32 v[82:83], v[34:35], v[224:225], v[82:83] op_sel_hi:[1,0,1]
v_pk_fma_f32 v[156:157], v[36:37], v[236:237], v[156:157] op_sel_hi:[1,0,1]
v_pk_mul_f32 v[156:157], v[156:157], v[236:237] op_sel:[0,1] op_sel_hi:[1,1]
v_pk_fma_f32 v[158:159], v[38:39], v[236:237], v[158:159] op_sel_hi:[1,0,1]
v_pk_mul_f32 v[158:159], v[158:159], v[236:237] op_sel:[0,1] op_sel_hi:[1,1]
v_pk_fma_f32 v[160:161], v[40:41], v[236:237], v[160:161] op_sel_hi:[1,0,1]
v_pk_mul_f32 v[160:161], v[160:161], v[236:237] op_sel:[0,1] op_sel_hi:[1,1]
v_pk_fma_f32 v[162:163], v[42:43], v[236:237], v[162:163] op_sel_hi:[1,0,1]
v_pk_mul_f32 v[162:163], v[162:163], v[236:237] op_sel:[0,1] op_sel_hi:[1,1]
v_cvt_pk_bf16_f32 v196, v104, v105
v_cvt_pk_bf16_f32 v197, v106, v107
v_mfma_f32_16x16x32_bf16 v[140:143], a[44:47], a[84:87], v[140:143]
buffer_load_dwordx4 v6, s[24:27], s58 offen offset:1024 lds
v_mfma_f32_16x16x32_bf16 v[60:63], a[64:67], a[44:47], v[60:63]
s_add_u32 m0, s59, 58240
v_cvt_pk_bf16_f32 v198, v120, v121
v_cvt_pk_bf16_f32 v199, v122, v123
v_mfma_f32_16x16x32_bf16 v[76:79], a[68:71], a[44:47], v[76:79]
ds_write_b128 v8, v[196:199]
v_cvt_pk_bf16_f32 v208, v136, v137
v_cvt_pk_bf16_f32 v209, v138, v139
v_cvt_pk_bf16_f32 v218, v152, v153
v_cvt_pk_bf16_f32 v219, v154, v155
ds_write_b64 v8, v[208:209] offset:1024
ds_write_b64 v8, v[218:219] offset:1032
s_mov_b32 s58, 1966080
buffer_load_dwordx4 v5, s[24:27], s58 offen lds
v_cvt_pk_bf16_f32 v192, v100, v101
v_cvt_pk_bf16_f32 v193, v102, v103
v_cvt_pk_bf16_f32 v194, v116, v117
v_cvt_pk_bf16_f32 v195, v118, v119
v_cvt_pk_bf16_f32 v176, v72, v73
v_cvt_pk_bf16_f32 v177, v74, v75
v_cvt_pk_bf16_f32 v178, v88, v89
v_cvt_pk_bf16_f32 v179, v90, v91
v_pk_fma_f32 v[60:61], v[28:29], v[220:221], v[60:61] op_sel_hi:[1,0,1]
v_pk_fma_f32 v[62:63], v[30:31], v[220:221], v[62:63] op_sel_hi:[1,0,1]
v_pk_fma_f32 v[76:77], v[32:33], v[220:221], v[76:77] op_sel_hi:[1,0,1]
v_pk_fma_f32 v[78:79], v[34:35], v[220:221], v[78:79] op_sel_hi:[1,0,1]
ds_read_b128 v[22:25], v11 offset:1152
s_nop 0
v_mfma_f32_16x16x32_bf16 v[104:107], v[192:195], v[176:179], v[46:49]
buffer_load_dwordx4 v6, s[24:27], s58 offen offset:1024 lds
v_mfma_f32_16x16x32_bf16 v[120:123], v[196:199], v[176:179], v[50:53]
s_add_u32 m0, s59, 66560
s_mov_b32 s58, 0
v_cvt_pk_bf16_f32 v188, v96, v97
v_cvt_pk_bf16_f32 v189, v98, v99
s_nop 1
v_max3_f32 v88, v104, v105, v106
v_cvt_pk_bf16_f32 v190, v112, v113
v_cvt_pk_bf16_f32 v191, v114, v115
s_waitcnt lgkmcnt(1)
s_barrier
ds_read_b64 v[200:201], v9 offset:1024
ds_read_b64 v[210:211], v9 offset:1032
buffer_load_dwordx4 v5, s[24:27], s58 offen lds
v_max3_f32 v89, v107, v120, v121
v_max3_f32 v88, v88, v122, v123
v_max_f32 v90, v88, v89
v_max_f32 v89, v88, v89
v_cvt_pk_bf16_f32 v172, v68, v69
v_cvt_pk_bf16_f32 v173, v70, v71
v_permlane16_swap_b32 v90, v89
v_cvt_pk_bf16_f32 v174, v84, v85
v_max_f32 v88, v90, v89
s_waitcnt lgkmcnt(2)
v_pk_mul_f32 v[132:133], v[132:133], v[22:23]
v_cvt_pk_bf16_f32 v206, v132, v133
v_pk_mul_f32 v[134:135], v[134:135], v[24:25]
buffer_load_dwordx4 v6, s[24:27], s58 offen offset:1024 lds
s_add_u32 m0, s59, 116480
s_mov_b32 s58, 786432
v_cvt_pk_bf16_f32 v207, v134, v135
v_pk_mul_f32 v[148:149], v[148:149], v[22:23]
v_cvt_pk_bf16_f32 v216, v148, v149
v_pk_mul_f32 v[150:151], v[150:151], v[24:25]
v_cvt_pk_bf16_f32 v217, v150, v151
v_max_f32 v89, v90, v89
v_cvt_pk_bf16_f32 v175, v86, v87
ds_read_b128 v[240:243], v11 offset:64
s_nop 0
v_mfma_f32_16x16x32_bf16 v[100:103], v[188:191], v[172:175], v[46:49]
ds_read_b128 v[244:247], v11 offset:1088
v_permlane32_swap_b32 v88, v89
v_mfma_f32_16x16x32_bf16 v[116:119], v[192:195], v[172:175], v[50:53]
buffer_load_dwordx4 v5, s[24:27], s58 offen lds
v_max_f32 v88, v88, v89
v_mul_f32 v88, v88, v234
s_nop 1
v_max3_f32 v84, v100, v101, v102
v_pk_fma_f32 v[104:105], v[104:105], v[234:235], v[88:89] op_sel_hi:[1,0,0] neg_lo:[0,0,1] neg_hi:[0,0,1]
v_pk_fma_f32 v[106:107], v[106:107], v[234:235], v[88:89] op_sel_hi:[1,0,0] neg_lo:[0,0,1] neg_hi:[0,0,1]
v_pk_fma_f32 v[120:121], v[120:121], v[234:235], v[88:89] op_sel_hi:[1,0,0] neg_lo:[0,0,1] neg_hi:[0,0,1]
v_pk_fma_f32 v[122:123], v[122:123], v[234:235], v[88:89] op_sel_hi:[1,0,0] neg_lo:[0,0,1] neg_hi:[0,0,1]
v_exp_f32 v104, v104
v_exp_f32 v105, v105
v_exp_f32 v106, v106
v_exp_f32 v107, v107
v_exp_f32 v120, v120
v_exp_f32 v121, v121
v_exp_f32 v122, v122
v_exp_f32 v123, v123
v_cvt_pk_bf16_f32 v72, v104, v105
buffer_load_dwordx4 v6, s[24:27], s58 offen offset:1024 lds
s_add_u32 m0, s59, 124800
s_mov_b32 s58, 917504
v_cvt_pk_bf16_f32 v73, v106, v107
v_cvt_pk_bf16_f32 v74, v120, v121
v_cvt_pk_bf16_f32 v75, v122, v123
s_waitcnt lgkmcnt(1)
v_pk_fma_f32 v[128:129], v[240:241], v[44:45], v[128:129] op_sel_hi:[1,0,1]
s_waitcnt lgkmcnt(0)
v_pk_mul_f32 v[128:129], v[128:129], v[244:245]
v_pk_fma_f32 v[130:131], v[242:243], v[44:45], v[130:131] op_sel_hi:[1,0,1]
v_pk_mul_f32 v[130:131], v[130:131], v[246:247]
v_pk_fma_f32 v[144:145], v[240:241], v[44:45], v[144:145] op_sel:[0,1,0] op_sel_hi:[1,1,1]
v_pk_mul_f32 v[144:145], v[144:145], v[244:245]
v_pk_fma_f32 v[146:147], v[242:243], v[44:45], v[146:147] op_sel:[0,1,0] op_sel_hi:[1,1,1]
v_pk_mul_f32 v[146:147], v[146:147], v[246:247]
v_cvt_pk_bf16_f32 v204, v128, v129
v_cvt_pk_bf16_f32 v205, v130, v131
v_mfma_f32_16x16x32_bf16 v[88:91], v[248:251], v[72:75], 0
buffer_load_dwordx4 v5, s[24:27], s58 offen lds
v_mfma_f32_16x16x32_bf16 v[104:107], v[206:209], v[72:75], 0
ds_read_b128 v[18:21], v11
v_cvt_pk_bf16_f32 v214, v144, v145
v_mfma_f32_16x16x32_bf16 v[120:123], v[216:219], v[72:75], 0
ds_read_b128 v[22:25], v11 offset:1024
s_nop 1
v_rcp_f32 v88, v88
v_cvt_pk_bf16_f32 v215, v146, v147
v_max3_f32 v85, v103, v116, v117
v_pk_mul_f32 v[104:105], v[104:105], v[88:89] op_sel_hi:[1,0]
v_pk_mul_f32 v[106:107], v[106:107], v[88:89] op_sel_hi:[1,0]
buffer_load_dwordx4 v6, s[24:27], s58 offen offset:1024 lds
v_pk_mul_f32 v[120:121], v[120:121], v[88:89] op_sel_hi:[1,0]
v_pk_mul_f32 v[122:123], v[122:123], v[88:89] op_sel_hi:[1,0]
v_cvt_pk_bf16_f32 v176, v104, v105
v_cvt_pk_bf16_f32 v177, v106, v107
v_cvt_pk_bf16_f32 v178, v120, v121
v_cvt_pk_bf16_f32 v179, v122, v123
v_max3_f32 v84, v84, v118, v119
v_max_f32 v86, v84, v85
v_max_f32 v85, v84, v85
v_cvt_pk_bf16_f32 v184, v92, v93
v_cvt_pk_bf16_f32 v185, v94, v95
v_permlane16_swap_b32 v86, v85
v_cvt_pk_bf16_f32 v186, v108, v109
buffer_store_dwordx4 v[176:179], v4, s[16:19], s74 offen offset:3072 sc1
v_max_f32 v84, v86, v85
v_max_f32 v85, v86, v85
v_cvt_pk_bf16_f32 v187, v110, v111
v_cvt_pk_bf16_f32 v168, v64, v65
v_permlane32_swap_b32 v84, v85
v_cvt_pk_bf16_f32 v169, v66, v67
v_max_f32 v84, v84, v85
v_mul_f32 v84, v84, v230
v_pk_fma_f32 v[100:101], v[100:101], v[230:231], v[84:85] op_sel_hi:[1,0,0] neg_lo:[0,0,1] neg_hi:[0,0,1]
v_pk_fma_f32 v[102:103], v[102:103], v[230:231], v[84:85] op_sel_hi:[1,0,0] neg_lo:[0,0,1] neg_hi:[0,0,1]
v_pk_fma_f32 v[116:117], v[116:117], v[230:231], v[84:85] op_sel_hi:[1,0,0] neg_lo:[0,0,1] neg_hi:[0,0,1]
v_pk_fma_f32 v[118:119], v[118:119], v[230:231], v[84:85] op_sel_hi:[1,0,0] neg_lo:[0,0,1] neg_hi:[0,0,1]
v_exp_f32 v100, v100
v_exp_f32 v101, v101
v_exp_f32 v102, v102
v_exp_f32 v103, v103
v_exp_f32 v116, v116
v_exp_f32 v117, v117
v_exp_f32 v118, v118
v_exp_f32 v119, v119
v_cvt_pk_bf16_f32 v68, v100, v101
v_cvt_pk_bf16_f32 v69, v102, v103
v_cvt_pk_bf16_f32 v70, v116, v117
v_cvt_pk_bf16_f32 v71, v118, v119
s_waitcnt lgkmcnt(1)
v_pk_fma_f32 v[124:125], v[18:19], v[44:45], v[124:125] op_sel_hi:[1,0,1]
s_waitcnt lgkmcnt(0)
v_pk_mul_f32 v[124:125], v[124:125], v[22:23]
v_pk_fma_f32 v[126:127], v[20:21], v[44:45], v[126:127] op_sel_hi:[1,0,1]
v_pk_mul_f32 v[126:127], v[126:127], v[24:25]
v_pk_fma_f32 v[140:141], v[18:19], v[44:45], v[140:141] op_sel:[0,1,0] op_sel_hi:[1,1,1]
v_pk_mul_f32 v[140:141], v[140:141], v[22:23]
v_pk_fma_f32 v[142:143], v[20:21], v[44:45], v[142:143] op_sel:[0,1,0] op_sel_hi:[1,1,1]
v_pk_mul_f32 v[142:143], v[142:143], v[24:25]
v_cvt_pk_bf16_f32 v170, v80, v81
v_cvt_pk_bf16_f32 v171, v82, v83
v_mfma_f32_16x16x32_bf16 v[84:87], v[248:251], v[68:71], 0
v_cvt_pk_bf16_f32 v202, v124, v125
v_cvt_pk_bf16_f32 v203, v126, v127
v_mfma_f32_16x16x32_bf16 v[100:103], v[204:207], v[68:71], 0
v_cvt_pk_bf16_f32 v212, v140, v141
v_cvt_pk_bf16_f32 v213, v142, v143
v_mfma_f32_16x16x32_bf16 v[116:119], v[214:217], v[68:71], 0
s_nop 1
v_rcp_f32 v84, v84
v_mfma_f32_16x16x32_bf16 v[96:99], v[184:187], v[168:171], v[46:49]
v_cvt_pk_bf16_f32 v180, v156, v157
v_cvt_pk_bf16_f32 v181, v158, v159
v_mfma_f32_16x16x32_bf16 v[112:115], v[188:191], v[168:171], v[50:53]
v_cvt_pk_bf16_f32 v182, v160, v161
v_cvt_pk_bf16_f32 v183, v162, v163
v_cvt_pk_bf16_f32 v164, v60, v61
s_nop 1
v_max3_f32 v80, v96, v97, v98
v_cvt_pk_bf16_f32 v165, v62, v63
v_pk_mul_f32 v[100:101], v[100:101], v[84:85] op_sel_hi:[1,0]
v_pk_mul_f32 v[102:103], v[102:103], v[84:85] op_sel_hi:[1,0]
v_pk_mul_f32 v[116:117], v[116:117], v[84:85] op_sel_hi:[1,0]
v_pk_mul_f32 v[118:119], v[118:119], v[84:85] op_sel_hi:[1,0]
v_cvt_pk_bf16_f32 v172, v100, v101
v_cvt_pk_bf16_f32 v173, v102, v103
v_cvt_pk_bf16_f32 v174, v116, v117
v_cvt_pk_bf16_f32 v175, v118, v119
buffer_store_dwordx4 v[172:175], v4, s[16:19], s74 offen offset:2048 sc1
v_max3_f32 v81, v99, v112, v113
v_max3_f32 v80, v80, v114, v115
v_max_f32 v82, v80, v81
v_max_f32 v81, v80, v81
v_cvt_pk_bf16_f32 v166, v76, v77
v_cvt_pk_bf16_f32 v167, v78, v79
v_permlane16_swap_b32 v82, v81
s_nop 0
v_mfma_f32_16x16x32_bf16 v[92:95], v[180:183], v[164:167], v[54:57]
v_max_f32 v80, v82, v81
v_max_f32 v81, v82, v81
v_mfma_f32_16x16x32_bf16 v[108:111], v[184:187], v[164:167], v[50:53]
s_nop 0
v_permlane32_swap_b32 v80, v81
v_max_f32 v80, v80, v81
v_mul_f32 v80, v80, v226
v_pk_fma_f32 v[96:97], v[96:97], v[226:227], v[80:81] op_sel_hi:[1,0,0] neg_lo:[0,0,1] neg_hi:[0,0,1]
v_pk_fma_f32 v[98:99], v[98:99], v[226:227], v[80:81] op_sel_hi:[1,0,0] neg_lo:[0,0,1] neg_hi:[0,0,1]
v_pk_fma_f32 v[112:113], v[112:113], v[226:227], v[80:81] op_sel_hi:[1,0,0] neg_lo:[0,0,1] neg_hi:[0,0,1]
v_pk_fma_f32 v[114:115], v[114:115], v[226:227], v[80:81] op_sel_hi:[1,0,0] neg_lo:[0,0,1] neg_hi:[0,0,1]
v_exp_f32 v96, v96
v_exp_f32 v97, v97
v_exp_f32 v98, v98
v_exp_f32 v99, v99
v_exp_f32 v112, v112
v_exp_f32 v113, v113
v_exp_f32 v114, v114
v_exp_f32 v115, v115
v_cvt_pk_bf16_f32 v64, v96, v97
v_cvt_pk_bf16_f32 v65, v98, v99
v_cvt_pk_bf16_f32 v66, v112, v113
v_cvt_pk_bf16_f32 v67, v114, v115
v_max3_f32 v76, v92, v93, v94
v_max3_f32 v77, v95, v108, v109
v_mfma_f32_16x16x32_bf16 v[80:83], v[248:251], v[64:67], 0
v_max3_f32 v76, v76, v110, v111
v_max_f32 v78, v76, v77
v_mfma_f32_16x16x32_bf16 v[96:99], v[202:205], v[64:67], 0
v_max_f32 v77, v76, v77
v_mfma_f32_16x16x32_bf16 v[112:115], v[212:215], v[64:67], 0
s_nop 2
v_rcp_f32 v80, v80
v_permlane16_swap_b32 v78, v77
s_nop 0
v_pk_mul_f32 v[96:97], v[96:97], v[80:81] op_sel_hi:[1,0]
v_pk_mul_f32 v[98:99], v[98:99], v[80:81] op_sel_hi:[1,0]
v_pk_mul_f32 v[112:113], v[112:113], v[80:81] op_sel_hi:[1,0]
v_pk_mul_f32 v[114:115], v[114:115], v[80:81] op_sel_hi:[1,0]
v_cvt_pk_bf16_f32 v168, v96, v97
v_cvt_pk_bf16_f32 v169, v98, v99
v_cvt_pk_bf16_f32 v170, v112, v113
v_cvt_pk_bf16_f32 v171, v114, v115
buffer_store_dwordx4 v[168:171], v4, s[16:19], s74 offen offset:1024 sc1
v_max_f32 v76, v78, v77
v_max_f32 v77, v78, v77
s_nop 1
v_permlane32_swap_b32 v76, v77
v_max_f32 v76, v76, v77
v_mul_f32 v76, v76, v222
v_pk_fma_f32 v[92:93], v[92:93], v[222:223], v[76:77] op_sel_hi:[1,0,0] neg_lo:[0,0,1] neg_hi:[0,0,1]
v_pk_fma_f32 v[94:95], v[94:95], v[222:223], v[76:77] op_sel_hi:[1,0,0] neg_lo:[0,0,1] neg_hi:[0,0,1]
v_pk_fma_f32 v[108:109], v[108:109], v[222:223], v[76:77] op_sel_hi:[1,0,0] neg_lo:[0,0,1] neg_hi:[0,0,1]
v_pk_fma_f32 v[110:111], v[110:111], v[222:223], v[76:77] op_sel_hi:[1,0,0] neg_lo:[0,0,1] neg_hi:[0,0,1]
v_exp_f32 v92, v92
v_exp_f32 v93, v93
v_exp_f32 v94, v94
v_exp_f32 v95, v95
v_exp_f32 v108, v108
v_exp_f32 v109, v109
v_exp_f32 v110, v110
v_exp_f32 v111, v111
v_cvt_pk_bf16_f32 v60, v92, v93
v_cvt_pk_bf16_f32 v61, v94, v95
v_cvt_pk_bf16_f32 v62, v108, v109
v_cvt_pk_bf16_f32 v63, v110, v111
s_nop 1
v_mfma_f32_16x16x32_bf16 v[76:79], v[248:251], v[60:63], 0
v_mfma_f32_16x16x32_bf16 v[92:95], v[200:203], v[60:63], 0
v_mfma_f32_16x16x32_bf16 v[108:111], v[210:213], v[60:63], 0
s_nop 5
v_rcp_f32 v76, v76
s_nop 0
v_pk_mul_f32 v[92:93], v[92:93], v[76:77] op_sel_hi:[1,0]
v_pk_mul_f32 v[94:95], v[94:95], v[76:77] op_sel_hi:[1,0]
v_pk_mul_f32 v[108:109], v[108:109], v[76:77] op_sel_hi:[1,0]
v_pk_mul_f32 v[110:111], v[110:111], v[76:77] op_sel_hi:[1,0]
v_cvt_pk_bf16_f32 v164, v92, v93
v_cvt_pk_bf16_f32 v165, v94, v95
v_cvt_pk_bf16_f32 v166, v108, v109
v_cvt_pk_bf16_f32 v167, v110, v111
buffer_store_dwordx4 v[164:167], v4, s[16:19], s74 offen sc1
s_nop 1
s_branch .Lqkve3
.Lx4:
buffer_load_dword v27, v14, s[76:79], 0 offen
s_mov_b32 s76, s98
s_mov_b32 s77, s99
s_mov_b32 s78, s100
v_mov_b32 v14, v15
s_mov_b32 s47, 5
s_branch .Lx4b
.Lx5:
buffer_load_dword v27, v14, s[76:79], 0 offen
s_mov_b32 s76, s98
s_mov_b32 s77, s99
s_mov_b32 s78, s100
v_mov_b32 v14, v15
s_mov_b32 s47, 5
s_branch .Lx5b
.Lx6:
buffer_load_dword v27, v14, s[76:79], 0 offen
s_mov_b32 s76, s98
s_mov_b32 s77, s99
s_mov_b32 s78, s100
v_mov_b32 v14, v15
s_mov_b32 s47, 5
s_branch .Lx6b
.Lx7:
buffer_load_dword v27, v14, s[76:79], 0 offen
s_mov_b32 s76, s98
s_mov_b32 s77, s99
s_mov_b32 s78, s100
v_mov_b32 v14, v15
s_mov_b32 s47, 5
s_branch .Lx7b
.Lsp8:
s_mov_b32 s15, 0
.Lsp8l:
v_mov_b32 v37, 0
buffer_atomic_add v37, v34, s[40:43], 0 offen sc0
s_add_u32 s15, s15, 1
s_cmp_gt_u32 s15, 100000
s_waitcnt vmcnt(0)
s_cbranch_scc1 .Lsp8b
v_cmp_ne_u32 vcc, v35, v37
s_sleep 2
s_cbranch_vccnz .Lsp8l
s_branch .Lsp8b
.Lx9:
buffer_load_dword v27, v14, s[76:79], 0 offen
s_mov_b32 s76, s98
s_mov_b32 s77, s99
s_mov_b32 s78, s100
v_mov_b32 v14, v15
s_mov_b32 s47, 5
s_branch .Lx9b
.Lx10:
buffer_load_dword v27, v14, s[76:79], 0 offen
s_mov_b32 s76, s98
s_mov_b32 s77, s99
s_mov_b32 s78, s100
v_mov_b32 v14, v15
s_mov_b32 s47, 5
s_branch .Lx10b
.Lx11:
buffer_load_dword v27, v14, s[76:79], 0 offen
s_mov_b32 s76, s98
s_mov_b32 s77, s99
s_mov_b32 s78, s100
v_mov_b32 v14, v15
s_mov_b32 s47, 5
s_branch .Lx11b
.Lx12:
buffer_load_dword v27, v14, s[76:79], 0 offen
s_mov_b32 s76, s98
s_mov_b32 s77, s99
s_mov_b32 s78, s100
v_mov_b32 v14, v15
s_mov_b32 s47, 5
s_branch .Lx12b
.Lx13:
buffer_load_dword v27, v14, s[76:79], 0 offen
s_mov_b32 s76, s98
s_mov_b32 s77, s99
s_mov_b32 s78, s100
v_mov_b32 v14, v15
s_mov_b32 s47, 5
s_branch .Lx13b
.Lsp14:
s_mov_b32 s15, 0
.Lsp14l:
v_mov_b32 v37, 0
buffer_atomic_add v37, v33, s[16:19], 0 offen sc0
s_add_u32 s15, s15, 1
s_cmp_gt_u32 s15, 100000
s_waitcnt vmcnt(0)
s_cbranch_scc1 .Lsp14b
v_cmp_ne_u32 vcc, v36, v37
s_sleep 2
s_cbranch_vccnz .Lsp14l
s_branch .Lsp14b
.Lx15:
buffer_load_dword v27, v14, s[76:79], 0 offen
s_mov_b32 s76, s98
s_mov_b32 s77, s99
s_mov_b32 s78, s100
v_mov_b32 v14, v15
s_mov_b32 s47, 5
s_branch .Lx15b
.Lx16:
buffer_load_dword v27, v14, s[76:79], 0 offen
s_mov_b32 s76, s98
s_mov_b32 s77, s99
s_mov_b32 s78, s100
v_mov_b32 v14, v15
s_mov_b32 s47, 5
s_branch .Lx16b
.Lx17:
buffer_load_dword v27, v14, s[76:79], 0 offen
s_mov_b32 s76, s98
s_mov_b32 s77, s99
s_mov_b32 s78, s100
v_mov_b32 v14, v15
s_mov_b32 s47, 5
s_branch .Lx17b
.Lx18:
buffer_load_dword v27, v14, s[76:79], 0 offen
s_mov_b32 s76, s98
s_mov_b32 s77, s99
s_mov_b32 s78, s100
v_mov_b32 v14, v15
s_mov_b32 s47, 5
s_branch .Lx18b
.Lx19:
buffer_load_dword v27, v14, s[76:79], 0 offen
s_mov_b32 s76, s98
s_mov_b32 s77, s99
s_mov_b32 s78, s100
v_mov_b32 v14, v15
s_mov_b32 s47, 5
s_branch .Lx19b
.Lx20:
buffer_load_dword v27, v14, s[76:79], 0 offen
s_mov_b32 s76, s98
s_mov_b32 s77, s99
s_mov_b32 s78, s100
v_mov_b32 v14, v15
s_mov_b32 s47, 5
s_branch .Lx20b
.Lx21:
buffer_load_dword v27, v14, s[76:79], 0 offen
s_mov_b32 s76, s98
s_mov_b32 s77, s99
s_mov_b32 s78, s100
v_mov_b32 v14, v15
s_mov_b32 s47, 5
s_branch .Lx21b
.Lsp22:
s_mov_b32 s15, 0
.Lsp22l:
v_mov_b32 v37, 0
buffer_atomic_add v37, v34, s[40:43], 0 offen sc0
s_add_u32 s15, s15, 1
s_cmp_gt_u32 s15, 100000
s_waitcnt vmcnt(0)
s_cbranch_scc1 .Lsp22b
v_cmp_ne_u32 vcc, v35, v37
s_sleep 2
s_cbranch_vccnz .Lsp22l
s_branch .Lsp22b
.Lx23:
buffer_load_dword v27, v14, s[76:79], 0 offen
s_mov_b32 s76, s98
s_mov_b32 s77, s99
s_mov_b32 s78, s100
v_mov_b32 v14, v15
s_mov_b32 s47, 5
s_branch .Lx23b
.Lx24:
buffer_load_dword v27, v14, s[76:79], 0 offen
s_mov_b32 s76, s98
s_mov_b32 s77, s99
s_mov_b32 s78, s100
v_mov_b32 v14, v15
s_mov_b32 s47, 5
s_branch .Lx24b
.Lx25:
buffer_load_dword v27, v14, s[76:79], 0 offen
s_mov_b32 s76, s98
s_mov_b32 s77, s99
s_mov_b32 s78, s100
v_mov_b32 v14, v15
s_mov_b32 s47, 5
s_branch .Lx25b
.Lx26:
buffer_load_dword v27, v14, s[76:79], 0 offen
s_mov_b32 s76, s98
s_mov_b32 s77, s99
s_mov_b32 s78, s100
v_mov_b32 v14, v15
s_mov_b32 s47, 5
s_branch .Lx26b
.Lx27:
buffer_load_dword v27, v14, s[76:79], 0 offen
s_mov_b32 s76, s98
s_mov_b32 s77, s99
s_mov_b32 s78, s100
v_mov_b32 v14, v15
s_mov_b32 s47, 5
s_branch .Lx27b
.Lsp28:
s_mov_b32 s15, 0
.Lsp28l:
v_mov_b32 v37, 0
buffer_atomic_add v37, v33, s[16:19], 0 offen sc0
s_add_u32 s15, s15, 1
s_cmp_gt_u32 s15, 100000
s_waitcnt vmcnt(0)
s_cbranch_scc1 .Lsp28b
v_cmp_ne_u32 vcc, v36, v37
s_sleep 2
s_cbranch_vccnz .Lsp28l
s_branch .Lsp28b
.Lx29:
buffer_load_dword v27, v14, s[76:79], 0 offen
s_mov_b32 s76, s98
s_mov_b32 s77, s99
s_mov_b32 s78, s100
v_mov_b32 v14, v15
s_mov_b32 s47, 5
s_branch .Lx29b
.Lx30:
buffer_load_dword v27, v14, s[76:79], 0 offen
s_mov_b32 s76, s98
s_mov_b32 s77, s99
s_mov_b32 s78, s100
v_mov_b32 v14, v15
s_mov_b32 s47, 5
s_branch .Lx30b
.Lx31:
buffer_load_dword v27, v14, s[76:79], 0 offen
s_mov_b32 s76, s98
s_mov_b32 s77, s99
s_mov_b32 s78, s100
v_mov_b32 v14, v15
s_mov_b32 s47, 5
s_branch .Lx31b
.Lqkv2:
s_add_u32 m0, s55, 0
s_nop 0
buffer_load_dwordx4 v21, s[36:39], s52 offen lds
buffer_load_dwordx4 v28, s[36:39], s52 offen offset:1024 lds
buffer_load_dword v22, s[36:39], s52 offen offset:2048 lds
s_add_u32 s52, s52, 128
s_add_u32 m0, s55, 2304
s_nop 0
buffer_load_dwordx4 v21, s[36:39], s53 offen lds
buffer_load_dwordx4 v28, s[36:39], s53 offen offset:1024 lds
buffer_load_dword v29, s[36:39], s53 offen offset:2048 lds
s_add_u32 s53, s53, 128
s_add_u32 m0, s56, 123648
s_nop 0
buffer_load_dwordx4 v18, s[20:23], s54 offen lds
buffer_load_dwordx4 v19, s[20:23], s54 offen offset:1024 lds
buffer_load_dwordx4 v20, s[20:23], s54 offen offset:2048 lds
s_add_u32 s54, s54, 196608
s_add_u32 m0, s56, 136064
s_nop 0
buffer_load_dwordx4 v18, s[20:23], s54 offen lds
buffer_load_dwordx4 v19, s[20:23], s54 offen offset:1024 lds
buffer_load_dwordx4 v20, s[20:23], s54 offen offset:2048 lds
s_add_u32 s54, s54, 196608
s_waitcnt vmcnt(12)
s_cmp_eq_u32 s14, 3
s_cselect_b32 s62, 0, 4096
v_mov_b32 v154, 1
v_lshlrev_b32 v155, 8, v1
v_permlane16_swap_b32 v128, v130
v_permlane16_swap_b32 v129, v131
v_permlane16_swap_b32 v132, v134
v_permlane16_swap_b32 v133, v135
v_permlane16_swap_b32 v136, v138
v_permlane16_swap_b32 v137, v139
v_permlane16_swap_b32 v140, v142
v_permlane16_swap_b32 v141, v143
buffer_store_dword v154, v155, s[40:43], s62 offen sc1
v_lshlrev_b32 v64, 16, v128
v_and_b32 v65, 0xffff0000, v128
v_lshlrev_b32 v66, 16, v129
v_and_b32 v67, 0xffff0000, v129
v_lshlrev_b32 v68, 16, v130
v_and_b32 v69, 0xffff0000, v130
v_lshlrev_b32 v70, 16, v131
v_and_b32 v71, 0xffff0000, v131
v_lshlrev_b32 v72, 16, v132
v_and_b32 v73, 0xffff0000, v132
v_lshlrev_b32 v74, 16, v133
v_and_b32 v75, 0xffff0000, v133
v_lshlrev_b32 v76, 16, v134
v_and_b32 v77, 0xffff0000, v134
v_lshlrev_b32 v78, 16, v135
v_and_b32 v79, 0xffff0000, v135
v_lshlrev_b32 v80, 16, v136
v_and_b32 v81, 0xffff0000, v136
v_lshlrev_b32 v82, 16, v137
v_and_b32 v83, 0xffff0000, v137
v_lshlrev_b32 v84, 16, v138
v_and_b32 v85, 0xffff0000, v138
v_lshlrev_b32 v86, 16, v139
v_and_b32 v87, 0xffff0000, v139
v_lshlrev_b32 v88, 16, v140
v_and_b32 v89, 0xffff0000, v140
v_lshlrev_b32 v90, 16, v141
v_and_b32 v91, 0xffff0000, v141
v_lshlrev_b32 v92, 16, v142
v_and_b32 v93, 0xffff0000, v142
v_lshlrev_b32 v94, 16, v143
v_and_b32 v95, 0xffff0000, v143
s_lshl_b32 s64, s6, 14
s_lshl_b32 s65, s49, 13
s_add_u32 s64, s64, s65
s_lshl_b32 s65, s7, 9
s_add_u32 s64, s64, s65
s_lshl_b32 s65, s48, 8
s_add_u32 s64, s64, s65
s_add_u32 s64, s64, 29360128
v_and_b32 v152, 31, v1
v_lshlrev_b32 v152, 3, v152
v_lshrrev_b32 v153, 5, v1
v_lshl_add_u32 v152, v153, 28, v152
s_lshl_b32 s62, s7, 18
s_add_u32 s62, s62, 0
s_add_u32 s63, s62, 0x20000
v_pk_mul_f32 v[146:147], v[64:65], v[64:65]
v_pk_mul_f32 v[150:151], v[80:81], v[80:81]
v_pk_fma_f32 v[146:147], v[66:67], v[66:67], v[146:147]
v_pk_add_f32 v[144:145], v[64:65], v[66:67]
v_pk_fma_f32 v[150:151], v[82:83], v[82:83], v[150:151]
v_pk_add_f32 v[148:149], v[80:81], v[82:83]
v_pk_fma_f32 v[146:147], v[68:69], v[68:69], v[146:147]
v_pk_add_f32 v[144:145], v[144:145], v[68:69]
v_pk_fma_f32 v[150:151], v[84:85], v[84:85], v[150:151]
v_pk_add_f32 v[148:149], v[148:149], v[84:85]
v_pk_fma_f32 v[146:147], v[70:71], v[70:71], v[146:147]
v_pk_add_f32 v[144:145], v[144:145], v[70:71]
v_pk_fma_f32 v[150:151], v[86:87], v[86:87], v[150:151]
v_pk_add_f32 v[148:149], v[148:149], v[86:87]
v_pk_fma_f32 v[146:147], v[72:73], v[72:73], v[146:147]
v_pk_add_f32 v[144:145], v[144:145], v[72:73]
v_pk_fma_f32 v[150:151], v[88:89], v[88:89], v[150:151]
v_pk_add_f32 v[148:149], v[148:149], v[88:89]
v_pk_fma_f32 v[146:147], v[74:75], v[74:75], v[146:147]
v_pk_add_f32 v[144:145], v[144:145], v[74:75]
v_pk_fma_f32 v[150:151], v[90:91], v[90:91], v[150:151]
v_pk_add_f32 v[148:149], v[148:149], v[90:91]
v_pk_fma_f32 v[146:147], v[76:77], v[76:77], v[146:147]
v_pk_add_f32 v[144:145], v[144:145], v[76:77]
v_pk_fma_f32 v[150:151], v[92:93], v[92:93], v[150:151]
v_pk_add_f32 v[148:149], v[148:149], v[92:93]
v_pk_fma_f32 v[146:147], v[78:79], v[78:79], v[146:147]
v_pk_add_f32 v[144:145], v[144:145], v[78:79]
v_pk_fma_f32 v[150:151], v[94:95], v[94:95], v[150:151]
v_pk_add_f32 v[148:149], v[148:149], v[94:95]
v_add_f32 v144, v144, v145
v_add_f32 v146, v146, v147
v_add_f32 v148, v148, v149
v_add_f32 v150, v150, v151
s_nop 0
v_permlane16_swap_b32 v144, v148
v_permlane16_swap_b32 v146, v150
v_add_f32 v144, v144, v148
v_add_f32 v146, v146, v150
s_nop 1
v_permlane32_swap_b32 v144, v146
v_add_f32 v144, v144, v146
s_nop 1
v_permlane32_swap_b32 v144, v145
buffer_store_dwordx2 v[144:145], v152, s[16:19], s64 offen sc1
s_lshl_b32 s62, s2, 10
s_add_u32 s62, s62, 31457280
s_cmp_eq_u32 s3, 0
s_cselect_b32 s62, s62, 268435456
buffer_store_dwordx4 v[156:159], v27, s[16:19], s62 offen sc1
v_accvgpr_write_b32 a224, v64
v_accvgpr_write_b32 a225, v65
v_accvgpr_write_b32 a226, v66
v_accvgpr_write_b32 a227, v67
v_accvgpr_write_b32 a228, v68
v_accvgpr_write_b32 a229, v69
v_accvgpr_write_b32 a230, v70
v_accvgpr_write_b32 a231, v71
v_accvgpr_write_b32 a232, v72
v_accvgpr_write_b32 a233, v73
v_accvgpr_write_b32 a234, v74
v_accvgpr_write_b32 a235, v75
v_accvgpr_write_b32 a236, v76
v_accvgpr_write_b32 a237, v77
v_accvgpr_write_b32 a238, v78
v_accvgpr_write_b32 a239, v79
v_accvgpr_write_b32 a240, v80
v_accvgpr_write_b32 a241, v81
v_accvgpr_write_b32 a242, v82
v_accvgpr_write_b32 a243, v83
v_accvgpr_write_b32 a244, v84
v_accvgpr_write_b32 a245, v85
v_accvgpr_write_b32 a246, v86
v_accvgpr_write_b32 a247, v87
v_accvgpr_write_b32 a248, v88
v_accvgpr_write_b32 a249, v89
v_accvgpr_write_b32 a250, v90
v_accvgpr_write_b32 a251, v91
v_accvgpr_write_b32 a252, v92
v_accvgpr_write_b32 a253, v93
v_accvgpr_write_b32 a254, v94
v_accvgpr_write_b32 a255, v95
s_add_u32 m0, s55, 18496
s_nop 0
buffer_load_dwordx4 v21, s[36:39], s52 offen lds
buffer_load_dwordx4 v28, s[36:39], s52 offen offset:1024 lds
buffer_load_dword v22, s[36:39], s52 offen offset:2048 lds
s_add_u32 s52, s52, 128
s_add_u32 m0, s55, 20800
s_nop 0
buffer_load_dwordx4 v21, s[36:39], s53 offen lds
buffer_load_dwordx4 v28, s[36:39], s53 offen offset:1024 lds
buffer_load_dword v29, s[36:39], s53 offen offset:2048 lds
s_add_u32 s53, s53, 128
s_add_u32 m0, s56, 73984
s_nop 0
buffer_load_dwordx4 v18, s[20:23], s54 offen lds
buffer_load_dwordx4 v19, s[20:23], s54 offen offset:1024 lds
buffer_load_dwordx4 v20, s[20:23], s54 offen offset:2048 lds
s_add_u32 s54, s54, 196608
s_waitcnt vmcnt(15) lgkmcnt(0)
s_barrier
ds_read_b128 a[0:3], v23
ds_read_b128 a[4:7], v23 offset:2304
ds_read_b128 a[8:11], v23 offset:4608
ds_read_b128 a[12:15], v23 offset:6912
ds_read_b64_tr_b16 a[20:21], v25 offset:49664
ds_read_b64_tr_b16 a[22:23], v25 offset:50176
ds_read_b64_tr_b16 a[24:25], v25 offset:49696
ds_read_b64_tr_b16 a[26:27], v25 offset:50208
ds_read_b128 a[16:19], v24
ds_read_b64_tr_b16 a[28:29], v25 offset:50688
ds_read_b64_tr_b16 a[30:31], v25 offset:51200
ds_read_b64_tr_b16 a[32:33], v25 offset:50720
ds_read_b64_tr_b16 a[34:35], v25 offset:51232
ds_read_b64_tr_b16 a[36:37], v25 offset:51712
ds_read_b64_tr_b16 a[38:39], v25 offset:52224
ds_read_b64_tr_b16 a[40:41], v25 offset:51744
ds_read_b64_tr_b16 a[42:43], v25 offset:52256
s_waitcnt vmcnt(12) lgkmcnt(8)
s_barrier
v_mfma_f32_16x16x32_bf16 v[60:63], a[20:23], a[0:3], 0
ds_read_b128 a[44:47], v30
s_add_u32 m0, s56, 86400
v_mfma_f32_16x16x32_bf16 v[76:79], a[24:27], a[0:3], 0
buffer_load_dwordx4 v18, s[20:23], s54 offen lds
v_mfma_f32_16x16x32_bf16 v[80:83], a[24:27], a[4:7], 0
s_sub_u32 s47, s47, 1
s_cbranch_scc1 .Lx18
.Lx18b:
v_mfma_f32_16x16x32_bf16 v[64:67], a[20:23], a[4:7], 0
buffer_load_dwordx4 v19, s[20:23], s54 offen offset:1024 lds
v_mfma_f32_16x16x32_bf16 v[68:71], a[20:23], a[8:11], 0
ds_read_b128 a[48:51], v30 offset:2304
v_mfma_f32_16x16x32_bf16 v[84:87], a[24:27], a[8:11], 0
ds_read_b128 a[52:55], v30 offset:4608
ds_read_b128 a[56:59], v30 offset:6912
v_mfma_f32_16x16x32_bf16 v[88:91], a[24:27], a[12:15], 0
buffer_load_dwordx4 v20, s[20:23], s54 offen offset:2048 lds
v_mfma_f32_16x16x32_bf16 v[72:75], a[20:23], a[12:15], 0
s_add_u32 s54, s54, 196608
s_waitcnt lgkmcnt(4)
v_mfma_f32_16x16x32_bf16 v[244:247], a[24:27], a[16:19], 0
ds_read_b64_tr_b16 a[64:65], v25 offset:62080
s_add_u32 m0, s55, 36992
v_mfma_f32_16x16x32_bf16 v[104:107], a[28:31], a[12:15], 0
buffer_load_dwordx4 v21, s[36:39], s52 offen lds
v_mfma_f32_16x16x32_bf16 v[120:123], a[32:35], a[12:15], 0
ds_read_b64_tr_b16 a[66:67], v25 offset:62592
v_mfma_f32_16x16x32_bf16 v[116:119], a[32:35], a[8:11], 0
ds_read_b64_tr_b16 a[68:69], v25 offset:62112
ds_read_b64_tr_b16 a[70:71], v25 offset:62624
v_mfma_f32_16x16x32_bf16 v[100:103], a[28:31], a[8:11], 0
buffer_load_dwordx4 v28, s[36:39], s52 offen offset:1024 lds
v_mfma_f32_16x16x32_bf16 v[96:99], a[28:31], a[4:7], 0
ds_read_b128 a[60:63], v31
v_mfma_f32_16x16x32_bf16 v[112:115], a[32:35], a[4:7], 0
buffer_load_dword v22, s[36:39], s52 offen offset:2048 lds
v_mfma_f32_16x16x32_bf16 v[108:111], a[32:35], a[0:3], 0
ds_read_b64_tr_b16 a[72:73], v25 offset:63104
s_add_u32 s52, s52, 128
v_mfma_f32_16x16x32_bf16 v[92:95], a[28:31], a[0:3], 0
s_add_u32 m0, s55, 39296
v_mfma_f32_16x16x32_bf16 v[124:127], a[0:3], a[36:39], 0
buffer_load_dwordx4 v21, s[36:39], s53 offen lds
v_mfma_f32_16x16x32_bf16 v[140:143], a[0:3], a[40:43], 0
ds_read_b64_tr_b16 a[74:75], v25 offset:63616
ds_read_b64_tr_b16 a[76:77], v25 offset:63136
v_mfma_f32_16x16x32_bf16 v[144:147], a[4:7], a[40:43], 0
ds_read_b64_tr_b16 a[78:79], v25 offset:63648
v_mfma_f32_16x16x32_bf16 v[128:131], a[4:7], a[36:39], 0
buffer_load_dwordx4 v28, s[36:39], s53 offen offset:1024 lds
v_mfma_f32_16x16x32_bf16 v[132:135], a[8:11], a[36:39], 0
ds_read_b64_tr_b16 a[80:81], v25 offset:64128
v_mfma_f32_16x16x32_bf16 v[148:151], a[8:11], a[40:43], 0
ds_read_b64_tr_b16 a[82:83], v25 offset:64640
ds_read_b64_tr_b16 a[84:85], v25 offset:64160
v_mfma_f32_16x16x32_bf16 v[152:155], a[12:15], a[40:43], 0
buffer_load_dword v29, s[36:39], s53 offen offset:2048 lds
v_mfma_f32_16x16x32_bf16 v[136:139], a[12:15], a[36:39], 0
s_add_u32 s53, s53, 128
v_mfma_f32_16x16x32_bf16 v[156:159], a[16:19], a[36:39], 0
ds_read_b64_tr_b16 a[86:87], v25 offset:64672
v_mfma_f32_16x16x32_bf16 v[160:163], a[16:19], a[40:43], 0
s_waitcnt vmcnt(9) lgkmcnt(8)
s_barrier
v_mfma_f32_16x16x32_bf16 v[60:63], a[64:67], a[44:47], v[60:63]
ds_read_b128 a[0:3], v23 offset:18496
s_add_u32 m0, s56, 98816
v_mfma_f32_16x16x32_bf16 v[76:79], a[68:71], a[44:47], v[76:79]
buffer_load_dwordx4 v18, s[20:23], s54 offen lds
v_mfma_f32_16x16x32_bf16 v[80:83], a[68:71], a[48:51], v[80:83]
ds_read_b128 a[4:7], v23 offset:20800
v_mfma_f32_16x16x32_bf16 v[64:67], a[64:67], a[48:51], v[64:67]
buffer_load_dwordx4 v19, s[20:23], s54 offen offset:1024 lds
v_mfma_f32_16x16x32_bf16 v[68:71], a[64:67], a[52:55], v[68:71]
ds_read_b128 a[8:11], v23 offset:23104
ds_read_b128 a[12:15], v23 offset:25408
v_mfma_f32_16x16x32_bf16 v[84:87], a[68:71], a[52:55], v[84:87]
ds_read_b64_tr_b16 a[20:21], v25
v_mfma_f32_16x16x32_bf16 v[88:91], a[68:71], a[56:59], v[88:91]
buffer_load_dwordx4 v20, s[20:23], s54 offen offset:2048 lds
v_mfma_f32_16x16x32_bf16 v[72:75], a[64:67], a[56:59], v[72:75]
s_add_u32 s54, s54, 196608
s_waitcnt lgkmcnt(5)
v_mfma_f32_16x16x32_bf16 v[244:247], a[68:71], a[60:63], v[244:247]
ds_read_b64_tr_b16 a[22:23], v25 offset:512
s_add_u32 m0, s56, 111232
v_mfma_f32_16x16x32_bf16 v[104:107], a[72:75], a[56:59], v[104:107]
buffer_load_dwordx4 v18, s[20:23], s54 offen lds
v_mfma_f32_16x16x32_bf16 v[120:123], a[76:79], a[56:59], v[120:123]
ds_read_b64_tr_b16 a[24:25], v25 offset:32
v_mfma_f32_16x16x32_bf16 v[116:119], a[76:79], a[52:55], v[116:119]
ds_read_b64_tr_b16 a[26:27], v25 offset:544
v_mfma_f32_16x16x32_bf16 v[100:103], a[72:75], a[52:55], v[100:103]
buffer_load_dwordx4 v19, s[20:23], s54 offen offset:1024 lds
v_mfma_f32_16x16x32_bf16 v[96:99], a[72:75], a[48:51], v[96:99]
ds_read_b128 a[16:19], v24 offset:18496
ds_read_b64_tr_b16 a[28:29], v25 offset:1024
v_mfma_f32_16x16x32_bf16 v[112:115], a[76:79], a[48:51], v[112:115]
buffer_load_dwordx4 v20, s[20:23], s54 offen offset:2048 lds
v_mfma_f32_16x16x32_bf16 v[108:111], a[76:79], a[44:47], v[108:111]
s_add_u32 s54, s54, 196608
v_mfma_f32_16x16x32_bf16 v[92:95], a[72:75], a[44:47], v[92:95]
ds_read_b64_tr_b16 a[30:31], v25 offset:1536
s_add_u32 m0, s55, 55488
v_mfma_f32_16x16x32_bf16 v[124:127], a[44:47], a[80:83], v[124:127]
buffer_load_dwordx4 v21, s[36:39], s52 offen lds
v_mfma_f32_16x16x32_bf16 v[140:143], a[44:47], a[84:87], v[140:143]
ds_read_b64_tr_b16 a[32:33], v25 offset:1056
v_mfma_f32_16x16x32_bf16 v[144:147], a[48:51], a[84:87], v[144:147]
ds_read_b64_tr_b16 a[34:35], v25 offset:1568
v_mfma_f32_16x16x32_bf16 v[128:131], a[48:51], a[80:83], v[128:131]
buffer_load_dwordx4 v28, s[36:39], s52 offen offset:1024 lds
v_mfma_f32_16x16x32_bf16 v[132:135], a[52:55], a[80:83], v[132:135]
ds_read_b64_tr_b16 a[36:37], v25 offset:2048
v_mfma_f32_16x16x32_bf16 v[148:151], a[52:55], a[84:87], v[148:151]
ds_read_b64_tr_b16 a[38:39], v25 offset:2560
ds_read_b64_tr_b16 a[40:41], v25 offset:2080
v_mfma_f32_16x16x32_bf16 v[152:155], a[56:59], a[84:87], v[152:155]
buffer_load_dword v22, s[36:39], s52 offen offset:2048 lds
v_mfma_f32_16x16x32_bf16 v[136:139], a[56:59], a[80:83], v[136:139]
s_add_u32 s52, s52, 128
v_mfma_f32_16x16x32_bf16 v[156:159], a[60:63], a[80:83], v[156:159]
ds_read_b64_tr_b16 a[42:43], v25 offset:2592
v_mfma_f32_16x16x32_bf16 v[160:163], a[60:63], a[84:87], v[160:163]
s_waitcnt vmcnt(15) lgkmcnt(8)
s_barrier
v_mfma_f32_16x16x32_bf16 v[60:63], a[20:23], a[0:3], v[60:63]
ds_read_b128 a[44:47], v30 offset:18496
s_add_u32 m0, s55, 57792
v_mfma_f32_16x16x32_bf16 v[76:79], a[24:27], a[0:3], v[76:79]
buffer_load_dwordx4 v21, s[36:39], s53 offen lds
v_mfma_f32_16x16x32_bf16 v[80:83], a[24:27], a[4:7], v[80:83]
s_sub_u32 s47, s47, 1
s_cbranch_scc1 .Lx19
.Lx19b:
v_mfma_f32_16x16x32_bf16 v[64:67], a[20:23], a[4:7], v[64:67]
buffer_load_dwordx4 v28, s[36:39], s53 offen offset:1024 lds
v_mfma_f32_16x16x32_bf16 v[68:71], a[20:23], a[8:11], v[68:71]
ds_read_b128 a[48:51], v30 offset:20800
v_mfma_f32_16x16x32_bf16 v[84:87], a[24:27], a[8:11], v[84:87]
ds_read_b128 a[52:55], v30 offset:23104
ds_read_b128 a[56:59], v30 offset:25408
v_mfma_f32_16x16x32_bf16 v[88:91], a[24:27], a[12:15], v[88:91]
buffer_load_dword v29, s[36:39], s53 offen offset:2048 lds
v_mfma_f32_16x16x32_bf16 v[72:75], a[20:23], a[12:15], v[72:75]
s_add_u32 s53, s53, 128
s_waitcnt lgkmcnt(4)
v_mfma_f32_16x16x32_bf16 v[244:247], a[24:27], a[16:19], v[244:247]
ds_read_b64_tr_b16 a[64:65], v25 offset:12416
s_add_u32 m0, s56, 123648
v_mfma_f32_16x16x32_bf16 v[104:107], a[28:31], a[12:15], v[104:107]
buffer_load_dwordx4 v18, s[20:23], s54 offen lds
v_mfma_f32_16x16x32_bf16 v[120:123], a[32:35], a[12:15], v[120:123]
ds_read_b64_tr_b16 a[66:67], v25 offset:12928
v_mfma_f32_16x16x32_bf16 v[116:119], a[32:35], a[8:11], v[116:119]
ds_read_b64_tr_b16 a[68:69], v25 offset:12448
ds_read_b64_tr_b16 a[70:71], v25 offset:12960
v_mfma_f32_16x16x32_bf16 v[100:103], a[28:31], a[8:11], v[100:103]
buffer_load_dwordx4 v19, s[20:23], s54 offen offset:1024 lds
v_mfma_f32_16x16x32_bf16 v[96:99], a[28:31], a[4:7], v[96:99]
ds_read_b128 a[60:63], v31 offset:18496
v_mfma_f32_16x16x32_bf16 v[112:115], a[32:35], a[4:7], v[112:115]
buffer_load_dwordx4 v20, s[20:23], s54 offen offset:2048 lds
v_mfma_f32_16x16x32_bf16 v[108:111], a[32:35], a[0:3], v[108:111]
ds_read_b64_tr_b16 a[72:73], v25 offset:13440
s_add_u32 s54, s54, 196608
v_mfma_f32_16x16x32_bf16 v[92:95], a[28:31], a[0:3], v[92:95]
s_add_u32 m0, s56, 136064
v_mfma_f32_16x16x32_bf16 v[124:127], a[0:3], a[36:39], v[124:127]
buffer_load_dwordx4 v18, s[20:23], s54 offen lds
v_mfma_f32_16x16x32_bf16 v[140:143], a[0:3], a[40:43], v[140:143]
ds_read_b64_tr_b16 a[74:75], v25 offset:13952
ds_read_b64_tr_b16 a[76:77], v25 offset:13472
v_mfma_f32_16x16x32_bf16 v[144:147], a[4:7], a[40:43], v[144:147]
ds_read_b64_tr_b16 a[78:79], v25 offset:13984
v_mfma_f32_16x16x32_bf16 v[128:131], a[4:7], a[36:39], v[128:131]
buffer_load_dwordx4 v19, s[20:23], s54 offen offset:1024 lds
v_mfma_f32_16x16x32_bf16 v[132:135], a[8:11], a[36:39], v[132:135]
ds_read_b64_tr_b16 a[80:81], v25 offset:14464
v_mfma_f32_16x16x32_bf16 v[148:151], a[8:11], a[40:43], v[148:151]
ds_read_b64_tr_b16 a[82:83], v25 offset:14976
ds_read_b64_tr_b16 a[84:85], v25 offset:14496
v_mfma_f32_16x16x32_bf16 v[152:155], a[12:15], a[40:43], v[152:155]
buffer_load_dwordx4 v20, s[20:23], s54 offen offset:2048 lds
v_mfma_f32_16x16x32_bf16 v[136:139], a[12:15], a[36:39], v[136:139]
s_add_u32 s54, s54, 196608
v_mfma_f32_16x16x32_bf16 v[156:159], a[16:19], a[36:39], v[156:159]
ds_read_b64_tr_b16 a[86:87], v25 offset:15008
v_mfma_f32_16x16x32_bf16 v[160:163], a[16:19], a[40:43], v[160:163]
s_waitcnt vmcnt(15) lgkmcnt(8)
s_barrier
v_mfma_f32_16x16x32_bf16 v[60:63], a[64:67], a[44:47], v[60:63]
ds_read_b128 a[0:3], v23 offset:36992
s_add_u32 m0, s55, 0
v_mfma_f32_16x16x32_bf16 v[76:79], a[68:71], a[44:47], v[76:79]
buffer_load_dwordx4 v21, s[36:39], s52 offen lds
v_mfma_f32_16x16x32_bf16 v[80:83], a[68:71], a[48:51], v[80:83]
ds_read_b128 a[4:7], v23 offset:39296
v_mfma_f32_16x16x32_bf16 v[64:67], a[64:67], a[48:51], v[64:67]
buffer_load_dwordx4 v28, s[36:39], s52 offen offset:1024 lds
v_mfma_f32_16x16x32_bf16 v[68:71], a[64:67], a[52:55], v[68:71]
ds_read_b128 a[8:11], v23 offset:41600
ds_read_b128 a[12:15], v23 offset:43904
v_mfma_f32_16x16x32_bf16 v[84:87], a[68:71], a[52:55], v[84:87]
ds_read_b64_tr_b16 a[20:21], v25 offset:24832
v_mfma_f32_16x16x32_bf16 v[88:91], a[68:71], a[56:59], v[88:91]
buffer_load_dword v22, s[36:39], s52 offen offset:2048 lds
v_mfma_f32_16x16x32_bf16 v[72:75], a[64:67], a[56:59], v[72:75]
s_add_u32 s52, s52, 128
s_add_u32 m0, s55, 2304
s_waitcnt lgkmcnt(5)
v_mfma_f32_16x16x32_bf16 v[244:247], a[68:71], a[60:63], v[244:247]
buffer_load_dwordx4 v21, s[36:39], s53 offen lds
v_mfma_f32_16x16x32_bf16 v[104:107], a[72:75], a[56:59], v[104:107]
ds_read_b64_tr_b16 a[22:23], v25 offset:25344
v_mfma_f32_16x16x32_bf16 v[120:123], a[76:79], a[56:59], v[120:123]
ds_read_b64_tr_b16 a[24:25], v25 offset:24864
ds_read_b64_tr_b16 a[26:27], v25 offset:25376
v_mfma_f32_16x16x32_bf16 v[116:119], a[76:79], a[52:55], v[116:119]
buffer_load_dwordx4 v28, s[36:39], s53 offen offset:1024 lds
v_mfma_f32_16x16x32_bf16 v[100:103], a[72:75], a[52:55], v[100:103]
ds_read_b128 a[16:19], v24 offset:36992
v_mfma_f32_16x16x32_bf16 v[96:99], a[72:75], a[48:51], v[96:99]
buffer_load_dword v29, s[36:39], s53 offen offset:2048 lds
v_mfma_f32_16x16x32_bf16 v[112:115], a[76:79], a[48:51], v[112:115]
ds_read_b64_tr_b16 a[28:29], v25 offset:25856
s_add_u32 s53, s53, 128
v_mfma_f32_16x16x32_bf16 v[108:111], a[76:79], a[44:47], v[108:111]
s_add_u32 m0, s56, 73984
v_mfma_f32_16x16x32_bf16 v[92:95], a[72:75], a[44:47], v[92:95]
buffer_load_dwordx4 v18, s[20:23], s54 offen lds
v_mfma_f32_16x16x32_bf16 v[124:127], a[44:47], a[80:83], v[124:127]
ds_read_b64_tr_b16 a[30:31], v25 offset:26368
ds_read_b64_tr_b16 a[32:33], v25 offset:25888
v_mfma_f32_16x16x32_bf16 v[140:143], a[44:47], a[84:87], v[140:143]
buffer_load_dwordx4 v19, s[20:23], s54 offen offset:1024 lds
v_mfma_f32_16x16x32_bf16 v[144:147], a[48:51], a[84:87], v[144:147]
ds_read_b64_tr_b16 a[34:35], v25 offset:26400
v_mfma_f32_16x16x32_bf16 v[128:131], a[48:51], a[80:83], v[128:131]
ds_read_b64_tr_b16 a[36:37], v25 offset:26880
v_mfma_f32_16x16x32_bf16 v[132:135], a[52:55], a[80:83], v[132:135]
buffer_load_dwordx4 v20, s[20:23], s54 offen offset:2048 lds
v_mfma_f32_16x16x32_bf16 v[148:151], a[52:55], a[84:87], v[148:151]
ds_read_b64_tr_b16 a[38:39], v25 offset:27392
s_add_u32 s54, s54, 196608
v_mfma_f32_16x16x32_bf16 v[152:155], a[56:59], a[84:87], v[152:155]
buffer_load_dword v37, v34, s[40:43], 0 offen sc1
v_mfma_f32_16x16x32_bf16 v[136:139], a[56:59], a[80:83], v[136:139]
ds_read_b64_tr_b16 a[40:41], v25 offset:26912
v_mfma_f32_16x16x32_bf16 v[156:159], a[60:63], a[80:83], v[156:159]
ds_read_b64_tr_b16 a[42:43], v25 offset:27424
v_mfma_f32_16x16x32_bf16 v[160:163], a[60:63], a[84:87], v[160:163]
s_waitcnt vmcnt(22) lgkmcnt(8)
s_barrier
v_mfma_f32_16x16x32_bf16 v[60:63], a[20:23], a[0:3], v[60:63]
ds_read_b128 a[44:47], v30 offset:36992
s_add_u32 m0, s56, 86400
v_mfma_f32_16x16x32_bf16 v[76:79], a[24:27], a[0:3], v[76:79]
buffer_load_dwordx4 v18, s[20:23], s54 offen lds
v_mfma_f32_16x16x32_bf16 v[80:83], a[24:27], a[4:7], v[80:83]
s_sub_u32 s47, s47, 1
s_cbranch_scc1 .Lx20
.Lx20b:
v_mfma_f32_16x16x32_bf16 v[64:67], a[20:23], a[4:7], v[64:67]
buffer_load_dwordx4 v19, s[20:23], s54 offen offset:1024 lds
v_mfma_f32_16x16x32_bf16 v[68:71], a[20:23], a[8:11], v[68:71]
ds_read_b128 a[48:51], v30 offset:39296
v_mfma_f32_16x16x32_bf16 v[84:87], a[24:27], a[8:11], v[84:87]
ds_read_b128 a[52:55], v30 offset:41600
ds_read_b128 a[56:59], v30 offset:43904
v_mfma_f32_16x16x32_bf16 v[88:91], a[24:27], a[12:15], v[88:91]
buffer_load_dwordx4 v20, s[20:23], s54 offen offset:2048 lds
v_mfma_f32_16x16x32_bf16 v[72:75], a[20:23], a[12:15], v[72:75]
s_add_u32 s54, s54, 196608
s_waitcnt lgkmcnt(4)
v_mfma_f32_16x16x32_bf16 v[244:247], a[24:27], a[16:19], v[244:247]
ds_read_b64_tr_b16 a[64:65], v25 offset:37248
s_add_u32 m0, s55, 18496
v_mfma_f32_16x16x32_bf16 v[104:107], a[28:31], a[12:15], v[104:107]
buffer_load_dwordx4 v21, s[36:39], s52 offen lds
v_mfma_f32_16x16x32_bf16 v[120:123], a[32:35], a[12:15], v[120:123]
ds_read_b64_tr_b16 a[66:67], v25 offset:37760
v_mfma_f32_16x16x32_bf16 v[116:119], a[32:35], a[8:11], v[116:119]
ds_read_b64_tr_b16 a[68:69], v25 offset:37280
ds_read_b64_tr_b16 a[70:71], v25 offset:37792
v_mfma_f32_16x16x32_bf16 v[100:103], a[28:31], a[8:11], v[100:103]
buffer_load_dwordx4 v28, s[36:39], s52 offen offset:1024 lds
v_mfma_f32_16x16x32_bf16 v[96:99], a[28:31], a[4:7], v[96:99]
ds_read_b128 a[60:63], v31 offset:36992
v_mfma_f32_16x16x32_bf16 v[112:115], a[32:35], a[4:7], v[112:115]
buffer_load_dword v22, s[36:39], s52 offen offset:2048 lds
v_mfma_f32_16x16x32_bf16 v[108:111], a[32:35], a[0:3], v[108:111]
ds_read_b64_tr_b16 a[72:73], v25 offset:38272
s_add_u32 s52, s52, 128
v_mfma_f32_16x16x32_bf16 v[92:95], a[28:31], a[0:3], v[92:95]
s_add_u32 m0, s55, 20800
v_mfma_f32_16x16x32_bf16 v[124:127], a[0:3], a[36:39], v[124:127]
buffer_load_dwordx4 v21, s[36:39], s53 offen lds
v_mfma_f32_16x16x32_bf16 v[140:143], a[0:3], a[40:43], v[140:143]
ds_read_b64_tr_b16 a[74:75], v25 offset:38784
ds_read_b64_tr_b16 a[76:77], v25 offset:38304
v_mfma_f32_16x16x32_bf16 v[144:147], a[4:7], a[40:43], v[144:147]
ds_read_b64_tr_b16 a[78:79], v25 offset:38816
v_mfma_f32_16x16x32_bf16 v[128:131], a[4:7], a[36:39], v[128:131]
buffer_load_dwordx4 v28, s[36:39], s53 offen offset:1024 lds
v_mfma_f32_16x16x32_bf16 v[132:135], a[8:11], a[36:39], v[132:135]
ds_read_b64_tr_b16 a[80:81], v25 offset:39296
v_mfma_f32_16x16x32_bf16 v[148:151], a[8:11], a[40:43], v[148:151]
ds_read_b64_tr_b16 a[82:83], v25 offset:39808
ds_read_b64_tr_b16 a[84:85], v25 offset:39328
v_mfma_f32_16x16x32_bf16 v[152:155], a[12:15], a[40:43], v[152:155]
buffer_load_dword v29, s[36:39], s53 offen offset:2048 lds
v_mfma_f32_16x16x32_bf16 v[136:139], a[12:15], a[36:39], v[136:139]
s_add_u32 s53, s53, 128
v_mfma_f32_16x16x32_bf16 v[156:159], a[16:19], a[36:39], v[156:159]
ds_read_b64_tr_b16 a[86:87], v25 offset:39840
v_mfma_f32_16x16x32_bf16 v[160:163], a[16:19], a[40:43], v[160:163]
s_waitcnt vmcnt(22) lgkmcnt(8)
s_barrier
v_mfma_f32_16x16x32_bf16 v[60:63], a[64:67], a[44:47], v[60:63]
ds_read_b128 a[0:3], v23 offset:55488
s_add_u32 m0, s56, 98816
v_mfma_f32_16x16x32_bf16 v[76:79], a[68:71], a[44:47], v[76:79]
buffer_load_dwordx4 v18, s[20:23], s54 offen lds
v_mfma_f32_16x16x32_bf16 v[80:83], a[68:71], a[48:51], v[80:83]
ds_read_b128 a[4:7], v23 offset:57792
v_mfma_f32_16x16x32_bf16 v[64:67], a[64:67], a[48:51], v[64:67]
ds_read_b128 a[8:11], v23 offset:60096
v_mfma_f32_16x16x32_bf16 v[68:71], a[64:67], a[52:55], v[68:71]
ds_read_b128 a[12:15], v23 offset:62400
v_mfma_f32_16x16x32_bf16 v[84:87], a[68:71], a[52:55], v[84:87]
buffer_load_dwordx4 v19, s[20:23], s54 offen offset:1024 lds
v_mfma_f32_16x16x32_bf16 v[88:91], a[68:71], a[56:59], v[88:91]
ds_read_b64_tr_b16 a[20:21], v25 offset:49664
v_mfma_f32_16x16x32_bf16 v[72:75], a[64:67], a[56:59], v[72:75]
ds_read_b64_tr_b16 a[22:23], v25 offset:50176
s_waitcnt lgkmcnt(6)
v_mfma_f32_16x16x32_bf16 v[244:247], a[68:71], a[60:63], v[244:247]
v_mfma_f32_16x16x32_bf16 v[104:107], a[72:75], a[56:59], v[104:107]
buffer_load_dwordx4 v20, s[20:23], s54 offen offset:2048 lds
v_mfma_f32_16x16x32_bf16 v[120:123], a[76:79], a[56:59], v[120:123]
ds_read_b64_tr_b16 a[24:25], v25 offset:49696
s_add_u32 s54, s54, 196608
v_mfma_f32_16x16x32_bf16 v[116:119], a[76:79], a[52:55], v[116:119]
ds_read_b64_tr_b16 a[26:27], v25 offset:50208
v_mfma_f32_16x16x32_bf16 v[100:103], a[72:75], a[52:55], v[100:103]
ds_read_b128 a[16:19], v24 offset:55488
s_add_u32 m0, s55, 36992
v_mfma_f32_16x16x32_bf16 v[96:99], a[72:75], a[48:51], v[96:99]
buffer_load_dwordx4 v21, s[36:39], s52 offen lds
v_mfma_f32_16x16x32_bf16 v[112:115], a[76:79], a[48:51], v[112:115]
ds_read_b64_tr_b16 a[28:29], v25 offset:50688
v_mfma_f32_16x16x32_bf16 v[108:111], a[76:79], a[44:47], v[108:111]
ds_read_b64_tr_b16 a[30:31], v25 offset:51200
v_mfma_f32_16x16x32_bf16 v[92:95], a[72:75], a[44:47], v[92:95]
ds_read_b64_tr_b16 a[32:33], v25 offset:50720
v_mfma_f32_16x16x32_bf16 v[124:127], a[44:47], a[80:83], v[124:127]
buffer_load_dwordx4 v28, s[36:39], s52 offen offset:1024 lds
v_mfma_f32_16x16x32_bf16 v[140:143], a[44:47], a[84:87], v[140:143]
v_mfma_f32_16x16x32_bf16 v[144:147], a[48:51], a[84:87], v[144:147]
ds_read_b64_tr_b16 a[34:35], v25 offset:51232
v_mfma_f32_16x16x32_bf16 v[128:131], a[48:51], a[80:83], v[128:131]
ds_read_b64_tr_b16 a[36:37], v25 offset:51712
v_mfma_f32_16x16x32_bf16 v[132:135], a[52:55], a[80:83], v[132:135]
buffer_load_dword v22, s[36:39], s52 offen offset:2048 lds
v_mfma_f32_16x16x32_bf16 v[148:151], a[52:55], a[84:87], v[148:151]
ds_read_b64_tr_b16 a[38:39], v25 offset:52224
s_add_u32 s52, s52, 128
v_mfma_f32_16x16x32_bf16 v[152:155], a[56:59], a[84:87], v[152:155]
ds_read_b64_tr_b16 a[40:41], v25 offset:51744
v_mfma_f32_16x16x32_bf16 v[136:139], a[56:59], a[80:83], v[136:139]
ds_read_b64_tr_b16 a[42:43], v25 offset:52256
v_mfma_f32_16x16x32_bf16 v[156:159], a[60:63], a[80:83], v[156:159]
v_mfma_f32_16x16x32_bf16 v[160:163], a[60:63], a[84:87], v[160:163]
s_waitcnt vmcnt(25) lgkmcnt(8)
s_barrier
v_mfma_f32_16x16x32_bf16 v[60:63], a[20:23], a[0:3], v[60:63]
ds_read_b128 a[44:47], v30 offset:55488
s_add_u32 m0, s56, 111232
v_mfma_f32_16x16x32_bf16 v[76:79], a[24:27], a[0:3], v[76:79]
buffer_load_dwordx4 v18, s[20:23], s54 offen lds
v_mfma_f32_16x16x32_bf16 v[80:83], a[24:27], a[4:7], v[80:83]
s_sub_u32 s47, s47, 1
s_cbranch_scc1 .Lx21
.Lx21b:
v_mfma_f32_16x16x32_bf16 v[64:67], a[20:23], a[4:7], v[64:67]
ds_read_b128 a[48:51], v30 offset:57792
v_mfma_f32_16x16x32_bf16 v[68:71], a[20:23], a[8:11], v[68:71]
ds_read_b128 a[52:55], v30 offset:60096
v_mfma_f32_16x16x32_bf16 v[84:87], a[24:27], a[8:11], v[84:87]
buffer_load_dwordx4 v19, s[20:23], s54 offen offset:1024 lds
v_mfma_f32_16x16x32_bf16 v[88:91], a[24:27], a[12:15], v[88:91]
ds_read_b128 a[56:59], v30 offset:62400
v_mfma_f32_16x16x32_bf16 v[72:75], a[20:23], a[12:15], v[72:75]
ds_read_b64_tr_b16 a[64:65], v25 offset:62080
s_waitcnt lgkmcnt(5)
v_mfma_f32_16x16x32_bf16 v[244:247], a[24:27], a[16:19], v[244:247]
ds_read_b64_tr_b16 a[66:67], v25 offset:62592
v_mfma_f32_16x16x32_bf16 v[104:107], a[28:31], a[12:15], v[104:107]
buffer_load_dwordx4 v20, s[20:23], s54 offen offset:2048 lds
v_mfma_f32_16x16x32_bf16 v[120:123], a[32:35], a[12:15], v[120:123]
ds_read_b64_tr_b16 a[68:69], v25 offset:62112
s_add_u32 s54, s54, 196608
v_mfma_f32_16x16x32_bf16 v[116:119], a[32:35], a[8:11], v[116:119]
ds_read_b64_tr_b16 a[70:71], v25 offset:62624
v_mfma_f32_16x16x32_bf16 v[100:103], a[28:31], a[8:11], v[100:103]
ds_read_b128 a[60:63], v31 offset:55488
s_add_u32 m0, s55, 39296
v_mfma_f32_16x16x32_bf16 v[96:99], a[28:31], a[4:7], v[96:99]
buffer_load_dwordx4 v21, s[36:39], s53 offen lds
v_mfma_f32_16x16x32_bf16 v[112:115], a[32:35], a[4:7], v[112:115]
v_mfma_f32_16x16x32_bf16 v[108:111], a[32:35], a[0:3], v[108:111]
ds_read_b64_tr_b16 a[72:73], v25 offset:63104
v_mfma_f32_16x16x32_bf16 v[92:95], a[28:31], a[0:3], v[92:95]
ds_read_b64_tr_b16 a[74:75], v25 offset:63616
v_mfma_f32_16x16x32_bf16 v[124:127], a[0:3], a[36:39], v[124:127]
buffer_load_dwordx4 v28, s[36:39], s53 offen offset:1024 lds
v_mfma_f32_16x16x32_bf16 v[140:143], a[0:3], a[40:43], v[140:143]
ds_read_b64_tr_b16 a[76:77], v25 offset:63136
v_mfma_f32_16x16x32_bf16 v[144:147], a[4:7], a[40:43], v[144:147]
ds_read_b64_tr_b16 a[78:79], v25 offset:63648
v_mfma_f32_16x16x32_bf16 v[128:131], a[4:7], a[36:39], v[128:131]
ds_read_b64_tr_b16 a[80:81], v25 offset:64128
v_mfma_f32_16x16x32_bf16 v[132:135], a[8:11], a[36:39], v[132:135]
buffer_load_dword v29, s[36:39], s53 offen offset:2048 lds
v_mfma_f32_16x16x32_bf16 v[148:151], a[8:11], a[40:43], v[148:151]
ds_read_b64_tr_b16 a[82:83], v25 offset:64640
s_add_u32 s53, s53, 128
v_mfma_f32_16x16x32_bf16 v[152:155], a[12:15], a[40:43], v[152:155]
ds_read_b64_tr_b16 a[84:85], v25 offset:64160
v_mfma_f32_16x16x32_bf16 v[136:139], a[12:15], a[36:39], v[136:139]
ds_read_b64_tr_b16 a[86:87], v25 offset:64672
v_mfma_f32_16x16x32_bf16 v[156:159], a[16:19], a[36:39], v[156:159]
v_mfma_f32_16x16x32_bf16 v[160:163], a[16:19], a[40:43], v[160:163]
s_waitcnt vmcnt(22) lgkmcnt(8)
s_barrier
s_waitcnt vmcnt(21)
v_cmp_ne_u32 vcc, v35, v37
s_nop 0
s_cbranch_vccnz .Lsp22
.Lsp22b:
v_mov_b32 v37, 0
v_mfma_f32_16x16x32_bf16 v[60:63], a[64:67], a[44:47], v[60:63]
ds_read_b128 a[0:3], v23
v_mfma_f32_16x16x32_bf16 v[76:79], a[68:71], a[44:47], v[76:79]
buffer_atomic_add v35, v32, s[16:19], 0 offen
v_mfma_f32_16x16x32_bf16 v[80:83], a[68:71], a[48:51], v[80:83]
ds_read_b128 a[4:7], v23 offset:2304
v_mfma_f32_16x16x32_bf16 v[64:67], a[64:67], a[48:51], v[64:67]
ds_read_b128 a[8:11], v23 offset:4608
s_add_u32 m0, s56, 123648
v_mfma_f32_16x16x32_bf16 v[68:71], a[64:67], a[52:55], v[68:71]
buffer_load_dwordx4 v18, s[20:23], s54 offen lds
v_mfma_f32_16x16x32_bf16 v[84:87], a[68:71], a[52:55], v[84:87]
ds_read_b128 a[12:15], v23 offset:6912
v_mfma_f32_16x16x32_bf16 v[88:91], a[68:71], a[56:59], v[88:91]
ds_read_b64_tr_b16 a[20:21], v25
v_mfma_f32_16x16x32_bf16 v[72:75], a[64:67], a[56:59], v[72:75]
ds_read_b64_tr_b16 a[22:23], v25 offset:512
s_waitcnt lgkmcnt(6)
v_mfma_f32_16x16x32_bf16 v[244:247], a[68:71], a[60:63], v[244:247]
buffer_load_dwordx4 v19, s[20:23], s54 offen offset:1024 lds
v_mfma_f32_16x16x32_bf16 v[104:107], a[72:75], a[56:59], v[104:107]
ds_read_b64_tr_b16 a[24:25], v25 offset:32
v_mfma_f32_16x16x32_bf16 v[120:123], a[76:79], a[56:59], v[120:123]
ds_read_b64_tr_b16 a[26:27], v25 offset:544
v_mfma_f32_16x16x32_bf16 v[116:119], a[76:79], a[52:55], v[116:119]
buffer_load_dwordx4 v20, s[20:23], s54 offen offset:2048 lds
v_mfma_f32_16x16x32_bf16 v[100:103], a[72:75], a[52:55], v[100:103]
ds_read_b128 a[16:19], v24
s_add_u32 s54, s54, 196608
v_mfma_f32_16x16x32_bf16 v[96:99], a[72:75], a[48:51], v[96:99]
v_mfma_f32_16x16x32_bf16 v[112:115], a[76:79], a[48:51], v[112:115]
ds_read_b64_tr_b16 a[28:29], v25 offset:1024
s_add_u32 m0, s55, 55488
v_mfma_f32_16x16x32_bf16 v[108:111], a[76:79], a[44:47], v[108:111]
buffer_load_dwordx4 v21, s[36:39], s52 offen lds
v_mfma_f32_16x16x32_bf16 v[92:95], a[72:75], a[44:47], v[92:95]
ds_read_b64_tr_b16 a[30:31], v25 offset:1536
v_mfma_f32_16x16x32_bf16 v[124:127], a[44:47], a[80:83], v[124:127]
ds_read_b64_tr_b16 a[32:33], v25 offset:1056
v_mfma_f32_16x16x32_bf16 v[140:143], a[44:47], a[84:87], v[140:143]
buffer_load_dwordx4 v28, s[36:39], s52 offen offset:1024 lds
v_mfma_f32_16x16x32_bf16 v[144:147], a[48:51], a[84:87], v[144:147]
ds_read_b64_tr_b16 a[34:35], v25 offset:1568
v_mfma_f32_16x16x32_bf16 v[128:131], a[48:51], a[80:83], v[128:131]
ds_read_b64_tr_b16 a[36:37], v25 offset:2048
v_mfma_f32_16x16x32_bf16 v[132:135], a[52:55], a[80:83], v[132:135]
ds_read_b64_tr_b16 a[38:39], v25 offset:2560
v_mfma_f32_16x16x32_bf16 v[148:151], a[52:55], a[84:87], v[148:151]
buffer_load_dword v22, s[36:39], s52 offen offset:2048 lds
v_mfma_f32_16x16x32_bf16 v[152:155], a[56:59], a[84:87], v[152:155]
ds_read_b64_tr_b16 a[40:41], v25 offset:2080
s_add_u32 s52, s52, 128
v_mfma_f32_16x16x32_bf16 v[136:139], a[56:59], a[80:83], v[136:139]
ds_read_b64_tr_b16 a[42:43], v25 offset:2592
v_mfma_f32_16x16x32_bf16 v[156:159], a[60:63], a[80:83], v[156:159]
v_mfma_f32_16x16x32_bf16 v[160:163], a[60:63], a[84:87], v[160:163]
s_waitcnt vmcnt(25) lgkmcnt(8)
s_barrier
v_mfma_f32_16x16x32_bf16 v[60:63], a[20:23], a[0:3], v[60:63]
ds_read_b128 a[44:47], v30
s_add_u32 m0, s56, 136064
v_mfma_f32_16x16x32_bf16 v[76:79], a[24:27], a[0:3], v[76:79]
buffer_load_dwordx4 v18, s[20:23], s54 offen lds
v_mfma_f32_16x16x32_bf16 v[80:83], a[24:27], a[4:7], v[80:83]
s_sub_u32 s47, s47, 1
s_cbranch_scc1 .Lx23
.Lx23b:
v_mfma_f32_16x16x32_bf16 v[64:67], a[20:23], a[4:7], v[64:67]
ds_read_b128 a[48:51], v30 offset:2304
v_mfma_f32_16x16x32_bf16 v[68:71], a[20:23], a[8:11], v[68:71]
ds_read_b128 a[52:55], v30 offset:4608
v_mfma_f32_16x16x32_bf16 v[84:87], a[24:27], a[8:11], v[84:87]
buffer_load_dwordx4 v19, s[20:23], s54 offen offset:1024 lds
v_mfma_f32_16x16x32_bf16 v[88:91], a[24:27], a[12:15], v[88:91]
ds_read_b128 a[56:59], v30 offset:6912
v_mfma_f32_16x16x32_bf16 v[72:75], a[20:23], a[12:15], v[72:75]
ds_read_b64_tr_b16 a[64:65], v25 offset:12416
s_waitcnt lgkmcnt(5)
v_mfma_f32_16x16x32_bf16 v[244:247], a[24:27], a[16:19], v[244:247]
ds_read_b64_tr_b16 a[66:67], v25 offset:12928
v_mfma_f32_16x16x32_bf16 v[104:107], a[28:31], a[12:15], v[104:107]
buffer_load_dwordx4 v20, s[20:23], s54 offen offset:2048 lds
v_mfma_f32_16x16x32_bf16 v[120:123], a[32:35], a[12:15], v[120:123]
ds_read_b64_tr_b16 a[68:69], v25 offset:12448
s_add_u32 s54, s54, 196608
v_mfma_f32_16x16x32_bf16 v[116:119], a[32:35], a[8:11], v[116:119]
ds_read_b64_tr_b16 a[70:71], v25 offset:12960
v_mfma_f32_16x16x32_bf16 v[100:103], a[28:31], a[8:11], v[100:103]
ds_read_b128 a[60:63], v31
s_add_u32 m0, s55, 57792
v_mfma_f32_16x16x32_bf16 v[96:99], a[28:31], a[4:7], v[96:99]
buffer_load_dwordx4 v21, s[36:39], s53 offen lds
v_mfma_f32_16x16x32_bf16 v[112:115], a[32:35], a[4:7], v[112:115]
v_mfma_f32_16x16x32_bf16 v[108:111], a[32:35], a[0:3], v[108:111]
ds_read_b64_tr_b16 a[72:73], v25 offset:13440
v_mfma_f32_16x16x32_bf16 v[92:95], a[28:31], a[0:3], v[92:95]
ds_read_b64_tr_b16 a[74:75], v25 offset:13952
v_mfma_f32_16x16x32_bf16 v[124:127], a[0:3], a[36:39], v[124:127]
buffer_load_dwordx4 v28, s[36:39], s53 offen offset:1024 lds
v_mfma_f32_16x16x32_bf16 v[140:143], a[0:3], a[40:43], v[140:143]
ds_read_b64_tr_b16 a[76:77], v25 offset:13472
v_mfma_f32_16x16x32_bf16 v[144:147], a[4:7], a[40:43], v[144:147]
ds_read_b64_tr_b16 a[78:79], v25 offset:13984
v_mfma_f32_16x16x32_bf16 v[128:131], a[4:7], a[36:39], v[128:131]
ds_read_b64_tr_b16 a[80:81], v25 offset:14464
v_mfma_f32_16x16x32_bf16 v[132:135], a[8:11], a[36:39], v[132:135]
buffer_load_dword v29, s[36:39], s53 offen offset:2048 lds
v_mfma_f32_16x16x32_bf16 v[148:151], a[8:11], a[40:43], v[148:151]
ds_read_b64_tr_b16 a[82:83], v25 offset:14976
s_add_u32 s53, s53, 128
v_mfma_f32_16x16x32_bf16 v[152:155], a[12:15], a[40:43], v[152:155]
ds_read_b64_tr_b16 a[84:85], v25 offset:14496
v_mfma_f32_16x16x32_bf16 v[136:139], a[12:15], a[36:39], v[136:139]
ds_read_b64_tr_b16 a[86:87], v25 offset:15008
v_mfma_f32_16x16x32_bf16 v[156:159], a[16:19], a[36:39], v[156:159]
v_mfma_f32_16x16x32_bf16 v[160:163], a[16:19], a[40:43], v[160:163]
s_waitcnt vmcnt(22) lgkmcnt(8)
s_barrier
v_mfma_f32_16x16x32_bf16 v[60:63], a[64:67], a[44:47], v[60:63]
ds_read_b128 a[0:3], v23 offset:18496
s_add_u32 m0, s56, 73984
v_mfma_f32_16x16x32_bf16 v[76:79], a[68:71], a[44:47], v[76:79]
buffer_load_dwordx4 v18, s[20:23], s54 offen lds
v_mfma_f32_16x16x32_bf16 v[80:83], a[68:71], a[48:51], v[80:83]
ds_read_b128 a[4:7], v23 offset:20800
v_mfma_f32_16x16x32_bf16 v[64:67], a[64:67], a[48:51], v[64:67]
ds_read_b128 a[8:11], v23 offset:23104
v_mfma_f32_16x16x32_bf16 v[68:71], a[64:67], a[52:55], v[68:71]
ds_read_b128 a[12:15], v23 offset:25408
v_mfma_f32_16x16x32_bf16 v[84:87], a[68:71], a[52:55], v[84:87]
buffer_load_dwordx4 v19, s[20:23], s54 offen offset:1024 lds
v_mfma_f32_16x16x32_bf16 v[88:91], a[68:71], a[56:59], v[88:91]
ds_read_b64_tr_b16 a[20:21], v25 offset:24832
v_mfma_f32_16x16x32_bf16 v[72:75], a[64:67], a[56:59], v[72:75]
ds_read_b64_tr_b16 a[22:23], v25 offset:25344
s_waitcnt lgkmcnt(6)
v_mfma_f32_16x16x32_bf16 v[244:247], a[68:71], a[60:63], v[244:247]
v_mfma_f32_16x16x32_bf16 v[104:107], a[72:75], a[56:59], v[104:107]
buffer_load_dwordx4 v20, s[20:23], s54 offen offset:2048 lds
v_mfma_f32_16x16x32_bf16 v[120:123], a[76:79], a[56:59], v[120:123]
ds_read_b64_tr_b16 a[24:25], v25 offset:24864
s_add_u32 s54, s54, 196608
v_mfma_f32_16x16x32_bf16 v[116:119], a[76:79], a[52:55], v[116:119]
ds_read_b64_tr_b16 a[26:27], v25 offset:25376
v_mfma_f32_16x16x32_bf16 v[100:103], a[72:75], a[52:55], v[100:103]
ds_read_b128 a[16:19], v24 offset:18496
s_add_u32 m0, s55, 0
v_mfma_f32_16x16x32_bf16 v[96:99], a[72:75], a[48:51], v[96:99]
buffer_load_dwordx4 v21, s[36:39], s52 offen lds
v_mfma_f32_16x16x32_bf16 v[112:115], a[76:79], a[48:51], v[112:115]
ds_read_b64_tr_b16 a[28:29], v25 offset:25856
v_mfma_f32_16x16x32_bf16 v[108:111], a[76:79], a[44:47], v[108:111]
ds_read_b64_tr_b16 a[30:31], v25 offset:26368
v_mfma_f32_16x16x32_bf16 v[92:95], a[72:75], a[44:47], v[92:95]
ds_read_b64_tr_b16 a[32:33], v25 offset:25888
v_mfma_f32_16x16x32_bf16 v[124:127], a[44:47], a[80:83], v[124:127]
buffer_load_dwordx4 v28, s[36:39], s52 offen offset:1024 lds
v_mfma_f32_16x16x32_bf16 v[140:143], a[44:47], a[84:87], v[140:143]
v_mfma_f32_16x16x32_bf16 v[144:147], a[48:51], a[84:87], v[144:147]
ds_read_b64_tr_b16 a[34:35], v25 offset:26400
v_mfma_f32_16x16x32_bf16 v[128:131], a[48:51], a[80:83], v[128:131]
ds_read_b64_tr_b16 a[36:37], v25 offset:26880
v_mfma_f32_16x16x32_bf16 v[132:135], a[52:55], a[80:83], v[132:135]
buffer_load_dword v22, s[36:39], s52 offen offset:2048 lds
v_mfma_f32_16x16x32_bf16 v[148:151], a[52:55], a[84:87], v[148:151]
ds_read_b64_tr_b16 a[38:39], v25 offset:27392
s_add_u32 s52, s52, 128
v_mfma_f32_16x16x32_bf16 v[152:155], a[56:59], a[84:87], v[152:155]
ds_read_b64_tr_b16 a[40:41], v25 offset:26912
v_mfma_f32_16x16x32_bf16 v[136:139], a[56:59], a[80:83], v[136:139]
ds_read_b64_tr_b16 a[42:43], v25 offset:27424
v_mfma_f32_16x16x32_bf16 v[156:159], a[60:63], a[80:83], v[156:159]
v_mfma_f32_16x16x32_bf16 v[160:163], a[60:63], a[84:87], v[160:163]
s_waitcnt vmcnt(22) lgkmcnt(8)
s_barrier
v_mfma_f32_16x16x32_bf16 v[60:63], a[20:23], a[0:3], v[60:63]
ds_read_b128 a[44:47], v30 offset:18496
s_add_u32 m0, s56, 86400
v_mfma_f32_16x16x32_bf16 v[76:79], a[24:27], a[0:3], v[76:79]
buffer_load_dwordx4 v18, s[20:23], s54 offen lds
v_mfma_f32_16x16x32_bf16 v[80:83], a[24:27], a[4:7], v[80:83]
s_sub_u32 s47, s47, 1
s_cbranch_scc1 .Lx24
.Lx24b:
v_mfma_f32_16x16x32_bf16 v[64:67], a[20:23], a[4:7], v[64:67]
ds_read_b128 a[48:51], v30 offset:20800
v_mfma_f32_16x16x32_bf16 v[68:71], a[20:23], a[8:11], v[68:71]
ds_read_b128 a[52:55], v30 offset:23104
v_mfma_f32_16x16x32_bf16 v[84:87], a[24:27], a[8:11], v[84:87]
buffer_load_dwordx4 v19, s[20:23], s54 offen offset:1024 lds
v_mfma_f32_16x16x32_bf16 v[88:91], a[24:27], a[12:15], v[88:91]
ds_read_b128 a[56:59], v30 offset:25408
v_mfma_f32_16x16x32_bf16 v[72:75], a[20:23], a[12:15], v[72:75]
ds_read_b64_tr_b16 a[64:65], v25 offset:37248
s_waitcnt lgkmcnt(5)
v_mfma_f32_16x16x32_bf16 v[244:247], a[24:27], a[16:19], v[244:247]
ds_read_b64_tr_b16 a[66:67], v25 offset:37760
v_mfma_f32_16x16x32_bf16 v[104:107], a[28:31], a[12:15], v[104:107]
buffer_load_dwordx4 v20, s[20:23], s54 offen offset:2048 lds
v_mfma_f32_16x16x32_bf16 v[120:123], a[32:35], a[12:15], v[120:123]
ds_read_b64_tr_b16 a[68:69], v25 offset:37280
s_add_u32 s54, s54, 196608
v_mfma_f32_16x16x32_bf16 v[116:119], a[32:35], a[8:11], v[116:119]
ds_read_b64_tr_b16 a[70:71], v25 offset:37792
v_mfma_f32_16x16x32_bf16 v[100:103], a[28:31], a[8:11], v[100:103]
ds_read_b128 a[60:63], v31 offset:18496
s_add_u32 m0, s55, 2304
v_mfma_f32_16x16x32_bf16 v[96:99], a[28:31], a[4:7], v[96:99]
buffer_load_dwordx4 v21, s[36:39], s53 offen lds
v_mfma_f32_16x16x32_bf16 v[112:115], a[32:35], a[4:7], v[112:115]
v_mfma_f32_16x16x32_bf16 v[108:111], a[32:35], a[0:3], v[108:111]
ds_read_b64_tr_b16 a[72:73], v25 offset:38272
v_mfma_f32_16x16x32_bf16 v[92:95], a[28:31], a[0:3], v[92:95]
ds_read_b64_tr_b16 a[74:75], v25 offset:38784
v_mfma_f32_16x16x32_bf16 v[124:127], a[0:3], a[36:39], v[124:127]
buffer_load_dwordx4 v28, s[36:39], s53 offen offset:1024 lds
v_mfma_f32_16x16x32_bf16 v[140:143], a[0:3], a[40:43], v[140:143]
ds_read_b64_tr_b16 a[76:77], v25 offset:38304
v_mfma_f32_16x16x32_bf16 v[144:147], a[4:7], a[40:43], v[144:147]
ds_read_b64_tr_b16 a[78:79], v25 offset:38816
v_mfma_f32_16x16x32_bf16 v[128:131], a[4:7], a[36:39], v[128:131]
ds_read_b64_tr_b16 a[80:81], v25 offset:39296
v_mfma_f32_16x16x32_bf16 v[132:135], a[8:11], a[36:39], v[132:135]
buffer_load_dword v29, s[36:39], s53 offen offset:2048 lds
v_mfma_f32_16x16x32_bf16 v[148:151], a[8:11], a[40:43], v[148:151]
ds_read_b64_tr_b16 a[82:83], v25 offset:39808
s_add_u32 s53, s53, 128
v_mfma_f32_16x16x32_bf16 v[152:155], a[12:15], a[40:43], v[152:155]
ds_read_b64_tr_b16 a[84:85], v25 offset:39328
v_mfma_f32_16x16x32_bf16 v[136:139], a[12:15], a[36:39], v[136:139]
ds_read_b64_tr_b16 a[86:87], v25 offset:39840
v_mfma_f32_16x16x32_bf16 v[156:159], a[16:19], a[36:39], v[156:159]
v_mfma_f32_16x16x32_bf16 v[160:163], a[16:19], a[40:43], v[160:163]
s_waitcnt vmcnt(21) lgkmcnt(8)
s_barrier
v_mfma_f32_16x16x32_bf16 v[60:63], a[64:67], a[44:47], v[60:63]
ds_read_b128 a[0:3], v23 offset:36992
s_add_u32 m0, s56, 98816
v_mfma_f32_16x16x32_bf16 v[76:79], a[68:71], a[44:47], v[76:79]
buffer_load_dwordx4 v18, s[20:23], s54 offen lds
v_mfma_f32_16x16x32_bf16 v[80:83], a[68:71], a[48:51], v[80:83]
ds_read_b128 a[4:7], v23 offset:39296
v_mfma_f32_16x16x32_bf16 v[64:67], a[64:67], a[48:51], v[64:67]
ds_read_b128 a[8:11], v23 offset:41600
v_mfma_f32_16x16x32_bf16 v[68:71], a[64:67], a[52:55], v[68:71]
ds_read_b128 a[12:15], v23 offset:43904
v_mfma_f32_16x16x32_bf16 v[84:87], a[68:71], a[52:55], v[84:87]
buffer_load_dwordx4 v19, s[20:23], s54 offen offset:1024 lds
v_mfma_f32_16x16x32_bf16 v[88:91], a[68:71], a[56:59], v[88:91]
ds_read_b64_tr_b16 a[20:21], v25 offset:49664
v_mfma_f32_16x16x32_bf16 v[72:75], a[64:67], a[56:59], v[72:75]
ds_read_b64_tr_b16 a[22:23], v25 offset:50176
s_waitcnt lgkmcnt(6)
v_mfma_f32_16x16x32_bf16 v[244:247], a[68:71], a[60:63], v[244:247]
v_mfma_f32_16x16x32_bf16 v[104:107], a[72:75], a[56:59], v[104:107]
buffer_load_dwordx4 v20, s[20:23], s54 offen offset:2048 lds
v_mfma_f32_16x16x32_bf16 v[120:123], a[76:79], a[56:59], v[120:123]
ds_read_b64_tr_b16 a[24:25], v25 offset:49696
s_add_u32 s54, s54, 196608
v_mfma_f32_16x16x32_bf16 v[116:119], a[76:79], a[52:55], v[116:119]
ds_read_b64_tr_b16 a[26:27], v25 offset:50208
v_mfma_f32_16x16x32_bf16 v[100:103], a[72:75], a[52:55], v[100:103]
ds_read_b128 a[16:19], v24 offset:36992
s_add_u32 m0, s55, 18496
v_mfma_f32_16x16x32_bf16 v[96:99], a[72:75], a[48:51], v[96:99]
buffer_load_dwordx4 v21, s[36:39], s52 offen lds
v_mfma_f32_16x16x32_bf16 v[112:115], a[76:79], a[48:51], v[112:115]
ds_read_b64_tr_b16 a[28:29], v25 offset:50688
v_mfma_f32_16x16x32_bf16 v[108:111], a[76:79], a[44:47], v[108:111]
ds_read_b64_tr_b16 a[30:31], v25 offset:51200
v_mfma_f32_16x16x32_bf16 v[92:95], a[72:75], a[44:47], v[92:95]
ds_read_b64_tr_b16 a[32:33], v25 offset:50720
v_mfma_f32_16x16x32_bf16 v[124:127], a[44:47], a[80:83], v[124:127]
buffer_load_dwordx4 v28, s[36:39], s52 offen offset:1024 lds
v_mfma_f32_16x16x32_bf16 v[140:143], a[44:47], a[84:87], v[140:143]
v_mfma_f32_16x16x32_bf16 v[144:147], a[48:51], a[84:87], v[144:147]
ds_read_b64_tr_b16 a[34:35], v25 offset:51232
v_mfma_f32_16x16x32_bf16 v[128:131], a[48:51], a[80:83], v[128:131]
ds_read_b64_tr_b16 a[36:37], v25 offset:51712
v_mfma_f32_16x16x32_bf16 v[132:135], a[52:55], a[80:83], v[132:135]
buffer_load_dword v22, s[36:39], s52 offen offset:2048 lds
v_mfma_f32_16x16x32_bf16 v[148:151], a[52:55], a[84:87], v[148:151]
ds_read_b64_tr_b16 a[38:39], v25 offset:52224
s_add_u32 s52, s52, 128
v_mfma_f32_16x16x32_bf16 v[152:155], a[56:59], a[84:87], v[152:155]
ds_read_b64_tr_b16 a[40:41], v25 offset:51744
v_mfma_f32_16x16x32_bf16 v[136:139], a[56:59], a[80:83], v[136:139]
ds_read_b64_tr_b16 a[42:43], v25 offset:52256
v_mfma_f32_16x16x32_bf16 v[156:159], a[60:63], a[80:83], v[156:159]
v_mfma_f32_16x16x32_bf16 v[160:163], a[60:63], a[84:87], v[160:163]
s_waitcnt vmcnt(21) lgkmcnt(8)
s_barrier
v_mfma_f32_16x16x32_bf16 v[60:63], a[20:23], a[0:3], v[60:63]
ds_read_b128 a[44:47], v30 offset:36992
s_add_u32 m0, s56, 111232
v_mfma_f32_16x16x32_bf16 v[76:79], a[24:27], a[0:3], v[76:79]
buffer_load_dwordx4 v18, s[20:23], s54 offen lds
v_mfma_f32_16x16x32_bf16 v[80:83], a[24:27], a[4:7], v[80:83]
s_sub_u32 s47, s47, 1
s_cbranch_scc1 .Lx25
.Lx25b:
v_mfma_f32_16x16x32_bf16 v[64:67], a[20:23], a[4:7], v[64:67]
ds_read_b128 a[48:51], v30 offset:39296
v_mfma_f32_16x16x32_bf16 v[68:71], a[20:23], a[8:11], v[68:71]
buffer_load_dwordx4 v19, s[20:23], s54 offen offset:1024 lds
v_mfma_f32_16x16x32_bf16 v[84:87], a[24:27], a[8:11], v[84:87]
ds_read_b128 a[52:55], v30 offset:41600
v_mfma_f32_16x16x32_bf16 v[88:91], a[24:27], a[12:15], v[88:91]
ds_read_b128 a[56:59], v30 offset:43904
v_mfma_f32_16x16x32_bf16 v[72:75], a[20:23], a[12:15], v[72:75]
ds_read_b64_tr_b16 a[64:65], v25 offset:62080
s_waitcnt lgkmcnt(5)
v_mfma_f32_16x16x32_bf16 v[244:247], a[24:27], a[16:19], v[244:247]
buffer_load_dwordx4 v20, s[20:23], s54 offen offset:2048 lds
v_mfma_f32_16x16x32_bf16 v[104:107], a[28:31], a[12:15], v[104:107]
ds_read_b64_tr_b16 a[66:67], v25 offset:62592
s_add_u32 s54, s54, 196608
v_mfma_f32_16x16x32_bf16 v[120:123], a[32:35], a[12:15], v[120:123]
ds_read_b64_tr_b16 a[68:69], v25 offset:62112
s_add_u32 m0, s55, 20800
v_mfma_f32_16x16x32_bf16 v[116:119], a[32:35], a[8:11], v[116:119]
buffer_load_dwordx4 v21, s[36:39], s53 offen lds
v_mfma_f32_16x16x32_bf16 v[100:103], a[28:31], a[8:11], v[100:103]
ds_read_b64_tr_b16 a[70:71], v25 offset:62624
v_mfma_f32_16x16x32_bf16 v[96:99], a[28:31], a[4:7], v[96:99]
ds_read_b128 a[60:63], v31 offset:36992
v_mfma_f32_16x16x32_bf16 v[112:115], a[32:35], a[4:7], v[112:115]
ds_read_b64_tr_b16 a[72:73], v25 offset:63104
v_mfma_f32_16x16x32_bf16 v[108:111], a[32:35], a[0:3], v[108:111]
buffer_load_dwordx4 v28, s[36:39], s53 offen offset:1024 lds
v_mfma_f32_16x16x32_bf16 v[92:95], a[28:31], a[0:3], v[92:95]
ds_read_b64_tr_b16 a[74:75], v25 offset:63616
v_mfma_f32_16x16x32_bf16 v[124:127], a[0:3], a[36:39], v[124:127]
ds_read_b64_tr_b16 a[76:77], v25 offset:63136
v_mfma_f32_16x16x32_bf16 v[140:143], a[0:3], a[40:43], v[140:143]
buffer_load_dword v29, s[36:39], s53 offen offset:2048 lds
v_mfma_f32_16x16x32_bf16 v[144:147], a[4:7], a[40:43], v[144:147]
ds_read_b64_tr_b16 a[78:79], v25 offset:63648
s_add_u32 s53, s53, 128
v_mfma_f32_16x16x32_bf16 v[128:131], a[4:7], a[36:39], v[128:131]
ds_read_b64_tr_b16 a[80:81], v25 offset:64128
v_mfma_f32_16x16x32_bf16 v[132:135], a[8:11], a[36:39], v[132:135]
ds_read_b64_tr_b16 a[82:83], v25 offset:64640
v_mfma_f32_16x16x32_bf16 v[148:151], a[8:11], a[40:43], v[148:151]
buffer_atomic_add v37, v33, s[16:19], 0 offen sc0
v_mfma_f32_16x16x32_bf16 v[152:155], a[12:15], a[40:43], v[152:155]
ds_read_b64_tr_b16 a[84:85], v25 offset:64160
v_mfma_f32_16x16x32_bf16 v[136:139], a[12:15], a[36:39], v[136:139]
ds_read_b64_tr_b16 a[86:87], v25 offset:64672
v_mfma_f32_16x16x32_bf16 v[156:159], a[16:19], a[36:39], v[156:159]
v_mfma_f32_16x16x32_bf16 v[160:163], a[16:19], a[40:43], v[160:163]
s_waitcnt vmcnt(22) lgkmcnt(8)
s_barrier
v_mfma_f32_16x16x32_bf16 v[60:63], a[64:67], a[44:47], v[60:63]
ds_read_b128 a[0:3], v23 offset:55488
s_add_u32 m0, s56, 123648
v_mfma_f32_16x16x32_bf16 v[76:79], a[68:71], a[44:47], v[76:79]
buffer_load_dwordx4 v18, s[20:23], s54 offen lds
v_mfma_f32_16x16x32_bf16 v[80:83], a[68:71], a[48:51], v[80:83]
ds_read_b128 a[4:7], v23 offset:57792
v_mfma_f32_16x16x32_bf16 v[64:67], a[64:67], a[48:51], v[64:67]
ds_read_b128 a[8:11], v23 offset:60096
v_mfma_f32_16x16x32_bf16 v[68:71], a[64:67], a[52:55], v[68:71]
ds_read_b128 a[12:15], v23 offset:62400
v_mfma_f32_16x16x32_bf16 v[84:87], a[68:71], a[52:55], v[84:87]
buffer_load_dwordx4 v19, s[20:23], s54 offen offset:1024 lds
v_mfma_f32_16x16x32_bf16 v[88:91], a[68:71], a[56:59], v[88:91]
ds_read_b64_tr_b16 a[20:21], v25
v_mfma_f32_16x16x32_bf16 v[72:75], a[64:67], a[56:59], v[72:75]
ds_read_b64_tr_b16 a[22:23], v25 offset:512
s_waitcnt lgkmcnt(6)
v_mfma_f32_16x16x32_bf16 v[244:247], a[68:71], a[60:63], v[244:247]
v_mfma_f32_16x16x32_bf16 v[104:107], a[72:75], a[56:59], v[104:107]
buffer_load_dwordx4 v20, s[20:23], s54 offen offset:2048 lds
v_mfma_f32_16x16x32_bf16 v[120:123], a[76:79], a[56:59], v[120:123]
ds_read_b64_tr_b16 a[24:25], v25 offset:32
s_add_u32 s54, s54, 196608
v_mfma_f32_16x16x32_bf16 v[116:119], a[76:79], a[52:55], v[116:119]
ds_read_b64_tr_b16 a[26:27], v25 offset:544
v_mfma_f32_16x16x32_bf16 v[100:103], a[72:75], a[52:55], v[100:103]
ds_read_b128 a[16:19], v24 offset:55488
s_add_u32 m0, s55, 36992
v_mfma_f32_16x16x32_bf16 v[96:99], a[72:75], a[48:51], v[96:99]
buffer_load_dwordx4 v21, s[36:39], s52 offen lds
v_mfma_f32_16x16x32_bf16 v[112:115], a[76:79], a[48:51], v[112:115]
ds_read_b64_tr_b16 a[28:29], v25 offset:1024
v_mfma_f32_16x16x32_bf16 v[108:111], a[76:79], a[44:47], v[108:111]
ds_read_b64_tr_b16 a[30:31], v25 offset:1536
v_mfma_f32_16x16x32_bf16 v[92:95], a[72:75], a[44:47], v[92:95]
ds_read_b64_tr_b16 a[32:33], v25 offset:1056
v_mfma_f32_16x16x32_bf16 v[124:127], a[44:47], a[80:83], v[124:127]
buffer_load_dwordx4 v28, s[36:39], s52 offen offset:1024 lds
v_mfma_f32_16x16x32_bf16 v[140:143], a[44:47], a[84:87], v[140:143]
v_mfma_f32_16x16x32_bf16 v[144:147], a[48:51], a[84:87], v[144:147]
ds_read_b64_tr_b16 a[34:35], v25 offset:1568
v_mfma_f32_16x16x32_bf16 v[128:131], a[48:51], a[80:83], v[128:131]
ds_read_b64_tr_b16 a[36:37], v25 offset:2048
v_mfma_f32_16x16x32_bf16 v[132:135], a[52:55], a[80:83], v[132:135]
buffer_load_dword v22, s[36:39], s52 offen offset:2048 lds
v_mfma_f32_16x16x32_bf16 v[148:151], a[52:55], a[84:87], v[148:151]
ds_read_b64_tr_b16 a[38:39], v25 offset:2560
s_add_u32 s52, s52, 128
v_mfma_f32_16x16x32_bf16 v[152:155], a[56:59], a[84:87], v[152:155]
ds_read_b64_tr_b16 a[40:41], v25 offset:2080
v_mfma_f32_16x16x32_bf16 v[136:139], a[56:59], a[80:83], v[136:139]
ds_read_b64_tr_b16 a[42:43], v25 offset:2592
v_mfma_f32_16x16x32_bf16 v[156:159], a[60:63], a[80:83], v[156:159]
v_mfma_f32_16x16x32_bf16 v[160:163], a[60:63], a[84:87], v[160:163]
s_waitcnt vmcnt(22) lgkmcnt(8)
s_barrier
v_mfma_f32_16x16x32_bf16 v[60:63], a[20:23], a[0:3], v[60:63]
ds_read_b128 a[44:47], v30 offset:55488
s_add_u32 m0, s56, 136064
v_mfma_f32_16x16x32_bf16 v[76:79], a[24:27], a[0:3], v[76:79]
buffer_load_dwordx4 v18, s[20:23], s54 offen lds
v_mfma_f32_16x16x32_bf16 v[80:83], a[24:27], a[4:7], v[80:83]
s_sub_u32 s47, s47, 1
s_cbranch_scc1 .Lx26
.Lx26b:
v_mfma_f32_16x16x32_bf16 v[64:67], a[20:23], a[4:7], v[64:67]
ds_read_b128 a[48:51], v30 offset:57792
v_mfma_f32_16x16x32_bf16 v[68:71], a[20:23], a[8:11], v[68:71]
ds_read_b128 a[52:55], v30 offset:60096
v_mfma_f32_16x16x32_bf16 v[84:87], a[24:27], a[8:11], v[84:87]
buffer_load_dwordx4 v19, s[20:23], s54 offen offset:1024 lds
v_mfma_f32_16x16x32_bf16 v[88:91], a[24:27], a[12:15], v[88:91]
ds_read_b128 a[56:59], v30 offset:62400
v_mfma_f32_16x16x32_bf16 v[72:75], a[20:23], a[12:15], v[72:75]
ds_read_b64_tr_b16 a[64:65], v25 offset:12416
s_waitcnt lgkmcnt(5)
v_mfma_f32_16x16x32_bf16 v[244:247], a[24:27], a[16:19], v[244:247]
ds_read_b64_tr_b16 a[66:67], v25 offset:12928
v_mfma_f32_16x16x32_bf16 v[104:107], a[28:31], a[12:15], v[104:107]
buffer_load_dwordx4 v20, s[20:23], s54 offen offset:2048 lds
v_mfma_f32_16x16x32_bf16 v[120:123], a[32:35], a[12:15], v[120:123]
ds_read_b64_tr_b16 a[68:69], v25 offset:12448
s_add_u32 s54, s54, 196608
v_mfma_f32_16x16x32_bf16 v[116:119], a[32:35], a[8:11], v[116:119]
ds_read_b64_tr_b16 a[70:71], v25 offset:12960
v_mfma_f32_16x16x32_bf16 v[100:103], a[28:31], a[8:11], v[100:103]
ds_read_b128 a[60:63], v31 offset:55488
s_add_u32 m0, s55, 39296
v_mfma_f32_16x16x32_bf16 v[96:99], a[28:31], a[4:7], v[96:99]
buffer_load_dwordx4 v21, s[36:39], s53 offen lds
v_mfma_f32_16x16x32_bf16 v[112:115], a[32:35], a[4:7], v[112:115]
v_mfma_f32_16x16x32_bf16 v[108:111], a[32:35], a[0:3], v[108:111]
ds_read_b64_tr_b16 a[72:73], v25 offset:13440
v_mfma_f32_16x16x32_bf16 v[92:95], a[28:31], a[0:3], v[92:95]
ds_read_b64_tr_b16 a[74:75], v25 offset:13952
v_mfma_f32_16x16x32_bf16 v[124:127], a[0:3], a[36:39], v[124:127]
buffer_load_dwordx4 v28, s[36:39], s53 offen offset:1024 lds
v_mfma_f32_16x16x32_bf16 v[140:143], a[0:3], a[40:43], v[140:143]
ds_read_b64_tr_b16 a[76:77], v25 offset:13472
v_mfma_f32_16x16x32_bf16 v[144:147], a[4:7], a[40:43], v[144:147]
ds_read_b64_tr_b16 a[78:79], v25 offset:13984
v_mfma_f32_16x16x32_bf16 v[128:131], a[4:7], a[36:39], v[128:131]
ds_read_b64_tr_b16 a[80:81], v25 offset:14464
v_mfma_f32_16x16x32_bf16 v[132:135], a[8:11], a[36:39], v[132:135]
buffer_load_dword v29, s[36:39], s53 offen offset:2048 lds
v_mfma_f32_16x16x32_bf16 v[148:151], a[8:11], a[40:43], v[148:151]
ds_read_b64_tr_b16 a[82:83], v25 offset:14976
s_add_u32 s53, s53, 128
v_mfma_f32_16x16x32_bf16 v[152:155], a[12:15], a[40:43], v[152:155]
ds_read_b64_tr_b16 a[84:85], v25 offset:14496
v_mfma_f32_16x16x32_bf16 v[136:139], a[12:15], a[36:39], v[136:139]
ds_read_b64_tr_b16 a[86:87], v25 offset:15008
v_mfma_f32_16x16x32_bf16 v[156:159], a[16:19], a[36:39], v[156:159]
v_mfma_f32_16x16x32_bf16 v[160:163], a[16:19], a[40:43], v[160:163]
s_waitcnt vmcnt(22) lgkmcnt(8)
s_barrier
v_mfma_f32_16x16x32_bf16 v[60:63], a[64:67], a[44:47], v[60:63]
ds_read_b128 a[0:3], v23
s_add_u32 m0, s56, 73984
v_mfma_f32_16x16x32_bf16 v[76:79], a[68:71], a[44:47], v[76:79]
buffer_load_dwordx4 v18, s[20:23], s54 offen lds
v_mfma_f32_16x16x32_bf16 v[80:83], a[68:71], a[48:51], v[80:83]
ds_read_b128 a[4:7], v23 offset:2304
v_mfma_f32_16x16x32_bf16 v[64:67], a[64:67], a[48:51], v[64:67]
ds_read_b128 a[8:11], v23 offset:4608
v_mfma_f32_16x16x32_bf16 v[68:71], a[64:67], a[52:55], v[68:71]
ds_read_b128 a[12:15], v23 offset:6912
v_mfma_f32_16x16x32_bf16 v[84:87], a[68:71], a[52:55], v[84:87]
buffer_load_dwordx4 v19, s[20:23], s54 offen offset:1024 lds
v_mfma_f32_16x16x32_bf16 v[88:91], a[68:71], a[56:59], v[88:91]
ds_read_b64_tr_b16 a[20:21], v25 offset:24832
v_mfma_f32_16x16x32_bf16 v[72:75], a[64:67], a[56:59], v[72:75]
ds_read_b64_tr_b16 a[22:23], v25 offset:25344
s_waitcnt lgkmcnt(6)
v_mfma_f32_16x16x32_bf16 v[244:247], a[68:71], a[60:63], v[244:247]
v_mfma_f32_16x16x32_bf16 v[104:107], a[72:75], a[56:59], v[104:107]
buffer_load_dwordx4 v20, s[20:23], s54 offen offset:2048 lds
v_mfma_f32_16x16x32_bf16 v[120:123], a[76:79], a[56:59], v[120:123]
ds_read_b64_tr_b16 a[24:25], v25 offset:24864
s_add_u32 s54, s54, 196608
v_mfma_f32_16x16x32_bf16 v[116:119], a[76:79], a[52:55], v[116:119]
ds_read_b64_tr_b16 a[26:27], v25 offset:25376
v_mfma_f32_16x16x32_bf16 v[100:103], a[72:75], a[52:55], v[100:103]
ds_read_b128 a[16:19], v24
s_add_u32 m0, s55, 55488
v_mfma_f32_16x16x32_bf16 v[96:99], a[72:75], a[48:51], v[96:99]
buffer_load_dwordx4 v21, s[36:39], s52 offen lds
v_mfma_f32_16x16x32_bf16 v[112:115], a[76:79], a[48:51], v[112:115]
ds_read_b64_tr_b16 a[28:29], v25 offset:25856
v_mfma_f32_16x16x32_bf16 v[108:111], a[76:79], a[44:47], v[108:111]
ds_read_b64_tr_b16 a[30:31], v25 offset:26368
v_mfma_f32_16x16x32_bf16 v[92:95], a[72:75], a[44:47], v[92:95]
ds_read_b64_tr_b16 a[32:33], v25 offset:25888
v_mfma_f32_16x16x32_bf16 v[124:127], a[44:47], a[80:83], v[124:127]
buffer_load_dwordx4 v28, s[36:39], s52 offen offset:1024 lds
v_mfma_f32_16x16x32_bf16 v[140:143], a[44:47], a[84:87], v[140:143]
v_mfma_f32_16x16x32_bf16 v[144:147], a[48:51], a[84:87], v[144:147]
ds_read_b64_tr_b16 a[34:35], v25 offset:26400
v_mfma_f32_16x16x32_bf16 v[128:131], a[48:51], a[80:83], v[128:131]
ds_read_b64_tr_b16 a[36:37], v25 offset:26880
v_mfma_f32_16x16x32_bf16 v[132:135], a[52:55], a[80:83], v[132:135]
buffer_load_dword v22, s[36:39], s52 offen offset:2048 lds
v_mfma_f32_16x16x32_bf16 v[148:151], a[52:55], a[84:87], v[148:151]
ds_read_b64_tr_b16 a[38:39], v25 offset:27392
s_add_u32 s52, s52, 128
v_mfma_f32_16x16x32_bf16 v[152:155], a[56:59], a[84:87], v[152:155]
ds_read_b64_tr_b16 a[40:41], v25 offset:26912
v_mfma_f32_16x16x32_bf16 v[136:139], a[56:59], a[80:83], v[136:139]
ds_read_b64_tr_b16 a[42:43], v25 offset:27424
v_mfma_f32_16x16x32_bf16 v[156:159], a[60:63], a[80:83], v[156:159]
v_mfma_f32_16x16x32_bf16 v[160:163], a[60:63], a[84:87], v[160:163]
s_waitcnt vmcnt(22) lgkmcnt(8)
s_barrier
v_mfma_f32_16x16x32_bf16 v[60:63], a[20:23], a[0:3], v[60:63]
ds_read_b128 a[44:47], v30
s_add_u32 m0, s56, 86400
v_mfma_f32_16x16x32_bf16 v[76:79], a[24:27], a[0:3], v[76:79]
buffer_load_dwordx4 v18, s[20:23], s54 offen lds
v_mfma_f32_16x16x32_bf16 v[80:83], a[24:27], a[4:7], v[80:83]
s_sub_u32 s47, s47, 1
s_cbranch_scc1 .Lx27
.Lx27b:
v_mfma_f32_16x16x32_bf16 v[64:67], a[20:23], a[4:7], v[64:67]
ds_read_b128 a[48:51], v30 offset:2304
v_mfma_f32_16x16x32_bf16 v[68:71], a[20:23], a[8:11], v[68:71]
ds_read_b128 a[52:55], v30 offset:4608
v_mfma_f32_16x16x32_bf16 v[84:87], a[24:27], a[8:11], v[84:87]
buffer_load_dwordx4 v19, s[20:23], s54 offen offset:1024 lds
v_mfma_f32_16x16x32_bf16 v[88:91], a[24:27], a[12:15], v[88:91]
ds_read_b128 a[56:59], v30 offset:6912
v_mfma_f32_16x16x32_bf16 v[72:75], a[20:23], a[12:15], v[72:75]
ds_read_b64_tr_b16 a[64:65], v25 offset:37248
s_waitcnt lgkmcnt(5)
v_mfma_f32_16x16x32_bf16 v[244:247], a[24:27], a[16:19], v[244:247]
ds_read_b64_tr_b16 a[66:67], v25 offset:37760
v_mfma_f32_16x16x32_bf16 v[104:107], a[28:31], a[12:15], v[104:107]
buffer_load_dwordx4 v20, s[20:23], s54 offen offset:2048 lds
v_mfma_f32_16x16x32_bf16 v[120:123], a[32:35], a[12:15], v[120:123]
ds_read_b64_tr_b16 a[68:69], v25 offset:37280
s_add_u32 s54, s54, 196608
v_mfma_f32_16x16x32_bf16 v[116:119], a[32:35], a[8:11], v[116:119]
ds_read_b64_tr_b16 a[70:71], v25 offset:37792
v_mfma_f32_16x16x32_bf16 v[100:103], a[28:31], a[8:11], v[100:103]
ds_read_b128 a[60:63], v31
s_add_u32 m0, s55, 57792
v_mfma_f32_16x16x32_bf16 v[96:99], a[28:31], a[4:7], v[96:99]
buffer_load_dwordx4 v21, s[36:39], s53 offen lds
v_mfma_f32_16x16x32_bf16 v[112:115], a[32:35], a[4:7], v[112:115]
v_mfma_f32_16x16x32_bf16 v[108:111], a[32:35], a[0:3], v[108:111]
ds_read_b64_tr_b16 a[72:73], v25 offset:38272
v_mfma_f32_16x16x32_bf16 v[92:95], a[28:31], a[0:3], v[92:95]
ds_read_b64_tr_b16 a[74:75], v25 offset:38784
v_mfma_f32_16x16x32_bf16 v[124:127], a[0:3], a[36:39], v[124:127]
buffer_load_dwordx4 v28, s[36:39], s53 offen offset:1024 lds
v_mfma_f32_16x16x32_bf16 v[140:143], a[0:3], a[40:43], v[140:143]
ds_read_b64_tr_b16 a[76:77], v25 offset:38304
v_mfma_f32_16x16x32_bf16 v[144:147], a[4:7], a[40:43], v[144:147]
ds_read_b64_tr_b16 a[78:79], v25 offset:38816
v_mfma_f32_16x16x32_bf16 v[128:131], a[4:7], a[36:39], v[128:131]
ds_read_b64_tr_b16 a[80:81], v25 offset:39296
v_mfma_f32_16x16x32_bf16 v[132:135], a[8:11], a[36:39], v[132:135]
buffer_load_dword v29, s[36:39], s53 offen offset:2048 lds
v_mfma_f32_16x16x32_bf16 v[148:151], a[8:11], a[40:43], v[148:151]
ds_read_b64_tr_b16 a[82:83], v25 offset:39808
s_add_u32 s53, s53, 128
v_mfma_f32_16x16x32_bf16 v[152:155], a[12:15], a[40:43], v[152:155]
ds_read_b64_tr_b16 a[84:85], v25 offset:39328
v_mfma_f32_16x16x32_bf16 v[136:139], a[12:15], a[36:39], v[136:139]
ds_read_b64_tr_b16 a[86:87], v25 offset:39840
v_mfma_f32_16x16x32_bf16 v[156:159], a[16:19], a[36:39], v[156:159]
v_mfma_f32_16x16x32_bf16 v[160:163], a[16:19], a[40:43], v[160:163]
s_waitcnt vmcnt(24)
v_cmp_ne_u32 vcc, v36, v37
s_nop 0
s_cbranch_vccnz .Lsp28
.Lsp28b:
s_waitcnt vmcnt(21) lgkmcnt(8)
s_barrier
v_mfma_f32_16x16x32_bf16 v[60:63], a[64:67], a[44:47], v[60:63]
ds_read_b128 a[0:3], v23 offset:18496
s_add_u32 m0, s56, 98816
v_mfma_f32_16x16x32_bf16 v[76:79], a[68:71], a[44:47], v[76:79]
buffer_load_dwordx4 v18, s[20:23], s54 offen lds
v_mfma_f32_16x16x32_bf16 v[80:83], a[68:71], a[48:51], v[80:83]
ds_read_b128 a[4:7], v23 offset:20800
v_mfma_f32_16x16x32_bf16 v[64:67], a[64:67], a[48:51], v[64:67]
ds_read_b128 a[8:11], v23 offset:23104
v_mfma_f32_16x16x32_bf16 v[68:71], a[64:67], a[52:55], v[68:71]
buffer_load_dwordx4 v19, s[20:23], s54 offen offset:1024 lds
v_mfma_f32_16x16x32_bf16 v[84:87], a[68:71], a[52:55], v[84:87]
ds_read_b128 a[12:15], v23 offset:25408
v_mfma_f32_16x16x32_bf16 v[88:91], a[68:71], a[56:59], v[88:91]
ds_read_b64_tr_b16 a[20:21], v25 offset:49664
v_mfma_f32_16x16x32_bf16 v[72:75], a[64:67], a[56:59], v[72:75]
ds_read_b64_tr_b16 a[22:23], v25 offset:50176
s_waitcnt lgkmcnt(6)
v_mfma_f32_16x16x32_bf16 v[244:247], a[68:71], a[60:63], v[244:247]
buffer_load_dwordx4 v20, s[20:23], s54 offen offset:2048 lds
v_mfma_f32_16x16x32_bf16 v[104:107], a[72:75], a[56:59], v[104:107]
ds_read_b64_tr_b16 a[24:25], v25 offset:49696
s_add_u32 s54, s54, 196608
v_mfma_f32_16x16x32_bf16 v[120:123], a[76:79], a[56:59], v[120:123]
ds_read_b64_tr_b16 a[26:27], v25 offset:50208
s_add_u32 m0, s55, 0
v_mfma_f32_16x16x32_bf16 v[116:119], a[76:79], a[52:55], v[116:119]
buffer_load_dwordx4 v21, s[36:39], s52 offen lds
v_mfma_f32_16x16x32_bf16 v[100:103], a[72:75], a[52:55], v[100:103]
ds_read_b128 a[16:19], v24 offset:18496
v_mfma_f32_16x16x32_bf16 v[96:99], a[72:75], a[48:51], v[96:99]
v_mfma_f32_16x16x32_bf16 v[112:115], a[76:79], a[48:51], v[112:115]
ds_read_b64_tr_b16 a[28:29], v25 offset:50688
v_mfma_f32_16x16x32_bf16 v[108:111], a[76:79], a[44:47], v[108:111]
buffer_load_dwordx4 v28, s[36:39], s52 offen offset:1024 lds
v_mfma_f32_16x16x32_bf16 v[92:95], a[72:75], a[44:47], v[92:95]
ds_read_b64_tr_b16 a[30:31], v25 offset:51200
v_mfma_f32_16x16x32_bf16 v[124:127], a[44:47], a[80:83], v[124:127]
ds_read_b64_tr_b16 a[32:33], v25 offset:50720
v_mfma_f32_16x16x32_bf16 v[140:143], a[44:47], a[84:87], v[140:143]
buffer_load_dword v22, s[36:39], s52 offen offset:2048 lds
v_mfma_f32_16x16x32_bf16 v[144:147], a[48:51], a[84:87], v[144:147]
ds_read_b64_tr_b16 a[34:35], v25 offset:51232
s_add_u32 s52, s52, 128
v_mfma_f32_16x16x32_bf16 v[128:131], a[48:51], a[80:83], v[128:131]
ds_read_b64_tr_b16 a[36:37], v25 offset:51712
v_mfma_f32_16x16x32_bf16 v[132:135], a[52:55], a[80:83], v[132:135]
ds_read_b64_tr_b16 a[38:39], v25 offset:52224
v_mfma_f32_16x16x32_bf16 v[148:151], a[52:55], a[84:87], v[148:151]
buffer_load_dwordx4 v[164:167], v26, s[16:19], s75 offen sc1
v_mfma_f32_16x16x32_bf16 v[152:155], a[56:59], a[84:87], v[152:155]
ds_read_b64_tr_b16 a[40:41], v25 offset:51744
v_mfma_f32_16x16x32_bf16 v[136:139], a[56:59], a[80:83], v[136:139]
ds_read_b64_tr_b16 a[42:43], v25 offset:52256
v_mfma_f32_16x16x32_bf16 v[156:159], a[60:63], a[80:83], v[156:159]
v_mfma_f32_16x16x32_bf16 v[160:163], a[60:63], a[84:87], v[160:163]
s_waitcnt vmcnt(22) lgkmcnt(8)
s_barrier
v_mfma_f32_16x16x32_bf16 v[60:63], a[20:23], a[0:3], v[60:63]
ds_read_b128 a[44:47], v30 offset:18496
s_add_u32 m0, s56, 111232
v_mfma_f32_16x16x32_bf16 v[76:79], a[24:27], a[0:3], v[76:79]
buffer_load_dwordx4 v18, s[20:23], s54 offen lds
v_mfma_f32_16x16x32_bf16 v[80:83], a[24:27], a[4:7], v[80:83]
s_sub_u32 s47, s47, 1
s_cbranch_scc1 .Lx29
.Lx29b:
v_mfma_f32_16x16x32_bf16 v[64:67], a[20:23], a[4:7], v[64:67]
ds_read_b128 a[48:51], v30 offset:20800
v_mfma_f32_16x16x32_bf16 v[68:71], a[20:23], a[8:11], v[68:71]
buffer_load_dwordx4 v19, s[20:23], s54 offen offset:1024 lds
v_mfma_f32_16x16x32_bf16 v[84:87], a[24:27], a[8:11], v[84:87]
ds_read_b128 a[52:55], v30 offset:23104
v_mfma_f32_16x16x32_bf16 v[88:91], a[24:27], a[12:15], v[88:91]
ds_read_b128 a[56:59], v30 offset:25408
v_mfma_f32_16x16x32_bf16 v[72:75], a[20:23], a[12:15], v[72:75]
ds_read_b64_tr_b16 a[64:65], v25 offset:62080
s_waitcnt lgkmcnt(5)
v_mfma_f32_16x16x32_bf16 v[244:247], a[24:27], a[16:19], v[244:247]
buffer_load_dwordx4 v20, s[20:23], s54 offen offset:2048 lds
v_mfma_f32_16x16x32_bf16 v[104:107], a[28:31], a[12:15], v[104:107]
ds_read_b64_tr_b16 a[66:67], v25 offset:62592
s_add_u32 s54, s54, 196608
v_mfma_f32_16x16x32_bf16 v[120:123], a[32:35], a[12:15], v[120:123]
ds_read_b64_tr_b16 a[68:69], v25 offset:62112
s_add_u32 m0, s55, 2304
v_mfma_f32_16x16x32_bf16 v[116:119], a[32:35], a[8:11], v[116:119]
buffer_load_dwordx4 v21, s[36:39], s53 offen lds
v_mfma_f32_16x16x32_bf16 v[100:103], a[28:31], a[8:11], v[100:103]
ds_read_b64_tr_b16 a[70:71], v25 offset:62624
v_mfma_f32_16x16x32_bf16 v[96:99], a[28:31], a[4:7], v[96:99]
ds_read_b128 a[60:63], v31 offset:18496
v_mfma_f32_16x16x32_bf16 v[112:115], a[32:35], a[4:7], v[112:115]
ds_read_b64_tr_b16 a[72:73], v25 offset:63104
v_mfma_f32_16x16x32_bf16 v[108:111], a[32:35], a[0:3], v[108:111]
buffer_load_dwordx4 v28, s[36:39], s53 offen offset:1024 lds
v_mfma_f32_16x16x32_bf16 v[92:95], a[28:31], a[0:3], v[92:95]
ds_read_b64_tr_b16 a[74:75], v25 offset:63616
v_mfma_f32_16x16x32_bf16 v[124:127], a[0:3], a[36:39], v[124:127]
ds_read_b64_tr_b16 a[76:77], v25 offset:63136
v_mfma_f32_16x16x32_bf16 v[140:143], a[0:3], a[40:43], v[140:143]
buffer_load_dword v29, s[36:39], s53 offen offset:2048 lds
v_mfma_f32_16x16x32_bf16 v[144:147], a[4:7], a[40:43], v[144:147]
ds_read_b64_tr_b16 a[78:79], v25 offset:63648
s_add_u32 s53, s53, 128
v_mfma_f32_16x16x32_bf16 v[128:131], a[4:7], a[36:39], v[128:131]
ds_read_b64_tr_b16 a[80:81], v25 offset:64128
v_mfma_f32_16x16x32_bf16 v[132:135], a[8:11], a[36:39], v[132:135]
ds_read_b64_tr_b16 a[82:83], v25 offset:64640
v_mfma_f32_16x16x32_bf16 v[148:151], a[8:11], a[40:43], v[148:151]
buffer_load_dwordx4 v[168:171], v26, s[16:19], s75 offen offset:1024 sc1
v_mfma_f32_16x16x32_bf16 v[152:155], a[12:15], a[40:43], v[152:155]
ds_read_b64_tr_b16 a[84:85], v25 offset:64160
v_mfma_f32_16x16x32_bf16 v[136:139], a[12:15], a[36:39], v[136:139]
ds_read_b64_tr_b16 a[86:87], v25 offset:64672
v_mfma_f32_16x16x32_bf16 v[156:159], a[16:19], a[36:39], v[156:159]
v_mfma_f32_16x16x32_bf16 v[160:163], a[16:19], a[40:43], v[160:163]
s_waitcnt vmcnt(23) lgkmcnt(8)
s_barrier
v_mfma_f32_16x16x32_bf16 v[60:63], a[64:67], a[44:47], v[60:63]
ds_read_b128 a[0:3], v23 offset:36992
s_add_u32 m0, s56, 123648
v_mfma_f32_16x16x32_bf16 v[76:79], a[68:71], a[44:47], v[76:79]
buffer_load_dwordx4 v18, s[20:23], s54 offen lds
v_mfma_f32_16x16x32_bf16 v[80:83], a[68:71], a[48:51], v[80:83]
ds_read_b128 a[4:7], v23 offset:39296
v_mfma_f32_16x16x32_bf16 v[64:67], a[64:67], a[48:51], v[64:67]
ds_read_b128 a[8:11], v23 offset:41600
v_mfma_f32_16x16x32_bf16 v[68:71], a[64:67], a[52:55], v[68:71]
buffer_load_dwordx4 v19, s[20:23], s54 offen offset:1024 lds
v_mfma_f32_16x16x32_bf16 v[84:87], a[68:71], a[52:55], v[84:87]
ds_read_b128 a[12:15], v23 offset:43904
v_mfma_f32_16x16x32_bf16 v[88:91], a[68:71], a[56:59], v[88:91]
ds_read_b64_tr_b16 a[20:21], v25
v_mfma_f32_16x16x32_bf16 v[72:75], a[64:67], a[56:59], v[72:75]
ds_read_b64_tr_b16 a[22:23], v25 offset:512
s_waitcnt lgkmcnt(6)
v_mfma_f32_16x16x32_bf16 v[244:247], a[68:71], a[60:63], v[244:247]
buffer_load_dwordx4 v20, s[20:23], s54 offen offset:2048 lds
v_mfma_f32_16x16x32_bf16 v[104:107], a[72:75], a[56:59], v[104:107]
ds_read_b64_tr_b16 a[24:25], v25 offset:32
s_add_u32 s54, s54, 196608
v_mfma_f32_16x16x32_bf16 v[120:123], a[76:79], a[56:59], v[120:123]
ds_read_b64_tr_b16 a[26:27], v25 offset:544
s_add_u32 m0, s55, 18496
v_mfma_f32_16x16x32_bf16 v[116:119], a[76:79], a[52:55], v[116:119]
buffer_load_dwordx4 v21, s[36:39], s52 offen lds
v_mfma_f32_16x16x32_bf16 v[100:103], a[72:75], a[52:55], v[100:103]
ds_read_b128 a[16:19], v24 offset:36992
v_mfma_f32_16x16x32_bf16 v[96:99], a[72:75], a[48:51], v[96:99]
v_mfma_f32_16x16x32_bf16 v[112:115], a[76:79], a[48:51], v[112:115]
ds_read_b64_tr_b16 a[28:29], v25 offset:1024
v_mfma_f32_16x16x32_bf16 v[108:111], a[76:79], a[44:47], v[108:111]
buffer_load_dwordx4 v28, s[36:39], s52 offen offset:1024 lds
v_mfma_f32_16x16x32_bf16 v[92:95], a[72:75], a[44:47], v[92:95]
ds_read_b64_tr_b16 a[30:31], v25 offset:1536
v_mfma_f32_16x16x32_bf16 v[124:127], a[44:47], a[80:83], v[124:127]
ds_read_b64_tr_b16 a[32:33], v25 offset:1056
v_mfma_f32_16x16x32_bf16 v[140:143], a[44:47], a[84:87], v[140:143]
buffer_load_dword v22, s[36:39], s52 offen offset:2048 lds
v_mfma_f32_16x16x32_bf16 v[144:147], a[48:51], a[84:87], v[144:147]
ds_read_b64_tr_b16 a[34:35], v25 offset:1568
s_add_u32 s52, s52, 128
v_mfma_f32_16x16x32_bf16 v[128:131], a[48:51], a[80:83], v[128:131]
ds_read_b64_tr_b16 a[36:37], v25 offset:2048
v_mfma_f32_16x16x32_bf16 v[132:135], a[52:55], a[80:83], v[132:135]
ds_read_b64_tr_b16 a[38:39], v25 offset:2560
v_mfma_f32_16x16x32_bf16 v[148:151], a[52:55], a[84:87], v[148:151]
buffer_load_dwordx4 v[172:175], v26, s[16:19], s75 offen offset:2048 sc1
v_mfma_f32_16x16x32_bf16 v[152:155], a[56:59], a[84:87], v[152:155]
ds_read_b64_tr_b16 a[40:41], v25 offset:2080
v_mfma_f32_16x16x32_bf16 v[136:139], a[56:59], a[80:83], v[136:139]
ds_read_b64_tr_b16 a[42:43], v25 offset:2592
v_mfma_f32_16x16x32_bf16 v[156:159], a[60:63], a[80:83], v[156:159]
v_mfma_f32_16x16x32_bf16 v[160:163], a[60:63], a[84:87], v[160:163]
s_waitcnt vmcnt(24) lgkmcnt(8)
s_barrier
v_mfma_f32_16x16x32_bf16 v[60:63], a[20:23], a[0:3], v[60:63]
ds_read_b128 a[44:47], v30 offset:36992
s_add_u32 m0, s56, 136064
v_mfma_f32_16x16x32_bf16 v[76:79], a[24:27], a[0:3], v[76:79]
buffer_load_dwordx4 v18, s[20:23], s54 offen lds
v_mfma_f32_16x16x32_bf16 v[80:83], a[24:27], a[4:7], v[80:83]
s_sub_u32 s47, s47, 1
s_cbranch_scc1 .Lx30
.Lx30b:
v_mfma_f32_16x16x32_bf16 v[64:67], a[20:23], a[4:7], v[64:67]
ds_read_b128 a[48:51], v30 offset:39296
v_mfma_f32_16x16x32_bf16 v[68:71], a[20:23], a[8:11], v[68:71]
buffer_load_dwordx4 v19, s[20:23], s54 offen offset:1024 lds
v_mfma_f32_16x16x32_bf16 v[84:87], a[24:27], a[8:11], v[84:87]
ds_read_b128 a[52:55], v30 offset:41600
v_mfma_f32_16x16x32_bf16 v[88:91], a[24:27], a[12:15], v[88:91]
ds_read_b128 a[56:59], v30 offset:43904
v_mfma_f32_16x16x32_bf16 v[72:75], a[20:23], a[12:15], v[72:75]
ds_read_b64_tr_b16 a[64:65], v25 offset:12416
s_waitcnt lgkmcnt(5)
v_mfma_f32_16x16x32_bf16 v[244:247], a[24:27], a[16:19], v[244:247]
buffer_load_dwordx4 v20, s[20:23], s54 offen offset:2048 lds
v_mfma_f32_16x16x32_bf16 v[104:107], a[28:31], a[12:15], v[104:107]
ds_read_b64_tr_b16 a[66:67], v25 offset:12928
s_add_u32 s54, s54, 196608
v_mfma_f32_16x16x32_bf16 v[120:123], a[32:35], a[12:15], v[120:123]
ds_read_b64_tr_b16 a[68:69], v25 offset:12448
s_add_u32 m0, s55, 20800
v_mfma_f32_16x16x32_bf16 v[116:119], a[32:35], a[8:11], v[116:119]
buffer_load_dwordx4 v21, s[36:39], s53 offen lds
v_mfma_f32_16x16x32_bf16 v[100:103], a[28:31], a[8:11], v[100:103]
ds_read_b64_tr_b16 a[70:71], v25 offset:12960
v_mfma_f32_16x16x32_bf16 v[96:99], a[28:31], a[4:7], v[96:99]
ds_read_b128 a[60:63], v31 offset:36992
v_mfma_f32_16x16x32_bf16 v[112:115], a[32:35], a[4:7], v[112:115]
ds_read_b64_tr_b16 a[72:73], v25 offset:13440
v_mfma_f32_16x16x32_bf16 v[108:111], a[32:35], a[0:3], v[108:111]
buffer_load_dwordx4 v28, s[36:39], s53 offen offset:1024 lds
v_mfma_f32_16x16x32_bf16 v[92:95], a[28:31], a[0:3], v[92:95]
ds_read_b64_tr_b16 a[74:75], v25 offset:13952
v_mfma_f32_16x16x32_bf16 v[124:127], a[0:3], a[36:39], v[124:127]
ds_read_b64_tr_b16 a[76:77], v25 offset:13472
v_mfma_f32_16x16x32_bf16 v[140:143], a[0:3], a[40:43], v[140:143]
buffer_load_dword v29, s[36:39], s53 offen offset:2048 lds
v_mfma_f32_16x16x32_bf16 v[144:147], a[4:7], a[40:43], v[144:147]
ds_read_b64_tr_b16 a[78:79], v25 offset:13984
s_add_u32 s53, s53, 128
v_mfma_f32_16x16x32_bf16 v[128:131], a[4:7], a[36:39], v[128:131]
ds_read_b64_tr_b16 a[80:81], v25 offset:14464
v_mfma_f32_16x16x32_bf16 v[132:135], a[8:11], a[36:39], v[132:135]
ds_read_b64_tr_b16 a[82:83], v25 offset:14976
v_mfma_f32_16x16x32_bf16 v[148:151], a[8:11], a[40:43], v[148:151]
buffer_load_dwordx4 v[176:179], v26, s[16:19], s75 offen offset:3072 sc1
v_mfma_f32_16x16x32_bf16 v[152:155], a[12:15], a[40:43], v[152:155]
ds_read_b64_tr_b16 a[84:85], v25 offset:14496
s_add_u32 s75, s75, 4096
v_mfma_f32_16x16x32_bf16 v[136:139], a[12:15], a[36:39], v[136:139]
ds_read_b64_tr_b16 a[86:87], v25 offset:15008
v_mfma_f32_16x16x32_bf16 v[156:159], a[16:19], a[36:39], v[156:159]
v_mfma_f32_16x16x32_bf16 v[160:163], a[16:19], a[40:43], v[160:163]
s_waitcnt vmcnt(25) lgkmcnt(8)
s_barrier
v_mfma_f32_16x16x32_bf16 v[60:63], a[64:67], a[44:47], v[60:63]
ds_read_b128 a[0:3], v23 offset:55488
s_add_u32 m0, s56, 73984
v_mfma_f32_16x16x32_bf16 v[76:79], a[68:71], a[44:47], v[76:79]
buffer_load_dwordx4 v18, s[20:23], s54 offen lds
v_mfma_f32_16x16x32_bf16 v[80:83], a[68:71], a[48:51], v[80:83]
ds_read_b128 a[4:7], v23 offset:57792
v_mfma_f32_16x16x32_bf16 v[64:67], a[64:67], a[48:51], v[64:67]
ds_read_b128 a[8:11], v23 offset:60096
v_mfma_f32_16x16x32_bf16 v[68:71], a[64:67], a[52:55], v[68:71]
buffer_load_dwordx4 v19, s[20:23], s54 offen offset:1024 lds
v_mfma_f32_16x16x32_bf16 v[84:87], a[68:71], a[52:55], v[84:87]
ds_read_b128 a[12:15], v23 offset:62400
v_mfma_f32_16x16x32_bf16 v[88:91], a[68:71], a[56:59], v[88:91]
ds_read_b64_tr_b16 a[20:21], v25 offset:24832
v_mfma_f32_16x16x32_bf16 v[72:75], a[64:67], a[56:59], v[72:75]
ds_read_b64_tr_b16 a[22:23], v25 offset:25344
s_waitcnt lgkmcnt(6)
v_mfma_f32_16x16x32_bf16 v[244:247], a[68:71], a[60:63], v[244:247]
buffer_load_dwordx4 v20, s[20:23], s54 offen offset:2048 lds
v_mfma_f32_16x16x32_bf16 v[104:107], a[72:75], a[56:59], v[104:107]
ds_read_b64_tr_b16 a[24:25], v25 offset:24864
s_add_u32 s54, s54, 196608
v_mfma_f32_16x16x32_bf16 v[120:123], a[76:79], a[56:59], v[120:123]
ds_read_b64_tr_b16 a[26:27], v25 offset:25376
s_add_u32 m0, s55, 36992
v_mfma_f32_16x16x32_bf16 v[116:119], a[76:79], a[52:55], v[116:119]
buffer_load_dwordx4 v21, s[36:39], s52 offen lds
v_mfma_f32_16x16x32_bf16 v[100:103], a[72:75], a[52:55], v[100:103]
ds_read_b128 a[16:19], v24 offset:55488
v_mfma_f32_16x16x32_bf16 v[96:99], a[72:75], a[48:51], v[96:99]
v_mfma_f32_16x16x32_bf16 v[112:115], a[76:79], a[48:51], v[112:115]
ds_read_b64_tr_b16 a[28:29], v25 offset:25856
v_mfma_f32_16x16x32_bf16 v[108:111], a[76:79], a[44:47], v[108:111]
buffer_load_dwordx4 v28, s[36:39], s52 offen offset:1024 lds
v_mfma_f32_16x16x32_bf16 v[92:95], a[72:75], a[44:47], v[92:95]
ds_read_b64_tr_b16 a[30:31], v25 offset:26368
v_mfma_f32_16x16x32_bf16 v[124:127], a[44:47], a[80:83], v[124:127]
ds_read_b64_tr_b16 a[32:33], v25 offset:25888
v_mfma_f32_16x16x32_bf16 v[140:143], a[44:47], a[84:87], v[140:143]
buffer_load_dword v22, s[36:39], s52 offen offset:2048 lds
v_mfma_f32_16x16x32_bf16 v[144:147], a[48:51], a[84:87], v[144:147]
ds_read_b64_tr_b16 a[34:35], v25 offset:26400
s_add_u32 s52, s52, 128
v_mfma_f32_16x16x32_bf16 v[128:131], a[48:51], a[80:83], v[128:131]
ds_read_b64_tr_b16 a[36:37], v25 offset:26880
v_mfma_f32_16x16x32_bf16 v[132:135], a[52:55], a[80:83], v[132:135]
ds_read_b64_tr_b16 a[38:39], v25 offset:27392
v_mfma_f32_16x16x32_bf16 v[148:151], a[52:55], a[84:87], v[148:151]
buffer_load_dwordx4 v[180:183], v26, s[16:19], s75 offen sc1
v_mfma_f32_16x16x32_bf16 v[152:155], a[56:59], a[84:87], v[152:155]
ds_read_b64_tr_b16 a[40:41], v25 offset:26912
v_mfma_f32_16x16x32_bf16 v[136:139], a[56:59], a[80:83], v[136:139]
ds_read_b64_tr_b16 a[42:43], v25 offset:27424
v_mfma_f32_16x16x32_bf16 v[156:159], a[60:63], a[80:83], v[156:159]
v_mfma_f32_16x16x32_bf16 v[160:163], a[60:63], a[84:87], v[160:163]
s_waitcnt vmcnt(25) lgkmcnt(8)
s_barrier
v_mfma_f32_16x16x32_bf16 v[60:63], a[20:23], a[0:3], v[60:63]
ds_read_b128 a[44:47], v30 offset:55488
s_add_u32 m0, s56, 86400
v_mfma_f32_16x16x32_bf16 v[76:79], a[24:27], a[0:3], v[76:79]
buffer_load_dwordx4 v18, s[20:23], s54 offen lds
v_mfma_f32_16x16x32_bf16 v[80:83], a[24:27], a[4:7], v[80:83]
s_sub_u32 s47, s47, 1
s_cbranch_scc1 .Lx31
.Lx31b:
v_mfma_f32_16x16x32_bf16 v[64:67], a[20:23], a[4:7], v[64:67]
ds_read_b128 a[48:51], v30 offset:57792
s_waitcnt vmcnt(22)
v_add_f32 v164, v164, v168
v_mfma_f32_16x16x32_bf16 v[68:71], a[20:23], a[8:11], v[68:71]
buffer_load_dwordx4 v19, s[20:23], s54 offen offset:1024 lds
v_mfma_f32_16x16x32_bf16 v[84:87], a[24:27], a[8:11], v[84:87]
ds_read_b128 a[52:55], v30 offset:60096
v_mfma_f32_16x16x32_bf16 v[88:91], a[24:27], a[12:15], v[88:91]
ds_read_b128 a[56:59], v30 offset:62400
v_mfma_f32_16x16x32_bf16 v[72:75], a[20:23], a[12:15], v[72:75]
ds_read_b64_tr_b16 a[64:65], v25 offset:37248
s_waitcnt lgkmcnt(5)
v_mfma_f32_16x16x32_bf16 v[244:247], a[24:27], a[16:19], v[244:247]
buffer_load_dwordx4 v20, s[20:23], s54 offen offset:2048 lds
v_mfma_f32_16x16x32_bf16 v[104:107], a[28:31], a[12:15], v[104:107]
ds_read_b64_tr_b16 a[66:67], v25 offset:37760
s_add_u32 s54, s54, 196608
v_mfma_f32_16x16x32_bf16 v[120:123], a[32:35], a[12:15], v[120:123]
ds_read_b64_tr_b16 a[68:69], v25 offset:37280
s_add_u32 m0, s55, 39296
v_mfma_f32_16x16x32_bf16 v[116:119], a[32:35], a[8:11], v[116:119]
buffer_load_dwordx4 v21, s[36:39], s53 offen lds
v_mfma_f32_16x16x32_bf16 v[100:103], a[28:31], a[8:11], v[100:103]
ds_read_b64_tr_b16 a[70:71], v25 offset:37792
v_add_f32 v165, v165, v169
v_mfma_f32_16x16x32_bf16 v[96:99], a[28:31], a[4:7], v[96:99]
ds_read_b128 a[60:63], v31 offset:55488
v_mfma_f32_16x16x32_bf16 v[112:115], a[32:35], a[4:7], v[112:115]
ds_read_b64_tr_b16 a[72:73], v25 offset:38272
v_mfma_f32_16x16x32_bf16 v[108:111], a[32:35], a[0:3], v[108:111]
buffer_load_dwordx4 v28, s[36:39], s53 offen offset:1024 lds
v_mfma_f32_16x16x32_bf16 v[92:95], a[28:31], a[0:3], v[92:95]
ds_read_b64_tr_b16 a[74:75], v25 offset:38784
v_mfma_f32_16x16x32_bf16 v[124:127], a[0:3], a[36:39], v[124:127]
ds_read_b64_tr_b16 a[76:77], v25 offset:38304
v_add_f32 v166, v166, v170
v_mfma_f32_16x16x32_bf16 v[140:143], a[0:3], a[40:43], v[140:143]
buffer_load_dword v29, s[36:39], s53 offen offset:2048 lds
v_mfma_f32_16x16x32_bf16 v[144:147], a[4:7], a[40:43], v[144:147]
ds_read_b64_tr_b16 a[78:79], v25 offset:38816
s_add_u32 s53, s53, 128
v_mfma_f32_16x16x32_bf16 v[128:131], a[4:7], a[36:39], v[128:131]
ds_read_b64_tr_b16 a[80:81], v25 offset:39296
v_mfma_f32_16x16x32_bf16 v[132:135], a[8:11], a[36:39], v[132:135]
ds_read_b64_tr_b16 a[82:83], v25 offset:39808
v_mfma_f32_16x16x32_bf16 v[148:151], a[8:11], a[40:43], v[148:151]
buffer_load_dwordx4 v[184:187], v26, s[16:19], s75 offen offset:1024 sc1
v_mfma_f32_16x16x32_bf16 v[152:155], a[12:15], a[40:43], v[152:155]
ds_read_b64_tr_b16 a[84:85], v25 offset:39328
v_add_f32 v167, v167, v171
v_mfma_f32_16x16x32_bf16 v[136:139], a[12:15], a[36:39], v[136:139]
ds_read_b64_tr_b16 a[86:87], v25 offset:39840
v_mfma_f32_16x16x32_bf16 v[156:159], a[16:19], a[36:39], v[156:159]
v_mfma_f32_16x16x32_bf16 v[160:163], a[16:19], a[40:43], v[160:163]
s_waitcnt vmcnt(25) lgkmcnt(8)
s_barrier
v_mfma_f32_16x16x32_bf16 v[60:63], a[64:67], a[44:47], v[60:63]
ds_read_b128 a[0:3], v23
s_add_u32 m0, s56, 98816
v_mfma_f32_16x16x32_bf16 v[76:79], a[68:71], a[44:47], v[76:79]
buffer_load_dwordx4 v18, s[20:23], s54 offen lds
v_mfma_f32_16x16x32_bf16 v[80:83], a[68:71], a[48:51], v[80:83]
ds_read_b128 a[4:7], v23 offset:2304
s_waitcnt vmcnt(22)
v_add_f32 v164, v164, v172
v_mfma_f32_16x16x32_bf16 v[64:67], a[64:67], a[48:51], v[64:67]
ds_read_b128 a[8:11], v23 offset:4608
v_mfma_f32_16x16x32_bf16 v[68:71], a[64:67], a[52:55], v[68:71]
buffer_load_dwordx4 v19, s[20:23], s54 offen offset:1024 lds
v_mfma_f32_16x16x32_bf16 v[84:87], a[68:71], a[52:55], v[84:87]
ds_read_b128 a[12:15], v23 offset:6912
v_mfma_f32_16x16x32_bf16 v[88:91], a[68:71], a[56:59], v[88:91]
ds_read_b64_tr_b16 a[20:21], v25 offset:49664
v_mfma_f32_16x16x32_bf16 v[72:75], a[64:67], a[56:59], v[72:75]
ds_read_b64_tr_b16 a[22:23], v25 offset:50176
s_waitcnt lgkmcnt(6)
v_mfma_f32_16x16x32_bf16 v[244:247], a[68:71], a[60:63], v[244:247]
buffer_load_dwordx4 v20, s[20:23], s54 offen offset:2048 lds
v_mfma_f32_16x16x32_bf16 v[104:107], a[72:75], a[56:59], v[104:107]
ds_read_b64_tr_b16 a[24:25], v25 offset:49696
s_add_u32 s54, s54, 196608
v_mfma_f32_16x16x32_bf16 v[120:123], a[76:79], a[56:59], v[120:123]
ds_read_b64_tr_b16 a[26:27], v25 offset:50208
s_add_u32 m0, s55, 55488
v_mfma_f32_16x16x32_bf16 v[116:119], a[76:79], a[52:55], v[116:119]
buffer_load_dwordx4 v21, s[36:39], s52 offen lds
v_mfma_f32_16x16x32_bf16 v[100:103], a[72:75], a[52:55], v[100:103]
ds_read_b128 a[16:19], v24
v_add_f32 v165, v165, v173
v_mfma_f32_16x16x32_bf16 v[96:99], a[72:75], a[48:51], v[96:99]
v_mfma_f32_16x16x32_bf16 v[112:115], a[76:79], a[48:51], v[112:115]
ds_read_b64_tr_b16 a[28:29], v25 offset:50688
v_mfma_f32_16x16x32_bf16 v[108:111], a[76:79], a[44:47], v[108:111]
buffer_load_dwordx4 v28, s[36:39], s52 offen offset:1024 lds
v_mfma_f32_16x16x32_bf16 v[92:95], a[72:75], a[44:47], v[92:95]
ds_read_b64_tr_b16 a[30:31], v25 offset:51200
v_add_f32 v166, v166, v174
v_mfma_f32_16x16x32_bf16 v[124:127], a[44:47], a[80:83], v[124:127]
ds_read_b64_tr_b16 a[32:33], v25 offset:50720
v_mfma_f32_16x16x32_bf16 v[140:143], a[44:47], a[84:87], v[140:143]
buffer_load_dword v22, s[36:39], s52 offen offset:2048 lds
v_mfma_f32_16x16x32_bf16 v[144:147], a[48:51], a[84:87], v[144:147]
ds_read_b64_tr_b16 a[34:35], v25 offset:51232
s_add_u32 s52, s52, 128
v_mfma_f32_16x16x32_bf16 v[128:131], a[48:51], a[80:83], v[128:131]
ds_read_b64_tr_b16 a[36:37], v25 offset:51712
v_mfma_f32_16x16x32_bf16 v[132:135], a[52:55], a[80:83], v[132:135]
ds_read_b64_tr_b16 a[38:39], v25 offset:52224
v_mfma_f32_16x16x32_bf16 v[148:151], a[52:55], a[84:87], v[148:151]
buffer_load_dwordx4 v[188:191], v26, s[16:19], s75 offen offset:2048 sc1
v_mfma_f32_16x16x32_bf16 v[152:155], a[56:59], a[84:87], v[152:155]
ds_read_b64_tr_b16 a[40:41], v25 offset:51744
v_add_f32 v167, v167, v175
v_mfma_f32_16x16x32_bf16 v[136:139], a[56:59], a[80:83], v[136:139]
ds_read_b64_tr_b16 a[42:43], v25 offset:52256
v_mfma_f32_16x16x32_bf16 v[156:159], a[60:63], a[80:83], v[156:159]
v_mfma_f32_16x16x32_bf16 v[160:163], a[60:63], a[84:87], v[160:163]
s_waitcnt vmcnt(25) lgkmcnt(8)
s_barrier
v_mfma_f32_16x16x32_bf16 v[60:63], a[20:23], a[0:3], v[60:63]
ds_read_b128 a[44:47], v30
s_add_u32 m0, s56, 111232
v_mfma_f32_16x16x32_bf16 v[76:79], a[24:27], a[0:3], v[76:79]
buffer_load_dwordx4 v18, s[20:23], s54 offen lds
v_mfma_f32_16x16x32_bf16 v[80:83], a[24:27], a[4:7], v[80:83]
ds_read_b128 a[48:51], v30 offset:2304
s_waitcnt vmcnt(22)
v_add_f32 v164, v164, v176
v_mfma_f32_16x16x32_bf16 v[64:67], a[20:23], a[4:7], v[64:67]
ds_read_b128 a[52:55], v30 offset:4608
v_mfma_f32_16x16x32_bf16 v[68:71], a[20:23], a[8:11], v[68:71]
buffer_load_dwordx4 v19, s[20:23], s54 offen offset:1024 lds
v_mfma_f32_16x16x32_bf16 v[84:87], a[24:27], a[8:11], v[84:87]
ds_read_b128 a[56:59], v30 offset:6912
v_mfma_f32_16x16x32_bf16 v[88:91], a[24:27], a[12:15], v[88:91]
ds_read_b64_tr_b16 a[64:65], v25 offset:62080
v_mfma_f32_16x16x32_bf16 v[72:75], a[20:23], a[12:15], v[72:75]
ds_read_b64_tr_b16 a[66:67], v25 offset:62592
s_waitcnt lgkmcnt(6)
v_mfma_f32_16x16x32_bf16 v[244:247], a[24:27], a[16:19], v[244:247]
buffer_load_dwordx4 v20, s[20:23], s54 offen offset:2048 lds
v_mfma_f32_16x16x32_bf16 v[104:107], a[28:31], a[12:15], v[104:107]
ds_read_b64_tr_b16 a[68:69], v25 offset:62112
s_add_u32 s54, s54, 196608
v_mfma_f32_16x16x32_bf16 v[120:123], a[32:35], a[12:15], v[120:123]
ds_read_b64_tr_b16 a[70:71], v25 offset:62624
s_add_u32 m0, s55, 57792
v_mfma_f32_16x16x32_bf16 v[116:119], a[32:35], a[8:11], v[116:119]
buffer_load_dwordx4 v21, s[36:39], s53 offen lds
v_mfma_f32_16x16x32_bf16 v[100:103], a[28:31], a[8:11], v[100:103]
ds_read_b128 a[60:63], v31
v_add_f32 v165, v165, v177
v_mfma_f32_16x16x32_bf16 v[96:99], a[28:31], a[4:7], v[96:99]
v_mfma_f32_16x16x32_bf16 v[112:115], a[32:35], a[4:7], v[112:115]
ds_read_b64_tr_b16 a[72:73], v25 offset:63104
v_mfma_f32_16x16x32_bf16 v[108:111], a[32:35], a[0:3], v[108:111]
buffer_load_dwordx4 v28, s[36:39], s53 offen offset:1024 lds
v_mfma_f32_16x16x32_bf16 v[92:95], a[28:31], a[0:3], v[92:95]
ds_read_b64_tr_b16 a[74:75], v25 offset:63616
v_add_f32 v166, v166, v178
v_mfma_f32_16x16x32_bf16 v[124:127], a[0:3], a[36:39], v[124:127]
ds_read_b64_tr_b16 a[76:77], v25 offset:63136
v_mfma_f32_16x16x32_bf16 v[140:143], a[0:3], a[40:43], v[140:143]
buffer_load_dword v29, s[36:39], s53 offen offset:2048 lds
v_mfma_f32_16x16x32_bf16 v[144:147], a[4:7], a[40:43], v[144:147]
ds_read_b64_tr_b16 a[78:79], v25 offset:63648
s_add_u32 s53, s53, 128
v_mfma_f32_16x16x32_bf16 v[128:131], a[4:7], a[36:39], v[128:131]
ds_read_b64_tr_b16 a[80:81], v25 offset:64128
v_mfma_f32_16x16x32_bf16 v[132:135], a[8:11], a[36:39], v[132:135]
ds_read_b64_tr_b16 a[82:83], v25 offset:64640
v_mfma_f32_16x16x32_bf16 v[148:151], a[8:11], a[40:43], v[148:151]
buffer_load_dwordx4 v[192:195], v26, s[16:19], s75 offen offset:3072 sc1
v_mfma_f32_16x16x32_bf16 v[152:155], a[12:15], a[40:43], v[152:155]
ds_read_b64_tr_b16 a[84:85], v25 offset:64160
v_add_f32 v167, v167, v179
v_mfma_f32_16x16x32_bf16 v[136:139], a[12:15], a[36:39], v[136:139]
ds_read_b64_tr_b16 a[86:87], v25 offset:64672
v_mfma_f32_16x16x32_bf16 v[156:159], a[16:19], a[36:39], v[156:159]
v_mfma_f32_16x16x32_bf16 v[160:163], a[16:19], a[40:43], v[160:163]
s_waitcnt vmcnt(25) lgkmcnt(8)
s_barrier
v_mfma_f32_16x16x32_bf16 v[60:63], a[64:67], a[44:47], v[60:63]
ds_read_b128 a[0:3], v23 offset:18496
s_add_u32 m0, s56, 123648
v_mfma_f32_16x16x32_bf16 v[76:79], a[68:71], a[44:47], v[76:79]
buffer_load_dwordx4 v18, s[20:23], s54 offen lds
v_mfma_f32_16x16x32_bf16 v[80:83], a[68:71], a[48:51], v[80:83]
ds_read_b128 a[4:7], v23 offset:20800
s_waitcnt vmcnt(22)
v_add_f32 v164, v164, v180
v_mfma_f32_16x16x32_bf16 v[64:67], a[64:67], a[48:51], v[64:67]
ds_read_b128 a[8:11], v23 offset:23104
v_mfma_f32_16x16x32_bf16 v[68:71], a[64:67], a[52:55], v[68:71]
v_mfma_f32_16x16x32_bf16 v[84:87], a[68:71], a[52:55], v[84:87]
ds_read_b128 a[12:15], v23 offset:25408
v_mfma_f32_16x16x32_bf16 v[88:91], a[68:71], a[56:59], v[88:91]
ds_read_b64_tr_b16 a[20:21], v25
v_mfma_f32_16x16x32_bf16 v[72:75], a[64:67], a[56:59], v[72:75]
ds_read_b64_tr_b16 a[22:23], v25 offset:512
s_waitcnt lgkmcnt(6)
v_mfma_f32_16x16x32_bf16 v[244:247], a[68:71], a[60:63], v[244:247]
v_add_f32 v165, v165, v181
v_mfma_f32_16x16x32_bf16 v[104:107], a[72:75], a[56:59], v[104:107]
buffer_load_dwordx4 v19, s[20:23], s54 offen offset:1024 lds
v_mfma_f32_16x16x32_bf16 v[120:123], a[76:79], a[56:59], v[120:123]
ds_read_b64_tr_b16 a[24:25], v25 offset:32
v_mfma_f32_16x16x32_bf16 v[116:119], a[76:79], a[52:55], v[116:119]
ds_read_b64_tr_b16 a[26:27], v25 offset:544
v_mfma_f32_16x16x32_bf16 v[100:103], a[72:75], a[52:55], v[100:103]
ds_read_b128 a[16:19], v24 offset:18496
v_mfma_f32_16x16x32_bf16 v[96:99], a[72:75], a[48:51], v[96:99]
v_mfma_f32_16x16x32_bf16 v[112:115], a[76:79], a[48:51], v[112:115]
ds_read_b64_tr_b16 a[28:29], v25 offset:1024
v_add_f32 v166, v166, v182
v_mfma_f32_16x16x32_bf16 v[108:111], a[76:79], a[44:47], v[108:111]
ds_read_b64_tr_b16 a[30:31], v25 offset:1536
v_mfma_f32_16x16x32_bf16 v[92:95], a[72:75], a[44:47], v[92:95]
ds_read_b64_tr_b16 a[32:33], v25 offset:1056
v_mfma_f32_16x16x32_bf16 v[124:127], a[44:47], a[80:83], v[124:127]
buffer_load_dwordx4 v20, s[20:23], s54 offen offset:2048 lds
v_mfma_f32_16x16x32_bf16 v[140:143], a[44:47], a[84:87], v[140:143]
s_add_u32 s54, s54, 196608
v_mfma_f32_16x16x32_bf16 v[144:147], a[48:51], a[84:87], v[144:147]
ds_read_b64_tr_b16 a[34:35], v25 offset:1568
v_mfma_f32_16x16x32_bf16 v[128:131], a[48:51], a[80:83], v[128:131]
ds_read_b64_tr_b16 a[36:37], v25 offset:2048
v_mfma_f32_16x16x32_bf16 v[132:135], a[52:55], a[80:83], v[132:135]
ds_read_b64_tr_b16 a[38:39], v25 offset:2560
v_add_f32 v167, v167, v183
v_mfma_f32_16x16x32_bf16 v[148:151], a[52:55], a[84:87], v[148:151]
v_mfma_f32_16x16x32_bf16 v[152:155], a[56:59], a[84:87], v[152:155]
ds_read_b64_tr_b16 a[40:41], v25 offset:2080
v_mfma_f32_16x16x32_bf16 v[136:139], a[56:59], a[80:83], v[136:139]
ds_read_b64_tr_b16 a[42:43], v25 offset:2592
v_mfma_f32_16x16x32_bf16 v[156:159], a[60:63], a[80:83], v[156:159]
v_mfma_f32_16x16x32_bf16 v[160:163], a[60:63], a[84:87], v[160:163]
s_waitcnt vmcnt(21) lgkmcnt(8)
s_barrier
v_mfma_f32_16x16x32_bf16 v[60:63], a[20:23], a[0:3], v[60:63]
ds_read_b128 a[44:47], v30 offset:18496
s_add_u32 m0, s56, 136064
v_mfma_f32_16x16x32_bf16 v[76:79], a[24:27], a[0:3], v[76:79]
buffer_load_dwordx4 v18, s[20:23], s54 offen lds
v_mfma_f32_16x16x32_bf16 v[80:83], a[24:27], a[4:7], v[80:83]
ds_read_b128 a[48:51], v30 offset:20800
s_waitcnt vmcnt(18)
v_add_f32 v164, v164, v184
v_mfma_f32_16x16x32_bf16 v[64:67], a[20:23], a[4:7], v[64:67]
ds_read_b128 a[52:55], v30 offset:23104
v_mfma_f32_16x16x32_bf16 v[68:71], a[20:23], a[8:11], v[68:71]
v_mfma_f32_16x16x32_bf16 v[84:87], a[24:27], a[8:11], v[84:87]
ds_read_b128 a[56:59], v30 offset:25408
v_mfma_f32_16x16x32_bf16 v[88:91], a[24:27], a[12:15], v[88:91]
ds_read_b64_tr_b16 a[64:65], v25 offset:12416
v_mfma_f32_16x16x32_bf16 v[72:75], a[20:23], a[12:15], v[72:75]
ds_read_b64_tr_b16 a[66:67], v25 offset:12928
s_waitcnt lgkmcnt(6)
v_mfma_f32_16x16x32_bf16 v[244:247], a[24:27], a[16:19], v[244:247]
v_add_f32 v165, v165, v185
v_mfma_f32_16x16x32_bf16 v[104:107], a[28:31], a[12:15], v[104:107]
buffer_load_dwordx4 v19, s[20:23], s54 offen offset:1024 lds
v_mfma_f32_16x16x32_bf16 v[120:123], a[32:35], a[12:15], v[120:123]
ds_read_b64_tr_b16 a[68:69], v25 offset:12448
v_mfma_f32_16x16x32_bf16 v[116:119], a[32:35], a[8:11], v[116:119]
ds_read_b64_tr_b16 a[70:71], v25 offset:12960
v_mfma_f32_16x16x32_bf16 v[100:103], a[28:31], a[8:11], v[100:103]
ds_read_b128 a[60:63], v31 offset:18496
v_mfma_f32_16x16x32_bf16 v[96:99], a[28:31], a[4:7], v[96:99]
v_mfma_f32_16x16x32_bf16 v[112:115], a[32:35], a[4:7], v[112:115]
ds_read_b64_tr_b16 a[72:73], v25 offset:13440
v_add_f32 v166, v166, v186
v_mfma_f32_16x16x32_bf16 v[108:111], a[32:35], a[0:3], v[108:111]
ds_read_b64_tr_b16 a[74:75], v25 offset:13952
v_mfma_f32_16x16x32_bf16 v[92:95], a[28:31], a[0:3], v[92:95]
ds_read_b64_tr_b16 a[76:77], v25 offset:13472
v_mfma_f32_16x16x32_bf16 v[124:127], a[0:3], a[36:39], v[124:127]
buffer_load_dwordx4 v20, s[20:23], s54 offen offset:2048 lds
v_mfma_f32_16x16x32_bf16 v[140:143], a[0:3], a[40:43], v[140:143]
s_add_u32 s54, s54, 196608
v_mfma_f32_16x16x32_bf16 v[144:147], a[4:7], a[40:43], v[144:147]
ds_read_b64_tr_b16 a[78:79], v25 offset:13984
v_mfma_f32_16x16x32_bf16 v[128:131], a[4:7], a[36:39], v[128:131]
ds_read_b64_tr_b16 a[80:81], v25 offset:14464
v_mfma_f32_16x16x32_bf16 v[132:135], a[8:11], a[36:39], v[132:135]
ds_read_b64_tr_b16 a[82:83], v25 offset:14976
v_add_f32 v167, v167, v187
v_mfma_f32_16x16x32_bf16 v[148:151], a[8:11], a[40:43], v[148:151]
v_mfma_f32_16x16x32_bf16 v[152:155], a[12:15], a[40:43], v[152:155]
ds_read_b64_tr_b16 a[84:85], v25 offset:14496
v_mfma_f32_16x16x32_bf16 v[136:139], a[12:15], a[36:39], v[136:139]
ds_read_b64_tr_b16 a[86:87], v25 offset:15008
v_mfma_f32_16x16x32_bf16 v[156:159], a[16:19], a[36:39], v[156:159]
v_mfma_f32_16x16x32_bf16 v[160:163], a[16:19], a[40:43], v[160:163]
s_waitcnt vmcnt(17) lgkmcnt(8)
s_barrier
v_mfma_f32_16x16x32_bf16 v[60:63], a[64:67], a[44:47], v[60:63]
s_add_u32 m0, s59, 0
s_mov_b32 s58, 1048576
s_waitcnt vmcnt(13)
v_add_f32 v164, v164, v188
v_mfma_f32_16x16x32_bf16 v[76:79], a[68:71], a[44:47], v[76:79]
buffer_load_dwordx4 v5, s[24:27], s58 offen lds
v_mfma_f32_16x16x32_bf16 v[80:83], a[68:71], a[48:51], v[80:83]
ds_read_b128 a[0:3], v23 offset:36992
v_mfma_f32_16x16x32_bf16 v[64:67], a[64:67], a[48:51], v[64:67]
ds_read_b128 a[4:7], v23 offset:39296
v_mfma_f32_16x16x32_bf16 v[68:71], a[64:67], a[52:55], v[68:71]
ds_read_b128 a[8:11], v23 offset:41600
v_mfma_f32_16x16x32_bf16 v[84:87], a[68:71], a[52:55], v[84:87]
buffer_load_dwordx4 v6, s[24:27], s58 offen offset:1024 lds
v_mfma_f32_16x16x32_bf16 v[88:91], a[68:71], a[56:59], v[88:91]
ds_read_b128 a[12:15], v23 offset:43904
v_add_f32 v165, v165, v189
v_mfma_f32_16x16x32_bf16 v[72:75], a[64:67], a[56:59], v[72:75]
ds_read_b64_tr_b16 a[20:21], v25 offset:24832
s_waitcnt lgkmcnt(5)
v_mfma_f32_16x16x32_bf16 v[244:247], a[68:71], a[60:63], v[244:247]
s_add_u32 m0, s59, 8320
s_mov_b32 s58, 1179648
v_mfma_f32_16x16x32_bf16 v[104:107], a[72:75], a[56:59], v[104:107]
buffer_load_dwordx4 v5, s[24:27], s58 offen lds
v_mfma_f32_16x16x32_bf16 v[120:123], a[76:79], a[56:59], v[120:123]
ds_read_b64_tr_b16 a[22:23], v25 offset:25344
v_mfma_f32_16x16x32_bf16 v[116:119], a[76:79], a[52:55], v[116:119]
ds_read_b64_tr_b16 a[24:25], v25 offset:24864
v_mfma_f32_16x16x32_bf16 v[100:103], a[72:75], a[52:55], v[100:103]
ds_read_b64_tr_b16 a[26:27], v25 offset:25376
v_mfma_f32_16x16x32_bf16 v[96:99], a[72:75], a[48:51], v[96:99]
buffer_load_dwordx4 v6, s[24:27], s58 offen offset:1024 lds
v_mfma_f32_16x16x32_bf16 v[112:115], a[76:79], a[48:51], v[112:115]
ds_read_b128 a[16:19], v24 offset:36992
v_add_f32 v166, v166, v190
v_mfma_f32_16x16x32_bf16 v[108:111], a[76:79], a[44:47], v[108:111]
ds_read_b64_tr_b16 a[28:29], v25 offset:25856
v_mfma_f32_16x16x32_bf16 v[92:95], a[72:75], a[44:47], v[92:95]
s_add_u32 m0, s59, 16640
s_mov_b32 s58, 1310720
v_mfma_f32_16x16x32_bf16 v[124:127], a[44:47], a[80:83], v[124:127]
buffer_load_dwordx4 v5, s[24:27], s58 offen lds
v_mfma_f32_16x16x32_bf16 v[140:143], a[44:47], a[84:87], v[140:143]
ds_read_b64_tr_b16 a[30:31], v25 offset:26368
v_mfma_f32_16x16x32_bf16 v[144:147], a[48:51], a[84:87], v[144:147]
ds_read_b64_tr_b16 a[32:33], v25 offset:25888
v_mfma_f32_16x16x32_bf16 v[128:131], a[48:51], a[80:83], v[128:131]
ds_read_b64_tr_b16 a[34:35], v25 offset:26400
v_add_f32 v167, v167, v191
v_mfma_f32_16x16x32_bf16 v[132:135], a[52:55], a[80:83], v[132:135]
buffer_load_dwordx4 v6, s[24:27], s58 offen offset:1024 lds
v_mfma_f32_16x16x32_bf16 v[148:151], a[52:55], a[84:87], v[148:151]
ds_read_b64_tr_b16 a[36:37], v25 offset:26880
v_mfma_f32_16x16x32_bf16 v[152:155], a[56:59], a[84:87], v[152:155]
ds_read_b64_tr_b16 a[38:39], v25 offset:27392
v_mfma_f32_16x16x32_bf16 v[136:139], a[56:59], a[80:83], v[136:139]
ds_read_b64_tr_b16 a[40:41], v25 offset:26912
v_mfma_f32_16x16x32_bf16 v[156:159], a[60:63], a[80:83], v[156:159]
ds_read_b64_tr_b16 a[42:43], v25 offset:27424
v_mfma_f32_16x16x32_bf16 v[160:163], a[60:63], a[84:87], v[160:163]
s_waitcnt vmcnt(16) lgkmcnt(8)
s_barrier
v_mfma_f32_16x16x32_bf16 v[60:63], a[20:23], a[0:3], v[60:63]
s_add_u32 m0, s59, 24960
s_mov_b32 s58, 1441792
s_waitcnt vmcnt(12)
v_add_f32 v164, v164, v192
v_mfma_f32_16x16x32_bf16 v[76:79], a[24:27], a[0:3], v[76:79]
buffer_load_dwordx4 v5, s[24:27], s58 offen lds
v_mfma_f32_16x16x32_bf16 v[80:83], a[24:27], a[4:7], v[80:83]
ds_read_b128 a[44:47], v30 offset:36992
v_mfma_f32_16x16x32_bf16 v[64:67], a[20:23], a[4:7], v[64:67]
ds_read_b128 a[48:51], v30 offset:39296
v_mfma_f32_16x16x32_bf16 v[68:71], a[20:23], a[8:11], v[68:71]
ds_read_b128 a[52:55], v30 offset:41600
v_mfma_f32_16x16x32_bf16 v[84:87], a[24:27], a[8:11], v[84:87]
buffer_load_dwordx4 v6, s[24:27], s58 offen offset:1024 lds
v_mfma_f32_16x16x32_bf16 v[88:91], a[24:27], a[12:15], v[88:91]
ds_read_b128 a[56:59], v30 offset:43904
v_add_f32 v165, v165, v193
v_mfma_f32_16x16x32_bf16 v[72:75], a[20:23], a[12:15], v[72:75]
ds_read_b64_tr_b16 a[64:65], v25 offset:37248
s_waitcnt lgkmcnt(5)
v_mfma_f32_16x16x32_bf16 v[244:247], a[24:27], a[16:19], v[244:247]
s_add_u32 m0, s59, 74880
s_mov_b32 s58, 131072
v_mfma_f32_16x16x32_bf16 v[104:107], a[28:31], a[12:15], v[104:107]
buffer_load_dwordx4 v5, s[24:27], s58 offen lds
v_mfma_f32_16x16x32_bf16 v[120:123], a[32:35], a[12:15], v[120:123]
ds_read_b64_tr_b16 a[66:67], v25 offset:37760
v_mfma_f32_16x16x32_bf16 v[116:119], a[32:35], a[8:11], v[116:119]
ds_read_b64_tr_b16 a[68:69], v25 offset:37280
v_mfma_f32_16x16x32_bf16 v[100:103], a[28:31], a[8:11], v[100:103]
ds_read_b64_tr_b16 a[70:71], v25 offset:37792
v_mfma_f32_16x16x32_bf16 v[96:99], a[28:31], a[4:7], v[96:99]
buffer_load_dwordx4 v6, s[24:27], s58 offen offset:1024 lds
v_mfma_f32_16x16x32_bf16 v[112:115], a[32:35], a[4:7], v[112:115]
ds_read_b128 a[60:63], v31 offset:36992
v_add_f32 v166, v166, v194
v_mfma_f32_16x16x32_bf16 v[108:111], a[32:35], a[0:3], v[108:111]
ds_read_b64_tr_b16 a[72:73], v25 offset:38272
v_mfma_f32_16x16x32_bf16 v[92:95], a[28:31], a[0:3], v[92:95]
s_add_u32 m0, s59, 83200
s_mov_b32 s58, 262144
v_mfma_f32_16x16x32_bf16 v[124:127], a[0:3], a[36:39], v[124:127]
buffer_load_dwordx4 v5, s[24:27], s58 offen lds
v_mfma_f32_16x16x32_bf16 v[140:143], a[0:3], a[40:43], v[140:143]
ds_read_b64_tr_b16 a[74:75], v25 offset:38784
v_mfma_f32_16x16x32_bf16 v[144:147], a[4:7], a[40:43], v[144:147]
ds_read_b64_tr_b16 a[76:77], v25 offset:38304
v_mfma_f32_16x16x32_bf16 v[128:131], a[4:7], a[36:39], v[128:131]
ds_read_b64_tr_b16 a[78:79], v25 offset:38816
v_add_f32 v167, v167, v195
v_mfma_f32_16x16x32_bf16 v[132:135], a[8:11], a[36:39], v[132:135]
buffer_load_dwordx4 v6, s[24:27], s58 offen offset:1024 lds
v_mfma_f32_16x16x32_bf16 v[148:151], a[8:11], a[40:43], v[148:151]
ds_read_b64_tr_b16 a[80:81], v25 offset:39296
v_mfma_f32_16x16x32_bf16 v[152:155], a[12:15], a[40:43], v[152:155]
ds_read_b64_tr_b16 a[82:83], v25 offset:39808
v_mfma_f32_16x16x32_bf16 v[136:139], a[12:15], a[36:39], v[136:139]
ds_read_b64_tr_b16 a[84:85], v25 offset:39328
v_mfma_f32_16x16x32_bf16 v[156:159], a[16:19], a[36:39], v[156:159]
ds_read_b64_tr_b16 a[86:87], v25 offset:39840
v_mfma_f32_16x16x32_bf16 v[160:163], a[16:19], a[40:43], v[160:163]
s_waitcnt vmcnt(15) lgkmcnt(8)
s_barrier
v_mfma_f32_16x16x32_bf16 v[60:63], a[64:67], a[44:47], v[60:63]
s_add_u32 m0, s59, 33280
s_mov_b32 s58, 1572864
v_permlane32_swap_b32 v164, v166
v_mfma_f32_16x16x32_bf16 v[76:79], a[68:71], a[44:47], v[76:79]
buffer_load_dwordx4 v5, s[24:27], s58 offen lds
v_mfma_f32_16x16x32_bf16 v[80:83], a[68:71], a[48:51], v[80:83]
ds_read_b128 a[0:3], v23 offset:55488
v_mfma_f32_16x16x32_bf16 v[64:67], a[64:67], a[48:51], v[64:67]
ds_read_b128 a[4:7], v23 offset:57792
v_permlane32_swap_b32 v165, v167
v_mfma_f32_16x16x32_bf16 v[68:71], a[64:67], a[52:55], v[68:71]
ds_read_b128 a[8:11], v23 offset:60096
v_mfma_f32_16x16x32_bf16 v[84:87], a[68:71], a[52:55], v[84:87]
buffer_load_dwordx4 v6, s[24:27], s58 offen offset:1024 lds
v_mfma_f32_16x16x32_bf16 v[88:91], a[68:71], a[56:59], v[88:91]
ds_read_b128 a[12:15], v23 offset:62400
v_add_f32 v164, v164, v166
v_mfma_f32_16x16x32_bf16 v[72:75], a[64:67], a[56:59], v[72:75]
ds_read_b64_tr_b16 a[20:21], v25 offset:49664
s_waitcnt lgkmcnt(5)
v_mfma_f32_16x16x32_bf16 v[244:247], a[68:71], a[60:63], v[244:247]
s_add_u32 m0, s59, 41600
s_mov_b32 s58, 1703936
v_mfma_f32_16x16x32_bf16 v[104:107], a[72:75], a[56:59], v[104:107]
buffer_load_dwordx4 v5, s[24:27], s58 offen lds
v_mfma_f32_16x16x32_bf16 v[120:123], a[76:79], a[56:59], v[120:123]
ds_read_b64_tr_b16 a[22:23], v25 offset:50176
v_add_f32 v165, v165, v167
v_mfma_f32_16x16x32_bf16 v[116:119], a[76:79], a[52:55], v[116:119]
ds_read_b64_tr_b16 a[24:25], v25 offset:49696
v_mfma_f32_16x16x32_bf16 v[100:103], a[72:75], a[52:55], v[100:103]
ds_read_b64_tr_b16 a[26:27], v25 offset:50208
v_mul_f32 v164, 0xba800000, v164
v_mfma_f32_16x16x32_bf16 v[96:99], a[72:75], a[48:51], v[96:99]
buffer_load_dwordx4 v6, s[24:27], s58 offen offset:1024 lds
v_mfma_f32_16x16x32_bf16 v[112:115], a[76:79], a[48:51], v[112:115]
ds_read_b128 a[16:19], v24 offset:55488
v_mfma_f32_16x16x32_bf16 v[108:111], a[76:79], a[44:47], v[108:111]
ds_read_b64_tr_b16 a[28:29], v25 offset:50688
v_mul_f32 v165, 0x3a800000, v165
v_mfma_f32_16x16x32_bf16 v[92:95], a[72:75], a[44:47], v[92:95]
s_add_u32 m0, s59, 91520
s_mov_b32 s58, 393216
v_mfma_f32_16x16x32_bf16 v[124:127], a[44:47], a[80:83], v[124:127]
buffer_load_dwordx4 v5, s[24:27], s58 offen lds
v_mfma_f32_16x16x32_bf16 v[140:143], a[44:47], a[84:87], v[140:143]
ds_read_b64_tr_b16 a[30:31], v25 offset:51200
v_fma_f32 v165, -v164, v164, v165
v_mfma_f32_16x16x32_bf16 v[144:147], a[48:51], a[84:87], v[144:147]
ds_read_b64_tr_b16 a[32:33], v25 offset:50720
v_mfma_f32_16x16x32_bf16 v[128:131], a[48:51], a[80:83], v[128:131]
ds_read_b64_tr_b16 a[34:35], v25 offset:51232
v_max_f32 v165, 0, v165
v_mfma_f32_16x16x32_bf16 v[132:135], a[52:55], a[80:83], v[132:135]
buffer_load_dwordx4 v6, s[24:27], s58 offen offset:1024 lds
v_mfma_f32_16x16x32_bf16 v[148:151], a[52:55], a[84:87], v[148:151]
ds_read_b64_tr_b16 a[36:37], v25 offset:51712
v_mfma_f32_16x16x32_bf16 v[152:155], a[56:59], a[84:87], v[152:155]
ds_read_b64_tr_b16 a[38:39], v25 offset:52224
v_add_f32 v165, 0x3727c5ac, v165
v_mfma_f32_16x16x32_bf16 v[136:139], a[56:59], a[80:83], v[136:139]
ds_read_b64_tr_b16 a[40:41], v25 offset:51744
v_mfma_f32_16x16x32_bf16 v[156:159], a[60:63], a[80:83], v[156:159]
ds_read_b64_tr_b16 a[42:43], v25 offset:52256
v_mfma_f32_16x16x32_bf16 v[160:163], a[60:63], a[84:87], v[160:163]
s_waitcnt vmcnt(18) lgkmcnt(8)
s_barrier
v_mfma_f32_16x16x32_bf16 v[60:63], a[20:23], a[0:3], v[60:63]
s_add_u32 m0, s59, 99840
s_mov_b32 s58, 524288
v_rsq_f32 v166, v165
v_mfma_f32_16x16x32_bf16 v[76:79], a[24:27], a[0:3], v[76:79]
buffer_load_dwordx4 v5, s[24:27], s58 offen lds
v_mfma_f32_16x16x32_bf16 v[80:83], a[24:27], a[4:7], v[80:83]
ds_read_b128 a[44:47], v30 offset:55488
v_mfma_f32_16x16x32_bf16 v[64:67], a[20:23], a[4:7], v[64:67]
ds_read_b128 a[48:51], v30 offset:57792
v_mfma_f32_16x16x32_bf16 v[68:71], a[20:23], a[8:11], v[68:71]
ds_read_b128 a[52:55], v30 offset:60096
v_mfma_f32_16x16x32_bf16 v[84:87], a[24:27], a[8:11], v[84:87]
ds_read_b128 a[56:59], v30 offset:62400
v_mov_b32 v165, v166
v_mfma_f32_16x16x32_bf16 v[88:91], a[24:27], a[12:15], v[88:91]
ds_read_b64_tr_b16 a[64:65], v25 offset:62080
v_mfma_f32_16x16x32_bf16 v[72:75], a[20:23], a[12:15], v[72:75]
ds_read_b64_tr_b16 a[66:67], v25 offset:62592
s_waitcnt lgkmcnt(6)
v_mfma_f32_16x16x32_bf16 v[244:247], a[24:27], a[16:19], v[244:247]
buffer_load_dwordx4 v6, s[24:27], s58 offen offset:1024 lds
v_mfma_f32_16x16x32_bf16 v[104:107], a[28:31], a[12:15], v[104:107]
v_mfma_f32_16x16x32_bf16 v[120:123], a[32:35], a[12:15], v[120:123]
ds_read_b64_tr_b16 a[68:69], v25 offset:62112
v_mul_f32 v166, 0x3e8293ee, v166
v_mfma_f32_16x16x32_bf16 v[116:119], a[32:35], a[8:11], v[116:119]
ds_read_b64_tr_b16 a[70:71], v25 offset:62624
v_mfma_f32_16x16x32_bf16 v[100:103], a[28:31], a[8:11], v[100:103]
s_add_u32 m0, s59, 108160
s_mov_b32 s58, 655360
v_mfma_f32_16x16x32_bf16 v[96:99], a[28:31], a[4:7], v[96:99]
buffer_load_dwordx4 v5, s[24:27], s58 offen lds
v_mfma_f32_16x16x32_bf16 v[112:115], a[32:35], a[4:7], v[112:115]
ds_read_b128 a[60:63], v31 offset:55488
v_mfma_f32_16x16x32_bf16 v[108:111], a[32:35], a[0:3], v[108:111]
ds_read_b64_tr_b16 a[72:73], v25 offset:63104
ds_write_b128 v7, v[164:167]
v_mfma_f32_16x16x32_bf16 v[92:95], a[28:31], a[0:3], v[92:95]
ds_read_b64_tr_b16 a[74:75], v25 offset:63616
v_mfma_f32_16x16x32_bf16 v[124:127], a[0:3], a[36:39], v[124:127]
ds_read_b64_tr_b16 a[76:77], v25 offset:63136
v_mfma_f32_16x16x32_bf16 v[140:143], a[0:3], a[40:43], v[140:143]
ds_write_b32 v17, v164
v_mfma_f32_16x16x32_bf16 v[144:147], a[4:7], a[40:43], v[144:147]
buffer_load_dwordx4 v6, s[24:27], s58 offen offset:1024 lds
v_mfma_f32_16x16x32_bf16 v[128:131], a[4:7], a[36:39], v[128:131]
ds_read_b64_tr_b16 a[78:79], v25 offset:63648
v_mfma_f32_16x16x32_bf16 v[132:135], a[8:11], a[36:39], v[132:135]
ds_read_b64_tr_b16 a[80:81], v25 offset:64128
v_mfma_f32_16x16x32_bf16 v[148:151], a[8:11], a[40:43], v[148:151]
ds_read_b64_tr_b16 a[82:83], v25 offset:64640
v_mfma_f32_16x16x32_bf16 v[152:155], a[12:15], a[40:43], v[152:155]
ds_read_b64_tr_b16 a[84:85], v25 offset:64160
ds_write_b32 v17, v165 offset:1024
v_mfma_f32_16x16x32_bf16 v[136:139], a[12:15], a[36:39], v[136:139]
ds_read_b64_tr_b16 a[86:87], v25 offset:64672
v_mfma_f32_16x16x32_bf16 v[156:159], a[16:19], a[36:39], v[156:159]
v_mfma_f32_16x16x32_bf16 v[160:163], a[16:19], a[40:43], v[160:163]
s_waitcnt lgkmcnt(0)
s_barrier
v_mfma_f32_16x16x32_bf16 v[244:247], a[68:71], a[60:63], v[244:247]
ds_read_b128 v[232:235], v10 offset:1792
v_mfma_f32_16x16x32_bf16 v[156:159], a[60:63], a[80:83], v[156:159]
ds_read_b128 v[228:231], v10 offset:1536
v_mfma_f32_16x16x32_bf16 v[160:163], a[60:63], a[84:87], v[160:163]
ds_read_b128 v[224:227], v10 offset:1280
v_mfma_f32_16x16x32_bf16 v[104:107], a[72:75], a[56:59], v[104:107]
ds_read_b128 v[220:223], v10 offset:1024
v_mfma_f32_16x16x32_bf16 v[120:123], a[76:79], a[56:59], v[120:123]
v_mfma_f32_16x16x32_bf16 v[136:139], a[56:59], a[80:83], v[136:139]
v_mfma_f32_16x16x32_bf16 v[152:155], a[56:59], a[84:87], v[152:155]
v_mfma_f32_16x16x32_bf16 v[100:103], a[72:75], a[52:55], v[100:103]
v_mfma_f32_16x16x32_bf16 v[116:119], a[76:79], a[52:55], v[116:119]
s_mov_b32 exec_lo, 0x10001
s_mov_b32 exec_hi, 0x10001
ds_write_b128 v13, v[244:247] offset:64
s_mov_b64 exec, 0xffff
ds_write_b32 v12, v156 offset:512
ds_write_b32 v12, v160 offset:576
s_mov_b64 exec, -1
v_mfma_f32_16x16x32_bf16 v[96:99], a[72:75], a[48:51], v[96:99]
v_mfma_f32_16x16x32_bf16 v[112:115], a[76:79], a[48:51], v[112:115]
v_mfma_f32_16x16x32_bf16 v[92:95], a[72:75], a[44:47], v[92:95]
v_mfma_f32_16x16x32_bf16 v[108:111], a[76:79], a[44:47], v[108:111]
v_mfma_f32_16x16x32_bf16 v[72:75], a[64:67], a[56:59], v[72:75]
v_mfma_f32_16x16x32_bf16 v[88:91], a[68:71], a[56:59], v[88:91]
s_waitcnt lgkmcnt(0)
s_barrier
v_mfma_f32_16x16x32_bf16 v[132:135], a[52:55], a[80:83], v[132:135]
ds_read_b128 v[28:31], v13
s_add_u32 m0, s59, 49920
v_mfma_f32_16x16x32_bf16 v[148:151], a[52:55], a[84:87], v[148:151]
ds_read_b128 v[32:35], v13 offset:64
s_mov_b32 s58, 1835008
v_mfma_f32_16x16x32_bf16 v[68:71], a[64:67], a[52:55], v[68:71]
ds_read_b128 v[36:39], v13 offset:256
v_mfma_f32_16x16x32_bf16 v[84:87], a[68:71], a[52:55], v[84:87]
ds_read_b128 v[40:43], v13 offset:320
v_mfma_f32_16x16x32_bf16 v[128:131], a[48:51], a[80:83], v[128:131]
ds_read_b32 v44, v12 offset:512
v_mfma_f32_16x16x32_bf16 v[144:147], a[48:51], a[84:87], v[144:147]
ds_read_b32 v45, v12 offset:576
v_mfma_f32_16x16x32_bf16 v[64:67], a[64:67], a[48:51], v[64:67]
ds_read_b128 v[240:243], v11 offset:704
v_mfma_f32_16x16x32_bf16 v[80:83], a[68:71], a[48:51], v[80:83]
ds_read_b128 v[244:247], v11 offset:1728
v_mfma_f32_16x16x32_bf16 v[124:127], a[44:47], a[80:83], v[124:127]
buffer_load_dwordx4 v5, s[24:27], s58 offen lds
ds_read_b128 v[18:21], v11 offset:448
s_waitcnt lgkmcnt(8)
v_pk_fma_f32 v[72:73], v[28:29], v[232:233], v[72:73] op_sel_hi:[1,0,1]
v_pk_fma_f32 v[74:75], v[30:31], v[232:233], v[74:75] op_sel_hi:[1,0,1]
s_waitcnt lgkmcnt(6)
v_pk_fma_f32 v[104:105], v[36:37], v[232:233], v[104:105] op_sel_hi:[1,0,1]
v_pk_mul_f32 v[104:105], v[104:105], v[232:233] op_sel:[0,1] op_sel_hi:[1,1]
v_pk_fma_f32 v[106:107], v[38:39], v[232:233], v[106:107] op_sel_hi:[1,0,1]
v_pk_mul_f32 v[106:107], v[106:107], v[232:233] op_sel:[0,1] op_sel_hi:[1,1]
s_waitcnt lgkmcnt(5)
v_pk_fma_f32 v[120:121], v[40:41], v[232:233], v[120:121] op_sel_hi:[1,0,1]
v_pk_mul_f32 v[120:121], v[120:121], v[232:233] op_sel:[0,1] op_sel_hi:[1,1]
v_pk_fma_f32 v[122:123], v[42:43], v[232:233], v[122:123] op_sel_hi:[1,0,1]
v_pk_mul_f32 v[122:123], v[122:123], v[232:233] op_sel:[0,1] op_sel_hi:[1,1]
v_pk_fma_f32 v[100:101], v[36:37], v[228:229], v[100:101] op_sel_hi:[1,0,1]
v_pk_mul_f32 v[100:101], v[100:101], v[228:229] op_sel:[0,1] op_sel_hi:[1,1]
v_pk_fma_f32 v[102:103], v[38:39], v[228:229], v[102:103] op_sel_hi:[1,0,1]
v_pk_mul_f32 v[102:103], v[102:103], v[228:229] op_sel:[0,1] op_sel_hi:[1,1]
v_pk_fma_f32 v[116:117], v[40:41], v[228:229], v[116:117] op_sel_hi:[1,0,1]
v_pk_mul_f32 v[116:117], v[116:117], v[228:229] op_sel:[0,1] op_sel_hi:[1,1]
v_pk_fma_f32 v[118:119], v[42:43], v[228:229], v[118:119] op_sel_hi:[1,0,1]
v_pk_mul_f32 v[118:119], v[118:119], v[228:229] op_sel:[0,1] op_sel_hi:[1,1]
s_waitcnt lgkmcnt(2)
v_pk_fma_f32 v[156:157], v[240:241], v[44:45], v[156:157] op_sel_hi:[1,0,1]
v_pk_fma_f32 v[158:159], v[242:243], v[44:45], v[158:159] op_sel_hi:[1,0,1]
v_pk_fma_f32 v[160:161], v[240:241], v[44:45], v[160:161] op_sel:[0,1,0] op_sel_hi:[1,1,1]
v_pk_fma_f32 v[162:163], v[242:243], v[44:45], v[162:163] op_sel:[0,1,0] op_sel_hi:[1,1,1]
s_waitcnt lgkmcnt(1)
v_pk_mul_f32 v[156:157], v[156:157], v[244:245]
v_pk_mul_f32 v[158:159], v[158:159], v[246:247]
v_pk_mul_f32 v[160:161], v[160:161], v[244:245]
v_pk_mul_f32 v[162:163], v[162:163], v[246:247]
v_pk_fma_f32 v[88:89], v[32:33], v[232:233], v[88:89] op_sel_hi:[1,0,1]
v_pk_fma_f32 v[90:91], v[34:35], v[232:233], v[90:91] op_sel_hi:[1,0,1]
v_pk_fma_f32 v[96:97], v[36:37], v[224:225], v[96:97] op_sel_hi:[1,0,1]
s_waitcnt lgkmcnt(0)
v_pk_fma_f32 v[136:137], v[18:19], v[44:45], v[136:137] op_sel_hi:[1,0,1]
v_pk_fma_f32 v[138:139], v[20:21], v[44:45], v[138:139] op_sel_hi:[1,0,1]
v_pk_fma_f32 v[152:153], v[18:19], v[44:45], v[152:153] op_sel:[0,1,0] op_sel_hi:[1,1,1]
v_pk_fma_f32 v[154:155], v[20:21], v[44:45], v[154:155] op_sel:[0,1,0] op_sel_hi:[1,1,1]
v_pk_mul_f32 v[96:97], v[96:97], v[224:225] op_sel:[0,1] op_sel_hi:[1,1]
v_pk_fma_f32 v[98:99], v[38:39], v[224:225], v[98:99] op_sel_hi:[1,0,1]
v_pk_mul_f32 v[98:99], v[98:99], v[224:225] op_sel:[0,1] op_sel_hi:[1,1]
v_pk_fma_f32 v[112:113], v[40:41], v[224:225], v[112:113] op_sel_hi:[1,0,1]
v_pk_mul_f32 v[112:113], v[112:113], v[224:225] op_sel:[0,1] op_sel_hi:[1,1]
v_pk_fma_f32 v[114:115], v[42:43], v[224:225], v[114:115] op_sel_hi:[1,0,1]
v_pk_mul_f32 v[114:115], v[114:115], v[224:225] op_sel:[0,1] op_sel_hi:[1,1]
v_pk_fma_f32 v[68:69], v[28:29], v[228:229], v[68:69] op_sel_hi:[1,0,1]
v_pk_fma_f32 v[70:71], v[30:31], v[228:229], v[70:71] op_sel_hi:[1,0,1]
v_pk_fma_f32 v[84:85], v[32:33], v[228:229], v[84:85] op_sel_hi:[1,0,1]
v_pk_fma_f32 v[86:87], v[34:35], v[228:229], v[86:87] op_sel_hi:[1,0,1]
v_pk_fma_f32 v[92:93], v[36:37], v[220:221], v[92:93] op_sel_hi:[1,0,1]
v_pk_mul_f32 v[92:93], v[92:93], v[220:221] op_sel:[0,1] op_sel_hi:[1,1]
v_pk_fma_f32 v[94:95], v[38:39], v[220:221], v[94:95] op_sel_hi:[1,0,1]
v_pk_mul_f32 v[94:95], v[94:95], v[220:221] op_sel:[0,1] op_sel_hi:[1,1]
v_pk_fma_f32 v[108:109], v[40:41], v[220:221], v[108:109] op_sel_hi:[1,0,1]
v_pk_mul_f32 v[108:109], v[108:109], v[220:221] op_sel:[0,1] op_sel_hi:[1,1]
v_pk_fma_f32 v[110:111], v[42:43], v[220:221], v[110:111] op_sel_hi:[1,0,1]
v_pk_mul_f32 v[110:111], v[110:111], v[220:221] op_sel:[0,1] op_sel_hi:[1,1]
v_pk_fma_f32 v[64:65], v[28:29], v[224:225], v[64:65] op_sel_hi:[1,0,1]
v_pk_fma_f32 v[66:67], v[30:31], v[224:225], v[66:67] op_sel_hi:[1,0,1]
v_pk_fma_f32 v[80:81], v[32:33], v[224:225], v[80:81] op_sel_hi:[1,0,1]
v_pk_fma_f32 v[82:83], v[34:35], v[224:225], v[82:83] op_sel_hi:[1,0,1]
v_cvt_pk_bf16_f32 v236, v156, v157
v_cvt_pk_bf16_f32 v237, v158, v159
v_mfma_f32_16x16x32_bf16 v[140:143], a[44:47], a[84:87], v[140:143]
buffer_load_dwordx4 v6, s[24:27], s58 offen offset:1024 lds
v_mfma_f32_16x16x32_bf16 v[60:63], a[64:67], a[44:47], v[60:63]
s_add_u32 m0, s59, 58240
v_cvt_pk_bf16_f32 v238, v160, v161
v_cvt_pk_bf16_f32 v239, v162, v163
v_mfma_f32_16x16x32_bf16 v[76:79], a[68:71], a[44:47], v[76:79]
ds_write_b128 v8, v[236:239] offset:1024
s_mov_b32 s58, 1966080
v_cvt_pk_bf16_f32 v196, v104, v105
v_cvt_pk_bf16_f32 v197, v106, v107
v_cvt_pk_bf16_f32 v198, v120, v121
v_cvt_pk_bf16_f32 v199, v122, v123
ds_read_b128 v[22:25], v11 offset:1472
buffer_load_dwordx4 v5, s[24:27], s58 offen lds
v_cvt_pk_bf16_f32 v192, v100, v101
v_cvt_pk_bf16_f32 v193, v102, v103
v_cvt_pk_bf16_f32 v194, v116, v117
v_cvt_pk_bf16_f32 v195, v118, v119
v_cvt_pk_bf16_f32 v176, v72, v73
v_cvt_pk_bf16_f32 v177, v74, v75
v_cvt_pk_bf16_f32 v178, v88, v89
v_cvt_pk_bf16_f32 v179, v90, v91
v_pk_fma_f32 v[60:61], v[28:29], v[220:221], v[60:61] op_sel_hi:[1,0,1]
v_pk_fma_f32 v[62:63], v[30:31], v[220:221], v[62:63] op_sel_hi:[1,0,1]
v_pk_fma_f32 v[76:77], v[32:33], v[220:221], v[76:77] op_sel_hi:[1,0,1]
v_pk_fma_f32 v[78:79], v[34:35], v[220:221], v[78:79] op_sel_hi:[1,0,1]
ds_read_b128 v[240:243], v11 offset:384
s_nop 0
v_mfma_f32_16x16x32_bf16 v[104:107], v[192:195], v[176:179], v[46:49]
buffer_load_dwordx4 v6, s[24:27], s58 offen offset:1024 lds
v_mfma_f32_16x16x32_bf16 v[120:123], v[196:199], v[176:179], v[50:53]
s_add_u32 m0, s59, 66560
s_waitcnt lgkmcnt(2)
s_barrier
ds_read_b128 v[180:183], v9
ds_read_b64 v[200:201], v9 offset:1024
ds_read_b64 v[210:211], v9 offset:1032
s_mov_b32 s58, 0
s_waitcnt lgkmcnt(4)
v_pk_mul_f32 v[136:137], v[136:137], v[22:23]
v_cvt_pk_bf16_f32 v208, v136, v137
v_pk_mul_f32 v[138:139], v[138:139], v[24:25]
buffer_load_dwordx4 v5, s[24:27], s58 offen lds
v_cvt_pk_bf16_f32 v209, v138, v139
v_pk_mul_f32 v[152:153], v[152:153], v[22:23]
v_cvt_pk_bf16_f32 v218, v152, v153
v_pk_mul_f32 v[154:155], v[154:155], v[24:25]
v_cvt_pk_bf16_f32 v219, v154, v155
ds_read_b128 v[244:247], v11 offset:1408
v_max3_f32 v88, v104, v105, v106
v_max3_f32 v89, v107, v120, v121
v_max3_f32 v88, v88, v122, v123
s_waitcnt lgkmcnt(4)
v_pk_fma_f32 v[132:133], v[240:241], v[44:45], v[132:133] op_sel_hi:[1,0,1]
v_pk_fma_f32 v[134:135], v[242:243], v[44:45], v[134:135] op_sel_hi:[1,0,1]
v_pk_fma_f32 v[148:149], v[240:241], v[44:45], v[148:149] op_sel:[0,1,0] op_sel_hi:[1,1,1]
buffer_load_dwordx4 v6, s[24:27], s58 offen offset:1024 lds
s_add_u32 m0, s59, 116480
s_mov_b32 s58, 786432
v_pk_fma_f32 v[150:151], v[242:243], v[44:45], v[150:151] op_sel:[0,1,0] op_sel_hi:[1,1,1]
v_max_f32 v90, v88, v89
v_max_f32 v89, v88, v89
v_cvt_pk_bf16_f32 v188, v96, v97
v_cvt_pk_bf16_f32 v189, v98, v99
v_permlane16_swap_b32 v90, v89
v_cvt_pk_bf16_f32 v190, v112, v113
v_max_f32 v88, v90, v89
v_max_f32 v89, v90, v89
v_cvt_pk_bf16_f32 v191, v114, v115
buffer_load_dwordx4 v5, s[24:27], s58 offen lds
v_permlane32_swap_b32 v88, v89
v_cvt_pk_bf16_f32 v172, v68, v69
v_max_f32 v88, v88, v89
v_mul_f32 v88, v88, v234
s_waitcnt lgkmcnt(0)
v_pk_mul_f32 v[132:133], v[132:133], v[244:245]
v_cvt_pk_bf16_f32 v206, v132, v133
v_pk_mul_f32 v[134:135], v[134:135], v[246:247]
v_cvt_pk_bf16_f32 v207, v134, v135
v_pk_mul_f32 v[148:149], v[148:149], v[244:245]
v_cvt_pk_bf16_f32 v216, v148, v149
v_pk_mul_f32 v[150:151], v[150:151], v[246:247]
v_cvt_pk_bf16_f32 v217, v150, v151
buffer_load_dwordx4 v6, s[24:27], s58 offen offset:1024 lds
s_add_u32 m0, s59, 124800
s_mov_b32 s58, 917504
v_pk_fma_f32 v[104:105], v[104:105], v[234:235], v[88:89] op_sel_hi:[1,0,0] neg_lo:[0,0,1] neg_hi:[0,0,1]
v_pk_fma_f32 v[106:107], v[106:107], v[234:235], v[88:89] op_sel_hi:[1,0,0] neg_lo:[0,0,1] neg_hi:[0,0,1]
v_pk_fma_f32 v[120:121], v[120:121], v[234:235], v[88:89] op_sel_hi:[1,0,0] neg_lo:[0,0,1] neg_hi:[0,0,1]
v_pk_fma_f32 v[122:123], v[122:123], v[234:235], v[88:89] op_sel_hi:[1,0,0] neg_lo:[0,0,1] neg_hi:[0,0,1]
v_exp_f32 v104, v104
v_exp_f32 v105, v105
v_exp_f32 v106, v106
v_exp_f32 v107, v107
v_exp_f32 v120, v120
v_exp_f32 v121, v121
v_exp_f32 v122, v122
v_exp_f32 v123, v123
v_cvt_pk_bf16_f32 v72, v104, v105
buffer_load_dwordx4 v5, s[24:27], s58 offen lds
v_cvt_pk_bf16_f32 v73, v106, v107
v_cvt_pk_bf16_f32 v74, v120, v121
v_cvt_pk_bf16_f32 v75, v122, v123
v_cvt_pk_bf16_f32 v173, v70, v71
v_cvt_pk_bf16_f32 v174, v84, v85
v_mfma_f32_16x16x32_bf16 v[88:91], v[248:251], v[72:75], 0
ds_read_b128 v[18:21], v11 offset:320
v_cvt_pk_bf16_f32 v175, v86, v87
v_mfma_f32_16x16x32_bf16 v[104:107], v[206:209], v[72:75], 0
ds_read_b128 v[22:25], v11 offset:1344
v_cvt_pk_bf16_f32 v184, v92, v93
v_mfma_f32_16x16x32_bf16 v[120:123], v[216:219], v[72:75], 0
buffer_load_dwordx4 v6, s[24:27], s58 offen offset:1024 lds
v_mfma_f32_16x16x32_bf16 v[100:103], v[188:191], v[172:175], v[46:49]
ds_read_b128 v[240:243], v11 offset:256
v_rcp_f32 v88, v88
v_mfma_f32_16x16x32_bf16 v[116:119], v[192:195], v[172:175], v[50:53]
ds_read_b128 v[244:247], v11 offset:1280
v_cvt_pk_bf16_f32 v185, v94, v95
s_nop 2
v_max3_f32 v84, v100, v101, v102
v_cvt_pk_bf16_f32 v186, v108, v109
v_cvt_pk_bf16_f32 v187, v110, v111
v_pk_mul_f32 v[104:105], v[104:105], v[88:89] op_sel_hi:[1,0]
v_pk_mul_f32 v[106:107], v[106:107], v[88:89] op_sel_hi:[1,0]
v_pk_mul_f32 v[120:121], v[120:121], v[88:89] op_sel_hi:[1,0]
v_pk_mul_f32 v[122:123], v[122:123], v[88:89] op_sel_hi:[1,0]
v_cvt_pk_bf16_f32 v176, v104, v105
v_cvt_pk_bf16_f32 v177, v106, v107
v_cvt_pk_bf16_f32 v178, v120, v121
v_cvt_pk_bf16_f32 v179, v122, v123
buffer_store_dwordx4 v[176:179], v4, s[16:19], s74 offen offset:3072 sc1
s_waitcnt lgkmcnt(3)
v_pk_fma_f32 v[128:129], v[18:19], v[44:45], v[128:129] op_sel_hi:[1,0,1]
v_pk_fma_f32 v[130:131], v[20:21], v[44:45], v[130:131] op_sel_hi:[1,0,1]
s_waitcnt lgkmcnt(2)
v_pk_mul_f32 v[128:129], v[128:129], v[22:23]
v_cvt_pk_bf16_f32 v204, v128, v129
v_pk_mul_f32 v[130:131], v[130:131], v[24:25]
v_cvt_pk_bf16_f32 v205, v130, v131
v_pk_fma_f32 v[144:145], v[18:19], v[44:45], v[144:145] op_sel:[0,1,0] op_sel_hi:[1,1,1]
v_pk_mul_f32 v[144:145], v[144:145], v[22:23]
v_cvt_pk_bf16_f32 v214, v144, v145
v_pk_fma_f32 v[146:147], v[20:21], v[44:45], v[146:147] op_sel:[0,1,0] op_sel_hi:[1,1,1]
v_pk_mul_f32 v[146:147], v[146:147], v[24:25]
v_cvt_pk_bf16_f32 v215, v146, v147
v_max3_f32 v85, v103, v116, v117
v_max3_f32 v84, v84, v118, v119
v_max_f32 v86, v84, v85
v_max_f32 v85, v84, v85
v_cvt_pk_bf16_f32 v168, v64, v65
v_cvt_pk_bf16_f32 v169, v66, v67
v_permlane16_swap_b32 v86, v85
v_cvt_pk_bf16_f32 v170, v80, v81
v_max_f32 v84, v86, v85
v_max_f32 v85, v86, v85
v_cvt_pk_bf16_f32 v171, v82, v83
s_waitcnt lgkmcnt(1)
v_pk_fma_f32 v[124:125], v[240:241], v[44:45], v[124:125] op_sel_hi:[1,0,1]
s_waitcnt lgkmcnt(0)
v_pk_mul_f32 v[124:125], v[124:125], v[244:245]
v_pk_fma_f32 v[126:127], v[242:243], v[44:45], v[126:127] op_sel_hi:[1,0,1]
v_pk_mul_f32 v[126:127], v[126:127], v[246:247]
v_pk_fma_f32 v[140:141], v[240:241], v[44:45], v[140:141] op_sel:[0,1,0] op_sel_hi:[1,1,1]
v_pk_mul_f32 v[140:141], v[140:141], v[244:245]
v_pk_fma_f32 v[142:143], v[242:243], v[44:45], v[142:143] op_sel:[0,1,0] op_sel_hi:[1,1,1]
v_pk_mul_f32 v[142:143], v[142:143], v[246:247]
v_permlane32_swap_b32 v84, v85
s_nop 0
v_mfma_f32_16x16x32_bf16 v[96:99], v[184:187], v[168:171], v[46:49]
v_max_f32 v84, v84, v85
v_mul_f32 v84, v84, v230
v_mfma_f32_16x16x32_bf16 v[112:115], v[188:191], v[168:171], v[50:53]
v_cvt_pk_bf16_f32 v202, v124, v125
v_cvt_pk_bf16_f32 v203, v126, v127
v_cvt_pk_bf16_f32 v212, v140, v141
v_cvt_pk_bf16_f32 v213, v142, v143
s_nop 0
v_max3_f32 v80, v96, v97, v98
v_pk_fma_f32 v[100:101], v[100:101], v[230:231], v[84:85] op_sel_hi:[1,0,0] neg_lo:[0,0,1] neg_hi:[0,0,1]
v_pk_fma_f32 v[102:103], v[102:103], v[230:231], v[84:85] op_sel_hi:[1,0,0] neg_lo:[0,0,1] neg_hi:[0,0,1]
v_pk_fma_f32 v[116:117], v[116:117], v[230:231], v[84:85] op_sel_hi:[1,0,0] neg_lo:[0,0,1] neg_hi:[0,0,1]
v_pk_fma_f32 v[118:119], v[118:119], v[230:231], v[84:85] op_sel_hi:[1,0,0] neg_lo:[0,0,1] neg_hi:[0,0,1]
v_exp_f32 v100, v100
v_exp_f32 v101, v101
v_exp_f32 v102, v102
v_exp_f32 v103, v103
v_exp_f32 v116, v116
v_exp_f32 v117, v117
v_exp_f32 v118, v118
v_exp_f32 v119, v119
v_cvt_pk_bf16_f32 v68, v100, v101
v_cvt_pk_bf16_f32 v69, v102, v103
v_cvt_pk_bf16_f32 v70, v116, v117
v_cvt_pk_bf16_f32 v71, v118, v119
v_max3_f32 v81, v99, v112, v113
v_max3_f32 v80, v80, v114, v115
v_mfma_f32_16x16x32_bf16 v[84:87], v[248:251], v[68:71], 0
v_max_f32 v82, v80, v81
v_max_f32 v81, v80, v81
v_mfma_f32_16x16x32_bf16 v[100:103], v[204:207], v[68:71], 0
s_nop 0
v_permlane16_swap_b32 v82, v81
v_mfma_f32_16x16x32_bf16 v[116:119], v[214:217], v[68:71], 0
s_nop 1
v_rcp_f32 v84, v84
v_max_f32 v80, v82, v81
v_max_f32 v81, v82, v81
v_cvt_pk_bf16_f32 v164, v60, v61
v_pk_mul_f32 v[100:101], v[100:101], v[84:85] op_sel_hi:[1,0]
v_pk_mul_f32 v[102:103], v[102:103], v[84:85] op_sel_hi:[1,0]
v_pk_mul_f32 v[116:117], v[116:117], v[84:85] op_sel_hi:[1,0]
v_pk_mul_f32 v[118:119], v[118:119], v[84:85] op_sel_hi:[1,0]
v_cvt_pk_bf16_f32 v172, v100, v101
v_cvt_pk_bf16_f32 v173, v102, v103
v_cvt_pk_bf16_f32 v174, v116, v117
v_cvt_pk_bf16_f32 v175, v118, v119
buffer_store_dwordx4 v[172:175], v4, s[16:19], s74 offen offset:2048 sc1
v_permlane32_swap_b32 v80, v81
v_cvt_pk_bf16_f32 v165, v62, v63
v_max_f32 v80, v80, v81
v_mul_f32 v80, v80, v226
v_pk_fma_f32 v[96:97], v[96:97], v[226:227], v[80:81] op_sel_hi:[1,0,0] neg_lo:[0,0,1] neg_hi:[0,0,1]
v_pk_fma_f32 v[98:99], v[98:99], v[226:227], v[80:81] op_sel_hi:[1,0,0] neg_lo:[0,0,1] neg_hi:[0,0,1]
v_pk_fma_f32 v[112:113], v[112:113], v[226:227], v[80:81] op_sel_hi:[1,0,0] neg_lo:[0,0,1] neg_hi:[0,0,1]
v_pk_fma_f32 v[114:115], v[114:115], v[226:227], v[80:81] op_sel_hi:[1,0,0] neg_lo:[0,0,1] neg_hi:[0,0,1]
v_exp_f32 v96, v96
v_exp_f32 v97, v97
v_exp_f32 v98, v98
v_exp_f32 v99, v99
v_exp_f32 v112, v112
v_exp_f32 v113, v113
v_exp_f32 v114, v114
v_exp_f32 v115, v115
v_cvt_pk_bf16_f32 v64, v96, v97
v_cvt_pk_bf16_f32 v65, v98, v99
v_cvt_pk_bf16_f32 v66, v112, v113
v_cvt_pk_bf16_f32 v67, v114, v115
v_cvt_pk_bf16_f32 v166, v76, v77
v_cvt_pk_bf16_f32 v167, v78, v79
v_mfma_f32_16x16x32_bf16 v[80:83], v[248:251], v[64:67], 0
v_mfma_f32_16x16x32_bf16 v[96:99], v[202:205], v[64:67], 0
v_mfma_f32_16x16x32_bf16 v[112:115], v[212:215], v[64:67], 0
s_nop 5
v_rcp_f32 v80, v80
v_mfma_f32_16x16x32_bf16 v[92:95], v[180:183], v[164:167], v[46:49]
v_mfma_f32_16x16x32_bf16 v[108:111], v[184:187], v[164:167], v[50:53]
s_nop 6
v_max3_f32 v76, v92, v93, v94
v_pk_mul_f32 v[96:97], v[96:97], v[80:81] op_sel_hi:[1,0]
v_pk_mul_f32 v[98:99], v[98:99], v[80:81] op_sel_hi:[1,0]
v_pk_mul_f32 v[112:113], v[112:113], v[80:81] op_sel_hi:[1,0]
v_pk_mul_f32 v[114:115], v[114:115], v[80:81] op_sel_hi:[1,0]
v_cvt_pk_bf16_f32 v168, v96, v97
v_cvt_pk_bf16_f32 v169, v98, v99
v_cvt_pk_bf16_f32 v170, v112, v113
v_cvt_pk_bf16_f32 v171, v114, v115
buffer_store_dwordx4 v[168:171], v4, s[16:19], s74 offen offset:1024 sc1
v_max3_f32 v77, v95, v108, v109
v_max3_f32 v76, v76, v110, v111
v_max_f32 v78, v76, v77
v_max_f32 v77, v76, v77
s_nop 1
v_permlane16_swap_b32 v78, v77
v_max_f32 v76, v78, v77
v_max_f32 v77, v78, v77
s_nop 1
v_permlane32_swap_b32 v76, v77
v_max_f32 v76, v76, v77
v_mul_f32 v76, v76, v222
v_pk_fma_f32 v[92:93], v[92:93], v[222:223], v[76:77] op_sel_hi:[1,0,0] neg_lo:[0,0,1] neg_hi:[0,0,1]
v_pk_fma_f32 v[94:95], v[94:95], v[222:223], v[76:77] op_sel_hi:[1,0,0] neg_lo:[0,0,1] neg_hi:[0,0,1]
v_pk_fma_f32 v[108:109], v[108:109], v[222:223], v[76:77] op_sel_hi:[1,0,0] neg_lo:[0,0,1] neg_hi:[0,0,1]
v_pk_fma_f32 v[110:111], v[110:111], v[222:223], v[76:77] op_sel_hi:[1,0,0] neg_lo:[0,0,1] neg_hi:[0,0,1]
v_exp_f32 v92, v92
v_exp_f32 v93, v93
v_exp_f32 v94, v94
v_exp_f32 v95, v95
v_exp_f32 v108, v108
v_exp_f32 v109, v109
v_exp_f32 v110, v110
v_exp_f32 v111, v111
v_cvt_pk_bf16_f32 v60, v92, v93
v_cvt_pk_bf16_f32 v61, v94, v95
v_cvt_pk_bf16_f32 v62, v108, v109
v_cvt_pk_bf16_f32 v63, v110, v111
s_nop 1
v_mfma_f32_16x16x32_bf16 v[76:79], v[248:251], v[60:63], 0
v_mfma_f32_16x16x32_bf16 v[92:95], v[200:203], v[60:63], 0
v_mfma_f32_16x16x32_bf16 v[108:111], v[210:213], v[60:63], 0
s_nop 5
v_rcp_f32 v76, v76
s_nop 0
v_pk_mul_f32 v[92:93], v[92:93], v[76:77] op_sel_hi:[1,0]
v_pk_mul_f32 v[94:95], v[94:95], v[76:77] op_sel_hi:[1,0]
v_pk_mul_f32 v[108:109], v[108:109], v[76:77] op_sel_hi:[1,0]
v_pk_mul_f32 v[110:111], v[110:111], v[76:77] op_sel_hi:[1,0]
v_cvt_pk_bf16_f32 v164, v92, v93
v_cvt_pk_bf16_f32 v165, v94, v95
v_cvt_pk_bf16_f32 v166, v108, v109
v_cvt_pk_bf16_f32 v167, v110, v111
buffer_store_dwordx4 v[164:167], v4, s[16:19], s74 offen sc1
s_nop 1
.Lqkve3:
s_lshl_b32 s62, s6, 13
s_lshl_b32 s63, s3, 11
s_add_u32 s62, s62, s63
v_lshl_add_u32 v4, v1, 4, s62
v_bfe_u32 v5, v1, 3, 1
v_lshrrev_b32 v2, 4, v1
v_lshl_add_u32 v5, v2, 3, v5
s_lshl_b32 s62, s3, 1
v_add_u32 v5, s62, v5
v_mul_u32_u24 v5, 2048, v5
v_and_b32 v2, 7, v1
v_lshl_add_u32 v5, v2, 4, v5
s_lshl_b32 s62, s7, 7
v_add_u32 v5, s62, v5
v_add_u32 v6, 64512, v5
v_bfe_u32 v8, v1, 3, 2
v_mul_u32_u24 v8, 2080, v8
v_bfe_u32 v2, v1, 2, 1
v_lshl_add_u32 v8, v2, 7, v8
v_bfe_u32 v2, v1, 5, 1
v_lshl_add_u32 v8, v2, 8, v8
v_and_b32 v2, 3, v1
v_lshl_add_u32 v8, v2, 3, v8
s_mov_b32 s57, 66560
v_add_u32 v7, s57, v8
s_mov_b32 s52, 4194304
s_mov_b32 s53, 4325376
s_mov_b32 s54, 2097152
s_mul_i32 s56, s3, 2080
v_accvgpr_read_b32 v32, a224
v_accvgpr_read_b32 v33, a225
v_accvgpr_read_b32 v34, a226
v_accvgpr_read_b32 v35, a227
v_accvgpr_read_b32 v36, a228
v_accvgpr_read_b32 v37, a229
v_accvgpr_read_b32 v38, a230
v_accvgpr_read_b32 v39, a231
v_accvgpr_read_b32 v40, a232
v_accvgpr_read_b32 v41, a233
v_accvgpr_read_b32 v42, a234
v_accvgpr_read_b32 v43, a235
v_accvgpr_read_b32 v44, a236
v_accvgpr_read_b32 v45, a237
v_accvgpr_read_b32 v46, a238
v_accvgpr_read_b32 v47, a239
v_accvgpr_read_b32 v48, a240
v_accvgpr_read_b32 v49, a241
v_accvgpr_read_b32 v50, a242
v_accvgpr_read_b32 v51, a243
v_accvgpr_read_b32 v52, a244
v_accvgpr_read_b32 v53, a245
v_accvgpr_read_b32 v54, a246
v_accvgpr_read_b32 v55, a247
v_accvgpr_read_b32 v56, a248
v_accvgpr_read_b32 v57, a249
v_accvgpr_read_b32 v58, a250
v_accvgpr_read_b32 v59, a251
v_accvgpr_read_b32 v60, a252
v_accvgpr_read_b32 v61, a253
v_accvgpr_read_b32 v62, a254
v_accvgpr_read_b32 v63, a255
s_and_b32 s62, s3, 1
s_mul_i32 s62, s62, 28672
s_add_u32 s62, s62, s51
v_lshrrev_b32 v12, 4, v1
v_mul_u32_u24 v12, 57344, v12
v_and_b32 v2, 15, v1
v_lshl_add_u32 v12, v2, 4, v12
v_add_u32 v12, s62, v12
v_add_u32 v13, 6112, v12
v_add_u32 v14, 12224, v12
v_add_u32 v15, 18336, v12
s_mul_i32 s59, s3, 4224
s_mov_b32 s58, 0
s_mov_b32 s36, s82
s_mov_b32 s37, s83
s_lshl_b32 s62, s8, 7
s_add_u32 s62, s62, 30410752
s_lshl_b32 s64, s6, 7
s_add_u32 s64, s64, 30410752
v_mov_b32 v252, s62
v_mov_b32 v253, s64
s_waitcnt vmcnt(0) lgkmcnt(0)
s_barrier
s_cmp_lg_u32 s3, 0
s_cbranch_scc1 .Lnosig32
v_mov_b32 v255, 1
s_mov_b64 exec, 1
buffer_atomic_add v255, v252, s[16:19], 0 offen
s_mov_b64 exec, -1
.Lnosig32:
s_cmp_lg_u32 s3, 1
s_cbranch_scc1 .Lnopoll35
s_mov_b64 exec, 1
s_mov_b32 s15, 0
s_mov_b64 exec, 1
v_mov_b32 v254, 0
buffer_atomic_add v254, v253, s[16:19], 0 offen sc0
.Lpoll33:
s_waitcnt vmcnt(0)
v_cmp_ne_u32 vcc, 16, v254
s_add_u32 s15, s15, 1
s_cbranch_vccz .Lnopoll35r
s_sleep 2
s_mov_b64 exec, 1
v_mov_b32 v254, 0
buffer_atomic_add v254, v253, s[16:19], 0 offen sc0
s_cmp_le_u32 s15, 100000
s_cbranch_scc1 .Lpoll33
.Lgot34:
s_waitcnt vmcnt(0)
s_branch .Lnopoll35r
.Lnopoll35:
s_mov_b64 exec, 0
s_cmp_eq_u32 s3, 2
s_cbranch_scc1 .Lpad1
s_cmp_eq_u32 s3, 3
s_cbranch_scc1 .Lnopoll35r
s_branch .Lnopoll35r
.Lnopoll35r:
s_mov_b64 exec, -1
s_barrier
buffer_load_dwordx4 v[64:67], v4, s[16:19], s52 offen sc1
buffer_load_dwordx4 v[68:71], v4, s[16:19], s52 offen offset:1024 sc1
s_add_u32 s52, s52, 0x40000
buffer_load_dwordx4 v[72:75], v4, s[16:19], s53 offen sc1
buffer_load_dwordx4 v[76:79], v4, s[16:19], s53 offen offset:1024 sc1
s_add_u32 s53, s53, 0x40000
buffer_load_dwordx4 v[80:83], v4, s[16:19], s52 offen sc1
buffer_load_dwordx4 v[84:87], v4, s[16:19], s52 offen offset:1024 sc1
s_add_u32 s52, s52, 0x40000
buffer_load_dwordx4 v[88:91], v4, s[16:19], s53 offen sc1
buffer_load_dwordx4 v[92:95], v4, s[16:19], s53 offen offset:1024 sc1
s_add_u32 s53, s53, 0x40000
buffer_load_dwordx4 v[96:99], v4, s[16:19], s52 offen sc1
buffer_load_dwordx4 v[100:103], v4, s[16:19], s52 offen offset:1024 sc1
s_add_u32 s52, s52, 0x40000
buffer_load_dwordx4 v[104:107], v4, s[16:19], s53 offen sc1
buffer_load_dwordx4 v[108:111], v4, s[16:19], s53 offen offset:1024 sc1
s_add_u32 s53, s53, 0x40000
ds_read_b64_tr_b16 a[0:1], v7
ds_read_b64_tr_b16 a[2:3], v7 offset:512
ds_read_b64_tr_b16 a[4:5], v7 offset:32
ds_read_b64_tr_b16 a[6:7], v7 offset:544
ds_read_b64_tr_b16 a[8:9], v7 offset:64
ds_read_b64_tr_b16 a[10:11], v7 offset:576
ds_read_b64_tr_b16 a[12:13], v7 offset:96
ds_read_b64_tr_b16 a[14:15], v7 offset:608
ds_read_b64_tr_b16 a[16:17], v7 offset:1024
ds_read_b64_tr_b16 a[18:19], v7 offset:1536
ds_read_b64_tr_b16 a[20:21], v7 offset:1056
ds_read_b64_tr_b16 a[22:23], v7 offset:1568
ds_read_b64_tr_b16 a[24:25], v7 offset:1088
ds_read_b64_tr_b16 a[26:27], v7 offset:1600
ds_read_b64_tr_b16 a[28:29], v7 offset:1120
ds_read_b64_tr_b16 a[30:31], v7 offset:1632
s_waitcnt vmcnt(11) lgkmcnt(14)
v_mfma_f32_16x16x32_bf16 v[32:35], a[0:3], v[64:67], v[32:35]
ds_read_b64_tr_b16 a[32:33], v7 offset:8320
ds_read_b64_tr_b16 a[34:35], v7 offset:8832
s_waitcnt vmcnt(10)
v_mfma_f32_16x16x32_bf16 v[48:51], a[0:3], v[68:71], v[48:51]
buffer_load_dwordx4 v[112:115], v4, s[16:19], s52 offen sc1
s_waitcnt lgkmcnt(14)
v_mfma_f32_16x16x32_bf16 v[52:55], a[4:7], v[68:71], v[52:55]
ds_read_b64_tr_b16 a[36:37], v7 offset:8352
ds_read_b64_tr_b16 a[38:39], v7 offset:8864
v_mfma_f32_16x16x32_bf16 v[36:39], a[4:7], v[64:67], v[36:39]
ds_read_b64_tr_b16 a[40:41], v7 offset:8384
ds_read_b64_tr_b16 a[42:43], v7 offset:8896
s_waitcnt lgkmcnt(15)
v_mfma_f32_16x16x32_bf16 v[40:43], a[8:11], v[64:67], v[40:43]
buffer_load_dwordx4 v[116:119], v4, s[16:19], s52 offen offset:1024 sc1
v_mfma_f32_16x16x32_bf16 v[56:59], a[8:11], v[68:71], v[56:59]
ds_read_b64_tr_b16 a[44:45], v7 offset:8416
s_add_u32 s52, s52, 0x40000
s_waitcnt lgkmcnt(15)
v_mfma_f32_16x16x32_bf16 v[60:63], a[12:15], v[68:71], v[60:63]
ds_read_b64_tr_b16 a[46:47], v7 offset:8928
v_mfma_f32_16x16x32_bf16 v[44:47], a[12:15], v[64:67], v[44:47]
ds_read_b64_tr_b16 a[48:49], v7 offset:9344
ds_read_b64_tr_b16 a[50:51], v7 offset:9856
s_waitcnt vmcnt(11) lgkmcnt(15)
v_mfma_f32_16x16x32_bf16 v[32:35], a[16:19], v[72:75], v[32:35]
buffer_load_dwordx4 v[120:123], v4, s[16:19], s53 offen sc1
s_waitcnt vmcnt(11)
v_mfma_f32_16x16x32_bf16 v[48:51], a[16:19], v[76:79], v[48:51]
ds_read_b64_tr_b16 a[52:53], v7 offset:9376
ds_read_b64_tr_b16 a[54:55], v7 offset:9888
s_waitcnt lgkmcnt(15)
v_mfma_f32_16x16x32_bf16 v[52:55], a[20:23], v[76:79], v[52:55]
ds_read_b64_tr_b16 a[56:57], v7 offset:9408
ds_read_b64_tr_b16 a[58:59], v7 offset:9920
v_mfma_f32_16x16x32_bf16 v[36:39], a[20:23], v[72:75], v[36:39]
buffer_load_dwordx4 v[124:127], v4, s[16:19], s53 offen offset:1024 sc1
s_waitcnt lgkmcnt(15)
v_mfma_f32_16x16x32_bf16 v[40:43], a[24:27], v[72:75], v[40:43]
ds_read_b64_tr_b16 a[60:61], v7 offset:9440
s_add_u32 s53, s53, 0x40000
v_mfma_f32_16x16x32_bf16 v[56:59], a[24:27], v[76:79], v[56:59]
ds_read_b64_tr_b16 a[62:63], v7 offset:9952
s_waitcnt lgkmcnt(15)
v_mfma_f32_16x16x32_bf16 v[60:63], a[28:31], v[76:79], v[60:63]
v_mfma_f32_16x16x32_bf16 v[44:47], a[28:31], v[72:75], v[44:47]
s_waitcnt vmcnt(11) lgkmcnt(14)
v_mfma_f32_16x16x32_bf16 v[32:35], a[32:35], v[80:83], v[32:35]
ds_read_b64_tr_b16 a[0:1], v7 offset:16640
ds_read_b64_tr_b16 a[2:3], v7 offset:17152
s_waitcnt vmcnt(10)
v_mfma_f32_16x16x32_bf16 v[48:51], a[32:35], v[84:87], v[48:51]
buffer_load_dwordx4 v[64:67], v4, s[16:19], s52 offen sc1
s_waitcnt lgkmcnt(14)
v_mfma_f32_16x16x32_bf16 v[52:55], a[36:39], v[84:87], v[52:55]
ds_read_b64_tr_b16 a[4:5], v7 offset:16672
ds_read_b64_tr_b16 a[6:7], v7 offset:17184
v_mfma_f32_16x16x32_bf16 v[36:39], a[36:39], v[80:83], v[36:39]
ds_read_b64_tr_b16 a[8:9], v7 offset:16704
ds_read_b64_tr_b16 a[10:11], v7 offset:17216
s_waitcnt lgkmcnt(15)
v_mfma_f32_16x16x32_bf16 v[40:43], a[40:43], v[80:83], v[40:43]
buffer_load_dwordx4 v[68:71], v4, s[16:19], s52 offen offset:1024 sc1
v_mfma_f32_16x16x32_bf16 v[56:59], a[40:43], v[84:87], v[56:59]
ds_read_b64_tr_b16 a[12:13], v7 offset:16736
s_add_u32 s52, s52, 0x40000
s_waitcnt lgkmcnt(15)
v_mfma_f32_16x16x32_bf16 v[60:63], a[44:47], v[84:87], v[60:63]
ds_read_b64_tr_b16 a[14:15], v7 offset:17248
v_mfma_f32_16x16x32_bf16 v[44:47], a[44:47], v[80:83], v[44:47]
ds_read_b64_tr_b16 a[16:17], v7 offset:17664
ds_read_b64_tr_b16 a[18:19], v7 offset:18176
s_waitcnt vmcnt(11) lgkmcnt(15)
v_mfma_f32_16x16x32_bf16 v[32:35], a[48:51], v[88:91], v[32:35]
buffer_load_dwordx4 v[72:75], v4, s[16:19], s53 offen sc1
s_waitcnt vmcnt(11)
v_mfma_f32_16x16x32_bf16 v[48:51], a[48:51], v[92:95], v[48:51]
ds_read_b64_tr_b16 a[20:21], v7 offset:17696
ds_read_b64_tr_b16 a[22:23], v7 offset:18208
s_waitcnt lgkmcnt(15)
v_mfma_f32_16x16x32_bf16 v[52:55], a[52:55], v[92:95], v[52:55]
ds_read_b64_tr_b16 a[24:25], v7 offset:17728
ds_read_b64_tr_b16 a[26:27], v7 offset:18240
v_mfma_f32_16x16x32_bf16 v[36:39], a[52:55], v[88:91], v[36:39]
buffer_load_dwordx4 v[76:79], v4, s[16:19], s53 offen offset:1024 sc1
s_waitcnt lgkmcnt(15)
v_mfma_f32_16x16x32_bf16 v[40:43], a[56:59], v[88:91], v[40:43]
ds_read_b64_tr_b16 a[28:29], v7 offset:17760
s_add_u32 s53, s53, 0x40000
v_mfma_f32_16x16x32_bf16 v[56:59], a[56:59], v[92:95], v[56:59]
ds_read_b64_tr_b16 a[30:31], v7 offset:18272
s_waitcnt lgkmcnt(15)
v_mfma_f32_16x16x32_bf16 v[60:63], a[60:63], v[92:95], v[60:63]
v_mfma_f32_16x16x32_bf16 v[44:47], a[60:63], v[88:91], v[44:47]
s_waitcnt vmcnt(11) lgkmcnt(14)
v_mfma_f32_16x16x32_bf16 v[32:35], a[0:3], v[96:99], v[32:35]
ds_read_b64_tr_b16 a[32:33], v7 offset:24960
ds_read_b64_tr_b16 a[34:35], v7 offset:25472
s_waitcnt vmcnt(10)
v_mfma_f32_16x16x32_bf16 v[48:51], a[0:3], v[100:103], v[48:51]
buffer_load_dwordx4 v[80:83], v4, s[16:19], s52 offen sc1
s_waitcnt lgkmcnt(14)
v_mfma_f32_16x16x32_bf16 v[52:55], a[4:7], v[100:103], v[52:55]
ds_read_b64_tr_b16 a[36:37], v7 offset:24992
ds_read_b64_tr_b16 a[38:39], v7 offset:25504
v_mfma_f32_16x16x32_bf16 v[36:39], a[4:7], v[96:99], v[36:39]
ds_read_b64_tr_b16 a[40:41], v7 offset:25024
ds_read_b64_tr_b16 a[42:43], v7 offset:25536
s_waitcnt lgkmcnt(15)
v_mfma_f32_16x16x32_bf16 v[40:43], a[8:11], v[96:99], v[40:43]
buffer_load_dwordx4 v[84:87], v4, s[16:19], s52 offen offset:1024 sc1
v_mfma_f32_16x16x32_bf16 v[56:59], a[8:11], v[100:103], v[56:59]
ds_read_b64_tr_b16 a[44:45], v7 offset:25056
s_add_u32 s52, s52, 0x40000
s_waitcnt lgkmcnt(15)
v_mfma_f32_16x16x32_bf16 v[60:63], a[12:15], v[100:103], v[60:63]
ds_read_b64_tr_b16 a[46:47], v7 offset:25568
v_mfma_f32_16x16x32_bf16 v[44:47], a[12:15], v[96:99], v[44:47]
ds_read_b64_tr_b16 a[48:49], v7 offset:25984
ds_read_b64_tr_b16 a[50:51], v7 offset:26496
s_waitcnt vmcnt(11) lgkmcnt(15)
v_mfma_f32_16x16x32_bf16 v[32:35], a[16:19], v[104:107], v[32:35]
buffer_load_dwordx4 v[88:91], v4, s[16:19], s53 offen sc1
s_waitcnt vmcnt(11)
v_mfma_f32_16x16x32_bf16 v[48:51], a[16:19], v[108:111], v[48:51]
ds_read_b64_tr_b16 a[52:53], v7 offset:26016
ds_read_b64_tr_b16 a[54:55], v7 offset:26528
s_waitcnt lgkmcnt(15)
v_mfma_f32_16x16x32_bf16 v[52:55], a[20:23], v[108:111], v[52:55]
ds_read_b64_tr_b16 a[56:57], v7 offset:26048
ds_read_b64_tr_b16 a[58:59], v7 offset:26560
v_mfma_f32_16x16x32_bf16 v[36:39], a[20:23], v[104:107], v[36:39]
buffer_load_dwordx4 v[92:95], v4, s[16:19], s53 offen offset:1024 sc1
s_waitcnt lgkmcnt(15)
v_mfma_f32_16x16x32_bf16 v[40:43], a[24:27], v[104:107], v[40:43]
ds_read_b64_tr_b16 a[60:61], v7 offset:26080
s_add_u32 s53, s53, 0x40000
v_mfma_f32_16x16x32_bf16 v[56:59], a[24:27], v[108:111], v[56:59]
ds_read_b64_tr_b16 a[62:63], v7 offset:26592
s_waitcnt lgkmcnt(15)
v_mfma_f32_16x16x32_bf16 v[60:63], a[28:31], v[108:111], v[60:63]
v_mfma_f32_16x16x32_bf16 v[44:47], a[28:31], v[104:107], v[44:47]
s_waitcnt vmcnt(11) lgkmcnt(14)
v_mfma_f32_16x16x32_bf16 v[32:35], a[32:35], v[112:115], v[32:35]
ds_read_b64_tr_b16 a[0:1], v7 offset:33280
ds_read_b64_tr_b16 a[2:3], v7 offset:33792
s_waitcnt vmcnt(10)
v_mfma_f32_16x16x32_bf16 v[48:51], a[32:35], v[116:119], v[48:51]
buffer_load_dwordx4 v[96:99], v4, s[16:19], s52 offen sc1
s_waitcnt lgkmcnt(14)
v_mfma_f32_16x16x32_bf16 v[52:55], a[36:39], v[116:119], v[52:55]
ds_read_b64_tr_b16 a[4:5], v7 offset:33312
ds_read_b64_tr_b16 a[6:7], v7 offset:33824
v_mfma_f32_16x16x32_bf16 v[36:39], a[36:39], v[112:115], v[36:39]
ds_read_b64_tr_b16 a[8:9], v7 offset:33344
ds_read_b64_tr_b16 a[10:11], v7 offset:33856
s_waitcnt lgkmcnt(15)
v_mfma_f32_16x16x32_bf16 v[40:43], a[40:43], v[112:115], v[40:43]
buffer_load_dwordx4 v[100:103], v4, s[16:19], s52 offen offset:1024 sc1
v_mfma_f32_16x16x32_bf16 v[56:59], a[40:43], v[116:119], v[56:59]
ds_read_b64_tr_b16 a[12:13], v7 offset:33376
s_add_u32 s52, s52, 0x40000
s_waitcnt lgkmcnt(15)
v_mfma_f32_16x16x32_bf16 v[60:63], a[44:47], v[116:119], v[60:63]
ds_read_b64_tr_b16 a[14:15], v7 offset:33888
v_mfma_f32_16x16x32_bf16 v[44:47], a[44:47], v[112:115], v[44:47]
ds_read_b64_tr_b16 a[16:17], v7 offset:34304
ds_read_b64_tr_b16 a[18:19], v7 offset:34816
s_waitcnt vmcnt(11) lgkmcnt(15)
v_mfma_f32_16x16x32_bf16 v[32:35], a[48:51], v[120:123], v[32:35]
buffer_load_dwordx4 v[104:107], v4, s[16:19], s53 offen sc1
s_waitcnt vmcnt(11)
v_mfma_f32_16x16x32_bf16 v[48:51], a[48:51], v[124:127], v[48:51]
ds_read_b64_tr_b16 a[20:21], v7 offset:34336
ds_read_b64_tr_b16 a[22:23], v7 offset:34848
s_waitcnt lgkmcnt(15)
v_mfma_f32_16x16x32_bf16 v[52:55], a[52:55], v[124:127], v[52:55]
ds_read_b64_tr_b16 a[24:25], v7 offset:34368
ds_read_b64_tr_b16 a[26:27], v7 offset:34880
v_mfma_f32_16x16x32_bf16 v[36:39], a[52:55], v[120:123], v[36:39]
buffer_load_dwordx4 v[108:111], v4, s[16:19], s53 offen offset:1024 sc1
s_waitcnt lgkmcnt(15)
v_mfma_f32_16x16x32_bf16 v[40:43], a[56:59], v[120:123], v[40:43]
ds_read_b64_tr_b16 a[28:29], v7 offset:34400
s_add_u32 s53, s53, 0x40000
v_mfma_f32_16x16x32_bf16 v[56:59], a[56:59], v[124:127], v[56:59]
ds_read_b64_tr_b16 a[30:31], v7 offset:34912
s_waitcnt lgkmcnt(15)
v_mfma_f32_16x16x32_bf16 v[60:63], a[60:63], v[124:127], v[60:63]
v_mfma_f32_16x16x32_bf16 v[44:47], a[60:63], v[120:123], v[44:47]
s_waitcnt vmcnt(11) lgkmcnt(14)
v_mfma_f32_16x16x32_bf16 v[32:35], a[0:3], v[64:67], v[32:35]
ds_read_b64_tr_b16 a[32:33], v7 offset:41600
ds_read_b64_tr_b16 a[34:35], v7 offset:42112
s_waitcnt vmcnt(10)
v_mfma_f32_16x16x32_bf16 v[48:51], a[0:3], v[68:71], v[48:51]
buffer_load_dwordx4 v[112:115], v4, s[16:19], s52 offen sc1
s_waitcnt lgkmcnt(14)
v_mfma_f32_16x16x32_bf16 v[52:55], a[4:7], v[68:71], v[52:55]
ds_read_b64_tr_b16 a[36:37], v7 offset:41632
ds_read_b64_tr_b16 a[38:39], v7 offset:42144
v_mfma_f32_16x16x32_bf16 v[36:39], a[4:7], v[64:67], v[36:39]
ds_read_b64_tr_b16 a[40:41], v7 offset:41664
ds_read_b64_tr_b16 a[42:43], v7 offset:42176
s_waitcnt lgkmcnt(15)
v_mfma_f32_16x16x32_bf16 v[40:43], a[8:11], v[64:67], v[40:43]
buffer_load_dwordx4 v[116:119], v4, s[16:19], s52 offen offset:1024 sc1
v_mfma_f32_16x16x32_bf16 v[56:59], a[8:11], v[68:71], v[56:59]
ds_read_b64_tr_b16 a[44:45], v7 offset:41696
s_add_u32 s52, s52, 0x40000
s_waitcnt lgkmcnt(15)
v_mfma_f32_16x16x32_bf16 v[60:63], a[12:15], v[68:71], v[60:63]
ds_read_b64_tr_b16 a[46:47], v7 offset:42208
v_mfma_f32_16x16x32_bf16 v[44:47], a[12:15], v[64:67], v[44:47]
ds_read_b64_tr_b16 a[48:49], v7 offset:42624
ds_read_b64_tr_b16 a[50:51], v7 offset:43136
s_waitcnt vmcnt(11) lgkmcnt(15)
v_mfma_f32_16x16x32_bf16 v[32:35], a[16:19], v[72:75], v[32:35]
buffer_load_dwordx4 v[120:123], v4, s[16:19], s53 offen sc1
s_waitcnt vmcnt(11)
v_mfma_f32_16x16x32_bf16 v[48:51], a[16:19], v[76:79], v[48:51]
ds_read_b64_tr_b16 a[52:53], v7 offset:42656
ds_read_b64_tr_b16 a[54:55], v7 offset:43168
s_waitcnt lgkmcnt(15)
v_mfma_f32_16x16x32_bf16 v[52:55], a[20:23], v[76:79], v[52:55]
ds_read_b64_tr_b16 a[56:57], v7 offset:42688
ds_read_b64_tr_b16 a[58:59], v7 offset:43200
v_mfma_f32_16x16x32_bf16 v[36:39], a[20:23], v[72:75], v[36:39]
buffer_load_dwordx4 v[124:127], v4, s[16:19], s53 offen offset:1024 sc1
s_waitcnt lgkmcnt(15)
v_mfma_f32_16x16x32_bf16 v[40:43], a[24:27], v[72:75], v[40:43]
ds_read_b64_tr_b16 a[60:61], v7 offset:42720
s_add_u32 s53, s53, 0x40000
v_mfma_f32_16x16x32_bf16 v[56:59], a[24:27], v[76:79], v[56:59]
ds_read_b64_tr_b16 a[62:63], v7 offset:43232
s_waitcnt lgkmcnt(15)
v_mfma_f32_16x16x32_bf16 v[60:63], a[28:31], v[76:79], v[60:63]
v_mfma_f32_16x16x32_bf16 v[44:47], a[28:31], v[72:75], v[44:47]
s_waitcnt vmcnt(11) lgkmcnt(14)
v_mfma_f32_16x16x32_bf16 v[32:35], a[32:35], v[80:83], v[32:35]
ds_read_b64_tr_b16 a[0:1], v7 offset:49920
ds_read_b64_tr_b16 a[2:3], v7 offset:50432
s_waitcnt vmcnt(10)
v_mfma_f32_16x16x32_bf16 v[48:51], a[32:35], v[84:87], v[48:51]
buffer_load_dwordx4 v[64:67], v4, s[16:19], s52 offen sc1
s_waitcnt lgkmcnt(14)
v_mfma_f32_16x16x32_bf16 v[52:55], a[36:39], v[84:87], v[52:55]
ds_read_b64_tr_b16 a[4:5], v7 offset:49952
ds_read_b64_tr_b16 a[6:7], v7 offset:50464
v_mfma_f32_16x16x32_bf16 v[36:39], a[36:39], v[80:83], v[36:39]
ds_read_b64_tr_b16 a[8:9], v7 offset:49984
ds_read_b64_tr_b16 a[10:11], v7 offset:50496
s_waitcnt lgkmcnt(15)
v_mfma_f32_16x16x32_bf16 v[40:43], a[40:43], v[80:83], v[40:43]
buffer_load_dwordx4 v[68:71], v4, s[16:19], s52 offen offset:1024 sc1
v_mfma_f32_16x16x32_bf16 v[56:59], a[40:43], v[84:87], v[56:59]
ds_read_b64_tr_b16 a[12:13], v7 offset:50016
s_add_u32 s52, s52, 0x40000
s_waitcnt lgkmcnt(15)
v_mfma_f32_16x16x32_bf16 v[60:63], a[44:47], v[84:87], v[60:63]
ds_read_b64_tr_b16 a[14:15], v7 offset:50528
v_mfma_f32_16x16x32_bf16 v[44:47], a[44:47], v[80:83], v[44:47]
ds_read_b64_tr_b16 a[16:17], v7 offset:50944
ds_read_b64_tr_b16 a[18:19], v7 offset:51456
s_waitcnt vmcnt(11) lgkmcnt(15)
v_mfma_f32_16x16x32_bf16 v[32:35], a[48:51], v[88:91], v[32:35]
buffer_load_dwordx4 v[72:75], v4, s[16:19], s53 offen sc1
s_waitcnt vmcnt(11)
v_mfma_f32_16x16x32_bf16 v[48:51], a[48:51], v[92:95], v[48:51]
ds_read_b64_tr_b16 a[20:21], v7 offset:50976
ds_read_b64_tr_b16 a[22:23], v7 offset:51488
s_waitcnt lgkmcnt(15)
v_mfma_f32_16x16x32_bf16 v[52:55], a[52:55], v[92:95], v[52:55]
ds_read_b64_tr_b16 a[24:25], v7 offset:51008
ds_read_b64_tr_b16 a[26:27], v7 offset:51520
v_mfma_f32_16x16x32_bf16 v[36:39], a[52:55], v[88:91], v[36:39]
buffer_load_dwordx4 v[76:79], v4, s[16:19], s53 offen offset:1024 sc1
s_waitcnt lgkmcnt(15)
v_mfma_f32_16x16x32_bf16 v[40:43], a[56:59], v[88:91], v[40:43]
ds_read_b64_tr_b16 a[28:29], v7 offset:51040
s_add_u32 s53, s53, 0x40000
v_mfma_f32_16x16x32_bf16 v[56:59], a[56:59], v[92:95], v[56:59]
ds_read_b64_tr_b16 a[30:31], v7 offset:51552
s_waitcnt lgkmcnt(15)
v_mfma_f32_16x16x32_bf16 v[60:63], a[60:63], v[92:95], v[60:63]
v_mfma_f32_16x16x32_bf16 v[44:47], a[60:63], v[88:91], v[44:47]
s_waitcnt vmcnt(11) lgkmcnt(14)
v_mfma_f32_16x16x32_bf16 v[32:35], a[0:3], v[96:99], v[32:35]
ds_read_b64_tr_b16 a[32:33], v7 offset:58240
ds_read_b64_tr_b16 a[34:35], v7 offset:58752
s_waitcnt vmcnt(10)
v_mfma_f32_16x16x32_bf16 v[48:51], a[0:3], v[100:103], v[48:51]
buffer_load_dwordx4 v[80:83], v4, s[16:19], s52 offen sc1
s_waitcnt lgkmcnt(14)
v_mfma_f32_16x16x32_bf16 v[52:55], a[4:7], v[100:103], v[52:55]
ds_read_b64_tr_b16 a[36:37], v7 offset:58272
ds_read_b64_tr_b16 a[38:39], v7 offset:58784
v_mfma_f32_16x16x32_bf16 v[36:39], a[4:7], v[96:99], v[36:39]
ds_read_b64_tr_b16 a[40:41], v7 offset:58304
ds_read_b64_tr_b16 a[42:43], v7 offset:58816
s_waitcnt lgkmcnt(15)
v_mfma_f32_16x16x32_bf16 v[40:43], a[8:11], v[96:99], v[40:43]
buffer_load_dwordx4 v[84:87], v4, s[16:19], s52 offen offset:1024 sc1
v_mfma_f32_16x16x32_bf16 v[56:59], a[8:11], v[100:103], v[56:59]
ds_read_b64_tr_b16 a[44:45], v7 offset:58336
s_add_u32 s52, s52, 0x40000
s_waitcnt lgkmcnt(15)
v_mfma_f32_16x16x32_bf16 v[60:63], a[12:15], v[100:103], v[60:63]
ds_read_b64_tr_b16 a[46:47], v7 offset:58848
v_mfma_f32_16x16x32_bf16 v[44:47], a[12:15], v[96:99], v[44:47]
ds_read_b64_tr_b16 a[48:49], v7 offset:59264
ds_read_b64_tr_b16 a[50:51], v7 offset:59776
s_waitcnt vmcnt(11) lgkmcnt(15)
v_mfma_f32_16x16x32_bf16 v[32:35], a[16:19], v[104:107], v[32:35]
buffer_load_dwordx4 v[88:91], v4, s[16:19], s53 offen sc1
s_waitcnt vmcnt(11)
v_mfma_f32_16x16x32_bf16 v[48:51], a[16:19], v[108:111], v[48:51]
ds_read_b64_tr_b16 a[52:53], v7 offset:59296
ds_read_b64_tr_b16 a[54:55], v7 offset:59808
s_waitcnt lgkmcnt(15)
v_mfma_f32_16x16x32_bf16 v[52:55], a[20:23], v[108:111], v[52:55]
ds_read_b64_tr_b16 a[56:57], v7 offset:59328
ds_read_b64_tr_b16 a[58:59], v7 offset:59840
v_mfma_f32_16x16x32_bf16 v[36:39], a[20:23], v[104:107], v[36:39]
buffer_load_dwordx4 v[92:95], v4, s[16:19], s53 offen offset:1024 sc1
s_waitcnt lgkmcnt(15)
v_mfma_f32_16x16x32_bf16 v[40:43], a[24:27], v[104:107], v[40:43]
ds_read_b64_tr_b16 a[60:61], v7 offset:59360
s_add_u32 s53, s53, 0x40000
v_mfma_f32_16x16x32_bf16 v[56:59], a[24:27], v[108:111], v[56:59]
ds_read_b64_tr_b16 a[62:63], v7 offset:59872
s_waitcnt lgkmcnt(15)
v_mfma_f32_16x16x32_bf16 v[60:63], a[28:31], v[108:111], v[60:63]
v_mfma_f32_16x16x32_bf16 v[44:47], a[28:31], v[104:107], v[44:47]
s_xor_b32 s57, s57, 66560
v_add_u32 v7, s57, v8
s_waitcnt vmcnt(11) lgkmcnt(14)
v_mfma_f32_16x16x32_bf16 v[32:35], a[32:35], v[112:115], v[32:35]
ds_read_b64_tr_b16 a[0:1], v7
ds_read_b64_tr_b16 a[2:3], v7 offset:512
s_waitcnt vmcnt(10)
v_mfma_f32_16x16x32_bf16 v[48:51], a[32:35], v[116:119], v[48:51]
buffer_load_dwordx4 v[96:99], v4, s[16:19], s52 offen sc1
s_waitcnt lgkmcnt(14)
v_mfma_f32_16x16x32_bf16 v[52:55], a[36:39], v[116:119], v[52:55]
ds_read_b64_tr_b16 a[4:5], v7 offset:32
ds_read_b64_tr_b16 a[6:7], v7 offset:544
v_mfma_f32_16x16x32_bf16 v[36:39], a[36:39], v[112:115], v[36:39]
ds_read_b64_tr_b16 a[8:9], v7 offset:64
ds_read_b64_tr_b16 a[10:11], v7 offset:576
s_waitcnt lgkmcnt(15)
v_mfma_f32_16x16x32_bf16 v[40:43], a[40:43], v[112:115], v[40:43]
buffer_load_dwordx4 v[100:103], v4, s[16:19], s52 offen offset:1024 sc1
v_mfma_f32_16x16x32_bf16 v[56:59], a[40:43], v[116:119], v[56:59]
ds_read_b64_tr_b16 a[12:13], v7 offset:96
s_add_u32 s52, s52, 0x40000
s_waitcnt lgkmcnt(15)
v_mfma_f32_16x16x32_bf16 v[60:63], a[44:47], v[116:119], v[60:63]
ds_read_b64_tr_b16 a[14:15], v7 offset:608
v_mfma_f32_16x16x32_bf16 v[44:47], a[44:47], v[112:115], v[44:47]
ds_read_b64_tr_b16 a[16:17], v7 offset:1024
ds_read_b64_tr_b16 a[18:19], v7 offset:1536
s_waitcnt vmcnt(11) lgkmcnt(15)
v_mfma_f32_16x16x32_bf16 v[32:35], a[48:51], v[120:123], v[32:35]
buffer_load_dwordx4 v[104:107], v4, s[16:19], s53 offen sc1
s_waitcnt vmcnt(11)
v_mfma_f32_16x16x32_bf16 v[48:51], a[48:51], v[124:127], v[48:51]
ds_read_b64_tr_b16 a[20:21], v7 offset:1056
ds_read_b64_tr_b16 a[22:23], v7 offset:1568
s_waitcnt lgkmcnt(15)
v_mfma_f32_16x16x32_bf16 v[52:55], a[52:55], v[124:127], v[52:55]
ds_read_b64_tr_b16 a[24:25], v7 offset:1088
ds_read_b64_tr_b16 a[26:27], v7 offset:1600
v_mfma_f32_16x16x32_bf16 v[36:39], a[52:55], v[120:123], v[36:39]
buffer_load_dwordx4 v[108:111], v4, s[16:19], s53 offen offset:1024 sc1
s_waitcnt lgkmcnt(15)
v_mfma_f32_16x16x32_bf16 v[40:43], a[56:59], v[120:123], v[40:43]
ds_read_b64_tr_b16 a[28:29], v7 offset:1120
s_add_u32 s53, s53, 0x40000
v_mfma_f32_16x16x32_bf16 v[56:59], a[56:59], v[124:127], v[56:59]
ds_read_b64_tr_b16 a[30:31], v7 offset:1632
s_waitcnt lgkmcnt(15)
v_mfma_f32_16x16x32_bf16 v[60:63], a[60:63], v[124:127], v[60:63]
v_mfma_f32_16x16x32_bf16 v[44:47], a[60:63], v[120:123], v[44:47]
s_waitcnt vmcnt(11) lgkmcnt(14)
v_mfma_f32_16x16x32_bf16 v[32:35], a[0:3], v[64:67], v[32:35]
ds_read_b64_tr_b16 a[32:33], v7 offset:8320
ds_read_b64_tr_b16 a[34:35], v7 offset:8832
s_waitcnt vmcnt(10)
v_mfma_f32_16x16x32_bf16 v[48:51], a[0:3], v[68:71], v[48:51]
buffer_load_dwordx4 v[112:115], v4, s[16:19], s52 offen sc1
s_waitcnt lgkmcnt(14)
v_mfma_f32_16x16x32_bf16 v[52:55], a[4:7], v[68:71], v[52:55]
ds_read_b64_tr_b16 a[36:37], v7 offset:8352
ds_read_b64_tr_b16 a[38:39], v7 offset:8864
v_mfma_f32_16x16x32_bf16 v[36:39], a[4:7], v[64:67], v[36:39]
ds_read_b64_tr_b16 a[40:41], v7 offset:8384
ds_read_b64_tr_b16 a[42:43], v7 offset:8896
s_waitcnt lgkmcnt(15)
v_mfma_f32_16x16x32_bf16 v[40:43], a[8:11], v[64:67], v[40:43]
buffer_load_dwordx4 v[116:119], v4, s[16:19], s52 offen offset:1024 sc1
v_mfma_f32_16x16x32_bf16 v[56:59], a[8:11], v[68:71], v[56:59]
ds_read_b64_tr_b16 a[44:45], v7 offset:8416
s_add_u32 s52, s52, 0x40000
s_waitcnt lgkmcnt(15)
v_mfma_f32_16x16x32_bf16 v[60:63], a[12:15], v[68:71], v[60:63]
ds_read_b64_tr_b16 a[46:47], v7 offset:8928
v_mfma_f32_16x16x32_bf16 v[44:47], a[12:15], v[64:67], v[44:47]
ds_read_b64_tr_b16 a[48:49], v7 offset:9344
ds_read_b64_tr_b16 a[50:51], v7 offset:9856
s_waitcnt vmcnt(11) lgkmcnt(15)
v_mfma_f32_16x16x32_bf16 v[32:35], a[16:19], v[72:75], v[32:35]
buffer_load_dwordx4 v[120:123], v4, s[16:19], s53 offen sc1
s_waitcnt vmcnt(11)
v_mfma_f32_16x16x32_bf16 v[48:51], a[16:19], v[76:79], v[48:51]
ds_read_b64_tr_b16 a[52:53], v7 offset:9376
ds_read_b64_tr_b16 a[54:55], v7 offset:9888
s_waitcnt lgkmcnt(15)
v_mfma_f32_16x16x32_bf16 v[52:55], a[20:23], v[76:79], v[52:55]
ds_read_b64_tr_b16 a[56:57], v7 offset:9408
ds_read_b64_tr_b16 a[58:59], v7 offset:9920
v_mfma_f32_16x16x32_bf16 v[36:39], a[20:23], v[72:75], v[36:39]
buffer_load_dwordx4 v[124:127], v4, s[16:19], s53 offen offset:1024 sc1
s_waitcnt lgkmcnt(15)
v_mfma_f32_16x16x32_bf16 v[40:43], a[24:27], v[72:75], v[40:43]
ds_read_b64_tr_b16 a[60:61], v7 offset:9440
s_add_u32 s53, s53, 0x40000
v_mfma_f32_16x16x32_bf16 v[56:59], a[24:27], v[76:79], v[56:59]
ds_read_b64_tr_b16 a[62:63], v7 offset:9952
s_waitcnt lgkmcnt(15)
v_mfma_f32_16x16x32_bf16 v[60:63], a[28:31], v[76:79], v[60:63]
v_mfma_f32_16x16x32_bf16 v[44:47], a[28:31], v[72:75], v[44:47]
s_waitcnt vmcnt(11) lgkmcnt(14)
v_mfma_f32_16x16x32_bf16 v[32:35], a[32:35], v[80:83], v[32:35]
ds_read_b64_tr_b16 a[0:1], v7 offset:16640
ds_read_b64_tr_b16 a[2:3], v7 offset:17152
s_waitcnt vmcnt(10)
v_mfma_f32_16x16x32_bf16 v[48:51], a[32:35], v[84:87], v[48:51]
buffer_load_dwordx4 v[64:67], v4, s[16:19], s52 offen sc1
s_waitcnt lgkmcnt(14)
v_mfma_f32_16x16x32_bf16 v[52:55], a[36:39], v[84:87], v[52:55]
ds_read_b64_tr_b16 a[4:5], v7 offset:16672
ds_read_b64_tr_b16 a[6:7], v7 offset:17184
v_mfma_f32_16x16x32_bf16 v[36:39], a[36:39], v[80:83], v[36:39]
ds_read_b64_tr_b16 a[8:9], v7 offset:16704
ds_read_b64_tr_b16 a[10:11], v7 offset:17216
s_waitcnt lgkmcnt(15)
v_mfma_f32_16x16x32_bf16 v[40:43], a[40:43], v[80:83], v[40:43]
buffer_load_dwordx4 v[68:71], v4, s[16:19], s52 offen offset:1024 sc1
v_mfma_f32_16x16x32_bf16 v[56:59], a[40:43], v[84:87], v[56:59]
ds_read_b64_tr_b16 a[12:13], v7 offset:16736
s_add_u32 s52, s52, 0x40000
s_waitcnt lgkmcnt(15)
v_mfma_f32_16x16x32_bf16 v[60:63], a[44:47], v[84:87], v[60:63]
ds_read_b64_tr_b16 a[14:15], v7 offset:17248
v_mfma_f32_16x16x32_bf16 v[44:47], a[44:47], v[80:83], v[44:47]
ds_read_b64_tr_b16 a[16:17], v7 offset:17664
ds_read_b64_tr_b16 a[18:19], v7 offset:18176
s_waitcnt vmcnt(11) lgkmcnt(15)
v_mfma_f32_16x16x32_bf16 v[32:35], a[48:51], v[88:91], v[32:35]
buffer_load_dwordx4 v[72:75], v4, s[16:19], s53 offen sc1
s_waitcnt vmcnt(11)
v_mfma_f32_16x16x32_bf16 v[48:51], a[48:51], v[92:95], v[48:51]
ds_read_b64_tr_b16 a[20:21], v7 offset:17696
ds_read_b64_tr_b16 a[22:23], v7 offset:18208
s_waitcnt lgkmcnt(15)
v_mfma_f32_16x16x32_bf16 v[52:55], a[52:55], v[92:95], v[52:55]
ds_read_b64_tr_b16 a[24:25], v7 offset:17728
ds_read_b64_tr_b16 a[26:27], v7 offset:18240
v_mfma_f32_16x16x32_bf16 v[36:39], a[52:55], v[88:91], v[36:39]
buffer_load_dwordx4 v[76:79], v4, s[16:19], s53 offen offset:1024 sc1
s_waitcnt lgkmcnt(15)
v_mfma_f32_16x16x32_bf16 v[40:43], a[56:59], v[88:91], v[40:43]
ds_read_b64_tr_b16 a[28:29], v7 offset:17760
s_add_u32 s53, s53, 0x40000
v_mfma_f32_16x16x32_bf16 v[56:59], a[56:59], v[92:95], v[56:59]
ds_read_b64_tr_b16 a[30:31], v7 offset:18272
s_waitcnt lgkmcnt(15)
v_mfma_f32_16x16x32_bf16 v[60:63], a[60:63], v[92:95], v[60:63]
v_mfma_f32_16x16x32_bf16 v[44:47], a[60:63], v[88:91], v[44:47]
s_waitcnt vmcnt(11) lgkmcnt(14)
v_mfma_f32_16x16x32_bf16 v[32:35], a[0:3], v[96:99], v[32:35]
ds_read_b64_tr_b16 a[32:33], v7 offset:24960
ds_read_b64_tr_b16 a[34:35], v7 offset:25472
s_waitcnt vmcnt(10)
v_mfma_f32_16x16x32_bf16 v[48:51], a[0:3], v[100:103], v[48:51]
buffer_load_dwordx4 v[80:83], v4, s[16:19], s52 offen sc1
s_waitcnt lgkmcnt(14)
v_mfma_f32_16x16x32_bf16 v[52:55], a[4:7], v[100:103], v[52:55]
ds_read_b64_tr_b16 a[36:37], v7 offset:24992
ds_read_b64_tr_b16 a[38:39], v7 offset:25504
v_mfma_f32_16x16x32_bf16 v[36:39], a[4:7], v[96:99], v[36:39]
ds_read_b64_tr_b16 a[40:41], v7 offset:25024
ds_read_b64_tr_b16 a[42:43], v7 offset:25536
s_waitcnt lgkmcnt(15)
v_mfma_f32_16x16x32_bf16 v[40:43], a[8:11], v[96:99], v[40:43]
buffer_load_dwordx4 v[84:87], v4, s[16:19], s52 offen offset:1024 sc1
v_mfma_f32_16x16x32_bf16 v[56:59], a[8:11], v[100:103], v[56:59]
ds_read_b64_tr_b16 a[44:45], v7 offset:25056
s_add_u32 s52, s52, 0x40000
s_waitcnt lgkmcnt(15)
v_mfma_f32_16x16x32_bf16 v[60:63], a[12:15], v[100:103], v[60:63]
.Lpad1:
s_cbranch_execz .Lnopoll35r
ds_read_b64_tr_b16 a[46:47], v7 offset:25568
v_mfma_f32_16x16x32_bf16 v[44:47], a[12:15], v[96:99], v[44:47]
ds_read_b64_tr_b16 a[48:49], v7 offset:25984
ds_read_b64_tr_b16 a[50:51], v7 offset:26496
s_waitcnt vmcnt(11) lgkmcnt(15)
v_mfma_f32_16x16x32_bf16 v[32:35], a[16:19], v[104:107], v[32:35]
buffer_load_dwordx4 v[88:91], v4, s[16:19], s53 offen sc1
s_waitcnt vmcnt(11)
v_mfma_f32_16x16x32_bf16 v[48:51], a[16:19], v[108:111], v[48:51]
ds_read_b64_tr_b16 a[52:53], v7 offset:26016
ds_read_b64_tr_b16 a[54:55], v7 offset:26528
s_waitcnt lgkmcnt(15)
v_mfma_f32_16x16x32_bf16 v[52:55], a[20:23], v[108:111], v[52:55]
ds_read_b64_tr_b16 a[56:57], v7 offset:26048
ds_read_b64_tr_b16 a[58:59], v7 offset:26560
v_mfma_f32_16x16x32_bf16 v[36:39], a[20:23], v[104:107], v[36:39]
buffer_load_dwordx4 v[92:95], v4, s[16:19], s53 offen offset:1024 sc1
s_waitcnt lgkmcnt(15)
v_mfma_f32_16x16x32_bf16 v[40:43], a[24:27], v[104:107], v[40:43]
ds_read_b64_tr_b16 a[60:61], v7 offset:26080
s_add_u32 s53, s53, 0x40000
v_mfma_f32_16x16x32_bf16 v[56:59], a[24:27], v[108:111], v[56:59]
ds_read_b64_tr_b16 a[62:63], v7 offset:26592
s_waitcnt lgkmcnt(15)
v_mfma_f32_16x16x32_bf16 v[60:63], a[28:31], v[108:111], v[60:63]
v_mfma_f32_16x16x32_bf16 v[44:47], a[28:31], v[104:107], v[44:47]
s_waitcnt vmcnt(11) lgkmcnt(14)
v_mfma_f32_16x16x32_bf16 v[32:35], a[32:35], v[112:115], v[32:35]
ds_read_b64_tr_b16 a[0:1], v7 offset:33280
ds_read_b64_tr_b16 a[2:3], v7 offset:33792
s_waitcnt vmcnt(10)
v_mfma_f32_16x16x32_bf16 v[48:51], a[32:35], v[116:119], v[48:51]
buffer_load_dwordx4 v[96:99], v4, s[16:19], s52 offen sc1
s_waitcnt lgkmcnt(14)
v_mfma_f32_16x16x32_bf16 v[52:55], a[36:39], v[116:119], v[52:55]
ds_read_b64_tr_b16 a[4:5], v7 offset:33312
ds_read_b64_tr_b16 a[6:7], v7 offset:33824
v_mfma_f32_16x16x32_bf16 v[36:39], a[36:39], v[112:115], v[36:39]
ds_read_b64_tr_b16 a[8:9], v7 offset:33344
ds_read_b64_tr_b16 a[10:11], v7 offset:33856
s_waitcnt lgkmcnt(15)
v_mfma_f32_16x16x32_bf16 v[40:43], a[40:43], v[112:115], v[40:43]
buffer_load_dwordx4 v[100:103], v4, s[16:19], s52 offen offset:1024 sc1
v_mfma_f32_16x16x32_bf16 v[56:59], a[40:43], v[116:119], v[56:59]
ds_read_b64_tr_b16 a[12:13], v7 offset:33376
s_add_u32 s52, s52, 0x40000
s_waitcnt lgkmcnt(15)
v_mfma_f32_16x16x32_bf16 v[60:63], a[44:47], v[116:119], v[60:63]
ds_read_b64_tr_b16 a[14:15], v7 offset:33888
v_mfma_f32_16x16x32_bf16 v[44:47], a[44:47], v[112:115], v[44:47]
ds_read_b64_tr_b16 a[16:17], v7 offset:34304
ds_read_b64_tr_b16 a[18:19], v7 offset:34816
s_waitcnt vmcnt(11) lgkmcnt(15)
v_mfma_f32_16x16x32_bf16 v[32:35], a[48:51], v[120:123], v[32:35]
buffer_load_dwordx4 v[104:107], v4, s[16:19], s53 offen sc1
s_waitcnt vmcnt(11)
v_mfma_f32_16x16x32_bf16 v[48:51], a[48:51], v[124:127], v[48:51]
ds_read_b64_tr_b16 a[20:21], v7 offset:34336
ds_read_b64_tr_b16 a[22:23], v7 offset:34848
s_waitcnt lgkmcnt(15)
v_mfma_f32_16x16x32_bf16 v[52:55], a[52:55], v[124:127], v[52:55]
ds_read_b64_tr_b16 a[24:25], v7 offset:34368
ds_read_b64_tr_b16 a[26:27], v7 offset:34880
v_mfma_f32_16x16x32_bf16 v[36:39], a[52:55], v[120:123], v[36:39]
buffer_load_dwordx4 v[108:111], v4, s[16:19], s53 offen offset:1024 sc1
s_waitcnt lgkmcnt(15)
v_mfma_f32_16x16x32_bf16 v[40:43], a[56:59], v[120:123], v[40:43]
ds_read_b64_tr_b16 a[28:29], v7 offset:34400
s_add_u32 s53, s53, 0x40000
v_mfma_f32_16x16x32_bf16 v[56:59], a[56:59], v[124:127], v[56:59]
ds_read_b64_tr_b16 a[30:31], v7 offset:34912
s_waitcnt lgkmcnt(15)
v_mfma_f32_16x16x32_bf16 v[60:63], a[60:63], v[124:127], v[60:63]
v_mfma_f32_16x16x32_bf16 v[44:47], a[60:63], v[120:123], v[44:47]
s_waitcnt vmcnt(11) lgkmcnt(14)
v_mfma_f32_16x16x32_bf16 v[32:35], a[0:3], v[64:67], v[32:35]
ds_read_b64_tr_b16 a[32:33], v7 offset:41600
ds_read_b64_tr_b16 a[34:35], v7 offset:42112
s_waitcnt vmcnt(10)
v_mfma_f32_16x16x32_bf16 v[48:51], a[0:3], v[68:71], v[48:51]
buffer_load_dwordx4 v[112:115], v4, s[16:19], s52 offen sc1
s_waitcnt lgkmcnt(14)
v_mfma_f32_16x16x32_bf16 v[52:55], a[4:7], v[68:71], v[52:55]
ds_read_b64_tr_b16 a[36:37], v7 offset:41632
ds_read_b64_tr_b16 a[38:39], v7 offset:42144
v_mfma_f32_16x16x32_bf16 v[36:39], a[4:7], v[64:67], v[36:39]
ds_read_b64_tr_b16 a[40:41], v7 offset:41664
ds_read_b64_tr_b16 a[42:43], v7 offset:42176
s_waitcnt lgkmcnt(15)
v_mfma_f32_16x16x32_bf16 v[40:43], a[8:11], v[64:67], v[40:43]
buffer_load_dwordx4 v[116:119], v4, s[16:19], s52 offen offset:1024 sc1
v_mfma_f32_16x16x32_bf16 v[56:59], a[8:11], v[68:71], v[56:59]
ds_read_b64_tr_b16 a[44:45], v7 offset:41696
s_add_u32 s52, s52, 0x40000
s_waitcnt lgkmcnt(15)
v_mfma_f32_16x16x32_bf16 v[60:63], a[12:15], v[68:71], v[60:63]
ds_read_b64_tr_b16 a[46:47], v7 offset:42208
v_mfma_f32_16x16x32_bf16 v[44:47], a[12:15], v[64:67], v[44:47]
ds_read_b64_tr_b16 a[48:49], v7 offset:42624
ds_read_b64_tr_b16 a[50:51], v7 offset:43136
s_waitcnt vmcnt(11) lgkmcnt(15)
v_mfma_f32_16x16x32_bf16 v[32:35], a[16:19], v[72:75], v[32:35]
buffer_load_dwordx4 v[120:123], v4, s[16:19], s53 offen sc1
s_waitcnt vmcnt(11)
v_mfma_f32_16x16x32_bf16 v[48:51], a[16:19], v[76:79], v[48:51]
ds_read_b64_tr_b16 a[52:53], v7 offset:42656
ds_read_b64_tr_b16 a[54:55], v7 offset:43168
s_waitcnt lgkmcnt(15)
v_mfma_f32_16x16x32_bf16 v[52:55], a[20:23], v[76:79], v[52:55]
ds_read_b64_tr_b16 a[56:57], v7 offset:42688
ds_read_b64_tr_b16 a[58:59], v7 offset:43200
v_mfma_f32_16x16x32_bf16 v[36:39], a[20:23], v[72:75], v[36:39]
buffer_load_dwordx4 v[124:127], v4, s[16:19], s53 offen offset:1024 sc1
s_waitcnt lgkmcnt(15)
v_mfma_f32_16x16x32_bf16 v[40:43], a[24:27], v[72:75], v[40:43]
ds_read_b64_tr_b16 a[60:61], v7 offset:42720
s_add_u32 s53, s53, 0x40000
v_mfma_f32_16x16x32_bf16 v[56:59], a[24:27], v[76:79], v[56:59]
ds_read_b64_tr_b16 a[62:63], v7 offset:43232
s_waitcnt lgkmcnt(15)
v_mfma_f32_16x16x32_bf16 v[60:63], a[28:31], v[76:79], v[60:63]
v_mfma_f32_16x16x32_bf16 v[44:47], a[28:31], v[72:75], v[44:47]
s_waitcnt lgkmcnt(0)
s_barrier
s_waitcnt vmcnt(11)
v_mfma_f32_16x16x32_bf16 v[32:35], a[32:35], v[80:83], v[32:35]
ds_read_b64_tr_b16 a[0:1], v7 offset:49920
ds_read_b64_tr_b16 a[2:3], v7 offset:50432
s_add_u32 m0, s59, 84480
s_waitcnt vmcnt(10)
v_mfma_f32_16x16x32_bf16 v[48:51], a[32:35], v[84:87], v[48:51]
ds_read_b64_tr_b16 a[4:5], v7 offset:49952
buffer_load_dwordx4 v12, s[32:35], s58 offen lds
v_mfma_f32_16x16x32_bf16 v[52:55], a[36:39], v[84:87], v[52:55]
ds_read_b64_tr_b16 a[6:7], v7 offset:50464
ds_read_b64_tr_b16 a[8:9], v7 offset:49984
v_mfma_f32_16x16x32_bf16 v[36:39], a[36:39], v[80:83], v[36:39]
ds_read_b64_tr_b16 a[10:11], v7 offset:50496
v_mfma_f32_16x16x32_bf16 v[40:43], a[40:43], v[80:83], v[40:43]
ds_read_b64_tr_b16 a[12:13], v7 offset:50016
buffer_load_dwordx4 v13, s[32:35], s58 offen offset:1056 lds
v_mfma_f32_16x16x32_bf16 v[56:59], a[40:43], v[84:87], v[56:59]
ds_read_b64_tr_b16 a[14:15], v7 offset:50528
ds_read_b64_tr_b16 a[16:17], v7 offset:50944
v_mfma_f32_16x16x32_bf16 v[60:63], a[44:47], v[84:87], v[60:63]
ds_read_b64_tr_b16 a[18:19], v7 offset:51456
ds_read_b64_tr_b16 a[20:21], v7 offset:50976
v_mfma_f32_16x16x32_bf16 v[44:47], a[44:47], v[80:83], v[44:47]
ds_read_b64_tr_b16 a[22:23], v7 offset:51488
s_waitcnt vmcnt(11)
v_mfma_f32_16x16x32_bf16 v[32:35], a[48:51], v[88:91], v[32:35]
ds_read_b64_tr_b16 a[24:25], v7 offset:51008
buffer_load_dwordx4 v14, s[32:35], s58 offen offset:2112 lds
s_waitcnt vmcnt(11)
v_mfma_f32_16x16x32_bf16 v[48:51], a[48:51], v[92:95], v[48:51]
ds_read_b64_tr_b16 a[26:27], v7 offset:51520
ds_read_b64_tr_b16 a[28:29], v7 offset:51040
v_mfma_f32_16x16x32_bf16 v[52:55], a[52:55], v[92:95], v[52:55]
ds_read_b64_tr_b16 a[30:31], v7 offset:51552
v_mfma_f32_16x16x32_bf16 v[36:39], a[52:55], v[88:91], v[36:39]
buffer_load_dwordx4 v15, s[32:35], s58 offen offset:3168 lds
v_mfma_f32_16x16x32_bf16 v[40:43], a[56:59], v[88:91], v[40:43]
s_add_u32 s58, s58, 229376
v_mfma_f32_16x16x32_bf16 v[56:59], a[56:59], v[92:95], v[56:59]
v_mfma_f32_16x16x32_bf16 v[60:63], a[60:63], v[92:95], v[60:63]
v_mfma_f32_16x16x32_bf16 v[44:47], a[60:63], v[88:91], v[44:47]
s_waitcnt vmcnt(11) lgkmcnt(14)
v_mfma_f32_16x16x32_bf16 v[32:35], a[0:3], v[96:99], v[32:35]
ds_read_b64_tr_b16 a[32:33], v7 offset:58240
s_add_u32 m0, s59, 101376
s_waitcnt vmcnt(10)
v_mfma_f32_16x16x32_bf16 v[48:51], a[0:3], v[100:103], v[48:51]
buffer_load_dwordx4 v12, s[32:35], s58 offen lds
s_waitcnt lgkmcnt(13)
v_mfma_f32_16x16x32_bf16 v[52:55], a[4:7], v[100:103], v[52:55]
ds_read_b64_tr_b16 a[34:35], v7 offset:58752
ds_read_b64_tr_b16 a[36:37], v7 offset:58272
v_mfma_f32_16x16x32_bf16 v[36:39], a[4:7], v[96:99], v[36:39]
ds_read_b64_tr_b16 a[38:39], v7 offset:58784
ds_read_b64_tr_b16 a[40:41], v7 offset:58304
s_waitcnt lgkmcnt(15)
v_mfma_f32_16x16x32_bf16 v[40:43], a[8:11], v[96:99], v[40:43]
buffer_load_dwordx4 v13, s[32:35], s58 offen offset:1056 lds
v_mfma_f32_16x16x32_bf16 v[56:59], a[8:11], v[100:103], v[56:59]
ds_read_b64_tr_b16 a[42:43], v7 offset:58816
ds_read_b64_tr_b16 a[44:45], v7 offset:58336
s_waitcnt lgkmcnt(15)
v_mfma_f32_16x16x32_bf16 v[60:63], a[12:15], v[100:103], v[60:63]
ds_read_b64_tr_b16 a[46:47], v7 offset:58848
v_mfma_f32_16x16x32_bf16 v[44:47], a[12:15], v[96:99], v[44:47]
ds_read_b64_tr_b16 a[48:49], v7 offset:59264
ds_read_b64_tr_b16 a[50:51], v7 offset:59776
s_waitcnt vmcnt(11) lgkmcnt(15)
v_mfma_f32_16x16x32_bf16 v[32:35], a[16:19], v[104:107], v[32:35]
buffer_load_dwordx4 v14, s[32:35], s58 offen offset:2112 lds
s_waitcnt vmcnt(11)
v_mfma_f32_16x16x32_bf16 v[48:51], a[16:19], v[108:111], v[48:51]
ds_read_b64_tr_b16 a[52:53], v7 offset:59296
ds_read_b64_tr_b16 a[54:55], v7 offset:59808
s_waitcnt lgkmcnt(15)
v_mfma_f32_16x16x32_bf16 v[52:55], a[20:23], v[108:111], v[52:55]
ds_read_b64_tr_b16 a[56:57], v7 offset:59328
ds_read_b64_tr_b16 a[58:59], v7 offset:59840
v_mfma_f32_16x16x32_bf16 v[36:39], a[20:23], v[104:107], v[36:39]
buffer_load_dwordx4 v15, s[32:35], s58 offen offset:3168 lds
s_waitcnt lgkmcnt(15)
v_mfma_f32_16x16x32_bf16 v[40:43], a[24:27], v[104:107], v[40:43]
ds_read_b64_tr_b16 a[60:61], v7 offset:59360
s_add_u32 s58, s58, 229376
v_mfma_f32_16x16x32_bf16 v[56:59], a[24:27], v[108:111], v[56:59]
ds_read_b64_tr_b16 a[62:63], v7 offset:59872
s_waitcnt lgkmcnt(15)
v_mfma_f32_16x16x32_bf16 v[60:63], a[28:31], v[108:111], v[60:63]
v_mfma_f32_16x16x32_bf16 v[44:47], a[28:31], v[104:107], v[44:47]
s_waitcnt vmcnt(11) lgkmcnt(14)
v_mfma_f32_16x16x32_bf16 v[32:35], a[32:35], v[112:115], v[32:35]
s_add_u32 m0, s59, 118272
s_lshl_b32 s64, s6, 14
s_lshl_b32 s65, s49, 13
s_waitcnt vmcnt(10)
v_mfma_f32_16x16x32_bf16 v[48:51], a[32:35], v[116:119], v[48:51]
buffer_load_dwordx4 v12, s[32:35], s58 offen lds
s_waitcnt lgkmcnt(12)
v_mfma_f32_16x16x32_bf16 v[52:55], a[36:39], v[116:119], v[52:55]
s_add_u32 s64, s64, s65
s_lshl_b32 s65, s7, 9
s_add_u32 s64, s64, s65
v_mfma_f32_16x16x32_bf16 v[36:39], a[36:39], v[112:115], v[36:39]
s_lshl_b32 s65, s48, 8
s_add_u32 s64, s64, s65
s_add_u32 s64, s64, 29622272
s_waitcnt lgkmcnt(10)
v_mfma_f32_16x16x32_bf16 v[40:43], a[40:43], v[112:115], v[40:43]
s_lshl_b32 s62, s7, 18
v_and_b32 v152, 31, v1
v_lshlrev_b32 v152, 3, v152
v_mfma_f32_16x16x32_bf16 v[56:59], a[40:43], v[116:119], v[56:59]
buffer_load_dwordx4 v13, s[32:35], s58 offen offset:1056 lds
s_waitcnt lgkmcnt(8)
v_mfma_f32_16x16x32_bf16 v[60:63], a[44:47], v[116:119], v[60:63]
s_add_u32 s62, s62, 8388608
v_lshrrev_b32 v153, 5, v1
v_lshl_add_u32 v152, v153, 28, v152
v_mfma_f32_16x16x32_bf16 v[44:47], a[44:47], v[112:115], v[44:47]
s_add_u32 s63, s62, 0x20000
s_waitcnt vmcnt(11) lgkmcnt(6)
v_mfma_f32_16x16x32_bf16 v[32:35], a[48:51], v[120:123], v[32:35]
s_waitcnt vmcnt(10)
v_mfma_f32_16x16x32_bf16 v[48:51], a[48:51], v[124:127], v[48:51]
buffer_load_dwordx4 v14, s[32:35], s58 offen offset:2112 lds
s_waitcnt lgkmcnt(4)
v_mfma_f32_16x16x32_bf16 v[52:55], a[52:55], v[124:127], v[52:55]
s_nop 2
v_cvt_pk_bf16_f32 v128, v32, v33
v_cvt_pk_bf16_f32 v129, v34, v35
v_mfma_f32_16x16x32_bf16 v[36:39], a[52:55], v[120:123], v[36:39]
v_cvt_pk_bf16_f32 v136, v48, v49
v_cvt_pk_bf16_f32 v137, v50, v51
s_waitcnt lgkmcnt(2)
v_mfma_f32_16x16x32_bf16 v[40:43], a[56:59], v[120:123], v[40:43]
v_cvt_pk_bf16_f32 v138, v52, v53
v_cvt_pk_bf16_f32 v139, v54, v55
v_mfma_f32_16x16x32_bf16 v[56:59], a[56:59], v[124:127], v[56:59]
buffer_load_dwordx4 v15, s[32:35], s58 offen offset:3168 lds
s_waitcnt lgkmcnt(0)
v_mfma_f32_16x16x32_bf16 v[60:63], a[60:63], v[124:127], v[60:63]
s_add_u32 s58, s58, 229376
v_cvt_pk_bf16_f32 v130, v36, v37
v_cvt_pk_bf16_f32 v131, v38, v39
v_mfma_f32_16x16x32_bf16 v[44:47], a[60:63], v[120:123], v[44:47]
v_cvt_pk_bf16_f32 v132, v40, v41
v_cvt_pk_bf16_f32 v133, v42, v43
v_cvt_pk_bf16_f32 v140, v56, v57
v_cvt_pk_bf16_f32 v141, v58, v59
v_cvt_pk_bf16_f32 v142, v60, v61
v_cvt_pk_bf16_f32 v143, v62, v63
v_pk_mul_f32 v[146:147], v[32:33], v[32:33]
buffer_store_dwordx4 v[128:131], v4, s[16:19], s62 offen sc1
v_cvt_pk_bf16_f32 v134, v44, v45
v_cvt_pk_bf16_f32 v135, v46, v47
v_pk_mul_f32 v[150:151], v[48:49], v[48:49]
v_pk_fma_f32 v[146:147], v[34:35], v[34:35], v[146:147]
v_pk_add_f32 v[144:145], v[32:33], v[34:35]
v_pk_fma_f32 v[150:151], v[50:51], v[50:51], v[150:151]
v_pk_add_f32 v[148:149], v[48:49], v[50:51]
v_pk_fma_f32 v[146:147], v[36:37], v[36:37], v[146:147]
v_pk_add_f32 v[144:145], v[144:145], v[36:37]
v_pk_fma_f32 v[150:151], v[52:53], v[52:53], v[150:151]
v_pk_add_f32 v[148:149], v[148:149], v[52:53]
v_pk_fma_f32 v[146:147], v[38:39], v[38:39], v[146:147]
v_pk_add_f32 v[144:145], v[144:145], v[38:39]
buffer_store_dwordx4 v[132:135], v4, s[16:19], s63 offen sc1
v_pk_fma_f32 v[150:151], v[54:55], v[54:55], v[150:151]
v_pk_add_f32 v[148:149], v[148:149], v[54:55]
v_pk_fma_f32 v[146:147], v[40:41], v[40:41], v[146:147]
v_pk_add_f32 v[144:145], v[144:145], v[40:41]
v_pk_fma_f32 v[150:151], v[56:57], v[56:57], v[150:151]
v_pk_add_f32 v[148:149], v[148:149], v[56:57]
v_pk_fma_f32 v[146:147], v[42:43], v[42:43], v[146:147]
v_pk_add_f32 v[144:145], v[144:145], v[42:43]
v_pk_fma_f32 v[150:151], v[58:59], v[58:59], v[150:151]
v_pk_add_f32 v[148:149], v[148:149], v[58:59]
v_pk_fma_f32 v[146:147], v[44:45], v[44:45], v[146:147]
v_pk_add_f32 v[144:145], v[144:145], v[44:45]
v_pk_fma_f32 v[150:151], v[60:61], v[60:61], v[150:151]
buffer_store_dwordx4 v[136:139], v4, s[16:19], s62 offen offset:1024 sc1
v_pk_add_f32 v[148:149], v[148:149], v[60:61]
v_pk_fma_f32 v[146:147], v[46:47], v[46:47], v[146:147]
v_pk_add_f32 v[144:145], v[144:145], v[46:47]
v_pk_fma_f32 v[150:151], v[62:63], v[62:63], v[150:151]
v_pk_add_f32 v[148:149], v[148:149], v[62:63]
v_add_f32 v144, v144, v145
v_add_f32 v146, v146, v147
v_add_f32 v148, v148, v149
v_add_f32 v150, v150, v151
s_nop 0
v_permlane16_swap_b32 v144, v148
v_permlane16_swap_b32 v146, v150
v_add_f32 v144, v144, v148
buffer_store_dwordx4 v[140:143], v4, s[16:19], s63 offen offset:1024 sc1
v_add_f32 v146, v146, v150
s_nop 1
v_permlane32_swap_b32 v144, v146
v_add_f32 v144, v144, v146
s_nop 1
v_permlane32_swap_b32 v144, v145
buffer_store_dwordx2 v[144:145], v152, s[16:19], s64 offen sc1
s_nop 1
v_accvgpr_write_b32 a224, v32
v_accvgpr_write_b32 a225, v33
v_accvgpr_write_b32 a226, v34
v_accvgpr_write_b32 a227, v35
v_accvgpr_write_b32 a228, v36
v_accvgpr_write_b32 a229, v37
v_accvgpr_write_b32 a230, v38
v_accvgpr_write_b32 a231, v39
v_accvgpr_write_b32 a232, v40
v_accvgpr_write_b32 a233, v41
v_accvgpr_write_b32 a234, v42
v_accvgpr_write_b32 a235, v43
v_accvgpr_write_b32 a236, v44
v_accvgpr_write_b32 a237, v45
v_accvgpr_write_b32 a238, v46
v_accvgpr_write_b32 a239, v47
v_accvgpr_write_b32 a240, v48
v_accvgpr_write_b32 a241, v49
v_accvgpr_write_b32 a242, v50
v_accvgpr_write_b32 a243, v51
v_accvgpr_write_b32 a244, v52
v_accvgpr_write_b32 a245, v53
v_accvgpr_write_b32 a246, v54
v_accvgpr_write_b32 a247, v55
v_accvgpr_write_b32 a248, v56
v_accvgpr_write_b32 a249, v57
v_accvgpr_write_b32 a250, v58
v_accvgpr_write_b32 a251, v59
v_accvgpr_write_b32 a252, v60
v_accvgpr_write_b32 a253, v61
v_accvgpr_write_b32 a254, v62
v_accvgpr_write_b32 a255, v63
s_lshl_b32 s62, s10, 14
s_lshl_b32 s63, s3, 12
s_add_u32 s62, s62, s63
s_lshl_b32 s63, s12, 11
s_add_u32 s62, s62, s63
v_lshl_add_u32 v10, v1, 4, s62
v_xor_b32 v11, 2048, v10
v_bfe_u32 v16, v1, 2, 3
v_mul_u32_u24 v16, 1056, v16
v_bfe_u32 v2, v1, 5, 1
v_lshl_add_u32 v16, v2, 8, v16
v_and_b32 v2, 3, v1
v_lshl_add_u32 v16, v2, 3, v16
s_lshl_b32 s62, s12, 6
s_add_u32 s62, s62, 84480
s_xor_b32 s63, s12, 1
s_mul_i32 s63, s63, 192
s_add_u32 s63, s63, 84480
v_add_u32 v17, s63, v16
v_add_u32 v16, s62, v16
s_mov_b32 s52, 8388608
s_mov_b32 s54, s58
s_mov_b32 s55, s59
s_mul_i32 s59, s3, 2112
s_and_b32 s62, s7, 1
s_mul_i32 s62, s62, 3670016
s_lshr_b32 s63, s7, 1
s_lshl_b32 s63, s63, 8
s_add_u32 s62, s62, s63
s_lshl_b32 s63, s3, 12
s_add_u32 s62, s62, s63
v_lshrrev_b32 v5, 4, v1
v_lshlrev_b32 v5, 14, v5
v_and_b32 v2, 15, v1
v_lshl_add_u32 v5, v2, 4, v5
v_add_u32 v5, s62, v5
v_add_u32 v6, 992, v5
s_lshl_b32 s62, s10, 15
s_lshl_b32 s63, s3, 13
s_add_u32 s62, s62, s63
v_lshl_add_u32 v4, v1, 4, s62
s_and_b32 s47, s5, 3
s_lshr_b32 s63, s5, 2
s_lshl_b32 s63, s63, 3
s_add_u32 s63, s63, s4
s_lshl_b32 s62, s63, 1
s_add_u32 s62, s62, s48
s_mul_i32 s62, s62, 1792
v_lshrrev_b32 v7, 2, v1
v_min_u32 v8, 13, v7
v_lshl_add_u32 v8, v8, 7, s62
s_lshl_b32 s62, s63, 2
s_add_u32 s62, s62, s3
s_mul_i32 s62, s62, 640
v_and_b32 v7, 7, v7
v_min_u32 v7, 4, v7
v_lshl_add_u32 v7, v7, 7, s62
v_lshrrev_b32 v2, 5, v1
v_mul_u32_u24 v2, 3670016, v2
v_add_u32 v7, v7, v2
s_mul_i32 s44, s47, 163840
s_add_u32 s45, s47, 12
s_mul_i32 s45, s45, 229376
v_and_b32 v2, 1, v1
v_lshlrev_b32 v2, 4, v2
v_mov_b32 v9, 0x3f80
v_lshlrev_b32 v2, v2, v9
v_bfe_u32 v9, v1, 1, 3
v_cmp_eq_u32 vcc, 0, v9
s_nop 1
v_cndmask_b32 v20, 0, v2, vcc
v_cmp_eq_u32 vcc, 1, v9
s_nop 1
v_cndmask_b32 v21, 0, v2, vcc
v_cmp_eq_u32 vcc, 2, v9
s_nop 1
v_cndmask_b32 v22, 0, v2, vcc
v_cmp_eq_u32 vcc, 3, v9
s_nop 1
v_cndmask_b32 v23, 0, v2, vcc
s_add_u32 s62, s55, 84480
v_lshl_add_u32 v9, v1, 4, s62
v_mov_b64 v[24:25], 0
v_mov_b64 v[26:27], 0
s_lshl_b32 s62, s6, 7
s_add_u32 s62, s62, 30412800
s_lshl_b32 s64, s10, 1
s_lshl_b32 s64, s64, 7
s_add_u32 s64, s64, 30412800
s_add_u32 s65, s64, 128
v_mov_b32 v252, s62
v_mov_b32 v253, s64
v_writelane_b32 v253, s65, 1
s_waitcnt vmcnt(0) lgkmcnt(0)
s_barrier
s_cmp_lg_u32 s3, 0
s_cbranch_scc1 .Lnosig37
v_mov_b32 v255, 1
s_mov_b64 exec, 1
buffer_atomic_add v255, v252, s[16:19], 0 offen
s_mov_b64 exec, -1
.Lnosig37:
s_cmp_lg_u32 s3, 1
s_cbranch_scc1 .Lnopoll40
s_mov_b64 exec, 3
s_mov_b32 s15, 0
s_mov_b64 exec, 3
v_mov_b32 v254, 0
buffer_atomic_add v254, v253, s[16:19], 0 offen sc0
.Lpoll38:
s_waitcnt vmcnt(0)
v_cmp_ne_u32 vcc, 16, v254
s_add_u32 s15, s15, 1
s_cbranch_vccz .Lnopoll40r
s_sleep 2
s_mov_b64 exec, 3
v_mov_b32 v254, 0
buffer_atomic_add v254, v253, s[16:19], 0 offen sc0
s_cmp_le_u32 s15, 100000
s_cbranch_scc1 .Lpoll38
.Lgot39:
s_waitcnt vmcnt(0)
s_branch .Lnopoll40r
.Lnopoll40:
s_mov_b64 exec, 0
s_cmp_eq_u32 s3, 2
s_cbranch_scc1 .Lpad2
s_cmp_eq_u32 s3, 3
s_cbranch_scc1 .Lpad3
s_branch .Lpad4
.Lnopoll40r:
s_mov_b64 exec, -1
s_barrier
buffer_load_dwordx4 a[128:131], v10, s[16:19], s52 offen sc1
buffer_load_dwordx4 a[132:135], v10, s[16:19], s52 offen offset:1024 sc1
buffer_load_dwordx4 a[136:139], v11, s[16:19], s52 offen sc1
buffer_load_dwordx4 a[140:143], v11, s[16:19], s52 offen offset:1024 sc1
s_add_u32 s52, s52, 0x20000
buffer_load_dwordx4 a[144:147], v10, s[16:19], s52 offen sc1
buffer_load_dwordx4 a[148:151], v10, s[16:19], s52 offen offset:1024 sc1
buffer_load_dwordx4 a[152:155], v11, s[16:19], s52 offen sc1
buffer_load_dwordx4 a[156:159], v11, s[16:19], s52 offen offset:1024 sc1
s_add_u32 s52, s52, 0x20000
ds_read_b64_tr_b16 a[0:1], v16
ds_read_b64_tr_b16 a[2:3], v16 offset:512
ds_read_b64_tr_b16 a[4:5], v16 offset:32
ds_read_b64_tr_b16 a[6:7], v16 offset:544
ds_read_b64_tr_b16 a[8:9], v16 offset:8448
ds_read_b64_tr_b16 a[10:11], v16 offset:8960
ds_read_b64_tr_b16 a[12:13], v16 offset:8480
ds_read_b64_tr_b16 a[14:15], v16 offset:8992
ds_read_b64_tr_b16 a[16:17], v16 offset:64
ds_read_b64_tr_b16 a[18:19], v16 offset:576
ds_read_b64_tr_b16 a[20:21], v16 offset:96
ds_read_b64_tr_b16 a[22:23], v16 offset:608
ds_read_b64_tr_b16 a[24:25], v16 offset:8512
ds_read_b64_tr_b16 a[26:27], v16 offset:9024
ds_read_b64_tr_b16 a[28:29], v16 offset:8544
ds_read_b64_tr_b16 a[30:31], v16 offset:9056
ds_read_b64_tr_b16 a[32:33], v16 offset:128
ds_read_b64_tr_b16 a[34:35], v16 offset:640
ds_read_b64_tr_b16 a[36:37], v16 offset:160
ds_read_b64_tr_b16 a[38:39], v16 offset:672
ds_read_b64_tr_b16 a[40:41], v16 offset:8576
ds_read_b64_tr_b16 a[42:43], v16 offset:9088
ds_read_b64_tr_b16 a[44:45], v16 offset:8608
ds_read_b64_tr_b16 a[46:47], v16 offset:9120
ds_read_b64_tr_b16 a[48:49], v17
ds_read_b64_tr_b16 a[50:51], v17 offset:512
ds_read_b64_tr_b16 a[52:53], v17 offset:32
ds_read_b64_tr_b16 a[54:55], v17 offset:544
ds_read_b64_tr_b16 a[56:57], v17 offset:8448
ds_read_b64_tr_b16 a[58:59], v17 offset:8960
ds_read_b64_tr_b16 a[60:61], v17 offset:8480
ds_read_b64_tr_b16 a[62:63], v17 offset:8992
ds_read_b128 a[192:195], v9
ds_read_b128 a[196:199], v9 offset:1056
ds_read_b128 a[200:203], v9 offset:2112
ds_read_b128 a[204:207], v9 offset:3168
s_add_u32 m0, s55, 135168
s_nop 0
buffer_load_dwordx4 v12, s[32:35], s54 offen lds
buffer_load_dwordx4 v13, s[32:35], s54 offen offset:1056 lds
buffer_load_dwordx4 v14, s[32:35], s54 offen offset:2112 lds
buffer_load_dwordx4 v15, s[32:35], s54 offen offset:3168 lds
s_add_u32 s54, s54, 229376
s_mul_i32 s66, s13, 917504
s_add_u32 s66, s66, 12582912
s_add_u32 s65, s66, 393216
s_lshl_b32 s62, s12, 19
s_add_u32 s62, s62, s66
s_add_u32 s63, s62, 0x20000
s_add_u32 s64, s62, 0x40000
s_lshl_b32 s74, s3, 13
s_add_u32 s74, s74, 49920
v_lshl_add_u32 v2, v1, 3, s74
s_waitcnt lgkmcnt(0)
s_barrier
s_waitcnt vmcnt(11)
v_mfma_f32_16x16x32_bf16 v[32:35], a[0:3], a[128:131], 0
buffer_load_dwordx4 a[160:163], v10, s[16:19], s52 offen sc1
s_waitcnt vmcnt(11)
v_mfma_f32_16x16x32_bf16 v[36:39], a[0:3], a[132:135], 0
ds_read_b64_tr_b16 a[64:65], v16 offset:16896
v_mfma_f32_16x16x32_bf16 v[52:55], a[4:7], a[132:135], 0
ds_read_b64_tr_b16 a[66:67], v16 offset:17408
v_mfma_f32_16x16x32_bf16 v[48:51], a[4:7], a[128:131], 0
ds_read_b64_tr_b16 a[68:69], v16 offset:16928
v_mfma_f32_16x16x32_bf16 v[64:67], a[8:11], a[128:131], 0
buffer_load_dwordx4 a[164:167], v10, s[16:19], s52 offen offset:1024 sc1
v_mfma_f32_16x16x32_bf16 v[68:71], a[8:11], a[132:135], 0
ds_read_b64_tr_b16 a[70:71], v16 offset:17440
v_mfma_f32_16x16x32_bf16 v[24:27], v[20:23], a[192:195], v[24:27]
ds_read_b64_tr_b16 a[72:73], v16 offset:25344
v_mfma_f32_16x16x32_bf16 v[84:87], a[12:15], a[132:135], 0
ds_read_b64_tr_b16 a[74:75], v16 offset:25856
v_mfma_f32_16x16x32_bf16 v[80:83], a[12:15], a[128:131], 0
buffer_load_dwordx4 a[168:171], v11, s[16:19], s52 offen sc1
v_mfma_f32_16x16x32_bf16 v[96:99], a[16:19], a[128:131], 0
ds_read_b64_tr_b16 a[76:77], v16 offset:25376
v_mfma_f32_16x16x32_bf16 v[100:103], a[16:19], a[132:135], 0
ds_read_b64_tr_b16 a[78:79], v16 offset:25888
v_mfma_f32_16x16x32_bf16 v[116:119], a[20:23], a[132:135], 0
ds_read_b64_tr_b16 a[80:81], v16 offset:16960
v_mfma_f32_16x16x32_bf16 v[112:115], a[20:23], a[128:131], 0
buffer_load_dwordx4 a[172:175], v11, s[16:19], s52 offen offset:1024 sc1
v_mfma_f32_16x16x32_bf16 v[128:131], a[24:27], a[128:131], 0
s_add_u32 s52, s52, 0x20000
s_add_u32 m0, s55, 84480
v_mfma_f32_16x16x32_bf16 v[132:135], a[24:27], a[132:135], 0
ds_read_b64_tr_b16 a[82:83], v16 offset:17472
v_mfma_f32_16x16x32_bf16 v[148:151], a[28:31], a[132:135], 0
ds_read_b64_tr_b16 a[84:85], v16 offset:16992
v_mfma_f32_16x16x32_bf16 v[144:147], a[28:31], a[128:131], 0
buffer_load_dwordx4 v12, s[32:35], s54 offen lds
v_mfma_f32_16x16x32_bf16 v[160:163], a[32:35], a[128:131], 0
ds_read_b64_tr_b16 a[86:87], v16 offset:17504
v_mfma_f32_16x16x32_bf16 v[164:167], a[32:35], a[132:135], 0
ds_read_b64_tr_b16 a[88:89], v16 offset:25408
v_mfma_f32_16x16x32_bf16 v[24:27], v[20:23], a[196:199], v[24:27]
ds_read_b64_tr_b16 a[90:91], v16 offset:25920
v_mfma_f32_16x16x32_bf16 v[180:183], a[36:39], a[132:135], 0
buffer_load_dwordx4 a[176:179], v10, s[16:19], s52 offen sc1
v_mfma_f32_16x16x32_bf16 v[176:179], a[36:39], a[128:131], 0
ds_read_b64_tr_b16 a[92:93], v16 offset:25440
v_mfma_f32_16x16x32_bf16 v[192:195], a[40:43], a[128:131], 0
.Lpad2:
s_cbranch_execz .Lpad5
ds_read_b64_tr_b16 a[94:95], v16 offset:25952
v_mfma_f32_16x16x32_bf16 v[196:199], a[40:43], a[132:135], 0
ds_read_b64_tr_b16 a[96:97], v16 offset:17024
v_mfma_f32_16x16x32_bf16 v[212:215], a[44:47], a[132:135], 0
buffer_load_dwordx4 v13, s[32:35], s54 offen offset:1056 lds
v_mfma_f32_16x16x32_bf16 v[208:211], a[44:47], a[128:131], 0
ds_read_b64_tr_b16 a[98:99], v16 offset:17536
v_mfma_f32_16x16x32_bf16 v[224:227], a[48:51], a[128:131], 0
ds_read_b64_tr_b16 a[100:101], v16 offset:17056
v_mfma_f32_16x16x32_bf16 v[228:231], a[48:51], a[132:135], 0
ds_read_b64_tr_b16 a[102:103], v16 offset:17568
v_mfma_f32_16x16x32_bf16 v[236:239], a[52:55], a[132:135], 0
buffer_load_dwordx4 a[180:183], v10, s[16:19], s52 offen offset:1024 sc1
v_mfma_f32_16x16x32_bf16 v[232:235], a[52:55], a[128:131], 0
ds_read_b64_tr_b16 a[104:105], v16 offset:25472
v_mfma_f32_16x16x32_bf16 v[240:243], a[56:59], a[128:131], 0
ds_read_b64_tr_b16 a[106:107], v16 offset:25984
v_mfma_f32_16x16x32_bf16 v[244:247], a[56:59], a[132:135], 0
ds_read_b64_tr_b16 a[108:109], v16 offset:25504
v_mfma_f32_16x16x32_bf16 v[24:27], v[20:23], a[200:203], v[24:27]
buffer_load_dwordx4 v14, s[32:35], s54 offen offset:2112 lds
v_mfma_f32_16x16x32_bf16 v[252:255], a[60:63], a[132:135], 0
ds_read_b64_tr_b16 a[110:111], v16 offset:26016
v_mfma_f32_16x16x32_bf16 v[248:251], a[60:63], a[128:131], 0
ds_read_b64_tr_b16 a[112:113], v17 offset:16896
s_waitcnt vmcnt(17)
v_mfma_f32_16x16x32_bf16 v[220:223], a[44:47], a[140:143], 0
ds_read_b64_tr_b16 a[114:115], v17 offset:17408
v_mfma_f32_16x16x32_bf16 v[216:219], a[44:47], a[136:139], 0
buffer_load_dwordx4 a[184:187], v11, s[16:19], s52 offen sc1
v_mfma_f32_16x16x32_bf16 v[200:203], a[40:43], a[136:139], 0
ds_read_b64_tr_b16 a[116:117], v17 offset:16928
v_mfma_f32_16x16x32_bf16 v[204:207], a[40:43], a[140:143], 0
ds_read_b64_tr_b16 a[118:119], v17 offset:17440
v_mfma_f32_16x16x32_bf16 v[188:191], a[36:39], a[140:143], 0
ds_read_b64_tr_b16 a[120:121], v17 offset:25344
v_mfma_f32_16x16x32_bf16 v[184:187], a[36:39], a[136:139], 0
buffer_load_dwordx4 v15, s[32:35], s54 offen offset:3168 lds
v_mfma_f32_16x16x32_bf16 v[168:171], a[32:35], a[136:139], 0
s_add_u32 s54, s54, 229376
ds_read_b64_tr_b16 a[122:123], v17 offset:25856
v_mfma_f32_16x16x32_bf16 v[172:175], a[32:35], a[140:143], 0
ds_read_b64_tr_b16 a[124:125], v17 offset:25376
v_mfma_f32_16x16x32_bf16 v[156:159], a[28:31], a[140:143], 0
ds_read_b64_tr_b16 a[126:127], v17 offset:25888
v_mfma_f32_16x16x32_bf16 v[152:155], a[28:31], a[136:139], 0
buffer_load_dwordx4 a[188:191], v11, s[16:19], s52 offen offset:1024 sc1
v_mfma_f32_16x16x32_bf16 v[24:27], v[20:23], a[204:207], v[24:27]
s_add_u32 s52, s52, 0x20000
ds_read_b128 a[208:211], v9 offset:16896
v_mfma_f32_16x16x32_bf16 v[136:139], a[24:27], a[136:139], 0
ds_read_b128 a[212:215], v9 offset:17952
v_mfma_f32_16x16x32_bf16 v[140:143], a[24:27], a[140:143], 0
ds_read_b128 a[216:219], v9 offset:19008
v_mfma_f32_16x16x32_bf16 v[124:127], a[20:23], a[140:143], 0
ds_read_b128 a[220:223], v9 offset:20064
v_mfma_f32_16x16x32_bf16 v[120:123], a[20:23], a[136:139], 0
v_mfma_f32_16x16x32_bf16 v[104:107], a[16:19], a[136:139], 0
v_mfma_f32_16x16x32_bf16 v[108:111], a[16:19], a[140:143], 0
v_mfma_f32_16x16x32_bf16 v[92:95], a[12:15], a[140:143], 0
v_mfma_f32_16x16x32_bf16 v[88:91], a[12:15], a[136:139], 0
v_mfma_f32_16x16x32_bf16 v[72:75], a[8:11], a[136:139], 0
v_mfma_f32_16x16x32_bf16 v[76:79], a[8:11], a[140:143], 0
v_mfma_f32_16x16x32_bf16 v[60:63], a[4:7], a[140:143], 0
v_mfma_f32_16x16x32_bf16 v[56:59], a[4:7], a[136:139], 0
v_mfma_f32_16x16x32_bf16 v[40:43], a[0:3], a[136:139], 0
v_mfma_f32_16x16x32_bf16 v[44:47], a[0:3], a[140:143], 0
s_waitcnt lgkmcnt(0)
s_barrier
s_waitcnt vmcnt(19)
v_mfma_f32_16x16x32_bf16 v[32:35], a[64:67], a[144:147], v[32:35]
s_add_u32 m0, s74, 0
s_mov_b32 s67, 29622272
s_waitcnt vmcnt(18)
v_mfma_f32_16x16x32_bf16 v[36:39], a[64:67], a[148:151], v[36:39]
buffer_load_dwordx4 v4, s[16:19], s67 offen sc1 lds
v_mfma_f32_16x16x32_bf16 v[52:55], a[68:71], a[148:151], v[52:55]
ds_read_b64_tr_b16 a[0:1], v16 offset:33792
v_mfma_f32_16x16x32_bf16 v[48:51], a[68:71], a[144:147], v[48:51]
ds_read_b64_tr_b16 a[2:3], v16 offset:34304
v_mfma_f32_16x16x32_bf16 v[64:67], a[72:75], a[144:147], v[64:67]
buffer_load_dwordx4 v4, s[16:19], s67 offen offset:1024 sc1 lds
v_mfma_f32_16x16x32_bf16 v[68:71], a[72:75], a[148:151], v[68:71]
ds_read_b64_tr_b16 a[4:5], v16 offset:33824
v_mfma_f32_16x16x32_bf16 v[24:27], v[20:23], a[208:211], v[24:27]
ds_read_b64_tr_b16 a[6:7], v16 offset:34336
v_mfma_f32_16x16x32_bf16 v[84:87], a[76:79], a[148:151], v[84:87]
buffer_load_dwordx4 v4, s[16:19], s67 offen offset:2048 sc1 lds
v_mfma_f32_16x16x32_bf16 v[80:83], a[76:79], a[144:147], v[80:83]
ds_read_b64_tr_b16 a[8:9], v16 offset:42240
v_mfma_f32_16x16x32_bf16 v[96:99], a[80:83], a[144:147], v[96:99]
ds_read_b64_tr_b16 a[10:11], v16 offset:42752
v_mfma_f32_16x16x32_bf16 v[100:103], a[80:83], a[148:151], v[100:103]
buffer_load_dwordx4 v4, s[16:19], s67 offen offset:3072 sc1 lds
v_mfma_f32_16x16x32_bf16 v[116:119], a[84:87], a[148:151], v[116:119]
s_add_u32 m0, s74, 4096
s_mov_b32 s67, 29626368
v_mfma_f32_16x16x32_bf16 v[112:115], a[84:87], a[144:147], v[112:115]
ds_read_b64_tr_b16 a[12:13], v16 offset:42272
v_mfma_f32_16x16x32_bf16 v[128:131], a[88:91], a[144:147], v[128:131]
buffer_load_dwordx4 v4, s[16:19], s67 offen sc1 lds
v_mfma_f32_16x16x32_bf16 v[132:135], a[88:91], a[148:151], v[132:135]
ds_read_b64_tr_b16 a[14:15], v16 offset:42784
v_mfma_f32_16x16x32_bf16 v[148:151], a[92:95], a[148:151], v[148:151]
ds_read_b64_tr_b16 a[16:17], v16 offset:33856
v_mfma_f32_16x16x32_bf16 v[144:147], a[92:95], a[144:147], v[144:147]
buffer_load_dwordx4 v4, s[16:19], s67 offen offset:1024 sc1 lds
v_mfma_f32_16x16x32_bf16 v[160:163], a[96:99], a[144:147], v[160:163]
ds_read_b64_tr_b16 a[18:19], v16 offset:34368
v_mfma_f32_16x16x32_bf16 v[164:167], a[96:99], a[148:151], v[164:167]
ds_read_b64_tr_b16 a[20:21], v16 offset:33888
v_mfma_f32_16x16x32_bf16 v[24:27], v[20:23], a[212:215], v[24:27]
buffer_load_dwordx4 v4, s[16:19], s67 offen offset:2048 sc1 lds
v_mfma_f32_16x16x32_bf16 v[180:183], a[100:103], a[148:151], v[180:183]
ds_read_b64_tr_b16 a[22:23], v16 offset:34400
v_mfma_f32_16x16x32_bf16 v[176:179], a[100:103], a[144:147], v[176:179]
ds_read_b64_tr_b16 a[24:25], v16 offset:42304
v_mfma_f32_16x16x32_bf16 v[192:195], a[104:107], a[144:147], v[192:195]
buffer_load_dwordx4 v4, s[16:19], s67 offen offset:3072 sc1 lds
v_mfma_f32_16x16x32_bf16 v[196:199], a[104:107], a[148:151], v[196:199]
s_add_u32 m0, s55, 101376
ds_read_b64_tr_b16 a[26:27], v16 offset:42816
v_mfma_f32_16x16x32_bf16 v[212:215], a[108:111], a[148:151], v[212:215]
ds_read_b64_tr_b16 a[28:29], v16 offset:42336
v_mfma_f32_16x16x32_bf16 v[208:211], a[108:111], a[144:147], v[208:211]
buffer_load_dwordx4 v12, s[32:35], s54 offen lds
v_mfma_f32_16x16x32_bf16 v[224:227], a[112:115], a[144:147], v[224:227]
ds_read_b64_tr_b16 a[30:31], v16 offset:42848
v_mfma_f32_16x16x32_bf16 v[228:231], a[112:115], a[148:151], v[228:231]
ds_read_b64_tr_b16 a[32:33], v16 offset:33920
v_mfma_f32_16x16x32_bf16 v[236:239], a[116:119], a[148:151], v[236:239]
buffer_load_dwordx4 a[128:131], v10, s[16:19], s52 offen sc1
v_mfma_f32_16x16x32_bf16 v[232:235], a[116:119], a[144:147], v[232:235]
ds_read_b64_tr_b16 a[34:35], v16 offset:34432
v_mfma_f32_16x16x32_bf16 v[240:243], a[120:123], a[144:147], v[240:243]
ds_read_b64_tr_b16 a[36:37], v16 offset:33952
v_mfma_f32_16x16x32_bf16 v[244:247], a[120:123], a[148:151], v[244:247]
buffer_load_dwordx4 v13, s[32:35], s54 offen offset:1056 lds
v_mfma_f32_16x16x32_bf16 v[24:27], v[20:23], a[216:219], v[24:27]
ds_read_b64_tr_b16 a[38:39], v16 offset:34464
v_mfma_f32_16x16x32_bf16 v[252:255], a[124:127], a[148:151], v[252:255]
ds_read_b64_tr_b16 a[40:41], v16 offset:42368
v_mfma_f32_16x16x32_bf16 v[248:251], a[124:127], a[144:147], v[248:251]
buffer_load_dwordx4 a[132:135], v10, s[16:19], s52 offen offset:1024 sc1
s_waitcnt vmcnt(28)
v_mfma_f32_16x16x32_bf16 v[220:223], a[108:111], a[156:159], v[220:223]
ds_read_b64_tr_b16 a[42:43], v16 offset:42880
v_mfma_f32_16x16x32_bf16 v[216:219], a[108:111], a[152:155], v[216:219]
ds_read_b64_tr_b16 a[44:45], v16 offset:42400
v_mfma_f32_16x16x32_bf16 v[200:203], a[104:107], a[152:155], v[200:203]
buffer_load_dwordx4 v14, s[32:35], s54 offen offset:2112 lds
v_mfma_f32_16x16x32_bf16 v[204:207], a[104:107], a[156:159], v[204:207]
ds_read_b64_tr_b16 a[46:47], v16 offset:42912
v_mfma_f32_16x16x32_bf16 v[188:191], a[100:103], a[156:159], v[188:191]
ds_read_b64_tr_b16 a[48:49], v17 offset:33792
v_mfma_f32_16x16x32_bf16 v[184:187], a[100:103], a[152:155], v[184:187]
buffer_load_dwordx4 a[136:139], v11, s[16:19], s52 offen sc1
v_mfma_f32_16x16x32_bf16 v[168:171], a[96:99], a[152:155], v[168:171]
ds_read_b64_tr_b16 a[50:51], v17 offset:34304
v_mfma_f32_16x16x32_bf16 v[172:175], a[96:99], a[156:159], v[172:175]
ds_read_b64_tr_b16 a[52:53], v17 offset:33824
v_mfma_f32_16x16x32_bf16 v[156:159], a[92:95], a[156:159], v[156:159]
buffer_load_dwordx4 v15, s[32:35], s54 offen offset:3168 lds
v_mfma_f32_16x16x32_bf16 v[152:155], a[92:95], a[152:155], v[152:155]
s_add_u32 s54, s54, 229376
ds_read_b64_tr_b16 a[54:55], v17 offset:34336
v_mfma_f32_16x16x32_bf16 v[24:27], v[20:23], a[220:223], v[24:27]
ds_read_b64_tr_b16 a[56:57], v17 offset:42240
v_mfma_f32_16x16x32_bf16 v[136:139], a[88:91], a[152:155], v[136:139]
buffer_load_dwordx4 a[140:143], v11, s[16:19], s52 offen offset:1024 sc1
v_mfma_f32_16x16x32_bf16 v[140:143], a[88:91], a[156:159], v[140:143]
s_add_u32 s52, s52, 0x20000
ds_read_b64_tr_b16 a[58:59], v17 offset:42752
v_mfma_f32_16x16x32_bf16 v[124:127], a[84:87], a[156:159], v[124:127]
ds_read_b64_tr_b16 a[60:61], v17 offset:42272
v_mfma_f32_16x16x32_bf16 v[120:123], a[84:87], a[152:155], v[120:123]
ds_read_b64_tr_b16 a[62:63], v17 offset:42784
v_mfma_f32_16x16x32_bf16 v[104:107], a[80:83], a[152:155], v[104:107]
ds_read_b128 a[192:195], v9 offset:33792
v_mfma_f32_16x16x32_bf16 v[108:111], a[80:83], a[156:159], v[108:111]
ds_read_b128 a[196:199], v9 offset:34848
v_mfma_f32_16x16x32_bf16 v[92:95], a[76:79], a[156:159], v[92:95]
ds_read_b128 a[200:203], v9 offset:35904
v_mfma_f32_16x16x32_bf16 v[88:91], a[76:79], a[152:155], v[88:91]
ds_read_b128 a[204:207], v9 offset:36960
v_mfma_f32_16x16x32_bf16 v[72:75], a[72:75], a[152:155], v[72:75]
v_mfma_f32_16x16x32_bf16 v[76:79], a[72:75], a[156:159], v[76:79]
v_mfma_f32_16x16x32_bf16 v[60:63], a[68:71], a[156:159], v[60:63]
v_mfma_f32_16x16x32_bf16 v[56:59], a[68:71], a[152:155], v[56:59]
v_mfma_f32_16x16x32_bf16 v[40:43], a[64:67], a[152:155], v[40:43]
v_mfma_f32_16x16x32_bf16 v[44:47], a[64:67], a[156:159], v[44:47]
s_waitcnt vmcnt(28) lgkmcnt(0)
s_barrier
s_waitcnt vmcnt(27)
v_mfma_f32_16x16x32_bf16 v[32:35], a[0:3], a[160:163], v[32:35]
s_add_u32 m0, s55, 118272
ds_read_b64_tr_b16 a[64:65], v16 offset:50688
s_waitcnt vmcnt(26)
v_mfma_f32_16x16x32_bf16 v[36:39], a[0:3], a[164:167], v[36:39]
buffer_load_dwordx4 v12, s[32:35], s54 offen lds
v_mfma_f32_16x16x32_bf16 v[52:55], a[4:7], a[164:167], v[52:55]
ds_read_b64_tr_b16 a[66:67], v16 offset:51200
v_mfma_f32_16x16x32_bf16 v[48:51], a[4:7], a[160:163], v[48:51]
ds_read_b64_tr_b16 a[68:69], v16 offset:50720
v_mfma_f32_16x16x32_bf16 v[64:67], a[8:11], a[160:163], v[64:67]
ds_read_b64_tr_b16 a[70:71], v16 offset:51232
v_mfma_f32_16x16x32_bf16 v[68:71], a[8:11], a[164:167], v[68:71]
ds_read_b64_tr_b16 a[72:73], v16 offset:59136
v_mfma_f32_16x16x32_bf16 v[24:27], v[20:23], a[192:195], v[24:27]
ds_read_b64_tr_b16 a[74:75], v16 offset:59648
v_mfma_f32_16x16x32_bf16 v[84:87], a[12:15], a[164:167], v[84:87]
ds_read_b64_tr_b16 a[76:77], v16 offset:59168
v_mfma_f32_16x16x32_bf16 v[80:83], a[12:15], a[160:163], v[80:83]
buffer_load_dwordx4 a[144:147], v10, s[16:19], s52 offen sc1
v_mfma_f32_16x16x32_bf16 v[96:99], a[16:19], a[160:163], v[96:99]
ds_read_b64_tr_b16 a[78:79], v16 offset:59680
v_mfma_f32_16x16x32_bf16 v[100:103], a[16:19], a[164:167], v[100:103]
ds_read_b64_tr_b16 a[80:81], v16 offset:50752
v_mfma_f32_16x16x32_bf16 v[116:119], a[20:23], a[164:167], v[116:119]
ds_read_b64_tr_b16 a[82:83], v16 offset:51264
v_mfma_f32_16x16x32_bf16 v[112:115], a[20:23], a[160:163], v[112:115]
ds_read_b64_tr_b16 a[84:85], v16 offset:50784
v_mfma_f32_16x16x32_bf16 v[128:131], a[24:27], a[160:163], v[128:131]
s_waitcnt vmcnt(10)
ds_read_b64 v[28:29], v2
v_mfma_f32_16x16x32_bf16 v[132:135], a[24:27], a[164:167], v[132:135]
ds_read_b64 v[30:31], v2 offset:512
v_mfma_f32_16x16x32_bf16 v[148:151], a[28:31], a[164:167], v[148:151]
ds_read_b64 v[18:19], v2 offset:1024
v_mfma_f32_16x16x32_bf16 v[144:147], a[28:31], a[160:163], v[144:147]
buffer_load_dwordx4 v13, s[32:35], s54 offen offset:1056 lds
v_mfma_f32_16x16x32_bf16 v[160:163], a[32:35], a[160:163], v[160:163]
ds_read_b64_tr_b16 a[86:87], v16 offset:51296
v_mfma_f32_16x16x32_bf16 v[164:167], a[32:35], a[164:167], v[164:167]
ds_read_b64_tr_b16 a[88:89], v16 offset:59200
v_mfma_f32_16x16x32_bf16 v[24:27], v[20:23], a[196:199], v[24:27]
ds_read_b64_tr_b16 a[90:91], v16 offset:59712
v_mfma_f32_16x16x32_bf16 v[180:183], a[36:39], a[164:167], v[180:183]
ds_read_b64_tr_b16 a[92:93], v16 offset:59232
v_mfma_f32_16x16x32_bf16 v[176:179], a[36:39], a[160:163], v[176:179]
ds_read_b64_tr_b16 a[94:95], v16 offset:59744
v_mfma_f32_16x16x32_bf16 v[192:195], a[40:43], a[160:163], v[192:195]
ds_read_b64_tr_b16 a[96:97], v16 offset:50816
s_waitcnt lgkmcnt(7)
v_add_f32 v28, v28, v30
v_mfma_f32_16x16x32_bf16 v[196:199], a[40:43], a[164:167], v[196:199]
buffer_load_dwordx4 a[148:151], v10, s[16:19], s52 offen offset:1024 sc1
v_mfma_f32_16x16x32_bf16 v[212:215], a[44:47], a[164:167], v[212:215]
ds_read_b64_tr_b16 a[98:99], v16 offset:51328
v_add_f32 v29, v29, v31
v_mfma_f32_16x16x32_bf16 v[208:211], a[44:47], a[160:163], v[208:211]
ds_read_b64 v[30:31], v2 offset:1536
s_waitcnt lgkmcnt(8)
v_add_f32 v28, v28, v18
v_mfma_f32_16x16x32_bf16 v[224:227], a[48:51], a[160:163], v[224:227]
ds_read_b64_tr_b16 a[100:101], v16 offset:50848
v_add_f32 v29, v29, v19
v_mfma_f32_16x16x32_bf16 v[228:231], a[48:51], a[164:167], v[228:231]
ds_read_b64 v[18:19], v2 offset:2048
v_mfma_f32_16x16x32_bf16 v[236:239], a[52:55], a[164:167], v[236:239]
ds_read_b64_tr_b16 a[102:103], v16 offset:51360
v_mfma_f32_16x16x32_bf16 v[232:235], a[52:55], a[160:163], v[232:235]
ds_read_b64_tr_b16 a[104:105], v16 offset:59264
v_mfma_f32_16x16x32_bf16 v[240:243], a[56:59], a[160:163], v[240:243]
buffer_load_dwordx4 v14, s[32:35], s54 offen offset:2112 lds
v_mfma_f32_16x16x32_bf16 v[244:247], a[56:59], a[164:167], v[244:247]
ds_read_b64_tr_b16 a[106:107], v16 offset:59776
v_mfma_f32_16x16x32_bf16 v[24:27], v[20:23], a[200:203], v[24:27]
ds_read_b64_tr_b16 a[108:109], v16 offset:59296
v_mfma_f32_16x16x32_bf16 v[252:255], a[60:63], a[164:167], v[252:255]
ds_read_b64_tr_b16 a[110:111], v16 offset:59808
s_waitcnt lgkmcnt(7)
v_add_f32 v28, v28, v30
v_mfma_f32_16x16x32_bf16 v[248:251], a[60:63], a[160:163], v[248:251]
ds_read_b64_tr_b16 a[112:113], v17 offset:50688
v_add_f32 v29, v29, v31
v_mfma_f32_16x16x32_bf16 v[220:223], a[44:47], a[172:175], v[220:223]
ds_read_b64 v[30:31], v2 offset:2560
s_waitcnt lgkmcnt(7)
v_add_f32 v28, v28, v18
v_mfma_f32_16x16x32_bf16 v[216:219], a[44:47], a[168:171], v[216:219]
ds_read_b64_tr_b16 a[114:115], v17 offset:51200
v_add_f32 v29, v29, v19
v_mfma_f32_16x16x32_bf16 v[200:203], a[40:43], a[168:171], v[200:203]
ds_read_b64 v[18:19], v2 offset:3072
v_mfma_f32_16x16x32_bf16 v[204:207], a[40:43], a[172:175], v[204:207]
buffer_load_dwordx4 a[152:155], v11, s[16:19], s52 offen sc1
v_mfma_f32_16x16x32_bf16 v[188:191], a[36:39], a[172:175], v[188:191]
ds_read_b64_tr_b16 a[116:117], v17 offset:50720
v_mfma_f32_16x16x32_bf16 v[184:187], a[36:39], a[168:171], v[184:187]
ds_read_b64_tr_b16 a[118:119], v17 offset:51232
v_mfma_f32_16x16x32_bf16 v[168:171], a[32:35], a[168:171], v[168:171]
ds_read_b64_tr_b16 a[120:121], v17 offset:59136
v_mfma_f32_16x16x32_bf16 v[172:175], a[32:35], a[172:175], v[172:175]
ds_read_b64_tr_b16 a[122:123], v17 offset:59648
v_mfma_f32_16x16x32_bf16 v[156:159], a[28:31], a[172:175], v[156:159]
ds_read_b64_tr_b16 a[124:125], v17 offset:59168
s_waitcnt lgkmcnt(7)
v_add_f32 v28, v28, v30
v_mfma_f32_16x16x32_bf16 v[152:155], a[28:31], a[168:171], v[152:155]
ds_read_b64_tr_b16 a[126:127], v17 offset:59680
v_add_f32 v29, v29, v31
v_mfma_f32_16x16x32_bf16 v[24:27], v[20:23], a[204:207], v[24:27]
ds_read_b64 v[30:31], v2 offset:3584
s_waitcnt lgkmcnt(7)
v_add_f32 v28, v28, v18
v_mfma_f32_16x16x32_bf16 v[136:139], a[24:27], a[168:171], v[136:139]
buffer_load_dwordx4 v15, s[32:35], s54 offen offset:3168 lds
v_mfma_f32_16x16x32_bf16 v[140:143], a[24:27], a[172:175], v[140:143]
s_add_u32 s54, s54, 229376
v_add_f32 v29, v29, v19
v_mfma_f32_16x16x32_bf16 v[124:127], a[20:23], a[172:175], v[124:127]
ds_read_b64 v[18:19], v2 offset:4096
v_mfma_f32_16x16x32_bf16 v[120:123], a[20:23], a[168:171], v[120:123]
ds_read_b128 a[208:211], v9 offset:50688
v_mfma_f32_16x16x32_bf16 v[104:107], a[16:19], a[168:171], v[104:107]
ds_read_b128 a[212:215], v9 offset:51744
v_mfma_f32_16x16x32_bf16 v[108:111], a[16:19], a[172:175], v[108:111]
ds_read_b128 a[216:219], v9 offset:52800
v_mfma_f32_16x16x32_bf16 v[92:95], a[12:15], a[172:175], v[92:95]
ds_read_b128 a[220:223], v9 offset:53856
v_mfma_f32_16x16x32_bf16 v[88:91], a[12:15], a[168:171], v[88:91]
buffer_load_dwordx4 a[156:159], v11, s[16:19], s52 offen offset:1024 sc1
v_mfma_f32_16x16x32_bf16 v[72:75], a[8:11], a[168:171], v[72:75]
s_add_u32 s52, s52, 0x20000
s_waitcnt lgkmcnt(5)
v_add_f32 v28, v28, v30
v_add_f32 v29, v29, v31
v_mfma_f32_16x16x32_bf16 v[76:79], a[8:11], a[172:175], v[76:79]
ds_read_b64 v[30:31], v2 offset:4608
v_mfma_f32_16x16x32_bf16 v[60:63], a[4:7], a[172:175], v[60:63]
s_waitcnt lgkmcnt(5)
v_add_f32 v28, v28, v18
v_add_f32 v29, v29, v19
v_mfma_f32_16x16x32_bf16 v[56:59], a[4:7], a[168:171], v[56:59]
ds_read_b64 v[18:19], v2 offset:5120
v_mfma_f32_16x16x32_bf16 v[40:43], a[0:3], a[168:171], v[40:43]
v_mfma_f32_16x16x32_bf16 v[44:47], a[0:3], a[172:175], v[44:47]
s_waitcnt lgkmcnt(0)
s_barrier
v_mfma_f32_16x16x32_bf16 v[32:35], a[64:67], a[176:179], v[32:35]
s_add_u32 m0, s55, 135168
v_add_f32 v28, v28, v30
v_add_f32 v29, v29, v31
v_mfma_f32_16x16x32_bf16 v[36:39], a[64:67], a[180:183], v[36:39]
ds_read_b64 v[30:31], v2 offset:5632
v_add_f32 v28, v28, v18
v_mfma_f32_16x16x32_bf16 v[52:55], a[68:71], a[180:183], v[52:55]
buffer_load_dwordx4 v12, s[32:35], s54 offen lds
v_mfma_f32_16x16x32_bf16 v[48:51], a[68:71], a[176:179], v[48:51]
ds_read_b64_tr_b16 a[0:1], v16
v_add_f32 v29, v29, v19
v_mfma_f32_16x16x32_bf16 v[64:67], a[72:75], a[176:179], v[64:67]
ds_read_b64 v[18:19], v2 offset:6144
v_mfma_f32_16x16x32_bf16 v[68:71], a[72:75], a[180:183], v[68:71]
ds_read_b64_tr_b16 a[2:3], v16 offset:512
v_mfma_f32_16x16x32_bf16 v[24:27], v[20:23], a[208:211], v[24:27]
ds_read_b64_tr_b16 a[4:5], v16 offset:32
v_mfma_f32_16x16x32_bf16 v[84:87], a[76:79], a[180:183], v[84:87]
ds_read_b64_tr_b16 a[6:7], v16 offset:544
v_mfma_f32_16x16x32_bf16 v[80:83], a[76:79], a[176:179], v[80:83]
ds_read_b64_tr_b16 a[8:9], v16 offset:8448
v_mfma_f32_16x16x32_bf16 v[96:99], a[80:83], a[176:179], v[96:99]
buffer_load_dwordx4 a[160:163], v10, s[16:19], s52 offen sc1
v_mfma_f32_16x16x32_bf16 v[100:103], a[80:83], a[180:183], v[100:103]
ds_read_b64_tr_b16 a[10:11], v16 offset:8960
s_waitcnt lgkmcnt(7)
v_add_f32 v28, v28, v30
v_mfma_f32_16x16x32_bf16 v[116:119], a[84:87], a[180:183], v[116:119]
ds_read_b64_tr_b16 a[12:13], v16 offset:8480
v_add_f32 v29, v29, v31
v_mfma_f32_16x16x32_bf16 v[112:115], a[84:87], a[176:179], v[112:115]
ds_read_b64 v[30:31], v2 offset:6656
s_waitcnt lgkmcnt(7)
v_add_f32 v28, v28, v18
v_mfma_f32_16x16x32_bf16 v[128:131], a[88:91], a[176:179], v[128:131]
ds_read_b64_tr_b16 a[14:15], v16 offset:8992
v_add_f32 v29, v29, v19
v_mfma_f32_16x16x32_bf16 v[132:135], a[88:91], a[180:183], v[132:135]
ds_read_b64 v[18:19], v2 offset:7168
v_mfma_f32_16x16x32_bf16 v[148:151], a[92:95], a[180:183], v[148:151]
ds_read_b64_tr_b16 a[16:17], v16 offset:64
v_mfma_f32_16x16x32_bf16 v[144:147], a[92:95], a[176:179], v[144:147]
buffer_load_dwordx4 v13, s[32:35], s54 offen offset:1056 lds
v_mfma_f32_16x16x32_bf16 v[160:163], a[96:99], a[176:179], v[160:163]
ds_read_b64_tr_b16 a[18:19], v16 offset:576
v_mfma_f32_16x16x32_bf16 v[164:167], a[96:99], a[180:183], v[164:167]
ds_read_b64_tr_b16 a[20:21], v16 offset:96
v_mfma_f32_16x16x32_bf16 v[24:27], v[20:23], a[212:215], v[24:27]
ds_read_b64_tr_b16 a[22:23], v16 offset:608
v_mfma_f32_16x16x32_bf16 v[180:183], a[100:103], a[180:183], v[180:183]
ds_read_b64_tr_b16 a[24:25], v16 offset:8512
s_waitcnt lgkmcnt(7)
v_add_f32 v28, v28, v30
v_mfma_f32_16x16x32_bf16 v[176:179], a[100:103], a[176:179], v[176:179]
ds_read_b64_tr_b16 a[26:27], v16 offset:9024
v_add_f32 v29, v29, v31
v_mfma_f32_16x16x32_bf16 v[192:195], a[104:107], a[176:179], v[192:195]
ds_read_b64 v[30:31], v2 offset:7680
s_waitcnt lgkmcnt(7)
v_add_f32 v28, v28, v18
v_mfma_f32_16x16x32_bf16 v[196:199], a[104:107], a[180:183], v[196:199]
buffer_load_dwordx4 a[164:167], v10, s[16:19], s52 offen offset:1024 sc1
v_mfma_f32_16x16x32_bf16 v[212:215], a[108:111], a[180:183], v[212:215]
ds_read_b64_tr_b16 a[28:29], v16 offset:8544
v_add_f32 v29, v29, v19
v_mfma_f32_16x16x32_bf16 v[208:211], a[108:111], a[176:179], v[208:211]
ds_read_b64_tr_b16 a[30:31], v16 offset:9056
v_lshlrev_b32 v18, 4, v0
v_mfma_f32_16x16x32_bf16 v[224:227], a[112:115], a[176:179], v[224:227]
ds_read_b64_tr_b16 a[32:33], v16 offset:128
v_add_u32 v18, 152576, v18
v_mfma_f32_16x16x32_bf16 v[228:231], a[112:115], a[180:183], v[228:231]
ds_read_b64_tr_b16 a[34:35], v16 offset:640
v_mfma_f32_16x16x32_bf16 v[236:239], a[116:119], a[180:183], v[236:239]
ds_read_b64_tr_b16 a[36:37], v16 offset:160
v_mfma_f32_16x16x32_bf16 v[232:235], a[116:119], a[176:179], v[232:235]
ds_read_b64_tr_b16 a[38:39], v16 offset:672
v_mfma_f32_16x16x32_bf16 v[240:243], a[120:123], a[176:179], v[240:243]
buffer_load_dwordx4 v14, s[32:35], s54 offen offset:2112 lds
v_mfma_f32_16x16x32_bf16 v[244:247], a[120:123], a[180:183], v[244:247]
ds_read_b64_tr_b16 a[40:41], v16 offset:8576
s_waitcnt lgkmcnt(7)
v_add_f32 v28, v28, v30
v_mfma_f32_16x16x32_bf16 v[24:27], v[20:23], a[216:219], v[24:27]
ds_read_b64_tr_b16 a[42:43], v16 offset:9088
v_add_f32 v29, v29, v31
v_mfma_f32_16x16x32_bf16 v[252:255], a[124:127], a[180:183], v[252:255]
ds_read_b64_tr_b16 a[44:45], v16 offset:8608
v_mul_f32 v28, 0xba800000, v28
v_mfma_f32_16x16x32_bf16 v[248:251], a[124:127], a[176:179], v[248:251]
ds_read_b64_tr_b16 a[46:47], v16 offset:9120
v_mul_f32 v29, 0x3a800000, v29
v_mfma_f32_16x16x32_bf16 v[220:223], a[108:111], a[188:191], v[220:223]
ds_read_b64_tr_b16 a[48:49], v17
v_fma_f32 v29, -v28, v28, v29
v_mfma_f32_16x16x32_bf16 v[216:219], a[108:111], a[184:187], v[216:219]
ds_read_b64_tr_b16 a[50:51], v17 offset:512
v_max_f32 v29, 0, v29
v_mfma_f32_16x16x32_bf16 v[200:203], a[104:107], a[184:187], v[200:203]
buffer_load_dwordx4 a[168:171], v11, s[16:19], s52 offen sc1
v_mfma_f32_16x16x32_bf16 v[204:207], a[104:107], a[188:191], v[204:207]
ds_read_b64_tr_b16 a[52:53], v17 offset:32
v_add_f32 v29, 0x3727c5ac, v29
v_mfma_f32_16x16x32_bf16 v[188:191], a[100:103], a[188:191], v[188:191]
ds_read_b64_tr_b16 a[54:55], v17 offset:544
v_rsq_f32 v30, v29
v_mfma_f32_16x16x32_bf16 v[184:187], a[100:103], a[184:187], v[184:187]
ds_read_b64_tr_b16 a[56:57], v17 offset:8448
v_mul_f32 v30, 0xbfb8aa3b, v30
v_mfma_f32_16x16x32_bf16 v[168:171], a[96:99], a[184:187], v[168:171]
ds_write_b128 v18, v[28:31]
v_mfma_f32_16x16x32_bf16 v[172:175], a[96:99], a[188:191], v[172:175]
ds_read_b64_tr_b16 a[58:59], v17 offset:8960
v_mfma_f32_16x16x32_bf16 v[156:159], a[92:95], a[188:191], v[156:159]
ds_read_b64_tr_b16 a[60:61], v17 offset:8480
v_mfma_f32_16x16x32_bf16 v[152:155], a[92:95], a[184:187], v[152:155]
buffer_load_dwordx4 v15, s[32:35], s54 offen offset:3168 lds
v_mfma_f32_16x16x32_bf16 v[24:27], v[20:23], a[220:223], v[24:27]
s_add_u32 s54, s54, 229376
ds_read_b64_tr_b16 a[62:63], v17 offset:8992
v_mfma_f32_16x16x32_bf16 v[136:139], a[88:91], a[184:187], v[136:139]
ds_read_b128 a[192:195], v9
v_mfma_f32_16x16x32_bf16 v[140:143], a[88:91], a[188:191], v[140:143]
ds_read_b128 a[196:199], v9 offset:1056
v_mfma_f32_16x16x32_bf16 v[124:127], a[84:87], a[188:191], v[124:127]
ds_read_b128 a[200:203], v9 offset:2112
v_mfma_f32_16x16x32_bf16 v[120:123], a[84:87], a[184:187], v[120:123]
ds_read_b128 a[204:207], v9 offset:3168
v_mfma_f32_16x16x32_bf16 v[104:107], a[80:83], a[184:187], v[104:107]
v_mfma_f32_16x16x32_bf16 v[108:111], a[80:83], a[188:191], v[108:111]
buffer_load_dwordx4 a[172:175], v11, s[16:19], s52 offen offset:1024 sc1
v_mfma_f32_16x16x32_bf16 v[92:95], a[76:79], a[188:191], v[92:95]
s_add_u32 s52, s52, 0x20000
v_mfma_f32_16x16x32_bf16 v[88:91], a[76:79], a[184:187], v[88:91]
v_mfma_f32_16x16x32_bf16 v[72:75], a[72:75], a[184:187], v[72:75]
v_mfma_f32_16x16x32_bf16 v[76:79], a[72:75], a[188:191], v[76:79]
v_mfma_f32_16x16x32_bf16 v[60:63], a[68:71], a[188:191], v[60:63]
v_mfma_f32_16x16x32_bf16 v[56:59], a[68:71], a[184:187], v[56:59]
v_mfma_f32_16x16x32_bf16 v[40:43], a[64:67], a[184:187], v[40:43]
v_mfma_f32_16x16x32_bf16 v[44:47], a[64:67], a[188:191], v[44:47]
s_mov_b32 s58, -131072
s_sub_u32 s67, s59, 16896
s_mov_b32 s15, -6
.p2align 6
.Lk42:
s_waitcnt vmcnt(17) lgkmcnt(0)
s_barrier
v_mfma_f32_16x16x32_bf16 v[32:35], a[0:3], a[128:131], v[32:35]
ds_read_b64_tr_b16 a[64:65], v16 offset:16896
s_add_u32 m0, s55, 84480
v_mfma_f32_16x16x32_bf16 v[36:39], a[0:3], a[132:135], v[36:39]
buffer_load_dwordx4 v12, s[32:35], s54 offen lds
v_mfma_f32_16x16x32_bf16 v[52:55], a[4:7], a[132:135], v[52:55]
s_sub_u32 s47, s47, 1
s_cbranch_scc1 .Lx43
.Lx43b:
v_mfma_f32_16x16x32_bf16 v[48:51], a[4:7], a[128:131], v[48:51]
ds_read_b64_tr_b16 a[66:67], v16 offset:17408
v_mfma_f32_16x16x32_bf16 v[64:67], a[8:11], a[128:131], v[64:67]
ds_read_b64_tr_b16 a[68:69], v16 offset:16928
v_mfma_f32_16x16x32_bf16 v[68:71], a[8:11], a[132:135], v[68:71]
ds_read_b64_tr_b16 a[70:71], v16 offset:17440
v_mfma_f32_16x16x32_bf16 v[24:27], v[20:23], a[192:195], v[24:27]
v_mfma_f32_16x16x32_bf16 v[84:87], a[12:15], a[132:135], v[84:87]
buffer_load_dwordx4 a[176:179], v10, s[16:19], s52 offen sc1
v_mfma_f32_16x16x32_bf16 v[80:83], a[12:15], a[128:131], v[80:83]
ds_read_b64_tr_b16 a[72:73], v16 offset:25344
v_mfma_f32_16x16x32_bf16 v[96:99], a[16:19], a[128:131], v[96:99]
ds_read_b64_tr_b16 a[74:75], v16 offset:25856
v_mfma_f32_16x16x32_bf16 v[100:103], a[16:19], a[132:135], v[100:103]
ds_read_b64_tr_b16 a[76:77], v16 offset:25376
v_mfma_f32_16x16x32_bf16 v[116:119], a[20:23], a[132:135], v[116:119]
ds_read_b64_tr_b16 a[78:79], v16 offset:25888
v_mfma_f32_16x16x32_bf16 v[112:115], a[20:23], a[128:131], v[112:115]
v_mfma_f32_16x16x32_bf16 v[128:131], a[24:27], a[128:131], v[128:131]
buffer_load_dwordx4 v13, s[32:35], s54 offen offset:1056 lds
v_mfma_f32_16x16x32_bf16 v[132:135], a[24:27], a[132:135], v[132:135]
ds_read_b64_tr_b16 a[80:81], v16 offset:16960
v_mfma_f32_16x16x32_bf16 v[148:151], a[28:31], a[132:135], v[148:151]
ds_read_b64_tr_b16 a[82:83], v16 offset:17472
v_mfma_f32_16x16x32_bf16 v[144:147], a[28:31], a[128:131], v[144:147]
ds_read_b64_tr_b16 a[84:85], v16 offset:16992
v_mfma_f32_16x16x32_bf16 v[160:163], a[32:35], a[128:131], v[160:163]
ds_read_b64_tr_b16 a[86:87], v16 offset:17504
v_mfma_f32_16x16x32_bf16 v[164:167], a[32:35], a[132:135], v[164:167]
v_mfma_f32_16x16x32_bf16 v[24:27], v[20:23], a[196:199], v[24:27]
ds_read_b64_tr_b16 a[88:89], v16 offset:25408
v_mfma_f32_16x16x32_bf16 v[180:183], a[36:39], a[132:135], v[180:183]
buffer_load_dwordx4 a[180:183], v10, s[16:19], s52 offen offset:1024 sc1
v_mfma_f32_16x16x32_bf16 v[176:179], a[36:39], a[128:131], v[176:179]
ds_read_b64_tr_b16 a[90:91], v16 offset:25920
v_mfma_f32_16x16x32_bf16 v[192:195], a[40:43], a[128:131], v[192:195]
ds_read_b64_tr_b16 a[92:93], v16 offset:25440
v_mfma_f32_16x16x32_bf16 v[196:199], a[40:43], a[132:135], v[196:199]
ds_read_b64_tr_b16 a[94:95], v16 offset:25952
v_mfma_f32_16x16x32_bf16 v[212:215], a[44:47], a[132:135], v[212:215]
v_mfma_f32_16x16x32_bf16 v[208:211], a[44:47], a[128:131], v[208:211]
ds_read_b64_tr_b16 a[96:97], v16 offset:17024
v_mfma_f32_16x16x32_bf16 v[224:227], a[48:51], a[128:131], v[224:227]
buffer_load_dwordx4 v14, s[32:35], s54 offen offset:2112 lds
v_mfma_f32_16x16x32_bf16 v[228:231], a[48:51], a[132:135], v[228:231]
ds_read_b64_tr_b16 a[98:99], v16 offset:17536
v_mfma_f32_16x16x32_bf16 v[236:239], a[52:55], a[132:135], v[236:239]
ds_read_b64_tr_b16 a[100:101], v16 offset:17056
.Lpad3:
s_cbranch_execz .Lpad6
v_mfma_f32_16x16x32_bf16 v[232:235], a[52:55], a[128:131], v[232:235]
ds_read_b64_tr_b16 a[102:103], v16 offset:17568
v_mfma_f32_16x16x32_bf16 v[240:243], a[56:59], a[128:131], v[240:243]
v_mfma_f32_16x16x32_bf16 v[244:247], a[56:59], a[132:135], v[244:247]
ds_read_b64_tr_b16 a[104:105], v16 offset:25472
v_mfma_f32_16x16x32_bf16 v[24:27], v[20:23], a[200:203], v[24:27]
ds_read_b64_tr_b16 a[106:107], v16 offset:25984
v_mfma_f32_16x16x32_bf16 v[252:255], a[60:63], a[132:135], v[252:255]
buffer_load_dwordx4 a[184:187], v11, s[16:19], s52 offen sc1
v_mfma_f32_16x16x32_bf16 v[248:251], a[60:63], a[128:131], v[248:251]
ds_read_b64_tr_b16 a[108:109], v16 offset:25504
s_waitcnt vmcnt(22)
v_mfma_f32_16x16x32_bf16 v[220:223], a[44:47], a[140:143], v[220:223]
ds_read_b64_tr_b16 a[110:111], v16 offset:26016
v_mfma_f32_16x16x32_bf16 v[216:219], a[44:47], a[136:139], v[216:219]
v_mfma_f32_16x16x32_bf16 v[200:203], a[40:43], a[136:139], v[200:203]
ds_read_b64_tr_b16 a[112:113], v17 offset:16896
v_mfma_f32_16x16x32_bf16 v[204:207], a[40:43], a[140:143], v[204:207]
ds_read_b64_tr_b16 a[114:115], v17 offset:17408
v_mfma_f32_16x16x32_bf16 v[188:191], a[36:39], a[140:143], v[188:191]
buffer_load_dwordx4 v15, s[32:35], s54 offen offset:3168 lds
v_mfma_f32_16x16x32_bf16 v[184:187], a[36:39], a[136:139], v[184:187]
ds_read_b64_tr_b16 a[116:117], v17 offset:16928
s_add_u32 s54, s54, 229376
v_mfma_f32_16x16x32_bf16 v[168:171], a[32:35], a[136:139], v[168:171]
ds_read_b64_tr_b16 a[118:119], v17 offset:17440
v_mfma_f32_16x16x32_bf16 v[172:175], a[32:35], a[140:143], v[172:175]
v_mfma_f32_16x16x32_bf16 v[156:159], a[28:31], a[140:143], v[156:159]
ds_read_b64_tr_b16 a[120:121], v17 offset:25344
v_mfma_f32_16x16x32_bf16 v[152:155], a[28:31], a[136:139], v[152:155]
ds_read_b64_tr_b16 a[122:123], v17 offset:25856
v_mfma_f32_16x16x32_bf16 v[24:27], v[20:23], a[204:207], v[24:27]
ds_read_b64_tr_b16 a[124:125], v17 offset:25376
v_mfma_f32_16x16x32_bf16 v[136:139], a[24:27], a[136:139], v[136:139]
buffer_load_dwordx4 a[188:191], v11, s[16:19], s52 offen offset:1024 sc1
v_mfma_f32_16x16x32_bf16 v[140:143], a[24:27], a[140:143], v[140:143]
ds_read_b64_tr_b16 a[126:127], v17 offset:25888
s_add_u32 s52, s52, 0x20000
v_mfma_f32_16x16x32_bf16 v[124:127], a[20:23], a[140:143], v[124:127]
v_mfma_f32_16x16x32_bf16 v[120:123], a[20:23], a[136:139], v[120:123]
ds_read_b128 a[208:211], v9 offset:16896
v_mfma_f32_16x16x32_bf16 v[104:107], a[16:19], a[136:139], v[104:107]
ds_read_b128 a[212:215], v9 offset:17952
v_mfma_f32_16x16x32_bf16 v[108:111], a[16:19], a[140:143], v[108:111]
ds_read_b128 a[216:219], v9 offset:19008
s_max_i32 m0, s67, s59
v_mfma_f32_16x16x32_bf16 v[92:95], a[12:15], a[140:143], v[92:95]
buffer_load_dwordx4 v5, s[28:31], s58 offen lds
v_mfma_f32_16x16x32_bf16 v[88:91], a[12:15], a[136:139], v[88:91]
ds_read_b128 a[220:223], v9 offset:20064
v_mfma_f32_16x16x32_bf16 v[72:75], a[8:11], a[136:139], v[72:75]
v_mfma_f32_16x16x32_bf16 v[76:79], a[8:11], a[140:143], v[76:79]
v_mfma_f32_16x16x32_bf16 v[60:63], a[4:7], a[140:143], v[60:63]
v_mfma_f32_16x16x32_bf16 v[56:59], a[4:7], a[136:139], v[56:59]
v_mfma_f32_16x16x32_bf16 v[40:43], a[0:3], a[136:139], v[40:43]
v_mfma_f32_16x16x32_bf16 v[44:47], a[0:3], a[140:143], v[44:47]
s_waitcnt vmcnt(18) lgkmcnt(0)
s_barrier
v_mfma_f32_16x16x32_bf16 v[32:35], a[64:67], a[144:147], v[32:35]
ds_read_b64_tr_b16 a[0:1], v16 offset:33792
s_add_u32 m0, s55, 101376
v_mfma_f32_16x16x32_bf16 v[36:39], a[64:67], a[148:151], v[36:39]
buffer_load_dwordx4 v12, s[32:35], s54 offen lds
v_mfma_f32_16x16x32_bf16 v[52:55], a[68:71], a[148:151], v[52:55]
s_sub_u32 s47, s47, 1
s_cbranch_scc1 .Lx44
.Lx44b:
v_mfma_f32_16x16x32_bf16 v[48:51], a[68:71], a[144:147], v[48:51]
ds_read_b64_tr_b16 a[2:3], v16 offset:34304
v_mfma_f32_16x16x32_bf16 v[64:67], a[72:75], a[144:147], v[64:67]
ds_read_b64_tr_b16 a[4:5], v16 offset:33824
v_mfma_f32_16x16x32_bf16 v[68:71], a[72:75], a[148:151], v[68:71]
ds_read_b64_tr_b16 a[6:7], v16 offset:34336
v_mfma_f32_16x16x32_bf16 v[24:27], v[20:23], a[208:211], v[24:27]
ds_read_b64_tr_b16 a[8:9], v16 offset:42240
v_mfma_f32_16x16x32_bf16 v[84:87], a[76:79], a[148:151], v[84:87]
buffer_load_dwordx4 a[128:131], v10, s[16:19], s52 offen sc1
v_mfma_f32_16x16x32_bf16 v[80:83], a[76:79], a[144:147], v[80:83]
v_mfma_f32_16x16x32_bf16 v[96:99], a[80:83], a[144:147], v[96:99]
ds_read_b64_tr_b16 a[10:11], v16 offset:42752
v_mfma_f32_16x16x32_bf16 v[100:103], a[80:83], a[148:151], v[100:103]
ds_read_b64_tr_b16 a[12:13], v16 offset:42272
v_mfma_f32_16x16x32_bf16 v[116:119], a[84:87], a[148:151], v[116:119]
ds_read_b64_tr_b16 a[14:15], v16 offset:42784
v_mfma_f32_16x16x32_bf16 v[112:115], a[84:87], a[144:147], v[112:115]
ds_read_b64_tr_b16 a[16:17], v16 offset:33856
v_mfma_f32_16x16x32_bf16 v[128:131], a[88:91], a[144:147], v[128:131]
buffer_load_dwordx4 v13, s[32:35], s54 offen offset:1056 lds
v_mfma_f32_16x16x32_bf16 v[132:135], a[88:91], a[148:151], v[132:135]
v_mfma_f32_16x16x32_bf16 v[148:151], a[92:95], a[148:151], v[148:151]
ds_read_b64_tr_b16 a[18:19], v16 offset:34368
v_mfma_f32_16x16x32_bf16 v[144:147], a[92:95], a[144:147], v[144:147]
ds_read_b64_tr_b16 a[20:21], v16 offset:33888
v_mfma_f32_16x16x32_bf16 v[160:163], a[96:99], a[144:147], v[160:163]
ds_read_b64_tr_b16 a[22:23], v16 offset:34400
v_mfma_f32_16x16x32_bf16 v[164:167], a[96:99], a[148:151], v[164:167]
ds_read_b64_tr_b16 a[24:25], v16 offset:42304
v_mfma_f32_16x16x32_bf16 v[24:27], v[20:23], a[212:215], v[24:27]
ds_read_b64_tr_b16 a[26:27], v16 offset:42816
v_mfma_f32_16x16x32_bf16 v[180:183], a[100:103], a[148:151], v[180:183]
buffer_load_dwordx4 a[132:135], v10, s[16:19], s52 offen offset:1024 sc1
v_mfma_f32_16x16x32_bf16 v[176:179], a[100:103], a[144:147], v[176:179]
v_mfma_f32_16x16x32_bf16 v[192:195], a[104:107], a[144:147], v[192:195]
ds_read_b64_tr_b16 a[28:29], v16 offset:42336
v_mfma_f32_16x16x32_bf16 v[196:199], a[104:107], a[148:151], v[196:199]
ds_read_b64_tr_b16 a[30:31], v16 offset:42848
v_mfma_f32_16x16x32_bf16 v[212:215], a[108:111], a[148:151], v[212:215]
ds_read_b64_tr_b16 a[32:33], v16 offset:33920
v_mfma_f32_16x16x32_bf16 v[208:211], a[108:111], a[144:147], v[208:211]
ds_read_b64_tr_b16 a[34:35], v16 offset:34432
v_mfma_f32_16x16x32_bf16 v[224:227], a[112:115], a[144:147], v[224:227]
buffer_load_dwordx4 v14, s[32:35], s54 offen offset:2112 lds
v_mfma_f32_16x16x32_bf16 v[228:231], a[112:115], a[148:151], v[228:231]
v_mfma_f32_16x16x32_bf16 v[236:239], a[116:119], a[148:151], v[236:239]
ds_read_b64_tr_b16 a[36:37], v16 offset:33952
v_mfma_f32_16x16x32_bf16 v[232:235], a[116:119], a[144:147], v[232:235]
ds_read_b64_tr_b16 a[38:39], v16 offset:34464
v_mfma_f32_16x16x32_bf16 v[240:243], a[120:123], a[144:147], v[240:243]
ds_read_b64_tr_b16 a[40:41], v16 offset:42368
v_mfma_f32_16x16x32_bf16 v[244:247], a[120:123], a[148:151], v[244:247]
ds_read_b64_tr_b16 a[42:43], v16 offset:42880
v_mfma_f32_16x16x32_bf16 v[24:27], v[20:23], a[216:219], v[24:27]
ds_read_b64_tr_b16 a[44:45], v16 offset:42400
v_mfma_f32_16x16x32_bf16 v[252:255], a[124:127], a[148:151], v[252:255]
buffer_load_dwordx4 a[136:139], v11, s[16:19], s52 offen sc1
v_mfma_f32_16x16x32_bf16 v[248:251], a[124:127], a[144:147], v[248:251]
s_waitcnt vmcnt(23)
v_mfma_f32_16x16x32_bf16 v[220:223], a[108:111], a[156:159], v[220:223]
ds_read_b64_tr_b16 a[46:47], v16 offset:42912
v_mfma_f32_16x16x32_bf16 v[216:219], a[108:111], a[152:155], v[216:219]
ds_read_b64_tr_b16 a[48:49], v17 offset:33792
v_mfma_f32_16x16x32_bf16 v[200:203], a[104:107], a[152:155], v[200:203]
ds_read_b64_tr_b16 a[50:51], v17 offset:34304
v_mfma_f32_16x16x32_bf16 v[204:207], a[104:107], a[156:159], v[204:207]
ds_read_b64_tr_b16 a[52:53], v17 offset:33824
v_mfma_f32_16x16x32_bf16 v[188:191], a[100:103], a[156:159], v[188:191]
buffer_load_dwordx4 v15, s[32:35], s54 offen offset:3168 lds
v_mfma_f32_16x16x32_bf16 v[184:187], a[100:103], a[152:155], v[184:187]
s_add_u32 s54, s54, 229376
v_mfma_f32_16x16x32_bf16 v[168:171], a[96:99], a[152:155], v[168:171]
ds_read_b64_tr_b16 a[54:55], v17 offset:34336
v_mfma_f32_16x16x32_bf16 v[172:175], a[96:99], a[156:159], v[172:175]
ds_read_b64_tr_b16 a[56:57], v17 offset:42240
v_mfma_f32_16x16x32_bf16 v[156:159], a[92:95], a[156:159], v[156:159]
ds_read_b64_tr_b16 a[58:59], v17 offset:42752
v_mfma_f32_16x16x32_bf16 v[152:155], a[92:95], a[152:155], v[152:155]
ds_read_b64_tr_b16 a[60:61], v17 offset:42272
v_mfma_f32_16x16x32_bf16 v[24:27], v[20:23], a[220:223], v[24:27]
ds_read_b64_tr_b16 a[62:63], v17 offset:42784
v_mfma_f32_16x16x32_bf16 v[136:139], a[88:91], a[152:155], v[136:139]
buffer_load_dwordx4 a[140:143], v11, s[16:19], s52 offen offset:1024 sc1
v_mfma_f32_16x16x32_bf16 v[140:143], a[88:91], a[156:159], v[140:143]
s_add_u32 s52, s52, 0x20000
v_mfma_f32_16x16x32_bf16 v[124:127], a[84:87], a[156:159], v[124:127]
ds_read_b128 a[192:195], v9 offset:33792
v_mfma_f32_16x16x32_bf16 v[120:123], a[84:87], a[152:155], v[120:123]
ds_read_b128 a[196:199], v9 offset:34848
v_mfma_f32_16x16x32_bf16 v[104:107], a[80:83], a[152:155], v[104:107]
ds_read_b128 a[200:203], v9 offset:35904
v_mfma_f32_16x16x32_bf16 v[108:111], a[80:83], a[156:159], v[108:111]
ds_read_b128 a[204:207], v9 offset:36960
s_max_i32 m0, s67, s59
v_mfma_f32_16x16x32_bf16 v[92:95], a[76:79], a[156:159], v[92:95]
buffer_load_dwordx4 v6, s[28:31], s58 offen offset:1056 lds
v_mfma_f32_16x16x32_bf16 v[88:91], a[76:79], a[152:155], v[88:91]
s_add_u32 s67, s67, 8448
s_add_u32 s58, s58, 0x10000
v_mfma_f32_16x16x32_bf16 v[72:75], a[72:75], a[152:155], v[72:75]
v_mfma_f32_16x16x32_bf16 v[76:79], a[72:75], a[156:159], v[76:79]
v_mfma_f32_16x16x32_bf16 v[60:63], a[68:71], a[156:159], v[60:63]
v_mfma_f32_16x16x32_bf16 v[56:59], a[68:71], a[152:155], v[56:59]
v_mfma_f32_16x16x32_bf16 v[40:43], a[64:67], a[152:155], v[40:43]
v_mfma_f32_16x16x32_bf16 v[44:47], a[64:67], a[156:159], v[44:47]
s_waitcnt vmcnt(19) lgkmcnt(0)
s_barrier
v_mfma_f32_16x16x32_bf16 v[32:35], a[0:3], a[160:163], v[32:35]
ds_read_b64_tr_b16 a[64:65], v16 offset:50688
s_add_u32 m0, s55, 118272
v_mfma_f32_16x16x32_bf16 v[36:39], a[0:3], a[164:167], v[36:39]
buffer_load_dwordx4 v12, s[32:35], s54 offen lds
v_mfma_f32_16x16x32_bf16 v[52:55], a[4:7], a[164:167], v[52:55]
s_sub_u32 s47, s47, 1
s_cbranch_scc1 .Lx45
.Lx45b:
v_mfma_f32_16x16x32_bf16 v[48:51], a[4:7], a[160:163], v[48:51]
ds_read_b64_tr_b16 a[66:67], v16 offset:51200
v_mfma_f32_16x16x32_bf16 v[64:67], a[8:11], a[160:163], v[64:67]
ds_read_b64_tr_b16 a[68:69], v16 offset:50720
v_mfma_f32_16x16x32_bf16 v[68:71], a[8:11], a[164:167], v[68:71]
ds_read_b64_tr_b16 a[70:71], v16 offset:51232
v_mfma_f32_16x16x32_bf16 v[24:27], v[20:23], a[192:195], v[24:27]
v_mfma_f32_16x16x32_bf16 v[84:87], a[12:15], a[164:167], v[84:87]
buffer_load_dwordx4 a[144:147], v10, s[16:19], s52 offen sc1
v_mfma_f32_16x16x32_bf16 v[80:83], a[12:15], a[160:163], v[80:83]
ds_read_b64_tr_b16 a[72:73], v16 offset:59136
v_mfma_f32_16x16x32_bf16 v[96:99], a[16:19], a[160:163], v[96:99]
ds_read_b64_tr_b16 a[74:75], v16 offset:59648
v_mfma_f32_16x16x32_bf16 v[100:103], a[16:19], a[164:167], v[100:103]
ds_read_b64_tr_b16 a[76:77], v16 offset:59168
v_mfma_f32_16x16x32_bf16 v[116:119], a[20:23], a[164:167], v[116:119]
ds_read_b64_tr_b16 a[78:79], v16 offset:59680
v_mfma_f32_16x16x32_bf16 v[112:115], a[20:23], a[160:163], v[112:115]
v_mfma_f32_16x16x32_bf16 v[128:131], a[24:27], a[160:163], v[128:131]
buffer_load_dwordx4 v13, s[32:35], s54 offen offset:1056 lds
v_mfma_f32_16x16x32_bf16 v[132:135], a[24:27], a[164:167], v[132:135]
ds_read_b64_tr_b16 a[80:81], v16 offset:50752
v_mfma_f32_16x16x32_bf16 v[148:151], a[28:31], a[164:167], v[148:151]
ds_read_b64_tr_b16 a[82:83], v16 offset:51264
v_mfma_f32_16x16x32_bf16 v[144:147], a[28:31], a[160:163], v[144:147]
ds_read_b64_tr_b16 a[84:85], v16 offset:50784
v_mfma_f32_16x16x32_bf16 v[160:163], a[32:35], a[160:163], v[160:163]
ds_read_b64_tr_b16 a[86:87], v16 offset:51296
v_mfma_f32_16x16x32_bf16 v[164:167], a[32:35], a[164:167], v[164:167]
v_mfma_f32_16x16x32_bf16 v[24:27], v[20:23], a[196:199], v[24:27]
ds_read_b64_tr_b16 a[88:89], v16 offset:59200
v_mfma_f32_16x16x32_bf16 v[180:183], a[36:39], a[164:167], v[180:183]
buffer_load_dwordx4 a[148:151], v10, s[16:19], s52 offen offset:1024 sc1
v_mfma_f32_16x16x32_bf16 v[176:179], a[36:39], a[160:163], v[176:179]
ds_read_b64_tr_b16 a[90:91], v16 offset:59712
v_mfma_f32_16x16x32_bf16 v[192:195], a[40:43], a[160:163], v[192:195]
ds_read_b64_tr_b16 a[92:93], v16 offset:59232
v_mfma_f32_16x16x32_bf16 v[196:199], a[40:43], a[164:167], v[196:199]
ds_read_b64_tr_b16 a[94:95], v16 offset:59744
v_mfma_f32_16x16x32_bf16 v[212:215], a[44:47], a[164:167], v[212:215]
v_mfma_f32_16x16x32_bf16 v[208:211], a[44:47], a[160:163], v[208:211]
ds_read_b64_tr_b16 a[96:97], v16 offset:50816
v_mfma_f32_16x16x32_bf16 v[224:227], a[48:51], a[160:163], v[224:227]
buffer_load_dwordx4 v14, s[32:35], s54 offen offset:2112 lds
v_mfma_f32_16x16x32_bf16 v[228:231], a[48:51], a[164:167], v[228:231]
ds_read_b64_tr_b16 a[98:99], v16 offset:51328
v_mfma_f32_16x16x32_bf16 v[236:239], a[52:55], a[164:167], v[236:239]
ds_read_b64_tr_b16 a[100:101], v16 offset:50848
v_mfma_f32_16x16x32_bf16 v[232:235], a[52:55], a[160:163], v[232:235]
ds_read_b64_tr_b16 a[102:103], v16 offset:51360
v_mfma_f32_16x16x32_bf16 v[240:243], a[56:59], a[160:163], v[240:243]
v_mfma_f32_16x16x32_bf16 v[244:247], a[56:59], a[164:167], v[244:247]
ds_read_b64_tr_b16 a[104:105], v16 offset:59264
v_mfma_f32_16x16x32_bf16 v[24:27], v[20:23], a[200:203], v[24:27]
ds_read_b64_tr_b16 a[106:107], v16 offset:59776
v_mfma_f32_16x16x32_bf16 v[252:255], a[60:63], a[164:167], v[252:255]
buffer_load_dwordx4 a[152:155], v11, s[16:19], s52 offen sc1
v_mfma_f32_16x16x32_bf16 v[248:251], a[60:63], a[160:163], v[248:251]
ds_read_b64_tr_b16 a[108:109], v16 offset:59296
s_waitcnt vmcnt(24)
v_mfma_f32_16x16x32_bf16 v[220:223], a[44:47], a[172:175], v[220:223]
ds_read_b64_tr_b16 a[110:111], v16 offset:59808
v_mfma_f32_16x16x32_bf16 v[216:219], a[44:47], a[168:171], v[216:219]
v_mfma_f32_16x16x32_bf16 v[200:203], a[40:43], a[168:171], v[200:203]
ds_read_b64_tr_b16 a[112:113], v17 offset:50688
v_mfma_f32_16x16x32_bf16 v[204:207], a[40:43], a[172:175], v[204:207]
ds_read_b64_tr_b16 a[114:115], v17 offset:51200
v_mfma_f32_16x16x32_bf16 v[188:191], a[36:39], a[172:175], v[188:191]
buffer_load_dwordx4 v15, s[32:35], s54 offen offset:3168 lds
v_mfma_f32_16x16x32_bf16 v[184:187], a[36:39], a[168:171], v[184:187]
ds_read_b64_tr_b16 a[116:117], v17 offset:50720
s_add_u32 s54, s54, 229376
v_mfma_f32_16x16x32_bf16 v[168:171], a[32:35], a[168:171], v[168:171]
ds_read_b64_tr_b16 a[118:119], v17 offset:51232
v_mfma_f32_16x16x32_bf16 v[172:175], a[32:35], a[172:175], v[172:175]
v_mfma_f32_16x16x32_bf16 v[156:159], a[28:31], a[172:175], v[156:159]
ds_read_b64_tr_b16 a[120:121], v17 offset:59136
v_mfma_f32_16x16x32_bf16 v[152:155], a[28:31], a[168:171], v[152:155]
ds_read_b64_tr_b16 a[122:123], v17 offset:59648
v_mfma_f32_16x16x32_bf16 v[24:27], v[20:23], a[204:207], v[24:27]
ds_read_b64_tr_b16 a[124:125], v17 offset:59168
v_mfma_f32_16x16x32_bf16 v[136:139], a[24:27], a[168:171], v[136:139]
buffer_load_dwordx4 a[156:159], v11, s[16:19], s52 offen offset:1024 sc1
v_mfma_f32_16x16x32_bf16 v[140:143], a[24:27], a[172:175], v[140:143]
ds_read_b64_tr_b16 a[126:127], v17 offset:59680
s_add_u32 s52, s52, 0x20000
v_mfma_f32_16x16x32_bf16 v[124:127], a[20:23], a[172:175], v[124:127]
v_mfma_f32_16x16x32_bf16 v[120:123], a[20:23], a[168:171], v[120:123]
ds_read_b128 a[208:211], v9 offset:50688
v_mfma_f32_16x16x32_bf16 v[104:107], a[16:19], a[168:171], v[104:107]
ds_read_b128 a[212:215], v9 offset:51744
v_mfma_f32_16x16x32_bf16 v[108:111], a[16:19], a[172:175], v[108:111]
ds_read_b128 a[216:219], v9 offset:52800
s_max_i32 m0, s67, s59
v_mfma_f32_16x16x32_bf16 v[92:95], a[12:15], a[172:175], v[92:95]
buffer_load_dwordx4 v5, s[28:31], s58 offen lds
v_mfma_f32_16x16x32_bf16 v[88:91], a[12:15], a[168:171], v[88:91]
ds_read_b128 a[220:223], v9 offset:53856
v_mfma_f32_16x16x32_bf16 v[72:75], a[8:11], a[168:171], v[72:75]
v_mfma_f32_16x16x32_bf16 v[76:79], a[8:11], a[172:175], v[76:79]
v_mfma_f32_16x16x32_bf16 v[60:63], a[4:7], a[172:175], v[60:63]
v_mfma_f32_16x16x32_bf16 v[56:59], a[4:7], a[168:171], v[56:59]
v_mfma_f32_16x16x32_bf16 v[40:43], a[0:3], a[168:171], v[40:43]
v_mfma_f32_16x16x32_bf16 v[44:47], a[0:3], a[172:175], v[44:47]
s_waitcnt vmcnt(20) lgkmcnt(0)
s_barrier
v_mfma_f32_16x16x32_bf16 v[32:35], a[64:67], a[176:179], v[32:35]
ds_read_b64_tr_b16 a[0:1], v16
s_add_u32 m0, s55, 135168
v_mfma_f32_16x16x32_bf16 v[36:39], a[64:67], a[180:183], v[36:39]
buffer_load_dwordx4 v12, s[32:35], s54 offen lds
v_mfma_f32_16x16x32_bf16 v[52:55], a[68:71], a[180:183], v[52:55]
s_sub_u32 s47, s47, 1
s_cbranch_scc1 .Lx46
.Lx46b:
v_mfma_f32_16x16x32_bf16 v[48:51], a[68:71], a[176:179], v[48:51]
ds_read_b64_tr_b16 a[2:3], v16 offset:512
v_mfma_f32_16x16x32_bf16 v[64:67], a[72:75], a[176:179], v[64:67]
ds_read_b64_tr_b16 a[4:5], v16 offset:32
v_mfma_f32_16x16x32_bf16 v[68:71], a[72:75], a[180:183], v[68:71]
ds_read_b64_tr_b16 a[6:7], v16 offset:544
v_mfma_f32_16x16x32_bf16 v[24:27], v[20:23], a[208:211], v[24:27]
ds_read_b64_tr_b16 a[8:9], v16 offset:8448
v_mfma_f32_16x16x32_bf16 v[84:87], a[76:79], a[180:183], v[84:87]
buffer_load_dwordx4 a[160:163], v10, s[16:19], s52 offen sc1
v_mfma_f32_16x16x32_bf16 v[80:83], a[76:79], a[176:179], v[80:83]
v_mfma_f32_16x16x32_bf16 v[96:99], a[80:83], a[176:179], v[96:99]
ds_read_b64_tr_b16 a[10:11], v16 offset:8960
v_mfma_f32_16x16x32_bf16 v[100:103], a[80:83], a[180:183], v[100:103]
ds_read_b64_tr_b16 a[12:13], v16 offset:8480
v_mfma_f32_16x16x32_bf16 v[116:119], a[84:87], a[180:183], v[116:119]
ds_read_b64_tr_b16 a[14:15], v16 offset:8992
v_mfma_f32_16x16x32_bf16 v[112:115], a[84:87], a[176:179], v[112:115]
ds_read_b64_tr_b16 a[16:17], v16 offset:64
v_mfma_f32_16x16x32_bf16 v[128:131], a[88:91], a[176:179], v[128:131]
buffer_load_dwordx4 v13, s[32:35], s54 offen offset:1056 lds
v_mfma_f32_16x16x32_bf16 v[132:135], a[88:91], a[180:183], v[132:135]
v_mfma_f32_16x16x32_bf16 v[148:151], a[92:95], a[180:183], v[148:151]
ds_read_b64_tr_b16 a[18:19], v16 offset:576
v_mfma_f32_16x16x32_bf16 v[144:147], a[92:95], a[176:179], v[144:147]
ds_read_b64_tr_b16 a[20:21], v16 offset:96
v_mfma_f32_16x16x32_bf16 v[160:163], a[96:99], a[176:179], v[160:163]
ds_read_b64_tr_b16 a[22:23], v16 offset:608
v_mfma_f32_16x16x32_bf16 v[164:167], a[96:99], a[180:183], v[164:167]
ds_read_b64_tr_b16 a[24:25], v16 offset:8512
v_mfma_f32_16x16x32_bf16 v[24:27], v[20:23], a[212:215], v[24:27]
ds_read_b64_tr_b16 a[26:27], v16 offset:9024
v_mfma_f32_16x16x32_bf16 v[180:183], a[100:103], a[180:183], v[180:183]
buffer_load_dwordx4 a[164:167], v10, s[16:19], s52 offen offset:1024 sc1
v_mfma_f32_16x16x32_bf16 v[176:179], a[100:103], a[176:179], v[176:179]
v_mfma_f32_16x16x32_bf16 v[192:195], a[104:107], a[176:179], v[192:195]
ds_read_b64_tr_b16 a[28:29], v16 offset:8544
v_mfma_f32_16x16x32_bf16 v[196:199], a[104:107], a[180:183], v[196:199]
ds_read_b64_tr_b16 a[30:31], v16 offset:9056
v_mfma_f32_16x16x32_bf16 v[212:215], a[108:111], a[180:183], v[212:215]
ds_read_b64_tr_b16 a[32:33], v16 offset:128
v_mfma_f32_16x16x32_bf16 v[208:211], a[108:111], a[176:179], v[208:211]
ds_read_b64_tr_b16 a[34:35], v16 offset:640
v_mfma_f32_16x16x32_bf16 v[224:227], a[112:115], a[176:179], v[224:227]
buffer_load_dwordx4 v14, s[32:35], s54 offen offset:2112 lds
v_mfma_f32_16x16x32_bf16 v[228:231], a[112:115], a[180:183], v[228:231]
v_mfma_f32_16x16x32_bf16 v[236:239], a[116:119], a[180:183], v[236:239]
ds_read_b64_tr_b16 a[36:37], v16 offset:160
v_mfma_f32_16x16x32_bf16 v[232:235], a[116:119], a[176:179], v[232:235]
ds_read_b64_tr_b16 a[38:39], v16 offset:672
v_mfma_f32_16x16x32_bf16 v[240:243], a[120:123], a[176:179], v[240:243]
ds_read_b64_tr_b16 a[40:41], v16 offset:8576
v_mfma_f32_16x16x32_bf16 v[244:247], a[120:123], a[180:183], v[244:247]
ds_read_b64_tr_b16 a[42:43], v16 offset:9088
v_mfma_f32_16x16x32_bf16 v[24:27], v[20:23], a[216:219], v[24:27]
ds_read_b64_tr_b16 a[44:45], v16 offset:8608
v_mfma_f32_16x16x32_bf16 v[252:255], a[124:127], a[180:183], v[252:255]
buffer_load_dwordx4 a[168:171], v11, s[16:19], s52 offen sc1
v_mfma_f32_16x16x32_bf16 v[248:251], a[124:127], a[176:179], v[248:251]
s_waitcnt vmcnt(25)
v_mfma_f32_16x16x32_bf16 v[220:223], a[108:111], a[188:191], v[220:223]
ds_read_b64_tr_b16 a[46:47], v16 offset:9120
v_mfma_f32_16x16x32_bf16 v[216:219], a[108:111], a[184:187], v[216:219]
ds_read_b64_tr_b16 a[48:49], v17
v_mfma_f32_16x16x32_bf16 v[200:203], a[104:107], a[184:187], v[200:203]
ds_read_b64_tr_b16 a[50:51], v17 offset:512
v_mfma_f32_16x16x32_bf16 v[204:207], a[104:107], a[188:191], v[204:207]
ds_read_b64_tr_b16 a[52:53], v17 offset:32
v_mfma_f32_16x16x32_bf16 v[188:191], a[100:103], a[188:191], v[188:191]
buffer_load_dwordx4 v15, s[32:35], s54 offen offset:3168 lds
v_mfma_f32_16x16x32_bf16 v[184:187], a[100:103], a[184:187], v[184:187]
s_add_u32 s54, s54, 229376
v_mfma_f32_16x16x32_bf16 v[168:171], a[96:99], a[184:187], v[168:171]
ds_read_b64_tr_b16 a[54:55], v17 offset:544
v_mfma_f32_16x16x32_bf16 v[172:175], a[96:99], a[188:191], v[172:175]
ds_read_b64_tr_b16 a[56:57], v17 offset:8448
v_mfma_f32_16x16x32_bf16 v[156:159], a[92:95], a[188:191], v[156:159]
ds_read_b64_tr_b16 a[58:59], v17 offset:8960
v_mfma_f32_16x16x32_bf16 v[152:155], a[92:95], a[184:187], v[152:155]
ds_read_b64_tr_b16 a[60:61], v17 offset:8480
v_mfma_f32_16x16x32_bf16 v[24:27], v[20:23], a[220:223], v[24:27]
ds_read_b64_tr_b16 a[62:63], v17 offset:8992
v_mfma_f32_16x16x32_bf16 v[136:139], a[88:91], a[184:187], v[136:139]
buffer_load_dwordx4 a[172:175], v11, s[16:19], s52 offen offset:1024 sc1
v_mfma_f32_16x16x32_bf16 v[140:143], a[88:91], a[188:191], v[140:143]
s_add_u32 s52, s52, 0x20000
v_mfma_f32_16x16x32_bf16 v[124:127], a[84:87], a[188:191], v[124:127]
ds_read_b128 a[192:195], v9
v_mfma_f32_16x16x32_bf16 v[120:123], a[84:87], a[184:187], v[120:123]
ds_read_b128 a[196:199], v9 offset:1056
v_mfma_f32_16x16x32_bf16 v[104:107], a[80:83], a[184:187], v[104:107]
ds_read_b128 a[200:203], v9 offset:2112
v_mfma_f32_16x16x32_bf16 v[108:111], a[80:83], a[188:191], v[108:111]
ds_read_b128 a[204:207], v9 offset:3168
s_max_i32 m0, s67, s59
v_mfma_f32_16x16x32_bf16 v[92:95], a[76:79], a[188:191], v[92:95]
buffer_load_dwordx4 v6, s[28:31], s58 offen offset:1056 lds
v_mfma_f32_16x16x32_bf16 v[88:91], a[76:79], a[184:187], v[88:91]
s_add_u32 s67, s67, 8448
s_add_u32 s58, s58, 0x10000
v_mfma_f32_16x16x32_bf16 v[72:75], a[72:75], a[184:187], v[72:75]
v_mfma_f32_16x16x32_bf16 v[76:79], a[72:75], a[188:191], v[76:79]
v_mfma_f32_16x16x32_bf16 v[60:63], a[68:71], a[188:191], v[60:63]
v_mfma_f32_16x16x32_bf16 v[56:59], a[68:71], a[184:187], v[56:59]
v_mfma_f32_16x16x32_bf16 v[40:43], a[64:67], a[184:187], v[40:43]
s_add_u32 s15, s15, 1
v_mfma_f32_16x16x32_bf16 v[44:47], a[64:67], a[188:191], v[44:47]
s_cbranch_scc0 .Lk42
s_waitcnt vmcnt(11) lgkmcnt(0)
s_barrier
v_mfma_f32_16x16x32_bf16 v[24:27], v[20:23], a[192:195], v[24:27]
buffer_load_dwordx4 a[176:179], v10, s[16:19], s52 offen sc1
v_mfma_f32_16x16x32_bf16 v[24:27], v[20:23], a[196:199], v[24:27]
ds_read_b64_tr_b16 a[64:65], v16 offset:16896
v_mov_b32 v18, v5
v_mfma_f32_16x16x32_bf16 v[24:27], v[20:23], a[200:203], v[24:27]
ds_read_b64_tr_b16 a[66:67], v16 offset:17408
v_mov_b32 v19, v6
v_mfma_f32_16x16x32_bf16 v[24:27], v[20:23], a[204:207], v[24:27]
ds_read_b64_tr_b16 a[68:69], v16 offset:16928
s_lshl_b32 s74, s48, 10
v_mfma_f32_16x16x32_bf16 v[32:35], a[0:3], a[128:131], v[32:35]
buffer_load_dwordx4 a[180:183], v10, s[16:19], s52 offen offset:1024 sc1
v_mfma_f32_16x16x32_bf16 v[48:51], a[4:7], a[128:131], v[48:51]
ds_read_b64_tr_b16 a[70:71], v16 offset:17440
s_lshl_b32 s75, s49, 9
v_mfma_f32_16x16x32_bf16 v[64:67], a[8:11], a[128:131], v[64:67]
ds_read_b64_tr_b16 a[72:73], v16 offset:25344
s_add_u32 s74, s74, s75
v_mfma_f32_16x16x32_bf16 v[80:83], a[12:15], a[128:131], v[80:83]
ds_read_b64_tr_b16 a[74:75], v16 offset:25856
s_add_u32 s74, s74, 159488
v_mfma_f32_16x16x32_bf16 v[36:39], a[0:3], a[132:135], v[36:39]
buffer_load_dwordx4 a[184:187], v11, s[16:19], s52 offen sc1
v_mfma_f32_16x16x32_bf16 v[52:55], a[4:7], a[132:135], v[52:55]
ds_read_b64_tr_b16 a[76:77], v16 offset:25376
v_bfe_u32 v2, v1, 4, 1
v_mfma_f32_16x16x32_bf16 v[68:71], a[8:11], a[132:135], v[68:71]
ds_read_b64_tr_b16 a[78:79], v16 offset:25888
s_lshl_b32 s75, s12, 9
v_mfma_f32_16x16x32_bf16 v[84:87], a[12:15], a[132:135], v[84:87]
ds_read_b64_tr_b16 a[80:81], v16 offset:33792
s_mov_b32 s58, 655360
v_mfma_f32_16x16x32_bf16 v[40:43], a[0:3], a[136:139], v[40:43]
buffer_load_dwordx4 a[188:191], v11, s[16:19], s52 offen offset:1024 sc1
v_mfma_f32_16x16x32_bf16 v[56:59], a[4:7], a[136:139], v[56:59]
s_add_u32 s52, s52, 0x20000
ds_read_b64_tr_b16 a[82:83], v16 offset:34304
v_mfma_f32_16x16x32_bf16 v[72:75], a[8:11], a[136:139], v[72:75]
ds_read_b64_tr_b16 a[84:85], v16 offset:33824
v_mfma_f32_16x16x32_bf16 v[88:91], a[12:15], a[136:139], v[88:91]
ds_read_b64_tr_b16 a[86:87], v16 offset:34336
v_mfma_f32_16x16x32_bf16 v[44:47], a[0:3], a[140:143], v[44:47]
ds_read_b64_tr_b16 a[88:89], v16 offset:42240
v_mfma_f32_16x16x32_bf16 v[60:63], a[4:7], a[140:143], v[60:63]
ds_read_b64_tr_b16 a[90:91], v16 offset:42752
v_mfma_f32_16x16x32_bf16 v[76:79], a[8:11], a[140:143], v[76:79]
ds_read_b64_tr_b16 a[92:93], v16 offset:42272
v_mfma_f32_16x16x32_bf16 v[92:95], a[12:15], a[140:143], v[92:95]
ds_read_b64_tr_b16 a[94:95], v16 offset:42784
v_mfma_f32_16x16x32_bf16 v[96:99], a[16:19], a[128:131], v[96:99]
ds_read_b64_tr_b16 a[112:113], v16 offset:16960
v_mfma_f32_16x16x32_bf16 v[112:115], a[20:23], a[128:131], v[112:115]
ds_read_b64_tr_b16 a[114:115], v16 offset:17472
v_mfma_f32_16x16x32_bf16 v[128:131], a[24:27], a[128:131], v[128:131]
ds_read_b64_tr_b16 a[116:117], v16 offset:16992
v_mfma_f32_16x16x32_bf16 v[144:147], a[28:31], a[128:131], v[144:147]
ds_read_b64_tr_b16 a[118:119], v16 offset:17504
v_mfma_f32_16x16x32_bf16 v[100:103], a[16:19], a[132:135], v[100:103]
ds_read_b64_tr_b16 a[120:121], v16 offset:25408
v_mfma_f32_16x16x32_bf16 v[116:119], a[20:23], a[132:135], v[116:119]
ds_read_b64_tr_b16 a[122:123], v16 offset:25920
v_mfma_f32_16x16x32_bf16 v[132:135], a[24:27], a[132:135], v[132:135]
ds_read_b64_tr_b16 a[124:125], v16 offset:25440
v_mfma_f32_16x16x32_bf16 v[148:151], a[28:31], a[132:135], v[148:151]
ds_read_b64_tr_b16 a[126:127], v16 offset:25952
v_mfma_f32_16x16x32_bf16 v[104:107], a[16:19], a[136:139], v[104:107]
ds_read_b128 a[208:211], v9 offset:16896
v_mfma_f32_16x16x32_bf16 v[120:123], a[20:23], a[136:139], v[120:123]
ds_read_b128 a[212:215], v9 offset:17952
v_mfma_f32_16x16x32_bf16 v[136:139], a[24:27], a[136:139], v[136:139]
ds_read_b128 a[216:219], v9 offset:19008
v_mfma_f32_16x16x32_bf16 v[152:155], a[28:31], a[136:139], v[152:155]
ds_read_b128 a[220:223], v9 offset:20064
v_mfma_f32_16x16x32_bf16 v[108:111], a[16:19], a[140:143], v[108:111]
ds_read_b128 a[192:195], v9 offset:33792
v_mfma_f32_16x16x32_bf16 v[124:127], a[20:23], a[140:143], v[124:127]
ds_read_b128 a[196:199], v9 offset:34848
v_mfma_f32_16x16x32_bf16 v[140:143], a[24:27], a[140:143], v[140:143]
ds_read_b128 a[200:203], v9 offset:35904
v_mfma_f32_16x16x32_bf16 v[156:159], a[28:31], a[140:143], v[156:159]
ds_read_b128 a[204:207], v9 offset:36960
v_mfma_f32_16x16x32_bf16 v[160:163], a[32:35], a[128:131], v[160:163]
ds_read_b64_tr_b16 a[0:1], v16 offset:33856
s_waitcnt lgkmcnt(8)
v_mfma_f32_16x16x32_bf16 v[24:27], v[20:23], a[208:211], v[24:27]
ds_read_b64_tr_b16 a[2:3], v16 offset:34368
s_waitcnt vmcnt(6)
s_barrier
s_waitcnt lgkmcnt(8)
v_mfma_f32_16x16x32_bf16 v[24:27], v[20:23], a[212:215], v[24:27]
ds_read_b64_tr_b16 a[96:97], v16 offset:50688
s_waitcnt lgkmcnt(8)
v_mfma_f32_16x16x32_bf16 v[24:27], v[20:23], a[216:219], v[24:27]
ds_read_b64_tr_b16 a[98:99], v16 offset:51200
s_waitcnt lgkmcnt(8)
v_mfma_f32_16x16x32_bf16 v[24:27], v[20:23], a[220:223], v[24:27]
ds_read_b64_tr_b16 a[100:101], v16 offset:50720
s_waitcnt lgkmcnt(8)
v_mfma_f32_16x16x32_bf16 v[24:27], v[20:23], a[192:195], v[24:27]
ds_read_b64_tr_b16 a[102:103], v16 offset:51232
s_waitcnt lgkmcnt(8)
v_mfma_f32_16x16x32_bf16 v[24:27], v[20:23], a[196:199], v[24:27]
ds_read_b64_tr_b16 a[104:105], v16 offset:59136
s_waitcnt lgkmcnt(8)
v_mfma_f32_16x16x32_bf16 v[24:27], v[20:23], a[200:203], v[24:27]
ds_read_b64_tr_b16 a[106:107], v16 offset:59648
s_waitcnt lgkmcnt(8)
v_mfma_f32_16x16x32_bf16 v[24:27], v[20:23], a[204:207], v[24:27]
ds_read_b64_tr_b16 a[108:109], v16 offset:59168
v_mfma_f32_16x16x32_bf16 v[176:179], a[36:39], a[128:131], v[176:179]
ds_read_b64_tr_b16 a[110:111], v16 offset:59680
v_mfma_f32_16x16x32_bf16 v[192:195], a[40:43], a[128:131], v[192:195]
ds_read_b128 a[208:211], v9 offset:50688
v_mfma_f32_16x16x32_bf16 v[208:211], a[44:47], a[128:131], v[208:211]
ds_read_b128 a[212:215], v9 offset:51744
v_mfma_f32_16x16x32_bf16 v[164:167], a[32:35], a[132:135], v[164:167]
ds_read_b128 a[216:219], v9 offset:52800
v_mfma_f32_16x16x32_bf16 v[180:183], a[36:39], a[132:135], v[180:183]
ds_read_b128 a[220:223], v9 offset:53856
v_and_b32 v9, 15, v1
v_mfma_f32_16x16x32_bf16 v[196:199], a[40:43], a[132:135], v[196:199]
ds_read_b64_tr_b16 a[4:5], v16 offset:33888
v_lshl_add_u32 v9, v9, 5, s74
v_mfma_f32_16x16x32_bf16 v[212:215], a[44:47], a[132:135], v[212:215]
s_lshl_b32 s74, s3, 10
v_lshl_add_u32 v9, v2, 4, v9
.Lpad4:
s_cbranch_execz .Lnopoll40r
v_bfe_u32 v2, v1, 5, 1
v_mfma_f32_16x16x32_bf16 v[168:171], a[32:35], a[136:139], v[168:171]
s_add_u32 s74, s74, s75
v_mul_u32_u24 v2, 2816, v2
v_sub_u32 v9, v9, v2
v_mfma_f32_16x16x32_bf16 v[184:187], a[36:39], a[136:139], v[184:187]
s_add_u32 s74, s74, 152576
v_and_b32 v2, 15, v1
v_lshl_add_u32 v2, v2, 4, s74
v_mfma_f32_16x16x32_bf16 v[200:203], a[40:43], a[136:139], v[200:203]
ds_read_b32 v28, v2 offset:8
v_xor_b32 v8, 512, v2
s_waitcnt lgkmcnt(5)
v_mfma_f32_16x16x32_bf16 v[24:27], v[20:23], a[208:211], v[24:27]
ds_read_b32 v29, v2 offset:264
s_lshl_b32 s74, s12, 7
s_waitcnt lgkmcnt(5)
v_mfma_f32_16x16x32_bf16 v[24:27], v[20:23], a[212:215], v[24:27]
ds_read_b32 v30, v8 offset:8
s_add_u32 s74, s74, 161536
s_waitcnt lgkmcnt(5)
v_mfma_f32_16x16x32_bf16 v[24:27], v[20:23], a[216:219], v[24:27]
ds_read_b32 v31, v8 offset:264
s_xor_b32 s75, s12, 1
s_waitcnt lgkmcnt(5)
v_mfma_f32_16x16x32_bf16 v[24:27], v[20:23], a[220:223], v[24:27]
s_mul_i32 s75, s75, 384
s_add_u32 s75, s75, 161536
v_mfma_f32_16x16x32_bf16 v[216:219], a[44:47], a[136:139], v[216:219]
ds_read_b64_tr_b16 a[6:7], v16 offset:34400
v_mfma_f32_16x16x32_bf16 v[172:175], a[32:35], a[140:143], v[172:175]
s_nop 2
ds_write_b128 v9, v[24:27]
v_lshlrev_b32 v9, 4, v1
v_mfma_f32_16x16x32_bf16 v[188:191], a[36:39], a[140:143], v[188:191]
ds_read_b64_tr_b16 a[8:9], v16 offset:42304
v_add_u32 v9, 159488, v9
v_mfma_f32_16x16x32_bf16 v[204:207], a[40:43], a[140:143], v[204:207]
ds_read_b64_tr_b16 a[10:11], v16 offset:42816
v_mfma_f32_16x16x32_bf16 v[220:223], a[44:47], a[140:143], v[220:223]
ds_read_b64_tr_b16 a[12:13], v16 offset:42336
v_mfma_f32_16x16x32_bf16 v[224:227], a[48:51], a[128:131], v[224:227]
ds_read_b64_tr_b16 a[14:15], v16 offset:42848
v_mfma_f32_16x16x32_bf16 v[232:235], a[52:55], a[128:131], v[232:235]
ds_read_b64_tr_b16 a[16:17], v16 offset:50752
v_mfma_f32_16x16x32_bf16 v[240:243], a[56:59], a[128:131], v[240:243]
ds_read_b64_tr_b16 a[18:19], v16 offset:51264
v_mfma_f32_16x16x32_bf16 v[248:251], a[60:63], a[128:131], v[248:251]
ds_read_b64_tr_b16 a[20:21], v16 offset:50784
v_mfma_f32_16x16x32_bf16 v[228:231], a[48:51], a[132:135], v[228:231]
s_waitcnt lgkmcnt(7)
s_barrier
ds_read_b128 v[20:23], v9
v_mfma_f32_16x16x32_bf16 v[236:239], a[52:55], a[132:135], v[236:239]
ds_read_b128 v[24:27], v9 offset:1024
v_mfma_f32_16x16x32_bf16 v[244:247], a[56:59], a[132:135], v[244:247]
ds_read_b64_tr_b16 a[22:23], v16 offset:51296
v_mfma_f32_16x16x32_bf16 v[252:255], a[60:63], a[132:135], v[252:255]
ds_read_b64_tr_b16 a[24:25], v16 offset:59200
v_mfma_f32_16x16x32_bf16 v[32:35], a[64:67], a[144:147], v[32:35]
ds_read_b64_tr_b16 a[26:27], v16 offset:59712
v_mfma_f32_16x16x32_bf16 v[48:51], a[68:71], a[144:147], v[48:51]
ds_read_b64_tr_b16 a[28:29], v16 offset:59232
v_mfma_f32_16x16x32_bf16 v[64:67], a[72:75], a[144:147], v[64:67]
ds_read_b64_tr_b16 a[30:31], v16 offset:59744
v_mfma_f32_16x16x32_bf16 v[80:83], a[76:79], a[144:147], v[80:83]
ds_read_b64_tr_b16 a[32:33], v16 offset:17024
v_mfma_f32_16x16x32_bf16 v[32:35], a[80:83], a[160:163], v[32:35]
ds_read_b64_tr_b16 a[34:35], v16 offset:17536
v_mfma_f32_16x16x32_bf16 v[48:51], a[84:87], a[160:163], v[48:51]
ds_read_b64_tr_b16 a[36:37], v16 offset:17056
s_waitcnt lgkmcnt(8)
v_add_f32 v20, v20, v24
v_mfma_f32_16x16x32_bf16 v[64:67], a[88:91], a[160:163], v[64:67]
ds_read_b64_tr_b16 a[38:39], v16 offset:17568
v_add_f32 v21, v21, v25
v_mfma_f32_16x16x32_bf16 v[80:83], a[92:95], a[160:163], v[80:83]
ds_read_b64 v[24:25], v8
v_add_f32 v22, v22, v26
s_waitcnt vmcnt(3)
v_mfma_f32_16x16x32_bf16 v[32:35], a[96:99], a[176:179], v[32:35]
ds_read_b64_tr_b16 a[40:41], v16 offset:25472
v_add_f32 v23, v23, v27
v_mfma_f32_16x16x32_bf16 v[48:51], a[100:103], a[176:179], v[48:51]
ds_write_b128 v9, v[20:23] offset:2048
v_lshrrev_b32 v9, 4, v1
v_mfma_f32_16x16x32_bf16 v[64:67], a[104:107], a[176:179], v[64:67]
ds_read_b64 v[20:21], v2
v_lshlrev_b32 v9, 4, v9
v_mfma_f32_16x16x32_bf16 v[80:83], a[108:111], a[176:179], v[80:83]
ds_read_b64 v[22:23], v2 offset:256
ds_read_b64 v[26:27], v8 offset:256
v_add_u32 v8, s75, v9
v_add_u32 v9, s74, v9
ds_read_b128 v[12:15], v9
ds_read_b128 v[4:7], v9 offset:64
ds_read_b64_tr_b16 a[42:43], v16 offset:25984
ds_read_b64_tr_b16 a[44:45], v16 offset:25504
ds_read_b64_tr_b16 a[46:47], v16 offset:26016
ds_read_b64_tr_b16 a[48:49], v16 offset:33920
ds_read_b64_tr_b16 a[50:51], v16 offset:34432
ds_read_b64_tr_b16 a[52:53], v16 offset:33952
ds_read_b64_tr_b16 a[54:55], v16 offset:34464
ds_read_b64_tr_b16 a[56:57], v16 offset:42368
ds_read_b64_tr_b16 a[58:59], v16 offset:42880
ds_read_b64_tr_b16 a[60:61], v16 offset:42400
ds_read_b64_tr_b16 a[62:63], v16 offset:42912
s_waitcnt lgkmcnt(12)
v_pk_fma_f32 v[32:33], v[12:13], v[20:21], v[32:33] op_sel_hi:[1,0,1]
v_pk_fma_f32 v[34:35], v[14:15], v[20:21], v[34:35] op_sel_hi:[1,0,1]
v_pk_fma_f32 v[36:37], v[12:13], v[22:23], v[36:37] op_sel_hi:[1,0,1]
v_pk_fma_f32 v[38:39], v[14:15], v[22:23], v[38:39] op_sel_hi:[1,0,1]
v_pk_fma_f32 v[40:41], v[12:13], v[24:25], v[40:41] op_sel_hi:[1,0,1]
v_pk_fma_f32 v[42:43], v[14:15], v[24:25], v[42:43] op_sel_hi:[1,0,1]
v_pk_fma_f32 v[44:45], v[12:13], v[26:27], v[44:45] op_sel_hi:[1,0,1]
v_pk_fma_f32 v[46:47], v[14:15], v[26:27], v[46:47] op_sel_hi:[1,0,1]
ds_read_b128 v[12:15], v9 offset:512
s_waitcnt lgkmcnt(12)
v_pk_fma_f32 v[48:49], v[4:5], v[20:21], v[48:49] op_sel_hi:[1,0,1]
v_pk_fma_f32 v[50:51], v[6:7], v[20:21], v[50:51] op_sel_hi:[1,0,1]
v_pk_fma_f32 v[52:53], v[4:5], v[22:23], v[52:53] op_sel_hi:[1,0,1]
v_pk_fma_f32 v[54:55], v[6:7], v[22:23], v[54:55] op_sel_hi:[1,0,1]
v_pk_fma_f32 v[56:57], v[4:5], v[24:25], v[56:57] op_sel_hi:[1,0,1]
v_pk_fma_f32 v[58:59], v[6:7], v[24:25], v[58:59] op_sel_hi:[1,0,1]
v_pk_fma_f32 v[60:61], v[4:5], v[26:27], v[60:61] op_sel_hi:[1,0,1]
v_pk_fma_f32 v[62:63], v[6:7], v[26:27], v[62:63] op_sel_hi:[1,0,1]
ds_read_b128 v[4:7], v9 offset:576
s_waitcnt lgkmcnt(1)
v_pk_fma_f32 v[64:65], v[12:13], v[20:21], v[64:65] op_sel_hi:[1,0,1]
v_pk_fma_f32 v[66:67], v[14:15], v[20:21], v[66:67] op_sel_hi:[1,0,1]
v_pk_fma_f32 v[68:69], v[12:13], v[22:23], v[68:69] op_sel_hi:[1,0,1]
v_pk_fma_f32 v[70:71], v[14:15], v[22:23], v[70:71] op_sel_hi:[1,0,1]
v_pk_fma_f32 v[72:73], v[12:13], v[24:25], v[72:73] op_sel_hi:[1,0,1]
v_pk_fma_f32 v[74:75], v[14:15], v[24:25], v[74:75] op_sel_hi:[1,0,1]
v_pk_fma_f32 v[76:77], v[12:13], v[26:27], v[76:77] op_sel_hi:[1,0,1]
v_pk_fma_f32 v[78:79], v[14:15], v[26:27], v[78:79] op_sel_hi:[1,0,1]
ds_read_b128 v[12:15], v9 offset:832
s_waitcnt lgkmcnt(1)
v_pk_fma_f32 v[80:81], v[4:5], v[20:21], v[80:81] op_sel_hi:[1,0,1]
v_pk_fma_f32 v[82:83], v[6:7], v[20:21], v[82:83] op_sel_hi:[1,0,1]
v_pk_fma_f32 v[84:85], v[4:5], v[22:23], v[84:85] op_sel_hi:[1,0,1]
v_pk_fma_f32 v[86:87], v[6:7], v[22:23], v[86:87] op_sel_hi:[1,0,1]
v_pk_fma_f32 v[88:89], v[4:5], v[24:25], v[88:89] op_sel_hi:[1,0,1]
v_pk_fma_f32 v[90:91], v[6:7], v[24:25], v[90:91] op_sel_hi:[1,0,1]
v_pk_fma_f32 v[92:93], v[4:5], v[26:27], v[92:93] op_sel_hi:[1,0,1]
v_pk_fma_f32 v[94:95], v[6:7], v[26:27], v[94:95] op_sel_hi:[1,0,1]
ds_read_b128 v[4:7], v9 offset:704
v_pk_mul_f32 v[64:65], v[64:65], v[32:33]
v_pk_mul_f32 v[32:33], v[32:33], v[28:29] op_sel_hi:[1,0]
v_pk_mul_f32 v[66:67], v[66:67], v[34:35]
v_pk_mul_f32 v[34:35], v[34:35], v[28:29] op_sel_hi:[1,0]
v_pk_mul_f32 v[80:81], v[80:81], v[48:49]
v_pk_mul_f32 v[48:49], v[48:49], v[28:29] op_sel_hi:[1,0]
v_pk_mul_f32 v[82:83], v[82:83], v[50:51]
v_pk_mul_f32 v[50:51], v[50:51], v[28:29] op_sel_hi:[1,0]
v_exp_f32 v32, v32
s_nop 0
v_mfma_f32_16x16x32_bf16 v[36:39], a[64:67], a[148:151], v[36:39]
v_exp_f32 v33, v33
v_mfma_f32_16x16x32_bf16 v[52:55], a[68:71], a[148:151], v[52:55]
v_exp_f32 v34, v34
v_mfma_f32_16x16x32_bf16 v[68:71], a[72:75], a[148:151], v[68:71]
v_exp_f32 v35, v35
v_mfma_f32_16x16x32_bf16 v[84:87], a[76:79], a[148:151], v[84:87]
v_exp_f32 v48, v48
v_mfma_f32_16x16x32_bf16 v[36:39], a[80:83], a[164:167], v[36:39]
v_exp_f32 v49, v49
v_mfma_f32_16x16x32_bf16 v[52:55], a[84:87], a[164:167], v[52:55]
v_exp_f32 v50, v50
v_mfma_f32_16x16x32_bf16 v[68:71], a[88:91], a[164:167], v[68:71]
v_exp_f32 v51, v51
v_mfma_f32_16x16x32_bf16 v[84:87], a[92:95], a[164:167], v[84:87]
s_waitcnt vmcnt(2)
v_mfma_f32_16x16x32_bf16 v[36:39], a[96:99], a[180:183], v[36:39]
v_mfma_f32_16x16x32_bf16 v[52:55], a[100:103], a[180:183], v[52:55]
v_mfma_f32_16x16x32_bf16 v[68:71], a[104:107], a[180:183], v[68:71]
v_mfma_f32_16x16x32_bf16 v[84:87], a[108:111], a[180:183], v[84:87]
s_nop 6
v_pk_mul_f32 v[68:69], v[68:69], v[36:37]
v_pk_mul_f32 v[36:37], v[36:37], v[28:29] op_sel:[0,1] op_sel_hi:[1,1]
v_pk_mul_f32 v[70:71], v[70:71], v[38:39]
v_pk_mul_f32 v[38:39], v[38:39], v[28:29] op_sel:[0,1] op_sel_hi:[1,1]
v_pk_mul_f32 v[84:85], v[84:85], v[52:53]
v_pk_mul_f32 v[52:53], v[52:53], v[28:29] op_sel:[0,1] op_sel_hi:[1,1]
v_pk_mul_f32 v[86:87], v[86:87], v[54:55]
v_pk_mul_f32 v[54:55], v[54:55], v[28:29] op_sel:[0,1] op_sel_hi:[1,1]
v_pk_fma_f32 v[32:33], v[32:33], v[20:21], v[20:21] op_sel:[0,1,1] op_sel_hi:[1,1,1]
v_pk_fma_f32 v[34:35], v[34:35], v[20:21], v[20:21] op_sel:[0,1,1] op_sel_hi:[1,1,1]
v_pk_fma_f32 v[48:49], v[48:49], v[20:21], v[20:21] op_sel:[0,1,1] op_sel_hi:[1,1,1]
v_pk_fma_f32 v[50:51], v[50:51], v[20:21], v[20:21] op_sel:[0,1,1] op_sel_hi:[1,1,1]
v_rcp_f32 v32, v32
s_nop 0
v_mfma_f32_16x16x32_bf16 v[40:43], a[64:67], a[152:155], v[40:43]
v_rcp_f32 v33, v33
v_mfma_f32_16x16x32_bf16 v[56:59], a[68:71], a[152:155], v[56:59]
v_rcp_f32 v34, v34
v_mfma_f32_16x16x32_bf16 v[72:75], a[72:75], a[152:155], v[72:75]
v_rcp_f32 v35, v35
v_mfma_f32_16x16x32_bf16 v[88:91], a[76:79], a[152:155], v[88:91]
v_rcp_f32 v48, v48
v_mfma_f32_16x16x32_bf16 v[40:43], a[80:83], a[168:171], v[40:43]
v_rcp_f32 v49, v49
v_mfma_f32_16x16x32_bf16 v[56:59], a[84:87], a[168:171], v[56:59]
v_rcp_f32 v50, v50
v_mfma_f32_16x16x32_bf16 v[72:75], a[88:91], a[168:171], v[72:75]
v_rcp_f32 v51, v51
v_mfma_f32_16x16x32_bf16 v[88:91], a[92:95], a[168:171], v[88:91]
v_exp_f32 v36, v36
s_waitcnt vmcnt(1)
v_mfma_f32_16x16x32_bf16 v[40:43], a[96:99], a[184:187], v[40:43]
v_exp_f32 v37, v37
v_mfma_f32_16x16x32_bf16 v[56:59], a[100:103], a[184:187], v[56:59]
v_exp_f32 v38, v38
v_mfma_f32_16x16x32_bf16 v[72:75], a[104:107], a[184:187], v[72:75]
v_exp_f32 v39, v39
v_mfma_f32_16x16x32_bf16 v[88:91], a[108:111], a[184:187], v[88:91]
v_exp_f32 v52, v52
v_exp_f32 v53, v53
v_exp_f32 v54, v54
v_exp_f32 v55, v55
v_pk_mul_f32 v[64:65], v[64:65], v[32:33]
v_pk_mul_f32 v[66:67], v[66:67], v[34:35]
v_pk_mul_f32 v[80:81], v[80:81], v[48:49]
v_pk_mul_f32 v[82:83], v[82:83], v[50:51]
ds_read_b128 v[48:51], v9 offset:128
v_pk_mul_f32 v[72:73], v[72:73], v[40:41]
v_pk_mul_f32 v[40:41], v[40:41], v[30:31] op_sel_hi:[1,0]
v_pk_mul_f32 v[74:75], v[74:75], v[42:43]
v_pk_mul_f32 v[42:43], v[42:43], v[30:31] op_sel_hi:[1,0]
v_pk_mul_f32 v[88:89], v[88:89], v[56:57]
v_pk_mul_f32 v[56:57], v[56:57], v[30:31] op_sel_hi:[1,0]
v_pk_mul_f32 v[90:91], v[90:91], v[58:59]
v_pk_mul_f32 v[58:59], v[58:59], v[30:31] op_sel_hi:[1,0]
v_pk_fma_f32 v[36:37], v[36:37], v[22:23], v[22:23] op_sel:[0,1,1] op_sel_hi:[1,1,1]
v_pk_fma_f32 v[38:39], v[38:39], v[22:23], v[22:23] op_sel:[0,1,1] op_sel_hi:[1,1,1]
v_pk_fma_f32 v[52:53], v[52:53], v[22:23], v[22:23] op_sel:[0,1,1] op_sel_hi:[1,1,1]
v_pk_fma_f32 v[54:55], v[54:55], v[22:23], v[22:23] op_sel:[0,1,1] op_sel_hi:[1,1,1]
v_cvt_pk_bf16_f32 v32, v64, v65
v_cvt_pk_bf16_f32 v33, v66, v67
ds_read_b128 v[64:67], v9 offset:192
v_cvt_pk_bf16_f32 v34, v80, v81
v_cvt_pk_bf16_f32 v35, v82, v83
v_mfma_f32_16x16x32_bf16 v[44:47], a[64:67], a[156:159], v[44:47]
buffer_store_dwordx4 v[32:35], v10, s[16:19], s62 offen sc1
v_mfma_f32_16x16x32_bf16 v[60:63], a[68:71], a[156:159], v[60:63]
ds_read_b128 v[80:83], v9 offset:640
v_rcp_f32 v36, v36
v_mfma_f32_16x16x32_bf16 v[76:79], a[72:75], a[156:159], v[76:79]
ds_read_b64_tr_b16 a[64:65], v16 offset:50816
v_rcp_f32 v37, v37
v_mfma_f32_16x16x32_bf16 v[92:95], a[76:79], a[156:159], v[92:95]
ds_read_b64_tr_b16 a[66:67], v16 offset:51328
v_rcp_f32 v38, v38
v_mfma_f32_16x16x32_bf16 v[44:47], a[80:83], a[172:175], v[44:47]
ds_read_b64_tr_b16 a[68:69], v16 offset:50848
v_rcp_f32 v39, v39
v_mfma_f32_16x16x32_bf16 v[60:63], a[84:87], a[172:175], v[60:63]
ds_read_b64_tr_b16 a[70:71], v16 offset:51360
v_rcp_f32 v52, v52
v_mfma_f32_16x16x32_bf16 v[76:79], a[88:91], a[172:175], v[76:79]
ds_read_b64_tr_b16 a[72:73], v16 offset:59264
v_rcp_f32 v53, v53
v_mfma_f32_16x16x32_bf16 v[92:95], a[92:95], a[172:175], v[92:95]
ds_read_b64_tr_b16 a[74:75], v16 offset:59776
v_rcp_f32 v54, v54
s_waitcnt vmcnt(1)
v_mfma_f32_16x16x32_bf16 v[44:47], a[96:99], a[188:191], v[44:47]
ds_read_b64_tr_b16 a[76:77], v16 offset:59296
v_rcp_f32 v55, v55
v_mfma_f32_16x16x32_bf16 v[60:63], a[100:103], a[188:191], v[60:63]
ds_read_b64_tr_b16 a[78:79], v16 offset:59808
v_exp_f32 v40, v40
v_mfma_f32_16x16x32_bf16 v[76:79], a[104:107], a[188:191], v[76:79]
ds_read_b64_tr_b16 a[80:81], v17 offset:16896
v_exp_f32 v41, v41
v_mfma_f32_16x16x32_bf16 v[92:95], a[108:111], a[188:191], v[92:95]
ds_read_b64_tr_b16 a[82:83], v17 offset:17408
v_exp_f32 v42, v42
v_exp_f32 v43, v43
v_exp_f32 v56, v56
v_exp_f32 v57, v57
v_exp_f32 v58, v58
v_exp_f32 v59, v59
v_pk_mul_f32 v[68:69], v[68:69], v[36:37]
v_pk_mul_f32 v[70:71], v[70:71], v[38:39]
v_pk_mul_f32 v[84:85], v[84:85], v[52:53]
v_pk_mul_f32 v[86:87], v[86:87], v[54:55]
v_pk_mul_f32 v[76:77], v[76:77], v[44:45]
v_pk_mul_f32 v[44:45], v[44:45], v[30:31] op_sel:[0,1] op_sel_hi:[1,1]
v_pk_mul_f32 v[78:79], v[78:79], v[46:47]
v_pk_mul_f32 v[46:47], v[46:47], v[30:31] op_sel:[0,1] op_sel_hi:[1,1]
v_pk_mul_f32 v[92:93], v[92:93], v[60:61]
v_pk_mul_f32 v[60:61], v[60:61], v[30:31] op_sel:[0,1] op_sel_hi:[1,1]
v_pk_mul_f32 v[94:95], v[94:95], v[62:63]
v_pk_mul_f32 v[62:63], v[62:63], v[30:31] op_sel:[0,1] op_sel_hi:[1,1]
v_pk_fma_f32 v[40:41], v[40:41], v[24:25], v[24:25] op_sel:[0,1,1] op_sel_hi:[1,1,1]
v_pk_fma_f32 v[42:43], v[42:43], v[24:25], v[24:25] op_sel:[0,1,1] op_sel_hi:[1,1,1]
v_pk_fma_f32 v[56:57], v[56:57], v[24:25], v[24:25] op_sel:[0,1,1] op_sel_hi:[1,1,1]
v_pk_fma_f32 v[58:59], v[58:59], v[24:25], v[24:25] op_sel:[0,1,1] op_sel_hi:[1,1,1]
v_cvt_pk_bf16_f32 v36, v68, v69
v_cvt_pk_bf16_f32 v37, v70, v71
v_cvt_pk_bf16_f32 v38, v84, v85
v_cvt_pk_bf16_f32 v39, v86, v87
v_mfma_f32_16x16x32_bf16 v[96:99], a[112:115], a[144:147], v[96:99]
buffer_store_dwordx4 v[36:39], v10, s[16:19], s62 offen offset:1024 sc1
v_mfma_f32_16x16x32_bf16 v[112:115], a[116:119], a[144:147], v[112:115]
ds_read_b64_tr_b16 a[84:85], v17 offset:16928
v_rcp_f32 v40, v40
v_mfma_f32_16x16x32_bf16 v[128:131], a[120:123], a[144:147], v[128:131]
ds_read_b64_tr_b16 a[86:87], v17 offset:17440
v_rcp_f32 v41, v41
v_mfma_f32_16x16x32_bf16 v[144:147], a[124:127], a[144:147], v[144:147]
ds_read_b64_tr_b16 a[88:89], v17 offset:25344
v_rcp_f32 v42, v42
v_mfma_f32_16x16x32_bf16 v[96:99], a[0:3], a[160:163], v[96:99]
ds_read_b64_tr_b16 a[90:91], v17 offset:25856
v_rcp_f32 v43, v43
v_mfma_f32_16x16x32_bf16 v[112:115], a[4:7], a[160:163], v[112:115]
ds_read_b64_tr_b16 a[92:93], v17 offset:25376
v_rcp_f32 v56, v56
v_mfma_f32_16x16x32_bf16 v[128:131], a[8:11], a[160:163], v[128:131]
ds_read_b64_tr_b16 a[94:95], v17 offset:25888
v_rcp_f32 v57, v57
v_mfma_f32_16x16x32_bf16 v[144:147], a[12:15], a[160:163], v[144:147]
ds_read_b64_tr_b16 a[96:97], v17 offset:33792
v_rcp_f32 v58, v58
v_mfma_f32_16x16x32_bf16 v[96:99], a[16:19], a[176:179], v[96:99]
ds_read_b64_tr_b16 a[98:99], v17 offset:34304
v_rcp_f32 v59, v59
v_mfma_f32_16x16x32_bf16 v[112:115], a[20:23], a[176:179], v[112:115]
ds_read_b64_tr_b16 a[100:101], v17 offset:33824
v_exp_f32 v44, v44
v_mfma_f32_16x16x32_bf16 v[128:131], a[24:27], a[176:179], v[128:131]
ds_read_b64_tr_b16 a[102:103], v17 offset:34336
v_exp_f32 v45, v45
v_mfma_f32_16x16x32_bf16 v[144:147], a[28:31], a[176:179], v[144:147]
ds_read_b64_tr_b16 a[104:105], v17 offset:42240
v_exp_f32 v46, v46
v_exp_f32 v47, v47
v_exp_f32 v60, v60
v_exp_f32 v61, v61
v_exp_f32 v62, v62
v_exp_f32 v63, v63
v_pk_mul_f32 v[72:73], v[72:73], v[40:41]
v_pk_mul_f32 v[74:75], v[74:75], v[42:43]
v_pk_mul_f32 v[88:89], v[88:89], v[56:57]
v_pk_mul_f32 v[90:91], v[90:91], v[58:59]
s_waitcnt lgkmcnt(15)
v_pk_fma_f32 v[96:97], v[48:49], v[20:21], v[96:97] op_sel_hi:[1,0,1]
v_pk_fma_f32 v[98:99], v[50:51], v[20:21], v[98:99] op_sel_hi:[1,0,1]
v_pk_fma_f32 v[112:113], v[64:65], v[20:21], v[112:113] op_sel_hi:[1,0,1]
v_pk_fma_f32 v[114:115], v[66:67], v[20:21], v[114:115] op_sel_hi:[1,0,1]
v_pk_fma_f32 v[128:129], v[80:81], v[20:21], v[128:129] op_sel_hi:[1,0,1]
v_pk_fma_f32 v[130:131], v[82:83], v[20:21], v[130:131] op_sel_hi:[1,0,1]
v_pk_fma_f32 v[144:145], v[4:5], v[20:21], v[144:145] op_sel_hi:[1,0,1]
v_pk_fma_f32 v[146:147], v[6:7], v[20:21], v[146:147] op_sel_hi:[1,0,1]
v_pk_mul_f32 v[128:129], v[128:129], v[96:97]
v_pk_mul_f32 v[96:97], v[96:97], v[28:29] op_sel_hi:[1,0]
v_pk_mul_f32 v[130:131], v[130:131], v[98:99]
v_pk_mul_f32 v[98:99], v[98:99], v[28:29] op_sel_hi:[1,0]
v_pk_mul_f32 v[144:145], v[144:145], v[112:113]
v_pk_mul_f32 v[112:113], v[112:113], v[28:29] op_sel_hi:[1,0]
v_pk_mul_f32 v[146:147], v[146:147], v[114:115]
v_pk_mul_f32 v[114:115], v[114:115], v[28:29] op_sel_hi:[1,0]
v_pk_fma_f32 v[44:45], v[44:45], v[26:27], v[26:27] op_sel:[0,1,1] op_sel_hi:[1,1,1]
v_pk_fma_f32 v[46:47], v[46:47], v[26:27], v[26:27] op_sel:[0,1,1] op_sel_hi:[1,1,1]
v_pk_fma_f32 v[60:61], v[60:61], v[26:27], v[26:27] op_sel:[0,1,1] op_sel_hi:[1,1,1]
v_pk_fma_f32 v[62:63], v[62:63], v[26:27], v[26:27] op_sel:[0,1,1] op_sel_hi:[1,1,1]
v_cvt_pk_bf16_f32 v40, v72, v73
v_cvt_pk_bf16_f32 v41, v74, v75
v_cvt_pk_bf16_f32 v42, v88, v89
v_cvt_pk_bf16_f32 v43, v90, v91
v_mfma_f32_16x16x32_bf16 v[100:103], a[112:115], a[148:151], v[100:103]
buffer_store_dwordx4 v[40:43], v11, s[16:19], s62 offen sc1
v_mfma_f32_16x16x32_bf16 v[116:119], a[116:119], a[148:151], v[116:119]
ds_read_b64_tr_b16 a[106:107], v17 offset:42752
v_rcp_f32 v44, v44
v_mfma_f32_16x16x32_bf16 v[132:135], a[120:123], a[148:151], v[132:135]
ds_read_b64_tr_b16 a[108:109], v17 offset:42272
v_rcp_f32 v45, v45
v_mfma_f32_16x16x32_bf16 v[148:151], a[124:127], a[148:151], v[148:151]
ds_read_b64_tr_b16 a[110:111], v17 offset:42784
v_rcp_f32 v46, v46
v_mfma_f32_16x16x32_bf16 v[100:103], a[0:3], a[164:167], v[100:103]
v_rcp_f32 v47, v47
v_mfma_f32_16x16x32_bf16 v[116:119], a[4:7], a[164:167], v[116:119]
v_rcp_f32 v60, v60
v_mfma_f32_16x16x32_bf16 v[132:135], a[8:11], a[164:167], v[132:135]
v_rcp_f32 v61, v61
v_mfma_f32_16x16x32_bf16 v[148:151], a[12:15], a[164:167], v[148:151]
v_rcp_f32 v62, v62
v_mfma_f32_16x16x32_bf16 v[100:103], a[16:19], a[180:183], v[100:103]
v_rcp_f32 v63, v63
v_mfma_f32_16x16x32_bf16 v[116:119], a[20:23], a[180:183], v[116:119]
v_exp_f32 v96, v96
v_mfma_f32_16x16x32_bf16 v[132:135], a[24:27], a[180:183], v[132:135]
v_exp_f32 v97, v97
v_mfma_f32_16x16x32_bf16 v[148:151], a[28:31], a[180:183], v[148:151]
v_exp_f32 v98, v98
v_exp_f32 v99, v99
v_exp_f32 v112, v112
v_exp_f32 v113, v113
v_exp_f32 v114, v114
v_exp_f32 v115, v115
v_pk_mul_f32 v[76:77], v[76:77], v[44:45]
v_pk_mul_f32 v[78:79], v[78:79], v[46:47]
v_pk_mul_f32 v[92:93], v[92:93], v[60:61]
v_pk_mul_f32 v[94:95], v[94:95], v[62:63]
v_pk_fma_f32 v[100:101], v[48:49], v[22:23], v[100:101] op_sel_hi:[1,0,1]
v_pk_fma_f32 v[102:103], v[50:51], v[22:23], v[102:103] op_sel_hi:[1,0,1]
v_pk_fma_f32 v[116:117], v[64:65], v[22:23], v[116:117] op_sel_hi:[1,0,1]
v_pk_fma_f32 v[118:119], v[66:67], v[22:23], v[118:119] op_sel_hi:[1,0,1]
v_pk_fma_f32 v[132:133], v[80:81], v[22:23], v[132:133] op_sel_hi:[1,0,1]
v_pk_fma_f32 v[134:135], v[82:83], v[22:23], v[134:135] op_sel_hi:[1,0,1]
v_pk_fma_f32 v[148:149], v[4:5], v[22:23], v[148:149] op_sel_hi:[1,0,1]
v_pk_fma_f32 v[150:151], v[6:7], v[22:23], v[150:151] op_sel_hi:[1,0,1]
v_pk_mul_f32 v[132:133], v[132:133], v[100:101]
v_pk_mul_f32 v[100:101], v[100:101], v[28:29] op_sel:[0,1] op_sel_hi:[1,1]
v_pk_mul_f32 v[134:135], v[134:135], v[102:103]
v_pk_mul_f32 v[102:103], v[102:103], v[28:29] op_sel:[0,1] op_sel_hi:[1,1]
v_pk_mul_f32 v[148:149], v[148:149], v[116:117]
v_pk_mul_f32 v[116:117], v[116:117], v[28:29] op_sel:[0,1] op_sel_hi:[1,1]
v_pk_mul_f32 v[150:151], v[150:151], v[118:119]
v_pk_mul_f32 v[118:119], v[118:119], v[28:29] op_sel:[0,1] op_sel_hi:[1,1]
v_pk_fma_f32 v[96:97], v[96:97], v[20:21], v[20:21] op_sel:[0,1,1] op_sel_hi:[1,1,1]
v_pk_fma_f32 v[98:99], v[98:99], v[20:21], v[20:21] op_sel:[0,1,1] op_sel_hi:[1,1,1]
v_pk_fma_f32 v[112:113], v[112:113], v[20:21], v[20:21] op_sel:[0,1,1] op_sel_hi:[1,1,1]
v_pk_fma_f32 v[114:115], v[114:115], v[20:21], v[20:21] op_sel:[0,1,1] op_sel_hi:[1,1,1]
v_cvt_pk_bf16_f32 v44, v76, v77
v_cvt_pk_bf16_f32 v45, v78, v79
v_cvt_pk_bf16_f32 v46, v92, v93
v_cvt_pk_bf16_f32 v47, v94, v95
v_mfma_f32_16x16x32_bf16 v[104:107], a[112:115], a[152:155], v[104:107]
buffer_store_dwordx4 v[44:47], v11, s[16:19], s62 offen offset:1024 sc1
v_mfma_f32_16x16x32_bf16 v[120:123], a[116:119], a[152:155], v[120:123]
v_rcp_f32 v96, v96
v_mfma_f32_16x16x32_bf16 v[136:139], a[120:123], a[152:155], v[136:139]
v_rcp_f32 v97, v97
v_mfma_f32_16x16x32_bf16 v[152:155], a[124:127], a[152:155], v[152:155]
v_rcp_f32 v98, v98
v_mfma_f32_16x16x32_bf16 v[104:107], a[0:3], a[168:171], v[104:107]
v_rcp_f32 v99, v99
v_mfma_f32_16x16x32_bf16 v[120:123], a[4:7], a[168:171], v[120:123]
v_rcp_f32 v112, v112
v_mfma_f32_16x16x32_bf16 v[136:139], a[8:11], a[168:171], v[136:139]
v_rcp_f32 v113, v113
v_mfma_f32_16x16x32_bf16 v[152:155], a[12:15], a[168:171], v[152:155]
v_rcp_f32 v114, v114
v_mfma_f32_16x16x32_bf16 v[104:107], a[16:19], a[184:187], v[104:107]
v_rcp_f32 v115, v115
v_mfma_f32_16x16x32_bf16 v[120:123], a[20:23], a[184:187], v[120:123]
v_exp_f32 v100, v100
v_mfma_f32_16x16x32_bf16 v[136:139], a[24:27], a[184:187], v[136:139]
v_exp_f32 v101, v101
v_mfma_f32_16x16x32_bf16 v[152:155], a[28:31], a[184:187], v[152:155]
v_exp_f32 v102, v102
v_exp_f32 v103, v103
v_exp_f32 v116, v116
v_exp_f32 v117, v117
v_exp_f32 v118, v118
v_exp_f32 v119, v119
v_pk_mul_f32 v[128:129], v[128:129], v[96:97]
v_pk_mul_f32 v[130:131], v[130:131], v[98:99]
v_pk_mul_f32 v[144:145], v[144:145], v[112:113]
v_pk_mul_f32 v[146:147], v[146:147], v[114:115]
ds_read_b128 v[112:115], v9 offset:256
v_pk_fma_f32 v[104:105], v[48:49], v[24:25], v[104:105] op_sel_hi:[1,0,1]
v_pk_fma_f32 v[106:107], v[50:51], v[24:25], v[106:107] op_sel_hi:[1,0,1]
v_pk_fma_f32 v[120:121], v[64:65], v[24:25], v[120:121] op_sel_hi:[1,0,1]
v_pk_fma_f32 v[122:123], v[66:67], v[24:25], v[122:123] op_sel_hi:[1,0,1]
v_pk_fma_f32 v[136:137], v[80:81], v[24:25], v[136:137] op_sel_hi:[1,0,1]
v_pk_fma_f32 v[138:139], v[82:83], v[24:25], v[138:139] op_sel_hi:[1,0,1]
v_pk_fma_f32 v[152:153], v[4:5], v[24:25], v[152:153] op_sel_hi:[1,0,1]
v_pk_fma_f32 v[154:155], v[6:7], v[24:25], v[154:155] op_sel_hi:[1,0,1]
v_pk_mul_f32 v[136:137], v[136:137], v[104:105]
v_pk_mul_f32 v[104:105], v[104:105], v[30:31] op_sel_hi:[1,0]
v_pk_mul_f32 v[138:139], v[138:139], v[106:107]
v_pk_mul_f32 v[106:107], v[106:107], v[30:31] op_sel_hi:[1,0]
v_pk_mul_f32 v[152:153], v[152:153], v[120:121]
v_pk_mul_f32 v[120:121], v[120:121], v[30:31] op_sel_hi:[1,0]
v_pk_mul_f32 v[154:155], v[154:155], v[122:123]
v_pk_mul_f32 v[122:123], v[122:123], v[30:31] op_sel_hi:[1,0]
v_pk_fma_f32 v[100:101], v[100:101], v[22:23], v[22:23] op_sel:[0,1,1] op_sel_hi:[1,1,1]
v_pk_fma_f32 v[102:103], v[102:103], v[22:23], v[22:23] op_sel:[0,1,1] op_sel_hi:[1,1,1]
v_pk_fma_f32 v[116:117], v[116:117], v[22:23], v[22:23] op_sel:[0,1,1] op_sel_hi:[1,1,1]
v_pk_fma_f32 v[118:119], v[118:119], v[22:23], v[22:23] op_sel:[0,1,1] op_sel_hi:[1,1,1]
v_cvt_pk_bf16_f32 v96, v128, v129
v_cvt_pk_bf16_f32 v97, v130, v131
ds_read_b128 v[128:131], v9 offset:320
v_cvt_pk_bf16_f32 v98, v144, v145
v_cvt_pk_bf16_f32 v99, v146, v147
v_mfma_f32_16x16x32_bf16 v[108:111], a[112:115], a[156:159], v[108:111]
buffer_store_dwordx4 v[96:99], v10, s[16:19], s63 offen sc1
v_mfma_f32_16x16x32_bf16 v[124:127], a[116:119], a[156:159], v[124:127]
ds_read_b128 v[144:147], v9 offset:768
v_rcp_f32 v100, v100
v_mfma_f32_16x16x32_bf16 v[140:143], a[120:123], a[156:159], v[140:143]
ds_read_b64_tr_b16 a[112:113], v17 offset:50688
v_rcp_f32 v101, v101
v_mfma_f32_16x16x32_bf16 v[156:159], a[124:127], a[156:159], v[156:159]
ds_read_b64_tr_b16 a[114:115], v17 offset:51200
v_rcp_f32 v102, v102
v_mfma_f32_16x16x32_bf16 v[108:111], a[0:3], a[172:175], v[108:111]
ds_read_b64_tr_b16 a[116:117], v17 offset:50720
v_rcp_f32 v103, v103
v_mfma_f32_16x16x32_bf16 v[124:127], a[4:7], a[172:175], v[124:127]
ds_read_b64_tr_b16 a[118:119], v17 offset:51232
v_rcp_f32 v116, v116
v_mfma_f32_16x16x32_bf16 v[140:143], a[8:11], a[172:175], v[140:143]
ds_read_b64_tr_b16 a[120:121], v17 offset:59136
v_rcp_f32 v117, v117
v_mfma_f32_16x16x32_bf16 v[156:159], a[12:15], a[172:175], v[156:159]
ds_read_b64_tr_b16 a[122:123], v17 offset:59648
v_rcp_f32 v118, v118
v_mfma_f32_16x16x32_bf16 v[108:111], a[16:19], a[188:191], v[108:111]
ds_read_b64_tr_b16 a[124:125], v17 offset:59168
v_rcp_f32 v119, v119
v_mfma_f32_16x16x32_bf16 v[124:127], a[20:23], a[188:191], v[124:127]
ds_read_b64_tr_b16 a[126:127], v17 offset:59680
v_exp_f32 v104, v104
v_mfma_f32_16x16x32_bf16 v[140:143], a[24:27], a[188:191], v[140:143]
v_exp_f32 v105, v105
v_mfma_f32_16x16x32_bf16 v[156:159], a[28:31], a[188:191], v[156:159]
v_exp_f32 v106, v106
v_exp_f32 v107, v107
v_exp_f32 v120, v120
v_exp_f32 v121, v121
v_exp_f32 v122, v122
v_exp_f32 v123, v123
v_pk_mul_f32 v[132:133], v[132:133], v[100:101]
v_pk_mul_f32 v[134:135], v[134:135], v[102:103]
v_pk_mul_f32 v[148:149], v[148:149], v[116:117]
v_pk_mul_f32 v[150:151], v[150:151], v[118:119]
v_pk_fma_f32 v[108:109], v[48:49], v[26:27], v[108:109] op_sel_hi:[1,0,1]
v_pk_fma_f32 v[110:111], v[50:51], v[26:27], v[110:111] op_sel_hi:[1,0,1]
v_pk_fma_f32 v[124:125], v[64:65], v[26:27], v[124:125] op_sel_hi:[1,0,1]
v_pk_fma_f32 v[126:127], v[66:67], v[26:27], v[126:127] op_sel_hi:[1,0,1]
v_pk_fma_f32 v[140:141], v[80:81], v[26:27], v[140:141] op_sel_hi:[1,0,1]
v_pk_fma_f32 v[142:143], v[82:83], v[26:27], v[142:143] op_sel_hi:[1,0,1]
s_waitcnt lgkmcnt(0)
s_barrier
v_pk_fma_f32 v[156:157], v[4:5], v[26:27], v[156:157] op_sel_hi:[1,0,1]
v_pk_fma_f32 v[158:159], v[6:7], v[26:27], v[158:159] op_sel_hi:[1,0,1]
ds_read_b128 v[4:7], v8 offset:576
v_pk_mul_f32 v[140:141], v[140:141], v[108:109]
v_pk_mul_f32 v[108:109], v[108:109], v[30:31] op_sel:[0,1] op_sel_hi:[1,1]
v_pk_mul_f32 v[142:143], v[142:143], v[110:111]
v_pk_mul_f32 v[110:111], v[110:111], v[30:31] op_sel:[0,1] op_sel_hi:[1,1]
v_pk_mul_f32 v[156:157], v[156:157], v[124:125]
v_pk_mul_f32 v[124:125], v[124:125], v[30:31] op_sel:[0,1] op_sel_hi:[1,1]
v_pk_mul_f32 v[158:159], v[158:159], v[126:127]
v_pk_mul_f32 v[126:127], v[126:127], v[30:31] op_sel:[0,1] op_sel_hi:[1,1]
v_pk_fma_f32 v[104:105], v[104:105], v[24:25], v[24:25] op_sel:[0,1,1] op_sel_hi:[1,1,1]
v_pk_fma_f32 v[106:107], v[106:107], v[24:25], v[24:25] op_sel:[0,1,1] op_sel_hi:[1,1,1]
v_pk_fma_f32 v[120:121], v[120:121], v[24:25], v[24:25] op_sel:[0,1,1] op_sel_hi:[1,1,1]
v_pk_fma_f32 v[122:123], v[122:123], v[24:25], v[24:25] op_sel:[0,1,1] op_sel_hi:[1,1,1]
v_cvt_pk_bf16_f32 v100, v132, v133
v_cvt_pk_bf16_f32 v101, v134, v135
v_cvt_pk_bf16_f32 v102, v148, v149
v_cvt_pk_bf16_f32 v103, v150, v151
v_mfma_f32_16x16x32_bf16 v[160:163], a[32:35], a[144:147], v[160:163]
buffer_store_dwordx4 v[100:103], v10, s[16:19], s63 offen offset:1024 sc1
v_mfma_f32_16x16x32_bf16 v[176:179], a[36:39], a[144:147], v[176:179]
s_add_u32 m0, s59, 84480
v_rcp_f32 v104, v104
v_mfma_f32_16x16x32_bf16 v[192:195], a[40:43], a[144:147], v[192:195]
v_rcp_f32 v105, v105
v_mfma_f32_16x16x32_bf16 v[208:211], a[44:47], a[144:147], v[208:211]
v_rcp_f32 v106, v106
v_mfma_f32_16x16x32_bf16 v[160:163], a[48:51], a[160:163], v[160:163]
buffer_load_dwordx4 v18, s[28:31], s58 offen lds
v_mfma_f32_16x16x32_bf16 v[176:179], a[52:55], a[160:163], v[176:179]
v_rcp_f32 v107, v107
v_mfma_f32_16x16x32_bf16 v[192:195], a[56:59], a[160:163], v[192:195]
v_rcp_f32 v120, v120
v_mfma_f32_16x16x32_bf16 v[208:211], a[60:63], a[160:163], v[208:211]
v_rcp_f32 v121, v121
v_mfma_f32_16x16x32_bf16 v[160:163], a[64:67], a[176:179], v[160:163]
buffer_load_dwordx4 v19, s[28:31], s58 offen offset:1056 lds
v_mfma_f32_16x16x32_bf16 v[176:179], a[68:71], a[176:179], v[176:179]
s_add_u32 m0, s59, 92928
s_mov_b32 s58, 720896
v_rcp_f32 v122, v122
v_mfma_f32_16x16x32_bf16 v[192:195], a[72:75], a[176:179], v[192:195]
v_rcp_f32 v123, v123
.Lpad5:
s_cbranch_execz .Lnopoll40r
v_mfma_f32_16x16x32_bf16 v[208:211], a[76:79], a[176:179], v[208:211]
v_exp_f32 v108, v108
v_exp_f32 v109, v109
v_exp_f32 v110, v110
v_exp_f32 v111, v111
v_exp_f32 v124, v124
v_exp_f32 v125, v125
v_exp_f32 v126, v126
v_exp_f32 v127, v127
v_pk_mul_f32 v[136:137], v[136:137], v[104:105]
v_pk_mul_f32 v[138:139], v[138:139], v[106:107]
v_pk_mul_f32 v[152:153], v[152:153], v[120:121]
v_pk_mul_f32 v[154:155], v[154:155], v[122:123]
v_pk_fma_f32 v[160:161], v[112:113], v[20:21], v[160:161] op_sel_hi:[1,0,1]
v_pk_fma_f32 v[162:163], v[114:115], v[20:21], v[162:163] op_sel_hi:[1,0,1]
v_pk_fma_f32 v[176:177], v[128:129], v[20:21], v[176:177] op_sel_hi:[1,0,1]
v_pk_fma_f32 v[178:179], v[130:131], v[20:21], v[178:179] op_sel_hi:[1,0,1]
v_pk_fma_f32 v[192:193], v[144:145], v[20:21], v[192:193] op_sel_hi:[1,0,1]
v_pk_fma_f32 v[194:195], v[146:147], v[20:21], v[194:195] op_sel_hi:[1,0,1]
v_pk_fma_f32 v[208:209], v[12:13], v[20:21], v[208:209] op_sel_hi:[1,0,1]
v_pk_fma_f32 v[210:211], v[14:15], v[20:21], v[210:211] op_sel_hi:[1,0,1]
v_pk_mul_f32 v[192:193], v[192:193], v[160:161]
v_pk_mul_f32 v[160:161], v[160:161], v[28:29] op_sel_hi:[1,0]
v_pk_mul_f32 v[194:195], v[194:195], v[162:163]
v_pk_mul_f32 v[162:163], v[162:163], v[28:29] op_sel_hi:[1,0]
v_pk_mul_f32 v[208:209], v[208:209], v[176:177]
v_pk_mul_f32 v[176:177], v[176:177], v[28:29] op_sel_hi:[1,0]
v_pk_mul_f32 v[210:211], v[210:211], v[178:179]
v_pk_mul_f32 v[178:179], v[178:179], v[28:29] op_sel_hi:[1,0]
v_pk_fma_f32 v[108:109], v[108:109], v[26:27], v[26:27] op_sel:[0,1,1] op_sel_hi:[1,1,1]
v_pk_fma_f32 v[110:111], v[110:111], v[26:27], v[26:27] op_sel:[0,1,1] op_sel_hi:[1,1,1]
v_pk_fma_f32 v[124:125], v[124:125], v[26:27], v[26:27] op_sel:[0,1,1] op_sel_hi:[1,1,1]
v_pk_fma_f32 v[126:127], v[126:127], v[26:27], v[26:27] op_sel:[0,1,1] op_sel_hi:[1,1,1]
v_cvt_pk_bf16_f32 v104, v136, v137
v_cvt_pk_bf16_f32 v105, v138, v139
v_cvt_pk_bf16_f32 v106, v152, v153
v_cvt_pk_bf16_f32 v107, v154, v155
v_mfma_f32_16x16x32_bf16 v[164:167], a[32:35], a[148:151], v[164:167]
buffer_store_dwordx4 v[104:107], v11, s[16:19], s63 offen sc1
v_mfma_f32_16x16x32_bf16 v[180:183], a[36:39], a[148:151], v[180:183]
v_rcp_f32 v108, v108
v_mfma_f32_16x16x32_bf16 v[196:199], a[40:43], a[148:151], v[196:199]
v_rcp_f32 v109, v109
v_mfma_f32_16x16x32_bf16 v[212:215], a[44:47], a[148:151], v[212:215]
v_rcp_f32 v110, v110
v_mfma_f32_16x16x32_bf16 v[164:167], a[48:51], a[164:167], v[164:167]
buffer_load_dwordx4 v18, s[28:31], s58 offen lds
v_mfma_f32_16x16x32_bf16 v[180:183], a[52:55], a[164:167], v[180:183]
v_rcp_f32 v111, v111
v_mfma_f32_16x16x32_bf16 v[196:199], a[56:59], a[164:167], v[196:199]
v_rcp_f32 v124, v124
v_mfma_f32_16x16x32_bf16 v[212:215], a[60:63], a[164:167], v[212:215]
v_rcp_f32 v125, v125
v_mfma_f32_16x16x32_bf16 v[164:167], a[64:67], a[180:183], v[164:167]
buffer_load_dwordx4 v19, s[28:31], s58 offen offset:1056 lds
v_mfma_f32_16x16x32_bf16 v[180:183], a[68:71], a[180:183], v[180:183]
s_add_u32 m0, s59, 101376
s_mov_b32 s58, 786432
v_rcp_f32 v126, v126
v_mfma_f32_16x16x32_bf16 v[196:199], a[72:75], a[180:183], v[196:199]
v_rcp_f32 v127, v127
v_mfma_f32_16x16x32_bf16 v[212:215], a[76:79], a[180:183], v[212:215]
v_exp_f32 v160, v160
v_exp_f32 v161, v161
v_exp_f32 v162, v162
v_exp_f32 v163, v163
v_exp_f32 v176, v176
v_exp_f32 v177, v177
v_exp_f32 v178, v178
v_exp_f32 v179, v179
v_pk_mul_f32 v[140:141], v[140:141], v[108:109]
v_pk_mul_f32 v[142:143], v[142:143], v[110:111]
v_pk_mul_f32 v[156:157], v[156:157], v[124:125]
v_pk_mul_f32 v[158:159], v[158:159], v[126:127]
v_pk_fma_f32 v[164:165], v[112:113], v[22:23], v[164:165] op_sel_hi:[1,0,1]
v_pk_fma_f32 v[166:167], v[114:115], v[22:23], v[166:167] op_sel_hi:[1,0,1]
v_pk_fma_f32 v[180:181], v[128:129], v[22:23], v[180:181] op_sel_hi:[1,0,1]
v_pk_fma_f32 v[182:183], v[130:131], v[22:23], v[182:183] op_sel_hi:[1,0,1]
v_pk_fma_f32 v[196:197], v[144:145], v[22:23], v[196:197] op_sel_hi:[1,0,1]
v_pk_fma_f32 v[198:199], v[146:147], v[22:23], v[198:199] op_sel_hi:[1,0,1]
v_pk_fma_f32 v[212:213], v[12:13], v[22:23], v[212:213] op_sel_hi:[1,0,1]
v_pk_fma_f32 v[214:215], v[14:15], v[22:23], v[214:215] op_sel_hi:[1,0,1]
v_pk_mul_f32 v[196:197], v[196:197], v[164:165]
v_pk_mul_f32 v[164:165], v[164:165], v[28:29] op_sel:[0,1] op_sel_hi:[1,1]
v_pk_mul_f32 v[198:199], v[198:199], v[166:167]
v_pk_mul_f32 v[166:167], v[166:167], v[28:29] op_sel:[0,1] op_sel_hi:[1,1]
v_pk_mul_f32 v[212:213], v[212:213], v[180:181]
v_pk_mul_f32 v[180:181], v[180:181], v[28:29] op_sel:[0,1] op_sel_hi:[1,1]
v_pk_mul_f32 v[214:215], v[214:215], v[182:183]
v_pk_mul_f32 v[182:183], v[182:183], v[28:29] op_sel:[0,1] op_sel_hi:[1,1]
v_pk_fma_f32 v[160:161], v[160:161], v[20:21], v[20:21] op_sel:[0,1,1] op_sel_hi:[1,1,1]
v_pk_fma_f32 v[162:163], v[162:163], v[20:21], v[20:21] op_sel:[0,1,1] op_sel_hi:[1,1,1]
v_pk_fma_f32 v[176:177], v[176:177], v[20:21], v[20:21] op_sel:[0,1,1] op_sel_hi:[1,1,1]
v_pk_fma_f32 v[178:179], v[178:179], v[20:21], v[20:21] op_sel:[0,1,1] op_sel_hi:[1,1,1]
v_cvt_pk_bf16_f32 v108, v140, v141
v_cvt_pk_bf16_f32 v109, v142, v143
v_cvt_pk_bf16_f32 v110, v156, v157
v_cvt_pk_bf16_f32 v111, v158, v159
v_mfma_f32_16x16x32_bf16 v[168:171], a[32:35], a[152:155], v[168:171]
buffer_store_dwordx4 v[108:111], v11, s[16:19], s63 offen offset:1024 sc1
v_mfma_f32_16x16x32_bf16 v[184:187], a[36:39], a[152:155], v[184:187]
v_rcp_f32 v160, v160
v_mfma_f32_16x16x32_bf16 v[200:203], a[40:43], a[152:155], v[200:203]
v_rcp_f32 v161, v161
v_mfma_f32_16x16x32_bf16 v[216:219], a[44:47], a[152:155], v[216:219]
v_rcp_f32 v162, v162
v_mfma_f32_16x16x32_bf16 v[168:171], a[48:51], a[168:171], v[168:171]
buffer_load_dwordx4 v18, s[28:31], s58 offen lds
v_mfma_f32_16x16x32_bf16 v[184:187], a[52:55], a[168:171], v[184:187]
v_rcp_f32 v163, v163
v_mfma_f32_16x16x32_bf16 v[200:203], a[56:59], a[168:171], v[200:203]
v_rcp_f32 v176, v176
v_mfma_f32_16x16x32_bf16 v[216:219], a[60:63], a[168:171], v[216:219]
v_rcp_f32 v177, v177
v_mfma_f32_16x16x32_bf16 v[168:171], a[64:67], a[184:187], v[168:171]
buffer_load_dwordx4 v19, s[28:31], s58 offen offset:1056 lds
v_mfma_f32_16x16x32_bf16 v[184:187], a[68:71], a[184:187], v[184:187]
s_add_u32 m0, s59, 109824
s_mov_b32 s58, 851968
v_rcp_f32 v178, v178
v_mfma_f32_16x16x32_bf16 v[200:203], a[72:75], a[184:187], v[200:203]
v_rcp_f32 v179, v179
v_mfma_f32_16x16x32_bf16 v[216:219], a[76:79], a[184:187], v[216:219]
v_exp_f32 v164, v164
v_exp_f32 v165, v165
v_exp_f32 v166, v166
v_exp_f32 v167, v167
v_exp_f32 v180, v180
v_exp_f32 v181, v181
v_exp_f32 v182, v182
v_exp_f32 v183, v183
v_pk_mul_f32 v[192:193], v[192:193], v[160:161]
v_pk_mul_f32 v[194:195], v[194:195], v[162:163]
v_pk_mul_f32 v[208:209], v[208:209], v[176:177]
v_pk_mul_f32 v[210:211], v[210:211], v[178:179]
ds_read_b128 v[176:179], v8
v_pk_fma_f32 v[168:169], v[112:113], v[24:25], v[168:169] op_sel_hi:[1,0,1]
v_pk_fma_f32 v[170:171], v[114:115], v[24:25], v[170:171] op_sel_hi:[1,0,1]
v_pk_fma_f32 v[184:185], v[128:129], v[24:25], v[184:185] op_sel_hi:[1,0,1]
v_pk_fma_f32 v[186:187], v[130:131], v[24:25], v[186:187] op_sel_hi:[1,0,1]
v_pk_fma_f32 v[200:201], v[144:145], v[24:25], v[200:201] op_sel_hi:[1,0,1]
v_pk_fma_f32 v[202:203], v[146:147], v[24:25], v[202:203] op_sel_hi:[1,0,1]
v_pk_fma_f32 v[216:217], v[12:13], v[24:25], v[216:217] op_sel_hi:[1,0,1]
v_pk_fma_f32 v[218:219], v[14:15], v[24:25], v[218:219] op_sel_hi:[1,0,1]
v_pk_mul_f32 v[200:201], v[200:201], v[168:169]
v_pk_mul_f32 v[168:169], v[168:169], v[30:31] op_sel_hi:[1,0]
v_pk_mul_f32 v[202:203], v[202:203], v[170:171]
v_pk_mul_f32 v[170:171], v[170:171], v[30:31] op_sel_hi:[1,0]
v_pk_mul_f32 v[216:217], v[216:217], v[184:185]
v_pk_mul_f32 v[184:185], v[184:185], v[30:31] op_sel_hi:[1,0]
v_pk_mul_f32 v[218:219], v[218:219], v[186:187]
v_pk_mul_f32 v[186:187], v[186:187], v[30:31] op_sel_hi:[1,0]
v_pk_fma_f32 v[164:165], v[164:165], v[22:23], v[22:23] op_sel:[0,1,1] op_sel_hi:[1,1,1]
v_pk_fma_f32 v[166:167], v[166:167], v[22:23], v[22:23] op_sel:[0,1,1] op_sel_hi:[1,1,1]
v_pk_fma_f32 v[180:181], v[180:181], v[22:23], v[22:23] op_sel:[0,1,1] op_sel_hi:[1,1,1]
v_pk_fma_f32 v[182:183], v[182:183], v[22:23], v[22:23] op_sel:[0,1,1] op_sel_hi:[1,1,1]
v_cvt_pk_bf16_f32 v160, v192, v193
v_cvt_pk_bf16_f32 v161, v194, v195
ds_read_b128 v[192:195], v8 offset:64
v_cvt_pk_bf16_f32 v162, v208, v209
v_cvt_pk_bf16_f32 v163, v210, v211
v_mfma_f32_16x16x32_bf16 v[172:175], a[32:35], a[156:159], v[172:175]
buffer_store_dwordx4 v[160:163], v10, s[16:19], s64 offen sc1
v_mfma_f32_16x16x32_bf16 v[188:191], a[36:39], a[156:159], v[188:191]
ds_read_b128 v[208:211], v8 offset:512
v_rcp_f32 v164, v164
v_mfma_f32_16x16x32_bf16 v[204:207], a[40:43], a[156:159], v[204:207]
v_rcp_f32 v165, v165
v_mfma_f32_16x16x32_bf16 v[220:223], a[44:47], a[156:159], v[220:223]
v_rcp_f32 v166, v166
v_mfma_f32_16x16x32_bf16 v[172:175], a[48:51], a[172:175], v[172:175]
buffer_load_dwordx4 v18, s[28:31], s58 offen lds
v_mfma_f32_16x16x32_bf16 v[188:191], a[52:55], a[172:175], v[188:191]
v_rcp_f32 v167, v167
v_mfma_f32_16x16x32_bf16 v[204:207], a[56:59], a[172:175], v[204:207]
v_rcp_f32 v180, v180
v_mfma_f32_16x16x32_bf16 v[220:223], a[60:63], a[172:175], v[220:223]
v_rcp_f32 v181, v181
v_mfma_f32_16x16x32_bf16 v[172:175], a[64:67], a[188:191], v[172:175]
buffer_load_dwordx4 v19, s[28:31], s58 offen offset:1056 lds
v_mfma_f32_16x16x32_bf16 v[188:191], a[68:71], a[188:191], v[188:191]
v_rcp_f32 v182, v182
v_mfma_f32_16x16x32_bf16 v[204:207], a[72:75], a[188:191], v[204:207]
v_rcp_f32 v183, v183
v_mfma_f32_16x16x32_bf16 v[220:223], a[76:79], a[188:191], v[220:223]
v_exp_f32 v168, v168
v_exp_f32 v169, v169
v_exp_f32 v170, v170
v_exp_f32 v171, v171
v_exp_f32 v184, v184
v_exp_f32 v185, v185
v_exp_f32 v186, v186
v_exp_f32 v187, v187
v_pk_mul_f32 v[196:197], v[196:197], v[164:165]
v_pk_mul_f32 v[198:199], v[198:199], v[166:167]
v_pk_mul_f32 v[212:213], v[212:213], v[180:181]
v_pk_mul_f32 v[214:215], v[214:215], v[182:183]
v_pk_fma_f32 v[172:173], v[112:113], v[26:27], v[172:173] op_sel_hi:[1,0,1]
v_pk_fma_f32 v[174:175], v[114:115], v[26:27], v[174:175] op_sel_hi:[1,0,1]
v_pk_fma_f32 v[188:189], v[128:129], v[26:27], v[188:189] op_sel_hi:[1,0,1]
v_pk_fma_f32 v[190:191], v[130:131], v[26:27], v[190:191] op_sel_hi:[1,0,1]
v_pk_fma_f32 v[204:205], v[144:145], v[26:27], v[204:205] op_sel_hi:[1,0,1]
v_pk_fma_f32 v[206:207], v[146:147], v[26:27], v[206:207] op_sel_hi:[1,0,1]
v_pk_fma_f32 v[220:221], v[12:13], v[26:27], v[220:221] op_sel_hi:[1,0,1]
v_pk_fma_f32 v[222:223], v[14:15], v[26:27], v[222:223] op_sel_hi:[1,0,1]
v_pk_mul_f32 v[204:205], v[204:205], v[172:173]
v_pk_mul_f32 v[172:173], v[172:173], v[30:31] op_sel:[0,1] op_sel_hi:[1,1]
v_pk_mul_f32 v[206:207], v[206:207], v[174:175]
v_pk_mul_f32 v[174:175], v[174:175], v[30:31] op_sel:[0,1] op_sel_hi:[1,1]
v_pk_mul_f32 v[220:221], v[220:221], v[188:189]
v_pk_mul_f32 v[188:189], v[188:189], v[30:31] op_sel:[0,1] op_sel_hi:[1,1]
v_pk_mul_f32 v[222:223], v[222:223], v[190:191]
v_pk_mul_f32 v[190:191], v[190:191], v[30:31] op_sel:[0,1] op_sel_hi:[1,1]
v_pk_fma_f32 v[168:169], v[168:169], v[24:25], v[24:25] op_sel:[0,1,1] op_sel_hi:[1,1,1]
v_pk_fma_f32 v[170:171], v[170:171], v[24:25], v[24:25] op_sel:[0,1,1] op_sel_hi:[1,1,1]
v_pk_fma_f32 v[184:185], v[184:185], v[24:25], v[24:25] op_sel:[0,1,1] op_sel_hi:[1,1,1]
v_pk_fma_f32 v[186:187], v[186:187], v[24:25], v[24:25] op_sel:[0,1,1] op_sel_hi:[1,1,1]
v_cvt_pk_bf16_f32 v164, v196, v197
v_cvt_pk_bf16_f32 v165, v198, v199
v_cvt_pk_bf16_f32 v166, v212, v213
v_cvt_pk_bf16_f32 v167, v214, v215
v_mfma_f32_16x16x32_bf16 v[224:227], a[80:83], a[144:147], v[224:227]
buffer_store_dwordx4 v[164:167], v10, s[16:19], s64 offen offset:1024 sc1
v_mfma_f32_16x16x32_bf16 v[232:235], a[84:87], a[144:147], v[232:235]
v_rcp_f32 v168, v168
v_mfma_f32_16x16x32_bf16 v[240:243], a[88:91], a[144:147], v[240:243]
v_rcp_f32 v169, v169
v_mfma_f32_16x16x32_bf16 v[248:251], a[92:95], a[144:147], v[248:251]
v_rcp_f32 v170, v170
v_mfma_f32_16x16x32_bf16 v[224:227], a[96:99], a[160:163], v[224:227]
v_rcp_f32 v171, v171
v_mfma_f32_16x16x32_bf16 v[232:235], a[100:103], a[160:163], v[232:235]
v_rcp_f32 v184, v184
v_mfma_f32_16x16x32_bf16 v[240:243], a[104:107], a[160:163], v[240:243]
v_rcp_f32 v185, v185
v_mfma_f32_16x16x32_bf16 v[248:251], a[108:111], a[160:163], v[248:251]
v_rcp_f32 v186, v186
v_mfma_f32_16x16x32_bf16 v[224:227], a[112:115], a[176:179], v[224:227]
v_rcp_f32 v187, v187
v_mfma_f32_16x16x32_bf16 v[232:235], a[116:119], a[176:179], v[232:235]
v_exp_f32 v172, v172
v_mfma_f32_16x16x32_bf16 v[240:243], a[120:123], a[176:179], v[240:243]
v_exp_f32 v173, v173
v_mfma_f32_16x16x32_bf16 v[248:251], a[124:127], a[176:179], v[248:251]
v_exp_f32 v174, v174
v_exp_f32 v175, v175
v_exp_f32 v188, v188
v_exp_f32 v189, v189
v_exp_f32 v190, v190
v_exp_f32 v191, v191
v_pk_mul_f32 v[200:201], v[200:201], v[168:169]
v_pk_mul_f32 v[202:203], v[202:203], v[170:171]
v_pk_mul_f32 v[216:217], v[216:217], v[184:185]
v_pk_mul_f32 v[218:219], v[218:219], v[186:187]
s_waitcnt lgkmcnt(2)
v_pk_fma_f32 v[224:225], v[176:177], v[20:21], v[224:225] op_sel_hi:[1,0,1]
v_pk_fma_f32 v[226:227], v[178:179], v[20:21], v[226:227] op_sel_hi:[1,0,1]
s_waitcnt lgkmcnt(1)
v_pk_fma_f32 v[232:233], v[192:193], v[20:21], v[232:233] op_sel_hi:[1,0,1]
v_pk_fma_f32 v[234:235], v[194:195], v[20:21], v[234:235] op_sel_hi:[1,0,1]
s_waitcnt lgkmcnt(0)
v_pk_fma_f32 v[240:241], v[208:209], v[20:21], v[240:241] op_sel_hi:[1,0,1]
v_pk_fma_f32 v[242:243], v[210:211], v[20:21], v[242:243] op_sel_hi:[1,0,1]
v_pk_fma_f32 v[248:249], v[4:5], v[20:21], v[248:249] op_sel_hi:[1,0,1]
v_pk_fma_f32 v[250:251], v[6:7], v[20:21], v[250:251] op_sel_hi:[1,0,1]
v_pk_mul_f32 v[240:241], v[240:241], v[224:225]
v_pk_mul_f32 v[224:225], v[224:225], v[28:29] op_sel_hi:[1,0]
v_pk_mul_f32 v[242:243], v[242:243], v[226:227]
v_pk_mul_f32 v[226:227], v[226:227], v[28:29] op_sel_hi:[1,0]
v_pk_mul_f32 v[248:249], v[248:249], v[232:233]
v_pk_mul_f32 v[232:233], v[232:233], v[28:29] op_sel_hi:[1,0]
v_pk_mul_f32 v[250:251], v[250:251], v[234:235]
v_pk_mul_f32 v[234:235], v[234:235], v[28:29] op_sel_hi:[1,0]
v_pk_fma_f32 v[172:173], v[172:173], v[26:27], v[26:27] op_sel:[0,1,1] op_sel_hi:[1,1,1]
v_pk_fma_f32 v[174:175], v[174:175], v[26:27], v[26:27] op_sel:[0,1,1] op_sel_hi:[1,1,1]
v_pk_fma_f32 v[188:189], v[188:189], v[26:27], v[26:27] op_sel:[0,1,1] op_sel_hi:[1,1,1]
v_pk_fma_f32 v[190:191], v[190:191], v[26:27], v[26:27] op_sel:[0,1,1] op_sel_hi:[1,1,1]
v_cvt_pk_bf16_f32 v168, v200, v201
v_cvt_pk_bf16_f32 v169, v202, v203
v_cvt_pk_bf16_f32 v170, v216, v217
v_cvt_pk_bf16_f32 v171, v218, v219
v_mfma_f32_16x16x32_bf16 v[228:231], a[80:83], a[148:151], v[228:231]
buffer_store_dwordx4 v[168:171], v11, s[16:19], s64 offen sc1
v_mfma_f32_16x16x32_bf16 v[236:239], a[84:87], a[148:151], v[236:239]
v_rcp_f32 v172, v172
v_mfma_f32_16x16x32_bf16 v[244:247], a[88:91], a[148:151], v[244:247]
v_rcp_f32 v173, v173
v_mfma_f32_16x16x32_bf16 v[252:255], a[92:95], a[148:151], v[252:255]
v_rcp_f32 v174, v174
v_mfma_f32_16x16x32_bf16 v[228:231], a[96:99], a[164:167], v[228:231]
v_rcp_f32 v175, v175
v_mfma_f32_16x16x32_bf16 v[236:239], a[100:103], a[164:167], v[236:239]
v_rcp_f32 v188, v188
v_mfma_f32_16x16x32_bf16 v[244:247], a[104:107], a[164:167], v[244:247]
v_rcp_f32 v189, v189
v_mfma_f32_16x16x32_bf16 v[252:255], a[108:111], a[164:167], v[252:255]
v_rcp_f32 v190, v190
v_mfma_f32_16x16x32_bf16 v[228:231], a[112:115], a[180:183], v[228:231]
v_rcp_f32 v191, v191
v_mfma_f32_16x16x32_bf16 v[236:239], a[116:119], a[180:183], v[236:239]
v_exp_f32 v224, v224
v_mfma_f32_16x16x32_bf16 v[244:247], a[120:123], a[180:183], v[244:247]
v_exp_f32 v225, v225
v_mfma_f32_16x16x32_bf16 v[252:255], a[124:127], a[180:183], v[252:255]
v_exp_f32 v226, v226
v_exp_f32 v227, v227
v_exp_f32 v232, v232
v_exp_f32 v233, v233
v_exp_f32 v234, v234
v_exp_f32 v235, v235
v_pk_mul_f32 v[204:205], v[204:205], v[172:173]
v_pk_mul_f32 v[206:207], v[206:207], v[174:175]
v_pk_mul_f32 v[220:221], v[220:221], v[188:189]
v_pk_mul_f32 v[222:223], v[222:223], v[190:191]
v_pk_fma_f32 v[228:229], v[176:177], v[22:23], v[228:229] op_sel_hi:[1,0,1]
v_pk_fma_f32 v[230:231], v[178:179], v[22:23], v[230:231] op_sel_hi:[1,0,1]
v_pk_fma_f32 v[236:237], v[192:193], v[22:23], v[236:237] op_sel_hi:[1,0,1]
v_pk_fma_f32 v[238:239], v[194:195], v[22:23], v[238:239] op_sel_hi:[1,0,1]
v_pk_fma_f32 v[244:245], v[208:209], v[22:23], v[244:245] op_sel_hi:[1,0,1]
v_pk_fma_f32 v[246:247], v[210:211], v[22:23], v[246:247] op_sel_hi:[1,0,1]
v_pk_fma_f32 v[252:253], v[4:5], v[22:23], v[252:253] op_sel_hi:[1,0,1]
v_pk_fma_f32 v[254:255], v[6:7], v[22:23], v[254:255] op_sel_hi:[1,0,1]
v_pk_mul_f32 v[244:245], v[244:245], v[228:229]
v_pk_mul_f32 v[228:229], v[228:229], v[28:29] op_sel:[0,1] op_sel_hi:[1,1]
v_pk_mul_f32 v[246:247], v[246:247], v[230:231]
v_pk_mul_f32 v[230:231], v[230:231], v[28:29] op_sel:[0,1] op_sel_hi:[1,1]
v_pk_mul_f32 v[252:253], v[252:253], v[236:237]
v_pk_mul_f32 v[236:237], v[236:237], v[28:29] op_sel:[0,1] op_sel_hi:[1,1]
v_pk_mul_f32 v[254:255], v[254:255], v[238:239]
v_pk_mul_f32 v[238:239], v[238:239], v[28:29] op_sel:[0,1] op_sel_hi:[1,1]
v_pk_fma_f32 v[224:225], v[224:225], v[20:21], v[20:21] op_sel:[0,1,1] op_sel_hi:[1,1,1]
v_pk_fma_f32 v[226:227], v[226:227], v[20:21], v[20:21] op_sel:[0,1,1] op_sel_hi:[1,1,1]
v_pk_fma_f32 v[232:233], v[232:233], v[20:21], v[20:21] op_sel:[0,1,1] op_sel_hi:[1,1,1]
v_pk_fma_f32 v[234:235], v[234:235], v[20:21], v[20:21] op_sel:[0,1,1] op_sel_hi:[1,1,1]
v_cvt_pk_bf16_f32 v172, v204, v205
v_cvt_pk_bf16_f32 v173, v206, v207
v_cvt_pk_bf16_f32 v174, v220, v221
v_cvt_pk_bf16_f32 v175, v222, v223
buffer_store_dwordx4 v[172:175], v11, s[16:19], s64 offen offset:1024 sc1
v_rcp_f32 v224, v224
v_rcp_f32 v225, v225
v_rcp_f32 v226, v226
v_rcp_f32 v227, v227
v_rcp_f32 v232, v232
v_rcp_f32 v233, v233
v_rcp_f32 v234, v234
v_rcp_f32 v235, v235
v_exp_f32 v228, v228
v_exp_f32 v229, v229
v_exp_f32 v230, v230
v_exp_f32 v231, v231
v_exp_f32 v236, v236
v_exp_f32 v237, v237
v_exp_f32 v238, v238
v_exp_f32 v239, v239
v_pk_mul_f32 v[240:241], v[240:241], v[224:225]
v_pk_mul_f32 v[242:243], v[242:243], v[226:227]
v_pk_mul_f32 v[248:249], v[248:249], v[232:233]
v_pk_mul_f32 v[250:251], v[250:251], v[234:235]
v_pk_fma_f32 v[228:229], v[228:229], v[22:23], v[22:23] op_sel:[0,1,1] op_sel_hi:[1,1,1]
v_pk_fma_f32 v[230:231], v[230:231], v[22:23], v[22:23] op_sel:[0,1,1] op_sel_hi:[1,1,1]
v_pk_fma_f32 v[236:237], v[236:237], v[22:23], v[22:23] op_sel:[0,1,1] op_sel_hi:[1,1,1]
v_pk_fma_f32 v[238:239], v[238:239], v[22:23], v[22:23] op_sel:[0,1,1] op_sel_hi:[1,1,1]
v_cvt_pk_bf16_f32 v224, v240, v241
v_cvt_pk_bf16_f32 v225, v242, v243
v_cvt_pk_bf16_f32 v226, v248, v249
v_cvt_pk_bf16_f32 v227, v250, v251
buffer_store_dwordx4 v[224:227], v10, s[16:19], s65 offen sc1
v_rcp_f32 v228, v228
v_rcp_f32 v229, v229
v_rcp_f32 v230, v230
v_rcp_f32 v231, v231
v_rcp_f32 v236, v236
v_rcp_f32 v237, v237
v_rcp_f32 v238, v238
v_rcp_f32 v239, v239
v_pk_mul_f32 v[244:245], v[244:245], v[228:229]
v_pk_mul_f32 v[246:247], v[246:247], v[230:231]
v_pk_mul_f32 v[252:253], v[252:253], v[236:237]
v_pk_mul_f32 v[254:255], v[254:255], v[238:239]
v_cvt_pk_bf16_f32 v228, v244, v245
v_cvt_pk_bf16_f32 v229, v246, v247
v_cvt_pk_bf16_f32 v230, v252, v253
v_cvt_pk_bf16_f32 v231, v254, v255
buffer_store_dwordx4 v[228:231], v10, s[16:19], s65 offen offset:1024 sc1
s_nop 1
s_branch .Lj47
.Lpad6:
s_cbranch_execz .Lnopoll40r
.Lx43:
buffer_load_dword v4, v8, s[32:35], s45 offen
buffer_load_dword v4, v7, s[28:31], s44 offen
s_add_u32 s44, s44, 655360
s_add_u32 s45, s45, 917504
s_mov_b32 s47, 3
s_branch .Lx43b
.Lx44:
buffer_load_dword v4, v8, s[32:35], s45 offen
buffer_load_dword v4, v7, s[28:31], s44 offen
s_add_u32 s44, s44, 655360
s_add_u32 s45, s45, 917504
s_mov_b32 s47, 3
s_branch .Lx44b
.Lx45:
buffer_load_dword v4, v8, s[32:35], s45 offen
buffer_load_dword v4, v7, s[28:31], s44 offen
s_add_u32 s44, s44, 655360
s_add_u32 s45, s45, 917504
s_mov_b32 s47, 3
s_branch .Lx45b
.Lx46:
buffer_load_dword v4, v8, s[32:35], s45 offen
buffer_load_dword v4, v7, s[28:31], s44 offen
s_add_u32 s44, s44, 655360
s_add_u32 s45, s45, 917504
s_mov_b32 s47, 3
s_branch .Lx46b
.Lj47:
s_lshl_b32 s62, s6, 13
s_lshl_b32 s63, s3, 11
s_add_u32 s62, s62, s63
v_lshl_add_u32 v4, v1, 4, s62
s_and_b32 s62, s7, 1
s_mul_i32 s62, s62, 3670016
s_lshr_b32 s63, s7, 1
s_lshl_b32 s63, s63, 8
s_add_u32 s62, s62, s63
s_lshl_b32 s63, s3, 12
s_add_u32 s62, s62, s63
v_lshrrev_b32 v5, 4, v1
v_lshlrev_b32 v5, 14, v5
v_and_b32 v2, 15, v1
v_lshl_add_u32 v5, v2, 4, v5
v_add_u32 v5, s62, v5
v_add_u32 v6, 992, v5
v_bfe_u32 v8, v1, 2, 3
v_mul_u32_u24 v8, 1056, v8
v_bfe_u32 v2, v1, 5, 1
v_lshl_add_u32 v8, v2, 8, v8
v_and_b32 v2, 3, v1
v_lshl_add_u32 v8, v2, 3, v8
s_and_b32 s62, s7, 1
s_lshl_b32 s63, s62, 7
s_xor_b32 s64, s63, 128
v_add_u32 v7, s63, v8
v_add_u32 v10, s64, v8
s_mul_i32 s52, s62, 7340032
s_add_u32 s52, s52, 12582912
s_mov_b32 s54, 917504
s_mul_i32 s55, s3, 2112
s_add_u32 s56, s55, 67584
s_mov_b32 s57, 67584
s_lshl_b32 s70, s2, 10
s_lshl_b32 s62, s3, 7
s_add_u32 s70, s70, s62
s_add_u32 s70, s70, 31457280
s_xor_b32 s71, s70, 1024
v_min_u32 v12, 1, v1
v_lshlrev_b32 v12, 28, v12
v_mov_b32 v13, 1
v_mov_b32 v15, 0
s_lshl_b32 s68, s7, 18
s_add_u32 s68, s68, 33554432
s_xor_b32 s69, s68, 262144
v_mov_b32 v11, v4
v_and_b32 v2, 1, v1
v_lshlrev_b32 v2, 4, v2
v_mov_b32 v224, 0x3f80
v_lshlrev_b32 v2, v2, v224
v_bfe_u32 v224, v1, 2, 2
v_lshrrev_b32 v225, 4, v1
v_cmp_eq_u32 vcc, v224, v225
s_nop 1
v_cndmask_b32 v2, 0, v2, vcc
v_and_b32 v224, 2, v1
v_cmp_eq_u32 vcc, 0, v224
s_nop 1
v_cndmask_b32 v226, 0, v2, vcc
v_cndmask_b32 v227, v2, 0, vcc
v_mov_b64 v[224:225], 0
v_mov_b64 v[228:229], 0
v_mov_b64 v[64:65], 0
v_mov_b64 v[66:67], 0
v_mov_b64 v[68:69], 0
v_mov_b64 v[70:71], 0
v_mov_b64 v[72:73], 0
v_mov_b64 v[74:75], 0
v_mov_b64 v[76:77], 0
v_mov_b64 v[78:79], 0
v_mov_b64 v[80:81], 0
v_mov_b64 v[82:83], 0
v_mov_b64 v[84:85], 0
v_mov_b64 v[86:87], 0
v_mov_b64 v[88:89], 0
v_mov_b64 v[90:91], 0
v_mov_b64 v[92:93], 0
v_mov_b64 v[94:95], 0
v_accvgpr_read_b32 v32, a224
v_accvgpr_read_b32 v33, a225
v_accvgpr_read_b32 v34, a226
v_accvgpr_read_b32 v35, a227
v_accvgpr_read_b32 v36, a228
v_accvgpr_read_b32 v37, a229
v_accvgpr_read_b32 v38, a230
v_accvgpr_read_b32 v39, a231
v_accvgpr_read_b32 v40, a232
v_accvgpr_read_b32 v41, a233
v_accvgpr_read_b32 v42, a234
v_accvgpr_read_b32 v43, a235
v_accvgpr_read_b32 v44, a236
v_accvgpr_read_b32 v45, a237
v_accvgpr_read_b32 v46, a238
v_accvgpr_read_b32 v47, a239
v_accvgpr_read_b32 v48, a240
v_accvgpr_read_b32 v49, a241
v_accvgpr_read_b32 v50, a242
v_accvgpr_read_b32 v51, a243
v_accvgpr_read_b32 v52, a244
v_accvgpr_read_b32 v53, a245
v_accvgpr_read_b32 v54, a246
v_accvgpr_read_b32 v55, a247
v_accvgpr_read_b32 v56, a248
v_accvgpr_read_b32 v57, a249
v_accvgpr_read_b32 v58, a250
v_accvgpr_read_b32 v59, a251
v_accvgpr_read_b32 v60, a252
v_accvgpr_read_b32 v61, a253
v_accvgpr_read_b32 v62, a254
v_accvgpr_read_b32 v63, a255
v_bfe_u32 v18, v1, 3, 1
v_lshrrev_b32 v2, 4, v1
v_lshl_add_u32 v18, v2, 3, v18
s_lshl_b32 s62, s3, 1
v_add_u32 v18, s62, v18
v_mul_u32_u24 v18, 6144, v18
v_and_b32 v2, 7, v1
v_lshl_add_u32 v18, v2, 4, v18
s_lshl_b32 s62, s9, 7
v_add_u32 v18, s62, v18
v_add_u32 v19, 1024, v18
v_add_u32 v20, 2048, v18
s_mul_i32 s59, s3, 3104
s_mov_b32 s58, 0
s_lshl_b32 s62, s10, 1
s_lshr_b32 s63, s11, 4
s_add_u32 s62, s62, s63
s_lshl_b32 s62, s62, 7
s_add_u32 s62, s62, 30414848
s_and_b32 s64, s6, 14
s_and_b32 s63, s7, 1
s_add_u32 s64, s64, s63
s_lshl_b32 s64, s64, 7
s_add_u32 s64, s64, 30414848
v_mov_b32 v252, s62
v_mov_b32 v253, s64
s_waitcnt vmcnt(0) lgkmcnt(0)
s_barrier
s_cmp_lg_u32 s3, 0
s_cbranch_scc1 .Lnosig48
v_mov_b32 v255, 1
s_mov_b64 exec, 1
buffer_atomic_add v255, v252, s[16:19], 0 offen
s_mov_b64 exec, -1
.Lnosig48:
s_cmp_lg_u32 s3, 1
s_cbranch_scc1 .Lnopoll51
s_mov_b64 exec, 1
s_mov_b32 s15, 0
s_mov_b64 exec, 1
v_mov_b32 v254, 0
buffer_atomic_add v254, v253, s[16:19], 0 offen sc0
.Lpoll49:
s_waitcnt vmcnt(0)
v_cmp_ne_u32 vcc, 16, v254
s_add_u32 s15, s15, 1
s_cbranch_vccz .Lnopoll51r
s_sleep 2
s_mov_b64 exec, 1
v_mov_b32 v254, 0
buffer_atomic_add v254, v253, s[16:19], 0 offen sc0
s_cmp_le_u32 s15, 100000
s_cbranch_scc1 .Lpoll49
.Lgot50:
s_waitcnt vmcnt(0)
s_branch .Lnopoll51r
.Lnopoll51:
s_mov_b64 exec, 0
s_cmp_eq_u32 s3, 2
s_cbranch_scc1 .Lpad7
s_cmp_eq_u32 s3, 3
s_cbranch_scc1 .Lpad8
s_branch .Lpad9
.Lnopoll51r:
s_mov_b64 exec, -1
s_barrier
buffer_load_dwordx4 v[96:99], v4, s[16:19], s52 offen sc1
buffer_load_dwordx4 v[100:103], v4, s[16:19], s52 offen offset:1024 sc1
s_add_u32 s52, s52, 0x20000
buffer_load_dwordx4 v[104:107], v4, s[16:19], s52 offen sc1
buffer_load_dwordx4 v[108:111], v4, s[16:19], s52 offen offset:1024 sc1
s_add_u32 s52, s52, 0x20000
buffer_load_dwordx4 v[112:115], v4, s[16:19], s52 offen sc1
buffer_load_dwordx4 v[116:119], v4, s[16:19], s52 offen offset:1024 sc1
s_add_u32 s52, s52, 0x20000
buffer_load_dwordx4 v[120:123], v4, s[16:19], s52 offen sc1
buffer_load_dwordx4 v[124:127], v4, s[16:19], s52 offen offset:1024 sc1
s_add_u32 s52, s52, 0x20000
buffer_load_dwordx4 v[128:131], v4, s[16:19], s52 offen sc1
buffer_load_dwordx4 v[132:135], v4, s[16:19], s52 offen offset:1024 sc1
s_add_u32 s52, s52, 0x20000
buffer_load_dwordx4 v[136:139], v4, s[16:19], s52 offen sc1
buffer_load_dwordx4 v[140:143], v4, s[16:19], s52 offen offset:1024 sc1
s_add_u32 s52, s52, 0x20000
ds_read_b64_tr_b16 a[0:1], v7
ds_read_b64_tr_b16 a[2:3], v7 offset:512
ds_read_b64_tr_b16 a[4:5], v7 offset:32
ds_read_b64_tr_b16 a[6:7], v7 offset:544
ds_read_b64_tr_b16 a[8:9], v7 offset:64
ds_read_b64_tr_b16 a[10:11], v7 offset:576
ds_read_b64_tr_b16 a[12:13], v7 offset:96
ds_read_b64_tr_b16 a[14:15], v7 offset:608
ds_read_b64_tr_b16 a[16:17], v10
ds_read_b64_tr_b16 a[18:19], v10 offset:512
ds_read_b64_tr_b16 a[20:21], v10 offset:32
ds_read_b64_tr_b16 a[22:23], v10 offset:544
ds_read_b64_tr_b16 a[24:25], v10 offset:64
ds_read_b64_tr_b16 a[26:27], v10 offset:576
ds_read_b64_tr_b16 a[28:29], v10 offset:96
ds_read_b64_tr_b16 a[30:31], v10 offset:608
s_waitcnt lgkmcnt(0)
s_mov_b32 s15, -4
.p2align 6
.Lk53:
.Lpad7:
s_cbranch_execz .Lpad10
s_waitcnt vmcnt(10) lgkmcnt(8)
s_barrier
v_mfma_f32_16x16x32_bf16 v[32:35], a[0:3], v[96:99], v[32:35]
ds_read_b64_tr_b16 a[32:33], v7 offset:8448
s_add_u32 m0, s56, 50688
v_mfma_f32_16x16x32_bf16 v[48:51], a[0:3], v[100:103], v[48:51]
buffer_load_dwordx4 v5, s[28:31], s54 offen lds
v_mfma_f32_16x16x32_bf16 v[52:55], a[4:7], v[100:103], v[52:55]
ds_read_b64_tr_b16 a[34:35], v7 offset:8960
ds_read_b64_tr_b16 a[36:37], v7 offset:8480
v_mfma_f32_16x16x32_bf16 v[36:39], a[4:7], v[96:99], v[36:39]
ds_read_b64_tr_b16 a[38:39], v7 offset:8992
v_mfma_f32_16x16x32_bf16 v[40:43], a[8:11], v[96:99], v[40:43]
buffer_load_dwordx4 v[144:147], v4, s[16:19], s52 offen sc1
v_mfma_f32_16x16x32_bf16 v[56:59], a[8:11], v[100:103], v[56:59]
ds_read_b64_tr_b16 a[40:41], v7 offset:8512
ds_read_b64_tr_b16 a[42:43], v7 offset:9024
v_mfma_f32_16x16x32_bf16 v[60:63], a[12:15], v[100:103], v[60:63]
ds_read_b64_tr_b16 a[44:45], v7 offset:8544
ds_read_b64_tr_b16 a[46:47], v7 offset:9056
v_mfma_f32_16x16x32_bf16 v[44:47], a[12:15], v[96:99], v[44:47]
s_waitcnt lgkmcnt(8)
v_mfma_f32_16x16x32_bf16 v[64:67], a[16:19], v[96:99], v[64:67]
buffer_load_dwordx4 v6, s[28:31], s54 offen offset:1056 lds
v_mfma_f32_16x16x32_bf16 v[80:83], a[16:19], v[100:103], v[80:83]
ds_read_b64_tr_b16 a[48:49], v10 offset:8448
s_add_u32 s54, s54, 0x10000
v_mfma_f32_16x16x32_bf16 v[84:87], a[20:23], v[100:103], v[84:87]
ds_read_b64_tr_b16 a[50:51], v10 offset:8960
ds_read_b64_tr_b16 a[52:53], v10 offset:8480
v_mfma_f32_16x16x32_bf16 v[68:71], a[20:23], v[96:99], v[68:71]
ds_read_b64_tr_b16 a[54:55], v10 offset:8992
v_mfma_f32_16x16x32_bf16 v[72:75], a[24:27], v[96:99], v[72:75]
buffer_load_dwordx4 v[148:151], v4, s[16:19], s52 offen offset:1024 sc1
v_mfma_f32_16x16x32_bf16 v[88:91], a[24:27], v[100:103], v[88:91]
ds_read_b64_tr_b16 a[56:57], v10 offset:8512
s_add_u32 s52, s52, 0x20000
v_mfma_f32_16x16x32_bf16 v[92:95], a[28:31], v[100:103], v[92:95]
ds_read_b64_tr_b16 a[58:59], v10 offset:9024
ds_read_b64_tr_b16 a[60:61], v10 offset:8544
v_mfma_f32_16x16x32_bf16 v[76:79], a[28:31], v[96:99], v[76:79]
ds_read_b64_tr_b16 a[62:63], v10 offset:9056
s_waitcnt vmcnt(12) lgkmcnt(8)
v_mfma_f32_16x16x32_bf16 v[32:35], a[32:35], v[104:107], v[32:35]
ds_read_b64_tr_b16 a[0:1], v7 offset:16896
s_add_u32 m0, s56, 59136
v_mfma_f32_16x16x32_bf16 v[48:51], a[32:35], v[108:111], v[48:51]
buffer_load_dwordx4 v5, s[28:31], s54 offen lds
v_mfma_f32_16x16x32_bf16 v[52:55], a[36:39], v[108:111], v[52:55]
ds_read_b64_tr_b16 a[2:3], v7 offset:17408
ds_read_b64_tr_b16 a[4:5], v7 offset:16928
v_mfma_f32_16x16x32_bf16 v[36:39], a[36:39], v[104:107], v[36:39]
ds_read_b64_tr_b16 a[6:7], v7 offset:17440
v_mfma_f32_16x16x32_bf16 v[40:43], a[40:43], v[104:107], v[40:43]
buffer_load_dwordx4 v[152:155], v4, s[16:19], s52 offen sc1
v_mfma_f32_16x16x32_bf16 v[56:59], a[40:43], v[108:111], v[56:59]
ds_read_b64_tr_b16 a[8:9], v7 offset:16960
ds_read_b64_tr_b16 a[10:11], v7 offset:17472
v_mfma_f32_16x16x32_bf16 v[60:63], a[44:47], v[108:111], v[60:63]
ds_read_b64_tr_b16 a[12:13], v7 offset:16992
ds_read_b64_tr_b16 a[14:15], v7 offset:17504
v_mfma_f32_16x16x32_bf16 v[44:47], a[44:47], v[104:107], v[44:47]
s_waitcnt lgkmcnt(8)
v_mfma_f32_16x16x32_bf16 v[64:67], a[48:51], v[104:107], v[64:67]
buffer_load_dwordx4 v6, s[28:31], s54 offen offset:1056 lds
v_mfma_f32_16x16x32_bf16 v[80:83], a[48:51], v[108:111], v[80:83]
ds_read_b64_tr_b16 a[16:17], v10 offset:16896
s_add_u32 s54, s54, 0x10000
v_mfma_f32_16x16x32_bf16 v[84:87], a[52:55], v[108:111], v[84:87]
ds_read_b64_tr_b16 a[18:19], v10 offset:17408
ds_read_b64_tr_b16 a[20:21], v10 offset:16928
v_mfma_f32_16x16x32_bf16 v[68:71], a[52:55], v[104:107], v[68:71]
ds_read_b64_tr_b16 a[22:23], v10 offset:17440
v_mfma_f32_16x16x32_bf16 v[72:75], a[56:59], v[104:107], v[72:75]
buffer_load_dwordx4 v[156:159], v4, s[16:19], s52 offen offset:1024 sc1
v_mfma_f32_16x16x32_bf16 v[88:91], a[56:59], v[108:111], v[88:91]
ds_read_b64_tr_b16 a[24:25], v10 offset:16960
s_add_u32 s52, s52, 0x20000
v_mfma_f32_16x16x32_bf16 v[92:95], a[60:63], v[108:111], v[92:95]
ds_read_b64_tr_b16 a[26:27], v10 offset:17472
ds_read_b64_tr_b16 a[28:29], v10 offset:16992
v_mfma_f32_16x16x32_bf16 v[76:79], a[60:63], v[104:107], v[76:79]
ds_read_b64_tr_b16 a[30:31], v10 offset:17504
s_waitcnt vmcnt(14) lgkmcnt(8)
s_barrier
v_mfma_f32_16x16x32_bf16 v[32:35], a[0:3], v[112:115], v[32:35]
ds_read_b64_tr_b16 a[32:33], v7 offset:25344
s_add_u32 m0, s55, 0
v_mfma_f32_16x16x32_bf16 v[48:51], a[0:3], v[116:119], v[48:51]
buffer_load_dwordx4 v5, s[28:31], s54 offen lds
v_mfma_f32_16x16x32_bf16 v[52:55], a[4:7], v[116:119], v[52:55]
ds_read_b64_tr_b16 a[34:35], v7 offset:25856
ds_read_b64_tr_b16 a[36:37], v7 offset:25376
v_mfma_f32_16x16x32_bf16 v[36:39], a[4:7], v[112:115], v[36:39]
ds_read_b64_tr_b16 a[38:39], v7 offset:25888
v_mfma_f32_16x16x32_bf16 v[40:43], a[8:11], v[112:115], v[40:43]
buffer_load_dwordx4 v[96:99], v4, s[16:19], s52 offen sc1
v_mfma_f32_16x16x32_bf16 v[56:59], a[8:11], v[116:119], v[56:59]
ds_read_b64_tr_b16 a[40:41], v7 offset:25408
ds_read_b64_tr_b16 a[42:43], v7 offset:25920
v_mfma_f32_16x16x32_bf16 v[60:63], a[12:15], v[116:119], v[60:63]
ds_read_b64_tr_b16 a[44:45], v7 offset:25440
ds_read_b64_tr_b16 a[46:47], v7 offset:25952
v_mfma_f32_16x16x32_bf16 v[44:47], a[12:15], v[112:115], v[44:47]
s_waitcnt lgkmcnt(8)
v_mfma_f32_16x16x32_bf16 v[64:67], a[16:19], v[112:115], v[64:67]
buffer_load_dwordx4 v6, s[28:31], s54 offen offset:1056 lds
v_mfma_f32_16x16x32_bf16 v[80:83], a[16:19], v[116:119], v[80:83]
ds_read_b64_tr_b16 a[48:49], v10 offset:25344
s_add_u32 s54, s54, 0x10000
v_mfma_f32_16x16x32_bf16 v[84:87], a[20:23], v[116:119], v[84:87]
ds_read_b64_tr_b16 a[50:51], v10 offset:25856
ds_read_b64_tr_b16 a[52:53], v10 offset:25376
v_mfma_f32_16x16x32_bf16 v[68:71], a[20:23], v[112:115], v[68:71]
ds_read_b64_tr_b16 a[54:55], v10 offset:25888
v_mfma_f32_16x16x32_bf16 v[72:75], a[24:27], v[112:115], v[72:75]
buffer_load_dwordx4 v[100:103], v4, s[16:19], s52 offen offset:1024 sc1
v_mfma_f32_16x16x32_bf16 v[88:91], a[24:27], v[116:119], v[88:91]
ds_read_b64_tr_b16 a[56:57], v10 offset:25408
s_add_u32 s52, s52, 0x20000
v_mfma_f32_16x16x32_bf16 v[92:95], a[28:31], v[116:119], v[92:95]
ds_read_b64_tr_b16 a[58:59], v10 offset:25920
ds_read_b64_tr_b16 a[60:61], v10 offset:25440
v_mfma_f32_16x16x32_bf16 v[76:79], a[28:31], v[112:115], v[76:79]
ds_read_b64_tr_b16 a[62:63], v10 offset:25952
s_waitcnt vmcnt(16) lgkmcnt(8)
v_mfma_f32_16x16x32_bf16 v[32:35], a[32:35], v[120:123], v[32:35]
ds_read_b64_tr_b16 a[0:1], v7 offset:33792
s_add_u32 m0, s55, 8448
v_mfma_f32_16x16x32_bf16 v[48:51], a[32:35], v[124:127], v[48:51]
buffer_load_dwordx4 v5, s[28:31], s54 offen lds
v_mfma_f32_16x16x32_bf16 v[52:55], a[36:39], v[124:127], v[52:55]
ds_read_b64_tr_b16 a[2:3], v7 offset:34304
ds_read_b64_tr_b16 a[4:5], v7 offset:33824
v_mfma_f32_16x16x32_bf16 v[36:39], a[36:39], v[120:123], v[36:39]
ds_read_b64_tr_b16 a[6:7], v7 offset:34336
v_mfma_f32_16x16x32_bf16 v[40:43], a[40:43], v[120:123], v[40:43]
buffer_load_dwordx4 v[104:107], v4, s[16:19], s52 offen sc1
v_mfma_f32_16x16x32_bf16 v[56:59], a[40:43], v[124:127], v[56:59]
ds_read_b64_tr_b16 a[8:9], v7 offset:33856
ds_read_b64_tr_b16 a[10:11], v7 offset:34368
v_mfma_f32_16x16x32_bf16 v[60:63], a[44:47], v[124:127], v[60:63]
ds_read_b64_tr_b16 a[12:13], v7 offset:33888
ds_read_b64_tr_b16 a[14:15], v7 offset:34400
v_mfma_f32_16x16x32_bf16 v[44:47], a[44:47], v[120:123], v[44:47]
s_waitcnt lgkmcnt(8)
v_mfma_f32_16x16x32_bf16 v[64:67], a[48:51], v[120:123], v[64:67]
buffer_load_dwordx4 v6, s[28:31], s54 offen offset:1056 lds
v_mfma_f32_16x16x32_bf16 v[80:83], a[48:51], v[124:127], v[80:83]
ds_read_b64_tr_b16 a[16:17], v10 offset:33792
s_add_u32 s54, s54, 0x10000
v_mfma_f32_16x16x32_bf16 v[84:87], a[52:55], v[124:127], v[84:87]
ds_read_b64_tr_b16 a[18:19], v10 offset:34304
ds_read_b64_tr_b16 a[20:21], v10 offset:33824
v_mfma_f32_16x16x32_bf16 v[68:71], a[52:55], v[120:123], v[68:71]
ds_read_b64_tr_b16 a[22:23], v10 offset:34336
v_mfma_f32_16x16x32_bf16 v[72:75], a[56:59], v[120:123], v[72:75]
buffer_load_dwordx4 v[108:111], v4, s[16:19], s52 offen offset:1024 sc1
v_mfma_f32_16x16x32_bf16 v[88:91], a[56:59], v[124:127], v[88:91]
ds_read_b64_tr_b16 a[24:25], v10 offset:33856
s_add_u32 s52, s52, 0x20000
v_mfma_f32_16x16x32_bf16 v[92:95], a[60:63], v[124:127], v[92:95]
ds_read_b64_tr_b16 a[26:27], v10 offset:34368
ds_read_b64_tr_b16 a[28:29], v10 offset:33888
v_mfma_f32_16x16x32_bf16 v[76:79], a[60:63], v[120:123], v[76:79]
ds_read_b64_tr_b16 a[30:31], v10 offset:34400
s_waitcnt vmcnt(18) lgkmcnt(8)
s_barrier
v_mfma_f32_16x16x32_bf16 v[32:35], a[0:3], v[128:131], v[32:35]
ds_read_b64_tr_b16 a[32:33], v7 offset:42240
s_add_u32 m0, s55, 16896
v_mfma_f32_16x16x32_bf16 v[48:51], a[0:3], v[132:135], v[48:51]
buffer_load_dwordx4 v5, s[28:31], s54 offen lds
v_mfma_f32_16x16x32_bf16 v[52:55], a[4:7], v[132:135], v[52:55]
ds_read_b64_tr_b16 a[34:35], v7 offset:42752
ds_read_b64_tr_b16 a[36:37], v7 offset:42272
v_mfma_f32_16x16x32_bf16 v[36:39], a[4:7], v[128:131], v[36:39]
ds_read_b64_tr_b16 a[38:39], v7 offset:42784
v_mfma_f32_16x16x32_bf16 v[40:43], a[8:11], v[128:131], v[40:43]
buffer_load_dwordx4 v[112:115], v4, s[16:19], s52 offen sc1
v_mfma_f32_16x16x32_bf16 v[56:59], a[8:11], v[132:135], v[56:59]
ds_read_b64_tr_b16 a[40:41], v7 offset:42304
ds_read_b64_tr_b16 a[42:43], v7 offset:42816
v_mfma_f32_16x16x32_bf16 v[60:63], a[12:15], v[132:135], v[60:63]
ds_read_b64_tr_b16 a[44:45], v7 offset:42336
ds_read_b64_tr_b16 a[46:47], v7 offset:42848
v_mfma_f32_16x16x32_bf16 v[44:47], a[12:15], v[128:131], v[44:47]
s_waitcnt lgkmcnt(8)
v_mfma_f32_16x16x32_bf16 v[64:67], a[16:19], v[128:131], v[64:67]
buffer_load_dwordx4 v6, s[28:31], s54 offen offset:1056 lds
v_mfma_f32_16x16x32_bf16 v[80:83], a[16:19], v[132:135], v[80:83]
ds_read_b64_tr_b16 a[48:49], v10 offset:42240
s_add_u32 s54, s54, 0x10000
v_mfma_f32_16x16x32_bf16 v[84:87], a[20:23], v[132:135], v[84:87]
ds_read_b64_tr_b16 a[50:51], v10 offset:42752
ds_read_b64_tr_b16 a[52:53], v10 offset:42272
v_mfma_f32_16x16x32_bf16 v[68:71], a[20:23], v[128:131], v[68:71]
ds_read_b64_tr_b16 a[54:55], v10 offset:42784
v_mfma_f32_16x16x32_bf16 v[72:75], a[24:27], v[128:131], v[72:75]
buffer_load_dwordx4 v[116:119], v4, s[16:19], s52 offen offset:1024 sc1
v_mfma_f32_16x16x32_bf16 v[88:91], a[24:27], v[132:135], v[88:91]
ds_read_b64_tr_b16 a[56:57], v10 offset:42304
s_add_u32 s52, s52, 0x20000
v_mfma_f32_16x16x32_bf16 v[92:95], a[28:31], v[132:135], v[92:95]
ds_read_b64_tr_b16 a[58:59], v10 offset:42816
ds_read_b64_tr_b16 a[60:61], v10 offset:42336
v_mfma_f32_16x16x32_bf16 v[76:79], a[28:31], v[128:131], v[76:79]
ds_read_b64_tr_b16 a[62:63], v10 offset:42848
s_waitcnt vmcnt(20) lgkmcnt(8)
v_mfma_f32_16x16x32_bf16 v[32:35], a[32:35], v[136:139], v[32:35]
ds_read_b64_tr_b16 a[0:1], v7 offset:50688
s_add_u32 m0, s55, 25344
v_mfma_f32_16x16x32_bf16 v[48:51], a[32:35], v[140:143], v[48:51]
buffer_load_dwordx4 v5, s[28:31], s54 offen lds
v_mfma_f32_16x16x32_bf16 v[52:55], a[36:39], v[140:143], v[52:55]
ds_read_b64_tr_b16 a[2:3], v7 offset:51200
ds_read_b64_tr_b16 a[4:5], v7 offset:50720
v_mfma_f32_16x16x32_bf16 v[36:39], a[36:39], v[136:139], v[36:39]
ds_read_b64_tr_b16 a[6:7], v7 offset:51232
v_mfma_f32_16x16x32_bf16 v[40:43], a[40:43], v[136:139], v[40:43]
buffer_load_dwordx4 v[120:123], v4, s[16:19], s52 offen sc1
v_mfma_f32_16x16x32_bf16 v[56:59], a[40:43], v[140:143], v[56:59]
ds_read_b64_tr_b16 a[8:9], v7 offset:50752
ds_read_b64_tr_b16 a[10:11], v7 offset:51264
v_mfma_f32_16x16x32_bf16 v[60:63], a[44:47], v[140:143], v[60:63]
ds_read_b64_tr_b16 a[12:13], v7 offset:50784
ds_read_b64_tr_b16 a[14:15], v7 offset:51296
v_mfma_f32_16x16x32_bf16 v[44:47], a[44:47], v[136:139], v[44:47]
s_waitcnt lgkmcnt(8)
v_mfma_f32_16x16x32_bf16 v[64:67], a[48:51], v[136:139], v[64:67]
buffer_load_dwordx4 v6, s[28:31], s54 offen offset:1056 lds
v_mfma_f32_16x16x32_bf16 v[80:83], a[48:51], v[140:143], v[80:83]
ds_read_b64_tr_b16 a[16:17], v10 offset:50688
s_add_u32 s54, s54, 0x10000
v_mfma_f32_16x16x32_bf16 v[84:87], a[52:55], v[140:143], v[84:87]
ds_read_b64_tr_b16 a[18:19], v10 offset:51200
ds_read_b64_tr_b16 a[20:21], v10 offset:50720
v_mfma_f32_16x16x32_bf16 v[68:71], a[52:55], v[136:139], v[68:71]
ds_read_b64_tr_b16 a[22:23], v10 offset:51232
v_mfma_f32_16x16x32_bf16 v[72:75], a[56:59], v[136:139], v[72:75]
buffer_load_dwordx4 v[124:127], v4, s[16:19], s52 offen offset:1024 sc1
v_mfma_f32_16x16x32_bf16 v[88:91], a[56:59], v[140:143], v[88:91]
ds_read_b64_tr_b16 a[24:25], v10 offset:50752
s_add_u32 s52, s52, 0x20000
v_mfma_f32_16x16x32_bf16 v[92:95], a[60:63], v[140:143], v[92:95]
ds_read_b64_tr_b16 a[26:27], v10 offset:51264
ds_read_b64_tr_b16 a[28:29], v10 offset:50784
v_mfma_f32_16x16x32_bf16 v[76:79], a[60:63], v[136:139], v[76:79]
ds_read_b64_tr_b16 a[30:31], v10 offset:51296
s_waitcnt vmcnt(20) lgkmcnt(8)
s_barrier
v_mfma_f32_16x16x32_bf16 v[32:35], a[0:3], v[144:147], v[32:35]
ds_read_b64_tr_b16 a[32:33], v7 offset:59136
s_add_u32 m0, s55, 33792
v_mfma_f32_16x16x32_bf16 v[48:51], a[0:3], v[148:151], v[48:51]
buffer_load_dwordx4 v5, s[28:31], s54 offen lds
v_mfma_f32_16x16x32_bf16 v[52:55], a[4:7], v[148:151], v[52:55]
ds_read_b64_tr_b16 a[34:35], v7 offset:59648
ds_read_b64_tr_b16 a[36:37], v7 offset:59168
v_mfma_f32_16x16x32_bf16 v[36:39], a[4:7], v[144:147], v[36:39]
ds_read_b64_tr_b16 a[38:39], v7 offset:59680
v_mfma_f32_16x16x32_bf16 v[40:43], a[8:11], v[144:147], v[40:43]
buffer_load_dwordx4 v[128:131], v4, s[16:19], s52 offen sc1
v_mfma_f32_16x16x32_bf16 v[56:59], a[8:11], v[148:151], v[56:59]
ds_read_b64_tr_b16 a[40:41], v7 offset:59200
ds_read_b64_tr_b16 a[42:43], v7 offset:59712
v_mfma_f32_16x16x32_bf16 v[60:63], a[12:15], v[148:151], v[60:63]
ds_read_b64_tr_b16 a[44:45], v7 offset:59232
ds_read_b64_tr_b16 a[46:47], v7 offset:59744
v_mfma_f32_16x16x32_bf16 v[44:47], a[12:15], v[144:147], v[44:47]
s_waitcnt lgkmcnt(8)
v_mfma_f32_16x16x32_bf16 v[64:67], a[16:19], v[144:147], v[64:67]
buffer_load_dwordx4 v6, s[28:31], s54 offen offset:1056 lds
v_mfma_f32_16x16x32_bf16 v[80:83], a[16:19], v[148:151], v[80:83]
ds_read_b64_tr_b16 a[48:49], v10 offset:59136
s_add_u32 s54, s54, 0x10000
v_mfma_f32_16x16x32_bf16 v[84:87], a[20:23], v[148:151], v[84:87]
ds_read_b64_tr_b16 a[50:51], v10 offset:59648
ds_read_b64_tr_b16 a[52:53], v10 offset:59168
v_mfma_f32_16x16x32_bf16 v[68:71], a[20:23], v[144:147], v[68:71]
ds_read_b64_tr_b16 a[54:55], v10 offset:59680
v_mfma_f32_16x16x32_bf16 v[72:75], a[24:27], v[144:147], v[72:75]
buffer_load_dwordx4 v[132:135], v4, s[16:19], s52 offen offset:1024 sc1
v_mfma_f32_16x16x32_bf16 v[88:91], a[24:27], v[148:151], v[88:91]
ds_read_b64_tr_b16 a[56:57], v10 offset:59200
s_add_u32 s52, s52, 0x20000
v_mfma_f32_16x16x32_bf16 v[92:95], a[28:31], v[148:151], v[92:95]
ds_read_b64_tr_b16 a[58:59], v10 offset:59712
ds_read_b64_tr_b16 a[60:61], v10 offset:59232
v_mfma_f32_16x16x32_bf16 v[76:79], a[28:31], v[144:147], v[76:79]
ds_read_b64_tr_b16 a[62:63], v10 offset:59744
v_add_u32 v7, s57, v7
v_add_u32 v10, s57, v10
s_sub_u32 s57, 0, s57
s_waitcnt vmcnt(20) lgkmcnt(8)
v_mfma_f32_16x16x32_bf16 v[32:35], a[32:35], v[152:155], v[32:35]
ds_read_b64_tr_b16 a[0:1], v7
s_add_u32 m0, s55, 42240
v_mfma_f32_16x16x32_bf16 v[48:51], a[32:35], v[156:159], v[48:51]
buffer_load_dwordx4 v5, s[28:31], s54 offen lds
v_mfma_f32_16x16x32_bf16 v[52:55], a[36:39], v[156:159], v[52:55]
ds_read_b64_tr_b16 a[2:3], v7 offset:512
ds_read_b64_tr_b16 a[4:5], v7 offset:32
v_mfma_f32_16x16x32_bf16 v[36:39], a[36:39], v[152:155], v[36:39]
ds_read_b64_tr_b16 a[6:7], v7 offset:544
v_mfma_f32_16x16x32_bf16 v[40:43], a[40:43], v[152:155], v[40:43]
buffer_load_dwordx4 v[136:139], v4, s[16:19], s52 offen sc1
v_mfma_f32_16x16x32_bf16 v[56:59], a[40:43], v[156:159], v[56:59]
ds_read_b64_tr_b16 a[8:9], v7 offset:64
ds_read_b64_tr_b16 a[10:11], v7 offset:576
v_mfma_f32_16x16x32_bf16 v[60:63], a[44:47], v[156:159], v[60:63]
ds_read_b64_tr_b16 a[12:13], v7 offset:96
ds_read_b64_tr_b16 a[14:15], v7 offset:608
v_mfma_f32_16x16x32_bf16 v[44:47], a[44:47], v[152:155], v[44:47]
s_waitcnt lgkmcnt(8)
v_mfma_f32_16x16x32_bf16 v[64:67], a[48:51], v[152:155], v[64:67]
buffer_load_dwordx4 v6, s[28:31], s54 offen offset:1056 lds
v_mfma_f32_16x16x32_bf16 v[80:83], a[48:51], v[156:159], v[80:83]
ds_read_b64_tr_b16 a[16:17], v10
s_add_u32 s54, s54, 0x10000
v_mfma_f32_16x16x32_bf16 v[84:87], a[52:55], v[156:159], v[84:87]
ds_read_b64_tr_b16 a[18:19], v10 offset:512
ds_read_b64_tr_b16 a[20:21], v10 offset:32
v_mfma_f32_16x16x32_bf16 v[68:71], a[52:55], v[152:155], v[68:71]
ds_read_b64_tr_b16 a[22:23], v10 offset:544
v_mfma_f32_16x16x32_bf16 v[72:75], a[56:59], v[152:155], v[72:75]
buffer_load_dwordx4 v[140:143], v4, s[16:19], s52 offen offset:1024 sc1
v_mfma_f32_16x16x32_bf16 v[88:91], a[56:59], v[156:159], v[88:91]
ds_read_b64_tr_b16 a[24:25], v10 offset:64
s_add_u32 s52, s52, 0x20000
v_mfma_f32_16x16x32_bf16 v[92:95], a[60:63], v[156:159], v[92:95]
ds_read_b64_tr_b16 a[26:27], v10 offset:576
ds_read_b64_tr_b16 a[28:29], v10 offset:96
v_mfma_f32_16x16x32_bf16 v[76:79], a[60:63], v[152:155], v[76:79]
ds_read_b64_tr_b16 a[30:31], v10 offset:608
s_mov_b32 s62, s55
s_mov_b32 s55, s56
s_mov_b32 s56, s62
s_add_u32 s15, s15, 1
s_cbranch_scc0 .Lk53
s_waitcnt vmcnt(20) lgkmcnt(8)
s_barrier
v_mfma_f32_16x16x32_bf16 v[32:35], a[0:3], v[96:99], v[32:35]
ds_read_b64_tr_b16 a[32:33], v7 offset:8448
s_add_u32 m0, s56, 50688
v_mfma_f32_16x16x32_bf16 v[48:51], a[0:3], v[100:103], v[48:51]
buffer_load_dwordx4 v5, s[28:31], s54 offen lds
v_mfma_f32_16x16x32_bf16 v[52:55], a[4:7], v[100:103], v[52:55]
ds_read_b64_tr_b16 a[34:35], v7 offset:8960
ds_read_b64_tr_b16 a[36:37], v7 offset:8480
v_mfma_f32_16x16x32_bf16 v[36:39], a[4:7], v[96:99], v[36:39]
ds_read_b64_tr_b16 a[38:39], v7 offset:8992
v_mfma_f32_16x16x32_bf16 v[40:43], a[8:11], v[96:99], v[40:43]
buffer_load_dwordx4 v[144:147], v4, s[16:19], s52 offen sc1
v_mfma_f32_16x16x32_bf16 v[56:59], a[8:11], v[100:103], v[56:59]
ds_read_b64_tr_b16 a[40:41], v7 offset:8512
ds_read_b64_tr_b16 a[42:43], v7 offset:9024
v_mfma_f32_16x16x32_bf16 v[60:63], a[12:15], v[100:103], v[60:63]
ds_read_b64_tr_b16 a[44:45], v7 offset:8544
ds_read_b64_tr_b16 a[46:47], v7 offset:9056
v_mfma_f32_16x16x32_bf16 v[44:47], a[12:15], v[96:99], v[44:47]
s_waitcnt lgkmcnt(8)
v_mfma_f32_16x16x32_bf16 v[64:67], a[16:19], v[96:99], v[64:67]
buffer_load_dwordx4 v6, s[28:31], s54 offen offset:1056 lds
v_mfma_f32_16x16x32_bf16 v[80:83], a[16:19], v[100:103], v[80:83]
ds_read_b64_tr_b16 a[48:49], v10 offset:8448
s_add_u32 s54, s54, 0x10000
v_mfma_f32_16x16x32_bf16 v[84:87], a[20:23], v[100:103], v[84:87]
ds_read_b64_tr_b16 a[50:51], v10 offset:8960
ds_read_b64_tr_b16 a[52:53], v10 offset:8480
v_mfma_f32_16x16x32_bf16 v[68:71], a[20:23], v[96:99], v[68:71]
ds_read_b64_tr_b16 a[54:55], v10 offset:8992
v_mfma_f32_16x16x32_bf16 v[72:75], a[24:27], v[96:99], v[72:75]
buffer_load_dwordx4 v[148:151], v4, s[16:19], s52 offen offset:1024 sc1
v_mfma_f32_16x16x32_bf16 v[88:91], a[24:27], v[100:103], v[88:91]
ds_read_b64_tr_b16 a[56:57], v10 offset:8512
s_add_u32 s52, s52, 0x20000
v_mfma_f32_16x16x32_bf16 v[92:95], a[28:31], v[100:103], v[92:95]
ds_read_b64_tr_b16 a[58:59], v10 offset:9024
ds_read_b64_tr_b16 a[60:61], v10 offset:8544
v_mfma_f32_16x16x32_bf16 v[76:79], a[28:31], v[96:99], v[76:79]
ds_read_b64_tr_b16 a[62:63], v10 offset:9056
s_waitcnt vmcnt(20) lgkmcnt(8)
v_mfma_f32_16x16x32_bf16 v[32:35], a[32:35], v[104:107], v[32:35]
ds_read_b64_tr_b16 a[0:1], v7 offset:16896
s_add_u32 m0, s56, 59136
v_mfma_f32_16x16x32_bf16 v[48:51], a[32:35], v[108:111], v[48:51]
buffer_load_dwordx4 v5, s[28:31], s54 offen lds
v_mfma_f32_16x16x32_bf16 v[52:55], a[36:39], v[108:111], v[52:55]
ds_read_b64_tr_b16 a[2:3], v7 offset:17408
ds_read_b64_tr_b16 a[4:5], v7 offset:16928
v_mfma_f32_16x16x32_bf16 v[36:39], a[36:39], v[104:107], v[36:39]
ds_read_b64_tr_b16 a[6:7], v7 offset:17440
v_mfma_f32_16x16x32_bf16 v[40:43], a[40:43], v[104:107], v[40:43]
buffer_load_dwordx4 v[152:155], v4, s[16:19], s52 offen sc1
v_mfma_f32_16x16x32_bf16 v[56:59], a[40:43], v[108:111], v[56:59]
ds_read_b64_tr_b16 a[8:9], v7 offset:16960
ds_read_b64_tr_b16 a[10:11], v7 offset:17472
v_mfma_f32_16x16x32_bf16 v[60:63], a[44:47], v[108:111], v[60:63]
ds_read_b64_tr_b16 a[12:13], v7 offset:16992
ds_read_b64_tr_b16 a[14:15], v7 offset:17504
v_mfma_f32_16x16x32_bf16 v[44:47], a[44:47], v[104:107], v[44:47]
s_waitcnt lgkmcnt(8)
v_mfma_f32_16x16x32_bf16 v[64:67], a[48:51], v[104:107], v[64:67]
buffer_load_dwordx4 v6, s[28:31], s54 offen offset:1056 lds
v_mfma_f32_16x16x32_bf16 v[80:83], a[48:51], v[108:111], v[80:83]
ds_read_b64_tr_b16 a[16:17], v10 offset:16896
s_add_u32 s54, s54, 0x10000
v_mfma_f32_16x16x32_bf16 v[84:87], a[52:55], v[108:111], v[84:87]
ds_read_b64_tr_b16 a[18:19], v10 offset:17408
ds_read_b64_tr_b16 a[20:21], v10 offset:16928
v_mfma_f32_16x16x32_bf16 v[68:71], a[52:55], v[104:107], v[68:71]
ds_read_b64_tr_b16 a[22:23], v10 offset:17440
v_mfma_f32_16x16x32_bf16 v[72:75], a[56:59], v[104:107], v[72:75]
buffer_load_dwordx4 v[156:159], v4, s[16:19], s52 offen offset:1024 sc1
v_mfma_f32_16x16x32_bf16 v[88:91], a[56:59], v[108:111], v[88:91]
ds_read_b64_tr_b16 a[24:25], v10 offset:16960
s_add_u32 s52, s52, 0x20000
v_mfma_f32_16x16x32_bf16 v[92:95], a[60:63], v[108:111], v[92:95]
ds_read_b64_tr_b16 a[26:27], v10 offset:17472
ds_read_b64_tr_b16 a[28:29], v10 offset:16992
v_mfma_f32_16x16x32_bf16 v[76:79], a[60:63], v[104:107], v[76:79]
ds_read_b64_tr_b16 a[30:31], v10 offset:17504
s_waitcnt vmcnt(20) lgkmcnt(8)
s_barrier
v_mfma_f32_16x16x32_bf16 v[32:35], a[0:3], v[112:115], v[32:35]
ds_read_b64_tr_b16 a[32:33], v7 offset:25344
s_add_u32 m0, s55, 0
v_mfma_f32_16x16x32_bf16 v[48:51], a[0:3], v[116:119], v[48:51]
buffer_load_dwordx4 v5, s[28:31], s54 offen lds
v_mfma_f32_16x16x32_bf16 v[52:55], a[4:7], v[116:119], v[52:55]
ds_read_b64_tr_b16 a[34:35], v7 offset:25856
ds_read_b64_tr_b16 a[36:37], v7 offset:25376
v_mfma_f32_16x16x32_bf16 v[36:39], a[4:7], v[112:115], v[36:39]
ds_read_b64_tr_b16 a[38:39], v7 offset:25888
v_mfma_f32_16x16x32_bf16 v[40:43], a[8:11], v[112:115], v[40:43]
buffer_load_dwordx4 v[96:99], v4, s[16:19], s52 offen sc1
v_mfma_f32_16x16x32_bf16 v[56:59], a[8:11], v[116:119], v[56:59]
ds_read_b64_tr_b16 a[40:41], v7 offset:25408
ds_read_b64_tr_b16 a[42:43], v7 offset:25920
v_mfma_f32_16x16x32_bf16 v[60:63], a[12:15], v[116:119], v[60:63]
ds_read_b64_tr_b16 a[44:45], v7 offset:25440
ds_read_b64_tr_b16 a[46:47], v7 offset:25952
v_mfma_f32_16x16x32_bf16 v[44:47], a[12:15], v[112:115], v[44:47]
s_waitcnt lgkmcnt(8)
v_mfma_f32_16x16x32_bf16 v[64:67], a[16:19], v[112:115], v[64:67]
buffer_load_dwordx4 v6, s[28:31], s54 offen offset:1056 lds
v_mfma_f32_16x16x32_bf16 v[80:83], a[16:19], v[116:119], v[80:83]
ds_read_b64_tr_b16 a[48:49], v10 offset:25344
s_add_u32 s54, s54, 0x10000
v_mfma_f32_16x16x32_bf16 v[84:87], a[20:23], v[116:119], v[84:87]
ds_read_b64_tr_b16 a[50:51], v10 offset:25856
ds_read_b64_tr_b16 a[52:53], v10 offset:25376
v_mfma_f32_16x16x32_bf16 v[68:71], a[20:23], v[112:115], v[68:71]
ds_read_b64_tr_b16 a[54:55], v10 offset:25888
v_mfma_f32_16x16x32_bf16 v[72:75], a[24:27], v[112:115], v[72:75]
buffer_load_dwordx4 v[100:103], v4, s[16:19], s52 offen offset:1024 sc1
v_mfma_f32_16x16x32_bf16 v[88:91], a[24:27], v[116:119], v[88:91]
ds_read_b64_tr_b16 a[56:57], v10 offset:25408
s_add_u32 s52, s52, 0x20000
v_mfma_f32_16x16x32_bf16 v[92:95], a[28:31], v[116:119], v[92:95]
ds_read_b64_tr_b16 a[58:59], v10 offset:25920
ds_read_b64_tr_b16 a[60:61], v10 offset:25440
v_mfma_f32_16x16x32_bf16 v[76:79], a[28:31], v[112:115], v[76:79]
ds_read_b64_tr_b16 a[62:63], v10 offset:25952
s_waitcnt vmcnt(20) lgkmcnt(8)
v_mfma_f32_16x16x32_bf16 v[32:35], a[32:35], v[120:123], v[32:35]
ds_read_b64_tr_b16 a[0:1], v7 offset:33792
s_add_u32 m0, s55, 8448
v_mfma_f32_16x16x32_bf16 v[48:51], a[32:35], v[124:127], v[48:51]
buffer_load_dwordx4 v5, s[28:31], s54 offen lds
v_mfma_f32_16x16x32_bf16 v[52:55], a[36:39], v[124:127], v[52:55]
ds_read_b64_tr_b16 a[2:3], v7 offset:34304
ds_read_b64_tr_b16 a[4:5], v7 offset:33824
v_mfma_f32_16x16x32_bf16 v[36:39], a[36:39], v[120:123], v[36:39]
ds_read_b64_tr_b16 a[6:7], v7 offset:34336
v_mfma_f32_16x16x32_bf16 v[40:43], a[40:43], v[120:123], v[40:43]
buffer_load_dwordx4 v[104:107], v4, s[16:19], s52 offen sc1
v_mfma_f32_16x16x32_bf16 v[56:59], a[40:43], v[124:127], v[56:59]
ds_read_b64_tr_b16 a[8:9], v7 offset:33856
ds_read_b64_tr_b16 a[10:11], v7 offset:34368
v_mfma_f32_16x16x32_bf16 v[60:63], a[44:47], v[124:127], v[60:63]
ds_read_b64_tr_b16 a[12:13], v7 offset:33888
ds_read_b64_tr_b16 a[14:15], v7 offset:34400
v_mfma_f32_16x16x32_bf16 v[44:47], a[44:47], v[120:123], v[44:47]
s_waitcnt lgkmcnt(8)
v_mfma_f32_16x16x32_bf16 v[64:67], a[48:51], v[120:123], v[64:67]
buffer_load_dwordx4 v6, s[28:31], s54 offen offset:1056 lds
v_mfma_f32_16x16x32_bf16 v[80:83], a[48:51], v[124:127], v[80:83]
ds_read_b64_tr_b16 a[16:17], v10 offset:33792
s_add_u32 s54, s54, 0x10000
v_mfma_f32_16x16x32_bf16 v[84:87], a[52:55], v[124:127], v[84:87]
ds_read_b64_tr_b16 a[18:19], v10 offset:34304
ds_read_b64_tr_b16 a[20:21], v10 offset:33824
v_mfma_f32_16x16x32_bf16 v[68:71], a[52:55], v[120:123], v[68:71]
ds_read_b64_tr_b16 a[22:23], v10 offset:34336
v_mfma_f32_16x16x32_bf16 v[72:75], a[56:59], v[120:123], v[72:75]
buffer_load_dwordx4 v[108:111], v4, s[16:19], s52 offen offset:1024 sc1
v_mfma_f32_16x16x32_bf16 v[88:91], a[56:59], v[124:127], v[88:91]
ds_read_b64_tr_b16 a[24:25], v10 offset:33856
s_add_u32 s52, s52, 0x20000
v_mfma_f32_16x16x32_bf16 v[92:95], a[60:63], v[124:127], v[92:95]
ds_read_b64_tr_b16 a[26:27], v10 offset:34368
ds_read_b64_tr_b16 a[28:29], v10 offset:33888
v_mfma_f32_16x16x32_bf16 v[76:79], a[60:63], v[120:123], v[76:79]
ds_read_b64_tr_b16 a[30:31], v10 offset:34400
s_waitcnt vmcnt(20) lgkmcnt(8)
s_barrier
v_mfma_f32_16x16x32_bf16 v[32:35], a[0:3], v[128:131], v[32:35]
ds_read_b64_tr_b16 a[32:33], v7 offset:42240
s_add_u32 m0, s55, 16896
v_mfma_f32_16x16x32_bf16 v[48:51], a[0:3], v[132:135], v[48:51]
buffer_load_dwordx4 v5, s[28:31], s54 offen lds
v_mfma_f32_16x16x32_bf16 v[52:55], a[4:7], v[132:135], v[52:55]
ds_read_b64_tr_b16 a[34:35], v7 offset:42752
ds_read_b64_tr_b16 a[36:37], v7 offset:42272
v_mfma_f32_16x16x32_bf16 v[36:39], a[4:7], v[128:131], v[36:39]
ds_read_b64_tr_b16 a[38:39], v7 offset:42784
v_mfma_f32_16x16x32_bf16 v[40:43], a[8:11], v[128:131], v[40:43]
buffer_load_dwordx4 v[112:115], v4, s[16:19], s52 offen sc1
v_mfma_f32_16x16x32_bf16 v[56:59], a[8:11], v[132:135], v[56:59]
ds_read_b64_tr_b16 a[40:41], v7 offset:42304
ds_read_b64_tr_b16 a[42:43], v7 offset:42816
v_mfma_f32_16x16x32_bf16 v[60:63], a[12:15], v[132:135], v[60:63]
ds_read_b64_tr_b16 a[44:45], v7 offset:42336
ds_read_b64_tr_b16 a[46:47], v7 offset:42848
v_mfma_f32_16x16x32_bf16 v[44:47], a[12:15], v[128:131], v[44:47]
s_waitcnt lgkmcnt(8)
v_mfma_f32_16x16x32_bf16 v[64:67], a[16:19], v[128:131], v[64:67]
buffer_load_dwordx4 v6, s[28:31], s54 offen offset:1056 lds
v_mfma_f32_16x16x32_bf16 v[80:83], a[16:19], v[132:135], v[80:83]
ds_read_b64_tr_b16 a[48:49], v10 offset:42240
s_add_u32 s54, s54, 0x10000
.Lpad8:
s_cbranch_execz .Lnopoll51r
v_mfma_f32_16x16x32_bf16 v[84:87], a[20:23], v[132:135], v[84:87]
ds_read_b64_tr_b16 a[50:51], v10 offset:42752
ds_read_b64_tr_b16 a[52:53], v10 offset:42272
v_mfma_f32_16x16x32_bf16 v[68:71], a[20:23], v[128:131], v[68:71]
ds_read_b64_tr_b16 a[54:55], v10 offset:42784
v_mfma_f32_16x16x32_bf16 v[72:75], a[24:27], v[128:131], v[72:75]
buffer_load_dwordx4 v[116:119], v4, s[16:19], s52 offen offset:1024 sc1
v_mfma_f32_16x16x32_bf16 v[88:91], a[24:27], v[132:135], v[88:91]
ds_read_b64_tr_b16 a[56:57], v10 offset:42304
s_add_u32 s52, s52, 0x20000
v_mfma_f32_16x16x32_bf16 v[92:95], a[28:31], v[132:135], v[92:95]
ds_read_b64_tr_b16 a[58:59], v10 offset:42816
ds_read_b64_tr_b16 a[60:61], v10 offset:42336
v_mfma_f32_16x16x32_bf16 v[76:79], a[28:31], v[128:131], v[76:79]
ds_read_b64_tr_b16 a[62:63], v10 offset:42848
s_waitcnt vmcnt(20) lgkmcnt(8)
v_mfma_f32_16x16x32_bf16 v[32:35], a[32:35], v[136:139], v[32:35]
ds_read_b64_tr_b16 a[0:1], v7 offset:50688
s_add_u32 m0, s55, 25344
v_mfma_f32_16x16x32_bf16 v[48:51], a[32:35], v[140:143], v[48:51]
buffer_load_dwordx4 v5, s[28:31], s54 offen lds
v_mfma_f32_16x16x32_bf16 v[52:55], a[36:39], v[140:143], v[52:55]
ds_read_b64_tr_b16 a[2:3], v7 offset:51200
ds_read_b64_tr_b16 a[4:5], v7 offset:50720
v_mfma_f32_16x16x32_bf16 v[36:39], a[36:39], v[136:139], v[36:39]
ds_read_b64_tr_b16 a[6:7], v7 offset:51232
v_mfma_f32_16x16x32_bf16 v[40:43], a[40:43], v[136:139], v[40:43]
buffer_load_dwordx4 v[120:123], v4, s[16:19], s52 offen sc1
v_mfma_f32_16x16x32_bf16 v[56:59], a[40:43], v[140:143], v[56:59]
ds_read_b64_tr_b16 a[8:9], v7 offset:50752
ds_read_b64_tr_b16 a[10:11], v7 offset:51264
v_mfma_f32_16x16x32_bf16 v[60:63], a[44:47], v[140:143], v[60:63]
ds_read_b64_tr_b16 a[12:13], v7 offset:50784
ds_read_b64_tr_b16 a[14:15], v7 offset:51296
v_mfma_f32_16x16x32_bf16 v[44:47], a[44:47], v[136:139], v[44:47]
s_waitcnt lgkmcnt(8)
v_mfma_f32_16x16x32_bf16 v[64:67], a[48:51], v[136:139], v[64:67]
buffer_load_dwordx4 v6, s[28:31], s54 offen offset:1056 lds
v_mfma_f32_16x16x32_bf16 v[80:83], a[48:51], v[140:143], v[80:83]
ds_read_b64_tr_b16 a[16:17], v10 offset:50688
s_add_u32 s54, s54, 0x10000
v_mfma_f32_16x16x32_bf16 v[84:87], a[52:55], v[140:143], v[84:87]
ds_read_b64_tr_b16 a[18:19], v10 offset:51200
ds_read_b64_tr_b16 a[20:21], v10 offset:50720
v_mfma_f32_16x16x32_bf16 v[68:71], a[52:55], v[136:139], v[68:71]
ds_read_b64_tr_b16 a[22:23], v10 offset:51232
v_mfma_f32_16x16x32_bf16 v[72:75], a[56:59], v[136:139], v[72:75]
buffer_load_dwordx4 v[124:127], v4, s[16:19], s52 offen offset:1024 sc1
v_mfma_f32_16x16x32_bf16 v[88:91], a[56:59], v[140:143], v[88:91]
ds_read_b64_tr_b16 a[24:25], v10 offset:50752
s_add_u32 s52, s52, 0x20000
v_mfma_f32_16x16x32_bf16 v[92:95], a[60:63], v[140:143], v[92:95]
ds_read_b64_tr_b16 a[26:27], v10 offset:51264
ds_read_b64_tr_b16 a[28:29], v10 offset:50784
v_mfma_f32_16x16x32_bf16 v[76:79], a[60:63], v[136:139], v[76:79]
ds_read_b64_tr_b16 a[30:31], v10 offset:51296
s_waitcnt vmcnt(20) lgkmcnt(8)
s_barrier
v_mfma_f32_16x16x32_bf16 v[32:35], a[0:3], v[144:147], v[32:35]
ds_read_b64_tr_b16 a[32:33], v7 offset:59136
s_add_u32 m0, s55, 33792
v_mfma_f32_16x16x32_bf16 v[48:51], a[0:3], v[148:151], v[48:51]
buffer_load_dwordx4 v5, s[28:31], s54 offen lds
v_mfma_f32_16x16x32_bf16 v[52:55], a[4:7], v[148:151], v[52:55]
ds_read_b64_tr_b16 a[34:35], v7 offset:59648
ds_read_b64_tr_b16 a[36:37], v7 offset:59168
v_mfma_f32_16x16x32_bf16 v[36:39], a[4:7], v[144:147], v[36:39]
ds_read_b64_tr_b16 a[38:39], v7 offset:59680
v_mfma_f32_16x16x32_bf16 v[40:43], a[8:11], v[144:147], v[40:43]
buffer_load_dwordx4 v[128:131], v4, s[16:19], s52 offen sc1
v_mfma_f32_16x16x32_bf16 v[56:59], a[8:11], v[148:151], v[56:59]
ds_read_b64_tr_b16 a[40:41], v7 offset:59200
ds_read_b64_tr_b16 a[42:43], v7 offset:59712
v_mfma_f32_16x16x32_bf16 v[60:63], a[12:15], v[148:151], v[60:63]
ds_read_b64_tr_b16 a[44:45], v7 offset:59232
ds_read_b64_tr_b16 a[46:47], v7 offset:59744
v_mfma_f32_16x16x32_bf16 v[44:47], a[12:15], v[144:147], v[44:47]
s_waitcnt lgkmcnt(8)
v_mfma_f32_16x16x32_bf16 v[64:67], a[16:19], v[144:147], v[64:67]
buffer_load_dwordx4 v6, s[28:31], s54 offen offset:1056 lds
v_mfma_f32_16x16x32_bf16 v[80:83], a[16:19], v[148:151], v[80:83]
ds_read_b64_tr_b16 a[48:49], v10 offset:59136
s_add_u32 s54, s54, 0x10000
v_mfma_f32_16x16x32_bf16 v[84:87], a[20:23], v[148:151], v[84:87]
ds_read_b64_tr_b16 a[50:51], v10 offset:59648
ds_read_b64_tr_b16 a[52:53], v10 offset:59168
v_mfma_f32_16x16x32_bf16 v[68:71], a[20:23], v[144:147], v[68:71]
ds_read_b64_tr_b16 a[54:55], v10 offset:59680
v_mfma_f32_16x16x32_bf16 v[72:75], a[24:27], v[144:147], v[72:75]
buffer_load_dwordx4 v[132:135], v4, s[16:19], s52 offen offset:1024 sc1
v_mfma_f32_16x16x32_bf16 v[88:91], a[24:27], v[148:151], v[88:91]
ds_read_b64_tr_b16 a[56:57], v10 offset:59200
s_add_u32 s52, s52, 0x20000
v_mfma_f32_16x16x32_bf16 v[92:95], a[28:31], v[148:151], v[92:95]
ds_read_b64_tr_b16 a[58:59], v10 offset:59712
ds_read_b64_tr_b16 a[60:61], v10 offset:59232
v_mfma_f32_16x16x32_bf16 v[76:79], a[28:31], v[144:147], v[76:79]
ds_read_b64_tr_b16 a[62:63], v10 offset:59744
v_add_u32 v7, s57, v7
v_add_u32 v10, s57, v10
s_sub_u32 s57, 0, s57
s_waitcnt vmcnt(20) lgkmcnt(8)
v_mfma_f32_16x16x32_bf16 v[32:35], a[32:35], v[152:155], v[32:35]
ds_read_b64_tr_b16 a[0:1], v10
s_add_u32 m0, s55, 42240
v_mfma_f32_16x16x32_bf16 v[48:51], a[32:35], v[156:159], v[48:51]
buffer_load_dwordx4 v5, s[28:31], s54 offen lds
v_mfma_f32_16x16x32_bf16 v[52:55], a[36:39], v[156:159], v[52:55]
ds_read_b64_tr_b16 a[2:3], v10 offset:512
ds_read_b64_tr_b16 a[4:5], v10 offset:32
v_mfma_f32_16x16x32_bf16 v[36:39], a[36:39], v[152:155], v[36:39]
ds_read_b64_tr_b16 a[6:7], v10 offset:544
v_mfma_f32_16x16x32_bf16 v[40:43], a[40:43], v[152:155], v[40:43]
buffer_load_dwordx4 v[136:139], v4, s[16:19], s52 offen sc1
v_mfma_f32_16x16x32_bf16 v[56:59], a[40:43], v[156:159], v[56:59]
ds_read_b64_tr_b16 a[8:9], v10 offset:64
ds_read_b64_tr_b16 a[10:11], v10 offset:576
v_mfma_f32_16x16x32_bf16 v[60:63], a[44:47], v[156:159], v[60:63]
ds_read_b64_tr_b16 a[12:13], v10 offset:96
ds_read_b64_tr_b16 a[14:15], v10 offset:608
v_mfma_f32_16x16x32_bf16 v[44:47], a[44:47], v[152:155], v[44:47]
s_waitcnt lgkmcnt(8)
v_mfma_f32_16x16x32_bf16 v[64:67], a[48:51], v[152:155], v[64:67]
buffer_load_dwordx4 v6, s[28:31], s54 offen offset:1056 lds
v_mfma_f32_16x16x32_bf16 v[80:83], a[48:51], v[156:159], v[80:83]
ds_read_b64_tr_b16 a[16:17], v10 offset:8448
s_add_u32 s54, s54, 0x10000
v_mfma_f32_16x16x32_bf16 v[84:87], a[52:55], v[156:159], v[84:87]
ds_read_b64_tr_b16 a[18:19], v10 offset:8960
ds_read_b64_tr_b16 a[20:21], v10 offset:8480
v_mfma_f32_16x16x32_bf16 v[68:71], a[52:55], v[152:155], v[68:71]
ds_read_b64_tr_b16 a[22:23], v10 offset:8992
v_mfma_f32_16x16x32_bf16 v[72:75], a[56:59], v[152:155], v[72:75]
buffer_load_dwordx4 v[140:143], v4, s[16:19], s52 offen offset:1024 sc1
v_mfma_f32_16x16x32_bf16 v[88:91], a[56:59], v[156:159], v[88:91]
ds_read_b64_tr_b16 a[24:25], v10 offset:8512
s_add_u32 s52, s52, 0x20000
v_mfma_f32_16x16x32_bf16 v[92:95], a[60:63], v[156:159], v[92:95]
ds_read_b64_tr_b16 a[26:27], v10 offset:9024
ds_read_b64_tr_b16 a[28:29], v10 offset:8544
v_mfma_f32_16x16x32_bf16 v[76:79], a[60:63], v[152:155], v[76:79]
ds_read_b64_tr_b16 a[30:31], v10 offset:9056
s_mov_b32 s62, s55
s_mov_b32 s55, s56
s_mov_b32 s56, s62
s_waitcnt vmcnt(20) lgkmcnt(8)
s_barrier
v_mfma_f32_16x16x32_bf16 v[64:67], a[0:3], v[96:99], v[64:67]
ds_read_b64_tr_b16 a[32:33], v10 offset:16896
ds_read_b64_tr_b16 a[34:35], v10 offset:17408
s_add_u32 m0, s56, 50688
v_mfma_f32_16x16x32_bf16 v[80:83], a[0:3], v[100:103], v[80:83]
ds_read_b64_tr_b16 a[36:37], v10 offset:16928
buffer_load_dwordx4 v5, s[28:31], s54 offen lds
v_mfma_f32_16x16x32_bf16 v[84:87], a[4:7], v[100:103], v[84:87]
buffer_load_dwordx4 v6, s[28:31], s54 offen offset:1056 lds
v_mfma_f32_16x16x32_bf16 v[68:71], a[4:7], v[96:99], v[68:71]
ds_read_b64_tr_b16 a[38:39], v10 offset:17440
ds_read_b64_tr_b16 a[40:41], v10 offset:16960
s_add_u32 s54, s54, 0x10000
v_mfma_f32_16x16x32_bf16 v[72:75], a[8:11], v[96:99], v[72:75]
buffer_load_dwordx4 v[144:147], v4, s[16:19], s52 offen sc1
v_mfma_f32_16x16x32_bf16 v[88:91], a[8:11], v[100:103], v[88:91]
ds_read_b64_tr_b16 a[42:43], v10 offset:17472
ds_read_b64_tr_b16 a[44:45], v10 offset:16992
v_mfma_f32_16x16x32_bf16 v[92:95], a[12:15], v[100:103], v[92:95]
buffer_load_dwordx4 v[148:151], v4, s[16:19], s52 offen offset:1024 sc1
v_mfma_f32_16x16x32_bf16 v[76:79], a[12:15], v[96:99], v[76:79]
ds_read_b64_tr_b16 a[46:47], v10 offset:17504
s_add_u32 s52, s52, 0x20000
s_add_u32 m0, s56, 59136
s_waitcnt vmcnt(20) lgkmcnt(8)
v_mfma_f32_16x16x32_bf16 v[64:67], a[16:19], v[104:107], v[64:67]
ds_read_b64_tr_b16 a[48:49], v10 offset:25344
buffer_load_dwordx4 v5, s[28:31], s54 offen lds
v_mfma_f32_16x16x32_bf16 v[80:83], a[16:19], v[108:111], v[80:83]
ds_read_b64_tr_b16 a[50:51], v10 offset:25856
v_mfma_f32_16x16x32_bf16 v[84:87], a[20:23], v[108:111], v[84:87]
ds_read_b64_tr_b16 a[52:53], v10 offset:25376
buffer_load_dwordx4 v6, s[28:31], s54 offen offset:1056 lds
v_mfma_f32_16x16x32_bf16 v[68:71], a[20:23], v[104:107], v[68:71]
ds_read_b64_tr_b16 a[54:55], v10 offset:25888
s_add_u32 s54, s54, 0x10000
v_mfma_f32_16x16x32_bf16 v[72:75], a[24:27], v[104:107], v[72:75]
ds_read_b64_tr_b16 a[56:57], v10 offset:25408
buffer_load_dwordx4 v[152:155], v4, s[16:19], s52 offen sc1
v_mfma_f32_16x16x32_bf16 v[88:91], a[24:27], v[108:111], v[88:91]
ds_read_b64_tr_b16 a[58:59], v10 offset:25920
v_mfma_f32_16x16x32_bf16 v[92:95], a[28:31], v[108:111], v[92:95]
ds_read_b64_tr_b16 a[60:61], v10 offset:25440
buffer_load_dwordx4 v[156:159], v4, s[16:19], s52 offen offset:1024 sc1
v_mfma_f32_16x16x32_bf16 v[76:79], a[28:31], v[104:107], v[76:79]
ds_read_b64_tr_b16 a[62:63], v10 offset:25952
s_add_u32 s52, s52, 0x20000
s_waitcnt vmcnt(20) lgkmcnt(8)
v_mfma_f32_16x16x32_bf16 v[64:67], a[32:35], v[112:115], v[64:67]
ds_read_b64_tr_b16 a[0:1], v10 offset:33792
ds_read_b64_tr_b16 a[2:3], v10 offset:34304
v_mfma_f32_16x16x32_bf16 v[80:83], a[32:35], v[116:119], v[80:83]
buffer_load_dwordx4 v[160:163], v4, s[16:19], s52 offen sc1
v_mfma_f32_16x16x32_bf16 v[84:87], a[36:39], v[116:119], v[84:87]
ds_read_b64_tr_b16 a[4:5], v10 offset:33824
ds_read_b64_tr_b16 a[6:7], v10 offset:34336
v_mfma_f32_16x16x32_bf16 v[68:71], a[36:39], v[112:115], v[68:71]
ds_read_b64_tr_b16 a[8:9], v10 offset:33856
v_mfma_f32_16x16x32_bf16 v[72:75], a[40:43], v[112:115], v[72:75]
buffer_load_dwordx4 v[164:167], v4, s[16:19], s52 offen offset:1024 sc1
v_mfma_f32_16x16x32_bf16 v[88:91], a[40:43], v[116:119], v[88:91]
ds_read_b64_tr_b16 a[10:11], v10 offset:34368
s_add_u32 s52, s52, 0x20000
v_mfma_f32_16x16x32_bf16 v[92:95], a[44:47], v[116:119], v[92:95]
ds_read_b64_tr_b16 a[12:13], v10 offset:33888
v_mfma_f32_16x16x32_bf16 v[76:79], a[44:47], v[112:115], v[76:79]
ds_read_b64_tr_b16 a[14:15], v10 offset:34400
s_waitcnt vmcnt(18) lgkmcnt(8)
v_mfma_f32_16x16x32_bf16 v[64:67], a[48:51], v[120:123], v[64:67]
buffer_load_dwordx4 v[168:171], v4, s[16:19], s52 offen sc1
v_mfma_f32_16x16x32_bf16 v[80:83], a[48:51], v[124:127], v[80:83]
ds_read_b64_tr_b16 a[16:17], v10 offset:42240
ds_read_b64_tr_b16 a[18:19], v10 offset:42752
v_mfma_f32_16x16x32_bf16 v[84:87], a[52:55], v[124:127], v[84:87]
ds_read_b64_tr_b16 a[20:21], v10 offset:42272
v_mfma_f32_16x16x32_bf16 v[68:71], a[52:55], v[120:123], v[68:71]
ds_read_b64_tr_b16 a[22:23], v10 offset:42784
ds_read_b64_tr_b16 a[24:25], v10 offset:42304
v_mfma_f32_16x16x32_bf16 v[72:75], a[56:59], v[120:123], v[72:75]
buffer_load_dwordx4 v[172:175], v4, s[16:19], s52 offen offset:1024 sc1
v_mfma_f32_16x16x32_bf16 v[88:91], a[56:59], v[124:127], v[88:91]
s_add_u32 s52, s52, 0x20000
v_mfma_f32_16x16x32_bf16 v[92:95], a[60:63], v[124:127], v[92:95]
ds_read_b64_tr_b16 a[26:27], v10 offset:42816
ds_read_b64_tr_b16 a[28:29], v10 offset:42336
v_mfma_f32_16x16x32_bf16 v[76:79], a[60:63], v[120:123], v[76:79]
ds_read_b64_tr_b16 a[30:31], v10 offset:42848
s_waitcnt vmcnt(16) lgkmcnt(8)
v_mfma_f32_16x16x32_bf16 v[64:67], a[0:3], v[128:131], v[64:67]
ds_read_b64_tr_b16 a[32:33], v10 offset:50688
ds_read_b64_tr_b16 a[34:35], v10 offset:51200
v_mfma_f32_16x16x32_bf16 v[80:83], a[0:3], v[132:135], v[80:83]
buffer_load_dwordx4 v[176:179], v4, s[16:19], s52 offen sc1
v_mfma_f32_16x16x32_bf16 v[84:87], a[4:7], v[132:135], v[84:87]
ds_read_b64_tr_b16 a[36:37], v10 offset:50720
ds_read_b64_tr_b16 a[38:39], v10 offset:51232
v_mfma_f32_16x16x32_bf16 v[68:71], a[4:7], v[128:131], v[68:71]
ds_read_b64_tr_b16 a[40:41], v10 offset:50752
v_mfma_f32_16x16x32_bf16 v[72:75], a[8:11], v[128:131], v[72:75]
buffer_load_dwordx4 v[180:183], v4, s[16:19], s52 offen offset:1024 sc1
v_mfma_f32_16x16x32_bf16 v[88:91], a[8:11], v[132:135], v[88:91]
ds_read_b64_tr_b16 a[42:43], v10 offset:51264
s_add_u32 s52, s52, 0x20000
v_mfma_f32_16x16x32_bf16 v[92:95], a[12:15], v[132:135], v[92:95]
ds_read_b64_tr_b16 a[44:45], v10 offset:50784
v_mfma_f32_16x16x32_bf16 v[76:79], a[12:15], v[128:131], v[76:79]
ds_read_b64_tr_b16 a[46:47], v10 offset:51296
s_waitcnt vmcnt(14) lgkmcnt(8)
v_mfma_f32_16x16x32_bf16 v[64:67], a[16:19], v[136:139], v[64:67]
buffer_load_dwordx4 v[184:187], v4, s[16:19], s52 offen sc1
v_mfma_f32_16x16x32_bf16 v[80:83], a[16:19], v[140:143], v[80:83]
ds_read_b64_tr_b16 a[48:49], v10 offset:59136
ds_read_b64_tr_b16 a[50:51], v10 offset:59648
v_mfma_f32_16x16x32_bf16 v[84:87], a[20:23], v[140:143], v[84:87]
ds_read_b64_tr_b16 a[52:53], v10 offset:59168
v_mfma_f32_16x16x32_bf16 v[68:71], a[20:23], v[136:139], v[68:71]
ds_read_b64_tr_b16 a[54:55], v10 offset:59680
ds_read_b64_tr_b16 a[56:57], v10 offset:59200
v_mfma_f32_16x16x32_bf16 v[72:75], a[24:27], v[136:139], v[72:75]
buffer_load_dwordx4 v[188:191], v4, s[16:19], s52 offen offset:1024 sc1
v_mfma_f32_16x16x32_bf16 v[88:91], a[24:27], v[140:143], v[88:91]
s_add_u32 s52, s52, 0x20000
v_mfma_f32_16x16x32_bf16 v[92:95], a[28:31], v[140:143], v[92:95]
ds_read_b64_tr_b16 a[58:59], v10 offset:59712
ds_read_b64_tr_b16 a[60:61], v10 offset:59232
v_mfma_f32_16x16x32_bf16 v[76:79], a[28:31], v[136:139], v[76:79]
ds_read_b64_tr_b16 a[62:63], v10 offset:59744
s_waitcnt vmcnt(10) lgkmcnt(8)
s_barrier
v_add_u32 v10, s57, v10
v_mfma_f32_16x16x32_bf16 v[64:67], a[32:35], v[144:147], v[64:67]
ds_read_b64_tr_b16 a[0:1], v10
ds_read_b64_tr_b16 a[2:3], v10 offset:512
v_mfma_f32_16x16x32_bf16 v[80:83], a[32:35], v[148:151], v[80:83]
buffer_load_dwordx4 v[192:195], v4, s[16:19], s52 offen sc1
v_mfma_f32_16x16x32_bf16 v[84:87], a[36:39], v[148:151], v[84:87]
ds_read_b64_tr_b16 a[4:5], v10 offset:32
ds_read_b64_tr_b16 a[6:7], v10 offset:544
v_mfma_f32_16x16x32_bf16 v[68:71], a[36:39], v[144:147], v[68:71]
ds_read_b64_tr_b16 a[8:9], v10 offset:64
v_mfma_f32_16x16x32_bf16 v[72:75], a[40:43], v[144:147], v[72:75]
buffer_load_dwordx4 v[196:199], v4, s[16:19], s52 offen offset:1024 sc1
v_mfma_f32_16x16x32_bf16 v[88:91], a[40:43], v[148:151], v[88:91]
ds_read_b64_tr_b16 a[10:11], v10 offset:576
s_add_u32 s52, s52, 0x20000
v_mfma_f32_16x16x32_bf16 v[92:95], a[44:47], v[148:151], v[92:95]
ds_read_b64_tr_b16 a[12:13], v10 offset:96
v_mfma_f32_16x16x32_bf16 v[76:79], a[44:47], v[144:147], v[76:79]
ds_read_b64_tr_b16 a[14:15], v10 offset:608
s_waitcnt vmcnt(10) lgkmcnt(8)
v_mfma_f32_16x16x32_bf16 v[64:67], a[48:51], v[152:155], v[64:67]
buffer_load_dwordx4 v[200:203], v4, s[16:19], s52 offen sc1
v_mfma_f32_16x16x32_bf16 v[80:83], a[48:51], v[156:159], v[80:83]
ds_read_b64_tr_b16 a[16:17], v10 offset:8448
ds_read_b64_tr_b16 a[18:19], v10 offset:8960
v_mfma_f32_16x16x32_bf16 v[84:87], a[52:55], v[156:159], v[84:87]
ds_read_b64_tr_b16 a[20:21], v10 offset:8480
v_mfma_f32_16x16x32_bf16 v[68:71], a[52:55], v[152:155], v[68:71]
ds_read_b64_tr_b16 a[22:23], v10 offset:8992
ds_read_b64_tr_b16 a[24:25], v10 offset:8512
v_mfma_f32_16x16x32_bf16 v[72:75], a[56:59], v[152:155], v[72:75]
buffer_load_dwordx4 v[204:207], v4, s[16:19], s52 offen offset:1024 sc1
v_mfma_f32_16x16x32_bf16 v[88:91], a[56:59], v[156:159], v[88:91]
s_add_u32 s52, s52, 0x20000
v_mfma_f32_16x16x32_bf16 v[92:95], a[60:63], v[156:159], v[92:95]
ds_read_b64_tr_b16 a[26:27], v10 offset:9024
ds_read_b64_tr_b16 a[28:29], v10 offset:8544
v_mfma_f32_16x16x32_bf16 v[76:79], a[60:63], v[152:155], v[76:79]
ds_read_b64_tr_b16 a[30:31], v10 offset:9056
s_waitcnt vmcnt(10) lgkmcnt(8)
v_mfma_f32_16x16x32_bf16 v[64:67], a[0:3], v[160:163], v[64:67]
ds_read_b64_tr_b16 a[32:33], v10 offset:16896
ds_read_b64_tr_b16 a[34:35], v10 offset:17408
v_mfma_f32_16x16x32_bf16 v[80:83], a[0:3], v[164:167], v[80:83]
buffer_load_dwordx4 v[208:211], v4, s[16:19], s52 offen sc1
v_mfma_f32_16x16x32_bf16 v[84:87], a[4:7], v[164:167], v[84:87]
ds_read_b64_tr_b16 a[36:37], v10 offset:16928
ds_read_b64_tr_b16 a[38:39], v10 offset:17440
v_mfma_f32_16x16x32_bf16 v[68:71], a[4:7], v[160:163], v[68:71]
ds_read_b64_tr_b16 a[40:41], v10 offset:16960
v_mfma_f32_16x16x32_bf16 v[72:75], a[8:11], v[160:163], v[72:75]
buffer_load_dwordx4 v[212:215], v4, s[16:19], s52 offen offset:1024 sc1
v_mfma_f32_16x16x32_bf16 v[88:91], a[8:11], v[164:167], v[88:91]
ds_read_b64_tr_b16 a[42:43], v10 offset:17472
s_add_u32 s52, s52, 0x20000
v_mfma_f32_16x16x32_bf16 v[92:95], a[12:15], v[164:167], v[92:95]
ds_read_b64_tr_b16 a[44:45], v10 offset:16992
v_mfma_f32_16x16x32_bf16 v[76:79], a[12:15], v[160:163], v[76:79]
ds_read_b64_tr_b16 a[46:47], v10 offset:17504
s_waitcnt vmcnt(10) lgkmcnt(8)
v_mfma_f32_16x16x32_bf16 v[64:67], a[16:19], v[168:171], v[64:67]
buffer_load_dwordx4 v[216:219], v4, s[16:19], s52 offen sc1
v_mfma_f32_16x16x32_bf16 v[80:83], a[16:19], v[172:175], v[80:83]
ds_read_b64_tr_b16 a[48:49], v10 offset:25344
ds_read_b64_tr_b16 a[50:51], v10 offset:25856
v_mfma_f32_16x16x32_bf16 v[84:87], a[20:23], v[172:175], v[84:87]
ds_read_b64_tr_b16 a[52:53], v10 offset:25376
v_mfma_f32_16x16x32_bf16 v[68:71], a[20:23], v[168:171], v[68:71]
ds_read_b64_tr_b16 a[54:55], v10 offset:25888
ds_read_b64_tr_b16 a[56:57], v10 offset:25408
v_mfma_f32_16x16x32_bf16 v[72:75], a[24:27], v[168:171], v[72:75]
buffer_load_dwordx4 v[220:223], v4, s[16:19], s52 offen offset:1024 sc1
v_mfma_f32_16x16x32_bf16 v[88:91], a[24:27], v[172:175], v[88:91]
s_add_u32 s52, s52, 0x20000
v_mfma_f32_16x16x32_bf16 v[92:95], a[28:31], v[172:175], v[92:95]
ds_read_b64_tr_b16 a[58:59], v10 offset:25920
ds_read_b64_tr_b16 a[60:61], v10 offset:25440
v_mfma_f32_16x16x32_bf16 v[76:79], a[28:31], v[168:171], v[76:79]
ds_read_b64_tr_b16 a[62:63], v10 offset:25952
s_waitcnt vmcnt(10) lgkmcnt(8)
v_mfma_f32_16x16x32_bf16 v[64:67], a[32:35], v[176:179], v[64:67]
ds_read_b64_tr_b16 a[0:1], v10 offset:33792
v_mfma_f32_16x16x32_bf16 v[80:83], a[32:35], v[180:183], v[80:83]
ds_read_b64_tr_b16 a[2:3], v10 offset:34304
v_mfma_f32_16x16x32_bf16 v[84:87], a[36:39], v[180:183], v[84:87]
ds_read_b64_tr_b16 a[4:5], v10 offset:33824
v_mfma_f32_16x16x32_bf16 v[68:71], a[36:39], v[176:179], v[68:71]
ds_read_b64_tr_b16 a[6:7], v10 offset:34336
v_mfma_f32_16x16x32_bf16 v[72:75], a[40:43], v[176:179], v[72:75]
ds_read_b64_tr_b16 a[8:9], v10 offset:33856
v_mfma_f32_16x16x32_bf16 v[88:91], a[40:43], v[180:183], v[88:91]
ds_read_b64_tr_b16 a[10:11], v10 offset:34368
v_mfma_f32_16x16x32_bf16 v[92:95], a[44:47], v[180:183], v[92:95]
ds_read_b64_tr_b16 a[12:13], v10 offset:33888
v_mfma_f32_16x16x32_bf16 v[76:79], a[44:47], v[176:179], v[76:79]
ds_read_b64_tr_b16 a[14:15], v10 offset:34400
s_waitcnt vmcnt(8) lgkmcnt(8)
v_mfma_f32_16x16x32_bf16 v[64:67], a[48:51], v[184:187], v[64:67]
ds_read_b64_tr_b16 a[16:17], v10 offset:42240
v_mfma_f32_16x16x32_bf16 v[80:83], a[48:51], v[188:191], v[80:83]
ds_read_b64_tr_b16 a[18:19], v10 offset:42752
v_mfma_f32_16x16x32_bf16 v[84:87], a[52:55], v[188:191], v[84:87]
ds_read_b64_tr_b16 a[20:21], v10 offset:42272
v_mfma_f32_16x16x32_bf16 v[68:71], a[52:55], v[184:187], v[68:71]
ds_read_b64_tr_b16 a[22:23], v10 offset:42784
v_mfma_f32_16x16x32_bf16 v[72:75], a[56:59], v[184:187], v[72:75]
ds_read_b64_tr_b16 a[24:25], v10 offset:42304
v_mfma_f32_16x16x32_bf16 v[88:91], a[56:59], v[188:191], v[88:91]
ds_read_b64_tr_b16 a[26:27], v10 offset:42816
v_mfma_f32_16x16x32_bf16 v[92:95], a[60:63], v[188:191], v[92:95]
ds_read_b64_tr_b16 a[28:29], v10 offset:42336
v_mfma_f32_16x16x32_bf16 v[76:79], a[60:63], v[184:187], v[76:79]
ds_read_b64_tr_b16 a[30:31], v10 offset:42848
s_waitcnt vmcnt(6) lgkmcnt(8)
v_mfma_f32_16x16x32_bf16 v[64:67], a[0:3], v[192:195], v[64:67]
ds_read_b64_tr_b16 a[32:33], v10 offset:50688
v_mfma_f32_16x16x32_bf16 v[80:83], a[0:3], v[196:199], v[80:83]
ds_read_b64_tr_b16 a[34:35], v10 offset:51200
v_mfma_f32_16x16x32_bf16 v[84:87], a[4:7], v[196:199], v[84:87]
ds_read_b64_tr_b16 a[36:37], v10 offset:50720
v_mfma_f32_16x16x32_bf16 v[68:71], a[4:7], v[192:195], v[68:71]
ds_read_b64_tr_b16 a[38:39], v10 offset:51232
v_mfma_f32_16x16x32_bf16 v[72:75], a[8:11], v[192:195], v[72:75]
ds_read_b64_tr_b16 a[40:41], v10 offset:50752
v_mfma_f32_16x16x32_bf16 v[88:91], a[8:11], v[196:199], v[88:91]
ds_read_b64_tr_b16 a[42:43], v10 offset:51264
v_mfma_f32_16x16x32_bf16 v[92:95], a[12:15], v[196:199], v[92:95]
ds_read_b64_tr_b16 a[44:45], v10 offset:50784
v_mfma_f32_16x16x32_bf16 v[76:79], a[12:15], v[192:195], v[76:79]
ds_read_b64_tr_b16 a[46:47], v10 offset:51296
s_waitcnt vmcnt(4) lgkmcnt(8)
v_mfma_f32_16x16x32_bf16 v[64:67], a[16:19], v[200:203], v[64:67]
ds_read_b64_tr_b16 a[48:49], v10 offset:59136
v_mfma_f32_16x16x32_bf16 v[80:83], a[16:19], v[204:207], v[80:83]
ds_read_b64_tr_b16 a[50:51], v10 offset:59648
v_mfma_f32_16x16x32_bf16 v[84:87], a[20:23], v[204:207], v[84:87]
ds_read_b64_tr_b16 a[52:53], v10 offset:59168
v_mfma_f32_16x16x32_bf16 v[68:71], a[20:23], v[200:203], v[68:71]
ds_read_b64_tr_b16 a[54:55], v10 offset:59680
v_mfma_f32_16x16x32_bf16 v[72:75], a[24:27], v[200:203], v[72:75]
ds_read_b64_tr_b16 a[56:57], v10 offset:59200
v_mfma_f32_16x16x32_bf16 v[88:91], a[24:27], v[204:207], v[88:91]
ds_read_b64_tr_b16 a[58:59], v10 offset:59712
v_mfma_f32_16x16x32_bf16 v[92:95], a[28:31], v[204:207], v[92:95]
ds_read_b64_tr_b16 a[60:61], v10 offset:59232
v_mfma_f32_16x16x32_bf16 v[76:79], a[28:31], v[200:203], v[76:79]
ds_read_b64_tr_b16 a[62:63], v10 offset:59744
s_waitcnt vmcnt(2) lgkmcnt(8)
v_mfma_f32_16x16x32_bf16 v[64:67], a[32:35], v[208:211], v[64:67]
ds_read_b64_tr_b16 a[0:1], v7
v_mfma_f32_16x16x32_bf16 v[80:83], a[32:35], v[212:215], v[80:83]
ds_read_b64_tr_b16 a[2:3], v7 offset:512
v_mfma_f32_16x16x32_bf16 v[84:87], a[36:39], v[212:215], v[84:87]
ds_read_b64_tr_b16 a[4:5], v7 offset:32
v_mfma_f32_16x16x32_bf16 v[68:71], a[36:39], v[208:211], v[68:71]
ds_read_b64_tr_b16 a[6:7], v7 offset:544
v_mfma_f32_16x16x32_bf16 v[72:75], a[40:43], v[208:211], v[72:75]
ds_read_b64_tr_b16 a[8:9], v7 offset:64
v_mfma_f32_16x16x32_bf16 v[88:91], a[40:43], v[212:215], v[88:91]
ds_read_b64_tr_b16 a[10:11], v7 offset:576
v_mfma_f32_16x16x32_bf16 v[92:95], a[44:47], v[212:215], v[92:95]
ds_read_b64_tr_b16 a[12:13], v7 offset:96
v_mfma_f32_16x16x32_bf16 v[76:79], a[44:47], v[208:211], v[76:79]
ds_read_b64_tr_b16 a[14:15], v7 offset:608
s_waitcnt vmcnt(0) lgkmcnt(8)
v_mfma_f32_16x16x32_bf16 v[64:67], a[48:51], v[216:219], v[64:67]
ds_read_b64_tr_b16 a[16:17], v7 offset:8448
v_mfma_f32_16x16x32_bf16 v[80:83], a[48:51], v[220:223], v[80:83]
ds_read_b64_tr_b16 a[18:19], v7 offset:8960
v_mfma_f32_16x16x32_bf16 v[84:87], a[52:55], v[220:223], v[84:87]
ds_read_b64_tr_b16 a[20:21], v7 offset:8480
v_mfma_f32_16x16x32_bf16 v[68:71], a[52:55], v[216:219], v[68:71]
ds_read_b64_tr_b16 a[22:23], v7 offset:8992
v_mfma_f32_16x16x32_bf16 v[72:75], a[56:59], v[216:219], v[72:75]
ds_read_b64_tr_b16 a[24:25], v7 offset:8512
v_mfma_f32_16x16x32_bf16 v[88:91], a[56:59], v[220:223], v[88:91]
ds_read_b64_tr_b16 a[26:27], v7 offset:9024
v_mfma_f32_16x16x32_bf16 v[92:95], a[60:63], v[220:223], v[92:95]
ds_read_b64_tr_b16 a[28:29], v7 offset:8544
v_mfma_f32_16x16x32_bf16 v[76:79], a[60:63], v[216:219], v[76:79]
ds_read_b64_tr_b16 a[30:31], v7 offset:9056
s_waitcnt lgkmcnt(8)
v_mfma_f32_16x16x32_bf16 v[32:35], a[0:3], v[96:99], v[32:35]
ds_read_b64_tr_b16 a[32:33], v7 offset:16896
v_cvt_pk_bf16_f32 v232, v64, v65
v_cvt_pk_bf16_f32 v233, v66, v67
v_mfma_f32_16x16x32_bf16 v[48:51], a[0:3], v[100:103], v[48:51]
ds_read_b64_tr_b16 a[34:35], v7 offset:17408
v_cvt_pk_bf16_f32 v234, v68, v69
v_mfma_f32_16x16x32_bf16 v[52:55], a[4:7], v[100:103], v[52:55]
ds_read_b64_tr_b16 a[36:37], v7 offset:16928
v_cvt_pk_bf16_f32 v235, v70, v71
buffer_store_dwordx4 v[232:235], v11, s[16:19], s69 offen sc1
v_mfma_f32_16x16x32_bf16 v[36:39], a[4:7], v[96:99], v[36:39]
ds_read_b64_tr_b16 a[38:39], v7 offset:17440
s_add_u32 s69, s69, 131072
v_mfma_f32_16x16x32_bf16 v[40:43], a[8:11], v[96:99], v[40:43]
ds_read_b64_tr_b16 a[40:41], v7 offset:16960
v_cvt_pk_bf16_f32 v236, v72, v73
v_cvt_pk_bf16_f32 v237, v74, v75
v_mfma_f32_16x16x32_bf16 v[56:59], a[8:11], v[100:103], v[56:59]
ds_read_b64_tr_b16 a[42:43], v7 offset:17472
v_cvt_pk_bf16_f32 v238, v76, v77
v_mfma_f32_16x16x32_bf16 v[60:63], a[12:15], v[100:103], v[60:63]
ds_read_b64_tr_b16 a[44:45], v7 offset:16992
v_cvt_pk_bf16_f32 v239, v78, v79
buffer_store_dwordx4 v[236:239], v11, s[16:19], s69 offen sc1
v_mfma_f32_16x16x32_bf16 v[44:47], a[12:15], v[96:99], v[44:47]
ds_read_b64_tr_b16 a[46:47], v7 offset:17504
s_add_u32 s69, s69, -130048
s_waitcnt lgkmcnt(8)
v_mfma_f32_16x16x32_bf16 v[32:35], a[16:19], v[104:107], v[32:35]
ds_read_b64_tr_b16 a[48:49], v7 offset:25344
v_cvt_pk_bf16_f32 v240, v80, v81
v_mfma_f32_16x16x32_bf16 v[48:51], a[16:19], v[108:111], v[48:51]
ds_read_b64_tr_b16 a[50:51], v7 offset:25856
v_cvt_pk_bf16_f32 v241, v82, v83
v_cvt_pk_bf16_f32 v242, v84, v85
v_mfma_f32_16x16x32_bf16 v[52:55], a[20:23], v[108:111], v[52:55]
ds_read_b64_tr_b16 a[52:53], v7 offset:25376
v_cvt_pk_bf16_f32 v243, v86, v87
v_mfma_f32_16x16x32_bf16 v[36:39], a[20:23], v[104:107], v[36:39]
ds_read_b64_tr_b16 a[54:55], v7 offset:25888
buffer_store_dwordx4 v[240:243], v11, s[16:19], s69 offen sc1
s_add_u32 s69, s69, 131072
v_mfma_f32_16x16x32_bf16 v[40:43], a[24:27], v[104:107], v[40:43]
ds_read_b64_tr_b16 a[56:57], v7 offset:25408
v_cvt_pk_bf16_f32 v244, v88, v89
v_mfma_f32_16x16x32_bf16 v[56:59], a[24:27], v[108:111], v[56:59]
ds_read_b64_tr_b16 a[58:59], v7 offset:25920
v_cvt_pk_bf16_f32 v245, v90, v91
v_cvt_pk_bf16_f32 v246, v92, v93
v_mfma_f32_16x16x32_bf16 v[60:63], a[28:31], v[108:111], v[60:63]
ds_read_b64_tr_b16 a[60:61], v7 offset:25440
v_cvt_pk_bf16_f32 v247, v94, v95
v_mfma_f32_16x16x32_bf16 v[44:47], a[28:31], v[104:107], v[44:47]
ds_read_b64_tr_b16 a[62:63], v7 offset:25952
buffer_store_dwordx4 v[244:247], v11, s[16:19], s69 offen sc1
s_waitcnt lgkmcnt(8)
v_mfma_f32_16x16x32_bf16 v[32:35], a[32:35], v[112:115], v[32:35]
ds_read_b64_tr_b16 a[0:1], v7 offset:33792
v_mfma_f32_16x16x32_bf16 v[48:51], a[32:35], v[116:119], v[48:51]
ds_read_b64_tr_b16 a[2:3], v7 offset:34304
v_mfma_f32_16x16x32_bf16 v[52:55], a[36:39], v[116:119], v[52:55]
ds_read_b64_tr_b16 a[4:5], v7 offset:33824
v_mfma_f32_16x16x32_bf16 v[36:39], a[36:39], v[112:115], v[36:39]
ds_read_b64_tr_b16 a[6:7], v7 offset:34336
v_mfma_f32_16x16x32_bf16 v[40:43], a[40:43], v[112:115], v[40:43]
ds_read_b64_tr_b16 a[8:9], v7 offset:33856
v_mfma_f32_16x16x32_bf16 v[56:59], a[40:43], v[116:119], v[56:59]
ds_read_b64_tr_b16 a[10:11], v7 offset:34368
v_mfma_f32_16x16x32_bf16 v[60:63], a[44:47], v[116:119], v[60:63]
.Lpad9:
s_cbranch_execz .Lnopoll51r
ds_read_b64_tr_b16 a[12:13], v7 offset:33888
v_mfma_f32_16x16x32_bf16 v[44:47], a[44:47], v[112:115], v[44:47]
ds_read_b64_tr_b16 a[14:15], v7 offset:34400
s_waitcnt lgkmcnt(8)
v_mfma_f32_16x16x32_bf16 v[32:35], a[48:51], v[120:123], v[32:35]
ds_read_b64_tr_b16 a[16:17], v7 offset:42240
v_mfma_f32_16x16x32_bf16 v[48:51], a[48:51], v[124:127], v[48:51]
ds_read_b64_tr_b16 a[18:19], v7 offset:42752
v_mfma_f32_16x16x32_bf16 v[52:55], a[52:55], v[124:127], v[52:55]
ds_read_b64_tr_b16 a[20:21], v7 offset:42272
v_mfma_f32_16x16x32_bf16 v[36:39], a[52:55], v[120:123], v[36:39]
ds_read_b64_tr_b16 a[22:23], v7 offset:42784
v_mfma_f32_16x16x32_bf16 v[40:43], a[56:59], v[120:123], v[40:43]
ds_read_b64_tr_b16 a[24:25], v7 offset:42304
v_mfma_f32_16x16x32_bf16 v[56:59], a[56:59], v[124:127], v[56:59]
ds_read_b64_tr_b16 a[26:27], v7 offset:42816
v_mfma_f32_16x16x32_bf16 v[60:63], a[60:63], v[124:127], v[60:63]
ds_read_b64_tr_b16 a[28:29], v7 offset:42336
v_mfma_f32_16x16x32_bf16 v[44:47], a[60:63], v[120:123], v[44:47]
ds_read_b64_tr_b16 a[30:31], v7 offset:42848
s_waitcnt lgkmcnt(8)
v_mfma_f32_16x16x32_bf16 v[32:35], a[0:3], v[128:131], v[32:35]
ds_read_b64_tr_b16 a[32:33], v7 offset:50688
v_mfma_f32_16x16x32_bf16 v[48:51], a[0:3], v[132:135], v[48:51]
ds_read_b64_tr_b16 a[34:35], v7 offset:51200
v_mfma_f32_16x16x32_bf16 v[52:55], a[4:7], v[132:135], v[52:55]
ds_read_b64_tr_b16 a[36:37], v7 offset:50720
v_mfma_f32_16x16x32_bf16 v[36:39], a[4:7], v[128:131], v[36:39]
ds_read_b64_tr_b16 a[38:39], v7 offset:51232
v_mfma_f32_16x16x32_bf16 v[40:43], a[8:11], v[128:131], v[40:43]
ds_read_b64_tr_b16 a[40:41], v7 offset:50752
v_mfma_f32_16x16x32_bf16 v[56:59], a[8:11], v[132:135], v[56:59]
ds_read_b64_tr_b16 a[42:43], v7 offset:51264
v_mfma_f32_16x16x32_bf16 v[60:63], a[12:15], v[132:135], v[60:63]
ds_read_b64_tr_b16 a[44:45], v7 offset:50784
v_mfma_f32_16x16x32_bf16 v[44:47], a[12:15], v[128:131], v[44:47]
ds_read_b64_tr_b16 a[46:47], v7 offset:51296
s_waitcnt lgkmcnt(8)
v_mfma_f32_16x16x32_bf16 v[32:35], a[16:19], v[136:139], v[32:35]
ds_read_b64_tr_b16 a[48:49], v7 offset:59136
v_mfma_f32_16x16x32_bf16 v[48:51], a[16:19], v[140:143], v[48:51]
ds_read_b64_tr_b16 a[50:51], v7 offset:59648
v_mfma_f32_16x16x32_bf16 v[52:55], a[20:23], v[140:143], v[52:55]
ds_read_b64_tr_b16 a[52:53], v7 offset:59168
v_mfma_f32_16x16x32_bf16 v[36:39], a[20:23], v[136:139], v[36:39]
ds_read_b64_tr_b16 a[54:55], v7 offset:59680
v_mfma_f32_16x16x32_bf16 v[40:43], a[24:27], v[136:139], v[40:43]
ds_read_b64_tr_b16 a[56:57], v7 offset:59200
v_mfma_f32_16x16x32_bf16 v[56:59], a[24:27], v[140:143], v[56:59]
ds_read_b64_tr_b16 a[58:59], v7 offset:59712
v_mfma_f32_16x16x32_bf16 v[60:63], a[28:31], v[140:143], v[60:63]
ds_read_b64_tr_b16 a[60:61], v7 offset:59232
v_mfma_f32_16x16x32_bf16 v[44:47], a[28:31], v[136:139], v[44:47]
ds_read_b64_tr_b16 a[62:63], v7 offset:59744
v_add_u32 v7, s57, v7
s_waitcnt lgkmcnt(8)
v_mfma_f32_16x16x32_bf16 v[32:35], a[32:35], v[144:147], v[32:35]
ds_read_b64_tr_b16 a[0:1], v7
v_mfma_f32_16x16x32_bf16 v[48:51], a[32:35], v[148:151], v[48:51]
ds_read_b64_tr_b16 a[2:3], v7 offset:512
v_mfma_f32_16x16x32_bf16 v[52:55], a[36:39], v[148:151], v[52:55]
ds_read_b64_tr_b16 a[4:5], v7 offset:32
v_mfma_f32_16x16x32_bf16 v[36:39], a[36:39], v[144:147], v[36:39]
ds_read_b64_tr_b16 a[6:7], v7 offset:544
v_mfma_f32_16x16x32_bf16 v[40:43], a[40:43], v[144:147], v[40:43]
ds_read_b64_tr_b16 a[8:9], v7 offset:64
v_mfma_f32_16x16x32_bf16 v[56:59], a[40:43], v[148:151], v[56:59]
ds_read_b64_tr_b16 a[10:11], v7 offset:576
v_mfma_f32_16x16x32_bf16 v[60:63], a[44:47], v[148:151], v[60:63]
ds_read_b64_tr_b16 a[12:13], v7 offset:96
v_mfma_f32_16x16x32_bf16 v[44:47], a[44:47], v[144:147], v[44:47]
ds_read_b64_tr_b16 a[14:15], v7 offset:608
s_waitcnt lgkmcnt(8)
v_mfma_f32_16x16x32_bf16 v[32:35], a[48:51], v[152:155], v[32:35]
ds_read_b64_tr_b16 a[16:17], v7 offset:8448
v_mfma_f32_16x16x32_bf16 v[48:51], a[48:51], v[156:159], v[48:51]
ds_read_b64_tr_b16 a[18:19], v7 offset:8960
v_mfma_f32_16x16x32_bf16 v[52:55], a[52:55], v[156:159], v[52:55]
ds_read_b64_tr_b16 a[20:21], v7 offset:8480
v_mfma_f32_16x16x32_bf16 v[36:39], a[52:55], v[152:155], v[36:39]
ds_read_b64_tr_b16 a[22:23], v7 offset:8992
v_mfma_f32_16x16x32_bf16 v[40:43], a[56:59], v[152:155], v[40:43]
ds_read_b64_tr_b16 a[24:25], v7 offset:8512
v_mfma_f32_16x16x32_bf16 v[56:59], a[56:59], v[156:159], v[56:59]
ds_read_b64_tr_b16 a[26:27], v7 offset:9024
v_mfma_f32_16x16x32_bf16 v[60:63], a[60:63], v[156:159], v[60:63]
ds_read_b64_tr_b16 a[28:29], v7 offset:8544
v_mfma_f32_16x16x32_bf16 v[44:47], a[60:63], v[152:155], v[44:47]
ds_read_b64_tr_b16 a[30:31], v7 offset:9056
s_waitcnt lgkmcnt(8)
s_barrier
v_mfma_f32_16x16x32_bf16 v[32:35], a[0:3], v[160:163], v[32:35]
ds_read_b64_tr_b16 a[32:33], v7 offset:16896
ds_read_b64_tr_b16 a[34:35], v7 offset:17408
v_mfma_f32_16x16x32_bf16 v[48:51], a[0:3], v[164:167], v[48:51]
s_waitcnt vmcnt(0)
buffer_atomic_add v13, v12, s[16:19], s71 offen
v_mfma_f32_16x16x32_bf16 v[52:55], a[4:7], v[164:167], v[52:55]
ds_read_b64_tr_b16 a[36:37], v7 offset:16928
ds_read_b64_tr_b16 a[38:39], v7 offset:17440
v_mfma_f32_16x16x32_bf16 v[36:39], a[4:7], v[160:163], v[36:39]
ds_read_b64_tr_b16 a[40:41], v7 offset:16960
s_add_u32 m0, s59, 117248
v_mfma_f32_16x16x32_bf16 v[40:43], a[8:11], v[160:163], v[40:43]
buffer_load_dwordx4 v18, s[20:23], s58 offen lds
v_mfma_f32_16x16x32_bf16 v[56:59], a[8:11], v[164:167], v[56:59]
ds_read_b64_tr_b16 a[42:43], v7 offset:17472
ds_read_b64_tr_b16 a[44:45], v7 offset:16992
v_mfma_f32_16x16x32_bf16 v[60:63], a[12:15], v[164:167], v[60:63]
ds_read_b64_tr_b16 a[46:47], v7 offset:17504
v_mfma_f32_16x16x32_bf16 v[44:47], a[12:15], v[160:163], v[44:47]
ds_read_b64_tr_b16 a[48:49], v7 offset:25344
s_waitcnt lgkmcnt(9)
v_mfma_f32_16x16x32_bf16 v[32:35], a[16:19], v[168:171], v[32:35]
buffer_load_dwordx4 v19, s[20:23], s58 offen offset:1024 lds
v_mfma_f32_16x16x32_bf16 v[48:51], a[16:19], v[172:175], v[48:51]
ds_read_b64_tr_b16 a[50:51], v7 offset:25856
ds_read_b64_tr_b16 a[52:53], v7 offset:25376
v_mfma_f32_16x16x32_bf16 v[52:55], a[20:23], v[172:175], v[52:55]
buffer_load_dwordx4 v20, s[20:23], s58 offen offset:2048 lds
v_mfma_f32_16x16x32_bf16 v[36:39], a[20:23], v[168:171], v[36:39]
ds_read_b64_tr_b16 a[54:55], v7 offset:25888
s_add_u32 s58, s58, 196608
v_mfma_f32_16x16x32_bf16 v[40:43], a[24:27], v[168:171], v[40:43]
ds_read_b64_tr_b16 a[56:57], v7 offset:25408
s_add_u32 m0, s59, 129664
v_mfma_f32_16x16x32_bf16 v[56:59], a[24:27], v[172:175], v[56:59]
buffer_load_dwordx4 v18, s[20:23], s58 offen lds
v_mfma_f32_16x16x32_bf16 v[60:63], a[28:31], v[172:175], v[60:63]
ds_read_b64_tr_b16 a[58:59], v7 offset:25920
ds_read_b64_tr_b16 a[60:61], v7 offset:25440
v_mfma_f32_16x16x32_bf16 v[44:47], a[28:31], v[168:171], v[44:47]
ds_read_b64_tr_b16 a[62:63], v7 offset:25952
s_waitcnt lgkmcnt(8)
v_mfma_f32_16x16x32_bf16 v[32:35], a[32:35], v[176:179], v[32:35]
ds_read_b64_tr_b16 a[0:1], v7 offset:33792
ds_read_b64_tr_b16 a[2:3], v7 offset:34304
v_mfma_f32_16x16x32_bf16 v[48:51], a[32:35], v[180:183], v[48:51]
buffer_load_dwordx4 v19, s[20:23], s58 offen offset:1024 lds
v_mfma_f32_16x16x32_bf16 v[52:55], a[36:39], v[180:183], v[52:55]
ds_read_b64_tr_b16 a[4:5], v7 offset:33824
v_mfma_f32_16x16x32_bf16 v[36:39], a[36:39], v[176:179], v[36:39]
ds_read_b64_tr_b16 a[6:7], v7 offset:34336
ds_read_b64_tr_b16 a[8:9], v7 offset:33856
v_mfma_f32_16x16x32_bf16 v[40:43], a[40:43], v[176:179], v[40:43]
buffer_load_dwordx4 v20, s[20:23], s58 offen offset:2048 lds
v_mfma_f32_16x16x32_bf16 v[56:59], a[40:43], v[180:183], v[56:59]
ds_read_b64_tr_b16 a[10:11], v7 offset:34368
s_add_u32 s58, s58, 196608
v_mfma_f32_16x16x32_bf16 v[60:63], a[44:47], v[180:183], v[60:63]
ds_read_b64_tr_b16 a[12:13], v7 offset:33888
v_mfma_f32_16x16x32_bf16 v[44:47], a[44:47], v[176:179], v[44:47]
ds_read_b64_tr_b16 a[14:15], v7 offset:34400
s_add_u32 m0, s59, 67584
s_waitcnt lgkmcnt(8)
v_mfma_f32_16x16x32_bf16 v[32:35], a[48:51], v[184:187], v[32:35]
buffer_load_dwordx4 v18, s[20:23], s58 offen lds
v_mfma_f32_16x16x32_bf16 v[48:51], a[48:51], v[188:191], v[48:51]
ds_read_b64_tr_b16 a[16:17], v7 offset:42240
v_mfma_f32_16x16x32_bf16 v[52:55], a[52:55], v[188:191], v[52:55]
ds_read_b64_tr_b16 a[18:19], v7 offset:42752
ds_read_b64_tr_b16 a[20:21], v7 offset:42272
v_mfma_f32_16x16x32_bf16 v[36:39], a[52:55], v[184:187], v[36:39]
ds_read_b64_tr_b16 a[22:23], v7 offset:42784
v_mfma_f32_16x16x32_bf16 v[40:43], a[56:59], v[184:187], v[40:43]
buffer_load_dwordx4 v19, s[20:23], s58 offen offset:1024 lds
v_mfma_f32_16x16x32_bf16 v[56:59], a[56:59], v[188:191], v[56:59]
ds_read_b64_tr_b16 a[24:25], v7 offset:42304
ds_read_b64_tr_b16 a[26:27], v7 offset:42816
v_mfma_f32_16x16x32_bf16 v[60:63], a[60:63], v[188:191], v[60:63]
ds_read_b64_tr_b16 a[28:29], v7 offset:42336
v_mfma_f32_16x16x32_bf16 v[44:47], a[60:63], v[184:187], v[44:47]
ds_read_b64_tr_b16 a[30:31], v7 offset:42848
s_waitcnt lgkmcnt(8)
v_mfma_f32_16x16x32_bf16 v[32:35], a[0:3], v[192:195], v[32:35]
ds_read_b64_tr_b16 a[32:33], v7 offset:50688
ds_read_b64_tr_b16 a[34:35], v7 offset:51200
v_mfma_f32_16x16x32_bf16 v[48:51], a[0:3], v[196:199], v[48:51]
buffer_atomic_add v15, v12, s[16:19], s70 offen sc0
v_mfma_f32_16x16x32_bf16 v[52:55], a[4:7], v[196:199], v[52:55]
ds_read_b64_tr_b16 a[36:37], v7 offset:50720
ds_read_b64_tr_b16 a[38:39], v7 offset:51232
v_mfma_f32_16x16x32_bf16 v[36:39], a[4:7], v[192:195], v[36:39]
ds_read_b64_tr_b16 a[40:41], v7 offset:50752
ds_read_b64_tr_b16 a[42:43], v7 offset:51264
v_mfma_f32_16x16x32_bf16 v[40:43], a[8:11], v[192:195], v[40:43]
buffer_load_dwordx4 v20, s[20:23], s58 offen offset:2048 lds
v_mfma_f32_16x16x32_bf16 v[56:59], a[8:11], v[196:199], v[56:59]
s_add_u32 s58, s58, 196608
v_mfma_f32_16x16x32_bf16 v[60:63], a[12:15], v[196:199], v[60:63]
ds_read_b64_tr_b16 a[44:45], v7 offset:50784
ds_read_b64_tr_b16 a[46:47], v7 offset:51296
v_mfma_f32_16x16x32_bf16 v[44:47], a[12:15], v[192:195], v[44:47]
ds_read_b64_tr_b16 a[48:49], v7 offset:59136
s_add_u32 m0, s59, 80000
s_waitcnt lgkmcnt(9)
v_mfma_f32_16x16x32_bf16 v[32:35], a[16:19], v[200:203], v[32:35]
buffer_load_dwordx4 v18, s[20:23], s58 offen lds
v_mfma_f32_16x16x32_bf16 v[48:51], a[16:19], v[204:207], v[48:51]
ds_read_b64_tr_b16 a[50:51], v7 offset:59648
ds_read_b64_tr_b16 a[52:53], v7 offset:59168
v_mfma_f32_16x16x32_bf16 v[52:55], a[20:23], v[204:207], v[52:55]
buffer_load_dwordx4 v19, s[20:23], s58 offen offset:1024 lds
v_mfma_f32_16x16x32_bf16 v[36:39], a[20:23], v[200:203], v[36:39]
ds_read_b64_tr_b16 a[54:55], v7 offset:59680
v_mfma_f32_16x16x32_bf16 v[40:43], a[24:27], v[200:203], v[40:43]
ds_read_b64_tr_b16 a[56:57], v7 offset:59200
ds_read_b64_tr_b16 a[58:59], v7 offset:59712
v_mfma_f32_16x16x32_bf16 v[56:59], a[24:27], v[204:207], v[56:59]
buffer_load_dwordx4 v20, s[20:23], s58 offen offset:2048 lds
v_mfma_f32_16x16x32_bf16 v[60:63], a[28:31], v[204:207], v[60:63]
ds_read_b64_tr_b16 a[60:61], v7 offset:59232
s_add_u32 s58, s58, 196608
v_mfma_f32_16x16x32_bf16 v[44:47], a[28:31], v[200:203], v[44:47]
ds_read_b64_tr_b16 a[62:63], v7 offset:59744
s_waitcnt lgkmcnt(8)
v_mfma_f32_16x16x32_bf16 v[32:35], a[32:35], v[208:211], v[32:35]
s_add_u32 m0, s59, 92416
v_mfma_f32_16x16x32_bf16 v[48:51], a[32:35], v[212:215], v[48:51]
buffer_load_dwordx4 v18, s[20:23], s58 offen lds
v_mfma_f32_16x16x32_bf16 v[52:55], a[36:39], v[212:215], v[52:55]
v_mfma_f32_16x16x32_bf16 v[36:39], a[36:39], v[208:211], v[36:39]
v_mfma_f32_16x16x32_bf16 v[40:43], a[40:43], v[208:211], v[40:43]
v_mfma_f32_16x16x32_bf16 v[56:59], a[40:43], v[212:215], v[56:59]
v_mfma_f32_16x16x32_bf16 v[60:63], a[44:47], v[212:215], v[60:63]
buffer_load_dwordx4 v19, s[20:23], s58 offen offset:1024 lds
v_mfma_f32_16x16x32_bf16 v[44:47], a[44:47], v[208:211], v[44:47]
s_waitcnt lgkmcnt(0)
v_mfma_f32_16x16x32_bf16 v[32:35], a[48:51], v[216:219], v[32:35]
v_mfma_f32_16x16x32_bf16 v[48:51], a[48:51], v[220:223], v[48:51]
v_mfma_f32_16x16x32_bf16 v[52:55], a[52:55], v[220:223], v[52:55]
v_mfma_f32_16x16x32_bf16 v[36:39], a[52:55], v[216:219], v[36:39]
buffer_load_dwordx4 v20, s[20:23], s58 offen offset:2048 lds
v_mfma_f32_16x16x32_bf16 v[40:43], a[56:59], v[216:219], v[40:43]
s_add_u32 s58, s58, 196608
v_mfma_f32_16x16x32_bf16 v[56:59], a[56:59], v[220:223], v[56:59]
v_mfma_f32_16x16x32_bf16 v[60:63], a[60:63], v[220:223], v[60:63]
v_mfma_f32_16x16x32_bf16 v[44:47], a[60:63], v[216:219], v[44:47]
s_waitcnt vmcnt(7)
v_cmp_ne_u32 vcc, 0, v15
s_nop 0
s_cbranch_vccz .Lxs54
.Lxs54b:
buffer_load_dwordx4 v[232:235], v11, s[16:19], s68 offen sc1
s_add_u32 s68, s68, 131072
buffer_load_dwordx4 v[236:239], v11, s[16:19], s68 offen sc1
s_add_u32 s68, s68, -130048
buffer_load_dwordx4 v[240:243], v11, s[16:19], s68 offen sc1
s_add_u32 s68, s68, 131072
buffer_load_dwordx4 v[244:247], v11, s[16:19], s68 offen sc1
s_waitcnt vmcnt(3)
v_mfma_f32_16x16x32_bf16 v[32:35], v[226:229], v[232:235], v[32:35]
s_lshl_b32 s64, s6, 14
s_lshl_b32 s65, s49, 13
s_add_u32 s64, s64, s65
v_mfma_f32_16x16x32_bf16 v[36:39], v[224:227], v[232:235], v[36:39]
s_lshl_b32 s65, s7, 9
s_add_u32 s64, s64, s65
s_lshl_b32 s65, s48, 8
s_waitcnt vmcnt(2)
v_mfma_f32_16x16x32_bf16 v[40:43], v[226:229], v[236:239], v[40:43]
s_add_u32 s64, s64, s65
s_add_u32 s64, s64, 62914560
v_and_b32 v152, 31, v1
v_mfma_f32_16x16x32_bf16 v[44:47], v[224:227], v[236:239], v[44:47]
s_lshl_b32 s62, s7, 18
v_lshlrev_b32 v152, 3, v152
v_lshrrev_b32 v153, 5, v1
s_waitcnt vmcnt(1)
v_mfma_f32_16x16x32_bf16 v[48:51], v[226:229], v[240:243], v[48:51]
s_add_u32 s62, s62, 33554432
v_lshl_add_u32 v152, v153, 28, v152
s_add_u32 s63, s62, 0x20000
v_mfma_f32_16x16x32_bf16 v[52:55], v[224:227], v[240:243], v[52:55]
v_cvt_pk_bf16_f32 v128, v32, v33
v_cvt_pk_bf16_f32 v129, v34, v35
s_waitcnt vmcnt(0)
v_mfma_f32_16x16x32_bf16 v[56:59], v[226:229], v[244:247], v[56:59]
v_cvt_pk_bf16_f32 v130, v36, v37
v_cvt_pk_bf16_f32 v131, v38, v39
v_mfma_f32_16x16x32_bf16 v[60:63], v[224:227], v[244:247], v[60:63]
buffer_store_dwordx4 v[128:131], v4, s[16:19], s62 offen sc1
v_cvt_pk_bf16_f32 v132, v40, v41
v_cvt_pk_bf16_f32 v133, v42, v43
v_cvt_pk_bf16_f32 v134, v44, v45
v_cvt_pk_bf16_f32 v135, v46, v47
v_cvt_pk_bf16_f32 v136, v48, v49
v_cvt_pk_bf16_f32 v137, v50, v51
v_cvt_pk_bf16_f32 v138, v52, v53
v_cvt_pk_bf16_f32 v139, v54, v55
v_cvt_pk_bf16_f32 v140, v56, v57
v_cvt_pk_bf16_f32 v141, v58, v59
v_cvt_pk_bf16_f32 v142, v60, v61
v_cvt_pk_bf16_f32 v143, v62, v63
v_pk_mul_f32 v[146:147], v[32:33], v[32:33]
buffer_store_dwordx4 v[132:135], v4, s[16:19], s63 offen sc1
v_pk_mul_f32 v[150:151], v[48:49], v[48:49]
v_pk_fma_f32 v[146:147], v[34:35], v[34:35], v[146:147]
v_pk_add_f32 v[144:145], v[32:33], v[34:35]
v_pk_fma_f32 v[150:151], v[50:51], v[50:51], v[150:151]
v_pk_add_f32 v[148:149], v[48:49], v[50:51]
v_pk_fma_f32 v[146:147], v[36:37], v[36:37], v[146:147]
v_pk_add_f32 v[144:145], v[144:145], v[36:37]
v_pk_fma_f32 v[150:151], v[52:53], v[52:53], v[150:151]
v_pk_add_f32 v[148:149], v[148:149], v[52:53]
v_pk_fma_f32 v[146:147], v[38:39], v[38:39], v[146:147]
v_pk_add_f32 v[144:145], v[144:145], v[38:39]
v_pk_fma_f32 v[150:151], v[54:55], v[54:55], v[150:151]
v_pk_add_f32 v[148:149], v[148:149], v[54:55]
buffer_store_dwordx4 v[136:139], v4, s[16:19], s62 offen offset:1024 sc1
v_pk_fma_f32 v[146:147], v[40:41], v[40:41], v[146:147]
v_pk_add_f32 v[144:145], v[144:145], v[40:41]
v_pk_fma_f32 v[150:151], v[56:57], v[56:57], v[150:151]
v_pk_add_f32 v[148:149], v[148:149], v[56:57]
v_pk_fma_f32 v[146:147], v[42:43], v[42:43], v[146:147]
v_pk_add_f32 v[144:145], v[144:145], v[42:43]
v_pk_fma_f32 v[150:151], v[58:59], v[58:59], v[150:151]
v_pk_add_f32 v[148:149], v[148:149], v[58:59]
v_pk_fma_f32 v[146:147], v[44:45], v[44:45], v[146:147]
v_pk_add_f32 v[144:145], v[144:145], v[44:45]
v_pk_fma_f32 v[150:151], v[60:61], v[60:61], v[150:151]
v_pk_add_f32 v[148:149], v[148:149], v[60:61]
v_pk_fma_f32 v[146:147], v[46:47], v[46:47], v[146:147]
buffer_store_dwordx4 v[140:143], v4, s[16:19], s63 offen offset:1024 sc1
v_pk_add_f32 v[144:145], v[144:145], v[46:47]
v_pk_fma_f32 v[150:151], v[62:63], v[62:63], v[150:151]
v_pk_add_f32 v[148:149], v[148:149], v[62:63]
v_add_f32 v144, v144, v145
v_add_f32 v146, v146, v147
v_add_f32 v148, v148, v149
v_add_f32 v150, v150, v151
s_nop 0
v_permlane16_swap_b32 v144, v148
v_permlane16_swap_b32 v146, v150
v_add_f32 v144, v144, v148
v_add_f32 v146, v146, v150
s_nop 1
v_permlane32_swap_b32 v144, v146
v_add_f32 v144, v144, v146
s_nop 1
v_permlane32_swap_b32 v144, v145
buffer_store_dwordx2 v[144:145], v152, s[16:19], s64 offen sc1
s_nop 1
v_accvgpr_write_b32 a224, v32
v_accvgpr_write_b32 a225, v33
v_accvgpr_write_b32 a226, v34
v_accvgpr_write_b32 a227, v35
v_accvgpr_write_b32 a228, v36
v_accvgpr_write_b32 a229, v37
v_accvgpr_write_b32 a230, v38
v_accvgpr_write_b32 a231, v39
v_accvgpr_write_b32 a232, v40
v_accvgpr_write_b32 a233, v41
v_accvgpr_write_b32 a234, v42
v_accvgpr_write_b32 a235, v43
v_accvgpr_write_b32 a236, v44
v_accvgpr_write_b32 a237, v45
v_accvgpr_write_b32 a238, v46
v_accvgpr_write_b32 a239, v47
v_accvgpr_write_b32 a240, v48
v_accvgpr_write_b32 a241, v49
v_accvgpr_write_b32 a242, v50
v_accvgpr_write_b32 a243, v51
v_accvgpr_write_b32 a244, v52
v_accvgpr_write_b32 a245, v53
v_accvgpr_write_b32 a246, v54
v_accvgpr_write_b32 a247, v55
v_accvgpr_write_b32 a248, v56
v_accvgpr_write_b32 a249, v57
v_accvgpr_write_b32 a250, v58
v_accvgpr_write_b32 a251, v59
v_accvgpr_write_b32 a252, v60
v_accvgpr_write_b32 a253, v61
v_accvgpr_write_b32 a254, v62
v_accvgpr_write_b32 a255, v63
s_lshl_b32 s62, s8, 13
s_lshl_b32 s63, s3, 11
s_add_u32 s62, s62, s63
v_lshl_add_u32 v21, v1, 4, s62
s_lshl_b32 s62, s50, 10
s_sub_u32 s62, s62, 2048
v_lshl_add_u32 v22, v0, 2, s62
s_mul_i32 s62, s48, 4608
v_lshl_add_u32 v23, v1, 4, s62
v_lshrrev_b32 v24, 4, v1
v_mul_u32_u24 v24, 2304, v24
v_and_b32 v2, 15, v1
v_lshl_add_u32 v24, v2, 4, v24
s_mov_b32 s52, 33554432
s_mov_b32 s54, s58
s_mov_b32 s56, s59
s_mul_i32 s55, s3, 2304
v_bfe_u32 v25, v1, 3, 2
v_mul_u32_u24 v25, 3104, v25
v_bfe_u32 v2, v1, 2, 1
v_lshl_add_u32 v25, v2, 7, v25
v_bfe_u32 v2, v1, 5, 1
v_lshl_add_u32 v25, v2, 8, v25
v_and_b32 v2, 3, v1
v_lshl_add_u32 v25, v2, 3, v25
s_lshl_b32 s62, s49, 6
s_add_u32 s62, s62, 67584
v_add_u32 v25, s62, v25
s_lshl_b32 s62, s8, 1
s_add_u32 s62, s62, s3
s_lshr_b32 s63, s50, 2
s_cmp_lt_u32 s3, 2
s_cselect_b32 s62, s62, s63
s_lshl_b32 s62, s62, 13
s_cmp_eq_u32 s3, 3
s_cselect_b32 s62, 268435456, s62
v_lshl_add_u32 v26, v1, 4, s62
s_lshr_b32 s63, s20, 7
s_sub_u32 s63, 3, s63
s_and_b32 s63, s63, 7
s_and_b32 s62, s9, 8
s_add_u32 s63, s63, s62
s_lshl_b32 s62, s5, 2
s_add_u32 s62, s62, s3
s_mul_i32 s62, s62, 12288
s_lshl_b32 s64, s63, 7
s_add_u32 s62, s62, s64
s_xor_b32 s63, s63, s9
s_cmp_lt_u32 s63, 4
s_cselect_b32 s62, s62, 16777216
v_lshrrev_b32 v14, 3, v1
v_min_u32 v14, 5, v14
v_lshl_add_u32 v14, v14, 11, s62
s_mov_b32 s44, 983040
buffer_load_dword v27, v14, s[20:23], s44 offen
s_mov_b32 s44, 2555904
s_mul_i32 s59, s3, 2080
v_bfe_u32 v5, v1, 3, 1
v_lshrrev_b32 v2, 4, v1
v_lshl_add_u32 v5, v2, 3, v5
s_lshl_b32 s62, s3, 1
v_add_u32 v5, s62, v5
v_mul_u32_u24 v5, 2048, v5
v_and_b32 v2, 7, v1
v_lshl_add_u32 v5, v2, 4, v5
s_lshl_b32 s62, s7, 7
v_add_u32 v5, s62, v5
v_add_u32 v6, 64512, v5
s_lshl_b32 s62, s6, 7
s_add_u32 s62, s62, 30416896
s_lshl_b32 s64, s8, 7
s_add_u32 s64, s64, 30416896
s_lshr_b32 s65, s50, 3
s_lshl_b32 s65, s65, 7
s_add_u32 s65, s65, 30416896
v_mov_b32 v252, s62
v_mov_b32 v253, s64
v_writelane_b32 v253, s65, 1
s_waitcnt vmcnt(1) lgkmcnt(0)
s_barrier
s_cmp_lg_u32 s3, 0
s_cbranch_scc1 .Lnosig55
v_mov_b32 v255, 1
s_mov_b64 exec, 1
buffer_atomic_add v255, v252, s[16:19], 0 offen
s_mov_b64 exec, -1
.Lnosig55:
s_cmp_lg_u32 s3, 1
s_cbranch_scc1 .Lfirst59
s_mov_b64 exec, 3
v_mov_b32 v254, 0
buffer_atomic_add v254, v253, s[16:19], 0 offen sc0
s_mov_b64 exec, -1
.Lfirst59:
ds_read_b64_tr_b16 a[20:21], v25 offset:49664
ds_read_b64_tr_b16 a[22:23], v25 offset:50176
ds_read_b64_tr_b16 a[24:25], v25 offset:49696
ds_read_b64_tr_b16 a[26:27], v25 offset:50208
ds_read_b64_tr_b16 a[28:29], v25 offset:50688
ds_read_b64_tr_b16 a[30:31], v25 offset:51200
ds_read_b64_tr_b16 a[32:33], v25 offset:50720
ds_read_b64_tr_b16 a[34:35], v25 offset:51232
ds_read_b64_tr_b16 a[36:37], v25 offset:51712
ds_read_b64_tr_b16 a[38:39], v25 offset:52224
ds_read_b64_tr_b16 a[40:41], v25 offset:51744
ds_read_b64_tr_b16 a[42:43], v25 offset:52256
v_lshrrev_b32 v2, 4, v1
v_lshlrev_b32 v2, 2, v2
v_and_b32 v13, 15, v1
v_sub_u32 v2, v13, v2
v_mov_b32 v13, 0xff61b1e6
v_subrev_u32 v54, 0, v2
v_cmp_gt_u32 vcc, 8, v54
s_nop 1
v_cndmask_b32 v50, v13, 0, vcc
v_cmp_gt_i32 vcc, -8, v54
s_nop 1
v_cndmask_b32 v46, v13, 0, vcc
v_subrev_u32 v54, 1, v2
v_cmp_gt_u32 vcc, 8, v54
s_nop 1
v_cndmask_b32 v51, v13, 0, vcc
v_cmp_gt_i32 vcc, -8, v54
s_nop 1
v_cndmask_b32 v47, v13, 0, vcc
v_subrev_u32 v54, 2, v2
v_cmp_gt_u32 vcc, 8, v54
s_nop 1
v_cndmask_b32 v52, v13, 0, vcc
v_cmp_gt_i32 vcc, -8, v54
s_nop 1
v_cndmask_b32 v48, v13, 0, vcc
v_subrev_u32 v54, 3, v2
v_cmp_gt_u32 vcc, 8, v54
s_nop 1
v_cndmask_b32 v53, v13, 0, vcc
v_cmp_gt_i32 vcc, -8, v54
s_nop 1
v_cndmask_b32 v49, v13, 0, vcc
s_cmp_lt_u32 s8, 2
s_cselect_b64 vcc, -1, 0
v_cndmask_b32 v54, v46, v13, vcc
v_cndmask_b32 v55, v47, v13, vcc
v_cndmask_b32 v56, v48, v13, vcc
v_cndmask_b32 v57, v49, v13, vcc
v_mov_b64 v[60:61], 0
v_mov_b64 v[62:63], 0
v_mov_b64 v[64:65], 0
v_mov_b64 v[66:67], 0
v_mov_b64 v[68:69], 0
v_mov_b64 v[70:71], 0
v_mov_b64 v[72:73], 0
v_mov_b64 v[74:75], 0
v_mov_b64 v[76:77], 0
v_mov_b64 v[78:79], 0
v_mov_b64 v[80:81], 0
v_mov_b64 v[82:83], 0
v_mov_b64 v[84:85], 0
v_mov_b64 v[86:87], 0
v_mov_b64 v[88:89], 0
v_mov_b64 v[90:91], 0
v_mov_b64 v[92:93], 0
v_mov_b64 v[94:95], 0
v_mov_b64 v[96:97], 0
v_mov_b64 v[98:99], 0
v_mov_b64 v[100:101], 0
v_mov_b64 v[102:103], 0
v_mov_b64 v[104:105], 0
v_mov_b64 v[106:107], 0
v_mov_b64 v[108:109], 0
v_mov_b64 v[110:111], 0
v_mov_b64 v[112:113], 0
v_mov_b64 v[114:115], 0
v_mov_b64 v[116:117], 0
v_mov_b64 v[118:119], 0
v_mov_b64 v[120:121], 0
v_mov_b64 v[122:123], 0
v_mov_b64 v[124:125], 0
v_mov_b64 v[126:127], 0
v_mov_b64 v[128:129], 0
v_mov_b64 v[130:131], 0
v_mov_b64 v[132:133], 0
v_mov_b64 v[134:135], 0
v_mov_b64 v[136:137], 0
v_mov_b64 v[138:139], 0
v_mov_b64 v[140:141], 0
v_mov_b64 v[142:143], 0
v_mov_b64 v[144:145], 0
v_mov_b64 v[146:147], 0
v_mov_b64 v[148:149], 0
v_mov_b64 v[150:151], 0
v_mov_b64 v[152:153], 0
v_mov_b64 v[154:155], 0
v_mov_b64 v[156:157], 0
v_mov_b64 v[158:159], 0
v_mov_b64 v[160:161], 0
v_mov_b64 v[162:163], 0
v_mov_b64 v[164:165], 0
v_mov_b64 v[166:167], 0
v_mov_b64 v[168:169], 0
v_mov_b64 v[170:171], 0
v_mov_b64 v[172:173], 0
v_mov_b64 v[174:175], 0
s_mov_b32 s75, 62914560
v_and_b32 v10, 15, v1
v_lshlrev_b32 v12, 2, v10
v_lshlrev_b32 v10, 4, v10
v_add_u32 v10, 152576, v10
v_lshrrev_b32 v11, 4, v1
v_lshlrev_b32 v11, 4, v11
s_lshl_b32 s62, s49, 7
s_add_u32 s62, s62, 158720
v_add_u32 v12, s62, v12
v_add_u32 v13, s62, v11
v_add_u32 v11, 156672, v11
s_lshl_b32 s62, s3, 11
s_add_u32 s62, s62, 143360
v_lshl_add_u32 v8, v1, 4, s62
v_xor_b32 v9, 2048, v8
v_mov_b32 v248, 0x3f803f80
v_mov_b32 v249, 0x3f803f80
v_mov_b32 v250, 0x3f803f80
v_mov_b32 v251, 0x3f803f80
v_and_b32 v7, 31, v1
v_lshrrev_b32 v2, 5, v1
v_lshl_add_u32 v7, v7, 1, v2
v_and_b32 v2, 0xc0, v0
v_add_u32 v7, v7, v2
v_lshlrev_b32 v17, 2, v7
v_add_u32 v17, 156672, v17
v_lshlrev_b32 v7, 4, v7
v_add_u32 v7, 152576, v7
s_lshl_b32 s74, s9, 1
s_add_u32 s74, s74, s49
s_lshl_b32 s74, s74, 17
s_lshl_b32 s63, s8, 13
s_add_u32 s74, s74, s63
s_lshl_b32 s63, s48, 12
s_add_u32 s74, s74, s63
s_add_u32 s74, s74, 37748736
s_mov_b32 s62, 0
v_lshl_add_u32 v4, v1, 4, s62
ds_read_b128 v[28:31], v13
ds_read_b128 v[32:35], v13 offset:64
ds_read_b128 v[36:39], v13 offset:256
ds_read_b128 v[40:43], v13 offset:320
ds_read_b32 v44, v12 offset:512
.Lpad10:
s_cbranch_execz .Lnopoll51r
ds_read_b32 v45, v12 offset:576
s_waitcnt lgkmcnt(0)
s_cmp_lg_u32 s3, 1
s_cbranch_scc1 .Lnopoll58
s_mov_b64 exec, 3
s_mov_b32 s15, 0
.Lpoll56:
s_waitcnt vmcnt(0)
v_cmp_ne_u32 vcc, 16, v254
s_add_u32 s15, s15, 1
s_cbranch_vccz .Lnopoll58r
s_sleep 2
s_mov_b64 exec, 3
v_mov_b32 v254, 0
buffer_atomic_add v254, v253, s[16:19], 0 offen sc0
s_cmp_le_u32 s15, 100000
s_cbranch_scc1 .Lpoll56
.Lgot57:
s_waitcnt vmcnt(0)
s_branch .Lnopoll58r
.Lnopoll58:
s_mov_b64 exec, 0
s_cmp_eq_u32 s3, 2
s_cbranch_scc1 .Lpad11
s_cmp_eq_u32 s3, 3
s_cbranch_scc1 .Lpad12
s_branch .Lpad13
.Lnopoll58r:
s_mov_b64 exec, -1
s_barrier
s_cmp_eq_u32 s48, 1
s_cbranch_scc1 .Lqkv60
s_add_u32 m0, s55, 36864
s_nop 0
buffer_load_dwordx4 v21, s[16:19], s52 offen sc1 lds
buffer_load_dwordx4 v21, s[16:19], s52 offen offset:1024 sc1 lds
buffer_load_dword v22, s[16:19], s52 offen offset:2048 sc1 lds
s_add_u32 s52, s52, 0x20000
s_add_u32 m0, s55, 46080
s_nop 0
buffer_load_dwordx4 v21, s[16:19], s52 offen sc1 lds
buffer_load_dwordx4 v21, s[16:19], s52 offen offset:1024 sc1 lds
buffer_load_dword v22, s[16:19], s52 offen offset:2048 sc1 lds
s_add_u32 s52, s52, 0x20000
s_add_u32 m0, s55, 0
s_nop 0
buffer_load_dwordx4 v21, s[16:19], s52 offen sc1 lds
buffer_load_dwordx4 v21, s[16:19], s52 offen offset:1024 sc1 lds
buffer_load_dword v22, s[16:19], s52 offen offset:2048 sc1 lds
s_add_u32 s52, s52, 0x20000
s_add_u32 m0, s55, 9216
s_nop 0
buffer_load_dwordx4 v21, s[16:19], s52 offen sc1 lds
buffer_load_dwordx4 v21, s[16:19], s52 offen offset:1024 sc1 lds
buffer_load_dword v22, s[16:19], s52 offen offset:2048 sc1 lds
s_add_u32 s52, s52, 0x20000
s_add_u32 m0, s55, 18432
s_nop 0
buffer_load_dwordx4 v21, s[16:19], s52 offen sc1 lds
buffer_load_dwordx4 v21, s[16:19], s52 offen offset:1024 sc1 lds
buffer_load_dword v22, s[16:19], s52 offen offset:2048 sc1 lds
s_add_u32 s52, s52, 0x20000
s_waitcnt vmcnt(12)
s_barrier
ds_read_b128 a[0:3], v23 offset:36864
ds_read_b128 a[4:7], v23 offset:37888
ds_read_b128 a[8:11], v23 offset:39168
ds_read_b128 a[12:15], v23 offset:40192
ds_read_b128 a[16:19], v24 offset:38912
s_waitcnt lgkmcnt(0)
s_mov_b32 s15, -4
.p2align 6
.Lk62:
s_waitcnt vmcnt(9) lgkmcnt(8)
s_barrier
v_mfma_f32_16x16x32_bf16 v[60:63], a[20:23], a[0:3], v[60:63]
ds_read_b128 a[44:47], v23 offset:46080
s_add_u32 m0, s56, 104832
v_mfma_f32_16x16x32_bf16 v[76:79], a[24:27], a[0:3], v[76:79]
buffer_load_dwordx4 v18, s[20:23], s54 offen lds
v_mfma_f32_16x16x32_bf16 v[80:83], a[24:27], a[4:7], v[80:83]
ds_read_b128 a[48:51], v23 offset:47104
v_add_f32 v164, v164, v168
v_mfma_f32_16x16x32_bf16 v[64:67], a[20:23], a[4:7], v[64:67]
ds_read_b128 a[52:55], v23 offset:48384
v_mfma_f32_16x16x32_bf16 v[68:71], a[20:23], a[8:11], v[68:71]
buffer_load_dwordx4 v19, s[20:23], s54 offen offset:1024 lds
v_mfma_f32_16x16x32_bf16 v[84:87], a[24:27], a[8:11], v[84:87]
ds_read_b128 a[56:59], v23 offset:49408
v_mfma_f32_16x16x32_bf16 v[88:91], a[24:27], a[12:15], v[88:91]
ds_read_b64_tr_b16 a[64:65], v25 offset:62080
v_add_f32 v165, v165, v169
v_mfma_f32_16x16x32_bf16 v[72:75], a[20:23], a[12:15], v[72:75]
ds_read_b64_tr_b16 a[66:67], v25 offset:62592
s_waitcnt lgkmcnt(6)
v_mfma_f32_16x16x32_bf16 v[104:107], a[28:31], a[12:15], v[104:107]
buffer_load_dwordx4 v20, s[20:23], s54 offen offset:2048 lds
v_mfma_f32_16x16x32_bf16 v[120:123], a[32:35], a[12:15], v[120:123]
ds_read_b64_tr_b16 a[68:69], v25 offset:62112
s_add_u32 s54, s54, 196608
v_mfma_f32_16x16x32_bf16 v[116:119], a[32:35], a[8:11], v[116:119]
ds_read_b64_tr_b16 a[70:71], v25 offset:62624
s_add_u32 m0, s55, 27648
v_mfma_f32_16x16x32_bf16 v[100:103], a[28:31], a[8:11], v[100:103]
buffer_load_dwordx4 v21, s[16:19], s52 offen sc1 lds
v_mfma_f32_16x16x32_bf16 v[96:99], a[28:31], a[4:7], v[96:99]
ds_read_b128 a[60:63], v24 offset:48128
v_mfma_f32_16x16x32_bf16 v[112:115], a[32:35], a[4:7], v[112:115]
ds_read_b64_tr_b16 a[72:73], v25 offset:63104
v_mfma_f32_16x16x32_bf16 v[108:111], a[32:35], a[0:3], v[108:111]
buffer_load_dwordx4 v21, s[16:19], s52 offen offset:1024 sc1 lds
v_mfma_f32_16x16x32_bf16 v[92:95], a[28:31], a[0:3], v[92:95]
ds_read_b64_tr_b16 a[74:75], v25 offset:63616
v_add_f32 v166, v166, v170
v_mfma_f32_16x16x32_bf16 v[156:159], a[28:31], a[16:19], v[156:159]
ds_read_b64_tr_b16 a[76:77], v25 offset:63136
v_mfma_f32_16x16x32_bf16 v[160:163], a[32:35], a[16:19], v[160:163]
ds_read_b64_tr_b16 a[78:79], v25 offset:63648
v_mfma_f32_16x16x32_bf16 v[124:127], a[0:3], a[36:39], v[124:127]
buffer_load_dword v22, s[16:19], s52 offen offset:2048 sc1 lds
v_mfma_f32_16x16x32_bf16 v[140:143], a[0:3], a[40:43], v[140:143]
ds_read_b64_tr_b16 a[80:81], v25 offset:64128
s_add_u32 s52, s52, 0x20000
v_mfma_f32_16x16x32_bf16 v[144:147], a[4:7], a[40:43], v[144:147]
ds_read_b64_tr_b16 a[82:83], v25 offset:64640
v_add_f32 v167, v167, v171
v_mfma_f32_16x16x32_bf16 v[128:131], a[4:7], a[36:39], v[128:131]
buffer_load_dword v27, v14, s[20:23], s44 offen
v_mfma_f32_16x16x32_bf16 v[132:135], a[8:11], a[36:39], v[132:135]
ds_read_b64_tr_b16 a[84:85], v25 offset:64160
s_add_u32 s44, s44, 1572864
v_mfma_f32_16x16x32_bf16 v[148:151], a[8:11], a[40:43], v[148:151]
ds_read_b64_tr_b16 a[86:87], v25 offset:64672
v_mfma_f32_16x16x32_bf16 v[152:155], a[12:15], a[40:43], v[152:155]
v_mfma_f32_16x16x32_bf16 v[136:139], a[12:15], a[36:39], v[136:139]
s_waitcnt vmcnt(13) lgkmcnt(8)
s_barrier
v_mfma_f32_16x16x32_bf16 v[60:63], a[64:67], a[44:47], v[60:63]
ds_read_b128 a[0:3], v23
s_add_u32 m0, s56, 117248
v_mfma_f32_16x16x32_bf16 v[76:79], a[68:71], a[44:47], v[76:79]
buffer_load_dwordx4 v18, s[20:23], s54 offen lds
v_mfma_f32_16x16x32_bf16 v[80:83], a[68:71], a[48:51], v[80:83]
ds_read_b128 a[4:7], v23 offset:1024
v_mfma_f32_16x16x32_bf16 v[64:67], a[64:67], a[48:51], v[64:67]
ds_read_b128 a[8:11], v23 offset:2304
v_mfma_f32_16x16x32_bf16 v[68:71], a[64:67], a[52:55], v[68:71]
buffer_load_dwordx4 v19, s[20:23], s54 offen offset:1024 lds
v_mfma_f32_16x16x32_bf16 v[84:87], a[68:71], a[52:55], v[84:87]
ds_read_b128 a[12:15], v23 offset:3328
v_mfma_f32_16x16x32_bf16 v[88:91], a[68:71], a[56:59], v[88:91]
ds_read_b64_tr_b16 a[20:21], v25
v_mfma_f32_16x16x32_bf16 v[72:75], a[64:67], a[56:59], v[72:75]
ds_read_b64_tr_b16 a[22:23], v25 offset:512
s_waitcnt lgkmcnt(6)
v_mfma_f32_16x16x32_bf16 v[104:107], a[72:75], a[56:59], v[104:107]
buffer_load_dwordx4 v20, s[20:23], s54 offen offset:2048 lds
v_mfma_f32_16x16x32_bf16 v[120:123], a[76:79], a[56:59], v[120:123]
ds_read_b64_tr_b16 a[24:25], v25 offset:32
s_add_u32 s54, s54, 196608
v_mfma_f32_16x16x32_bf16 v[116:119], a[76:79], a[52:55], v[116:119]
ds_read_b64_tr_b16 a[26:27], v25 offset:544
s_add_u32 m0, s55, 36864
v_mfma_f32_16x16x32_bf16 v[100:103], a[72:75], a[52:55], v[100:103]
buffer_load_dwordx4 v21, s[16:19], s52 offen sc1 lds
v_mfma_f32_16x16x32_bf16 v[96:99], a[72:75], a[48:51], v[96:99]
ds_read_b128 a[16:19], v24 offset:2048
v_mfma_f32_16x16x32_bf16 v[112:115], a[76:79], a[48:51], v[112:115]
ds_read_b64_tr_b16 a[28:29], v25 offset:1024
v_mfma_f32_16x16x32_bf16 v[108:111], a[76:79], a[44:47], v[108:111]
buffer_load_dwordx4 v21, s[16:19], s52 offen offset:1024 sc1 lds
v_mfma_f32_16x16x32_bf16 v[92:95], a[72:75], a[44:47], v[92:95]
ds_read_b64_tr_b16 a[30:31], v25 offset:1536
v_mfma_f32_16x16x32_bf16 v[156:159], a[72:75], a[60:63], v[156:159]
ds_read_b64_tr_b16 a[32:33], v25 offset:1056
v_mfma_f32_16x16x32_bf16 v[160:163], a[76:79], a[60:63], v[160:163]
ds_read_b64_tr_b16 a[34:35], v25 offset:1568
v_mfma_f32_16x16x32_bf16 v[124:127], a[44:47], a[80:83], v[124:127]
buffer_load_dword v22, s[16:19], s52 offen offset:2048 sc1 lds
v_mfma_f32_16x16x32_bf16 v[140:143], a[44:47], a[84:87], v[140:143]
ds_read_b64_tr_b16 a[36:37], v25 offset:2048
s_add_u32 s52, s52, 0x20000
v_mfma_f32_16x16x32_bf16 v[144:147], a[48:51], a[84:87], v[144:147]
ds_read_b64_tr_b16 a[38:39], v25 offset:2560
v_mfma_f32_16x16x32_bf16 v[128:131], a[48:51], a[80:83], v[128:131]
buffer_load_dwordx4 v[168:171], v26, s[16:19], s75 offen sc1
v_mfma_f32_16x16x32_bf16 v[132:135], a[52:55], a[80:83], v[132:135]
ds_read_b64_tr_b16 a[40:41], v25 offset:2080
v_mfma_f32_16x16x32_bf16 v[148:151], a[52:55], a[84:87], v[148:151]
ds_read_b64_tr_b16 a[42:43], v25 offset:2592
v_mfma_f32_16x16x32_bf16 v[152:155], a[56:59], a[84:87], v[152:155]
v_mfma_f32_16x16x32_bf16 v[136:139], a[56:59], a[80:83], v[136:139]
s_waitcnt vmcnt(17) lgkmcnt(8)
s_barrier
v_mfma_f32_16x16x32_bf16 v[60:63], a[20:23], a[0:3], v[60:63]
ds_read_b128 a[44:47], v23 offset:9216
s_add_u32 m0, s56, 129664
v_mfma_f32_16x16x32_bf16 v[76:79], a[24:27], a[0:3], v[76:79]
buffer_load_dwordx4 v18, s[20:23], s54 offen lds
v_mfma_f32_16x16x32_bf16 v[80:83], a[24:27], a[4:7], v[80:83]
ds_read_b128 a[48:51], v23 offset:10240
v_mfma_f32_16x16x32_bf16 v[64:67], a[20:23], a[4:7], v[64:67]
ds_read_b128 a[52:55], v23 offset:11520
v_mfma_f32_16x16x32_bf16 v[68:71], a[20:23], a[8:11], v[68:71]
ds_read_b128 a[56:59], v23 offset:12544
v_mfma_f32_16x16x32_bf16 v[84:87], a[24:27], a[8:11], v[84:87]
buffer_load_dwordx4 v19, s[20:23], s54 offen offset:1024 lds
v_mfma_f32_16x16x32_bf16 v[88:91], a[24:27], a[12:15], v[88:91]
ds_read_b64_tr_b16 a[64:65], v25 offset:12416
v_mfma_f32_16x16x32_bf16 v[72:75], a[20:23], a[12:15], v[72:75]
ds_read_b64_tr_b16 a[66:67], v25 offset:12928
s_waitcnt lgkmcnt(6)
v_mfma_f32_16x16x32_bf16 v[104:107], a[28:31], a[12:15], v[104:107]
ds_read_b64_tr_b16 a[68:69], v25 offset:12448
v_mfma_f32_16x16x32_bf16 v[120:123], a[32:35], a[12:15], v[120:123]
buffer_load_dwordx4 v20, s[20:23], s54 offen offset:2048 lds
v_mfma_f32_16x16x32_bf16 v[116:119], a[32:35], a[8:11], v[116:119]
ds_read_b64_tr_b16 a[70:71], v25 offset:12960
s_add_u32 s54, s54, 196608
v_mfma_f32_16x16x32_bf16 v[100:103], a[28:31], a[8:11], v[100:103]
ds_read_b128 a[60:63], v24 offset:11264
v_mfma_f32_16x16x32_bf16 v[96:99], a[28:31], a[4:7], v[96:99]
s_add_u32 m0, s55, 46080
v_mfma_f32_16x16x32_bf16 v[112:115], a[32:35], a[4:7], v[112:115]
buffer_load_dwordx4 v21, s[16:19], s52 offen sc1 lds
v_mfma_f32_16x16x32_bf16 v[108:111], a[32:35], a[0:3], v[108:111]
ds_read_b64_tr_b16 a[72:73], v25 offset:13440
v_mfma_f32_16x16x32_bf16 v[92:95], a[28:31], a[0:3], v[92:95]
ds_read_b64_tr_b16 a[74:75], v25 offset:13952
v_mfma_f32_16x16x32_bf16 v[156:159], a[28:31], a[16:19], v[156:159]
ds_read_b64_tr_b16 a[76:77], v25 offset:13472
v_mfma_f32_16x16x32_bf16 v[160:163], a[32:35], a[16:19], v[160:163]
buffer_load_dwordx4 v21, s[16:19], s52 offen offset:1024 sc1 lds
v_mfma_f32_16x16x32_bf16 v[124:127], a[0:3], a[36:39], v[124:127]
ds_read_b64_tr_b16 a[78:79], v25 offset:13984
v_mfma_f32_16x16x32_bf16 v[140:143], a[0:3], a[40:43], v[140:143]
ds_read_b64_tr_b16 a[80:81], v25 offset:14464
v_mfma_f32_16x16x32_bf16 v[144:147], a[4:7], a[40:43], v[144:147]
ds_read_b64_tr_b16 a[82:83], v25 offset:14976
v_mfma_f32_16x16x32_bf16 v[128:131], a[4:7], a[36:39], v[128:131]
buffer_load_dword v22, s[16:19], s52 offen offset:2048 sc1 lds
v_mfma_f32_16x16x32_bf16 v[132:135], a[8:11], a[36:39], v[132:135]
ds_read_b64_tr_b16 a[84:85], v25 offset:14496
s_add_u32 s52, s52, 0x20000
v_mfma_f32_16x16x32_bf16 v[148:151], a[8:11], a[40:43], v[148:151]
ds_read_b64_tr_b16 a[86:87], v25 offset:15008
v_mfma_f32_16x16x32_bf16 v[152:155], a[12:15], a[40:43], v[152:155]
v_mfma_f32_16x16x32_bf16 v[136:139], a[12:15], a[36:39], v[136:139]
s_waitcnt vmcnt(20) lgkmcnt(8)
s_barrier
v_mfma_f32_16x16x32_bf16 v[60:63], a[64:67], a[44:47], v[60:63]
ds_read_b128 a[0:3], v23 offset:18432
s_add_u32 m0, s56, 67584
v_mfma_f32_16x16x32_bf16 v[76:79], a[68:71], a[44:47], v[76:79]
buffer_load_dwordx4 v18, s[20:23], s54 offen lds
v_mfma_f32_16x16x32_bf16 v[80:83], a[68:71], a[48:51], v[80:83]
ds_read_b128 a[4:7], v23 offset:19456
v_add_f32 v164, v164, v172
v_mfma_f32_16x16x32_bf16 v[64:67], a[64:67], a[48:51], v[64:67]
ds_read_b128 a[8:11], v23 offset:20736
v_mfma_f32_16x16x32_bf16 v[68:71], a[64:67], a[52:55], v[68:71]
ds_read_b128 a[12:15], v23 offset:21760
v_mfma_f32_16x16x32_bf16 v[84:87], a[68:71], a[52:55], v[84:87]
buffer_load_dwordx4 v19, s[20:23], s54 offen offset:1024 lds
v_mfma_f32_16x16x32_bf16 v[88:91], a[68:71], a[56:59], v[88:91]
ds_read_b64_tr_b16 a[20:21], v25 offset:24832
v_mfma_f32_16x16x32_bf16 v[72:75], a[64:67], a[56:59], v[72:75]
ds_read_b64_tr_b16 a[22:23], v25 offset:25344
s_waitcnt lgkmcnt(6)
v_mfma_f32_16x16x32_bf16 v[104:107], a[72:75], a[56:59], v[104:107]
ds_read_b64_tr_b16 a[24:25], v25 offset:24864
v_add_f32 v165, v165, v173
v_mfma_f32_16x16x32_bf16 v[120:123], a[76:79], a[56:59], v[120:123]
buffer_load_dwordx4 v20, s[20:23], s54 offen offset:2048 lds
v_mfma_f32_16x16x32_bf16 v[116:119], a[76:79], a[52:55], v[116:119]
ds_read_b64_tr_b16 a[26:27], v25 offset:25376
s_add_u32 s54, s54, 196608
v_mfma_f32_16x16x32_bf16 v[100:103], a[72:75], a[52:55], v[100:103]
ds_read_b128 a[16:19], v24 offset:20480
v_mfma_f32_16x16x32_bf16 v[96:99], a[72:75], a[48:51], v[96:99]
s_add_u32 m0, s55, 0
v_mfma_f32_16x16x32_bf16 v[112:115], a[76:79], a[48:51], v[112:115]
buffer_load_dwordx4 v21, s[16:19], s52 offen sc1 lds
v_mfma_f32_16x16x32_bf16 v[108:111], a[76:79], a[44:47], v[108:111]
ds_read_b64_tr_b16 a[28:29], v25 offset:25856
v_add_f32 v166, v166, v174
v_mfma_f32_16x16x32_bf16 v[92:95], a[72:75], a[44:47], v[92:95]
ds_read_b64_tr_b16 a[30:31], v25 offset:26368
v_mfma_f32_16x16x32_bf16 v[156:159], a[72:75], a[60:63], v[156:159]
ds_read_b64_tr_b16 a[32:33], v25 offset:25888
v_mfma_f32_16x16x32_bf16 v[160:163], a[76:79], a[60:63], v[160:163]
buffer_load_dwordx4 v21, s[16:19], s52 offen offset:1024 sc1 lds
v_mfma_f32_16x16x32_bf16 v[124:127], a[44:47], a[80:83], v[124:127]
ds_read_b64_tr_b16 a[34:35], v25 offset:26400
v_mfma_f32_16x16x32_bf16 v[140:143], a[44:47], a[84:87], v[140:143]
ds_read_b64_tr_b16 a[36:37], v25 offset:26880
v_add_f32 v167, v167, v175
v_mfma_f32_16x16x32_bf16 v[144:147], a[48:51], a[84:87], v[144:147]
ds_read_b64_tr_b16 a[38:39], v25 offset:27392
v_mfma_f32_16x16x32_bf16 v[128:131], a[48:51], a[80:83], v[128:131]
buffer_load_dword v22, s[16:19], s52 offen offset:2048 sc1 lds
v_mfma_f32_16x16x32_bf16 v[132:135], a[52:55], a[80:83], v[132:135]
ds_read_b64_tr_b16 a[40:41], v25 offset:26912
s_add_u32 s52, s52, 0x20000
v_mfma_f32_16x16x32_bf16 v[148:151], a[52:55], a[84:87], v[148:151]
ds_read_b64_tr_b16 a[42:43], v25 offset:27424
v_mfma_f32_16x16x32_bf16 v[152:155], a[56:59], a[84:87], v[152:155]
v_mfma_f32_16x16x32_bf16 v[136:139], a[56:59], a[80:83], v[136:139]
s_waitcnt vmcnt(20) lgkmcnt(8)
s_barrier
v_mfma_f32_16x16x32_bf16 v[60:63], a[20:23], a[0:3], v[60:63]
ds_read_b128 a[44:47], v23 offset:27648
s_add_u32 m0, s56, 80000
v_mfma_f32_16x16x32_bf16 v[76:79], a[24:27], a[0:3], v[76:79]
buffer_load_dwordx4 v18, s[20:23], s54 offen lds
v_mfma_f32_16x16x32_bf16 v[80:83], a[24:27], a[4:7], v[80:83]
ds_read_b128 a[48:51], v23 offset:28672
v_mfma_f32_16x16x32_bf16 v[64:67], a[20:23], a[4:7], v[64:67]
ds_read_b128 a[52:55], v23 offset:29952
v_mfma_f32_16x16x32_bf16 v[68:71], a[20:23], a[8:11], v[68:71]
buffer_load_dwordx4 v19, s[20:23], s54 offen offset:1024 lds
v_mfma_f32_16x16x32_bf16 v[84:87], a[24:27], a[8:11], v[84:87]
ds_read_b128 a[56:59], v23 offset:30976
v_mfma_f32_16x16x32_bf16 v[88:91], a[24:27], a[12:15], v[88:91]
ds_read_b64_tr_b16 a[64:65], v25 offset:37248
v_mfma_f32_16x16x32_bf16 v[72:75], a[20:23], a[12:15], v[72:75]
ds_read_b64_tr_b16 a[66:67], v25 offset:37760
s_waitcnt lgkmcnt(6)
v_mfma_f32_16x16x32_bf16 v[104:107], a[28:31], a[12:15], v[104:107]
buffer_load_dwordx4 v20, s[20:23], s54 offen offset:2048 lds
v_mfma_f32_16x16x32_bf16 v[120:123], a[32:35], a[12:15], v[120:123]
ds_read_b64_tr_b16 a[68:69], v25 offset:37280
s_add_u32 s54, s54, 196608
v_mfma_f32_16x16x32_bf16 v[116:119], a[32:35], a[8:11], v[116:119]
ds_read_b64_tr_b16 a[70:71], v25 offset:37792
s_add_u32 m0, s55, 9216
v_mfma_f32_16x16x32_bf16 v[100:103], a[28:31], a[8:11], v[100:103]
buffer_load_dwordx4 v21, s[16:19], s52 offen sc1 lds
v_mfma_f32_16x16x32_bf16 v[96:99], a[28:31], a[4:7], v[96:99]
ds_read_b128 a[60:63], v24 offset:29696
v_mfma_f32_16x16x32_bf16 v[112:115], a[32:35], a[4:7], v[112:115]
ds_read_b64_tr_b16 a[72:73], v25 offset:38272
v_mfma_f32_16x16x32_bf16 v[108:111], a[32:35], a[0:3], v[108:111]
buffer_load_dwordx4 v21, s[16:19], s52 offen offset:1024 sc1 lds
v_mfma_f32_16x16x32_bf16 v[92:95], a[28:31], a[0:3], v[92:95]
ds_read_b64_tr_b16 a[74:75], v25 offset:38784
v_mfma_f32_16x16x32_bf16 v[156:159], a[28:31], a[16:19], v[156:159]
ds_read_b64_tr_b16 a[76:77], v25 offset:38304
v_mfma_f32_16x16x32_bf16 v[160:163], a[32:35], a[16:19], v[160:163]
ds_read_b64_tr_b16 a[78:79], v25 offset:38816
v_mfma_f32_16x16x32_bf16 v[124:127], a[0:3], a[36:39], v[124:127]
buffer_load_dword v22, s[16:19], s52 offen offset:2048 sc1 lds
v_mfma_f32_16x16x32_bf16 v[140:143], a[0:3], a[40:43], v[140:143]
ds_read_b64_tr_b16 a[80:81], v25 offset:39296
s_add_u32 s52, s52, 0x20000
v_mfma_f32_16x16x32_bf16 v[144:147], a[4:7], a[40:43], v[144:147]
ds_read_b64_tr_b16 a[82:83], v25 offset:39808
v_mfma_f32_16x16x32_bf16 v[128:131], a[4:7], a[36:39], v[128:131]
buffer_load_dwordx4 v[172:175], v26, s[16:19], s75 offen offset:1024 sc1
v_mfma_f32_16x16x32_bf16 v[132:135], a[8:11], a[36:39], v[132:135]
ds_read_b64_tr_b16 a[84:85], v25 offset:39328
s_add_u32 s75, s75, 2048
v_mfma_f32_16x16x32_bf16 v[148:151], a[8:11], a[40:43], v[148:151]
ds_read_b64_tr_b16 a[86:87], v25 offset:39840
v_mfma_f32_16x16x32_bf16 v[152:155], a[12:15], a[40:43], v[152:155]
v_mfma_f32_16x16x32_bf16 v[136:139], a[12:15], a[36:39], v[136:139]
s_waitcnt vmcnt(20) lgkmcnt(8)
s_barrier
v_mfma_f32_16x16x32_bf16 v[60:63], a[64:67], a[44:47], v[60:63]
ds_read_b128 a[0:3], v23 offset:36864
s_add_u32 m0, s56, 92416
v_mfma_f32_16x16x32_bf16 v[76:79], a[68:71], a[44:47], v[76:79]
buffer_load_dwordx4 v18, s[20:23], s54 offen lds
v_mfma_f32_16x16x32_bf16 v[80:83], a[68:71], a[48:51], v[80:83]
ds_read_b128 a[4:7], v23 offset:37888
v_mfma_f32_16x16x32_bf16 v[64:67], a[64:67], a[48:51], v[64:67]
ds_read_b128 a[8:11], v23 offset:39168
v_mfma_f32_16x16x32_bf16 v[68:71], a[64:67], a[52:55], v[68:71]
ds_read_b128 a[12:15], v23 offset:40192
v_mfma_f32_16x16x32_bf16 v[84:87], a[68:71], a[52:55], v[84:87]
buffer_load_dwordx4 v19, s[20:23], s54 offen offset:1024 lds
v_mfma_f32_16x16x32_bf16 v[88:91], a[68:71], a[56:59], v[88:91]
ds_read_b64_tr_b16 a[20:21], v25 offset:49664
v_mfma_f32_16x16x32_bf16 v[72:75], a[64:67], a[56:59], v[72:75]
ds_read_b64_tr_b16 a[22:23], v25 offset:50176
s_waitcnt lgkmcnt(6)
v_mfma_f32_16x16x32_bf16 v[104:107], a[72:75], a[56:59], v[104:107]
ds_read_b64_tr_b16 a[24:25], v25 offset:49696
v_mfma_f32_16x16x32_bf16 v[120:123], a[76:79], a[56:59], v[120:123]
buffer_load_dwordx4 v20, s[20:23], s54 offen offset:2048 lds
v_mfma_f32_16x16x32_bf16 v[116:119], a[76:79], a[52:55], v[116:119]
ds_read_b64_tr_b16 a[26:27], v25 offset:50208
s_add_u32 s54, s54, 196608
v_mfma_f32_16x16x32_bf16 v[100:103], a[72:75], a[52:55], v[100:103]
ds_read_b128 a[16:19], v24 offset:38912
v_mfma_f32_16x16x32_bf16 v[96:99], a[72:75], a[48:51], v[96:99]
s_add_u32 m0, s55, 18432
v_mfma_f32_16x16x32_bf16 v[112:115], a[76:79], a[48:51], v[112:115]
buffer_load_dwordx4 v21, s[16:19], s52 offen sc1 lds
v_mfma_f32_16x16x32_bf16 v[108:111], a[76:79], a[44:47], v[108:111]
ds_read_b64_tr_b16 a[28:29], v25 offset:50688
v_mfma_f32_16x16x32_bf16 v[92:95], a[72:75], a[44:47], v[92:95]
ds_read_b64_tr_b16 a[30:31], v25 offset:51200
v_mfma_f32_16x16x32_bf16 v[156:159], a[72:75], a[60:63], v[156:159]
ds_read_b64_tr_b16 a[32:33], v25 offset:50720
v_mfma_f32_16x16x32_bf16 v[160:163], a[76:79], a[60:63], v[160:163]
buffer_load_dwordx4 v21, s[16:19], s52 offen offset:1024 sc1 lds
v_mfma_f32_16x16x32_bf16 v[124:127], a[44:47], a[80:83], v[124:127]
ds_read_b64_tr_b16 a[34:35], v25 offset:51232
v_mfma_f32_16x16x32_bf16 v[140:143], a[44:47], a[84:87], v[140:143]
ds_read_b64_tr_b16 a[36:37], v25 offset:51712
v_mfma_f32_16x16x32_bf16 v[144:147], a[48:51], a[84:87], v[144:147]
ds_read_b64_tr_b16 a[38:39], v25 offset:52224
v_mfma_f32_16x16x32_bf16 v[128:131], a[48:51], a[80:83], v[128:131]
buffer_load_dword v22, s[16:19], s52 offen offset:2048 sc1 lds
v_mfma_f32_16x16x32_bf16 v[132:135], a[52:55], a[80:83], v[132:135]
ds_read_b64_tr_b16 a[40:41], v25 offset:51744
s_add_u32 s52, s52, 0x20000
v_mfma_f32_16x16x32_bf16 v[148:151], a[52:55], a[84:87], v[148:151]
ds_read_b64_tr_b16 a[42:43], v25 offset:52256
v_mfma_f32_16x16x32_bf16 v[152:155], a[56:59], a[84:87], v[152:155]
s_add_u32 s15, s15, 1
v_mfma_f32_16x16x32_bf16 v[136:139], a[56:59], a[80:83], v[136:139]
s_cbranch_scc0 .Lk62
s_waitcnt vmcnt(19) lgkmcnt(8)
s_barrier
v_mfma_f32_16x16x32_bf16 v[60:63], a[20:23], a[0:3], v[60:63]
ds_read_b128 a[44:47], v23 offset:46080
s_add_u32 m0, s56, 104832
v_mfma_f32_16x16x32_bf16 v[76:79], a[24:27], a[0:3], v[76:79]
buffer_load_dwordx4 v18, s[20:23], s54 offen lds
v_mfma_f32_16x16x32_bf16 v[80:83], a[24:27], a[4:7], v[80:83]
ds_read_b128 a[48:51], v23 offset:47104
v_add_f32 v164, v164, v168
v_mfma_f32_16x16x32_bf16 v[64:67], a[20:23], a[4:7], v[64:67]
ds_read_b128 a[52:55], v23 offset:48384
v_mfma_f32_16x16x32_bf16 v[68:71], a[20:23], a[8:11], v[68:71]
ds_read_b128 a[56:59], v23 offset:49408
v_mfma_f32_16x16x32_bf16 v[84:87], a[24:27], a[8:11], v[84:87]
buffer_load_dwordx4 v19, s[20:23], s54 offen offset:1024 lds
v_mfma_f32_16x16x32_bf16 v[88:91], a[24:27], a[12:15], v[88:91]
ds_read_b64_tr_b16 a[64:65], v25 offset:62080
v_mfma_f32_16x16x32_bf16 v[72:75], a[20:23], a[12:15], v[72:75]
ds_read_b64_tr_b16 a[66:67], v25 offset:62592
s_waitcnt lgkmcnt(6)
v_mfma_f32_16x16x32_bf16 v[104:107], a[28:31], a[12:15], v[104:107]
ds_read_b64_tr_b16 a[68:69], v25 offset:62112
v_add_f32 v165, v165, v169
v_mfma_f32_16x16x32_bf16 v[120:123], a[32:35], a[12:15], v[120:123]
buffer_load_dwordx4 v20, s[20:23], s54 offen offset:2048 lds
v_mfma_f32_16x16x32_bf16 v[116:119], a[32:35], a[8:11], v[116:119]
ds_read_b64_tr_b16 a[70:71], v25 offset:62624
s_add_u32 s54, s54, 196608
v_mfma_f32_16x16x32_bf16 v[100:103], a[28:31], a[8:11], v[100:103]
ds_read_b128 a[60:63], v24 offset:48128
v_mfma_f32_16x16x32_bf16 v[96:99], a[28:31], a[4:7], v[96:99]
s_add_u32 m0, s55, 27648
v_mfma_f32_16x16x32_bf16 v[112:115], a[32:35], a[4:7], v[112:115]
buffer_load_dwordx4 v21, s[16:19], s52 offen sc1 lds
v_mfma_f32_16x16x32_bf16 v[108:111], a[32:35], a[0:3], v[108:111]
ds_read_b64_tr_b16 a[72:73], v25 offset:63104
v_add_f32 v166, v166, v170
v_mfma_f32_16x16x32_bf16 v[92:95], a[28:31], a[0:3], v[92:95]
ds_read_b64_tr_b16 a[74:75], v25 offset:63616
v_mfma_f32_16x16x32_bf16 v[156:159], a[28:31], a[16:19], v[156:159]
ds_read_b64_tr_b16 a[76:77], v25 offset:63136
v_mfma_f32_16x16x32_bf16 v[160:163], a[32:35], a[16:19], v[160:163]
buffer_load_dwordx4 v21, s[16:19], s52 offen offset:1024 sc1 lds
v_mfma_f32_16x16x32_bf16 v[124:127], a[0:3], a[36:39], v[124:127]
ds_read_b64_tr_b16 a[78:79], v25 offset:63648
v_mfma_f32_16x16x32_bf16 v[140:143], a[0:3], a[40:43], v[140:143]
ds_read_b64_tr_b16 a[80:81], v25 offset:64128
v_add_f32 v167, v167, v171
v_mfma_f32_16x16x32_bf16 v[144:147], a[4:7], a[40:43], v[144:147]
ds_read_b64_tr_b16 a[82:83], v25 offset:64640
v_mfma_f32_16x16x32_bf16 v[128:131], a[4:7], a[36:39], v[128:131]
buffer_load_dword v22, s[16:19], s52 offen offset:2048 sc1 lds
v_mfma_f32_16x16x32_bf16 v[132:135], a[8:11], a[36:39], v[132:135]
ds_read_b64_tr_b16 a[84:85], v25 offset:64160
s_add_u32 s52, s52, 0x20000
v_mfma_f32_16x16x32_bf16 v[148:151], a[8:11], a[40:43], v[148:151]
ds_read_b64_tr_b16 a[86:87], v25 offset:64672
v_mfma_f32_16x16x32_bf16 v[152:155], a[12:15], a[40:43], v[152:155]
v_mfma_f32_16x16x32_bf16 v[136:139], a[12:15], a[36:39], v[136:139]
s_waitcnt vmcnt(19) lgkmcnt(8)
s_barrier
v_mfma_f32_16x16x32_bf16 v[60:63], a[64:67], a[44:47], v[60:63]
ds_read_b128 a[0:3], v23
s_add_u32 m0, s56, 117248
v_mfma_f32_16x16x32_bf16 v[76:79], a[68:71], a[44:47], v[76:79]
buffer_load_dwordx4 v18, s[20:23], s54 offen lds
v_mfma_f32_16x16x32_bf16 v[80:83], a[68:71], a[48:51], v[80:83]
ds_read_b128 a[4:7], v23 offset:1024
v_mfma_f32_16x16x32_bf16 v[64:67], a[64:67], a[48:51], v[64:67]
ds_read_b128 a[8:11], v23 offset:2304
v_mfma_f32_16x16x32_bf16 v[68:71], a[64:67], a[52:55], v[68:71]
ds_read_b128 a[12:15], v23 offset:3328
v_mfma_f32_16x16x32_bf16 v[84:87], a[68:71], a[52:55], v[84:87]
buffer_load_dwordx4 v19, s[20:23], s54 offen offset:1024 lds
v_mfma_f32_16x16x32_bf16 v[88:91], a[68:71], a[56:59], v[88:91]
ds_read_b64_tr_b16 a[20:21], v25
v_mfma_f32_16x16x32_bf16 v[72:75], a[64:67], a[56:59], v[72:75]
ds_read_b64_tr_b16 a[22:23], v25 offset:512
s_waitcnt lgkmcnt(6)
v_mfma_f32_16x16x32_bf16 v[104:107], a[72:75], a[56:59], v[104:107]
ds_read_b64_tr_b16 a[24:25], v25 offset:32
v_mfma_f32_16x16x32_bf16 v[120:123], a[76:79], a[56:59], v[120:123]
buffer_load_dwordx4 v20, s[20:23], s54 offen offset:2048 lds
v_mfma_f32_16x16x32_bf16 v[116:119], a[76:79], a[52:55], v[116:119]
ds_read_b64_tr_b16 a[26:27], v25 offset:544
s_add_u32 s54, s54, 196608
v_mfma_f32_16x16x32_bf16 v[100:103], a[72:75], a[52:55], v[100:103]
ds_read_b128 a[16:19], v24 offset:2048
v_mfma_f32_16x16x32_bf16 v[96:99], a[72:75], a[48:51], v[96:99]
s_add_u32 m0, s55, 36864
v_mfma_f32_16x16x32_bf16 v[112:115], a[76:79], a[48:51], v[112:115]
buffer_load_dwordx4 v21, s[16:19], s52 offen sc1 lds
v_mfma_f32_16x16x32_bf16 v[108:111], a[76:79], a[44:47], v[108:111]
ds_read_b64_tr_b16 a[28:29], v25 offset:1024
v_mfma_f32_16x16x32_bf16 v[92:95], a[72:75], a[44:47], v[92:95]
ds_read_b64_tr_b16 a[30:31], v25 offset:1536
v_mfma_f32_16x16x32_bf16 v[156:159], a[72:75], a[60:63], v[156:159]
ds_read_b64_tr_b16 a[32:33], v25 offset:1056
v_mfma_f32_16x16x32_bf16 v[160:163], a[76:79], a[60:63], v[160:163]
buffer_load_dwordx4 v21, s[16:19], s52 offen offset:1024 sc1 lds
v_mfma_f32_16x16x32_bf16 v[124:127], a[44:47], a[80:83], v[124:127]
ds_read_b64_tr_b16 a[34:35], v25 offset:1568
v_mfma_f32_16x16x32_bf16 v[140:143], a[44:47], a[84:87], v[140:143]
ds_read_b64_tr_b16 a[36:37], v25 offset:2048
v_mfma_f32_16x16x32_bf16 v[144:147], a[48:51], a[84:87], v[144:147]
ds_read_b64_tr_b16 a[38:39], v25 offset:2560
v_mfma_f32_16x16x32_bf16 v[128:131], a[48:51], a[80:83], v[128:131]
buffer_load_dword v22, s[16:19], s52 offen offset:2048 sc1 lds
v_mfma_f32_16x16x32_bf16 v[132:135], a[52:55], a[80:83], v[132:135]
ds_read_b64_tr_b16 a[40:41], v25 offset:2080
s_add_u32 s52, s52, 0x20000
v_mfma_f32_16x16x32_bf16 v[148:151], a[52:55], a[84:87], v[148:151]
ds_read_b64_tr_b16 a[42:43], v25 offset:2592
v_mfma_f32_16x16x32_bf16 v[152:155], a[56:59], a[84:87], v[152:155]
v_mfma_f32_16x16x32_bf16 v[136:139], a[56:59], a[80:83], v[136:139]
s_waitcnt vmcnt(19) lgkmcnt(8)
s_barrier
v_mfma_f32_16x16x32_bf16 v[60:63], a[20:23], a[0:3], v[60:63]
ds_read_b128 a[44:47], v23 offset:9216
s_add_u32 m0, s56, 129664
v_mfma_f32_16x16x32_bf16 v[76:79], a[24:27], a[0:3], v[76:79]
buffer_load_dwordx4 v18, s[20:23], s54 offen lds
v_mfma_f32_16x16x32_bf16 v[80:83], a[24:27], a[4:7], v[80:83]
ds_read_b128 a[48:51], v23 offset:10240
s_waitcnt vmcnt(19)
.Lpad11:
s_cbranch_execz .Lpad14
v_add_f32 v164, v164, v172
v_mfma_f32_16x16x32_bf16 v[64:67], a[20:23], a[4:7], v[64:67]
ds_read_b128 a[52:55], v23 offset:11520
v_mfma_f32_16x16x32_bf16 v[68:71], a[20:23], a[8:11], v[68:71]
ds_read_b128 a[56:59], v23 offset:12544
v_mfma_f32_16x16x32_bf16 v[84:87], a[24:27], a[8:11], v[84:87]
buffer_load_dwordx4 v19, s[20:23], s54 offen offset:1024 lds
v_mfma_f32_16x16x32_bf16 v[88:91], a[24:27], a[12:15], v[88:91]
ds_read_b64_tr_b16 a[64:65], v25 offset:12416
v_mfma_f32_16x16x32_bf16 v[72:75], a[20:23], a[12:15], v[72:75]
ds_read_b64_tr_b16 a[66:67], v25 offset:12928
s_waitcnt lgkmcnt(6)
v_mfma_f32_16x16x32_bf16 v[104:107], a[28:31], a[12:15], v[104:107]
ds_read_b64_tr_b16 a[68:69], v25 offset:12448
v_add_f32 v165, v165, v173
v_mfma_f32_16x16x32_bf16 v[120:123], a[32:35], a[12:15], v[120:123]
buffer_load_dwordx4 v20, s[20:23], s54 offen offset:2048 lds
v_mfma_f32_16x16x32_bf16 v[116:119], a[32:35], a[8:11], v[116:119]
ds_read_b64_tr_b16 a[70:71], v25 offset:12960
s_add_u32 s54, s54, 196608
v_mfma_f32_16x16x32_bf16 v[100:103], a[28:31], a[8:11], v[100:103]
ds_read_b128 a[60:63], v24 offset:11264
v_mfma_f32_16x16x32_bf16 v[96:99], a[28:31], a[4:7], v[96:99]
s_add_u32 m0, s55, 46080
v_mfma_f32_16x16x32_bf16 v[112:115], a[32:35], a[4:7], v[112:115]
buffer_load_dwordx4 v21, s[16:19], s52 offen sc1 lds
v_mfma_f32_16x16x32_bf16 v[108:111], a[32:35], a[0:3], v[108:111]
ds_read_b64_tr_b16 a[72:73], v25 offset:13440
v_add_f32 v166, v166, v174
v_mfma_f32_16x16x32_bf16 v[92:95], a[28:31], a[0:3], v[92:95]
ds_read_b64_tr_b16 a[74:75], v25 offset:13952
v_mfma_f32_16x16x32_bf16 v[156:159], a[28:31], a[16:19], v[156:159]
ds_read_b64_tr_b16 a[76:77], v25 offset:13472
v_mfma_f32_16x16x32_bf16 v[160:163], a[32:35], a[16:19], v[160:163]
buffer_load_dwordx4 v21, s[16:19], s52 offen offset:1024 sc1 lds
v_mfma_f32_16x16x32_bf16 v[124:127], a[0:3], a[36:39], v[124:127]
ds_read_b64_tr_b16 a[78:79], v25 offset:13984
v_mfma_f32_16x16x32_bf16 v[140:143], a[0:3], a[40:43], v[140:143]
ds_read_b64_tr_b16 a[80:81], v25 offset:14464
v_add_f32 v167, v167, v175
v_mfma_f32_16x16x32_bf16 v[144:147], a[4:7], a[40:43], v[144:147]
ds_read_b64_tr_b16 a[82:83], v25 offset:14976
v_mfma_f32_16x16x32_bf16 v[128:131], a[4:7], a[36:39], v[128:131]
buffer_load_dword v22, s[16:19], s52 offen offset:2048 sc1 lds
v_mfma_f32_16x16x32_bf16 v[132:135], a[8:11], a[36:39], v[132:135]
ds_read_b64_tr_b16 a[84:85], v25 offset:14496
s_add_u32 s52, s52, 0x20000
v_mfma_f32_16x16x32_bf16 v[148:151], a[8:11], a[40:43], v[148:151]
ds_read_b64_tr_b16 a[86:87], v25 offset:15008
v_mfma_f32_16x16x32_bf16 v[152:155], a[12:15], a[40:43], v[152:155]
v_mfma_f32_16x16x32_bf16 v[136:139], a[12:15], a[36:39], v[136:139]
s_waitcnt vmcnt(18) lgkmcnt(8)
s_barrier
v_mfma_f32_16x16x32_bf16 v[60:63], a[64:67], a[44:47], v[60:63]
ds_read_b128 a[0:3], v23 offset:18432
s_add_u32 m0, s59, 0
s_mov_b32 s58, 1048576
v_mfma_f32_16x16x32_bf16 v[76:79], a[68:71], a[44:47], v[76:79]
buffer_load_dwordx4 v5, s[24:27], s58 offen lds
v_mfma_f32_16x16x32_bf16 v[80:83], a[68:71], a[48:51], v[80:83]
ds_read_b128 a[4:7], v23 offset:19456
v_permlane32_swap_b32 v164, v166
v_mfma_f32_16x16x32_bf16 v[64:67], a[64:67], a[48:51], v[64:67]
ds_read_b128 a[8:11], v23 offset:20736
v_mfma_f32_16x16x32_bf16 v[68:71], a[64:67], a[52:55], v[68:71]
ds_read_b128 a[12:15], v23 offset:21760
v_permlane32_swap_b32 v165, v167
v_mfma_f32_16x16x32_bf16 v[84:87], a[68:71], a[52:55], v[84:87]
buffer_load_dwordx4 v6, s[24:27], s58 offen offset:1024 lds
v_mfma_f32_16x16x32_bf16 v[88:91], a[68:71], a[56:59], v[88:91]
ds_read_b64_tr_b16 a[20:21], v25 offset:24832
v_mfma_f32_16x16x32_bf16 v[72:75], a[64:67], a[56:59], v[72:75]
v_add_f32 v164, v164, v166
s_waitcnt lgkmcnt(5)
v_mfma_f32_16x16x32_bf16 v[104:107], a[72:75], a[56:59], v[104:107]
ds_read_b64_tr_b16 a[22:23], v25 offset:25344
s_add_u32 m0, s59, 58240
s_mov_b32 s58, 1966080
v_mfma_f32_16x16x32_bf16 v[120:123], a[76:79], a[56:59], v[120:123]
buffer_load_dwordx4 v5, s[24:27], s58 offen lds
v_mfma_f32_16x16x32_bf16 v[116:119], a[76:79], a[52:55], v[116:119]
ds_read_b64_tr_b16 a[24:25], v25 offset:24864
v_add_f32 v165, v165, v167
v_mfma_f32_16x16x32_bf16 v[100:103], a[72:75], a[52:55], v[100:103]
ds_read_b64_tr_b16 a[26:27], v25 offset:25376
v_mfma_f32_16x16x32_bf16 v[96:99], a[72:75], a[48:51], v[96:99]
ds_read_b128 a[16:19], v24 offset:20480
v_mfma_f32_16x16x32_bf16 v[112:115], a[76:79], a[48:51], v[112:115]
buffer_load_dwordx4 v6, s[24:27], s58 offen offset:1024 lds
v_mfma_f32_16x16x32_bf16 v[108:111], a[76:79], a[44:47], v[108:111]
ds_read_b64_tr_b16 a[28:29], v25 offset:25856
v_mul_f32 v164, 0xba800000, v164
v_mfma_f32_16x16x32_bf16 v[92:95], a[72:75], a[44:47], v[92:95]
ds_read_b64_tr_b16 a[30:31], v25 offset:26368
v_mfma_f32_16x16x32_bf16 v[156:159], a[72:75], a[60:63], v[156:159]
s_add_u32 m0, s59, 66560
s_mov_b32 s58, 0
v_mul_f32 v165, 0x3a800000, v165
v_mfma_f32_16x16x32_bf16 v[160:163], a[76:79], a[60:63], v[160:163]
buffer_load_dwordx4 v5, s[24:27], s58 offen lds
v_mfma_f32_16x16x32_bf16 v[124:127], a[44:47], a[80:83], v[124:127]
ds_read_b64_tr_b16 a[32:33], v25 offset:25888
v_mfma_f32_16x16x32_bf16 v[140:143], a[44:47], a[84:87], v[140:143]
ds_read_b64_tr_b16 a[34:35], v25 offset:26400
v_fma_f32 v165, -v164, v164, v165
v_mfma_f32_16x16x32_bf16 v[144:147], a[48:51], a[84:87], v[144:147]
ds_read_b64_tr_b16 a[36:37], v25 offset:26880
v_mfma_f32_16x16x32_bf16 v[128:131], a[48:51], a[80:83], v[128:131]
buffer_load_dwordx4 v6, s[24:27], s58 offen offset:1024 lds
v_mfma_f32_16x16x32_bf16 v[132:135], a[52:55], a[80:83], v[132:135]
ds_read_b64_tr_b16 a[38:39], v25 offset:27392
v_max_f32 v165, 0, v165
v_mfma_f32_16x16x32_bf16 v[148:151], a[52:55], a[84:87], v[148:151]
ds_read_b64_tr_b16 a[40:41], v25 offset:26912
v_mfma_f32_16x16x32_bf16 v[152:155], a[56:59], a[84:87], v[152:155]
ds_read_b64_tr_b16 a[42:43], v25 offset:27424
v_mfma_f32_16x16x32_bf16 v[136:139], a[56:59], a[80:83], v[136:139]
s_waitcnt vmcnt(18) lgkmcnt(8)
s_barrier
v_mfma_f32_16x16x32_bf16 v[60:63], a[20:23], a[0:3], v[60:63]
ds_read_b128 a[44:47], v23 offset:27648
s_add_u32 m0, s59, 8320
s_mov_b32 s58, 1179648
v_mfma_f32_16x16x32_bf16 v[76:79], a[24:27], a[0:3], v[76:79]
buffer_load_dwordx4 v5, s[24:27], s58 offen lds
v_mfma_f32_16x16x32_bf16 v[80:83], a[24:27], a[4:7], v[80:83]
ds_read_b128 a[48:51], v23 offset:28672
v_add_f32 v165, 0x3727c5ac, v165
v_mfma_f32_16x16x32_bf16 v[64:67], a[20:23], a[4:7], v[64:67]
ds_read_b128 a[52:55], v23 offset:29952
v_mfma_f32_16x16x32_bf16 v[68:71], a[20:23], a[8:11], v[68:71]
ds_read_b128 a[56:59], v23 offset:30976
v_mfma_f32_16x16x32_bf16 v[84:87], a[24:27], a[8:11], v[84:87]
buffer_load_dwordx4 v6, s[24:27], s58 offen offset:1024 lds
v_mfma_f32_16x16x32_bf16 v[88:91], a[24:27], a[12:15], v[88:91]
ds_read_b64_tr_b16 a[64:65], v25 offset:37248
v_mfma_f32_16x16x32_bf16 v[72:75], a[20:23], a[12:15], v[72:75]
v_rsq_f32 v166, v165
s_waitcnt lgkmcnt(5)
v_mfma_f32_16x16x32_bf16 v[104:107], a[28:31], a[12:15], v[104:107]
ds_read_b64_tr_b16 a[66:67], v25 offset:37760
s_add_u32 m0, s59, 74880
s_mov_b32 s58, 131072
v_mfma_f32_16x16x32_bf16 v[120:123], a[32:35], a[12:15], v[120:123]
buffer_load_dwordx4 v5, s[24:27], s58 offen lds
v_mfma_f32_16x16x32_bf16 v[116:119], a[32:35], a[8:11], v[116:119]
ds_read_b64_tr_b16 a[68:69], v25 offset:37280
v_mfma_f32_16x16x32_bf16 v[100:103], a[28:31], a[8:11], v[100:103]
ds_read_b64_tr_b16 a[70:71], v25 offset:37792
v_mfma_f32_16x16x32_bf16 v[96:99], a[28:31], a[4:7], v[96:99]
ds_read_b128 a[60:63], v24 offset:29696
v_mfma_f32_16x16x32_bf16 v[112:115], a[32:35], a[4:7], v[112:115]
buffer_load_dwordx4 v6, s[24:27], s58 offen offset:1024 lds
v_mfma_f32_16x16x32_bf16 v[108:111], a[32:35], a[0:3], v[108:111]
ds_read_b64_tr_b16 a[72:73], v25 offset:38272
v_mov_b32 v165, v166
v_mfma_f32_16x16x32_bf16 v[92:95], a[28:31], a[0:3], v[92:95]
ds_read_b64_tr_b16 a[74:75], v25 offset:38784
v_mfma_f32_16x16x32_bf16 v[156:159], a[28:31], a[16:19], v[156:159]
s_add_u32 m0, s59, 83200
s_mov_b32 s58, 262144
v_mfma_f32_16x16x32_bf16 v[160:163], a[32:35], a[16:19], v[160:163]
buffer_load_dwordx4 v5, s[24:27], s58 offen lds
v_mfma_f32_16x16x32_bf16 v[124:127], a[0:3], a[36:39], v[124:127]
ds_read_b64_tr_b16 a[76:77], v25 offset:38304
v_mfma_f32_16x16x32_bf16 v[140:143], a[0:3], a[40:43], v[140:143]
ds_read_b64_tr_b16 a[78:79], v25 offset:38816
v_mul_f32 v166, 0x3e8293ee, v166
v_mfma_f32_16x16x32_bf16 v[144:147], a[4:7], a[40:43], v[144:147]
ds_read_b64_tr_b16 a[80:81], v25 offset:39296
v_mfma_f32_16x16x32_bf16 v[128:131], a[4:7], a[36:39], v[128:131]
buffer_load_dwordx4 v6, s[24:27], s58 offen offset:1024 lds
v_mfma_f32_16x16x32_bf16 v[132:135], a[8:11], a[36:39], v[132:135]
ds_read_b64_tr_b16 a[82:83], v25 offset:39808
v_mfma_f32_16x16x32_bf16 v[148:151], a[8:11], a[40:43], v[148:151]
ds_read_b64_tr_b16 a[84:85], v25 offset:39328
v_mfma_f32_16x16x32_bf16 v[152:155], a[12:15], a[40:43], v[152:155]
ds_read_b64_tr_b16 a[86:87], v25 offset:39840
v_mfma_f32_16x16x32_bf16 v[136:139], a[12:15], a[36:39], v[136:139]
s_waitcnt vmcnt(18) lgkmcnt(8)
s_barrier
v_mfma_f32_16x16x32_bf16 v[60:63], a[64:67], a[44:47], v[60:63]
s_add_u32 m0, s59, 16640
s_mov_b32 s58, 1310720
ds_write_b128 v7, v[164:167]
v_mfma_f32_16x16x32_bf16 v[76:79], a[68:71], a[44:47], v[76:79]
buffer_load_dwordx4 v5, s[24:27], s58 offen lds
v_mfma_f32_16x16x32_bf16 v[80:83], a[68:71], a[48:51], v[80:83]
ds_read_b128 a[0:3], v23 offset:36864
v_mfma_f32_16x16x32_bf16 v[64:67], a[64:67], a[48:51], v[64:67]
ds_read_b128 a[4:7], v23 offset:37888
v_mfma_f32_16x16x32_bf16 v[68:71], a[64:67], a[52:55], v[68:71]
ds_read_b128 a[8:11], v23 offset:39168
v_mfma_f32_16x16x32_bf16 v[84:87], a[68:71], a[52:55], v[84:87]
ds_read_b128 a[12:15], v23 offset:40192
v_mfma_f32_16x16x32_bf16 v[88:91], a[68:71], a[56:59], v[88:91]
ds_read_b64_tr_b16 a[20:21], v25 offset:49664
v_mfma_f32_16x16x32_bf16 v[72:75], a[64:67], a[56:59], v[72:75]
ds_read_b64_tr_b16 a[22:23], v25 offset:50176
s_waitcnt lgkmcnt(7)
v_mfma_f32_16x16x32_bf16 v[104:107], a[72:75], a[56:59], v[104:107]
buffer_load_dwordx4 v6, s[24:27], s58 offen offset:1024 lds
v_mfma_f32_16x16x32_bf16 v[120:123], a[76:79], a[56:59], v[120:123]
ds_read_b64_tr_b16 a[24:25], v25 offset:49696
v_mfma_f32_16x16x32_bf16 v[116:119], a[76:79], a[52:55], v[116:119]
ds_read_b64_tr_b16 a[26:27], v25 offset:50208
ds_write_b32 v17, v164
v_mfma_f32_16x16x32_bf16 v[100:103], a[72:75], a[52:55], v[100:103]
ds_read_b128 a[16:19], v24 offset:38912
v_mfma_f32_16x16x32_bf16 v[96:99], a[72:75], a[48:51], v[96:99]
s_add_u32 m0, s59, 91520
s_mov_b32 s58, 393216
v_mfma_f32_16x16x32_bf16 v[112:115], a[76:79], a[48:51], v[112:115]
buffer_load_dwordx4 v5, s[24:27], s58 offen lds
v_mfma_f32_16x16x32_bf16 v[108:111], a[76:79], a[44:47], v[108:111]
v_mfma_f32_16x16x32_bf16 v[92:95], a[72:75], a[44:47], v[92:95]
ds_read_b64_tr_b16 a[28:29], v25 offset:50688
v_mfma_f32_16x16x32_bf16 v[156:159], a[72:75], a[60:63], v[156:159]
ds_read_b64_tr_b16 a[30:31], v25 offset:51200
v_mfma_f32_16x16x32_bf16 v[160:163], a[76:79], a[60:63], v[160:163]
ds_read_b64_tr_b16 a[32:33], v25 offset:50720
ds_write_b32 v17, v165 offset:1024
v_mfma_f32_16x16x32_bf16 v[124:127], a[44:47], a[80:83], v[124:127]
ds_read_b64_tr_b16 a[34:35], v25 offset:51232
v_mfma_f32_16x16x32_bf16 v[140:143], a[44:47], a[84:87], v[140:143]
buffer_load_dwordx4 v6, s[24:27], s58 offen offset:1024 lds
v_mfma_f32_16x16x32_bf16 v[144:147], a[48:51], a[84:87], v[144:147]
ds_read_b64_tr_b16 a[36:37], v25 offset:51712
v_mfma_f32_16x16x32_bf16 v[128:131], a[48:51], a[80:83], v[128:131]
ds_read_b64_tr_b16 a[38:39], v25 offset:52224
v_mfma_f32_16x16x32_bf16 v[132:135], a[52:55], a[80:83], v[132:135]
ds_read_b64_tr_b16 a[40:41], v25 offset:51744
v_mfma_f32_16x16x32_bf16 v[148:151], a[52:55], a[84:87], v[148:151]
ds_read_b64_tr_b16 a[42:43], v25 offset:52256
v_mfma_f32_16x16x32_bf16 v[152:155], a[56:59], a[84:87], v[152:155]
v_mfma_f32_16x16x32_bf16 v[136:139], a[56:59], a[80:83], v[136:139]
s_waitcnt vmcnt(16) lgkmcnt(9)
s_barrier
v_mfma_f32_16x16x32_bf16 v[60:63], a[20:23], a[0:3], v[60:63]
ds_read_b128 a[44:47], v23 offset:46080
s_add_u32 m0, s59, 24960
s_mov_b32 s58, 1441792
v_mfma_f32_16x16x32_bf16 v[76:79], a[24:27], a[0:3], v[76:79]
buffer_load_dwordx4 v5, s[24:27], s58 offen lds
v_mfma_f32_16x16x32_bf16 v[80:83], a[24:27], a[4:7], v[80:83]
ds_read_b128 a[48:51], v23 offset:47104
v_mfma_f32_16x16x32_bf16 v[64:67], a[20:23], a[4:7], v[64:67]
ds_read_b128 a[52:55], v23 offset:48384
v_mfma_f32_16x16x32_bf16 v[68:71], a[20:23], a[8:11], v[68:71]
ds_read_b128 a[56:59], v23 offset:49408
v_mfma_f32_16x16x32_bf16 v[84:87], a[24:27], a[8:11], v[84:87]
buffer_load_dwordx4 v6, s[24:27], s58 offen offset:1024 lds
v_mfma_f32_16x16x32_bf16 v[88:91], a[24:27], a[12:15], v[88:91]
ds_read_b64_tr_b16 a[64:65], v25 offset:62080
v_mfma_f32_16x16x32_bf16 v[72:75], a[20:23], a[12:15], v[72:75]
s_waitcnt lgkmcnt(5)
v_mfma_f32_16x16x32_bf16 v[104:107], a[28:31], a[12:15], v[104:107]
ds_read_b64_tr_b16 a[66:67], v25 offset:62592
s_add_u32 m0, s59, 99840
s_mov_b32 s58, 524288
v_mfma_f32_16x16x32_bf16 v[120:123], a[32:35], a[12:15], v[120:123]
buffer_load_dwordx4 v5, s[24:27], s58 offen lds
v_mfma_f32_16x16x32_bf16 v[116:119], a[32:35], a[8:11], v[116:119]
ds_read_b64_tr_b16 a[68:69], v25 offset:62112
v_mfma_f32_16x16x32_bf16 v[100:103], a[28:31], a[8:11], v[100:103]
ds_read_b64_tr_b16 a[70:71], v25 offset:62624
v_mfma_f32_16x16x32_bf16 v[96:99], a[28:31], a[4:7], v[96:99]
ds_read_b128 a[60:63], v24 offset:48128
v_mfma_f32_16x16x32_bf16 v[112:115], a[32:35], a[4:7], v[112:115]
buffer_load_dwordx4 v6, s[24:27], s58 offen offset:1024 lds
v_mfma_f32_16x16x32_bf16 v[108:111], a[32:35], a[0:3], v[108:111]
ds_read_b64_tr_b16 a[72:73], v25 offset:63104
v_mfma_f32_16x16x32_bf16 v[92:95], a[28:31], a[0:3], v[92:95]
ds_read_b64_tr_b16 a[74:75], v25 offset:63616
v_mfma_f32_16x16x32_bf16 v[156:159], a[28:31], a[16:19], v[156:159]
s_add_u32 m0, s59, 108160
s_mov_b32 s58, 655360
v_mfma_f32_16x16x32_bf16 v[160:163], a[32:35], a[16:19], v[160:163]
buffer_load_dwordx4 v5, s[24:27], s58 offen lds
v_mfma_f32_16x16x32_bf16 v[124:127], a[0:3], a[36:39], v[124:127]
ds_read_b64_tr_b16 a[76:77], v25 offset:63136
v_mfma_f32_16x16x32_bf16 v[140:143], a[0:3], a[40:43], v[140:143]
ds_read_b64_tr_b16 a[78:79], v25 offset:63648
v_mfma_f32_16x16x32_bf16 v[144:147], a[4:7], a[40:43], v[144:147]
ds_read_b64_tr_b16 a[80:81], v25 offset:64128
v_mfma_f32_16x16x32_bf16 v[128:131], a[4:7], a[36:39], v[128:131]
buffer_load_dwordx4 v6, s[24:27], s58 offen offset:1024 lds
v_mfma_f32_16x16x32_bf16 v[132:135], a[8:11], a[36:39], v[132:135]
ds_read_b64_tr_b16 a[82:83], v25 offset:64640
v_mfma_f32_16x16x32_bf16 v[148:151], a[8:11], a[40:43], v[148:151]
ds_read_b64_tr_b16 a[84:85], v25 offset:64160
v_mfma_f32_16x16x32_bf16 v[152:155], a[12:15], a[40:43], v[152:155]
ds_read_b64_tr_b16 a[86:87], v25 offset:64672
v_mfma_f32_16x16x32_bf16 v[136:139], a[12:15], a[36:39], v[136:139]
s_waitcnt lgkmcnt(0)
s_barrier
v_mfma_f32_16x16x32_bf16 v[156:159], a[72:75], a[60:63], v[156:159]
ds_read_b128 v[232:235], v10 offset:768
s_add_u32 m0, s59, 33280
v_mfma_f32_16x16x32_bf16 v[160:163], a[76:79], a[60:63], v[160:163]
ds_read_b128 v[236:239], v10 offset:2816
s_mov_b32 s58, 1572864
v_mfma_f32_16x16x32_bf16 v[104:107], a[72:75], a[56:59], v[104:107]
ds_read_b128 v[228:231], v10 offset:512
v_mfma_f32_16x16x32_bf16 v[120:123], a[76:79], a[56:59], v[120:123]
ds_read_b128 v[224:227], v10 offset:256
v_mfma_f32_16x16x32_bf16 v[136:139], a[56:59], a[80:83], v[136:139]
ds_read_b128 v[220:223], v10
v_mfma_f32_16x16x32_bf16 v[152:155], a[56:59], a[84:87], v[152:155]
ds_read_b128 v[240:243], v11 offset:192
v_mfma_f32_16x16x32_bf16 v[100:103], a[72:75], a[52:55], v[100:103]
ds_read_b128 v[244:247], v11 offset:1216
v_mfma_f32_16x16x32_bf16 v[116:119], a[76:79], a[52:55], v[116:119]
buffer_load_dwordx4 v5, s[24:27], s58 offen lds
v_mfma_f32_16x16x32_bf16 v[96:99], a[72:75], a[48:51], v[96:99]
ds_read_b128 v[18:21], v11 offset:128
ds_read_b128 v[22:25], v11 offset:1152
s_waitcnt lgkmcnt(8)
v_pk_fma_f32 v[104:105], v[36:37], v[232:233], v[104:105] op_sel_hi:[1,0,1]
v_pk_mul_f32 v[104:105], v[104:105], v[232:233] op_sel:[0,1] op_sel_hi:[1,1]
v_pk_fma_f32 v[106:107], v[38:39], v[232:233], v[106:107] op_sel_hi:[1,0,1]
v_pk_mul_f32 v[106:107], v[106:107], v[232:233] op_sel:[0,1] op_sel_hi:[1,1]
v_pk_fma_f32 v[120:121], v[40:41], v[232:233], v[120:121] op_sel_hi:[1,0,1]
v_pk_mul_f32 v[120:121], v[120:121], v[232:233] op_sel:[0,1] op_sel_hi:[1,1]
v_pk_fma_f32 v[122:123], v[42:43], v[232:233], v[122:123] op_sel_hi:[1,0,1]
v_pk_mul_f32 v[122:123], v[122:123], v[232:233] op_sel:[0,1] op_sel_hi:[1,1]
s_waitcnt lgkmcnt(6)
v_pk_fma_f32 v[100:101], v[36:37], v[228:229], v[100:101] op_sel_hi:[1,0,1]
v_pk_mul_f32 v[100:101], v[100:101], v[228:229] op_sel:[0,1] op_sel_hi:[1,1]
v_pk_fma_f32 v[102:103], v[38:39], v[228:229], v[102:103] op_sel_hi:[1,0,1]
v_pk_mul_f32 v[102:103], v[102:103], v[228:229] op_sel:[0,1] op_sel_hi:[1,1]
v_pk_fma_f32 v[116:117], v[40:41], v[228:229], v[116:117] op_sel_hi:[1,0,1]
v_pk_mul_f32 v[116:117], v[116:117], v[228:229] op_sel:[0,1] op_sel_hi:[1,1]
s_waitcnt lgkmcnt(3)
v_pk_fma_f32 v[136:137], v[240:241], v[44:45], v[136:137] op_sel_hi:[1,0,1]
v_pk_fma_f32 v[138:139], v[242:243], v[44:45], v[138:139] op_sel_hi:[1,0,1]
v_pk_fma_f32 v[152:153], v[240:241], v[44:45], v[152:153] op_sel:[0,1,0] op_sel_hi:[1,1,1]
v_pk_fma_f32 v[154:155], v[242:243], v[44:45], v[154:155] op_sel:[0,1,0] op_sel_hi:[1,1,1]
s_waitcnt lgkmcnt(2)
v_pk_mul_f32 v[136:137], v[136:137], v[244:245]
v_pk_mul_f32 v[138:139], v[138:139], v[246:247]
v_pk_mul_f32 v[152:153], v[152:153], v[244:245]
v_pk_mul_f32 v[154:155], v[154:155], v[246:247]
v_pk_fma_f32 v[118:119], v[42:43], v[228:229], v[118:119] op_sel_hi:[1,0,1]
v_pk_mul_f32 v[118:119], v[118:119], v[228:229] op_sel:[0,1] op_sel_hi:[1,1]
v_pk_fma_f32 v[96:97], v[36:37], v[224:225], v[96:97] op_sel_hi:[1,0,1]
v_pk_mul_f32 v[96:97], v[96:97], v[224:225] op_sel:[0,1] op_sel_hi:[1,1]
v_pk_fma_f32 v[98:99], v[38:39], v[224:225], v[98:99] op_sel_hi:[1,0,1]
v_pk_mul_f32 v[98:99], v[98:99], v[224:225] op_sel:[0,1] op_sel_hi:[1,1]
v_pk_fma_f32 v[156:157], v[36:37], v[236:237], v[156:157] op_sel_hi:[1,0,1]
v_pk_mul_f32 v[156:157], v[156:157], v[236:237] op_sel:[0,1] op_sel_hi:[1,1]
v_pk_fma_f32 v[158:159], v[38:39], v[236:237], v[158:159] op_sel_hi:[1,0,1]
v_pk_mul_f32 v[158:159], v[158:159], v[236:237] op_sel:[0,1] op_sel_hi:[1,1]
v_pk_fma_f32 v[160:161], v[40:41], v[236:237], v[160:161] op_sel_hi:[1,0,1]
v_pk_mul_f32 v[160:161], v[160:161], v[236:237] op_sel:[0,1] op_sel_hi:[1,1]
v_pk_fma_f32 v[162:163], v[42:43], v[236:237], v[162:163] op_sel_hi:[1,0,1]
v_pk_mul_f32 v[162:163], v[162:163], v[236:237] op_sel:[0,1] op_sel_hi:[1,1]
v_cvt_pk_bf16_f32 v196, v104, v105
v_cvt_pk_bf16_f32 v197, v106, v107
v_mfma_f32_16x16x32_bf16 v[112:115], a[76:79], a[48:51], v[112:115]
buffer_load_dwordx4 v6, s[24:27], s58 offen offset:1024 lds
v_mfma_f32_16x16x32_bf16 v[92:95], a[72:75], a[44:47], v[92:95]
s_add_u32 m0, s59, 41600
v_cvt_pk_bf16_f32 v198, v120, v121
v_cvt_pk_bf16_f32 v199, v122, v123
v_mfma_f32_16x16x32_bf16 v[108:111], a[76:79], a[44:47], v[108:111]
ds_write_b128 v8, v[196:199]
v_cvt_pk_bf16_f32 v208, v136, v137
v_mfma_f32_16x16x32_bf16 v[72:75], a[64:67], a[56:59], v[72:75]
s_mov_b32 s58, 1703936
v_cvt_pk_bf16_f32 v209, v138, v139
v_cvt_pk_bf16_f32 v218, v152, v153
v_mfma_f32_16x16x32_bf16 v[88:91], a[68:71], a[56:59], v[88:91]
ds_write_b64 v8, v[208:209] offset:1024
v_cvt_pk_bf16_f32 v219, v154, v155
ds_write_b64 v8, v[218:219] offset:1032
v_cvt_pk_bf16_f32 v192, v100, v101
v_pk_fma_f32 v[72:73], v[28:29], v[232:233], v[72:73] op_sel_hi:[1,0,1]
v_pk_fma_f32 v[74:75], v[30:31], v[232:233], v[74:75] op_sel_hi:[1,0,1]
s_nop 1
v_pk_fma_f32 v[88:89], v[32:33], v[232:233], v[88:89] op_sel_hi:[1,0,1]
v_pk_fma_f32 v[90:91], v[34:35], v[232:233], v[90:91] op_sel_hi:[1,0,1]
v_pk_fma_f32 v[112:113], v[40:41], v[224:225], v[112:113] op_sel_hi:[1,0,1]
v_pk_mul_f32 v[112:113], v[112:113], v[224:225] op_sel:[0,1] op_sel_hi:[1,1]
v_pk_fma_f32 v[114:115], v[42:43], v[224:225], v[114:115] op_sel_hi:[1,0,1]
v_pk_mul_f32 v[114:115], v[114:115], v[224:225] op_sel:[0,1] op_sel_hi:[1,1]
v_pk_fma_f32 v[92:93], v[36:37], v[220:221], v[92:93] op_sel_hi:[1,0,1]
v_pk_mul_f32 v[92:93], v[92:93], v[220:221] op_sel:[0,1] op_sel_hi:[1,1]
v_pk_fma_f32 v[94:95], v[38:39], v[220:221], v[94:95] op_sel_hi:[1,0,1]
v_pk_mul_f32 v[94:95], v[94:95], v[220:221] op_sel:[0,1] op_sel_hi:[1,1]
v_pk_fma_f32 v[108:109], v[40:41], v[220:221], v[108:109] op_sel_hi:[1,0,1]
v_pk_mul_f32 v[108:109], v[108:109], v[220:221] op_sel:[0,1] op_sel_hi:[1,1]
v_pk_fma_f32 v[110:111], v[42:43], v[220:221], v[110:111] op_sel_hi:[1,0,1]
v_pk_mul_f32 v[110:111], v[110:111], v[220:221] op_sel:[0,1] op_sel_hi:[1,1]
v_cvt_pk_bf16_f32 v193, v102, v103
v_cvt_pk_bf16_f32 v194, v116, v117
v_mfma_f32_16x16x32_bf16 v[132:135], a[52:55], a[80:83], v[132:135]
buffer_load_dwordx4 v5, s[24:27], s58 offen lds
v_mfma_f32_16x16x32_bf16 v[148:151], a[52:55], a[84:87], v[148:151]
ds_read_b128 v[240:243], v11 offset:64
v_cvt_pk_bf16_f32 v195, v118, v119
v_mfma_f32_16x16x32_bf16 v[68:71], a[64:67], a[52:55], v[68:71]
ds_read_b128 v[244:247], v11 offset:1088
s_waitcnt lgkmcnt(2)
s_barrier
v_mfma_f32_16x16x32_bf16 v[84:87], a[68:71], a[52:55], v[84:87]
ds_read_b64 v[200:201], v9 offset:1024
v_cvt_pk_bf16_f32 v176, v72, v73
v_mfma_f32_16x16x32_bf16 v[128:131], a[48:51], a[80:83], v[128:131]
ds_read_b64 v[210:211], v9 offset:1032
buffer_load_dwordx4 v6, s[24:27], s58 offen offset:1024 lds
s_add_u32 m0, s59, 49920
v_pk_fma_f32 v[132:133], v[18:19], v[44:45], v[132:133] op_sel_hi:[1,0,1]
v_pk_mul_f32 v[132:133], v[132:133], v[22:23]
v_pk_fma_f32 v[134:135], v[20:21], v[44:45], v[134:135] op_sel_hi:[1,0,1]
v_pk_mul_f32 v[134:135], v[134:135], v[24:25]
v_pk_fma_f32 v[148:149], v[18:19], v[44:45], v[148:149] op_sel:[0,1,0] op_sel_hi:[1,1,1]
v_pk_mul_f32 v[148:149], v[148:149], v[22:23]
v_pk_fma_f32 v[150:151], v[20:21], v[44:45], v[150:151] op_sel:[0,1,0] op_sel_hi:[1,1,1]
v_pk_mul_f32 v[150:151], v[150:151], v[24:25]
v_pk_fma_f32 v[68:69], v[28:29], v[228:229], v[68:69] op_sel_hi:[1,0,1]
v_pk_fma_f32 v[70:71], v[30:31], v[228:229], v[70:71] op_sel_hi:[1,0,1]
v_pk_fma_f32 v[84:85], v[32:33], v[228:229], v[84:85] op_sel_hi:[1,0,1]
v_pk_fma_f32 v[86:87], v[34:35], v[228:229], v[86:87] op_sel_hi:[1,0,1]
s_mov_b32 s58, 1835008
v_cvt_pk_bf16_f32 v177, v74, v75
v_mfma_f32_16x16x32_bf16 v[144:147], a[48:51], a[84:87], v[144:147]
buffer_load_dwordx4 v5, s[24:27], s58 offen lds
v_mfma_f32_16x16x32_bf16 v[64:67], a[64:67], a[48:51], v[64:67]
ds_read_b128 v[18:21], v11
v_cvt_pk_bf16_f32 v178, v88, v89
v_mfma_f32_16x16x32_bf16 v[80:83], a[68:71], a[48:51], v[80:83]
ds_read_b128 v[22:25], v11 offset:1024
v_cvt_pk_bf16_f32 v179, v90, v91
v_mfma_f32_16x16x32_bf16 v[124:127], a[44:47], a[80:83], v[124:127]
v_cvt_pk_bf16_f32 v206, v132, v133
v_cvt_pk_bf16_f32 v207, v134, v135
v_cvt_pk_bf16_f32 v216, v148, v149
v_cvt_pk_bf16_f32 v217, v150, v151
v_cvt_pk_bf16_f32 v188, v96, v97
s_waitcnt lgkmcnt(5)
v_pk_fma_f32 v[128:129], v[240:241], v[44:45], v[128:129] op_sel_hi:[1,0,1]
s_waitcnt lgkmcnt(4)
v_pk_mul_f32 v[128:129], v[128:129], v[244:245]
v_pk_fma_f32 v[130:131], v[242:243], v[44:45], v[130:131] op_sel_hi:[1,0,1]
v_pk_mul_f32 v[130:131], v[130:131], v[246:247]
v_pk_fma_f32 v[144:145], v[240:241], v[44:45], v[144:145] op_sel:[0,1,0] op_sel_hi:[1,1,1]
v_pk_mul_f32 v[144:145], v[144:145], v[244:245]
v_pk_fma_f32 v[146:147], v[242:243], v[44:45], v[146:147] op_sel:[0,1,0] op_sel_hi:[1,1,1]
v_pk_mul_f32 v[146:147], v[146:147], v[246:247]
v_pk_fma_f32 v[64:65], v[28:29], v[224:225], v[64:65] op_sel_hi:[1,0,1]
v_pk_fma_f32 v[66:67], v[30:31], v[224:225], v[66:67] op_sel_hi:[1,0,1]
v_pk_fma_f32 v[80:81], v[32:33], v[224:225], v[80:81] op_sel_hi:[1,0,1]
v_pk_fma_f32 v[82:83], v[34:35], v[224:225], v[82:83] op_sel_hi:[1,0,1]
v_cvt_pk_bf16_f32 v189, v98, v99
v_cvt_pk_bf16_f32 v190, v112, v113
v_mfma_f32_16x16x32_bf16 v[140:143], a[44:47], a[84:87], v[140:143]
buffer_load_dwordx4 v6, s[24:27], s58 offen offset:1024 lds
v_mfma_f32_16x16x32_bf16 v[60:63], a[64:67], a[44:47], v[60:63]
s_add_u32 m0, s59, 116480
s_mov_b32 s58, 786432
v_cvt_pk_bf16_f32 v191, v114, v115
v_mfma_f32_16x16x32_bf16 v[76:79], a[68:71], a[44:47], v[76:79]
v_cvt_pk_bf16_f32 v172, v68, v69
v_cvt_pk_bf16_f32 v173, v70, v71
v_mfma_f32_16x16x32_bf16 v[104:107], v[192:195], v[176:179], v[46:49]
v_cvt_pk_bf16_f32 v174, v84, v85
v_cvt_pk_bf16_f32 v175, v86, v87
v_cvt_pk_bf16_f32 v204, v128, v129
v_cvt_pk_bf16_f32 v205, v130, v131
v_cvt_pk_bf16_f32 v214, v144, v145
s_waitcnt lgkmcnt(1)
v_pk_fma_f32 v[124:125], v[18:19], v[44:45], v[124:125] op_sel_hi:[1,0,1]
s_waitcnt lgkmcnt(0)
v_pk_mul_f32 v[124:125], v[124:125], v[22:23]
v_pk_fma_f32 v[126:127], v[20:21], v[44:45], v[126:127] op_sel_hi:[1,0,1]
v_pk_mul_f32 v[126:127], v[126:127], v[24:25]
v_pk_fma_f32 v[140:141], v[18:19], v[44:45], v[140:141] op_sel:[0,1,0] op_sel_hi:[1,1,1]
v_pk_mul_f32 v[140:141], v[140:141], v[22:23]
v_pk_fma_f32 v[142:143], v[20:21], v[44:45], v[142:143] op_sel:[0,1,0] op_sel_hi:[1,1,1]
v_pk_mul_f32 v[142:143], v[142:143], v[24:25]
v_pk_fma_f32 v[60:61], v[28:29], v[220:221], v[60:61] op_sel_hi:[1,0,1]
v_pk_fma_f32 v[62:63], v[30:31], v[220:221], v[62:63] op_sel_hi:[1,0,1]
v_pk_fma_f32 v[76:77], v[32:33], v[220:221], v[76:77] op_sel_hi:[1,0,1]
v_pk_fma_f32 v[78:79], v[34:35], v[220:221], v[78:79] op_sel_hi:[1,0,1]
v_max3_f32 v88, v104, v105, v106
v_cvt_pk_bf16_f32 v215, v146, v147
v_mfma_f32_16x16x32_bf16 v[120:123], v[196:199], v[176:179], v[50:53]
buffer_load_dwordx4 v5, s[24:27], s58 offen lds
v_mfma_f32_16x16x32_bf16 v[100:103], v[188:191], v[172:175], v[46:49]
v_cvt_pk_bf16_f32 v184, v92, v93
v_cvt_pk_bf16_f32 v185, v94, v95
v_mfma_f32_16x16x32_bf16 v[116:119], v[192:195], v[172:175], v[50:53]
s_nop 2
v_max3_f32 v89, v107, v120, v121
v_max3_f32 v88, v88, v122, v123
v_max_f32 v90, v88, v89
v_max_f32 v89, v88, v89
v_max3_f32 v84, v100, v101, v102
v_cvt_pk_bf16_f32 v186, v108, v109
v_permlane16_swap_b32 v90, v89
v_max3_f32 v85, v103, v116, v117
buffer_load_dwordx4 v6, s[24:27], s58 offen offset:1024 lds
s_add_u32 m0, s59, 124800
s_mov_b32 s58, 917504
v_max_f32 v88, v90, v89
v_max_f32 v89, v90, v89
v_max3_f32 v84, v84, v118, v119
v_max_f32 v86, v84, v85
v_permlane32_swap_b32 v88, v89
v_max_f32 v85, v84, v85
v_max_f32 v88, v88, v89
v_mul_f32 v88, v88, v234
v_pk_fma_f32 v[104:105], v[104:105], v[234:235], v[88:89] op_sel_hi:[1,0,0] neg_lo:[0,0,1] neg_hi:[0,0,1]
v_pk_fma_f32 v[106:107], v[106:107], v[234:235], v[88:89] op_sel_hi:[1,0,0] neg_lo:[0,0,1] neg_hi:[0,0,1]
buffer_load_dwordx4 v5, s[24:27], s58 offen lds
v_pk_fma_f32 v[120:121], v[120:121], v[234:235], v[88:89] op_sel_hi:[1,0,0] neg_lo:[0,0,1] neg_hi:[0,0,1]
v_pk_fma_f32 v[122:123], v[122:123], v[234:235], v[88:89] op_sel_hi:[1,0,0] neg_lo:[0,0,1] neg_hi:[0,0,1]
v_exp_f32 v104, v104
v_exp_f32 v105, v105
v_exp_f32 v106, v106
v_exp_f32 v107, v107
v_exp_f32 v120, v120
v_exp_f32 v121, v121
v_exp_f32 v122, v122
v_exp_f32 v123, v123
v_cvt_pk_bf16_f32 v72, v104, v105
buffer_load_dwordx4 v6, s[24:27], s58 offen offset:1024 lds
v_cvt_pk_bf16_f32 v73, v106, v107
v_cvt_pk_bf16_f32 v74, v120, v121
v_cvt_pk_bf16_f32 v75, v122, v123
v_permlane16_swap_b32 v86, v85
s_nop 0
v_mfma_f32_16x16x32_bf16 v[88:91], v[248:251], v[72:75], 0
v_max_f32 v84, v86, v85
v_max_f32 v85, v86, v85
v_mfma_f32_16x16x32_bf16 v[104:107], v[206:209], v[72:75], 0
s_nop 0
v_permlane32_swap_b32 v84, v85
v_mfma_f32_16x16x32_bf16 v[120:123], v[216:219], v[72:75], 0
s_nop 1
v_rcp_f32 v88, v88
v_max_f32 v84, v84, v85
v_mul_f32 v84, v84, v230
v_cvt_pk_bf16_f32 v187, v110, v111
v_pk_mul_f32 v[104:105], v[104:105], v[88:89] op_sel_hi:[1,0]
.Lpad12:
s_cbranch_execz .Lpad15
v_pk_mul_f32 v[106:107], v[106:107], v[88:89] op_sel_hi:[1,0]
v_pk_mul_f32 v[120:121], v[120:121], v[88:89] op_sel_hi:[1,0]
v_pk_mul_f32 v[122:123], v[122:123], v[88:89] op_sel_hi:[1,0]
v_cvt_pk_bf16_f32 v176, v104, v105
v_cvt_pk_bf16_f32 v177, v106, v107
v_cvt_pk_bf16_f32 v178, v120, v121
v_cvt_pk_bf16_f32 v179, v122, v123
buffer_store_dwordx4 v[176:179], v4, s[16:19], s74 offen offset:3072 sc1
v_pk_fma_f32 v[100:101], v[100:101], v[230:231], v[84:85] op_sel_hi:[1,0,0] neg_lo:[0,0,1] neg_hi:[0,0,1]
v_pk_fma_f32 v[102:103], v[102:103], v[230:231], v[84:85] op_sel_hi:[1,0,0] neg_lo:[0,0,1] neg_hi:[0,0,1]
v_pk_fma_f32 v[116:117], v[116:117], v[230:231], v[84:85] op_sel_hi:[1,0,0] neg_lo:[0,0,1] neg_hi:[0,0,1]
v_pk_fma_f32 v[118:119], v[118:119], v[230:231], v[84:85] op_sel_hi:[1,0,0] neg_lo:[0,0,1] neg_hi:[0,0,1]
v_exp_f32 v100, v100
v_exp_f32 v101, v101
v_exp_f32 v102, v102
v_exp_f32 v103, v103
v_exp_f32 v116, v116
v_exp_f32 v117, v117
v_exp_f32 v118, v118
v_exp_f32 v119, v119
v_cvt_pk_bf16_f32 v68, v100, v101
v_cvt_pk_bf16_f32 v69, v102, v103
v_cvt_pk_bf16_f32 v70, v116, v117
v_cvt_pk_bf16_f32 v71, v118, v119
v_cvt_pk_bf16_f32 v168, v64, v65
v_cvt_pk_bf16_f32 v169, v66, v67
v_mfma_f32_16x16x32_bf16 v[84:87], v[248:251], v[68:71], 0
v_cvt_pk_bf16_f32 v170, v80, v81
v_cvt_pk_bf16_f32 v171, v82, v83
v_mfma_f32_16x16x32_bf16 v[100:103], v[204:207], v[68:71], 0
v_cvt_pk_bf16_f32 v202, v124, v125
v_cvt_pk_bf16_f32 v203, v126, v127
v_mfma_f32_16x16x32_bf16 v[116:119], v[214:217], v[68:71], 0
s_nop 1
v_rcp_f32 v84, v84
v_mfma_f32_16x16x32_bf16 v[96:99], v[184:187], v[168:171], v[46:49]
v_cvt_pk_bf16_f32 v212, v140, v141
v_cvt_pk_bf16_f32 v213, v142, v143
v_mfma_f32_16x16x32_bf16 v[112:115], v[188:191], v[168:171], v[50:53]
v_cvt_pk_bf16_f32 v180, v156, v157
v_cvt_pk_bf16_f32 v181, v158, v159
v_cvt_pk_bf16_f32 v182, v160, v161
s_nop 1
v_max3_f32 v80, v96, v97, v98
v_cvt_pk_bf16_f32 v183, v162, v163
v_pk_mul_f32 v[100:101], v[100:101], v[84:85] op_sel_hi:[1,0]
v_pk_mul_f32 v[102:103], v[102:103], v[84:85] op_sel_hi:[1,0]
v_pk_mul_f32 v[116:117], v[116:117], v[84:85] op_sel_hi:[1,0]
v_pk_mul_f32 v[118:119], v[118:119], v[84:85] op_sel_hi:[1,0]
v_cvt_pk_bf16_f32 v172, v100, v101
v_cvt_pk_bf16_f32 v173, v102, v103
v_cvt_pk_bf16_f32 v174, v116, v117
v_cvt_pk_bf16_f32 v175, v118, v119
buffer_store_dwordx4 v[172:175], v4, s[16:19], s74 offen offset:2048 sc1
v_max3_f32 v81, v99, v112, v113
v_max3_f32 v80, v80, v114, v115
v_max_f32 v82, v80, v81
v_max_f32 v81, v80, v81
v_cvt_pk_bf16_f32 v164, v60, v61
v_cvt_pk_bf16_f32 v165, v62, v63
v_permlane16_swap_b32 v82, v81
v_cvt_pk_bf16_f32 v166, v76, v77
v_max_f32 v80, v82, v81
v_max_f32 v81, v82, v81
v_cvt_pk_bf16_f32 v167, v78, v79
s_nop 0
v_permlane32_swap_b32 v80, v81
v_mfma_f32_16x16x32_bf16 v[92:95], v[180:183], v[164:167], v[54:57]
v_max_f32 v80, v80, v81
v_mul_f32 v80, v80, v226
v_mfma_f32_16x16x32_bf16 v[108:111], v[184:187], v[164:167], v[50:53]
s_nop 4
v_max3_f32 v76, v92, v93, v94
v_pk_fma_f32 v[96:97], v[96:97], v[226:227], v[80:81] op_sel_hi:[1,0,0] neg_lo:[0,0,1] neg_hi:[0,0,1]
v_pk_fma_f32 v[98:99], v[98:99], v[226:227], v[80:81] op_sel_hi:[1,0,0] neg_lo:[0,0,1] neg_hi:[0,0,1]
v_pk_fma_f32 v[112:113], v[112:113], v[226:227], v[80:81] op_sel_hi:[1,0,0] neg_lo:[0,0,1] neg_hi:[0,0,1]
v_pk_fma_f32 v[114:115], v[114:115], v[226:227], v[80:81] op_sel_hi:[1,0,0] neg_lo:[0,0,1] neg_hi:[0,0,1]
v_exp_f32 v96, v96
v_exp_f32 v97, v97
v_exp_f32 v98, v98
v_exp_f32 v99, v99
v_exp_f32 v112, v112
v_exp_f32 v113, v113
v_exp_f32 v114, v114
v_exp_f32 v115, v115
v_cvt_pk_bf16_f32 v64, v96, v97
v_cvt_pk_bf16_f32 v65, v98, v99
v_cvt_pk_bf16_f32 v66, v112, v113
v_cvt_pk_bf16_f32 v67, v114, v115
v_max3_f32 v77, v95, v108, v109
v_max3_f32 v76, v76, v110, v111
v_mfma_f32_16x16x32_bf16 v[80:83], v[248:251], v[64:67], 0
v_max_f32 v78, v76, v77
v_max_f32 v77, v76, v77
v_mfma_f32_16x16x32_bf16 v[96:99], v[202:205], v[64:67], 0
s_nop 0
v_permlane16_swap_b32 v78, v77
v_mfma_f32_16x16x32_bf16 v[112:115], v[212:215], v[64:67], 0
s_nop 1
v_rcp_f32 v80, v80
v_max_f32 v76, v78, v77
v_max_f32 v77, v78, v77
v_pk_mul_f32 v[96:97], v[96:97], v[80:81] op_sel_hi:[1,0]
v_pk_mul_f32 v[98:99], v[98:99], v[80:81] op_sel_hi:[1,0]
s_nop 0
v_pk_mul_f32 v[112:113], v[112:113], v[80:81] op_sel_hi:[1,0]
v_pk_mul_f32 v[114:115], v[114:115], v[80:81] op_sel_hi:[1,0]
v_cvt_pk_bf16_f32 v168, v96, v97
v_cvt_pk_bf16_f32 v169, v98, v99
v_cvt_pk_bf16_f32 v170, v112, v113
v_cvt_pk_bf16_f32 v171, v114, v115
buffer_store_dwordx4 v[168:171], v4, s[16:19], s74 offen offset:1024 sc1
v_permlane32_swap_b32 v76, v77
v_max_f32 v76, v76, v77
v_mul_f32 v76, v76, v222
v_pk_fma_f32 v[92:93], v[92:93], v[222:223], v[76:77] op_sel_hi:[1,0,0] neg_lo:[0,0,1] neg_hi:[0,0,1]
v_pk_fma_f32 v[94:95], v[94:95], v[222:223], v[76:77] op_sel_hi:[1,0,0] neg_lo:[0,0,1] neg_hi:[0,0,1]
v_pk_fma_f32 v[108:109], v[108:109], v[222:223], v[76:77] op_sel_hi:[1,0,0] neg_lo:[0,0,1] neg_hi:[0,0,1]
v_pk_fma_f32 v[110:111], v[110:111], v[222:223], v[76:77] op_sel_hi:[1,0,0] neg_lo:[0,0,1] neg_hi:[0,0,1]
v_exp_f32 v92, v92
v_exp_f32 v93, v93
v_exp_f32 v94, v94
v_exp_f32 v95, v95
v_exp_f32 v108, v108
v_exp_f32 v109, v109
v_exp_f32 v110, v110
v_exp_f32 v111, v111
v_cvt_pk_bf16_f32 v60, v92, v93
v_cvt_pk_bf16_f32 v61, v94, v95
v_cvt_pk_bf16_f32 v62, v108, v109
v_cvt_pk_bf16_f32 v63, v110, v111
s_nop 1
v_mfma_f32_16x16x32_bf16 v[76:79], v[248:251], v[60:63], 0
v_mfma_f32_16x16x32_bf16 v[92:95], v[200:203], v[60:63], 0
v_mfma_f32_16x16x32_bf16 v[108:111], v[210:213], v[60:63], 0
s_nop 5
v_rcp_f32 v76, v76
s_nop 0
v_pk_mul_f32 v[92:93], v[92:93], v[76:77] op_sel_hi:[1,0]
v_pk_mul_f32 v[94:95], v[94:95], v[76:77] op_sel_hi:[1,0]
v_pk_mul_f32 v[108:109], v[108:109], v[76:77] op_sel_hi:[1,0]
v_pk_mul_f32 v[110:111], v[110:111], v[76:77] op_sel_hi:[1,0]
v_cvt_pk_bf16_f32 v164, v92, v93
v_cvt_pk_bf16_f32 v165, v94, v95
v_cvt_pk_bf16_f32 v166, v108, v109
v_cvt_pk_bf16_f32 v167, v110, v111
buffer_store_dwordx4 v[164:167], v4, s[16:19], s74 offen sc1
s_nop 1
s_branch .Lqkve61
.Lpad13:
s_cbranch_execz .Lpad16
.Lxs54:
s_mov_b32 s15, 0
.Lxs54l:
v_mov_b32 v15, 0
buffer_atomic_add v15, v12, s[16:19], s70 offen sc0
s_add_u32 s15, s15, 1
s_cmp_gt_u32 s15, 100000
s_waitcnt vmcnt(0)
s_cbranch_scc1 .Lxs54b
v_cmp_ne_u32 vcc, 0, v15
s_nop 0
s_cbranch_vccz .Lxs54l
s_branch .Lxs54b
.Lqkv60:
.Lpad14:
s_cbranch_execz .Lpad17
s_add_u32 m0, s55, 36864
s_nop 0
buffer_load_dwordx4 v21, s[16:19], s52 offen sc1 lds
buffer_load_dwordx4 v21, s[16:19], s52 offen offset:1024 sc1 lds
buffer_load_dword v22, s[16:19], s52 offen offset:2048 sc1 lds
s_add_u32 s52, s52, 0x20000
s_add_u32 m0, s55, 46080
s_nop 0
buffer_load_dwordx4 v21, s[16:19], s52 offen sc1 lds
buffer_load_dwordx4 v21, s[16:19], s52 offen offset:1024 sc1 lds
buffer_load_dword v22, s[16:19], s52 offen offset:2048 sc1 lds
s_add_u32 s52, s52, 0x20000
s_add_u32 m0, s55, 0
s_nop 0
buffer_load_dwordx4 v21, s[16:19], s52 offen sc1 lds
buffer_load_dwordx4 v21, s[16:19], s52 offen offset:1024 sc1 lds
buffer_load_dword v22, s[16:19], s52 offen offset:2048 sc1 lds
s_add_u32 s52, s52, 0x20000
s_add_u32 m0, s55, 9216
s_nop 0
buffer_load_dwordx4 v21, s[16:19], s52 offen sc1 lds
buffer_load_dwordx4 v21, s[16:19], s52 offen offset:1024 sc1 lds
buffer_load_dword v22, s[16:19], s52 offen offset:2048 sc1 lds
s_add_u32 s52, s52, 0x20000
s_add_u32 m0, s55, 18432
s_nop 0
buffer_load_dwordx4 v21, s[16:19], s52 offen sc1 lds
buffer_load_dwordx4 v21, s[16:19], s52 offen offset:1024 sc1 lds
buffer_load_dword v22, s[16:19], s52 offen offset:2048 sc1 lds
s_add_u32 s52, s52, 0x20000
s_waitcnt vmcnt(12)
s_barrier
ds_read_b128 a[0:3], v23 offset:36864
ds_read_b128 a[4:7], v23 offset:37888
ds_read_b128 a[8:11], v23 offset:39168
ds_read_b128 a[12:15], v23 offset:40192
ds_read_b128 a[16:19], v24 offset:38912
s_waitcnt lgkmcnt(0)
s_mov_b32 s15, -4
.p2align 6
.Lk63:
s_waitcnt vmcnt(9) lgkmcnt(8)
s_barrier
v_mfma_f32_16x16x32_bf16 v[60:63], a[20:23], a[0:3], v[60:63]
ds_read_b128 a[44:47], v23 offset:46080
s_add_u32 m0, s56, 104832
v_mfma_f32_16x16x32_bf16 v[76:79], a[24:27], a[0:3], v[76:79]
buffer_load_dwordx4 v18, s[20:23], s54 offen lds
v_mfma_f32_16x16x32_bf16 v[80:83], a[24:27], a[4:7], v[80:83]
ds_read_b128 a[48:51], v23 offset:47104
v_add_f32 v164, v164, v168
v_mfma_f32_16x16x32_bf16 v[64:67], a[20:23], a[4:7], v[64:67]
ds_read_b128 a[52:55], v23 offset:48384
v_mfma_f32_16x16x32_bf16 v[68:71], a[20:23], a[8:11], v[68:71]
buffer_load_dwordx4 v19, s[20:23], s54 offen offset:1024 lds
v_mfma_f32_16x16x32_bf16 v[84:87], a[24:27], a[8:11], v[84:87]
ds_read_b128 a[56:59], v23 offset:49408
v_mfma_f32_16x16x32_bf16 v[88:91], a[24:27], a[12:15], v[88:91]
ds_read_b64_tr_b16 a[64:65], v25 offset:62080
v_add_f32 v165, v165, v169
v_mfma_f32_16x16x32_bf16 v[72:75], a[20:23], a[12:15], v[72:75]
ds_read_b64_tr_b16 a[66:67], v25 offset:62592
s_waitcnt lgkmcnt(6)
v_mfma_f32_16x16x32_bf16 v[104:107], a[28:31], a[12:15], v[104:107]
buffer_load_dwordx4 v20, s[20:23], s54 offen offset:2048 lds
v_mfma_f32_16x16x32_bf16 v[120:123], a[32:35], a[12:15], v[120:123]
ds_read_b64_tr_b16 a[68:69], v25 offset:62112
s_add_u32 s54, s54, 196608
v_mfma_f32_16x16x32_bf16 v[116:119], a[32:35], a[8:11], v[116:119]
ds_read_b64_tr_b16 a[70:71], v25 offset:62624
s_add_u32 m0, s55, 27648
v_mfma_f32_16x16x32_bf16 v[100:103], a[28:31], a[8:11], v[100:103]
buffer_load_dwordx4 v21, s[16:19], s52 offen sc1 lds
v_mfma_f32_16x16x32_bf16 v[96:99], a[28:31], a[4:7], v[96:99]
ds_read_b128 a[60:63], v24 offset:48128
v_mfma_f32_16x16x32_bf16 v[112:115], a[32:35], a[4:7], v[112:115]
ds_read_b64_tr_b16 a[72:73], v25 offset:63104
v_mfma_f32_16x16x32_bf16 v[108:111], a[32:35], a[0:3], v[108:111]
buffer_load_dwordx4 v21, s[16:19], s52 offen offset:1024 sc1 lds
v_mfma_f32_16x16x32_bf16 v[92:95], a[28:31], a[0:3], v[92:95]
ds_read_b64_tr_b16 a[74:75], v25 offset:63616
v_add_f32 v166, v166, v170
v_mfma_f32_16x16x32_bf16 v[124:127], a[0:3], a[36:39], v[124:127]
ds_read_b64_tr_b16 a[76:77], v25 offset:63136
v_mfma_f32_16x16x32_bf16 v[140:143], a[0:3], a[40:43], v[140:143]
ds_read_b64_tr_b16 a[78:79], v25 offset:63648
v_mfma_f32_16x16x32_bf16 v[144:147], a[4:7], a[40:43], v[144:147]
buffer_load_dword v22, s[16:19], s52 offen offset:2048 sc1 lds
v_mfma_f32_16x16x32_bf16 v[128:131], a[4:7], a[36:39], v[128:131]
ds_read_b64_tr_b16 a[80:81], v25 offset:64128
s_add_u32 s52, s52, 0x20000
v_mfma_f32_16x16x32_bf16 v[132:135], a[8:11], a[36:39], v[132:135]
ds_read_b64_tr_b16 a[82:83], v25 offset:64640
v_add_f32 v167, v167, v171
v_mfma_f32_16x16x32_bf16 v[148:151], a[8:11], a[40:43], v[148:151]
buffer_load_dword v27, v14, s[20:23], s44 offen
v_mfma_f32_16x16x32_bf16 v[152:155], a[12:15], a[40:43], v[152:155]
ds_read_b64_tr_b16 a[84:85], v25 offset:64160
s_add_u32 s44, s44, 1572864
v_mfma_f32_16x16x32_bf16 v[136:139], a[12:15], a[36:39], v[136:139]
ds_read_b64_tr_b16 a[86:87], v25 offset:64672
v_mfma_f32_16x16x32_bf16 v[156:159], a[16:19], a[36:39], v[156:159]
v_mfma_f32_16x16x32_bf16 v[160:163], a[16:19], a[40:43], v[160:163]
s_waitcnt vmcnt(13) lgkmcnt(8)
s_barrier
v_mfma_f32_16x16x32_bf16 v[60:63], a[64:67], a[44:47], v[60:63]
ds_read_b128 a[0:3], v23
s_add_u32 m0, s56, 117248
v_mfma_f32_16x16x32_bf16 v[76:79], a[68:71], a[44:47], v[76:79]
buffer_load_dwordx4 v18, s[20:23], s54 offen lds
v_mfma_f32_16x16x32_bf16 v[80:83], a[68:71], a[48:51], v[80:83]
ds_read_b128 a[4:7], v23 offset:1024
v_mfma_f32_16x16x32_bf16 v[64:67], a[64:67], a[48:51], v[64:67]
ds_read_b128 a[8:11], v23 offset:2304
v_mfma_f32_16x16x32_bf16 v[68:71], a[64:67], a[52:55], v[68:71]
buffer_load_dwordx4 v19, s[20:23], s54 offen offset:1024 lds
v_mfma_f32_16x16x32_bf16 v[84:87], a[68:71], a[52:55], v[84:87]
ds_read_b128 a[12:15], v23 offset:3328
v_mfma_f32_16x16x32_bf16 v[88:91], a[68:71], a[56:59], v[88:91]
ds_read_b64_tr_b16 a[20:21], v25
v_mfma_f32_16x16x32_bf16 v[72:75], a[64:67], a[56:59], v[72:75]
ds_read_b64_tr_b16 a[22:23], v25 offset:512
s_waitcnt lgkmcnt(6)
v_mfma_f32_16x16x32_bf16 v[104:107], a[72:75], a[56:59], v[104:107]
buffer_load_dwordx4 v20, s[20:23], s54 offen offset:2048 lds
v_mfma_f32_16x16x32_bf16 v[120:123], a[76:79], a[56:59], v[120:123]
ds_read_b64_tr_b16 a[24:25], v25 offset:32
s_add_u32 s54, s54, 196608
v_mfma_f32_16x16x32_bf16 v[116:119], a[76:79], a[52:55], v[116:119]
ds_read_b64_tr_b16 a[26:27], v25 offset:544
s_add_u32 m0, s55, 36864
v_mfma_f32_16x16x32_bf16 v[100:103], a[72:75], a[52:55], v[100:103]
buffer_load_dwordx4 v21, s[16:19], s52 offen sc1 lds
v_mfma_f32_16x16x32_bf16 v[96:99], a[72:75], a[48:51], v[96:99]
ds_read_b128 a[16:19], v24 offset:2048
v_mfma_f32_16x16x32_bf16 v[112:115], a[76:79], a[48:51], v[112:115]
ds_read_b64_tr_b16 a[28:29], v25 offset:1024
v_mfma_f32_16x16x32_bf16 v[108:111], a[76:79], a[44:47], v[108:111]
buffer_load_dwordx4 v21, s[16:19], s52 offen offset:1024 sc1 lds
v_mfma_f32_16x16x32_bf16 v[92:95], a[72:75], a[44:47], v[92:95]
ds_read_b64_tr_b16 a[30:31], v25 offset:1536
v_mfma_f32_16x16x32_bf16 v[124:127], a[44:47], a[80:83], v[124:127]
ds_read_b64_tr_b16 a[32:33], v25 offset:1056
v_mfma_f32_16x16x32_bf16 v[140:143], a[44:47], a[84:87], v[140:143]
ds_read_b64_tr_b16 a[34:35], v25 offset:1568
v_mfma_f32_16x16x32_bf16 v[144:147], a[48:51], a[84:87], v[144:147]
buffer_load_dword v22, s[16:19], s52 offen offset:2048 sc1 lds
v_mfma_f32_16x16x32_bf16 v[128:131], a[48:51], a[80:83], v[128:131]
ds_read_b64_tr_b16 a[36:37], v25 offset:2048
s_add_u32 s52, s52, 0x20000
v_mfma_f32_16x16x32_bf16 v[132:135], a[52:55], a[80:83], v[132:135]
ds_read_b64_tr_b16 a[38:39], v25 offset:2560
v_mfma_f32_16x16x32_bf16 v[148:151], a[52:55], a[84:87], v[148:151]
buffer_load_dwordx4 v[168:171], v26, s[16:19], s75 offen sc1
v_mfma_f32_16x16x32_bf16 v[152:155], a[56:59], a[84:87], v[152:155]
ds_read_b64_tr_b16 a[40:41], v25 offset:2080
v_mfma_f32_16x16x32_bf16 v[136:139], a[56:59], a[80:83], v[136:139]
ds_read_b64_tr_b16 a[42:43], v25 offset:2592
v_mfma_f32_16x16x32_bf16 v[156:159], a[60:63], a[80:83], v[156:159]
v_mfma_f32_16x16x32_bf16 v[160:163], a[60:63], a[84:87], v[160:163]
s_waitcnt vmcnt(17) lgkmcnt(8)
s_barrier
v_mfma_f32_16x16x32_bf16 v[60:63], a[20:23], a[0:3], v[60:63]
ds_read_b128 a[44:47], v23 offset:9216
s_add_u32 m0, s56, 129664
v_mfma_f32_16x16x32_bf16 v[76:79], a[24:27], a[0:3], v[76:79]
buffer_load_dwordx4 v18, s[20:23], s54 offen lds
v_mfma_f32_16x16x32_bf16 v[80:83], a[24:27], a[4:7], v[80:83]
ds_read_b128 a[48:51], v23 offset:10240
v_mfma_f32_16x16x32_bf16 v[64:67], a[20:23], a[4:7], v[64:67]
ds_read_b128 a[52:55], v23 offset:11520
v_mfma_f32_16x16x32_bf16 v[68:71], a[20:23], a[8:11], v[68:71]
ds_read_b128 a[56:59], v23 offset:12544
v_mfma_f32_16x16x32_bf16 v[84:87], a[24:27], a[8:11], v[84:87]
buffer_load_dwordx4 v19, s[20:23], s54 offen offset:1024 lds
v_mfma_f32_16x16x32_bf16 v[88:91], a[24:27], a[12:15], v[88:91]
ds_read_b64_tr_b16 a[64:65], v25 offset:12416
v_mfma_f32_16x16x32_bf16 v[72:75], a[20:23], a[12:15], v[72:75]
ds_read_b64_tr_b16 a[66:67], v25 offset:12928
s_waitcnt lgkmcnt(6)
v_mfma_f32_16x16x32_bf16 v[104:107], a[28:31], a[12:15], v[104:107]
ds_read_b64_tr_b16 a[68:69], v25 offset:12448
v_mfma_f32_16x16x32_bf16 v[120:123], a[32:35], a[12:15], v[120:123]
buffer_load_dwordx4 v20, s[20:23], s54 offen offset:2048 lds
v_mfma_f32_16x16x32_bf16 v[116:119], a[32:35], a[8:11], v[116:119]
ds_read_b64_tr_b16 a[70:71], v25 offset:12960
s_add_u32 s54, s54, 196608
v_mfma_f32_16x16x32_bf16 v[100:103], a[28:31], a[8:11], v[100:103]
ds_read_b128 a[60:63], v24 offset:11264
v_mfma_f32_16x16x32_bf16 v[96:99], a[28:31], a[4:7], v[96:99]
s_add_u32 m0, s55, 46080
v_mfma_f32_16x16x32_bf16 v[112:115], a[32:35], a[4:7], v[112:115]
buffer_load_dwordx4 v21, s[16:19], s52 offen sc1 lds
v_mfma_f32_16x16x32_bf16 v[108:111], a[32:35], a[0:3], v[108:111]
ds_read_b64_tr_b16 a[72:73], v25 offset:13440
v_mfma_f32_16x16x32_bf16 v[92:95], a[28:31], a[0:3], v[92:95]
ds_read_b64_tr_b16 a[74:75], v25 offset:13952
v_mfma_f32_16x16x32_bf16 v[124:127], a[0:3], a[36:39], v[124:127]
ds_read_b64_tr_b16 a[76:77], v25 offset:13472
v_mfma_f32_16x16x32_bf16 v[140:143], a[0:3], a[40:43], v[140:143]
buffer_load_dwordx4 v21, s[16:19], s52 offen offset:1024 sc1 lds
v_mfma_f32_16x16x32_bf16 v[144:147], a[4:7], a[40:43], v[144:147]
ds_read_b64_tr_b16 a[78:79], v25 offset:13984
v_mfma_f32_16x16x32_bf16 v[128:131], a[4:7], a[36:39], v[128:131]
ds_read_b64_tr_b16 a[80:81], v25 offset:14464
v_mfma_f32_16x16x32_bf16 v[132:135], a[8:11], a[36:39], v[132:135]
ds_read_b64_tr_b16 a[82:83], v25 offset:14976
v_mfma_f32_16x16x32_bf16 v[148:151], a[8:11], a[40:43], v[148:151]
buffer_load_dword v22, s[16:19], s52 offen offset:2048 sc1 lds
v_mfma_f32_16x16x32_bf16 v[152:155], a[12:15], a[40:43], v[152:155]
ds_read_b64_tr_b16 a[84:85], v25 offset:14496
s_add_u32 s52, s52, 0x20000
v_mfma_f32_16x16x32_bf16 v[136:139], a[12:15], a[36:39], v[136:139]
ds_read_b64_tr_b16 a[86:87], v25 offset:15008
v_mfma_f32_16x16x32_bf16 v[156:159], a[16:19], a[36:39], v[156:159]
v_mfma_f32_16x16x32_bf16 v[160:163], a[16:19], a[40:43], v[160:163]
s_waitcnt vmcnt(20) lgkmcnt(8)
s_barrier
v_mfma_f32_16x16x32_bf16 v[60:63], a[64:67], a[44:47], v[60:63]
ds_read_b128 a[0:3], v23 offset:18432
s_add_u32 m0, s56, 67584
v_mfma_f32_16x16x32_bf16 v[76:79], a[68:71], a[44:47], v[76:79]
buffer_load_dwordx4 v18, s[20:23], s54 offen lds
v_mfma_f32_16x16x32_bf16 v[80:83], a[68:71], a[48:51], v[80:83]
ds_read_b128 a[4:7], v23 offset:19456
v_add_f32 v164, v164, v172
v_mfma_f32_16x16x32_bf16 v[64:67], a[64:67], a[48:51], v[64:67]
ds_read_b128 a[8:11], v23 offset:20736
v_mfma_f32_16x16x32_bf16 v[68:71], a[64:67], a[52:55], v[68:71]
ds_read_b128 a[12:15], v23 offset:21760
v_mfma_f32_16x16x32_bf16 v[84:87], a[68:71], a[52:55], v[84:87]
buffer_load_dwordx4 v19, s[20:23], s54 offen offset:1024 lds
v_mfma_f32_16x16x32_bf16 v[88:91], a[68:71], a[56:59], v[88:91]
ds_read_b64_tr_b16 a[20:21], v25 offset:24832
v_mfma_f32_16x16x32_bf16 v[72:75], a[64:67], a[56:59], v[72:75]
ds_read_b64_tr_b16 a[22:23], v25 offset:25344
s_waitcnt lgkmcnt(6)
v_mfma_f32_16x16x32_bf16 v[104:107], a[72:75], a[56:59], v[104:107]
ds_read_b64_tr_b16 a[24:25], v25 offset:24864
v_add_f32 v165, v165, v173
v_mfma_f32_16x16x32_bf16 v[120:123], a[76:79], a[56:59], v[120:123]
buffer_load_dwordx4 v20, s[20:23], s54 offen offset:2048 lds
v_mfma_f32_16x16x32_bf16 v[116:119], a[76:79], a[52:55], v[116:119]
ds_read_b64_tr_b16 a[26:27], v25 offset:25376
s_add_u32 s54, s54, 196608
v_mfma_f32_16x16x32_bf16 v[100:103], a[72:75], a[52:55], v[100:103]
ds_read_b128 a[16:19], v24 offset:20480
v_mfma_f32_16x16x32_bf16 v[96:99], a[72:75], a[48:51], v[96:99]
s_add_u32 m0, s55, 0
v_mfma_f32_16x16x32_bf16 v[112:115], a[76:79], a[48:51], v[112:115]
buffer_load_dwordx4 v21, s[16:19], s52 offen sc1 lds
v_mfma_f32_16x16x32_bf16 v[108:111], a[76:79], a[44:47], v[108:111]
ds_read_b64_tr_b16 a[28:29], v25 offset:25856
v_add_f32 v166, v166, v174
v_mfma_f32_16x16x32_bf16 v[92:95], a[72:75], a[44:47], v[92:95]
ds_read_b64_tr_b16 a[30:31], v25 offset:26368
v_mfma_f32_16x16x32_bf16 v[124:127], a[44:47], a[80:83], v[124:127]
ds_read_b64_tr_b16 a[32:33], v25 offset:25888
v_mfma_f32_16x16x32_bf16 v[140:143], a[44:47], a[84:87], v[140:143]
buffer_load_dwordx4 v21, s[16:19], s52 offen offset:1024 sc1 lds
v_mfma_f32_16x16x32_bf16 v[144:147], a[48:51], a[84:87], v[144:147]
ds_read_b64_tr_b16 a[34:35], v25 offset:26400
v_mfma_f32_16x16x32_bf16 v[128:131], a[48:51], a[80:83], v[128:131]
ds_read_b64_tr_b16 a[36:37], v25 offset:26880
v_add_f32 v167, v167, v175
v_mfma_f32_16x16x32_bf16 v[132:135], a[52:55], a[80:83], v[132:135]
ds_read_b64_tr_b16 a[38:39], v25 offset:27392
v_mfma_f32_16x16x32_bf16 v[148:151], a[52:55], a[84:87], v[148:151]
buffer_load_dword v22, s[16:19], s52 offen offset:2048 sc1 lds
v_mfma_f32_16x16x32_bf16 v[152:155], a[56:59], a[84:87], v[152:155]
ds_read_b64_tr_b16 a[40:41], v25 offset:26912
s_add_u32 s52, s52, 0x20000
v_mfma_f32_16x16x32_bf16 v[136:139], a[56:59], a[80:83], v[136:139]
ds_read_b64_tr_b16 a[42:43], v25 offset:27424
v_mfma_f32_16x16x32_bf16 v[156:159], a[60:63], a[80:83], v[156:159]
v_mfma_f32_16x16x32_bf16 v[160:163], a[60:63], a[84:87], v[160:163]
s_waitcnt vmcnt(20) lgkmcnt(8)
s_barrier
v_mfma_f32_16x16x32_bf16 v[60:63], a[20:23], a[0:3], v[60:63]
ds_read_b128 a[44:47], v23 offset:27648
s_add_u32 m0, s56, 80000
v_mfma_f32_16x16x32_bf16 v[76:79], a[24:27], a[0:3], v[76:79]
buffer_load_dwordx4 v18, s[20:23], s54 offen lds
v_mfma_f32_16x16x32_bf16 v[80:83], a[24:27], a[4:7], v[80:83]
ds_read_b128 a[48:51], v23 offset:28672
v_mfma_f32_16x16x32_bf16 v[64:67], a[20:23], a[4:7], v[64:67]
ds_read_b128 a[52:55], v23 offset:29952
v_mfma_f32_16x16x32_bf16 v[68:71], a[20:23], a[8:11], v[68:71]
buffer_load_dwordx4 v19, s[20:23], s54 offen offset:1024 lds
v_mfma_f32_16x16x32_bf16 v[84:87], a[24:27], a[8:11], v[84:87]
ds_read_b128 a[56:59], v23 offset:30976
v_mfma_f32_16x16x32_bf16 v[88:91], a[24:27], a[12:15], v[88:91]
ds_read_b64_tr_b16 a[64:65], v25 offset:37248
v_mfma_f32_16x16x32_bf16 v[72:75], a[20:23], a[12:15], v[72:75]
ds_read_b64_tr_b16 a[66:67], v25 offset:37760
s_waitcnt lgkmcnt(6)
v_mfma_f32_16x16x32_bf16 v[104:107], a[28:31], a[12:15], v[104:107]
buffer_load_dwordx4 v20, s[20:23], s54 offen offset:2048 lds
v_mfma_f32_16x16x32_bf16 v[120:123], a[32:35], a[12:15], v[120:123]
ds_read_b64_tr_b16 a[68:69], v25 offset:37280
s_add_u32 s54, s54, 196608
v_mfma_f32_16x16x32_bf16 v[116:119], a[32:35], a[8:11], v[116:119]
ds_read_b64_tr_b16 a[70:71], v25 offset:37792
s_add_u32 m0, s55, 9216
v_mfma_f32_16x16x32_bf16 v[100:103], a[28:31], a[8:11], v[100:103]
buffer_load_dwordx4 v21, s[16:19], s52 offen sc1 lds
v_mfma_f32_16x16x32_bf16 v[96:99], a[28:31], a[4:7], v[96:99]
ds_read_b128 a[60:63], v24 offset:29696
v_mfma_f32_16x16x32_bf16 v[112:115], a[32:35], a[4:7], v[112:115]
ds_read_b64_tr_b16 a[72:73], v25 offset:38272
v_mfma_f32_16x16x32_bf16 v[108:111], a[32:35], a[0:3], v[108:111]
buffer_load_dwordx4 v21, s[16:19], s52 offen offset:1024 sc1 lds
v_mfma_f32_16x16x32_bf16 v[92:95], a[28:31], a[0:3], v[92:95]
ds_read_b64_tr_b16 a[74:75], v25 offset:38784
v_mfma_f32_16x16x32_bf16 v[124:127], a[0:3], a[36:39], v[124:127]
ds_read_b64_tr_b16 a[76:77], v25 offset:38304
v_mfma_f32_16x16x32_bf16 v[140:143], a[0:3], a[40:43], v[140:143]
ds_read_b64_tr_b16 a[78:79], v25 offset:38816
v_mfma_f32_16x16x32_bf16 v[144:147], a[4:7], a[40:43], v[144:147]
buffer_load_dword v22, s[16:19], s52 offen offset:2048 sc1 lds
v_mfma_f32_16x16x32_bf16 v[128:131], a[4:7], a[36:39], v[128:131]
ds_read_b64_tr_b16 a[80:81], v25 offset:39296
s_add_u32 s52, s52, 0x20000
v_mfma_f32_16x16x32_bf16 v[132:135], a[8:11], a[36:39], v[132:135]
ds_read_b64_tr_b16 a[82:83], v25 offset:39808
v_mfma_f32_16x16x32_bf16 v[148:151], a[8:11], a[40:43], v[148:151]
buffer_load_dwordx4 v[172:175], v26, s[16:19], s75 offen offset:1024 sc1
v_mfma_f32_16x16x32_bf16 v[152:155], a[12:15], a[40:43], v[152:155]
ds_read_b64_tr_b16 a[84:85], v25 offset:39328
s_add_u32 s75, s75, 2048
v_mfma_f32_16x16x32_bf16 v[136:139], a[12:15], a[36:39], v[136:139]
ds_read_b64_tr_b16 a[86:87], v25 offset:39840
v_mfma_f32_16x16x32_bf16 v[156:159], a[16:19], a[36:39], v[156:159]
v_mfma_f32_16x16x32_bf16 v[160:163], a[16:19], a[40:43], v[160:163]
s_waitcnt vmcnt(20) lgkmcnt(8)
s_barrier
v_mfma_f32_16x16x32_bf16 v[60:63], a[64:67], a[44:47], v[60:63]
ds_read_b128 a[0:3], v23 offset:36864
s_add_u32 m0, s56, 92416
v_mfma_f32_16x16x32_bf16 v[76:79], a[68:71], a[44:47], v[76:79]
buffer_load_dwordx4 v18, s[20:23], s54 offen lds
v_mfma_f32_16x16x32_bf16 v[80:83], a[68:71], a[48:51], v[80:83]
ds_read_b128 a[4:7], v23 offset:37888
v_mfma_f32_16x16x32_bf16 v[64:67], a[64:67], a[48:51], v[64:67]
ds_read_b128 a[8:11], v23 offset:39168
v_mfma_f32_16x16x32_bf16 v[68:71], a[64:67], a[52:55], v[68:71]
ds_read_b128 a[12:15], v23 offset:40192
v_mfma_f32_16x16x32_bf16 v[84:87], a[68:71], a[52:55], v[84:87]
buffer_load_dwordx4 v19, s[20:23], s54 offen offset:1024 lds
v_mfma_f32_16x16x32_bf16 v[88:91], a[68:71], a[56:59], v[88:91]
ds_read_b64_tr_b16 a[20:21], v25 offset:49664
v_mfma_f32_16x16x32_bf16 v[72:75], a[64:67], a[56:59], v[72:75]
ds_read_b64_tr_b16 a[22:23], v25 offset:50176
s_waitcnt lgkmcnt(6)
v_mfma_f32_16x16x32_bf16 v[104:107], a[72:75], a[56:59], v[104:107]
ds_read_b64_tr_b16 a[24:25], v25 offset:49696
v_mfma_f32_16x16x32_bf16 v[120:123], a[76:79], a[56:59], v[120:123]
buffer_load_dwordx4 v20, s[20:23], s54 offen offset:2048 lds
v_mfma_f32_16x16x32_bf16 v[116:119], a[76:79], a[52:55], v[116:119]
ds_read_b64_tr_b16 a[26:27], v25 offset:50208
s_add_u32 s54, s54, 196608
v_mfma_f32_16x16x32_bf16 v[100:103], a[72:75], a[52:55], v[100:103]
ds_read_b128 a[16:19], v24 offset:38912
v_mfma_f32_16x16x32_bf16 v[96:99], a[72:75], a[48:51], v[96:99]
s_add_u32 m0, s55, 18432
v_mfma_f32_16x16x32_bf16 v[112:115], a[76:79], a[48:51], v[112:115]
buffer_load_dwordx4 v21, s[16:19], s52 offen sc1 lds
v_mfma_f32_16x16x32_bf16 v[108:111], a[76:79], a[44:47], v[108:111]
ds_read_b64_tr_b16 a[28:29], v25 offset:50688
v_mfma_f32_16x16x32_bf16 v[92:95], a[72:75], a[44:47], v[92:95]
ds_read_b64_tr_b16 a[30:31], v25 offset:51200
v_mfma_f32_16x16x32_bf16 v[124:127], a[44:47], a[80:83], v[124:127]
ds_read_b64_tr_b16 a[32:33], v25 offset:50720
v_mfma_f32_16x16x32_bf16 v[140:143], a[44:47], a[84:87], v[140:143]
buffer_load_dwordx4 v21, s[16:19], s52 offen offset:1024 sc1 lds
v_mfma_f32_16x16x32_bf16 v[144:147], a[48:51], a[84:87], v[144:147]
ds_read_b64_tr_b16 a[34:35], v25 offset:51232
v_mfma_f32_16x16x32_bf16 v[128:131], a[48:51], a[80:83], v[128:131]
ds_read_b64_tr_b16 a[36:37], v25 offset:51712
v_mfma_f32_16x16x32_bf16 v[132:135], a[52:55], a[80:83], v[132:135]
ds_read_b64_tr_b16 a[38:39], v25 offset:52224
v_mfma_f32_16x16x32_bf16 v[148:151], a[52:55], a[84:87], v[148:151]
buffer_load_dword v22, s[16:19], s52 offen offset:2048 sc1 lds
v_mfma_f32_16x16x32_bf16 v[152:155], a[56:59], a[84:87], v[152:155]
ds_read_b64_tr_b16 a[40:41], v25 offset:51744
s_add_u32 s52, s52, 0x20000
v_mfma_f32_16x16x32_bf16 v[136:139], a[56:59], a[80:83], v[136:139]
ds_read_b64_tr_b16 a[42:43], v25 offset:52256
v_mfma_f32_16x16x32_bf16 v[156:159], a[60:63], a[80:83], v[156:159]
s_add_u32 s15, s15, 1
v_mfma_f32_16x16x32_bf16 v[160:163], a[60:63], a[84:87], v[160:163]
s_cbranch_scc0 .Lk63
s_waitcnt vmcnt(19) lgkmcnt(8)
s_barrier
v_mfma_f32_16x16x32_bf16 v[60:63], a[20:23], a[0:3], v[60:63]
ds_read_b128 a[44:47], v23 offset:46080
s_add_u32 m0, s56, 104832
v_mfma_f32_16x16x32_bf16 v[76:79], a[24:27], a[0:3], v[76:79]
buffer_load_dwordx4 v18, s[20:23], s54 offen lds
v_mfma_f32_16x16x32_bf16 v[80:83], a[24:27], a[4:7], v[80:83]
ds_read_b128 a[48:51], v23 offset:47104
.Lpad15:
s_cbranch_execz .Lnopoll58r
v_add_f32 v164, v164, v168
v_mfma_f32_16x16x32_bf16 v[64:67], a[20:23], a[4:7], v[64:67]
ds_read_b128 a[52:55], v23 offset:48384
v_mfma_f32_16x16x32_bf16 v[68:71], a[20:23], a[8:11], v[68:71]
ds_read_b128 a[56:59], v23 offset:49408
v_mfma_f32_16x16x32_bf16 v[84:87], a[24:27], a[8:11], v[84:87]
buffer_load_dwordx4 v19, s[20:23], s54 offen offset:1024 lds
v_mfma_f32_16x16x32_bf16 v[88:91], a[24:27], a[12:15], v[88:91]
ds_read_b64_tr_b16 a[64:65], v25 offset:62080
v_mfma_f32_16x16x32_bf16 v[72:75], a[20:23], a[12:15], v[72:75]
ds_read_b64_tr_b16 a[66:67], v25 offset:62592
s_waitcnt lgkmcnt(6)
v_mfma_f32_16x16x32_bf16 v[104:107], a[28:31], a[12:15], v[104:107]
ds_read_b64_tr_b16 a[68:69], v25 offset:62112
v_add_f32 v165, v165, v169
v_mfma_f32_16x16x32_bf16 v[120:123], a[32:35], a[12:15], v[120:123]
buffer_load_dwordx4 v20, s[20:23], s54 offen offset:2048 lds
v_mfma_f32_16x16x32_bf16 v[116:119], a[32:35], a[8:11], v[116:119]
ds_read_b64_tr_b16 a[70:71], v25 offset:62624
s_add_u32 s54, s54, 196608
v_mfma_f32_16x16x32_bf16 v[100:103], a[28:31], a[8:11], v[100:103]
ds_read_b128 a[60:63], v24 offset:48128
v_mfma_f32_16x16x32_bf16 v[96:99], a[28:31], a[4:7], v[96:99]
s_add_u32 m0, s55, 27648
v_mfma_f32_16x16x32_bf16 v[112:115], a[32:35], a[4:7], v[112:115]
buffer_load_dwordx4 v21, s[16:19], s52 offen sc1 lds
v_mfma_f32_16x16x32_bf16 v[108:111], a[32:35], a[0:3], v[108:111]
ds_read_b64_tr_b16 a[72:73], v25 offset:63104
v_add_f32 v166, v166, v170
v_mfma_f32_16x16x32_bf16 v[92:95], a[28:31], a[0:3], v[92:95]
ds_read_b64_tr_b16 a[74:75], v25 offset:63616
v_mfma_f32_16x16x32_bf16 v[124:127], a[0:3], a[36:39], v[124:127]
ds_read_b64_tr_b16 a[76:77], v25 offset:63136
v_mfma_f32_16x16x32_bf16 v[140:143], a[0:3], a[40:43], v[140:143]
buffer_load_dwordx4 v21, s[16:19], s52 offen offset:1024 sc1 lds
v_mfma_f32_16x16x32_bf16 v[144:147], a[4:7], a[40:43], v[144:147]
ds_read_b64_tr_b16 a[78:79], v25 offset:63648
v_mfma_f32_16x16x32_bf16 v[128:131], a[4:7], a[36:39], v[128:131]
ds_read_b64_tr_b16 a[80:81], v25 offset:64128
v_add_f32 v167, v167, v171
v_mfma_f32_16x16x32_bf16 v[132:135], a[8:11], a[36:39], v[132:135]
ds_read_b64_tr_b16 a[82:83], v25 offset:64640
v_mfma_f32_16x16x32_bf16 v[148:151], a[8:11], a[40:43], v[148:151]
buffer_load_dword v22, s[16:19], s52 offen offset:2048 sc1 lds
v_mfma_f32_16x16x32_bf16 v[152:155], a[12:15], a[40:43], v[152:155]
ds_read_b64_tr_b16 a[84:85], v25 offset:64160
s_add_u32 s52, s52, 0x20000
v_mfma_f32_16x16x32_bf16 v[136:139], a[12:15], a[36:39], v[136:139]
ds_read_b64_tr_b16 a[86:87], v25 offset:64672
v_mfma_f32_16x16x32_bf16 v[156:159], a[16:19], a[36:39], v[156:159]
v_mfma_f32_16x16x32_bf16 v[160:163], a[16:19], a[40:43], v[160:163]
s_waitcnt vmcnt(19) lgkmcnt(8)
s_barrier
v_mfma_f32_16x16x32_bf16 v[60:63], a[64:67], a[44:47], v[60:63]
ds_read_b128 a[0:3], v23
s_add_u32 m0, s56, 117248
v_mfma_f32_16x16x32_bf16 v[76:79], a[68:71], a[44:47], v[76:79]
buffer_load_dwordx4 v18, s[20:23], s54 offen lds
v_mfma_f32_16x16x32_bf16 v[80:83], a[68:71], a[48:51], v[80:83]
ds_read_b128 a[4:7], v23 offset:1024
v_mfma_f32_16x16x32_bf16 v[64:67], a[64:67], a[48:51], v[64:67]
ds_read_b128 a[8:11], v23 offset:2304
v_mfma_f32_16x16x32_bf16 v[68:71], a[64:67], a[52:55], v[68:71]
ds_read_b128 a[12:15], v23 offset:3328
v_mfma_f32_16x16x32_bf16 v[84:87], a[68:71], a[52:55], v[84:87]
buffer_load_dwordx4 v19, s[20:23], s54 offen offset:1024 lds
v_mfma_f32_16x16x32_bf16 v[88:91], a[68:71], a[56:59], v[88:91]
ds_read_b64_tr_b16 a[20:21], v25
v_mfma_f32_16x16x32_bf16 v[72:75], a[64:67], a[56:59], v[72:75]
ds_read_b64_tr_b16 a[22:23], v25 offset:512
s_waitcnt lgkmcnt(6)
v_mfma_f32_16x16x32_bf16 v[104:107], a[72:75], a[56:59], v[104:107]
ds_read_b64_tr_b16 a[24:25], v25 offset:32
v_mfma_f32_16x16x32_bf16 v[120:123], a[76:79], a[56:59], v[120:123]
buffer_load_dwordx4 v20, s[20:23], s54 offen offset:2048 lds
v_mfma_f32_16x16x32_bf16 v[116:119], a[76:79], a[52:55], v[116:119]
ds_read_b64_tr_b16 a[26:27], v25 offset:544
s_add_u32 s54, s54, 196608
v_mfma_f32_16x16x32_bf16 v[100:103], a[72:75], a[52:55], v[100:103]
ds_read_b128 a[16:19], v24 offset:2048
v_mfma_f32_16x16x32_bf16 v[96:99], a[72:75], a[48:51], v[96:99]
s_add_u32 m0, s55, 36864
v_mfma_f32_16x16x32_bf16 v[112:115], a[76:79], a[48:51], v[112:115]
buffer_load_dwordx4 v21, s[16:19], s52 offen sc1 lds
v_mfma_f32_16x16x32_bf16 v[108:111], a[76:79], a[44:47], v[108:111]
ds_read_b64_tr_b16 a[28:29], v25 offset:1024
v_mfma_f32_16x16x32_bf16 v[92:95], a[72:75], a[44:47], v[92:95]
ds_read_b64_tr_b16 a[30:31], v25 offset:1536
v_mfma_f32_16x16x32_bf16 v[124:127], a[44:47], a[80:83], v[124:127]
ds_read_b64_tr_b16 a[32:33], v25 offset:1056
v_mfma_f32_16x16x32_bf16 v[140:143], a[44:47], a[84:87], v[140:143]
buffer_load_dwordx4 v21, s[16:19], s52 offen offset:1024 sc1 lds
v_mfma_f32_16x16x32_bf16 v[144:147], a[48:51], a[84:87], v[144:147]
ds_read_b64_tr_b16 a[34:35], v25 offset:1568
v_mfma_f32_16x16x32_bf16 v[128:131], a[48:51], a[80:83], v[128:131]
ds_read_b64_tr_b16 a[36:37], v25 offset:2048
v_mfma_f32_16x16x32_bf16 v[132:135], a[52:55], a[80:83], v[132:135]
ds_read_b64_tr_b16 a[38:39], v25 offset:2560
v_mfma_f32_16x16x32_bf16 v[148:151], a[52:55], a[84:87], v[148:151]
buffer_load_dword v22, s[16:19], s52 offen offset:2048 sc1 lds
v_mfma_f32_16x16x32_bf16 v[152:155], a[56:59], a[84:87], v[152:155]
ds_read_b64_tr_b16 a[40:41], v25 offset:2080
s_add_u32 s52, s52, 0x20000
v_mfma_f32_16x16x32_bf16 v[136:139], a[56:59], a[80:83], v[136:139]
ds_read_b64_tr_b16 a[42:43], v25 offset:2592
v_mfma_f32_16x16x32_bf16 v[156:159], a[60:63], a[80:83], v[156:159]
v_mfma_f32_16x16x32_bf16 v[160:163], a[60:63], a[84:87], v[160:163]
s_waitcnt vmcnt(19) lgkmcnt(8)
s_barrier
v_mfma_f32_16x16x32_bf16 v[60:63], a[20:23], a[0:3], v[60:63]
ds_read_b128 a[44:47], v23 offset:9216
s_add_u32 m0, s56, 129664
v_mfma_f32_16x16x32_bf16 v[76:79], a[24:27], a[0:3], v[76:79]
buffer_load_dwordx4 v18, s[20:23], s54 offen lds
v_mfma_f32_16x16x32_bf16 v[80:83], a[24:27], a[4:7], v[80:83]
ds_read_b128 a[48:51], v23 offset:10240
s_waitcnt vmcnt(19)
v_add_f32 v164, v164, v172
v_mfma_f32_16x16x32_bf16 v[64:67], a[20:23], a[4:7], v[64:67]
ds_read_b128 a[52:55], v23 offset:11520
v_mfma_f32_16x16x32_bf16 v[68:71], a[20:23], a[8:11], v[68:71]
ds_read_b128 a[56:59], v23 offset:12544
v_mfma_f32_16x16x32_bf16 v[84:87], a[24:27], a[8:11], v[84:87]
buffer_load_dwordx4 v19, s[20:23], s54 offen offset:1024 lds
v_mfma_f32_16x16x32_bf16 v[88:91], a[24:27], a[12:15], v[88:91]
ds_read_b64_tr_b16 a[64:65], v25 offset:12416
v_mfma_f32_16x16x32_bf16 v[72:75], a[20:23], a[12:15], v[72:75]
ds_read_b64_tr_b16 a[66:67], v25 offset:12928
s_waitcnt lgkmcnt(6)
v_mfma_f32_16x16x32_bf16 v[104:107], a[28:31], a[12:15], v[104:107]
ds_read_b64_tr_b16 a[68:69], v25 offset:12448
v_add_f32 v165, v165, v173
v_mfma_f32_16x16x32_bf16 v[120:123], a[32:35], a[12:15], v[120:123]
buffer_load_dwordx4 v20, s[20:23], s54 offen offset:2048 lds
v_mfma_f32_16x16x32_bf16 v[116:119], a[32:35], a[8:11], v[116:119]
ds_read_b64_tr_b16 a[70:71], v25 offset:12960
s_add_u32 s54, s54, 196608
v_mfma_f32_16x16x32_bf16 v[100:103], a[28:31], a[8:11], v[100:103]
ds_read_b128 a[60:63], v24 offset:11264
v_mfma_f32_16x16x32_bf16 v[96:99], a[28:31], a[4:7], v[96:99]
s_add_u32 m0, s55, 46080
v_mfma_f32_16x16x32_bf16 v[112:115], a[32:35], a[4:7], v[112:115]
buffer_load_dwordx4 v21, s[16:19], s52 offen sc1 lds
v_mfma_f32_16x16x32_bf16 v[108:111], a[32:35], a[0:3], v[108:111]
ds_read_b64_tr_b16 a[72:73], v25 offset:13440
v_add_f32 v166, v166, v174
v_mfma_f32_16x16x32_bf16 v[92:95], a[28:31], a[0:3], v[92:95]
ds_read_b64_tr_b16 a[74:75], v25 offset:13952
v_mfma_f32_16x16x32_bf16 v[124:127], a[0:3], a[36:39], v[124:127]
ds_read_b64_tr_b16 a[76:77], v25 offset:13472
v_mfma_f32_16x16x32_bf16 v[140:143], a[0:3], a[40:43], v[140:143]
buffer_load_dwordx4 v21, s[16:19], s52 offen offset:1024 sc1 lds
v_mfma_f32_16x16x32_bf16 v[144:147], a[4:7], a[40:43], v[144:147]
ds_read_b64_tr_b16 a[78:79], v25 offset:13984
v_mfma_f32_16x16x32_bf16 v[128:131], a[4:7], a[36:39], v[128:131]
ds_read_b64_tr_b16 a[80:81], v25 offset:14464
v_add_f32 v167, v167, v175
v_mfma_f32_16x16x32_bf16 v[132:135], a[8:11], a[36:39], v[132:135]
ds_read_b64_tr_b16 a[82:83], v25 offset:14976
v_mfma_f32_16x16x32_bf16 v[148:151], a[8:11], a[40:43], v[148:151]
buffer_load_dword v22, s[16:19], s52 offen offset:2048 sc1 lds
v_mfma_f32_16x16x32_bf16 v[152:155], a[12:15], a[40:43], v[152:155]
ds_read_b64_tr_b16 a[84:85], v25 offset:14496
s_add_u32 s52, s52, 0x20000
v_mfma_f32_16x16x32_bf16 v[136:139], a[12:15], a[36:39], v[136:139]
ds_read_b64_tr_b16 a[86:87], v25 offset:15008
v_mfma_f32_16x16x32_bf16 v[156:159], a[16:19], a[36:39], v[156:159]
v_mfma_f32_16x16x32_bf16 v[160:163], a[16:19], a[40:43], v[160:163]
s_waitcnt vmcnt(18) lgkmcnt(8)
s_barrier
v_mfma_f32_16x16x32_bf16 v[60:63], a[64:67], a[44:47], v[60:63]
ds_read_b128 a[0:3], v23 offset:18432
s_add_u32 m0, s59, 0
s_mov_b32 s58, 1048576
v_mfma_f32_16x16x32_bf16 v[76:79], a[68:71], a[44:47], v[76:79]
buffer_load_dwordx4 v5, s[24:27], s58 offen lds
v_mfma_f32_16x16x32_bf16 v[80:83], a[68:71], a[48:51], v[80:83]
ds_read_b128 a[4:7], v23 offset:19456
v_permlane32_swap_b32 v164, v166
v_mfma_f32_16x16x32_bf16 v[64:67], a[64:67], a[48:51], v[64:67]
ds_read_b128 a[8:11], v23 offset:20736
v_mfma_f32_16x16x32_bf16 v[68:71], a[64:67], a[52:55], v[68:71]
ds_read_b128 a[12:15], v23 offset:21760
v_permlane32_swap_b32 v165, v167
v_mfma_f32_16x16x32_bf16 v[84:87], a[68:71], a[52:55], v[84:87]
buffer_load_dwordx4 v6, s[24:27], s58 offen offset:1024 lds
v_mfma_f32_16x16x32_bf16 v[88:91], a[68:71], a[56:59], v[88:91]
ds_read_b64_tr_b16 a[20:21], v25 offset:24832
v_mfma_f32_16x16x32_bf16 v[72:75], a[64:67], a[56:59], v[72:75]
v_add_f32 v164, v164, v166
s_waitcnt lgkmcnt(5)
v_mfma_f32_16x16x32_bf16 v[104:107], a[72:75], a[56:59], v[104:107]
ds_read_b64_tr_b16 a[22:23], v25 offset:25344
s_add_u32 m0, s59, 58240
s_mov_b32 s58, 1966080
v_mfma_f32_16x16x32_bf16 v[120:123], a[76:79], a[56:59], v[120:123]
buffer_load_dwordx4 v5, s[24:27], s58 offen lds
v_mfma_f32_16x16x32_bf16 v[116:119], a[76:79], a[52:55], v[116:119]
ds_read_b64_tr_b16 a[24:25], v25 offset:24864
v_add_f32 v165, v165, v167
v_mfma_f32_16x16x32_bf16 v[100:103], a[72:75], a[52:55], v[100:103]
ds_read_b64_tr_b16 a[26:27], v25 offset:25376
v_mfma_f32_16x16x32_bf16 v[96:99], a[72:75], a[48:51], v[96:99]
ds_read_b128 a[16:19], v24 offset:20480
v_mfma_f32_16x16x32_bf16 v[112:115], a[76:79], a[48:51], v[112:115]
buffer_load_dwordx4 v6, s[24:27], s58 offen offset:1024 lds
v_mfma_f32_16x16x32_bf16 v[108:111], a[76:79], a[44:47], v[108:111]
ds_read_b64_tr_b16 a[28:29], v25 offset:25856
v_mul_f32 v164, 0xba800000, v164
v_mfma_f32_16x16x32_bf16 v[92:95], a[72:75], a[44:47], v[92:95]
ds_read_b64_tr_b16 a[30:31], v25 offset:26368
v_mfma_f32_16x16x32_bf16 v[124:127], a[44:47], a[80:83], v[124:127]
s_add_u32 m0, s59, 66560
s_mov_b32 s58, 0
v_mul_f32 v165, 0x3a800000, v165
v_mfma_f32_16x16x32_bf16 v[140:143], a[44:47], a[84:87], v[140:143]
buffer_load_dwordx4 v5, s[24:27], s58 offen lds
v_mfma_f32_16x16x32_bf16 v[144:147], a[48:51], a[84:87], v[144:147]
ds_read_b64_tr_b16 a[32:33], v25 offset:25888
v_mfma_f32_16x16x32_bf16 v[128:131], a[48:51], a[80:83], v[128:131]
ds_read_b64_tr_b16 a[34:35], v25 offset:26400
v_fma_f32 v165, -v164, v164, v165
v_mfma_f32_16x16x32_bf16 v[132:135], a[52:55], a[80:83], v[132:135]
ds_read_b64_tr_b16 a[36:37], v25 offset:26880
v_mfma_f32_16x16x32_bf16 v[148:151], a[52:55], a[84:87], v[148:151]
buffer_load_dwordx4 v6, s[24:27], s58 offen offset:1024 lds
v_mfma_f32_16x16x32_bf16 v[152:155], a[56:59], a[84:87], v[152:155]
ds_read_b64_tr_b16 a[38:39], v25 offset:27392
v_max_f32 v165, 0, v165
v_mfma_f32_16x16x32_bf16 v[136:139], a[56:59], a[80:83], v[136:139]
ds_read_b64_tr_b16 a[40:41], v25 offset:26912
v_mfma_f32_16x16x32_bf16 v[156:159], a[60:63], a[80:83], v[156:159]
ds_read_b64_tr_b16 a[42:43], v25 offset:27424
v_mfma_f32_16x16x32_bf16 v[160:163], a[60:63], a[84:87], v[160:163]
s_waitcnt vmcnt(18) lgkmcnt(8)
s_barrier
v_mfma_f32_16x16x32_bf16 v[60:63], a[20:23], a[0:3], v[60:63]
ds_read_b128 a[44:47], v23 offset:27648
s_add_u32 m0, s59, 8320
s_mov_b32 s58, 1179648
v_mfma_f32_16x16x32_bf16 v[76:79], a[24:27], a[0:3], v[76:79]
buffer_load_dwordx4 v5, s[24:27], s58 offen lds
v_mfma_f32_16x16x32_bf16 v[80:83], a[24:27], a[4:7], v[80:83]
ds_read_b128 a[48:51], v23 offset:28672
v_add_f32 v165, 0x3727c5ac, v165
v_mfma_f32_16x16x32_bf16 v[64:67], a[20:23], a[4:7], v[64:67]
ds_read_b128 a[52:55], v23 offset:29952
v_mfma_f32_16x16x32_bf16 v[68:71], a[20:23], a[8:11], v[68:71]
ds_read_b128 a[56:59], v23 offset:30976
v_mfma_f32_16x16x32_bf16 v[84:87], a[24:27], a[8:11], v[84:87]
buffer_load_dwordx4 v6, s[24:27], s58 offen offset:1024 lds
v_mfma_f32_16x16x32_bf16 v[88:91], a[24:27], a[12:15], v[88:91]
ds_read_b64_tr_b16 a[64:65], v25 offset:37248
v_mfma_f32_16x16x32_bf16 v[72:75], a[20:23], a[12:15], v[72:75]
v_rsq_f32 v166, v165
s_waitcnt lgkmcnt(5)
v_mfma_f32_16x16x32_bf16 v[104:107], a[28:31], a[12:15], v[104:107]
ds_read_b64_tr_b16 a[66:67], v25 offset:37760
s_add_u32 m0, s59, 74880
s_mov_b32 s58, 131072
v_mfma_f32_16x16x32_bf16 v[120:123], a[32:35], a[12:15], v[120:123]
buffer_load_dwordx4 v5, s[24:27], s58 offen lds
v_mfma_f32_16x16x32_bf16 v[116:119], a[32:35], a[8:11], v[116:119]
ds_read_b64_tr_b16 a[68:69], v25 offset:37280
v_mfma_f32_16x16x32_bf16 v[100:103], a[28:31], a[8:11], v[100:103]
ds_read_b64_tr_b16 a[70:71], v25 offset:37792
v_mfma_f32_16x16x32_bf16 v[96:99], a[28:31], a[4:7], v[96:99]
ds_read_b128 a[60:63], v24 offset:29696
v_mfma_f32_16x16x32_bf16 v[112:115], a[32:35], a[4:7], v[112:115]
buffer_load_dwordx4 v6, s[24:27], s58 offen offset:1024 lds
v_mfma_f32_16x16x32_bf16 v[108:111], a[32:35], a[0:3], v[108:111]
ds_read_b64_tr_b16 a[72:73], v25 offset:38272
v_mov_b32 v165, v166
v_mfma_f32_16x16x32_bf16 v[92:95], a[28:31], a[0:3], v[92:95]
ds_read_b64_tr_b16 a[74:75], v25 offset:38784
v_mfma_f32_16x16x32_bf16 v[124:127], a[0:3], a[36:39], v[124:127]
s_add_u32 m0, s59, 83200
s_mov_b32 s58, 262144
v_mfma_f32_16x16x32_bf16 v[140:143], a[0:3], a[40:43], v[140:143]
buffer_load_dwordx4 v5, s[24:27], s58 offen lds
v_mfma_f32_16x16x32_bf16 v[144:147], a[4:7], a[40:43], v[144:147]
ds_read_b64_tr_b16 a[76:77], v25 offset:38304
v_mfma_f32_16x16x32_bf16 v[128:131], a[4:7], a[36:39], v[128:131]
ds_read_b64_tr_b16 a[78:79], v25 offset:38816
v_mul_f32 v166, 0x3e8293ee, v166
v_mfma_f32_16x16x32_bf16 v[132:135], a[8:11], a[36:39], v[132:135]
ds_read_b64_tr_b16 a[80:81], v25 offset:39296
v_mfma_f32_16x16x32_bf16 v[148:151], a[8:11], a[40:43], v[148:151]
buffer_load_dwordx4 v6, s[24:27], s58 offen offset:1024 lds
v_mfma_f32_16x16x32_bf16 v[152:155], a[12:15], a[40:43], v[152:155]
ds_read_b64_tr_b16 a[82:83], v25 offset:39808
v_mfma_f32_16x16x32_bf16 v[136:139], a[12:15], a[36:39], v[136:139]
ds_read_b64_tr_b16 a[84:85], v25 offset:39328
v_mfma_f32_16x16x32_bf16 v[156:159], a[16:19], a[36:39], v[156:159]
ds_read_b64_tr_b16 a[86:87], v25 offset:39840
v_mfma_f32_16x16x32_bf16 v[160:163], a[16:19], a[40:43], v[160:163]
s_waitcnt vmcnt(18) lgkmcnt(8)
s_barrier
v_mfma_f32_16x16x32_bf16 v[60:63], a[64:67], a[44:47], v[60:63]
s_add_u32 m0, s59, 16640
s_mov_b32 s58, 1310720
ds_write_b128 v7, v[164:167]
v_mfma_f32_16x16x32_bf16 v[76:79], a[68:71], a[44:47], v[76:79]
buffer_load_dwordx4 v5, s[24:27], s58 offen lds
v_mfma_f32_16x16x32_bf16 v[80:83], a[68:71], a[48:51], v[80:83]
ds_read_b128 a[0:3], v23 offset:36864
v_mfma_f32_16x16x32_bf16 v[64:67], a[64:67], a[48:51], v[64:67]
ds_read_b128 a[4:7], v23 offset:37888
v_mfma_f32_16x16x32_bf16 v[68:71], a[64:67], a[52:55], v[68:71]
ds_read_b128 a[8:11], v23 offset:39168
v_mfma_f32_16x16x32_bf16 v[84:87], a[68:71], a[52:55], v[84:87]
ds_read_b128 a[12:15], v23 offset:40192
v_mfma_f32_16x16x32_bf16 v[88:91], a[68:71], a[56:59], v[88:91]
ds_read_b64_tr_b16 a[20:21], v25 offset:49664
v_mfma_f32_16x16x32_bf16 v[72:75], a[64:67], a[56:59], v[72:75]
ds_read_b64_tr_b16 a[22:23], v25 offset:50176
s_waitcnt lgkmcnt(7)
v_mfma_f32_16x16x32_bf16 v[104:107], a[72:75], a[56:59], v[104:107]
buffer_load_dwordx4 v6, s[24:27], s58 offen offset:1024 lds
v_mfma_f32_16x16x32_bf16 v[120:123], a[76:79], a[56:59], v[120:123]
ds_read_b64_tr_b16 a[24:25], v25 offset:49696
v_mfma_f32_16x16x32_bf16 v[116:119], a[76:79], a[52:55], v[116:119]
ds_read_b64_tr_b16 a[26:27], v25 offset:50208
ds_write_b32 v17, v164
v_mfma_f32_16x16x32_bf16 v[100:103], a[72:75], a[52:55], v[100:103]
ds_read_b128 a[16:19], v24 offset:38912
v_mfma_f32_16x16x32_bf16 v[96:99], a[72:75], a[48:51], v[96:99]
s_add_u32 m0, s59, 91520
s_mov_b32 s58, 393216
v_mfma_f32_16x16x32_bf16 v[112:115], a[76:79], a[48:51], v[112:115]
buffer_load_dwordx4 v5, s[24:27], s58 offen lds
v_mfma_f32_16x16x32_bf16 v[108:111], a[76:79], a[44:47], v[108:111]
v_mfma_f32_16x16x32_bf16 v[92:95], a[72:75], a[44:47], v[92:95]
ds_read_b64_tr_b16 a[28:29], v25 offset:50688
v_mfma_f32_16x16x32_bf16 v[124:127], a[44:47], a[80:83], v[124:127]
ds_read_b64_tr_b16 a[30:31], v25 offset:51200
v_mfma_f32_16x16x32_bf16 v[140:143], a[44:47], a[84:87], v[140:143]
ds_read_b64_tr_b16 a[32:33], v25 offset:50720
ds_write_b32 v17, v165 offset:1024
v_mfma_f32_16x16x32_bf16 v[144:147], a[48:51], a[84:87], v[144:147]
ds_read_b64_tr_b16 a[34:35], v25 offset:51232
v_mfma_f32_16x16x32_bf16 v[128:131], a[48:51], a[80:83], v[128:131]
buffer_load_dwordx4 v6, s[24:27], s58 offen offset:1024 lds
v_mfma_f32_16x16x32_bf16 v[132:135], a[52:55], a[80:83], v[132:135]
ds_read_b64_tr_b16 a[36:37], v25 offset:51712
v_mfma_f32_16x16x32_bf16 v[148:151], a[52:55], a[84:87], v[148:151]
ds_read_b64_tr_b16 a[38:39], v25 offset:52224
v_mfma_f32_16x16x32_bf16 v[152:155], a[56:59], a[84:87], v[152:155]
ds_read_b64_tr_b16 a[40:41], v25 offset:51744
v_mfma_f32_16x16x32_bf16 v[136:139], a[56:59], a[80:83], v[136:139]
ds_read_b64_tr_b16 a[42:43], v25 offset:52256
v_mfma_f32_16x16x32_bf16 v[156:159], a[60:63], a[80:83], v[156:159]
v_mfma_f32_16x16x32_bf16 v[160:163], a[60:63], a[84:87], v[160:163]
s_waitcnt vmcnt(16) lgkmcnt(9)
s_barrier
v_mfma_f32_16x16x32_bf16 v[60:63], a[20:23], a[0:3], v[60:63]
ds_read_b128 a[44:47], v23 offset:46080
s_add_u32 m0, s59, 24960
s_mov_b32 s58, 1441792
v_mfma_f32_16x16x32_bf16 v[76:79], a[24:27], a[0:3], v[76:79]
buffer_load_dwordx4 v5, s[24:27], s58 offen lds
v_mfma_f32_16x16x32_bf16 v[80:83], a[24:27], a[4:7], v[80:83]
ds_read_b128 a[48:51], v23 offset:47104
v_mfma_f32_16x16x32_bf16 v[64:67], a[20:23], a[4:7], v[64:67]
ds_read_b128 a[52:55], v23 offset:48384
v_mfma_f32_16x16x32_bf16 v[68:71], a[20:23], a[8:11], v[68:71]
ds_read_b128 a[56:59], v23 offset:49408
v_mfma_f32_16x16x32_bf16 v[84:87], a[24:27], a[8:11], v[84:87]
buffer_load_dwordx4 v6, s[24:27], s58 offen offset:1024 lds
v_mfma_f32_16x16x32_bf16 v[88:91], a[24:27], a[12:15], v[88:91]
ds_read_b64_tr_b16 a[64:65], v25 offset:62080
v_mfma_f32_16x16x32_bf16 v[72:75], a[20:23], a[12:15], v[72:75]
s_waitcnt lgkmcnt(5)
v_mfma_f32_16x16x32_bf16 v[104:107], a[28:31], a[12:15], v[104:107]
ds_read_b64_tr_b16 a[66:67], v25 offset:62592
s_add_u32 m0, s59, 99840
s_mov_b32 s58, 524288
v_mfma_f32_16x16x32_bf16 v[120:123], a[32:35], a[12:15], v[120:123]
buffer_load_dwordx4 v5, s[24:27], s58 offen lds
v_mfma_f32_16x16x32_bf16 v[116:119], a[32:35], a[8:11], v[116:119]
ds_read_b64_tr_b16 a[68:69], v25 offset:62112
v_mfma_f32_16x16x32_bf16 v[100:103], a[28:31], a[8:11], v[100:103]
ds_read_b64_tr_b16 a[70:71], v25 offset:62624
v_mfma_f32_16x16x32_bf16 v[96:99], a[28:31], a[4:7], v[96:99]
ds_read_b128 a[60:63], v24 offset:48128
v_mfma_f32_16x16x32_bf16 v[112:115], a[32:35], a[4:7], v[112:115]
buffer_load_dwordx4 v6, s[24:27], s58 offen offset:1024 lds
v_mfma_f32_16x16x32_bf16 v[108:111], a[32:35], a[0:3], v[108:111]
ds_read_b64_tr_b16 a[72:73], v25 offset:63104
v_mfma_f32_16x16x32_bf16 v[92:95], a[28:31], a[0:3], v[92:95]
ds_read_b64_tr_b16 a[74:75], v25 offset:63616
v_mfma_f32_16x16x32_bf16 v[124:127], a[0:3], a[36:39], v[124:127]
s_add_u32 m0, s59, 108160
s_mov_b32 s58, 655360
v_mfma_f32_16x16x32_bf16 v[140:143], a[0:3], a[40:43], v[140:143]
buffer_load_dwordx4 v5, s[24:27], s58 offen lds
v_mfma_f32_16x16x32_bf16 v[144:147], a[4:7], a[40:43], v[144:147]
ds_read_b64_tr_b16 a[76:77], v25 offset:63136
v_mfma_f32_16x16x32_bf16 v[128:131], a[4:7], a[36:39], v[128:131]
ds_read_b64_tr_b16 a[78:79], v25 offset:63648
v_mfma_f32_16x16x32_bf16 v[132:135], a[8:11], a[36:39], v[132:135]
ds_read_b64_tr_b16 a[80:81], v25 offset:64128
v_mfma_f32_16x16x32_bf16 v[148:151], a[8:11], a[40:43], v[148:151]
buffer_load_dwordx4 v6, s[24:27], s58 offen offset:1024 lds
v_mfma_f32_16x16x32_bf16 v[152:155], a[12:15], a[40:43], v[152:155]
ds_read_b64_tr_b16 a[82:83], v25 offset:64640
v_mfma_f32_16x16x32_bf16 v[136:139], a[12:15], a[36:39], v[136:139]
ds_read_b64_tr_b16 a[84:85], v25 offset:64160
v_mfma_f32_16x16x32_bf16 v[156:159], a[16:19], a[36:39], v[156:159]
ds_read_b64_tr_b16 a[86:87], v25 offset:64672
v_mfma_f32_16x16x32_bf16 v[160:163], a[16:19], a[40:43], v[160:163]
s_waitcnt lgkmcnt(0)
s_barrier
v_mfma_f32_16x16x32_bf16 v[156:159], a[60:63], a[80:83], v[156:159]
ds_read_b128 v[232:235], v10 offset:1792
s_add_u32 m0, s59, 33280
v_mfma_f32_16x16x32_bf16 v[160:163], a[60:63], a[84:87], v[160:163]
ds_read_b128 v[228:231], v10 offset:1536
s_mov_b32 s58, 1572864
v_mfma_f32_16x16x32_bf16 v[104:107], a[72:75], a[56:59], v[104:107]
ds_read_b128 v[224:227], v10 offset:1280
v_mfma_f32_16x16x32_bf16 v[120:123], a[76:79], a[56:59], v[120:123]
ds_read_b128 v[220:223], v10 offset:1024
v_mfma_f32_16x16x32_bf16 v[136:139], a[56:59], a[80:83], v[136:139]
ds_read_b128 v[240:243], v11 offset:704
v_mfma_f32_16x16x32_bf16 v[152:155], a[56:59], a[84:87], v[152:155]
ds_read_b128 v[244:247], v11 offset:1728
v_mfma_f32_16x16x32_bf16 v[100:103], a[72:75], a[52:55], v[100:103]
buffer_load_dwordx4 v5, s[24:27], s58 offen lds
v_mfma_f32_16x16x32_bf16 v[116:119], a[76:79], a[52:55], v[116:119]
ds_read_b128 v[18:21], v11 offset:448
v_mfma_f32_16x16x32_bf16 v[96:99], a[72:75], a[48:51], v[96:99]
ds_read_b128 v[22:25], v11 offset:1472
s_waitcnt lgkmcnt(7)
v_pk_fma_f32 v[104:105], v[36:37], v[232:233], v[104:105] op_sel_hi:[1,0,1]
v_pk_mul_f32 v[104:105], v[104:105], v[232:233] op_sel:[0,1] op_sel_hi:[1,1]
v_pk_fma_f32 v[106:107], v[38:39], v[232:233], v[106:107] op_sel_hi:[1,0,1]
v_pk_mul_f32 v[106:107], v[106:107], v[232:233] op_sel:[0,1] op_sel_hi:[1,1]
v_pk_fma_f32 v[120:121], v[40:41], v[232:233], v[120:121] op_sel_hi:[1,0,1]
v_pk_mul_f32 v[120:121], v[120:121], v[232:233] op_sel:[0,1] op_sel_hi:[1,1]
v_pk_fma_f32 v[122:123], v[42:43], v[232:233], v[122:123] op_sel_hi:[1,0,1]
v_pk_mul_f32 v[122:123], v[122:123], v[232:233] op_sel:[0,1] op_sel_hi:[1,1]
s_waitcnt lgkmcnt(6)
v_pk_fma_f32 v[100:101], v[36:37], v[228:229], v[100:101] op_sel_hi:[1,0,1]
v_pk_mul_f32 v[100:101], v[100:101], v[228:229] op_sel:[0,1] op_sel_hi:[1,1]
s_waitcnt lgkmcnt(3)
v_pk_fma_f32 v[156:157], v[240:241], v[44:45], v[156:157] op_sel_hi:[1,0,1]
v_pk_fma_f32 v[158:159], v[242:243], v[44:45], v[158:159] op_sel_hi:[1,0,1]
v_pk_fma_f32 v[160:161], v[240:241], v[44:45], v[160:161] op_sel:[0,1,0] op_sel_hi:[1,1,1]
v_pk_fma_f32 v[162:163], v[242:243], v[44:45], v[162:163] op_sel:[0,1,0] op_sel_hi:[1,1,1]
s_waitcnt lgkmcnt(2)
v_pk_mul_f32 v[156:157], v[156:157], v[244:245]
v_pk_mul_f32 v[158:159], v[158:159], v[246:247]
v_pk_mul_f32 v[160:161], v[160:161], v[244:245]
v_pk_mul_f32 v[162:163], v[162:163], v[246:247]
v_pk_fma_f32 v[102:103], v[38:39], v[228:229], v[102:103] op_sel_hi:[1,0,1]
v_pk_mul_f32 v[102:103], v[102:103], v[228:229] op_sel:[0,1] op_sel_hi:[1,1]
v_pk_fma_f32 v[116:117], v[40:41], v[228:229], v[116:117] op_sel_hi:[1,0,1]
v_pk_mul_f32 v[116:117], v[116:117], v[228:229] op_sel:[0,1] op_sel_hi:[1,1]
s_waitcnt lgkmcnt(1)
v_pk_fma_f32 v[136:137], v[18:19], v[44:45], v[136:137] op_sel_hi:[1,0,1]
v_pk_fma_f32 v[138:139], v[20:21], v[44:45], v[138:139] op_sel_hi:[1,0,1]
v_pk_fma_f32 v[152:153], v[18:19], v[44:45], v[152:153] op_sel:[0,1,0] op_sel_hi:[1,1,1]
v_pk_fma_f32 v[154:155], v[20:21], v[44:45], v[154:155] op_sel:[0,1,0] op_sel_hi:[1,1,1]
s_waitcnt lgkmcnt(0)
v_pk_mul_f32 v[136:137], v[136:137], v[22:23]
v_pk_mul_f32 v[138:139], v[138:139], v[24:25]
v_pk_mul_f32 v[152:153], v[152:153], v[22:23]
v_pk_mul_f32 v[154:155], v[154:155], v[24:25]
v_pk_fma_f32 v[118:119], v[42:43], v[228:229], v[118:119] op_sel_hi:[1,0,1]
v_pk_mul_f32 v[118:119], v[118:119], v[228:229] op_sel:[0,1] op_sel_hi:[1,1]
v_pk_fma_f32 v[96:97], v[36:37], v[224:225], v[96:97] op_sel_hi:[1,0,1]
v_pk_mul_f32 v[96:97], v[96:97], v[224:225] op_sel:[0,1] op_sel_hi:[1,1]
v_pk_fma_f32 v[98:99], v[38:39], v[224:225], v[98:99] op_sel_hi:[1,0,1]
v_pk_mul_f32 v[98:99], v[98:99], v[224:225] op_sel:[0,1] op_sel_hi:[1,1]
v_cvt_pk_bf16_f32 v236, v156, v157
v_cvt_pk_bf16_f32 v237, v158, v159
v_mfma_f32_16x16x32_bf16 v[112:115], a[76:79], a[48:51], v[112:115]
buffer_load_dwordx4 v6, s[24:27], s58 offen offset:1024 lds
v_mfma_f32_16x16x32_bf16 v[92:95], a[72:75], a[44:47], v[92:95]
s_add_u32 m0, s59, 41600
v_cvt_pk_bf16_f32 v238, v160, v161
v_cvt_pk_bf16_f32 v239, v162, v163
v_mfma_f32_16x16x32_bf16 v[108:111], a[76:79], a[44:47], v[108:111]
ds_write_b128 v8, v[236:239] offset:1024
s_mov_b32 s58, 1703936
v_mfma_f32_16x16x32_bf16 v[72:75], a[64:67], a[56:59], v[72:75]
ds_read_b128 v[240:243], v11 offset:384
v_cvt_pk_bf16_f32 v196, v104, v105
v_mfma_f32_16x16x32_bf16 v[88:91], a[68:71], a[56:59], v[88:91]
buffer_load_dwordx4 v5, s[24:27], s58 offen lds
v_cvt_pk_bf16_f32 v197, v106, v107
v_cvt_pk_bf16_f32 v198, v120, v121
v_cvt_pk_bf16_f32 v199, v122, v123
s_nop 0
v_pk_fma_f32 v[72:73], v[28:29], v[232:233], v[72:73] op_sel_hi:[1,0,1]
v_pk_fma_f32 v[74:75], v[30:31], v[232:233], v[74:75] op_sel_hi:[1,0,1]
s_nop 0
v_pk_fma_f32 v[88:89], v[32:33], v[232:233], v[88:89] op_sel_hi:[1,0,1]
v_pk_fma_f32 v[90:91], v[34:35], v[232:233], v[90:91] op_sel_hi:[1,0,1]
v_pk_fma_f32 v[112:113], v[40:41], v[224:225], v[112:113] op_sel_hi:[1,0,1]
v_pk_mul_f32 v[112:113], v[112:113], v[224:225] op_sel:[0,1] op_sel_hi:[1,1]
v_pk_fma_f32 v[114:115], v[42:43], v[224:225], v[114:115] op_sel_hi:[1,0,1]
v_pk_mul_f32 v[114:115], v[114:115], v[224:225] op_sel:[0,1] op_sel_hi:[1,1]
v_pk_fma_f32 v[92:93], v[36:37], v[220:221], v[92:93] op_sel_hi:[1,0,1]
v_pk_mul_f32 v[92:93], v[92:93], v[220:221] op_sel:[0,1] op_sel_hi:[1,1]
v_pk_fma_f32 v[94:95], v[38:39], v[220:221], v[94:95] op_sel_hi:[1,0,1]
v_pk_mul_f32 v[94:95], v[94:95], v[220:221] op_sel:[0,1] op_sel_hi:[1,1]
v_pk_fma_f32 v[108:109], v[40:41], v[220:221], v[108:109] op_sel_hi:[1,0,1]
v_pk_mul_f32 v[108:109], v[108:109], v[220:221] op_sel:[0,1] op_sel_hi:[1,1]
v_pk_fma_f32 v[110:111], v[42:43], v[220:221], v[110:111] op_sel_hi:[1,0,1]
v_pk_mul_f32 v[110:111], v[110:111], v[220:221] op_sel:[0,1] op_sel_hi:[1,1]
v_cvt_pk_bf16_f32 v208, v136, v137
v_cvt_pk_bf16_f32 v209, v138, v139
v_mfma_f32_16x16x32_bf16 v[132:135], a[52:55], a[80:83], v[132:135]
s_waitcnt lgkmcnt(1)
s_barrier
ds_read_b128 v[180:183], v9
v_mfma_f32_16x16x32_bf16 v[148:151], a[52:55], a[84:87], v[148:151]
ds_read_b64 v[200:201], v9 offset:1024
v_cvt_pk_bf16_f32 v218, v152, v153
v_mfma_f32_16x16x32_bf16 v[68:71], a[64:67], a[52:55], v[68:71]
ds_read_b64 v[210:211], v9 offset:1032
v_cvt_pk_bf16_f32 v219, v154, v155
v_mfma_f32_16x16x32_bf16 v[84:87], a[68:71], a[52:55], v[84:87]
buffer_load_dwordx4 v6, s[24:27], s58 offen offset:1024 lds
v_mfma_f32_16x16x32_bf16 v[128:131], a[48:51], a[80:83], v[128:131]
s_add_u32 m0, s59, 49920
s_mov_b32 s58, 1835008
v_cvt_pk_bf16_f32 v192, v100, v101
v_cvt_pk_bf16_f32 v193, v102, v103
v_cvt_pk_bf16_f32 v194, v116, v117
v_cvt_pk_bf16_f32 v195, v118, v119
s_waitcnt lgkmcnt(3)
v_pk_fma_f32 v[132:133], v[240:241], v[44:45], v[132:133] op_sel_hi:[1,0,1]
v_pk_fma_f32 v[134:135], v[242:243], v[44:45], v[134:135] op_sel_hi:[1,0,1]
.Lpad16:
s_cbranch_execz .Lnopoll58r
v_pk_fma_f32 v[148:149], v[240:241], v[44:45], v[148:149] op_sel:[0,1,0] op_sel_hi:[1,1,1]
v_pk_fma_f32 v[150:151], v[242:243], v[44:45], v[150:151] op_sel:[0,1,0] op_sel_hi:[1,1,1]
v_pk_fma_f32 v[68:69], v[28:29], v[228:229], v[68:69] op_sel_hi:[1,0,1]
v_pk_fma_f32 v[70:71], v[30:31], v[228:229], v[70:71] op_sel_hi:[1,0,1]
v_pk_fma_f32 v[84:85], v[32:33], v[228:229], v[84:85] op_sel_hi:[1,0,1]
v_pk_fma_f32 v[86:87], v[34:35], v[228:229], v[86:87] op_sel_hi:[1,0,1]
v_cvt_pk_bf16_f32 v176, v72, v73
v_cvt_pk_bf16_f32 v177, v74, v75
v_mfma_f32_16x16x32_bf16 v[144:147], a[48:51], a[84:87], v[144:147]
buffer_load_dwordx4 v5, s[24:27], s58 offen lds
v_mfma_f32_16x16x32_bf16 v[64:67], a[64:67], a[48:51], v[64:67]
ds_read_b128 v[244:247], v11 offset:1408
v_cvt_pk_bf16_f32 v178, v88, v89
v_mfma_f32_16x16x32_bf16 v[80:83], a[68:71], a[48:51], v[80:83]
ds_read_b128 v[18:21], v11 offset:320
v_cvt_pk_bf16_f32 v179, v90, v91
v_mfma_f32_16x16x32_bf16 v[124:127], a[44:47], a[80:83], v[124:127]
ds_read_b128 v[22:25], v11 offset:1344
v_cvt_pk_bf16_f32 v188, v96, v97
v_mfma_f32_16x16x32_bf16 v[140:143], a[44:47], a[84:87], v[140:143]
buffer_load_dwordx4 v6, s[24:27], s58 offen offset:1024 lds
v_mfma_f32_16x16x32_bf16 v[60:63], a[64:67], a[44:47], v[60:63]
s_add_u32 m0, s59, 116480
s_mov_b32 s58, 786432
v_cvt_pk_bf16_f32 v189, v98, v99
v_mfma_f32_16x16x32_bf16 v[76:79], a[68:71], a[44:47], v[76:79]
ds_read_b128 v[240:243], v11 offset:256
v_cvt_pk_bf16_f32 v190, v112, v113
v_mfma_f32_16x16x32_bf16 v[104:107], v[192:195], v[176:179], v[46:49]
v_cvt_pk_bf16_f32 v191, v114, v115
v_cvt_pk_bf16_f32 v172, v68, v69
v_cvt_pk_bf16_f32 v173, v70, v71
v_cvt_pk_bf16_f32 v174, v84, v85
v_cvt_pk_bf16_f32 v175, v86, v87
v_pk_fma_f32 v[64:65], v[28:29], v[224:225], v[64:65] op_sel_hi:[1,0,1]
v_pk_fma_f32 v[66:67], v[30:31], v[224:225], v[66:67] op_sel_hi:[1,0,1]
s_waitcnt lgkmcnt(3)
v_pk_mul_f32 v[132:133], v[132:133], v[244:245]
v_pk_mul_f32 v[134:135], v[134:135], v[246:247]
v_pk_mul_f32 v[148:149], v[148:149], v[244:245]
v_pk_mul_f32 v[150:151], v[150:151], v[246:247]
s_waitcnt lgkmcnt(2)
v_pk_fma_f32 v[128:129], v[18:19], v[44:45], v[128:129] op_sel_hi:[1,0,1]
v_pk_fma_f32 v[130:131], v[20:21], v[44:45], v[130:131] op_sel_hi:[1,0,1]
v_pk_fma_f32 v[144:145], v[18:19], v[44:45], v[144:145] op_sel:[0,1,0] op_sel_hi:[1,1,1]
v_pk_fma_f32 v[146:147], v[20:21], v[44:45], v[146:147] op_sel:[0,1,0] op_sel_hi:[1,1,1]
s_waitcnt lgkmcnt(1)
v_pk_mul_f32 v[128:129], v[128:129], v[22:23]
v_pk_mul_f32 v[130:131], v[130:131], v[24:25]
v_pk_mul_f32 v[144:145], v[144:145], v[22:23]
v_pk_mul_f32 v[146:147], v[146:147], v[24:25]
v_pk_fma_f32 v[80:81], v[32:33], v[224:225], v[80:81] op_sel_hi:[1,0,1]
v_pk_fma_f32 v[82:83], v[34:35], v[224:225], v[82:83] op_sel_hi:[1,0,1]
v_pk_fma_f32 v[60:61], v[28:29], v[220:221], v[60:61] op_sel_hi:[1,0,1]
v_pk_fma_f32 v[62:63], v[30:31], v[220:221], v[62:63] op_sel_hi:[1,0,1]
v_pk_fma_f32 v[76:77], v[32:33], v[220:221], v[76:77] op_sel_hi:[1,0,1]
v_pk_fma_f32 v[78:79], v[34:35], v[220:221], v[78:79] op_sel_hi:[1,0,1]
v_cvt_pk_bf16_f32 v206, v132, v133
v_cvt_pk_bf16_f32 v207, v134, v135
v_mfma_f32_16x16x32_bf16 v[120:123], v[196:199], v[176:179], v[50:53]
buffer_load_dwordx4 v5, s[24:27], s58 offen lds
v_mfma_f32_16x16x32_bf16 v[100:103], v[188:191], v[172:175], v[46:49]
ds_read_b128 v[244:247], v11 offset:1280
v_cvt_pk_bf16_f32 v216, v148, v149
v_mfma_f32_16x16x32_bf16 v[116:119], v[192:195], v[172:175], v[50:53]
v_cvt_pk_bf16_f32 v217, v150, v151
v_max3_f32 v88, v104, v105, v106
s_nop 0
v_max3_f32 v89, v107, v120, v121
v_max3_f32 v88, v88, v122, v123
v_max_f32 v90, v88, v89
v_max_f32 v89, v88, v89
v_cvt_pk_bf16_f32 v204, v128, v129
buffer_load_dwordx4 v6, s[24:27], s58 offen offset:1024 lds
s_add_u32 m0, s59, 124800
s_mov_b32 s58, 917504
v_permlane16_swap_b32 v90, v89
v_cvt_pk_bf16_f32 v205, v130, v131
v_max_f32 v88, v90, v89
v_max_f32 v89, v90, v89
v_cvt_pk_bf16_f32 v214, v144, v145
v_cvt_pk_bf16_f32 v215, v146, v147
v_permlane32_swap_b32 v88, v89
v_max3_f32 v84, v100, v101, v102
v_max_f32 v88, v88, v89
buffer_load_dwordx4 v5, s[24:27], s58 offen lds
v_mul_f32 v88, v88, v234
v_pk_fma_f32 v[104:105], v[104:105], v[234:235], v[88:89] op_sel_hi:[1,0,0] neg_lo:[0,0,1] neg_hi:[0,0,1]
v_pk_fma_f32 v[106:107], v[106:107], v[234:235], v[88:89] op_sel_hi:[1,0,0] neg_lo:[0,0,1] neg_hi:[0,0,1]
v_pk_fma_f32 v[120:121], v[120:121], v[234:235], v[88:89] op_sel_hi:[1,0,0] neg_lo:[0,0,1] neg_hi:[0,0,1]
v_pk_fma_f32 v[122:123], v[122:123], v[234:235], v[88:89] op_sel_hi:[1,0,0] neg_lo:[0,0,1] neg_hi:[0,0,1]
v_exp_f32 v104, v104
v_exp_f32 v105, v105
v_exp_f32 v106, v106
v_exp_f32 v107, v107
v_exp_f32 v120, v120
v_exp_f32 v121, v121
v_exp_f32 v122, v122
v_exp_f32 v123, v123
v_cvt_pk_bf16_f32 v72, v104, v105
buffer_load_dwordx4 v6, s[24:27], s58 offen offset:1024 lds
v_cvt_pk_bf16_f32 v73, v106, v107
v_cvt_pk_bf16_f32 v74, v120, v121
v_cvt_pk_bf16_f32 v75, v122, v123
s_waitcnt lgkmcnt(1)
v_pk_fma_f32 v[124:125], v[240:241], v[44:45], v[124:125] op_sel_hi:[1,0,1]
s_waitcnt lgkmcnt(0)
v_pk_mul_f32 v[124:125], v[124:125], v[244:245]
v_pk_fma_f32 v[126:127], v[242:243], v[44:45], v[126:127] op_sel_hi:[1,0,1]
v_pk_mul_f32 v[126:127], v[126:127], v[246:247]
v_pk_fma_f32 v[140:141], v[240:241], v[44:45], v[140:141] op_sel:[0,1,0] op_sel_hi:[1,1,1]
v_pk_mul_f32 v[140:141], v[140:141], v[244:245]
v_pk_fma_f32 v[142:143], v[242:243], v[44:45], v[142:143] op_sel:[0,1,0] op_sel_hi:[1,1,1]
v_pk_mul_f32 v[142:143], v[142:143], v[246:247]
v_max3_f32 v85, v103, v116, v117
v_max3_f32 v84, v84, v118, v119
v_mfma_f32_16x16x32_bf16 v[88:91], v[248:251], v[72:75], 0
v_max_f32 v86, v84, v85
v_max_f32 v85, v84, v85
v_mfma_f32_16x16x32_bf16 v[104:107], v[206:209], v[72:75], 0
s_nop 0
v_permlane16_swap_b32 v86, v85
v_mfma_f32_16x16x32_bf16 v[120:123], v[216:219], v[72:75], 0
s_nop 1
v_rcp_f32 v88, v88
v_max_f32 v84, v86, v85
v_max_f32 v85, v86, v85
v_cvt_pk_bf16_f32 v184, v92, v93
v_pk_mul_f32 v[104:105], v[104:105], v[88:89] op_sel_hi:[1,0]
v_pk_mul_f32 v[106:107], v[106:107], v[88:89] op_sel_hi:[1,0]
v_pk_mul_f32 v[120:121], v[120:121], v[88:89] op_sel_hi:[1,0]
v_pk_mul_f32 v[122:123], v[122:123], v[88:89] op_sel_hi:[1,0]
v_cvt_pk_bf16_f32 v176, v104, v105
v_cvt_pk_bf16_f32 v177, v106, v107
v_cvt_pk_bf16_f32 v178, v120, v121
v_cvt_pk_bf16_f32 v179, v122, v123
buffer_store_dwordx4 v[176:179], v4, s[16:19], s74 offen offset:3072 sc1
v_permlane32_swap_b32 v84, v85
v_cvt_pk_bf16_f32 v185, v94, v95
v_max_f32 v84, v84, v85
v_mul_f32 v84, v84, v230
v_pk_fma_f32 v[100:101], v[100:101], v[230:231], v[84:85] op_sel_hi:[1,0,0] neg_lo:[0,0,1] neg_hi:[0,0,1]
v_pk_fma_f32 v[102:103], v[102:103], v[230:231], v[84:85] op_sel_hi:[1,0,0] neg_lo:[0,0,1] neg_hi:[0,0,1]
v_pk_fma_f32 v[116:117], v[116:117], v[230:231], v[84:85] op_sel_hi:[1,0,0] neg_lo:[0,0,1] neg_hi:[0,0,1]
v_pk_fma_f32 v[118:119], v[118:119], v[230:231], v[84:85] op_sel_hi:[1,0,0] neg_lo:[0,0,1] neg_hi:[0,0,1]
v_exp_f32 v100, v100
v_exp_f32 v101, v101
v_exp_f32 v102, v102
v_exp_f32 v103, v103
v_exp_f32 v116, v116
v_exp_f32 v117, v117
v_exp_f32 v118, v118
v_exp_f32 v119, v119
v_cvt_pk_bf16_f32 v68, v100, v101
v_cvt_pk_bf16_f32 v69, v102, v103
v_cvt_pk_bf16_f32 v70, v116, v117
v_cvt_pk_bf16_f32 v71, v118, v119
v_cvt_pk_bf16_f32 v186, v108, v109
v_cvt_pk_bf16_f32 v187, v110, v111
v_mfma_f32_16x16x32_bf16 v[84:87], v[248:251], v[68:71], 0
v_cvt_pk_bf16_f32 v168, v64, v65
v_cvt_pk_bf16_f32 v169, v66, v67
v_mfma_f32_16x16x32_bf16 v[100:103], v[204:207], v[68:71], 0
v_cvt_pk_bf16_f32 v170, v80, v81
v_cvt_pk_bf16_f32 v171, v82, v83
v_mfma_f32_16x16x32_bf16 v[116:119], v[214:217], v[68:71], 0
s_nop 1
v_rcp_f32 v84, v84
v_mfma_f32_16x16x32_bf16 v[96:99], v[184:187], v[168:171], v[46:49]
v_cvt_pk_bf16_f32 v202, v124, v125
v_cvt_pk_bf16_f32 v203, v126, v127
v_mfma_f32_16x16x32_bf16 v[112:115], v[188:191], v[168:171], v[50:53]
v_cvt_pk_bf16_f32 v212, v140, v141
v_cvt_pk_bf16_f32 v213, v142, v143
v_cvt_pk_bf16_f32 v164, v60, v61
s_nop 1
v_max3_f32 v80, v96, v97, v98
v_cvt_pk_bf16_f32 v165, v62, v63
v_pk_mul_f32 v[100:101], v[100:101], v[84:85] op_sel_hi:[1,0]
v_pk_mul_f32 v[102:103], v[102:103], v[84:85] op_sel_hi:[1,0]
v_pk_mul_f32 v[116:117], v[116:117], v[84:85] op_sel_hi:[1,0]
v_pk_mul_f32 v[118:119], v[118:119], v[84:85] op_sel_hi:[1,0]
v_cvt_pk_bf16_f32 v172, v100, v101
v_cvt_pk_bf16_f32 v173, v102, v103
v_cvt_pk_bf16_f32 v174, v116, v117
v_cvt_pk_bf16_f32 v175, v118, v119
buffer_store_dwordx4 v[172:175], v4, s[16:19], s74 offen offset:2048 sc1
v_max3_f32 v81, v99, v112, v113
v_max3_f32 v80, v80, v114, v115
v_max_f32 v82, v80, v81
v_max_f32 v81, v80, v81
v_cvt_pk_bf16_f32 v166, v76, v77
v_cvt_pk_bf16_f32 v167, v78, v79
v_permlane16_swap_b32 v82, v81
s_nop 0
v_mfma_f32_16x16x32_bf16 v[92:95], v[180:183], v[164:167], v[46:49]
v_max_f32 v80, v82, v81
v_max_f32 v81, v82, v81
v_mfma_f32_16x16x32_bf16 v[108:111], v[184:187], v[164:167], v[50:53]
s_nop 0
v_permlane32_swap_b32 v80, v81
v_max_f32 v80, v80, v81
v_mul_f32 v80, v80, v226
v_pk_fma_f32 v[96:97], v[96:97], v[226:227], v[80:81] op_sel_hi:[1,0,0] neg_lo:[0,0,1] neg_hi:[0,0,1]
v_pk_fma_f32 v[98:99], v[98:99], v[226:227], v[80:81] op_sel_hi:[1,0,0] neg_lo:[0,0,1] neg_hi:[0,0,1]
v_pk_fma_f32 v[112:113], v[112:113], v[226:227], v[80:81] op_sel_hi:[1,0,0] neg_lo:[0,0,1] neg_hi:[0,0,1]
v_pk_fma_f32 v[114:115], v[114:115], v[226:227], v[80:81] op_sel_hi:[1,0,0] neg_lo:[0,0,1] neg_hi:[0,0,1]
v_exp_f32 v96, v96
v_exp_f32 v97, v97
v_exp_f32 v98, v98
v_exp_f32 v99, v99
v_exp_f32 v112, v112
v_exp_f32 v113, v113
v_exp_f32 v114, v114
v_exp_f32 v115, v115
v_cvt_pk_bf16_f32 v64, v96, v97
v_cvt_pk_bf16_f32 v65, v98, v99
v_cvt_pk_bf16_f32 v66, v112, v113
v_cvt_pk_bf16_f32 v67, v114, v115
v_max3_f32 v76, v92, v93, v94
v_max3_f32 v77, v95, v108, v109
v_mfma_f32_16x16x32_bf16 v[80:83], v[248:251], v[64:67], 0
v_max3_f32 v76, v76, v110, v111
v_max_f32 v78, v76, v77
v_mfma_f32_16x16x32_bf16 v[96:99], v[202:205], v[64:67], 0
v_max_f32 v77, v76, v77
v_mfma_f32_16x16x32_bf16 v[112:115], v[212:215], v[64:67], 0
s_nop 2
v_rcp_f32 v80, v80
v_permlane16_swap_b32 v78, v77
s_nop 0
v_pk_mul_f32 v[96:97], v[96:97], v[80:81] op_sel_hi:[1,0]
v_pk_mul_f32 v[98:99], v[98:99], v[80:81] op_sel_hi:[1,0]
v_pk_mul_f32 v[112:113], v[112:113], v[80:81] op_sel_hi:[1,0]
v_pk_mul_f32 v[114:115], v[114:115], v[80:81] op_sel_hi:[1,0]
v_cvt_pk_bf16_f32 v168, v96, v97
v_cvt_pk_bf16_f32 v169, v98, v99
v_cvt_pk_bf16_f32 v170, v112, v113
v_cvt_pk_bf16_f32 v171, v114, v115
buffer_store_dwordx4 v[168:171], v4, s[16:19], s74 offen offset:1024 sc1
v_max_f32 v76, v78, v77
v_max_f32 v77, v78, v77
s_nop 1
v_permlane32_swap_b32 v76, v77
v_max_f32 v76, v76, v77
v_mul_f32 v76, v76, v222
v_pk_fma_f32 v[92:93], v[92:93], v[222:223], v[76:77] op_sel_hi:[1,0,0] neg_lo:[0,0,1] neg_hi:[0,0,1]
v_pk_fma_f32 v[94:95], v[94:95], v[222:223], v[76:77] op_sel_hi:[1,0,0] neg_lo:[0,0,1] neg_hi:[0,0,1]
v_pk_fma_f32 v[108:109], v[108:109], v[222:223], v[76:77] op_sel_hi:[1,0,0] neg_lo:[0,0,1] neg_hi:[0,0,1]
v_pk_fma_f32 v[110:111], v[110:111], v[222:223], v[76:77] op_sel_hi:[1,0,0] neg_lo:[0,0,1] neg_hi:[0,0,1]
v_exp_f32 v92, v92
v_exp_f32 v93, v93
v_exp_f32 v94, v94
v_exp_f32 v95, v95
v_exp_f32 v108, v108
v_exp_f32 v109, v109
v_exp_f32 v110, v110
v_exp_f32 v111, v111
v_cvt_pk_bf16_f32 v60, v92, v93
v_cvt_pk_bf16_f32 v61, v94, v95
v_cvt_pk_bf16_f32 v62, v108, v109
v_cvt_pk_bf16_f32 v63, v110, v111
s_nop 1
v_mfma_f32_16x16x32_bf16 v[76:79], v[248:251], v[60:63], 0
v_mfma_f32_16x16x32_bf16 v[92:95], v[200:203], v[60:63], 0
v_mfma_f32_16x16x32_bf16 v[108:111], v[210:213], v[60:63], 0
s_nop 5
v_rcp_f32 v76, v76
s_nop 0
v_pk_mul_f32 v[92:93], v[92:93], v[76:77] op_sel_hi:[1,0]
v_pk_mul_f32 v[94:95], v[94:95], v[76:77] op_sel_hi:[1,0]
v_pk_mul_f32 v[108:109], v[108:109], v[76:77] op_sel_hi:[1,0]
v_pk_mul_f32 v[110:111], v[110:111], v[76:77] op_sel_hi:[1,0]
v_cvt_pk_bf16_f32 v164, v92, v93
v_cvt_pk_bf16_f32 v165, v94, v95
v_cvt_pk_bf16_f32 v166, v108, v109
v_cvt_pk_bf16_f32 v167, v110, v111
buffer_store_dwordx4 v[164:167], v4, s[16:19], s74 offen sc1
s_nop 1
.Lqkve61:
.Lpad17:
s_cbranch_execz .Lnopoll58r
s_lshl_b32 s62, s6, 13
s_lshl_b32 s63, s3, 11
s_add_u32 s62, s62, s63
v_lshl_add_u32 v4, v1, 4, s62
v_bfe_u32 v5, v1, 3, 1
v_lshrrev_b32 v2, 4, v1
v_lshl_add_u32 v5, v2, 3, v5
s_lshl_b32 s62, s3, 1
v_add_u32 v5, s62, v5
v_mul_u32_u24 v5, 2048, v5
v_and_b32 v2, 7, v1
v_lshl_add_u32 v5, v2, 4, v5
s_lshl_b32 s62, s7, 7
v_add_u32 v5, s62, v5
v_add_u32 v6, 64512, v5
v_bfe_u32 v8, v1, 3, 2
v_mul_u32_u24 v8, 2080, v8
v_bfe_u32 v2, v1, 2, 1
v_lshl_add_u32 v8, v2, 7, v8
v_bfe_u32 v2, v1, 5, 1
v_lshl_add_u32 v8, v2, 8, v8
v_and_b32 v2, 3, v1
v_lshl_add_u32 v8, v2, 3, v8
s_mov_b32 s57, 66560
v_add_u32 v7, s57, v8
s_mov_b32 s52, 37748736
s_mov_b32 s53, 37879808
s_mov_b32 s54, 2097152
s_mul_i32 s56, s3, 2080
v_accvgpr_read_b32 v32, a224
v_accvgpr_read_b32 v33, a225
v_accvgpr_read_b32 v34, a226
v_accvgpr_read_b32 v35, a227
v_accvgpr_read_b32 v36, a228
v_accvgpr_read_b32 v37, a229
v_accvgpr_read_b32 v38, a230
v_accvgpr_read_b32 v39, a231
v_accvgpr_read_b32 v40, a232
v_accvgpr_read_b32 v41, a233
v_accvgpr_read_b32 v42, a234
v_accvgpr_read_b32 v43, a235
v_accvgpr_read_b32 v44, a236
v_accvgpr_read_b32 v45, a237
v_accvgpr_read_b32 v46, a238
v_accvgpr_read_b32 v47, a239
v_accvgpr_read_b32 v48, a240
v_accvgpr_read_b32 v49, a241
v_accvgpr_read_b32 v50, a242
v_accvgpr_read_b32 v51, a243
v_accvgpr_read_b32 v52, a244
v_accvgpr_read_b32 v53, a245
v_accvgpr_read_b32 v54, a246
v_accvgpr_read_b32 v55, a247
v_accvgpr_read_b32 v56, a248
v_accvgpr_read_b32 v57, a249
v_accvgpr_read_b32 v58, a250
v_accvgpr_read_b32 v59, a251
v_accvgpr_read_b32 v60, a252
v_accvgpr_read_b32 v61, a253
v_accvgpr_read_b32 v62, a254
v_accvgpr_read_b32 v63, a255
s_and_b32 s62, s3, 1
s_mul_i32 s62, s62, 28672
s_add_u32 s62, s62, s51
v_lshrrev_b32 v12, 4, v1
v_mul_u32_u24 v12, 57344, v12
v_and_b32 v2, 15, v1
v_lshl_add_u32 v12, v2, 4, v12
v_add_u32 v12, s62, v12
v_add_u32 v13, 6112, v12
v_add_u32 v14, 12224, v12
v_add_u32 v15, 18336, v12
s_mul_i32 s59, s3, 4224
s_mov_b32 s58, 0
s_lshl_b32 s62, s8, 7
s_add_u32 s62, s62, 30418944
s_lshl_b32 s64, s6, 7
s_add_u32 s64, s64, 30418944
v_mov_b32 v252, s62
v_mov_b32 v253, s64
s_waitcnt vmcnt(0) lgkmcnt(0)
s_barrier
s_cmp_lg_u32 s3, 0
s_cbranch_scc1 .Lnosig64
v_mov_b32 v255, 1
s_mov_b64 exec, 1
buffer_atomic_add v255, v252, s[16:19], 0 offen
s_mov_b64 exec, -1
.Lnosig64:
s_cmp_lg_u32 s3, 1
s_cbranch_scc1 .Lnopoll67
s_mov_b64 exec, 1
s_mov_b32 s15, 0
s_mov_b64 exec, 1
v_mov_b32 v254, 0
buffer_atomic_add v254, v253, s[16:19], 0 offen sc0
.Lpoll65:
s_waitcnt vmcnt(0)
v_cmp_ne_u32 vcc, 16, v254
s_add_u32 s15, s15, 1
s_cbranch_vccz .Lnopoll67r
s_sleep 2
s_mov_b64 exec, 1
v_mov_b32 v254, 0
buffer_atomic_add v254, v253, s[16:19], 0 offen sc0
s_cmp_le_u32 s15, 100000
s_cbranch_scc1 .Lpoll65
.Lgot66:
s_waitcnt vmcnt(0)
s_branch .Lnopoll67r
.Lnopoll67:
s_mov_b64 exec, 0
s_cmp_eq_u32 s3, 2
s_cbranch_scc1 .Lpad18
s_cmp_eq_u32 s3, 3
s_cbranch_scc1 .Lpad19
s_branch .Lnopoll67r
.Lnopoll67r:
s_mov_b64 exec, -1
s_barrier
buffer_load_dwordx4 v[64:67], v4, s[16:19], s52 offen sc1
buffer_load_dwordx4 v[68:71], v4, s[16:19], s52 offen offset:1024 sc1
s_add_u32 s52, s52, 0x40000
buffer_load_dwordx4 v[72:75], v4, s[16:19], s53 offen sc1
buffer_load_dwordx4 v[76:79], v4, s[16:19], s53 offen offset:1024 sc1
s_add_u32 s53, s53, 0x40000
buffer_load_dwordx4 v[80:83], v4, s[16:19], s52 offen sc1
buffer_load_dwordx4 v[84:87], v4, s[16:19], s52 offen offset:1024 sc1
s_add_u32 s52, s52, 0x40000
buffer_load_dwordx4 v[88:91], v4, s[16:19], s53 offen sc1
buffer_load_dwordx4 v[92:95], v4, s[16:19], s53 offen offset:1024 sc1
s_add_u32 s53, s53, 0x40000
buffer_load_dwordx4 v[96:99], v4, s[16:19], s52 offen sc1
buffer_load_dwordx4 v[100:103], v4, s[16:19], s52 offen offset:1024 sc1
s_add_u32 s52, s52, 0x40000
buffer_load_dwordx4 v[104:107], v4, s[16:19], s53 offen sc1
buffer_load_dwordx4 v[108:111], v4, s[16:19], s53 offen offset:1024 sc1
s_add_u32 s53, s53, 0x40000
ds_read_b64_tr_b16 a[0:1], v7
ds_read_b64_tr_b16 a[2:3], v7 offset:512
ds_read_b64_tr_b16 a[4:5], v7 offset:32
ds_read_b64_tr_b16 a[6:7], v7 offset:544
ds_read_b64_tr_b16 a[8:9], v7 offset:64
ds_read_b64_tr_b16 a[10:11], v7 offset:576
ds_read_b64_tr_b16 a[12:13], v7 offset:96
ds_read_b64_tr_b16 a[14:15], v7 offset:608
ds_read_b64_tr_b16 a[16:17], v7 offset:1024
ds_read_b64_tr_b16 a[18:19], v7 offset:1536
ds_read_b64_tr_b16 a[20:21], v7 offset:1056
ds_read_b64_tr_b16 a[22:23], v7 offset:1568
ds_read_b64_tr_b16 a[24:25], v7 offset:1088
ds_read_b64_tr_b16 a[26:27], v7 offset:1600
ds_read_b64_tr_b16 a[28:29], v7 offset:1120
ds_read_b64_tr_b16 a[30:31], v7 offset:1632
s_waitcnt vmcnt(11) lgkmcnt(14)
v_mfma_f32_16x16x32_bf16 v[32:35], a[0:3], v[64:67], v[32:35]
ds_read_b64_tr_b16 a[32:33], v7 offset:8320
ds_read_b64_tr_b16 a[34:35], v7 offset:8832
s_waitcnt vmcnt(10)
v_mfma_f32_16x16x32_bf16 v[48:51], a[0:3], v[68:71], v[48:51]
buffer_load_dwordx4 v[112:115], v4, s[16:19], s52 offen sc1
s_waitcnt lgkmcnt(14)
v_mfma_f32_16x16x32_bf16 v[52:55], a[4:7], v[68:71], v[52:55]
ds_read_b64_tr_b16 a[36:37], v7 offset:8352
ds_read_b64_tr_b16 a[38:39], v7 offset:8864
v_mfma_f32_16x16x32_bf16 v[36:39], a[4:7], v[64:67], v[36:39]
ds_read_b64_tr_b16 a[40:41], v7 offset:8384
ds_read_b64_tr_b16 a[42:43], v7 offset:8896
s_waitcnt lgkmcnt(15)
v_mfma_f32_16x16x32_bf16 v[40:43], a[8:11], v[64:67], v[40:43]
buffer_load_dwordx4 v[116:119], v4, s[16:19], s52 offen offset:1024 sc1
v_mfma_f32_16x16x32_bf16 v[56:59], a[8:11], v[68:71], v[56:59]
ds_read_b64_tr_b16 a[44:45], v7 offset:8416
s_add_u32 s52, s52, 0x40000
s_waitcnt lgkmcnt(15)
v_mfma_f32_16x16x32_bf16 v[60:63], a[12:15], v[68:71], v[60:63]
ds_read_b64_tr_b16 a[46:47], v7 offset:8928
v_mfma_f32_16x16x32_bf16 v[44:47], a[12:15], v[64:67], v[44:47]
ds_read_b64_tr_b16 a[48:49], v7 offset:9344
ds_read_b64_tr_b16 a[50:51], v7 offset:9856
s_waitcnt vmcnt(11) lgkmcnt(15)
v_mfma_f32_16x16x32_bf16 v[32:35], a[16:19], v[72:75], v[32:35]
buffer_load_dwordx4 v[120:123], v4, s[16:19], s53 offen sc1
s_waitcnt vmcnt(11)
v_mfma_f32_16x16x32_bf16 v[48:51], a[16:19], v[76:79], v[48:51]
ds_read_b64_tr_b16 a[52:53], v7 offset:9376
ds_read_b64_tr_b16 a[54:55], v7 offset:9888
s_waitcnt lgkmcnt(15)
v_mfma_f32_16x16x32_bf16 v[52:55], a[20:23], v[76:79], v[52:55]
ds_read_b64_tr_b16 a[56:57], v7 offset:9408
ds_read_b64_tr_b16 a[58:59], v7 offset:9920
v_mfma_f32_16x16x32_bf16 v[36:39], a[20:23], v[72:75], v[36:39]
buffer_load_dwordx4 v[124:127], v4, s[16:19], s53 offen offset:1024 sc1
s_waitcnt lgkmcnt(15)
v_mfma_f32_16x16x32_bf16 v[40:43], a[24:27], v[72:75], v[40:43]
ds_read_b64_tr_b16 a[60:61], v7 offset:9440
s_add_u32 s53, s53, 0x40000
v_mfma_f32_16x16x32_bf16 v[56:59], a[24:27], v[76:79], v[56:59]
ds_read_b64_tr_b16 a[62:63], v7 offset:9952
s_waitcnt lgkmcnt(15)
v_mfma_f32_16x16x32_bf16 v[60:63], a[28:31], v[76:79], v[60:63]
v_mfma_f32_16x16x32_bf16 v[44:47], a[28:31], v[72:75], v[44:47]
s_waitcnt vmcnt(11) lgkmcnt(14)
v_mfma_f32_16x16x32_bf16 v[32:35], a[32:35], v[80:83], v[32:35]
ds_read_b64_tr_b16 a[0:1], v7 offset:16640
ds_read_b64_tr_b16 a[2:3], v7 offset:17152
s_waitcnt vmcnt(10)
v_mfma_f32_16x16x32_bf16 v[48:51], a[32:35], v[84:87], v[48:51]
buffer_load_dwordx4 v[64:67], v4, s[16:19], s52 offen sc1
s_waitcnt lgkmcnt(14)
v_mfma_f32_16x16x32_bf16 v[52:55], a[36:39], v[84:87], v[52:55]
ds_read_b64_tr_b16 a[4:5], v7 offset:16672
ds_read_b64_tr_b16 a[6:7], v7 offset:17184
v_mfma_f32_16x16x32_bf16 v[36:39], a[36:39], v[80:83], v[36:39]
ds_read_b64_tr_b16 a[8:9], v7 offset:16704
ds_read_b64_tr_b16 a[10:11], v7 offset:17216
s_waitcnt lgkmcnt(15)
v_mfma_f32_16x16x32_bf16 v[40:43], a[40:43], v[80:83], v[40:43]
buffer_load_dwordx4 v[68:71], v4, s[16:19], s52 offen offset:1024 sc1
v_mfma_f32_16x16x32_bf16 v[56:59], a[40:43], v[84:87], v[56:59]
ds_read_b64_tr_b16 a[12:13], v7 offset:16736
s_add_u32 s52, s52, 0x40000
s_waitcnt lgkmcnt(15)
v_mfma_f32_16x16x32_bf16 v[60:63], a[44:47], v[84:87], v[60:63]
ds_read_b64_tr_b16 a[14:15], v7 offset:17248
v_mfma_f32_16x16x32_bf16 v[44:47], a[44:47], v[80:83], v[44:47]
ds_read_b64_tr_b16 a[16:17], v7 offset:17664
ds_read_b64_tr_b16 a[18:19], v7 offset:18176
s_waitcnt vmcnt(11) lgkmcnt(15)
v_mfma_f32_16x16x32_bf16 v[32:35], a[48:51], v[88:91], v[32:35]
buffer_load_dwordx4 v[72:75], v4, s[16:19], s53 offen sc1
s_waitcnt vmcnt(11)
v_mfma_f32_16x16x32_bf16 v[48:51], a[48:51], v[92:95], v[48:51]
ds_read_b64_tr_b16 a[20:21], v7 offset:17696
ds_read_b64_tr_b16 a[22:23], v7 offset:18208
s_waitcnt lgkmcnt(15)
v_mfma_f32_16x16x32_bf16 v[52:55], a[52:55], v[92:95], v[52:55]
ds_read_b64_tr_b16 a[24:25], v7 offset:17728
ds_read_b64_tr_b16 a[26:27], v7 offset:18240
v_mfma_f32_16x16x32_bf16 v[36:39], a[52:55], v[88:91], v[36:39]
buffer_load_dwordx4 v[76:79], v4, s[16:19], s53 offen offset:1024 sc1
s_waitcnt lgkmcnt(15)
v_mfma_f32_16x16x32_bf16 v[40:43], a[56:59], v[88:91], v[40:43]
ds_read_b64_tr_b16 a[28:29], v7 offset:17760
s_add_u32 s53, s53, 0x40000
v_mfma_f32_16x16x32_bf16 v[56:59], a[56:59], v[92:95], v[56:59]
ds_read_b64_tr_b16 a[30:31], v7 offset:18272
s_waitcnt lgkmcnt(15)
v_mfma_f32_16x16x32_bf16 v[60:63], a[60:63], v[92:95], v[60:63]
v_mfma_f32_16x16x32_bf16 v[44:47], a[60:63], v[88:91], v[44:47]
s_waitcnt vmcnt(11) lgkmcnt(14)
v_mfma_f32_16x16x32_bf16 v[32:35], a[0:3], v[96:99], v[32:35]
ds_read_b64_tr_b16 a[32:33], v7 offset:24960
ds_read_b64_tr_b16 a[34:35], v7 offset:25472
s_waitcnt vmcnt(10)
v_mfma_f32_16x16x32_bf16 v[48:51], a[0:3], v[100:103], v[48:51]
buffer_load_dwordx4 v[80:83], v4, s[16:19], s52 offen sc1
s_waitcnt lgkmcnt(14)
v_mfma_f32_16x16x32_bf16 v[52:55], a[4:7], v[100:103], v[52:55]
ds_read_b64_tr_b16 a[36:37], v7 offset:24992
ds_read_b64_tr_b16 a[38:39], v7 offset:25504
v_mfma_f32_16x16x32_bf16 v[36:39], a[4:7], v[96:99], v[36:39]
ds_read_b64_tr_b16 a[40:41], v7 offset:25024
ds_read_b64_tr_b16 a[42:43], v7 offset:25536
s_waitcnt lgkmcnt(15)
v_mfma_f32_16x16x32_bf16 v[40:43], a[8:11], v[96:99], v[40:43]
buffer_load_dwordx4 v[84:87], v4, s[16:19], s52 offen offset:1024 sc1
v_mfma_f32_16x16x32_bf16 v[56:59], a[8:11], v[100:103], v[56:59]
ds_read_b64_tr_b16 a[44:45], v7 offset:25056
s_add_u32 s52, s52, 0x40000
s_waitcnt lgkmcnt(15)
v_mfma_f32_16x16x32_bf16 v[60:63], a[12:15], v[100:103], v[60:63]
ds_read_b64_tr_b16 a[46:47], v7 offset:25568
v_mfma_f32_16x16x32_bf16 v[44:47], a[12:15], v[96:99], v[44:47]
ds_read_b64_tr_b16 a[48:49], v7 offset:25984
ds_read_b64_tr_b16 a[50:51], v7 offset:26496
s_waitcnt vmcnt(11) lgkmcnt(15)
v_mfma_f32_16x16x32_bf16 v[32:35], a[16:19], v[104:107], v[32:35]
buffer_load_dwordx4 v[88:91], v4, s[16:19], s53 offen sc1
s_waitcnt vmcnt(11)
v_mfma_f32_16x16x32_bf16 v[48:51], a[16:19], v[108:111], v[48:51]
ds_read_b64_tr_b16 a[52:53], v7 offset:26016
ds_read_b64_tr_b16 a[54:55], v7 offset:26528
s_waitcnt lgkmcnt(15)
v_mfma_f32_16x16x32_bf16 v[52:55], a[20:23], v[108:111], v[52:55]
ds_read_b64_tr_b16 a[56:57], v7 offset:26048
ds_read_b64_tr_b16 a[58:59], v7 offset:26560
v_mfma_f32_16x16x32_bf16 v[36:39], a[20:23], v[104:107], v[36:39]
buffer_load_dwordx4 v[92:95], v4, s[16:19], s53 offen offset:1024 sc1
s_waitcnt lgkmcnt(15)
v_mfma_f32_16x16x32_bf16 v[40:43], a[24:27], v[104:107], v[40:43]
ds_read_b64_tr_b16 a[60:61], v7 offset:26080
s_add_u32 s53, s53, 0x40000
v_mfma_f32_16x16x32_bf16 v[56:59], a[24:27], v[108:111], v[56:59]
ds_read_b64_tr_b16 a[62:63], v7 offset:26592
s_waitcnt lgkmcnt(15)
v_mfma_f32_16x16x32_bf16 v[60:63], a[28:31], v[108:111], v[60:63]
v_mfma_f32_16x16x32_bf16 v[44:47], a[28:31], v[104:107], v[44:47]
s_waitcnt vmcnt(11) lgkmcnt(14)
v_mfma_f32_16x16x32_bf16 v[32:35], a[32:35], v[112:115], v[32:35]
ds_read_b64_tr_b16 a[0:1], v7 offset:33280
ds_read_b64_tr_b16 a[2:3], v7 offset:33792
s_waitcnt vmcnt(10)
v_mfma_f32_16x16x32_bf16 v[48:51], a[32:35], v[116:119], v[48:51]
buffer_load_dwordx4 v[96:99], v4, s[16:19], s52 offen sc1
s_waitcnt lgkmcnt(14)
v_mfma_f32_16x16x32_bf16 v[52:55], a[36:39], v[116:119], v[52:55]
ds_read_b64_tr_b16 a[4:5], v7 offset:33312
ds_read_b64_tr_b16 a[6:7], v7 offset:33824
v_mfma_f32_16x16x32_bf16 v[36:39], a[36:39], v[112:115], v[36:39]
ds_read_b64_tr_b16 a[8:9], v7 offset:33344
ds_read_b64_tr_b16 a[10:11], v7 offset:33856
s_waitcnt lgkmcnt(15)
v_mfma_f32_16x16x32_bf16 v[40:43], a[40:43], v[112:115], v[40:43]
buffer_load_dwordx4 v[100:103], v4, s[16:19], s52 offen offset:1024 sc1
v_mfma_f32_16x16x32_bf16 v[56:59], a[40:43], v[116:119], v[56:59]
ds_read_b64_tr_b16 a[12:13], v7 offset:33376
s_add_u32 s52, s52, 0x40000
s_waitcnt lgkmcnt(15)
v_mfma_f32_16x16x32_bf16 v[60:63], a[44:47], v[116:119], v[60:63]
ds_read_b64_tr_b16 a[14:15], v7 offset:33888
v_mfma_f32_16x16x32_bf16 v[44:47], a[44:47], v[112:115], v[44:47]
ds_read_b64_tr_b16 a[16:17], v7 offset:34304
ds_read_b64_tr_b16 a[18:19], v7 offset:34816
.Lpad18:
s_cbranch_execz .Lnopoll67r
s_waitcnt vmcnt(11) lgkmcnt(15)
v_mfma_f32_16x16x32_bf16 v[32:35], a[48:51], v[120:123], v[32:35]
buffer_load_dwordx4 v[104:107], v4, s[16:19], s53 offen sc1
s_waitcnt vmcnt(11)
v_mfma_f32_16x16x32_bf16 v[48:51], a[48:51], v[124:127], v[48:51]
ds_read_b64_tr_b16 a[20:21], v7 offset:34336
ds_read_b64_tr_b16 a[22:23], v7 offset:34848
s_waitcnt lgkmcnt(15)
v_mfma_f32_16x16x32_bf16 v[52:55], a[52:55], v[124:127], v[52:55]
ds_read_b64_tr_b16 a[24:25], v7 offset:34368
ds_read_b64_tr_b16 a[26:27], v7 offset:34880
v_mfma_f32_16x16x32_bf16 v[36:39], a[52:55], v[120:123], v[36:39]
buffer_load_dwordx4 v[108:111], v4, s[16:19], s53 offen offset:1024 sc1
s_waitcnt lgkmcnt(15)
v_mfma_f32_16x16x32_bf16 v[40:43], a[56:59], v[120:123], v[40:43]
ds_read_b64_tr_b16 a[28:29], v7 offset:34400
s_add_u32 s53, s53, 0x40000
v_mfma_f32_16x16x32_bf16 v[56:59], a[56:59], v[124:127], v[56:59]
ds_read_b64_tr_b16 a[30:31], v7 offset:34912
s_waitcnt lgkmcnt(15)
v_mfma_f32_16x16x32_bf16 v[60:63], a[60:63], v[124:127], v[60:63]
v_mfma_f32_16x16x32_bf16 v[44:47], a[60:63], v[120:123], v[44:47]
s_waitcnt vmcnt(11) lgkmcnt(14)
v_mfma_f32_16x16x32_bf16 v[32:35], a[0:3], v[64:67], v[32:35]
ds_read_b64_tr_b16 a[32:33], v7 offset:41600
ds_read_b64_tr_b16 a[34:35], v7 offset:42112
s_waitcnt vmcnt(10)
v_mfma_f32_16x16x32_bf16 v[48:51], a[0:3], v[68:71], v[48:51]
buffer_load_dwordx4 v[112:115], v4, s[16:19], s52 offen sc1
s_waitcnt lgkmcnt(14)
v_mfma_f32_16x16x32_bf16 v[52:55], a[4:7], v[68:71], v[52:55]
ds_read_b64_tr_b16 a[36:37], v7 offset:41632
ds_read_b64_tr_b16 a[38:39], v7 offset:42144
v_mfma_f32_16x16x32_bf16 v[36:39], a[4:7], v[64:67], v[36:39]
ds_read_b64_tr_b16 a[40:41], v7 offset:41664
ds_read_b64_tr_b16 a[42:43], v7 offset:42176
s_waitcnt lgkmcnt(15)
v_mfma_f32_16x16x32_bf16 v[40:43], a[8:11], v[64:67], v[40:43]
buffer_load_dwordx4 v[116:119], v4, s[16:19], s52 offen offset:1024 sc1
v_mfma_f32_16x16x32_bf16 v[56:59], a[8:11], v[68:71], v[56:59]
ds_read_b64_tr_b16 a[44:45], v7 offset:41696
s_add_u32 s52, s52, 0x40000
s_waitcnt lgkmcnt(15)
v_mfma_f32_16x16x32_bf16 v[60:63], a[12:15], v[68:71], v[60:63]
ds_read_b64_tr_b16 a[46:47], v7 offset:42208
v_mfma_f32_16x16x32_bf16 v[44:47], a[12:15], v[64:67], v[44:47]
ds_read_b64_tr_b16 a[48:49], v7 offset:42624
ds_read_b64_tr_b16 a[50:51], v7 offset:43136
s_waitcnt vmcnt(11) lgkmcnt(15)
v_mfma_f32_16x16x32_bf16 v[32:35], a[16:19], v[72:75], v[32:35]
buffer_load_dwordx4 v[120:123], v4, s[16:19], s53 offen sc1
s_waitcnt vmcnt(11)
v_mfma_f32_16x16x32_bf16 v[48:51], a[16:19], v[76:79], v[48:51]
ds_read_b64_tr_b16 a[52:53], v7 offset:42656
ds_read_b64_tr_b16 a[54:55], v7 offset:43168
s_waitcnt lgkmcnt(15)
v_mfma_f32_16x16x32_bf16 v[52:55], a[20:23], v[76:79], v[52:55]
ds_read_b64_tr_b16 a[56:57], v7 offset:42688
ds_read_b64_tr_b16 a[58:59], v7 offset:43200
v_mfma_f32_16x16x32_bf16 v[36:39], a[20:23], v[72:75], v[36:39]
buffer_load_dwordx4 v[124:127], v4, s[16:19], s53 offen offset:1024 sc1
s_waitcnt lgkmcnt(15)
v_mfma_f32_16x16x32_bf16 v[40:43], a[24:27], v[72:75], v[40:43]
ds_read_b64_tr_b16 a[60:61], v7 offset:42720
s_add_u32 s53, s53, 0x40000
v_mfma_f32_16x16x32_bf16 v[56:59], a[24:27], v[76:79], v[56:59]
ds_read_b64_tr_b16 a[62:63], v7 offset:43232
s_waitcnt lgkmcnt(15)
v_mfma_f32_16x16x32_bf16 v[60:63], a[28:31], v[76:79], v[60:63]
v_mfma_f32_16x16x32_bf16 v[44:47], a[28:31], v[72:75], v[44:47]
s_waitcnt vmcnt(11) lgkmcnt(14)
v_mfma_f32_16x16x32_bf16 v[32:35], a[32:35], v[80:83], v[32:35]
ds_read_b64_tr_b16 a[0:1], v7 offset:49920
ds_read_b64_tr_b16 a[2:3], v7 offset:50432
s_waitcnt vmcnt(10)
v_mfma_f32_16x16x32_bf16 v[48:51], a[32:35], v[84:87], v[48:51]
buffer_load_dwordx4 v[64:67], v4, s[16:19], s52 offen sc1
s_waitcnt lgkmcnt(14)
v_mfma_f32_16x16x32_bf16 v[52:55], a[36:39], v[84:87], v[52:55]
ds_read_b64_tr_b16 a[4:5], v7 offset:49952
ds_read_b64_tr_b16 a[6:7], v7 offset:50464
v_mfma_f32_16x16x32_bf16 v[36:39], a[36:39], v[80:83], v[36:39]
ds_read_b64_tr_b16 a[8:9], v7 offset:49984
ds_read_b64_tr_b16 a[10:11], v7 offset:50496
s_waitcnt lgkmcnt(15)
v_mfma_f32_16x16x32_bf16 v[40:43], a[40:43], v[80:83], v[40:43]
buffer_load_dwordx4 v[68:71], v4, s[16:19], s52 offen offset:1024 sc1
v_mfma_f32_16x16x32_bf16 v[56:59], a[40:43], v[84:87], v[56:59]
ds_read_b64_tr_b16 a[12:13], v7 offset:50016
s_add_u32 s52, s52, 0x40000
s_waitcnt lgkmcnt(15)
v_mfma_f32_16x16x32_bf16 v[60:63], a[44:47], v[84:87], v[60:63]
ds_read_b64_tr_b16 a[14:15], v7 offset:50528
v_mfma_f32_16x16x32_bf16 v[44:47], a[44:47], v[80:83], v[44:47]
ds_read_b64_tr_b16 a[16:17], v7 offset:50944
ds_read_b64_tr_b16 a[18:19], v7 offset:51456
s_waitcnt vmcnt(11) lgkmcnt(15)
v_mfma_f32_16x16x32_bf16 v[32:35], a[48:51], v[88:91], v[32:35]
buffer_load_dwordx4 v[72:75], v4, s[16:19], s53 offen sc1
s_waitcnt vmcnt(11)
v_mfma_f32_16x16x32_bf16 v[48:51], a[48:51], v[92:95], v[48:51]
ds_read_b64_tr_b16 a[20:21], v7 offset:50976
ds_read_b64_tr_b16 a[22:23], v7 offset:51488
s_waitcnt lgkmcnt(15)
v_mfma_f32_16x16x32_bf16 v[52:55], a[52:55], v[92:95], v[52:55]
ds_read_b64_tr_b16 a[24:25], v7 offset:51008
ds_read_b64_tr_b16 a[26:27], v7 offset:51520
v_mfma_f32_16x16x32_bf16 v[36:39], a[52:55], v[88:91], v[36:39]
buffer_load_dwordx4 v[76:79], v4, s[16:19], s53 offen offset:1024 sc1
s_waitcnt lgkmcnt(15)
v_mfma_f32_16x16x32_bf16 v[40:43], a[56:59], v[88:91], v[40:43]
ds_read_b64_tr_b16 a[28:29], v7 offset:51040
s_add_u32 s53, s53, 0x40000
v_mfma_f32_16x16x32_bf16 v[56:59], a[56:59], v[92:95], v[56:59]
ds_read_b64_tr_b16 a[30:31], v7 offset:51552
s_waitcnt lgkmcnt(15)
v_mfma_f32_16x16x32_bf16 v[60:63], a[60:63], v[92:95], v[60:63]
v_mfma_f32_16x16x32_bf16 v[44:47], a[60:63], v[88:91], v[44:47]
s_waitcnt vmcnt(11) lgkmcnt(14)
v_mfma_f32_16x16x32_bf16 v[32:35], a[0:3], v[96:99], v[32:35]
ds_read_b64_tr_b16 a[32:33], v7 offset:58240
ds_read_b64_tr_b16 a[34:35], v7 offset:58752
s_waitcnt vmcnt(10)
v_mfma_f32_16x16x32_bf16 v[48:51], a[0:3], v[100:103], v[48:51]
buffer_load_dwordx4 v[80:83], v4, s[16:19], s52 offen sc1
s_waitcnt lgkmcnt(14)
v_mfma_f32_16x16x32_bf16 v[52:55], a[4:7], v[100:103], v[52:55]
ds_read_b64_tr_b16 a[36:37], v7 offset:58272
ds_read_b64_tr_b16 a[38:39], v7 offset:58784
v_mfma_f32_16x16x32_bf16 v[36:39], a[4:7], v[96:99], v[36:39]
ds_read_b64_tr_b16 a[40:41], v7 offset:58304
ds_read_b64_tr_b16 a[42:43], v7 offset:58816
s_waitcnt lgkmcnt(15)
v_mfma_f32_16x16x32_bf16 v[40:43], a[8:11], v[96:99], v[40:43]
buffer_load_dwordx4 v[84:87], v4, s[16:19], s52 offen offset:1024 sc1
v_mfma_f32_16x16x32_bf16 v[56:59], a[8:11], v[100:103], v[56:59]
ds_read_b64_tr_b16 a[44:45], v7 offset:58336
s_add_u32 s52, s52, 0x40000
s_waitcnt lgkmcnt(15)
v_mfma_f32_16x16x32_bf16 v[60:63], a[12:15], v[100:103], v[60:63]
ds_read_b64_tr_b16 a[46:47], v7 offset:58848
v_mfma_f32_16x16x32_bf16 v[44:47], a[12:15], v[96:99], v[44:47]
ds_read_b64_tr_b16 a[48:49], v7 offset:59264
ds_read_b64_tr_b16 a[50:51], v7 offset:59776
s_waitcnt vmcnt(11) lgkmcnt(15)
v_mfma_f32_16x16x32_bf16 v[32:35], a[16:19], v[104:107], v[32:35]
buffer_load_dwordx4 v[88:91], v4, s[16:19], s53 offen sc1
s_waitcnt vmcnt(11)
v_mfma_f32_16x16x32_bf16 v[48:51], a[16:19], v[108:111], v[48:51]
ds_read_b64_tr_b16 a[52:53], v7 offset:59296
ds_read_b64_tr_b16 a[54:55], v7 offset:59808
s_waitcnt lgkmcnt(15)
v_mfma_f32_16x16x32_bf16 v[52:55], a[20:23], v[108:111], v[52:55]
ds_read_b64_tr_b16 a[56:57], v7 offset:59328
ds_read_b64_tr_b16 a[58:59], v7 offset:59840
v_mfma_f32_16x16x32_bf16 v[36:39], a[20:23], v[104:107], v[36:39]
buffer_load_dwordx4 v[92:95], v4, s[16:19], s53 offen offset:1024 sc1
s_waitcnt lgkmcnt(15)
v_mfma_f32_16x16x32_bf16 v[40:43], a[24:27], v[104:107], v[40:43]
ds_read_b64_tr_b16 a[60:61], v7 offset:59360
s_add_u32 s53, s53, 0x40000
v_mfma_f32_16x16x32_bf16 v[56:59], a[24:27], v[108:111], v[56:59]
ds_read_b64_tr_b16 a[62:63], v7 offset:59872
s_waitcnt lgkmcnt(15)
v_mfma_f32_16x16x32_bf16 v[60:63], a[28:31], v[108:111], v[60:63]
v_mfma_f32_16x16x32_bf16 v[44:47], a[28:31], v[104:107], v[44:47]
s_xor_b32 s57, s57, 66560
v_add_u32 v7, s57, v8
s_waitcnt vmcnt(11) lgkmcnt(14)
v_mfma_f32_16x16x32_bf16 v[32:35], a[32:35], v[112:115], v[32:35]
ds_read_b64_tr_b16 a[0:1], v7
ds_read_b64_tr_b16 a[2:3], v7 offset:512
s_waitcnt vmcnt(10)
v_mfma_f32_16x16x32_bf16 v[48:51], a[32:35], v[116:119], v[48:51]
buffer_load_dwordx4 v[96:99], v4, s[16:19], s52 offen sc1
s_waitcnt lgkmcnt(14)
v_mfma_f32_16x16x32_bf16 v[52:55], a[36:39], v[116:119], v[52:55]
ds_read_b64_tr_b16 a[4:5], v7 offset:32
ds_read_b64_tr_b16 a[6:7], v7 offset:544
v_mfma_f32_16x16x32_bf16 v[36:39], a[36:39], v[112:115], v[36:39]
ds_read_b64_tr_b16 a[8:9], v7 offset:64
ds_read_b64_tr_b16 a[10:11], v7 offset:576
s_waitcnt lgkmcnt(15)
v_mfma_f32_16x16x32_bf16 v[40:43], a[40:43], v[112:115], v[40:43]
buffer_load_dwordx4 v[100:103], v4, s[16:19], s52 offen offset:1024 sc1
v_mfma_f32_16x16x32_bf16 v[56:59], a[40:43], v[116:119], v[56:59]
ds_read_b64_tr_b16 a[12:13], v7 offset:96
s_add_u32 s52, s52, 0x40000
s_waitcnt lgkmcnt(15)
v_mfma_f32_16x16x32_bf16 v[60:63], a[44:47], v[116:119], v[60:63]
ds_read_b64_tr_b16 a[14:15], v7 offset:608
v_mfma_f32_16x16x32_bf16 v[44:47], a[44:47], v[112:115], v[44:47]
ds_read_b64_tr_b16 a[16:17], v7 offset:1024
ds_read_b64_tr_b16 a[18:19], v7 offset:1536
s_waitcnt vmcnt(11) lgkmcnt(15)
v_mfma_f32_16x16x32_bf16 v[32:35], a[48:51], v[120:123], v[32:35]
buffer_load_dwordx4 v[104:107], v4, s[16:19], s53 offen sc1
s_waitcnt vmcnt(11)
v_mfma_f32_16x16x32_bf16 v[48:51], a[48:51], v[124:127], v[48:51]
ds_read_b64_tr_b16 a[20:21], v7 offset:1056
ds_read_b64_tr_b16 a[22:23], v7 offset:1568
s_waitcnt lgkmcnt(15)
v_mfma_f32_16x16x32_bf16 v[52:55], a[52:55], v[124:127], v[52:55]
ds_read_b64_tr_b16 a[24:25], v7 offset:1088
ds_read_b64_tr_b16 a[26:27], v7 offset:1600
v_mfma_f32_16x16x32_bf16 v[36:39], a[52:55], v[120:123], v[36:39]
buffer_load_dwordx4 v[108:111], v4, s[16:19], s53 offen offset:1024 sc1
s_waitcnt lgkmcnt(15)
v_mfma_f32_16x16x32_bf16 v[40:43], a[56:59], v[120:123], v[40:43]
ds_read_b64_tr_b16 a[28:29], v7 offset:1120
s_add_u32 s53, s53, 0x40000
v_mfma_f32_16x16x32_bf16 v[56:59], a[56:59], v[124:127], v[56:59]
ds_read_b64_tr_b16 a[30:31], v7 offset:1632
s_waitcnt lgkmcnt(15)
v_mfma_f32_16x16x32_bf16 v[60:63], a[60:63], v[124:127], v[60:63]
v_mfma_f32_16x16x32_bf16 v[44:47], a[60:63], v[120:123], v[44:47]
s_waitcnt vmcnt(11) lgkmcnt(14)
v_mfma_f32_16x16x32_bf16 v[32:35], a[0:3], v[64:67], v[32:35]
ds_read_b64_tr_b16 a[32:33], v7 offset:8320
ds_read_b64_tr_b16 a[34:35], v7 offset:8832
s_waitcnt vmcnt(10)
v_mfma_f32_16x16x32_bf16 v[48:51], a[0:3], v[68:71], v[48:51]
buffer_load_dwordx4 v[112:115], v4, s[16:19], s52 offen sc1
s_waitcnt lgkmcnt(14)
v_mfma_f32_16x16x32_bf16 v[52:55], a[4:7], v[68:71], v[52:55]
ds_read_b64_tr_b16 a[36:37], v7 offset:8352
ds_read_b64_tr_b16 a[38:39], v7 offset:8864
v_mfma_f32_16x16x32_bf16 v[36:39], a[4:7], v[64:67], v[36:39]
ds_read_b64_tr_b16 a[40:41], v7 offset:8384
ds_read_b64_tr_b16 a[42:43], v7 offset:8896
s_waitcnt lgkmcnt(15)
v_mfma_f32_16x16x32_bf16 v[40:43], a[8:11], v[64:67], v[40:43]
buffer_load_dwordx4 v[116:119], v4, s[16:19], s52 offen offset:1024 sc1
v_mfma_f32_16x16x32_bf16 v[56:59], a[8:11], v[68:71], v[56:59]
ds_read_b64_tr_b16 a[44:45], v7 offset:8416
s_add_u32 s52, s52, 0x40000
s_waitcnt lgkmcnt(15)
v_mfma_f32_16x16x32_bf16 v[60:63], a[12:15], v[68:71], v[60:63]
ds_read_b64_tr_b16 a[46:47], v7 offset:8928
v_mfma_f32_16x16x32_bf16 v[44:47], a[12:15], v[64:67], v[44:47]
ds_read_b64_tr_b16 a[48:49], v7 offset:9344
ds_read_b64_tr_b16 a[50:51], v7 offset:9856
s_waitcnt vmcnt(11) lgkmcnt(15)
v_mfma_f32_16x16x32_bf16 v[32:35], a[16:19], v[72:75], v[32:35]
buffer_load_dwordx4 v[120:123], v4, s[16:19], s53 offen sc1
s_waitcnt vmcnt(11)
v_mfma_f32_16x16x32_bf16 v[48:51], a[16:19], v[76:79], v[48:51]
ds_read_b64_tr_b16 a[52:53], v7 offset:9376
ds_read_b64_tr_b16 a[54:55], v7 offset:9888
s_waitcnt lgkmcnt(15)
v_mfma_f32_16x16x32_bf16 v[52:55], a[20:23], v[76:79], v[52:55]
ds_read_b64_tr_b16 a[56:57], v7 offset:9408
ds_read_b64_tr_b16 a[58:59], v7 offset:9920
v_mfma_f32_16x16x32_bf16 v[36:39], a[20:23], v[72:75], v[36:39]
buffer_load_dwordx4 v[124:127], v4, s[16:19], s53 offen offset:1024 sc1
s_waitcnt lgkmcnt(15)
v_mfma_f32_16x16x32_bf16 v[40:43], a[24:27], v[72:75], v[40:43]
ds_read_b64_tr_b16 a[60:61], v7 offset:9440
s_add_u32 s53, s53, 0x40000
v_mfma_f32_16x16x32_bf16 v[56:59], a[24:27], v[76:79], v[56:59]
ds_read_b64_tr_b16 a[62:63], v7 offset:9952
s_waitcnt lgkmcnt(15)
v_mfma_f32_16x16x32_bf16 v[60:63], a[28:31], v[76:79], v[60:63]
v_mfma_f32_16x16x32_bf16 v[44:47], a[28:31], v[72:75], v[44:47]
s_waitcnt vmcnt(11) lgkmcnt(14)
v_mfma_f32_16x16x32_bf16 v[32:35], a[32:35], v[80:83], v[32:35]
ds_read_b64_tr_b16 a[0:1], v7 offset:16640
ds_read_b64_tr_b16 a[2:3], v7 offset:17152
s_waitcnt vmcnt(10)
v_mfma_f32_16x16x32_bf16 v[48:51], a[32:35], v[84:87], v[48:51]
buffer_load_dwordx4 v[64:67], v4, s[16:19], s52 offen sc1
s_waitcnt lgkmcnt(14)
v_mfma_f32_16x16x32_bf16 v[52:55], a[36:39], v[84:87], v[52:55]
ds_read_b64_tr_b16 a[4:5], v7 offset:16672
ds_read_b64_tr_b16 a[6:7], v7 offset:17184
v_mfma_f32_16x16x32_bf16 v[36:39], a[36:39], v[80:83], v[36:39]
ds_read_b64_tr_b16 a[8:9], v7 offset:16704
ds_read_b64_tr_b16 a[10:11], v7 offset:17216
s_waitcnt lgkmcnt(15)
v_mfma_f32_16x16x32_bf16 v[40:43], a[40:43], v[80:83], v[40:43]
buffer_load_dwordx4 v[68:71], v4, s[16:19], s52 offen offset:1024 sc1
v_mfma_f32_16x16x32_bf16 v[56:59], a[40:43], v[84:87], v[56:59]
ds_read_b64_tr_b16 a[12:13], v7 offset:16736
s_add_u32 s52, s52, 0x40000
s_waitcnt lgkmcnt(15)
v_mfma_f32_16x16x32_bf16 v[60:63], a[44:47], v[84:87], v[60:63]
ds_read_b64_tr_b16 a[14:15], v7 offset:17248
v_mfma_f32_16x16x32_bf16 v[44:47], a[44:47], v[80:83], v[44:47]
ds_read_b64_tr_b16 a[16:17], v7 offset:17664
ds_read_b64_tr_b16 a[18:19], v7 offset:18176
s_waitcnt vmcnt(11) lgkmcnt(15)
v_mfma_f32_16x16x32_bf16 v[32:35], a[48:51], v[88:91], v[32:35]
buffer_load_dwordx4 v[72:75], v4, s[16:19], s53 offen sc1
s_waitcnt vmcnt(11)
v_mfma_f32_16x16x32_bf16 v[48:51], a[48:51], v[92:95], v[48:51]
ds_read_b64_tr_b16 a[20:21], v7 offset:17696
ds_read_b64_tr_b16 a[22:23], v7 offset:18208
s_waitcnt lgkmcnt(15)
v_mfma_f32_16x16x32_bf16 v[52:55], a[52:55], v[92:95], v[52:55]
ds_read_b64_tr_b16 a[24:25], v7 offset:17728
ds_read_b64_tr_b16 a[26:27], v7 offset:18240
v_mfma_f32_16x16x32_bf16 v[36:39], a[52:55], v[88:91], v[36:39]
buffer_load_dwordx4 v[76:79], v4, s[16:19], s53 offen offset:1024 sc1
s_waitcnt lgkmcnt(15)
v_mfma_f32_16x16x32_bf16 v[40:43], a[56:59], v[88:91], v[40:43]
ds_read_b64_tr_b16 a[28:29], v7 offset:17760
s_add_u32 s53, s53, 0x40000
v_mfma_f32_16x16x32_bf16 v[56:59], a[56:59], v[92:95], v[56:59]
ds_read_b64_tr_b16 a[30:31], v7 offset:18272
s_waitcnt lgkmcnt(15)
v_mfma_f32_16x16x32_bf16 v[60:63], a[60:63], v[92:95], v[60:63]
v_mfma_f32_16x16x32_bf16 v[44:47], a[60:63], v[88:91], v[44:47]
s_waitcnt vmcnt(11) lgkmcnt(14)
v_mfma_f32_16x16x32_bf16 v[32:35], a[0:3], v[96:99], v[32:35]
ds_read_b64_tr_b16 a[32:33], v7 offset:24960
ds_read_b64_tr_b16 a[34:35], v7 offset:25472
s_waitcnt vmcnt(10)
v_mfma_f32_16x16x32_bf16 v[48:51], a[0:3], v[100:103], v[48:51]
buffer_load_dwordx4 v[80:83], v4, s[16:19], s52 offen sc1
s_waitcnt lgkmcnt(14)
v_mfma_f32_16x16x32_bf16 v[52:55], a[4:7], v[100:103], v[52:55]
ds_read_b64_tr_b16 a[36:37], v7 offset:24992
ds_read_b64_tr_b16 a[38:39], v7 offset:25504
v_mfma_f32_16x16x32_bf16 v[36:39], a[4:7], v[96:99], v[36:39]
ds_read_b64_tr_b16 a[40:41], v7 offset:25024
ds_read_b64_tr_b16 a[42:43], v7 offset:25536
s_waitcnt lgkmcnt(15)
v_mfma_f32_16x16x32_bf16 v[40:43], a[8:11], v[96:99], v[40:43]
buffer_load_dwordx4 v[84:87], v4, s[16:19], s52 offen offset:1024 sc1
v_mfma_f32_16x16x32_bf16 v[56:59], a[8:11], v[100:103], v[56:59]
ds_read_b64_tr_b16 a[44:45], v7 offset:25056
s_add_u32 s52, s52, 0x40000
s_waitcnt lgkmcnt(15)
v_mfma_f32_16x16x32_bf16 v[60:63], a[12:15], v[100:103], v[60:63]
ds_read_b64_tr_b16 a[46:47], v7 offset:25568
v_mfma_f32_16x16x32_bf16 v[44:47], a[12:15], v[96:99], v[44:47]
ds_read_b64_tr_b16 a[48:49], v7 offset:25984
ds_read_b64_tr_b16 a[50:51], v7 offset:26496
s_waitcnt vmcnt(11) lgkmcnt(15)
v_mfma_f32_16x16x32_bf16 v[32:35], a[16:19], v[104:107], v[32:35]
buffer_load_dwordx4 v[88:91], v4, s[16:19], s53 offen sc1
s_waitcnt vmcnt(11)
v_mfma_f32_16x16x32_bf16 v[48:51], a[16:19], v[108:111], v[48:51]
ds_read_b64_tr_b16 a[52:53], v7 offset:26016
ds_read_b64_tr_b16 a[54:55], v7 offset:26528
s_waitcnt lgkmcnt(15)
v_mfma_f32_16x16x32_bf16 v[52:55], a[20:23], v[108:111], v[52:55]
ds_read_b64_tr_b16 a[56:57], v7 offset:26048
ds_read_b64_tr_b16 a[58:59], v7 offset:26560
v_mfma_f32_16x16x32_bf16 v[36:39], a[20:23], v[104:107], v[36:39]
buffer_load_dwordx4 v[92:95], v4, s[16:19], s53 offen offset:1024 sc1
s_waitcnt lgkmcnt(15)
v_mfma_f32_16x16x32_bf16 v[40:43], a[24:27], v[104:107], v[40:43]
ds_read_b64_tr_b16 a[60:61], v7 offset:26080
s_add_u32 s53, s53, 0x40000
v_mfma_f32_16x16x32_bf16 v[56:59], a[24:27], v[108:111], v[56:59]
ds_read_b64_tr_b16 a[62:63], v7 offset:26592
s_waitcnt lgkmcnt(15)
v_mfma_f32_16x16x32_bf16 v[60:63], a[28:31], v[108:111], v[60:63]
v_mfma_f32_16x16x32_bf16 v[44:47], a[28:31], v[104:107], v[44:47]
s_waitcnt vmcnt(11) lgkmcnt(14)
v_mfma_f32_16x16x32_bf16 v[32:35], a[32:35], v[112:115], v[32:35]
ds_read_b64_tr_b16 a[0:1], v7 offset:33280
ds_read_b64_tr_b16 a[2:3], v7 offset:33792
s_waitcnt vmcnt(10)
v_mfma_f32_16x16x32_bf16 v[48:51], a[32:35], v[116:119], v[48:51]
buffer_load_dwordx4 v[96:99], v4, s[16:19], s52 offen sc1
s_waitcnt lgkmcnt(14)
v_mfma_f32_16x16x32_bf16 v[52:55], a[36:39], v[116:119], v[52:55]
ds_read_b64_tr_b16 a[4:5], v7 offset:33312
ds_read_b64_tr_b16 a[6:7], v7 offset:33824
v_mfma_f32_16x16x32_bf16 v[36:39], a[36:39], v[112:115], v[36:39]
ds_read_b64_tr_b16 a[8:9], v7 offset:33344
ds_read_b64_tr_b16 a[10:11], v7 offset:33856
s_waitcnt lgkmcnt(15)
v_mfma_f32_16x16x32_bf16 v[40:43], a[40:43], v[112:115], v[40:43]
buffer_load_dwordx4 v[100:103], v4, s[16:19], s52 offen offset:1024 sc1
v_mfma_f32_16x16x32_bf16 v[56:59], a[40:43], v[116:119], v[56:59]
ds_read_b64_tr_b16 a[12:13], v7 offset:33376
s_add_u32 s52, s52, 0x40000
s_waitcnt lgkmcnt(15)
v_mfma_f32_16x16x32_bf16 v[60:63], a[44:47], v[116:119], v[60:63]
ds_read_b64_tr_b16 a[14:15], v7 offset:33888
v_mfma_f32_16x16x32_bf16 v[44:47], a[44:47], v[112:115], v[44:47]
ds_read_b64_tr_b16 a[16:17], v7 offset:34304
ds_read_b64_tr_b16 a[18:19], v7 offset:34816
s_waitcnt vmcnt(11) lgkmcnt(15)
v_mfma_f32_16x16x32_bf16 v[32:35], a[48:51], v[120:123], v[32:35]
buffer_load_dwordx4 v[104:107], v4, s[16:19], s53 offen sc1
s_waitcnt vmcnt(11)
v_mfma_f32_16x16x32_bf16 v[48:51], a[48:51], v[124:127], v[48:51]
ds_read_b64_tr_b16 a[20:21], v7 offset:34336
ds_read_b64_tr_b16 a[22:23], v7 offset:34848
s_waitcnt lgkmcnt(15)
v_mfma_f32_16x16x32_bf16 v[52:55], a[52:55], v[124:127], v[52:55]
ds_read_b64_tr_b16 a[24:25], v7 offset:34368
ds_read_b64_tr_b16 a[26:27], v7 offset:34880
v_mfma_f32_16x16x32_bf16 v[36:39], a[52:55], v[120:123], v[36:39]
buffer_load_dwordx4 v[108:111], v4, s[16:19], s53 offen offset:1024 sc1
s_waitcnt lgkmcnt(15)
v_mfma_f32_16x16x32_bf16 v[40:43], a[56:59], v[120:123], v[40:43]
ds_read_b64_tr_b16 a[28:29], v7 offset:34400
s_add_u32 s53, s53, 0x40000
v_mfma_f32_16x16x32_bf16 v[56:59], a[56:59], v[124:127], v[56:59]
ds_read_b64_tr_b16 a[30:31], v7 offset:34912
s_waitcnt lgkmcnt(15)
v_mfma_f32_16x16x32_bf16 v[60:63], a[60:63], v[124:127], v[60:63]
v_mfma_f32_16x16x32_bf16 v[44:47], a[60:63], v[120:123], v[44:47]
s_waitcnt vmcnt(11) lgkmcnt(14)
v_mfma_f32_16x16x32_bf16 v[32:35], a[0:3], v[64:67], v[32:35]
ds_read_b64_tr_b16 a[32:33], v7 offset:41600
ds_read_b64_tr_b16 a[34:35], v7 offset:42112
s_waitcnt vmcnt(10)
v_mfma_f32_16x16x32_bf16 v[48:51], a[0:3], v[68:71], v[48:51]
buffer_load_dwordx4 v[112:115], v4, s[16:19], s52 offen sc1
s_waitcnt lgkmcnt(14)
v_mfma_f32_16x16x32_bf16 v[52:55], a[4:7], v[68:71], v[52:55]
ds_read_b64_tr_b16 a[36:37], v7 offset:41632
ds_read_b64_tr_b16 a[38:39], v7 offset:42144
v_mfma_f32_16x16x32_bf16 v[36:39], a[4:7], v[64:67], v[36:39]
ds_read_b64_tr_b16 a[40:41], v7 offset:41664
ds_read_b64_tr_b16 a[42:43], v7 offset:42176
s_waitcnt lgkmcnt(15)
v_mfma_f32_16x16x32_bf16 v[40:43], a[8:11], v[64:67], v[40:43]
buffer_load_dwordx4 v[116:119], v4, s[16:19], s52 offen offset:1024 sc1
v_mfma_f32_16x16x32_bf16 v[56:59], a[8:11], v[68:71], v[56:59]
ds_read_b64_tr_b16 a[44:45], v7 offset:41696
s_add_u32 s52, s52, 0x40000
s_waitcnt lgkmcnt(15)
v_mfma_f32_16x16x32_bf16 v[60:63], a[12:15], v[68:71], v[60:63]
ds_read_b64_tr_b16 a[46:47], v7 offset:42208
v_mfma_f32_16x16x32_bf16 v[44:47], a[12:15], v[64:67], v[44:47]
ds_read_b64_tr_b16 a[48:49], v7 offset:42624
ds_read_b64_tr_b16 a[50:51], v7 offset:43136
s_waitcnt vmcnt(11) lgkmcnt(15)
v_mfma_f32_16x16x32_bf16 v[32:35], a[16:19], v[72:75], v[32:35]
buffer_load_dwordx4 v[120:123], v4, s[16:19], s53 offen sc1
s_waitcnt vmcnt(11)
v_mfma_f32_16x16x32_bf16 v[48:51], a[16:19], v[76:79], v[48:51]
ds_read_b64_tr_b16 a[52:53], v7 offset:42656
ds_read_b64_tr_b16 a[54:55], v7 offset:43168
s_waitcnt lgkmcnt(15)
v_mfma_f32_16x16x32_bf16 v[52:55], a[20:23], v[76:79], v[52:55]
ds_read_b64_tr_b16 a[56:57], v7 offset:42688
ds_read_b64_tr_b16 a[58:59], v7 offset:43200
v_mfma_f32_16x16x32_bf16 v[36:39], a[20:23], v[72:75], v[36:39]
buffer_load_dwordx4 v[124:127], v4, s[16:19], s53 offen offset:1024 sc1
s_waitcnt lgkmcnt(15)
v_mfma_f32_16x16x32_bf16 v[40:43], a[24:27], v[72:75], v[40:43]
ds_read_b64_tr_b16 a[60:61], v7 offset:42720
s_add_u32 s53, s53, 0x40000
v_mfma_f32_16x16x32_bf16 v[56:59], a[24:27], v[76:79], v[56:59]
ds_read_b64_tr_b16 a[62:63], v7 offset:43232
s_waitcnt lgkmcnt(15)
v_mfma_f32_16x16x32_bf16 v[60:63], a[28:31], v[76:79], v[60:63]
v_mfma_f32_16x16x32_bf16 v[44:47], a[28:31], v[72:75], v[44:47]
s_waitcnt lgkmcnt(0)
s_barrier
s_waitcnt vmcnt(11)
v_mfma_f32_16x16x32_bf16 v[32:35], a[32:35], v[80:83], v[32:35]
ds_read_b64_tr_b16 a[0:1], v7 offset:49920
ds_read_b64_tr_b16 a[2:3], v7 offset:50432
s_add_u32 m0, s59, 84480
s_waitcnt vmcnt(10)
v_mfma_f32_16x16x32_bf16 v[48:51], a[32:35], v[84:87], v[48:51]
ds_read_b64_tr_b16 a[4:5], v7 offset:49952
buffer_load_dwordx4 v12, s[32:35], s58 offen lds
v_mfma_f32_16x16x32_bf16 v[52:55], a[36:39], v[84:87], v[52:55]
ds_read_b64_tr_b16 a[6:7], v7 offset:50464
ds_read_b64_tr_b16 a[8:9], v7 offset:49984
v_mfma_f32_16x16x32_bf16 v[36:39], a[36:39], v[80:83], v[36:39]
ds_read_b64_tr_b16 a[10:11], v7 offset:50496
v_mfma_f32_16x16x32_bf16 v[40:43], a[40:43], v[80:83], v[40:43]
ds_read_b64_tr_b16 a[12:13], v7 offset:50016
buffer_load_dwordx4 v13, s[32:35], s58 offen offset:1056 lds
v_mfma_f32_16x16x32_bf16 v[56:59], a[40:43], v[84:87], v[56:59]
ds_read_b64_tr_b16 a[14:15], v7 offset:50528
ds_read_b64_tr_b16 a[16:17], v7 offset:50944
v_mfma_f32_16x16x32_bf16 v[60:63], a[44:47], v[84:87], v[60:63]
ds_read_b64_tr_b16 a[18:19], v7 offset:51456
ds_read_b64_tr_b16 a[20:21], v7 offset:50976
v_mfma_f32_16x16x32_bf16 v[44:47], a[44:47], v[80:83], v[44:47]
ds_read_b64_tr_b16 a[22:23], v7 offset:51488
s_waitcnt vmcnt(11)
v_mfma_f32_16x16x32_bf16 v[32:35], a[48:51], v[88:91], v[32:35]
ds_read_b64_tr_b16 a[24:25], v7 offset:51008
buffer_load_dwordx4 v14, s[32:35], s58 offen offset:2112 lds
s_waitcnt vmcnt(11)
v_mfma_f32_16x16x32_bf16 v[48:51], a[48:51], v[92:95], v[48:51]
ds_read_b64_tr_b16 a[26:27], v7 offset:51520
ds_read_b64_tr_b16 a[28:29], v7 offset:51040
v_mfma_f32_16x16x32_bf16 v[52:55], a[52:55], v[92:95], v[52:55]
ds_read_b64_tr_b16 a[30:31], v7 offset:51552
v_mfma_f32_16x16x32_bf16 v[36:39], a[52:55], v[88:91], v[36:39]
buffer_load_dwordx4 v15, s[32:35], s58 offen offset:3168 lds
v_mfma_f32_16x16x32_bf16 v[40:43], a[56:59], v[88:91], v[40:43]
s_add_u32 s58, s58, 229376
v_mfma_f32_16x16x32_bf16 v[56:59], a[56:59], v[92:95], v[56:59]
v_mfma_f32_16x16x32_bf16 v[60:63], a[60:63], v[92:95], v[60:63]
v_mfma_f32_16x16x32_bf16 v[44:47], a[60:63], v[88:91], v[44:47]
s_waitcnt vmcnt(11) lgkmcnt(14)
v_mfma_f32_16x16x32_bf16 v[32:35], a[0:3], v[96:99], v[32:35]
ds_read_b64_tr_b16 a[32:33], v7 offset:58240
s_add_u32 m0, s59, 101376
s_waitcnt vmcnt(10)
v_mfma_f32_16x16x32_bf16 v[48:51], a[0:3], v[100:103], v[48:51]
buffer_load_dwordx4 v12, s[32:35], s58 offen lds
s_waitcnt lgkmcnt(13)
v_mfma_f32_16x16x32_bf16 v[52:55], a[4:7], v[100:103], v[52:55]
ds_read_b64_tr_b16 a[34:35], v7 offset:58752
ds_read_b64_tr_b16 a[36:37], v7 offset:58272
v_mfma_f32_16x16x32_bf16 v[36:39], a[4:7], v[96:99], v[36:39]
ds_read_b64_tr_b16 a[38:39], v7 offset:58784
ds_read_b64_tr_b16 a[40:41], v7 offset:58304
s_waitcnt lgkmcnt(15)
v_mfma_f32_16x16x32_bf16 v[40:43], a[8:11], v[96:99], v[40:43]
buffer_load_dwordx4 v13, s[32:35], s58 offen offset:1056 lds
v_mfma_f32_16x16x32_bf16 v[56:59], a[8:11], v[100:103], v[56:59]
ds_read_b64_tr_b16 a[42:43], v7 offset:58816
ds_read_b64_tr_b16 a[44:45], v7 offset:58336
s_waitcnt lgkmcnt(15)
v_mfma_f32_16x16x32_bf16 v[60:63], a[12:15], v[100:103], v[60:63]
ds_read_b64_tr_b16 a[46:47], v7 offset:58848
v_mfma_f32_16x16x32_bf16 v[44:47], a[12:15], v[96:99], v[44:47]
ds_read_b64_tr_b16 a[48:49], v7 offset:59264
ds_read_b64_tr_b16 a[50:51], v7 offset:59776
s_waitcnt vmcnt(11) lgkmcnt(15)
v_mfma_f32_16x16x32_bf16 v[32:35], a[16:19], v[104:107], v[32:35]
buffer_load_dwordx4 v14, s[32:35], s58 offen offset:2112 lds
s_waitcnt vmcnt(11)
v_mfma_f32_16x16x32_bf16 v[48:51], a[16:19], v[108:111], v[48:51]
ds_read_b64_tr_b16 a[52:53], v7 offset:59296
ds_read_b64_tr_b16 a[54:55], v7 offset:59808
s_waitcnt lgkmcnt(15)
v_mfma_f32_16x16x32_bf16 v[52:55], a[20:23], v[108:111], v[52:55]
ds_read_b64_tr_b16 a[56:57], v7 offset:59328
ds_read_b64_tr_b16 a[58:59], v7 offset:59840
v_mfma_f32_16x16x32_bf16 v[36:39], a[20:23], v[104:107], v[36:39]
buffer_load_dwordx4 v15, s[32:35], s58 offen offset:3168 lds
s_waitcnt lgkmcnt(15)
v_mfma_f32_16x16x32_bf16 v[40:43], a[24:27], v[104:107], v[40:43]
ds_read_b64_tr_b16 a[60:61], v7 offset:59360
s_add_u32 s58, s58, 229376
v_mfma_f32_16x16x32_bf16 v[56:59], a[24:27], v[108:111], v[56:59]
ds_read_b64_tr_b16 a[62:63], v7 offset:59872
s_waitcnt lgkmcnt(15)
v_mfma_f32_16x16x32_bf16 v[60:63], a[28:31], v[108:111], v[60:63]
v_mfma_f32_16x16x32_bf16 v[44:47], a[28:31], v[104:107], v[44:47]
s_waitcnt vmcnt(11) lgkmcnt(14)
v_mfma_f32_16x16x32_bf16 v[32:35], a[32:35], v[112:115], v[32:35]
s_add_u32 m0, s59, 118272
s_lshl_b32 s64, s6, 14
s_lshl_b32 s65, s49, 13
s_waitcnt vmcnt(10)
v_mfma_f32_16x16x32_bf16 v[48:51], a[32:35], v[116:119], v[48:51]
buffer_load_dwordx4 v12, s[32:35], s58 offen lds
s_waitcnt lgkmcnt(12)
v_mfma_f32_16x16x32_bf16 v[52:55], a[36:39], v[116:119], v[52:55]
s_add_u32 s64, s64, s65
s_lshl_b32 s65, s7, 9
s_add_u32 s64, s64, s65
v_mfma_f32_16x16x32_bf16 v[36:39], a[36:39], v[112:115], v[36:39]
s_lshl_b32 s65, s48, 8
s_add_u32 s64, s64, s65
s_add_u32 s64, s64, 63176704
s_waitcnt lgkmcnt(10)
v_mfma_f32_16x16x32_bf16 v[40:43], a[40:43], v[112:115], v[40:43]
s_lshl_b32 s62, s7, 18
v_and_b32 v152, 31, v1
v_lshlrev_b32 v152, 3, v152
v_mfma_f32_16x16x32_bf16 v[56:59], a[40:43], v[116:119], v[56:59]
buffer_load_dwordx4 v13, s[32:35], s58 offen offset:1056 lds
s_waitcnt lgkmcnt(8)
v_mfma_f32_16x16x32_bf16 v[60:63], a[44:47], v[116:119], v[60:63]
s_add_u32 s62, s62, 41943040
.Lpad19:
s_cbranch_execz .Lnopoll67r
v_lshrrev_b32 v153, 5, v1
v_lshl_add_u32 v152, v153, 28, v152
v_mfma_f32_16x16x32_bf16 v[44:47], a[44:47], v[112:115], v[44:47]
s_add_u32 s63, s62, 0x20000
s_waitcnt vmcnt(11) lgkmcnt(6)
v_mfma_f32_16x16x32_bf16 v[32:35], a[48:51], v[120:123], v[32:35]
s_waitcnt vmcnt(10)
v_mfma_f32_16x16x32_bf16 v[48:51], a[48:51], v[124:127], v[48:51]
buffer_load_dwordx4 v14, s[32:35], s58 offen offset:2112 lds
s_waitcnt lgkmcnt(4)
v_mfma_f32_16x16x32_bf16 v[52:55], a[52:55], v[124:127], v[52:55]
s_nop 2
v_cvt_pk_bf16_f32 v128, v32, v33
v_cvt_pk_bf16_f32 v129, v34, v35
v_mfma_f32_16x16x32_bf16 v[36:39], a[52:55], v[120:123], v[36:39]
v_cvt_pk_bf16_f32 v136, v48, v49
v_cvt_pk_bf16_f32 v137, v50, v51
s_waitcnt lgkmcnt(2)
v_mfma_f32_16x16x32_bf16 v[40:43], a[56:59], v[120:123], v[40:43]
v_cvt_pk_bf16_f32 v138, v52, v53
v_cvt_pk_bf16_f32 v139, v54, v55
v_mfma_f32_16x16x32_bf16 v[56:59], a[56:59], v[124:127], v[56:59]
buffer_load_dwordx4 v15, s[32:35], s58 offen offset:3168 lds
s_waitcnt lgkmcnt(0)
v_mfma_f32_16x16x32_bf16 v[60:63], a[60:63], v[124:127], v[60:63]
s_add_u32 s58, s58, 229376
v_cvt_pk_bf16_f32 v130, v36, v37
v_cvt_pk_bf16_f32 v131, v38, v39
v_mfma_f32_16x16x32_bf16 v[44:47], a[60:63], v[120:123], v[44:47]
v_cvt_pk_bf16_f32 v132, v40, v41
v_cvt_pk_bf16_f32 v133, v42, v43
v_cvt_pk_bf16_f32 v140, v56, v57
v_cvt_pk_bf16_f32 v141, v58, v59
v_cvt_pk_bf16_f32 v142, v60, v61
v_cvt_pk_bf16_f32 v143, v62, v63
v_pk_mul_f32 v[146:147], v[32:33], v[32:33]
buffer_store_dwordx4 v[128:131], v4, s[16:19], s62 offen sc1
v_cvt_pk_bf16_f32 v134, v44, v45
v_cvt_pk_bf16_f32 v135, v46, v47
v_pk_mul_f32 v[150:151], v[48:49], v[48:49]
v_pk_fma_f32 v[146:147], v[34:35], v[34:35], v[146:147]
v_pk_add_f32 v[144:145], v[32:33], v[34:35]
v_pk_fma_f32 v[150:151], v[50:51], v[50:51], v[150:151]
v_pk_add_f32 v[148:149], v[48:49], v[50:51]
v_pk_fma_f32 v[146:147], v[36:37], v[36:37], v[146:147]
v_pk_add_f32 v[144:145], v[144:145], v[36:37]
v_pk_fma_f32 v[150:151], v[52:53], v[52:53], v[150:151]
v_pk_add_f32 v[148:149], v[148:149], v[52:53]
v_pk_fma_f32 v[146:147], v[38:39], v[38:39], v[146:147]
v_pk_add_f32 v[144:145], v[144:145], v[38:39]
buffer_store_dwordx4 v[132:135], v4, s[16:19], s63 offen sc1
v_pk_fma_f32 v[150:151], v[54:55], v[54:55], v[150:151]
v_pk_add_f32 v[148:149], v[148:149], v[54:55]
v_pk_fma_f32 v[146:147], v[40:41], v[40:41], v[146:147]
v_pk_add_f32 v[144:145], v[144:145], v[40:41]
v_pk_fma_f32 v[150:151], v[56:57], v[56:57], v[150:151]
v_pk_add_f32 v[148:149], v[148:149], v[56:57]
v_pk_fma_f32 v[146:147], v[42:43], v[42:43], v[146:147]
v_pk_add_f32 v[144:145], v[144:145], v[42:43]
v_pk_fma_f32 v[150:151], v[58:59], v[58:59], v[150:151]
v_pk_add_f32 v[148:149], v[148:149], v[58:59]
v_pk_fma_f32 v[146:147], v[44:45], v[44:45], v[146:147]
v_pk_add_f32 v[144:145], v[144:145], v[44:45]
v_pk_fma_f32 v[150:151], v[60:61], v[60:61], v[150:151]
buffer_store_dwordx4 v[136:139], v4, s[16:19], s62 offen offset:1024 sc1
v_pk_add_f32 v[148:149], v[148:149], v[60:61]
v_pk_fma_f32 v[146:147], v[46:47], v[46:47], v[146:147]
v_pk_add_f32 v[144:145], v[144:145], v[46:47]
v_pk_fma_f32 v[150:151], v[62:63], v[62:63], v[150:151]
v_pk_add_f32 v[148:149], v[148:149], v[62:63]
v_add_f32 v144, v144, v145
v_add_f32 v146, v146, v147
v_add_f32 v148, v148, v149
v_add_f32 v150, v150, v151
s_nop 0
v_permlane16_swap_b32 v144, v148
v_permlane16_swap_b32 v146, v150
v_add_f32 v144, v144, v148
buffer_store_dwordx4 v[140:143], v4, s[16:19], s63 offen offset:1024 sc1
v_add_f32 v146, v146, v150
s_nop 1
v_permlane32_swap_b32 v144, v146
v_add_f32 v144, v144, v146
s_nop 1
v_permlane32_swap_b32 v144, v145
buffer_store_dwordx2 v[144:145], v152, s[16:19], s64 offen sc1
s_nop 1
v_accvgpr_write_b32 a224, v32
v_accvgpr_write_b32 a225, v33
v_accvgpr_write_b32 a226, v34
v_accvgpr_write_b32 a227, v35
v_accvgpr_write_b32 a228, v36
v_accvgpr_write_b32 a229, v37
v_accvgpr_write_b32 a230, v38
v_accvgpr_write_b32 a231, v39
v_accvgpr_write_b32 a232, v40
v_accvgpr_write_b32 a233, v41
v_accvgpr_write_b32 a234, v42
v_accvgpr_write_b32 a235, v43
v_accvgpr_write_b32 a236, v44
v_accvgpr_write_b32 a237, v45
v_accvgpr_write_b32 a238, v46
v_accvgpr_write_b32 a239, v47
v_accvgpr_write_b32 a240, v48
v_accvgpr_write_b32 a241, v49
v_accvgpr_write_b32 a242, v50
v_accvgpr_write_b32 a243, v51
v_accvgpr_write_b32 a244, v52
v_accvgpr_write_b32 a245, v53
v_accvgpr_write_b32 a246, v54
v_accvgpr_write_b32 a247, v55
v_accvgpr_write_b32 a248, v56
v_accvgpr_write_b32 a249, v57
v_accvgpr_write_b32 a250, v58
v_accvgpr_write_b32 a251, v59
v_accvgpr_write_b32 a252, v60
v_accvgpr_write_b32 a253, v61
v_accvgpr_write_b32 a254, v62
v_accvgpr_write_b32 a255, v63
s_lshl_b32 s62, s10, 14
s_lshl_b32 s63, s3, 12
s_add_u32 s62, s62, s63
s_lshl_b32 s63, s12, 11
s_add_u32 s62, s62, s63
v_lshl_add_u32 v10, v1, 4, s62
v_xor_b32 v11, 2048, v10
v_bfe_u32 v16, v1, 2, 3
v_mul_u32_u24 v16, 1056, v16
v_bfe_u32 v2, v1, 5, 1
v_lshl_add_u32 v16, v2, 8, v16
v_and_b32 v2, 3, v1
v_lshl_add_u32 v16, v2, 3, v16
s_lshl_b32 s62, s12, 6
s_add_u32 s62, s62, 84480
s_xor_b32 s63, s12, 1
s_mul_i32 s63, s63, 192
s_add_u32 s63, s63, 84480
v_add_u32 v17, s63, v16
v_add_u32 v16, s62, v16
s_mov_b32 s52, 41943040
s_mov_b32 s54, s58
s_mov_b32 s55, s59
s_mul_i32 s59, s3, 2112
s_and_b32 s62, s7, 1
s_mul_i32 s62, s62, 3670016
s_lshr_b32 s63, s7, 1
s_lshl_b32 s63, s63, 8
s_add_u32 s62, s62, s63
s_lshl_b32 s63, s3, 12
s_add_u32 s62, s62, s63
v_lshrrev_b32 v5, 4, v1
v_lshlrev_b32 v5, 14, v5
v_and_b32 v2, 15, v1
v_lshl_add_u32 v5, v2, 4, v5
v_add_u32 v5, s62, v5
v_add_u32 v6, 992, v5
s_lshl_b32 s62, s10, 15
s_lshl_b32 s63, s3, 13
s_add_u32 s62, s62, s63
v_lshl_add_u32 v4, v1, 4, s62
s_lshl_b32 s62, s6, 7
s_add_u32 s62, s62, 30420992
s_lshl_b32 s64, s10, 1
s_lshl_b32 s64, s64, 7
s_add_u32 s64, s64, 30420992
s_add_u32 s65, s64, 128
v_mov_b32 v252, s62
v_mov_b32 v253, s64
v_writelane_b32 v253, s65, 1
s_waitcnt vmcnt(0) lgkmcnt(0)
s_barrier
s_cmp_lg_u32 s3, 0
s_cbranch_scc1 .Lnosig69
v_mov_b32 v255, 1
s_mov_b64 exec, 1
buffer_atomic_add v255, v252, s[16:19], 0 offen
s_mov_b64 exec, -1
.Lnosig69:
s_cmp_lg_u32 s3, 1
s_cbranch_scc1 .Lnopoll72
s_mov_b64 exec, 3
s_mov_b32 s15, 0
s_mov_b64 exec, 3
v_mov_b32 v254, 0
buffer_atomic_add v254, v253, s[16:19], 0 offen sc0
.Lpoll70:
s_waitcnt vmcnt(0)
v_cmp_ne_u32 vcc, 16, v254
s_add_u32 s15, s15, 1
s_cbranch_vccz .Lnopoll72r
s_sleep 2
s_mov_b64 exec, 3
v_mov_b32 v254, 0
buffer_atomic_add v254, v253, s[16:19], 0 offen sc0
s_cmp_le_u32 s15, 100000
s_cbranch_scc1 .Lpoll70
.Lgot71:
s_waitcnt vmcnt(0)
s_branch .Lnopoll72r
.Lnopoll72:
s_mov_b64 exec, 0
s_cmp_eq_u32 s3, 2
s_cbranch_scc1 .Lpad20
s_cmp_eq_u32 s3, 3
s_cbranch_scc1 .Lpad21
s_branch .Lpad22
.Lnopoll72r:
s_mov_b64 exec, -1
s_barrier
buffer_load_dwordx4 a[128:131], v10, s[16:19], s52 offen sc1
buffer_load_dwordx4 a[132:135], v10, s[16:19], s52 offen offset:1024 sc1
buffer_load_dwordx4 a[136:139], v11, s[16:19], s52 offen sc1
buffer_load_dwordx4 a[140:143], v11, s[16:19], s52 offen offset:1024 sc1
s_add_u32 s52, s52, 0x20000
buffer_load_dwordx4 a[144:147], v10, s[16:19], s52 offen sc1
buffer_load_dwordx4 a[148:151], v10, s[16:19], s52 offen offset:1024 sc1
buffer_load_dwordx4 a[152:155], v11, s[16:19], s52 offen sc1
buffer_load_dwordx4 a[156:159], v11, s[16:19], s52 offen offset:1024 sc1
s_add_u32 s52, s52, 0x20000
ds_read_b64_tr_b16 a[0:1], v16
ds_read_b64_tr_b16 a[2:3], v16 offset:512
ds_read_b64_tr_b16 a[4:5], v16 offset:32
ds_read_b64_tr_b16 a[6:7], v16 offset:544
ds_read_b64_tr_b16 a[8:9], v16 offset:8448
ds_read_b64_tr_b16 a[10:11], v16 offset:8960
ds_read_b64_tr_b16 a[12:13], v16 offset:8480
ds_read_b64_tr_b16 a[14:15], v16 offset:8992
ds_read_b64_tr_b16 a[16:17], v16 offset:64
ds_read_b64_tr_b16 a[18:19], v16 offset:576
ds_read_b64_tr_b16 a[20:21], v16 offset:96
ds_read_b64_tr_b16 a[22:23], v16 offset:608
ds_read_b64_tr_b16 a[24:25], v16 offset:8512
ds_read_b64_tr_b16 a[26:27], v16 offset:9024
ds_read_b64_tr_b16 a[28:29], v16 offset:8544
ds_read_b64_tr_b16 a[30:31], v16 offset:9056
ds_read_b64_tr_b16 a[32:33], v16 offset:128
ds_read_b64_tr_b16 a[34:35], v16 offset:640
ds_read_b64_tr_b16 a[36:37], v16 offset:160
ds_read_b64_tr_b16 a[38:39], v16 offset:672
ds_read_b64_tr_b16 a[40:41], v16 offset:8576
ds_read_b64_tr_b16 a[42:43], v16 offset:9088
ds_read_b64_tr_b16 a[44:45], v16 offset:8608
ds_read_b64_tr_b16 a[46:47], v16 offset:9120
ds_read_b64_tr_b16 a[48:49], v17
ds_read_b64_tr_b16 a[50:51], v17 offset:512
ds_read_b64_tr_b16 a[52:53], v17 offset:32
ds_read_b64_tr_b16 a[54:55], v17 offset:544
ds_read_b64_tr_b16 a[56:57], v17 offset:8448
ds_read_b64_tr_b16 a[58:59], v17 offset:8960
ds_read_b64_tr_b16 a[60:61], v17 offset:8480
ds_read_b64_tr_b16 a[62:63], v17 offset:8992
s_add_u32 m0, s55, 135168
s_nop 0
buffer_load_dwordx4 v12, s[32:35], s54 offen lds
buffer_load_dwordx4 v13, s[32:35], s54 offen offset:1056 lds
buffer_load_dwordx4 v14, s[32:35], s54 offen offset:2112 lds
buffer_load_dwordx4 v15, s[32:35], s54 offen offset:3168 lds
s_add_u32 s54, s54, 229376
s_mul_i32 s66, s13, 917504
s_add_u32 s66, s66, 46137344
s_add_u32 s65, s66, 393216
s_lshl_b32 s62, s12, 19
s_add_u32 s62, s62, s66
s_add_u32 s63, s62, 0x20000
s_add_u32 s64, s62, 0x40000
s_lshl_b32 s74, s3, 10
s_lshl_b32 s75, s12, 9
s_add_u32 s74, s74, s75
s_add_u32 s74, s74, 152576
v_and_b32 v18, 15, v1
v_lshl_add_u32 v18, v18, 4, s74
v_xor_b32 v19, 512, v18
s_lshl_b32 s74, s12, 7
s_add_u32 s74, s74, 161536
s_xor_b32 s75, s12, 1
s_mul_i32 s75, s75, 384
s_add_u32 s75, s75, 161536
v_lshrrev_b32 v9, 4, v1
v_lshlrev_b32 v9, 4, v9
v_add_u32 v8, s75, v9
v_add_u32 v9, s74, v9
s_lshl_b32 s74, s3, 13
s_add_u32 s74, s74, 49920
v_lshl_add_u32 v2, v1, 4, s74
s_waitcnt lgkmcnt(0)
s_barrier
s_waitcnt vmcnt(11)
v_mfma_f32_16x16x32_bf16 v[32:35], a[0:3], a[128:131], 0
buffer_load_dwordx4 a[160:163], v10, s[16:19], s52 offen sc1
s_waitcnt vmcnt(11)
v_mfma_f32_16x16x32_bf16 v[36:39], a[0:3], a[132:135], 0
ds_read_b64_tr_b16 a[64:65], v16 offset:16896
v_mfma_f32_16x16x32_bf16 v[52:55], a[4:7], a[132:135], 0
ds_read_b64_tr_b16 a[66:67], v16 offset:17408
v_mfma_f32_16x16x32_bf16 v[48:51], a[4:7], a[128:131], 0
ds_read_b64_tr_b16 a[68:69], v16 offset:16928
v_mfma_f32_16x16x32_bf16 v[64:67], a[8:11], a[128:131], 0
buffer_load_dwordx4 a[164:167], v10, s[16:19], s52 offen offset:1024 sc1
v_mfma_f32_16x16x32_bf16 v[68:71], a[8:11], a[132:135], 0
ds_read_b64_tr_b16 a[70:71], v16 offset:17440
v_mfma_f32_16x16x32_bf16 v[84:87], a[12:15], a[132:135], 0
ds_read_b64_tr_b16 a[72:73], v16 offset:25344
v_mfma_f32_16x16x32_bf16 v[80:83], a[12:15], a[128:131], 0
ds_read_b64_tr_b16 a[74:75], v16 offset:25856
v_mfma_f32_16x16x32_bf16 v[96:99], a[16:19], a[128:131], 0
buffer_load_dwordx4 a[168:171], v11, s[16:19], s52 offen sc1
v_mfma_f32_16x16x32_bf16 v[100:103], a[16:19], a[132:135], 0
ds_read_b64_tr_b16 a[76:77], v16 offset:25376
v_mfma_f32_16x16x32_bf16 v[116:119], a[20:23], a[132:135], 0
ds_read_b64_tr_b16 a[78:79], v16 offset:25888
v_mfma_f32_16x16x32_bf16 v[112:115], a[20:23], a[128:131], 0
ds_read_b64_tr_b16 a[80:81], v16 offset:16960
v_mfma_f32_16x16x32_bf16 v[128:131], a[24:27], a[128:131], 0
buffer_load_dwordx4 a[172:175], v11, s[16:19], s52 offen offset:1024 sc1
v_mfma_f32_16x16x32_bf16 v[132:135], a[24:27], a[132:135], 0
s_add_u32 s52, s52, 0x20000
s_add_u32 m0, s55, 84480
v_mfma_f32_16x16x32_bf16 v[148:151], a[28:31], a[132:135], 0
ds_read_b64_tr_b16 a[82:83], v16 offset:17472
v_mfma_f32_16x16x32_bf16 v[144:147], a[28:31], a[128:131], 0
ds_read_b64_tr_b16 a[84:85], v16 offset:16992
v_mfma_f32_16x16x32_bf16 v[160:163], a[32:35], a[128:131], 0
buffer_load_dwordx4 v12, s[32:35], s54 offen lds
v_mfma_f32_16x16x32_bf16 v[164:167], a[32:35], a[132:135], 0
ds_read_b64_tr_b16 a[86:87], v16 offset:17504
v_mfma_f32_16x16x32_bf16 v[180:183], a[36:39], a[132:135], 0
ds_read_b64_tr_b16 a[88:89], v16 offset:25408
v_mfma_f32_16x16x32_bf16 v[176:179], a[36:39], a[128:131], 0
ds_read_b64_tr_b16 a[90:91], v16 offset:25920
v_mfma_f32_16x16x32_bf16 v[192:195], a[40:43], a[128:131], 0
buffer_load_dwordx4 a[176:179], v10, s[16:19], s52 offen sc1
v_mfma_f32_16x16x32_bf16 v[196:199], a[40:43], a[132:135], 0
ds_read_b64_tr_b16 a[92:93], v16 offset:25440
v_mfma_f32_16x16x32_bf16 v[212:215], a[44:47], a[132:135], 0
ds_read_b64_tr_b16 a[94:95], v16 offset:25952
v_mfma_f32_16x16x32_bf16 v[208:211], a[44:47], a[128:131], 0
ds_read_b64_tr_b16 a[96:97], v16 offset:17024
v_mfma_f32_16x16x32_bf16 v[224:227], a[48:51], a[128:131], 0
buffer_load_dwordx4 v13, s[32:35], s54 offen offset:1056 lds
v_mfma_f32_16x16x32_bf16 v[228:231], a[48:51], a[132:135], 0
ds_read_b64_tr_b16 a[98:99], v16 offset:17536
v_mfma_f32_16x16x32_bf16 v[236:239], a[52:55], a[132:135], 0
ds_read_b64_tr_b16 a[100:101], v16 offset:17056
v_mfma_f32_16x16x32_bf16 v[232:235], a[52:55], a[128:131], 0
ds_read_b64_tr_b16 a[102:103], v16 offset:17568
v_mfma_f32_16x16x32_bf16 v[240:243], a[56:59], a[128:131], 0
buffer_load_dwordx4 a[180:183], v10, s[16:19], s52 offen offset:1024 sc1
v_mfma_f32_16x16x32_bf16 v[244:247], a[56:59], a[132:135], 0
ds_read_b64_tr_b16 a[104:105], v16 offset:25472
v_mfma_f32_16x16x32_bf16 v[252:255], a[60:63], a[132:135], 0
ds_read_b64_tr_b16 a[106:107], v16 offset:25984
v_mfma_f32_16x16x32_bf16 v[248:251], a[60:63], a[128:131], 0
ds_read_b64_tr_b16 a[108:109], v16 offset:25504
s_waitcnt vmcnt(16)
v_mfma_f32_16x16x32_bf16 v[220:223], a[44:47], a[140:143], 0
buffer_load_dwordx4 v14, s[32:35], s54 offen offset:2112 lds
v_mfma_f32_16x16x32_bf16 v[216:219], a[44:47], a[136:139], 0
ds_read_b64_tr_b16 a[110:111], v16 offset:26016
v_mfma_f32_16x16x32_bf16 v[200:203], a[40:43], a[136:139], 0
ds_read_b64_tr_b16 a[112:113], v17 offset:16896
v_mfma_f32_16x16x32_bf16 v[204:207], a[40:43], a[140:143], 0
ds_read_b64_tr_b16 a[114:115], v17 offset:17408
v_mfma_f32_16x16x32_bf16 v[188:191], a[36:39], a[140:143], 0
buffer_load_dwordx4 a[184:187], v11, s[16:19], s52 offen sc1
v_mfma_f32_16x16x32_bf16 v[184:187], a[36:39], a[136:139], 0
ds_read_b64_tr_b16 a[116:117], v17 offset:16928
v_mfma_f32_16x16x32_bf16 v[168:171], a[32:35], a[136:139], 0
ds_read_b64_tr_b16 a[118:119], v17 offset:17440
v_mfma_f32_16x16x32_bf16 v[172:175], a[32:35], a[140:143], 0
ds_read_b64_tr_b16 a[120:121], v17 offset:25344
v_mfma_f32_16x16x32_bf16 v[156:159], a[28:31], a[140:143], 0
buffer_load_dwordx4 v15, s[32:35], s54 offen offset:3168 lds
v_mfma_f32_16x16x32_bf16 v[152:155], a[28:31], a[136:139], 0
s_add_u32 s54, s54, 229376
ds_read_b64_tr_b16 a[122:123], v17 offset:25856
v_mfma_f32_16x16x32_bf16 v[136:139], a[24:27], a[136:139], 0
ds_read_b64_tr_b16 a[124:125], v17 offset:25376
v_mfma_f32_16x16x32_bf16 v[140:143], a[24:27], a[140:143], 0
ds_read_b64_tr_b16 a[126:127], v17 offset:25888
v_mfma_f32_16x16x32_bf16 v[124:127], a[20:23], a[140:143], 0
buffer_load_dwordx4 a[188:191], v11, s[16:19], s52 offen offset:1024 sc1
v_mfma_f32_16x16x32_bf16 v[120:123], a[20:23], a[136:139], 0
s_add_u32 s52, s52, 0x20000
v_mfma_f32_16x16x32_bf16 v[104:107], a[16:19], a[136:139], 0
v_mfma_f32_16x16x32_bf16 v[108:111], a[16:19], a[140:143], 0
v_mfma_f32_16x16x32_bf16 v[92:95], a[12:15], a[140:143], 0
v_mfma_f32_16x16x32_bf16 v[88:91], a[12:15], a[136:139], 0
v_mfma_f32_16x16x32_bf16 v[72:75], a[8:11], a[136:139], 0
v_mfma_f32_16x16x32_bf16 v[76:79], a[8:11], a[140:143], 0
v_mfma_f32_16x16x32_bf16 v[60:63], a[4:7], a[140:143], 0
v_mfma_f32_16x16x32_bf16 v[56:59], a[4:7], a[136:139], 0
v_mfma_f32_16x16x32_bf16 v[40:43], a[0:3], a[136:139], 0
v_mfma_f32_16x16x32_bf16 v[44:47], a[0:3], a[140:143], 0
s_waitcnt lgkmcnt(0)
s_barrier
s_waitcnt vmcnt(19)
v_mfma_f32_16x16x32_bf16 v[32:35], a[64:67], a[144:147], v[32:35]
s_add_u32 m0, s74, 0
s_mov_b32 s67, 63176704
s_waitcnt vmcnt(18)
v_mfma_f32_16x16x32_bf16 v[36:39], a[64:67], a[148:151], v[36:39]
buffer_load_dwordx4 v4, s[16:19], s67 offen sc1 lds
v_mfma_f32_16x16x32_bf16 v[52:55], a[68:71], a[148:151], v[52:55]
ds_read_b64_tr_b16 a[0:1], v16 offset:33792
v_mfma_f32_16x16x32_bf16 v[48:51], a[68:71], a[144:147], v[48:51]
ds_read_b64_tr_b16 a[2:3], v16 offset:34304
v_mfma_f32_16x16x32_bf16 v[64:67], a[72:75], a[144:147], v[64:67]
buffer_load_dwordx4 v4, s[16:19], s67 offen offset:1024 sc1 lds
v_mfma_f32_16x16x32_bf16 v[68:71], a[72:75], a[148:151], v[68:71]
ds_read_b64_tr_b16 a[4:5], v16 offset:33824
v_mfma_f32_16x16x32_bf16 v[84:87], a[76:79], a[148:151], v[84:87]
ds_read_b64_tr_b16 a[6:7], v16 offset:34336
v_mfma_f32_16x16x32_bf16 v[80:83], a[76:79], a[144:147], v[80:83]
buffer_load_dwordx4 v4, s[16:19], s67 offen offset:2048 sc1 lds
v_mfma_f32_16x16x32_bf16 v[96:99], a[80:83], a[144:147], v[96:99]
ds_read_b64_tr_b16 a[8:9], v16 offset:42240
v_mfma_f32_16x16x32_bf16 v[100:103], a[80:83], a[148:151], v[100:103]
ds_read_b64_tr_b16 a[10:11], v16 offset:42752
v_mfma_f32_16x16x32_bf16 v[116:119], a[84:87], a[148:151], v[116:119]
buffer_load_dwordx4 v4, s[16:19], s67 offen offset:3072 sc1 lds
v_mfma_f32_16x16x32_bf16 v[112:115], a[84:87], a[144:147], v[112:115]
s_add_u32 m0, s74, 4096
s_mov_b32 s67, 63180800
v_mfma_f32_16x16x32_bf16 v[128:131], a[88:91], a[144:147], v[128:131]
ds_read_b64_tr_b16 a[12:13], v16 offset:42272
v_mfma_f32_16x16x32_bf16 v[132:135], a[88:91], a[148:151], v[132:135]
buffer_load_dwordx4 v4, s[16:19], s67 offen sc1 lds
v_mfma_f32_16x16x32_bf16 v[148:151], a[92:95], a[148:151], v[148:151]
ds_read_b64_tr_b16 a[14:15], v16 offset:42784
v_mfma_f32_16x16x32_bf16 v[144:147], a[92:95], a[144:147], v[144:147]
ds_read_b64_tr_b16 a[16:17], v16 offset:33856
v_mfma_f32_16x16x32_bf16 v[160:163], a[96:99], a[144:147], v[160:163]
buffer_load_dwordx4 v4, s[16:19], s67 offen offset:1024 sc1 lds
v_mfma_f32_16x16x32_bf16 v[164:167], a[96:99], a[148:151], v[164:167]
ds_read_b64_tr_b16 a[18:19], v16 offset:34368
v_mfma_f32_16x16x32_bf16 v[180:183], a[100:103], a[148:151], v[180:183]
ds_read_b64_tr_b16 a[20:21], v16 offset:33888
v_mfma_f32_16x16x32_bf16 v[176:179], a[100:103], a[144:147], v[176:179]
buffer_load_dwordx4 v4, s[16:19], s67 offen offset:2048 sc1 lds
v_mfma_f32_16x16x32_bf16 v[192:195], a[104:107], a[144:147], v[192:195]
ds_read_b64_tr_b16 a[22:23], v16 offset:34400
v_mfma_f32_16x16x32_bf16 v[196:199], a[104:107], a[148:151], v[196:199]
ds_read_b64_tr_b16 a[24:25], v16 offset:42304
v_mfma_f32_16x16x32_bf16 v[212:215], a[108:111], a[148:151], v[212:215]
buffer_load_dwordx4 v4, s[16:19], s67 offen offset:3072 sc1 lds
v_mfma_f32_16x16x32_bf16 v[208:211], a[108:111], a[144:147], v[208:211]
s_add_u32 m0, s55, 101376
ds_read_b64_tr_b16 a[26:27], v16 offset:42816
v_mfma_f32_16x16x32_bf16 v[224:227], a[112:115], a[144:147], v[224:227]
ds_read_b64_tr_b16 a[28:29], v16 offset:42336
v_mfma_f32_16x16x32_bf16 v[228:231], a[112:115], a[148:151], v[228:231]
buffer_load_dwordx4 v12, s[32:35], s54 offen lds
v_mfma_f32_16x16x32_bf16 v[236:239], a[116:119], a[148:151], v[236:239]
ds_read_b64_tr_b16 a[30:31], v16 offset:42848
v_mfma_f32_16x16x32_bf16 v[232:235], a[116:119], a[144:147], v[232:235]
ds_read_b64_tr_b16 a[32:33], v16 offset:33920
v_mfma_f32_16x16x32_bf16 v[240:243], a[120:123], a[144:147], v[240:243]
buffer_load_dwordx4 a[128:131], v10, s[16:19], s52 offen sc1
v_mfma_f32_16x16x32_bf16 v[244:247], a[120:123], a[148:151], v[244:247]
ds_read_b64_tr_b16 a[34:35], v16 offset:34432
v_mfma_f32_16x16x32_bf16 v[252:255], a[124:127], a[148:151], v[252:255]
ds_read_b64_tr_b16 a[36:37], v16 offset:33952
v_mfma_f32_16x16x32_bf16 v[248:251], a[124:127], a[144:147], v[248:251]
buffer_load_dwordx4 v13, s[32:35], s54 offen offset:1056 lds
s_waitcnt vmcnt(27)
v_mfma_f32_16x16x32_bf16 v[220:223], a[108:111], a[156:159], v[220:223]
ds_read_b64_tr_b16 a[38:39], v16 offset:34464
v_mfma_f32_16x16x32_bf16 v[216:219], a[108:111], a[152:155], v[216:219]
ds_read_b64_tr_b16 a[40:41], v16 offset:42368
v_mfma_f32_16x16x32_bf16 v[200:203], a[104:107], a[152:155], v[200:203]
buffer_load_dwordx4 a[132:135], v10, s[16:19], s52 offen offset:1024 sc1
v_mfma_f32_16x16x32_bf16 v[204:207], a[104:107], a[156:159], v[204:207]
ds_read_b64_tr_b16 a[42:43], v16 offset:42880
v_mfma_f32_16x16x32_bf16 v[188:191], a[100:103], a[156:159], v[188:191]
ds_read_b64_tr_b16 a[44:45], v16 offset:42400
v_mfma_f32_16x16x32_bf16 v[184:187], a[100:103], a[152:155], v[184:187]
buffer_load_dwordx4 v14, s[32:35], s54 offen offset:2112 lds
v_mfma_f32_16x16x32_bf16 v[168:171], a[96:99], a[152:155], v[168:171]
ds_read_b64_tr_b16 a[46:47], v16 offset:42912
v_mfma_f32_16x16x32_bf16 v[172:175], a[96:99], a[156:159], v[172:175]
ds_read_b64_tr_b16 a[48:49], v17 offset:33792
v_mfma_f32_16x16x32_bf16 v[156:159], a[92:95], a[156:159], v[156:159]
buffer_load_dwordx4 a[136:139], v11, s[16:19], s52 offen sc1
v_mfma_f32_16x16x32_bf16 v[152:155], a[92:95], a[152:155], v[152:155]
ds_read_b64_tr_b16 a[50:51], v17 offset:34304
v_mfma_f32_16x16x32_bf16 v[136:139], a[88:91], a[152:155], v[136:139]
ds_read_b64_tr_b16 a[52:53], v17 offset:33824
v_mfma_f32_16x16x32_bf16 v[140:143], a[88:91], a[156:159], v[140:143]
buffer_load_dwordx4 v15, s[32:35], s54 offen offset:3168 lds
v_mfma_f32_16x16x32_bf16 v[124:127], a[84:87], a[156:159], v[124:127]
s_add_u32 s54, s54, 229376
ds_read_b64_tr_b16 a[54:55], v17 offset:34336
v_mfma_f32_16x16x32_bf16 v[120:123], a[84:87], a[152:155], v[120:123]
ds_read_b64_tr_b16 a[56:57], v17 offset:42240
v_mfma_f32_16x16x32_bf16 v[104:107], a[80:83], a[152:155], v[104:107]
buffer_load_dwordx4 a[140:143], v11, s[16:19], s52 offen offset:1024 sc1
v_mfma_f32_16x16x32_bf16 v[108:111], a[80:83], a[156:159], v[108:111]
s_add_u32 s52, s52, 0x20000
ds_read_b64_tr_b16 a[58:59], v17 offset:42752
v_mfma_f32_16x16x32_bf16 v[92:95], a[76:79], a[156:159], v[92:95]
ds_read_b64_tr_b16 a[60:61], v17 offset:42272
v_mfma_f32_16x16x32_bf16 v[88:91], a[76:79], a[152:155], v[88:91]
ds_read_b64_tr_b16 a[62:63], v17 offset:42784
v_mfma_f32_16x16x32_bf16 v[72:75], a[72:75], a[152:155], v[72:75]
v_mfma_f32_16x16x32_bf16 v[76:79], a[72:75], a[156:159], v[76:79]
v_mfma_f32_16x16x32_bf16 v[60:63], a[68:71], a[156:159], v[60:63]
v_mfma_f32_16x16x32_bf16 v[56:59], a[68:71], a[152:155], v[56:59]
v_mfma_f32_16x16x32_bf16 v[40:43], a[64:67], a[152:155], v[40:43]
v_mfma_f32_16x16x32_bf16 v[44:47], a[64:67], a[156:159], v[44:47]
s_waitcnt vmcnt(28) lgkmcnt(0)
s_barrier
s_waitcnt vmcnt(27)
v_mfma_f32_16x16x32_bf16 v[32:35], a[0:3], a[160:163], v[32:35]
s_add_u32 m0, s55, 118272
ds_read_b64_tr_b16 a[64:65], v16 offset:50688
s_waitcnt vmcnt(26)
v_mfma_f32_16x16x32_bf16 v[36:39], a[0:3], a[164:167], v[36:39]
buffer_load_dwordx4 v12, s[32:35], s54 offen lds
v_mfma_f32_16x16x32_bf16 v[52:55], a[4:7], a[164:167], v[52:55]
ds_read_b64_tr_b16 a[66:67], v16 offset:51200
v_mfma_f32_16x16x32_bf16 v[48:51], a[4:7], a[160:163], v[48:51]
ds_read_b64_tr_b16 a[68:69], v16 offset:50720
v_mfma_f32_16x16x32_bf16 v[64:67], a[8:11], a[160:163], v[64:67]
ds_read_b64_tr_b16 a[70:71], v16 offset:51232
v_mfma_f32_16x16x32_bf16 v[68:71], a[8:11], a[164:167], v[68:71]
ds_read_b64_tr_b16 a[72:73], v16 offset:59136
v_mfma_f32_16x16x32_bf16 v[84:87], a[12:15], a[164:167], v[84:87]
ds_read_b64_tr_b16 a[74:75], v16 offset:59648
v_mfma_f32_16x16x32_bf16 v[80:83], a[12:15], a[160:163], v[80:83]
buffer_load_dwordx4 a[144:147], v10, s[16:19], s52 offen sc1
v_mfma_f32_16x16x32_bf16 v[96:99], a[16:19], a[160:163], v[96:99]
ds_read_b64_tr_b16 a[76:77], v16 offset:59168
v_mfma_f32_16x16x32_bf16 v[100:103], a[16:19], a[164:167], v[100:103]
ds_read_b64_tr_b16 a[78:79], v16 offset:59680
v_mfma_f32_16x16x32_bf16 v[116:119], a[20:23], a[164:167], v[116:119]
ds_read_b64_tr_b16 a[80:81], v16 offset:50752
v_mfma_f32_16x16x32_bf16 v[112:115], a[20:23], a[160:163], v[112:115]
ds_read_b64_tr_b16 a[82:83], v16 offset:51264
v_mfma_f32_16x16x32_bf16 v[128:131], a[24:27], a[160:163], v[128:131]
ds_read_b64_tr_b16 a[84:85], v16 offset:50784
v_mfma_f32_16x16x32_bf16 v[132:135], a[24:27], a[164:167], v[132:135]
s_waitcnt vmcnt(10)
ds_read_b128 v[20:23], v2
v_mfma_f32_16x16x32_bf16 v[148:151], a[28:31], a[164:167], v[148:151]
ds_read_b128 v[28:31], v2 offset:1024
v_mfma_f32_16x16x32_bf16 v[144:147], a[28:31], a[160:163], v[144:147]
ds_read_b128 v[24:27], v2 offset:2048
v_mfma_f32_16x16x32_bf16 v[160:163], a[32:35], a[160:163], v[160:163]
buffer_load_dwordx4 v13, s[32:35], s54 offen offset:1056 lds
v_mfma_f32_16x16x32_bf16 v[164:167], a[32:35], a[164:167], v[164:167]
ds_read_b64_tr_b16 a[86:87], v16 offset:51296
v_mfma_f32_16x16x32_bf16 v[180:183], a[36:39], a[164:167], v[180:183]
ds_read_b64_tr_b16 a[88:89], v16 offset:59200
v_mfma_f32_16x16x32_bf16 v[176:179], a[36:39], a[160:163], v[176:179]
ds_read_b64_tr_b16 a[90:91], v16 offset:59712
v_mfma_f32_16x16x32_bf16 v[192:195], a[40:43], a[160:163], v[192:195]
ds_read_b64_tr_b16 a[92:93], v16 offset:59232
v_mfma_f32_16x16x32_bf16 v[196:199], a[40:43], a[164:167], v[196:199]
ds_read_b64_tr_b16 a[94:95], v16 offset:59744
v_mfma_f32_16x16x32_bf16 v[212:215], a[44:47], a[164:167], v[212:215]
buffer_load_dwordx4 a[148:151], v10, s[16:19], s52 offen offset:1024 sc1
v_mfma_f32_16x16x32_bf16 v[208:211], a[44:47], a[160:163], v[208:211]
ds_read_b64_tr_b16 a[96:97], v16 offset:50816
s_waitcnt lgkmcnt(7)
v_add_f32 v20, v20, v28
v_mfma_f32_16x16x32_bf16 v[224:227], a[48:51], a[160:163], v[224:227]
ds_read_b64_tr_b16 a[98:99], v16 offset:51328
v_add_f32 v21, v21, v29
v_mfma_f32_16x16x32_bf16 v[228:231], a[48:51], a[164:167], v[228:231]
ds_read_b64_tr_b16 a[100:101], v16 offset:50848
v_add_f32 v22, v22, v30
v_mfma_f32_16x16x32_bf16 v[236:239], a[52:55], a[164:167], v[236:239]
ds_read_b64_tr_b16 a[102:103], v16 offset:51360
v_add_f32 v23, v23, v31
v_mfma_f32_16x16x32_bf16 v[232:235], a[52:55], a[160:163], v[232:235]
ds_read_b128 v[28:31], v2 offset:3072
.Lpad20:
s_cbranch_execz .Lpad23
s_waitcnt lgkmcnt(10)
v_add_f32 v20, v20, v24
v_mfma_f32_16x16x32_bf16 v[240:243], a[56:59], a[160:163], v[240:243]
buffer_load_dwordx4 v14, s[32:35], s54 offen offset:2112 lds
v_mfma_f32_16x16x32_bf16 v[244:247], a[56:59], a[164:167], v[244:247]
ds_read_b64_tr_b16 a[104:105], v16 offset:59264
v_add_f32 v21, v21, v25
v_mfma_f32_16x16x32_bf16 v[252:255], a[60:63], a[164:167], v[252:255]
ds_read_b64_tr_b16 a[106:107], v16 offset:59776
v_add_f32 v22, v22, v26
v_mfma_f32_16x16x32_bf16 v[248:251], a[60:63], a[160:163], v[248:251]
ds_read_b64_tr_b16 a[108:109], v16 offset:59296
v_add_f32 v23, v23, v27
v_mfma_f32_16x16x32_bf16 v[220:223], a[44:47], a[172:175], v[220:223]
ds_read_b128 v[24:27], v2 offset:4096
v_mfma_f32_16x16x32_bf16 v[216:219], a[44:47], a[168:171], v[216:219]
ds_read_b64_tr_b16 a[110:111], v16 offset:59808
v_mfma_f32_16x16x32_bf16 v[200:203], a[40:43], a[168:171], v[200:203]
buffer_load_dwordx4 a[152:155], v11, s[16:19], s52 offen sc1
v_mfma_f32_16x16x32_bf16 v[204:207], a[40:43], a[172:175], v[204:207]
ds_read_b64_tr_b16 a[112:113], v17 offset:50688
s_waitcnt lgkmcnt(6)
v_add_f32 v20, v20, v28
v_mfma_f32_16x16x32_bf16 v[188:191], a[36:39], a[172:175], v[188:191]
ds_read_b64_tr_b16 a[114:115], v17 offset:51200
v_add_f32 v21, v21, v29
v_mfma_f32_16x16x32_bf16 v[184:187], a[36:39], a[168:171], v[184:187]
ds_read_b64_tr_b16 a[116:117], v17 offset:50720
v_add_f32 v22, v22, v30
v_mfma_f32_16x16x32_bf16 v[168:171], a[32:35], a[168:171], v[168:171]
ds_read_b64_tr_b16 a[118:119], v17 offset:51232
v_add_f32 v23, v23, v31
v_mfma_f32_16x16x32_bf16 v[172:175], a[32:35], a[172:175], v[172:175]
ds_read_b128 v[28:31], v2 offset:5120
v_mfma_f32_16x16x32_bf16 v[156:159], a[28:31], a[172:175], v[156:159]
buffer_load_dwordx4 v15, s[32:35], s54 offen offset:3168 lds
v_mfma_f32_16x16x32_bf16 v[152:155], a[28:31], a[168:171], v[152:155]
s_add_u32 s54, s54, 229376
s_waitcnt lgkmcnt(6)
v_add_f32 v20, v20, v24
v_add_f32 v21, v21, v25
v_mfma_f32_16x16x32_bf16 v[136:139], a[24:27], a[168:171], v[136:139]
ds_read_b64_tr_b16 a[120:121], v17 offset:59136
v_add_f32 v22, v22, v26
v_mfma_f32_16x16x32_bf16 v[140:143], a[24:27], a[172:175], v[140:143]
ds_read_b64_tr_b16 a[122:123], v17 offset:59648
v_mfma_f32_16x16x32_bf16 v[124:127], a[20:23], a[172:175], v[124:127]
ds_read_b64_tr_b16 a[124:125], v17 offset:59168
v_mfma_f32_16x16x32_bf16 v[120:123], a[20:23], a[168:171], v[120:123]
ds_read_b64_tr_b16 a[126:127], v17 offset:59680
v_mfma_f32_16x16x32_bf16 v[104:107], a[16:19], a[168:171], v[104:107]
buffer_load_dwordx4 a[156:159], v11, s[16:19], s52 offen offset:1024 sc1
v_mfma_f32_16x16x32_bf16 v[108:111], a[16:19], a[172:175], v[108:111]
s_add_u32 s52, s52, 0x20000
v_mfma_f32_16x16x32_bf16 v[92:95], a[12:15], a[172:175], v[92:95]
v_mfma_f32_16x16x32_bf16 v[88:91], a[12:15], a[168:171], v[88:91]
v_mfma_f32_16x16x32_bf16 v[72:75], a[8:11], a[168:171], v[72:75]
v_mfma_f32_16x16x32_bf16 v[76:79], a[8:11], a[172:175], v[76:79]
v_mfma_f32_16x16x32_bf16 v[60:63], a[4:7], a[172:175], v[60:63]
v_mfma_f32_16x16x32_bf16 v[56:59], a[4:7], a[168:171], v[56:59]
v_mfma_f32_16x16x32_bf16 v[40:43], a[0:3], a[168:171], v[40:43]
v_mfma_f32_16x16x32_bf16 v[44:47], a[0:3], a[172:175], v[44:47]
s_waitcnt lgkmcnt(0)
s_barrier
v_mfma_f32_16x16x32_bf16 v[32:35], a[64:67], a[176:179], v[32:35]
s_add_u32 m0, s55, 135168
v_add_f32 v23, v23, v27
v_add_f32 v20, v20, v28
v_mfma_f32_16x16x32_bf16 v[36:39], a[64:67], a[180:183], v[36:39]
ds_read_b128 v[24:27], v2 offset:6144
v_add_f32 v21, v21, v29
v_mfma_f32_16x16x32_bf16 v[52:55], a[68:71], a[180:183], v[52:55]
buffer_load_dwordx4 v12, s[32:35], s54 offen lds
v_mfma_f32_16x16x32_bf16 v[48:51], a[68:71], a[176:179], v[48:51]
ds_read_b64_tr_b16 a[0:1], v16
v_add_f32 v22, v22, v30
v_mfma_f32_16x16x32_bf16 v[64:67], a[72:75], a[176:179], v[64:67]
ds_read_b64_tr_b16 a[2:3], v16 offset:512
v_add_f32 v23, v23, v31
v_mfma_f32_16x16x32_bf16 v[68:71], a[72:75], a[180:183], v[68:71]
ds_read_b128 v[28:31], v2 offset:7168
v_mfma_f32_16x16x32_bf16 v[84:87], a[76:79], a[180:183], v[84:87]
ds_read_b64_tr_b16 a[4:5], v16 offset:32
v_mfma_f32_16x16x32_bf16 v[80:83], a[76:79], a[176:179], v[80:83]
ds_read_b64_tr_b16 a[6:7], v16 offset:544
v_mfma_f32_16x16x32_bf16 v[96:99], a[80:83], a[176:179], v[96:99]
buffer_load_dwordx4 a[160:163], v10, s[16:19], s52 offen sc1
v_mfma_f32_16x16x32_bf16 v[100:103], a[80:83], a[180:183], v[100:103]
ds_read_b64_tr_b16 a[8:9], v16 offset:8448
s_waitcnt lgkmcnt(6)
v_add_f32 v20, v20, v24
v_mfma_f32_16x16x32_bf16 v[116:119], a[84:87], a[180:183], v[116:119]
ds_read_b64_tr_b16 a[10:11], v16 offset:8960
v_add_f32 v21, v21, v25
v_mfma_f32_16x16x32_bf16 v[112:115], a[84:87], a[176:179], v[112:115]
ds_read_b64_tr_b16 a[12:13], v16 offset:8480
v_add_f32 v22, v22, v26
v_mfma_f32_16x16x32_bf16 v[128:131], a[88:91], a[176:179], v[128:131]
ds_read_b64_tr_b16 a[14:15], v16 offset:8992
v_add_f32 v23, v23, v27
v_mfma_f32_16x16x32_bf16 v[132:135], a[88:91], a[180:183], v[132:135]
ds_read_b64_tr_b16 a[16:17], v16 offset:64
s_waitcnt lgkmcnt(7)
v_add_f32 v20, v20, v28
v_mfma_f32_16x16x32_bf16 v[148:151], a[92:95], a[180:183], v[148:151]
buffer_load_dwordx4 v13, s[32:35], s54 offen offset:1056 lds
v_mfma_f32_16x16x32_bf16 v[144:147], a[92:95], a[176:179], v[144:147]
ds_read_b64_tr_b16 a[18:19], v16 offset:576
v_add_f32 v21, v21, v29
v_mfma_f32_16x16x32_bf16 v[160:163], a[96:99], a[176:179], v[160:163]
ds_read_b64_tr_b16 a[20:21], v16 offset:96
v_add_f32 v22, v22, v30
v_mfma_f32_16x16x32_bf16 v[164:167], a[96:99], a[180:183], v[164:167]
ds_read_b64_tr_b16 a[22:23], v16 offset:608
v_permlane32_swap_b32 v20, v22
v_mfma_f32_16x16x32_bf16 v[180:183], a[100:103], a[180:183], v[180:183]
ds_read_b64_tr_b16 a[24:25], v16 offset:8512
v_add_f32 v23, v23, v31
v_mfma_f32_16x16x32_bf16 v[176:179], a[100:103], a[176:179], v[176:179]
ds_read_b64_tr_b16 a[26:27], v16 offset:9024
v_permlane32_swap_b32 v21, v23
v_mfma_f32_16x16x32_bf16 v[192:195], a[104:107], a[176:179], v[192:195]
buffer_load_dwordx4 a[164:167], v10, s[16:19], s52 offen offset:1024 sc1
v_mfma_f32_16x16x32_bf16 v[196:199], a[104:107], a[180:183], v[196:199]
ds_read_b64_tr_b16 a[28:29], v16 offset:8544
v_add_f32 v20, v20, v22
v_mfma_f32_16x16x32_bf16 v[212:215], a[108:111], a[180:183], v[212:215]
ds_read_b64_tr_b16 a[30:31], v16 offset:9056
v_add_f32 v21, v21, v23
v_mfma_f32_16x16x32_bf16 v[208:211], a[108:111], a[176:179], v[208:211]
ds_read_b64_tr_b16 a[32:33], v16 offset:128
v_mul_f32 v20, 0xba800000, v20
v_mfma_f32_16x16x32_bf16 v[224:227], a[112:115], a[176:179], v[224:227]
ds_read_b64_tr_b16 a[34:35], v16 offset:640
v_mul_f32 v21, 0x3a800000, v21
v_mfma_f32_16x16x32_bf16 v[228:231], a[112:115], a[180:183], v[228:231]
ds_read_b64_tr_b16 a[36:37], v16 offset:160
v_fma_f32 v21, -v20, v20, v21
v_mfma_f32_16x16x32_bf16 v[236:239], a[116:119], a[180:183], v[236:239]
buffer_load_dwordx4 v14, s[32:35], s54 offen offset:2112 lds
v_mfma_f32_16x16x32_bf16 v[232:235], a[116:119], a[176:179], v[232:235]
ds_read_b64_tr_b16 a[38:39], v16 offset:672
v_max_f32 v21, 0, v21
v_mfma_f32_16x16x32_bf16 v[240:243], a[120:123], a[176:179], v[240:243]
ds_read_b64_tr_b16 a[40:41], v16 offset:8576
v_add_f32 v21, 0x3727c5ac, v21
v_mfma_f32_16x16x32_bf16 v[244:247], a[120:123], a[180:183], v[244:247]
ds_read_b64_tr_b16 a[42:43], v16 offset:9088
v_rsq_f32 v22, v21
v_mfma_f32_16x16x32_bf16 v[252:255], a[124:127], a[180:183], v[252:255]
ds_read_b64_tr_b16 a[44:45], v16 offset:8608
v_and_b32 v24, 31, v1
v_mfma_f32_16x16x32_bf16 v[248:251], a[124:127], a[176:179], v[248:251]
ds_read_b64_tr_b16 a[46:47], v16 offset:9120
v_lshrrev_b32 v25, 5, v1
v_mfma_f32_16x16x32_bf16 v[220:223], a[108:111], a[188:191], v[220:223]
buffer_load_dwordx4 a[168:171], v11, s[16:19], s52 offen sc1
v_mfma_f32_16x16x32_bf16 v[216:219], a[108:111], a[184:187], v[216:219]
ds_read_b64_tr_b16 a[48:49], v17
v_lshl_add_u32 v24, v24, 1, v25
v_mfma_f32_16x16x32_bf16 v[200:203], a[104:107], a[184:187], v[200:203]
ds_read_b64_tr_b16 a[50:51], v17 offset:512
v_and_b32 v25, 0xc0, v0
v_mfma_f32_16x16x32_bf16 v[204:207], a[104:107], a[188:191], v[204:207]
ds_read_b64_tr_b16 a[52:53], v17 offset:32
v_add_u32 v24, v24, v25
v_mfma_f32_16x16x32_bf16 v[188:191], a[100:103], a[188:191], v[188:191]
ds_read_b64_tr_b16 a[54:55], v17 offset:544
v_lshlrev_b32 v24, 4, v24
v_mfma_f32_16x16x32_bf16 v[184:187], a[100:103], a[184:187], v[184:187]
ds_read_b64_tr_b16 a[56:57], v17 offset:8448
v_add_u32 v24, 152576, v24
v_mfma_f32_16x16x32_bf16 v[168:171], a[96:99], a[184:187], v[168:171]
buffer_load_dwordx4 v15, s[32:35], s54 offen offset:3168 lds
v_mfma_f32_16x16x32_bf16 v[172:175], a[96:99], a[188:191], v[172:175]
s_add_u32 s54, s54, 229376
v_mul_f32 v22, 0xbfb8aa3b, v22
v_mfma_f32_16x16x32_bf16 v[156:159], a[92:95], a[188:191], v[156:159]
ds_write_b128 v24, v[20:23]
v_mfma_f32_16x16x32_bf16 v[152:155], a[92:95], a[184:187], v[152:155]
ds_read_b64 v[20:21], v18
v_mfma_f32_16x16x32_bf16 v[136:139], a[88:91], a[184:187], v[136:139]
ds_read_b64 v[22:23], v18 offset:256
v_mfma_f32_16x16x32_bf16 v[140:143], a[88:91], a[188:191], v[140:143]
ds_read_b64 v[24:25], v19
v_mfma_f32_16x16x32_bf16 v[124:127], a[84:87], a[188:191], v[124:127]
ds_read_b64 v[26:27], v19 offset:256
v_mfma_f32_16x16x32_bf16 v[120:123], a[84:87], a[184:187], v[120:123]
ds_read_b32 v28, v18 offset:8
v_mfma_f32_16x16x32_bf16 v[104:107], a[80:83], a[184:187], v[104:107]
ds_read_b32 v29, v18 offset:264
v_mfma_f32_16x16x32_bf16 v[108:111], a[80:83], a[188:191], v[108:111]
ds_read_b32 v30, v19 offset:8
v_mfma_f32_16x16x32_bf16 v[92:95], a[76:79], a[188:191], v[92:95]
ds_read_b32 v31, v19 offset:264
v_mfma_f32_16x16x32_bf16 v[88:91], a[76:79], a[184:187], v[88:91]
buffer_load_dwordx4 a[172:175], v11, s[16:19], s52 offen offset:1024 sc1
v_mfma_f32_16x16x32_bf16 v[72:75], a[72:75], a[184:187], v[72:75]
s_add_u32 s52, s52, 0x20000
ds_read_b64_tr_b16 a[58:59], v17 offset:8960
v_mfma_f32_16x16x32_bf16 v[76:79], a[72:75], a[188:191], v[76:79]
ds_read_b64_tr_b16 a[60:61], v17 offset:8480
v_mfma_f32_16x16x32_bf16 v[60:63], a[68:71], a[188:191], v[60:63]
ds_read_b64_tr_b16 a[62:63], v17 offset:8992
v_mfma_f32_16x16x32_bf16 v[56:59], a[68:71], a[184:187], v[56:59]
v_mfma_f32_16x16x32_bf16 v[40:43], a[64:67], a[184:187], v[40:43]
v_mfma_f32_16x16x32_bf16 v[44:47], a[64:67], a[188:191], v[44:47]
s_mov_b32 s58, -131072
s_sub_u32 s67, s59, 16896
s_mov_b32 s15, -6
.p2align 6
.Lk74:
s_waitcnt vmcnt(17) lgkmcnt(0)
s_barrier
v_mfma_f32_16x16x32_bf16 v[32:35], a[0:3], a[128:131], v[32:35]
ds_read_b64_tr_b16 a[64:65], v16 offset:16896
s_add_u32 m0, s55, 84480
v_mfma_f32_16x16x32_bf16 v[36:39], a[0:3], a[132:135], v[36:39]
buffer_load_dwordx4 v12, s[32:35], s54 offen lds
v_mfma_f32_16x16x32_bf16 v[52:55], a[4:7], a[132:135], v[52:55]
ds_read_b64_tr_b16 a[66:67], v16 offset:17408
v_mfma_f32_16x16x32_bf16 v[48:51], a[4:7], a[128:131], v[48:51]
ds_read_b64_tr_b16 a[68:69], v16 offset:16928
v_mfma_f32_16x16x32_bf16 v[64:67], a[8:11], a[128:131], v[64:67]
ds_read_b64_tr_b16 a[70:71], v16 offset:17440
v_mfma_f32_16x16x32_bf16 v[68:71], a[8:11], a[132:135], v[68:71]
v_mfma_f32_16x16x32_bf16 v[84:87], a[12:15], a[132:135], v[84:87]
ds_read_b64_tr_b16 a[72:73], v16 offset:25344
v_mfma_f32_16x16x32_bf16 v[80:83], a[12:15], a[128:131], v[80:83]
buffer_load_dwordx4 a[176:179], v10, s[16:19], s52 offen sc1
v_mfma_f32_16x16x32_bf16 v[96:99], a[16:19], a[128:131], v[96:99]
ds_read_b64_tr_b16 a[74:75], v16 offset:25856
v_mfma_f32_16x16x32_bf16 v[100:103], a[16:19], a[132:135], v[100:103]
ds_read_b64_tr_b16 a[76:77], v16 offset:25376
v_mfma_f32_16x16x32_bf16 v[116:119], a[20:23], a[132:135], v[116:119]
v_mfma_f32_16x16x32_bf16 v[112:115], a[20:23], a[128:131], v[112:115]
ds_read_b64_tr_b16 a[78:79], v16 offset:25888
v_mfma_f32_16x16x32_bf16 v[128:131], a[24:27], a[128:131], v[128:131]
ds_read_b64_tr_b16 a[80:81], v16 offset:16960
v_mfma_f32_16x16x32_bf16 v[132:135], a[24:27], a[132:135], v[132:135]
buffer_load_dwordx4 v13, s[32:35], s54 offen offset:1056 lds
v_mfma_f32_16x16x32_bf16 v[148:151], a[28:31], a[132:135], v[148:151]
ds_read_b64_tr_b16 a[82:83], v16 offset:17472
v_mfma_f32_16x16x32_bf16 v[144:147], a[28:31], a[128:131], v[144:147]
v_mfma_f32_16x16x32_bf16 v[160:163], a[32:35], a[128:131], v[160:163]
ds_read_b64_tr_b16 a[84:85], v16 offset:16992
v_mfma_f32_16x16x32_bf16 v[164:167], a[32:35], a[132:135], v[164:167]
ds_read_b64_tr_b16 a[86:87], v16 offset:17504
v_mfma_f32_16x16x32_bf16 v[180:183], a[36:39], a[132:135], v[180:183]
ds_read_b64_tr_b16 a[88:89], v16 offset:25408
v_mfma_f32_16x16x32_bf16 v[176:179], a[36:39], a[128:131], v[176:179]
buffer_load_dwordx4 a[180:183], v10, s[16:19], s52 offen offset:1024 sc1
v_mfma_f32_16x16x32_bf16 v[192:195], a[40:43], a[128:131], v[192:195]
v_mfma_f32_16x16x32_bf16 v[196:199], a[40:43], a[132:135], v[196:199]
ds_read_b64_tr_b16 a[90:91], v16 offset:25920
v_mfma_f32_16x16x32_bf16 v[212:215], a[44:47], a[132:135], v[212:215]
ds_read_b64_tr_b16 a[92:93], v16 offset:25440
v_mfma_f32_16x16x32_bf16 v[208:211], a[44:47], a[128:131], v[208:211]
ds_read_b64_tr_b16 a[94:95], v16 offset:25952
v_mfma_f32_16x16x32_bf16 v[224:227], a[48:51], a[128:131], v[224:227]
v_mfma_f32_16x16x32_bf16 v[228:231], a[48:51], a[132:135], v[228:231]
buffer_load_dwordx4 v14, s[32:35], s54 offen offset:2112 lds
v_mfma_f32_16x16x32_bf16 v[236:239], a[52:55], a[132:135], v[236:239]
ds_read_b64_tr_b16 a[96:97], v16 offset:17024
v_mfma_f32_16x16x32_bf16 v[232:235], a[52:55], a[128:131], v[232:235]
ds_read_b64_tr_b16 a[98:99], v16 offset:17536
v_mfma_f32_16x16x32_bf16 v[240:243], a[56:59], a[128:131], v[240:243]
ds_read_b64_tr_b16 a[100:101], v16 offset:17056
v_mfma_f32_16x16x32_bf16 v[244:247], a[56:59], a[132:135], v[244:247]
ds_read_b64_tr_b16 a[102:103], v16 offset:17568
v_mfma_f32_16x16x32_bf16 v[252:255], a[60:63], a[132:135], v[252:255]
v_mfma_f32_16x16x32_bf16 v[248:251], a[60:63], a[128:131], v[248:251]
buffer_load_dwordx4 a[184:187], v11, s[16:19], s52 offen sc1
s_waitcnt vmcnt(22)
v_mfma_f32_16x16x32_bf16 v[220:223], a[44:47], a[140:143], v[220:223]
ds_read_b64_tr_b16 a[104:105], v16 offset:25472
v_mfma_f32_16x16x32_bf16 v[216:219], a[44:47], a[136:139], v[216:219]
ds_read_b64_tr_b16 a[106:107], v16 offset:25984
v_mfma_f32_16x16x32_bf16 v[200:203], a[40:43], a[136:139], v[200:203]
ds_read_b64_tr_b16 a[108:109], v16 offset:25504
v_mfma_f32_16x16x32_bf16 v[204:207], a[40:43], a[140:143], v[204:207]
v_mfma_f32_16x16x32_bf16 v[188:191], a[36:39], a[140:143], v[188:191]
ds_read_b64_tr_b16 a[110:111], v16 offset:26016
v_mfma_f32_16x16x32_bf16 v[184:187], a[36:39], a[136:139], v[184:187]
buffer_load_dwordx4 v15, s[32:35], s54 offen offset:3168 lds
v_mfma_f32_16x16x32_bf16 v[168:171], a[32:35], a[136:139], v[168:171]
ds_read_b64_tr_b16 a[112:113], v17 offset:16896
s_add_u32 s54, s54, 229376
v_mfma_f32_16x16x32_bf16 v[172:175], a[32:35], a[140:143], v[172:175]
ds_read_b64_tr_b16 a[114:115], v17 offset:17408
v_mfma_f32_16x16x32_bf16 v[156:159], a[28:31], a[140:143], v[156:159]
v_mfma_f32_16x16x32_bf16 v[152:155], a[28:31], a[136:139], v[152:155]
ds_read_b64_tr_b16 a[116:117], v17 offset:16928
v_mfma_f32_16x16x32_bf16 v[136:139], a[24:27], a[136:139], v[136:139]
ds_read_b64_tr_b16 a[118:119], v17 offset:17440
v_mfma_f32_16x16x32_bf16 v[140:143], a[24:27], a[140:143], v[140:143]
buffer_load_dwordx4 a[188:191], v11, s[16:19], s52 offen offset:1024 sc1
v_mfma_f32_16x16x32_bf16 v[124:127], a[20:23], a[140:143], v[124:127]
ds_read_b64_tr_b16 a[120:121], v17 offset:25344
s_add_u32 s52, s52, 0x20000
v_mfma_f32_16x16x32_bf16 v[120:123], a[20:23], a[136:139], v[120:123]
v_mfma_f32_16x16x32_bf16 v[104:107], a[16:19], a[136:139], v[104:107]
ds_read_b64_tr_b16 a[122:123], v17 offset:25856
v_mfma_f32_16x16x32_bf16 v[108:111], a[16:19], a[140:143], v[108:111]
ds_read_b64_tr_b16 a[124:125], v17 offset:25376
v_mfma_f32_16x16x32_bf16 v[92:95], a[12:15], a[140:143], v[92:95]
ds_read_b64_tr_b16 a[126:127], v17 offset:25888
s_max_i32 m0, s67, s59
v_mfma_f32_16x16x32_bf16 v[88:91], a[12:15], a[136:139], v[88:91]
buffer_load_dwordx4 v5, s[28:31], s58 offen lds
v_mfma_f32_16x16x32_bf16 v[72:75], a[8:11], a[136:139], v[72:75]
v_mfma_f32_16x16x32_bf16 v[76:79], a[8:11], a[140:143], v[76:79]
v_mfma_f32_16x16x32_bf16 v[60:63], a[4:7], a[140:143], v[60:63]
v_mfma_f32_16x16x32_bf16 v[56:59], a[4:7], a[136:139], v[56:59]
v_mfma_f32_16x16x32_bf16 v[40:43], a[0:3], a[136:139], v[40:43]
v_mfma_f32_16x16x32_bf16 v[44:47], a[0:3], a[140:143], v[44:47]
s_waitcnt vmcnt(18) lgkmcnt(0)
s_barrier
v_mfma_f32_16x16x32_bf16 v[32:35], a[64:67], a[144:147], v[32:35]
ds_read_b64_tr_b16 a[0:1], v16 offset:33792
s_add_u32 m0, s55, 101376
v_mfma_f32_16x16x32_bf16 v[36:39], a[64:67], a[148:151], v[36:39]
buffer_load_dwordx4 v12, s[32:35], s54 offen lds
v_mfma_f32_16x16x32_bf16 v[52:55], a[68:71], a[148:151], v[52:55]
ds_read_b64_tr_b16 a[2:3], v16 offset:34304
v_mfma_f32_16x16x32_bf16 v[48:51], a[68:71], a[144:147], v[48:51]
ds_read_b64_tr_b16 a[4:5], v16 offset:33824
v_mfma_f32_16x16x32_bf16 v[64:67], a[72:75], a[144:147], v[64:67]
ds_read_b64_tr_b16 a[6:7], v16 offset:34336
v_mfma_f32_16x16x32_bf16 v[68:71], a[72:75], a[148:151], v[68:71]
v_mfma_f32_16x16x32_bf16 v[84:87], a[76:79], a[148:151], v[84:87]
ds_read_b64_tr_b16 a[8:9], v16 offset:42240
v_mfma_f32_16x16x32_bf16 v[80:83], a[76:79], a[144:147], v[80:83]
buffer_load_dwordx4 a[128:131], v10, s[16:19], s52 offen sc1
v_mfma_f32_16x16x32_bf16 v[96:99], a[80:83], a[144:147], v[96:99]
ds_read_b64_tr_b16 a[10:11], v16 offset:42752
v_mfma_f32_16x16x32_bf16 v[100:103], a[80:83], a[148:151], v[100:103]
ds_read_b64_tr_b16 a[12:13], v16 offset:42272
v_mfma_f32_16x16x32_bf16 v[116:119], a[84:87], a[148:151], v[116:119]
ds_read_b64_tr_b16 a[14:15], v16 offset:42784
v_mfma_f32_16x16x32_bf16 v[112:115], a[84:87], a[144:147], v[112:115]
v_mfma_f32_16x16x32_bf16 v[128:131], a[88:91], a[144:147], v[128:131]
ds_read_b64_tr_b16 a[16:17], v16 offset:33856
v_mfma_f32_16x16x32_bf16 v[132:135], a[88:91], a[148:151], v[132:135]
buffer_load_dwordx4 v13, s[32:35], s54 offen offset:1056 lds
v_mfma_f32_16x16x32_bf16 v[148:151], a[92:95], a[148:151], v[148:151]
ds_read_b64_tr_b16 a[18:19], v16 offset:34368
v_mfma_f32_16x16x32_bf16 v[144:147], a[92:95], a[144:147], v[144:147]
ds_read_b64_tr_b16 a[20:21], v16 offset:33888
v_mfma_f32_16x16x32_bf16 v[160:163], a[96:99], a[144:147], v[160:163]
v_mfma_f32_16x16x32_bf16 v[164:167], a[96:99], a[148:151], v[164:167]
ds_read_b64_tr_b16 a[22:23], v16 offset:34400
v_mfma_f32_16x16x32_bf16 v[180:183], a[100:103], a[148:151], v[180:183]
ds_read_b64_tr_b16 a[24:25], v16 offset:42304
v_mfma_f32_16x16x32_bf16 v[176:179], a[100:103], a[144:147], v[176:179]
buffer_load_dwordx4 a[132:135], v10, s[16:19], s52 offen offset:1024 sc1
v_mfma_f32_16x16x32_bf16 v[192:195], a[104:107], a[144:147], v[192:195]
ds_read_b64_tr_b16 a[26:27], v16 offset:42816
v_mfma_f32_16x16x32_bf16 v[196:199], a[104:107], a[148:151], v[196:199]
ds_read_b64_tr_b16 a[28:29], v16 offset:42336
v_mfma_f32_16x16x32_bf16 v[212:215], a[108:111], a[148:151], v[212:215]
v_mfma_f32_16x16x32_bf16 v[208:211], a[108:111], a[144:147], v[208:211]
ds_read_b64_tr_b16 a[30:31], v16 offset:42848
v_mfma_f32_16x16x32_bf16 v[224:227], a[112:115], a[144:147], v[224:227]
ds_read_b64_tr_b16 a[32:33], v16 offset:33920
v_mfma_f32_16x16x32_bf16 v[228:231], a[112:115], a[148:151], v[228:231]
buffer_load_dwordx4 v14, s[32:35], s54 offen offset:2112 lds
v_mfma_f32_16x16x32_bf16 v[236:239], a[116:119], a[148:151], v[236:239]
ds_read_b64_tr_b16 a[34:35], v16 offset:34432
v_mfma_f32_16x16x32_bf16 v[232:235], a[116:119], a[144:147], v[232:235]
v_mfma_f32_16x16x32_bf16 v[240:243], a[120:123], a[144:147], v[240:243]
ds_read_b64_tr_b16 a[36:37], v16 offset:33952
v_mfma_f32_16x16x32_bf16 v[244:247], a[120:123], a[148:151], v[244:247]
ds_read_b64_tr_b16 a[38:39], v16 offset:34464
v_mfma_f32_16x16x32_bf16 v[252:255], a[124:127], a[148:151], v[252:255]
ds_read_b64_tr_b16 a[40:41], v16 offset:42368
v_mfma_f32_16x16x32_bf16 v[248:251], a[124:127], a[144:147], v[248:251]
buffer_load_dwordx4 a[136:139], v11, s[16:19], s52 offen sc1
s_waitcnt vmcnt(23)
v_mfma_f32_16x16x32_bf16 v[220:223], a[108:111], a[156:159], v[220:223]
ds_read_b64_tr_b16 a[42:43], v16 offset:42880
v_mfma_f32_16x16x32_bf16 v[216:219], a[108:111], a[152:155], v[216:219]
v_mfma_f32_16x16x32_bf16 v[200:203], a[104:107], a[152:155], v[200:203]
ds_read_b64_tr_b16 a[44:45], v16 offset:42400
v_mfma_f32_16x16x32_bf16 v[204:207], a[104:107], a[156:159], v[204:207]
ds_read_b64_tr_b16 a[46:47], v16 offset:42912
v_mfma_f32_16x16x32_bf16 v[188:191], a[100:103], a[156:159], v[188:191]
ds_read_b64_tr_b16 a[48:49], v17 offset:33792
v_mfma_f32_16x16x32_bf16 v[184:187], a[100:103], a[152:155], v[184:187]
buffer_load_dwordx4 v15, s[32:35], s54 offen offset:3168 lds
v_mfma_f32_16x16x32_bf16 v[168:171], a[96:99], a[152:155], v[168:171]
s_add_u32 s54, s54, 229376
v_mfma_f32_16x16x32_bf16 v[172:175], a[96:99], a[156:159], v[172:175]
ds_read_b64_tr_b16 a[50:51], v17 offset:34304
v_mfma_f32_16x16x32_bf16 v[156:159], a[92:95], a[156:159], v[156:159]
ds_read_b64_tr_b16 a[52:53], v17 offset:33824
v_mfma_f32_16x16x32_bf16 v[152:155], a[92:95], a[152:155], v[152:155]
ds_read_b64_tr_b16 a[54:55], v17 offset:34336
v_mfma_f32_16x16x32_bf16 v[136:139], a[88:91], a[152:155], v[136:139]
ds_read_b64_tr_b16 a[56:57], v17 offset:42240
v_mfma_f32_16x16x32_bf16 v[140:143], a[88:91], a[156:159], v[140:143]
buffer_load_dwordx4 a[140:143], v11, s[16:19], s52 offen offset:1024 sc1
v_mfma_f32_16x16x32_bf16 v[124:127], a[84:87], a[156:159], v[124:127]
s_add_u32 s52, s52, 0x20000
v_mfma_f32_16x16x32_bf16 v[120:123], a[84:87], a[152:155], v[120:123]
ds_read_b64_tr_b16 a[58:59], v17 offset:42752
v_mfma_f32_16x16x32_bf16 v[104:107], a[80:83], a[152:155], v[104:107]
ds_read_b64_tr_b16 a[60:61], v17 offset:42272
v_mfma_f32_16x16x32_bf16 v[108:111], a[80:83], a[156:159], v[108:111]
ds_read_b64_tr_b16 a[62:63], v17 offset:42784
v_mfma_f32_16x16x32_bf16 v[92:95], a[76:79], a[156:159], v[92:95]
s_max_i32 m0, s67, s59
v_mfma_f32_16x16x32_bf16 v[88:91], a[76:79], a[152:155], v[88:91]
buffer_load_dwordx4 v6, s[28:31], s58 offen offset:1056 lds
v_mfma_f32_16x16x32_bf16 v[72:75], a[72:75], a[152:155], v[72:75]
s_add_u32 s67, s67, 8448
s_add_u32 s58, s58, 0x10000
v_mfma_f32_16x16x32_bf16 v[76:79], a[72:75], a[156:159], v[76:79]
v_mfma_f32_16x16x32_bf16 v[60:63], a[68:71], a[156:159], v[60:63]
v_mfma_f32_16x16x32_bf16 v[56:59], a[68:71], a[152:155], v[56:59]
v_mfma_f32_16x16x32_bf16 v[40:43], a[64:67], a[152:155], v[40:43]
v_mfma_f32_16x16x32_bf16 v[44:47], a[64:67], a[156:159], v[44:47]
s_waitcnt vmcnt(19) lgkmcnt(0)
s_barrier
v_mfma_f32_16x16x32_bf16 v[32:35], a[0:3], a[160:163], v[32:35]
ds_read_b64_tr_b16 a[64:65], v16 offset:50688
s_add_u32 m0, s55, 118272
v_mfma_f32_16x16x32_bf16 v[36:39], a[0:3], a[164:167], v[36:39]
buffer_load_dwordx4 v12, s[32:35], s54 offen lds
v_mfma_f32_16x16x32_bf16 v[52:55], a[4:7], a[164:167], v[52:55]
ds_read_b64_tr_b16 a[66:67], v16 offset:51200
v_mfma_f32_16x16x32_bf16 v[48:51], a[4:7], a[160:163], v[48:51]
ds_read_b64_tr_b16 a[68:69], v16 offset:50720
v_mfma_f32_16x16x32_bf16 v[64:67], a[8:11], a[160:163], v[64:67]
ds_read_b64_tr_b16 a[70:71], v16 offset:51232
v_mfma_f32_16x16x32_bf16 v[68:71], a[8:11], a[164:167], v[68:71]
v_mfma_f32_16x16x32_bf16 v[84:87], a[12:15], a[164:167], v[84:87]
ds_read_b64_tr_b16 a[72:73], v16 offset:59136
v_mfma_f32_16x16x32_bf16 v[80:83], a[12:15], a[160:163], v[80:83]
buffer_load_dwordx4 a[144:147], v10, s[16:19], s52 offen sc1
v_mfma_f32_16x16x32_bf16 v[96:99], a[16:19], a[160:163], v[96:99]
ds_read_b64_tr_b16 a[74:75], v16 offset:59648
v_mfma_f32_16x16x32_bf16 v[100:103], a[16:19], a[164:167], v[100:103]
ds_read_b64_tr_b16 a[76:77], v16 offset:59168
v_mfma_f32_16x16x32_bf16 v[116:119], a[20:23], a[164:167], v[116:119]
v_mfma_f32_16x16x32_bf16 v[112:115], a[20:23], a[160:163], v[112:115]
ds_read_b64_tr_b16 a[78:79], v16 offset:59680
v_mfma_f32_16x16x32_bf16 v[128:131], a[24:27], a[160:163], v[128:131]
ds_read_b64_tr_b16 a[80:81], v16 offset:50752
v_mfma_f32_16x16x32_bf16 v[132:135], a[24:27], a[164:167], v[132:135]
buffer_load_dwordx4 v13, s[32:35], s54 offen offset:1056 lds
v_mfma_f32_16x16x32_bf16 v[148:151], a[28:31], a[164:167], v[148:151]
ds_read_b64_tr_b16 a[82:83], v16 offset:51264
v_mfma_f32_16x16x32_bf16 v[144:147], a[28:31], a[160:163], v[144:147]
v_mfma_f32_16x16x32_bf16 v[160:163], a[32:35], a[160:163], v[160:163]
ds_read_b64_tr_b16 a[84:85], v16 offset:50784
v_mfma_f32_16x16x32_bf16 v[164:167], a[32:35], a[164:167], v[164:167]
ds_read_b64_tr_b16 a[86:87], v16 offset:51296
v_mfma_f32_16x16x32_bf16 v[180:183], a[36:39], a[164:167], v[180:183]
ds_read_b64_tr_b16 a[88:89], v16 offset:59200
v_mfma_f32_16x16x32_bf16 v[176:179], a[36:39], a[160:163], v[176:179]
buffer_load_dwordx4 a[148:151], v10, s[16:19], s52 offen offset:1024 sc1
v_mfma_f32_16x16x32_bf16 v[192:195], a[40:43], a[160:163], v[192:195]
v_mfma_f32_16x16x32_bf16 v[196:199], a[40:43], a[164:167], v[196:199]
ds_read_b64_tr_b16 a[90:91], v16 offset:59712
v_mfma_f32_16x16x32_bf16 v[212:215], a[44:47], a[164:167], v[212:215]
ds_read_b64_tr_b16 a[92:93], v16 offset:59232
v_mfma_f32_16x16x32_bf16 v[208:211], a[44:47], a[160:163], v[208:211]
ds_read_b64_tr_b16 a[94:95], v16 offset:59744
v_mfma_f32_16x16x32_bf16 v[224:227], a[48:51], a[160:163], v[224:227]
v_mfma_f32_16x16x32_bf16 v[228:231], a[48:51], a[164:167], v[228:231]
buffer_load_dwordx4 v14, s[32:35], s54 offen offset:2112 lds
v_mfma_f32_16x16x32_bf16 v[236:239], a[52:55], a[164:167], v[236:239]
ds_read_b64_tr_b16 a[96:97], v16 offset:50816
v_mfma_f32_16x16x32_bf16 v[232:235], a[52:55], a[160:163], v[232:235]
ds_read_b64_tr_b16 a[98:99], v16 offset:51328
v_mfma_f32_16x16x32_bf16 v[240:243], a[56:59], a[160:163], v[240:243]
ds_read_b64_tr_b16 a[100:101], v16 offset:50848
v_mfma_f32_16x16x32_bf16 v[244:247], a[56:59], a[164:167], v[244:247]
ds_read_b64_tr_b16 a[102:103], v16 offset:51360
v_mfma_f32_16x16x32_bf16 v[252:255], a[60:63], a[164:167], v[252:255]
v_mfma_f32_16x16x32_bf16 v[248:251], a[60:63], a[160:163], v[248:251]
buffer_load_dwordx4 a[152:155], v11, s[16:19], s52 offen sc1
s_waitcnt vmcnt(24)
v_mfma_f32_16x16x32_bf16 v[220:223], a[44:47], a[172:175], v[220:223]
ds_read_b64_tr_b16 a[104:105], v16 offset:59264
v_mfma_f32_16x16x32_bf16 v[216:219], a[44:47], a[168:171], v[216:219]
ds_read_b64_tr_b16 a[106:107], v16 offset:59776
v_mfma_f32_16x16x32_bf16 v[200:203], a[40:43], a[168:171], v[200:203]
ds_read_b64_tr_b16 a[108:109], v16 offset:59296
v_mfma_f32_16x16x32_bf16 v[204:207], a[40:43], a[172:175], v[204:207]
v_mfma_f32_16x16x32_bf16 v[188:191], a[36:39], a[172:175], v[188:191]
ds_read_b64_tr_b16 a[110:111], v16 offset:59808
v_mfma_f32_16x16x32_bf16 v[184:187], a[36:39], a[168:171], v[184:187]
buffer_load_dwordx4 v15, s[32:35], s54 offen offset:3168 lds
v_mfma_f32_16x16x32_bf16 v[168:171], a[32:35], a[168:171], v[168:171]
ds_read_b64_tr_b16 a[112:113], v17 offset:50688
s_add_u32 s54, s54, 229376
v_mfma_f32_16x16x32_bf16 v[172:175], a[32:35], a[172:175], v[172:175]
ds_read_b64_tr_b16 a[114:115], v17 offset:51200
v_mfma_f32_16x16x32_bf16 v[156:159], a[28:31], a[172:175], v[156:159]
v_mfma_f32_16x16x32_bf16 v[152:155], a[28:31], a[168:171], v[152:155]
ds_read_b64_tr_b16 a[116:117], v17 offset:50720
v_mfma_f32_16x16x32_bf16 v[136:139], a[24:27], a[168:171], v[136:139]
ds_read_b64_tr_b16 a[118:119], v17 offset:51232
v_mfma_f32_16x16x32_bf16 v[140:143], a[24:27], a[172:175], v[140:143]
buffer_load_dwordx4 a[156:159], v11, s[16:19], s52 offen offset:1024 sc1
v_mfma_f32_16x16x32_bf16 v[124:127], a[20:23], a[172:175], v[124:127]
ds_read_b64_tr_b16 a[120:121], v17 offset:59136
s_add_u32 s52, s52, 0x20000
v_mfma_f32_16x16x32_bf16 v[120:123], a[20:23], a[168:171], v[120:123]
v_mfma_f32_16x16x32_bf16 v[104:107], a[16:19], a[168:171], v[104:107]
ds_read_b64_tr_b16 a[122:123], v17 offset:59648
v_mfma_f32_16x16x32_bf16 v[108:111], a[16:19], a[172:175], v[108:111]
ds_read_b64_tr_b16 a[124:125], v17 offset:59168
v_mfma_f32_16x16x32_bf16 v[92:95], a[12:15], a[172:175], v[92:95]
ds_read_b64_tr_b16 a[126:127], v17 offset:59680
s_max_i32 m0, s67, s59
v_mfma_f32_16x16x32_bf16 v[88:91], a[12:15], a[168:171], v[88:91]
buffer_load_dwordx4 v5, s[28:31], s58 offen lds
v_mfma_f32_16x16x32_bf16 v[72:75], a[8:11], a[168:171], v[72:75]
v_mfma_f32_16x16x32_bf16 v[76:79], a[8:11], a[172:175], v[76:79]
v_mfma_f32_16x16x32_bf16 v[60:63], a[4:7], a[172:175], v[60:63]
v_mfma_f32_16x16x32_bf16 v[56:59], a[4:7], a[168:171], v[56:59]
v_mfma_f32_16x16x32_bf16 v[40:43], a[0:3], a[168:171], v[40:43]
v_mfma_f32_16x16x32_bf16 v[44:47], a[0:3], a[172:175], v[44:47]
s_waitcnt vmcnt(20) lgkmcnt(0)
s_barrier
v_mfma_f32_16x16x32_bf16 v[32:35], a[64:67], a[176:179], v[32:35]
ds_read_b64_tr_b16 a[0:1], v16
s_add_u32 m0, s55, 135168
v_mfma_f32_16x16x32_bf16 v[36:39], a[64:67], a[180:183], v[36:39]
buffer_load_dwordx4 v12, s[32:35], s54 offen lds
v_mfma_f32_16x16x32_bf16 v[52:55], a[68:71], a[180:183], v[52:55]
ds_read_b64_tr_b16 a[2:3], v16 offset:512
v_mfma_f32_16x16x32_bf16 v[48:51], a[68:71], a[176:179], v[48:51]
ds_read_b64_tr_b16 a[4:5], v16 offset:32
v_mfma_f32_16x16x32_bf16 v[64:67], a[72:75], a[176:179], v[64:67]
ds_read_b64_tr_b16 a[6:7], v16 offset:544
.Lpad21:
s_cbranch_execz .Lnopoll72r
v_mfma_f32_16x16x32_bf16 v[68:71], a[72:75], a[180:183], v[68:71]
v_mfma_f32_16x16x32_bf16 v[84:87], a[76:79], a[180:183], v[84:87]
ds_read_b64_tr_b16 a[8:9], v16 offset:8448
v_mfma_f32_16x16x32_bf16 v[80:83], a[76:79], a[176:179], v[80:83]
buffer_load_dwordx4 a[160:163], v10, s[16:19], s52 offen sc1
v_mfma_f32_16x16x32_bf16 v[96:99], a[80:83], a[176:179], v[96:99]
ds_read_b64_tr_b16 a[10:11], v16 offset:8960
v_mfma_f32_16x16x32_bf16 v[100:103], a[80:83], a[180:183], v[100:103]
ds_read_b64_tr_b16 a[12:13], v16 offset:8480
v_mfma_f32_16x16x32_bf16 v[116:119], a[84:87], a[180:183], v[116:119]
ds_read_b64_tr_b16 a[14:15], v16 offset:8992
v_mfma_f32_16x16x32_bf16 v[112:115], a[84:87], a[176:179], v[112:115]
v_mfma_f32_16x16x32_bf16 v[128:131], a[88:91], a[176:179], v[128:131]
ds_read_b64_tr_b16 a[16:17], v16 offset:64
v_mfma_f32_16x16x32_bf16 v[132:135], a[88:91], a[180:183], v[132:135]
buffer_load_dwordx4 v13, s[32:35], s54 offen offset:1056 lds
v_mfma_f32_16x16x32_bf16 v[148:151], a[92:95], a[180:183], v[148:151]
ds_read_b64_tr_b16 a[18:19], v16 offset:576
v_mfma_f32_16x16x32_bf16 v[144:147], a[92:95], a[176:179], v[144:147]
ds_read_b64_tr_b16 a[20:21], v16 offset:96
v_mfma_f32_16x16x32_bf16 v[160:163], a[96:99], a[176:179], v[160:163]
v_mfma_f32_16x16x32_bf16 v[164:167], a[96:99], a[180:183], v[164:167]
ds_read_b64_tr_b16 a[22:23], v16 offset:608
v_mfma_f32_16x16x32_bf16 v[180:183], a[100:103], a[180:183], v[180:183]
ds_read_b64_tr_b16 a[24:25], v16 offset:8512
v_mfma_f32_16x16x32_bf16 v[176:179], a[100:103], a[176:179], v[176:179]
buffer_load_dwordx4 a[164:167], v10, s[16:19], s52 offen offset:1024 sc1
v_mfma_f32_16x16x32_bf16 v[192:195], a[104:107], a[176:179], v[192:195]
ds_read_b64_tr_b16 a[26:27], v16 offset:9024
v_mfma_f32_16x16x32_bf16 v[196:199], a[104:107], a[180:183], v[196:199]
ds_read_b64_tr_b16 a[28:29], v16 offset:8544
v_mfma_f32_16x16x32_bf16 v[212:215], a[108:111], a[180:183], v[212:215]
v_mfma_f32_16x16x32_bf16 v[208:211], a[108:111], a[176:179], v[208:211]
ds_read_b64_tr_b16 a[30:31], v16 offset:9056
v_mfma_f32_16x16x32_bf16 v[224:227], a[112:115], a[176:179], v[224:227]
ds_read_b64_tr_b16 a[32:33], v16 offset:128
v_mfma_f32_16x16x32_bf16 v[228:231], a[112:115], a[180:183], v[228:231]
buffer_load_dwordx4 v14, s[32:35], s54 offen offset:2112 lds
v_mfma_f32_16x16x32_bf16 v[236:239], a[116:119], a[180:183], v[236:239]
ds_read_b64_tr_b16 a[34:35], v16 offset:640
v_mfma_f32_16x16x32_bf16 v[232:235], a[116:119], a[176:179], v[232:235]
v_mfma_f32_16x16x32_bf16 v[240:243], a[120:123], a[176:179], v[240:243]
ds_read_b64_tr_b16 a[36:37], v16 offset:160
v_mfma_f32_16x16x32_bf16 v[244:247], a[120:123], a[180:183], v[244:247]
ds_read_b64_tr_b16 a[38:39], v16 offset:672
v_mfma_f32_16x16x32_bf16 v[252:255], a[124:127], a[180:183], v[252:255]
ds_read_b64_tr_b16 a[40:41], v16 offset:8576
v_mfma_f32_16x16x32_bf16 v[248:251], a[124:127], a[176:179], v[248:251]
buffer_load_dwordx4 a[168:171], v11, s[16:19], s52 offen sc1
s_waitcnt vmcnt(25)
v_mfma_f32_16x16x32_bf16 v[220:223], a[108:111], a[188:191], v[220:223]
ds_read_b64_tr_b16 a[42:43], v16 offset:9088
v_mfma_f32_16x16x32_bf16 v[216:219], a[108:111], a[184:187], v[216:219]
v_mfma_f32_16x16x32_bf16 v[200:203], a[104:107], a[184:187], v[200:203]
ds_read_b64_tr_b16 a[44:45], v16 offset:8608
v_mfma_f32_16x16x32_bf16 v[204:207], a[104:107], a[188:191], v[204:207]
ds_read_b64_tr_b16 a[46:47], v16 offset:9120
v_mfma_f32_16x16x32_bf16 v[188:191], a[100:103], a[188:191], v[188:191]
ds_read_b64_tr_b16 a[48:49], v17
v_mfma_f32_16x16x32_bf16 v[184:187], a[100:103], a[184:187], v[184:187]
buffer_load_dwordx4 v15, s[32:35], s54 offen offset:3168 lds
v_mfma_f32_16x16x32_bf16 v[168:171], a[96:99], a[184:187], v[168:171]
s_add_u32 s54, s54, 229376
v_mfma_f32_16x16x32_bf16 v[172:175], a[96:99], a[188:191], v[172:175]
ds_read_b64_tr_b16 a[50:51], v17 offset:512
v_mfma_f32_16x16x32_bf16 v[156:159], a[92:95], a[188:191], v[156:159]
ds_read_b64_tr_b16 a[52:53], v17 offset:32
v_mfma_f32_16x16x32_bf16 v[152:155], a[92:95], a[184:187], v[152:155]
ds_read_b64_tr_b16 a[54:55], v17 offset:544
v_mfma_f32_16x16x32_bf16 v[136:139], a[88:91], a[184:187], v[136:139]
ds_read_b64_tr_b16 a[56:57], v17 offset:8448
v_mfma_f32_16x16x32_bf16 v[140:143], a[88:91], a[188:191], v[140:143]
buffer_load_dwordx4 a[172:175], v11, s[16:19], s52 offen offset:1024 sc1
v_mfma_f32_16x16x32_bf16 v[124:127], a[84:87], a[188:191], v[124:127]
s_add_u32 s52, s52, 0x20000
v_mfma_f32_16x16x32_bf16 v[120:123], a[84:87], a[184:187], v[120:123]
ds_read_b64_tr_b16 a[58:59], v17 offset:8960
v_mfma_f32_16x16x32_bf16 v[104:107], a[80:83], a[184:187], v[104:107]
ds_read_b64_tr_b16 a[60:61], v17 offset:8480
v_mfma_f32_16x16x32_bf16 v[108:111], a[80:83], a[188:191], v[108:111]
ds_read_b64_tr_b16 a[62:63], v17 offset:8992
v_mfma_f32_16x16x32_bf16 v[92:95], a[76:79], a[188:191], v[92:95]
s_max_i32 m0, s67, s59
v_mfma_f32_16x16x32_bf16 v[88:91], a[76:79], a[184:187], v[88:91]
buffer_load_dwordx4 v6, s[28:31], s58 offen offset:1056 lds
v_mfma_f32_16x16x32_bf16 v[72:75], a[72:75], a[184:187], v[72:75]
s_add_u32 s67, s67, 8448
s_add_u32 s58, s58, 0x10000
v_mfma_f32_16x16x32_bf16 v[76:79], a[72:75], a[188:191], v[76:79]
v_mfma_f32_16x16x32_bf16 v[60:63], a[68:71], a[188:191], v[60:63]
v_mfma_f32_16x16x32_bf16 v[56:59], a[68:71], a[184:187], v[56:59]
v_mfma_f32_16x16x32_bf16 v[40:43], a[64:67], a[184:187], v[40:43]
s_add_u32 s15, s15, 1
v_mfma_f32_16x16x32_bf16 v[44:47], a[64:67], a[188:191], v[44:47]
s_cbranch_scc0 .Lk74
s_waitcnt vmcnt(11) lgkmcnt(0)
s_barrier
v_mfma_f32_16x16x32_bf16 v[32:35], a[0:3], a[128:131], v[32:35]
ds_read_b128 v[12:15], v9
v_mov_b32 v18, v5
v_mfma_f32_16x16x32_bf16 v[48:51], a[4:7], a[128:131], v[48:51]
buffer_load_dwordx4 a[176:179], v10, s[16:19], s52 offen sc1
v_mfma_f32_16x16x32_bf16 v[64:67], a[8:11], a[128:131], v[64:67]
ds_read_b64_tr_b16 a[64:65], v16 offset:16896
v_mov_b32 v19, v6
v_mfma_f32_16x16x32_bf16 v[80:83], a[12:15], a[128:131], v[80:83]
ds_read_b128 v[4:7], v9 offset:64
s_mov_b32 s58, 655360
v_mfma_f32_16x16x32_bf16 v[36:39], a[0:3], a[132:135], v[36:39]
ds_read_b64_tr_b16 a[66:67], v16 offset:17408
v_mfma_f32_16x16x32_bf16 v[52:55], a[4:7], a[132:135], v[52:55]
buffer_load_dwordx4 a[180:183], v10, s[16:19], s52 offen offset:1024 sc1
v_mfma_f32_16x16x32_bf16 v[68:71], a[8:11], a[132:135], v[68:71]
ds_read_b64_tr_b16 a[68:69], v16 offset:16928
v_mfma_f32_16x16x32_bf16 v[84:87], a[12:15], a[132:135], v[84:87]
ds_read_b64_tr_b16 a[70:71], v16 offset:17440
v_mfma_f32_16x16x32_bf16 v[40:43], a[0:3], a[136:139], v[40:43]
ds_read_b64_tr_b16 a[72:73], v16 offset:25344
s_waitcnt lgkmcnt(6)
v_fmac_f32 v32, v12, v20
v_mfma_f32_16x16x32_bf16 v[56:59], a[4:7], a[136:139], v[56:59]
buffer_load_dwordx4 a[184:187], v11, s[16:19], s52 offen sc1
v_mfma_f32_16x16x32_bf16 v[72:75], a[8:11], a[136:139], v[72:75]
ds_read_b64_tr_b16 a[74:75], v16 offset:25856
v_fmac_f32 v33, v13, v20
v_mfma_f32_16x16x32_bf16 v[88:91], a[12:15], a[136:139], v[88:91]
ds_read_b64_tr_b16 a[76:77], v16 offset:25376
v_fmac_f32 v34, v14, v20
v_mfma_f32_16x16x32_bf16 v[44:47], a[0:3], a[140:143], v[44:47]
ds_read_b64_tr_b16 a[78:79], v16 offset:25888
v_fmac_f32 v35, v15, v20
v_mfma_f32_16x16x32_bf16 v[60:63], a[4:7], a[140:143], v[60:63]
buffer_load_dwordx4 a[188:191], v11, s[16:19], s52 offen offset:1024 sc1
v_mfma_f32_16x16x32_bf16 v[76:79], a[8:11], a[140:143], v[76:79]
s_add_u32 s52, s52, 0x20000
ds_read_b64_tr_b16 a[80:81], v16 offset:33792
v_mfma_f32_16x16x32_bf16 v[92:95], a[12:15], a[140:143], v[92:95]
ds_read_b64_tr_b16 a[82:83], v16 offset:34304
v_fmac_f32 v36, v12, v22
v_mfma_f32_16x16x32_bf16 v[96:99], a[16:19], a[128:131], v[96:99]
ds_read_b64_tr_b16 a[84:85], v16 offset:33824
v_fmac_f32 v37, v13, v22
v_mfma_f32_16x16x32_bf16 v[112:115], a[20:23], a[128:131], v[112:115]
ds_read_b64_tr_b16 a[86:87], v16 offset:34336
v_fmac_f32 v38, v14, v22
v_mfma_f32_16x16x32_bf16 v[128:131], a[24:27], a[128:131], v[128:131]
ds_read_b64_tr_b16 a[88:89], v16 offset:42240
v_fmac_f32 v39, v15, v22
v_mfma_f32_16x16x32_bf16 v[144:147], a[28:31], a[128:131], v[144:147]
ds_read_b64_tr_b16 a[90:91], v16 offset:42752
v_fmac_f32 v40, v12, v24
v_mfma_f32_16x16x32_bf16 v[100:103], a[16:19], a[132:135], v[100:103]
ds_read_b64_tr_b16 a[92:93], v16 offset:42272
v_fmac_f32 v41, v13, v24
v_mfma_f32_16x16x32_bf16 v[116:119], a[20:23], a[132:135], v[116:119]
ds_read_b64_tr_b16 a[94:95], v16 offset:42784
v_fmac_f32 v42, v14, v24
v_mfma_f32_16x16x32_bf16 v[132:135], a[24:27], a[132:135], v[132:135]
ds_read_b64_tr_b16 a[112:113], v16 offset:16960
v_fmac_f32 v43, v15, v24
v_mfma_f32_16x16x32_bf16 v[148:151], a[28:31], a[132:135], v[148:151]
ds_read_b64_tr_b16 a[114:115], v16 offset:17472
v_fmac_f32 v44, v12, v26
v_mfma_f32_16x16x32_bf16 v[104:107], a[16:19], a[136:139], v[104:107]
ds_read_b64_tr_b16 a[116:117], v16 offset:16992
v_fmac_f32 v45, v13, v26
v_mfma_f32_16x16x32_bf16 v[120:123], a[20:23], a[136:139], v[120:123]
ds_read_b64_tr_b16 a[118:119], v16 offset:17504
v_fmac_f32 v46, v14, v26
v_mfma_f32_16x16x32_bf16 v[136:139], a[24:27], a[136:139], v[136:139]
ds_read_b64_tr_b16 a[120:121], v16 offset:25408
v_fmac_f32 v47, v15, v26
v_mfma_f32_16x16x32_bf16 v[152:155], a[28:31], a[136:139], v[152:155]
ds_read_b128 v[12:15], v9 offset:512
s_waitcnt lgkmcnt(15)
v_fmac_f32 v48, v4, v20
v_mfma_f32_16x16x32_bf16 v[108:111], a[16:19], a[140:143], v[108:111]
ds_read_b64_tr_b16 a[122:123], v16 offset:25920
v_fmac_f32 v49, v5, v20
v_mfma_f32_16x16x32_bf16 v[124:127], a[20:23], a[140:143], v[124:127]
ds_read_b64_tr_b16 a[124:125], v16 offset:25440
v_fmac_f32 v50, v6, v20
v_mfma_f32_16x16x32_bf16 v[140:143], a[24:27], a[140:143], v[140:143]
ds_read_b64_tr_b16 a[126:127], v16 offset:25952
v_fmac_f32 v51, v7, v20
v_mfma_f32_16x16x32_bf16 v[156:159], a[28:31], a[140:143], v[156:159]
ds_read_b64_tr_b16 a[192:193], v16 offset:33856
v_fmac_f32 v52, v4, v22
v_mfma_f32_16x16x32_bf16 v[160:163], a[32:35], a[128:131], v[160:163]
ds_read_b64_tr_b16 a[194:195], v16 offset:34368
v_fmac_f32 v53, v5, v22
v_mfma_f32_16x16x32_bf16 v[176:179], a[36:39], a[128:131], v[176:179]
ds_read_b64_tr_b16 a[196:197], v16 offset:33888
v_fmac_f32 v54, v6, v22
v_mfma_f32_16x16x32_bf16 v[192:195], a[40:43], a[128:131], v[192:195]
ds_read_b64_tr_b16 a[198:199], v16 offset:34400
v_fmac_f32 v55, v7, v22
v_mfma_f32_16x16x32_bf16 v[208:211], a[44:47], a[128:131], v[208:211]
ds_read_b64_tr_b16 a[200:201], v16 offset:42304
v_fmac_f32 v56, v4, v24
v_mfma_f32_16x16x32_bf16 v[164:167], a[32:35], a[132:135], v[164:167]
ds_read_b64_tr_b16 a[202:203], v16 offset:42816
v_fmac_f32 v57, v5, v24
v_mfma_f32_16x16x32_bf16 v[180:183], a[36:39], a[132:135], v[180:183]
ds_read_b64_tr_b16 a[204:205], v16 offset:42336
s_waitcnt vmcnt(6)
s_barrier
v_mfma_f32_16x16x32_bf16 v[196:199], a[40:43], a[132:135], v[196:199]
ds_read_b64_tr_b16 a[96:97], v16 offset:50688
v_fmac_f32 v58, v6, v24
v_mfma_f32_16x16x32_bf16 v[212:215], a[44:47], a[132:135], v[212:215]
ds_read_b64_tr_b16 a[98:99], v16 offset:51200
v_fmac_f32 v59, v7, v24
v_mfma_f32_16x16x32_bf16 v[168:171], a[32:35], a[136:139], v[168:171]
ds_read_b64_tr_b16 a[100:101], v16 offset:50720
v_fmac_f32 v60, v4, v26
v_mfma_f32_16x16x32_bf16 v[184:187], a[36:39], a[136:139], v[184:187]
ds_read_b64_tr_b16 a[102:103], v16 offset:51232
v_fmac_f32 v61, v5, v26
v_mfma_f32_16x16x32_bf16 v[200:203], a[40:43], a[136:139], v[200:203]
ds_read_b64_tr_b16 a[104:105], v16 offset:59136
v_fmac_f32 v62, v6, v26
v_mfma_f32_16x16x32_bf16 v[216:219], a[44:47], a[136:139], v[216:219]
ds_read_b64_tr_b16 a[106:107], v16 offset:59648
v_fmac_f32 v63, v7, v26
v_mfma_f32_16x16x32_bf16 v[172:175], a[32:35], a[140:143], v[172:175]
ds_read_b128 v[4:7], v9 offset:576
s_waitcnt lgkmcnt(15)
v_fmac_f32 v64, v12, v20
v_mfma_f32_16x16x32_bf16 v[188:191], a[36:39], a[140:143], v[188:191]
ds_read_b64_tr_b16 a[108:109], v16 offset:59168
v_fmac_f32 v65, v13, v20
v_mfma_f32_16x16x32_bf16 v[204:207], a[40:43], a[140:143], v[204:207]
ds_read_b64_tr_b16 a[110:111], v16 offset:59680
v_fmac_f32 v66, v14, v20
v_mfma_f32_16x16x32_bf16 v[220:223], a[44:47], a[140:143], v[220:223]
ds_read_b64_tr_b16 a[206:207], v16 offset:42848
v_fmac_f32 v67, v15, v20
v_mfma_f32_16x16x32_bf16 v[224:227], a[48:51], a[128:131], v[224:227]
ds_read_b64_tr_b16 a[208:209], v16 offset:50752
v_fmac_f32 v68, v12, v22
v_mfma_f32_16x16x32_bf16 v[232:235], a[52:55], a[128:131], v[232:235]
ds_read_b64_tr_b16 a[210:211], v16 offset:51264
v_fmac_f32 v69, v13, v22
v_mfma_f32_16x16x32_bf16 v[240:243], a[56:59], a[128:131], v[240:243]
ds_read_b64_tr_b16 a[212:213], v16 offset:50784
v_fmac_f32 v70, v14, v22
v_mfma_f32_16x16x32_bf16 v[248:251], a[60:63], a[128:131], v[248:251]
ds_read_b64_tr_b16 a[214:215], v16 offset:51296
v_fmac_f32 v71, v15, v22
v_mfma_f32_16x16x32_bf16 v[228:231], a[48:51], a[132:135], v[228:231]
ds_read_b64_tr_b16 a[216:217], v16 offset:59200
v_fmac_f32 v72, v12, v24
v_mfma_f32_16x16x32_bf16 v[236:239], a[52:55], a[132:135], v[236:239]
ds_read_b64_tr_b16 a[218:219], v16 offset:59712
v_fmac_f32 v73, v13, v24
v_mfma_f32_16x16x32_bf16 v[244:247], a[56:59], a[132:135], v[244:247]
ds_read_b64_tr_b16 a[220:221], v16 offset:59232
v_fmac_f32 v74, v14, v24
v_mfma_f32_16x16x32_bf16 v[252:255], a[60:63], a[132:135], v[252:255]
ds_read_b64_tr_b16 a[222:223], v16 offset:59744
v_fmac_f32 v75, v15, v24
v_mfma_f32_16x16x32_bf16 v[32:35], a[64:67], a[144:147], v[32:35]
ds_read_b64_tr_b16 a[0:1], v16 offset:17024
v_fmac_f32 v76, v12, v26
v_mfma_f32_16x16x32_bf16 v[48:51], a[68:71], a[144:147], v[48:51]
ds_read_b64_tr_b16 a[2:3], v16 offset:17536
v_fmac_f32 v77, v13, v26
v_mfma_f32_16x16x32_bf16 v[64:67], a[72:75], a[144:147], v[64:67]
ds_read_b64_tr_b16 a[4:5], v16 offset:17056
v_fmac_f32 v78, v14, v26
v_fmac_f32 v79, v15, v26
ds_read_b128 v[12:15], v9 offset:832
s_waitcnt lgkmcnt(15)
v_fmac_f32 v80, v4, v20
v_fmac_f32 v81, v5, v20
v_fmac_f32 v82, v6, v20
v_fmac_f32 v83, v7, v20
v_fmac_f32 v84, v4, v22
v_fmac_f32 v85, v5, v22
v_mfma_f32_16x16x32_bf16 v[80:83], a[76:79], a[144:147], v[80:83]
ds_read_b64_tr_b16 a[6:7], v16 offset:17568
v_fmac_f32 v86, v6, v22
v_mfma_f32_16x16x32_bf16 v[32:35], a[80:83], a[160:163], v[32:35]
ds_read_b64_tr_b16 a[8:9], v16 offset:25472
v_fmac_f32 v87, v7, v22
v_mfma_f32_16x16x32_bf16 v[48:51], a[84:87], a[160:163], v[48:51]
ds_read_b64_tr_b16 a[10:11], v16 offset:25984
v_fmac_f32 v88, v4, v24
v_mfma_f32_16x16x32_bf16 v[64:67], a[88:91], a[160:163], v[64:67]
ds_read_b64_tr_b16 a[12:13], v16 offset:25504
v_fmac_f32 v89, v5, v24
v_mfma_f32_16x16x32_bf16 v[80:83], a[92:95], a[160:163], v[80:83]
ds_read_b64_tr_b16 a[14:15], v16 offset:26016
v_fmac_f32 v90, v6, v24
s_waitcnt vmcnt(3)
v_mfma_f32_16x16x32_bf16 v[32:35], a[96:99], a[176:179], v[32:35]
ds_read_b64_tr_b16 a[16:17], v16 offset:33920
v_fmac_f32 v91, v7, v24
v_mfma_f32_16x16x32_bf16 v[48:51], a[100:103], a[176:179], v[48:51]
ds_read_b64_tr_b16 a[18:19], v16 offset:34432
v_fmac_f32 v92, v4, v26
v_mfma_f32_16x16x32_bf16 v[64:67], a[104:107], a[176:179], v[64:67]
ds_read_b64_tr_b16 a[20:21], v16 offset:33952
v_fmac_f32 v93, v5, v26
s_waitcnt lgkmcnt(15)
v_mfma_f32_16x16x32_bf16 v[80:83], a[108:111], a[176:179], v[80:83]
ds_read_b64_tr_b16 a[22:23], v16 offset:34464
v_fmac_f32 v94, v6, v26
v_fmac_f32 v95, v7, v26
ds_read_b128 v[4:7], v9 offset:704
v_pk_mul_f32 v[64:65], v[64:65], v[32:33]
v_pk_mul_f32 v[32:33], v[32:33], v[28:29] op_sel_hi:[1,0]
v_pk_mul_f32 v[66:67], v[66:67], v[34:35]
v_pk_mul_f32 v[34:35], v[34:35], v[28:29] op_sel_hi:[1,0]
v_pk_mul_f32 v[80:81], v[80:81], v[48:49]
v_pk_mul_f32 v[48:49], v[48:49], v[28:29] op_sel_hi:[1,0]
v_pk_mul_f32 v[82:83], v[82:83], v[50:51]
v_pk_mul_f32 v[50:51], v[50:51], v[28:29] op_sel_hi:[1,0]
v_exp_f32 v32, v32
s_nop 0
v_mfma_f32_16x16x32_bf16 v[36:39], a[64:67], a[148:151], v[36:39]
ds_read_b64_tr_b16 a[24:25], v16 offset:42368
v_exp_f32 v33, v33
v_mfma_f32_16x16x32_bf16 v[52:55], a[68:71], a[148:151], v[52:55]
ds_read_b64_tr_b16 a[26:27], v16 offset:42880
v_exp_f32 v34, v34
v_mfma_f32_16x16x32_bf16 v[68:71], a[72:75], a[148:151], v[68:71]
ds_read_b64_tr_b16 a[28:29], v16 offset:42400
v_exp_f32 v35, v35
v_mfma_f32_16x16x32_bf16 v[84:87], a[76:79], a[148:151], v[84:87]
ds_read_b64_tr_b16 a[30:31], v16 offset:42912
v_exp_f32 v48, v48
v_mfma_f32_16x16x32_bf16 v[36:39], a[80:83], a[164:167], v[36:39]
ds_read_b64_tr_b16 a[32:33], v16 offset:50816
v_exp_f32 v49, v49
v_mfma_f32_16x16x32_bf16 v[52:55], a[84:87], a[164:167], v[52:55]
ds_read_b64_tr_b16 a[34:35], v16 offset:51328
v_exp_f32 v50, v50
v_mfma_f32_16x16x32_bf16 v[68:71], a[88:91], a[164:167], v[68:71]
ds_read_b64_tr_b16 a[36:37], v16 offset:50848
v_exp_f32 v51, v51
v_mfma_f32_16x16x32_bf16 v[84:87], a[92:95], a[164:167], v[84:87]
ds_read_b64_tr_b16 a[38:39], v16 offset:51360
s_waitcnt vmcnt(2)
v_mfma_f32_16x16x32_bf16 v[36:39], a[96:99], a[180:183], v[36:39]
ds_read_b64_tr_b16 a[40:41], v16 offset:59264
v_mfma_f32_16x16x32_bf16 v[52:55], a[100:103], a[180:183], v[52:55]
ds_read_b64_tr_b16 a[42:43], v16 offset:59776
v_mfma_f32_16x16x32_bf16 v[68:71], a[104:107], a[180:183], v[68:71]
ds_read_b64_tr_b16 a[44:45], v16 offset:59296
v_mfma_f32_16x16x32_bf16 v[84:87], a[108:111], a[180:183], v[84:87]
ds_read_b64_tr_b16 a[46:47], v16 offset:59808
s_nop 4
v_pk_mul_f32 v[68:69], v[68:69], v[36:37]
v_pk_mul_f32 v[36:37], v[36:37], v[28:29] op_sel:[0,1] op_sel_hi:[1,1]
v_pk_mul_f32 v[70:71], v[70:71], v[38:39]
v_pk_mul_f32 v[38:39], v[38:39], v[28:29] op_sel:[0,1] op_sel_hi:[1,1]
v_pk_mul_f32 v[84:85], v[84:85], v[52:53]
v_pk_mul_f32 v[52:53], v[52:53], v[28:29] op_sel:[0,1] op_sel_hi:[1,1]
v_pk_mul_f32 v[86:87], v[86:87], v[54:55]
v_pk_mul_f32 v[54:55], v[54:55], v[28:29] op_sel:[0,1] op_sel_hi:[1,1]
v_pk_fma_f32 v[32:33], v[32:33], v[20:21], v[20:21] op_sel:[0,1,1] op_sel_hi:[1,1,1]
v_pk_fma_f32 v[34:35], v[34:35], v[20:21], v[20:21] op_sel:[0,1,1] op_sel_hi:[1,1,1]
v_pk_fma_f32 v[48:49], v[48:49], v[20:21], v[20:21] op_sel:[0,1,1] op_sel_hi:[1,1,1]
v_pk_fma_f32 v[50:51], v[50:51], v[20:21], v[20:21] op_sel:[0,1,1] op_sel_hi:[1,1,1]
v_rcp_f32 v32, v32
s_nop 0
v_mfma_f32_16x16x32_bf16 v[40:43], a[64:67], a[152:155], v[40:43]
ds_read_b64_tr_b16 a[48:49], v17 offset:16896
v_rcp_f32 v33, v33
v_mfma_f32_16x16x32_bf16 v[56:59], a[68:71], a[152:155], v[56:59]
ds_read_b64_tr_b16 a[50:51], v17 offset:17408
v_rcp_f32 v34, v34
v_mfma_f32_16x16x32_bf16 v[72:75], a[72:75], a[152:155], v[72:75]
ds_read_b64_tr_b16 a[52:53], v17 offset:16928
v_rcp_f32 v35, v35
v_mfma_f32_16x16x32_bf16 v[88:91], a[76:79], a[152:155], v[88:91]
ds_read_b64_tr_b16 a[54:55], v17 offset:17440
v_rcp_f32 v48, v48
v_mfma_f32_16x16x32_bf16 v[40:43], a[80:83], a[168:171], v[40:43]
ds_read_b64_tr_b16 a[56:57], v17 offset:25344
v_rcp_f32 v49, v49
v_mfma_f32_16x16x32_bf16 v[56:59], a[84:87], a[168:171], v[56:59]
ds_read_b64_tr_b16 a[58:59], v17 offset:25856
v_rcp_f32 v50, v50
v_mfma_f32_16x16x32_bf16 v[72:75], a[88:91], a[168:171], v[72:75]
ds_read_b64_tr_b16 a[60:61], v17 offset:25376
v_rcp_f32 v51, v51
v_mfma_f32_16x16x32_bf16 v[88:91], a[92:95], a[168:171], v[88:91]
ds_read_b64_tr_b16 a[62:63], v17 offset:25888
v_exp_f32 v36, v36
s_waitcnt vmcnt(1)
v_mfma_f32_16x16x32_bf16 v[40:43], a[96:99], a[184:187], v[40:43]
v_exp_f32 v37, v37
v_mfma_f32_16x16x32_bf16 v[56:59], a[100:103], a[184:187], v[56:59]
v_exp_f32 v38, v38
v_mfma_f32_16x16x32_bf16 v[72:75], a[104:107], a[184:187], v[72:75]
v_exp_f32 v39, v39
v_mfma_f32_16x16x32_bf16 v[88:91], a[108:111], a[184:187], v[88:91]
v_exp_f32 v52, v52
v_exp_f32 v53, v53
v_exp_f32 v54, v54
v_exp_f32 v55, v55
v_pk_mul_f32 v[64:65], v[64:65], v[32:33]
v_pk_mul_f32 v[66:67], v[66:67], v[34:35]
v_pk_mul_f32 v[80:81], v[80:81], v[48:49]
v_pk_mul_f32 v[82:83], v[82:83], v[50:51]
ds_read_b128 v[48:51], v9 offset:128
v_pk_mul_f32 v[72:73], v[72:73], v[40:41]
v_pk_mul_f32 v[40:41], v[40:41], v[30:31] op_sel_hi:[1,0]
v_pk_mul_f32 v[74:75], v[74:75], v[42:43]
v_pk_mul_f32 v[42:43], v[42:43], v[30:31] op_sel_hi:[1,0]
v_pk_mul_f32 v[88:89], v[88:89], v[56:57]
v_pk_mul_f32 v[56:57], v[56:57], v[30:31] op_sel_hi:[1,0]
v_pk_mul_f32 v[90:91], v[90:91], v[58:59]
v_pk_mul_f32 v[58:59], v[58:59], v[30:31] op_sel_hi:[1,0]
v_pk_fma_f32 v[36:37], v[36:37], v[22:23], v[22:23] op_sel:[0,1,1] op_sel_hi:[1,1,1]
v_pk_fma_f32 v[38:39], v[38:39], v[22:23], v[22:23] op_sel:[0,1,1] op_sel_hi:[1,1,1]
v_pk_fma_f32 v[52:53], v[52:53], v[22:23], v[22:23] op_sel:[0,1,1] op_sel_hi:[1,1,1]
v_pk_fma_f32 v[54:55], v[54:55], v[22:23], v[22:23] op_sel:[0,1,1] op_sel_hi:[1,1,1]
v_cvt_pk_bf16_f32 v32, v64, v65
v_cvt_pk_bf16_f32 v33, v66, v67
ds_read_b128 v[64:67], v9 offset:192
v_cvt_pk_bf16_f32 v34, v80, v81
v_cvt_pk_bf16_f32 v35, v82, v83
v_mfma_f32_16x16x32_bf16 v[44:47], a[64:67], a[156:159], v[44:47]
buffer_store_dwordx4 v[32:35], v10, s[16:19], s62 offen sc1
v_mfma_f32_16x16x32_bf16 v[60:63], a[68:71], a[156:159], v[60:63]
ds_read_b128 v[80:83], v9 offset:640
v_rcp_f32 v36, v36
v_mfma_f32_16x16x32_bf16 v[76:79], a[72:75], a[156:159], v[76:79]
ds_read_b64_tr_b16 a[64:65], v17 offset:33792
v_rcp_f32 v37, v37
v_mfma_f32_16x16x32_bf16 v[92:95], a[76:79], a[156:159], v[92:95]
ds_read_b64_tr_b16 a[66:67], v17 offset:34304
v_rcp_f32 v38, v38
v_mfma_f32_16x16x32_bf16 v[44:47], a[80:83], a[172:175], v[44:47]
ds_read_b64_tr_b16 a[68:69], v17 offset:33824
v_rcp_f32 v39, v39
v_mfma_f32_16x16x32_bf16 v[60:63], a[84:87], a[172:175], v[60:63]
ds_read_b64_tr_b16 a[70:71], v17 offset:34336
v_rcp_f32 v52, v52
v_mfma_f32_16x16x32_bf16 v[76:79], a[88:91], a[172:175], v[76:79]
ds_read_b64_tr_b16 a[72:73], v17 offset:42240
v_rcp_f32 v53, v53
v_mfma_f32_16x16x32_bf16 v[92:95], a[92:95], a[172:175], v[92:95]
ds_read_b64_tr_b16 a[74:75], v17 offset:42752
v_rcp_f32 v54, v54
s_waitcnt vmcnt(1)
v_mfma_f32_16x16x32_bf16 v[44:47], a[96:99], a[188:191], v[44:47]
ds_read_b64_tr_b16 a[76:77], v17 offset:42272
v_rcp_f32 v55, v55
v_mfma_f32_16x16x32_bf16 v[60:63], a[100:103], a[188:191], v[60:63]
ds_read_b64_tr_b16 a[78:79], v17 offset:42784
v_exp_f32 v40, v40
v_mfma_f32_16x16x32_bf16 v[76:79], a[104:107], a[188:191], v[76:79]
ds_read_b64_tr_b16 a[80:81], v17 offset:50688
v_exp_f32 v41, v41
v_mfma_f32_16x16x32_bf16 v[92:95], a[108:111], a[188:191], v[92:95]
ds_read_b64_tr_b16 a[82:83], v17 offset:51200
v_exp_f32 v42, v42
v_exp_f32 v43, v43
v_exp_f32 v56, v56
v_exp_f32 v57, v57
v_exp_f32 v58, v58
v_exp_f32 v59, v59
v_pk_mul_f32 v[68:69], v[68:69], v[36:37]
v_pk_mul_f32 v[70:71], v[70:71], v[38:39]
v_pk_mul_f32 v[84:85], v[84:85], v[52:53]
v_pk_mul_f32 v[86:87], v[86:87], v[54:55]
v_pk_mul_f32 v[76:77], v[76:77], v[44:45]
v_pk_mul_f32 v[44:45], v[44:45], v[30:31] op_sel:[0,1] op_sel_hi:[1,1]
v_pk_mul_f32 v[78:79], v[78:79], v[46:47]
v_pk_mul_f32 v[46:47], v[46:47], v[30:31] op_sel:[0,1] op_sel_hi:[1,1]
v_pk_mul_f32 v[92:93], v[92:93], v[60:61]
v_pk_mul_f32 v[60:61], v[60:61], v[30:31] op_sel:[0,1] op_sel_hi:[1,1]
v_pk_mul_f32 v[94:95], v[94:95], v[62:63]
v_pk_mul_f32 v[62:63], v[62:63], v[30:31] op_sel:[0,1] op_sel_hi:[1,1]
v_pk_fma_f32 v[40:41], v[40:41], v[24:25], v[24:25] op_sel:[0,1,1] op_sel_hi:[1,1,1]
v_pk_fma_f32 v[42:43], v[42:43], v[24:25], v[24:25] op_sel:[0,1,1] op_sel_hi:[1,1,1]
v_pk_fma_f32 v[56:57], v[56:57], v[24:25], v[24:25] op_sel:[0,1,1] op_sel_hi:[1,1,1]
v_pk_fma_f32 v[58:59], v[58:59], v[24:25], v[24:25] op_sel:[0,1,1] op_sel_hi:[1,1,1]
v_cvt_pk_bf16_f32 v36, v68, v69
v_cvt_pk_bf16_f32 v37, v70, v71
v_cvt_pk_bf16_f32 v38, v84, v85
v_cvt_pk_bf16_f32 v39, v86, v87
v_mfma_f32_16x16x32_bf16 v[96:99], a[112:115], a[144:147], v[96:99]
buffer_store_dwordx4 v[36:39], v10, s[16:19], s62 offen offset:1024 sc1
v_mfma_f32_16x16x32_bf16 v[112:115], a[116:119], a[144:147], v[112:115]
ds_read_b64_tr_b16 a[84:85], v17 offset:50720
v_rcp_f32 v40, v40
v_mfma_f32_16x16x32_bf16 v[128:131], a[120:123], a[144:147], v[128:131]
ds_read_b64_tr_b16 a[86:87], v17 offset:51232
v_rcp_f32 v41, v41
v_mfma_f32_16x16x32_bf16 v[144:147], a[124:127], a[144:147], v[144:147]
ds_read_b64_tr_b16 a[88:89], v17 offset:59136
v_rcp_f32 v42, v42
v_mfma_f32_16x16x32_bf16 v[96:99], a[192:195], a[160:163], v[96:99]
ds_read_b64_tr_b16 a[90:91], v17 offset:59648
v_rcp_f32 v43, v43
v_mfma_f32_16x16x32_bf16 v[112:115], a[196:199], a[160:163], v[112:115]
ds_read_b64_tr_b16 a[92:93], v17 offset:59168
v_rcp_f32 v56, v56
v_mfma_f32_16x16x32_bf16 v[128:131], a[200:203], a[160:163], v[128:131]
ds_read_b64_tr_b16 a[94:95], v17 offset:59680
v_rcp_f32 v57, v57
v_mfma_f32_16x16x32_bf16 v[144:147], a[204:207], a[160:163], v[144:147]
v_rcp_f32 v58, v58
v_mfma_f32_16x16x32_bf16 v[96:99], a[208:211], a[176:179], v[96:99]
v_rcp_f32 v59, v59
v_mfma_f32_16x16x32_bf16 v[112:115], a[212:215], a[176:179], v[112:115]
v_exp_f32 v44, v44
s_waitcnt lgkmcnt(15)
v_mfma_f32_16x16x32_bf16 v[128:131], a[216:219], a[176:179], v[128:131]
v_exp_f32 v45, v45
v_mfma_f32_16x16x32_bf16 v[144:147], a[220:223], a[176:179], v[144:147]
v_exp_f32 v46, v46
v_exp_f32 v47, v47
v_exp_f32 v60, v60
v_exp_f32 v61, v61
v_exp_f32 v62, v62
s_waitcnt lgkmcnt(0)
s_barrier
v_exp_f32 v63, v63
v_pk_mul_f32 v[72:73], v[72:73], v[40:41]
v_pk_mul_f32 v[74:75], v[74:75], v[42:43]
v_pk_mul_f32 v[88:89], v[88:89], v[56:57]
v_pk_mul_f32 v[90:91], v[90:91], v[58:59]
v_pk_fma_f32 v[96:97], v[48:49], v[20:21], v[96:97] op_sel_hi:[1,0,1]
v_pk_fma_f32 v[98:99], v[50:51], v[20:21], v[98:99] op_sel_hi:[1,0,1]
v_pk_fma_f32 v[112:113], v[64:65], v[20:21], v[112:113] op_sel_hi:[1,0,1]
v_pk_fma_f32 v[114:115], v[66:67], v[20:21], v[114:115] op_sel_hi:[1,0,1]
v_pk_fma_f32 v[128:129], v[80:81], v[20:21], v[128:129] op_sel_hi:[1,0,1]
v_pk_fma_f32 v[130:131], v[82:83], v[20:21], v[130:131] op_sel_hi:[1,0,1]
v_pk_fma_f32 v[144:145], v[4:5], v[20:21], v[144:145] op_sel_hi:[1,0,1]
v_pk_fma_f32 v[146:147], v[6:7], v[20:21], v[146:147] op_sel_hi:[1,0,1]
v_pk_mul_f32 v[128:129], v[128:129], v[96:97]
v_pk_mul_f32 v[96:97], v[96:97], v[28:29] op_sel_hi:[1,0]
v_pk_mul_f32 v[130:131], v[130:131], v[98:99]
v_pk_mul_f32 v[98:99], v[98:99], v[28:29] op_sel_hi:[1,0]
v_pk_mul_f32 v[144:145], v[144:145], v[112:113]
v_pk_mul_f32 v[112:113], v[112:113], v[28:29] op_sel_hi:[1,0]
v_pk_mul_f32 v[146:147], v[146:147], v[114:115]
v_pk_mul_f32 v[114:115], v[114:115], v[28:29] op_sel_hi:[1,0]
v_pk_fma_f32 v[44:45], v[44:45], v[26:27], v[26:27] op_sel:[0,1,1] op_sel_hi:[1,1,1]
v_pk_fma_f32 v[46:47], v[46:47], v[26:27], v[26:27] op_sel:[0,1,1] op_sel_hi:[1,1,1]
v_pk_fma_f32 v[60:61], v[60:61], v[26:27], v[26:27] op_sel:[0,1,1] op_sel_hi:[1,1,1]
v_pk_fma_f32 v[62:63], v[62:63], v[26:27], v[26:27] op_sel:[0,1,1] op_sel_hi:[1,1,1]
v_cvt_pk_bf16_f32 v40, v72, v73
v_cvt_pk_bf16_f32 v41, v74, v75
v_cvt_pk_bf16_f32 v42, v88, v89
v_cvt_pk_bf16_f32 v43, v90, v91
v_mfma_f32_16x16x32_bf16 v[100:103], a[112:115], a[148:151], v[100:103]
buffer_store_dwordx4 v[40:43], v11, s[16:19], s62 offen sc1
v_mfma_f32_16x16x32_bf16 v[116:119], a[116:119], a[148:151], v[116:119]
s_add_u32 m0, s59, 84480
v_rcp_f32 v44, v44
v_mfma_f32_16x16x32_bf16 v[132:135], a[120:123], a[148:151], v[132:135]
v_rcp_f32 v45, v45
v_mfma_f32_16x16x32_bf16 v[148:151], a[124:127], a[148:151], v[148:151]
v_rcp_f32 v46, v46
v_mfma_f32_16x16x32_bf16 v[100:103], a[192:195], a[164:167], v[100:103]
buffer_load_dwordx4 v18, s[28:31], s58 offen lds
v_mfma_f32_16x16x32_bf16 v[116:119], a[196:199], a[164:167], v[116:119]
v_rcp_f32 v47, v47
v_mfma_f32_16x16x32_bf16 v[132:135], a[200:203], a[164:167], v[132:135]
v_rcp_f32 v60, v60
v_mfma_f32_16x16x32_bf16 v[148:151], a[204:207], a[164:167], v[148:151]
v_rcp_f32 v61, v61
v_mfma_f32_16x16x32_bf16 v[100:103], a[208:211], a[180:183], v[100:103]
buffer_load_dwordx4 v19, s[28:31], s58 offen offset:1056 lds
v_mfma_f32_16x16x32_bf16 v[116:119], a[212:215], a[180:183], v[116:119]
s_add_u32 m0, s59, 92928
s_mov_b32 s58, 720896
v_rcp_f32 v62, v62
v_mfma_f32_16x16x32_bf16 v[132:135], a[216:219], a[180:183], v[132:135]
v_rcp_f32 v63, v63
v_mfma_f32_16x16x32_bf16 v[148:151], a[220:223], a[180:183], v[148:151]
v_exp_f32 v96, v96
v_exp_f32 v97, v97
v_exp_f32 v98, v98
v_exp_f32 v99, v99
v_exp_f32 v112, v112
v_exp_f32 v113, v113
v_exp_f32 v114, v114
v_exp_f32 v115, v115
v_pk_mul_f32 v[76:77], v[76:77], v[44:45]
v_pk_mul_f32 v[78:79], v[78:79], v[46:47]
v_pk_mul_f32 v[92:93], v[92:93], v[60:61]
v_pk_mul_f32 v[94:95], v[94:95], v[62:63]
v_pk_fma_f32 v[100:101], v[48:49], v[22:23], v[100:101] op_sel_hi:[1,0,1]
.Lpad22:
s_cbranch_execz .Lnopoll72r
v_pk_fma_f32 v[102:103], v[50:51], v[22:23], v[102:103] op_sel_hi:[1,0,1]
v_pk_fma_f32 v[116:117], v[64:65], v[22:23], v[116:117] op_sel_hi:[1,0,1]
v_pk_fma_f32 v[118:119], v[66:67], v[22:23], v[118:119] op_sel_hi:[1,0,1]
v_pk_fma_f32 v[132:133], v[80:81], v[22:23], v[132:133] op_sel_hi:[1,0,1]
v_pk_fma_f32 v[134:135], v[82:83], v[22:23], v[134:135] op_sel_hi:[1,0,1]
v_pk_fma_f32 v[148:149], v[4:5], v[22:23], v[148:149] op_sel_hi:[1,0,1]
v_pk_fma_f32 v[150:151], v[6:7], v[22:23], v[150:151] op_sel_hi:[1,0,1]
v_pk_mul_f32 v[132:133], v[132:133], v[100:101]
v_pk_mul_f32 v[100:101], v[100:101], v[28:29] op_sel:[0,1] op_sel_hi:[1,1]
v_pk_mul_f32 v[134:135], v[134:135], v[102:103]
v_pk_mul_f32 v[102:103], v[102:103], v[28:29] op_sel:[0,1] op_sel_hi:[1,1]
v_pk_mul_f32 v[148:149], v[148:149], v[116:117]
v_pk_mul_f32 v[116:117], v[116:117], v[28:29] op_sel:[0,1] op_sel_hi:[1,1]
v_pk_mul_f32 v[150:151], v[150:151], v[118:119]
v_pk_mul_f32 v[118:119], v[118:119], v[28:29] op_sel:[0,1] op_sel_hi:[1,1]
v_pk_fma_f32 v[96:97], v[96:97], v[20:21], v[20:21] op_sel:[0,1,1] op_sel_hi:[1,1,1]
v_pk_fma_f32 v[98:99], v[98:99], v[20:21], v[20:21] op_sel:[0,1,1] op_sel_hi:[1,1,1]
v_pk_fma_f32 v[112:113], v[112:113], v[20:21], v[20:21] op_sel:[0,1,1] op_sel_hi:[1,1,1]
v_pk_fma_f32 v[114:115], v[114:115], v[20:21], v[20:21] op_sel:[0,1,1] op_sel_hi:[1,1,1]
v_cvt_pk_bf16_f32 v44, v76, v77
v_cvt_pk_bf16_f32 v45, v78, v79
v_cvt_pk_bf16_f32 v46, v92, v93
v_cvt_pk_bf16_f32 v47, v94, v95
v_mfma_f32_16x16x32_bf16 v[104:107], a[112:115], a[152:155], v[104:107]
buffer_store_dwordx4 v[44:47], v11, s[16:19], s62 offen offset:1024 sc1
v_mfma_f32_16x16x32_bf16 v[120:123], a[116:119], a[152:155], v[120:123]
v_rcp_f32 v96, v96
v_mfma_f32_16x16x32_bf16 v[136:139], a[120:123], a[152:155], v[136:139]
v_rcp_f32 v97, v97
v_mfma_f32_16x16x32_bf16 v[152:155], a[124:127], a[152:155], v[152:155]
v_rcp_f32 v98, v98
v_mfma_f32_16x16x32_bf16 v[104:107], a[192:195], a[168:171], v[104:107]
buffer_load_dwordx4 v18, s[28:31], s58 offen lds
v_mfma_f32_16x16x32_bf16 v[120:123], a[196:199], a[168:171], v[120:123]
v_rcp_f32 v99, v99
v_mfma_f32_16x16x32_bf16 v[136:139], a[200:203], a[168:171], v[136:139]
v_rcp_f32 v112, v112
v_mfma_f32_16x16x32_bf16 v[152:155], a[204:207], a[168:171], v[152:155]
v_rcp_f32 v113, v113
v_mfma_f32_16x16x32_bf16 v[104:107], a[208:211], a[184:187], v[104:107]
buffer_load_dwordx4 v19, s[28:31], s58 offen offset:1056 lds
v_mfma_f32_16x16x32_bf16 v[120:123], a[212:215], a[184:187], v[120:123]
s_add_u32 m0, s59, 101376
s_mov_b32 s58, 786432
v_rcp_f32 v114, v114
v_mfma_f32_16x16x32_bf16 v[136:139], a[216:219], a[184:187], v[136:139]
v_rcp_f32 v115, v115
v_mfma_f32_16x16x32_bf16 v[152:155], a[220:223], a[184:187], v[152:155]
v_exp_f32 v100, v100
v_exp_f32 v101, v101
v_exp_f32 v102, v102
v_exp_f32 v103, v103
v_exp_f32 v116, v116
v_exp_f32 v117, v117
v_exp_f32 v118, v118
v_exp_f32 v119, v119
v_pk_mul_f32 v[128:129], v[128:129], v[96:97]
v_pk_mul_f32 v[130:131], v[130:131], v[98:99]
v_pk_mul_f32 v[144:145], v[144:145], v[112:113]
v_pk_mul_f32 v[146:147], v[146:147], v[114:115]
ds_read_b128 v[112:115], v9 offset:256
v_pk_fma_f32 v[104:105], v[48:49], v[24:25], v[104:105] op_sel_hi:[1,0,1]
v_pk_fma_f32 v[106:107], v[50:51], v[24:25], v[106:107] op_sel_hi:[1,0,1]
v_pk_fma_f32 v[120:121], v[64:65], v[24:25], v[120:121] op_sel_hi:[1,0,1]
v_pk_fma_f32 v[122:123], v[66:67], v[24:25], v[122:123] op_sel_hi:[1,0,1]
v_pk_fma_f32 v[136:137], v[80:81], v[24:25], v[136:137] op_sel_hi:[1,0,1]
v_pk_fma_f32 v[138:139], v[82:83], v[24:25], v[138:139] op_sel_hi:[1,0,1]
v_pk_fma_f32 v[152:153], v[4:5], v[24:25], v[152:153] op_sel_hi:[1,0,1]
v_pk_fma_f32 v[154:155], v[6:7], v[24:25], v[154:155] op_sel_hi:[1,0,1]
v_pk_mul_f32 v[136:137], v[136:137], v[104:105]
v_pk_mul_f32 v[104:105], v[104:105], v[30:31] op_sel_hi:[1,0]
v_pk_mul_f32 v[138:139], v[138:139], v[106:107]
v_pk_mul_f32 v[106:107], v[106:107], v[30:31] op_sel_hi:[1,0]
v_pk_mul_f32 v[152:153], v[152:153], v[120:121]
v_pk_mul_f32 v[120:121], v[120:121], v[30:31] op_sel_hi:[1,0]
v_pk_mul_f32 v[154:155], v[154:155], v[122:123]
v_pk_mul_f32 v[122:123], v[122:123], v[30:31] op_sel_hi:[1,0]
v_pk_fma_f32 v[100:101], v[100:101], v[22:23], v[22:23] op_sel:[0,1,1] op_sel_hi:[1,1,1]
v_pk_fma_f32 v[102:103], v[102:103], v[22:23], v[22:23] op_sel:[0,1,1] op_sel_hi:[1,1,1]
v_pk_fma_f32 v[116:117], v[116:117], v[22:23], v[22:23] op_sel:[0,1,1] op_sel_hi:[1,1,1]
v_pk_fma_f32 v[118:119], v[118:119], v[22:23], v[22:23] op_sel:[0,1,1] op_sel_hi:[1,1,1]
v_cvt_pk_bf16_f32 v96, v128, v129
v_cvt_pk_bf16_f32 v97, v130, v131
ds_read_b128 v[128:131], v9 offset:320
v_cvt_pk_bf16_f32 v98, v144, v145
v_cvt_pk_bf16_f32 v99, v146, v147
v_mfma_f32_16x16x32_bf16 v[108:111], a[112:115], a[156:159], v[108:111]
buffer_store_dwordx4 v[96:99], v10, s[16:19], s63 offen sc1
v_mfma_f32_16x16x32_bf16 v[124:127], a[116:119], a[156:159], v[124:127]
ds_read_b128 v[144:147], v9 offset:768
v_rcp_f32 v100, v100
v_mfma_f32_16x16x32_bf16 v[140:143], a[120:123], a[156:159], v[140:143]
v_rcp_f32 v101, v101
v_mfma_f32_16x16x32_bf16 v[156:159], a[124:127], a[156:159], v[156:159]
v_rcp_f32 v102, v102
v_mfma_f32_16x16x32_bf16 v[108:111], a[192:195], a[172:175], v[108:111]
buffer_load_dwordx4 v18, s[28:31], s58 offen lds
v_mfma_f32_16x16x32_bf16 v[124:127], a[196:199], a[172:175], v[124:127]
v_rcp_f32 v103, v103
v_mfma_f32_16x16x32_bf16 v[140:143], a[200:203], a[172:175], v[140:143]
v_rcp_f32 v116, v116
v_mfma_f32_16x16x32_bf16 v[156:159], a[204:207], a[172:175], v[156:159]
v_rcp_f32 v117, v117
v_mfma_f32_16x16x32_bf16 v[108:111], a[208:211], a[188:191], v[108:111]
buffer_load_dwordx4 v19, s[28:31], s58 offen offset:1056 lds
v_mfma_f32_16x16x32_bf16 v[124:127], a[212:215], a[188:191], v[124:127]
s_add_u32 m0, s59, 109824
s_mov_b32 s58, 851968
v_rcp_f32 v118, v118
v_mfma_f32_16x16x32_bf16 v[140:143], a[216:219], a[188:191], v[140:143]
v_rcp_f32 v119, v119
v_mfma_f32_16x16x32_bf16 v[156:159], a[220:223], a[188:191], v[156:159]
v_exp_f32 v104, v104
v_exp_f32 v105, v105
v_exp_f32 v106, v106
v_exp_f32 v107, v107
v_exp_f32 v120, v120
v_exp_f32 v121, v121
v_exp_f32 v122, v122
v_exp_f32 v123, v123
v_pk_mul_f32 v[132:133], v[132:133], v[100:101]
v_pk_mul_f32 v[134:135], v[134:135], v[102:103]
v_pk_mul_f32 v[148:149], v[148:149], v[116:117]
v_pk_mul_f32 v[150:151], v[150:151], v[118:119]
v_pk_fma_f32 v[108:109], v[48:49], v[26:27], v[108:109] op_sel_hi:[1,0,1]
v_pk_fma_f32 v[110:111], v[50:51], v[26:27], v[110:111] op_sel_hi:[1,0,1]
v_pk_fma_f32 v[124:125], v[64:65], v[26:27], v[124:125] op_sel_hi:[1,0,1]
v_pk_fma_f32 v[126:127], v[66:67], v[26:27], v[126:127] op_sel_hi:[1,0,1]
v_pk_fma_f32 v[140:141], v[80:81], v[26:27], v[140:141] op_sel_hi:[1,0,1]
v_pk_fma_f32 v[142:143], v[82:83], v[26:27], v[142:143] op_sel_hi:[1,0,1]
v_pk_fma_f32 v[156:157], v[4:5], v[26:27], v[156:157] op_sel_hi:[1,0,1]
v_pk_fma_f32 v[158:159], v[6:7], v[26:27], v[158:159] op_sel_hi:[1,0,1]
ds_read_b128 v[4:7], v8 offset:576
v_pk_mul_f32 v[140:141], v[140:141], v[108:109]
v_pk_mul_f32 v[108:109], v[108:109], v[30:31] op_sel:[0,1] op_sel_hi:[1,1]
v_pk_mul_f32 v[142:143], v[142:143], v[110:111]
v_pk_mul_f32 v[110:111], v[110:111], v[30:31] op_sel:[0,1] op_sel_hi:[1,1]
v_pk_mul_f32 v[156:157], v[156:157], v[124:125]
v_pk_mul_f32 v[124:125], v[124:125], v[30:31] op_sel:[0,1] op_sel_hi:[1,1]
v_pk_mul_f32 v[158:159], v[158:159], v[126:127]
v_pk_mul_f32 v[126:127], v[126:127], v[30:31] op_sel:[0,1] op_sel_hi:[1,1]
v_pk_fma_f32 v[104:105], v[104:105], v[24:25], v[24:25] op_sel:[0,1,1] op_sel_hi:[1,1,1]
v_pk_fma_f32 v[106:107], v[106:107], v[24:25], v[24:25] op_sel:[0,1,1] op_sel_hi:[1,1,1]
v_pk_fma_f32 v[120:121], v[120:121], v[24:25], v[24:25] op_sel:[0,1,1] op_sel_hi:[1,1,1]
v_pk_fma_f32 v[122:123], v[122:123], v[24:25], v[24:25] op_sel:[0,1,1] op_sel_hi:[1,1,1]
v_cvt_pk_bf16_f32 v100, v132, v133
v_cvt_pk_bf16_f32 v101, v134, v135
v_cvt_pk_bf16_f32 v102, v148, v149
v_cvt_pk_bf16_f32 v103, v150, v151
v_mfma_f32_16x16x32_bf16 v[160:163], a[0:3], a[144:147], v[160:163]
buffer_store_dwordx4 v[100:103], v10, s[16:19], s63 offen offset:1024 sc1
v_mfma_f32_16x16x32_bf16 v[176:179], a[4:7], a[144:147], v[176:179]
v_rcp_f32 v104, v104
v_mfma_f32_16x16x32_bf16 v[192:195], a[8:11], a[144:147], v[192:195]
v_rcp_f32 v105, v105
v_mfma_f32_16x16x32_bf16 v[208:211], a[12:15], a[144:147], v[208:211]
v_rcp_f32 v106, v106
v_mfma_f32_16x16x32_bf16 v[160:163], a[16:19], a[160:163], v[160:163]
buffer_load_dwordx4 v18, s[28:31], s58 offen lds
v_mfma_f32_16x16x32_bf16 v[176:179], a[20:23], a[160:163], v[176:179]
v_rcp_f32 v107, v107
v_mfma_f32_16x16x32_bf16 v[192:195], a[24:27], a[160:163], v[192:195]
v_rcp_f32 v120, v120
v_mfma_f32_16x16x32_bf16 v[208:211], a[28:31], a[160:163], v[208:211]
v_rcp_f32 v121, v121
v_mfma_f32_16x16x32_bf16 v[160:163], a[32:35], a[176:179], v[160:163]
buffer_load_dwordx4 v19, s[28:31], s58 offen offset:1056 lds
v_mfma_f32_16x16x32_bf16 v[176:179], a[36:39], a[176:179], v[176:179]
v_rcp_f32 v122, v122
v_mfma_f32_16x16x32_bf16 v[192:195], a[40:43], a[176:179], v[192:195]
v_rcp_f32 v123, v123
v_mfma_f32_16x16x32_bf16 v[208:211], a[44:47], a[176:179], v[208:211]
v_exp_f32 v108, v108
v_exp_f32 v109, v109
v_exp_f32 v110, v110
v_exp_f32 v111, v111
v_exp_f32 v124, v124
v_exp_f32 v125, v125
v_exp_f32 v126, v126
v_exp_f32 v127, v127
v_pk_mul_f32 v[136:137], v[136:137], v[104:105]
v_pk_mul_f32 v[138:139], v[138:139], v[106:107]
v_pk_mul_f32 v[152:153], v[152:153], v[120:121]
v_pk_mul_f32 v[154:155], v[154:155], v[122:123]
s_waitcnt lgkmcnt(3)
v_pk_fma_f32 v[160:161], v[112:113], v[20:21], v[160:161] op_sel_hi:[1,0,1]
v_pk_fma_f32 v[162:163], v[114:115], v[20:21], v[162:163] op_sel_hi:[1,0,1]
s_waitcnt lgkmcnt(2)
v_pk_fma_f32 v[176:177], v[128:129], v[20:21], v[176:177] op_sel_hi:[1,0,1]
v_pk_fma_f32 v[178:179], v[130:131], v[20:21], v[178:179] op_sel_hi:[1,0,1]
s_waitcnt lgkmcnt(1)
v_pk_fma_f32 v[192:193], v[144:145], v[20:21], v[192:193] op_sel_hi:[1,0,1]
v_pk_fma_f32 v[194:195], v[146:147], v[20:21], v[194:195] op_sel_hi:[1,0,1]
v_pk_fma_f32 v[208:209], v[12:13], v[20:21], v[208:209] op_sel_hi:[1,0,1]
v_pk_fma_f32 v[210:211], v[14:15], v[20:21], v[210:211] op_sel_hi:[1,0,1]
v_pk_mul_f32 v[192:193], v[192:193], v[160:161]
v_pk_mul_f32 v[160:161], v[160:161], v[28:29] op_sel_hi:[1,0]
v_pk_mul_f32 v[194:195], v[194:195], v[162:163]
v_pk_mul_f32 v[162:163], v[162:163], v[28:29] op_sel_hi:[1,0]
v_pk_mul_f32 v[208:209], v[208:209], v[176:177]
v_pk_mul_f32 v[176:177], v[176:177], v[28:29] op_sel_hi:[1,0]
v_pk_mul_f32 v[210:211], v[210:211], v[178:179]
v_pk_mul_f32 v[178:179], v[178:179], v[28:29] op_sel_hi:[1,0]
v_pk_fma_f32 v[108:109], v[108:109], v[26:27], v[26:27] op_sel:[0,1,1] op_sel_hi:[1,1,1]
v_pk_fma_f32 v[110:111], v[110:111], v[26:27], v[26:27] op_sel:[0,1,1] op_sel_hi:[1,1,1]
v_pk_fma_f32 v[124:125], v[124:125], v[26:27], v[26:27] op_sel:[0,1,1] op_sel_hi:[1,1,1]
v_pk_fma_f32 v[126:127], v[126:127], v[26:27], v[26:27] op_sel:[0,1,1] op_sel_hi:[1,1,1]
v_cvt_pk_bf16_f32 v104, v136, v137
v_cvt_pk_bf16_f32 v105, v138, v139
v_cvt_pk_bf16_f32 v106, v152, v153
v_cvt_pk_bf16_f32 v107, v154, v155
v_mfma_f32_16x16x32_bf16 v[164:167], a[0:3], a[148:151], v[164:167]
buffer_store_dwordx4 v[104:107], v11, s[16:19], s63 offen sc1
v_mfma_f32_16x16x32_bf16 v[180:183], a[4:7], a[148:151], v[180:183]
v_rcp_f32 v108, v108
v_mfma_f32_16x16x32_bf16 v[196:199], a[8:11], a[148:151], v[196:199]
v_rcp_f32 v109, v109
v_mfma_f32_16x16x32_bf16 v[212:215], a[12:15], a[148:151], v[212:215]
v_rcp_f32 v110, v110
v_mfma_f32_16x16x32_bf16 v[164:167], a[16:19], a[164:167], v[164:167]
v_rcp_f32 v111, v111
v_mfma_f32_16x16x32_bf16 v[180:183], a[20:23], a[164:167], v[180:183]
v_rcp_f32 v124, v124
v_mfma_f32_16x16x32_bf16 v[196:199], a[24:27], a[164:167], v[196:199]
v_rcp_f32 v125, v125
v_mfma_f32_16x16x32_bf16 v[212:215], a[28:31], a[164:167], v[212:215]
v_rcp_f32 v126, v126
v_mfma_f32_16x16x32_bf16 v[164:167], a[32:35], a[180:183], v[164:167]
v_rcp_f32 v127, v127
v_mfma_f32_16x16x32_bf16 v[180:183], a[36:39], a[180:183], v[180:183]
v_exp_f32 v160, v160
v_mfma_f32_16x16x32_bf16 v[196:199], a[40:43], a[180:183], v[196:199]
v_exp_f32 v161, v161
v_mfma_f32_16x16x32_bf16 v[212:215], a[44:47], a[180:183], v[212:215]
v_exp_f32 v162, v162
v_exp_f32 v163, v163
v_exp_f32 v176, v176
v_exp_f32 v177, v177
v_exp_f32 v178, v178
v_exp_f32 v179, v179
v_pk_mul_f32 v[140:141], v[140:141], v[108:109]
v_pk_mul_f32 v[142:143], v[142:143], v[110:111]
v_pk_mul_f32 v[156:157], v[156:157], v[124:125]
v_pk_mul_f32 v[158:159], v[158:159], v[126:127]
v_pk_fma_f32 v[164:165], v[112:113], v[22:23], v[164:165] op_sel_hi:[1,0,1]
v_pk_fma_f32 v[166:167], v[114:115], v[22:23], v[166:167] op_sel_hi:[1,0,1]
v_pk_fma_f32 v[180:181], v[128:129], v[22:23], v[180:181] op_sel_hi:[1,0,1]
v_pk_fma_f32 v[182:183], v[130:131], v[22:23], v[182:183] op_sel_hi:[1,0,1]
v_pk_fma_f32 v[196:197], v[144:145], v[22:23], v[196:197] op_sel_hi:[1,0,1]
v_pk_fma_f32 v[198:199], v[146:147], v[22:23], v[198:199] op_sel_hi:[1,0,1]
v_pk_fma_f32 v[212:213], v[12:13], v[22:23], v[212:213] op_sel_hi:[1,0,1]
v_pk_fma_f32 v[214:215], v[14:15], v[22:23], v[214:215] op_sel_hi:[1,0,1]
v_pk_mul_f32 v[196:197], v[196:197], v[164:165]
v_pk_mul_f32 v[164:165], v[164:165], v[28:29] op_sel:[0,1] op_sel_hi:[1,1]
v_pk_mul_f32 v[198:199], v[198:199], v[166:167]
v_pk_mul_f32 v[166:167], v[166:167], v[28:29] op_sel:[0,1] op_sel_hi:[1,1]
v_pk_mul_f32 v[212:213], v[212:213], v[180:181]
v_pk_mul_f32 v[180:181], v[180:181], v[28:29] op_sel:[0,1] op_sel_hi:[1,1]
v_pk_mul_f32 v[214:215], v[214:215], v[182:183]
v_pk_mul_f32 v[182:183], v[182:183], v[28:29] op_sel:[0,1] op_sel_hi:[1,1]
v_pk_fma_f32 v[160:161], v[160:161], v[20:21], v[20:21] op_sel:[0,1,1] op_sel_hi:[1,1,1]
v_pk_fma_f32 v[162:163], v[162:163], v[20:21], v[20:21] op_sel:[0,1,1] op_sel_hi:[1,1,1]
v_pk_fma_f32 v[176:177], v[176:177], v[20:21], v[20:21] op_sel:[0,1,1] op_sel_hi:[1,1,1]
v_pk_fma_f32 v[178:179], v[178:179], v[20:21], v[20:21] op_sel:[0,1,1] op_sel_hi:[1,1,1]
v_cvt_pk_bf16_f32 v108, v140, v141
v_cvt_pk_bf16_f32 v109, v142, v143
v_cvt_pk_bf16_f32 v110, v156, v157
v_cvt_pk_bf16_f32 v111, v158, v159
v_mfma_f32_16x16x32_bf16 v[168:171], a[0:3], a[152:155], v[168:171]
buffer_store_dwordx4 v[108:111], v11, s[16:19], s63 offen offset:1024 sc1
v_mfma_f32_16x16x32_bf16 v[184:187], a[4:7], a[152:155], v[184:187]
v_rcp_f32 v160, v160
v_mfma_f32_16x16x32_bf16 v[200:203], a[8:11], a[152:155], v[200:203]
v_rcp_f32 v161, v161
v_mfma_f32_16x16x32_bf16 v[216:219], a[12:15], a[152:155], v[216:219]
v_rcp_f32 v162, v162
v_mfma_f32_16x16x32_bf16 v[168:171], a[16:19], a[168:171], v[168:171]
v_rcp_f32 v163, v163
v_mfma_f32_16x16x32_bf16 v[184:187], a[20:23], a[168:171], v[184:187]
v_rcp_f32 v176, v176
v_mfma_f32_16x16x32_bf16 v[200:203], a[24:27], a[168:171], v[200:203]
v_rcp_f32 v177, v177
v_mfma_f32_16x16x32_bf16 v[216:219], a[28:31], a[168:171], v[216:219]
v_rcp_f32 v178, v178
v_mfma_f32_16x16x32_bf16 v[168:171], a[32:35], a[184:187], v[168:171]
v_rcp_f32 v179, v179
v_mfma_f32_16x16x32_bf16 v[184:187], a[36:39], a[184:187], v[184:187]
v_exp_f32 v164, v164
v_mfma_f32_16x16x32_bf16 v[200:203], a[40:43], a[184:187], v[200:203]
v_exp_f32 v165, v165
v_mfma_f32_16x16x32_bf16 v[216:219], a[44:47], a[184:187], v[216:219]
v_exp_f32 v166, v166
v_exp_f32 v167, v167
v_exp_f32 v180, v180
v_exp_f32 v181, v181
v_exp_f32 v182, v182
v_exp_f32 v183, v183
v_pk_mul_f32 v[192:193], v[192:193], v[160:161]
v_pk_mul_f32 v[194:195], v[194:195], v[162:163]
v_pk_mul_f32 v[208:209], v[208:209], v[176:177]
v_pk_mul_f32 v[210:211], v[210:211], v[178:179]
ds_read_b128 v[176:179], v8
v_pk_fma_f32 v[168:169], v[112:113], v[24:25], v[168:169] op_sel_hi:[1,0,1]
v_pk_fma_f32 v[170:171], v[114:115], v[24:25], v[170:171] op_sel_hi:[1,0,1]
v_pk_fma_f32 v[184:185], v[128:129], v[24:25], v[184:185] op_sel_hi:[1,0,1]
v_pk_fma_f32 v[186:187], v[130:131], v[24:25], v[186:187] op_sel_hi:[1,0,1]
v_pk_fma_f32 v[200:201], v[144:145], v[24:25], v[200:201] op_sel_hi:[1,0,1]
v_pk_fma_f32 v[202:203], v[146:147], v[24:25], v[202:203] op_sel_hi:[1,0,1]
v_pk_fma_f32 v[216:217], v[12:13], v[24:25], v[216:217] op_sel_hi:[1,0,1]
v_pk_fma_f32 v[218:219], v[14:15], v[24:25], v[218:219] op_sel_hi:[1,0,1]
v_pk_mul_f32 v[200:201], v[200:201], v[168:169]
v_pk_mul_f32 v[168:169], v[168:169], v[30:31] op_sel_hi:[1,0]
v_pk_mul_f32 v[202:203], v[202:203], v[170:171]
v_pk_mul_f32 v[170:171], v[170:171], v[30:31] op_sel_hi:[1,0]
v_pk_mul_f32 v[216:217], v[216:217], v[184:185]
v_pk_mul_f32 v[184:185], v[184:185], v[30:31] op_sel_hi:[1,0]
v_pk_mul_f32 v[218:219], v[218:219], v[186:187]
v_pk_mul_f32 v[186:187], v[186:187], v[30:31] op_sel_hi:[1,0]
v_pk_fma_f32 v[164:165], v[164:165], v[22:23], v[22:23] op_sel:[0,1,1] op_sel_hi:[1,1,1]
v_pk_fma_f32 v[166:167], v[166:167], v[22:23], v[22:23] op_sel:[0,1,1] op_sel_hi:[1,1,1]
v_pk_fma_f32 v[180:181], v[180:181], v[22:23], v[22:23] op_sel:[0,1,1] op_sel_hi:[1,1,1]
v_pk_fma_f32 v[182:183], v[182:183], v[22:23], v[22:23] op_sel:[0,1,1] op_sel_hi:[1,1,1]
v_cvt_pk_bf16_f32 v160, v192, v193
v_cvt_pk_bf16_f32 v161, v194, v195
ds_read_b128 v[192:195], v8 offset:64
v_cvt_pk_bf16_f32 v162, v208, v209
v_cvt_pk_bf16_f32 v163, v210, v211
v_mfma_f32_16x16x32_bf16 v[172:175], a[0:3], a[156:159], v[172:175]
buffer_store_dwordx4 v[160:163], v10, s[16:19], s64 offen sc1
v_mfma_f32_16x16x32_bf16 v[188:191], a[4:7], a[156:159], v[188:191]
ds_read_b128 v[208:211], v8 offset:512
v_rcp_f32 v164, v164
v_mfma_f32_16x16x32_bf16 v[204:207], a[8:11], a[156:159], v[204:207]
v_rcp_f32 v165, v165
v_mfma_f32_16x16x32_bf16 v[220:223], a[12:15], a[156:159], v[220:223]
v_rcp_f32 v166, v166
v_mfma_f32_16x16x32_bf16 v[172:175], a[16:19], a[172:175], v[172:175]
v_rcp_f32 v167, v167
v_mfma_f32_16x16x32_bf16 v[188:191], a[20:23], a[172:175], v[188:191]
v_rcp_f32 v180, v180
v_mfma_f32_16x16x32_bf16 v[204:207], a[24:27], a[172:175], v[204:207]
v_rcp_f32 v181, v181
v_mfma_f32_16x16x32_bf16 v[220:223], a[28:31], a[172:175], v[220:223]
v_rcp_f32 v182, v182
v_mfma_f32_16x16x32_bf16 v[172:175], a[32:35], a[188:191], v[172:175]
v_rcp_f32 v183, v183
v_mfma_f32_16x16x32_bf16 v[188:191], a[36:39], a[188:191], v[188:191]
v_exp_f32 v168, v168
v_mfma_f32_16x16x32_bf16 v[204:207], a[40:43], a[188:191], v[204:207]
v_exp_f32 v169, v169
v_mfma_f32_16x16x32_bf16 v[220:223], a[44:47], a[188:191], v[220:223]
v_exp_f32 v170, v170
v_exp_f32 v171, v171
v_exp_f32 v184, v184
v_exp_f32 v185, v185
v_exp_f32 v186, v186
v_exp_f32 v187, v187
v_pk_mul_f32 v[196:197], v[196:197], v[164:165]
v_pk_mul_f32 v[198:199], v[198:199], v[166:167]
v_pk_mul_f32 v[212:213], v[212:213], v[180:181]
v_pk_mul_f32 v[214:215], v[214:215], v[182:183]
v_pk_fma_f32 v[172:173], v[112:113], v[26:27], v[172:173] op_sel_hi:[1,0,1]
v_pk_fma_f32 v[174:175], v[114:115], v[26:27], v[174:175] op_sel_hi:[1,0,1]
v_pk_fma_f32 v[188:189], v[128:129], v[26:27], v[188:189] op_sel_hi:[1,0,1]
v_pk_fma_f32 v[190:191], v[130:131], v[26:27], v[190:191] op_sel_hi:[1,0,1]
v_pk_fma_f32 v[204:205], v[144:145], v[26:27], v[204:205] op_sel_hi:[1,0,1]
v_pk_fma_f32 v[206:207], v[146:147], v[26:27], v[206:207] op_sel_hi:[1,0,1]
v_pk_fma_f32 v[220:221], v[12:13], v[26:27], v[220:221] op_sel_hi:[1,0,1]
v_pk_fma_f32 v[222:223], v[14:15], v[26:27], v[222:223] op_sel_hi:[1,0,1]
v_pk_mul_f32 v[204:205], v[204:205], v[172:173]
v_pk_mul_f32 v[172:173], v[172:173], v[30:31] op_sel:[0,1] op_sel_hi:[1,1]
v_pk_mul_f32 v[206:207], v[206:207], v[174:175]
v_pk_mul_f32 v[174:175], v[174:175], v[30:31] op_sel:[0,1] op_sel_hi:[1,1]
v_pk_mul_f32 v[220:221], v[220:221], v[188:189]
v_pk_mul_f32 v[188:189], v[188:189], v[30:31] op_sel:[0,1] op_sel_hi:[1,1]
v_pk_mul_f32 v[222:223], v[222:223], v[190:191]
v_pk_mul_f32 v[190:191], v[190:191], v[30:31] op_sel:[0,1] op_sel_hi:[1,1]
v_pk_fma_f32 v[168:169], v[168:169], v[24:25], v[24:25] op_sel:[0,1,1] op_sel_hi:[1,1,1]
v_pk_fma_f32 v[170:171], v[170:171], v[24:25], v[24:25] op_sel:[0,1,1] op_sel_hi:[1,1,1]
v_pk_fma_f32 v[184:185], v[184:185], v[24:25], v[24:25] op_sel:[0,1,1] op_sel_hi:[1,1,1]
v_pk_fma_f32 v[186:187], v[186:187], v[24:25], v[24:25] op_sel:[0,1,1] op_sel_hi:[1,1,1]
v_cvt_pk_bf16_f32 v164, v196, v197
v_cvt_pk_bf16_f32 v165, v198, v199
v_cvt_pk_bf16_f32 v166, v212, v213
v_cvt_pk_bf16_f32 v167, v214, v215
v_mfma_f32_16x16x32_bf16 v[224:227], a[48:51], a[144:147], v[224:227]
buffer_store_dwordx4 v[164:167], v10, s[16:19], s64 offen offset:1024 sc1
v_mfma_f32_16x16x32_bf16 v[232:235], a[52:55], a[144:147], v[232:235]
v_rcp_f32 v168, v168
v_mfma_f32_16x16x32_bf16 v[240:243], a[56:59], a[144:147], v[240:243]
v_rcp_f32 v169, v169
v_mfma_f32_16x16x32_bf16 v[248:251], a[60:63], a[144:147], v[248:251]
v_rcp_f32 v170, v170
v_mfma_f32_16x16x32_bf16 v[224:227], a[64:67], a[160:163], v[224:227]
v_rcp_f32 v171, v171
v_mfma_f32_16x16x32_bf16 v[232:235], a[68:71], a[160:163], v[232:235]
v_rcp_f32 v184, v184
v_mfma_f32_16x16x32_bf16 v[240:243], a[72:75], a[160:163], v[240:243]
v_rcp_f32 v185, v185
v_mfma_f32_16x16x32_bf16 v[248:251], a[76:79], a[160:163], v[248:251]
v_rcp_f32 v186, v186
v_mfma_f32_16x16x32_bf16 v[224:227], a[80:83], a[176:179], v[224:227]
v_rcp_f32 v187, v187
v_mfma_f32_16x16x32_bf16 v[232:235], a[84:87], a[176:179], v[232:235]
v_exp_f32 v172, v172
v_mfma_f32_16x16x32_bf16 v[240:243], a[88:91], a[176:179], v[240:243]
v_exp_f32 v173, v173
v_mfma_f32_16x16x32_bf16 v[248:251], a[92:95], a[176:179], v[248:251]
v_exp_f32 v174, v174
v_exp_f32 v175, v175
v_exp_f32 v188, v188
v_exp_f32 v189, v189
v_exp_f32 v190, v190
v_exp_f32 v191, v191
v_pk_mul_f32 v[200:201], v[200:201], v[168:169]
v_pk_mul_f32 v[202:203], v[202:203], v[170:171]
v_pk_mul_f32 v[216:217], v[216:217], v[184:185]
v_pk_mul_f32 v[218:219], v[218:219], v[186:187]
s_waitcnt lgkmcnt(2)
v_pk_fma_f32 v[224:225], v[176:177], v[20:21], v[224:225] op_sel_hi:[1,0,1]
v_pk_fma_f32 v[226:227], v[178:179], v[20:21], v[226:227] op_sel_hi:[1,0,1]
s_waitcnt lgkmcnt(1)
v_pk_fma_f32 v[232:233], v[192:193], v[20:21], v[232:233] op_sel_hi:[1,0,1]
v_pk_fma_f32 v[234:235], v[194:195], v[20:21], v[234:235] op_sel_hi:[1,0,1]
s_waitcnt lgkmcnt(0)
v_pk_fma_f32 v[240:241], v[208:209], v[20:21], v[240:241] op_sel_hi:[1,0,1]
v_pk_fma_f32 v[242:243], v[210:211], v[20:21], v[242:243] op_sel_hi:[1,0,1]
v_pk_fma_f32 v[248:249], v[4:5], v[20:21], v[248:249] op_sel_hi:[1,0,1]
v_pk_fma_f32 v[250:251], v[6:7], v[20:21], v[250:251] op_sel_hi:[1,0,1]
v_pk_mul_f32 v[240:241], v[240:241], v[224:225]
v_pk_mul_f32 v[224:225], v[224:225], v[28:29] op_sel_hi:[1,0]
v_pk_mul_f32 v[242:243], v[242:243], v[226:227]
v_pk_mul_f32 v[226:227], v[226:227], v[28:29] op_sel_hi:[1,0]
v_pk_mul_f32 v[248:249], v[248:249], v[232:233]
v_pk_mul_f32 v[232:233], v[232:233], v[28:29] op_sel_hi:[1,0]
v_pk_mul_f32 v[250:251], v[250:251], v[234:235]
v_pk_mul_f32 v[234:235], v[234:235], v[28:29] op_sel_hi:[1,0]
v_pk_fma_f32 v[172:173], v[172:173], v[26:27], v[26:27] op_sel:[0,1,1] op_sel_hi:[1,1,1]
v_pk_fma_f32 v[174:175], v[174:175], v[26:27], v[26:27] op_sel:[0,1,1] op_sel_hi:[1,1,1]
v_pk_fma_f32 v[188:189], v[188:189], v[26:27], v[26:27] op_sel:[0,1,1] op_sel_hi:[1,1,1]
v_pk_fma_f32 v[190:191], v[190:191], v[26:27], v[26:27] op_sel:[0,1,1] op_sel_hi:[1,1,1]
v_cvt_pk_bf16_f32 v168, v200, v201
v_cvt_pk_bf16_f32 v169, v202, v203
v_cvt_pk_bf16_f32 v170, v216, v217
v_cvt_pk_bf16_f32 v171, v218, v219
v_mfma_f32_16x16x32_bf16 v[228:231], a[48:51], a[148:151], v[228:231]
buffer_store_dwordx4 v[168:171], v11, s[16:19], s64 offen sc1
v_mfma_f32_16x16x32_bf16 v[236:239], a[52:55], a[148:151], v[236:239]
v_rcp_f32 v172, v172
v_mfma_f32_16x16x32_bf16 v[244:247], a[56:59], a[148:151], v[244:247]
v_rcp_f32 v173, v173
v_mfma_f32_16x16x32_bf16 v[252:255], a[60:63], a[148:151], v[252:255]
v_rcp_f32 v174, v174
v_mfma_f32_16x16x32_bf16 v[228:231], a[64:67], a[164:167], v[228:231]
v_rcp_f32 v175, v175
v_mfma_f32_16x16x32_bf16 v[236:239], a[68:71], a[164:167], v[236:239]
v_rcp_f32 v188, v188
v_mfma_f32_16x16x32_bf16 v[244:247], a[72:75], a[164:167], v[244:247]
v_rcp_f32 v189, v189
v_mfma_f32_16x16x32_bf16 v[252:255], a[76:79], a[164:167], v[252:255]
v_rcp_f32 v190, v190
v_mfma_f32_16x16x32_bf16 v[228:231], a[80:83], a[180:183], v[228:231]
v_rcp_f32 v191, v191
v_mfma_f32_16x16x32_bf16 v[236:239], a[84:87], a[180:183], v[236:239]
v_exp_f32 v224, v224
v_mfma_f32_16x16x32_bf16 v[244:247], a[88:91], a[180:183], v[244:247]
v_exp_f32 v225, v225
v_mfma_f32_16x16x32_bf16 v[252:255], a[92:95], a[180:183], v[252:255]
v_exp_f32 v226, v226
v_exp_f32 v227, v227
v_exp_f32 v232, v232
v_exp_f32 v233, v233
v_exp_f32 v234, v234
v_exp_f32 v235, v235
v_pk_mul_f32 v[204:205], v[204:205], v[172:173]
v_pk_mul_f32 v[206:207], v[206:207], v[174:175]
v_pk_mul_f32 v[220:221], v[220:221], v[188:189]
v_pk_mul_f32 v[222:223], v[222:223], v[190:191]
v_pk_fma_f32 v[228:229], v[176:177], v[22:23], v[228:229] op_sel_hi:[1,0,1]
v_pk_fma_f32 v[230:231], v[178:179], v[22:23], v[230:231] op_sel_hi:[1,0,1]
v_pk_fma_f32 v[236:237], v[192:193], v[22:23], v[236:237] op_sel_hi:[1,0,1]
v_pk_fma_f32 v[238:239], v[194:195], v[22:23], v[238:239] op_sel_hi:[1,0,1]
v_pk_fma_f32 v[244:245], v[208:209], v[22:23], v[244:245] op_sel_hi:[1,0,1]
v_pk_fma_f32 v[246:247], v[210:211], v[22:23], v[246:247] op_sel_hi:[1,0,1]
v_pk_fma_f32 v[252:253], v[4:5], v[22:23], v[252:253] op_sel_hi:[1,0,1]
v_pk_fma_f32 v[254:255], v[6:7], v[22:23], v[254:255] op_sel_hi:[1,0,1]
v_pk_mul_f32 v[244:245], v[244:245], v[228:229]
v_pk_mul_f32 v[228:229], v[228:229], v[28:29] op_sel:[0,1] op_sel_hi:[1,1]
v_pk_mul_f32 v[246:247], v[246:247], v[230:231]
v_pk_mul_f32 v[230:231], v[230:231], v[28:29] op_sel:[0,1] op_sel_hi:[1,1]
v_pk_mul_f32 v[252:253], v[252:253], v[236:237]
v_pk_mul_f32 v[236:237], v[236:237], v[28:29] op_sel:[0,1] op_sel_hi:[1,1]
v_pk_mul_f32 v[254:255], v[254:255], v[238:239]
v_pk_mul_f32 v[238:239], v[238:239], v[28:29] op_sel:[0,1] op_sel_hi:[1,1]
v_pk_fma_f32 v[224:225], v[224:225], v[20:21], v[20:21] op_sel:[0,1,1] op_sel_hi:[1,1,1]
v_pk_fma_f32 v[226:227], v[226:227], v[20:21], v[20:21] op_sel:[0,1,1] op_sel_hi:[1,1,1]
v_pk_fma_f32 v[232:233], v[232:233], v[20:21], v[20:21] op_sel:[0,1,1] op_sel_hi:[1,1,1]
v_pk_fma_f32 v[234:235], v[234:235], v[20:21], v[20:21] op_sel:[0,1,1] op_sel_hi:[1,1,1]
v_cvt_pk_bf16_f32 v172, v204, v205
v_cvt_pk_bf16_f32 v173, v206, v207
v_cvt_pk_bf16_f32 v174, v220, v221
v_cvt_pk_bf16_f32 v175, v222, v223
buffer_store_dwordx4 v[172:175], v11, s[16:19], s64 offen offset:1024 sc1
v_rcp_f32 v224, v224
v_rcp_f32 v225, v225
v_rcp_f32 v226, v226
v_rcp_f32 v227, v227
v_rcp_f32 v232, v232
v_rcp_f32 v233, v233
v_rcp_f32 v234, v234
v_rcp_f32 v235, v235
v_exp_f32 v228, v228
v_exp_f32 v229, v229
v_exp_f32 v230, v230
v_exp_f32 v231, v231
v_exp_f32 v236, v236
v_exp_f32 v237, v237
v_exp_f32 v238, v238
v_exp_f32 v239, v239
v_pk_mul_f32 v[240:241], v[240:241], v[224:225]
v_pk_mul_f32 v[242:243], v[242:243], v[226:227]
v_pk_mul_f32 v[248:249], v[248:249], v[232:233]
v_pk_mul_f32 v[250:251], v[250:251], v[234:235]
v_pk_fma_f32 v[228:229], v[228:229], v[22:23], v[22:23] op_sel:[0,1,1] op_sel_hi:[1,1,1]
v_pk_fma_f32 v[230:231], v[230:231], v[22:23], v[22:23] op_sel:[0,1,1] op_sel_hi:[1,1,1]
v_pk_fma_f32 v[236:237], v[236:237], v[22:23], v[22:23] op_sel:[0,1,1] op_sel_hi:[1,1,1]
v_pk_fma_f32 v[238:239], v[238:239], v[22:23], v[22:23] op_sel:[0,1,1] op_sel_hi:[1,1,1]
v_cvt_pk_bf16_f32 v224, v240, v241
v_cvt_pk_bf16_f32 v225, v242, v243
v_cvt_pk_bf16_f32 v226, v248, v249
v_cvt_pk_bf16_f32 v227, v250, v251
buffer_store_dwordx4 v[224:227], v10, s[16:19], s65 offen sc1
v_rcp_f32 v228, v228
v_rcp_f32 v229, v229
v_rcp_f32 v230, v230
v_rcp_f32 v231, v231
v_rcp_f32 v236, v236
v_rcp_f32 v237, v237
v_rcp_f32 v238, v238
v_rcp_f32 v239, v239
v_pk_mul_f32 v[244:245], v[244:245], v[228:229]
v_pk_mul_f32 v[246:247], v[246:247], v[230:231]
v_pk_mul_f32 v[252:253], v[252:253], v[236:237]
v_pk_mul_f32 v[254:255], v[254:255], v[238:239]
v_cvt_pk_bf16_f32 v228, v244, v245
v_cvt_pk_bf16_f32 v229, v246, v247
v_cvt_pk_bf16_f32 v230, v252, v253
v_cvt_pk_bf16_f32 v231, v254, v255
buffer_store_dwordx4 v[228:231], v10, s[16:19], s65 offen offset:1024 sc1
s_nop 1
s_lshl_b32 s62, s6, 13
s_lshl_b32 s63, s3, 11
s_add_u32 s62, s62, s63
v_lshl_add_u32 v4, v1, 4, s62
s_and_b32 s62, s7, 1
s_mul_i32 s62, s62, 3670016
s_lshr_b32 s63, s7, 1
s_lshl_b32 s63, s63, 8
s_add_u32 s62, s62, s63
s_lshl_b32 s63, s3, 12
s_add_u32 s62, s62, s63
v_lshrrev_b32 v5, 4, v1
v_lshlrev_b32 v5, 14, v5
v_and_b32 v2, 15, v1
v_lshl_add_u32 v5, v2, 4, v5
v_add_u32 v5, s62, v5
v_add_u32 v6, 992, v5
v_bfe_u32 v8, v1, 2, 3
v_mul_u32_u24 v8, 1056, v8
v_bfe_u32 v2, v1, 5, 1
v_lshl_add_u32 v8, v2, 8, v8
v_and_b32 v2, 3, v1
v_lshl_add_u32 v8, v2, 3, v8
s_and_b32 s62, s7, 1
s_lshl_b32 s63, s62, 7
s_xor_b32 s64, s63, 128
v_add_u32 v7, s63, v8
v_add_u32 v10, s64, v8
s_mul_i32 s52, s62, 7340032
s_add_u32 s52, s52, 46137344
s_mov_b32 s54, 917504
s_mul_i32 s55, s3, 2112
s_add_u32 s56, s55, 67584
s_mov_b32 s57, 67584
s_lshl_b32 s70, s2, 10
s_lshl_b32 s62, s3, 7
s_add_u32 s70, s70, s62
s_add_u32 s70, s70, 31457792
s_xor_b32 s71, s70, 1024
v_min_u32 v12, 1, v1
v_lshlrev_b32 v12, 28, v12
v_mov_b32 v13, 1
v_mov_b32 v15, 0
s_lshl_b32 s68, s7, 18
s_add_u32 s68, s68, 146800640
s_xor_b32 s69, s68, 262144
v_mov_b32 v11, v4
v_and_b32 v2, 1, v1
v_lshlrev_b32 v2, 4, v2
v_mov_b32 v224, 0x3f80
v_lshlrev_b32 v2, v2, v224
v_bfe_u32 v224, v1, 2, 2
v_lshrrev_b32 v225, 4, v1
v_cmp_eq_u32 vcc, v224, v225
s_nop 1
v_cndmask_b32 v2, 0, v2, vcc
v_and_b32 v224, 2, v1
v_cmp_eq_u32 vcc, 0, v224
s_nop 1
v_cndmask_b32 v226, 0, v2, vcc
.Lpad23:
s_cbranch_execz .Lnopoll72r
v_cndmask_b32 v227, v2, 0, vcc
v_mov_b64 v[224:225], 0
v_mov_b64 v[228:229], 0
v_mov_b64 v[64:65], 0
v_mov_b64 v[66:67], 0
v_mov_b64 v[68:69], 0
v_mov_b64 v[70:71], 0
v_mov_b64 v[72:73], 0
v_mov_b64 v[74:75], 0
v_mov_b64 v[76:77], 0
v_mov_b64 v[78:79], 0
v_mov_b64 v[80:81], 0
v_mov_b64 v[82:83], 0
v_mov_b64 v[84:85], 0
v_mov_b64 v[86:87], 0
v_mov_b64 v[88:89], 0
v_mov_b64 v[90:91], 0
v_mov_b64 v[92:93], 0
v_mov_b64 v[94:95], 0
v_accvgpr_read_b32 v32, a224
v_accvgpr_read_b32 v33, a225
v_accvgpr_read_b32 v34, a226
v_accvgpr_read_b32 v35, a227
v_accvgpr_read_b32 v36, a228
v_accvgpr_read_b32 v37, a229
v_accvgpr_read_b32 v38, a230
v_accvgpr_read_b32 v39, a231
v_accvgpr_read_b32 v40, a232
v_accvgpr_read_b32 v41, a233
v_accvgpr_read_b32 v42, a234
v_accvgpr_read_b32 v43, a235
v_accvgpr_read_b32 v44, a236
v_accvgpr_read_b32 v45, a237
v_accvgpr_read_b32 v46, a238
v_accvgpr_read_b32 v47, a239
v_accvgpr_read_b32 v48, a240
v_accvgpr_read_b32 v49, a241
v_accvgpr_read_b32 v50, a242
v_accvgpr_read_b32 v51, a243
v_accvgpr_read_b32 v52, a244
v_accvgpr_read_b32 v53, a245
v_accvgpr_read_b32 v54, a246
v_accvgpr_read_b32 v55, a247
v_accvgpr_read_b32 v56, a248
v_accvgpr_read_b32 v57, a249
v_accvgpr_read_b32 v58, a250
v_accvgpr_read_b32 v59, a251
v_accvgpr_read_b32 v60, a252
v_accvgpr_read_b32 v61, a253
v_accvgpr_read_b32 v62, a254
v_accvgpr_read_b32 v63, a255
s_lshr_b32 s62, s6, 1
s_lshl_b32 s62, s62, 8
s_and_b32 s63, s6, 1
s_add_u32 s62, s62, s63
s_lshl_b32 s63, s3, 6
s_add_u32 s62, s62, s63
s_lshl_b32 s62, s62, 11
s_lshl_b32 s63, s7, 7
s_add_u32 s62, s62, s63
v_and_b32 v16, 15, v1
v_lshlrev_b32 v16, 12, v16
v_bfe_u32 v2, v1, 4, 1
v_lshl_add_u32 v16, v2, 5, v16
v_bfe_u32 v2, v1, 5, 1
v_lshl_add_u32 v16, v2, 4, v16
v_add_u32 v16, s62, v16
v_add_u32 v17, 0x10000, v16
s_lshl_b32 s62, s10, 1
s_lshr_b32 s63, s11, 4
s_add_u32 s62, s62, s63
s_lshl_b32 s62, s62, 7
s_add_u32 s62, s62, 30423040
s_and_b32 s64, s6, 14
s_and_b32 s63, s7, 1
s_add_u32 s64, s64, s63
s_lshl_b32 s64, s64, 7
s_add_u32 s64, s64, 30423040
v_mov_b32 v252, s62
v_mov_b32 v253, s64
s_waitcnt vmcnt(0) lgkmcnt(0)
s_barrier
s_cmp_lg_u32 s3, 0
s_cbranch_scc1 .Lnosig75
v_mov_b32 v255, 1
s_mov_b64 exec, 1
buffer_atomic_add v255, v252, s[16:19], 0 offen
s_mov_b64 exec, -1
.Lnosig75:
s_cmp_lg_u32 s3, 1
s_cbranch_scc1 .Lnopoll78
s_mov_b64 exec, 1
s_mov_b32 s15, 0
s_mov_b64 exec, 1
v_mov_b32 v254, 0
buffer_atomic_add v254, v253, s[16:19], 0 offen sc0
.Lpoll76:
s_waitcnt vmcnt(0)
v_cmp_ne_u32 vcc, 16, v254
s_add_u32 s15, s15, 1
s_cbranch_vccz .Lnopoll78r
s_sleep 2
s_mov_b64 exec, 1
v_mov_b32 v254, 0
buffer_atomic_add v254, v253, s[16:19], 0 offen sc0
s_cmp_le_u32 s15, 100000
s_cbranch_scc1 .Lpoll76
.Lgot77:
s_waitcnt vmcnt(0)
s_branch .Lnopoll78r
.Lnopoll78:
s_mov_b64 exec, 0
s_cmp_eq_u32 s3, 2
s_cbranch_scc1 .Lpad24
s_cmp_eq_u32 s3, 3
s_cbranch_scc1 .Lpad25
s_branch .Lnopoll78r
.Lnopoll78r:
s_mov_b64 exec, -1
s_barrier
buffer_load_dwordx4 v[96:99], v4, s[16:19], s52 offen sc1
buffer_load_dwordx4 v[100:103], v4, s[16:19], s52 offen offset:1024 sc1
s_add_u32 s52, s52, 0x20000
buffer_load_dwordx4 v[104:107], v4, s[16:19], s52 offen sc1
buffer_load_dwordx4 v[108:111], v4, s[16:19], s52 offen offset:1024 sc1
s_add_u32 s52, s52, 0x20000
buffer_load_dwordx4 v[112:115], v4, s[16:19], s52 offen sc1
buffer_load_dwordx4 v[116:119], v4, s[16:19], s52 offen offset:1024 sc1
s_add_u32 s52, s52, 0x20000
buffer_load_dwordx4 v[120:123], v4, s[16:19], s52 offen sc1
buffer_load_dwordx4 v[124:127], v4, s[16:19], s52 offen offset:1024 sc1
s_add_u32 s52, s52, 0x20000
buffer_load_dwordx4 v[128:131], v4, s[16:19], s52 offen sc1
buffer_load_dwordx4 v[132:135], v4, s[16:19], s52 offen offset:1024 sc1
s_add_u32 s52, s52, 0x20000
buffer_load_dwordx4 v[136:139], v4, s[16:19], s52 offen sc1
buffer_load_dwordx4 v[140:143], v4, s[16:19], s52 offen offset:1024 sc1
s_add_u32 s52, s52, 0x20000
ds_read_b64_tr_b16 a[0:1], v7
ds_read_b64_tr_b16 a[2:3], v7 offset:512
ds_read_b64_tr_b16 a[4:5], v7 offset:32
ds_read_b64_tr_b16 a[6:7], v7 offset:544
ds_read_b64_tr_b16 a[8:9], v7 offset:64
ds_read_b64_tr_b16 a[10:11], v7 offset:576
ds_read_b64_tr_b16 a[12:13], v7 offset:96
ds_read_b64_tr_b16 a[14:15], v7 offset:608
ds_read_b64_tr_b16 a[16:17], v10
ds_read_b64_tr_b16 a[18:19], v10 offset:512
ds_read_b64_tr_b16 a[20:21], v10 offset:32
ds_read_b64_tr_b16 a[22:23], v10 offset:544
ds_read_b64_tr_b16 a[24:25], v10 offset:64
ds_read_b64_tr_b16 a[26:27], v10 offset:576
ds_read_b64_tr_b16 a[28:29], v10 offset:96
ds_read_b64_tr_b16 a[30:31], v10 offset:608
s_waitcnt lgkmcnt(0)
s_mov_b32 s15, -4
.p2align 6
.Lk80:
s_waitcnt vmcnt(10) lgkmcnt(8)
s_barrier
v_mfma_f32_16x16x32_bf16 v[32:35], a[0:3], v[96:99], v[32:35]
ds_read_b64_tr_b16 a[32:33], v7 offset:8448
s_add_u32 m0, s56, 50688
v_mfma_f32_16x16x32_bf16 v[48:51], a[0:3], v[100:103], v[48:51]
buffer_load_dwordx4 v5, s[28:31], s54 offen lds
v_mfma_f32_16x16x32_bf16 v[52:55], a[4:7], v[100:103], v[52:55]
ds_read_b64_tr_b16 a[34:35], v7 offset:8960
ds_read_b64_tr_b16 a[36:37], v7 offset:8480
v_mfma_f32_16x16x32_bf16 v[36:39], a[4:7], v[96:99], v[36:39]
ds_read_b64_tr_b16 a[38:39], v7 offset:8992
v_mfma_f32_16x16x32_bf16 v[40:43], a[8:11], v[96:99], v[40:43]
buffer_load_dwordx4 v[144:147], v4, s[16:19], s52 offen sc1
v_mfma_f32_16x16x32_bf16 v[56:59], a[8:11], v[100:103], v[56:59]
ds_read_b64_tr_b16 a[40:41], v7 offset:8512
ds_read_b64_tr_b16 a[42:43], v7 offset:9024
v_mfma_f32_16x16x32_bf16 v[60:63], a[12:15], v[100:103], v[60:63]
ds_read_b64_tr_b16 a[44:45], v7 offset:8544
ds_read_b64_tr_b16 a[46:47], v7 offset:9056
v_mfma_f32_16x16x32_bf16 v[44:47], a[12:15], v[96:99], v[44:47]
s_waitcnt lgkmcnt(8)
v_mfma_f32_16x16x32_bf16 v[64:67], a[16:19], v[96:99], v[64:67]
buffer_load_dwordx4 v6, s[28:31], s54 offen offset:1056 lds
v_mfma_f32_16x16x32_bf16 v[80:83], a[16:19], v[100:103], v[80:83]
ds_read_b64_tr_b16 a[48:49], v10 offset:8448
s_add_u32 s54, s54, 0x10000
v_mfma_f32_16x16x32_bf16 v[84:87], a[20:23], v[100:103], v[84:87]
ds_read_b64_tr_b16 a[50:51], v10 offset:8960
ds_read_b64_tr_b16 a[52:53], v10 offset:8480
v_mfma_f32_16x16x32_bf16 v[68:71], a[20:23], v[96:99], v[68:71]
ds_read_b64_tr_b16 a[54:55], v10 offset:8992
v_mfma_f32_16x16x32_bf16 v[72:75], a[24:27], v[96:99], v[72:75]
buffer_load_dwordx4 v[148:151], v4, s[16:19], s52 offen offset:1024 sc1
v_mfma_f32_16x16x32_bf16 v[88:91], a[24:27], v[100:103], v[88:91]
ds_read_b64_tr_b16 a[56:57], v10 offset:8512
s_add_u32 s52, s52, 0x20000
v_mfma_f32_16x16x32_bf16 v[92:95], a[28:31], v[100:103], v[92:95]
ds_read_b64_tr_b16 a[58:59], v10 offset:9024
ds_read_b64_tr_b16 a[60:61], v10 offset:8544
v_mfma_f32_16x16x32_bf16 v[76:79], a[28:31], v[96:99], v[76:79]
ds_read_b64_tr_b16 a[62:63], v10 offset:9056
s_waitcnt vmcnt(12) lgkmcnt(8)
v_mfma_f32_16x16x32_bf16 v[32:35], a[32:35], v[104:107], v[32:35]
ds_read_b64_tr_b16 a[0:1], v7 offset:16896
s_add_u32 m0, s56, 59136
v_mfma_f32_16x16x32_bf16 v[48:51], a[32:35], v[108:111], v[48:51]
buffer_load_dwordx4 v5, s[28:31], s54 offen lds
v_mfma_f32_16x16x32_bf16 v[52:55], a[36:39], v[108:111], v[52:55]
ds_read_b64_tr_b16 a[2:3], v7 offset:17408
ds_read_b64_tr_b16 a[4:5], v7 offset:16928
v_mfma_f32_16x16x32_bf16 v[36:39], a[36:39], v[104:107], v[36:39]
ds_read_b64_tr_b16 a[6:7], v7 offset:17440
v_mfma_f32_16x16x32_bf16 v[40:43], a[40:43], v[104:107], v[40:43]
buffer_load_dwordx4 v[152:155], v4, s[16:19], s52 offen sc1
v_mfma_f32_16x16x32_bf16 v[56:59], a[40:43], v[108:111], v[56:59]
ds_read_b64_tr_b16 a[8:9], v7 offset:16960
ds_read_b64_tr_b16 a[10:11], v7 offset:17472
v_mfma_f32_16x16x32_bf16 v[60:63], a[44:47], v[108:111], v[60:63]
ds_read_b64_tr_b16 a[12:13], v7 offset:16992
ds_read_b64_tr_b16 a[14:15], v7 offset:17504
v_mfma_f32_16x16x32_bf16 v[44:47], a[44:47], v[104:107], v[44:47]
s_waitcnt lgkmcnt(8)
v_mfma_f32_16x16x32_bf16 v[64:67], a[48:51], v[104:107], v[64:67]
buffer_load_dwordx4 v6, s[28:31], s54 offen offset:1056 lds
v_mfma_f32_16x16x32_bf16 v[80:83], a[48:51], v[108:111], v[80:83]
ds_read_b64_tr_b16 a[16:17], v10 offset:16896
s_add_u32 s54, s54, 0x10000
v_mfma_f32_16x16x32_bf16 v[84:87], a[52:55], v[108:111], v[84:87]
ds_read_b64_tr_b16 a[18:19], v10 offset:17408
ds_read_b64_tr_b16 a[20:21], v10 offset:16928
v_mfma_f32_16x16x32_bf16 v[68:71], a[52:55], v[104:107], v[68:71]
ds_read_b64_tr_b16 a[22:23], v10 offset:17440
v_mfma_f32_16x16x32_bf16 v[72:75], a[56:59], v[104:107], v[72:75]
buffer_load_dwordx4 v[156:159], v4, s[16:19], s52 offen offset:1024 sc1
v_mfma_f32_16x16x32_bf16 v[88:91], a[56:59], v[108:111], v[88:91]
ds_read_b64_tr_b16 a[24:25], v10 offset:16960
s_add_u32 s52, s52, 0x20000
v_mfma_f32_16x16x32_bf16 v[92:95], a[60:63], v[108:111], v[92:95]
ds_read_b64_tr_b16 a[26:27], v10 offset:17472
ds_read_b64_tr_b16 a[28:29], v10 offset:16992
v_mfma_f32_16x16x32_bf16 v[76:79], a[60:63], v[104:107], v[76:79]
ds_read_b64_tr_b16 a[30:31], v10 offset:17504
s_waitcnt vmcnt(14) lgkmcnt(8)
s_barrier
v_mfma_f32_16x16x32_bf16 v[32:35], a[0:3], v[112:115], v[32:35]
ds_read_b64_tr_b16 a[32:33], v7 offset:25344
s_add_u32 m0, s55, 0
v_mfma_f32_16x16x32_bf16 v[48:51], a[0:3], v[116:119], v[48:51]
buffer_load_dwordx4 v5, s[28:31], s54 offen lds
v_mfma_f32_16x16x32_bf16 v[52:55], a[4:7], v[116:119], v[52:55]
ds_read_b64_tr_b16 a[34:35], v7 offset:25856
ds_read_b64_tr_b16 a[36:37], v7 offset:25376
v_mfma_f32_16x16x32_bf16 v[36:39], a[4:7], v[112:115], v[36:39]
ds_read_b64_tr_b16 a[38:39], v7 offset:25888
v_mfma_f32_16x16x32_bf16 v[40:43], a[8:11], v[112:115], v[40:43]
buffer_load_dwordx4 v[96:99], v4, s[16:19], s52 offen sc1
v_mfma_f32_16x16x32_bf16 v[56:59], a[8:11], v[116:119], v[56:59]
ds_read_b64_tr_b16 a[40:41], v7 offset:25408
ds_read_b64_tr_b16 a[42:43], v7 offset:25920
v_mfma_f32_16x16x32_bf16 v[60:63], a[12:15], v[116:119], v[60:63]
ds_read_b64_tr_b16 a[44:45], v7 offset:25440
ds_read_b64_tr_b16 a[46:47], v7 offset:25952
v_mfma_f32_16x16x32_bf16 v[44:47], a[12:15], v[112:115], v[44:47]
s_waitcnt lgkmcnt(8)
v_mfma_f32_16x16x32_bf16 v[64:67], a[16:19], v[112:115], v[64:67]
buffer_load_dwordx4 v6, s[28:31], s54 offen offset:1056 lds
v_mfma_f32_16x16x32_bf16 v[80:83], a[16:19], v[116:119], v[80:83]
ds_read_b64_tr_b16 a[48:49], v10 offset:25344
s_add_u32 s54, s54, 0x10000
v_mfma_f32_16x16x32_bf16 v[84:87], a[20:23], v[116:119], v[84:87]
ds_read_b64_tr_b16 a[50:51], v10 offset:25856
ds_read_b64_tr_b16 a[52:53], v10 offset:25376
v_mfma_f32_16x16x32_bf16 v[68:71], a[20:23], v[112:115], v[68:71]
ds_read_b64_tr_b16 a[54:55], v10 offset:25888
v_mfma_f32_16x16x32_bf16 v[72:75], a[24:27], v[112:115], v[72:75]
buffer_load_dwordx4 v[100:103], v4, s[16:19], s52 offen offset:1024 sc1
v_mfma_f32_16x16x32_bf16 v[88:91], a[24:27], v[116:119], v[88:91]
ds_read_b64_tr_b16 a[56:57], v10 offset:25408
s_add_u32 s52, s52, 0x20000
v_mfma_f32_16x16x32_bf16 v[92:95], a[28:31], v[116:119], v[92:95]
ds_read_b64_tr_b16 a[58:59], v10 offset:25920
ds_read_b64_tr_b16 a[60:61], v10 offset:25440
v_mfma_f32_16x16x32_bf16 v[76:79], a[28:31], v[112:115], v[76:79]
ds_read_b64_tr_b16 a[62:63], v10 offset:25952
s_waitcnt vmcnt(16) lgkmcnt(8)
v_mfma_f32_16x16x32_bf16 v[32:35], a[32:35], v[120:123], v[32:35]
ds_read_b64_tr_b16 a[0:1], v7 offset:33792
s_add_u32 m0, s55, 8448
v_mfma_f32_16x16x32_bf16 v[48:51], a[32:35], v[124:127], v[48:51]
buffer_load_dwordx4 v5, s[28:31], s54 offen lds
v_mfma_f32_16x16x32_bf16 v[52:55], a[36:39], v[124:127], v[52:55]
ds_read_b64_tr_b16 a[2:3], v7 offset:34304
ds_read_b64_tr_b16 a[4:5], v7 offset:33824
v_mfma_f32_16x16x32_bf16 v[36:39], a[36:39], v[120:123], v[36:39]
ds_read_b64_tr_b16 a[6:7], v7 offset:34336
v_mfma_f32_16x16x32_bf16 v[40:43], a[40:43], v[120:123], v[40:43]
buffer_load_dwordx4 v[104:107], v4, s[16:19], s52 offen sc1
v_mfma_f32_16x16x32_bf16 v[56:59], a[40:43], v[124:127], v[56:59]
ds_read_b64_tr_b16 a[8:9], v7 offset:33856
ds_read_b64_tr_b16 a[10:11], v7 offset:34368
v_mfma_f32_16x16x32_bf16 v[60:63], a[44:47], v[124:127], v[60:63]
ds_read_b64_tr_b16 a[12:13], v7 offset:33888
ds_read_b64_tr_b16 a[14:15], v7 offset:34400
v_mfma_f32_16x16x32_bf16 v[44:47], a[44:47], v[120:123], v[44:47]
s_waitcnt lgkmcnt(8)
v_mfma_f32_16x16x32_bf16 v[64:67], a[48:51], v[120:123], v[64:67]
buffer_load_dwordx4 v6, s[28:31], s54 offen offset:1056 lds
v_mfma_f32_16x16x32_bf16 v[80:83], a[48:51], v[124:127], v[80:83]
ds_read_b64_tr_b16 a[16:17], v10 offset:33792
s_add_u32 s54, s54, 0x10000
v_mfma_f32_16x16x32_bf16 v[84:87], a[52:55], v[124:127], v[84:87]
ds_read_b64_tr_b16 a[18:19], v10 offset:34304
ds_read_b64_tr_b16 a[20:21], v10 offset:33824
v_mfma_f32_16x16x32_bf16 v[68:71], a[52:55], v[120:123], v[68:71]
ds_read_b64_tr_b16 a[22:23], v10 offset:34336
v_mfma_f32_16x16x32_bf16 v[72:75], a[56:59], v[120:123], v[72:75]
buffer_load_dwordx4 v[108:111], v4, s[16:19], s52 offen offset:1024 sc1
v_mfma_f32_16x16x32_bf16 v[88:91], a[56:59], v[124:127], v[88:91]
ds_read_b64_tr_b16 a[24:25], v10 offset:33856
s_add_u32 s52, s52, 0x20000
v_mfma_f32_16x16x32_bf16 v[92:95], a[60:63], v[124:127], v[92:95]
ds_read_b64_tr_b16 a[26:27], v10 offset:34368
ds_read_b64_tr_b16 a[28:29], v10 offset:33888
v_mfma_f32_16x16x32_bf16 v[76:79], a[60:63], v[120:123], v[76:79]
ds_read_b64_tr_b16 a[30:31], v10 offset:34400
s_waitcnt vmcnt(18) lgkmcnt(8)
s_barrier
v_mfma_f32_16x16x32_bf16 v[32:35], a[0:3], v[128:131], v[32:35]
ds_read_b64_tr_b16 a[32:33], v7 offset:42240
s_add_u32 m0, s55, 16896
v_mfma_f32_16x16x32_bf16 v[48:51], a[0:3], v[132:135], v[48:51]
buffer_load_dwordx4 v5, s[28:31], s54 offen lds
v_mfma_f32_16x16x32_bf16 v[52:55], a[4:7], v[132:135], v[52:55]
ds_read_b64_tr_b16 a[34:35], v7 offset:42752
ds_read_b64_tr_b16 a[36:37], v7 offset:42272
v_mfma_f32_16x16x32_bf16 v[36:39], a[4:7], v[128:131], v[36:39]
ds_read_b64_tr_b16 a[38:39], v7 offset:42784
v_mfma_f32_16x16x32_bf16 v[40:43], a[8:11], v[128:131], v[40:43]
buffer_load_dwordx4 v[112:115], v4, s[16:19], s52 offen sc1
v_mfma_f32_16x16x32_bf16 v[56:59], a[8:11], v[132:135], v[56:59]
ds_read_b64_tr_b16 a[40:41], v7 offset:42304
ds_read_b64_tr_b16 a[42:43], v7 offset:42816
v_mfma_f32_16x16x32_bf16 v[60:63], a[12:15], v[132:135], v[60:63]
ds_read_b64_tr_b16 a[44:45], v7 offset:42336
ds_read_b64_tr_b16 a[46:47], v7 offset:42848
v_mfma_f32_16x16x32_bf16 v[44:47], a[12:15], v[128:131], v[44:47]
s_waitcnt lgkmcnt(8)
v_mfma_f32_16x16x32_bf16 v[64:67], a[16:19], v[128:131], v[64:67]
buffer_load_dwordx4 v6, s[28:31], s54 offen offset:1056 lds
v_mfma_f32_16x16x32_bf16 v[80:83], a[16:19], v[132:135], v[80:83]
ds_read_b64_tr_b16 a[48:49], v10 offset:42240
s_add_u32 s54, s54, 0x10000
v_mfma_f32_16x16x32_bf16 v[84:87], a[20:23], v[132:135], v[84:87]
ds_read_b64_tr_b16 a[50:51], v10 offset:42752
ds_read_b64_tr_b16 a[52:53], v10 offset:42272
v_mfma_f32_16x16x32_bf16 v[68:71], a[20:23], v[128:131], v[68:71]
ds_read_b64_tr_b16 a[54:55], v10 offset:42784
v_mfma_f32_16x16x32_bf16 v[72:75], a[24:27], v[128:131], v[72:75]
buffer_load_dwordx4 v[116:119], v4, s[16:19], s52 offen offset:1024 sc1
v_mfma_f32_16x16x32_bf16 v[88:91], a[24:27], v[132:135], v[88:91]
ds_read_b64_tr_b16 a[56:57], v10 offset:42304
s_add_u32 s52, s52, 0x20000
v_mfma_f32_16x16x32_bf16 v[92:95], a[28:31], v[132:135], v[92:95]
ds_read_b64_tr_b16 a[58:59], v10 offset:42816
ds_read_b64_tr_b16 a[60:61], v10 offset:42336
v_mfma_f32_16x16x32_bf16 v[76:79], a[28:31], v[128:131], v[76:79]
ds_read_b64_tr_b16 a[62:63], v10 offset:42848
s_waitcnt vmcnt(20) lgkmcnt(8)
v_mfma_f32_16x16x32_bf16 v[32:35], a[32:35], v[136:139], v[32:35]
ds_read_b64_tr_b16 a[0:1], v7 offset:50688
s_add_u32 m0, s55, 25344
v_mfma_f32_16x16x32_bf16 v[48:51], a[32:35], v[140:143], v[48:51]
buffer_load_dwordx4 v5, s[28:31], s54 offen lds
v_mfma_f32_16x16x32_bf16 v[52:55], a[36:39], v[140:143], v[52:55]
ds_read_b64_tr_b16 a[2:3], v7 offset:51200
ds_read_b64_tr_b16 a[4:5], v7 offset:50720
v_mfma_f32_16x16x32_bf16 v[36:39], a[36:39], v[136:139], v[36:39]
ds_read_b64_tr_b16 a[6:7], v7 offset:51232
v_mfma_f32_16x16x32_bf16 v[40:43], a[40:43], v[136:139], v[40:43]
buffer_load_dwordx4 v[120:123], v4, s[16:19], s52 offen sc1
v_mfma_f32_16x16x32_bf16 v[56:59], a[40:43], v[140:143], v[56:59]
ds_read_b64_tr_b16 a[8:9], v7 offset:50752
ds_read_b64_tr_b16 a[10:11], v7 offset:51264
v_mfma_f32_16x16x32_bf16 v[60:63], a[44:47], v[140:143], v[60:63]
ds_read_b64_tr_b16 a[12:13], v7 offset:50784
ds_read_b64_tr_b16 a[14:15], v7 offset:51296
v_mfma_f32_16x16x32_bf16 v[44:47], a[44:47], v[136:139], v[44:47]
s_waitcnt lgkmcnt(8)
v_mfma_f32_16x16x32_bf16 v[64:67], a[48:51], v[136:139], v[64:67]
buffer_load_dwordx4 v6, s[28:31], s54 offen offset:1056 lds
v_mfma_f32_16x16x32_bf16 v[80:83], a[48:51], v[140:143], v[80:83]
ds_read_b64_tr_b16 a[16:17], v10 offset:50688
s_add_u32 s54, s54, 0x10000
v_mfma_f32_16x16x32_bf16 v[84:87], a[52:55], v[140:143], v[84:87]
ds_read_b64_tr_b16 a[18:19], v10 offset:51200
ds_read_b64_tr_b16 a[20:21], v10 offset:50720
v_mfma_f32_16x16x32_bf16 v[68:71], a[52:55], v[136:139], v[68:71]
ds_read_b64_tr_b16 a[22:23], v10 offset:51232
v_mfma_f32_16x16x32_bf16 v[72:75], a[56:59], v[136:139], v[72:75]
buffer_load_dwordx4 v[124:127], v4, s[16:19], s52 offen offset:1024 sc1
v_mfma_f32_16x16x32_bf16 v[88:91], a[56:59], v[140:143], v[88:91]
ds_read_b64_tr_b16 a[24:25], v10 offset:50752
s_add_u32 s52, s52, 0x20000
v_mfma_f32_16x16x32_bf16 v[92:95], a[60:63], v[140:143], v[92:95]
ds_read_b64_tr_b16 a[26:27], v10 offset:51264
ds_read_b64_tr_b16 a[28:29], v10 offset:50784
v_mfma_f32_16x16x32_bf16 v[76:79], a[60:63], v[136:139], v[76:79]
ds_read_b64_tr_b16 a[30:31], v10 offset:51296
s_waitcnt vmcnt(20) lgkmcnt(8)
s_barrier
v_mfma_f32_16x16x32_bf16 v[32:35], a[0:3], v[144:147], v[32:35]
ds_read_b64_tr_b16 a[32:33], v7 offset:59136
s_add_u32 m0, s55, 33792
v_mfma_f32_16x16x32_bf16 v[48:51], a[0:3], v[148:151], v[48:51]
buffer_load_dwordx4 v5, s[28:31], s54 offen lds
v_mfma_f32_16x16x32_bf16 v[52:55], a[4:7], v[148:151], v[52:55]
ds_read_b64_tr_b16 a[34:35], v7 offset:59648
ds_read_b64_tr_b16 a[36:37], v7 offset:59168
v_mfma_f32_16x16x32_bf16 v[36:39], a[4:7], v[144:147], v[36:39]
ds_read_b64_tr_b16 a[38:39], v7 offset:59680
v_mfma_f32_16x16x32_bf16 v[40:43], a[8:11], v[144:147], v[40:43]
buffer_load_dwordx4 v[128:131], v4, s[16:19], s52 offen sc1
v_mfma_f32_16x16x32_bf16 v[56:59], a[8:11], v[148:151], v[56:59]
ds_read_b64_tr_b16 a[40:41], v7 offset:59200
ds_read_b64_tr_b16 a[42:43], v7 offset:59712
v_mfma_f32_16x16x32_bf16 v[60:63], a[12:15], v[148:151], v[60:63]
ds_read_b64_tr_b16 a[44:45], v7 offset:59232
ds_read_b64_tr_b16 a[46:47], v7 offset:59744
v_mfma_f32_16x16x32_bf16 v[44:47], a[12:15], v[144:147], v[44:47]
s_waitcnt lgkmcnt(8)
v_mfma_f32_16x16x32_bf16 v[64:67], a[16:19], v[144:147], v[64:67]
buffer_load_dwordx4 v6, s[28:31], s54 offen offset:1056 lds
v_mfma_f32_16x16x32_bf16 v[80:83], a[16:19], v[148:151], v[80:83]
ds_read_b64_tr_b16 a[48:49], v10 offset:59136
s_add_u32 s54, s54, 0x10000
v_mfma_f32_16x16x32_bf16 v[84:87], a[20:23], v[148:151], v[84:87]
ds_read_b64_tr_b16 a[50:51], v10 offset:59648
ds_read_b64_tr_b16 a[52:53], v10 offset:59168
v_mfma_f32_16x16x32_bf16 v[68:71], a[20:23], v[144:147], v[68:71]
ds_read_b64_tr_b16 a[54:55], v10 offset:59680
v_mfma_f32_16x16x32_bf16 v[72:75], a[24:27], v[144:147], v[72:75]
buffer_load_dwordx4 v[132:135], v4, s[16:19], s52 offen offset:1024 sc1
v_mfma_f32_16x16x32_bf16 v[88:91], a[24:27], v[148:151], v[88:91]
ds_read_b64_tr_b16 a[56:57], v10 offset:59200
s_add_u32 s52, s52, 0x20000
v_mfma_f32_16x16x32_bf16 v[92:95], a[28:31], v[148:151], v[92:95]
ds_read_b64_tr_b16 a[58:59], v10 offset:59712
ds_read_b64_tr_b16 a[60:61], v10 offset:59232
v_mfma_f32_16x16x32_bf16 v[76:79], a[28:31], v[144:147], v[76:79]
ds_read_b64_tr_b16 a[62:63], v10 offset:59744
v_add_u32 v7, s57, v7
v_add_u32 v10, s57, v10
s_sub_u32 s57, 0, s57
s_waitcnt vmcnt(20) lgkmcnt(8)
v_mfma_f32_16x16x32_bf16 v[32:35], a[32:35], v[152:155], v[32:35]
ds_read_b64_tr_b16 a[0:1], v7
s_add_u32 m0, s55, 42240
v_mfma_f32_16x16x32_bf16 v[48:51], a[32:35], v[156:159], v[48:51]
buffer_load_dwordx4 v5, s[28:31], s54 offen lds
v_mfma_f32_16x16x32_bf16 v[52:55], a[36:39], v[156:159], v[52:55]
ds_read_b64_tr_b16 a[2:3], v7 offset:512
ds_read_b64_tr_b16 a[4:5], v7 offset:32
v_mfma_f32_16x16x32_bf16 v[36:39], a[36:39], v[152:155], v[36:39]
ds_read_b64_tr_b16 a[6:7], v7 offset:544
v_mfma_f32_16x16x32_bf16 v[40:43], a[40:43], v[152:155], v[40:43]
buffer_load_dwordx4 v[136:139], v4, s[16:19], s52 offen sc1
v_mfma_f32_16x16x32_bf16 v[56:59], a[40:43], v[156:159], v[56:59]
ds_read_b64_tr_b16 a[8:9], v7 offset:64
ds_read_b64_tr_b16 a[10:11], v7 offset:576
v_mfma_f32_16x16x32_bf16 v[60:63], a[44:47], v[156:159], v[60:63]
ds_read_b64_tr_b16 a[12:13], v7 offset:96
ds_read_b64_tr_b16 a[14:15], v7 offset:608
v_mfma_f32_16x16x32_bf16 v[44:47], a[44:47], v[152:155], v[44:47]
s_waitcnt lgkmcnt(8)
v_mfma_f32_16x16x32_bf16 v[64:67], a[48:51], v[152:155], v[64:67]
buffer_load_dwordx4 v6, s[28:31], s54 offen offset:1056 lds
v_mfma_f32_16x16x32_bf16 v[80:83], a[48:51], v[156:159], v[80:83]
ds_read_b64_tr_b16 a[16:17], v10
s_add_u32 s54, s54, 0x10000
v_mfma_f32_16x16x32_bf16 v[84:87], a[52:55], v[156:159], v[84:87]
ds_read_b64_tr_b16 a[18:19], v10 offset:512
ds_read_b64_tr_b16 a[20:21], v10 offset:32
v_mfma_f32_16x16x32_bf16 v[68:71], a[52:55], v[152:155], v[68:71]
ds_read_b64_tr_b16 a[22:23], v10 offset:544
v_mfma_f32_16x16x32_bf16 v[72:75], a[56:59], v[152:155], v[72:75]
buffer_load_dwordx4 v[140:143], v4, s[16:19], s52 offen offset:1024 sc1
v_mfma_f32_16x16x32_bf16 v[88:91], a[56:59], v[156:159], v[88:91]
ds_read_b64_tr_b16 a[24:25], v10 offset:64
s_add_u32 s52, s52, 0x20000
v_mfma_f32_16x16x32_bf16 v[92:95], a[60:63], v[156:159], v[92:95]
ds_read_b64_tr_b16 a[26:27], v10 offset:576
ds_read_b64_tr_b16 a[28:29], v10 offset:96
v_mfma_f32_16x16x32_bf16 v[76:79], a[60:63], v[152:155], v[76:79]
ds_read_b64_tr_b16 a[30:31], v10 offset:608
s_mov_b32 s62, s55
s_mov_b32 s55, s56
s_mov_b32 s56, s62
s_add_u32 s15, s15, 1
s_cbranch_scc0 .Lk80
s_waitcnt vmcnt(20) lgkmcnt(8)
s_barrier
v_mfma_f32_16x16x32_bf16 v[32:35], a[0:3], v[96:99], v[32:35]
ds_read_b64_tr_b16 a[32:33], v7 offset:8448
s_add_u32 m0, s56, 50688
v_mfma_f32_16x16x32_bf16 v[48:51], a[0:3], v[100:103], v[48:51]
buffer_load_dwordx4 v5, s[28:31], s54 offen lds
v_mfma_f32_16x16x32_bf16 v[52:55], a[4:7], v[100:103], v[52:55]
ds_read_b64_tr_b16 a[34:35], v7 offset:8960
ds_read_b64_tr_b16 a[36:37], v7 offset:8480
v_mfma_f32_16x16x32_bf16 v[36:39], a[4:7], v[96:99], v[36:39]
ds_read_b64_tr_b16 a[38:39], v7 offset:8992
v_mfma_f32_16x16x32_bf16 v[40:43], a[8:11], v[96:99], v[40:43]
buffer_load_dwordx4 v[144:147], v4, s[16:19], s52 offen sc1
v_mfma_f32_16x16x32_bf16 v[56:59], a[8:11], v[100:103], v[56:59]
ds_read_b64_tr_b16 a[40:41], v7 offset:8512
ds_read_b64_tr_b16 a[42:43], v7 offset:9024
v_mfma_f32_16x16x32_bf16 v[60:63], a[12:15], v[100:103], v[60:63]
ds_read_b64_tr_b16 a[44:45], v7 offset:8544
ds_read_b64_tr_b16 a[46:47], v7 offset:9056
v_mfma_f32_16x16x32_bf16 v[44:47], a[12:15], v[96:99], v[44:47]
s_waitcnt lgkmcnt(8)
v_mfma_f32_16x16x32_bf16 v[64:67], a[16:19], v[96:99], v[64:67]
buffer_load_dwordx4 v6, s[28:31], s54 offen offset:1056 lds
v_mfma_f32_16x16x32_bf16 v[80:83], a[16:19], v[100:103], v[80:83]
ds_read_b64_tr_b16 a[48:49], v10 offset:8448
s_add_u32 s54, s54, 0x10000
v_mfma_f32_16x16x32_bf16 v[84:87], a[20:23], v[100:103], v[84:87]
ds_read_b64_tr_b16 a[50:51], v10 offset:8960
ds_read_b64_tr_b16 a[52:53], v10 offset:8480
v_mfma_f32_16x16x32_bf16 v[68:71], a[20:23], v[96:99], v[68:71]
ds_read_b64_tr_b16 a[54:55], v10 offset:8992
v_mfma_f32_16x16x32_bf16 v[72:75], a[24:27], v[96:99], v[72:75]
buffer_load_dwordx4 v[148:151], v4, s[16:19], s52 offen offset:1024 sc1
v_mfma_f32_16x16x32_bf16 v[88:91], a[24:27], v[100:103], v[88:91]
ds_read_b64_tr_b16 a[56:57], v10 offset:8512
s_add_u32 s52, s52, 0x20000
v_mfma_f32_16x16x32_bf16 v[92:95], a[28:31], v[100:103], v[92:95]
ds_read_b64_tr_b16 a[58:59], v10 offset:9024
ds_read_b64_tr_b16 a[60:61], v10 offset:8544
v_mfma_f32_16x16x32_bf16 v[76:79], a[28:31], v[96:99], v[76:79]
ds_read_b64_tr_b16 a[62:63], v10 offset:9056
s_waitcnt vmcnt(20) lgkmcnt(8)
v_mfma_f32_16x16x32_bf16 v[32:35], a[32:35], v[104:107], v[32:35]
ds_read_b64_tr_b16 a[0:1], v7 offset:16896
s_add_u32 m0, s56, 59136
v_mfma_f32_16x16x32_bf16 v[48:51], a[32:35], v[108:111], v[48:51]
buffer_load_dwordx4 v5, s[28:31], s54 offen lds
v_mfma_f32_16x16x32_bf16 v[52:55], a[36:39], v[108:111], v[52:55]
ds_read_b64_tr_b16 a[2:3], v7 offset:17408
ds_read_b64_tr_b16 a[4:5], v7 offset:16928
v_mfma_f32_16x16x32_bf16 v[36:39], a[36:39], v[104:107], v[36:39]
ds_read_b64_tr_b16 a[6:7], v7 offset:17440
v_mfma_f32_16x16x32_bf16 v[40:43], a[40:43], v[104:107], v[40:43]
buffer_load_dwordx4 v[152:155], v4, s[16:19], s52 offen sc1
v_mfma_f32_16x16x32_bf16 v[56:59], a[40:43], v[108:111], v[56:59]
ds_read_b64_tr_b16 a[8:9], v7 offset:16960
ds_read_b64_tr_b16 a[10:11], v7 offset:17472
v_mfma_f32_16x16x32_bf16 v[60:63], a[44:47], v[108:111], v[60:63]
ds_read_b64_tr_b16 a[12:13], v7 offset:16992
ds_read_b64_tr_b16 a[14:15], v7 offset:17504
v_mfma_f32_16x16x32_bf16 v[44:47], a[44:47], v[104:107], v[44:47]
s_waitcnt lgkmcnt(8)
v_mfma_f32_16x16x32_bf16 v[64:67], a[48:51], v[104:107], v[64:67]
buffer_load_dwordx4 v6, s[28:31], s54 offen offset:1056 lds
v_mfma_f32_16x16x32_bf16 v[80:83], a[48:51], v[108:111], v[80:83]
ds_read_b64_tr_b16 a[16:17], v10 offset:16896
s_add_u32 s54, s54, 0x10000
v_mfma_f32_16x16x32_bf16 v[84:87], a[52:55], v[108:111], v[84:87]
.Lpad24:
s_cbranch_execz .Lnopoll78r
ds_read_b64_tr_b16 a[18:19], v10 offset:17408
ds_read_b64_tr_b16 a[20:21], v10 offset:16928
v_mfma_f32_16x16x32_bf16 v[68:71], a[52:55], v[104:107], v[68:71]
ds_read_b64_tr_b16 a[22:23], v10 offset:17440
v_mfma_f32_16x16x32_bf16 v[72:75], a[56:59], v[104:107], v[72:75]
buffer_load_dwordx4 v[156:159], v4, s[16:19], s52 offen offset:1024 sc1
v_mfma_f32_16x16x32_bf16 v[88:91], a[56:59], v[108:111], v[88:91]
ds_read_b64_tr_b16 a[24:25], v10 offset:16960
s_add_u32 s52, s52, 0x20000
v_mfma_f32_16x16x32_bf16 v[92:95], a[60:63], v[108:111], v[92:95]
ds_read_b64_tr_b16 a[26:27], v10 offset:17472
ds_read_b64_tr_b16 a[28:29], v10 offset:16992
v_mfma_f32_16x16x32_bf16 v[76:79], a[60:63], v[104:107], v[76:79]
ds_read_b64_tr_b16 a[30:31], v10 offset:17504
s_waitcnt vmcnt(20) lgkmcnt(8)
s_barrier
v_mfma_f32_16x16x32_bf16 v[32:35], a[0:3], v[112:115], v[32:35]
ds_read_b64_tr_b16 a[32:33], v7 offset:25344
s_add_u32 m0, s55, 0
v_mfma_f32_16x16x32_bf16 v[48:51], a[0:3], v[116:119], v[48:51]
buffer_load_dwordx4 v5, s[28:31], s54 offen lds
v_mfma_f32_16x16x32_bf16 v[52:55], a[4:7], v[116:119], v[52:55]
ds_read_b64_tr_b16 a[34:35], v7 offset:25856
ds_read_b64_tr_b16 a[36:37], v7 offset:25376
v_mfma_f32_16x16x32_bf16 v[36:39], a[4:7], v[112:115], v[36:39]
ds_read_b64_tr_b16 a[38:39], v7 offset:25888
v_mfma_f32_16x16x32_bf16 v[40:43], a[8:11], v[112:115], v[40:43]
buffer_load_dwordx4 v[96:99], v4, s[16:19], s52 offen sc1
v_mfma_f32_16x16x32_bf16 v[56:59], a[8:11], v[116:119], v[56:59]
ds_read_b64_tr_b16 a[40:41], v7 offset:25408
ds_read_b64_tr_b16 a[42:43], v7 offset:25920
v_mfma_f32_16x16x32_bf16 v[60:63], a[12:15], v[116:119], v[60:63]
ds_read_b64_tr_b16 a[44:45], v7 offset:25440
ds_read_b64_tr_b16 a[46:47], v7 offset:25952
v_mfma_f32_16x16x32_bf16 v[44:47], a[12:15], v[112:115], v[44:47]
s_waitcnt lgkmcnt(8)
v_mfma_f32_16x16x32_bf16 v[64:67], a[16:19], v[112:115], v[64:67]
buffer_load_dwordx4 v6, s[28:31], s54 offen offset:1056 lds
v_mfma_f32_16x16x32_bf16 v[80:83], a[16:19], v[116:119], v[80:83]
ds_read_b64_tr_b16 a[48:49], v10 offset:25344
s_add_u32 s54, s54, 0x10000
v_mfma_f32_16x16x32_bf16 v[84:87], a[20:23], v[116:119], v[84:87]
ds_read_b64_tr_b16 a[50:51], v10 offset:25856
ds_read_b64_tr_b16 a[52:53], v10 offset:25376
v_mfma_f32_16x16x32_bf16 v[68:71], a[20:23], v[112:115], v[68:71]
ds_read_b64_tr_b16 a[54:55], v10 offset:25888
v_mfma_f32_16x16x32_bf16 v[72:75], a[24:27], v[112:115], v[72:75]
buffer_load_dwordx4 v[100:103], v4, s[16:19], s52 offen offset:1024 sc1
v_mfma_f32_16x16x32_bf16 v[88:91], a[24:27], v[116:119], v[88:91]
ds_read_b64_tr_b16 a[56:57], v10 offset:25408
s_add_u32 s52, s52, 0x20000
v_mfma_f32_16x16x32_bf16 v[92:95], a[28:31], v[116:119], v[92:95]
ds_read_b64_tr_b16 a[58:59], v10 offset:25920
ds_read_b64_tr_b16 a[60:61], v10 offset:25440
v_mfma_f32_16x16x32_bf16 v[76:79], a[28:31], v[112:115], v[76:79]
ds_read_b64_tr_b16 a[62:63], v10 offset:25952
s_waitcnt vmcnt(20) lgkmcnt(8)
v_mfma_f32_16x16x32_bf16 v[32:35], a[32:35], v[120:123], v[32:35]
ds_read_b64_tr_b16 a[0:1], v7 offset:33792
s_add_u32 m0, s55, 8448
v_mfma_f32_16x16x32_bf16 v[48:51], a[32:35], v[124:127], v[48:51]
buffer_load_dwordx4 v5, s[28:31], s54 offen lds
v_mfma_f32_16x16x32_bf16 v[52:55], a[36:39], v[124:127], v[52:55]
ds_read_b64_tr_b16 a[2:3], v7 offset:34304
ds_read_b64_tr_b16 a[4:5], v7 offset:33824
v_mfma_f32_16x16x32_bf16 v[36:39], a[36:39], v[120:123], v[36:39]
ds_read_b64_tr_b16 a[6:7], v7 offset:34336
v_mfma_f32_16x16x32_bf16 v[40:43], a[40:43], v[120:123], v[40:43]
buffer_load_dwordx4 v[104:107], v4, s[16:19], s52 offen sc1
v_mfma_f32_16x16x32_bf16 v[56:59], a[40:43], v[124:127], v[56:59]
ds_read_b64_tr_b16 a[8:9], v7 offset:33856
ds_read_b64_tr_b16 a[10:11], v7 offset:34368
v_mfma_f32_16x16x32_bf16 v[60:63], a[44:47], v[124:127], v[60:63]
ds_read_b64_tr_b16 a[12:13], v7 offset:33888
ds_read_b64_tr_b16 a[14:15], v7 offset:34400
v_mfma_f32_16x16x32_bf16 v[44:47], a[44:47], v[120:123], v[44:47]
s_waitcnt lgkmcnt(8)
v_mfma_f32_16x16x32_bf16 v[64:67], a[48:51], v[120:123], v[64:67]
buffer_load_dwordx4 v6, s[28:31], s54 offen offset:1056 lds
v_mfma_f32_16x16x32_bf16 v[80:83], a[48:51], v[124:127], v[80:83]
ds_read_b64_tr_b16 a[16:17], v10 offset:33792
s_add_u32 s54, s54, 0x10000
v_mfma_f32_16x16x32_bf16 v[84:87], a[52:55], v[124:127], v[84:87]
ds_read_b64_tr_b16 a[18:19], v10 offset:34304
ds_read_b64_tr_b16 a[20:21], v10 offset:33824
v_mfma_f32_16x16x32_bf16 v[68:71], a[52:55], v[120:123], v[68:71]
ds_read_b64_tr_b16 a[22:23], v10 offset:34336
v_mfma_f32_16x16x32_bf16 v[72:75], a[56:59], v[120:123], v[72:75]
buffer_load_dwordx4 v[108:111], v4, s[16:19], s52 offen offset:1024 sc1
v_mfma_f32_16x16x32_bf16 v[88:91], a[56:59], v[124:127], v[88:91]
ds_read_b64_tr_b16 a[24:25], v10 offset:33856
s_add_u32 s52, s52, 0x20000
v_mfma_f32_16x16x32_bf16 v[92:95], a[60:63], v[124:127], v[92:95]
ds_read_b64_tr_b16 a[26:27], v10 offset:34368
ds_read_b64_tr_b16 a[28:29], v10 offset:33888
v_mfma_f32_16x16x32_bf16 v[76:79], a[60:63], v[120:123], v[76:79]
ds_read_b64_tr_b16 a[30:31], v10 offset:34400
s_waitcnt vmcnt(20) lgkmcnt(8)
s_barrier
v_mfma_f32_16x16x32_bf16 v[32:35], a[0:3], v[128:131], v[32:35]
ds_read_b64_tr_b16 a[32:33], v7 offset:42240
s_add_u32 m0, s55, 16896
v_mfma_f32_16x16x32_bf16 v[48:51], a[0:3], v[132:135], v[48:51]
buffer_load_dwordx4 v5, s[28:31], s54 offen lds
v_mfma_f32_16x16x32_bf16 v[52:55], a[4:7], v[132:135], v[52:55]
ds_read_b64_tr_b16 a[34:35], v7 offset:42752
ds_read_b64_tr_b16 a[36:37], v7 offset:42272
v_mfma_f32_16x16x32_bf16 v[36:39], a[4:7], v[128:131], v[36:39]
ds_read_b64_tr_b16 a[38:39], v7 offset:42784
v_mfma_f32_16x16x32_bf16 v[40:43], a[8:11], v[128:131], v[40:43]
buffer_load_dwordx4 v[112:115], v4, s[16:19], s52 offen sc1
v_mfma_f32_16x16x32_bf16 v[56:59], a[8:11], v[132:135], v[56:59]
ds_read_b64_tr_b16 a[40:41], v7 offset:42304
ds_read_b64_tr_b16 a[42:43], v7 offset:42816
v_mfma_f32_16x16x32_bf16 v[60:63], a[12:15], v[132:135], v[60:63]
ds_read_b64_tr_b16 a[44:45], v7 offset:42336
ds_read_b64_tr_b16 a[46:47], v7 offset:42848
v_mfma_f32_16x16x32_bf16 v[44:47], a[12:15], v[128:131], v[44:47]
s_waitcnt lgkmcnt(8)
v_mfma_f32_16x16x32_bf16 v[64:67], a[16:19], v[128:131], v[64:67]
buffer_load_dwordx4 v6, s[28:31], s54 offen offset:1056 lds
v_mfma_f32_16x16x32_bf16 v[80:83], a[16:19], v[132:135], v[80:83]
ds_read_b64_tr_b16 a[48:49], v10 offset:42240
s_add_u32 s54, s54, 0x10000
v_mfma_f32_16x16x32_bf16 v[84:87], a[20:23], v[132:135], v[84:87]
ds_read_b64_tr_b16 a[50:51], v10 offset:42752
ds_read_b64_tr_b16 a[52:53], v10 offset:42272
v_mfma_f32_16x16x32_bf16 v[68:71], a[20:23], v[128:131], v[68:71]
ds_read_b64_tr_b16 a[54:55], v10 offset:42784
v_mfma_f32_16x16x32_bf16 v[72:75], a[24:27], v[128:131], v[72:75]
buffer_load_dwordx4 v[116:119], v4, s[16:19], s52 offen offset:1024 sc1
v_mfma_f32_16x16x32_bf16 v[88:91], a[24:27], v[132:135], v[88:91]
ds_read_b64_tr_b16 a[56:57], v10 offset:42304
s_add_u32 s52, s52, 0x20000
v_mfma_f32_16x16x32_bf16 v[92:95], a[28:31], v[132:135], v[92:95]
ds_read_b64_tr_b16 a[58:59], v10 offset:42816
ds_read_b64_tr_b16 a[60:61], v10 offset:42336
v_mfma_f32_16x16x32_bf16 v[76:79], a[28:31], v[128:131], v[76:79]
ds_read_b64_tr_b16 a[62:63], v10 offset:42848
s_waitcnt vmcnt(20) lgkmcnt(8)
v_mfma_f32_16x16x32_bf16 v[32:35], a[32:35], v[136:139], v[32:35]
ds_read_b64_tr_b16 a[0:1], v7 offset:50688
s_add_u32 m0, s55, 25344
v_mfma_f32_16x16x32_bf16 v[48:51], a[32:35], v[140:143], v[48:51]
buffer_load_dwordx4 v5, s[28:31], s54 offen lds
v_mfma_f32_16x16x32_bf16 v[52:55], a[36:39], v[140:143], v[52:55]
ds_read_b64_tr_b16 a[2:3], v7 offset:51200
ds_read_b64_tr_b16 a[4:5], v7 offset:50720
v_mfma_f32_16x16x32_bf16 v[36:39], a[36:39], v[136:139], v[36:39]
ds_read_b64_tr_b16 a[6:7], v7 offset:51232
v_mfma_f32_16x16x32_bf16 v[40:43], a[40:43], v[136:139], v[40:43]
buffer_load_dwordx4 v[120:123], v4, s[16:19], s52 offen sc1
v_mfma_f32_16x16x32_bf16 v[56:59], a[40:43], v[140:143], v[56:59]
ds_read_b64_tr_b16 a[8:9], v7 offset:50752
ds_read_b64_tr_b16 a[10:11], v7 offset:51264
v_mfma_f32_16x16x32_bf16 v[60:63], a[44:47], v[140:143], v[60:63]
ds_read_b64_tr_b16 a[12:13], v7 offset:50784
ds_read_b64_tr_b16 a[14:15], v7 offset:51296
v_mfma_f32_16x16x32_bf16 v[44:47], a[44:47], v[136:139], v[44:47]
s_waitcnt lgkmcnt(8)
v_mfma_f32_16x16x32_bf16 v[64:67], a[48:51], v[136:139], v[64:67]
buffer_load_dwordx4 v6, s[28:31], s54 offen offset:1056 lds
v_mfma_f32_16x16x32_bf16 v[80:83], a[48:51], v[140:143], v[80:83]
ds_read_b64_tr_b16 a[16:17], v10 offset:50688
s_add_u32 s54, s54, 0x10000
v_mfma_f32_16x16x32_bf16 v[84:87], a[52:55], v[140:143], v[84:87]
ds_read_b64_tr_b16 a[18:19], v10 offset:51200
ds_read_b64_tr_b16 a[20:21], v10 offset:50720
v_mfma_f32_16x16x32_bf16 v[68:71], a[52:55], v[136:139], v[68:71]
ds_read_b64_tr_b16 a[22:23], v10 offset:51232
v_mfma_f32_16x16x32_bf16 v[72:75], a[56:59], v[136:139], v[72:75]
buffer_load_dwordx4 v[124:127], v4, s[16:19], s52 offen offset:1024 sc1
v_mfma_f32_16x16x32_bf16 v[88:91], a[56:59], v[140:143], v[88:91]
ds_read_b64_tr_b16 a[24:25], v10 offset:50752
s_add_u32 s52, s52, 0x20000
v_mfma_f32_16x16x32_bf16 v[92:95], a[60:63], v[140:143], v[92:95]
ds_read_b64_tr_b16 a[26:27], v10 offset:51264
ds_read_b64_tr_b16 a[28:29], v10 offset:50784
v_mfma_f32_16x16x32_bf16 v[76:79], a[60:63], v[136:139], v[76:79]
ds_read_b64_tr_b16 a[30:31], v10 offset:51296
s_waitcnt vmcnt(20) lgkmcnt(8)
s_barrier
v_mfma_f32_16x16x32_bf16 v[32:35], a[0:3], v[144:147], v[32:35]
ds_read_b64_tr_b16 a[32:33], v7 offset:59136
s_add_u32 m0, s55, 33792
v_mfma_f32_16x16x32_bf16 v[48:51], a[0:3], v[148:151], v[48:51]
buffer_load_dwordx4 v5, s[28:31], s54 offen lds
v_mfma_f32_16x16x32_bf16 v[52:55], a[4:7], v[148:151], v[52:55]
ds_read_b64_tr_b16 a[34:35], v7 offset:59648
ds_read_b64_tr_b16 a[36:37], v7 offset:59168
v_mfma_f32_16x16x32_bf16 v[36:39], a[4:7], v[144:147], v[36:39]
ds_read_b64_tr_b16 a[38:39], v7 offset:59680
v_mfma_f32_16x16x32_bf16 v[40:43], a[8:11], v[144:147], v[40:43]
buffer_load_dwordx4 v[128:131], v4, s[16:19], s52 offen sc1
v_mfma_f32_16x16x32_bf16 v[56:59], a[8:11], v[148:151], v[56:59]
ds_read_b64_tr_b16 a[40:41], v7 offset:59200
ds_read_b64_tr_b16 a[42:43], v7 offset:59712
v_mfma_f32_16x16x32_bf16 v[60:63], a[12:15], v[148:151], v[60:63]
ds_read_b64_tr_b16 a[44:45], v7 offset:59232
ds_read_b64_tr_b16 a[46:47], v7 offset:59744
v_mfma_f32_16x16x32_bf16 v[44:47], a[12:15], v[144:147], v[44:47]
s_waitcnt lgkmcnt(8)
v_mfma_f32_16x16x32_bf16 v[64:67], a[16:19], v[144:147], v[64:67]
buffer_load_dwordx4 v6, s[28:31], s54 offen offset:1056 lds
v_mfma_f32_16x16x32_bf16 v[80:83], a[16:19], v[148:151], v[80:83]
ds_read_b64_tr_b16 a[48:49], v10 offset:59136
s_add_u32 s54, s54, 0x10000
v_mfma_f32_16x16x32_bf16 v[84:87], a[20:23], v[148:151], v[84:87]
ds_read_b64_tr_b16 a[50:51], v10 offset:59648
ds_read_b64_tr_b16 a[52:53], v10 offset:59168
v_mfma_f32_16x16x32_bf16 v[68:71], a[20:23], v[144:147], v[68:71]
ds_read_b64_tr_b16 a[54:55], v10 offset:59680
v_mfma_f32_16x16x32_bf16 v[72:75], a[24:27], v[144:147], v[72:75]
buffer_load_dwordx4 v[132:135], v4, s[16:19], s52 offen offset:1024 sc1
v_mfma_f32_16x16x32_bf16 v[88:91], a[24:27], v[148:151], v[88:91]
ds_read_b64_tr_b16 a[56:57], v10 offset:59200
s_add_u32 s52, s52, 0x20000
v_mfma_f32_16x16x32_bf16 v[92:95], a[28:31], v[148:151], v[92:95]
ds_read_b64_tr_b16 a[58:59], v10 offset:59712
ds_read_b64_tr_b16 a[60:61], v10 offset:59232
v_mfma_f32_16x16x32_bf16 v[76:79], a[28:31], v[144:147], v[76:79]
ds_read_b64_tr_b16 a[62:63], v10 offset:59744
v_add_u32 v7, s57, v7
v_add_u32 v10, s57, v10
s_sub_u32 s57, 0, s57
s_waitcnt vmcnt(20) lgkmcnt(8)
v_mfma_f32_16x16x32_bf16 v[32:35], a[32:35], v[152:155], v[32:35]
ds_read_b64_tr_b16 a[0:1], v10
s_add_u32 m0, s55, 42240
v_mfma_f32_16x16x32_bf16 v[48:51], a[32:35], v[156:159], v[48:51]
buffer_load_dwordx4 v5, s[28:31], s54 offen lds
v_mfma_f32_16x16x32_bf16 v[52:55], a[36:39], v[156:159], v[52:55]
ds_read_b64_tr_b16 a[2:3], v10 offset:512
ds_read_b64_tr_b16 a[4:5], v10 offset:32
v_mfma_f32_16x16x32_bf16 v[36:39], a[36:39], v[152:155], v[36:39]
ds_read_b64_tr_b16 a[6:7], v10 offset:544
v_mfma_f32_16x16x32_bf16 v[40:43], a[40:43], v[152:155], v[40:43]
buffer_load_dwordx4 v[136:139], v4, s[16:19], s52 offen sc1
v_mfma_f32_16x16x32_bf16 v[56:59], a[40:43], v[156:159], v[56:59]
ds_read_b64_tr_b16 a[8:9], v10 offset:64
ds_read_b64_tr_b16 a[10:11], v10 offset:576
v_mfma_f32_16x16x32_bf16 v[60:63], a[44:47], v[156:159], v[60:63]
ds_read_b64_tr_b16 a[12:13], v10 offset:96
ds_read_b64_tr_b16 a[14:15], v10 offset:608
v_mfma_f32_16x16x32_bf16 v[44:47], a[44:47], v[152:155], v[44:47]
s_waitcnt lgkmcnt(8)
v_mfma_f32_16x16x32_bf16 v[64:67], a[48:51], v[152:155], v[64:67]
buffer_load_dwordx4 v6, s[28:31], s54 offen offset:1056 lds
v_mfma_f32_16x16x32_bf16 v[80:83], a[48:51], v[156:159], v[80:83]
ds_read_b64_tr_b16 a[16:17], v10 offset:8448
s_add_u32 s54, s54, 0x10000
v_mfma_f32_16x16x32_bf16 v[84:87], a[52:55], v[156:159], v[84:87]
ds_read_b64_tr_b16 a[18:19], v10 offset:8960
ds_read_b64_tr_b16 a[20:21], v10 offset:8480
v_mfma_f32_16x16x32_bf16 v[68:71], a[52:55], v[152:155], v[68:71]
ds_read_b64_tr_b16 a[22:23], v10 offset:8992
v_mfma_f32_16x16x32_bf16 v[72:75], a[56:59], v[152:155], v[72:75]
buffer_load_dwordx4 v[140:143], v4, s[16:19], s52 offen offset:1024 sc1
v_mfma_f32_16x16x32_bf16 v[88:91], a[56:59], v[156:159], v[88:91]
ds_read_b64_tr_b16 a[24:25], v10 offset:8512
s_add_u32 s52, s52, 0x20000
v_mfma_f32_16x16x32_bf16 v[92:95], a[60:63], v[156:159], v[92:95]
ds_read_b64_tr_b16 a[26:27], v10 offset:9024
ds_read_b64_tr_b16 a[28:29], v10 offset:8544
v_mfma_f32_16x16x32_bf16 v[76:79], a[60:63], v[152:155], v[76:79]
ds_read_b64_tr_b16 a[30:31], v10 offset:9056
s_mov_b32 s62, s55
s_mov_b32 s55, s56
s_mov_b32 s56, s62
s_waitcnt vmcnt(20) lgkmcnt(8)
s_barrier
v_mfma_f32_16x16x32_bf16 v[64:67], a[0:3], v[96:99], v[64:67]
ds_read_b64_tr_b16 a[32:33], v10 offset:16896
ds_read_b64_tr_b16 a[34:35], v10 offset:17408
s_add_u32 m0, s56, 50688
v_mfma_f32_16x16x32_bf16 v[80:83], a[0:3], v[100:103], v[80:83]
ds_read_b64_tr_b16 a[36:37], v10 offset:16928
buffer_load_dwordx4 v5, s[28:31], s54 offen lds
v_mfma_f32_16x16x32_bf16 v[84:87], a[4:7], v[100:103], v[84:87]
buffer_load_dwordx4 v6, s[28:31], s54 offen offset:1056 lds
v_mfma_f32_16x16x32_bf16 v[68:71], a[4:7], v[96:99], v[68:71]
ds_read_b64_tr_b16 a[38:39], v10 offset:17440
ds_read_b64_tr_b16 a[40:41], v10 offset:16960
s_add_u32 s54, s54, 0x10000
v_mfma_f32_16x16x32_bf16 v[72:75], a[8:11], v[96:99], v[72:75]
buffer_load_dwordx4 v[144:147], v4, s[16:19], s52 offen sc1
v_mfma_f32_16x16x32_bf16 v[88:91], a[8:11], v[100:103], v[88:91]
ds_read_b64_tr_b16 a[42:43], v10 offset:17472
ds_read_b64_tr_b16 a[44:45], v10 offset:16992
v_mfma_f32_16x16x32_bf16 v[92:95], a[12:15], v[100:103], v[92:95]
buffer_load_dwordx4 v[148:151], v4, s[16:19], s52 offen offset:1024 sc1
v_mfma_f32_16x16x32_bf16 v[76:79], a[12:15], v[96:99], v[76:79]
ds_read_b64_tr_b16 a[46:47], v10 offset:17504
s_add_u32 s52, s52, 0x20000
s_add_u32 m0, s56, 59136
s_waitcnt vmcnt(20) lgkmcnt(8)
v_mfma_f32_16x16x32_bf16 v[64:67], a[16:19], v[104:107], v[64:67]
ds_read_b64_tr_b16 a[48:49], v10 offset:25344
buffer_load_dwordx4 v5, s[28:31], s54 offen lds
v_mfma_f32_16x16x32_bf16 v[80:83], a[16:19], v[108:111], v[80:83]
ds_read_b64_tr_b16 a[50:51], v10 offset:25856
v_mfma_f32_16x16x32_bf16 v[84:87], a[20:23], v[108:111], v[84:87]
ds_read_b64_tr_b16 a[52:53], v10 offset:25376
buffer_load_dwordx4 v6, s[28:31], s54 offen offset:1056 lds
v_mfma_f32_16x16x32_bf16 v[68:71], a[20:23], v[104:107], v[68:71]
ds_read_b64_tr_b16 a[54:55], v10 offset:25888
s_add_u32 s54, s54, 0x10000
v_mfma_f32_16x16x32_bf16 v[72:75], a[24:27], v[104:107], v[72:75]
ds_read_b64_tr_b16 a[56:57], v10 offset:25408
buffer_load_dwordx4 v[152:155], v4, s[16:19], s52 offen sc1
v_mfma_f32_16x16x32_bf16 v[88:91], a[24:27], v[108:111], v[88:91]
ds_read_b64_tr_b16 a[58:59], v10 offset:25920
v_mfma_f32_16x16x32_bf16 v[92:95], a[28:31], v[108:111], v[92:95]
ds_read_b64_tr_b16 a[60:61], v10 offset:25440
buffer_load_dwordx4 v[156:159], v4, s[16:19], s52 offen offset:1024 sc1
v_mfma_f32_16x16x32_bf16 v[76:79], a[28:31], v[104:107], v[76:79]
ds_read_b64_tr_b16 a[62:63], v10 offset:25952
s_add_u32 s52, s52, 0x20000
s_waitcnt vmcnt(20) lgkmcnt(8)
v_mfma_f32_16x16x32_bf16 v[64:67], a[32:35], v[112:115], v[64:67]
ds_read_b64_tr_b16 a[0:1], v10 offset:33792
ds_read_b64_tr_b16 a[2:3], v10 offset:34304
v_mfma_f32_16x16x32_bf16 v[80:83], a[32:35], v[116:119], v[80:83]
buffer_load_dwordx4 v[160:163], v4, s[16:19], s52 offen sc1
v_mfma_f32_16x16x32_bf16 v[84:87], a[36:39], v[116:119], v[84:87]
ds_read_b64_tr_b16 a[4:5], v10 offset:33824
ds_read_b64_tr_b16 a[6:7], v10 offset:34336
v_mfma_f32_16x16x32_bf16 v[68:71], a[36:39], v[112:115], v[68:71]
ds_read_b64_tr_b16 a[8:9], v10 offset:33856
v_mfma_f32_16x16x32_bf16 v[72:75], a[40:43], v[112:115], v[72:75]
buffer_load_dwordx4 v[164:167], v4, s[16:19], s52 offen offset:1024 sc1
v_mfma_f32_16x16x32_bf16 v[88:91], a[40:43], v[116:119], v[88:91]
ds_read_b64_tr_b16 a[10:11], v10 offset:34368
s_add_u32 s52, s52, 0x20000
v_mfma_f32_16x16x32_bf16 v[92:95], a[44:47], v[116:119], v[92:95]
ds_read_b64_tr_b16 a[12:13], v10 offset:33888
v_mfma_f32_16x16x32_bf16 v[76:79], a[44:47], v[112:115], v[76:79]
ds_read_b64_tr_b16 a[14:15], v10 offset:34400
s_waitcnt vmcnt(18) lgkmcnt(8)
v_mfma_f32_16x16x32_bf16 v[64:67], a[48:51], v[120:123], v[64:67]
buffer_load_dwordx4 v[168:171], v4, s[16:19], s52 offen sc1
v_mfma_f32_16x16x32_bf16 v[80:83], a[48:51], v[124:127], v[80:83]
ds_read_b64_tr_b16 a[16:17], v10 offset:42240
ds_read_b64_tr_b16 a[18:19], v10 offset:42752
v_mfma_f32_16x16x32_bf16 v[84:87], a[52:55], v[124:127], v[84:87]
ds_read_b64_tr_b16 a[20:21], v10 offset:42272
v_mfma_f32_16x16x32_bf16 v[68:71], a[52:55], v[120:123], v[68:71]
ds_read_b64_tr_b16 a[22:23], v10 offset:42784
ds_read_b64_tr_b16 a[24:25], v10 offset:42304
v_mfma_f32_16x16x32_bf16 v[72:75], a[56:59], v[120:123], v[72:75]
buffer_load_dwordx4 v[172:175], v4, s[16:19], s52 offen offset:1024 sc1
v_mfma_f32_16x16x32_bf16 v[88:91], a[56:59], v[124:127], v[88:91]
s_add_u32 s52, s52, 0x20000
v_mfma_f32_16x16x32_bf16 v[92:95], a[60:63], v[124:127], v[92:95]
ds_read_b64_tr_b16 a[26:27], v10 offset:42816
ds_read_b64_tr_b16 a[28:29], v10 offset:42336
v_mfma_f32_16x16x32_bf16 v[76:79], a[60:63], v[120:123], v[76:79]
ds_read_b64_tr_b16 a[30:31], v10 offset:42848
s_waitcnt vmcnt(16) lgkmcnt(8)
v_mfma_f32_16x16x32_bf16 v[64:67], a[0:3], v[128:131], v[64:67]
ds_read_b64_tr_b16 a[32:33], v10 offset:50688
ds_read_b64_tr_b16 a[34:35], v10 offset:51200
v_mfma_f32_16x16x32_bf16 v[80:83], a[0:3], v[132:135], v[80:83]
buffer_load_dwordx4 v[176:179], v4, s[16:19], s52 offen sc1
v_mfma_f32_16x16x32_bf16 v[84:87], a[4:7], v[132:135], v[84:87]
ds_read_b64_tr_b16 a[36:37], v10 offset:50720
ds_read_b64_tr_b16 a[38:39], v10 offset:51232
v_mfma_f32_16x16x32_bf16 v[68:71], a[4:7], v[128:131], v[68:71]
ds_read_b64_tr_b16 a[40:41], v10 offset:50752
v_mfma_f32_16x16x32_bf16 v[72:75], a[8:11], v[128:131], v[72:75]
buffer_load_dwordx4 v[180:183], v4, s[16:19], s52 offen offset:1024 sc1
v_mfma_f32_16x16x32_bf16 v[88:91], a[8:11], v[132:135], v[88:91]
ds_read_b64_tr_b16 a[42:43], v10 offset:51264
s_add_u32 s52, s52, 0x20000
v_mfma_f32_16x16x32_bf16 v[92:95], a[12:15], v[132:135], v[92:95]
ds_read_b64_tr_b16 a[44:45], v10 offset:50784
v_mfma_f32_16x16x32_bf16 v[76:79], a[12:15], v[128:131], v[76:79]
ds_read_b64_tr_b16 a[46:47], v10 offset:51296
s_waitcnt vmcnt(14) lgkmcnt(8)
v_mfma_f32_16x16x32_bf16 v[64:67], a[16:19], v[136:139], v[64:67]
buffer_load_dwordx4 v[184:187], v4, s[16:19], s52 offen sc1
v_mfma_f32_16x16x32_bf16 v[80:83], a[16:19], v[140:143], v[80:83]
ds_read_b64_tr_b16 a[48:49], v10 offset:59136
ds_read_b64_tr_b16 a[50:51], v10 offset:59648
v_mfma_f32_16x16x32_bf16 v[84:87], a[20:23], v[140:143], v[84:87]
ds_read_b64_tr_b16 a[52:53], v10 offset:59168
v_mfma_f32_16x16x32_bf16 v[68:71], a[20:23], v[136:139], v[68:71]
ds_read_b64_tr_b16 a[54:55], v10 offset:59680
ds_read_b64_tr_b16 a[56:57], v10 offset:59200
v_mfma_f32_16x16x32_bf16 v[72:75], a[24:27], v[136:139], v[72:75]
buffer_load_dwordx4 v[188:191], v4, s[16:19], s52 offen offset:1024 sc1
v_mfma_f32_16x16x32_bf16 v[88:91], a[24:27], v[140:143], v[88:91]
s_add_u32 s52, s52, 0x20000
v_mfma_f32_16x16x32_bf16 v[92:95], a[28:31], v[140:143], v[92:95]
ds_read_b64_tr_b16 a[58:59], v10 offset:59712
ds_read_b64_tr_b16 a[60:61], v10 offset:59232
v_mfma_f32_16x16x32_bf16 v[76:79], a[28:31], v[136:139], v[76:79]
ds_read_b64_tr_b16 a[62:63], v10 offset:59744
s_waitcnt vmcnt(10) lgkmcnt(8)
s_barrier
v_add_u32 v10, s57, v10
v_mfma_f32_16x16x32_bf16 v[64:67], a[32:35], v[144:147], v[64:67]
ds_read_b64_tr_b16 a[0:1], v10
ds_read_b64_tr_b16 a[2:3], v10 offset:512
v_mfma_f32_16x16x32_bf16 v[80:83], a[32:35], v[148:151], v[80:83]
buffer_load_dwordx4 v[192:195], v4, s[16:19], s52 offen sc1
v_mfma_f32_16x16x32_bf16 v[84:87], a[36:39], v[148:151], v[84:87]
ds_read_b64_tr_b16 a[4:5], v10 offset:32
ds_read_b64_tr_b16 a[6:7], v10 offset:544
v_mfma_f32_16x16x32_bf16 v[68:71], a[36:39], v[144:147], v[68:71]
ds_read_b64_tr_b16 a[8:9], v10 offset:64
v_mfma_f32_16x16x32_bf16 v[72:75], a[40:43], v[144:147], v[72:75]
buffer_load_dwordx4 v[196:199], v4, s[16:19], s52 offen offset:1024 sc1
v_mfma_f32_16x16x32_bf16 v[88:91], a[40:43], v[148:151], v[88:91]
ds_read_b64_tr_b16 a[10:11], v10 offset:576
s_add_u32 s52, s52, 0x20000
v_mfma_f32_16x16x32_bf16 v[92:95], a[44:47], v[148:151], v[92:95]
ds_read_b64_tr_b16 a[12:13], v10 offset:96
v_mfma_f32_16x16x32_bf16 v[76:79], a[44:47], v[144:147], v[76:79]
ds_read_b64_tr_b16 a[14:15], v10 offset:608
s_waitcnt vmcnt(10) lgkmcnt(8)
v_mfma_f32_16x16x32_bf16 v[64:67], a[48:51], v[152:155], v[64:67]
buffer_load_dwordx4 v[200:203], v4, s[16:19], s52 offen sc1
v_mfma_f32_16x16x32_bf16 v[80:83], a[48:51], v[156:159], v[80:83]
ds_read_b64_tr_b16 a[16:17], v10 offset:8448
ds_read_b64_tr_b16 a[18:19], v10 offset:8960
v_mfma_f32_16x16x32_bf16 v[84:87], a[52:55], v[156:159], v[84:87]
ds_read_b64_tr_b16 a[20:21], v10 offset:8480
v_mfma_f32_16x16x32_bf16 v[68:71], a[52:55], v[152:155], v[68:71]
ds_read_b64_tr_b16 a[22:23], v10 offset:8992
ds_read_b64_tr_b16 a[24:25], v10 offset:8512
v_mfma_f32_16x16x32_bf16 v[72:75], a[56:59], v[152:155], v[72:75]
buffer_load_dwordx4 v[204:207], v4, s[16:19], s52 offen offset:1024 sc1
v_mfma_f32_16x16x32_bf16 v[88:91], a[56:59], v[156:159], v[88:91]
s_add_u32 s52, s52, 0x20000
v_mfma_f32_16x16x32_bf16 v[92:95], a[60:63], v[156:159], v[92:95]
ds_read_b64_tr_b16 a[26:27], v10 offset:9024
ds_read_b64_tr_b16 a[28:29], v10 offset:8544
v_mfma_f32_16x16x32_bf16 v[76:79], a[60:63], v[152:155], v[76:79]
ds_read_b64_tr_b16 a[30:31], v10 offset:9056
s_waitcnt vmcnt(10) lgkmcnt(8)
v_mfma_f32_16x16x32_bf16 v[64:67], a[0:3], v[160:163], v[64:67]
ds_read_b64_tr_b16 a[32:33], v10 offset:16896
ds_read_b64_tr_b16 a[34:35], v10 offset:17408
v_mfma_f32_16x16x32_bf16 v[80:83], a[0:3], v[164:167], v[80:83]
buffer_load_dwordx4 v[208:211], v4, s[16:19], s52 offen sc1
v_mfma_f32_16x16x32_bf16 v[84:87], a[4:7], v[164:167], v[84:87]
ds_read_b64_tr_b16 a[36:37], v10 offset:16928
ds_read_b64_tr_b16 a[38:39], v10 offset:17440
v_mfma_f32_16x16x32_bf16 v[68:71], a[4:7], v[160:163], v[68:71]
ds_read_b64_tr_b16 a[40:41], v10 offset:16960
v_mfma_f32_16x16x32_bf16 v[72:75], a[8:11], v[160:163], v[72:75]
buffer_load_dwordx4 v[212:215], v4, s[16:19], s52 offen offset:1024 sc1
v_mfma_f32_16x16x32_bf16 v[88:91], a[8:11], v[164:167], v[88:91]
ds_read_b64_tr_b16 a[42:43], v10 offset:17472
s_add_u32 s52, s52, 0x20000
v_mfma_f32_16x16x32_bf16 v[92:95], a[12:15], v[164:167], v[92:95]
ds_read_b64_tr_b16 a[44:45], v10 offset:16992
v_mfma_f32_16x16x32_bf16 v[76:79], a[12:15], v[160:163], v[76:79]
ds_read_b64_tr_b16 a[46:47], v10 offset:17504
s_waitcnt vmcnt(10) lgkmcnt(8)
v_mfma_f32_16x16x32_bf16 v[64:67], a[16:19], v[168:171], v[64:67]
buffer_load_dwordx4 v[216:219], v4, s[16:19], s52 offen sc1
v_mfma_f32_16x16x32_bf16 v[80:83], a[16:19], v[172:175], v[80:83]
ds_read_b64_tr_b16 a[48:49], v10 offset:25344
ds_read_b64_tr_b16 a[50:51], v10 offset:25856
v_mfma_f32_16x16x32_bf16 v[84:87], a[20:23], v[172:175], v[84:87]
ds_read_b64_tr_b16 a[52:53], v10 offset:25376
v_mfma_f32_16x16x32_bf16 v[68:71], a[20:23], v[168:171], v[68:71]
ds_read_b64_tr_b16 a[54:55], v10 offset:25888
ds_read_b64_tr_b16 a[56:57], v10 offset:25408
v_mfma_f32_16x16x32_bf16 v[72:75], a[24:27], v[168:171], v[72:75]
buffer_load_dwordx4 v[220:223], v4, s[16:19], s52 offen offset:1024 sc1
v_mfma_f32_16x16x32_bf16 v[88:91], a[24:27], v[172:175], v[88:91]
s_add_u32 s52, s52, 0x20000
v_mfma_f32_16x16x32_bf16 v[92:95], a[28:31], v[172:175], v[92:95]
ds_read_b64_tr_b16 a[58:59], v10 offset:25920
ds_read_b64_tr_b16 a[60:61], v10 offset:25440
v_mfma_f32_16x16x32_bf16 v[76:79], a[28:31], v[168:171], v[76:79]
ds_read_b64_tr_b16 a[62:63], v10 offset:25952
s_waitcnt vmcnt(10) lgkmcnt(8)
v_mfma_f32_16x16x32_bf16 v[64:67], a[32:35], v[176:179], v[64:67]
ds_read_b64_tr_b16 a[0:1], v10 offset:33792
v_mfma_f32_16x16x32_bf16 v[80:83], a[32:35], v[180:183], v[80:83]
ds_read_b64_tr_b16 a[2:3], v10 offset:34304
v_mfma_f32_16x16x32_bf16 v[84:87], a[36:39], v[180:183], v[84:87]
ds_read_b64_tr_b16 a[4:5], v10 offset:33824
v_mfma_f32_16x16x32_bf16 v[68:71], a[36:39], v[176:179], v[68:71]
ds_read_b64_tr_b16 a[6:7], v10 offset:34336
v_mfma_f32_16x16x32_bf16 v[72:75], a[40:43], v[176:179], v[72:75]
ds_read_b64_tr_b16 a[8:9], v10 offset:33856
v_mfma_f32_16x16x32_bf16 v[88:91], a[40:43], v[180:183], v[88:91]
ds_read_b64_tr_b16 a[10:11], v10 offset:34368
v_mfma_f32_16x16x32_bf16 v[92:95], a[44:47], v[180:183], v[92:95]
ds_read_b64_tr_b16 a[12:13], v10 offset:33888
v_mfma_f32_16x16x32_bf16 v[76:79], a[44:47], v[176:179], v[76:79]
ds_read_b64_tr_b16 a[14:15], v10 offset:34400
s_waitcnt vmcnt(8) lgkmcnt(8)
v_mfma_f32_16x16x32_bf16 v[64:67], a[48:51], v[184:187], v[64:67]
ds_read_b64_tr_b16 a[16:17], v10 offset:42240
v_mfma_f32_16x16x32_bf16 v[80:83], a[48:51], v[188:191], v[80:83]
ds_read_b64_tr_b16 a[18:19], v10 offset:42752
v_mfma_f32_16x16x32_bf16 v[84:87], a[52:55], v[188:191], v[84:87]
ds_read_b64_tr_b16 a[20:21], v10 offset:42272
v_mfma_f32_16x16x32_bf16 v[68:71], a[52:55], v[184:187], v[68:71]
ds_read_b64_tr_b16 a[22:23], v10 offset:42784
v_mfma_f32_16x16x32_bf16 v[72:75], a[56:59], v[184:187], v[72:75]
ds_read_b64_tr_b16 a[24:25], v10 offset:42304
v_mfma_f32_16x16x32_bf16 v[88:91], a[56:59], v[188:191], v[88:91]
ds_read_b64_tr_b16 a[26:27], v10 offset:42816
v_mfma_f32_16x16x32_bf16 v[92:95], a[60:63], v[188:191], v[92:95]
ds_read_b64_tr_b16 a[28:29], v10 offset:42336
v_mfma_f32_16x16x32_bf16 v[76:79], a[60:63], v[184:187], v[76:79]
ds_read_b64_tr_b16 a[30:31], v10 offset:42848
s_waitcnt vmcnt(6) lgkmcnt(8)
v_mfma_f32_16x16x32_bf16 v[64:67], a[0:3], v[192:195], v[64:67]
ds_read_b64_tr_b16 a[32:33], v10 offset:50688
v_mfma_f32_16x16x32_bf16 v[80:83], a[0:3], v[196:199], v[80:83]
ds_read_b64_tr_b16 a[34:35], v10 offset:51200
v_mfma_f32_16x16x32_bf16 v[84:87], a[4:7], v[196:199], v[84:87]
ds_read_b64_tr_b16 a[36:37], v10 offset:50720
v_mfma_f32_16x16x32_bf16 v[68:71], a[4:7], v[192:195], v[68:71]
ds_read_b64_tr_b16 a[38:39], v10 offset:51232
v_mfma_f32_16x16x32_bf16 v[72:75], a[8:11], v[192:195], v[72:75]
ds_read_b64_tr_b16 a[40:41], v10 offset:50752
v_mfma_f32_16x16x32_bf16 v[88:91], a[8:11], v[196:199], v[88:91]
ds_read_b64_tr_b16 a[42:43], v10 offset:51264
v_mfma_f32_16x16x32_bf16 v[92:95], a[12:15], v[196:199], v[92:95]
ds_read_b64_tr_b16 a[44:45], v10 offset:50784
v_mfma_f32_16x16x32_bf16 v[76:79], a[12:15], v[192:195], v[76:79]
ds_read_b64_tr_b16 a[46:47], v10 offset:51296
.Lpad25:
s_cbranch_execz .Lnopoll78r
s_waitcnt vmcnt(4) lgkmcnt(8)
v_mfma_f32_16x16x32_bf16 v[64:67], a[16:19], v[200:203], v[64:67]
ds_read_b64_tr_b16 a[48:49], v10 offset:59136
v_mfma_f32_16x16x32_bf16 v[80:83], a[16:19], v[204:207], v[80:83]
ds_read_b64_tr_b16 a[50:51], v10 offset:59648
v_mfma_f32_16x16x32_bf16 v[84:87], a[20:23], v[204:207], v[84:87]
ds_read_b64_tr_b16 a[52:53], v10 offset:59168
v_mfma_f32_16x16x32_bf16 v[68:71], a[20:23], v[200:203], v[68:71]
ds_read_b64_tr_b16 a[54:55], v10 offset:59680
v_mfma_f32_16x16x32_bf16 v[72:75], a[24:27], v[200:203], v[72:75]
ds_read_b64_tr_b16 a[56:57], v10 offset:59200
v_mfma_f32_16x16x32_bf16 v[88:91], a[24:27], v[204:207], v[88:91]
ds_read_b64_tr_b16 a[58:59], v10 offset:59712
v_mfma_f32_16x16x32_bf16 v[92:95], a[28:31], v[204:207], v[92:95]
ds_read_b64_tr_b16 a[60:61], v10 offset:59232
v_mfma_f32_16x16x32_bf16 v[76:79], a[28:31], v[200:203], v[76:79]
ds_read_b64_tr_b16 a[62:63], v10 offset:59744
s_waitcnt vmcnt(2) lgkmcnt(8)
v_mfma_f32_16x16x32_bf16 v[64:67], a[32:35], v[208:211], v[64:67]
ds_read_b64_tr_b16 a[0:1], v7
v_mfma_f32_16x16x32_bf16 v[80:83], a[32:35], v[212:215], v[80:83]
ds_read_b64_tr_b16 a[2:3], v7 offset:512
v_mfma_f32_16x16x32_bf16 v[84:87], a[36:39], v[212:215], v[84:87]
ds_read_b64_tr_b16 a[4:5], v7 offset:32
v_mfma_f32_16x16x32_bf16 v[68:71], a[36:39], v[208:211], v[68:71]
ds_read_b64_tr_b16 a[6:7], v7 offset:544
v_mfma_f32_16x16x32_bf16 v[72:75], a[40:43], v[208:211], v[72:75]
ds_read_b64_tr_b16 a[8:9], v7 offset:64
v_mfma_f32_16x16x32_bf16 v[88:91], a[40:43], v[212:215], v[88:91]
ds_read_b64_tr_b16 a[10:11], v7 offset:576
v_mfma_f32_16x16x32_bf16 v[92:95], a[44:47], v[212:215], v[92:95]
ds_read_b64_tr_b16 a[12:13], v7 offset:96
v_mfma_f32_16x16x32_bf16 v[76:79], a[44:47], v[208:211], v[76:79]
ds_read_b64_tr_b16 a[14:15], v7 offset:608
s_waitcnt vmcnt(0) lgkmcnt(8)
v_mfma_f32_16x16x32_bf16 v[64:67], a[48:51], v[216:219], v[64:67]
ds_read_b64_tr_b16 a[16:17], v7 offset:8448
v_mfma_f32_16x16x32_bf16 v[80:83], a[48:51], v[220:223], v[80:83]
ds_read_b64_tr_b16 a[18:19], v7 offset:8960
v_mfma_f32_16x16x32_bf16 v[84:87], a[52:55], v[220:223], v[84:87]
ds_read_b64_tr_b16 a[20:21], v7 offset:8480
v_mfma_f32_16x16x32_bf16 v[68:71], a[52:55], v[216:219], v[68:71]
ds_read_b64_tr_b16 a[22:23], v7 offset:8992
v_mfma_f32_16x16x32_bf16 v[72:75], a[56:59], v[216:219], v[72:75]
ds_read_b64_tr_b16 a[24:25], v7 offset:8512
v_mfma_f32_16x16x32_bf16 v[88:91], a[56:59], v[220:223], v[88:91]
ds_read_b64_tr_b16 a[26:27], v7 offset:9024
v_mfma_f32_16x16x32_bf16 v[92:95], a[60:63], v[220:223], v[92:95]
ds_read_b64_tr_b16 a[28:29], v7 offset:8544
v_mfma_f32_16x16x32_bf16 v[76:79], a[60:63], v[216:219], v[76:79]
ds_read_b64_tr_b16 a[30:31], v7 offset:9056
s_waitcnt lgkmcnt(8)
v_mfma_f32_16x16x32_bf16 v[32:35], a[0:3], v[96:99], v[32:35]
ds_read_b64_tr_b16 a[32:33], v7 offset:16896
v_cvt_pk_bf16_f32 v232, v64, v65
v_cvt_pk_bf16_f32 v233, v66, v67
v_mfma_f32_16x16x32_bf16 v[48:51], a[0:3], v[100:103], v[48:51]
ds_read_b64_tr_b16 a[34:35], v7 offset:17408
v_cvt_pk_bf16_f32 v234, v68, v69
v_mfma_f32_16x16x32_bf16 v[52:55], a[4:7], v[100:103], v[52:55]
ds_read_b64_tr_b16 a[36:37], v7 offset:16928
v_cvt_pk_bf16_f32 v235, v70, v71
buffer_store_dwordx4 v[232:235], v11, s[16:19], s69 offen sc1
v_mfma_f32_16x16x32_bf16 v[36:39], a[4:7], v[96:99], v[36:39]
ds_read_b64_tr_b16 a[38:39], v7 offset:17440
s_add_u32 s69, s69, 131072
v_mfma_f32_16x16x32_bf16 v[40:43], a[8:11], v[96:99], v[40:43]
ds_read_b64_tr_b16 a[40:41], v7 offset:16960
v_cvt_pk_bf16_f32 v236, v72, v73
v_cvt_pk_bf16_f32 v237, v74, v75
v_mfma_f32_16x16x32_bf16 v[56:59], a[8:11], v[100:103], v[56:59]
ds_read_b64_tr_b16 a[42:43], v7 offset:17472
v_cvt_pk_bf16_f32 v238, v76, v77
v_mfma_f32_16x16x32_bf16 v[60:63], a[12:15], v[100:103], v[60:63]
ds_read_b64_tr_b16 a[44:45], v7 offset:16992
v_cvt_pk_bf16_f32 v239, v78, v79
buffer_store_dwordx4 v[236:239], v11, s[16:19], s69 offen sc1
v_mfma_f32_16x16x32_bf16 v[44:47], a[12:15], v[96:99], v[44:47]
ds_read_b64_tr_b16 a[46:47], v7 offset:17504
s_add_u32 s69, s69, -130048
s_waitcnt lgkmcnt(8)
v_mfma_f32_16x16x32_bf16 v[32:35], a[16:19], v[104:107], v[32:35]
ds_read_b64_tr_b16 a[48:49], v7 offset:25344
v_cvt_pk_bf16_f32 v240, v80, v81
v_mfma_f32_16x16x32_bf16 v[48:51], a[16:19], v[108:111], v[48:51]
ds_read_b64_tr_b16 a[50:51], v7 offset:25856
v_cvt_pk_bf16_f32 v241, v82, v83
v_cvt_pk_bf16_f32 v242, v84, v85
v_mfma_f32_16x16x32_bf16 v[52:55], a[20:23], v[108:111], v[52:55]
ds_read_b64_tr_b16 a[52:53], v7 offset:25376
v_cvt_pk_bf16_f32 v243, v86, v87
v_mfma_f32_16x16x32_bf16 v[36:39], a[20:23], v[104:107], v[36:39]
ds_read_b64_tr_b16 a[54:55], v7 offset:25888
buffer_store_dwordx4 v[240:243], v11, s[16:19], s69 offen sc1
s_add_u32 s69, s69, 131072
v_mfma_f32_16x16x32_bf16 v[40:43], a[24:27], v[104:107], v[40:43]
ds_read_b64_tr_b16 a[56:57], v7 offset:25408
v_cvt_pk_bf16_f32 v244, v88, v89
v_mfma_f32_16x16x32_bf16 v[56:59], a[24:27], v[108:111], v[56:59]
ds_read_b64_tr_b16 a[58:59], v7 offset:25920
v_cvt_pk_bf16_f32 v245, v90, v91
v_cvt_pk_bf16_f32 v246, v92, v93
v_mfma_f32_16x16x32_bf16 v[60:63], a[28:31], v[108:111], v[60:63]
ds_read_b64_tr_b16 a[60:61], v7 offset:25440
v_cvt_pk_bf16_f32 v247, v94, v95
v_mfma_f32_16x16x32_bf16 v[44:47], a[28:31], v[104:107], v[44:47]
ds_read_b64_tr_b16 a[62:63], v7 offset:25952
buffer_store_dwordx4 v[244:247], v11, s[16:19], s69 offen sc1
s_waitcnt lgkmcnt(8)
v_mfma_f32_16x16x32_bf16 v[32:35], a[32:35], v[112:115], v[32:35]
ds_read_b64_tr_b16 a[0:1], v7 offset:33792
v_mfma_f32_16x16x32_bf16 v[48:51], a[32:35], v[116:119], v[48:51]
ds_read_b64_tr_b16 a[2:3], v7 offset:34304
v_mfma_f32_16x16x32_bf16 v[52:55], a[36:39], v[116:119], v[52:55]
ds_read_b64_tr_b16 a[4:5], v7 offset:33824
v_mfma_f32_16x16x32_bf16 v[36:39], a[36:39], v[112:115], v[36:39]
ds_read_b64_tr_b16 a[6:7], v7 offset:34336
v_mfma_f32_16x16x32_bf16 v[40:43], a[40:43], v[112:115], v[40:43]
ds_read_b64_tr_b16 a[8:9], v7 offset:33856
v_mfma_f32_16x16x32_bf16 v[56:59], a[40:43], v[116:119], v[56:59]
ds_read_b64_tr_b16 a[10:11], v7 offset:34368
v_mfma_f32_16x16x32_bf16 v[60:63], a[44:47], v[116:119], v[60:63]
ds_read_b64_tr_b16 a[12:13], v7 offset:33888
v_mfma_f32_16x16x32_bf16 v[44:47], a[44:47], v[112:115], v[44:47]
ds_read_b64_tr_b16 a[14:15], v7 offset:34400
s_waitcnt lgkmcnt(8)
v_mfma_f32_16x16x32_bf16 v[32:35], a[48:51], v[120:123], v[32:35]
ds_read_b64_tr_b16 a[16:17], v7 offset:42240
v_mfma_f32_16x16x32_bf16 v[48:51], a[48:51], v[124:127], v[48:51]
ds_read_b64_tr_b16 a[18:19], v7 offset:42752
v_mfma_f32_16x16x32_bf16 v[52:55], a[52:55], v[124:127], v[52:55]
ds_read_b64_tr_b16 a[20:21], v7 offset:42272
v_mfma_f32_16x16x32_bf16 v[36:39], a[52:55], v[120:123], v[36:39]
ds_read_b64_tr_b16 a[22:23], v7 offset:42784
v_mfma_f32_16x16x32_bf16 v[40:43], a[56:59], v[120:123], v[40:43]
ds_read_b64_tr_b16 a[24:25], v7 offset:42304
v_mfma_f32_16x16x32_bf16 v[56:59], a[56:59], v[124:127], v[56:59]
ds_read_b64_tr_b16 a[26:27], v7 offset:42816
v_mfma_f32_16x16x32_bf16 v[60:63], a[60:63], v[124:127], v[60:63]
ds_read_b64_tr_b16 a[28:29], v7 offset:42336
v_mfma_f32_16x16x32_bf16 v[44:47], a[60:63], v[120:123], v[44:47]
ds_read_b64_tr_b16 a[30:31], v7 offset:42848
s_waitcnt lgkmcnt(8)
v_mfma_f32_16x16x32_bf16 v[32:35], a[0:3], v[128:131], v[32:35]
ds_read_b64_tr_b16 a[32:33], v7 offset:50688
v_mfma_f32_16x16x32_bf16 v[48:51], a[0:3], v[132:135], v[48:51]
ds_read_b64_tr_b16 a[34:35], v7 offset:51200
v_mfma_f32_16x16x32_bf16 v[52:55], a[4:7], v[132:135], v[52:55]
ds_read_b64_tr_b16 a[36:37], v7 offset:50720
v_mfma_f32_16x16x32_bf16 v[36:39], a[4:7], v[128:131], v[36:39]
ds_read_b64_tr_b16 a[38:39], v7 offset:51232
v_mfma_f32_16x16x32_bf16 v[40:43], a[8:11], v[128:131], v[40:43]
ds_read_b64_tr_b16 a[40:41], v7 offset:50752
v_mfma_f32_16x16x32_bf16 v[56:59], a[8:11], v[132:135], v[56:59]
ds_read_b64_tr_b16 a[42:43], v7 offset:51264
v_mfma_f32_16x16x32_bf16 v[60:63], a[12:15], v[132:135], v[60:63]
ds_read_b64_tr_b16 a[44:45], v7 offset:50784
v_mfma_f32_16x16x32_bf16 v[44:47], a[12:15], v[128:131], v[44:47]
ds_read_b64_tr_b16 a[46:47], v7 offset:51296
s_waitcnt lgkmcnt(8)
v_mfma_f32_16x16x32_bf16 v[32:35], a[16:19], v[136:139], v[32:35]
ds_read_b64_tr_b16 a[48:49], v7 offset:59136
v_mfma_f32_16x16x32_bf16 v[48:51], a[16:19], v[140:143], v[48:51]
ds_read_b64_tr_b16 a[50:51], v7 offset:59648
v_mfma_f32_16x16x32_bf16 v[52:55], a[20:23], v[140:143], v[52:55]
ds_read_b64_tr_b16 a[52:53], v7 offset:59168
v_mfma_f32_16x16x32_bf16 v[36:39], a[20:23], v[136:139], v[36:39]
ds_read_b64_tr_b16 a[54:55], v7 offset:59680
v_mfma_f32_16x16x32_bf16 v[40:43], a[24:27], v[136:139], v[40:43]
ds_read_b64_tr_b16 a[56:57], v7 offset:59200
v_mfma_f32_16x16x32_bf16 v[56:59], a[24:27], v[140:143], v[56:59]
ds_read_b64_tr_b16 a[58:59], v7 offset:59712
v_mfma_f32_16x16x32_bf16 v[60:63], a[28:31], v[140:143], v[60:63]
ds_read_b64_tr_b16 a[60:61], v7 offset:59232
v_mfma_f32_16x16x32_bf16 v[44:47], a[28:31], v[136:139], v[44:47]
ds_read_b64_tr_b16 a[62:63], v7 offset:59744
v_add_u32 v7, s57, v7
s_waitcnt lgkmcnt(8)
v_mfma_f32_16x16x32_bf16 v[32:35], a[32:35], v[144:147], v[32:35]
ds_read_b64_tr_b16 a[0:1], v7
v_mfma_f32_16x16x32_bf16 v[48:51], a[32:35], v[148:151], v[48:51]
ds_read_b64_tr_b16 a[2:3], v7 offset:512
v_mfma_f32_16x16x32_bf16 v[52:55], a[36:39], v[148:151], v[52:55]
ds_read_b64_tr_b16 a[4:5], v7 offset:32
v_mfma_f32_16x16x32_bf16 v[36:39], a[36:39], v[144:147], v[36:39]
ds_read_b64_tr_b16 a[6:7], v7 offset:544
v_mfma_f32_16x16x32_bf16 v[40:43], a[40:43], v[144:147], v[40:43]
ds_read_b64_tr_b16 a[8:9], v7 offset:64
v_mfma_f32_16x16x32_bf16 v[56:59], a[40:43], v[148:151], v[56:59]
ds_read_b64_tr_b16 a[10:11], v7 offset:576
v_mfma_f32_16x16x32_bf16 v[60:63], a[44:47], v[148:151], v[60:63]
ds_read_b64_tr_b16 a[12:13], v7 offset:96
v_mfma_f32_16x16x32_bf16 v[44:47], a[44:47], v[144:147], v[44:47]
ds_read_b64_tr_b16 a[14:15], v7 offset:608
s_waitcnt lgkmcnt(8)
v_mfma_f32_16x16x32_bf16 v[32:35], a[48:51], v[152:155], v[32:35]
ds_read_b64_tr_b16 a[16:17], v7 offset:8448
v_mfma_f32_16x16x32_bf16 v[48:51], a[48:51], v[156:159], v[48:51]
ds_read_b64_tr_b16 a[18:19], v7 offset:8960
v_mfma_f32_16x16x32_bf16 v[52:55], a[52:55], v[156:159], v[52:55]
ds_read_b64_tr_b16 a[20:21], v7 offset:8480
v_mfma_f32_16x16x32_bf16 v[36:39], a[52:55], v[152:155], v[36:39]
ds_read_b64_tr_b16 a[22:23], v7 offset:8992
v_mfma_f32_16x16x32_bf16 v[40:43], a[56:59], v[152:155], v[40:43]
ds_read_b64_tr_b16 a[24:25], v7 offset:8512
v_mfma_f32_16x16x32_bf16 v[56:59], a[56:59], v[156:159], v[56:59]
ds_read_b64_tr_b16 a[26:27], v7 offset:9024
v_mfma_f32_16x16x32_bf16 v[60:63], a[60:63], v[156:159], v[60:63]
ds_read_b64_tr_b16 a[28:29], v7 offset:8544
v_mfma_f32_16x16x32_bf16 v[44:47], a[60:63], v[152:155], v[44:47]
ds_read_b64_tr_b16 a[30:31], v7 offset:9056
s_waitcnt lgkmcnt(8)
v_mfma_f32_16x16x32_bf16 v[32:35], a[0:3], v[160:163], v[32:35]
ds_read_b64_tr_b16 a[32:33], v7 offset:16896
ds_read_b64_tr_b16 a[34:35], v7 offset:17408
v_mfma_f32_16x16x32_bf16 v[48:51], a[0:3], v[164:167], v[48:51]
s_waitcnt vmcnt(0)
buffer_atomic_add v13, v12, s[16:19], s71 offen
v_mfma_f32_16x16x32_bf16 v[52:55], a[4:7], v[164:167], v[52:55]
ds_read_b64_tr_b16 a[36:37], v7 offset:16928
v_mfma_f32_16x16x32_bf16 v[36:39], a[4:7], v[160:163], v[36:39]
ds_read_b64_tr_b16 a[38:39], v7 offset:17440
v_mfma_f32_16x16x32_bf16 v[40:43], a[8:11], v[160:163], v[40:43]
ds_read_b64_tr_b16 a[40:41], v7 offset:16960
v_mfma_f32_16x16x32_bf16 v[56:59], a[8:11], v[164:167], v[56:59]
ds_read_b64_tr_b16 a[42:43], v7 offset:17472
v_mfma_f32_16x16x32_bf16 v[60:63], a[12:15], v[164:167], v[60:63]
ds_read_b64_tr_b16 a[44:45], v7 offset:16992
v_mfma_f32_16x16x32_bf16 v[44:47], a[12:15], v[160:163], v[44:47]
ds_read_b64_tr_b16 a[46:47], v7 offset:17504
s_waitcnt lgkmcnt(8)
v_mfma_f32_16x16x32_bf16 v[32:35], a[16:19], v[168:171], v[32:35]
ds_read_b64_tr_b16 a[48:49], v7 offset:25344
v_mfma_f32_16x16x32_bf16 v[48:51], a[16:19], v[172:175], v[48:51]
ds_read_b64_tr_b16 a[50:51], v7 offset:25856
v_mfma_f32_16x16x32_bf16 v[52:55], a[20:23], v[172:175], v[52:55]
ds_read_b64_tr_b16 a[52:53], v7 offset:25376
v_mfma_f32_16x16x32_bf16 v[36:39], a[20:23], v[168:171], v[36:39]
ds_read_b64_tr_b16 a[54:55], v7 offset:25888
v_mfma_f32_16x16x32_bf16 v[40:43], a[24:27], v[168:171], v[40:43]
ds_read_b64_tr_b16 a[56:57], v7 offset:25408
v_mfma_f32_16x16x32_bf16 v[56:59], a[24:27], v[172:175], v[56:59]
ds_read_b64_tr_b16 a[58:59], v7 offset:25920
v_mfma_f32_16x16x32_bf16 v[60:63], a[28:31], v[172:175], v[60:63]
ds_read_b64_tr_b16 a[60:61], v7 offset:25440
v_mfma_f32_16x16x32_bf16 v[44:47], a[28:31], v[168:171], v[44:47]
ds_read_b64_tr_b16 a[62:63], v7 offset:25952
s_waitcnt lgkmcnt(8)
v_mfma_f32_16x16x32_bf16 v[32:35], a[32:35], v[176:179], v[32:35]
ds_read_b64_tr_b16 a[0:1], v7 offset:33792
v_mfma_f32_16x16x32_bf16 v[48:51], a[32:35], v[180:183], v[48:51]
ds_read_b64_tr_b16 a[2:3], v7 offset:34304
v_mfma_f32_16x16x32_bf16 v[52:55], a[36:39], v[180:183], v[52:55]
ds_read_b64_tr_b16 a[4:5], v7 offset:33824
v_mfma_f32_16x16x32_bf16 v[36:39], a[36:39], v[176:179], v[36:39]
ds_read_b64_tr_b16 a[6:7], v7 offset:34336
v_mfma_f32_16x16x32_bf16 v[40:43], a[40:43], v[176:179], v[40:43]
ds_read_b64_tr_b16 a[8:9], v7 offset:33856
v_mfma_f32_16x16x32_bf16 v[56:59], a[40:43], v[180:183], v[56:59]
ds_read_b64_tr_b16 a[10:11], v7 offset:34368
v_mfma_f32_16x16x32_bf16 v[60:63], a[44:47], v[180:183], v[60:63]
ds_read_b64_tr_b16 a[12:13], v7 offset:33888
v_mfma_f32_16x16x32_bf16 v[44:47], a[44:47], v[176:179], v[44:47]
ds_read_b64_tr_b16 a[14:15], v7 offset:34400
s_waitcnt lgkmcnt(8)
v_mfma_f32_16x16x32_bf16 v[32:35], a[48:51], v[184:187], v[32:35]
ds_read_b64_tr_b16 a[16:17], v7 offset:42240
v_mfma_f32_16x16x32_bf16 v[48:51], a[48:51], v[188:191], v[48:51]
ds_read_b64_tr_b16 a[18:19], v7 offset:42752
v_mfma_f32_16x16x32_bf16 v[52:55], a[52:55], v[188:191], v[52:55]
ds_read_b64_tr_b16 a[20:21], v7 offset:42272
v_mfma_f32_16x16x32_bf16 v[36:39], a[52:55], v[184:187], v[36:39]
ds_read_b64_tr_b16 a[22:23], v7 offset:42784
v_mfma_f32_16x16x32_bf16 v[40:43], a[56:59], v[184:187], v[40:43]
ds_read_b64_tr_b16 a[24:25], v7 offset:42304
v_mfma_f32_16x16x32_bf16 v[56:59], a[56:59], v[188:191], v[56:59]
ds_read_b64_tr_b16 a[26:27], v7 offset:42816
v_mfma_f32_16x16x32_bf16 v[60:63], a[60:63], v[188:191], v[60:63]
ds_read_b64_tr_b16 a[28:29], v7 offset:42336
v_mfma_f32_16x16x32_bf16 v[44:47], a[60:63], v[184:187], v[44:47]
ds_read_b64_tr_b16 a[30:31], v7 offset:42848
s_waitcnt lgkmcnt(8)
v_mfma_f32_16x16x32_bf16 v[32:35], a[0:3], v[192:195], v[32:35]
ds_read_b64_tr_b16 a[32:33], v7 offset:50688
ds_read_b64_tr_b16 a[34:35], v7 offset:51200
v_mfma_f32_16x16x32_bf16 v[48:51], a[0:3], v[196:199], v[48:51]
buffer_atomic_add v15, v12, s[16:19], s70 offen sc0
v_mfma_f32_16x16x32_bf16 v[52:55], a[4:7], v[196:199], v[52:55]
ds_read_b64_tr_b16 a[36:37], v7 offset:50720
v_mfma_f32_16x16x32_bf16 v[36:39], a[4:7], v[192:195], v[36:39]
ds_read_b64_tr_b16 a[38:39], v7 offset:51232
v_mfma_f32_16x16x32_bf16 v[40:43], a[8:11], v[192:195], v[40:43]
ds_read_b64_tr_b16 a[40:41], v7 offset:50752
v_mfma_f32_16x16x32_bf16 v[56:59], a[8:11], v[196:199], v[56:59]
ds_read_b64_tr_b16 a[42:43], v7 offset:51264
v_mfma_f32_16x16x32_bf16 v[60:63], a[12:15], v[196:199], v[60:63]
ds_read_b64_tr_b16 a[44:45], v7 offset:50784
v_mfma_f32_16x16x32_bf16 v[44:47], a[12:15], v[192:195], v[44:47]
ds_read_b64_tr_b16 a[46:47], v7 offset:51296
s_waitcnt lgkmcnt(8)
v_mfma_f32_16x16x32_bf16 v[32:35], a[16:19], v[200:203], v[32:35]
ds_read_b64_tr_b16 a[48:49], v7 offset:59136
v_mfma_f32_16x16x32_bf16 v[48:51], a[16:19], v[204:207], v[48:51]
ds_read_b64_tr_b16 a[50:51], v7 offset:59648
v_mfma_f32_16x16x32_bf16 v[52:55], a[20:23], v[204:207], v[52:55]
ds_read_b64_tr_b16 a[52:53], v7 offset:59168
v_mfma_f32_16x16x32_bf16 v[36:39], a[20:23], v[200:203], v[36:39]
ds_read_b64_tr_b16 a[54:55], v7 offset:59680
v_mfma_f32_16x16x32_bf16 v[40:43], a[24:27], v[200:203], v[40:43]
ds_read_b64_tr_b16 a[56:57], v7 offset:59200
v_mfma_f32_16x16x32_bf16 v[56:59], a[24:27], v[204:207], v[56:59]
ds_read_b64_tr_b16 a[58:59], v7 offset:59712
v_mfma_f32_16x16x32_bf16 v[60:63], a[28:31], v[204:207], v[60:63]
ds_read_b64_tr_b16 a[60:61], v7 offset:59232
v_mfma_f32_16x16x32_bf16 v[44:47], a[28:31], v[200:203], v[44:47]
ds_read_b64_tr_b16 a[62:63], v7 offset:59744
s_waitcnt lgkmcnt(8)
v_mfma_f32_16x16x32_bf16 v[32:35], a[32:35], v[208:211], v[32:35]
v_mfma_f32_16x16x32_bf16 v[48:51], a[32:35], v[212:215], v[48:51]
v_mfma_f32_16x16x32_bf16 v[52:55], a[36:39], v[212:215], v[52:55]
v_mfma_f32_16x16x32_bf16 v[36:39], a[36:39], v[208:211], v[36:39]
v_mfma_f32_16x16x32_bf16 v[40:43], a[40:43], v[208:211], v[40:43]
v_mfma_f32_16x16x32_bf16 v[56:59], a[40:43], v[212:215], v[56:59]
v_mfma_f32_16x16x32_bf16 v[60:63], a[44:47], v[212:215], v[60:63]
v_mfma_f32_16x16x32_bf16 v[44:47], a[44:47], v[208:211], v[44:47]
s_waitcnt lgkmcnt(0)
v_mfma_f32_16x16x32_bf16 v[32:35], a[48:51], v[216:219], v[32:35]
v_mfma_f32_16x16x32_bf16 v[48:51], a[48:51], v[220:223], v[48:51]
v_mfma_f32_16x16x32_bf16 v[52:55], a[52:55], v[220:223], v[52:55]
v_mfma_f32_16x16x32_bf16 v[36:39], a[52:55], v[216:219], v[36:39]
v_mfma_f32_16x16x32_bf16 v[40:43], a[56:59], v[216:219], v[40:43]
v_mfma_f32_16x16x32_bf16 v[56:59], a[56:59], v[220:223], v[56:59]
v_mfma_f32_16x16x32_bf16 v[60:63], a[60:63], v[220:223], v[60:63]
v_mfma_f32_16x16x32_bf16 v[44:47], a[60:63], v[216:219], v[44:47]
s_waitcnt vmcnt(0)
v_cmp_ne_u32 vcc, 0, v15
s_nop 0
s_cbranch_vccz .Lxs81
.Lxs81b:
buffer_load_dwordx4 v[232:235], v11, s[16:19], s68 offen sc1
s_add_u32 s68, s68, 131072
buffer_load_dwordx4 v[236:239], v11, s[16:19], s68 offen sc1
s_add_u32 s68, s68, -130048
buffer_load_dwordx4 v[240:243], v11, s[16:19], s68 offen sc1
s_add_u32 s68, s68, 131072
buffer_load_dwordx4 v[244:247], v11, s[16:19], s68 offen sc1
s_waitcnt vmcnt(3)
v_mfma_f32_16x16x32_bf16 v[32:35], v[226:229], v[232:235], v[32:35]
v_mfma_f32_16x16x32_bf16 v[36:39], v[224:227], v[232:235], v[36:39]
s_waitcnt vmcnt(2)
v_mfma_f32_16x16x32_bf16 v[40:43], v[226:229], v[236:239], v[40:43]
s_nop 4
v_cvt_pk_bf16_f32 v128, v32, v33
v_cvt_pk_bf16_f32 v129, v34, v35
v_mfma_f32_16x16x32_bf16 v[44:47], v[224:227], v[236:239], v[44:47]
v_cvt_pk_bf16_f32 v130, v36, v37
v_cvt_pk_bf16_f32 v131, v38, v39
s_waitcnt vmcnt(1)
v_mfma_f32_16x16x32_bf16 v[48:51], v[226:229], v[240:243], v[48:51]
v_permlane16_swap_b32 v128, v130
v_mfma_f32_16x16x32_bf16 v[52:55], v[224:227], v[240:243], v[52:55]
v_permlane16_swap_b32 v129, v131
s_waitcnt vmcnt(0)
v_mfma_f32_16x16x32_bf16 v[56:59], v[226:229], v[244:247], v[56:59]
buffer_store_dwordx4 v[128:131], v16, s[36:39], 0 offen sc1
v_mfma_f32_16x16x32_bf16 v[60:63], v[224:227], v[244:247], v[60:63]
v_cvt_pk_bf16_f32 v132, v40, v41
v_cvt_pk_bf16_f32 v133, v42, v43
v_cvt_pk_bf16_f32 v134, v44, v45
v_cvt_pk_bf16_f32 v135, v46, v47
v_cvt_pk_bf16_f32 v136, v48, v49
v_permlane16_swap_b32 v132, v134
v_permlane16_swap_b32 v133, v135
v_cvt_pk_bf16_f32 v137, v50, v51
v_cvt_pk_bf16_f32 v138, v52, v53
buffer_store_dwordx4 v[132:135], v16, s[36:39], 0 offen offset:64 sc1
v_cvt_pk_bf16_f32 v139, v54, v55
v_permlane16_swap_b32 v136, v138
s_nop 0
v_permlane16_swap_b32 v137, v139
v_cvt_pk_bf16_f32 v140, v56, v57
v_cvt_pk_bf16_f32 v141, v58, v59
v_cvt_pk_bf16_f32 v142, v60, v61
v_cvt_pk_bf16_f32 v143, v62, v63
s_nop 0
v_permlane16_swap_b32 v140, v142
v_permlane16_swap_b32 v141, v143
buffer_store_dwordx4 v[136:139], v17, s[36:39], 0 offen sc1
buffer_store_dwordx4 v[140:143], v17, s[36:39], 0 offen offset:64 sc1
s_nop 1
.Lend:
s_endpgm
.Lxs81:
s_mov_b32 s15, 0
.Lxs81l:
v_mov_b32 v15, 0
buffer_atomic_add v15, v12, s[16:19], s70 offen sc0
s_add_u32 s15, s15, 1
s_cmp_gt_u32 s15, 100000
s_waitcnt vmcnt(0)
s_cbranch_scc1 .Lxs81b
v_cmp_ne_u32 vcc, 0, v15
s_nop 0
s_cbranch_vccz .Lxs81l
s_branch .Lxs81b
.section .rodata,"a"
.p2align 6
.amdhsa_kernel interleave_layers__sliding_local_dilated__swiglu_ffn__prompt_kernel
  .amdhsa_next_free_vgpr 512
  .amdhsa_next_free_sgpr 102
  .amdhsa_accum_offset 256
  .amdhsa_group_segment_fixed_size 0
  .amdhsa_kernarg_size 80
  .amdhsa_user_sgpr_count 2
  .amdhsa_user_sgpr_kernarg_segment_ptr 1
  .amdhsa_system_sgpr_workgroup_id_x 1
  .amdhsa_float_denorm_mode_32 3
.end_amdhsa_kernel
```

```asm
; @launch grid=(256,1,1) block=(256,1,1) lds=162560
.amdgcn_target "amdgcn-amd-amdhsa--gfx950"
.text
.globl interleave_layers__sliding_local_dilated__swiglu_ffn__prompt_kernel
.p2align 8
.type interleave_layers__sliding_local_dilated__swiglu_ffn__prompt_kernel,@function
interleave_layers__sliding_local_dilated__swiglu_ffn__prompt_kernel:
s_load_dwordx4 s[68:71], s[0:1], 0
s_load_dwordx2 s[72:73], s[0:1], 16
s_load_dwordx8 s[76:83], s[0:1], 32
s_load_dwordx4 s[84:87], s[0:1], 64
s_cmp_lt_u32 s2, 256
s_cbranch_scc1 .Lgo
s_endpgm
.p2align 12
.Lgo:
v_lshrrev_b32 v2, 6, v0
v_and_b32 v1, 63, v0
v_readfirstlane_b32 s3, v2
s_and_b32 s4, s2, 7
s_lshr_b32 s5, s2, 3
s_lshr_b32 s6, s4, 1
s_lshl_b32 s6, s6, 2
s_and_b32 s62, s5, 3
s_add_u32 s6, s6, s62
s_and_b32 s7, s4, 1
s_lshr_b32 s62, s5, 2
s_lshl_b32 s62, s62, 1
s_add_u32 s7, s7, s62
s_lshr_b32 s8, s4, 2
s_lshl_b32 s8, s8, 3
s_and_b32 s62, s5, 7
s_add_u32 s8, s8, s62
s_and_b32 s9, s4, 3
s_lshl_b32 s9, s9, 2
s_lshr_b32 s62, s5, 3
s_add_u32 s9, s9, s62
s_lshr_b32 s62, s6, 1
s_lshl_b32 s62, s62, 8
s_and_b32 s63, s6, 1
s_add_u32 s62, s62, s63
s_lshl_b32 s63, s3, 6
s_add_u32 s62, s62, s63
s_lshl_b32 s62, s62, 11
s_lshl_b32 s63, s7, 7
s_add_u32 s62, s62, s63
v_and_b32 v160, 15, v1
v_lshlrev_b32 v160, 12, v160
v_bfe_u32 v2, v1, 4, 1
v_lshl_add_u32 v160, v2, 5, v160
v_bfe_u32 v2, v1, 5, 1
v_lshl_add_u32 v160, v2, 4, v160
v_add_u32 v160, s62, v160
v_add_u32 v161, 0x10000, v160
s_sub_u32 s64, s3, 1
s_max_i32 s64, s64, 0
s_lshl_b32 s64, s64, 11
s_lshl_b32 s66, s9, 7
s_add_u32 s66, s66, s64
s_cmp_eq_u32 s3, 1
s_cselect_b32 s66, 8388608, s66
s_mul_i32 s65, s8, 122880
s_add_u32 s65, s65, s66
v_lshrrev_b32 v9, 1, v1
v_min_u32 v9, 19, v9
v_mul_u32_u24 v9, 6144, v9
s_waitcnt lgkmcnt(0)
s_mov_b32 s36, s68
s_mov_b32 s37, s69
s_mov_b32 s38, 4194304
s_mov_b32 s39, 0x20000
s_mov_b32 s16, s86
s_mov_b32 s17, s87
s_mov_b32 s18, 268435456
s_mov_b32 s19, 0x20000
s_xor_b32 s14, s3, 3
s_lshl_b32 s14, s14, 8
s_add_u32 s14, s14, s2
v_lshlrev_b32 v27, 4, v1
v_mov_b64 v[156:157], 0
v_mov_b64 v[158:159], 0
s_cmp_ge_u32 s14, 16
s_cbranch_scc1 .Lz1
s_lshl_b32 s62, s2, 13
s_add_u32 s62, s62, 30408704
s_add_u32 s63, s62, 4096
buffer_store_dwordx4 v[156:159], v27, s[16:19], s62 offen sc1
buffer_store_dwordx4 v[156:159], v27, s[16:19], s62 offen offset:1024 sc1
buffer_store_dwordx4 v[156:159], v27, s[16:19], s62 offen offset:2048 sc1
buffer_store_dwordx4 v[156:159], v27, s[16:19], s62 offen offset:3072 sc1
buffer_store_dwordx4 v[156:159], v27, s[16:19], s63 offen sc1
buffer_store_dwordx4 v[156:159], v27, s[16:19], s63 offen offset:1024 sc1
buffer_store_dwordx4 v[156:159], v27, s[16:19], s63 offen offset:2048 sc1
buffer_store_dwordx4 v[156:159], v27, s[16:19], s63 offen offset:3072 sc1
.Lz1:
buffer_load_dwordx4 v[128:131], v160, s[36:39], 0 offen
buffer_load_dwordx4 v[132:135], v160, s[36:39], 0 offen offset:64
buffer_load_dwordx4 v[136:139], v161, s[36:39], 0 offen
buffer_load_dwordx4 v[140:143], v161, s[36:39], 0 offen offset:64
s_mov_b32 s20, s70
s_mov_b32 s21, s71
s_mov_b32 s22, 6291456
s_mov_b32 s23, 0x20000
buffer_load_dword v58, v9, s[20:23], s65 offen
s_mov_b32 s40, s84
s_mov_b32 s41, s85
s_mov_b32 s42, 256
s_mov_b32 s43, 0x20000
s_getpc_b64 s[62:63]
.Lpc:
s_lshl_b32 s64, s5, 12
v_lshrrev_b32 v59, 3, v0
v_lshl_add_u32 v59, v59, 7, s64
v_add_u32 v2, 0x20000, v59
v_min_u32 v2, .Lend-.Lpc, v2
v_min_u32 v59, .Lend-.Lpc, v59
global_load_dword v59, v59, s[62:63]
global_load_dword v58, v2, s[62:63]
s_mov_b32 s24, s72
s_mov_b32 s25, s73
s_mov_b32 s26, 2097152
s_mov_b32 s27, 0x20000
s_mov_b32 s28, s80
s_mov_b32 s29, s81
s_mov_b32 s30, 7340032
s_mov_b32 s31, 0x20000
s_cmp_lt_u32 s3, 2
s_cselect_b32 s32, s76, s78
s_cselect_b32 s33, s77, s79
s_mov_b32 s34, 7340032
s_mov_b32 s35, 0x20000
s_lshr_b32 s10, s4, 2
s_lshl_b32 s10, s10, 2
s_and_b32 s62, s5, 3
s_add_u32 s10, s10, s62
s_and_b32 s11, s4, 3
s_lshl_b32 s11, s11, 3
s_lshr_b32 s62, s5, 2
s_add_u32 s11, s11, s62
s_and_b32 s12, s11, 1
s_lshr_b32 s13, s11, 1
s_mul_i32 s51, s13, 448
s_mul_i32 s62, s12, 192
s_add_u32 s51, s51, s62
s_and_b32 s48, s3, 1
s_lshr_b32 s49, s3, 1
s_lshl_b32 s50, s8, 3
s_sub_u32 s50, s50, 9
s_cmp_lt_u32 s8, 2
s_cselect_b32 s50, 7, s50
s_mul_i32 s62, s8, 393216
s_add_u32 s62, s62, s66
v_mul_u32_u24 v14, 6144, v1
v_add_u32 v14, s62, v14
s_lshl_b32 s62, s8, 4
s_add_u32 s62, s62, s9
s_lshl_b32 s62, s62, 2
s_add_u32 s62, s62, s3
s_mul_i32 s62, s62, 6656
v_min_u32 v15, 51, v1
v_lshl_add_u32 v15, v15, 7, s62
s_sub_u32 s63, s8, 4
s_lshl_b32 s64, s8, 1
s_add_u32 s64, s64, 1
s_cmp_lt_u32 s8, 5
s_cselect_b64 vcc, -1, 0
s_cselect_b32 s46, s64, s63
v_cndmask_b32 v14, v14, v15, vcc
s_lshl_b32 s62, s2, 1
s_add_u32 s62, s62, s48
s_mul_i32 s62, s62, 5376
v_min_u32 v16, 41, v1
v_lshl_add_u32 v16, v16, 7, s62
s_cmp_lt_u32 s46, 6
s_cselect_b64 vcc, -1, 0
v_cndmask_b32 v15, v14, v16, vcc
v_cndmask_b32 v14, v16, v14, vcc
s_cmp_lt_u32 s8, 5
s_cselect_b32 s62, s24, s20
s_cselect_b32 s63, s25, s21
s_cselect_b32 s64, s26, s22
s_sub_u32 s47, s46, 6
s_cmp_lt_u32 s46, 6
s_cselect_b32 s47, s46, s47
s_cselect_b32 s76, s62, s32
s_cselect_b32 s98, s32, s62
s_cselect_b32 s77, s63, s33
s_cselect_b32 s99, s33, s63
s_cselect_b32 s78, s64, s34
s_cselect_b32 s100, s34, s64
s_mov_b32 s79, 0x20000
v_bfe_u32 v18, v1, 3, 1
v_bfe_u32 v2, v1, 5, 1
v_lshl_add_u32 v18, v2, 2, v18
v_and_b32 v2, 16, v1
v_add_u32 v18, v18, v2
s_lshl_b32 s62, s49, 2
s_add_u32 s62, s62, s48
s_lshl_b32 s62, s62, 1
v_add_u32 v18, s62, v18
v_mul_u32_u24 v18, 6144, v18
v_and_b32 v2, 7, v1
v_lshl_add_u32 v18, v2, 4, v18
s_lshl_b32 s62, s9, 7
v_add_u32 v18, s62, v18
v_add_u32 v19, 1024, v18
v_add_u32 v20, 2048, v18
s_mul_i32 s59, s3, 3104
s_mov_b32 s58, 0
s_lshr_b32 s62, s8, 1
s_lshl_b32 s62, s62, 8
s_and_b32 s67, s8, 1
s_add_u32 s62, s62, s67
s_lshl_b32 s62, s62, 11
s_lshl_b32 s63, s3, 17
s_add_u32 s62, s62, s63
v_lshrrev_b32 v2, 4, v1
v_xor_b32 v2, v2, v1
v_and_b32 v2, 7, v2
v_lshlrev_b32 v2, 4, v2
v_lshrrev_b32 v21, 3, v1
v_lshl_add_u32 v21, v21, 12, v2
v_add_u32 v21, s62, v21
v_xor_b32 v28, 64, v21
v_add_u32 v28, 31744, v28
s_lshr_b32 s63, s50, 3
s_lshr_b32 s62, s63, 1
s_lshl_b32 s62, s62, 8
s_and_b32 s67, s63, 1
s_add_u32 s62, s62, s67
s_lshl_b32 s62, s62, 11
s_lshl_b32 s63, s3, 14
s_add_u32 s62, s62, s63
s_add_u32 s62, s62, 456704
s_lshl_b32 s63, s3, 5
v_and_b32 v2, 31, v1
v_lshlrev_b32 v2, 2, v2
v_xor_b32 v2, s63, v2
v_lshrrev_b32 v22, 5, v1
v_lshl_add_u32 v22, v22, 12, v2
v_add_u32 v22, s62, v22
v_xor_b32 v29, 16, v22
v_add_u32 v29, -57344, v29
s_mov_b32 s52, 0
s_mov_b32 s53, 65536
s_mul_i32 s55, s3, 4608
s_mov_b32 s54, 0
s_mul_i32 s56, s3, 3104
v_bfe_u32 v24, v1, 1, 3
v_lshrrev_b32 v2, 4, v1
v_xor_b32 v2, v2, v24
v_lshlrev_b32 v2, 4, v2
v_and_b32 v23, 15, v1
v_lshl_add_u32 v23, v23, 7, v2
s_mul_i32 s62, s48, 9216
v_add_u32 v23, s62, v23
v_xor_b32 v30, 64, v23
v_mul_u32_u24 v24, 2304, v24
v_add_u32 v24, v24, v2
v_and_b32 v2, 1, v1
v_lshl_add_u32 v24, v2, 7, v24
v_add_u32 v24, 2048, v24
v_xor_b32 v31, 64, v24
v_and_b32 v2, 15, v1
v_cmp_eq_u32 vcc, 0, v2
v_mov_b32 v2, 18432
s_nop 0
v_cndmask_b32 v24, v24, v2, vcc
v_cndmask_b32 v31, v31, v2, vcc
v_bfe_u32 v25, v1, 3, 2
v_mul_u32_u24 v25, 3104, v25
v_bfe_u32 v2, v1, 2, 1
v_lshl_add_u32 v25, v2, 7, v25
v_bfe_u32 v2, v1, 5, 1
v_lshl_add_u32 v25, v2, 8, v25
v_and_b32 v2, 3, v1
v_lshl_add_u32 v25, v2, 3, v25
s_lshl_b32 s62, s49, 6
s_add_u32 s62, s62, 73984
v_add_u32 v25, s62, v25
s_lshl_b32 s62, s8, 1
s_add_u32 s62, s62, s3
s_lshr_b32 s63, s50, 2
s_cmp_lt_u32 s3, 2
s_cselect_b32 s62, s62, s63
s_lshl_b32 s62, s62, 13
s_cmp_eq_u32 s3, 3
s_cselect_b32 s62, 268435456, s62
v_lshl_add_u32 v26, v1, 4, s62
s_mul_i32 s59, s3, 2080
v_bfe_u32 v5, v1, 3, 1
v_lshrrev_b32 v2, 4, v1
v_lshl_add_u32 v5, v2, 3, v5
s_lshl_b32 s62, s3, 1
v_add_u32 v5, s62, v5
v_mul_u32_u24 v5, 2048, v5
v_and_b32 v2, 7, v1
v_lshl_add_u32 v5, v2, 4, v5
s_lshl_b32 s62, s7, 7
v_add_u32 v5, s62, v5
v_add_u32 v6, 64512, v5
s_lshl_b32 s62, s6, 10
s_add_u32 s62, s62, 30408704
s_lshl_b32 s64, s8, 10
s_add_u32 s64, s64, 30408704
s_lshr_b32 s67, s9, 1
s_and_b32 s67, s67, 3
s_lshl_b32 s67, s67, 7
s_add_u32 s64, s64, s67
s_lshr_b32 s65, s50, 3
s_lshl_b32 s65, s65, 10
s_add_u32 s65, s65, 30408704
s_lshr_b32 s67, s9, 1
s_and_b32 s67, s67, 3
s_lshl_b32 s67, s67, 7
s_add_u32 s65, s65, s67
v_mov_b32 v2, 268435456
v_cmp_eq_u32 vcc, 65, v0
v_mov_b32 v33, s65
s_nop 0
v_cndmask_b32 v33, v2, v33, vcc
v_cndmask_b32 v36, 0, 16, vcc
v_cmp_eq_u32 vcc, 64, v0
v_mov_b32 v32, s64
s_nop 0
v_cndmask_b32 v33, v33, v32, vcc
v_lshl_add_u32 v32, v1, 7, s62
v_cndmask_b32 v34, v2, 0, vcc
v_cndmask_b32 v35, 0, 16, vcc
v_cndmask_b32 v36, v36, 16, vcc
v_lshrrev_b32 v37, 3, v0
v_cmp_eq_u32 vcc, 8, v37
s_nop 1
v_cndmask_b32 v32, v2, v32, vcc
v_mov_b32 v38, 1
v_lshrrev_b32 v2, 4, v1
v_lshlrev_b32 v2, 2, v2
v_and_b32 v13, 15, v1
v_sub_u32 v2, v13, v2
v_mov_b32 v13, 0xff61b1e6
v_subrev_u32 v54, 0, v2
v_cmp_gt_u32 vcc, 8, v54
s_nop 1
v_cndmask_b32 v50, v13, 0, vcc
v_cmp_gt_i32 vcc, -8, v54
s_nop 1
v_cndmask_b32 v46, v13, 0, vcc
v_subrev_u32 v54, 1, v2
v_cmp_gt_u32 vcc, 8, v54
s_nop 1
v_cndmask_b32 v51, v13, 0, vcc
v_cmp_gt_i32 vcc, -8, v54
s_nop 1
v_cndmask_b32 v47, v13, 0, vcc
v_subrev_u32 v54, 2, v2
v_cmp_gt_u32 vcc, 8, v54
s_nop 1
v_cndmask_b32 v52, v13, 0, vcc
v_cmp_gt_i32 vcc, -8, v54
s_nop 1
v_cndmask_b32 v48, v13, 0, vcc
v_subrev_u32 v54, 3, v2
v_cmp_gt_u32 vcc, 8, v54
s_nop 1
v_cndmask_b32 v53, v13, 0, vcc
v_cmp_gt_i32 vcc, -8, v54
s_nop 1
v_cndmask_b32 v49, v13, 0, vcc
s_cmp_lt_u32 s8, 2
s_cselect_b64 vcc, -1, 0
v_cndmask_b32 v54, v46, v13, vcc
v_cndmask_b32 v55, v47, v13, vcc
v_cndmask_b32 v56, v48, v13, vcc
v_cndmask_b32 v57, v49, v13, vcc
s_mov_b32 s75, 29360128
v_and_b32 v10, 15, v1
v_lshlrev_b32 v12, 2, v10
v_lshlrev_b32 v10, 4, v10
v_add_u32 v10, 152576, v10
v_lshrrev_b32 v11, 4, v1
v_lshlrev_b32 v11, 4, v11
s_lshl_b32 s62, s49, 7
s_add_u32 s62, s62, 158720
v_add_u32 v12, s62, v12
v_add_u32 v13, s62, v11
v_add_u32 v11, 156672, v11
s_lshl_b32 s62, s3, 11
s_add_u32 s62, s62, 143360
v_lshl_add_u32 v8, v1, 4, s62
v_xor_b32 v9, 2048, v8
v_mov_b32 v248, 0x3f803f80
v_mov_b32 v249, 0x3f803f80
v_mov_b32 v250, 0x3f803f80
v_mov_b32 v251, 0x3f803f80
s_mul_i32 s62, s3, 18496
s_add_u32 s62, s62, 18432
v_mov_b32 v2, s62
ds_write_b128 v2, v[248:251]
v_and_b32 v7, 31, v1
v_lshrrev_b32 v2, 5, v1
v_lshl_add_u32 v7, v7, 1, v2
v_and_b32 v2, 0xc0, v0
v_add_u32 v7, v7, v2
v_lshlrev_b32 v17, 2, v7
v_add_u32 v17, 156672, v17
v_lshlrev_b32 v7, 4, v7
v_add_u32 v7, 152576, v7
s_lshl_b32 s74, s9, 1
s_add_u32 s74, s74, s49
s_lshl_b32 s74, s74, 17
s_lshl_b32 s63, s8, 13
s_add_u32 s74, s74, s63
s_lshl_b32 s63, s48, 12
s_add_u32 s74, s74, s63
s_add_u32 s74, s74, 4194304
s_mov_b32 s62, 0
v_lshl_add_u32 v4, v1, 4, s62
v_lshrrev_b32 v2, 3, v1
v_cmp_eq_u32 vcc, 3, v2
v_add_u32 v2, 67108480, v4
s_nop 0
v_cndmask_b32 v4, v4, v2, vcc
s_nop 1
s_cmp_eq_u32 s48, 1
s_cbranch_scc1 .Lqkv2
s_add_u32 m0, s55, 0
s_nop 0
buffer_load_dwordx4 v21, s[36:39], s52 offen lds
buffer_load_dwordx4 v28, s[36:39], s52 offen offset:1024 lds
buffer_load_dword v22, s[36:39], s52 offen offset:2048 lds
s_add_u32 s52, s52, 128
s_add_u32 m0, s55, 2304
s_nop 0
buffer_load_dwordx4 v21, s[36:39], s53 offen lds
buffer_load_dwordx4 v28, s[36:39], s53 offen offset:1024 lds
buffer_load_dword v29, s[36:39], s53 offen offset:2048 lds
s_add_u32 s53, s53, 128
s_add_u32 m0, s56, 123648
s_nop 0
buffer_load_dwordx4 v18, s[20:23], s54 offen lds
buffer_load_dwordx4 v19, s[20:23], s54 offen offset:1024 lds
buffer_load_dwordx4 v20, s[20:23], s54 offen offset:2048 lds
s_add_u32 s54, s54, 196608
s_add_u32 m0, s56, 136064
s_nop 0
buffer_load_dwordx4 v18, s[20:23], s54 offen lds
buffer_load_dwordx4 v19, s[20:23], s54 offen offset:1024 lds
buffer_load_dwordx4 v20, s[20:23], s54 offen offset:2048 lds
s_add_u32 s54, s54, 196608
s_waitcnt vmcnt(12)
s_cmp_lt_u32 s14, 16
s_cselect_b32 s62, 0, 4096
v_mov_b32 v154, 1
v_lshlrev_b32 v155, 8, v1
v_permlane16_swap_b32 v128, v130
v_permlane16_swap_b32 v129, v131
v_permlane16_swap_b32 v132, v134
v_permlane16_swap_b32 v133, v135
v_permlane16_swap_b32 v136, v138
v_permlane16_swap_b32 v137, v139
v_permlane16_swap_b32 v140, v142
v_permlane16_swap_b32 v141, v143
buffer_atomic_add v154, v155, s[40:43], s62 offen
v_lshlrev_b32 v64, 16, v128
v_and_b32 v65, 0xffff0000, v128
v_lshlrev_b32 v66, 16, v129
v_and_b32 v67, 0xffff0000, v129
v_lshlrev_b32 v68, 16, v130
v_and_b32 v69, 0xffff0000, v130
v_lshlrev_b32 v70, 16, v131
v_and_b32 v71, 0xffff0000, v131
v_lshlrev_b32 v72, 16, v132
v_and_b32 v73, 0xffff0000, v132
v_lshlrev_b32 v74, 16, v133
v_and_b32 v75, 0xffff0000, v133
v_lshlrev_b32 v76, 16, v134
v_and_b32 v77, 0xffff0000, v134
v_lshlrev_b32 v78, 16, v135
v_and_b32 v79, 0xffff0000, v135
v_lshlrev_b32 v80, 16, v136
v_and_b32 v81, 0xffff0000, v136
v_lshlrev_b32 v82, 16, v137
v_and_b32 v83, 0xffff0000, v137
v_lshlrev_b32 v84, 16, v138
v_and_b32 v85, 0xffff0000, v138
v_lshlrev_b32 v86, 16, v139
v_and_b32 v87, 0xffff0000, v139
v_lshlrev_b32 v88, 16, v140
v_and_b32 v89, 0xffff0000, v140
v_lshlrev_b32 v90, 16, v141
v_and_b32 v91, 0xffff0000, v141
v_lshlrev_b32 v92, 16, v142
v_and_b32 v93, 0xffff0000, v142
v_lshlrev_b32 v94, 16, v143
v_and_b32 v95, 0xffff0000, v143
s_lshl_b32 s64, s6, 14
s_lshl_b32 s65, s49, 13
s_add_u32 s64, s64, s65
s_lshl_b32 s65, s7, 9
s_add_u32 s64, s64, s65
s_lshl_b32 s65, s48, 8
s_add_u32 s64, s64, s65
s_add_u32 s64, s64, 29360128
v_and_b32 v152, 31, v1
v_lshlrev_b32 v152, 3, v152
v_lshrrev_b32 v153, 5, v1
v_lshl_add_u32 v152, v153, 28, v152
s_lshl_b32 s62, s7, 18
s_add_u32 s62, s62, 0
s_add_u32 s63, s62, 0x20000
v_pk_mul_f32 v[146:147], v[64:65], v[64:65]
v_pk_mul_f32 v[150:151], v[80:81], v[80:81]
v_pk_fma_f32 v[146:147], v[66:67], v[66:67], v[146:147]
v_pk_add_f32 v[144:145], v[64:65], v[66:67]
v_pk_fma_f32 v[150:151], v[82:83], v[82:83], v[150:151]
v_pk_add_f32 v[148:149], v[80:81], v[82:83]
v_pk_fma_f32 v[146:147], v[68:69], v[68:69], v[146:147]
v_pk_add_f32 v[144:145], v[144:145], v[68:69]
v_pk_fma_f32 v[150:151], v[84:85], v[84:85], v[150:151]
v_pk_add_f32 v[148:149], v[148:149], v[84:85]
v_pk_fma_f32 v[146:147], v[70:71], v[70:71], v[146:147]
v_pk_add_f32 v[144:145], v[144:145], v[70:71]
v_pk_fma_f32 v[150:151], v[86:87], v[86:87], v[150:151]
v_pk_add_f32 v[148:149], v[148:149], v[86:87]
v_pk_fma_f32 v[146:147], v[72:73], v[72:73], v[146:147]
v_pk_add_f32 v[144:145], v[144:145], v[72:73]
v_pk_fma_f32 v[150:151], v[88:89], v[88:89], v[150:151]
v_pk_add_f32 v[148:149], v[148:149], v[88:89]
v_pk_fma_f32 v[146:147], v[74:75], v[74:75], v[146:147]
v_pk_add_f32 v[144:145], v[144:145], v[74:75]
v_pk_fma_f32 v[150:151], v[90:91], v[90:91], v[150:151]
v_pk_add_f32 v[148:149], v[148:149], v[90:91]
v_pk_fma_f32 v[146:147], v[76:77], v[76:77], v[146:147]
v_pk_add_f32 v[144:145], v[144:145], v[76:77]
v_pk_fma_f32 v[150:151], v[92:93], v[92:93], v[150:151]
v_pk_add_f32 v[148:149], v[148:149], v[92:93]
v_pk_fma_f32 v[146:147], v[78:79], v[78:79], v[146:147]
v_pk_add_f32 v[144:145], v[144:145], v[78:79]
v_pk_fma_f32 v[150:151], v[94:95], v[94:95], v[150:151]
v_pk_add_f32 v[148:149], v[148:149], v[94:95]
v_add_f32 v144, v144, v145
v_add_f32 v146, v146, v147
v_add_f32 v148, v148, v149
v_add_f32 v150, v150, v151
s_nop 0
v_permlane16_swap_b32 v144, v148
v_permlane16_swap_b32 v146, v150
v_add_f32 v144, v144, v148
v_add_f32 v146, v146, v150
s_nop 1
v_permlane32_swap_b32 v144, v146
v_add_f32 v144, v144, v146
s_nop 1
v_permlane32_swap_b32 v144, v145
buffer_store_dwordx2 v[144:145], v152, s[16:19], s64 offen sc1
s_lshl_b32 s62, s2, 10
s_add_u32 s62, s62, 31457280
s_cmp_eq_u32 s3, 0
s_cselect_b32 s62, s62, 268435456
buffer_store_dwordx4 v[156:159], v27, s[16:19], s62 offen sc1
v_accvgpr_write_b32 a224, v64
v_accvgpr_write_b32 a225, v65
v_accvgpr_write_b32 a226, v66
v_accvgpr_write_b32 a227, v67
v_accvgpr_write_b32 a228, v68
v_accvgpr_write_b32 a229, v69
v_accvgpr_write_b32 a230, v70
v_accvgpr_write_b32 a231, v71
v_accvgpr_write_b32 a232, v72
v_accvgpr_write_b32 a233, v73
v_accvgpr_write_b32 a234, v74
v_accvgpr_write_b32 a235, v75
v_accvgpr_write_b32 a236, v76
v_accvgpr_write_b32 a237, v77
v_accvgpr_write_b32 a238, v78
v_accvgpr_write_b32 a239, v79
v_accvgpr_write_b32 a240, v80
v_accvgpr_write_b32 a241, v81
v_accvgpr_write_b32 a242, v82
v_accvgpr_write_b32 a243, v83
v_accvgpr_write_b32 a244, v84
v_accvgpr_write_b32 a245, v85
v_accvgpr_write_b32 a246, v86
v_accvgpr_write_b32 a247, v87
v_accvgpr_write_b32 a248, v88
v_accvgpr_write_b32 a249, v89
v_accvgpr_write_b32 a250, v90
v_accvgpr_write_b32 a251, v91
v_accvgpr_write_b32 a252, v92
v_accvgpr_write_b32 a253, v93
v_accvgpr_write_b32 a254, v94
v_accvgpr_write_b32 a255, v95
s_add_u32 m0, s55, 18496
s_nop 0
buffer_load_dwordx4 v21, s[36:39], s52 offen lds
buffer_load_dwordx4 v28, s[36:39], s52 offen offset:1024 lds
buffer_load_dword v22, s[36:39], s52 offen offset:2048 lds
s_add_u32 s52, s52, 128
s_add_u32 m0, s55, 20800
s_nop 0
buffer_load_dwordx4 v21, s[36:39], s53 offen lds
buffer_load_dwordx4 v28, s[36:39], s53 offen offset:1024 lds
buffer_load_dword v29, s[36:39], s53 offen offset:2048 lds
s_add_u32 s53, s53, 128
s_add_u32 m0, s56, 73984
s_nop 0
buffer_load_dwordx4 v18, s[20:23], s54 offen lds
buffer_load_dwordx4 v19, s[20:23], s54 offen offset:1024 lds
buffer_load_dwordx4 v20, s[20:23], s54 offen offset:2048 lds
s_add_u32 s54, s54, 196608
s_waitcnt vmcnt(15) lgkmcnt(0)
s_barrier
ds_read_b128 a[0:3], v23
ds_read_b128 a[4:7], v23 offset:2304
ds_read_b128 a[8:11], v23 offset:4608
ds_read_b128 a[12:15], v23 offset:6912
ds_read_b64_tr_b16 a[20:21], v25 offset:49664
ds_read_b64_tr_b16 a[22:23], v25 offset:50176
ds_read_b64_tr_b16 a[24:25], v25 offset:49696
ds_read_b64_tr_b16 a[26:27], v25 offset:50208
ds_read_b128 a[16:19], v24
ds_read_b64_tr_b16 a[28:29], v25 offset:50688
ds_read_b64_tr_b16 a[30:31], v25 offset:51200
ds_read_b64_tr_b16 a[32:33], v25 offset:50720
ds_read_b64_tr_b16 a[34:35], v25 offset:51232
ds_read_b64_tr_b16 a[36:37], v25 offset:51712
ds_read_b64_tr_b16 a[38:39], v25 offset:52224
ds_read_b64_tr_b16 a[40:41], v25 offset:51744
ds_read_b64_tr_b16 a[42:43], v25 offset:52256
s_waitcnt vmcnt(12) lgkmcnt(8)
s_barrier
v_mfma_f32_16x16x32_bf16 v[60:63], a[20:23], a[0:3], 0
ds_read_b128 a[44:47], v30
s_add_u32 m0, s56, 86400
v_mfma_f32_16x16x32_bf16 v[76:79], a[24:27], a[0:3], 0
buffer_load_dwordx4 v18, s[20:23], s54 offen lds
v_mfma_f32_16x16x32_bf16 v[80:83], a[24:27], a[4:7], 0
s_sub_u32 s47, s47, 1
s_cbranch_scc1 .Lx4
.Lx4b:
v_mfma_f32_16x16x32_bf16 v[64:67], a[20:23], a[4:7], 0
buffer_load_dwordx4 v19, s[20:23], s54 offen offset:1024 lds
v_mfma_f32_16x16x32_bf16 v[68:71], a[20:23], a[8:11], 0
ds_read_b128 a[48:51], v30 offset:2304
v_mfma_f32_16x16x32_bf16 v[84:87], a[24:27], a[8:11], 0
ds_read_b128 a[52:55], v30 offset:4608
ds_read_b128 a[56:59], v30 offset:6912
v_mfma_f32_16x16x32_bf16 v[88:91], a[24:27], a[12:15], 0
buffer_load_dwordx4 v20, s[20:23], s54 offen offset:2048 lds
v_mfma_f32_16x16x32_bf16 v[72:75], a[20:23], a[12:15], 0
s_add_u32 s54, s54, 196608
s_waitcnt lgkmcnt(4)
v_mfma_f32_16x16x32_bf16 v[244:247], a[20:23], a[16:19], 0
ds_read_b64_tr_b16 a[64:65], v25 offset:62080
s_add_u32 m0, s55, 36992
v_mfma_f32_16x16x32_bf16 v[104:107], a[28:31], a[12:15], 0
buffer_load_dwordx4 v21, s[36:39], s52 offen lds
v_mfma_f32_16x16x32_bf16 v[120:123], a[32:35], a[12:15], 0
ds_read_b64_tr_b16 a[66:67], v25 offset:62592
v_mfma_f32_16x16x32_bf16 v[116:119], a[32:35], a[8:11], 0
ds_read_b64_tr_b16 a[68:69], v25 offset:62112
ds_read_b64_tr_b16 a[70:71], v25 offset:62624
v_mfma_f32_16x16x32_bf16 v[100:103], a[28:31], a[8:11], 0
buffer_load_dwordx4 v28, s[36:39], s52 offen offset:1024 lds
v_mfma_f32_16x16x32_bf16 v[96:99], a[28:31], a[4:7], 0
ds_read_b128 a[60:63], v31
v_mfma_f32_16x16x32_bf16 v[112:115], a[32:35], a[4:7], 0
buffer_load_dword v22, s[36:39], s52 offen offset:2048 lds
v_mfma_f32_16x16x32_bf16 v[108:111], a[32:35], a[0:3], 0
ds_read_b64_tr_b16 a[72:73], v25 offset:63104
s_add_u32 s52, s52, 128
v_mfma_f32_16x16x32_bf16 v[92:95], a[28:31], a[0:3], 0
s_add_u32 m0, s55, 39296
v_mfma_f32_16x16x32_bf16 v[156:159], a[28:31], a[16:19], 0
buffer_load_dwordx4 v21, s[36:39], s53 offen lds
v_mfma_f32_16x16x32_bf16 v[160:163], a[32:35], a[16:19], 0
ds_read_b64_tr_b16 a[74:75], v25 offset:63616
ds_read_b64_tr_b16 a[76:77], v25 offset:63136
v_mfma_f32_16x16x32_bf16 v[124:127], a[0:3], a[36:39], 0
ds_read_b64_tr_b16 a[78:79], v25 offset:63648
v_mfma_f32_16x16x32_bf16 v[140:143], a[0:3], a[40:43], 0
buffer_load_dwordx4 v28, s[36:39], s53 offen offset:1024 lds
v_mfma_f32_16x16x32_bf16 v[144:147], a[4:7], a[40:43], 0
ds_read_b64_tr_b16 a[80:81], v25 offset:64128
v_mfma_f32_16x16x32_bf16 v[128:131], a[4:7], a[36:39], 0
ds_read_b64_tr_b16 a[82:83], v25 offset:64640
ds_read_b64_tr_b16 a[84:85], v25 offset:64160
v_mfma_f32_16x16x32_bf16 v[132:135], a[8:11], a[36:39], 0
buffer_load_dword v29, s[36:39], s53 offen offset:2048 lds
v_mfma_f32_16x16x32_bf16 v[148:151], a[8:11], a[40:43], 0
s_add_u32 s53, s53, 128
v_mfma_f32_16x16x32_bf16 v[152:155], a[12:15], a[40:43], 0
ds_read_b64_tr_b16 a[86:87], v25 offset:64672
v_mfma_f32_16x16x32_bf16 v[136:139], a[12:15], a[36:39], 0
s_waitcnt vmcnt(9) lgkmcnt(8)
s_barrier
v_mfma_f32_16x16x32_bf16 v[60:63], a[64:67], a[44:47], v[60:63]
ds_read_b128 a[0:3], v23 offset:18496
s_add_u32 m0, s56, 98816
v_mfma_f32_16x16x32_bf16 v[76:79], a[68:71], a[44:47], v[76:79]
buffer_load_dwordx4 v18, s[20:23], s54 offen lds
v_mfma_f32_16x16x32_bf16 v[80:83], a[68:71], a[48:51], v[80:83]
ds_read_b128 a[4:7], v23 offset:20800
v_mfma_f32_16x16x32_bf16 v[64:67], a[64:67], a[48:51], v[64:67]
buffer_load_dwordx4 v19, s[20:23], s54 offen offset:1024 lds
v_mfma_f32_16x16x32_bf16 v[68:71], a[64:67], a[52:55], v[68:71]
ds_read_b128 a[8:11], v23 offset:23104
ds_read_b128 a[12:15], v23 offset:25408
v_mfma_f32_16x16x32_bf16 v[84:87], a[68:71], a[52:55], v[84:87]
ds_read_b64_tr_b16 a[20:21], v25
v_mfma_f32_16x16x32_bf16 v[88:91], a[68:71], a[56:59], v[88:91]
buffer_load_dwordx4 v20, s[20:23], s54 offen offset:2048 lds
v_mfma_f32_16x16x32_bf16 v[72:75], a[64:67], a[56:59], v[72:75]
s_add_u32 s54, s54, 196608
s_waitcnt lgkmcnt(5)
v_mfma_f32_16x16x32_bf16 v[244:247], a[64:67], a[60:63], v[244:247]
ds_read_b64_tr_b16 a[22:23], v25 offset:512
s_add_u32 m0, s56, 111232
v_mfma_f32_16x16x32_bf16 v[104:107], a[72:75], a[56:59], v[104:107]
buffer_load_dwordx4 v18, s[20:23], s54 offen lds
v_mfma_f32_16x16x32_bf16 v[120:123], a[76:79], a[56:59], v[120:123]
ds_read_b64_tr_b16 a[24:25], v25 offset:32
v_mfma_f32_16x16x32_bf16 v[116:119], a[76:79], a[52:55], v[116:119]
ds_read_b64_tr_b16 a[26:27], v25 offset:544
v_mfma_f32_16x16x32_bf16 v[100:103], a[72:75], a[52:55], v[100:103]
buffer_load_dwordx4 v19, s[20:23], s54 offen offset:1024 lds
v_mfma_f32_16x16x32_bf16 v[96:99], a[72:75], a[48:51], v[96:99]
ds_read_b128 a[16:19], v24 offset:18496
ds_read_b64_tr_b16 a[28:29], v25 offset:1024
v_mfma_f32_16x16x32_bf16 v[112:115], a[76:79], a[48:51], v[112:115]
buffer_load_dwordx4 v20, s[20:23], s54 offen offset:2048 lds
v_mfma_f32_16x16x32_bf16 v[108:111], a[76:79], a[44:47], v[108:111]
s_add_u32 s54, s54, 196608
v_mfma_f32_16x16x32_bf16 v[92:95], a[72:75], a[44:47], v[92:95]
ds_read_b64_tr_b16 a[30:31], v25 offset:1536
s_add_u32 m0, s55, 55488
v_mfma_f32_16x16x32_bf16 v[156:159], a[72:75], a[60:63], v[156:159]
buffer_load_dwordx4 v21, s[36:39], s52 offen lds
v_mfma_f32_16x16x32_bf16 v[160:163], a[76:79], a[60:63], v[160:163]
ds_read_b64_tr_b16 a[32:33], v25 offset:1056
v_mfma_f32_16x16x32_bf16 v[124:127], a[44:47], a[80:83], v[124:127]
ds_read_b64_tr_b16 a[34:35], v25 offset:1568
v_mfma_f32_16x16x32_bf16 v[140:143], a[44:47], a[84:87], v[140:143]
buffer_load_dwordx4 v28, s[36:39], s52 offen offset:1024 lds
v_mfma_f32_16x16x32_bf16 v[144:147], a[48:51], a[84:87], v[144:147]
ds_read_b64_tr_b16 a[36:37], v25 offset:2048
v_mfma_f32_16x16x32_bf16 v[128:131], a[48:51], a[80:83], v[128:131]
ds_read_b64_tr_b16 a[38:39], v25 offset:2560
ds_read_b64_tr_b16 a[40:41], v25 offset:2080
v_mfma_f32_16x16x32_bf16 v[132:135], a[52:55], a[80:83], v[132:135]
buffer_load_dword v22, s[36:39], s52 offen offset:2048 lds
v_mfma_f32_16x16x32_bf16 v[148:151], a[52:55], a[84:87], v[148:151]
s_add_u32 s52, s52, 128
v_mfma_f32_16x16x32_bf16 v[152:155], a[56:59], a[84:87], v[152:155]
ds_read_b64_tr_b16 a[42:43], v25 offset:2592
v_mfma_f32_16x16x32_bf16 v[136:139], a[56:59], a[80:83], v[136:139]
s_waitcnt vmcnt(15) lgkmcnt(8)
s_barrier
v_mfma_f32_16x16x32_bf16 v[60:63], a[20:23], a[0:3], v[60:63]
ds_read_b128 a[44:47], v30 offset:18496
s_add_u32 m0, s55, 57792
v_mfma_f32_16x16x32_bf16 v[76:79], a[24:27], a[0:3], v[76:79]
buffer_load_dwordx4 v21, s[36:39], s53 offen lds
v_mfma_f32_16x16x32_bf16 v[80:83], a[24:27], a[4:7], v[80:83]
s_sub_u32 s47, s47, 1
s_cbranch_scc1 .Lx5
.Lx5b:
v_mfma_f32_16x16x32_bf16 v[64:67], a[20:23], a[4:7], v[64:67]
buffer_load_dwordx4 v28, s[36:39], s53 offen offset:1024 lds
v_mfma_f32_16x16x32_bf16 v[68:71], a[20:23], a[8:11], v[68:71]
ds_read_b128 a[48:51], v30 offset:20800
v_mfma_f32_16x16x32_bf16 v[84:87], a[24:27], a[8:11], v[84:87]
ds_read_b128 a[52:55], v30 offset:23104
ds_read_b128 a[56:59], v30 offset:25408
v_mfma_f32_16x16x32_bf16 v[88:91], a[24:27], a[12:15], v[88:91]
buffer_load_dword v29, s[36:39], s53 offen offset:2048 lds
v_mfma_f32_16x16x32_bf16 v[72:75], a[20:23], a[12:15], v[72:75]
s_add_u32 s53, s53, 128
s_waitcnt lgkmcnt(4)
v_mfma_f32_16x16x32_bf16 v[244:247], a[20:23], a[16:19], v[244:247]
ds_read_b64_tr_b16 a[64:65], v25 offset:12416
s_add_u32 m0, s56, 123648
v_mfma_f32_16x16x32_bf16 v[104:107], a[28:31], a[12:15], v[104:107]
buffer_load_dwordx4 v18, s[20:23], s54 offen lds
v_mfma_f32_16x16x32_bf16 v[120:123], a[32:35], a[12:15], v[120:123]
ds_read_b64_tr_b16 a[66:67], v25 offset:12928
v_mfma_f32_16x16x32_bf16 v[116:119], a[32:35], a[8:11], v[116:119]
ds_read_b64_tr_b16 a[68:69], v25 offset:12448
ds_read_b64_tr_b16 a[70:71], v25 offset:12960
v_mfma_f32_16x16x32_bf16 v[100:103], a[28:31], a[8:11], v[100:103]
buffer_load_dwordx4 v19, s[20:23], s54 offen offset:1024 lds
v_mfma_f32_16x16x32_bf16 v[96:99], a[28:31], a[4:7], v[96:99]
ds_read_b128 a[60:63], v31 offset:18496
v_mfma_f32_16x16x32_bf16 v[112:115], a[32:35], a[4:7], v[112:115]
buffer_load_dwordx4 v20, s[20:23], s54 offen offset:2048 lds
v_mfma_f32_16x16x32_bf16 v[108:111], a[32:35], a[0:3], v[108:111]
ds_read_b64_tr_b16 a[72:73], v25 offset:13440
s_add_u32 s54, s54, 196608
v_mfma_f32_16x16x32_bf16 v[92:95], a[28:31], a[0:3], v[92:95]
s_add_u32 m0, s56, 136064
v_mfma_f32_16x16x32_bf16 v[156:159], a[28:31], a[16:19], v[156:159]
buffer_load_dwordx4 v18, s[20:23], s54 offen lds
v_mfma_f32_16x16x32_bf16 v[160:163], a[32:35], a[16:19], v[160:163]
ds_read_b64_tr_b16 a[74:75], v25 offset:13952
ds_read_b64_tr_b16 a[76:77], v25 offset:13472
v_mfma_f32_16x16x32_bf16 v[124:127], a[0:3], a[36:39], v[124:127]
ds_read_b64_tr_b16 a[78:79], v25 offset:13984
v_mfma_f32_16x16x32_bf16 v[140:143], a[0:3], a[40:43], v[140:143]
buffer_load_dwordx4 v19, s[20:23], s54 offen offset:1024 lds
v_mfma_f32_16x16x32_bf16 v[144:147], a[4:7], a[40:43], v[144:147]
ds_read_b64_tr_b16 a[80:81], v25 offset:14464
v_mfma_f32_16x16x32_bf16 v[128:131], a[4:7], a[36:39], v[128:131]
ds_read_b64_tr_b16 a[82:83], v25 offset:14976
ds_read_b64_tr_b16 a[84:85], v25 offset:14496
v_mfma_f32_16x16x32_bf16 v[132:135], a[8:11], a[36:39], v[132:135]
buffer_load_dwordx4 v20, s[20:23], s54 offen offset:2048 lds
v_mfma_f32_16x16x32_bf16 v[148:151], a[8:11], a[40:43], v[148:151]
s_add_u32 s54, s54, 196608
v_mfma_f32_16x16x32_bf16 v[152:155], a[12:15], a[40:43], v[152:155]
ds_read_b64_tr_b16 a[86:87], v25 offset:15008
v_mfma_f32_16x16x32_bf16 v[136:139], a[12:15], a[36:39], v[136:139]
s_waitcnt vmcnt(15) lgkmcnt(8)
s_barrier
v_mfma_f32_16x16x32_bf16 v[60:63], a[64:67], a[44:47], v[60:63]
ds_read_b128 a[0:3], v23 offset:36992
s_add_u32 m0, s55, 0
v_mfma_f32_16x16x32_bf16 v[76:79], a[68:71], a[44:47], v[76:79]
buffer_load_dwordx4 v21, s[36:39], s52 offen lds
v_mfma_f32_16x16x32_bf16 v[80:83], a[68:71], a[48:51], v[80:83]
ds_read_b128 a[4:7], v23 offset:39296
v_mfma_f32_16x16x32_bf16 v[64:67], a[64:67], a[48:51], v[64:67]
buffer_load_dwordx4 v28, s[36:39], s52 offen offset:1024 lds
v_mfma_f32_16x16x32_bf16 v[68:71], a[64:67], a[52:55], v[68:71]
ds_read_b128 a[8:11], v23 offset:41600
ds_read_b128 a[12:15], v23 offset:43904
v_mfma_f32_16x16x32_bf16 v[84:87], a[68:71], a[52:55], v[84:87]
ds_read_b64_tr_b16 a[20:21], v25 offset:24832
v_mfma_f32_16x16x32_bf16 v[88:91], a[68:71], a[56:59], v[88:91]
buffer_load_dword v22, s[36:39], s52 offen offset:2048 lds
v_mfma_f32_16x16x32_bf16 v[72:75], a[64:67], a[56:59], v[72:75]
s_add_u32 s52, s52, 128
s_add_u32 m0, s55, 2304
s_waitcnt lgkmcnt(5)
v_mfma_f32_16x16x32_bf16 v[244:247], a[64:67], a[60:63], v[244:247]
buffer_load_dwordx4 v21, s[36:39], s53 offen lds
v_mfma_f32_16x16x32_bf16 v[104:107], a[72:75], a[56:59], v[104:107]
ds_read_b64_tr_b16 a[22:23], v25 offset:25344
v_mfma_f32_16x16x32_bf16 v[120:123], a[76:79], a[56:59], v[120:123]
ds_read_b64_tr_b16 a[24:25], v25 offset:24864
ds_read_b64_tr_b16 a[26:27], v25 offset:25376
v_mfma_f32_16x16x32_bf16 v[116:119], a[76:79], a[52:55], v[116:119]
buffer_load_dwordx4 v28, s[36:39], s53 offen offset:1024 lds
v_mfma_f32_16x16x32_bf16 v[100:103], a[72:75], a[52:55], v[100:103]
ds_read_b128 a[16:19], v24 offset:36992
v_mfma_f32_16x16x32_bf16 v[96:99], a[72:75], a[48:51], v[96:99]
buffer_load_dword v29, s[36:39], s53 offen offset:2048 lds
v_mfma_f32_16x16x32_bf16 v[112:115], a[76:79], a[48:51], v[112:115]
ds_read_b64_tr_b16 a[28:29], v25 offset:25856
s_add_u32 s53, s53, 128
v_mfma_f32_16x16x32_bf16 v[108:111], a[76:79], a[44:47], v[108:111]
s_add_u32 m0, s56, 73984
v_mfma_f32_16x16x32_bf16 v[92:95], a[72:75], a[44:47], v[92:95]
buffer_load_dwordx4 v18, s[20:23], s54 offen lds
v_mfma_f32_16x16x32_bf16 v[156:159], a[72:75], a[60:63], v[156:159]
ds_read_b64_tr_b16 a[30:31], v25 offset:26368
ds_read_b64_tr_b16 a[32:33], v25 offset:25888
v_mfma_f32_16x16x32_bf16 v[160:163], a[76:79], a[60:63], v[160:163]
buffer_load_dwordx4 v19, s[20:23], s54 offen offset:1024 lds
v_mfma_f32_16x16x32_bf16 v[124:127], a[44:47], a[80:83], v[124:127]
ds_read_b64_tr_b16 a[34:35], v25 offset:26400
v_mfma_f32_16x16x32_bf16 v[140:143], a[44:47], a[84:87], v[140:143]
ds_read_b64_tr_b16 a[36:37], v25 offset:26880
v_mfma_f32_16x16x32_bf16 v[144:147], a[48:51], a[84:87], v[144:147]
buffer_load_dwordx4 v20, s[20:23], s54 offen offset:2048 lds
v_mfma_f32_16x16x32_bf16 v[128:131], a[48:51], a[80:83], v[128:131]
ds_read_b64_tr_b16 a[38:39], v25 offset:27392
s_add_u32 s54, s54, 196608
v_mfma_f32_16x16x32_bf16 v[132:135], a[52:55], a[80:83], v[132:135]
buffer_load_dword v37, v34, s[40:43], 0 offen sc1
v_mfma_f32_16x16x32_bf16 v[148:151], a[52:55], a[84:87], v[148:151]
ds_read_b64_tr_b16 a[40:41], v25 offset:26912
v_mfma_f32_16x16x32_bf16 v[152:155], a[56:59], a[84:87], v[152:155]
ds_read_b64_tr_b16 a[42:43], v25 offset:27424
v_mfma_f32_16x16x32_bf16 v[136:139], a[56:59], a[80:83], v[136:139]
s_waitcnt vmcnt(22) lgkmcnt(8)
s_barrier
v_mfma_f32_16x16x32_bf16 v[60:63], a[20:23], a[0:3], v[60:63]
ds_read_b128 a[44:47], v30 offset:36992
s_add_u32 m0, s56, 86400
v_mfma_f32_16x16x32_bf16 v[76:79], a[24:27], a[0:3], v[76:79]
buffer_load_dwordx4 v18, s[20:23], s54 offen lds
v_mfma_f32_16x16x32_bf16 v[80:83], a[24:27], a[4:7], v[80:83]
s_sub_u32 s47, s47, 1
s_cbranch_scc1 .Lx6
.Lx6b:
v_mfma_f32_16x16x32_bf16 v[64:67], a[20:23], a[4:7], v[64:67]
buffer_load_dwordx4 v19, s[20:23], s54 offen offset:1024 lds
v_mfma_f32_16x16x32_bf16 v[68:71], a[20:23], a[8:11], v[68:71]
ds_read_b128 a[48:51], v30 offset:39296
v_mfma_f32_16x16x32_bf16 v[84:87], a[24:27], a[8:11], v[84:87]
ds_read_b128 a[52:55], v30 offset:41600
ds_read_b128 a[56:59], v30 offset:43904
v_mfma_f32_16x16x32_bf16 v[88:91], a[24:27], a[12:15], v[88:91]
buffer_load_dwordx4 v20, s[20:23], s54 offen offset:2048 lds
v_mfma_f32_16x16x32_bf16 v[72:75], a[20:23], a[12:15], v[72:75]
s_add_u32 s54, s54, 196608
s_waitcnt lgkmcnt(4)
v_mfma_f32_16x16x32_bf16 v[244:247], a[20:23], a[16:19], v[244:247]
ds_read_b64_tr_b16 a[64:65], v25 offset:37248
s_add_u32 m0, s55, 18496
v_mfma_f32_16x16x32_bf16 v[104:107], a[28:31], a[12:15], v[104:107]
buffer_load_dwordx4 v21, s[36:39], s52 offen lds
v_mfma_f32_16x16x32_bf16 v[120:123], a[32:35], a[12:15], v[120:123]
ds_read_b64_tr_b16 a[66:67], v25 offset:37760
v_mfma_f32_16x16x32_bf16 v[116:119], a[32:35], a[8:11], v[116:119]
ds_read_b64_tr_b16 a[68:69], v25 offset:37280
ds_read_b64_tr_b16 a[70:71], v25 offset:37792
v_mfma_f32_16x16x32_bf16 v[100:103], a[28:31], a[8:11], v[100:103]
buffer_load_dwordx4 v28, s[36:39], s52 offen offset:1024 lds
v_mfma_f32_16x16x32_bf16 v[96:99], a[28:31], a[4:7], v[96:99]
ds_read_b128 a[60:63], v31 offset:36992
v_mfma_f32_16x16x32_bf16 v[112:115], a[32:35], a[4:7], v[112:115]
buffer_load_dword v22, s[36:39], s52 offen offset:2048 lds
v_mfma_f32_16x16x32_bf16 v[108:111], a[32:35], a[0:3], v[108:111]
ds_read_b64_tr_b16 a[72:73], v25 offset:38272
s_add_u32 s52, s52, 128
v_mfma_f32_16x16x32_bf16 v[92:95], a[28:31], a[0:3], v[92:95]
s_add_u32 m0, s55, 20800
v_mfma_f32_16x16x32_bf16 v[156:159], a[28:31], a[16:19], v[156:159]
buffer_load_dwordx4 v21, s[36:39], s53 offen lds
v_mfma_f32_16x16x32_bf16 v[160:163], a[32:35], a[16:19], v[160:163]
ds_read_b64_tr_b16 a[74:75], v25 offset:38784
ds_read_b64_tr_b16 a[76:77], v25 offset:38304
v_mfma_f32_16x16x32_bf16 v[124:127], a[0:3], a[36:39], v[124:127]
ds_read_b64_tr_b16 a[78:79], v25 offset:38816
v_mfma_f32_16x16x32_bf16 v[140:143], a[0:3], a[40:43], v[140:143]
buffer_load_dwordx4 v28, s[36:39], s53 offen offset:1024 lds
v_mfma_f32_16x16x32_bf16 v[144:147], a[4:7], a[40:43], v[144:147]
ds_read_b64_tr_b16 a[80:81], v25 offset:39296
v_mfma_f32_16x16x32_bf16 v[128:131], a[4:7], a[36:39], v[128:131]
ds_read_b64_tr_b16 a[82:83], v25 offset:39808
ds_read_b64_tr_b16 a[84:85], v25 offset:39328
v_mfma_f32_16x16x32_bf16 v[132:135], a[8:11], a[36:39], v[132:135]
buffer_load_dword v29, s[36:39], s53 offen offset:2048 lds
v_mfma_f32_16x16x32_bf16 v[148:151], a[8:11], a[40:43], v[148:151]
s_add_u32 s53, s53, 128
v_mfma_f32_16x16x32_bf16 v[152:155], a[12:15], a[40:43], v[152:155]
ds_read_b64_tr_b16 a[86:87], v25 offset:39840
v_mfma_f32_16x16x32_bf16 v[136:139], a[12:15], a[36:39], v[136:139]
s_waitcnt vmcnt(22) lgkmcnt(8)
s_barrier
v_mfma_f32_16x16x32_bf16 v[60:63], a[64:67], a[44:47], v[60:63]
ds_read_b128 a[0:3], v23 offset:55488
s_add_u32 m0, s56, 98816
v_mfma_f32_16x16x32_bf16 v[76:79], a[68:71], a[44:47], v[76:79]
buffer_load_dwordx4 v18, s[20:23], s54 offen lds
v_mfma_f32_16x16x32_bf16 v[80:83], a[68:71], a[48:51], v[80:83]
ds_read_b128 a[4:7], v23 offset:57792
v_mfma_f32_16x16x32_bf16 v[64:67], a[64:67], a[48:51], v[64:67]
ds_read_b128 a[8:11], v23 offset:60096
v_mfma_f32_16x16x32_bf16 v[68:71], a[64:67], a[52:55], v[68:71]
ds_read_b128 a[12:15], v23 offset:62400
v_mfma_f32_16x16x32_bf16 v[84:87], a[68:71], a[52:55], v[84:87]
buffer_load_dwordx4 v19, s[20:23], s54 offen offset:1024 lds
v_mfma_f32_16x16x32_bf16 v[88:91], a[68:71], a[56:59], v[88:91]
ds_read_b64_tr_b16 a[20:21], v25 offset:49664
v_mfma_f32_16x16x32_bf16 v[72:75], a[64:67], a[56:59], v[72:75]
ds_read_b64_tr_b16 a[22:23], v25 offset:50176
s_waitcnt lgkmcnt(6)
v_mfma_f32_16x16x32_bf16 v[244:247], a[64:67], a[60:63], v[244:247]
v_mfma_f32_16x16x32_bf16 v[104:107], a[72:75], a[56:59], v[104:107]
buffer_load_dwordx4 v20, s[20:23], s54 offen offset:2048 lds
v_mfma_f32_16x16x32_bf16 v[120:123], a[76:79], a[56:59], v[120:123]
ds_read_b64_tr_b16 a[24:25], v25 offset:49696
s_add_u32 s54, s54, 196608
v_mfma_f32_16x16x32_bf16 v[116:119], a[76:79], a[52:55], v[116:119]
ds_read_b64_tr_b16 a[26:27], v25 offset:50208
v_mfma_f32_16x16x32_bf16 v[100:103], a[72:75], a[52:55], v[100:103]
ds_read_b128 a[16:19], v24 offset:55488
s_add_u32 m0, s55, 36992
v_mfma_f32_16x16x32_bf16 v[96:99], a[72:75], a[48:51], v[96:99]
buffer_load_dwordx4 v21, s[36:39], s52 offen lds
v_mfma_f32_16x16x32_bf16 v[112:115], a[76:79], a[48:51], v[112:115]
ds_read_b64_tr_b16 a[28:29], v25 offset:50688
v_mfma_f32_16x16x32_bf16 v[108:111], a[76:79], a[44:47], v[108:111]
ds_read_b64_tr_b16 a[30:31], v25 offset:51200
v_mfma_f32_16x16x32_bf16 v[92:95], a[72:75], a[44:47], v[92:95]
ds_read_b64_tr_b16 a[32:33], v25 offset:50720
v_mfma_f32_16x16x32_bf16 v[156:159], a[72:75], a[60:63], v[156:159]
buffer_load_dwordx4 v28, s[36:39], s52 offen offset:1024 lds
v_mfma_f32_16x16x32_bf16 v[160:163], a[76:79], a[60:63], v[160:163]
v_mfma_f32_16x16x32_bf16 v[124:127], a[44:47], a[80:83], v[124:127]
ds_read_b64_tr_b16 a[34:35], v25 offset:51232
v_mfma_f32_16x16x32_bf16 v[140:143], a[44:47], a[84:87], v[140:143]
ds_read_b64_tr_b16 a[36:37], v25 offset:51712
v_mfma_f32_16x16x32_bf16 v[144:147], a[48:51], a[84:87], v[144:147]
buffer_load_dword v22, s[36:39], s52 offen offset:2048 lds
v_mfma_f32_16x16x32_bf16 v[128:131], a[48:51], a[80:83], v[128:131]
ds_read_b64_tr_b16 a[38:39], v25 offset:52224
s_add_u32 s52, s52, 128
v_mfma_f32_16x16x32_bf16 v[132:135], a[52:55], a[80:83], v[132:135]
ds_read_b64_tr_b16 a[40:41], v25 offset:51744
v_mfma_f32_16x16x32_bf16 v[148:151], a[52:55], a[84:87], v[148:151]
ds_read_b64_tr_b16 a[42:43], v25 offset:52256
v_mfma_f32_16x16x32_bf16 v[152:155], a[56:59], a[84:87], v[152:155]
v_mfma_f32_16x16x32_bf16 v[136:139], a[56:59], a[80:83], v[136:139]
s_waitcnt vmcnt(25) lgkmcnt(8)
s_barrier
v_mfma_f32_16x16x32_bf16 v[60:63], a[20:23], a[0:3], v[60:63]
ds_read_b128 a[44:47], v30 offset:55488
s_add_u32 m0, s56, 111232
v_mfma_f32_16x16x32_bf16 v[76:79], a[24:27], a[0:3], v[76:79]
buffer_load_dwordx4 v18, s[20:23], s54 offen lds
v_mfma_f32_16x16x32_bf16 v[80:83], a[24:27], a[4:7], v[80:83]
s_sub_u32 s47, s47, 1
s_cbranch_scc1 .Lx7
.Lx7b:
v_mfma_f32_16x16x32_bf16 v[64:67], a[20:23], a[4:7], v[64:67]
ds_read_b128 a[48:51], v30 offset:57792
v_mfma_f32_16x16x32_bf16 v[68:71], a[20:23], a[8:11], v[68:71]
ds_read_b128 a[52:55], v30 offset:60096
v_mfma_f32_16x16x32_bf16 v[84:87], a[24:27], a[8:11], v[84:87]
buffer_load_dwordx4 v19, s[20:23], s54 offen offset:1024 lds
v_mfma_f32_16x16x32_bf16 v[88:91], a[24:27], a[12:15], v[88:91]
ds_read_b128 a[56:59], v30 offset:62400
v_mfma_f32_16x16x32_bf16 v[72:75], a[20:23], a[12:15], v[72:75]
ds_read_b64_tr_b16 a[64:65], v25 offset:62080
s_waitcnt lgkmcnt(5)
v_mfma_f32_16x16x32_bf16 v[244:247], a[20:23], a[16:19], v[244:247]
ds_read_b64_tr_b16 a[66:67], v25 offset:62592
v_mfma_f32_16x16x32_bf16 v[104:107], a[28:31], a[12:15], v[104:107]
buffer_load_dwordx4 v20, s[20:23], s54 offen offset:2048 lds
v_mfma_f32_16x16x32_bf16 v[120:123], a[32:35], a[12:15], v[120:123]
ds_read_b64_tr_b16 a[68:69], v25 offset:62112
s_add_u32 s54, s54, 196608
v_mfma_f32_16x16x32_bf16 v[116:119], a[32:35], a[8:11], v[116:119]
ds_read_b64_tr_b16 a[70:71], v25 offset:62624
v_mfma_f32_16x16x32_bf16 v[100:103], a[28:31], a[8:11], v[100:103]
ds_read_b128 a[60:63], v31 offset:55488
s_add_u32 m0, s55, 39296
v_mfma_f32_16x16x32_bf16 v[96:99], a[28:31], a[4:7], v[96:99]
buffer_load_dwordx4 v21, s[36:39], s53 offen lds
v_mfma_f32_16x16x32_bf16 v[112:115], a[32:35], a[4:7], v[112:115]
v_mfma_f32_16x16x32_bf16 v[108:111], a[32:35], a[0:3], v[108:111]
ds_read_b64_tr_b16 a[72:73], v25 offset:63104
v_mfma_f32_16x16x32_bf16 v[92:95], a[28:31], a[0:3], v[92:95]
ds_read_b64_tr_b16 a[74:75], v25 offset:63616
v_mfma_f32_16x16x32_bf16 v[156:159], a[28:31], a[16:19], v[156:159]
buffer_load_dwordx4 v28, s[36:39], s53 offen offset:1024 lds
v_mfma_f32_16x16x32_bf16 v[160:163], a[32:35], a[16:19], v[160:163]
ds_read_b64_tr_b16 a[76:77], v25 offset:63136
v_mfma_f32_16x16x32_bf16 v[124:127], a[0:3], a[36:39], v[124:127]
ds_read_b64_tr_b16 a[78:79], v25 offset:63648
v_mfma_f32_16x16x32_bf16 v[140:143], a[0:3], a[40:43], v[140:143]
ds_read_b64_tr_b16 a[80:81], v25 offset:64128
v_mfma_f32_16x16x32_bf16 v[144:147], a[4:7], a[40:43], v[144:147]
buffer_load_dword v29, s[36:39], s53 offen offset:2048 lds
v_mfma_f32_16x16x32_bf16 v[128:131], a[4:7], a[36:39], v[128:131]
ds_read_b64_tr_b16 a[82:83], v25 offset:64640
s_add_u32 s53, s53, 128
v_mfma_f32_16x16x32_bf16 v[132:135], a[8:11], a[36:39], v[132:135]
ds_read_b64_tr_b16 a[84:85], v25 offset:64160
v_mfma_f32_16x16x32_bf16 v[148:151], a[8:11], a[40:43], v[148:151]
ds_read_b64_tr_b16 a[86:87], v25 offset:64672
v_mfma_f32_16x16x32_bf16 v[152:155], a[12:15], a[40:43], v[152:155]
v_mfma_f32_16x16x32_bf16 v[136:139], a[12:15], a[36:39], v[136:139]
s_waitcnt vmcnt(22) lgkmcnt(8)
s_barrier
s_waitcnt vmcnt(21)
v_cmp_ne_u32 vcc, v35, v37
s_nop 0
s_cbranch_vccnz .Lsp8
.Lsp8b:
v_mov_b32 v37, 0
v_mfma_f32_16x16x32_bf16 v[60:63], a[64:67], a[44:47], v[60:63]
ds_read_b128 a[0:3], v23
v_mfma_f32_16x16x32_bf16 v[76:79], a[68:71], a[44:47], v[76:79]
buffer_atomic_add v38, v32, s[16:19], 0 offen
v_mfma_f32_16x16x32_bf16 v[80:83], a[68:71], a[48:51], v[80:83]
ds_read_b128 a[4:7], v23 offset:2304
v_mfma_f32_16x16x32_bf16 v[64:67], a[64:67], a[48:51], v[64:67]
ds_read_b128 a[8:11], v23 offset:4608
s_add_u32 m0, s56, 123648
v_mfma_f32_16x16x32_bf16 v[68:71], a[64:67], a[52:55], v[68:71]
buffer_load_dwordx4 v18, s[20:23], s54 offen lds
v_mfma_f32_16x16x32_bf16 v[84:87], a[68:71], a[52:55], v[84:87]
ds_read_b128 a[12:15], v23 offset:6912
v_mfma_f32_16x16x32_bf16 v[88:91], a[68:71], a[56:59], v[88:91]
ds_read_b64_tr_b16 a[20:21], v25
v_mfma_f32_16x16x32_bf16 v[72:75], a[64:67], a[56:59], v[72:75]
ds_read_b64_tr_b16 a[22:23], v25 offset:512
s_waitcnt lgkmcnt(6)
v_mfma_f32_16x16x32_bf16 v[244:247], a[64:67], a[60:63], v[244:247]
buffer_load_dwordx4 v19, s[20:23], s54 offen offset:1024 lds
v_mfma_f32_16x16x32_bf16 v[104:107], a[72:75], a[56:59], v[104:107]
ds_read_b64_tr_b16 a[24:25], v25 offset:32
v_mfma_f32_16x16x32_bf16 v[120:123], a[76:79], a[56:59], v[120:123]
ds_read_b64_tr_b16 a[26:27], v25 offset:544
v_mfma_f32_16x16x32_bf16 v[116:119], a[76:79], a[52:55], v[116:119]
buffer_load_dwordx4 v20, s[20:23], s54 offen offset:2048 lds
v_mfma_f32_16x16x32_bf16 v[100:103], a[72:75], a[52:55], v[100:103]
ds_read_b128 a[16:19], v24
s_add_u32 s54, s54, 196608
v_mfma_f32_16x16x32_bf16 v[96:99], a[72:75], a[48:51], v[96:99]
v_mfma_f32_16x16x32_bf16 v[112:115], a[76:79], a[48:51], v[112:115]
ds_read_b64_tr_b16 a[28:29], v25 offset:1024
s_add_u32 m0, s55, 55488
v_mfma_f32_16x16x32_bf16 v[108:111], a[76:79], a[44:47], v[108:111]
buffer_load_dwordx4 v21, s[36:39], s52 offen lds
v_mfma_f32_16x16x32_bf16 v[92:95], a[72:75], a[44:47], v[92:95]
ds_read_b64_tr_b16 a[30:31], v25 offset:1536
v_mfma_f32_16x16x32_bf16 v[156:159], a[72:75], a[60:63], v[156:159]
ds_read_b64_tr_b16 a[32:33], v25 offset:1056
v_mfma_f32_16x16x32_bf16 v[160:163], a[76:79], a[60:63], v[160:163]
buffer_load_dwordx4 v28, s[36:39], s52 offen offset:1024 lds
v_mfma_f32_16x16x32_bf16 v[124:127], a[44:47], a[80:83], v[124:127]
ds_read_b64_tr_b16 a[34:35], v25 offset:1568
v_mfma_f32_16x16x32_bf16 v[140:143], a[44:47], a[84:87], v[140:143]
ds_read_b64_tr_b16 a[36:37], v25 offset:2048
v_mfma_f32_16x16x32_bf16 v[144:147], a[48:51], a[84:87], v[144:147]
ds_read_b64_tr_b16 a[38:39], v25 offset:2560
v_mfma_f32_16x16x32_bf16 v[128:131], a[48:51], a[80:83], v[128:131]
buffer_load_dword v22, s[36:39], s52 offen offset:2048 lds
v_mfma_f32_16x16x32_bf16 v[132:135], a[52:55], a[80:83], v[132:135]
ds_read_b64_tr_b16 a[40:41], v25 offset:2080
s_add_u32 s52, s52, 128
v_mfma_f32_16x16x32_bf16 v[148:151], a[52:55], a[84:87], v[148:151]
ds_read_b64_tr_b16 a[42:43], v25 offset:2592
v_mfma_f32_16x16x32_bf16 v[152:155], a[56:59], a[84:87], v[152:155]
v_mfma_f32_16x16x32_bf16 v[136:139], a[56:59], a[80:83], v[136:139]
s_waitcnt vmcnt(25) lgkmcnt(8)
s_barrier
v_mfma_f32_16x16x32_bf16 v[60:63], a[20:23], a[0:3], v[60:63]
ds_read_b128 a[44:47], v30
s_add_u32 m0, s56, 136064
v_mfma_f32_16x16x32_bf16 v[76:79], a[24:27], a[0:3], v[76:79]
buffer_load_dwordx4 v18, s[20:23], s54 offen lds
v_mfma_f32_16x16x32_bf16 v[80:83], a[24:27], a[4:7], v[80:83]
s_sub_u32 s47, s47, 1
s_cbranch_scc1 .Lx9
.Lx9b:
v_mfma_f32_16x16x32_bf16 v[64:67], a[20:23], a[4:7], v[64:67]
ds_read_b128 a[48:51], v30 offset:2304
v_mfma_f32_16x16x32_bf16 v[68:71], a[20:23], a[8:11], v[68:71]
ds_read_b128 a[52:55], v30 offset:4608
v_mfma_f32_16x16x32_bf16 v[84:87], a[24:27], a[8:11], v[84:87]
buffer_load_dwordx4 v19, s[20:23], s54 offen offset:1024 lds
v_mfma_f32_16x16x32_bf16 v[88:91], a[24:27], a[12:15], v[88:91]
ds_read_b128 a[56:59], v30 offset:6912
v_mfma_f32_16x16x32_bf16 v[72:75], a[20:23], a[12:15], v[72:75]
ds_read_b64_tr_b16 a[64:65], v25 offset:12416
s_waitcnt lgkmcnt(5)
v_mfma_f32_16x16x32_bf16 v[244:247], a[20:23], a[16:19], v[244:247]
ds_read_b64_tr_b16 a[66:67], v25 offset:12928
v_mfma_f32_16x16x32_bf16 v[104:107], a[28:31], a[12:15], v[104:107]
buffer_load_dwordx4 v20, s[20:23], s54 offen offset:2048 lds
v_mfma_f32_16x16x32_bf16 v[120:123], a[32:35], a[12:15], v[120:123]
ds_read_b64_tr_b16 a[68:69], v25 offset:12448
s_add_u32 s54, s54, 196608
v_mfma_f32_16x16x32_bf16 v[116:119], a[32:35], a[8:11], v[116:119]
ds_read_b64_tr_b16 a[70:71], v25 offset:12960
v_mfma_f32_16x16x32_bf16 v[100:103], a[28:31], a[8:11], v[100:103]
ds_read_b128 a[60:63], v31
s_add_u32 m0, s55, 57792
v_mfma_f32_16x16x32_bf16 v[96:99], a[28:31], a[4:7], v[96:99]
buffer_load_dwordx4 v21, s[36:39], s53 offen lds
v_mfma_f32_16x16x32_bf16 v[112:115], a[32:35], a[4:7], v[112:115]
v_mfma_f32_16x16x32_bf16 v[108:111], a[32:35], a[0:3], v[108:111]
ds_read_b64_tr_b16 a[72:73], v25 offset:13440
v_mfma_f32_16x16x32_bf16 v[92:95], a[28:31], a[0:3], v[92:95]
ds_read_b64_tr_b16 a[74:75], v25 offset:13952
v_mfma_f32_16x16x32_bf16 v[156:159], a[28:31], a[16:19], v[156:159]
buffer_load_dwordx4 v28, s[36:39], s53 offen offset:1024 lds
v_mfma_f32_16x16x32_bf16 v[160:163], a[32:35], a[16:19], v[160:163]
ds_read_b64_tr_b16 a[76:77], v25 offset:13472
v_mfma_f32_16x16x32_bf16 v[124:127], a[0:3], a[36:39], v[124:127]
ds_read_b64_tr_b16 a[78:79], v25 offset:13984
v_mfma_f32_16x16x32_bf16 v[140:143], a[0:3], a[40:43], v[140:143]
ds_read_b64_tr_b16 a[80:81], v25 offset:14464
v_mfma_f32_16x16x32_bf16 v[144:147], a[4:7], a[40:43], v[144:147]
buffer_load_dword v29, s[36:39], s53 offen offset:2048 lds
v_mfma_f32_16x16x32_bf16 v[128:131], a[4:7], a[36:39], v[128:131]
ds_read_b64_tr_b16 a[82:83], v25 offset:14976
s_add_u32 s53, s53, 128
v_mfma_f32_16x16x32_bf16 v[132:135], a[8:11], a[36:39], v[132:135]
ds_read_b64_tr_b16 a[84:85], v25 offset:14496
v_mfma_f32_16x16x32_bf16 v[148:151], a[8:11], a[40:43], v[148:151]
ds_read_b64_tr_b16 a[86:87], v25 offset:15008
v_mfma_f32_16x16x32_bf16 v[152:155], a[12:15], a[40:43], v[152:155]
v_mfma_f32_16x16x32_bf16 v[136:139], a[12:15], a[36:39], v[136:139]
s_waitcnt vmcnt(22) lgkmcnt(8)
s_barrier
v_mfma_f32_16x16x32_bf16 v[60:63], a[64:67], a[44:47], v[60:63]
ds_read_b128 a[0:3], v23 offset:18496
s_add_u32 m0, s56, 73984
v_mfma_f32_16x16x32_bf16 v[76:79], a[68:71], a[44:47], v[76:79]
buffer_load_dwordx4 v18, s[20:23], s54 offen lds
v_mfma_f32_16x16x32_bf16 v[80:83], a[68:71], a[48:51], v[80:83]
ds_read_b128 a[4:7], v23 offset:20800
v_mfma_f32_16x16x32_bf16 v[64:67], a[64:67], a[48:51], v[64:67]
ds_read_b128 a[8:11], v23 offset:23104
v_mfma_f32_16x16x32_bf16 v[68:71], a[64:67], a[52:55], v[68:71]
ds_read_b128 a[12:15], v23 offset:25408
v_mfma_f32_16x16x32_bf16 v[84:87], a[68:71], a[52:55], v[84:87]
buffer_load_dwordx4 v19, s[20:23], s54 offen offset:1024 lds
v_mfma_f32_16x16x32_bf16 v[88:91], a[68:71], a[56:59], v[88:91]
ds_read_b64_tr_b16 a[20:21], v25 offset:24832
v_mfma_f32_16x16x32_bf16 v[72:75], a[64:67], a[56:59], v[72:75]
ds_read_b64_tr_b16 a[22:23], v25 offset:25344
s_waitcnt lgkmcnt(6)
v_mfma_f32_16x16x32_bf16 v[244:247], a[64:67], a[60:63], v[244:247]
v_mfma_f32_16x16x32_bf16 v[104:107], a[72:75], a[56:59], v[104:107]
buffer_load_dwordx4 v20, s[20:23], s54 offen offset:2048 lds
v_mfma_f32_16x16x32_bf16 v[120:123], a[76:79], a[56:59], v[120:123]
ds_read_b64_tr_b16 a[24:25], v25 offset:24864
s_add_u32 s54, s54, 196608
v_mfma_f32_16x16x32_bf16 v[116:119], a[76:79], a[52:55], v[116:119]
ds_read_b64_tr_b16 a[26:27], v25 offset:25376
v_mfma_f32_16x16x32_bf16 v[100:103], a[72:75], a[52:55], v[100:103]
ds_read_b128 a[16:19], v24 offset:18496
s_add_u32 m0, s55, 0
v_mfma_f32_16x16x32_bf16 v[96:99], a[72:75], a[48:51], v[96:99]
buffer_load_dwordx4 v21, s[36:39], s52 offen lds
v_mfma_f32_16x16x32_bf16 v[112:115], a[76:79], a[48:51], v[112:115]
ds_read_b64_tr_b16 a[28:29], v25 offset:25856
v_mfma_f32_16x16x32_bf16 v[108:111], a[76:79], a[44:47], v[108:111]
ds_read_b64_tr_b16 a[30:31], v25 offset:26368
v_mfma_f32_16x16x32_bf16 v[92:95], a[72:75], a[44:47], v[92:95]
ds_read_b64_tr_b16 a[32:33], v25 offset:25888
v_mfma_f32_16x16x32_bf16 v[156:159], a[72:75], a[60:63], v[156:159]
buffer_load_dwordx4 v28, s[36:39], s52 offen offset:1024 lds
v_mfma_f32_16x16x32_bf16 v[160:163], a[76:79], a[60:63], v[160:163]
v_mfma_f32_16x16x32_bf16 v[124:127], a[44:47], a[80:83], v[124:127]
ds_read_b64_tr_b16 a[34:35], v25 offset:26400
v_mfma_f32_16x16x32_bf16 v[140:143], a[44:47], a[84:87], v[140:143]
ds_read_b64_tr_b16 a[36:37], v25 offset:26880
v_mfma_f32_16x16x32_bf16 v[144:147], a[48:51], a[84:87], v[144:147]
buffer_load_dword v22, s[36:39], s52 offen offset:2048 lds
v_mfma_f32_16x16x32_bf16 v[128:131], a[48:51], a[80:83], v[128:131]
ds_read_b64_tr_b16 a[38:39], v25 offset:27392
s_add_u32 s52, s52, 128
v_mfma_f32_16x16x32_bf16 v[132:135], a[52:55], a[80:83], v[132:135]
ds_read_b64_tr_b16 a[40:41], v25 offset:26912
v_mfma_f32_16x16x32_bf16 v[148:151], a[52:55], a[84:87], v[148:151]
ds_read_b64_tr_b16 a[42:43], v25 offset:27424
v_mfma_f32_16x16x32_bf16 v[152:155], a[56:59], a[84:87], v[152:155]
v_mfma_f32_16x16x32_bf16 v[136:139], a[56:59], a[80:83], v[136:139]
s_waitcnt vmcnt(22) lgkmcnt(8)
s_barrier
v_mfma_f32_16x16x32_bf16 v[60:63], a[20:23], a[0:3], v[60:63]
ds_read_b128 a[44:47], v30 offset:18496
s_add_u32 m0, s56, 86400
v_mfma_f32_16x16x32_bf16 v[76:79], a[24:27], a[0:3], v[76:79]
buffer_load_dwordx4 v18, s[20:23], s54 offen lds
v_mfma_f32_16x16x32_bf16 v[80:83], a[24:27], a[4:7], v[80:83]
s_sub_u32 s47, s47, 1
s_cbranch_scc1 .Lx10
.Lx10b:
v_mfma_f32_16x16x32_bf16 v[64:67], a[20:23], a[4:7], v[64:67]
ds_read_b128 a[48:51], v30 offset:20800
v_mfma_f32_16x16x32_bf16 v[68:71], a[20:23], a[8:11], v[68:71]
ds_read_b128 a[52:55], v30 offset:23104
v_mfma_f32_16x16x32_bf16 v[84:87], a[24:27], a[8:11], v[84:87]
buffer_load_dwordx4 v19, s[20:23], s54 offen offset:1024 lds
v_mfma_f32_16x16x32_bf16 v[88:91], a[24:27], a[12:15], v[88:91]
ds_read_b128 a[56:59], v30 offset:25408
v_mfma_f32_16x16x32_bf16 v[72:75], a[20:23], a[12:15], v[72:75]
ds_read_b64_tr_b16 a[64:65], v25 offset:37248
s_waitcnt lgkmcnt(5)
v_mfma_f32_16x16x32_bf16 v[244:247], a[20:23], a[16:19], v[244:247]
ds_read_b64_tr_b16 a[66:67], v25 offset:37760
v_mfma_f32_16x16x32_bf16 v[104:107], a[28:31], a[12:15], v[104:107]
buffer_load_dwordx4 v20, s[20:23], s54 offen offset:2048 lds
v_mfma_f32_16x16x32_bf16 v[120:123], a[32:35], a[12:15], v[120:123]
ds_read_b64_tr_b16 a[68:69], v25 offset:37280
s_add_u32 s54, s54, 196608
v_mfma_f32_16x16x32_bf16 v[116:119], a[32:35], a[8:11], v[116:119]
ds_read_b64_tr_b16 a[70:71], v25 offset:37792
v_mfma_f32_16x16x32_bf16 v[100:103], a[28:31], a[8:11], v[100:103]
ds_read_b128 a[60:63], v31 offset:18496
s_add_u32 m0, s55, 2304
v_mfma_f32_16x16x32_bf16 v[96:99], a[28:31], a[4:7], v[96:99]
buffer_load_dwordx4 v21, s[36:39], s53 offen lds
v_mfma_f32_16x16x32_bf16 v[112:115], a[32:35], a[4:7], v[112:115]
v_mfma_f32_16x16x32_bf16 v[108:111], a[32:35], a[0:3], v[108:111]
ds_read_b64_tr_b16 a[72:73], v25 offset:38272
v_mfma_f32_16x16x32_bf16 v[92:95], a[28:31], a[0:3], v[92:95]
ds_read_b64_tr_b16 a[74:75], v25 offset:38784
v_mfma_f32_16x16x32_bf16 v[156:159], a[28:31], a[16:19], v[156:159]
buffer_load_dwordx4 v28, s[36:39], s53 offen offset:1024 lds
v_mfma_f32_16x16x32_bf16 v[160:163], a[32:35], a[16:19], v[160:163]
ds_read_b64_tr_b16 a[76:77], v25 offset:38304
v_mfma_f32_16x16x32_bf16 v[124:127], a[0:3], a[36:39], v[124:127]
ds_read_b64_tr_b16 a[78:79], v25 offset:38816
v_mfma_f32_16x16x32_bf16 v[140:143], a[0:3], a[40:43], v[140:143]
ds_read_b64_tr_b16 a[80:81], v25 offset:39296
v_mfma_f32_16x16x32_bf16 v[144:147], a[4:7], a[40:43], v[144:147]
buffer_load_dword v29, s[36:39], s53 offen offset:2048 lds
v_mfma_f32_16x16x32_bf16 v[128:131], a[4:7], a[36:39], v[128:131]
ds_read_b64_tr_b16 a[82:83], v25 offset:39808
s_add_u32 s53, s53, 128
v_mfma_f32_16x16x32_bf16 v[132:135], a[8:11], a[36:39], v[132:135]
ds_read_b64_tr_b16 a[84:85], v25 offset:39328
v_mfma_f32_16x16x32_bf16 v[148:151], a[8:11], a[40:43], v[148:151]
ds_read_b64_tr_b16 a[86:87], v25 offset:39840
v_mfma_f32_16x16x32_bf16 v[152:155], a[12:15], a[40:43], v[152:155]
v_mfma_f32_16x16x32_bf16 v[136:139], a[12:15], a[36:39], v[136:139]
s_waitcnt vmcnt(21) lgkmcnt(8)
s_barrier
v_mfma_f32_16x16x32_bf16 v[60:63], a[64:67], a[44:47], v[60:63]
ds_read_b128 a[0:3], v23 offset:36992
s_add_u32 m0, s56, 98816
v_mfma_f32_16x16x32_bf16 v[76:79], a[68:71], a[44:47], v[76:79]
buffer_load_dwordx4 v18, s[20:23], s54 offen lds
v_mfma_f32_16x16x32_bf16 v[80:83], a[68:71], a[48:51], v[80:83]
ds_read_b128 a[4:7], v23 offset:39296
v_mfma_f32_16x16x32_bf16 v[64:67], a[64:67], a[48:51], v[64:67]
ds_read_b128 a[8:11], v23 offset:41600
v_mfma_f32_16x16x32_bf16 v[68:71], a[64:67], a[52:55], v[68:71]
ds_read_b128 a[12:15], v23 offset:43904
v_mfma_f32_16x16x32_bf16 v[84:87], a[68:71], a[52:55], v[84:87]
buffer_load_dwordx4 v19, s[20:23], s54 offen offset:1024 lds
v_mfma_f32_16x16x32_bf16 v[88:91], a[68:71], a[56:59], v[88:91]
ds_read_b64_tr_b16 a[20:21], v25 offset:49664
v_mfma_f32_16x16x32_bf16 v[72:75], a[64:67], a[56:59], v[72:75]
ds_read_b64_tr_b16 a[22:23], v25 offset:50176
s_waitcnt lgkmcnt(6)
v_mfma_f32_16x16x32_bf16 v[244:247], a[64:67], a[60:63], v[244:247]
v_mfma_f32_16x16x32_bf16 v[104:107], a[72:75], a[56:59], v[104:107]
buffer_load_dwordx4 v20, s[20:23], s54 offen offset:2048 lds
v_mfma_f32_16x16x32_bf16 v[120:123], a[76:79], a[56:59], v[120:123]
ds_read_b64_tr_b16 a[24:25], v25 offset:49696
s_add_u32 s54, s54, 196608
v_mfma_f32_16x16x32_bf16 v[116:119], a[76:79], a[52:55], v[116:119]
ds_read_b64_tr_b16 a[26:27], v25 offset:50208
v_mfma_f32_16x16x32_bf16 v[100:103], a[72:75], a[52:55], v[100:103]
ds_read_b128 a[16:19], v24 offset:36992
s_add_u32 m0, s55, 18496
v_mfma_f32_16x16x32_bf16 v[96:99], a[72:75], a[48:51], v[96:99]
buffer_load_dwordx4 v21, s[36:39], s52 offen lds
v_mfma_f32_16x16x32_bf16 v[112:115], a[76:79], a[48:51], v[112:115]
ds_read_b64_tr_b16 a[28:29], v25 offset:50688
v_mfma_f32_16x16x32_bf16 v[108:111], a[76:79], a[44:47], v[108:111]
ds_read_b64_tr_b16 a[30:31], v25 offset:51200
v_mfma_f32_16x16x32_bf16 v[92:95], a[72:75], a[44:47], v[92:95]
ds_read_b64_tr_b16 a[32:33], v25 offset:50720
v_mfma_f32_16x16x32_bf16 v[156:159], a[72:75], a[60:63], v[156:159]
buffer_load_dwordx4 v28, s[36:39], s52 offen offset:1024 lds
v_mfma_f32_16x16x32_bf16 v[160:163], a[76:79], a[60:63], v[160:163]
v_mfma_f32_16x16x32_bf16 v[124:127], a[44:47], a[80:83], v[124:127]
ds_read_b64_tr_b16 a[34:35], v25 offset:51232
v_mfma_f32_16x16x32_bf16 v[140:143], a[44:47], a[84:87], v[140:143]
ds_read_b64_tr_b16 a[36:37], v25 offset:51712
v_mfma_f32_16x16x32_bf16 v[144:147], a[48:51], a[84:87], v[144:147]
buffer_load_dword v22, s[36:39], s52 offen offset:2048 lds
v_mfma_f32_16x16x32_bf16 v[128:131], a[48:51], a[80:83], v[128:131]
ds_read_b64_tr_b16 a[38:39], v25 offset:52224
s_add_u32 s52, s52, 128
v_mfma_f32_16x16x32_bf16 v[132:135], a[52:55], a[80:83], v[132:135]
ds_read_b64_tr_b16 a[40:41], v25 offset:51744
v_mfma_f32_16x16x32_bf16 v[148:151], a[52:55], a[84:87], v[148:151]
ds_read_b64_tr_b16 a[42:43], v25 offset:52256
v_mfma_f32_16x16x32_bf16 v[152:155], a[56:59], a[84:87], v[152:155]
v_mfma_f32_16x16x32_bf16 v[136:139], a[56:59], a[80:83], v[136:139]
s_waitcnt vmcnt(21) lgkmcnt(8)
s_barrier
v_mfma_f32_16x16x32_bf16 v[60:63], a[20:23], a[0:3], v[60:63]
ds_read_b128 a[44:47], v30 offset:36992
s_add_u32 m0, s56, 111232
v_mfma_f32_16x16x32_bf16 v[76:79], a[24:27], a[0:3], v[76:79]
buffer_load_dwordx4 v18, s[20:23], s54 offen lds
v_mfma_f32_16x16x32_bf16 v[80:83], a[24:27], a[4:7], v[80:83]
s_sub_u32 s47, s47, 1
s_cbranch_scc1 .Lx11
.Lx11b:
v_mfma_f32_16x16x32_bf16 v[64:67], a[20:23], a[4:7], v[64:67]
ds_read_b128 a[48:51], v30 offset:39296
v_mfma_f32_16x16x32_bf16 v[68:71], a[20:23], a[8:11], v[68:71]
buffer_load_dwordx4 v19, s[20:23], s54 offen offset:1024 lds
v_mfma_f32_16x16x32_bf16 v[84:87], a[24:27], a[8:11], v[84:87]
ds_read_b128 a[52:55], v30 offset:41600
v_mfma_f32_16x16x32_bf16 v[88:91], a[24:27], a[12:15], v[88:91]
ds_read_b128 a[56:59], v30 offset:43904
v_mfma_f32_16x16x32_bf16 v[72:75], a[20:23], a[12:15], v[72:75]
ds_read_b64_tr_b16 a[64:65], v25 offset:62080
s_waitcnt lgkmcnt(5)
v_mfma_f32_16x16x32_bf16 v[244:247], a[20:23], a[16:19], v[244:247]
buffer_load_dwordx4 v20, s[20:23], s54 offen offset:2048 lds
v_mfma_f32_16x16x32_bf16 v[104:107], a[28:31], a[12:15], v[104:107]
ds_read_b64_tr_b16 a[66:67], v25 offset:62592
s_add_u32 s54, s54, 196608
v_mfma_f32_16x16x32_bf16 v[120:123], a[32:35], a[12:15], v[120:123]
ds_read_b64_tr_b16 a[68:69], v25 offset:62112
s_add_u32 m0, s55, 20800
v_mfma_f32_16x16x32_bf16 v[116:119], a[32:35], a[8:11], v[116:119]
buffer_load_dwordx4 v21, s[36:39], s53 offen lds
v_mfma_f32_16x16x32_bf16 v[100:103], a[28:31], a[8:11], v[100:103]
ds_read_b64_tr_b16 a[70:71], v25 offset:62624
v_mfma_f32_16x16x32_bf16 v[96:99], a[28:31], a[4:7], v[96:99]
ds_read_b128 a[60:63], v31 offset:36992
v_mfma_f32_16x16x32_bf16 v[112:115], a[32:35], a[4:7], v[112:115]
ds_read_b64_tr_b16 a[72:73], v25 offset:63104
v_mfma_f32_16x16x32_bf16 v[108:111], a[32:35], a[0:3], v[108:111]
buffer_load_dwordx4 v28, s[36:39], s53 offen offset:1024 lds
v_mfma_f32_16x16x32_bf16 v[92:95], a[28:31], a[0:3], v[92:95]
ds_read_b64_tr_b16 a[74:75], v25 offset:63616
v_mfma_f32_16x16x32_bf16 v[156:159], a[28:31], a[16:19], v[156:159]
ds_read_b64_tr_b16 a[76:77], v25 offset:63136
v_mfma_f32_16x16x32_bf16 v[160:163], a[32:35], a[16:19], v[160:163]
buffer_load_dword v29, s[36:39], s53 offen offset:2048 lds
v_mfma_f32_16x16x32_bf16 v[124:127], a[0:3], a[36:39], v[124:127]
ds_read_b64_tr_b16 a[78:79], v25 offset:63648
s_add_u32 s53, s53, 128
v_mfma_f32_16x16x32_bf16 v[140:143], a[0:3], a[40:43], v[140:143]
ds_read_b64_tr_b16 a[80:81], v25 offset:64128
v_mfma_f32_16x16x32_bf16 v[144:147], a[4:7], a[40:43], v[144:147]
ds_read_b64_tr_b16 a[82:83], v25 offset:64640
v_mfma_f32_16x16x32_bf16 v[128:131], a[4:7], a[36:39], v[128:131]
buffer_atomic_add v37, v33, s[16:19], 0 offen sc0
v_mfma_f32_16x16x32_bf16 v[132:135], a[8:11], a[36:39], v[132:135]
ds_read_b64_tr_b16 a[84:85], v25 offset:64160
v_mfma_f32_16x16x32_bf16 v[148:151], a[8:11], a[40:43], v[148:151]
ds_read_b64_tr_b16 a[86:87], v25 offset:64672
v_mfma_f32_16x16x32_bf16 v[152:155], a[12:15], a[40:43], v[152:155]
v_mfma_f32_16x16x32_bf16 v[136:139], a[12:15], a[36:39], v[136:139]
s_waitcnt vmcnt(22) lgkmcnt(8)
s_barrier
v_mfma_f32_16x16x32_bf16 v[60:63], a[64:67], a[44:47], v[60:63]
ds_read_b128 a[0:3], v23 offset:55488
s_add_u32 m0, s56, 123648
v_mfma_f32_16x16x32_bf16 v[76:79], a[68:71], a[44:47], v[76:79]
buffer_load_dwordx4 v18, s[20:23], s54 offen lds
v_mfma_f32_16x16x32_bf16 v[80:83], a[68:71], a[48:51], v[80:83]
ds_read_b128 a[4:7], v23 offset:57792
v_mfma_f32_16x16x32_bf16 v[64:67], a[64:67], a[48:51], v[64:67]
ds_read_b128 a[8:11], v23 offset:60096
v_mfma_f32_16x16x32_bf16 v[68:71], a[64:67], a[52:55], v[68:71]
ds_read_b128 a[12:15], v23 offset:62400
v_mfma_f32_16x16x32_bf16 v[84:87], a[68:71], a[52:55], v[84:87]
buffer_load_dwordx4 v19, s[20:23], s54 offen offset:1024 lds
v_mfma_f32_16x16x32_bf16 v[88:91], a[68:71], a[56:59], v[88:91]
ds_read_b64_tr_b16 a[20:21], v25
v_mfma_f32_16x16x32_bf16 v[72:75], a[64:67], a[56:59], v[72:75]
ds_read_b64_tr_b16 a[22:23], v25 offset:512
s_waitcnt lgkmcnt(6)
v_mfma_f32_16x16x32_bf16 v[244:247], a[64:67], a[60:63], v[244:247]
v_mfma_f32_16x16x32_bf16 v[104:107], a[72:75], a[56:59], v[104:107]
buffer_load_dwordx4 v20, s[20:23], s54 offen offset:2048 lds
v_mfma_f32_16x16x32_bf16 v[120:123], a[76:79], a[56:59], v[120:123]
ds_read_b64_tr_b16 a[24:25], v25 offset:32
s_add_u32 s54, s54, 196608
v_mfma_f32_16x16x32_bf16 v[116:119], a[76:79], a[52:55], v[116:119]
ds_read_b64_tr_b16 a[26:27], v25 offset:544
v_mfma_f32_16x16x32_bf16 v[100:103], a[72:75], a[52:55], v[100:103]
ds_read_b128 a[16:19], v24 offset:55488
s_add_u32 m0, s55, 36992
v_mfma_f32_16x16x32_bf16 v[96:99], a[72:75], a[48:51], v[96:99]
buffer_load_dwordx4 v21, s[36:39], s52 offen lds
v_mfma_f32_16x16x32_bf16 v[112:115], a[76:79], a[48:51], v[112:115]
ds_read_b64_tr_b16 a[28:29], v25 offset:1024
v_mfma_f32_16x16x32_bf16 v[108:111], a[76:79], a[44:47], v[108:111]
ds_read_b64_tr_b16 a[30:31], v25 offset:1536
v_mfma_f32_16x16x32_bf16 v[92:95], a[72:75], a[44:47], v[92:95]
ds_read_b64_tr_b16 a[32:33], v25 offset:1056
v_mfma_f32_16x16x32_bf16 v[156:159], a[72:75], a[60:63], v[156:159]
buffer_load_dwordx4 v28, s[36:39], s52 offen offset:1024 lds
v_mfma_f32_16x16x32_bf16 v[160:163], a[76:79], a[60:63], v[160:163]
v_mfma_f32_16x16x32_bf16 v[124:127], a[44:47], a[80:83], v[124:127]
ds_read_b64_tr_b16 a[34:35], v25 offset:1568
v_mfma_f32_16x16x32_bf16 v[140:143], a[44:47], a[84:87], v[140:143]
ds_read_b64_tr_b16 a[36:37], v25 offset:2048
v_mfma_f32_16x16x32_bf16 v[144:147], a[48:51], a[84:87], v[144:147]
buffer_load_dword v22, s[36:39], s52 offen offset:2048 lds
v_mfma_f32_16x16x32_bf16 v[128:131], a[48:51], a[80:83], v[128:131]
ds_read_b64_tr_b16 a[38:39], v25 offset:2560
s_add_u32 s52, s52, 128
v_mfma_f32_16x16x32_bf16 v[132:135], a[52:55], a[80:83], v[132:135]
ds_read_b64_tr_b16 a[40:41], v25 offset:2080
v_mfma_f32_16x16x32_bf16 v[148:151], a[52:55], a[84:87], v[148:151]
ds_read_b64_tr_b16 a[42:43], v25 offset:2592
v_mfma_f32_16x16x32_bf16 v[152:155], a[56:59], a[84:87], v[152:155]
v_mfma_f32_16x16x32_bf16 v[136:139], a[56:59], a[80:83], v[136:139]
s_waitcnt vmcnt(22) lgkmcnt(8)
s_barrier
v_mfma_f32_16x16x32_bf16 v[60:63], a[20:23], a[0:3], v[60:63]
ds_read_b128 a[44:47], v30 offset:55488
s_add_u32 m0, s56, 136064
v_mfma_f32_16x16x32_bf16 v[76:79], a[24:27], a[0:3], v[76:79]
buffer_load_dwordx4 v18, s[20:23], s54 offen lds
v_mfma_f32_16x16x32_bf16 v[80:83], a[24:27], a[4:7], v[80:83]
s_sub_u32 s47, s47, 1
s_cbranch_scc1 .Lx12
.Lx12b:
v_mfma_f32_16x16x32_bf16 v[64:67], a[20:23], a[4:7], v[64:67]
ds_read_b128 a[48:51], v30 offset:57792
v_mfma_f32_16x16x32_bf16 v[68:71], a[20:23], a[8:11], v[68:71]
ds_read_b128 a[52:55], v30 offset:60096
v_mfma_f32_16x16x32_bf16 v[84:87], a[24:27], a[8:11], v[84:87]
buffer_load_dwordx4 v19, s[20:23], s54 offen offset:1024 lds
v_mfma_f32_16x16x32_bf16 v[88:91], a[24:27], a[12:15], v[88:91]
ds_read_b128 a[56:59], v30 offset:62400
v_mfma_f32_16x16x32_bf16 v[72:75], a[20:23], a[12:15], v[72:75]
ds_read_b64_tr_b16 a[64:65], v25 offset:12416
s_waitcnt lgkmcnt(5)
v_mfma_f32_16x16x32_bf16 v[244:247], a[20:23], a[16:19], v[244:247]
ds_read_b64_tr_b16 a[66:67], v25 offset:12928
v_mfma_f32_16x16x32_bf16 v[104:107], a[28:31], a[12:15], v[104:107]
buffer_load_dwordx4 v20, s[20:23], s54 offen offset:2048 lds
v_mfma_f32_16x16x32_bf16 v[120:123], a[32:35], a[12:15], v[120:123]
ds_read_b64_tr_b16 a[68:69], v25 offset:12448
s_add_u32 s54, s54, 196608
v_mfma_f32_16x16x32_bf16 v[116:119], a[32:35], a[8:11], v[116:119]
ds_read_b64_tr_b16 a[70:71], v25 offset:12960
v_mfma_f32_16x16x32_bf16 v[100:103], a[28:31], a[8:11], v[100:103]
ds_read_b128 a[60:63], v31 offset:55488
s_add_u32 m0, s55, 39296
v_mfma_f32_16x16x32_bf16 v[96:99], a[28:31], a[4:7], v[96:99]
buffer_load_dwordx4 v21, s[36:39], s53 offen lds
v_mfma_f32_16x16x32_bf16 v[112:115], a[32:35], a[4:7], v[112:115]
v_mfma_f32_16x16x32_bf16 v[108:111], a[32:35], a[0:3], v[108:111]
ds_read_b64_tr_b16 a[72:73], v25 offset:13440
v_mfma_f32_16x16x32_bf16 v[92:95], a[28:31], a[0:3], v[92:95]
ds_read_b64_tr_b16 a[74:75], v25 offset:13952
v_mfma_f32_16x16x32_bf16 v[156:159], a[28:31], a[16:19], v[156:159]
buffer_load_dwordx4 v28, s[36:39], s53 offen offset:1024 lds
v_mfma_f32_16x16x32_bf16 v[160:163], a[32:35], a[16:19], v[160:163]
ds_read_b64_tr_b16 a[76:77], v25 offset:13472
v_mfma_f32_16x16x32_bf16 v[124:127], a[0:3], a[36:39], v[124:127]
ds_read_b64_tr_b16 a[78:79], v25 offset:13984
v_mfma_f32_16x16x32_bf16 v[140:143], a[0:3], a[40:43], v[140:143]
ds_read_b64_tr_b16 a[80:81], v25 offset:14464
v_mfma_f32_16x16x32_bf16 v[144:147], a[4:7], a[40:43], v[144:147]
buffer_load_dword v29, s[36:39], s53 offen offset:2048 lds
v_mfma_f32_16x16x32_bf16 v[128:131], a[4:7], a[36:39], v[128:131]
ds_read_b64_tr_b16 a[82:83], v25 offset:14976
s_add_u32 s53, s53, 128
v_mfma_f32_16x16x32_bf16 v[132:135], a[8:11], a[36:39], v[132:135]
ds_read_b64_tr_b16 a[84:85], v25 offset:14496
v_mfma_f32_16x16x32_bf16 v[148:151], a[8:11], a[40:43], v[148:151]
ds_read_b64_tr_b16 a[86:87], v25 offset:15008
v_mfma_f32_16x16x32_bf16 v[152:155], a[12:15], a[40:43], v[152:155]
v_mfma_f32_16x16x32_bf16 v[136:139], a[12:15], a[36:39], v[136:139]
s_waitcnt vmcnt(22) lgkmcnt(8)
s_barrier
v_mfma_f32_16x16x32_bf16 v[60:63], a[64:67], a[44:47], v[60:63]
ds_read_b128 a[0:3], v23
s_add_u32 m0, s56, 73984
v_mfma_f32_16x16x32_bf16 v[76:79], a[68:71], a[44:47], v[76:79]
buffer_load_dwordx4 v18, s[20:23], s54 offen lds
v_mfma_f32_16x16x32_bf16 v[80:83], a[68:71], a[48:51], v[80:83]
ds_read_b128 a[4:7], v23 offset:2304
v_mfma_f32_16x16x32_bf16 v[64:67], a[64:67], a[48:51], v[64:67]
ds_read_b128 a[8:11], v23 offset:4608
v_mfma_f32_16x16x32_bf16 v[68:71], a[64:67], a[52:55], v[68:71]
ds_read_b128 a[12:15], v23 offset:6912
v_mfma_f32_16x16x32_bf16 v[84:87], a[68:71], a[52:55], v[84:87]
buffer_load_dwordx4 v19, s[20:23], s54 offen offset:1024 lds
v_mfma_f32_16x16x32_bf16 v[88:91], a[68:71], a[56:59], v[88:91]
ds_read_b64_tr_b16 a[20:21], v25 offset:24832
v_mfma_f32_16x16x32_bf16 v[72:75], a[64:67], a[56:59], v[72:75]
ds_read_b64_tr_b16 a[22:23], v25 offset:25344
s_waitcnt lgkmcnt(6)
v_mfma_f32_16x16x32_bf16 v[244:247], a[64:67], a[60:63], v[244:247]
v_mfma_f32_16x16x32_bf16 v[104:107], a[72:75], a[56:59], v[104:107]
buffer_load_dwordx4 v20, s[20:23], s54 offen offset:2048 lds
v_mfma_f32_16x16x32_bf16 v[120:123], a[76:79], a[56:59], v[120:123]
ds_read_b64_tr_b16 a[24:25], v25 offset:24864
s_add_u32 s54, s54, 196608
v_mfma_f32_16x16x32_bf16 v[116:119], a[76:79], a[52:55], v[116:119]
ds_read_b64_tr_b16 a[26:27], v25 offset:25376
v_mfma_f32_16x16x32_bf16 v[100:103], a[72:75], a[52:55], v[100:103]
ds_read_b128 a[16:19], v24
s_add_u32 m0, s55, 55488
v_mfma_f32_16x16x32_bf16 v[96:99], a[72:75], a[48:51], v[96:99]
buffer_load_dwordx4 v21, s[36:39], s52 offen lds
v_mfma_f32_16x16x32_bf16 v[112:115], a[76:79], a[48:51], v[112:115]
ds_read_b64_tr_b16 a[28:29], v25 offset:25856
v_mfma_f32_16x16x32_bf16 v[108:111], a[76:79], a[44:47], v[108:111]
ds_read_b64_tr_b16 a[30:31], v25 offset:26368
v_mfma_f32_16x16x32_bf16 v[92:95], a[72:75], a[44:47], v[92:95]
ds_read_b64_tr_b16 a[32:33], v25 offset:25888
v_mfma_f32_16x16x32_bf16 v[156:159], a[72:75], a[60:63], v[156:159]
buffer_load_dwordx4 v28, s[36:39], s52 offen offset:1024 lds
v_mfma_f32_16x16x32_bf16 v[160:163], a[76:79], a[60:63], v[160:163]
v_mfma_f32_16x16x32_bf16 v[124:127], a[44:47], a[80:83], v[124:127]
ds_read_b64_tr_b16 a[34:35], v25 offset:26400
v_mfma_f32_16x16x32_bf16 v[140:143], a[44:47], a[84:87], v[140:143]
ds_read_b64_tr_b16 a[36:37], v25 offset:26880
v_mfma_f32_16x16x32_bf16 v[144:147], a[48:51], a[84:87], v[144:147]
buffer_load_dword v22, s[36:39], s52 offen offset:2048 lds
v_mfma_f32_16x16x32_bf16 v[128:131], a[48:51], a[80:83], v[128:131]
ds_read_b64_tr_b16 a[38:39], v25 offset:27392
s_add_u32 s52, s52, 128
v_mfma_f32_16x16x32_bf16 v[132:135], a[52:55], a[80:83], v[132:135]
ds_read_b64_tr_b16 a[40:41], v25 offset:26912
v_mfma_f32_16x16x32_bf16 v[148:151], a[52:55], a[84:87], v[148:151]
ds_read_b64_tr_b16 a[42:43], v25 offset:27424
v_mfma_f32_16x16x32_bf16 v[152:155], a[56:59], a[84:87], v[152:155]
v_mfma_f32_16x16x32_bf16 v[136:139], a[56:59], a[80:83], v[136:139]
s_waitcnt vmcnt(22) lgkmcnt(8)
s_barrier
v_mfma_f32_16x16x32_bf16 v[60:63], a[20:23], a[0:3], v[60:63]
ds_read_b128 a[44:47], v30
s_add_u32 m0, s56, 86400
v_mfma_f32_16x16x32_bf16 v[76:79], a[24:27], a[0:3], v[76:79]
buffer_load_dwordx4 v18, s[20:23], s54 offen lds
v_mfma_f32_16x16x32_bf16 v[80:83], a[24:27], a[4:7], v[80:83]
s_sub_u32 s47, s47, 1
s_cbranch_scc1 .Lx13
.Lx13b:
v_mfma_f32_16x16x32_bf16 v[64:67], a[20:23], a[4:7], v[64:67]
ds_read_b128 a[48:51], v30 offset:2304
v_mfma_f32_16x16x32_bf16 v[68:71], a[20:23], a[8:11], v[68:71]
ds_read_b128 a[52:55], v30 offset:4608
v_mfma_f32_16x16x32_bf16 v[84:87], a[24:27], a[8:11], v[84:87]
buffer_load_dwordx4 v19, s[20:23], s54 offen offset:1024 lds
v_mfma_f32_16x16x32_bf16 v[88:91], a[24:27], a[12:15], v[88:91]
ds_read_b128 a[56:59], v30 offset:6912
v_mfma_f32_16x16x32_bf16 v[72:75], a[20:23], a[12:15], v[72:75]
ds_read_b64_tr_b16 a[64:65], v25 offset:37248
s_waitcnt lgkmcnt(5)
v_mfma_f32_16x16x32_bf16 v[244:247], a[20:23], a[16:19], v[244:247]
ds_read_b64_tr_b16 a[66:67], v25 offset:37760
v_mfma_f32_16x16x32_bf16 v[104:107], a[28:31], a[12:15], v[104:107]
buffer_load_dwordx4 v20, s[20:23], s54 offen offset:2048 lds
v_mfma_f32_16x16x32_bf16 v[120:123], a[32:35], a[12:15], v[120:123]
ds_read_b64_tr_b16 a[68:69], v25 offset:37280
s_add_u32 s54, s54, 196608
v_mfma_f32_16x16x32_bf16 v[116:119], a[32:35], a[8:11], v[116:119]
ds_read_b64_tr_b16 a[70:71], v25 offset:37792
v_mfma_f32_16x16x32_bf16 v[100:103], a[28:31], a[8:11], v[100:103]
ds_read_b128 a[60:63], v31
s_add_u32 m0, s55, 57792
v_mfma_f32_16x16x32_bf16 v[96:99], a[28:31], a[4:7], v[96:99]
buffer_load_dwordx4 v21, s[36:39], s53 offen lds
v_mfma_f32_16x16x32_bf16 v[112:115], a[32:35], a[4:7], v[112:115]
v_mfma_f32_16x16x32_bf16 v[108:111], a[32:35], a[0:3], v[108:111]
ds_read_b64_tr_b16 a[72:73], v25 offset:38272
v_mfma_f32_16x16x32_bf16 v[92:95], a[28:31], a[0:3], v[92:95]
ds_read_b64_tr_b16 a[74:75], v25 offset:38784
v_mfma_f32_16x16x32_bf16 v[156:159], a[28:31], a[16:19], v[156:159]
buffer_load_dwordx4 v28, s[36:39], s53 offen offset:1024 lds
v_mfma_f32_16x16x32_bf16 v[160:163], a[32:35], a[16:19], v[160:163]
ds_read_b64_tr_b16 a[76:77], v25 offset:38304
v_mfma_f32_16x16x32_bf16 v[124:127], a[0:3], a[36:39], v[124:127]
ds_read_b64_tr_b16 a[78:79], v25 offset:38816
v_mfma_f32_16x16x32_bf16 v[140:143], a[0:3], a[40:43], v[140:143]
ds_read_b64_tr_b16 a[80:81], v25 offset:39296
v_mfma_f32_16x16x32_bf16 v[144:147], a[4:7], a[40:43], v[144:147]
buffer_load_dword v29, s[36:39], s53 offen offset:2048 lds
v_mfma_f32_16x16x32_bf16 v[128:131], a[4:7], a[36:39], v[128:131]
ds_read_b64_tr_b16 a[82:83], v25 offset:39808
s_add_u32 s53, s53, 128
v_mfma_f32_16x16x32_bf16 v[132:135], a[8:11], a[36:39], v[132:135]
ds_read_b64_tr_b16 a[84:85], v25 offset:39328
v_mfma_f32_16x16x32_bf16 v[148:151], a[8:11], a[40:43], v[148:151]
ds_read_b64_tr_b16 a[86:87], v25 offset:39840
v_mfma_f32_16x16x32_bf16 v[152:155], a[12:15], a[40:43], v[152:155]
v_mfma_f32_16x16x32_bf16 v[136:139], a[12:15], a[36:39], v[136:139]
s_waitcnt vmcnt(24)
v_cmp_ne_u32 vcc, v36, v37
s_nop 0
s_cbranch_vccnz .Lsp14
.Lsp14b:
s_waitcnt vmcnt(21) lgkmcnt(8)
s_barrier
v_mfma_f32_16x16x32_bf16 v[60:63], a[64:67], a[44:47], v[60:63]
ds_read_b128 a[0:3], v23 offset:18496
s_add_u32 m0, s56, 98816
v_mfma_f32_16x16x32_bf16 v[76:79], a[68:71], a[44:47], v[76:79]
buffer_load_dwordx4 v18, s[20:23], s54 offen lds
v_mfma_f32_16x16x32_bf16 v[80:83], a[68:71], a[48:51], v[80:83]
ds_read_b128 a[4:7], v23 offset:20800
v_mfma_f32_16x16x32_bf16 v[64:67], a[64:67], a[48:51], v[64:67]
ds_read_b128 a[8:11], v23 offset:23104
v_mfma_f32_16x16x32_bf16 v[68:71], a[64:67], a[52:55], v[68:71]
buffer_load_dwordx4 v19, s[20:23], s54 offen offset:1024 lds
v_mfma_f32_16x16x32_bf16 v[84:87], a[68:71], a[52:55], v[84:87]
ds_read_b128 a[12:15], v23 offset:25408
v_mfma_f32_16x16x32_bf16 v[88:91], a[68:71], a[56:59], v[88:91]
ds_read_b64_tr_b16 a[20:21], v25 offset:49664
v_mfma_f32_16x16x32_bf16 v[72:75], a[64:67], a[56:59], v[72:75]
ds_read_b64_tr_b16 a[22:23], v25 offset:50176
s_waitcnt lgkmcnt(6)
v_mfma_f32_16x16x32_bf16 v[244:247], a[64:67], a[60:63], v[244:247]
buffer_load_dwordx4 v20, s[20:23], s54 offen offset:2048 lds
v_mfma_f32_16x16x32_bf16 v[104:107], a[72:75], a[56:59], v[104:107]
ds_read_b64_tr_b16 a[24:25], v25 offset:49696
s_add_u32 s54, s54, 196608
v_mfma_f32_16x16x32_bf16 v[120:123], a[76:79], a[56:59], v[120:123]
ds_read_b64_tr_b16 a[26:27], v25 offset:50208
s_add_u32 m0, s55, 0
v_mfma_f32_16x16x32_bf16 v[116:119], a[76:79], a[52:55], v[116:119]
buffer_load_dwordx4 v21, s[36:39], s52 offen lds
v_mfma_f32_16x16x32_bf16 v[100:103], a[72:75], a[52:55], v[100:103]
ds_read_b128 a[16:19], v24 offset:18496
v_mfma_f32_16x16x32_bf16 v[96:99], a[72:75], a[48:51], v[96:99]
v_mfma_f32_16x16x32_bf16 v[112:115], a[76:79], a[48:51], v[112:115]
ds_read_b64_tr_b16 a[28:29], v25 offset:50688
v_mfma_f32_16x16x32_bf16 v[108:111], a[76:79], a[44:47], v[108:111]
buffer_load_dwordx4 v28, s[36:39], s52 offen offset:1024 lds
v_mfma_f32_16x16x32_bf16 v[92:95], a[72:75], a[44:47], v[92:95]
ds_read_b64_tr_b16 a[30:31], v25 offset:51200
v_mfma_f32_16x16x32_bf16 v[156:159], a[72:75], a[60:63], v[156:159]
ds_read_b64_tr_b16 a[32:33], v25 offset:50720
v_mfma_f32_16x16x32_bf16 v[160:163], a[76:79], a[60:63], v[160:163]
buffer_load_dword v22, s[36:39], s52 offen offset:2048 lds
v_mfma_f32_16x16x32_bf16 v[124:127], a[44:47], a[80:83], v[124:127]
ds_read_b64_tr_b16 a[34:35], v25 offset:51232
s_add_u32 s52, s52, 128
v_mfma_f32_16x16x32_bf16 v[140:143], a[44:47], a[84:87], v[140:143]
ds_read_b64_tr_b16 a[36:37], v25 offset:51712
v_mfma_f32_16x16x32_bf16 v[144:147], a[48:51], a[84:87], v[144:147]
ds_read_b64_tr_b16 a[38:39], v25 offset:52224
v_mfma_f32_16x16x32_bf16 v[128:131], a[48:51], a[80:83], v[128:131]
buffer_load_dwordx4 v[164:167], v26, s[16:19], s75 offen sc1
v_mfma_f32_16x16x32_bf16 v[132:135], a[52:55], a[80:83], v[132:135]
ds_read_b64_tr_b16 a[40:41], v25 offset:51744
v_mfma_f32_16x16x32_bf16 v[148:151], a[52:55], a[84:87], v[148:151]
ds_read_b64_tr_b16 a[42:43], v25 offset:52256
v_mfma_f32_16x16x32_bf16 v[152:155], a[56:59], a[84:87], v[152:155]
v_mfma_f32_16x16x32_bf16 v[136:139], a[56:59], a[80:83], v[136:139]
s_waitcnt vmcnt(22) lgkmcnt(8)
s_barrier
v_mfma_f32_16x16x32_bf16 v[60:63], a[20:23], a[0:3], v[60:63]
ds_read_b128 a[44:47], v30 offset:18496
s_add_u32 m0, s56, 111232
v_mfma_f32_16x16x32_bf16 v[76:79], a[24:27], a[0:3], v[76:79]
buffer_load_dwordx4 v18, s[20:23], s54 offen lds
v_mfma_f32_16x16x32_bf16 v[80:83], a[24:27], a[4:7], v[80:83]
s_sub_u32 s47, s47, 1
s_cbranch_scc1 .Lx15
.Lx15b:
v_mfma_f32_16x16x32_bf16 v[64:67], a[20:23], a[4:7], v[64:67]
ds_read_b128 a[48:51], v30 offset:20800
v_mfma_f32_16x16x32_bf16 v[68:71], a[20:23], a[8:11], v[68:71]
buffer_load_dwordx4 v19, s[20:23], s54 offen offset:1024 lds
v_mfma_f32_16x16x32_bf16 v[84:87], a[24:27], a[8:11], v[84:87]
ds_read_b128 a[52:55], v30 offset:23104
v_mfma_f32_16x16x32_bf16 v[88:91], a[24:27], a[12:15], v[88:91]
ds_read_b128 a[56:59], v30 offset:25408
v_mfma_f32_16x16x32_bf16 v[72:75], a[20:23], a[12:15], v[72:75]
ds_read_b64_tr_b16 a[64:65], v25 offset:62080
s_waitcnt lgkmcnt(5)
v_mfma_f32_16x16x32_bf16 v[244:247], a[20:23], a[16:19], v[244:247]
buffer_load_dwordx4 v20, s[20:23], s54 offen offset:2048 lds
v_mfma_f32_16x16x32_bf16 v[104:107], a[28:31], a[12:15], v[104:107]
ds_read_b64_tr_b16 a[66:67], v25 offset:62592
s_add_u32 s54, s54, 196608
v_mfma_f32_16x16x32_bf16 v[120:123], a[32:35], a[12:15], v[120:123]
ds_read_b64_tr_b16 a[68:69], v25 offset:62112
s_add_u32 m0, s55, 2304
v_mfma_f32_16x16x32_bf16 v[116:119], a[32:35], a[8:11], v[116:119]
buffer_load_dwordx4 v21, s[36:39], s53 offen lds
v_mfma_f32_16x16x32_bf16 v[100:103], a[28:31], a[8:11], v[100:103]
ds_read_b64_tr_b16 a[70:71], v25 offset:62624
v_mfma_f32_16x16x32_bf16 v[96:99], a[28:31], a[4:7], v[96:99]
ds_read_b128 a[60:63], v31 offset:18496
v_mfma_f32_16x16x32_bf16 v[112:115], a[32:35], a[4:7], v[112:115]
ds_read_b64_tr_b16 a[72:73], v25 offset:63104
v_mfma_f32_16x16x32_bf16 v[108:111], a[32:35], a[0:3], v[108:111]
buffer_load_dwordx4 v28, s[36:39], s53 offen offset:1024 lds
v_mfma_f32_16x16x32_bf16 v[92:95], a[28:31], a[0:3], v[92:95]
ds_read_b64_tr_b16 a[74:75], v25 offset:63616
v_mfma_f32_16x16x32_bf16 v[156:159], a[28:31], a[16:19], v[156:159]
ds_read_b64_tr_b16 a[76:77], v25 offset:63136
v_mfma_f32_16x16x32_bf16 v[160:163], a[32:35], a[16:19], v[160:163]
buffer_load_dword v29, s[36:39], s53 offen offset:2048 lds
v_mfma_f32_16x16x32_bf16 v[124:127], a[0:3], a[36:39], v[124:127]
ds_read_b64_tr_b16 a[78:79], v25 offset:63648
s_add_u32 s53, s53, 128
v_mfma_f32_16x16x32_bf16 v[140:143], a[0:3], a[40:43], v[140:143]
ds_read_b64_tr_b16 a[80:81], v25 offset:64128
v_mfma_f32_16x16x32_bf16 v[144:147], a[4:7], a[40:43], v[144:147]
ds_read_b64_tr_b16 a[82:83], v25 offset:64640
v_mfma_f32_16x16x32_bf16 v[128:131], a[4:7], a[36:39], v[128:131]
buffer_load_dwordx4 v[168:171], v26, s[16:19], s75 offen offset:1024 sc1
v_mfma_f32_16x16x32_bf16 v[132:135], a[8:11], a[36:39], v[132:135]
ds_read_b64_tr_b16 a[84:85], v25 offset:64160
v_mfma_f32_16x16x32_bf16 v[148:151], a[8:11], a[40:43], v[148:151]
ds_read_b64_tr_b16 a[86:87], v25 offset:64672
v_mfma_f32_16x16x32_bf16 v[152:155], a[12:15], a[40:43], v[152:155]
v_mfma_f32_16x16x32_bf16 v[136:139], a[12:15], a[36:39], v[136:139]
s_waitcnt vmcnt(23) lgkmcnt(8)
s_barrier
v_mfma_f32_16x16x32_bf16 v[60:63], a[64:67], a[44:47], v[60:63]
ds_read_b128 a[0:3], v23 offset:36992
s_add_u32 m0, s56, 123648
v_mfma_f32_16x16x32_bf16 v[76:79], a[68:71], a[44:47], v[76:79]
buffer_load_dwordx4 v18, s[20:23], s54 offen lds
v_mfma_f32_16x16x32_bf16 v[80:83], a[68:71], a[48:51], v[80:83]
ds_read_b128 a[4:7], v23 offset:39296
v_mfma_f32_16x16x32_bf16 v[64:67], a[64:67], a[48:51], v[64:67]
ds_read_b128 a[8:11], v23 offset:41600
v_mfma_f32_16x16x32_bf16 v[68:71], a[64:67], a[52:55], v[68:71]
buffer_load_dwordx4 v19, s[20:23], s54 offen offset:1024 lds
v_mfma_f32_16x16x32_bf16 v[84:87], a[68:71], a[52:55], v[84:87]
ds_read_b128 a[12:15], v23 offset:43904
v_mfma_f32_16x16x32_bf16 v[88:91], a[68:71], a[56:59], v[88:91]
ds_read_b64_tr_b16 a[20:21], v25
v_mfma_f32_16x16x32_bf16 v[72:75], a[64:67], a[56:59], v[72:75]
ds_read_b64_tr_b16 a[22:23], v25 offset:512
s_waitcnt lgkmcnt(6)
v_mfma_f32_16x16x32_bf16 v[244:247], a[64:67], a[60:63], v[244:247]
buffer_load_dwordx4 v20, s[20:23], s54 offen offset:2048 lds
v_mfma_f32_16x16x32_bf16 v[104:107], a[72:75], a[56:59], v[104:107]
ds_read_b64_tr_b16 a[24:25], v25 offset:32
s_add_u32 s54, s54, 196608
v_mfma_f32_16x16x32_bf16 v[120:123], a[76:79], a[56:59], v[120:123]
ds_read_b64_tr_b16 a[26:27], v25 offset:544
s_add_u32 m0, s55, 18496
v_mfma_f32_16x16x32_bf16 v[116:119], a[76:79], a[52:55], v[116:119]
buffer_load_dwordx4 v21, s[36:39], s52 offen lds
v_mfma_f32_16x16x32_bf16 v[100:103], a[72:75], a[52:55], v[100:103]
ds_read_b128 a[16:19], v24 offset:36992
v_mfma_f32_16x16x32_bf16 v[96:99], a[72:75], a[48:51], v[96:99]
v_mfma_f32_16x16x32_bf16 v[112:115], a[76:79], a[48:51], v[112:115]
ds_read_b64_tr_b16 a[28:29], v25 offset:1024
v_mfma_f32_16x16x32_bf16 v[108:111], a[76:79], a[44:47], v[108:111]
buffer_load_dwordx4 v28, s[36:39], s52 offen offset:1024 lds
v_mfma_f32_16x16x32_bf16 v[92:95], a[72:75], a[44:47], v[92:95]
ds_read_b64_tr_b16 a[30:31], v25 offset:1536
v_mfma_f32_16x16x32_bf16 v[156:159], a[72:75], a[60:63], v[156:159]
ds_read_b64_tr_b16 a[32:33], v25 offset:1056
v_mfma_f32_16x16x32_bf16 v[160:163], a[76:79], a[60:63], v[160:163]
buffer_load_dword v22, s[36:39], s52 offen offset:2048 lds
v_mfma_f32_16x16x32_bf16 v[124:127], a[44:47], a[80:83], v[124:127]
ds_read_b64_tr_b16 a[34:35], v25 offset:1568
s_add_u32 s52, s52, 128
v_mfma_f32_16x16x32_bf16 v[140:143], a[44:47], a[84:87], v[140:143]
ds_read_b64_tr_b16 a[36:37], v25 offset:2048
v_mfma_f32_16x16x32_bf16 v[144:147], a[48:51], a[84:87], v[144:147]
ds_read_b64_tr_b16 a[38:39], v25 offset:2560
v_mfma_f32_16x16x32_bf16 v[128:131], a[48:51], a[80:83], v[128:131]
buffer_load_dwordx4 v[172:175], v26, s[16:19], s75 offen offset:2048 sc1
v_mfma_f32_16x16x32_bf16 v[132:135], a[52:55], a[80:83], v[132:135]
ds_read_b64_tr_b16 a[40:41], v25 offset:2080
v_mfma_f32_16x16x32_bf16 v[148:151], a[52:55], a[84:87], v[148:151]
ds_read_b64_tr_b16 a[42:43], v25 offset:2592
v_mfma_f32_16x16x32_bf16 v[152:155], a[56:59], a[84:87], v[152:155]
v_mfma_f32_16x16x32_bf16 v[136:139], a[56:59], a[80:83], v[136:139]
s_waitcnt vmcnt(24) lgkmcnt(8)
s_barrier
v_mfma_f32_16x16x32_bf16 v[60:63], a[20:23], a[0:3], v[60:63]
ds_read_b128 a[44:47], v30 offset:36992
s_add_u32 m0, s56, 136064
v_mfma_f32_16x16x32_bf16 v[76:79], a[24:27], a[0:3], v[76:79]
buffer_load_dwordx4 v18, s[20:23], s54 offen lds
v_mfma_f32_16x16x32_bf16 v[80:83], a[24:27], a[4:7], v[80:83]
s_sub_u32 s47, s47, 1
s_cbranch_scc1 .Lx16
.Lx16b:
v_mfma_f32_16x16x32_bf16 v[64:67], a[20:23], a[4:7], v[64:67]
ds_read_b128 a[48:51], v30 offset:39296
v_mfma_f32_16x16x32_bf16 v[68:71], a[20:23], a[8:11], v[68:71]
buffer_load_dwordx4 v19, s[20:23], s54 offen offset:1024 lds
v_mfma_f32_16x16x32_bf16 v[84:87], a[24:27], a[8:11], v[84:87]
ds_read_b128 a[52:55], v30 offset:41600
v_mfma_f32_16x16x32_bf16 v[88:91], a[24:27], a[12:15], v[88:91]
ds_read_b128 a[56:59], v30 offset:43904
v_mfma_f32_16x16x32_bf16 v[72:75], a[20:23], a[12:15], v[72:75]
ds_read_b64_tr_b16 a[64:65], v25 offset:12416
s_waitcnt lgkmcnt(5)
v_mfma_f32_16x16x32_bf16 v[244:247], a[20:23], a[16:19], v[244:247]
buffer_load_dwordx4 v20, s[20:23], s54 offen offset:2048 lds
v_mfma_f32_16x16x32_bf16 v[104:107], a[28:31], a[12:15], v[104:107]
ds_read_b64_tr_b16 a[66:67], v25 offset:12928
s_add_u32 s54, s54, 196608
v_mfma_f32_16x16x32_bf16 v[120:123], a[32:35], a[12:15], v[120:123]
ds_read_b64_tr_b16 a[68:69], v25 offset:12448
s_add_u32 m0, s55, 20800
v_mfma_f32_16x16x32_bf16 v[116:119], a[32:35], a[8:11], v[116:119]
buffer_load_dwordx4 v21, s[36:39], s53 offen lds
v_mfma_f32_16x16x32_bf16 v[100:103], a[28:31], a[8:11], v[100:103]
ds_read_b64_tr_b16 a[70:71], v25 offset:12960
v_mfma_f32_16x16x32_bf16 v[96:99], a[28:31], a[4:7], v[96:99]
ds_read_b128 a[60:63], v31 offset:36992
v_mfma_f32_16x16x32_bf16 v[112:115], a[32:35], a[4:7], v[112:115]
ds_read_b64_tr_b16 a[72:73], v25 offset:13440
v_mfma_f32_16x16x32_bf16 v[108:111], a[32:35], a[0:3], v[108:111]
buffer_load_dwordx4 v28, s[36:39], s53 offen offset:1024 lds
v_mfma_f32_16x16x32_bf16 v[92:95], a[28:31], a[0:3], v[92:95]
ds_read_b64_tr_b16 a[74:75], v25 offset:13952
v_mfma_f32_16x16x32_bf16 v[156:159], a[28:31], a[16:19], v[156:159]
ds_read_b64_tr_b16 a[76:77], v25 offset:13472
v_mfma_f32_16x16x32_bf16 v[160:163], a[32:35], a[16:19], v[160:163]
buffer_load_dword v29, s[36:39], s53 offen offset:2048 lds
v_mfma_f32_16x16x32_bf16 v[124:127], a[0:3], a[36:39], v[124:127]
ds_read_b64_tr_b16 a[78:79], v25 offset:13984
s_add_u32 s53, s53, 128
v_mfma_f32_16x16x32_bf16 v[140:143], a[0:3], a[40:43], v[140:143]
ds_read_b64_tr_b16 a[80:81], v25 offset:14464
v_mfma_f32_16x16x32_bf16 v[144:147], a[4:7], a[40:43], v[144:147]
ds_read_b64_tr_b16 a[82:83], v25 offset:14976
v_mfma_f32_16x16x32_bf16 v[128:131], a[4:7], a[36:39], v[128:131]
buffer_load_dwordx4 v[176:179], v26, s[16:19], s75 offen offset:3072 sc1
v_mfma_f32_16x16x32_bf16 v[132:135], a[8:11], a[36:39], v[132:135]
ds_read_b64_tr_b16 a[84:85], v25 offset:14496
s_add_u32 s75, s75, 4096
v_mfma_f32_16x16x32_bf16 v[148:151], a[8:11], a[40:43], v[148:151]
ds_read_b64_tr_b16 a[86:87], v25 offset:15008
v_mfma_f32_16x16x32_bf16 v[152:155], a[12:15], a[40:43], v[152:155]
v_mfma_f32_16x16x32_bf16 v[136:139], a[12:15], a[36:39], v[136:139]
s_waitcnt vmcnt(25) lgkmcnt(8)
s_barrier
v_mfma_f32_16x16x32_bf16 v[60:63], a[64:67], a[44:47], v[60:63]
ds_read_b128 a[0:3], v23 offset:55488
s_add_u32 m0, s56, 73984
v_mfma_f32_16x16x32_bf16 v[76:79], a[68:71], a[44:47], v[76:79]
buffer_load_dwordx4 v18, s[20:23], s54 offen lds
v_mfma_f32_16x16x32_bf16 v[80:83], a[68:71], a[48:51], v[80:83]
ds_read_b128 a[4:7], v23 offset:57792
v_mfma_f32_16x16x32_bf16 v[64:67], a[64:67], a[48:51], v[64:67]
ds_read_b128 a[8:11], v23 offset:60096
v_mfma_f32_16x16x32_bf16 v[68:71], a[64:67], a[52:55], v[68:71]
buffer_load_dwordx4 v19, s[20:23], s54 offen offset:1024 lds
v_mfma_f32_16x16x32_bf16 v[84:87], a[68:71], a[52:55], v[84:87]
ds_read_b128 a[12:15], v23 offset:62400
v_mfma_f32_16x16x32_bf16 v[88:91], a[68:71], a[56:59], v[88:91]
ds_read_b64_tr_b16 a[20:21], v25 offset:24832
v_mfma_f32_16x16x32_bf16 v[72:75], a[64:67], a[56:59], v[72:75]
ds_read_b64_tr_b16 a[22:23], v25 offset:25344
s_waitcnt lgkmcnt(6)
v_mfma_f32_16x16x32_bf16 v[244:247], a[64:67], a[60:63], v[244:247]
buffer_load_dwordx4 v20, s[20:23], s54 offen offset:2048 lds
v_mfma_f32_16x16x32_bf16 v[104:107], a[72:75], a[56:59], v[104:107]
ds_read_b64_tr_b16 a[24:25], v25 offset:24864
s_add_u32 s54, s54, 196608
v_mfma_f32_16x16x32_bf16 v[120:123], a[76:79], a[56:59], v[120:123]
ds_read_b64_tr_b16 a[26:27], v25 offset:25376
s_add_u32 m0, s55, 36992
v_mfma_f32_16x16x32_bf16 v[116:119], a[76:79], a[52:55], v[116:119]
buffer_load_dwordx4 v21, s[36:39], s52 offen lds
v_mfma_f32_16x16x32_bf16 v[100:103], a[72:75], a[52:55], v[100:103]
ds_read_b128 a[16:19], v24 offset:55488
v_mfma_f32_16x16x32_bf16 v[96:99], a[72:75], a[48:51], v[96:99]
v_mfma_f32_16x16x32_bf16 v[112:115], a[76:79], a[48:51], v[112:115]
ds_read_b64_tr_b16 a[28:29], v25 offset:25856
v_mfma_f32_16x16x32_bf16 v[108:111], a[76:79], a[44:47], v[108:111]
buffer_load_dwordx4 v28, s[36:39], s52 offen offset:1024 lds
v_mfma_f32_16x16x32_bf16 v[92:95], a[72:75], a[44:47], v[92:95]
ds_read_b64_tr_b16 a[30:31], v25 offset:26368
v_mfma_f32_16x16x32_bf16 v[156:159], a[72:75], a[60:63], v[156:159]
ds_read_b64_tr_b16 a[32:33], v25 offset:25888
v_mfma_f32_16x16x32_bf16 v[160:163], a[76:79], a[60:63], v[160:163]
buffer_load_dword v22, s[36:39], s52 offen offset:2048 lds
v_mfma_f32_16x16x32_bf16 v[124:127], a[44:47], a[80:83], v[124:127]
ds_read_b64_tr_b16 a[34:35], v25 offset:26400
s_add_u32 s52, s52, 128
v_mfma_f32_16x16x32_bf16 v[140:143], a[44:47], a[84:87], v[140:143]
ds_read_b64_tr_b16 a[36:37], v25 offset:26880
v_mfma_f32_16x16x32_bf16 v[144:147], a[48:51], a[84:87], v[144:147]
ds_read_b64_tr_b16 a[38:39], v25 offset:27392
v_mfma_f32_16x16x32_bf16 v[128:131], a[48:51], a[80:83], v[128:131]
buffer_load_dwordx4 v[180:183], v26, s[16:19], s75 offen sc1
v_mfma_f32_16x16x32_bf16 v[132:135], a[52:55], a[80:83], v[132:135]
ds_read_b64_tr_b16 a[40:41], v25 offset:26912
v_mfma_f32_16x16x32_bf16 v[148:151], a[52:55], a[84:87], v[148:151]
ds_read_b64_tr_b16 a[42:43], v25 offset:27424
v_mfma_f32_16x16x32_bf16 v[152:155], a[56:59], a[84:87], v[152:155]
v_mfma_f32_16x16x32_bf16 v[136:139], a[56:59], a[80:83], v[136:139]
s_waitcnt vmcnt(25) lgkmcnt(8)
s_barrier
v_mfma_f32_16x16x32_bf16 v[60:63], a[20:23], a[0:3], v[60:63]
ds_read_b128 a[44:47], v30 offset:55488
s_add_u32 m0, s56, 86400
v_mfma_f32_16x16x32_bf16 v[76:79], a[24:27], a[0:3], v[76:79]
buffer_load_dwordx4 v18, s[20:23], s54 offen lds
v_mfma_f32_16x16x32_bf16 v[80:83], a[24:27], a[4:7], v[80:83]
s_sub_u32 s47, s47, 1
s_cbranch_scc1 .Lx17
.Lx17b:
v_mfma_f32_16x16x32_bf16 v[64:67], a[20:23], a[4:7], v[64:67]
ds_read_b128 a[48:51], v30 offset:57792
s_waitcnt vmcnt(22)
v_add_f32 v164, v164, v168
v_mfma_f32_16x16x32_bf16 v[68:71], a[20:23], a[8:11], v[68:71]
buffer_load_dwordx4 v19, s[20:23], s54 offen offset:1024 lds
v_mfma_f32_16x16x32_bf16 v[84:87], a[24:27], a[8:11], v[84:87]
ds_read_b128 a[52:55], v30 offset:60096
v_mfma_f32_16x16x32_bf16 v[88:91], a[24:27], a[12:15], v[88:91]
ds_read_b128 a[56:59], v30 offset:62400
v_mfma_f32_16x16x32_bf16 v[72:75], a[20:23], a[12:15], v[72:75]
ds_read_b64_tr_b16 a[64:65], v25 offset:37248
s_waitcnt lgkmcnt(5)
v_mfma_f32_16x16x32_bf16 v[244:247], a[20:23], a[16:19], v[244:247]
buffer_load_dwordx4 v20, s[20:23], s54 offen offset:2048 lds
v_mfma_f32_16x16x32_bf16 v[104:107], a[28:31], a[12:15], v[104:107]
ds_read_b64_tr_b16 a[66:67], v25 offset:37760
s_add_u32 s54, s54, 196608
v_mfma_f32_16x16x32_bf16 v[120:123], a[32:35], a[12:15], v[120:123]
ds_read_b64_tr_b16 a[68:69], v25 offset:37280
s_add_u32 m0, s55, 39296
v_mfma_f32_16x16x32_bf16 v[116:119], a[32:35], a[8:11], v[116:119]
buffer_load_dwordx4 v21, s[36:39], s53 offen lds
v_mfma_f32_16x16x32_bf16 v[100:103], a[28:31], a[8:11], v[100:103]
ds_read_b64_tr_b16 a[70:71], v25 offset:37792
v_add_f32 v165, v165, v169
v_mfma_f32_16x16x32_bf16 v[96:99], a[28:31], a[4:7], v[96:99]
ds_read_b128 a[60:63], v31 offset:55488
v_mfma_f32_16x16x32_bf16 v[112:115], a[32:35], a[4:7], v[112:115]
ds_read_b64_tr_b16 a[72:73], v25 offset:38272
v_mfma_f32_16x16x32_bf16 v[108:111], a[32:35], a[0:3], v[108:111]
buffer_load_dwordx4 v28, s[36:39], s53 offen offset:1024 lds
v_mfma_f32_16x16x32_bf16 v[92:95], a[28:31], a[0:3], v[92:95]
ds_read_b64_tr_b16 a[74:75], v25 offset:38784
v_mfma_f32_16x16x32_bf16 v[156:159], a[28:31], a[16:19], v[156:159]
ds_read_b64_tr_b16 a[76:77], v25 offset:38304
v_add_f32 v166, v166, v170
v_mfma_f32_16x16x32_bf16 v[160:163], a[32:35], a[16:19], v[160:163]
buffer_load_dword v29, s[36:39], s53 offen offset:2048 lds
v_mfma_f32_16x16x32_bf16 v[124:127], a[0:3], a[36:39], v[124:127]
ds_read_b64_tr_b16 a[78:79], v25 offset:38816
s_add_u32 s53, s53, 128
v_mfma_f32_16x16x32_bf16 v[140:143], a[0:3], a[40:43], v[140:143]
ds_read_b64_tr_b16 a[80:81], v25 offset:39296
v_mfma_f32_16x16x32_bf16 v[144:147], a[4:7], a[40:43], v[144:147]
ds_read_b64_tr_b16 a[82:83], v25 offset:39808
v_mfma_f32_16x16x32_bf16 v[128:131], a[4:7], a[36:39], v[128:131]
buffer_load_dwordx4 v[184:187], v26, s[16:19], s75 offen offset:1024 sc1
v_mfma_f32_16x16x32_bf16 v[132:135], a[8:11], a[36:39], v[132:135]
ds_read_b64_tr_b16 a[84:85], v25 offset:39328
v_add_f32 v167, v167, v171
v_mfma_f32_16x16x32_bf16 v[148:151], a[8:11], a[40:43], v[148:151]
ds_read_b64_tr_b16 a[86:87], v25 offset:39840
v_mfma_f32_16x16x32_bf16 v[152:155], a[12:15], a[40:43], v[152:155]
v_mfma_f32_16x16x32_bf16 v[136:139], a[12:15], a[36:39], v[136:139]
s_waitcnt vmcnt(25) lgkmcnt(8)
s_barrier
v_mfma_f32_16x16x32_bf16 v[60:63], a[64:67], a[44:47], v[60:63]
ds_read_b128 a[0:3], v23
s_add_u32 m0, s56, 98816
v_mfma_f32_16x16x32_bf16 v[76:79], a[68:71], a[44:47], v[76:79]
buffer_load_dwordx4 v18, s[20:23], s54 offen lds
v_mfma_f32_16x16x32_bf16 v[80:83], a[68:71], a[48:51], v[80:83]
ds_read_b128 a[4:7], v23 offset:2304
s_waitcnt vmcnt(22)
v_add_f32 v164, v164, v172
v_mfma_f32_16x16x32_bf16 v[64:67], a[64:67], a[48:51], v[64:67]
ds_read_b128 a[8:11], v23 offset:4608
v_mfma_f32_16x16x32_bf16 v[68:71], a[64:67], a[52:55], v[68:71]
buffer_load_dwordx4 v19, s[20:23], s54 offen offset:1024 lds
v_mfma_f32_16x16x32_bf16 v[84:87], a[68:71], a[52:55], v[84:87]
ds_read_b128 a[12:15], v23 offset:6912
v_mfma_f32_16x16x32_bf16 v[88:91], a[68:71], a[56:59], v[88:91]
ds_read_b64_tr_b16 a[20:21], v25 offset:49664
v_mfma_f32_16x16x32_bf16 v[72:75], a[64:67], a[56:59], v[72:75]
ds_read_b64_tr_b16 a[22:23], v25 offset:50176
s_waitcnt lgkmcnt(6)
v_mfma_f32_16x16x32_bf16 v[244:247], a[64:67], a[60:63], v[244:247]
buffer_load_dwordx4 v20, s[20:23], s54 offen offset:2048 lds
v_mfma_f32_16x16x32_bf16 v[104:107], a[72:75], a[56:59], v[104:107]
ds_read_b64_tr_b16 a[24:25], v25 offset:49696
s_add_u32 s54, s54, 196608
v_mfma_f32_16x16x32_bf16 v[120:123], a[76:79], a[56:59], v[120:123]
ds_read_b64_tr_b16 a[26:27], v25 offset:50208
s_add_u32 m0, s55, 55488
v_mfma_f32_16x16x32_bf16 v[116:119], a[76:79], a[52:55], v[116:119]
buffer_load_dwordx4 v21, s[36:39], s52 offen lds
v_mfma_f32_16x16x32_bf16 v[100:103], a[72:75], a[52:55], v[100:103]
ds_read_b128 a[16:19], v24
v_add_f32 v165, v165, v173
v_mfma_f32_16x16x32_bf16 v[96:99], a[72:75], a[48:51], v[96:99]
v_mfma_f32_16x16x32_bf16 v[112:115], a[76:79], a[48:51], v[112:115]
ds_read_b64_tr_b16 a[28:29], v25 offset:50688
v_mfma_f32_16x16x32_bf16 v[108:111], a[76:79], a[44:47], v[108:111]
buffer_load_dwordx4 v28, s[36:39], s52 offen offset:1024 lds
v_mfma_f32_16x16x32_bf16 v[92:95], a[72:75], a[44:47], v[92:95]
ds_read_b64_tr_b16 a[30:31], v25 offset:51200
v_add_f32 v166, v166, v174
v_mfma_f32_16x16x32_bf16 v[156:159], a[72:75], a[60:63], v[156:159]
ds_read_b64_tr_b16 a[32:33], v25 offset:50720
v_mfma_f32_16x16x32_bf16 v[160:163], a[76:79], a[60:63], v[160:163]
buffer_load_dword v22, s[36:39], s52 offen offset:2048 lds
v_mfma_f32_16x16x32_bf16 v[124:127], a[44:47], a[80:83], v[124:127]
ds_read_b64_tr_b16 a[34:35], v25 offset:51232
s_add_u32 s52, s52, 128
v_mfma_f32_16x16x32_bf16 v[140:143], a[44:47], a[84:87], v[140:143]
ds_read_b64_tr_b16 a[36:37], v25 offset:51712
v_mfma_f32_16x16x32_bf16 v[144:147], a[48:51], a[84:87], v[144:147]
ds_read_b64_tr_b16 a[38:39], v25 offset:52224
v_mfma_f32_16x16x32_bf16 v[128:131], a[48:51], a[80:83], v[128:131]
buffer_load_dwordx4 v[188:191], v26, s[16:19], s75 offen offset:2048 sc1
v_mfma_f32_16x16x32_bf16 v[132:135], a[52:55], a[80:83], v[132:135]
ds_read_b64_tr_b16 a[40:41], v25 offset:51744
v_add_f32 v167, v167, v175
v_mfma_f32_16x16x32_bf16 v[148:151], a[52:55], a[84:87], v[148:151]
ds_read_b64_tr_b16 a[42:43], v25 offset:52256
v_mfma_f32_16x16x32_bf16 v[152:155], a[56:59], a[84:87], v[152:155]
v_mfma_f32_16x16x32_bf16 v[136:139], a[56:59], a[80:83], v[136:139]
s_waitcnt vmcnt(25) lgkmcnt(8)
s_barrier
v_mfma_f32_16x16x32_bf16 v[60:63], a[20:23], a[0:3], v[60:63]
ds_read_b128 a[44:47], v30
s_add_u32 m0, s56, 111232
v_mfma_f32_16x16x32_bf16 v[76:79], a[24:27], a[0:3], v[76:79]
buffer_load_dwordx4 v18, s[20:23], s54 offen lds
v_mfma_f32_16x16x32_bf16 v[80:83], a[24:27], a[4:7], v[80:83]
ds_read_b128 a[48:51], v30 offset:2304
s_waitcnt vmcnt(22)
v_add_f32 v164, v164, v176
v_mfma_f32_16x16x32_bf16 v[64:67], a[20:23], a[4:7], v[64:67]
ds_read_b128 a[52:55], v30 offset:4608
v_mfma_f32_16x16x32_bf16 v[68:71], a[20:23], a[8:11], v[68:71]
buffer_load_dwordx4 v19, s[20:23], s54 offen offset:1024 lds
v_mfma_f32_16x16x32_bf16 v[84:87], a[24:27], a[8:11], v[84:87]
ds_read_b128 a[56:59], v30 offset:6912
v_mfma_f32_16x16x32_bf16 v[88:91], a[24:27], a[12:15], v[88:91]
ds_read_b64_tr_b16 a[64:65], v25 offset:62080
v_mfma_f32_16x16x32_bf16 v[72:75], a[20:23], a[12:15], v[72:75]
ds_read_b64_tr_b16 a[66:67], v25 offset:62592
s_waitcnt lgkmcnt(6)
v_mfma_f32_16x16x32_bf16 v[244:247], a[20:23], a[16:19], v[244:247]
buffer_load_dwordx4 v20, s[20:23], s54 offen offset:2048 lds
v_mfma_f32_16x16x32_bf16 v[104:107], a[28:31], a[12:15], v[104:107]
ds_read_b64_tr_b16 a[68:69], v25 offset:62112
s_add_u32 s54, s54, 196608
v_mfma_f32_16x16x32_bf16 v[120:123], a[32:35], a[12:15], v[120:123]
ds_read_b64_tr_b16 a[70:71], v25 offset:62624
s_add_u32 m0, s55, 57792
v_mfma_f32_16x16x32_bf16 v[116:119], a[32:35], a[8:11], v[116:119]
buffer_load_dwordx4 v21, s[36:39], s53 offen lds
v_mfma_f32_16x16x32_bf16 v[100:103], a[28:31], a[8:11], v[100:103]
ds_read_b128 a[60:63], v31
v_add_f32 v165, v165, v177
v_mfma_f32_16x16x32_bf16 v[96:99], a[28:31], a[4:7], v[96:99]
v_mfma_f32_16x16x32_bf16 v[112:115], a[32:35], a[4:7], v[112:115]
ds_read_b64_tr_b16 a[72:73], v25 offset:63104
v_mfma_f32_16x16x32_bf16 v[108:111], a[32:35], a[0:3], v[108:111]
buffer_load_dwordx4 v28, s[36:39], s53 offen offset:1024 lds
v_mfma_f32_16x16x32_bf16 v[92:95], a[28:31], a[0:3], v[92:95]
ds_read_b64_tr_b16 a[74:75], v25 offset:63616
v_add_f32 v166, v166, v178
v_mfma_f32_16x16x32_bf16 v[156:159], a[28:31], a[16:19], v[156:159]
ds_read_b64_tr_b16 a[76:77], v25 offset:63136
v_mfma_f32_16x16x32_bf16 v[160:163], a[32:35], a[16:19], v[160:163]
buffer_load_dword v29, s[36:39], s53 offen offset:2048 lds
v_mfma_f32_16x16x32_bf16 v[124:127], a[0:3], a[36:39], v[124:127]
ds_read_b64_tr_b16 a[78:79], v25 offset:63648
s_add_u32 s53, s53, 128
v_mfma_f32_16x16x32_bf16 v[140:143], a[0:3], a[40:43], v[140:143]
ds_read_b64_tr_b16 a[80:81], v25 offset:64128
v_mfma_f32_16x16x32_bf16 v[144:147], a[4:7], a[40:43], v[144:147]
ds_read_b64_tr_b16 a[82:83], v25 offset:64640
v_mfma_f32_16x16x32_bf16 v[128:131], a[4:7], a[36:39], v[128:131]
buffer_load_dwordx4 v[192:195], v26, s[16:19], s75 offen offset:3072 sc1
v_mfma_f32_16x16x32_bf16 v[132:135], a[8:11], a[36:39], v[132:135]
ds_read_b64_tr_b16 a[84:85], v25 offset:64160
v_add_f32 v167, v167, v179
v_mfma_f32_16x16x32_bf16 v[148:151], a[8:11], a[40:43], v[148:151]
ds_read_b64_tr_b16 a[86:87], v25 offset:64672
v_mfma_f32_16x16x32_bf16 v[152:155], a[12:15], a[40:43], v[152:155]
v_mfma_f32_16x16x32_bf16 v[136:139], a[12:15], a[36:39], v[136:139]
s_waitcnt vmcnt(25) lgkmcnt(8)
s_barrier
v_mfma_f32_16x16x32_bf16 v[60:63], a[64:67], a[44:47], v[60:63]
ds_read_b128 a[0:3], v23 offset:18496
s_add_u32 m0, s56, 123648
v_mfma_f32_16x16x32_bf16 v[76:79], a[68:71], a[44:47], v[76:79]
buffer_load_dwordx4 v18, s[20:23], s54 offen lds
v_mfma_f32_16x16x32_bf16 v[80:83], a[68:71], a[48:51], v[80:83]
ds_read_b128 a[4:7], v23 offset:20800
s_waitcnt vmcnt(22)
v_add_f32 v164, v164, v180
v_mfma_f32_16x16x32_bf16 v[64:67], a[64:67], a[48:51], v[64:67]
ds_read_b128 a[8:11], v23 offset:23104
v_mfma_f32_16x16x32_bf16 v[68:71], a[64:67], a[52:55], v[68:71]
v_mfma_f32_16x16x32_bf16 v[84:87], a[68:71], a[52:55], v[84:87]
ds_read_b128 a[12:15], v23 offset:25408
v_mfma_f32_16x16x32_bf16 v[88:91], a[68:71], a[56:59], v[88:91]
ds_read_b64_tr_b16 a[20:21], v25
v_mfma_f32_16x16x32_bf16 v[72:75], a[64:67], a[56:59], v[72:75]
ds_read_b64_tr_b16 a[22:23], v25 offset:512
s_waitcnt lgkmcnt(6)
v_mfma_f32_16x16x32_bf16 v[244:247], a[64:67], a[60:63], v[244:247]
v_add_f32 v165, v165, v181
v_mfma_f32_16x16x32_bf16 v[104:107], a[72:75], a[56:59], v[104:107]
buffer_load_dwordx4 v19, s[20:23], s54 offen offset:1024 lds
v_mfma_f32_16x16x32_bf16 v[120:123], a[76:79], a[56:59], v[120:123]
ds_read_b64_tr_b16 a[24:25], v25 offset:32
v_mfma_f32_16x16x32_bf16 v[116:119], a[76:79], a[52:55], v[116:119]
ds_read_b64_tr_b16 a[26:27], v25 offset:544
v_mfma_f32_16x16x32_bf16 v[100:103], a[72:75], a[52:55], v[100:103]
ds_read_b128 a[16:19], v24 offset:18496
v_mfma_f32_16x16x32_bf16 v[96:99], a[72:75], a[48:51], v[96:99]
v_mfma_f32_16x16x32_bf16 v[112:115], a[76:79], a[48:51], v[112:115]
ds_read_b64_tr_b16 a[28:29], v25 offset:1024
v_add_f32 v166, v166, v182
v_mfma_f32_16x16x32_bf16 v[108:111], a[76:79], a[44:47], v[108:111]
ds_read_b64_tr_b16 a[30:31], v25 offset:1536
v_mfma_f32_16x16x32_bf16 v[92:95], a[72:75], a[44:47], v[92:95]
ds_read_b64_tr_b16 a[32:33], v25 offset:1056
v_mfma_f32_16x16x32_bf16 v[156:159], a[72:75], a[60:63], v[156:159]
buffer_load_dwordx4 v20, s[20:23], s54 offen offset:2048 lds
v_mfma_f32_16x16x32_bf16 v[160:163], a[76:79], a[60:63], v[160:163]
s_add_u32 s54, s54, 196608
v_mfma_f32_16x16x32_bf16 v[124:127], a[44:47], a[80:83], v[124:127]
ds_read_b64_tr_b16 a[34:35], v25 offset:1568
v_mfma_f32_16x16x32_bf16 v[140:143], a[44:47], a[84:87], v[140:143]
ds_read_b64_tr_b16 a[36:37], v25 offset:2048
v_mfma_f32_16x16x32_bf16 v[144:147], a[48:51], a[84:87], v[144:147]
ds_read_b64_tr_b16 a[38:39], v25 offset:2560
v_add_f32 v167, v167, v183
v_mfma_f32_16x16x32_bf16 v[128:131], a[48:51], a[80:83], v[128:131]
v_mfma_f32_16x16x32_bf16 v[132:135], a[52:55], a[80:83], v[132:135]
ds_read_b64_tr_b16 a[40:41], v25 offset:2080
v_mfma_f32_16x16x32_bf16 v[148:151], a[52:55], a[84:87], v[148:151]
ds_read_b64_tr_b16 a[42:43], v25 offset:2592
v_mfma_f32_16x16x32_bf16 v[152:155], a[56:59], a[84:87], v[152:155]
v_mfma_f32_16x16x32_bf16 v[136:139], a[56:59], a[80:83], v[136:139]
s_waitcnt vmcnt(21) lgkmcnt(8)
s_barrier
v_mfma_f32_16x16x32_bf16 v[60:63], a[20:23], a[0:3], v[60:63]
ds_read_b128 a[44:47], v30 offset:18496
s_add_u32 m0, s56, 136064
v_mfma_f32_16x16x32_bf16 v[76:79], a[24:27], a[0:3], v[76:79]
buffer_load_dwordx4 v18, s[20:23], s54 offen lds
v_mfma_f32_16x16x32_bf16 v[80:83], a[24:27], a[4:7], v[80:83]
ds_read_b128 a[48:51], v30 offset:20800
s_waitcnt vmcnt(18)
v_add_f32 v164, v164, v184
v_mfma_f32_16x16x32_bf16 v[64:67], a[20:23], a[4:7], v[64:67]
ds_read_b128 a[52:55], v30 offset:23104
v_mfma_f32_16x16x32_bf16 v[68:71], a[20:23], a[8:11], v[68:71]
v_mfma_f32_16x16x32_bf16 v[84:87], a[24:27], a[8:11], v[84:87]
ds_read_b128 a[56:59], v30 offset:25408
v_mfma_f32_16x16x32_bf16 v[88:91], a[24:27], a[12:15], v[88:91]
ds_read_b64_tr_b16 a[64:65], v25 offset:12416
v_mfma_f32_16x16x32_bf16 v[72:75], a[20:23], a[12:15], v[72:75]
ds_read_b64_tr_b16 a[66:67], v25 offset:12928
s_waitcnt lgkmcnt(6)
v_mfma_f32_16x16x32_bf16 v[244:247], a[20:23], a[16:19], v[244:247]
v_add_f32 v165, v165, v185
v_mfma_f32_16x16x32_bf16 v[104:107], a[28:31], a[12:15], v[104:107]
buffer_load_dwordx4 v19, s[20:23], s54 offen offset:1024 lds
v_mfma_f32_16x16x32_bf16 v[120:123], a[32:35], a[12:15], v[120:123]
ds_read_b64_tr_b16 a[68:69], v25 offset:12448
v_mfma_f32_16x16x32_bf16 v[116:119], a[32:35], a[8:11], v[116:119]
ds_read_b64_tr_b16 a[70:71], v25 offset:12960
v_mfma_f32_16x16x32_bf16 v[100:103], a[28:31], a[8:11], v[100:103]
ds_read_b128 a[60:63], v31 offset:18496
v_mfma_f32_16x16x32_bf16 v[96:99], a[28:31], a[4:7], v[96:99]
v_mfma_f32_16x16x32_bf16 v[112:115], a[32:35], a[4:7], v[112:115]
ds_read_b64_tr_b16 a[72:73], v25 offset:13440
v_add_f32 v166, v166, v186
v_mfma_f32_16x16x32_bf16 v[108:111], a[32:35], a[0:3], v[108:111]
ds_read_b64_tr_b16 a[74:75], v25 offset:13952
v_mfma_f32_16x16x32_bf16 v[92:95], a[28:31], a[0:3], v[92:95]
ds_read_b64_tr_b16 a[76:77], v25 offset:13472
v_mfma_f32_16x16x32_bf16 v[156:159], a[28:31], a[16:19], v[156:159]
buffer_load_dwordx4 v20, s[20:23], s54 offen offset:2048 lds
v_mfma_f32_16x16x32_bf16 v[160:163], a[32:35], a[16:19], v[160:163]
s_add_u32 s54, s54, 196608
v_mfma_f32_16x16x32_bf16 v[124:127], a[0:3], a[36:39], v[124:127]
ds_read_b64_tr_b16 a[78:79], v25 offset:13984
v_mfma_f32_16x16x32_bf16 v[140:143], a[0:3], a[40:43], v[140:143]
ds_read_b64_tr_b16 a[80:81], v25 offset:14464
v_mfma_f32_16x16x32_bf16 v[144:147], a[4:7], a[40:43], v[144:147]
ds_read_b64_tr_b16 a[82:83], v25 offset:14976
v_add_f32 v167, v167, v187
v_mfma_f32_16x16x32_bf16 v[128:131], a[4:7], a[36:39], v[128:131]
v_mfma_f32_16x16x32_bf16 v[132:135], a[8:11], a[36:39], v[132:135]
ds_read_b64_tr_b16 a[84:85], v25 offset:14496
v_mfma_f32_16x16x32_bf16 v[148:151], a[8:11], a[40:43], v[148:151]
ds_read_b64_tr_b16 a[86:87], v25 offset:15008
v_mfma_f32_16x16x32_bf16 v[152:155], a[12:15], a[40:43], v[152:155]
v_mfma_f32_16x16x32_bf16 v[136:139], a[12:15], a[36:39], v[136:139]
s_waitcnt vmcnt(17) lgkmcnt(8)
s_barrier
v_mfma_f32_16x16x32_bf16 v[60:63], a[64:67], a[44:47], v[60:63]
s_add_u32 m0, s59, 0
s_mov_b32 s58, 1048576
s_waitcnt vmcnt(13)
v_add_f32 v164, v164, v188
v_mfma_f32_16x16x32_bf16 v[76:79], a[68:71], a[44:47], v[76:79]
buffer_load_dwordx4 v5, s[24:27], s58 offen lds
v_mfma_f32_16x16x32_bf16 v[80:83], a[68:71], a[48:51], v[80:83]
ds_read_b128 a[0:3], v23 offset:36992
v_mfma_f32_16x16x32_bf16 v[64:67], a[64:67], a[48:51], v[64:67]
ds_read_b128 a[4:7], v23 offset:39296
v_mfma_f32_16x16x32_bf16 v[68:71], a[64:67], a[52:55], v[68:71]
ds_read_b128 a[8:11], v23 offset:41600
v_mfma_f32_16x16x32_bf16 v[84:87], a[68:71], a[52:55], v[84:87]
buffer_load_dwordx4 v6, s[24:27], s58 offen offset:1024 lds
v_mfma_f32_16x16x32_bf16 v[88:91], a[68:71], a[56:59], v[88:91]
ds_read_b128 a[12:15], v23 offset:43904
v_add_f32 v165, v165, v189
v_mfma_f32_16x16x32_bf16 v[72:75], a[64:67], a[56:59], v[72:75]
ds_read_b64_tr_b16 a[20:21], v25 offset:24832
s_waitcnt lgkmcnt(5)
v_mfma_f32_16x16x32_bf16 v[244:247], a[64:67], a[60:63], v[244:247]
s_add_u32 m0, s59, 8320
s_mov_b32 s58, 1179648
v_mfma_f32_16x16x32_bf16 v[104:107], a[72:75], a[56:59], v[104:107]
buffer_load_dwordx4 v5, s[24:27], s58 offen lds
v_mfma_f32_16x16x32_bf16 v[120:123], a[76:79], a[56:59], v[120:123]
ds_read_b64_tr_b16 a[22:23], v25 offset:25344
v_mfma_f32_16x16x32_bf16 v[116:119], a[76:79], a[52:55], v[116:119]
ds_read_b64_tr_b16 a[24:25], v25 offset:24864
v_mfma_f32_16x16x32_bf16 v[100:103], a[72:75], a[52:55], v[100:103]
ds_read_b64_tr_b16 a[26:27], v25 offset:25376
v_mfma_f32_16x16x32_bf16 v[96:99], a[72:75], a[48:51], v[96:99]
buffer_load_dwordx4 v6, s[24:27], s58 offen offset:1024 lds
v_mfma_f32_16x16x32_bf16 v[112:115], a[76:79], a[48:51], v[112:115]
ds_read_b128 a[16:19], v24 offset:36992
v_add_f32 v166, v166, v190
v_mfma_f32_16x16x32_bf16 v[108:111], a[76:79], a[44:47], v[108:111]
ds_read_b64_tr_b16 a[28:29], v25 offset:25856
v_mfma_f32_16x16x32_bf16 v[92:95], a[72:75], a[44:47], v[92:95]
s_add_u32 m0, s59, 16640
s_mov_b32 s58, 1310720
v_mfma_f32_16x16x32_bf16 v[156:159], a[72:75], a[60:63], v[156:159]
buffer_load_dwordx4 v5, s[24:27], s58 offen lds
v_mfma_f32_16x16x32_bf16 v[160:163], a[76:79], a[60:63], v[160:163]
ds_read_b64_tr_b16 a[30:31], v25 offset:26368
v_mfma_f32_16x16x32_bf16 v[124:127], a[44:47], a[80:83], v[124:127]
ds_read_b64_tr_b16 a[32:33], v25 offset:25888
v_mfma_f32_16x16x32_bf16 v[140:143], a[44:47], a[84:87], v[140:143]
ds_read_b64_tr_b16 a[34:35], v25 offset:26400
v_add_f32 v167, v167, v191
v_mfma_f32_16x16x32_bf16 v[144:147], a[48:51], a[84:87], v[144:147]
buffer_load_dwordx4 v6, s[24:27], s58 offen offset:1024 lds
v_mfma_f32_16x16x32_bf16 v[128:131], a[48:51], a[80:83], v[128:131]
ds_read_b64_tr_b16 a[36:37], v25 offset:26880
v_mfma_f32_16x16x32_bf16 v[132:135], a[52:55], a[80:83], v[132:135]
ds_read_b64_tr_b16 a[38:39], v25 offset:27392
v_mfma_f32_16x16x32_bf16 v[148:151], a[52:55], a[84:87], v[148:151]
ds_read_b64_tr_b16 a[40:41], v25 offset:26912
v_mfma_f32_16x16x32_bf16 v[152:155], a[56:59], a[84:87], v[152:155]
ds_read_b64_tr_b16 a[42:43], v25 offset:27424
v_mfma_f32_16x16x32_bf16 v[136:139], a[56:59], a[80:83], v[136:139]
s_waitcnt vmcnt(16) lgkmcnt(8)
s_barrier
v_mfma_f32_16x16x32_bf16 v[60:63], a[20:23], a[0:3], v[60:63]
s_add_u32 m0, s59, 24960
s_mov_b32 s58, 1441792
s_waitcnt vmcnt(12)
v_add_f32 v164, v164, v192
v_mfma_f32_16x16x32_bf16 v[76:79], a[24:27], a[0:3], v[76:79]
buffer_load_dwordx4 v5, s[24:27], s58 offen lds
v_mfma_f32_16x16x32_bf16 v[80:83], a[24:27], a[4:7], v[80:83]
ds_read_b128 a[44:47], v30 offset:36992
v_mfma_f32_16x16x32_bf16 v[64:67], a[20:23], a[4:7], v[64:67]
ds_read_b128 a[48:51], v30 offset:39296
v_mfma_f32_16x16x32_bf16 v[68:71], a[20:23], a[8:11], v[68:71]
ds_read_b128 a[52:55], v30 offset:41600
v_mfma_f32_16x16x32_bf16 v[84:87], a[24:27], a[8:11], v[84:87]
buffer_load_dwordx4 v6, s[24:27], s58 offen offset:1024 lds
v_mfma_f32_16x16x32_bf16 v[88:91], a[24:27], a[12:15], v[88:91]
ds_read_b128 a[56:59], v30 offset:43904
v_add_f32 v165, v165, v193
v_mfma_f32_16x16x32_bf16 v[72:75], a[20:23], a[12:15], v[72:75]
ds_read_b64_tr_b16 a[64:65], v25 offset:37248
s_waitcnt lgkmcnt(5)
v_mfma_f32_16x16x32_bf16 v[244:247], a[20:23], a[16:19], v[244:247]
s_add_u32 m0, s59, 74880
s_mov_b32 s58, 131072
v_mfma_f32_16x16x32_bf16 v[104:107], a[28:31], a[12:15], v[104:107]
buffer_load_dwordx4 v5, s[24:27], s58 offen lds
v_mfma_f32_16x16x32_bf16 v[120:123], a[32:35], a[12:15], v[120:123]
ds_read_b64_tr_b16 a[66:67], v25 offset:37760
v_mfma_f32_16x16x32_bf16 v[116:119], a[32:35], a[8:11], v[116:119]
ds_read_b64_tr_b16 a[68:69], v25 offset:37280
v_mfma_f32_16x16x32_bf16 v[100:103], a[28:31], a[8:11], v[100:103]
ds_read_b64_tr_b16 a[70:71], v25 offset:37792
v_mfma_f32_16x16x32_bf16 v[96:99], a[28:31], a[4:7], v[96:99]
buffer_load_dwordx4 v6, s[24:27], s58 offen offset:1024 lds
v_mfma_f32_16x16x32_bf16 v[112:115], a[32:35], a[4:7], v[112:115]
ds_read_b128 a[60:63], v31 offset:36992
v_add_f32 v166, v166, v194
v_mfma_f32_16x16x32_bf16 v[108:111], a[32:35], a[0:3], v[108:111]
ds_read_b64_tr_b16 a[72:73], v25 offset:38272
v_mfma_f32_16x16x32_bf16 v[92:95], a[28:31], a[0:3], v[92:95]
s_add_u32 m0, s59, 83200
s_mov_b32 s58, 262144
v_mfma_f32_16x16x32_bf16 v[156:159], a[28:31], a[16:19], v[156:159]
buffer_load_dwordx4 v5, s[24:27], s58 offen lds
v_mfma_f32_16x16x32_bf16 v[160:163], a[32:35], a[16:19], v[160:163]
ds_read_b64_tr_b16 a[74:75], v25 offset:38784
v_mfma_f32_16x16x32_bf16 v[124:127], a[0:3], a[36:39], v[124:127]
ds_read_b64_tr_b16 a[76:77], v25 offset:38304
v_mfma_f32_16x16x32_bf16 v[140:143], a[0:3], a[40:43], v[140:143]
ds_read_b64_tr_b16 a[78:79], v25 offset:38816
v_add_f32 v167, v167, v195
v_mfma_f32_16x16x32_bf16 v[144:147], a[4:7], a[40:43], v[144:147]
buffer_load_dwordx4 v6, s[24:27], s58 offen offset:1024 lds
v_mfma_f32_16x16x32_bf16 v[128:131], a[4:7], a[36:39], v[128:131]
ds_read_b64_tr_b16 a[80:81], v25 offset:39296
v_mfma_f32_16x16x32_bf16 v[132:135], a[8:11], a[36:39], v[132:135]
ds_read_b64_tr_b16 a[82:83], v25 offset:39808
v_mfma_f32_16x16x32_bf16 v[148:151], a[8:11], a[40:43], v[148:151]
ds_read_b64_tr_b16 a[84:85], v25 offset:39328
v_mfma_f32_16x16x32_bf16 v[152:155], a[12:15], a[40:43], v[152:155]
ds_read_b64_tr_b16 a[86:87], v25 offset:39840
v_mfma_f32_16x16x32_bf16 v[136:139], a[12:15], a[36:39], v[136:139]
s_waitcnt vmcnt(15) lgkmcnt(8)
s_barrier
v_mfma_f32_16x16x32_bf16 v[60:63], a[64:67], a[44:47], v[60:63]
s_add_u32 m0, s59, 33280
s_mov_b32 s58, 1572864
v_permlane32_swap_b32 v164, v166
v_mfma_f32_16x16x32_bf16 v[76:79], a[68:71], a[44:47], v[76:79]
buffer_load_dwordx4 v5, s[24:27], s58 offen lds
v_mfma_f32_16x16x32_bf16 v[80:83], a[68:71], a[48:51], v[80:83]
ds_read_b128 a[0:3], v23 offset:55488
v_mfma_f32_16x16x32_bf16 v[64:67], a[64:67], a[48:51], v[64:67]
ds_read_b128 a[4:7], v23 offset:57792
v_permlane32_swap_b32 v165, v167
v_mfma_f32_16x16x32_bf16 v[68:71], a[64:67], a[52:55], v[68:71]
ds_read_b128 a[8:11], v23 offset:60096
v_mfma_f32_16x16x32_bf16 v[84:87], a[68:71], a[52:55], v[84:87]
buffer_load_dwordx4 v6, s[24:27], s58 offen offset:1024 lds
v_mfma_f32_16x16x32_bf16 v[88:91], a[68:71], a[56:59], v[88:91]
ds_read_b128 a[12:15], v23 offset:62400
v_add_f32 v164, v164, v166
v_mfma_f32_16x16x32_bf16 v[72:75], a[64:67], a[56:59], v[72:75]
ds_read_b64_tr_b16 a[20:21], v25 offset:49664
s_waitcnt lgkmcnt(5)
v_mfma_f32_16x16x32_bf16 v[244:247], a[64:67], a[60:63], v[244:247]
s_add_u32 m0, s59, 41600
s_mov_b32 s58, 1703936
v_mfma_f32_16x16x32_bf16 v[104:107], a[72:75], a[56:59], v[104:107]
buffer_load_dwordx4 v5, s[24:27], s58 offen lds
v_mfma_f32_16x16x32_bf16 v[120:123], a[76:79], a[56:59], v[120:123]
ds_read_b64_tr_b16 a[22:23], v25 offset:50176
v_add_f32 v165, v165, v167
v_mfma_f32_16x16x32_bf16 v[116:119], a[76:79], a[52:55], v[116:119]
ds_read_b64_tr_b16 a[24:25], v25 offset:49696
v_mfma_f32_16x16x32_bf16 v[100:103], a[72:75], a[52:55], v[100:103]
ds_read_b64_tr_b16 a[26:27], v25 offset:50208
v_mul_f32 v164, 0xba800000, v164
v_mfma_f32_16x16x32_bf16 v[96:99], a[72:75], a[48:51], v[96:99]
buffer_load_dwordx4 v6, s[24:27], s58 offen offset:1024 lds
v_mfma_f32_16x16x32_bf16 v[112:115], a[76:79], a[48:51], v[112:115]
ds_read_b128 a[16:19], v24 offset:55488
v_mfma_f32_16x16x32_bf16 v[108:111], a[76:79], a[44:47], v[108:111]
ds_read_b64_tr_b16 a[28:29], v25 offset:50688
v_mul_f32 v165, 0x3a800000, v165
v_mfma_f32_16x16x32_bf16 v[92:95], a[72:75], a[44:47], v[92:95]
s_add_u32 m0, s59, 91520
s_mov_b32 s58, 393216
v_mfma_f32_16x16x32_bf16 v[156:159], a[72:75], a[60:63], v[156:159]
buffer_load_dwordx4 v5, s[24:27], s58 offen lds
v_mfma_f32_16x16x32_bf16 v[160:163], a[76:79], a[60:63], v[160:163]
ds_read_b64_tr_b16 a[30:31], v25 offset:51200
v_fma_f32 v165, -v164, v164, v165
v_mfma_f32_16x16x32_bf16 v[124:127], a[44:47], a[80:83], v[124:127]
ds_read_b64_tr_b16 a[32:33], v25 offset:50720
v_mfma_f32_16x16x32_bf16 v[140:143], a[44:47], a[84:87], v[140:143]
ds_read_b64_tr_b16 a[34:35], v25 offset:51232
v_max_f32 v165, 0, v165
v_mfma_f32_16x16x32_bf16 v[144:147], a[48:51], a[84:87], v[144:147]
buffer_load_dwordx4 v6, s[24:27], s58 offen offset:1024 lds
v_mfma_f32_16x16x32_bf16 v[128:131], a[48:51], a[80:83], v[128:131]
ds_read_b64_tr_b16 a[36:37], v25 offset:51712
v_mfma_f32_16x16x32_bf16 v[132:135], a[52:55], a[80:83], v[132:135]
ds_read_b64_tr_b16 a[38:39], v25 offset:52224
v_add_f32 v165, 0x3727c5ac, v165
v_mfma_f32_16x16x32_bf16 v[148:151], a[52:55], a[84:87], v[148:151]
ds_read_b64_tr_b16 a[40:41], v25 offset:51744
v_mfma_f32_16x16x32_bf16 v[152:155], a[56:59], a[84:87], v[152:155]
ds_read_b64_tr_b16 a[42:43], v25 offset:52256
v_mfma_f32_16x16x32_bf16 v[136:139], a[56:59], a[80:83], v[136:139]
s_waitcnt vmcnt(18) lgkmcnt(8)
s_barrier
v_mfma_f32_16x16x32_bf16 v[60:63], a[20:23], a[0:3], v[60:63]
s_add_u32 m0, s59, 99840
s_mov_b32 s58, 524288
v_rsq_f32 v166, v165
v_mfma_f32_16x16x32_bf16 v[76:79], a[24:27], a[0:3], v[76:79]
buffer_load_dwordx4 v5, s[24:27], s58 offen lds
v_mfma_f32_16x16x32_bf16 v[80:83], a[24:27], a[4:7], v[80:83]
ds_read_b128 a[44:47], v30 offset:55488
v_mfma_f32_16x16x32_bf16 v[64:67], a[20:23], a[4:7], v[64:67]
ds_read_b128 a[48:51], v30 offset:57792
v_mfma_f32_16x16x32_bf16 v[68:71], a[20:23], a[8:11], v[68:71]
ds_read_b128 a[52:55], v30 offset:60096
v_mfma_f32_16x16x32_bf16 v[84:87], a[24:27], a[8:11], v[84:87]
ds_read_b128 a[56:59], v30 offset:62400
v_mov_b32 v165, v166
v_mfma_f32_16x16x32_bf16 v[88:91], a[24:27], a[12:15], v[88:91]
ds_read_b64_tr_b16 a[64:65], v25 offset:62080
v_mfma_f32_16x16x32_bf16 v[72:75], a[20:23], a[12:15], v[72:75]
ds_read_b64_tr_b16 a[66:67], v25 offset:62592
s_waitcnt lgkmcnt(6)
v_mfma_f32_16x16x32_bf16 v[244:247], a[20:23], a[16:19], v[244:247]
buffer_load_dwordx4 v6, s[24:27], s58 offen offset:1024 lds
v_mfma_f32_16x16x32_bf16 v[104:107], a[28:31], a[12:15], v[104:107]
v_mfma_f32_16x16x32_bf16 v[120:123], a[32:35], a[12:15], v[120:123]
ds_read_b64_tr_b16 a[68:69], v25 offset:62112
v_mul_f32 v166, 0x3e8293ee, v166
v_mfma_f32_16x16x32_bf16 v[116:119], a[32:35], a[8:11], v[116:119]
ds_read_b64_tr_b16 a[70:71], v25 offset:62624
v_mfma_f32_16x16x32_bf16 v[100:103], a[28:31], a[8:11], v[100:103]
s_add_u32 m0, s59, 108160
s_mov_b32 s58, 655360
v_mfma_f32_16x16x32_bf16 v[96:99], a[28:31], a[4:7], v[96:99]
buffer_load_dwordx4 v5, s[24:27], s58 offen lds
v_mfma_f32_16x16x32_bf16 v[112:115], a[32:35], a[4:7], v[112:115]
ds_read_b128 a[60:63], v31 offset:55488
v_mfma_f32_16x16x32_bf16 v[108:111], a[32:35], a[0:3], v[108:111]
ds_read_b64_tr_b16 a[72:73], v25 offset:63104
ds_write_b128 v7, v[164:167]
v_mfma_f32_16x16x32_bf16 v[92:95], a[28:31], a[0:3], v[92:95]
ds_read_b64_tr_b16 a[74:75], v25 offset:63616
v_mfma_f32_16x16x32_bf16 v[156:159], a[28:31], a[16:19], v[156:159]
ds_read_b64_tr_b16 a[76:77], v25 offset:63136
v_mfma_f32_16x16x32_bf16 v[160:163], a[32:35], a[16:19], v[160:163]
ds_write_b32 v17, v164
v_mfma_f32_16x16x32_bf16 v[124:127], a[0:3], a[36:39], v[124:127]
buffer_load_dwordx4 v6, s[24:27], s58 offen offset:1024 lds
v_mfma_f32_16x16x32_bf16 v[140:143], a[0:3], a[40:43], v[140:143]
ds_read_b64_tr_b16 a[78:79], v25 offset:63648
v_mfma_f32_16x16x32_bf16 v[144:147], a[4:7], a[40:43], v[144:147]
ds_read_b64_tr_b16 a[80:81], v25 offset:64128
v_mfma_f32_16x16x32_bf16 v[128:131], a[4:7], a[36:39], v[128:131]
ds_read_b64_tr_b16 a[82:83], v25 offset:64640
v_mfma_f32_16x16x32_bf16 v[132:135], a[8:11], a[36:39], v[132:135]
ds_read_b64_tr_b16 a[84:85], v25 offset:64160
ds_write_b32 v17, v165 offset:1024
v_mfma_f32_16x16x32_bf16 v[148:151], a[8:11], a[40:43], v[148:151]
ds_read_b64_tr_b16 a[86:87], v25 offset:64672
v_mfma_f32_16x16x32_bf16 v[152:155], a[12:15], a[40:43], v[152:155]
v_mfma_f32_16x16x32_bf16 v[136:139], a[12:15], a[36:39], v[136:139]
s_waitcnt lgkmcnt(0)
s_barrier
v_mfma_f32_16x16x32_bf16 v[244:247], a[64:67], a[60:63], v[244:247]
ds_read_b128 v[232:235], v10 offset:768
v_mfma_f32_16x16x32_bf16 v[156:159], a[72:75], a[60:63], v[156:159]
ds_read_b128 v[236:239], v10 offset:2816
v_mfma_f32_16x16x32_bf16 v[160:163], a[76:79], a[60:63], v[160:163]
ds_read_b128 v[228:231], v10 offset:512
v_mfma_f32_16x16x32_bf16 v[104:107], a[72:75], a[56:59], v[104:107]
ds_read_b128 v[224:227], v10 offset:256
v_mfma_f32_16x16x32_bf16 v[120:123], a[76:79], a[56:59], v[120:123]
ds_read_b128 v[220:223], v10
v_mfma_f32_16x16x32_bf16 v[136:139], a[56:59], a[80:83], v[136:139]
v_mfma_f32_16x16x32_bf16 v[152:155], a[56:59], a[84:87], v[152:155]
v_mfma_f32_16x16x32_bf16 v[100:103], a[72:75], a[52:55], v[100:103]
v_mfma_f32_16x16x32_bf16 v[116:119], a[76:79], a[52:55], v[116:119]
s_mov_b32 exec_lo, 0x10001
s_mov_b32 exec_hi, 0x10001
ds_write_b128 v13, v[244:247]
ds_write_b128 v13, v[156:159] offset:256
ds_write_b128 v13, v[160:163] offset:320
s_mov_b64 exec, -1
v_mfma_f32_16x16x32_bf16 v[96:99], a[72:75], a[48:51], v[96:99]
v_mfma_f32_16x16x32_bf16 v[112:115], a[76:79], a[48:51], v[112:115]
v_mfma_f32_16x16x32_bf16 v[92:95], a[72:75], a[44:47], v[92:95]
v_mfma_f32_16x16x32_bf16 v[108:111], a[76:79], a[44:47], v[108:111]
v_mfma_f32_16x16x32_bf16 v[72:75], a[64:67], a[56:59], v[72:75]
v_mfma_f32_16x16x32_bf16 v[88:91], a[68:71], a[56:59], v[88:91]
s_waitcnt lgkmcnt(0)
s_barrier
v_mfma_f32_16x16x32_bf16 v[132:135], a[52:55], a[80:83], v[132:135]
ds_read_b128 v[28:31], v13
s_add_u32 m0, s59, 49920
v_mfma_f32_16x16x32_bf16 v[148:151], a[52:55], a[84:87], v[148:151]
ds_read_b128 v[32:35], v13 offset:64
s_mov_b32 s58, 1835008
v_mfma_f32_16x16x32_bf16 v[68:71], a[64:67], a[52:55], v[68:71]
ds_read_b128 v[36:39], v13 offset:256
v_mfma_f32_16x16x32_bf16 v[84:87], a[68:71], a[52:55], v[84:87]
ds_read_b128 v[40:43], v13 offset:320
v_mfma_f32_16x16x32_bf16 v[128:131], a[48:51], a[80:83], v[128:131]
ds_read_b32 v44, v12 offset:512
v_mfma_f32_16x16x32_bf16 v[144:147], a[48:51], a[84:87], v[144:147]
ds_read_b32 v45, v12 offset:576
v_mfma_f32_16x16x32_bf16 v[64:67], a[64:67], a[48:51], v[64:67]
ds_read_b128 v[240:243], v11 offset:192
v_mfma_f32_16x16x32_bf16 v[80:83], a[68:71], a[48:51], v[80:83]
ds_read_b128 v[244:247], v11 offset:1216
v_mfma_f32_16x16x32_bf16 v[124:127], a[44:47], a[80:83], v[124:127]
buffer_load_dwordx4 v5, s[24:27], s58 offen lds
ds_read_b128 v[18:21], v11 offset:128
s_waitcnt lgkmcnt(8)
v_pk_fma_f32 v[72:73], v[28:29], v[232:233], v[72:73] op_sel_hi:[1,0,1]
v_pk_fma_f32 v[74:75], v[30:31], v[232:233], v[74:75] op_sel_hi:[1,0,1]
s_waitcnt lgkmcnt(6)
v_pk_fma_f32 v[104:105], v[36:37], v[232:233], v[104:105] op_sel_hi:[1,0,1]
v_pk_mul_f32 v[104:105], v[104:105], v[232:233] op_sel:[0,1] op_sel_hi:[1,1]
v_pk_fma_f32 v[106:107], v[38:39], v[232:233], v[106:107] op_sel_hi:[1,0,1]
v_pk_mul_f32 v[106:107], v[106:107], v[232:233] op_sel:[0,1] op_sel_hi:[1,1]
s_waitcnt lgkmcnt(5)
v_pk_fma_f32 v[120:121], v[40:41], v[232:233], v[120:121] op_sel_hi:[1,0,1]
v_pk_mul_f32 v[120:121], v[120:121], v[232:233] op_sel:[0,1] op_sel_hi:[1,1]
v_pk_fma_f32 v[122:123], v[42:43], v[232:233], v[122:123] op_sel_hi:[1,0,1]
v_pk_mul_f32 v[122:123], v[122:123], v[232:233] op_sel:[0,1] op_sel_hi:[1,1]
v_pk_fma_f32 v[100:101], v[36:37], v[228:229], v[100:101] op_sel_hi:[1,0,1]
v_pk_mul_f32 v[100:101], v[100:101], v[228:229] op_sel:[0,1] op_sel_hi:[1,1]
v_pk_fma_f32 v[102:103], v[38:39], v[228:229], v[102:103] op_sel_hi:[1,0,1]
v_pk_mul_f32 v[102:103], v[102:103], v[228:229] op_sel:[0,1] op_sel_hi:[1,1]
v_pk_fma_f32 v[116:117], v[40:41], v[228:229], v[116:117] op_sel_hi:[1,0,1]
v_pk_mul_f32 v[116:117], v[116:117], v[228:229] op_sel:[0,1] op_sel_hi:[1,1]
v_pk_fma_f32 v[118:119], v[42:43], v[228:229], v[118:119] op_sel_hi:[1,0,1]
v_pk_mul_f32 v[118:119], v[118:119], v[228:229] op_sel:[0,1] op_sel_hi:[1,1]
s_waitcnt lgkmcnt(2)
v_pk_fma_f32 v[136:137], v[240:241], v[44:45], v[136:137] op_sel_hi:[1,0,1]
v_pk_fma_f32 v[138:139], v[242:243], v[44:45], v[138:139] op_sel_hi:[1,0,1]
v_pk_fma_f32 v[152:153], v[240:241], v[44:45], v[152:153] op_sel:[0,1,0] op_sel_hi:[1,1,1]
v_pk_fma_f32 v[154:155], v[242:243], v[44:45], v[154:155] op_sel:[0,1,0] op_sel_hi:[1,1,1]
s_waitcnt lgkmcnt(1)
v_pk_mul_f32 v[136:137], v[136:137], v[244:245]
v_pk_mul_f32 v[138:139], v[138:139], v[246:247]
v_pk_mul_f32 v[152:153], v[152:153], v[244:245]
v_pk_mul_f32 v[154:155], v[154:155], v[246:247]
v_pk_fma_f32 v[88:89], v[32:33], v[232:233], v[88:89] op_sel_hi:[1,0,1]
v_pk_fma_f32 v[90:91], v[34:35], v[232:233], v[90:91] op_sel_hi:[1,0,1]
v_pk_fma_f32 v[96:97], v[36:37], v[224:225], v[96:97] op_sel_hi:[1,0,1]
s_waitcnt lgkmcnt(0)
v_pk_fma_f32 v[132:133], v[18:19], v[44:45], v[132:133] op_sel_hi:[1,0,1]
v_pk_fma_f32 v[134:135], v[20:21], v[44:45], v[134:135] op_sel_hi:[1,0,1]
v_pk_fma_f32 v[148:149], v[18:19], v[44:45], v[148:149] op_sel:[0,1,0] op_sel_hi:[1,1,1]
v_pk_fma_f32 v[150:151], v[20:21], v[44:45], v[150:151] op_sel:[0,1,0] op_sel_hi:[1,1,1]
v_pk_mul_f32 v[96:97], v[96:97], v[224:225] op_sel:[0,1] op_sel_hi:[1,1]
v_pk_fma_f32 v[98:99], v[38:39], v[224:225], v[98:99] op_sel_hi:[1,0,1]
v_pk_mul_f32 v[98:99], v[98:99], v[224:225] op_sel:[0,1] op_sel_hi:[1,1]
v_pk_fma_f32 v[112:113], v[40:41], v[224:225], v[112:113] op_sel_hi:[1,0,1]
v_pk_mul_f32 v[112:113], v[112:113], v[224:225] op_sel:[0,1] op_sel_hi:[1,1]
v_pk_fma_f32 v[114:115], v[42:43], v[224:225], v[114:115] op_sel_hi:[1,0,1]
v_pk_mul_f32 v[114:115], v[114:115], v[224:225] op_sel:[0,1] op_sel_hi:[1,1]
v_pk_fma_f32 v[68:69], v[28:29], v[228:229], v[68:69] op_sel_hi:[1,0,1]
v_pk_fma_f32 v[70:71], v[30:31], v[228:229], v[70:71] op_sel_hi:[1,0,1]
v_pk_fma_f32 v[84:85], v[32:33], v[228:229], v[84:85] op_sel_hi:[1,0,1]
v_pk_fma_f32 v[86:87], v[34:35], v[228:229], v[86:87] op_sel_hi:[1,0,1]
v_pk_fma_f32 v[92:93], v[36:37], v[220:221], v[92:93] op_sel_hi:[1,0,1]
v_pk_mul_f32 v[92:93], v[92:93], v[220:221] op_sel:[0,1] op_sel_hi:[1,1]
v_pk_fma_f32 v[94:95], v[38:39], v[220:221], v[94:95] op_sel_hi:[1,0,1]
v_pk_mul_f32 v[94:95], v[94:95], v[220:221] op_sel:[0,1] op_sel_hi:[1,1]
v_pk_fma_f32 v[108:109], v[40:41], v[220:221], v[108:109] op_sel_hi:[1,0,1]
v_pk_mul_f32 v[108:109], v[108:109], v[220:221] op_sel:[0,1] op_sel_hi:[1,1]
v_pk_fma_f32 v[110:111], v[42:43], v[220:221], v[110:111] op_sel_hi:[1,0,1]
v_pk_mul_f32 v[110:111], v[110:111], v[220:221] op_sel:[0,1] op_sel_hi:[1,1]
v_pk_fma_f32 v[64:65], v[28:29], v[224:225], v[64:65] op_sel_hi:[1,0,1]
v_pk_fma_f32 v[66:67], v[30:31], v[224:225], v[66:67] op_sel_hi:[1,0,1]
v_pk_fma_f32 v[80:81], v[32:33], v[224:225], v[80:81] op_sel_hi:[1,0,1]
v_pk_fma_f32 v[82:83], v[34:35], v[224:225], v[82:83] op_sel_hi:[1,0,1]
v_pk_fma_f32 v[156:157], v[36:37], v[236:237], v[156:157] op_sel_hi:[1,0,1]
v_pk_mul_f32 v[156:157], v[156:157], v[236:237] op_sel:[0,1] op_sel_hi:[1,1]
v_pk_fma_f32 v[158:159], v[38:39], v[236:237], v[158:159] op_sel_hi:[1,0,1]
v_pk_mul_f32 v[158:159], v[158:159], v[236:237] op_sel:[0,1] op_sel_hi:[1,1]
v_pk_fma_f32 v[160:161], v[40:41], v[236:237], v[160:161] op_sel_hi:[1,0,1]
v_pk_mul_f32 v[160:161], v[160:161], v[236:237] op_sel:[0,1] op_sel_hi:[1,1]
v_pk_fma_f32 v[162:163], v[42:43], v[236:237], v[162:163] op_sel_hi:[1,0,1]
v_pk_mul_f32 v[162:163], v[162:163], v[236:237] op_sel:[0,1] op_sel_hi:[1,1]
v_cvt_pk_bf16_f32 v196, v104, v105
v_cvt_pk_bf16_f32 v197, v106, v107
v_mfma_f32_16x16x32_bf16 v[140:143], a[44:47], a[84:87], v[140:143]
buffer_load_dwordx4 v6, s[24:27], s58 offen offset:1024 lds
v_mfma_f32_16x16x32_bf16 v[60:63], a[64:67], a[44:47], v[60:63]
s_add_u32 m0, s59, 58240
v_cvt_pk_bf16_f32 v198, v120, v121
v_cvt_pk_bf16_f32 v199, v122, v123
v_mfma_f32_16x16x32_bf16 v[76:79], a[68:71], a[44:47], v[76:79]
ds_write_b128 v8, v[196:199]
v_cvt_pk_bf16_f32 v208, v136, v137
v_cvt_pk_bf16_f32 v209, v138, v139
v_cvt_pk_bf16_f32 v218, v152, v153
v_cvt_pk_bf16_f32 v219, v154, v155
ds_write_b64 v8, v[208:209] offset:1024
ds_write_b64 v8, v[218:219] offset:1032
s_mov_b32 s58, 1966080
buffer_load_dwordx4 v5, s[24:27], s58 offen lds
v_cvt_pk_bf16_f32 v192, v100, v101
v_cvt_pk_bf16_f32 v193, v102, v103
v_cvt_pk_bf16_f32 v194, v116, v117
v_cvt_pk_bf16_f32 v195, v118, v119
v_cvt_pk_bf16_f32 v176, v72, v73
v_cvt_pk_bf16_f32 v177, v74, v75
v_cvt_pk_bf16_f32 v178, v88, v89
v_cvt_pk_bf16_f32 v179, v90, v91
v_pk_fma_f32 v[60:61], v[28:29], v[220:221], v[60:61] op_sel_hi:[1,0,1]
v_pk_fma_f32 v[62:63], v[30:31], v[220:221], v[62:63] op_sel_hi:[1,0,1]
v_pk_fma_f32 v[76:77], v[32:33], v[220:221], v[76:77] op_sel_hi:[1,0,1]
v_pk_fma_f32 v[78:79], v[34:35], v[220:221], v[78:79] op_sel_hi:[1,0,1]
ds_read_b128 v[22:25], v11 offset:1152
s_nop 0
v_mfma_f32_16x16x32_bf16 v[104:107], v[192:195], v[176:179], v[46:49]
buffer_load_dwordx4 v6, s[24:27], s58 offen offset:1024 lds
v_mfma_f32_16x16x32_bf16 v[120:123], v[196:199], v[176:179], v[50:53]
s_add_u32 m0, s59, 66560
s_mov_b32 s58, 0
v_cvt_pk_bf16_f32 v188, v96, v97
v_cvt_pk_bf16_f32 v189, v98, v99
s_nop 1
v_max3_f32 v88, v104, v105, v106
v_cvt_pk_bf16_f32 v190, v112, v113
v_cvt_pk_bf16_f32 v191, v114, v115
s_waitcnt lgkmcnt(1)
s_barrier
ds_read_b64 v[200:201], v9 offset:1024
ds_read_b64 v[210:211], v9 offset:1032
buffer_load_dwordx4 v5, s[24:27], s58 offen lds
v_max3_f32 v89, v107, v120, v121
v_max3_f32 v88, v88, v122, v123
v_max_f32 v90, v88, v89
v_max_f32 v89, v88, v89
v_cvt_pk_bf16_f32 v172, v68, v69
v_cvt_pk_bf16_f32 v173, v70, v71
v_permlane16_swap_b32 v90, v89
v_cvt_pk_bf16_f32 v174, v84, v85
v_max_f32 v88, v90, v89
s_waitcnt lgkmcnt(2)
v_pk_mul_f32 v[132:133], v[132:133], v[22:23]
v_cvt_pk_bf16_f32 v206, v132, v133
v_pk_mul_f32 v[134:135], v[134:135], v[24:25]
buffer_load_dwordx4 v6, s[24:27], s58 offen offset:1024 lds
s_add_u32 m0, s59, 116480
s_mov_b32 s58, 786432
v_cvt_pk_bf16_f32 v207, v134, v135
v_pk_mul_f32 v[148:149], v[148:149], v[22:23]
v_cvt_pk_bf16_f32 v216, v148, v149
v_pk_mul_f32 v[150:151], v[150:151], v[24:25]
v_cvt_pk_bf16_f32 v217, v150, v151
v_max_f32 v89, v90, v89
v_cvt_pk_bf16_f32 v175, v86, v87
ds_read_b128 v[240:243], v11 offset:64
s_nop 0
v_mfma_f32_16x16x32_bf16 v[100:103], v[188:191], v[172:175], v[46:49]
ds_read_b128 v[244:247], v11 offset:1088
v_permlane32_swap_b32 v88, v89
v_mfma_f32_16x16x32_bf16 v[116:119], v[192:195], v[172:175], v[50:53]
buffer_load_dwordx4 v5, s[24:27], s58 offen lds
v_max_f32 v88, v88, v89
v_mul_f32 v88, v88, v234
s_nop 1
v_max3_f32 v84, v100, v101, v102
v_pk_fma_f32 v[104:105], v[104:105], v[234:235], v[88:89] op_sel_hi:[1,0,0] neg_lo:[0,0,1] neg_hi:[0,0,1]
v_pk_fma_f32 v[106:107], v[106:107], v[234:235], v[88:89] op_sel_hi:[1,0,0] neg_lo:[0,0,1] neg_hi:[0,0,1]
v_pk_fma_f32 v[120:121], v[120:121], v[234:235], v[88:89] op_sel_hi:[1,0,0] neg_lo:[0,0,1] neg_hi:[0,0,1]
v_pk_fma_f32 v[122:123], v[122:123], v[234:235], v[88:89] op_sel_hi:[1,0,0] neg_lo:[0,0,1] neg_hi:[0,0,1]
v_exp_f32 v104, v104
v_exp_f32 v105, v105
v_exp_f32 v106, v106
v_exp_f32 v107, v107
v_exp_f32 v120, v120
v_exp_f32 v121, v121
v_exp_f32 v122, v122
v_exp_f32 v123, v123
v_cvt_pk_bf16_f32 v72, v104, v105
buffer_load_dwordx4 v6, s[24:27], s58 offen offset:1024 lds
s_add_u32 m0, s59, 124800
s_mov_b32 s58, 917504
v_cvt_pk_bf16_f32 v73, v106, v107
v_cvt_pk_bf16_f32 v74, v120, v121
v_cvt_pk_bf16_f32 v75, v122, v123
s_waitcnt lgkmcnt(1)
v_pk_fma_f32 v[128:129], v[240:241], v[44:45], v[128:129] op_sel_hi:[1,0,1]
s_waitcnt lgkmcnt(0)
v_pk_mul_f32 v[128:129], v[128:129], v[244:245]
v_pk_fma_f32 v[130:131], v[242:243], v[44:45], v[130:131] op_sel_hi:[1,0,1]
v_pk_mul_f32 v[130:131], v[130:131], v[246:247]
v_pk_fma_f32 v[144:145], v[240:241], v[44:45], v[144:145] op_sel:[0,1,0] op_sel_hi:[1,1,1]
v_pk_mul_f32 v[144:145], v[144:145], v[244:245]
v_pk_fma_f32 v[146:147], v[242:243], v[44:45], v[146:147] op_sel:[0,1,0] op_sel_hi:[1,1,1]
v_pk_mul_f32 v[146:147], v[146:147], v[246:247]
v_cvt_pk_bf16_f32 v204, v128, v129
v_cvt_pk_bf16_f32 v205, v130, v131
v_mfma_f32_16x16x32_bf16 v[88:91], v[248:251], v[72:75], 0
buffer_load_dwordx4 v5, s[24:27], s58 offen lds
v_mfma_f32_16x16x32_bf16 v[104:107], v[206:209], v[72:75], 0
ds_read_b128 v[18:21], v11
v_cvt_pk_bf16_f32 v214, v144, v145
v_mfma_f32_16x16x32_bf16 v[120:123], v[216:219], v[72:75], 0
ds_read_b128 v[22:25], v11 offset:1024
s_nop 1
v_rcp_f32 v88, v88
v_cvt_pk_bf16_f32 v215, v146, v147
v_max3_f32 v85, v103, v116, v117
v_pk_mul_f32 v[104:105], v[104:105], v[88:89] op_sel_hi:[1,0]
v_pk_mul_f32 v[106:107], v[106:107], v[88:89] op_sel_hi:[1,0]
buffer_load_dwordx4 v6, s[24:27], s58 offen offset:1024 lds
v_pk_mul_f32 v[120:121], v[120:121], v[88:89] op_sel_hi:[1,0]
v_pk_mul_f32 v[122:123], v[122:123], v[88:89] op_sel_hi:[1,0]
v_cvt_pk_bf16_f32 v176, v104, v105
v_cvt_pk_bf16_f32 v177, v106, v107
v_cvt_pk_bf16_f32 v178, v120, v121
v_cvt_pk_bf16_f32 v179, v122, v123
v_max3_f32 v84, v84, v118, v119
v_max_f32 v86, v84, v85
v_max_f32 v85, v84, v85
v_cvt_pk_bf16_f32 v184, v92, v93
v_cvt_pk_bf16_f32 v185, v94, v95
v_permlane16_swap_b32 v86, v85
v_cvt_pk_bf16_f32 v186, v108, v109
buffer_store_dwordx4 v[176:179], v4, s[16:19], s74 offen offset:3072 sc1
v_max_f32 v84, v86, v85
v_max_f32 v85, v86, v85
v_cvt_pk_bf16_f32 v187, v110, v111
v_cvt_pk_bf16_f32 v168, v64, v65
v_permlane32_swap_b32 v84, v85
v_cvt_pk_bf16_f32 v169, v66, v67
v_max_f32 v84, v84, v85
v_mul_f32 v84, v84, v230
v_pk_fma_f32 v[100:101], v[100:101], v[230:231], v[84:85] op_sel_hi:[1,0,0] neg_lo:[0,0,1] neg_hi:[0,0,1]
v_pk_fma_f32 v[102:103], v[102:103], v[230:231], v[84:85] op_sel_hi:[1,0,0] neg_lo:[0,0,1] neg_hi:[0,0,1]
v_pk_fma_f32 v[116:117], v[116:117], v[230:231], v[84:85] op_sel_hi:[1,0,0] neg_lo:[0,0,1] neg_hi:[0,0,1]
v_pk_fma_f32 v[118:119], v[118:119], v[230:231], v[84:85] op_sel_hi:[1,0,0] neg_lo:[0,0,1] neg_hi:[0,0,1]
v_exp_f32 v100, v100
v_exp_f32 v101, v101
v_exp_f32 v102, v102
v_exp_f32 v103, v103
v_exp_f32 v116, v116
v_exp_f32 v117, v117
v_exp_f32 v118, v118
v_exp_f32 v119, v119
v_cvt_pk_bf16_f32 v68, v100, v101
v_cvt_pk_bf16_f32 v69, v102, v103
v_cvt_pk_bf16_f32 v70, v116, v117
v_cvt_pk_bf16_f32 v71, v118, v119
s_waitcnt lgkmcnt(1)
v_pk_fma_f32 v[124:125], v[18:19], v[44:45], v[124:125] op_sel_hi:[1,0,1]
s_waitcnt lgkmcnt(0)
v_pk_mul_f32 v[124:125], v[124:125], v[22:23]
v_pk_fma_f32 v[126:127], v[20:21], v[44:45], v[126:127] op_sel_hi:[1,0,1]
v_pk_mul_f32 v[126:127], v[126:127], v[24:25]
v_pk_fma_f32 v[140:141], v[18:19], v[44:45], v[140:141] op_sel:[0,1,0] op_sel_hi:[1,1,1]
v_pk_mul_f32 v[140:141], v[140:141], v[22:23]
v_pk_fma_f32 v[142:143], v[20:21], v[44:45], v[142:143] op_sel:[0,1,0] op_sel_hi:[1,1,1]
v_pk_mul_f32 v[142:143], v[142:143], v[24:25]
v_cvt_pk_bf16_f32 v170, v80, v81
v_cvt_pk_bf16_f32 v171, v82, v83
v_mfma_f32_16x16x32_bf16 v[84:87], v[248:251], v[68:71], 0
v_cvt_pk_bf16_f32 v202, v124, v125
v_cvt_pk_bf16_f32 v203, v126, v127
v_mfma_f32_16x16x32_bf16 v[100:103], v[204:207], v[68:71], 0
v_cvt_pk_bf16_f32 v212, v140, v141
v_cvt_pk_bf16_f32 v213, v142, v143
v_mfma_f32_16x16x32_bf16 v[116:119], v[214:217], v[68:71], 0
s_nop 1
v_rcp_f32 v84, v84
v_mfma_f32_16x16x32_bf16 v[96:99], v[184:187], v[168:171], v[46:49]
v_cvt_pk_bf16_f32 v180, v156, v157
v_cvt_pk_bf16_f32 v181, v158, v159
v_mfma_f32_16x16x32_bf16 v[112:115], v[188:191], v[168:171], v[50:53]
v_cvt_pk_bf16_f32 v182, v160, v161
v_cvt_pk_bf16_f32 v183, v162, v163
v_cvt_pk_bf16_f32 v164, v60, v61
s_nop 1
v_max3_f32 v80, v96, v97, v98
v_cvt_pk_bf16_f32 v165, v62, v63
v_pk_mul_f32 v[100:101], v[100:101], v[84:85] op_sel_hi:[1,0]
v_pk_mul_f32 v[102:103], v[102:103], v[84:85] op_sel_hi:[1,0]
v_pk_mul_f32 v[116:117], v[116:117], v[84:85] op_sel_hi:[1,0]
v_pk_mul_f32 v[118:119], v[118:119], v[84:85] op_sel_hi:[1,0]
v_cvt_pk_bf16_f32 v172, v100, v101
v_cvt_pk_bf16_f32 v173, v102, v103
v_cvt_pk_bf16_f32 v174, v116, v117
v_cvt_pk_bf16_f32 v175, v118, v119
buffer_store_dwordx4 v[172:175], v4, s[16:19], s74 offen offset:2048 sc1
v_max3_f32 v81, v99, v112, v113
v_max3_f32 v80, v80, v114, v115
v_max_f32 v82, v80, v81
v_max_f32 v81, v80, v81
v_cvt_pk_bf16_f32 v166, v76, v77
v_cvt_pk_bf16_f32 v167, v78, v79
v_permlane16_swap_b32 v82, v81
s_nop 0
v_mfma_f32_16x16x32_bf16 v[92:95], v[180:183], v[164:167], v[54:57]
v_max_f32 v80, v82, v81
v_max_f32 v81, v82, v81
v_mfma_f32_16x16x32_bf16 v[108:111], v[184:187], v[164:167], v[50:53]
s_nop 0
v_permlane32_swap_b32 v80, v81
v_max_f32 v80, v80, v81
v_mul_f32 v80, v80, v226
v_pk_fma_f32 v[96:97], v[96:97], v[226:227], v[80:81] op_sel_hi:[1,0,0] neg_lo:[0,0,1] neg_hi:[0,0,1]
v_pk_fma_f32 v[98:99], v[98:99], v[226:227], v[80:81] op_sel_hi:[1,0,0] neg_lo:[0,0,1] neg_hi:[0,0,1]
v_pk_fma_f32 v[112:113], v[112:113], v[226:227], v[80:81] op_sel_hi:[1,0,0] neg_lo:[0,0,1] neg_hi:[0,0,1]
v_pk_fma_f32 v[114:115], v[114:115], v[226:227], v[80:81] op_sel_hi:[1,0,0] neg_lo:[0,0,1] neg_hi:[0,0,1]
v_exp_f32 v96, v96
v_exp_f32 v97, v97
v_exp_f32 v98, v98
v_exp_f32 v99, v99
v_exp_f32 v112, v112
v_exp_f32 v113, v113
v_exp_f32 v114, v114
v_exp_f32 v115, v115
v_cvt_pk_bf16_f32 v64, v96, v97
v_cvt_pk_bf16_f32 v65, v98, v99
v_cvt_pk_bf16_f32 v66, v112, v113
v_cvt_pk_bf16_f32 v67, v114, v115
v_max3_f32 v76, v92, v93, v94
v_max3_f32 v77, v95, v108, v109
v_mfma_f32_16x16x32_bf16 v[80:83], v[248:251], v[64:67], 0
v_max3_f32 v76, v76, v110, v111
v_max_f32 v78, v76, v77
v_mfma_f32_16x16x32_bf16 v[96:99], v[202:205], v[64:67], 0
v_max_f32 v77, v76, v77
v_mfma_f32_16x16x32_bf16 v[112:115], v[212:215], v[64:67], 0
s_nop 2
v_rcp_f32 v80, v80
v_permlane16_swap_b32 v78, v77
s_nop 0
v_pk_mul_f32 v[96:97], v[96:97], v[80:81] op_sel_hi:[1,0]
v_pk_mul_f32 v[98:99], v[98:99], v[80:81] op_sel_hi:[1,0]
v_pk_mul_f32 v[112:113], v[112:113], v[80:81] op_sel_hi:[1,0]
v_pk_mul_f32 v[114:115], v[114:115], v[80:81] op_sel_hi:[1,0]
v_cvt_pk_bf16_f32 v168, v96, v97
v_cvt_pk_bf16_f32 v169, v98, v99
v_cvt_pk_bf16_f32 v170, v112, v113
v_cvt_pk_bf16_f32 v171, v114, v115
buffer_store_dwordx4 v[168:171], v4, s[16:19], s74 offen offset:1024 sc1
v_max_f32 v76, v78, v77
v_max_f32 v77, v78, v77
s_nop 1
v_permlane32_swap_b32 v76, v77
v_max_f32 v76, v76, v77
v_mul_f32 v76, v76, v222
v_pk_fma_f32 v[92:93], v[92:93], v[222:223], v[76:77] op_sel_hi:[1,0,0] neg_lo:[0,0,1] neg_hi:[0,0,1]
v_pk_fma_f32 v[94:95], v[94:95], v[222:223], v[76:77] op_sel_hi:[1,0,0] neg_lo:[0,0,1] neg_hi:[0,0,1]
v_pk_fma_f32 v[108:109], v[108:109], v[222:223], v[76:77] op_sel_hi:[1,0,0] neg_lo:[0,0,1] neg_hi:[0,0,1]
v_pk_fma_f32 v[110:111], v[110:111], v[222:223], v[76:77] op_sel_hi:[1,0,0] neg_lo:[0,0,1] neg_hi:[0,0,1]
v_exp_f32 v92, v92
v_exp_f32 v93, v93
v_exp_f32 v94, v94
v_exp_f32 v95, v95
v_exp_f32 v108, v108
v_exp_f32 v109, v109
v_exp_f32 v110, v110
v_exp_f32 v111, v111
v_cvt_pk_bf16_f32 v60, v92, v93
v_cvt_pk_bf16_f32 v61, v94, v95
v_cvt_pk_bf16_f32 v62, v108, v109
v_cvt_pk_bf16_f32 v63, v110, v111
s_nop 1
v_mfma_f32_16x16x32_bf16 v[76:79], v[248:251], v[60:63], 0
v_mfma_f32_16x16x32_bf16 v[92:95], v[200:203], v[60:63], 0
v_mfma_f32_16x16x32_bf16 v[108:111], v[210:213], v[60:63], 0
s_nop 5
v_rcp_f32 v76, v76
s_nop 0
v_pk_mul_f32 v[92:93], v[92:93], v[76:77] op_sel_hi:[1,0]
v_pk_mul_f32 v[94:95], v[94:95], v[76:77] op_sel_hi:[1,0]
v_pk_mul_f32 v[108:109], v[108:109], v[76:77] op_sel_hi:[1,0]
v_pk_mul_f32 v[110:111], v[110:111], v[76:77] op_sel_hi:[1,0]
v_cvt_pk_bf16_f32 v164, v92, v93
v_cvt_pk_bf16_f32 v165, v94, v95
v_cvt_pk_bf16_f32 v166, v108, v109
v_cvt_pk_bf16_f32 v167, v110, v111
buffer_store_dwordx4 v[164:167], v4, s[16:19], s74 offen sc1
s_nop 1
s_branch .Lqkve3
.Lx4:
buffer_load_dword v27, v14, s[76:79], 0 offen
s_mov_b32 s76, s98
s_mov_b32 s77, s99
s_mov_b32 s78, s100
v_mov_b32 v14, v15
s_mov_b32 s47, 5
s_branch .Lx4b
.Lx5:
buffer_load_dword v27, v14, s[76:79], 0 offen
s_mov_b32 s76, s98
s_mov_b32 s77, s99
s_mov_b32 s78, s100
v_mov_b32 v14, v15
s_mov_b32 s47, 5
s_branch .Lx5b
.Lx6:
buffer_load_dword v27, v14, s[76:79], 0 offen
s_mov_b32 s76, s98
s_mov_b32 s77, s99
s_mov_b32 s78, s100
v_mov_b32 v14, v15
s_mov_b32 s47, 5
s_branch .Lx6b
.Lx7:
buffer_load_dword v27, v14, s[76:79], 0 offen
s_mov_b32 s76, s98
s_mov_b32 s77, s99
s_mov_b32 s78, s100
v_mov_b32 v14, v15
s_mov_b32 s47, 5
s_branch .Lx7b
.Lsp8:
s_mov_b32 s15, 0
.Lsp8l:
v_mov_b32 v37, 0
buffer_atomic_add v37, v34, s[40:43], 0 offen sc0
s_add_u32 s15, s15, 1
s_cmp_gt_u32 s15, 100000
s_waitcnt vmcnt(0)
s_cbranch_scc1 .Lsp8b
v_cmp_ne_u32 vcc, v35, v37
s_sleep 2
s_cbranch_vccnz .Lsp8l
s_branch .Lsp8b
.Lx9:
buffer_load_dword v27, v14, s[76:79], 0 offen
s_mov_b32 s76, s98
s_mov_b32 s77, s99
s_mov_b32 s78, s100
v_mov_b32 v14, v15
s_mov_b32 s47, 5
s_branch .Lx9b
.Lx10:
buffer_load_dword v27, v14, s[76:79], 0 offen
s_mov_b32 s76, s98
s_mov_b32 s77, s99
s_mov_b32 s78, s100
v_mov_b32 v14, v15
s_mov_b32 s47, 5
s_branch .Lx10b
.Lx11:
buffer_load_dword v27, v14, s[76:79], 0 offen
s_mov_b32 s76, s98
s_mov_b32 s77, s99
s_mov_b32 s78, s100
v_mov_b32 v14, v15
s_mov_b32 s47, 5
s_branch .Lx11b
.Lx12:
buffer_load_dword v27, v14, s[76:79], 0 offen
s_mov_b32 s76, s98
s_mov_b32 s77, s99
s_mov_b32 s78, s100
v_mov_b32 v14, v15
s_mov_b32 s47, 5
s_branch .Lx12b
.Lx13:
buffer_load_dword v27, v14, s[76:79], 0 offen
s_mov_b32 s76, s98
s_mov_b32 s77, s99
s_mov_b32 s78, s100
v_mov_b32 v14, v15
s_mov_b32 s47, 5
s_branch .Lx13b
.Lsp14:
s_mov_b32 s15, 0
.Lsp14l:
v_mov_b32 v37, 0
buffer_atomic_add v37, v33, s[16:19], 0 offen sc0
s_add_u32 s15, s15, 1
s_cmp_gt_u32 s15, 100000
s_waitcnt vmcnt(0)
s_cbranch_scc1 .Lsp14b
v_cmp_ne_u32 vcc, v36, v37
s_sleep 2
s_cbranch_vccnz .Lsp14l
s_branch .Lsp14b
.Lx15:
buffer_load_dword v27, v14, s[76:79], 0 offen
s_mov_b32 s76, s98
s_mov_b32 s77, s99
s_mov_b32 s78, s100
v_mov_b32 v14, v15
s_mov_b32 s47, 5
s_branch .Lx15b
.Lx16:
buffer_load_dword v27, v14, s[76:79], 0 offen
s_mov_b32 s76, s98
s_mov_b32 s77, s99
s_mov_b32 s78, s100
v_mov_b32 v14, v15
s_mov_b32 s47, 5
s_branch .Lx16b
.Lx17:
buffer_load_dword v27, v14, s[76:79], 0 offen
s_mov_b32 s76, s98
s_mov_b32 s77, s99
s_mov_b32 s78, s100
v_mov_b32 v14, v15
s_mov_b32 s47, 5
s_branch .Lx17b
.Lx18:
buffer_load_dword v27, v14, s[76:79], 0 offen
s_mov_b32 s76, s98
s_mov_b32 s77, s99
s_mov_b32 s78, s100
v_mov_b32 v14, v15
s_mov_b32 s47, 5
s_branch .Lx18b
.Lx19:
buffer_load_dword v27, v14, s[76:79], 0 offen
s_mov_b32 s76, s98
s_mov_b32 s77, s99
s_mov_b32 s78, s100
v_mov_b32 v14, v15
s_mov_b32 s47, 5
s_branch .Lx19b
.Lx20:
buffer_load_dword v27, v14, s[76:79], 0 offen
s_mov_b32 s76, s98
s_mov_b32 s77, s99
s_mov_b32 s78, s100
v_mov_b32 v14, v15
s_mov_b32 s47, 5
s_branch .Lx20b
.Lx21:
buffer_load_dword v27, v14, s[76:79], 0 offen
s_mov_b32 s76, s98
s_mov_b32 s77, s99
s_mov_b32 s78, s100
v_mov_b32 v14, v15
s_mov_b32 s47, 5
s_branch .Lx21b
.Lsp22:
s_mov_b32 s15, 0
.Lsp22l:
v_mov_b32 v37, 0
buffer_atomic_add v37, v34, s[40:43], 0 offen sc0
s_add_u32 s15, s15, 1
s_cmp_gt_u32 s15, 100000
s_waitcnt vmcnt(0)
s_cbranch_scc1 .Lsp22b
v_cmp_ne_u32 vcc, v35, v37
s_sleep 2
s_cbranch_vccnz .Lsp22l
s_branch .Lsp22b
.Lx23:
buffer_load_dword v27, v14, s[76:79], 0 offen
s_mov_b32 s76, s98
s_mov_b32 s77, s99
s_mov_b32 s78, s100
v_mov_b32 v14, v15
s_mov_b32 s47, 5
s_branch .Lx23b
.Lx24:
buffer_load_dword v27, v14, s[76:79], 0 offen
s_mov_b32 s76, s98
s_mov_b32 s77, s99
s_mov_b32 s78, s100
v_mov_b32 v14, v15
s_mov_b32 s47, 5
s_branch .Lx24b
.Lx25:
buffer_load_dword v27, v14, s[76:79], 0 offen
s_mov_b32 s76, s98
s_mov_b32 s77, s99
s_mov_b32 s78, s100
v_mov_b32 v14, v15
s_mov_b32 s47, 5
s_branch .Lx25b
.Lx26:
buffer_load_dword v27, v14, s[76:79], 0 offen
s_mov_b32 s76, s98
s_mov_b32 s77, s99
s_mov_b32 s78, s100
v_mov_b32 v14, v15
s_mov_b32 s47, 5
s_branch .Lx26b
.Lx27:
buffer_load_dword v27, v14, s[76:79], 0 offen
s_mov_b32 s76, s98
s_mov_b32 s77, s99
s_mov_b32 s78, s100
v_mov_b32 v14, v15
s_mov_b32 s47, 5
s_branch .Lx27b
.Lsp28:
s_mov_b32 s15, 0
.Lsp28l:
v_mov_b32 v37, 0
buffer_atomic_add v37, v33, s[16:19], 0 offen sc0
s_add_u32 s15, s15, 1
s_cmp_gt_u32 s15, 100000
s_waitcnt vmcnt(0)
s_cbranch_scc1 .Lsp28b
v_cmp_ne_u32 vcc, v36, v37
s_sleep 2
s_cbranch_vccnz .Lsp28l
s_branch .Lsp28b
.Lx29:
buffer_load_dword v27, v14, s[76:79], 0 offen
s_mov_b32 s76, s98
s_mov_b32 s77, s99
s_mov_b32 s78, s100
v_mov_b32 v14, v15
s_mov_b32 s47, 5
s_branch .Lx29b
.Lx30:
buffer_load_dword v27, v14, s[76:79], 0 offen
s_mov_b32 s76, s98
s_mov_b32 s77, s99
s_mov_b32 s78, s100
v_mov_b32 v14, v15
s_mov_b32 s47, 5
s_branch .Lx30b
.Lx31:
buffer_load_dword v27, v14, s[76:79], 0 offen
s_mov_b32 s76, s98
s_mov_b32 s77, s99
s_mov_b32 s78, s100
v_mov_b32 v14, v15
s_mov_b32 s47, 5
s_branch .Lx31b
.Lqkv2:
s_add_u32 m0, s55, 0
s_nop 0
buffer_load_dwordx4 v21, s[36:39], s52 offen lds
buffer_load_dwordx4 v28, s[36:39], s52 offen offset:1024 lds
buffer_load_dword v22, s[36:39], s52 offen offset:2048 lds
s_add_u32 s52, s52, 128
s_add_u32 m0, s55, 2304
s_nop 0
buffer_load_dwordx4 v21, s[36:39], s53 offen lds
buffer_load_dwordx4 v28, s[36:39], s53 offen offset:1024 lds
buffer_load_dword v29, s[36:39], s53 offen offset:2048 lds
s_add_u32 s53, s53, 128
s_add_u32 m0, s56, 123648
s_nop 0
buffer_load_dwordx4 v18, s[20:23], s54 offen lds
buffer_load_dwordx4 v19, s[20:23], s54 offen offset:1024 lds
buffer_load_dwordx4 v20, s[20:23], s54 offen offset:2048 lds
s_add_u32 s54, s54, 196608
s_add_u32 m0, s56, 136064
s_nop 0
buffer_load_dwordx4 v18, s[20:23], s54 offen lds
buffer_load_dwordx4 v19, s[20:23], s54 offen offset:1024 lds
buffer_load_dwordx4 v20, s[20:23], s54 offen offset:2048 lds
s_add_u32 s54, s54, 196608
s_waitcnt vmcnt(12)
s_cmp_lt_u32 s14, 16
s_cselect_b32 s62, 0, 4096
v_mov_b32 v154, 1
v_lshlrev_b32 v155, 8, v1
v_permlane16_swap_b32 v128, v130
v_permlane16_swap_b32 v129, v131
v_permlane16_swap_b32 v132, v134
v_permlane16_swap_b32 v133, v135
v_permlane16_swap_b32 v136, v138
v_permlane16_swap_b32 v137, v139
v_permlane16_swap_b32 v140, v142
v_permlane16_swap_b32 v141, v143
buffer_atomic_add v154, v155, s[40:43], s62 offen
v_lshlrev_b32 v64, 16, v128
v_and_b32 v65, 0xffff0000, v128
v_lshlrev_b32 v66, 16, v129
v_and_b32 v67, 0xffff0000, v129
v_lshlrev_b32 v68, 16, v130
v_and_b32 v69, 0xffff0000, v130
v_lshlrev_b32 v70, 16, v131
v_and_b32 v71, 0xffff0000, v131
v_lshlrev_b32 v72, 16, v132
v_and_b32 v73, 0xffff0000, v132
v_lshlrev_b32 v74, 16, v133
v_and_b32 v75, 0xffff0000, v133
v_lshlrev_b32 v76, 16, v134
v_and_b32 v77, 0xffff0000, v134
v_lshlrev_b32 v78, 16, v135
v_and_b32 v79, 0xffff0000, v135
v_lshlrev_b32 v80, 16, v136
v_and_b32 v81, 0xffff0000, v136
v_lshlrev_b32 v82, 16, v137
v_and_b32 v83, 0xffff0000, v137
v_lshlrev_b32 v84, 16, v138
v_and_b32 v85, 0xffff0000, v138
v_lshlrev_b32 v86, 16, v139
v_and_b32 v87, 0xffff0000, v139
v_lshlrev_b32 v88, 16, v140
v_and_b32 v89, 0xffff0000, v140
v_lshlrev_b32 v90, 16, v141
v_and_b32 v91, 0xffff0000, v141
v_lshlrev_b32 v92, 16, v142
v_and_b32 v93, 0xffff0000, v142
v_lshlrev_b32 v94, 16, v143
v_and_b32 v95, 0xffff0000, v143
s_lshl_b32 s64, s6, 14
s_lshl_b32 s65, s49, 13
s_add_u32 s64, s64, s65
s_lshl_b32 s65, s7, 9
s_add_u32 s64, s64, s65
s_lshl_b32 s65, s48, 8
s_add_u32 s64, s64, s65
s_add_u32 s64, s64, 29360128
v_and_b32 v152, 31, v1
v_lshlrev_b32 v152, 3, v152
v_lshrrev_b32 v153, 5, v1
v_lshl_add_u32 v152, v153, 28, v152
s_lshl_b32 s62, s7, 18
s_add_u32 s62, s62, 0
s_add_u32 s63, s62, 0x20000
v_pk_mul_f32 v[146:147], v[64:65], v[64:65]
v_pk_mul_f32 v[150:151], v[80:81], v[80:81]
v_pk_fma_f32 v[146:147], v[66:67], v[66:67], v[146:147]
v_pk_add_f32 v[144:145], v[64:65], v[66:67]
v_pk_fma_f32 v[150:151], v[82:83], v[82:83], v[150:151]
v_pk_add_f32 v[148:149], v[80:81], v[82:83]
v_pk_fma_f32 v[146:147], v[68:69], v[68:69], v[146:147]
v_pk_add_f32 v[144:145], v[144:145], v[68:69]
v_pk_fma_f32 v[150:151], v[84:85], v[84:85], v[150:151]
v_pk_add_f32 v[148:149], v[148:149], v[84:85]
v_pk_fma_f32 v[146:147], v[70:71], v[70:71], v[146:147]
v_pk_add_f32 v[144:145], v[144:145], v[70:71]
v_pk_fma_f32 v[150:151], v[86:87], v[86:87], v[150:151]
v_pk_add_f32 v[148:149], v[148:149], v[86:87]
v_pk_fma_f32 v[146:147], v[72:73], v[72:73], v[146:147]
v_pk_add_f32 v[144:145], v[144:145], v[72:73]
v_pk_fma_f32 v[150:151], v[88:89], v[88:89], v[150:151]
v_pk_add_f32 v[148:149], v[148:149], v[88:89]
v_pk_fma_f32 v[146:147], v[74:75], v[74:75], v[146:147]
v_pk_add_f32 v[144:145], v[144:145], v[74:75]
v_pk_fma_f32 v[150:151], v[90:91], v[90:91], v[150:151]
v_pk_add_f32 v[148:149], v[148:149], v[90:91]
v_pk_fma_f32 v[146:147], v[76:77], v[76:77], v[146:147]
v_pk_add_f32 v[144:145], v[144:145], v[76:77]
v_pk_fma_f32 v[150:151], v[92:93], v[92:93], v[150:151]
v_pk_add_f32 v[148:149], v[148:149], v[92:93]
v_pk_fma_f32 v[146:147], v[78:79], v[78:79], v[146:147]
v_pk_add_f32 v[144:145], v[144:145], v[78:79]
v_pk_fma_f32 v[150:151], v[94:95], v[94:95], v[150:151]
v_pk_add_f32 v[148:149], v[148:149], v[94:95]
v_add_f32 v144, v144, v145
v_add_f32 v146, v146, v147
v_add_f32 v148, v148, v149
v_add_f32 v150, v150, v151
s_nop 0
v_permlane16_swap_b32 v144, v148
v_permlane16_swap_b32 v146, v150
v_add_f32 v144, v144, v148
v_add_f32 v146, v146, v150
s_nop 1
v_permlane32_swap_b32 v144, v146
v_add_f32 v144, v144, v146
s_nop 1
v_permlane32_swap_b32 v144, v145
buffer_store_dwordx2 v[144:145], v152, s[16:19], s64 offen sc1
s_lshl_b32 s62, s2, 10
s_add_u32 s62, s62, 31457280
s_cmp_eq_u32 s3, 0
s_cselect_b32 s62, s62, 268435456
buffer_store_dwordx4 v[156:159], v27, s[16:19], s62 offen sc1
v_accvgpr_write_b32 a224, v64
v_accvgpr_write_b32 a225, v65
v_accvgpr_write_b32 a226, v66
v_accvgpr_write_b32 a227, v67
v_accvgpr_write_b32 a228, v68
v_accvgpr_write_b32 a229, v69
v_accvgpr_write_b32 a230, v70
v_accvgpr_write_b32 a231, v71
v_accvgpr_write_b32 a232, v72
v_accvgpr_write_b32 a233, v73
v_accvgpr_write_b32 a234, v74
v_accvgpr_write_b32 a235, v75
v_accvgpr_write_b32 a236, v76
v_accvgpr_write_b32 a237, v77
v_accvgpr_write_b32 a238, v78
v_accvgpr_write_b32 a239, v79
v_accvgpr_write_b32 a240, v80
v_accvgpr_write_b32 a241, v81
v_accvgpr_write_b32 a242, v82
v_accvgpr_write_b32 a243, v83
v_accvgpr_write_b32 a244, v84
v_accvgpr_write_b32 a245, v85
v_accvgpr_write_b32 a246, v86
v_accvgpr_write_b32 a247, v87
v_accvgpr_write_b32 a248, v88
v_accvgpr_write_b32 a249, v89
v_accvgpr_write_b32 a250, v90
v_accvgpr_write_b32 a251, v91
v_accvgpr_write_b32 a252, v92
v_accvgpr_write_b32 a253, v93
v_accvgpr_write_b32 a254, v94
v_accvgpr_write_b32 a255, v95
s_add_u32 m0, s55, 18496
s_nop 0
buffer_load_dwordx4 v21, s[36:39], s52 offen lds
buffer_load_dwordx4 v28, s[36:39], s52 offen offset:1024 lds
buffer_load_dword v22, s[36:39], s52 offen offset:2048 lds
s_add_u32 s52, s52, 128
s_add_u32 m0, s55, 20800
s_nop 0
buffer_load_dwordx4 v21, s[36:39], s53 offen lds
buffer_load_dwordx4 v28, s[36:39], s53 offen offset:1024 lds
buffer_load_dword v29, s[36:39], s53 offen offset:2048 lds
s_add_u32 s53, s53, 128
s_add_u32 m0, s56, 73984
s_nop 0
buffer_load_dwordx4 v18, s[20:23], s54 offen lds
buffer_load_dwordx4 v19, s[20:23], s54 offen offset:1024 lds
buffer_load_dwordx4 v20, s[20:23], s54 offen offset:2048 lds
s_add_u32 s54, s54, 196608
s_waitcnt vmcnt(15) lgkmcnt(0)
s_barrier
ds_read_b128 a[0:3], v23
ds_read_b128 a[4:7], v23 offset:2304
ds_read_b128 a[8:11], v23 offset:4608
ds_read_b128 a[12:15], v23 offset:6912
ds_read_b64_tr_b16 a[20:21], v25 offset:49664
ds_read_b64_tr_b16 a[22:23], v25 offset:50176
ds_read_b64_tr_b16 a[24:25], v25 offset:49696
ds_read_b64_tr_b16 a[26:27], v25 offset:50208
ds_read_b128 a[16:19], v24
ds_read_b64_tr_b16 a[28:29], v25 offset:50688
ds_read_b64_tr_b16 a[30:31], v25 offset:51200
ds_read_b64_tr_b16 a[32:33], v25 offset:50720
ds_read_b64_tr_b16 a[34:35], v25 offset:51232
ds_read_b64_tr_b16 a[36:37], v25 offset:51712
ds_read_b64_tr_b16 a[38:39], v25 offset:52224
ds_read_b64_tr_b16 a[40:41], v25 offset:51744
ds_read_b64_tr_b16 a[42:43], v25 offset:52256
s_waitcnt vmcnt(12) lgkmcnt(8)
s_barrier
v_mfma_f32_16x16x32_bf16 v[60:63], a[20:23], a[0:3], 0
ds_read_b128 a[44:47], v30
ds_read_b128 a[48:51], v30 offset:2304
v_mfma_f32_16x16x32_bf16 v[76:79], a[24:27], a[0:3], 0
s_add_u32 m0, s56, 86400
v_mfma_f32_16x16x32_bf16 v[80:83], a[24:27], a[4:7], 0
buffer_load_dwordx4 v18, s[20:23], s54 offen lds
v_mfma_f32_16x16x32_bf16 v[64:67], a[20:23], a[4:7], 0
s_sub_u32 s47, s47, 1
s_cbranch_scc1 .Lx18
.Lx18b:
v_mfma_f32_16x16x32_bf16 v[68:71], a[20:23], a[8:11], 0
buffer_load_dwordx4 v19, s[20:23], s54 offen offset:1024 lds
v_mfma_f32_16x16x32_bf16 v[84:87], a[24:27], a[8:11], 0
ds_read_b128 a[52:55], v30 offset:4608
ds_read_b128 a[56:59], v30 offset:6912
v_mfma_f32_16x16x32_bf16 v[88:91], a[24:27], a[12:15], 0
ds_read_b64_tr_b16 a[64:65], v25 offset:62080
v_mfma_f32_16x16x32_bf16 v[72:75], a[20:23], a[12:15], 0
ds_read_b64_tr_b16 a[66:67], v25 offset:62592
s_waitcnt lgkmcnt(6)
v_mfma_f32_16x16x32_bf16 v[244:247], a[24:27], a[16:19], 0
buffer_load_dwordx4 v20, s[20:23], s54 offen offset:2048 lds
v_mfma_f32_16x16x32_bf16 v[104:107], a[28:31], a[12:15], 0
s_add_u32 s54, s54, 196608
s_add_u32 m0, s55, 36992
v_mfma_f32_16x16x32_bf16 v[120:123], a[32:35], a[12:15], 0
buffer_load_dwordx4 v21, s[36:39], s52 offen lds
v_mfma_f32_16x16x32_bf16 v[116:119], a[32:35], a[8:11], 0
ds_read_b64_tr_b16 a[68:69], v25 offset:62112
ds_read_b64_tr_b16 a[70:71], v25 offset:62624
v_mfma_f32_16x16x32_bf16 v[100:103], a[28:31], a[8:11], 0
ds_read_b128 a[60:63], v31
v_mfma_f32_16x16x32_bf16 v[96:99], a[28:31], a[4:7], 0
buffer_load_dwordx4 v28, s[36:39], s52 offen offset:1024 lds
v_mfma_f32_16x16x32_bf16 v[112:115], a[32:35], a[4:7], 0
ds_read_b64_tr_b16 a[72:73], v25 offset:63104
v_mfma_f32_16x16x32_bf16 v[108:111], a[32:35], a[0:3], 0
buffer_load_dword v22, s[36:39], s52 offen offset:2048 lds
v_mfma_f32_16x16x32_bf16 v[92:95], a[28:31], a[0:3], 0
ds_read_b64_tr_b16 a[74:75], v25 offset:63616
s_add_u32 s52, s52, 128
v_mfma_f32_16x16x32_bf16 v[124:127], a[0:3], a[36:39], 0
ds_read_b64_tr_b16 a[76:77], v25 offset:63136
s_add_u32 m0, s55, 39296
v_mfma_f32_16x16x32_bf16 v[140:143], a[0:3], a[40:43], 0
buffer_load_dwordx4 v21, s[36:39], s53 offen lds
v_mfma_f32_16x16x32_bf16 v[144:147], a[4:7], a[40:43], 0
ds_read_b64_tr_b16 a[78:79], v25 offset:63648
v_mfma_f32_16x16x32_bf16 v[128:131], a[4:7], a[36:39], 0
ds_read_b64_tr_b16 a[80:81], v25 offset:64128
v_mfma_f32_16x16x32_bf16 v[132:135], a[8:11], a[36:39], 0
buffer_load_dwordx4 v28, s[36:39], s53 offen offset:1024 lds
v_mfma_f32_16x16x32_bf16 v[148:151], a[8:11], a[40:43], 0
ds_read_b64_tr_b16 a[82:83], v25 offset:64640
ds_read_b64_tr_b16 a[84:85], v25 offset:64160
v_mfma_f32_16x16x32_bf16 v[152:155], a[12:15], a[40:43], 0
ds_read_b64_tr_b16 a[86:87], v25 offset:64672
v_mfma_f32_16x16x32_bf16 v[136:139], a[12:15], a[36:39], 0
buffer_load_dword v29, s[36:39], s53 offen offset:2048 lds
v_mfma_f32_16x16x32_bf16 v[156:159], a[16:19], a[36:39], 0
s_add_u32 s53, s53, 128
v_mfma_f32_16x16x32_bf16 v[160:163], a[16:19], a[40:43], 0
s_waitcnt vmcnt(9) lgkmcnt(8)
s_barrier
v_mfma_f32_16x16x32_bf16 v[60:63], a[64:67], a[44:47], v[60:63]
ds_read_b128 a[0:3], v23 offset:18496
ds_read_b128 a[4:7], v23 offset:20800
v_mfma_f32_16x16x32_bf16 v[76:79], a[68:71], a[44:47], v[76:79]
s_add_u32 m0, s56, 98816
v_mfma_f32_16x16x32_bf16 v[80:83], a[68:71], a[48:51], v[80:83]
buffer_load_dwordx4 v18, s[20:23], s54 offen lds
v_mfma_f32_16x16x32_bf16 v[64:67], a[64:67], a[48:51], v[64:67]
ds_read_b128 a[8:11], v23 offset:23104
ds_read_b128 a[12:15], v23 offset:25408
v_mfma_f32_16x16x32_bf16 v[68:71], a[64:67], a[52:55], v[68:71]
buffer_load_dwordx4 v19, s[20:23], s54 offen offset:1024 lds
v_mfma_f32_16x16x32_bf16 v[84:87], a[68:71], a[52:55], v[84:87]
ds_read_b64_tr_b16 a[20:21], v25
v_mfma_f32_16x16x32_bf16 v[88:91], a[68:71], a[56:59], v[88:91]
ds_read_b64_tr_b16 a[22:23], v25 offset:512
v_mfma_f32_16x16x32_bf16 v[72:75], a[64:67], a[56:59], v[72:75]
ds_read_b64_tr_b16 a[24:25], v25 offset:32
s_waitcnt lgkmcnt(7)
v_mfma_f32_16x16x32_bf16 v[244:247], a[68:71], a[60:63], v[244:247]
buffer_load_dwordx4 v20, s[20:23], s54 offen offset:2048 lds
v_mfma_f32_16x16x32_bf16 v[104:107], a[72:75], a[56:59], v[104:107]
s_add_u32 s54, s54, 196608
s_add_u32 m0, s56, 111232
v_mfma_f32_16x16x32_bf16 v[120:123], a[76:79], a[56:59], v[120:123]
buffer_load_dwordx4 v18, s[20:23], s54 offen lds
v_mfma_f32_16x16x32_bf16 v[116:119], a[76:79], a[52:55], v[116:119]
ds_read_b64_tr_b16 a[26:27], v25 offset:544
v_mfma_f32_16x16x32_bf16 v[100:103], a[72:75], a[52:55], v[100:103]
ds_read_b128 a[16:19], v24 offset:18496
ds_read_b64_tr_b16 a[28:29], v25 offset:1024
v_mfma_f32_16x16x32_bf16 v[96:99], a[72:75], a[48:51], v[96:99]
buffer_load_dwordx4 v19, s[20:23], s54 offen offset:1024 lds
v_mfma_f32_16x16x32_bf16 v[112:115], a[76:79], a[48:51], v[112:115]
ds_read_b64_tr_b16 a[30:31], v25 offset:1536
v_mfma_f32_16x16x32_bf16 v[108:111], a[76:79], a[44:47], v[108:111]
buffer_load_dwordx4 v20, s[20:23], s54 offen offset:2048 lds
v_mfma_f32_16x16x32_bf16 v[92:95], a[72:75], a[44:47], v[92:95]
s_add_u32 s54, s54, 196608
v_mfma_f32_16x16x32_bf16 v[124:127], a[44:47], a[80:83], v[124:127]
ds_read_b64_tr_b16 a[32:33], v25 offset:1056
s_add_u32 m0, s55, 55488
v_mfma_f32_16x16x32_bf16 v[140:143], a[44:47], a[84:87], v[140:143]
buffer_load_dwordx4 v21, s[36:39], s52 offen lds
v_mfma_f32_16x16x32_bf16 v[144:147], a[48:51], a[84:87], v[144:147]
ds_read_b64_tr_b16 a[34:35], v25 offset:1568
v_mfma_f32_16x16x32_bf16 v[128:131], a[48:51], a[80:83], v[128:131]
ds_read_b64_tr_b16 a[36:37], v25 offset:2048
v_mfma_f32_16x16x32_bf16 v[132:135], a[52:55], a[80:83], v[132:135]
buffer_load_dwordx4 v28, s[36:39], s52 offen offset:1024 lds
v_mfma_f32_16x16x32_bf16 v[148:151], a[52:55], a[84:87], v[148:151]
ds_read_b64_tr_b16 a[38:39], v25 offset:2560
ds_read_b64_tr_b16 a[40:41], v25 offset:2080
v_mfma_f32_16x16x32_bf16 v[152:155], a[56:59], a[84:87], v[152:155]
ds_read_b64_tr_b16 a[42:43], v25 offset:2592
v_mfma_f32_16x16x32_bf16 v[136:139], a[56:59], a[80:83], v[136:139]
buffer_load_dword v22, s[36:39], s52 offen offset:2048 lds
v_mfma_f32_16x16x32_bf16 v[156:159], a[60:63], a[80:83], v[156:159]
s_add_u32 s52, s52, 128
v_mfma_f32_16x16x32_bf16 v[160:163], a[60:63], a[84:87], v[160:163]
s_waitcnt vmcnt(15) lgkmcnt(8)
s_barrier
v_mfma_f32_16x16x32_bf16 v[60:63], a[20:23], a[0:3], v[60:63]
ds_read_b128 a[44:47], v30 offset:18496
ds_read_b128 a[48:51], v30 offset:20800
v_mfma_f32_16x16x32_bf16 v[76:79], a[24:27], a[0:3], v[76:79]
s_add_u32 m0, s55, 57792
v_mfma_f32_16x16x32_bf16 v[80:83], a[24:27], a[4:7], v[80:83]
buffer_load_dwordx4 v21, s[36:39], s53 offen lds
v_mfma_f32_16x16x32_bf16 v[64:67], a[20:23], a[4:7], v[64:67]
s_sub_u32 s47, s47, 1
s_cbranch_scc1 .Lx19
.Lx19b:
v_mfma_f32_16x16x32_bf16 v[68:71], a[20:23], a[8:11], v[68:71]
buffer_load_dwordx4 v28, s[36:39], s53 offen offset:1024 lds
v_mfma_f32_16x16x32_bf16 v[84:87], a[24:27], a[8:11], v[84:87]
ds_read_b128 a[52:55], v30 offset:23104
ds_read_b128 a[56:59], v30 offset:25408
v_mfma_f32_16x16x32_bf16 v[88:91], a[24:27], a[12:15], v[88:91]
ds_read_b64_tr_b16 a[64:65], v25 offset:12416
v_mfma_f32_16x16x32_bf16 v[72:75], a[20:23], a[12:15], v[72:75]
ds_read_b64_tr_b16 a[66:67], v25 offset:12928
s_waitcnt lgkmcnt(6)
v_mfma_f32_16x16x32_bf16 v[244:247], a[24:27], a[16:19], v[244:247]
buffer_load_dword v29, s[36:39], s53 offen offset:2048 lds
v_mfma_f32_16x16x32_bf16 v[104:107], a[28:31], a[12:15], v[104:107]
s_add_u32 s53, s53, 128
s_add_u32 m0, s56, 123648
v_mfma_f32_16x16x32_bf16 v[120:123], a[32:35], a[12:15], v[120:123]
buffer_load_dwordx4 v18, s[20:23], s54 offen lds
v_mfma_f32_16x16x32_bf16 v[116:119], a[32:35], a[8:11], v[116:119]
ds_read_b64_tr_b16 a[68:69], v25 offset:12448
ds_read_b64_tr_b16 a[70:71], v25 offset:12960
v_mfma_f32_16x16x32_bf16 v[100:103], a[28:31], a[8:11], v[100:103]
ds_read_b128 a[60:63], v31 offset:18496
v_mfma_f32_16x16x32_bf16 v[96:99], a[28:31], a[4:7], v[96:99]
buffer_load_dwordx4 v19, s[20:23], s54 offen offset:1024 lds
v_mfma_f32_16x16x32_bf16 v[112:115], a[32:35], a[4:7], v[112:115]
ds_read_b64_tr_b16 a[72:73], v25 offset:13440
v_mfma_f32_16x16x32_bf16 v[108:111], a[32:35], a[0:3], v[108:111]
buffer_load_dwordx4 v20, s[20:23], s54 offen offset:2048 lds
v_mfma_f32_16x16x32_bf16 v[92:95], a[28:31], a[0:3], v[92:95]
ds_read_b64_tr_b16 a[74:75], v25 offset:13952
s_add_u32 s54, s54, 196608
v_mfma_f32_16x16x32_bf16 v[124:127], a[0:3], a[36:39], v[124:127]
ds_read_b64_tr_b16 a[76:77], v25 offset:13472
s_add_u32 m0, s56, 136064
v_mfma_f32_16x16x32_bf16 v[140:143], a[0:3], a[40:43], v[140:143]
buffer_load_dwordx4 v18, s[20:23], s54 offen lds
v_mfma_f32_16x16x32_bf16 v[144:147], a[4:7], a[40:43], v[144:147]
ds_read_b64_tr_b16 a[78:79], v25 offset:13984
v_mfma_f32_16x16x32_bf16 v[128:131], a[4:7], a[36:39], v[128:131]
ds_read_b64_tr_b16 a[80:81], v25 offset:14464
v_mfma_f32_16x16x32_bf16 v[132:135], a[8:11], a[36:39], v[132:135]
buffer_load_dwordx4 v19, s[20:23], s54 offen offset:1024 lds
v_mfma_f32_16x16x32_bf16 v[148:151], a[8:11], a[40:43], v[148:151]
ds_read_b64_tr_b16 a[82:83], v25 offset:14976
ds_read_b64_tr_b16 a[84:85], v25 offset:14496
v_mfma_f32_16x16x32_bf16 v[152:155], a[12:15], a[40:43], v[152:155]
ds_read_b64_tr_b16 a[86:87], v25 offset:15008
v_mfma_f32_16x16x32_bf16 v[136:139], a[12:15], a[36:39], v[136:139]
buffer_load_dwordx4 v20, s[20:23], s54 offen offset:2048 lds
v_mfma_f32_16x16x32_bf16 v[156:159], a[16:19], a[36:39], v[156:159]
s_add_u32 s54, s54, 196608
v_mfma_f32_16x16x32_bf16 v[160:163], a[16:19], a[40:43], v[160:163]
s_waitcnt vmcnt(15) lgkmcnt(8)
s_barrier
v_mfma_f32_16x16x32_bf16 v[60:63], a[64:67], a[44:47], v[60:63]
ds_read_b128 a[0:3], v23 offset:36992
ds_read_b128 a[4:7], v23 offset:39296
v_mfma_f32_16x16x32_bf16 v[76:79], a[68:71], a[44:47], v[76:79]
s_add_u32 m0, s55, 0
v_mfma_f32_16x16x32_bf16 v[80:83], a[68:71], a[48:51], v[80:83]
buffer_load_dwordx4 v21, s[36:39], s52 offen lds
v_mfma_f32_16x16x32_bf16 v[64:67], a[64:67], a[48:51], v[64:67]
ds_read_b128 a[8:11], v23 offset:41600
ds_read_b128 a[12:15], v23 offset:43904
v_mfma_f32_16x16x32_bf16 v[68:71], a[64:67], a[52:55], v[68:71]
buffer_load_dwordx4 v28, s[36:39], s52 offen offset:1024 lds
v_mfma_f32_16x16x32_bf16 v[84:87], a[68:71], a[52:55], v[84:87]
ds_read_b64_tr_b16 a[20:21], v25 offset:24832
v_mfma_f32_16x16x32_bf16 v[88:91], a[68:71], a[56:59], v[88:91]
ds_read_b64_tr_b16 a[22:23], v25 offset:25344
v_mfma_f32_16x16x32_bf16 v[72:75], a[64:67], a[56:59], v[72:75]
ds_read_b64_tr_b16 a[24:25], v25 offset:24864
s_waitcnt lgkmcnt(7)
v_mfma_f32_16x16x32_bf16 v[244:247], a[68:71], a[60:63], v[244:247]
buffer_load_dword v22, s[36:39], s52 offen offset:2048 lds
v_mfma_f32_16x16x32_bf16 v[104:107], a[72:75], a[56:59], v[104:107]
ds_read_b64_tr_b16 a[26:27], v25 offset:25376
s_add_u32 s52, s52, 128
s_add_u32 m0, s55, 2304
v_mfma_f32_16x16x32_bf16 v[120:123], a[76:79], a[56:59], v[120:123]
buffer_load_dwordx4 v21, s[36:39], s53 offen lds
v_mfma_f32_16x16x32_bf16 v[116:119], a[76:79], a[52:55], v[116:119]
ds_read_b128 a[16:19], v24 offset:36992
v_mfma_f32_16x16x32_bf16 v[100:103], a[72:75], a[52:55], v[100:103]
buffer_load_dwordx4 v28, s[36:39], s53 offen offset:1024 lds
v_mfma_f32_16x16x32_bf16 v[96:99], a[72:75], a[48:51], v[96:99]
ds_read_b64_tr_b16 a[28:29], v25 offset:25856
v_mfma_f32_16x16x32_bf16 v[112:115], a[76:79], a[48:51], v[112:115]
buffer_load_dword v29, s[36:39], s53 offen offset:2048 lds
v_mfma_f32_16x16x32_bf16 v[108:111], a[76:79], a[44:47], v[108:111]
ds_read_b64_tr_b16 a[30:31], v25 offset:26368
s_add_u32 s53, s53, 128
v_mfma_f32_16x16x32_bf16 v[92:95], a[72:75], a[44:47], v[92:95]
ds_read_b64_tr_b16 a[32:33], v25 offset:25888
s_add_u32 m0, s56, 73984
v_mfma_f32_16x16x32_bf16 v[124:127], a[44:47], a[80:83], v[124:127]
buffer_load_dwordx4 v18, s[20:23], s54 offen lds
v_mfma_f32_16x16x32_bf16 v[140:143], a[44:47], a[84:87], v[140:143]
ds_read_b64_tr_b16 a[34:35], v25 offset:26400
v_mfma_f32_16x16x32_bf16 v[144:147], a[48:51], a[84:87], v[144:147]
buffer_load_dwordx4 v19, s[20:23], s54 offen offset:1024 lds
v_mfma_f32_16x16x32_bf16 v[128:131], a[48:51], a[80:83], v[128:131]
ds_read_b64_tr_b16 a[36:37], v25 offset:26880
v_mfma_f32_16x16x32_bf16 v[132:135], a[52:55], a[80:83], v[132:135]
ds_read_b64_tr_b16 a[38:39], v25 offset:27392
ds_read_b64_tr_b16 a[40:41], v25 offset:26912
v_mfma_f32_16x16x32_bf16 v[148:151], a[52:55], a[84:87], v[148:151]
buffer_load_dwordx4 v20, s[20:23], s54 offen offset:2048 lds
v_mfma_f32_16x16x32_bf16 v[152:155], a[56:59], a[84:87], v[152:155]
s_add_u32 s54, s54, 196608
v_mfma_f32_16x16x32_bf16 v[136:139], a[56:59], a[80:83], v[136:139]
buffer_load_dword v37, v34, s[40:43], 0 offen sc1
v_mfma_f32_16x16x32_bf16 v[156:159], a[60:63], a[80:83], v[156:159]
ds_read_b64_tr_b16 a[42:43], v25 offset:27424
v_mfma_f32_16x16x32_bf16 v[160:163], a[60:63], a[84:87], v[160:163]
s_waitcnt vmcnt(22) lgkmcnt(8)
s_barrier
v_mfma_f32_16x16x32_bf16 v[60:63], a[20:23], a[0:3], v[60:63]
ds_read_b128 a[44:47], v30 offset:36992
ds_read_b128 a[48:51], v30 offset:39296
v_mfma_f32_16x16x32_bf16 v[76:79], a[24:27], a[0:3], v[76:79]
s_add_u32 m0, s56, 86400
v_mfma_f32_16x16x32_bf16 v[80:83], a[24:27], a[4:7], v[80:83]
buffer_load_dwordx4 v18, s[20:23], s54 offen lds
v_mfma_f32_16x16x32_bf16 v[64:67], a[20:23], a[4:7], v[64:67]
s_sub_u32 s47, s47, 1
s_cbranch_scc1 .Lx20
.Lx20b:
v_mfma_f32_16x16x32_bf16 v[68:71], a[20:23], a[8:11], v[68:71]
buffer_load_dwordx4 v19, s[20:23], s54 offen offset:1024 lds
v_mfma_f32_16x16x32_bf16 v[84:87], a[24:27], a[8:11], v[84:87]
ds_read_b128 a[52:55], v30 offset:41600
ds_read_b128 a[56:59], v30 offset:43904
v_mfma_f32_16x16x32_bf16 v[88:91], a[24:27], a[12:15], v[88:91]
ds_read_b64_tr_b16 a[64:65], v25 offset:37248
v_mfma_f32_16x16x32_bf16 v[72:75], a[20:23], a[12:15], v[72:75]
ds_read_b64_tr_b16 a[66:67], v25 offset:37760
s_waitcnt lgkmcnt(6)
v_mfma_f32_16x16x32_bf16 v[244:247], a[24:27], a[16:19], v[244:247]
buffer_load_dwordx4 v20, s[20:23], s54 offen offset:2048 lds
v_mfma_f32_16x16x32_bf16 v[104:107], a[28:31], a[12:15], v[104:107]
s_add_u32 s54, s54, 196608
s_add_u32 m0, s55, 18496
v_mfma_f32_16x16x32_bf16 v[120:123], a[32:35], a[12:15], v[120:123]
buffer_load_dwordx4 v21, s[36:39], s52 offen lds
v_mfma_f32_16x16x32_bf16 v[116:119], a[32:35], a[8:11], v[116:119]
ds_read_b64_tr_b16 a[68:69], v25 offset:37280
ds_read_b64_tr_b16 a[70:71], v25 offset:37792
v_mfma_f32_16x16x32_bf16 v[100:103], a[28:31], a[8:11], v[100:103]
ds_read_b128 a[60:63], v31 offset:36992
v_mfma_f32_16x16x32_bf16 v[96:99], a[28:31], a[4:7], v[96:99]
buffer_load_dwordx4 v28, s[36:39], s52 offen offset:1024 lds
v_mfma_f32_16x16x32_bf16 v[112:115], a[32:35], a[4:7], v[112:115]
ds_read_b64_tr_b16 a[72:73], v25 offset:38272
v_mfma_f32_16x16x32_bf16 v[108:111], a[32:35], a[0:3], v[108:111]
buffer_load_dword v22, s[36:39], s52 offen offset:2048 lds
v_mfma_f32_16x16x32_bf16 v[92:95], a[28:31], a[0:3], v[92:95]
ds_read_b64_tr_b16 a[74:75], v25 offset:38784
s_add_u32 s52, s52, 128
v_mfma_f32_16x16x32_bf16 v[124:127], a[0:3], a[36:39], v[124:127]
ds_read_b64_tr_b16 a[76:77], v25 offset:38304
s_add_u32 m0, s55, 20800
v_mfma_f32_16x16x32_bf16 v[140:143], a[0:3], a[40:43], v[140:143]
buffer_load_dwordx4 v21, s[36:39], s53 offen lds
v_mfma_f32_16x16x32_bf16 v[144:147], a[4:7], a[40:43], v[144:147]
ds_read_b64_tr_b16 a[78:79], v25 offset:38816
v_mfma_f32_16x16x32_bf16 v[128:131], a[4:7], a[36:39], v[128:131]
ds_read_b64_tr_b16 a[80:81], v25 offset:39296
v_mfma_f32_16x16x32_bf16 v[132:135], a[8:11], a[36:39], v[132:135]
buffer_load_dwordx4 v28, s[36:39], s53 offen offset:1024 lds
v_mfma_f32_16x16x32_bf16 v[148:151], a[8:11], a[40:43], v[148:151]
ds_read_b64_tr_b16 a[82:83], v25 offset:39808
ds_read_b64_tr_b16 a[84:85], v25 offset:39328
v_mfma_f32_16x16x32_bf16 v[152:155], a[12:15], a[40:43], v[152:155]
ds_read_b64_tr_b16 a[86:87], v25 offset:39840
v_mfma_f32_16x16x32_bf16 v[136:139], a[12:15], a[36:39], v[136:139]
buffer_load_dword v29, s[36:39], s53 offen offset:2048 lds
v_mfma_f32_16x16x32_bf16 v[156:159], a[16:19], a[36:39], v[156:159]
s_add_u32 s53, s53, 128
v_mfma_f32_16x16x32_bf16 v[160:163], a[16:19], a[40:43], v[160:163]
s_waitcnt vmcnt(22) lgkmcnt(8)
s_barrier
v_mfma_f32_16x16x32_bf16 v[60:63], a[64:67], a[44:47], v[60:63]
ds_read_b128 a[0:3], v23 offset:55488
v_mfma_f32_16x16x32_bf16 v[76:79], a[68:71], a[44:47], v[76:79]
ds_read_b128 a[4:7], v23 offset:57792
s_add_u32 m0, s56, 98816
v_mfma_f32_16x16x32_bf16 v[80:83], a[68:71], a[48:51], v[80:83]
buffer_load_dwordx4 v18, s[20:23], s54 offen lds
v_mfma_f32_16x16x32_bf16 v[64:67], a[64:67], a[48:51], v[64:67]
ds_read_b128 a[8:11], v23 offset:60096
v_mfma_f32_16x16x32_bf16 v[68:71], a[64:67], a[52:55], v[68:71]
ds_read_b128 a[12:15], v23 offset:62400
v_mfma_f32_16x16x32_bf16 v[84:87], a[68:71], a[52:55], v[84:87]
ds_read_b64_tr_b16 a[20:21], v25 offset:49664
v_mfma_f32_16x16x32_bf16 v[88:91], a[68:71], a[56:59], v[88:91]
buffer_load_dwordx4 v19, s[20:23], s54 offen offset:1024 lds
v_mfma_f32_16x16x32_bf16 v[72:75], a[64:67], a[56:59], v[72:75]
ds_read_b64_tr_b16 a[22:23], v25 offset:50176
s_waitcnt lgkmcnt(6)
v_mfma_f32_16x16x32_bf16 v[244:247], a[68:71], a[60:63], v[244:247]
v_mfma_f32_16x16x32_bf16 v[104:107], a[72:75], a[56:59], v[104:107]
ds_read_b64_tr_b16 a[24:25], v25 offset:49696
v_mfma_f32_16x16x32_bf16 v[120:123], a[76:79], a[56:59], v[120:123]
buffer_load_dwordx4 v20, s[20:23], s54 offen offset:2048 lds
v_mfma_f32_16x16x32_bf16 v[116:119], a[76:79], a[52:55], v[116:119]
ds_read_b64_tr_b16 a[26:27], v25 offset:50208
s_add_u32 s54, s54, 196608
v_mfma_f32_16x16x32_bf16 v[100:103], a[72:75], a[52:55], v[100:103]
ds_read_b128 a[16:19], v24 offset:55488
v_mfma_f32_16x16x32_bf16 v[96:99], a[72:75], a[48:51], v[96:99]
ds_read_b64_tr_b16 a[28:29], v25 offset:50688
s_add_u32 m0, s55, 36992
v_mfma_f32_16x16x32_bf16 v[112:115], a[76:79], a[48:51], v[112:115]
buffer_load_dwordx4 v21, s[36:39], s52 offen lds
v_mfma_f32_16x16x32_bf16 v[108:111], a[76:79], a[44:47], v[108:111]
ds_read_b64_tr_b16 a[30:31], v25 offset:51200
v_mfma_f32_16x16x32_bf16 v[92:95], a[72:75], a[44:47], v[92:95]
ds_read_b64_tr_b16 a[32:33], v25 offset:50720
v_mfma_f32_16x16x32_bf16 v[124:127], a[44:47], a[80:83], v[124:127]
v_mfma_f32_16x16x32_bf16 v[140:143], a[44:47], a[84:87], v[140:143]
buffer_load_dwordx4 v28, s[36:39], s52 offen offset:1024 lds
v_mfma_f32_16x16x32_bf16 v[144:147], a[48:51], a[84:87], v[144:147]
ds_read_b64_tr_b16 a[34:35], v25 offset:51232
v_mfma_f32_16x16x32_bf16 v[128:131], a[48:51], a[80:83], v[128:131]
ds_read_b64_tr_b16 a[36:37], v25 offset:51712
v_mfma_f32_16x16x32_bf16 v[132:135], a[52:55], a[80:83], v[132:135]
ds_read_b64_tr_b16 a[38:39], v25 offset:52224
v_mfma_f32_16x16x32_bf16 v[148:151], a[52:55], a[84:87], v[148:151]
buffer_load_dword v22, s[36:39], s52 offen offset:2048 lds
v_mfma_f32_16x16x32_bf16 v[152:155], a[56:59], a[84:87], v[152:155]
ds_read_b64_tr_b16 a[40:41], v25 offset:51744
s_add_u32 s52, s52, 128
v_mfma_f32_16x16x32_bf16 v[136:139], a[56:59], a[80:83], v[136:139]
ds_read_b64_tr_b16 a[42:43], v25 offset:52256
v_mfma_f32_16x16x32_bf16 v[156:159], a[60:63], a[80:83], v[156:159]
v_mfma_f32_16x16x32_bf16 v[160:163], a[60:63], a[84:87], v[160:163]
s_waitcnt vmcnt(25) lgkmcnt(8)
s_barrier
v_mfma_f32_16x16x32_bf16 v[60:63], a[20:23], a[0:3], v[60:63]
ds_read_b128 a[44:47], v30 offset:55488
v_mfma_f32_16x16x32_bf16 v[76:79], a[24:27], a[0:3], v[76:79]
ds_read_b128 a[48:51], v30 offset:57792
s_add_u32 m0, s56, 111232
v_mfma_f32_16x16x32_bf16 v[80:83], a[24:27], a[4:7], v[80:83]
buffer_load_dwordx4 v18, s[20:23], s54 offen lds
v_mfma_f32_16x16x32_bf16 v[64:67], a[20:23], a[4:7], v[64:67]
s_sub_u32 s47, s47, 1
s_cbranch_scc1 .Lx21
.Lx21b:
v_mfma_f32_16x16x32_bf16 v[68:71], a[20:23], a[8:11], v[68:71]
ds_read_b128 a[52:55], v30 offset:60096
v_mfma_f32_16x16x32_bf16 v[84:87], a[24:27], a[8:11], v[84:87]
ds_read_b128 a[56:59], v30 offset:62400
v_mfma_f32_16x16x32_bf16 v[88:91], a[24:27], a[12:15], v[88:91]
buffer_load_dwordx4 v19, s[20:23], s54 offen offset:1024 lds
v_mfma_f32_16x16x32_bf16 v[72:75], a[20:23], a[12:15], v[72:75]
ds_read_b64_tr_b16 a[64:65], v25 offset:62080
s_waitcnt lgkmcnt(5)
v_mfma_f32_16x16x32_bf16 v[244:247], a[24:27], a[16:19], v[244:247]
ds_read_b64_tr_b16 a[66:67], v25 offset:62592
v_mfma_f32_16x16x32_bf16 v[104:107], a[28:31], a[12:15], v[104:107]
ds_read_b64_tr_b16 a[68:69], v25 offset:62112
v_mfma_f32_16x16x32_bf16 v[120:123], a[32:35], a[12:15], v[120:123]
buffer_load_dwordx4 v20, s[20:23], s54 offen offset:2048 lds
v_mfma_f32_16x16x32_bf16 v[116:119], a[32:35], a[8:11], v[116:119]
ds_read_b64_tr_b16 a[70:71], v25 offset:62624
s_add_u32 s54, s54, 196608
v_mfma_f32_16x16x32_bf16 v[100:103], a[28:31], a[8:11], v[100:103]
ds_read_b128 a[60:63], v31 offset:55488
v_mfma_f32_16x16x32_bf16 v[96:99], a[28:31], a[4:7], v[96:99]
s_add_u32 m0, s55, 39296
v_mfma_f32_16x16x32_bf16 v[112:115], a[32:35], a[4:7], v[112:115]
buffer_load_dwordx4 v21, s[36:39], s53 offen lds
v_mfma_f32_16x16x32_bf16 v[108:111], a[32:35], a[0:3], v[108:111]
ds_read_b64_tr_b16 a[72:73], v25 offset:63104
v_mfma_f32_16x16x32_bf16 v[92:95], a[28:31], a[0:3], v[92:95]
ds_read_b64_tr_b16 a[74:75], v25 offset:63616
v_mfma_f32_16x16x32_bf16 v[124:127], a[0:3], a[36:39], v[124:127]
ds_read_b64_tr_b16 a[76:77], v25 offset:63136
v_mfma_f32_16x16x32_bf16 v[140:143], a[0:3], a[40:43], v[140:143]
buffer_load_dwordx4 v28, s[36:39], s53 offen offset:1024 lds
v_mfma_f32_16x16x32_bf16 v[144:147], a[4:7], a[40:43], v[144:147]
ds_read_b64_tr_b16 a[78:79], v25 offset:63648
v_mfma_f32_16x16x32_bf16 v[128:131], a[4:7], a[36:39], v[128:131]
ds_read_b64_tr_b16 a[80:81], v25 offset:64128
v_mfma_f32_16x16x32_bf16 v[132:135], a[8:11], a[36:39], v[132:135]
ds_read_b64_tr_b16 a[82:83], v25 offset:64640
v_mfma_f32_16x16x32_bf16 v[148:151], a[8:11], a[40:43], v[148:151]
buffer_load_dword v29, s[36:39], s53 offen offset:2048 lds
v_mfma_f32_16x16x32_bf16 v[152:155], a[12:15], a[40:43], v[152:155]
ds_read_b64_tr_b16 a[84:85], v25 offset:64160
s_add_u32 s53, s53, 128
v_mfma_f32_16x16x32_bf16 v[136:139], a[12:15], a[36:39], v[136:139]
ds_read_b64_tr_b16 a[86:87], v25 offset:64672
v_mfma_f32_16x16x32_bf16 v[156:159], a[16:19], a[36:39], v[156:159]
v_mfma_f32_16x16x32_bf16 v[160:163], a[16:19], a[40:43], v[160:163]
s_waitcnt vmcnt(22) lgkmcnt(8)
s_barrier
s_waitcnt vmcnt(21)
v_cmp_ne_u32 vcc, v35, v37
s_nop 0
s_cbranch_vccnz .Lsp22
.Lsp22b:
v_mov_b32 v37, 0
v_mfma_f32_16x16x32_bf16 v[60:63], a[64:67], a[44:47], v[60:63]
ds_read_b128 a[0:3], v23
v_mfma_f32_16x16x32_bf16 v[76:79], a[68:71], a[44:47], v[76:79]
ds_read_b128 a[4:7], v23 offset:2304
v_mfma_f32_16x16x32_bf16 v[80:83], a[68:71], a[48:51], v[80:83]
buffer_atomic_add v38, v32, s[16:19], 0 offen
v_mfma_f32_16x16x32_bf16 v[64:67], a[64:67], a[48:51], v[64:67]
ds_read_b128 a[8:11], v23 offset:4608
v_mfma_f32_16x16x32_bf16 v[68:71], a[64:67], a[52:55], v[68:71]
ds_read_b128 a[12:15], v23 offset:6912
s_add_u32 m0, s56, 123648
v_mfma_f32_16x16x32_bf16 v[84:87], a[68:71], a[52:55], v[84:87]
buffer_load_dwordx4 v18, s[20:23], s54 offen lds
v_mfma_f32_16x16x32_bf16 v[88:91], a[68:71], a[56:59], v[88:91]
ds_read_b64_tr_b16 a[20:21], v25
v_mfma_f32_16x16x32_bf16 v[72:75], a[64:67], a[56:59], v[72:75]
ds_read_b64_tr_b16 a[22:23], v25 offset:512
s_waitcnt lgkmcnt(6)
v_mfma_f32_16x16x32_bf16 v[244:247], a[68:71], a[60:63], v[244:247]
ds_read_b64_tr_b16 a[24:25], v25 offset:32
v_mfma_f32_16x16x32_bf16 v[104:107], a[72:75], a[56:59], v[104:107]
buffer_load_dwordx4 v19, s[20:23], s54 offen offset:1024 lds
v_mfma_f32_16x16x32_bf16 v[120:123], a[76:79], a[56:59], v[120:123]
ds_read_b64_tr_b16 a[26:27], v25 offset:544
v_mfma_f32_16x16x32_bf16 v[116:119], a[76:79], a[52:55], v[116:119]
ds_read_b128 a[16:19], v24
v_mfma_f32_16x16x32_bf16 v[100:103], a[72:75], a[52:55], v[100:103]
buffer_load_dwordx4 v20, s[20:23], s54 offen offset:2048 lds
v_mfma_f32_16x16x32_bf16 v[96:99], a[72:75], a[48:51], v[96:99]
s_add_u32 s54, s54, 196608
v_mfma_f32_16x16x32_bf16 v[112:115], a[76:79], a[48:51], v[112:115]
ds_read_b64_tr_b16 a[28:29], v25 offset:1024
v_mfma_f32_16x16x32_bf16 v[108:111], a[76:79], a[44:47], v[108:111]
ds_read_b64_tr_b16 a[30:31], v25 offset:1536
s_add_u32 m0, s55, 55488
v_mfma_f32_16x16x32_bf16 v[92:95], a[72:75], a[44:47], v[92:95]
buffer_load_dwordx4 v21, s[36:39], s52 offen lds
v_mfma_f32_16x16x32_bf16 v[124:127], a[44:47], a[80:83], v[124:127]
ds_read_b64_tr_b16 a[32:33], v25 offset:1056
v_mfma_f32_16x16x32_bf16 v[140:143], a[44:47], a[84:87], v[140:143]
ds_read_b64_tr_b16 a[34:35], v25 offset:1568
v_mfma_f32_16x16x32_bf16 v[144:147], a[48:51], a[84:87], v[144:147]
buffer_load_dwordx4 v28, s[36:39], s52 offen offset:1024 lds
v_mfma_f32_16x16x32_bf16 v[128:131], a[48:51], a[80:83], v[128:131]
ds_read_b64_tr_b16 a[36:37], v25 offset:2048
v_mfma_f32_16x16x32_bf16 v[132:135], a[52:55], a[80:83], v[132:135]
ds_read_b64_tr_b16 a[38:39], v25 offset:2560
v_mfma_f32_16x16x32_bf16 v[148:151], a[52:55], a[84:87], v[148:151]
ds_read_b64_tr_b16 a[40:41], v25 offset:2080
v_mfma_f32_16x16x32_bf16 v[152:155], a[56:59], a[84:87], v[152:155]
buffer_load_dword v22, s[36:39], s52 offen offset:2048 lds
v_mfma_f32_16x16x32_bf16 v[136:139], a[56:59], a[80:83], v[136:139]
ds_read_b64_tr_b16 a[42:43], v25 offset:2592
s_add_u32 s52, s52, 128
v_mfma_f32_16x16x32_bf16 v[156:159], a[60:63], a[80:83], v[156:159]
v_mfma_f32_16x16x32_bf16 v[160:163], a[60:63], a[84:87], v[160:163]
s_waitcnt vmcnt(25) lgkmcnt(8)
s_barrier
v_mfma_f32_16x16x32_bf16 v[60:63], a[20:23], a[0:3], v[60:63]
ds_read_b128 a[44:47], v30
v_mfma_f32_16x16x32_bf16 v[76:79], a[24:27], a[0:3], v[76:79]
ds_read_b128 a[48:51], v30 offset:2304
s_add_u32 m0, s56, 136064
v_mfma_f32_16x16x32_bf16 v[80:83], a[24:27], a[4:7], v[80:83]
buffer_load_dwordx4 v18, s[20:23], s54 offen lds
v_mfma_f32_16x16x32_bf16 v[64:67], a[20:23], a[4:7], v[64:67]
s_sub_u32 s47, s47, 1
s_cbranch_scc1 .Lx23
.Lx23b:
v_mfma_f32_16x16x32_bf16 v[68:71], a[20:23], a[8:11], v[68:71]
ds_read_b128 a[52:55], v30 offset:4608
v_mfma_f32_16x16x32_bf16 v[84:87], a[24:27], a[8:11], v[84:87]
ds_read_b128 a[56:59], v30 offset:6912
v_mfma_f32_16x16x32_bf16 v[88:91], a[24:27], a[12:15], v[88:91]
buffer_load_dwordx4 v19, s[20:23], s54 offen offset:1024 lds
v_mfma_f32_16x16x32_bf16 v[72:75], a[20:23], a[12:15], v[72:75]
ds_read_b64_tr_b16 a[64:65], v25 offset:12416
s_waitcnt lgkmcnt(5)
v_mfma_f32_16x16x32_bf16 v[244:247], a[24:27], a[16:19], v[244:247]
ds_read_b64_tr_b16 a[66:67], v25 offset:12928
v_mfma_f32_16x16x32_bf16 v[104:107], a[28:31], a[12:15], v[104:107]
ds_read_b64_tr_b16 a[68:69], v25 offset:12448
v_mfma_f32_16x16x32_bf16 v[120:123], a[32:35], a[12:15], v[120:123]
buffer_load_dwordx4 v20, s[20:23], s54 offen offset:2048 lds
v_mfma_f32_16x16x32_bf16 v[116:119], a[32:35], a[8:11], v[116:119]
ds_read_b64_tr_b16 a[70:71], v25 offset:12960
s_add_u32 s54, s54, 196608
v_mfma_f32_16x16x32_bf16 v[100:103], a[28:31], a[8:11], v[100:103]
ds_read_b128 a[60:63], v31
v_mfma_f32_16x16x32_bf16 v[96:99], a[28:31], a[4:7], v[96:99]
s_add_u32 m0, s55, 57792
v_mfma_f32_16x16x32_bf16 v[112:115], a[32:35], a[4:7], v[112:115]
buffer_load_dwordx4 v21, s[36:39], s53 offen lds
v_mfma_f32_16x16x32_bf16 v[108:111], a[32:35], a[0:3], v[108:111]
ds_read_b64_tr_b16 a[72:73], v25 offset:13440
v_mfma_f32_16x16x32_bf16 v[92:95], a[28:31], a[0:3], v[92:95]
ds_read_b64_tr_b16 a[74:75], v25 offset:13952
v_mfma_f32_16x16x32_bf16 v[124:127], a[0:3], a[36:39], v[124:127]
ds_read_b64_tr_b16 a[76:77], v25 offset:13472
v_mfma_f32_16x16x32_bf16 v[140:143], a[0:3], a[40:43], v[140:143]
buffer_load_dwordx4 v28, s[36:39], s53 offen offset:1024 lds
v_mfma_f32_16x16x32_bf16 v[144:147], a[4:7], a[40:43], v[144:147]
ds_read_b64_tr_b16 a[78:79], v25 offset:13984
v_mfma_f32_16x16x32_bf16 v[128:131], a[4:7], a[36:39], v[128:131]
ds_read_b64_tr_b16 a[80:81], v25 offset:14464
v_mfma_f32_16x16x32_bf16 v[132:135], a[8:11], a[36:39], v[132:135]
ds_read_b64_tr_b16 a[82:83], v25 offset:14976
v_mfma_f32_16x16x32_bf16 v[148:151], a[8:11], a[40:43], v[148:151]
buffer_load_dword v29, s[36:39], s53 offen offset:2048 lds
v_mfma_f32_16x16x32_bf16 v[152:155], a[12:15], a[40:43], v[152:155]
ds_read_b64_tr_b16 a[84:85], v25 offset:14496
s_add_u32 s53, s53, 128
v_mfma_f32_16x16x32_bf16 v[136:139], a[12:15], a[36:39], v[136:139]
ds_read_b64_tr_b16 a[86:87], v25 offset:15008
v_mfma_f32_16x16x32_bf16 v[156:159], a[16:19], a[36:39], v[156:159]
v_mfma_f32_16x16x32_bf16 v[160:163], a[16:19], a[40:43], v[160:163]
s_waitcnt vmcnt(22) lgkmcnt(8)
s_barrier
v_mfma_f32_16x16x32_bf16 v[60:63], a[64:67], a[44:47], v[60:63]
ds_read_b128 a[0:3], v23 offset:18496
v_mfma_f32_16x16x32_bf16 v[76:79], a[68:71], a[44:47], v[76:79]
ds_read_b128 a[4:7], v23 offset:20800
s_add_u32 m0, s56, 73984
v_mfma_f32_16x16x32_bf16 v[80:83], a[68:71], a[48:51], v[80:83]
buffer_load_dwordx4 v18, s[20:23], s54 offen lds
v_mfma_f32_16x16x32_bf16 v[64:67], a[64:67], a[48:51], v[64:67]
ds_read_b128 a[8:11], v23 offset:23104
v_mfma_f32_16x16x32_bf16 v[68:71], a[64:67], a[52:55], v[68:71]
ds_read_b128 a[12:15], v23 offset:25408
v_mfma_f32_16x16x32_bf16 v[84:87], a[68:71], a[52:55], v[84:87]
ds_read_b64_tr_b16 a[20:21], v25 offset:24832
v_mfma_f32_16x16x32_bf16 v[88:91], a[68:71], a[56:59], v[88:91]
buffer_load_dwordx4 v19, s[20:23], s54 offen offset:1024 lds
v_mfma_f32_16x16x32_bf16 v[72:75], a[64:67], a[56:59], v[72:75]
ds_read_b64_tr_b16 a[22:23], v25 offset:25344
s_waitcnt lgkmcnt(6)
v_mfma_f32_16x16x32_bf16 v[244:247], a[68:71], a[60:63], v[244:247]
v_mfma_f32_16x16x32_bf16 v[104:107], a[72:75], a[56:59], v[104:107]
ds_read_b64_tr_b16 a[24:25], v25 offset:24864
v_mfma_f32_16x16x32_bf16 v[120:123], a[76:79], a[56:59], v[120:123]
buffer_load_dwordx4 v20, s[20:23], s54 offen offset:2048 lds
v_mfma_f32_16x16x32_bf16 v[116:119], a[76:79], a[52:55], v[116:119]
ds_read_b64_tr_b16 a[26:27], v25 offset:25376
s_add_u32 s54, s54, 196608
v_mfma_f32_16x16x32_bf16 v[100:103], a[72:75], a[52:55], v[100:103]
ds_read_b128 a[16:19], v24 offset:18496
v_mfma_f32_16x16x32_bf16 v[96:99], a[72:75], a[48:51], v[96:99]
ds_read_b64_tr_b16 a[28:29], v25 offset:25856
s_add_u32 m0, s55, 0
v_mfma_f32_16x16x32_bf16 v[112:115], a[76:79], a[48:51], v[112:115]
buffer_load_dwordx4 v21, s[36:39], s52 offen lds
v_mfma_f32_16x16x32_bf16 v[108:111], a[76:79], a[44:47], v[108:111]
ds_read_b64_tr_b16 a[30:31], v25 offset:26368
v_mfma_f32_16x16x32_bf16 v[92:95], a[72:75], a[44:47], v[92:95]
ds_read_b64_tr_b16 a[32:33], v25 offset:25888
v_mfma_f32_16x16x32_bf16 v[124:127], a[44:47], a[80:83], v[124:127]
v_mfma_f32_16x16x32_bf16 v[140:143], a[44:47], a[84:87], v[140:143]
buffer_load_dwordx4 v28, s[36:39], s52 offen offset:1024 lds
v_mfma_f32_16x16x32_bf16 v[144:147], a[48:51], a[84:87], v[144:147]
ds_read_b64_tr_b16 a[34:35], v25 offset:26400
v_mfma_f32_16x16x32_bf16 v[128:131], a[48:51], a[80:83], v[128:131]
ds_read_b64_tr_b16 a[36:37], v25 offset:26880
v_mfma_f32_16x16x32_bf16 v[132:135], a[52:55], a[80:83], v[132:135]
ds_read_b64_tr_b16 a[38:39], v25 offset:27392
v_mfma_f32_16x16x32_bf16 v[148:151], a[52:55], a[84:87], v[148:151]
buffer_load_dword v22, s[36:39], s52 offen offset:2048 lds
v_mfma_f32_16x16x32_bf16 v[152:155], a[56:59], a[84:87], v[152:155]
ds_read_b64_tr_b16 a[40:41], v25 offset:26912
s_add_u32 s52, s52, 128
v_mfma_f32_16x16x32_bf16 v[136:139], a[56:59], a[80:83], v[136:139]
ds_read_b64_tr_b16 a[42:43], v25 offset:27424
v_mfma_f32_16x16x32_bf16 v[156:159], a[60:63], a[80:83], v[156:159]
v_mfma_f32_16x16x32_bf16 v[160:163], a[60:63], a[84:87], v[160:163]
s_waitcnt vmcnt(22) lgkmcnt(8)
s_barrier
v_mfma_f32_16x16x32_bf16 v[60:63], a[20:23], a[0:3], v[60:63]
ds_read_b128 a[44:47], v30 offset:18496
v_mfma_f32_16x16x32_bf16 v[76:79], a[24:27], a[0:3], v[76:79]
ds_read_b128 a[48:51], v30 offset:20800
s_add_u32 m0, s56, 86400
v_mfma_f32_16x16x32_bf16 v[80:83], a[24:27], a[4:7], v[80:83]
buffer_load_dwordx4 v18, s[20:23], s54 offen lds
v_mfma_f32_16x16x32_bf16 v[64:67], a[20:23], a[4:7], v[64:67]
s_sub_u32 s47, s47, 1
s_cbranch_scc1 .Lx24
.Lx24b:
v_mfma_f32_16x16x32_bf16 v[68:71], a[20:23], a[8:11], v[68:71]
ds_read_b128 a[52:55], v30 offset:23104
v_mfma_f32_16x16x32_bf16 v[84:87], a[24:27], a[8:11], v[84:87]
ds_read_b128 a[56:59], v30 offset:25408
v_mfma_f32_16x16x32_bf16 v[88:91], a[24:27], a[12:15], v[88:91]
buffer_load_dwordx4 v19, s[20:23], s54 offen offset:1024 lds
v_mfma_f32_16x16x32_bf16 v[72:75], a[20:23], a[12:15], v[72:75]
ds_read_b64_tr_b16 a[64:65], v25 offset:37248
s_waitcnt lgkmcnt(5)
v_mfma_f32_16x16x32_bf16 v[244:247], a[24:27], a[16:19], v[244:247]
ds_read_b64_tr_b16 a[66:67], v25 offset:37760
v_mfma_f32_16x16x32_bf16 v[104:107], a[28:31], a[12:15], v[104:107]
ds_read_b64_tr_b16 a[68:69], v25 offset:37280
v_mfma_f32_16x16x32_bf16 v[120:123], a[32:35], a[12:15], v[120:123]
buffer_load_dwordx4 v20, s[20:23], s54 offen offset:2048 lds
v_mfma_f32_16x16x32_bf16 v[116:119], a[32:35], a[8:11], v[116:119]
ds_read_b64_tr_b16 a[70:71], v25 offset:37792
s_add_u32 s54, s54, 196608
v_mfma_f32_16x16x32_bf16 v[100:103], a[28:31], a[8:11], v[100:103]
ds_read_b128 a[60:63], v31 offset:18496
v_mfma_f32_16x16x32_bf16 v[96:99], a[28:31], a[4:7], v[96:99]
s_add_u32 m0, s55, 2304
v_mfma_f32_16x16x32_bf16 v[112:115], a[32:35], a[4:7], v[112:115]
buffer_load_dwordx4 v21, s[36:39], s53 offen lds
v_mfma_f32_16x16x32_bf16 v[108:111], a[32:35], a[0:3], v[108:111]
ds_read_b64_tr_b16 a[72:73], v25 offset:38272
v_mfma_f32_16x16x32_bf16 v[92:95], a[28:31], a[0:3], v[92:95]
ds_read_b64_tr_b16 a[74:75], v25 offset:38784
v_mfma_f32_16x16x32_bf16 v[124:127], a[0:3], a[36:39], v[124:127]
ds_read_b64_tr_b16 a[76:77], v25 offset:38304
v_mfma_f32_16x16x32_bf16 v[140:143], a[0:3], a[40:43], v[140:143]
buffer_load_dwordx4 v28, s[36:39], s53 offen offset:1024 lds
v_mfma_f32_16x16x32_bf16 v[144:147], a[4:7], a[40:43], v[144:147]
ds_read_b64_tr_b16 a[78:79], v25 offset:38816
v_mfma_f32_16x16x32_bf16 v[128:131], a[4:7], a[36:39], v[128:131]
ds_read_b64_tr_b16 a[80:81], v25 offset:39296
v_mfma_f32_16x16x32_bf16 v[132:135], a[8:11], a[36:39], v[132:135]
ds_read_b64_tr_b16 a[82:83], v25 offset:39808
v_mfma_f32_16x16x32_bf16 v[148:151], a[8:11], a[40:43], v[148:151]
buffer_load_dword v29, s[36:39], s53 offen offset:2048 lds
v_mfma_f32_16x16x32_bf16 v[152:155], a[12:15], a[40:43], v[152:155]
ds_read_b64_tr_b16 a[84:85], v25 offset:39328
s_add_u32 s53, s53, 128
v_mfma_f32_16x16x32_bf16 v[136:139], a[12:15], a[36:39], v[136:139]
ds_read_b64_tr_b16 a[86:87], v25 offset:39840
v_mfma_f32_16x16x32_bf16 v[156:159], a[16:19], a[36:39], v[156:159]
v_mfma_f32_16x16x32_bf16 v[160:163], a[16:19], a[40:43], v[160:163]
s_waitcnt vmcnt(21) lgkmcnt(8)
s_barrier
v_mfma_f32_16x16x32_bf16 v[60:63], a[64:67], a[44:47], v[60:63]
ds_read_b128 a[0:3], v23 offset:36992
v_mfma_f32_16x16x32_bf16 v[76:79], a[68:71], a[44:47], v[76:79]
ds_read_b128 a[4:7], v23 offset:39296
s_add_u32 m0, s56, 98816
v_mfma_f32_16x16x32_bf16 v[80:83], a[68:71], a[48:51], v[80:83]
buffer_load_dwordx4 v18, s[20:23], s54 offen lds
v_mfma_f32_16x16x32_bf16 v[64:67], a[64:67], a[48:51], v[64:67]
ds_read_b128 a[8:11], v23 offset:41600
v_mfma_f32_16x16x32_bf16 v[68:71], a[64:67], a[52:55], v[68:71]
ds_read_b128 a[12:15], v23 offset:43904
v_mfma_f32_16x16x32_bf16 v[84:87], a[68:71], a[52:55], v[84:87]
ds_read_b64_tr_b16 a[20:21], v25 offset:49664
v_mfma_f32_16x16x32_bf16 v[88:91], a[68:71], a[56:59], v[88:91]
buffer_load_dwordx4 v19, s[20:23], s54 offen offset:1024 lds
v_mfma_f32_16x16x32_bf16 v[72:75], a[64:67], a[56:59], v[72:75]
ds_read_b64_tr_b16 a[22:23], v25 offset:50176
s_waitcnt lgkmcnt(6)
v_mfma_f32_16x16x32_bf16 v[244:247], a[68:71], a[60:63], v[244:247]
v_mfma_f32_16x16x32_bf16 v[104:107], a[72:75], a[56:59], v[104:107]
ds_read_b64_tr_b16 a[24:25], v25 offset:49696
v_mfma_f32_16x16x32_bf16 v[120:123], a[76:79], a[56:59], v[120:123]
buffer_load_dwordx4 v20, s[20:23], s54 offen offset:2048 lds
v_mfma_f32_16x16x32_bf16 v[116:119], a[76:79], a[52:55], v[116:119]
ds_read_b64_tr_b16 a[26:27], v25 offset:50208
s_add_u32 s54, s54, 196608
v_mfma_f32_16x16x32_bf16 v[100:103], a[72:75], a[52:55], v[100:103]
ds_read_b128 a[16:19], v24 offset:36992
v_mfma_f32_16x16x32_bf16 v[96:99], a[72:75], a[48:51], v[96:99]
ds_read_b64_tr_b16 a[28:29], v25 offset:50688
s_add_u32 m0, s55, 18496
v_mfma_f32_16x16x32_bf16 v[112:115], a[76:79], a[48:51], v[112:115]
buffer_load_dwordx4 v21, s[36:39], s52 offen lds
v_mfma_f32_16x16x32_bf16 v[108:111], a[76:79], a[44:47], v[108:111]
ds_read_b64_tr_b16 a[30:31], v25 offset:51200
v_mfma_f32_16x16x32_bf16 v[92:95], a[72:75], a[44:47], v[92:95]
ds_read_b64_tr_b16 a[32:33], v25 offset:50720
v_mfma_f32_16x16x32_bf16 v[124:127], a[44:47], a[80:83], v[124:127]
v_mfma_f32_16x16x32_bf16 v[140:143], a[44:47], a[84:87], v[140:143]
buffer_load_dwordx4 v28, s[36:39], s52 offen offset:1024 lds
v_mfma_f32_16x16x32_bf16 v[144:147], a[48:51], a[84:87], v[144:147]
ds_read_b64_tr_b16 a[34:35], v25 offset:51232
v_mfma_f32_16x16x32_bf16 v[128:131], a[48:51], a[80:83], v[128:131]
ds_read_b64_tr_b16 a[36:37], v25 offset:51712
v_mfma_f32_16x16x32_bf16 v[132:135], a[52:55], a[80:83], v[132:135]
ds_read_b64_tr_b16 a[38:39], v25 offset:52224
v_mfma_f32_16x16x32_bf16 v[148:151], a[52:55], a[84:87], v[148:151]
buffer_load_dword v22, s[36:39], s52 offen offset:2048 lds
v_mfma_f32_16x16x32_bf16 v[152:155], a[56:59], a[84:87], v[152:155]
ds_read_b64_tr_b16 a[40:41], v25 offset:51744
s_add_u32 s52, s52, 128
v_mfma_f32_16x16x32_bf16 v[136:139], a[56:59], a[80:83], v[136:139]
ds_read_b64_tr_b16 a[42:43], v25 offset:52256
v_mfma_f32_16x16x32_bf16 v[156:159], a[60:63], a[80:83], v[156:159]
v_mfma_f32_16x16x32_bf16 v[160:163], a[60:63], a[84:87], v[160:163]
s_waitcnt vmcnt(21) lgkmcnt(8)
s_barrier
v_mfma_f32_16x16x32_bf16 v[60:63], a[20:23], a[0:3], v[60:63]
ds_read_b128 a[44:47], v30 offset:36992
v_mfma_f32_16x16x32_bf16 v[76:79], a[24:27], a[0:3], v[76:79]
ds_read_b128 a[48:51], v30 offset:39296
s_add_u32 m0, s56, 111232
v_mfma_f32_16x16x32_bf16 v[80:83], a[24:27], a[4:7], v[80:83]
buffer_load_dwordx4 v18, s[20:23], s54 offen lds
v_mfma_f32_16x16x32_bf16 v[64:67], a[20:23], a[4:7], v[64:67]
s_sub_u32 s47, s47, 1
s_cbranch_scc1 .Lx25
.Lx25b:
v_mfma_f32_16x16x32_bf16 v[68:71], a[20:23], a[8:11], v[68:71]
ds_read_b128 a[52:55], v30 offset:41600
v_mfma_f32_16x16x32_bf16 v[84:87], a[24:27], a[8:11], v[84:87]
buffer_load_dwordx4 v19, s[20:23], s54 offen offset:1024 lds
v_mfma_f32_16x16x32_bf16 v[88:91], a[24:27], a[12:15], v[88:91]
ds_read_b128 a[56:59], v30 offset:43904
v_mfma_f32_16x16x32_bf16 v[72:75], a[20:23], a[12:15], v[72:75]
ds_read_b64_tr_b16 a[64:65], v25 offset:62080
s_waitcnt lgkmcnt(5)
v_mfma_f32_16x16x32_bf16 v[244:247], a[24:27], a[16:19], v[244:247]
ds_read_b64_tr_b16 a[66:67], v25 offset:62592
v_mfma_f32_16x16x32_bf16 v[104:107], a[28:31], a[12:15], v[104:107]
buffer_load_dwordx4 v20, s[20:23], s54 offen offset:2048 lds
v_mfma_f32_16x16x32_bf16 v[120:123], a[32:35], a[12:15], v[120:123]
ds_read_b64_tr_b16 a[68:69], v25 offset:62112
s_add_u32 s54, s54, 196608
v_mfma_f32_16x16x32_bf16 v[116:119], a[32:35], a[8:11], v[116:119]
ds_read_b64_tr_b16 a[70:71], v25 offset:62624
s_add_u32 m0, s55, 20800
v_mfma_f32_16x16x32_bf16 v[100:103], a[28:31], a[8:11], v[100:103]
buffer_load_dwordx4 v21, s[36:39], s53 offen lds
v_mfma_f32_16x16x32_bf16 v[96:99], a[28:31], a[4:7], v[96:99]
ds_read_b128 a[60:63], v31 offset:36992
v_mfma_f32_16x16x32_bf16 v[112:115], a[32:35], a[4:7], v[112:115]
ds_read_b64_tr_b16 a[72:73], v25 offset:63104
v_mfma_f32_16x16x32_bf16 v[108:111], a[32:35], a[0:3], v[108:111]
ds_read_b64_tr_b16 a[74:75], v25 offset:63616
v_mfma_f32_16x16x32_bf16 v[92:95], a[28:31], a[0:3], v[92:95]
buffer_load_dwordx4 v28, s[36:39], s53 offen offset:1024 lds
v_mfma_f32_16x16x32_bf16 v[124:127], a[0:3], a[36:39], v[124:127]
ds_read_b64_tr_b16 a[76:77], v25 offset:63136
v_mfma_f32_16x16x32_bf16 v[140:143], a[0:3], a[40:43], v[140:143]
ds_read_b64_tr_b16 a[78:79], v25 offset:63648
v_mfma_f32_16x16x32_bf16 v[144:147], a[4:7], a[40:43], v[144:147]
buffer_load_dword v29, s[36:39], s53 offen offset:2048 lds
v_mfma_f32_16x16x32_bf16 v[128:131], a[4:7], a[36:39], v[128:131]
ds_read_b64_tr_b16 a[80:81], v25 offset:64128
s_add_u32 s53, s53, 128
v_mfma_f32_16x16x32_bf16 v[132:135], a[8:11], a[36:39], v[132:135]
ds_read_b64_tr_b16 a[82:83], v25 offset:64640
v_mfma_f32_16x16x32_bf16 v[148:151], a[8:11], a[40:43], v[148:151]
ds_read_b64_tr_b16 a[84:85], v25 offset:64160
v_mfma_f32_16x16x32_bf16 v[152:155], a[12:15], a[40:43], v[152:155]
buffer_atomic_add v37, v33, s[16:19], 0 offen sc0
v_mfma_f32_16x16x32_bf16 v[136:139], a[12:15], a[36:39], v[136:139]
ds_read_b64_tr_b16 a[86:87], v25 offset:64672
v_mfma_f32_16x16x32_bf16 v[156:159], a[16:19], a[36:39], v[156:159]
v_mfma_f32_16x16x32_bf16 v[160:163], a[16:19], a[40:43], v[160:163]
s_waitcnt vmcnt(22) lgkmcnt(8)
s_barrier
v_mfma_f32_16x16x32_bf16 v[60:63], a[64:67], a[44:47], v[60:63]
ds_read_b128 a[0:3], v23 offset:55488
v_mfma_f32_16x16x32_bf16 v[76:79], a[68:71], a[44:47], v[76:79]
ds_read_b128 a[4:7], v23 offset:57792
s_add_u32 m0, s56, 123648
v_mfma_f32_16x16x32_bf16 v[80:83], a[68:71], a[48:51], v[80:83]
buffer_load_dwordx4 v18, s[20:23], s54 offen lds
v_mfma_f32_16x16x32_bf16 v[64:67], a[64:67], a[48:51], v[64:67]
ds_read_b128 a[8:11], v23 offset:60096
v_mfma_f32_16x16x32_bf16 v[68:71], a[64:67], a[52:55], v[68:71]
ds_read_b128 a[12:15], v23 offset:62400
v_mfma_f32_16x16x32_bf16 v[84:87], a[68:71], a[52:55], v[84:87]
ds_read_b64_tr_b16 a[20:21], v25
v_mfma_f32_16x16x32_bf16 v[88:91], a[68:71], a[56:59], v[88:91]
buffer_load_dwordx4 v19, s[20:23], s54 offen offset:1024 lds
v_mfma_f32_16x16x32_bf16 v[72:75], a[64:67], a[56:59], v[72:75]
ds_read_b64_tr_b16 a[22:23], v25 offset:512
s_waitcnt lgkmcnt(6)
v_mfma_f32_16x16x32_bf16 v[244:247], a[68:71], a[60:63], v[244:247]
v_mfma_f32_16x16x32_bf16 v[104:107], a[72:75], a[56:59], v[104:107]
ds_read_b64_tr_b16 a[24:25], v25 offset:32
v_mfma_f32_16x16x32_bf16 v[120:123], a[76:79], a[56:59], v[120:123]
buffer_load_dwordx4 v20, s[20:23], s54 offen offset:2048 lds
v_mfma_f32_16x16x32_bf16 v[116:119], a[76:79], a[52:55], v[116:119]
ds_read_b64_tr_b16 a[26:27], v25 offset:544
s_add_u32 s54, s54, 196608
v_mfma_f32_16x16x32_bf16 v[100:103], a[72:75], a[52:55], v[100:103]
ds_read_b128 a[16:19], v24 offset:55488
v_mfma_f32_16x16x32_bf16 v[96:99], a[72:75], a[48:51], v[96:99]
ds_read_b64_tr_b16 a[28:29], v25 offset:1024
s_add_u32 m0, s55, 36992
v_mfma_f32_16x16x32_bf16 v[112:115], a[76:79], a[48:51], v[112:115]
buffer_load_dwordx4 v21, s[36:39], s52 offen lds
v_mfma_f32_16x16x32_bf16 v[108:111], a[76:79], a[44:47], v[108:111]
ds_read_b64_tr_b16 a[30:31], v25 offset:1536
v_mfma_f32_16x16x32_bf16 v[92:95], a[72:75], a[44:47], v[92:95]
ds_read_b64_tr_b16 a[32:33], v25 offset:1056
v_mfma_f32_16x16x32_bf16 v[124:127], a[44:47], a[80:83], v[124:127]
v_mfma_f32_16x16x32_bf16 v[140:143], a[44:47], a[84:87], v[140:143]
buffer_load_dwordx4 v28, s[36:39], s52 offen offset:1024 lds
v_mfma_f32_16x16x32_bf16 v[144:147], a[48:51], a[84:87], v[144:147]
ds_read_b64_tr_b16 a[34:35], v25 offset:1568
v_mfma_f32_16x16x32_bf16 v[128:131], a[48:51], a[80:83], v[128:131]
ds_read_b64_tr_b16 a[36:37], v25 offset:2048
v_mfma_f32_16x16x32_bf16 v[132:135], a[52:55], a[80:83], v[132:135]
ds_read_b64_tr_b16 a[38:39], v25 offset:2560
v_mfma_f32_16x16x32_bf16 v[148:151], a[52:55], a[84:87], v[148:151]
buffer_load_dword v22, s[36:39], s52 offen offset:2048 lds
v_mfma_f32_16x16x32_bf16 v[152:155], a[56:59], a[84:87], v[152:155]
ds_read_b64_tr_b16 a[40:41], v25 offset:2080
s_add_u32 s52, s52, 128
v_mfma_f32_16x16x32_bf16 v[136:139], a[56:59], a[80:83], v[136:139]
ds_read_b64_tr_b16 a[42:43], v25 offset:2592
v_mfma_f32_16x16x32_bf16 v[156:159], a[60:63], a[80:83], v[156:159]
v_mfma_f32_16x16x32_bf16 v[160:163], a[60:63], a[84:87], v[160:163]
s_waitcnt vmcnt(22) lgkmcnt(8)
s_barrier
v_mfma_f32_16x16x32_bf16 v[60:63], a[20:23], a[0:3], v[60:63]
ds_read_b128 a[44:47], v30 offset:55488
v_mfma_f32_16x16x32_bf16 v[76:79], a[24:27], a[0:3], v[76:79]
ds_read_b128 a[48:51], v30 offset:57792
s_add_u32 m0, s56, 136064
v_mfma_f32_16x16x32_bf16 v[80:83], a[24:27], a[4:7], v[80:83]
buffer_load_dwordx4 v18, s[20:23], s54 offen lds
v_mfma_f32_16x16x32_bf16 v[64:67], a[20:23], a[4:7], v[64:67]
s_sub_u32 s47, s47, 1
s_cbranch_scc1 .Lx26
.Lx26b:
v_mfma_f32_16x16x32_bf16 v[68:71], a[20:23], a[8:11], v[68:71]
ds_read_b128 a[52:55], v30 offset:60096
v_mfma_f32_16x16x32_bf16 v[84:87], a[24:27], a[8:11], v[84:87]
ds_read_b128 a[56:59], v30 offset:62400
v_mfma_f32_16x16x32_bf16 v[88:91], a[24:27], a[12:15], v[88:91]
buffer_load_dwordx4 v19, s[20:23], s54 offen offset:1024 lds
v_mfma_f32_16x16x32_bf16 v[72:75], a[20:23], a[12:15], v[72:75]
ds_read_b64_tr_b16 a[64:65], v25 offset:12416
s_waitcnt lgkmcnt(5)
v_mfma_f32_16x16x32_bf16 v[244:247], a[24:27], a[16:19], v[244:247]
ds_read_b64_tr_b16 a[66:67], v25 offset:12928
v_mfma_f32_16x16x32_bf16 v[104:107], a[28:31], a[12:15], v[104:107]
ds_read_b64_tr_b16 a[68:69], v25 offset:12448
v_mfma_f32_16x16x32_bf16 v[120:123], a[32:35], a[12:15], v[120:123]
buffer_load_dwordx4 v20, s[20:23], s54 offen offset:2048 lds
v_mfma_f32_16x16x32_bf16 v[116:119], a[32:35], a[8:11], v[116:119]
ds_read_b64_tr_b16 a[70:71], v25 offset:12960
s_add_u32 s54, s54, 196608
v_mfma_f32_16x16x32_bf16 v[100:103], a[28:31], a[8:11], v[100:103]
ds_read_b128 a[60:63], v31 offset:55488
v_mfma_f32_16x16x32_bf16 v[96:99], a[28:31], a[4:7], v[96:99]
s_add_u32 m0, s55, 39296
v_mfma_f32_16x16x32_bf16 v[112:115], a[32:35], a[4:7], v[112:115]
buffer_load_dwordx4 v21, s[36:39], s53 offen lds
v_mfma_f32_16x16x32_bf16 v[108:111], a[32:35], a[0:3], v[108:111]
ds_read_b64_tr_b16 a[72:73], v25 offset:13440
v_mfma_f32_16x16x32_bf16 v[92:95], a[28:31], a[0:3], v[92:95]
ds_read_b64_tr_b16 a[74:75], v25 offset:13952
v_mfma_f32_16x16x32_bf16 v[124:127], a[0:3], a[36:39], v[124:127]
ds_read_b64_tr_b16 a[76:77], v25 offset:13472
v_mfma_f32_16x16x32_bf16 v[140:143], a[0:3], a[40:43], v[140:143]
buffer_load_dwordx4 v28, s[36:39], s53 offen offset:1024 lds
v_mfma_f32_16x16x32_bf16 v[144:147], a[4:7], a[40:43], v[144:147]
ds_read_b64_tr_b16 a[78:79], v25 offset:13984
v_mfma_f32_16x16x32_bf16 v[128:131], a[4:7], a[36:39], v[128:131]
ds_read_b64_tr_b16 a[80:81], v25 offset:14464
v_mfma_f32_16x16x32_bf16 v[132:135], a[8:11], a[36:39], v[132:135]
ds_read_b64_tr_b16 a[82:83], v25 offset:14976
v_mfma_f32_16x16x32_bf16 v[148:151], a[8:11], a[40:43], v[148:151]
buffer_load_dword v29, s[36:39], s53 offen offset:2048 lds
v_mfma_f32_16x16x32_bf16 v[152:155], a[12:15], a[40:43], v[152:155]
ds_read_b64_tr_b16 a[84:85], v25 offset:14496
s_add_u32 s53, s53, 128
v_mfma_f32_16x16x32_bf16 v[136:139], a[12:15], a[36:39], v[136:139]
ds_read_b64_tr_b16 a[86:87], v25 offset:15008
v_mfma_f32_16x16x32_bf16 v[156:159], a[16:19], a[36:39], v[156:159]
v_mfma_f32_16x16x32_bf16 v[160:163], a[16:19], a[40:43], v[160:163]
s_waitcnt vmcnt(22) lgkmcnt(8)
s_barrier
v_mfma_f32_16x16x32_bf16 v[60:63], a[64:67], a[44:47], v[60:63]
ds_read_b128 a[0:3], v23
v_mfma_f32_16x16x32_bf16 v[76:79], a[68:71], a[44:47], v[76:79]
ds_read_b128 a[4:7], v23 offset:2304
s_add_u32 m0, s56, 73984
v_mfma_f32_16x16x32_bf16 v[80:83], a[68:71], a[48:51], v[80:83]
buffer_load_dwordx4 v18, s[20:23], s54 offen lds
v_mfma_f32_16x16x32_bf16 v[64:67], a[64:67], a[48:51], v[64:67]
ds_read_b128 a[8:11], v23 offset:4608
v_mfma_f32_16x16x32_bf16 v[68:71], a[64:67], a[52:55], v[68:71]
ds_read_b128 a[12:15], v23 offset:6912
v_mfma_f32_16x16x32_bf16 v[84:87], a[68:71], a[52:55], v[84:87]
ds_read_b64_tr_b16 a[20:21], v25 offset:24832
v_mfma_f32_16x16x32_bf16 v[88:91], a[68:71], a[56:59], v[88:91]
buffer_load_dwordx4 v19, s[20:23], s54 offen offset:1024 lds
v_mfma_f32_16x16x32_bf16 v[72:75], a[64:67], a[56:59], v[72:75]
ds_read_b64_tr_b16 a[22:23], v25 offset:25344
s_waitcnt lgkmcnt(6)
v_mfma_f32_16x16x32_bf16 v[244:247], a[68:71], a[60:63], v[244:247]
v_mfma_f32_16x16x32_bf16 v[104:107], a[72:75], a[56:59], v[104:107]
ds_read_b64_tr_b16 a[24:25], v25 offset:24864
v_mfma_f32_16x16x32_bf16 v[120:123], a[76:79], a[56:59], v[120:123]
buffer_load_dwordx4 v20, s[20:23], s54 offen offset:2048 lds
v_mfma_f32_16x16x32_bf16 v[116:119], a[76:79], a[52:55], v[116:119]
ds_read_b64_tr_b16 a[26:27], v25 offset:25376
s_add_u32 s54, s54, 196608
v_mfma_f32_16x16x32_bf16 v[100:103], a[72:75], a[52:55], v[100:103]
ds_read_b128 a[16:19], v24
v_mfma_f32_16x16x32_bf16 v[96:99], a[72:75], a[48:51], v[96:99]
ds_read_b64_tr_b16 a[28:29], v25 offset:25856
s_add_u32 m0, s55, 55488
v_mfma_f32_16x16x32_bf16 v[112:115], a[76:79], a[48:51], v[112:115]
buffer_load_dwordx4 v21, s[36:39], s52 offen lds
v_mfma_f32_16x16x32_bf16 v[108:111], a[76:79], a[44:47], v[108:111]
ds_read_b64_tr_b16 a[30:31], v25 offset:26368
v_mfma_f32_16x16x32_bf16 v[92:95], a[72:75], a[44:47], v[92:95]
ds_read_b64_tr_b16 a[32:33], v25 offset:25888
v_mfma_f32_16x16x32_bf16 v[124:127], a[44:47], a[80:83], v[124:127]
v_mfma_f32_16x16x32_bf16 v[140:143], a[44:47], a[84:87], v[140:143]
buffer_load_dwordx4 v28, s[36:39], s52 offen offset:1024 lds
v_mfma_f32_16x16x32_bf16 v[144:147], a[48:51], a[84:87], v[144:147]
ds_read_b64_tr_b16 a[34:35], v25 offset:26400
v_mfma_f32_16x16x32_bf16 v[128:131], a[48:51], a[80:83], v[128:131]
ds_read_b64_tr_b16 a[36:37], v25 offset:26880
v_mfma_f32_16x16x32_bf16 v[132:135], a[52:55], a[80:83], v[132:135]
ds_read_b64_tr_b16 a[38:39], v25 offset:27392
v_mfma_f32_16x16x32_bf16 v[148:151], a[52:55], a[84:87], v[148:151]
buffer_load_dword v22, s[36:39], s52 offen offset:2048 lds
v_mfma_f32_16x16x32_bf16 v[152:155], a[56:59], a[84:87], v[152:155]
ds_read_b64_tr_b16 a[40:41], v25 offset:26912
s_add_u32 s52, s52, 128
v_mfma_f32_16x16x32_bf16 v[136:139], a[56:59], a[80:83], v[136:139]
ds_read_b64_tr_b16 a[42:43], v25 offset:27424
v_mfma_f32_16x16x32_bf16 v[156:159], a[60:63], a[80:83], v[156:159]
v_mfma_f32_16x16x32_bf16 v[160:163], a[60:63], a[84:87], v[160:163]
s_waitcnt vmcnt(22) lgkmcnt(8)
s_barrier
v_mfma_f32_16x16x32_bf16 v[60:63], a[20:23], a[0:3], v[60:63]
ds_read_b128 a[44:47], v30
v_mfma_f32_16x16x32_bf16 v[76:79], a[24:27], a[0:3], v[76:79]
ds_read_b128 a[48:51], v30 offset:2304
s_add_u32 m0, s56, 86400
v_mfma_f32_16x16x32_bf16 v[80:83], a[24:27], a[4:7], v[80:83]
buffer_load_dwordx4 v18, s[20:23], s54 offen lds
v_mfma_f32_16x16x32_bf16 v[64:67], a[20:23], a[4:7], v[64:67]
s_sub_u32 s47, s47, 1
s_cbranch_scc1 .Lx27
.Lx27b:
v_mfma_f32_16x16x32_bf16 v[68:71], a[20:23], a[8:11], v[68:71]
ds_read_b128 a[52:55], v30 offset:4608
v_mfma_f32_16x16x32_bf16 v[84:87], a[24:27], a[8:11], v[84:87]
ds_read_b128 a[56:59], v30 offset:6912
v_mfma_f32_16x16x32_bf16 v[88:91], a[24:27], a[12:15], v[88:91]
buffer_load_dwordx4 v19, s[20:23], s54 offen offset:1024 lds
v_mfma_f32_16x16x32_bf16 v[72:75], a[20:23], a[12:15], v[72:75]
ds_read_b64_tr_b16 a[64:65], v25 offset:37248
s_waitcnt lgkmcnt(5)
v_mfma_f32_16x16x32_bf16 v[244:247], a[24:27], a[16:19], v[244:247]
ds_read_b64_tr_b16 a[66:67], v25 offset:37760
v_mfma_f32_16x16x32_bf16 v[104:107], a[28:31], a[12:15], v[104:107]
ds_read_b64_tr_b16 a[68:69], v25 offset:37280
v_mfma_f32_16x16x32_bf16 v[120:123], a[32:35], a[12:15], v[120:123]
buffer_load_dwordx4 v20, s[20:23], s54 offen offset:2048 lds
v_mfma_f32_16x16x32_bf16 v[116:119], a[32:35], a[8:11], v[116:119]
ds_read_b64_tr_b16 a[70:71], v25 offset:37792
s_add_u32 s54, s54, 196608
v_mfma_f32_16x16x32_bf16 v[100:103], a[28:31], a[8:11], v[100:103]
ds_read_b128 a[60:63], v31
v_mfma_f32_16x16x32_bf16 v[96:99], a[28:31], a[4:7], v[96:99]
s_add_u32 m0, s55, 57792
v_mfma_f32_16x16x32_bf16 v[112:115], a[32:35], a[4:7], v[112:115]
buffer_load_dwordx4 v21, s[36:39], s53 offen lds
v_mfma_f32_16x16x32_bf16 v[108:111], a[32:35], a[0:3], v[108:111]
ds_read_b64_tr_b16 a[72:73], v25 offset:38272
v_mfma_f32_16x16x32_bf16 v[92:95], a[28:31], a[0:3], v[92:95]
ds_read_b64_tr_b16 a[74:75], v25 offset:38784
v_mfma_f32_16x16x32_bf16 v[124:127], a[0:3], a[36:39], v[124:127]
ds_read_b64_tr_b16 a[76:77], v25 offset:38304
v_mfma_f32_16x16x32_bf16 v[140:143], a[0:3], a[40:43], v[140:143]
buffer_load_dwordx4 v28, s[36:39], s53 offen offset:1024 lds
v_mfma_f32_16x16x32_bf16 v[144:147], a[4:7], a[40:43], v[144:147]
ds_read_b64_tr_b16 a[78:79], v25 offset:38816
v_mfma_f32_16x16x32_bf16 v[128:131], a[4:7], a[36:39], v[128:131]
ds_read_b64_tr_b16 a[80:81], v25 offset:39296
v_mfma_f32_16x16x32_bf16 v[132:135], a[8:11], a[36:39], v[132:135]
ds_read_b64_tr_b16 a[82:83], v25 offset:39808
v_mfma_f32_16x16x32_bf16 v[148:151], a[8:11], a[40:43], v[148:151]
buffer_load_dword v29, s[36:39], s53 offen offset:2048 lds
v_mfma_f32_16x16x32_bf16 v[152:155], a[12:15], a[40:43], v[152:155]
ds_read_b64_tr_b16 a[84:85], v25 offset:39328
s_add_u32 s53, s53, 128
v_mfma_f32_16x16x32_bf16 v[136:139], a[12:15], a[36:39], v[136:139]
ds_read_b64_tr_b16 a[86:87], v25 offset:39840
v_mfma_f32_16x16x32_bf16 v[156:159], a[16:19], a[36:39], v[156:159]
v_mfma_f32_16x16x32_bf16 v[160:163], a[16:19], a[40:43], v[160:163]
s_waitcnt vmcnt(24)
v_cmp_ne_u32 vcc, v36, v37
s_nop 0
s_cbranch_vccnz .Lsp28
.Lsp28b:
s_waitcnt vmcnt(21) lgkmcnt(8)
s_barrier
v_mfma_f32_16x16x32_bf16 v[60:63], a[64:67], a[44:47], v[60:63]
ds_read_b128 a[0:3], v23 offset:18496
v_mfma_f32_16x16x32_bf16 v[76:79], a[68:71], a[44:47], v[76:79]
ds_read_b128 a[4:7], v23 offset:20800
s_add_u32 m0, s56, 98816
v_mfma_f32_16x16x32_bf16 v[80:83], a[68:71], a[48:51], v[80:83]
buffer_load_dwordx4 v18, s[20:23], s54 offen lds
v_mfma_f32_16x16x32_bf16 v[64:67], a[64:67], a[48:51], v[64:67]
ds_read_b128 a[8:11], v23 offset:23104
v_mfma_f32_16x16x32_bf16 v[68:71], a[64:67], a[52:55], v[68:71]
ds_read_b128 a[12:15], v23 offset:25408
v_mfma_f32_16x16x32_bf16 v[84:87], a[68:71], a[52:55], v[84:87]
buffer_load_dwordx4 v19, s[20:23], s54 offen offset:1024 lds
v_mfma_f32_16x16x32_bf16 v[88:91], a[68:71], a[56:59], v[88:91]
ds_read_b64_tr_b16 a[20:21], v25 offset:49664
v_mfma_f32_16x16x32_bf16 v[72:75], a[64:67], a[56:59], v[72:75]
ds_read_b64_tr_b16 a[22:23], v25 offset:50176
s_waitcnt lgkmcnt(6)
v_mfma_f32_16x16x32_bf16 v[244:247], a[68:71], a[60:63], v[244:247]
ds_read_b64_tr_b16 a[24:25], v25 offset:49696
v_mfma_f32_16x16x32_bf16 v[104:107], a[72:75], a[56:59], v[104:107]
buffer_load_dwordx4 v20, s[20:23], s54 offen offset:2048 lds
v_mfma_f32_16x16x32_bf16 v[120:123], a[76:79], a[56:59], v[120:123]
ds_read_b64_tr_b16 a[26:27], v25 offset:50208
s_add_u32 s54, s54, 196608
v_mfma_f32_16x16x32_bf16 v[116:119], a[76:79], a[52:55], v[116:119]
ds_read_b128 a[16:19], v24 offset:18496
s_add_u32 m0, s55, 0
v_mfma_f32_16x16x32_bf16 v[100:103], a[72:75], a[52:55], v[100:103]
buffer_load_dwordx4 v21, s[36:39], s52 offen lds
v_mfma_f32_16x16x32_bf16 v[96:99], a[72:75], a[48:51], v[96:99]
v_mfma_f32_16x16x32_bf16 v[112:115], a[76:79], a[48:51], v[112:115]
ds_read_b64_tr_b16 a[28:29], v25 offset:50688
v_mfma_f32_16x16x32_bf16 v[108:111], a[76:79], a[44:47], v[108:111]
ds_read_b64_tr_b16 a[30:31], v25 offset:51200
v_mfma_f32_16x16x32_bf16 v[92:95], a[72:75], a[44:47], v[92:95]
buffer_load_dwordx4 v28, s[36:39], s52 offen offset:1024 lds
v_mfma_f32_16x16x32_bf16 v[124:127], a[44:47], a[80:83], v[124:127]
ds_read_b64_tr_b16 a[32:33], v25 offset:50720
v_mfma_f32_16x16x32_bf16 v[140:143], a[44:47], a[84:87], v[140:143]
ds_read_b64_tr_b16 a[34:35], v25 offset:51232
v_mfma_f32_16x16x32_bf16 v[144:147], a[48:51], a[84:87], v[144:147]
buffer_load_dword v22, s[36:39], s52 offen offset:2048 lds
v_mfma_f32_16x16x32_bf16 v[128:131], a[48:51], a[80:83], v[128:131]
ds_read_b64_tr_b16 a[36:37], v25 offset:51712
s_add_u32 s52, s52, 128
v_mfma_f32_16x16x32_bf16 v[132:135], a[52:55], a[80:83], v[132:135]
ds_read_b64_tr_b16 a[38:39], v25 offset:52224
v_mfma_f32_16x16x32_bf16 v[148:151], a[52:55], a[84:87], v[148:151]
ds_read_b64_tr_b16 a[40:41], v25 offset:51744
v_mfma_f32_16x16x32_bf16 v[152:155], a[56:59], a[84:87], v[152:155]
buffer_load_dwordx4 v[164:167], v26, s[16:19], s75 offen sc1
v_mfma_f32_16x16x32_bf16 v[136:139], a[56:59], a[80:83], v[136:139]
ds_read_b64_tr_b16 a[42:43], v25 offset:52256
v_mfma_f32_16x16x32_bf16 v[156:159], a[60:63], a[80:83], v[156:159]
v_mfma_f32_16x16x32_bf16 v[160:163], a[60:63], a[84:87], v[160:163]
s_waitcnt vmcnt(22) lgkmcnt(8)
s_barrier
v_mfma_f32_16x16x32_bf16 v[60:63], a[20:23], a[0:3], v[60:63]
ds_read_b128 a[44:47], v30 offset:18496
v_mfma_f32_16x16x32_bf16 v[76:79], a[24:27], a[0:3], v[76:79]
ds_read_b128 a[48:51], v30 offset:20800
s_add_u32 m0, s56, 111232
v_mfma_f32_16x16x32_bf16 v[80:83], a[24:27], a[4:7], v[80:83]
buffer_load_dwordx4 v18, s[20:23], s54 offen lds
v_mfma_f32_16x16x32_bf16 v[64:67], a[20:23], a[4:7], v[64:67]
s_sub_u32 s47, s47, 1
s_cbranch_scc1 .Lx29
.Lx29b:
v_mfma_f32_16x16x32_bf16 v[68:71], a[20:23], a[8:11], v[68:71]
ds_read_b128 a[52:55], v30 offset:23104
v_mfma_f32_16x16x32_bf16 v[84:87], a[24:27], a[8:11], v[84:87]
buffer_load_dwordx4 v19, s[20:23], s54 offen offset:1024 lds
v_mfma_f32_16x16x32_bf16 v[88:91], a[24:27], a[12:15], v[88:91]
ds_read_b128 a[56:59], v30 offset:25408
v_mfma_f32_16x16x32_bf16 v[72:75], a[20:23], a[12:15], v[72:75]
ds_read_b64_tr_b16 a[64:65], v25 offset:62080
s_waitcnt lgkmcnt(5)
v_mfma_f32_16x16x32_bf16 v[244:247], a[24:27], a[16:19], v[244:247]
ds_read_b64_tr_b16 a[66:67], v25 offset:62592
v_mfma_f32_16x16x32_bf16 v[104:107], a[28:31], a[12:15], v[104:107]
buffer_load_dwordx4 v20, s[20:23], s54 offen offset:2048 lds
v_mfma_f32_16x16x32_bf16 v[120:123], a[32:35], a[12:15], v[120:123]
ds_read_b64_tr_b16 a[68:69], v25 offset:62112
s_add_u32 s54, s54, 196608
v_mfma_f32_16x16x32_bf16 v[116:119], a[32:35], a[8:11], v[116:119]
ds_read_b64_tr_b16 a[70:71], v25 offset:62624
s_add_u32 m0, s55, 2304
v_mfma_f32_16x16x32_bf16 v[100:103], a[28:31], a[8:11], v[100:103]
buffer_load_dwordx4 v21, s[36:39], s53 offen lds
v_mfma_f32_16x16x32_bf16 v[96:99], a[28:31], a[4:7], v[96:99]
ds_read_b128 a[60:63], v31 offset:18496
v_mfma_f32_16x16x32_bf16 v[112:115], a[32:35], a[4:7], v[112:115]
ds_read_b64_tr_b16 a[72:73], v25 offset:63104
v_mfma_f32_16x16x32_bf16 v[108:111], a[32:35], a[0:3], v[108:111]
ds_read_b64_tr_b16 a[74:75], v25 offset:63616
v_mfma_f32_16x16x32_bf16 v[92:95], a[28:31], a[0:3], v[92:95]
buffer_load_dwordx4 v28, s[36:39], s53 offen offset:1024 lds
v_mfma_f32_16x16x32_bf16 v[124:127], a[0:3], a[36:39], v[124:127]
ds_read_b64_tr_b16 a[76:77], v25 offset:63136
v_mfma_f32_16x16x32_bf16 v[140:143], a[0:3], a[40:43], v[140:143]
ds_read_b64_tr_b16 a[78:79], v25 offset:63648
v_mfma_f32_16x16x32_bf16 v[144:147], a[4:7], a[40:43], v[144:147]
buffer_load_dword v29, s[36:39], s53 offen offset:2048 lds
v_mfma_f32_16x16x32_bf16 v[128:131], a[4:7], a[36:39], v[128:131]
ds_read_b64_tr_b16 a[80:81], v25 offset:64128
s_add_u32 s53, s53, 128
v_mfma_f32_16x16x32_bf16 v[132:135], a[8:11], a[36:39], v[132:135]
ds_read_b64_tr_b16 a[82:83], v25 offset:64640
v_mfma_f32_16x16x32_bf16 v[148:151], a[8:11], a[40:43], v[148:151]
ds_read_b64_tr_b16 a[84:85], v25 offset:64160
v_mfma_f32_16x16x32_bf16 v[152:155], a[12:15], a[40:43], v[152:155]
buffer_load_dwordx4 v[168:171], v26, s[16:19], s75 offen offset:1024 sc1
v_mfma_f32_16x16x32_bf16 v[136:139], a[12:15], a[36:39], v[136:139]
ds_read_b64_tr_b16 a[86:87], v25 offset:64672
v_mfma_f32_16x16x32_bf16 v[156:159], a[16:19], a[36:39], v[156:159]
v_mfma_f32_16x16x32_bf16 v[160:163], a[16:19], a[40:43], v[160:163]
s_waitcnt vmcnt(23) lgkmcnt(8)
s_barrier
v_mfma_f32_16x16x32_bf16 v[60:63], a[64:67], a[44:47], v[60:63]
ds_read_b128 a[0:3], v23 offset:36992
v_mfma_f32_16x16x32_bf16 v[76:79], a[68:71], a[44:47], v[76:79]
ds_read_b128 a[4:7], v23 offset:39296
s_add_u32 m0, s56, 123648
v_mfma_f32_16x16x32_bf16 v[80:83], a[68:71], a[48:51], v[80:83]
buffer_load_dwordx4 v18, s[20:23], s54 offen lds
v_mfma_f32_16x16x32_bf16 v[64:67], a[64:67], a[48:51], v[64:67]
ds_read_b128 a[8:11], v23 offset:41600
v_mfma_f32_16x16x32_bf16 v[68:71], a[64:67], a[52:55], v[68:71]
ds_read_b128 a[12:15], v23 offset:43904
v_mfma_f32_16x16x32_bf16 v[84:87], a[68:71], a[52:55], v[84:87]
buffer_load_dwordx4 v19, s[20:23], s54 offen offset:1024 lds
v_mfma_f32_16x16x32_bf16 v[88:91], a[68:71], a[56:59], v[88:91]
ds_read_b64_tr_b16 a[20:21], v25
v_mfma_f32_16x16x32_bf16 v[72:75], a[64:67], a[56:59], v[72:75]
ds_read_b64_tr_b16 a[22:23], v25 offset:512
s_waitcnt lgkmcnt(6)
v_mfma_f32_16x16x32_bf16 v[244:247], a[68:71], a[60:63], v[244:247]
ds_read_b64_tr_b16 a[24:25], v25 offset:32
v_mfma_f32_16x16x32_bf16 v[104:107], a[72:75], a[56:59], v[104:107]
buffer_load_dwordx4 v20, s[20:23], s54 offen offset:2048 lds
v_mfma_f32_16x16x32_bf16 v[120:123], a[76:79], a[56:59], v[120:123]
ds_read_b64_tr_b16 a[26:27], v25 offset:544
s_add_u32 s54, s54, 196608
v_mfma_f32_16x16x32_bf16 v[116:119], a[76:79], a[52:55], v[116:119]
ds_read_b128 a[16:19], v24 offset:36992
s_add_u32 m0, s55, 18496
v_mfma_f32_16x16x32_bf16 v[100:103], a[72:75], a[52:55], v[100:103]
buffer_load_dwordx4 v21, s[36:39], s52 offen lds
v_mfma_f32_16x16x32_bf16 v[96:99], a[72:75], a[48:51], v[96:99]
v_mfma_f32_16x16x32_bf16 v[112:115], a[76:79], a[48:51], v[112:115]
ds_read_b64_tr_b16 a[28:29], v25 offset:1024
v_mfma_f32_16x16x32_bf16 v[108:111], a[76:79], a[44:47], v[108:111]
ds_read_b64_tr_b16 a[30:31], v25 offset:1536
v_mfma_f32_16x16x32_bf16 v[92:95], a[72:75], a[44:47], v[92:95]
buffer_load_dwordx4 v28, s[36:39], s52 offen offset:1024 lds
v_mfma_f32_16x16x32_bf16 v[124:127], a[44:47], a[80:83], v[124:127]
ds_read_b64_tr_b16 a[32:33], v25 offset:1056
v_mfma_f32_16x16x32_bf16 v[140:143], a[44:47], a[84:87], v[140:143]
ds_read_b64_tr_b16 a[34:35], v25 offset:1568
v_mfma_f32_16x16x32_bf16 v[144:147], a[48:51], a[84:87], v[144:147]
buffer_load_dword v22, s[36:39], s52 offen offset:2048 lds
v_mfma_f32_16x16x32_bf16 v[128:131], a[48:51], a[80:83], v[128:131]
ds_read_b64_tr_b16 a[36:37], v25 offset:2048
s_add_u32 s52, s52, 128
v_mfma_f32_16x16x32_bf16 v[132:135], a[52:55], a[80:83], v[132:135]
ds_read_b64_tr_b16 a[38:39], v25 offset:2560
v_mfma_f32_16x16x32_bf16 v[148:151], a[52:55], a[84:87], v[148:151]
ds_read_b64_tr_b16 a[40:41], v25 offset:2080
v_mfma_f32_16x16x32_bf16 v[152:155], a[56:59], a[84:87], v[152:155]
buffer_load_dwordx4 v[172:175], v26, s[16:19], s75 offen offset:2048 sc1
v_mfma_f32_16x16x32_bf16 v[136:139], a[56:59], a[80:83], v[136:139]
ds_read_b64_tr_b16 a[42:43], v25 offset:2592
v_mfma_f32_16x16x32_bf16 v[156:159], a[60:63], a[80:83], v[156:159]
v_mfma_f32_16x16x32_bf16 v[160:163], a[60:63], a[84:87], v[160:163]
s_waitcnt vmcnt(24) lgkmcnt(8)
s_barrier
v_mfma_f32_16x16x32_bf16 v[60:63], a[20:23], a[0:3], v[60:63]
ds_read_b128 a[44:47], v30 offset:36992
v_mfma_f32_16x16x32_bf16 v[76:79], a[24:27], a[0:3], v[76:79]
ds_read_b128 a[48:51], v30 offset:39296
s_add_u32 m0, s56, 136064
v_mfma_f32_16x16x32_bf16 v[80:83], a[24:27], a[4:7], v[80:83]
buffer_load_dwordx4 v18, s[20:23], s54 offen lds
v_mfma_f32_16x16x32_bf16 v[64:67], a[20:23], a[4:7], v[64:67]
s_sub_u32 s47, s47, 1
s_cbranch_scc1 .Lx30
.Lx30b:
v_mfma_f32_16x16x32_bf16 v[68:71], a[20:23], a[8:11], v[68:71]
ds_read_b128 a[52:55], v30 offset:41600
v_mfma_f32_16x16x32_bf16 v[84:87], a[24:27], a[8:11], v[84:87]
buffer_load_dwordx4 v19, s[20:23], s54 offen offset:1024 lds
v_mfma_f32_16x16x32_bf16 v[88:91], a[24:27], a[12:15], v[88:91]
ds_read_b128 a[56:59], v30 offset:43904
v_mfma_f32_16x16x32_bf16 v[72:75], a[20:23], a[12:15], v[72:75]
ds_read_b64_tr_b16 a[64:65], v25 offset:12416
s_waitcnt lgkmcnt(5)
v_mfma_f32_16x16x32_bf16 v[244:247], a[24:27], a[16:19], v[244:247]
ds_read_b64_tr_b16 a[66:67], v25 offset:12928
v_mfma_f32_16x16x32_bf16 v[104:107], a[28:31], a[12:15], v[104:107]
buffer_load_dwordx4 v20, s[20:23], s54 offen offset:2048 lds
v_mfma_f32_16x16x32_bf16 v[120:123], a[32:35], a[12:15], v[120:123]
ds_read_b64_tr_b16 a[68:69], v25 offset:12448
s_add_u32 s54, s54, 196608
v_mfma_f32_16x16x32_bf16 v[116:119], a[32:35], a[8:11], v[116:119]
ds_read_b64_tr_b16 a[70:71], v25 offset:12960
s_add_u32 m0, s55, 20800
v_mfma_f32_16x16x32_bf16 v[100:103], a[28:31], a[8:11], v[100:103]
buffer_load_dwordx4 v21, s[36:39], s53 offen lds
v_mfma_f32_16x16x32_bf16 v[96:99], a[28:31], a[4:7], v[96:99]
ds_read_b128 a[60:63], v31 offset:36992
v_mfma_f32_16x16x32_bf16 v[112:115], a[32:35], a[4:7], v[112:115]
ds_read_b64_tr_b16 a[72:73], v25 offset:13440
v_mfma_f32_16x16x32_bf16 v[108:111], a[32:35], a[0:3], v[108:111]
ds_read_b64_tr_b16 a[74:75], v25 offset:13952
v_mfma_f32_16x16x32_bf16 v[92:95], a[28:31], a[0:3], v[92:95]
buffer_load_dwordx4 v28, s[36:39], s53 offen offset:1024 lds
v_mfma_f32_16x16x32_bf16 v[124:127], a[0:3], a[36:39], v[124:127]
ds_read_b64_tr_b16 a[76:77], v25 offset:13472
v_mfma_f32_16x16x32_bf16 v[140:143], a[0:3], a[40:43], v[140:143]
ds_read_b64_tr_b16 a[78:79], v25 offset:13984
v_mfma_f32_16x16x32_bf16 v[144:147], a[4:7], a[40:43], v[144:147]
buffer_load_dword v29, s[36:39], s53 offen offset:2048 lds
v_mfma_f32_16x16x32_bf16 v[128:131], a[4:7], a[36:39], v[128:131]
ds_read_b64_tr_b16 a[80:81], v25 offset:14464
s_add_u32 s53, s53, 128
v_mfma_f32_16x16x32_bf16 v[132:135], a[8:11], a[36:39], v[132:135]
ds_read_b64_tr_b16 a[82:83], v25 offset:14976
v_mfma_f32_16x16x32_bf16 v[148:151], a[8:11], a[40:43], v[148:151]
ds_read_b64_tr_b16 a[84:85], v25 offset:14496
v_mfma_f32_16x16x32_bf16 v[152:155], a[12:15], a[40:43], v[152:155]
buffer_load_dwordx4 v[176:179], v26, s[16:19], s75 offen offset:3072 sc1
v_mfma_f32_16x16x32_bf16 v[136:139], a[12:15], a[36:39], v[136:139]
ds_read_b64_tr_b16 a[86:87], v25 offset:15008
s_add_u32 s75, s75, 4096
v_mfma_f32_16x16x32_bf16 v[156:159], a[16:19], a[36:39], v[156:159]
v_mfma_f32_16x16x32_bf16 v[160:163], a[16:19], a[40:43], v[160:163]
s_waitcnt vmcnt(25) lgkmcnt(8)
s_barrier
v_mfma_f32_16x16x32_bf16 v[60:63], a[64:67], a[44:47], v[60:63]
ds_read_b128 a[0:3], v23 offset:55488
v_mfma_f32_16x16x32_bf16 v[76:79], a[68:71], a[44:47], v[76:79]
ds_read_b128 a[4:7], v23 offset:57792
s_add_u32 m0, s56, 73984
v_mfma_f32_16x16x32_bf16 v[80:83], a[68:71], a[48:51], v[80:83]
buffer_load_dwordx4 v18, s[20:23], s54 offen lds
v_mfma_f32_16x16x32_bf16 v[64:67], a[64:67], a[48:51], v[64:67]
ds_read_b128 a[8:11], v23 offset:60096
v_mfma_f32_16x16x32_bf16 v[68:71], a[64:67], a[52:55], v[68:71]
ds_read_b128 a[12:15], v23 offset:62400
v_mfma_f32_16x16x32_bf16 v[84:87], a[68:71], a[52:55], v[84:87]
buffer_load_dwordx4 v19, s[20:23], s54 offen offset:1024 lds
v_mfma_f32_16x16x32_bf16 v[88:91], a[68:71], a[56:59], v[88:91]
ds_read_b64_tr_b16 a[20:21], v25 offset:24832
v_mfma_f32_16x16x32_bf16 v[72:75], a[64:67], a[56:59], v[72:75]
ds_read_b64_tr_b16 a[22:23], v25 offset:25344
s_waitcnt lgkmcnt(6)
v_mfma_f32_16x16x32_bf16 v[244:247], a[68:71], a[60:63], v[244:247]
ds_read_b64_tr_b16 a[24:25], v25 offset:24864
v_mfma_f32_16x16x32_bf16 v[104:107], a[72:75], a[56:59], v[104:107]
buffer_load_dwordx4 v20, s[20:23], s54 offen offset:2048 lds
v_mfma_f32_16x16x32_bf16 v[120:123], a[76:79], a[56:59], v[120:123]
ds_read_b64_tr_b16 a[26:27], v25 offset:25376
s_add_u32 s54, s54, 196608
v_mfma_f32_16x16x32_bf16 v[116:119], a[76:79], a[52:55], v[116:119]
ds_read_b128 a[16:19], v24 offset:55488
s_add_u32 m0, s55, 36992
v_mfma_f32_16x16x32_bf16 v[100:103], a[72:75], a[52:55], v[100:103]
buffer_load_dwordx4 v21, s[36:39], s52 offen lds
v_mfma_f32_16x16x32_bf16 v[96:99], a[72:75], a[48:51], v[96:99]
v_mfma_f32_16x16x32_bf16 v[112:115], a[76:79], a[48:51], v[112:115]
ds_read_b64_tr_b16 a[28:29], v25 offset:25856
v_mfma_f32_16x16x32_bf16 v[108:111], a[76:79], a[44:47], v[108:111]
ds_read_b64_tr_b16 a[30:31], v25 offset:26368
v_mfma_f32_16x16x32_bf16 v[92:95], a[72:75], a[44:47], v[92:95]
buffer_load_dwordx4 v28, s[36:39], s52 offen offset:1024 lds
v_mfma_f32_16x16x32_bf16 v[124:127], a[44:47], a[80:83], v[124:127]
ds_read_b64_tr_b16 a[32:33], v25 offset:25888
v_mfma_f32_16x16x32_bf16 v[140:143], a[44:47], a[84:87], v[140:143]
ds_read_b64_tr_b16 a[34:35], v25 offset:26400
v_mfma_f32_16x16x32_bf16 v[144:147], a[48:51], a[84:87], v[144:147]
buffer_load_dword v22, s[36:39], s52 offen offset:2048 lds
v_mfma_f32_16x16x32_bf16 v[128:131], a[48:51], a[80:83], v[128:131]
ds_read_b64_tr_b16 a[36:37], v25 offset:26880
s_add_u32 s52, s52, 128
v_mfma_f32_16x16x32_bf16 v[132:135], a[52:55], a[80:83], v[132:135]
ds_read_b64_tr_b16 a[38:39], v25 offset:27392
v_mfma_f32_16x16x32_bf16 v[148:151], a[52:55], a[84:87], v[148:151]
ds_read_b64_tr_b16 a[40:41], v25 offset:26912
v_mfma_f32_16x16x32_bf16 v[152:155], a[56:59], a[84:87], v[152:155]
buffer_load_dwordx4 v[180:183], v26, s[16:19], s75 offen sc1
v_mfma_f32_16x16x32_bf16 v[136:139], a[56:59], a[80:83], v[136:139]
ds_read_b64_tr_b16 a[42:43], v25 offset:27424
v_mfma_f32_16x16x32_bf16 v[156:159], a[60:63], a[80:83], v[156:159]
v_mfma_f32_16x16x32_bf16 v[160:163], a[60:63], a[84:87], v[160:163]
s_waitcnt vmcnt(25) lgkmcnt(8)
s_barrier
v_mfma_f32_16x16x32_bf16 v[60:63], a[20:23], a[0:3], v[60:63]
ds_read_b128 a[44:47], v30 offset:55488
s_waitcnt vmcnt(21)
v_add_f32 v164, v164, v168
v_mfma_f32_16x16x32_bf16 v[76:79], a[24:27], a[0:3], v[76:79]
ds_read_b128 a[48:51], v30 offset:57792
s_add_u32 m0, s56, 86400
v_mfma_f32_16x16x32_bf16 v[80:83], a[24:27], a[4:7], v[80:83]
buffer_load_dwordx4 v18, s[20:23], s54 offen lds
v_mfma_f32_16x16x32_bf16 v[64:67], a[20:23], a[4:7], v[64:67]
s_sub_u32 s47, s47, 1
s_cbranch_scc1 .Lx31
.Lx31b:
v_mfma_f32_16x16x32_bf16 v[68:71], a[20:23], a[8:11], v[68:71]
ds_read_b128 a[52:55], v30 offset:60096
v_mfma_f32_16x16x32_bf16 v[84:87], a[24:27], a[8:11], v[84:87]
buffer_load_dwordx4 v19, s[20:23], s54 offen offset:1024 lds
v_mfma_f32_16x16x32_bf16 v[88:91], a[24:27], a[12:15], v[88:91]
ds_read_b128 a[56:59], v30 offset:62400
v_mfma_f32_16x16x32_bf16 v[72:75], a[20:23], a[12:15], v[72:75]
ds_read_b64_tr_b16 a[64:65], v25 offset:37248
s_waitcnt lgkmcnt(5)
v_mfma_f32_16x16x32_bf16 v[244:247], a[24:27], a[16:19], v[244:247]
ds_read_b64_tr_b16 a[66:67], v25 offset:37760
v_add_f32 v165, v165, v169
v_mfma_f32_16x16x32_bf16 v[104:107], a[28:31], a[12:15], v[104:107]
buffer_load_dwordx4 v20, s[20:23], s54 offen offset:2048 lds
v_mfma_f32_16x16x32_bf16 v[120:123], a[32:35], a[12:15], v[120:123]
ds_read_b64_tr_b16 a[68:69], v25 offset:37280
s_add_u32 s54, s54, 196608
v_mfma_f32_16x16x32_bf16 v[116:119], a[32:35], a[8:11], v[116:119]
ds_read_b64_tr_b16 a[70:71], v25 offset:37792
s_add_u32 m0, s55, 39296
v_mfma_f32_16x16x32_bf16 v[100:103], a[28:31], a[8:11], v[100:103]
buffer_load_dwordx4 v21, s[36:39], s53 offen lds
v_mfma_f32_16x16x32_bf16 v[96:99], a[28:31], a[4:7], v[96:99]
ds_read_b128 a[60:63], v31 offset:55488
v_mfma_f32_16x16x32_bf16 v[112:115], a[32:35], a[4:7], v[112:115]
ds_read_b64_tr_b16 a[72:73], v25 offset:38272
v_mfma_f32_16x16x32_bf16 v[108:111], a[32:35], a[0:3], v[108:111]
ds_read_b64_tr_b16 a[74:75], v25 offset:38784
v_mfma_f32_16x16x32_bf16 v[92:95], a[28:31], a[0:3], v[92:95]
buffer_load_dwordx4 v28, s[36:39], s53 offen offset:1024 lds
v_mfma_f32_16x16x32_bf16 v[124:127], a[0:3], a[36:39], v[124:127]
ds_read_b64_tr_b16 a[76:77], v25 offset:38304
v_add_f32 v166, v166, v170
v_mfma_f32_16x16x32_bf16 v[140:143], a[0:3], a[40:43], v[140:143]
ds_read_b64_tr_b16 a[78:79], v25 offset:38816
v_mfma_f32_16x16x32_bf16 v[144:147], a[4:7], a[40:43], v[144:147]
buffer_load_dword v29, s[36:39], s53 offen offset:2048 lds
v_mfma_f32_16x16x32_bf16 v[128:131], a[4:7], a[36:39], v[128:131]
ds_read_b64_tr_b16 a[80:81], v25 offset:39296
s_add_u32 s53, s53, 128
v_mfma_f32_16x16x32_bf16 v[132:135], a[8:11], a[36:39], v[132:135]
ds_read_b64_tr_b16 a[82:83], v25 offset:39808
v_mfma_f32_16x16x32_bf16 v[148:151], a[8:11], a[40:43], v[148:151]
ds_read_b64_tr_b16 a[84:85], v25 offset:39328
v_add_f32 v167, v167, v171
v_mfma_f32_16x16x32_bf16 v[152:155], a[12:15], a[40:43], v[152:155]
buffer_load_dwordx4 v[184:187], v26, s[16:19], s75 offen offset:1024 sc1
v_mfma_f32_16x16x32_bf16 v[136:139], a[12:15], a[36:39], v[136:139]
ds_read_b64_tr_b16 a[86:87], v25 offset:39840
v_mfma_f32_16x16x32_bf16 v[156:159], a[16:19], a[36:39], v[156:159]
v_mfma_f32_16x16x32_bf16 v[160:163], a[16:19], a[40:43], v[160:163]
s_waitcnt vmcnt(25) lgkmcnt(8)
s_barrier
v_mfma_f32_16x16x32_bf16 v[60:63], a[64:67], a[44:47], v[60:63]
ds_read_b128 a[0:3], v23
s_waitcnt vmcnt(21)
v_add_f32 v164, v164, v172
v_mfma_f32_16x16x32_bf16 v[76:79], a[68:71], a[44:47], v[76:79]
ds_read_b128 a[4:7], v23 offset:2304
s_add_u32 m0, s56, 98816
v_mfma_f32_16x16x32_bf16 v[80:83], a[68:71], a[48:51], v[80:83]
buffer_load_dwordx4 v18, s[20:23], s54 offen lds
v_mfma_f32_16x16x32_bf16 v[64:67], a[64:67], a[48:51], v[64:67]
ds_read_b128 a[8:11], v23 offset:4608
v_mfma_f32_16x16x32_bf16 v[68:71], a[64:67], a[52:55], v[68:71]
ds_read_b128 a[12:15], v23 offset:6912
v_mfma_f32_16x16x32_bf16 v[84:87], a[68:71], a[52:55], v[84:87]
buffer_load_dwordx4 v19, s[20:23], s54 offen offset:1024 lds
v_mfma_f32_16x16x32_bf16 v[88:91], a[68:71], a[56:59], v[88:91]
ds_read_b64_tr_b16 a[20:21], v25 offset:49664
v_mfma_f32_16x16x32_bf16 v[72:75], a[64:67], a[56:59], v[72:75]
ds_read_b64_tr_b16 a[22:23], v25 offset:50176
s_waitcnt lgkmcnt(6)
v_mfma_f32_16x16x32_bf16 v[244:247], a[68:71], a[60:63], v[244:247]
ds_read_b64_tr_b16 a[24:25], v25 offset:49696
v_add_f32 v165, v165, v173
v_mfma_f32_16x16x32_bf16 v[104:107], a[72:75], a[56:59], v[104:107]
buffer_load_dwordx4 v20, s[20:23], s54 offen offset:2048 lds
v_mfma_f32_16x16x32_bf16 v[120:123], a[76:79], a[56:59], v[120:123]
ds_read_b64_tr_b16 a[26:27], v25 offset:50208
s_add_u32 s54, s54, 196608
v_mfma_f32_16x16x32_bf16 v[116:119], a[76:79], a[52:55], v[116:119]
ds_read_b128 a[16:19], v24
s_add_u32 m0, s55, 55488
v_mfma_f32_16x16x32_bf16 v[100:103], a[72:75], a[52:55], v[100:103]
buffer_load_dwordx4 v21, s[36:39], s52 offen lds
v_mfma_f32_16x16x32_bf16 v[96:99], a[72:75], a[48:51], v[96:99]
v_mfma_f32_16x16x32_bf16 v[112:115], a[76:79], a[48:51], v[112:115]
ds_read_b64_tr_b16 a[28:29], v25 offset:50688
v_mfma_f32_16x16x32_bf16 v[108:111], a[76:79], a[44:47], v[108:111]
ds_read_b64_tr_b16 a[30:31], v25 offset:51200
v_add_f32 v166, v166, v174
v_mfma_f32_16x16x32_bf16 v[92:95], a[72:75], a[44:47], v[92:95]
buffer_load_dwordx4 v28, s[36:39], s52 offen offset:1024 lds
v_mfma_f32_16x16x32_bf16 v[124:127], a[44:47], a[80:83], v[124:127]
ds_read_b64_tr_b16 a[32:33], v25 offset:50720
v_mfma_f32_16x16x32_bf16 v[140:143], a[44:47], a[84:87], v[140:143]
ds_read_b64_tr_b16 a[34:35], v25 offset:51232
v_mfma_f32_16x16x32_bf16 v[144:147], a[48:51], a[84:87], v[144:147]
buffer_load_dword v22, s[36:39], s52 offen offset:2048 lds
v_mfma_f32_16x16x32_bf16 v[128:131], a[48:51], a[80:83], v[128:131]
ds_read_b64_tr_b16 a[36:37], v25 offset:51712
s_add_u32 s52, s52, 128
v_mfma_f32_16x16x32_bf16 v[132:135], a[52:55], a[80:83], v[132:135]
ds_read_b64_tr_b16 a[38:39], v25 offset:52224
v_mfma_f32_16x16x32_bf16 v[148:151], a[52:55], a[84:87], v[148:151]
ds_read_b64_tr_b16 a[40:41], v25 offset:51744
v_add_f32 v167, v167, v175
v_mfma_f32_16x16x32_bf16 v[152:155], a[56:59], a[84:87], v[152:155]
buffer_load_dwordx4 v[188:191], v26, s[16:19], s75 offen offset:2048 sc1
v_mfma_f32_16x16x32_bf16 v[136:139], a[56:59], a[80:83], v[136:139]
ds_read_b64_tr_b16 a[42:43], v25 offset:52256
v_mfma_f32_16x16x32_bf16 v[156:159], a[60:63], a[80:83], v[156:159]
v_mfma_f32_16x16x32_bf16 v[160:163], a[60:63], a[84:87], v[160:163]
s_waitcnt vmcnt(25) lgkmcnt(8)
s_barrier
v_mfma_f32_16x16x32_bf16 v[60:63], a[20:23], a[0:3], v[60:63]
ds_read_b128 a[44:47], v30
s_waitcnt vmcnt(21)
v_add_f32 v164, v164, v176
v_mfma_f32_16x16x32_bf16 v[76:79], a[24:27], a[0:3], v[76:79]
ds_read_b128 a[48:51], v30 offset:2304
s_add_u32 m0, s56, 111232
v_mfma_f32_16x16x32_bf16 v[80:83], a[24:27], a[4:7], v[80:83]
buffer_load_dwordx4 v18, s[20:23], s54 offen lds
v_mfma_f32_16x16x32_bf16 v[64:67], a[20:23], a[4:7], v[64:67]
ds_read_b128 a[52:55], v30 offset:4608
v_mfma_f32_16x16x32_bf16 v[68:71], a[20:23], a[8:11], v[68:71]
ds_read_b128 a[56:59], v30 offset:6912
v_mfma_f32_16x16x32_bf16 v[84:87], a[24:27], a[8:11], v[84:87]
buffer_load_dwordx4 v19, s[20:23], s54 offen offset:1024 lds
v_mfma_f32_16x16x32_bf16 v[88:91], a[24:27], a[12:15], v[88:91]
ds_read_b64_tr_b16 a[64:65], v25 offset:62080
v_mfma_f32_16x16x32_bf16 v[72:75], a[20:23], a[12:15], v[72:75]
ds_read_b64_tr_b16 a[66:67], v25 offset:62592
s_waitcnt lgkmcnt(6)
v_mfma_f32_16x16x32_bf16 v[244:247], a[24:27], a[16:19], v[244:247]
ds_read_b64_tr_b16 a[68:69], v25 offset:62112
v_add_f32 v165, v165, v177
v_mfma_f32_16x16x32_bf16 v[104:107], a[28:31], a[12:15], v[104:107]
buffer_load_dwordx4 v20, s[20:23], s54 offen offset:2048 lds
v_mfma_f32_16x16x32_bf16 v[120:123], a[32:35], a[12:15], v[120:123]
ds_read_b64_tr_b16 a[70:71], v25 offset:62624
s_add_u32 s54, s54, 196608
v_mfma_f32_16x16x32_bf16 v[116:119], a[32:35], a[8:11], v[116:119]
ds_read_b128 a[60:63], v31
s_add_u32 m0, s55, 57792
v_mfma_f32_16x16x32_bf16 v[100:103], a[28:31], a[8:11], v[100:103]
buffer_load_dwordx4 v21, s[36:39], s53 offen lds
v_mfma_f32_16x16x32_bf16 v[96:99], a[28:31], a[4:7], v[96:99]
v_mfma_f32_16x16x32_bf16 v[112:115], a[32:35], a[4:7], v[112:115]
ds_read_b64_tr_b16 a[72:73], v25 offset:63104
v_mfma_f32_16x16x32_bf16 v[108:111], a[32:35], a[0:3], v[108:111]
ds_read_b64_tr_b16 a[74:75], v25 offset:63616
v_add_f32 v166, v166, v178
v_mfma_f32_16x16x32_bf16 v[92:95], a[28:31], a[0:3], v[92:95]
buffer_load_dwordx4 v28, s[36:39], s53 offen offset:1024 lds
v_mfma_f32_16x16x32_bf16 v[124:127], a[0:3], a[36:39], v[124:127]
ds_read_b64_tr_b16 a[76:77], v25 offset:63136
v_mfma_f32_16x16x32_bf16 v[140:143], a[0:3], a[40:43], v[140:143]
ds_read_b64_tr_b16 a[78:79], v25 offset:63648
v_mfma_f32_16x16x32_bf16 v[144:147], a[4:7], a[40:43], v[144:147]
buffer_load_dword v29, s[36:39], s53 offen offset:2048 lds
v_mfma_f32_16x16x32_bf16 v[128:131], a[4:7], a[36:39], v[128:131]
ds_read_b64_tr_b16 a[80:81], v25 offset:64128
s_add_u32 s53, s53, 128
v_mfma_f32_16x16x32_bf16 v[132:135], a[8:11], a[36:39], v[132:135]
ds_read_b64_tr_b16 a[82:83], v25 offset:64640
v_mfma_f32_16x16x32_bf16 v[148:151], a[8:11], a[40:43], v[148:151]
ds_read_b64_tr_b16 a[84:85], v25 offset:64160
v_add_f32 v167, v167, v179
v_mfma_f32_16x16x32_bf16 v[152:155], a[12:15], a[40:43], v[152:155]
buffer_load_dwordx4 v[192:195], v26, s[16:19], s75 offen offset:3072 sc1
v_mfma_f32_16x16x32_bf16 v[136:139], a[12:15], a[36:39], v[136:139]
ds_read_b64_tr_b16 a[86:87], v25 offset:64672
v_mfma_f32_16x16x32_bf16 v[156:159], a[16:19], a[36:39], v[156:159]
v_mfma_f32_16x16x32_bf16 v[160:163], a[16:19], a[40:43], v[160:163]
s_waitcnt vmcnt(25) lgkmcnt(8)
s_barrier
v_mfma_f32_16x16x32_bf16 v[60:63], a[64:67], a[44:47], v[60:63]
ds_read_b128 a[0:3], v23 offset:18496
s_waitcnt vmcnt(21)
v_add_f32 v164, v164, v180
v_mfma_f32_16x16x32_bf16 v[76:79], a[68:71], a[44:47], v[76:79]
ds_read_b128 a[4:7], v23 offset:20800
s_add_u32 m0, s56, 123648
v_mfma_f32_16x16x32_bf16 v[80:83], a[68:71], a[48:51], v[80:83]
buffer_load_dwordx4 v18, s[20:23], s54 offen lds
v_mfma_f32_16x16x32_bf16 v[64:67], a[64:67], a[48:51], v[64:67]
ds_read_b128 a[8:11], v23 offset:23104
v_mfma_f32_16x16x32_bf16 v[68:71], a[64:67], a[52:55], v[68:71]
v_mfma_f32_16x16x32_bf16 v[84:87], a[68:71], a[52:55], v[84:87]
ds_read_b128 a[12:15], v23 offset:25408
v_mfma_f32_16x16x32_bf16 v[88:91], a[68:71], a[56:59], v[88:91]
ds_read_b64_tr_b16 a[20:21], v25
v_mfma_f32_16x16x32_bf16 v[72:75], a[64:67], a[56:59], v[72:75]
ds_read_b64_tr_b16 a[22:23], v25 offset:512
s_waitcnt lgkmcnt(6)
v_mfma_f32_16x16x32_bf16 v[244:247], a[68:71], a[60:63], v[244:247]
v_add_f32 v165, v165, v181
v_mfma_f32_16x16x32_bf16 v[104:107], a[72:75], a[56:59], v[104:107]
ds_read_b64_tr_b16 a[24:25], v25 offset:32
v_mfma_f32_16x16x32_bf16 v[120:123], a[76:79], a[56:59], v[120:123]
buffer_load_dwordx4 v19, s[20:23], s54 offen offset:1024 lds
v_mfma_f32_16x16x32_bf16 v[116:119], a[76:79], a[52:55], v[116:119]
ds_read_b64_tr_b16 a[26:27], v25 offset:544
v_mfma_f32_16x16x32_bf16 v[100:103], a[72:75], a[52:55], v[100:103]
ds_read_b128 a[16:19], v24 offset:18496
v_mfma_f32_16x16x32_bf16 v[96:99], a[72:75], a[48:51], v[96:99]
v_mfma_f32_16x16x32_bf16 v[112:115], a[76:79], a[48:51], v[112:115]
ds_read_b64_tr_b16 a[28:29], v25 offset:1024
v_add_f32 v166, v166, v182
v_mfma_f32_16x16x32_bf16 v[108:111], a[76:79], a[44:47], v[108:111]
ds_read_b64_tr_b16 a[30:31], v25 offset:1536
v_mfma_f32_16x16x32_bf16 v[92:95], a[72:75], a[44:47], v[92:95]
ds_read_b64_tr_b16 a[32:33], v25 offset:1056
v_mfma_f32_16x16x32_bf16 v[124:127], a[44:47], a[80:83], v[124:127]
v_mfma_f32_16x16x32_bf16 v[140:143], a[44:47], a[84:87], v[140:143]
buffer_load_dwordx4 v20, s[20:23], s54 offen offset:2048 lds
v_mfma_f32_16x16x32_bf16 v[144:147], a[48:51], a[84:87], v[144:147]
ds_read_b64_tr_b16 a[34:35], v25 offset:1568
s_add_u32 s54, s54, 196608
v_mfma_f32_16x16x32_bf16 v[128:131], a[48:51], a[80:83], v[128:131]
ds_read_b64_tr_b16 a[36:37], v25 offset:2048
v_mfma_f32_16x16x32_bf16 v[132:135], a[52:55], a[80:83], v[132:135]
ds_read_b64_tr_b16 a[38:39], v25 offset:2560
v_add_f32 v167, v167, v183
v_mfma_f32_16x16x32_bf16 v[148:151], a[52:55], a[84:87], v[148:151]
v_mfma_f32_16x16x32_bf16 v[152:155], a[56:59], a[84:87], v[152:155]
ds_read_b64_tr_b16 a[40:41], v25 offset:2080
v_mfma_f32_16x16x32_bf16 v[136:139], a[56:59], a[80:83], v[136:139]
ds_read_b64_tr_b16 a[42:43], v25 offset:2592
v_mfma_f32_16x16x32_bf16 v[156:159], a[60:63], a[80:83], v[156:159]
v_mfma_f32_16x16x32_bf16 v[160:163], a[60:63], a[84:87], v[160:163]
s_waitcnt vmcnt(21) lgkmcnt(8)
s_barrier
v_mfma_f32_16x16x32_bf16 v[60:63], a[20:23], a[0:3], v[60:63]
ds_read_b128 a[44:47], v30 offset:18496
s_waitcnt vmcnt(17)
v_add_f32 v164, v164, v184
v_mfma_f32_16x16x32_bf16 v[76:79], a[24:27], a[0:3], v[76:79]
ds_read_b128 a[48:51], v30 offset:20800
s_add_u32 m0, s56, 136064
v_mfma_f32_16x16x32_bf16 v[80:83], a[24:27], a[4:7], v[80:83]
buffer_load_dwordx4 v18, s[20:23], s54 offen lds
v_mfma_f32_16x16x32_bf16 v[64:67], a[20:23], a[4:7], v[64:67]
ds_read_b128 a[52:55], v30 offset:23104
v_mfma_f32_16x16x32_bf16 v[68:71], a[20:23], a[8:11], v[68:71]
v_mfma_f32_16x16x32_bf16 v[84:87], a[24:27], a[8:11], v[84:87]
ds_read_b128 a[56:59], v30 offset:25408
v_mfma_f32_16x16x32_bf16 v[88:91], a[24:27], a[12:15], v[88:91]
ds_read_b64_tr_b16 a[64:65], v25 offset:12416
v_mfma_f32_16x16x32_bf16 v[72:75], a[20:23], a[12:15], v[72:75]
ds_read_b64_tr_b16 a[66:67], v25 offset:12928
s_waitcnt lgkmcnt(6)
v_mfma_f32_16x16x32_bf16 v[244:247], a[24:27], a[16:19], v[244:247]
v_add_f32 v165, v165, v185
v_mfma_f32_16x16x32_bf16 v[104:107], a[28:31], a[12:15], v[104:107]
ds_read_b64_tr_b16 a[68:69], v25 offset:12448
v_mfma_f32_16x16x32_bf16 v[120:123], a[32:35], a[12:15], v[120:123]
buffer_load_dwordx4 v19, s[20:23], s54 offen offset:1024 lds
v_mfma_f32_16x16x32_bf16 v[116:119], a[32:35], a[8:11], v[116:119]
ds_read_b64_tr_b16 a[70:71], v25 offset:12960
v_mfma_f32_16x16x32_bf16 v[100:103], a[28:31], a[8:11], v[100:103]
ds_read_b128 a[60:63], v31 offset:18496
v_mfma_f32_16x16x32_bf16 v[96:99], a[28:31], a[4:7], v[96:99]
v_mfma_f32_16x16x32_bf16 v[112:115], a[32:35], a[4:7], v[112:115]
ds_read_b64_tr_b16 a[72:73], v25 offset:13440
v_add_f32 v166, v166, v186
v_mfma_f32_16x16x32_bf16 v[108:111], a[32:35], a[0:3], v[108:111]
ds_read_b64_tr_b16 a[74:75], v25 offset:13952
v_mfma_f32_16x16x32_bf16 v[92:95], a[28:31], a[0:3], v[92:95]
ds_read_b64_tr_b16 a[76:77], v25 offset:13472
v_mfma_f32_16x16x32_bf16 v[124:127], a[0:3], a[36:39], v[124:127]
v_mfma_f32_16x16x32_bf16 v[140:143], a[0:3], a[40:43], v[140:143]
buffer_load_dwordx4 v20, s[20:23], s54 offen offset:2048 lds
v_mfma_f32_16x16x32_bf16 v[144:147], a[4:7], a[40:43], v[144:147]
ds_read_b64_tr_b16 a[78:79], v25 offset:13984
s_add_u32 s54, s54, 196608
v_mfma_f32_16x16x32_bf16 v[128:131], a[4:7], a[36:39], v[128:131]
ds_read_b64_tr_b16 a[80:81], v25 offset:14464
v_mfma_f32_16x16x32_bf16 v[132:135], a[8:11], a[36:39], v[132:135]
ds_read_b64_tr_b16 a[82:83], v25 offset:14976
v_add_f32 v167, v167, v187
v_mfma_f32_16x16x32_bf16 v[148:151], a[8:11], a[40:43], v[148:151]
v_mfma_f32_16x16x32_bf16 v[152:155], a[12:15], a[40:43], v[152:155]
ds_read_b64_tr_b16 a[84:85], v25 offset:14496
v_mfma_f32_16x16x32_bf16 v[136:139], a[12:15], a[36:39], v[136:139]
ds_read_b64_tr_b16 a[86:87], v25 offset:15008
v_mfma_f32_16x16x32_bf16 v[156:159], a[16:19], a[36:39], v[156:159]
v_mfma_f32_16x16x32_bf16 v[160:163], a[16:19], a[40:43], v[160:163]
s_waitcnt vmcnt(17) lgkmcnt(8)
s_barrier
v_mfma_f32_16x16x32_bf16 v[60:63], a[64:67], a[44:47], v[60:63]
ds_read_b128 a[0:3], v23 offset:36992
s_waitcnt vmcnt(13)
v_add_f32 v164, v164, v188
v_mfma_f32_16x16x32_bf16 v[76:79], a[68:71], a[44:47], v[76:79]
s_add_u32 m0, s59, 0
s_mov_b32 s58, 1048576
v_mfma_f32_16x16x32_bf16 v[80:83], a[68:71], a[48:51], v[80:83]
buffer_load_dwordx4 v5, s[24:27], s58 offen lds
v_mfma_f32_16x16x32_bf16 v[64:67], a[64:67], a[48:51], v[64:67]
ds_read_b128 a[4:7], v23 offset:39296
v_mfma_f32_16x16x32_bf16 v[68:71], a[64:67], a[52:55], v[68:71]
ds_read_b128 a[8:11], v23 offset:41600
v_mfma_f32_16x16x32_bf16 v[84:87], a[68:71], a[52:55], v[84:87]
ds_read_b128 a[12:15], v23 offset:43904
v_add_f32 v165, v165, v189
v_mfma_f32_16x16x32_bf16 v[88:91], a[68:71], a[56:59], v[88:91]
buffer_load_dwordx4 v6, s[24:27], s58 offen offset:1024 lds
v_mfma_f32_16x16x32_bf16 v[72:75], a[64:67], a[56:59], v[72:75]
ds_read_b64_tr_b16 a[20:21], v25 offset:24832
s_waitcnt lgkmcnt(5)
v_mfma_f32_16x16x32_bf16 v[244:247], a[68:71], a[60:63], v[244:247]
ds_read_b64_tr_b16 a[22:23], v25 offset:25344
v_mfma_f32_16x16x32_bf16 v[104:107], a[72:75], a[56:59], v[104:107]
s_add_u32 m0, s59, 8320
s_mov_b32 s58, 1179648
v_mfma_f32_16x16x32_bf16 v[120:123], a[76:79], a[56:59], v[120:123]
buffer_load_dwordx4 v5, s[24:27], s58 offen lds
v_mfma_f32_16x16x32_bf16 v[116:119], a[76:79], a[52:55], v[116:119]
ds_read_b64_tr_b16 a[24:25], v25 offset:24864
v_mfma_f32_16x16x32_bf16 v[100:103], a[72:75], a[52:55], v[100:103]
ds_read_b64_tr_b16 a[26:27], v25 offset:25376
v_mfma_f32_16x16x32_bf16 v[96:99], a[72:75], a[48:51], v[96:99]
ds_read_b128 a[16:19], v24 offset:36992
v_add_f32 v166, v166, v190
v_mfma_f32_16x16x32_bf16 v[112:115], a[76:79], a[48:51], v[112:115]
buffer_load_dwordx4 v6, s[24:27], s58 offen offset:1024 lds
v_mfma_f32_16x16x32_bf16 v[108:111], a[76:79], a[44:47], v[108:111]
ds_read_b64_tr_b16 a[28:29], v25 offset:25856
v_mfma_f32_16x16x32_bf16 v[92:95], a[72:75], a[44:47], v[92:95]
ds_read_b64_tr_b16 a[30:31], v25 offset:26368
v_mfma_f32_16x16x32_bf16 v[124:127], a[44:47], a[80:83], v[124:127]
s_add_u32 m0, s59, 16640
s_mov_b32 s58, 1310720
v_mfma_f32_16x16x32_bf16 v[140:143], a[44:47], a[84:87], v[140:143]
buffer_load_dwordx4 v5, s[24:27], s58 offen lds
v_mfma_f32_16x16x32_bf16 v[144:147], a[48:51], a[84:87], v[144:147]
ds_read_b64_tr_b16 a[32:33], v25 offset:25888
v_mfma_f32_16x16x32_bf16 v[128:131], a[48:51], a[80:83], v[128:131]
ds_read_b64_tr_b16 a[34:35], v25 offset:26400
v_add_f32 v167, v167, v191
v_mfma_f32_16x16x32_bf16 v[132:135], a[52:55], a[80:83], v[132:135]
ds_read_b64_tr_b16 a[36:37], v25 offset:26880
v_mfma_f32_16x16x32_bf16 v[148:151], a[52:55], a[84:87], v[148:151]
buffer_load_dwordx4 v6, s[24:27], s58 offen offset:1024 lds
v_mfma_f32_16x16x32_bf16 v[152:155], a[56:59], a[84:87], v[152:155]
ds_read_b64_tr_b16 a[38:39], v25 offset:27392
v_mfma_f32_16x16x32_bf16 v[136:139], a[56:59], a[80:83], v[136:139]
ds_read_b64_tr_b16 a[40:41], v25 offset:26912
v_mfma_f32_16x16x32_bf16 v[156:159], a[60:63], a[80:83], v[156:159]
ds_read_b64_tr_b16 a[42:43], v25 offset:27424
v_mfma_f32_16x16x32_bf16 v[160:163], a[60:63], a[84:87], v[160:163]
s_waitcnt vmcnt(16) lgkmcnt(8)
s_barrier
v_mfma_f32_16x16x32_bf16 v[60:63], a[20:23], a[0:3], v[60:63]
ds_read_b128 a[44:47], v30 offset:36992
s_waitcnt vmcnt(12)
v_add_f32 v164, v164, v192
v_mfma_f32_16x16x32_bf16 v[76:79], a[24:27], a[0:3], v[76:79]
s_add_u32 m0, s59, 24960
s_mov_b32 s58, 1441792
v_mfma_f32_16x16x32_bf16 v[80:83], a[24:27], a[4:7], v[80:83]
buffer_load_dwordx4 v5, s[24:27], s58 offen lds
v_mfma_f32_16x16x32_bf16 v[64:67], a[20:23], a[4:7], v[64:67]
ds_read_b128 a[48:51], v30 offset:39296
v_mfma_f32_16x16x32_bf16 v[68:71], a[20:23], a[8:11], v[68:71]
ds_read_b128 a[52:55], v30 offset:41600
v_mfma_f32_16x16x32_bf16 v[84:87], a[24:27], a[8:11], v[84:87]
ds_read_b128 a[56:59], v30 offset:43904
v_add_f32 v165, v165, v193
v_mfma_f32_16x16x32_bf16 v[88:91], a[24:27], a[12:15], v[88:91]
buffer_load_dwordx4 v6, s[24:27], s58 offen offset:1024 lds
v_mfma_f32_16x16x32_bf16 v[72:75], a[20:23], a[12:15], v[72:75]
ds_read_b64_tr_b16 a[64:65], v25 offset:37248
s_waitcnt lgkmcnt(5)
v_mfma_f32_16x16x32_bf16 v[244:247], a[24:27], a[16:19], v[244:247]
ds_read_b64_tr_b16 a[66:67], v25 offset:37760
v_mfma_f32_16x16x32_bf16 v[104:107], a[28:31], a[12:15], v[104:107]
s_add_u32 m0, s59, 74880
s_mov_b32 s58, 131072
v_mfma_f32_16x16x32_bf16 v[120:123], a[32:35], a[12:15], v[120:123]
buffer_load_dwordx4 v5, s[24:27], s58 offen lds
v_mfma_f32_16x16x32_bf16 v[116:119], a[32:35], a[8:11], v[116:119]
ds_read_b64_tr_b16 a[68:69], v25 offset:37280
v_mfma_f32_16x16x32_bf16 v[100:103], a[28:31], a[8:11], v[100:103]
ds_read_b64_tr_b16 a[70:71], v25 offset:37792
v_mfma_f32_16x16x32_bf16 v[96:99], a[28:31], a[4:7], v[96:99]
ds_read_b128 a[60:63], v31 offset:36992
v_add_f32 v166, v166, v194
v_mfma_f32_16x16x32_bf16 v[112:115], a[32:35], a[4:7], v[112:115]
buffer_load_dwordx4 v6, s[24:27], s58 offen offset:1024 lds
v_mfma_f32_16x16x32_bf16 v[108:111], a[32:35], a[0:3], v[108:111]
ds_read_b64_tr_b16 a[72:73], v25 offset:38272
v_mfma_f32_16x16x32_bf16 v[92:95], a[28:31], a[0:3], v[92:95]
ds_read_b64_tr_b16 a[74:75], v25 offset:38784
v_mfma_f32_16x16x32_bf16 v[124:127], a[0:3], a[36:39], v[124:127]
s_add_u32 m0, s59, 83200
s_mov_b32 s58, 262144
v_mfma_f32_16x16x32_bf16 v[140:143], a[0:3], a[40:43], v[140:143]
buffer_load_dwordx4 v5, s[24:27], s58 offen lds
v_mfma_f32_16x16x32_bf16 v[144:147], a[4:7], a[40:43], v[144:147]
ds_read_b64_tr_b16 a[76:77], v25 offset:38304
v_mfma_f32_16x16x32_bf16 v[128:131], a[4:7], a[36:39], v[128:131]
ds_read_b64_tr_b16 a[78:79], v25 offset:38816
v_add_f32 v167, v167, v195
v_mfma_f32_16x16x32_bf16 v[132:135], a[8:11], a[36:39], v[132:135]
ds_read_b64_tr_b16 a[80:81], v25 offset:39296
v_mfma_f32_16x16x32_bf16 v[148:151], a[8:11], a[40:43], v[148:151]
buffer_load_dwordx4 v6, s[24:27], s58 offen offset:1024 lds
v_mfma_f32_16x16x32_bf16 v[152:155], a[12:15], a[40:43], v[152:155]
ds_read_b64_tr_b16 a[82:83], v25 offset:39808
v_mfma_f32_16x16x32_bf16 v[136:139], a[12:15], a[36:39], v[136:139]
ds_read_b64_tr_b16 a[84:85], v25 offset:39328
v_mfma_f32_16x16x32_bf16 v[156:159], a[16:19], a[36:39], v[156:159]
ds_read_b64_tr_b16 a[86:87], v25 offset:39840
v_mfma_f32_16x16x32_bf16 v[160:163], a[16:19], a[40:43], v[160:163]
s_waitcnt vmcnt(15) lgkmcnt(8)
s_barrier
v_mfma_f32_16x16x32_bf16 v[60:63], a[64:67], a[44:47], v[60:63]
ds_read_b128 a[0:3], v23 offset:55488
v_permlane32_swap_b32 v164, v166
v_mfma_f32_16x16x32_bf16 v[76:79], a[68:71], a[44:47], v[76:79]
s_add_u32 m0, s59, 33280
s_mov_b32 s58, 1572864
v_mfma_f32_16x16x32_bf16 v[80:83], a[68:71], a[48:51], v[80:83]
buffer_load_dwordx4 v5, s[24:27], s58 offen lds
v_mfma_f32_16x16x32_bf16 v[64:67], a[64:67], a[48:51], v[64:67]
ds_read_b128 a[4:7], v23 offset:57792
v_permlane32_swap_b32 v165, v167
v_mfma_f32_16x16x32_bf16 v[68:71], a[64:67], a[52:55], v[68:71]
ds_read_b128 a[8:11], v23 offset:60096
v_mfma_f32_16x16x32_bf16 v[84:87], a[68:71], a[52:55], v[84:87]
ds_read_b128 a[12:15], v23 offset:62400
v_add_f32 v164, v164, v166
v_mfma_f32_16x16x32_bf16 v[88:91], a[68:71], a[56:59], v[88:91]
buffer_load_dwordx4 v6, s[24:27], s58 offen offset:1024 lds
v_mfma_f32_16x16x32_bf16 v[72:75], a[64:67], a[56:59], v[72:75]
ds_read_b64_tr_b16 a[20:21], v25 offset:49664
s_waitcnt lgkmcnt(5)
v_mfma_f32_16x16x32_bf16 v[244:247], a[68:71], a[60:63], v[244:247]
ds_read_b64_tr_b16 a[22:23], v25 offset:50176
v_mfma_f32_16x16x32_bf16 v[104:107], a[72:75], a[56:59], v[104:107]
s_add_u32 m0, s59, 41600
s_mov_b32 s58, 1703936
v_add_f32 v165, v165, v167
v_mfma_f32_16x16x32_bf16 v[120:123], a[76:79], a[56:59], v[120:123]
buffer_load_dwordx4 v5, s[24:27], s58 offen lds
v_mfma_f32_16x16x32_bf16 v[116:119], a[76:79], a[52:55], v[116:119]
ds_read_b64_tr_b16 a[24:25], v25 offset:49696
v_mfma_f32_16x16x32_bf16 v[100:103], a[72:75], a[52:55], v[100:103]
ds_read_b64_tr_b16 a[26:27], v25 offset:50208
v_mul_f32 v164, 0xba800000, v164
v_mfma_f32_16x16x32_bf16 v[96:99], a[72:75], a[48:51], v[96:99]
ds_read_b128 a[16:19], v24 offset:55488
v_mfma_f32_16x16x32_bf16 v[112:115], a[76:79], a[48:51], v[112:115]
buffer_load_dwordx4 v6, s[24:27], s58 offen offset:1024 lds
v_mfma_f32_16x16x32_bf16 v[108:111], a[76:79], a[44:47], v[108:111]
ds_read_b64_tr_b16 a[28:29], v25 offset:50688
v_mul_f32 v165, 0x3a800000, v165
v_mfma_f32_16x16x32_bf16 v[92:95], a[72:75], a[44:47], v[92:95]
ds_read_b64_tr_b16 a[30:31], v25 offset:51200
v_mfma_f32_16x16x32_bf16 v[124:127], a[44:47], a[80:83], v[124:127]
s_add_u32 m0, s59, 91520
s_mov_b32 s58, 393216
v_fma_f32 v165, -v164, v164, v165
v_mfma_f32_16x16x32_bf16 v[140:143], a[44:47], a[84:87], v[140:143]
buffer_load_dwordx4 v5, s[24:27], s58 offen lds
v_mfma_f32_16x16x32_bf16 v[144:147], a[48:51], a[84:87], v[144:147]
ds_read_b64_tr_b16 a[32:33], v25 offset:50720
v_mfma_f32_16x16x32_bf16 v[128:131], a[48:51], a[80:83], v[128:131]
ds_read_b64_tr_b16 a[34:35], v25 offset:51232
v_max_f32 v165, 0, v165
v_mfma_f32_16x16x32_bf16 v[132:135], a[52:55], a[80:83], v[132:135]
ds_read_b64_tr_b16 a[36:37], v25 offset:51712
v_mfma_f32_16x16x32_bf16 v[148:151], a[52:55], a[84:87], v[148:151]
buffer_load_dwordx4 v6, s[24:27], s58 offen offset:1024 lds
v_mfma_f32_16x16x32_bf16 v[152:155], a[56:59], a[84:87], v[152:155]
ds_read_b64_tr_b16 a[38:39], v25 offset:52224
v_add_f32 v165, 0x3727c5ac, v165
v_mfma_f32_16x16x32_bf16 v[136:139], a[56:59], a[80:83], v[136:139]
ds_read_b64_tr_b16 a[40:41], v25 offset:51744
v_mfma_f32_16x16x32_bf16 v[156:159], a[60:63], a[80:83], v[156:159]
ds_read_b64_tr_b16 a[42:43], v25 offset:52256
v_mfma_f32_16x16x32_bf16 v[160:163], a[60:63], a[84:87], v[160:163]
s_waitcnt vmcnt(18) lgkmcnt(8)
s_barrier
v_mfma_f32_16x16x32_bf16 v[60:63], a[20:23], a[0:3], v[60:63]
ds_read_b128 a[44:47], v30 offset:55488
v_rsq_f32 v166, v165
v_mfma_f32_16x16x32_bf16 v[76:79], a[24:27], a[0:3], v[76:79]
s_add_u32 m0, s59, 99840
s_mov_b32 s58, 524288
v_mfma_f32_16x16x32_bf16 v[80:83], a[24:27], a[4:7], v[80:83]
buffer_load_dwordx4 v5, s[24:27], s58 offen lds
v_mfma_f32_16x16x32_bf16 v[64:67], a[20:23], a[4:7], v[64:67]
ds_read_b128 a[48:51], v30 offset:57792
v_mfma_f32_16x16x32_bf16 v[68:71], a[20:23], a[8:11], v[68:71]
ds_read_b128 a[52:55], v30 offset:60096
v_mfma_f32_16x16x32_bf16 v[84:87], a[24:27], a[8:11], v[84:87]
ds_read_b128 a[56:59], v30 offset:62400
v_mov_b32 v165, v166
v_mfma_f32_16x16x32_bf16 v[88:91], a[24:27], a[12:15], v[88:91]
ds_read_b64_tr_b16 a[64:65], v25 offset:62080
v_mfma_f32_16x16x32_bf16 v[72:75], a[20:23], a[12:15], v[72:75]
ds_read_b64_tr_b16 a[66:67], v25 offset:62592
s_waitcnt lgkmcnt(6)
v_mfma_f32_16x16x32_bf16 v[244:247], a[24:27], a[16:19], v[244:247]
buffer_load_dwordx4 v6, s[24:27], s58 offen offset:1024 lds
v_mfma_f32_16x16x32_bf16 v[104:107], a[28:31], a[12:15], v[104:107]
v_mfma_f32_16x16x32_bf16 v[120:123], a[32:35], a[12:15], v[120:123]
ds_read_b64_tr_b16 a[68:69], v25 offset:62112
v_mul_f32 v166, 0x3e8293ee, v166
v_mfma_f32_16x16x32_bf16 v[116:119], a[32:35], a[8:11], v[116:119]
ds_read_b64_tr_b16 a[70:71], v25 offset:62624
v_mfma_f32_16x16x32_bf16 v[100:103], a[28:31], a[8:11], v[100:103]
ds_read_b128 a[60:63], v31 offset:55488
v_mfma_f32_16x16x32_bf16 v[96:99], a[28:31], a[4:7], v[96:99]
s_add_u32 m0, s59, 108160
s_mov_b32 s58, 655360
v_mfma_f32_16x16x32_bf16 v[112:115], a[32:35], a[4:7], v[112:115]
buffer_load_dwordx4 v5, s[24:27], s58 offen lds
v_mfma_f32_16x16x32_bf16 v[108:111], a[32:35], a[0:3], v[108:111]
ds_read_b64_tr_b16 a[72:73], v25 offset:63104
ds_write_b128 v7, v[164:167]
v_mfma_f32_16x16x32_bf16 v[92:95], a[28:31], a[0:3], v[92:95]
ds_read_b64_tr_b16 a[74:75], v25 offset:63616
v_mfma_f32_16x16x32_bf16 v[124:127], a[0:3], a[36:39], v[124:127]
ds_read_b64_tr_b16 a[76:77], v25 offset:63136
v_mfma_f32_16x16x32_bf16 v[140:143], a[0:3], a[40:43], v[140:143]
ds_write_b32 v17, v164
v_mfma_f32_16x16x32_bf16 v[144:147], a[4:7], a[40:43], v[144:147]
ds_read_b64_tr_b16 a[78:79], v25 offset:63648
v_mfma_f32_16x16x32_bf16 v[128:131], a[4:7], a[36:39], v[128:131]
buffer_load_dwordx4 v6, s[24:27], s58 offen offset:1024 lds
v_mfma_f32_16x16x32_bf16 v[132:135], a[8:11], a[36:39], v[132:135]
ds_read_b64_tr_b16 a[80:81], v25 offset:64128
v_mfma_f32_16x16x32_bf16 v[148:151], a[8:11], a[40:43], v[148:151]
ds_read_b64_tr_b16 a[82:83], v25 offset:64640
v_mfma_f32_16x16x32_bf16 v[152:155], a[12:15], a[40:43], v[152:155]
ds_read_b64_tr_b16 a[84:85], v25 offset:64160
ds_write_b32 v17, v165 offset:1024
v_mfma_f32_16x16x32_bf16 v[136:139], a[12:15], a[36:39], v[136:139]
ds_read_b64_tr_b16 a[86:87], v25 offset:64672
v_mfma_f32_16x16x32_bf16 v[156:159], a[16:19], a[36:39], v[156:159]
v_mfma_f32_16x16x32_bf16 v[160:163], a[16:19], a[40:43], v[160:163]
s_waitcnt lgkmcnt(0)
s_barrier
v_mfma_f32_16x16x32_bf16 v[244:247], a[68:71], a[60:63], v[244:247]
ds_read_b128 v[232:235], v10 offset:1792
v_mfma_f32_16x16x32_bf16 v[156:159], a[60:63], a[80:83], v[156:159]
ds_read_b128 v[228:231], v10 offset:1536
v_mfma_f32_16x16x32_bf16 v[160:163], a[60:63], a[84:87], v[160:163]
ds_read_b128 v[224:227], v10 offset:1280
v_mfma_f32_16x16x32_bf16 v[104:107], a[72:75], a[56:59], v[104:107]
ds_read_b128 v[220:223], v10 offset:1024
v_mfma_f32_16x16x32_bf16 v[120:123], a[76:79], a[56:59], v[120:123]
v_mfma_f32_16x16x32_bf16 v[136:139], a[56:59], a[80:83], v[136:139]
v_mfma_f32_16x16x32_bf16 v[152:155], a[56:59], a[84:87], v[152:155]
v_mfma_f32_16x16x32_bf16 v[100:103], a[72:75], a[52:55], v[100:103]
v_mfma_f32_16x16x32_bf16 v[116:119], a[76:79], a[52:55], v[116:119]
s_mov_b32 exec_lo, 0x10001
s_mov_b32 exec_hi, 0x10001
ds_write_b128 v13, v[244:247] offset:64
s_mov_b64 exec, 0xffff
ds_write_b32 v12, v156 offset:512
ds_write_b32 v12, v160 offset:576
s_mov_b64 exec, -1
v_mfma_f32_16x16x32_bf16 v[96:99], a[72:75], a[48:51], v[96:99]
v_mfma_f32_16x16x32_bf16 v[112:115], a[76:79], a[48:51], v[112:115]
v_mfma_f32_16x16x32_bf16 v[92:95], a[72:75], a[44:47], v[92:95]
v_mfma_f32_16x16x32_bf16 v[108:111], a[76:79], a[44:47], v[108:111]
v_mfma_f32_16x16x32_bf16 v[72:75], a[64:67], a[56:59], v[72:75]
v_mfma_f32_16x16x32_bf16 v[88:91], a[68:71], a[56:59], v[88:91]
s_waitcnt lgkmcnt(0)
s_barrier
v_mfma_f32_16x16x32_bf16 v[132:135], a[52:55], a[80:83], v[132:135]
ds_read_b128 v[28:31], v13
s_add_u32 m0, s59, 49920
v_mfma_f32_16x16x32_bf16 v[148:151], a[52:55], a[84:87], v[148:151]
ds_read_b128 v[32:35], v13 offset:64
s_mov_b32 s58, 1835008
v_mfma_f32_16x16x32_bf16 v[68:71], a[64:67], a[52:55], v[68:71]
ds_read_b128 v[36:39], v13 offset:256
v_mfma_f32_16x16x32_bf16 v[84:87], a[68:71], a[52:55], v[84:87]
ds_read_b128 v[40:43], v13 offset:320
v_mfma_f32_16x16x32_bf16 v[128:131], a[48:51], a[80:83], v[128:131]
ds_read_b32 v44, v12 offset:512
v_mfma_f32_16x16x32_bf16 v[144:147], a[48:51], a[84:87], v[144:147]
ds_read_b32 v45, v12 offset:576
v_mfma_f32_16x16x32_bf16 v[64:67], a[64:67], a[48:51], v[64:67]
ds_read_b128 v[240:243], v11 offset:704
v_mfma_f32_16x16x32_bf16 v[80:83], a[68:71], a[48:51], v[80:83]
ds_read_b128 v[244:247], v11 offset:1728
v_mfma_f32_16x16x32_bf16 v[124:127], a[44:47], a[80:83], v[124:127]
buffer_load_dwordx4 v5, s[24:27], s58 offen lds
ds_read_b128 v[18:21], v11 offset:448
s_waitcnt lgkmcnt(8)
v_pk_fma_f32 v[72:73], v[28:29], v[232:233], v[72:73] op_sel_hi:[1,0,1]
v_pk_fma_f32 v[74:75], v[30:31], v[232:233], v[74:75] op_sel_hi:[1,0,1]
s_waitcnt lgkmcnt(6)
v_pk_fma_f32 v[104:105], v[36:37], v[232:233], v[104:105] op_sel_hi:[1,0,1]
v_pk_mul_f32 v[104:105], v[104:105], v[232:233] op_sel:[0,1] op_sel_hi:[1,1]
v_pk_fma_f32 v[106:107], v[38:39], v[232:233], v[106:107] op_sel_hi:[1,0,1]
v_pk_mul_f32 v[106:107], v[106:107], v[232:233] op_sel:[0,1] op_sel_hi:[1,1]
s_waitcnt lgkmcnt(5)
v_pk_fma_f32 v[120:121], v[40:41], v[232:233], v[120:121] op_sel_hi:[1,0,1]
v_pk_mul_f32 v[120:121], v[120:121], v[232:233] op_sel:[0,1] op_sel_hi:[1,1]
v_pk_fma_f32 v[122:123], v[42:43], v[232:233], v[122:123] op_sel_hi:[1,0,1]
v_pk_mul_f32 v[122:123], v[122:123], v[232:233] op_sel:[0,1] op_sel_hi:[1,1]
v_pk_fma_f32 v[100:101], v[36:37], v[228:229], v[100:101] op_sel_hi:[1,0,1]
v_pk_mul_f32 v[100:101], v[100:101], v[228:229] op_sel:[0,1] op_sel_hi:[1,1]
v_pk_fma_f32 v[102:103], v[38:39], v[228:229], v[102:103] op_sel_hi:[1,0,1]
v_pk_mul_f32 v[102:103], v[102:103], v[228:229] op_sel:[0,1] op_sel_hi:[1,1]
v_pk_fma_f32 v[116:117], v[40:41], v[228:229], v[116:117] op_sel_hi:[1,0,1]
v_pk_mul_f32 v[116:117], v[116:117], v[228:229] op_sel:[0,1] op_sel_hi:[1,1]
v_pk_fma_f32 v[118:119], v[42:43], v[228:229], v[118:119] op_sel_hi:[1,0,1]
v_pk_mul_f32 v[118:119], v[118:119], v[228:229] op_sel:[0,1] op_sel_hi:[1,1]
s_waitcnt lgkmcnt(2)
v_pk_fma_f32 v[156:157], v[240:241], v[44:45], v[156:157] op_sel_hi:[1,0,1]
v_pk_fma_f32 v[158:159], v[242:243], v[44:45], v[158:159] op_sel_hi:[1,0,1]
v_pk_fma_f32 v[160:161], v[240:241], v[44:45], v[160:161] op_sel:[0,1,0] op_sel_hi:[1,1,1]
v_pk_fma_f32 v[162:163], v[242:243], v[44:45], v[162:163] op_sel:[0,1,0] op_sel_hi:[1,1,1]
s_waitcnt lgkmcnt(1)
v_pk_mul_f32 v[156:157], v[156:157], v[244:245]
v_pk_mul_f32 v[158:159], v[158:159], v[246:247]
v_pk_mul_f32 v[160:161], v[160:161], v[244:245]
v_pk_mul_f32 v[162:163], v[162:163], v[246:247]
v_pk_fma_f32 v[88:89], v[32:33], v[232:233], v[88:89] op_sel_hi:[1,0,1]
v_pk_fma_f32 v[90:91], v[34:35], v[232:233], v[90:91] op_sel_hi:[1,0,1]
v_pk_fma_f32 v[96:97], v[36:37], v[224:225], v[96:97] op_sel_hi:[1,0,1]
s_waitcnt lgkmcnt(0)
v_pk_fma_f32 v[136:137], v[18:19], v[44:45], v[136:137] op_sel_hi:[1,0,1]
v_pk_fma_f32 v[138:139], v[20:21], v[44:45], v[138:139] op_sel_hi:[1,0,1]
v_pk_fma_f32 v[152:153], v[18:19], v[44:45], v[152:153] op_sel:[0,1,0] op_sel_hi:[1,1,1]
v_pk_fma_f32 v[154:155], v[20:21], v[44:45], v[154:155] op_sel:[0,1,0] op_sel_hi:[1,1,1]
v_pk_mul_f32 v[96:97], v[96:97], v[224:225] op_sel:[0,1] op_sel_hi:[1,1]
v_pk_fma_f32 v[98:99], v[38:39], v[224:225], v[98:99] op_sel_hi:[1,0,1]
v_pk_mul_f32 v[98:99], v[98:99], v[224:225] op_sel:[0,1] op_sel_hi:[1,1]
v_pk_fma_f32 v[112:113], v[40:41], v[224:225], v[112:113] op_sel_hi:[1,0,1]
v_pk_mul_f32 v[112:113], v[112:113], v[224:225] op_sel:[0,1] op_sel_hi:[1,1]
v_pk_fma_f32 v[114:115], v[42:43], v[224:225], v[114:115] op_sel_hi:[1,0,1]
v_pk_mul_f32 v[114:115], v[114:115], v[224:225] op_sel:[0,1] op_sel_hi:[1,1]
v_pk_fma_f32 v[68:69], v[28:29], v[228:229], v[68:69] op_sel_hi:[1,0,1]
v_pk_fma_f32 v[70:71], v[30:31], v[228:229], v[70:71] op_sel_hi:[1,0,1]
v_pk_fma_f32 v[84:85], v[32:33], v[228:229], v[84:85] op_sel_hi:[1,0,1]
v_pk_fma_f32 v[86:87], v[34:35], v[228:229], v[86:87] op_sel_hi:[1,0,1]
v_pk_fma_f32 v[92:93], v[36:37], v[220:221], v[92:93] op_sel_hi:[1,0,1]
v_pk_mul_f32 v[92:93], v[92:93], v[220:221] op_sel:[0,1] op_sel_hi:[1,1]
v_pk_fma_f32 v[94:95], v[38:39], v[220:221], v[94:95] op_sel_hi:[1,0,1]
v_pk_mul_f32 v[94:95], v[94:95], v[220:221] op_sel:[0,1] op_sel_hi:[1,1]
v_pk_fma_f32 v[108:109], v[40:41], v[220:221], v[108:109] op_sel_hi:[1,0,1]
v_pk_mul_f32 v[108:109], v[108:109], v[220:221] op_sel:[0,1] op_sel_hi:[1,1]
v_pk_fma_f32 v[110:111], v[42:43], v[220:221], v[110:111] op_sel_hi:[1,0,1]
v_pk_mul_f32 v[110:111], v[110:111], v[220:221] op_sel:[0,1] op_sel_hi:[1,1]
v_pk_fma_f32 v[64:65], v[28:29], v[224:225], v[64:65] op_sel_hi:[1,0,1]
v_pk_fma_f32 v[66:67], v[30:31], v[224:225], v[66:67] op_sel_hi:[1,0,1]
v_pk_fma_f32 v[80:81], v[32:33], v[224:225], v[80:81] op_sel_hi:[1,0,1]
v_pk_fma_f32 v[82:83], v[34:35], v[224:225], v[82:83] op_sel_hi:[1,0,1]
v_cvt_pk_bf16_f32 v236, v156, v157
v_cvt_pk_bf16_f32 v237, v158, v159
v_mfma_f32_16x16x32_bf16 v[140:143], a[44:47], a[84:87], v[140:143]
buffer_load_dwordx4 v6, s[24:27], s58 offen offset:1024 lds
v_mfma_f32_16x16x32_bf16 v[60:63], a[64:67], a[44:47], v[60:63]
s_add_u32 m0, s59, 58240
v_cvt_pk_bf16_f32 v238, v160, v161
v_cvt_pk_bf16_f32 v239, v162, v163
v_mfma_f32_16x16x32_bf16 v[76:79], a[68:71], a[44:47], v[76:79]
ds_write_b128 v8, v[236:239] offset:1024
s_mov_b32 s58, 1966080
v_cvt_pk_bf16_f32 v196, v104, v105
v_cvt_pk_bf16_f32 v197, v106, v107
v_cvt_pk_bf16_f32 v198, v120, v121
v_cvt_pk_bf16_f32 v199, v122, v123
ds_read_b128 v[22:25], v11 offset:1472
buffer_load_dwordx4 v5, s[24:27], s58 offen lds
v_cvt_pk_bf16_f32 v192, v100, v101
v_cvt_pk_bf16_f32 v193, v102, v103
v_cvt_pk_bf16_f32 v194, v116, v117
v_cvt_pk_bf16_f32 v195, v118, v119
v_cvt_pk_bf16_f32 v176, v72, v73
v_cvt_pk_bf16_f32 v177, v74, v75
v_cvt_pk_bf16_f32 v178, v88, v89
v_cvt_pk_bf16_f32 v179, v90, v91
v_pk_fma_f32 v[60:61], v[28:29], v[220:221], v[60:61] op_sel_hi:[1,0,1]
v_pk_fma_f32 v[62:63], v[30:31], v[220:221], v[62:63] op_sel_hi:[1,0,1]
v_pk_fma_f32 v[76:77], v[32:33], v[220:221], v[76:77] op_sel_hi:[1,0,1]
v_pk_fma_f32 v[78:79], v[34:35], v[220:221], v[78:79] op_sel_hi:[1,0,1]
ds_read_b128 v[240:243], v11 offset:384
s_nop 0
v_mfma_f32_16x16x32_bf16 v[104:107], v[192:195], v[176:179], v[46:49]
buffer_load_dwordx4 v6, s[24:27], s58 offen offset:1024 lds
v_mfma_f32_16x16x32_bf16 v[120:123], v[196:199], v[176:179], v[50:53]
s_add_u32 m0, s59, 66560
s_waitcnt lgkmcnt(2)
s_barrier
ds_read_b128 v[180:183], v9
ds_read_b64 v[200:201], v9 offset:1024
ds_read_b64 v[210:211], v9 offset:1032
s_mov_b32 s58, 0
s_waitcnt lgkmcnt(4)
v_pk_mul_f32 v[136:137], v[136:137], v[22:23]
v_cvt_pk_bf16_f32 v208, v136, v137
v_pk_mul_f32 v[138:139], v[138:139], v[24:25]
buffer_load_dwordx4 v5, s[24:27], s58 offen lds
v_cvt_pk_bf16_f32 v209, v138, v139
v_pk_mul_f32 v[152:153], v[152:153], v[22:23]
v_cvt_pk_bf16_f32 v218, v152, v153
v_pk_mul_f32 v[154:155], v[154:155], v[24:25]
v_cvt_pk_bf16_f32 v219, v154, v155
ds_read_b128 v[244:247], v11 offset:1408
v_max3_f32 v88, v104, v105, v106
v_max3_f32 v89, v107, v120, v121
v_max3_f32 v88, v88, v122, v123
s_waitcnt lgkmcnt(4)
v_pk_fma_f32 v[132:133], v[240:241], v[44:45], v[132:133] op_sel_hi:[1,0,1]
v_pk_fma_f32 v[134:135], v[242:243], v[44:45], v[134:135] op_sel_hi:[1,0,1]
v_pk_fma_f32 v[148:149], v[240:241], v[44:45], v[148:149] op_sel:[0,1,0] op_sel_hi:[1,1,1]
buffer_load_dwordx4 v6, s[24:27], s58 offen offset:1024 lds
s_add_u32 m0, s59, 116480
s_mov_b32 s58, 786432
v_pk_fma_f32 v[150:151], v[242:243], v[44:45], v[150:151] op_sel:[0,1,0] op_sel_hi:[1,1,1]
v_max_f32 v90, v88, v89
v_max_f32 v89, v88, v89
v_cvt_pk_bf16_f32 v188, v96, v97
v_cvt_pk_bf16_f32 v189, v98, v99
v_permlane16_swap_b32 v90, v89
v_cvt_pk_bf16_f32 v190, v112, v113
v_max_f32 v88, v90, v89
v_max_f32 v89, v90, v89
v_cvt_pk_bf16_f32 v191, v114, v115
buffer_load_dwordx4 v5, s[24:27], s58 offen lds
v_permlane32_swap_b32 v88, v89
v_cvt_pk_bf16_f32 v172, v68, v69
v_max_f32 v88, v88, v89
v_mul_f32 v88, v88, v234
s_waitcnt lgkmcnt(0)
v_pk_mul_f32 v[132:133], v[132:133], v[244:245]
v_cvt_pk_bf16_f32 v206, v132, v133
v_pk_mul_f32 v[134:135], v[134:135], v[246:247]
v_cvt_pk_bf16_f32 v207, v134, v135
v_pk_mul_f32 v[148:149], v[148:149], v[244:245]
v_cvt_pk_bf16_f32 v216, v148, v149
v_pk_mul_f32 v[150:151], v[150:151], v[246:247]
v_cvt_pk_bf16_f32 v217, v150, v151
buffer_load_dwordx4 v6, s[24:27], s58 offen offset:1024 lds
s_add_u32 m0, s59, 124800
s_mov_b32 s58, 917504
v_pk_fma_f32 v[104:105], v[104:105], v[234:235], v[88:89] op_sel_hi:[1,0,0] neg_lo:[0,0,1] neg_hi:[0,0,1]
v_pk_fma_f32 v[106:107], v[106:107], v[234:235], v[88:89] op_sel_hi:[1,0,0] neg_lo:[0,0,1] neg_hi:[0,0,1]
v_pk_fma_f32 v[120:121], v[120:121], v[234:235], v[88:89] op_sel_hi:[1,0,0] neg_lo:[0,0,1] neg_hi:[0,0,1]
v_pk_fma_f32 v[122:123], v[122:123], v[234:235], v[88:89] op_sel_hi:[1,0,0] neg_lo:[0,0,1] neg_hi:[0,0,1]
v_exp_f32 v104, v104
v_exp_f32 v105, v105
v_exp_f32 v106, v106
v_exp_f32 v107, v107
v_exp_f32 v120, v120
v_exp_f32 v121, v121
v_exp_f32 v122, v122
v_exp_f32 v123, v123
v_cvt_pk_bf16_f32 v72, v104, v105
buffer_load_dwordx4 v5, s[24:27], s58 offen lds
v_cvt_pk_bf16_f32 v73, v106, v107
v_cvt_pk_bf16_f32 v74, v120, v121
v_cvt_pk_bf16_f32 v75, v122, v123
v_cvt_pk_bf16_f32 v173, v70, v71
v_cvt_pk_bf16_f32 v174, v84, v85
v_mfma_f32_16x16x32_bf16 v[88:91], v[248:251], v[72:75], 0
ds_read_b128 v[18:21], v11 offset:320
v_cvt_pk_bf16_f32 v175, v86, v87
v_mfma_f32_16x16x32_bf16 v[104:107], v[206:209], v[72:75], 0
ds_read_b128 v[22:25], v11 offset:1344
v_cvt_pk_bf16_f32 v184, v92, v93
v_mfma_f32_16x16x32_bf16 v[120:123], v[216:219], v[72:75], 0
buffer_load_dwordx4 v6, s[24:27], s58 offen offset:1024 lds
v_mfma_f32_16x16x32_bf16 v[100:103], v[188:191], v[172:175], v[46:49]
ds_read_b128 v[240:243], v11 offset:256
v_rcp_f32 v88, v88
v_mfma_f32_16x16x32_bf16 v[116:119], v[192:195], v[172:175], v[50:53]
ds_read_b128 v[244:247], v11 offset:1280
v_cvt_pk_bf16_f32 v185, v94, v95
s_nop 2
v_max3_f32 v84, v100, v101, v102
v_cvt_pk_bf16_f32 v186, v108, v109
v_cvt_pk_bf16_f32 v187, v110, v111
v_pk_mul_f32 v[104:105], v[104:105], v[88:89] op_sel_hi:[1,0]
v_pk_mul_f32 v[106:107], v[106:107], v[88:89] op_sel_hi:[1,0]
v_pk_mul_f32 v[120:121], v[120:121], v[88:89] op_sel_hi:[1,0]
v_pk_mul_f32 v[122:123], v[122:123], v[88:89] op_sel_hi:[1,0]
v_cvt_pk_bf16_f32 v176, v104, v105
v_cvt_pk_bf16_f32 v177, v106, v107
v_cvt_pk_bf16_f32 v178, v120, v121
v_cvt_pk_bf16_f32 v179, v122, v123
buffer_store_dwordx4 v[176:179], v4, s[16:19], s74 offen offset:3072 sc1
s_waitcnt lgkmcnt(3)
v_pk_fma_f32 v[128:129], v[18:19], v[44:45], v[128:129] op_sel_hi:[1,0,1]
v_pk_fma_f32 v[130:131], v[20:21], v[44:45], v[130:131] op_sel_hi:[1,0,1]
s_waitcnt lgkmcnt(2)
v_pk_mul_f32 v[128:129], v[128:129], v[22:23]
v_cvt_pk_bf16_f32 v204, v128, v129
v_pk_mul_f32 v[130:131], v[130:131], v[24:25]
v_cvt_pk_bf16_f32 v205, v130, v131
v_pk_fma_f32 v[144:145], v[18:19], v[44:45], v[144:145] op_sel:[0,1,0] op_sel_hi:[1,1,1]
v_pk_mul_f32 v[144:145], v[144:145], v[22:23]
v_cvt_pk_bf16_f32 v214, v144, v145
v_pk_fma_f32 v[146:147], v[20:21], v[44:45], v[146:147] op_sel:[0,1,0] op_sel_hi:[1,1,1]
v_pk_mul_f32 v[146:147], v[146:147], v[24:25]
v_cvt_pk_bf16_f32 v215, v146, v147
v_max3_f32 v85, v103, v116, v117
v_max3_f32 v84, v84, v118, v119
v_max_f32 v86, v84, v85
v_max_f32 v85, v84, v85
v_cvt_pk_bf16_f32 v168, v64, v65
v_cvt_pk_bf16_f32 v169, v66, v67
v_permlane16_swap_b32 v86, v85
v_cvt_pk_bf16_f32 v170, v80, v81
v_max_f32 v84, v86, v85
v_max_f32 v85, v86, v85
v_cvt_pk_bf16_f32 v171, v82, v83
s_waitcnt lgkmcnt(1)
v_pk_fma_f32 v[124:125], v[240:241], v[44:45], v[124:125] op_sel_hi:[1,0,1]
s_waitcnt lgkmcnt(0)
v_pk_mul_f32 v[124:125], v[124:125], v[244:245]
v_pk_fma_f32 v[126:127], v[242:243], v[44:45], v[126:127] op_sel_hi:[1,0,1]
v_pk_mul_f32 v[126:127], v[126:127], v[246:247]
v_pk_fma_f32 v[140:141], v[240:241], v[44:45], v[140:141] op_sel:[0,1,0] op_sel_hi:[1,1,1]
v_pk_mul_f32 v[140:141], v[140:141], v[244:245]
v_pk_fma_f32 v[142:143], v[242:243], v[44:45], v[142:143] op_sel:[0,1,0] op_sel_hi:[1,1,1]
v_pk_mul_f32 v[142:143], v[142:143], v[246:247]
v_permlane32_swap_b32 v84, v85
s_nop 0
v_mfma_f32_16x16x32_bf16 v[96:99], v[184:187], v[168:171], v[46:49]
v_max_f32 v84, v84, v85
v_mul_f32 v84, v84, v230
v_mfma_f32_16x16x32_bf16 v[112:115], v[188:191], v[168:171], v[50:53]
v_cvt_pk_bf16_f32 v202, v124, v125
v_cvt_pk_bf16_f32 v203, v126, v127
v_cvt_pk_bf16_f32 v212, v140, v141
v_cvt_pk_bf16_f32 v213, v142, v143
s_nop 0
v_max3_f32 v80, v96, v97, v98
v_pk_fma_f32 v[100:101], v[100:101], v[230:231], v[84:85] op_sel_hi:[1,0,0] neg_lo:[0,0,1] neg_hi:[0,0,1]
v_pk_fma_f32 v[102:103], v[102:103], v[230:231], v[84:85] op_sel_hi:[1,0,0] neg_lo:[0,0,1] neg_hi:[0,0,1]
v_pk_fma_f32 v[116:117], v[116:117], v[230:231], v[84:85] op_sel_hi:[1,0,0] neg_lo:[0,0,1] neg_hi:[0,0,1]
v_pk_fma_f32 v[118:119], v[118:119], v[230:231], v[84:85] op_sel_hi:[1,0,0] neg_lo:[0,0,1] neg_hi:[0,0,1]
v_exp_f32 v100, v100
v_exp_f32 v101, v101
v_exp_f32 v102, v102
v_exp_f32 v103, v103
v_exp_f32 v116, v116
v_exp_f32 v117, v117
v_exp_f32 v118, v118
v_exp_f32 v119, v119
v_cvt_pk_bf16_f32 v68, v100, v101
v_cvt_pk_bf16_f32 v69, v102, v103
v_cvt_pk_bf16_f32 v70, v116, v117
v_cvt_pk_bf16_f32 v71, v118, v119
v_max3_f32 v81, v99, v112, v113
v_max3_f32 v80, v80, v114, v115
v_mfma_f32_16x16x32_bf16 v[84:87], v[248:251], v[68:71], 0
v_max_f32 v82, v80, v81
v_max_f32 v81, v80, v81
v_mfma_f32_16x16x32_bf16 v[100:103], v[204:207], v[68:71], 0
s_nop 0
v_permlane16_swap_b32 v82, v81
v_mfma_f32_16x16x32_bf16 v[116:119], v[214:217], v[68:71], 0
s_nop 1
v_rcp_f32 v84, v84
v_max_f32 v80, v82, v81
v_max_f32 v81, v82, v81
v_cvt_pk_bf16_f32 v164, v60, v61
v_pk_mul_f32 v[100:101], v[100:101], v[84:85] op_sel_hi:[1,0]
v_pk_mul_f32 v[102:103], v[102:103], v[84:85] op_sel_hi:[1,0]
v_pk_mul_f32 v[116:117], v[116:117], v[84:85] op_sel_hi:[1,0]
v_pk_mul_f32 v[118:119], v[118:119], v[84:85] op_sel_hi:[1,0]
v_cvt_pk_bf16_f32 v172, v100, v101
v_cvt_pk_bf16_f32 v173, v102, v103
v_cvt_pk_bf16_f32 v174, v116, v117
v_cvt_pk_bf16_f32 v175, v118, v119
buffer_store_dwordx4 v[172:175], v4, s[16:19], s74 offen offset:2048 sc1
v_permlane32_swap_b32 v80, v81
v_cvt_pk_bf16_f32 v165, v62, v63
v_max_f32 v80, v80, v81
v_mul_f32 v80, v80, v226
v_pk_fma_f32 v[96:97], v[96:97], v[226:227], v[80:81] op_sel_hi:[1,0,0] neg_lo:[0,0,1] neg_hi:[0,0,1]
v_pk_fma_f32 v[98:99], v[98:99], v[226:227], v[80:81] op_sel_hi:[1,0,0] neg_lo:[0,0,1] neg_hi:[0,0,1]
v_pk_fma_f32 v[112:113], v[112:113], v[226:227], v[80:81] op_sel_hi:[1,0,0] neg_lo:[0,0,1] neg_hi:[0,0,1]
v_pk_fma_f32 v[114:115], v[114:115], v[226:227], v[80:81] op_sel_hi:[1,0,0] neg_lo:[0,0,1] neg_hi:[0,0,1]
v_exp_f32 v96, v96
v_exp_f32 v97, v97
v_exp_f32 v98, v98
v_exp_f32 v99, v99
v_exp_f32 v112, v112
v_exp_f32 v113, v113
v_exp_f32 v114, v114
v_exp_f32 v115, v115
v_cvt_pk_bf16_f32 v64, v96, v97
v_cvt_pk_bf16_f32 v65, v98, v99
v_cvt_pk_bf16_f32 v66, v112, v113
v_cvt_pk_bf16_f32 v67, v114, v115
v_cvt_pk_bf16_f32 v166, v76, v77
v_cvt_pk_bf16_f32 v167, v78, v79
v_mfma_f32_16x16x32_bf16 v[80:83], v[248:251], v[64:67], 0
v_mfma_f32_16x16x32_bf16 v[96:99], v[202:205], v[64:67], 0
v_mfma_f32_16x16x32_bf16 v[112:115], v[212:215], v[64:67], 0
s_nop 5
v_rcp_f32 v80, v80
v_mfma_f32_16x16x32_bf16 v[92:95], v[180:183], v[164:167], v[46:49]
v_mfma_f32_16x16x32_bf16 v[108:111], v[184:187], v[164:167], v[50:53]
s_nop 6
v_max3_f32 v76, v92, v93, v94
v_pk_mul_f32 v[96:97], v[96:97], v[80:81] op_sel_hi:[1,0]
v_pk_mul_f32 v[98:99], v[98:99], v[80:81] op_sel_hi:[1,0]
v_pk_mul_f32 v[112:113], v[112:113], v[80:81] op_sel_hi:[1,0]
v_pk_mul_f32 v[114:115], v[114:115], v[80:81] op_sel_hi:[1,0]
v_cvt_pk_bf16_f32 v168, v96, v97
v_cvt_pk_bf16_f32 v169, v98, v99
v_cvt_pk_bf16_f32 v170, v112, v113
v_cvt_pk_bf16_f32 v171, v114, v115
buffer_store_dwordx4 v[168:171], v4, s[16:19], s74 offen offset:1024 sc1
v_max3_f32 v77, v95, v108, v109
v_max3_f32 v76, v76, v110, v111
v_max_f32 v78, v76, v77
v_max_f32 v77, v76, v77
s_nop 1
v_permlane16_swap_b32 v78, v77
v_max_f32 v76, v78, v77
v_max_f32 v77, v78, v77
s_nop 1
v_permlane32_swap_b32 v76, v77
v_max_f32 v76, v76, v77
v_mul_f32 v76, v76, v222
v_pk_fma_f32 v[92:93], v[92:93], v[222:223], v[76:77] op_sel_hi:[1,0,0] neg_lo:[0,0,1] neg_hi:[0,0,1]
v_pk_fma_f32 v[94:95], v[94:95], v[222:223], v[76:77] op_sel_hi:[1,0,0] neg_lo:[0,0,1] neg_hi:[0,0,1]
v_pk_fma_f32 v[108:109], v[108:109], v[222:223], v[76:77] op_sel_hi:[1,0,0] neg_lo:[0,0,1] neg_hi:[0,0,1]
v_pk_fma_f32 v[110:111], v[110:111], v[222:223], v[76:77] op_sel_hi:[1,0,0] neg_lo:[0,0,1] neg_hi:[0,0,1]
v_exp_f32 v92, v92
v_exp_f32 v93, v93
v_exp_f32 v94, v94
v_exp_f32 v95, v95
v_exp_f32 v108, v108
v_exp_f32 v109, v109
v_exp_f32 v110, v110
v_exp_f32 v111, v111
v_cvt_pk_bf16_f32 v60, v92, v93
v_cvt_pk_bf16_f32 v61, v94, v95
v_cvt_pk_bf16_f32 v62, v108, v109
v_cvt_pk_bf16_f32 v63, v110, v111
s_nop 1
v_mfma_f32_16x16x32_bf16 v[76:79], v[248:251], v[60:63], 0
v_mfma_f32_16x16x32_bf16 v[92:95], v[200:203], v[60:63], 0
v_mfma_f32_16x16x32_bf16 v[108:111], v[210:213], v[60:63], 0
s_nop 5
v_rcp_f32 v76, v76
s_nop 0
v_pk_mul_f32 v[92:93], v[92:93], v[76:77] op_sel_hi:[1,0]
v_pk_mul_f32 v[94:95], v[94:95], v[76:77] op_sel_hi:[1,0]
v_pk_mul_f32 v[108:109], v[108:109], v[76:77] op_sel_hi:[1,0]
v_pk_mul_f32 v[110:111], v[110:111], v[76:77] op_sel_hi:[1,0]
v_cvt_pk_bf16_f32 v164, v92, v93
v_cvt_pk_bf16_f32 v165, v94, v95
v_cvt_pk_bf16_f32 v166, v108, v109
v_cvt_pk_bf16_f32 v167, v110, v111
buffer_store_dwordx4 v[164:167], v4, s[16:19], s74 offen sc1
s_nop 1
.Lqkve3:
s_lshl_b32 s62, s6, 13
s_lshl_b32 s63, s3, 11
s_add_u32 s62, s62, s63
v_lshl_add_u32 v4, v1, 4, s62
v_lshrrev_b32 v2, 3, v1
v_cmp_eq_u32 vcc, 3, v2
v_add_u32 v2, 67108480, v4
s_nop 0
v_cndmask_b32 v4, v4, v2, vcc
v_bfe_u32 v5, v1, 3, 1
v_lshrrev_b32 v2, 4, v1
v_lshl_add_u32 v5, v2, 3, v5
s_lshl_b32 s62, s3, 1
v_add_u32 v5, s62, v5
v_mul_u32_u24 v5, 2048, v5
v_and_b32 v2, 7, v1
v_lshl_add_u32 v5, v2, 4, v5
s_lshl_b32 s62, s7, 7
v_add_u32 v5, s62, v5
v_add_u32 v6, 64512, v5
v_bfe_u32 v8, v1, 3, 2
v_mul_u32_u24 v8, 2080, v8
v_bfe_u32 v2, v1, 2, 1
v_lshl_add_u32 v8, v2, 7, v8
v_bfe_u32 v2, v1, 5, 1
v_lshl_add_u32 v8, v2, 8, v8
v_and_b32 v2, 3, v1
v_lshl_add_u32 v8, v2, 3, v8
s_mov_b32 s57, 66560
v_add_u32 v7, s57, v8
s_mov_b32 s52, 4194304
s_mov_b32 s53, 4325376
s_mov_b32 s54, 2097152
s_mul_i32 s56, s3, 2080
v_accvgpr_read_b32 v32, a224
v_accvgpr_read_b32 v33, a225
v_accvgpr_read_b32 v34, a226
v_accvgpr_read_b32 v35, a227
v_accvgpr_read_b32 v36, a228
v_accvgpr_read_b32 v37, a229
v_accvgpr_read_b32 v38, a230
v_accvgpr_read_b32 v39, a231
v_accvgpr_read_b32 v40, a232
v_accvgpr_read_b32 v41, a233
v_accvgpr_read_b32 v42, a234
v_accvgpr_read_b32 v43, a235
v_accvgpr_read_b32 v44, a236
v_accvgpr_read_b32 v45, a237
v_accvgpr_read_b32 v46, a238
v_accvgpr_read_b32 v47, a239
v_accvgpr_read_b32 v48, a240
v_accvgpr_read_b32 v49, a241
v_accvgpr_read_b32 v50, a242
v_accvgpr_read_b32 v51, a243
v_accvgpr_read_b32 v52, a244
v_accvgpr_read_b32 v53, a245
v_accvgpr_read_b32 v54, a246
v_accvgpr_read_b32 v55, a247
v_accvgpr_read_b32 v56, a248
v_accvgpr_read_b32 v57, a249
v_accvgpr_read_b32 v58, a250
v_accvgpr_read_b32 v59, a251
v_accvgpr_read_b32 v60, a252
v_accvgpr_read_b32 v61, a253
v_accvgpr_read_b32 v62, a254
v_accvgpr_read_b32 v63, a255
s_and_b32 s62, s3, 1
s_mul_i32 s62, s62, 28672
s_add_u32 s62, s62, s51
v_lshrrev_b32 v12, 4, v1
v_mul_u32_u24 v12, 57344, v12
v_and_b32 v2, 15, v1
v_lshl_add_u32 v12, v2, 4, v12
v_add_u32 v12, s62, v12
v_add_u32 v13, 6112, v12
v_add_u32 v14, 12224, v12
v_add_u32 v15, 18336, v12
s_mul_i32 s59, s3, 4224
s_mov_b32 s58, 0
s_mov_b32 s36, s82
s_mov_b32 s37, s83
s_lshl_b32 s62, s8, 10
s_add_u32 s62, s62, 30425088
s_lshl_b32 s64, s6, 10
s_add_u32 s64, s64, 30425088
s_lshr_b32 s67, s5, 2
s_and_b32 s67, s67, 3
s_lshl_b32 s67, s67, 7
s_add_u32 s64, s64, s67
v_lshl_add_u32 v252, v1, 7, s62
v_mov_b32 v253, s64
s_waitcnt vmcnt(0) lgkmcnt(0)
s_barrier
s_cmp_lg_u32 s3, 0
s_cbranch_scc1 .Lnosig32
v_mov_b32 v255, 1
s_mov_b64 exec, 15
buffer_atomic_add v255, v252, s[16:19], 0 offen
s_mov_b64 exec, -1
.Lnosig32:
s_cmp_lg_u32 s3, 1
s_cbranch_scc1 .Lnopoll35
s_mov_b64 exec, 1
s_mov_b32 s15, 0
s_mov_b64 exec, 1
v_mov_b32 v254, 0
buffer_atomic_add v254, v253, s[16:19], 0 offen sc0
.Lpoll33:
s_waitcnt vmcnt(0)
v_cmp_ne_u32 vcc, 16, v254
s_add_u32 s15, s15, 1
s_cbranch_vccz .Lnopoll35r
s_mov_b64 exec, 1
v_mov_b32 v254, 0
buffer_atomic_add v254, v253, s[16:19], 0 offen sc0
s_cmp_le_u32 s15, 100000
s_cbranch_scc1 .Lpoll33
.Lgot34:
s_waitcnt vmcnt(0)
s_branch .Lnopoll35r
.Lnopoll35:
s_mov_b64 exec, 0
s_cmp_eq_u32 s3, 2
s_cbranch_scc1 .Lpad1
s_cmp_eq_u32 s3, 3
s_cbranch_scc1 .Lnopoll35r
s_branch .Lnopoll35r
.Lnopoll35r:
s_mov_b64 exec, -1
s_barrier
buffer_load_dwordx4 v[64:67], v4, s[16:19], s52 offen sc1
buffer_load_dwordx4 v[68:71], v4, s[16:19], s52 offen offset:1024 sc1
s_add_u32 s52, s52, 0x40000
buffer_load_dwordx4 v[72:75], v4, s[16:19], s53 offen sc1
buffer_load_dwordx4 v[76:79], v4, s[16:19], s53 offen offset:1024 sc1
s_add_u32 s53, s53, 0x40000
buffer_load_dwordx4 v[80:83], v4, s[16:19], s52 offen sc1
buffer_load_dwordx4 v[84:87], v4, s[16:19], s52 offen offset:1024 sc1
s_add_u32 s52, s52, 0x40000
buffer_load_dwordx4 v[88:91], v4, s[16:19], s53 offen sc1
buffer_load_dwordx4 v[92:95], v4, s[16:19], s53 offen offset:1024 sc1
s_add_u32 s53, s53, 0x40000
buffer_load_dwordx4 v[96:99], v4, s[16:19], s52 offen sc1
buffer_load_dwordx4 v[100:103], v4, s[16:19], s52 offen offset:1024 sc1
s_add_u32 s52, s52, 0x40000
buffer_load_dwordx4 v[104:107], v4, s[16:19], s53 offen sc1
buffer_load_dwordx4 v[108:111], v4, s[16:19], s53 offen offset:1024 sc1
s_add_u32 s53, s53, 0x40000
ds_read_b64_tr_b16 a[0:1], v7
ds_read_b64_tr_b16 a[2:3], v7 offset:512
ds_read_b64_tr_b16 a[4:5], v7 offset:32
ds_read_b64_tr_b16 a[6:7], v7 offset:544
ds_read_b64_tr_b16 a[8:9], v7 offset:64
ds_read_b64_tr_b16 a[10:11], v7 offset:576
ds_read_b64_tr_b16 a[12:13], v7 offset:96
ds_read_b64_tr_b16 a[14:15], v7 offset:608
ds_read_b64_tr_b16 a[16:17], v7 offset:1024
ds_read_b64_tr_b16 a[18:19], v7 offset:1536
ds_read_b64_tr_b16 a[20:21], v7 offset:1056
ds_read_b64_tr_b16 a[22:23], v7 offset:1568
ds_read_b64_tr_b16 a[24:25], v7 offset:1088
ds_read_b64_tr_b16 a[26:27], v7 offset:1600
ds_read_b64_tr_b16 a[28:29], v7 offset:1120
ds_read_b64_tr_b16 a[30:31], v7 offset:1632
s_waitcnt vmcnt(11) lgkmcnt(14)
v_mfma_f32_16x16x32_bf16 v[32:35], a[0:3], v[64:67], v[32:35]
ds_read_b64_tr_b16 a[32:33], v7 offset:8320
ds_read_b64_tr_b16 a[34:35], v7 offset:8832
s_waitcnt vmcnt(10)
v_mfma_f32_16x16x32_bf16 v[48:51], a[0:3], v[68:71], v[48:51]
buffer_load_dwordx4 v[112:115], v4, s[16:19], s52 offen sc1
s_waitcnt lgkmcnt(14)
v_mfma_f32_16x16x32_bf16 v[52:55], a[4:7], v[68:71], v[52:55]
ds_read_b64_tr_b16 a[36:37], v7 offset:8352
ds_read_b64_tr_b16 a[38:39], v7 offset:8864
v_mfma_f32_16x16x32_bf16 v[36:39], a[4:7], v[64:67], v[36:39]
ds_read_b64_tr_b16 a[40:41], v7 offset:8384
ds_read_b64_tr_b16 a[42:43], v7 offset:8896
s_waitcnt lgkmcnt(15)
v_mfma_f32_16x16x32_bf16 v[40:43], a[8:11], v[64:67], v[40:43]
buffer_load_dwordx4 v[116:119], v4, s[16:19], s52 offen offset:1024 sc1
v_mfma_f32_16x16x32_bf16 v[56:59], a[8:11], v[68:71], v[56:59]
ds_read_b64_tr_b16 a[44:45], v7 offset:8416
s_add_u32 s52, s52, 0x40000
s_waitcnt lgkmcnt(15)
v_mfma_f32_16x16x32_bf16 v[60:63], a[12:15], v[68:71], v[60:63]
ds_read_b64_tr_b16 a[46:47], v7 offset:8928
v_mfma_f32_16x16x32_bf16 v[44:47], a[12:15], v[64:67], v[44:47]
ds_read_b64_tr_b16 a[48:49], v7 offset:9344
ds_read_b64_tr_b16 a[50:51], v7 offset:9856
s_waitcnt vmcnt(11) lgkmcnt(15)
v_mfma_f32_16x16x32_bf16 v[32:35], a[16:19], v[72:75], v[32:35]
buffer_load_dwordx4 v[120:123], v4, s[16:19], s53 offen sc1
s_waitcnt vmcnt(11)
v_mfma_f32_16x16x32_bf16 v[48:51], a[16:19], v[76:79], v[48:51]
ds_read_b64_tr_b16 a[52:53], v7 offset:9376
ds_read_b64_tr_b16 a[54:55], v7 offset:9888
s_waitcnt lgkmcnt(15)
v_mfma_f32_16x16x32_bf16 v[52:55], a[20:23], v[76:79], v[52:55]
ds_read_b64_tr_b16 a[56:57], v7 offset:9408
ds_read_b64_tr_b16 a[58:59], v7 offset:9920
v_mfma_f32_16x16x32_bf16 v[36:39], a[20:23], v[72:75], v[36:39]
buffer_load_dwordx4 v[124:127], v4, s[16:19], s53 offen offset:1024 sc1
s_waitcnt lgkmcnt(15)
v_mfma_f32_16x16x32_bf16 v[40:43], a[24:27], v[72:75], v[40:43]
ds_read_b64_tr_b16 a[60:61], v7 offset:9440
s_add_u32 s53, s53, 0x40000
v_mfma_f32_16x16x32_bf16 v[56:59], a[24:27], v[76:79], v[56:59]
ds_read_b64_tr_b16 a[62:63], v7 offset:9952
s_waitcnt lgkmcnt(15)
v_mfma_f32_16x16x32_bf16 v[60:63], a[28:31], v[76:79], v[60:63]
v_mfma_f32_16x16x32_bf16 v[44:47], a[28:31], v[72:75], v[44:47]
s_waitcnt vmcnt(11) lgkmcnt(14)
v_mfma_f32_16x16x32_bf16 v[32:35], a[32:35], v[80:83], v[32:35]
ds_read_b64_tr_b16 a[0:1], v7 offset:16640
ds_read_b64_tr_b16 a[2:3], v7 offset:17152
s_waitcnt vmcnt(10)
v_mfma_f32_16x16x32_bf16 v[48:51], a[32:35], v[84:87], v[48:51]
buffer_load_dwordx4 v[64:67], v4, s[16:19], s52 offen sc1
s_waitcnt lgkmcnt(14)
v_mfma_f32_16x16x32_bf16 v[52:55], a[36:39], v[84:87], v[52:55]
ds_read_b64_tr_b16 a[4:5], v7 offset:16672
ds_read_b64_tr_b16 a[6:7], v7 offset:17184
v_mfma_f32_16x16x32_bf16 v[36:39], a[36:39], v[80:83], v[36:39]
ds_read_b64_tr_b16 a[8:9], v7 offset:16704
ds_read_b64_tr_b16 a[10:11], v7 offset:17216
s_waitcnt lgkmcnt(15)
v_mfma_f32_16x16x32_bf16 v[40:43], a[40:43], v[80:83], v[40:43]
buffer_load_dwordx4 v[68:71], v4, s[16:19], s52 offen offset:1024 sc1
v_mfma_f32_16x16x32_bf16 v[56:59], a[40:43], v[84:87], v[56:59]
ds_read_b64_tr_b16 a[12:13], v7 offset:16736
s_add_u32 s52, s52, 0x40000
s_waitcnt lgkmcnt(15)
v_mfma_f32_16x16x32_bf16 v[60:63], a[44:47], v[84:87], v[60:63]
ds_read_b64_tr_b16 a[14:15], v7 offset:17248
v_mfma_f32_16x16x32_bf16 v[44:47], a[44:47], v[80:83], v[44:47]
ds_read_b64_tr_b16 a[16:17], v7 offset:17664
ds_read_b64_tr_b16 a[18:19], v7 offset:18176
s_waitcnt vmcnt(11) lgkmcnt(15)
v_mfma_f32_16x16x32_bf16 v[32:35], a[48:51], v[88:91], v[32:35]
buffer_load_dwordx4 v[72:75], v4, s[16:19], s53 offen sc1
s_waitcnt vmcnt(11)
v_mfma_f32_16x16x32_bf16 v[48:51], a[48:51], v[92:95], v[48:51]
ds_read_b64_tr_b16 a[20:21], v7 offset:17696
ds_read_b64_tr_b16 a[22:23], v7 offset:18208
s_waitcnt lgkmcnt(15)
v_mfma_f32_16x16x32_bf16 v[52:55], a[52:55], v[92:95], v[52:55]
ds_read_b64_tr_b16 a[24:25], v7 offset:17728
ds_read_b64_tr_b16 a[26:27], v7 offset:18240
v_mfma_f32_16x16x32_bf16 v[36:39], a[52:55], v[88:91], v[36:39]
buffer_load_dwordx4 v[76:79], v4, s[16:19], s53 offen offset:1024 sc1
s_waitcnt lgkmcnt(15)
v_mfma_f32_16x16x32_bf16 v[40:43], a[56:59], v[88:91], v[40:43]
ds_read_b64_tr_b16 a[28:29], v7 offset:17760
s_add_u32 s53, s53, 0x40000
v_mfma_f32_16x16x32_bf16 v[56:59], a[56:59], v[92:95], v[56:59]
ds_read_b64_tr_b16 a[30:31], v7 offset:18272
s_waitcnt lgkmcnt(15)
v_mfma_f32_16x16x32_bf16 v[60:63], a[60:63], v[92:95], v[60:63]
v_mfma_f32_16x16x32_bf16 v[44:47], a[60:63], v[88:91], v[44:47]
s_waitcnt vmcnt(11) lgkmcnt(14)
v_mfma_f32_16x16x32_bf16 v[32:35], a[0:3], v[96:99], v[32:35]
ds_read_b64_tr_b16 a[32:33], v7 offset:24960
ds_read_b64_tr_b16 a[34:35], v7 offset:25472
s_waitcnt vmcnt(10)
v_mfma_f32_16x16x32_bf16 v[48:51], a[0:3], v[100:103], v[48:51]
buffer_load_dwordx4 v[80:83], v4, s[16:19], s52 offen sc1
s_waitcnt lgkmcnt(14)
v_mfma_f32_16x16x32_bf16 v[52:55], a[4:7], v[100:103], v[52:55]
ds_read_b64_tr_b16 a[36:37], v7 offset:24992
ds_read_b64_tr_b16 a[38:39], v7 offset:25504
v_mfma_f32_16x16x32_bf16 v[36:39], a[4:7], v[96:99], v[36:39]
ds_read_b64_tr_b16 a[40:41], v7 offset:25024
ds_read_b64_tr_b16 a[42:43], v7 offset:25536
s_waitcnt lgkmcnt(15)
v_mfma_f32_16x16x32_bf16 v[40:43], a[8:11], v[96:99], v[40:43]
buffer_load_dwordx4 v[84:87], v4, s[16:19], s52 offen offset:1024 sc1
v_mfma_f32_16x16x32_bf16 v[56:59], a[8:11], v[100:103], v[56:59]
ds_read_b64_tr_b16 a[44:45], v7 offset:25056
s_add_u32 s52, s52, 0x40000
s_waitcnt lgkmcnt(15)
v_mfma_f32_16x16x32_bf16 v[60:63], a[12:15], v[100:103], v[60:63]
ds_read_b64_tr_b16 a[46:47], v7 offset:25568
v_mfma_f32_16x16x32_bf16 v[44:47], a[12:15], v[96:99], v[44:47]
ds_read_b64_tr_b16 a[48:49], v7 offset:25984
ds_read_b64_tr_b16 a[50:51], v7 offset:26496
s_waitcnt vmcnt(11) lgkmcnt(15)
v_mfma_f32_16x16x32_bf16 v[32:35], a[16:19], v[104:107], v[32:35]
buffer_load_dwordx4 v[88:91], v4, s[16:19], s53 offen sc1
s_waitcnt vmcnt(11)
v_mfma_f32_16x16x32_bf16 v[48:51], a[16:19], v[108:111], v[48:51]
ds_read_b64_tr_b16 a[52:53], v7 offset:26016
ds_read_b64_tr_b16 a[54:55], v7 offset:26528
s_waitcnt lgkmcnt(15)
v_mfma_f32_16x16x32_bf16 v[52:55], a[20:23], v[108:111], v[52:55]
ds_read_b64_tr_b16 a[56:57], v7 offset:26048
ds_read_b64_tr_b16 a[58:59], v7 offset:26560
v_mfma_f32_16x16x32_bf16 v[36:39], a[20:23], v[104:107], v[36:39]
buffer_load_dwordx4 v[92:95], v4, s[16:19], s53 offen offset:1024 sc1
s_waitcnt lgkmcnt(15)
v_mfma_f32_16x16x32_bf16 v[40:43], a[24:27], v[104:107], v[40:43]
ds_read_b64_tr_b16 a[60:61], v7 offset:26080
s_add_u32 s53, s53, 0x40000
v_mfma_f32_16x16x32_bf16 v[56:59], a[24:27], v[108:111], v[56:59]
ds_read_b64_tr_b16 a[62:63], v7 offset:26592
s_waitcnt lgkmcnt(15)
v_mfma_f32_16x16x32_bf16 v[60:63], a[28:31], v[108:111], v[60:63]
v_mfma_f32_16x16x32_bf16 v[44:47], a[28:31], v[104:107], v[44:47]
s_waitcnt vmcnt(11) lgkmcnt(14)
v_mfma_f32_16x16x32_bf16 v[32:35], a[32:35], v[112:115], v[32:35]
ds_read_b64_tr_b16 a[0:1], v7 offset:33280
ds_read_b64_tr_b16 a[2:3], v7 offset:33792
s_waitcnt vmcnt(10)
v_mfma_f32_16x16x32_bf16 v[48:51], a[32:35], v[116:119], v[48:51]
buffer_load_dwordx4 v[96:99], v4, s[16:19], s52 offen sc1
s_waitcnt lgkmcnt(14)
v_mfma_f32_16x16x32_bf16 v[52:55], a[36:39], v[116:119], v[52:55]
ds_read_b64_tr_b16 a[4:5], v7 offset:33312
ds_read_b64_tr_b16 a[6:7], v7 offset:33824
v_mfma_f32_16x16x32_bf16 v[36:39], a[36:39], v[112:115], v[36:39]
ds_read_b64_tr_b16 a[8:9], v7 offset:33344
ds_read_b64_tr_b16 a[10:11], v7 offset:33856
s_waitcnt lgkmcnt(15)
v_mfma_f32_16x16x32_bf16 v[40:43], a[40:43], v[112:115], v[40:43]
buffer_load_dwordx4 v[100:103], v4, s[16:19], s52 offen offset:1024 sc1
v_mfma_f32_16x16x32_bf16 v[56:59], a[40:43], v[116:119], v[56:59]
ds_read_b64_tr_b16 a[12:13], v7 offset:33376
s_add_u32 s52, s52, 0x40000
s_waitcnt lgkmcnt(15)
v_mfma_f32_16x16x32_bf16 v[60:63], a[44:47], v[116:119], v[60:63]
ds_read_b64_tr_b16 a[14:15], v7 offset:33888
v_mfma_f32_16x16x32_bf16 v[44:47], a[44:47], v[112:115], v[44:47]
ds_read_b64_tr_b16 a[16:17], v7 offset:34304
ds_read_b64_tr_b16 a[18:19], v7 offset:34816
s_waitcnt vmcnt(11) lgkmcnt(15)
v_mfma_f32_16x16x32_bf16 v[32:35], a[48:51], v[120:123], v[32:35]
buffer_load_dwordx4 v[104:107], v4, s[16:19], s53 offen sc1
s_waitcnt vmcnt(11)
v_mfma_f32_16x16x32_bf16 v[48:51], a[48:51], v[124:127], v[48:51]
ds_read_b64_tr_b16 a[20:21], v7 offset:34336
ds_read_b64_tr_b16 a[22:23], v7 offset:34848
s_waitcnt lgkmcnt(15)
v_mfma_f32_16x16x32_bf16 v[52:55], a[52:55], v[124:127], v[52:55]
ds_read_b64_tr_b16 a[24:25], v7 offset:34368
ds_read_b64_tr_b16 a[26:27], v7 offset:34880
v_mfma_f32_16x16x32_bf16 v[36:39], a[52:55], v[120:123], v[36:39]
buffer_load_dwordx4 v[108:111], v4, s[16:19], s53 offen offset:1024 sc1
s_waitcnt lgkmcnt(15)
v_mfma_f32_16x16x32_bf16 v[40:43], a[56:59], v[120:123], v[40:43]
ds_read_b64_tr_b16 a[28:29], v7 offset:34400
s_add_u32 s53, s53, 0x40000
v_mfma_f32_16x16x32_bf16 v[56:59], a[56:59], v[124:127], v[56:59]
ds_read_b64_tr_b16 a[30:31], v7 offset:34912
s_waitcnt lgkmcnt(15)
v_mfma_f32_16x16x32_bf16 v[60:63], a[60:63], v[124:127], v[60:63]
v_mfma_f32_16x16x32_bf16 v[44:47], a[60:63], v[120:123], v[44:47]
s_waitcnt vmcnt(11) lgkmcnt(14)
v_mfma_f32_16x16x32_bf16 v[32:35], a[0:3], v[64:67], v[32:35]
ds_read_b64_tr_b16 a[32:33], v7 offset:41600
ds_read_b64_tr_b16 a[34:35], v7 offset:42112
s_waitcnt vmcnt(10)
v_mfma_f32_16x16x32_bf16 v[48:51], a[0:3], v[68:71], v[48:51]
buffer_load_dwordx4 v[112:115], v4, s[16:19], s52 offen sc1
s_waitcnt lgkmcnt(14)
v_mfma_f32_16x16x32_bf16 v[52:55], a[4:7], v[68:71], v[52:55]
ds_read_b64_tr_b16 a[36:37], v7 offset:41632
ds_read_b64_tr_b16 a[38:39], v7 offset:42144
v_mfma_f32_16x16x32_bf16 v[36:39], a[4:7], v[64:67], v[36:39]
ds_read_b64_tr_b16 a[40:41], v7 offset:41664
ds_read_b64_tr_b16 a[42:43], v7 offset:42176
s_waitcnt lgkmcnt(15)
v_mfma_f32_16x16x32_bf16 v[40:43], a[8:11], v[64:67], v[40:43]
buffer_load_dwordx4 v[116:119], v4, s[16:19], s52 offen offset:1024 sc1
v_mfma_f32_16x16x32_bf16 v[56:59], a[8:11], v[68:71], v[56:59]
ds_read_b64_tr_b16 a[44:45], v7 offset:41696
s_add_u32 s52, s52, 0x40000
s_waitcnt lgkmcnt(15)
v_mfma_f32_16x16x32_bf16 v[60:63], a[12:15], v[68:71], v[60:63]
ds_read_b64_tr_b16 a[46:47], v7 offset:42208
v_mfma_f32_16x16x32_bf16 v[44:47], a[12:15], v[64:67], v[44:47]
ds_read_b64_tr_b16 a[48:49], v7 offset:42624
ds_read_b64_tr_b16 a[50:51], v7 offset:43136
s_waitcnt vmcnt(11) lgkmcnt(15)
v_mfma_f32_16x16x32_bf16 v[32:35], a[16:19], v[72:75], v[32:35]
buffer_load_dwordx4 v[120:123], v4, s[16:19], s53 offen sc1
s_waitcnt vmcnt(11)
v_mfma_f32_16x16x32_bf16 v[48:51], a[16:19], v[76:79], v[48:51]
ds_read_b64_tr_b16 a[52:53], v7 offset:42656
ds_read_b64_tr_b16 a[54:55], v7 offset:43168
s_waitcnt lgkmcnt(15)
v_mfma_f32_16x16x32_bf16 v[52:55], a[20:23], v[76:79], v[52:55]
ds_read_b64_tr_b16 a[56:57], v7 offset:42688
ds_read_b64_tr_b16 a[58:59], v7 offset:43200
v_mfma_f32_16x16x32_bf16 v[36:39], a[20:23], v[72:75], v[36:39]
buffer_load_dwordx4 v[124:127], v4, s[16:19], s53 offen offset:1024 sc1
s_waitcnt lgkmcnt(15)
v_mfma_f32_16x16x32_bf16 v[40:43], a[24:27], v[72:75], v[40:43]
ds_read_b64_tr_b16 a[60:61], v7 offset:42720
s_add_u32 s53, s53, 0x40000
v_mfma_f32_16x16x32_bf16 v[56:59], a[24:27], v[76:79], v[56:59]
ds_read_b64_tr_b16 a[62:63], v7 offset:43232
s_waitcnt lgkmcnt(15)
v_mfma_f32_16x16x32_bf16 v[60:63], a[28:31], v[76:79], v[60:63]
v_mfma_f32_16x16x32_bf16 v[44:47], a[28:31], v[72:75], v[44:47]
s_waitcnt vmcnt(11) lgkmcnt(14)
v_mfma_f32_16x16x32_bf16 v[32:35], a[32:35], v[80:83], v[32:35]
ds_read_b64_tr_b16 a[0:1], v7 offset:49920
ds_read_b64_tr_b16 a[2:3], v7 offset:50432
s_waitcnt vmcnt(10)
v_mfma_f32_16x16x32_bf16 v[48:51], a[32:35], v[84:87], v[48:51]
buffer_load_dwordx4 v[64:67], v4, s[16:19], s52 offen sc1
s_waitcnt lgkmcnt(14)
v_mfma_f32_16x16x32_bf16 v[52:55], a[36:39], v[84:87], v[52:55]
ds_read_b64_tr_b16 a[4:5], v7 offset:49952
ds_read_b64_tr_b16 a[6:7], v7 offset:50464
v_mfma_f32_16x16x32_bf16 v[36:39], a[36:39], v[80:83], v[36:39]
ds_read_b64_tr_b16 a[8:9], v7 offset:49984
ds_read_b64_tr_b16 a[10:11], v7 offset:50496
s_waitcnt lgkmcnt(15)
v_mfma_f32_16x16x32_bf16 v[40:43], a[40:43], v[80:83], v[40:43]
buffer_load_dwordx4 v[68:71], v4, s[16:19], s52 offen offset:1024 sc1
v_mfma_f32_16x16x32_bf16 v[56:59], a[40:43], v[84:87], v[56:59]
ds_read_b64_tr_b16 a[12:13], v7 offset:50016
s_add_u32 s52, s52, 0x40000
s_waitcnt lgkmcnt(15)
v_mfma_f32_16x16x32_bf16 v[60:63], a[44:47], v[84:87], v[60:63]
ds_read_b64_tr_b16 a[14:15], v7 offset:50528
v_mfma_f32_16x16x32_bf16 v[44:47], a[44:47], v[80:83], v[44:47]
ds_read_b64_tr_b16 a[16:17], v7 offset:50944
ds_read_b64_tr_b16 a[18:19], v7 offset:51456
s_waitcnt vmcnt(11) lgkmcnt(15)
v_mfma_f32_16x16x32_bf16 v[32:35], a[48:51], v[88:91], v[32:35]
buffer_load_dwordx4 v[72:75], v4, s[16:19], s53 offen sc1
s_waitcnt vmcnt(11)
v_mfma_f32_16x16x32_bf16 v[48:51], a[48:51], v[92:95], v[48:51]
ds_read_b64_tr_b16 a[20:21], v7 offset:50976
ds_read_b64_tr_b16 a[22:23], v7 offset:51488
s_waitcnt lgkmcnt(15)
v_mfma_f32_16x16x32_bf16 v[52:55], a[52:55], v[92:95], v[52:55]
ds_read_b64_tr_b16 a[24:25], v7 offset:51008
ds_read_b64_tr_b16 a[26:27], v7 offset:51520
v_mfma_f32_16x16x32_bf16 v[36:39], a[52:55], v[88:91], v[36:39]
buffer_load_dwordx4 v[76:79], v4, s[16:19], s53 offen offset:1024 sc1
s_waitcnt lgkmcnt(15)
v_mfma_f32_16x16x32_bf16 v[40:43], a[56:59], v[88:91], v[40:43]
ds_read_b64_tr_b16 a[28:29], v7 offset:51040
s_add_u32 s53, s53, 0x40000
v_mfma_f32_16x16x32_bf16 v[56:59], a[56:59], v[92:95], v[56:59]
ds_read_b64_tr_b16 a[30:31], v7 offset:51552
s_waitcnt lgkmcnt(15)
v_mfma_f32_16x16x32_bf16 v[60:63], a[60:63], v[92:95], v[60:63]
v_mfma_f32_16x16x32_bf16 v[44:47], a[60:63], v[88:91], v[44:47]
s_waitcnt vmcnt(11) lgkmcnt(14)
v_mfma_f32_16x16x32_bf16 v[32:35], a[0:3], v[96:99], v[32:35]
ds_read_b64_tr_b16 a[32:33], v7 offset:58240
ds_read_b64_tr_b16 a[34:35], v7 offset:58752
s_waitcnt vmcnt(10)
v_mfma_f32_16x16x32_bf16 v[48:51], a[0:3], v[100:103], v[48:51]
buffer_load_dwordx4 v[80:83], v4, s[16:19], s52 offen sc1
s_waitcnt lgkmcnt(14)
v_mfma_f32_16x16x32_bf16 v[52:55], a[4:7], v[100:103], v[52:55]
ds_read_b64_tr_b16 a[36:37], v7 offset:58272
ds_read_b64_tr_b16 a[38:39], v7 offset:58784
v_mfma_f32_16x16x32_bf16 v[36:39], a[4:7], v[96:99], v[36:39]
ds_read_b64_tr_b16 a[40:41], v7 offset:58304
ds_read_b64_tr_b16 a[42:43], v7 offset:58816
s_waitcnt lgkmcnt(15)
v_mfma_f32_16x16x32_bf16 v[40:43], a[8:11], v[96:99], v[40:43]
buffer_load_dwordx4 v[84:87], v4, s[16:19], s52 offen offset:1024 sc1
v_mfma_f32_16x16x32_bf16 v[56:59], a[8:11], v[100:103], v[56:59]
ds_read_b64_tr_b16 a[44:45], v7 offset:58336
s_add_u32 s52, s52, 0x40000
s_waitcnt lgkmcnt(15)
v_mfma_f32_16x16x32_bf16 v[60:63], a[12:15], v[100:103], v[60:63]
ds_read_b64_tr_b16 a[46:47], v7 offset:58848
v_mfma_f32_16x16x32_bf16 v[44:47], a[12:15], v[96:99], v[44:47]
ds_read_b64_tr_b16 a[48:49], v7 offset:59264
ds_read_b64_tr_b16 a[50:51], v7 offset:59776
s_waitcnt vmcnt(11) lgkmcnt(15)
v_mfma_f32_16x16x32_bf16 v[32:35], a[16:19], v[104:107], v[32:35]
buffer_load_dwordx4 v[88:91], v4, s[16:19], s53 offen sc1
s_waitcnt vmcnt(11)
v_mfma_f32_16x16x32_bf16 v[48:51], a[16:19], v[108:111], v[48:51]
ds_read_b64_tr_b16 a[52:53], v7 offset:59296
ds_read_b64_tr_b16 a[54:55], v7 offset:59808
s_waitcnt lgkmcnt(15)
v_mfma_f32_16x16x32_bf16 v[52:55], a[20:23], v[108:111], v[52:55]
ds_read_b64_tr_b16 a[56:57], v7 offset:59328
ds_read_b64_tr_b16 a[58:59], v7 offset:59840
v_mfma_f32_16x16x32_bf16 v[36:39], a[20:23], v[104:107], v[36:39]
buffer_load_dwordx4 v[92:95], v4, s[16:19], s53 offen offset:1024 sc1
s_waitcnt lgkmcnt(15)
v_mfma_f32_16x16x32_bf16 v[40:43], a[24:27], v[104:107], v[40:43]
ds_read_b64_tr_b16 a[60:61], v7 offset:59360
s_add_u32 s53, s53, 0x40000
v_mfma_f32_16x16x32_bf16 v[56:59], a[24:27], v[108:111], v[56:59]
ds_read_b64_tr_b16 a[62:63], v7 offset:59872
s_waitcnt lgkmcnt(15)
v_mfma_f32_16x16x32_bf16 v[60:63], a[28:31], v[108:111], v[60:63]
v_mfma_f32_16x16x32_bf16 v[44:47], a[28:31], v[104:107], v[44:47]
s_xor_b32 s57, s57, 66560
v_add_u32 v7, s57, v8
s_waitcnt vmcnt(11) lgkmcnt(14)
v_mfma_f32_16x16x32_bf16 v[32:35], a[32:35], v[112:115], v[32:35]
ds_read_b64_tr_b16 a[0:1], v7
ds_read_b64_tr_b16 a[2:3], v7 offset:512
s_waitcnt vmcnt(10)
v_mfma_f32_16x16x32_bf16 v[48:51], a[32:35], v[116:119], v[48:51]
buffer_load_dwordx4 v[96:99], v4, s[16:19], s52 offen sc1
s_waitcnt lgkmcnt(14)
v_mfma_f32_16x16x32_bf16 v[52:55], a[36:39], v[116:119], v[52:55]
ds_read_b64_tr_b16 a[4:5], v7 offset:32
ds_read_b64_tr_b16 a[6:7], v7 offset:544
v_mfma_f32_16x16x32_bf16 v[36:39], a[36:39], v[112:115], v[36:39]
ds_read_b64_tr_b16 a[8:9], v7 offset:64
ds_read_b64_tr_b16 a[10:11], v7 offset:576
s_waitcnt lgkmcnt(15)
v_mfma_f32_16x16x32_bf16 v[40:43], a[40:43], v[112:115], v[40:43]
buffer_load_dwordx4 v[100:103], v4, s[16:19], s52 offen offset:1024 sc1
v_mfma_f32_16x16x32_bf16 v[56:59], a[40:43], v[116:119], v[56:59]
ds_read_b64_tr_b16 a[12:13], v7 offset:96
s_add_u32 s52, s52, 0x40000
s_waitcnt lgkmcnt(15)
v_mfma_f32_16x16x32_bf16 v[60:63], a[44:47], v[116:119], v[60:63]
ds_read_b64_tr_b16 a[14:15], v7 offset:608
v_mfma_f32_16x16x32_bf16 v[44:47], a[44:47], v[112:115], v[44:47]
ds_read_b64_tr_b16 a[16:17], v7 offset:1024
ds_read_b64_tr_b16 a[18:19], v7 offset:1536
s_waitcnt vmcnt(11) lgkmcnt(15)
v_mfma_f32_16x16x32_bf16 v[32:35], a[48:51], v[120:123], v[32:35]
buffer_load_dwordx4 v[104:107], v4, s[16:19], s53 offen sc1
s_waitcnt vmcnt(11)
v_mfma_f32_16x16x32_bf16 v[48:51], a[48:51], v[124:127], v[48:51]
ds_read_b64_tr_b16 a[20:21], v7 offset:1056
ds_read_b64_tr_b16 a[22:23], v7 offset:1568
s_waitcnt lgkmcnt(15)
v_mfma_f32_16x16x32_bf16 v[52:55], a[52:55], v[124:127], v[52:55]
ds_read_b64_tr_b16 a[24:25], v7 offset:1088
ds_read_b64_tr_b16 a[26:27], v7 offset:1600
v_mfma_f32_16x16x32_bf16 v[36:39], a[52:55], v[120:123], v[36:39]
buffer_load_dwordx4 v[108:111], v4, s[16:19], s53 offen offset:1024 sc1
s_waitcnt lgkmcnt(15)
v_mfma_f32_16x16x32_bf16 v[40:43], a[56:59], v[120:123], v[40:43]
ds_read_b64_tr_b16 a[28:29], v7 offset:1120
s_add_u32 s53, s53, 0x40000
v_mfma_f32_16x16x32_bf16 v[56:59], a[56:59], v[124:127], v[56:59]
ds_read_b64_tr_b16 a[30:31], v7 offset:1632
s_waitcnt lgkmcnt(15)
v_mfma_f32_16x16x32_bf16 v[60:63], a[60:63], v[124:127], v[60:63]
v_mfma_f32_16x16x32_bf16 v[44:47], a[60:63], v[120:123], v[44:47]
s_waitcnt vmcnt(11) lgkmcnt(14)
v_mfma_f32_16x16x32_bf16 v[32:35], a[0:3], v[64:67], v[32:35]
ds_read_b64_tr_b16 a[32:33], v7 offset:8320
ds_read_b64_tr_b16 a[34:35], v7 offset:8832
s_waitcnt vmcnt(10)
v_mfma_f32_16x16x32_bf16 v[48:51], a[0:3], v[68:71], v[48:51]
buffer_load_dwordx4 v[112:115], v4, s[16:19], s52 offen sc1
s_waitcnt lgkmcnt(14)
v_mfma_f32_16x16x32_bf16 v[52:55], a[4:7], v[68:71], v[52:55]
ds_read_b64_tr_b16 a[36:37], v7 offset:8352
ds_read_b64_tr_b16 a[38:39], v7 offset:8864
v_mfma_f32_16x16x32_bf16 v[36:39], a[4:7], v[64:67], v[36:39]
ds_read_b64_tr_b16 a[40:41], v7 offset:8384
ds_read_b64_tr_b16 a[42:43], v7 offset:8896
s_waitcnt lgkmcnt(15)
v_mfma_f32_16x16x32_bf16 v[40:43], a[8:11], v[64:67], v[40:43]
buffer_load_dwordx4 v[116:119], v4, s[16:19], s52 offen offset:1024 sc1
v_mfma_f32_16x16x32_bf16 v[56:59], a[8:11], v[68:71], v[56:59]
ds_read_b64_tr_b16 a[44:45], v7 offset:8416
s_add_u32 s52, s52, 0x40000
s_waitcnt lgkmcnt(15)
v_mfma_f32_16x16x32_bf16 v[60:63], a[12:15], v[68:71], v[60:63]
ds_read_b64_tr_b16 a[46:47], v7 offset:8928
v_mfma_f32_16x16x32_bf16 v[44:47], a[12:15], v[64:67], v[44:47]
ds_read_b64_tr_b16 a[48:49], v7 offset:9344
ds_read_b64_tr_b16 a[50:51], v7 offset:9856
s_waitcnt vmcnt(11) lgkmcnt(15)
v_mfma_f32_16x16x32_bf16 v[32:35], a[16:19], v[72:75], v[32:35]
buffer_load_dwordx4 v[120:123], v4, s[16:19], s53 offen sc1
s_waitcnt vmcnt(11)
v_mfma_f32_16x16x32_bf16 v[48:51], a[16:19], v[76:79], v[48:51]
ds_read_b64_tr_b16 a[52:53], v7 offset:9376
ds_read_b64_tr_b16 a[54:55], v7 offset:9888
s_waitcnt lgkmcnt(15)
v_mfma_f32_16x16x32_bf16 v[52:55], a[20:23], v[76:79], v[52:55]
ds_read_b64_tr_b16 a[56:57], v7 offset:9408
ds_read_b64_tr_b16 a[58:59], v7 offset:9920
v_mfma_f32_16x16x32_bf16 v[36:39], a[20:23], v[72:75], v[36:39]
buffer_load_dwordx4 v[124:127], v4, s[16:19], s53 offen offset:1024 sc1
s_waitcnt lgkmcnt(15)
v_mfma_f32_16x16x32_bf16 v[40:43], a[24:27], v[72:75], v[40:43]
ds_read_b64_tr_b16 a[60:61], v7 offset:9440
s_add_u32 s53, s53, 0x40000
v_mfma_f32_16x16x32_bf16 v[56:59], a[24:27], v[76:79], v[56:59]
ds_read_b64_tr_b16 a[62:63], v7 offset:9952
s_waitcnt lgkmcnt(15)
v_mfma_f32_16x16x32_bf16 v[60:63], a[28:31], v[76:79], v[60:63]
v_mfma_f32_16x16x32_bf16 v[44:47], a[28:31], v[72:75], v[44:47]
s_waitcnt vmcnt(11) lgkmcnt(14)
v_mfma_f32_16x16x32_bf16 v[32:35], a[32:35], v[80:83], v[32:35]
ds_read_b64_tr_b16 a[0:1], v7 offset:16640
ds_read_b64_tr_b16 a[2:3], v7 offset:17152
s_waitcnt vmcnt(10)
v_mfma_f32_16x16x32_bf16 v[48:51], a[32:35], v[84:87], v[48:51]
buffer_load_dwordx4 v[64:67], v4, s[16:19], s52 offen sc1
s_waitcnt lgkmcnt(14)
v_mfma_f32_16x16x32_bf16 v[52:55], a[36:39], v[84:87], v[52:55]
ds_read_b64_tr_b16 a[4:5], v7 offset:16672
ds_read_b64_tr_b16 a[6:7], v7 offset:17184
v_mfma_f32_16x16x32_bf16 v[36:39], a[36:39], v[80:83], v[36:39]
ds_read_b64_tr_b16 a[8:9], v7 offset:16704
ds_read_b64_tr_b16 a[10:11], v7 offset:17216
s_waitcnt lgkmcnt(15)
v_mfma_f32_16x16x32_bf16 v[40:43], a[40:43], v[80:83], v[40:43]
buffer_load_dwordx4 v[68:71], v4, s[16:19], s52 offen offset:1024 sc1
v_mfma_f32_16x16x32_bf16 v[56:59], a[40:43], v[84:87], v[56:59]
ds_read_b64_tr_b16 a[12:13], v7 offset:16736
s_add_u32 s52, s52, 0x40000
s_waitcnt lgkmcnt(15)
v_mfma_f32_16x16x32_bf16 v[60:63], a[44:47], v[84:87], v[60:63]
ds_read_b64_tr_b16 a[14:15], v7 offset:17248
v_mfma_f32_16x16x32_bf16 v[44:47], a[44:47], v[80:83], v[44:47]
ds_read_b64_tr_b16 a[16:17], v7 offset:17664
ds_read_b64_tr_b16 a[18:19], v7 offset:18176
s_waitcnt vmcnt(11) lgkmcnt(15)
v_mfma_f32_16x16x32_bf16 v[32:35], a[48:51], v[88:91], v[32:35]
buffer_load_dwordx4 v[72:75], v4, s[16:19], s53 offen sc1
s_waitcnt vmcnt(11)
v_mfma_f32_16x16x32_bf16 v[48:51], a[48:51], v[92:95], v[48:51]
ds_read_b64_tr_b16 a[20:21], v7 offset:17696
ds_read_b64_tr_b16 a[22:23], v7 offset:18208
s_waitcnt lgkmcnt(15)
v_mfma_f32_16x16x32_bf16 v[52:55], a[52:55], v[92:95], v[52:55]
ds_read_b64_tr_b16 a[24:25], v7 offset:17728
ds_read_b64_tr_b16 a[26:27], v7 offset:18240
v_mfma_f32_16x16x32_bf16 v[36:39], a[52:55], v[88:91], v[36:39]
buffer_load_dwordx4 v[76:79], v4, s[16:19], s53 offen offset:1024 sc1
s_waitcnt lgkmcnt(15)
v_mfma_f32_16x16x32_bf16 v[40:43], a[56:59], v[88:91], v[40:43]
ds_read_b64_tr_b16 a[28:29], v7 offset:17760
s_add_u32 s53, s53, 0x40000
v_mfma_f32_16x16x32_bf16 v[56:59], a[56:59], v[92:95], v[56:59]
ds_read_b64_tr_b16 a[30:31], v7 offset:18272
s_waitcnt lgkmcnt(15)
v_mfma_f32_16x16x32_bf16 v[60:63], a[60:63], v[92:95], v[60:63]
v_mfma_f32_16x16x32_bf16 v[44:47], a[60:63], v[88:91], v[44:47]
s_waitcnt vmcnt(11) lgkmcnt(14)
v_mfma_f32_16x16x32_bf16 v[32:35], a[0:3], v[96:99], v[32:35]
ds_read_b64_tr_b16 a[32:33], v7 offset:24960
ds_read_b64_tr_b16 a[34:35], v7 offset:25472
s_waitcnt vmcnt(10)
v_mfma_f32_16x16x32_bf16 v[48:51], a[0:3], v[100:103], v[48:51]
buffer_load_dwordx4 v[80:83], v4, s[16:19], s52 offen sc1
s_waitcnt lgkmcnt(14)
v_mfma_f32_16x16x32_bf16 v[52:55], a[4:7], v[100:103], v[52:55]
ds_read_b64_tr_b16 a[36:37], v7 offset:24992
ds_read_b64_tr_b16 a[38:39], v7 offset:25504
v_mfma_f32_16x16x32_bf16 v[36:39], a[4:7], v[96:99], v[36:39]
ds_read_b64_tr_b16 a[40:41], v7 offset:25024
ds_read_b64_tr_b16 a[42:43], v7 offset:25536
s_waitcnt lgkmcnt(15)
v_mfma_f32_16x16x32_bf16 v[40:43], a[8:11], v[96:99], v[40:43]
.Lpad1:
s_cbranch_execz .Lnopoll35r
buffer_load_dwordx4 v[84:87], v4, s[16:19], s52 offen offset:1024 sc1
v_mfma_f32_16x16x32_bf16 v[56:59], a[8:11], v[100:103], v[56:59]
ds_read_b64_tr_b16 a[44:45], v7 offset:25056
s_add_u32 s52, s52, 0x40000
s_waitcnt lgkmcnt(15)
v_mfma_f32_16x16x32_bf16 v[60:63], a[12:15], v[100:103], v[60:63]
ds_read_b64_tr_b16 a[46:47], v7 offset:25568
v_mfma_f32_16x16x32_bf16 v[44:47], a[12:15], v[96:99], v[44:47]
ds_read_b64_tr_b16 a[48:49], v7 offset:25984
ds_read_b64_tr_b16 a[50:51], v7 offset:26496
s_waitcnt vmcnt(11) lgkmcnt(15)
v_mfma_f32_16x16x32_bf16 v[32:35], a[16:19], v[104:107], v[32:35]
buffer_load_dwordx4 v[88:91], v4, s[16:19], s53 offen sc1
s_waitcnt vmcnt(11)
v_mfma_f32_16x16x32_bf16 v[48:51], a[16:19], v[108:111], v[48:51]
ds_read_b64_tr_b16 a[52:53], v7 offset:26016
ds_read_b64_tr_b16 a[54:55], v7 offset:26528
s_waitcnt lgkmcnt(15)
v_mfma_f32_16x16x32_bf16 v[52:55], a[20:23], v[108:111], v[52:55]
ds_read_b64_tr_b16 a[56:57], v7 offset:26048
ds_read_b64_tr_b16 a[58:59], v7 offset:26560
v_mfma_f32_16x16x32_bf16 v[36:39], a[20:23], v[104:107], v[36:39]
buffer_load_dwordx4 v[92:95], v4, s[16:19], s53 offen offset:1024 sc1
s_waitcnt lgkmcnt(15)
v_mfma_f32_16x16x32_bf16 v[40:43], a[24:27], v[104:107], v[40:43]
ds_read_b64_tr_b16 a[60:61], v7 offset:26080
s_add_u32 s53, s53, 0x40000
v_mfma_f32_16x16x32_bf16 v[56:59], a[24:27], v[108:111], v[56:59]
ds_read_b64_tr_b16 a[62:63], v7 offset:26592
s_waitcnt lgkmcnt(15)
v_mfma_f32_16x16x32_bf16 v[60:63], a[28:31], v[108:111], v[60:63]
v_mfma_f32_16x16x32_bf16 v[44:47], a[28:31], v[104:107], v[44:47]
s_waitcnt vmcnt(11) lgkmcnt(14)
v_mfma_f32_16x16x32_bf16 v[32:35], a[32:35], v[112:115], v[32:35]
ds_read_b64_tr_b16 a[0:1], v7 offset:33280
ds_read_b64_tr_b16 a[2:3], v7 offset:33792
s_waitcnt vmcnt(10)
v_mfma_f32_16x16x32_bf16 v[48:51], a[32:35], v[116:119], v[48:51]
buffer_load_dwordx4 v[96:99], v4, s[16:19], s52 offen sc1
s_waitcnt lgkmcnt(14)
v_mfma_f32_16x16x32_bf16 v[52:55], a[36:39], v[116:119], v[52:55]
ds_read_b64_tr_b16 a[4:5], v7 offset:33312
ds_read_b64_tr_b16 a[6:7], v7 offset:33824
v_mfma_f32_16x16x32_bf16 v[36:39], a[36:39], v[112:115], v[36:39]
ds_read_b64_tr_b16 a[8:9], v7 offset:33344
ds_read_b64_tr_b16 a[10:11], v7 offset:33856
s_waitcnt lgkmcnt(15)
v_mfma_f32_16x16x32_bf16 v[40:43], a[40:43], v[112:115], v[40:43]
buffer_load_dwordx4 v[100:103], v4, s[16:19], s52 offen offset:1024 sc1
v_mfma_f32_16x16x32_bf16 v[56:59], a[40:43], v[116:119], v[56:59]
ds_read_b64_tr_b16 a[12:13], v7 offset:33376
s_add_u32 s52, s52, 0x40000
s_waitcnt lgkmcnt(15)
v_mfma_f32_16x16x32_bf16 v[60:63], a[44:47], v[116:119], v[60:63]
ds_read_b64_tr_b16 a[14:15], v7 offset:33888
v_mfma_f32_16x16x32_bf16 v[44:47], a[44:47], v[112:115], v[44:47]
ds_read_b64_tr_b16 a[16:17], v7 offset:34304
ds_read_b64_tr_b16 a[18:19], v7 offset:34816
s_waitcnt vmcnt(11) lgkmcnt(15)
v_mfma_f32_16x16x32_bf16 v[32:35], a[48:51], v[120:123], v[32:35]
buffer_load_dwordx4 v[104:107], v4, s[16:19], s53 offen sc1
s_waitcnt vmcnt(11)
v_mfma_f32_16x16x32_bf16 v[48:51], a[48:51], v[124:127], v[48:51]
ds_read_b64_tr_b16 a[20:21], v7 offset:34336
ds_read_b64_tr_b16 a[22:23], v7 offset:34848
s_waitcnt lgkmcnt(15)
v_mfma_f32_16x16x32_bf16 v[52:55], a[52:55], v[124:127], v[52:55]
ds_read_b64_tr_b16 a[24:25], v7 offset:34368
ds_read_b64_tr_b16 a[26:27], v7 offset:34880
v_mfma_f32_16x16x32_bf16 v[36:39], a[52:55], v[120:123], v[36:39]
buffer_load_dwordx4 v[108:111], v4, s[16:19], s53 offen offset:1024 sc1
s_waitcnt lgkmcnt(15)
v_mfma_f32_16x16x32_bf16 v[40:43], a[56:59], v[120:123], v[40:43]
ds_read_b64_tr_b16 a[28:29], v7 offset:34400
s_add_u32 s53, s53, 0x40000
v_mfma_f32_16x16x32_bf16 v[56:59], a[56:59], v[124:127], v[56:59]
ds_read_b64_tr_b16 a[30:31], v7 offset:34912
s_waitcnt lgkmcnt(15)
v_mfma_f32_16x16x32_bf16 v[60:63], a[60:63], v[124:127], v[60:63]
v_mfma_f32_16x16x32_bf16 v[44:47], a[60:63], v[120:123], v[44:47]
s_waitcnt vmcnt(11) lgkmcnt(14)
v_mfma_f32_16x16x32_bf16 v[32:35], a[0:3], v[64:67], v[32:35]
ds_read_b64_tr_b16 a[32:33], v7 offset:41600
ds_read_b64_tr_b16 a[34:35], v7 offset:42112
s_waitcnt vmcnt(10)
v_mfma_f32_16x16x32_bf16 v[48:51], a[0:3], v[68:71], v[48:51]
buffer_load_dwordx4 v[112:115], v4, s[16:19], s52 offen sc1
s_waitcnt lgkmcnt(14)
v_mfma_f32_16x16x32_bf16 v[52:55], a[4:7], v[68:71], v[52:55]
ds_read_b64_tr_b16 a[36:37], v7 offset:41632
ds_read_b64_tr_b16 a[38:39], v7 offset:42144
v_mfma_f32_16x16x32_bf16 v[36:39], a[4:7], v[64:67], v[36:39]
ds_read_b64_tr_b16 a[40:41], v7 offset:41664
ds_read_b64_tr_b16 a[42:43], v7 offset:42176
s_waitcnt lgkmcnt(15)
v_mfma_f32_16x16x32_bf16 v[40:43], a[8:11], v[64:67], v[40:43]
buffer_load_dwordx4 v[116:119], v4, s[16:19], s52 offen offset:1024 sc1
v_mfma_f32_16x16x32_bf16 v[56:59], a[8:11], v[68:71], v[56:59]
ds_read_b64_tr_b16 a[44:45], v7 offset:41696
s_add_u32 s52, s52, 0x40000
s_waitcnt lgkmcnt(15)
v_mfma_f32_16x16x32_bf16 v[60:63], a[12:15], v[68:71], v[60:63]
ds_read_b64_tr_b16 a[46:47], v7 offset:42208
v_mfma_f32_16x16x32_bf16 v[44:47], a[12:15], v[64:67], v[44:47]
ds_read_b64_tr_b16 a[48:49], v7 offset:42624
ds_read_b64_tr_b16 a[50:51], v7 offset:43136
s_waitcnt vmcnt(11) lgkmcnt(15)
v_mfma_f32_16x16x32_bf16 v[32:35], a[16:19], v[72:75], v[32:35]
buffer_load_dwordx4 v[120:123], v4, s[16:19], s53 offen sc1
s_waitcnt vmcnt(11)
v_mfma_f32_16x16x32_bf16 v[48:51], a[16:19], v[76:79], v[48:51]
ds_read_b64_tr_b16 a[52:53], v7 offset:42656
ds_read_b64_tr_b16 a[54:55], v7 offset:43168
s_waitcnt lgkmcnt(15)
v_mfma_f32_16x16x32_bf16 v[52:55], a[20:23], v[76:79], v[52:55]
ds_read_b64_tr_b16 a[56:57], v7 offset:42688
ds_read_b64_tr_b16 a[58:59], v7 offset:43200
v_mfma_f32_16x16x32_bf16 v[36:39], a[20:23], v[72:75], v[36:39]
buffer_load_dwordx4 v[124:127], v4, s[16:19], s53 offen offset:1024 sc1
s_waitcnt lgkmcnt(15)
v_mfma_f32_16x16x32_bf16 v[40:43], a[24:27], v[72:75], v[40:43]
ds_read_b64_tr_b16 a[60:61], v7 offset:42720
s_add_u32 s53, s53, 0x40000
v_mfma_f32_16x16x32_bf16 v[56:59], a[24:27], v[76:79], v[56:59]
ds_read_b64_tr_b16 a[62:63], v7 offset:43232
s_waitcnt lgkmcnt(15)
v_mfma_f32_16x16x32_bf16 v[60:63], a[28:31], v[76:79], v[60:63]
v_mfma_f32_16x16x32_bf16 v[44:47], a[28:31], v[72:75], v[44:47]
s_waitcnt lgkmcnt(0)
s_barrier
s_waitcnt vmcnt(11)
v_mfma_f32_16x16x32_bf16 v[32:35], a[32:35], v[80:83], v[32:35]
ds_read_b64_tr_b16 a[0:1], v7 offset:49920
ds_read_b64_tr_b16 a[2:3], v7 offset:50432
s_add_u32 m0, s59, 84480
s_waitcnt vmcnt(10)
v_mfma_f32_16x16x32_bf16 v[48:51], a[32:35], v[84:87], v[48:51]
ds_read_b64_tr_b16 a[4:5], v7 offset:49952
buffer_load_dwordx4 v12, s[32:35], s58 offen lds
v_mfma_f32_16x16x32_bf16 v[52:55], a[36:39], v[84:87], v[52:55]
ds_read_b64_tr_b16 a[6:7], v7 offset:50464
ds_read_b64_tr_b16 a[8:9], v7 offset:49984
v_mfma_f32_16x16x32_bf16 v[36:39], a[36:39], v[80:83], v[36:39]
ds_read_b64_tr_b16 a[10:11], v7 offset:50496
v_mfma_f32_16x16x32_bf16 v[40:43], a[40:43], v[80:83], v[40:43]
ds_read_b64_tr_b16 a[12:13], v7 offset:50016
buffer_load_dwordx4 v13, s[32:35], s58 offen offset:1056 lds
v_mfma_f32_16x16x32_bf16 v[56:59], a[40:43], v[84:87], v[56:59]
ds_read_b64_tr_b16 a[14:15], v7 offset:50528
ds_read_b64_tr_b16 a[16:17], v7 offset:50944
v_mfma_f32_16x16x32_bf16 v[60:63], a[44:47], v[84:87], v[60:63]
ds_read_b64_tr_b16 a[18:19], v7 offset:51456
ds_read_b64_tr_b16 a[20:21], v7 offset:50976
v_mfma_f32_16x16x32_bf16 v[44:47], a[44:47], v[80:83], v[44:47]
ds_read_b64_tr_b16 a[22:23], v7 offset:51488
s_waitcnt vmcnt(11)
v_mfma_f32_16x16x32_bf16 v[32:35], a[48:51], v[88:91], v[32:35]
ds_read_b64_tr_b16 a[24:25], v7 offset:51008
buffer_load_dwordx4 v14, s[32:35], s58 offen offset:2112 lds
s_waitcnt vmcnt(11)
v_mfma_f32_16x16x32_bf16 v[48:51], a[48:51], v[92:95], v[48:51]
ds_read_b64_tr_b16 a[26:27], v7 offset:51520
ds_read_b64_tr_b16 a[28:29], v7 offset:51040
v_mfma_f32_16x16x32_bf16 v[52:55], a[52:55], v[92:95], v[52:55]
ds_read_b64_tr_b16 a[30:31], v7 offset:51552
v_mfma_f32_16x16x32_bf16 v[36:39], a[52:55], v[88:91], v[36:39]
buffer_load_dwordx4 v15, s[32:35], s58 offen offset:3168 lds
v_mfma_f32_16x16x32_bf16 v[40:43], a[56:59], v[88:91], v[40:43]
s_add_u32 s58, s58, 229376
v_mfma_f32_16x16x32_bf16 v[56:59], a[56:59], v[92:95], v[56:59]
v_mfma_f32_16x16x32_bf16 v[60:63], a[60:63], v[92:95], v[60:63]
v_mfma_f32_16x16x32_bf16 v[44:47], a[60:63], v[88:91], v[44:47]
s_waitcnt vmcnt(11) lgkmcnt(14)
v_mfma_f32_16x16x32_bf16 v[32:35], a[0:3], v[96:99], v[32:35]
ds_read_b64_tr_b16 a[32:33], v7 offset:58240
s_add_u32 m0, s59, 101376
s_waitcnt vmcnt(10)
v_mfma_f32_16x16x32_bf16 v[48:51], a[0:3], v[100:103], v[48:51]
buffer_load_dwordx4 v12, s[32:35], s58 offen lds
s_waitcnt lgkmcnt(13)
v_mfma_f32_16x16x32_bf16 v[52:55], a[4:7], v[100:103], v[52:55]
ds_read_b64_tr_b16 a[34:35], v7 offset:58752
ds_read_b64_tr_b16 a[36:37], v7 offset:58272
v_mfma_f32_16x16x32_bf16 v[36:39], a[4:7], v[96:99], v[36:39]
ds_read_b64_tr_b16 a[38:39], v7 offset:58784
ds_read_b64_tr_b16 a[40:41], v7 offset:58304
s_waitcnt lgkmcnt(15)
v_mfma_f32_16x16x32_bf16 v[40:43], a[8:11], v[96:99], v[40:43]
buffer_load_dwordx4 v13, s[32:35], s58 offen offset:1056 lds
v_mfma_f32_16x16x32_bf16 v[56:59], a[8:11], v[100:103], v[56:59]
ds_read_b64_tr_b16 a[42:43], v7 offset:58816
ds_read_b64_tr_b16 a[44:45], v7 offset:58336
s_waitcnt lgkmcnt(15)
v_mfma_f32_16x16x32_bf16 v[60:63], a[12:15], v[100:103], v[60:63]
ds_read_b64_tr_b16 a[46:47], v7 offset:58848
v_mfma_f32_16x16x32_bf16 v[44:47], a[12:15], v[96:99], v[44:47]
ds_read_b64_tr_b16 a[48:49], v7 offset:59264
ds_read_b64_tr_b16 a[50:51], v7 offset:59776
s_waitcnt vmcnt(11) lgkmcnt(15)
v_mfma_f32_16x16x32_bf16 v[32:35], a[16:19], v[104:107], v[32:35]
buffer_load_dwordx4 v14, s[32:35], s58 offen offset:2112 lds
s_waitcnt vmcnt(11)
v_mfma_f32_16x16x32_bf16 v[48:51], a[16:19], v[108:111], v[48:51]
ds_read_b64_tr_b16 a[52:53], v7 offset:59296
ds_read_b64_tr_b16 a[54:55], v7 offset:59808
s_waitcnt lgkmcnt(15)
v_mfma_f32_16x16x32_bf16 v[52:55], a[20:23], v[108:111], v[52:55]
ds_read_b64_tr_b16 a[56:57], v7 offset:59328
ds_read_b64_tr_b16 a[58:59], v7 offset:59840
v_mfma_f32_16x16x32_bf16 v[36:39], a[20:23], v[104:107], v[36:39]
buffer_load_dwordx4 v15, s[32:35], s58 offen offset:3168 lds
s_waitcnt lgkmcnt(15)
v_mfma_f32_16x16x32_bf16 v[40:43], a[24:27], v[104:107], v[40:43]
ds_read_b64_tr_b16 a[60:61], v7 offset:59360
s_add_u32 s58, s58, 229376
v_mfma_f32_16x16x32_bf16 v[56:59], a[24:27], v[108:111], v[56:59]
ds_read_b64_tr_b16 a[62:63], v7 offset:59872
s_waitcnt lgkmcnt(15)
v_mfma_f32_16x16x32_bf16 v[60:63], a[28:31], v[108:111], v[60:63]
v_mfma_f32_16x16x32_bf16 v[44:47], a[28:31], v[104:107], v[44:47]
s_waitcnt vmcnt(11) lgkmcnt(14)
v_mfma_f32_16x16x32_bf16 v[32:35], a[32:35], v[112:115], v[32:35]
s_add_u32 m0, s59, 118272
s_lshl_b32 s64, s6, 14
s_lshl_b32 s65, s49, 13
s_waitcnt vmcnt(10)
v_mfma_f32_16x16x32_bf16 v[48:51], a[32:35], v[116:119], v[48:51]
buffer_load_dwordx4 v12, s[32:35], s58 offen lds
s_waitcnt lgkmcnt(12)
v_mfma_f32_16x16x32_bf16 v[52:55], a[36:39], v[116:119], v[52:55]
s_add_u32 s64, s64, s65
s_lshl_b32 s65, s7, 9
s_add_u32 s64, s64, s65
v_mfma_f32_16x16x32_bf16 v[36:39], a[36:39], v[112:115], v[36:39]
s_lshl_b32 s65, s48, 8
s_add_u32 s64, s64, s65
s_add_u32 s64, s64, 29622272
s_waitcnt lgkmcnt(10)
v_mfma_f32_16x16x32_bf16 v[40:43], a[40:43], v[112:115], v[40:43]
s_lshl_b32 s62, s7, 18
v_and_b32 v152, 31, v1
v_lshlrev_b32 v152, 3, v152
v_mfma_f32_16x16x32_bf16 v[56:59], a[40:43], v[116:119], v[56:59]
buffer_load_dwordx4 v13, s[32:35], s58 offen offset:1056 lds
s_waitcnt lgkmcnt(8)
v_mfma_f32_16x16x32_bf16 v[60:63], a[44:47], v[116:119], v[60:63]
s_add_u32 s62, s62, 8388608
v_lshrrev_b32 v153, 5, v1
v_lshl_add_u32 v152, v153, 28, v152
v_mfma_f32_16x16x32_bf16 v[44:47], a[44:47], v[112:115], v[44:47]
s_add_u32 s63, s62, 0x20000
s_waitcnt vmcnt(11) lgkmcnt(6)
v_mfma_f32_16x16x32_bf16 v[32:35], a[48:51], v[120:123], v[32:35]
s_waitcnt vmcnt(10)
v_mfma_f32_16x16x32_bf16 v[48:51], a[48:51], v[124:127], v[48:51]
buffer_load_dwordx4 v14, s[32:35], s58 offen offset:2112 lds
s_waitcnt lgkmcnt(4)
v_mfma_f32_16x16x32_bf16 v[52:55], a[52:55], v[124:127], v[52:55]
s_nop 2
v_cvt_pk_bf16_f32 v128, v32, v33
v_cvt_pk_bf16_f32 v129, v34, v35
v_mfma_f32_16x16x32_bf16 v[36:39], a[52:55], v[120:123], v[36:39]
v_cvt_pk_bf16_f32 v136, v48, v49
v_cvt_pk_bf16_f32 v137, v50, v51
s_waitcnt lgkmcnt(2)
v_mfma_f32_16x16x32_bf16 v[40:43], a[56:59], v[120:123], v[40:43]
v_cvt_pk_bf16_f32 v138, v52, v53
v_cvt_pk_bf16_f32 v139, v54, v55
v_mfma_f32_16x16x32_bf16 v[56:59], a[56:59], v[124:127], v[56:59]
buffer_load_dwordx4 v15, s[32:35], s58 offen offset:3168 lds
s_waitcnt lgkmcnt(0)
v_mfma_f32_16x16x32_bf16 v[60:63], a[60:63], v[124:127], v[60:63]
s_add_u32 s58, s58, 229376
v_cvt_pk_bf16_f32 v130, v36, v37
v_cvt_pk_bf16_f32 v131, v38, v39
v_mfma_f32_16x16x32_bf16 v[44:47], a[60:63], v[120:123], v[44:47]
v_cvt_pk_bf16_f32 v132, v40, v41
v_cvt_pk_bf16_f32 v133, v42, v43
v_cvt_pk_bf16_f32 v140, v56, v57
v_cvt_pk_bf16_f32 v141, v58, v59
v_cvt_pk_bf16_f32 v142, v60, v61
v_cvt_pk_bf16_f32 v143, v62, v63
v_pk_mul_f32 v[146:147], v[32:33], v[32:33]
buffer_store_dwordx4 v[128:131], v4, s[16:19], s62 offen sc1
v_cvt_pk_bf16_f32 v134, v44, v45
v_cvt_pk_bf16_f32 v135, v46, v47
v_pk_mul_f32 v[150:151], v[48:49], v[48:49]
v_pk_fma_f32 v[146:147], v[34:35], v[34:35], v[146:147]
v_pk_add_f32 v[144:145], v[32:33], v[34:35]
v_pk_fma_f32 v[150:151], v[50:51], v[50:51], v[150:151]
v_pk_add_f32 v[148:149], v[48:49], v[50:51]
v_pk_fma_f32 v[146:147], v[36:37], v[36:37], v[146:147]
v_pk_add_f32 v[144:145], v[144:145], v[36:37]
v_pk_fma_f32 v[150:151], v[52:53], v[52:53], v[150:151]
v_pk_add_f32 v[148:149], v[148:149], v[52:53]
v_pk_fma_f32 v[146:147], v[38:39], v[38:39], v[146:147]
v_pk_add_f32 v[144:145], v[144:145], v[38:39]
buffer_store_dwordx4 v[132:135], v4, s[16:19], s63 offen sc1
v_pk_fma_f32 v[150:151], v[54:55], v[54:55], v[150:151]
v_pk_add_f32 v[148:149], v[148:149], v[54:55]
v_pk_fma_f32 v[146:147], v[40:41], v[40:41], v[146:147]
v_pk_add_f32 v[144:145], v[144:145], v[40:41]
v_pk_fma_f32 v[150:151], v[56:57], v[56:57], v[150:151]
v_pk_add_f32 v[148:149], v[148:149], v[56:57]
v_pk_fma_f32 v[146:147], v[42:43], v[42:43], v[146:147]
v_pk_add_f32 v[144:145], v[144:145], v[42:43]
v_pk_fma_f32 v[150:151], v[58:59], v[58:59], v[150:151]
v_pk_add_f32 v[148:149], v[148:149], v[58:59]
v_pk_fma_f32 v[146:147], v[44:45], v[44:45], v[146:147]
v_pk_add_f32 v[144:145], v[144:145], v[44:45]
v_pk_fma_f32 v[150:151], v[60:61], v[60:61], v[150:151]
buffer_store_dwordx4 v[136:139], v4, s[16:19], s62 offen offset:1024 sc1
v_pk_add_f32 v[148:149], v[148:149], v[60:61]
v_pk_fma_f32 v[146:147], v[46:47], v[46:47], v[146:147]
v_pk_add_f32 v[144:145], v[144:145], v[46:47]
v_pk_fma_f32 v[150:151], v[62:63], v[62:63], v[150:151]
v_pk_add_f32 v[148:149], v[148:149], v[62:63]
v_add_f32 v144, v144, v145
v_add_f32 v146, v146, v147
v_add_f32 v148, v148, v149
v_add_f32 v150, v150, v151
s_nop 0
v_permlane16_swap_b32 v144, v148
v_permlane16_swap_b32 v146, v150
v_add_f32 v144, v144, v148
buffer_store_dwordx4 v[140:143], v4, s[16:19], s63 offen offset:1024 sc1
v_add_f32 v146, v146, v150
s_nop 1
v_permlane32_swap_b32 v144, v146
v_add_f32 v144, v144, v146
s_nop 1
v_permlane32_swap_b32 v144, v145
buffer_store_dwordx2 v[144:145], v152, s[16:19], s64 offen sc1
s_nop 1
v_accvgpr_write_b32 a224, v32
v_accvgpr_write_b32 a225, v33
v_accvgpr_write_b32 a226, v34
v_accvgpr_write_b32 a227, v35
v_accvgpr_write_b32 a228, v36
v_accvgpr_write_b32 a229, v37
v_accvgpr_write_b32 a230, v38
v_accvgpr_write_b32 a231, v39
v_accvgpr_write_b32 a232, v40
v_accvgpr_write_b32 a233, v41
v_accvgpr_write_b32 a234, v42
v_accvgpr_write_b32 a235, v43
v_accvgpr_write_b32 a236, v44
v_accvgpr_write_b32 a237, v45
v_accvgpr_write_b32 a238, v46
v_accvgpr_write_b32 a239, v47
v_accvgpr_write_b32 a240, v48
v_accvgpr_write_b32 a241, v49
v_accvgpr_write_b32 a242, v50
v_accvgpr_write_b32 a243, v51
v_accvgpr_write_b32 a244, v52
v_accvgpr_write_b32 a245, v53
v_accvgpr_write_b32 a246, v54
v_accvgpr_write_b32 a247, v55
v_accvgpr_write_b32 a248, v56
v_accvgpr_write_b32 a249, v57
v_accvgpr_write_b32 a250, v58
v_accvgpr_write_b32 a251, v59
v_accvgpr_write_b32 a252, v60
v_accvgpr_write_b32 a253, v61
v_accvgpr_write_b32 a254, v62
v_accvgpr_write_b32 a255, v63
s_lshl_b32 s62, s10, 14
s_lshl_b32 s63, s3, 12
s_add_u32 s62, s62, s63
s_lshl_b32 s63, s12, 11
s_add_u32 s62, s62, s63
v_lshl_add_u32 v10, v1, 4, s62
v_lshrrev_b32 v2, 3, v1
v_cmp_eq_u32 vcc, 3, v2
v_add_u32 v2, 67108480, v10
s_nop 0
v_cndmask_b32 v10, v10, v2, vcc
v_xor_b32 v11, 2048, v10
v_bfe_u32 v16, v1, 2, 3
v_mul_u32_u24 v16, 1056, v16
v_bfe_u32 v2, v1, 5, 1
v_lshl_add_u32 v16, v2, 8, v16
v_and_b32 v2, 3, v1
v_lshl_add_u32 v16, v2, 3, v16
s_lshl_b32 s62, s12, 6
s_add_u32 s62, s62, 84480
s_xor_b32 s63, s12, 1
s_mul_i32 s63, s63, 192
s_add_u32 s63, s63, 84480
v_add_u32 v17, s63, v16
v_add_u32 v16, s62, v16
s_mov_b32 s52, 8388608
s_mov_b32 s54, s58
s_mov_b32 s55, s59
s_mul_i32 s59, s3, 2112
s_and_b32 s62, s7, 1
s_mul_i32 s62, s62, 3670016
s_lshr_b32 s63, s7, 1
s_lshl_b32 s63, s63, 8
s_add_u32 s62, s62, s63
s_lshl_b32 s63, s3, 12
s_add_u32 s62, s62, s63
v_lshrrev_b32 v5, 4, v1
v_lshlrev_b32 v5, 14, v5
v_and_b32 v2, 15, v1
v_lshl_add_u32 v5, v2, 4, v5
v_add_u32 v5, s62, v5
v_add_u32 v6, 992, v5
s_lshl_b32 s62, s10, 15
s_lshl_b32 s63, s3, 13
s_add_u32 s62, s62, s63
v_lshl_add_u32 v4, v1, 4, s62
s_and_b32 s47, s5, 3
s_lshr_b32 s63, s5, 2
s_lshl_b32 s63, s63, 3
s_add_u32 s63, s63, s4
s_lshl_b32 s62, s63, 1
s_add_u32 s62, s62, s48
s_mul_i32 s62, s62, 1792
v_lshrrev_b32 v7, 2, v1
v_min_u32 v8, 13, v7
v_lshl_add_u32 v8, v8, 7, s62
s_lshl_b32 s62, s63, 2
s_add_u32 s62, s62, s3
s_mul_i32 s62, s62, 640
v_and_b32 v7, 7, v7
v_min_u32 v7, 4, v7
v_lshl_add_u32 v7, v7, 7, s62
v_lshrrev_b32 v2, 5, v1
v_mul_u32_u24 v2, 3670016, v2
v_add_u32 v7, v7, v2
s_mul_i32 s44, s47, 163840
s_add_u32 s45, s47, 12
s_mul_i32 s45, s45, 229376
v_and_b32 v2, 1, v1
v_lshlrev_b32 v2, 4, v2
v_mov_b32 v9, 0x3f80
v_lshlrev_b32 v2, v2, v9
v_bfe_u32 v9, v1, 1, 3
v_cmp_eq_u32 vcc, 0, v9
s_nop 1
v_cndmask_b32 v20, 0, v2, vcc
v_cmp_eq_u32 vcc, 1, v9
s_nop 1
v_cndmask_b32 v21, 0, v2, vcc
v_cmp_eq_u32 vcc, 2, v9
s_nop 1
v_cndmask_b32 v22, 0, v2, vcc
v_cmp_eq_u32 vcc, 3, v9
s_nop 1
v_cndmask_b32 v23, 0, v2, vcc
s_add_u32 s62, s55, 84480
v_lshl_add_u32 v9, v1, 4, s62
v_mov_b64 v[24:25], 0
v_mov_b64 v[26:27], 0
s_lshl_b32 s62, s6, 10
s_add_u32 s62, s62, 30441472
s_lshl_b32 s64, s10, 1
s_lshl_b32 s64, s64, 10
s_add_u32 s64, s64, 30441472
s_lshr_b32 s67, s5, 2
s_and_b32 s67, s67, 3
s_lshl_b32 s67, s67, 7
s_add_u32 s64, s64, s67
s_add_u32 s65, s64, 1024
v_lshl_add_u32 v252, v1, 7, s62
v_mov_b32 v253, s64
v_writelane_b32 v253, s65, 1
s_waitcnt vmcnt(0) lgkmcnt(0)
s_barrier
s_cmp_lg_u32 s3, 0
s_cbranch_scc1 .Lnosig37
v_mov_b32 v255, 1
s_mov_b64 exec, 15
buffer_atomic_add v255, v252, s[16:19], 0 offen
s_mov_b64 exec, -1
.Lnosig37:
s_cmp_lg_u32 s3, 1
s_cbranch_scc1 .Lnopoll40
s_mov_b64 exec, 3
s_mov_b32 s15, 0
s_mov_b64 exec, 3
v_mov_b32 v254, 0
buffer_atomic_add v254, v253, s[16:19], 0 offen sc0
.Lpoll38:
s_waitcnt vmcnt(0)
v_cmp_ne_u32 vcc, 16, v254
s_add_u32 s15, s15, 1
s_cbranch_vccz .Lnopoll40r
s_mov_b64 exec, 3
v_mov_b32 v254, 0
buffer_atomic_add v254, v253, s[16:19], 0 offen sc0
s_cmp_le_u32 s15, 100000
s_cbranch_scc1 .Lpoll38
.Lgot39:
s_waitcnt vmcnt(0)
s_branch .Lnopoll40r
.Lnopoll40:
s_mov_b64 exec, 0
s_cmp_eq_u32 s3, 2
s_cbranch_scc1 .Lpad2
s_cmp_eq_u32 s3, 3
s_cbranch_scc1 .Lpad3
s_branch .Lpad4
.Lnopoll40r:
s_mov_b64 exec, -1
s_barrier
buffer_load_dwordx4 a[128:131], v10, s[16:19], s52 offen sc1
buffer_load_dwordx4 a[132:135], v10, s[16:19], s52 offen offset:1024 sc1
buffer_load_dwordx4 a[136:139], v11, s[16:19], s52 offen sc1
buffer_load_dwordx4 a[140:143], v11, s[16:19], s52 offen offset:1024 sc1
s_add_u32 s52, s52, 0x20000
buffer_load_dwordx4 a[144:147], v10, s[16:19], s52 offen sc1
buffer_load_dwordx4 a[148:151], v10, s[16:19], s52 offen offset:1024 sc1
buffer_load_dwordx4 a[152:155], v11, s[16:19], s52 offen sc1
buffer_load_dwordx4 a[156:159], v11, s[16:19], s52 offen offset:1024 sc1
s_add_u32 s52, s52, 0x20000
ds_read_b64_tr_b16 a[0:1], v16
ds_read_b64_tr_b16 a[2:3], v16 offset:512
ds_read_b64_tr_b16 a[4:5], v16 offset:32
ds_read_b64_tr_b16 a[6:7], v16 offset:544
ds_read_b64_tr_b16 a[8:9], v16 offset:8448
ds_read_b64_tr_b16 a[10:11], v16 offset:8960
ds_read_b64_tr_b16 a[12:13], v16 offset:8480
ds_read_b64_tr_b16 a[14:15], v16 offset:8992
ds_read_b64_tr_b16 a[16:17], v16 offset:64
ds_read_b64_tr_b16 a[18:19], v16 offset:576
ds_read_b64_tr_b16 a[20:21], v16 offset:96
ds_read_b64_tr_b16 a[22:23], v16 offset:608
ds_read_b64_tr_b16 a[24:25], v16 offset:8512
ds_read_b64_tr_b16 a[26:27], v16 offset:9024
ds_read_b64_tr_b16 a[28:29], v16 offset:8544
ds_read_b64_tr_b16 a[30:31], v16 offset:9056
ds_read_b64_tr_b16 a[32:33], v16 offset:128
ds_read_b64_tr_b16 a[34:35], v16 offset:640
ds_read_b64_tr_b16 a[36:37], v16 offset:160
ds_read_b64_tr_b16 a[38:39], v16 offset:672
ds_read_b64_tr_b16 a[40:41], v16 offset:8576
ds_read_b64_tr_b16 a[42:43], v16 offset:9088
ds_read_b64_tr_b16 a[44:45], v16 offset:8608
ds_read_b64_tr_b16 a[46:47], v16 offset:9120
ds_read_b64_tr_b16 a[48:49], v17
ds_read_b64_tr_b16 a[50:51], v17 offset:512
ds_read_b64_tr_b16 a[52:53], v17 offset:32
ds_read_b64_tr_b16 a[54:55], v17 offset:544
ds_read_b64_tr_b16 a[56:57], v17 offset:8448
ds_read_b64_tr_b16 a[58:59], v17 offset:8960
ds_read_b64_tr_b16 a[60:61], v17 offset:8480
ds_read_b64_tr_b16 a[62:63], v17 offset:8992
ds_read_b128 a[192:195], v9
ds_read_b128 a[196:199], v9 offset:1056
ds_read_b128 a[200:203], v9 offset:2112
ds_read_b128 a[204:207], v9 offset:3168
s_add_u32 m0, s55, 135168
s_nop 0
buffer_load_dwordx4 v12, s[32:35], s54 offen lds
buffer_load_dwordx4 v13, s[32:35], s54 offen offset:1056 lds
buffer_load_dwordx4 v14, s[32:35], s54 offen offset:2112 lds
buffer_load_dwordx4 v15, s[32:35], s54 offen offset:3168 lds
s_add_u32 s54, s54, 229376
s_mul_i32 s66, s13, 917504
s_add_u32 s66, s66, 12582912
s_add_u32 s65, s66, 393216
s_lshl_b32 s62, s12, 19
s_add_u32 s62, s62, s66
s_add_u32 s63, s62, 0x20000
s_add_u32 s64, s62, 0x40000
s_lshl_b32 s74, s3, 13
s_add_u32 s74, s74, 49920
v_lshl_add_u32 v2, v1, 3, s74
s_waitcnt lgkmcnt(0)
s_barrier
s_waitcnt vmcnt(11)
v_mfma_f32_16x16x32_bf16 v[32:35], a[0:3], a[128:131], 0
buffer_load_dwordx4 a[160:163], v10, s[16:19], s52 offen sc1
s_waitcnt vmcnt(11)
v_mfma_f32_16x16x32_bf16 v[36:39], a[0:3], a[132:135], 0
ds_read_b64_tr_b16 a[64:65], v16 offset:16896
v_mfma_f32_16x16x32_bf16 v[52:55], a[4:7], a[132:135], 0
ds_read_b64_tr_b16 a[66:67], v16 offset:17408
v_mfma_f32_16x16x32_bf16 v[48:51], a[4:7], a[128:131], 0
ds_read_b64_tr_b16 a[68:69], v16 offset:16928
v_mfma_f32_16x16x32_bf16 v[64:67], a[8:11], a[128:131], 0
buffer_load_dwordx4 a[164:167], v10, s[16:19], s52 offen offset:1024 sc1
v_mfma_f32_16x16x32_bf16 v[68:71], a[8:11], a[132:135], 0
ds_read_b64_tr_b16 a[70:71], v16 offset:17440
v_mfma_f32_16x16x32_bf16 v[24:27], v[20:23], a[192:195], v[24:27]
ds_read_b64_tr_b16 a[72:73], v16 offset:25344
v_mfma_f32_16x16x32_bf16 v[84:87], a[12:15], a[132:135], 0
ds_read_b64_tr_b16 a[74:75], v16 offset:25856
v_mfma_f32_16x16x32_bf16 v[80:83], a[12:15], a[128:131], 0
buffer_load_dwordx4 a[168:171], v11, s[16:19], s52 offen sc1
v_mfma_f32_16x16x32_bf16 v[96:99], a[16:19], a[128:131], 0
ds_read_b64_tr_b16 a[76:77], v16 offset:25376
v_mfma_f32_16x16x32_bf16 v[100:103], a[16:19], a[132:135], 0
ds_read_b64_tr_b16 a[78:79], v16 offset:25888
v_mfma_f32_16x16x32_bf16 v[116:119], a[20:23], a[132:135], 0
ds_read_b64_tr_b16 a[80:81], v16 offset:16960
v_mfma_f32_16x16x32_bf16 v[112:115], a[20:23], a[128:131], 0
buffer_load_dwordx4 a[172:175], v11, s[16:19], s52 offen offset:1024 sc1
v_mfma_f32_16x16x32_bf16 v[128:131], a[24:27], a[128:131], 0
s_add_u32 s52, s52, 0x20000
s_add_u32 m0, s55, 84480
v_mfma_f32_16x16x32_bf16 v[132:135], a[24:27], a[132:135], 0
ds_read_b64_tr_b16 a[82:83], v16 offset:17472
v_mfma_f32_16x16x32_bf16 v[148:151], a[28:31], a[132:135], 0
ds_read_b64_tr_b16 a[84:85], v16 offset:16992
v_mfma_f32_16x16x32_bf16 v[144:147], a[28:31], a[128:131], 0
buffer_load_dwordx4 v12, s[32:35], s54 offen lds
v_mfma_f32_16x16x32_bf16 v[160:163], a[32:35], a[128:131], 0
.Lpad2:
s_cbranch_execz .Lpad5
ds_read_b64_tr_b16 a[86:87], v16 offset:17504
v_mfma_f32_16x16x32_bf16 v[164:167], a[32:35], a[132:135], 0
ds_read_b64_tr_b16 a[88:89], v16 offset:25408
v_mfma_f32_16x16x32_bf16 v[24:27], v[20:23], a[196:199], v[24:27]
ds_read_b64_tr_b16 a[90:91], v16 offset:25920
v_mfma_f32_16x16x32_bf16 v[180:183], a[36:39], a[132:135], 0
buffer_load_dwordx4 a[176:179], v10, s[16:19], s52 offen sc1
v_mfma_f32_16x16x32_bf16 v[176:179], a[36:39], a[128:131], 0
ds_read_b64_tr_b16 a[92:93], v16 offset:25440
v_mfma_f32_16x16x32_bf16 v[192:195], a[40:43], a[128:131], 0
ds_read_b64_tr_b16 a[94:95], v16 offset:25952
v_mfma_f32_16x16x32_bf16 v[196:199], a[40:43], a[132:135], 0
ds_read_b64_tr_b16 a[96:97], v16 offset:17024
v_mfma_f32_16x16x32_bf16 v[212:215], a[44:47], a[132:135], 0
buffer_load_dwordx4 v13, s[32:35], s54 offen offset:1056 lds
v_mfma_f32_16x16x32_bf16 v[208:211], a[44:47], a[128:131], 0
ds_read_b64_tr_b16 a[98:99], v16 offset:17536
v_mfma_f32_16x16x32_bf16 v[224:227], a[48:51], a[128:131], 0
ds_read_b64_tr_b16 a[100:101], v16 offset:17056
v_mfma_f32_16x16x32_bf16 v[228:231], a[48:51], a[132:135], 0
ds_read_b64_tr_b16 a[102:103], v16 offset:17568
v_mfma_f32_16x16x32_bf16 v[236:239], a[52:55], a[132:135], 0
buffer_load_dwordx4 a[180:183], v10, s[16:19], s52 offen offset:1024 sc1
v_mfma_f32_16x16x32_bf16 v[232:235], a[52:55], a[128:131], 0
ds_read_b64_tr_b16 a[104:105], v16 offset:25472
v_mfma_f32_16x16x32_bf16 v[240:243], a[56:59], a[128:131], 0
ds_read_b64_tr_b16 a[106:107], v16 offset:25984
v_mfma_f32_16x16x32_bf16 v[244:247], a[56:59], a[132:135], 0
ds_read_b64_tr_b16 a[108:109], v16 offset:25504
v_mfma_f32_16x16x32_bf16 v[24:27], v[20:23], a[200:203], v[24:27]
buffer_load_dwordx4 v14, s[32:35], s54 offen offset:2112 lds
v_mfma_f32_16x16x32_bf16 v[252:255], a[60:63], a[132:135], 0
ds_read_b64_tr_b16 a[110:111], v16 offset:26016
v_mfma_f32_16x16x32_bf16 v[248:251], a[60:63], a[128:131], 0
ds_read_b64_tr_b16 a[112:113], v17 offset:16896
s_waitcnt vmcnt(17)
v_mfma_f32_16x16x32_bf16 v[220:223], a[44:47], a[140:143], 0
ds_read_b64_tr_b16 a[114:115], v17 offset:17408
v_mfma_f32_16x16x32_bf16 v[216:219], a[44:47], a[136:139], 0
buffer_load_dwordx4 a[184:187], v11, s[16:19], s52 offen sc1
v_mfma_f32_16x16x32_bf16 v[200:203], a[40:43], a[136:139], 0
ds_read_b64_tr_b16 a[116:117], v17 offset:16928
v_mfma_f32_16x16x32_bf16 v[204:207], a[40:43], a[140:143], 0
ds_read_b64_tr_b16 a[118:119], v17 offset:17440
v_mfma_f32_16x16x32_bf16 v[188:191], a[36:39], a[140:143], 0
ds_read_b64_tr_b16 a[120:121], v17 offset:25344
v_mfma_f32_16x16x32_bf16 v[184:187], a[36:39], a[136:139], 0
buffer_load_dwordx4 v15, s[32:35], s54 offen offset:3168 lds
v_mfma_f32_16x16x32_bf16 v[168:171], a[32:35], a[136:139], 0
s_add_u32 s54, s54, 229376
ds_read_b64_tr_b16 a[122:123], v17 offset:25856
v_mfma_f32_16x16x32_bf16 v[172:175], a[32:35], a[140:143], 0
ds_read_b64_tr_b16 a[124:125], v17 offset:25376
v_mfma_f32_16x16x32_bf16 v[156:159], a[28:31], a[140:143], 0
ds_read_b64_tr_b16 a[126:127], v17 offset:25888
v_mfma_f32_16x16x32_bf16 v[152:155], a[28:31], a[136:139], 0
buffer_load_dwordx4 a[188:191], v11, s[16:19], s52 offen offset:1024 sc1
v_mfma_f32_16x16x32_bf16 v[24:27], v[20:23], a[204:207], v[24:27]
s_add_u32 s52, s52, 0x20000
ds_read_b128 a[208:211], v9 offset:16896
v_mfma_f32_16x16x32_bf16 v[136:139], a[24:27], a[136:139], 0
ds_read_b128 a[212:215], v9 offset:17952
v_mfma_f32_16x16x32_bf16 v[140:143], a[24:27], a[140:143], 0
ds_read_b128 a[216:219], v9 offset:19008
v_mfma_f32_16x16x32_bf16 v[124:127], a[20:23], a[140:143], 0
ds_read_b128 a[220:223], v9 offset:20064
v_mfma_f32_16x16x32_bf16 v[120:123], a[20:23], a[136:139], 0
v_mfma_f32_16x16x32_bf16 v[104:107], a[16:19], a[136:139], 0
v_mfma_f32_16x16x32_bf16 v[108:111], a[16:19], a[140:143], 0
v_mfma_f32_16x16x32_bf16 v[92:95], a[12:15], a[140:143], 0
v_mfma_f32_16x16x32_bf16 v[88:91], a[12:15], a[136:139], 0
v_mfma_f32_16x16x32_bf16 v[72:75], a[8:11], a[136:139], 0
v_mfma_f32_16x16x32_bf16 v[76:79], a[8:11], a[140:143], 0
v_mfma_f32_16x16x32_bf16 v[60:63], a[4:7], a[140:143], 0
v_mfma_f32_16x16x32_bf16 v[56:59], a[4:7], a[136:139], 0
v_mfma_f32_16x16x32_bf16 v[40:43], a[0:3], a[136:139], 0
v_mfma_f32_16x16x32_bf16 v[44:47], a[0:3], a[140:143], 0
s_waitcnt lgkmcnt(0)
s_barrier
s_waitcnt vmcnt(19)
v_mfma_f32_16x16x32_bf16 v[32:35], a[64:67], a[144:147], v[32:35]
s_add_u32 m0, s74, 0
s_mov_b32 s67, 29622272
s_waitcnt vmcnt(18)
v_mfma_f32_16x16x32_bf16 v[36:39], a[64:67], a[148:151], v[36:39]
buffer_load_dwordx4 v4, s[16:19], s67 offen sc1 lds
v_mfma_f32_16x16x32_bf16 v[52:55], a[68:71], a[148:151], v[52:55]
ds_read_b64_tr_b16 a[0:1], v16 offset:33792
v_mfma_f32_16x16x32_bf16 v[48:51], a[68:71], a[144:147], v[48:51]
ds_read_b64_tr_b16 a[2:3], v16 offset:34304
v_mfma_f32_16x16x32_bf16 v[64:67], a[72:75], a[144:147], v[64:67]
buffer_load_dwordx4 v4, s[16:19], s67 offen offset:1024 sc1 lds
v_mfma_f32_16x16x32_bf16 v[68:71], a[72:75], a[148:151], v[68:71]
ds_read_b64_tr_b16 a[4:5], v16 offset:33824
v_mfma_f32_16x16x32_bf16 v[24:27], v[20:23], a[208:211], v[24:27]
ds_read_b64_tr_b16 a[6:7], v16 offset:34336
v_mfma_f32_16x16x32_bf16 v[84:87], a[76:79], a[148:151], v[84:87]
buffer_load_dwordx4 v4, s[16:19], s67 offen offset:2048 sc1 lds
v_mfma_f32_16x16x32_bf16 v[80:83], a[76:79], a[144:147], v[80:83]
ds_read_b64_tr_b16 a[8:9], v16 offset:42240
v_mfma_f32_16x16x32_bf16 v[96:99], a[80:83], a[144:147], v[96:99]
ds_read_b64_tr_b16 a[10:11], v16 offset:42752
v_mfma_f32_16x16x32_bf16 v[100:103], a[80:83], a[148:151], v[100:103]
buffer_load_dwordx4 v4, s[16:19], s67 offen offset:3072 sc1 lds
v_mfma_f32_16x16x32_bf16 v[116:119], a[84:87], a[148:151], v[116:119]
s_add_u32 m0, s74, 4096
s_mov_b32 s67, 29626368
v_mfma_f32_16x16x32_bf16 v[112:115], a[84:87], a[144:147], v[112:115]
ds_read_b64_tr_b16 a[12:13], v16 offset:42272
v_mfma_f32_16x16x32_bf16 v[128:131], a[88:91], a[144:147], v[128:131]
buffer_load_dwordx4 v4, s[16:19], s67 offen sc1 lds
v_mfma_f32_16x16x32_bf16 v[132:135], a[88:91], a[148:151], v[132:135]
ds_read_b64_tr_b16 a[14:15], v16 offset:42784
v_mfma_f32_16x16x32_bf16 v[148:151], a[92:95], a[148:151], v[148:151]
ds_read_b64_tr_b16 a[16:17], v16 offset:33856
v_mfma_f32_16x16x32_bf16 v[144:147], a[92:95], a[144:147], v[144:147]
buffer_load_dwordx4 v4, s[16:19], s67 offen offset:1024 sc1 lds
v_mfma_f32_16x16x32_bf16 v[160:163], a[96:99], a[144:147], v[160:163]
ds_read_b64_tr_b16 a[18:19], v16 offset:34368
v_mfma_f32_16x16x32_bf16 v[164:167], a[96:99], a[148:151], v[164:167]
ds_read_b64_tr_b16 a[20:21], v16 offset:33888
v_mfma_f32_16x16x32_bf16 v[24:27], v[20:23], a[212:215], v[24:27]
buffer_load_dwordx4 v4, s[16:19], s67 offen offset:2048 sc1 lds
v_mfma_f32_16x16x32_bf16 v[180:183], a[100:103], a[148:151], v[180:183]
ds_read_b64_tr_b16 a[22:23], v16 offset:34400
v_mfma_f32_16x16x32_bf16 v[176:179], a[100:103], a[144:147], v[176:179]
ds_read_b64_tr_b16 a[24:25], v16 offset:42304
v_mfma_f32_16x16x32_bf16 v[192:195], a[104:107], a[144:147], v[192:195]
buffer_load_dwordx4 v4, s[16:19], s67 offen offset:3072 sc1 lds
v_mfma_f32_16x16x32_bf16 v[196:199], a[104:107], a[148:151], v[196:199]
s_add_u32 m0, s55, 101376
ds_read_b64_tr_b16 a[26:27], v16 offset:42816
v_mfma_f32_16x16x32_bf16 v[212:215], a[108:111], a[148:151], v[212:215]
ds_read_b64_tr_b16 a[28:29], v16 offset:42336
v_mfma_f32_16x16x32_bf16 v[208:211], a[108:111], a[144:147], v[208:211]
buffer_load_dwordx4 v12, s[32:35], s54 offen lds
v_mfma_f32_16x16x32_bf16 v[224:227], a[112:115], a[144:147], v[224:227]
ds_read_b64_tr_b16 a[30:31], v16 offset:42848
v_mfma_f32_16x16x32_bf16 v[228:231], a[112:115], a[148:151], v[228:231]
ds_read_b64_tr_b16 a[32:33], v16 offset:33920
v_mfma_f32_16x16x32_bf16 v[236:239], a[116:119], a[148:151], v[236:239]
buffer_load_dwordx4 a[128:131], v10, s[16:19], s52 offen sc1
v_mfma_f32_16x16x32_bf16 v[232:235], a[116:119], a[144:147], v[232:235]
ds_read_b64_tr_b16 a[34:35], v16 offset:34432
v_mfma_f32_16x16x32_bf16 v[240:243], a[120:123], a[144:147], v[240:243]
ds_read_b64_tr_b16 a[36:37], v16 offset:33952
v_mfma_f32_16x16x32_bf16 v[244:247], a[120:123], a[148:151], v[244:247]
buffer_load_dwordx4 v13, s[32:35], s54 offen offset:1056 lds
v_mfma_f32_16x16x32_bf16 v[24:27], v[20:23], a[216:219], v[24:27]
ds_read_b64_tr_b16 a[38:39], v16 offset:34464
v_mfma_f32_16x16x32_bf16 v[252:255], a[124:127], a[148:151], v[252:255]
ds_read_b64_tr_b16 a[40:41], v16 offset:42368
v_mfma_f32_16x16x32_bf16 v[248:251], a[124:127], a[144:147], v[248:251]
buffer_load_dwordx4 a[132:135], v10, s[16:19], s52 offen offset:1024 sc1
s_waitcnt vmcnt(28)
v_mfma_f32_16x16x32_bf16 v[220:223], a[108:111], a[156:159], v[220:223]
ds_read_b64_tr_b16 a[42:43], v16 offset:42880
v_mfma_f32_16x16x32_bf16 v[216:219], a[108:111], a[152:155], v[216:219]
ds_read_b64_tr_b16 a[44:45], v16 offset:42400
v_mfma_f32_16x16x32_bf16 v[200:203], a[104:107], a[152:155], v[200:203]
buffer_load_dwordx4 v14, s[32:35], s54 offen offset:2112 lds
v_mfma_f32_16x16x32_bf16 v[204:207], a[104:107], a[156:159], v[204:207]
ds_read_b64_tr_b16 a[46:47], v16 offset:42912
v_mfma_f32_16x16x32_bf16 v[188:191], a[100:103], a[156:159], v[188:191]
ds_read_b64_tr_b16 a[48:49], v17 offset:33792
v_mfma_f32_16x16x32_bf16 v[184:187], a[100:103], a[152:155], v[184:187]
buffer_load_dwordx4 a[136:139], v11, s[16:19], s52 offen sc1
v_mfma_f32_16x16x32_bf16 v[168:171], a[96:99], a[152:155], v[168:171]
ds_read_b64_tr_b16 a[50:51], v17 offset:34304
v_mfma_f32_16x16x32_bf16 v[172:175], a[96:99], a[156:159], v[172:175]
ds_read_b64_tr_b16 a[52:53], v17 offset:33824
v_mfma_f32_16x16x32_bf16 v[156:159], a[92:95], a[156:159], v[156:159]
buffer_load_dwordx4 v15, s[32:35], s54 offen offset:3168 lds
v_mfma_f32_16x16x32_bf16 v[152:155], a[92:95], a[152:155], v[152:155]
s_add_u32 s54, s54, 229376
ds_read_b64_tr_b16 a[54:55], v17 offset:34336
v_mfma_f32_16x16x32_bf16 v[24:27], v[20:23], a[220:223], v[24:27]
ds_read_b64_tr_b16 a[56:57], v17 offset:42240
v_mfma_f32_16x16x32_bf16 v[136:139], a[88:91], a[152:155], v[136:139]
buffer_load_dwordx4 a[140:143], v11, s[16:19], s52 offen offset:1024 sc1
v_mfma_f32_16x16x32_bf16 v[140:143], a[88:91], a[156:159], v[140:143]
s_add_u32 s52, s52, 0x20000
ds_read_b64_tr_b16 a[58:59], v17 offset:42752
v_mfma_f32_16x16x32_bf16 v[124:127], a[84:87], a[156:159], v[124:127]
ds_read_b64_tr_b16 a[60:61], v17 offset:42272
v_mfma_f32_16x16x32_bf16 v[120:123], a[84:87], a[152:155], v[120:123]
ds_read_b64_tr_b16 a[62:63], v17 offset:42784
v_mfma_f32_16x16x32_bf16 v[104:107], a[80:83], a[152:155], v[104:107]
ds_read_b128 a[192:195], v9 offset:33792
v_mfma_f32_16x16x32_bf16 v[108:111], a[80:83], a[156:159], v[108:111]
ds_read_b128 a[196:199], v9 offset:34848
v_mfma_f32_16x16x32_bf16 v[92:95], a[76:79], a[156:159], v[92:95]
ds_read_b128 a[200:203], v9 offset:35904
v_mfma_f32_16x16x32_bf16 v[88:91], a[76:79], a[152:155], v[88:91]
ds_read_b128 a[204:207], v9 offset:36960
v_mfma_f32_16x16x32_bf16 v[72:75], a[72:75], a[152:155], v[72:75]
v_mfma_f32_16x16x32_bf16 v[76:79], a[72:75], a[156:159], v[76:79]
v_mfma_f32_16x16x32_bf16 v[60:63], a[68:71], a[156:159], v[60:63]
v_mfma_f32_16x16x32_bf16 v[56:59], a[68:71], a[152:155], v[56:59]
v_mfma_f32_16x16x32_bf16 v[40:43], a[64:67], a[152:155], v[40:43]
v_mfma_f32_16x16x32_bf16 v[44:47], a[64:67], a[156:159], v[44:47]
s_waitcnt vmcnt(28) lgkmcnt(0)
s_barrier
s_waitcnt vmcnt(27)
v_mfma_f32_16x16x32_bf16 v[32:35], a[0:3], a[160:163], v[32:35]
s_add_u32 m0, s55, 118272
ds_read_b64_tr_b16 a[64:65], v16 offset:50688
s_waitcnt vmcnt(26)
v_mfma_f32_16x16x32_bf16 v[36:39], a[0:3], a[164:167], v[36:39]
buffer_load_dwordx4 v12, s[32:35], s54 offen lds
v_mfma_f32_16x16x32_bf16 v[52:55], a[4:7], a[164:167], v[52:55]
ds_read_b64_tr_b16 a[66:67], v16 offset:51200
v_mfma_f32_16x16x32_bf16 v[48:51], a[4:7], a[160:163], v[48:51]
ds_read_b64_tr_b16 a[68:69], v16 offset:50720
v_mfma_f32_16x16x32_bf16 v[64:67], a[8:11], a[160:163], v[64:67]
ds_read_b64_tr_b16 a[70:71], v16 offset:51232
v_mfma_f32_16x16x32_bf16 v[68:71], a[8:11], a[164:167], v[68:71]
ds_read_b64_tr_b16 a[72:73], v16 offset:59136
v_mfma_f32_16x16x32_bf16 v[24:27], v[20:23], a[192:195], v[24:27]
ds_read_b64_tr_b16 a[74:75], v16 offset:59648
v_mfma_f32_16x16x32_bf16 v[84:87], a[12:15], a[164:167], v[84:87]
ds_read_b64_tr_b16 a[76:77], v16 offset:59168
v_mfma_f32_16x16x32_bf16 v[80:83], a[12:15], a[160:163], v[80:83]
buffer_load_dwordx4 a[144:147], v10, s[16:19], s52 offen sc1
v_mfma_f32_16x16x32_bf16 v[96:99], a[16:19], a[160:163], v[96:99]
ds_read_b64_tr_b16 a[78:79], v16 offset:59680
v_mfma_f32_16x16x32_bf16 v[100:103], a[16:19], a[164:167], v[100:103]
ds_read_b64_tr_b16 a[80:81], v16 offset:50752
v_mfma_f32_16x16x32_bf16 v[116:119], a[20:23], a[164:167], v[116:119]
ds_read_b64_tr_b16 a[82:83], v16 offset:51264
v_mfma_f32_16x16x32_bf16 v[112:115], a[20:23], a[160:163], v[112:115]
ds_read_b64_tr_b16 a[84:85], v16 offset:50784
v_mfma_f32_16x16x32_bf16 v[128:131], a[24:27], a[160:163], v[128:131]
s_waitcnt vmcnt(10)
ds_read_b64 v[28:29], v2
v_mfma_f32_16x16x32_bf16 v[132:135], a[24:27], a[164:167], v[132:135]
ds_read_b64 v[30:31], v2 offset:512
v_mfma_f32_16x16x32_bf16 v[148:151], a[28:31], a[164:167], v[148:151]
ds_read_b64 v[18:19], v2 offset:1024
v_mfma_f32_16x16x32_bf16 v[144:147], a[28:31], a[160:163], v[144:147]
buffer_load_dwordx4 v13, s[32:35], s54 offen offset:1056 lds
v_mfma_f32_16x16x32_bf16 v[160:163], a[32:35], a[160:163], v[160:163]
ds_read_b64_tr_b16 a[86:87], v16 offset:51296
v_mfma_f32_16x16x32_bf16 v[164:167], a[32:35], a[164:167], v[164:167]
ds_read_b64_tr_b16 a[88:89], v16 offset:59200
v_mfma_f32_16x16x32_bf16 v[24:27], v[20:23], a[196:199], v[24:27]
ds_read_b64_tr_b16 a[90:91], v16 offset:59712
v_mfma_f32_16x16x32_bf16 v[180:183], a[36:39], a[164:167], v[180:183]
ds_read_b64_tr_b16 a[92:93], v16 offset:59232
v_mfma_f32_16x16x32_bf16 v[176:179], a[36:39], a[160:163], v[176:179]
ds_read_b64_tr_b16 a[94:95], v16 offset:59744
v_mfma_f32_16x16x32_bf16 v[192:195], a[40:43], a[160:163], v[192:195]
ds_read_b64_tr_b16 a[96:97], v16 offset:50816
s_waitcnt lgkmcnt(7)
v_add_f32 v28, v28, v30
v_mfma_f32_16x16x32_bf16 v[196:199], a[40:43], a[164:167], v[196:199]
buffer_load_dwordx4 a[148:151], v10, s[16:19], s52 offen offset:1024 sc1
v_mfma_f32_16x16x32_bf16 v[212:215], a[44:47], a[164:167], v[212:215]
ds_read_b64_tr_b16 a[98:99], v16 offset:51328
v_add_f32 v29, v29, v31
v_mfma_f32_16x16x32_bf16 v[208:211], a[44:47], a[160:163], v[208:211]
ds_read_b64 v[30:31], v2 offset:1536
s_waitcnt lgkmcnt(8)
v_add_f32 v28, v28, v18
v_mfma_f32_16x16x32_bf16 v[224:227], a[48:51], a[160:163], v[224:227]
ds_read_b64_tr_b16 a[100:101], v16 offset:50848
v_add_f32 v29, v29, v19
v_mfma_f32_16x16x32_bf16 v[228:231], a[48:51], a[164:167], v[228:231]
ds_read_b64 v[18:19], v2 offset:2048
v_mfma_f32_16x16x32_bf16 v[236:239], a[52:55], a[164:167], v[236:239]
ds_read_b64_tr_b16 a[102:103], v16 offset:51360
v_mfma_f32_16x16x32_bf16 v[232:235], a[52:55], a[160:163], v[232:235]
ds_read_b64_tr_b16 a[104:105], v16 offset:59264
v_mfma_f32_16x16x32_bf16 v[240:243], a[56:59], a[160:163], v[240:243]
buffer_load_dwordx4 v14, s[32:35], s54 offen offset:2112 lds
v_mfma_f32_16x16x32_bf16 v[244:247], a[56:59], a[164:167], v[244:247]
ds_read_b64_tr_b16 a[106:107], v16 offset:59776
v_mfma_f32_16x16x32_bf16 v[24:27], v[20:23], a[200:203], v[24:27]
ds_read_b64_tr_b16 a[108:109], v16 offset:59296
v_mfma_f32_16x16x32_bf16 v[252:255], a[60:63], a[164:167], v[252:255]
ds_read_b64_tr_b16 a[110:111], v16 offset:59808
s_waitcnt lgkmcnt(7)
v_add_f32 v28, v28, v30
v_mfma_f32_16x16x32_bf16 v[248:251], a[60:63], a[160:163], v[248:251]
ds_read_b64_tr_b16 a[112:113], v17 offset:50688
v_add_f32 v29, v29, v31
v_mfma_f32_16x16x32_bf16 v[220:223], a[44:47], a[172:175], v[220:223]
ds_read_b64 v[30:31], v2 offset:2560
s_waitcnt lgkmcnt(7)
v_add_f32 v28, v28, v18
v_mfma_f32_16x16x32_bf16 v[216:219], a[44:47], a[168:171], v[216:219]
ds_read_b64_tr_b16 a[114:115], v17 offset:51200
v_add_f32 v29, v29, v19
v_mfma_f32_16x16x32_bf16 v[200:203], a[40:43], a[168:171], v[200:203]
ds_read_b64 v[18:19], v2 offset:3072
v_mfma_f32_16x16x32_bf16 v[204:207], a[40:43], a[172:175], v[204:207]
buffer_load_dwordx4 a[152:155], v11, s[16:19], s52 offen sc1
v_mfma_f32_16x16x32_bf16 v[188:191], a[36:39], a[172:175], v[188:191]
ds_read_b64_tr_b16 a[116:117], v17 offset:50720
v_mfma_f32_16x16x32_bf16 v[184:187], a[36:39], a[168:171], v[184:187]
ds_read_b64_tr_b16 a[118:119], v17 offset:51232
v_mfma_f32_16x16x32_bf16 v[168:171], a[32:35], a[168:171], v[168:171]
ds_read_b64_tr_b16 a[120:121], v17 offset:59136
v_mfma_f32_16x16x32_bf16 v[172:175], a[32:35], a[172:175], v[172:175]
ds_read_b64_tr_b16 a[122:123], v17 offset:59648
v_mfma_f32_16x16x32_bf16 v[156:159], a[28:31], a[172:175], v[156:159]
ds_read_b64_tr_b16 a[124:125], v17 offset:59168
s_waitcnt lgkmcnt(7)
v_add_f32 v28, v28, v30
v_mfma_f32_16x16x32_bf16 v[152:155], a[28:31], a[168:171], v[152:155]
ds_read_b64_tr_b16 a[126:127], v17 offset:59680
v_add_f32 v29, v29, v31
v_mfma_f32_16x16x32_bf16 v[24:27], v[20:23], a[204:207], v[24:27]
ds_read_b64 v[30:31], v2 offset:3584
s_waitcnt lgkmcnt(7)
v_add_f32 v28, v28, v18
v_mfma_f32_16x16x32_bf16 v[136:139], a[24:27], a[168:171], v[136:139]
buffer_load_dwordx4 v15, s[32:35], s54 offen offset:3168 lds
v_mfma_f32_16x16x32_bf16 v[140:143], a[24:27], a[172:175], v[140:143]
s_add_u32 s54, s54, 229376
v_add_f32 v29, v29, v19
v_mfma_f32_16x16x32_bf16 v[124:127], a[20:23], a[172:175], v[124:127]
ds_read_b64 v[18:19], v2 offset:4096
v_mfma_f32_16x16x32_bf16 v[120:123], a[20:23], a[168:171], v[120:123]
ds_read_b128 a[208:211], v9 offset:50688
v_mfma_f32_16x16x32_bf16 v[104:107], a[16:19], a[168:171], v[104:107]
ds_read_b128 a[212:215], v9 offset:51744
v_mfma_f32_16x16x32_bf16 v[108:111], a[16:19], a[172:175], v[108:111]
ds_read_b128 a[216:219], v9 offset:52800
v_mfma_f32_16x16x32_bf16 v[92:95], a[12:15], a[172:175], v[92:95]
ds_read_b128 a[220:223], v9 offset:53856
v_mfma_f32_16x16x32_bf16 v[88:91], a[12:15], a[168:171], v[88:91]
buffer_load_dwordx4 a[156:159], v11, s[16:19], s52 offen offset:1024 sc1
v_mfma_f32_16x16x32_bf16 v[72:75], a[8:11], a[168:171], v[72:75]
s_add_u32 s52, s52, 0x20000
s_waitcnt lgkmcnt(5)
v_add_f32 v28, v28, v30
v_add_f32 v29, v29, v31
v_mfma_f32_16x16x32_bf16 v[76:79], a[8:11], a[172:175], v[76:79]
ds_read_b64 v[30:31], v2 offset:4608
v_mfma_f32_16x16x32_bf16 v[60:63], a[4:7], a[172:175], v[60:63]
s_waitcnt lgkmcnt(5)
v_add_f32 v28, v28, v18
v_add_f32 v29, v29, v19
v_mfma_f32_16x16x32_bf16 v[56:59], a[4:7], a[168:171], v[56:59]
ds_read_b64 v[18:19], v2 offset:5120
v_mfma_f32_16x16x32_bf16 v[40:43], a[0:3], a[168:171], v[40:43]
v_mfma_f32_16x16x32_bf16 v[44:47], a[0:3], a[172:175], v[44:47]
s_waitcnt lgkmcnt(0)
s_barrier
v_mfma_f32_16x16x32_bf16 v[32:35], a[64:67], a[176:179], v[32:35]
s_add_u32 m0, s55, 135168
v_add_f32 v28, v28, v30
v_add_f32 v29, v29, v31
v_mfma_f32_16x16x32_bf16 v[36:39], a[64:67], a[180:183], v[36:39]
ds_read_b64 v[30:31], v2 offset:5632
v_add_f32 v28, v28, v18
v_mfma_f32_16x16x32_bf16 v[52:55], a[68:71], a[180:183], v[52:55]
buffer_load_dwordx4 v12, s[32:35], s54 offen lds
v_mfma_f32_16x16x32_bf16 v[48:51], a[68:71], a[176:179], v[48:51]
ds_read_b64_tr_b16 a[0:1], v16
v_add_f32 v29, v29, v19
v_mfma_f32_16x16x32_bf16 v[64:67], a[72:75], a[176:179], v[64:67]
ds_read_b64 v[18:19], v2 offset:6144
v_mfma_f32_16x16x32_bf16 v[68:71], a[72:75], a[180:183], v[68:71]
ds_read_b64_tr_b16 a[2:3], v16 offset:512
v_mfma_f32_16x16x32_bf16 v[24:27], v[20:23], a[208:211], v[24:27]
ds_read_b64_tr_b16 a[4:5], v16 offset:32
v_mfma_f32_16x16x32_bf16 v[84:87], a[76:79], a[180:183], v[84:87]
ds_read_b64_tr_b16 a[6:7], v16 offset:544
v_mfma_f32_16x16x32_bf16 v[80:83], a[76:79], a[176:179], v[80:83]
ds_read_b64_tr_b16 a[8:9], v16 offset:8448
v_mfma_f32_16x16x32_bf16 v[96:99], a[80:83], a[176:179], v[96:99]
buffer_load_dwordx4 a[160:163], v10, s[16:19], s52 offen sc1
v_mfma_f32_16x16x32_bf16 v[100:103], a[80:83], a[180:183], v[100:103]
ds_read_b64_tr_b16 a[10:11], v16 offset:8960
s_waitcnt lgkmcnt(7)
v_add_f32 v28, v28, v30
v_mfma_f32_16x16x32_bf16 v[116:119], a[84:87], a[180:183], v[116:119]
ds_read_b64_tr_b16 a[12:13], v16 offset:8480
v_add_f32 v29, v29, v31
v_mfma_f32_16x16x32_bf16 v[112:115], a[84:87], a[176:179], v[112:115]
ds_read_b64 v[30:31], v2 offset:6656
s_waitcnt lgkmcnt(7)
v_add_f32 v28, v28, v18
v_mfma_f32_16x16x32_bf16 v[128:131], a[88:91], a[176:179], v[128:131]
ds_read_b64_tr_b16 a[14:15], v16 offset:8992
v_add_f32 v29, v29, v19
v_mfma_f32_16x16x32_bf16 v[132:135], a[88:91], a[180:183], v[132:135]
ds_read_b64 v[18:19], v2 offset:7168
v_mfma_f32_16x16x32_bf16 v[148:151], a[92:95], a[180:183], v[148:151]
ds_read_b64_tr_b16 a[16:17], v16 offset:64
v_mfma_f32_16x16x32_bf16 v[144:147], a[92:95], a[176:179], v[144:147]
buffer_load_dwordx4 v13, s[32:35], s54 offen offset:1056 lds
v_mfma_f32_16x16x32_bf16 v[160:163], a[96:99], a[176:179], v[160:163]
ds_read_b64_tr_b16 a[18:19], v16 offset:576
v_mfma_f32_16x16x32_bf16 v[164:167], a[96:99], a[180:183], v[164:167]
ds_read_b64_tr_b16 a[20:21], v16 offset:96
v_mfma_f32_16x16x32_bf16 v[24:27], v[20:23], a[212:215], v[24:27]
ds_read_b64_tr_b16 a[22:23], v16 offset:608
v_mfma_f32_16x16x32_bf16 v[180:183], a[100:103], a[180:183], v[180:183]
ds_read_b64_tr_b16 a[24:25], v16 offset:8512
s_waitcnt lgkmcnt(7)
v_add_f32 v28, v28, v30
v_mfma_f32_16x16x32_bf16 v[176:179], a[100:103], a[176:179], v[176:179]
ds_read_b64_tr_b16 a[26:27], v16 offset:9024
v_add_f32 v29, v29, v31
v_mfma_f32_16x16x32_bf16 v[192:195], a[104:107], a[176:179], v[192:195]
ds_read_b64 v[30:31], v2 offset:7680
s_waitcnt lgkmcnt(7)
v_add_f32 v28, v28, v18
v_mfma_f32_16x16x32_bf16 v[196:199], a[104:107], a[180:183], v[196:199]
buffer_load_dwordx4 a[164:167], v10, s[16:19], s52 offen offset:1024 sc1
v_mfma_f32_16x16x32_bf16 v[212:215], a[108:111], a[180:183], v[212:215]
ds_read_b64_tr_b16 a[28:29], v16 offset:8544
v_add_f32 v29, v29, v19
v_mfma_f32_16x16x32_bf16 v[208:211], a[108:111], a[176:179], v[208:211]
ds_read_b64_tr_b16 a[30:31], v16 offset:9056
v_lshlrev_b32 v18, 4, v0
v_mfma_f32_16x16x32_bf16 v[224:227], a[112:115], a[176:179], v[224:227]
ds_read_b64_tr_b16 a[32:33], v16 offset:128
v_add_u32 v18, 152576, v18
v_mfma_f32_16x16x32_bf16 v[228:231], a[112:115], a[180:183], v[228:231]
ds_read_b64_tr_b16 a[34:35], v16 offset:640
v_mfma_f32_16x16x32_bf16 v[236:239], a[116:119], a[180:183], v[236:239]
ds_read_b64_tr_b16 a[36:37], v16 offset:160
v_mfma_f32_16x16x32_bf16 v[232:235], a[116:119], a[176:179], v[232:235]
ds_read_b64_tr_b16 a[38:39], v16 offset:672
v_mfma_f32_16x16x32_bf16 v[240:243], a[120:123], a[176:179], v[240:243]
buffer_load_dwordx4 v14, s[32:35], s54 offen offset:2112 lds
v_mfma_f32_16x16x32_bf16 v[244:247], a[120:123], a[180:183], v[244:247]
ds_read_b64_tr_b16 a[40:41], v16 offset:8576
s_waitcnt lgkmcnt(7)
v_add_f32 v28, v28, v30
v_mfma_f32_16x16x32_bf16 v[24:27], v[20:23], a[216:219], v[24:27]
ds_read_b64_tr_b16 a[42:43], v16 offset:9088
v_add_f32 v29, v29, v31
v_mfma_f32_16x16x32_bf16 v[252:255], a[124:127], a[180:183], v[252:255]
ds_read_b64_tr_b16 a[44:45], v16 offset:8608
v_mul_f32 v28, 0xba800000, v28
v_mfma_f32_16x16x32_bf16 v[248:251], a[124:127], a[176:179], v[248:251]
ds_read_b64_tr_b16 a[46:47], v16 offset:9120
v_mul_f32 v29, 0x3a800000, v29
v_mfma_f32_16x16x32_bf16 v[220:223], a[108:111], a[188:191], v[220:223]
ds_read_b64_tr_b16 a[48:49], v17
v_fma_f32 v29, -v28, v28, v29
v_mfma_f32_16x16x32_bf16 v[216:219], a[108:111], a[184:187], v[216:219]
ds_read_b64_tr_b16 a[50:51], v17 offset:512
v_max_f32 v29, 0, v29
v_mfma_f32_16x16x32_bf16 v[200:203], a[104:107], a[184:187], v[200:203]
buffer_load_dwordx4 a[168:171], v11, s[16:19], s52 offen sc1
v_mfma_f32_16x16x32_bf16 v[204:207], a[104:107], a[188:191], v[204:207]
ds_read_b64_tr_b16 a[52:53], v17 offset:32
v_add_f32 v29, 0x3727c5ac, v29
v_mfma_f32_16x16x32_bf16 v[188:191], a[100:103], a[188:191], v[188:191]
ds_read_b64_tr_b16 a[54:55], v17 offset:544
v_rsq_f32 v30, v29
v_mfma_f32_16x16x32_bf16 v[184:187], a[100:103], a[184:187], v[184:187]
ds_read_b64_tr_b16 a[56:57], v17 offset:8448
v_mul_f32 v30, 0xbfb8aa3b, v30
v_mfma_f32_16x16x32_bf16 v[168:171], a[96:99], a[184:187], v[168:171]
ds_write_b128 v18, v[28:31]
v_mfma_f32_16x16x32_bf16 v[172:175], a[96:99], a[188:191], v[172:175]
ds_read_b64_tr_b16 a[58:59], v17 offset:8960
v_mfma_f32_16x16x32_bf16 v[156:159], a[92:95], a[188:191], v[156:159]
ds_read_b64_tr_b16 a[60:61], v17 offset:8480
v_mfma_f32_16x16x32_bf16 v[152:155], a[92:95], a[184:187], v[152:155]
buffer_load_dwordx4 v15, s[32:35], s54 offen offset:3168 lds
v_mfma_f32_16x16x32_bf16 v[24:27], v[20:23], a[220:223], v[24:27]
s_add_u32 s54, s54, 229376
ds_read_b64_tr_b16 a[62:63], v17 offset:8992
v_mfma_f32_16x16x32_bf16 v[136:139], a[88:91], a[184:187], v[136:139]
ds_read_b128 a[192:195], v9
v_mfma_f32_16x16x32_bf16 v[140:143], a[88:91], a[188:191], v[140:143]
ds_read_b128 a[196:199], v9 offset:1056
v_mfma_f32_16x16x32_bf16 v[124:127], a[84:87], a[188:191], v[124:127]
ds_read_b128 a[200:203], v9 offset:2112
v_mfma_f32_16x16x32_bf16 v[120:123], a[84:87], a[184:187], v[120:123]
ds_read_b128 a[204:207], v9 offset:3168
v_mfma_f32_16x16x32_bf16 v[104:107], a[80:83], a[184:187], v[104:107]
v_mfma_f32_16x16x32_bf16 v[108:111], a[80:83], a[188:191], v[108:111]
buffer_load_dwordx4 a[172:175], v11, s[16:19], s52 offen offset:1024 sc1
v_mfma_f32_16x16x32_bf16 v[92:95], a[76:79], a[188:191], v[92:95]
s_add_u32 s52, s52, 0x20000
v_mfma_f32_16x16x32_bf16 v[88:91], a[76:79], a[184:187], v[88:91]
v_mfma_f32_16x16x32_bf16 v[72:75], a[72:75], a[184:187], v[72:75]
v_mfma_f32_16x16x32_bf16 v[76:79], a[72:75], a[188:191], v[76:79]
v_mfma_f32_16x16x32_bf16 v[60:63], a[68:71], a[188:191], v[60:63]
v_mfma_f32_16x16x32_bf16 v[56:59], a[68:71], a[184:187], v[56:59]
v_mfma_f32_16x16x32_bf16 v[40:43], a[64:67], a[184:187], v[40:43]
v_mfma_f32_16x16x32_bf16 v[44:47], a[64:67], a[188:191], v[44:47]
s_mov_b32 s58, -131072
s_sub_u32 s67, s59, 16896
s_mov_b32 s15, -6
.p2align 6
.Lk42:
s_waitcnt vmcnt(17) lgkmcnt(0)
s_barrier
v_mfma_f32_16x16x32_bf16 v[32:35], a[0:3], a[128:131], v[32:35]
ds_read_b64_tr_b16 a[64:65], v16 offset:16896
s_add_u32 m0, s55, 84480
v_mfma_f32_16x16x32_bf16 v[36:39], a[0:3], a[132:135], v[36:39]
buffer_load_dwordx4 v12, s[32:35], s54 offen lds
v_mfma_f32_16x16x32_bf16 v[52:55], a[4:7], a[132:135], v[52:55]
s_sub_u32 s47, s47, 1
s_cbranch_scc1 .Lx43
.Lx43b:
v_mfma_f32_16x16x32_bf16 v[48:51], a[4:7], a[128:131], v[48:51]
ds_read_b64_tr_b16 a[66:67], v16 offset:17408
v_mfma_f32_16x16x32_bf16 v[64:67], a[8:11], a[128:131], v[64:67]
ds_read_b64_tr_b16 a[68:69], v16 offset:16928
v_mfma_f32_16x16x32_bf16 v[68:71], a[8:11], a[132:135], v[68:71]
ds_read_b64_tr_b16 a[70:71], v16 offset:17440
v_mfma_f32_16x16x32_bf16 v[24:27], v[20:23], a[192:195], v[24:27]
v_mfma_f32_16x16x32_bf16 v[84:87], a[12:15], a[132:135], v[84:87]
buffer_load_dwordx4 a[176:179], v10, s[16:19], s52 offen sc1
v_mfma_f32_16x16x32_bf16 v[80:83], a[12:15], a[128:131], v[80:83]
ds_read_b64_tr_b16 a[72:73], v16 offset:25344
v_mfma_f32_16x16x32_bf16 v[96:99], a[16:19], a[128:131], v[96:99]
ds_read_b64_tr_b16 a[74:75], v16 offset:25856
v_mfma_f32_16x16x32_bf16 v[100:103], a[16:19], a[132:135], v[100:103]
ds_read_b64_tr_b16 a[76:77], v16 offset:25376
v_mfma_f32_16x16x32_bf16 v[116:119], a[20:23], a[132:135], v[116:119]
ds_read_b64_tr_b16 a[78:79], v16 offset:25888
v_mfma_f32_16x16x32_bf16 v[112:115], a[20:23], a[128:131], v[112:115]
v_mfma_f32_16x16x32_bf16 v[128:131], a[24:27], a[128:131], v[128:131]
buffer_load_dwordx4 v13, s[32:35], s54 offen offset:1056 lds
v_mfma_f32_16x16x32_bf16 v[132:135], a[24:27], a[132:135], v[132:135]
ds_read_b64_tr_b16 a[80:81], v16 offset:16960
v_mfma_f32_16x16x32_bf16 v[148:151], a[28:31], a[132:135], v[148:151]
ds_read_b64_tr_b16 a[82:83], v16 offset:17472
v_mfma_f32_16x16x32_bf16 v[144:147], a[28:31], a[128:131], v[144:147]
ds_read_b64_tr_b16 a[84:85], v16 offset:16992
v_mfma_f32_16x16x32_bf16 v[160:163], a[32:35], a[128:131], v[160:163]
ds_read_b64_tr_b16 a[86:87], v16 offset:17504
v_mfma_f32_16x16x32_bf16 v[164:167], a[32:35], a[132:135], v[164:167]
v_mfma_f32_16x16x32_bf16 v[24:27], v[20:23], a[196:199], v[24:27]
ds_read_b64_tr_b16 a[88:89], v16 offset:25408
v_mfma_f32_16x16x32_bf16 v[180:183], a[36:39], a[132:135], v[180:183]
.Lpad3:
s_cbranch_execz .Lpad6
buffer_load_dwordx4 a[180:183], v10, s[16:19], s52 offen offset:1024 sc1
v_mfma_f32_16x16x32_bf16 v[176:179], a[36:39], a[128:131], v[176:179]
ds_read_b64_tr_b16 a[90:91], v16 offset:25920
v_mfma_f32_16x16x32_bf16 v[192:195], a[40:43], a[128:131], v[192:195]
ds_read_b64_tr_b16 a[92:93], v16 offset:25440
v_mfma_f32_16x16x32_bf16 v[196:199], a[40:43], a[132:135], v[196:199]
ds_read_b64_tr_b16 a[94:95], v16 offset:25952
v_mfma_f32_16x16x32_bf16 v[212:215], a[44:47], a[132:135], v[212:215]
v_mfma_f32_16x16x32_bf16 v[208:211], a[44:47], a[128:131], v[208:211]
ds_read_b64_tr_b16 a[96:97], v16 offset:17024
v_mfma_f32_16x16x32_bf16 v[224:227], a[48:51], a[128:131], v[224:227]
buffer_load_dwordx4 v14, s[32:35], s54 offen offset:2112 lds
v_mfma_f32_16x16x32_bf16 v[228:231], a[48:51], a[132:135], v[228:231]
ds_read_b64_tr_b16 a[98:99], v16 offset:17536
v_mfma_f32_16x16x32_bf16 v[236:239], a[52:55], a[132:135], v[236:239]
ds_read_b64_tr_b16 a[100:101], v16 offset:17056
v_mfma_f32_16x16x32_bf16 v[232:235], a[52:55], a[128:131], v[232:235]
ds_read_b64_tr_b16 a[102:103], v16 offset:17568
v_mfma_f32_16x16x32_bf16 v[240:243], a[56:59], a[128:131], v[240:243]
v_mfma_f32_16x16x32_bf16 v[244:247], a[56:59], a[132:135], v[244:247]
ds_read_b64_tr_b16 a[104:105], v16 offset:25472
v_mfma_f32_16x16x32_bf16 v[24:27], v[20:23], a[200:203], v[24:27]
ds_read_b64_tr_b16 a[106:107], v16 offset:25984
v_mfma_f32_16x16x32_bf16 v[252:255], a[60:63], a[132:135], v[252:255]
buffer_load_dwordx4 a[184:187], v11, s[16:19], s52 offen sc1
v_mfma_f32_16x16x32_bf16 v[248:251], a[60:63], a[128:131], v[248:251]
ds_read_b64_tr_b16 a[108:109], v16 offset:25504
s_waitcnt vmcnt(22)
v_mfma_f32_16x16x32_bf16 v[220:223], a[44:47], a[140:143], v[220:223]
ds_read_b64_tr_b16 a[110:111], v16 offset:26016
v_mfma_f32_16x16x32_bf16 v[216:219], a[44:47], a[136:139], v[216:219]
v_mfma_f32_16x16x32_bf16 v[200:203], a[40:43], a[136:139], v[200:203]
ds_read_b64_tr_b16 a[112:113], v17 offset:16896
v_mfma_f32_16x16x32_bf16 v[204:207], a[40:43], a[140:143], v[204:207]
ds_read_b64_tr_b16 a[114:115], v17 offset:17408
v_mfma_f32_16x16x32_bf16 v[188:191], a[36:39], a[140:143], v[188:191]
buffer_load_dwordx4 v15, s[32:35], s54 offen offset:3168 lds
v_mfma_f32_16x16x32_bf16 v[184:187], a[36:39], a[136:139], v[184:187]
ds_read_b64_tr_b16 a[116:117], v17 offset:16928
s_add_u32 s54, s54, 229376
v_mfma_f32_16x16x32_bf16 v[168:171], a[32:35], a[136:139], v[168:171]
ds_read_b64_tr_b16 a[118:119], v17 offset:17440
v_mfma_f32_16x16x32_bf16 v[172:175], a[32:35], a[140:143], v[172:175]
v_mfma_f32_16x16x32_bf16 v[156:159], a[28:31], a[140:143], v[156:159]
ds_read_b64_tr_b16 a[120:121], v17 offset:25344
v_mfma_f32_16x16x32_bf16 v[152:155], a[28:31], a[136:139], v[152:155]
ds_read_b64_tr_b16 a[122:123], v17 offset:25856
v_mfma_f32_16x16x32_bf16 v[24:27], v[20:23], a[204:207], v[24:27]
ds_read_b64_tr_b16 a[124:125], v17 offset:25376
v_mfma_f32_16x16x32_bf16 v[136:139], a[24:27], a[136:139], v[136:139]
buffer_load_dwordx4 a[188:191], v11, s[16:19], s52 offen offset:1024 sc1
v_mfma_f32_16x16x32_bf16 v[140:143], a[24:27], a[140:143], v[140:143]
ds_read_b64_tr_b16 a[126:127], v17 offset:25888
s_add_u32 s52, s52, 0x20000
v_mfma_f32_16x16x32_bf16 v[124:127], a[20:23], a[140:143], v[124:127]
v_mfma_f32_16x16x32_bf16 v[120:123], a[20:23], a[136:139], v[120:123]
ds_read_b128 a[208:211], v9 offset:16896
v_mfma_f32_16x16x32_bf16 v[104:107], a[16:19], a[136:139], v[104:107]
ds_read_b128 a[212:215], v9 offset:17952
v_mfma_f32_16x16x32_bf16 v[108:111], a[16:19], a[140:143], v[108:111]
ds_read_b128 a[216:219], v9 offset:19008
s_max_i32 m0, s67, s59
v_mfma_f32_16x16x32_bf16 v[92:95], a[12:15], a[140:143], v[92:95]
buffer_load_dwordx4 v5, s[28:31], s58 offen lds
v_mfma_f32_16x16x32_bf16 v[88:91], a[12:15], a[136:139], v[88:91]
ds_read_b128 a[220:223], v9 offset:20064
v_mfma_f32_16x16x32_bf16 v[72:75], a[8:11], a[136:139], v[72:75]
v_mfma_f32_16x16x32_bf16 v[76:79], a[8:11], a[140:143], v[76:79]
v_mfma_f32_16x16x32_bf16 v[60:63], a[4:7], a[140:143], v[60:63]
v_mfma_f32_16x16x32_bf16 v[56:59], a[4:7], a[136:139], v[56:59]
v_mfma_f32_16x16x32_bf16 v[40:43], a[0:3], a[136:139], v[40:43]
v_mfma_f32_16x16x32_bf16 v[44:47], a[0:3], a[140:143], v[44:47]
s_waitcnt vmcnt(18) lgkmcnt(0)
s_barrier
v_mfma_f32_16x16x32_bf16 v[32:35], a[64:67], a[144:147], v[32:35]
ds_read_b64_tr_b16 a[0:1], v16 offset:33792
s_add_u32 m0, s55, 101376
v_mfma_f32_16x16x32_bf16 v[36:39], a[64:67], a[148:151], v[36:39]
buffer_load_dwordx4 v12, s[32:35], s54 offen lds
v_mfma_f32_16x16x32_bf16 v[52:55], a[68:71], a[148:151], v[52:55]
s_sub_u32 s47, s47, 1
s_cbranch_scc1 .Lx44
.Lx44b:
v_mfma_f32_16x16x32_bf16 v[48:51], a[68:71], a[144:147], v[48:51]
ds_read_b64_tr_b16 a[2:3], v16 offset:34304
v_mfma_f32_16x16x32_bf16 v[64:67], a[72:75], a[144:147], v[64:67]
ds_read_b64_tr_b16 a[4:5], v16 offset:33824
v_mfma_f32_16x16x32_bf16 v[68:71], a[72:75], a[148:151], v[68:71]
ds_read_b64_tr_b16 a[6:7], v16 offset:34336
v_mfma_f32_16x16x32_bf16 v[24:27], v[20:23], a[208:211], v[24:27]
ds_read_b64_tr_b16 a[8:9], v16 offset:42240
v_mfma_f32_16x16x32_bf16 v[84:87], a[76:79], a[148:151], v[84:87]
buffer_load_dwordx4 a[128:131], v10, s[16:19], s52 offen sc1
v_mfma_f32_16x16x32_bf16 v[80:83], a[76:79], a[144:147], v[80:83]
v_mfma_f32_16x16x32_bf16 v[96:99], a[80:83], a[144:147], v[96:99]
ds_read_b64_tr_b16 a[10:11], v16 offset:42752
v_mfma_f32_16x16x32_bf16 v[100:103], a[80:83], a[148:151], v[100:103]
ds_read_b64_tr_b16 a[12:13], v16 offset:42272
v_mfma_f32_16x16x32_bf16 v[116:119], a[84:87], a[148:151], v[116:119]
ds_read_b64_tr_b16 a[14:15], v16 offset:42784
v_mfma_f32_16x16x32_bf16 v[112:115], a[84:87], a[144:147], v[112:115]
ds_read_b64_tr_b16 a[16:17], v16 offset:33856
v_mfma_f32_16x16x32_bf16 v[128:131], a[88:91], a[144:147], v[128:131]
buffer_load_dwordx4 v13, s[32:35], s54 offen offset:1056 lds
v_mfma_f32_16x16x32_bf16 v[132:135], a[88:91], a[148:151], v[132:135]
v_mfma_f32_16x16x32_bf16 v[148:151], a[92:95], a[148:151], v[148:151]
ds_read_b64_tr_b16 a[18:19], v16 offset:34368
v_mfma_f32_16x16x32_bf16 v[144:147], a[92:95], a[144:147], v[144:147]
ds_read_b64_tr_b16 a[20:21], v16 offset:33888
v_mfma_f32_16x16x32_bf16 v[160:163], a[96:99], a[144:147], v[160:163]
ds_read_b64_tr_b16 a[22:23], v16 offset:34400
v_mfma_f32_16x16x32_bf16 v[164:167], a[96:99], a[148:151], v[164:167]
ds_read_b64_tr_b16 a[24:25], v16 offset:42304
v_mfma_f32_16x16x32_bf16 v[24:27], v[20:23], a[212:215], v[24:27]
ds_read_b64_tr_b16 a[26:27], v16 offset:42816
v_mfma_f32_16x16x32_bf16 v[180:183], a[100:103], a[148:151], v[180:183]
buffer_load_dwordx4 a[132:135], v10, s[16:19], s52 offen offset:1024 sc1
v_mfma_f32_16x16x32_bf16 v[176:179], a[100:103], a[144:147], v[176:179]
v_mfma_f32_16x16x32_bf16 v[192:195], a[104:107], a[144:147], v[192:195]
ds_read_b64_tr_b16 a[28:29], v16 offset:42336
v_mfma_f32_16x16x32_bf16 v[196:199], a[104:107], a[148:151], v[196:199]
ds_read_b64_tr_b16 a[30:31], v16 offset:42848
v_mfma_f32_16x16x32_bf16 v[212:215], a[108:111], a[148:151], v[212:215]
ds_read_b64_tr_b16 a[32:33], v16 offset:33920
v_mfma_f32_16x16x32_bf16 v[208:211], a[108:111], a[144:147], v[208:211]
ds_read_b64_tr_b16 a[34:35], v16 offset:34432
v_mfma_f32_16x16x32_bf16 v[224:227], a[112:115], a[144:147], v[224:227]
buffer_load_dwordx4 v14, s[32:35], s54 offen offset:2112 lds
v_mfma_f32_16x16x32_bf16 v[228:231], a[112:115], a[148:151], v[228:231]
v_mfma_f32_16x16x32_bf16 v[236:239], a[116:119], a[148:151], v[236:239]
ds_read_b64_tr_b16 a[36:37], v16 offset:33952
v_mfma_f32_16x16x32_bf16 v[232:235], a[116:119], a[144:147], v[232:235]
ds_read_b64_tr_b16 a[38:39], v16 offset:34464
v_mfma_f32_16x16x32_bf16 v[240:243], a[120:123], a[144:147], v[240:243]
ds_read_b64_tr_b16 a[40:41], v16 offset:42368
v_mfma_f32_16x16x32_bf16 v[244:247], a[120:123], a[148:151], v[244:247]
ds_read_b64_tr_b16 a[42:43], v16 offset:42880
v_mfma_f32_16x16x32_bf16 v[24:27], v[20:23], a[216:219], v[24:27]
ds_read_b64_tr_b16 a[44:45], v16 offset:42400
v_mfma_f32_16x16x32_bf16 v[252:255], a[124:127], a[148:151], v[252:255]
buffer_load_dwordx4 a[136:139], v11, s[16:19], s52 offen sc1
v_mfma_f32_16x16x32_bf16 v[248:251], a[124:127], a[144:147], v[248:251]
s_waitcnt vmcnt(23)
v_mfma_f32_16x16x32_bf16 v[220:223], a[108:111], a[156:159], v[220:223]
ds_read_b64_tr_b16 a[46:47], v16 offset:42912
v_mfma_f32_16x16x32_bf16 v[216:219], a[108:111], a[152:155], v[216:219]
ds_read_b64_tr_b16 a[48:49], v17 offset:33792
v_mfma_f32_16x16x32_bf16 v[200:203], a[104:107], a[152:155], v[200:203]
ds_read_b64_tr_b16 a[50:51], v17 offset:34304
v_mfma_f32_16x16x32_bf16 v[204:207], a[104:107], a[156:159], v[204:207]
ds_read_b64_tr_b16 a[52:53], v17 offset:33824
v_mfma_f32_16x16x32_bf16 v[188:191], a[100:103], a[156:159], v[188:191]
buffer_load_dwordx4 v15, s[32:35], s54 offen offset:3168 lds
v_mfma_f32_16x16x32_bf16 v[184:187], a[100:103], a[152:155], v[184:187]
s_add_u32 s54, s54, 229376
v_mfma_f32_16x16x32_bf16 v[168:171], a[96:99], a[152:155], v[168:171]
ds_read_b64_tr_b16 a[54:55], v17 offset:34336
v_mfma_f32_16x16x32_bf16 v[172:175], a[96:99], a[156:159], v[172:175]
ds_read_b64_tr_b16 a[56:57], v17 offset:42240
v_mfma_f32_16x16x32_bf16 v[156:159], a[92:95], a[156:159], v[156:159]
ds_read_b64_tr_b16 a[58:59], v17 offset:42752
v_mfma_f32_16x16x32_bf16 v[152:155], a[92:95], a[152:155], v[152:155]
ds_read_b64_tr_b16 a[60:61], v17 offset:42272
v_mfma_f32_16x16x32_bf16 v[24:27], v[20:23], a[220:223], v[24:27]
ds_read_b64_tr_b16 a[62:63], v17 offset:42784
v_mfma_f32_16x16x32_bf16 v[136:139], a[88:91], a[152:155], v[136:139]
buffer_load_dwordx4 a[140:143], v11, s[16:19], s52 offen offset:1024 sc1
v_mfma_f32_16x16x32_bf16 v[140:143], a[88:91], a[156:159], v[140:143]
s_add_u32 s52, s52, 0x20000
v_mfma_f32_16x16x32_bf16 v[124:127], a[84:87], a[156:159], v[124:127]
ds_read_b128 a[192:195], v9 offset:33792
v_mfma_f32_16x16x32_bf16 v[120:123], a[84:87], a[152:155], v[120:123]
ds_read_b128 a[196:199], v9 offset:34848
v_mfma_f32_16x16x32_bf16 v[104:107], a[80:83], a[152:155], v[104:107]
ds_read_b128 a[200:203], v9 offset:35904
v_mfma_f32_16x16x32_bf16 v[108:111], a[80:83], a[156:159], v[108:111]
ds_read_b128 a[204:207], v9 offset:36960
s_max_i32 m0, s67, s59
v_mfma_f32_16x16x32_bf16 v[92:95], a[76:79], a[156:159], v[92:95]
buffer_load_dwordx4 v6, s[28:31], s58 offen offset:1056 lds
v_mfma_f32_16x16x32_bf16 v[88:91], a[76:79], a[152:155], v[88:91]
s_add_u32 s67, s67, 8448
s_add_u32 s58, s58, 0x10000
v_mfma_f32_16x16x32_bf16 v[72:75], a[72:75], a[152:155], v[72:75]
v_mfma_f32_16x16x32_bf16 v[76:79], a[72:75], a[156:159], v[76:79]
v_mfma_f32_16x16x32_bf16 v[60:63], a[68:71], a[156:159], v[60:63]
v_mfma_f32_16x16x32_bf16 v[56:59], a[68:71], a[152:155], v[56:59]
v_mfma_f32_16x16x32_bf16 v[40:43], a[64:67], a[152:155], v[40:43]
v_mfma_f32_16x16x32_bf16 v[44:47], a[64:67], a[156:159], v[44:47]
s_waitcnt vmcnt(19) lgkmcnt(0)
s_barrier
v_mfma_f32_16x16x32_bf16 v[32:35], a[0:3], a[160:163], v[32:35]
ds_read_b64_tr_b16 a[64:65], v16 offset:50688
s_add_u32 m0, s55, 118272
v_mfma_f32_16x16x32_bf16 v[36:39], a[0:3], a[164:167], v[36:39]
buffer_load_dwordx4 v12, s[32:35], s54 offen lds
v_mfma_f32_16x16x32_bf16 v[52:55], a[4:7], a[164:167], v[52:55]
s_sub_u32 s47, s47, 1
s_cbranch_scc1 .Lx45
.Lx45b:
v_mfma_f32_16x16x32_bf16 v[48:51], a[4:7], a[160:163], v[48:51]
ds_read_b64_tr_b16 a[66:67], v16 offset:51200
v_mfma_f32_16x16x32_bf16 v[64:67], a[8:11], a[160:163], v[64:67]
ds_read_b64_tr_b16 a[68:69], v16 offset:50720
v_mfma_f32_16x16x32_bf16 v[68:71], a[8:11], a[164:167], v[68:71]
ds_read_b64_tr_b16 a[70:71], v16 offset:51232
v_mfma_f32_16x16x32_bf16 v[24:27], v[20:23], a[192:195], v[24:27]
v_mfma_f32_16x16x32_bf16 v[84:87], a[12:15], a[164:167], v[84:87]
buffer_load_dwordx4 a[144:147], v10, s[16:19], s52 offen sc1
v_mfma_f32_16x16x32_bf16 v[80:83], a[12:15], a[160:163], v[80:83]
ds_read_b64_tr_b16 a[72:73], v16 offset:59136
v_mfma_f32_16x16x32_bf16 v[96:99], a[16:19], a[160:163], v[96:99]
ds_read_b64_tr_b16 a[74:75], v16 offset:59648
v_mfma_f32_16x16x32_bf16 v[100:103], a[16:19], a[164:167], v[100:103]
ds_read_b64_tr_b16 a[76:77], v16 offset:59168
v_mfma_f32_16x16x32_bf16 v[116:119], a[20:23], a[164:167], v[116:119]
ds_read_b64_tr_b16 a[78:79], v16 offset:59680
v_mfma_f32_16x16x32_bf16 v[112:115], a[20:23], a[160:163], v[112:115]
v_mfma_f32_16x16x32_bf16 v[128:131], a[24:27], a[160:163], v[128:131]
buffer_load_dwordx4 v13, s[32:35], s54 offen offset:1056 lds
v_mfma_f32_16x16x32_bf16 v[132:135], a[24:27], a[164:167], v[132:135]
ds_read_b64_tr_b16 a[80:81], v16 offset:50752
v_mfma_f32_16x16x32_bf16 v[148:151], a[28:31], a[164:167], v[148:151]
ds_read_b64_tr_b16 a[82:83], v16 offset:51264
v_mfma_f32_16x16x32_bf16 v[144:147], a[28:31], a[160:163], v[144:147]
ds_read_b64_tr_b16 a[84:85], v16 offset:50784
v_mfma_f32_16x16x32_bf16 v[160:163], a[32:35], a[160:163], v[160:163]
ds_read_b64_tr_b16 a[86:87], v16 offset:51296
v_mfma_f32_16x16x32_bf16 v[164:167], a[32:35], a[164:167], v[164:167]
v_mfma_f32_16x16x32_bf16 v[24:27], v[20:23], a[196:199], v[24:27]
ds_read_b64_tr_b16 a[88:89], v16 offset:59200
v_mfma_f32_16x16x32_bf16 v[180:183], a[36:39], a[164:167], v[180:183]
buffer_load_dwordx4 a[148:151], v10, s[16:19], s52 offen offset:1024 sc1
v_mfma_f32_16x16x32_bf16 v[176:179], a[36:39], a[160:163], v[176:179]
ds_read_b64_tr_b16 a[90:91], v16 offset:59712
v_mfma_f32_16x16x32_bf16 v[192:195], a[40:43], a[160:163], v[192:195]
ds_read_b64_tr_b16 a[92:93], v16 offset:59232
v_mfma_f32_16x16x32_bf16 v[196:199], a[40:43], a[164:167], v[196:199]
ds_read_b64_tr_b16 a[94:95], v16 offset:59744
v_mfma_f32_16x16x32_bf16 v[212:215], a[44:47], a[164:167], v[212:215]
v_mfma_f32_16x16x32_bf16 v[208:211], a[44:47], a[160:163], v[208:211]
ds_read_b64_tr_b16 a[96:97], v16 offset:50816
v_mfma_f32_16x16x32_bf16 v[224:227], a[48:51], a[160:163], v[224:227]
buffer_load_dwordx4 v14, s[32:35], s54 offen offset:2112 lds
v_mfma_f32_16x16x32_bf16 v[228:231], a[48:51], a[164:167], v[228:231]
ds_read_b64_tr_b16 a[98:99], v16 offset:51328
v_mfma_f32_16x16x32_bf16 v[236:239], a[52:55], a[164:167], v[236:239]
ds_read_b64_tr_b16 a[100:101], v16 offset:50848
v_mfma_f32_16x16x32_bf16 v[232:235], a[52:55], a[160:163], v[232:235]
ds_read_b64_tr_b16 a[102:103], v16 offset:51360
v_mfma_f32_16x16x32_bf16 v[240:243], a[56:59], a[160:163], v[240:243]
v_mfma_f32_16x16x32_bf16 v[244:247], a[56:59], a[164:167], v[244:247]
ds_read_b64_tr_b16 a[104:105], v16 offset:59264
v_mfma_f32_16x16x32_bf16 v[24:27], v[20:23], a[200:203], v[24:27]
ds_read_b64_tr_b16 a[106:107], v16 offset:59776
v_mfma_f32_16x16x32_bf16 v[252:255], a[60:63], a[164:167], v[252:255]
buffer_load_dwordx4 a[152:155], v11, s[16:19], s52 offen sc1
v_mfma_f32_16x16x32_bf16 v[248:251], a[60:63], a[160:163], v[248:251]
ds_read_b64_tr_b16 a[108:109], v16 offset:59296
s_waitcnt vmcnt(24)
v_mfma_f32_16x16x32_bf16 v[220:223], a[44:47], a[172:175], v[220:223]
ds_read_b64_tr_b16 a[110:111], v16 offset:59808
v_mfma_f32_16x16x32_bf16 v[216:219], a[44:47], a[168:171], v[216:219]
v_mfma_f32_16x16x32_bf16 v[200:203], a[40:43], a[168:171], v[200:203]
ds_read_b64_tr_b16 a[112:113], v17 offset:50688
v_mfma_f32_16x16x32_bf16 v[204:207], a[40:43], a[172:175], v[204:207]
ds_read_b64_tr_b16 a[114:115], v17 offset:51200
v_mfma_f32_16x16x32_bf16 v[188:191], a[36:39], a[172:175], v[188:191]
buffer_load_dwordx4 v15, s[32:35], s54 offen offset:3168 lds
v_mfma_f32_16x16x32_bf16 v[184:187], a[36:39], a[168:171], v[184:187]
ds_read_b64_tr_b16 a[116:117], v17 offset:50720
s_add_u32 s54, s54, 229376
v_mfma_f32_16x16x32_bf16 v[168:171], a[32:35], a[168:171], v[168:171]
ds_read_b64_tr_b16 a[118:119], v17 offset:51232
v_mfma_f32_16x16x32_bf16 v[172:175], a[32:35], a[172:175], v[172:175]
v_mfma_f32_16x16x32_bf16 v[156:159], a[28:31], a[172:175], v[156:159]
ds_read_b64_tr_b16 a[120:121], v17 offset:59136
v_mfma_f32_16x16x32_bf16 v[152:155], a[28:31], a[168:171], v[152:155]
ds_read_b64_tr_b16 a[122:123], v17 offset:59648
v_mfma_f32_16x16x32_bf16 v[24:27], v[20:23], a[204:207], v[24:27]
ds_read_b64_tr_b16 a[124:125], v17 offset:59168
v_mfma_f32_16x16x32_bf16 v[136:139], a[24:27], a[168:171], v[136:139]
buffer_load_dwordx4 a[156:159], v11, s[16:19], s52 offen offset:1024 sc1
v_mfma_f32_16x16x32_bf16 v[140:143], a[24:27], a[172:175], v[140:143]
ds_read_b64_tr_b16 a[126:127], v17 offset:59680
s_add_u32 s52, s52, 0x20000
v_mfma_f32_16x16x32_bf16 v[124:127], a[20:23], a[172:175], v[124:127]
v_mfma_f32_16x16x32_bf16 v[120:123], a[20:23], a[168:171], v[120:123]
ds_read_b128 a[208:211], v9 offset:50688
v_mfma_f32_16x16x32_bf16 v[104:107], a[16:19], a[168:171], v[104:107]
ds_read_b128 a[212:215], v9 offset:51744
v_mfma_f32_16x16x32_bf16 v[108:111], a[16:19], a[172:175], v[108:111]
ds_read_b128 a[216:219], v9 offset:52800
s_max_i32 m0, s67, s59
v_mfma_f32_16x16x32_bf16 v[92:95], a[12:15], a[172:175], v[92:95]
buffer_load_dwordx4 v5, s[28:31], s58 offen lds
v_mfma_f32_16x16x32_bf16 v[88:91], a[12:15], a[168:171], v[88:91]
ds_read_b128 a[220:223], v9 offset:53856
v_mfma_f32_16x16x32_bf16 v[72:75], a[8:11], a[168:171], v[72:75]
v_mfma_f32_16x16x32_bf16 v[76:79], a[8:11], a[172:175], v[76:79]
v_mfma_f32_16x16x32_bf16 v[60:63], a[4:7], a[172:175], v[60:63]
v_mfma_f32_16x16x32_bf16 v[56:59], a[4:7], a[168:171], v[56:59]
v_mfma_f32_16x16x32_bf16 v[40:43], a[0:3], a[168:171], v[40:43]
v_mfma_f32_16x16x32_bf16 v[44:47], a[0:3], a[172:175], v[44:47]
s_waitcnt vmcnt(20) lgkmcnt(0)
s_barrier
v_mfma_f32_16x16x32_bf16 v[32:35], a[64:67], a[176:179], v[32:35]
ds_read_b64_tr_b16 a[0:1], v16
s_add_u32 m0, s55, 135168
v_mfma_f32_16x16x32_bf16 v[36:39], a[64:67], a[180:183], v[36:39]
buffer_load_dwordx4 v12, s[32:35], s54 offen lds
v_mfma_f32_16x16x32_bf16 v[52:55], a[68:71], a[180:183], v[52:55]
s_sub_u32 s47, s47, 1
s_cbranch_scc1 .Lx46
.Lx46b:
v_mfma_f32_16x16x32_bf16 v[48:51], a[68:71], a[176:179], v[48:51]
ds_read_b64_tr_b16 a[2:3], v16 offset:512
v_mfma_f32_16x16x32_bf16 v[64:67], a[72:75], a[176:179], v[64:67]
ds_read_b64_tr_b16 a[4:5], v16 offset:32
v_mfma_f32_16x16x32_bf16 v[68:71], a[72:75], a[180:183], v[68:71]
ds_read_b64_tr_b16 a[6:7], v16 offset:544
v_mfma_f32_16x16x32_bf16 v[24:27], v[20:23], a[208:211], v[24:27]
ds_read_b64_tr_b16 a[8:9], v16 offset:8448
v_mfma_f32_16x16x32_bf16 v[84:87], a[76:79], a[180:183], v[84:87]
buffer_load_dwordx4 a[160:163], v10, s[16:19], s52 offen sc1
v_mfma_f32_16x16x32_bf16 v[80:83], a[76:79], a[176:179], v[80:83]
v_mfma_f32_16x16x32_bf16 v[96:99], a[80:83], a[176:179], v[96:99]
ds_read_b64_tr_b16 a[10:11], v16 offset:8960
v_mfma_f32_16x16x32_bf16 v[100:103], a[80:83], a[180:183], v[100:103]
ds_read_b64_tr_b16 a[12:13], v16 offset:8480
v_mfma_f32_16x16x32_bf16 v[116:119], a[84:87], a[180:183], v[116:119]
ds_read_b64_tr_b16 a[14:15], v16 offset:8992
v_mfma_f32_16x16x32_bf16 v[112:115], a[84:87], a[176:179], v[112:115]
ds_read_b64_tr_b16 a[16:17], v16 offset:64
v_mfma_f32_16x16x32_bf16 v[128:131], a[88:91], a[176:179], v[128:131]
buffer_load_dwordx4 v13, s[32:35], s54 offen offset:1056 lds
v_mfma_f32_16x16x32_bf16 v[132:135], a[88:91], a[180:183], v[132:135]
v_mfma_f32_16x16x32_bf16 v[148:151], a[92:95], a[180:183], v[148:151]
ds_read_b64_tr_b16 a[18:19], v16 offset:576
v_mfma_f32_16x16x32_bf16 v[144:147], a[92:95], a[176:179], v[144:147]
ds_read_b64_tr_b16 a[20:21], v16 offset:96
v_mfma_f32_16x16x32_bf16 v[160:163], a[96:99], a[176:179], v[160:163]
ds_read_b64_tr_b16 a[22:23], v16 offset:608
v_mfma_f32_16x16x32_bf16 v[164:167], a[96:99], a[180:183], v[164:167]
ds_read_b64_tr_b16 a[24:25], v16 offset:8512
v_mfma_f32_16x16x32_bf16 v[24:27], v[20:23], a[212:215], v[24:27]
ds_read_b64_tr_b16 a[26:27], v16 offset:9024
v_mfma_f32_16x16x32_bf16 v[180:183], a[100:103], a[180:183], v[180:183]
buffer_load_dwordx4 a[164:167], v10, s[16:19], s52 offen offset:1024 sc1
v_mfma_f32_16x16x32_bf16 v[176:179], a[100:103], a[176:179], v[176:179]
v_mfma_f32_16x16x32_bf16 v[192:195], a[104:107], a[176:179], v[192:195]
ds_read_b64_tr_b16 a[28:29], v16 offset:8544
v_mfma_f32_16x16x32_bf16 v[196:199], a[104:107], a[180:183], v[196:199]
ds_read_b64_tr_b16 a[30:31], v16 offset:9056
v_mfma_f32_16x16x32_bf16 v[212:215], a[108:111], a[180:183], v[212:215]
ds_read_b64_tr_b16 a[32:33], v16 offset:128
v_mfma_f32_16x16x32_bf16 v[208:211], a[108:111], a[176:179], v[208:211]
ds_read_b64_tr_b16 a[34:35], v16 offset:640
v_mfma_f32_16x16x32_bf16 v[224:227], a[112:115], a[176:179], v[224:227]
buffer_load_dwordx4 v14, s[32:35], s54 offen offset:2112 lds
v_mfma_f32_16x16x32_bf16 v[228:231], a[112:115], a[180:183], v[228:231]
v_mfma_f32_16x16x32_bf16 v[236:239], a[116:119], a[180:183], v[236:239]
ds_read_b64_tr_b16 a[36:37], v16 offset:160
v_mfma_f32_16x16x32_bf16 v[232:235], a[116:119], a[176:179], v[232:235]
ds_read_b64_tr_b16 a[38:39], v16 offset:672
v_mfma_f32_16x16x32_bf16 v[240:243], a[120:123], a[176:179], v[240:243]
ds_read_b64_tr_b16 a[40:41], v16 offset:8576
v_mfma_f32_16x16x32_bf16 v[244:247], a[120:123], a[180:183], v[244:247]
ds_read_b64_tr_b16 a[42:43], v16 offset:9088
v_mfma_f32_16x16x32_bf16 v[24:27], v[20:23], a[216:219], v[24:27]
ds_read_b64_tr_b16 a[44:45], v16 offset:8608
v_mfma_f32_16x16x32_bf16 v[252:255], a[124:127], a[180:183], v[252:255]
buffer_load_dwordx4 a[168:171], v11, s[16:19], s52 offen sc1
v_mfma_f32_16x16x32_bf16 v[248:251], a[124:127], a[176:179], v[248:251]
s_waitcnt vmcnt(25)
v_mfma_f32_16x16x32_bf16 v[220:223], a[108:111], a[188:191], v[220:223]
ds_read_b64_tr_b16 a[46:47], v16 offset:9120
v_mfma_f32_16x16x32_bf16 v[216:219], a[108:111], a[184:187], v[216:219]
ds_read_b64_tr_b16 a[48:49], v17
v_mfma_f32_16x16x32_bf16 v[200:203], a[104:107], a[184:187], v[200:203]
ds_read_b64_tr_b16 a[50:51], v17 offset:512
v_mfma_f32_16x16x32_bf16 v[204:207], a[104:107], a[188:191], v[204:207]
ds_read_b64_tr_b16 a[52:53], v17 offset:32
v_mfma_f32_16x16x32_bf16 v[188:191], a[100:103], a[188:191], v[188:191]
buffer_load_dwordx4 v15, s[32:35], s54 offen offset:3168 lds
v_mfma_f32_16x16x32_bf16 v[184:187], a[100:103], a[184:187], v[184:187]
s_add_u32 s54, s54, 229376
v_mfma_f32_16x16x32_bf16 v[168:171], a[96:99], a[184:187], v[168:171]
ds_read_b64_tr_b16 a[54:55], v17 offset:544
v_mfma_f32_16x16x32_bf16 v[172:175], a[96:99], a[188:191], v[172:175]
ds_read_b64_tr_b16 a[56:57], v17 offset:8448
v_mfma_f32_16x16x32_bf16 v[156:159], a[92:95], a[188:191], v[156:159]
ds_read_b64_tr_b16 a[58:59], v17 offset:8960
v_mfma_f32_16x16x32_bf16 v[152:155], a[92:95], a[184:187], v[152:155]
ds_read_b64_tr_b16 a[60:61], v17 offset:8480
v_mfma_f32_16x16x32_bf16 v[24:27], v[20:23], a[220:223], v[24:27]
ds_read_b64_tr_b16 a[62:63], v17 offset:8992
v_mfma_f32_16x16x32_bf16 v[136:139], a[88:91], a[184:187], v[136:139]
buffer_load_dwordx4 a[172:175], v11, s[16:19], s52 offen offset:1024 sc1
v_mfma_f32_16x16x32_bf16 v[140:143], a[88:91], a[188:191], v[140:143]
s_add_u32 s52, s52, 0x20000
v_mfma_f32_16x16x32_bf16 v[124:127], a[84:87], a[188:191], v[124:127]
ds_read_b128 a[192:195], v9
v_mfma_f32_16x16x32_bf16 v[120:123], a[84:87], a[184:187], v[120:123]
ds_read_b128 a[196:199], v9 offset:1056
v_mfma_f32_16x16x32_bf16 v[104:107], a[80:83], a[184:187], v[104:107]
ds_read_b128 a[200:203], v9 offset:2112
v_mfma_f32_16x16x32_bf16 v[108:111], a[80:83], a[188:191], v[108:111]
ds_read_b128 a[204:207], v9 offset:3168
s_max_i32 m0, s67, s59
v_mfma_f32_16x16x32_bf16 v[92:95], a[76:79], a[188:191], v[92:95]
buffer_load_dwordx4 v6, s[28:31], s58 offen offset:1056 lds
v_mfma_f32_16x16x32_bf16 v[88:91], a[76:79], a[184:187], v[88:91]
s_add_u32 s67, s67, 8448
s_add_u32 s58, s58, 0x10000
v_mfma_f32_16x16x32_bf16 v[72:75], a[72:75], a[184:187], v[72:75]
v_mfma_f32_16x16x32_bf16 v[76:79], a[72:75], a[188:191], v[76:79]
v_mfma_f32_16x16x32_bf16 v[60:63], a[68:71], a[188:191], v[60:63]
v_mfma_f32_16x16x32_bf16 v[56:59], a[68:71], a[184:187], v[56:59]
v_mfma_f32_16x16x32_bf16 v[40:43], a[64:67], a[184:187], v[40:43]
s_add_u32 s15, s15, 1
v_mfma_f32_16x16x32_bf16 v[44:47], a[64:67], a[188:191], v[44:47]
s_cbranch_scc0 .Lk42
s_waitcnt vmcnt(11) lgkmcnt(0)
s_barrier
v_mfma_f32_16x16x32_bf16 v[24:27], v[20:23], a[192:195], v[24:27]
buffer_load_dwordx4 a[176:179], v10, s[16:19], s52 offen sc1
v_mfma_f32_16x16x32_bf16 v[24:27], v[20:23], a[196:199], v[24:27]
ds_read_b64_tr_b16 a[64:65], v16 offset:16896
v_mov_b32 v18, v5
v_mfma_f32_16x16x32_bf16 v[24:27], v[20:23], a[200:203], v[24:27]
ds_read_b64_tr_b16 a[66:67], v16 offset:17408
v_mov_b32 v19, v6
v_mfma_f32_16x16x32_bf16 v[24:27], v[20:23], a[204:207], v[24:27]
ds_read_b64_tr_b16 a[68:69], v16 offset:16928
s_lshl_b32 s74, s48, 10
v_mfma_f32_16x16x32_bf16 v[32:35], a[0:3], a[128:131], v[32:35]
buffer_load_dwordx4 a[180:183], v10, s[16:19], s52 offen offset:1024 sc1
v_mfma_f32_16x16x32_bf16 v[48:51], a[4:7], a[128:131], v[48:51]
ds_read_b64_tr_b16 a[70:71], v16 offset:17440
s_lshl_b32 s75, s49, 9
v_mfma_f32_16x16x32_bf16 v[64:67], a[8:11], a[128:131], v[64:67]
ds_read_b64_tr_b16 a[72:73], v16 offset:25344
s_add_u32 s74, s74, s75
v_mfma_f32_16x16x32_bf16 v[80:83], a[12:15], a[128:131], v[80:83]
ds_read_b64_tr_b16 a[74:75], v16 offset:25856
s_add_u32 s74, s74, 159488
v_mfma_f32_16x16x32_bf16 v[36:39], a[0:3], a[132:135], v[36:39]
buffer_load_dwordx4 a[184:187], v11, s[16:19], s52 offen sc1
v_mfma_f32_16x16x32_bf16 v[52:55], a[4:7], a[132:135], v[52:55]
ds_read_b64_tr_b16 a[76:77], v16 offset:25376
v_bfe_u32 v2, v1, 4, 1
v_mfma_f32_16x16x32_bf16 v[68:71], a[8:11], a[132:135], v[68:71]
ds_read_b64_tr_b16 a[78:79], v16 offset:25888
s_lshl_b32 s75, s12, 9
v_mfma_f32_16x16x32_bf16 v[84:87], a[12:15], a[132:135], v[84:87]
ds_read_b64_tr_b16 a[80:81], v16 offset:33792
s_mov_b32 s58, 655360
v_mfma_f32_16x16x32_bf16 v[40:43], a[0:3], a[136:139], v[40:43]
buffer_load_dwordx4 a[188:191], v11, s[16:19], s52 offen offset:1024 sc1
v_mfma_f32_16x16x32_bf16 v[56:59], a[4:7], a[136:139], v[56:59]
s_add_u32 s52, s52, 0x20000
ds_read_b64_tr_b16 a[82:83], v16 offset:34304
v_mfma_f32_16x16x32_bf16 v[72:75], a[8:11], a[136:139], v[72:75]
ds_read_b64_tr_b16 a[84:85], v16 offset:33824
v_mfma_f32_16x16x32_bf16 v[88:91], a[12:15], a[136:139], v[88:91]
ds_read_b64_tr_b16 a[86:87], v16 offset:34336
v_mfma_f32_16x16x32_bf16 v[44:47], a[0:3], a[140:143], v[44:47]
ds_read_b64_tr_b16 a[88:89], v16 offset:42240
v_mfma_f32_16x16x32_bf16 v[60:63], a[4:7], a[140:143], v[60:63]
ds_read_b64_tr_b16 a[90:91], v16 offset:42752
v_mfma_f32_16x16x32_bf16 v[76:79], a[8:11], a[140:143], v[76:79]
ds_read_b64_tr_b16 a[92:93], v16 offset:42272
v_mfma_f32_16x16x32_bf16 v[92:95], a[12:15], a[140:143], v[92:95]
ds_read_b64_tr_b16 a[94:95], v16 offset:42784
v_mfma_f32_16x16x32_bf16 v[96:99], a[16:19], a[128:131], v[96:99]
ds_read_b64_tr_b16 a[112:113], v16 offset:16960
v_mfma_f32_16x16x32_bf16 v[112:115], a[20:23], a[128:131], v[112:115]
ds_read_b64_tr_b16 a[114:115], v16 offset:17472
v_mfma_f32_16x16x32_bf16 v[128:131], a[24:27], a[128:131], v[128:131]
ds_read_b64_tr_b16 a[116:117], v16 offset:16992
v_mfma_f32_16x16x32_bf16 v[144:147], a[28:31], a[128:131], v[144:147]
ds_read_b64_tr_b16 a[118:119], v16 offset:17504
v_mfma_f32_16x16x32_bf16 v[100:103], a[16:19], a[132:135], v[100:103]
ds_read_b64_tr_b16 a[120:121], v16 offset:25408
v_mfma_f32_16x16x32_bf16 v[116:119], a[20:23], a[132:135], v[116:119]
ds_read_b64_tr_b16 a[122:123], v16 offset:25920
v_mfma_f32_16x16x32_bf16 v[132:135], a[24:27], a[132:135], v[132:135]
ds_read_b64_tr_b16 a[124:125], v16 offset:25440
v_mfma_f32_16x16x32_bf16 v[148:151], a[28:31], a[132:135], v[148:151]
ds_read_b64_tr_b16 a[126:127], v16 offset:25952
v_mfma_f32_16x16x32_bf16 v[104:107], a[16:19], a[136:139], v[104:107]
ds_read_b128 a[208:211], v9 offset:16896
v_mfma_f32_16x16x32_bf16 v[120:123], a[20:23], a[136:139], v[120:123]
ds_read_b128 a[212:215], v9 offset:17952
v_mfma_f32_16x16x32_bf16 v[136:139], a[24:27], a[136:139], v[136:139]
ds_read_b128 a[216:219], v9 offset:19008
v_mfma_f32_16x16x32_bf16 v[152:155], a[28:31], a[136:139], v[152:155]
ds_read_b128 a[220:223], v9 offset:20064
v_mfma_f32_16x16x32_bf16 v[108:111], a[16:19], a[140:143], v[108:111]
ds_read_b128 a[192:195], v9 offset:33792
v_mfma_f32_16x16x32_bf16 v[124:127], a[20:23], a[140:143], v[124:127]
ds_read_b128 a[196:199], v9 offset:34848
v_mfma_f32_16x16x32_bf16 v[140:143], a[24:27], a[140:143], v[140:143]
ds_read_b128 a[200:203], v9 offset:35904
v_mfma_f32_16x16x32_bf16 v[156:159], a[28:31], a[140:143], v[156:159]
ds_read_b128 a[204:207], v9 offset:36960
v_mfma_f32_16x16x32_bf16 v[160:163], a[32:35], a[128:131], v[160:163]
ds_read_b64_tr_b16 a[0:1], v16 offset:33856
s_waitcnt lgkmcnt(8)
v_mfma_f32_16x16x32_bf16 v[24:27], v[20:23], a[208:211], v[24:27]
ds_read_b64_tr_b16 a[2:3], v16 offset:34368
s_waitcnt vmcnt(6)
s_barrier
s_waitcnt lgkmcnt(8)
v_mfma_f32_16x16x32_bf16 v[24:27], v[20:23], a[212:215], v[24:27]
ds_read_b64_tr_b16 a[96:97], v16 offset:50688
s_waitcnt lgkmcnt(8)
v_mfma_f32_16x16x32_bf16 v[24:27], v[20:23], a[216:219], v[24:27]
ds_read_b64_tr_b16 a[98:99], v16 offset:51200
s_waitcnt lgkmcnt(8)
v_mfma_f32_16x16x32_bf16 v[24:27], v[20:23], a[220:223], v[24:27]
ds_read_b64_tr_b16 a[100:101], v16 offset:50720
s_waitcnt lgkmcnt(8)
v_mfma_f32_16x16x32_bf16 v[24:27], v[20:23], a[192:195], v[24:27]
ds_read_b64_tr_b16 a[102:103], v16 offset:51232
s_waitcnt lgkmcnt(8)
v_mfma_f32_16x16x32_bf16 v[24:27], v[20:23], a[196:199], v[24:27]
ds_read_b64_tr_b16 a[104:105], v16 offset:59136
s_waitcnt lgkmcnt(8)
v_mfma_f32_16x16x32_bf16 v[24:27], v[20:23], a[200:203], v[24:27]
ds_read_b64_tr_b16 a[106:107], v16 offset:59648
s_waitcnt lgkmcnt(8)
v_mfma_f32_16x16x32_bf16 v[24:27], v[20:23], a[204:207], v[24:27]
ds_read_b64_tr_b16 a[108:109], v16 offset:59168
.Lpad4:
s_cbranch_execz .Lnopoll40r
v_mfma_f32_16x16x32_bf16 v[176:179], a[36:39], a[128:131], v[176:179]
ds_read_b64_tr_b16 a[110:111], v16 offset:59680
v_mfma_f32_16x16x32_bf16 v[192:195], a[40:43], a[128:131], v[192:195]
ds_read_b128 a[208:211], v9 offset:50688
v_mfma_f32_16x16x32_bf16 v[208:211], a[44:47], a[128:131], v[208:211]
ds_read_b128 a[212:215], v9 offset:51744
v_mfma_f32_16x16x32_bf16 v[164:167], a[32:35], a[132:135], v[164:167]
ds_read_b128 a[216:219], v9 offset:52800
v_mfma_f32_16x16x32_bf16 v[180:183], a[36:39], a[132:135], v[180:183]
ds_read_b128 a[220:223], v9 offset:53856
v_and_b32 v9, 15, v1
v_mfma_f32_16x16x32_bf16 v[196:199], a[40:43], a[132:135], v[196:199]
ds_read_b64_tr_b16 a[4:5], v16 offset:33888
v_lshl_add_u32 v9, v9, 5, s74
v_mfma_f32_16x16x32_bf16 v[212:215], a[44:47], a[132:135], v[212:215]
s_lshl_b32 s74, s3, 10
v_lshl_add_u32 v9, v2, 4, v9
v_bfe_u32 v2, v1, 5, 1
v_mfma_f32_16x16x32_bf16 v[168:171], a[32:35], a[136:139], v[168:171]
s_add_u32 s74, s74, s75
v_mul_u32_u24 v2, 2816, v2
v_sub_u32 v9, v9, v2
v_mfma_f32_16x16x32_bf16 v[184:187], a[36:39], a[136:139], v[184:187]
s_add_u32 s74, s74, 152576
v_and_b32 v2, 15, v1
v_lshl_add_u32 v2, v2, 4, s74
v_mfma_f32_16x16x32_bf16 v[200:203], a[40:43], a[136:139], v[200:203]
ds_read_b32 v28, v2 offset:8
v_xor_b32 v8, 512, v2
s_waitcnt lgkmcnt(5)
v_mfma_f32_16x16x32_bf16 v[24:27], v[20:23], a[208:211], v[24:27]
ds_read_b32 v29, v2 offset:264
s_lshl_b32 s74, s12, 7
s_waitcnt lgkmcnt(5)
v_mfma_f32_16x16x32_bf16 v[24:27], v[20:23], a[212:215], v[24:27]
ds_read_b32 v30, v8 offset:8
s_add_u32 s74, s74, 161536
s_waitcnt lgkmcnt(5)
v_mfma_f32_16x16x32_bf16 v[24:27], v[20:23], a[216:219], v[24:27]
ds_read_b32 v31, v8 offset:264
s_xor_b32 s75, s12, 1
s_waitcnt lgkmcnt(5)
v_mfma_f32_16x16x32_bf16 v[24:27], v[20:23], a[220:223], v[24:27]
s_mul_i32 s75, s75, 384
s_add_u32 s75, s75, 161536
v_mfma_f32_16x16x32_bf16 v[216:219], a[44:47], a[136:139], v[216:219]
ds_read_b64_tr_b16 a[6:7], v16 offset:34400
v_mfma_f32_16x16x32_bf16 v[172:175], a[32:35], a[140:143], v[172:175]
s_nop 2
ds_write_b128 v9, v[24:27]
v_lshlrev_b32 v9, 4, v1
v_mfma_f32_16x16x32_bf16 v[188:191], a[36:39], a[140:143], v[188:191]
ds_read_b64_tr_b16 a[8:9], v16 offset:42304
v_add_u32 v9, 159488, v9
v_mfma_f32_16x16x32_bf16 v[204:207], a[40:43], a[140:143], v[204:207]
ds_read_b64_tr_b16 a[10:11], v16 offset:42816
v_mfma_f32_16x16x32_bf16 v[220:223], a[44:47], a[140:143], v[220:223]
ds_read_b64_tr_b16 a[12:13], v16 offset:42336
v_mfma_f32_16x16x32_bf16 v[224:227], a[48:51], a[128:131], v[224:227]
ds_read_b64_tr_b16 a[14:15], v16 offset:42848
v_mfma_f32_16x16x32_bf16 v[232:235], a[52:55], a[128:131], v[232:235]
ds_read_b64_tr_b16 a[16:17], v16 offset:50752
v_mfma_f32_16x16x32_bf16 v[240:243], a[56:59], a[128:131], v[240:243]
ds_read_b64_tr_b16 a[18:19], v16 offset:51264
v_mfma_f32_16x16x32_bf16 v[248:251], a[60:63], a[128:131], v[248:251]
ds_read_b64_tr_b16 a[20:21], v16 offset:50784
v_mfma_f32_16x16x32_bf16 v[228:231], a[48:51], a[132:135], v[228:231]
s_waitcnt lgkmcnt(7)
s_barrier
ds_read_b128 v[20:23], v9
v_mfma_f32_16x16x32_bf16 v[236:239], a[52:55], a[132:135], v[236:239]
ds_read_b128 v[24:27], v9 offset:1024
v_mfma_f32_16x16x32_bf16 v[244:247], a[56:59], a[132:135], v[244:247]
ds_read_b64_tr_b16 a[22:23], v16 offset:51296
v_mfma_f32_16x16x32_bf16 v[252:255], a[60:63], a[132:135], v[252:255]
ds_read_b64_tr_b16 a[24:25], v16 offset:59200
v_mfma_f32_16x16x32_bf16 v[32:35], a[64:67], a[144:147], v[32:35]
ds_read_b64_tr_b16 a[26:27], v16 offset:59712
v_mfma_f32_16x16x32_bf16 v[48:51], a[68:71], a[144:147], v[48:51]
ds_read_b64_tr_b16 a[28:29], v16 offset:59232
v_mfma_f32_16x16x32_bf16 v[64:67], a[72:75], a[144:147], v[64:67]
ds_read_b64_tr_b16 a[30:31], v16 offset:59744
v_mfma_f32_16x16x32_bf16 v[80:83], a[76:79], a[144:147], v[80:83]
ds_read_b64_tr_b16 a[32:33], v16 offset:17024
v_mfma_f32_16x16x32_bf16 v[32:35], a[80:83], a[160:163], v[32:35]
ds_read_b64_tr_b16 a[34:35], v16 offset:17536
v_mfma_f32_16x16x32_bf16 v[48:51], a[84:87], a[160:163], v[48:51]
ds_read_b64_tr_b16 a[36:37], v16 offset:17056
s_waitcnt lgkmcnt(8)
v_add_f32 v20, v20, v24
v_mfma_f32_16x16x32_bf16 v[64:67], a[88:91], a[160:163], v[64:67]
ds_read_b64_tr_b16 a[38:39], v16 offset:17568
v_add_f32 v21, v21, v25
v_mfma_f32_16x16x32_bf16 v[80:83], a[92:95], a[160:163], v[80:83]
ds_read_b64 v[24:25], v8
v_add_f32 v22, v22, v26
s_waitcnt vmcnt(3)
v_mfma_f32_16x16x32_bf16 v[32:35], a[96:99], a[176:179], v[32:35]
ds_read_b64_tr_b16 a[40:41], v16 offset:25472
v_add_f32 v23, v23, v27
v_mfma_f32_16x16x32_bf16 v[48:51], a[100:103], a[176:179], v[48:51]
ds_write_b128 v9, v[20:23] offset:2048
v_lshrrev_b32 v9, 4, v1
v_mfma_f32_16x16x32_bf16 v[64:67], a[104:107], a[176:179], v[64:67]
ds_read_b64 v[20:21], v2
v_lshlrev_b32 v9, 4, v9
v_mfma_f32_16x16x32_bf16 v[80:83], a[108:111], a[176:179], v[80:83]
ds_read_b64 v[22:23], v2 offset:256
ds_read_b64 v[26:27], v8 offset:256
v_add_u32 v8, s75, v9
v_add_u32 v9, s74, v9
ds_read_b128 v[12:15], v9
ds_read_b128 v[4:7], v9 offset:64
ds_read_b64_tr_b16 a[42:43], v16 offset:25984
ds_read_b64_tr_b16 a[44:45], v16 offset:25504
ds_read_b64_tr_b16 a[46:47], v16 offset:26016
ds_read_b64_tr_b16 a[48:49], v16 offset:33920
ds_read_b64_tr_b16 a[50:51], v16 offset:34432
ds_read_b64_tr_b16 a[52:53], v16 offset:33952
ds_read_b64_tr_b16 a[54:55], v16 offset:34464
ds_read_b64_tr_b16 a[56:57], v16 offset:42368
ds_read_b64_tr_b16 a[58:59], v16 offset:42880
ds_read_b64_tr_b16 a[60:61], v16 offset:42400
ds_read_b64_tr_b16 a[62:63], v16 offset:42912
s_waitcnt lgkmcnt(12)
v_pk_fma_f32 v[32:33], v[12:13], v[20:21], v[32:33] op_sel_hi:[1,0,1]
v_pk_fma_f32 v[34:35], v[14:15], v[20:21], v[34:35] op_sel_hi:[1,0,1]
v_pk_fma_f32 v[36:37], v[12:13], v[22:23], v[36:37] op_sel_hi:[1,0,1]
v_pk_fma_f32 v[38:39], v[14:15], v[22:23], v[38:39] op_sel_hi:[1,0,1]
v_pk_fma_f32 v[40:41], v[12:13], v[24:25], v[40:41] op_sel_hi:[1,0,1]
v_pk_fma_f32 v[42:43], v[14:15], v[24:25], v[42:43] op_sel_hi:[1,0,1]
v_pk_fma_f32 v[44:45], v[12:13], v[26:27], v[44:45] op_sel_hi:[1,0,1]
v_pk_fma_f32 v[46:47], v[14:15], v[26:27], v[46:47] op_sel_hi:[1,0,1]
ds_read_b128 v[12:15], v9 offset:512
s_waitcnt lgkmcnt(12)
v_pk_fma_f32 v[48:49], v[4:5], v[20:21], v[48:49] op_sel_hi:[1,0,1]
v_pk_fma_f32 v[50:51], v[6:7], v[20:21], v[50:51] op_sel_hi:[1,0,1]
v_pk_fma_f32 v[52:53], v[4:5], v[22:23], v[52:53] op_sel_hi:[1,0,1]
v_pk_fma_f32 v[54:55], v[6:7], v[22:23], v[54:55] op_sel_hi:[1,0,1]
v_pk_fma_f32 v[56:57], v[4:5], v[24:25], v[56:57] op_sel_hi:[1,0,1]
v_pk_fma_f32 v[58:59], v[6:7], v[24:25], v[58:59] op_sel_hi:[1,0,1]
v_pk_fma_f32 v[60:61], v[4:5], v[26:27], v[60:61] op_sel_hi:[1,0,1]
v_pk_fma_f32 v[62:63], v[6:7], v[26:27], v[62:63] op_sel_hi:[1,0,1]
ds_read_b128 v[4:7], v9 offset:576
s_waitcnt lgkmcnt(1)
v_pk_fma_f32 v[64:65], v[12:13], v[20:21], v[64:65] op_sel_hi:[1,0,1]
v_pk_fma_f32 v[66:67], v[14:15], v[20:21], v[66:67] op_sel_hi:[1,0,1]
v_pk_fma_f32 v[68:69], v[12:13], v[22:23], v[68:69] op_sel_hi:[1,0,1]
v_pk_fma_f32 v[70:71], v[14:15], v[22:23], v[70:71] op_sel_hi:[1,0,1]
v_pk_fma_f32 v[72:73], v[12:13], v[24:25], v[72:73] op_sel_hi:[1,0,1]
v_pk_fma_f32 v[74:75], v[14:15], v[24:25], v[74:75] op_sel_hi:[1,0,1]
v_pk_fma_f32 v[76:77], v[12:13], v[26:27], v[76:77] op_sel_hi:[1,0,1]
v_pk_fma_f32 v[78:79], v[14:15], v[26:27], v[78:79] op_sel_hi:[1,0,1]
ds_read_b128 v[12:15], v9 offset:832
s_waitcnt lgkmcnt(1)
v_pk_fma_f32 v[80:81], v[4:5], v[20:21], v[80:81] op_sel_hi:[1,0,1]
v_pk_fma_f32 v[82:83], v[6:7], v[20:21], v[82:83] op_sel_hi:[1,0,1]
v_pk_fma_f32 v[84:85], v[4:5], v[22:23], v[84:85] op_sel_hi:[1,0,1]
v_pk_fma_f32 v[86:87], v[6:7], v[22:23], v[86:87] op_sel_hi:[1,0,1]
v_pk_fma_f32 v[88:89], v[4:5], v[24:25], v[88:89] op_sel_hi:[1,0,1]
v_pk_fma_f32 v[90:91], v[6:7], v[24:25], v[90:91] op_sel_hi:[1,0,1]
v_pk_fma_f32 v[92:93], v[4:5], v[26:27], v[92:93] op_sel_hi:[1,0,1]
v_pk_fma_f32 v[94:95], v[6:7], v[26:27], v[94:95] op_sel_hi:[1,0,1]
ds_read_b128 v[4:7], v9 offset:704
v_pk_mul_f32 v[64:65], v[64:65], v[32:33]
v_pk_mul_f32 v[32:33], v[32:33], v[28:29] op_sel_hi:[1,0]
v_pk_mul_f32 v[66:67], v[66:67], v[34:35]
v_pk_mul_f32 v[34:35], v[34:35], v[28:29] op_sel_hi:[1,0]
v_pk_mul_f32 v[80:81], v[80:81], v[48:49]
v_pk_mul_f32 v[48:49], v[48:49], v[28:29] op_sel_hi:[1,0]
v_pk_mul_f32 v[82:83], v[82:83], v[50:51]
v_pk_mul_f32 v[50:51], v[50:51], v[28:29] op_sel_hi:[1,0]
v_exp_f32 v32, v32
s_nop 0
v_mfma_f32_16x16x32_bf16 v[36:39], a[64:67], a[148:151], v[36:39]
v_exp_f32 v33, v33
v_mfma_f32_16x16x32_bf16 v[52:55], a[68:71], a[148:151], v[52:55]
v_exp_f32 v34, v34
v_mfma_f32_16x16x32_bf16 v[68:71], a[72:75], a[148:151], v[68:71]
v_exp_f32 v35, v35
v_mfma_f32_16x16x32_bf16 v[84:87], a[76:79], a[148:151], v[84:87]
v_exp_f32 v48, v48
v_mfma_f32_16x16x32_bf16 v[36:39], a[80:83], a[164:167], v[36:39]
v_exp_f32 v49, v49
v_mfma_f32_16x16x32_bf16 v[52:55], a[84:87], a[164:167], v[52:55]
v_exp_f32 v50, v50
v_mfma_f32_16x16x32_bf16 v[68:71], a[88:91], a[164:167], v[68:71]
v_exp_f32 v51, v51
v_mfma_f32_16x16x32_bf16 v[84:87], a[92:95], a[164:167], v[84:87]
s_waitcnt vmcnt(2)
v_mfma_f32_16x16x32_bf16 v[36:39], a[96:99], a[180:183], v[36:39]
v_mfma_f32_16x16x32_bf16 v[52:55], a[100:103], a[180:183], v[52:55]
v_mfma_f32_16x16x32_bf16 v[68:71], a[104:107], a[180:183], v[68:71]
v_mfma_f32_16x16x32_bf16 v[84:87], a[108:111], a[180:183], v[84:87]
s_nop 6
v_pk_mul_f32 v[68:69], v[68:69], v[36:37]
v_pk_mul_f32 v[36:37], v[36:37], v[28:29] op_sel:[0,1] op_sel_hi:[1,1]
v_pk_mul_f32 v[70:71], v[70:71], v[38:39]
v_pk_mul_f32 v[38:39], v[38:39], v[28:29] op_sel:[0,1] op_sel_hi:[1,1]
v_pk_mul_f32 v[84:85], v[84:85], v[52:53]
v_pk_mul_f32 v[52:53], v[52:53], v[28:29] op_sel:[0,1] op_sel_hi:[1,1]
v_pk_mul_f32 v[86:87], v[86:87], v[54:55]
v_pk_mul_f32 v[54:55], v[54:55], v[28:29] op_sel:[0,1] op_sel_hi:[1,1]
v_pk_fma_f32 v[32:33], v[32:33], v[20:21], v[20:21] op_sel:[0,1,1] op_sel_hi:[1,1,1]
v_pk_fma_f32 v[34:35], v[34:35], v[20:21], v[20:21] op_sel:[0,1,1] op_sel_hi:[1,1,1]
v_pk_fma_f32 v[48:49], v[48:49], v[20:21], v[20:21] op_sel:[0,1,1] op_sel_hi:[1,1,1]
v_pk_fma_f32 v[50:51], v[50:51], v[20:21], v[20:21] op_sel:[0,1,1] op_sel_hi:[1,1,1]
v_rcp_f32 v32, v32
s_nop 0
v_mfma_f32_16x16x32_bf16 v[40:43], a[64:67], a[152:155], v[40:43]
v_rcp_f32 v33, v33
v_mfma_f32_16x16x32_bf16 v[56:59], a[68:71], a[152:155], v[56:59]
v_rcp_f32 v34, v34
v_mfma_f32_16x16x32_bf16 v[72:75], a[72:75], a[152:155], v[72:75]
v_rcp_f32 v35, v35
v_mfma_f32_16x16x32_bf16 v[88:91], a[76:79], a[152:155], v[88:91]
v_rcp_f32 v48, v48
v_mfma_f32_16x16x32_bf16 v[40:43], a[80:83], a[168:171], v[40:43]
v_rcp_f32 v49, v49
v_mfma_f32_16x16x32_bf16 v[56:59], a[84:87], a[168:171], v[56:59]
v_rcp_f32 v50, v50
v_mfma_f32_16x16x32_bf16 v[72:75], a[88:91], a[168:171], v[72:75]
v_rcp_f32 v51, v51
v_mfma_f32_16x16x32_bf16 v[88:91], a[92:95], a[168:171], v[88:91]
v_exp_f32 v36, v36
s_waitcnt vmcnt(1)
v_mfma_f32_16x16x32_bf16 v[40:43], a[96:99], a[184:187], v[40:43]
v_exp_f32 v37, v37
v_mfma_f32_16x16x32_bf16 v[56:59], a[100:103], a[184:187], v[56:59]
v_exp_f32 v38, v38
v_mfma_f32_16x16x32_bf16 v[72:75], a[104:107], a[184:187], v[72:75]
v_exp_f32 v39, v39
v_mfma_f32_16x16x32_bf16 v[88:91], a[108:111], a[184:187], v[88:91]
v_exp_f32 v52, v52
v_exp_f32 v53, v53
v_exp_f32 v54, v54
v_exp_f32 v55, v55
v_pk_mul_f32 v[64:65], v[64:65], v[32:33]
v_pk_mul_f32 v[66:67], v[66:67], v[34:35]
v_pk_mul_f32 v[80:81], v[80:81], v[48:49]
v_pk_mul_f32 v[82:83], v[82:83], v[50:51]
ds_read_b128 v[48:51], v9 offset:128
v_pk_mul_f32 v[72:73], v[72:73], v[40:41]
v_pk_mul_f32 v[40:41], v[40:41], v[30:31] op_sel_hi:[1,0]
v_pk_mul_f32 v[74:75], v[74:75], v[42:43]
v_pk_mul_f32 v[42:43], v[42:43], v[30:31] op_sel_hi:[1,0]
v_pk_mul_f32 v[88:89], v[88:89], v[56:57]
v_pk_mul_f32 v[56:57], v[56:57], v[30:31] op_sel_hi:[1,0]
v_pk_mul_f32 v[90:91], v[90:91], v[58:59]
v_pk_mul_f32 v[58:59], v[58:59], v[30:31] op_sel_hi:[1,0]
v_pk_fma_f32 v[36:37], v[36:37], v[22:23], v[22:23] op_sel:[0,1,1] op_sel_hi:[1,1,1]
v_pk_fma_f32 v[38:39], v[38:39], v[22:23], v[22:23] op_sel:[0,1,1] op_sel_hi:[1,1,1]
v_pk_fma_f32 v[52:53], v[52:53], v[22:23], v[22:23] op_sel:[0,1,1] op_sel_hi:[1,1,1]
v_pk_fma_f32 v[54:55], v[54:55], v[22:23], v[22:23] op_sel:[0,1,1] op_sel_hi:[1,1,1]
v_cvt_pk_bf16_f32 v32, v64, v65
v_cvt_pk_bf16_f32 v33, v66, v67
ds_read_b128 v[64:67], v9 offset:192
v_cvt_pk_bf16_f32 v34, v80, v81
v_cvt_pk_bf16_f32 v35, v82, v83
v_mfma_f32_16x16x32_bf16 v[44:47], a[64:67], a[156:159], v[44:47]
buffer_store_dwordx4 v[32:35], v10, s[16:19], s62 offen sc1
v_mfma_f32_16x16x32_bf16 v[60:63], a[68:71], a[156:159], v[60:63]
ds_read_b128 v[80:83], v9 offset:640
v_rcp_f32 v36, v36
v_mfma_f32_16x16x32_bf16 v[76:79], a[72:75], a[156:159], v[76:79]
ds_read_b64_tr_b16 a[64:65], v16 offset:50816
v_rcp_f32 v37, v37
v_mfma_f32_16x16x32_bf16 v[92:95], a[76:79], a[156:159], v[92:95]
ds_read_b64_tr_b16 a[66:67], v16 offset:51328
v_rcp_f32 v38, v38
v_mfma_f32_16x16x32_bf16 v[44:47], a[80:83], a[172:175], v[44:47]
ds_read_b64_tr_b16 a[68:69], v16 offset:50848
v_rcp_f32 v39, v39
v_mfma_f32_16x16x32_bf16 v[60:63], a[84:87], a[172:175], v[60:63]
ds_read_b64_tr_b16 a[70:71], v16 offset:51360
v_rcp_f32 v52, v52
v_mfma_f32_16x16x32_bf16 v[76:79], a[88:91], a[172:175], v[76:79]
ds_read_b64_tr_b16 a[72:73], v16 offset:59264
v_rcp_f32 v53, v53
v_mfma_f32_16x16x32_bf16 v[92:95], a[92:95], a[172:175], v[92:95]
ds_read_b64_tr_b16 a[74:75], v16 offset:59776
v_rcp_f32 v54, v54
s_waitcnt vmcnt(1)
v_mfma_f32_16x16x32_bf16 v[44:47], a[96:99], a[188:191], v[44:47]
ds_read_b64_tr_b16 a[76:77], v16 offset:59296
v_rcp_f32 v55, v55
v_mfma_f32_16x16x32_bf16 v[60:63], a[100:103], a[188:191], v[60:63]
ds_read_b64_tr_b16 a[78:79], v16 offset:59808
v_exp_f32 v40, v40
v_mfma_f32_16x16x32_bf16 v[76:79], a[104:107], a[188:191], v[76:79]
ds_read_b64_tr_b16 a[80:81], v17 offset:16896
v_exp_f32 v41, v41
v_mfma_f32_16x16x32_bf16 v[92:95], a[108:111], a[188:191], v[92:95]
ds_read_b64_tr_b16 a[82:83], v17 offset:17408
v_exp_f32 v42, v42
v_exp_f32 v43, v43
v_exp_f32 v56, v56
v_exp_f32 v57, v57
v_exp_f32 v58, v58
v_exp_f32 v59, v59
v_pk_mul_f32 v[68:69], v[68:69], v[36:37]
v_pk_mul_f32 v[70:71], v[70:71], v[38:39]
v_pk_mul_f32 v[84:85], v[84:85], v[52:53]
v_pk_mul_f32 v[86:87], v[86:87], v[54:55]
v_pk_mul_f32 v[76:77], v[76:77], v[44:45]
v_pk_mul_f32 v[44:45], v[44:45], v[30:31] op_sel:[0,1] op_sel_hi:[1,1]
v_pk_mul_f32 v[78:79], v[78:79], v[46:47]
v_pk_mul_f32 v[46:47], v[46:47], v[30:31] op_sel:[0,1] op_sel_hi:[1,1]
v_pk_mul_f32 v[92:93], v[92:93], v[60:61]
v_pk_mul_f32 v[60:61], v[60:61], v[30:31] op_sel:[0,1] op_sel_hi:[1,1]
v_pk_mul_f32 v[94:95], v[94:95], v[62:63]
v_pk_mul_f32 v[62:63], v[62:63], v[30:31] op_sel:[0,1] op_sel_hi:[1,1]
v_pk_fma_f32 v[40:41], v[40:41], v[24:25], v[24:25] op_sel:[0,1,1] op_sel_hi:[1,1,1]
v_pk_fma_f32 v[42:43], v[42:43], v[24:25], v[24:25] op_sel:[0,1,1] op_sel_hi:[1,1,1]
v_pk_fma_f32 v[56:57], v[56:57], v[24:25], v[24:25] op_sel:[0,1,1] op_sel_hi:[1,1,1]
v_pk_fma_f32 v[58:59], v[58:59], v[24:25], v[24:25] op_sel:[0,1,1] op_sel_hi:[1,1,1]
v_cvt_pk_bf16_f32 v36, v68, v69
v_cvt_pk_bf16_f32 v37, v70, v71
v_cvt_pk_bf16_f32 v38, v84, v85
v_cvt_pk_bf16_f32 v39, v86, v87
v_mfma_f32_16x16x32_bf16 v[96:99], a[112:115], a[144:147], v[96:99]
buffer_store_dwordx4 v[36:39], v10, s[16:19], s62 offen offset:1024 sc1
v_mfma_f32_16x16x32_bf16 v[112:115], a[116:119], a[144:147], v[112:115]
ds_read_b64_tr_b16 a[84:85], v17 offset:16928
v_rcp_f32 v40, v40
v_mfma_f32_16x16x32_bf16 v[128:131], a[120:123], a[144:147], v[128:131]
ds_read_b64_tr_b16 a[86:87], v17 offset:17440
v_rcp_f32 v41, v41
v_mfma_f32_16x16x32_bf16 v[144:147], a[124:127], a[144:147], v[144:147]
ds_read_b64_tr_b16 a[88:89], v17 offset:25344
v_rcp_f32 v42, v42
v_mfma_f32_16x16x32_bf16 v[96:99], a[0:3], a[160:163], v[96:99]
ds_read_b64_tr_b16 a[90:91], v17 offset:25856
v_rcp_f32 v43, v43
v_mfma_f32_16x16x32_bf16 v[112:115], a[4:7], a[160:163], v[112:115]
ds_read_b64_tr_b16 a[92:93], v17 offset:25376
v_rcp_f32 v56, v56
v_mfma_f32_16x16x32_bf16 v[128:131], a[8:11], a[160:163], v[128:131]
ds_read_b64_tr_b16 a[94:95], v17 offset:25888
v_rcp_f32 v57, v57
v_mfma_f32_16x16x32_bf16 v[144:147], a[12:15], a[160:163], v[144:147]
ds_read_b64_tr_b16 a[96:97], v17 offset:33792
v_rcp_f32 v58, v58
v_mfma_f32_16x16x32_bf16 v[96:99], a[16:19], a[176:179], v[96:99]
ds_read_b64_tr_b16 a[98:99], v17 offset:34304
v_rcp_f32 v59, v59
v_mfma_f32_16x16x32_bf16 v[112:115], a[20:23], a[176:179], v[112:115]
ds_read_b64_tr_b16 a[100:101], v17 offset:33824
v_exp_f32 v44, v44
v_mfma_f32_16x16x32_bf16 v[128:131], a[24:27], a[176:179], v[128:131]
ds_read_b64_tr_b16 a[102:103], v17 offset:34336
v_exp_f32 v45, v45
v_mfma_f32_16x16x32_bf16 v[144:147], a[28:31], a[176:179], v[144:147]
ds_read_b64_tr_b16 a[104:105], v17 offset:42240
v_exp_f32 v46, v46
v_exp_f32 v47, v47
v_exp_f32 v60, v60
v_exp_f32 v61, v61
v_exp_f32 v62, v62
v_exp_f32 v63, v63
v_pk_mul_f32 v[72:73], v[72:73], v[40:41]
v_pk_mul_f32 v[74:75], v[74:75], v[42:43]
v_pk_mul_f32 v[88:89], v[88:89], v[56:57]
v_pk_mul_f32 v[90:91], v[90:91], v[58:59]
s_waitcnt lgkmcnt(15)
v_pk_fma_f32 v[96:97], v[48:49], v[20:21], v[96:97] op_sel_hi:[1,0,1]
v_pk_fma_f32 v[98:99], v[50:51], v[20:21], v[98:99] op_sel_hi:[1,0,1]
v_pk_fma_f32 v[112:113], v[64:65], v[20:21], v[112:113] op_sel_hi:[1,0,1]
v_pk_fma_f32 v[114:115], v[66:67], v[20:21], v[114:115] op_sel_hi:[1,0,1]
v_pk_fma_f32 v[128:129], v[80:81], v[20:21], v[128:129] op_sel_hi:[1,0,1]
v_pk_fma_f32 v[130:131], v[82:83], v[20:21], v[130:131] op_sel_hi:[1,0,1]
v_pk_fma_f32 v[144:145], v[4:5], v[20:21], v[144:145] op_sel_hi:[1,0,1]
v_pk_fma_f32 v[146:147], v[6:7], v[20:21], v[146:147] op_sel_hi:[1,0,1]
v_pk_mul_f32 v[128:129], v[128:129], v[96:97]
v_pk_mul_f32 v[96:97], v[96:97], v[28:29] op_sel_hi:[1,0]
v_pk_mul_f32 v[130:131], v[130:131], v[98:99]
v_pk_mul_f32 v[98:99], v[98:99], v[28:29] op_sel_hi:[1,0]
v_pk_mul_f32 v[144:145], v[144:145], v[112:113]
v_pk_mul_f32 v[112:113], v[112:113], v[28:29] op_sel_hi:[1,0]
v_pk_mul_f32 v[146:147], v[146:147], v[114:115]
v_pk_mul_f32 v[114:115], v[114:115], v[28:29] op_sel_hi:[1,0]
v_pk_fma_f32 v[44:45], v[44:45], v[26:27], v[26:27] op_sel:[0,1,1] op_sel_hi:[1,1,1]
v_pk_fma_f32 v[46:47], v[46:47], v[26:27], v[26:27] op_sel:[0,1,1] op_sel_hi:[1,1,1]
v_pk_fma_f32 v[60:61], v[60:61], v[26:27], v[26:27] op_sel:[0,1,1] op_sel_hi:[1,1,1]
v_pk_fma_f32 v[62:63], v[62:63], v[26:27], v[26:27] op_sel:[0,1,1] op_sel_hi:[1,1,1]
v_cvt_pk_bf16_f32 v40, v72, v73
v_cvt_pk_bf16_f32 v41, v74, v75
v_cvt_pk_bf16_f32 v42, v88, v89
v_cvt_pk_bf16_f32 v43, v90, v91
v_mfma_f32_16x16x32_bf16 v[100:103], a[112:115], a[148:151], v[100:103]
buffer_store_dwordx4 v[40:43], v11, s[16:19], s62 offen sc1
v_mfma_f32_16x16x32_bf16 v[116:119], a[116:119], a[148:151], v[116:119]
ds_read_b64_tr_b16 a[106:107], v17 offset:42752
v_rcp_f32 v44, v44
v_mfma_f32_16x16x32_bf16 v[132:135], a[120:123], a[148:151], v[132:135]
ds_read_b64_tr_b16 a[108:109], v17 offset:42272
v_rcp_f32 v45, v45
v_mfma_f32_16x16x32_bf16 v[148:151], a[124:127], a[148:151], v[148:151]
ds_read_b64_tr_b16 a[110:111], v17 offset:42784
v_rcp_f32 v46, v46
v_mfma_f32_16x16x32_bf16 v[100:103], a[0:3], a[164:167], v[100:103]
v_rcp_f32 v47, v47
v_mfma_f32_16x16x32_bf16 v[116:119], a[4:7], a[164:167], v[116:119]
v_rcp_f32 v60, v60
v_mfma_f32_16x16x32_bf16 v[132:135], a[8:11], a[164:167], v[132:135]
v_rcp_f32 v61, v61
v_mfma_f32_16x16x32_bf16 v[148:151], a[12:15], a[164:167], v[148:151]
v_rcp_f32 v62, v62
v_mfma_f32_16x16x32_bf16 v[100:103], a[16:19], a[180:183], v[100:103]
v_rcp_f32 v63, v63
v_mfma_f32_16x16x32_bf16 v[116:119], a[20:23], a[180:183], v[116:119]
v_exp_f32 v96, v96
v_mfma_f32_16x16x32_bf16 v[132:135], a[24:27], a[180:183], v[132:135]
v_exp_f32 v97, v97
v_mfma_f32_16x16x32_bf16 v[148:151], a[28:31], a[180:183], v[148:151]
v_exp_f32 v98, v98
v_exp_f32 v99, v99
v_exp_f32 v112, v112
v_exp_f32 v113, v113
v_exp_f32 v114, v114
v_exp_f32 v115, v115
v_pk_mul_f32 v[76:77], v[76:77], v[44:45]
v_pk_mul_f32 v[78:79], v[78:79], v[46:47]
v_pk_mul_f32 v[92:93], v[92:93], v[60:61]
v_pk_mul_f32 v[94:95], v[94:95], v[62:63]
v_pk_fma_f32 v[100:101], v[48:49], v[22:23], v[100:101] op_sel_hi:[1,0,1]
v_pk_fma_f32 v[102:103], v[50:51], v[22:23], v[102:103] op_sel_hi:[1,0,1]
v_pk_fma_f32 v[116:117], v[64:65], v[22:23], v[116:117] op_sel_hi:[1,0,1]
v_pk_fma_f32 v[118:119], v[66:67], v[22:23], v[118:119] op_sel_hi:[1,0,1]
v_pk_fma_f32 v[132:133], v[80:81], v[22:23], v[132:133] op_sel_hi:[1,0,1]
v_pk_fma_f32 v[134:135], v[82:83], v[22:23], v[134:135] op_sel_hi:[1,0,1]
v_pk_fma_f32 v[148:149], v[4:5], v[22:23], v[148:149] op_sel_hi:[1,0,1]
v_pk_fma_f32 v[150:151], v[6:7], v[22:23], v[150:151] op_sel_hi:[1,0,1]
v_pk_mul_f32 v[132:133], v[132:133], v[100:101]
v_pk_mul_f32 v[100:101], v[100:101], v[28:29] op_sel:[0,1] op_sel_hi:[1,1]
v_pk_mul_f32 v[134:135], v[134:135], v[102:103]
v_pk_mul_f32 v[102:103], v[102:103], v[28:29] op_sel:[0,1] op_sel_hi:[1,1]
v_pk_mul_f32 v[148:149], v[148:149], v[116:117]
v_pk_mul_f32 v[116:117], v[116:117], v[28:29] op_sel:[0,1] op_sel_hi:[1,1]
v_pk_mul_f32 v[150:151], v[150:151], v[118:119]
v_pk_mul_f32 v[118:119], v[118:119], v[28:29] op_sel:[0,1] op_sel_hi:[1,1]
v_pk_fma_f32 v[96:97], v[96:97], v[20:21], v[20:21] op_sel:[0,1,1] op_sel_hi:[1,1,1]
v_pk_fma_f32 v[98:99], v[98:99], v[20:21], v[20:21] op_sel:[0,1,1] op_sel_hi:[1,1,1]
v_pk_fma_f32 v[112:113], v[112:113], v[20:21], v[20:21] op_sel:[0,1,1] op_sel_hi:[1,1,1]
v_pk_fma_f32 v[114:115], v[114:115], v[20:21], v[20:21] op_sel:[0,1,1] op_sel_hi:[1,1,1]
v_cvt_pk_bf16_f32 v44, v76, v77
v_cvt_pk_bf16_f32 v45, v78, v79
v_cvt_pk_bf16_f32 v46, v92, v93
v_cvt_pk_bf16_f32 v47, v94, v95
v_mfma_f32_16x16x32_bf16 v[104:107], a[112:115], a[152:155], v[104:107]
buffer_store_dwordx4 v[44:47], v11, s[16:19], s62 offen offset:1024 sc1
v_mfma_f32_16x16x32_bf16 v[120:123], a[116:119], a[152:155], v[120:123]
v_rcp_f32 v96, v96
v_mfma_f32_16x16x32_bf16 v[136:139], a[120:123], a[152:155], v[136:139]
v_rcp_f32 v97, v97
v_mfma_f32_16x16x32_bf16 v[152:155], a[124:127], a[152:155], v[152:155]
v_rcp_f32 v98, v98
v_mfma_f32_16x16x32_bf16 v[104:107], a[0:3], a[168:171], v[104:107]
v_rcp_f32 v99, v99
v_mfma_f32_16x16x32_bf16 v[120:123], a[4:7], a[168:171], v[120:123]
v_rcp_f32 v112, v112
v_mfma_f32_16x16x32_bf16 v[136:139], a[8:11], a[168:171], v[136:139]
v_rcp_f32 v113, v113
v_mfma_f32_16x16x32_bf16 v[152:155], a[12:15], a[168:171], v[152:155]
v_rcp_f32 v114, v114
v_mfma_f32_16x16x32_bf16 v[104:107], a[16:19], a[184:187], v[104:107]
v_rcp_f32 v115, v115
v_mfma_f32_16x16x32_bf16 v[120:123], a[20:23], a[184:187], v[120:123]
v_exp_f32 v100, v100
v_mfma_f32_16x16x32_bf16 v[136:139], a[24:27], a[184:187], v[136:139]
v_exp_f32 v101, v101
v_mfma_f32_16x16x32_bf16 v[152:155], a[28:31], a[184:187], v[152:155]
v_exp_f32 v102, v102
v_exp_f32 v103, v103
v_exp_f32 v116, v116
v_exp_f32 v117, v117
v_exp_f32 v118, v118
v_exp_f32 v119, v119
v_pk_mul_f32 v[128:129], v[128:129], v[96:97]
v_pk_mul_f32 v[130:131], v[130:131], v[98:99]
v_pk_mul_f32 v[144:145], v[144:145], v[112:113]
v_pk_mul_f32 v[146:147], v[146:147], v[114:115]
ds_read_b128 v[112:115], v9 offset:256
v_pk_fma_f32 v[104:105], v[48:49], v[24:25], v[104:105] op_sel_hi:[1,0,1]
v_pk_fma_f32 v[106:107], v[50:51], v[24:25], v[106:107] op_sel_hi:[1,0,1]
v_pk_fma_f32 v[120:121], v[64:65], v[24:25], v[120:121] op_sel_hi:[1,0,1]
v_pk_fma_f32 v[122:123], v[66:67], v[24:25], v[122:123] op_sel_hi:[1,0,1]
v_pk_fma_f32 v[136:137], v[80:81], v[24:25], v[136:137] op_sel_hi:[1,0,1]
v_pk_fma_f32 v[138:139], v[82:83], v[24:25], v[138:139] op_sel_hi:[1,0,1]
v_pk_fma_f32 v[152:153], v[4:5], v[24:25], v[152:153] op_sel_hi:[1,0,1]
v_pk_fma_f32 v[154:155], v[6:7], v[24:25], v[154:155] op_sel_hi:[1,0,1]
v_pk_mul_f32 v[136:137], v[136:137], v[104:105]
v_pk_mul_f32 v[104:105], v[104:105], v[30:31] op_sel_hi:[1,0]
v_pk_mul_f32 v[138:139], v[138:139], v[106:107]
v_pk_mul_f32 v[106:107], v[106:107], v[30:31] op_sel_hi:[1,0]
v_pk_mul_f32 v[152:153], v[152:153], v[120:121]
v_pk_mul_f32 v[120:121], v[120:121], v[30:31] op_sel_hi:[1,0]
v_pk_mul_f32 v[154:155], v[154:155], v[122:123]
v_pk_mul_f32 v[122:123], v[122:123], v[30:31] op_sel_hi:[1,0]
v_pk_fma_f32 v[100:101], v[100:101], v[22:23], v[22:23] op_sel:[0,1,1] op_sel_hi:[1,1,1]
v_pk_fma_f32 v[102:103], v[102:103], v[22:23], v[22:23] op_sel:[0,1,1] op_sel_hi:[1,1,1]
v_pk_fma_f32 v[116:117], v[116:117], v[22:23], v[22:23] op_sel:[0,1,1] op_sel_hi:[1,1,1]
v_pk_fma_f32 v[118:119], v[118:119], v[22:23], v[22:23] op_sel:[0,1,1] op_sel_hi:[1,1,1]
v_cvt_pk_bf16_f32 v96, v128, v129
v_cvt_pk_bf16_f32 v97, v130, v131
ds_read_b128 v[128:131], v9 offset:320
v_cvt_pk_bf16_f32 v98, v144, v145
v_cvt_pk_bf16_f32 v99, v146, v147
v_mfma_f32_16x16x32_bf16 v[108:111], a[112:115], a[156:159], v[108:111]
buffer_store_dwordx4 v[96:99], v10, s[16:19], s63 offen sc1
v_mfma_f32_16x16x32_bf16 v[124:127], a[116:119], a[156:159], v[124:127]
ds_read_b128 v[144:147], v9 offset:768
v_rcp_f32 v100, v100
v_mfma_f32_16x16x32_bf16 v[140:143], a[120:123], a[156:159], v[140:143]
ds_read_b64_tr_b16 a[112:113], v17 offset:50688
v_rcp_f32 v101, v101
v_mfma_f32_16x16x32_bf16 v[156:159], a[124:127], a[156:159], v[156:159]
ds_read_b64_tr_b16 a[114:115], v17 offset:51200
v_rcp_f32 v102, v102
v_mfma_f32_16x16x32_bf16 v[108:111], a[0:3], a[172:175], v[108:111]
ds_read_b64_tr_b16 a[116:117], v17 offset:50720
v_rcp_f32 v103, v103
v_mfma_f32_16x16x32_bf16 v[124:127], a[4:7], a[172:175], v[124:127]
ds_read_b64_tr_b16 a[118:119], v17 offset:51232
v_rcp_f32 v116, v116
v_mfma_f32_16x16x32_bf16 v[140:143], a[8:11], a[172:175], v[140:143]
ds_read_b64_tr_b16 a[120:121], v17 offset:59136
v_rcp_f32 v117, v117
v_mfma_f32_16x16x32_bf16 v[156:159], a[12:15], a[172:175], v[156:159]
ds_read_b64_tr_b16 a[122:123], v17 offset:59648
v_rcp_f32 v118, v118
v_mfma_f32_16x16x32_bf16 v[108:111], a[16:19], a[188:191], v[108:111]
ds_read_b64_tr_b16 a[124:125], v17 offset:59168
v_rcp_f32 v119, v119
v_mfma_f32_16x16x32_bf16 v[124:127], a[20:23], a[188:191], v[124:127]
ds_read_b64_tr_b16 a[126:127], v17 offset:59680
v_exp_f32 v104, v104
v_mfma_f32_16x16x32_bf16 v[140:143], a[24:27], a[188:191], v[140:143]
v_exp_f32 v105, v105
v_mfma_f32_16x16x32_bf16 v[156:159], a[28:31], a[188:191], v[156:159]
v_exp_f32 v106, v106
v_exp_f32 v107, v107
v_exp_f32 v120, v120
v_exp_f32 v121, v121
v_exp_f32 v122, v122
v_exp_f32 v123, v123
v_pk_mul_f32 v[132:133], v[132:133], v[100:101]
v_pk_mul_f32 v[134:135], v[134:135], v[102:103]
v_pk_mul_f32 v[148:149], v[148:149], v[116:117]
v_pk_mul_f32 v[150:151], v[150:151], v[118:119]
v_pk_fma_f32 v[108:109], v[48:49], v[26:27], v[108:109] op_sel_hi:[1,0,1]
v_pk_fma_f32 v[110:111], v[50:51], v[26:27], v[110:111] op_sel_hi:[1,0,1]
v_pk_fma_f32 v[124:125], v[64:65], v[26:27], v[124:125] op_sel_hi:[1,0,1]
v_pk_fma_f32 v[126:127], v[66:67], v[26:27], v[126:127] op_sel_hi:[1,0,1]
v_pk_fma_f32 v[140:141], v[80:81], v[26:27], v[140:141] op_sel_hi:[1,0,1]
v_pk_fma_f32 v[142:143], v[82:83], v[26:27], v[142:143] op_sel_hi:[1,0,1]
s_waitcnt lgkmcnt(0)
s_barrier
v_pk_fma_f32 v[156:157], v[4:5], v[26:27], v[156:157] op_sel_hi:[1,0,1]
v_pk_fma_f32 v[158:159], v[6:7], v[26:27], v[158:159] op_sel_hi:[1,0,1]
ds_read_b128 v[4:7], v8 offset:576
v_pk_mul_f32 v[140:141], v[140:141], v[108:109]
v_pk_mul_f32 v[108:109], v[108:109], v[30:31] op_sel:[0,1] op_sel_hi:[1,1]
v_pk_mul_f32 v[142:143], v[142:143], v[110:111]
v_pk_mul_f32 v[110:111], v[110:111], v[30:31] op_sel:[0,1] op_sel_hi:[1,1]
v_pk_mul_f32 v[156:157], v[156:157], v[124:125]
v_pk_mul_f32 v[124:125], v[124:125], v[30:31] op_sel:[0,1] op_sel_hi:[1,1]
v_pk_mul_f32 v[158:159], v[158:159], v[126:127]
v_pk_mul_f32 v[126:127], v[126:127], v[30:31] op_sel:[0,1] op_sel_hi:[1,1]
v_pk_fma_f32 v[104:105], v[104:105], v[24:25], v[24:25] op_sel:[0,1,1] op_sel_hi:[1,1,1]
v_pk_fma_f32 v[106:107], v[106:107], v[24:25], v[24:25] op_sel:[0,1,1] op_sel_hi:[1,1,1]
v_pk_fma_f32 v[120:121], v[120:121], v[24:25], v[24:25] op_sel:[0,1,1] op_sel_hi:[1,1,1]
v_pk_fma_f32 v[122:123], v[122:123], v[24:25], v[24:25] op_sel:[0,1,1] op_sel_hi:[1,1,1]
v_cvt_pk_bf16_f32 v100, v132, v133
v_cvt_pk_bf16_f32 v101, v134, v135
v_cvt_pk_bf16_f32 v102, v148, v149
v_cvt_pk_bf16_f32 v103, v150, v151
v_mfma_f32_16x16x32_bf16 v[160:163], a[32:35], a[144:147], v[160:163]
buffer_store_dwordx4 v[100:103], v10, s[16:19], s63 offen offset:1024 sc1
v_mfma_f32_16x16x32_bf16 v[176:179], a[36:39], a[144:147], v[176:179]
s_add_u32 m0, s59, 84480
v_rcp_f32 v104, v104
v_mfma_f32_16x16x32_bf16 v[192:195], a[40:43], a[144:147], v[192:195]
.Lpad5:
s_cbranch_execz .Lnopoll40r
v_rcp_f32 v105, v105
v_mfma_f32_16x16x32_bf16 v[208:211], a[44:47], a[144:147], v[208:211]
v_rcp_f32 v106, v106
v_mfma_f32_16x16x32_bf16 v[160:163], a[48:51], a[160:163], v[160:163]
buffer_load_dwordx4 v18, s[28:31], s58 offen lds
v_mfma_f32_16x16x32_bf16 v[176:179], a[52:55], a[160:163], v[176:179]
v_rcp_f32 v107, v107
v_mfma_f32_16x16x32_bf16 v[192:195], a[56:59], a[160:163], v[192:195]
v_rcp_f32 v120, v120
v_mfma_f32_16x16x32_bf16 v[208:211], a[60:63], a[160:163], v[208:211]
v_rcp_f32 v121, v121
v_mfma_f32_16x16x32_bf16 v[160:163], a[64:67], a[176:179], v[160:163]
buffer_load_dwordx4 v19, s[28:31], s58 offen offset:1056 lds
v_mfma_f32_16x16x32_bf16 v[176:179], a[68:71], a[176:179], v[176:179]
s_add_u32 m0, s59, 92928
s_mov_b32 s58, 720896
v_rcp_f32 v122, v122
v_mfma_f32_16x16x32_bf16 v[192:195], a[72:75], a[176:179], v[192:195]
v_rcp_f32 v123, v123
v_mfma_f32_16x16x32_bf16 v[208:211], a[76:79], a[176:179], v[208:211]
v_exp_f32 v108, v108
v_exp_f32 v109, v109
v_exp_f32 v110, v110
v_exp_f32 v111, v111
v_exp_f32 v124, v124
v_exp_f32 v125, v125
v_exp_f32 v126, v126
v_exp_f32 v127, v127
v_pk_mul_f32 v[136:137], v[136:137], v[104:105]
v_pk_mul_f32 v[138:139], v[138:139], v[106:107]
v_pk_mul_f32 v[152:153], v[152:153], v[120:121]
v_pk_mul_f32 v[154:155], v[154:155], v[122:123]
v_pk_fma_f32 v[160:161], v[112:113], v[20:21], v[160:161] op_sel_hi:[1,0,1]
v_pk_fma_f32 v[162:163], v[114:115], v[20:21], v[162:163] op_sel_hi:[1,0,1]
v_pk_fma_f32 v[176:177], v[128:129], v[20:21], v[176:177] op_sel_hi:[1,0,1]
v_pk_fma_f32 v[178:179], v[130:131], v[20:21], v[178:179] op_sel_hi:[1,0,1]
v_pk_fma_f32 v[192:193], v[144:145], v[20:21], v[192:193] op_sel_hi:[1,0,1]
v_pk_fma_f32 v[194:195], v[146:147], v[20:21], v[194:195] op_sel_hi:[1,0,1]
v_pk_fma_f32 v[208:209], v[12:13], v[20:21], v[208:209] op_sel_hi:[1,0,1]
v_pk_fma_f32 v[210:211], v[14:15], v[20:21], v[210:211] op_sel_hi:[1,0,1]
v_pk_mul_f32 v[192:193], v[192:193], v[160:161]
v_pk_mul_f32 v[160:161], v[160:161], v[28:29] op_sel_hi:[1,0]
v_pk_mul_f32 v[194:195], v[194:195], v[162:163]
v_pk_mul_f32 v[162:163], v[162:163], v[28:29] op_sel_hi:[1,0]
v_pk_mul_f32 v[208:209], v[208:209], v[176:177]
v_pk_mul_f32 v[176:177], v[176:177], v[28:29] op_sel_hi:[1,0]
v_pk_mul_f32 v[210:211], v[210:211], v[178:179]
v_pk_mul_f32 v[178:179], v[178:179], v[28:29] op_sel_hi:[1,0]
v_pk_fma_f32 v[108:109], v[108:109], v[26:27], v[26:27] op_sel:[0,1,1] op_sel_hi:[1,1,1]
v_pk_fma_f32 v[110:111], v[110:111], v[26:27], v[26:27] op_sel:[0,1,1] op_sel_hi:[1,1,1]
v_pk_fma_f32 v[124:125], v[124:125], v[26:27], v[26:27] op_sel:[0,1,1] op_sel_hi:[1,1,1]
v_pk_fma_f32 v[126:127], v[126:127], v[26:27], v[26:27] op_sel:[0,1,1] op_sel_hi:[1,1,1]
v_cvt_pk_bf16_f32 v104, v136, v137
v_cvt_pk_bf16_f32 v105, v138, v139
v_cvt_pk_bf16_f32 v106, v152, v153
v_cvt_pk_bf16_f32 v107, v154, v155
v_mfma_f32_16x16x32_bf16 v[164:167], a[32:35], a[148:151], v[164:167]
buffer_store_dwordx4 v[104:107], v11, s[16:19], s63 offen sc1
v_mfma_f32_16x16x32_bf16 v[180:183], a[36:39], a[148:151], v[180:183]
v_rcp_f32 v108, v108
v_mfma_f32_16x16x32_bf16 v[196:199], a[40:43], a[148:151], v[196:199]
v_rcp_f32 v109, v109
v_mfma_f32_16x16x32_bf16 v[212:215], a[44:47], a[148:151], v[212:215]
v_rcp_f32 v110, v110
v_mfma_f32_16x16x32_bf16 v[164:167], a[48:51], a[164:167], v[164:167]
buffer_load_dwordx4 v18, s[28:31], s58 offen lds
v_mfma_f32_16x16x32_bf16 v[180:183], a[52:55], a[164:167], v[180:183]
v_rcp_f32 v111, v111
v_mfma_f32_16x16x32_bf16 v[196:199], a[56:59], a[164:167], v[196:199]
v_rcp_f32 v124, v124
v_mfma_f32_16x16x32_bf16 v[212:215], a[60:63], a[164:167], v[212:215]
v_rcp_f32 v125, v125
v_mfma_f32_16x16x32_bf16 v[164:167], a[64:67], a[180:183], v[164:167]
buffer_load_dwordx4 v19, s[28:31], s58 offen offset:1056 lds
v_mfma_f32_16x16x32_bf16 v[180:183], a[68:71], a[180:183], v[180:183]
s_add_u32 m0, s59, 101376
s_mov_b32 s58, 786432
v_rcp_f32 v126, v126
v_mfma_f32_16x16x32_bf16 v[196:199], a[72:75], a[180:183], v[196:199]
v_rcp_f32 v127, v127
v_mfma_f32_16x16x32_bf16 v[212:215], a[76:79], a[180:183], v[212:215]
v_exp_f32 v160, v160
v_exp_f32 v161, v161
v_exp_f32 v162, v162
v_exp_f32 v163, v163
v_exp_f32 v176, v176
v_exp_f32 v177, v177
v_exp_f32 v178, v178
v_exp_f32 v179, v179
v_pk_mul_f32 v[140:141], v[140:141], v[108:109]
v_pk_mul_f32 v[142:143], v[142:143], v[110:111]
v_pk_mul_f32 v[156:157], v[156:157], v[124:125]
v_pk_mul_f32 v[158:159], v[158:159], v[126:127]
v_pk_fma_f32 v[164:165], v[112:113], v[22:23], v[164:165] op_sel_hi:[1,0,1]
v_pk_fma_f32 v[166:167], v[114:115], v[22:23], v[166:167] op_sel_hi:[1,0,1]
v_pk_fma_f32 v[180:181], v[128:129], v[22:23], v[180:181] op_sel_hi:[1,0,1]
v_pk_fma_f32 v[182:183], v[130:131], v[22:23], v[182:183] op_sel_hi:[1,0,1]
v_pk_fma_f32 v[196:197], v[144:145], v[22:23], v[196:197] op_sel_hi:[1,0,1]
v_pk_fma_f32 v[198:199], v[146:147], v[22:23], v[198:199] op_sel_hi:[1,0,1]
v_pk_fma_f32 v[212:213], v[12:13], v[22:23], v[212:213] op_sel_hi:[1,0,1]
v_pk_fma_f32 v[214:215], v[14:15], v[22:23], v[214:215] op_sel_hi:[1,0,1]
v_pk_mul_f32 v[196:197], v[196:197], v[164:165]
v_pk_mul_f32 v[164:165], v[164:165], v[28:29] op_sel:[0,1] op_sel_hi:[1,1]
v_pk_mul_f32 v[198:199], v[198:199], v[166:167]
v_pk_mul_f32 v[166:167], v[166:167], v[28:29] op_sel:[0,1] op_sel_hi:[1,1]
v_pk_mul_f32 v[212:213], v[212:213], v[180:181]
v_pk_mul_f32 v[180:181], v[180:181], v[28:29] op_sel:[0,1] op_sel_hi:[1,1]
v_pk_mul_f32 v[214:215], v[214:215], v[182:183]
v_pk_mul_f32 v[182:183], v[182:183], v[28:29] op_sel:[0,1] op_sel_hi:[1,1]
v_pk_fma_f32 v[160:161], v[160:161], v[20:21], v[20:21] op_sel:[0,1,1] op_sel_hi:[1,1,1]
v_pk_fma_f32 v[162:163], v[162:163], v[20:21], v[20:21] op_sel:[0,1,1] op_sel_hi:[1,1,1]
v_pk_fma_f32 v[176:177], v[176:177], v[20:21], v[20:21] op_sel:[0,1,1] op_sel_hi:[1,1,1]
v_pk_fma_f32 v[178:179], v[178:179], v[20:21], v[20:21] op_sel:[0,1,1] op_sel_hi:[1,1,1]
v_cvt_pk_bf16_f32 v108, v140, v141
v_cvt_pk_bf16_f32 v109, v142, v143
v_cvt_pk_bf16_f32 v110, v156, v157
v_cvt_pk_bf16_f32 v111, v158, v159
v_mfma_f32_16x16x32_bf16 v[168:171], a[32:35], a[152:155], v[168:171]
buffer_store_dwordx4 v[108:111], v11, s[16:19], s63 offen offset:1024 sc1
v_mfma_f32_16x16x32_bf16 v[184:187], a[36:39], a[152:155], v[184:187]
v_rcp_f32 v160, v160
v_mfma_f32_16x16x32_bf16 v[200:203], a[40:43], a[152:155], v[200:203]
v_rcp_f32 v161, v161
v_mfma_f32_16x16x32_bf16 v[216:219], a[44:47], a[152:155], v[216:219]
v_rcp_f32 v162, v162
v_mfma_f32_16x16x32_bf16 v[168:171], a[48:51], a[168:171], v[168:171]
buffer_load_dwordx4 v18, s[28:31], s58 offen lds
v_mfma_f32_16x16x32_bf16 v[184:187], a[52:55], a[168:171], v[184:187]
v_rcp_f32 v163, v163
v_mfma_f32_16x16x32_bf16 v[200:203], a[56:59], a[168:171], v[200:203]
v_rcp_f32 v176, v176
v_mfma_f32_16x16x32_bf16 v[216:219], a[60:63], a[168:171], v[216:219]
v_rcp_f32 v177, v177
v_mfma_f32_16x16x32_bf16 v[168:171], a[64:67], a[184:187], v[168:171]
buffer_load_dwordx4 v19, s[28:31], s58 offen offset:1056 lds
v_mfma_f32_16x16x32_bf16 v[184:187], a[68:71], a[184:187], v[184:187]
s_add_u32 m0, s59, 109824
s_mov_b32 s58, 851968
v_rcp_f32 v178, v178
v_mfma_f32_16x16x32_bf16 v[200:203], a[72:75], a[184:187], v[200:203]
v_rcp_f32 v179, v179
v_mfma_f32_16x16x32_bf16 v[216:219], a[76:79], a[184:187], v[216:219]
v_exp_f32 v164, v164
v_exp_f32 v165, v165
v_exp_f32 v166, v166
v_exp_f32 v167, v167
v_exp_f32 v180, v180
v_exp_f32 v181, v181
v_exp_f32 v182, v182
v_exp_f32 v183, v183
v_pk_mul_f32 v[192:193], v[192:193], v[160:161]
v_pk_mul_f32 v[194:195], v[194:195], v[162:163]
v_pk_mul_f32 v[208:209], v[208:209], v[176:177]
v_pk_mul_f32 v[210:211], v[210:211], v[178:179]
ds_read_b128 v[176:179], v8
v_pk_fma_f32 v[168:169], v[112:113], v[24:25], v[168:169] op_sel_hi:[1,0,1]
v_pk_fma_f32 v[170:171], v[114:115], v[24:25], v[170:171] op_sel_hi:[1,0,1]
v_pk_fma_f32 v[184:185], v[128:129], v[24:25], v[184:185] op_sel_hi:[1,0,1]
v_pk_fma_f32 v[186:187], v[130:131], v[24:25], v[186:187] op_sel_hi:[1,0,1]
v_pk_fma_f32 v[200:201], v[144:145], v[24:25], v[200:201] op_sel_hi:[1,0,1]
v_pk_fma_f32 v[202:203], v[146:147], v[24:25], v[202:203] op_sel_hi:[1,0,1]
v_pk_fma_f32 v[216:217], v[12:13], v[24:25], v[216:217] op_sel_hi:[1,0,1]
v_pk_fma_f32 v[218:219], v[14:15], v[24:25], v[218:219] op_sel_hi:[1,0,1]
v_pk_mul_f32 v[200:201], v[200:201], v[168:169]
v_pk_mul_f32 v[168:169], v[168:169], v[30:31] op_sel_hi:[1,0]
v_pk_mul_f32 v[202:203], v[202:203], v[170:171]
v_pk_mul_f32 v[170:171], v[170:171], v[30:31] op_sel_hi:[1,0]
v_pk_mul_f32 v[216:217], v[216:217], v[184:185]
v_pk_mul_f32 v[184:185], v[184:185], v[30:31] op_sel_hi:[1,0]
v_pk_mul_f32 v[218:219], v[218:219], v[186:187]
v_pk_mul_f32 v[186:187], v[186:187], v[30:31] op_sel_hi:[1,0]
v_pk_fma_f32 v[164:165], v[164:165], v[22:23], v[22:23] op_sel:[0,1,1] op_sel_hi:[1,1,1]
v_pk_fma_f32 v[166:167], v[166:167], v[22:23], v[22:23] op_sel:[0,1,1] op_sel_hi:[1,1,1]
v_pk_fma_f32 v[180:181], v[180:181], v[22:23], v[22:23] op_sel:[0,1,1] op_sel_hi:[1,1,1]
v_pk_fma_f32 v[182:183], v[182:183], v[22:23], v[22:23] op_sel:[0,1,1] op_sel_hi:[1,1,1]
v_cvt_pk_bf16_f32 v160, v192, v193
v_cvt_pk_bf16_f32 v161, v194, v195
ds_read_b128 v[192:195], v8 offset:64
v_cvt_pk_bf16_f32 v162, v208, v209
v_cvt_pk_bf16_f32 v163, v210, v211
v_mfma_f32_16x16x32_bf16 v[172:175], a[32:35], a[156:159], v[172:175]
buffer_store_dwordx4 v[160:163], v10, s[16:19], s64 offen sc1
v_mfma_f32_16x16x32_bf16 v[188:191], a[36:39], a[156:159], v[188:191]
ds_read_b128 v[208:211], v8 offset:512
v_rcp_f32 v164, v164
v_mfma_f32_16x16x32_bf16 v[204:207], a[40:43], a[156:159], v[204:207]
v_rcp_f32 v165, v165
v_mfma_f32_16x16x32_bf16 v[220:223], a[44:47], a[156:159], v[220:223]
v_rcp_f32 v166, v166
v_mfma_f32_16x16x32_bf16 v[172:175], a[48:51], a[172:175], v[172:175]
buffer_load_dwordx4 v18, s[28:31], s58 offen lds
v_mfma_f32_16x16x32_bf16 v[188:191], a[52:55], a[172:175], v[188:191]
v_rcp_f32 v167, v167
v_mfma_f32_16x16x32_bf16 v[204:207], a[56:59], a[172:175], v[204:207]
v_rcp_f32 v180, v180
v_mfma_f32_16x16x32_bf16 v[220:223], a[60:63], a[172:175], v[220:223]
v_rcp_f32 v181, v181
v_mfma_f32_16x16x32_bf16 v[172:175], a[64:67], a[188:191], v[172:175]
buffer_load_dwordx4 v19, s[28:31], s58 offen offset:1056 lds
v_mfma_f32_16x16x32_bf16 v[188:191], a[68:71], a[188:191], v[188:191]
v_rcp_f32 v182, v182
v_mfma_f32_16x16x32_bf16 v[204:207], a[72:75], a[188:191], v[204:207]
v_rcp_f32 v183, v183
v_mfma_f32_16x16x32_bf16 v[220:223], a[76:79], a[188:191], v[220:223]
v_exp_f32 v168, v168
v_exp_f32 v169, v169
v_exp_f32 v170, v170
v_exp_f32 v171, v171
v_exp_f32 v184, v184
v_exp_f32 v185, v185
v_exp_f32 v186, v186
v_exp_f32 v187, v187
v_pk_mul_f32 v[196:197], v[196:197], v[164:165]
v_pk_mul_f32 v[198:199], v[198:199], v[166:167]
v_pk_mul_f32 v[212:213], v[212:213], v[180:181]
v_pk_mul_f32 v[214:215], v[214:215], v[182:183]
v_pk_fma_f32 v[172:173], v[112:113], v[26:27], v[172:173] op_sel_hi:[1,0,1]
v_pk_fma_f32 v[174:175], v[114:115], v[26:27], v[174:175] op_sel_hi:[1,0,1]
v_pk_fma_f32 v[188:189], v[128:129], v[26:27], v[188:189] op_sel_hi:[1,0,1]
v_pk_fma_f32 v[190:191], v[130:131], v[26:27], v[190:191] op_sel_hi:[1,0,1]
v_pk_fma_f32 v[204:205], v[144:145], v[26:27], v[204:205] op_sel_hi:[1,0,1]
v_pk_fma_f32 v[206:207], v[146:147], v[26:27], v[206:207] op_sel_hi:[1,0,1]
v_pk_fma_f32 v[220:221], v[12:13], v[26:27], v[220:221] op_sel_hi:[1,0,1]
v_pk_fma_f32 v[222:223], v[14:15], v[26:27], v[222:223] op_sel_hi:[1,0,1]
v_pk_mul_f32 v[204:205], v[204:205], v[172:173]
v_pk_mul_f32 v[172:173], v[172:173], v[30:31] op_sel:[0,1] op_sel_hi:[1,1]
v_pk_mul_f32 v[206:207], v[206:207], v[174:175]
v_pk_mul_f32 v[174:175], v[174:175], v[30:31] op_sel:[0,1] op_sel_hi:[1,1]
v_pk_mul_f32 v[220:221], v[220:221], v[188:189]
v_pk_mul_f32 v[188:189], v[188:189], v[30:31] op_sel:[0,1] op_sel_hi:[1,1]
v_pk_mul_f32 v[222:223], v[222:223], v[190:191]
v_pk_mul_f32 v[190:191], v[190:191], v[30:31] op_sel:[0,1] op_sel_hi:[1,1]
v_pk_fma_f32 v[168:169], v[168:169], v[24:25], v[24:25] op_sel:[0,1,1] op_sel_hi:[1,1,1]
v_pk_fma_f32 v[170:171], v[170:171], v[24:25], v[24:25] op_sel:[0,1,1] op_sel_hi:[1,1,1]
v_pk_fma_f32 v[184:185], v[184:185], v[24:25], v[24:25] op_sel:[0,1,1] op_sel_hi:[1,1,1]
v_pk_fma_f32 v[186:187], v[186:187], v[24:25], v[24:25] op_sel:[0,1,1] op_sel_hi:[1,1,1]
v_cvt_pk_bf16_f32 v164, v196, v197
v_cvt_pk_bf16_f32 v165, v198, v199
v_cvt_pk_bf16_f32 v166, v212, v213
v_cvt_pk_bf16_f32 v167, v214, v215
v_mfma_f32_16x16x32_bf16 v[224:227], a[80:83], a[144:147], v[224:227]
buffer_store_dwordx4 v[164:167], v10, s[16:19], s64 offen offset:1024 sc1
v_mfma_f32_16x16x32_bf16 v[232:235], a[84:87], a[144:147], v[232:235]
v_rcp_f32 v168, v168
v_mfma_f32_16x16x32_bf16 v[240:243], a[88:91], a[144:147], v[240:243]
v_rcp_f32 v169, v169
v_mfma_f32_16x16x32_bf16 v[248:251], a[92:95], a[144:147], v[248:251]
v_rcp_f32 v170, v170
v_mfma_f32_16x16x32_bf16 v[224:227], a[96:99], a[160:163], v[224:227]
v_rcp_f32 v171, v171
v_mfma_f32_16x16x32_bf16 v[232:235], a[100:103], a[160:163], v[232:235]
v_rcp_f32 v184, v184
v_mfma_f32_16x16x32_bf16 v[240:243], a[104:107], a[160:163], v[240:243]
v_rcp_f32 v185, v185
v_mfma_f32_16x16x32_bf16 v[248:251], a[108:111], a[160:163], v[248:251]
v_rcp_f32 v186, v186
v_mfma_f32_16x16x32_bf16 v[224:227], a[112:115], a[176:179], v[224:227]
v_rcp_f32 v187, v187
v_mfma_f32_16x16x32_bf16 v[232:235], a[116:119], a[176:179], v[232:235]
v_exp_f32 v172, v172
v_mfma_f32_16x16x32_bf16 v[240:243], a[120:123], a[176:179], v[240:243]
v_exp_f32 v173, v173
v_mfma_f32_16x16x32_bf16 v[248:251], a[124:127], a[176:179], v[248:251]
v_exp_f32 v174, v174
v_exp_f32 v175, v175
v_exp_f32 v188, v188
v_exp_f32 v189, v189
v_exp_f32 v190, v190
v_exp_f32 v191, v191
v_pk_mul_f32 v[200:201], v[200:201], v[168:169]
v_pk_mul_f32 v[202:203], v[202:203], v[170:171]
v_pk_mul_f32 v[216:217], v[216:217], v[184:185]
v_pk_mul_f32 v[218:219], v[218:219], v[186:187]
s_waitcnt lgkmcnt(2)
v_pk_fma_f32 v[224:225], v[176:177], v[20:21], v[224:225] op_sel_hi:[1,0,1]
v_pk_fma_f32 v[226:227], v[178:179], v[20:21], v[226:227] op_sel_hi:[1,0,1]
s_waitcnt lgkmcnt(1)
v_pk_fma_f32 v[232:233], v[192:193], v[20:21], v[232:233] op_sel_hi:[1,0,1]
v_pk_fma_f32 v[234:235], v[194:195], v[20:21], v[234:235] op_sel_hi:[1,0,1]
s_waitcnt lgkmcnt(0)
v_pk_fma_f32 v[240:241], v[208:209], v[20:21], v[240:241] op_sel_hi:[1,0,1]
v_pk_fma_f32 v[242:243], v[210:211], v[20:21], v[242:243] op_sel_hi:[1,0,1]
v_pk_fma_f32 v[248:249], v[4:5], v[20:21], v[248:249] op_sel_hi:[1,0,1]
v_pk_fma_f32 v[250:251], v[6:7], v[20:21], v[250:251] op_sel_hi:[1,0,1]
v_pk_mul_f32 v[240:241], v[240:241], v[224:225]
v_pk_mul_f32 v[224:225], v[224:225], v[28:29] op_sel_hi:[1,0]
v_pk_mul_f32 v[242:243], v[242:243], v[226:227]
v_pk_mul_f32 v[226:227], v[226:227], v[28:29] op_sel_hi:[1,0]
v_pk_mul_f32 v[248:249], v[248:249], v[232:233]
v_pk_mul_f32 v[232:233], v[232:233], v[28:29] op_sel_hi:[1,0]
v_pk_mul_f32 v[250:251], v[250:251], v[234:235]
v_pk_mul_f32 v[234:235], v[234:235], v[28:29] op_sel_hi:[1,0]
v_pk_fma_f32 v[172:173], v[172:173], v[26:27], v[26:27] op_sel:[0,1,1] op_sel_hi:[1,1,1]
v_pk_fma_f32 v[174:175], v[174:175], v[26:27], v[26:27] op_sel:[0,1,1] op_sel_hi:[1,1,1]
v_pk_fma_f32 v[188:189], v[188:189], v[26:27], v[26:27] op_sel:[0,1,1] op_sel_hi:[1,1,1]
v_pk_fma_f32 v[190:191], v[190:191], v[26:27], v[26:27] op_sel:[0,1,1] op_sel_hi:[1,1,1]
v_cvt_pk_bf16_f32 v168, v200, v201
v_cvt_pk_bf16_f32 v169, v202, v203
v_cvt_pk_bf16_f32 v170, v216, v217
v_cvt_pk_bf16_f32 v171, v218, v219
v_mfma_f32_16x16x32_bf16 v[228:231], a[80:83], a[148:151], v[228:231]
buffer_store_dwordx4 v[168:171], v11, s[16:19], s64 offen sc1
v_mfma_f32_16x16x32_bf16 v[236:239], a[84:87], a[148:151], v[236:239]
v_rcp_f32 v172, v172
v_mfma_f32_16x16x32_bf16 v[244:247], a[88:91], a[148:151], v[244:247]
v_rcp_f32 v173, v173
v_mfma_f32_16x16x32_bf16 v[252:255], a[92:95], a[148:151], v[252:255]
v_rcp_f32 v174, v174
v_mfma_f32_16x16x32_bf16 v[228:231], a[96:99], a[164:167], v[228:231]
v_rcp_f32 v175, v175
v_mfma_f32_16x16x32_bf16 v[236:239], a[100:103], a[164:167], v[236:239]
v_rcp_f32 v188, v188
v_mfma_f32_16x16x32_bf16 v[244:247], a[104:107], a[164:167], v[244:247]
v_rcp_f32 v189, v189
v_mfma_f32_16x16x32_bf16 v[252:255], a[108:111], a[164:167], v[252:255]
v_rcp_f32 v190, v190
v_mfma_f32_16x16x32_bf16 v[228:231], a[112:115], a[180:183], v[228:231]
v_rcp_f32 v191, v191
v_mfma_f32_16x16x32_bf16 v[236:239], a[116:119], a[180:183], v[236:239]
v_exp_f32 v224, v224
v_mfma_f32_16x16x32_bf16 v[244:247], a[120:123], a[180:183], v[244:247]
v_exp_f32 v225, v225
v_mfma_f32_16x16x32_bf16 v[252:255], a[124:127], a[180:183], v[252:255]
v_exp_f32 v226, v226
v_exp_f32 v227, v227
v_exp_f32 v232, v232
v_exp_f32 v233, v233
v_exp_f32 v234, v234
v_exp_f32 v235, v235
v_pk_mul_f32 v[204:205], v[204:205], v[172:173]
v_pk_mul_f32 v[206:207], v[206:207], v[174:175]
v_pk_mul_f32 v[220:221], v[220:221], v[188:189]
v_pk_mul_f32 v[222:223], v[222:223], v[190:191]
v_pk_fma_f32 v[228:229], v[176:177], v[22:23], v[228:229] op_sel_hi:[1,0,1]
v_pk_fma_f32 v[230:231], v[178:179], v[22:23], v[230:231] op_sel_hi:[1,0,1]
v_pk_fma_f32 v[236:237], v[192:193], v[22:23], v[236:237] op_sel_hi:[1,0,1]
v_pk_fma_f32 v[238:239], v[194:195], v[22:23], v[238:239] op_sel_hi:[1,0,1]
v_pk_fma_f32 v[244:245], v[208:209], v[22:23], v[244:245] op_sel_hi:[1,0,1]
v_pk_fma_f32 v[246:247], v[210:211], v[22:23], v[246:247] op_sel_hi:[1,0,1]
v_pk_fma_f32 v[252:253], v[4:5], v[22:23], v[252:253] op_sel_hi:[1,0,1]
v_pk_fma_f32 v[254:255], v[6:7], v[22:23], v[254:255] op_sel_hi:[1,0,1]
v_pk_mul_f32 v[244:245], v[244:245], v[228:229]
v_pk_mul_f32 v[228:229], v[228:229], v[28:29] op_sel:[0,1] op_sel_hi:[1,1]
v_pk_mul_f32 v[246:247], v[246:247], v[230:231]
v_pk_mul_f32 v[230:231], v[230:231], v[28:29] op_sel:[0,1] op_sel_hi:[1,1]
v_pk_mul_f32 v[252:253], v[252:253], v[236:237]
v_pk_mul_f32 v[236:237], v[236:237], v[28:29] op_sel:[0,1] op_sel_hi:[1,1]
v_pk_mul_f32 v[254:255], v[254:255], v[238:239]
v_pk_mul_f32 v[238:239], v[238:239], v[28:29] op_sel:[0,1] op_sel_hi:[1,1]
v_pk_fma_f32 v[224:225], v[224:225], v[20:21], v[20:21] op_sel:[0,1,1] op_sel_hi:[1,1,1]
v_pk_fma_f32 v[226:227], v[226:227], v[20:21], v[20:21] op_sel:[0,1,1] op_sel_hi:[1,1,1]
v_pk_fma_f32 v[232:233], v[232:233], v[20:21], v[20:21] op_sel:[0,1,1] op_sel_hi:[1,1,1]
v_pk_fma_f32 v[234:235], v[234:235], v[20:21], v[20:21] op_sel:[0,1,1] op_sel_hi:[1,1,1]
v_cvt_pk_bf16_f32 v172, v204, v205
v_cvt_pk_bf16_f32 v173, v206, v207
v_cvt_pk_bf16_f32 v174, v220, v221
v_cvt_pk_bf16_f32 v175, v222, v223
buffer_store_dwordx4 v[172:175], v11, s[16:19], s64 offen offset:1024 sc1
v_rcp_f32 v224, v224
v_rcp_f32 v225, v225
v_rcp_f32 v226, v226
v_rcp_f32 v227, v227
v_rcp_f32 v232, v232
v_rcp_f32 v233, v233
v_rcp_f32 v234, v234
v_rcp_f32 v235, v235
v_exp_f32 v228, v228
v_exp_f32 v229, v229
v_exp_f32 v230, v230
v_exp_f32 v231, v231
v_exp_f32 v236, v236
v_exp_f32 v237, v237
v_exp_f32 v238, v238
v_exp_f32 v239, v239
v_pk_mul_f32 v[240:241], v[240:241], v[224:225]
v_pk_mul_f32 v[242:243], v[242:243], v[226:227]
v_pk_mul_f32 v[248:249], v[248:249], v[232:233]
v_pk_mul_f32 v[250:251], v[250:251], v[234:235]
v_pk_fma_f32 v[228:229], v[228:229], v[22:23], v[22:23] op_sel:[0,1,1] op_sel_hi:[1,1,1]
v_pk_fma_f32 v[230:231], v[230:231], v[22:23], v[22:23] op_sel:[0,1,1] op_sel_hi:[1,1,1]
v_pk_fma_f32 v[236:237], v[236:237], v[22:23], v[22:23] op_sel:[0,1,1] op_sel_hi:[1,1,1]
v_pk_fma_f32 v[238:239], v[238:239], v[22:23], v[22:23] op_sel:[0,1,1] op_sel_hi:[1,1,1]
v_cvt_pk_bf16_f32 v224, v240, v241
v_cvt_pk_bf16_f32 v225, v242, v243
v_cvt_pk_bf16_f32 v226, v248, v249
v_cvt_pk_bf16_f32 v227, v250, v251
buffer_store_dwordx4 v[224:227], v10, s[16:19], s65 offen sc1
v_rcp_f32 v228, v228
v_rcp_f32 v229, v229
v_rcp_f32 v230, v230
v_rcp_f32 v231, v231
v_rcp_f32 v236, v236
v_rcp_f32 v237, v237
v_rcp_f32 v238, v238
v_rcp_f32 v239, v239
v_pk_mul_f32 v[244:245], v[244:245], v[228:229]
v_pk_mul_f32 v[246:247], v[246:247], v[230:231]
v_pk_mul_f32 v[252:253], v[252:253], v[236:237]
v_pk_mul_f32 v[254:255], v[254:255], v[238:239]
v_cvt_pk_bf16_f32 v228, v244, v245
v_cvt_pk_bf16_f32 v229, v246, v247
v_cvt_pk_bf16_f32 v230, v252, v253
v_cvt_pk_bf16_f32 v231, v254, v255
buffer_store_dwordx4 v[228:231], v10, s[16:19], s65 offen offset:1024 sc1
s_nop 1
s_branch .Lj47
.Lpad6:
s_cbranch_execz .Lnopoll40r
.Lx43:
buffer_load_dword v4, v8, s[32:35], s45 offen
buffer_load_dword v4, v7, s[28:31], s44 offen
s_add_u32 s44, s44, 655360
s_add_u32 s45, s45, 917504
s_mov_b32 s47, 3
s_branch .Lx43b
.Lx44:
buffer_load_dword v4, v8, s[32:35], s45 offen
buffer_load_dword v4, v7, s[28:31], s44 offen
s_add_u32 s44, s44, 655360
s_add_u32 s45, s45, 917504
s_mov_b32 s47, 3
s_branch .Lx44b
.Lx45:
buffer_load_dword v4, v8, s[32:35], s45 offen
buffer_load_dword v4, v7, s[28:31], s44 offen
s_add_u32 s44, s44, 655360
s_add_u32 s45, s45, 917504
s_mov_b32 s47, 3
s_branch .Lx45b
.Lx46:
buffer_load_dword v4, v8, s[32:35], s45 offen
buffer_load_dword v4, v7, s[28:31], s44 offen
s_add_u32 s44, s44, 655360
s_add_u32 s45, s45, 917504
s_mov_b32 s47, 3
s_branch .Lx46b
.Lj47:
s_lshl_b32 s62, s5, 2
s_add_u32 s62, s62, s3
s_lshl_b32 s62, s62, 12
s_and_b32 s63, s7, 1
s_mul_i32 s63, s63, 3670016
s_add_u32 s62, s62, s63
s_lshr_b32 s63, s28, 7
s_sub_u32 s63, 3, s63
s_and_b32 s63, s63, 6
s_lshl_b32 s63, s63, 7
s_add_u32 s62, s62, s63
v_lshrrev_b32 v2, 5, v1
v_mul_u32_u24 v2, 1024, v2
v_bfe_u32 v9, v1, 4, 1
v_lshl_add_u32 v9, v9, 11, v2
v_add_u32 v9, s62, v9
v_bfe_u32 v2, v1, 3, 1
v_lshl_add_u32 v9, v2, 7, v9
s_mov_b32 s44, 16777216
s_mov_b32 s45, 1966080
s_lshl_b32 s62, s6, 13
s_lshl_b32 s63, s3, 11
s_add_u32 s62, s62, s63
v_lshl_add_u32 v4, v1, 4, s62
v_lshrrev_b32 v2, 3, v1
v_cmp_eq_u32 vcc, 3, v2
v_add_u32 v2, 67108480, v4
s_nop 0
v_cndmask_b32 v4, v4, v2, vcc
s_and_b32 s62, s7, 1
s_mul_i32 s62, s62, 3670016
s_lshr_b32 s63, s7, 1
s_lshl_b32 s63, s63, 8
s_add_u32 s62, s62, s63
s_lshl_b32 s63, s3, 12
s_add_u32 s62, s62, s63
v_lshrrev_b32 v5, 4, v1
v_lshlrev_b32 v5, 14, v5
v_and_b32 v2, 15, v1
v_lshl_add_u32 v5, v2, 4, v5
v_add_u32 v5, s62, v5
v_add_u32 v6, 992, v5
v_bfe_u32 v8, v1, 2, 3
v_mul_u32_u24 v8, 1056, v8
v_bfe_u32 v2, v1, 5, 1
v_lshl_add_u32 v8, v2, 8, v8
v_and_b32 v2, 3, v1
v_lshl_add_u32 v8, v2, 3, v8
s_and_b32 s62, s7, 1
s_lshl_b32 s63, s62, 7
s_xor_b32 s64, s63, 128
v_add_u32 v7, s63, v8
v_add_u32 v10, s64, v8
s_mul_i32 s52, s62, 7340032
s_add_u32 s52, s52, 12582912
s_mov_b32 s54, 917504
s_mul_i32 s55, s3, 2112
s_add_u32 s56, s55, 67584
s_mov_b32 s57, 67584
s_lshl_b32 s70, s2, 10
s_lshl_b32 s62, s3, 7
s_add_u32 s70, s70, s62
s_add_u32 s70, s70, 31457280
s_xor_b32 s71, s70, 1024
v_min_u32 v12, 1, v1
v_lshlrev_b32 v12, 28, v12
v_mov_b32 v13, 1
v_mov_b32 v15, 0
s_lshl_b32 s68, s7, 18
s_add_u32 s68, s68, 33554432
s_xor_b32 s69, s68, 262144
v_mov_b32 v11, v4
v_and_b32 v2, 1, v1
v_lshlrev_b32 v2, 4, v2
v_mov_b32 v224, 0x3f80
v_lshlrev_b32 v2, v2, v224
v_bfe_u32 v224, v1, 2, 2
v_lshrrev_b32 v225, 4, v1
v_cmp_eq_u32 vcc, v224, v225
s_nop 1
v_cndmask_b32 v2, 0, v2, vcc
v_and_b32 v224, 2, v1
v_cmp_eq_u32 vcc, 0, v224
s_nop 1
v_cndmask_b32 v226, 0, v2, vcc
v_cndmask_b32 v227, v2, 0, vcc
v_mov_b64 v[224:225], 0
v_mov_b64 v[228:229], 0
v_mov_b64 v[64:65], 0
v_mov_b64 v[66:67], 0
v_mov_b64 v[68:69], 0
v_mov_b64 v[70:71], 0
v_mov_b64 v[72:73], 0
v_mov_b64 v[74:75], 0
v_mov_b64 v[76:77], 0
v_mov_b64 v[78:79], 0
v_mov_b64 v[80:81], 0
v_mov_b64 v[82:83], 0
v_mov_b64 v[84:85], 0
v_mov_b64 v[86:87], 0
v_mov_b64 v[88:89], 0
v_mov_b64 v[90:91], 0
v_mov_b64 v[92:93], 0
v_mov_b64 v[94:95], 0
v_accvgpr_read_b32 v32, a224
v_accvgpr_read_b32 v33, a225
v_accvgpr_read_b32 v34, a226
v_accvgpr_read_b32 v35, a227
v_accvgpr_read_b32 v36, a228
v_accvgpr_read_b32 v37, a229
v_accvgpr_read_b32 v38, a230
v_accvgpr_read_b32 v39, a231
v_accvgpr_read_b32 v40, a232
v_accvgpr_read_b32 v41, a233
v_accvgpr_read_b32 v42, a234
v_accvgpr_read_b32 v43, a235
v_accvgpr_read_b32 v44, a236
v_accvgpr_read_b32 v45, a237
v_accvgpr_read_b32 v46, a238
v_accvgpr_read_b32 v47, a239
v_accvgpr_read_b32 v48, a240
v_accvgpr_read_b32 v49, a241
v_accvgpr_read_b32 v50, a242
v_accvgpr_read_b32 v51, a243
v_accvgpr_read_b32 v52, a244
v_accvgpr_read_b32 v53, a245
v_accvgpr_read_b32 v54, a246
v_accvgpr_read_b32 v55, a247
v_accvgpr_read_b32 v56, a248
v_accvgpr_read_b32 v57, a249
v_accvgpr_read_b32 v58, a250
v_accvgpr_read_b32 v59, a251
v_accvgpr_read_b32 v60, a252
v_accvgpr_read_b32 v61, a253
v_accvgpr_read_b32 v62, a254
v_accvgpr_read_b32 v63, a255
v_bfe_u32 v18, v1, 3, 1
v_lshrrev_b32 v2, 4, v1
v_lshl_add_u32 v18, v2, 3, v18
s_lshl_b32 s62, s3, 1
v_add_u32 v18, s62, v18
v_mul_u32_u24 v18, 6144, v18
v_and_b32 v2, 7, v1
v_lshl_add_u32 v18, v2, 4, v18
s_lshl_b32 s62, s9, 7
v_add_u32 v18, s62, v18
v_add_u32 v19, 1024, v18
v_add_u32 v20, 2048, v18
s_mul_i32 s59, s3, 3104
s_mov_b32 s58, 0
s_lshl_b32 s62, s10, 1
s_lshr_b32 s63, s11, 4
s_add_u32 s62, s62, s63
s_lshl_b32 s62, s62, 10
s_add_u32 s62, s62, 30457856
s_and_b32 s64, s6, 14
s_and_b32 s63, s7, 1
s_add_u32 s64, s64, s63
s_lshl_b32 s64, s64, 10
s_add_u32 s64, s64, 30457856
s_lshr_b32 s67, s5, 2
s_and_b32 s67, s67, 3
s_lshl_b32 s67, s67, 7
s_add_u32 s64, s64, s67
v_lshl_add_u32 v252, v1, 7, s62
v_mov_b32 v253, s64
s_waitcnt vmcnt(0) lgkmcnt(0)
s_barrier
s_cmp_lg_u32 s3, 0
s_cbranch_scc1 .Lnosig48
v_mov_b32 v255, 1
s_mov_b64 exec, 15
buffer_atomic_add v255, v252, s[16:19], 0 offen
s_mov_b64 exec, -1
.Lnosig48:
s_cmp_lg_u32 s3, 1
s_cbranch_scc1 .Lnopoll51
s_mov_b64 exec, 1
s_mov_b32 s15, 0
s_mov_b64 exec, 1
v_mov_b32 v254, 0
buffer_atomic_add v254, v253, s[16:19], 0 offen sc0
.Lpoll49:
s_waitcnt vmcnt(0)
v_cmp_ne_u32 vcc, 16, v254
s_add_u32 s15, s15, 1
s_cbranch_vccz .Lnopoll51r
s_mov_b64 exec, 1
v_mov_b32 v254, 0
buffer_atomic_add v254, v253, s[16:19], 0 offen sc0
s_cmp_le_u32 s15, 100000
s_cbranch_scc1 .Lpoll49
.Lgot50:
s_waitcnt vmcnt(0)
s_branch .Lnopoll51r
.Lnopoll51:
s_mov_b64 exec, 0
s_cmp_eq_u32 s3, 2
s_cbranch_scc1 .Lpad7
s_cmp_eq_u32 s3, 3
s_cbranch_scc1 .Lpad8
s_branch .Lpad9
.Lnopoll51r:
s_mov_b64 exec, -1
s_barrier
buffer_load_dwordx4 v[96:99], v4, s[16:19], s52 offen sc1
buffer_load_dwordx4 v[100:103], v4, s[16:19], s52 offen offset:1024 sc1
s_add_u32 s52, s52, 0x20000
buffer_load_dwordx4 v[104:107], v4, s[16:19], s52 offen sc1
buffer_load_dwordx4 v[108:111], v4, s[16:19], s52 offen offset:1024 sc1
s_add_u32 s52, s52, 0x20000
buffer_load_dwordx4 v[112:115], v4, s[16:19], s52 offen sc1
buffer_load_dwordx4 v[116:119], v4, s[16:19], s52 offen offset:1024 sc1
.Lpad7:
s_cbranch_execz .Lpad10
s_add_u32 s52, s52, 0x20000
buffer_load_dwordx4 v[120:123], v4, s[16:19], s52 offen sc1
buffer_load_dwordx4 v[124:127], v4, s[16:19], s52 offen offset:1024 sc1
s_add_u32 s52, s52, 0x20000
buffer_load_dwordx4 v[128:131], v4, s[16:19], s52 offen sc1
buffer_load_dwordx4 v[132:135], v4, s[16:19], s52 offen offset:1024 sc1
s_add_u32 s52, s52, 0x20000
buffer_load_dwordx4 v[136:139], v4, s[16:19], s52 offen sc1
buffer_load_dwordx4 v[140:143], v4, s[16:19], s52 offen offset:1024 sc1
s_add_u32 s52, s52, 0x20000
ds_read_b64_tr_b16 a[0:1], v7
ds_read_b64_tr_b16 a[2:3], v7 offset:512
ds_read_b64_tr_b16 a[4:5], v7 offset:32
ds_read_b64_tr_b16 a[6:7], v7 offset:544
ds_read_b64_tr_b16 a[8:9], v7 offset:64
ds_read_b64_tr_b16 a[10:11], v7 offset:576
ds_read_b64_tr_b16 a[12:13], v7 offset:96
ds_read_b64_tr_b16 a[14:15], v7 offset:608
ds_read_b64_tr_b16 a[16:17], v10
ds_read_b64_tr_b16 a[18:19], v10 offset:512
ds_read_b64_tr_b16 a[20:21], v10 offset:32
ds_read_b64_tr_b16 a[22:23], v10 offset:544
ds_read_b64_tr_b16 a[24:25], v10 offset:64
ds_read_b64_tr_b16 a[26:27], v10 offset:576
ds_read_b64_tr_b16 a[28:29], v10 offset:96
ds_read_b64_tr_b16 a[30:31], v10 offset:608
s_waitcnt lgkmcnt(0)
s_mov_b32 s15, -4
.p2align 6
.Lk53:
s_waitcnt vmcnt(10) lgkmcnt(8)
s_barrier
v_mfma_f32_16x16x32_bf16 v[32:35], a[0:3], v[96:99], v[32:35]
ds_read_b64_tr_b16 a[32:33], v7 offset:8448
s_add_u32 m0, s56, 50688
v_mfma_f32_16x16x32_bf16 v[48:51], a[0:3], v[100:103], v[48:51]
buffer_load_dwordx4 v5, s[28:31], s54 offen lds
v_mfma_f32_16x16x32_bf16 v[52:55], a[4:7], v[100:103], v[52:55]
ds_read_b64_tr_b16 a[34:35], v7 offset:8960
ds_read_b64_tr_b16 a[36:37], v7 offset:8480
v_mfma_f32_16x16x32_bf16 v[36:39], a[4:7], v[96:99], v[36:39]
ds_read_b64_tr_b16 a[38:39], v7 offset:8992
v_mfma_f32_16x16x32_bf16 v[40:43], a[8:11], v[96:99], v[40:43]
buffer_load_dwordx4 v[144:147], v4, s[16:19], s52 offen sc1
v_mfma_f32_16x16x32_bf16 v[56:59], a[8:11], v[100:103], v[56:59]
ds_read_b64_tr_b16 a[40:41], v7 offset:8512
ds_read_b64_tr_b16 a[42:43], v7 offset:9024
v_mfma_f32_16x16x32_bf16 v[60:63], a[12:15], v[100:103], v[60:63]
ds_read_b64_tr_b16 a[44:45], v7 offset:8544
ds_read_b64_tr_b16 a[46:47], v7 offset:9056
v_mfma_f32_16x16x32_bf16 v[44:47], a[12:15], v[96:99], v[44:47]
s_waitcnt lgkmcnt(8)
v_mfma_f32_16x16x32_bf16 v[64:67], a[16:19], v[96:99], v[64:67]
buffer_load_dwordx4 v6, s[28:31], s54 offen offset:1056 lds
v_mfma_f32_16x16x32_bf16 v[80:83], a[16:19], v[100:103], v[80:83]
ds_read_b64_tr_b16 a[48:49], v10 offset:8448
s_add_u32 s54, s54, 0x10000
v_mfma_f32_16x16x32_bf16 v[84:87], a[20:23], v[100:103], v[84:87]
ds_read_b64_tr_b16 a[50:51], v10 offset:8960
ds_read_b64_tr_b16 a[52:53], v10 offset:8480
v_mfma_f32_16x16x32_bf16 v[68:71], a[20:23], v[96:99], v[68:71]
ds_read_b64_tr_b16 a[54:55], v10 offset:8992
v_mfma_f32_16x16x32_bf16 v[72:75], a[24:27], v[96:99], v[72:75]
buffer_load_dwordx4 v[148:151], v4, s[16:19], s52 offen offset:1024 sc1
v_mfma_f32_16x16x32_bf16 v[88:91], a[24:27], v[100:103], v[88:91]
ds_read_b64_tr_b16 a[56:57], v10 offset:8512
s_add_u32 s52, s52, 0x20000
v_mfma_f32_16x16x32_bf16 v[92:95], a[28:31], v[100:103], v[92:95]
ds_read_b64_tr_b16 a[58:59], v10 offset:9024
ds_read_b64_tr_b16 a[60:61], v10 offset:8544
v_mfma_f32_16x16x32_bf16 v[76:79], a[28:31], v[96:99], v[76:79]
ds_read_b64_tr_b16 a[62:63], v10 offset:9056
s_waitcnt vmcnt(12) lgkmcnt(8)
v_mfma_f32_16x16x32_bf16 v[32:35], a[32:35], v[104:107], v[32:35]
ds_read_b64_tr_b16 a[0:1], v7 offset:16896
s_add_u32 m0, s56, 59136
v_mfma_f32_16x16x32_bf16 v[48:51], a[32:35], v[108:111], v[48:51]
buffer_load_dwordx4 v5, s[28:31], s54 offen lds
v_mfma_f32_16x16x32_bf16 v[52:55], a[36:39], v[108:111], v[52:55]
ds_read_b64_tr_b16 a[2:3], v7 offset:17408
ds_read_b64_tr_b16 a[4:5], v7 offset:16928
v_mfma_f32_16x16x32_bf16 v[36:39], a[36:39], v[104:107], v[36:39]
ds_read_b64_tr_b16 a[6:7], v7 offset:17440
ds_read_b64_tr_b16 a[8:9], v7 offset:16960
v_mfma_f32_16x16x32_bf16 v[40:43], a[40:43], v[104:107], v[40:43]
buffer_load_dwordx4 v[152:155], v4, s[16:19], s52 offen sc1
v_mfma_f32_16x16x32_bf16 v[56:59], a[40:43], v[108:111], v[56:59]
ds_read_b64_tr_b16 a[10:11], v7 offset:17472
ds_read_b64_tr_b16 a[12:13], v7 offset:16992
v_mfma_f32_16x16x32_bf16 v[60:63], a[44:47], v[108:111], v[60:63]
ds_read_b64_tr_b16 a[14:15], v7 offset:17504
ds_read_b64_tr_b16 a[16:17], v10 offset:16896
v_mfma_f32_16x16x32_bf16 v[44:47], a[44:47], v[104:107], v[44:47]
ds_read_b64_tr_b16 a[18:19], v10 offset:17408
s_waitcnt lgkmcnt(10)
v_mfma_f32_16x16x32_bf16 v[64:67], a[48:51], v[104:107], v[64:67]
buffer_load_dwordx4 v6, s[28:31], s54 offen offset:1056 lds
v_mfma_f32_16x16x32_bf16 v[80:83], a[48:51], v[108:111], v[80:83]
ds_read_b64_tr_b16 a[20:21], v10 offset:16928
s_add_u32 s54, s54, 0x10000
v_mfma_f32_16x16x32_bf16 v[84:87], a[52:55], v[108:111], v[84:87]
buffer_load_dwordx4 v[156:159], v4, s[16:19], s52 offen offset:1024 sc1
v_mfma_f32_16x16x32_bf16 v[68:71], a[52:55], v[104:107], v[68:71]
ds_read_b64_tr_b16 a[22:23], v10 offset:17440
s_add_u32 s52, s52, 0x20000
v_mfma_f32_16x16x32_bf16 v[72:75], a[56:59], v[104:107], v[72:75]
ds_read_b64_tr_b16 a[24:25], v10 offset:16960
ds_read_b64_tr_b16 a[26:27], v10 offset:17472
v_mfma_f32_16x16x32_bf16 v[88:91], a[56:59], v[108:111], v[88:91]
buffer_load_dword v27, v9, s[28:31], s44 offen
v_mfma_f32_16x16x32_bf16 v[92:95], a[60:63], v[108:111], v[92:95]
ds_read_b64_tr_b16 a[28:29], v10 offset:16992
s_mov_b32 s44, s45
s_add_u32 s45, s45, 0x80000
v_mfma_f32_16x16x32_bf16 v[76:79], a[60:63], v[104:107], v[76:79]
ds_read_b64_tr_b16 a[30:31], v10 offset:17504
s_waitcnt vmcnt(15) lgkmcnt(8)
s_barrier
v_mfma_f32_16x16x32_bf16 v[32:35], a[0:3], v[112:115], v[32:35]
ds_read_b64_tr_b16 a[32:33], v7 offset:25344
s_add_u32 m0, s55, 0
v_mfma_f32_16x16x32_bf16 v[48:51], a[0:3], v[116:119], v[48:51]
buffer_load_dwordx4 v5, s[28:31], s54 offen lds
v_mfma_f32_16x16x32_bf16 v[52:55], a[4:7], v[116:119], v[52:55]
ds_read_b64_tr_b16 a[34:35], v7 offset:25856
ds_read_b64_tr_b16 a[36:37], v7 offset:25376
v_mfma_f32_16x16x32_bf16 v[36:39], a[4:7], v[112:115], v[36:39]
ds_read_b64_tr_b16 a[38:39], v7 offset:25888
v_mfma_f32_16x16x32_bf16 v[40:43], a[8:11], v[112:115], v[40:43]
buffer_load_dwordx4 v[96:99], v4, s[16:19], s52 offen sc1
v_mfma_f32_16x16x32_bf16 v[56:59], a[8:11], v[116:119], v[56:59]
ds_read_b64_tr_b16 a[40:41], v7 offset:25408
ds_read_b64_tr_b16 a[42:43], v7 offset:25920
v_mfma_f32_16x16x32_bf16 v[60:63], a[12:15], v[116:119], v[60:63]
ds_read_b64_tr_b16 a[44:45], v7 offset:25440
ds_read_b64_tr_b16 a[46:47], v7 offset:25952
v_mfma_f32_16x16x32_bf16 v[44:47], a[12:15], v[112:115], v[44:47]
s_waitcnt lgkmcnt(8)
v_mfma_f32_16x16x32_bf16 v[64:67], a[16:19], v[112:115], v[64:67]
buffer_load_dwordx4 v6, s[28:31], s54 offen offset:1056 lds
v_mfma_f32_16x16x32_bf16 v[80:83], a[16:19], v[116:119], v[80:83]
ds_read_b64_tr_b16 a[48:49], v10 offset:25344
s_add_u32 s54, s54, 0x10000
v_mfma_f32_16x16x32_bf16 v[84:87], a[20:23], v[116:119], v[84:87]
ds_read_b64_tr_b16 a[50:51], v10 offset:25856
ds_read_b64_tr_b16 a[52:53], v10 offset:25376
v_mfma_f32_16x16x32_bf16 v[68:71], a[20:23], v[112:115], v[68:71]
ds_read_b64_tr_b16 a[54:55], v10 offset:25888
v_mfma_f32_16x16x32_bf16 v[72:75], a[24:27], v[112:115], v[72:75]
buffer_load_dwordx4 v[100:103], v4, s[16:19], s52 offen offset:1024 sc1
v_mfma_f32_16x16x32_bf16 v[88:91], a[24:27], v[116:119], v[88:91]
ds_read_b64_tr_b16 a[56:57], v10 offset:25408
s_add_u32 s52, s52, 0x20000
v_mfma_f32_16x16x32_bf16 v[92:95], a[28:31], v[116:119], v[92:95]
ds_read_b64_tr_b16 a[58:59], v10 offset:25920
ds_read_b64_tr_b16 a[60:61], v10 offset:25440
v_mfma_f32_16x16x32_bf16 v[76:79], a[28:31], v[112:115], v[76:79]
ds_read_b64_tr_b16 a[62:63], v10 offset:25952
s_waitcnt vmcnt(17) lgkmcnt(8)
v_mfma_f32_16x16x32_bf16 v[32:35], a[32:35], v[120:123], v[32:35]
ds_read_b64_tr_b16 a[0:1], v7 offset:33792
s_add_u32 m0, s55, 8448
v_mfma_f32_16x16x32_bf16 v[48:51], a[32:35], v[124:127], v[48:51]
buffer_load_dwordx4 v5, s[28:31], s54 offen lds
v_mfma_f32_16x16x32_bf16 v[52:55], a[36:39], v[124:127], v[52:55]
ds_read_b64_tr_b16 a[2:3], v7 offset:34304
ds_read_b64_tr_b16 a[4:5], v7 offset:33824
v_mfma_f32_16x16x32_bf16 v[36:39], a[36:39], v[120:123], v[36:39]
ds_read_b64_tr_b16 a[6:7], v7 offset:34336
v_mfma_f32_16x16x32_bf16 v[40:43], a[40:43], v[120:123], v[40:43]
buffer_load_dwordx4 v[104:107], v4, s[16:19], s52 offen sc1
v_mfma_f32_16x16x32_bf16 v[56:59], a[40:43], v[124:127], v[56:59]
ds_read_b64_tr_b16 a[8:9], v7 offset:33856
ds_read_b64_tr_b16 a[10:11], v7 offset:34368
v_mfma_f32_16x16x32_bf16 v[60:63], a[44:47], v[124:127], v[60:63]
ds_read_b64_tr_b16 a[12:13], v7 offset:33888
ds_read_b64_tr_b16 a[14:15], v7 offset:34400
v_mfma_f32_16x16x32_bf16 v[44:47], a[44:47], v[120:123], v[44:47]
s_waitcnt lgkmcnt(8)
v_mfma_f32_16x16x32_bf16 v[64:67], a[48:51], v[120:123], v[64:67]
buffer_load_dwordx4 v6, s[28:31], s54 offen offset:1056 lds
v_mfma_f32_16x16x32_bf16 v[80:83], a[48:51], v[124:127], v[80:83]
ds_read_b64_tr_b16 a[16:17], v10 offset:33792
s_add_u32 s54, s54, 0x10000
v_mfma_f32_16x16x32_bf16 v[84:87], a[52:55], v[124:127], v[84:87]
ds_read_b64_tr_b16 a[18:19], v10 offset:34304
ds_read_b64_tr_b16 a[20:21], v10 offset:33824
v_mfma_f32_16x16x32_bf16 v[68:71], a[52:55], v[120:123], v[68:71]
ds_read_b64_tr_b16 a[22:23], v10 offset:34336
v_mfma_f32_16x16x32_bf16 v[72:75], a[56:59], v[120:123], v[72:75]
buffer_load_dwordx4 v[108:111], v4, s[16:19], s52 offen offset:1024 sc1
v_mfma_f32_16x16x32_bf16 v[88:91], a[56:59], v[124:127], v[88:91]
ds_read_b64_tr_b16 a[24:25], v10 offset:33856
s_add_u32 s52, s52, 0x20000
v_mfma_f32_16x16x32_bf16 v[92:95], a[60:63], v[124:127], v[92:95]
ds_read_b64_tr_b16 a[26:27], v10 offset:34368
ds_read_b64_tr_b16 a[28:29], v10 offset:33888
v_mfma_f32_16x16x32_bf16 v[76:79], a[60:63], v[120:123], v[76:79]
ds_read_b64_tr_b16 a[30:31], v10 offset:34400
s_waitcnt vmcnt(19) lgkmcnt(8)
s_barrier
v_mfma_f32_16x16x32_bf16 v[32:35], a[0:3], v[128:131], v[32:35]
ds_read_b64_tr_b16 a[32:33], v7 offset:42240
s_add_u32 m0, s55, 16896
v_mfma_f32_16x16x32_bf16 v[48:51], a[0:3], v[132:135], v[48:51]
buffer_load_dwordx4 v5, s[28:31], s54 offen lds
v_mfma_f32_16x16x32_bf16 v[52:55], a[4:7], v[132:135], v[52:55]
ds_read_b64_tr_b16 a[34:35], v7 offset:42752
ds_read_b64_tr_b16 a[36:37], v7 offset:42272
v_mfma_f32_16x16x32_bf16 v[36:39], a[4:7], v[128:131], v[36:39]
ds_read_b64_tr_b16 a[38:39], v7 offset:42784
v_mfma_f32_16x16x32_bf16 v[40:43], a[8:11], v[128:131], v[40:43]
buffer_load_dwordx4 v[112:115], v4, s[16:19], s52 offen sc1
v_mfma_f32_16x16x32_bf16 v[56:59], a[8:11], v[132:135], v[56:59]
ds_read_b64_tr_b16 a[40:41], v7 offset:42304
ds_read_b64_tr_b16 a[42:43], v7 offset:42816
v_mfma_f32_16x16x32_bf16 v[60:63], a[12:15], v[132:135], v[60:63]
ds_read_b64_tr_b16 a[44:45], v7 offset:42336
ds_read_b64_tr_b16 a[46:47], v7 offset:42848
v_mfma_f32_16x16x32_bf16 v[44:47], a[12:15], v[128:131], v[44:47]
s_waitcnt lgkmcnt(8)
v_mfma_f32_16x16x32_bf16 v[64:67], a[16:19], v[128:131], v[64:67]
buffer_load_dwordx4 v6, s[28:31], s54 offen offset:1056 lds
v_mfma_f32_16x16x32_bf16 v[80:83], a[16:19], v[132:135], v[80:83]
ds_read_b64_tr_b16 a[48:49], v10 offset:42240
s_add_u32 s54, s54, 0x10000
v_mfma_f32_16x16x32_bf16 v[84:87], a[20:23], v[132:135], v[84:87]
ds_read_b64_tr_b16 a[50:51], v10 offset:42752
ds_read_b64_tr_b16 a[52:53], v10 offset:42272
v_mfma_f32_16x16x32_bf16 v[68:71], a[20:23], v[128:131], v[68:71]
ds_read_b64_tr_b16 a[54:55], v10 offset:42784
v_mfma_f32_16x16x32_bf16 v[72:75], a[24:27], v[128:131], v[72:75]
buffer_load_dwordx4 v[116:119], v4, s[16:19], s52 offen offset:1024 sc1
v_mfma_f32_16x16x32_bf16 v[88:91], a[24:27], v[132:135], v[88:91]
ds_read_b64_tr_b16 a[56:57], v10 offset:42304
s_add_u32 s52, s52, 0x20000
v_mfma_f32_16x16x32_bf16 v[92:95], a[28:31], v[132:135], v[92:95]
ds_read_b64_tr_b16 a[58:59], v10 offset:42816
ds_read_b64_tr_b16 a[60:61], v10 offset:42336
v_mfma_f32_16x16x32_bf16 v[76:79], a[28:31], v[128:131], v[76:79]
ds_read_b64_tr_b16 a[62:63], v10 offset:42848
s_waitcnt vmcnt(21) lgkmcnt(8)
v_mfma_f32_16x16x32_bf16 v[32:35], a[32:35], v[136:139], v[32:35]
ds_read_b64_tr_b16 a[0:1], v7 offset:50688
s_add_u32 m0, s55, 25344
v_mfma_f32_16x16x32_bf16 v[48:51], a[32:35], v[140:143], v[48:51]
buffer_load_dwordx4 v5, s[28:31], s54 offen lds
v_mfma_f32_16x16x32_bf16 v[52:55], a[36:39], v[140:143], v[52:55]
ds_read_b64_tr_b16 a[2:3], v7 offset:51200
ds_read_b64_tr_b16 a[4:5], v7 offset:50720
v_mfma_f32_16x16x32_bf16 v[36:39], a[36:39], v[136:139], v[36:39]
ds_read_b64_tr_b16 a[6:7], v7 offset:51232
v_mfma_f32_16x16x32_bf16 v[40:43], a[40:43], v[136:139], v[40:43]
buffer_load_dwordx4 v[120:123], v4, s[16:19], s52 offen sc1
v_mfma_f32_16x16x32_bf16 v[56:59], a[40:43], v[140:143], v[56:59]
ds_read_b64_tr_b16 a[8:9], v7 offset:50752
ds_read_b64_tr_b16 a[10:11], v7 offset:51264
v_mfma_f32_16x16x32_bf16 v[60:63], a[44:47], v[140:143], v[60:63]
ds_read_b64_tr_b16 a[12:13], v7 offset:50784
ds_read_b64_tr_b16 a[14:15], v7 offset:51296
v_mfma_f32_16x16x32_bf16 v[44:47], a[44:47], v[136:139], v[44:47]
s_waitcnt lgkmcnt(8)
v_mfma_f32_16x16x32_bf16 v[64:67], a[48:51], v[136:139], v[64:67]
buffer_load_dwordx4 v6, s[28:31], s54 offen offset:1056 lds
v_mfma_f32_16x16x32_bf16 v[80:83], a[48:51], v[140:143], v[80:83]
ds_read_b64_tr_b16 a[16:17], v10 offset:50688
s_add_u32 s54, s54, 0x10000
v_mfma_f32_16x16x32_bf16 v[84:87], a[52:55], v[140:143], v[84:87]
ds_read_b64_tr_b16 a[18:19], v10 offset:51200
ds_read_b64_tr_b16 a[20:21], v10 offset:50720
v_mfma_f32_16x16x32_bf16 v[68:71], a[52:55], v[136:139], v[68:71]
ds_read_b64_tr_b16 a[22:23], v10 offset:51232
v_mfma_f32_16x16x32_bf16 v[72:75], a[56:59], v[136:139], v[72:75]
buffer_load_dwordx4 v[124:127], v4, s[16:19], s52 offen offset:1024 sc1
v_mfma_f32_16x16x32_bf16 v[88:91], a[56:59], v[140:143], v[88:91]
ds_read_b64_tr_b16 a[24:25], v10 offset:50752
s_add_u32 s52, s52, 0x20000
v_mfma_f32_16x16x32_bf16 v[92:95], a[60:63], v[140:143], v[92:95]
ds_read_b64_tr_b16 a[26:27], v10 offset:51264
ds_read_b64_tr_b16 a[28:29], v10 offset:50784
v_mfma_f32_16x16x32_bf16 v[76:79], a[60:63], v[136:139], v[76:79]
ds_read_b64_tr_b16 a[30:31], v10 offset:51296
s_waitcnt vmcnt(21) lgkmcnt(8)
s_barrier
v_mfma_f32_16x16x32_bf16 v[32:35], a[0:3], v[144:147], v[32:35]
ds_read_b64_tr_b16 a[32:33], v7 offset:59136
s_add_u32 m0, s55, 33792
v_mfma_f32_16x16x32_bf16 v[48:51], a[0:3], v[148:151], v[48:51]
buffer_load_dwordx4 v5, s[28:31], s54 offen lds
v_mfma_f32_16x16x32_bf16 v[52:55], a[4:7], v[148:151], v[52:55]
ds_read_b64_tr_b16 a[34:35], v7 offset:59648
ds_read_b64_tr_b16 a[36:37], v7 offset:59168
v_mfma_f32_16x16x32_bf16 v[36:39], a[4:7], v[144:147], v[36:39]
ds_read_b64_tr_b16 a[38:39], v7 offset:59680
v_mfma_f32_16x16x32_bf16 v[40:43], a[8:11], v[144:147], v[40:43]
buffer_load_dwordx4 v[128:131], v4, s[16:19], s52 offen sc1
v_mfma_f32_16x16x32_bf16 v[56:59], a[8:11], v[148:151], v[56:59]
ds_read_b64_tr_b16 a[40:41], v7 offset:59200
ds_read_b64_tr_b16 a[42:43], v7 offset:59712
v_mfma_f32_16x16x32_bf16 v[60:63], a[12:15], v[148:151], v[60:63]
ds_read_b64_tr_b16 a[44:45], v7 offset:59232
ds_read_b64_tr_b16 a[46:47], v7 offset:59744
v_mfma_f32_16x16x32_bf16 v[44:47], a[12:15], v[144:147], v[44:47]
s_waitcnt lgkmcnt(8)
v_mfma_f32_16x16x32_bf16 v[64:67], a[16:19], v[144:147], v[64:67]
buffer_load_dwordx4 v6, s[28:31], s54 offen offset:1056 lds
v_mfma_f32_16x16x32_bf16 v[80:83], a[16:19], v[148:151], v[80:83]
ds_read_b64_tr_b16 a[48:49], v10 offset:59136
s_add_u32 s54, s54, 0x10000
v_mfma_f32_16x16x32_bf16 v[84:87], a[20:23], v[148:151], v[84:87]
ds_read_b64_tr_b16 a[50:51], v10 offset:59648
ds_read_b64_tr_b16 a[52:53], v10 offset:59168
v_mfma_f32_16x16x32_bf16 v[68:71], a[20:23], v[144:147], v[68:71]
ds_read_b64_tr_b16 a[54:55], v10 offset:59680
v_mfma_f32_16x16x32_bf16 v[72:75], a[24:27], v[144:147], v[72:75]
buffer_load_dwordx4 v[132:135], v4, s[16:19], s52 offen offset:1024 sc1
v_mfma_f32_16x16x32_bf16 v[88:91], a[24:27], v[148:151], v[88:91]
ds_read_b64_tr_b16 a[56:57], v10 offset:59200
s_add_u32 s52, s52, 0x20000
v_mfma_f32_16x16x32_bf16 v[92:95], a[28:31], v[148:151], v[92:95]
ds_read_b64_tr_b16 a[58:59], v10 offset:59712
ds_read_b64_tr_b16 a[60:61], v10 offset:59232
v_mfma_f32_16x16x32_bf16 v[76:79], a[28:31], v[144:147], v[76:79]
ds_read_b64_tr_b16 a[62:63], v10 offset:59744
v_add_u32 v7, s57, v7
v_add_u32 v10, s57, v10
s_sub_u32 s57, 0, s57
s_waitcnt vmcnt(21) lgkmcnt(8)
v_mfma_f32_16x16x32_bf16 v[32:35], a[32:35], v[152:155], v[32:35]
ds_read_b64_tr_b16 a[0:1], v7
s_add_u32 m0, s55, 42240
v_mfma_f32_16x16x32_bf16 v[48:51], a[32:35], v[156:159], v[48:51]
buffer_load_dwordx4 v5, s[28:31], s54 offen lds
v_mfma_f32_16x16x32_bf16 v[52:55], a[36:39], v[156:159], v[52:55]
ds_read_b64_tr_b16 a[2:3], v7 offset:512
ds_read_b64_tr_b16 a[4:5], v7 offset:32
v_mfma_f32_16x16x32_bf16 v[36:39], a[36:39], v[152:155], v[36:39]
ds_read_b64_tr_b16 a[6:7], v7 offset:544
v_mfma_f32_16x16x32_bf16 v[40:43], a[40:43], v[152:155], v[40:43]
buffer_load_dwordx4 v[136:139], v4, s[16:19], s52 offen sc1
v_mfma_f32_16x16x32_bf16 v[56:59], a[40:43], v[156:159], v[56:59]
ds_read_b64_tr_b16 a[8:9], v7 offset:64
ds_read_b64_tr_b16 a[10:11], v7 offset:576
v_mfma_f32_16x16x32_bf16 v[60:63], a[44:47], v[156:159], v[60:63]
ds_read_b64_tr_b16 a[12:13], v7 offset:96
ds_read_b64_tr_b16 a[14:15], v7 offset:608
v_mfma_f32_16x16x32_bf16 v[44:47], a[44:47], v[152:155], v[44:47]
s_waitcnt lgkmcnt(8)
v_mfma_f32_16x16x32_bf16 v[64:67], a[48:51], v[152:155], v[64:67]
buffer_load_dwordx4 v6, s[28:31], s54 offen offset:1056 lds
v_mfma_f32_16x16x32_bf16 v[80:83], a[48:51], v[156:159], v[80:83]
ds_read_b64_tr_b16 a[16:17], v10
s_add_u32 s54, s54, 0x10000
v_mfma_f32_16x16x32_bf16 v[84:87], a[52:55], v[156:159], v[84:87]
ds_read_b64_tr_b16 a[18:19], v10 offset:512
ds_read_b64_tr_b16 a[20:21], v10 offset:32
v_mfma_f32_16x16x32_bf16 v[68:71], a[52:55], v[152:155], v[68:71]
ds_read_b64_tr_b16 a[22:23], v10 offset:544
v_mfma_f32_16x16x32_bf16 v[72:75], a[56:59], v[152:155], v[72:75]
buffer_load_dwordx4 v[140:143], v4, s[16:19], s52 offen offset:1024 sc1
v_mfma_f32_16x16x32_bf16 v[88:91], a[56:59], v[156:159], v[88:91]
ds_read_b64_tr_b16 a[24:25], v10 offset:64
s_add_u32 s52, s52, 0x20000
v_mfma_f32_16x16x32_bf16 v[92:95], a[60:63], v[156:159], v[92:95]
ds_read_b64_tr_b16 a[26:27], v10 offset:576
ds_read_b64_tr_b16 a[28:29], v10 offset:96
v_mfma_f32_16x16x32_bf16 v[76:79], a[60:63], v[152:155], v[76:79]
ds_read_b64_tr_b16 a[30:31], v10 offset:608
s_mov_b32 s62, s55
s_mov_b32 s55, s56
s_mov_b32 s56, s62
s_add_u32 s15, s15, 1
s_cbranch_scc0 .Lk53
s_waitcnt vmcnt(20) lgkmcnt(8)
s_barrier
v_mfma_f32_16x16x32_bf16 v[32:35], a[0:3], v[96:99], v[32:35]
ds_read_b64_tr_b16 a[32:33], v7 offset:8448
s_add_u32 m0, s56, 50688
v_mfma_f32_16x16x32_bf16 v[48:51], a[0:3], v[100:103], v[48:51]
buffer_load_dwordx4 v5, s[28:31], s54 offen lds
v_mfma_f32_16x16x32_bf16 v[52:55], a[4:7], v[100:103], v[52:55]
ds_read_b64_tr_b16 a[34:35], v7 offset:8960
ds_read_b64_tr_b16 a[36:37], v7 offset:8480
v_mfma_f32_16x16x32_bf16 v[36:39], a[4:7], v[96:99], v[36:39]
ds_read_b64_tr_b16 a[38:39], v7 offset:8992
v_mfma_f32_16x16x32_bf16 v[40:43], a[8:11], v[96:99], v[40:43]
buffer_load_dwordx4 v[144:147], v4, s[16:19], s52 offen sc1
v_mfma_f32_16x16x32_bf16 v[56:59], a[8:11], v[100:103], v[56:59]
ds_read_b64_tr_b16 a[40:41], v7 offset:8512
ds_read_b64_tr_b16 a[42:43], v7 offset:9024
v_mfma_f32_16x16x32_bf16 v[60:63], a[12:15], v[100:103], v[60:63]
ds_read_b64_tr_b16 a[44:45], v7 offset:8544
ds_read_b64_tr_b16 a[46:47], v7 offset:9056
v_mfma_f32_16x16x32_bf16 v[44:47], a[12:15], v[96:99], v[44:47]
s_waitcnt lgkmcnt(8)
v_mfma_f32_16x16x32_bf16 v[64:67], a[16:19], v[96:99], v[64:67]
buffer_load_dwordx4 v6, s[28:31], s54 offen offset:1056 lds
v_mfma_f32_16x16x32_bf16 v[80:83], a[16:19], v[100:103], v[80:83]
ds_read_b64_tr_b16 a[48:49], v10 offset:8448
s_add_u32 s54, s54, 0x10000
v_mfma_f32_16x16x32_bf16 v[84:87], a[20:23], v[100:103], v[84:87]
ds_read_b64_tr_b16 a[50:51], v10 offset:8960
ds_read_b64_tr_b16 a[52:53], v10 offset:8480
v_mfma_f32_16x16x32_bf16 v[68:71], a[20:23], v[96:99], v[68:71]
ds_read_b64_tr_b16 a[54:55], v10 offset:8992
v_mfma_f32_16x16x32_bf16 v[72:75], a[24:27], v[96:99], v[72:75]
buffer_load_dwordx4 v[148:151], v4, s[16:19], s52 offen offset:1024 sc1
v_mfma_f32_16x16x32_bf16 v[88:91], a[24:27], v[100:103], v[88:91]
ds_read_b64_tr_b16 a[56:57], v10 offset:8512
s_add_u32 s52, s52, 0x20000
v_mfma_f32_16x16x32_bf16 v[92:95], a[28:31], v[100:103], v[92:95]
ds_read_b64_tr_b16 a[58:59], v10 offset:9024
ds_read_b64_tr_b16 a[60:61], v10 offset:8544
v_mfma_f32_16x16x32_bf16 v[76:79], a[28:31], v[96:99], v[76:79]
ds_read_b64_tr_b16 a[62:63], v10 offset:9056
s_waitcnt vmcnt(20) lgkmcnt(8)
v_mfma_f32_16x16x32_bf16 v[32:35], a[32:35], v[104:107], v[32:35]
ds_read_b64_tr_b16 a[0:1], v7 offset:16896
s_add_u32 m0, s56, 59136
v_mfma_f32_16x16x32_bf16 v[48:51], a[32:35], v[108:111], v[48:51]
buffer_load_dwordx4 v5, s[28:31], s54 offen lds
v_mfma_f32_16x16x32_bf16 v[52:55], a[36:39], v[108:111], v[52:55]
ds_read_b64_tr_b16 a[2:3], v7 offset:17408
ds_read_b64_tr_b16 a[4:5], v7 offset:16928
v_mfma_f32_16x16x32_bf16 v[36:39], a[36:39], v[104:107], v[36:39]
ds_read_b64_tr_b16 a[6:7], v7 offset:17440
v_mfma_f32_16x16x32_bf16 v[40:43], a[40:43], v[104:107], v[40:43]
buffer_load_dwordx4 v[152:155], v4, s[16:19], s52 offen sc1
v_mfma_f32_16x16x32_bf16 v[56:59], a[40:43], v[108:111], v[56:59]
ds_read_b64_tr_b16 a[8:9], v7 offset:16960
ds_read_b64_tr_b16 a[10:11], v7 offset:17472
v_mfma_f32_16x16x32_bf16 v[60:63], a[44:47], v[108:111], v[60:63]
ds_read_b64_tr_b16 a[12:13], v7 offset:16992
ds_read_b64_tr_b16 a[14:15], v7 offset:17504
v_mfma_f32_16x16x32_bf16 v[44:47], a[44:47], v[104:107], v[44:47]
s_waitcnt lgkmcnt(8)
v_mfma_f32_16x16x32_bf16 v[64:67], a[48:51], v[104:107], v[64:67]
buffer_load_dwordx4 v6, s[28:31], s54 offen offset:1056 lds
v_mfma_f32_16x16x32_bf16 v[80:83], a[48:51], v[108:111], v[80:83]
ds_read_b64_tr_b16 a[16:17], v10 offset:16896
s_add_u32 s54, s54, 0x10000
v_mfma_f32_16x16x32_bf16 v[84:87], a[52:55], v[108:111], v[84:87]
ds_read_b64_tr_b16 a[18:19], v10 offset:17408
ds_read_b64_tr_b16 a[20:21], v10 offset:16928
v_mfma_f32_16x16x32_bf16 v[68:71], a[52:55], v[104:107], v[68:71]
ds_read_b64_tr_b16 a[22:23], v10 offset:17440
v_mfma_f32_16x16x32_bf16 v[72:75], a[56:59], v[104:107], v[72:75]
buffer_load_dwordx4 v[156:159], v4, s[16:19], s52 offen offset:1024 sc1
v_mfma_f32_16x16x32_bf16 v[88:91], a[56:59], v[108:111], v[88:91]
ds_read_b64_tr_b16 a[24:25], v10 offset:16960
s_add_u32 s52, s52, 0x20000
v_mfma_f32_16x16x32_bf16 v[92:95], a[60:63], v[108:111], v[92:95]
ds_read_b64_tr_b16 a[26:27], v10 offset:17472
ds_read_b64_tr_b16 a[28:29], v10 offset:16992
v_mfma_f32_16x16x32_bf16 v[76:79], a[60:63], v[104:107], v[76:79]
ds_read_b64_tr_b16 a[30:31], v10 offset:17504
s_waitcnt vmcnt(20) lgkmcnt(8)
s_barrier
v_mfma_f32_16x16x32_bf16 v[32:35], a[0:3], v[112:115], v[32:35]
ds_read_b64_tr_b16 a[32:33], v7 offset:25344
s_add_u32 m0, s55, 0
v_mfma_f32_16x16x32_bf16 v[48:51], a[0:3], v[116:119], v[48:51]
buffer_load_dwordx4 v5, s[28:31], s54 offen lds
v_mfma_f32_16x16x32_bf16 v[52:55], a[4:7], v[116:119], v[52:55]
ds_read_b64_tr_b16 a[34:35], v7 offset:25856
ds_read_b64_tr_b16 a[36:37], v7 offset:25376
v_mfma_f32_16x16x32_bf16 v[36:39], a[4:7], v[112:115], v[36:39]
ds_read_b64_tr_b16 a[38:39], v7 offset:25888
v_mfma_f32_16x16x32_bf16 v[40:43], a[8:11], v[112:115], v[40:43]
buffer_load_dwordx4 v[96:99], v4, s[16:19], s52 offen sc1
v_mfma_f32_16x16x32_bf16 v[56:59], a[8:11], v[116:119], v[56:59]
ds_read_b64_tr_b16 a[40:41], v7 offset:25408
ds_read_b64_tr_b16 a[42:43], v7 offset:25920
v_mfma_f32_16x16x32_bf16 v[60:63], a[12:15], v[116:119], v[60:63]
ds_read_b64_tr_b16 a[44:45], v7 offset:25440
ds_read_b64_tr_b16 a[46:47], v7 offset:25952
v_mfma_f32_16x16x32_bf16 v[44:47], a[12:15], v[112:115], v[44:47]
s_waitcnt lgkmcnt(8)
v_mfma_f32_16x16x32_bf16 v[64:67], a[16:19], v[112:115], v[64:67]
buffer_load_dwordx4 v6, s[28:31], s54 offen offset:1056 lds
v_mfma_f32_16x16x32_bf16 v[80:83], a[16:19], v[116:119], v[80:83]
ds_read_b64_tr_b16 a[48:49], v10 offset:25344
s_add_u32 s54, s54, 0x10000
v_mfma_f32_16x16x32_bf16 v[84:87], a[20:23], v[116:119], v[84:87]
ds_read_b64_tr_b16 a[50:51], v10 offset:25856
ds_read_b64_tr_b16 a[52:53], v10 offset:25376
v_mfma_f32_16x16x32_bf16 v[68:71], a[20:23], v[112:115], v[68:71]
ds_read_b64_tr_b16 a[54:55], v10 offset:25888
v_mfma_f32_16x16x32_bf16 v[72:75], a[24:27], v[112:115], v[72:75]
buffer_load_dwordx4 v[100:103], v4, s[16:19], s52 offen offset:1024 sc1
v_mfma_f32_16x16x32_bf16 v[88:91], a[24:27], v[116:119], v[88:91]
ds_read_b64_tr_b16 a[56:57], v10 offset:25408
s_add_u32 s52, s52, 0x20000
v_mfma_f32_16x16x32_bf16 v[92:95], a[28:31], v[116:119], v[92:95]
ds_read_b64_tr_b16 a[58:59], v10 offset:25920
ds_read_b64_tr_b16 a[60:61], v10 offset:25440
v_mfma_f32_16x16x32_bf16 v[76:79], a[28:31], v[112:115], v[76:79]
ds_read_b64_tr_b16 a[62:63], v10 offset:25952
s_waitcnt vmcnt(20) lgkmcnt(8)
v_mfma_f32_16x16x32_bf16 v[32:35], a[32:35], v[120:123], v[32:35]
ds_read_b64_tr_b16 a[0:1], v7 offset:33792
s_add_u32 m0, s55, 8448
v_mfma_f32_16x16x32_bf16 v[48:51], a[32:35], v[124:127], v[48:51]
buffer_load_dwordx4 v5, s[28:31], s54 offen lds
v_mfma_f32_16x16x32_bf16 v[52:55], a[36:39], v[124:127], v[52:55]
ds_read_b64_tr_b16 a[2:3], v7 offset:34304
ds_read_b64_tr_b16 a[4:5], v7 offset:33824
v_mfma_f32_16x16x32_bf16 v[36:39], a[36:39], v[120:123], v[36:39]
ds_read_b64_tr_b16 a[6:7], v7 offset:34336
v_mfma_f32_16x16x32_bf16 v[40:43], a[40:43], v[120:123], v[40:43]
buffer_load_dwordx4 v[104:107], v4, s[16:19], s52 offen sc1
v_mfma_f32_16x16x32_bf16 v[56:59], a[40:43], v[124:127], v[56:59]
ds_read_b64_tr_b16 a[8:9], v7 offset:33856
ds_read_b64_tr_b16 a[10:11], v7 offset:34368
v_mfma_f32_16x16x32_bf16 v[60:63], a[44:47], v[124:127], v[60:63]
ds_read_b64_tr_b16 a[12:13], v7 offset:33888
ds_read_b64_tr_b16 a[14:15], v7 offset:34400
v_mfma_f32_16x16x32_bf16 v[44:47], a[44:47], v[120:123], v[44:47]
s_waitcnt lgkmcnt(8)
v_mfma_f32_16x16x32_bf16 v[64:67], a[48:51], v[120:123], v[64:67]
buffer_load_dwordx4 v6, s[28:31], s54 offen offset:1056 lds
v_mfma_f32_16x16x32_bf16 v[80:83], a[48:51], v[124:127], v[80:83]
ds_read_b64_tr_b16 a[16:17], v10 offset:33792
s_add_u32 s54, s54, 0x10000
v_mfma_f32_16x16x32_bf16 v[84:87], a[52:55], v[124:127], v[84:87]
ds_read_b64_tr_b16 a[18:19], v10 offset:34304
ds_read_b64_tr_b16 a[20:21], v10 offset:33824
v_mfma_f32_16x16x32_bf16 v[68:71], a[52:55], v[120:123], v[68:71]
ds_read_b64_tr_b16 a[22:23], v10 offset:34336
v_mfma_f32_16x16x32_bf16 v[72:75], a[56:59], v[120:123], v[72:75]
buffer_load_dwordx4 v[108:111], v4, s[16:19], s52 offen offset:1024 sc1
.Lpad8:
s_cbranch_execz .Lnopoll51r
v_mfma_f32_16x16x32_bf16 v[88:91], a[56:59], v[124:127], v[88:91]
ds_read_b64_tr_b16 a[24:25], v10 offset:33856
s_add_u32 s52, s52, 0x20000
v_mfma_f32_16x16x32_bf16 v[92:95], a[60:63], v[124:127], v[92:95]
ds_read_b64_tr_b16 a[26:27], v10 offset:34368
ds_read_b64_tr_b16 a[28:29], v10 offset:33888
v_mfma_f32_16x16x32_bf16 v[76:79], a[60:63], v[120:123], v[76:79]
ds_read_b64_tr_b16 a[30:31], v10 offset:34400
s_waitcnt vmcnt(20) lgkmcnt(8)
s_barrier
v_mfma_f32_16x16x32_bf16 v[32:35], a[0:3], v[128:131], v[32:35]
ds_read_b64_tr_b16 a[32:33], v7 offset:42240
s_add_u32 m0, s55, 16896
v_mfma_f32_16x16x32_bf16 v[48:51], a[0:3], v[132:135], v[48:51]
buffer_load_dwordx4 v5, s[28:31], s54 offen lds
v_mfma_f32_16x16x32_bf16 v[52:55], a[4:7], v[132:135], v[52:55]
ds_read_b64_tr_b16 a[34:35], v7 offset:42752
ds_read_b64_tr_b16 a[36:37], v7 offset:42272
v_mfma_f32_16x16x32_bf16 v[36:39], a[4:7], v[128:131], v[36:39]
ds_read_b64_tr_b16 a[38:39], v7 offset:42784
v_mfma_f32_16x16x32_bf16 v[40:43], a[8:11], v[128:131], v[40:43]
buffer_load_dwordx4 v[112:115], v4, s[16:19], s52 offen sc1
v_mfma_f32_16x16x32_bf16 v[56:59], a[8:11], v[132:135], v[56:59]
ds_read_b64_tr_b16 a[40:41], v7 offset:42304
ds_read_b64_tr_b16 a[42:43], v7 offset:42816
v_mfma_f32_16x16x32_bf16 v[60:63], a[12:15], v[132:135], v[60:63]
ds_read_b64_tr_b16 a[44:45], v7 offset:42336
ds_read_b64_tr_b16 a[46:47], v7 offset:42848
v_mfma_f32_16x16x32_bf16 v[44:47], a[12:15], v[128:131], v[44:47]
s_waitcnt lgkmcnt(8)
v_mfma_f32_16x16x32_bf16 v[64:67], a[16:19], v[128:131], v[64:67]
buffer_load_dwordx4 v6, s[28:31], s54 offen offset:1056 lds
v_mfma_f32_16x16x32_bf16 v[80:83], a[16:19], v[132:135], v[80:83]
ds_read_b64_tr_b16 a[48:49], v10 offset:42240
s_add_u32 s54, s54, 0x10000
v_mfma_f32_16x16x32_bf16 v[84:87], a[20:23], v[132:135], v[84:87]
ds_read_b64_tr_b16 a[50:51], v10 offset:42752
ds_read_b64_tr_b16 a[52:53], v10 offset:42272
v_mfma_f32_16x16x32_bf16 v[68:71], a[20:23], v[128:131], v[68:71]
ds_read_b64_tr_b16 a[54:55], v10 offset:42784
v_mfma_f32_16x16x32_bf16 v[72:75], a[24:27], v[128:131], v[72:75]
buffer_load_dwordx4 v[116:119], v4, s[16:19], s52 offen offset:1024 sc1
v_mfma_f32_16x16x32_bf16 v[88:91], a[24:27], v[132:135], v[88:91]
ds_read_b64_tr_b16 a[56:57], v10 offset:42304
s_add_u32 s52, s52, 0x20000
v_mfma_f32_16x16x32_bf16 v[92:95], a[28:31], v[132:135], v[92:95]
ds_read_b64_tr_b16 a[58:59], v10 offset:42816
ds_read_b64_tr_b16 a[60:61], v10 offset:42336
v_mfma_f32_16x16x32_bf16 v[76:79], a[28:31], v[128:131], v[76:79]
ds_read_b64_tr_b16 a[62:63], v10 offset:42848
s_waitcnt vmcnt(20) lgkmcnt(8)
v_mfma_f32_16x16x32_bf16 v[32:35], a[32:35], v[136:139], v[32:35]
ds_read_b64_tr_b16 a[0:1], v7 offset:50688
s_add_u32 m0, s55, 25344
v_mfma_f32_16x16x32_bf16 v[48:51], a[32:35], v[140:143], v[48:51]
buffer_load_dwordx4 v5, s[28:31], s54 offen lds
v_mfma_f32_16x16x32_bf16 v[52:55], a[36:39], v[140:143], v[52:55]
ds_read_b64_tr_b16 a[2:3], v7 offset:51200
ds_read_b64_tr_b16 a[4:5], v7 offset:50720
v_mfma_f32_16x16x32_bf16 v[36:39], a[36:39], v[136:139], v[36:39]
ds_read_b64_tr_b16 a[6:7], v7 offset:51232
v_mfma_f32_16x16x32_bf16 v[40:43], a[40:43], v[136:139], v[40:43]
buffer_load_dwordx4 v[120:123], v4, s[16:19], s52 offen sc1
v_mfma_f32_16x16x32_bf16 v[56:59], a[40:43], v[140:143], v[56:59]
ds_read_b64_tr_b16 a[8:9], v7 offset:50752
ds_read_b64_tr_b16 a[10:11], v7 offset:51264
v_mfma_f32_16x16x32_bf16 v[60:63], a[44:47], v[140:143], v[60:63]
ds_read_b64_tr_b16 a[12:13], v7 offset:50784
ds_read_b64_tr_b16 a[14:15], v7 offset:51296
v_mfma_f32_16x16x32_bf16 v[44:47], a[44:47], v[136:139], v[44:47]
s_waitcnt lgkmcnt(8)
v_mfma_f32_16x16x32_bf16 v[64:67], a[48:51], v[136:139], v[64:67]
buffer_load_dwordx4 v6, s[28:31], s54 offen offset:1056 lds
v_mfma_f32_16x16x32_bf16 v[80:83], a[48:51], v[140:143], v[80:83]
ds_read_b64_tr_b16 a[16:17], v10 offset:50688
s_add_u32 s54, s54, 0x10000
v_mfma_f32_16x16x32_bf16 v[84:87], a[52:55], v[140:143], v[84:87]
ds_read_b64_tr_b16 a[18:19], v10 offset:51200
ds_read_b64_tr_b16 a[20:21], v10 offset:50720
v_mfma_f32_16x16x32_bf16 v[68:71], a[52:55], v[136:139], v[68:71]
ds_read_b64_tr_b16 a[22:23], v10 offset:51232
v_mfma_f32_16x16x32_bf16 v[72:75], a[56:59], v[136:139], v[72:75]
buffer_load_dwordx4 v[124:127], v4, s[16:19], s52 offen offset:1024 sc1
v_mfma_f32_16x16x32_bf16 v[88:91], a[56:59], v[140:143], v[88:91]
ds_read_b64_tr_b16 a[24:25], v10 offset:50752
s_add_u32 s52, s52, 0x20000
v_mfma_f32_16x16x32_bf16 v[92:95], a[60:63], v[140:143], v[92:95]
ds_read_b64_tr_b16 a[26:27], v10 offset:51264
ds_read_b64_tr_b16 a[28:29], v10 offset:50784
v_mfma_f32_16x16x32_bf16 v[76:79], a[60:63], v[136:139], v[76:79]
ds_read_b64_tr_b16 a[30:31], v10 offset:51296
s_waitcnt vmcnt(20) lgkmcnt(8)
s_barrier
v_mfma_f32_16x16x32_bf16 v[32:35], a[0:3], v[144:147], v[32:35]
ds_read_b64_tr_b16 a[32:33], v7 offset:59136
s_add_u32 m0, s55, 33792
v_mfma_f32_16x16x32_bf16 v[48:51], a[0:3], v[148:151], v[48:51]
buffer_load_dwordx4 v5, s[28:31], s54 offen lds
v_mfma_f32_16x16x32_bf16 v[52:55], a[4:7], v[148:151], v[52:55]
ds_read_b64_tr_b16 a[34:35], v7 offset:59648
ds_read_b64_tr_b16 a[36:37], v7 offset:59168
v_mfma_f32_16x16x32_bf16 v[36:39], a[4:7], v[144:147], v[36:39]
ds_read_b64_tr_b16 a[38:39], v7 offset:59680
v_mfma_f32_16x16x32_bf16 v[40:43], a[8:11], v[144:147], v[40:43]
buffer_load_dwordx4 v[128:131], v4, s[16:19], s52 offen sc1
v_mfma_f32_16x16x32_bf16 v[56:59], a[8:11], v[148:151], v[56:59]
ds_read_b64_tr_b16 a[40:41], v7 offset:59200
ds_read_b64_tr_b16 a[42:43], v7 offset:59712
v_mfma_f32_16x16x32_bf16 v[60:63], a[12:15], v[148:151], v[60:63]
ds_read_b64_tr_b16 a[44:45], v7 offset:59232
ds_read_b64_tr_b16 a[46:47], v7 offset:59744
v_mfma_f32_16x16x32_bf16 v[44:47], a[12:15], v[144:147], v[44:47]
s_waitcnt lgkmcnt(8)
v_mfma_f32_16x16x32_bf16 v[64:67], a[16:19], v[144:147], v[64:67]
buffer_load_dwordx4 v6, s[28:31], s54 offen offset:1056 lds
v_mfma_f32_16x16x32_bf16 v[80:83], a[16:19], v[148:151], v[80:83]
ds_read_b64_tr_b16 a[48:49], v10 offset:59136
s_add_u32 s54, s54, 0x10000
v_mfma_f32_16x16x32_bf16 v[84:87], a[20:23], v[148:151], v[84:87]
ds_read_b64_tr_b16 a[50:51], v10 offset:59648
ds_read_b64_tr_b16 a[52:53], v10 offset:59168
v_mfma_f32_16x16x32_bf16 v[68:71], a[20:23], v[144:147], v[68:71]
ds_read_b64_tr_b16 a[54:55], v10 offset:59680
v_mfma_f32_16x16x32_bf16 v[72:75], a[24:27], v[144:147], v[72:75]
buffer_load_dwordx4 v[132:135], v4, s[16:19], s52 offen offset:1024 sc1
v_mfma_f32_16x16x32_bf16 v[88:91], a[24:27], v[148:151], v[88:91]
ds_read_b64_tr_b16 a[56:57], v10 offset:59200
s_add_u32 s52, s52, 0x20000
v_mfma_f32_16x16x32_bf16 v[92:95], a[28:31], v[148:151], v[92:95]
ds_read_b64_tr_b16 a[58:59], v10 offset:59712
ds_read_b64_tr_b16 a[60:61], v10 offset:59232
v_mfma_f32_16x16x32_bf16 v[76:79], a[28:31], v[144:147], v[76:79]
ds_read_b64_tr_b16 a[62:63], v10 offset:59744
v_add_u32 v7, s57, v7
v_add_u32 v10, s57, v10
s_sub_u32 s57, 0, s57
s_waitcnt vmcnt(20) lgkmcnt(8)
v_mfma_f32_16x16x32_bf16 v[32:35], a[32:35], v[152:155], v[32:35]
ds_read_b64_tr_b16 a[0:1], v10
s_add_u32 m0, s55, 42240
v_mfma_f32_16x16x32_bf16 v[48:51], a[32:35], v[156:159], v[48:51]
buffer_load_dwordx4 v5, s[28:31], s54 offen lds
v_mfma_f32_16x16x32_bf16 v[52:55], a[36:39], v[156:159], v[52:55]
ds_read_b64_tr_b16 a[2:3], v10 offset:512
ds_read_b64_tr_b16 a[4:5], v10 offset:32
v_mfma_f32_16x16x32_bf16 v[36:39], a[36:39], v[152:155], v[36:39]
ds_read_b64_tr_b16 a[6:7], v10 offset:544
v_mfma_f32_16x16x32_bf16 v[40:43], a[40:43], v[152:155], v[40:43]
buffer_load_dwordx4 v[136:139], v4, s[16:19], s52 offen sc1
v_mfma_f32_16x16x32_bf16 v[56:59], a[40:43], v[156:159], v[56:59]
ds_read_b64_tr_b16 a[8:9], v10 offset:64
ds_read_b64_tr_b16 a[10:11], v10 offset:576
v_mfma_f32_16x16x32_bf16 v[60:63], a[44:47], v[156:159], v[60:63]
ds_read_b64_tr_b16 a[12:13], v10 offset:96
ds_read_b64_tr_b16 a[14:15], v10 offset:608
v_mfma_f32_16x16x32_bf16 v[44:47], a[44:47], v[152:155], v[44:47]
s_waitcnt lgkmcnt(8)
v_mfma_f32_16x16x32_bf16 v[64:67], a[48:51], v[152:155], v[64:67]
buffer_load_dwordx4 v6, s[28:31], s54 offen offset:1056 lds
v_mfma_f32_16x16x32_bf16 v[80:83], a[48:51], v[156:159], v[80:83]
ds_read_b64_tr_b16 a[16:17], v10 offset:8448
s_add_u32 s54, s54, 0x10000
v_mfma_f32_16x16x32_bf16 v[84:87], a[52:55], v[156:159], v[84:87]
ds_read_b64_tr_b16 a[18:19], v10 offset:8960
ds_read_b64_tr_b16 a[20:21], v10 offset:8480
v_mfma_f32_16x16x32_bf16 v[68:71], a[52:55], v[152:155], v[68:71]
ds_read_b64_tr_b16 a[22:23], v10 offset:8992
v_mfma_f32_16x16x32_bf16 v[72:75], a[56:59], v[152:155], v[72:75]
buffer_load_dwordx4 v[140:143], v4, s[16:19], s52 offen offset:1024 sc1
v_mfma_f32_16x16x32_bf16 v[88:91], a[56:59], v[156:159], v[88:91]
ds_read_b64_tr_b16 a[24:25], v10 offset:8512
s_add_u32 s52, s52, 0x20000
v_mfma_f32_16x16x32_bf16 v[92:95], a[60:63], v[156:159], v[92:95]
ds_read_b64_tr_b16 a[26:27], v10 offset:9024
ds_read_b64_tr_b16 a[28:29], v10 offset:8544
v_mfma_f32_16x16x32_bf16 v[76:79], a[60:63], v[152:155], v[76:79]
ds_read_b64_tr_b16 a[30:31], v10 offset:9056
s_mov_b32 s62, s55
s_mov_b32 s55, s56
s_mov_b32 s56, s62
s_waitcnt vmcnt(20) lgkmcnt(8)
s_barrier
v_mfma_f32_16x16x32_bf16 v[64:67], a[0:3], v[96:99], v[64:67]
ds_read_b64_tr_b16 a[32:33], v10 offset:16896
ds_read_b64_tr_b16 a[34:35], v10 offset:17408
s_add_u32 m0, s56, 50688
v_mfma_f32_16x16x32_bf16 v[80:83], a[0:3], v[100:103], v[80:83]
ds_read_b64_tr_b16 a[36:37], v10 offset:16928
buffer_load_dwordx4 v5, s[28:31], s54 offen lds
v_mfma_f32_16x16x32_bf16 v[84:87], a[4:7], v[100:103], v[84:87]
buffer_load_dwordx4 v6, s[28:31], s54 offen offset:1056 lds
v_mfma_f32_16x16x32_bf16 v[68:71], a[4:7], v[96:99], v[68:71]
ds_read_b64_tr_b16 a[38:39], v10 offset:17440
ds_read_b64_tr_b16 a[40:41], v10 offset:16960
s_add_u32 s54, s54, 0x10000
v_mfma_f32_16x16x32_bf16 v[72:75], a[8:11], v[96:99], v[72:75]
buffer_load_dwordx4 v[144:147], v4, s[16:19], s52 offen sc1
v_mfma_f32_16x16x32_bf16 v[88:91], a[8:11], v[100:103], v[88:91]
ds_read_b64_tr_b16 a[42:43], v10 offset:17472
ds_read_b64_tr_b16 a[44:45], v10 offset:16992
v_mfma_f32_16x16x32_bf16 v[92:95], a[12:15], v[100:103], v[92:95]
buffer_load_dwordx4 v[148:151], v4, s[16:19], s52 offen offset:1024 sc1
v_mfma_f32_16x16x32_bf16 v[76:79], a[12:15], v[96:99], v[76:79]
ds_read_b64_tr_b16 a[46:47], v10 offset:17504
s_add_u32 s52, s52, 0x20000
s_add_u32 m0, s56, 59136
s_waitcnt vmcnt(20) lgkmcnt(8)
v_mfma_f32_16x16x32_bf16 v[64:67], a[16:19], v[104:107], v[64:67]
ds_read_b64_tr_b16 a[48:49], v10 offset:25344
buffer_load_dwordx4 v5, s[28:31], s54 offen lds
v_mfma_f32_16x16x32_bf16 v[80:83], a[16:19], v[108:111], v[80:83]
ds_read_b64_tr_b16 a[50:51], v10 offset:25856
v_mfma_f32_16x16x32_bf16 v[84:87], a[20:23], v[108:111], v[84:87]
ds_read_b64_tr_b16 a[52:53], v10 offset:25376
buffer_load_dwordx4 v6, s[28:31], s54 offen offset:1056 lds
v_mfma_f32_16x16x32_bf16 v[68:71], a[20:23], v[104:107], v[68:71]
ds_read_b64_tr_b16 a[54:55], v10 offset:25888
s_add_u32 s54, s54, 0x10000
v_mfma_f32_16x16x32_bf16 v[72:75], a[24:27], v[104:107], v[72:75]
ds_read_b64_tr_b16 a[56:57], v10 offset:25408
buffer_load_dwordx4 v[152:155], v4, s[16:19], s52 offen sc1
v_mfma_f32_16x16x32_bf16 v[88:91], a[24:27], v[108:111], v[88:91]
ds_read_b64_tr_b16 a[58:59], v10 offset:25920
v_mfma_f32_16x16x32_bf16 v[92:95], a[28:31], v[108:111], v[92:95]
ds_read_b64_tr_b16 a[60:61], v10 offset:25440
buffer_load_dwordx4 v[156:159], v4, s[16:19], s52 offen offset:1024 sc1
v_mfma_f32_16x16x32_bf16 v[76:79], a[28:31], v[104:107], v[76:79]
ds_read_b64_tr_b16 a[62:63], v10 offset:25952
s_add_u32 s52, s52, 0x20000
s_waitcnt vmcnt(20) lgkmcnt(8)
v_mfma_f32_16x16x32_bf16 v[64:67], a[32:35], v[112:115], v[64:67]
ds_read_b64_tr_b16 a[0:1], v10 offset:33792
ds_read_b64_tr_b16 a[2:3], v10 offset:34304
v_mfma_f32_16x16x32_bf16 v[80:83], a[32:35], v[116:119], v[80:83]
buffer_load_dwordx4 v[160:163], v4, s[16:19], s52 offen sc1
v_mfma_f32_16x16x32_bf16 v[84:87], a[36:39], v[116:119], v[84:87]
ds_read_b64_tr_b16 a[4:5], v10 offset:33824
ds_read_b64_tr_b16 a[6:7], v10 offset:34336
v_mfma_f32_16x16x32_bf16 v[68:71], a[36:39], v[112:115], v[68:71]
ds_read_b64_tr_b16 a[8:9], v10 offset:33856
v_mfma_f32_16x16x32_bf16 v[72:75], a[40:43], v[112:115], v[72:75]
buffer_load_dwordx4 v[164:167], v4, s[16:19], s52 offen offset:1024 sc1
v_mfma_f32_16x16x32_bf16 v[88:91], a[40:43], v[116:119], v[88:91]
ds_read_b64_tr_b16 a[10:11], v10 offset:34368
s_add_u32 s52, s52, 0x20000
v_mfma_f32_16x16x32_bf16 v[92:95], a[44:47], v[116:119], v[92:95]
ds_read_b64_tr_b16 a[12:13], v10 offset:33888
v_mfma_f32_16x16x32_bf16 v[76:79], a[44:47], v[112:115], v[76:79]
ds_read_b64_tr_b16 a[14:15], v10 offset:34400
s_waitcnt vmcnt(18) lgkmcnt(8)
v_mfma_f32_16x16x32_bf16 v[64:67], a[48:51], v[120:123], v[64:67]
buffer_load_dwordx4 v[168:171], v4, s[16:19], s52 offen sc1
v_mfma_f32_16x16x32_bf16 v[80:83], a[48:51], v[124:127], v[80:83]
ds_read_b64_tr_b16 a[16:17], v10 offset:42240
ds_read_b64_tr_b16 a[18:19], v10 offset:42752
v_mfma_f32_16x16x32_bf16 v[84:87], a[52:55], v[124:127], v[84:87]
ds_read_b64_tr_b16 a[20:21], v10 offset:42272
v_mfma_f32_16x16x32_bf16 v[68:71], a[52:55], v[120:123], v[68:71]
ds_read_b64_tr_b16 a[22:23], v10 offset:42784
ds_read_b64_tr_b16 a[24:25], v10 offset:42304
v_mfma_f32_16x16x32_bf16 v[72:75], a[56:59], v[120:123], v[72:75]
buffer_load_dwordx4 v[172:175], v4, s[16:19], s52 offen offset:1024 sc1
v_mfma_f32_16x16x32_bf16 v[88:91], a[56:59], v[124:127], v[88:91]
s_add_u32 s52, s52, 0x20000
v_mfma_f32_16x16x32_bf16 v[92:95], a[60:63], v[124:127], v[92:95]
ds_read_b64_tr_b16 a[26:27], v10 offset:42816
ds_read_b64_tr_b16 a[28:29], v10 offset:42336
v_mfma_f32_16x16x32_bf16 v[76:79], a[60:63], v[120:123], v[76:79]
ds_read_b64_tr_b16 a[30:31], v10 offset:42848
s_waitcnt vmcnt(16) lgkmcnt(8)
v_mfma_f32_16x16x32_bf16 v[64:67], a[0:3], v[128:131], v[64:67]
ds_read_b64_tr_b16 a[32:33], v10 offset:50688
ds_read_b64_tr_b16 a[34:35], v10 offset:51200
v_mfma_f32_16x16x32_bf16 v[80:83], a[0:3], v[132:135], v[80:83]
buffer_load_dwordx4 v[176:179], v4, s[16:19], s52 offen sc1
v_mfma_f32_16x16x32_bf16 v[84:87], a[4:7], v[132:135], v[84:87]
ds_read_b64_tr_b16 a[36:37], v10 offset:50720
ds_read_b64_tr_b16 a[38:39], v10 offset:51232
v_mfma_f32_16x16x32_bf16 v[68:71], a[4:7], v[128:131], v[68:71]
ds_read_b64_tr_b16 a[40:41], v10 offset:50752
v_mfma_f32_16x16x32_bf16 v[72:75], a[8:11], v[128:131], v[72:75]
buffer_load_dwordx4 v[180:183], v4, s[16:19], s52 offen offset:1024 sc1
v_mfma_f32_16x16x32_bf16 v[88:91], a[8:11], v[132:135], v[88:91]
ds_read_b64_tr_b16 a[42:43], v10 offset:51264
s_add_u32 s52, s52, 0x20000
v_mfma_f32_16x16x32_bf16 v[92:95], a[12:15], v[132:135], v[92:95]
ds_read_b64_tr_b16 a[44:45], v10 offset:50784
v_mfma_f32_16x16x32_bf16 v[76:79], a[12:15], v[128:131], v[76:79]
ds_read_b64_tr_b16 a[46:47], v10 offset:51296
s_waitcnt vmcnt(14) lgkmcnt(8)
v_mfma_f32_16x16x32_bf16 v[64:67], a[16:19], v[136:139], v[64:67]
buffer_load_dwordx4 v[184:187], v4, s[16:19], s52 offen sc1
v_mfma_f32_16x16x32_bf16 v[80:83], a[16:19], v[140:143], v[80:83]
ds_read_b64_tr_b16 a[48:49], v10 offset:59136
ds_read_b64_tr_b16 a[50:51], v10 offset:59648
v_mfma_f32_16x16x32_bf16 v[84:87], a[20:23], v[140:143], v[84:87]
ds_read_b64_tr_b16 a[52:53], v10 offset:59168
v_mfma_f32_16x16x32_bf16 v[68:71], a[20:23], v[136:139], v[68:71]
ds_read_b64_tr_b16 a[54:55], v10 offset:59680
ds_read_b64_tr_b16 a[56:57], v10 offset:59200
v_mfma_f32_16x16x32_bf16 v[72:75], a[24:27], v[136:139], v[72:75]
buffer_load_dwordx4 v[188:191], v4, s[16:19], s52 offen offset:1024 sc1
v_mfma_f32_16x16x32_bf16 v[88:91], a[24:27], v[140:143], v[88:91]
s_add_u32 s52, s52, 0x20000
v_mfma_f32_16x16x32_bf16 v[92:95], a[28:31], v[140:143], v[92:95]
ds_read_b64_tr_b16 a[58:59], v10 offset:59712
ds_read_b64_tr_b16 a[60:61], v10 offset:59232
v_mfma_f32_16x16x32_bf16 v[76:79], a[28:31], v[136:139], v[76:79]
ds_read_b64_tr_b16 a[62:63], v10 offset:59744
s_waitcnt vmcnt(10) lgkmcnt(8)
s_barrier
v_add_u32 v10, s57, v10
v_mfma_f32_16x16x32_bf16 v[64:67], a[32:35], v[144:147], v[64:67]
ds_read_b64_tr_b16 a[0:1], v10
ds_read_b64_tr_b16 a[2:3], v10 offset:512
v_mfma_f32_16x16x32_bf16 v[80:83], a[32:35], v[148:151], v[80:83]
buffer_load_dwordx4 v[192:195], v4, s[16:19], s52 offen sc1
v_mfma_f32_16x16x32_bf16 v[84:87], a[36:39], v[148:151], v[84:87]
ds_read_b64_tr_b16 a[4:5], v10 offset:32
ds_read_b64_tr_b16 a[6:7], v10 offset:544
v_mfma_f32_16x16x32_bf16 v[68:71], a[36:39], v[144:147], v[68:71]
ds_read_b64_tr_b16 a[8:9], v10 offset:64
v_mfma_f32_16x16x32_bf16 v[72:75], a[40:43], v[144:147], v[72:75]
buffer_load_dwordx4 v[196:199], v4, s[16:19], s52 offen offset:1024 sc1
v_mfma_f32_16x16x32_bf16 v[88:91], a[40:43], v[148:151], v[88:91]
ds_read_b64_tr_b16 a[10:11], v10 offset:576
s_add_u32 s52, s52, 0x20000
v_mfma_f32_16x16x32_bf16 v[92:95], a[44:47], v[148:151], v[92:95]
ds_read_b64_tr_b16 a[12:13], v10 offset:96
v_mfma_f32_16x16x32_bf16 v[76:79], a[44:47], v[144:147], v[76:79]
ds_read_b64_tr_b16 a[14:15], v10 offset:608
s_waitcnt vmcnt(10) lgkmcnt(8)
v_mfma_f32_16x16x32_bf16 v[64:67], a[48:51], v[152:155], v[64:67]
buffer_load_dwordx4 v[200:203], v4, s[16:19], s52 offen sc1
v_mfma_f32_16x16x32_bf16 v[80:83], a[48:51], v[156:159], v[80:83]
ds_read_b64_tr_b16 a[16:17], v10 offset:8448
ds_read_b64_tr_b16 a[18:19], v10 offset:8960
v_mfma_f32_16x16x32_bf16 v[84:87], a[52:55], v[156:159], v[84:87]
ds_read_b64_tr_b16 a[20:21], v10 offset:8480
v_mfma_f32_16x16x32_bf16 v[68:71], a[52:55], v[152:155], v[68:71]
ds_read_b64_tr_b16 a[22:23], v10 offset:8992
ds_read_b64_tr_b16 a[24:25], v10 offset:8512
v_mfma_f32_16x16x32_bf16 v[72:75], a[56:59], v[152:155], v[72:75]
buffer_load_dwordx4 v[204:207], v4, s[16:19], s52 offen offset:1024 sc1
v_mfma_f32_16x16x32_bf16 v[88:91], a[56:59], v[156:159], v[88:91]
s_add_u32 s52, s52, 0x20000
v_mfma_f32_16x16x32_bf16 v[92:95], a[60:63], v[156:159], v[92:95]
ds_read_b64_tr_b16 a[26:27], v10 offset:9024
ds_read_b64_tr_b16 a[28:29], v10 offset:8544
v_mfma_f32_16x16x32_bf16 v[76:79], a[60:63], v[152:155], v[76:79]
ds_read_b64_tr_b16 a[30:31], v10 offset:9056
s_waitcnt vmcnt(10) lgkmcnt(8)
v_mfma_f32_16x16x32_bf16 v[64:67], a[0:3], v[160:163], v[64:67]
ds_read_b64_tr_b16 a[32:33], v10 offset:16896
ds_read_b64_tr_b16 a[34:35], v10 offset:17408
v_mfma_f32_16x16x32_bf16 v[80:83], a[0:3], v[164:167], v[80:83]
buffer_load_dwordx4 v[208:211], v4, s[16:19], s52 offen sc1
v_mfma_f32_16x16x32_bf16 v[84:87], a[4:7], v[164:167], v[84:87]
ds_read_b64_tr_b16 a[36:37], v10 offset:16928
ds_read_b64_tr_b16 a[38:39], v10 offset:17440
v_mfma_f32_16x16x32_bf16 v[68:71], a[4:7], v[160:163], v[68:71]
ds_read_b64_tr_b16 a[40:41], v10 offset:16960
v_mfma_f32_16x16x32_bf16 v[72:75], a[8:11], v[160:163], v[72:75]
buffer_load_dwordx4 v[212:215], v4, s[16:19], s52 offen offset:1024 sc1
v_mfma_f32_16x16x32_bf16 v[88:91], a[8:11], v[164:167], v[88:91]
ds_read_b64_tr_b16 a[42:43], v10 offset:17472
s_add_u32 s52, s52, 0x20000
v_mfma_f32_16x16x32_bf16 v[92:95], a[12:15], v[164:167], v[92:95]
ds_read_b64_tr_b16 a[44:45], v10 offset:16992
v_mfma_f32_16x16x32_bf16 v[76:79], a[12:15], v[160:163], v[76:79]
ds_read_b64_tr_b16 a[46:47], v10 offset:17504
s_waitcnt vmcnt(10) lgkmcnt(8)
v_mfma_f32_16x16x32_bf16 v[64:67], a[16:19], v[168:171], v[64:67]
buffer_load_dwordx4 v[216:219], v4, s[16:19], s52 offen sc1
v_mfma_f32_16x16x32_bf16 v[80:83], a[16:19], v[172:175], v[80:83]
ds_read_b64_tr_b16 a[48:49], v10 offset:25344
ds_read_b64_tr_b16 a[50:51], v10 offset:25856
v_mfma_f32_16x16x32_bf16 v[84:87], a[20:23], v[172:175], v[84:87]
ds_read_b64_tr_b16 a[52:53], v10 offset:25376
v_mfma_f32_16x16x32_bf16 v[68:71], a[20:23], v[168:171], v[68:71]
ds_read_b64_tr_b16 a[54:55], v10 offset:25888
ds_read_b64_tr_b16 a[56:57], v10 offset:25408
v_mfma_f32_16x16x32_bf16 v[72:75], a[24:27], v[168:171], v[72:75]
buffer_load_dwordx4 v[220:223], v4, s[16:19], s52 offen offset:1024 sc1
v_mfma_f32_16x16x32_bf16 v[88:91], a[24:27], v[172:175], v[88:91]
s_add_u32 s52, s52, 0x20000
v_mfma_f32_16x16x32_bf16 v[92:95], a[28:31], v[172:175], v[92:95]
ds_read_b64_tr_b16 a[58:59], v10 offset:25920
ds_read_b64_tr_b16 a[60:61], v10 offset:25440
v_mfma_f32_16x16x32_bf16 v[76:79], a[28:31], v[168:171], v[76:79]
ds_read_b64_tr_b16 a[62:63], v10 offset:25952
s_waitcnt vmcnt(10) lgkmcnt(8)
v_mfma_f32_16x16x32_bf16 v[64:67], a[32:35], v[176:179], v[64:67]
ds_read_b64_tr_b16 a[0:1], v10 offset:33792
v_mfma_f32_16x16x32_bf16 v[80:83], a[32:35], v[180:183], v[80:83]
ds_read_b64_tr_b16 a[2:3], v10 offset:34304
v_mfma_f32_16x16x32_bf16 v[84:87], a[36:39], v[180:183], v[84:87]
ds_read_b64_tr_b16 a[4:5], v10 offset:33824
v_mfma_f32_16x16x32_bf16 v[68:71], a[36:39], v[176:179], v[68:71]
ds_read_b64_tr_b16 a[6:7], v10 offset:34336
v_mfma_f32_16x16x32_bf16 v[72:75], a[40:43], v[176:179], v[72:75]
ds_read_b64_tr_b16 a[8:9], v10 offset:33856
v_mfma_f32_16x16x32_bf16 v[88:91], a[40:43], v[180:183], v[88:91]
ds_read_b64_tr_b16 a[10:11], v10 offset:34368
v_mfma_f32_16x16x32_bf16 v[92:95], a[44:47], v[180:183], v[92:95]
ds_read_b64_tr_b16 a[12:13], v10 offset:33888
v_mfma_f32_16x16x32_bf16 v[76:79], a[44:47], v[176:179], v[76:79]
ds_read_b64_tr_b16 a[14:15], v10 offset:34400
s_waitcnt vmcnt(8) lgkmcnt(8)
v_mfma_f32_16x16x32_bf16 v[64:67], a[48:51], v[184:187], v[64:67]
ds_read_b64_tr_b16 a[16:17], v10 offset:42240
v_mfma_f32_16x16x32_bf16 v[80:83], a[48:51], v[188:191], v[80:83]
ds_read_b64_tr_b16 a[18:19], v10 offset:42752
v_mfma_f32_16x16x32_bf16 v[84:87], a[52:55], v[188:191], v[84:87]
ds_read_b64_tr_b16 a[20:21], v10 offset:42272
v_mfma_f32_16x16x32_bf16 v[68:71], a[52:55], v[184:187], v[68:71]
ds_read_b64_tr_b16 a[22:23], v10 offset:42784
v_mfma_f32_16x16x32_bf16 v[72:75], a[56:59], v[184:187], v[72:75]
ds_read_b64_tr_b16 a[24:25], v10 offset:42304
v_mfma_f32_16x16x32_bf16 v[88:91], a[56:59], v[188:191], v[88:91]
ds_read_b64_tr_b16 a[26:27], v10 offset:42816
v_mfma_f32_16x16x32_bf16 v[92:95], a[60:63], v[188:191], v[92:95]
ds_read_b64_tr_b16 a[28:29], v10 offset:42336
v_mfma_f32_16x16x32_bf16 v[76:79], a[60:63], v[184:187], v[76:79]
ds_read_b64_tr_b16 a[30:31], v10 offset:42848
s_waitcnt vmcnt(6) lgkmcnt(8)
v_mfma_f32_16x16x32_bf16 v[64:67], a[0:3], v[192:195], v[64:67]
ds_read_b64_tr_b16 a[32:33], v10 offset:50688
v_mfma_f32_16x16x32_bf16 v[80:83], a[0:3], v[196:199], v[80:83]
ds_read_b64_tr_b16 a[34:35], v10 offset:51200
v_mfma_f32_16x16x32_bf16 v[84:87], a[4:7], v[196:199], v[84:87]
ds_read_b64_tr_b16 a[36:37], v10 offset:50720
v_mfma_f32_16x16x32_bf16 v[68:71], a[4:7], v[192:195], v[68:71]
ds_read_b64_tr_b16 a[38:39], v10 offset:51232
v_mfma_f32_16x16x32_bf16 v[72:75], a[8:11], v[192:195], v[72:75]
ds_read_b64_tr_b16 a[40:41], v10 offset:50752
v_mfma_f32_16x16x32_bf16 v[88:91], a[8:11], v[196:199], v[88:91]
ds_read_b64_tr_b16 a[42:43], v10 offset:51264
v_mfma_f32_16x16x32_bf16 v[92:95], a[12:15], v[196:199], v[92:95]
ds_read_b64_tr_b16 a[44:45], v10 offset:50784
v_mfma_f32_16x16x32_bf16 v[76:79], a[12:15], v[192:195], v[76:79]
ds_read_b64_tr_b16 a[46:47], v10 offset:51296
s_waitcnt vmcnt(4) lgkmcnt(8)
v_mfma_f32_16x16x32_bf16 v[64:67], a[16:19], v[200:203], v[64:67]
ds_read_b64_tr_b16 a[48:49], v10 offset:59136
v_mfma_f32_16x16x32_bf16 v[80:83], a[16:19], v[204:207], v[80:83]
ds_read_b64_tr_b16 a[50:51], v10 offset:59648
v_mfma_f32_16x16x32_bf16 v[84:87], a[20:23], v[204:207], v[84:87]
ds_read_b64_tr_b16 a[52:53], v10 offset:59168
v_mfma_f32_16x16x32_bf16 v[68:71], a[20:23], v[200:203], v[68:71]
ds_read_b64_tr_b16 a[54:55], v10 offset:59680
v_mfma_f32_16x16x32_bf16 v[72:75], a[24:27], v[200:203], v[72:75]
ds_read_b64_tr_b16 a[56:57], v10 offset:59200
v_mfma_f32_16x16x32_bf16 v[88:91], a[24:27], v[204:207], v[88:91]
ds_read_b64_tr_b16 a[58:59], v10 offset:59712
v_mfma_f32_16x16x32_bf16 v[92:95], a[28:31], v[204:207], v[92:95]
ds_read_b64_tr_b16 a[60:61], v10 offset:59232
v_mfma_f32_16x16x32_bf16 v[76:79], a[28:31], v[200:203], v[76:79]
ds_read_b64_tr_b16 a[62:63], v10 offset:59744
s_waitcnt vmcnt(2) lgkmcnt(8)
v_mfma_f32_16x16x32_bf16 v[64:67], a[32:35], v[208:211], v[64:67]
ds_read_b64_tr_b16 a[0:1], v7
v_mfma_f32_16x16x32_bf16 v[80:83], a[32:35], v[212:215], v[80:83]
ds_read_b64_tr_b16 a[2:3], v7 offset:512
v_mfma_f32_16x16x32_bf16 v[84:87], a[36:39], v[212:215], v[84:87]
ds_read_b64_tr_b16 a[4:5], v7 offset:32
v_mfma_f32_16x16x32_bf16 v[68:71], a[36:39], v[208:211], v[68:71]
ds_read_b64_tr_b16 a[6:7], v7 offset:544
v_mfma_f32_16x16x32_bf16 v[72:75], a[40:43], v[208:211], v[72:75]
ds_read_b64_tr_b16 a[8:9], v7 offset:64
v_mfma_f32_16x16x32_bf16 v[88:91], a[40:43], v[212:215], v[88:91]
ds_read_b64_tr_b16 a[10:11], v7 offset:576
v_mfma_f32_16x16x32_bf16 v[92:95], a[44:47], v[212:215], v[92:95]
ds_read_b64_tr_b16 a[12:13], v7 offset:96
v_mfma_f32_16x16x32_bf16 v[76:79], a[44:47], v[208:211], v[76:79]
ds_read_b64_tr_b16 a[14:15], v7 offset:608
s_waitcnt vmcnt(0) lgkmcnt(8)
v_mfma_f32_16x16x32_bf16 v[64:67], a[48:51], v[216:219], v[64:67]
ds_read_b64_tr_b16 a[16:17], v7 offset:8448
v_mfma_f32_16x16x32_bf16 v[80:83], a[48:51], v[220:223], v[80:83]
ds_read_b64_tr_b16 a[18:19], v7 offset:8960
v_mfma_f32_16x16x32_bf16 v[84:87], a[52:55], v[220:223], v[84:87]
ds_read_b64_tr_b16 a[20:21], v7 offset:8480
v_mfma_f32_16x16x32_bf16 v[68:71], a[52:55], v[216:219], v[68:71]
ds_read_b64_tr_b16 a[22:23], v7 offset:8992
v_mfma_f32_16x16x32_bf16 v[72:75], a[56:59], v[216:219], v[72:75]
ds_read_b64_tr_b16 a[24:25], v7 offset:8512
v_mfma_f32_16x16x32_bf16 v[88:91], a[56:59], v[220:223], v[88:91]
ds_read_b64_tr_b16 a[26:27], v7 offset:9024
v_mfma_f32_16x16x32_bf16 v[92:95], a[60:63], v[220:223], v[92:95]
ds_read_b64_tr_b16 a[28:29], v7 offset:8544
v_mfma_f32_16x16x32_bf16 v[76:79], a[60:63], v[216:219], v[76:79]
ds_read_b64_tr_b16 a[30:31], v7 offset:9056
s_waitcnt lgkmcnt(8)
v_mfma_f32_16x16x32_bf16 v[32:35], a[0:3], v[96:99], v[32:35]
ds_read_b64_tr_b16 a[32:33], v7 offset:16896
v_cvt_pk_bf16_f32 v232, v64, v65
v_cvt_pk_bf16_f32 v233, v66, v67
v_mfma_f32_16x16x32_bf16 v[48:51], a[0:3], v[100:103], v[48:51]
ds_read_b64_tr_b16 a[34:35], v7 offset:17408
v_cvt_pk_bf16_f32 v234, v68, v69
v_mfma_f32_16x16x32_bf16 v[52:55], a[4:7], v[100:103], v[52:55]
ds_read_b64_tr_b16 a[36:37], v7 offset:16928
v_cvt_pk_bf16_f32 v235, v70, v71
buffer_store_dwordx4 v[232:235], v11, s[16:19], s69 offen sc1
v_mfma_f32_16x16x32_bf16 v[36:39], a[4:7], v[96:99], v[36:39]
ds_read_b64_tr_b16 a[38:39], v7 offset:17440
s_add_u32 s69, s69, 131072
v_mfma_f32_16x16x32_bf16 v[40:43], a[8:11], v[96:99], v[40:43]
ds_read_b64_tr_b16 a[40:41], v7 offset:16960
v_cvt_pk_bf16_f32 v236, v72, v73
v_cvt_pk_bf16_f32 v237, v74, v75
v_mfma_f32_16x16x32_bf16 v[56:59], a[8:11], v[100:103], v[56:59]
ds_read_b64_tr_b16 a[42:43], v7 offset:17472
v_cvt_pk_bf16_f32 v238, v76, v77
v_mfma_f32_16x16x32_bf16 v[60:63], a[12:15], v[100:103], v[60:63]
ds_read_b64_tr_b16 a[44:45], v7 offset:16992
v_cvt_pk_bf16_f32 v239, v78, v79
buffer_store_dwordx4 v[236:239], v11, s[16:19], s69 offen sc1
v_mfma_f32_16x16x32_bf16 v[44:47], a[12:15], v[96:99], v[44:47]
ds_read_b64_tr_b16 a[46:47], v7 offset:17504
s_add_u32 s69, s69, -130048
s_waitcnt lgkmcnt(8)
v_mfma_f32_16x16x32_bf16 v[32:35], a[16:19], v[104:107], v[32:35]
ds_read_b64_tr_b16 a[48:49], v7 offset:25344
v_cvt_pk_bf16_f32 v240, v80, v81
v_mfma_f32_16x16x32_bf16 v[48:51], a[16:19], v[108:111], v[48:51]
ds_read_b64_tr_b16 a[50:51], v7 offset:25856
v_cvt_pk_bf16_f32 v241, v82, v83
v_cvt_pk_bf16_f32 v242, v84, v85
.Lpad9:
s_cbranch_execz .Lnopoll51r
v_mfma_f32_16x16x32_bf16 v[52:55], a[20:23], v[108:111], v[52:55]
ds_read_b64_tr_b16 a[52:53], v7 offset:25376
v_cvt_pk_bf16_f32 v243, v86, v87
v_mfma_f32_16x16x32_bf16 v[36:39], a[20:23], v[104:107], v[36:39]
ds_read_b64_tr_b16 a[54:55], v7 offset:25888
buffer_store_dwordx4 v[240:243], v11, s[16:19], s69 offen sc1
s_add_u32 s69, s69, 131072
v_mfma_f32_16x16x32_bf16 v[40:43], a[24:27], v[104:107], v[40:43]
ds_read_b64_tr_b16 a[56:57], v7 offset:25408
v_cvt_pk_bf16_f32 v244, v88, v89
v_mfma_f32_16x16x32_bf16 v[56:59], a[24:27], v[108:111], v[56:59]
ds_read_b64_tr_b16 a[58:59], v7 offset:25920
v_cvt_pk_bf16_f32 v245, v90, v91
v_cvt_pk_bf16_f32 v246, v92, v93
v_mfma_f32_16x16x32_bf16 v[60:63], a[28:31], v[108:111], v[60:63]
ds_read_b64_tr_b16 a[60:61], v7 offset:25440
v_cvt_pk_bf16_f32 v247, v94, v95
v_mfma_f32_16x16x32_bf16 v[44:47], a[28:31], v[104:107], v[44:47]
ds_read_b64_tr_b16 a[62:63], v7 offset:25952
buffer_store_dwordx4 v[244:247], v11, s[16:19], s69 offen sc1
s_waitcnt lgkmcnt(8)
v_mfma_f32_16x16x32_bf16 v[32:35], a[32:35], v[112:115], v[32:35]
ds_read_b64_tr_b16 a[0:1], v7 offset:33792
v_mfma_f32_16x16x32_bf16 v[48:51], a[32:35], v[116:119], v[48:51]
ds_read_b64_tr_b16 a[2:3], v7 offset:34304
v_mfma_f32_16x16x32_bf16 v[52:55], a[36:39], v[116:119], v[52:55]
ds_read_b64_tr_b16 a[4:5], v7 offset:33824
v_mfma_f32_16x16x32_bf16 v[36:39], a[36:39], v[112:115], v[36:39]
ds_read_b64_tr_b16 a[6:7], v7 offset:34336
v_mfma_f32_16x16x32_bf16 v[40:43], a[40:43], v[112:115], v[40:43]
ds_read_b64_tr_b16 a[8:9], v7 offset:33856
v_mfma_f32_16x16x32_bf16 v[56:59], a[40:43], v[116:119], v[56:59]
ds_read_b64_tr_b16 a[10:11], v7 offset:34368
v_mfma_f32_16x16x32_bf16 v[60:63], a[44:47], v[116:119], v[60:63]
ds_read_b64_tr_b16 a[12:13], v7 offset:33888
v_mfma_f32_16x16x32_bf16 v[44:47], a[44:47], v[112:115], v[44:47]
ds_read_b64_tr_b16 a[14:15], v7 offset:34400
s_waitcnt lgkmcnt(8)
v_mfma_f32_16x16x32_bf16 v[32:35], a[48:51], v[120:123], v[32:35]
ds_read_b64_tr_b16 a[16:17], v7 offset:42240
v_mfma_f32_16x16x32_bf16 v[48:51], a[48:51], v[124:127], v[48:51]
ds_read_b64_tr_b16 a[18:19], v7 offset:42752
v_mfma_f32_16x16x32_bf16 v[52:55], a[52:55], v[124:127], v[52:55]
ds_read_b64_tr_b16 a[20:21], v7 offset:42272
v_mfma_f32_16x16x32_bf16 v[36:39], a[52:55], v[120:123], v[36:39]
ds_read_b64_tr_b16 a[22:23], v7 offset:42784
v_mfma_f32_16x16x32_bf16 v[40:43], a[56:59], v[120:123], v[40:43]
ds_read_b64_tr_b16 a[24:25], v7 offset:42304
v_mfma_f32_16x16x32_bf16 v[56:59], a[56:59], v[124:127], v[56:59]
ds_read_b64_tr_b16 a[26:27], v7 offset:42816
v_mfma_f32_16x16x32_bf16 v[60:63], a[60:63], v[124:127], v[60:63]
ds_read_b64_tr_b16 a[28:29], v7 offset:42336
v_mfma_f32_16x16x32_bf16 v[44:47], a[60:63], v[120:123], v[44:47]
ds_read_b64_tr_b16 a[30:31], v7 offset:42848
s_waitcnt lgkmcnt(8)
v_mfma_f32_16x16x32_bf16 v[32:35], a[0:3], v[128:131], v[32:35]
ds_read_b64_tr_b16 a[32:33], v7 offset:50688
v_mfma_f32_16x16x32_bf16 v[48:51], a[0:3], v[132:135], v[48:51]
ds_read_b64_tr_b16 a[34:35], v7 offset:51200
v_mfma_f32_16x16x32_bf16 v[52:55], a[4:7], v[132:135], v[52:55]
ds_read_b64_tr_b16 a[36:37], v7 offset:50720
v_mfma_f32_16x16x32_bf16 v[36:39], a[4:7], v[128:131], v[36:39]
ds_read_b64_tr_b16 a[38:39], v7 offset:51232
v_mfma_f32_16x16x32_bf16 v[40:43], a[8:11], v[128:131], v[40:43]
ds_read_b64_tr_b16 a[40:41], v7 offset:50752
v_mfma_f32_16x16x32_bf16 v[56:59], a[8:11], v[132:135], v[56:59]
ds_read_b64_tr_b16 a[42:43], v7 offset:51264
v_mfma_f32_16x16x32_bf16 v[60:63], a[12:15], v[132:135], v[60:63]
ds_read_b64_tr_b16 a[44:45], v7 offset:50784
v_mfma_f32_16x16x32_bf16 v[44:47], a[12:15], v[128:131], v[44:47]
ds_read_b64_tr_b16 a[46:47], v7 offset:51296
s_waitcnt lgkmcnt(8)
v_mfma_f32_16x16x32_bf16 v[32:35], a[16:19], v[136:139], v[32:35]
ds_read_b64_tr_b16 a[48:49], v7 offset:59136
v_mfma_f32_16x16x32_bf16 v[48:51], a[16:19], v[140:143], v[48:51]
ds_read_b64_tr_b16 a[50:51], v7 offset:59648
v_mfma_f32_16x16x32_bf16 v[52:55], a[20:23], v[140:143], v[52:55]
ds_read_b64_tr_b16 a[52:53], v7 offset:59168
v_mfma_f32_16x16x32_bf16 v[36:39], a[20:23], v[136:139], v[36:39]
ds_read_b64_tr_b16 a[54:55], v7 offset:59680
v_mfma_f32_16x16x32_bf16 v[40:43], a[24:27], v[136:139], v[40:43]
ds_read_b64_tr_b16 a[56:57], v7 offset:59200
v_mfma_f32_16x16x32_bf16 v[56:59], a[24:27], v[140:143], v[56:59]
ds_read_b64_tr_b16 a[58:59], v7 offset:59712
v_mfma_f32_16x16x32_bf16 v[60:63], a[28:31], v[140:143], v[60:63]
ds_read_b64_tr_b16 a[60:61], v7 offset:59232
v_mfma_f32_16x16x32_bf16 v[44:47], a[28:31], v[136:139], v[44:47]
ds_read_b64_tr_b16 a[62:63], v7 offset:59744
v_add_u32 v7, s57, v7
s_waitcnt lgkmcnt(8)
v_mfma_f32_16x16x32_bf16 v[32:35], a[32:35], v[144:147], v[32:35]
ds_read_b64_tr_b16 a[0:1], v7
ds_read_b64_tr_b16 a[2:3], v7 offset:512
v_mfma_f32_16x16x32_bf16 v[48:51], a[32:35], v[148:151], v[48:51]
s_waitcnt vmcnt(0)
buffer_atomic_add v13, v12, s[16:19], s71 offen
v_mfma_f32_16x16x32_bf16 v[52:55], a[36:39], v[148:151], v[52:55]
ds_read_b64_tr_b16 a[4:5], v7 offset:32
v_mfma_f32_16x16x32_bf16 v[36:39], a[36:39], v[144:147], v[36:39]
ds_read_b64_tr_b16 a[6:7], v7 offset:544
v_mfma_f32_16x16x32_bf16 v[40:43], a[40:43], v[144:147], v[40:43]
ds_read_b64_tr_b16 a[8:9], v7 offset:64
v_mfma_f32_16x16x32_bf16 v[56:59], a[40:43], v[148:151], v[56:59]
ds_read_b64_tr_b16 a[10:11], v7 offset:576
v_mfma_f32_16x16x32_bf16 v[60:63], a[44:47], v[148:151], v[60:63]
ds_read_b64_tr_b16 a[12:13], v7 offset:96
v_mfma_f32_16x16x32_bf16 v[44:47], a[44:47], v[144:147], v[44:47]
ds_read_b64_tr_b16 a[14:15], v7 offset:608
s_waitcnt lgkmcnt(8)
v_mfma_f32_16x16x32_bf16 v[32:35], a[48:51], v[152:155], v[32:35]
ds_read_b64_tr_b16 a[16:17], v7 offset:8448
v_mfma_f32_16x16x32_bf16 v[48:51], a[48:51], v[156:159], v[48:51]
ds_read_b64_tr_b16 a[18:19], v7 offset:8960
v_mfma_f32_16x16x32_bf16 v[52:55], a[52:55], v[156:159], v[52:55]
ds_read_b64_tr_b16 a[20:21], v7 offset:8480
v_mfma_f32_16x16x32_bf16 v[36:39], a[52:55], v[152:155], v[36:39]
ds_read_b64_tr_b16 a[22:23], v7 offset:8992
v_mfma_f32_16x16x32_bf16 v[40:43], a[56:59], v[152:155], v[40:43]
ds_read_b64_tr_b16 a[24:25], v7 offset:8512
v_mfma_f32_16x16x32_bf16 v[56:59], a[56:59], v[156:159], v[56:59]
ds_read_b64_tr_b16 a[26:27], v7 offset:9024
v_mfma_f32_16x16x32_bf16 v[60:63], a[60:63], v[156:159], v[60:63]
ds_read_b64_tr_b16 a[28:29], v7 offset:8544
v_mfma_f32_16x16x32_bf16 v[44:47], a[60:63], v[152:155], v[44:47]
ds_read_b64_tr_b16 a[30:31], v7 offset:9056
s_waitcnt lgkmcnt(8)
s_barrier
v_mfma_f32_16x16x32_bf16 v[32:35], a[0:3], v[160:163], v[32:35]
ds_read_b64_tr_b16 a[32:33], v7 offset:16896
ds_read_b64_tr_b16 a[34:35], v7 offset:17408
v_mfma_f32_16x16x32_bf16 v[48:51], a[0:3], v[164:167], v[48:51]
buffer_atomic_add v15, v12, s[16:19], s70 offen sc0
v_mfma_f32_16x16x32_bf16 v[52:55], a[4:7], v[164:167], v[52:55]
ds_read_b64_tr_b16 a[36:37], v7 offset:16928
ds_read_b64_tr_b16 a[38:39], v7 offset:17440
v_mfma_f32_16x16x32_bf16 v[36:39], a[4:7], v[160:163], v[36:39]
ds_read_b64_tr_b16 a[40:41], v7 offset:16960
s_add_u32 m0, s59, 117248
v_mfma_f32_16x16x32_bf16 v[40:43], a[8:11], v[160:163], v[40:43]
buffer_load_dwordx4 v18, s[20:23], s58 offen lds
v_mfma_f32_16x16x32_bf16 v[56:59], a[8:11], v[164:167], v[56:59]
ds_read_b64_tr_b16 a[42:43], v7 offset:17472
ds_read_b64_tr_b16 a[44:45], v7 offset:16992
v_mfma_f32_16x16x32_bf16 v[60:63], a[12:15], v[164:167], v[60:63]
ds_read_b64_tr_b16 a[46:47], v7 offset:17504
v_mfma_f32_16x16x32_bf16 v[44:47], a[12:15], v[160:163], v[44:47]
ds_read_b64_tr_b16 a[48:49], v7 offset:25344
s_waitcnt lgkmcnt(9)
v_mfma_f32_16x16x32_bf16 v[32:35], a[16:19], v[168:171], v[32:35]
buffer_load_dwordx4 v19, s[20:23], s58 offen offset:1024 lds
v_mfma_f32_16x16x32_bf16 v[48:51], a[16:19], v[172:175], v[48:51]
ds_read_b64_tr_b16 a[50:51], v7 offset:25856
ds_read_b64_tr_b16 a[52:53], v7 offset:25376
v_mfma_f32_16x16x32_bf16 v[52:55], a[20:23], v[172:175], v[52:55]
buffer_load_dwordx4 v20, s[20:23], s58 offen offset:2048 lds
v_mfma_f32_16x16x32_bf16 v[36:39], a[20:23], v[168:171], v[36:39]
ds_read_b64_tr_b16 a[54:55], v7 offset:25888
s_add_u32 s58, s58, 196608
v_mfma_f32_16x16x32_bf16 v[40:43], a[24:27], v[168:171], v[40:43]
ds_read_b64_tr_b16 a[56:57], v7 offset:25408
s_add_u32 m0, s59, 129664
v_mfma_f32_16x16x32_bf16 v[56:59], a[24:27], v[172:175], v[56:59]
buffer_load_dwordx4 v18, s[20:23], s58 offen lds
v_mfma_f32_16x16x32_bf16 v[60:63], a[28:31], v[172:175], v[60:63]
ds_read_b64_tr_b16 a[58:59], v7 offset:25920
ds_read_b64_tr_b16 a[60:61], v7 offset:25440
v_mfma_f32_16x16x32_bf16 v[44:47], a[28:31], v[168:171], v[44:47]
ds_read_b64_tr_b16 a[62:63], v7 offset:25952
s_waitcnt lgkmcnt(8)
v_mfma_f32_16x16x32_bf16 v[32:35], a[32:35], v[176:179], v[32:35]
ds_read_b64_tr_b16 a[0:1], v7 offset:33792
ds_read_b64_tr_b16 a[2:3], v7 offset:34304
v_mfma_f32_16x16x32_bf16 v[48:51], a[32:35], v[180:183], v[48:51]
buffer_load_dwordx4 v19, s[20:23], s58 offen offset:1024 lds
v_mfma_f32_16x16x32_bf16 v[52:55], a[36:39], v[180:183], v[52:55]
ds_read_b64_tr_b16 a[4:5], v7 offset:33824
v_mfma_f32_16x16x32_bf16 v[36:39], a[36:39], v[176:179], v[36:39]
ds_read_b64_tr_b16 a[6:7], v7 offset:34336
ds_read_b64_tr_b16 a[8:9], v7 offset:33856
v_mfma_f32_16x16x32_bf16 v[40:43], a[40:43], v[176:179], v[40:43]
buffer_load_dwordx4 v20, s[20:23], s58 offen offset:2048 lds
v_mfma_f32_16x16x32_bf16 v[56:59], a[40:43], v[180:183], v[56:59]
ds_read_b64_tr_b16 a[10:11], v7 offset:34368
s_add_u32 s58, s58, 196608
v_mfma_f32_16x16x32_bf16 v[60:63], a[44:47], v[180:183], v[60:63]
ds_read_b64_tr_b16 a[12:13], v7 offset:33888
v_mfma_f32_16x16x32_bf16 v[44:47], a[44:47], v[176:179], v[44:47]
ds_read_b64_tr_b16 a[14:15], v7 offset:34400
s_add_u32 m0, s59, 67584
s_waitcnt lgkmcnt(8)
v_mfma_f32_16x16x32_bf16 v[32:35], a[48:51], v[184:187], v[32:35]
buffer_load_dwordx4 v18, s[20:23], s58 offen lds
v_mfma_f32_16x16x32_bf16 v[48:51], a[48:51], v[188:191], v[48:51]
ds_read_b64_tr_b16 a[16:17], v7 offset:42240
v_mfma_f32_16x16x32_bf16 v[52:55], a[52:55], v[188:191], v[52:55]
ds_read_b64_tr_b16 a[18:19], v7 offset:42752
ds_read_b64_tr_b16 a[20:21], v7 offset:42272
v_mfma_f32_16x16x32_bf16 v[36:39], a[52:55], v[184:187], v[36:39]
ds_read_b64_tr_b16 a[22:23], v7 offset:42784
v_mfma_f32_16x16x32_bf16 v[40:43], a[56:59], v[184:187], v[40:43]
buffer_load_dwordx4 v19, s[20:23], s58 offen offset:1024 lds
v_mfma_f32_16x16x32_bf16 v[56:59], a[56:59], v[188:191], v[56:59]
ds_read_b64_tr_b16 a[24:25], v7 offset:42304
ds_read_b64_tr_b16 a[26:27], v7 offset:42816
v_mfma_f32_16x16x32_bf16 v[60:63], a[60:63], v[188:191], v[60:63]
ds_read_b64_tr_b16 a[28:29], v7 offset:42336
v_mfma_f32_16x16x32_bf16 v[44:47], a[60:63], v[184:187], v[44:47]
ds_read_b64_tr_b16 a[30:31], v7 offset:42848
s_waitcnt vmcnt(8)
v_cmp_ne_u32 vcc, 0, v15
s_nop 0
s_cbranch_vccz .Lxs54
.Lxs54b:
s_waitcnt lgkmcnt(8)
v_mfma_f32_16x16x32_bf16 v[32:35], a[0:3], v[192:195], v[32:35]
ds_read_b64_tr_b16 a[32:33], v7 offset:50688
ds_read_b64_tr_b16 a[34:35], v7 offset:51200
v_mfma_f32_16x16x32_bf16 v[48:51], a[0:3], v[196:199], v[48:51]
ds_read_b64_tr_b16 a[36:37], v7 offset:50720
buffer_load_dwordx4 v[232:235], v11, s[16:19], s68 offen sc1
v_mfma_f32_16x16x32_bf16 v[52:55], a[4:7], v[196:199], v[52:55]
ds_read_b64_tr_b16 a[38:39], v7 offset:51232
s_add_u32 s68, s68, 131072
v_mfma_f32_16x16x32_bf16 v[36:39], a[4:7], v[192:195], v[36:39]
ds_read_b64_tr_b16 a[40:41], v7 offset:50752
buffer_load_dwordx4 v[236:239], v11, s[16:19], s68 offen sc1
v_mfma_f32_16x16x32_bf16 v[40:43], a[8:11], v[192:195], v[40:43]
ds_read_b64_tr_b16 a[42:43], v7 offset:51264
s_add_u32 s68, s68, -130048
v_mfma_f32_16x16x32_bf16 v[56:59], a[8:11], v[196:199], v[56:59]
ds_read_b64_tr_b16 a[44:45], v7 offset:50784
buffer_load_dwordx4 v[240:243], v11, s[16:19], s68 offen sc1
v_mfma_f32_16x16x32_bf16 v[60:63], a[12:15], v[196:199], v[60:63]
ds_read_b64_tr_b16 a[46:47], v7 offset:51296
s_add_u32 s68, s68, 131072
v_mfma_f32_16x16x32_bf16 v[44:47], a[12:15], v[192:195], v[44:47]
buffer_load_dwordx4 v[244:247], v11, s[16:19], s68 offen sc1
s_waitcnt lgkmcnt(8)
v_mfma_f32_16x16x32_bf16 v[32:35], a[16:19], v[200:203], v[32:35]
ds_read_b64_tr_b16 a[48:49], v7 offset:59136
buffer_load_dwordx4 v20, s[20:23], s58 offen offset:2048 lds
v_mfma_f32_16x16x32_bf16 v[48:51], a[16:19], v[204:207], v[48:51]
ds_read_b64_tr_b16 a[50:51], v7 offset:59648
s_add_u32 s58, s58, 196608
s_add_u32 m0, s59, 80000
v_mfma_f32_16x16x32_bf16 v[52:55], a[20:23], v[204:207], v[52:55]
ds_read_b64_tr_b16 a[52:53], v7 offset:59168
buffer_load_dwordx4 v18, s[20:23], s58 offen lds
v_mfma_f32_16x16x32_bf16 v[36:39], a[20:23], v[200:203], v[36:39]
ds_read_b64_tr_b16 a[54:55], v7 offset:59680
v_mfma_f32_16x16x32_bf16 v[40:43], a[24:27], v[200:203], v[40:43]
ds_read_b64_tr_b16 a[56:57], v7 offset:59200
buffer_load_dwordx4 v19, s[20:23], s58 offen offset:1024 lds
v_mfma_f32_16x16x32_bf16 v[56:59], a[24:27], v[204:207], v[56:59]
ds_read_b64_tr_b16 a[58:59], v7 offset:59712
v_mfma_f32_16x16x32_bf16 v[60:63], a[28:31], v[204:207], v[60:63]
ds_read_b64_tr_b16 a[60:61], v7 offset:59232
buffer_load_dwordx4 v20, s[20:23], s58 offen offset:2048 lds
v_mfma_f32_16x16x32_bf16 v[44:47], a[28:31], v[200:203], v[44:47]
ds_read_b64_tr_b16 a[62:63], v7 offset:59744
s_add_u32 s58, s58, 196608
s_waitcnt lgkmcnt(8)
v_mfma_f32_16x16x32_bf16 v[32:35], a[32:35], v[208:211], v[32:35]
s_add_u32 m0, s59, 92416
v_mfma_f32_16x16x32_bf16 v[48:51], a[32:35], v[212:215], v[48:51]
buffer_load_dwordx4 v18, s[20:23], s58 offen lds
v_mfma_f32_16x16x32_bf16 v[52:55], a[36:39], v[212:215], v[52:55]
v_mfma_f32_16x16x32_bf16 v[36:39], a[36:39], v[208:211], v[36:39]
v_mfma_f32_16x16x32_bf16 v[40:43], a[40:43], v[208:211], v[40:43]
v_mfma_f32_16x16x32_bf16 v[56:59], a[40:43], v[212:215], v[56:59]
v_mfma_f32_16x16x32_bf16 v[60:63], a[44:47], v[212:215], v[60:63]
buffer_load_dwordx4 v19, s[20:23], s58 offen offset:1024 lds
v_mfma_f32_16x16x32_bf16 v[44:47], a[44:47], v[208:211], v[44:47]
s_waitcnt lgkmcnt(0)
v_mfma_f32_16x16x32_bf16 v[32:35], a[48:51], v[216:219], v[32:35]
v_mfma_f32_16x16x32_bf16 v[48:51], a[48:51], v[220:223], v[48:51]
v_mfma_f32_16x16x32_bf16 v[52:55], a[52:55], v[220:223], v[52:55]
v_mfma_f32_16x16x32_bf16 v[36:39], a[52:55], v[216:219], v[36:39]
buffer_load_dwordx4 v20, s[20:23], s58 offen offset:2048 lds
v_mfma_f32_16x16x32_bf16 v[40:43], a[56:59], v[216:219], v[40:43]
s_add_u32 s58, s58, 196608
v_mfma_f32_16x16x32_bf16 v[56:59], a[56:59], v[220:223], v[56:59]
v_mfma_f32_16x16x32_bf16 v[60:63], a[60:63], v[220:223], v[60:63]
v_mfma_f32_16x16x32_bf16 v[44:47], a[60:63], v[216:219], v[44:47]
s_waitcnt vmcnt(10)
v_mfma_f32_16x16x32_bf16 v[32:35], v[226:229], v[232:235], v[32:35]
s_lshl_b32 s64, s6, 14
s_lshl_b32 s65, s49, 13
s_add_u32 s64, s64, s65
v_mfma_f32_16x16x32_bf16 v[36:39], v[224:227], v[232:235], v[36:39]
s_lshl_b32 s65, s7, 9
s_add_u32 s64, s64, s65
s_lshl_b32 s65, s48, 8
s_waitcnt vmcnt(9)
v_mfma_f32_16x16x32_bf16 v[40:43], v[226:229], v[236:239], v[40:43]
s_add_u32 s64, s64, s65
s_add_u32 s64, s64, 62914560
v_and_b32 v152, 31, v1
v_mfma_f32_16x16x32_bf16 v[44:47], v[224:227], v[236:239], v[44:47]
s_lshl_b32 s62, s7, 18
v_lshlrev_b32 v152, 3, v152
v_lshrrev_b32 v153, 5, v1
s_waitcnt vmcnt(8)
v_mfma_f32_16x16x32_bf16 v[48:51], v[226:229], v[240:243], v[48:51]
s_add_u32 s62, s62, 33554432
v_lshl_add_u32 v152, v153, 28, v152
s_add_u32 s63, s62, 0x20000
v_mfma_f32_16x16x32_bf16 v[52:55], v[224:227], v[240:243], v[52:55]
v_cvt_pk_bf16_f32 v128, v32, v33
v_cvt_pk_bf16_f32 v129, v34, v35
s_waitcnt vmcnt(7)
v_mfma_f32_16x16x32_bf16 v[56:59], v[226:229], v[244:247], v[56:59]
v_cvt_pk_bf16_f32 v130, v36, v37
v_cvt_pk_bf16_f32 v131, v38, v39
v_mfma_f32_16x16x32_bf16 v[60:63], v[224:227], v[244:247], v[60:63]
buffer_store_dwordx4 v[128:131], v4, s[16:19], s62 offen sc1
v_cvt_pk_bf16_f32 v132, v40, v41
v_cvt_pk_bf16_f32 v133, v42, v43
v_cvt_pk_bf16_f32 v134, v44, v45
v_cvt_pk_bf16_f32 v135, v46, v47
v_cvt_pk_bf16_f32 v136, v48, v49
v_cvt_pk_bf16_f32 v137, v50, v51
v_cvt_pk_bf16_f32 v138, v52, v53
v_cvt_pk_bf16_f32 v139, v54, v55
v_cvt_pk_bf16_f32 v140, v56, v57
v_cvt_pk_bf16_f32 v141, v58, v59
v_cvt_pk_bf16_f32 v142, v60, v61
v_cvt_pk_bf16_f32 v143, v62, v63
v_pk_mul_f32 v[146:147], v[32:33], v[32:33]
buffer_store_dwordx4 v[132:135], v4, s[16:19], s63 offen sc1
v_pk_mul_f32 v[150:151], v[48:49], v[48:49]
v_pk_fma_f32 v[146:147], v[34:35], v[34:35], v[146:147]
v_pk_add_f32 v[144:145], v[32:33], v[34:35]
v_pk_fma_f32 v[150:151], v[50:51], v[50:51], v[150:151]
v_pk_add_f32 v[148:149], v[48:49], v[50:51]
v_pk_fma_f32 v[146:147], v[36:37], v[36:37], v[146:147]
v_pk_add_f32 v[144:145], v[144:145], v[36:37]
v_pk_fma_f32 v[150:151], v[52:53], v[52:53], v[150:151]
v_pk_add_f32 v[148:149], v[148:149], v[52:53]
v_pk_fma_f32 v[146:147], v[38:39], v[38:39], v[146:147]
v_pk_add_f32 v[144:145], v[144:145], v[38:39]
v_pk_fma_f32 v[150:151], v[54:55], v[54:55], v[150:151]
v_pk_add_f32 v[148:149], v[148:149], v[54:55]
buffer_store_dwordx4 v[136:139], v4, s[16:19], s62 offen offset:1024 sc1
v_pk_fma_f32 v[146:147], v[40:41], v[40:41], v[146:147]
v_pk_add_f32 v[144:145], v[144:145], v[40:41]
v_pk_fma_f32 v[150:151], v[56:57], v[56:57], v[150:151]
v_pk_add_f32 v[148:149], v[148:149], v[56:57]
v_pk_fma_f32 v[146:147], v[42:43], v[42:43], v[146:147]
v_pk_add_f32 v[144:145], v[144:145], v[42:43]
v_pk_fma_f32 v[150:151], v[58:59], v[58:59], v[150:151]
v_pk_add_f32 v[148:149], v[148:149], v[58:59]
v_pk_fma_f32 v[146:147], v[44:45], v[44:45], v[146:147]
v_pk_add_f32 v[144:145], v[144:145], v[44:45]
v_pk_fma_f32 v[150:151], v[60:61], v[60:61], v[150:151]
v_pk_add_f32 v[148:149], v[148:149], v[60:61]
v_pk_fma_f32 v[146:147], v[46:47], v[46:47], v[146:147]
buffer_store_dwordx4 v[140:143], v4, s[16:19], s63 offen offset:1024 sc1
v_pk_add_f32 v[144:145], v[144:145], v[46:47]
v_pk_fma_f32 v[150:151], v[62:63], v[62:63], v[150:151]
v_pk_add_f32 v[148:149], v[148:149], v[62:63]
v_add_f32 v144, v144, v145
v_add_f32 v146, v146, v147
v_add_f32 v148, v148, v149
v_add_f32 v150, v150, v151
s_nop 0
v_permlane16_swap_b32 v144, v148
v_permlane16_swap_b32 v146, v150
v_add_f32 v144, v144, v148
v_add_f32 v146, v146, v150
s_nop 1
v_permlane32_swap_b32 v144, v146
v_add_f32 v144, v144, v146
s_nop 1
v_permlane32_swap_b32 v144, v145
buffer_store_dwordx2 v[144:145], v152, s[16:19], s64 offen sc1
s_nop 1
v_accvgpr_write_b32 a224, v32
v_accvgpr_write_b32 a225, v33
v_accvgpr_write_b32 a226, v34
v_accvgpr_write_b32 a227, v35
v_accvgpr_write_b32 a228, v36
v_accvgpr_write_b32 a229, v37
v_accvgpr_write_b32 a230, v38
v_accvgpr_write_b32 a231, v39
v_accvgpr_write_b32 a232, v40
v_accvgpr_write_b32 a233, v41
v_accvgpr_write_b32 a234, v42
v_accvgpr_write_b32 a235, v43
v_accvgpr_write_b32 a236, v44
v_accvgpr_write_b32 a237, v45
v_accvgpr_write_b32 a238, v46
v_accvgpr_write_b32 a239, v47
v_accvgpr_write_b32 a240, v48
v_accvgpr_write_b32 a241, v49
v_accvgpr_write_b32 a242, v50
v_accvgpr_write_b32 a243, v51
v_accvgpr_write_b32 a244, v52
v_accvgpr_write_b32 a245, v53
v_accvgpr_write_b32 a246, v54
v_accvgpr_write_b32 a247, v55
v_accvgpr_write_b32 a248, v56
v_accvgpr_write_b32 a249, v57
v_accvgpr_write_b32 a250, v58
v_accvgpr_write_b32 a251, v59
v_accvgpr_write_b32 a252, v60
v_accvgpr_write_b32 a253, v61
v_accvgpr_write_b32 a254, v62
v_accvgpr_write_b32 a255, v63
s_lshl_b32 s62, s8, 13
s_lshl_b32 s63, s3, 11
s_add_u32 s62, s62, s63
v_lshl_add_u32 v21, v1, 4, s62
v_lshrrev_b32 v2, 3, v1
v_cmp_eq_u32 vcc, 3, v2
v_add_u32 v2, 67108480, v21
s_nop 0
v_cndmask_b32 v21, v21, v2, vcc
s_lshl_b32 s62, s50, 10
s_sub_u32 s62, s62, 2048
v_lshl_add_u32 v22, v0, 2, s62
v_lshrrev_b32 v2, 5, v0
v_cmp_eq_u32 vcc, 3, v2
v_add_u32 v2, 67108480, v22
s_nop 0
v_cndmask_b32 v22, v22, v2, vcc
s_mul_i32 s62, s48, 4608
v_lshl_add_u32 v23, v1, 4, s62
v_lshrrev_b32 v24, 4, v1
v_mul_u32_u24 v24, 2304, v24
v_and_b32 v2, 15, v1
v_lshl_add_u32 v24, v2, 4, v24
s_mov_b32 s52, 33554432
s_mov_b32 s54, s58
s_mov_b32 s56, s59
s_mul_i32 s55, s3, 2304
v_bfe_u32 v25, v1, 3, 2
v_mul_u32_u24 v25, 3104, v25
v_bfe_u32 v2, v1, 2, 1
v_lshl_add_u32 v25, v2, 7, v25
v_bfe_u32 v2, v1, 5, 1
v_lshl_add_u32 v25, v2, 8, v25
v_and_b32 v2, 3, v1
v_lshl_add_u32 v25, v2, 3, v25
s_lshl_b32 s62, s49, 6
s_add_u32 s62, s62, 67584
v_add_u32 v25, s62, v25
s_lshl_b32 s62, s8, 1
s_add_u32 s62, s62, s3
s_lshr_b32 s63, s50, 2
s_cmp_lt_u32 s3, 2
s_cselect_b32 s62, s62, s63
s_lshl_b32 s62, s62, 13
s_cmp_eq_u32 s3, 3
s_cselect_b32 s62, 268435456, s62
v_lshl_add_u32 v26, v1, 4, s62
s_lshr_b32 s63, s20, 7
s_sub_u32 s63, 3, s63
s_and_b32 s63, s63, 7
s_and_b32 s62, s9, 8
s_add_u32 s63, s63, s62
s_lshl_b32 s62, s5, 2
s_add_u32 s62, s62, s3
s_mul_i32 s62, s62, 12288
s_lshl_b32 s64, s63, 7
s_add_u32 s62, s62, s64
s_xor_b32 s63, s63, s9
s_cmp_lt_u32 s63, 4
s_cselect_b32 s62, s62, 16777216
v_lshrrev_b32 v14, 3, v1
v_min_u32 v14, 5, v14
v_lshl_add_u32 v14, v14, 11, s62
s_mov_b32 s44, 983040
buffer_load_dword v27, v14, s[20:23], s44 offen
s_mov_b32 s44, 2555904
s_mul_i32 s59, s3, 2080
v_bfe_u32 v5, v1, 3, 1
v_lshrrev_b32 v2, 4, v1
v_lshl_add_u32 v5, v2, 3, v5
s_lshl_b32 s62, s3, 1
v_add_u32 v5, s62, v5
v_mul_u32_u24 v5, 2048, v5
v_and_b32 v2, 7, v1
v_lshl_add_u32 v5, v2, 4, v5
s_lshl_b32 s62, s7, 7
v_add_u32 v5, s62, v5
v_add_u32 v6, 64512, v5
s_lshl_b32 s62, s6, 10
s_add_u32 s62, s62, 30474240
s_lshl_b32 s64, s8, 10
s_add_u32 s64, s64, 30474240
s_lshr_b32 s67, s9, 1
s_and_b32 s67, s67, 3
s_lshl_b32 s67, s67, 7
s_add_u32 s64, s64, s67
s_lshr_b32 s65, s50, 3
s_lshl_b32 s65, s65, 10
s_add_u32 s65, s65, 30474240
s_lshr_b32 s67, s9, 1
s_and_b32 s67, s67, 3
s_lshl_b32 s67, s67, 7
s_add_u32 s65, s65, s67
v_lshl_add_u32 v252, v1, 7, s62
v_mov_b32 v253, s64
v_writelane_b32 v253, s65, 1
s_waitcnt vmcnt(1) lgkmcnt(0)
s_barrier
s_cmp_lg_u32 s3, 0
s_cbranch_scc1 .Lnosig55
v_mov_b32 v255, 1
s_mov_b64 exec, 15
buffer_atomic_add v255, v252, s[16:19], 0 offen
s_mov_b64 exec, -1
.Lnosig55:
s_cmp_lg_u32 s3, 1
s_cbranch_scc1 .Lfirst59
s_mov_b64 exec, 3
v_mov_b32 v254, 0
buffer_atomic_add v254, v253, s[16:19], 0 offen sc0
s_mov_b64 exec, -1
.Lfirst59:
ds_read_b64_tr_b16 a[20:21], v25 offset:49664
ds_read_b64_tr_b16 a[22:23], v25 offset:50176
ds_read_b64_tr_b16 a[24:25], v25 offset:49696
ds_read_b64_tr_b16 a[26:27], v25 offset:50208
ds_read_b64_tr_b16 a[28:29], v25 offset:50688
ds_read_b64_tr_b16 a[30:31], v25 offset:51200
ds_read_b64_tr_b16 a[32:33], v25 offset:50720
ds_read_b64_tr_b16 a[34:35], v25 offset:51232
ds_read_b64_tr_b16 a[36:37], v25 offset:51712
ds_read_b64_tr_b16 a[38:39], v25 offset:52224
ds_read_b64_tr_b16 a[40:41], v25 offset:51744
ds_read_b64_tr_b16 a[42:43], v25 offset:52256
v_lshrrev_b32 v2, 4, v1
v_lshlrev_b32 v2, 2, v2
v_and_b32 v13, 15, v1
v_sub_u32 v2, v13, v2
v_mov_b32 v13, 0xff61b1e6
v_subrev_u32 v54, 0, v2
v_cmp_gt_u32 vcc, 8, v54
s_nop 1
v_cndmask_b32 v50, v13, 0, vcc
v_cmp_gt_i32 vcc, -8, v54
s_nop 1
v_cndmask_b32 v46, v13, 0, vcc
v_subrev_u32 v54, 1, v2
v_cmp_gt_u32 vcc, 8, v54
s_nop 1
v_cndmask_b32 v51, v13, 0, vcc
v_cmp_gt_i32 vcc, -8, v54
s_nop 1
v_cndmask_b32 v47, v13, 0, vcc
v_subrev_u32 v54, 2, v2
v_cmp_gt_u32 vcc, 8, v54
s_nop 1
v_cndmask_b32 v52, v13, 0, vcc
v_cmp_gt_i32 vcc, -8, v54
s_nop 1
v_cndmask_b32 v48, v13, 0, vcc
v_subrev_u32 v54, 3, v2
v_cmp_gt_u32 vcc, 8, v54
s_nop 1
v_cndmask_b32 v53, v13, 0, vcc
v_cmp_gt_i32 vcc, -8, v54
s_nop 1
v_cndmask_b32 v49, v13, 0, vcc
s_cmp_lt_u32 s8, 2
s_cselect_b64 vcc, -1, 0
v_cndmask_b32 v54, v46, v13, vcc
v_cndmask_b32 v55, v47, v13, vcc
v_cndmask_b32 v56, v48, v13, vcc
v_cndmask_b32 v57, v49, v13, vcc
v_mov_b64 v[60:61], 0
v_mov_b64 v[62:63], 0
v_mov_b64 v[64:65], 0
v_mov_b64 v[66:67], 0
v_mov_b64 v[68:69], 0
v_mov_b64 v[70:71], 0
v_mov_b64 v[72:73], 0
v_mov_b64 v[74:75], 0
v_mov_b64 v[76:77], 0
v_mov_b64 v[78:79], 0
v_mov_b64 v[80:81], 0
v_mov_b64 v[82:83], 0
v_mov_b64 v[84:85], 0
v_mov_b64 v[86:87], 0
v_mov_b64 v[88:89], 0
v_mov_b64 v[90:91], 0
v_mov_b64 v[92:93], 0
v_mov_b64 v[94:95], 0
v_mov_b64 v[96:97], 0
v_mov_b64 v[98:99], 0
v_mov_b64 v[100:101], 0
v_mov_b64 v[102:103], 0
v_mov_b64 v[104:105], 0
v_mov_b64 v[106:107], 0
v_mov_b64 v[108:109], 0
v_mov_b64 v[110:111], 0
v_mov_b64 v[112:113], 0
v_mov_b64 v[114:115], 0
v_mov_b64 v[116:117], 0
v_mov_b64 v[118:119], 0
v_mov_b64 v[120:121], 0
v_mov_b64 v[122:123], 0
v_mov_b64 v[124:125], 0
v_mov_b64 v[126:127], 0
v_mov_b64 v[128:129], 0
.Lpad10:
s_cbranch_execz .Lnopoll51r
v_mov_b64 v[130:131], 0
v_mov_b64 v[132:133], 0
v_mov_b64 v[134:135], 0
v_mov_b64 v[136:137], 0
v_mov_b64 v[138:139], 0
v_mov_b64 v[140:141], 0
v_mov_b64 v[142:143], 0
v_mov_b64 v[144:145], 0
v_mov_b64 v[146:147], 0
v_mov_b64 v[148:149], 0
v_mov_b64 v[150:151], 0
v_mov_b64 v[152:153], 0
v_mov_b64 v[154:155], 0
v_mov_b64 v[156:157], 0
v_mov_b64 v[158:159], 0
v_mov_b64 v[160:161], 0
v_mov_b64 v[162:163], 0
v_mov_b64 v[164:165], 0
v_mov_b64 v[166:167], 0
v_mov_b64 v[168:169], 0
v_mov_b64 v[170:171], 0
v_mov_b64 v[172:173], 0
v_mov_b64 v[174:175], 0
s_mov_b32 s75, 62914560
v_and_b32 v10, 15, v1
v_lshlrev_b32 v12, 2, v10
v_lshlrev_b32 v10, 4, v10
v_add_u32 v10, 152576, v10
v_lshrrev_b32 v11, 4, v1
v_lshlrev_b32 v11, 4, v11
s_lshl_b32 s62, s49, 7
s_add_u32 s62, s62, 158720
v_add_u32 v12, s62, v12
v_add_u32 v13, s62, v11
v_add_u32 v11, 156672, v11
s_lshl_b32 s62, s3, 11
s_add_u32 s62, s62, 143360
v_lshl_add_u32 v8, v1, 4, s62
v_xor_b32 v9, 2048, v8
v_mov_b32 v248, 0x3f803f80
v_mov_b32 v249, 0x3f803f80
v_mov_b32 v250, 0x3f803f80
v_mov_b32 v251, 0x3f803f80
v_and_b32 v7, 31, v1
v_lshrrev_b32 v2, 5, v1
v_lshl_add_u32 v7, v7, 1, v2
v_and_b32 v2, 0xc0, v0
v_add_u32 v7, v7, v2
v_lshlrev_b32 v17, 2, v7
v_add_u32 v17, 156672, v17
v_lshlrev_b32 v7, 4, v7
v_add_u32 v7, 152576, v7
s_lshl_b32 s74, s9, 1
s_add_u32 s74, s74, s49
s_lshl_b32 s74, s74, 17
s_lshl_b32 s63, s8, 13
s_add_u32 s74, s74, s63
s_lshl_b32 s63, s48, 12
s_add_u32 s74, s74, s63
s_add_u32 s74, s74, 37748736
s_mov_b32 s62, 0
v_lshl_add_u32 v4, v1, 4, s62
v_lshrrev_b32 v2, 3, v1
v_cmp_eq_u32 vcc, 3, v2
v_add_u32 v2, 67108480, v4
s_nop 0
v_cndmask_b32 v4, v4, v2, vcc
ds_read_b128 v[28:31], v13
ds_read_b128 v[32:35], v13 offset:64
ds_read_b128 v[36:39], v13 offset:256
ds_read_b128 v[40:43], v13 offset:320
ds_read_b32 v44, v12 offset:512
ds_read_b32 v45, v12 offset:576
s_waitcnt lgkmcnt(0)
s_cmp_lg_u32 s3, 1
s_cbranch_scc1 .Lnopoll58
s_mov_b64 exec, 3
s_mov_b32 s15, 0
.Lpoll56:
s_waitcnt vmcnt(0)
v_cmp_ne_u32 vcc, 16, v254
s_add_u32 s15, s15, 1
s_cbranch_vccz .Lnopoll58r
s_mov_b64 exec, 3
v_mov_b32 v254, 0
buffer_atomic_add v254, v253, s[16:19], 0 offen sc0
s_cmp_le_u32 s15, 100000
s_cbranch_scc1 .Lpoll56
.Lgot57:
s_waitcnt vmcnt(0)
s_branch .Lnopoll58r
.Lnopoll58:
s_mov_b64 exec, 0
s_cmp_eq_u32 s3, 2
s_cbranch_scc1 .Lpad11
s_cmp_eq_u32 s3, 3
s_cbranch_scc1 .Lpad12
s_branch .Lpad13
.Lnopoll58r:
s_mov_b64 exec, -1
s_barrier
s_cmp_eq_u32 s48, 1
s_cbranch_scc1 .Lqkv60
s_add_u32 m0, s55, 36864
s_nop 0
buffer_load_dwordx4 v21, s[16:19], s52 offen sc1 lds
buffer_load_dwordx4 v21, s[16:19], s52 offen offset:1024 sc1 lds
buffer_load_dword v22, s[16:19], s52 offen offset:2048 sc1 lds
s_add_u32 s52, s52, 0x20000
s_add_u32 m0, s55, 46080
s_nop 0
buffer_load_dwordx4 v21, s[16:19], s52 offen sc1 lds
buffer_load_dwordx4 v21, s[16:19], s52 offen offset:1024 sc1 lds
buffer_load_dword v22, s[16:19], s52 offen offset:2048 sc1 lds
s_add_u32 s52, s52, 0x20000
s_add_u32 m0, s55, 0
s_nop 0
buffer_load_dwordx4 v21, s[16:19], s52 offen sc1 lds
buffer_load_dwordx4 v21, s[16:19], s52 offen offset:1024 sc1 lds
buffer_load_dword v22, s[16:19], s52 offen offset:2048 sc1 lds
s_add_u32 s52, s52, 0x20000
s_add_u32 m0, s55, 9216
s_nop 0
buffer_load_dwordx4 v21, s[16:19], s52 offen sc1 lds
buffer_load_dwordx4 v21, s[16:19], s52 offen offset:1024 sc1 lds
buffer_load_dword v22, s[16:19], s52 offen offset:2048 sc1 lds
s_add_u32 s52, s52, 0x20000
s_add_u32 m0, s55, 18432
s_nop 0
buffer_load_dwordx4 v21, s[16:19], s52 offen sc1 lds
buffer_load_dwordx4 v21, s[16:19], s52 offen offset:1024 sc1 lds
buffer_load_dword v22, s[16:19], s52 offen offset:2048 sc1 lds
s_add_u32 s52, s52, 0x20000
s_waitcnt vmcnt(12)
s_barrier
ds_read_b128 a[0:3], v23 offset:36864
ds_read_b128 a[4:7], v23 offset:37888
ds_read_b128 a[8:11], v23 offset:39168
ds_read_b128 a[12:15], v23 offset:40192
ds_read_b128 a[16:19], v24 offset:38912
s_waitcnt lgkmcnt(0)
s_mov_b32 s15, -4
.p2align 6
.Lk62:
s_waitcnt vmcnt(9) lgkmcnt(8)
s_barrier
v_mfma_f32_16x16x32_bf16 v[60:63], a[20:23], a[0:3], v[60:63]
ds_read_b128 a[44:47], v23 offset:46080
s_add_u32 m0, s56, 104832
v_mfma_f32_16x16x32_bf16 v[76:79], a[24:27], a[0:3], v[76:79]
buffer_load_dwordx4 v18, s[20:23], s54 offen lds
v_mfma_f32_16x16x32_bf16 v[80:83], a[24:27], a[4:7], v[80:83]
ds_read_b128 a[48:51], v23 offset:47104
v_add_f32 v164, v164, v168
v_mfma_f32_16x16x32_bf16 v[64:67], a[20:23], a[4:7], v[64:67]
ds_read_b128 a[52:55], v23 offset:48384
v_mfma_f32_16x16x32_bf16 v[68:71], a[20:23], a[8:11], v[68:71]
buffer_load_dwordx4 v19, s[20:23], s54 offen offset:1024 lds
v_mfma_f32_16x16x32_bf16 v[84:87], a[24:27], a[8:11], v[84:87]
ds_read_b128 a[56:59], v23 offset:49408
v_mfma_f32_16x16x32_bf16 v[88:91], a[24:27], a[12:15], v[88:91]
ds_read_b64_tr_b16 a[64:65], v25 offset:62080
v_add_f32 v165, v165, v169
v_mfma_f32_16x16x32_bf16 v[72:75], a[20:23], a[12:15], v[72:75]
ds_read_b64_tr_b16 a[66:67], v25 offset:62592
s_waitcnt lgkmcnt(6)
v_mfma_f32_16x16x32_bf16 v[104:107], a[28:31], a[12:15], v[104:107]
buffer_load_dwordx4 v20, s[20:23], s54 offen offset:2048 lds
v_mfma_f32_16x16x32_bf16 v[120:123], a[32:35], a[12:15], v[120:123]
ds_read_b64_tr_b16 a[68:69], v25 offset:62112
s_add_u32 s54, s54, 196608
v_mfma_f32_16x16x32_bf16 v[116:119], a[32:35], a[8:11], v[116:119]
ds_read_b64_tr_b16 a[70:71], v25 offset:62624
s_add_u32 m0, s55, 27648
v_mfma_f32_16x16x32_bf16 v[100:103], a[28:31], a[8:11], v[100:103]
buffer_load_dwordx4 v21, s[16:19], s52 offen sc1 lds
v_mfma_f32_16x16x32_bf16 v[96:99], a[28:31], a[4:7], v[96:99]
ds_read_b128 a[60:63], v24 offset:48128
v_mfma_f32_16x16x32_bf16 v[112:115], a[32:35], a[4:7], v[112:115]
ds_read_b64_tr_b16 a[72:73], v25 offset:63104
v_mfma_f32_16x16x32_bf16 v[108:111], a[32:35], a[0:3], v[108:111]
buffer_load_dwordx4 v21, s[16:19], s52 offen offset:1024 sc1 lds
v_mfma_f32_16x16x32_bf16 v[92:95], a[28:31], a[0:3], v[92:95]
ds_read_b64_tr_b16 a[74:75], v25 offset:63616
v_add_f32 v166, v166, v170
v_mfma_f32_16x16x32_bf16 v[156:159], a[28:31], a[16:19], v[156:159]
ds_read_b64_tr_b16 a[76:77], v25 offset:63136
v_mfma_f32_16x16x32_bf16 v[160:163], a[32:35], a[16:19], v[160:163]
ds_read_b64_tr_b16 a[78:79], v25 offset:63648
v_mfma_f32_16x16x32_bf16 v[124:127], a[0:3], a[36:39], v[124:127]
buffer_load_dword v22, s[16:19], s52 offen offset:2048 sc1 lds
v_mfma_f32_16x16x32_bf16 v[140:143], a[0:3], a[40:43], v[140:143]
ds_read_b64_tr_b16 a[80:81], v25 offset:64128
s_add_u32 s52, s52, 0x20000
v_mfma_f32_16x16x32_bf16 v[144:147], a[4:7], a[40:43], v[144:147]
ds_read_b64_tr_b16 a[82:83], v25 offset:64640
v_add_f32 v167, v167, v171
v_mfma_f32_16x16x32_bf16 v[128:131], a[4:7], a[36:39], v[128:131]
buffer_load_dword v27, v14, s[20:23], s44 offen
v_mfma_f32_16x16x32_bf16 v[132:135], a[8:11], a[36:39], v[132:135]
ds_read_b64_tr_b16 a[84:85], v25 offset:64160
s_add_u32 s44, s44, 1572864
v_mfma_f32_16x16x32_bf16 v[148:151], a[8:11], a[40:43], v[148:151]
ds_read_b64_tr_b16 a[86:87], v25 offset:64672
v_mfma_f32_16x16x32_bf16 v[152:155], a[12:15], a[40:43], v[152:155]
v_mfma_f32_16x16x32_bf16 v[136:139], a[12:15], a[36:39], v[136:139]
s_waitcnt vmcnt(13) lgkmcnt(8)
s_barrier
v_mfma_f32_16x16x32_bf16 v[60:63], a[64:67], a[44:47], v[60:63]
ds_read_b128 a[0:3], v23
s_add_u32 m0, s56, 117248
v_mfma_f32_16x16x32_bf16 v[76:79], a[68:71], a[44:47], v[76:79]
buffer_load_dwordx4 v18, s[20:23], s54 offen lds
v_mfma_f32_16x16x32_bf16 v[80:83], a[68:71], a[48:51], v[80:83]
ds_read_b128 a[4:7], v23 offset:1024
v_mfma_f32_16x16x32_bf16 v[64:67], a[64:67], a[48:51], v[64:67]
ds_read_b128 a[8:11], v23 offset:2304
v_mfma_f32_16x16x32_bf16 v[68:71], a[64:67], a[52:55], v[68:71]
buffer_load_dwordx4 v19, s[20:23], s54 offen offset:1024 lds
v_mfma_f32_16x16x32_bf16 v[84:87], a[68:71], a[52:55], v[84:87]
ds_read_b128 a[12:15], v23 offset:3328
v_mfma_f32_16x16x32_bf16 v[88:91], a[68:71], a[56:59], v[88:91]
ds_read_b64_tr_b16 a[20:21], v25
v_mfma_f32_16x16x32_bf16 v[72:75], a[64:67], a[56:59], v[72:75]
ds_read_b64_tr_b16 a[22:23], v25 offset:512
s_waitcnt lgkmcnt(6)
v_mfma_f32_16x16x32_bf16 v[104:107], a[72:75], a[56:59], v[104:107]
buffer_load_dwordx4 v20, s[20:23], s54 offen offset:2048 lds
v_mfma_f32_16x16x32_bf16 v[120:123], a[76:79], a[56:59], v[120:123]
ds_read_b64_tr_b16 a[24:25], v25 offset:32
s_add_u32 s54, s54, 196608
v_mfma_f32_16x16x32_bf16 v[116:119], a[76:79], a[52:55], v[116:119]
ds_read_b64_tr_b16 a[26:27], v25 offset:544
s_add_u32 m0, s55, 36864
v_mfma_f32_16x16x32_bf16 v[100:103], a[72:75], a[52:55], v[100:103]
buffer_load_dwordx4 v21, s[16:19], s52 offen sc1 lds
v_mfma_f32_16x16x32_bf16 v[96:99], a[72:75], a[48:51], v[96:99]
ds_read_b128 a[16:19], v24 offset:2048
v_mfma_f32_16x16x32_bf16 v[112:115], a[76:79], a[48:51], v[112:115]
ds_read_b64_tr_b16 a[28:29], v25 offset:1024
v_mfma_f32_16x16x32_bf16 v[108:111], a[76:79], a[44:47], v[108:111]
buffer_load_dwordx4 v21, s[16:19], s52 offen offset:1024 sc1 lds
v_mfma_f32_16x16x32_bf16 v[92:95], a[72:75], a[44:47], v[92:95]
ds_read_b64_tr_b16 a[30:31], v25 offset:1536
v_mfma_f32_16x16x32_bf16 v[156:159], a[72:75], a[60:63], v[156:159]
ds_read_b64_tr_b16 a[32:33], v25 offset:1056
v_mfma_f32_16x16x32_bf16 v[160:163], a[76:79], a[60:63], v[160:163]
ds_read_b64_tr_b16 a[34:35], v25 offset:1568
v_mfma_f32_16x16x32_bf16 v[124:127], a[44:47], a[80:83], v[124:127]
buffer_load_dword v22, s[16:19], s52 offen offset:2048 sc1 lds
v_mfma_f32_16x16x32_bf16 v[140:143], a[44:47], a[84:87], v[140:143]
ds_read_b64_tr_b16 a[36:37], v25 offset:2048
s_add_u32 s52, s52, 0x20000
v_mfma_f32_16x16x32_bf16 v[144:147], a[48:51], a[84:87], v[144:147]
ds_read_b64_tr_b16 a[38:39], v25 offset:2560
v_mfma_f32_16x16x32_bf16 v[128:131], a[48:51], a[80:83], v[128:131]
buffer_load_dwordx4 v[168:171], v26, s[16:19], s75 offen sc1
v_mfma_f32_16x16x32_bf16 v[132:135], a[52:55], a[80:83], v[132:135]
ds_read_b64_tr_b16 a[40:41], v25 offset:2080
v_mfma_f32_16x16x32_bf16 v[148:151], a[52:55], a[84:87], v[148:151]
ds_read_b64_tr_b16 a[42:43], v25 offset:2592
v_mfma_f32_16x16x32_bf16 v[152:155], a[56:59], a[84:87], v[152:155]
v_mfma_f32_16x16x32_bf16 v[136:139], a[56:59], a[80:83], v[136:139]
s_waitcnt vmcnt(17) lgkmcnt(8)
s_barrier
v_mfma_f32_16x16x32_bf16 v[60:63], a[20:23], a[0:3], v[60:63]
ds_read_b128 a[44:47], v23 offset:9216
s_add_u32 m0, s56, 129664
v_mfma_f32_16x16x32_bf16 v[76:79], a[24:27], a[0:3], v[76:79]
buffer_load_dwordx4 v18, s[20:23], s54 offen lds
v_mfma_f32_16x16x32_bf16 v[80:83], a[24:27], a[4:7], v[80:83]
ds_read_b128 a[48:51], v23 offset:10240
v_mfma_f32_16x16x32_bf16 v[64:67], a[20:23], a[4:7], v[64:67]
ds_read_b128 a[52:55], v23 offset:11520
v_mfma_f32_16x16x32_bf16 v[68:71], a[20:23], a[8:11], v[68:71]
ds_read_b128 a[56:59], v23 offset:12544
v_mfma_f32_16x16x32_bf16 v[84:87], a[24:27], a[8:11], v[84:87]
buffer_load_dwordx4 v19, s[20:23], s54 offen offset:1024 lds
v_mfma_f32_16x16x32_bf16 v[88:91], a[24:27], a[12:15], v[88:91]
ds_read_b64_tr_b16 a[64:65], v25 offset:12416
v_mfma_f32_16x16x32_bf16 v[72:75], a[20:23], a[12:15], v[72:75]
ds_read_b64_tr_b16 a[66:67], v25 offset:12928
s_waitcnt lgkmcnt(6)
v_mfma_f32_16x16x32_bf16 v[104:107], a[28:31], a[12:15], v[104:107]
ds_read_b64_tr_b16 a[68:69], v25 offset:12448
v_mfma_f32_16x16x32_bf16 v[120:123], a[32:35], a[12:15], v[120:123]
buffer_load_dwordx4 v20, s[20:23], s54 offen offset:2048 lds
v_mfma_f32_16x16x32_bf16 v[116:119], a[32:35], a[8:11], v[116:119]
ds_read_b64_tr_b16 a[70:71], v25 offset:12960
s_add_u32 s54, s54, 196608
v_mfma_f32_16x16x32_bf16 v[100:103], a[28:31], a[8:11], v[100:103]
ds_read_b128 a[60:63], v24 offset:11264
v_mfma_f32_16x16x32_bf16 v[96:99], a[28:31], a[4:7], v[96:99]
s_add_u32 m0, s55, 46080
v_mfma_f32_16x16x32_bf16 v[112:115], a[32:35], a[4:7], v[112:115]
buffer_load_dwordx4 v21, s[16:19], s52 offen sc1 lds
v_mfma_f32_16x16x32_bf16 v[108:111], a[32:35], a[0:3], v[108:111]
ds_read_b64_tr_b16 a[72:73], v25 offset:13440
v_mfma_f32_16x16x32_bf16 v[92:95], a[28:31], a[0:3], v[92:95]
ds_read_b64_tr_b16 a[74:75], v25 offset:13952
v_mfma_f32_16x16x32_bf16 v[156:159], a[28:31], a[16:19], v[156:159]
ds_read_b64_tr_b16 a[76:77], v25 offset:13472
v_mfma_f32_16x16x32_bf16 v[160:163], a[32:35], a[16:19], v[160:163]
buffer_load_dwordx4 v21, s[16:19], s52 offen offset:1024 sc1 lds
v_mfma_f32_16x16x32_bf16 v[124:127], a[0:3], a[36:39], v[124:127]
ds_read_b64_tr_b16 a[78:79], v25 offset:13984
v_mfma_f32_16x16x32_bf16 v[140:143], a[0:3], a[40:43], v[140:143]
ds_read_b64_tr_b16 a[80:81], v25 offset:14464
v_mfma_f32_16x16x32_bf16 v[144:147], a[4:7], a[40:43], v[144:147]
ds_read_b64_tr_b16 a[82:83], v25 offset:14976
v_mfma_f32_16x16x32_bf16 v[128:131], a[4:7], a[36:39], v[128:131]
buffer_load_dword v22, s[16:19], s52 offen offset:2048 sc1 lds
v_mfma_f32_16x16x32_bf16 v[132:135], a[8:11], a[36:39], v[132:135]
ds_read_b64_tr_b16 a[84:85], v25 offset:14496
s_add_u32 s52, s52, 0x20000
v_mfma_f32_16x16x32_bf16 v[148:151], a[8:11], a[40:43], v[148:151]
ds_read_b64_tr_b16 a[86:87], v25 offset:15008
v_mfma_f32_16x16x32_bf16 v[152:155], a[12:15], a[40:43], v[152:155]
v_mfma_f32_16x16x32_bf16 v[136:139], a[12:15], a[36:39], v[136:139]
s_waitcnt vmcnt(20) lgkmcnt(8)
s_barrier
v_mfma_f32_16x16x32_bf16 v[60:63], a[64:67], a[44:47], v[60:63]
ds_read_b128 a[0:3], v23 offset:18432
s_add_u32 m0, s56, 67584
v_mfma_f32_16x16x32_bf16 v[76:79], a[68:71], a[44:47], v[76:79]
buffer_load_dwordx4 v18, s[20:23], s54 offen lds
v_mfma_f32_16x16x32_bf16 v[80:83], a[68:71], a[48:51], v[80:83]
ds_read_b128 a[4:7], v23 offset:19456
v_add_f32 v164, v164, v172
v_mfma_f32_16x16x32_bf16 v[64:67], a[64:67], a[48:51], v[64:67]
ds_read_b128 a[8:11], v23 offset:20736
v_mfma_f32_16x16x32_bf16 v[68:71], a[64:67], a[52:55], v[68:71]
ds_read_b128 a[12:15], v23 offset:21760
v_mfma_f32_16x16x32_bf16 v[84:87], a[68:71], a[52:55], v[84:87]
buffer_load_dwordx4 v19, s[20:23], s54 offen offset:1024 lds
v_mfma_f32_16x16x32_bf16 v[88:91], a[68:71], a[56:59], v[88:91]
ds_read_b64_tr_b16 a[20:21], v25 offset:24832
v_mfma_f32_16x16x32_bf16 v[72:75], a[64:67], a[56:59], v[72:75]
ds_read_b64_tr_b16 a[22:23], v25 offset:25344
s_waitcnt lgkmcnt(6)
v_mfma_f32_16x16x32_bf16 v[104:107], a[72:75], a[56:59], v[104:107]
ds_read_b64_tr_b16 a[24:25], v25 offset:24864
v_add_f32 v165, v165, v173
v_mfma_f32_16x16x32_bf16 v[120:123], a[76:79], a[56:59], v[120:123]
buffer_load_dwordx4 v20, s[20:23], s54 offen offset:2048 lds
v_mfma_f32_16x16x32_bf16 v[116:119], a[76:79], a[52:55], v[116:119]
ds_read_b64_tr_b16 a[26:27], v25 offset:25376
s_add_u32 s54, s54, 196608
v_mfma_f32_16x16x32_bf16 v[100:103], a[72:75], a[52:55], v[100:103]
ds_read_b128 a[16:19], v24 offset:20480
v_mfma_f32_16x16x32_bf16 v[96:99], a[72:75], a[48:51], v[96:99]
s_add_u32 m0, s55, 0
v_mfma_f32_16x16x32_bf16 v[112:115], a[76:79], a[48:51], v[112:115]
buffer_load_dwordx4 v21, s[16:19], s52 offen sc1 lds
v_mfma_f32_16x16x32_bf16 v[108:111], a[76:79], a[44:47], v[108:111]
ds_read_b64_tr_b16 a[28:29], v25 offset:25856
v_add_f32 v166, v166, v174
v_mfma_f32_16x16x32_bf16 v[92:95], a[72:75], a[44:47], v[92:95]
ds_read_b64_tr_b16 a[30:31], v25 offset:26368
v_mfma_f32_16x16x32_bf16 v[156:159], a[72:75], a[60:63], v[156:159]
ds_read_b64_tr_b16 a[32:33], v25 offset:25888
v_mfma_f32_16x16x32_bf16 v[160:163], a[76:79], a[60:63], v[160:163]
buffer_load_dwordx4 v21, s[16:19], s52 offen offset:1024 sc1 lds
v_mfma_f32_16x16x32_bf16 v[124:127], a[44:47], a[80:83], v[124:127]
ds_read_b64_tr_b16 a[34:35], v25 offset:26400
v_mfma_f32_16x16x32_bf16 v[140:143], a[44:47], a[84:87], v[140:143]
ds_read_b64_tr_b16 a[36:37], v25 offset:26880
v_add_f32 v167, v167, v175
v_mfma_f32_16x16x32_bf16 v[144:147], a[48:51], a[84:87], v[144:147]
ds_read_b64_tr_b16 a[38:39], v25 offset:27392
v_mfma_f32_16x16x32_bf16 v[128:131], a[48:51], a[80:83], v[128:131]
buffer_load_dword v22, s[16:19], s52 offen offset:2048 sc1 lds
v_mfma_f32_16x16x32_bf16 v[132:135], a[52:55], a[80:83], v[132:135]
ds_read_b64_tr_b16 a[40:41], v25 offset:26912
s_add_u32 s52, s52, 0x20000
v_mfma_f32_16x16x32_bf16 v[148:151], a[52:55], a[84:87], v[148:151]
ds_read_b64_tr_b16 a[42:43], v25 offset:27424
v_mfma_f32_16x16x32_bf16 v[152:155], a[56:59], a[84:87], v[152:155]
v_mfma_f32_16x16x32_bf16 v[136:139], a[56:59], a[80:83], v[136:139]
s_waitcnt vmcnt(20) lgkmcnt(8)
s_barrier
v_mfma_f32_16x16x32_bf16 v[60:63], a[20:23], a[0:3], v[60:63]
ds_read_b128 a[44:47], v23 offset:27648
s_add_u32 m0, s56, 80000
v_mfma_f32_16x16x32_bf16 v[76:79], a[24:27], a[0:3], v[76:79]
buffer_load_dwordx4 v18, s[20:23], s54 offen lds
v_mfma_f32_16x16x32_bf16 v[80:83], a[24:27], a[4:7], v[80:83]
ds_read_b128 a[48:51], v23 offset:28672
v_mfma_f32_16x16x32_bf16 v[64:67], a[20:23], a[4:7], v[64:67]
ds_read_b128 a[52:55], v23 offset:29952
v_mfma_f32_16x16x32_bf16 v[68:71], a[20:23], a[8:11], v[68:71]
buffer_load_dwordx4 v19, s[20:23], s54 offen offset:1024 lds
v_mfma_f32_16x16x32_bf16 v[84:87], a[24:27], a[8:11], v[84:87]
ds_read_b128 a[56:59], v23 offset:30976
v_mfma_f32_16x16x32_bf16 v[88:91], a[24:27], a[12:15], v[88:91]
ds_read_b64_tr_b16 a[64:65], v25 offset:37248
v_mfma_f32_16x16x32_bf16 v[72:75], a[20:23], a[12:15], v[72:75]
ds_read_b64_tr_b16 a[66:67], v25 offset:37760
s_waitcnt lgkmcnt(6)
v_mfma_f32_16x16x32_bf16 v[104:107], a[28:31], a[12:15], v[104:107]
buffer_load_dwordx4 v20, s[20:23], s54 offen offset:2048 lds
v_mfma_f32_16x16x32_bf16 v[120:123], a[32:35], a[12:15], v[120:123]
ds_read_b64_tr_b16 a[68:69], v25 offset:37280
s_add_u32 s54, s54, 196608
v_mfma_f32_16x16x32_bf16 v[116:119], a[32:35], a[8:11], v[116:119]
ds_read_b64_tr_b16 a[70:71], v25 offset:37792
s_add_u32 m0, s55, 9216
v_mfma_f32_16x16x32_bf16 v[100:103], a[28:31], a[8:11], v[100:103]
buffer_load_dwordx4 v21, s[16:19], s52 offen sc1 lds
v_mfma_f32_16x16x32_bf16 v[96:99], a[28:31], a[4:7], v[96:99]
ds_read_b128 a[60:63], v24 offset:29696
v_mfma_f32_16x16x32_bf16 v[112:115], a[32:35], a[4:7], v[112:115]
ds_read_b64_tr_b16 a[72:73], v25 offset:38272
v_mfma_f32_16x16x32_bf16 v[108:111], a[32:35], a[0:3], v[108:111]
buffer_load_dwordx4 v21, s[16:19], s52 offen offset:1024 sc1 lds
v_mfma_f32_16x16x32_bf16 v[92:95], a[28:31], a[0:3], v[92:95]
ds_read_b64_tr_b16 a[74:75], v25 offset:38784
v_mfma_f32_16x16x32_bf16 v[156:159], a[28:31], a[16:19], v[156:159]
ds_read_b64_tr_b16 a[76:77], v25 offset:38304
v_mfma_f32_16x16x32_bf16 v[160:163], a[32:35], a[16:19], v[160:163]
ds_read_b64_tr_b16 a[78:79], v25 offset:38816
v_mfma_f32_16x16x32_bf16 v[124:127], a[0:3], a[36:39], v[124:127]
buffer_load_dword v22, s[16:19], s52 offen offset:2048 sc1 lds
v_mfma_f32_16x16x32_bf16 v[140:143], a[0:3], a[40:43], v[140:143]
ds_read_b64_tr_b16 a[80:81], v25 offset:39296
s_add_u32 s52, s52, 0x20000
v_mfma_f32_16x16x32_bf16 v[144:147], a[4:7], a[40:43], v[144:147]
ds_read_b64_tr_b16 a[82:83], v25 offset:39808
v_mfma_f32_16x16x32_bf16 v[128:131], a[4:7], a[36:39], v[128:131]
buffer_load_dwordx4 v[172:175], v26, s[16:19], s75 offen offset:1024 sc1
v_mfma_f32_16x16x32_bf16 v[132:135], a[8:11], a[36:39], v[132:135]
ds_read_b64_tr_b16 a[84:85], v25 offset:39328
s_add_u32 s75, s75, 2048
v_mfma_f32_16x16x32_bf16 v[148:151], a[8:11], a[40:43], v[148:151]
ds_read_b64_tr_b16 a[86:87], v25 offset:39840
v_mfma_f32_16x16x32_bf16 v[152:155], a[12:15], a[40:43], v[152:155]
v_mfma_f32_16x16x32_bf16 v[136:139], a[12:15], a[36:39], v[136:139]
s_waitcnt vmcnt(20) lgkmcnt(8)
s_barrier
v_mfma_f32_16x16x32_bf16 v[60:63], a[64:67], a[44:47], v[60:63]
ds_read_b128 a[0:3], v23 offset:36864
s_add_u32 m0, s56, 92416
v_mfma_f32_16x16x32_bf16 v[76:79], a[68:71], a[44:47], v[76:79]
buffer_load_dwordx4 v18, s[20:23], s54 offen lds
v_mfma_f32_16x16x32_bf16 v[80:83], a[68:71], a[48:51], v[80:83]
ds_read_b128 a[4:7], v23 offset:37888
v_mfma_f32_16x16x32_bf16 v[64:67], a[64:67], a[48:51], v[64:67]
ds_read_b128 a[8:11], v23 offset:39168
v_mfma_f32_16x16x32_bf16 v[68:71], a[64:67], a[52:55], v[68:71]
ds_read_b128 a[12:15], v23 offset:40192
v_mfma_f32_16x16x32_bf16 v[84:87], a[68:71], a[52:55], v[84:87]
buffer_load_dwordx4 v19, s[20:23], s54 offen offset:1024 lds
v_mfma_f32_16x16x32_bf16 v[88:91], a[68:71], a[56:59], v[88:91]
ds_read_b64_tr_b16 a[20:21], v25 offset:49664
v_mfma_f32_16x16x32_bf16 v[72:75], a[64:67], a[56:59], v[72:75]
ds_read_b64_tr_b16 a[22:23], v25 offset:50176
s_waitcnt lgkmcnt(6)
v_mfma_f32_16x16x32_bf16 v[104:107], a[72:75], a[56:59], v[104:107]
ds_read_b64_tr_b16 a[24:25], v25 offset:49696
v_mfma_f32_16x16x32_bf16 v[120:123], a[76:79], a[56:59], v[120:123]
buffer_load_dwordx4 v20, s[20:23], s54 offen offset:2048 lds
v_mfma_f32_16x16x32_bf16 v[116:119], a[76:79], a[52:55], v[116:119]
ds_read_b64_tr_b16 a[26:27], v25 offset:50208
s_add_u32 s54, s54, 196608
v_mfma_f32_16x16x32_bf16 v[100:103], a[72:75], a[52:55], v[100:103]
ds_read_b128 a[16:19], v24 offset:38912
v_mfma_f32_16x16x32_bf16 v[96:99], a[72:75], a[48:51], v[96:99]
s_add_u32 m0, s55, 18432
v_mfma_f32_16x16x32_bf16 v[112:115], a[76:79], a[48:51], v[112:115]
buffer_load_dwordx4 v21, s[16:19], s52 offen sc1 lds
v_mfma_f32_16x16x32_bf16 v[108:111], a[76:79], a[44:47], v[108:111]
ds_read_b64_tr_b16 a[28:29], v25 offset:50688
v_mfma_f32_16x16x32_bf16 v[92:95], a[72:75], a[44:47], v[92:95]
ds_read_b64_tr_b16 a[30:31], v25 offset:51200
v_mfma_f32_16x16x32_bf16 v[156:159], a[72:75], a[60:63], v[156:159]
ds_read_b64_tr_b16 a[32:33], v25 offset:50720
v_mfma_f32_16x16x32_bf16 v[160:163], a[76:79], a[60:63], v[160:163]
buffer_load_dwordx4 v21, s[16:19], s52 offen offset:1024 sc1 lds
v_mfma_f32_16x16x32_bf16 v[124:127], a[44:47], a[80:83], v[124:127]
ds_read_b64_tr_b16 a[34:35], v25 offset:51232
v_mfma_f32_16x16x32_bf16 v[140:143], a[44:47], a[84:87], v[140:143]
ds_read_b64_tr_b16 a[36:37], v25 offset:51712
v_mfma_f32_16x16x32_bf16 v[144:147], a[48:51], a[84:87], v[144:147]
ds_read_b64_tr_b16 a[38:39], v25 offset:52224
v_mfma_f32_16x16x32_bf16 v[128:131], a[48:51], a[80:83], v[128:131]
buffer_load_dword v22, s[16:19], s52 offen offset:2048 sc1 lds
v_mfma_f32_16x16x32_bf16 v[132:135], a[52:55], a[80:83], v[132:135]
ds_read_b64_tr_b16 a[40:41], v25 offset:51744
s_add_u32 s52, s52, 0x20000
v_mfma_f32_16x16x32_bf16 v[148:151], a[52:55], a[84:87], v[148:151]
ds_read_b64_tr_b16 a[42:43], v25 offset:52256
v_mfma_f32_16x16x32_bf16 v[152:155], a[56:59], a[84:87], v[152:155]
s_add_u32 s15, s15, 1
v_mfma_f32_16x16x32_bf16 v[136:139], a[56:59], a[80:83], v[136:139]
s_cbranch_scc0 .Lk62
s_waitcnt vmcnt(19) lgkmcnt(8)
s_barrier
v_mfma_f32_16x16x32_bf16 v[60:63], a[20:23], a[0:3], v[60:63]
ds_read_b128 a[44:47], v23 offset:46080
s_add_u32 m0, s56, 104832
v_mfma_f32_16x16x32_bf16 v[76:79], a[24:27], a[0:3], v[76:79]
buffer_load_dwordx4 v18, s[20:23], s54 offen lds
v_mfma_f32_16x16x32_bf16 v[80:83], a[24:27], a[4:7], v[80:83]
ds_read_b128 a[48:51], v23 offset:47104
v_add_f32 v164, v164, v168
v_mfma_f32_16x16x32_bf16 v[64:67], a[20:23], a[4:7], v[64:67]
ds_read_b128 a[52:55], v23 offset:48384
v_mfma_f32_16x16x32_bf16 v[68:71], a[20:23], a[8:11], v[68:71]
ds_read_b128 a[56:59], v23 offset:49408
v_mfma_f32_16x16x32_bf16 v[84:87], a[24:27], a[8:11], v[84:87]
buffer_load_dwordx4 v19, s[20:23], s54 offen offset:1024 lds
v_mfma_f32_16x16x32_bf16 v[88:91], a[24:27], a[12:15], v[88:91]
ds_read_b64_tr_b16 a[64:65], v25 offset:62080
v_mfma_f32_16x16x32_bf16 v[72:75], a[20:23], a[12:15], v[72:75]
ds_read_b64_tr_b16 a[66:67], v25 offset:62592
s_waitcnt lgkmcnt(6)
v_mfma_f32_16x16x32_bf16 v[104:107], a[28:31], a[12:15], v[104:107]
ds_read_b64_tr_b16 a[68:69], v25 offset:62112
v_add_f32 v165, v165, v169
v_mfma_f32_16x16x32_bf16 v[120:123], a[32:35], a[12:15], v[120:123]
buffer_load_dwordx4 v20, s[20:23], s54 offen offset:2048 lds
v_mfma_f32_16x16x32_bf16 v[116:119], a[32:35], a[8:11], v[116:119]
ds_read_b64_tr_b16 a[70:71], v25 offset:62624
s_add_u32 s54, s54, 196608
v_mfma_f32_16x16x32_bf16 v[100:103], a[28:31], a[8:11], v[100:103]
ds_read_b128 a[60:63], v24 offset:48128
v_mfma_f32_16x16x32_bf16 v[96:99], a[28:31], a[4:7], v[96:99]
s_add_u32 m0, s55, 27648
v_mfma_f32_16x16x32_bf16 v[112:115], a[32:35], a[4:7], v[112:115]
buffer_load_dwordx4 v21, s[16:19], s52 offen sc1 lds
v_mfma_f32_16x16x32_bf16 v[108:111], a[32:35], a[0:3], v[108:111]
ds_read_b64_tr_b16 a[72:73], v25 offset:63104
v_add_f32 v166, v166, v170
v_mfma_f32_16x16x32_bf16 v[92:95], a[28:31], a[0:3], v[92:95]
ds_read_b64_tr_b16 a[74:75], v25 offset:63616
v_mfma_f32_16x16x32_bf16 v[156:159], a[28:31], a[16:19], v[156:159]
ds_read_b64_tr_b16 a[76:77], v25 offset:63136
v_mfma_f32_16x16x32_bf16 v[160:163], a[32:35], a[16:19], v[160:163]
buffer_load_dwordx4 v21, s[16:19], s52 offen offset:1024 sc1 lds
v_mfma_f32_16x16x32_bf16 v[124:127], a[0:3], a[36:39], v[124:127]
ds_read_b64_tr_b16 a[78:79], v25 offset:63648
v_mfma_f32_16x16x32_bf16 v[140:143], a[0:3], a[40:43], v[140:143]
ds_read_b64_tr_b16 a[80:81], v25 offset:64128
v_add_f32 v167, v167, v171
v_mfma_f32_16x16x32_bf16 v[144:147], a[4:7], a[40:43], v[144:147]
ds_read_b64_tr_b16 a[82:83], v25 offset:64640
v_mfma_f32_16x16x32_bf16 v[128:131], a[4:7], a[36:39], v[128:131]
buffer_load_dword v22, s[16:19], s52 offen offset:2048 sc1 lds
v_mfma_f32_16x16x32_bf16 v[132:135], a[8:11], a[36:39], v[132:135]
ds_read_b64_tr_b16 a[84:85], v25 offset:64160
s_add_u32 s52, s52, 0x20000
v_mfma_f32_16x16x32_bf16 v[148:151], a[8:11], a[40:43], v[148:151]
ds_read_b64_tr_b16 a[86:87], v25 offset:64672
v_mfma_f32_16x16x32_bf16 v[152:155], a[12:15], a[40:43], v[152:155]
v_mfma_f32_16x16x32_bf16 v[136:139], a[12:15], a[36:39], v[136:139]
s_waitcnt vmcnt(19) lgkmcnt(8)
s_barrier
v_mfma_f32_16x16x32_bf16 v[60:63], a[64:67], a[44:47], v[60:63]
ds_read_b128 a[0:3], v23
s_add_u32 m0, s56, 117248
v_mfma_f32_16x16x32_bf16 v[76:79], a[68:71], a[44:47], v[76:79]
buffer_load_dwordx4 v18, s[20:23], s54 offen lds
v_mfma_f32_16x16x32_bf16 v[80:83], a[68:71], a[48:51], v[80:83]
ds_read_b128 a[4:7], v23 offset:1024
v_mfma_f32_16x16x32_bf16 v[64:67], a[64:67], a[48:51], v[64:67]
ds_read_b128 a[8:11], v23 offset:2304
v_mfma_f32_16x16x32_bf16 v[68:71], a[64:67], a[52:55], v[68:71]
ds_read_b128 a[12:15], v23 offset:3328
v_mfma_f32_16x16x32_bf16 v[84:87], a[68:71], a[52:55], v[84:87]
buffer_load_dwordx4 v19, s[20:23], s54 offen offset:1024 lds
v_mfma_f32_16x16x32_bf16 v[88:91], a[68:71], a[56:59], v[88:91]
.Lpad11:
s_cbranch_execz .Lpad14
ds_read_b64_tr_b16 a[20:21], v25
v_mfma_f32_16x16x32_bf16 v[72:75], a[64:67], a[56:59], v[72:75]
ds_read_b64_tr_b16 a[22:23], v25 offset:512
s_waitcnt lgkmcnt(6)
v_mfma_f32_16x16x32_bf16 v[104:107], a[72:75], a[56:59], v[104:107]
ds_read_b64_tr_b16 a[24:25], v25 offset:32
v_mfma_f32_16x16x32_bf16 v[120:123], a[76:79], a[56:59], v[120:123]
buffer_load_dwordx4 v20, s[20:23], s54 offen offset:2048 lds
v_mfma_f32_16x16x32_bf16 v[116:119], a[76:79], a[52:55], v[116:119]
ds_read_b64_tr_b16 a[26:27], v25 offset:544
s_add_u32 s54, s54, 196608
v_mfma_f32_16x16x32_bf16 v[100:103], a[72:75], a[52:55], v[100:103]
ds_read_b128 a[16:19], v24 offset:2048
v_mfma_f32_16x16x32_bf16 v[96:99], a[72:75], a[48:51], v[96:99]
s_add_u32 m0, s55, 36864
v_mfma_f32_16x16x32_bf16 v[112:115], a[76:79], a[48:51], v[112:115]
buffer_load_dwordx4 v21, s[16:19], s52 offen sc1 lds
v_mfma_f32_16x16x32_bf16 v[108:111], a[76:79], a[44:47], v[108:111]
ds_read_b64_tr_b16 a[28:29], v25 offset:1024
v_mfma_f32_16x16x32_bf16 v[92:95], a[72:75], a[44:47], v[92:95]
ds_read_b64_tr_b16 a[30:31], v25 offset:1536
v_mfma_f32_16x16x32_bf16 v[156:159], a[72:75], a[60:63], v[156:159]
ds_read_b64_tr_b16 a[32:33], v25 offset:1056
v_mfma_f32_16x16x32_bf16 v[160:163], a[76:79], a[60:63], v[160:163]
buffer_load_dwordx4 v21, s[16:19], s52 offen offset:1024 sc1 lds
v_mfma_f32_16x16x32_bf16 v[124:127], a[44:47], a[80:83], v[124:127]
ds_read_b64_tr_b16 a[34:35], v25 offset:1568
v_mfma_f32_16x16x32_bf16 v[140:143], a[44:47], a[84:87], v[140:143]
ds_read_b64_tr_b16 a[36:37], v25 offset:2048
v_mfma_f32_16x16x32_bf16 v[144:147], a[48:51], a[84:87], v[144:147]
ds_read_b64_tr_b16 a[38:39], v25 offset:2560
v_mfma_f32_16x16x32_bf16 v[128:131], a[48:51], a[80:83], v[128:131]
buffer_load_dword v22, s[16:19], s52 offen offset:2048 sc1 lds
v_mfma_f32_16x16x32_bf16 v[132:135], a[52:55], a[80:83], v[132:135]
ds_read_b64_tr_b16 a[40:41], v25 offset:2080
s_add_u32 s52, s52, 0x20000
v_mfma_f32_16x16x32_bf16 v[148:151], a[52:55], a[84:87], v[148:151]
ds_read_b64_tr_b16 a[42:43], v25 offset:2592
v_mfma_f32_16x16x32_bf16 v[152:155], a[56:59], a[84:87], v[152:155]
v_mfma_f32_16x16x32_bf16 v[136:139], a[56:59], a[80:83], v[136:139]
s_waitcnt vmcnt(19) lgkmcnt(8)
s_barrier
v_mfma_f32_16x16x32_bf16 v[60:63], a[20:23], a[0:3], v[60:63]
ds_read_b128 a[44:47], v23 offset:9216
s_add_u32 m0, s56, 129664
v_mfma_f32_16x16x32_bf16 v[76:79], a[24:27], a[0:3], v[76:79]
buffer_load_dwordx4 v18, s[20:23], s54 offen lds
v_mfma_f32_16x16x32_bf16 v[80:83], a[24:27], a[4:7], v[80:83]
ds_read_b128 a[48:51], v23 offset:10240
s_waitcnt vmcnt(19)
v_add_f32 v164, v164, v172
v_mfma_f32_16x16x32_bf16 v[64:67], a[20:23], a[4:7], v[64:67]
ds_read_b128 a[52:55], v23 offset:11520
v_mfma_f32_16x16x32_bf16 v[68:71], a[20:23], a[8:11], v[68:71]
ds_read_b128 a[56:59], v23 offset:12544
v_mfma_f32_16x16x32_bf16 v[84:87], a[24:27], a[8:11], v[84:87]
buffer_load_dwordx4 v19, s[20:23], s54 offen offset:1024 lds
v_mfma_f32_16x16x32_bf16 v[88:91], a[24:27], a[12:15], v[88:91]
ds_read_b64_tr_b16 a[64:65], v25 offset:12416
v_mfma_f32_16x16x32_bf16 v[72:75], a[20:23], a[12:15], v[72:75]
ds_read_b64_tr_b16 a[66:67], v25 offset:12928
s_waitcnt lgkmcnt(6)
v_mfma_f32_16x16x32_bf16 v[104:107], a[28:31], a[12:15], v[104:107]
ds_read_b64_tr_b16 a[68:69], v25 offset:12448
v_add_f32 v165, v165, v173
v_mfma_f32_16x16x32_bf16 v[120:123], a[32:35], a[12:15], v[120:123]
buffer_load_dwordx4 v20, s[20:23], s54 offen offset:2048 lds
v_mfma_f32_16x16x32_bf16 v[116:119], a[32:35], a[8:11], v[116:119]
ds_read_b64_tr_b16 a[70:71], v25 offset:12960
s_add_u32 s54, s54, 196608
v_mfma_f32_16x16x32_bf16 v[100:103], a[28:31], a[8:11], v[100:103]
ds_read_b128 a[60:63], v24 offset:11264
v_mfma_f32_16x16x32_bf16 v[96:99], a[28:31], a[4:7], v[96:99]
s_add_u32 m0, s55, 46080
v_mfma_f32_16x16x32_bf16 v[112:115], a[32:35], a[4:7], v[112:115]
buffer_load_dwordx4 v21, s[16:19], s52 offen sc1 lds
v_mfma_f32_16x16x32_bf16 v[108:111], a[32:35], a[0:3], v[108:111]
ds_read_b64_tr_b16 a[72:73], v25 offset:13440
v_add_f32 v166, v166, v174
v_mfma_f32_16x16x32_bf16 v[92:95], a[28:31], a[0:3], v[92:95]
ds_read_b64_tr_b16 a[74:75], v25 offset:13952
v_mfma_f32_16x16x32_bf16 v[156:159], a[28:31], a[16:19], v[156:159]
ds_read_b64_tr_b16 a[76:77], v25 offset:13472
v_mfma_f32_16x16x32_bf16 v[160:163], a[32:35], a[16:19], v[160:163]
buffer_load_dwordx4 v21, s[16:19], s52 offen offset:1024 sc1 lds
v_mfma_f32_16x16x32_bf16 v[124:127], a[0:3], a[36:39], v[124:127]
ds_read_b64_tr_b16 a[78:79], v25 offset:13984
v_mfma_f32_16x16x32_bf16 v[140:143], a[0:3], a[40:43], v[140:143]
ds_read_b64_tr_b16 a[80:81], v25 offset:14464
v_add_f32 v167, v167, v175
v_mfma_f32_16x16x32_bf16 v[144:147], a[4:7], a[40:43], v[144:147]
ds_read_b64_tr_b16 a[82:83], v25 offset:14976
v_mfma_f32_16x16x32_bf16 v[128:131], a[4:7], a[36:39], v[128:131]
buffer_load_dword v22, s[16:19], s52 offen offset:2048 sc1 lds
v_mfma_f32_16x16x32_bf16 v[132:135], a[8:11], a[36:39], v[132:135]
ds_read_b64_tr_b16 a[84:85], v25 offset:14496
s_add_u32 s52, s52, 0x20000
v_mfma_f32_16x16x32_bf16 v[148:151], a[8:11], a[40:43], v[148:151]
ds_read_b64_tr_b16 a[86:87], v25 offset:15008
v_mfma_f32_16x16x32_bf16 v[152:155], a[12:15], a[40:43], v[152:155]
v_mfma_f32_16x16x32_bf16 v[136:139], a[12:15], a[36:39], v[136:139]
s_waitcnt vmcnt(18) lgkmcnt(8)
s_barrier
v_mfma_f32_16x16x32_bf16 v[60:63], a[64:67], a[44:47], v[60:63]
ds_read_b128 a[0:3], v23 offset:18432
s_add_u32 m0, s59, 0
s_mov_b32 s58, 1048576
v_mfma_f32_16x16x32_bf16 v[76:79], a[68:71], a[44:47], v[76:79]
buffer_load_dwordx4 v5, s[24:27], s58 offen lds
v_mfma_f32_16x16x32_bf16 v[80:83], a[68:71], a[48:51], v[80:83]
ds_read_b128 a[4:7], v23 offset:19456
v_permlane32_swap_b32 v164, v166
v_mfma_f32_16x16x32_bf16 v[64:67], a[64:67], a[48:51], v[64:67]
ds_read_b128 a[8:11], v23 offset:20736
v_mfma_f32_16x16x32_bf16 v[68:71], a[64:67], a[52:55], v[68:71]
ds_read_b128 a[12:15], v23 offset:21760
v_permlane32_swap_b32 v165, v167
v_mfma_f32_16x16x32_bf16 v[84:87], a[68:71], a[52:55], v[84:87]
buffer_load_dwordx4 v6, s[24:27], s58 offen offset:1024 lds
v_mfma_f32_16x16x32_bf16 v[88:91], a[68:71], a[56:59], v[88:91]
ds_read_b64_tr_b16 a[20:21], v25 offset:24832
v_mfma_f32_16x16x32_bf16 v[72:75], a[64:67], a[56:59], v[72:75]
v_add_f32 v164, v164, v166
s_waitcnt lgkmcnt(5)
v_mfma_f32_16x16x32_bf16 v[104:107], a[72:75], a[56:59], v[104:107]
ds_read_b64_tr_b16 a[22:23], v25 offset:25344
s_add_u32 m0, s59, 58240
s_mov_b32 s58, 1966080
v_mfma_f32_16x16x32_bf16 v[120:123], a[76:79], a[56:59], v[120:123]
buffer_load_dwordx4 v5, s[24:27], s58 offen lds
v_mfma_f32_16x16x32_bf16 v[116:119], a[76:79], a[52:55], v[116:119]
ds_read_b64_tr_b16 a[24:25], v25 offset:24864
v_add_f32 v165, v165, v167
v_mfma_f32_16x16x32_bf16 v[100:103], a[72:75], a[52:55], v[100:103]
ds_read_b64_tr_b16 a[26:27], v25 offset:25376
v_mfma_f32_16x16x32_bf16 v[96:99], a[72:75], a[48:51], v[96:99]
ds_read_b128 a[16:19], v24 offset:20480
v_mfma_f32_16x16x32_bf16 v[112:115], a[76:79], a[48:51], v[112:115]
buffer_load_dwordx4 v6, s[24:27], s58 offen offset:1024 lds
v_mfma_f32_16x16x32_bf16 v[108:111], a[76:79], a[44:47], v[108:111]
ds_read_b64_tr_b16 a[28:29], v25 offset:25856
v_mul_f32 v164, 0xba800000, v164
v_mfma_f32_16x16x32_bf16 v[92:95], a[72:75], a[44:47], v[92:95]
ds_read_b64_tr_b16 a[30:31], v25 offset:26368
v_mfma_f32_16x16x32_bf16 v[156:159], a[72:75], a[60:63], v[156:159]
s_add_u32 m0, s59, 66560
s_mov_b32 s58, 0
v_mul_f32 v165, 0x3a800000, v165
v_mfma_f32_16x16x32_bf16 v[160:163], a[76:79], a[60:63], v[160:163]
buffer_load_dwordx4 v5, s[24:27], s58 offen lds
v_mfma_f32_16x16x32_bf16 v[124:127], a[44:47], a[80:83], v[124:127]
ds_read_b64_tr_b16 a[32:33], v25 offset:25888
v_mfma_f32_16x16x32_bf16 v[140:143], a[44:47], a[84:87], v[140:143]
ds_read_b64_tr_b16 a[34:35], v25 offset:26400
v_fma_f32 v165, -v164, v164, v165
v_mfma_f32_16x16x32_bf16 v[144:147], a[48:51], a[84:87], v[144:147]
ds_read_b64_tr_b16 a[36:37], v25 offset:26880
v_mfma_f32_16x16x32_bf16 v[128:131], a[48:51], a[80:83], v[128:131]
buffer_load_dwordx4 v6, s[24:27], s58 offen offset:1024 lds
v_mfma_f32_16x16x32_bf16 v[132:135], a[52:55], a[80:83], v[132:135]
ds_read_b64_tr_b16 a[38:39], v25 offset:27392
v_max_f32 v165, 0, v165
v_mfma_f32_16x16x32_bf16 v[148:151], a[52:55], a[84:87], v[148:151]
ds_read_b64_tr_b16 a[40:41], v25 offset:26912
v_mfma_f32_16x16x32_bf16 v[152:155], a[56:59], a[84:87], v[152:155]
ds_read_b64_tr_b16 a[42:43], v25 offset:27424
v_mfma_f32_16x16x32_bf16 v[136:139], a[56:59], a[80:83], v[136:139]
s_waitcnt vmcnt(18) lgkmcnt(8)
s_barrier
v_mfma_f32_16x16x32_bf16 v[60:63], a[20:23], a[0:3], v[60:63]
ds_read_b128 a[44:47], v23 offset:27648
s_add_u32 m0, s59, 8320
s_mov_b32 s58, 1179648
v_mfma_f32_16x16x32_bf16 v[76:79], a[24:27], a[0:3], v[76:79]
buffer_load_dwordx4 v5, s[24:27], s58 offen lds
v_mfma_f32_16x16x32_bf16 v[80:83], a[24:27], a[4:7], v[80:83]
ds_read_b128 a[48:51], v23 offset:28672
v_add_f32 v165, 0x3727c5ac, v165
v_mfma_f32_16x16x32_bf16 v[64:67], a[20:23], a[4:7], v[64:67]
ds_read_b128 a[52:55], v23 offset:29952
v_mfma_f32_16x16x32_bf16 v[68:71], a[20:23], a[8:11], v[68:71]
ds_read_b128 a[56:59], v23 offset:30976
v_mfma_f32_16x16x32_bf16 v[84:87], a[24:27], a[8:11], v[84:87]
buffer_load_dwordx4 v6, s[24:27], s58 offen offset:1024 lds
v_mfma_f32_16x16x32_bf16 v[88:91], a[24:27], a[12:15], v[88:91]
ds_read_b64_tr_b16 a[64:65], v25 offset:37248
v_mfma_f32_16x16x32_bf16 v[72:75], a[20:23], a[12:15], v[72:75]
v_rsq_f32 v166, v165
s_waitcnt lgkmcnt(5)
v_mfma_f32_16x16x32_bf16 v[104:107], a[28:31], a[12:15], v[104:107]
ds_read_b64_tr_b16 a[66:67], v25 offset:37760
s_add_u32 m0, s59, 74880
s_mov_b32 s58, 131072
v_mfma_f32_16x16x32_bf16 v[120:123], a[32:35], a[12:15], v[120:123]
buffer_load_dwordx4 v5, s[24:27], s58 offen lds
v_mfma_f32_16x16x32_bf16 v[116:119], a[32:35], a[8:11], v[116:119]
ds_read_b64_tr_b16 a[68:69], v25 offset:37280
v_mfma_f32_16x16x32_bf16 v[100:103], a[28:31], a[8:11], v[100:103]
ds_read_b64_tr_b16 a[70:71], v25 offset:37792
v_mfma_f32_16x16x32_bf16 v[96:99], a[28:31], a[4:7], v[96:99]
ds_read_b128 a[60:63], v24 offset:29696
v_mfma_f32_16x16x32_bf16 v[112:115], a[32:35], a[4:7], v[112:115]
buffer_load_dwordx4 v6, s[24:27], s58 offen offset:1024 lds
v_mfma_f32_16x16x32_bf16 v[108:111], a[32:35], a[0:3], v[108:111]
ds_read_b64_tr_b16 a[72:73], v25 offset:38272
v_mov_b32 v165, v166
v_mfma_f32_16x16x32_bf16 v[92:95], a[28:31], a[0:3], v[92:95]
ds_read_b64_tr_b16 a[74:75], v25 offset:38784
v_mfma_f32_16x16x32_bf16 v[156:159], a[28:31], a[16:19], v[156:159]
s_add_u32 m0, s59, 83200
s_mov_b32 s58, 262144
v_mfma_f32_16x16x32_bf16 v[160:163], a[32:35], a[16:19], v[160:163]
buffer_load_dwordx4 v5, s[24:27], s58 offen lds
v_mfma_f32_16x16x32_bf16 v[124:127], a[0:3], a[36:39], v[124:127]
ds_read_b64_tr_b16 a[76:77], v25 offset:38304
v_mfma_f32_16x16x32_bf16 v[140:143], a[0:3], a[40:43], v[140:143]
ds_read_b64_tr_b16 a[78:79], v25 offset:38816
v_mul_f32 v166, 0x3e8293ee, v166
v_mfma_f32_16x16x32_bf16 v[144:147], a[4:7], a[40:43], v[144:147]
ds_read_b64_tr_b16 a[80:81], v25 offset:39296
v_mfma_f32_16x16x32_bf16 v[128:131], a[4:7], a[36:39], v[128:131]
buffer_load_dwordx4 v6, s[24:27], s58 offen offset:1024 lds
v_mfma_f32_16x16x32_bf16 v[132:135], a[8:11], a[36:39], v[132:135]
ds_read_b64_tr_b16 a[82:83], v25 offset:39808
v_mfma_f32_16x16x32_bf16 v[148:151], a[8:11], a[40:43], v[148:151]
ds_read_b64_tr_b16 a[84:85], v25 offset:39328
v_mfma_f32_16x16x32_bf16 v[152:155], a[12:15], a[40:43], v[152:155]
ds_read_b64_tr_b16 a[86:87], v25 offset:39840
v_mfma_f32_16x16x32_bf16 v[136:139], a[12:15], a[36:39], v[136:139]
s_waitcnt vmcnt(18) lgkmcnt(8)
s_barrier
v_mfma_f32_16x16x32_bf16 v[60:63], a[64:67], a[44:47], v[60:63]
s_add_u32 m0, s59, 16640
s_mov_b32 s58, 1310720
ds_write_b128 v7, v[164:167]
v_mfma_f32_16x16x32_bf16 v[76:79], a[68:71], a[44:47], v[76:79]
buffer_load_dwordx4 v5, s[24:27], s58 offen lds
v_mfma_f32_16x16x32_bf16 v[80:83], a[68:71], a[48:51], v[80:83]
ds_read_b128 a[0:3], v23 offset:36864
v_mfma_f32_16x16x32_bf16 v[64:67], a[64:67], a[48:51], v[64:67]
ds_read_b128 a[4:7], v23 offset:37888
v_mfma_f32_16x16x32_bf16 v[68:71], a[64:67], a[52:55], v[68:71]
ds_read_b128 a[8:11], v23 offset:39168
v_mfma_f32_16x16x32_bf16 v[84:87], a[68:71], a[52:55], v[84:87]
ds_read_b128 a[12:15], v23 offset:40192
v_mfma_f32_16x16x32_bf16 v[88:91], a[68:71], a[56:59], v[88:91]
ds_read_b64_tr_b16 a[20:21], v25 offset:49664
v_mfma_f32_16x16x32_bf16 v[72:75], a[64:67], a[56:59], v[72:75]
ds_read_b64_tr_b16 a[22:23], v25 offset:50176
s_waitcnt lgkmcnt(7)
v_mfma_f32_16x16x32_bf16 v[104:107], a[72:75], a[56:59], v[104:107]
buffer_load_dwordx4 v6, s[24:27], s58 offen offset:1024 lds
v_mfma_f32_16x16x32_bf16 v[120:123], a[76:79], a[56:59], v[120:123]
ds_read_b64_tr_b16 a[24:25], v25 offset:49696
v_mfma_f32_16x16x32_bf16 v[116:119], a[76:79], a[52:55], v[116:119]
ds_read_b64_tr_b16 a[26:27], v25 offset:50208
ds_write_b32 v17, v164
v_mfma_f32_16x16x32_bf16 v[100:103], a[72:75], a[52:55], v[100:103]
ds_read_b128 a[16:19], v24 offset:38912
v_mfma_f32_16x16x32_bf16 v[96:99], a[72:75], a[48:51], v[96:99]
s_add_u32 m0, s59, 91520
s_mov_b32 s58, 393216
v_mfma_f32_16x16x32_bf16 v[112:115], a[76:79], a[48:51], v[112:115]
buffer_load_dwordx4 v5, s[24:27], s58 offen lds
v_mfma_f32_16x16x32_bf16 v[108:111], a[76:79], a[44:47], v[108:111]
v_mfma_f32_16x16x32_bf16 v[92:95], a[72:75], a[44:47], v[92:95]
ds_read_b64_tr_b16 a[28:29], v25 offset:50688
v_mfma_f32_16x16x32_bf16 v[156:159], a[72:75], a[60:63], v[156:159]
ds_read_b64_tr_b16 a[30:31], v25 offset:51200
v_mfma_f32_16x16x32_bf16 v[160:163], a[76:79], a[60:63], v[160:163]
ds_read_b64_tr_b16 a[32:33], v25 offset:50720
ds_write_b32 v17, v165 offset:1024
v_mfma_f32_16x16x32_bf16 v[124:127], a[44:47], a[80:83], v[124:127]
ds_read_b64_tr_b16 a[34:35], v25 offset:51232
v_mfma_f32_16x16x32_bf16 v[140:143], a[44:47], a[84:87], v[140:143]
buffer_load_dwordx4 v6, s[24:27], s58 offen offset:1024 lds
v_mfma_f32_16x16x32_bf16 v[144:147], a[48:51], a[84:87], v[144:147]
ds_read_b64_tr_b16 a[36:37], v25 offset:51712
v_mfma_f32_16x16x32_bf16 v[128:131], a[48:51], a[80:83], v[128:131]
ds_read_b64_tr_b16 a[38:39], v25 offset:52224
v_mfma_f32_16x16x32_bf16 v[132:135], a[52:55], a[80:83], v[132:135]
ds_read_b64_tr_b16 a[40:41], v25 offset:51744
v_mfma_f32_16x16x32_bf16 v[148:151], a[52:55], a[84:87], v[148:151]
ds_read_b64_tr_b16 a[42:43], v25 offset:52256
v_mfma_f32_16x16x32_bf16 v[152:155], a[56:59], a[84:87], v[152:155]
v_mfma_f32_16x16x32_bf16 v[136:139], a[56:59], a[80:83], v[136:139]
s_waitcnt vmcnt(16) lgkmcnt(9)
s_barrier
v_mfma_f32_16x16x32_bf16 v[60:63], a[20:23], a[0:3], v[60:63]
ds_read_b128 a[44:47], v23 offset:46080
s_add_u32 m0, s59, 24960
s_mov_b32 s58, 1441792
v_mfma_f32_16x16x32_bf16 v[76:79], a[24:27], a[0:3], v[76:79]
buffer_load_dwordx4 v5, s[24:27], s58 offen lds
v_mfma_f32_16x16x32_bf16 v[80:83], a[24:27], a[4:7], v[80:83]
ds_read_b128 a[48:51], v23 offset:47104
v_mfma_f32_16x16x32_bf16 v[64:67], a[20:23], a[4:7], v[64:67]
ds_read_b128 a[52:55], v23 offset:48384
v_mfma_f32_16x16x32_bf16 v[68:71], a[20:23], a[8:11], v[68:71]
ds_read_b128 a[56:59], v23 offset:49408
v_mfma_f32_16x16x32_bf16 v[84:87], a[24:27], a[8:11], v[84:87]
buffer_load_dwordx4 v6, s[24:27], s58 offen offset:1024 lds
v_mfma_f32_16x16x32_bf16 v[88:91], a[24:27], a[12:15], v[88:91]
ds_read_b64_tr_b16 a[64:65], v25 offset:62080
v_mfma_f32_16x16x32_bf16 v[72:75], a[20:23], a[12:15], v[72:75]
s_waitcnt lgkmcnt(5)
v_mfma_f32_16x16x32_bf16 v[104:107], a[28:31], a[12:15], v[104:107]
ds_read_b64_tr_b16 a[66:67], v25 offset:62592
s_add_u32 m0, s59, 99840
s_mov_b32 s58, 524288
v_mfma_f32_16x16x32_bf16 v[120:123], a[32:35], a[12:15], v[120:123]
buffer_load_dwordx4 v5, s[24:27], s58 offen lds
v_mfma_f32_16x16x32_bf16 v[116:119], a[32:35], a[8:11], v[116:119]
ds_read_b64_tr_b16 a[68:69], v25 offset:62112
v_mfma_f32_16x16x32_bf16 v[100:103], a[28:31], a[8:11], v[100:103]
ds_read_b64_tr_b16 a[70:71], v25 offset:62624
v_mfma_f32_16x16x32_bf16 v[96:99], a[28:31], a[4:7], v[96:99]
ds_read_b128 a[60:63], v24 offset:48128
v_mfma_f32_16x16x32_bf16 v[112:115], a[32:35], a[4:7], v[112:115]
buffer_load_dwordx4 v6, s[24:27], s58 offen offset:1024 lds
v_mfma_f32_16x16x32_bf16 v[108:111], a[32:35], a[0:3], v[108:111]
ds_read_b64_tr_b16 a[72:73], v25 offset:63104
v_mfma_f32_16x16x32_bf16 v[92:95], a[28:31], a[0:3], v[92:95]
ds_read_b64_tr_b16 a[74:75], v25 offset:63616
v_mfma_f32_16x16x32_bf16 v[156:159], a[28:31], a[16:19], v[156:159]
s_add_u32 m0, s59, 108160
s_mov_b32 s58, 655360
v_mfma_f32_16x16x32_bf16 v[160:163], a[32:35], a[16:19], v[160:163]
buffer_load_dwordx4 v5, s[24:27], s58 offen lds
v_mfma_f32_16x16x32_bf16 v[124:127], a[0:3], a[36:39], v[124:127]
ds_read_b64_tr_b16 a[76:77], v25 offset:63136
v_mfma_f32_16x16x32_bf16 v[140:143], a[0:3], a[40:43], v[140:143]
ds_read_b64_tr_b16 a[78:79], v25 offset:63648
v_mfma_f32_16x16x32_bf16 v[144:147], a[4:7], a[40:43], v[144:147]
ds_read_b64_tr_b16 a[80:81], v25 offset:64128
v_mfma_f32_16x16x32_bf16 v[128:131], a[4:7], a[36:39], v[128:131]
buffer_load_dwordx4 v6, s[24:27], s58 offen offset:1024 lds
v_mfma_f32_16x16x32_bf16 v[132:135], a[8:11], a[36:39], v[132:135]
ds_read_b64_tr_b16 a[82:83], v25 offset:64640
v_mfma_f32_16x16x32_bf16 v[148:151], a[8:11], a[40:43], v[148:151]
ds_read_b64_tr_b16 a[84:85], v25 offset:64160
v_mfma_f32_16x16x32_bf16 v[152:155], a[12:15], a[40:43], v[152:155]
ds_read_b64_tr_b16 a[86:87], v25 offset:64672
v_mfma_f32_16x16x32_bf16 v[136:139], a[12:15], a[36:39], v[136:139]
s_waitcnt lgkmcnt(0)
s_barrier
v_mfma_f32_16x16x32_bf16 v[156:159], a[72:75], a[60:63], v[156:159]
ds_read_b128 v[232:235], v10 offset:768
s_add_u32 m0, s59, 33280
v_mfma_f32_16x16x32_bf16 v[160:163], a[76:79], a[60:63], v[160:163]
ds_read_b128 v[236:239], v10 offset:2816
s_mov_b32 s58, 1572864
v_mfma_f32_16x16x32_bf16 v[104:107], a[72:75], a[56:59], v[104:107]
ds_read_b128 v[228:231], v10 offset:512
v_mfma_f32_16x16x32_bf16 v[120:123], a[76:79], a[56:59], v[120:123]
ds_read_b128 v[224:227], v10 offset:256
v_mfma_f32_16x16x32_bf16 v[136:139], a[56:59], a[80:83], v[136:139]
ds_read_b128 v[220:223], v10
v_mfma_f32_16x16x32_bf16 v[152:155], a[56:59], a[84:87], v[152:155]
ds_read_b128 v[240:243], v11 offset:192
v_mfma_f32_16x16x32_bf16 v[100:103], a[72:75], a[52:55], v[100:103]
ds_read_b128 v[244:247], v11 offset:1216
v_mfma_f32_16x16x32_bf16 v[116:119], a[76:79], a[52:55], v[116:119]
buffer_load_dwordx4 v5, s[24:27], s58 offen lds
v_mfma_f32_16x16x32_bf16 v[96:99], a[72:75], a[48:51], v[96:99]
ds_read_b128 v[18:21], v11 offset:128
ds_read_b128 v[22:25], v11 offset:1152
s_waitcnt lgkmcnt(8)
v_pk_fma_f32 v[104:105], v[36:37], v[232:233], v[104:105] op_sel_hi:[1,0,1]
v_pk_mul_f32 v[104:105], v[104:105], v[232:233] op_sel:[0,1] op_sel_hi:[1,1]
v_pk_fma_f32 v[106:107], v[38:39], v[232:233], v[106:107] op_sel_hi:[1,0,1]
v_pk_mul_f32 v[106:107], v[106:107], v[232:233] op_sel:[0,1] op_sel_hi:[1,1]
v_pk_fma_f32 v[120:121], v[40:41], v[232:233], v[120:121] op_sel_hi:[1,0,1]
v_pk_mul_f32 v[120:121], v[120:121], v[232:233] op_sel:[0,1] op_sel_hi:[1,1]
v_pk_fma_f32 v[122:123], v[42:43], v[232:233], v[122:123] op_sel_hi:[1,0,1]
v_pk_mul_f32 v[122:123], v[122:123], v[232:233] op_sel:[0,1] op_sel_hi:[1,1]
s_waitcnt lgkmcnt(6)
v_pk_fma_f32 v[100:101], v[36:37], v[228:229], v[100:101] op_sel_hi:[1,0,1]
v_pk_mul_f32 v[100:101], v[100:101], v[228:229] op_sel:[0,1] op_sel_hi:[1,1]
v_pk_fma_f32 v[102:103], v[38:39], v[228:229], v[102:103] op_sel_hi:[1,0,1]
v_pk_mul_f32 v[102:103], v[102:103], v[228:229] op_sel:[0,1] op_sel_hi:[1,1]
v_pk_fma_f32 v[116:117], v[40:41], v[228:229], v[116:117] op_sel_hi:[1,0,1]
v_pk_mul_f32 v[116:117], v[116:117], v[228:229] op_sel:[0,1] op_sel_hi:[1,1]
s_waitcnt lgkmcnt(3)
v_pk_fma_f32 v[136:137], v[240:241], v[44:45], v[136:137] op_sel_hi:[1,0,1]
v_pk_fma_f32 v[138:139], v[242:243], v[44:45], v[138:139] op_sel_hi:[1,0,1]
v_pk_fma_f32 v[152:153], v[240:241], v[44:45], v[152:153] op_sel:[0,1,0] op_sel_hi:[1,1,1]
v_pk_fma_f32 v[154:155], v[242:243], v[44:45], v[154:155] op_sel:[0,1,0] op_sel_hi:[1,1,1]
s_waitcnt lgkmcnt(2)
v_pk_mul_f32 v[136:137], v[136:137], v[244:245]
v_pk_mul_f32 v[138:139], v[138:139], v[246:247]
v_pk_mul_f32 v[152:153], v[152:153], v[244:245]
v_pk_mul_f32 v[154:155], v[154:155], v[246:247]
v_pk_fma_f32 v[118:119], v[42:43], v[228:229], v[118:119] op_sel_hi:[1,0,1]
v_pk_mul_f32 v[118:119], v[118:119], v[228:229] op_sel:[0,1] op_sel_hi:[1,1]
v_pk_fma_f32 v[96:97], v[36:37], v[224:225], v[96:97] op_sel_hi:[1,0,1]
v_pk_mul_f32 v[96:97], v[96:97], v[224:225] op_sel:[0,1] op_sel_hi:[1,1]
v_pk_fma_f32 v[98:99], v[38:39], v[224:225], v[98:99] op_sel_hi:[1,0,1]
v_pk_mul_f32 v[98:99], v[98:99], v[224:225] op_sel:[0,1] op_sel_hi:[1,1]
v_pk_fma_f32 v[156:157], v[36:37], v[236:237], v[156:157] op_sel_hi:[1,0,1]
v_pk_mul_f32 v[156:157], v[156:157], v[236:237] op_sel:[0,1] op_sel_hi:[1,1]
v_pk_fma_f32 v[158:159], v[38:39], v[236:237], v[158:159] op_sel_hi:[1,0,1]
v_pk_mul_f32 v[158:159], v[158:159], v[236:237] op_sel:[0,1] op_sel_hi:[1,1]
v_pk_fma_f32 v[160:161], v[40:41], v[236:237], v[160:161] op_sel_hi:[1,0,1]
v_pk_mul_f32 v[160:161], v[160:161], v[236:237] op_sel:[0,1] op_sel_hi:[1,1]
v_pk_fma_f32 v[162:163], v[42:43], v[236:237], v[162:163] op_sel_hi:[1,0,1]
v_pk_mul_f32 v[162:163], v[162:163], v[236:237] op_sel:[0,1] op_sel_hi:[1,1]
v_cvt_pk_bf16_f32 v196, v104, v105
v_cvt_pk_bf16_f32 v197, v106, v107
v_mfma_f32_16x16x32_bf16 v[112:115], a[76:79], a[48:51], v[112:115]
buffer_load_dwordx4 v6, s[24:27], s58 offen offset:1024 lds
v_mfma_f32_16x16x32_bf16 v[92:95], a[72:75], a[44:47], v[92:95]
s_add_u32 m0, s59, 41600
v_cvt_pk_bf16_f32 v198, v120, v121
v_cvt_pk_bf16_f32 v199, v122, v123
v_mfma_f32_16x16x32_bf16 v[108:111], a[76:79], a[44:47], v[108:111]
ds_write_b128 v8, v[196:199]
v_cvt_pk_bf16_f32 v208, v136, v137
v_mfma_f32_16x16x32_bf16 v[72:75], a[64:67], a[56:59], v[72:75]
s_mov_b32 s58, 1703936
v_cvt_pk_bf16_f32 v209, v138, v139
v_cvt_pk_bf16_f32 v218, v152, v153
v_mfma_f32_16x16x32_bf16 v[88:91], a[68:71], a[56:59], v[88:91]
ds_write_b64 v8, v[208:209] offset:1024
v_cvt_pk_bf16_f32 v219, v154, v155
ds_write_b64 v8, v[218:219] offset:1032
v_cvt_pk_bf16_f32 v192, v100, v101
v_pk_fma_f32 v[72:73], v[28:29], v[232:233], v[72:73] op_sel_hi:[1,0,1]
v_pk_fma_f32 v[74:75], v[30:31], v[232:233], v[74:75] op_sel_hi:[1,0,1]
s_nop 1
v_pk_fma_f32 v[88:89], v[32:33], v[232:233], v[88:89] op_sel_hi:[1,0,1]
v_pk_fma_f32 v[90:91], v[34:35], v[232:233], v[90:91] op_sel_hi:[1,0,1]
v_pk_fma_f32 v[112:113], v[40:41], v[224:225], v[112:113] op_sel_hi:[1,0,1]
v_pk_mul_f32 v[112:113], v[112:113], v[224:225] op_sel:[0,1] op_sel_hi:[1,1]
v_pk_fma_f32 v[114:115], v[42:43], v[224:225], v[114:115] op_sel_hi:[1,0,1]
v_pk_mul_f32 v[114:115], v[114:115], v[224:225] op_sel:[0,1] op_sel_hi:[1,1]
v_pk_fma_f32 v[92:93], v[36:37], v[220:221], v[92:93] op_sel_hi:[1,0,1]
v_pk_mul_f32 v[92:93], v[92:93], v[220:221] op_sel:[0,1] op_sel_hi:[1,1]
v_pk_fma_f32 v[94:95], v[38:39], v[220:221], v[94:95] op_sel_hi:[1,0,1]
v_pk_mul_f32 v[94:95], v[94:95], v[220:221] op_sel:[0,1] op_sel_hi:[1,1]
v_pk_fma_f32 v[108:109], v[40:41], v[220:221], v[108:109] op_sel_hi:[1,0,1]
v_pk_mul_f32 v[108:109], v[108:109], v[220:221] op_sel:[0,1] op_sel_hi:[1,1]
v_pk_fma_f32 v[110:111], v[42:43], v[220:221], v[110:111] op_sel_hi:[1,0,1]
v_pk_mul_f32 v[110:111], v[110:111], v[220:221] op_sel:[0,1] op_sel_hi:[1,1]
v_cvt_pk_bf16_f32 v193, v102, v103
v_cvt_pk_bf16_f32 v194, v116, v117
v_mfma_f32_16x16x32_bf16 v[132:135], a[52:55], a[80:83], v[132:135]
buffer_load_dwordx4 v5, s[24:27], s58 offen lds
v_mfma_f32_16x16x32_bf16 v[148:151], a[52:55], a[84:87], v[148:151]
ds_read_b128 v[240:243], v11 offset:64
v_cvt_pk_bf16_f32 v195, v118, v119
v_mfma_f32_16x16x32_bf16 v[68:71], a[64:67], a[52:55], v[68:71]
ds_read_b128 v[244:247], v11 offset:1088
s_waitcnt lgkmcnt(2)
s_barrier
v_mfma_f32_16x16x32_bf16 v[84:87], a[68:71], a[52:55], v[84:87]
ds_read_b64 v[200:201], v9 offset:1024
v_cvt_pk_bf16_f32 v176, v72, v73
v_mfma_f32_16x16x32_bf16 v[128:131], a[48:51], a[80:83], v[128:131]
ds_read_b64 v[210:211], v9 offset:1032
buffer_load_dwordx4 v6, s[24:27], s58 offen offset:1024 lds
s_add_u32 m0, s59, 49920
v_pk_fma_f32 v[132:133], v[18:19], v[44:45], v[132:133] op_sel_hi:[1,0,1]
v_pk_mul_f32 v[132:133], v[132:133], v[22:23]
v_pk_fma_f32 v[134:135], v[20:21], v[44:45], v[134:135] op_sel_hi:[1,0,1]
v_pk_mul_f32 v[134:135], v[134:135], v[24:25]
v_pk_fma_f32 v[148:149], v[18:19], v[44:45], v[148:149] op_sel:[0,1,0] op_sel_hi:[1,1,1]
v_pk_mul_f32 v[148:149], v[148:149], v[22:23]
v_pk_fma_f32 v[150:151], v[20:21], v[44:45], v[150:151] op_sel:[0,1,0] op_sel_hi:[1,1,1]
v_pk_mul_f32 v[150:151], v[150:151], v[24:25]
v_pk_fma_f32 v[68:69], v[28:29], v[228:229], v[68:69] op_sel_hi:[1,0,1]
v_pk_fma_f32 v[70:71], v[30:31], v[228:229], v[70:71] op_sel_hi:[1,0,1]
v_pk_fma_f32 v[84:85], v[32:33], v[228:229], v[84:85] op_sel_hi:[1,0,1]
v_pk_fma_f32 v[86:87], v[34:35], v[228:229], v[86:87] op_sel_hi:[1,0,1]
s_mov_b32 s58, 1835008
v_cvt_pk_bf16_f32 v177, v74, v75
v_mfma_f32_16x16x32_bf16 v[144:147], a[48:51], a[84:87], v[144:147]
buffer_load_dwordx4 v5, s[24:27], s58 offen lds
v_mfma_f32_16x16x32_bf16 v[64:67], a[64:67], a[48:51], v[64:67]
ds_read_b128 v[18:21], v11
v_cvt_pk_bf16_f32 v178, v88, v89
v_mfma_f32_16x16x32_bf16 v[80:83], a[68:71], a[48:51], v[80:83]
ds_read_b128 v[22:25], v11 offset:1024
v_cvt_pk_bf16_f32 v179, v90, v91
v_mfma_f32_16x16x32_bf16 v[124:127], a[44:47], a[80:83], v[124:127]
v_cvt_pk_bf16_f32 v206, v132, v133
v_cvt_pk_bf16_f32 v207, v134, v135
v_cvt_pk_bf16_f32 v216, v148, v149
v_cvt_pk_bf16_f32 v217, v150, v151
v_cvt_pk_bf16_f32 v188, v96, v97
s_waitcnt lgkmcnt(5)
v_pk_fma_f32 v[128:129], v[240:241], v[44:45], v[128:129] op_sel_hi:[1,0,1]
s_waitcnt lgkmcnt(4)
v_pk_mul_f32 v[128:129], v[128:129], v[244:245]
v_pk_fma_f32 v[130:131], v[242:243], v[44:45], v[130:131] op_sel_hi:[1,0,1]
v_pk_mul_f32 v[130:131], v[130:131], v[246:247]
v_pk_fma_f32 v[144:145], v[240:241], v[44:45], v[144:145] op_sel:[0,1,0] op_sel_hi:[1,1,1]
v_pk_mul_f32 v[144:145], v[144:145], v[244:245]
v_pk_fma_f32 v[146:147], v[242:243], v[44:45], v[146:147] op_sel:[0,1,0] op_sel_hi:[1,1,1]
v_pk_mul_f32 v[146:147], v[146:147], v[246:247]
v_pk_fma_f32 v[64:65], v[28:29], v[224:225], v[64:65] op_sel_hi:[1,0,1]
v_pk_fma_f32 v[66:67], v[30:31], v[224:225], v[66:67] op_sel_hi:[1,0,1]
v_pk_fma_f32 v[80:81], v[32:33], v[224:225], v[80:81] op_sel_hi:[1,0,1]
v_pk_fma_f32 v[82:83], v[34:35], v[224:225], v[82:83] op_sel_hi:[1,0,1]
v_cvt_pk_bf16_f32 v189, v98, v99
v_cvt_pk_bf16_f32 v190, v112, v113
v_mfma_f32_16x16x32_bf16 v[140:143], a[44:47], a[84:87], v[140:143]
buffer_load_dwordx4 v6, s[24:27], s58 offen offset:1024 lds
v_mfma_f32_16x16x32_bf16 v[60:63], a[64:67], a[44:47], v[60:63]
s_add_u32 m0, s59, 116480
s_mov_b32 s58, 786432
v_cvt_pk_bf16_f32 v191, v114, v115
v_mfma_f32_16x16x32_bf16 v[76:79], a[68:71], a[44:47], v[76:79]
v_cvt_pk_bf16_f32 v172, v68, v69
v_cvt_pk_bf16_f32 v173, v70, v71
v_mfma_f32_16x16x32_bf16 v[104:107], v[192:195], v[176:179], v[46:49]
v_cvt_pk_bf16_f32 v174, v84, v85
v_cvt_pk_bf16_f32 v175, v86, v87
v_cvt_pk_bf16_f32 v204, v128, v129
v_cvt_pk_bf16_f32 v205, v130, v131
v_cvt_pk_bf16_f32 v214, v144, v145
s_waitcnt lgkmcnt(1)
v_pk_fma_f32 v[124:125], v[18:19], v[44:45], v[124:125] op_sel_hi:[1,0,1]
s_waitcnt lgkmcnt(0)
v_pk_mul_f32 v[124:125], v[124:125], v[22:23]
v_pk_fma_f32 v[126:127], v[20:21], v[44:45], v[126:127] op_sel_hi:[1,0,1]
v_pk_mul_f32 v[126:127], v[126:127], v[24:25]
v_pk_fma_f32 v[140:141], v[18:19], v[44:45], v[140:141] op_sel:[0,1,0] op_sel_hi:[1,1,1]
v_pk_mul_f32 v[140:141], v[140:141], v[22:23]
v_pk_fma_f32 v[142:143], v[20:21], v[44:45], v[142:143] op_sel:[0,1,0] op_sel_hi:[1,1,1]
v_pk_mul_f32 v[142:143], v[142:143], v[24:25]
v_pk_fma_f32 v[60:61], v[28:29], v[220:221], v[60:61] op_sel_hi:[1,0,1]
v_pk_fma_f32 v[62:63], v[30:31], v[220:221], v[62:63] op_sel_hi:[1,0,1]
.Lpad12:
s_cbranch_execz .Lpad15
v_pk_fma_f32 v[76:77], v[32:33], v[220:221], v[76:77] op_sel_hi:[1,0,1]
v_pk_fma_f32 v[78:79], v[34:35], v[220:221], v[78:79] op_sel_hi:[1,0,1]
v_max3_f32 v88, v104, v105, v106
v_cvt_pk_bf16_f32 v215, v146, v147
v_mfma_f32_16x16x32_bf16 v[120:123], v[196:199], v[176:179], v[50:53]
buffer_load_dwordx4 v5, s[24:27], s58 offen lds
v_mfma_f32_16x16x32_bf16 v[100:103], v[188:191], v[172:175], v[46:49]
v_cvt_pk_bf16_f32 v184, v92, v93
v_cvt_pk_bf16_f32 v185, v94, v95
v_mfma_f32_16x16x32_bf16 v[116:119], v[192:195], v[172:175], v[50:53]
s_nop 2
v_max3_f32 v89, v107, v120, v121
v_max3_f32 v88, v88, v122, v123
v_max_f32 v90, v88, v89
v_max_f32 v89, v88, v89
v_max3_f32 v84, v100, v101, v102
v_cvt_pk_bf16_f32 v186, v108, v109
v_permlane16_swap_b32 v90, v89
v_max3_f32 v85, v103, v116, v117
buffer_load_dwordx4 v6, s[24:27], s58 offen offset:1024 lds
s_add_u32 m0, s59, 124800
s_mov_b32 s58, 917504
v_max_f32 v88, v90, v89
v_max_f32 v89, v90, v89
v_max3_f32 v84, v84, v118, v119
v_max_f32 v86, v84, v85
v_permlane32_swap_b32 v88, v89
v_max_f32 v85, v84, v85
v_max_f32 v88, v88, v89
v_mul_f32 v88, v88, v234
v_pk_fma_f32 v[104:105], v[104:105], v[234:235], v[88:89] op_sel_hi:[1,0,0] neg_lo:[0,0,1] neg_hi:[0,0,1]
v_pk_fma_f32 v[106:107], v[106:107], v[234:235], v[88:89] op_sel_hi:[1,0,0] neg_lo:[0,0,1] neg_hi:[0,0,1]
buffer_load_dwordx4 v5, s[24:27], s58 offen lds
v_pk_fma_f32 v[120:121], v[120:121], v[234:235], v[88:89] op_sel_hi:[1,0,0] neg_lo:[0,0,1] neg_hi:[0,0,1]
v_pk_fma_f32 v[122:123], v[122:123], v[234:235], v[88:89] op_sel_hi:[1,0,0] neg_lo:[0,0,1] neg_hi:[0,0,1]
v_exp_f32 v104, v104
v_exp_f32 v105, v105
v_exp_f32 v106, v106
v_exp_f32 v107, v107
v_exp_f32 v120, v120
v_exp_f32 v121, v121
v_exp_f32 v122, v122
v_exp_f32 v123, v123
v_cvt_pk_bf16_f32 v72, v104, v105
buffer_load_dwordx4 v6, s[24:27], s58 offen offset:1024 lds
v_cvt_pk_bf16_f32 v73, v106, v107
v_cvt_pk_bf16_f32 v74, v120, v121
v_cvt_pk_bf16_f32 v75, v122, v123
v_permlane16_swap_b32 v86, v85
s_nop 0
v_mfma_f32_16x16x32_bf16 v[88:91], v[248:251], v[72:75], 0
v_max_f32 v84, v86, v85
v_max_f32 v85, v86, v85
v_mfma_f32_16x16x32_bf16 v[104:107], v[206:209], v[72:75], 0
s_nop 0
v_permlane32_swap_b32 v84, v85
v_mfma_f32_16x16x32_bf16 v[120:123], v[216:219], v[72:75], 0
s_nop 1
v_rcp_f32 v88, v88
v_max_f32 v84, v84, v85
v_mul_f32 v84, v84, v230
v_cvt_pk_bf16_f32 v187, v110, v111
v_pk_mul_f32 v[104:105], v[104:105], v[88:89] op_sel_hi:[1,0]
v_pk_mul_f32 v[106:107], v[106:107], v[88:89] op_sel_hi:[1,0]
v_pk_mul_f32 v[120:121], v[120:121], v[88:89] op_sel_hi:[1,0]
v_pk_mul_f32 v[122:123], v[122:123], v[88:89] op_sel_hi:[1,0]
v_cvt_pk_bf16_f32 v176, v104, v105
v_cvt_pk_bf16_f32 v177, v106, v107
v_cvt_pk_bf16_f32 v178, v120, v121
v_cvt_pk_bf16_f32 v179, v122, v123
buffer_store_dwordx4 v[176:179], v4, s[16:19], s74 offen offset:3072 sc1
v_pk_fma_f32 v[100:101], v[100:101], v[230:231], v[84:85] op_sel_hi:[1,0,0] neg_lo:[0,0,1] neg_hi:[0,0,1]
v_pk_fma_f32 v[102:103], v[102:103], v[230:231], v[84:85] op_sel_hi:[1,0,0] neg_lo:[0,0,1] neg_hi:[0,0,1]
v_pk_fma_f32 v[116:117], v[116:117], v[230:231], v[84:85] op_sel_hi:[1,0,0] neg_lo:[0,0,1] neg_hi:[0,0,1]
v_pk_fma_f32 v[118:119], v[118:119], v[230:231], v[84:85] op_sel_hi:[1,0,0] neg_lo:[0,0,1] neg_hi:[0,0,1]
v_exp_f32 v100, v100
v_exp_f32 v101, v101
v_exp_f32 v102, v102
v_exp_f32 v103, v103
v_exp_f32 v116, v116
v_exp_f32 v117, v117
v_exp_f32 v118, v118
v_exp_f32 v119, v119
v_cvt_pk_bf16_f32 v68, v100, v101
v_cvt_pk_bf16_f32 v69, v102, v103
v_cvt_pk_bf16_f32 v70, v116, v117
v_cvt_pk_bf16_f32 v71, v118, v119
v_cvt_pk_bf16_f32 v168, v64, v65
v_cvt_pk_bf16_f32 v169, v66, v67
v_mfma_f32_16x16x32_bf16 v[84:87], v[248:251], v[68:71], 0
v_cvt_pk_bf16_f32 v170, v80, v81
v_cvt_pk_bf16_f32 v171, v82, v83
v_mfma_f32_16x16x32_bf16 v[100:103], v[204:207], v[68:71], 0
v_cvt_pk_bf16_f32 v202, v124, v125
v_cvt_pk_bf16_f32 v203, v126, v127
v_mfma_f32_16x16x32_bf16 v[116:119], v[214:217], v[68:71], 0
s_nop 1
v_rcp_f32 v84, v84
v_mfma_f32_16x16x32_bf16 v[96:99], v[184:187], v[168:171], v[46:49]
v_cvt_pk_bf16_f32 v212, v140, v141
v_cvt_pk_bf16_f32 v213, v142, v143
v_mfma_f32_16x16x32_bf16 v[112:115], v[188:191], v[168:171], v[50:53]
v_cvt_pk_bf16_f32 v180, v156, v157
v_cvt_pk_bf16_f32 v181, v158, v159
v_cvt_pk_bf16_f32 v182, v160, v161
s_nop 1
v_max3_f32 v80, v96, v97, v98
v_cvt_pk_bf16_f32 v183, v162, v163
v_pk_mul_f32 v[100:101], v[100:101], v[84:85] op_sel_hi:[1,0]
v_pk_mul_f32 v[102:103], v[102:103], v[84:85] op_sel_hi:[1,0]
v_pk_mul_f32 v[116:117], v[116:117], v[84:85] op_sel_hi:[1,0]
v_pk_mul_f32 v[118:119], v[118:119], v[84:85] op_sel_hi:[1,0]
v_cvt_pk_bf16_f32 v172, v100, v101
v_cvt_pk_bf16_f32 v173, v102, v103
v_cvt_pk_bf16_f32 v174, v116, v117
v_cvt_pk_bf16_f32 v175, v118, v119
buffer_store_dwordx4 v[172:175], v4, s[16:19], s74 offen offset:2048 sc1
v_max3_f32 v81, v99, v112, v113
v_max3_f32 v80, v80, v114, v115
v_max_f32 v82, v80, v81
v_max_f32 v81, v80, v81
v_cvt_pk_bf16_f32 v164, v60, v61
v_cvt_pk_bf16_f32 v165, v62, v63
v_permlane16_swap_b32 v82, v81
v_cvt_pk_bf16_f32 v166, v76, v77
v_max_f32 v80, v82, v81
v_max_f32 v81, v82, v81
v_cvt_pk_bf16_f32 v167, v78, v79
s_nop 0
v_permlane32_swap_b32 v80, v81
v_mfma_f32_16x16x32_bf16 v[92:95], v[180:183], v[164:167], v[54:57]
v_max_f32 v80, v80, v81
v_mul_f32 v80, v80, v226
v_mfma_f32_16x16x32_bf16 v[108:111], v[184:187], v[164:167], v[50:53]
s_nop 4
v_max3_f32 v76, v92, v93, v94
v_pk_fma_f32 v[96:97], v[96:97], v[226:227], v[80:81] op_sel_hi:[1,0,0] neg_lo:[0,0,1] neg_hi:[0,0,1]
v_pk_fma_f32 v[98:99], v[98:99], v[226:227], v[80:81] op_sel_hi:[1,0,0] neg_lo:[0,0,1] neg_hi:[0,0,1]
v_pk_fma_f32 v[112:113], v[112:113], v[226:227], v[80:81] op_sel_hi:[1,0,0] neg_lo:[0,0,1] neg_hi:[0,0,1]
v_pk_fma_f32 v[114:115], v[114:115], v[226:227], v[80:81] op_sel_hi:[1,0,0] neg_lo:[0,0,1] neg_hi:[0,0,1]
v_exp_f32 v96, v96
v_exp_f32 v97, v97
v_exp_f32 v98, v98
v_exp_f32 v99, v99
v_exp_f32 v112, v112
v_exp_f32 v113, v113
v_exp_f32 v114, v114
v_exp_f32 v115, v115
v_cvt_pk_bf16_f32 v64, v96, v97
v_cvt_pk_bf16_f32 v65, v98, v99
v_cvt_pk_bf16_f32 v66, v112, v113
v_cvt_pk_bf16_f32 v67, v114, v115
v_max3_f32 v77, v95, v108, v109
v_max3_f32 v76, v76, v110, v111
v_mfma_f32_16x16x32_bf16 v[80:83], v[248:251], v[64:67], 0
v_max_f32 v78, v76, v77
v_max_f32 v77, v76, v77
v_mfma_f32_16x16x32_bf16 v[96:99], v[202:205], v[64:67], 0
s_nop 0
v_permlane16_swap_b32 v78, v77
v_mfma_f32_16x16x32_bf16 v[112:115], v[212:215], v[64:67], 0
s_nop 1
v_rcp_f32 v80, v80
v_max_f32 v76, v78, v77
v_max_f32 v77, v78, v77
v_pk_mul_f32 v[96:97], v[96:97], v[80:81] op_sel_hi:[1,0]
v_pk_mul_f32 v[98:99], v[98:99], v[80:81] op_sel_hi:[1,0]
s_nop 0
v_pk_mul_f32 v[112:113], v[112:113], v[80:81] op_sel_hi:[1,0]
v_pk_mul_f32 v[114:115], v[114:115], v[80:81] op_sel_hi:[1,0]
v_cvt_pk_bf16_f32 v168, v96, v97
v_cvt_pk_bf16_f32 v169, v98, v99
v_cvt_pk_bf16_f32 v170, v112, v113
v_cvt_pk_bf16_f32 v171, v114, v115
buffer_store_dwordx4 v[168:171], v4, s[16:19], s74 offen offset:1024 sc1
v_permlane32_swap_b32 v76, v77
v_max_f32 v76, v76, v77
v_mul_f32 v76, v76, v222
v_pk_fma_f32 v[92:93], v[92:93], v[222:223], v[76:77] op_sel_hi:[1,0,0] neg_lo:[0,0,1] neg_hi:[0,0,1]
v_pk_fma_f32 v[94:95], v[94:95], v[222:223], v[76:77] op_sel_hi:[1,0,0] neg_lo:[0,0,1] neg_hi:[0,0,1]
v_pk_fma_f32 v[108:109], v[108:109], v[222:223], v[76:77] op_sel_hi:[1,0,0] neg_lo:[0,0,1] neg_hi:[0,0,1]
v_pk_fma_f32 v[110:111], v[110:111], v[222:223], v[76:77] op_sel_hi:[1,0,0] neg_lo:[0,0,1] neg_hi:[0,0,1]
v_exp_f32 v92, v92
v_exp_f32 v93, v93
v_exp_f32 v94, v94
v_exp_f32 v95, v95
v_exp_f32 v108, v108
v_exp_f32 v109, v109
v_exp_f32 v110, v110
v_exp_f32 v111, v111
v_cvt_pk_bf16_f32 v60, v92, v93
v_cvt_pk_bf16_f32 v61, v94, v95
v_cvt_pk_bf16_f32 v62, v108, v109
v_cvt_pk_bf16_f32 v63, v110, v111
s_nop 1
v_mfma_f32_16x16x32_bf16 v[76:79], v[248:251], v[60:63], 0
v_mfma_f32_16x16x32_bf16 v[92:95], v[200:203], v[60:63], 0
v_mfma_f32_16x16x32_bf16 v[108:111], v[210:213], v[60:63], 0
s_nop 5
v_rcp_f32 v76, v76
s_nop 0
v_pk_mul_f32 v[92:93], v[92:93], v[76:77] op_sel_hi:[1,0]
v_pk_mul_f32 v[94:95], v[94:95], v[76:77] op_sel_hi:[1,0]
v_pk_mul_f32 v[108:109], v[108:109], v[76:77] op_sel_hi:[1,0]
v_pk_mul_f32 v[110:111], v[110:111], v[76:77] op_sel_hi:[1,0]
v_cvt_pk_bf16_f32 v164, v92, v93
v_cvt_pk_bf16_f32 v165, v94, v95
v_cvt_pk_bf16_f32 v166, v108, v109
v_cvt_pk_bf16_f32 v167, v110, v111
buffer_store_dwordx4 v[164:167], v4, s[16:19], s74 offen sc1
s_nop 1
s_branch .Lqkve61
.Lpad13:
s_cbranch_execz .Lpad16
.Lxs54:
s_mov_b32 s15, 0
.Lxs54l:
v_mov_b32 v15, 0
buffer_atomic_add v15, v12, s[16:19], s70 offen sc0
s_add_u32 s15, s15, 1
s_cmp_gt_u32 s15, 100000
s_waitcnt vmcnt(0)
s_cbranch_scc1 .Lxs54b
v_cmp_ne_u32 vcc, 0, v15
s_nop 0
s_cbranch_vccz .Lxs54l
s_branch .Lxs54b
.Lqkv60:
.Lpad14:
s_cbranch_execz .Lpad17
s_add_u32 m0, s55, 36864
s_nop 0
buffer_load_dwordx4 v21, s[16:19], s52 offen sc1 lds
buffer_load_dwordx4 v21, s[16:19], s52 offen offset:1024 sc1 lds
buffer_load_dword v22, s[16:19], s52 offen offset:2048 sc1 lds
s_add_u32 s52, s52, 0x20000
s_add_u32 m0, s55, 46080
s_nop 0
buffer_load_dwordx4 v21, s[16:19], s52 offen sc1 lds
buffer_load_dwordx4 v21, s[16:19], s52 offen offset:1024 sc1 lds
buffer_load_dword v22, s[16:19], s52 offen offset:2048 sc1 lds
s_add_u32 s52, s52, 0x20000
s_add_u32 m0, s55, 0
s_nop 0
buffer_load_dwordx4 v21, s[16:19], s52 offen sc1 lds
buffer_load_dwordx4 v21, s[16:19], s52 offen offset:1024 sc1 lds
buffer_load_dword v22, s[16:19], s52 offen offset:2048 sc1 lds
s_add_u32 s52, s52, 0x20000
s_add_u32 m0, s55, 9216
s_nop 0
buffer_load_dwordx4 v21, s[16:19], s52 offen sc1 lds
buffer_load_dwordx4 v21, s[16:19], s52 offen offset:1024 sc1 lds
buffer_load_dword v22, s[16:19], s52 offen offset:2048 sc1 lds
s_add_u32 s52, s52, 0x20000
s_add_u32 m0, s55, 18432
s_nop 0
buffer_load_dwordx4 v21, s[16:19], s52 offen sc1 lds
buffer_load_dwordx4 v21, s[16:19], s52 offen offset:1024 sc1 lds
buffer_load_dword v22, s[16:19], s52 offen offset:2048 sc1 lds
s_add_u32 s52, s52, 0x20000
s_waitcnt vmcnt(12)
s_barrier
ds_read_b128 a[0:3], v23 offset:36864
ds_read_b128 a[4:7], v23 offset:37888
ds_read_b128 a[8:11], v23 offset:39168
ds_read_b128 a[12:15], v23 offset:40192
ds_read_b128 a[16:19], v24 offset:38912
s_waitcnt lgkmcnt(0)
s_mov_b32 s15, -4
.p2align 6
.Lk63:
s_waitcnt vmcnt(9) lgkmcnt(8)
s_barrier
v_mfma_f32_16x16x32_bf16 v[60:63], a[20:23], a[0:3], v[60:63]
ds_read_b128 a[44:47], v23 offset:46080
v_add_f32 v164, v164, v168
v_mfma_f32_16x16x32_bf16 v[76:79], a[24:27], a[0:3], v[76:79]
ds_read_b128 a[48:51], v23 offset:47104
s_add_u32 m0, s56, 104832
v_mfma_f32_16x16x32_bf16 v[80:83], a[24:27], a[4:7], v[80:83]
buffer_load_dwordx4 v18, s[20:23], s54 offen lds
v_mfma_f32_16x16x32_bf16 v[64:67], a[20:23], a[4:7], v[64:67]
ds_read_b128 a[52:55], v23 offset:48384
v_mfma_f32_16x16x32_bf16 v[68:71], a[20:23], a[8:11], v[68:71]
ds_read_b128 a[56:59], v23 offset:49408
v_mfma_f32_16x16x32_bf16 v[84:87], a[24:27], a[8:11], v[84:87]
buffer_load_dwordx4 v19, s[20:23], s54 offen offset:1024 lds
v_mfma_f32_16x16x32_bf16 v[88:91], a[24:27], a[12:15], v[88:91]
ds_read_b64_tr_b16 a[64:65], v25 offset:62080
v_add_f32 v165, v165, v169
v_mfma_f32_16x16x32_bf16 v[72:75], a[20:23], a[12:15], v[72:75]
ds_read_b64_tr_b16 a[66:67], v25 offset:62592
s_waitcnt lgkmcnt(6)
v_mfma_f32_16x16x32_bf16 v[104:107], a[28:31], a[12:15], v[104:107]
buffer_load_dwordx4 v20, s[20:23], s54 offen offset:2048 lds
v_mfma_f32_16x16x32_bf16 v[120:123], a[32:35], a[12:15], v[120:123]
ds_read_b64_tr_b16 a[68:69], v25 offset:62112
s_add_u32 s54, s54, 196608
v_mfma_f32_16x16x32_bf16 v[116:119], a[32:35], a[8:11], v[116:119]
ds_read_b64_tr_b16 a[70:71], v25 offset:62624
v_mfma_f32_16x16x32_bf16 v[100:103], a[28:31], a[8:11], v[100:103]
ds_read_b128 a[60:63], v24 offset:48128
s_add_u32 m0, s55, 27648
v_mfma_f32_16x16x32_bf16 v[96:99], a[28:31], a[4:7], v[96:99]
buffer_load_dwordx4 v21, s[16:19], s52 offen sc1 lds
v_mfma_f32_16x16x32_bf16 v[112:115], a[32:35], a[4:7], v[112:115]
ds_read_b64_tr_b16 a[72:73], v25 offset:63104
v_mfma_f32_16x16x32_bf16 v[108:111], a[32:35], a[0:3], v[108:111]
ds_read_b64_tr_b16 a[74:75], v25 offset:63616
v_add_f32 v166, v166, v170
v_mfma_f32_16x16x32_bf16 v[92:95], a[28:31], a[0:3], v[92:95]
buffer_load_dwordx4 v21, s[16:19], s52 offen offset:1024 sc1 lds
v_mfma_f32_16x16x32_bf16 v[124:127], a[0:3], a[36:39], v[124:127]
ds_read_b64_tr_b16 a[76:77], v25 offset:63136
v_mfma_f32_16x16x32_bf16 v[140:143], a[0:3], a[40:43], v[140:143]
ds_read_b64_tr_b16 a[78:79], v25 offset:63648
v_mfma_f32_16x16x32_bf16 v[144:147], a[4:7], a[40:43], v[144:147]
ds_read_b64_tr_b16 a[80:81], v25 offset:64128
v_add_f32 v167, v167, v171
v_mfma_f32_16x16x32_bf16 v[128:131], a[4:7], a[36:39], v[128:131]
buffer_load_dword v22, s[16:19], s52 offen offset:2048 sc1 lds
v_mfma_f32_16x16x32_bf16 v[132:135], a[8:11], a[36:39], v[132:135]
ds_read_b64_tr_b16 a[82:83], v25 offset:64640
s_add_u32 s52, s52, 0x20000
v_mfma_f32_16x16x32_bf16 v[148:151], a[8:11], a[40:43], v[148:151]
ds_read_b64_tr_b16 a[84:85], v25 offset:64160
v_mfma_f32_16x16x32_bf16 v[152:155], a[12:15], a[40:43], v[152:155]
buffer_load_dword v27, v14, s[20:23], s44 offen
v_mfma_f32_16x16x32_bf16 v[136:139], a[12:15], a[36:39], v[136:139]
ds_read_b64_tr_b16 a[86:87], v25 offset:64672
s_add_u32 s44, s44, 1572864
v_mfma_f32_16x16x32_bf16 v[156:159], a[16:19], a[36:39], v[156:159]
v_mfma_f32_16x16x32_bf16 v[160:163], a[16:19], a[40:43], v[160:163]
s_waitcnt vmcnt(13) lgkmcnt(8)
s_barrier
v_mfma_f32_16x16x32_bf16 v[60:63], a[64:67], a[44:47], v[60:63]
ds_read_b128 a[0:3], v23
v_mfma_f32_16x16x32_bf16 v[76:79], a[68:71], a[44:47], v[76:79]
ds_read_b128 a[4:7], v23 offset:1024
s_add_u32 m0, s56, 117248
v_mfma_f32_16x16x32_bf16 v[80:83], a[68:71], a[48:51], v[80:83]
buffer_load_dwordx4 v18, s[20:23], s54 offen lds
v_mfma_f32_16x16x32_bf16 v[64:67], a[64:67], a[48:51], v[64:67]
ds_read_b128 a[8:11], v23 offset:2304
v_mfma_f32_16x16x32_bf16 v[68:71], a[64:67], a[52:55], v[68:71]
ds_read_b128 a[12:15], v23 offset:3328
v_mfma_f32_16x16x32_bf16 v[84:87], a[68:71], a[52:55], v[84:87]
buffer_load_dwordx4 v19, s[20:23], s54 offen offset:1024 lds
v_mfma_f32_16x16x32_bf16 v[88:91], a[68:71], a[56:59], v[88:91]
ds_read_b64_tr_b16 a[20:21], v25
v_mfma_f32_16x16x32_bf16 v[72:75], a[64:67], a[56:59], v[72:75]
ds_read_b64_tr_b16 a[22:23], v25 offset:512
s_waitcnt lgkmcnt(6)
v_mfma_f32_16x16x32_bf16 v[104:107], a[72:75], a[56:59], v[104:107]
buffer_load_dwordx4 v20, s[20:23], s54 offen offset:2048 lds
v_mfma_f32_16x16x32_bf16 v[120:123], a[76:79], a[56:59], v[120:123]
ds_read_b64_tr_b16 a[24:25], v25 offset:32
s_add_u32 s54, s54, 196608
v_mfma_f32_16x16x32_bf16 v[116:119], a[76:79], a[52:55], v[116:119]
ds_read_b64_tr_b16 a[26:27], v25 offset:544
v_mfma_f32_16x16x32_bf16 v[100:103], a[72:75], a[52:55], v[100:103]
ds_read_b128 a[16:19], v24 offset:2048
s_add_u32 m0, s55, 36864
v_mfma_f32_16x16x32_bf16 v[96:99], a[72:75], a[48:51], v[96:99]
buffer_load_dwordx4 v21, s[16:19], s52 offen sc1 lds
v_mfma_f32_16x16x32_bf16 v[112:115], a[76:79], a[48:51], v[112:115]
ds_read_b64_tr_b16 a[28:29], v25 offset:1024
v_mfma_f32_16x16x32_bf16 v[108:111], a[76:79], a[44:47], v[108:111]
ds_read_b64_tr_b16 a[30:31], v25 offset:1536
v_mfma_f32_16x16x32_bf16 v[92:95], a[72:75], a[44:47], v[92:95]
buffer_load_dwordx4 v21, s[16:19], s52 offen offset:1024 sc1 lds
v_mfma_f32_16x16x32_bf16 v[124:127], a[44:47], a[80:83], v[124:127]
ds_read_b64_tr_b16 a[32:33], v25 offset:1056
v_mfma_f32_16x16x32_bf16 v[140:143], a[44:47], a[84:87], v[140:143]
ds_read_b64_tr_b16 a[34:35], v25 offset:1568
v_mfma_f32_16x16x32_bf16 v[144:147], a[48:51], a[84:87], v[144:147]
ds_read_b64_tr_b16 a[36:37], v25 offset:2048
v_mfma_f32_16x16x32_bf16 v[128:131], a[48:51], a[80:83], v[128:131]
buffer_load_dword v22, s[16:19], s52 offen offset:2048 sc1 lds
v_mfma_f32_16x16x32_bf16 v[132:135], a[52:55], a[80:83], v[132:135]
ds_read_b64_tr_b16 a[38:39], v25 offset:2560
s_add_u32 s52, s52, 0x20000
v_mfma_f32_16x16x32_bf16 v[148:151], a[52:55], a[84:87], v[148:151]
ds_read_b64_tr_b16 a[40:41], v25 offset:2080
v_mfma_f32_16x16x32_bf16 v[152:155], a[56:59], a[84:87], v[152:155]
buffer_load_dwordx4 v[168:171], v26, s[16:19], s75 offen sc1
v_mfma_f32_16x16x32_bf16 v[136:139], a[56:59], a[80:83], v[136:139]
ds_read_b64_tr_b16 a[42:43], v25 offset:2592
v_mfma_f32_16x16x32_bf16 v[156:159], a[60:63], a[80:83], v[156:159]
v_mfma_f32_16x16x32_bf16 v[160:163], a[60:63], a[84:87], v[160:163]
s_waitcnt vmcnt(17) lgkmcnt(8)
s_barrier
v_mfma_f32_16x16x32_bf16 v[60:63], a[20:23], a[0:3], v[60:63]
ds_read_b128 a[44:47], v23 offset:9216
v_mfma_f32_16x16x32_bf16 v[76:79], a[24:27], a[0:3], v[76:79]
ds_read_b128 a[48:51], v23 offset:10240
s_add_u32 m0, s56, 129664
v_mfma_f32_16x16x32_bf16 v[80:83], a[24:27], a[4:7], v[80:83]
buffer_load_dwordx4 v18, s[20:23], s54 offen lds
v_mfma_f32_16x16x32_bf16 v[64:67], a[20:23], a[4:7], v[64:67]
ds_read_b128 a[52:55], v23 offset:11520
v_mfma_f32_16x16x32_bf16 v[68:71], a[20:23], a[8:11], v[68:71]
ds_read_b128 a[56:59], v23 offset:12544
v_mfma_f32_16x16x32_bf16 v[84:87], a[24:27], a[8:11], v[84:87]
ds_read_b64_tr_b16 a[64:65], v25 offset:12416
v_mfma_f32_16x16x32_bf16 v[88:91], a[24:27], a[12:15], v[88:91]
buffer_load_dwordx4 v19, s[20:23], s54 offen offset:1024 lds
v_mfma_f32_16x16x32_bf16 v[72:75], a[20:23], a[12:15], v[72:75]
ds_read_b64_tr_b16 a[66:67], v25 offset:12928
s_waitcnt lgkmcnt(6)
v_mfma_f32_16x16x32_bf16 v[104:107], a[28:31], a[12:15], v[104:107]
ds_read_b64_tr_b16 a[68:69], v25 offset:12448
v_mfma_f32_16x16x32_bf16 v[120:123], a[32:35], a[12:15], v[120:123]
ds_read_b64_tr_b16 a[70:71], v25 offset:12960
v_mfma_f32_16x16x32_bf16 v[116:119], a[32:35], a[8:11], v[116:119]
buffer_load_dwordx4 v20, s[20:23], s54 offen offset:2048 lds
v_mfma_f32_16x16x32_bf16 v[100:103], a[28:31], a[8:11], v[100:103]
ds_read_b128 a[60:63], v24 offset:11264
s_add_u32 s54, s54, 196608
v_mfma_f32_16x16x32_bf16 v[96:99], a[28:31], a[4:7], v[96:99]
v_mfma_f32_16x16x32_bf16 v[112:115], a[32:35], a[4:7], v[112:115]
ds_read_b64_tr_b16 a[72:73], v25 offset:13440
s_add_u32 m0, s55, 46080
v_mfma_f32_16x16x32_bf16 v[108:111], a[32:35], a[0:3], v[108:111]
buffer_load_dwordx4 v21, s[16:19], s52 offen sc1 lds
v_mfma_f32_16x16x32_bf16 v[92:95], a[28:31], a[0:3], v[92:95]
ds_read_b64_tr_b16 a[74:75], v25 offset:13952
v_mfma_f32_16x16x32_bf16 v[124:127], a[0:3], a[36:39], v[124:127]
ds_read_b64_tr_b16 a[76:77], v25 offset:13472
v_mfma_f32_16x16x32_bf16 v[140:143], a[0:3], a[40:43], v[140:143]
ds_read_b64_tr_b16 a[78:79], v25 offset:13984
v_mfma_f32_16x16x32_bf16 v[144:147], a[4:7], a[40:43], v[144:147]
buffer_load_dwordx4 v21, s[16:19], s52 offen offset:1024 sc1 lds
v_mfma_f32_16x16x32_bf16 v[128:131], a[4:7], a[36:39], v[128:131]
ds_read_b64_tr_b16 a[80:81], v25 offset:14464
v_mfma_f32_16x16x32_bf16 v[132:135], a[8:11], a[36:39], v[132:135]
ds_read_b64_tr_b16 a[82:83], v25 offset:14976
v_mfma_f32_16x16x32_bf16 v[148:151], a[8:11], a[40:43], v[148:151]
ds_read_b64_tr_b16 a[84:85], v25 offset:14496
v_mfma_f32_16x16x32_bf16 v[152:155], a[12:15], a[40:43], v[152:155]
buffer_load_dword v22, s[16:19], s52 offen offset:2048 sc1 lds
v_mfma_f32_16x16x32_bf16 v[136:139], a[12:15], a[36:39], v[136:139]
ds_read_b64_tr_b16 a[86:87], v25 offset:15008
s_add_u32 s52, s52, 0x20000
v_mfma_f32_16x16x32_bf16 v[156:159], a[16:19], a[36:39], v[156:159]
v_mfma_f32_16x16x32_bf16 v[160:163], a[16:19], a[40:43], v[160:163]
s_waitcnt vmcnt(20) lgkmcnt(8)
s_barrier
v_mfma_f32_16x16x32_bf16 v[60:63], a[64:67], a[44:47], v[60:63]
ds_read_b128 a[0:3], v23 offset:18432
v_add_f32 v164, v164, v172
v_mfma_f32_16x16x32_bf16 v[76:79], a[68:71], a[44:47], v[76:79]
ds_read_b128 a[4:7], v23 offset:19456
s_add_u32 m0, s56, 67584
v_mfma_f32_16x16x32_bf16 v[80:83], a[68:71], a[48:51], v[80:83]
buffer_load_dwordx4 v18, s[20:23], s54 offen lds
v_mfma_f32_16x16x32_bf16 v[64:67], a[64:67], a[48:51], v[64:67]
ds_read_b128 a[8:11], v23 offset:20736
v_mfma_f32_16x16x32_bf16 v[68:71], a[64:67], a[52:55], v[68:71]
ds_read_b128 a[12:15], v23 offset:21760
v_mfma_f32_16x16x32_bf16 v[84:87], a[68:71], a[52:55], v[84:87]
ds_read_b64_tr_b16 a[20:21], v25 offset:24832
v_mfma_f32_16x16x32_bf16 v[88:91], a[68:71], a[56:59], v[88:91]
buffer_load_dwordx4 v19, s[20:23], s54 offen offset:1024 lds
v_mfma_f32_16x16x32_bf16 v[72:75], a[64:67], a[56:59], v[72:75]
ds_read_b64_tr_b16 a[22:23], v25 offset:25344
s_waitcnt lgkmcnt(6)
v_mfma_f32_16x16x32_bf16 v[104:107], a[72:75], a[56:59], v[104:107]
ds_read_b64_tr_b16 a[24:25], v25 offset:24864
v_add_f32 v165, v165, v173
v_mfma_f32_16x16x32_bf16 v[120:123], a[76:79], a[56:59], v[120:123]
ds_read_b64_tr_b16 a[26:27], v25 offset:25376
v_mfma_f32_16x16x32_bf16 v[116:119], a[76:79], a[52:55], v[116:119]
buffer_load_dwordx4 v20, s[20:23], s54 offen offset:2048 lds
v_mfma_f32_16x16x32_bf16 v[100:103], a[72:75], a[52:55], v[100:103]
ds_read_b128 a[16:19], v24 offset:20480
s_add_u32 s54, s54, 196608
v_mfma_f32_16x16x32_bf16 v[96:99], a[72:75], a[48:51], v[96:99]
v_mfma_f32_16x16x32_bf16 v[112:115], a[76:79], a[48:51], v[112:115]
ds_read_b64_tr_b16 a[28:29], v25 offset:25856
s_add_u32 m0, s55, 0
v_mfma_f32_16x16x32_bf16 v[108:111], a[76:79], a[44:47], v[108:111]
buffer_load_dwordx4 v21, s[16:19], s52 offen sc1 lds
v_mfma_f32_16x16x32_bf16 v[92:95], a[72:75], a[44:47], v[92:95]
ds_read_b64_tr_b16 a[30:31], v25 offset:26368
v_add_f32 v166, v166, v174
v_mfma_f32_16x16x32_bf16 v[124:127], a[44:47], a[80:83], v[124:127]
ds_read_b64_tr_b16 a[32:33], v25 offset:25888
v_mfma_f32_16x16x32_bf16 v[140:143], a[44:47], a[84:87], v[140:143]
ds_read_b64_tr_b16 a[34:35], v25 offset:26400
v_mfma_f32_16x16x32_bf16 v[144:147], a[48:51], a[84:87], v[144:147]
buffer_load_dwordx4 v21, s[16:19], s52 offen offset:1024 sc1 lds
v_mfma_f32_16x16x32_bf16 v[128:131], a[48:51], a[80:83], v[128:131]
ds_read_b64_tr_b16 a[36:37], v25 offset:26880
v_mfma_f32_16x16x32_bf16 v[132:135], a[52:55], a[80:83], v[132:135]
ds_read_b64_tr_b16 a[38:39], v25 offset:27392
v_add_f32 v167, v167, v175
v_mfma_f32_16x16x32_bf16 v[148:151], a[52:55], a[84:87], v[148:151]
ds_read_b64_tr_b16 a[40:41], v25 offset:26912
v_mfma_f32_16x16x32_bf16 v[152:155], a[56:59], a[84:87], v[152:155]
buffer_load_dword v22, s[16:19], s52 offen offset:2048 sc1 lds
v_mfma_f32_16x16x32_bf16 v[136:139], a[56:59], a[80:83], v[136:139]
ds_read_b64_tr_b16 a[42:43], v25 offset:27424
s_add_u32 s52, s52, 0x20000
v_mfma_f32_16x16x32_bf16 v[156:159], a[60:63], a[80:83], v[156:159]
v_mfma_f32_16x16x32_bf16 v[160:163], a[60:63], a[84:87], v[160:163]
s_waitcnt vmcnt(20) lgkmcnt(8)
s_barrier
v_mfma_f32_16x16x32_bf16 v[60:63], a[20:23], a[0:3], v[60:63]
ds_read_b128 a[44:47], v23 offset:27648
v_mfma_f32_16x16x32_bf16 v[76:79], a[24:27], a[0:3], v[76:79]
ds_read_b128 a[48:51], v23 offset:28672
s_add_u32 m0, s56, 80000
v_mfma_f32_16x16x32_bf16 v[80:83], a[24:27], a[4:7], v[80:83]
buffer_load_dwordx4 v18, s[20:23], s54 offen lds
v_mfma_f32_16x16x32_bf16 v[64:67], a[20:23], a[4:7], v[64:67]
ds_read_b128 a[52:55], v23 offset:29952
v_mfma_f32_16x16x32_bf16 v[68:71], a[20:23], a[8:11], v[68:71]
ds_read_b128 a[56:59], v23 offset:30976
v_mfma_f32_16x16x32_bf16 v[84:87], a[24:27], a[8:11], v[84:87]
buffer_load_dwordx4 v19, s[20:23], s54 offen offset:1024 lds
v_mfma_f32_16x16x32_bf16 v[88:91], a[24:27], a[12:15], v[88:91]
ds_read_b64_tr_b16 a[64:65], v25 offset:37248
v_mfma_f32_16x16x32_bf16 v[72:75], a[20:23], a[12:15], v[72:75]
ds_read_b64_tr_b16 a[66:67], v25 offset:37760
s_waitcnt lgkmcnt(6)
v_mfma_f32_16x16x32_bf16 v[104:107], a[28:31], a[12:15], v[104:107]
buffer_load_dwordx4 v20, s[20:23], s54 offen offset:2048 lds
v_mfma_f32_16x16x32_bf16 v[120:123], a[32:35], a[12:15], v[120:123]
ds_read_b64_tr_b16 a[68:69], v25 offset:37280
s_add_u32 s54, s54, 196608
v_mfma_f32_16x16x32_bf16 v[116:119], a[32:35], a[8:11], v[116:119]
ds_read_b64_tr_b16 a[70:71], v25 offset:37792
v_mfma_f32_16x16x32_bf16 v[100:103], a[28:31], a[8:11], v[100:103]
ds_read_b128 a[60:63], v24 offset:29696
s_add_u32 m0, s55, 9216
v_mfma_f32_16x16x32_bf16 v[96:99], a[28:31], a[4:7], v[96:99]
buffer_load_dwordx4 v21, s[16:19], s52 offen sc1 lds
v_mfma_f32_16x16x32_bf16 v[112:115], a[32:35], a[4:7], v[112:115]
ds_read_b64_tr_b16 a[72:73], v25 offset:38272
v_mfma_f32_16x16x32_bf16 v[108:111], a[32:35], a[0:3], v[108:111]
ds_read_b64_tr_b16 a[74:75], v25 offset:38784
v_mfma_f32_16x16x32_bf16 v[92:95], a[28:31], a[0:3], v[92:95]
buffer_load_dwordx4 v21, s[16:19], s52 offen offset:1024 sc1 lds
v_mfma_f32_16x16x32_bf16 v[124:127], a[0:3], a[36:39], v[124:127]
ds_read_b64_tr_b16 a[76:77], v25 offset:38304
v_mfma_f32_16x16x32_bf16 v[140:143], a[0:3], a[40:43], v[140:143]
ds_read_b64_tr_b16 a[78:79], v25 offset:38816
v_mfma_f32_16x16x32_bf16 v[144:147], a[4:7], a[40:43], v[144:147]
ds_read_b64_tr_b16 a[80:81], v25 offset:39296
v_mfma_f32_16x16x32_bf16 v[128:131], a[4:7], a[36:39], v[128:131]
buffer_load_dword v22, s[16:19], s52 offen offset:2048 sc1 lds
v_mfma_f32_16x16x32_bf16 v[132:135], a[8:11], a[36:39], v[132:135]
ds_read_b64_tr_b16 a[82:83], v25 offset:39808
s_add_u32 s52, s52, 0x20000
v_mfma_f32_16x16x32_bf16 v[148:151], a[8:11], a[40:43], v[148:151]
ds_read_b64_tr_b16 a[84:85], v25 offset:39328
v_mfma_f32_16x16x32_bf16 v[152:155], a[12:15], a[40:43], v[152:155]
buffer_load_dwordx4 v[172:175], v26, s[16:19], s75 offen offset:1024 sc1
v_mfma_f32_16x16x32_bf16 v[136:139], a[12:15], a[36:39], v[136:139]
ds_read_b64_tr_b16 a[86:87], v25 offset:39840
s_add_u32 s75, s75, 2048
v_mfma_f32_16x16x32_bf16 v[156:159], a[16:19], a[36:39], v[156:159]
v_mfma_f32_16x16x32_bf16 v[160:163], a[16:19], a[40:43], v[160:163]
s_waitcnt vmcnt(20) lgkmcnt(8)
s_barrier
v_mfma_f32_16x16x32_bf16 v[60:63], a[64:67], a[44:47], v[60:63]
ds_read_b128 a[0:3], v23 offset:36864
v_mfma_f32_16x16x32_bf16 v[76:79], a[68:71], a[44:47], v[76:79]
ds_read_b128 a[4:7], v23 offset:37888
s_add_u32 m0, s56, 92416
v_mfma_f32_16x16x32_bf16 v[80:83], a[68:71], a[48:51], v[80:83]
buffer_load_dwordx4 v18, s[20:23], s54 offen lds
v_mfma_f32_16x16x32_bf16 v[64:67], a[64:67], a[48:51], v[64:67]
ds_read_b128 a[8:11], v23 offset:39168
v_mfma_f32_16x16x32_bf16 v[68:71], a[64:67], a[52:55], v[68:71]
ds_read_b128 a[12:15], v23 offset:40192
v_mfma_f32_16x16x32_bf16 v[84:87], a[68:71], a[52:55], v[84:87]
ds_read_b64_tr_b16 a[20:21], v25 offset:49664
v_mfma_f32_16x16x32_bf16 v[88:91], a[68:71], a[56:59], v[88:91]
.Lpad15:
s_cbranch_execz .Lnopoll58r
buffer_load_dwordx4 v19, s[20:23], s54 offen offset:1024 lds
v_mfma_f32_16x16x32_bf16 v[72:75], a[64:67], a[56:59], v[72:75]
ds_read_b64_tr_b16 a[22:23], v25 offset:50176
s_waitcnt lgkmcnt(6)
v_mfma_f32_16x16x32_bf16 v[104:107], a[72:75], a[56:59], v[104:107]
ds_read_b64_tr_b16 a[24:25], v25 offset:49696
v_mfma_f32_16x16x32_bf16 v[120:123], a[76:79], a[56:59], v[120:123]
ds_read_b64_tr_b16 a[26:27], v25 offset:50208
v_mfma_f32_16x16x32_bf16 v[116:119], a[76:79], a[52:55], v[116:119]
buffer_load_dwordx4 v20, s[20:23], s54 offen offset:2048 lds
v_mfma_f32_16x16x32_bf16 v[100:103], a[72:75], a[52:55], v[100:103]
ds_read_b128 a[16:19], v24 offset:38912
s_add_u32 s54, s54, 196608
v_mfma_f32_16x16x32_bf16 v[96:99], a[72:75], a[48:51], v[96:99]
v_mfma_f32_16x16x32_bf16 v[112:115], a[76:79], a[48:51], v[112:115]
ds_read_b64_tr_b16 a[28:29], v25 offset:50688
s_add_u32 m0, s55, 18432
v_mfma_f32_16x16x32_bf16 v[108:111], a[76:79], a[44:47], v[108:111]
buffer_load_dwordx4 v21, s[16:19], s52 offen sc1 lds
v_mfma_f32_16x16x32_bf16 v[92:95], a[72:75], a[44:47], v[92:95]
ds_read_b64_tr_b16 a[30:31], v25 offset:51200
v_mfma_f32_16x16x32_bf16 v[124:127], a[44:47], a[80:83], v[124:127]
ds_read_b64_tr_b16 a[32:33], v25 offset:50720
v_mfma_f32_16x16x32_bf16 v[140:143], a[44:47], a[84:87], v[140:143]
ds_read_b64_tr_b16 a[34:35], v25 offset:51232
v_mfma_f32_16x16x32_bf16 v[144:147], a[48:51], a[84:87], v[144:147]
buffer_load_dwordx4 v21, s[16:19], s52 offen offset:1024 sc1 lds
v_mfma_f32_16x16x32_bf16 v[128:131], a[48:51], a[80:83], v[128:131]
ds_read_b64_tr_b16 a[36:37], v25 offset:51712
v_mfma_f32_16x16x32_bf16 v[132:135], a[52:55], a[80:83], v[132:135]
ds_read_b64_tr_b16 a[38:39], v25 offset:52224
v_mfma_f32_16x16x32_bf16 v[148:151], a[52:55], a[84:87], v[148:151]
ds_read_b64_tr_b16 a[40:41], v25 offset:51744
v_mfma_f32_16x16x32_bf16 v[152:155], a[56:59], a[84:87], v[152:155]
buffer_load_dword v22, s[16:19], s52 offen offset:2048 sc1 lds
v_mfma_f32_16x16x32_bf16 v[136:139], a[56:59], a[80:83], v[136:139]
ds_read_b64_tr_b16 a[42:43], v25 offset:52256
s_add_u32 s52, s52, 0x20000
v_mfma_f32_16x16x32_bf16 v[156:159], a[60:63], a[80:83], v[156:159]
s_add_u32 s15, s15, 1
v_mfma_f32_16x16x32_bf16 v[160:163], a[60:63], a[84:87], v[160:163]
s_cbranch_scc0 .Lk63
s_waitcnt vmcnt(19) lgkmcnt(8)
s_barrier
v_mfma_f32_16x16x32_bf16 v[60:63], a[20:23], a[0:3], v[60:63]
ds_read_b128 a[44:47], v23 offset:46080
v_add_f32 v164, v164, v168
v_mfma_f32_16x16x32_bf16 v[76:79], a[24:27], a[0:3], v[76:79]
ds_read_b128 a[48:51], v23 offset:47104
s_add_u32 m0, s56, 104832
v_mfma_f32_16x16x32_bf16 v[80:83], a[24:27], a[4:7], v[80:83]
buffer_load_dwordx4 v18, s[20:23], s54 offen lds
v_mfma_f32_16x16x32_bf16 v[64:67], a[20:23], a[4:7], v[64:67]
ds_read_b128 a[52:55], v23 offset:48384
v_mfma_f32_16x16x32_bf16 v[68:71], a[20:23], a[8:11], v[68:71]
ds_read_b128 a[56:59], v23 offset:49408
v_mfma_f32_16x16x32_bf16 v[84:87], a[24:27], a[8:11], v[84:87]
ds_read_b64_tr_b16 a[64:65], v25 offset:62080
v_mfma_f32_16x16x32_bf16 v[88:91], a[24:27], a[12:15], v[88:91]
buffer_load_dwordx4 v19, s[20:23], s54 offen offset:1024 lds
v_mfma_f32_16x16x32_bf16 v[72:75], a[20:23], a[12:15], v[72:75]
ds_read_b64_tr_b16 a[66:67], v25 offset:62592
s_waitcnt lgkmcnt(6)
v_mfma_f32_16x16x32_bf16 v[104:107], a[28:31], a[12:15], v[104:107]
ds_read_b64_tr_b16 a[68:69], v25 offset:62112
v_add_f32 v165, v165, v169
v_mfma_f32_16x16x32_bf16 v[120:123], a[32:35], a[12:15], v[120:123]
ds_read_b64_tr_b16 a[70:71], v25 offset:62624
v_mfma_f32_16x16x32_bf16 v[116:119], a[32:35], a[8:11], v[116:119]
buffer_load_dwordx4 v20, s[20:23], s54 offen offset:2048 lds
v_mfma_f32_16x16x32_bf16 v[100:103], a[28:31], a[8:11], v[100:103]
ds_read_b128 a[60:63], v24 offset:48128
s_add_u32 s54, s54, 196608
v_mfma_f32_16x16x32_bf16 v[96:99], a[28:31], a[4:7], v[96:99]
v_mfma_f32_16x16x32_bf16 v[112:115], a[32:35], a[4:7], v[112:115]
ds_read_b64_tr_b16 a[72:73], v25 offset:63104
s_add_u32 m0, s55, 27648
v_mfma_f32_16x16x32_bf16 v[108:111], a[32:35], a[0:3], v[108:111]
buffer_load_dwordx4 v21, s[16:19], s52 offen sc1 lds
v_mfma_f32_16x16x32_bf16 v[92:95], a[28:31], a[0:3], v[92:95]
ds_read_b64_tr_b16 a[74:75], v25 offset:63616
v_add_f32 v166, v166, v170
v_mfma_f32_16x16x32_bf16 v[124:127], a[0:3], a[36:39], v[124:127]
ds_read_b64_tr_b16 a[76:77], v25 offset:63136
v_mfma_f32_16x16x32_bf16 v[140:143], a[0:3], a[40:43], v[140:143]
ds_read_b64_tr_b16 a[78:79], v25 offset:63648
v_mfma_f32_16x16x32_bf16 v[144:147], a[4:7], a[40:43], v[144:147]
buffer_load_dwordx4 v21, s[16:19], s52 offen offset:1024 sc1 lds
v_mfma_f32_16x16x32_bf16 v[128:131], a[4:7], a[36:39], v[128:131]
ds_read_b64_tr_b16 a[80:81], v25 offset:64128
v_mfma_f32_16x16x32_bf16 v[132:135], a[8:11], a[36:39], v[132:135]
ds_read_b64_tr_b16 a[82:83], v25 offset:64640
v_add_f32 v167, v167, v171
v_mfma_f32_16x16x32_bf16 v[148:151], a[8:11], a[40:43], v[148:151]
ds_read_b64_tr_b16 a[84:85], v25 offset:64160
v_mfma_f32_16x16x32_bf16 v[152:155], a[12:15], a[40:43], v[152:155]
buffer_load_dword v22, s[16:19], s52 offen offset:2048 sc1 lds
v_mfma_f32_16x16x32_bf16 v[136:139], a[12:15], a[36:39], v[136:139]
ds_read_b64_tr_b16 a[86:87], v25 offset:64672
s_add_u32 s52, s52, 0x20000
v_mfma_f32_16x16x32_bf16 v[156:159], a[16:19], a[36:39], v[156:159]
v_mfma_f32_16x16x32_bf16 v[160:163], a[16:19], a[40:43], v[160:163]
s_waitcnt vmcnt(19) lgkmcnt(8)
s_barrier
v_mfma_f32_16x16x32_bf16 v[60:63], a[64:67], a[44:47], v[60:63]
ds_read_b128 a[0:3], v23
v_mfma_f32_16x16x32_bf16 v[76:79], a[68:71], a[44:47], v[76:79]
ds_read_b128 a[4:7], v23 offset:1024
s_add_u32 m0, s56, 117248
v_mfma_f32_16x16x32_bf16 v[80:83], a[68:71], a[48:51], v[80:83]
buffer_load_dwordx4 v18, s[20:23], s54 offen lds
v_mfma_f32_16x16x32_bf16 v[64:67], a[64:67], a[48:51], v[64:67]
ds_read_b128 a[8:11], v23 offset:2304
v_mfma_f32_16x16x32_bf16 v[68:71], a[64:67], a[52:55], v[68:71]
ds_read_b128 a[12:15], v23 offset:3328
v_mfma_f32_16x16x32_bf16 v[84:87], a[68:71], a[52:55], v[84:87]
ds_read_b64_tr_b16 a[20:21], v25
v_mfma_f32_16x16x32_bf16 v[88:91], a[68:71], a[56:59], v[88:91]
buffer_load_dwordx4 v19, s[20:23], s54 offen offset:1024 lds
v_mfma_f32_16x16x32_bf16 v[72:75], a[64:67], a[56:59], v[72:75]
ds_read_b64_tr_b16 a[22:23], v25 offset:512
s_waitcnt lgkmcnt(6)
v_mfma_f32_16x16x32_bf16 v[104:107], a[72:75], a[56:59], v[104:107]
ds_read_b64_tr_b16 a[24:25], v25 offset:32
v_mfma_f32_16x16x32_bf16 v[120:123], a[76:79], a[56:59], v[120:123]
ds_read_b64_tr_b16 a[26:27], v25 offset:544
v_mfma_f32_16x16x32_bf16 v[116:119], a[76:79], a[52:55], v[116:119]
buffer_load_dwordx4 v20, s[20:23], s54 offen offset:2048 lds
v_mfma_f32_16x16x32_bf16 v[100:103], a[72:75], a[52:55], v[100:103]
ds_read_b128 a[16:19], v24 offset:2048
s_add_u32 s54, s54, 196608
v_mfma_f32_16x16x32_bf16 v[96:99], a[72:75], a[48:51], v[96:99]
v_mfma_f32_16x16x32_bf16 v[112:115], a[76:79], a[48:51], v[112:115]
ds_read_b64_tr_b16 a[28:29], v25 offset:1024
s_add_u32 m0, s55, 36864
v_mfma_f32_16x16x32_bf16 v[108:111], a[76:79], a[44:47], v[108:111]
buffer_load_dwordx4 v21, s[16:19], s52 offen sc1 lds
v_mfma_f32_16x16x32_bf16 v[92:95], a[72:75], a[44:47], v[92:95]
ds_read_b64_tr_b16 a[30:31], v25 offset:1536
v_mfma_f32_16x16x32_bf16 v[124:127], a[44:47], a[80:83], v[124:127]
ds_read_b64_tr_b16 a[32:33], v25 offset:1056
v_mfma_f32_16x16x32_bf16 v[140:143], a[44:47], a[84:87], v[140:143]
ds_read_b64_tr_b16 a[34:35], v25 offset:1568
v_mfma_f32_16x16x32_bf16 v[144:147], a[48:51], a[84:87], v[144:147]
buffer_load_dwordx4 v21, s[16:19], s52 offen offset:1024 sc1 lds
v_mfma_f32_16x16x32_bf16 v[128:131], a[48:51], a[80:83], v[128:131]
ds_read_b64_tr_b16 a[36:37], v25 offset:2048
v_mfma_f32_16x16x32_bf16 v[132:135], a[52:55], a[80:83], v[132:135]
ds_read_b64_tr_b16 a[38:39], v25 offset:2560
v_mfma_f32_16x16x32_bf16 v[148:151], a[52:55], a[84:87], v[148:151]
ds_read_b64_tr_b16 a[40:41], v25 offset:2080
v_mfma_f32_16x16x32_bf16 v[152:155], a[56:59], a[84:87], v[152:155]
buffer_load_dword v22, s[16:19], s52 offen offset:2048 sc1 lds
v_mfma_f32_16x16x32_bf16 v[136:139], a[56:59], a[80:83], v[136:139]
ds_read_b64_tr_b16 a[42:43], v25 offset:2592
s_add_u32 s52, s52, 0x20000
v_mfma_f32_16x16x32_bf16 v[156:159], a[60:63], a[80:83], v[156:159]
v_mfma_f32_16x16x32_bf16 v[160:163], a[60:63], a[84:87], v[160:163]
s_waitcnt vmcnt(19) lgkmcnt(8)
s_barrier
v_mfma_f32_16x16x32_bf16 v[60:63], a[20:23], a[0:3], v[60:63]
ds_read_b128 a[44:47], v23 offset:9216
s_waitcnt vmcnt(18)
v_add_f32 v164, v164, v172
v_mfma_f32_16x16x32_bf16 v[76:79], a[24:27], a[0:3], v[76:79]
ds_read_b128 a[48:51], v23 offset:10240
s_add_u32 m0, s56, 129664
v_mfma_f32_16x16x32_bf16 v[80:83], a[24:27], a[4:7], v[80:83]
buffer_load_dwordx4 v18, s[20:23], s54 offen lds
v_mfma_f32_16x16x32_bf16 v[64:67], a[20:23], a[4:7], v[64:67]
ds_read_b128 a[52:55], v23 offset:11520
v_mfma_f32_16x16x32_bf16 v[68:71], a[20:23], a[8:11], v[68:71]
ds_read_b128 a[56:59], v23 offset:12544
v_mfma_f32_16x16x32_bf16 v[84:87], a[24:27], a[8:11], v[84:87]
ds_read_b64_tr_b16 a[64:65], v25 offset:12416
v_mfma_f32_16x16x32_bf16 v[88:91], a[24:27], a[12:15], v[88:91]
buffer_load_dwordx4 v19, s[20:23], s54 offen offset:1024 lds
v_mfma_f32_16x16x32_bf16 v[72:75], a[20:23], a[12:15], v[72:75]
ds_read_b64_tr_b16 a[66:67], v25 offset:12928
s_waitcnt lgkmcnt(6)
v_mfma_f32_16x16x32_bf16 v[104:107], a[28:31], a[12:15], v[104:107]
ds_read_b64_tr_b16 a[68:69], v25 offset:12448
v_add_f32 v165, v165, v173
v_mfma_f32_16x16x32_bf16 v[120:123], a[32:35], a[12:15], v[120:123]
ds_read_b64_tr_b16 a[70:71], v25 offset:12960
v_mfma_f32_16x16x32_bf16 v[116:119], a[32:35], a[8:11], v[116:119]
buffer_load_dwordx4 v20, s[20:23], s54 offen offset:2048 lds
v_mfma_f32_16x16x32_bf16 v[100:103], a[28:31], a[8:11], v[100:103]
ds_read_b128 a[60:63], v24 offset:11264
s_add_u32 s54, s54, 196608
v_mfma_f32_16x16x32_bf16 v[96:99], a[28:31], a[4:7], v[96:99]
v_mfma_f32_16x16x32_bf16 v[112:115], a[32:35], a[4:7], v[112:115]
ds_read_b64_tr_b16 a[72:73], v25 offset:13440
s_add_u32 m0, s55, 46080
v_mfma_f32_16x16x32_bf16 v[108:111], a[32:35], a[0:3], v[108:111]
buffer_load_dwordx4 v21, s[16:19], s52 offen sc1 lds
v_mfma_f32_16x16x32_bf16 v[92:95], a[28:31], a[0:3], v[92:95]
ds_read_b64_tr_b16 a[74:75], v25 offset:13952
v_add_f32 v166, v166, v174
v_mfma_f32_16x16x32_bf16 v[124:127], a[0:3], a[36:39], v[124:127]
ds_read_b64_tr_b16 a[76:77], v25 offset:13472
v_mfma_f32_16x16x32_bf16 v[140:143], a[0:3], a[40:43], v[140:143]
ds_read_b64_tr_b16 a[78:79], v25 offset:13984
v_mfma_f32_16x16x32_bf16 v[144:147], a[4:7], a[40:43], v[144:147]
buffer_load_dwordx4 v21, s[16:19], s52 offen offset:1024 sc1 lds
v_mfma_f32_16x16x32_bf16 v[128:131], a[4:7], a[36:39], v[128:131]
ds_read_b64_tr_b16 a[80:81], v25 offset:14464
v_mfma_f32_16x16x32_bf16 v[132:135], a[8:11], a[36:39], v[132:135]
ds_read_b64_tr_b16 a[82:83], v25 offset:14976
v_add_f32 v167, v167, v175
v_mfma_f32_16x16x32_bf16 v[148:151], a[8:11], a[40:43], v[148:151]
ds_read_b64_tr_b16 a[84:85], v25 offset:14496
v_mfma_f32_16x16x32_bf16 v[152:155], a[12:15], a[40:43], v[152:155]
buffer_load_dword v22, s[16:19], s52 offen offset:2048 sc1 lds
v_mfma_f32_16x16x32_bf16 v[136:139], a[12:15], a[36:39], v[136:139]
ds_read_b64_tr_b16 a[86:87], v25 offset:15008
s_add_u32 s52, s52, 0x20000
v_mfma_f32_16x16x32_bf16 v[156:159], a[16:19], a[36:39], v[156:159]
v_mfma_f32_16x16x32_bf16 v[160:163], a[16:19], a[40:43], v[160:163]
s_waitcnt vmcnt(18) lgkmcnt(8)
s_barrier
v_mfma_f32_16x16x32_bf16 v[60:63], a[64:67], a[44:47], v[60:63]
ds_read_b128 a[0:3], v23 offset:18432
v_permlane32_swap_b32 v164, v166
v_mfma_f32_16x16x32_bf16 v[76:79], a[68:71], a[44:47], v[76:79]
ds_read_b128 a[4:7], v23 offset:19456
s_add_u32 m0, s59, 0
s_mov_b32 s58, 1048576
v_mfma_f32_16x16x32_bf16 v[80:83], a[68:71], a[48:51], v[80:83]
buffer_load_dwordx4 v5, s[24:27], s58 offen lds
v_mfma_f32_16x16x32_bf16 v[64:67], a[64:67], a[48:51], v[64:67]
ds_read_b128 a[8:11], v23 offset:20736
v_mfma_f32_16x16x32_bf16 v[68:71], a[64:67], a[52:55], v[68:71]
ds_read_b128 a[12:15], v23 offset:21760
v_permlane32_swap_b32 v165, v167
v_mfma_f32_16x16x32_bf16 v[84:87], a[68:71], a[52:55], v[84:87]
ds_read_b64_tr_b16 a[20:21], v25 offset:24832
v_mfma_f32_16x16x32_bf16 v[88:91], a[68:71], a[56:59], v[88:91]
buffer_load_dwordx4 v6, s[24:27], s58 offen offset:1024 lds
v_mfma_f32_16x16x32_bf16 v[72:75], a[64:67], a[56:59], v[72:75]
v_add_f32 v164, v164, v166
s_waitcnt lgkmcnt(5)
v_mfma_f32_16x16x32_bf16 v[104:107], a[72:75], a[56:59], v[104:107]
ds_read_b64_tr_b16 a[22:23], v25 offset:25344
v_add_f32 v165, v165, v167
v_mfma_f32_16x16x32_bf16 v[120:123], a[76:79], a[56:59], v[120:123]
ds_read_b64_tr_b16 a[24:25], v25 offset:24864
s_add_u32 m0, s59, 58240
s_mov_b32 s58, 1966080
v_mfma_f32_16x16x32_bf16 v[116:119], a[76:79], a[52:55], v[116:119]
buffer_load_dwordx4 v5, s[24:27], s58 offen lds
v_mfma_f32_16x16x32_bf16 v[100:103], a[72:75], a[52:55], v[100:103]
ds_read_b64_tr_b16 a[26:27], v25 offset:25376
v_mfma_f32_16x16x32_bf16 v[96:99], a[72:75], a[48:51], v[96:99]
ds_read_b128 a[16:19], v24 offset:20480
v_mfma_f32_16x16x32_bf16 v[112:115], a[76:79], a[48:51], v[112:115]
ds_read_b64_tr_b16 a[28:29], v25 offset:25856
v_mul_f32 v164, 0xba800000, v164
v_mfma_f32_16x16x32_bf16 v[108:111], a[76:79], a[44:47], v[108:111]
buffer_load_dwordx4 v6, s[24:27], s58 offen offset:1024 lds
v_mfma_f32_16x16x32_bf16 v[92:95], a[72:75], a[44:47], v[92:95]
ds_read_b64_tr_b16 a[30:31], v25 offset:26368
v_mfma_f32_16x16x32_bf16 v[124:127], a[44:47], a[80:83], v[124:127]
ds_read_b64_tr_b16 a[32:33], v25 offset:25888
v_mul_f32 v165, 0x3a800000, v165
v_mfma_f32_16x16x32_bf16 v[140:143], a[44:47], a[84:87], v[140:143]
s_add_u32 m0, s59, 66560
s_mov_b32 s58, 0
v_mfma_f32_16x16x32_bf16 v[144:147], a[48:51], a[84:87], v[144:147]
buffer_load_dwordx4 v5, s[24:27], s58 offen lds
v_mfma_f32_16x16x32_bf16 v[128:131], a[48:51], a[80:83], v[128:131]
ds_read_b64_tr_b16 a[34:35], v25 offset:26400
v_fma_f32 v165, -v164, v164, v165
v_mfma_f32_16x16x32_bf16 v[132:135], a[52:55], a[80:83], v[132:135]
ds_read_b64_tr_b16 a[36:37], v25 offset:26880
v_mfma_f32_16x16x32_bf16 v[148:151], a[52:55], a[84:87], v[148:151]
ds_read_b64_tr_b16 a[38:39], v25 offset:27392
v_max_f32 v165, 0, v165
v_mfma_f32_16x16x32_bf16 v[152:155], a[56:59], a[84:87], v[152:155]
buffer_load_dwordx4 v6, s[24:27], s58 offen offset:1024 lds
v_mfma_f32_16x16x32_bf16 v[136:139], a[56:59], a[80:83], v[136:139]
ds_read_b64_tr_b16 a[40:41], v25 offset:26912
v_mfma_f32_16x16x32_bf16 v[156:159], a[60:63], a[80:83], v[156:159]
ds_read_b64_tr_b16 a[42:43], v25 offset:27424
v_mfma_f32_16x16x32_bf16 v[160:163], a[60:63], a[84:87], v[160:163]
s_waitcnt vmcnt(18) lgkmcnt(8)
s_barrier
v_mfma_f32_16x16x32_bf16 v[60:63], a[20:23], a[0:3], v[60:63]
ds_read_b128 a[44:47], v23 offset:27648
v_add_f32 v165, 0x3727c5ac, v165
v_mfma_f32_16x16x32_bf16 v[76:79], a[24:27], a[0:3], v[76:79]
ds_read_b128 a[48:51], v23 offset:28672
s_add_u32 m0, s59, 8320
s_mov_b32 s58, 1179648
v_mfma_f32_16x16x32_bf16 v[80:83], a[24:27], a[4:7], v[80:83]
buffer_load_dwordx4 v5, s[24:27], s58 offen lds
v_mfma_f32_16x16x32_bf16 v[64:67], a[20:23], a[4:7], v[64:67]
ds_read_b128 a[52:55], v23 offset:29952
v_mfma_f32_16x16x32_bf16 v[68:71], a[20:23], a[8:11], v[68:71]
ds_read_b128 a[56:59], v23 offset:30976
v_mfma_f32_16x16x32_bf16 v[84:87], a[24:27], a[8:11], v[84:87]
ds_read_b64_tr_b16 a[64:65], v25 offset:37248
v_mfma_f32_16x16x32_bf16 v[88:91], a[24:27], a[12:15], v[88:91]
buffer_load_dwordx4 v6, s[24:27], s58 offen offset:1024 lds
v_mfma_f32_16x16x32_bf16 v[72:75], a[20:23], a[12:15], v[72:75]
v_rsq_f32 v166, v165
s_waitcnt lgkmcnt(5)
v_mfma_f32_16x16x32_bf16 v[104:107], a[28:31], a[12:15], v[104:107]
ds_read_b64_tr_b16 a[66:67], v25 offset:37760
v_mfma_f32_16x16x32_bf16 v[120:123], a[32:35], a[12:15], v[120:123]
ds_read_b64_tr_b16 a[68:69], v25 offset:37280
s_add_u32 m0, s59, 74880
s_mov_b32 s58, 131072
v_mfma_f32_16x16x32_bf16 v[116:119], a[32:35], a[8:11], v[116:119]
buffer_load_dwordx4 v5, s[24:27], s58 offen lds
v_mfma_f32_16x16x32_bf16 v[100:103], a[28:31], a[8:11], v[100:103]
ds_read_b64_tr_b16 a[70:71], v25 offset:37792
v_mfma_f32_16x16x32_bf16 v[96:99], a[28:31], a[4:7], v[96:99]
ds_read_b128 a[60:63], v24 offset:29696
v_mfma_f32_16x16x32_bf16 v[112:115], a[32:35], a[4:7], v[112:115]
ds_read_b64_tr_b16 a[72:73], v25 offset:38272
v_mov_b32 v165, v166
v_mfma_f32_16x16x32_bf16 v[108:111], a[32:35], a[0:3], v[108:111]
buffer_load_dwordx4 v6, s[24:27], s58 offen offset:1024 lds
v_mfma_f32_16x16x32_bf16 v[92:95], a[28:31], a[0:3], v[92:95]
ds_read_b64_tr_b16 a[74:75], v25 offset:38784
v_mfma_f32_16x16x32_bf16 v[124:127], a[0:3], a[36:39], v[124:127]
ds_read_b64_tr_b16 a[76:77], v25 offset:38304
v_mfma_f32_16x16x32_bf16 v[140:143], a[0:3], a[40:43], v[140:143]
s_add_u32 m0, s59, 83200
s_mov_b32 s58, 262144
v_mfma_f32_16x16x32_bf16 v[144:147], a[4:7], a[40:43], v[144:147]
buffer_load_dwordx4 v5, s[24:27], s58 offen lds
v_mfma_f32_16x16x32_bf16 v[128:131], a[4:7], a[36:39], v[128:131]
ds_read_b64_tr_b16 a[78:79], v25 offset:38816
v_mul_f32 v166, 0x3e8293ee, v166
v_mfma_f32_16x16x32_bf16 v[132:135], a[8:11], a[36:39], v[132:135]
ds_read_b64_tr_b16 a[80:81], v25 offset:39296
v_mfma_f32_16x16x32_bf16 v[148:151], a[8:11], a[40:43], v[148:151]
ds_read_b64_tr_b16 a[82:83], v25 offset:39808
v_mfma_f32_16x16x32_bf16 v[152:155], a[12:15], a[40:43], v[152:155]
buffer_load_dwordx4 v6, s[24:27], s58 offen offset:1024 lds
v_mfma_f32_16x16x32_bf16 v[136:139], a[12:15], a[36:39], v[136:139]
ds_read_b64_tr_b16 a[84:85], v25 offset:39328
v_mfma_f32_16x16x32_bf16 v[156:159], a[16:19], a[36:39], v[156:159]
ds_read_b64_tr_b16 a[86:87], v25 offset:39840
v_mfma_f32_16x16x32_bf16 v[160:163], a[16:19], a[40:43], v[160:163]
s_waitcnt vmcnt(18) lgkmcnt(8)
s_barrier
v_mfma_f32_16x16x32_bf16 v[60:63], a[64:67], a[44:47], v[60:63]
ds_read_b128 a[0:3], v23 offset:36864
ds_write_b128 v7, v[164:167]
v_mfma_f32_16x16x32_bf16 v[76:79], a[68:71], a[44:47], v[76:79]
s_add_u32 m0, s59, 16640
s_mov_b32 s58, 1310720
v_mfma_f32_16x16x32_bf16 v[80:83], a[68:71], a[48:51], v[80:83]
buffer_load_dwordx4 v5, s[24:27], s58 offen lds
v_mfma_f32_16x16x32_bf16 v[64:67], a[64:67], a[48:51], v[64:67]
ds_read_b128 a[4:7], v23 offset:37888
v_mfma_f32_16x16x32_bf16 v[68:71], a[64:67], a[52:55], v[68:71]
ds_read_b128 a[8:11], v23 offset:39168
v_mfma_f32_16x16x32_bf16 v[84:87], a[68:71], a[52:55], v[84:87]
ds_read_b128 a[12:15], v23 offset:40192
v_mfma_f32_16x16x32_bf16 v[88:91], a[68:71], a[56:59], v[88:91]
ds_read_b64_tr_b16 a[20:21], v25 offset:49664
v_mfma_f32_16x16x32_bf16 v[72:75], a[64:67], a[56:59], v[72:75]
ds_read_b64_tr_b16 a[22:23], v25 offset:50176
s_waitcnt lgkmcnt(7)
v_mfma_f32_16x16x32_bf16 v[104:107], a[72:75], a[56:59], v[104:107]
buffer_load_dwordx4 v6, s[24:27], s58 offen offset:1024 lds
v_mfma_f32_16x16x32_bf16 v[120:123], a[76:79], a[56:59], v[120:123]
ds_read_b64_tr_b16 a[24:25], v25 offset:49696
v_mfma_f32_16x16x32_bf16 v[116:119], a[76:79], a[52:55], v[116:119]
ds_read_b64_tr_b16 a[26:27], v25 offset:50208
ds_write_b32 v17, v164
v_mfma_f32_16x16x32_bf16 v[100:103], a[72:75], a[52:55], v[100:103]
ds_read_b128 a[16:19], v24 offset:38912
v_mfma_f32_16x16x32_bf16 v[96:99], a[72:75], a[48:51], v[96:99]
v_mfma_f32_16x16x32_bf16 v[112:115], a[76:79], a[48:51], v[112:115]
s_add_u32 m0, s59, 91520
s_mov_b32 s58, 393216
v_mfma_f32_16x16x32_bf16 v[108:111], a[76:79], a[44:47], v[108:111]
buffer_load_dwordx4 v5, s[24:27], s58 offen lds
v_mfma_f32_16x16x32_bf16 v[92:95], a[72:75], a[44:47], v[92:95]
ds_read_b64_tr_b16 a[28:29], v25 offset:50688
v_mfma_f32_16x16x32_bf16 v[124:127], a[44:47], a[80:83], v[124:127]
ds_read_b64_tr_b16 a[30:31], v25 offset:51200
v_mfma_f32_16x16x32_bf16 v[140:143], a[44:47], a[84:87], v[140:143]
ds_read_b64_tr_b16 a[32:33], v25 offset:50720
ds_write_b32 v17, v165 offset:1024
v_mfma_f32_16x16x32_bf16 v[144:147], a[48:51], a[84:87], v[144:147]
ds_read_b64_tr_b16 a[34:35], v25 offset:51232
v_mfma_f32_16x16x32_bf16 v[128:131], a[48:51], a[80:83], v[128:131]
ds_read_b64_tr_b16 a[36:37], v25 offset:51712
v_mfma_f32_16x16x32_bf16 v[132:135], a[52:55], a[80:83], v[132:135]
buffer_load_dwordx4 v6, s[24:27], s58 offen offset:1024 lds
v_mfma_f32_16x16x32_bf16 v[148:151], a[52:55], a[84:87], v[148:151]
ds_read_b64_tr_b16 a[38:39], v25 offset:52224
v_mfma_f32_16x16x32_bf16 v[152:155], a[56:59], a[84:87], v[152:155]
ds_read_b64_tr_b16 a[40:41], v25 offset:51744
v_mfma_f32_16x16x32_bf16 v[136:139], a[56:59], a[80:83], v[136:139]
ds_read_b64_tr_b16 a[42:43], v25 offset:52256
v_mfma_f32_16x16x32_bf16 v[156:159], a[60:63], a[80:83], v[156:159]
v_mfma_f32_16x16x32_bf16 v[160:163], a[60:63], a[84:87], v[160:163]
s_waitcnt vmcnt(16) lgkmcnt(9)
s_barrier
v_mfma_f32_16x16x32_bf16 v[60:63], a[20:23], a[0:3], v[60:63]
ds_read_b128 a[44:47], v23 offset:46080
v_mfma_f32_16x16x32_bf16 v[76:79], a[24:27], a[0:3], v[76:79]
ds_read_b128 a[48:51], v23 offset:47104
s_add_u32 m0, s59, 24960
s_mov_b32 s58, 1441792
v_mfma_f32_16x16x32_bf16 v[80:83], a[24:27], a[4:7], v[80:83]
buffer_load_dwordx4 v5, s[24:27], s58 offen lds
v_mfma_f32_16x16x32_bf16 v[64:67], a[20:23], a[4:7], v[64:67]
ds_read_b128 a[52:55], v23 offset:48384
v_mfma_f32_16x16x32_bf16 v[68:71], a[20:23], a[8:11], v[68:71]
ds_read_b128 a[56:59], v23 offset:49408
v_mfma_f32_16x16x32_bf16 v[84:87], a[24:27], a[8:11], v[84:87]
ds_read_b64_tr_b16 a[64:65], v25 offset:62080
v_mfma_f32_16x16x32_bf16 v[88:91], a[24:27], a[12:15], v[88:91]
buffer_load_dwordx4 v6, s[24:27], s58 offen offset:1024 lds
v_mfma_f32_16x16x32_bf16 v[72:75], a[20:23], a[12:15], v[72:75]
s_waitcnt lgkmcnt(5)
v_mfma_f32_16x16x32_bf16 v[104:107], a[28:31], a[12:15], v[104:107]
ds_read_b64_tr_b16 a[66:67], v25 offset:62592
v_mfma_f32_16x16x32_bf16 v[120:123], a[32:35], a[12:15], v[120:123]
ds_read_b64_tr_b16 a[68:69], v25 offset:62112
s_add_u32 m0, s59, 99840
s_mov_b32 s58, 524288
v_mfma_f32_16x16x32_bf16 v[116:119], a[32:35], a[8:11], v[116:119]
buffer_load_dwordx4 v5, s[24:27], s58 offen lds
v_mfma_f32_16x16x32_bf16 v[100:103], a[28:31], a[8:11], v[100:103]
ds_read_b64_tr_b16 a[70:71], v25 offset:62624
v_mfma_f32_16x16x32_bf16 v[96:99], a[28:31], a[4:7], v[96:99]
ds_read_b128 a[60:63], v24 offset:48128
v_mfma_f32_16x16x32_bf16 v[112:115], a[32:35], a[4:7], v[112:115]
ds_read_b64_tr_b16 a[72:73], v25 offset:63104
v_mfma_f32_16x16x32_bf16 v[108:111], a[32:35], a[0:3], v[108:111]
buffer_load_dwordx4 v6, s[24:27], s58 offen offset:1024 lds
v_mfma_f32_16x16x32_bf16 v[92:95], a[28:31], a[0:3], v[92:95]
ds_read_b64_tr_b16 a[74:75], v25 offset:63616
v_mfma_f32_16x16x32_bf16 v[124:127], a[0:3], a[36:39], v[124:127]
ds_read_b64_tr_b16 a[76:77], v25 offset:63136
v_mfma_f32_16x16x32_bf16 v[140:143], a[0:3], a[40:43], v[140:143]
s_add_u32 m0, s59, 108160
s_mov_b32 s58, 655360
v_mfma_f32_16x16x32_bf16 v[144:147], a[4:7], a[40:43], v[144:147]
buffer_load_dwordx4 v5, s[24:27], s58 offen lds
v_mfma_f32_16x16x32_bf16 v[128:131], a[4:7], a[36:39], v[128:131]
ds_read_b64_tr_b16 a[78:79], v25 offset:63648
v_mfma_f32_16x16x32_bf16 v[132:135], a[8:11], a[36:39], v[132:135]
ds_read_b64_tr_b16 a[80:81], v25 offset:64128
v_mfma_f32_16x16x32_bf16 v[148:151], a[8:11], a[40:43], v[148:151]
ds_read_b64_tr_b16 a[82:83], v25 offset:64640
v_mfma_f32_16x16x32_bf16 v[152:155], a[12:15], a[40:43], v[152:155]
buffer_load_dwordx4 v6, s[24:27], s58 offen offset:1024 lds
v_mfma_f32_16x16x32_bf16 v[136:139], a[12:15], a[36:39], v[136:139]
ds_read_b64_tr_b16 a[84:85], v25 offset:64160
v_mfma_f32_16x16x32_bf16 v[156:159], a[16:19], a[36:39], v[156:159]
ds_read_b64_tr_b16 a[86:87], v25 offset:64672
v_mfma_f32_16x16x32_bf16 v[160:163], a[16:19], a[40:43], v[160:163]
s_waitcnt lgkmcnt(0)
s_barrier
v_mfma_f32_16x16x32_bf16 v[156:159], a[60:63], a[80:83], v[156:159]
ds_read_b128 v[232:235], v10 offset:1792
s_add_u32 m0, s59, 33280
v_mfma_f32_16x16x32_bf16 v[160:163], a[60:63], a[84:87], v[160:163]
ds_read_b128 v[228:231], v10 offset:1536
s_mov_b32 s58, 1572864
v_mfma_f32_16x16x32_bf16 v[104:107], a[72:75], a[56:59], v[104:107]
ds_read_b128 v[224:227], v10 offset:1280
v_mfma_f32_16x16x32_bf16 v[120:123], a[76:79], a[56:59], v[120:123]
ds_read_b128 v[220:223], v10 offset:1024
v_mfma_f32_16x16x32_bf16 v[136:139], a[56:59], a[80:83], v[136:139]
ds_read_b128 v[240:243], v11 offset:704
v_mfma_f32_16x16x32_bf16 v[152:155], a[56:59], a[84:87], v[152:155]
ds_read_b128 v[244:247], v11 offset:1728
v_mfma_f32_16x16x32_bf16 v[100:103], a[72:75], a[52:55], v[100:103]
buffer_load_dwordx4 v5, s[24:27], s58 offen lds
v_mfma_f32_16x16x32_bf16 v[116:119], a[76:79], a[52:55], v[116:119]
ds_read_b128 v[18:21], v11 offset:448
v_mfma_f32_16x16x32_bf16 v[96:99], a[72:75], a[48:51], v[96:99]
ds_read_b128 v[22:25], v11 offset:1472
s_waitcnt lgkmcnt(7)
v_pk_fma_f32 v[104:105], v[36:37], v[232:233], v[104:105] op_sel_hi:[1,0,1]
v_pk_mul_f32 v[104:105], v[104:105], v[232:233] op_sel:[0,1] op_sel_hi:[1,1]
v_pk_fma_f32 v[106:107], v[38:39], v[232:233], v[106:107] op_sel_hi:[1,0,1]
v_pk_mul_f32 v[106:107], v[106:107], v[232:233] op_sel:[0,1] op_sel_hi:[1,1]
v_pk_fma_f32 v[120:121], v[40:41], v[232:233], v[120:121] op_sel_hi:[1,0,1]
v_pk_mul_f32 v[120:121], v[120:121], v[232:233] op_sel:[0,1] op_sel_hi:[1,1]
v_pk_fma_f32 v[122:123], v[42:43], v[232:233], v[122:123] op_sel_hi:[1,0,1]
v_pk_mul_f32 v[122:123], v[122:123], v[232:233] op_sel:[0,1] op_sel_hi:[1,1]
s_waitcnt lgkmcnt(6)
v_pk_fma_f32 v[100:101], v[36:37], v[228:229], v[100:101] op_sel_hi:[1,0,1]
v_pk_mul_f32 v[100:101], v[100:101], v[228:229] op_sel:[0,1] op_sel_hi:[1,1]
s_waitcnt lgkmcnt(3)
v_pk_fma_f32 v[156:157], v[240:241], v[44:45], v[156:157] op_sel_hi:[1,0,1]
v_pk_fma_f32 v[158:159], v[242:243], v[44:45], v[158:159] op_sel_hi:[1,0,1]
v_pk_fma_f32 v[160:161], v[240:241], v[44:45], v[160:161] op_sel:[0,1,0] op_sel_hi:[1,1,1]
v_pk_fma_f32 v[162:163], v[242:243], v[44:45], v[162:163] op_sel:[0,1,0] op_sel_hi:[1,1,1]
s_waitcnt lgkmcnt(2)
v_pk_mul_f32 v[156:157], v[156:157], v[244:245]
v_pk_mul_f32 v[158:159], v[158:159], v[246:247]
v_pk_mul_f32 v[160:161], v[160:161], v[244:245]
v_pk_mul_f32 v[162:163], v[162:163], v[246:247]
v_pk_fma_f32 v[102:103], v[38:39], v[228:229], v[102:103] op_sel_hi:[1,0,1]
v_pk_mul_f32 v[102:103], v[102:103], v[228:229] op_sel:[0,1] op_sel_hi:[1,1]
v_pk_fma_f32 v[116:117], v[40:41], v[228:229], v[116:117] op_sel_hi:[1,0,1]
v_pk_mul_f32 v[116:117], v[116:117], v[228:229] op_sel:[0,1] op_sel_hi:[1,1]
s_waitcnt lgkmcnt(1)
v_pk_fma_f32 v[136:137], v[18:19], v[44:45], v[136:137] op_sel_hi:[1,0,1]
v_pk_fma_f32 v[138:139], v[20:21], v[44:45], v[138:139] op_sel_hi:[1,0,1]
v_pk_fma_f32 v[152:153], v[18:19], v[44:45], v[152:153] op_sel:[0,1,0] op_sel_hi:[1,1,1]
v_pk_fma_f32 v[154:155], v[20:21], v[44:45], v[154:155] op_sel:[0,1,0] op_sel_hi:[1,1,1]
s_waitcnt lgkmcnt(0)
v_pk_mul_f32 v[136:137], v[136:137], v[22:23]
v_pk_mul_f32 v[138:139], v[138:139], v[24:25]
v_pk_mul_f32 v[152:153], v[152:153], v[22:23]
v_pk_mul_f32 v[154:155], v[154:155], v[24:25]
v_pk_fma_f32 v[118:119], v[42:43], v[228:229], v[118:119] op_sel_hi:[1,0,1]
v_pk_mul_f32 v[118:119], v[118:119], v[228:229] op_sel:[0,1] op_sel_hi:[1,1]
v_pk_fma_f32 v[96:97], v[36:37], v[224:225], v[96:97] op_sel_hi:[1,0,1]
v_pk_mul_f32 v[96:97], v[96:97], v[224:225] op_sel:[0,1] op_sel_hi:[1,1]
v_pk_fma_f32 v[98:99], v[38:39], v[224:225], v[98:99] op_sel_hi:[1,0,1]
v_pk_mul_f32 v[98:99], v[98:99], v[224:225] op_sel:[0,1] op_sel_hi:[1,1]
v_cvt_pk_bf16_f32 v236, v156, v157
v_cvt_pk_bf16_f32 v237, v158, v159
v_mfma_f32_16x16x32_bf16 v[112:115], a[76:79], a[48:51], v[112:115]
buffer_load_dwordx4 v6, s[24:27], s58 offen offset:1024 lds
v_mfma_f32_16x16x32_bf16 v[92:95], a[72:75], a[44:47], v[92:95]
s_add_u32 m0, s59, 41600
v_cvt_pk_bf16_f32 v238, v160, v161
v_cvt_pk_bf16_f32 v239, v162, v163
v_mfma_f32_16x16x32_bf16 v[108:111], a[76:79], a[44:47], v[108:111]
ds_write_b128 v8, v[236:239] offset:1024
s_mov_b32 s58, 1703936
.Lpad16:
s_cbranch_execz .Lnopoll58r
v_mfma_f32_16x16x32_bf16 v[72:75], a[64:67], a[56:59], v[72:75]
ds_read_b128 v[240:243], v11 offset:384
v_cvt_pk_bf16_f32 v196, v104, v105
v_mfma_f32_16x16x32_bf16 v[88:91], a[68:71], a[56:59], v[88:91]
buffer_load_dwordx4 v5, s[24:27], s58 offen lds
v_cvt_pk_bf16_f32 v197, v106, v107
v_cvt_pk_bf16_f32 v198, v120, v121
v_cvt_pk_bf16_f32 v199, v122, v123
s_nop 0
v_pk_fma_f32 v[72:73], v[28:29], v[232:233], v[72:73] op_sel_hi:[1,0,1]
v_pk_fma_f32 v[74:75], v[30:31], v[232:233], v[74:75] op_sel_hi:[1,0,1]
s_nop 0
v_pk_fma_f32 v[88:89], v[32:33], v[232:233], v[88:89] op_sel_hi:[1,0,1]
v_pk_fma_f32 v[90:91], v[34:35], v[232:233], v[90:91] op_sel_hi:[1,0,1]
v_pk_fma_f32 v[112:113], v[40:41], v[224:225], v[112:113] op_sel_hi:[1,0,1]
v_pk_mul_f32 v[112:113], v[112:113], v[224:225] op_sel:[0,1] op_sel_hi:[1,1]
v_pk_fma_f32 v[114:115], v[42:43], v[224:225], v[114:115] op_sel_hi:[1,0,1]
v_pk_mul_f32 v[114:115], v[114:115], v[224:225] op_sel:[0,1] op_sel_hi:[1,1]
v_pk_fma_f32 v[92:93], v[36:37], v[220:221], v[92:93] op_sel_hi:[1,0,1]
v_pk_mul_f32 v[92:93], v[92:93], v[220:221] op_sel:[0,1] op_sel_hi:[1,1]
v_pk_fma_f32 v[94:95], v[38:39], v[220:221], v[94:95] op_sel_hi:[1,0,1]
v_pk_mul_f32 v[94:95], v[94:95], v[220:221] op_sel:[0,1] op_sel_hi:[1,1]
v_pk_fma_f32 v[108:109], v[40:41], v[220:221], v[108:109] op_sel_hi:[1,0,1]
v_pk_mul_f32 v[108:109], v[108:109], v[220:221] op_sel:[0,1] op_sel_hi:[1,1]
v_pk_fma_f32 v[110:111], v[42:43], v[220:221], v[110:111] op_sel_hi:[1,0,1]
v_pk_mul_f32 v[110:111], v[110:111], v[220:221] op_sel:[0,1] op_sel_hi:[1,1]
v_cvt_pk_bf16_f32 v208, v136, v137
v_cvt_pk_bf16_f32 v209, v138, v139
v_mfma_f32_16x16x32_bf16 v[132:135], a[52:55], a[80:83], v[132:135]
s_waitcnt lgkmcnt(1)
s_barrier
ds_read_b128 v[180:183], v9
v_mfma_f32_16x16x32_bf16 v[148:151], a[52:55], a[84:87], v[148:151]
ds_read_b64 v[200:201], v9 offset:1024
v_cvt_pk_bf16_f32 v218, v152, v153
v_mfma_f32_16x16x32_bf16 v[68:71], a[64:67], a[52:55], v[68:71]
ds_read_b64 v[210:211], v9 offset:1032
v_cvt_pk_bf16_f32 v219, v154, v155
v_mfma_f32_16x16x32_bf16 v[84:87], a[68:71], a[52:55], v[84:87]
buffer_load_dwordx4 v6, s[24:27], s58 offen offset:1024 lds
v_mfma_f32_16x16x32_bf16 v[128:131], a[48:51], a[80:83], v[128:131]
s_add_u32 m0, s59, 49920
s_mov_b32 s58, 1835008
v_cvt_pk_bf16_f32 v192, v100, v101
v_cvt_pk_bf16_f32 v193, v102, v103
v_cvt_pk_bf16_f32 v194, v116, v117
v_cvt_pk_bf16_f32 v195, v118, v119
s_waitcnt lgkmcnt(3)
v_pk_fma_f32 v[132:133], v[240:241], v[44:45], v[132:133] op_sel_hi:[1,0,1]
v_pk_fma_f32 v[134:135], v[242:243], v[44:45], v[134:135] op_sel_hi:[1,0,1]
v_pk_fma_f32 v[148:149], v[240:241], v[44:45], v[148:149] op_sel:[0,1,0] op_sel_hi:[1,1,1]
v_pk_fma_f32 v[150:151], v[242:243], v[44:45], v[150:151] op_sel:[0,1,0] op_sel_hi:[1,1,1]
v_pk_fma_f32 v[68:69], v[28:29], v[228:229], v[68:69] op_sel_hi:[1,0,1]
v_pk_fma_f32 v[70:71], v[30:31], v[228:229], v[70:71] op_sel_hi:[1,0,1]
v_pk_fma_f32 v[84:85], v[32:33], v[228:229], v[84:85] op_sel_hi:[1,0,1]
v_pk_fma_f32 v[86:87], v[34:35], v[228:229], v[86:87] op_sel_hi:[1,0,1]
v_cvt_pk_bf16_f32 v176, v72, v73
v_cvt_pk_bf16_f32 v177, v74, v75
v_mfma_f32_16x16x32_bf16 v[144:147], a[48:51], a[84:87], v[144:147]
buffer_load_dwordx4 v5, s[24:27], s58 offen lds
v_mfma_f32_16x16x32_bf16 v[64:67], a[64:67], a[48:51], v[64:67]
ds_read_b128 v[244:247], v11 offset:1408
v_cvt_pk_bf16_f32 v178, v88, v89
v_mfma_f32_16x16x32_bf16 v[80:83], a[68:71], a[48:51], v[80:83]
ds_read_b128 v[18:21], v11 offset:320
v_cvt_pk_bf16_f32 v179, v90, v91
v_mfma_f32_16x16x32_bf16 v[124:127], a[44:47], a[80:83], v[124:127]
ds_read_b128 v[22:25], v11 offset:1344
v_cvt_pk_bf16_f32 v188, v96, v97
v_mfma_f32_16x16x32_bf16 v[140:143], a[44:47], a[84:87], v[140:143]
buffer_load_dwordx4 v6, s[24:27], s58 offen offset:1024 lds
v_mfma_f32_16x16x32_bf16 v[60:63], a[64:67], a[44:47], v[60:63]
s_add_u32 m0, s59, 116480
s_mov_b32 s58, 786432
v_cvt_pk_bf16_f32 v189, v98, v99
v_mfma_f32_16x16x32_bf16 v[76:79], a[68:71], a[44:47], v[76:79]
ds_read_b128 v[240:243], v11 offset:256
v_cvt_pk_bf16_f32 v190, v112, v113
v_mfma_f32_16x16x32_bf16 v[104:107], v[192:195], v[176:179], v[46:49]
v_cvt_pk_bf16_f32 v191, v114, v115
v_cvt_pk_bf16_f32 v172, v68, v69
v_cvt_pk_bf16_f32 v173, v70, v71
v_cvt_pk_bf16_f32 v174, v84, v85
v_cvt_pk_bf16_f32 v175, v86, v87
v_pk_fma_f32 v[64:65], v[28:29], v[224:225], v[64:65] op_sel_hi:[1,0,1]
v_pk_fma_f32 v[66:67], v[30:31], v[224:225], v[66:67] op_sel_hi:[1,0,1]
s_waitcnt lgkmcnt(3)
v_pk_mul_f32 v[132:133], v[132:133], v[244:245]
v_pk_mul_f32 v[134:135], v[134:135], v[246:247]
v_pk_mul_f32 v[148:149], v[148:149], v[244:245]
v_pk_mul_f32 v[150:151], v[150:151], v[246:247]
s_waitcnt lgkmcnt(2)
v_pk_fma_f32 v[128:129], v[18:19], v[44:45], v[128:129] op_sel_hi:[1,0,1]
v_pk_fma_f32 v[130:131], v[20:21], v[44:45], v[130:131] op_sel_hi:[1,0,1]
v_pk_fma_f32 v[144:145], v[18:19], v[44:45], v[144:145] op_sel:[0,1,0] op_sel_hi:[1,1,1]
v_pk_fma_f32 v[146:147], v[20:21], v[44:45], v[146:147] op_sel:[0,1,0] op_sel_hi:[1,1,1]
s_waitcnt lgkmcnt(1)
v_pk_mul_f32 v[128:129], v[128:129], v[22:23]
v_pk_mul_f32 v[130:131], v[130:131], v[24:25]
v_pk_mul_f32 v[144:145], v[144:145], v[22:23]
v_pk_mul_f32 v[146:147], v[146:147], v[24:25]
v_pk_fma_f32 v[80:81], v[32:33], v[224:225], v[80:81] op_sel_hi:[1,0,1]
v_pk_fma_f32 v[82:83], v[34:35], v[224:225], v[82:83] op_sel_hi:[1,0,1]
v_pk_fma_f32 v[60:61], v[28:29], v[220:221], v[60:61] op_sel_hi:[1,0,1]
v_pk_fma_f32 v[62:63], v[30:31], v[220:221], v[62:63] op_sel_hi:[1,0,1]
v_pk_fma_f32 v[76:77], v[32:33], v[220:221], v[76:77] op_sel_hi:[1,0,1]
v_pk_fma_f32 v[78:79], v[34:35], v[220:221], v[78:79] op_sel_hi:[1,0,1]
v_cvt_pk_bf16_f32 v206, v132, v133
v_cvt_pk_bf16_f32 v207, v134, v135
v_mfma_f32_16x16x32_bf16 v[120:123], v[196:199], v[176:179], v[50:53]
buffer_load_dwordx4 v5, s[24:27], s58 offen lds
v_mfma_f32_16x16x32_bf16 v[100:103], v[188:191], v[172:175], v[46:49]
ds_read_b128 v[244:247], v11 offset:1280
v_cvt_pk_bf16_f32 v216, v148, v149
v_mfma_f32_16x16x32_bf16 v[116:119], v[192:195], v[172:175], v[50:53]
v_cvt_pk_bf16_f32 v217, v150, v151
v_max3_f32 v88, v104, v105, v106
s_nop 0
v_max3_f32 v89, v107, v120, v121
v_max3_f32 v88, v88, v122, v123
v_max_f32 v90, v88, v89
v_max_f32 v89, v88, v89
v_cvt_pk_bf16_f32 v204, v128, v129
buffer_load_dwordx4 v6, s[24:27], s58 offen offset:1024 lds
s_add_u32 m0, s59, 124800
s_mov_b32 s58, 917504
v_permlane16_swap_b32 v90, v89
v_cvt_pk_bf16_f32 v205, v130, v131
v_max_f32 v88, v90, v89
v_max_f32 v89, v90, v89
v_cvt_pk_bf16_f32 v214, v144, v145
v_cvt_pk_bf16_f32 v215, v146, v147
v_permlane32_swap_b32 v88, v89
v_max3_f32 v84, v100, v101, v102
v_max_f32 v88, v88, v89
buffer_load_dwordx4 v5, s[24:27], s58 offen lds
v_mul_f32 v88, v88, v234
v_pk_fma_f32 v[104:105], v[104:105], v[234:235], v[88:89] op_sel_hi:[1,0,0] neg_lo:[0,0,1] neg_hi:[0,0,1]
v_pk_fma_f32 v[106:107], v[106:107], v[234:235], v[88:89] op_sel_hi:[1,0,0] neg_lo:[0,0,1] neg_hi:[0,0,1]
v_pk_fma_f32 v[120:121], v[120:121], v[234:235], v[88:89] op_sel_hi:[1,0,0] neg_lo:[0,0,1] neg_hi:[0,0,1]
v_pk_fma_f32 v[122:123], v[122:123], v[234:235], v[88:89] op_sel_hi:[1,0,0] neg_lo:[0,0,1] neg_hi:[0,0,1]
v_exp_f32 v104, v104
v_exp_f32 v105, v105
v_exp_f32 v106, v106
v_exp_f32 v107, v107
v_exp_f32 v120, v120
v_exp_f32 v121, v121
v_exp_f32 v122, v122
v_exp_f32 v123, v123
v_cvt_pk_bf16_f32 v72, v104, v105
buffer_load_dwordx4 v6, s[24:27], s58 offen offset:1024 lds
v_cvt_pk_bf16_f32 v73, v106, v107
v_cvt_pk_bf16_f32 v74, v120, v121
v_cvt_pk_bf16_f32 v75, v122, v123
s_waitcnt lgkmcnt(1)
v_pk_fma_f32 v[124:125], v[240:241], v[44:45], v[124:125] op_sel_hi:[1,0,1]
s_waitcnt lgkmcnt(0)
v_pk_mul_f32 v[124:125], v[124:125], v[244:245]
v_pk_fma_f32 v[126:127], v[242:243], v[44:45], v[126:127] op_sel_hi:[1,0,1]
v_pk_mul_f32 v[126:127], v[126:127], v[246:247]
v_pk_fma_f32 v[140:141], v[240:241], v[44:45], v[140:141] op_sel:[0,1,0] op_sel_hi:[1,1,1]
v_pk_mul_f32 v[140:141], v[140:141], v[244:245]
v_pk_fma_f32 v[142:143], v[242:243], v[44:45], v[142:143] op_sel:[0,1,0] op_sel_hi:[1,1,1]
v_pk_mul_f32 v[142:143], v[142:143], v[246:247]
v_max3_f32 v85, v103, v116, v117
v_max3_f32 v84, v84, v118, v119
v_mfma_f32_16x16x32_bf16 v[88:91], v[248:251], v[72:75], 0
v_max_f32 v86, v84, v85
v_max_f32 v85, v84, v85
v_mfma_f32_16x16x32_bf16 v[104:107], v[206:209], v[72:75], 0
s_nop 0
v_permlane16_swap_b32 v86, v85
v_mfma_f32_16x16x32_bf16 v[120:123], v[216:219], v[72:75], 0
s_nop 1
v_rcp_f32 v88, v88
v_max_f32 v84, v86, v85
v_max_f32 v85, v86, v85
v_cvt_pk_bf16_f32 v184, v92, v93
v_pk_mul_f32 v[104:105], v[104:105], v[88:89] op_sel_hi:[1,0]
v_pk_mul_f32 v[106:107], v[106:107], v[88:89] op_sel_hi:[1,0]
v_pk_mul_f32 v[120:121], v[120:121], v[88:89] op_sel_hi:[1,0]
v_pk_mul_f32 v[122:123], v[122:123], v[88:89] op_sel_hi:[1,0]
v_cvt_pk_bf16_f32 v176, v104, v105
v_cvt_pk_bf16_f32 v177, v106, v107
v_cvt_pk_bf16_f32 v178, v120, v121
v_cvt_pk_bf16_f32 v179, v122, v123
buffer_store_dwordx4 v[176:179], v4, s[16:19], s74 offen offset:3072 sc1
v_permlane32_swap_b32 v84, v85
v_cvt_pk_bf16_f32 v185, v94, v95
v_max_f32 v84, v84, v85
v_mul_f32 v84, v84, v230
v_pk_fma_f32 v[100:101], v[100:101], v[230:231], v[84:85] op_sel_hi:[1,0,0] neg_lo:[0,0,1] neg_hi:[0,0,1]
v_pk_fma_f32 v[102:103], v[102:103], v[230:231], v[84:85] op_sel_hi:[1,0,0] neg_lo:[0,0,1] neg_hi:[0,0,1]
v_pk_fma_f32 v[116:117], v[116:117], v[230:231], v[84:85] op_sel_hi:[1,0,0] neg_lo:[0,0,1] neg_hi:[0,0,1]
v_pk_fma_f32 v[118:119], v[118:119], v[230:231], v[84:85] op_sel_hi:[1,0,0] neg_lo:[0,0,1] neg_hi:[0,0,1]
v_exp_f32 v100, v100
v_exp_f32 v101, v101
v_exp_f32 v102, v102
v_exp_f32 v103, v103
v_exp_f32 v116, v116
v_exp_f32 v117, v117
v_exp_f32 v118, v118
v_exp_f32 v119, v119
v_cvt_pk_bf16_f32 v68, v100, v101
v_cvt_pk_bf16_f32 v69, v102, v103
v_cvt_pk_bf16_f32 v70, v116, v117
v_cvt_pk_bf16_f32 v71, v118, v119
v_cvt_pk_bf16_f32 v186, v108, v109
v_cvt_pk_bf16_f32 v187, v110, v111
v_mfma_f32_16x16x32_bf16 v[84:87], v[248:251], v[68:71], 0
v_cvt_pk_bf16_f32 v168, v64, v65
v_cvt_pk_bf16_f32 v169, v66, v67
v_mfma_f32_16x16x32_bf16 v[100:103], v[204:207], v[68:71], 0
v_cvt_pk_bf16_f32 v170, v80, v81
v_cvt_pk_bf16_f32 v171, v82, v83
v_mfma_f32_16x16x32_bf16 v[116:119], v[214:217], v[68:71], 0
s_nop 1
v_rcp_f32 v84, v84
v_mfma_f32_16x16x32_bf16 v[96:99], v[184:187], v[168:171], v[46:49]
v_cvt_pk_bf16_f32 v202, v124, v125
v_cvt_pk_bf16_f32 v203, v126, v127
v_mfma_f32_16x16x32_bf16 v[112:115], v[188:191], v[168:171], v[50:53]
v_cvt_pk_bf16_f32 v212, v140, v141
v_cvt_pk_bf16_f32 v213, v142, v143
v_cvt_pk_bf16_f32 v164, v60, v61
s_nop 1
v_max3_f32 v80, v96, v97, v98
v_cvt_pk_bf16_f32 v165, v62, v63
v_pk_mul_f32 v[100:101], v[100:101], v[84:85] op_sel_hi:[1,0]
v_pk_mul_f32 v[102:103], v[102:103], v[84:85] op_sel_hi:[1,0]
v_pk_mul_f32 v[116:117], v[116:117], v[84:85] op_sel_hi:[1,0]
v_pk_mul_f32 v[118:119], v[118:119], v[84:85] op_sel_hi:[1,0]
v_cvt_pk_bf16_f32 v172, v100, v101
v_cvt_pk_bf16_f32 v173, v102, v103
v_cvt_pk_bf16_f32 v174, v116, v117
v_cvt_pk_bf16_f32 v175, v118, v119
buffer_store_dwordx4 v[172:175], v4, s[16:19], s74 offen offset:2048 sc1
v_max3_f32 v81, v99, v112, v113
v_max3_f32 v80, v80, v114, v115
v_max_f32 v82, v80, v81
v_max_f32 v81, v80, v81
v_cvt_pk_bf16_f32 v166, v76, v77
v_cvt_pk_bf16_f32 v167, v78, v79
v_permlane16_swap_b32 v82, v81
s_nop 0
v_mfma_f32_16x16x32_bf16 v[92:95], v[180:183], v[164:167], v[46:49]
v_max_f32 v80, v82, v81
v_max_f32 v81, v82, v81
v_mfma_f32_16x16x32_bf16 v[108:111], v[184:187], v[164:167], v[50:53]
s_nop 0
v_permlane32_swap_b32 v80, v81
v_max_f32 v80, v80, v81
v_mul_f32 v80, v80, v226
v_pk_fma_f32 v[96:97], v[96:97], v[226:227], v[80:81] op_sel_hi:[1,0,0] neg_lo:[0,0,1] neg_hi:[0,0,1]
v_pk_fma_f32 v[98:99], v[98:99], v[226:227], v[80:81] op_sel_hi:[1,0,0] neg_lo:[0,0,1] neg_hi:[0,0,1]
v_pk_fma_f32 v[112:113], v[112:113], v[226:227], v[80:81] op_sel_hi:[1,0,0] neg_lo:[0,0,1] neg_hi:[0,0,1]
v_pk_fma_f32 v[114:115], v[114:115], v[226:227], v[80:81] op_sel_hi:[1,0,0] neg_lo:[0,0,1] neg_hi:[0,0,1]
v_exp_f32 v96, v96
v_exp_f32 v97, v97
v_exp_f32 v98, v98
v_exp_f32 v99, v99
v_exp_f32 v112, v112
v_exp_f32 v113, v113
v_exp_f32 v114, v114
v_exp_f32 v115, v115
v_cvt_pk_bf16_f32 v64, v96, v97
v_cvt_pk_bf16_f32 v65, v98, v99
v_cvt_pk_bf16_f32 v66, v112, v113
v_cvt_pk_bf16_f32 v67, v114, v115
v_max3_f32 v76, v92, v93, v94
v_max3_f32 v77, v95, v108, v109
v_mfma_f32_16x16x32_bf16 v[80:83], v[248:251], v[64:67], 0
v_max3_f32 v76, v76, v110, v111
v_max_f32 v78, v76, v77
v_mfma_f32_16x16x32_bf16 v[96:99], v[202:205], v[64:67], 0
v_max_f32 v77, v76, v77
v_mfma_f32_16x16x32_bf16 v[112:115], v[212:215], v[64:67], 0
s_nop 2
v_rcp_f32 v80, v80
v_permlane16_swap_b32 v78, v77
s_nop 0
v_pk_mul_f32 v[96:97], v[96:97], v[80:81] op_sel_hi:[1,0]
v_pk_mul_f32 v[98:99], v[98:99], v[80:81] op_sel_hi:[1,0]
v_pk_mul_f32 v[112:113], v[112:113], v[80:81] op_sel_hi:[1,0]
v_pk_mul_f32 v[114:115], v[114:115], v[80:81] op_sel_hi:[1,0]
v_cvt_pk_bf16_f32 v168, v96, v97
v_cvt_pk_bf16_f32 v169, v98, v99
v_cvt_pk_bf16_f32 v170, v112, v113
v_cvt_pk_bf16_f32 v171, v114, v115
buffer_store_dwordx4 v[168:171], v4, s[16:19], s74 offen offset:1024 sc1
v_max_f32 v76, v78, v77
v_max_f32 v77, v78, v77
s_nop 1
v_permlane32_swap_b32 v76, v77
v_max_f32 v76, v76, v77
v_mul_f32 v76, v76, v222
v_pk_fma_f32 v[92:93], v[92:93], v[222:223], v[76:77] op_sel_hi:[1,0,0] neg_lo:[0,0,1] neg_hi:[0,0,1]
v_pk_fma_f32 v[94:95], v[94:95], v[222:223], v[76:77] op_sel_hi:[1,0,0] neg_lo:[0,0,1] neg_hi:[0,0,1]
v_pk_fma_f32 v[108:109], v[108:109], v[222:223], v[76:77] op_sel_hi:[1,0,0] neg_lo:[0,0,1] neg_hi:[0,0,1]
v_pk_fma_f32 v[110:111], v[110:111], v[222:223], v[76:77] op_sel_hi:[1,0,0] neg_lo:[0,0,1] neg_hi:[0,0,1]
v_exp_f32 v92, v92
v_exp_f32 v93, v93
v_exp_f32 v94, v94
v_exp_f32 v95, v95
v_exp_f32 v108, v108
v_exp_f32 v109, v109
v_exp_f32 v110, v110
v_exp_f32 v111, v111
v_cvt_pk_bf16_f32 v60, v92, v93
v_cvt_pk_bf16_f32 v61, v94, v95
v_cvt_pk_bf16_f32 v62, v108, v109
v_cvt_pk_bf16_f32 v63, v110, v111
s_nop 1
v_mfma_f32_16x16x32_bf16 v[76:79], v[248:251], v[60:63], 0
v_mfma_f32_16x16x32_bf16 v[92:95], v[200:203], v[60:63], 0
v_mfma_f32_16x16x32_bf16 v[108:111], v[210:213], v[60:63], 0
s_nop 5
v_rcp_f32 v76, v76
s_nop 0
v_pk_mul_f32 v[92:93], v[92:93], v[76:77] op_sel_hi:[1,0]
v_pk_mul_f32 v[94:95], v[94:95], v[76:77] op_sel_hi:[1,0]
v_pk_mul_f32 v[108:109], v[108:109], v[76:77] op_sel_hi:[1,0]
v_pk_mul_f32 v[110:111], v[110:111], v[76:77] op_sel_hi:[1,0]
v_cvt_pk_bf16_f32 v164, v92, v93
v_cvt_pk_bf16_f32 v165, v94, v95
v_cvt_pk_bf16_f32 v166, v108, v109
v_cvt_pk_bf16_f32 v167, v110, v111
buffer_store_dwordx4 v[164:167], v4, s[16:19], s74 offen sc1
s_nop 1
.Lqkve61:
.Lpad17:
s_cbranch_execz .Lnopoll58r
s_lshl_b32 s62, s6, 13
s_lshl_b32 s63, s3, 11
s_add_u32 s62, s62, s63
v_lshl_add_u32 v4, v1, 4, s62
v_lshrrev_b32 v2, 3, v1
v_cmp_eq_u32 vcc, 3, v2
v_add_u32 v2, 67108480, v4
s_nop 0
v_cndmask_b32 v4, v4, v2, vcc
v_bfe_u32 v5, v1, 3, 1
v_lshrrev_b32 v2, 4, v1
v_lshl_add_u32 v5, v2, 3, v5
s_lshl_b32 s62, s3, 1
v_add_u32 v5, s62, v5
v_mul_u32_u24 v5, 2048, v5
v_and_b32 v2, 7, v1
v_lshl_add_u32 v5, v2, 4, v5
s_lshl_b32 s62, s7, 7
v_add_u32 v5, s62, v5
v_add_u32 v6, 64512, v5
v_bfe_u32 v8, v1, 3, 2
v_mul_u32_u24 v8, 2080, v8
v_bfe_u32 v2, v1, 2, 1
v_lshl_add_u32 v8, v2, 7, v8
v_bfe_u32 v2, v1, 5, 1
v_lshl_add_u32 v8, v2, 8, v8
v_and_b32 v2, 3, v1
v_lshl_add_u32 v8, v2, 3, v8
s_mov_b32 s57, 66560
v_add_u32 v7, s57, v8
s_mov_b32 s52, 37748736
s_mov_b32 s53, 37879808
s_mov_b32 s54, 2097152
s_mul_i32 s56, s3, 2080
v_accvgpr_read_b32 v32, a224
v_accvgpr_read_b32 v33, a225
v_accvgpr_read_b32 v34, a226
v_accvgpr_read_b32 v35, a227
v_accvgpr_read_b32 v36, a228
v_accvgpr_read_b32 v37, a229
v_accvgpr_read_b32 v38, a230
v_accvgpr_read_b32 v39, a231
v_accvgpr_read_b32 v40, a232
v_accvgpr_read_b32 v41, a233
v_accvgpr_read_b32 v42, a234
v_accvgpr_read_b32 v43, a235
v_accvgpr_read_b32 v44, a236
v_accvgpr_read_b32 v45, a237
v_accvgpr_read_b32 v46, a238
v_accvgpr_read_b32 v47, a239
v_accvgpr_read_b32 v48, a240
v_accvgpr_read_b32 v49, a241
v_accvgpr_read_b32 v50, a242
v_accvgpr_read_b32 v51, a243
v_accvgpr_read_b32 v52, a244
v_accvgpr_read_b32 v53, a245
v_accvgpr_read_b32 v54, a246
v_accvgpr_read_b32 v55, a247
v_accvgpr_read_b32 v56, a248
v_accvgpr_read_b32 v57, a249
v_accvgpr_read_b32 v58, a250
v_accvgpr_read_b32 v59, a251
v_accvgpr_read_b32 v60, a252
v_accvgpr_read_b32 v61, a253
v_accvgpr_read_b32 v62, a254
v_accvgpr_read_b32 v63, a255
s_and_b32 s62, s3, 1
s_mul_i32 s62, s62, 28672
s_add_u32 s62, s62, s51
v_lshrrev_b32 v12, 4, v1
v_mul_u32_u24 v12, 57344, v12
v_and_b32 v2, 15, v1
v_lshl_add_u32 v12, v2, 4, v12
v_add_u32 v12, s62, v12
v_add_u32 v13, 6112, v12
v_add_u32 v14, 12224, v12
v_add_u32 v15, 18336, v12
s_mul_i32 s59, s3, 4224
s_mov_b32 s58, 0
s_lshl_b32 s62, s8, 10
s_add_u32 s62, s62, 30490624
s_lshl_b32 s64, s6, 10
s_add_u32 s64, s64, 30490624
s_lshr_b32 s67, s5, 2
s_and_b32 s67, s67, 3
s_lshl_b32 s67, s67, 7
s_add_u32 s64, s64, s67
v_lshl_add_u32 v252, v1, 7, s62
v_mov_b32 v253, s64
s_waitcnt vmcnt(0) lgkmcnt(0)
s_barrier
s_cmp_lg_u32 s3, 0
s_cbranch_scc1 .Lnosig64
v_mov_b32 v255, 1
s_mov_b64 exec, 15
buffer_atomic_add v255, v252, s[16:19], 0 offen
s_mov_b64 exec, -1
.Lnosig64:
s_cmp_lg_u32 s3, 1
s_cbranch_scc1 .Lnopoll67
s_mov_b64 exec, 1
s_mov_b32 s15, 0
s_mov_b64 exec, 1
v_mov_b32 v254, 0
buffer_atomic_add v254, v253, s[16:19], 0 offen sc0
.Lpoll65:
s_waitcnt vmcnt(0)
v_cmp_ne_u32 vcc, 16, v254
s_add_u32 s15, s15, 1
s_cbranch_vccz .Lnopoll67r
s_mov_b64 exec, 1
v_mov_b32 v254, 0
buffer_atomic_add v254, v253, s[16:19], 0 offen sc0
s_cmp_le_u32 s15, 100000
s_cbranch_scc1 .Lpoll65
.Lgot66:
s_waitcnt vmcnt(0)
s_branch .Lnopoll67r
.Lnopoll67:
s_mov_b64 exec, 0
s_cmp_eq_u32 s3, 2
s_cbranch_scc1 .Lpad18
s_cmp_eq_u32 s3, 3
s_cbranch_scc1 .Lpad19
s_branch .Lnopoll67r
.Lnopoll67r:
s_mov_b64 exec, -1
s_barrier
buffer_load_dwordx4 v[64:67], v4, s[16:19], s52 offen sc1
buffer_load_dwordx4 v[68:71], v4, s[16:19], s52 offen offset:1024 sc1
s_add_u32 s52, s52, 0x40000
buffer_load_dwordx4 v[72:75], v4, s[16:19], s53 offen sc1
buffer_load_dwordx4 v[76:79], v4, s[16:19], s53 offen offset:1024 sc1
s_add_u32 s53, s53, 0x40000
buffer_load_dwordx4 v[80:83], v4, s[16:19], s52 offen sc1
buffer_load_dwordx4 v[84:87], v4, s[16:19], s52 offen offset:1024 sc1
s_add_u32 s52, s52, 0x40000
buffer_load_dwordx4 v[88:91], v4, s[16:19], s53 offen sc1
buffer_load_dwordx4 v[92:95], v4, s[16:19], s53 offen offset:1024 sc1
s_add_u32 s53, s53, 0x40000
buffer_load_dwordx4 v[96:99], v4, s[16:19], s52 offen sc1
buffer_load_dwordx4 v[100:103], v4, s[16:19], s52 offen offset:1024 sc1
s_add_u32 s52, s52, 0x40000
buffer_load_dwordx4 v[104:107], v4, s[16:19], s53 offen sc1
buffer_load_dwordx4 v[108:111], v4, s[16:19], s53 offen offset:1024 sc1
s_add_u32 s53, s53, 0x40000
ds_read_b64_tr_b16 a[0:1], v7
ds_read_b64_tr_b16 a[2:3], v7 offset:512
ds_read_b64_tr_b16 a[4:5], v7 offset:32
ds_read_b64_tr_b16 a[6:7], v7 offset:544
ds_read_b64_tr_b16 a[8:9], v7 offset:64
ds_read_b64_tr_b16 a[10:11], v7 offset:576
ds_read_b64_tr_b16 a[12:13], v7 offset:96
ds_read_b64_tr_b16 a[14:15], v7 offset:608
ds_read_b64_tr_b16 a[16:17], v7 offset:1024
ds_read_b64_tr_b16 a[18:19], v7 offset:1536
ds_read_b64_tr_b16 a[20:21], v7 offset:1056
ds_read_b64_tr_b16 a[22:23], v7 offset:1568
ds_read_b64_tr_b16 a[24:25], v7 offset:1088
ds_read_b64_tr_b16 a[26:27], v7 offset:1600
ds_read_b64_tr_b16 a[28:29], v7 offset:1120
ds_read_b64_tr_b16 a[30:31], v7 offset:1632
s_waitcnt vmcnt(11) lgkmcnt(14)
v_mfma_f32_16x16x32_bf16 v[32:35], a[0:3], v[64:67], v[32:35]
ds_read_b64_tr_b16 a[32:33], v7 offset:8320
ds_read_b64_tr_b16 a[34:35], v7 offset:8832
s_waitcnt vmcnt(10)
v_mfma_f32_16x16x32_bf16 v[48:51], a[0:3], v[68:71], v[48:51]
buffer_load_dwordx4 v[112:115], v4, s[16:19], s52 offen sc1
s_waitcnt lgkmcnt(14)
v_mfma_f32_16x16x32_bf16 v[52:55], a[4:7], v[68:71], v[52:55]
ds_read_b64_tr_b16 a[36:37], v7 offset:8352
ds_read_b64_tr_b16 a[38:39], v7 offset:8864
v_mfma_f32_16x16x32_bf16 v[36:39], a[4:7], v[64:67], v[36:39]
ds_read_b64_tr_b16 a[40:41], v7 offset:8384
ds_read_b64_tr_b16 a[42:43], v7 offset:8896
s_waitcnt lgkmcnt(15)
v_mfma_f32_16x16x32_bf16 v[40:43], a[8:11], v[64:67], v[40:43]
buffer_load_dwordx4 v[116:119], v4, s[16:19], s52 offen offset:1024 sc1
v_mfma_f32_16x16x32_bf16 v[56:59], a[8:11], v[68:71], v[56:59]
ds_read_b64_tr_b16 a[44:45], v7 offset:8416
s_add_u32 s52, s52, 0x40000
s_waitcnt lgkmcnt(15)
v_mfma_f32_16x16x32_bf16 v[60:63], a[12:15], v[68:71], v[60:63]
ds_read_b64_tr_b16 a[46:47], v7 offset:8928
v_mfma_f32_16x16x32_bf16 v[44:47], a[12:15], v[64:67], v[44:47]
ds_read_b64_tr_b16 a[48:49], v7 offset:9344
ds_read_b64_tr_b16 a[50:51], v7 offset:9856
s_waitcnt vmcnt(11) lgkmcnt(15)
v_mfma_f32_16x16x32_bf16 v[32:35], a[16:19], v[72:75], v[32:35]
buffer_load_dwordx4 v[120:123], v4, s[16:19], s53 offen sc1
s_waitcnt vmcnt(11)
v_mfma_f32_16x16x32_bf16 v[48:51], a[16:19], v[76:79], v[48:51]
ds_read_b64_tr_b16 a[52:53], v7 offset:9376
ds_read_b64_tr_b16 a[54:55], v7 offset:9888
s_waitcnt lgkmcnt(15)
v_mfma_f32_16x16x32_bf16 v[52:55], a[20:23], v[76:79], v[52:55]
ds_read_b64_tr_b16 a[56:57], v7 offset:9408
ds_read_b64_tr_b16 a[58:59], v7 offset:9920
v_mfma_f32_16x16x32_bf16 v[36:39], a[20:23], v[72:75], v[36:39]
buffer_load_dwordx4 v[124:127], v4, s[16:19], s53 offen offset:1024 sc1
s_waitcnt lgkmcnt(15)
v_mfma_f32_16x16x32_bf16 v[40:43], a[24:27], v[72:75], v[40:43]
ds_read_b64_tr_b16 a[60:61], v7 offset:9440
s_add_u32 s53, s53, 0x40000
v_mfma_f32_16x16x32_bf16 v[56:59], a[24:27], v[76:79], v[56:59]
ds_read_b64_tr_b16 a[62:63], v7 offset:9952
s_waitcnt lgkmcnt(15)
v_mfma_f32_16x16x32_bf16 v[60:63], a[28:31], v[76:79], v[60:63]
v_mfma_f32_16x16x32_bf16 v[44:47], a[28:31], v[72:75], v[44:47]
s_waitcnt vmcnt(11) lgkmcnt(14)
v_mfma_f32_16x16x32_bf16 v[32:35], a[32:35], v[80:83], v[32:35]
ds_read_b64_tr_b16 a[0:1], v7 offset:16640
ds_read_b64_tr_b16 a[2:3], v7 offset:17152
s_waitcnt vmcnt(10)
v_mfma_f32_16x16x32_bf16 v[48:51], a[32:35], v[84:87], v[48:51]
buffer_load_dwordx4 v[64:67], v4, s[16:19], s52 offen sc1
s_waitcnt lgkmcnt(14)
v_mfma_f32_16x16x32_bf16 v[52:55], a[36:39], v[84:87], v[52:55]
ds_read_b64_tr_b16 a[4:5], v7 offset:16672
ds_read_b64_tr_b16 a[6:7], v7 offset:17184
v_mfma_f32_16x16x32_bf16 v[36:39], a[36:39], v[80:83], v[36:39]
ds_read_b64_tr_b16 a[8:9], v7 offset:16704
ds_read_b64_tr_b16 a[10:11], v7 offset:17216
s_waitcnt lgkmcnt(15)
v_mfma_f32_16x16x32_bf16 v[40:43], a[40:43], v[80:83], v[40:43]
buffer_load_dwordx4 v[68:71], v4, s[16:19], s52 offen offset:1024 sc1
v_mfma_f32_16x16x32_bf16 v[56:59], a[40:43], v[84:87], v[56:59]
ds_read_b64_tr_b16 a[12:13], v7 offset:16736
s_add_u32 s52, s52, 0x40000
s_waitcnt lgkmcnt(15)
v_mfma_f32_16x16x32_bf16 v[60:63], a[44:47], v[84:87], v[60:63]
ds_read_b64_tr_b16 a[14:15], v7 offset:17248
v_mfma_f32_16x16x32_bf16 v[44:47], a[44:47], v[80:83], v[44:47]
ds_read_b64_tr_b16 a[16:17], v7 offset:17664
ds_read_b64_tr_b16 a[18:19], v7 offset:18176
s_waitcnt vmcnt(11) lgkmcnt(15)
v_mfma_f32_16x16x32_bf16 v[32:35], a[48:51], v[88:91], v[32:35]
buffer_load_dwordx4 v[72:75], v4, s[16:19], s53 offen sc1
s_waitcnt vmcnt(11)
v_mfma_f32_16x16x32_bf16 v[48:51], a[48:51], v[92:95], v[48:51]
ds_read_b64_tr_b16 a[20:21], v7 offset:17696
ds_read_b64_tr_b16 a[22:23], v7 offset:18208
s_waitcnt lgkmcnt(15)
v_mfma_f32_16x16x32_bf16 v[52:55], a[52:55], v[92:95], v[52:55]
ds_read_b64_tr_b16 a[24:25], v7 offset:17728
ds_read_b64_tr_b16 a[26:27], v7 offset:18240
v_mfma_f32_16x16x32_bf16 v[36:39], a[52:55], v[88:91], v[36:39]
buffer_load_dwordx4 v[76:79], v4, s[16:19], s53 offen offset:1024 sc1
s_waitcnt lgkmcnt(15)
v_mfma_f32_16x16x32_bf16 v[40:43], a[56:59], v[88:91], v[40:43]
ds_read_b64_tr_b16 a[28:29], v7 offset:17760
s_add_u32 s53, s53, 0x40000
v_mfma_f32_16x16x32_bf16 v[56:59], a[56:59], v[92:95], v[56:59]
ds_read_b64_tr_b16 a[30:31], v7 offset:18272
s_waitcnt lgkmcnt(15)
v_mfma_f32_16x16x32_bf16 v[60:63], a[60:63], v[92:95], v[60:63]
v_mfma_f32_16x16x32_bf16 v[44:47], a[60:63], v[88:91], v[44:47]
s_waitcnt vmcnt(11) lgkmcnt(14)
v_mfma_f32_16x16x32_bf16 v[32:35], a[0:3], v[96:99], v[32:35]
ds_read_b64_tr_b16 a[32:33], v7 offset:24960
ds_read_b64_tr_b16 a[34:35], v7 offset:25472
s_waitcnt vmcnt(10)
v_mfma_f32_16x16x32_bf16 v[48:51], a[0:3], v[100:103], v[48:51]
buffer_load_dwordx4 v[80:83], v4, s[16:19], s52 offen sc1
s_waitcnt lgkmcnt(14)
v_mfma_f32_16x16x32_bf16 v[52:55], a[4:7], v[100:103], v[52:55]
ds_read_b64_tr_b16 a[36:37], v7 offset:24992
ds_read_b64_tr_b16 a[38:39], v7 offset:25504
v_mfma_f32_16x16x32_bf16 v[36:39], a[4:7], v[96:99], v[36:39]
ds_read_b64_tr_b16 a[40:41], v7 offset:25024
ds_read_b64_tr_b16 a[42:43], v7 offset:25536
s_waitcnt lgkmcnt(15)
v_mfma_f32_16x16x32_bf16 v[40:43], a[8:11], v[96:99], v[40:43]
.Lpad18:
s_cbranch_execz .Lnopoll67r
buffer_load_dwordx4 v[84:87], v4, s[16:19], s52 offen offset:1024 sc1
v_mfma_f32_16x16x32_bf16 v[56:59], a[8:11], v[100:103], v[56:59]
ds_read_b64_tr_b16 a[44:45], v7 offset:25056
s_add_u32 s52, s52, 0x40000
s_waitcnt lgkmcnt(15)
v_mfma_f32_16x16x32_bf16 v[60:63], a[12:15], v[100:103], v[60:63]
ds_read_b64_tr_b16 a[46:47], v7 offset:25568
v_mfma_f32_16x16x32_bf16 v[44:47], a[12:15], v[96:99], v[44:47]
ds_read_b64_tr_b16 a[48:49], v7 offset:25984
ds_read_b64_tr_b16 a[50:51], v7 offset:26496
s_waitcnt vmcnt(11) lgkmcnt(15)
v_mfma_f32_16x16x32_bf16 v[32:35], a[16:19], v[104:107], v[32:35]
buffer_load_dwordx4 v[88:91], v4, s[16:19], s53 offen sc1
s_waitcnt vmcnt(11)
v_mfma_f32_16x16x32_bf16 v[48:51], a[16:19], v[108:111], v[48:51]
ds_read_b64_tr_b16 a[52:53], v7 offset:26016
ds_read_b64_tr_b16 a[54:55], v7 offset:26528
s_waitcnt lgkmcnt(15)
v_mfma_f32_16x16x32_bf16 v[52:55], a[20:23], v[108:111], v[52:55]
ds_read_b64_tr_b16 a[56:57], v7 offset:26048
ds_read_b64_tr_b16 a[58:59], v7 offset:26560
v_mfma_f32_16x16x32_bf16 v[36:39], a[20:23], v[104:107], v[36:39]
buffer_load_dwordx4 v[92:95], v4, s[16:19], s53 offen offset:1024 sc1
s_waitcnt lgkmcnt(15)
v_mfma_f32_16x16x32_bf16 v[40:43], a[24:27], v[104:107], v[40:43]
ds_read_b64_tr_b16 a[60:61], v7 offset:26080
s_add_u32 s53, s53, 0x40000
v_mfma_f32_16x16x32_bf16 v[56:59], a[24:27], v[108:111], v[56:59]
ds_read_b64_tr_b16 a[62:63], v7 offset:26592
s_waitcnt lgkmcnt(15)
v_mfma_f32_16x16x32_bf16 v[60:63], a[28:31], v[108:111], v[60:63]
v_mfma_f32_16x16x32_bf16 v[44:47], a[28:31], v[104:107], v[44:47]
s_waitcnt vmcnt(11) lgkmcnt(14)
v_mfma_f32_16x16x32_bf16 v[32:35], a[32:35], v[112:115], v[32:35]
ds_read_b64_tr_b16 a[0:1], v7 offset:33280
ds_read_b64_tr_b16 a[2:3], v7 offset:33792
s_waitcnt vmcnt(10)
v_mfma_f32_16x16x32_bf16 v[48:51], a[32:35], v[116:119], v[48:51]
buffer_load_dwordx4 v[96:99], v4, s[16:19], s52 offen sc1
s_waitcnt lgkmcnt(14)
v_mfma_f32_16x16x32_bf16 v[52:55], a[36:39], v[116:119], v[52:55]
ds_read_b64_tr_b16 a[4:5], v7 offset:33312
ds_read_b64_tr_b16 a[6:7], v7 offset:33824
v_mfma_f32_16x16x32_bf16 v[36:39], a[36:39], v[112:115], v[36:39]
ds_read_b64_tr_b16 a[8:9], v7 offset:33344
ds_read_b64_tr_b16 a[10:11], v7 offset:33856
s_waitcnt lgkmcnt(15)
v_mfma_f32_16x16x32_bf16 v[40:43], a[40:43], v[112:115], v[40:43]
buffer_load_dwordx4 v[100:103], v4, s[16:19], s52 offen offset:1024 sc1
v_mfma_f32_16x16x32_bf16 v[56:59], a[40:43], v[116:119], v[56:59]
ds_read_b64_tr_b16 a[12:13], v7 offset:33376
s_add_u32 s52, s52, 0x40000
s_waitcnt lgkmcnt(15)
v_mfma_f32_16x16x32_bf16 v[60:63], a[44:47], v[116:119], v[60:63]
ds_read_b64_tr_b16 a[14:15], v7 offset:33888
v_mfma_f32_16x16x32_bf16 v[44:47], a[44:47], v[112:115], v[44:47]
ds_read_b64_tr_b16 a[16:17], v7 offset:34304
ds_read_b64_tr_b16 a[18:19], v7 offset:34816
s_waitcnt vmcnt(11) lgkmcnt(15)
v_mfma_f32_16x16x32_bf16 v[32:35], a[48:51], v[120:123], v[32:35]
buffer_load_dwordx4 v[104:107], v4, s[16:19], s53 offen sc1
s_waitcnt vmcnt(11)
v_mfma_f32_16x16x32_bf16 v[48:51], a[48:51], v[124:127], v[48:51]
ds_read_b64_tr_b16 a[20:21], v7 offset:34336
ds_read_b64_tr_b16 a[22:23], v7 offset:34848
s_waitcnt lgkmcnt(15)
v_mfma_f32_16x16x32_bf16 v[52:55], a[52:55], v[124:127], v[52:55]
ds_read_b64_tr_b16 a[24:25], v7 offset:34368
ds_read_b64_tr_b16 a[26:27], v7 offset:34880
v_mfma_f32_16x16x32_bf16 v[36:39], a[52:55], v[120:123], v[36:39]
buffer_load_dwordx4 v[108:111], v4, s[16:19], s53 offen offset:1024 sc1
s_waitcnt lgkmcnt(15)
v_mfma_f32_16x16x32_bf16 v[40:43], a[56:59], v[120:123], v[40:43]
ds_read_b64_tr_b16 a[28:29], v7 offset:34400
s_add_u32 s53, s53, 0x40000
v_mfma_f32_16x16x32_bf16 v[56:59], a[56:59], v[124:127], v[56:59]
ds_read_b64_tr_b16 a[30:31], v7 offset:34912
s_waitcnt lgkmcnt(15)
v_mfma_f32_16x16x32_bf16 v[60:63], a[60:63], v[124:127], v[60:63]
v_mfma_f32_16x16x32_bf16 v[44:47], a[60:63], v[120:123], v[44:47]
s_waitcnt vmcnt(11) lgkmcnt(14)
v_mfma_f32_16x16x32_bf16 v[32:35], a[0:3], v[64:67], v[32:35]
ds_read_b64_tr_b16 a[32:33], v7 offset:41600
ds_read_b64_tr_b16 a[34:35], v7 offset:42112
s_waitcnt vmcnt(10)
v_mfma_f32_16x16x32_bf16 v[48:51], a[0:3], v[68:71], v[48:51]
buffer_load_dwordx4 v[112:115], v4, s[16:19], s52 offen sc1
s_waitcnt lgkmcnt(14)
v_mfma_f32_16x16x32_bf16 v[52:55], a[4:7], v[68:71], v[52:55]
ds_read_b64_tr_b16 a[36:37], v7 offset:41632
ds_read_b64_tr_b16 a[38:39], v7 offset:42144
v_mfma_f32_16x16x32_bf16 v[36:39], a[4:7], v[64:67], v[36:39]
ds_read_b64_tr_b16 a[40:41], v7 offset:41664
ds_read_b64_tr_b16 a[42:43], v7 offset:42176
s_waitcnt lgkmcnt(15)
v_mfma_f32_16x16x32_bf16 v[40:43], a[8:11], v[64:67], v[40:43]
buffer_load_dwordx4 v[116:119], v4, s[16:19], s52 offen offset:1024 sc1
v_mfma_f32_16x16x32_bf16 v[56:59], a[8:11], v[68:71], v[56:59]
ds_read_b64_tr_b16 a[44:45], v7 offset:41696
s_add_u32 s52, s52, 0x40000
s_waitcnt lgkmcnt(15)
v_mfma_f32_16x16x32_bf16 v[60:63], a[12:15], v[68:71], v[60:63]
ds_read_b64_tr_b16 a[46:47], v7 offset:42208
v_mfma_f32_16x16x32_bf16 v[44:47], a[12:15], v[64:67], v[44:47]
ds_read_b64_tr_b16 a[48:49], v7 offset:42624
ds_read_b64_tr_b16 a[50:51], v7 offset:43136
s_waitcnt vmcnt(11) lgkmcnt(15)
v_mfma_f32_16x16x32_bf16 v[32:35], a[16:19], v[72:75], v[32:35]
buffer_load_dwordx4 v[120:123], v4, s[16:19], s53 offen sc1
s_waitcnt vmcnt(11)
v_mfma_f32_16x16x32_bf16 v[48:51], a[16:19], v[76:79], v[48:51]
ds_read_b64_tr_b16 a[52:53], v7 offset:42656
ds_read_b64_tr_b16 a[54:55], v7 offset:43168
s_waitcnt lgkmcnt(15)
v_mfma_f32_16x16x32_bf16 v[52:55], a[20:23], v[76:79], v[52:55]
ds_read_b64_tr_b16 a[56:57], v7 offset:42688
ds_read_b64_tr_b16 a[58:59], v7 offset:43200
v_mfma_f32_16x16x32_bf16 v[36:39], a[20:23], v[72:75], v[36:39]
buffer_load_dwordx4 v[124:127], v4, s[16:19], s53 offen offset:1024 sc1
s_waitcnt lgkmcnt(15)
v_mfma_f32_16x16x32_bf16 v[40:43], a[24:27], v[72:75], v[40:43]
ds_read_b64_tr_b16 a[60:61], v7 offset:42720
s_add_u32 s53, s53, 0x40000
v_mfma_f32_16x16x32_bf16 v[56:59], a[24:27], v[76:79], v[56:59]
ds_read_b64_tr_b16 a[62:63], v7 offset:43232
s_waitcnt lgkmcnt(15)
v_mfma_f32_16x16x32_bf16 v[60:63], a[28:31], v[76:79], v[60:63]
v_mfma_f32_16x16x32_bf16 v[44:47], a[28:31], v[72:75], v[44:47]
s_waitcnt vmcnt(11) lgkmcnt(14)
v_mfma_f32_16x16x32_bf16 v[32:35], a[32:35], v[80:83], v[32:35]
ds_read_b64_tr_b16 a[0:1], v7 offset:49920
ds_read_b64_tr_b16 a[2:3], v7 offset:50432
s_waitcnt vmcnt(10)
v_mfma_f32_16x16x32_bf16 v[48:51], a[32:35], v[84:87], v[48:51]
buffer_load_dwordx4 v[64:67], v4, s[16:19], s52 offen sc1
s_waitcnt lgkmcnt(14)
v_mfma_f32_16x16x32_bf16 v[52:55], a[36:39], v[84:87], v[52:55]
ds_read_b64_tr_b16 a[4:5], v7 offset:49952
ds_read_b64_tr_b16 a[6:7], v7 offset:50464
v_mfma_f32_16x16x32_bf16 v[36:39], a[36:39], v[80:83], v[36:39]
ds_read_b64_tr_b16 a[8:9], v7 offset:49984
ds_read_b64_tr_b16 a[10:11], v7 offset:50496
s_waitcnt lgkmcnt(15)
v_mfma_f32_16x16x32_bf16 v[40:43], a[40:43], v[80:83], v[40:43]
buffer_load_dwordx4 v[68:71], v4, s[16:19], s52 offen offset:1024 sc1
v_mfma_f32_16x16x32_bf16 v[56:59], a[40:43], v[84:87], v[56:59]
ds_read_b64_tr_b16 a[12:13], v7 offset:50016
s_add_u32 s52, s52, 0x40000
s_waitcnt lgkmcnt(15)
v_mfma_f32_16x16x32_bf16 v[60:63], a[44:47], v[84:87], v[60:63]
ds_read_b64_tr_b16 a[14:15], v7 offset:50528
v_mfma_f32_16x16x32_bf16 v[44:47], a[44:47], v[80:83], v[44:47]
ds_read_b64_tr_b16 a[16:17], v7 offset:50944
ds_read_b64_tr_b16 a[18:19], v7 offset:51456
s_waitcnt vmcnt(11) lgkmcnt(15)
v_mfma_f32_16x16x32_bf16 v[32:35], a[48:51], v[88:91], v[32:35]
buffer_load_dwordx4 v[72:75], v4, s[16:19], s53 offen sc1
s_waitcnt vmcnt(11)
v_mfma_f32_16x16x32_bf16 v[48:51], a[48:51], v[92:95], v[48:51]
ds_read_b64_tr_b16 a[20:21], v7 offset:50976
ds_read_b64_tr_b16 a[22:23], v7 offset:51488
s_waitcnt lgkmcnt(15)
v_mfma_f32_16x16x32_bf16 v[52:55], a[52:55], v[92:95], v[52:55]
ds_read_b64_tr_b16 a[24:25], v7 offset:51008
ds_read_b64_tr_b16 a[26:27], v7 offset:51520
v_mfma_f32_16x16x32_bf16 v[36:39], a[52:55], v[88:91], v[36:39]
buffer_load_dwordx4 v[76:79], v4, s[16:19], s53 offen offset:1024 sc1
s_waitcnt lgkmcnt(15)
v_mfma_f32_16x16x32_bf16 v[40:43], a[56:59], v[88:91], v[40:43]
ds_read_b64_tr_b16 a[28:29], v7 offset:51040
s_add_u32 s53, s53, 0x40000
v_mfma_f32_16x16x32_bf16 v[56:59], a[56:59], v[92:95], v[56:59]
ds_read_b64_tr_b16 a[30:31], v7 offset:51552
s_waitcnt lgkmcnt(15)
v_mfma_f32_16x16x32_bf16 v[60:63], a[60:63], v[92:95], v[60:63]
v_mfma_f32_16x16x32_bf16 v[44:47], a[60:63], v[88:91], v[44:47]
s_waitcnt vmcnt(11) lgkmcnt(14)
v_mfma_f32_16x16x32_bf16 v[32:35], a[0:3], v[96:99], v[32:35]
ds_read_b64_tr_b16 a[32:33], v7 offset:58240
ds_read_b64_tr_b16 a[34:35], v7 offset:58752
s_waitcnt vmcnt(10)
v_mfma_f32_16x16x32_bf16 v[48:51], a[0:3], v[100:103], v[48:51]
buffer_load_dwordx4 v[80:83], v4, s[16:19], s52 offen sc1
s_waitcnt lgkmcnt(14)
v_mfma_f32_16x16x32_bf16 v[52:55], a[4:7], v[100:103], v[52:55]
ds_read_b64_tr_b16 a[36:37], v7 offset:58272
ds_read_b64_tr_b16 a[38:39], v7 offset:58784
v_mfma_f32_16x16x32_bf16 v[36:39], a[4:7], v[96:99], v[36:39]
ds_read_b64_tr_b16 a[40:41], v7 offset:58304
ds_read_b64_tr_b16 a[42:43], v7 offset:58816
s_waitcnt lgkmcnt(15)
v_mfma_f32_16x16x32_bf16 v[40:43], a[8:11], v[96:99], v[40:43]
buffer_load_dwordx4 v[84:87], v4, s[16:19], s52 offen offset:1024 sc1
v_mfma_f32_16x16x32_bf16 v[56:59], a[8:11], v[100:103], v[56:59]
ds_read_b64_tr_b16 a[44:45], v7 offset:58336
s_add_u32 s52, s52, 0x40000
s_waitcnt lgkmcnt(15)
v_mfma_f32_16x16x32_bf16 v[60:63], a[12:15], v[100:103], v[60:63]
ds_read_b64_tr_b16 a[46:47], v7 offset:58848
v_mfma_f32_16x16x32_bf16 v[44:47], a[12:15], v[96:99], v[44:47]
ds_read_b64_tr_b16 a[48:49], v7 offset:59264
ds_read_b64_tr_b16 a[50:51], v7 offset:59776
s_waitcnt vmcnt(11) lgkmcnt(15)
v_mfma_f32_16x16x32_bf16 v[32:35], a[16:19], v[104:107], v[32:35]
buffer_load_dwordx4 v[88:91], v4, s[16:19], s53 offen sc1
s_waitcnt vmcnt(11)
v_mfma_f32_16x16x32_bf16 v[48:51], a[16:19], v[108:111], v[48:51]
ds_read_b64_tr_b16 a[52:53], v7 offset:59296
ds_read_b64_tr_b16 a[54:55], v7 offset:59808
s_waitcnt lgkmcnt(15)
v_mfma_f32_16x16x32_bf16 v[52:55], a[20:23], v[108:111], v[52:55]
ds_read_b64_tr_b16 a[56:57], v7 offset:59328
ds_read_b64_tr_b16 a[58:59], v7 offset:59840
v_mfma_f32_16x16x32_bf16 v[36:39], a[20:23], v[104:107], v[36:39]
buffer_load_dwordx4 v[92:95], v4, s[16:19], s53 offen offset:1024 sc1
s_waitcnt lgkmcnt(15)
v_mfma_f32_16x16x32_bf16 v[40:43], a[24:27], v[104:107], v[40:43]
ds_read_b64_tr_b16 a[60:61], v7 offset:59360
s_add_u32 s53, s53, 0x40000
v_mfma_f32_16x16x32_bf16 v[56:59], a[24:27], v[108:111], v[56:59]
ds_read_b64_tr_b16 a[62:63], v7 offset:59872
s_waitcnt lgkmcnt(15)
v_mfma_f32_16x16x32_bf16 v[60:63], a[28:31], v[108:111], v[60:63]
v_mfma_f32_16x16x32_bf16 v[44:47], a[28:31], v[104:107], v[44:47]
s_xor_b32 s57, s57, 66560
v_add_u32 v7, s57, v8
s_waitcnt vmcnt(11) lgkmcnt(14)
v_mfma_f32_16x16x32_bf16 v[32:35], a[32:35], v[112:115], v[32:35]
ds_read_b64_tr_b16 a[0:1], v7
ds_read_b64_tr_b16 a[2:3], v7 offset:512
s_waitcnt vmcnt(10)
v_mfma_f32_16x16x32_bf16 v[48:51], a[32:35], v[116:119], v[48:51]
buffer_load_dwordx4 v[96:99], v4, s[16:19], s52 offen sc1
s_waitcnt lgkmcnt(14)
v_mfma_f32_16x16x32_bf16 v[52:55], a[36:39], v[116:119], v[52:55]
ds_read_b64_tr_b16 a[4:5], v7 offset:32
ds_read_b64_tr_b16 a[6:7], v7 offset:544
v_mfma_f32_16x16x32_bf16 v[36:39], a[36:39], v[112:115], v[36:39]
ds_read_b64_tr_b16 a[8:9], v7 offset:64
ds_read_b64_tr_b16 a[10:11], v7 offset:576
s_waitcnt lgkmcnt(15)
v_mfma_f32_16x16x32_bf16 v[40:43], a[40:43], v[112:115], v[40:43]
buffer_load_dwordx4 v[100:103], v4, s[16:19], s52 offen offset:1024 sc1
v_mfma_f32_16x16x32_bf16 v[56:59], a[40:43], v[116:119], v[56:59]
ds_read_b64_tr_b16 a[12:13], v7 offset:96
s_add_u32 s52, s52, 0x40000
s_waitcnt lgkmcnt(15)
v_mfma_f32_16x16x32_bf16 v[60:63], a[44:47], v[116:119], v[60:63]
ds_read_b64_tr_b16 a[14:15], v7 offset:608
v_mfma_f32_16x16x32_bf16 v[44:47], a[44:47], v[112:115], v[44:47]
ds_read_b64_tr_b16 a[16:17], v7 offset:1024
ds_read_b64_tr_b16 a[18:19], v7 offset:1536
s_waitcnt vmcnt(11) lgkmcnt(15)
v_mfma_f32_16x16x32_bf16 v[32:35], a[48:51], v[120:123], v[32:35]
buffer_load_dwordx4 v[104:107], v4, s[16:19], s53 offen sc1
s_waitcnt vmcnt(11)
v_mfma_f32_16x16x32_bf16 v[48:51], a[48:51], v[124:127], v[48:51]
ds_read_b64_tr_b16 a[20:21], v7 offset:1056
ds_read_b64_tr_b16 a[22:23], v7 offset:1568
s_waitcnt lgkmcnt(15)
v_mfma_f32_16x16x32_bf16 v[52:55], a[52:55], v[124:127], v[52:55]
ds_read_b64_tr_b16 a[24:25], v7 offset:1088
ds_read_b64_tr_b16 a[26:27], v7 offset:1600
v_mfma_f32_16x16x32_bf16 v[36:39], a[52:55], v[120:123], v[36:39]
buffer_load_dwordx4 v[108:111], v4, s[16:19], s53 offen offset:1024 sc1
s_waitcnt lgkmcnt(15)
v_mfma_f32_16x16x32_bf16 v[40:43], a[56:59], v[120:123], v[40:43]
ds_read_b64_tr_b16 a[28:29], v7 offset:1120
s_add_u32 s53, s53, 0x40000
v_mfma_f32_16x16x32_bf16 v[56:59], a[56:59], v[124:127], v[56:59]
ds_read_b64_tr_b16 a[30:31], v7 offset:1632
s_waitcnt lgkmcnt(15)
v_mfma_f32_16x16x32_bf16 v[60:63], a[60:63], v[124:127], v[60:63]
v_mfma_f32_16x16x32_bf16 v[44:47], a[60:63], v[120:123], v[44:47]
s_waitcnt vmcnt(11) lgkmcnt(14)
v_mfma_f32_16x16x32_bf16 v[32:35], a[0:3], v[64:67], v[32:35]
ds_read_b64_tr_b16 a[32:33], v7 offset:8320
ds_read_b64_tr_b16 a[34:35], v7 offset:8832
s_waitcnt vmcnt(10)
v_mfma_f32_16x16x32_bf16 v[48:51], a[0:3], v[68:71], v[48:51]
buffer_load_dwordx4 v[112:115], v4, s[16:19], s52 offen sc1
s_waitcnt lgkmcnt(14)
v_mfma_f32_16x16x32_bf16 v[52:55], a[4:7], v[68:71], v[52:55]
ds_read_b64_tr_b16 a[36:37], v7 offset:8352
ds_read_b64_tr_b16 a[38:39], v7 offset:8864
v_mfma_f32_16x16x32_bf16 v[36:39], a[4:7], v[64:67], v[36:39]
ds_read_b64_tr_b16 a[40:41], v7 offset:8384
ds_read_b64_tr_b16 a[42:43], v7 offset:8896
s_waitcnt lgkmcnt(15)
v_mfma_f32_16x16x32_bf16 v[40:43], a[8:11], v[64:67], v[40:43]
buffer_load_dwordx4 v[116:119], v4, s[16:19], s52 offen offset:1024 sc1
v_mfma_f32_16x16x32_bf16 v[56:59], a[8:11], v[68:71], v[56:59]
ds_read_b64_tr_b16 a[44:45], v7 offset:8416
s_add_u32 s52, s52, 0x40000
s_waitcnt lgkmcnt(15)
v_mfma_f32_16x16x32_bf16 v[60:63], a[12:15], v[68:71], v[60:63]
ds_read_b64_tr_b16 a[46:47], v7 offset:8928
v_mfma_f32_16x16x32_bf16 v[44:47], a[12:15], v[64:67], v[44:47]
ds_read_b64_tr_b16 a[48:49], v7 offset:9344
ds_read_b64_tr_b16 a[50:51], v7 offset:9856
s_waitcnt vmcnt(11) lgkmcnt(15)
v_mfma_f32_16x16x32_bf16 v[32:35], a[16:19], v[72:75], v[32:35]
buffer_load_dwordx4 v[120:123], v4, s[16:19], s53 offen sc1
s_waitcnt vmcnt(11)
v_mfma_f32_16x16x32_bf16 v[48:51], a[16:19], v[76:79], v[48:51]
ds_read_b64_tr_b16 a[52:53], v7 offset:9376
ds_read_b64_tr_b16 a[54:55], v7 offset:9888
s_waitcnt lgkmcnt(15)
v_mfma_f32_16x16x32_bf16 v[52:55], a[20:23], v[76:79], v[52:55]
ds_read_b64_tr_b16 a[56:57], v7 offset:9408
ds_read_b64_tr_b16 a[58:59], v7 offset:9920
v_mfma_f32_16x16x32_bf16 v[36:39], a[20:23], v[72:75], v[36:39]
buffer_load_dwordx4 v[124:127], v4, s[16:19], s53 offen offset:1024 sc1
s_waitcnt lgkmcnt(15)
v_mfma_f32_16x16x32_bf16 v[40:43], a[24:27], v[72:75], v[40:43]
ds_read_b64_tr_b16 a[60:61], v7 offset:9440
s_add_u32 s53, s53, 0x40000
v_mfma_f32_16x16x32_bf16 v[56:59], a[24:27], v[76:79], v[56:59]
ds_read_b64_tr_b16 a[62:63], v7 offset:9952
s_waitcnt lgkmcnt(15)
v_mfma_f32_16x16x32_bf16 v[60:63], a[28:31], v[76:79], v[60:63]
v_mfma_f32_16x16x32_bf16 v[44:47], a[28:31], v[72:75], v[44:47]
s_waitcnt vmcnt(11) lgkmcnt(14)
v_mfma_f32_16x16x32_bf16 v[32:35], a[32:35], v[80:83], v[32:35]
ds_read_b64_tr_b16 a[0:1], v7 offset:16640
ds_read_b64_tr_b16 a[2:3], v7 offset:17152
s_waitcnt vmcnt(10)
v_mfma_f32_16x16x32_bf16 v[48:51], a[32:35], v[84:87], v[48:51]
buffer_load_dwordx4 v[64:67], v4, s[16:19], s52 offen sc1
s_waitcnt lgkmcnt(14)
v_mfma_f32_16x16x32_bf16 v[52:55], a[36:39], v[84:87], v[52:55]
ds_read_b64_tr_b16 a[4:5], v7 offset:16672
ds_read_b64_tr_b16 a[6:7], v7 offset:17184
v_mfma_f32_16x16x32_bf16 v[36:39], a[36:39], v[80:83], v[36:39]
ds_read_b64_tr_b16 a[8:9], v7 offset:16704
ds_read_b64_tr_b16 a[10:11], v7 offset:17216
s_waitcnt lgkmcnt(15)
v_mfma_f32_16x16x32_bf16 v[40:43], a[40:43], v[80:83], v[40:43]
buffer_load_dwordx4 v[68:71], v4, s[16:19], s52 offen offset:1024 sc1
v_mfma_f32_16x16x32_bf16 v[56:59], a[40:43], v[84:87], v[56:59]
ds_read_b64_tr_b16 a[12:13], v7 offset:16736
s_add_u32 s52, s52, 0x40000
s_waitcnt lgkmcnt(15)
v_mfma_f32_16x16x32_bf16 v[60:63], a[44:47], v[84:87], v[60:63]
ds_read_b64_tr_b16 a[14:15], v7 offset:17248
v_mfma_f32_16x16x32_bf16 v[44:47], a[44:47], v[80:83], v[44:47]
ds_read_b64_tr_b16 a[16:17], v7 offset:17664
ds_read_b64_tr_b16 a[18:19], v7 offset:18176
s_waitcnt vmcnt(11) lgkmcnt(15)
v_mfma_f32_16x16x32_bf16 v[32:35], a[48:51], v[88:91], v[32:35]
buffer_load_dwordx4 v[72:75], v4, s[16:19], s53 offen sc1
s_waitcnt vmcnt(11)
v_mfma_f32_16x16x32_bf16 v[48:51], a[48:51], v[92:95], v[48:51]
ds_read_b64_tr_b16 a[20:21], v7 offset:17696
ds_read_b64_tr_b16 a[22:23], v7 offset:18208
s_waitcnt lgkmcnt(15)
v_mfma_f32_16x16x32_bf16 v[52:55], a[52:55], v[92:95], v[52:55]
ds_read_b64_tr_b16 a[24:25], v7 offset:17728
ds_read_b64_tr_b16 a[26:27], v7 offset:18240
v_mfma_f32_16x16x32_bf16 v[36:39], a[52:55], v[88:91], v[36:39]
buffer_load_dwordx4 v[76:79], v4, s[16:19], s53 offen offset:1024 sc1
s_waitcnt lgkmcnt(15)
v_mfma_f32_16x16x32_bf16 v[40:43], a[56:59], v[88:91], v[40:43]
ds_read_b64_tr_b16 a[28:29], v7 offset:17760
s_add_u32 s53, s53, 0x40000
v_mfma_f32_16x16x32_bf16 v[56:59], a[56:59], v[92:95], v[56:59]
ds_read_b64_tr_b16 a[30:31], v7 offset:18272
s_waitcnt lgkmcnt(15)
v_mfma_f32_16x16x32_bf16 v[60:63], a[60:63], v[92:95], v[60:63]
v_mfma_f32_16x16x32_bf16 v[44:47], a[60:63], v[88:91], v[44:47]
s_waitcnt vmcnt(11) lgkmcnt(14)
v_mfma_f32_16x16x32_bf16 v[32:35], a[0:3], v[96:99], v[32:35]
ds_read_b64_tr_b16 a[32:33], v7 offset:24960
ds_read_b64_tr_b16 a[34:35], v7 offset:25472
s_waitcnt vmcnt(10)
v_mfma_f32_16x16x32_bf16 v[48:51], a[0:3], v[100:103], v[48:51]
buffer_load_dwordx4 v[80:83], v4, s[16:19], s52 offen sc1
s_waitcnt lgkmcnt(14)
v_mfma_f32_16x16x32_bf16 v[52:55], a[4:7], v[100:103], v[52:55]
ds_read_b64_tr_b16 a[36:37], v7 offset:24992
ds_read_b64_tr_b16 a[38:39], v7 offset:25504
v_mfma_f32_16x16x32_bf16 v[36:39], a[4:7], v[96:99], v[36:39]
ds_read_b64_tr_b16 a[40:41], v7 offset:25024
ds_read_b64_tr_b16 a[42:43], v7 offset:25536
s_waitcnt lgkmcnt(15)
v_mfma_f32_16x16x32_bf16 v[40:43], a[8:11], v[96:99], v[40:43]
buffer_load_dwordx4 v[84:87], v4, s[16:19], s52 offen offset:1024 sc1
v_mfma_f32_16x16x32_bf16 v[56:59], a[8:11], v[100:103], v[56:59]
ds_read_b64_tr_b16 a[44:45], v7 offset:25056
s_add_u32 s52, s52, 0x40000
s_waitcnt lgkmcnt(15)
v_mfma_f32_16x16x32_bf16 v[60:63], a[12:15], v[100:103], v[60:63]
ds_read_b64_tr_b16 a[46:47], v7 offset:25568
v_mfma_f32_16x16x32_bf16 v[44:47], a[12:15], v[96:99], v[44:47]
ds_read_b64_tr_b16 a[48:49], v7 offset:25984
ds_read_b64_tr_b16 a[50:51], v7 offset:26496
s_waitcnt vmcnt(11) lgkmcnt(15)
v_mfma_f32_16x16x32_bf16 v[32:35], a[16:19], v[104:107], v[32:35]
buffer_load_dwordx4 v[88:91], v4, s[16:19], s53 offen sc1
s_waitcnt vmcnt(11)
v_mfma_f32_16x16x32_bf16 v[48:51], a[16:19], v[108:111], v[48:51]
ds_read_b64_tr_b16 a[52:53], v7 offset:26016
ds_read_b64_tr_b16 a[54:55], v7 offset:26528
s_waitcnt lgkmcnt(15)
v_mfma_f32_16x16x32_bf16 v[52:55], a[20:23], v[108:111], v[52:55]
ds_read_b64_tr_b16 a[56:57], v7 offset:26048
ds_read_b64_tr_b16 a[58:59], v7 offset:26560
v_mfma_f32_16x16x32_bf16 v[36:39], a[20:23], v[104:107], v[36:39]
buffer_load_dwordx4 v[92:95], v4, s[16:19], s53 offen offset:1024 sc1
s_waitcnt lgkmcnt(15)
v_mfma_f32_16x16x32_bf16 v[40:43], a[24:27], v[104:107], v[40:43]
ds_read_b64_tr_b16 a[60:61], v7 offset:26080
s_add_u32 s53, s53, 0x40000
v_mfma_f32_16x16x32_bf16 v[56:59], a[24:27], v[108:111], v[56:59]
ds_read_b64_tr_b16 a[62:63], v7 offset:26592
s_waitcnt lgkmcnt(15)
v_mfma_f32_16x16x32_bf16 v[60:63], a[28:31], v[108:111], v[60:63]
v_mfma_f32_16x16x32_bf16 v[44:47], a[28:31], v[104:107], v[44:47]
s_waitcnt vmcnt(11) lgkmcnt(14)
v_mfma_f32_16x16x32_bf16 v[32:35], a[32:35], v[112:115], v[32:35]
ds_read_b64_tr_b16 a[0:1], v7 offset:33280
ds_read_b64_tr_b16 a[2:3], v7 offset:33792
s_waitcnt vmcnt(10)
v_mfma_f32_16x16x32_bf16 v[48:51], a[32:35], v[116:119], v[48:51]
buffer_load_dwordx4 v[96:99], v4, s[16:19], s52 offen sc1
s_waitcnt lgkmcnt(14)
v_mfma_f32_16x16x32_bf16 v[52:55], a[36:39], v[116:119], v[52:55]
ds_read_b64_tr_b16 a[4:5], v7 offset:33312
ds_read_b64_tr_b16 a[6:7], v7 offset:33824
v_mfma_f32_16x16x32_bf16 v[36:39], a[36:39], v[112:115], v[36:39]
ds_read_b64_tr_b16 a[8:9], v7 offset:33344
ds_read_b64_tr_b16 a[10:11], v7 offset:33856
s_waitcnt lgkmcnt(15)
v_mfma_f32_16x16x32_bf16 v[40:43], a[40:43], v[112:115], v[40:43]
buffer_load_dwordx4 v[100:103], v4, s[16:19], s52 offen offset:1024 sc1
v_mfma_f32_16x16x32_bf16 v[56:59], a[40:43], v[116:119], v[56:59]
ds_read_b64_tr_b16 a[12:13], v7 offset:33376
s_add_u32 s52, s52, 0x40000
s_waitcnt lgkmcnt(15)
v_mfma_f32_16x16x32_bf16 v[60:63], a[44:47], v[116:119], v[60:63]
ds_read_b64_tr_b16 a[14:15], v7 offset:33888
v_mfma_f32_16x16x32_bf16 v[44:47], a[44:47], v[112:115], v[44:47]
ds_read_b64_tr_b16 a[16:17], v7 offset:34304
ds_read_b64_tr_b16 a[18:19], v7 offset:34816
s_waitcnt vmcnt(11) lgkmcnt(15)
v_mfma_f32_16x16x32_bf16 v[32:35], a[48:51], v[120:123], v[32:35]
buffer_load_dwordx4 v[104:107], v4, s[16:19], s53 offen sc1
s_waitcnt vmcnt(11)
v_mfma_f32_16x16x32_bf16 v[48:51], a[48:51], v[124:127], v[48:51]
ds_read_b64_tr_b16 a[20:21], v7 offset:34336
ds_read_b64_tr_b16 a[22:23], v7 offset:34848
s_waitcnt lgkmcnt(15)
v_mfma_f32_16x16x32_bf16 v[52:55], a[52:55], v[124:127], v[52:55]
ds_read_b64_tr_b16 a[24:25], v7 offset:34368
ds_read_b64_tr_b16 a[26:27], v7 offset:34880
v_mfma_f32_16x16x32_bf16 v[36:39], a[52:55], v[120:123], v[36:39]
buffer_load_dwordx4 v[108:111], v4, s[16:19], s53 offen offset:1024 sc1
s_waitcnt lgkmcnt(15)
v_mfma_f32_16x16x32_bf16 v[40:43], a[56:59], v[120:123], v[40:43]
ds_read_b64_tr_b16 a[28:29], v7 offset:34400
s_add_u32 s53, s53, 0x40000
v_mfma_f32_16x16x32_bf16 v[56:59], a[56:59], v[124:127], v[56:59]
ds_read_b64_tr_b16 a[30:31], v7 offset:34912
s_waitcnt lgkmcnt(15)
v_mfma_f32_16x16x32_bf16 v[60:63], a[60:63], v[124:127], v[60:63]
v_mfma_f32_16x16x32_bf16 v[44:47], a[60:63], v[120:123], v[44:47]
s_waitcnt vmcnt(11) lgkmcnt(14)
v_mfma_f32_16x16x32_bf16 v[32:35], a[0:3], v[64:67], v[32:35]
ds_read_b64_tr_b16 a[32:33], v7 offset:41600
ds_read_b64_tr_b16 a[34:35], v7 offset:42112
s_waitcnt vmcnt(10)
v_mfma_f32_16x16x32_bf16 v[48:51], a[0:3], v[68:71], v[48:51]
buffer_load_dwordx4 v[112:115], v4, s[16:19], s52 offen sc1
s_waitcnt lgkmcnt(14)
v_mfma_f32_16x16x32_bf16 v[52:55], a[4:7], v[68:71], v[52:55]
ds_read_b64_tr_b16 a[36:37], v7 offset:41632
ds_read_b64_tr_b16 a[38:39], v7 offset:42144
v_mfma_f32_16x16x32_bf16 v[36:39], a[4:7], v[64:67], v[36:39]
ds_read_b64_tr_b16 a[40:41], v7 offset:41664
ds_read_b64_tr_b16 a[42:43], v7 offset:42176
s_waitcnt lgkmcnt(15)
v_mfma_f32_16x16x32_bf16 v[40:43], a[8:11], v[64:67], v[40:43]
buffer_load_dwordx4 v[116:119], v4, s[16:19], s52 offen offset:1024 sc1
v_mfma_f32_16x16x32_bf16 v[56:59], a[8:11], v[68:71], v[56:59]
ds_read_b64_tr_b16 a[44:45], v7 offset:41696
s_add_u32 s52, s52, 0x40000
s_waitcnt lgkmcnt(15)
v_mfma_f32_16x16x32_bf16 v[60:63], a[12:15], v[68:71], v[60:63]
ds_read_b64_tr_b16 a[46:47], v7 offset:42208
v_mfma_f32_16x16x32_bf16 v[44:47], a[12:15], v[64:67], v[44:47]
ds_read_b64_tr_b16 a[48:49], v7 offset:42624
ds_read_b64_tr_b16 a[50:51], v7 offset:43136
s_waitcnt vmcnt(11) lgkmcnt(15)
v_mfma_f32_16x16x32_bf16 v[32:35], a[16:19], v[72:75], v[32:35]
buffer_load_dwordx4 v[120:123], v4, s[16:19], s53 offen sc1
s_waitcnt vmcnt(11)
v_mfma_f32_16x16x32_bf16 v[48:51], a[16:19], v[76:79], v[48:51]
ds_read_b64_tr_b16 a[52:53], v7 offset:42656
ds_read_b64_tr_b16 a[54:55], v7 offset:43168
s_waitcnt lgkmcnt(15)
v_mfma_f32_16x16x32_bf16 v[52:55], a[20:23], v[76:79], v[52:55]
ds_read_b64_tr_b16 a[56:57], v7 offset:42688
ds_read_b64_tr_b16 a[58:59], v7 offset:43200
v_mfma_f32_16x16x32_bf16 v[36:39], a[20:23], v[72:75], v[36:39]
buffer_load_dwordx4 v[124:127], v4, s[16:19], s53 offen offset:1024 sc1
s_waitcnt lgkmcnt(15)
v_mfma_f32_16x16x32_bf16 v[40:43], a[24:27], v[72:75], v[40:43]
ds_read_b64_tr_b16 a[60:61], v7 offset:42720
s_add_u32 s53, s53, 0x40000
v_mfma_f32_16x16x32_bf16 v[56:59], a[24:27], v[76:79], v[56:59]
ds_read_b64_tr_b16 a[62:63], v7 offset:43232
s_waitcnt lgkmcnt(15)
v_mfma_f32_16x16x32_bf16 v[60:63], a[28:31], v[76:79], v[60:63]
v_mfma_f32_16x16x32_bf16 v[44:47], a[28:31], v[72:75], v[44:47]
s_waitcnt lgkmcnt(0)
s_barrier
s_waitcnt vmcnt(11)
v_mfma_f32_16x16x32_bf16 v[32:35], a[32:35], v[80:83], v[32:35]
ds_read_b64_tr_b16 a[0:1], v7 offset:49920
ds_read_b64_tr_b16 a[2:3], v7 offset:50432
s_add_u32 m0, s59, 84480
s_waitcnt vmcnt(10)
v_mfma_f32_16x16x32_bf16 v[48:51], a[32:35], v[84:87], v[48:51]
ds_read_b64_tr_b16 a[4:5], v7 offset:49952
buffer_load_dwordx4 v12, s[32:35], s58 offen lds
v_mfma_f32_16x16x32_bf16 v[52:55], a[36:39], v[84:87], v[52:55]
ds_read_b64_tr_b16 a[6:7], v7 offset:50464
ds_read_b64_tr_b16 a[8:9], v7 offset:49984
v_mfma_f32_16x16x32_bf16 v[36:39], a[36:39], v[80:83], v[36:39]
ds_read_b64_tr_b16 a[10:11], v7 offset:50496
v_mfma_f32_16x16x32_bf16 v[40:43], a[40:43], v[80:83], v[40:43]
ds_read_b64_tr_b16 a[12:13], v7 offset:50016
buffer_load_dwordx4 v13, s[32:35], s58 offen offset:1056 lds
v_mfma_f32_16x16x32_bf16 v[56:59], a[40:43], v[84:87], v[56:59]
ds_read_b64_tr_b16 a[14:15], v7 offset:50528
ds_read_b64_tr_b16 a[16:17], v7 offset:50944
v_mfma_f32_16x16x32_bf16 v[60:63], a[44:47], v[84:87], v[60:63]
ds_read_b64_tr_b16 a[18:19], v7 offset:51456
ds_read_b64_tr_b16 a[20:21], v7 offset:50976
v_mfma_f32_16x16x32_bf16 v[44:47], a[44:47], v[80:83], v[44:47]
ds_read_b64_tr_b16 a[22:23], v7 offset:51488
s_waitcnt vmcnt(11)
v_mfma_f32_16x16x32_bf16 v[32:35], a[48:51], v[88:91], v[32:35]
ds_read_b64_tr_b16 a[24:25], v7 offset:51008
buffer_load_dwordx4 v14, s[32:35], s58 offen offset:2112 lds
s_waitcnt vmcnt(11)
v_mfma_f32_16x16x32_bf16 v[48:51], a[48:51], v[92:95], v[48:51]
ds_read_b64_tr_b16 a[26:27], v7 offset:51520
ds_read_b64_tr_b16 a[28:29], v7 offset:51040
v_mfma_f32_16x16x32_bf16 v[52:55], a[52:55], v[92:95], v[52:55]
ds_read_b64_tr_b16 a[30:31], v7 offset:51552
v_mfma_f32_16x16x32_bf16 v[36:39], a[52:55], v[88:91], v[36:39]
buffer_load_dwordx4 v15, s[32:35], s58 offen offset:3168 lds
v_mfma_f32_16x16x32_bf16 v[40:43], a[56:59], v[88:91], v[40:43]
s_add_u32 s58, s58, 229376
v_mfma_f32_16x16x32_bf16 v[56:59], a[56:59], v[92:95], v[56:59]
v_mfma_f32_16x16x32_bf16 v[60:63], a[60:63], v[92:95], v[60:63]
v_mfma_f32_16x16x32_bf16 v[44:47], a[60:63], v[88:91], v[44:47]
s_waitcnt vmcnt(11) lgkmcnt(14)
v_mfma_f32_16x16x32_bf16 v[32:35], a[0:3], v[96:99], v[32:35]
ds_read_b64_tr_b16 a[32:33], v7 offset:58240
s_add_u32 m0, s59, 101376
s_waitcnt vmcnt(10)
v_mfma_f32_16x16x32_bf16 v[48:51], a[0:3], v[100:103], v[48:51]
buffer_load_dwordx4 v12, s[32:35], s58 offen lds
s_waitcnt lgkmcnt(13)
v_mfma_f32_16x16x32_bf16 v[52:55], a[4:7], v[100:103], v[52:55]
ds_read_b64_tr_b16 a[34:35], v7 offset:58752
ds_read_b64_tr_b16 a[36:37], v7 offset:58272
.Lpad19:
s_cbranch_execz .Lnopoll67r
v_mfma_f32_16x16x32_bf16 v[36:39], a[4:7], v[96:99], v[36:39]
ds_read_b64_tr_b16 a[38:39], v7 offset:58784
ds_read_b64_tr_b16 a[40:41], v7 offset:58304
s_waitcnt lgkmcnt(15)
v_mfma_f32_16x16x32_bf16 v[40:43], a[8:11], v[96:99], v[40:43]
buffer_load_dwordx4 v13, s[32:35], s58 offen offset:1056 lds
v_mfma_f32_16x16x32_bf16 v[56:59], a[8:11], v[100:103], v[56:59]
ds_read_b64_tr_b16 a[42:43], v7 offset:58816
ds_read_b64_tr_b16 a[44:45], v7 offset:58336
s_waitcnt lgkmcnt(15)
v_mfma_f32_16x16x32_bf16 v[60:63], a[12:15], v[100:103], v[60:63]
ds_read_b64_tr_b16 a[46:47], v7 offset:58848
v_mfma_f32_16x16x32_bf16 v[44:47], a[12:15], v[96:99], v[44:47]
ds_read_b64_tr_b16 a[48:49], v7 offset:59264
ds_read_b64_tr_b16 a[50:51], v7 offset:59776
s_waitcnt vmcnt(11) lgkmcnt(15)
v_mfma_f32_16x16x32_bf16 v[32:35], a[16:19], v[104:107], v[32:35]
buffer_load_dwordx4 v14, s[32:35], s58 offen offset:2112 lds
s_waitcnt vmcnt(11)
v_mfma_f32_16x16x32_bf16 v[48:51], a[16:19], v[108:111], v[48:51]
ds_read_b64_tr_b16 a[52:53], v7 offset:59296
ds_read_b64_tr_b16 a[54:55], v7 offset:59808
s_waitcnt lgkmcnt(15)
v_mfma_f32_16x16x32_bf16 v[52:55], a[20:23], v[108:111], v[52:55]
ds_read_b64_tr_b16 a[56:57], v7 offset:59328
ds_read_b64_tr_b16 a[58:59], v7 offset:59840
v_mfma_f32_16x16x32_bf16 v[36:39], a[20:23], v[104:107], v[36:39]
buffer_load_dwordx4 v15, s[32:35], s58 offen offset:3168 lds
s_waitcnt lgkmcnt(15)
v_mfma_f32_16x16x32_bf16 v[40:43], a[24:27], v[104:107], v[40:43]
ds_read_b64_tr_b16 a[60:61], v7 offset:59360
s_add_u32 s58, s58, 229376
v_mfma_f32_16x16x32_bf16 v[56:59], a[24:27], v[108:111], v[56:59]
ds_read_b64_tr_b16 a[62:63], v7 offset:59872
s_waitcnt lgkmcnt(15)
v_mfma_f32_16x16x32_bf16 v[60:63], a[28:31], v[108:111], v[60:63]
v_mfma_f32_16x16x32_bf16 v[44:47], a[28:31], v[104:107], v[44:47]
s_waitcnt vmcnt(11) lgkmcnt(14)
v_mfma_f32_16x16x32_bf16 v[32:35], a[32:35], v[112:115], v[32:35]
s_add_u32 m0, s59, 118272
s_lshl_b32 s64, s6, 14
s_lshl_b32 s65, s49, 13
s_waitcnt vmcnt(10)
v_mfma_f32_16x16x32_bf16 v[48:51], a[32:35], v[116:119], v[48:51]
buffer_load_dwordx4 v12, s[32:35], s58 offen lds
s_waitcnt lgkmcnt(12)
v_mfma_f32_16x16x32_bf16 v[52:55], a[36:39], v[116:119], v[52:55]
s_add_u32 s64, s64, s65
s_lshl_b32 s65, s7, 9
s_add_u32 s64, s64, s65
v_mfma_f32_16x16x32_bf16 v[36:39], a[36:39], v[112:115], v[36:39]
s_lshl_b32 s65, s48, 8
s_add_u32 s64, s64, s65
s_add_u32 s64, s64, 63176704
s_waitcnt lgkmcnt(10)
v_mfma_f32_16x16x32_bf16 v[40:43], a[40:43], v[112:115], v[40:43]
s_lshl_b32 s62, s7, 18
v_and_b32 v152, 31, v1
v_lshlrev_b32 v152, 3, v152
v_mfma_f32_16x16x32_bf16 v[56:59], a[40:43], v[116:119], v[56:59]
buffer_load_dwordx4 v13, s[32:35], s58 offen offset:1056 lds
s_waitcnt lgkmcnt(8)
v_mfma_f32_16x16x32_bf16 v[60:63], a[44:47], v[116:119], v[60:63]
s_add_u32 s62, s62, 41943040
v_lshrrev_b32 v153, 5, v1
v_lshl_add_u32 v152, v153, 28, v152
v_mfma_f32_16x16x32_bf16 v[44:47], a[44:47], v[112:115], v[44:47]
s_add_u32 s63, s62, 0x20000
s_waitcnt vmcnt(11) lgkmcnt(6)
v_mfma_f32_16x16x32_bf16 v[32:35], a[48:51], v[120:123], v[32:35]
s_waitcnt vmcnt(10)
v_mfma_f32_16x16x32_bf16 v[48:51], a[48:51], v[124:127], v[48:51]
buffer_load_dwordx4 v14, s[32:35], s58 offen offset:2112 lds
s_waitcnt lgkmcnt(4)
v_mfma_f32_16x16x32_bf16 v[52:55], a[52:55], v[124:127], v[52:55]
s_nop 2
v_cvt_pk_bf16_f32 v128, v32, v33
v_cvt_pk_bf16_f32 v129, v34, v35
v_mfma_f32_16x16x32_bf16 v[36:39], a[52:55], v[120:123], v[36:39]
v_cvt_pk_bf16_f32 v136, v48, v49
v_cvt_pk_bf16_f32 v137, v50, v51
s_waitcnt lgkmcnt(2)
v_mfma_f32_16x16x32_bf16 v[40:43], a[56:59], v[120:123], v[40:43]
v_cvt_pk_bf16_f32 v138, v52, v53
v_cvt_pk_bf16_f32 v139, v54, v55
v_mfma_f32_16x16x32_bf16 v[56:59], a[56:59], v[124:127], v[56:59]
buffer_load_dwordx4 v15, s[32:35], s58 offen offset:3168 lds
s_waitcnt lgkmcnt(0)
v_mfma_f32_16x16x32_bf16 v[60:63], a[60:63], v[124:127], v[60:63]
s_add_u32 s58, s58, 229376
v_cvt_pk_bf16_f32 v130, v36, v37
v_cvt_pk_bf16_f32 v131, v38, v39
v_mfma_f32_16x16x32_bf16 v[44:47], a[60:63], v[120:123], v[44:47]
v_cvt_pk_bf16_f32 v132, v40, v41
v_cvt_pk_bf16_f32 v133, v42, v43
v_cvt_pk_bf16_f32 v140, v56, v57
v_cvt_pk_bf16_f32 v141, v58, v59
v_cvt_pk_bf16_f32 v142, v60, v61
v_cvt_pk_bf16_f32 v143, v62, v63
v_pk_mul_f32 v[146:147], v[32:33], v[32:33]
buffer_store_dwordx4 v[128:131], v4, s[16:19], s62 offen sc1
v_cvt_pk_bf16_f32 v134, v44, v45
v_cvt_pk_bf16_f32 v135, v46, v47
v_pk_mul_f32 v[150:151], v[48:49], v[48:49]
v_pk_fma_f32 v[146:147], v[34:35], v[34:35], v[146:147]
v_pk_add_f32 v[144:145], v[32:33], v[34:35]
v_pk_fma_f32 v[150:151], v[50:51], v[50:51], v[150:151]
v_pk_add_f32 v[148:149], v[48:49], v[50:51]
v_pk_fma_f32 v[146:147], v[36:37], v[36:37], v[146:147]
v_pk_add_f32 v[144:145], v[144:145], v[36:37]
v_pk_fma_f32 v[150:151], v[52:53], v[52:53], v[150:151]
v_pk_add_f32 v[148:149], v[148:149], v[52:53]
v_pk_fma_f32 v[146:147], v[38:39], v[38:39], v[146:147]
v_pk_add_f32 v[144:145], v[144:145], v[38:39]
buffer_store_dwordx4 v[132:135], v4, s[16:19], s63 offen sc1
v_pk_fma_f32 v[150:151], v[54:55], v[54:55], v[150:151]
v_pk_add_f32 v[148:149], v[148:149], v[54:55]
v_pk_fma_f32 v[146:147], v[40:41], v[40:41], v[146:147]
v_pk_add_f32 v[144:145], v[144:145], v[40:41]
v_pk_fma_f32 v[150:151], v[56:57], v[56:57], v[150:151]
v_pk_add_f32 v[148:149], v[148:149], v[56:57]
v_pk_fma_f32 v[146:147], v[42:43], v[42:43], v[146:147]
v_pk_add_f32 v[144:145], v[144:145], v[42:43]
v_pk_fma_f32 v[150:151], v[58:59], v[58:59], v[150:151]
v_pk_add_f32 v[148:149], v[148:149], v[58:59]
v_pk_fma_f32 v[146:147], v[44:45], v[44:45], v[146:147]
v_pk_add_f32 v[144:145], v[144:145], v[44:45]
v_pk_fma_f32 v[150:151], v[60:61], v[60:61], v[150:151]
buffer_store_dwordx4 v[136:139], v4, s[16:19], s62 offen offset:1024 sc1
v_pk_add_f32 v[148:149], v[148:149], v[60:61]
v_pk_fma_f32 v[146:147], v[46:47], v[46:47], v[146:147]
v_pk_add_f32 v[144:145], v[144:145], v[46:47]
v_pk_fma_f32 v[150:151], v[62:63], v[62:63], v[150:151]
v_pk_add_f32 v[148:149], v[148:149], v[62:63]
v_add_f32 v144, v144, v145
v_add_f32 v146, v146, v147
v_add_f32 v148, v148, v149
v_add_f32 v150, v150, v151
s_nop 0
v_permlane16_swap_b32 v144, v148
v_permlane16_swap_b32 v146, v150
v_add_f32 v144, v144, v148
buffer_store_dwordx4 v[140:143], v4, s[16:19], s63 offen offset:1024 sc1
v_add_f32 v146, v146, v150
s_nop 1
v_permlane32_swap_b32 v144, v146
v_add_f32 v144, v144, v146
s_nop 1
v_permlane32_swap_b32 v144, v145
buffer_store_dwordx2 v[144:145], v152, s[16:19], s64 offen sc1
s_nop 1
v_accvgpr_write_b32 a224, v32
v_accvgpr_write_b32 a225, v33
v_accvgpr_write_b32 a226, v34
v_accvgpr_write_b32 a227, v35
v_accvgpr_write_b32 a228, v36
v_accvgpr_write_b32 a229, v37
v_accvgpr_write_b32 a230, v38
v_accvgpr_write_b32 a231, v39
v_accvgpr_write_b32 a232, v40
v_accvgpr_write_b32 a233, v41
v_accvgpr_write_b32 a234, v42
v_accvgpr_write_b32 a235, v43
v_accvgpr_write_b32 a236, v44
v_accvgpr_write_b32 a237, v45
v_accvgpr_write_b32 a238, v46
v_accvgpr_write_b32 a239, v47
v_accvgpr_write_b32 a240, v48
v_accvgpr_write_b32 a241, v49
v_accvgpr_write_b32 a242, v50
v_accvgpr_write_b32 a243, v51
v_accvgpr_write_b32 a244, v52
v_accvgpr_write_b32 a245, v53
v_accvgpr_write_b32 a246, v54
v_accvgpr_write_b32 a247, v55
v_accvgpr_write_b32 a248, v56
v_accvgpr_write_b32 a249, v57
v_accvgpr_write_b32 a250, v58
v_accvgpr_write_b32 a251, v59
v_accvgpr_write_b32 a252, v60
v_accvgpr_write_b32 a253, v61
v_accvgpr_write_b32 a254, v62
v_accvgpr_write_b32 a255, v63
s_lshl_b32 s62, s10, 14
s_lshl_b32 s63, s3, 12
s_add_u32 s62, s62, s63
s_lshl_b32 s63, s12, 11
s_add_u32 s62, s62, s63
v_lshl_add_u32 v10, v1, 4, s62
v_lshrrev_b32 v2, 3, v1
v_cmp_eq_u32 vcc, 3, v2
v_add_u32 v2, 67108480, v10
s_nop 0
v_cndmask_b32 v10, v10, v2, vcc
v_xor_b32 v11, 2048, v10
v_bfe_u32 v16, v1, 2, 3
v_mul_u32_u24 v16, 1056, v16
v_bfe_u32 v2, v1, 5, 1
v_lshl_add_u32 v16, v2, 8, v16
v_and_b32 v2, 3, v1
v_lshl_add_u32 v16, v2, 3, v16
s_lshl_b32 s62, s12, 6
s_add_u32 s62, s62, 84480
s_xor_b32 s63, s12, 1
s_mul_i32 s63, s63, 192
s_add_u32 s63, s63, 84480
v_add_u32 v17, s63, v16
v_add_u32 v16, s62, v16
s_mov_b32 s52, 41943040
s_mov_b32 s54, s58
s_mov_b32 s55, s59
s_mul_i32 s59, s3, 2112
s_and_b32 s62, s7, 1
s_mul_i32 s62, s62, 3670016
s_lshr_b32 s63, s7, 1
s_lshl_b32 s63, s63, 8
s_add_u32 s62, s62, s63
s_lshl_b32 s63, s3, 12
s_add_u32 s62, s62, s63
v_lshrrev_b32 v5, 4, v1
v_lshlrev_b32 v5, 14, v5
v_and_b32 v2, 15, v1
v_lshl_add_u32 v5, v2, 4, v5
v_add_u32 v5, s62, v5
v_add_u32 v6, 992, v5
s_lshl_b32 s62, s10, 15
s_lshl_b32 s63, s3, 13
s_add_u32 s62, s62, s63
v_lshl_add_u32 v4, v1, 4, s62
s_lshl_b32 s62, s6, 10
s_add_u32 s62, s62, 30507008
s_lshl_b32 s64, s10, 1
s_lshl_b32 s64, s64, 10
s_add_u32 s64, s64, 30507008
s_lshr_b32 s67, s5, 2
s_and_b32 s67, s67, 3
s_lshl_b32 s67, s67, 7
s_add_u32 s64, s64, s67
s_add_u32 s65, s64, 1024
v_lshl_add_u32 v252, v1, 7, s62
v_mov_b32 v253, s64
v_writelane_b32 v253, s65, 1
s_waitcnt vmcnt(0) lgkmcnt(0)
s_barrier
s_cmp_lg_u32 s3, 0
s_cbranch_scc1 .Lnosig69
v_mov_b32 v255, 1
s_mov_b64 exec, 15
buffer_atomic_add v255, v252, s[16:19], 0 offen
s_mov_b64 exec, -1
.Lnosig69:
s_cmp_lg_u32 s3, 1
s_cbranch_scc1 .Lnopoll72
s_mov_b64 exec, 3
s_mov_b32 s15, 0
s_mov_b64 exec, 3
v_mov_b32 v254, 0
buffer_atomic_add v254, v253, s[16:19], 0 offen sc0
.Lpoll70:
s_waitcnt vmcnt(0)
v_cmp_ne_u32 vcc, 16, v254
s_add_u32 s15, s15, 1
s_cbranch_vccz .Lnopoll72r
s_mov_b64 exec, 3
v_mov_b32 v254, 0
buffer_atomic_add v254, v253, s[16:19], 0 offen sc0
s_cmp_le_u32 s15, 100000
s_cbranch_scc1 .Lpoll70
.Lgot71:
s_waitcnt vmcnt(0)
s_branch .Lnopoll72r
.Lnopoll72:
s_mov_b64 exec, 0
s_cmp_eq_u32 s3, 2
s_cbranch_scc1 .Lpad20
s_cmp_eq_u32 s3, 3
s_cbranch_scc1 .Lpad21
s_branch .Lpad22
.Lnopoll72r:
s_mov_b64 exec, -1
s_barrier
buffer_load_dwordx4 a[128:131], v10, s[16:19], s52 offen sc1
buffer_load_dwordx4 a[132:135], v10, s[16:19], s52 offen offset:1024 sc1
buffer_load_dwordx4 a[136:139], v11, s[16:19], s52 offen sc1
buffer_load_dwordx4 a[140:143], v11, s[16:19], s52 offen offset:1024 sc1
s_add_u32 s52, s52, 0x20000
buffer_load_dwordx4 a[144:147], v10, s[16:19], s52 offen sc1
buffer_load_dwordx4 a[148:151], v10, s[16:19], s52 offen offset:1024 sc1
buffer_load_dwordx4 a[152:155], v11, s[16:19], s52 offen sc1
buffer_load_dwordx4 a[156:159], v11, s[16:19], s52 offen offset:1024 sc1
s_add_u32 s52, s52, 0x20000
ds_read_b64_tr_b16 a[0:1], v16
ds_read_b64_tr_b16 a[2:3], v16 offset:512
ds_read_b64_tr_b16 a[4:5], v16 offset:32
ds_read_b64_tr_b16 a[6:7], v16 offset:544
ds_read_b64_tr_b16 a[8:9], v16 offset:8448
ds_read_b64_tr_b16 a[10:11], v16 offset:8960
ds_read_b64_tr_b16 a[12:13], v16 offset:8480
ds_read_b64_tr_b16 a[14:15], v16 offset:8992
ds_read_b64_tr_b16 a[16:17], v16 offset:64
ds_read_b64_tr_b16 a[18:19], v16 offset:576
ds_read_b64_tr_b16 a[20:21], v16 offset:96
ds_read_b64_tr_b16 a[22:23], v16 offset:608
ds_read_b64_tr_b16 a[24:25], v16 offset:8512
ds_read_b64_tr_b16 a[26:27], v16 offset:9024
ds_read_b64_tr_b16 a[28:29], v16 offset:8544
ds_read_b64_tr_b16 a[30:31], v16 offset:9056
ds_read_b64_tr_b16 a[32:33], v16 offset:128
ds_read_b64_tr_b16 a[34:35], v16 offset:640
ds_read_b64_tr_b16 a[36:37], v16 offset:160
ds_read_b64_tr_b16 a[38:39], v16 offset:672
ds_read_b64_tr_b16 a[40:41], v16 offset:8576
ds_read_b64_tr_b16 a[42:43], v16 offset:9088
ds_read_b64_tr_b16 a[44:45], v16 offset:8608
ds_read_b64_tr_b16 a[46:47], v16 offset:9120
ds_read_b64_tr_b16 a[48:49], v17
ds_read_b64_tr_b16 a[50:51], v17 offset:512
ds_read_b64_tr_b16 a[52:53], v17 offset:32
ds_read_b64_tr_b16 a[54:55], v17 offset:544
ds_read_b64_tr_b16 a[56:57], v17 offset:8448
ds_read_b64_tr_b16 a[58:59], v17 offset:8960
ds_read_b64_tr_b16 a[60:61], v17 offset:8480
ds_read_b64_tr_b16 a[62:63], v17 offset:8992
s_add_u32 m0, s55, 135168
s_nop 0
buffer_load_dwordx4 v12, s[32:35], s54 offen lds
buffer_load_dwordx4 v13, s[32:35], s54 offen offset:1056 lds
buffer_load_dwordx4 v14, s[32:35], s54 offen offset:2112 lds
buffer_load_dwordx4 v15, s[32:35], s54 offen offset:3168 lds
s_add_u32 s54, s54, 229376
s_mul_i32 s66, s13, 917504
s_add_u32 s66, s66, 46137344
s_add_u32 s65, s66, 393216
s_lshl_b32 s62, s12, 19
s_add_u32 s62, s62, s66
s_add_u32 s63, s62, 0x20000
s_add_u32 s64, s62, 0x40000
s_lshl_b32 s74, s3, 10
s_lshl_b32 s75, s12, 9
s_add_u32 s74, s74, s75
s_add_u32 s74, s74, 152576
v_and_b32 v18, 15, v1
v_lshl_add_u32 v18, v18, 4, s74
v_xor_b32 v19, 512, v18
s_lshl_b32 s74, s12, 7
s_add_u32 s74, s74, 161536
s_xor_b32 s75, s12, 1
s_mul_i32 s75, s75, 384
s_add_u32 s75, s75, 161536
v_lshrrev_b32 v9, 4, v1
v_lshlrev_b32 v9, 4, v9
v_add_u32 v8, s75, v9
v_add_u32 v9, s74, v9
s_lshl_b32 s74, s3, 13
s_add_u32 s74, s74, 49920
v_lshl_add_u32 v2, v1, 4, s74
s_waitcnt lgkmcnt(0)
s_barrier
s_waitcnt vmcnt(11)
v_mfma_f32_16x16x32_bf16 v[32:35], a[0:3], a[128:131], 0
buffer_load_dwordx4 a[160:163], v10, s[16:19], s52 offen sc1
s_waitcnt vmcnt(11)
v_mfma_f32_16x16x32_bf16 v[36:39], a[0:3], a[132:135], 0
ds_read_b64_tr_b16 a[64:65], v16 offset:16896
v_mfma_f32_16x16x32_bf16 v[52:55], a[4:7], a[132:135], 0
ds_read_b64_tr_b16 a[66:67], v16 offset:17408
v_mfma_f32_16x16x32_bf16 v[48:51], a[4:7], a[128:131], 0
ds_read_b64_tr_b16 a[68:69], v16 offset:16928
v_mfma_f32_16x16x32_bf16 v[64:67], a[8:11], a[128:131], 0
buffer_load_dwordx4 a[164:167], v10, s[16:19], s52 offen offset:1024 sc1
v_mfma_f32_16x16x32_bf16 v[68:71], a[8:11], a[132:135], 0
ds_read_b64_tr_b16 a[70:71], v16 offset:17440
v_mfma_f32_16x16x32_bf16 v[84:87], a[12:15], a[132:135], 0
ds_read_b64_tr_b16 a[72:73], v16 offset:25344
v_mfma_f32_16x16x32_bf16 v[80:83], a[12:15], a[128:131], 0
ds_read_b64_tr_b16 a[74:75], v16 offset:25856
v_mfma_f32_16x16x32_bf16 v[96:99], a[16:19], a[128:131], 0
buffer_load_dwordx4 a[168:171], v11, s[16:19], s52 offen sc1
v_mfma_f32_16x16x32_bf16 v[100:103], a[16:19], a[132:135], 0
ds_read_b64_tr_b16 a[76:77], v16 offset:25376
v_mfma_f32_16x16x32_bf16 v[116:119], a[20:23], a[132:135], 0
ds_read_b64_tr_b16 a[78:79], v16 offset:25888
v_mfma_f32_16x16x32_bf16 v[112:115], a[20:23], a[128:131], 0
ds_read_b64_tr_b16 a[80:81], v16 offset:16960
v_mfma_f32_16x16x32_bf16 v[128:131], a[24:27], a[128:131], 0
buffer_load_dwordx4 a[172:175], v11, s[16:19], s52 offen offset:1024 sc1
v_mfma_f32_16x16x32_bf16 v[132:135], a[24:27], a[132:135], 0
s_add_u32 s52, s52, 0x20000
s_add_u32 m0, s55, 84480
v_mfma_f32_16x16x32_bf16 v[148:151], a[28:31], a[132:135], 0
ds_read_b64_tr_b16 a[82:83], v16 offset:17472
v_mfma_f32_16x16x32_bf16 v[144:147], a[28:31], a[128:131], 0
ds_read_b64_tr_b16 a[84:85], v16 offset:16992
v_mfma_f32_16x16x32_bf16 v[160:163], a[32:35], a[128:131], 0
buffer_load_dwordx4 v12, s[32:35], s54 offen lds
v_mfma_f32_16x16x32_bf16 v[164:167], a[32:35], a[132:135], 0
ds_read_b64_tr_b16 a[86:87], v16 offset:17504
v_mfma_f32_16x16x32_bf16 v[180:183], a[36:39], a[132:135], 0
ds_read_b64_tr_b16 a[88:89], v16 offset:25408
v_mfma_f32_16x16x32_bf16 v[176:179], a[36:39], a[128:131], 0
ds_read_b64_tr_b16 a[90:91], v16 offset:25920
v_mfma_f32_16x16x32_bf16 v[192:195], a[40:43], a[128:131], 0
buffer_load_dwordx4 a[176:179], v10, s[16:19], s52 offen sc1
v_mfma_f32_16x16x32_bf16 v[196:199], a[40:43], a[132:135], 0
ds_read_b64_tr_b16 a[92:93], v16 offset:25440
v_mfma_f32_16x16x32_bf16 v[212:215], a[44:47], a[132:135], 0
ds_read_b64_tr_b16 a[94:95], v16 offset:25952
v_mfma_f32_16x16x32_bf16 v[208:211], a[44:47], a[128:131], 0
ds_read_b64_tr_b16 a[96:97], v16 offset:17024
v_mfma_f32_16x16x32_bf16 v[224:227], a[48:51], a[128:131], 0
buffer_load_dwordx4 v13, s[32:35], s54 offen offset:1056 lds
v_mfma_f32_16x16x32_bf16 v[228:231], a[48:51], a[132:135], 0
ds_read_b64_tr_b16 a[98:99], v16 offset:17536
v_mfma_f32_16x16x32_bf16 v[236:239], a[52:55], a[132:135], 0
ds_read_b64_tr_b16 a[100:101], v16 offset:17056
v_mfma_f32_16x16x32_bf16 v[232:235], a[52:55], a[128:131], 0
ds_read_b64_tr_b16 a[102:103], v16 offset:17568
v_mfma_f32_16x16x32_bf16 v[240:243], a[56:59], a[128:131], 0
buffer_load_dwordx4 a[180:183], v10, s[16:19], s52 offen offset:1024 sc1
v_mfma_f32_16x16x32_bf16 v[244:247], a[56:59], a[132:135], 0
ds_read_b64_tr_b16 a[104:105], v16 offset:25472
v_mfma_f32_16x16x32_bf16 v[252:255], a[60:63], a[132:135], 0
ds_read_b64_tr_b16 a[106:107], v16 offset:25984
v_mfma_f32_16x16x32_bf16 v[248:251], a[60:63], a[128:131], 0
ds_read_b64_tr_b16 a[108:109], v16 offset:25504
s_waitcnt vmcnt(16)
v_mfma_f32_16x16x32_bf16 v[220:223], a[44:47], a[140:143], 0
buffer_load_dwordx4 v14, s[32:35], s54 offen offset:2112 lds
v_mfma_f32_16x16x32_bf16 v[216:219], a[44:47], a[136:139], 0
ds_read_b64_tr_b16 a[110:111], v16 offset:26016
v_mfma_f32_16x16x32_bf16 v[200:203], a[40:43], a[136:139], 0
ds_read_b64_tr_b16 a[112:113], v17 offset:16896
v_mfma_f32_16x16x32_bf16 v[204:207], a[40:43], a[140:143], 0
ds_read_b64_tr_b16 a[114:115], v17 offset:17408
v_mfma_f32_16x16x32_bf16 v[188:191], a[36:39], a[140:143], 0
buffer_load_dwordx4 a[184:187], v11, s[16:19], s52 offen sc1
v_mfma_f32_16x16x32_bf16 v[184:187], a[36:39], a[136:139], 0
ds_read_b64_tr_b16 a[116:117], v17 offset:16928
v_mfma_f32_16x16x32_bf16 v[168:171], a[32:35], a[136:139], 0
ds_read_b64_tr_b16 a[118:119], v17 offset:17440
v_mfma_f32_16x16x32_bf16 v[172:175], a[32:35], a[140:143], 0
ds_read_b64_tr_b16 a[120:121], v17 offset:25344
v_mfma_f32_16x16x32_bf16 v[156:159], a[28:31], a[140:143], 0
buffer_load_dwordx4 v15, s[32:35], s54 offen offset:3168 lds
v_mfma_f32_16x16x32_bf16 v[152:155], a[28:31], a[136:139], 0
s_add_u32 s54, s54, 229376
ds_read_b64_tr_b16 a[122:123], v17 offset:25856
v_mfma_f32_16x16x32_bf16 v[136:139], a[24:27], a[136:139], 0
ds_read_b64_tr_b16 a[124:125], v17 offset:25376
v_mfma_f32_16x16x32_bf16 v[140:143], a[24:27], a[140:143], 0
ds_read_b64_tr_b16 a[126:127], v17 offset:25888
v_mfma_f32_16x16x32_bf16 v[124:127], a[20:23], a[140:143], 0
buffer_load_dwordx4 a[188:191], v11, s[16:19], s52 offen offset:1024 sc1
v_mfma_f32_16x16x32_bf16 v[120:123], a[20:23], a[136:139], 0
s_add_u32 s52, s52, 0x20000
v_mfma_f32_16x16x32_bf16 v[104:107], a[16:19], a[136:139], 0
v_mfma_f32_16x16x32_bf16 v[108:111], a[16:19], a[140:143], 0
v_mfma_f32_16x16x32_bf16 v[92:95], a[12:15], a[140:143], 0
v_mfma_f32_16x16x32_bf16 v[88:91], a[12:15], a[136:139], 0
v_mfma_f32_16x16x32_bf16 v[72:75], a[8:11], a[136:139], 0
v_mfma_f32_16x16x32_bf16 v[76:79], a[8:11], a[140:143], 0
v_mfma_f32_16x16x32_bf16 v[60:63], a[4:7], a[140:143], 0
v_mfma_f32_16x16x32_bf16 v[56:59], a[4:7], a[136:139], 0
v_mfma_f32_16x16x32_bf16 v[40:43], a[0:3], a[136:139], 0
v_mfma_f32_16x16x32_bf16 v[44:47], a[0:3], a[140:143], 0
s_waitcnt lgkmcnt(0)
s_barrier
s_waitcnt vmcnt(19)
v_mfma_f32_16x16x32_bf16 v[32:35], a[64:67], a[144:147], v[32:35]
s_add_u32 m0, s74, 0
s_mov_b32 s67, 63176704
s_waitcnt vmcnt(18)
v_mfma_f32_16x16x32_bf16 v[36:39], a[64:67], a[148:151], v[36:39]
buffer_load_dwordx4 v4, s[16:19], s67 offen sc1 lds
v_mfma_f32_16x16x32_bf16 v[52:55], a[68:71], a[148:151], v[52:55]
ds_read_b64_tr_b16 a[0:1], v16 offset:33792
v_mfma_f32_16x16x32_bf16 v[48:51], a[68:71], a[144:147], v[48:51]
ds_read_b64_tr_b16 a[2:3], v16 offset:34304
v_mfma_f32_16x16x32_bf16 v[64:67], a[72:75], a[144:147], v[64:67]
buffer_load_dwordx4 v4, s[16:19], s67 offen offset:1024 sc1 lds
v_mfma_f32_16x16x32_bf16 v[68:71], a[72:75], a[148:151], v[68:71]
ds_read_b64_tr_b16 a[4:5], v16 offset:33824
v_mfma_f32_16x16x32_bf16 v[84:87], a[76:79], a[148:151], v[84:87]
ds_read_b64_tr_b16 a[6:7], v16 offset:34336
v_mfma_f32_16x16x32_bf16 v[80:83], a[76:79], a[144:147], v[80:83]
buffer_load_dwordx4 v4, s[16:19], s67 offen offset:2048 sc1 lds
v_mfma_f32_16x16x32_bf16 v[96:99], a[80:83], a[144:147], v[96:99]
ds_read_b64_tr_b16 a[8:9], v16 offset:42240
v_mfma_f32_16x16x32_bf16 v[100:103], a[80:83], a[148:151], v[100:103]
ds_read_b64_tr_b16 a[10:11], v16 offset:42752
v_mfma_f32_16x16x32_bf16 v[116:119], a[84:87], a[148:151], v[116:119]
buffer_load_dwordx4 v4, s[16:19], s67 offen offset:3072 sc1 lds
v_mfma_f32_16x16x32_bf16 v[112:115], a[84:87], a[144:147], v[112:115]
s_add_u32 m0, s74, 4096
s_mov_b32 s67, 63180800
v_mfma_f32_16x16x32_bf16 v[128:131], a[88:91], a[144:147], v[128:131]
ds_read_b64_tr_b16 a[12:13], v16 offset:42272
v_mfma_f32_16x16x32_bf16 v[132:135], a[88:91], a[148:151], v[132:135]
buffer_load_dwordx4 v4, s[16:19], s67 offen sc1 lds
v_mfma_f32_16x16x32_bf16 v[148:151], a[92:95], a[148:151], v[148:151]
ds_read_b64_tr_b16 a[14:15], v16 offset:42784
v_mfma_f32_16x16x32_bf16 v[144:147], a[92:95], a[144:147], v[144:147]
ds_read_b64_tr_b16 a[16:17], v16 offset:33856
v_mfma_f32_16x16x32_bf16 v[160:163], a[96:99], a[144:147], v[160:163]
buffer_load_dwordx4 v4, s[16:19], s67 offen offset:1024 sc1 lds
v_mfma_f32_16x16x32_bf16 v[164:167], a[96:99], a[148:151], v[164:167]
ds_read_b64_tr_b16 a[18:19], v16 offset:34368
v_mfma_f32_16x16x32_bf16 v[180:183], a[100:103], a[148:151], v[180:183]
ds_read_b64_tr_b16 a[20:21], v16 offset:33888
v_mfma_f32_16x16x32_bf16 v[176:179], a[100:103], a[144:147], v[176:179]
buffer_load_dwordx4 v4, s[16:19], s67 offen offset:2048 sc1 lds
v_mfma_f32_16x16x32_bf16 v[192:195], a[104:107], a[144:147], v[192:195]
ds_read_b64_tr_b16 a[22:23], v16 offset:34400
v_mfma_f32_16x16x32_bf16 v[196:199], a[104:107], a[148:151], v[196:199]
ds_read_b64_tr_b16 a[24:25], v16 offset:42304
v_mfma_f32_16x16x32_bf16 v[212:215], a[108:111], a[148:151], v[212:215]
buffer_load_dwordx4 v4, s[16:19], s67 offen offset:3072 sc1 lds
v_mfma_f32_16x16x32_bf16 v[208:211], a[108:111], a[144:147], v[208:211]
s_add_u32 m0, s55, 101376
ds_read_b64_tr_b16 a[26:27], v16 offset:42816
v_mfma_f32_16x16x32_bf16 v[224:227], a[112:115], a[144:147], v[224:227]
ds_read_b64_tr_b16 a[28:29], v16 offset:42336
v_mfma_f32_16x16x32_bf16 v[228:231], a[112:115], a[148:151], v[228:231]
buffer_load_dwordx4 v12, s[32:35], s54 offen lds
v_mfma_f32_16x16x32_bf16 v[236:239], a[116:119], a[148:151], v[236:239]
ds_read_b64_tr_b16 a[30:31], v16 offset:42848
v_mfma_f32_16x16x32_bf16 v[232:235], a[116:119], a[144:147], v[232:235]
ds_read_b64_tr_b16 a[32:33], v16 offset:33920
v_mfma_f32_16x16x32_bf16 v[240:243], a[120:123], a[144:147], v[240:243]
buffer_load_dwordx4 a[128:131], v10, s[16:19], s52 offen sc1
v_mfma_f32_16x16x32_bf16 v[244:247], a[120:123], a[148:151], v[244:247]
ds_read_b64_tr_b16 a[34:35], v16 offset:34432
v_mfma_f32_16x16x32_bf16 v[252:255], a[124:127], a[148:151], v[252:255]
ds_read_b64_tr_b16 a[36:37], v16 offset:33952
v_mfma_f32_16x16x32_bf16 v[248:251], a[124:127], a[144:147], v[248:251]
buffer_load_dwordx4 v13, s[32:35], s54 offen offset:1056 lds
s_waitcnt vmcnt(27)
v_mfma_f32_16x16x32_bf16 v[220:223], a[108:111], a[156:159], v[220:223]
ds_read_b64_tr_b16 a[38:39], v16 offset:34464
v_mfma_f32_16x16x32_bf16 v[216:219], a[108:111], a[152:155], v[216:219]
ds_read_b64_tr_b16 a[40:41], v16 offset:42368
v_mfma_f32_16x16x32_bf16 v[200:203], a[104:107], a[152:155], v[200:203]
buffer_load_dwordx4 a[132:135], v10, s[16:19], s52 offen offset:1024 sc1
v_mfma_f32_16x16x32_bf16 v[204:207], a[104:107], a[156:159], v[204:207]
ds_read_b64_tr_b16 a[42:43], v16 offset:42880
v_mfma_f32_16x16x32_bf16 v[188:191], a[100:103], a[156:159], v[188:191]
ds_read_b64_tr_b16 a[44:45], v16 offset:42400
v_mfma_f32_16x16x32_bf16 v[184:187], a[100:103], a[152:155], v[184:187]
buffer_load_dwordx4 v14, s[32:35], s54 offen offset:2112 lds
v_mfma_f32_16x16x32_bf16 v[168:171], a[96:99], a[152:155], v[168:171]
ds_read_b64_tr_b16 a[46:47], v16 offset:42912
v_mfma_f32_16x16x32_bf16 v[172:175], a[96:99], a[156:159], v[172:175]
ds_read_b64_tr_b16 a[48:49], v17 offset:33792
v_mfma_f32_16x16x32_bf16 v[156:159], a[92:95], a[156:159], v[156:159]
buffer_load_dwordx4 a[136:139], v11, s[16:19], s52 offen sc1
v_mfma_f32_16x16x32_bf16 v[152:155], a[92:95], a[152:155], v[152:155]
ds_read_b64_tr_b16 a[50:51], v17 offset:34304
v_mfma_f32_16x16x32_bf16 v[136:139], a[88:91], a[152:155], v[136:139]
ds_read_b64_tr_b16 a[52:53], v17 offset:33824
v_mfma_f32_16x16x32_bf16 v[140:143], a[88:91], a[156:159], v[140:143]
buffer_load_dwordx4 v15, s[32:35], s54 offen offset:3168 lds
v_mfma_f32_16x16x32_bf16 v[124:127], a[84:87], a[156:159], v[124:127]
s_add_u32 s54, s54, 229376
ds_read_b64_tr_b16 a[54:55], v17 offset:34336
v_mfma_f32_16x16x32_bf16 v[120:123], a[84:87], a[152:155], v[120:123]
ds_read_b64_tr_b16 a[56:57], v17 offset:42240
v_mfma_f32_16x16x32_bf16 v[104:107], a[80:83], a[152:155], v[104:107]
buffer_load_dwordx4 a[140:143], v11, s[16:19], s52 offen offset:1024 sc1
v_mfma_f32_16x16x32_bf16 v[108:111], a[80:83], a[156:159], v[108:111]
s_add_u32 s52, s52, 0x20000
ds_read_b64_tr_b16 a[58:59], v17 offset:42752
v_mfma_f32_16x16x32_bf16 v[92:95], a[76:79], a[156:159], v[92:95]
ds_read_b64_tr_b16 a[60:61], v17 offset:42272
v_mfma_f32_16x16x32_bf16 v[88:91], a[76:79], a[152:155], v[88:91]
ds_read_b64_tr_b16 a[62:63], v17 offset:42784
v_mfma_f32_16x16x32_bf16 v[72:75], a[72:75], a[152:155], v[72:75]
v_mfma_f32_16x16x32_bf16 v[76:79], a[72:75], a[156:159], v[76:79]
v_mfma_f32_16x16x32_bf16 v[60:63], a[68:71], a[156:159], v[60:63]
v_mfma_f32_16x16x32_bf16 v[56:59], a[68:71], a[152:155], v[56:59]
v_mfma_f32_16x16x32_bf16 v[40:43], a[64:67], a[152:155], v[40:43]
v_mfma_f32_16x16x32_bf16 v[44:47], a[64:67], a[156:159], v[44:47]
s_waitcnt vmcnt(28) lgkmcnt(0)
s_barrier
s_waitcnt vmcnt(27)
v_mfma_f32_16x16x32_bf16 v[32:35], a[0:3], a[160:163], v[32:35]
s_add_u32 m0, s55, 118272
.Lpad20:
s_cbranch_execz .Lpad23
ds_read_b64_tr_b16 a[64:65], v16 offset:50688
s_waitcnt vmcnt(26)
v_mfma_f32_16x16x32_bf16 v[36:39], a[0:3], a[164:167], v[36:39]
buffer_load_dwordx4 v12, s[32:35], s54 offen lds
v_mfma_f32_16x16x32_bf16 v[52:55], a[4:7], a[164:167], v[52:55]
ds_read_b64_tr_b16 a[66:67], v16 offset:51200
v_mfma_f32_16x16x32_bf16 v[48:51], a[4:7], a[160:163], v[48:51]
ds_read_b64_tr_b16 a[68:69], v16 offset:50720
v_mfma_f32_16x16x32_bf16 v[64:67], a[8:11], a[160:163], v[64:67]
ds_read_b64_tr_b16 a[70:71], v16 offset:51232
v_mfma_f32_16x16x32_bf16 v[68:71], a[8:11], a[164:167], v[68:71]
ds_read_b64_tr_b16 a[72:73], v16 offset:59136
v_mfma_f32_16x16x32_bf16 v[84:87], a[12:15], a[164:167], v[84:87]
ds_read_b64_tr_b16 a[74:75], v16 offset:59648
v_mfma_f32_16x16x32_bf16 v[80:83], a[12:15], a[160:163], v[80:83]
buffer_load_dwordx4 a[144:147], v10, s[16:19], s52 offen sc1
v_mfma_f32_16x16x32_bf16 v[96:99], a[16:19], a[160:163], v[96:99]
ds_read_b64_tr_b16 a[76:77], v16 offset:59168
v_mfma_f32_16x16x32_bf16 v[100:103], a[16:19], a[164:167], v[100:103]
ds_read_b64_tr_b16 a[78:79], v16 offset:59680
v_mfma_f32_16x16x32_bf16 v[116:119], a[20:23], a[164:167], v[116:119]
ds_read_b64_tr_b16 a[80:81], v16 offset:50752
v_mfma_f32_16x16x32_bf16 v[112:115], a[20:23], a[160:163], v[112:115]
ds_read_b64_tr_b16 a[82:83], v16 offset:51264
v_mfma_f32_16x16x32_bf16 v[128:131], a[24:27], a[160:163], v[128:131]
ds_read_b64_tr_b16 a[84:85], v16 offset:50784
v_mfma_f32_16x16x32_bf16 v[132:135], a[24:27], a[164:167], v[132:135]
s_waitcnt vmcnt(10)
ds_read_b128 v[20:23], v2
v_mfma_f32_16x16x32_bf16 v[148:151], a[28:31], a[164:167], v[148:151]
ds_read_b128 v[28:31], v2 offset:1024
v_mfma_f32_16x16x32_bf16 v[144:147], a[28:31], a[160:163], v[144:147]
ds_read_b128 v[24:27], v2 offset:2048
v_mfma_f32_16x16x32_bf16 v[160:163], a[32:35], a[160:163], v[160:163]
buffer_load_dwordx4 v13, s[32:35], s54 offen offset:1056 lds
v_mfma_f32_16x16x32_bf16 v[164:167], a[32:35], a[164:167], v[164:167]
ds_read_b64_tr_b16 a[86:87], v16 offset:51296
v_mfma_f32_16x16x32_bf16 v[180:183], a[36:39], a[164:167], v[180:183]
ds_read_b64_tr_b16 a[88:89], v16 offset:59200
v_mfma_f32_16x16x32_bf16 v[176:179], a[36:39], a[160:163], v[176:179]
ds_read_b64_tr_b16 a[90:91], v16 offset:59712
v_mfma_f32_16x16x32_bf16 v[192:195], a[40:43], a[160:163], v[192:195]
ds_read_b64_tr_b16 a[92:93], v16 offset:59232
v_mfma_f32_16x16x32_bf16 v[196:199], a[40:43], a[164:167], v[196:199]
ds_read_b64_tr_b16 a[94:95], v16 offset:59744
v_mfma_f32_16x16x32_bf16 v[212:215], a[44:47], a[164:167], v[212:215]
buffer_load_dwordx4 a[148:151], v10, s[16:19], s52 offen offset:1024 sc1
v_mfma_f32_16x16x32_bf16 v[208:211], a[44:47], a[160:163], v[208:211]
ds_read_b64_tr_b16 a[96:97], v16 offset:50816
s_waitcnt lgkmcnt(7)
v_add_f32 v20, v20, v28
v_mfma_f32_16x16x32_bf16 v[224:227], a[48:51], a[160:163], v[224:227]
ds_read_b64_tr_b16 a[98:99], v16 offset:51328
v_add_f32 v21, v21, v29
v_mfma_f32_16x16x32_bf16 v[228:231], a[48:51], a[164:167], v[228:231]
ds_read_b64_tr_b16 a[100:101], v16 offset:50848
v_add_f32 v22, v22, v30
v_mfma_f32_16x16x32_bf16 v[236:239], a[52:55], a[164:167], v[236:239]
ds_read_b64_tr_b16 a[102:103], v16 offset:51360
v_add_f32 v23, v23, v31
v_mfma_f32_16x16x32_bf16 v[232:235], a[52:55], a[160:163], v[232:235]
ds_read_b128 v[28:31], v2 offset:3072
s_waitcnt lgkmcnt(10)
v_add_f32 v20, v20, v24
v_mfma_f32_16x16x32_bf16 v[240:243], a[56:59], a[160:163], v[240:243]
buffer_load_dwordx4 v14, s[32:35], s54 offen offset:2112 lds
v_mfma_f32_16x16x32_bf16 v[244:247], a[56:59], a[164:167], v[244:247]
ds_read_b64_tr_b16 a[104:105], v16 offset:59264
v_add_f32 v21, v21, v25
v_mfma_f32_16x16x32_bf16 v[252:255], a[60:63], a[164:167], v[252:255]
ds_read_b64_tr_b16 a[106:107], v16 offset:59776
v_add_f32 v22, v22, v26
v_mfma_f32_16x16x32_bf16 v[248:251], a[60:63], a[160:163], v[248:251]
ds_read_b64_tr_b16 a[108:109], v16 offset:59296
v_add_f32 v23, v23, v27
v_mfma_f32_16x16x32_bf16 v[220:223], a[44:47], a[172:175], v[220:223]
ds_read_b128 v[24:27], v2 offset:4096
v_mfma_f32_16x16x32_bf16 v[216:219], a[44:47], a[168:171], v[216:219]
ds_read_b64_tr_b16 a[110:111], v16 offset:59808
v_mfma_f32_16x16x32_bf16 v[200:203], a[40:43], a[168:171], v[200:203]
buffer_load_dwordx4 a[152:155], v11, s[16:19], s52 offen sc1
v_mfma_f32_16x16x32_bf16 v[204:207], a[40:43], a[172:175], v[204:207]
ds_read_b64_tr_b16 a[112:113], v17 offset:50688
s_waitcnt lgkmcnt(6)
v_add_f32 v20, v20, v28
v_mfma_f32_16x16x32_bf16 v[188:191], a[36:39], a[172:175], v[188:191]
ds_read_b64_tr_b16 a[114:115], v17 offset:51200
v_add_f32 v21, v21, v29
v_mfma_f32_16x16x32_bf16 v[184:187], a[36:39], a[168:171], v[184:187]
ds_read_b64_tr_b16 a[116:117], v17 offset:50720
v_add_f32 v22, v22, v30
v_mfma_f32_16x16x32_bf16 v[168:171], a[32:35], a[168:171], v[168:171]
ds_read_b64_tr_b16 a[118:119], v17 offset:51232
v_add_f32 v23, v23, v31
v_mfma_f32_16x16x32_bf16 v[172:175], a[32:35], a[172:175], v[172:175]
ds_read_b128 v[28:31], v2 offset:5120
v_mfma_f32_16x16x32_bf16 v[156:159], a[28:31], a[172:175], v[156:159]
buffer_load_dwordx4 v15, s[32:35], s54 offen offset:3168 lds
v_mfma_f32_16x16x32_bf16 v[152:155], a[28:31], a[168:171], v[152:155]
s_add_u32 s54, s54, 229376
s_waitcnt lgkmcnt(6)
v_add_f32 v20, v20, v24
v_add_f32 v21, v21, v25
v_mfma_f32_16x16x32_bf16 v[136:139], a[24:27], a[168:171], v[136:139]
ds_read_b64_tr_b16 a[120:121], v17 offset:59136
v_add_f32 v22, v22, v26
v_mfma_f32_16x16x32_bf16 v[140:143], a[24:27], a[172:175], v[140:143]
ds_read_b64_tr_b16 a[122:123], v17 offset:59648
v_mfma_f32_16x16x32_bf16 v[124:127], a[20:23], a[172:175], v[124:127]
ds_read_b64_tr_b16 a[124:125], v17 offset:59168
v_mfma_f32_16x16x32_bf16 v[120:123], a[20:23], a[168:171], v[120:123]
ds_read_b64_tr_b16 a[126:127], v17 offset:59680
v_mfma_f32_16x16x32_bf16 v[104:107], a[16:19], a[168:171], v[104:107]
buffer_load_dwordx4 a[156:159], v11, s[16:19], s52 offen offset:1024 sc1
v_mfma_f32_16x16x32_bf16 v[108:111], a[16:19], a[172:175], v[108:111]
s_add_u32 s52, s52, 0x20000
v_mfma_f32_16x16x32_bf16 v[92:95], a[12:15], a[172:175], v[92:95]
v_mfma_f32_16x16x32_bf16 v[88:91], a[12:15], a[168:171], v[88:91]
v_mfma_f32_16x16x32_bf16 v[72:75], a[8:11], a[168:171], v[72:75]
v_mfma_f32_16x16x32_bf16 v[76:79], a[8:11], a[172:175], v[76:79]
v_mfma_f32_16x16x32_bf16 v[60:63], a[4:7], a[172:175], v[60:63]
v_mfma_f32_16x16x32_bf16 v[56:59], a[4:7], a[168:171], v[56:59]
v_mfma_f32_16x16x32_bf16 v[40:43], a[0:3], a[168:171], v[40:43]
v_mfma_f32_16x16x32_bf16 v[44:47], a[0:3], a[172:175], v[44:47]
s_waitcnt lgkmcnt(0)
s_barrier
v_mfma_f32_16x16x32_bf16 v[32:35], a[64:67], a[176:179], v[32:35]
s_add_u32 m0, s55, 135168
v_add_f32 v23, v23, v27
v_add_f32 v20, v20, v28
v_mfma_f32_16x16x32_bf16 v[36:39], a[64:67], a[180:183], v[36:39]
ds_read_b128 v[24:27], v2 offset:6144
v_add_f32 v21, v21, v29
v_mfma_f32_16x16x32_bf16 v[52:55], a[68:71], a[180:183], v[52:55]
buffer_load_dwordx4 v12, s[32:35], s54 offen lds
v_mfma_f32_16x16x32_bf16 v[48:51], a[68:71], a[176:179], v[48:51]
ds_read_b64_tr_b16 a[0:1], v16
v_add_f32 v22, v22, v30
v_mfma_f32_16x16x32_bf16 v[64:67], a[72:75], a[176:179], v[64:67]
ds_read_b64_tr_b16 a[2:3], v16 offset:512
v_add_f32 v23, v23, v31
v_mfma_f32_16x16x32_bf16 v[68:71], a[72:75], a[180:183], v[68:71]
ds_read_b128 v[28:31], v2 offset:7168
v_mfma_f32_16x16x32_bf16 v[84:87], a[76:79], a[180:183], v[84:87]
ds_read_b64_tr_b16 a[4:5], v16 offset:32
v_mfma_f32_16x16x32_bf16 v[80:83], a[76:79], a[176:179], v[80:83]
ds_read_b64_tr_b16 a[6:7], v16 offset:544
v_mfma_f32_16x16x32_bf16 v[96:99], a[80:83], a[176:179], v[96:99]
buffer_load_dwordx4 a[160:163], v10, s[16:19], s52 offen sc1
v_mfma_f32_16x16x32_bf16 v[100:103], a[80:83], a[180:183], v[100:103]
ds_read_b64_tr_b16 a[8:9], v16 offset:8448
s_waitcnt lgkmcnt(6)
v_add_f32 v20, v20, v24
v_mfma_f32_16x16x32_bf16 v[116:119], a[84:87], a[180:183], v[116:119]
ds_read_b64_tr_b16 a[10:11], v16 offset:8960
v_add_f32 v21, v21, v25
v_mfma_f32_16x16x32_bf16 v[112:115], a[84:87], a[176:179], v[112:115]
ds_read_b64_tr_b16 a[12:13], v16 offset:8480
v_add_f32 v22, v22, v26
v_mfma_f32_16x16x32_bf16 v[128:131], a[88:91], a[176:179], v[128:131]
ds_read_b64_tr_b16 a[14:15], v16 offset:8992
v_add_f32 v23, v23, v27
v_mfma_f32_16x16x32_bf16 v[132:135], a[88:91], a[180:183], v[132:135]
ds_read_b64_tr_b16 a[16:17], v16 offset:64
s_waitcnt lgkmcnt(7)
v_add_f32 v20, v20, v28
v_mfma_f32_16x16x32_bf16 v[148:151], a[92:95], a[180:183], v[148:151]
buffer_load_dwordx4 v13, s[32:35], s54 offen offset:1056 lds
v_mfma_f32_16x16x32_bf16 v[144:147], a[92:95], a[176:179], v[144:147]
ds_read_b64_tr_b16 a[18:19], v16 offset:576
v_add_f32 v21, v21, v29
v_mfma_f32_16x16x32_bf16 v[160:163], a[96:99], a[176:179], v[160:163]
ds_read_b64_tr_b16 a[20:21], v16 offset:96
v_add_f32 v22, v22, v30
v_mfma_f32_16x16x32_bf16 v[164:167], a[96:99], a[180:183], v[164:167]
ds_read_b64_tr_b16 a[22:23], v16 offset:608
v_permlane32_swap_b32 v20, v22
v_mfma_f32_16x16x32_bf16 v[180:183], a[100:103], a[180:183], v[180:183]
ds_read_b64_tr_b16 a[24:25], v16 offset:8512
v_add_f32 v23, v23, v31
v_mfma_f32_16x16x32_bf16 v[176:179], a[100:103], a[176:179], v[176:179]
ds_read_b64_tr_b16 a[26:27], v16 offset:9024
v_permlane32_swap_b32 v21, v23
v_mfma_f32_16x16x32_bf16 v[192:195], a[104:107], a[176:179], v[192:195]
buffer_load_dwordx4 a[164:167], v10, s[16:19], s52 offen offset:1024 sc1
v_mfma_f32_16x16x32_bf16 v[196:199], a[104:107], a[180:183], v[196:199]
ds_read_b64_tr_b16 a[28:29], v16 offset:8544
v_add_f32 v20, v20, v22
v_mfma_f32_16x16x32_bf16 v[212:215], a[108:111], a[180:183], v[212:215]
ds_read_b64_tr_b16 a[30:31], v16 offset:9056
v_add_f32 v21, v21, v23
v_mfma_f32_16x16x32_bf16 v[208:211], a[108:111], a[176:179], v[208:211]
ds_read_b64_tr_b16 a[32:33], v16 offset:128
v_mul_f32 v20, 0xba800000, v20
v_mfma_f32_16x16x32_bf16 v[224:227], a[112:115], a[176:179], v[224:227]
ds_read_b64_tr_b16 a[34:35], v16 offset:640
v_mul_f32 v21, 0x3a800000, v21
v_mfma_f32_16x16x32_bf16 v[228:231], a[112:115], a[180:183], v[228:231]
ds_read_b64_tr_b16 a[36:37], v16 offset:160
v_fma_f32 v21, -v20, v20, v21
v_mfma_f32_16x16x32_bf16 v[236:239], a[116:119], a[180:183], v[236:239]
buffer_load_dwordx4 v14, s[32:35], s54 offen offset:2112 lds
v_mfma_f32_16x16x32_bf16 v[232:235], a[116:119], a[176:179], v[232:235]
ds_read_b64_tr_b16 a[38:39], v16 offset:672
v_max_f32 v21, 0, v21
v_mfma_f32_16x16x32_bf16 v[240:243], a[120:123], a[176:179], v[240:243]
ds_read_b64_tr_b16 a[40:41], v16 offset:8576
v_add_f32 v21, 0x3727c5ac, v21
v_mfma_f32_16x16x32_bf16 v[244:247], a[120:123], a[180:183], v[244:247]
ds_read_b64_tr_b16 a[42:43], v16 offset:9088
v_rsq_f32 v22, v21
v_mfma_f32_16x16x32_bf16 v[252:255], a[124:127], a[180:183], v[252:255]
ds_read_b64_tr_b16 a[44:45], v16 offset:8608
v_and_b32 v24, 31, v1
v_mfma_f32_16x16x32_bf16 v[248:251], a[124:127], a[176:179], v[248:251]
ds_read_b64_tr_b16 a[46:47], v16 offset:9120
v_lshrrev_b32 v25, 5, v1
v_mfma_f32_16x16x32_bf16 v[220:223], a[108:111], a[188:191], v[220:223]
buffer_load_dwordx4 a[168:171], v11, s[16:19], s52 offen sc1
v_mfma_f32_16x16x32_bf16 v[216:219], a[108:111], a[184:187], v[216:219]
ds_read_b64_tr_b16 a[48:49], v17
v_lshl_add_u32 v24, v24, 1, v25
v_mfma_f32_16x16x32_bf16 v[200:203], a[104:107], a[184:187], v[200:203]
ds_read_b64_tr_b16 a[50:51], v17 offset:512
v_and_b32 v25, 0xc0, v0
v_mfma_f32_16x16x32_bf16 v[204:207], a[104:107], a[188:191], v[204:207]
ds_read_b64_tr_b16 a[52:53], v17 offset:32
v_add_u32 v24, v24, v25
v_mfma_f32_16x16x32_bf16 v[188:191], a[100:103], a[188:191], v[188:191]
ds_read_b64_tr_b16 a[54:55], v17 offset:544
v_lshlrev_b32 v24, 4, v24
v_mfma_f32_16x16x32_bf16 v[184:187], a[100:103], a[184:187], v[184:187]
ds_read_b64_tr_b16 a[56:57], v17 offset:8448
v_add_u32 v24, 152576, v24
v_mfma_f32_16x16x32_bf16 v[168:171], a[96:99], a[184:187], v[168:171]
buffer_load_dwordx4 v15, s[32:35], s54 offen offset:3168 lds
v_mfma_f32_16x16x32_bf16 v[172:175], a[96:99], a[188:191], v[172:175]
s_add_u32 s54, s54, 229376
v_mul_f32 v22, 0xbfb8aa3b, v22
v_mfma_f32_16x16x32_bf16 v[156:159], a[92:95], a[188:191], v[156:159]
ds_write_b128 v24, v[20:23]
v_mfma_f32_16x16x32_bf16 v[152:155], a[92:95], a[184:187], v[152:155]
ds_read_b64 v[20:21], v18
v_mfma_f32_16x16x32_bf16 v[136:139], a[88:91], a[184:187], v[136:139]
ds_read_b64 v[22:23], v18 offset:256
v_mfma_f32_16x16x32_bf16 v[140:143], a[88:91], a[188:191], v[140:143]
ds_read_b64 v[24:25], v19
v_mfma_f32_16x16x32_bf16 v[124:127], a[84:87], a[188:191], v[124:127]
ds_read_b64 v[26:27], v19 offset:256
v_mfma_f32_16x16x32_bf16 v[120:123], a[84:87], a[184:187], v[120:123]
ds_read_b32 v28, v18 offset:8
v_mfma_f32_16x16x32_bf16 v[104:107], a[80:83], a[184:187], v[104:107]
ds_read_b32 v29, v18 offset:264
v_mfma_f32_16x16x32_bf16 v[108:111], a[80:83], a[188:191], v[108:111]
ds_read_b32 v30, v19 offset:8
v_mfma_f32_16x16x32_bf16 v[92:95], a[76:79], a[188:191], v[92:95]
ds_read_b32 v31, v19 offset:264
v_mfma_f32_16x16x32_bf16 v[88:91], a[76:79], a[184:187], v[88:91]
buffer_load_dwordx4 a[172:175], v11, s[16:19], s52 offen offset:1024 sc1
v_mfma_f32_16x16x32_bf16 v[72:75], a[72:75], a[184:187], v[72:75]
s_add_u32 s52, s52, 0x20000
ds_read_b64_tr_b16 a[58:59], v17 offset:8960
v_mfma_f32_16x16x32_bf16 v[76:79], a[72:75], a[188:191], v[76:79]
ds_read_b64_tr_b16 a[60:61], v17 offset:8480
v_mfma_f32_16x16x32_bf16 v[60:63], a[68:71], a[188:191], v[60:63]
ds_read_b64_tr_b16 a[62:63], v17 offset:8992
v_mfma_f32_16x16x32_bf16 v[56:59], a[68:71], a[184:187], v[56:59]
v_mfma_f32_16x16x32_bf16 v[40:43], a[64:67], a[184:187], v[40:43]
v_mfma_f32_16x16x32_bf16 v[44:47], a[64:67], a[188:191], v[44:47]
s_mov_b32 s58, -131072
s_sub_u32 s67, s59, 16896
s_mov_b32 s15, -6
.p2align 6
.Lk74:
s_waitcnt vmcnt(17) lgkmcnt(0)
s_barrier
v_mfma_f32_16x16x32_bf16 v[32:35], a[0:3], a[128:131], v[32:35]
ds_read_b64_tr_b16 a[64:65], v16 offset:16896
s_add_u32 m0, s55, 84480
v_mfma_f32_16x16x32_bf16 v[36:39], a[0:3], a[132:135], v[36:39]
buffer_load_dwordx4 v12, s[32:35], s54 offen lds
v_mfma_f32_16x16x32_bf16 v[52:55], a[4:7], a[132:135], v[52:55]
ds_read_b64_tr_b16 a[66:67], v16 offset:17408
v_mfma_f32_16x16x32_bf16 v[48:51], a[4:7], a[128:131], v[48:51]
ds_read_b64_tr_b16 a[68:69], v16 offset:16928
v_mfma_f32_16x16x32_bf16 v[64:67], a[8:11], a[128:131], v[64:67]
ds_read_b64_tr_b16 a[70:71], v16 offset:17440
v_mfma_f32_16x16x32_bf16 v[68:71], a[8:11], a[132:135], v[68:71]
v_mfma_f32_16x16x32_bf16 v[84:87], a[12:15], a[132:135], v[84:87]
ds_read_b64_tr_b16 a[72:73], v16 offset:25344
v_mfma_f32_16x16x32_bf16 v[80:83], a[12:15], a[128:131], v[80:83]
buffer_load_dwordx4 a[176:179], v10, s[16:19], s52 offen sc1
v_mfma_f32_16x16x32_bf16 v[96:99], a[16:19], a[128:131], v[96:99]
ds_read_b64_tr_b16 a[74:75], v16 offset:25856
v_mfma_f32_16x16x32_bf16 v[100:103], a[16:19], a[132:135], v[100:103]
ds_read_b64_tr_b16 a[76:77], v16 offset:25376
v_mfma_f32_16x16x32_bf16 v[116:119], a[20:23], a[132:135], v[116:119]
v_mfma_f32_16x16x32_bf16 v[112:115], a[20:23], a[128:131], v[112:115]
ds_read_b64_tr_b16 a[78:79], v16 offset:25888
v_mfma_f32_16x16x32_bf16 v[128:131], a[24:27], a[128:131], v[128:131]
ds_read_b64_tr_b16 a[80:81], v16 offset:16960
v_mfma_f32_16x16x32_bf16 v[132:135], a[24:27], a[132:135], v[132:135]
buffer_load_dwordx4 v13, s[32:35], s54 offen offset:1056 lds
v_mfma_f32_16x16x32_bf16 v[148:151], a[28:31], a[132:135], v[148:151]
ds_read_b64_tr_b16 a[82:83], v16 offset:17472
v_mfma_f32_16x16x32_bf16 v[144:147], a[28:31], a[128:131], v[144:147]
v_mfma_f32_16x16x32_bf16 v[160:163], a[32:35], a[128:131], v[160:163]
ds_read_b64_tr_b16 a[84:85], v16 offset:16992
v_mfma_f32_16x16x32_bf16 v[164:167], a[32:35], a[132:135], v[164:167]
ds_read_b64_tr_b16 a[86:87], v16 offset:17504
v_mfma_f32_16x16x32_bf16 v[180:183], a[36:39], a[132:135], v[180:183]
ds_read_b64_tr_b16 a[88:89], v16 offset:25408
v_mfma_f32_16x16x32_bf16 v[176:179], a[36:39], a[128:131], v[176:179]
buffer_load_dwordx4 a[180:183], v10, s[16:19], s52 offen offset:1024 sc1
v_mfma_f32_16x16x32_bf16 v[192:195], a[40:43], a[128:131], v[192:195]
v_mfma_f32_16x16x32_bf16 v[196:199], a[40:43], a[132:135], v[196:199]
ds_read_b64_tr_b16 a[90:91], v16 offset:25920
v_mfma_f32_16x16x32_bf16 v[212:215], a[44:47], a[132:135], v[212:215]
ds_read_b64_tr_b16 a[92:93], v16 offset:25440
v_mfma_f32_16x16x32_bf16 v[208:211], a[44:47], a[128:131], v[208:211]
ds_read_b64_tr_b16 a[94:95], v16 offset:25952
v_mfma_f32_16x16x32_bf16 v[224:227], a[48:51], a[128:131], v[224:227]
v_mfma_f32_16x16x32_bf16 v[228:231], a[48:51], a[132:135], v[228:231]
buffer_load_dwordx4 v14, s[32:35], s54 offen offset:2112 lds
v_mfma_f32_16x16x32_bf16 v[236:239], a[52:55], a[132:135], v[236:239]
ds_read_b64_tr_b16 a[96:97], v16 offset:17024
v_mfma_f32_16x16x32_bf16 v[232:235], a[52:55], a[128:131], v[232:235]
ds_read_b64_tr_b16 a[98:99], v16 offset:17536
v_mfma_f32_16x16x32_bf16 v[240:243], a[56:59], a[128:131], v[240:243]
ds_read_b64_tr_b16 a[100:101], v16 offset:17056
v_mfma_f32_16x16x32_bf16 v[244:247], a[56:59], a[132:135], v[244:247]
ds_read_b64_tr_b16 a[102:103], v16 offset:17568
v_mfma_f32_16x16x32_bf16 v[252:255], a[60:63], a[132:135], v[252:255]
v_mfma_f32_16x16x32_bf16 v[248:251], a[60:63], a[128:131], v[248:251]
buffer_load_dwordx4 a[184:187], v11, s[16:19], s52 offen sc1
s_waitcnt vmcnt(22)
v_mfma_f32_16x16x32_bf16 v[220:223], a[44:47], a[140:143], v[220:223]
ds_read_b64_tr_b16 a[104:105], v16 offset:25472
v_mfma_f32_16x16x32_bf16 v[216:219], a[44:47], a[136:139], v[216:219]
ds_read_b64_tr_b16 a[106:107], v16 offset:25984
v_mfma_f32_16x16x32_bf16 v[200:203], a[40:43], a[136:139], v[200:203]
ds_read_b64_tr_b16 a[108:109], v16 offset:25504
v_mfma_f32_16x16x32_bf16 v[204:207], a[40:43], a[140:143], v[204:207]
v_mfma_f32_16x16x32_bf16 v[188:191], a[36:39], a[140:143], v[188:191]
ds_read_b64_tr_b16 a[110:111], v16 offset:26016
v_mfma_f32_16x16x32_bf16 v[184:187], a[36:39], a[136:139], v[184:187]
buffer_load_dwordx4 v15, s[32:35], s54 offen offset:3168 lds
v_mfma_f32_16x16x32_bf16 v[168:171], a[32:35], a[136:139], v[168:171]
ds_read_b64_tr_b16 a[112:113], v17 offset:16896
s_add_u32 s54, s54, 229376
v_mfma_f32_16x16x32_bf16 v[172:175], a[32:35], a[140:143], v[172:175]
ds_read_b64_tr_b16 a[114:115], v17 offset:17408
v_mfma_f32_16x16x32_bf16 v[156:159], a[28:31], a[140:143], v[156:159]
v_mfma_f32_16x16x32_bf16 v[152:155], a[28:31], a[136:139], v[152:155]
ds_read_b64_tr_b16 a[116:117], v17 offset:16928
v_mfma_f32_16x16x32_bf16 v[136:139], a[24:27], a[136:139], v[136:139]
ds_read_b64_tr_b16 a[118:119], v17 offset:17440
v_mfma_f32_16x16x32_bf16 v[140:143], a[24:27], a[140:143], v[140:143]
buffer_load_dwordx4 a[188:191], v11, s[16:19], s52 offen offset:1024 sc1
v_mfma_f32_16x16x32_bf16 v[124:127], a[20:23], a[140:143], v[124:127]
ds_read_b64_tr_b16 a[120:121], v17 offset:25344
s_add_u32 s52, s52, 0x20000
v_mfma_f32_16x16x32_bf16 v[120:123], a[20:23], a[136:139], v[120:123]
v_mfma_f32_16x16x32_bf16 v[104:107], a[16:19], a[136:139], v[104:107]
ds_read_b64_tr_b16 a[122:123], v17 offset:25856
v_mfma_f32_16x16x32_bf16 v[108:111], a[16:19], a[140:143], v[108:111]
ds_read_b64_tr_b16 a[124:125], v17 offset:25376
v_mfma_f32_16x16x32_bf16 v[92:95], a[12:15], a[140:143], v[92:95]
ds_read_b64_tr_b16 a[126:127], v17 offset:25888
s_max_i32 m0, s67, s59
v_mfma_f32_16x16x32_bf16 v[88:91], a[12:15], a[136:139], v[88:91]
buffer_load_dwordx4 v5, s[28:31], s58 offen lds
v_mfma_f32_16x16x32_bf16 v[72:75], a[8:11], a[136:139], v[72:75]
v_mfma_f32_16x16x32_bf16 v[76:79], a[8:11], a[140:143], v[76:79]
v_mfma_f32_16x16x32_bf16 v[60:63], a[4:7], a[140:143], v[60:63]
v_mfma_f32_16x16x32_bf16 v[56:59], a[4:7], a[136:139], v[56:59]
v_mfma_f32_16x16x32_bf16 v[40:43], a[0:3], a[136:139], v[40:43]
v_mfma_f32_16x16x32_bf16 v[44:47], a[0:3], a[140:143], v[44:47]
s_waitcnt vmcnt(18) lgkmcnt(0)
s_barrier
v_mfma_f32_16x16x32_bf16 v[32:35], a[64:67], a[144:147], v[32:35]
ds_read_b64_tr_b16 a[0:1], v16 offset:33792
s_add_u32 m0, s55, 101376
v_mfma_f32_16x16x32_bf16 v[36:39], a[64:67], a[148:151], v[36:39]
buffer_load_dwordx4 v12, s[32:35], s54 offen lds
v_mfma_f32_16x16x32_bf16 v[52:55], a[68:71], a[148:151], v[52:55]
ds_read_b64_tr_b16 a[2:3], v16 offset:34304
v_mfma_f32_16x16x32_bf16 v[48:51], a[68:71], a[144:147], v[48:51]
ds_read_b64_tr_b16 a[4:5], v16 offset:33824
v_mfma_f32_16x16x32_bf16 v[64:67], a[72:75], a[144:147], v[64:67]
ds_read_b64_tr_b16 a[6:7], v16 offset:34336
v_mfma_f32_16x16x32_bf16 v[68:71], a[72:75], a[148:151], v[68:71]
v_mfma_f32_16x16x32_bf16 v[84:87], a[76:79], a[148:151], v[84:87]
ds_read_b64_tr_b16 a[8:9], v16 offset:42240
v_mfma_f32_16x16x32_bf16 v[80:83], a[76:79], a[144:147], v[80:83]
buffer_load_dwordx4 a[128:131], v10, s[16:19], s52 offen sc1
v_mfma_f32_16x16x32_bf16 v[96:99], a[80:83], a[144:147], v[96:99]
ds_read_b64_tr_b16 a[10:11], v16 offset:42752
v_mfma_f32_16x16x32_bf16 v[100:103], a[80:83], a[148:151], v[100:103]
ds_read_b64_tr_b16 a[12:13], v16 offset:42272
v_mfma_f32_16x16x32_bf16 v[116:119], a[84:87], a[148:151], v[116:119]
ds_read_b64_tr_b16 a[14:15], v16 offset:42784
v_mfma_f32_16x16x32_bf16 v[112:115], a[84:87], a[144:147], v[112:115]
v_mfma_f32_16x16x32_bf16 v[128:131], a[88:91], a[144:147], v[128:131]
ds_read_b64_tr_b16 a[16:17], v16 offset:33856
v_mfma_f32_16x16x32_bf16 v[132:135], a[88:91], a[148:151], v[132:135]
buffer_load_dwordx4 v13, s[32:35], s54 offen offset:1056 lds
v_mfma_f32_16x16x32_bf16 v[148:151], a[92:95], a[148:151], v[148:151]
ds_read_b64_tr_b16 a[18:19], v16 offset:34368
v_mfma_f32_16x16x32_bf16 v[144:147], a[92:95], a[144:147], v[144:147]
ds_read_b64_tr_b16 a[20:21], v16 offset:33888
v_mfma_f32_16x16x32_bf16 v[160:163], a[96:99], a[144:147], v[160:163]
v_mfma_f32_16x16x32_bf16 v[164:167], a[96:99], a[148:151], v[164:167]
ds_read_b64_tr_b16 a[22:23], v16 offset:34400
v_mfma_f32_16x16x32_bf16 v[180:183], a[100:103], a[148:151], v[180:183]
ds_read_b64_tr_b16 a[24:25], v16 offset:42304
v_mfma_f32_16x16x32_bf16 v[176:179], a[100:103], a[144:147], v[176:179]
buffer_load_dwordx4 a[132:135], v10, s[16:19], s52 offen offset:1024 sc1
v_mfma_f32_16x16x32_bf16 v[192:195], a[104:107], a[144:147], v[192:195]
ds_read_b64_tr_b16 a[26:27], v16 offset:42816
v_mfma_f32_16x16x32_bf16 v[196:199], a[104:107], a[148:151], v[196:199]
ds_read_b64_tr_b16 a[28:29], v16 offset:42336
v_mfma_f32_16x16x32_bf16 v[212:215], a[108:111], a[148:151], v[212:215]
v_mfma_f32_16x16x32_bf16 v[208:211], a[108:111], a[144:147], v[208:211]
ds_read_b64_tr_b16 a[30:31], v16 offset:42848
v_mfma_f32_16x16x32_bf16 v[224:227], a[112:115], a[144:147], v[224:227]
ds_read_b64_tr_b16 a[32:33], v16 offset:33920
v_mfma_f32_16x16x32_bf16 v[228:231], a[112:115], a[148:151], v[228:231]
buffer_load_dwordx4 v14, s[32:35], s54 offen offset:2112 lds
v_mfma_f32_16x16x32_bf16 v[236:239], a[116:119], a[148:151], v[236:239]
ds_read_b64_tr_b16 a[34:35], v16 offset:34432
v_mfma_f32_16x16x32_bf16 v[232:235], a[116:119], a[144:147], v[232:235]
v_mfma_f32_16x16x32_bf16 v[240:243], a[120:123], a[144:147], v[240:243]
ds_read_b64_tr_b16 a[36:37], v16 offset:33952
v_mfma_f32_16x16x32_bf16 v[244:247], a[120:123], a[148:151], v[244:247]
ds_read_b64_tr_b16 a[38:39], v16 offset:34464
v_mfma_f32_16x16x32_bf16 v[252:255], a[124:127], a[148:151], v[252:255]
ds_read_b64_tr_b16 a[40:41], v16 offset:42368
v_mfma_f32_16x16x32_bf16 v[248:251], a[124:127], a[144:147], v[248:251]
buffer_load_dwordx4 a[136:139], v11, s[16:19], s52 offen sc1
s_waitcnt vmcnt(23)
v_mfma_f32_16x16x32_bf16 v[220:223], a[108:111], a[156:159], v[220:223]
ds_read_b64_tr_b16 a[42:43], v16 offset:42880
v_mfma_f32_16x16x32_bf16 v[216:219], a[108:111], a[152:155], v[216:219]
v_mfma_f32_16x16x32_bf16 v[200:203], a[104:107], a[152:155], v[200:203]
ds_read_b64_tr_b16 a[44:45], v16 offset:42400
v_mfma_f32_16x16x32_bf16 v[204:207], a[104:107], a[156:159], v[204:207]
ds_read_b64_tr_b16 a[46:47], v16 offset:42912
v_mfma_f32_16x16x32_bf16 v[188:191], a[100:103], a[156:159], v[188:191]
ds_read_b64_tr_b16 a[48:49], v17 offset:33792
v_mfma_f32_16x16x32_bf16 v[184:187], a[100:103], a[152:155], v[184:187]
buffer_load_dwordx4 v15, s[32:35], s54 offen offset:3168 lds
v_mfma_f32_16x16x32_bf16 v[168:171], a[96:99], a[152:155], v[168:171]
s_add_u32 s54, s54, 229376
v_mfma_f32_16x16x32_bf16 v[172:175], a[96:99], a[156:159], v[172:175]
ds_read_b64_tr_b16 a[50:51], v17 offset:34304
v_mfma_f32_16x16x32_bf16 v[156:159], a[92:95], a[156:159], v[156:159]
ds_read_b64_tr_b16 a[52:53], v17 offset:33824
v_mfma_f32_16x16x32_bf16 v[152:155], a[92:95], a[152:155], v[152:155]
ds_read_b64_tr_b16 a[54:55], v17 offset:34336
v_mfma_f32_16x16x32_bf16 v[136:139], a[88:91], a[152:155], v[136:139]
ds_read_b64_tr_b16 a[56:57], v17 offset:42240
v_mfma_f32_16x16x32_bf16 v[140:143], a[88:91], a[156:159], v[140:143]
buffer_load_dwordx4 a[140:143], v11, s[16:19], s52 offen offset:1024 sc1
v_mfma_f32_16x16x32_bf16 v[124:127], a[84:87], a[156:159], v[124:127]
s_add_u32 s52, s52, 0x20000
v_mfma_f32_16x16x32_bf16 v[120:123], a[84:87], a[152:155], v[120:123]
ds_read_b64_tr_b16 a[58:59], v17 offset:42752
v_mfma_f32_16x16x32_bf16 v[104:107], a[80:83], a[152:155], v[104:107]
ds_read_b64_tr_b16 a[60:61], v17 offset:42272
v_mfma_f32_16x16x32_bf16 v[108:111], a[80:83], a[156:159], v[108:111]
ds_read_b64_tr_b16 a[62:63], v17 offset:42784
v_mfma_f32_16x16x32_bf16 v[92:95], a[76:79], a[156:159], v[92:95]
s_max_i32 m0, s67, s59
v_mfma_f32_16x16x32_bf16 v[88:91], a[76:79], a[152:155], v[88:91]
buffer_load_dwordx4 v6, s[28:31], s58 offen offset:1056 lds
v_mfma_f32_16x16x32_bf16 v[72:75], a[72:75], a[152:155], v[72:75]
s_add_u32 s67, s67, 8448
s_add_u32 s58, s58, 0x10000
v_mfma_f32_16x16x32_bf16 v[76:79], a[72:75], a[156:159], v[76:79]
v_mfma_f32_16x16x32_bf16 v[60:63], a[68:71], a[156:159], v[60:63]
v_mfma_f32_16x16x32_bf16 v[56:59], a[68:71], a[152:155], v[56:59]
v_mfma_f32_16x16x32_bf16 v[40:43], a[64:67], a[152:155], v[40:43]
v_mfma_f32_16x16x32_bf16 v[44:47], a[64:67], a[156:159], v[44:47]
s_waitcnt vmcnt(19) lgkmcnt(0)
s_barrier
v_mfma_f32_16x16x32_bf16 v[32:35], a[0:3], a[160:163], v[32:35]
ds_read_b64_tr_b16 a[64:65], v16 offset:50688
s_add_u32 m0, s55, 118272
v_mfma_f32_16x16x32_bf16 v[36:39], a[0:3], a[164:167], v[36:39]
buffer_load_dwordx4 v12, s[32:35], s54 offen lds
v_mfma_f32_16x16x32_bf16 v[52:55], a[4:7], a[164:167], v[52:55]
ds_read_b64_tr_b16 a[66:67], v16 offset:51200
v_mfma_f32_16x16x32_bf16 v[48:51], a[4:7], a[160:163], v[48:51]
ds_read_b64_tr_b16 a[68:69], v16 offset:50720
v_mfma_f32_16x16x32_bf16 v[64:67], a[8:11], a[160:163], v[64:67]
ds_read_b64_tr_b16 a[70:71], v16 offset:51232
v_mfma_f32_16x16x32_bf16 v[68:71], a[8:11], a[164:167], v[68:71]
v_mfma_f32_16x16x32_bf16 v[84:87], a[12:15], a[164:167], v[84:87]
ds_read_b64_tr_b16 a[72:73], v16 offset:59136
v_mfma_f32_16x16x32_bf16 v[80:83], a[12:15], a[160:163], v[80:83]
buffer_load_dwordx4 a[144:147], v10, s[16:19], s52 offen sc1
v_mfma_f32_16x16x32_bf16 v[96:99], a[16:19], a[160:163], v[96:99]
ds_read_b64_tr_b16 a[74:75], v16 offset:59648
v_mfma_f32_16x16x32_bf16 v[100:103], a[16:19], a[164:167], v[100:103]
ds_read_b64_tr_b16 a[76:77], v16 offset:59168
v_mfma_f32_16x16x32_bf16 v[116:119], a[20:23], a[164:167], v[116:119]
v_mfma_f32_16x16x32_bf16 v[112:115], a[20:23], a[160:163], v[112:115]
ds_read_b64_tr_b16 a[78:79], v16 offset:59680
v_mfma_f32_16x16x32_bf16 v[128:131], a[24:27], a[160:163], v[128:131]
ds_read_b64_tr_b16 a[80:81], v16 offset:50752
v_mfma_f32_16x16x32_bf16 v[132:135], a[24:27], a[164:167], v[132:135]
buffer_load_dwordx4 v13, s[32:35], s54 offen offset:1056 lds
v_mfma_f32_16x16x32_bf16 v[148:151], a[28:31], a[164:167], v[148:151]
ds_read_b64_tr_b16 a[82:83], v16 offset:51264
v_mfma_f32_16x16x32_bf16 v[144:147], a[28:31], a[160:163], v[144:147]
v_mfma_f32_16x16x32_bf16 v[160:163], a[32:35], a[160:163], v[160:163]
ds_read_b64_tr_b16 a[84:85], v16 offset:50784
v_mfma_f32_16x16x32_bf16 v[164:167], a[32:35], a[164:167], v[164:167]
ds_read_b64_tr_b16 a[86:87], v16 offset:51296
v_mfma_f32_16x16x32_bf16 v[180:183], a[36:39], a[164:167], v[180:183]
ds_read_b64_tr_b16 a[88:89], v16 offset:59200
v_mfma_f32_16x16x32_bf16 v[176:179], a[36:39], a[160:163], v[176:179]
buffer_load_dwordx4 a[148:151], v10, s[16:19], s52 offen offset:1024 sc1
v_mfma_f32_16x16x32_bf16 v[192:195], a[40:43], a[160:163], v[192:195]
v_mfma_f32_16x16x32_bf16 v[196:199], a[40:43], a[164:167], v[196:199]
ds_read_b64_tr_b16 a[90:91], v16 offset:59712
v_mfma_f32_16x16x32_bf16 v[212:215], a[44:47], a[164:167], v[212:215]
ds_read_b64_tr_b16 a[92:93], v16 offset:59232
v_mfma_f32_16x16x32_bf16 v[208:211], a[44:47], a[160:163], v[208:211]
ds_read_b64_tr_b16 a[94:95], v16 offset:59744
v_mfma_f32_16x16x32_bf16 v[224:227], a[48:51], a[160:163], v[224:227]
v_mfma_f32_16x16x32_bf16 v[228:231], a[48:51], a[164:167], v[228:231]
buffer_load_dwordx4 v14, s[32:35], s54 offen offset:2112 lds
v_mfma_f32_16x16x32_bf16 v[236:239], a[52:55], a[164:167], v[236:239]
ds_read_b64_tr_b16 a[96:97], v16 offset:50816
v_mfma_f32_16x16x32_bf16 v[232:235], a[52:55], a[160:163], v[232:235]
ds_read_b64_tr_b16 a[98:99], v16 offset:51328
v_mfma_f32_16x16x32_bf16 v[240:243], a[56:59], a[160:163], v[240:243]
ds_read_b64_tr_b16 a[100:101], v16 offset:50848
v_mfma_f32_16x16x32_bf16 v[244:247], a[56:59], a[164:167], v[244:247]
ds_read_b64_tr_b16 a[102:103], v16 offset:51360
v_mfma_f32_16x16x32_bf16 v[252:255], a[60:63], a[164:167], v[252:255]
.Lpad21:
s_cbranch_execz .Lnopoll72r
v_mfma_f32_16x16x32_bf16 v[248:251], a[60:63], a[160:163], v[248:251]
buffer_load_dwordx4 a[152:155], v11, s[16:19], s52 offen sc1
s_waitcnt vmcnt(24)
v_mfma_f32_16x16x32_bf16 v[220:223], a[44:47], a[172:175], v[220:223]
ds_read_b64_tr_b16 a[104:105], v16 offset:59264
v_mfma_f32_16x16x32_bf16 v[216:219], a[44:47], a[168:171], v[216:219]
ds_read_b64_tr_b16 a[106:107], v16 offset:59776
v_mfma_f32_16x16x32_bf16 v[200:203], a[40:43], a[168:171], v[200:203]
ds_read_b64_tr_b16 a[108:109], v16 offset:59296
v_mfma_f32_16x16x32_bf16 v[204:207], a[40:43], a[172:175], v[204:207]
v_mfma_f32_16x16x32_bf16 v[188:191], a[36:39], a[172:175], v[188:191]
ds_read_b64_tr_b16 a[110:111], v16 offset:59808
v_mfma_f32_16x16x32_bf16 v[184:187], a[36:39], a[168:171], v[184:187]
buffer_load_dwordx4 v15, s[32:35], s54 offen offset:3168 lds
v_mfma_f32_16x16x32_bf16 v[168:171], a[32:35], a[168:171], v[168:171]
ds_read_b64_tr_b16 a[112:113], v17 offset:50688
s_add_u32 s54, s54, 229376
v_mfma_f32_16x16x32_bf16 v[172:175], a[32:35], a[172:175], v[172:175]
ds_read_b64_tr_b16 a[114:115], v17 offset:51200
v_mfma_f32_16x16x32_bf16 v[156:159], a[28:31], a[172:175], v[156:159]
v_mfma_f32_16x16x32_bf16 v[152:155], a[28:31], a[168:171], v[152:155]
ds_read_b64_tr_b16 a[116:117], v17 offset:50720
v_mfma_f32_16x16x32_bf16 v[136:139], a[24:27], a[168:171], v[136:139]
ds_read_b64_tr_b16 a[118:119], v17 offset:51232
v_mfma_f32_16x16x32_bf16 v[140:143], a[24:27], a[172:175], v[140:143]
buffer_load_dwordx4 a[156:159], v11, s[16:19], s52 offen offset:1024 sc1
v_mfma_f32_16x16x32_bf16 v[124:127], a[20:23], a[172:175], v[124:127]
ds_read_b64_tr_b16 a[120:121], v17 offset:59136
s_add_u32 s52, s52, 0x20000
v_mfma_f32_16x16x32_bf16 v[120:123], a[20:23], a[168:171], v[120:123]
v_mfma_f32_16x16x32_bf16 v[104:107], a[16:19], a[168:171], v[104:107]
ds_read_b64_tr_b16 a[122:123], v17 offset:59648
v_mfma_f32_16x16x32_bf16 v[108:111], a[16:19], a[172:175], v[108:111]
ds_read_b64_tr_b16 a[124:125], v17 offset:59168
v_mfma_f32_16x16x32_bf16 v[92:95], a[12:15], a[172:175], v[92:95]
ds_read_b64_tr_b16 a[126:127], v17 offset:59680
s_max_i32 m0, s67, s59
v_mfma_f32_16x16x32_bf16 v[88:91], a[12:15], a[168:171], v[88:91]
buffer_load_dwordx4 v5, s[28:31], s58 offen lds
v_mfma_f32_16x16x32_bf16 v[72:75], a[8:11], a[168:171], v[72:75]
v_mfma_f32_16x16x32_bf16 v[76:79], a[8:11], a[172:175], v[76:79]
v_mfma_f32_16x16x32_bf16 v[60:63], a[4:7], a[172:175], v[60:63]
v_mfma_f32_16x16x32_bf16 v[56:59], a[4:7], a[168:171], v[56:59]
v_mfma_f32_16x16x32_bf16 v[40:43], a[0:3], a[168:171], v[40:43]
v_mfma_f32_16x16x32_bf16 v[44:47], a[0:3], a[172:175], v[44:47]
s_waitcnt vmcnt(20) lgkmcnt(0)
s_barrier
v_mfma_f32_16x16x32_bf16 v[32:35], a[64:67], a[176:179], v[32:35]
ds_read_b64_tr_b16 a[0:1], v16
s_add_u32 m0, s55, 135168
v_mfma_f32_16x16x32_bf16 v[36:39], a[64:67], a[180:183], v[36:39]
buffer_load_dwordx4 v12, s[32:35], s54 offen lds
v_mfma_f32_16x16x32_bf16 v[52:55], a[68:71], a[180:183], v[52:55]
ds_read_b64_tr_b16 a[2:3], v16 offset:512
v_mfma_f32_16x16x32_bf16 v[48:51], a[68:71], a[176:179], v[48:51]
ds_read_b64_tr_b16 a[4:5], v16 offset:32
v_mfma_f32_16x16x32_bf16 v[64:67], a[72:75], a[176:179], v[64:67]
ds_read_b64_tr_b16 a[6:7], v16 offset:544
v_mfma_f32_16x16x32_bf16 v[68:71], a[72:75], a[180:183], v[68:71]
v_mfma_f32_16x16x32_bf16 v[84:87], a[76:79], a[180:183], v[84:87]
ds_read_b64_tr_b16 a[8:9], v16 offset:8448
v_mfma_f32_16x16x32_bf16 v[80:83], a[76:79], a[176:179], v[80:83]
buffer_load_dwordx4 a[160:163], v10, s[16:19], s52 offen sc1
v_mfma_f32_16x16x32_bf16 v[96:99], a[80:83], a[176:179], v[96:99]
ds_read_b64_tr_b16 a[10:11], v16 offset:8960
v_mfma_f32_16x16x32_bf16 v[100:103], a[80:83], a[180:183], v[100:103]
ds_read_b64_tr_b16 a[12:13], v16 offset:8480
v_mfma_f32_16x16x32_bf16 v[116:119], a[84:87], a[180:183], v[116:119]
ds_read_b64_tr_b16 a[14:15], v16 offset:8992
v_mfma_f32_16x16x32_bf16 v[112:115], a[84:87], a[176:179], v[112:115]
v_mfma_f32_16x16x32_bf16 v[128:131], a[88:91], a[176:179], v[128:131]
ds_read_b64_tr_b16 a[16:17], v16 offset:64
v_mfma_f32_16x16x32_bf16 v[132:135], a[88:91], a[180:183], v[132:135]
buffer_load_dwordx4 v13, s[32:35], s54 offen offset:1056 lds
v_mfma_f32_16x16x32_bf16 v[148:151], a[92:95], a[180:183], v[148:151]
ds_read_b64_tr_b16 a[18:19], v16 offset:576
v_mfma_f32_16x16x32_bf16 v[144:147], a[92:95], a[176:179], v[144:147]
ds_read_b64_tr_b16 a[20:21], v16 offset:96
v_mfma_f32_16x16x32_bf16 v[160:163], a[96:99], a[176:179], v[160:163]
v_mfma_f32_16x16x32_bf16 v[164:167], a[96:99], a[180:183], v[164:167]
ds_read_b64_tr_b16 a[22:23], v16 offset:608
v_mfma_f32_16x16x32_bf16 v[180:183], a[100:103], a[180:183], v[180:183]
ds_read_b64_tr_b16 a[24:25], v16 offset:8512
v_mfma_f32_16x16x32_bf16 v[176:179], a[100:103], a[176:179], v[176:179]
buffer_load_dwordx4 a[164:167], v10, s[16:19], s52 offen offset:1024 sc1
v_mfma_f32_16x16x32_bf16 v[192:195], a[104:107], a[176:179], v[192:195]
ds_read_b64_tr_b16 a[26:27], v16 offset:9024
v_mfma_f32_16x16x32_bf16 v[196:199], a[104:107], a[180:183], v[196:199]
ds_read_b64_tr_b16 a[28:29], v16 offset:8544
v_mfma_f32_16x16x32_bf16 v[212:215], a[108:111], a[180:183], v[212:215]
v_mfma_f32_16x16x32_bf16 v[208:211], a[108:111], a[176:179], v[208:211]
ds_read_b64_tr_b16 a[30:31], v16 offset:9056
v_mfma_f32_16x16x32_bf16 v[224:227], a[112:115], a[176:179], v[224:227]
ds_read_b64_tr_b16 a[32:33], v16 offset:128
v_mfma_f32_16x16x32_bf16 v[228:231], a[112:115], a[180:183], v[228:231]
buffer_load_dwordx4 v14, s[32:35], s54 offen offset:2112 lds
v_mfma_f32_16x16x32_bf16 v[236:239], a[116:119], a[180:183], v[236:239]
ds_read_b64_tr_b16 a[34:35], v16 offset:640
v_mfma_f32_16x16x32_bf16 v[232:235], a[116:119], a[176:179], v[232:235]
v_mfma_f32_16x16x32_bf16 v[240:243], a[120:123], a[176:179], v[240:243]
ds_read_b64_tr_b16 a[36:37], v16 offset:160
v_mfma_f32_16x16x32_bf16 v[244:247], a[120:123], a[180:183], v[244:247]
ds_read_b64_tr_b16 a[38:39], v16 offset:672
v_mfma_f32_16x16x32_bf16 v[252:255], a[124:127], a[180:183], v[252:255]
ds_read_b64_tr_b16 a[40:41], v16 offset:8576
v_mfma_f32_16x16x32_bf16 v[248:251], a[124:127], a[176:179], v[248:251]
buffer_load_dwordx4 a[168:171], v11, s[16:19], s52 offen sc1
s_waitcnt vmcnt(25)
v_mfma_f32_16x16x32_bf16 v[220:223], a[108:111], a[188:191], v[220:223]
ds_read_b64_tr_b16 a[42:43], v16 offset:9088
v_mfma_f32_16x16x32_bf16 v[216:219], a[108:111], a[184:187], v[216:219]
v_mfma_f32_16x16x32_bf16 v[200:203], a[104:107], a[184:187], v[200:203]
ds_read_b64_tr_b16 a[44:45], v16 offset:8608
v_mfma_f32_16x16x32_bf16 v[204:207], a[104:107], a[188:191], v[204:207]
ds_read_b64_tr_b16 a[46:47], v16 offset:9120
v_mfma_f32_16x16x32_bf16 v[188:191], a[100:103], a[188:191], v[188:191]
ds_read_b64_tr_b16 a[48:49], v17
v_mfma_f32_16x16x32_bf16 v[184:187], a[100:103], a[184:187], v[184:187]
buffer_load_dwordx4 v15, s[32:35], s54 offen offset:3168 lds
v_mfma_f32_16x16x32_bf16 v[168:171], a[96:99], a[184:187], v[168:171]
s_add_u32 s54, s54, 229376
v_mfma_f32_16x16x32_bf16 v[172:175], a[96:99], a[188:191], v[172:175]
ds_read_b64_tr_b16 a[50:51], v17 offset:512
v_mfma_f32_16x16x32_bf16 v[156:159], a[92:95], a[188:191], v[156:159]
ds_read_b64_tr_b16 a[52:53], v17 offset:32
v_mfma_f32_16x16x32_bf16 v[152:155], a[92:95], a[184:187], v[152:155]
ds_read_b64_tr_b16 a[54:55], v17 offset:544
v_mfma_f32_16x16x32_bf16 v[136:139], a[88:91], a[184:187], v[136:139]
ds_read_b64_tr_b16 a[56:57], v17 offset:8448
v_mfma_f32_16x16x32_bf16 v[140:143], a[88:91], a[188:191], v[140:143]
buffer_load_dwordx4 a[172:175], v11, s[16:19], s52 offen offset:1024 sc1
v_mfma_f32_16x16x32_bf16 v[124:127], a[84:87], a[188:191], v[124:127]
s_add_u32 s52, s52, 0x20000
v_mfma_f32_16x16x32_bf16 v[120:123], a[84:87], a[184:187], v[120:123]
ds_read_b64_tr_b16 a[58:59], v17 offset:8960
v_mfma_f32_16x16x32_bf16 v[104:107], a[80:83], a[184:187], v[104:107]
ds_read_b64_tr_b16 a[60:61], v17 offset:8480
v_mfma_f32_16x16x32_bf16 v[108:111], a[80:83], a[188:191], v[108:111]
ds_read_b64_tr_b16 a[62:63], v17 offset:8992
v_mfma_f32_16x16x32_bf16 v[92:95], a[76:79], a[188:191], v[92:95]
s_max_i32 m0, s67, s59
v_mfma_f32_16x16x32_bf16 v[88:91], a[76:79], a[184:187], v[88:91]
buffer_load_dwordx4 v6, s[28:31], s58 offen offset:1056 lds
v_mfma_f32_16x16x32_bf16 v[72:75], a[72:75], a[184:187], v[72:75]
s_add_u32 s67, s67, 8448
s_add_u32 s58, s58, 0x10000
v_mfma_f32_16x16x32_bf16 v[76:79], a[72:75], a[188:191], v[76:79]
v_mfma_f32_16x16x32_bf16 v[60:63], a[68:71], a[188:191], v[60:63]
v_mfma_f32_16x16x32_bf16 v[56:59], a[68:71], a[184:187], v[56:59]
v_mfma_f32_16x16x32_bf16 v[40:43], a[64:67], a[184:187], v[40:43]
s_add_u32 s15, s15, 1
v_mfma_f32_16x16x32_bf16 v[44:47], a[64:67], a[188:191], v[44:47]
s_cbranch_scc0 .Lk74
s_waitcnt vmcnt(11) lgkmcnt(0)
s_barrier
v_mfma_f32_16x16x32_bf16 v[32:35], a[0:3], a[128:131], v[32:35]
ds_read_b128 v[12:15], v9
v_mov_b32 v18, v5
v_mfma_f32_16x16x32_bf16 v[48:51], a[4:7], a[128:131], v[48:51]
buffer_load_dwordx4 a[176:179], v10, s[16:19], s52 offen sc1
v_mfma_f32_16x16x32_bf16 v[64:67], a[8:11], a[128:131], v[64:67]
ds_read_b64_tr_b16 a[64:65], v16 offset:16896
v_mov_b32 v19, v6
v_mfma_f32_16x16x32_bf16 v[80:83], a[12:15], a[128:131], v[80:83]
ds_read_b128 v[4:7], v9 offset:64
s_mov_b32 s58, 655360
v_mfma_f32_16x16x32_bf16 v[36:39], a[0:3], a[132:135], v[36:39]
ds_read_b64_tr_b16 a[66:67], v16 offset:17408
v_mfma_f32_16x16x32_bf16 v[52:55], a[4:7], a[132:135], v[52:55]
buffer_load_dwordx4 a[180:183], v10, s[16:19], s52 offen offset:1024 sc1
v_mfma_f32_16x16x32_bf16 v[68:71], a[8:11], a[132:135], v[68:71]
ds_read_b64_tr_b16 a[68:69], v16 offset:16928
v_mfma_f32_16x16x32_bf16 v[84:87], a[12:15], a[132:135], v[84:87]
ds_read_b64_tr_b16 a[70:71], v16 offset:17440
v_mfma_f32_16x16x32_bf16 v[40:43], a[0:3], a[136:139], v[40:43]
ds_read_b64_tr_b16 a[72:73], v16 offset:25344
s_waitcnt lgkmcnt(6)
v_fmac_f32 v32, v12, v20
v_mfma_f32_16x16x32_bf16 v[56:59], a[4:7], a[136:139], v[56:59]
buffer_load_dwordx4 a[184:187], v11, s[16:19], s52 offen sc1
v_mfma_f32_16x16x32_bf16 v[72:75], a[8:11], a[136:139], v[72:75]
ds_read_b64_tr_b16 a[74:75], v16 offset:25856
v_fmac_f32 v33, v13, v20
v_mfma_f32_16x16x32_bf16 v[88:91], a[12:15], a[136:139], v[88:91]
ds_read_b64_tr_b16 a[76:77], v16 offset:25376
v_fmac_f32 v34, v14, v20
v_mfma_f32_16x16x32_bf16 v[44:47], a[0:3], a[140:143], v[44:47]
ds_read_b64_tr_b16 a[78:79], v16 offset:25888
v_fmac_f32 v35, v15, v20
v_mfma_f32_16x16x32_bf16 v[60:63], a[4:7], a[140:143], v[60:63]
buffer_load_dwordx4 a[188:191], v11, s[16:19], s52 offen offset:1024 sc1
v_mfma_f32_16x16x32_bf16 v[76:79], a[8:11], a[140:143], v[76:79]
s_add_u32 s52, s52, 0x20000
ds_read_b64_tr_b16 a[80:81], v16 offset:33792
v_mfma_f32_16x16x32_bf16 v[92:95], a[12:15], a[140:143], v[92:95]
ds_read_b64_tr_b16 a[82:83], v16 offset:34304
v_fmac_f32 v36, v12, v22
v_mfma_f32_16x16x32_bf16 v[96:99], a[16:19], a[128:131], v[96:99]
ds_read_b64_tr_b16 a[84:85], v16 offset:33824
v_fmac_f32 v37, v13, v22
v_mfma_f32_16x16x32_bf16 v[112:115], a[20:23], a[128:131], v[112:115]
ds_read_b64_tr_b16 a[86:87], v16 offset:34336
v_fmac_f32 v38, v14, v22
v_mfma_f32_16x16x32_bf16 v[128:131], a[24:27], a[128:131], v[128:131]
ds_read_b64_tr_b16 a[88:89], v16 offset:42240
v_fmac_f32 v39, v15, v22
v_mfma_f32_16x16x32_bf16 v[144:147], a[28:31], a[128:131], v[144:147]
ds_read_b64_tr_b16 a[90:91], v16 offset:42752
v_fmac_f32 v40, v12, v24
v_mfma_f32_16x16x32_bf16 v[100:103], a[16:19], a[132:135], v[100:103]
ds_read_b64_tr_b16 a[92:93], v16 offset:42272
v_fmac_f32 v41, v13, v24
v_mfma_f32_16x16x32_bf16 v[116:119], a[20:23], a[132:135], v[116:119]
ds_read_b64_tr_b16 a[94:95], v16 offset:42784
v_fmac_f32 v42, v14, v24
v_mfma_f32_16x16x32_bf16 v[132:135], a[24:27], a[132:135], v[132:135]
ds_read_b64_tr_b16 a[112:113], v16 offset:16960
v_fmac_f32 v43, v15, v24
v_mfma_f32_16x16x32_bf16 v[148:151], a[28:31], a[132:135], v[148:151]
ds_read_b64_tr_b16 a[114:115], v16 offset:17472
v_fmac_f32 v44, v12, v26
v_mfma_f32_16x16x32_bf16 v[104:107], a[16:19], a[136:139], v[104:107]
ds_read_b64_tr_b16 a[116:117], v16 offset:16992
v_fmac_f32 v45, v13, v26
v_mfma_f32_16x16x32_bf16 v[120:123], a[20:23], a[136:139], v[120:123]
ds_read_b64_tr_b16 a[118:119], v16 offset:17504
v_fmac_f32 v46, v14, v26
v_mfma_f32_16x16x32_bf16 v[136:139], a[24:27], a[136:139], v[136:139]
ds_read_b64_tr_b16 a[120:121], v16 offset:25408
v_fmac_f32 v47, v15, v26
v_mfma_f32_16x16x32_bf16 v[152:155], a[28:31], a[136:139], v[152:155]
ds_read_b128 v[12:15], v9 offset:512
s_waitcnt lgkmcnt(15)
v_fmac_f32 v48, v4, v20
v_mfma_f32_16x16x32_bf16 v[108:111], a[16:19], a[140:143], v[108:111]
ds_read_b64_tr_b16 a[122:123], v16 offset:25920
v_fmac_f32 v49, v5, v20
v_mfma_f32_16x16x32_bf16 v[124:127], a[20:23], a[140:143], v[124:127]
ds_read_b64_tr_b16 a[124:125], v16 offset:25440
v_fmac_f32 v50, v6, v20
v_mfma_f32_16x16x32_bf16 v[140:143], a[24:27], a[140:143], v[140:143]
ds_read_b64_tr_b16 a[126:127], v16 offset:25952
v_fmac_f32 v51, v7, v20
v_mfma_f32_16x16x32_bf16 v[156:159], a[28:31], a[140:143], v[156:159]
ds_read_b64_tr_b16 a[192:193], v16 offset:33856
v_fmac_f32 v52, v4, v22
v_mfma_f32_16x16x32_bf16 v[160:163], a[32:35], a[128:131], v[160:163]
ds_read_b64_tr_b16 a[194:195], v16 offset:34368
v_fmac_f32 v53, v5, v22
v_mfma_f32_16x16x32_bf16 v[176:179], a[36:39], a[128:131], v[176:179]
ds_read_b64_tr_b16 a[196:197], v16 offset:33888
v_fmac_f32 v54, v6, v22
v_mfma_f32_16x16x32_bf16 v[192:195], a[40:43], a[128:131], v[192:195]
ds_read_b64_tr_b16 a[198:199], v16 offset:34400
v_fmac_f32 v55, v7, v22
v_mfma_f32_16x16x32_bf16 v[208:211], a[44:47], a[128:131], v[208:211]
ds_read_b64_tr_b16 a[200:201], v16 offset:42304
v_fmac_f32 v56, v4, v24
v_mfma_f32_16x16x32_bf16 v[164:167], a[32:35], a[132:135], v[164:167]
ds_read_b64_tr_b16 a[202:203], v16 offset:42816
v_fmac_f32 v57, v5, v24
v_mfma_f32_16x16x32_bf16 v[180:183], a[36:39], a[132:135], v[180:183]
ds_read_b64_tr_b16 a[204:205], v16 offset:42336
s_waitcnt vmcnt(6)
s_barrier
v_mfma_f32_16x16x32_bf16 v[196:199], a[40:43], a[132:135], v[196:199]
ds_read_b64_tr_b16 a[96:97], v16 offset:50688
v_fmac_f32 v58, v6, v24
v_mfma_f32_16x16x32_bf16 v[212:215], a[44:47], a[132:135], v[212:215]
ds_read_b64_tr_b16 a[98:99], v16 offset:51200
v_fmac_f32 v59, v7, v24
v_mfma_f32_16x16x32_bf16 v[168:171], a[32:35], a[136:139], v[168:171]
ds_read_b64_tr_b16 a[100:101], v16 offset:50720
v_fmac_f32 v60, v4, v26
v_mfma_f32_16x16x32_bf16 v[184:187], a[36:39], a[136:139], v[184:187]
ds_read_b64_tr_b16 a[102:103], v16 offset:51232
v_fmac_f32 v61, v5, v26
v_mfma_f32_16x16x32_bf16 v[200:203], a[40:43], a[136:139], v[200:203]
ds_read_b64_tr_b16 a[104:105], v16 offset:59136
v_fmac_f32 v62, v6, v26
v_mfma_f32_16x16x32_bf16 v[216:219], a[44:47], a[136:139], v[216:219]
ds_read_b64_tr_b16 a[106:107], v16 offset:59648
v_fmac_f32 v63, v7, v26
v_mfma_f32_16x16x32_bf16 v[172:175], a[32:35], a[140:143], v[172:175]
ds_read_b128 v[4:7], v9 offset:576
s_waitcnt lgkmcnt(15)
v_fmac_f32 v64, v12, v20
v_mfma_f32_16x16x32_bf16 v[188:191], a[36:39], a[140:143], v[188:191]
ds_read_b64_tr_b16 a[108:109], v16 offset:59168
v_fmac_f32 v65, v13, v20
v_mfma_f32_16x16x32_bf16 v[204:207], a[40:43], a[140:143], v[204:207]
ds_read_b64_tr_b16 a[110:111], v16 offset:59680
v_fmac_f32 v66, v14, v20
v_mfma_f32_16x16x32_bf16 v[220:223], a[44:47], a[140:143], v[220:223]
ds_read_b64_tr_b16 a[206:207], v16 offset:42848
v_fmac_f32 v67, v15, v20
v_mfma_f32_16x16x32_bf16 v[224:227], a[48:51], a[128:131], v[224:227]
ds_read_b64_tr_b16 a[208:209], v16 offset:50752
v_fmac_f32 v68, v12, v22
v_mfma_f32_16x16x32_bf16 v[232:235], a[52:55], a[128:131], v[232:235]
ds_read_b64_tr_b16 a[210:211], v16 offset:51264
v_fmac_f32 v69, v13, v22
v_mfma_f32_16x16x32_bf16 v[240:243], a[56:59], a[128:131], v[240:243]
ds_read_b64_tr_b16 a[212:213], v16 offset:50784
v_fmac_f32 v70, v14, v22
v_mfma_f32_16x16x32_bf16 v[248:251], a[60:63], a[128:131], v[248:251]
ds_read_b64_tr_b16 a[214:215], v16 offset:51296
v_fmac_f32 v71, v15, v22
v_mfma_f32_16x16x32_bf16 v[228:231], a[48:51], a[132:135], v[228:231]
ds_read_b64_tr_b16 a[216:217], v16 offset:59200
v_fmac_f32 v72, v12, v24
v_mfma_f32_16x16x32_bf16 v[236:239], a[52:55], a[132:135], v[236:239]
ds_read_b64_tr_b16 a[218:219], v16 offset:59712
v_fmac_f32 v73, v13, v24
v_mfma_f32_16x16x32_bf16 v[244:247], a[56:59], a[132:135], v[244:247]
ds_read_b64_tr_b16 a[220:221], v16 offset:59232
v_fmac_f32 v74, v14, v24
v_mfma_f32_16x16x32_bf16 v[252:255], a[60:63], a[132:135], v[252:255]
ds_read_b64_tr_b16 a[222:223], v16 offset:59744
v_fmac_f32 v75, v15, v24
v_mfma_f32_16x16x32_bf16 v[32:35], a[64:67], a[144:147], v[32:35]
ds_read_b64_tr_b16 a[0:1], v16 offset:17024
v_fmac_f32 v76, v12, v26
v_mfma_f32_16x16x32_bf16 v[48:51], a[68:71], a[144:147], v[48:51]
ds_read_b64_tr_b16 a[2:3], v16 offset:17536
v_fmac_f32 v77, v13, v26
v_mfma_f32_16x16x32_bf16 v[64:67], a[72:75], a[144:147], v[64:67]
ds_read_b64_tr_b16 a[4:5], v16 offset:17056
v_fmac_f32 v78, v14, v26
v_fmac_f32 v79, v15, v26
ds_read_b128 v[12:15], v9 offset:832
s_waitcnt lgkmcnt(15)
v_fmac_f32 v80, v4, v20
v_fmac_f32 v81, v5, v20
v_fmac_f32 v82, v6, v20
v_fmac_f32 v83, v7, v20
v_fmac_f32 v84, v4, v22
v_fmac_f32 v85, v5, v22
v_mfma_f32_16x16x32_bf16 v[80:83], a[76:79], a[144:147], v[80:83]
ds_read_b64_tr_b16 a[6:7], v16 offset:17568
v_fmac_f32 v86, v6, v22
v_mfma_f32_16x16x32_bf16 v[32:35], a[80:83], a[160:163], v[32:35]
ds_read_b64_tr_b16 a[8:9], v16 offset:25472
v_fmac_f32 v87, v7, v22
v_mfma_f32_16x16x32_bf16 v[48:51], a[84:87], a[160:163], v[48:51]
ds_read_b64_tr_b16 a[10:11], v16 offset:25984
v_fmac_f32 v88, v4, v24
v_mfma_f32_16x16x32_bf16 v[64:67], a[88:91], a[160:163], v[64:67]
ds_read_b64_tr_b16 a[12:13], v16 offset:25504
v_fmac_f32 v89, v5, v24
v_mfma_f32_16x16x32_bf16 v[80:83], a[92:95], a[160:163], v[80:83]
ds_read_b64_tr_b16 a[14:15], v16 offset:26016
v_fmac_f32 v90, v6, v24
s_waitcnt vmcnt(3)
v_mfma_f32_16x16x32_bf16 v[32:35], a[96:99], a[176:179], v[32:35]
ds_read_b64_tr_b16 a[16:17], v16 offset:33920
v_fmac_f32 v91, v7, v24
v_mfma_f32_16x16x32_bf16 v[48:51], a[100:103], a[176:179], v[48:51]
ds_read_b64_tr_b16 a[18:19], v16 offset:34432
v_fmac_f32 v92, v4, v26
v_mfma_f32_16x16x32_bf16 v[64:67], a[104:107], a[176:179], v[64:67]
ds_read_b64_tr_b16 a[20:21], v16 offset:33952
v_fmac_f32 v93, v5, v26
s_waitcnt lgkmcnt(15)
v_mfma_f32_16x16x32_bf16 v[80:83], a[108:111], a[176:179], v[80:83]
ds_read_b64_tr_b16 a[22:23], v16 offset:34464
v_fmac_f32 v94, v6, v26
v_fmac_f32 v95, v7, v26
ds_read_b128 v[4:7], v9 offset:704
v_pk_mul_f32 v[64:65], v[64:65], v[32:33]
v_pk_mul_f32 v[32:33], v[32:33], v[28:29] op_sel_hi:[1,0]
v_pk_mul_f32 v[66:67], v[66:67], v[34:35]
v_pk_mul_f32 v[34:35], v[34:35], v[28:29] op_sel_hi:[1,0]
v_pk_mul_f32 v[80:81], v[80:81], v[48:49]
v_pk_mul_f32 v[48:49], v[48:49], v[28:29] op_sel_hi:[1,0]
v_pk_mul_f32 v[82:83], v[82:83], v[50:51]
v_pk_mul_f32 v[50:51], v[50:51], v[28:29] op_sel_hi:[1,0]
v_exp_f32 v32, v32
s_nop 0
v_mfma_f32_16x16x32_bf16 v[36:39], a[64:67], a[148:151], v[36:39]
ds_read_b64_tr_b16 a[24:25], v16 offset:42368
v_exp_f32 v33, v33
v_mfma_f32_16x16x32_bf16 v[52:55], a[68:71], a[148:151], v[52:55]
ds_read_b64_tr_b16 a[26:27], v16 offset:42880
v_exp_f32 v34, v34
v_mfma_f32_16x16x32_bf16 v[68:71], a[72:75], a[148:151], v[68:71]
ds_read_b64_tr_b16 a[28:29], v16 offset:42400
v_exp_f32 v35, v35
v_mfma_f32_16x16x32_bf16 v[84:87], a[76:79], a[148:151], v[84:87]
ds_read_b64_tr_b16 a[30:31], v16 offset:42912
v_exp_f32 v48, v48
v_mfma_f32_16x16x32_bf16 v[36:39], a[80:83], a[164:167], v[36:39]
ds_read_b64_tr_b16 a[32:33], v16 offset:50816
v_exp_f32 v49, v49
v_mfma_f32_16x16x32_bf16 v[52:55], a[84:87], a[164:167], v[52:55]
ds_read_b64_tr_b16 a[34:35], v16 offset:51328
v_exp_f32 v50, v50
v_mfma_f32_16x16x32_bf16 v[68:71], a[88:91], a[164:167], v[68:71]
ds_read_b64_tr_b16 a[36:37], v16 offset:50848
v_exp_f32 v51, v51
v_mfma_f32_16x16x32_bf16 v[84:87], a[92:95], a[164:167], v[84:87]
ds_read_b64_tr_b16 a[38:39], v16 offset:51360
s_waitcnt vmcnt(2)
v_mfma_f32_16x16x32_bf16 v[36:39], a[96:99], a[180:183], v[36:39]
ds_read_b64_tr_b16 a[40:41], v16 offset:59264
v_mfma_f32_16x16x32_bf16 v[52:55], a[100:103], a[180:183], v[52:55]
ds_read_b64_tr_b16 a[42:43], v16 offset:59776
v_mfma_f32_16x16x32_bf16 v[68:71], a[104:107], a[180:183], v[68:71]
ds_read_b64_tr_b16 a[44:45], v16 offset:59296
v_mfma_f32_16x16x32_bf16 v[84:87], a[108:111], a[180:183], v[84:87]
ds_read_b64_tr_b16 a[46:47], v16 offset:59808
s_nop 4
v_pk_mul_f32 v[68:69], v[68:69], v[36:37]
v_pk_mul_f32 v[36:37], v[36:37], v[28:29] op_sel:[0,1] op_sel_hi:[1,1]
v_pk_mul_f32 v[70:71], v[70:71], v[38:39]
v_pk_mul_f32 v[38:39], v[38:39], v[28:29] op_sel:[0,1] op_sel_hi:[1,1]
v_pk_mul_f32 v[84:85], v[84:85], v[52:53]
v_pk_mul_f32 v[52:53], v[52:53], v[28:29] op_sel:[0,1] op_sel_hi:[1,1]
v_pk_mul_f32 v[86:87], v[86:87], v[54:55]
v_pk_mul_f32 v[54:55], v[54:55], v[28:29] op_sel:[0,1] op_sel_hi:[1,1]
v_pk_fma_f32 v[32:33], v[32:33], v[20:21], v[20:21] op_sel:[0,1,1] op_sel_hi:[1,1,1]
v_pk_fma_f32 v[34:35], v[34:35], v[20:21], v[20:21] op_sel:[0,1,1] op_sel_hi:[1,1,1]
v_pk_fma_f32 v[48:49], v[48:49], v[20:21], v[20:21] op_sel:[0,1,1] op_sel_hi:[1,1,1]
v_pk_fma_f32 v[50:51], v[50:51], v[20:21], v[20:21] op_sel:[0,1,1] op_sel_hi:[1,1,1]
v_rcp_f32 v32, v32
s_nop 0
v_mfma_f32_16x16x32_bf16 v[40:43], a[64:67], a[152:155], v[40:43]
ds_read_b64_tr_b16 a[48:49], v17 offset:16896
v_rcp_f32 v33, v33
v_mfma_f32_16x16x32_bf16 v[56:59], a[68:71], a[152:155], v[56:59]
ds_read_b64_tr_b16 a[50:51], v17 offset:17408
v_rcp_f32 v34, v34
v_mfma_f32_16x16x32_bf16 v[72:75], a[72:75], a[152:155], v[72:75]
ds_read_b64_tr_b16 a[52:53], v17 offset:16928
v_rcp_f32 v35, v35
v_mfma_f32_16x16x32_bf16 v[88:91], a[76:79], a[152:155], v[88:91]
ds_read_b64_tr_b16 a[54:55], v17 offset:17440
v_rcp_f32 v48, v48
v_mfma_f32_16x16x32_bf16 v[40:43], a[80:83], a[168:171], v[40:43]
ds_read_b64_tr_b16 a[56:57], v17 offset:25344
v_rcp_f32 v49, v49
v_mfma_f32_16x16x32_bf16 v[56:59], a[84:87], a[168:171], v[56:59]
ds_read_b64_tr_b16 a[58:59], v17 offset:25856
v_rcp_f32 v50, v50
v_mfma_f32_16x16x32_bf16 v[72:75], a[88:91], a[168:171], v[72:75]
ds_read_b64_tr_b16 a[60:61], v17 offset:25376
v_rcp_f32 v51, v51
v_mfma_f32_16x16x32_bf16 v[88:91], a[92:95], a[168:171], v[88:91]
ds_read_b64_tr_b16 a[62:63], v17 offset:25888
v_exp_f32 v36, v36
s_waitcnt vmcnt(1)
v_mfma_f32_16x16x32_bf16 v[40:43], a[96:99], a[184:187], v[40:43]
v_exp_f32 v37, v37
v_mfma_f32_16x16x32_bf16 v[56:59], a[100:103], a[184:187], v[56:59]
v_exp_f32 v38, v38
v_mfma_f32_16x16x32_bf16 v[72:75], a[104:107], a[184:187], v[72:75]
v_exp_f32 v39, v39
v_mfma_f32_16x16x32_bf16 v[88:91], a[108:111], a[184:187], v[88:91]
v_exp_f32 v52, v52
v_exp_f32 v53, v53
v_exp_f32 v54, v54
v_exp_f32 v55, v55
v_pk_mul_f32 v[64:65], v[64:65], v[32:33]
v_pk_mul_f32 v[66:67], v[66:67], v[34:35]
v_pk_mul_f32 v[80:81], v[80:81], v[48:49]
v_pk_mul_f32 v[82:83], v[82:83], v[50:51]
ds_read_b128 v[48:51], v9 offset:128
v_pk_mul_f32 v[72:73], v[72:73], v[40:41]
v_pk_mul_f32 v[40:41], v[40:41], v[30:31] op_sel_hi:[1,0]
v_pk_mul_f32 v[74:75], v[74:75], v[42:43]
v_pk_mul_f32 v[42:43], v[42:43], v[30:31] op_sel_hi:[1,0]
v_pk_mul_f32 v[88:89], v[88:89], v[56:57]
v_pk_mul_f32 v[56:57], v[56:57], v[30:31] op_sel_hi:[1,0]
v_pk_mul_f32 v[90:91], v[90:91], v[58:59]
v_pk_mul_f32 v[58:59], v[58:59], v[30:31] op_sel_hi:[1,0]
v_pk_fma_f32 v[36:37], v[36:37], v[22:23], v[22:23] op_sel:[0,1,1] op_sel_hi:[1,1,1]
v_pk_fma_f32 v[38:39], v[38:39], v[22:23], v[22:23] op_sel:[0,1,1] op_sel_hi:[1,1,1]
v_pk_fma_f32 v[52:53], v[52:53], v[22:23], v[22:23] op_sel:[0,1,1] op_sel_hi:[1,1,1]
v_pk_fma_f32 v[54:55], v[54:55], v[22:23], v[22:23] op_sel:[0,1,1] op_sel_hi:[1,1,1]
v_cvt_pk_bf16_f32 v32, v64, v65
v_cvt_pk_bf16_f32 v33, v66, v67
ds_read_b128 v[64:67], v9 offset:192
v_cvt_pk_bf16_f32 v34, v80, v81
v_cvt_pk_bf16_f32 v35, v82, v83
v_mfma_f32_16x16x32_bf16 v[44:47], a[64:67], a[156:159], v[44:47]
buffer_store_dwordx4 v[32:35], v10, s[16:19], s62 offen sc1
v_mfma_f32_16x16x32_bf16 v[60:63], a[68:71], a[156:159], v[60:63]
ds_read_b128 v[80:83], v9 offset:640
v_rcp_f32 v36, v36
v_mfma_f32_16x16x32_bf16 v[76:79], a[72:75], a[156:159], v[76:79]
ds_read_b64_tr_b16 a[64:65], v17 offset:33792
v_rcp_f32 v37, v37
v_mfma_f32_16x16x32_bf16 v[92:95], a[76:79], a[156:159], v[92:95]
ds_read_b64_tr_b16 a[66:67], v17 offset:34304
v_rcp_f32 v38, v38
v_mfma_f32_16x16x32_bf16 v[44:47], a[80:83], a[172:175], v[44:47]
ds_read_b64_tr_b16 a[68:69], v17 offset:33824
v_rcp_f32 v39, v39
v_mfma_f32_16x16x32_bf16 v[60:63], a[84:87], a[172:175], v[60:63]
ds_read_b64_tr_b16 a[70:71], v17 offset:34336
v_rcp_f32 v52, v52
v_mfma_f32_16x16x32_bf16 v[76:79], a[88:91], a[172:175], v[76:79]
ds_read_b64_tr_b16 a[72:73], v17 offset:42240
v_rcp_f32 v53, v53
v_mfma_f32_16x16x32_bf16 v[92:95], a[92:95], a[172:175], v[92:95]
ds_read_b64_tr_b16 a[74:75], v17 offset:42752
v_rcp_f32 v54, v54
s_waitcnt vmcnt(1)
v_mfma_f32_16x16x32_bf16 v[44:47], a[96:99], a[188:191], v[44:47]
ds_read_b64_tr_b16 a[76:77], v17 offset:42272
v_rcp_f32 v55, v55
v_mfma_f32_16x16x32_bf16 v[60:63], a[100:103], a[188:191], v[60:63]
ds_read_b64_tr_b16 a[78:79], v17 offset:42784
v_exp_f32 v40, v40
v_mfma_f32_16x16x32_bf16 v[76:79], a[104:107], a[188:191], v[76:79]
ds_read_b64_tr_b16 a[80:81], v17 offset:50688
v_exp_f32 v41, v41
v_mfma_f32_16x16x32_bf16 v[92:95], a[108:111], a[188:191], v[92:95]
ds_read_b64_tr_b16 a[82:83], v17 offset:51200
v_exp_f32 v42, v42
v_exp_f32 v43, v43
v_exp_f32 v56, v56
v_exp_f32 v57, v57
v_exp_f32 v58, v58
v_exp_f32 v59, v59
v_pk_mul_f32 v[68:69], v[68:69], v[36:37]
v_pk_mul_f32 v[70:71], v[70:71], v[38:39]
v_pk_mul_f32 v[84:85], v[84:85], v[52:53]
v_pk_mul_f32 v[86:87], v[86:87], v[54:55]
v_pk_mul_f32 v[76:77], v[76:77], v[44:45]
v_pk_mul_f32 v[44:45], v[44:45], v[30:31] op_sel:[0,1] op_sel_hi:[1,1]
v_pk_mul_f32 v[78:79], v[78:79], v[46:47]
v_pk_mul_f32 v[46:47], v[46:47], v[30:31] op_sel:[0,1] op_sel_hi:[1,1]
v_pk_mul_f32 v[92:93], v[92:93], v[60:61]
v_pk_mul_f32 v[60:61], v[60:61], v[30:31] op_sel:[0,1] op_sel_hi:[1,1]
v_pk_mul_f32 v[94:95], v[94:95], v[62:63]
v_pk_mul_f32 v[62:63], v[62:63], v[30:31] op_sel:[0,1] op_sel_hi:[1,1]
v_pk_fma_f32 v[40:41], v[40:41], v[24:25], v[24:25] op_sel:[0,1,1] op_sel_hi:[1,1,1]
v_pk_fma_f32 v[42:43], v[42:43], v[24:25], v[24:25] op_sel:[0,1,1] op_sel_hi:[1,1,1]
v_pk_fma_f32 v[56:57], v[56:57], v[24:25], v[24:25] op_sel:[0,1,1] op_sel_hi:[1,1,1]
v_pk_fma_f32 v[58:59], v[58:59], v[24:25], v[24:25] op_sel:[0,1,1] op_sel_hi:[1,1,1]
v_cvt_pk_bf16_f32 v36, v68, v69
v_cvt_pk_bf16_f32 v37, v70, v71
v_cvt_pk_bf16_f32 v38, v84, v85
v_cvt_pk_bf16_f32 v39, v86, v87
v_mfma_f32_16x16x32_bf16 v[96:99], a[112:115], a[144:147], v[96:99]
buffer_store_dwordx4 v[36:39], v10, s[16:19], s62 offen offset:1024 sc1
v_mfma_f32_16x16x32_bf16 v[112:115], a[116:119], a[144:147], v[112:115]
ds_read_b64_tr_b16 a[84:85], v17 offset:50720
v_rcp_f32 v40, v40
v_mfma_f32_16x16x32_bf16 v[128:131], a[120:123], a[144:147], v[128:131]
ds_read_b64_tr_b16 a[86:87], v17 offset:51232
v_rcp_f32 v41, v41
v_mfma_f32_16x16x32_bf16 v[144:147], a[124:127], a[144:147], v[144:147]
ds_read_b64_tr_b16 a[88:89], v17 offset:59136
v_rcp_f32 v42, v42
v_mfma_f32_16x16x32_bf16 v[96:99], a[192:195], a[160:163], v[96:99]
ds_read_b64_tr_b16 a[90:91], v17 offset:59648
v_rcp_f32 v43, v43
v_mfma_f32_16x16x32_bf16 v[112:115], a[196:199], a[160:163], v[112:115]
ds_read_b64_tr_b16 a[92:93], v17 offset:59168
v_rcp_f32 v56, v56
v_mfma_f32_16x16x32_bf16 v[128:131], a[200:203], a[160:163], v[128:131]
ds_read_b64_tr_b16 a[94:95], v17 offset:59680
v_rcp_f32 v57, v57
v_mfma_f32_16x16x32_bf16 v[144:147], a[204:207], a[160:163], v[144:147]
v_rcp_f32 v58, v58
v_mfma_f32_16x16x32_bf16 v[96:99], a[208:211], a[176:179], v[96:99]
v_rcp_f32 v59, v59
v_mfma_f32_16x16x32_bf16 v[112:115], a[212:215], a[176:179], v[112:115]
v_exp_f32 v44, v44
s_waitcnt lgkmcnt(15)
v_mfma_f32_16x16x32_bf16 v[128:131], a[216:219], a[176:179], v[128:131]
v_exp_f32 v45, v45
v_mfma_f32_16x16x32_bf16 v[144:147], a[220:223], a[176:179], v[144:147]
v_exp_f32 v46, v46
v_exp_f32 v47, v47
v_exp_f32 v60, v60
v_exp_f32 v61, v61
v_exp_f32 v62, v62
s_waitcnt lgkmcnt(0)
s_barrier
v_exp_f32 v63, v63
v_pk_mul_f32 v[72:73], v[72:73], v[40:41]
v_pk_mul_f32 v[74:75], v[74:75], v[42:43]
v_pk_mul_f32 v[88:89], v[88:89], v[56:57]
.Lpad22:
s_cbranch_execz .Lnopoll72r
v_pk_mul_f32 v[90:91], v[90:91], v[58:59]
v_pk_fma_f32 v[96:97], v[48:49], v[20:21], v[96:97] op_sel_hi:[1,0,1]
v_pk_fma_f32 v[98:99], v[50:51], v[20:21], v[98:99] op_sel_hi:[1,0,1]
v_pk_fma_f32 v[112:113], v[64:65], v[20:21], v[112:113] op_sel_hi:[1,0,1]
v_pk_fma_f32 v[114:115], v[66:67], v[20:21], v[114:115] op_sel_hi:[1,0,1]
v_pk_fma_f32 v[128:129], v[80:81], v[20:21], v[128:129] op_sel_hi:[1,0,1]
v_pk_fma_f32 v[130:131], v[82:83], v[20:21], v[130:131] op_sel_hi:[1,0,1]
v_pk_fma_f32 v[144:145], v[4:5], v[20:21], v[144:145] op_sel_hi:[1,0,1]
v_pk_fma_f32 v[146:147], v[6:7], v[20:21], v[146:147] op_sel_hi:[1,0,1]
v_pk_mul_f32 v[128:129], v[128:129], v[96:97]
v_pk_mul_f32 v[96:97], v[96:97], v[28:29] op_sel_hi:[1,0]
v_pk_mul_f32 v[130:131], v[130:131], v[98:99]
v_pk_mul_f32 v[98:99], v[98:99], v[28:29] op_sel_hi:[1,0]
v_pk_mul_f32 v[144:145], v[144:145], v[112:113]
v_pk_mul_f32 v[112:113], v[112:113], v[28:29] op_sel_hi:[1,0]
v_pk_mul_f32 v[146:147], v[146:147], v[114:115]
v_pk_mul_f32 v[114:115], v[114:115], v[28:29] op_sel_hi:[1,0]
v_pk_fma_f32 v[44:45], v[44:45], v[26:27], v[26:27] op_sel:[0,1,1] op_sel_hi:[1,1,1]
v_pk_fma_f32 v[46:47], v[46:47], v[26:27], v[26:27] op_sel:[0,1,1] op_sel_hi:[1,1,1]
v_pk_fma_f32 v[60:61], v[60:61], v[26:27], v[26:27] op_sel:[0,1,1] op_sel_hi:[1,1,1]
v_pk_fma_f32 v[62:63], v[62:63], v[26:27], v[26:27] op_sel:[0,1,1] op_sel_hi:[1,1,1]
v_cvt_pk_bf16_f32 v40, v72, v73
v_cvt_pk_bf16_f32 v41, v74, v75
v_cvt_pk_bf16_f32 v42, v88, v89
v_cvt_pk_bf16_f32 v43, v90, v91
v_mfma_f32_16x16x32_bf16 v[100:103], a[112:115], a[148:151], v[100:103]
buffer_store_dwordx4 v[40:43], v11, s[16:19], s62 offen sc1
v_mfma_f32_16x16x32_bf16 v[116:119], a[116:119], a[148:151], v[116:119]
s_add_u32 m0, s59, 84480
v_rcp_f32 v44, v44
v_mfma_f32_16x16x32_bf16 v[132:135], a[120:123], a[148:151], v[132:135]
v_rcp_f32 v45, v45
v_mfma_f32_16x16x32_bf16 v[148:151], a[124:127], a[148:151], v[148:151]
v_rcp_f32 v46, v46
v_mfma_f32_16x16x32_bf16 v[100:103], a[192:195], a[164:167], v[100:103]
buffer_load_dwordx4 v18, s[28:31], s58 offen lds
v_mfma_f32_16x16x32_bf16 v[116:119], a[196:199], a[164:167], v[116:119]
v_rcp_f32 v47, v47
v_mfma_f32_16x16x32_bf16 v[132:135], a[200:203], a[164:167], v[132:135]
v_rcp_f32 v60, v60
v_mfma_f32_16x16x32_bf16 v[148:151], a[204:207], a[164:167], v[148:151]
v_rcp_f32 v61, v61
v_mfma_f32_16x16x32_bf16 v[100:103], a[208:211], a[180:183], v[100:103]
buffer_load_dwordx4 v19, s[28:31], s58 offen offset:1056 lds
v_mfma_f32_16x16x32_bf16 v[116:119], a[212:215], a[180:183], v[116:119]
s_add_u32 m0, s59, 92928
s_mov_b32 s58, 720896
v_rcp_f32 v62, v62
v_mfma_f32_16x16x32_bf16 v[132:135], a[216:219], a[180:183], v[132:135]
v_rcp_f32 v63, v63
v_mfma_f32_16x16x32_bf16 v[148:151], a[220:223], a[180:183], v[148:151]
v_exp_f32 v96, v96
v_exp_f32 v97, v97
v_exp_f32 v98, v98
v_exp_f32 v99, v99
v_exp_f32 v112, v112
v_exp_f32 v113, v113
v_exp_f32 v114, v114
v_exp_f32 v115, v115
v_pk_mul_f32 v[76:77], v[76:77], v[44:45]
v_pk_mul_f32 v[78:79], v[78:79], v[46:47]
v_pk_mul_f32 v[92:93], v[92:93], v[60:61]
v_pk_mul_f32 v[94:95], v[94:95], v[62:63]
v_pk_fma_f32 v[100:101], v[48:49], v[22:23], v[100:101] op_sel_hi:[1,0,1]
v_pk_fma_f32 v[102:103], v[50:51], v[22:23], v[102:103] op_sel_hi:[1,0,1]
v_pk_fma_f32 v[116:117], v[64:65], v[22:23], v[116:117] op_sel_hi:[1,0,1]
v_pk_fma_f32 v[118:119], v[66:67], v[22:23], v[118:119] op_sel_hi:[1,0,1]
v_pk_fma_f32 v[132:133], v[80:81], v[22:23], v[132:133] op_sel_hi:[1,0,1]
v_pk_fma_f32 v[134:135], v[82:83], v[22:23], v[134:135] op_sel_hi:[1,0,1]
v_pk_fma_f32 v[148:149], v[4:5], v[22:23], v[148:149] op_sel_hi:[1,0,1]
v_pk_fma_f32 v[150:151], v[6:7], v[22:23], v[150:151] op_sel_hi:[1,0,1]
v_pk_mul_f32 v[132:133], v[132:133], v[100:101]
v_pk_mul_f32 v[100:101], v[100:101], v[28:29] op_sel:[0,1] op_sel_hi:[1,1]
v_pk_mul_f32 v[134:135], v[134:135], v[102:103]
v_pk_mul_f32 v[102:103], v[102:103], v[28:29] op_sel:[0,1] op_sel_hi:[1,1]
v_pk_mul_f32 v[148:149], v[148:149], v[116:117]
v_pk_mul_f32 v[116:117], v[116:117], v[28:29] op_sel:[0,1] op_sel_hi:[1,1]
v_pk_mul_f32 v[150:151], v[150:151], v[118:119]
v_pk_mul_f32 v[118:119], v[118:119], v[28:29] op_sel:[0,1] op_sel_hi:[1,1]
v_pk_fma_f32 v[96:97], v[96:97], v[20:21], v[20:21] op_sel:[0,1,1] op_sel_hi:[1,1,1]
v_pk_fma_f32 v[98:99], v[98:99], v[20:21], v[20:21] op_sel:[0,1,1] op_sel_hi:[1,1,1]
v_pk_fma_f32 v[112:113], v[112:113], v[20:21], v[20:21] op_sel:[0,1,1] op_sel_hi:[1,1,1]
v_pk_fma_f32 v[114:115], v[114:115], v[20:21], v[20:21] op_sel:[0,1,1] op_sel_hi:[1,1,1]
v_cvt_pk_bf16_f32 v44, v76, v77
v_cvt_pk_bf16_f32 v45, v78, v79
v_cvt_pk_bf16_f32 v46, v92, v93
v_cvt_pk_bf16_f32 v47, v94, v95
v_mfma_f32_16x16x32_bf16 v[104:107], a[112:115], a[152:155], v[104:107]
buffer_store_dwordx4 v[44:47], v11, s[16:19], s62 offen offset:1024 sc1
v_mfma_f32_16x16x32_bf16 v[120:123], a[116:119], a[152:155], v[120:123]
v_rcp_f32 v96, v96
v_mfma_f32_16x16x32_bf16 v[136:139], a[120:123], a[152:155], v[136:139]
v_rcp_f32 v97, v97
v_mfma_f32_16x16x32_bf16 v[152:155], a[124:127], a[152:155], v[152:155]
v_rcp_f32 v98, v98
v_mfma_f32_16x16x32_bf16 v[104:107], a[192:195], a[168:171], v[104:107]
buffer_load_dwordx4 v18, s[28:31], s58 offen lds
v_mfma_f32_16x16x32_bf16 v[120:123], a[196:199], a[168:171], v[120:123]
v_rcp_f32 v99, v99
v_mfma_f32_16x16x32_bf16 v[136:139], a[200:203], a[168:171], v[136:139]
v_rcp_f32 v112, v112
v_mfma_f32_16x16x32_bf16 v[152:155], a[204:207], a[168:171], v[152:155]
v_rcp_f32 v113, v113
v_mfma_f32_16x16x32_bf16 v[104:107], a[208:211], a[184:187], v[104:107]
buffer_load_dwordx4 v19, s[28:31], s58 offen offset:1056 lds
v_mfma_f32_16x16x32_bf16 v[120:123], a[212:215], a[184:187], v[120:123]
s_add_u32 m0, s59, 101376
s_mov_b32 s58, 786432
v_rcp_f32 v114, v114
v_mfma_f32_16x16x32_bf16 v[136:139], a[216:219], a[184:187], v[136:139]
v_rcp_f32 v115, v115
v_mfma_f32_16x16x32_bf16 v[152:155], a[220:223], a[184:187], v[152:155]
v_exp_f32 v100, v100
v_exp_f32 v101, v101
v_exp_f32 v102, v102
v_exp_f32 v103, v103
v_exp_f32 v116, v116
v_exp_f32 v117, v117
v_exp_f32 v118, v118
v_exp_f32 v119, v119
v_pk_mul_f32 v[128:129], v[128:129], v[96:97]
v_pk_mul_f32 v[130:131], v[130:131], v[98:99]
v_pk_mul_f32 v[144:145], v[144:145], v[112:113]
v_pk_mul_f32 v[146:147], v[146:147], v[114:115]
ds_read_b128 v[112:115], v9 offset:256
v_pk_fma_f32 v[104:105], v[48:49], v[24:25], v[104:105] op_sel_hi:[1,0,1]
v_pk_fma_f32 v[106:107], v[50:51], v[24:25], v[106:107] op_sel_hi:[1,0,1]
v_pk_fma_f32 v[120:121], v[64:65], v[24:25], v[120:121] op_sel_hi:[1,0,1]
v_pk_fma_f32 v[122:123], v[66:67], v[24:25], v[122:123] op_sel_hi:[1,0,1]
v_pk_fma_f32 v[136:137], v[80:81], v[24:25], v[136:137] op_sel_hi:[1,0,1]
v_pk_fma_f32 v[138:139], v[82:83], v[24:25], v[138:139] op_sel_hi:[1,0,1]
v_pk_fma_f32 v[152:153], v[4:5], v[24:25], v[152:153] op_sel_hi:[1,0,1]
v_pk_fma_f32 v[154:155], v[6:7], v[24:25], v[154:155] op_sel_hi:[1,0,1]
v_pk_mul_f32 v[136:137], v[136:137], v[104:105]
v_pk_mul_f32 v[104:105], v[104:105], v[30:31] op_sel_hi:[1,0]
v_pk_mul_f32 v[138:139], v[138:139], v[106:107]
v_pk_mul_f32 v[106:107], v[106:107], v[30:31] op_sel_hi:[1,0]
v_pk_mul_f32 v[152:153], v[152:153], v[120:121]
v_pk_mul_f32 v[120:121], v[120:121], v[30:31] op_sel_hi:[1,0]
v_pk_mul_f32 v[154:155], v[154:155], v[122:123]
v_pk_mul_f32 v[122:123], v[122:123], v[30:31] op_sel_hi:[1,0]
v_pk_fma_f32 v[100:101], v[100:101], v[22:23], v[22:23] op_sel:[0,1,1] op_sel_hi:[1,1,1]
v_pk_fma_f32 v[102:103], v[102:103], v[22:23], v[22:23] op_sel:[0,1,1] op_sel_hi:[1,1,1]
v_pk_fma_f32 v[116:117], v[116:117], v[22:23], v[22:23] op_sel:[0,1,1] op_sel_hi:[1,1,1]
v_pk_fma_f32 v[118:119], v[118:119], v[22:23], v[22:23] op_sel:[0,1,1] op_sel_hi:[1,1,1]
v_cvt_pk_bf16_f32 v96, v128, v129
v_cvt_pk_bf16_f32 v97, v130, v131
ds_read_b128 v[128:131], v9 offset:320
v_cvt_pk_bf16_f32 v98, v144, v145
v_cvt_pk_bf16_f32 v99, v146, v147
v_mfma_f32_16x16x32_bf16 v[108:111], a[112:115], a[156:159], v[108:111]
buffer_store_dwordx4 v[96:99], v10, s[16:19], s63 offen sc1
v_mfma_f32_16x16x32_bf16 v[124:127], a[116:119], a[156:159], v[124:127]
ds_read_b128 v[144:147], v9 offset:768
v_rcp_f32 v100, v100
v_mfma_f32_16x16x32_bf16 v[140:143], a[120:123], a[156:159], v[140:143]
v_rcp_f32 v101, v101
v_mfma_f32_16x16x32_bf16 v[156:159], a[124:127], a[156:159], v[156:159]
v_rcp_f32 v102, v102
v_mfma_f32_16x16x32_bf16 v[108:111], a[192:195], a[172:175], v[108:111]
buffer_load_dwordx4 v18, s[28:31], s58 offen lds
v_mfma_f32_16x16x32_bf16 v[124:127], a[196:199], a[172:175], v[124:127]
v_rcp_f32 v103, v103
v_mfma_f32_16x16x32_bf16 v[140:143], a[200:203], a[172:175], v[140:143]
v_rcp_f32 v116, v116
v_mfma_f32_16x16x32_bf16 v[156:159], a[204:207], a[172:175], v[156:159]
v_rcp_f32 v117, v117
v_mfma_f32_16x16x32_bf16 v[108:111], a[208:211], a[188:191], v[108:111]
buffer_load_dwordx4 v19, s[28:31], s58 offen offset:1056 lds
v_mfma_f32_16x16x32_bf16 v[124:127], a[212:215], a[188:191], v[124:127]
s_add_u32 m0, s59, 109824
s_mov_b32 s58, 851968
v_rcp_f32 v118, v118
v_mfma_f32_16x16x32_bf16 v[140:143], a[216:219], a[188:191], v[140:143]
v_rcp_f32 v119, v119
v_mfma_f32_16x16x32_bf16 v[156:159], a[220:223], a[188:191], v[156:159]
v_exp_f32 v104, v104
v_exp_f32 v105, v105
v_exp_f32 v106, v106
v_exp_f32 v107, v107
v_exp_f32 v120, v120
v_exp_f32 v121, v121
v_exp_f32 v122, v122
v_exp_f32 v123, v123
v_pk_mul_f32 v[132:133], v[132:133], v[100:101]
v_pk_mul_f32 v[134:135], v[134:135], v[102:103]
v_pk_mul_f32 v[148:149], v[148:149], v[116:117]
v_pk_mul_f32 v[150:151], v[150:151], v[118:119]
v_pk_fma_f32 v[108:109], v[48:49], v[26:27], v[108:109] op_sel_hi:[1,0,1]
v_pk_fma_f32 v[110:111], v[50:51], v[26:27], v[110:111] op_sel_hi:[1,0,1]
v_pk_fma_f32 v[124:125], v[64:65], v[26:27], v[124:125] op_sel_hi:[1,0,1]
v_pk_fma_f32 v[126:127], v[66:67], v[26:27], v[126:127] op_sel_hi:[1,0,1]
v_pk_fma_f32 v[140:141], v[80:81], v[26:27], v[140:141] op_sel_hi:[1,0,1]
v_pk_fma_f32 v[142:143], v[82:83], v[26:27], v[142:143] op_sel_hi:[1,0,1]
v_pk_fma_f32 v[156:157], v[4:5], v[26:27], v[156:157] op_sel_hi:[1,0,1]
v_pk_fma_f32 v[158:159], v[6:7], v[26:27], v[158:159] op_sel_hi:[1,0,1]
ds_read_b128 v[4:7], v8 offset:576
v_pk_mul_f32 v[140:141], v[140:141], v[108:109]
v_pk_mul_f32 v[108:109], v[108:109], v[30:31] op_sel:[0,1] op_sel_hi:[1,1]
v_pk_mul_f32 v[142:143], v[142:143], v[110:111]
v_pk_mul_f32 v[110:111], v[110:111], v[30:31] op_sel:[0,1] op_sel_hi:[1,1]
v_pk_mul_f32 v[156:157], v[156:157], v[124:125]
v_pk_mul_f32 v[124:125], v[124:125], v[30:31] op_sel:[0,1] op_sel_hi:[1,1]
v_pk_mul_f32 v[158:159], v[158:159], v[126:127]
v_pk_mul_f32 v[126:127], v[126:127], v[30:31] op_sel:[0,1] op_sel_hi:[1,1]
v_pk_fma_f32 v[104:105], v[104:105], v[24:25], v[24:25] op_sel:[0,1,1] op_sel_hi:[1,1,1]
v_pk_fma_f32 v[106:107], v[106:107], v[24:25], v[24:25] op_sel:[0,1,1] op_sel_hi:[1,1,1]
v_pk_fma_f32 v[120:121], v[120:121], v[24:25], v[24:25] op_sel:[0,1,1] op_sel_hi:[1,1,1]
v_pk_fma_f32 v[122:123], v[122:123], v[24:25], v[24:25] op_sel:[0,1,1] op_sel_hi:[1,1,1]
v_cvt_pk_bf16_f32 v100, v132, v133
v_cvt_pk_bf16_f32 v101, v134, v135
v_cvt_pk_bf16_f32 v102, v148, v149
v_cvt_pk_bf16_f32 v103, v150, v151
v_mfma_f32_16x16x32_bf16 v[160:163], a[0:3], a[144:147], v[160:163]
buffer_store_dwordx4 v[100:103], v10, s[16:19], s63 offen offset:1024 sc1
v_mfma_f32_16x16x32_bf16 v[176:179], a[4:7], a[144:147], v[176:179]
v_rcp_f32 v104, v104
v_mfma_f32_16x16x32_bf16 v[192:195], a[8:11], a[144:147], v[192:195]
v_rcp_f32 v105, v105
v_mfma_f32_16x16x32_bf16 v[208:211], a[12:15], a[144:147], v[208:211]
v_rcp_f32 v106, v106
v_mfma_f32_16x16x32_bf16 v[160:163], a[16:19], a[160:163], v[160:163]
buffer_load_dwordx4 v18, s[28:31], s58 offen lds
v_mfma_f32_16x16x32_bf16 v[176:179], a[20:23], a[160:163], v[176:179]
v_rcp_f32 v107, v107
v_mfma_f32_16x16x32_bf16 v[192:195], a[24:27], a[160:163], v[192:195]
v_rcp_f32 v120, v120
v_mfma_f32_16x16x32_bf16 v[208:211], a[28:31], a[160:163], v[208:211]
v_rcp_f32 v121, v121
v_mfma_f32_16x16x32_bf16 v[160:163], a[32:35], a[176:179], v[160:163]
buffer_load_dwordx4 v19, s[28:31], s58 offen offset:1056 lds
v_mfma_f32_16x16x32_bf16 v[176:179], a[36:39], a[176:179], v[176:179]
v_rcp_f32 v122, v122
v_mfma_f32_16x16x32_bf16 v[192:195], a[40:43], a[176:179], v[192:195]
v_rcp_f32 v123, v123
v_mfma_f32_16x16x32_bf16 v[208:211], a[44:47], a[176:179], v[208:211]
v_exp_f32 v108, v108
v_exp_f32 v109, v109
v_exp_f32 v110, v110
v_exp_f32 v111, v111
v_exp_f32 v124, v124
v_exp_f32 v125, v125
v_exp_f32 v126, v126
v_exp_f32 v127, v127
v_pk_mul_f32 v[136:137], v[136:137], v[104:105]
v_pk_mul_f32 v[138:139], v[138:139], v[106:107]
v_pk_mul_f32 v[152:153], v[152:153], v[120:121]
v_pk_mul_f32 v[154:155], v[154:155], v[122:123]
s_waitcnt lgkmcnt(3)
v_pk_fma_f32 v[160:161], v[112:113], v[20:21], v[160:161] op_sel_hi:[1,0,1]
v_pk_fma_f32 v[162:163], v[114:115], v[20:21], v[162:163] op_sel_hi:[1,0,1]
s_waitcnt lgkmcnt(2)
v_pk_fma_f32 v[176:177], v[128:129], v[20:21], v[176:177] op_sel_hi:[1,0,1]
v_pk_fma_f32 v[178:179], v[130:131], v[20:21], v[178:179] op_sel_hi:[1,0,1]
s_waitcnt lgkmcnt(1)
v_pk_fma_f32 v[192:193], v[144:145], v[20:21], v[192:193] op_sel_hi:[1,0,1]
v_pk_fma_f32 v[194:195], v[146:147], v[20:21], v[194:195] op_sel_hi:[1,0,1]
v_pk_fma_f32 v[208:209], v[12:13], v[20:21], v[208:209] op_sel_hi:[1,0,1]
v_pk_fma_f32 v[210:211], v[14:15], v[20:21], v[210:211] op_sel_hi:[1,0,1]
v_pk_mul_f32 v[192:193], v[192:193], v[160:161]
v_pk_mul_f32 v[160:161], v[160:161], v[28:29] op_sel_hi:[1,0]
v_pk_mul_f32 v[194:195], v[194:195], v[162:163]
v_pk_mul_f32 v[162:163], v[162:163], v[28:29] op_sel_hi:[1,0]
v_pk_mul_f32 v[208:209], v[208:209], v[176:177]
v_pk_mul_f32 v[176:177], v[176:177], v[28:29] op_sel_hi:[1,0]
v_pk_mul_f32 v[210:211], v[210:211], v[178:179]
v_pk_mul_f32 v[178:179], v[178:179], v[28:29] op_sel_hi:[1,0]
v_pk_fma_f32 v[108:109], v[108:109], v[26:27], v[26:27] op_sel:[0,1,1] op_sel_hi:[1,1,1]
v_pk_fma_f32 v[110:111], v[110:111], v[26:27], v[26:27] op_sel:[0,1,1] op_sel_hi:[1,1,1]
v_pk_fma_f32 v[124:125], v[124:125], v[26:27], v[26:27] op_sel:[0,1,1] op_sel_hi:[1,1,1]
v_pk_fma_f32 v[126:127], v[126:127], v[26:27], v[26:27] op_sel:[0,1,1] op_sel_hi:[1,1,1]
v_cvt_pk_bf16_f32 v104, v136, v137
v_cvt_pk_bf16_f32 v105, v138, v139
v_cvt_pk_bf16_f32 v106, v152, v153
v_cvt_pk_bf16_f32 v107, v154, v155
v_mfma_f32_16x16x32_bf16 v[164:167], a[0:3], a[148:151], v[164:167]
buffer_store_dwordx4 v[104:107], v11, s[16:19], s63 offen sc1
v_mfma_f32_16x16x32_bf16 v[180:183], a[4:7], a[148:151], v[180:183]
v_rcp_f32 v108, v108
v_mfma_f32_16x16x32_bf16 v[196:199], a[8:11], a[148:151], v[196:199]
v_rcp_f32 v109, v109
v_mfma_f32_16x16x32_bf16 v[212:215], a[12:15], a[148:151], v[212:215]
v_rcp_f32 v110, v110
v_mfma_f32_16x16x32_bf16 v[164:167], a[16:19], a[164:167], v[164:167]
v_rcp_f32 v111, v111
v_mfma_f32_16x16x32_bf16 v[180:183], a[20:23], a[164:167], v[180:183]
v_rcp_f32 v124, v124
v_mfma_f32_16x16x32_bf16 v[196:199], a[24:27], a[164:167], v[196:199]
v_rcp_f32 v125, v125
v_mfma_f32_16x16x32_bf16 v[212:215], a[28:31], a[164:167], v[212:215]
v_rcp_f32 v126, v126
v_mfma_f32_16x16x32_bf16 v[164:167], a[32:35], a[180:183], v[164:167]
v_rcp_f32 v127, v127
v_mfma_f32_16x16x32_bf16 v[180:183], a[36:39], a[180:183], v[180:183]
v_exp_f32 v160, v160
v_mfma_f32_16x16x32_bf16 v[196:199], a[40:43], a[180:183], v[196:199]
v_exp_f32 v161, v161
v_mfma_f32_16x16x32_bf16 v[212:215], a[44:47], a[180:183], v[212:215]
v_exp_f32 v162, v162
v_exp_f32 v163, v163
v_exp_f32 v176, v176
v_exp_f32 v177, v177
v_exp_f32 v178, v178
v_exp_f32 v179, v179
v_pk_mul_f32 v[140:141], v[140:141], v[108:109]
v_pk_mul_f32 v[142:143], v[142:143], v[110:111]
v_pk_mul_f32 v[156:157], v[156:157], v[124:125]
v_pk_mul_f32 v[158:159], v[158:159], v[126:127]
v_pk_fma_f32 v[164:165], v[112:113], v[22:23], v[164:165] op_sel_hi:[1,0,1]
v_pk_fma_f32 v[166:167], v[114:115], v[22:23], v[166:167] op_sel_hi:[1,0,1]
v_pk_fma_f32 v[180:181], v[128:129], v[22:23], v[180:181] op_sel_hi:[1,0,1]
v_pk_fma_f32 v[182:183], v[130:131], v[22:23], v[182:183] op_sel_hi:[1,0,1]
v_pk_fma_f32 v[196:197], v[144:145], v[22:23], v[196:197] op_sel_hi:[1,0,1]
v_pk_fma_f32 v[198:199], v[146:147], v[22:23], v[198:199] op_sel_hi:[1,0,1]
v_pk_fma_f32 v[212:213], v[12:13], v[22:23], v[212:213] op_sel_hi:[1,0,1]
v_pk_fma_f32 v[214:215], v[14:15], v[22:23], v[214:215] op_sel_hi:[1,0,1]
v_pk_mul_f32 v[196:197], v[196:197], v[164:165]
v_pk_mul_f32 v[164:165], v[164:165], v[28:29] op_sel:[0,1] op_sel_hi:[1,1]
v_pk_mul_f32 v[198:199], v[198:199], v[166:167]
v_pk_mul_f32 v[166:167], v[166:167], v[28:29] op_sel:[0,1] op_sel_hi:[1,1]
v_pk_mul_f32 v[212:213], v[212:213], v[180:181]
v_pk_mul_f32 v[180:181], v[180:181], v[28:29] op_sel:[0,1] op_sel_hi:[1,1]
v_pk_mul_f32 v[214:215], v[214:215], v[182:183]
v_pk_mul_f32 v[182:183], v[182:183], v[28:29] op_sel:[0,1] op_sel_hi:[1,1]
v_pk_fma_f32 v[160:161], v[160:161], v[20:21], v[20:21] op_sel:[0,1,1] op_sel_hi:[1,1,1]
v_pk_fma_f32 v[162:163], v[162:163], v[20:21], v[20:21] op_sel:[0,1,1] op_sel_hi:[1,1,1]
v_pk_fma_f32 v[176:177], v[176:177], v[20:21], v[20:21] op_sel:[0,1,1] op_sel_hi:[1,1,1]
v_pk_fma_f32 v[178:179], v[178:179], v[20:21], v[20:21] op_sel:[0,1,1] op_sel_hi:[1,1,1]
v_cvt_pk_bf16_f32 v108, v140, v141
v_cvt_pk_bf16_f32 v109, v142, v143
v_cvt_pk_bf16_f32 v110, v156, v157
v_cvt_pk_bf16_f32 v111, v158, v159
v_mfma_f32_16x16x32_bf16 v[168:171], a[0:3], a[152:155], v[168:171]
buffer_store_dwordx4 v[108:111], v11, s[16:19], s63 offen offset:1024 sc1
v_mfma_f32_16x16x32_bf16 v[184:187], a[4:7], a[152:155], v[184:187]
v_rcp_f32 v160, v160
v_mfma_f32_16x16x32_bf16 v[200:203], a[8:11], a[152:155], v[200:203]
v_rcp_f32 v161, v161
v_mfma_f32_16x16x32_bf16 v[216:219], a[12:15], a[152:155], v[216:219]
v_rcp_f32 v162, v162
v_mfma_f32_16x16x32_bf16 v[168:171], a[16:19], a[168:171], v[168:171]
v_rcp_f32 v163, v163
v_mfma_f32_16x16x32_bf16 v[184:187], a[20:23], a[168:171], v[184:187]
v_rcp_f32 v176, v176
v_mfma_f32_16x16x32_bf16 v[200:203], a[24:27], a[168:171], v[200:203]
v_rcp_f32 v177, v177
v_mfma_f32_16x16x32_bf16 v[216:219], a[28:31], a[168:171], v[216:219]
v_rcp_f32 v178, v178
v_mfma_f32_16x16x32_bf16 v[168:171], a[32:35], a[184:187], v[168:171]
v_rcp_f32 v179, v179
v_mfma_f32_16x16x32_bf16 v[184:187], a[36:39], a[184:187], v[184:187]
v_exp_f32 v164, v164
v_mfma_f32_16x16x32_bf16 v[200:203], a[40:43], a[184:187], v[200:203]
v_exp_f32 v165, v165
v_mfma_f32_16x16x32_bf16 v[216:219], a[44:47], a[184:187], v[216:219]
v_exp_f32 v166, v166
v_exp_f32 v167, v167
v_exp_f32 v180, v180
v_exp_f32 v181, v181
v_exp_f32 v182, v182
v_exp_f32 v183, v183
v_pk_mul_f32 v[192:193], v[192:193], v[160:161]
v_pk_mul_f32 v[194:195], v[194:195], v[162:163]
v_pk_mul_f32 v[208:209], v[208:209], v[176:177]
v_pk_mul_f32 v[210:211], v[210:211], v[178:179]
ds_read_b128 v[176:179], v8
v_pk_fma_f32 v[168:169], v[112:113], v[24:25], v[168:169] op_sel_hi:[1,0,1]
v_pk_fma_f32 v[170:171], v[114:115], v[24:25], v[170:171] op_sel_hi:[1,0,1]
v_pk_fma_f32 v[184:185], v[128:129], v[24:25], v[184:185] op_sel_hi:[1,0,1]
v_pk_fma_f32 v[186:187], v[130:131], v[24:25], v[186:187] op_sel_hi:[1,0,1]
v_pk_fma_f32 v[200:201], v[144:145], v[24:25], v[200:201] op_sel_hi:[1,0,1]
v_pk_fma_f32 v[202:203], v[146:147], v[24:25], v[202:203] op_sel_hi:[1,0,1]
v_pk_fma_f32 v[216:217], v[12:13], v[24:25], v[216:217] op_sel_hi:[1,0,1]
v_pk_fma_f32 v[218:219], v[14:15], v[24:25], v[218:219] op_sel_hi:[1,0,1]
v_pk_mul_f32 v[200:201], v[200:201], v[168:169]
v_pk_mul_f32 v[168:169], v[168:169], v[30:31] op_sel_hi:[1,0]
v_pk_mul_f32 v[202:203], v[202:203], v[170:171]
v_pk_mul_f32 v[170:171], v[170:171], v[30:31] op_sel_hi:[1,0]
v_pk_mul_f32 v[216:217], v[216:217], v[184:185]
v_pk_mul_f32 v[184:185], v[184:185], v[30:31] op_sel_hi:[1,0]
v_pk_mul_f32 v[218:219], v[218:219], v[186:187]
v_pk_mul_f32 v[186:187], v[186:187], v[30:31] op_sel_hi:[1,0]
v_pk_fma_f32 v[164:165], v[164:165], v[22:23], v[22:23] op_sel:[0,1,1] op_sel_hi:[1,1,1]
v_pk_fma_f32 v[166:167], v[166:167], v[22:23], v[22:23] op_sel:[0,1,1] op_sel_hi:[1,1,1]
v_pk_fma_f32 v[180:181], v[180:181], v[22:23], v[22:23] op_sel:[0,1,1] op_sel_hi:[1,1,1]
v_pk_fma_f32 v[182:183], v[182:183], v[22:23], v[22:23] op_sel:[0,1,1] op_sel_hi:[1,1,1]
v_cvt_pk_bf16_f32 v160, v192, v193
v_cvt_pk_bf16_f32 v161, v194, v195
ds_read_b128 v[192:195], v8 offset:64
v_cvt_pk_bf16_f32 v162, v208, v209
v_cvt_pk_bf16_f32 v163, v210, v211
v_mfma_f32_16x16x32_bf16 v[172:175], a[0:3], a[156:159], v[172:175]
buffer_store_dwordx4 v[160:163], v10, s[16:19], s64 offen sc1
v_mfma_f32_16x16x32_bf16 v[188:191], a[4:7], a[156:159], v[188:191]
ds_read_b128 v[208:211], v8 offset:512
v_rcp_f32 v164, v164
v_mfma_f32_16x16x32_bf16 v[204:207], a[8:11], a[156:159], v[204:207]
v_rcp_f32 v165, v165
v_mfma_f32_16x16x32_bf16 v[220:223], a[12:15], a[156:159], v[220:223]
v_rcp_f32 v166, v166
v_mfma_f32_16x16x32_bf16 v[172:175], a[16:19], a[172:175], v[172:175]
v_rcp_f32 v167, v167
v_mfma_f32_16x16x32_bf16 v[188:191], a[20:23], a[172:175], v[188:191]
v_rcp_f32 v180, v180
v_mfma_f32_16x16x32_bf16 v[204:207], a[24:27], a[172:175], v[204:207]
v_rcp_f32 v181, v181
v_mfma_f32_16x16x32_bf16 v[220:223], a[28:31], a[172:175], v[220:223]
v_rcp_f32 v182, v182
v_mfma_f32_16x16x32_bf16 v[172:175], a[32:35], a[188:191], v[172:175]
v_rcp_f32 v183, v183
v_mfma_f32_16x16x32_bf16 v[188:191], a[36:39], a[188:191], v[188:191]
v_exp_f32 v168, v168
v_mfma_f32_16x16x32_bf16 v[204:207], a[40:43], a[188:191], v[204:207]
v_exp_f32 v169, v169
v_mfma_f32_16x16x32_bf16 v[220:223], a[44:47], a[188:191], v[220:223]
v_exp_f32 v170, v170
v_exp_f32 v171, v171
v_exp_f32 v184, v184
v_exp_f32 v185, v185
v_exp_f32 v186, v186
v_exp_f32 v187, v187
v_pk_mul_f32 v[196:197], v[196:197], v[164:165]
v_pk_mul_f32 v[198:199], v[198:199], v[166:167]
v_pk_mul_f32 v[212:213], v[212:213], v[180:181]
v_pk_mul_f32 v[214:215], v[214:215], v[182:183]
v_pk_fma_f32 v[172:173], v[112:113], v[26:27], v[172:173] op_sel_hi:[1,0,1]
v_pk_fma_f32 v[174:175], v[114:115], v[26:27], v[174:175] op_sel_hi:[1,0,1]
v_pk_fma_f32 v[188:189], v[128:129], v[26:27], v[188:189] op_sel_hi:[1,0,1]
v_pk_fma_f32 v[190:191], v[130:131], v[26:27], v[190:191] op_sel_hi:[1,0,1]
v_pk_fma_f32 v[204:205], v[144:145], v[26:27], v[204:205] op_sel_hi:[1,0,1]
v_pk_fma_f32 v[206:207], v[146:147], v[26:27], v[206:207] op_sel_hi:[1,0,1]
v_pk_fma_f32 v[220:221], v[12:13], v[26:27], v[220:221] op_sel_hi:[1,0,1]
v_pk_fma_f32 v[222:223], v[14:15], v[26:27], v[222:223] op_sel_hi:[1,0,1]
v_pk_mul_f32 v[204:205], v[204:205], v[172:173]
v_pk_mul_f32 v[172:173], v[172:173], v[30:31] op_sel:[0,1] op_sel_hi:[1,1]
v_pk_mul_f32 v[206:207], v[206:207], v[174:175]
v_pk_mul_f32 v[174:175], v[174:175], v[30:31] op_sel:[0,1] op_sel_hi:[1,1]
v_pk_mul_f32 v[220:221], v[220:221], v[188:189]
v_pk_mul_f32 v[188:189], v[188:189], v[30:31] op_sel:[0,1] op_sel_hi:[1,1]
v_pk_mul_f32 v[222:223], v[222:223], v[190:191]
v_pk_mul_f32 v[190:191], v[190:191], v[30:31] op_sel:[0,1] op_sel_hi:[1,1]
v_pk_fma_f32 v[168:169], v[168:169], v[24:25], v[24:25] op_sel:[0,1,1] op_sel_hi:[1,1,1]
v_pk_fma_f32 v[170:171], v[170:171], v[24:25], v[24:25] op_sel:[0,1,1] op_sel_hi:[1,1,1]
v_pk_fma_f32 v[184:185], v[184:185], v[24:25], v[24:25] op_sel:[0,1,1] op_sel_hi:[1,1,1]
v_pk_fma_f32 v[186:187], v[186:187], v[24:25], v[24:25] op_sel:[0,1,1] op_sel_hi:[1,1,1]
v_cvt_pk_bf16_f32 v164, v196, v197
v_cvt_pk_bf16_f32 v165, v198, v199
v_cvt_pk_bf16_f32 v166, v212, v213
v_cvt_pk_bf16_f32 v167, v214, v215
v_mfma_f32_16x16x32_bf16 v[224:227], a[48:51], a[144:147], v[224:227]
buffer_store_dwordx4 v[164:167], v10, s[16:19], s64 offen offset:1024 sc1
v_mfma_f32_16x16x32_bf16 v[232:235], a[52:55], a[144:147], v[232:235]
v_rcp_f32 v168, v168
v_mfma_f32_16x16x32_bf16 v[240:243], a[56:59], a[144:147], v[240:243]
v_rcp_f32 v169, v169
v_mfma_f32_16x16x32_bf16 v[248:251], a[60:63], a[144:147], v[248:251]
v_rcp_f32 v170, v170
v_mfma_f32_16x16x32_bf16 v[224:227], a[64:67], a[160:163], v[224:227]
v_rcp_f32 v171, v171
v_mfma_f32_16x16x32_bf16 v[232:235], a[68:71], a[160:163], v[232:235]
v_rcp_f32 v184, v184
v_mfma_f32_16x16x32_bf16 v[240:243], a[72:75], a[160:163], v[240:243]
v_rcp_f32 v185, v185
v_mfma_f32_16x16x32_bf16 v[248:251], a[76:79], a[160:163], v[248:251]
v_rcp_f32 v186, v186
v_mfma_f32_16x16x32_bf16 v[224:227], a[80:83], a[176:179], v[224:227]
v_rcp_f32 v187, v187
v_mfma_f32_16x16x32_bf16 v[232:235], a[84:87], a[176:179], v[232:235]
v_exp_f32 v172, v172
v_mfma_f32_16x16x32_bf16 v[240:243], a[88:91], a[176:179], v[240:243]
v_exp_f32 v173, v173
v_mfma_f32_16x16x32_bf16 v[248:251], a[92:95], a[176:179], v[248:251]
v_exp_f32 v174, v174
v_exp_f32 v175, v175
v_exp_f32 v188, v188
v_exp_f32 v189, v189
v_exp_f32 v190, v190
v_exp_f32 v191, v191
v_pk_mul_f32 v[200:201], v[200:201], v[168:169]
v_pk_mul_f32 v[202:203], v[202:203], v[170:171]
v_pk_mul_f32 v[216:217], v[216:217], v[184:185]
v_pk_mul_f32 v[218:219], v[218:219], v[186:187]
s_waitcnt lgkmcnt(2)
v_pk_fma_f32 v[224:225], v[176:177], v[20:21], v[224:225] op_sel_hi:[1,0,1]
v_pk_fma_f32 v[226:227], v[178:179], v[20:21], v[226:227] op_sel_hi:[1,0,1]
s_waitcnt lgkmcnt(1)
v_pk_fma_f32 v[232:233], v[192:193], v[20:21], v[232:233] op_sel_hi:[1,0,1]
v_pk_fma_f32 v[234:235], v[194:195], v[20:21], v[234:235] op_sel_hi:[1,0,1]
s_waitcnt lgkmcnt(0)
v_pk_fma_f32 v[240:241], v[208:209], v[20:21], v[240:241] op_sel_hi:[1,0,1]
v_pk_fma_f32 v[242:243], v[210:211], v[20:21], v[242:243] op_sel_hi:[1,0,1]
v_pk_fma_f32 v[248:249], v[4:5], v[20:21], v[248:249] op_sel_hi:[1,0,1]
v_pk_fma_f32 v[250:251], v[6:7], v[20:21], v[250:251] op_sel_hi:[1,0,1]
v_pk_mul_f32 v[240:241], v[240:241], v[224:225]
v_pk_mul_f32 v[224:225], v[224:225], v[28:29] op_sel_hi:[1,0]
v_pk_mul_f32 v[242:243], v[242:243], v[226:227]
v_pk_mul_f32 v[226:227], v[226:227], v[28:29] op_sel_hi:[1,0]
v_pk_mul_f32 v[248:249], v[248:249], v[232:233]
v_pk_mul_f32 v[232:233], v[232:233], v[28:29] op_sel_hi:[1,0]
v_pk_mul_f32 v[250:251], v[250:251], v[234:235]
v_pk_mul_f32 v[234:235], v[234:235], v[28:29] op_sel_hi:[1,0]
v_pk_fma_f32 v[172:173], v[172:173], v[26:27], v[26:27] op_sel:[0,1,1] op_sel_hi:[1,1,1]
v_pk_fma_f32 v[174:175], v[174:175], v[26:27], v[26:27] op_sel:[0,1,1] op_sel_hi:[1,1,1]
v_pk_fma_f32 v[188:189], v[188:189], v[26:27], v[26:27] op_sel:[0,1,1] op_sel_hi:[1,1,1]
v_pk_fma_f32 v[190:191], v[190:191], v[26:27], v[26:27] op_sel:[0,1,1] op_sel_hi:[1,1,1]
v_cvt_pk_bf16_f32 v168, v200, v201
v_cvt_pk_bf16_f32 v169, v202, v203
v_cvt_pk_bf16_f32 v170, v216, v217
v_cvt_pk_bf16_f32 v171, v218, v219
v_mfma_f32_16x16x32_bf16 v[228:231], a[48:51], a[148:151], v[228:231]
buffer_store_dwordx4 v[168:171], v11, s[16:19], s64 offen sc1
v_mfma_f32_16x16x32_bf16 v[236:239], a[52:55], a[148:151], v[236:239]
v_rcp_f32 v172, v172
v_mfma_f32_16x16x32_bf16 v[244:247], a[56:59], a[148:151], v[244:247]
v_rcp_f32 v173, v173
v_mfma_f32_16x16x32_bf16 v[252:255], a[60:63], a[148:151], v[252:255]
v_rcp_f32 v174, v174
v_mfma_f32_16x16x32_bf16 v[228:231], a[64:67], a[164:167], v[228:231]
v_rcp_f32 v175, v175
v_mfma_f32_16x16x32_bf16 v[236:239], a[68:71], a[164:167], v[236:239]
v_rcp_f32 v188, v188
v_mfma_f32_16x16x32_bf16 v[244:247], a[72:75], a[164:167], v[244:247]
v_rcp_f32 v189, v189
v_mfma_f32_16x16x32_bf16 v[252:255], a[76:79], a[164:167], v[252:255]
v_rcp_f32 v190, v190
v_mfma_f32_16x16x32_bf16 v[228:231], a[80:83], a[180:183], v[228:231]
v_rcp_f32 v191, v191
v_mfma_f32_16x16x32_bf16 v[236:239], a[84:87], a[180:183], v[236:239]
v_exp_f32 v224, v224
v_mfma_f32_16x16x32_bf16 v[244:247], a[88:91], a[180:183], v[244:247]
v_exp_f32 v225, v225
v_mfma_f32_16x16x32_bf16 v[252:255], a[92:95], a[180:183], v[252:255]
v_exp_f32 v226, v226
v_exp_f32 v227, v227
v_exp_f32 v232, v232
v_exp_f32 v233, v233
v_exp_f32 v234, v234
v_exp_f32 v235, v235
v_pk_mul_f32 v[204:205], v[204:205], v[172:173]
v_pk_mul_f32 v[206:207], v[206:207], v[174:175]
v_pk_mul_f32 v[220:221], v[220:221], v[188:189]
v_pk_mul_f32 v[222:223], v[222:223], v[190:191]
v_pk_fma_f32 v[228:229], v[176:177], v[22:23], v[228:229] op_sel_hi:[1,0,1]
v_pk_fma_f32 v[230:231], v[178:179], v[22:23], v[230:231] op_sel_hi:[1,0,1]
v_pk_fma_f32 v[236:237], v[192:193], v[22:23], v[236:237] op_sel_hi:[1,0,1]
v_pk_fma_f32 v[238:239], v[194:195], v[22:23], v[238:239] op_sel_hi:[1,0,1]
v_pk_fma_f32 v[244:245], v[208:209], v[22:23], v[244:245] op_sel_hi:[1,0,1]
v_pk_fma_f32 v[246:247], v[210:211], v[22:23], v[246:247] op_sel_hi:[1,0,1]
v_pk_fma_f32 v[252:253], v[4:5], v[22:23], v[252:253] op_sel_hi:[1,0,1]
v_pk_fma_f32 v[254:255], v[6:7], v[22:23], v[254:255] op_sel_hi:[1,0,1]
v_pk_mul_f32 v[244:245], v[244:245], v[228:229]
v_pk_mul_f32 v[228:229], v[228:229], v[28:29] op_sel:[0,1] op_sel_hi:[1,1]
v_pk_mul_f32 v[246:247], v[246:247], v[230:231]
v_pk_mul_f32 v[230:231], v[230:231], v[28:29] op_sel:[0,1] op_sel_hi:[1,1]
v_pk_mul_f32 v[252:253], v[252:253], v[236:237]
v_pk_mul_f32 v[236:237], v[236:237], v[28:29] op_sel:[0,1] op_sel_hi:[1,1]
v_pk_mul_f32 v[254:255], v[254:255], v[238:239]
v_pk_mul_f32 v[238:239], v[238:239], v[28:29] op_sel:[0,1] op_sel_hi:[1,1]
v_pk_fma_f32 v[224:225], v[224:225], v[20:21], v[20:21] op_sel:[0,1,1] op_sel_hi:[1,1,1]
v_pk_fma_f32 v[226:227], v[226:227], v[20:21], v[20:21] op_sel:[0,1,1] op_sel_hi:[1,1,1]
v_pk_fma_f32 v[232:233], v[232:233], v[20:21], v[20:21] op_sel:[0,1,1] op_sel_hi:[1,1,1]
v_pk_fma_f32 v[234:235], v[234:235], v[20:21], v[20:21] op_sel:[0,1,1] op_sel_hi:[1,1,1]
v_cvt_pk_bf16_f32 v172, v204, v205
v_cvt_pk_bf16_f32 v173, v206, v207
v_cvt_pk_bf16_f32 v174, v220, v221
v_cvt_pk_bf16_f32 v175, v222, v223
buffer_store_dwordx4 v[172:175], v11, s[16:19], s64 offen offset:1024 sc1
v_rcp_f32 v224, v224
v_rcp_f32 v225, v225
v_rcp_f32 v226, v226
v_rcp_f32 v227, v227
v_rcp_f32 v232, v232
v_rcp_f32 v233, v233
v_rcp_f32 v234, v234
v_rcp_f32 v235, v235
v_exp_f32 v228, v228
v_exp_f32 v229, v229
v_exp_f32 v230, v230
v_exp_f32 v231, v231
v_exp_f32 v236, v236
v_exp_f32 v237, v237
v_exp_f32 v238, v238
v_exp_f32 v239, v239
v_pk_mul_f32 v[240:241], v[240:241], v[224:225]
v_pk_mul_f32 v[242:243], v[242:243], v[226:227]
v_pk_mul_f32 v[248:249], v[248:249], v[232:233]
v_pk_mul_f32 v[250:251], v[250:251], v[234:235]
v_pk_fma_f32 v[228:229], v[228:229], v[22:23], v[22:23] op_sel:[0,1,1] op_sel_hi:[1,1,1]
v_pk_fma_f32 v[230:231], v[230:231], v[22:23], v[22:23] op_sel:[0,1,1] op_sel_hi:[1,1,1]
v_pk_fma_f32 v[236:237], v[236:237], v[22:23], v[22:23] op_sel:[0,1,1] op_sel_hi:[1,1,1]
v_pk_fma_f32 v[238:239], v[238:239], v[22:23], v[22:23] op_sel:[0,1,1] op_sel_hi:[1,1,1]
v_cvt_pk_bf16_f32 v224, v240, v241
v_cvt_pk_bf16_f32 v225, v242, v243
v_cvt_pk_bf16_f32 v226, v248, v249
v_cvt_pk_bf16_f32 v227, v250, v251
.Lpad23:
s_cbranch_execz .Lnopoll72r
buffer_store_dwordx4 v[224:227], v10, s[16:19], s65 offen sc1
v_rcp_f32 v228, v228
v_rcp_f32 v229, v229
v_rcp_f32 v230, v230
v_rcp_f32 v231, v231
v_rcp_f32 v236, v236
v_rcp_f32 v237, v237
v_rcp_f32 v238, v238
v_rcp_f32 v239, v239
v_pk_mul_f32 v[244:245], v[244:245], v[228:229]
v_pk_mul_f32 v[246:247], v[246:247], v[230:231]
v_pk_mul_f32 v[252:253], v[252:253], v[236:237]
v_pk_mul_f32 v[254:255], v[254:255], v[238:239]
v_cvt_pk_bf16_f32 v228, v244, v245
v_cvt_pk_bf16_f32 v229, v246, v247
v_cvt_pk_bf16_f32 v230, v252, v253
v_cvt_pk_bf16_f32 v231, v254, v255
buffer_store_dwordx4 v[228:231], v10, s[16:19], s65 offen offset:1024 sc1
s_nop 1
s_lshl_b32 s62, s5, 2
s_add_u32 s62, s62, s3
s_lshl_b32 s62, s62, 12
s_and_b32 s63, s7, 1
s_mul_i32 s63, s63, 3670016
s_add_u32 s62, s62, s63
s_lshr_b32 s63, s28, 7
s_sub_u32 s63, 3, s63
s_and_b32 s63, s63, 6
s_lshl_b32 s63, s63, 7
s_add_u32 s62, s62, s63
v_lshrrev_b32 v2, 5, v1
v_mul_u32_u24 v2, 1024, v2
v_bfe_u32 v9, v1, 4, 1
v_lshl_add_u32 v9, v9, 11, v2
v_add_u32 v9, s62, v9
v_bfe_u32 v2, v1, 3, 1
v_lshl_add_u32 v9, v2, 7, v9
s_mov_b32 s44, 16777216
s_mov_b32 s45, 1966080
s_lshl_b32 s62, s6, 13
s_lshl_b32 s63, s3, 11
s_add_u32 s62, s62, s63
v_lshl_add_u32 v4, v1, 4, s62
v_lshrrev_b32 v2, 3, v1
v_cmp_eq_u32 vcc, 3, v2
v_add_u32 v2, 67108480, v4
s_nop 0
v_cndmask_b32 v4, v4, v2, vcc
s_and_b32 s62, s7, 1
s_mul_i32 s62, s62, 3670016
s_lshr_b32 s63, s7, 1
s_lshl_b32 s63, s63, 8
s_add_u32 s62, s62, s63
s_lshl_b32 s63, s3, 12
s_add_u32 s62, s62, s63
v_lshrrev_b32 v5, 4, v1
v_lshlrev_b32 v5, 14, v5
v_and_b32 v2, 15, v1
v_lshl_add_u32 v5, v2, 4, v5
v_add_u32 v5, s62, v5
v_add_u32 v6, 992, v5
v_bfe_u32 v8, v1, 2, 3
v_mul_u32_u24 v8, 1056, v8
v_bfe_u32 v2, v1, 5, 1
v_lshl_add_u32 v8, v2, 8, v8
v_and_b32 v2, 3, v1
v_lshl_add_u32 v8, v2, 3, v8
s_and_b32 s62, s7, 1
s_lshl_b32 s63, s62, 7
s_xor_b32 s64, s63, 128
v_add_u32 v7, s63, v8
v_add_u32 v10, s64, v8
s_mul_i32 s52, s62, 7340032
s_add_u32 s52, s52, 46137344
s_mov_b32 s54, 917504
s_mul_i32 s55, s3, 2112
s_add_u32 s56, s55, 67584
s_mov_b32 s57, 67584
s_lshl_b32 s70, s2, 10
s_lshl_b32 s62, s3, 7
s_add_u32 s70, s70, s62
s_add_u32 s70, s70, 31457792
s_xor_b32 s71, s70, 1024
v_min_u32 v12, 1, v1
v_lshlrev_b32 v12, 28, v12
v_mov_b32 v13, 1
v_mov_b32 v15, 0
s_lshl_b32 s68, s7, 18
s_add_u32 s68, s68, 146800640
s_xor_b32 s69, s68, 262144
v_mov_b32 v11, v4
v_and_b32 v2, 1, v1
v_lshlrev_b32 v2, 4, v2
v_mov_b32 v224, 0x3f80
v_lshlrev_b32 v2, v2, v224
v_bfe_u32 v224, v1, 2, 2
v_lshrrev_b32 v225, 4, v1
v_cmp_eq_u32 vcc, v224, v225
s_nop 1
v_cndmask_b32 v2, 0, v2, vcc
v_and_b32 v224, 2, v1
v_cmp_eq_u32 vcc, 0, v224
s_nop 1
v_cndmask_b32 v226, 0, v2, vcc
v_cndmask_b32 v227, v2, 0, vcc
v_mov_b64 v[224:225], 0
v_mov_b64 v[228:229], 0
v_mov_b64 v[64:65], 0
v_mov_b64 v[66:67], 0
v_mov_b64 v[68:69], 0
v_mov_b64 v[70:71], 0
v_mov_b64 v[72:73], 0
v_mov_b64 v[74:75], 0
v_mov_b64 v[76:77], 0
v_mov_b64 v[78:79], 0
v_mov_b64 v[80:81], 0
v_mov_b64 v[82:83], 0
v_mov_b64 v[84:85], 0
v_mov_b64 v[86:87], 0
v_mov_b64 v[88:89], 0
v_mov_b64 v[90:91], 0
v_mov_b64 v[92:93], 0
v_mov_b64 v[94:95], 0
v_accvgpr_read_b32 v32, a224
v_accvgpr_read_b32 v33, a225
v_accvgpr_read_b32 v34, a226
v_accvgpr_read_b32 v35, a227
v_accvgpr_read_b32 v36, a228
v_accvgpr_read_b32 v37, a229
v_accvgpr_read_b32 v38, a230
v_accvgpr_read_b32 v39, a231
v_accvgpr_read_b32 v40, a232
v_accvgpr_read_b32 v41, a233
v_accvgpr_read_b32 v42, a234
v_accvgpr_read_b32 v43, a235
v_accvgpr_read_b32 v44, a236
v_accvgpr_read_b32 v45, a237
v_accvgpr_read_b32 v46, a238
v_accvgpr_read_b32 v47, a239
v_accvgpr_read_b32 v48, a240
v_accvgpr_read_b32 v49, a241
v_accvgpr_read_b32 v50, a242
v_accvgpr_read_b32 v51, a243
v_accvgpr_read_b32 v52, a244
v_accvgpr_read_b32 v53, a245
v_accvgpr_read_b32 v54, a246
v_accvgpr_read_b32 v55, a247
v_accvgpr_read_b32 v56, a248
v_accvgpr_read_b32 v57, a249
v_accvgpr_read_b32 v58, a250
v_accvgpr_read_b32 v59, a251
v_accvgpr_read_b32 v60, a252
v_accvgpr_read_b32 v61, a253
v_accvgpr_read_b32 v62, a254
v_accvgpr_read_b32 v63, a255
s_lshr_b32 s62, s6, 1
s_lshl_b32 s62, s62, 8
s_and_b32 s63, s6, 1
s_add_u32 s62, s62, s63
s_lshl_b32 s63, s3, 6
s_add_u32 s62, s62, s63
s_lshl_b32 s62, s62, 11
s_lshl_b32 s63, s7, 7
s_add_u32 s62, s62, s63
v_and_b32 v16, 15, v1
v_lshlrev_b32 v16, 12, v16
v_bfe_u32 v2, v1, 4, 1
v_lshl_add_u32 v16, v2, 5, v16
v_bfe_u32 v2, v1, 5, 1
v_lshl_add_u32 v16, v2, 4, v16
v_add_u32 v16, s62, v16
v_add_u32 v17, 0x10000, v16
s_lshl_b32 s62, s10, 1
s_lshr_b32 s63, s11, 4
s_add_u32 s62, s62, s63
s_lshl_b32 s62, s62, 10
s_add_u32 s62, s62, 30523392
s_and_b32 s64, s6, 14
s_and_b32 s63, s7, 1
s_add_u32 s64, s64, s63
s_lshl_b32 s64, s64, 10
s_add_u32 s64, s64, 30523392
s_lshr_b32 s67, s5, 2
s_and_b32 s67, s67, 3
s_lshl_b32 s67, s67, 7
s_add_u32 s64, s64, s67
v_lshl_add_u32 v252, v1, 7, s62
v_mov_b32 v253, s64
s_waitcnt vmcnt(0) lgkmcnt(0)
s_barrier
s_cmp_lg_u32 s3, 0
s_cbranch_scc1 .Lnosig75
v_mov_b32 v255, 1
s_mov_b64 exec, 15
buffer_atomic_add v255, v252, s[16:19], 0 offen
s_mov_b64 exec, -1
.Lnosig75:
s_cmp_lg_u32 s3, 1
s_cbranch_scc1 .Lnopoll78
s_mov_b64 exec, 1
s_mov_b32 s15, 0
s_mov_b64 exec, 1
v_mov_b32 v254, 0
buffer_atomic_add v254, v253, s[16:19], 0 offen sc0
.Lpoll76:
s_waitcnt vmcnt(0)
v_cmp_ne_u32 vcc, 16, v254
s_add_u32 s15, s15, 1
s_cbranch_vccz .Lnopoll78r
s_mov_b64 exec, 1
v_mov_b32 v254, 0
buffer_atomic_add v254, v253, s[16:19], 0 offen sc0
s_cmp_le_u32 s15, 100000
s_cbranch_scc1 .Lpoll76
.Lgot77:
s_waitcnt vmcnt(0)
s_branch .Lnopoll78r
.Lnopoll78:
s_mov_b64 exec, 0
s_cmp_eq_u32 s3, 2
s_cbranch_scc1 .Lpad24
s_cmp_eq_u32 s3, 3
s_cbranch_scc1 .Lpad25
s_branch .Lnopoll78r
.Lnopoll78r:
s_mov_b64 exec, -1
s_barrier
buffer_load_dwordx4 v[96:99], v4, s[16:19], s52 offen sc1
buffer_load_dwordx4 v[100:103], v4, s[16:19], s52 offen offset:1024 sc1
s_add_u32 s52, s52, 0x20000
buffer_load_dwordx4 v[104:107], v4, s[16:19], s52 offen sc1
buffer_load_dwordx4 v[108:111], v4, s[16:19], s52 offen offset:1024 sc1
s_add_u32 s52, s52, 0x20000
buffer_load_dwordx4 v[112:115], v4, s[16:19], s52 offen sc1
buffer_load_dwordx4 v[116:119], v4, s[16:19], s52 offen offset:1024 sc1
s_add_u32 s52, s52, 0x20000
buffer_load_dwordx4 v[120:123], v4, s[16:19], s52 offen sc1
buffer_load_dwordx4 v[124:127], v4, s[16:19], s52 offen offset:1024 sc1
s_add_u32 s52, s52, 0x20000
buffer_load_dwordx4 v[128:131], v4, s[16:19], s52 offen sc1
buffer_load_dwordx4 v[132:135], v4, s[16:19], s52 offen offset:1024 sc1
s_add_u32 s52, s52, 0x20000
buffer_load_dwordx4 v[136:139], v4, s[16:19], s52 offen sc1
buffer_load_dwordx4 v[140:143], v4, s[16:19], s52 offen offset:1024 sc1
s_add_u32 s52, s52, 0x20000
ds_read_b64_tr_b16 a[0:1], v7
ds_read_b64_tr_b16 a[2:3], v7 offset:512
ds_read_b64_tr_b16 a[4:5], v7 offset:32
ds_read_b64_tr_b16 a[6:7], v7 offset:544
ds_read_b64_tr_b16 a[8:9], v7 offset:64
ds_read_b64_tr_b16 a[10:11], v7 offset:576
ds_read_b64_tr_b16 a[12:13], v7 offset:96
ds_read_b64_tr_b16 a[14:15], v7 offset:608
ds_read_b64_tr_b16 a[16:17], v10
ds_read_b64_tr_b16 a[18:19], v10 offset:512
ds_read_b64_tr_b16 a[20:21], v10 offset:32
ds_read_b64_tr_b16 a[22:23], v10 offset:544
ds_read_b64_tr_b16 a[24:25], v10 offset:64
ds_read_b64_tr_b16 a[26:27], v10 offset:576
ds_read_b64_tr_b16 a[28:29], v10 offset:96
ds_read_b64_tr_b16 a[30:31], v10 offset:608
s_waitcnt lgkmcnt(0)
s_mov_b32 s15, -4
.p2align 6
.Lk80:
s_waitcnt vmcnt(10) lgkmcnt(8)
s_barrier
v_mfma_f32_16x16x32_bf16 v[32:35], a[0:3], v[96:99], v[32:35]
ds_read_b64_tr_b16 a[32:33], v7 offset:8448
s_add_u32 m0, s56, 50688
v_mfma_f32_16x16x32_bf16 v[48:51], a[0:3], v[100:103], v[48:51]
buffer_load_dwordx4 v5, s[28:31], s54 offen lds
v_mfma_f32_16x16x32_bf16 v[52:55], a[4:7], v[100:103], v[52:55]
ds_read_b64_tr_b16 a[34:35], v7 offset:8960
ds_read_b64_tr_b16 a[36:37], v7 offset:8480
v_mfma_f32_16x16x32_bf16 v[36:39], a[4:7], v[96:99], v[36:39]
ds_read_b64_tr_b16 a[38:39], v7 offset:8992
v_mfma_f32_16x16x32_bf16 v[40:43], a[8:11], v[96:99], v[40:43]
buffer_load_dwordx4 v[144:147], v4, s[16:19], s52 offen sc1
v_mfma_f32_16x16x32_bf16 v[56:59], a[8:11], v[100:103], v[56:59]
ds_read_b64_tr_b16 a[40:41], v7 offset:8512
ds_read_b64_tr_b16 a[42:43], v7 offset:9024
v_mfma_f32_16x16x32_bf16 v[60:63], a[12:15], v[100:103], v[60:63]
ds_read_b64_tr_b16 a[44:45], v7 offset:8544
ds_read_b64_tr_b16 a[46:47], v7 offset:9056
v_mfma_f32_16x16x32_bf16 v[44:47], a[12:15], v[96:99], v[44:47]
s_waitcnt lgkmcnt(8)
v_mfma_f32_16x16x32_bf16 v[64:67], a[16:19], v[96:99], v[64:67]
buffer_load_dwordx4 v6, s[28:31], s54 offen offset:1056 lds
v_mfma_f32_16x16x32_bf16 v[80:83], a[16:19], v[100:103], v[80:83]
ds_read_b64_tr_b16 a[48:49], v10 offset:8448
s_add_u32 s54, s54, 0x10000
v_mfma_f32_16x16x32_bf16 v[84:87], a[20:23], v[100:103], v[84:87]
ds_read_b64_tr_b16 a[50:51], v10 offset:8960
ds_read_b64_tr_b16 a[52:53], v10 offset:8480
v_mfma_f32_16x16x32_bf16 v[68:71], a[20:23], v[96:99], v[68:71]
ds_read_b64_tr_b16 a[54:55], v10 offset:8992
v_mfma_f32_16x16x32_bf16 v[72:75], a[24:27], v[96:99], v[72:75]
buffer_load_dwordx4 v[148:151], v4, s[16:19], s52 offen offset:1024 sc1
v_mfma_f32_16x16x32_bf16 v[88:91], a[24:27], v[100:103], v[88:91]
ds_read_b64_tr_b16 a[56:57], v10 offset:8512
s_add_u32 s52, s52, 0x20000
v_mfma_f32_16x16x32_bf16 v[92:95], a[28:31], v[100:103], v[92:95]
ds_read_b64_tr_b16 a[58:59], v10 offset:9024
ds_read_b64_tr_b16 a[60:61], v10 offset:8544
v_mfma_f32_16x16x32_bf16 v[76:79], a[28:31], v[96:99], v[76:79]
ds_read_b64_tr_b16 a[62:63], v10 offset:9056
s_waitcnt vmcnt(12) lgkmcnt(8)
v_mfma_f32_16x16x32_bf16 v[32:35], a[32:35], v[104:107], v[32:35]
ds_read_b64_tr_b16 a[0:1], v7 offset:16896
s_add_u32 m0, s56, 59136
v_mfma_f32_16x16x32_bf16 v[48:51], a[32:35], v[108:111], v[48:51]
buffer_load_dwordx4 v5, s[28:31], s54 offen lds
v_mfma_f32_16x16x32_bf16 v[52:55], a[36:39], v[108:111], v[52:55]
ds_read_b64_tr_b16 a[2:3], v7 offset:17408
ds_read_b64_tr_b16 a[4:5], v7 offset:16928
v_mfma_f32_16x16x32_bf16 v[36:39], a[36:39], v[104:107], v[36:39]
ds_read_b64_tr_b16 a[6:7], v7 offset:17440
ds_read_b64_tr_b16 a[8:9], v7 offset:16960
v_mfma_f32_16x16x32_bf16 v[40:43], a[40:43], v[104:107], v[40:43]
buffer_load_dwordx4 v[152:155], v4, s[16:19], s52 offen sc1
v_mfma_f32_16x16x32_bf16 v[56:59], a[40:43], v[108:111], v[56:59]
ds_read_b64_tr_b16 a[10:11], v7 offset:17472
ds_read_b64_tr_b16 a[12:13], v7 offset:16992
v_mfma_f32_16x16x32_bf16 v[60:63], a[44:47], v[108:111], v[60:63]
ds_read_b64_tr_b16 a[14:15], v7 offset:17504
ds_read_b64_tr_b16 a[16:17], v10 offset:16896
v_mfma_f32_16x16x32_bf16 v[44:47], a[44:47], v[104:107], v[44:47]
ds_read_b64_tr_b16 a[18:19], v10 offset:17408
s_waitcnt lgkmcnt(10)
v_mfma_f32_16x16x32_bf16 v[64:67], a[48:51], v[104:107], v[64:67]
buffer_load_dwordx4 v6, s[28:31], s54 offen offset:1056 lds
v_mfma_f32_16x16x32_bf16 v[80:83], a[48:51], v[108:111], v[80:83]
ds_read_b64_tr_b16 a[20:21], v10 offset:16928
s_add_u32 s54, s54, 0x10000
v_mfma_f32_16x16x32_bf16 v[84:87], a[52:55], v[108:111], v[84:87]
buffer_load_dwordx4 v[156:159], v4, s[16:19], s52 offen offset:1024 sc1
v_mfma_f32_16x16x32_bf16 v[68:71], a[52:55], v[104:107], v[68:71]
ds_read_b64_tr_b16 a[22:23], v10 offset:17440
s_add_u32 s52, s52, 0x20000
v_mfma_f32_16x16x32_bf16 v[72:75], a[56:59], v[104:107], v[72:75]
ds_read_b64_tr_b16 a[24:25], v10 offset:16960
ds_read_b64_tr_b16 a[26:27], v10 offset:17472
v_mfma_f32_16x16x32_bf16 v[88:91], a[56:59], v[108:111], v[88:91]
buffer_load_dword v27, v9, s[28:31], s44 offen
v_mfma_f32_16x16x32_bf16 v[92:95], a[60:63], v[108:111], v[92:95]
ds_read_b64_tr_b16 a[28:29], v10 offset:16992
s_mov_b32 s44, s45
s_add_u32 s45, s45, 0x80000
v_mfma_f32_16x16x32_bf16 v[76:79], a[60:63], v[104:107], v[76:79]
ds_read_b64_tr_b16 a[30:31], v10 offset:17504
s_waitcnt vmcnt(15) lgkmcnt(8)
s_barrier
v_mfma_f32_16x16x32_bf16 v[32:35], a[0:3], v[112:115], v[32:35]
ds_read_b64_tr_b16 a[32:33], v7 offset:25344
s_add_u32 m0, s55, 0
v_mfma_f32_16x16x32_bf16 v[48:51], a[0:3], v[116:119], v[48:51]
buffer_load_dwordx4 v5, s[28:31], s54 offen lds
v_mfma_f32_16x16x32_bf16 v[52:55], a[4:7], v[116:119], v[52:55]
ds_read_b64_tr_b16 a[34:35], v7 offset:25856
ds_read_b64_tr_b16 a[36:37], v7 offset:25376
v_mfma_f32_16x16x32_bf16 v[36:39], a[4:7], v[112:115], v[36:39]
ds_read_b64_tr_b16 a[38:39], v7 offset:25888
v_mfma_f32_16x16x32_bf16 v[40:43], a[8:11], v[112:115], v[40:43]
buffer_load_dwordx4 v[96:99], v4, s[16:19], s52 offen sc1
v_mfma_f32_16x16x32_bf16 v[56:59], a[8:11], v[116:119], v[56:59]
ds_read_b64_tr_b16 a[40:41], v7 offset:25408
ds_read_b64_tr_b16 a[42:43], v7 offset:25920
v_mfma_f32_16x16x32_bf16 v[60:63], a[12:15], v[116:119], v[60:63]
ds_read_b64_tr_b16 a[44:45], v7 offset:25440
ds_read_b64_tr_b16 a[46:47], v7 offset:25952
v_mfma_f32_16x16x32_bf16 v[44:47], a[12:15], v[112:115], v[44:47]
s_waitcnt lgkmcnt(8)
v_mfma_f32_16x16x32_bf16 v[64:67], a[16:19], v[112:115], v[64:67]
buffer_load_dwordx4 v6, s[28:31], s54 offen offset:1056 lds
v_mfma_f32_16x16x32_bf16 v[80:83], a[16:19], v[116:119], v[80:83]
ds_read_b64_tr_b16 a[48:49], v10 offset:25344
s_add_u32 s54, s54, 0x10000
v_mfma_f32_16x16x32_bf16 v[84:87], a[20:23], v[116:119], v[84:87]
ds_read_b64_tr_b16 a[50:51], v10 offset:25856
ds_read_b64_tr_b16 a[52:53], v10 offset:25376
v_mfma_f32_16x16x32_bf16 v[68:71], a[20:23], v[112:115], v[68:71]
ds_read_b64_tr_b16 a[54:55], v10 offset:25888
v_mfma_f32_16x16x32_bf16 v[72:75], a[24:27], v[112:115], v[72:75]
buffer_load_dwordx4 v[100:103], v4, s[16:19], s52 offen offset:1024 sc1
v_mfma_f32_16x16x32_bf16 v[88:91], a[24:27], v[116:119], v[88:91]
ds_read_b64_tr_b16 a[56:57], v10 offset:25408
s_add_u32 s52, s52, 0x20000
v_mfma_f32_16x16x32_bf16 v[92:95], a[28:31], v[116:119], v[92:95]
ds_read_b64_tr_b16 a[58:59], v10 offset:25920
ds_read_b64_tr_b16 a[60:61], v10 offset:25440
v_mfma_f32_16x16x32_bf16 v[76:79], a[28:31], v[112:115], v[76:79]
ds_read_b64_tr_b16 a[62:63], v10 offset:25952
s_waitcnt vmcnt(17) lgkmcnt(8)
v_mfma_f32_16x16x32_bf16 v[32:35], a[32:35], v[120:123], v[32:35]
ds_read_b64_tr_b16 a[0:1], v7 offset:33792
s_add_u32 m0, s55, 8448
v_mfma_f32_16x16x32_bf16 v[48:51], a[32:35], v[124:127], v[48:51]
buffer_load_dwordx4 v5, s[28:31], s54 offen lds
v_mfma_f32_16x16x32_bf16 v[52:55], a[36:39], v[124:127], v[52:55]
ds_read_b64_tr_b16 a[2:3], v7 offset:34304
ds_read_b64_tr_b16 a[4:5], v7 offset:33824
v_mfma_f32_16x16x32_bf16 v[36:39], a[36:39], v[120:123], v[36:39]
ds_read_b64_tr_b16 a[6:7], v7 offset:34336
v_mfma_f32_16x16x32_bf16 v[40:43], a[40:43], v[120:123], v[40:43]
buffer_load_dwordx4 v[104:107], v4, s[16:19], s52 offen sc1
v_mfma_f32_16x16x32_bf16 v[56:59], a[40:43], v[124:127], v[56:59]
ds_read_b64_tr_b16 a[8:9], v7 offset:33856
ds_read_b64_tr_b16 a[10:11], v7 offset:34368
v_mfma_f32_16x16x32_bf16 v[60:63], a[44:47], v[124:127], v[60:63]
ds_read_b64_tr_b16 a[12:13], v7 offset:33888
ds_read_b64_tr_b16 a[14:15], v7 offset:34400
v_mfma_f32_16x16x32_bf16 v[44:47], a[44:47], v[120:123], v[44:47]
s_waitcnt lgkmcnt(8)
v_mfma_f32_16x16x32_bf16 v[64:67], a[48:51], v[120:123], v[64:67]
buffer_load_dwordx4 v6, s[28:31], s54 offen offset:1056 lds
v_mfma_f32_16x16x32_bf16 v[80:83], a[48:51], v[124:127], v[80:83]
ds_read_b64_tr_b16 a[16:17], v10 offset:33792
s_add_u32 s54, s54, 0x10000
v_mfma_f32_16x16x32_bf16 v[84:87], a[52:55], v[124:127], v[84:87]
ds_read_b64_tr_b16 a[18:19], v10 offset:34304
ds_read_b64_tr_b16 a[20:21], v10 offset:33824
v_mfma_f32_16x16x32_bf16 v[68:71], a[52:55], v[120:123], v[68:71]
ds_read_b64_tr_b16 a[22:23], v10 offset:34336
v_mfma_f32_16x16x32_bf16 v[72:75], a[56:59], v[120:123], v[72:75]
buffer_load_dwordx4 v[108:111], v4, s[16:19], s52 offen offset:1024 sc1
v_mfma_f32_16x16x32_bf16 v[88:91], a[56:59], v[124:127], v[88:91]
ds_read_b64_tr_b16 a[24:25], v10 offset:33856
s_add_u32 s52, s52, 0x20000
v_mfma_f32_16x16x32_bf16 v[92:95], a[60:63], v[124:127], v[92:95]
ds_read_b64_tr_b16 a[26:27], v10 offset:34368
ds_read_b64_tr_b16 a[28:29], v10 offset:33888
v_mfma_f32_16x16x32_bf16 v[76:79], a[60:63], v[120:123], v[76:79]
ds_read_b64_tr_b16 a[30:31], v10 offset:34400
s_waitcnt vmcnt(19) lgkmcnt(8)
s_barrier
v_mfma_f32_16x16x32_bf16 v[32:35], a[0:3], v[128:131], v[32:35]
ds_read_b64_tr_b16 a[32:33], v7 offset:42240
s_add_u32 m0, s55, 16896
v_mfma_f32_16x16x32_bf16 v[48:51], a[0:3], v[132:135], v[48:51]
buffer_load_dwordx4 v5, s[28:31], s54 offen lds
v_mfma_f32_16x16x32_bf16 v[52:55], a[4:7], v[132:135], v[52:55]
ds_read_b64_tr_b16 a[34:35], v7 offset:42752
ds_read_b64_tr_b16 a[36:37], v7 offset:42272
v_mfma_f32_16x16x32_bf16 v[36:39], a[4:7], v[128:131], v[36:39]
ds_read_b64_tr_b16 a[38:39], v7 offset:42784
v_mfma_f32_16x16x32_bf16 v[40:43], a[8:11], v[128:131], v[40:43]
buffer_load_dwordx4 v[112:115], v4, s[16:19], s52 offen sc1
v_mfma_f32_16x16x32_bf16 v[56:59], a[8:11], v[132:135], v[56:59]
ds_read_b64_tr_b16 a[40:41], v7 offset:42304
ds_read_b64_tr_b16 a[42:43], v7 offset:42816
v_mfma_f32_16x16x32_bf16 v[60:63], a[12:15], v[132:135], v[60:63]
ds_read_b64_tr_b16 a[44:45], v7 offset:42336
ds_read_b64_tr_b16 a[46:47], v7 offset:42848
v_mfma_f32_16x16x32_bf16 v[44:47], a[12:15], v[128:131], v[44:47]
s_waitcnt lgkmcnt(8)
v_mfma_f32_16x16x32_bf16 v[64:67], a[16:19], v[128:131], v[64:67]
buffer_load_dwordx4 v6, s[28:31], s54 offen offset:1056 lds
v_mfma_f32_16x16x32_bf16 v[80:83], a[16:19], v[132:135], v[80:83]
ds_read_b64_tr_b16 a[48:49], v10 offset:42240
s_add_u32 s54, s54, 0x10000
v_mfma_f32_16x16x32_bf16 v[84:87], a[20:23], v[132:135], v[84:87]
ds_read_b64_tr_b16 a[50:51], v10 offset:42752
ds_read_b64_tr_b16 a[52:53], v10 offset:42272
v_mfma_f32_16x16x32_bf16 v[68:71], a[20:23], v[128:131], v[68:71]
ds_read_b64_tr_b16 a[54:55], v10 offset:42784
v_mfma_f32_16x16x32_bf16 v[72:75], a[24:27], v[128:131], v[72:75]
buffer_load_dwordx4 v[116:119], v4, s[16:19], s52 offen offset:1024 sc1
v_mfma_f32_16x16x32_bf16 v[88:91], a[24:27], v[132:135], v[88:91]
ds_read_b64_tr_b16 a[56:57], v10 offset:42304
s_add_u32 s52, s52, 0x20000
v_mfma_f32_16x16x32_bf16 v[92:95], a[28:31], v[132:135], v[92:95]
ds_read_b64_tr_b16 a[58:59], v10 offset:42816
ds_read_b64_tr_b16 a[60:61], v10 offset:42336
v_mfma_f32_16x16x32_bf16 v[76:79], a[28:31], v[128:131], v[76:79]
ds_read_b64_tr_b16 a[62:63], v10 offset:42848
s_waitcnt vmcnt(21) lgkmcnt(8)
v_mfma_f32_16x16x32_bf16 v[32:35], a[32:35], v[136:139], v[32:35]
ds_read_b64_tr_b16 a[0:1], v7 offset:50688
s_add_u32 m0, s55, 25344
v_mfma_f32_16x16x32_bf16 v[48:51], a[32:35], v[140:143], v[48:51]
buffer_load_dwordx4 v5, s[28:31], s54 offen lds
v_mfma_f32_16x16x32_bf16 v[52:55], a[36:39], v[140:143], v[52:55]
ds_read_b64_tr_b16 a[2:3], v7 offset:51200
ds_read_b64_tr_b16 a[4:5], v7 offset:50720
v_mfma_f32_16x16x32_bf16 v[36:39], a[36:39], v[136:139], v[36:39]
ds_read_b64_tr_b16 a[6:7], v7 offset:51232
v_mfma_f32_16x16x32_bf16 v[40:43], a[40:43], v[136:139], v[40:43]
buffer_load_dwordx4 v[120:123], v4, s[16:19], s52 offen sc1
v_mfma_f32_16x16x32_bf16 v[56:59], a[40:43], v[140:143], v[56:59]
ds_read_b64_tr_b16 a[8:9], v7 offset:50752
ds_read_b64_tr_b16 a[10:11], v7 offset:51264
v_mfma_f32_16x16x32_bf16 v[60:63], a[44:47], v[140:143], v[60:63]
ds_read_b64_tr_b16 a[12:13], v7 offset:50784
ds_read_b64_tr_b16 a[14:15], v7 offset:51296
v_mfma_f32_16x16x32_bf16 v[44:47], a[44:47], v[136:139], v[44:47]
s_waitcnt lgkmcnt(8)
v_mfma_f32_16x16x32_bf16 v[64:67], a[48:51], v[136:139], v[64:67]
buffer_load_dwordx4 v6, s[28:31], s54 offen offset:1056 lds
v_mfma_f32_16x16x32_bf16 v[80:83], a[48:51], v[140:143], v[80:83]
ds_read_b64_tr_b16 a[16:17], v10 offset:50688
s_add_u32 s54, s54, 0x10000
v_mfma_f32_16x16x32_bf16 v[84:87], a[52:55], v[140:143], v[84:87]
ds_read_b64_tr_b16 a[18:19], v10 offset:51200
ds_read_b64_tr_b16 a[20:21], v10 offset:50720
v_mfma_f32_16x16x32_bf16 v[68:71], a[52:55], v[136:139], v[68:71]
ds_read_b64_tr_b16 a[22:23], v10 offset:51232
v_mfma_f32_16x16x32_bf16 v[72:75], a[56:59], v[136:139], v[72:75]
buffer_load_dwordx4 v[124:127], v4, s[16:19], s52 offen offset:1024 sc1
v_mfma_f32_16x16x32_bf16 v[88:91], a[56:59], v[140:143], v[88:91]
ds_read_b64_tr_b16 a[24:25], v10 offset:50752
s_add_u32 s52, s52, 0x20000
v_mfma_f32_16x16x32_bf16 v[92:95], a[60:63], v[140:143], v[92:95]
ds_read_b64_tr_b16 a[26:27], v10 offset:51264
ds_read_b64_tr_b16 a[28:29], v10 offset:50784
v_mfma_f32_16x16x32_bf16 v[76:79], a[60:63], v[136:139], v[76:79]
ds_read_b64_tr_b16 a[30:31], v10 offset:51296
s_waitcnt vmcnt(21) lgkmcnt(8)
s_barrier
v_mfma_f32_16x16x32_bf16 v[32:35], a[0:3], v[144:147], v[32:35]
ds_read_b64_tr_b16 a[32:33], v7 offset:59136
s_add_u32 m0, s55, 33792
v_mfma_f32_16x16x32_bf16 v[48:51], a[0:3], v[148:151], v[48:51]
buffer_load_dwordx4 v5, s[28:31], s54 offen lds
v_mfma_f32_16x16x32_bf16 v[52:55], a[4:7], v[148:151], v[52:55]
ds_read_b64_tr_b16 a[34:35], v7 offset:59648
ds_read_b64_tr_b16 a[36:37], v7 offset:59168
v_mfma_f32_16x16x32_bf16 v[36:39], a[4:7], v[144:147], v[36:39]
ds_read_b64_tr_b16 a[38:39], v7 offset:59680
v_mfma_f32_16x16x32_bf16 v[40:43], a[8:11], v[144:147], v[40:43]
buffer_load_dwordx4 v[128:131], v4, s[16:19], s52 offen sc1
v_mfma_f32_16x16x32_bf16 v[56:59], a[8:11], v[148:151], v[56:59]
ds_read_b64_tr_b16 a[40:41], v7 offset:59200
ds_read_b64_tr_b16 a[42:43], v7 offset:59712
v_mfma_f32_16x16x32_bf16 v[60:63], a[12:15], v[148:151], v[60:63]
ds_read_b64_tr_b16 a[44:45], v7 offset:59232
ds_read_b64_tr_b16 a[46:47], v7 offset:59744
v_mfma_f32_16x16x32_bf16 v[44:47], a[12:15], v[144:147], v[44:47]
s_waitcnt lgkmcnt(8)
v_mfma_f32_16x16x32_bf16 v[64:67], a[16:19], v[144:147], v[64:67]
buffer_load_dwordx4 v6, s[28:31], s54 offen offset:1056 lds
v_mfma_f32_16x16x32_bf16 v[80:83], a[16:19], v[148:151], v[80:83]
ds_read_b64_tr_b16 a[48:49], v10 offset:59136
s_add_u32 s54, s54, 0x10000
v_mfma_f32_16x16x32_bf16 v[84:87], a[20:23], v[148:151], v[84:87]
ds_read_b64_tr_b16 a[50:51], v10 offset:59648
ds_read_b64_tr_b16 a[52:53], v10 offset:59168
v_mfma_f32_16x16x32_bf16 v[68:71], a[20:23], v[144:147], v[68:71]
ds_read_b64_tr_b16 a[54:55], v10 offset:59680
v_mfma_f32_16x16x32_bf16 v[72:75], a[24:27], v[144:147], v[72:75]
buffer_load_dwordx4 v[132:135], v4, s[16:19], s52 offen offset:1024 sc1
v_mfma_f32_16x16x32_bf16 v[88:91], a[24:27], v[148:151], v[88:91]
ds_read_b64_tr_b16 a[56:57], v10 offset:59200
s_add_u32 s52, s52, 0x20000
v_mfma_f32_16x16x32_bf16 v[92:95], a[28:31], v[148:151], v[92:95]
ds_read_b64_tr_b16 a[58:59], v10 offset:59712
ds_read_b64_tr_b16 a[60:61], v10 offset:59232
v_mfma_f32_16x16x32_bf16 v[76:79], a[28:31], v[144:147], v[76:79]
ds_read_b64_tr_b16 a[62:63], v10 offset:59744
v_add_u32 v7, s57, v7
v_add_u32 v10, s57, v10
s_sub_u32 s57, 0, s57
s_waitcnt vmcnt(21) lgkmcnt(8)
v_mfma_f32_16x16x32_bf16 v[32:35], a[32:35], v[152:155], v[32:35]
ds_read_b64_tr_b16 a[0:1], v7
s_add_u32 m0, s55, 42240
v_mfma_f32_16x16x32_bf16 v[48:51], a[32:35], v[156:159], v[48:51]
buffer_load_dwordx4 v5, s[28:31], s54 offen lds
v_mfma_f32_16x16x32_bf16 v[52:55], a[36:39], v[156:159], v[52:55]
ds_read_b64_tr_b16 a[2:3], v7 offset:512
ds_read_b64_tr_b16 a[4:5], v7 offset:32
v_mfma_f32_16x16x32_bf16 v[36:39], a[36:39], v[152:155], v[36:39]
ds_read_b64_tr_b16 a[6:7], v7 offset:544
v_mfma_f32_16x16x32_bf16 v[40:43], a[40:43], v[152:155], v[40:43]
buffer_load_dwordx4 v[136:139], v4, s[16:19], s52 offen sc1
v_mfma_f32_16x16x32_bf16 v[56:59], a[40:43], v[156:159], v[56:59]
ds_read_b64_tr_b16 a[8:9], v7 offset:64
ds_read_b64_tr_b16 a[10:11], v7 offset:576
v_mfma_f32_16x16x32_bf16 v[60:63], a[44:47], v[156:159], v[60:63]
ds_read_b64_tr_b16 a[12:13], v7 offset:96
ds_read_b64_tr_b16 a[14:15], v7 offset:608
v_mfma_f32_16x16x32_bf16 v[44:47], a[44:47], v[152:155], v[44:47]
s_waitcnt lgkmcnt(8)
v_mfma_f32_16x16x32_bf16 v[64:67], a[48:51], v[152:155], v[64:67]
buffer_load_dwordx4 v6, s[28:31], s54 offen offset:1056 lds
v_mfma_f32_16x16x32_bf16 v[80:83], a[48:51], v[156:159], v[80:83]
ds_read_b64_tr_b16 a[16:17], v10
s_add_u32 s54, s54, 0x10000
v_mfma_f32_16x16x32_bf16 v[84:87], a[52:55], v[156:159], v[84:87]
ds_read_b64_tr_b16 a[18:19], v10 offset:512
ds_read_b64_tr_b16 a[20:21], v10 offset:32
v_mfma_f32_16x16x32_bf16 v[68:71], a[52:55], v[152:155], v[68:71]
ds_read_b64_tr_b16 a[22:23], v10 offset:544
v_mfma_f32_16x16x32_bf16 v[72:75], a[56:59], v[152:155], v[72:75]
buffer_load_dwordx4 v[140:143], v4, s[16:19], s52 offen offset:1024 sc1
v_mfma_f32_16x16x32_bf16 v[88:91], a[56:59], v[156:159], v[88:91]
ds_read_b64_tr_b16 a[24:25], v10 offset:64
s_add_u32 s52, s52, 0x20000
.Lpad24:
s_cbranch_execz .Lnopoll78r
v_mfma_f32_16x16x32_bf16 v[92:95], a[60:63], v[156:159], v[92:95]
ds_read_b64_tr_b16 a[26:27], v10 offset:576
ds_read_b64_tr_b16 a[28:29], v10 offset:96
v_mfma_f32_16x16x32_bf16 v[76:79], a[60:63], v[152:155], v[76:79]
ds_read_b64_tr_b16 a[30:31], v10 offset:608
s_mov_b32 s62, s55
s_mov_b32 s55, s56
s_mov_b32 s56, s62
s_add_u32 s15, s15, 1
s_cbranch_scc0 .Lk80
s_waitcnt vmcnt(20) lgkmcnt(8)
s_barrier
v_mfma_f32_16x16x32_bf16 v[32:35], a[0:3], v[96:99], v[32:35]
ds_read_b64_tr_b16 a[32:33], v7 offset:8448
s_add_u32 m0, s56, 50688
v_mfma_f32_16x16x32_bf16 v[48:51], a[0:3], v[100:103], v[48:51]
buffer_load_dwordx4 v5, s[28:31], s54 offen lds
v_mfma_f32_16x16x32_bf16 v[52:55], a[4:7], v[100:103], v[52:55]
ds_read_b64_tr_b16 a[34:35], v7 offset:8960
ds_read_b64_tr_b16 a[36:37], v7 offset:8480
v_mfma_f32_16x16x32_bf16 v[36:39], a[4:7], v[96:99], v[36:39]
ds_read_b64_tr_b16 a[38:39], v7 offset:8992
v_mfma_f32_16x16x32_bf16 v[40:43], a[8:11], v[96:99], v[40:43]
buffer_load_dwordx4 v[144:147], v4, s[16:19], s52 offen sc1
v_mfma_f32_16x16x32_bf16 v[56:59], a[8:11], v[100:103], v[56:59]
ds_read_b64_tr_b16 a[40:41], v7 offset:8512
ds_read_b64_tr_b16 a[42:43], v7 offset:9024
v_mfma_f32_16x16x32_bf16 v[60:63], a[12:15], v[100:103], v[60:63]
ds_read_b64_tr_b16 a[44:45], v7 offset:8544
ds_read_b64_tr_b16 a[46:47], v7 offset:9056
v_mfma_f32_16x16x32_bf16 v[44:47], a[12:15], v[96:99], v[44:47]
s_waitcnt lgkmcnt(8)
v_mfma_f32_16x16x32_bf16 v[64:67], a[16:19], v[96:99], v[64:67]
buffer_load_dwordx4 v6, s[28:31], s54 offen offset:1056 lds
v_mfma_f32_16x16x32_bf16 v[80:83], a[16:19], v[100:103], v[80:83]
ds_read_b64_tr_b16 a[48:49], v10 offset:8448
s_add_u32 s54, s54, 0x10000
v_mfma_f32_16x16x32_bf16 v[84:87], a[20:23], v[100:103], v[84:87]
ds_read_b64_tr_b16 a[50:51], v10 offset:8960
ds_read_b64_tr_b16 a[52:53], v10 offset:8480
v_mfma_f32_16x16x32_bf16 v[68:71], a[20:23], v[96:99], v[68:71]
ds_read_b64_tr_b16 a[54:55], v10 offset:8992
v_mfma_f32_16x16x32_bf16 v[72:75], a[24:27], v[96:99], v[72:75]
buffer_load_dwordx4 v[148:151], v4, s[16:19], s52 offen offset:1024 sc1
v_mfma_f32_16x16x32_bf16 v[88:91], a[24:27], v[100:103], v[88:91]
ds_read_b64_tr_b16 a[56:57], v10 offset:8512
s_add_u32 s52, s52, 0x20000
v_mfma_f32_16x16x32_bf16 v[92:95], a[28:31], v[100:103], v[92:95]
ds_read_b64_tr_b16 a[58:59], v10 offset:9024
ds_read_b64_tr_b16 a[60:61], v10 offset:8544
v_mfma_f32_16x16x32_bf16 v[76:79], a[28:31], v[96:99], v[76:79]
ds_read_b64_tr_b16 a[62:63], v10 offset:9056
s_waitcnt vmcnt(20) lgkmcnt(8)
v_mfma_f32_16x16x32_bf16 v[32:35], a[32:35], v[104:107], v[32:35]
ds_read_b64_tr_b16 a[0:1], v7 offset:16896
s_add_u32 m0, s56, 59136
v_mfma_f32_16x16x32_bf16 v[48:51], a[32:35], v[108:111], v[48:51]
buffer_load_dwordx4 v5, s[28:31], s54 offen lds
v_mfma_f32_16x16x32_bf16 v[52:55], a[36:39], v[108:111], v[52:55]
ds_read_b64_tr_b16 a[2:3], v7 offset:17408
ds_read_b64_tr_b16 a[4:5], v7 offset:16928
v_mfma_f32_16x16x32_bf16 v[36:39], a[36:39], v[104:107], v[36:39]
ds_read_b64_tr_b16 a[6:7], v7 offset:17440
v_mfma_f32_16x16x32_bf16 v[40:43], a[40:43], v[104:107], v[40:43]
buffer_load_dwordx4 v[152:155], v4, s[16:19], s52 offen sc1
v_mfma_f32_16x16x32_bf16 v[56:59], a[40:43], v[108:111], v[56:59]
ds_read_b64_tr_b16 a[8:9], v7 offset:16960
ds_read_b64_tr_b16 a[10:11], v7 offset:17472
v_mfma_f32_16x16x32_bf16 v[60:63], a[44:47], v[108:111], v[60:63]
ds_read_b64_tr_b16 a[12:13], v7 offset:16992
ds_read_b64_tr_b16 a[14:15], v7 offset:17504
v_mfma_f32_16x16x32_bf16 v[44:47], a[44:47], v[104:107], v[44:47]
s_waitcnt lgkmcnt(8)
v_mfma_f32_16x16x32_bf16 v[64:67], a[48:51], v[104:107], v[64:67]
buffer_load_dwordx4 v6, s[28:31], s54 offen offset:1056 lds
v_mfma_f32_16x16x32_bf16 v[80:83], a[48:51], v[108:111], v[80:83]
ds_read_b64_tr_b16 a[16:17], v10 offset:16896
s_add_u32 s54, s54, 0x10000
v_mfma_f32_16x16x32_bf16 v[84:87], a[52:55], v[108:111], v[84:87]
ds_read_b64_tr_b16 a[18:19], v10 offset:17408
ds_read_b64_tr_b16 a[20:21], v10 offset:16928
v_mfma_f32_16x16x32_bf16 v[68:71], a[52:55], v[104:107], v[68:71]
ds_read_b64_tr_b16 a[22:23], v10 offset:17440
v_mfma_f32_16x16x32_bf16 v[72:75], a[56:59], v[104:107], v[72:75]
buffer_load_dwordx4 v[156:159], v4, s[16:19], s52 offen offset:1024 sc1
v_mfma_f32_16x16x32_bf16 v[88:91], a[56:59], v[108:111], v[88:91]
ds_read_b64_tr_b16 a[24:25], v10 offset:16960
s_add_u32 s52, s52, 0x20000
v_mfma_f32_16x16x32_bf16 v[92:95], a[60:63], v[108:111], v[92:95]
ds_read_b64_tr_b16 a[26:27], v10 offset:17472
ds_read_b64_tr_b16 a[28:29], v10 offset:16992
v_mfma_f32_16x16x32_bf16 v[76:79], a[60:63], v[104:107], v[76:79]
ds_read_b64_tr_b16 a[30:31], v10 offset:17504
s_waitcnt vmcnt(20) lgkmcnt(8)
s_barrier
v_mfma_f32_16x16x32_bf16 v[32:35], a[0:3], v[112:115], v[32:35]
ds_read_b64_tr_b16 a[32:33], v7 offset:25344
s_add_u32 m0, s55, 0
v_mfma_f32_16x16x32_bf16 v[48:51], a[0:3], v[116:119], v[48:51]
buffer_load_dwordx4 v5, s[28:31], s54 offen lds
v_mfma_f32_16x16x32_bf16 v[52:55], a[4:7], v[116:119], v[52:55]
ds_read_b64_tr_b16 a[34:35], v7 offset:25856
ds_read_b64_tr_b16 a[36:37], v7 offset:25376
v_mfma_f32_16x16x32_bf16 v[36:39], a[4:7], v[112:115], v[36:39]
ds_read_b64_tr_b16 a[38:39], v7 offset:25888
v_mfma_f32_16x16x32_bf16 v[40:43], a[8:11], v[112:115], v[40:43]
buffer_load_dwordx4 v[96:99], v4, s[16:19], s52 offen sc1
v_mfma_f32_16x16x32_bf16 v[56:59], a[8:11], v[116:119], v[56:59]
ds_read_b64_tr_b16 a[40:41], v7 offset:25408
ds_read_b64_tr_b16 a[42:43], v7 offset:25920
v_mfma_f32_16x16x32_bf16 v[60:63], a[12:15], v[116:119], v[60:63]
ds_read_b64_tr_b16 a[44:45], v7 offset:25440
ds_read_b64_tr_b16 a[46:47], v7 offset:25952
v_mfma_f32_16x16x32_bf16 v[44:47], a[12:15], v[112:115], v[44:47]
s_waitcnt lgkmcnt(8)
v_mfma_f32_16x16x32_bf16 v[64:67], a[16:19], v[112:115], v[64:67]
buffer_load_dwordx4 v6, s[28:31], s54 offen offset:1056 lds
v_mfma_f32_16x16x32_bf16 v[80:83], a[16:19], v[116:119], v[80:83]
ds_read_b64_tr_b16 a[48:49], v10 offset:25344
s_add_u32 s54, s54, 0x10000
v_mfma_f32_16x16x32_bf16 v[84:87], a[20:23], v[116:119], v[84:87]
ds_read_b64_tr_b16 a[50:51], v10 offset:25856
ds_read_b64_tr_b16 a[52:53], v10 offset:25376
v_mfma_f32_16x16x32_bf16 v[68:71], a[20:23], v[112:115], v[68:71]
ds_read_b64_tr_b16 a[54:55], v10 offset:25888
v_mfma_f32_16x16x32_bf16 v[72:75], a[24:27], v[112:115], v[72:75]
buffer_load_dwordx4 v[100:103], v4, s[16:19], s52 offen offset:1024 sc1
v_mfma_f32_16x16x32_bf16 v[88:91], a[24:27], v[116:119], v[88:91]
ds_read_b64_tr_b16 a[56:57], v10 offset:25408
s_add_u32 s52, s52, 0x20000
v_mfma_f32_16x16x32_bf16 v[92:95], a[28:31], v[116:119], v[92:95]
ds_read_b64_tr_b16 a[58:59], v10 offset:25920
ds_read_b64_tr_b16 a[60:61], v10 offset:25440
v_mfma_f32_16x16x32_bf16 v[76:79], a[28:31], v[112:115], v[76:79]
ds_read_b64_tr_b16 a[62:63], v10 offset:25952
s_waitcnt vmcnt(20) lgkmcnt(8)
v_mfma_f32_16x16x32_bf16 v[32:35], a[32:35], v[120:123], v[32:35]
ds_read_b64_tr_b16 a[0:1], v7 offset:33792
s_add_u32 m0, s55, 8448
v_mfma_f32_16x16x32_bf16 v[48:51], a[32:35], v[124:127], v[48:51]
buffer_load_dwordx4 v5, s[28:31], s54 offen lds
v_mfma_f32_16x16x32_bf16 v[52:55], a[36:39], v[124:127], v[52:55]
ds_read_b64_tr_b16 a[2:3], v7 offset:34304
ds_read_b64_tr_b16 a[4:5], v7 offset:33824
v_mfma_f32_16x16x32_bf16 v[36:39], a[36:39], v[120:123], v[36:39]
ds_read_b64_tr_b16 a[6:7], v7 offset:34336
v_mfma_f32_16x16x32_bf16 v[40:43], a[40:43], v[120:123], v[40:43]
buffer_load_dwordx4 v[104:107], v4, s[16:19], s52 offen sc1
v_mfma_f32_16x16x32_bf16 v[56:59], a[40:43], v[124:127], v[56:59]
ds_read_b64_tr_b16 a[8:9], v7 offset:33856
ds_read_b64_tr_b16 a[10:11], v7 offset:34368
v_mfma_f32_16x16x32_bf16 v[60:63], a[44:47], v[124:127], v[60:63]
ds_read_b64_tr_b16 a[12:13], v7 offset:33888
ds_read_b64_tr_b16 a[14:15], v7 offset:34400
v_mfma_f32_16x16x32_bf16 v[44:47], a[44:47], v[120:123], v[44:47]
s_waitcnt lgkmcnt(8)
v_mfma_f32_16x16x32_bf16 v[64:67], a[48:51], v[120:123], v[64:67]
buffer_load_dwordx4 v6, s[28:31], s54 offen offset:1056 lds
v_mfma_f32_16x16x32_bf16 v[80:83], a[48:51], v[124:127], v[80:83]
ds_read_b64_tr_b16 a[16:17], v10 offset:33792
s_add_u32 s54, s54, 0x10000
v_mfma_f32_16x16x32_bf16 v[84:87], a[52:55], v[124:127], v[84:87]
ds_read_b64_tr_b16 a[18:19], v10 offset:34304
ds_read_b64_tr_b16 a[20:21], v10 offset:33824
v_mfma_f32_16x16x32_bf16 v[68:71], a[52:55], v[120:123], v[68:71]
ds_read_b64_tr_b16 a[22:23], v10 offset:34336
v_mfma_f32_16x16x32_bf16 v[72:75], a[56:59], v[120:123], v[72:75]
buffer_load_dwordx4 v[108:111], v4, s[16:19], s52 offen offset:1024 sc1
v_mfma_f32_16x16x32_bf16 v[88:91], a[56:59], v[124:127], v[88:91]
ds_read_b64_tr_b16 a[24:25], v10 offset:33856
s_add_u32 s52, s52, 0x20000
v_mfma_f32_16x16x32_bf16 v[92:95], a[60:63], v[124:127], v[92:95]
ds_read_b64_tr_b16 a[26:27], v10 offset:34368
ds_read_b64_tr_b16 a[28:29], v10 offset:33888
v_mfma_f32_16x16x32_bf16 v[76:79], a[60:63], v[120:123], v[76:79]
ds_read_b64_tr_b16 a[30:31], v10 offset:34400
s_waitcnt vmcnt(20) lgkmcnt(8)
s_barrier
v_mfma_f32_16x16x32_bf16 v[32:35], a[0:3], v[128:131], v[32:35]
ds_read_b64_tr_b16 a[32:33], v7 offset:42240
s_add_u32 m0, s55, 16896
v_mfma_f32_16x16x32_bf16 v[48:51], a[0:3], v[132:135], v[48:51]
buffer_load_dwordx4 v5, s[28:31], s54 offen lds
v_mfma_f32_16x16x32_bf16 v[52:55], a[4:7], v[132:135], v[52:55]
ds_read_b64_tr_b16 a[34:35], v7 offset:42752
ds_read_b64_tr_b16 a[36:37], v7 offset:42272
v_mfma_f32_16x16x32_bf16 v[36:39], a[4:7], v[128:131], v[36:39]
ds_read_b64_tr_b16 a[38:39], v7 offset:42784
v_mfma_f32_16x16x32_bf16 v[40:43], a[8:11], v[128:131], v[40:43]
buffer_load_dwordx4 v[112:115], v4, s[16:19], s52 offen sc1
v_mfma_f32_16x16x32_bf16 v[56:59], a[8:11], v[132:135], v[56:59]
ds_read_b64_tr_b16 a[40:41], v7 offset:42304
ds_read_b64_tr_b16 a[42:43], v7 offset:42816
v_mfma_f32_16x16x32_bf16 v[60:63], a[12:15], v[132:135], v[60:63]
ds_read_b64_tr_b16 a[44:45], v7 offset:42336
ds_read_b64_tr_b16 a[46:47], v7 offset:42848
v_mfma_f32_16x16x32_bf16 v[44:47], a[12:15], v[128:131], v[44:47]
s_waitcnt lgkmcnt(8)
v_mfma_f32_16x16x32_bf16 v[64:67], a[16:19], v[128:131], v[64:67]
buffer_load_dwordx4 v6, s[28:31], s54 offen offset:1056 lds
v_mfma_f32_16x16x32_bf16 v[80:83], a[16:19], v[132:135], v[80:83]
ds_read_b64_tr_b16 a[48:49], v10 offset:42240
s_add_u32 s54, s54, 0x10000
v_mfma_f32_16x16x32_bf16 v[84:87], a[20:23], v[132:135], v[84:87]
ds_read_b64_tr_b16 a[50:51], v10 offset:42752
ds_read_b64_tr_b16 a[52:53], v10 offset:42272
v_mfma_f32_16x16x32_bf16 v[68:71], a[20:23], v[128:131], v[68:71]
ds_read_b64_tr_b16 a[54:55], v10 offset:42784
v_mfma_f32_16x16x32_bf16 v[72:75], a[24:27], v[128:131], v[72:75]
buffer_load_dwordx4 v[116:119], v4, s[16:19], s52 offen offset:1024 sc1
v_mfma_f32_16x16x32_bf16 v[88:91], a[24:27], v[132:135], v[88:91]
ds_read_b64_tr_b16 a[56:57], v10 offset:42304
s_add_u32 s52, s52, 0x20000
v_mfma_f32_16x16x32_bf16 v[92:95], a[28:31], v[132:135], v[92:95]
ds_read_b64_tr_b16 a[58:59], v10 offset:42816
ds_read_b64_tr_b16 a[60:61], v10 offset:42336
v_mfma_f32_16x16x32_bf16 v[76:79], a[28:31], v[128:131], v[76:79]
ds_read_b64_tr_b16 a[62:63], v10 offset:42848
s_waitcnt vmcnt(20) lgkmcnt(8)
v_mfma_f32_16x16x32_bf16 v[32:35], a[32:35], v[136:139], v[32:35]
ds_read_b64_tr_b16 a[0:1], v7 offset:50688
s_add_u32 m0, s55, 25344
v_mfma_f32_16x16x32_bf16 v[48:51], a[32:35], v[140:143], v[48:51]
buffer_load_dwordx4 v5, s[28:31], s54 offen lds
v_mfma_f32_16x16x32_bf16 v[52:55], a[36:39], v[140:143], v[52:55]
ds_read_b64_tr_b16 a[2:3], v7 offset:51200
ds_read_b64_tr_b16 a[4:5], v7 offset:50720
v_mfma_f32_16x16x32_bf16 v[36:39], a[36:39], v[136:139], v[36:39]
ds_read_b64_tr_b16 a[6:7], v7 offset:51232
v_mfma_f32_16x16x32_bf16 v[40:43], a[40:43], v[136:139], v[40:43]
buffer_load_dwordx4 v[120:123], v4, s[16:19], s52 offen sc1
v_mfma_f32_16x16x32_bf16 v[56:59], a[40:43], v[140:143], v[56:59]
ds_read_b64_tr_b16 a[8:9], v7 offset:50752
ds_read_b64_tr_b16 a[10:11], v7 offset:51264
v_mfma_f32_16x16x32_bf16 v[60:63], a[44:47], v[140:143], v[60:63]
ds_read_b64_tr_b16 a[12:13], v7 offset:50784
ds_read_b64_tr_b16 a[14:15], v7 offset:51296
v_mfma_f32_16x16x32_bf16 v[44:47], a[44:47], v[136:139], v[44:47]
s_waitcnt lgkmcnt(8)
v_mfma_f32_16x16x32_bf16 v[64:67], a[48:51], v[136:139], v[64:67]
buffer_load_dwordx4 v6, s[28:31], s54 offen offset:1056 lds
v_mfma_f32_16x16x32_bf16 v[80:83], a[48:51], v[140:143], v[80:83]
ds_read_b64_tr_b16 a[16:17], v10 offset:50688
s_add_u32 s54, s54, 0x10000
v_mfma_f32_16x16x32_bf16 v[84:87], a[52:55], v[140:143], v[84:87]
ds_read_b64_tr_b16 a[18:19], v10 offset:51200
ds_read_b64_tr_b16 a[20:21], v10 offset:50720
v_mfma_f32_16x16x32_bf16 v[68:71], a[52:55], v[136:139], v[68:71]
ds_read_b64_tr_b16 a[22:23], v10 offset:51232
v_mfma_f32_16x16x32_bf16 v[72:75], a[56:59], v[136:139], v[72:75]
buffer_load_dwordx4 v[124:127], v4, s[16:19], s52 offen offset:1024 sc1
v_mfma_f32_16x16x32_bf16 v[88:91], a[56:59], v[140:143], v[88:91]
ds_read_b64_tr_b16 a[24:25], v10 offset:50752
s_add_u32 s52, s52, 0x20000
v_mfma_f32_16x16x32_bf16 v[92:95], a[60:63], v[140:143], v[92:95]
ds_read_b64_tr_b16 a[26:27], v10 offset:51264
ds_read_b64_tr_b16 a[28:29], v10 offset:50784
v_mfma_f32_16x16x32_bf16 v[76:79], a[60:63], v[136:139], v[76:79]
ds_read_b64_tr_b16 a[30:31], v10 offset:51296
s_waitcnt vmcnt(20) lgkmcnt(8)
s_barrier
v_mfma_f32_16x16x32_bf16 v[32:35], a[0:3], v[144:147], v[32:35]
ds_read_b64_tr_b16 a[32:33], v7 offset:59136
s_add_u32 m0, s55, 33792
v_mfma_f32_16x16x32_bf16 v[48:51], a[0:3], v[148:151], v[48:51]
buffer_load_dwordx4 v5, s[28:31], s54 offen lds
v_mfma_f32_16x16x32_bf16 v[52:55], a[4:7], v[148:151], v[52:55]
ds_read_b64_tr_b16 a[34:35], v7 offset:59648
ds_read_b64_tr_b16 a[36:37], v7 offset:59168
v_mfma_f32_16x16x32_bf16 v[36:39], a[4:7], v[144:147], v[36:39]
ds_read_b64_tr_b16 a[38:39], v7 offset:59680
v_mfma_f32_16x16x32_bf16 v[40:43], a[8:11], v[144:147], v[40:43]
buffer_load_dwordx4 v[128:131], v4, s[16:19], s52 offen sc1
v_mfma_f32_16x16x32_bf16 v[56:59], a[8:11], v[148:151], v[56:59]
ds_read_b64_tr_b16 a[40:41], v7 offset:59200
ds_read_b64_tr_b16 a[42:43], v7 offset:59712
v_mfma_f32_16x16x32_bf16 v[60:63], a[12:15], v[148:151], v[60:63]
ds_read_b64_tr_b16 a[44:45], v7 offset:59232
ds_read_b64_tr_b16 a[46:47], v7 offset:59744
v_mfma_f32_16x16x32_bf16 v[44:47], a[12:15], v[144:147], v[44:47]
s_waitcnt lgkmcnt(8)
v_mfma_f32_16x16x32_bf16 v[64:67], a[16:19], v[144:147], v[64:67]
buffer_load_dwordx4 v6, s[28:31], s54 offen offset:1056 lds
v_mfma_f32_16x16x32_bf16 v[80:83], a[16:19], v[148:151], v[80:83]
ds_read_b64_tr_b16 a[48:49], v10 offset:59136
s_add_u32 s54, s54, 0x10000
v_mfma_f32_16x16x32_bf16 v[84:87], a[20:23], v[148:151], v[84:87]
ds_read_b64_tr_b16 a[50:51], v10 offset:59648
ds_read_b64_tr_b16 a[52:53], v10 offset:59168
v_mfma_f32_16x16x32_bf16 v[68:71], a[20:23], v[144:147], v[68:71]
ds_read_b64_tr_b16 a[54:55], v10 offset:59680
v_mfma_f32_16x16x32_bf16 v[72:75], a[24:27], v[144:147], v[72:75]
buffer_load_dwordx4 v[132:135], v4, s[16:19], s52 offen offset:1024 sc1
v_mfma_f32_16x16x32_bf16 v[88:91], a[24:27], v[148:151], v[88:91]
ds_read_b64_tr_b16 a[56:57], v10 offset:59200
s_add_u32 s52, s52, 0x20000
v_mfma_f32_16x16x32_bf16 v[92:95], a[28:31], v[148:151], v[92:95]
ds_read_b64_tr_b16 a[58:59], v10 offset:59712
ds_read_b64_tr_b16 a[60:61], v10 offset:59232
v_mfma_f32_16x16x32_bf16 v[76:79], a[28:31], v[144:147], v[76:79]
ds_read_b64_tr_b16 a[62:63], v10 offset:59744
v_add_u32 v7, s57, v7
v_add_u32 v10, s57, v10
s_sub_u32 s57, 0, s57
s_waitcnt vmcnt(20) lgkmcnt(8)
v_mfma_f32_16x16x32_bf16 v[32:35], a[32:35], v[152:155], v[32:35]
ds_read_b64_tr_b16 a[0:1], v10
s_add_u32 m0, s55, 42240
v_mfma_f32_16x16x32_bf16 v[48:51], a[32:35], v[156:159], v[48:51]
buffer_load_dwordx4 v5, s[28:31], s54 offen lds
v_mfma_f32_16x16x32_bf16 v[52:55], a[36:39], v[156:159], v[52:55]
ds_read_b64_tr_b16 a[2:3], v10 offset:512
ds_read_b64_tr_b16 a[4:5], v10 offset:32
v_mfma_f32_16x16x32_bf16 v[36:39], a[36:39], v[152:155], v[36:39]
ds_read_b64_tr_b16 a[6:7], v10 offset:544
v_mfma_f32_16x16x32_bf16 v[40:43], a[40:43], v[152:155], v[40:43]
buffer_load_dwordx4 v[136:139], v4, s[16:19], s52 offen sc1
v_mfma_f32_16x16x32_bf16 v[56:59], a[40:43], v[156:159], v[56:59]
ds_read_b64_tr_b16 a[8:9], v10 offset:64
ds_read_b64_tr_b16 a[10:11], v10 offset:576
v_mfma_f32_16x16x32_bf16 v[60:63], a[44:47], v[156:159], v[60:63]
ds_read_b64_tr_b16 a[12:13], v10 offset:96
ds_read_b64_tr_b16 a[14:15], v10 offset:608
v_mfma_f32_16x16x32_bf16 v[44:47], a[44:47], v[152:155], v[44:47]
s_waitcnt lgkmcnt(8)
v_mfma_f32_16x16x32_bf16 v[64:67], a[48:51], v[152:155], v[64:67]
buffer_load_dwordx4 v6, s[28:31], s54 offen offset:1056 lds
v_mfma_f32_16x16x32_bf16 v[80:83], a[48:51], v[156:159], v[80:83]
ds_read_b64_tr_b16 a[16:17], v10 offset:8448
s_add_u32 s54, s54, 0x10000
v_mfma_f32_16x16x32_bf16 v[84:87], a[52:55], v[156:159], v[84:87]
ds_read_b64_tr_b16 a[18:19], v10 offset:8960
ds_read_b64_tr_b16 a[20:21], v10 offset:8480
v_mfma_f32_16x16x32_bf16 v[68:71], a[52:55], v[152:155], v[68:71]
ds_read_b64_tr_b16 a[22:23], v10 offset:8992
v_mfma_f32_16x16x32_bf16 v[72:75], a[56:59], v[152:155], v[72:75]
buffer_load_dwordx4 v[140:143], v4, s[16:19], s52 offen offset:1024 sc1
v_mfma_f32_16x16x32_bf16 v[88:91], a[56:59], v[156:159], v[88:91]
ds_read_b64_tr_b16 a[24:25], v10 offset:8512
s_add_u32 s52, s52, 0x20000
v_mfma_f32_16x16x32_bf16 v[92:95], a[60:63], v[156:159], v[92:95]
ds_read_b64_tr_b16 a[26:27], v10 offset:9024
ds_read_b64_tr_b16 a[28:29], v10 offset:8544
v_mfma_f32_16x16x32_bf16 v[76:79], a[60:63], v[152:155], v[76:79]
ds_read_b64_tr_b16 a[30:31], v10 offset:9056
s_mov_b32 s62, s55
s_mov_b32 s55, s56
s_mov_b32 s56, s62
s_waitcnt vmcnt(20) lgkmcnt(8)
s_barrier
v_mfma_f32_16x16x32_bf16 v[64:67], a[0:3], v[96:99], v[64:67]
ds_read_b64_tr_b16 a[32:33], v10 offset:16896
ds_read_b64_tr_b16 a[34:35], v10 offset:17408
s_add_u32 m0, s56, 50688
v_mfma_f32_16x16x32_bf16 v[80:83], a[0:3], v[100:103], v[80:83]
ds_read_b64_tr_b16 a[36:37], v10 offset:16928
buffer_load_dwordx4 v5, s[28:31], s54 offen lds
v_mfma_f32_16x16x32_bf16 v[84:87], a[4:7], v[100:103], v[84:87]
buffer_load_dwordx4 v6, s[28:31], s54 offen offset:1056 lds
v_mfma_f32_16x16x32_bf16 v[68:71], a[4:7], v[96:99], v[68:71]
ds_read_b64_tr_b16 a[38:39], v10 offset:17440
ds_read_b64_tr_b16 a[40:41], v10 offset:16960
s_add_u32 s54, s54, 0x10000
v_mfma_f32_16x16x32_bf16 v[72:75], a[8:11], v[96:99], v[72:75]
buffer_load_dwordx4 v[144:147], v4, s[16:19], s52 offen sc1
v_mfma_f32_16x16x32_bf16 v[88:91], a[8:11], v[100:103], v[88:91]
ds_read_b64_tr_b16 a[42:43], v10 offset:17472
ds_read_b64_tr_b16 a[44:45], v10 offset:16992
v_mfma_f32_16x16x32_bf16 v[92:95], a[12:15], v[100:103], v[92:95]
buffer_load_dwordx4 v[148:151], v4, s[16:19], s52 offen offset:1024 sc1
v_mfma_f32_16x16x32_bf16 v[76:79], a[12:15], v[96:99], v[76:79]
ds_read_b64_tr_b16 a[46:47], v10 offset:17504
s_add_u32 s52, s52, 0x20000
s_add_u32 m0, s56, 59136
s_waitcnt vmcnt(20) lgkmcnt(8)
v_mfma_f32_16x16x32_bf16 v[64:67], a[16:19], v[104:107], v[64:67]
ds_read_b64_tr_b16 a[48:49], v10 offset:25344
buffer_load_dwordx4 v5, s[28:31], s54 offen lds
v_mfma_f32_16x16x32_bf16 v[80:83], a[16:19], v[108:111], v[80:83]
ds_read_b64_tr_b16 a[50:51], v10 offset:25856
v_mfma_f32_16x16x32_bf16 v[84:87], a[20:23], v[108:111], v[84:87]
ds_read_b64_tr_b16 a[52:53], v10 offset:25376
buffer_load_dwordx4 v6, s[28:31], s54 offen offset:1056 lds
v_mfma_f32_16x16x32_bf16 v[68:71], a[20:23], v[104:107], v[68:71]
ds_read_b64_tr_b16 a[54:55], v10 offset:25888
s_add_u32 s54, s54, 0x10000
v_mfma_f32_16x16x32_bf16 v[72:75], a[24:27], v[104:107], v[72:75]
ds_read_b64_tr_b16 a[56:57], v10 offset:25408
buffer_load_dwordx4 v[152:155], v4, s[16:19], s52 offen sc1
v_mfma_f32_16x16x32_bf16 v[88:91], a[24:27], v[108:111], v[88:91]
ds_read_b64_tr_b16 a[58:59], v10 offset:25920
v_mfma_f32_16x16x32_bf16 v[92:95], a[28:31], v[108:111], v[92:95]
ds_read_b64_tr_b16 a[60:61], v10 offset:25440
buffer_load_dwordx4 v[156:159], v4, s[16:19], s52 offen offset:1024 sc1
v_mfma_f32_16x16x32_bf16 v[76:79], a[28:31], v[104:107], v[76:79]
ds_read_b64_tr_b16 a[62:63], v10 offset:25952
s_add_u32 s52, s52, 0x20000
s_waitcnt vmcnt(20) lgkmcnt(8)
v_mfma_f32_16x16x32_bf16 v[64:67], a[32:35], v[112:115], v[64:67]
ds_read_b64_tr_b16 a[0:1], v10 offset:33792
ds_read_b64_tr_b16 a[2:3], v10 offset:34304
v_mfma_f32_16x16x32_bf16 v[80:83], a[32:35], v[116:119], v[80:83]
buffer_load_dwordx4 v[160:163], v4, s[16:19], s52 offen sc1
v_mfma_f32_16x16x32_bf16 v[84:87], a[36:39], v[116:119], v[84:87]
ds_read_b64_tr_b16 a[4:5], v10 offset:33824
ds_read_b64_tr_b16 a[6:7], v10 offset:34336
v_mfma_f32_16x16x32_bf16 v[68:71], a[36:39], v[112:115], v[68:71]
ds_read_b64_tr_b16 a[8:9], v10 offset:33856
v_mfma_f32_16x16x32_bf16 v[72:75], a[40:43], v[112:115], v[72:75]
buffer_load_dwordx4 v[164:167], v4, s[16:19], s52 offen offset:1024 sc1
v_mfma_f32_16x16x32_bf16 v[88:91], a[40:43], v[116:119], v[88:91]
ds_read_b64_tr_b16 a[10:11], v10 offset:34368
s_add_u32 s52, s52, 0x20000
v_mfma_f32_16x16x32_bf16 v[92:95], a[44:47], v[116:119], v[92:95]
ds_read_b64_tr_b16 a[12:13], v10 offset:33888
v_mfma_f32_16x16x32_bf16 v[76:79], a[44:47], v[112:115], v[76:79]
ds_read_b64_tr_b16 a[14:15], v10 offset:34400
s_waitcnt vmcnt(18) lgkmcnt(8)
v_mfma_f32_16x16x32_bf16 v[64:67], a[48:51], v[120:123], v[64:67]
buffer_load_dwordx4 v[168:171], v4, s[16:19], s52 offen sc1
v_mfma_f32_16x16x32_bf16 v[80:83], a[48:51], v[124:127], v[80:83]
ds_read_b64_tr_b16 a[16:17], v10 offset:42240
ds_read_b64_tr_b16 a[18:19], v10 offset:42752
v_mfma_f32_16x16x32_bf16 v[84:87], a[52:55], v[124:127], v[84:87]
ds_read_b64_tr_b16 a[20:21], v10 offset:42272
v_mfma_f32_16x16x32_bf16 v[68:71], a[52:55], v[120:123], v[68:71]
ds_read_b64_tr_b16 a[22:23], v10 offset:42784
ds_read_b64_tr_b16 a[24:25], v10 offset:42304
v_mfma_f32_16x16x32_bf16 v[72:75], a[56:59], v[120:123], v[72:75]
buffer_load_dwordx4 v[172:175], v4, s[16:19], s52 offen offset:1024 sc1
v_mfma_f32_16x16x32_bf16 v[88:91], a[56:59], v[124:127], v[88:91]
s_add_u32 s52, s52, 0x20000
v_mfma_f32_16x16x32_bf16 v[92:95], a[60:63], v[124:127], v[92:95]
ds_read_b64_tr_b16 a[26:27], v10 offset:42816
ds_read_b64_tr_b16 a[28:29], v10 offset:42336
v_mfma_f32_16x16x32_bf16 v[76:79], a[60:63], v[120:123], v[76:79]
ds_read_b64_tr_b16 a[30:31], v10 offset:42848
s_waitcnt vmcnt(16) lgkmcnt(8)
v_mfma_f32_16x16x32_bf16 v[64:67], a[0:3], v[128:131], v[64:67]
ds_read_b64_tr_b16 a[32:33], v10 offset:50688
ds_read_b64_tr_b16 a[34:35], v10 offset:51200
v_mfma_f32_16x16x32_bf16 v[80:83], a[0:3], v[132:135], v[80:83]
buffer_load_dwordx4 v[176:179], v4, s[16:19], s52 offen sc1
v_mfma_f32_16x16x32_bf16 v[84:87], a[4:7], v[132:135], v[84:87]
ds_read_b64_tr_b16 a[36:37], v10 offset:50720
ds_read_b64_tr_b16 a[38:39], v10 offset:51232
v_mfma_f32_16x16x32_bf16 v[68:71], a[4:7], v[128:131], v[68:71]
ds_read_b64_tr_b16 a[40:41], v10 offset:50752
v_mfma_f32_16x16x32_bf16 v[72:75], a[8:11], v[128:131], v[72:75]
buffer_load_dwordx4 v[180:183], v4, s[16:19], s52 offen offset:1024 sc1
v_mfma_f32_16x16x32_bf16 v[88:91], a[8:11], v[132:135], v[88:91]
ds_read_b64_tr_b16 a[42:43], v10 offset:51264
s_add_u32 s52, s52, 0x20000
v_mfma_f32_16x16x32_bf16 v[92:95], a[12:15], v[132:135], v[92:95]
ds_read_b64_tr_b16 a[44:45], v10 offset:50784
v_mfma_f32_16x16x32_bf16 v[76:79], a[12:15], v[128:131], v[76:79]
ds_read_b64_tr_b16 a[46:47], v10 offset:51296
s_waitcnt vmcnt(14) lgkmcnt(8)
v_mfma_f32_16x16x32_bf16 v[64:67], a[16:19], v[136:139], v[64:67]
buffer_load_dwordx4 v[184:187], v4, s[16:19], s52 offen sc1
v_mfma_f32_16x16x32_bf16 v[80:83], a[16:19], v[140:143], v[80:83]
ds_read_b64_tr_b16 a[48:49], v10 offset:59136
ds_read_b64_tr_b16 a[50:51], v10 offset:59648
v_mfma_f32_16x16x32_bf16 v[84:87], a[20:23], v[140:143], v[84:87]
ds_read_b64_tr_b16 a[52:53], v10 offset:59168
v_mfma_f32_16x16x32_bf16 v[68:71], a[20:23], v[136:139], v[68:71]
ds_read_b64_tr_b16 a[54:55], v10 offset:59680
ds_read_b64_tr_b16 a[56:57], v10 offset:59200
v_mfma_f32_16x16x32_bf16 v[72:75], a[24:27], v[136:139], v[72:75]
buffer_load_dwordx4 v[188:191], v4, s[16:19], s52 offen offset:1024 sc1
v_mfma_f32_16x16x32_bf16 v[88:91], a[24:27], v[140:143], v[88:91]
s_add_u32 s52, s52, 0x20000
v_mfma_f32_16x16x32_bf16 v[92:95], a[28:31], v[140:143], v[92:95]
ds_read_b64_tr_b16 a[58:59], v10 offset:59712
ds_read_b64_tr_b16 a[60:61], v10 offset:59232
v_mfma_f32_16x16x32_bf16 v[76:79], a[28:31], v[136:139], v[76:79]
ds_read_b64_tr_b16 a[62:63], v10 offset:59744
s_waitcnt vmcnt(10) lgkmcnt(8)
s_barrier
v_add_u32 v10, s57, v10
v_mfma_f32_16x16x32_bf16 v[64:67], a[32:35], v[144:147], v[64:67]
ds_read_b64_tr_b16 a[0:1], v10
ds_read_b64_tr_b16 a[2:3], v10 offset:512
v_mfma_f32_16x16x32_bf16 v[80:83], a[32:35], v[148:151], v[80:83]
buffer_load_dwordx4 v[192:195], v4, s[16:19], s52 offen sc1
v_mfma_f32_16x16x32_bf16 v[84:87], a[36:39], v[148:151], v[84:87]
ds_read_b64_tr_b16 a[4:5], v10 offset:32
ds_read_b64_tr_b16 a[6:7], v10 offset:544
v_mfma_f32_16x16x32_bf16 v[68:71], a[36:39], v[144:147], v[68:71]
ds_read_b64_tr_b16 a[8:9], v10 offset:64
v_mfma_f32_16x16x32_bf16 v[72:75], a[40:43], v[144:147], v[72:75]
buffer_load_dwordx4 v[196:199], v4, s[16:19], s52 offen offset:1024 sc1
v_mfma_f32_16x16x32_bf16 v[88:91], a[40:43], v[148:151], v[88:91]
ds_read_b64_tr_b16 a[10:11], v10 offset:576
s_add_u32 s52, s52, 0x20000
v_mfma_f32_16x16x32_bf16 v[92:95], a[44:47], v[148:151], v[92:95]
ds_read_b64_tr_b16 a[12:13], v10 offset:96
v_mfma_f32_16x16x32_bf16 v[76:79], a[44:47], v[144:147], v[76:79]
ds_read_b64_tr_b16 a[14:15], v10 offset:608
s_waitcnt vmcnt(10) lgkmcnt(8)
v_mfma_f32_16x16x32_bf16 v[64:67], a[48:51], v[152:155], v[64:67]
buffer_load_dwordx4 v[200:203], v4, s[16:19], s52 offen sc1
v_mfma_f32_16x16x32_bf16 v[80:83], a[48:51], v[156:159], v[80:83]
ds_read_b64_tr_b16 a[16:17], v10 offset:8448
ds_read_b64_tr_b16 a[18:19], v10 offset:8960
v_mfma_f32_16x16x32_bf16 v[84:87], a[52:55], v[156:159], v[84:87]
ds_read_b64_tr_b16 a[20:21], v10 offset:8480
v_mfma_f32_16x16x32_bf16 v[68:71], a[52:55], v[152:155], v[68:71]
ds_read_b64_tr_b16 a[22:23], v10 offset:8992
ds_read_b64_tr_b16 a[24:25], v10 offset:8512
v_mfma_f32_16x16x32_bf16 v[72:75], a[56:59], v[152:155], v[72:75]
buffer_load_dwordx4 v[204:207], v4, s[16:19], s52 offen offset:1024 sc1
v_mfma_f32_16x16x32_bf16 v[88:91], a[56:59], v[156:159], v[88:91]
s_add_u32 s52, s52, 0x20000
v_mfma_f32_16x16x32_bf16 v[92:95], a[60:63], v[156:159], v[92:95]
ds_read_b64_tr_b16 a[26:27], v10 offset:9024
ds_read_b64_tr_b16 a[28:29], v10 offset:8544
v_mfma_f32_16x16x32_bf16 v[76:79], a[60:63], v[152:155], v[76:79]
ds_read_b64_tr_b16 a[30:31], v10 offset:9056
s_waitcnt vmcnt(10) lgkmcnt(8)
v_mfma_f32_16x16x32_bf16 v[64:67], a[0:3], v[160:163], v[64:67]
ds_read_b64_tr_b16 a[32:33], v10 offset:16896
ds_read_b64_tr_b16 a[34:35], v10 offset:17408
v_mfma_f32_16x16x32_bf16 v[80:83], a[0:3], v[164:167], v[80:83]
buffer_load_dwordx4 v[208:211], v4, s[16:19], s52 offen sc1
v_mfma_f32_16x16x32_bf16 v[84:87], a[4:7], v[164:167], v[84:87]
ds_read_b64_tr_b16 a[36:37], v10 offset:16928
ds_read_b64_tr_b16 a[38:39], v10 offset:17440
v_mfma_f32_16x16x32_bf16 v[68:71], a[4:7], v[160:163], v[68:71]
ds_read_b64_tr_b16 a[40:41], v10 offset:16960
v_mfma_f32_16x16x32_bf16 v[72:75], a[8:11], v[160:163], v[72:75]
buffer_load_dwordx4 v[212:215], v4, s[16:19], s52 offen offset:1024 sc1
v_mfma_f32_16x16x32_bf16 v[88:91], a[8:11], v[164:167], v[88:91]
.Lpad25:
s_cbranch_execz .Lnopoll78r
ds_read_b64_tr_b16 a[42:43], v10 offset:17472
s_add_u32 s52, s52, 0x20000
v_mfma_f32_16x16x32_bf16 v[92:95], a[12:15], v[164:167], v[92:95]
ds_read_b64_tr_b16 a[44:45], v10 offset:16992
v_mfma_f32_16x16x32_bf16 v[76:79], a[12:15], v[160:163], v[76:79]
ds_read_b64_tr_b16 a[46:47], v10 offset:17504
s_waitcnt vmcnt(10) lgkmcnt(8)
v_mfma_f32_16x16x32_bf16 v[64:67], a[16:19], v[168:171], v[64:67]
buffer_load_dwordx4 v[216:219], v4, s[16:19], s52 offen sc1
v_mfma_f32_16x16x32_bf16 v[80:83], a[16:19], v[172:175], v[80:83]
ds_read_b64_tr_b16 a[48:49], v10 offset:25344
ds_read_b64_tr_b16 a[50:51], v10 offset:25856
v_mfma_f32_16x16x32_bf16 v[84:87], a[20:23], v[172:175], v[84:87]
ds_read_b64_tr_b16 a[52:53], v10 offset:25376
v_mfma_f32_16x16x32_bf16 v[68:71], a[20:23], v[168:171], v[68:71]
ds_read_b64_tr_b16 a[54:55], v10 offset:25888
ds_read_b64_tr_b16 a[56:57], v10 offset:25408
v_mfma_f32_16x16x32_bf16 v[72:75], a[24:27], v[168:171], v[72:75]
buffer_load_dwordx4 v[220:223], v4, s[16:19], s52 offen offset:1024 sc1
v_mfma_f32_16x16x32_bf16 v[88:91], a[24:27], v[172:175], v[88:91]
s_add_u32 s52, s52, 0x20000
v_mfma_f32_16x16x32_bf16 v[92:95], a[28:31], v[172:175], v[92:95]
ds_read_b64_tr_b16 a[58:59], v10 offset:25920
ds_read_b64_tr_b16 a[60:61], v10 offset:25440
v_mfma_f32_16x16x32_bf16 v[76:79], a[28:31], v[168:171], v[76:79]
ds_read_b64_tr_b16 a[62:63], v10 offset:25952
s_waitcnt vmcnt(10) lgkmcnt(8)
v_mfma_f32_16x16x32_bf16 v[64:67], a[32:35], v[176:179], v[64:67]
ds_read_b64_tr_b16 a[0:1], v10 offset:33792
v_mfma_f32_16x16x32_bf16 v[80:83], a[32:35], v[180:183], v[80:83]
ds_read_b64_tr_b16 a[2:3], v10 offset:34304
v_mfma_f32_16x16x32_bf16 v[84:87], a[36:39], v[180:183], v[84:87]
ds_read_b64_tr_b16 a[4:5], v10 offset:33824
v_mfma_f32_16x16x32_bf16 v[68:71], a[36:39], v[176:179], v[68:71]
ds_read_b64_tr_b16 a[6:7], v10 offset:34336
v_mfma_f32_16x16x32_bf16 v[72:75], a[40:43], v[176:179], v[72:75]
ds_read_b64_tr_b16 a[8:9], v10 offset:33856
v_mfma_f32_16x16x32_bf16 v[88:91], a[40:43], v[180:183], v[88:91]
ds_read_b64_tr_b16 a[10:11], v10 offset:34368
v_mfma_f32_16x16x32_bf16 v[92:95], a[44:47], v[180:183], v[92:95]
ds_read_b64_tr_b16 a[12:13], v10 offset:33888
v_mfma_f32_16x16x32_bf16 v[76:79], a[44:47], v[176:179], v[76:79]
ds_read_b64_tr_b16 a[14:15], v10 offset:34400
s_waitcnt vmcnt(8) lgkmcnt(8)
v_mfma_f32_16x16x32_bf16 v[64:67], a[48:51], v[184:187], v[64:67]
ds_read_b64_tr_b16 a[16:17], v10 offset:42240
v_mfma_f32_16x16x32_bf16 v[80:83], a[48:51], v[188:191], v[80:83]
ds_read_b64_tr_b16 a[18:19], v10 offset:42752
v_mfma_f32_16x16x32_bf16 v[84:87], a[52:55], v[188:191], v[84:87]
ds_read_b64_tr_b16 a[20:21], v10 offset:42272
v_mfma_f32_16x16x32_bf16 v[68:71], a[52:55], v[184:187], v[68:71]
ds_read_b64_tr_b16 a[22:23], v10 offset:42784
v_mfma_f32_16x16x32_bf16 v[72:75], a[56:59], v[184:187], v[72:75]
ds_read_b64_tr_b16 a[24:25], v10 offset:42304
v_mfma_f32_16x16x32_bf16 v[88:91], a[56:59], v[188:191], v[88:91]
ds_read_b64_tr_b16 a[26:27], v10 offset:42816
v_mfma_f32_16x16x32_bf16 v[92:95], a[60:63], v[188:191], v[92:95]
ds_read_b64_tr_b16 a[28:29], v10 offset:42336
v_mfma_f32_16x16x32_bf16 v[76:79], a[60:63], v[184:187], v[76:79]
ds_read_b64_tr_b16 a[30:31], v10 offset:42848
s_waitcnt vmcnt(6) lgkmcnt(8)
v_mfma_f32_16x16x32_bf16 v[64:67], a[0:3], v[192:195], v[64:67]
ds_read_b64_tr_b16 a[32:33], v10 offset:50688
v_mfma_f32_16x16x32_bf16 v[80:83], a[0:3], v[196:199], v[80:83]
ds_read_b64_tr_b16 a[34:35], v10 offset:51200
v_mfma_f32_16x16x32_bf16 v[84:87], a[4:7], v[196:199], v[84:87]
ds_read_b64_tr_b16 a[36:37], v10 offset:50720
v_mfma_f32_16x16x32_bf16 v[68:71], a[4:7], v[192:195], v[68:71]
ds_read_b64_tr_b16 a[38:39], v10 offset:51232
v_mfma_f32_16x16x32_bf16 v[72:75], a[8:11], v[192:195], v[72:75]
ds_read_b64_tr_b16 a[40:41], v10 offset:50752
v_mfma_f32_16x16x32_bf16 v[88:91], a[8:11], v[196:199], v[88:91]
ds_read_b64_tr_b16 a[42:43], v10 offset:51264
v_mfma_f32_16x16x32_bf16 v[92:95], a[12:15], v[196:199], v[92:95]
ds_read_b64_tr_b16 a[44:45], v10 offset:50784
v_mfma_f32_16x16x32_bf16 v[76:79], a[12:15], v[192:195], v[76:79]
ds_read_b64_tr_b16 a[46:47], v10 offset:51296
s_waitcnt vmcnt(4) lgkmcnt(8)
v_mfma_f32_16x16x32_bf16 v[64:67], a[16:19], v[200:203], v[64:67]
ds_read_b64_tr_b16 a[48:49], v10 offset:59136
v_mfma_f32_16x16x32_bf16 v[80:83], a[16:19], v[204:207], v[80:83]
ds_read_b64_tr_b16 a[50:51], v10 offset:59648
v_mfma_f32_16x16x32_bf16 v[84:87], a[20:23], v[204:207], v[84:87]
ds_read_b64_tr_b16 a[52:53], v10 offset:59168
v_mfma_f32_16x16x32_bf16 v[68:71], a[20:23], v[200:203], v[68:71]
ds_read_b64_tr_b16 a[54:55], v10 offset:59680
v_mfma_f32_16x16x32_bf16 v[72:75], a[24:27], v[200:203], v[72:75]
ds_read_b64_tr_b16 a[56:57], v10 offset:59200
v_mfma_f32_16x16x32_bf16 v[88:91], a[24:27], v[204:207], v[88:91]
ds_read_b64_tr_b16 a[58:59], v10 offset:59712
v_mfma_f32_16x16x32_bf16 v[92:95], a[28:31], v[204:207], v[92:95]
ds_read_b64_tr_b16 a[60:61], v10 offset:59232
v_mfma_f32_16x16x32_bf16 v[76:79], a[28:31], v[200:203], v[76:79]
ds_read_b64_tr_b16 a[62:63], v10 offset:59744
s_waitcnt vmcnt(2) lgkmcnt(8)
v_mfma_f32_16x16x32_bf16 v[64:67], a[32:35], v[208:211], v[64:67]
ds_read_b64_tr_b16 a[0:1], v7
v_mfma_f32_16x16x32_bf16 v[80:83], a[32:35], v[212:215], v[80:83]
ds_read_b64_tr_b16 a[2:3], v7 offset:512
v_mfma_f32_16x16x32_bf16 v[84:87], a[36:39], v[212:215], v[84:87]
ds_read_b64_tr_b16 a[4:5], v7 offset:32
v_mfma_f32_16x16x32_bf16 v[68:71], a[36:39], v[208:211], v[68:71]
ds_read_b64_tr_b16 a[6:7], v7 offset:544
v_mfma_f32_16x16x32_bf16 v[72:75], a[40:43], v[208:211], v[72:75]
ds_read_b64_tr_b16 a[8:9], v7 offset:64
v_mfma_f32_16x16x32_bf16 v[88:91], a[40:43], v[212:215], v[88:91]
ds_read_b64_tr_b16 a[10:11], v7 offset:576
v_mfma_f32_16x16x32_bf16 v[92:95], a[44:47], v[212:215], v[92:95]
ds_read_b64_tr_b16 a[12:13], v7 offset:96
v_mfma_f32_16x16x32_bf16 v[76:79], a[44:47], v[208:211], v[76:79]
ds_read_b64_tr_b16 a[14:15], v7 offset:608
s_waitcnt vmcnt(0) lgkmcnt(8)
v_mfma_f32_16x16x32_bf16 v[64:67], a[48:51], v[216:219], v[64:67]
ds_read_b64_tr_b16 a[16:17], v7 offset:8448
v_mfma_f32_16x16x32_bf16 v[80:83], a[48:51], v[220:223], v[80:83]
ds_read_b64_tr_b16 a[18:19], v7 offset:8960
v_mfma_f32_16x16x32_bf16 v[84:87], a[52:55], v[220:223], v[84:87]
ds_read_b64_tr_b16 a[20:21], v7 offset:8480
v_mfma_f32_16x16x32_bf16 v[68:71], a[52:55], v[216:219], v[68:71]
ds_read_b64_tr_b16 a[22:23], v7 offset:8992
v_mfma_f32_16x16x32_bf16 v[72:75], a[56:59], v[216:219], v[72:75]
ds_read_b64_tr_b16 a[24:25], v7 offset:8512
v_mfma_f32_16x16x32_bf16 v[88:91], a[56:59], v[220:223], v[88:91]
ds_read_b64_tr_b16 a[26:27], v7 offset:9024
v_mfma_f32_16x16x32_bf16 v[92:95], a[60:63], v[220:223], v[92:95]
ds_read_b64_tr_b16 a[28:29], v7 offset:8544
v_mfma_f32_16x16x32_bf16 v[76:79], a[60:63], v[216:219], v[76:79]
ds_read_b64_tr_b16 a[30:31], v7 offset:9056
s_waitcnt lgkmcnt(8)
v_mfma_f32_16x16x32_bf16 v[32:35], a[0:3], v[96:99], v[32:35]
ds_read_b64_tr_b16 a[32:33], v7 offset:16896
v_cvt_pk_bf16_f32 v232, v64, v65
v_cvt_pk_bf16_f32 v233, v66, v67
v_mfma_f32_16x16x32_bf16 v[48:51], a[0:3], v[100:103], v[48:51]
ds_read_b64_tr_b16 a[34:35], v7 offset:17408
v_cvt_pk_bf16_f32 v234, v68, v69
v_mfma_f32_16x16x32_bf16 v[52:55], a[4:7], v[100:103], v[52:55]
ds_read_b64_tr_b16 a[36:37], v7 offset:16928
v_cvt_pk_bf16_f32 v235, v70, v71
buffer_store_dwordx4 v[232:235], v11, s[16:19], s69 offen sc1
v_mfma_f32_16x16x32_bf16 v[36:39], a[4:7], v[96:99], v[36:39]
ds_read_b64_tr_b16 a[38:39], v7 offset:17440
s_add_u32 s69, s69, 131072
v_mfma_f32_16x16x32_bf16 v[40:43], a[8:11], v[96:99], v[40:43]
ds_read_b64_tr_b16 a[40:41], v7 offset:16960
v_cvt_pk_bf16_f32 v236, v72, v73
v_cvt_pk_bf16_f32 v237, v74, v75
v_mfma_f32_16x16x32_bf16 v[56:59], a[8:11], v[100:103], v[56:59]
ds_read_b64_tr_b16 a[42:43], v7 offset:17472
v_cvt_pk_bf16_f32 v238, v76, v77
v_mfma_f32_16x16x32_bf16 v[60:63], a[12:15], v[100:103], v[60:63]
ds_read_b64_tr_b16 a[44:45], v7 offset:16992
v_cvt_pk_bf16_f32 v239, v78, v79
buffer_store_dwordx4 v[236:239], v11, s[16:19], s69 offen sc1
v_mfma_f32_16x16x32_bf16 v[44:47], a[12:15], v[96:99], v[44:47]
ds_read_b64_tr_b16 a[46:47], v7 offset:17504
s_add_u32 s69, s69, -130048
s_waitcnt lgkmcnt(8)
v_mfma_f32_16x16x32_bf16 v[32:35], a[16:19], v[104:107], v[32:35]
ds_read_b64_tr_b16 a[48:49], v7 offset:25344
v_cvt_pk_bf16_f32 v240, v80, v81
v_mfma_f32_16x16x32_bf16 v[48:51], a[16:19], v[108:111], v[48:51]
ds_read_b64_tr_b16 a[50:51], v7 offset:25856
v_cvt_pk_bf16_f32 v241, v82, v83
v_cvt_pk_bf16_f32 v242, v84, v85
v_mfma_f32_16x16x32_bf16 v[52:55], a[20:23], v[108:111], v[52:55]
ds_read_b64_tr_b16 a[52:53], v7 offset:25376
v_cvt_pk_bf16_f32 v243, v86, v87
v_mfma_f32_16x16x32_bf16 v[36:39], a[20:23], v[104:107], v[36:39]
ds_read_b64_tr_b16 a[54:55], v7 offset:25888
buffer_store_dwordx4 v[240:243], v11, s[16:19], s69 offen sc1
s_add_u32 s69, s69, 131072
v_mfma_f32_16x16x32_bf16 v[40:43], a[24:27], v[104:107], v[40:43]
ds_read_b64_tr_b16 a[56:57], v7 offset:25408
v_cvt_pk_bf16_f32 v244, v88, v89
v_mfma_f32_16x16x32_bf16 v[56:59], a[24:27], v[108:111], v[56:59]
ds_read_b64_tr_b16 a[58:59], v7 offset:25920
v_cvt_pk_bf16_f32 v245, v90, v91
v_cvt_pk_bf16_f32 v246, v92, v93
v_mfma_f32_16x16x32_bf16 v[60:63], a[28:31], v[108:111], v[60:63]
ds_read_b64_tr_b16 a[60:61], v7 offset:25440
v_cvt_pk_bf16_f32 v247, v94, v95
v_mfma_f32_16x16x32_bf16 v[44:47], a[28:31], v[104:107], v[44:47]
ds_read_b64_tr_b16 a[62:63], v7 offset:25952
buffer_store_dwordx4 v[244:247], v11, s[16:19], s69 offen sc1
s_waitcnt lgkmcnt(8)
v_mfma_f32_16x16x32_bf16 v[32:35], a[32:35], v[112:115], v[32:35]
ds_read_b64_tr_b16 a[0:1], v7 offset:33792
v_mfma_f32_16x16x32_bf16 v[48:51], a[32:35], v[116:119], v[48:51]
ds_read_b64_tr_b16 a[2:3], v7 offset:34304
v_mfma_f32_16x16x32_bf16 v[52:55], a[36:39], v[116:119], v[52:55]
ds_read_b64_tr_b16 a[4:5], v7 offset:33824
v_mfma_f32_16x16x32_bf16 v[36:39], a[36:39], v[112:115], v[36:39]
ds_read_b64_tr_b16 a[6:7], v7 offset:34336
v_mfma_f32_16x16x32_bf16 v[40:43], a[40:43], v[112:115], v[40:43]
ds_read_b64_tr_b16 a[8:9], v7 offset:33856
v_mfma_f32_16x16x32_bf16 v[56:59], a[40:43], v[116:119], v[56:59]
ds_read_b64_tr_b16 a[10:11], v7 offset:34368
v_mfma_f32_16x16x32_bf16 v[60:63], a[44:47], v[116:119], v[60:63]
ds_read_b64_tr_b16 a[12:13], v7 offset:33888
v_mfma_f32_16x16x32_bf16 v[44:47], a[44:47], v[112:115], v[44:47]
ds_read_b64_tr_b16 a[14:15], v7 offset:34400
s_waitcnt lgkmcnt(8)
v_mfma_f32_16x16x32_bf16 v[32:35], a[48:51], v[120:123], v[32:35]
ds_read_b64_tr_b16 a[16:17], v7 offset:42240
v_mfma_f32_16x16x32_bf16 v[48:51], a[48:51], v[124:127], v[48:51]
ds_read_b64_tr_b16 a[18:19], v7 offset:42752
v_mfma_f32_16x16x32_bf16 v[52:55], a[52:55], v[124:127], v[52:55]
ds_read_b64_tr_b16 a[20:21], v7 offset:42272
v_mfma_f32_16x16x32_bf16 v[36:39], a[52:55], v[120:123], v[36:39]
ds_read_b64_tr_b16 a[22:23], v7 offset:42784
v_mfma_f32_16x16x32_bf16 v[40:43], a[56:59], v[120:123], v[40:43]
ds_read_b64_tr_b16 a[24:25], v7 offset:42304
v_mfma_f32_16x16x32_bf16 v[56:59], a[56:59], v[124:127], v[56:59]
ds_read_b64_tr_b16 a[26:27], v7 offset:42816
v_mfma_f32_16x16x32_bf16 v[60:63], a[60:63], v[124:127], v[60:63]
ds_read_b64_tr_b16 a[28:29], v7 offset:42336
v_mfma_f32_16x16x32_bf16 v[44:47], a[60:63], v[120:123], v[44:47]
ds_read_b64_tr_b16 a[30:31], v7 offset:42848
s_waitcnt lgkmcnt(8)
v_mfma_f32_16x16x32_bf16 v[32:35], a[0:3], v[128:131], v[32:35]
ds_read_b64_tr_b16 a[32:33], v7 offset:50688
v_mfma_f32_16x16x32_bf16 v[48:51], a[0:3], v[132:135], v[48:51]
ds_read_b64_tr_b16 a[34:35], v7 offset:51200
v_mfma_f32_16x16x32_bf16 v[52:55], a[4:7], v[132:135], v[52:55]
ds_read_b64_tr_b16 a[36:37], v7 offset:50720
v_mfma_f32_16x16x32_bf16 v[36:39], a[4:7], v[128:131], v[36:39]
ds_read_b64_tr_b16 a[38:39], v7 offset:51232
v_mfma_f32_16x16x32_bf16 v[40:43], a[8:11], v[128:131], v[40:43]
ds_read_b64_tr_b16 a[40:41], v7 offset:50752
v_mfma_f32_16x16x32_bf16 v[56:59], a[8:11], v[132:135], v[56:59]
ds_read_b64_tr_b16 a[42:43], v7 offset:51264
v_mfma_f32_16x16x32_bf16 v[60:63], a[12:15], v[132:135], v[60:63]
ds_read_b64_tr_b16 a[44:45], v7 offset:50784
v_mfma_f32_16x16x32_bf16 v[44:47], a[12:15], v[128:131], v[44:47]
ds_read_b64_tr_b16 a[46:47], v7 offset:51296
s_waitcnt lgkmcnt(8)
v_mfma_f32_16x16x32_bf16 v[32:35], a[16:19], v[136:139], v[32:35]
ds_read_b64_tr_b16 a[48:49], v7 offset:59136
v_mfma_f32_16x16x32_bf16 v[48:51], a[16:19], v[140:143], v[48:51]
ds_read_b64_tr_b16 a[50:51], v7 offset:59648
v_mfma_f32_16x16x32_bf16 v[52:55], a[20:23], v[140:143], v[52:55]
ds_read_b64_tr_b16 a[52:53], v7 offset:59168
v_mfma_f32_16x16x32_bf16 v[36:39], a[20:23], v[136:139], v[36:39]
ds_read_b64_tr_b16 a[54:55], v7 offset:59680
v_mfma_f32_16x16x32_bf16 v[40:43], a[24:27], v[136:139], v[40:43]
ds_read_b64_tr_b16 a[56:57], v7 offset:59200
v_mfma_f32_16x16x32_bf16 v[56:59], a[24:27], v[140:143], v[56:59]
ds_read_b64_tr_b16 a[58:59], v7 offset:59712
v_mfma_f32_16x16x32_bf16 v[60:63], a[28:31], v[140:143], v[60:63]
ds_read_b64_tr_b16 a[60:61], v7 offset:59232
v_mfma_f32_16x16x32_bf16 v[44:47], a[28:31], v[136:139], v[44:47]
ds_read_b64_tr_b16 a[62:63], v7 offset:59744
v_add_u32 v7, s57, v7
s_waitcnt lgkmcnt(8)
v_mfma_f32_16x16x32_bf16 v[32:35], a[32:35], v[144:147], v[32:35]
ds_read_b64_tr_b16 a[0:1], v7
ds_read_b64_tr_b16 a[2:3], v7 offset:512
v_mfma_f32_16x16x32_bf16 v[48:51], a[32:35], v[148:151], v[48:51]
s_waitcnt vmcnt(0)
buffer_atomic_add v13, v12, s[16:19], s71 offen
v_mfma_f32_16x16x32_bf16 v[52:55], a[36:39], v[148:151], v[52:55]
ds_read_b64_tr_b16 a[4:5], v7 offset:32
v_mfma_f32_16x16x32_bf16 v[36:39], a[36:39], v[144:147], v[36:39]
ds_read_b64_tr_b16 a[6:7], v7 offset:544
v_mfma_f32_16x16x32_bf16 v[40:43], a[40:43], v[144:147], v[40:43]
ds_read_b64_tr_b16 a[8:9], v7 offset:64
v_mfma_f32_16x16x32_bf16 v[56:59], a[40:43], v[148:151], v[56:59]
ds_read_b64_tr_b16 a[10:11], v7 offset:576
v_mfma_f32_16x16x32_bf16 v[60:63], a[44:47], v[148:151], v[60:63]
ds_read_b64_tr_b16 a[12:13], v7 offset:96
v_mfma_f32_16x16x32_bf16 v[44:47], a[44:47], v[144:147], v[44:47]
ds_read_b64_tr_b16 a[14:15], v7 offset:608
s_waitcnt lgkmcnt(8)
v_mfma_f32_16x16x32_bf16 v[32:35], a[48:51], v[152:155], v[32:35]
ds_read_b64_tr_b16 a[16:17], v7 offset:8448
v_mfma_f32_16x16x32_bf16 v[48:51], a[48:51], v[156:159], v[48:51]
ds_read_b64_tr_b16 a[18:19], v7 offset:8960
v_mfma_f32_16x16x32_bf16 v[52:55], a[52:55], v[156:159], v[52:55]
ds_read_b64_tr_b16 a[20:21], v7 offset:8480
v_mfma_f32_16x16x32_bf16 v[36:39], a[52:55], v[152:155], v[36:39]
ds_read_b64_tr_b16 a[22:23], v7 offset:8992
v_mfma_f32_16x16x32_bf16 v[40:43], a[56:59], v[152:155], v[40:43]
ds_read_b64_tr_b16 a[24:25], v7 offset:8512
v_mfma_f32_16x16x32_bf16 v[56:59], a[56:59], v[156:159], v[56:59]
ds_read_b64_tr_b16 a[26:27], v7 offset:9024
v_mfma_f32_16x16x32_bf16 v[60:63], a[60:63], v[156:159], v[60:63]
ds_read_b64_tr_b16 a[28:29], v7 offset:8544
v_mfma_f32_16x16x32_bf16 v[44:47], a[60:63], v[152:155], v[44:47]
ds_read_b64_tr_b16 a[30:31], v7 offset:9056
s_waitcnt lgkmcnt(8)
v_mfma_f32_16x16x32_bf16 v[32:35], a[0:3], v[160:163], v[32:35]
ds_read_b64_tr_b16 a[32:33], v7 offset:16896
ds_read_b64_tr_b16 a[34:35], v7 offset:17408
v_mfma_f32_16x16x32_bf16 v[48:51], a[0:3], v[164:167], v[48:51]
buffer_atomic_add v15, v12, s[16:19], s70 offen sc0
v_mfma_f32_16x16x32_bf16 v[52:55], a[4:7], v[164:167], v[52:55]
ds_read_b64_tr_b16 a[36:37], v7 offset:16928
v_mfma_f32_16x16x32_bf16 v[36:39], a[4:7], v[160:163], v[36:39]
ds_read_b64_tr_b16 a[38:39], v7 offset:17440
v_mfma_f32_16x16x32_bf16 v[40:43], a[8:11], v[160:163], v[40:43]
ds_read_b64_tr_b16 a[40:41], v7 offset:16960
v_mfma_f32_16x16x32_bf16 v[56:59], a[8:11], v[164:167], v[56:59]
ds_read_b64_tr_b16 a[42:43], v7 offset:17472
v_mfma_f32_16x16x32_bf16 v[60:63], a[12:15], v[164:167], v[60:63]
ds_read_b64_tr_b16 a[44:45], v7 offset:16992
v_mfma_f32_16x16x32_bf16 v[44:47], a[12:15], v[160:163], v[44:47]
ds_read_b64_tr_b16 a[46:47], v7 offset:17504
s_waitcnt lgkmcnt(8)
v_mfma_f32_16x16x32_bf16 v[32:35], a[16:19], v[168:171], v[32:35]
ds_read_b64_tr_b16 a[48:49], v7 offset:25344
v_mfma_f32_16x16x32_bf16 v[48:51], a[16:19], v[172:175], v[48:51]
ds_read_b64_tr_b16 a[50:51], v7 offset:25856
v_mfma_f32_16x16x32_bf16 v[52:55], a[20:23], v[172:175], v[52:55]
ds_read_b64_tr_b16 a[52:53], v7 offset:25376
v_mfma_f32_16x16x32_bf16 v[36:39], a[20:23], v[168:171], v[36:39]
ds_read_b64_tr_b16 a[54:55], v7 offset:25888
v_mfma_f32_16x16x32_bf16 v[40:43], a[24:27], v[168:171], v[40:43]
ds_read_b64_tr_b16 a[56:57], v7 offset:25408
v_mfma_f32_16x16x32_bf16 v[56:59], a[24:27], v[172:175], v[56:59]
ds_read_b64_tr_b16 a[58:59], v7 offset:25920
v_mfma_f32_16x16x32_bf16 v[60:63], a[28:31], v[172:175], v[60:63]
ds_read_b64_tr_b16 a[60:61], v7 offset:25440
v_mfma_f32_16x16x32_bf16 v[44:47], a[28:31], v[168:171], v[44:47]
ds_read_b64_tr_b16 a[62:63], v7 offset:25952
s_waitcnt lgkmcnt(8)
v_mfma_f32_16x16x32_bf16 v[32:35], a[32:35], v[176:179], v[32:35]
ds_read_b64_tr_b16 a[0:1], v7 offset:33792
v_mfma_f32_16x16x32_bf16 v[48:51], a[32:35], v[180:183], v[48:51]
ds_read_b64_tr_b16 a[2:3], v7 offset:34304
v_mfma_f32_16x16x32_bf16 v[52:55], a[36:39], v[180:183], v[52:55]
ds_read_b64_tr_b16 a[4:5], v7 offset:33824
v_mfma_f32_16x16x32_bf16 v[36:39], a[36:39], v[176:179], v[36:39]
ds_read_b64_tr_b16 a[6:7], v7 offset:34336
v_mfma_f32_16x16x32_bf16 v[40:43], a[40:43], v[176:179], v[40:43]
ds_read_b64_tr_b16 a[8:9], v7 offset:33856
v_mfma_f32_16x16x32_bf16 v[56:59], a[40:43], v[180:183], v[56:59]
ds_read_b64_tr_b16 a[10:11], v7 offset:34368
v_mfma_f32_16x16x32_bf16 v[60:63], a[44:47], v[180:183], v[60:63]
ds_read_b64_tr_b16 a[12:13], v7 offset:33888
v_mfma_f32_16x16x32_bf16 v[44:47], a[44:47], v[176:179], v[44:47]
ds_read_b64_tr_b16 a[14:15], v7 offset:34400
s_waitcnt lgkmcnt(8)
v_mfma_f32_16x16x32_bf16 v[32:35], a[48:51], v[184:187], v[32:35]
ds_read_b64_tr_b16 a[16:17], v7 offset:42240
v_mfma_f32_16x16x32_bf16 v[48:51], a[48:51], v[188:191], v[48:51]
ds_read_b64_tr_b16 a[18:19], v7 offset:42752
v_mfma_f32_16x16x32_bf16 v[52:55], a[52:55], v[188:191], v[52:55]
ds_read_b64_tr_b16 a[20:21], v7 offset:42272
v_mfma_f32_16x16x32_bf16 v[36:39], a[52:55], v[184:187], v[36:39]
ds_read_b64_tr_b16 a[22:23], v7 offset:42784
v_mfma_f32_16x16x32_bf16 v[40:43], a[56:59], v[184:187], v[40:43]
ds_read_b64_tr_b16 a[24:25], v7 offset:42304
v_mfma_f32_16x16x32_bf16 v[56:59], a[56:59], v[188:191], v[56:59]
ds_read_b64_tr_b16 a[26:27], v7 offset:42816
v_mfma_f32_16x16x32_bf16 v[60:63], a[60:63], v[188:191], v[60:63]
ds_read_b64_tr_b16 a[28:29], v7 offset:42336
v_mfma_f32_16x16x32_bf16 v[44:47], a[60:63], v[184:187], v[44:47]
ds_read_b64_tr_b16 a[30:31], v7 offset:42848
s_waitcnt vmcnt(0)
v_cmp_ne_u32 vcc, 0, v15
s_nop 0
s_cbranch_vccz .Lxs81
.Lxs81b:
s_waitcnt lgkmcnt(8)
v_mfma_f32_16x16x32_bf16 v[32:35], a[0:3], v[192:195], v[32:35]
ds_read_b64_tr_b16 a[32:33], v7 offset:50688
ds_read_b64_tr_b16 a[34:35], v7 offset:51200
v_mfma_f32_16x16x32_bf16 v[48:51], a[0:3], v[196:199], v[48:51]
buffer_load_dwordx4 v[232:235], v11, s[16:19], s68 offen sc1
v_mfma_f32_16x16x32_bf16 v[52:55], a[4:7], v[196:199], v[52:55]
ds_read_b64_tr_b16 a[36:37], v7 offset:50720
s_add_u32 s68, s68, 131072
v_mfma_f32_16x16x32_bf16 v[36:39], a[4:7], v[192:195], v[36:39]
ds_read_b64_tr_b16 a[38:39], v7 offset:51232
v_mfma_f32_16x16x32_bf16 v[40:43], a[8:11], v[192:195], v[40:43]
buffer_load_dwordx4 v[236:239], v11, s[16:19], s68 offen sc1
v_mfma_f32_16x16x32_bf16 v[56:59], a[8:11], v[196:199], v[56:59]
ds_read_b64_tr_b16 a[40:41], v7 offset:50752
s_add_u32 s68, s68, -130048
v_mfma_f32_16x16x32_bf16 v[60:63], a[12:15], v[196:199], v[60:63]
ds_read_b64_tr_b16 a[42:43], v7 offset:51264
ds_read_b64_tr_b16 a[44:45], v7 offset:50784
v_mfma_f32_16x16x32_bf16 v[44:47], a[12:15], v[192:195], v[44:47]
ds_read_b64_tr_b16 a[46:47], v7 offset:51296
s_waitcnt lgkmcnt(8)
v_mfma_f32_16x16x32_bf16 v[32:35], a[16:19], v[200:203], v[32:35]
buffer_load_dwordx4 v[240:243], v11, s[16:19], s68 offen sc1
v_mfma_f32_16x16x32_bf16 v[48:51], a[16:19], v[204:207], v[48:51]
s_add_u32 s68, s68, 131072
v_mfma_f32_16x16x32_bf16 v[52:55], a[20:23], v[204:207], v[52:55]
ds_read_b64_tr_b16 a[48:49], v7 offset:59136
ds_read_b64_tr_b16 a[50:51], v7 offset:59648
v_mfma_f32_16x16x32_bf16 v[36:39], a[20:23], v[200:203], v[36:39]
ds_read_b64_tr_b16 a[52:53], v7 offset:59168
ds_read_b64_tr_b16 a[54:55], v7 offset:59680
v_mfma_f32_16x16x32_bf16 v[40:43], a[24:27], v[200:203], v[40:43]
buffer_load_dwordx4 v[244:247], v11, s[16:19], s68 offen sc1
v_mfma_f32_16x16x32_bf16 v[56:59], a[24:27], v[204:207], v[56:59]
ds_read_b64_tr_b16 a[56:57], v7 offset:59200
v_mfma_f32_16x16x32_bf16 v[60:63], a[28:31], v[204:207], v[60:63]
ds_read_b64_tr_b16 a[58:59], v7 offset:59712
ds_read_b64_tr_b16 a[60:61], v7 offset:59232
v_mfma_f32_16x16x32_bf16 v[44:47], a[28:31], v[200:203], v[44:47]
ds_read_b64_tr_b16 a[62:63], v7 offset:59744
s_waitcnt lgkmcnt(8)
v_mfma_f32_16x16x32_bf16 v[32:35], a[32:35], v[208:211], v[32:35]
v_mfma_f32_16x16x32_bf16 v[48:51], a[32:35], v[212:215], v[48:51]
v_mfma_f32_16x16x32_bf16 v[52:55], a[36:39], v[212:215], v[52:55]
v_mfma_f32_16x16x32_bf16 v[36:39], a[36:39], v[208:211], v[36:39]
v_mfma_f32_16x16x32_bf16 v[40:43], a[40:43], v[208:211], v[40:43]
v_mfma_f32_16x16x32_bf16 v[56:59], a[40:43], v[212:215], v[56:59]
v_mfma_f32_16x16x32_bf16 v[60:63], a[44:47], v[212:215], v[60:63]
v_mfma_f32_16x16x32_bf16 v[44:47], a[44:47], v[208:211], v[44:47]
s_waitcnt lgkmcnt(0)
v_mfma_f32_16x16x32_bf16 v[32:35], a[48:51], v[216:219], v[32:35]
v_mfma_f32_16x16x32_bf16 v[48:51], a[48:51], v[220:223], v[48:51]
v_mfma_f32_16x16x32_bf16 v[52:55], a[52:55], v[220:223], v[52:55]
v_mfma_f32_16x16x32_bf16 v[36:39], a[52:55], v[216:219], v[36:39]
v_mfma_f32_16x16x32_bf16 v[40:43], a[56:59], v[216:219], v[40:43]
v_mfma_f32_16x16x32_bf16 v[56:59], a[56:59], v[220:223], v[56:59]
v_mfma_f32_16x16x32_bf16 v[60:63], a[60:63], v[220:223], v[60:63]
v_mfma_f32_16x16x32_bf16 v[44:47], a[60:63], v[216:219], v[44:47]
s_waitcnt vmcnt(3)
v_mfma_f32_16x16x32_bf16 v[32:35], v[226:229], v[232:235], v[32:35]
v_mfma_f32_16x16x32_bf16 v[36:39], v[224:227], v[232:235], v[36:39]
s_waitcnt vmcnt(2)
v_mfma_f32_16x16x32_bf16 v[40:43], v[226:229], v[236:239], v[40:43]
s_nop 4
v_cvt_pk_bf16_f32 v128, v32, v33
v_cvt_pk_bf16_f32 v129, v34, v35
v_mfma_f32_16x16x32_bf16 v[44:47], v[224:227], v[236:239], v[44:47]
v_cvt_pk_bf16_f32 v130, v36, v37
v_cvt_pk_bf16_f32 v131, v38, v39
s_waitcnt vmcnt(1)
v_mfma_f32_16x16x32_bf16 v[48:51], v[226:229], v[240:243], v[48:51]
v_permlane16_swap_b32 v128, v130
v_mfma_f32_16x16x32_bf16 v[52:55], v[224:227], v[240:243], v[52:55]
v_permlane16_swap_b32 v129, v131
s_waitcnt vmcnt(0)
v_mfma_f32_16x16x32_bf16 v[56:59], v[226:229], v[244:247], v[56:59]
buffer_store_dwordx4 v[128:131], v16, s[36:39], 0 offen sc1
v_mfma_f32_16x16x32_bf16 v[60:63], v[224:227], v[244:247], v[60:63]
v_cvt_pk_bf16_f32 v132, v40, v41
v_cvt_pk_bf16_f32 v133, v42, v43
v_cvt_pk_bf16_f32 v134, v44, v45
v_cvt_pk_bf16_f32 v135, v46, v47
v_cvt_pk_bf16_f32 v136, v48, v49
v_permlane16_swap_b32 v132, v134
v_permlane16_swap_b32 v133, v135
v_cvt_pk_bf16_f32 v137, v50, v51
v_cvt_pk_bf16_f32 v138, v52, v53
buffer_store_dwordx4 v[132:135], v16, s[36:39], 0 offen offset:64 sc1
v_cvt_pk_bf16_f32 v139, v54, v55
v_permlane16_swap_b32 v136, v138
s_nop 0
v_permlane16_swap_b32 v137, v139
v_cvt_pk_bf16_f32 v140, v56, v57
v_cvt_pk_bf16_f32 v141, v58, v59
v_cvt_pk_bf16_f32 v142, v60, v61
v_cvt_pk_bf16_f32 v143, v62, v63
s_nop 0
v_permlane16_swap_b32 v140, v142
v_permlane16_swap_b32 v141, v143
buffer_store_dwordx4 v[136:139], v17, s[36:39], 0 offen sc1
buffer_store_dwordx4 v[140:143], v17, s[36:39], 0 offen offset:64 sc1
s_nop 1
.Lend:
s_endpgm
.Lxs81:
s_mov_b32 s15, 0
.Lxs81l:
v_mov_b32 v15, 0
buffer_atomic_add v15, v12, s[16:19], s70 offen sc0
s_add_u32 s15, s15, 1
s_cmp_gt_u32 s15, 100000
s_waitcnt vmcnt(0)
s_cbranch_scc1 .Lxs81b
v_cmp_ne_u32 vcc, 0, v15
s_nop 0
s_cbranch_vccz .Lxs81l
s_branch .Lxs81b
.section .rodata,"a"
.p2align 6
.amdhsa_kernel interleave_layers__sliding_local_dilated__swiglu_ffn__prompt_kernel
  .amdhsa_next_free_vgpr 512
  .amdhsa_next_free_sgpr 102
  .amdhsa_accum_offset 256
  .amdhsa_group_segment_fixed_size 0
  .amdhsa_kernarg_size 80
  .amdhsa_user_sgpr_count 2
  .amdhsa_user_sgpr_kernarg_segment_ptr 1
  .amdhsa_system_sgpr_workgroup_id_x 1
  .amdhsa_float_denorm_mode_32 3
.end_amdhsa_kernel
```

```asm
; @launch grid=(256,1,1) block=(256,1,1) lds=162560
.amdgcn_target "amdgcn-amd-amdhsa--gfx950"
.macro MAA d,a,b
v_mfma_f32_16x16x32_bf16 v[\d:\d+3], a[\a:\a+3], a[\b:\b+3], v[\d:\d+3]
.endm
.macro MAV d,a,b
v_mfma_f32_16x16x32_bf16 v[\d:\d+3], a[\a:\a+3], v[\b:\b+3], v[\d:\d+3]
.endm
.macro TR d,v,o
ds_read_b64_tr_b16 a[\d:\d+1], v\v offset:\o
.endm
.macro RD d,v,o
ds_read_b128 a[\d:\d+3], v\v offset:\o
.endm
.text
.globl interleave_layers__sliding_local_dilated__swiglu_ffn__prompt_kernel
.p2align 8
.type interleave_layers__sliding_local_dilated__swiglu_ffn__prompt_kernel,@function
interleave_layers__sliding_local_dilated__swiglu_ffn__prompt_kernel:
s_load_dwordx4 s[68:71], s[0:1], 0
s_load_dwordx2 s[72:73], s[0:1], 16
s_load_dwordx8 s[76:83], s[0:1], 32
s_load_dwordx4 s[84:87], s[0:1], 64
s_cmp_lt_u32 s2, 256
s_cbranch_scc1 .Lgo
s_endpgm
.p2align 12
.Lgo:
v_lshrrev_b32 v2, 6, v0
v_and_b32 v1, 63, v0
v_readfirstlane_b32 s3, v2
s_and_b32 s4, s2, 7
s_lshr_b32 s5, s2, 3
s_lshr_b32 s6, s4, 1
s_lshl_b32 s6, s6, 2
s_and_b32 s62, s5, 3
s_add_u32 s6, s6, s62
s_and_b32 s7, s4, 1
s_lshr_b32 s62, s5, 2
s_lshl_b32 s62, s62, 1
s_add_u32 s7, s7, s62
s_lshr_b32 s8, s4, 2
s_lshl_b32 s8, s8, 3
s_and_b32 s62, s5, 7
s_add_u32 s8, s8, s62
s_and_b32 s9, s4, 3
s_lshl_b32 s9, s9, 2
s_lshr_b32 s62, s5, 3
s_add_u32 s9, s9, s62
s_lshr_b32 s62, s6, 1
s_lshl_b32 s62, s62, 8
s_and_b32 s63, s6, 1
s_add_u32 s62, s62, s63
s_lshl_b32 s63, s3, 6
s_add_u32 s62, s62, s63
s_lshl_b32 s62, s62, 11
s_lshl_b32 s63, s7, 7
s_add_u32 s62, s62, s63
v_and_b32 v160, 15, v1
v_lshlrev_b32 v160, 12, v160
v_bfe_u32 v2, v1, 4, 1
v_lshl_add_u32 v160, v2, 5, v160
v_bfe_u32 v2, v1, 5, 1
v_lshl_add_u32 v160, v2, 4, v160
v_add_u32 v160, s62, v160
v_add_u32 v161, 0x10000, v160
s_sub_u32 s64, s3, 1
s_max_i32 s64, s64, 0
s_lshl_b32 s64, s64, 11
s_lshl_b32 s66, s9, 7
s_add_u32 s66, s66, s64
s_cmp_eq_u32 s3, 1
s_cselect_b32 s66, 8388608, s66
s_mul_i32 s65, s8, 122880
s_add_u32 s65, s65, s66
v_lshrrev_b32 v9, 1, v1
v_min_u32 v9, 19, v9
v_mul_u32_u24 v9, 6144, v9
s_waitcnt lgkmcnt(0)
s_mov_b32 s36, s68
s_mov_b32 s37, s69
s_mov_b32 s38, 4194304
s_mov_b32 s39, 0x20000
s_mov_b32 s16, s86
s_mov_b32 s17, s87
s_mov_b32 s18, 268435456
s_mov_b32 s19, 0x20000
s_xor_b32 s14, s3, 3
s_lshl_b32 s14, s14, 8
s_add_u32 s14, s14, s2
v_lshlrev_b32 v27, 4, v1
v_mov_b64 v[156:157], 0
v_mov_b64 v[158:159], 0
s_cmp_ge_u32 s14, 16
s_cbranch_scc1 .Lz1
s_lshl_b32 s62, s2, 13
s_add_u32 s62, s62, 30408704
s_add_u32 s63, s62, 4096
buffer_store_dwordx4 v[156:159], v27, s[16:19], s62 offen sc1
buffer_store_dwordx4 v[156:159], v27, s[16:19], s62 offen offset:1024 sc1
buffer_store_dwordx4 v[156:159], v27, s[16:19], s62 offen offset:2048 sc1
buffer_store_dwordx4 v[156:159], v27, s[16:19], s62 offen offset:3072 sc1
buffer_store_dwordx4 v[156:159], v27, s[16:19], s63 offen sc1
buffer_store_dwordx4 v[156:159], v27, s[16:19], s63 offen offset:1024 sc1
buffer_store_dwordx4 v[156:159], v27, s[16:19], s63 offen offset:2048 sc1
buffer_store_dwordx4 v[156:159], v27, s[16:19], s63 offen offset:3072 sc1
.Lz1:
buffer_load_dwordx4 v[128:131], v160, s[36:39], 0 offen
buffer_load_dwordx4 v[132:135], v160, s[36:39], 0 offen offset:64
buffer_load_dwordx4 v[136:139], v161, s[36:39], 0 offen
buffer_load_dwordx4 v[140:143], v161, s[36:39], 0 offen offset:64
s_mov_b32 s20, s70
s_mov_b32 s21, s71
s_mov_b32 s22, 6291456
s_mov_b32 s23, 0x20000
buffer_load_dword v58, v9, s[20:23], s65 offen
s_mov_b32 s40, s84
s_mov_b32 s41, s85
s_mov_b32 s42, 256
s_mov_b32 s43, 0x20000
s_getpc_b64 s[62:63]
.Lpc:
s_lshl_b32 s64, s5, 12
v_lshrrev_b32 v59, 3, v0
v_lshl_add_u32 v59, v59, 7, s64
v_add_u32 v2, 0x20000, v59
v_min_u32 v2, .Lend-.Lpc, v2
v_min_u32 v59, .Lend-.Lpc, v59
global_load_dword v59, v59, s[62:63]
global_load_dword v58, v2, s[62:63]
s_mov_b32 s24, s72
s_mov_b32 s25, s73
s_mov_b32 s26, 2097152
s_mov_b32 s27, 0x20000
s_mov_b32 s28, s80
s_mov_b32 s29, s81
s_mov_b32 s30, 7340032
s_mov_b32 s31, 0x20000
s_cmp_lt_u32 s3, 2
s_cselect_b32 s32, s76, s78
s_cselect_b32 s33, s77, s79
s_mov_b32 s34, 7340032
s_mov_b32 s35, 0x20000
s_lshr_b32 s10, s4, 2
s_lshl_b32 s10, s10, 2
s_and_b32 s62, s5, 3
s_add_u32 s10, s10, s62
s_and_b32 s11, s4, 3
s_lshl_b32 s11, s11, 3
s_lshr_b32 s62, s5, 2
s_add_u32 s11, s11, s62
s_and_b32 s12, s11, 1
s_lshr_b32 s13, s11, 1
s_mul_i32 s51, s13, 448
s_mul_i32 s62, s12, 192
s_add_u32 s51, s51, s62
s_and_b32 s48, s3, 1
s_lshr_b32 s49, s3, 1
s_lshl_b32 s50, s8, 3
s_sub_u32 s50, s50, 9
s_cmp_lt_u32 s8, 2
s_cselect_b32 s50, 7, s50
s_mul_i32 s62, s8, 393216
s_add_u32 s62, s62, s66
v_mul_u32_u24 v14, 6144, v1
v_add_u32 v14, s62, v14
s_lshl_b32 s62, s8, 4
s_add_u32 s62, s62, s9
s_lshl_b32 s62, s62, 2
s_add_u32 s62, s62, s3
s_mul_i32 s62, s62, 6656
v_min_u32 v15, 51, v1
v_lshl_add_u32 v15, v15, 7, s62
s_sub_u32 s63, s8, 4
s_lshl_b32 s64, s8, 1
s_add_u32 s64, s64, 1
s_cmp_lt_u32 s8, 5
s_cselect_b64 vcc, -1, 0
s_cselect_b32 s46, s64, s63
v_cndmask_b32 v14, v14, v15, vcc
s_lshl_b32 s62, s2, 1
s_add_u32 s62, s62, s48
s_mul_i32 s62, s62, 5376
v_min_u32 v16, 41, v1
v_lshl_add_u32 v16, v16, 7, s62
s_cmp_lt_u32 s46, 6
s_cselect_b64 vcc, -1, 0
v_cndmask_b32 v15, v14, v16, vcc
v_cndmask_b32 v14, v16, v14, vcc
s_cmp_lt_u32 s8, 5
s_cselect_b32 s62, s24, s20
s_cselect_b32 s63, s25, s21
s_cselect_b32 s64, s26, s22
s_sub_u32 s47, s46, 6
s_cmp_lt_u32 s46, 6
s_cselect_b32 s47, s46, s47
s_cselect_b32 s76, s62, s32
s_cselect_b32 s98, s32, s62
s_cselect_b32 s77, s63, s33
s_cselect_b32 s99, s33, s63
s_cselect_b32 s78, s64, s34
s_cselect_b32 s100, s34, s64
s_mov_b32 s79, 0x20000
v_bfe_u32 v18, v1, 3, 1
v_bfe_u32 v2, v1, 5, 1
v_lshl_add_u32 v18, v2, 2, v18
v_and_b32 v2, 16, v1
v_add_u32 v18, v18, v2
s_lshl_b32 s62, s49, 2
s_add_u32 s62, s62, s48
s_lshl_b32 s62, s62, 1
v_add_u32 v18, s62, v18
v_mul_u32_u24 v18, 6144, v18
v_and_b32 v2, 7, v1
v_lshl_add_u32 v18, v2, 4, v18
s_lshl_b32 s62, s9, 7
v_add_u32 v18, s62, v18
v_add_u32 v19, 1024, v18
v_add_u32 v20, 2048, v18
s_mul_i32 s59, s3, 3104
s_mov_b32 s58, 0
s_lshr_b32 s62, s8, 1
s_lshl_b32 s62, s62, 8
s_and_b32 s67, s8, 1
s_add_u32 s62, s62, s67
s_lshl_b32 s62, s62, 11
s_lshl_b32 s63, s3, 17
s_add_u32 s62, s62, s63
v_lshrrev_b32 v2, 4, v1
v_xor_b32 v2, v2, v1
v_and_b32 v2, 7, v2
v_lshlrev_b32 v2, 4, v2
v_lshrrev_b32 v21, 3, v1
v_lshl_add_u32 v21, v21, 12, v2
v_add_u32 v21, s62, v21
v_xor_b32 v28, 64, v21
v_add_u32 v28, 31744, v28
s_lshr_b32 s63, s50, 3
s_lshr_b32 s62, s63, 1
s_lshl_b32 s62, s62, 8
s_and_b32 s67, s63, 1
s_add_u32 s62, s62, s67
s_lshl_b32 s62, s62, 11
s_lshl_b32 s63, s3, 14
s_add_u32 s62, s62, s63
s_add_u32 s62, s62, 456704
s_lshl_b32 s63, s3, 5
v_and_b32 v2, 31, v1
v_lshlrev_b32 v2, 2, v2
v_xor_b32 v2, s63, v2
v_lshrrev_b32 v22, 5, v1
v_lshl_add_u32 v22, v22, 12, v2
v_add_u32 v22, s62, v22
v_xor_b32 v29, 16, v22
v_add_u32 v29, -57344, v29
s_mov_b32 s52, 0
s_mov_b32 s53, 65536
s_mul_i32 s55, s3, 4608
s_mov_b32 s54, 0
s_mul_i32 s56, s3, 3104
v_bfe_u32 v24, v1, 1, 3
v_lshrrev_b32 v2, 4, v1
v_xor_b32 v2, v2, v24
v_lshlrev_b32 v2, 4, v2
v_and_b32 v23, 15, v1
v_lshl_add_u32 v23, v23, 7, v2
s_mul_i32 s62, s48, 9216
v_add_u32 v23, s62, v23
v_xor_b32 v30, 64, v23
v_mul_u32_u24 v24, 2304, v24
v_add_u32 v24, v24, v2
v_and_b32 v2, 1, v1
v_lshl_add_u32 v24, v2, 7, v24
v_add_u32 v24, 2048, v24
v_xor_b32 v31, 64, v24
v_and_b32 v2, 15, v1
v_cmp_eq_u32 vcc, 0, v2
v_mov_b32 v2, 18432
s_nop 0
v_cndmask_b32 v24, v24, v2, vcc
v_cndmask_b32 v31, v31, v2, vcc
v_bfe_u32 v25, v1, 3, 2
v_mul_u32_u24 v25, 3104, v25
v_bfe_u32 v2, v1, 2, 1
v_lshl_add_u32 v25, v2, 7, v25
v_bfe_u32 v2, v1, 5, 1
v_lshl_add_u32 v25, v2, 8, v25
v_and_b32 v2, 3, v1
v_lshl_add_u32 v25, v2, 3, v25
s_lshl_b32 s62, s49, 6
s_add_u32 s62, s62, 73984
v_add_u32 v25, s62, v25
s_lshl_b32 s62, s8, 1
s_add_u32 s62, s62, s3
s_lshr_b32 s63, s50, 2
s_cmp_lt_u32 s3, 2
s_cselect_b32 s62, s62, s63
s_lshl_b32 s62, s62, 13
s_cmp_eq_u32 s3, 3
s_cselect_b32 s62, 268435456, s62
v_lshl_add_u32 v26, v1, 4, s62
s_mul_i32 s59, s3, 2080
v_bfe_u32 v5, v1, 3, 1
v_lshrrev_b32 v2, 4, v1
v_lshl_add_u32 v5, v2, 3, v5
s_lshl_b32 s62, s3, 1
v_add_u32 v5, s62, v5
v_mul_u32_u24 v5, 2048, v5
v_and_b32 v2, 7, v1
v_lshl_add_u32 v5, v2, 4, v5
s_lshl_b32 s62, s7, 7
v_add_u32 v5, s62, v5
v_add_u32 v6, 64512, v5
s_lshl_b32 s62, s6, 10
s_add_u32 s62, s62, 30408704
s_lshl_b32 s64, s8, 10
s_add_u32 s64, s64, 30408704
s_lshr_b32 s67, s9, 1
s_and_b32 s67, s67, 3
s_lshl_b32 s67, s67, 7
s_add_u32 s64, s64, s67
s_lshr_b32 s65, s50, 3
s_lshl_b32 s65, s65, 10
s_add_u32 s65, s65, 30408704
s_lshr_b32 s67, s9, 1
s_and_b32 s67, s67, 3
s_lshl_b32 s67, s67, 7
s_add_u32 s65, s65, s67
v_mov_b32 v2, 268435456
v_cmp_eq_u32 vcc, 65, v0
v_mov_b32 v33, s65
s_nop 0
v_cndmask_b32 v33, v2, v33, vcc
v_cndmask_b32 v36, 0, 16, vcc
v_cmp_eq_u32 vcc, 64, v0
v_mov_b32 v32, s64
s_nop 0
v_cndmask_b32 v33, v33, v32, vcc
v_lshl_add_u32 v32, v1, 7, s62
v_cndmask_b32 v34, v2, 0, vcc
v_cndmask_b32 v35, 0, 16, vcc
v_cndmask_b32 v36, v36, 16, vcc
v_lshrrev_b32 v37, 3, v0
v_cmp_eq_u32 vcc, 8, v37
s_nop 1
v_cndmask_b32 v32, v2, v32, vcc
v_mov_b32 v38, 1
v_lshrrev_b32 v2, 4, v1
v_lshlrev_b32 v2, 2, v2
v_and_b32 v13, 15, v1
v_sub_u32 v2, v13, v2
v_mov_b32 v13, 0xff61b1e6
v_subrev_u32 v54, 0, v2
v_cmp_gt_u32 vcc, 8, v54
s_nop 1
v_cndmask_b32 v50, v13, 0, vcc
v_cmp_gt_i32 vcc, -8, v54
s_nop 1
v_cndmask_b32 v46, v13, 0, vcc
v_subrev_u32 v54, 1, v2
v_cmp_gt_u32 vcc, 8, v54
s_nop 1
v_cndmask_b32 v51, v13, 0, vcc
v_cmp_gt_i32 vcc, -8, v54
s_nop 1
v_cndmask_b32 v47, v13, 0, vcc
v_subrev_u32 v54, 2, v2
v_cmp_gt_u32 vcc, 8, v54
s_nop 1
v_cndmask_b32 v52, v13, 0, vcc
v_cmp_gt_i32 vcc, -8, v54
s_nop 1
v_cndmask_b32 v48, v13, 0, vcc
v_subrev_u32 v54, 3, v2
v_cmp_gt_u32 vcc, 8, v54
s_nop 1
v_cndmask_b32 v53, v13, 0, vcc
v_cmp_gt_i32 vcc, -8, v54
s_nop 1
v_cndmask_b32 v49, v13, 0, vcc
s_cmp_lt_u32 s8, 2
s_cselect_b64 vcc, -1, 0
v_cndmask_b32 v54, v46, v13, vcc
v_cndmask_b32 v55, v47, v13, vcc
v_cndmask_b32 v56, v48, v13, vcc
v_cndmask_b32 v57, v49, v13, vcc
s_mov_b32 s75, 29360128
v_and_b32 v10, 15, v1
v_lshlrev_b32 v12, 2, v10
v_lshlrev_b32 v10, 4, v10
v_add_u32 v10, 152576, v10
v_lshrrev_b32 v11, 4, v1
v_lshlrev_b32 v11, 4, v11
s_lshl_b32 s62, s49, 7
s_add_u32 s62, s62, 158720
v_add_u32 v12, s62, v12
v_add_u32 v13, s62, v11
v_add_u32 v11, 156672, v11
s_lshl_b32 s62, s3, 11
s_add_u32 s62, s62, 143360
v_lshl_add_u32 v8, v1, 4, s62
v_xor_b32 v9, 2048, v8
v_mov_b32 v248, 0x3f803f80
v_mov_b32 v249, 0x3f803f80
v_mov_b32 v250, 0x3f803f80
v_mov_b32 v251, 0x3f803f80
s_mul_i32 s62, s3, 18496
s_add_u32 s62, s62, 18432
v_mov_b32 v2, s62
ds_write_b128 v2, v[248:251]
v_and_b32 v7, 31, v1
v_lshrrev_b32 v2, 5, v1
v_lshl_add_u32 v7, v7, 1, v2
v_and_b32 v2, 0xc0, v0
v_add_u32 v7, v7, v2
v_lshlrev_b32 v17, 2, v7
v_add_u32 v17, 156672, v17
v_lshlrev_b32 v7, 4, v7
v_add_u32 v7, 152576, v7
s_lshl_b32 s74, s9, 1
s_add_u32 s74, s74, s49
s_lshl_b32 s74, s74, 17
s_lshl_b32 s63, s8, 13
s_add_u32 s74, s74, s63
s_lshl_b32 s63, s48, 12
s_add_u32 s74, s74, s63
s_add_u32 s74, s74, 4194304
s_mov_b32 s62, 0
v_lshl_add_u32 v4, v1, 4, s62
v_lshrrev_b32 v2, 3, v1
v_cmp_eq_u32 vcc, 3, v2
v_add_u32 v2, 67108480, v4
s_nop 0
v_cndmask_b32 v4, v4, v2, vcc
s_nop 1
s_cmp_eq_u32 s48, 1
s_cbranch_scc1 .Lqkv2
s_add_u32 m0, s55, 0
s_nop 0
buffer_load_dwordx4 v21, s[36:39], s52 offen lds
buffer_load_dwordx4 v28, s[36:39], s52 offen offset:1024 lds
buffer_load_dword v22, s[36:39], s52 offen offset:2048 lds
s_add_u32 s52, s52, 128
s_add_u32 m0, s55, 2304
s_nop 0
buffer_load_dwordx4 v21, s[36:39], s53 offen lds
buffer_load_dwordx4 v28, s[36:39], s53 offen offset:1024 lds
buffer_load_dword v29, s[36:39], s53 offen offset:2048 lds
s_add_u32 s53, s53, 128
s_add_u32 m0, s56, 123648
s_nop 0
buffer_load_dwordx4 v18, s[20:23], s54 offen lds
buffer_load_dwordx4 v19, s[20:23], s54 offen offset:1024 lds
buffer_load_dwordx4 v20, s[20:23], s54 offen offset:2048 lds
s_add_u32 s54, s54, 196608
s_add_u32 m0, s56, 136064
s_nop 0
buffer_load_dwordx4 v18, s[20:23], s54 offen lds
buffer_load_dwordx4 v19, s[20:23], s54 offen offset:1024 lds
buffer_load_dwordx4 v20, s[20:23], s54 offen offset:2048 lds
s_add_u32 s54, s54, 196608
s_waitcnt vmcnt(12)
s_cmp_lt_u32 s14, 16
s_cselect_b32 s62, 0, 4096
v_mov_b32 v154, 1
v_lshlrev_b32 v155, 8, v1
v_permlane16_swap_b32 v128, v130
v_permlane16_swap_b32 v129, v131
v_permlane16_swap_b32 v132, v134
v_permlane16_swap_b32 v133, v135
v_permlane16_swap_b32 v136, v138
v_permlane16_swap_b32 v137, v139
v_permlane16_swap_b32 v140, v142
v_permlane16_swap_b32 v141, v143
buffer_atomic_add v154, v155, s[40:43], s62 offen
v_lshlrev_b32 v64, 16, v128
v_and_b32 v65, 0xffff0000, v128
v_lshlrev_b32 v66, 16, v129
v_and_b32 v67, 0xffff0000, v129
v_lshlrev_b32 v68, 16, v130
v_and_b32 v69, 0xffff0000, v130
v_lshlrev_b32 v70, 16, v131
v_and_b32 v71, 0xffff0000, v131
v_lshlrev_b32 v72, 16, v132
v_and_b32 v73, 0xffff0000, v132
v_lshlrev_b32 v74, 16, v133
v_and_b32 v75, 0xffff0000, v133
v_lshlrev_b32 v76, 16, v134
v_and_b32 v77, 0xffff0000, v134
v_lshlrev_b32 v78, 16, v135
v_and_b32 v79, 0xffff0000, v135
v_lshlrev_b32 v80, 16, v136
v_and_b32 v81, 0xffff0000, v136
v_lshlrev_b32 v82, 16, v137
v_and_b32 v83, 0xffff0000, v137
v_lshlrev_b32 v84, 16, v138
v_and_b32 v85, 0xffff0000, v138
v_lshlrev_b32 v86, 16, v139
v_and_b32 v87, 0xffff0000, v139
v_lshlrev_b32 v88, 16, v140
v_and_b32 v89, 0xffff0000, v140
v_lshlrev_b32 v90, 16, v141
v_and_b32 v91, 0xffff0000, v141
v_lshlrev_b32 v92, 16, v142
v_and_b32 v93, 0xffff0000, v142
v_lshlrev_b32 v94, 16, v143
v_and_b32 v95, 0xffff0000, v143
s_lshl_b32 s64, s6, 14
s_lshl_b32 s65, s49, 13
s_add_u32 s64, s64, s65
s_lshl_b32 s65, s7, 9
s_add_u32 s64, s64, s65
s_lshl_b32 s65, s48, 8
s_add_u32 s64, s64, s65
s_add_u32 s64, s64, 29360128
v_and_b32 v152, 31, v1
v_lshlrev_b32 v152, 3, v152
v_lshrrev_b32 v153, 5, v1
v_lshl_add_u32 v152, v153, 28, v152
s_lshl_b32 s62, s7, 18
s_add_u32 s62, s62, 0
s_add_u32 s63, s62, 0x20000
v_pk_mul_f32 v[146:147], v[64:65], v[64:65]
v_pk_mul_f32 v[150:151], v[80:81], v[80:81]
v_pk_fma_f32 v[146:147], v[66:67], v[66:67], v[146:147]
v_pk_add_f32 v[144:145], v[64:65], v[66:67]
v_pk_fma_f32 v[150:151], v[82:83], v[82:83], v[150:151]
v_pk_add_f32 v[148:149], v[80:81], v[82:83]
v_pk_fma_f32 v[146:147], v[68:69], v[68:69], v[146:147]
v_pk_add_f32 v[144:145], v[144:145], v[68:69]
v_pk_fma_f32 v[150:151], v[84:85], v[84:85], v[150:151]
v_pk_add_f32 v[148:149], v[148:149], v[84:85]
v_pk_fma_f32 v[146:147], v[70:71], v[70:71], v[146:147]
v_pk_add_f32 v[144:145], v[144:145], v[70:71]
v_pk_fma_f32 v[150:151], v[86:87], v[86:87], v[150:151]
v_pk_add_f32 v[148:149], v[148:149], v[86:87]
v_pk_fma_f32 v[146:147], v[72:73], v[72:73], v[146:147]
v_pk_add_f32 v[144:145], v[144:145], v[72:73]
v_pk_fma_f32 v[150:151], v[88:89], v[88:89], v[150:151]
v_pk_add_f32 v[148:149], v[148:149], v[88:89]
v_pk_fma_f32 v[146:147], v[74:75], v[74:75], v[146:147]
v_pk_add_f32 v[144:145], v[144:145], v[74:75]
v_pk_fma_f32 v[150:151], v[90:91], v[90:91], v[150:151]
v_pk_add_f32 v[148:149], v[148:149], v[90:91]
v_pk_fma_f32 v[146:147], v[76:77], v[76:77], v[146:147]
v_pk_add_f32 v[144:145], v[144:145], v[76:77]
v_pk_fma_f32 v[150:151], v[92:93], v[92:93], v[150:151]
v_pk_add_f32 v[148:149], v[148:149], v[92:93]
v_pk_fma_f32 v[146:147], v[78:79], v[78:79], v[146:147]
v_pk_add_f32 v[144:145], v[144:145], v[78:79]
v_pk_fma_f32 v[150:151], v[94:95], v[94:95], v[150:151]
v_pk_add_f32 v[148:149], v[148:149], v[94:95]
v_add_f32 v144, v144, v145
v_add_f32 v146, v146, v147
v_add_f32 v148, v148, v149
v_add_f32 v150, v150, v151
s_nop 0
v_permlane16_swap_b32 v144, v148
v_permlane16_swap_b32 v146, v150
v_add_f32 v144, v144, v148
v_add_f32 v146, v146, v150
s_nop 1
v_permlane32_swap_b32 v144, v146
v_add_f32 v144, v144, v146
s_nop 1
v_permlane32_swap_b32 v144, v145
buffer_store_dwordx2 v[144:145], v152, s[16:19], s64 offen sc1
s_lshl_b32 s62, s2, 10
s_add_u32 s62, s62, 31457280
s_cmp_eq_u32 s3, 0
s_cselect_b32 s62, s62, 268435456
buffer_store_dwordx4 v[156:159], v27, s[16:19], s62 offen sc1
v_accvgpr_write_b32 a224, v64
v_accvgpr_write_b32 a225, v65
v_accvgpr_write_b32 a226, v66
v_accvgpr_write_b32 a227, v67
v_accvgpr_write_b32 a228, v68
v_accvgpr_write_b32 a229, v69
v_accvgpr_write_b32 a230, v70
v_accvgpr_write_b32 a231, v71
v_accvgpr_write_b32 a232, v72
v_accvgpr_write_b32 a233, v73
v_accvgpr_write_b32 a234, v74
v_accvgpr_write_b32 a235, v75
v_accvgpr_write_b32 a236, v76
v_accvgpr_write_b32 a237, v77
v_accvgpr_write_b32 a238, v78
v_accvgpr_write_b32 a239, v79
v_accvgpr_write_b32 a240, v80
v_accvgpr_write_b32 a241, v81
v_accvgpr_write_b32 a242, v82
v_accvgpr_write_b32 a243, v83
v_accvgpr_write_b32 a244, v84
v_accvgpr_write_b32 a245, v85
v_accvgpr_write_b32 a246, v86
v_accvgpr_write_b32 a247, v87
v_accvgpr_write_b32 a248, v88
v_accvgpr_write_b32 a249, v89
v_accvgpr_write_b32 a250, v90
v_accvgpr_write_b32 a251, v91
v_accvgpr_write_b32 a252, v92
v_accvgpr_write_b32 a253, v93
v_accvgpr_write_b32 a254, v94
v_accvgpr_write_b32 a255, v95
s_add_u32 m0, s55, 18496
s_nop 0
buffer_load_dwordx4 v21, s[36:39], s52 offen lds
buffer_load_dwordx4 v28, s[36:39], s52 offen offset:1024 lds
buffer_load_dword v22, s[36:39], s52 offen offset:2048 lds
s_add_u32 s52, s52, 128
s_add_u32 m0, s55, 20800
s_nop 0
buffer_load_dwordx4 v21, s[36:39], s53 offen lds
buffer_load_dwordx4 v28, s[36:39], s53 offen offset:1024 lds
buffer_load_dword v29, s[36:39], s53 offen offset:2048 lds
s_add_u32 s53, s53, 128
s_add_u32 m0, s56, 73984
s_nop 0
buffer_load_dwordx4 v18, s[20:23], s54 offen lds
buffer_load_dwordx4 v19, s[20:23], s54 offen offset:1024 lds
buffer_load_dwordx4 v20, s[20:23], s54 offen offset:2048 lds
s_add_u32 s54, s54, 196608
s_waitcnt vmcnt(15) lgkmcnt(0)
s_barrier
ds_read_b128 a[0:3], v23
RD 4,23,2304
RD 8,23,4608
RD 12,23,6912
TR 20,25,49664
TR 22,25,50176
TR 24,25,49696
TR 26,25,50208
ds_read_b128 a[16:19], v24
TR 28,25,50688
TR 30,25,51200
TR 32,25,50720
TR 34,25,51232
TR 36,25,51712
TR 38,25,52224
TR 40,25,51744
TR 42,25,52256
s_waitcnt vmcnt(12) lgkmcnt(8)
s_barrier
v_mfma_f32_16x16x32_bf16 v[60:63], a[20:23], a[0:3], 0
ds_read_b128 a[44:47], v30
s_add_u32 m0, s56, 86400
v_mfma_f32_16x16x32_bf16 v[76:79], a[24:27], a[0:3], 0
buffer_load_dwordx4 v18, s[20:23], s54 offen lds
v_mfma_f32_16x16x32_bf16 v[80:83], a[24:27], a[4:7], 0
s_sub_u32 s47, s47, 1
s_cbranch_scc1 .Lx4
.Lx4b:
v_mfma_f32_16x16x32_bf16 v[64:67], a[20:23], a[4:7], 0
buffer_load_dwordx4 v19, s[20:23], s54 offen offset:1024 lds
v_mfma_f32_16x16x32_bf16 v[68:71], a[20:23], a[8:11], 0
RD 48,30,2304
v_mfma_f32_16x16x32_bf16 v[84:87], a[24:27], a[8:11], 0
RD 52,30,4608
RD 56,30,6912
v_mfma_f32_16x16x32_bf16 v[88:91], a[24:27], a[12:15], 0
buffer_load_dwordx4 v20, s[20:23], s54 offen offset:2048 lds
v_mfma_f32_16x16x32_bf16 v[72:75], a[20:23], a[12:15], 0
s_add_u32 s54, s54, 196608
s_waitcnt lgkmcnt(4)
v_mfma_f32_16x16x32_bf16 v[244:247], a[20:23], a[16:19], 0
TR 64,25,62080
s_add_u32 m0, s55, 36992
v_mfma_f32_16x16x32_bf16 v[104:107], a[28:31], a[12:15], 0
buffer_load_dwordx4 v21, s[36:39], s52 offen lds
v_mfma_f32_16x16x32_bf16 v[120:123], a[32:35], a[12:15], 0
TR 66,25,62592
v_mfma_f32_16x16x32_bf16 v[116:119], a[32:35], a[8:11], 0
TR 68,25,62112
TR 70,25,62624
v_mfma_f32_16x16x32_bf16 v[100:103], a[28:31], a[8:11], 0
buffer_load_dwordx4 v28, s[36:39], s52 offen offset:1024 lds
v_mfma_f32_16x16x32_bf16 v[96:99], a[28:31], a[4:7], 0
ds_read_b128 a[60:63], v31
v_mfma_f32_16x16x32_bf16 v[112:115], a[32:35], a[4:7], 0
buffer_load_dword v22, s[36:39], s52 offen offset:2048 lds
v_mfma_f32_16x16x32_bf16 v[108:111], a[32:35], a[0:3], 0
TR 72,25,63104
s_add_u32 s52, s52, 128
v_mfma_f32_16x16x32_bf16 v[92:95], a[28:31], a[0:3], 0
s_add_u32 m0, s55, 39296
v_mfma_f32_16x16x32_bf16 v[156:159], a[28:31], a[16:19], 0
buffer_load_dwordx4 v21, s[36:39], s53 offen lds
v_mfma_f32_16x16x32_bf16 v[160:163], a[32:35], a[16:19], 0
TR 74,25,63616
TR 76,25,63136
v_mfma_f32_16x16x32_bf16 v[124:127], a[0:3], a[36:39], 0
TR 78,25,63648
v_mfma_f32_16x16x32_bf16 v[140:143], a[0:3], a[40:43], 0
buffer_load_dwordx4 v28, s[36:39], s53 offen offset:1024 lds
v_mfma_f32_16x16x32_bf16 v[144:147], a[4:7], a[40:43], 0
TR 80,25,64128
v_mfma_f32_16x16x32_bf16 v[128:131], a[4:7], a[36:39], 0
TR 82,25,64640
TR 84,25,64160
v_mfma_f32_16x16x32_bf16 v[132:135], a[8:11], a[36:39], 0
buffer_load_dword v29, s[36:39], s53 offen offset:2048 lds
v_mfma_f32_16x16x32_bf16 v[148:151], a[8:11], a[40:43], 0
s_add_u32 s53, s53, 128
v_mfma_f32_16x16x32_bf16 v[152:155], a[12:15], a[40:43], 0
TR 86,25,64672
v_mfma_f32_16x16x32_bf16 v[136:139], a[12:15], a[36:39], 0
s_waitcnt vmcnt(9) lgkmcnt(8)
s_barrier
MAA 60,64,44
RD 0,23,18496
s_add_u32 m0, s56, 98816
MAA 76,68,44
buffer_load_dwordx4 v18, s[20:23], s54 offen lds
MAA 80,68,48
RD 4,23,20800
MAA 64,64,48
buffer_load_dwordx4 v19, s[20:23], s54 offen offset:1024 lds
MAA 68,64,52
RD 8,23,23104
RD 12,23,25408
MAA 84,68,52
ds_read_b64_tr_b16 a[20:21], v25
MAA 88,68,56
buffer_load_dwordx4 v20, s[20:23], s54 offen offset:2048 lds
MAA 72,64,56
s_add_u32 s54, s54, 196608
s_waitcnt lgkmcnt(5)
MAA 244,64,60
TR 22,25,512
s_add_u32 m0, s56, 111232
MAA 104,72,56
buffer_load_dwordx4 v18, s[20:23], s54 offen lds
MAA 120,76,56
TR 24,25,32
MAA 116,76,52
TR 26,25,544
MAA 100,72,52
buffer_load_dwordx4 v19, s[20:23], s54 offen offset:1024 lds
MAA 96,72,48
RD 16,24,18496
TR 28,25,1024
MAA 112,76,48
buffer_load_dwordx4 v20, s[20:23], s54 offen offset:2048 lds
MAA 108,76,44
s_add_u32 s54, s54, 196608
MAA 92,72,44
TR 30,25,1536
s_add_u32 m0, s55, 55488
MAA 156,72,60
buffer_load_dwordx4 v21, s[36:39], s52 offen lds
MAA 160,76,60
TR 32,25,1056
MAA 124,44,80
TR 34,25,1568
MAA 140,44,84
buffer_load_dwordx4 v28, s[36:39], s52 offen offset:1024 lds
MAA 144,48,84
TR 36,25,2048
MAA 128,48,80
TR 38,25,2560
TR 40,25,2080
MAA 132,52,80
buffer_load_dword v22, s[36:39], s52 offen offset:2048 lds
MAA 148,52,84
s_add_u32 s52, s52, 128
MAA 152,56,84
TR 42,25,2592
MAA 136,56,80
s_waitcnt vmcnt(15) lgkmcnt(8)
s_barrier
MAA 60,20,0
RD 44,30,18496
s_add_u32 m0, s55, 57792
MAA 76,24,0
buffer_load_dwordx4 v21, s[36:39], s53 offen lds
MAA 80,24,4
s_sub_u32 s47, s47, 1
s_cbranch_scc1 .Lx5
.Lx5b:
MAA 64,20,4
buffer_load_dwordx4 v28, s[36:39], s53 offen offset:1024 lds
MAA 68,20,8
RD 48,30,20800
MAA 84,24,8
RD 52,30,23104
RD 56,30,25408
MAA 88,24,12
buffer_load_dword v29, s[36:39], s53 offen offset:2048 lds
MAA 72,20,12
s_add_u32 s53, s53, 128
s_waitcnt lgkmcnt(4)
MAA 244,20,16
TR 64,25,12416
s_add_u32 m0, s56, 123648
MAA 104,28,12
buffer_load_dwordx4 v18, s[20:23], s54 offen lds
MAA 120,32,12
TR 66,25,12928
MAA 116,32,8
TR 68,25,12448
TR 70,25,12960
MAA 100,28,8
buffer_load_dwordx4 v19, s[20:23], s54 offen offset:1024 lds
MAA 96,28,4
RD 60,31,18496
MAA 112,32,4
buffer_load_dwordx4 v20, s[20:23], s54 offen offset:2048 lds
MAA 108,32,0
TR 72,25,13440
s_add_u32 s54, s54, 196608
MAA 92,28,0
s_add_u32 m0, s56, 136064
MAA 156,28,16
buffer_load_dwordx4 v18, s[20:23], s54 offen lds
MAA 160,32,16
TR 74,25,13952
TR 76,25,13472
MAA 124,0,36
TR 78,25,13984
MAA 140,0,40
buffer_load_dwordx4 v19, s[20:23], s54 offen offset:1024 lds
MAA 144,4,40
TR 80,25,14464
MAA 128,4,36
TR 82,25,14976
TR 84,25,14496
MAA 132,8,36
buffer_load_dwordx4 v20, s[20:23], s54 offen offset:2048 lds
MAA 148,8,40
s_add_u32 s54, s54, 196608
MAA 152,12,40
TR 86,25,15008
MAA 136,12,36
s_waitcnt vmcnt(15) lgkmcnt(8)
s_barrier
MAA 60,64,44
RD 0,23,36992
s_add_u32 m0, s55, 0
MAA 76,68,44
buffer_load_dwordx4 v21, s[36:39], s52 offen lds
MAA 80,68,48
RD 4,23,39296
MAA 64,64,48
buffer_load_dwordx4 v28, s[36:39], s52 offen offset:1024 lds
MAA 68,64,52
RD 8,23,41600
RD 12,23,43904
MAA 84,68,52
TR 20,25,24832
MAA 88,68,56
buffer_load_dword v22, s[36:39], s52 offen offset:2048 lds
MAA 72,64,56
s_add_u32 s52, s52, 128
s_add_u32 m0, s55, 2304
s_waitcnt lgkmcnt(5)
MAA 244,64,60
buffer_load_dwordx4 v21, s[36:39], s53 offen lds
MAA 104,72,56
TR 22,25,25344
MAA 120,76,56
TR 24,25,24864
TR 26,25,25376
MAA 116,76,52
buffer_load_dwordx4 v28, s[36:39], s53 offen offset:1024 lds
MAA 100,72,52
RD 16,24,36992
MAA 96,72,48
buffer_load_dword v29, s[36:39], s53 offen offset:2048 lds
MAA 112,76,48
TR 28,25,25856
s_add_u32 s53, s53, 128
MAA 108,76,44
s_add_u32 m0, s56, 73984
MAA 92,72,44
buffer_load_dwordx4 v18, s[20:23], s54 offen lds
MAA 156,72,60
TR 30,25,26368
TR 32,25,25888
MAA 160,76,60
buffer_load_dwordx4 v19, s[20:23], s54 offen offset:1024 lds
MAA 124,44,80
TR 34,25,26400
MAA 140,44,84
TR 36,25,26880
MAA 144,48,84
buffer_load_dwordx4 v20, s[20:23], s54 offen offset:2048 lds
MAA 128,48,80
TR 38,25,27392
s_add_u32 s54, s54, 196608
MAA 132,52,80
buffer_load_dword v37, v34, s[40:43], 0 offen sc1
MAA 148,52,84
TR 40,25,26912
MAA 152,56,84
TR 42,25,27424
MAA 136,56,80
s_waitcnt vmcnt(22) lgkmcnt(8)
s_barrier
MAA 60,20,0
RD 44,30,36992
s_add_u32 m0, s56, 86400
MAA 76,24,0
buffer_load_dwordx4 v18, s[20:23], s54 offen lds
MAA 80,24,4
s_sub_u32 s47, s47, 1
s_cbranch_scc1 .Lx6
.Lx6b:
MAA 64,20,4
buffer_load_dwordx4 v19, s[20:23], s54 offen offset:1024 lds
MAA 68,20,8
RD 48,30,39296
MAA 84,24,8
RD 52,30,41600
RD 56,30,43904
MAA 88,24,12
buffer_load_dwordx4 v20, s[20:23], s54 offen offset:2048 lds
MAA 72,20,12
s_add_u32 s54, s54, 196608
s_waitcnt lgkmcnt(4)
MAA 244,20,16
TR 64,25,37248
s_add_u32 m0, s55, 18496
MAA 104,28,12
buffer_load_dwordx4 v21, s[36:39], s52 offen lds
MAA 120,32,12
TR 66,25,37760
MAA 116,32,8
TR 68,25,37280
TR 70,25,37792
MAA 100,28,8
buffer_load_dwordx4 v28, s[36:39], s52 offen offset:1024 lds
MAA 96,28,4
RD 60,31,36992
MAA 112,32,4
buffer_load_dword v22, s[36:39], s52 offen offset:2048 lds
MAA 108,32,0
TR 72,25,38272
s_add_u32 s52, s52, 128
MAA 92,28,0
s_add_u32 m0, s55, 20800
MAA 156,28,16
buffer_load_dwordx4 v21, s[36:39], s53 offen lds
MAA 160,32,16
TR 74,25,38784
TR 76,25,38304
MAA 124,0,36
TR 78,25,38816
MAA 140,0,40
buffer_load_dwordx4 v28, s[36:39], s53 offen offset:1024 lds
MAA 144,4,40
TR 80,25,39296
MAA 128,4,36
TR 82,25,39808
TR 84,25,39328
MAA 132,8,36
buffer_load_dword v29, s[36:39], s53 offen offset:2048 lds
MAA 148,8,40
s_add_u32 s53, s53, 128
MAA 152,12,40
TR 86,25,39840
MAA 136,12,36
s_waitcnt vmcnt(22) lgkmcnt(8)
s_barrier
MAA 60,64,44
RD 0,23,55488
s_add_u32 m0, s56, 98816
MAA 76,68,44
buffer_load_dwordx4 v18, s[20:23], s54 offen lds
MAA 80,68,48
RD 4,23,57792
MAA 64,64,48
RD 8,23,60096
MAA 68,64,52
RD 12,23,62400
MAA 84,68,52
buffer_load_dwordx4 v19, s[20:23], s54 offen offset:1024 lds
MAA 88,68,56
TR 20,25,49664
MAA 72,64,56
TR 22,25,50176
s_waitcnt lgkmcnt(6)
MAA 244,64,60
MAA 104,72,56
buffer_load_dwordx4 v20, s[20:23], s54 offen offset:2048 lds
MAA 120,76,56
TR 24,25,49696
s_add_u32 s54, s54, 196608
MAA 116,76,52
TR 26,25,50208
MAA 100,72,52
RD 16,24,55488
s_add_u32 m0, s55, 36992
MAA 96,72,48
buffer_load_dwordx4 v21, s[36:39], s52 offen lds
MAA 112,76,48
TR 28,25,50688
MAA 108,76,44
TR 30,25,51200
MAA 92,72,44
TR 32,25,50720
MAA 156,72,60
buffer_load_dwordx4 v28, s[36:39], s52 offen offset:1024 lds
MAA 160,76,60
MAA 124,44,80
TR 34,25,51232
MAA 140,44,84
TR 36,25,51712
MAA 144,48,84
buffer_load_dword v22, s[36:39], s52 offen offset:2048 lds
MAA 128,48,80
TR 38,25,52224
s_add_u32 s52, s52, 128
MAA 132,52,80
TR 40,25,51744
MAA 148,52,84
TR 42,25,52256
MAA 152,56,84
MAA 136,56,80
s_waitcnt vmcnt(25) lgkmcnt(8)
s_barrier
MAA 60,20,0
RD 44,30,55488
s_add_u32 m0, s56, 111232
MAA 76,24,0
buffer_load_dwordx4 v18, s[20:23], s54 offen lds
MAA 80,24,4
s_sub_u32 s47, s47, 1
s_cbranch_scc1 .Lx7
.Lx7b:
MAA 64,20,4
RD 48,30,57792
MAA 68,20,8
RD 52,30,60096
MAA 84,24,8
buffer_load_dwordx4 v19, s[20:23], s54 offen offset:1024 lds
MAA 88,24,12
RD 56,30,62400
MAA 72,20,12
TR 64,25,62080
s_waitcnt lgkmcnt(5)
MAA 244,20,16
TR 66,25,62592
MAA 104,28,12
buffer_load_dwordx4 v20, s[20:23], s54 offen offset:2048 lds
MAA 120,32,12
TR 68,25,62112
s_add_u32 s54, s54, 196608
MAA 116,32,8
TR 70,25,62624
MAA 100,28,8
RD 60,31,55488
s_add_u32 m0, s55, 39296
MAA 96,28,4
buffer_load_dwordx4 v21, s[36:39], s53 offen lds
MAA 112,32,4
MAA 108,32,0
TR 72,25,63104
MAA 92,28,0
TR 74,25,63616
MAA 156,28,16
buffer_load_dwordx4 v28, s[36:39], s53 offen offset:1024 lds
MAA 160,32,16
TR 76,25,63136
MAA 124,0,36
TR 78,25,63648
MAA 140,0,40
TR 80,25,64128
MAA 144,4,40
buffer_load_dword v29, s[36:39], s53 offen offset:2048 lds
MAA 128,4,36
TR 82,25,64640
s_add_u32 s53, s53, 128
MAA 132,8,36
TR 84,25,64160
MAA 148,8,40
TR 86,25,64672
MAA 152,12,40
MAA 136,12,36
s_waitcnt vmcnt(22) lgkmcnt(8)
s_barrier
s_waitcnt vmcnt(21)
v_cmp_gt_u32 vcc, v35, v37
s_nop 0
s_cbranch_vccnz .Lsp8
.Lsp8b:
v_mov_b32 v37, 0
MAA 60,64,44
ds_read_b128 a[0:3], v23
MAA 76,68,44
buffer_atomic_add v38, v32, s[16:19], 0 offen
MAA 80,68,48
RD 4,23,2304
MAA 64,64,48
RD 8,23,4608
s_add_u32 m0, s56, 123648
MAA 68,64,52
buffer_load_dwordx4 v18, s[20:23], s54 offen lds
MAA 84,68,52
RD 12,23,6912
MAA 88,68,56
ds_read_b64_tr_b16 a[20:21], v25
MAA 72,64,56
TR 22,25,512
s_waitcnt lgkmcnt(6)
MAA 244,64,60
buffer_load_dwordx4 v19, s[20:23], s54 offen offset:1024 lds
MAA 104,72,56
TR 24,25,32
MAA 120,76,56
TR 26,25,544
MAA 116,76,52
buffer_load_dwordx4 v20, s[20:23], s54 offen offset:2048 lds
MAA 100,72,52
ds_read_b128 a[16:19], v24
s_add_u32 s54, s54, 196608
MAA 96,72,48
MAA 112,76,48
TR 28,25,1024
s_add_u32 m0, s55, 55488
MAA 108,76,44
buffer_load_dwordx4 v21, s[36:39], s52 offen lds
MAA 92,72,44
TR 30,25,1536
MAA 156,72,60
TR 32,25,1056
MAA 160,76,60
buffer_load_dwordx4 v28, s[36:39], s52 offen offset:1024 lds
MAA 124,44,80
TR 34,25,1568
MAA 140,44,84
TR 36,25,2048
MAA 144,48,84
TR 38,25,2560
MAA 128,48,80
buffer_load_dword v22, s[36:39], s52 offen offset:2048 lds
MAA 132,52,80
TR 40,25,2080
s_add_u32 s52, s52, 128
MAA 148,52,84
TR 42,25,2592
MAA 152,56,84
MAA 136,56,80
s_waitcnt vmcnt(25) lgkmcnt(8)
s_barrier
MAA 60,20,0
ds_read_b128 a[44:47], v30
s_add_u32 m0, s56, 136064
MAA 76,24,0
buffer_load_dwordx4 v18, s[20:23], s54 offen lds
MAA 80,24,4
s_sub_u32 s47, s47, 1
s_cbranch_scc1 .Lx9
.Lx9b:
MAA 64,20,4
RD 48,30,2304
MAA 68,20,8
RD 52,30,4608
MAA 84,24,8
buffer_load_dwordx4 v19, s[20:23], s54 offen offset:1024 lds
MAA 88,24,12
RD 56,30,6912
MAA 72,20,12
TR 64,25,12416
s_waitcnt lgkmcnt(5)
MAA 244,20,16
TR 66,25,12928
MAA 104,28,12
buffer_load_dwordx4 v20, s[20:23], s54 offen offset:2048 lds
MAA 120,32,12
TR 68,25,12448
s_add_u32 s54, s54, 196608
MAA 116,32,8
TR 70,25,12960
MAA 100,28,8
ds_read_b128 a[60:63], v31
s_add_u32 m0, s55, 57792
MAA 96,28,4
buffer_load_dwordx4 v21, s[36:39], s53 offen lds
MAA 112,32,4
MAA 108,32,0
TR 72,25,13440
MAA 92,28,0
TR 74,25,13952
MAA 156,28,16
buffer_load_dwordx4 v28, s[36:39], s53 offen offset:1024 lds
MAA 160,32,16
TR 76,25,13472
MAA 124,0,36
TR 78,25,13984
MAA 140,0,40
TR 80,25,14464
MAA 144,4,40
buffer_load_dword v29, s[36:39], s53 offen offset:2048 lds
MAA 128,4,36
TR 82,25,14976
s_add_u32 s53, s53, 128
MAA 132,8,36
TR 84,25,14496
MAA 148,8,40
TR 86,25,15008
MAA 152,12,40
MAA 136,12,36
s_waitcnt vmcnt(22) lgkmcnt(8)
s_barrier
MAA 60,64,44
RD 0,23,18496
s_add_u32 m0, s56, 73984
MAA 76,68,44
buffer_load_dwordx4 v18, s[20:23], s54 offen lds
MAA 80,68,48
RD 4,23,20800
MAA 64,64,48
RD 8,23,23104
MAA 68,64,52
RD 12,23,25408
MAA 84,68,52
buffer_load_dwordx4 v19, s[20:23], s54 offen offset:1024 lds
MAA 88,68,56
TR 20,25,24832
MAA 72,64,56
TR 22,25,25344
s_waitcnt lgkmcnt(6)
MAA 244,64,60
MAA 104,72,56
buffer_load_dwordx4 v20, s[20:23], s54 offen offset:2048 lds
MAA 120,76,56
TR 24,25,24864
s_add_u32 s54, s54, 196608
MAA 116,76,52
TR 26,25,25376
MAA 100,72,52
RD 16,24,18496
s_add_u32 m0, s55, 0
MAA 96,72,48
buffer_load_dwordx4 v21, s[36:39], s52 offen lds
MAA 112,76,48
TR 28,25,25856
MAA 108,76,44
TR 30,25,26368
MAA 92,72,44
TR 32,25,25888
MAA 156,72,60
buffer_load_dwordx4 v28, s[36:39], s52 offen offset:1024 lds
MAA 160,76,60
MAA 124,44,80
TR 34,25,26400
MAA 140,44,84
TR 36,25,26880
MAA 144,48,84
buffer_load_dword v22, s[36:39], s52 offen offset:2048 lds
MAA 128,48,80
TR 38,25,27392
s_add_u32 s52, s52, 128
MAA 132,52,80
TR 40,25,26912
MAA 148,52,84
TR 42,25,27424
MAA 152,56,84
MAA 136,56,80
s_waitcnt vmcnt(22) lgkmcnt(8)
s_barrier
MAA 60,20,0
RD 44,30,18496
s_add_u32 m0, s56, 86400
MAA 76,24,0
buffer_load_dwordx4 v18, s[20:23], s54 offen lds
MAA 80,24,4
s_sub_u32 s47, s47, 1
s_cbranch_scc1 .Lx10
.Lx10b:
MAA 64,20,4
RD 48,30,20800
MAA 68,20,8
RD 52,30,23104
MAA 84,24,8
buffer_load_dwordx4 v19, s[20:23], s54 offen offset:1024 lds
MAA 88,24,12
RD 56,30,25408
MAA 72,20,12
TR 64,25,37248
s_waitcnt lgkmcnt(5)
MAA 244,20,16
TR 66,25,37760
MAA 104,28,12
buffer_load_dwordx4 v20, s[20:23], s54 offen offset:2048 lds
MAA 120,32,12
TR 68,25,37280
s_add_u32 s54, s54, 196608
MAA 116,32,8
TR 70,25,37792
MAA 100,28,8
RD 60,31,18496
s_add_u32 m0, s55, 2304
MAA 96,28,4
buffer_load_dwordx4 v21, s[36:39], s53 offen lds
MAA 112,32,4
MAA 108,32,0
TR 72,25,38272
MAA 92,28,0
TR 74,25,38784
MAA 156,28,16
buffer_load_dwordx4 v28, s[36:39], s53 offen offset:1024 lds
MAA 160,32,16
TR 76,25,38304
MAA 124,0,36
TR 78,25,38816
MAA 140,0,40
TR 80,25,39296
MAA 144,4,40
buffer_load_dword v29, s[36:39], s53 offen offset:2048 lds
MAA 128,4,36
TR 82,25,39808
s_add_u32 s53, s53, 128
MAA 132,8,36
TR 84,25,39328
MAA 148,8,40
TR 86,25,39840
MAA 152,12,40
MAA 136,12,36
s_waitcnt vmcnt(21) lgkmcnt(8)
s_barrier
MAA 60,64,44
RD 0,23,36992
s_add_u32 m0, s56, 98816
MAA 76,68,44
buffer_load_dwordx4 v18, s[20:23], s54 offen lds
MAA 80,68,48
RD 4,23,39296
MAA 64,64,48
RD 8,23,41600
MAA 68,64,52
RD 12,23,43904
MAA 84,68,52
buffer_load_dwordx4 v19, s[20:23], s54 offen offset:1024 lds
MAA 88,68,56
TR 20,25,49664
MAA 72,64,56
TR 22,25,50176
s_waitcnt lgkmcnt(6)
MAA 244,64,60
MAA 104,72,56
buffer_load_dwordx4 v20, s[20:23], s54 offen offset:2048 lds
MAA 120,76,56
TR 24,25,49696
s_add_u32 s54, s54, 196608
MAA 116,76,52
TR 26,25,50208
MAA 100,72,52
RD 16,24,36992
s_add_u32 m0, s55, 18496
MAA 96,72,48
buffer_load_dwordx4 v21, s[36:39], s52 offen lds
MAA 112,76,48
TR 28,25,50688
MAA 108,76,44
TR 30,25,51200
MAA 92,72,44
TR 32,25,50720
MAA 156,72,60
buffer_load_dwordx4 v28, s[36:39], s52 offen offset:1024 lds
MAA 160,76,60
MAA 124,44,80
TR 34,25,51232
MAA 140,44,84
TR 36,25,51712
MAA 144,48,84
buffer_load_dword v22, s[36:39], s52 offen offset:2048 lds
MAA 128,48,80
TR 38,25,52224
s_add_u32 s52, s52, 128
MAA 132,52,80
TR 40,25,51744
MAA 148,52,84
TR 42,25,52256
MAA 152,56,84
MAA 136,56,80
s_waitcnt vmcnt(21) lgkmcnt(8)
s_barrier
MAA 60,20,0
RD 44,30,36992
s_add_u32 m0, s56, 111232
MAA 76,24,0
buffer_load_dwordx4 v18, s[20:23], s54 offen lds
MAA 80,24,4
s_sub_u32 s47, s47, 1
s_cbranch_scc1 .Lx11
.Lx11b:
MAA 64,20,4
RD 48,30,39296
MAA 68,20,8
buffer_load_dwordx4 v19, s[20:23], s54 offen offset:1024 lds
MAA 84,24,8
RD 52,30,41600
MAA 88,24,12
RD 56,30,43904
MAA 72,20,12
TR 64,25,62080
s_waitcnt lgkmcnt(5)
MAA 244,20,16
buffer_load_dwordx4 v20, s[20:23], s54 offen offset:2048 lds
MAA 104,28,12
TR 66,25,62592
s_add_u32 s54, s54, 196608
MAA 120,32,12
TR 68,25,62112
s_add_u32 m0, s55, 20800
MAA 116,32,8
buffer_load_dwordx4 v21, s[36:39], s53 offen lds
MAA 100,28,8
TR 70,25,62624
MAA 96,28,4
RD 60,31,36992
MAA 112,32,4
TR 72,25,63104
MAA 108,32,0
buffer_load_dwordx4 v28, s[36:39], s53 offen offset:1024 lds
MAA 92,28,0
TR 74,25,63616
MAA 156,28,16
TR 76,25,63136
MAA 160,32,16
buffer_load_dword v29, s[36:39], s53 offen offset:2048 lds
MAA 124,0,36
TR 78,25,63648
s_add_u32 s53, s53, 128
MAA 140,0,40
TR 80,25,64128
MAA 144,4,40
TR 82,25,64640
MAA 128,4,36
buffer_atomic_add v37, v33, s[16:19], 0 offen sc0
MAA 132,8,36
TR 84,25,64160
MAA 148,8,40
TR 86,25,64672
MAA 152,12,40
MAA 136,12,36
s_waitcnt vmcnt(22) lgkmcnt(8)
s_barrier
MAA 60,64,44
RD 0,23,55488
s_add_u32 m0, s56, 123648
MAA 76,68,44
buffer_load_dwordx4 v18, s[20:23], s54 offen lds
MAA 80,68,48
RD 4,23,57792
MAA 64,64,48
RD 8,23,60096
MAA 68,64,52
RD 12,23,62400
MAA 84,68,52
buffer_load_dwordx4 v19, s[20:23], s54 offen offset:1024 lds
MAA 88,68,56
ds_read_b64_tr_b16 a[20:21], v25
MAA 72,64,56
TR 22,25,512
s_waitcnt lgkmcnt(6)
MAA 244,64,60
MAA 104,72,56
buffer_load_dwordx4 v20, s[20:23], s54 offen offset:2048 lds
MAA 120,76,56
TR 24,25,32
s_add_u32 s54, s54, 196608
MAA 116,76,52
TR 26,25,544
MAA 100,72,52
RD 16,24,55488
s_add_u32 m0, s55, 36992
MAA 96,72,48
buffer_load_dwordx4 v21, s[36:39], s52 offen lds
MAA 112,76,48
TR 28,25,1024
MAA 108,76,44
TR 30,25,1536
MAA 92,72,44
TR 32,25,1056
MAA 156,72,60
buffer_load_dwordx4 v28, s[36:39], s52 offen offset:1024 lds
MAA 160,76,60
MAA 124,44,80
TR 34,25,1568
MAA 140,44,84
TR 36,25,2048
MAA 144,48,84
buffer_load_dword v22, s[36:39], s52 offen offset:2048 lds
MAA 128,48,80
TR 38,25,2560
s_add_u32 s52, s52, 128
MAA 132,52,80
TR 40,25,2080
MAA 148,52,84
TR 42,25,2592
MAA 152,56,84
MAA 136,56,80
s_waitcnt vmcnt(22) lgkmcnt(8)
s_barrier
MAA 60,20,0
RD 44,30,55488
s_add_u32 m0, s56, 136064
MAA 76,24,0
buffer_load_dwordx4 v18, s[20:23], s54 offen lds
MAA 80,24,4
s_sub_u32 s47, s47, 1
s_cbranch_scc1 .Lx12
.Lx12b:
MAA 64,20,4
RD 48,30,57792
MAA 68,20,8
RD 52,30,60096
MAA 84,24,8
buffer_load_dwordx4 v19, s[20:23], s54 offen offset:1024 lds
MAA 88,24,12
RD 56,30,62400
MAA 72,20,12
TR 64,25,12416
s_waitcnt lgkmcnt(5)
MAA 244,20,16
TR 66,25,12928
MAA 104,28,12
buffer_load_dwordx4 v20, s[20:23], s54 offen offset:2048 lds
MAA 120,32,12
TR 68,25,12448
s_add_u32 s54, s54, 196608
MAA 116,32,8
TR 70,25,12960
MAA 100,28,8
RD 60,31,55488
s_add_u32 m0, s55, 39296
MAA 96,28,4
buffer_load_dwordx4 v21, s[36:39], s53 offen lds
MAA 112,32,4
MAA 108,32,0
TR 72,25,13440
MAA 92,28,0
TR 74,25,13952
MAA 156,28,16
buffer_load_dwordx4 v28, s[36:39], s53 offen offset:1024 lds
MAA 160,32,16
TR 76,25,13472
MAA 124,0,36
TR 78,25,13984
MAA 140,0,40
TR 80,25,14464
MAA 144,4,40
buffer_load_dword v29, s[36:39], s53 offen offset:2048 lds
MAA 128,4,36
TR 82,25,14976
s_add_u32 s53, s53, 128
MAA 132,8,36
TR 84,25,14496
MAA 148,8,40
TR 86,25,15008
MAA 152,12,40
MAA 136,12,36
s_waitcnt vmcnt(22) lgkmcnt(8)
s_barrier
MAA 60,64,44
ds_read_b128 a[0:3], v23
s_add_u32 m0, s56, 73984
MAA 76,68,44
buffer_load_dwordx4 v18, s[20:23], s54 offen lds
MAA 80,68,48
RD 4,23,2304
MAA 64,64,48
RD 8,23,4608
MAA 68,64,52
RD 12,23,6912
MAA 84,68,52
buffer_load_dwordx4 v19, s[20:23], s54 offen offset:1024 lds
MAA 88,68,56
TR 20,25,24832
MAA 72,64,56
TR 22,25,25344
s_waitcnt lgkmcnt(6)
MAA 244,64,60
MAA 104,72,56
buffer_load_dwordx4 v20, s[20:23], s54 offen offset:2048 lds
MAA 120,76,56
TR 24,25,24864
s_add_u32 s54, s54, 196608
MAA 116,76,52
TR 26,25,25376
MAA 100,72,52
ds_read_b128 a[16:19], v24
s_add_u32 m0, s55, 55488
MAA 96,72,48
buffer_load_dwordx4 v21, s[36:39], s52 offen lds
MAA 112,76,48
TR 28,25,25856
MAA 108,76,44
TR 30,25,26368
MAA 92,72,44
TR 32,25,25888
MAA 156,72,60
buffer_load_dwordx4 v28, s[36:39], s52 offen offset:1024 lds
MAA 160,76,60
MAA 124,44,80
TR 34,25,26400
MAA 140,44,84
TR 36,25,26880
MAA 144,48,84
buffer_load_dword v22, s[36:39], s52 offen offset:2048 lds
MAA 128,48,80
TR 38,25,27392
s_add_u32 s52, s52, 128
MAA 132,52,80
TR 40,25,26912
MAA 148,52,84
TR 42,25,27424
MAA 152,56,84
MAA 136,56,80
s_waitcnt vmcnt(22) lgkmcnt(8)
s_barrier
MAA 60,20,0
ds_read_b128 a[44:47], v30
s_add_u32 m0, s56, 86400
MAA 76,24,0
buffer_load_dwordx4 v18, s[20:23], s54 offen lds
MAA 80,24,4
s_sub_u32 s47, s47, 1
s_cbranch_scc1 .Lx13
.Lx13b:
MAA 64,20,4
RD 48,30,2304
MAA 68,20,8
RD 52,30,4608
MAA 84,24,8
buffer_load_dwordx4 v19, s[20:23], s54 offen offset:1024 lds
MAA 88,24,12
RD 56,30,6912
MAA 72,20,12
TR 64,25,37248
s_waitcnt lgkmcnt(5)
MAA 244,20,16
TR 66,25,37760
MAA 104,28,12
buffer_load_dwordx4 v20, s[20:23], s54 offen offset:2048 lds
MAA 120,32,12
TR 68,25,37280
s_add_u32 s54, s54, 196608
MAA 116,32,8
TR 70,25,37792
MAA 100,28,8
ds_read_b128 a[60:63], v31
s_add_u32 m0, s55, 57792
MAA 96,28,4
buffer_load_dwordx4 v21, s[36:39], s53 offen lds
MAA 112,32,4
MAA 108,32,0
TR 72,25,38272
MAA 92,28,0
TR 74,25,38784
MAA 156,28,16
buffer_load_dwordx4 v28, s[36:39], s53 offen offset:1024 lds
MAA 160,32,16
TR 76,25,38304
MAA 124,0,36
TR 78,25,38816
MAA 140,0,40
TR 80,25,39296
MAA 144,4,40
buffer_load_dword v29, s[36:39], s53 offen offset:2048 lds
MAA 128,4,36
TR 82,25,39808
s_add_u32 s53, s53, 128
MAA 132,8,36
TR 84,25,39328
MAA 148,8,40
TR 86,25,39840
MAA 152,12,40
MAA 136,12,36
s_waitcnt vmcnt(24)
v_cmp_gt_u32 vcc, v36, v37
s_nop 0
s_cbranch_vccnz .Lsp14
.Lsp14b:
s_waitcnt vmcnt(21) lgkmcnt(8)
s_barrier
MAA 60,64,44
RD 0,23,18496
s_add_u32 m0, s56, 98816
MAA 76,68,44
buffer_load_dwordx4 v18, s[20:23], s54 offen lds
MAA 80,68,48
RD 4,23,20800
MAA 64,64,48
RD 8,23,23104
MAA 68,64,52
buffer_load_dwordx4 v19, s[20:23], s54 offen offset:1024 lds
MAA 84,68,52
RD 12,23,25408
MAA 88,68,56
TR 20,25,49664
MAA 72,64,56
TR 22,25,50176
s_waitcnt lgkmcnt(6)
MAA 244,64,60
buffer_load_dwordx4 v20, s[20:23], s54 offen offset:2048 lds
MAA 104,72,56
TR 24,25,49696
s_add_u32 s54, s54, 196608
MAA 120,76,56
TR 26,25,50208
s_add_u32 m0, s55, 0
MAA 116,76,52
buffer_load_dwordx4 v21, s[36:39], s52 offen lds
MAA 100,72,52
RD 16,24,18496
MAA 96,72,48
MAA 112,76,48
TR 28,25,50688
MAA 108,76,44
buffer_load_dwordx4 v28, s[36:39], s52 offen offset:1024 lds
MAA 92,72,44
TR 30,25,51200
MAA 156,72,60
TR 32,25,50720
MAA 160,76,60
buffer_load_dword v22, s[36:39], s52 offen offset:2048 lds
MAA 124,44,80
TR 34,25,51232
s_add_u32 s52, s52, 128
MAA 140,44,84
TR 36,25,51712
MAA 144,48,84
TR 38,25,52224
MAA 128,48,80
buffer_load_dwordx4 v[164:167], v26, s[16:19], s75 offen sc1
MAA 132,52,80
TR 40,25,51744
MAA 148,52,84
TR 42,25,52256
MAA 152,56,84
MAA 136,56,80
s_waitcnt vmcnt(22) lgkmcnt(8)
s_barrier
MAA 60,20,0
RD 44,30,18496
s_add_u32 m0, s56, 111232
MAA 76,24,0
buffer_load_dwordx4 v18, s[20:23], s54 offen lds
MAA 80,24,4
s_sub_u32 s47, s47, 1
s_cbranch_scc1 .Lx15
.Lx15b:
MAA 64,20,4
RD 48,30,20800
MAA 68,20,8
buffer_load_dwordx4 v19, s[20:23], s54 offen offset:1024 lds
MAA 84,24,8
RD 52,30,23104
MAA 88,24,12
RD 56,30,25408
MAA 72,20,12
TR 64,25,62080
s_waitcnt lgkmcnt(5)
MAA 244,20,16
buffer_load_dwordx4 v20, s[20:23], s54 offen offset:2048 lds
MAA 104,28,12
TR 66,25,62592
s_add_u32 s54, s54, 196608
MAA 120,32,12
TR 68,25,62112
s_add_u32 m0, s55, 2304
MAA 116,32,8
buffer_load_dwordx4 v21, s[36:39], s53 offen lds
MAA 100,28,8
TR 70,25,62624
MAA 96,28,4
RD 60,31,18496
MAA 112,32,4
TR 72,25,63104
MAA 108,32,0
buffer_load_dwordx4 v28, s[36:39], s53 offen offset:1024 lds
MAA 92,28,0
TR 74,25,63616
MAA 156,28,16
TR 76,25,63136
MAA 160,32,16
buffer_load_dword v29, s[36:39], s53 offen offset:2048 lds
MAA 124,0,36
TR 78,25,63648
s_add_u32 s53, s53, 128
MAA 140,0,40
TR 80,25,64128
MAA 144,4,40
TR 82,25,64640
MAA 128,4,36
buffer_load_dwordx4 v[168:171], v26, s[16:19], s75 offen offset:1024 sc1
MAA 132,8,36
TR 84,25,64160
MAA 148,8,40
TR 86,25,64672
MAA 152,12,40
MAA 136,12,36
s_waitcnt vmcnt(23) lgkmcnt(8)
s_barrier
MAA 60,64,44
RD 0,23,36992
s_add_u32 m0, s56, 123648
MAA 76,68,44
buffer_load_dwordx4 v18, s[20:23], s54 offen lds
MAA 80,68,48
RD 4,23,39296
MAA 64,64,48
RD 8,23,41600
MAA 68,64,52
buffer_load_dwordx4 v19, s[20:23], s54 offen offset:1024 lds
MAA 84,68,52
RD 12,23,43904
MAA 88,68,56
ds_read_b64_tr_b16 a[20:21], v25
MAA 72,64,56
TR 22,25,512
s_waitcnt lgkmcnt(6)
MAA 244,64,60
buffer_load_dwordx4 v20, s[20:23], s54 offen offset:2048 lds
MAA 104,72,56
TR 24,25,32
s_add_u32 s54, s54, 196608
MAA 120,76,56
TR 26,25,544
s_add_u32 m0, s55, 18496
MAA 116,76,52
buffer_load_dwordx4 v21, s[36:39], s52 offen lds
MAA 100,72,52
RD 16,24,36992
MAA 96,72,48
MAA 112,76,48
TR 28,25,1024
MAA 108,76,44
buffer_load_dwordx4 v28, s[36:39], s52 offen offset:1024 lds
MAA 92,72,44
TR 30,25,1536
MAA 156,72,60
TR 32,25,1056
MAA 160,76,60
buffer_load_dword v22, s[36:39], s52 offen offset:2048 lds
MAA 124,44,80
TR 34,25,1568
s_add_u32 s52, s52, 128
MAA 140,44,84
TR 36,25,2048
MAA 144,48,84
TR 38,25,2560
MAA 128,48,80
buffer_load_dwordx4 v[172:175], v26, s[16:19], s75 offen offset:2048 sc1
MAA 132,52,80
TR 40,25,2080
MAA 148,52,84
TR 42,25,2592
MAA 152,56,84
MAA 136,56,80
s_waitcnt vmcnt(24) lgkmcnt(8)
s_barrier
MAA 60,20,0
RD 44,30,36992
s_add_u32 m0, s56, 136064
MAA 76,24,0
buffer_load_dwordx4 v18, s[20:23], s54 offen lds
MAA 80,24,4
s_sub_u32 s47, s47, 1
s_cbranch_scc1 .Lx16
.Lx16b:
MAA 64,20,4
RD 48,30,39296
MAA 68,20,8
buffer_load_dwordx4 v19, s[20:23], s54 offen offset:1024 lds
MAA 84,24,8
RD 52,30,41600
MAA 88,24,12
RD 56,30,43904
MAA 72,20,12
TR 64,25,12416
s_waitcnt lgkmcnt(5)
MAA 244,20,16
buffer_load_dwordx4 v20, s[20:23], s54 offen offset:2048 lds
MAA 104,28,12
TR 66,25,12928
s_add_u32 s54, s54, 196608
MAA 120,32,12
TR 68,25,12448
s_add_u32 m0, s55, 20800
MAA 116,32,8
buffer_load_dwordx4 v21, s[36:39], s53 offen lds
MAA 100,28,8
TR 70,25,12960
MAA 96,28,4
RD 60,31,36992
MAA 112,32,4
TR 72,25,13440
MAA 108,32,0
buffer_load_dwordx4 v28, s[36:39], s53 offen offset:1024 lds
MAA 92,28,0
TR 74,25,13952
MAA 156,28,16
TR 76,25,13472
MAA 160,32,16
buffer_load_dword v29, s[36:39], s53 offen offset:2048 lds
MAA 124,0,36
TR 78,25,13984
s_add_u32 s53, s53, 128
MAA 140,0,40
TR 80,25,14464
MAA 144,4,40
TR 82,25,14976
MAA 128,4,36
buffer_load_dwordx4 v[176:179], v26, s[16:19], s75 offen offset:3072 sc1
MAA 132,8,36
TR 84,25,14496
s_add_u32 s75, s75, 4096
MAA 148,8,40
TR 86,25,15008
MAA 152,12,40
MAA 136,12,36
s_waitcnt vmcnt(25) lgkmcnt(8)
s_barrier
MAA 60,64,44
RD 0,23,55488
s_add_u32 m0, s56, 73984
MAA 76,68,44
buffer_load_dwordx4 v18, s[20:23], s54 offen lds
MAA 80,68,48
RD 4,23,57792
MAA 64,64,48
RD 8,23,60096
MAA 68,64,52
buffer_load_dwordx4 v19, s[20:23], s54 offen offset:1024 lds
MAA 84,68,52
RD 12,23,62400
MAA 88,68,56
TR 20,25,24832
MAA 72,64,56
TR 22,25,25344
s_waitcnt lgkmcnt(6)
MAA 244,64,60
buffer_load_dwordx4 v20, s[20:23], s54 offen offset:2048 lds
MAA 104,72,56
TR 24,25,24864
s_add_u32 s54, s54, 196608
MAA 120,76,56
TR 26,25,25376
s_add_u32 m0, s55, 36992
MAA 116,76,52
buffer_load_dwordx4 v21, s[36:39], s52 offen lds
MAA 100,72,52
RD 16,24,55488
MAA 96,72,48
MAA 112,76,48
TR 28,25,25856
MAA 108,76,44
buffer_load_dwordx4 v28, s[36:39], s52 offen offset:1024 lds
MAA 92,72,44
TR 30,25,26368
MAA 156,72,60
TR 32,25,25888
MAA 160,76,60
buffer_load_dword v22, s[36:39], s52 offen offset:2048 lds
MAA 124,44,80
TR 34,25,26400
s_add_u32 s52, s52, 128
MAA 140,44,84
TR 36,25,26880
MAA 144,48,84
TR 38,25,27392
MAA 128,48,80
buffer_load_dwordx4 v[180:183], v26, s[16:19], s75 offen sc1
MAA 132,52,80
TR 40,25,26912
MAA 148,52,84
TR 42,25,27424
MAA 152,56,84
MAA 136,56,80
s_waitcnt vmcnt(25) lgkmcnt(8)
s_barrier
MAA 60,20,0
RD 44,30,55488
s_add_u32 m0, s56, 86400
MAA 76,24,0
buffer_load_dwordx4 v18, s[20:23], s54 offen lds
MAA 80,24,4
s_sub_u32 s47, s47, 1
s_cbranch_scc1 .Lx17
.Lx17b:
MAA 64,20,4
RD 48,30,57792
s_waitcnt vmcnt(22)
v_add_f32 v164, v164, v168
MAA 68,20,8
buffer_load_dwordx4 v19, s[20:23], s54 offen offset:1024 lds
MAA 84,24,8
RD 52,30,60096
MAA 88,24,12
RD 56,30,62400
MAA 72,20,12
TR 64,25,37248
s_waitcnt lgkmcnt(5)
MAA 244,20,16
buffer_load_dwordx4 v20, s[20:23], s54 offen offset:2048 lds
MAA 104,28,12
TR 66,25,37760
s_add_u32 s54, s54, 196608
MAA 120,32,12
TR 68,25,37280
s_add_u32 m0, s55, 39296
MAA 116,32,8
buffer_load_dwordx4 v21, s[36:39], s53 offen lds
MAA 100,28,8
TR 70,25,37792
v_add_f32 v165, v165, v169
MAA 96,28,4
RD 60,31,55488
MAA 112,32,4
TR 72,25,38272
MAA 108,32,0
buffer_load_dwordx4 v28, s[36:39], s53 offen offset:1024 lds
MAA 92,28,0
TR 74,25,38784
MAA 156,28,16
TR 76,25,38304
v_add_f32 v166, v166, v170
MAA 160,32,16
buffer_load_dword v29, s[36:39], s53 offen offset:2048 lds
MAA 124,0,36
TR 78,25,38816
s_add_u32 s53, s53, 128
MAA 140,0,40
TR 80,25,39296
MAA 144,4,40
TR 82,25,39808
MAA 128,4,36
buffer_load_dwordx4 v[184:187], v26, s[16:19], s75 offen offset:1024 sc1
MAA 132,8,36
TR 84,25,39328
v_add_f32 v167, v167, v171
MAA 148,8,40
TR 86,25,39840
MAA 152,12,40
MAA 136,12,36
s_waitcnt vmcnt(25) lgkmcnt(8)
s_barrier
MAA 60,64,44
ds_read_b128 a[0:3], v23
s_add_u32 m0, s56, 98816
MAA 76,68,44
buffer_load_dwordx4 v18, s[20:23], s54 offen lds
MAA 80,68,48
RD 4,23,2304
s_waitcnt vmcnt(22)
v_add_f32 v164, v164, v172
MAA 64,64,48
RD 8,23,4608
MAA 68,64,52
buffer_load_dwordx4 v19, s[20:23], s54 offen offset:1024 lds
MAA 84,68,52
RD 12,23,6912
MAA 88,68,56
TR 20,25,49664
MAA 72,64,56
TR 22,25,50176
s_waitcnt lgkmcnt(6)
MAA 244,64,60
buffer_load_dwordx4 v20, s[20:23], s54 offen offset:2048 lds
MAA 104,72,56
TR 24,25,49696
s_add_u32 s54, s54, 196608
MAA 120,76,56
TR 26,25,50208
s_add_u32 m0, s55, 55488
MAA 116,76,52
buffer_load_dwordx4 v21, s[36:39], s52 offen lds
MAA 100,72,52
ds_read_b128 a[16:19], v24
v_add_f32 v165, v165, v173
MAA 96,72,48
MAA 112,76,48
TR 28,25,50688
MAA 108,76,44
buffer_load_dwordx4 v28, s[36:39], s52 offen offset:1024 lds
MAA 92,72,44
TR 30,25,51200
v_add_f32 v166, v166, v174
MAA 156,72,60
TR 32,25,50720
MAA 160,76,60
buffer_load_dword v22, s[36:39], s52 offen offset:2048 lds
MAA 124,44,80
TR 34,25,51232
s_add_u32 s52, s52, 128
MAA 140,44,84
TR 36,25,51712
MAA 144,48,84
TR 38,25,52224
MAA 128,48,80
buffer_load_dwordx4 v[188:191], v26, s[16:19], s75 offen offset:2048 sc1
MAA 132,52,80
TR 40,25,51744
v_add_f32 v167, v167, v175
MAA 148,52,84
TR 42,25,52256
MAA 152,56,84
MAA 136,56,80
s_waitcnt vmcnt(25) lgkmcnt(8)
s_barrier
MAA 60,20,0
ds_read_b128 a[44:47], v30
s_add_u32 m0, s56, 111232
MAA 76,24,0
buffer_load_dwordx4 v18, s[20:23], s54 offen lds
MAA 80,24,4
RD 48,30,2304
s_waitcnt vmcnt(22)
v_add_f32 v164, v164, v176
MAA 64,20,4
RD 52,30,4608
MAA 68,20,8
buffer_load_dwordx4 v19, s[20:23], s54 offen offset:1024 lds
MAA 84,24,8
RD 56,30,6912
MAA 88,24,12
TR 64,25,62080
MAA 72,20,12
TR 66,25,62592
s_waitcnt lgkmcnt(6)
MAA 244,20,16
buffer_load_dwordx4 v20, s[20:23], s54 offen offset:2048 lds
MAA 104,28,12
TR 68,25,62112
s_add_u32 s54, s54, 196608
MAA 120,32,12
TR 70,25,62624
s_add_u32 m0, s55, 57792
MAA 116,32,8
buffer_load_dwordx4 v21, s[36:39], s53 offen lds
MAA 100,28,8
ds_read_b128 a[60:63], v31
v_add_f32 v165, v165, v177
MAA 96,28,4
MAA 112,32,4
TR 72,25,63104
MAA 108,32,0
buffer_load_dwordx4 v28, s[36:39], s53 offen offset:1024 lds
MAA 92,28,0
TR 74,25,63616
v_add_f32 v166, v166, v178
MAA 156,28,16
TR 76,25,63136
MAA 160,32,16
buffer_load_dword v29, s[36:39], s53 offen offset:2048 lds
MAA 124,0,36
TR 78,25,63648
s_add_u32 s53, s53, 128
MAA 140,0,40
TR 80,25,64128
MAA 144,4,40
TR 82,25,64640
MAA 128,4,36
buffer_load_dwordx4 v[192:195], v26, s[16:19], s75 offen offset:3072 sc1
MAA 132,8,36
TR 84,25,64160
v_add_f32 v167, v167, v179
MAA 148,8,40
TR 86,25,64672
MAA 152,12,40
MAA 136,12,36
s_waitcnt vmcnt(25) lgkmcnt(8)
s_barrier
MAA 60,64,44
RD 0,23,18496
s_add_u32 m0, s56, 123648
MAA 76,68,44
buffer_load_dwordx4 v18, s[20:23], s54 offen lds
MAA 80,68,48
RD 4,23,20800
s_waitcnt vmcnt(22)
v_add_f32 v164, v164, v180
MAA 64,64,48
RD 8,23,23104
MAA 68,64,52
MAA 84,68,52
RD 12,23,25408
MAA 88,68,56
ds_read_b64_tr_b16 a[20:21], v25
MAA 72,64,56
TR 22,25,512
s_waitcnt lgkmcnt(6)
MAA 244,64,60
v_add_f32 v165, v165, v181
MAA 104,72,56
buffer_load_dwordx4 v19, s[20:23], s54 offen offset:1024 lds
MAA 120,76,56
TR 24,25,32
MAA 116,76,52
TR 26,25,544
MAA 100,72,52
RD 16,24,18496
MAA 96,72,48
MAA 112,76,48
TR 28,25,1024
v_add_f32 v166, v166, v182
MAA 108,76,44
TR 30,25,1536
MAA 92,72,44
TR 32,25,1056
MAA 156,72,60
buffer_load_dwordx4 v20, s[20:23], s54 offen offset:2048 lds
MAA 160,76,60
s_add_u32 s54, s54, 196608
MAA 124,44,80
TR 34,25,1568
MAA 140,44,84
TR 36,25,2048
MAA 144,48,84
TR 38,25,2560
v_add_f32 v167, v167, v183
MAA 128,48,80
MAA 132,52,80
TR 40,25,2080
MAA 148,52,84
TR 42,25,2592
MAA 152,56,84
MAA 136,56,80
s_waitcnt vmcnt(21) lgkmcnt(8)
s_barrier
MAA 60,20,0
RD 44,30,18496
s_add_u32 m0, s56, 136064
MAA 76,24,0
buffer_load_dwordx4 v18, s[20:23], s54 offen lds
MAA 80,24,4
RD 48,30,20800
s_waitcnt vmcnt(18)
v_add_f32 v164, v164, v184
MAA 64,20,4
RD 52,30,23104
MAA 68,20,8
MAA 84,24,8
RD 56,30,25408
MAA 88,24,12
TR 64,25,12416
MAA 72,20,12
TR 66,25,12928
s_waitcnt lgkmcnt(6)
MAA 244,20,16
v_add_f32 v165, v165, v185
MAA 104,28,12
buffer_load_dwordx4 v19, s[20:23], s54 offen offset:1024 lds
MAA 120,32,12
TR 68,25,12448
MAA 116,32,8
TR 70,25,12960
MAA 100,28,8
RD 60,31,18496
MAA 96,28,4
MAA 112,32,4
TR 72,25,13440
v_add_f32 v166, v166, v186
MAA 108,32,0
TR 74,25,13952
MAA 92,28,0
TR 76,25,13472
MAA 156,28,16
buffer_load_dwordx4 v20, s[20:23], s54 offen offset:2048 lds
MAA 160,32,16
s_add_u32 s54, s54, 196608
MAA 124,0,36
TR 78,25,13984
MAA 140,0,40
TR 80,25,14464
MAA 144,4,40
TR 82,25,14976
v_add_f32 v167, v167, v187
MAA 128,4,36
MAA 132,8,36
TR 84,25,14496
MAA 148,8,40
TR 86,25,15008
MAA 152,12,40
MAA 136,12,36
s_waitcnt vmcnt(17) lgkmcnt(8)
s_barrier
MAA 60,64,44
s_add_u32 m0, s59, 0
s_mov_b32 s58, 1048576
s_waitcnt vmcnt(13)
v_add_f32 v164, v164, v188
MAA 76,68,44
buffer_load_dwordx4 v5, s[24:27], s58 offen lds
MAA 80,68,48
RD 0,23,36992
MAA 64,64,48
RD 4,23,39296
MAA 68,64,52
RD 8,23,41600
MAA 84,68,52
buffer_load_dwordx4 v6, s[24:27], s58 offen offset:1024 lds
MAA 88,68,56
RD 12,23,43904
v_add_f32 v165, v165, v189
MAA 72,64,56
TR 20,25,24832
s_waitcnt lgkmcnt(5)
MAA 244,64,60
s_add_u32 m0, s59, 8320
s_mov_b32 s58, 1179648
MAA 104,72,56
buffer_load_dwordx4 v5, s[24:27], s58 offen lds
MAA 120,76,56
TR 22,25,25344
MAA 116,76,52
TR 24,25,24864
MAA 100,72,52
TR 26,25,25376
MAA 96,72,48
buffer_load_dwordx4 v6, s[24:27], s58 offen offset:1024 lds
MAA 112,76,48
RD 16,24,36992
v_add_f32 v166, v166, v190
MAA 108,76,44
TR 28,25,25856
MAA 92,72,44
s_add_u32 m0, s59, 16640
s_mov_b32 s58, 1310720
MAA 156,72,60
buffer_load_dwordx4 v5, s[24:27], s58 offen lds
MAA 160,76,60
TR 30,25,26368
MAA 124,44,80
TR 32,25,25888
MAA 140,44,84
TR 34,25,26400
v_add_f32 v167, v167, v191
MAA 144,48,84
buffer_load_dwordx4 v6, s[24:27], s58 offen offset:1024 lds
MAA 128,48,80
TR 36,25,26880
MAA 132,52,80
TR 38,25,27392
MAA 148,52,84
TR 40,25,26912
MAA 152,56,84
TR 42,25,27424
MAA 136,56,80
s_waitcnt vmcnt(16) lgkmcnt(8)
s_barrier
MAA 60,20,0
s_add_u32 m0, s59, 24960
s_mov_b32 s58, 1441792
s_waitcnt vmcnt(12)
v_add_f32 v164, v164, v192
MAA 76,24,0
buffer_load_dwordx4 v5, s[24:27], s58 offen lds
MAA 80,24,4
RD 44,30,36992
MAA 64,20,4
RD 48,30,39296
MAA 68,20,8
RD 52,30,41600
MAA 84,24,8
buffer_load_dwordx4 v6, s[24:27], s58 offen offset:1024 lds
MAA 88,24,12
RD 56,30,43904
v_add_f32 v165, v165, v193
MAA 72,20,12
TR 64,25,37248
s_waitcnt lgkmcnt(5)
MAA 244,20,16
s_add_u32 m0, s59, 74880
s_mov_b32 s58, 131072
MAA 104,28,12
buffer_load_dwordx4 v5, s[24:27], s58 offen lds
MAA 120,32,12
TR 66,25,37760
MAA 116,32,8
TR 68,25,37280
MAA 100,28,8
TR 70,25,37792
MAA 96,28,4
buffer_load_dwordx4 v6, s[24:27], s58 offen offset:1024 lds
MAA 112,32,4
RD 60,31,36992
v_add_f32 v166, v166, v194
MAA 108,32,0
TR 72,25,38272
MAA 92,28,0
s_add_u32 m0, s59, 83200
s_mov_b32 s58, 262144
MAA 156,28,16
buffer_load_dwordx4 v5, s[24:27], s58 offen lds
MAA 160,32,16
TR 74,25,38784
MAA 124,0,36
TR 76,25,38304
MAA 140,0,40
TR 78,25,38816
v_add_f32 v167, v167, v195
MAA 144,4,40
buffer_load_dwordx4 v6, s[24:27], s58 offen offset:1024 lds
MAA 128,4,36
TR 80,25,39296
MAA 132,8,36
TR 82,25,39808
MAA 148,8,40
TR 84,25,39328
MAA 152,12,40
TR 86,25,39840
MAA 136,12,36
s_waitcnt vmcnt(15) lgkmcnt(8)
s_barrier
MAA 60,64,44
s_add_u32 m0, s59, 33280
s_mov_b32 s58, 1572864
v_permlane32_swap_b32 v164, v166
MAA 76,68,44
buffer_load_dwordx4 v5, s[24:27], s58 offen lds
MAA 80,68,48
RD 0,23,55488
MAA 64,64,48
RD 4,23,57792
v_permlane32_swap_b32 v165, v167
MAA 68,64,52
RD 8,23,60096
MAA 84,68,52
buffer_load_dwordx4 v6, s[24:27], s58 offen offset:1024 lds
MAA 88,68,56
RD 12,23,62400
v_add_f32 v164, v164, v166
MAA 72,64,56
TR 20,25,49664
s_waitcnt lgkmcnt(5)
MAA 244,64,60
s_add_u32 m0, s59, 41600
s_mov_b32 s58, 1703936
MAA 104,72,56
buffer_load_dwordx4 v5, s[24:27], s58 offen lds
MAA 120,76,56
TR 22,25,50176
v_add_f32 v165, v165, v167
MAA 116,76,52
TR 24,25,49696
MAA 100,72,52
TR 26,25,50208
v_mul_f32 v164, 0xba800000, v164
MAA 96,72,48
buffer_load_dwordx4 v6, s[24:27], s58 offen offset:1024 lds
MAA 112,76,48
RD 16,24,55488
MAA 108,76,44
TR 28,25,50688
v_mul_f32 v165, 0x3a800000, v165
MAA 92,72,44
s_add_u32 m0, s59, 91520
s_mov_b32 s58, 393216
MAA 156,72,60
buffer_load_dwordx4 v5, s[24:27], s58 offen lds
MAA 160,76,60
TR 30,25,51200
v_fma_f32 v165, -v164, v164, v165
MAA 124,44,80
TR 32,25,50720
MAA 140,44,84
TR 34,25,51232
v_max_f32 v165, 0, v165
MAA 144,48,84
buffer_load_dwordx4 v6, s[24:27], s58 offen offset:1024 lds
MAA 128,48,80
TR 36,25,51712
MAA 132,52,80
TR 38,25,52224
v_add_f32 v165, 0x3727c5ac, v165
MAA 148,52,84
TR 40,25,51744
MAA 152,56,84
TR 42,25,52256
MAA 136,56,80
s_waitcnt vmcnt(18) lgkmcnt(8)
s_barrier
MAA 60,20,0
s_add_u32 m0, s59, 99840
s_mov_b32 s58, 524288
v_rsq_f32 v166, v165
MAA 76,24,0
buffer_load_dwordx4 v5, s[24:27], s58 offen lds
MAA 80,24,4
RD 44,30,55488
MAA 64,20,4
RD 48,30,57792
MAA 68,20,8
RD 52,30,60096
MAA 84,24,8
RD 56,30,62400
v_mov_b32 v165, v166
MAA 88,24,12
TR 64,25,62080
MAA 72,20,12
TR 66,25,62592
s_waitcnt lgkmcnt(6)
MAA 244,20,16
buffer_load_dwordx4 v6, s[24:27], s58 offen offset:1024 lds
MAA 104,28,12
MAA 120,32,12
TR 68,25,62112
v_mul_f32 v166, 0x3e8293ee, v166
MAA 116,32,8
TR 70,25,62624
MAA 100,28,8
s_add_u32 m0, s59, 108160
s_mov_b32 s58, 655360
MAA 96,28,4
buffer_load_dwordx4 v5, s[24:27], s58 offen lds
MAA 112,32,4
RD 60,31,55488
MAA 108,32,0
TR 72,25,63104
ds_write_b128 v7, v[164:167]
MAA 92,28,0
TR 74,25,63616
MAA 156,28,16
TR 76,25,63136
MAA 160,32,16
ds_write_b32 v17, v164
MAA 124,0,36
buffer_load_dwordx4 v6, s[24:27], s58 offen offset:1024 lds
MAA 140,0,40
TR 78,25,63648
MAA 144,4,40
TR 80,25,64128
MAA 128,4,36
TR 82,25,64640
MAA 132,8,36
TR 84,25,64160
ds_write_b32 v17, v165 offset:1024
MAA 148,8,40
TR 86,25,64672
MAA 152,12,40
MAA 136,12,36
s_waitcnt lgkmcnt(0)
s_barrier
MAA 244,64,60
ds_read_b128 v[232:235], v10 offset:768
MAA 156,72,60
ds_read_b128 v[236:239], v10 offset:2816
MAA 160,76,60
ds_read_b128 v[228:231], v10 offset:512
MAA 104,72,56
ds_read_b128 v[224:227], v10 offset:256
MAA 120,76,56
ds_read_b128 v[220:223], v10
MAA 136,56,80
MAA 152,56,84
MAA 100,72,52
MAA 116,76,52
s_mov_b32 exec_lo, 0x10001
s_mov_b32 exec_hi, 0x10001
ds_write_b128 v13, v[244:247]
ds_write_b128 v13, v[156:159] offset:256
ds_write_b128 v13, v[160:163] offset:320
s_mov_b64 exec, -1
MAA 96,72,48
MAA 112,76,48
MAA 92,72,44
MAA 108,76,44
MAA 72,64,56
MAA 88,68,56
s_waitcnt lgkmcnt(0)
s_barrier
MAA 132,52,80
ds_read_b128 v[28:31], v13
s_add_u32 m0, s59, 49920
MAA 148,52,84
ds_read_b128 v[32:35], v13 offset:64
s_mov_b32 s58, 1835008
MAA 68,64,52
ds_read_b128 v[36:39], v13 offset:256
MAA 84,68,52
ds_read_b128 v[40:43], v13 offset:320
MAA 128,48,80
ds_read_b32 v44, v12 offset:512
MAA 144,48,84
ds_read_b32 v45, v12 offset:576
MAA 64,64,48
ds_read_b128 v[240:243], v11 offset:192
MAA 80,68,48
ds_read_b128 v[244:247], v11 offset:1216
MAA 124,44,80
buffer_load_dwordx4 v5, s[24:27], s58 offen lds
ds_read_b128 v[18:21], v11 offset:128
s_waitcnt lgkmcnt(8)
v_pk_fma_f32 v[72:73], v[28:29], v[232:233], v[72:73] op_sel_hi:[1,0,1]
v_pk_fma_f32 v[74:75], v[30:31], v[232:233], v[74:75] op_sel_hi:[1,0,1]
s_waitcnt lgkmcnt(6)
v_pk_fma_f32 v[104:105], v[36:37], v[232:233], v[104:105] op_sel_hi:[1,0,1]
v_pk_mul_f32 v[104:105], v[104:105], v[232:233] op_sel:[0,1] op_sel_hi:[1,1]
v_pk_fma_f32 v[106:107], v[38:39], v[232:233], v[106:107] op_sel_hi:[1,0,1]
v_pk_mul_f32 v[106:107], v[106:107], v[232:233] op_sel:[0,1] op_sel_hi:[1,1]
s_waitcnt lgkmcnt(5)
v_pk_fma_f32 v[120:121], v[40:41], v[232:233], v[120:121] op_sel_hi:[1,0,1]
v_pk_mul_f32 v[120:121], v[120:121], v[232:233] op_sel:[0,1] op_sel_hi:[1,1]
v_pk_fma_f32 v[122:123], v[42:43], v[232:233], v[122:123] op_sel_hi:[1,0,1]
v_pk_mul_f32 v[122:123], v[122:123], v[232:233] op_sel:[0,1] op_sel_hi:[1,1]
v_pk_fma_f32 v[100:101], v[36:37], v[228:229], v[100:101] op_sel_hi:[1,0,1]
v_pk_mul_f32 v[100:101], v[100:101], v[228:229] op_sel:[0,1] op_sel_hi:[1,1]
v_pk_fma_f32 v[102:103], v[38:39], v[228:229], v[102:103] op_sel_hi:[1,0,1]
v_pk_mul_f32 v[102:103], v[102:103], v[228:229] op_sel:[0,1] op_sel_hi:[1,1]
v_pk_fma_f32 v[116:117], v[40:41], v[228:229], v[116:117] op_sel_hi:[1,0,1]
v_pk_mul_f32 v[116:117], v[116:117], v[228:229] op_sel:[0,1] op_sel_hi:[1,1]
v_pk_fma_f32 v[118:119], v[42:43], v[228:229], v[118:119] op_sel_hi:[1,0,1]
v_pk_mul_f32 v[118:119], v[118:119], v[228:229] op_sel:[0,1] op_sel_hi:[1,1]
s_waitcnt lgkmcnt(2)
v_pk_fma_f32 v[136:137], v[240:241], v[44:45], v[136:137] op_sel_hi:[1,0,1]
v_pk_fma_f32 v[138:139], v[242:243], v[44:45], v[138:139] op_sel_hi:[1,0,1]
v_pk_fma_f32 v[152:153], v[240:241], v[44:45], v[152:153] op_sel:[0,1,0] op_sel_hi:[1,1,1]
v_pk_fma_f32 v[154:155], v[242:243], v[44:45], v[154:155] op_sel:[0,1,0] op_sel_hi:[1,1,1]
s_waitcnt lgkmcnt(1)
v_pk_mul_f32 v[136:137], v[136:137], v[244:245]
v_pk_mul_f32 v[138:139], v[138:139], v[246:247]
v_pk_mul_f32 v[152:153], v[152:153], v[244:245]
v_pk_mul_f32 v[154:155], v[154:155], v[246:247]
v_pk_fma_f32 v[88:89], v[32:33], v[232:233], v[88:89] op_sel_hi:[1,0,1]
v_pk_fma_f32 v[90:91], v[34:35], v[232:233], v[90:91] op_sel_hi:[1,0,1]
v_pk_fma_f32 v[96:97], v[36:37], v[224:225], v[96:97] op_sel_hi:[1,0,1]
s_waitcnt lgkmcnt(0)
v_pk_fma_f32 v[132:133], v[18:19], v[44:45], v[132:133] op_sel_hi:[1,0,1]
v_pk_fma_f32 v[134:135], v[20:21], v[44:45], v[134:135] op_sel_hi:[1,0,1]
v_pk_fma_f32 v[148:149], v[18:19], v[44:45], v[148:149] op_sel:[0,1,0] op_sel_hi:[1,1,1]
v_pk_fma_f32 v[150:151], v[20:21], v[44:45], v[150:151] op_sel:[0,1,0] op_sel_hi:[1,1,1]
v_pk_mul_f32 v[96:97], v[96:97], v[224:225] op_sel:[0,1] op_sel_hi:[1,1]
v_pk_fma_f32 v[98:99], v[38:39], v[224:225], v[98:99] op_sel_hi:[1,0,1]
v_pk_mul_f32 v[98:99], v[98:99], v[224:225] op_sel:[0,1] op_sel_hi:[1,1]
v_pk_fma_f32 v[112:113], v[40:41], v[224:225], v[112:113] op_sel_hi:[1,0,1]
v_pk_mul_f32 v[112:113], v[112:113], v[224:225] op_sel:[0,1] op_sel_hi:[1,1]
v_pk_fma_f32 v[114:115], v[42:43], v[224:225], v[114:115] op_sel_hi:[1,0,1]
v_pk_mul_f32 v[114:115], v[114:115], v[224:225] op_sel:[0,1] op_sel_hi:[1,1]
v_pk_fma_f32 v[68:69], v[28:29], v[228:229], v[68:69] op_sel_hi:[1,0,1]
v_pk_fma_f32 v[70:71], v[30:31], v[228:229], v[70:71] op_sel_hi:[1,0,1]
v_pk_fma_f32 v[84:85], v[32:33], v[228:229], v[84:85] op_sel_hi:[1,0,1]
v_pk_fma_f32 v[86:87], v[34:35], v[228:229], v[86:87] op_sel_hi:[1,0,1]
v_pk_fma_f32 v[92:93], v[36:37], v[220:221], v[92:93] op_sel_hi:[1,0,1]
v_pk_mul_f32 v[92:93], v[92:93], v[220:221] op_sel:[0,1] op_sel_hi:[1,1]
v_pk_fma_f32 v[94:95], v[38:39], v[220:221], v[94:95] op_sel_hi:[1,0,1]
v_pk_mul_f32 v[94:95], v[94:95], v[220:221] op_sel:[0,1] op_sel_hi:[1,1]
v_pk_fma_f32 v[108:109], v[40:41], v[220:221], v[108:109] op_sel_hi:[1,0,1]
v_pk_mul_f32 v[108:109], v[108:109], v[220:221] op_sel:[0,1] op_sel_hi:[1,1]
v_pk_fma_f32 v[110:111], v[42:43], v[220:221], v[110:111] op_sel_hi:[1,0,1]
v_pk_mul_f32 v[110:111], v[110:111], v[220:221] op_sel:[0,1] op_sel_hi:[1,1]
v_pk_fma_f32 v[64:65], v[28:29], v[224:225], v[64:65] op_sel_hi:[1,0,1]
v_pk_fma_f32 v[66:67], v[30:31], v[224:225], v[66:67] op_sel_hi:[1,0,1]
v_pk_fma_f32 v[80:81], v[32:33], v[224:225], v[80:81] op_sel_hi:[1,0,1]
v_pk_fma_f32 v[82:83], v[34:35], v[224:225], v[82:83] op_sel_hi:[1,0,1]
v_pk_fma_f32 v[156:157], v[36:37], v[236:237], v[156:157] op_sel_hi:[1,0,1]
v_pk_mul_f32 v[156:157], v[156:157], v[236:237] op_sel:[0,1] op_sel_hi:[1,1]
v_pk_fma_f32 v[158:159], v[38:39], v[236:237], v[158:159] op_sel_hi:[1,0,1]
v_pk_mul_f32 v[158:159], v[158:159], v[236:237] op_sel:[0,1] op_sel_hi:[1,1]
v_pk_fma_f32 v[160:161], v[40:41], v[236:237], v[160:161] op_sel_hi:[1,0,1]
v_pk_mul_f32 v[160:161], v[160:161], v[236:237] op_sel:[0,1] op_sel_hi:[1,1]
v_pk_fma_f32 v[162:163], v[42:43], v[236:237], v[162:163] op_sel_hi:[1,0,1]
v_pk_mul_f32 v[162:163], v[162:163], v[236:237] op_sel:[0,1] op_sel_hi:[1,1]
v_cvt_pk_bf16_f32 v196, v104, v105
v_cvt_pk_bf16_f32 v197, v106, v107
MAA 140,44,84
buffer_load_dwordx4 v6, s[24:27], s58 offen offset:1024 lds
MAA 60,64,44
s_add_u32 m0, s59, 58240
v_cvt_pk_bf16_f32 v198, v120, v121
v_cvt_pk_bf16_f32 v199, v122, v123
MAA 76,68,44
ds_write_b128 v8, v[196:199]
v_cvt_pk_bf16_f32 v208, v136, v137
v_cvt_pk_bf16_f32 v209, v138, v139
v_cvt_pk_bf16_f32 v218, v152, v153
v_cvt_pk_bf16_f32 v219, v154, v155
ds_write_b64 v8, v[208:209] offset:1024
ds_write_b64 v8, v[218:219] offset:1032
s_mov_b32 s58, 1966080
buffer_load_dwordx4 v5, s[24:27], s58 offen lds
v_cvt_pk_bf16_f32 v192, v100, v101
v_cvt_pk_bf16_f32 v193, v102, v103
v_cvt_pk_bf16_f32 v194, v116, v117
v_cvt_pk_bf16_f32 v195, v118, v119
v_cvt_pk_bf16_f32 v176, v72, v73
v_cvt_pk_bf16_f32 v177, v74, v75
v_cvt_pk_bf16_f32 v178, v88, v89
v_cvt_pk_bf16_f32 v179, v90, v91
v_pk_fma_f32 v[60:61], v[28:29], v[220:221], v[60:61] op_sel_hi:[1,0,1]
v_pk_fma_f32 v[62:63], v[30:31], v[220:221], v[62:63] op_sel_hi:[1,0,1]
v_pk_fma_f32 v[76:77], v[32:33], v[220:221], v[76:77] op_sel_hi:[1,0,1]
v_pk_fma_f32 v[78:79], v[34:35], v[220:221], v[78:79] op_sel_hi:[1,0,1]
ds_read_b128 v[22:25], v11 offset:1152
s_nop 0
v_mfma_f32_16x16x32_bf16 v[104:107], v[192:195], v[176:179], v[46:49]
buffer_load_dwordx4 v6, s[24:27], s58 offen offset:1024 lds
v_mfma_f32_16x16x32_bf16 v[120:123], v[196:199], v[176:179], v[50:53]
s_add_u32 m0, s59, 66560
s_mov_b32 s58, 0
v_cvt_pk_bf16_f32 v188, v96, v97
v_cvt_pk_bf16_f32 v189, v98, v99
s_nop 1
v_max3_f32 v88, v104, v105, v106
v_cvt_pk_bf16_f32 v190, v112, v113
v_cvt_pk_bf16_f32 v191, v114, v115
s_waitcnt lgkmcnt(1)
s_barrier
ds_read_b64 v[200:201], v9 offset:1024
ds_read_b64 v[210:211], v9 offset:1032
buffer_load_dwordx4 v5, s[24:27], s58 offen lds
v_max3_f32 v89, v107, v120, v121
v_max3_f32 v88, v88, v122, v123
v_max_f32 v90, v88, v89
v_max_f32 v89, v88, v89
v_cvt_pk_bf16_f32 v172, v68, v69
v_cvt_pk_bf16_f32 v173, v70, v71
v_permlane16_swap_b32 v90, v89
v_cvt_pk_bf16_f32 v174, v84, v85
v_max_f32 v88, v90, v89
s_waitcnt lgkmcnt(2)
v_pk_mul_f32 v[132:133], v[132:133], v[22:23]
v_cvt_pk_bf16_f32 v206, v132, v133
v_pk_mul_f32 v[134:135], v[134:135], v[24:25]
buffer_load_dwordx4 v6, s[24:27], s58 offen offset:1024 lds
s_add_u32 m0, s59, 116480
s_mov_b32 s58, 786432
v_cvt_pk_bf16_f32 v207, v134, v135
v_pk_mul_f32 v[148:149], v[148:149], v[22:23]
v_cvt_pk_bf16_f32 v216, v148, v149
v_pk_mul_f32 v[150:151], v[150:151], v[24:25]
v_cvt_pk_bf16_f32 v217, v150, v151
v_max_f32 v89, v90, v89
v_cvt_pk_bf16_f32 v175, v86, v87
ds_read_b128 v[240:243], v11 offset:64
s_nop 0
v_mfma_f32_16x16x32_bf16 v[100:103], v[188:191], v[172:175], v[46:49]
ds_read_b128 v[244:247], v11 offset:1088
v_permlane32_swap_b32 v88, v89
v_mfma_f32_16x16x32_bf16 v[116:119], v[192:195], v[172:175], v[50:53]
buffer_load_dwordx4 v5, s[24:27], s58 offen lds
v_max_f32 v88, v88, v89
v_mul_f32 v88, v88, v234
s_nop 1
v_max3_f32 v84, v100, v101, v102
v_pk_fma_f32 v[104:105], v[104:105], v[234:235], v[88:89] op_sel_hi:[1,0,0] neg_lo:[0,0,1] neg_hi:[0,0,1]
v_pk_fma_f32 v[106:107], v[106:107], v[234:235], v[88:89] op_sel_hi:[1,0,0] neg_lo:[0,0,1] neg_hi:[0,0,1]
v_pk_fma_f32 v[120:121], v[120:121], v[234:235], v[88:89] op_sel_hi:[1,0,0] neg_lo:[0,0,1] neg_hi:[0,0,1]
v_pk_fma_f32 v[122:123], v[122:123], v[234:235], v[88:89] op_sel_hi:[1,0,0] neg_lo:[0,0,1] neg_hi:[0,0,1]
v_exp_f32 v104, v104
v_exp_f32 v105, v105
v_exp_f32 v106, v106
v_exp_f32 v107, v107
v_exp_f32 v120, v120
v_exp_f32 v121, v121
v_exp_f32 v122, v122
v_exp_f32 v123, v123
v_cvt_pk_bf16_f32 v72, v104, v105
buffer_load_dwordx4 v6, s[24:27], s58 offen offset:1024 lds
s_add_u32 m0, s59, 124800
s_mov_b32 s58, 917504
v_cvt_pk_bf16_f32 v73, v106, v107
v_cvt_pk_bf16_f32 v74, v120, v121
v_cvt_pk_bf16_f32 v75, v122, v123
s_waitcnt lgkmcnt(1)
v_pk_fma_f32 v[128:129], v[240:241], v[44:45], v[128:129] op_sel_hi:[1,0,1]
s_waitcnt lgkmcnt(0)
v_pk_mul_f32 v[128:129], v[128:129], v[244:245]
v_pk_fma_f32 v[130:131], v[242:243], v[44:45], v[130:131] op_sel_hi:[1,0,1]
v_pk_mul_f32 v[130:131], v[130:131], v[246:247]
v_pk_fma_f32 v[144:145], v[240:241], v[44:45], v[144:145] op_sel:[0,1,0] op_sel_hi:[1,1,1]
v_pk_mul_f32 v[144:145], v[144:145], v[244:245]
v_pk_fma_f32 v[146:147], v[242:243], v[44:45], v[146:147] op_sel:[0,1,0] op_sel_hi:[1,1,1]
v_pk_mul_f32 v[146:147], v[146:147], v[246:247]
v_cvt_pk_bf16_f32 v204, v128, v129
v_cvt_pk_bf16_f32 v205, v130, v131
v_mfma_f32_16x16x32_bf16 v[88:91], v[248:251], v[72:75], 0
buffer_load_dwordx4 v5, s[24:27], s58 offen lds
v_mfma_f32_16x16x32_bf16 v[104:107], v[206:209], v[72:75], 0
ds_read_b128 v[18:21], v11
v_cvt_pk_bf16_f32 v214, v144, v145
v_mfma_f32_16x16x32_bf16 v[120:123], v[216:219], v[72:75], 0
ds_read_b128 v[22:25], v11 offset:1024
s_nop 1
v_rcp_f32 v88, v88
v_cvt_pk_bf16_f32 v215, v146, v147
v_max3_f32 v85, v103, v116, v117
v_pk_mul_f32 v[104:105], v[104:105], v[88:89] op_sel_hi:[1,0]
v_pk_mul_f32 v[106:107], v[106:107], v[88:89] op_sel_hi:[1,0]
buffer_load_dwordx4 v6, s[24:27], s58 offen offset:1024 lds
v_pk_mul_f32 v[120:121], v[120:121], v[88:89] op_sel_hi:[1,0]
v_pk_mul_f32 v[122:123], v[122:123], v[88:89] op_sel_hi:[1,0]
v_cvt_pk_bf16_f32 v176, v104, v105
v_cvt_pk_bf16_f32 v177, v106, v107
v_cvt_pk_bf16_f32 v178, v120, v121
v_cvt_pk_bf16_f32 v179, v122, v123
v_max3_f32 v84, v84, v118, v119
v_max_f32 v86, v84, v85
v_max_f32 v85, v84, v85
v_cvt_pk_bf16_f32 v184, v92, v93
v_cvt_pk_bf16_f32 v185, v94, v95
v_permlane16_swap_b32 v86, v85
v_cvt_pk_bf16_f32 v186, v108, v109
buffer_store_dwordx4 v[176:179], v4, s[16:19], s74 offen offset:3072 sc1
v_max_f32 v84, v86, v85
v_max_f32 v85, v86, v85
v_cvt_pk_bf16_f32 v187, v110, v111
v_cvt_pk_bf16_f32 v168, v64, v65
v_permlane32_swap_b32 v84, v85
v_cvt_pk_bf16_f32 v169, v66, v67
v_max_f32 v84, v84, v85
v_mul_f32 v84, v84, v230
v_pk_fma_f32 v[100:101], v[100:101], v[230:231], v[84:85] op_sel_hi:[1,0,0] neg_lo:[0,0,1] neg_hi:[0,0,1]
v_pk_fma_f32 v[102:103], v[102:103], v[230:231], v[84:85] op_sel_hi:[1,0,0] neg_lo:[0,0,1] neg_hi:[0,0,1]
v_pk_fma_f32 v[116:117], v[116:117], v[230:231], v[84:85] op_sel_hi:[1,0,0] neg_lo:[0,0,1] neg_hi:[0,0,1]
v_pk_fma_f32 v[118:119], v[118:119], v[230:231], v[84:85] op_sel_hi:[1,0,0] neg_lo:[0,0,1] neg_hi:[0,0,1]
v_exp_f32 v100, v100
v_exp_f32 v101, v101
v_exp_f32 v102, v102
v_exp_f32 v103, v103
v_exp_f32 v116, v116
v_exp_f32 v117, v117
v_exp_f32 v118, v118
v_exp_f32 v119, v119
v_cvt_pk_bf16_f32 v68, v100, v101
v_cvt_pk_bf16_f32 v69, v102, v103
v_cvt_pk_bf16_f32 v70, v116, v117
v_cvt_pk_bf16_f32 v71, v118, v119
s_waitcnt lgkmcnt(1)
v_pk_fma_f32 v[124:125], v[18:19], v[44:45], v[124:125] op_sel_hi:[1,0,1]
s_waitcnt lgkmcnt(0)
v_pk_mul_f32 v[124:125], v[124:125], v[22:23]
v_pk_fma_f32 v[126:127], v[20:21], v[44:45], v[126:127] op_sel_hi:[1,0,1]
v_pk_mul_f32 v[126:127], v[126:127], v[24:25]
v_pk_fma_f32 v[140:141], v[18:19], v[44:45], v[140:141] op_sel:[0,1,0] op_sel_hi:[1,1,1]
v_pk_mul_f32 v[140:141], v[140:141], v[22:23]
v_pk_fma_f32 v[142:143], v[20:21], v[44:45], v[142:143] op_sel:[0,1,0] op_sel_hi:[1,1,1]
v_pk_mul_f32 v[142:143], v[142:143], v[24:25]
v_cvt_pk_bf16_f32 v170, v80, v81
v_cvt_pk_bf16_f32 v171, v82, v83
v_mfma_f32_16x16x32_bf16 v[84:87], v[248:251], v[68:71], 0
v_cvt_pk_bf16_f32 v202, v124, v125
v_cvt_pk_bf16_f32 v203, v126, v127
v_mfma_f32_16x16x32_bf16 v[100:103], v[204:207], v[68:71], 0
v_cvt_pk_bf16_f32 v212, v140, v141
v_cvt_pk_bf16_f32 v213, v142, v143
v_mfma_f32_16x16x32_bf16 v[116:119], v[214:217], v[68:71], 0
s_nop 1
v_rcp_f32 v84, v84
v_mfma_f32_16x16x32_bf16 v[96:99], v[184:187], v[168:171], v[46:49]
v_cvt_pk_bf16_f32 v180, v156, v157
v_cvt_pk_bf16_f32 v181, v158, v159
v_mfma_f32_16x16x32_bf16 v[112:115], v[188:191], v[168:171], v[50:53]
v_cvt_pk_bf16_f32 v182, v160, v161
v_cvt_pk_bf16_f32 v183, v162, v163
v_cvt_pk_bf16_f32 v164, v60, v61
s_nop 1
v_max3_f32 v80, v96, v97, v98
v_cvt_pk_bf16_f32 v165, v62, v63
v_pk_mul_f32 v[100:101], v[100:101], v[84:85] op_sel_hi:[1,0]
v_pk_mul_f32 v[102:103], v[102:103], v[84:85] op_sel_hi:[1,0]
v_pk_mul_f32 v[116:117], v[116:117], v[84:85] op_sel_hi:[1,0]
v_pk_mul_f32 v[118:119], v[118:119], v[84:85] op_sel_hi:[1,0]
v_cvt_pk_bf16_f32 v172, v100, v101
v_cvt_pk_bf16_f32 v173, v102, v103
v_cvt_pk_bf16_f32 v174, v116, v117
v_cvt_pk_bf16_f32 v175, v118, v119
buffer_store_dwordx4 v[172:175], v4, s[16:19], s74 offen offset:2048 sc1
v_max3_f32 v81, v99, v112, v113
v_max3_f32 v80, v80, v114, v115
v_max_f32 v82, v80, v81
v_max_f32 v81, v80, v81
v_cvt_pk_bf16_f32 v166, v76, v77
v_cvt_pk_bf16_f32 v167, v78, v79
v_permlane16_swap_b32 v82, v81
s_nop 0
v_mfma_f32_16x16x32_bf16 v[92:95], v[180:183], v[164:167], v[54:57]
v_max_f32 v80, v82, v81
v_max_f32 v81, v82, v81
v_mfma_f32_16x16x32_bf16 v[108:111], v[184:187], v[164:167], v[50:53]
s_nop 0
v_permlane32_swap_b32 v80, v81
v_max_f32 v80, v80, v81
v_mul_f32 v80, v80, v226
v_pk_fma_f32 v[96:97], v[96:97], v[226:227], v[80:81] op_sel_hi:[1,0,0] neg_lo:[0,0,1] neg_hi:[0,0,1]
v_pk_fma_f32 v[98:99], v[98:99], v[226:227], v[80:81] op_sel_hi:[1,0,0] neg_lo:[0,0,1] neg_hi:[0,0,1]
v_pk_fma_f32 v[112:113], v[112:113], v[226:227], v[80:81] op_sel_hi:[1,0,0] neg_lo:[0,0,1] neg_hi:[0,0,1]
v_pk_fma_f32 v[114:115], v[114:115], v[226:227], v[80:81] op_sel_hi:[1,0,0] neg_lo:[0,0,1] neg_hi:[0,0,1]
v_exp_f32 v96, v96
v_exp_f32 v97, v97
v_exp_f32 v98, v98
v_exp_f32 v99, v99
v_exp_f32 v112, v112
v_exp_f32 v113, v113
v_exp_f32 v114, v114
v_exp_f32 v115, v115
v_cvt_pk_bf16_f32 v64, v96, v97
v_cvt_pk_bf16_f32 v65, v98, v99
v_cvt_pk_bf16_f32 v66, v112, v113
v_cvt_pk_bf16_f32 v67, v114, v115
v_max3_f32 v76, v92, v93, v94
v_max3_f32 v77, v95, v108, v109
v_mfma_f32_16x16x32_bf16 v[80:83], v[248:251], v[64:67], 0
v_max3_f32 v76, v76, v110, v111
v_max_f32 v78, v76, v77
v_mfma_f32_16x16x32_bf16 v[96:99], v[202:205], v[64:67], 0
v_max_f32 v77, v76, v77
v_mfma_f32_16x16x32_bf16 v[112:115], v[212:215], v[64:67], 0
s_nop 2
v_rcp_f32 v80, v80
v_permlane16_swap_b32 v78, v77
s_nop 0
v_pk_mul_f32 v[96:97], v[96:97], v[80:81] op_sel_hi:[1,0]
v_pk_mul_f32 v[98:99], v[98:99], v[80:81] op_sel_hi:[1,0]
v_pk_mul_f32 v[112:113], v[112:113], v[80:81] op_sel_hi:[1,0]
v_pk_mul_f32 v[114:115], v[114:115], v[80:81] op_sel_hi:[1,0]
v_cvt_pk_bf16_f32 v168, v96, v97
v_cvt_pk_bf16_f32 v169, v98, v99
v_cvt_pk_bf16_f32 v170, v112, v113
v_cvt_pk_bf16_f32 v171, v114, v115
buffer_store_dwordx4 v[168:171], v4, s[16:19], s74 offen offset:1024 sc1
v_max_f32 v76, v78, v77
v_max_f32 v77, v78, v77
s_nop 1
v_permlane32_swap_b32 v76, v77
v_max_f32 v76, v76, v77
v_mul_f32 v76, v76, v222
v_pk_fma_f32 v[92:93], v[92:93], v[222:223], v[76:77] op_sel_hi:[1,0,0] neg_lo:[0,0,1] neg_hi:[0,0,1]
v_pk_fma_f32 v[94:95], v[94:95], v[222:223], v[76:77] op_sel_hi:[1,0,0] neg_lo:[0,0,1] neg_hi:[0,0,1]
v_pk_fma_f32 v[108:109], v[108:109], v[222:223], v[76:77] op_sel_hi:[1,0,0] neg_lo:[0,0,1] neg_hi:[0,0,1]
v_pk_fma_f32 v[110:111], v[110:111], v[222:223], v[76:77] op_sel_hi:[1,0,0] neg_lo:[0,0,1] neg_hi:[0,0,1]
v_exp_f32 v92, v92
v_exp_f32 v93, v93
v_exp_f32 v94, v94
v_exp_f32 v95, v95
v_exp_f32 v108, v108
v_exp_f32 v109, v109
v_exp_f32 v110, v110
v_exp_f32 v111, v111
v_cvt_pk_bf16_f32 v60, v92, v93
v_cvt_pk_bf16_f32 v61, v94, v95
v_cvt_pk_bf16_f32 v62, v108, v109
v_cvt_pk_bf16_f32 v63, v110, v111
s_nop 1
v_mfma_f32_16x16x32_bf16 v[76:79], v[248:251], v[60:63], 0
v_mfma_f32_16x16x32_bf16 v[92:95], v[200:203], v[60:63], 0
v_mfma_f32_16x16x32_bf16 v[108:111], v[210:213], v[60:63], 0
s_nop 5
v_rcp_f32 v76, v76
s_nop 0
v_pk_mul_f32 v[92:93], v[92:93], v[76:77] op_sel_hi:[1,0]
v_pk_mul_f32 v[94:95], v[94:95], v[76:77] op_sel_hi:[1,0]
v_pk_mul_f32 v[108:109], v[108:109], v[76:77] op_sel_hi:[1,0]
v_pk_mul_f32 v[110:111], v[110:111], v[76:77] op_sel_hi:[1,0]
v_cvt_pk_bf16_f32 v164, v92, v93
v_cvt_pk_bf16_f32 v165, v94, v95
v_cvt_pk_bf16_f32 v166, v108, v109
v_cvt_pk_bf16_f32 v167, v110, v111
buffer_store_dwordx4 v[164:167], v4, s[16:19], s74 offen sc1
s_nop 1
s_branch .Lqkve3
.Lx4:
buffer_load_dword v27, v14, s[76:79], 0 offen
s_mov_b32 s76, s98
s_mov_b32 s77, s99
s_mov_b32 s78, s100
v_mov_b32 v14, v15
s_mov_b32 s47, 5
s_branch .Lx4b
.Lx5:
buffer_load_dword v27, v14, s[76:79], 0 offen
s_mov_b32 s76, s98
s_mov_b32 s77, s99
s_mov_b32 s78, s100
v_mov_b32 v14, v15
s_mov_b32 s47, 5
s_branch .Lx5b
.Lx6:
buffer_load_dword v27, v14, s[76:79], 0 offen
s_mov_b32 s76, s98
s_mov_b32 s77, s99
s_mov_b32 s78, s100
v_mov_b32 v14, v15
s_mov_b32 s47, 5
s_branch .Lx6b
.Lx7:
buffer_load_dword v27, v14, s[76:79], 0 offen
s_mov_b32 s76, s98
s_mov_b32 s77, s99
s_mov_b32 s78, s100
v_mov_b32 v14, v15
s_mov_b32 s47, 5
s_branch .Lx7b
.Lsp8:
s_mov_b32 s15, 0
.Lsp8l:
v_mov_b32 v37, 0
buffer_atomic_add v37, v34, s[40:43], 0 offen sc0
s_add_u32 s15, s15, 1
s_cmp_gt_u32 s15, 100000
s_waitcnt vmcnt(0)
s_cbranch_scc1 .Lsp8b
v_cmp_gt_u32 vcc, v35, v37
s_nop 0
s_cbranch_vccnz .Lsp8l
s_branch .Lsp8b
.Lx9:
buffer_load_dword v27, v14, s[76:79], 0 offen
s_mov_b32 s76, s98
s_mov_b32 s77, s99
s_mov_b32 s78, s100
v_mov_b32 v14, v15
s_mov_b32 s47, 5
s_branch .Lx9b
.Lx10:
buffer_load_dword v27, v14, s[76:79], 0 offen
s_mov_b32 s76, s98
s_mov_b32 s77, s99
s_mov_b32 s78, s100
v_mov_b32 v14, v15
s_mov_b32 s47, 5
s_branch .Lx10b
.Lx11:
buffer_load_dword v27, v14, s[76:79], 0 offen
s_mov_b32 s76, s98
s_mov_b32 s77, s99
s_mov_b32 s78, s100
v_mov_b32 v14, v15
s_mov_b32 s47, 5
s_branch .Lx11b
.Lx12:
buffer_load_dword v27, v14, s[76:79], 0 offen
s_mov_b32 s76, s98
s_mov_b32 s77, s99
s_mov_b32 s78, s100
v_mov_b32 v14, v15
s_mov_b32 s47, 5
s_branch .Lx12b
.Lx13:
buffer_load_dword v27, v14, s[76:79], 0 offen
s_mov_b32 s76, s98
s_mov_b32 s77, s99
s_mov_b32 s78, s100
v_mov_b32 v14, v15
s_mov_b32 s47, 5
s_branch .Lx13b
.Lsp14:
s_mov_b32 s15, 0
.Lsp14l:
v_mov_b32 v37, 0
buffer_atomic_add v37, v33, s[16:19], 0 offen sc0
s_add_u32 s15, s15, 1
s_cmp_gt_u32 s15, 100000
s_waitcnt vmcnt(0)
s_cbranch_scc1 .Lsp14b
v_cmp_gt_u32 vcc, v36, v37
s_nop 0
s_cbranch_vccnz .Lsp14l
s_branch .Lsp14b
.Lx15:
buffer_load_dword v27, v14, s[76:79], 0 offen
s_mov_b32 s76, s98
s_mov_b32 s77, s99
s_mov_b32 s78, s100
v_mov_b32 v14, v15
s_mov_b32 s47, 5
s_branch .Lx15b
.Lx16:
buffer_load_dword v27, v14, s[76:79], 0 offen
s_mov_b32 s76, s98
s_mov_b32 s77, s99
s_mov_b32 s78, s100
v_mov_b32 v14, v15
s_mov_b32 s47, 5
s_branch .Lx16b
.Lx17:
buffer_load_dword v27, v14, s[76:79], 0 offen
s_mov_b32 s76, s98
s_mov_b32 s77, s99
s_mov_b32 s78, s100
v_mov_b32 v14, v15
s_mov_b32 s47, 5
s_branch .Lx17b
.Lx18:
buffer_load_dword v27, v14, s[76:79], 0 offen
s_mov_b32 s76, s98
s_mov_b32 s77, s99
s_mov_b32 s78, s100
v_mov_b32 v14, v15
s_mov_b32 s47, 5
s_branch .Lx18b
.Lx19:
buffer_load_dword v27, v14, s[76:79], 0 offen
s_mov_b32 s76, s98
s_mov_b32 s77, s99
s_mov_b32 s78, s100
v_mov_b32 v14, v15
s_mov_b32 s47, 5
s_branch .Lx19b
.Lx20:
buffer_load_dword v27, v14, s[76:79], 0 offen
s_mov_b32 s76, s98
s_mov_b32 s77, s99
s_mov_b32 s78, s100
v_mov_b32 v14, v15
s_mov_b32 s47, 5
s_branch .Lx20b
.Lx21:
buffer_load_dword v27, v14, s[76:79], 0 offen
s_mov_b32 s76, s98
s_mov_b32 s77, s99
s_mov_b32 s78, s100
v_mov_b32 v14, v15
s_mov_b32 s47, 5
s_branch .Lx21b
.Lsp22:
s_mov_b32 s15, 0
.Lsp22l:
v_mov_b32 v37, 0
buffer_atomic_add v37, v34, s[40:43], 0 offen sc0
s_add_u32 s15, s15, 1
s_cmp_gt_u32 s15, 100000
s_waitcnt vmcnt(0)
s_cbranch_scc1 .Lsp22b
v_cmp_gt_u32 vcc, v35, v37
s_nop 0
s_cbranch_vccnz .Lsp22l
s_branch .Lsp22b
.Lx23:
buffer_load_dword v27, v14, s[76:79], 0 offen
s_mov_b32 s76, s98
s_mov_b32 s77, s99
s_mov_b32 s78, s100
v_mov_b32 v14, v15
s_mov_b32 s47, 5
s_branch .Lx23b
.Lx24:
buffer_load_dword v27, v14, s[76:79], 0 offen
s_mov_b32 s76, s98
s_mov_b32 s77, s99
s_mov_b32 s78, s100
v_mov_b32 v14, v15
s_mov_b32 s47, 5
s_branch .Lx24b
.Lx25:
buffer_load_dword v27, v14, s[76:79], 0 offen
s_mov_b32 s76, s98
s_mov_b32 s77, s99
s_mov_b32 s78, s100
v_mov_b32 v14, v15
s_mov_b32 s47, 5
s_branch .Lx25b
.Lx26:
buffer_load_dword v27, v14, s[76:79], 0 offen
s_mov_b32 s76, s98
s_mov_b32 s77, s99
s_mov_b32 s78, s100
v_mov_b32 v14, v15
s_mov_b32 s47, 5
s_branch .Lx26b
.Lx27:
buffer_load_dword v27, v14, s[76:79], 0 offen
s_mov_b32 s76, s98
s_mov_b32 s77, s99
s_mov_b32 s78, s100
v_mov_b32 v14, v15
s_mov_b32 s47, 5
s_branch .Lx27b
.Lsp28:
s_mov_b32 s15, 0
.Lsp28l:
v_mov_b32 v37, 0
buffer_atomic_add v37, v33, s[16:19], 0 offen sc0
s_add_u32 s15, s15, 1
s_cmp_gt_u32 s15, 100000
s_waitcnt vmcnt(0)
s_cbranch_scc1 .Lsp28b
v_cmp_gt_u32 vcc, v36, v37
s_nop 0
s_cbranch_vccnz .Lsp28l
s_branch .Lsp28b
.Lx29:
buffer_load_dword v27, v14, s[76:79], 0 offen
s_mov_b32 s76, s98
s_mov_b32 s77, s99
s_mov_b32 s78, s100
v_mov_b32 v14, v15
s_mov_b32 s47, 5
s_branch .Lx29b
.Lx30:
buffer_load_dword v27, v14, s[76:79], 0 offen
s_mov_b32 s76, s98
s_mov_b32 s77, s99
s_mov_b32 s78, s100
v_mov_b32 v14, v15
s_mov_b32 s47, 5
s_branch .Lx30b
.Lx31:
buffer_load_dword v27, v14, s[76:79], 0 offen
s_mov_b32 s76, s98
s_mov_b32 s77, s99
s_mov_b32 s78, s100
v_mov_b32 v14, v15
s_mov_b32 s47, 5
s_branch .Lx31b
.Lqkv2:
s_add_u32 m0, s55, 0
s_nop 0
buffer_load_dwordx4 v21, s[36:39], s52 offen lds
buffer_load_dwordx4 v28, s[36:39], s52 offen offset:1024 lds
buffer_load_dword v22, s[36:39], s52 offen offset:2048 lds
s_add_u32 s52, s52, 128
s_add_u32 m0, s55, 2304
s_nop 0
buffer_load_dwordx4 v21, s[36:39], s53 offen lds
buffer_load_dwordx4 v28, s[36:39], s53 offen offset:1024 lds
buffer_load_dword v29, s[36:39], s53 offen offset:2048 lds
s_add_u32 s53, s53, 128
s_add_u32 m0, s56, 123648
s_nop 0
buffer_load_dwordx4 v18, s[20:23], s54 offen lds
buffer_load_dwordx4 v19, s[20:23], s54 offen offset:1024 lds
buffer_load_dwordx4 v20, s[20:23], s54 offen offset:2048 lds
s_add_u32 s54, s54, 196608
s_add_u32 m0, s56, 136064
s_nop 0
buffer_load_dwordx4 v18, s[20:23], s54 offen lds
buffer_load_dwordx4 v19, s[20:23], s54 offen offset:1024 lds
buffer_load_dwordx4 v20, s[20:23], s54 offen offset:2048 lds
s_add_u32 s54, s54, 196608
s_waitcnt vmcnt(12)
s_cmp_lt_u32 s14, 16
s_cselect_b32 s62, 0, 4096
v_mov_b32 v154, 1
v_lshlrev_b32 v155, 8, v1
v_permlane16_swap_b32 v128, v130
v_permlane16_swap_b32 v129, v131
v_permlane16_swap_b32 v132, v134
v_permlane16_swap_b32 v133, v135
v_permlane16_swap_b32 v136, v138
v_permlane16_swap_b32 v137, v139
v_permlane16_swap_b32 v140, v142
v_permlane16_swap_b32 v141, v143
buffer_atomic_add v154, v155, s[40:43], s62 offen
v_lshlrev_b32 v64, 16, v128
v_and_b32 v65, 0xffff0000, v128
v_lshlrev_b32 v66, 16, v129
v_and_b32 v67, 0xffff0000, v129
v_lshlrev_b32 v68, 16, v130
v_and_b32 v69, 0xffff0000, v130
v_lshlrev_b32 v70, 16, v131
v_and_b32 v71, 0xffff0000, v131
v_lshlrev_b32 v72, 16, v132
v_and_b32 v73, 0xffff0000, v132
v_lshlrev_b32 v74, 16, v133
v_and_b32 v75, 0xffff0000, v133
v_lshlrev_b32 v76, 16, v134
v_and_b32 v77, 0xffff0000, v134
v_lshlrev_b32 v78, 16, v135
v_and_b32 v79, 0xffff0000, v135
v_lshlrev_b32 v80, 16, v136
v_and_b32 v81, 0xffff0000, v136
v_lshlrev_b32 v82, 16, v137
v_and_b32 v83, 0xffff0000, v137
v_lshlrev_b32 v84, 16, v138
v_and_b32 v85, 0xffff0000, v138
v_lshlrev_b32 v86, 16, v139
v_and_b32 v87, 0xffff0000, v139
v_lshlrev_b32 v88, 16, v140
v_and_b32 v89, 0xffff0000, v140
v_lshlrev_b32 v90, 16, v141
v_and_b32 v91, 0xffff0000, v141
v_lshlrev_b32 v92, 16, v142
v_and_b32 v93, 0xffff0000, v142
v_lshlrev_b32 v94, 16, v143
v_and_b32 v95, 0xffff0000, v143
s_lshl_b32 s64, s6, 14
s_lshl_b32 s65, s49, 13
s_add_u32 s64, s64, s65
s_lshl_b32 s65, s7, 9
s_add_u32 s64, s64, s65
s_lshl_b32 s65, s48, 8
s_add_u32 s64, s64, s65
s_add_u32 s64, s64, 29360128
v_and_b32 v152, 31, v1
v_lshlrev_b32 v152, 3, v152
v_lshrrev_b32 v153, 5, v1
v_lshl_add_u32 v152, v153, 28, v152
s_lshl_b32 s62, s7, 18
s_add_u32 s62, s62, 0
s_add_u32 s63, s62, 0x20000
v_pk_mul_f32 v[146:147], v[64:65], v[64:65]
v_pk_mul_f32 v[150:151], v[80:81], v[80:81]
v_pk_fma_f32 v[146:147], v[66:67], v[66:67], v[146:147]
v_pk_add_f32 v[144:145], v[64:65], v[66:67]
v_pk_fma_f32 v[150:151], v[82:83], v[82:83], v[150:151]
v_pk_add_f32 v[148:149], v[80:81], v[82:83]
v_pk_fma_f32 v[146:147], v[68:69], v[68:69], v[146:147]
v_pk_add_f32 v[144:145], v[144:145], v[68:69]
v_pk_fma_f32 v[150:151], v[84:85], v[84:85], v[150:151]
v_pk_add_f32 v[148:149], v[148:149], v[84:85]
v_pk_fma_f32 v[146:147], v[70:71], v[70:71], v[146:147]
v_pk_add_f32 v[144:145], v[144:145], v[70:71]
v_pk_fma_f32 v[150:151], v[86:87], v[86:87], v[150:151]
v_pk_add_f32 v[148:149], v[148:149], v[86:87]
v_pk_fma_f32 v[146:147], v[72:73], v[72:73], v[146:147]
v_pk_add_f32 v[144:145], v[144:145], v[72:73]
v_pk_fma_f32 v[150:151], v[88:89], v[88:89], v[150:151]
v_pk_add_f32 v[148:149], v[148:149], v[88:89]
v_pk_fma_f32 v[146:147], v[74:75], v[74:75], v[146:147]
v_pk_add_f32 v[144:145], v[144:145], v[74:75]
v_pk_fma_f32 v[150:151], v[90:91], v[90:91], v[150:151]
v_pk_add_f32 v[148:149], v[148:149], v[90:91]
v_pk_fma_f32 v[146:147], v[76:77], v[76:77], v[146:147]
v_pk_add_f32 v[144:145], v[144:145], v[76:77]
v_pk_fma_f32 v[150:151], v[92:93], v[92:93], v[150:151]
v_pk_add_f32 v[148:149], v[148:149], v[92:93]
v_pk_fma_f32 v[146:147], v[78:79], v[78:79], v[146:147]
v_pk_add_f32 v[144:145], v[144:145], v[78:79]
v_pk_fma_f32 v[150:151], v[94:95], v[94:95], v[150:151]
v_pk_add_f32 v[148:149], v[148:149], v[94:95]
v_add_f32 v144, v144, v145
v_add_f32 v146, v146, v147
v_add_f32 v148, v148, v149
v_add_f32 v150, v150, v151
s_nop 0
v_permlane16_swap_b32 v144, v148
v_permlane16_swap_b32 v146, v150
v_add_f32 v144, v144, v148
v_add_f32 v146, v146, v150
s_nop 1
v_permlane32_swap_b32 v144, v146
v_add_f32 v144, v144, v146
s_nop 1
v_permlane32_swap_b32 v144, v145
buffer_store_dwordx2 v[144:145], v152, s[16:19], s64 offen sc1
s_lshl_b32 s62, s2, 10
s_add_u32 s62, s62, 31457280
s_cmp_eq_u32 s3, 0
s_cselect_b32 s62, s62, 268435456
buffer_store_dwordx4 v[156:159], v27, s[16:19], s62 offen sc1
v_accvgpr_write_b32 a224, v64
v_accvgpr_write_b32 a225, v65
v_accvgpr_write_b32 a226, v66
v_accvgpr_write_b32 a227, v67
v_accvgpr_write_b32 a228, v68
v_accvgpr_write_b32 a229, v69
v_accvgpr_write_b32 a230, v70
v_accvgpr_write_b32 a231, v71
v_accvgpr_write_b32 a232, v72
v_accvgpr_write_b32 a233, v73
v_accvgpr_write_b32 a234, v74
v_accvgpr_write_b32 a235, v75
v_accvgpr_write_b32 a236, v76
v_accvgpr_write_b32 a237, v77
v_accvgpr_write_b32 a238, v78
v_accvgpr_write_b32 a239, v79
v_accvgpr_write_b32 a240, v80
v_accvgpr_write_b32 a241, v81
v_accvgpr_write_b32 a242, v82
v_accvgpr_write_b32 a243, v83
v_accvgpr_write_b32 a244, v84
v_accvgpr_write_b32 a245, v85
v_accvgpr_write_b32 a246, v86
v_accvgpr_write_b32 a247, v87
v_accvgpr_write_b32 a248, v88
v_accvgpr_write_b32 a249, v89
v_accvgpr_write_b32 a250, v90
v_accvgpr_write_b32 a251, v91
v_accvgpr_write_b32 a252, v92
v_accvgpr_write_b32 a253, v93
v_accvgpr_write_b32 a254, v94
v_accvgpr_write_b32 a255, v95
s_add_u32 m0, s55, 18496
s_nop 0
buffer_load_dwordx4 v21, s[36:39], s52 offen lds
buffer_load_dwordx4 v28, s[36:39], s52 offen offset:1024 lds
buffer_load_dword v22, s[36:39], s52 offen offset:2048 lds
s_add_u32 s52, s52, 128
s_add_u32 m0, s55, 20800
s_nop 0
buffer_load_dwordx4 v21, s[36:39], s53 offen lds
buffer_load_dwordx4 v28, s[36:39], s53 offen offset:1024 lds
buffer_load_dword v29, s[36:39], s53 offen offset:2048 lds
s_add_u32 s53, s53, 128
s_add_u32 m0, s56, 73984
s_nop 0
buffer_load_dwordx4 v18, s[20:23], s54 offen lds
buffer_load_dwordx4 v19, s[20:23], s54 offen offset:1024 lds
buffer_load_dwordx4 v20, s[20:23], s54 offen offset:2048 lds
s_add_u32 s54, s54, 196608
s_waitcnt vmcnt(15) lgkmcnt(0)
s_barrier
ds_read_b128 a[0:3], v23
RD 4,23,2304
RD 8,23,4608
RD 12,23,6912
TR 20,25,49664
TR 22,25,50176
TR 24,25,49696
TR 26,25,50208
ds_read_b128 a[16:19], v24
TR 28,25,50688
TR 30,25,51200
TR 32,25,50720
TR 34,25,51232
TR 36,25,51712
TR 38,25,52224
TR 40,25,51744
TR 42,25,52256
s_waitcnt vmcnt(12) lgkmcnt(8)
s_barrier
v_mfma_f32_16x16x32_bf16 v[60:63], a[20:23], a[0:3], 0
ds_read_b128 a[44:47], v30
RD 48,30,2304
v_mfma_f32_16x16x32_bf16 v[76:79], a[24:27], a[0:3], 0
s_add_u32 m0, s56, 86400
v_mfma_f32_16x16x32_bf16 v[80:83], a[24:27], a[4:7], 0
buffer_load_dwordx4 v18, s[20:23], s54 offen lds
v_mfma_f32_16x16x32_bf16 v[64:67], a[20:23], a[4:7], 0
s_sub_u32 s47, s47, 1
s_cbranch_scc1 .Lx18
.Lx18b:
v_mfma_f32_16x16x32_bf16 v[68:71], a[20:23], a[8:11], 0
buffer_load_dwordx4 v19, s[20:23], s54 offen offset:1024 lds
v_mfma_f32_16x16x32_bf16 v[84:87], a[24:27], a[8:11], 0
RD 52,30,4608
RD 56,30,6912
v_mfma_f32_16x16x32_bf16 v[88:91], a[24:27], a[12:15], 0
TR 64,25,62080
v_mfma_f32_16x16x32_bf16 v[72:75], a[20:23], a[12:15], 0
TR 66,25,62592
s_waitcnt lgkmcnt(6)
v_mfma_f32_16x16x32_bf16 v[244:247], a[24:27], a[16:19], 0
buffer_load_dwordx4 v20, s[20:23], s54 offen offset:2048 lds
v_mfma_f32_16x16x32_bf16 v[104:107], a[28:31], a[12:15], 0
s_add_u32 s54, s54, 196608
s_add_u32 m0, s55, 36992
v_mfma_f32_16x16x32_bf16 v[120:123], a[32:35], a[12:15], 0
buffer_load_dwordx4 v21, s[36:39], s52 offen lds
v_mfma_f32_16x16x32_bf16 v[116:119], a[32:35], a[8:11], 0
TR 68,25,62112
TR 70,25,62624
v_mfma_f32_16x16x32_bf16 v[100:103], a[28:31], a[8:11], 0
ds_read_b128 a[60:63], v31
v_mfma_f32_16x16x32_bf16 v[96:99], a[28:31], a[4:7], 0
buffer_load_dwordx4 v28, s[36:39], s52 offen offset:1024 lds
v_mfma_f32_16x16x32_bf16 v[112:115], a[32:35], a[4:7], 0
TR 72,25,63104
v_mfma_f32_16x16x32_bf16 v[108:111], a[32:35], a[0:3], 0
buffer_load_dword v22, s[36:39], s52 offen offset:2048 lds
v_mfma_f32_16x16x32_bf16 v[92:95], a[28:31], a[0:3], 0
TR 74,25,63616
s_add_u32 s52, s52, 128
v_mfma_f32_16x16x32_bf16 v[124:127], a[0:3], a[36:39], 0
TR 76,25,63136
s_add_u32 m0, s55, 39296
v_mfma_f32_16x16x32_bf16 v[140:143], a[0:3], a[40:43], 0
buffer_load_dwordx4 v21, s[36:39], s53 offen lds
v_mfma_f32_16x16x32_bf16 v[144:147], a[4:7], a[40:43], 0
TR 78,25,63648
v_mfma_f32_16x16x32_bf16 v[128:131], a[4:7], a[36:39], 0
TR 80,25,64128
v_mfma_f32_16x16x32_bf16 v[132:135], a[8:11], a[36:39], 0
buffer_load_dwordx4 v28, s[36:39], s53 offen offset:1024 lds
v_mfma_f32_16x16x32_bf16 v[148:151], a[8:11], a[40:43], 0
TR 82,25,64640
TR 84,25,64160
v_mfma_f32_16x16x32_bf16 v[152:155], a[12:15], a[40:43], 0
TR 86,25,64672
v_mfma_f32_16x16x32_bf16 v[136:139], a[12:15], a[36:39], 0
buffer_load_dword v29, s[36:39], s53 offen offset:2048 lds
v_mfma_f32_16x16x32_bf16 v[156:159], a[16:19], a[36:39], 0
s_add_u32 s53, s53, 128
v_mfma_f32_16x16x32_bf16 v[160:163], a[16:19], a[40:43], 0
s_waitcnt vmcnt(9) lgkmcnt(8)
s_barrier
MAA 60,64,44
RD 0,23,18496
RD 4,23,20800
MAA 76,68,44
s_add_u32 m0, s56, 98816
MAA 80,68,48
buffer_load_dwordx4 v18, s[20:23], s54 offen lds
MAA 64,64,48
RD 8,23,23104
RD 12,23,25408
MAA 68,64,52
buffer_load_dwordx4 v19, s[20:23], s54 offen offset:1024 lds
MAA 84,68,52
ds_read_b64_tr_b16 a[20:21], v25
MAA 88,68,56
TR 22,25,512
MAA 72,64,56
TR 24,25,32
s_waitcnt lgkmcnt(7)
MAA 244,68,60
buffer_load_dwordx4 v20, s[20:23], s54 offen offset:2048 lds
MAA 104,72,56
s_add_u32 s54, s54, 196608
s_add_u32 m0, s56, 111232
MAA 120,76,56
buffer_load_dwordx4 v18, s[20:23], s54 offen lds
MAA 116,76,52
TR 26,25,544
MAA 100,72,52
RD 16,24,18496
TR 28,25,1024
MAA 96,72,48
buffer_load_dwordx4 v19, s[20:23], s54 offen offset:1024 lds
MAA 112,76,48
TR 30,25,1536
MAA 108,76,44
buffer_load_dwordx4 v20, s[20:23], s54 offen offset:2048 lds
MAA 92,72,44
s_add_u32 s54, s54, 196608
MAA 124,44,80
TR 32,25,1056
s_add_u32 m0, s55, 55488
MAA 140,44,84
buffer_load_dwordx4 v21, s[36:39], s52 offen lds
MAA 144,48,84
TR 34,25,1568
MAA 128,48,80
TR 36,25,2048
MAA 132,52,80
buffer_load_dwordx4 v28, s[36:39], s52 offen offset:1024 lds
MAA 148,52,84
TR 38,25,2560
TR 40,25,2080
MAA 152,56,84
TR 42,25,2592
MAA 136,56,80
buffer_load_dword v22, s[36:39], s52 offen offset:2048 lds
MAA 156,60,80
s_add_u32 s52, s52, 128
MAA 160,60,84
s_waitcnt vmcnt(15) lgkmcnt(8)
s_barrier
MAA 60,20,0
RD 44,30,18496
RD 48,30,20800
MAA 76,24,0
s_add_u32 m0, s55, 57792
MAA 80,24,4
buffer_load_dwordx4 v21, s[36:39], s53 offen lds
MAA 64,20,4
s_sub_u32 s47, s47, 1
s_cbranch_scc1 .Lx19
.Lx19b:
MAA 68,20,8
buffer_load_dwordx4 v28, s[36:39], s53 offen offset:1024 lds
MAA 84,24,8
RD 52,30,23104
RD 56,30,25408
MAA 88,24,12
TR 64,25,12416
MAA 72,20,12
TR 66,25,12928
s_waitcnt lgkmcnt(6)
MAA 244,24,16
buffer_load_dword v29, s[36:39], s53 offen offset:2048 lds
MAA 104,28,12
s_add_u32 s53, s53, 128
s_add_u32 m0, s56, 123648
MAA 120,32,12
buffer_load_dwordx4 v18, s[20:23], s54 offen lds
MAA 116,32,8
TR 68,25,12448
TR 70,25,12960
MAA 100,28,8
RD 60,31,18496
MAA 96,28,4
buffer_load_dwordx4 v19, s[20:23], s54 offen offset:1024 lds
MAA 112,32,4
TR 72,25,13440
MAA 108,32,0
buffer_load_dwordx4 v20, s[20:23], s54 offen offset:2048 lds
MAA 92,28,0
TR 74,25,13952
s_add_u32 s54, s54, 196608
MAA 124,0,36
TR 76,25,13472
s_add_u32 m0, s56, 136064
MAA 140,0,40
buffer_load_dwordx4 v18, s[20:23], s54 offen lds
MAA 144,4,40
TR 78,25,13984
MAA 128,4,36
TR 80,25,14464
MAA 132,8,36
buffer_load_dwordx4 v19, s[20:23], s54 offen offset:1024 lds
MAA 148,8,40
TR 82,25,14976
TR 84,25,14496
MAA 152,12,40
TR 86,25,15008
MAA 136,12,36
buffer_load_dwordx4 v20, s[20:23], s54 offen offset:2048 lds
MAA 156,16,36
s_add_u32 s54, s54, 196608
MAA 160,16,40
s_waitcnt vmcnt(15) lgkmcnt(8)
s_barrier
MAA 60,64,44
RD 0,23,36992
RD 4,23,39296
MAA 76,68,44
s_add_u32 m0, s55, 0
MAA 80,68,48
buffer_load_dwordx4 v21, s[36:39], s52 offen lds
MAA 64,64,48
RD 8,23,41600
RD 12,23,43904
MAA 68,64,52
buffer_load_dwordx4 v28, s[36:39], s52 offen offset:1024 lds
MAA 84,68,52
TR 20,25,24832
MAA 88,68,56
TR 22,25,25344
MAA 72,64,56
TR 24,25,24864
s_waitcnt lgkmcnt(7)
MAA 244,68,60
buffer_load_dword v22, s[36:39], s52 offen offset:2048 lds
MAA 104,72,56
TR 26,25,25376
s_add_u32 s52, s52, 128
s_add_u32 m0, s55, 2304
MAA 120,76,56
buffer_load_dwordx4 v21, s[36:39], s53 offen lds
MAA 116,76,52
RD 16,24,36992
MAA 100,72,52
buffer_load_dwordx4 v28, s[36:39], s53 offen offset:1024 lds
MAA 96,72,48
TR 28,25,25856
MAA 112,76,48
buffer_load_dword v29, s[36:39], s53 offen offset:2048 lds
MAA 108,76,44
TR 30,25,26368
s_add_u32 s53, s53, 128
MAA 92,72,44
TR 32,25,25888
s_add_u32 m0, s56, 73984
MAA 124,44,80
buffer_load_dwordx4 v18, s[20:23], s54 offen lds
MAA 140,44,84
TR 34,25,26400
MAA 144,48,84
buffer_load_dwordx4 v19, s[20:23], s54 offen offset:1024 lds
MAA 128,48,80
TR 36,25,26880
MAA 132,52,80
TR 38,25,27392
TR 40,25,26912
MAA 148,52,84
buffer_load_dwordx4 v20, s[20:23], s54 offen offset:2048 lds
MAA 152,56,84
s_add_u32 s54, s54, 196608
MAA 136,56,80
buffer_load_dword v37, v34, s[40:43], 0 offen sc1
MAA 156,60,80
TR 42,25,27424
MAA 160,60,84
s_waitcnt vmcnt(22) lgkmcnt(8)
s_barrier
MAA 60,20,0
RD 44,30,36992
RD 48,30,39296
MAA 76,24,0
s_add_u32 m0, s56, 86400
MAA 80,24,4
buffer_load_dwordx4 v18, s[20:23], s54 offen lds
MAA 64,20,4
s_sub_u32 s47, s47, 1
s_cbranch_scc1 .Lx20
.Lx20b:
MAA 68,20,8
buffer_load_dwordx4 v19, s[20:23], s54 offen offset:1024 lds
MAA 84,24,8
RD 52,30,41600
RD 56,30,43904
MAA 88,24,12
TR 64,25,37248
MAA 72,20,12
TR 66,25,37760
s_waitcnt lgkmcnt(6)
MAA 244,24,16
buffer_load_dwordx4 v20, s[20:23], s54 offen offset:2048 lds
MAA 104,28,12
s_add_u32 s54, s54, 196608
s_add_u32 m0, s55, 18496
MAA 120,32,12
buffer_load_dwordx4 v21, s[36:39], s52 offen lds
MAA 116,32,8
TR 68,25,37280
TR 70,25,37792
MAA 100,28,8
RD 60,31,36992
MAA 96,28,4
buffer_load_dwordx4 v28, s[36:39], s52 offen offset:1024 lds
MAA 112,32,4
TR 72,25,38272
MAA 108,32,0
buffer_load_dword v22, s[36:39], s52 offen offset:2048 lds
MAA 92,28,0
TR 74,25,38784
s_add_u32 s52, s52, 128
MAA 124,0,36
TR 76,25,38304
s_add_u32 m0, s55, 20800
MAA 140,0,40
buffer_load_dwordx4 v21, s[36:39], s53 offen lds
MAA 144,4,40
TR 78,25,38816
MAA 128,4,36
TR 80,25,39296
MAA 132,8,36
buffer_load_dwordx4 v28, s[36:39], s53 offen offset:1024 lds
MAA 148,8,40
TR 82,25,39808
TR 84,25,39328
MAA 152,12,40
TR 86,25,39840
MAA 136,12,36
buffer_load_dword v29, s[36:39], s53 offen offset:2048 lds
MAA 156,16,36
s_add_u32 s53, s53, 128
MAA 160,16,40
s_waitcnt vmcnt(22) lgkmcnt(8)
s_barrier
MAA 60,64,44
RD 0,23,55488
MAA 76,68,44
RD 4,23,57792
s_add_u32 m0, s56, 98816
MAA 80,68,48
buffer_load_dwordx4 v18, s[20:23], s54 offen lds
MAA 64,64,48
RD 8,23,60096
MAA 68,64,52
RD 12,23,62400
MAA 84,68,52
TR 20,25,49664
MAA 88,68,56
buffer_load_dwordx4 v19, s[20:23], s54 offen offset:1024 lds
MAA 72,64,56
TR 22,25,50176
s_waitcnt lgkmcnt(6)
MAA 244,68,60
MAA 104,72,56
TR 24,25,49696
MAA 120,76,56
buffer_load_dwordx4 v20, s[20:23], s54 offen offset:2048 lds
MAA 116,76,52
TR 26,25,50208
s_add_u32 s54, s54, 196608
MAA 100,72,52
RD 16,24,55488
MAA 96,72,48
TR 28,25,50688
s_add_u32 m0, s55, 36992
MAA 112,76,48
buffer_load_dwordx4 v21, s[36:39], s52 offen lds
MAA 108,76,44
TR 30,25,51200
MAA 92,72,44
TR 32,25,50720
MAA 124,44,80
MAA 140,44,84
buffer_load_dwordx4 v28, s[36:39], s52 offen offset:1024 lds
MAA 144,48,84
TR 34,25,51232
MAA 128,48,80
TR 36,25,51712
MAA 132,52,80
TR 38,25,52224
MAA 148,52,84
buffer_load_dword v22, s[36:39], s52 offen offset:2048 lds
MAA 152,56,84
TR 40,25,51744
s_add_u32 s52, s52, 128
MAA 136,56,80
TR 42,25,52256
MAA 156,60,80
MAA 160,60,84
s_waitcnt vmcnt(25) lgkmcnt(8)
s_barrier
MAA 60,20,0
RD 44,30,55488
MAA 76,24,0
RD 48,30,57792
s_add_u32 m0, s56, 111232
MAA 80,24,4
buffer_load_dwordx4 v18, s[20:23], s54 offen lds
MAA 64,20,4
s_sub_u32 s47, s47, 1
s_cbranch_scc1 .Lx21
.Lx21b:
MAA 68,20,8
RD 52,30,60096
MAA 84,24,8
RD 56,30,62400
MAA 88,24,12
buffer_load_dwordx4 v19, s[20:23], s54 offen offset:1024 lds
MAA 72,20,12
TR 64,25,62080
s_waitcnt lgkmcnt(5)
MAA 244,24,16
TR 66,25,62592
MAA 104,28,12
TR 68,25,62112
MAA 120,32,12
buffer_load_dwordx4 v20, s[20:23], s54 offen offset:2048 lds
MAA 116,32,8
TR 70,25,62624
s_add_u32 s54, s54, 196608
MAA 100,28,8
RD 60,31,55488
MAA 96,28,4
s_add_u32 m0, s55, 39296
MAA 112,32,4
buffer_load_dwordx4 v21, s[36:39], s53 offen lds
MAA 108,32,0
TR 72,25,63104
MAA 92,28,0
TR 74,25,63616
MAA 124,0,36
TR 76,25,63136
MAA 140,0,40
buffer_load_dwordx4 v28, s[36:39], s53 offen offset:1024 lds
MAA 144,4,40
TR 78,25,63648
MAA 128,4,36
TR 80,25,64128
MAA 132,8,36
TR 82,25,64640
MAA 148,8,40
buffer_load_dword v29, s[36:39], s53 offen offset:2048 lds
MAA 152,12,40
TR 84,25,64160
s_add_u32 s53, s53, 128
MAA 136,12,36
TR 86,25,64672
MAA 156,16,36
MAA 160,16,40
s_waitcnt vmcnt(22) lgkmcnt(8)
s_barrier
s_waitcnt vmcnt(21)
v_cmp_gt_u32 vcc, v35, v37
s_nop 0
s_cbranch_vccnz .Lsp22
.Lsp22b:
v_mov_b32 v37, 0
MAA 60,64,44
ds_read_b128 a[0:3], v23
MAA 76,68,44
RD 4,23,2304
MAA 80,68,48
buffer_atomic_add v38, v32, s[16:19], 0 offen
MAA 64,64,48
RD 8,23,4608
MAA 68,64,52
RD 12,23,6912
s_add_u32 m0, s56, 123648
MAA 84,68,52
buffer_load_dwordx4 v18, s[20:23], s54 offen lds
MAA 88,68,56
ds_read_b64_tr_b16 a[20:21], v25
MAA 72,64,56
TR 22,25,512
s_waitcnt lgkmcnt(6)
MAA 244,68,60
TR 24,25,32
MAA 104,72,56
buffer_load_dwordx4 v19, s[20:23], s54 offen offset:1024 lds
MAA 120,76,56
TR 26,25,544
MAA 116,76,52
ds_read_b128 a[16:19], v24
MAA 100,72,52
buffer_load_dwordx4 v20, s[20:23], s54 offen offset:2048 lds
MAA 96,72,48
s_add_u32 s54, s54, 196608
MAA 112,76,48
TR 28,25,1024
MAA 108,76,44
TR 30,25,1536
s_add_u32 m0, s55, 55488
MAA 92,72,44
buffer_load_dwordx4 v21, s[36:39], s52 offen lds
MAA 124,44,80
TR 32,25,1056
MAA 140,44,84
TR 34,25,1568
MAA 144,48,84
buffer_load_dwordx4 v28, s[36:39], s52 offen offset:1024 lds
MAA 128,48,80
TR 36,25,2048
MAA 132,52,80
TR 38,25,2560
MAA 148,52,84
TR 40,25,2080
MAA 152,56,84
buffer_load_dword v22, s[36:39], s52 offen offset:2048 lds
MAA 136,56,80
TR 42,25,2592
s_add_u32 s52, s52, 128
MAA 156,60,80
MAA 160,60,84
s_waitcnt vmcnt(25) lgkmcnt(8)
s_barrier
MAA 60,20,0
ds_read_b128 a[44:47], v30
MAA 76,24,0
RD 48,30,2304
s_add_u32 m0, s56, 136064
MAA 80,24,4
buffer_load_dwordx4 v18, s[20:23], s54 offen lds
MAA 64,20,4
s_sub_u32 s47, s47, 1
s_cbranch_scc1 .Lx23
.Lx23b:
MAA 68,20,8
RD 52,30,4608
MAA 84,24,8
RD 56,30,6912
MAA 88,24,12
buffer_load_dwordx4 v19, s[20:23], s54 offen offset:1024 lds
MAA 72,20,12
TR 64,25,12416
s_waitcnt lgkmcnt(5)
MAA 244,24,16
TR 66,25,12928
MAA 104,28,12
TR 68,25,12448
MAA 120,32,12
buffer_load_dwordx4 v20, s[20:23], s54 offen offset:2048 lds
MAA 116,32,8
TR 70,25,12960
s_add_u32 s54, s54, 196608
MAA 100,28,8
ds_read_b128 a[60:63], v31
MAA 96,28,4
s_add_u32 m0, s55, 57792
MAA 112,32,4
buffer_load_dwordx4 v21, s[36:39], s53 offen lds
MAA 108,32,0
TR 72,25,13440
MAA 92,28,0
TR 74,25,13952
MAA 124,0,36
TR 76,25,13472
MAA 140,0,40
buffer_load_dwordx4 v28, s[36:39], s53 offen offset:1024 lds
MAA 144,4,40
TR 78,25,13984
MAA 128,4,36
TR 80,25,14464
MAA 132,8,36
TR 82,25,14976
MAA 148,8,40
buffer_load_dword v29, s[36:39], s53 offen offset:2048 lds
MAA 152,12,40
TR 84,25,14496
s_add_u32 s53, s53, 128
MAA 136,12,36
TR 86,25,15008
MAA 156,16,36
MAA 160,16,40
s_waitcnt vmcnt(22) lgkmcnt(8)
s_barrier
MAA 60,64,44
RD 0,23,18496
MAA 76,68,44
RD 4,23,20800
s_add_u32 m0, s56, 73984
MAA 80,68,48
buffer_load_dwordx4 v18, s[20:23], s54 offen lds
MAA 64,64,48
RD 8,23,23104
MAA 68,64,52
RD 12,23,25408
MAA 84,68,52
TR 20,25,24832
MAA 88,68,56
buffer_load_dwordx4 v19, s[20:23], s54 offen offset:1024 lds
MAA 72,64,56
TR 22,25,25344
s_waitcnt lgkmcnt(6)
MAA 244,68,60
MAA 104,72,56
TR 24,25,24864
MAA 120,76,56
buffer_load_dwordx4 v20, s[20:23], s54 offen offset:2048 lds
MAA 116,76,52
TR 26,25,25376
s_add_u32 s54, s54, 196608
MAA 100,72,52
RD 16,24,18496
MAA 96,72,48
TR 28,25,25856
s_add_u32 m0, s55, 0
MAA 112,76,48
buffer_load_dwordx4 v21, s[36:39], s52 offen lds
MAA 108,76,44
TR 30,25,26368
MAA 92,72,44
TR 32,25,25888
MAA 124,44,80
MAA 140,44,84
buffer_load_dwordx4 v28, s[36:39], s52 offen offset:1024 lds
MAA 144,48,84
TR 34,25,26400
MAA 128,48,80
TR 36,25,26880
MAA 132,52,80
TR 38,25,27392
MAA 148,52,84
buffer_load_dword v22, s[36:39], s52 offen offset:2048 lds
MAA 152,56,84
TR 40,25,26912
s_add_u32 s52, s52, 128
MAA 136,56,80
TR 42,25,27424
MAA 156,60,80
MAA 160,60,84
s_waitcnt vmcnt(22) lgkmcnt(8)
s_barrier
MAA 60,20,0
RD 44,30,18496
MAA 76,24,0
RD 48,30,20800
s_add_u32 m0, s56, 86400
MAA 80,24,4
buffer_load_dwordx4 v18, s[20:23], s54 offen lds
MAA 64,20,4
s_sub_u32 s47, s47, 1
s_cbranch_scc1 .Lx24
.Lx24b:
MAA 68,20,8
RD 52,30,23104
MAA 84,24,8
RD 56,30,25408
MAA 88,24,12
buffer_load_dwordx4 v19, s[20:23], s54 offen offset:1024 lds
MAA 72,20,12
TR 64,25,37248
s_waitcnt lgkmcnt(5)
MAA 244,24,16
TR 66,25,37760
MAA 104,28,12
TR 68,25,37280
MAA 120,32,12
buffer_load_dwordx4 v20, s[20:23], s54 offen offset:2048 lds
MAA 116,32,8
TR 70,25,37792
s_add_u32 s54, s54, 196608
MAA 100,28,8
RD 60,31,18496
MAA 96,28,4
s_add_u32 m0, s55, 2304
MAA 112,32,4
buffer_load_dwordx4 v21, s[36:39], s53 offen lds
MAA 108,32,0
TR 72,25,38272
MAA 92,28,0
TR 74,25,38784
MAA 124,0,36
TR 76,25,38304
MAA 140,0,40
buffer_load_dwordx4 v28, s[36:39], s53 offen offset:1024 lds
MAA 144,4,40
TR 78,25,38816
MAA 128,4,36
TR 80,25,39296
MAA 132,8,36
TR 82,25,39808
MAA 148,8,40
buffer_load_dword v29, s[36:39], s53 offen offset:2048 lds
MAA 152,12,40
TR 84,25,39328
s_add_u32 s53, s53, 128
MAA 136,12,36
TR 86,25,39840
MAA 156,16,36
MAA 160,16,40
s_waitcnt vmcnt(21) lgkmcnt(8)
s_barrier
MAA 60,64,44
RD 0,23,36992
MAA 76,68,44
RD 4,23,39296
s_add_u32 m0, s56, 98816
MAA 80,68,48
buffer_load_dwordx4 v18, s[20:23], s54 offen lds
MAA 64,64,48
RD 8,23,41600
MAA 68,64,52
RD 12,23,43904
MAA 84,68,52
TR 20,25,49664
MAA 88,68,56
buffer_load_dwordx4 v19, s[20:23], s54 offen offset:1024 lds
MAA 72,64,56
TR 22,25,50176
s_waitcnt lgkmcnt(6)
MAA 244,68,60
MAA 104,72,56
TR 24,25,49696
MAA 120,76,56
buffer_load_dwordx4 v20, s[20:23], s54 offen offset:2048 lds
MAA 116,76,52
TR 26,25,50208
s_add_u32 s54, s54, 196608
MAA 100,72,52
RD 16,24,36992
MAA 96,72,48
TR 28,25,50688
s_add_u32 m0, s55, 18496
MAA 112,76,48
buffer_load_dwordx4 v21, s[36:39], s52 offen lds
MAA 108,76,44
TR 30,25,51200
MAA 92,72,44
TR 32,25,50720
MAA 124,44,80
MAA 140,44,84
buffer_load_dwordx4 v28, s[36:39], s52 offen offset:1024 lds
MAA 144,48,84
TR 34,25,51232
MAA 128,48,80
TR 36,25,51712
MAA 132,52,80
TR 38,25,52224
MAA 148,52,84
buffer_load_dword v22, s[36:39], s52 offen offset:2048 lds
MAA 152,56,84
TR 40,25,51744
s_add_u32 s52, s52, 128
MAA 136,56,80
TR 42,25,52256
MAA 156,60,80
MAA 160,60,84
s_waitcnt vmcnt(21) lgkmcnt(8)
s_barrier
MAA 60,20,0
RD 44,30,36992
MAA 76,24,0
RD 48,30,39296
s_add_u32 m0, s56, 111232
MAA 80,24,4
buffer_load_dwordx4 v18, s[20:23], s54 offen lds
MAA 64,20,4
s_sub_u32 s47, s47, 1
s_cbranch_scc1 .Lx25
.Lx25b:
MAA 68,20,8
RD 52,30,41600
MAA 84,24,8
buffer_load_dwordx4 v19, s[20:23], s54 offen offset:1024 lds
MAA 88,24,12
RD 56,30,43904
MAA 72,20,12
TR 64,25,62080
s_waitcnt lgkmcnt(5)
MAA 244,24,16
TR 66,25,62592
MAA 104,28,12
buffer_load_dwordx4 v20, s[20:23], s54 offen offset:2048 lds
MAA 120,32,12
TR 68,25,62112
s_add_u32 s54, s54, 196608
MAA 116,32,8
TR 70,25,62624
s_add_u32 m0, s55, 20800
MAA 100,28,8
buffer_load_dwordx4 v21, s[36:39], s53 offen lds
MAA 96,28,4
RD 60,31,36992
MAA 112,32,4
TR 72,25,63104
MAA 108,32,0
TR 74,25,63616
MAA 92,28,0
buffer_load_dwordx4 v28, s[36:39], s53 offen offset:1024 lds
MAA 124,0,36
TR 76,25,63136
MAA 140,0,40
TR 78,25,63648
MAA 144,4,40
buffer_load_dword v29, s[36:39], s53 offen offset:2048 lds
MAA 128,4,36
TR 80,25,64128
s_add_u32 s53, s53, 128
MAA 132,8,36
TR 82,25,64640
MAA 148,8,40
TR 84,25,64160
MAA 152,12,40
buffer_atomic_add v37, v33, s[16:19], 0 offen sc0
MAA 136,12,36
TR 86,25,64672
MAA 156,16,36
MAA 160,16,40
s_waitcnt vmcnt(22) lgkmcnt(8)
s_barrier
MAA 60,64,44
RD 0,23,55488
MAA 76,68,44
RD 4,23,57792
s_add_u32 m0, s56, 123648
MAA 80,68,48
buffer_load_dwordx4 v18, s[20:23], s54 offen lds
MAA 64,64,48
RD 8,23,60096
MAA 68,64,52
RD 12,23,62400
MAA 84,68,52
ds_read_b64_tr_b16 a[20:21], v25
MAA 88,68,56
buffer_load_dwordx4 v19, s[20:23], s54 offen offset:1024 lds
MAA 72,64,56
TR 22,25,512
s_waitcnt lgkmcnt(6)
MAA 244,68,60
MAA 104,72,56
TR 24,25,32
MAA 120,76,56
buffer_load_dwordx4 v20, s[20:23], s54 offen offset:2048 lds
MAA 116,76,52
TR 26,25,544
s_add_u32 s54, s54, 196608
MAA 100,72,52
RD 16,24,55488
MAA 96,72,48
TR 28,25,1024
s_add_u32 m0, s55, 36992
MAA 112,76,48
buffer_load_dwordx4 v21, s[36:39], s52 offen lds
MAA 108,76,44
TR 30,25,1536
MAA 92,72,44
TR 32,25,1056
MAA 124,44,80
MAA 140,44,84
buffer_load_dwordx4 v28, s[36:39], s52 offen offset:1024 lds
MAA 144,48,84
TR 34,25,1568
MAA 128,48,80
TR 36,25,2048
MAA 132,52,80
TR 38,25,2560
MAA 148,52,84
buffer_load_dword v22, s[36:39], s52 offen offset:2048 lds
MAA 152,56,84
TR 40,25,2080
s_add_u32 s52, s52, 128
MAA 136,56,80
TR 42,25,2592
MAA 156,60,80
MAA 160,60,84
s_waitcnt vmcnt(22) lgkmcnt(8)
s_barrier
MAA 60,20,0
RD 44,30,55488
MAA 76,24,0
RD 48,30,57792
s_add_u32 m0, s56, 136064
MAA 80,24,4
buffer_load_dwordx4 v18, s[20:23], s54 offen lds
MAA 64,20,4
s_sub_u32 s47, s47, 1
s_cbranch_scc1 .Lx26
.Lx26b:
MAA 68,20,8
RD 52,30,60096
MAA 84,24,8
RD 56,30,62400
MAA 88,24,12
buffer_load_dwordx4 v19, s[20:23], s54 offen offset:1024 lds
MAA 72,20,12
TR 64,25,12416
s_waitcnt lgkmcnt(5)
MAA 244,24,16
TR 66,25,12928
MAA 104,28,12
TR 68,25,12448
MAA 120,32,12
buffer_load_dwordx4 v20, s[20:23], s54 offen offset:2048 lds
MAA 116,32,8
TR 70,25,12960
s_add_u32 s54, s54, 196608
MAA 100,28,8
RD 60,31,55488
MAA 96,28,4
s_add_u32 m0, s55, 39296
MAA 112,32,4
buffer_load_dwordx4 v21, s[36:39], s53 offen lds
MAA 108,32,0
TR 72,25,13440
MAA 92,28,0
TR 74,25,13952
MAA 124,0,36
TR 76,25,13472
MAA 140,0,40
buffer_load_dwordx4 v28, s[36:39], s53 offen offset:1024 lds
MAA 144,4,40
TR 78,25,13984
MAA 128,4,36
TR 80,25,14464
MAA 132,8,36
TR 82,25,14976
MAA 148,8,40
buffer_load_dword v29, s[36:39], s53 offen offset:2048 lds
MAA 152,12,40
TR 84,25,14496
s_add_u32 s53, s53, 128
MAA 136,12,36
TR 86,25,15008
MAA 156,16,36
MAA 160,16,40
s_waitcnt vmcnt(22) lgkmcnt(8)
s_barrier
MAA 60,64,44
ds_read_b128 a[0:3], v23
MAA 76,68,44
RD 4,23,2304
s_add_u32 m0, s56, 73984
MAA 80,68,48
buffer_load_dwordx4 v18, s[20:23], s54 offen lds
MAA 64,64,48
RD 8,23,4608
MAA 68,64,52
RD 12,23,6912
MAA 84,68,52
TR 20,25,24832
MAA 88,68,56
buffer_load_dwordx4 v19, s[20:23], s54 offen offset:1024 lds
MAA 72,64,56
TR 22,25,25344
s_waitcnt lgkmcnt(6)
MAA 244,68,60
MAA 104,72,56
TR 24,25,24864
MAA 120,76,56
buffer_load_dwordx4 v20, s[20:23], s54 offen offset:2048 lds
MAA 116,76,52
TR 26,25,25376
s_add_u32 s54, s54, 196608
MAA 100,72,52
ds_read_b128 a[16:19], v24
MAA 96,72,48
TR 28,25,25856
s_add_u32 m0, s55, 55488
MAA 112,76,48
buffer_load_dwordx4 v21, s[36:39], s52 offen lds
MAA 108,76,44
TR 30,25,26368
MAA 92,72,44
TR 32,25,25888
MAA 124,44,80
MAA 140,44,84
buffer_load_dwordx4 v28, s[36:39], s52 offen offset:1024 lds
MAA 144,48,84
TR 34,25,26400
MAA 128,48,80
TR 36,25,26880
MAA 132,52,80
TR 38,25,27392
MAA 148,52,84
buffer_load_dword v22, s[36:39], s52 offen offset:2048 lds
MAA 152,56,84
TR 40,25,26912
s_add_u32 s52, s52, 128
MAA 136,56,80
TR 42,25,27424
MAA 156,60,80
MAA 160,60,84
s_waitcnt vmcnt(22) lgkmcnt(8)
s_barrier
MAA 60,20,0
ds_read_b128 a[44:47], v30
MAA 76,24,0
RD 48,30,2304
s_add_u32 m0, s56, 86400
MAA 80,24,4
buffer_load_dwordx4 v18, s[20:23], s54 offen lds
MAA 64,20,4
s_sub_u32 s47, s47, 1
s_cbranch_scc1 .Lx27
.Lx27b:
MAA 68,20,8
RD 52,30,4608
MAA 84,24,8
RD 56,30,6912
MAA 88,24,12
buffer_load_dwordx4 v19, s[20:23], s54 offen offset:1024 lds
MAA 72,20,12
TR 64,25,37248
s_waitcnt lgkmcnt(5)
MAA 244,24,16
TR 66,25,37760
MAA 104,28,12
TR 68,25,37280
MAA 120,32,12
buffer_load_dwordx4 v20, s[20:23], s54 offen offset:2048 lds
MAA 116,32,8
TR 70,25,37792
s_add_u32 s54, s54, 196608
MAA 100,28,8
ds_read_b128 a[60:63], v31
MAA 96,28,4
s_add_u32 m0, s55, 57792
MAA 112,32,4
buffer_load_dwordx4 v21, s[36:39], s53 offen lds
MAA 108,32,0
TR 72,25,38272
MAA 92,28,0
TR 74,25,38784
MAA 124,0,36
TR 76,25,38304
MAA 140,0,40
buffer_load_dwordx4 v28, s[36:39], s53 offen offset:1024 lds
MAA 144,4,40
TR 78,25,38816
MAA 128,4,36
TR 80,25,39296
MAA 132,8,36
TR 82,25,39808
MAA 148,8,40
buffer_load_dword v29, s[36:39], s53 offen offset:2048 lds
MAA 152,12,40
TR 84,25,39328
s_add_u32 s53, s53, 128
MAA 136,12,36
TR 86,25,39840
MAA 156,16,36
MAA 160,16,40
s_waitcnt vmcnt(24)
v_cmp_gt_u32 vcc, v36, v37
s_nop 0
s_cbranch_vccnz .Lsp28
.Lsp28b:
s_waitcnt vmcnt(21) lgkmcnt(8)
s_barrier
MAA 60,64,44
RD 0,23,18496
MAA 76,68,44
RD 4,23,20800
s_add_u32 m0, s56, 98816
MAA 80,68,48
buffer_load_dwordx4 v18, s[20:23], s54 offen lds
MAA 64,64,48
RD 8,23,23104
MAA 68,64,52
RD 12,23,25408
MAA 84,68,52
buffer_load_dwordx4 v19, s[20:23], s54 offen offset:1024 lds
MAA 88,68,56
TR 20,25,49664
MAA 72,64,56
TR 22,25,50176
s_waitcnt lgkmcnt(6)
MAA 244,68,60
TR 24,25,49696
MAA 104,72,56
buffer_load_dwordx4 v20, s[20:23], s54 offen offset:2048 lds
MAA 120,76,56
TR 26,25,50208
s_add_u32 s54, s54, 196608
MAA 116,76,52
RD 16,24,18496
s_add_u32 m0, s55, 0
MAA 100,72,52
buffer_load_dwordx4 v21, s[36:39], s52 offen lds
MAA 96,72,48
MAA 112,76,48
TR 28,25,50688
MAA 108,76,44
TR 30,25,51200
MAA 92,72,44
buffer_load_dwordx4 v28, s[36:39], s52 offen offset:1024 lds
MAA 124,44,80
TR 32,25,50720
MAA 140,44,84
TR 34,25,51232
MAA 144,48,84
buffer_load_dword v22, s[36:39], s52 offen offset:2048 lds
MAA 128,48,80
TR 36,25,51712
s_add_u32 s52, s52, 128
MAA 132,52,80
TR 38,25,52224
MAA 148,52,84
TR 40,25,51744
MAA 152,56,84
buffer_load_dwordx4 v[164:167], v26, s[16:19], s75 offen sc1
MAA 136,56,80
TR 42,25,52256
MAA 156,60,80
MAA 160,60,84
s_waitcnt vmcnt(22) lgkmcnt(8)
s_barrier
MAA 60,20,0
RD 44,30,18496
MAA 76,24,0
RD 48,30,20800
s_add_u32 m0, s56, 111232
MAA 80,24,4
buffer_load_dwordx4 v18, s[20:23], s54 offen lds
MAA 64,20,4
s_sub_u32 s47, s47, 1
s_cbranch_scc1 .Lx29
.Lx29b:
MAA 68,20,8
RD 52,30,23104
MAA 84,24,8
buffer_load_dwordx4 v19, s[20:23], s54 offen offset:1024 lds
MAA 88,24,12
RD 56,30,25408
MAA 72,20,12
TR 64,25,62080
s_waitcnt lgkmcnt(5)
MAA 244,24,16
TR 66,25,62592
MAA 104,28,12
buffer_load_dwordx4 v20, s[20:23], s54 offen offset:2048 lds
MAA 120,32,12
TR 68,25,62112
s_add_u32 s54, s54, 196608
MAA 116,32,8
TR 70,25,62624
s_add_u32 m0, s55, 2304
MAA 100,28,8
buffer_load_dwordx4 v21, s[36:39], s53 offen lds
MAA 96,28,4
RD 60,31,18496
MAA 112,32,4
TR 72,25,63104
MAA 108,32,0
TR 74,25,63616
MAA 92,28,0
buffer_load_dwordx4 v28, s[36:39], s53 offen offset:1024 lds
MAA 124,0,36
TR 76,25,63136
MAA 140,0,40
TR 78,25,63648
MAA 144,4,40
buffer_load_dword v29, s[36:39], s53 offen offset:2048 lds
MAA 128,4,36
TR 80,25,64128
s_add_u32 s53, s53, 128
MAA 132,8,36
TR 82,25,64640
MAA 148,8,40
TR 84,25,64160
MAA 152,12,40
buffer_load_dwordx4 v[168:171], v26, s[16:19], s75 offen offset:1024 sc1
MAA 136,12,36
TR 86,25,64672
MAA 156,16,36
MAA 160,16,40
s_waitcnt vmcnt(23) lgkmcnt(8)
s_barrier
MAA 60,64,44
RD 0,23,36992
MAA 76,68,44
RD 4,23,39296
s_add_u32 m0, s56, 123648
MAA 80,68,48
buffer_load_dwordx4 v18, s[20:23], s54 offen lds
MAA 64,64,48
RD 8,23,41600
MAA 68,64,52
RD 12,23,43904
MAA 84,68,52
buffer_load_dwordx4 v19, s[20:23], s54 offen offset:1024 lds
MAA 88,68,56
ds_read_b64_tr_b16 a[20:21], v25
MAA 72,64,56
TR 22,25,512
s_waitcnt lgkmcnt(6)
MAA 244,68,60
TR 24,25,32
MAA 104,72,56
buffer_load_dwordx4 v20, s[20:23], s54 offen offset:2048 lds
MAA 120,76,56
TR 26,25,544
s_add_u32 s54, s54, 196608
MAA 116,76,52
RD 16,24,36992
s_add_u32 m0, s55, 18496
MAA 100,72,52
buffer_load_dwordx4 v21, s[36:39], s52 offen lds
MAA 96,72,48
MAA 112,76,48
TR 28,25,1024
MAA 108,76,44
TR 30,25,1536
MAA 92,72,44
buffer_load_dwordx4 v28, s[36:39], s52 offen offset:1024 lds
MAA 124,44,80
TR 32,25,1056
MAA 140,44,84
TR 34,25,1568
MAA 144,48,84
buffer_load_dword v22, s[36:39], s52 offen offset:2048 lds
MAA 128,48,80
TR 36,25,2048
s_add_u32 s52, s52, 128
MAA 132,52,80
TR 38,25,2560
MAA 148,52,84
TR 40,25,2080
MAA 152,56,84
buffer_load_dwordx4 v[172:175], v26, s[16:19], s75 offen offset:2048 sc1
MAA 136,56,80
TR 42,25,2592
MAA 156,60,80
MAA 160,60,84
s_waitcnt vmcnt(24) lgkmcnt(8)
s_barrier
MAA 60,20,0
RD 44,30,36992
MAA 76,24,0
RD 48,30,39296
s_add_u32 m0, s56, 136064
MAA 80,24,4
buffer_load_dwordx4 v18, s[20:23], s54 offen lds
MAA 64,20,4
s_sub_u32 s47, s47, 1
s_cbranch_scc1 .Lx30
.Lx30b:
MAA 68,20,8
RD 52,30,41600
MAA 84,24,8
buffer_load_dwordx4 v19, s[20:23], s54 offen offset:1024 lds
MAA 88,24,12
RD 56,30,43904
MAA 72,20,12
TR 64,25,12416
s_waitcnt lgkmcnt(5)
MAA 244,24,16
TR 66,25,12928
MAA 104,28,12
buffer_load_dwordx4 v20, s[20:23], s54 offen offset:2048 lds
MAA 120,32,12
TR 68,25,12448
s_add_u32 s54, s54, 196608
MAA 116,32,8
TR 70,25,12960
s_add_u32 m0, s55, 20800
MAA 100,28,8
buffer_load_dwordx4 v21, s[36:39], s53 offen lds
MAA 96,28,4
RD 60,31,36992
MAA 112,32,4
TR 72,25,13440
MAA 108,32,0
TR 74,25,13952
MAA 92,28,0
buffer_load_dwordx4 v28, s[36:39], s53 offen offset:1024 lds
MAA 124,0,36
TR 76,25,13472
MAA 140,0,40
TR 78,25,13984
MAA 144,4,40
buffer_load_dword v29, s[36:39], s53 offen offset:2048 lds
MAA 128,4,36
TR 80,25,14464
s_add_u32 s53, s53, 128
MAA 132,8,36
TR 82,25,14976
MAA 148,8,40
TR 84,25,14496
MAA 152,12,40
buffer_load_dwordx4 v[176:179], v26, s[16:19], s75 offen offset:3072 sc1
MAA 136,12,36
TR 86,25,15008
s_add_u32 s75, s75, 4096
MAA 156,16,36
MAA 160,16,40
s_waitcnt vmcnt(25) lgkmcnt(8)
s_barrier
MAA 60,64,44
RD 0,23,55488
MAA 76,68,44
RD 4,23,57792
s_add_u32 m0, s56, 73984
MAA 80,68,48
buffer_load_dwordx4 v18, s[20:23], s54 offen lds
MAA 64,64,48
RD 8,23,60096
MAA 68,64,52
RD 12,23,62400
MAA 84,68,52
buffer_load_dwordx4 v19, s[20:23], s54 offen offset:1024 lds
MAA 88,68,56
TR 20,25,24832
MAA 72,64,56
TR 22,25,25344
s_waitcnt lgkmcnt(6)
MAA 244,68,60
TR 24,25,24864
MAA 104,72,56
buffer_load_dwordx4 v20, s[20:23], s54 offen offset:2048 lds
MAA 120,76,56
TR 26,25,25376
s_add_u32 s54, s54, 196608
MAA 116,76,52
RD 16,24,55488
s_add_u32 m0, s55, 36992
MAA 100,72,52
buffer_load_dwordx4 v21, s[36:39], s52 offen lds
MAA 96,72,48
MAA 112,76,48
TR 28,25,25856
MAA 108,76,44
TR 30,25,26368
MAA 92,72,44
buffer_load_dwordx4 v28, s[36:39], s52 offen offset:1024 lds
MAA 124,44,80
TR 32,25,25888
MAA 140,44,84
TR 34,25,26400
MAA 144,48,84
buffer_load_dword v22, s[36:39], s52 offen offset:2048 lds
MAA 128,48,80
TR 36,25,26880
s_add_u32 s52, s52, 128
MAA 132,52,80
TR 38,25,27392
MAA 148,52,84
TR 40,25,26912
MAA 152,56,84
buffer_load_dwordx4 v[180:183], v26, s[16:19], s75 offen sc1
MAA 136,56,80
TR 42,25,27424
MAA 156,60,80
MAA 160,60,84
s_waitcnt vmcnt(25) lgkmcnt(8)
s_barrier
MAA 60,20,0
RD 44,30,55488
s_waitcnt vmcnt(21)
v_add_f32 v164, v164, v168
MAA 76,24,0
RD 48,30,57792
s_add_u32 m0, s56, 86400
MAA 80,24,4
buffer_load_dwordx4 v18, s[20:23], s54 offen lds
MAA 64,20,4
s_sub_u32 s47, s47, 1
s_cbranch_scc1 .Lx31
.Lx31b:
MAA 68,20,8
RD 52,30,60096
MAA 84,24,8
buffer_load_dwordx4 v19, s[20:23], s54 offen offset:1024 lds
MAA 88,24,12
RD 56,30,62400
MAA 72,20,12
TR 64,25,37248
s_waitcnt lgkmcnt(5)
MAA 244,24,16
TR 66,25,37760
v_add_f32 v165, v165, v169
MAA 104,28,12
buffer_load_dwordx4 v20, s[20:23], s54 offen offset:2048 lds
MAA 120,32,12
TR 68,25,37280
s_add_u32 s54, s54, 196608
MAA 116,32,8
TR 70,25,37792
s_add_u32 m0, s55, 39296
MAA 100,28,8
buffer_load_dwordx4 v21, s[36:39], s53 offen lds
MAA 96,28,4
RD 60,31,55488
MAA 112,32,4
TR 72,25,38272
MAA 108,32,0
TR 74,25,38784
MAA 92,28,0
buffer_load_dwordx4 v28, s[36:39], s53 offen offset:1024 lds
MAA 124,0,36
TR 76,25,38304
v_add_f32 v166, v166, v170
MAA 140,0,40
TR 78,25,38816
MAA 144,4,40
buffer_load_dword v29, s[36:39], s53 offen offset:2048 lds
MAA 128,4,36
TR 80,25,39296
s_add_u32 s53, s53, 128
MAA 132,8,36
TR 82,25,39808
MAA 148,8,40
TR 84,25,39328
v_add_f32 v167, v167, v171
MAA 152,12,40
buffer_load_dwordx4 v[184:187], v26, s[16:19], s75 offen offset:1024 sc1
MAA 136,12,36
TR 86,25,39840
MAA 156,16,36
MAA 160,16,40
s_waitcnt vmcnt(25) lgkmcnt(8)
s_barrier
MAA 60,64,44
ds_read_b128 a[0:3], v23
s_waitcnt vmcnt(21)
v_add_f32 v164, v164, v172
MAA 76,68,44
RD 4,23,2304
s_add_u32 m0, s56, 98816
MAA 80,68,48
buffer_load_dwordx4 v18, s[20:23], s54 offen lds
MAA 64,64,48
RD 8,23,4608
MAA 68,64,52
RD 12,23,6912
MAA 84,68,52
buffer_load_dwordx4 v19, s[20:23], s54 offen offset:1024 lds
MAA 88,68,56
TR 20,25,49664
MAA 72,64,56
TR 22,25,50176
s_waitcnt lgkmcnt(6)
MAA 244,68,60
TR 24,25,49696
v_add_f32 v165, v165, v173
MAA 104,72,56
buffer_load_dwordx4 v20, s[20:23], s54 offen offset:2048 lds
MAA 120,76,56
TR 26,25,50208
s_add_u32 s54, s54, 196608
MAA 116,76,52
ds_read_b128 a[16:19], v24
s_add_u32 m0, s55, 55488
MAA 100,72,52
buffer_load_dwordx4 v21, s[36:39], s52 offen lds
MAA 96,72,48
MAA 112,76,48
TR 28,25,50688
MAA 108,76,44
TR 30,25,51200
v_add_f32 v166, v166, v174
MAA 92,72,44
buffer_load_dwordx4 v28, s[36:39], s52 offen offset:1024 lds
MAA 124,44,80
TR 32,25,50720
MAA 140,44,84
TR 34,25,51232
MAA 144,48,84
buffer_load_dword v22, s[36:39], s52 offen offset:2048 lds
MAA 128,48,80
TR 36,25,51712
s_add_u32 s52, s52, 128
MAA 132,52,80
TR 38,25,52224
MAA 148,52,84
TR 40,25,51744
v_add_f32 v167, v167, v175
MAA 152,56,84
buffer_load_dwordx4 v[188:191], v26, s[16:19], s75 offen offset:2048 sc1
MAA 136,56,80
TR 42,25,52256
MAA 156,60,80
MAA 160,60,84
s_waitcnt vmcnt(25) lgkmcnt(8)
s_barrier
MAA 60,20,0
ds_read_b128 a[44:47], v30
s_waitcnt vmcnt(21)
v_add_f32 v164, v164, v176
MAA 76,24,0
RD 48,30,2304
s_add_u32 m0, s56, 111232
MAA 80,24,4
buffer_load_dwordx4 v18, s[20:23], s54 offen lds
MAA 64,20,4
RD 52,30,4608
MAA 68,20,8
RD 56,30,6912
MAA 84,24,8
buffer_load_dwordx4 v19, s[20:23], s54 offen offset:1024 lds
MAA 88,24,12
TR 64,25,62080
MAA 72,20,12
TR 66,25,62592
s_waitcnt lgkmcnt(6)
MAA 244,24,16
TR 68,25,62112
v_add_f32 v165, v165, v177
MAA 104,28,12
buffer_load_dwordx4 v20, s[20:23], s54 offen offset:2048 lds
MAA 120,32,12
TR 70,25,62624
s_add_u32 s54, s54, 196608
MAA 116,32,8
ds_read_b128 a[60:63], v31
s_add_u32 m0, s55, 57792
MAA 100,28,8
buffer_load_dwordx4 v21, s[36:39], s53 offen lds
MAA 96,28,4
MAA 112,32,4
TR 72,25,63104
MAA 108,32,0
TR 74,25,63616
v_add_f32 v166, v166, v178
MAA 92,28,0
buffer_load_dwordx4 v28, s[36:39], s53 offen offset:1024 lds
MAA 124,0,36
TR 76,25,63136
MAA 140,0,40
TR 78,25,63648
MAA 144,4,40
buffer_load_dword v29, s[36:39], s53 offen offset:2048 lds
MAA 128,4,36
TR 80,25,64128
s_add_u32 s53, s53, 128
MAA 132,8,36
TR 82,25,64640
MAA 148,8,40
TR 84,25,64160
v_add_f32 v167, v167, v179
MAA 152,12,40
buffer_load_dwordx4 v[192:195], v26, s[16:19], s75 offen offset:3072 sc1
MAA 136,12,36
TR 86,25,64672
MAA 156,16,36
MAA 160,16,40
s_waitcnt vmcnt(25) lgkmcnt(8)
s_barrier
MAA 60,64,44
RD 0,23,18496
s_waitcnt vmcnt(21)
v_add_f32 v164, v164, v180
MAA 76,68,44
RD 4,23,20800
s_add_u32 m0, s56, 123648
MAA 80,68,48
buffer_load_dwordx4 v18, s[20:23], s54 offen lds
MAA 64,64,48
RD 8,23,23104
MAA 68,64,52
MAA 84,68,52
RD 12,23,25408
MAA 88,68,56
ds_read_b64_tr_b16 a[20:21], v25
MAA 72,64,56
TR 22,25,512
s_waitcnt lgkmcnt(6)
MAA 244,68,60
v_add_f32 v165, v165, v181
MAA 104,72,56
TR 24,25,32
MAA 120,76,56
buffer_load_dwordx4 v19, s[20:23], s54 offen offset:1024 lds
MAA 116,76,52
TR 26,25,544
MAA 100,72,52
RD 16,24,18496
MAA 96,72,48
MAA 112,76,48
TR 28,25,1024
v_add_f32 v166, v166, v182
MAA 108,76,44
TR 30,25,1536
MAA 92,72,44
TR 32,25,1056
MAA 124,44,80
MAA 140,44,84
buffer_load_dwordx4 v20, s[20:23], s54 offen offset:2048 lds
MAA 144,48,84
TR 34,25,1568
s_add_u32 s54, s54, 196608
MAA 128,48,80
TR 36,25,2048
MAA 132,52,80
TR 38,25,2560
v_add_f32 v167, v167, v183
MAA 148,52,84
MAA 152,56,84
TR 40,25,2080
MAA 136,56,80
TR 42,25,2592
MAA 156,60,80
MAA 160,60,84
s_waitcnt vmcnt(21) lgkmcnt(8)
s_barrier
MAA 60,20,0
RD 44,30,18496
s_waitcnt vmcnt(17)
v_add_f32 v164, v164, v184
MAA 76,24,0
RD 48,30,20800
s_add_u32 m0, s56, 136064
MAA 80,24,4
buffer_load_dwordx4 v18, s[20:23], s54 offen lds
MAA 64,20,4
RD 52,30,23104
MAA 68,20,8
MAA 84,24,8
RD 56,30,25408
MAA 88,24,12
TR 64,25,12416
MAA 72,20,12
TR 66,25,12928
s_waitcnt lgkmcnt(6)
MAA 244,24,16
v_add_f32 v165, v165, v185
MAA 104,28,12
TR 68,25,12448
MAA 120,32,12
buffer_load_dwordx4 v19, s[20:23], s54 offen offset:1024 lds
MAA 116,32,8
TR 70,25,12960
MAA 100,28,8
RD 60,31,18496
MAA 96,28,4
MAA 112,32,4
TR 72,25,13440
v_add_f32 v166, v166, v186
MAA 108,32,0
TR 74,25,13952
MAA 92,28,0
TR 76,25,13472
MAA 124,0,36
MAA 140,0,40
buffer_load_dwordx4 v20, s[20:23], s54 offen offset:2048 lds
MAA 144,4,40
TR 78,25,13984
s_add_u32 s54, s54, 196608
MAA 128,4,36
TR 80,25,14464
MAA 132,8,36
TR 82,25,14976
v_add_f32 v167, v167, v187
MAA 148,8,40
MAA 152,12,40
TR 84,25,14496
MAA 136,12,36
TR 86,25,15008
MAA 156,16,36
MAA 160,16,40
s_waitcnt vmcnt(17) lgkmcnt(8)
s_barrier
MAA 60,64,44
RD 0,23,36992
s_waitcnt vmcnt(13)
v_add_f32 v164, v164, v188
MAA 76,68,44
s_add_u32 m0, s59, 0
s_mov_b32 s58, 1048576
MAA 80,68,48
buffer_load_dwordx4 v5, s[24:27], s58 offen lds
MAA 64,64,48
RD 4,23,39296
MAA 68,64,52
RD 8,23,41600
MAA 84,68,52
RD 12,23,43904
v_add_f32 v165, v165, v189
MAA 88,68,56
buffer_load_dwordx4 v6, s[24:27], s58 offen offset:1024 lds
MAA 72,64,56
TR 20,25,24832
s_waitcnt lgkmcnt(5)
MAA 244,68,60
TR 22,25,25344
MAA 104,72,56
s_add_u32 m0, s59, 8320
s_mov_b32 s58, 1179648
MAA 120,76,56
buffer_load_dwordx4 v5, s[24:27], s58 offen lds
MAA 116,76,52
TR 24,25,24864
MAA 100,72,52
TR 26,25,25376
MAA 96,72,48
RD 16,24,36992
v_add_f32 v166, v166, v190
MAA 112,76,48
buffer_load_dwordx4 v6, s[24:27], s58 offen offset:1024 lds
MAA 108,76,44
TR 28,25,25856
MAA 92,72,44
TR 30,25,26368
MAA 124,44,80
s_add_u32 m0, s59, 16640
s_mov_b32 s58, 1310720
MAA 140,44,84
buffer_load_dwordx4 v5, s[24:27], s58 offen lds
MAA 144,48,84
TR 32,25,25888
MAA 128,48,80
TR 34,25,26400
v_add_f32 v167, v167, v191
MAA 132,52,80
TR 36,25,26880
MAA 148,52,84
buffer_load_dwordx4 v6, s[24:27], s58 offen offset:1024 lds
MAA 152,56,84
TR 38,25,27392
MAA 136,56,80
TR 40,25,26912
MAA 156,60,80
TR 42,25,27424
MAA 160,60,84
s_waitcnt vmcnt(16) lgkmcnt(8)
s_barrier
MAA 60,20,0
RD 44,30,36992
s_waitcnt vmcnt(12)
v_add_f32 v164, v164, v192
MAA 76,24,0
s_add_u32 m0, s59, 24960
s_mov_b32 s58, 1441792
MAA 80,24,4
buffer_load_dwordx4 v5, s[24:27], s58 offen lds
MAA 64,20,4
RD 48,30,39296
MAA 68,20,8
RD 52,30,41600
MAA 84,24,8
RD 56,30,43904
v_add_f32 v165, v165, v193
MAA 88,24,12
buffer_load_dwordx4 v6, s[24:27], s58 offen offset:1024 lds
MAA 72,20,12
TR 64,25,37248
s_waitcnt lgkmcnt(5)
MAA 244,24,16
TR 66,25,37760
MAA 104,28,12
s_add_u32 m0, s59, 74880
s_mov_b32 s58, 131072
MAA 120,32,12
buffer_load_dwordx4 v5, s[24:27], s58 offen lds
MAA 116,32,8
TR 68,25,37280
MAA 100,28,8
TR 70,25,37792
MAA 96,28,4
RD 60,31,36992
v_add_f32 v166, v166, v194
MAA 112,32,4
buffer_load_dwordx4 v6, s[24:27], s58 offen offset:1024 lds
MAA 108,32,0
TR 72,25,38272
MAA 92,28,0
TR 74,25,38784
MAA 124,0,36
s_add_u32 m0, s59, 83200
s_mov_b32 s58, 262144
MAA 140,0,40
buffer_load_dwordx4 v5, s[24:27], s58 offen lds
MAA 144,4,40
TR 76,25,38304
MAA 128,4,36
TR 78,25,38816
v_add_f32 v167, v167, v195
MAA 132,8,36
TR 80,25,39296
MAA 148,8,40
buffer_load_dwordx4 v6, s[24:27], s58 offen offset:1024 lds
MAA 152,12,40
TR 82,25,39808
MAA 136,12,36
TR 84,25,39328
MAA 156,16,36
TR 86,25,39840
MAA 160,16,40
s_waitcnt vmcnt(15) lgkmcnt(8)
s_barrier
MAA 60,64,44
RD 0,23,55488
v_permlane32_swap_b32 v164, v166
MAA 76,68,44
s_add_u32 m0, s59, 33280
s_mov_b32 s58, 1572864
MAA 80,68,48
buffer_load_dwordx4 v5, s[24:27], s58 offen lds
MAA 64,64,48
RD 4,23,57792
v_permlane32_swap_b32 v165, v167
MAA 68,64,52
RD 8,23,60096
MAA 84,68,52
RD 12,23,62400
v_add_f32 v164, v164, v166
MAA 88,68,56
buffer_load_dwordx4 v6, s[24:27], s58 offen offset:1024 lds
MAA 72,64,56
TR 20,25,49664
s_waitcnt lgkmcnt(5)
MAA 244,68,60
TR 22,25,50176
MAA 104,72,56
s_add_u32 m0, s59, 41600
s_mov_b32 s58, 1703936
v_add_f32 v165, v165, v167
MAA 120,76,56
buffer_load_dwordx4 v5, s[24:27], s58 offen lds
MAA 116,76,52
TR 24,25,49696
MAA 100,72,52
TR 26,25,50208
v_mul_f32 v164, 0xba800000, v164
MAA 96,72,48
RD 16,24,55488
MAA 112,76,48
buffer_load_dwordx4 v6, s[24:27], s58 offen offset:1024 lds
MAA 108,76,44
TR 28,25,50688
v_mul_f32 v165, 0x3a800000, v165
MAA 92,72,44
TR 30,25,51200
MAA 124,44,80
s_add_u32 m0, s59, 91520
s_mov_b32 s58, 393216
v_fma_f32 v165, -v164, v164, v165
MAA 140,44,84
buffer_load_dwordx4 v5, s[24:27], s58 offen lds
MAA 144,48,84
TR 32,25,50720
MAA 128,48,80
TR 34,25,51232
v_max_f32 v165, 0, v165
MAA 132,52,80
TR 36,25,51712
MAA 148,52,84
buffer_load_dwordx4 v6, s[24:27], s58 offen offset:1024 lds
MAA 152,56,84
TR 38,25,52224
v_add_f32 v165, 0x3727c5ac, v165
MAA 136,56,80
TR 40,25,51744
MAA 156,60,80
TR 42,25,52256
MAA 160,60,84
s_waitcnt vmcnt(18) lgkmcnt(8)
s_barrier
MAA 60,20,0
RD 44,30,55488
v_rsq_f32 v166, v165
MAA 76,24,0
s_add_u32 m0, s59, 99840
s_mov_b32 s58, 524288
MAA 80,24,4
buffer_load_dwordx4 v5, s[24:27], s58 offen lds
MAA 64,20,4
RD 48,30,57792
MAA 68,20,8
RD 52,30,60096
MAA 84,24,8
RD 56,30,62400
v_mov_b32 v165, v166
MAA 88,24,12
TR 64,25,62080
MAA 72,20,12
TR 66,25,62592
s_waitcnt lgkmcnt(6)
MAA 244,24,16
buffer_load_dwordx4 v6, s[24:27], s58 offen offset:1024 lds
MAA 104,28,12
MAA 120,32,12
TR 68,25,62112
v_mul_f32 v166, 0x3e8293ee, v166
MAA 116,32,8
TR 70,25,62624
MAA 100,28,8
RD 60,31,55488
MAA 96,28,4
s_add_u32 m0, s59, 108160
s_mov_b32 s58, 655360
MAA 112,32,4
buffer_load_dwordx4 v5, s[24:27], s58 offen lds
MAA 108,32,0
TR 72,25,63104
ds_write_b128 v7, v[164:167]
MAA 92,28,0
TR 74,25,63616
MAA 124,0,36
TR 76,25,63136
MAA 140,0,40
ds_write_b32 v17, v164
MAA 144,4,40
TR 78,25,63648
MAA 128,4,36
buffer_load_dwordx4 v6, s[24:27], s58 offen offset:1024 lds
MAA 132,8,36
TR 80,25,64128
MAA 148,8,40
TR 82,25,64640
MAA 152,12,40
TR 84,25,64160
ds_write_b32 v17, v165 offset:1024
MAA 136,12,36
TR 86,25,64672
MAA 156,16,36
MAA 160,16,40
s_waitcnt lgkmcnt(0)
s_barrier
MAA 244,68,60
ds_read_b128 v[232:235], v10 offset:1792
MAA 156,60,80
ds_read_b128 v[228:231], v10 offset:1536
MAA 160,60,84
ds_read_b128 v[224:227], v10 offset:1280
MAA 104,72,56
ds_read_b128 v[220:223], v10 offset:1024
MAA 120,76,56
MAA 136,56,80
MAA 152,56,84
MAA 100,72,52
MAA 116,76,52
s_mov_b32 exec_lo, 0x10001
s_mov_b32 exec_hi, 0x10001
ds_write_b128 v13, v[244:247] offset:64
s_mov_b64 exec, 0xffff
ds_write_b32 v12, v156 offset:512
ds_write_b32 v12, v160 offset:576
s_mov_b64 exec, -1
MAA 96,72,48
MAA 112,76,48
MAA 92,72,44
MAA 108,76,44
MAA 72,64,56
MAA 88,68,56
s_waitcnt lgkmcnt(0)
s_barrier
MAA 132,52,80
ds_read_b128 v[28:31], v13
s_add_u32 m0, s59, 49920
MAA 148,52,84
ds_read_b128 v[32:35], v13 offset:64
s_mov_b32 s58, 1835008
MAA 68,64,52
ds_read_b128 v[36:39], v13 offset:256
MAA 84,68,52
ds_read_b128 v[40:43], v13 offset:320
MAA 128,48,80
ds_read_b32 v44, v12 offset:512
MAA 144,48,84
ds_read_b32 v45, v12 offset:576
MAA 64,64,48
ds_read_b128 v[240:243], v11 offset:704
MAA 80,68,48
ds_read_b128 v[244:247], v11 offset:1728
MAA 124,44,80
buffer_load_dwordx4 v5, s[24:27], s58 offen lds
ds_read_b128 v[18:21], v11 offset:448
s_waitcnt lgkmcnt(8)
v_pk_fma_f32 v[72:73], v[28:29], v[232:233], v[72:73] op_sel_hi:[1,0,1]
v_pk_fma_f32 v[74:75], v[30:31], v[232:233], v[74:75] op_sel_hi:[1,0,1]
s_waitcnt lgkmcnt(6)
v_pk_fma_f32 v[104:105], v[36:37], v[232:233], v[104:105] op_sel_hi:[1,0,1]
v_pk_mul_f32 v[104:105], v[104:105], v[232:233] op_sel:[0,1] op_sel_hi:[1,1]
v_pk_fma_f32 v[106:107], v[38:39], v[232:233], v[106:107] op_sel_hi:[1,0,1]
v_pk_mul_f32 v[106:107], v[106:107], v[232:233] op_sel:[0,1] op_sel_hi:[1,1]
s_waitcnt lgkmcnt(5)
v_pk_fma_f32 v[120:121], v[40:41], v[232:233], v[120:121] op_sel_hi:[1,0,1]
v_pk_mul_f32 v[120:121], v[120:121], v[232:233] op_sel:[0,1] op_sel_hi:[1,1]
v_pk_fma_f32 v[122:123], v[42:43], v[232:233], v[122:123] op_sel_hi:[1,0,1]
v_pk_mul_f32 v[122:123], v[122:123], v[232:233] op_sel:[0,1] op_sel_hi:[1,1]
v_pk_fma_f32 v[100:101], v[36:37], v[228:229], v[100:101] op_sel_hi:[1,0,1]
v_pk_mul_f32 v[100:101], v[100:101], v[228:229] op_sel:[0,1] op_sel_hi:[1,1]
v_pk_fma_f32 v[102:103], v[38:39], v[228:229], v[102:103] op_sel_hi:[1,0,1]
v_pk_mul_f32 v[102:103], v[102:103], v[228:229] op_sel:[0,1] op_sel_hi:[1,1]
v_pk_fma_f32 v[116:117], v[40:41], v[228:229], v[116:117] op_sel_hi:[1,0,1]
v_pk_mul_f32 v[116:117], v[116:117], v[228:229] op_sel:[0,1] op_sel_hi:[1,1]
v_pk_fma_f32 v[118:119], v[42:43], v[228:229], v[118:119] op_sel_hi:[1,0,1]
v_pk_mul_f32 v[118:119], v[118:119], v[228:229] op_sel:[0,1] op_sel_hi:[1,1]
s_waitcnt lgkmcnt(2)
v_pk_fma_f32 v[156:157], v[240:241], v[44:45], v[156:157] op_sel_hi:[1,0,1]
v_pk_fma_f32 v[158:159], v[242:243], v[44:45], v[158:159] op_sel_hi:[1,0,1]
v_pk_fma_f32 v[160:161], v[240:241], v[44:45], v[160:161] op_sel:[0,1,0] op_sel_hi:[1,1,1]
v_pk_fma_f32 v[162:163], v[242:243], v[44:45], v[162:163] op_sel:[0,1,0] op_sel_hi:[1,1,1]
s_waitcnt lgkmcnt(1)
v_pk_mul_f32 v[156:157], v[156:157], v[244:245]
v_pk_mul_f32 v[158:159], v[158:159], v[246:247]
v_pk_mul_f32 v[160:161], v[160:161], v[244:245]
v_pk_mul_f32 v[162:163], v[162:163], v[246:247]
v_pk_fma_f32 v[88:89], v[32:33], v[232:233], v[88:89] op_sel_hi:[1,0,1]
v_pk_fma_f32 v[90:91], v[34:35], v[232:233], v[90:91] op_sel_hi:[1,0,1]
v_pk_fma_f32 v[96:97], v[36:37], v[224:225], v[96:97] op_sel_hi:[1,0,1]
s_waitcnt lgkmcnt(0)
v_pk_fma_f32 v[136:137], v[18:19], v[44:45], v[136:137] op_sel_hi:[1,0,1]
v_pk_fma_f32 v[138:139], v[20:21], v[44:45], v[138:139] op_sel_hi:[1,0,1]
v_pk_fma_f32 v[152:153], v[18:19], v[44:45], v[152:153] op_sel:[0,1,0] op_sel_hi:[1,1,1]
v_pk_fma_f32 v[154:155], v[20:21], v[44:45], v[154:155] op_sel:[0,1,0] op_sel_hi:[1,1,1]
v_pk_mul_f32 v[96:97], v[96:97], v[224:225] op_sel:[0,1] op_sel_hi:[1,1]
v_pk_fma_f32 v[98:99], v[38:39], v[224:225], v[98:99] op_sel_hi:[1,0,1]
v_pk_mul_f32 v[98:99], v[98:99], v[224:225] op_sel:[0,1] op_sel_hi:[1,1]
v_pk_fma_f32 v[112:113], v[40:41], v[224:225], v[112:113] op_sel_hi:[1,0,1]
v_pk_mul_f32 v[112:113], v[112:113], v[224:225] op_sel:[0,1] op_sel_hi:[1,1]
v_pk_fma_f32 v[114:115], v[42:43], v[224:225], v[114:115] op_sel_hi:[1,0,1]
v_pk_mul_f32 v[114:115], v[114:115], v[224:225] op_sel:[0,1] op_sel_hi:[1,1]
v_pk_fma_f32 v[68:69], v[28:29], v[228:229], v[68:69] op_sel_hi:[1,0,1]
v_pk_fma_f32 v[70:71], v[30:31], v[228:229], v[70:71] op_sel_hi:[1,0,1]
v_pk_fma_f32 v[84:85], v[32:33], v[228:229], v[84:85] op_sel_hi:[1,0,1]
v_pk_fma_f32 v[86:87], v[34:35], v[228:229], v[86:87] op_sel_hi:[1,0,1]
v_pk_fma_f32 v[92:93], v[36:37], v[220:221], v[92:93] op_sel_hi:[1,0,1]
v_pk_mul_f32 v[92:93], v[92:93], v[220:221] op_sel:[0,1] op_sel_hi:[1,1]
v_pk_fma_f32 v[94:95], v[38:39], v[220:221], v[94:95] op_sel_hi:[1,0,1]
v_pk_mul_f32 v[94:95], v[94:95], v[220:221] op_sel:[0,1] op_sel_hi:[1,1]
v_pk_fma_f32 v[108:109], v[40:41], v[220:221], v[108:109] op_sel_hi:[1,0,1]
v_pk_mul_f32 v[108:109], v[108:109], v[220:221] op_sel:[0,1] op_sel_hi:[1,1]
v_pk_fma_f32 v[110:111], v[42:43], v[220:221], v[110:111] op_sel_hi:[1,0,1]
v_pk_mul_f32 v[110:111], v[110:111], v[220:221] op_sel:[0,1] op_sel_hi:[1,1]
v_pk_fma_f32 v[64:65], v[28:29], v[224:225], v[64:65] op_sel_hi:[1,0,1]
v_pk_fma_f32 v[66:67], v[30:31], v[224:225], v[66:67] op_sel_hi:[1,0,1]
v_pk_fma_f32 v[80:81], v[32:33], v[224:225], v[80:81] op_sel_hi:[1,0,1]
v_pk_fma_f32 v[82:83], v[34:35], v[224:225], v[82:83] op_sel_hi:[1,0,1]
v_cvt_pk_bf16_f32 v236, v156, v157
v_cvt_pk_bf16_f32 v237, v158, v159
MAA 140,44,84
buffer_load_dwordx4 v6, s[24:27], s58 offen offset:1024 lds
MAA 60,64,44
s_add_u32 m0, s59, 58240
v_cvt_pk_bf16_f32 v238, v160, v161
v_cvt_pk_bf16_f32 v239, v162, v163
MAA 76,68,44
ds_write_b128 v8, v[236:239] offset:1024
s_mov_b32 s58, 1966080
v_cvt_pk_bf16_f32 v196, v104, v105
v_cvt_pk_bf16_f32 v197, v106, v107
v_cvt_pk_bf16_f32 v198, v120, v121
v_cvt_pk_bf16_f32 v199, v122, v123
ds_read_b128 v[22:25], v11 offset:1472
buffer_load_dwordx4 v5, s[24:27], s58 offen lds
v_cvt_pk_bf16_f32 v192, v100, v101
v_cvt_pk_bf16_f32 v193, v102, v103
v_cvt_pk_bf16_f32 v194, v116, v117
v_cvt_pk_bf16_f32 v195, v118, v119
v_cvt_pk_bf16_f32 v176, v72, v73
v_cvt_pk_bf16_f32 v177, v74, v75
v_cvt_pk_bf16_f32 v178, v88, v89
v_cvt_pk_bf16_f32 v179, v90, v91
v_pk_fma_f32 v[60:61], v[28:29], v[220:221], v[60:61] op_sel_hi:[1,0,1]
v_pk_fma_f32 v[62:63], v[30:31], v[220:221], v[62:63] op_sel_hi:[1,0,1]
v_pk_fma_f32 v[76:77], v[32:33], v[220:221], v[76:77] op_sel_hi:[1,0,1]
v_pk_fma_f32 v[78:79], v[34:35], v[220:221], v[78:79] op_sel_hi:[1,0,1]
ds_read_b128 v[240:243], v11 offset:384
s_nop 0
v_mfma_f32_16x16x32_bf16 v[104:107], v[192:195], v[176:179], v[46:49]
buffer_load_dwordx4 v6, s[24:27], s58 offen offset:1024 lds
v_mfma_f32_16x16x32_bf16 v[120:123], v[196:199], v[176:179], v[50:53]
s_add_u32 m0, s59, 66560
s_waitcnt lgkmcnt(2)
s_barrier
ds_read_b128 v[180:183], v9
ds_read_b64 v[200:201], v9 offset:1024
ds_read_b64 v[210:211], v9 offset:1032
s_mov_b32 s58, 0
s_waitcnt lgkmcnt(4)
v_pk_mul_f32 v[136:137], v[136:137], v[22:23]
v_cvt_pk_bf16_f32 v208, v136, v137
v_pk_mul_f32 v[138:139], v[138:139], v[24:25]
buffer_load_dwordx4 v5, s[24:27], s58 offen lds
v_cvt_pk_bf16_f32 v209, v138, v139
v_pk_mul_f32 v[152:153], v[152:153], v[22:23]
v_cvt_pk_bf16_f32 v218, v152, v153
v_pk_mul_f32 v[154:155], v[154:155], v[24:25]
v_cvt_pk_bf16_f32 v219, v154, v155
ds_read_b128 v[244:247], v11 offset:1408
v_max3_f32 v88, v104, v105, v106
v_max3_f32 v89, v107, v120, v121
v_max3_f32 v88, v88, v122, v123
s_waitcnt lgkmcnt(4)
v_pk_fma_f32 v[132:133], v[240:241], v[44:45], v[132:133] op_sel_hi:[1,0,1]
v_pk_fma_f32 v[134:135], v[242:243], v[44:45], v[134:135] op_sel_hi:[1,0,1]
v_pk_fma_f32 v[148:149], v[240:241], v[44:45], v[148:149] op_sel:[0,1,0] op_sel_hi:[1,1,1]
buffer_load_dwordx4 v6, s[24:27], s58 offen offset:1024 lds
s_add_u32 m0, s59, 116480
s_mov_b32 s58, 786432
v_pk_fma_f32 v[150:151], v[242:243], v[44:45], v[150:151] op_sel:[0,1,0] op_sel_hi:[1,1,1]
v_max_f32 v90, v88, v89
v_max_f32 v89, v88, v89
v_cvt_pk_bf16_f32 v188, v96, v97
v_cvt_pk_bf16_f32 v189, v98, v99
v_permlane16_swap_b32 v90, v89
v_cvt_pk_bf16_f32 v190, v112, v113
v_max_f32 v88, v90, v89
v_max_f32 v89, v90, v89
v_cvt_pk_bf16_f32 v191, v114, v115
buffer_load_dwordx4 v5, s[24:27], s58 offen lds
v_permlane32_swap_b32 v88, v89
v_cvt_pk_bf16_f32 v172, v68, v69
v_max_f32 v88, v88, v89
v_mul_f32 v88, v88, v234
s_waitcnt lgkmcnt(0)
v_pk_mul_f32 v[132:133], v[132:133], v[244:245]
v_cvt_pk_bf16_f32 v206, v132, v133
v_pk_mul_f32 v[134:135], v[134:135], v[246:247]
v_cvt_pk_bf16_f32 v207, v134, v135
v_pk_mul_f32 v[148:149], v[148:149], v[244:245]
v_cvt_pk_bf16_f32 v216, v148, v149
v_pk_mul_f32 v[150:151], v[150:151], v[246:247]
v_cvt_pk_bf16_f32 v217, v150, v151
buffer_load_dwordx4 v6, s[24:27], s58 offen offset:1024 lds
s_add_u32 m0, s59, 124800
s_mov_b32 s58, 917504
v_pk_fma_f32 v[104:105], v[104:105], v[234:235], v[88:89] op_sel_hi:[1,0,0] neg_lo:[0,0,1] neg_hi:[0,0,1]
v_pk_fma_f32 v[106:107], v[106:107], v[234:235], v[88:89] op_sel_hi:[1,0,0] neg_lo:[0,0,1] neg_hi:[0,0,1]
v_pk_fma_f32 v[120:121], v[120:121], v[234:235], v[88:89] op_sel_hi:[1,0,0] neg_lo:[0,0,1] neg_hi:[0,0,1]
v_pk_fma_f32 v[122:123], v[122:123], v[234:235], v[88:89] op_sel_hi:[1,0,0] neg_lo:[0,0,1] neg_hi:[0,0,1]
v_exp_f32 v104, v104
v_exp_f32 v105, v105
v_exp_f32 v106, v106
v_exp_f32 v107, v107
v_exp_f32 v120, v120
v_exp_f32 v121, v121
v_exp_f32 v122, v122
v_exp_f32 v123, v123
v_cvt_pk_bf16_f32 v72, v104, v105
buffer_load_dwordx4 v5, s[24:27], s58 offen lds
v_cvt_pk_bf16_f32 v73, v106, v107
v_cvt_pk_bf16_f32 v74, v120, v121
v_cvt_pk_bf16_f32 v75, v122, v123
v_cvt_pk_bf16_f32 v173, v70, v71
v_cvt_pk_bf16_f32 v174, v84, v85
v_mfma_f32_16x16x32_bf16 v[88:91], v[248:251], v[72:75], 0
ds_read_b128 v[18:21], v11 offset:320
v_cvt_pk_bf16_f32 v175, v86, v87
v_mfma_f32_16x16x32_bf16 v[104:107], v[206:209], v[72:75], 0
ds_read_b128 v[22:25], v11 offset:1344
v_cvt_pk_bf16_f32 v184, v92, v93
v_mfma_f32_16x16x32_bf16 v[120:123], v[216:219], v[72:75], 0
buffer_load_dwordx4 v6, s[24:27], s58 offen offset:1024 lds
v_mfma_f32_16x16x32_bf16 v[100:103], v[188:191], v[172:175], v[46:49]
ds_read_b128 v[240:243], v11 offset:256
v_rcp_f32 v88, v88
v_mfma_f32_16x16x32_bf16 v[116:119], v[192:195], v[172:175], v[50:53]
ds_read_b128 v[244:247], v11 offset:1280
v_cvt_pk_bf16_f32 v185, v94, v95
s_nop 2
v_max3_f32 v84, v100, v101, v102
v_cvt_pk_bf16_f32 v186, v108, v109
v_cvt_pk_bf16_f32 v187, v110, v111
v_pk_mul_f32 v[104:105], v[104:105], v[88:89] op_sel_hi:[1,0]
v_pk_mul_f32 v[106:107], v[106:107], v[88:89] op_sel_hi:[1,0]
v_pk_mul_f32 v[120:121], v[120:121], v[88:89] op_sel_hi:[1,0]
v_pk_mul_f32 v[122:123], v[122:123], v[88:89] op_sel_hi:[1,0]
v_cvt_pk_bf16_f32 v176, v104, v105
v_cvt_pk_bf16_f32 v177, v106, v107
v_cvt_pk_bf16_f32 v178, v120, v121
v_cvt_pk_bf16_f32 v179, v122, v123
buffer_store_dwordx4 v[176:179], v4, s[16:19], s74 offen offset:3072 sc1
s_waitcnt lgkmcnt(3)
v_pk_fma_f32 v[128:129], v[18:19], v[44:45], v[128:129] op_sel_hi:[1,0,1]
v_pk_fma_f32 v[130:131], v[20:21], v[44:45], v[130:131] op_sel_hi:[1,0,1]
s_waitcnt lgkmcnt(2)
v_pk_mul_f32 v[128:129], v[128:129], v[22:23]
v_cvt_pk_bf16_f32 v204, v128, v129
v_pk_mul_f32 v[130:131], v[130:131], v[24:25]
v_cvt_pk_bf16_f32 v205, v130, v131
v_pk_fma_f32 v[144:145], v[18:19], v[44:45], v[144:145] op_sel:[0,1,0] op_sel_hi:[1,1,1]
v_pk_mul_f32 v[144:145], v[144:145], v[22:23]
v_cvt_pk_bf16_f32 v214, v144, v145
v_pk_fma_f32 v[146:147], v[20:21], v[44:45], v[146:147] op_sel:[0,1,0] op_sel_hi:[1,1,1]
v_pk_mul_f32 v[146:147], v[146:147], v[24:25]
v_cvt_pk_bf16_f32 v215, v146, v147
v_max3_f32 v85, v103, v116, v117
v_max3_f32 v84, v84, v118, v119
v_max_f32 v86, v84, v85
v_max_f32 v85, v84, v85
v_cvt_pk_bf16_f32 v168, v64, v65
v_cvt_pk_bf16_f32 v169, v66, v67
v_permlane16_swap_b32 v86, v85
v_cvt_pk_bf16_f32 v170, v80, v81
v_max_f32 v84, v86, v85
v_max_f32 v85, v86, v85
v_cvt_pk_bf16_f32 v171, v82, v83
s_waitcnt lgkmcnt(1)
v_pk_fma_f32 v[124:125], v[240:241], v[44:45], v[124:125] op_sel_hi:[1,0,1]
s_waitcnt lgkmcnt(0)
v_pk_mul_f32 v[124:125], v[124:125], v[244:245]
v_pk_fma_f32 v[126:127], v[242:243], v[44:45], v[126:127] op_sel_hi:[1,0,1]
v_pk_mul_f32 v[126:127], v[126:127], v[246:247]
v_pk_fma_f32 v[140:141], v[240:241], v[44:45], v[140:141] op_sel:[0,1,0] op_sel_hi:[1,1,1]
v_pk_mul_f32 v[140:141], v[140:141], v[244:245]
v_pk_fma_f32 v[142:143], v[242:243], v[44:45], v[142:143] op_sel:[0,1,0] op_sel_hi:[1,1,1]
v_pk_mul_f32 v[142:143], v[142:143], v[246:247]
v_permlane32_swap_b32 v84, v85
s_nop 0
v_mfma_f32_16x16x32_bf16 v[96:99], v[184:187], v[168:171], v[46:49]
v_max_f32 v84, v84, v85
v_mul_f32 v84, v84, v230
v_mfma_f32_16x16x32_bf16 v[112:115], v[188:191], v[168:171], v[50:53]
v_cvt_pk_bf16_f32 v202, v124, v125
v_cvt_pk_bf16_f32 v203, v126, v127
v_cvt_pk_bf16_f32 v212, v140, v141
v_cvt_pk_bf16_f32 v213, v142, v143
s_nop 0
v_max3_f32 v80, v96, v97, v98
v_pk_fma_f32 v[100:101], v[100:101], v[230:231], v[84:85] op_sel_hi:[1,0,0] neg_lo:[0,0,1] neg_hi:[0,0,1]
v_pk_fma_f32 v[102:103], v[102:103], v[230:231], v[84:85] op_sel_hi:[1,0,0] neg_lo:[0,0,1] neg_hi:[0,0,1]
v_pk_fma_f32 v[116:117], v[116:117], v[230:231], v[84:85] op_sel_hi:[1,0,0] neg_lo:[0,0,1] neg_hi:[0,0,1]
v_pk_fma_f32 v[118:119], v[118:119], v[230:231], v[84:85] op_sel_hi:[1,0,0] neg_lo:[0,0,1] neg_hi:[0,0,1]
v_exp_f32 v100, v100
v_exp_f32 v101, v101
v_exp_f32 v102, v102
v_exp_f32 v103, v103
v_exp_f32 v116, v116
v_exp_f32 v117, v117
v_exp_f32 v118, v118
v_exp_f32 v119, v119
v_cvt_pk_bf16_f32 v68, v100, v101
v_cvt_pk_bf16_f32 v69, v102, v103
v_cvt_pk_bf16_f32 v70, v116, v117
v_cvt_pk_bf16_f32 v71, v118, v119
v_max3_f32 v81, v99, v112, v113
v_max3_f32 v80, v80, v114, v115
v_mfma_f32_16x16x32_bf16 v[84:87], v[248:251], v[68:71], 0
v_max_f32 v82, v80, v81
v_max_f32 v81, v80, v81
v_mfma_f32_16x16x32_bf16 v[100:103], v[204:207], v[68:71], 0
s_nop 0
v_permlane16_swap_b32 v82, v81
v_mfma_f32_16x16x32_bf16 v[116:119], v[214:217], v[68:71], 0
s_nop 1
v_rcp_f32 v84, v84
v_max_f32 v80, v82, v81
v_max_f32 v81, v82, v81
v_cvt_pk_bf16_f32 v164, v60, v61
v_pk_mul_f32 v[100:101], v[100:101], v[84:85] op_sel_hi:[1,0]
v_pk_mul_f32 v[102:103], v[102:103], v[84:85] op_sel_hi:[1,0]
v_pk_mul_f32 v[116:117], v[116:117], v[84:85] op_sel_hi:[1,0]
v_pk_mul_f32 v[118:119], v[118:119], v[84:85] op_sel_hi:[1,0]
v_cvt_pk_bf16_f32 v172, v100, v101
v_cvt_pk_bf16_f32 v173, v102, v103
v_cvt_pk_bf16_f32 v174, v116, v117
v_cvt_pk_bf16_f32 v175, v118, v119
buffer_store_dwordx4 v[172:175], v4, s[16:19], s74 offen offset:2048 sc1
v_permlane32_swap_b32 v80, v81
v_cvt_pk_bf16_f32 v165, v62, v63
v_max_f32 v80, v80, v81
v_mul_f32 v80, v80, v226
v_pk_fma_f32 v[96:97], v[96:97], v[226:227], v[80:81] op_sel_hi:[1,0,0] neg_lo:[0,0,1] neg_hi:[0,0,1]
v_pk_fma_f32 v[98:99], v[98:99], v[226:227], v[80:81] op_sel_hi:[1,0,0] neg_lo:[0,0,1] neg_hi:[0,0,1]
v_pk_fma_f32 v[112:113], v[112:113], v[226:227], v[80:81] op_sel_hi:[1,0,0] neg_lo:[0,0,1] neg_hi:[0,0,1]
v_pk_fma_f32 v[114:115], v[114:115], v[226:227], v[80:81] op_sel_hi:[1,0,0] neg_lo:[0,0,1] neg_hi:[0,0,1]
v_exp_f32 v96, v96
v_exp_f32 v97, v97
v_exp_f32 v98, v98
v_exp_f32 v99, v99
v_exp_f32 v112, v112
v_exp_f32 v113, v113
v_exp_f32 v114, v114
v_exp_f32 v115, v115
v_cvt_pk_bf16_f32 v64, v96, v97
v_cvt_pk_bf16_f32 v65, v98, v99
v_cvt_pk_bf16_f32 v66, v112, v113
v_cvt_pk_bf16_f32 v67, v114, v115
v_cvt_pk_bf16_f32 v166, v76, v77
v_cvt_pk_bf16_f32 v167, v78, v79
v_mfma_f32_16x16x32_bf16 v[80:83], v[248:251], v[64:67], 0
v_mfma_f32_16x16x32_bf16 v[96:99], v[202:205], v[64:67], 0
v_mfma_f32_16x16x32_bf16 v[112:115], v[212:215], v[64:67], 0
s_nop 5
v_rcp_f32 v80, v80
v_mfma_f32_16x16x32_bf16 v[92:95], v[180:183], v[164:167], v[46:49]
v_mfma_f32_16x16x32_bf16 v[108:111], v[184:187], v[164:167], v[50:53]
s_nop 6
v_max3_f32 v76, v92, v93, v94
v_pk_mul_f32 v[96:97], v[96:97], v[80:81] op_sel_hi:[1,0]
v_pk_mul_f32 v[98:99], v[98:99], v[80:81] op_sel_hi:[1,0]
v_pk_mul_f32 v[112:113], v[112:113], v[80:81] op_sel_hi:[1,0]
v_pk_mul_f32 v[114:115], v[114:115], v[80:81] op_sel_hi:[1,0]
v_cvt_pk_bf16_f32 v168, v96, v97
v_cvt_pk_bf16_f32 v169, v98, v99
v_cvt_pk_bf16_f32 v170, v112, v113
v_cvt_pk_bf16_f32 v171, v114, v115
buffer_store_dwordx4 v[168:171], v4, s[16:19], s74 offen offset:1024 sc1
v_max3_f32 v77, v95, v108, v109
v_max3_f32 v76, v76, v110, v111
v_max_f32 v78, v76, v77
v_max_f32 v77, v76, v77
s_nop 1
v_permlane16_swap_b32 v78, v77
v_max_f32 v76, v78, v77
v_max_f32 v77, v78, v77
s_nop 1
v_permlane32_swap_b32 v76, v77
v_max_f32 v76, v76, v77
v_mul_f32 v76, v76, v222
v_pk_fma_f32 v[92:93], v[92:93], v[222:223], v[76:77] op_sel_hi:[1,0,0] neg_lo:[0,0,1] neg_hi:[0,0,1]
v_pk_fma_f32 v[94:95], v[94:95], v[222:223], v[76:77] op_sel_hi:[1,0,0] neg_lo:[0,0,1] neg_hi:[0,0,1]
v_pk_fma_f32 v[108:109], v[108:109], v[222:223], v[76:77] op_sel_hi:[1,0,0] neg_lo:[0,0,1] neg_hi:[0,0,1]
v_pk_fma_f32 v[110:111], v[110:111], v[222:223], v[76:77] op_sel_hi:[1,0,0] neg_lo:[0,0,1] neg_hi:[0,0,1]
v_exp_f32 v92, v92
v_exp_f32 v93, v93
v_exp_f32 v94, v94
v_exp_f32 v95, v95
v_exp_f32 v108, v108
v_exp_f32 v109, v109
v_exp_f32 v110, v110
v_exp_f32 v111, v111
v_cvt_pk_bf16_f32 v60, v92, v93
v_cvt_pk_bf16_f32 v61, v94, v95
v_cvt_pk_bf16_f32 v62, v108, v109
v_cvt_pk_bf16_f32 v63, v110, v111
s_nop 1
v_mfma_f32_16x16x32_bf16 v[76:79], v[248:251], v[60:63], 0
v_mfma_f32_16x16x32_bf16 v[92:95], v[200:203], v[60:63], 0
v_mfma_f32_16x16x32_bf16 v[108:111], v[210:213], v[60:63], 0
s_nop 5
v_rcp_f32 v76, v76
s_nop 0
v_pk_mul_f32 v[92:93], v[92:93], v[76:77] op_sel_hi:[1,0]
v_pk_mul_f32 v[94:95], v[94:95], v[76:77] op_sel_hi:[1,0]
v_pk_mul_f32 v[108:109], v[108:109], v[76:77] op_sel_hi:[1,0]
v_pk_mul_f32 v[110:111], v[110:111], v[76:77] op_sel_hi:[1,0]
v_cvt_pk_bf16_f32 v164, v92, v93
v_cvt_pk_bf16_f32 v165, v94, v95
v_cvt_pk_bf16_f32 v166, v108, v109
v_cvt_pk_bf16_f32 v167, v110, v111
buffer_store_dwordx4 v[164:167], v4, s[16:19], s74 offen sc1
s_nop 1
.Lqkve3:
s_lshl_b32 s62, s6, 13
s_lshl_b32 s63, s3, 11
s_add_u32 s62, s62, s63
v_lshl_add_u32 v4, v1, 4, s62
v_lshrrev_b32 v2, 3, v1
v_cmp_eq_u32 vcc, 3, v2
v_add_u32 v2, 67108480, v4
s_nop 0
v_cndmask_b32 v4, v4, v2, vcc
v_bfe_u32 v5, v1, 3, 1
v_lshrrev_b32 v2, 4, v1
v_lshl_add_u32 v5, v2, 3, v5
s_lshl_b32 s62, s3, 1
v_add_u32 v5, s62, v5
v_mul_u32_u24 v5, 2048, v5
v_and_b32 v2, 7, v1
v_lshl_add_u32 v5, v2, 4, v5
s_lshl_b32 s62, s7, 7
v_add_u32 v5, s62, v5
v_add_u32 v6, 64512, v5
v_bfe_u32 v8, v1, 3, 2
v_mul_u32_u24 v8, 2080, v8
v_bfe_u32 v2, v1, 2, 1
v_lshl_add_u32 v8, v2, 7, v8
v_bfe_u32 v2, v1, 5, 1
v_lshl_add_u32 v8, v2, 8, v8
v_and_b32 v2, 3, v1
v_lshl_add_u32 v8, v2, 3, v8
s_mov_b32 s57, 66560
v_add_u32 v7, s57, v8
s_mov_b32 s52, 4194304
s_mov_b32 s53, 4325376
s_mov_b32 s54, 2097152
s_mul_i32 s56, s3, 2080
v_accvgpr_read_b32 v32, a224
v_accvgpr_read_b32 v33, a225
v_accvgpr_read_b32 v34, a226
v_accvgpr_read_b32 v35, a227
v_accvgpr_read_b32 v36, a228
v_accvgpr_read_b32 v37, a229
v_accvgpr_read_b32 v38, a230
v_accvgpr_read_b32 v39, a231
v_accvgpr_read_b32 v40, a232
v_accvgpr_read_b32 v41, a233
v_accvgpr_read_b32 v42, a234
v_accvgpr_read_b32 v43, a235
v_accvgpr_read_b32 v44, a236
v_accvgpr_read_b32 v45, a237
v_accvgpr_read_b32 v46, a238
v_accvgpr_read_b32 v47, a239
v_accvgpr_read_b32 v48, a240
v_accvgpr_read_b32 v49, a241
v_accvgpr_read_b32 v50, a242
v_accvgpr_read_b32 v51, a243
v_accvgpr_read_b32 v52, a244
v_accvgpr_read_b32 v53, a245
v_accvgpr_read_b32 v54, a246
v_accvgpr_read_b32 v55, a247
v_accvgpr_read_b32 v56, a248
v_accvgpr_read_b32 v57, a249
v_accvgpr_read_b32 v58, a250
v_accvgpr_read_b32 v59, a251
v_accvgpr_read_b32 v60, a252
v_accvgpr_read_b32 v61, a253
v_accvgpr_read_b32 v62, a254
v_accvgpr_read_b32 v63, a255
s_and_b32 s62, s3, 1
s_mul_i32 s62, s62, 28672
s_add_u32 s62, s62, s51
v_lshrrev_b32 v12, 4, v1
v_mul_u32_u24 v12, 57344, v12
v_and_b32 v2, 15, v1
v_lshl_add_u32 v12, v2, 4, v12
v_add_u32 v12, s62, v12
v_add_u32 v13, 6112, v12
v_add_u32 v14, 12224, v12
v_add_u32 v15, 18336, v12
s_mul_i32 s59, s3, 4224
s_mov_b32 s58, 0
s_mov_b32 s36, s82
s_mov_b32 s37, s83
s_lshl_b32 s62, s8, 10
s_add_u32 s62, s62, 30425088
s_lshl_b32 s64, s6, 10
s_add_u32 s64, s64, 30425088
s_lshr_b32 s67, s5, 2
s_and_b32 s67, s67, 3
s_lshl_b32 s67, s67, 7
s_add_u32 s64, s64, s67
v_lshl_add_u32 v252, v1, 7, s62
v_mov_b32 v253, s64
s_waitcnt vmcnt(0) lgkmcnt(0)
s_barrier
s_cmp_lg_u32 s3, 0
s_cbranch_scc1 .Lnosig32
v_mov_b32 v255, 1
s_mov_b64 exec, 15
buffer_atomic_add v255, v252, s[16:19], 0 offen
s_mov_b64 exec, -1
.Lnosig32:
s_cmp_lg_u32 s3, 1
s_cbranch_scc1 .Lnopoll35
s_mov_b64 exec, 1
s_mov_b32 s15, 0
s_mov_b64 exec, 1
v_mov_b32 v254, 0
buffer_atomic_add v254, v253, s[16:19], 0 offen sc0
.Lpoll33:
s_waitcnt vmcnt(0)
v_cmp_ne_u32 vcc, 16, v254
s_add_u32 s15, s15, 1
s_cbranch_vccz .Lnopoll35r
s_mov_b64 exec, 1
v_mov_b32 v254, 0
buffer_atomic_add v254, v253, s[16:19], 0 offen sc0
s_cmp_le_u32 s15, 100000
s_cbranch_scc1 .Lpoll33
.Lgot34:
s_waitcnt vmcnt(0)
s_branch .Lnopoll35r
.Lnopoll35:
s_mov_b64 exec, 0
s_cmp_eq_u32 s3, 2
s_cbranch_scc1 .Lpad1
s_cmp_eq_u32 s3, 3
s_cbranch_scc1 .Lpad2
s_branch .Lpad3
.Lnopoll35r:
s_mov_b64 exec, -1
s_barrier
buffer_load_dwordx4 v[64:67], v4, s[16:19], s52 offen sc1
buffer_load_dwordx4 v[68:71], v4, s[16:19], s52 offen offset:1024 sc1
s_add_u32 s52, s52, 0x40000
buffer_load_dwordx4 v[72:75], v4, s[16:19], s53 offen sc1
buffer_load_dwordx4 v[76:79], v4, s[16:19], s53 offen offset:1024 sc1
s_add_u32 s53, s53, 0x40000
buffer_load_dwordx4 v[80:83], v4, s[16:19], s52 offen sc1
buffer_load_dwordx4 v[84:87], v4, s[16:19], s52 offen offset:1024 sc1
s_add_u32 s52, s52, 0x40000
buffer_load_dwordx4 v[88:91], v4, s[16:19], s53 offen sc1
buffer_load_dwordx4 v[92:95], v4, s[16:19], s53 offen offset:1024 sc1
s_add_u32 s53, s53, 0x40000
buffer_load_dwordx4 v[96:99], v4, s[16:19], s52 offen sc1
buffer_load_dwordx4 v[100:103], v4, s[16:19], s52 offen offset:1024 sc1
s_add_u32 s52, s52, 0x40000
buffer_load_dwordx4 v[104:107], v4, s[16:19], s53 offen sc1
buffer_load_dwordx4 v[108:111], v4, s[16:19], s53 offen offset:1024 sc1
s_add_u32 s53, s53, 0x40000
ds_read_b64_tr_b16 a[0:1], v7
TR 2,7,512
TR 4,7,32
TR 6,7,544
TR 8,7,64
TR 10,7,576
TR 12,7,96
TR 14,7,608
TR 16,7,1024
TR 18,7,1536
TR 20,7,1056
TR 22,7,1568
TR 24,7,1088
TR 26,7,1600
TR 28,7,1120
TR 30,7,1632
s_waitcnt vmcnt(11) lgkmcnt(14)
MAV 32,0,64
TR 32,7,8320
TR 34,7,8832
s_waitcnt vmcnt(10)
MAV 48,0,68
buffer_load_dwordx4 v[112:115], v4, s[16:19], s52 offen sc1
s_waitcnt lgkmcnt(14)
MAV 52,4,68
TR 36,7,8352
TR 38,7,8864
MAV 36,4,64
TR 40,7,8384
TR 42,7,8896
s_waitcnt lgkmcnt(15)
MAV 40,8,64
buffer_load_dwordx4 v[116:119], v4, s[16:19], s52 offen offset:1024 sc1
MAV 56,8,68
TR 44,7,8416
s_add_u32 s52, s52, 0x40000
s_waitcnt lgkmcnt(15)
MAV 60,12,68
TR 46,7,8928
MAV 44,12,64
TR 48,7,9344
TR 50,7,9856
s_waitcnt vmcnt(11) lgkmcnt(15)
MAV 32,16,72
buffer_load_dwordx4 v[120:123], v4, s[16:19], s53 offen sc1
s_waitcnt vmcnt(11)
MAV 48,16,76
TR 52,7,9376
TR 54,7,9888
s_waitcnt lgkmcnt(15)
MAV 52,20,76
TR 56,7,9408
TR 58,7,9920
MAV 36,20,72
buffer_load_dwordx4 v[124:127], v4, s[16:19], s53 offen offset:1024 sc1
s_waitcnt lgkmcnt(15)
MAV 40,24,72
TR 60,7,9440
s_add_u32 s53, s53, 0x40000
MAV 56,24,76
TR 62,7,9952
s_waitcnt lgkmcnt(15)
MAV 60,28,76
MAV 44,28,72
s_waitcnt vmcnt(11) lgkmcnt(14)
MAV 32,32,80
TR 0,7,16640
TR 2,7,17152
s_waitcnt vmcnt(10)
MAV 48,32,84
buffer_load_dwordx4 v[64:67], v4, s[16:19], s52 offen sc1
s_waitcnt lgkmcnt(14)
MAV 52,36,84
TR 4,7,16672
TR 6,7,17184
MAV 36,36,80
TR 8,7,16704
TR 10,7,17216
s_waitcnt lgkmcnt(15)
MAV 40,40,80
buffer_load_dwordx4 v[68:71], v4, s[16:19], s52 offen offset:1024 sc1
MAV 56,40,84
TR 12,7,16736
s_add_u32 s52, s52, 0x40000
s_waitcnt lgkmcnt(15)
MAV 60,44,84
TR 14,7,17248
MAV 44,44,80
TR 16,7,17664
TR 18,7,18176
s_waitcnt vmcnt(11) lgkmcnt(15)
MAV 32,48,88
buffer_load_dwordx4 v[72:75], v4, s[16:19], s53 offen sc1
s_waitcnt vmcnt(11)
MAV 48,48,92
TR 20,7,17696
TR 22,7,18208
s_waitcnt lgkmcnt(15)
MAV 52,52,92
TR 24,7,17728
TR 26,7,18240
MAV 36,52,88
buffer_load_dwordx4 v[76:79], v4, s[16:19], s53 offen offset:1024 sc1
s_waitcnt lgkmcnt(15)
MAV 40,56,88
TR 28,7,17760
s_add_u32 s53, s53, 0x40000
MAV 56,56,92
TR 30,7,18272
s_waitcnt lgkmcnt(15)
MAV 60,60,92
MAV 44,60,88
s_waitcnt vmcnt(11) lgkmcnt(14)
MAV 32,0,96
TR 32,7,24960
TR 34,7,25472
s_waitcnt vmcnt(10)
MAV 48,0,100
buffer_load_dwordx4 v[80:83], v4, s[16:19], s52 offen sc1
s_waitcnt lgkmcnt(14)
MAV 52,4,100
TR 36,7,24992
TR 38,7,25504
MAV 36,4,96
TR 40,7,25024
TR 42,7,25536
s_waitcnt lgkmcnt(15)
MAV 40,8,96
buffer_load_dwordx4 v[84:87], v4, s[16:19], s52 offen offset:1024 sc1
MAV 56,8,100
TR 44,7,25056
s_add_u32 s52, s52, 0x40000
s_waitcnt lgkmcnt(15)
MAV 60,12,100
TR 46,7,25568
MAV 44,12,96
TR 48,7,25984
TR 50,7,26496
s_waitcnt vmcnt(11) lgkmcnt(15)
MAV 32,16,104
buffer_load_dwordx4 v[88:91], v4, s[16:19], s53 offen sc1
s_waitcnt vmcnt(11)
MAV 48,16,108
TR 52,7,26016
TR 54,7,26528
s_waitcnt lgkmcnt(15)
MAV 52,20,108
TR 56,7,26048
TR 58,7,26560
MAV 36,20,104
buffer_load_dwordx4 v[92:95], v4, s[16:19], s53 offen offset:1024 sc1
s_waitcnt lgkmcnt(15)
MAV 40,24,104
TR 60,7,26080
s_add_u32 s53, s53, 0x40000
MAV 56,24,108
TR 62,7,26592
s_waitcnt lgkmcnt(15)
MAV 60,28,108
MAV 44,28,104
s_waitcnt vmcnt(11) lgkmcnt(14)
MAV 32,32,112
TR 0,7,33280
TR 2,7,33792
s_waitcnt vmcnt(10)
MAV 48,32,116
buffer_load_dwordx4 v[96:99], v4, s[16:19], s52 offen sc1
s_waitcnt lgkmcnt(14)
MAV 52,36,116
TR 4,7,33312
TR 6,7,33824
MAV 36,36,112
TR 8,7,33344
TR 10,7,33856
s_waitcnt lgkmcnt(15)
MAV 40,40,112
buffer_load_dwordx4 v[100:103], v4, s[16:19], s52 offen offset:1024 sc1
MAV 56,40,116
TR 12,7,33376
s_add_u32 s52, s52, 0x40000
s_waitcnt lgkmcnt(15)
MAV 60,44,116
TR 14,7,33888
MAV 44,44,112
TR 16,7,34304
TR 18,7,34816
s_waitcnt vmcnt(11) lgkmcnt(15)
MAV 32,48,120
buffer_load_dwordx4 v[104:107], v4, s[16:19], s53 offen sc1
s_waitcnt vmcnt(11)
MAV 48,48,124
TR 20,7,34336
TR 22,7,34848
s_waitcnt lgkmcnt(15)
MAV 52,52,124
TR 24,7,34368
TR 26,7,34880
MAV 36,52,120
buffer_load_dwordx4 v[108:111], v4, s[16:19], s53 offen offset:1024 sc1
s_waitcnt lgkmcnt(15)
MAV 40,56,120
TR 28,7,34400
s_add_u32 s53, s53, 0x40000
MAV 56,56,124
TR 30,7,34912
s_waitcnt lgkmcnt(15)
MAV 60,60,124
MAV 44,60,120
s_waitcnt vmcnt(11) lgkmcnt(14)
MAV 32,0,64
TR 32,7,41600
TR 34,7,42112
s_waitcnt vmcnt(10)
MAV 48,0,68
buffer_load_dwordx4 v[112:115], v4, s[16:19], s52 offen sc1
s_waitcnt lgkmcnt(14)
MAV 52,4,68
TR 36,7,41632
TR 38,7,42144
MAV 36,4,64
TR 40,7,41664
TR 42,7,42176
s_waitcnt lgkmcnt(15)
MAV 40,8,64
buffer_load_dwordx4 v[116:119], v4, s[16:19], s52 offen offset:1024 sc1
MAV 56,8,68
TR 44,7,41696
s_add_u32 s52, s52, 0x40000
s_waitcnt lgkmcnt(15)
MAV 60,12,68
TR 46,7,42208
MAV 44,12,64
TR 48,7,42624
TR 50,7,43136
s_waitcnt vmcnt(11) lgkmcnt(15)
MAV 32,16,72
buffer_load_dwordx4 v[120:123], v4, s[16:19], s53 offen sc1
s_waitcnt vmcnt(11)
MAV 48,16,76
TR 52,7,42656
TR 54,7,43168
s_waitcnt lgkmcnt(15)
MAV 52,20,76
TR 56,7,42688
TR 58,7,43200
MAV 36,20,72
buffer_load_dwordx4 v[124:127], v4, s[16:19], s53 offen offset:1024 sc1
s_waitcnt lgkmcnt(15)
MAV 40,24,72
TR 60,7,42720
s_add_u32 s53, s53, 0x40000
MAV 56,24,76
TR 62,7,43232
s_waitcnt lgkmcnt(15)
MAV 60,28,76
MAV 44,28,72
s_waitcnt vmcnt(11) lgkmcnt(14)
MAV 32,32,80
TR 0,7,49920
TR 2,7,50432
s_waitcnt vmcnt(10)
MAV 48,32,84
buffer_load_dwordx4 v[64:67], v4, s[16:19], s52 offen sc1
s_waitcnt lgkmcnt(14)
MAV 52,36,84
TR 4,7,49952
TR 6,7,50464
MAV 36,36,80
TR 8,7,49984
TR 10,7,50496
s_waitcnt lgkmcnt(15)
MAV 40,40,80
buffer_load_dwordx4 v[68:71], v4, s[16:19], s52 offen offset:1024 sc1
MAV 56,40,84
TR 12,7,50016
s_add_u32 s52, s52, 0x40000
s_waitcnt lgkmcnt(15)
MAV 60,44,84
TR 14,7,50528
MAV 44,44,80
TR 16,7,50944
TR 18,7,51456
s_waitcnt vmcnt(11) lgkmcnt(15)
MAV 32,48,88
buffer_load_dwordx4 v[72:75], v4, s[16:19], s53 offen sc1
s_waitcnt vmcnt(11)
MAV 48,48,92
TR 20,7,50976
TR 22,7,51488
s_waitcnt lgkmcnt(15)
MAV 52,52,92
TR 24,7,51008
TR 26,7,51520
MAV 36,52,88
buffer_load_dwordx4 v[76:79], v4, s[16:19], s53 offen offset:1024 sc1
s_waitcnt lgkmcnt(15)
MAV 40,56,88
TR 28,7,51040
s_add_u32 s53, s53, 0x40000
MAV 56,56,92
TR 30,7,51552
s_waitcnt lgkmcnt(15)
MAV 60,60,92
MAV 44,60,88
s_waitcnt vmcnt(11) lgkmcnt(14)
MAV 32,0,96
TR 32,7,58240
TR 34,7,58752
s_waitcnt vmcnt(10)
MAV 48,0,100
buffer_load_dwordx4 v[80:83], v4, s[16:19], s52 offen sc1
s_waitcnt lgkmcnt(14)
MAV 52,4,100
TR 36,7,58272
TR 38,7,58784
MAV 36,4,96
TR 40,7,58304
TR 42,7,58816
s_waitcnt lgkmcnt(15)
MAV 40,8,96
buffer_load_dwordx4 v[84:87], v4, s[16:19], s52 offen offset:1024 sc1
MAV 56,8,100
TR 44,7,58336
s_add_u32 s52, s52, 0x40000
s_waitcnt lgkmcnt(15)
MAV 60,12,100
TR 46,7,58848
MAV 44,12,96
TR 48,7,59264
TR 50,7,59776
s_waitcnt vmcnt(11) lgkmcnt(15)
MAV 32,16,104
buffer_load_dwordx4 v[88:91], v4, s[16:19], s53 offen sc1
s_waitcnt vmcnt(11)
MAV 48,16,108
TR 52,7,59296
TR 54,7,59808
s_waitcnt lgkmcnt(15)
MAV 52,20,108
TR 56,7,59328
TR 58,7,59840
MAV 36,20,104
buffer_load_dwordx4 v[92:95], v4, s[16:19], s53 offen offset:1024 sc1
s_waitcnt lgkmcnt(15)
MAV 40,24,104
TR 60,7,59360
s_add_u32 s53, s53, 0x40000
MAV 56,24,108
TR 62,7,59872
s_waitcnt lgkmcnt(15)
MAV 60,28,108
MAV 44,28,104
s_xor_b32 s57, s57, 66560
v_add_u32 v7, s57, v8
s_waitcnt vmcnt(11) lgkmcnt(14)
MAV 32,32,112
ds_read_b64_tr_b16 a[0:1], v7
TR 2,7,512
s_waitcnt vmcnt(10)
MAV 48,32,116
buffer_load_dwordx4 v[96:99], v4, s[16:19], s52 offen sc1
s_waitcnt lgkmcnt(14)
MAV 52,36,116
TR 4,7,32
TR 6,7,544
MAV 36,36,112
TR 8,7,64
TR 10,7,576
s_waitcnt lgkmcnt(15)
MAV 40,40,112
buffer_load_dwordx4 v[100:103], v4, s[16:19], s52 offen offset:1024 sc1
MAV 56,40,116
TR 12,7,96
s_add_u32 s52, s52, 0x40000
s_waitcnt lgkmcnt(15)
MAV 60,44,116
TR 14,7,608
MAV 44,44,112
TR 16,7,1024
TR 18,7,1536
s_waitcnt vmcnt(11) lgkmcnt(15)
MAV 32,48,120
buffer_load_dwordx4 v[104:107], v4, s[16:19], s53 offen sc1
s_waitcnt vmcnt(11)
MAV 48,48,124
TR 20,7,1056
TR 22,7,1568
s_waitcnt lgkmcnt(15)
MAV 52,52,124
TR 24,7,1088
TR 26,7,1600
MAV 36,52,120
buffer_load_dwordx4 v[108:111], v4, s[16:19], s53 offen offset:1024 sc1
s_waitcnt lgkmcnt(15)
MAV 40,56,120
TR 28,7,1120
s_add_u32 s53, s53, 0x40000
MAV 56,56,124
TR 30,7,1632
s_waitcnt lgkmcnt(15)
MAV 60,60,124
MAV 44,60,120
s_waitcnt vmcnt(11) lgkmcnt(14)
MAV 32,0,64
TR 32,7,8320
TR 34,7,8832
s_waitcnt vmcnt(10)
MAV 48,0,68
buffer_load_dwordx4 v[112:115], v4, s[16:19], s52 offen sc1
s_waitcnt lgkmcnt(14)
MAV 52,4,68
TR 36,7,8352
TR 38,7,8864
MAV 36,4,64
TR 40,7,8384
TR 42,7,8896
s_waitcnt lgkmcnt(15)
MAV 40,8,64
buffer_load_dwordx4 v[116:119], v4, s[16:19], s52 offen offset:1024 sc1
MAV 56,8,68
TR 44,7,8416
s_add_u32 s52, s52, 0x40000
s_waitcnt lgkmcnt(15)
MAV 60,12,68
TR 46,7,8928
MAV 44,12,64
TR 48,7,9344
TR 50,7,9856
s_waitcnt vmcnt(11) lgkmcnt(15)
MAV 32,16,72
buffer_load_dwordx4 v[120:123], v4, s[16:19], s53 offen sc1
s_waitcnt vmcnt(11)
MAV 48,16,76
TR 52,7,9376
TR 54,7,9888
s_waitcnt lgkmcnt(15)
MAV 52,20,76
TR 56,7,9408
TR 58,7,9920
MAV 36,20,72
buffer_load_dwordx4 v[124:127], v4, s[16:19], s53 offen offset:1024 sc1
s_waitcnt lgkmcnt(15)
MAV 40,24,72
TR 60,7,9440
s_add_u32 s53, s53, 0x40000
MAV 56,24,76
TR 62,7,9952
s_waitcnt lgkmcnt(15)
MAV 60,28,76
MAV 44,28,72
s_waitcnt vmcnt(11) lgkmcnt(14)
MAV 32,32,80
TR 0,7,16640
TR 2,7,17152
s_waitcnt vmcnt(10)
MAV 48,32,84
buffer_load_dwordx4 v[64:67], v4, s[16:19], s52 offen sc1
s_waitcnt lgkmcnt(14)
MAV 52,36,84
TR 4,7,16672
TR 6,7,17184
MAV 36,36,80
TR 8,7,16704
TR 10,7,17216
s_waitcnt lgkmcnt(15)
MAV 40,40,80
buffer_load_dwordx4 v[68:71], v4, s[16:19], s52 offen offset:1024 sc1
MAV 56,40,84
TR 12,7,16736
s_add_u32 s52, s52, 0x40000
s_waitcnt lgkmcnt(15)
MAV 60,44,84
TR 14,7,17248
MAV 44,44,80
TR 16,7,17664
TR 18,7,18176
s_waitcnt vmcnt(11) lgkmcnt(15)
MAV 32,48,88
buffer_load_dwordx4 v[72:75], v4, s[16:19], s53 offen sc1
s_waitcnt vmcnt(11)
MAV 48,48,92
TR 20,7,17696
TR 22,7,18208
s_waitcnt lgkmcnt(15)
MAV 52,52,92
TR 24,7,17728
TR 26,7,18240
MAV 36,52,88
buffer_load_dwordx4 v[76:79], v4, s[16:19], s53 offen offset:1024 sc1
s_waitcnt lgkmcnt(15)
MAV 40,56,88
TR 28,7,17760
s_add_u32 s53, s53, 0x40000
MAV 56,56,92
TR 30,7,18272
s_waitcnt lgkmcnt(15)
MAV 60,60,92
MAV 44,60,88
s_waitcnt vmcnt(11) lgkmcnt(14)
MAV 32,0,96
TR 32,7,24960
TR 34,7,25472
s_waitcnt vmcnt(10)
MAV 48,0,100
buffer_load_dwordx4 v[80:83], v4, s[16:19], s52 offen sc1
s_waitcnt lgkmcnt(14)
MAV 52,4,100
TR 36,7,24992
TR 38,7,25504
MAV 36,4,96
TR 40,7,25024
TR 42,7,25536
s_waitcnt lgkmcnt(15)
MAV 40,8,96
.Lpad1:
s_cbranch_execz .Lpad4
buffer_load_dwordx4 v[84:87], v4, s[16:19], s52 offen offset:1024 sc1
MAV 56,8,100
TR 44,7,25056
s_add_u32 s52, s52, 0x40000
s_waitcnt lgkmcnt(15)
MAV 60,12,100
TR 46,7,25568
MAV 44,12,96
TR 48,7,25984
TR 50,7,26496
s_waitcnt vmcnt(11) lgkmcnt(15)
MAV 32,16,104
buffer_load_dwordx4 v[88:91], v4, s[16:19], s53 offen sc1
s_waitcnt vmcnt(11)
MAV 48,16,108
TR 52,7,26016
TR 54,7,26528
s_waitcnt lgkmcnt(15)
MAV 52,20,108
TR 56,7,26048
TR 58,7,26560
MAV 36,20,104
buffer_load_dwordx4 v[92:95], v4, s[16:19], s53 offen offset:1024 sc1
s_waitcnt lgkmcnt(15)
MAV 40,24,104
TR 60,7,26080
s_add_u32 s53, s53, 0x40000
MAV 56,24,108
TR 62,7,26592
s_waitcnt lgkmcnt(15)
MAV 60,28,108
MAV 44,28,104
s_waitcnt vmcnt(11) lgkmcnt(14)
MAV 32,32,112
TR 0,7,33280
TR 2,7,33792
s_waitcnt vmcnt(10)
MAV 48,32,116
buffer_load_dwordx4 v[96:99], v4, s[16:19], s52 offen sc1
s_waitcnt lgkmcnt(14)
MAV 52,36,116
TR 4,7,33312
TR 6,7,33824
MAV 36,36,112
TR 8,7,33344
TR 10,7,33856
s_waitcnt lgkmcnt(15)
MAV 40,40,112
buffer_load_dwordx4 v[100:103], v4, s[16:19], s52 offen offset:1024 sc1
MAV 56,40,116
TR 12,7,33376
s_add_u32 s52, s52, 0x40000
s_waitcnt lgkmcnt(15)
MAV 60,44,116
TR 14,7,33888
MAV 44,44,112
TR 16,7,34304
TR 18,7,34816
s_waitcnt vmcnt(11) lgkmcnt(15)
MAV 32,48,120
buffer_load_dwordx4 v[104:107], v4, s[16:19], s53 offen sc1
s_waitcnt vmcnt(11)
MAV 48,48,124
TR 20,7,34336
TR 22,7,34848
s_waitcnt lgkmcnt(15)
MAV 52,52,124
TR 24,7,34368
TR 26,7,34880
MAV 36,52,120
buffer_load_dwordx4 v[108:111], v4, s[16:19], s53 offen offset:1024 sc1
s_waitcnt lgkmcnt(15)
MAV 40,56,120
TR 28,7,34400
s_add_u32 s53, s53, 0x40000
MAV 56,56,124
TR 30,7,34912
s_waitcnt lgkmcnt(15)
MAV 60,60,124
MAV 44,60,120
s_waitcnt vmcnt(11) lgkmcnt(14)
MAV 32,0,64
TR 32,7,41600
TR 34,7,42112
s_waitcnt vmcnt(10)
MAV 48,0,68
buffer_load_dwordx4 v[112:115], v4, s[16:19], s52 offen sc1
s_waitcnt lgkmcnt(14)
MAV 52,4,68
TR 36,7,41632
TR 38,7,42144
MAV 36,4,64
TR 40,7,41664
TR 42,7,42176
s_waitcnt lgkmcnt(15)
MAV 40,8,64
buffer_load_dwordx4 v[116:119], v4, s[16:19], s52 offen offset:1024 sc1
MAV 56,8,68
TR 44,7,41696
s_add_u32 s52, s52, 0x40000
s_waitcnt lgkmcnt(15)
MAV 60,12,68
TR 46,7,42208
MAV 44,12,64
TR 48,7,42624
TR 50,7,43136
s_waitcnt vmcnt(11) lgkmcnt(15)
MAV 32,16,72
buffer_load_dwordx4 v[120:123], v4, s[16:19], s53 offen sc1
s_waitcnt vmcnt(11)
MAV 48,16,76
TR 52,7,42656
TR 54,7,43168
s_waitcnt lgkmcnt(15)
MAV 52,20,76
TR 56,7,42688
TR 58,7,43200
MAV 36,20,72
buffer_load_dwordx4 v[124:127], v4, s[16:19], s53 offen offset:1024 sc1
s_waitcnt lgkmcnt(15)
MAV 40,24,72
TR 60,7,42720
s_add_u32 s53, s53, 0x40000
MAV 56,24,76
TR 62,7,43232
s_waitcnt lgkmcnt(15)
MAV 60,28,76
MAV 44,28,72
s_waitcnt lgkmcnt(0)
s_barrier
s_waitcnt vmcnt(11)
MAV 32,32,80
TR 0,7,49920
TR 2,7,50432
s_add_u32 m0, s59, 84480
s_waitcnt vmcnt(10)
MAV 48,32,84
TR 4,7,49952
buffer_load_dwordx4 v12, s[32:35], s58 offen lds
MAV 52,36,84
TR 6,7,50464
TR 8,7,49984
MAV 36,36,80
TR 10,7,50496
MAV 40,40,80
TR 12,7,50016
buffer_load_dwordx4 v13, s[32:35], s58 offen offset:1056 lds
MAV 56,40,84
TR 14,7,50528
TR 16,7,50944
MAV 60,44,84
TR 18,7,51456
TR 20,7,50976
MAV 44,44,80
TR 22,7,51488
s_waitcnt vmcnt(11)
MAV 32,48,88
TR 24,7,51008
buffer_load_dwordx4 v14, s[32:35], s58 offen offset:2112 lds
s_waitcnt vmcnt(11)
MAV 48,48,92
TR 26,7,51520
TR 28,7,51040
MAV 52,52,92
TR 30,7,51552
MAV 36,52,88
buffer_load_dwordx4 v15, s[32:35], s58 offen offset:3168 lds
MAV 40,56,88
s_add_u32 s58, s58, 229376
MAV 56,56,92
MAV 60,60,92
MAV 44,60,88
s_waitcnt vmcnt(11) lgkmcnt(14)
MAV 32,0,96
TR 32,7,58240
s_add_u32 m0, s59, 101376
s_waitcnt vmcnt(10)
MAV 48,0,100
buffer_load_dwordx4 v12, s[32:35], s58 offen lds
s_waitcnt lgkmcnt(13)
MAV 52,4,100
TR 34,7,58752
TR 36,7,58272
MAV 36,4,96
TR 38,7,58784
TR 40,7,58304
s_waitcnt lgkmcnt(15)
MAV 40,8,96
buffer_load_dwordx4 v13, s[32:35], s58 offen offset:1056 lds
MAV 56,8,100
TR 42,7,58816
TR 44,7,58336
s_waitcnt lgkmcnt(15)
MAV 60,12,100
TR 46,7,58848
MAV 44,12,96
TR 48,7,59264
TR 50,7,59776
s_waitcnt vmcnt(11) lgkmcnt(15)
MAV 32,16,104
buffer_load_dwordx4 v14, s[32:35], s58 offen offset:2112 lds
s_waitcnt vmcnt(11)
MAV 48,16,108
TR 52,7,59296
TR 54,7,59808
s_waitcnt lgkmcnt(15)
MAV 52,20,108
TR 56,7,59328
TR 58,7,59840
MAV 36,20,104
buffer_load_dwordx4 v15, s[32:35], s58 offen offset:3168 lds
s_waitcnt lgkmcnt(15)
MAV 40,24,104
TR 60,7,59360
s_add_u32 s58, s58, 229376
MAV 56,24,108
TR 62,7,59872
s_waitcnt lgkmcnt(15)
MAV 60,28,108
MAV 44,28,104
s_waitcnt vmcnt(11) lgkmcnt(14)
MAV 32,32,112
s_add_u32 m0, s59, 118272
s_lshl_b32 s64, s6, 14
s_lshl_b32 s65, s49, 13
s_waitcnt vmcnt(10)
MAV 48,32,116
buffer_load_dwordx4 v12, s[32:35], s58 offen lds
s_waitcnt lgkmcnt(12)
MAV 52,36,116
s_add_u32 s64, s64, s65
s_lshl_b32 s65, s7, 9
s_add_u32 s64, s64, s65
MAV 36,36,112
s_lshl_b32 s65, s48, 8
s_add_u32 s64, s64, s65
s_add_u32 s64, s64, 29622272
s_waitcnt lgkmcnt(10)
MAV 40,40,112
s_lshl_b32 s62, s7, 18
v_and_b32 v152, 31, v1
v_lshlrev_b32 v152, 3, v152
MAV 56,40,116
buffer_load_dwordx4 v13, s[32:35], s58 offen offset:1056 lds
s_waitcnt lgkmcnt(8)
MAV 60,44,116
s_add_u32 s62, s62, 8388608
v_lshrrev_b32 v153, 5, v1
v_lshl_add_u32 v152, v153, 28, v152
MAV 44,44,112
s_add_u32 s63, s62, 0x20000
s_waitcnt vmcnt(11) lgkmcnt(6)
MAV 32,48,120
s_waitcnt vmcnt(10)
MAV 48,48,124
buffer_load_dwordx4 v14, s[32:35], s58 offen offset:2112 lds
s_waitcnt lgkmcnt(4)
MAV 52,52,124
s_nop 2
v_cvt_pk_bf16_f32 v128, v32, v33
v_cvt_pk_bf16_f32 v129, v34, v35
MAV 36,52,120
v_cvt_pk_bf16_f32 v136, v48, v49
v_cvt_pk_bf16_f32 v137, v50, v51
s_waitcnt lgkmcnt(2)
MAV 40,56,120
v_cvt_pk_bf16_f32 v138, v52, v53
v_cvt_pk_bf16_f32 v139, v54, v55
MAV 56,56,124
buffer_load_dwordx4 v15, s[32:35], s58 offen offset:3168 lds
s_waitcnt lgkmcnt(0)
MAV 60,60,124
s_add_u32 s58, s58, 229376
v_cvt_pk_bf16_f32 v130, v36, v37
v_cvt_pk_bf16_f32 v131, v38, v39
MAV 44,60,120
v_cvt_pk_bf16_f32 v132, v40, v41
v_cvt_pk_bf16_f32 v133, v42, v43
v_cvt_pk_bf16_f32 v140, v56, v57
v_cvt_pk_bf16_f32 v141, v58, v59
v_cvt_pk_bf16_f32 v142, v60, v61
v_cvt_pk_bf16_f32 v143, v62, v63
v_pk_mul_f32 v[146:147], v[32:33], v[32:33]
buffer_store_dwordx4 v[128:131], v4, s[16:19], s62 offen sc1
v_cvt_pk_bf16_f32 v134, v44, v45
v_cvt_pk_bf16_f32 v135, v46, v47
v_pk_mul_f32 v[150:151], v[48:49], v[48:49]
v_pk_fma_f32 v[146:147], v[34:35], v[34:35], v[146:147]
v_pk_add_f32 v[144:145], v[32:33], v[34:35]
v_pk_fma_f32 v[150:151], v[50:51], v[50:51], v[150:151]
v_pk_add_f32 v[148:149], v[48:49], v[50:51]
v_pk_fma_f32 v[146:147], v[36:37], v[36:37], v[146:147]
v_pk_add_f32 v[144:145], v[144:145], v[36:37]
v_pk_fma_f32 v[150:151], v[52:53], v[52:53], v[150:151]
v_pk_add_f32 v[148:149], v[148:149], v[52:53]
v_pk_fma_f32 v[146:147], v[38:39], v[38:39], v[146:147]
v_pk_add_f32 v[144:145], v[144:145], v[38:39]
buffer_store_dwordx4 v[132:135], v4, s[16:19], s63 offen sc1
v_pk_fma_f32 v[150:151], v[54:55], v[54:55], v[150:151]
v_pk_add_f32 v[148:149], v[148:149], v[54:55]
v_pk_fma_f32 v[146:147], v[40:41], v[40:41], v[146:147]
v_pk_add_f32 v[144:145], v[144:145], v[40:41]
v_pk_fma_f32 v[150:151], v[56:57], v[56:57], v[150:151]
v_pk_add_f32 v[148:149], v[148:149], v[56:57]
v_pk_fma_f32 v[146:147], v[42:43], v[42:43], v[146:147]
v_pk_add_f32 v[144:145], v[144:145], v[42:43]
v_pk_fma_f32 v[150:151], v[58:59], v[58:59], v[150:151]
v_pk_add_f32 v[148:149], v[148:149], v[58:59]
v_pk_fma_f32 v[146:147], v[44:45], v[44:45], v[146:147]
v_pk_add_f32 v[144:145], v[144:145], v[44:45]
v_pk_fma_f32 v[150:151], v[60:61], v[60:61], v[150:151]
buffer_store_dwordx4 v[136:139], v4, s[16:19], s62 offen offset:1024 sc1
v_pk_add_f32 v[148:149], v[148:149], v[60:61]
v_pk_fma_f32 v[146:147], v[46:47], v[46:47], v[146:147]
v_pk_add_f32 v[144:145], v[144:145], v[46:47]
v_pk_fma_f32 v[150:151], v[62:63], v[62:63], v[150:151]
v_pk_add_f32 v[148:149], v[148:149], v[62:63]
v_add_f32 v144, v144, v145
v_add_f32 v146, v146, v147
v_add_f32 v148, v148, v149
v_add_f32 v150, v150, v151
s_nop 0
v_permlane16_swap_b32 v144, v148
v_permlane16_swap_b32 v146, v150
v_add_f32 v144, v144, v148
buffer_store_dwordx4 v[140:143], v4, s[16:19], s63 offen offset:1024 sc1
v_add_f32 v146, v146, v150
s_nop 1
v_permlane32_swap_b32 v144, v146
v_add_f32 v144, v144, v146
s_nop 1
v_permlane32_swap_b32 v144, v145
buffer_store_dwordx2 v[144:145], v152, s[16:19], s64 offen sc1
s_nop 1
v_accvgpr_write_b32 a224, v32
v_accvgpr_write_b32 a225, v33
v_accvgpr_write_b32 a226, v34
v_accvgpr_write_b32 a227, v35
v_accvgpr_write_b32 a228, v36
v_accvgpr_write_b32 a229, v37
v_accvgpr_write_b32 a230, v38
v_accvgpr_write_b32 a231, v39
v_accvgpr_write_b32 a232, v40
v_accvgpr_write_b32 a233, v41
v_accvgpr_write_b32 a234, v42
v_accvgpr_write_b32 a235, v43
v_accvgpr_write_b32 a236, v44
v_accvgpr_write_b32 a237, v45
v_accvgpr_write_b32 a238, v46
v_accvgpr_write_b32 a239, v47
v_accvgpr_write_b32 a240, v48
v_accvgpr_write_b32 a241, v49
v_accvgpr_write_b32 a242, v50
v_accvgpr_write_b32 a243, v51
v_accvgpr_write_b32 a244, v52
v_accvgpr_write_b32 a245, v53
v_accvgpr_write_b32 a246, v54
v_accvgpr_write_b32 a247, v55
v_accvgpr_write_b32 a248, v56
v_accvgpr_write_b32 a249, v57
v_accvgpr_write_b32 a250, v58
v_accvgpr_write_b32 a251, v59
v_accvgpr_write_b32 a252, v60
v_accvgpr_write_b32 a253, v61
v_accvgpr_write_b32 a254, v62
v_accvgpr_write_b32 a255, v63
s_lshl_b32 s62, s10, 14
s_lshl_b32 s63, s3, 12
s_add_u32 s62, s62, s63
s_lshl_b32 s63, s12, 11
s_add_u32 s62, s62, s63
v_lshl_add_u32 v10, v1, 4, s62
v_lshrrev_b32 v2, 3, v1
v_cmp_eq_u32 vcc, 3, v2
v_add_u32 v2, 67108480, v10
s_nop 0
v_cndmask_b32 v10, v10, v2, vcc
v_xor_b32 v11, 2048, v10
v_bfe_u32 v16, v1, 2, 3
v_mul_u32_u24 v16, 1056, v16
v_bfe_u32 v2, v1, 5, 1
v_lshl_add_u32 v16, v2, 8, v16
v_and_b32 v2, 3, v1
v_lshl_add_u32 v16, v2, 3, v16
s_lshl_b32 s62, s12, 6
s_add_u32 s62, s62, 84480
s_xor_b32 s63, s12, 1
s_mul_i32 s63, s63, 192
s_add_u32 s63, s63, 84480
v_add_u32 v17, s63, v16
v_add_u32 v16, s62, v16
s_mov_b32 s52, 8388608
s_mov_b32 s54, s58
s_mov_b32 s55, s59
s_mul_i32 s59, s3, 2112
s_and_b32 s62, s7, 1
s_mul_i32 s62, s62, 3670016
s_lshr_b32 s63, s7, 1
s_lshl_b32 s63, s63, 8
s_add_u32 s62, s62, s63
s_lshl_b32 s63, s3, 12
s_add_u32 s62, s62, s63
v_lshrrev_b32 v5, 4, v1
v_lshlrev_b32 v5, 14, v5
v_and_b32 v2, 15, v1
v_lshl_add_u32 v5, v2, 4, v5
v_add_u32 v5, s62, v5
v_add_u32 v6, 992, v5
s_lshl_b32 s62, s10, 15
s_lshl_b32 s63, s3, 13
s_add_u32 s62, s62, s63
v_lshl_add_u32 v4, v1, 4, s62
s_and_b32 s47, s5, 3
s_lshr_b32 s63, s5, 2
s_lshl_b32 s63, s63, 3
s_add_u32 s63, s63, s4
s_lshl_b32 s62, s63, 1
s_add_u32 s62, s62, s48
s_mul_i32 s62, s62, 1792
v_lshrrev_b32 v7, 2, v1
v_min_u32 v8, 13, v7
v_lshl_add_u32 v8, v8, 7, s62
s_lshl_b32 s62, s63, 2
s_add_u32 s62, s62, s3
s_mul_i32 s62, s62, 640
v_and_b32 v7, 7, v7
v_min_u32 v7, 4, v7
v_lshl_add_u32 v7, v7, 7, s62
v_lshrrev_b32 v2, 5, v1
v_mul_u32_u24 v2, 3670016, v2
v_add_u32 v7, v7, v2
s_mul_i32 s44, s47, 163840
s_add_u32 s45, s47, 12
s_mul_i32 s45, s45, 229376
v_and_b32 v2, 1, v1
v_lshlrev_b32 v2, 4, v2
v_mov_b32 v9, 0x3f80
v_lshlrev_b32 v2, v2, v9
v_bfe_u32 v9, v1, 1, 3
v_cmp_eq_u32 vcc, 0, v9
s_nop 1
v_cndmask_b32 v20, 0, v2, vcc
v_cmp_eq_u32 vcc, 1, v9
s_nop 1
v_cndmask_b32 v21, 0, v2, vcc
v_cmp_eq_u32 vcc, 2, v9
s_nop 1
v_cndmask_b32 v22, 0, v2, vcc
v_cmp_eq_u32 vcc, 3, v9
s_nop 1
v_cndmask_b32 v23, 0, v2, vcc
s_add_u32 s62, s55, 84480
v_lshl_add_u32 v9, v1, 4, s62
v_mov_b64 v[24:25], 0
v_mov_b64 v[26:27], 0
s_lshl_b32 s62, s6, 10
s_add_u32 s62, s62, 30441472
s_lshl_b32 s64, s10, 1
s_lshl_b32 s64, s64, 10
s_add_u32 s64, s64, 30441472
s_lshr_b32 s67, s5, 2
s_and_b32 s67, s67, 3
s_lshl_b32 s67, s67, 7
s_add_u32 s64, s64, s67
s_add_u32 s65, s64, 1024
v_lshl_add_u32 v252, v1, 7, s62
v_mov_b32 v253, s64
v_writelane_b32 v253, s65, 1
s_waitcnt vmcnt(0) lgkmcnt(0)
s_barrier
s_cmp_lg_u32 s3, 0
s_cbranch_scc1 .Lnosig37
v_mov_b32 v255, 1
s_mov_b64 exec, 15
buffer_atomic_add v255, v252, s[16:19], 0 offen
s_mov_b64 exec, -1
.Lnosig37:
s_cmp_lg_u32 s3, 1
s_cbranch_scc1 .Lnopoll40
s_mov_b64 exec, 3
s_mov_b32 s15, 0
s_mov_b64 exec, 3
v_mov_b32 v254, 0
buffer_atomic_add v254, v253, s[16:19], 0 offen sc0
.Lpoll38:
s_waitcnt vmcnt(0)
v_cmp_ne_u32 vcc, 16, v254
s_add_u32 s15, s15, 1
s_cbranch_vccz .Lnopoll40r
s_mov_b64 exec, 3
v_mov_b32 v254, 0
buffer_atomic_add v254, v253, s[16:19], 0 offen sc0
s_cmp_le_u32 s15, 100000
s_cbranch_scc1 .Lpoll38
.Lgot39:
s_waitcnt vmcnt(0)
s_branch .Lnopoll40r
.Lnopoll40:
s_mov_b64 exec, 0
s_cmp_eq_u32 s3, 2
s_cbranch_scc1 .Lpad6
s_cmp_eq_u32 s3, 3
s_cbranch_scc1 .Lpad7
s_branch .Lpad8
.Lnopoll40r:
s_mov_b64 exec, -1
s_barrier
buffer_load_dwordx4 a[128:131], v10, s[16:19], s52 offen sc1
buffer_load_dwordx4 a[132:135], v10, s[16:19], s52 offen offset:1024 sc1
buffer_load_dwordx4 a[136:139], v11, s[16:19], s52 offen sc1
buffer_load_dwordx4 a[140:143], v11, s[16:19], s52 offen offset:1024 sc1
s_add_u32 s52, s52, 0x20000
buffer_load_dwordx4 a[144:147], v10, s[16:19], s52 offen sc1
buffer_load_dwordx4 a[148:151], v10, s[16:19], s52 offen offset:1024 sc1
buffer_load_dwordx4 a[152:155], v11, s[16:19], s52 offen sc1
buffer_load_dwordx4 a[156:159], v11, s[16:19], s52 offen offset:1024 sc1
s_add_u32 s52, s52, 0x20000
ds_read_b64_tr_b16 a[0:1], v16
TR 2,16,512
TR 4,16,32
TR 6,16,544
TR 8,16,8448
TR 10,16,8960
TR 12,16,8480
TR 14,16,8992
TR 16,16,64
TR 18,16,576
TR 20,16,96
TR 22,16,608
TR 24,16,8512
TR 26,16,9024
TR 28,16,8544
TR 30,16,9056
TR 32,16,128
TR 34,16,640
TR 36,16,160
TR 38,16,672
TR 40,16,8576
TR 42,16,9088
TR 44,16,8608
TR 46,16,9120
ds_read_b64_tr_b16 a[48:49], v17
TR 50,17,512
TR 52,17,32
TR 54,17,544
TR 56,17,8448
TR 58,17,8960
TR 60,17,8480
TR 62,17,8992
ds_read_b128 a[192:195], v9
RD 196,9,1056
RD 200,9,2112
RD 204,9,3168
s_add_u32 m0, s55, 135168
s_nop 0
buffer_load_dwordx4 v12, s[32:35], s54 offen lds
buffer_load_dwordx4 v13, s[32:35], s54 offen offset:1056 lds
buffer_load_dwordx4 v14, s[32:35], s54 offen offset:2112 lds
buffer_load_dwordx4 v15, s[32:35], s54 offen offset:3168 lds
s_add_u32 s54, s54, 229376
s_mul_i32 s66, s13, 917504
s_add_u32 s66, s66, 12582912
s_add_u32 s65, s66, 393216
s_lshl_b32 s62, s12, 19
s_add_u32 s62, s62, s66
s_add_u32 s63, s62, 0x20000
s_add_u32 s64, s62, 0x40000
s_lshl_b32 s72, s10, 1
s_lshr_b32 s74, s11, 4
s_add_u32 s72, s72, s74
s_lshl_b32 s72, s72, 10
s_add_u32 s72, s72, 30457856
s_and_b32 s73, s6, 14
s_and_b32 s74, s7, 1
s_add_u32 s73, s73, s74
s_lshl_b32 s73, s73, 10
s_add_u32 s73, s73, 30457856
s_lshr_b32 s67, s5, 2
s_and_b32 s67, s67, 3
s_lshl_b32 s67, s67, 7
s_add_u32 s73, s73, s67
s_lshl_b32 s74, s3, 13
s_add_u32 s74, s74, 49920
v_lshl_add_u32 v2, v1, 3, s74
s_waitcnt lgkmcnt(0)
s_barrier
s_waitcnt vmcnt(11)
v_mfma_f32_16x16x32_bf16 v[32:35], a[0:3], a[128:131], 0
buffer_load_dwordx4 a[160:163], v10, s[16:19], s52 offen sc1
s_waitcnt vmcnt(11)
v_mfma_f32_16x16x32_bf16 v[36:39], a[0:3], a[132:135], 0
TR 64,16,16896
v_mfma_f32_16x16x32_bf16 v[52:55], a[4:7], a[132:135], 0
TR 66,16,17408
v_mfma_f32_16x16x32_bf16 v[48:51], a[4:7], a[128:131], 0
TR 68,16,16928
v_mfma_f32_16x16x32_bf16 v[64:67], a[8:11], a[128:131], 0
buffer_load_dwordx4 a[164:167], v10, s[16:19], s52 offen offset:1024 sc1
v_mfma_f32_16x16x32_bf16 v[68:71], a[8:11], a[132:135], 0
TR 70,16,17440
v_mfma_f32_16x16x32_bf16 v[24:27], v[20:23], a[192:195], v[24:27]
TR 72,16,25344
v_mfma_f32_16x16x32_bf16 v[84:87], a[12:15], a[132:135], 0
TR 74,16,25856
v_mfma_f32_16x16x32_bf16 v[80:83], a[12:15], a[128:131], 0
buffer_load_dwordx4 a[168:171], v11, s[16:19], s52 offen sc1
v_mfma_f32_16x16x32_bf16 v[96:99], a[16:19], a[128:131], 0
TR 76,16,25376
v_mfma_f32_16x16x32_bf16 v[100:103], a[16:19], a[132:135], 0
TR 78,16,25888
v_mfma_f32_16x16x32_bf16 v[116:119], a[20:23], a[132:135], 0
TR 80,16,16960
v_mfma_f32_16x16x32_bf16 v[112:115], a[20:23], a[128:131], 0
buffer_load_dwordx4 a[172:175], v11, s[16:19], s52 offen offset:1024 sc1
v_mfma_f32_16x16x32_bf16 v[128:131], a[24:27], a[128:131], 0
s_add_u32 s52, s52, 0x20000
.Lpad2:
s_cbranch_execz .Lpad5
s_add_u32 m0, s55, 84480
v_mfma_f32_16x16x32_bf16 v[132:135], a[24:27], a[132:135], 0
TR 82,16,17472
v_mfma_f32_16x16x32_bf16 v[148:151], a[28:31], a[132:135], 0
TR 84,16,16992
v_mfma_f32_16x16x32_bf16 v[144:147], a[28:31], a[128:131], 0
buffer_load_dwordx4 v12, s[32:35], s54 offen lds
v_mfma_f32_16x16x32_bf16 v[160:163], a[32:35], a[128:131], 0
TR 86,16,17504
v_mfma_f32_16x16x32_bf16 v[164:167], a[32:35], a[132:135], 0
TR 88,16,25408
v_mfma_f32_16x16x32_bf16 v[24:27], v[20:23], a[196:199], v[24:27]
TR 90,16,25920
v_mfma_f32_16x16x32_bf16 v[180:183], a[36:39], a[132:135], 0
buffer_load_dwordx4 a[176:179], v10, s[16:19], s52 offen sc1
v_mfma_f32_16x16x32_bf16 v[176:179], a[36:39], a[128:131], 0
TR 92,16,25440
v_mfma_f32_16x16x32_bf16 v[192:195], a[40:43], a[128:131], 0
TR 94,16,25952
v_mfma_f32_16x16x32_bf16 v[196:199], a[40:43], a[132:135], 0
TR 96,16,17024
v_mfma_f32_16x16x32_bf16 v[212:215], a[44:47], a[132:135], 0
buffer_load_dwordx4 v13, s[32:35], s54 offen offset:1056 lds
v_mfma_f32_16x16x32_bf16 v[208:211], a[44:47], a[128:131], 0
TR 98,16,17536
v_mfma_f32_16x16x32_bf16 v[224:227], a[48:51], a[128:131], 0
TR 100,16,17056
v_mfma_f32_16x16x32_bf16 v[228:231], a[48:51], a[132:135], 0
TR 102,16,17568
v_mfma_f32_16x16x32_bf16 v[236:239], a[52:55], a[132:135], 0
buffer_load_dwordx4 a[180:183], v10, s[16:19], s52 offen offset:1024 sc1
v_mfma_f32_16x16x32_bf16 v[232:235], a[52:55], a[128:131], 0
TR 104,16,25472
v_mfma_f32_16x16x32_bf16 v[240:243], a[56:59], a[128:131], 0
TR 106,16,25984
v_mfma_f32_16x16x32_bf16 v[244:247], a[56:59], a[132:135], 0
TR 108,16,25504
v_mfma_f32_16x16x32_bf16 v[24:27], v[20:23], a[200:203], v[24:27]
buffer_load_dwordx4 v14, s[32:35], s54 offen offset:2112 lds
v_mfma_f32_16x16x32_bf16 v[252:255], a[60:63], a[132:135], 0
TR 110,16,26016
v_mfma_f32_16x16x32_bf16 v[248:251], a[60:63], a[128:131], 0
TR 112,17,16896
s_waitcnt vmcnt(17)
v_mfma_f32_16x16x32_bf16 v[220:223], a[44:47], a[140:143], 0
TR 114,17,17408
v_mfma_f32_16x16x32_bf16 v[216:219], a[44:47], a[136:139], 0
buffer_load_dwordx4 a[184:187], v11, s[16:19], s52 offen sc1
v_mfma_f32_16x16x32_bf16 v[200:203], a[40:43], a[136:139], 0
TR 116,17,16928
v_mfma_f32_16x16x32_bf16 v[204:207], a[40:43], a[140:143], 0
TR 118,17,17440
v_mfma_f32_16x16x32_bf16 v[188:191], a[36:39], a[140:143], 0
TR 120,17,25344
v_mfma_f32_16x16x32_bf16 v[184:187], a[36:39], a[136:139], 0
buffer_load_dwordx4 v15, s[32:35], s54 offen offset:3168 lds
v_mfma_f32_16x16x32_bf16 v[168:171], a[32:35], a[136:139], 0
s_add_u32 s54, s54, 229376
TR 122,17,25856
v_mfma_f32_16x16x32_bf16 v[172:175], a[32:35], a[140:143], 0
TR 124,17,25376
v_mfma_f32_16x16x32_bf16 v[156:159], a[28:31], a[140:143], 0
TR 126,17,25888
v_mfma_f32_16x16x32_bf16 v[152:155], a[28:31], a[136:139], 0
buffer_load_dwordx4 a[188:191], v11, s[16:19], s52 offen offset:1024 sc1
v_mfma_f32_16x16x32_bf16 v[24:27], v[20:23], a[204:207], v[24:27]
s_add_u32 s52, s52, 0x20000
RD 208,9,16896
v_mfma_f32_16x16x32_bf16 v[136:139], a[24:27], a[136:139], 0
RD 212,9,17952
v_mfma_f32_16x16x32_bf16 v[140:143], a[24:27], a[140:143], 0
RD 216,9,19008
v_mfma_f32_16x16x32_bf16 v[124:127], a[20:23], a[140:143], 0
RD 220,9,20064
v_mfma_f32_16x16x32_bf16 v[120:123], a[20:23], a[136:139], 0
v_mfma_f32_16x16x32_bf16 v[104:107], a[16:19], a[136:139], 0
v_mfma_f32_16x16x32_bf16 v[108:111], a[16:19], a[140:143], 0
v_mfma_f32_16x16x32_bf16 v[92:95], a[12:15], a[140:143], 0
v_mfma_f32_16x16x32_bf16 v[88:91], a[12:15], a[136:139], 0
v_mfma_f32_16x16x32_bf16 v[72:75], a[8:11], a[136:139], 0
v_mfma_f32_16x16x32_bf16 v[76:79], a[8:11], a[140:143], 0
v_mfma_f32_16x16x32_bf16 v[60:63], a[4:7], a[140:143], 0
v_mfma_f32_16x16x32_bf16 v[56:59], a[4:7], a[136:139], 0
v_mfma_f32_16x16x32_bf16 v[40:43], a[0:3], a[136:139], 0
v_mfma_f32_16x16x32_bf16 v[44:47], a[0:3], a[140:143], 0
s_waitcnt lgkmcnt(0)
s_barrier
s_waitcnt vmcnt(19)
MAA 32,64,144
s_add_u32 m0, s74, 0
s_mov_b32 s67, 29622272
s_waitcnt vmcnt(18)
MAA 36,64,148
buffer_load_dwordx4 v4, s[16:19], s67 offen sc1 lds
MAA 52,68,148
TR 0,16,33792
MAA 48,68,144
TR 2,16,34304
MAA 64,72,144
buffer_load_dwordx4 v4, s[16:19], s67 offen offset:1024 sc1 lds
MAA 68,72,148
TR 4,16,33824
v_mfma_f32_16x16x32_bf16 v[24:27], v[20:23], a[208:211], v[24:27]
TR 6,16,34336
MAA 84,76,148
buffer_load_dwordx4 v4, s[16:19], s67 offen offset:2048 sc1 lds
MAA 80,76,144
TR 8,16,42240
MAA 96,80,144
TR 10,16,42752
MAA 100,80,148
buffer_load_dwordx4 v4, s[16:19], s67 offen offset:3072 sc1 lds
MAA 116,84,148
s_add_u32 m0, s74, 4096
s_mov_b32 s67, 29626368
MAA 112,84,144
TR 12,16,42272
MAA 128,88,144
buffer_load_dwordx4 v4, s[16:19], s67 offen sc1 lds
MAA 132,88,148
TR 14,16,42784
MAA 148,92,148
TR 16,16,33856
MAA 144,92,144
buffer_load_dwordx4 v4, s[16:19], s67 offen offset:1024 sc1 lds
MAA 160,96,144
TR 18,16,34368
MAA 164,96,148
TR 20,16,33888
v_mfma_f32_16x16x32_bf16 v[24:27], v[20:23], a[212:215], v[24:27]
buffer_load_dwordx4 v4, s[16:19], s67 offen offset:2048 sc1 lds
MAA 180,100,148
TR 22,16,34400
MAA 176,100,144
TR 24,16,42304
MAA 192,104,144
buffer_load_dwordx4 v4, s[16:19], s67 offen offset:3072 sc1 lds
MAA 196,104,148
s_add_u32 m0, s55, 101376
TR 26,16,42816
MAA 212,108,148
TR 28,16,42336
MAA 208,108,144
buffer_load_dwordx4 v12, s[32:35], s54 offen lds
MAA 224,112,144
TR 30,16,42848
MAA 228,112,148
TR 32,16,33920
MAA 236,116,148
buffer_load_dwordx4 a[128:131], v10, s[16:19], s52 offen sc1
MAA 232,116,144
TR 34,16,34432
MAA 240,120,144
TR 36,16,33952
MAA 244,120,148
buffer_load_dwordx4 v13, s[32:35], s54 offen offset:1056 lds
v_mfma_f32_16x16x32_bf16 v[24:27], v[20:23], a[216:219], v[24:27]
TR 38,16,34464
MAA 252,124,148
TR 40,16,42368
MAA 248,124,144
buffer_load_dwordx4 a[132:135], v10, s[16:19], s52 offen offset:1024 sc1
s_waitcnt vmcnt(28)
MAA 220,108,156
TR 42,16,42880
MAA 216,108,152
TR 44,16,42400
MAA 200,104,152
buffer_load_dwordx4 v14, s[32:35], s54 offen offset:2112 lds
MAA 204,104,156
TR 46,16,42912
MAA 188,100,156
TR 48,17,33792
MAA 184,100,152
buffer_load_dwordx4 a[136:139], v11, s[16:19], s52 offen sc1
MAA 168,96,152
TR 50,17,34304
MAA 172,96,156
TR 52,17,33824
MAA 156,92,156
buffer_load_dwordx4 v15, s[32:35], s54 offen offset:3168 lds
MAA 152,92,152
s_add_u32 s54, s54, 229376
TR 54,17,34336
v_mfma_f32_16x16x32_bf16 v[24:27], v[20:23], a[220:223], v[24:27]
TR 56,17,42240
MAA 136,88,152
buffer_load_dwordx4 a[140:143], v11, s[16:19], s52 offen offset:1024 sc1
MAA 140,88,156
s_add_u32 s52, s52, 0x20000
TR 58,17,42752
MAA 124,84,156
TR 60,17,42272
MAA 120,84,152
TR 62,17,42784
MAA 104,80,152
RD 192,9,33792
MAA 108,80,156
RD 196,9,34848
MAA 92,76,156
RD 200,9,35904
MAA 88,76,152
RD 204,9,36960
MAA 72,72,152
MAA 76,72,156
MAA 60,68,156
MAA 56,68,152
MAA 40,64,152
MAA 44,64,156
s_waitcnt vmcnt(28) lgkmcnt(0)
s_barrier
s_waitcnt vmcnt(27)
MAA 32,0,160
s_add_u32 m0, s55, 118272
TR 64,16,50688
s_waitcnt vmcnt(26)
MAA 36,0,164
buffer_load_dwordx4 v12, s[32:35], s54 offen lds
MAA 52,4,164
TR 66,16,51200
MAA 48,4,160
TR 68,16,50720
MAA 64,8,160
TR 70,16,51232
MAA 68,8,164
TR 72,16,59136
v_mfma_f32_16x16x32_bf16 v[24:27], v[20:23], a[192:195], v[24:27]
TR 74,16,59648
MAA 84,12,164
TR 76,16,59168
MAA 80,12,160
buffer_load_dwordx4 a[144:147], v10, s[16:19], s52 offen sc1
MAA 96,16,160
TR 78,16,59680
MAA 100,16,164
TR 80,16,50752
MAA 116,20,164
TR 82,16,51264
MAA 112,20,160
TR 84,16,50784
MAA 128,24,160
s_waitcnt vmcnt(10)
ds_read_b64 v[28:29], v2
MAA 132,24,164
ds_read_b64 v[30:31], v2 offset:512
MAA 148,28,164
ds_read_b64 v[18:19], v2 offset:1024
MAA 144,28,160
buffer_load_dwordx4 v13, s[32:35], s54 offen offset:1056 lds
MAA 160,32,160
TR 86,16,51296
MAA 164,32,164
TR 88,16,59200
v_mfma_f32_16x16x32_bf16 v[24:27], v[20:23], a[196:199], v[24:27]
TR 90,16,59712
MAA 180,36,164
TR 92,16,59232
MAA 176,36,160
TR 94,16,59744
MAA 192,40,160
TR 96,16,50816
s_waitcnt lgkmcnt(7)
v_add_f32 v28, v28, v30
MAA 196,40,164
buffer_load_dwordx4 a[148:151], v10, s[16:19], s52 offen offset:1024 sc1
MAA 212,44,164
TR 98,16,51328
v_add_f32 v29, v29, v31
MAA 208,44,160
ds_read_b64 v[30:31], v2 offset:1536
s_waitcnt lgkmcnt(8)
v_add_f32 v28, v28, v18
MAA 224,48,160
TR 100,16,50848
v_add_f32 v29, v29, v19
MAA 228,48,164
ds_read_b64 v[18:19], v2 offset:2048
MAA 236,52,164
TR 102,16,51360
MAA 232,52,160
TR 104,16,59264
MAA 240,56,160
buffer_load_dwordx4 v14, s[32:35], s54 offen offset:2112 lds
MAA 244,56,164
TR 106,16,59776
v_mfma_f32_16x16x32_bf16 v[24:27], v[20:23], a[200:203], v[24:27]
TR 108,16,59296
MAA 252,60,164
TR 110,16,59808
s_waitcnt lgkmcnt(7)
v_add_f32 v28, v28, v30
MAA 248,60,160
TR 112,17,50688
v_add_f32 v29, v29, v31
MAA 220,44,172
ds_read_b64 v[30:31], v2 offset:2560
s_waitcnt lgkmcnt(7)
v_add_f32 v28, v28, v18
MAA 216,44,168
TR 114,17,51200
v_add_f32 v29, v29, v19
MAA 200,40,168
ds_read_b64 v[18:19], v2 offset:3072
MAA 204,40,172
buffer_load_dwordx4 a[152:155], v11, s[16:19], s52 offen sc1
MAA 188,36,172
TR 116,17,50720
MAA 184,36,168
TR 118,17,51232
MAA 168,32,168
TR 120,17,59136
MAA 172,32,172
TR 122,17,59648
MAA 156,28,172
TR 124,17,59168
s_waitcnt lgkmcnt(7)
v_add_f32 v28, v28, v30
MAA 152,28,168
TR 126,17,59680
v_add_f32 v29, v29, v31
v_mfma_f32_16x16x32_bf16 v[24:27], v[20:23], a[204:207], v[24:27]
ds_read_b64 v[30:31], v2 offset:3584
s_waitcnt lgkmcnt(7)
v_add_f32 v28, v28, v18
MAA 136,24,168
buffer_load_dwordx4 v15, s[32:35], s54 offen offset:3168 lds
MAA 140,24,172
s_add_u32 s54, s54, 229376
v_add_f32 v29, v29, v19
MAA 124,20,172
ds_read_b64 v[18:19], v2 offset:4096
MAA 120,20,168
RD 208,9,50688
MAA 104,16,168
RD 212,9,51744
MAA 108,16,172
RD 216,9,52800
MAA 92,12,172
RD 220,9,53856
MAA 88,12,168
buffer_load_dwordx4 a[156:159], v11, s[16:19], s52 offen offset:1024 sc1
MAA 72,8,168
s_add_u32 s52, s52, 0x20000
s_waitcnt lgkmcnt(5)
v_add_f32 v28, v28, v30
v_add_f32 v29, v29, v31
MAA 76,8,172
ds_read_b64 v[30:31], v2 offset:4608
MAA 60,4,172
s_waitcnt lgkmcnt(5)
v_add_f32 v28, v28, v18
v_add_f32 v29, v29, v19
MAA 56,4,168
ds_read_b64 v[18:19], v2 offset:5120
MAA 40,0,168
MAA 44,0,172
s_waitcnt lgkmcnt(0)
s_barrier
MAA 32,64,176
s_add_u32 m0, s55, 135168
v_add_f32 v28, v28, v30
v_add_f32 v29, v29, v31
MAA 36,64,180
ds_read_b64 v[30:31], v2 offset:5632
v_add_f32 v28, v28, v18
MAA 52,68,180
buffer_load_dwordx4 v12, s[32:35], s54 offen lds
MAA 48,68,176
ds_read_b64_tr_b16 a[0:1], v16
v_add_f32 v29, v29, v19
MAA 64,72,176
ds_read_b64 v[18:19], v2 offset:6144
MAA 68,72,180
TR 2,16,512
v_mfma_f32_16x16x32_bf16 v[24:27], v[20:23], a[208:211], v[24:27]
TR 4,16,32
MAA 84,76,180
TR 6,16,544
MAA 80,76,176
TR 8,16,8448
MAA 96,80,176
buffer_load_dwordx4 a[160:163], v10, s[16:19], s52 offen sc1
MAA 100,80,180
TR 10,16,8960
s_waitcnt lgkmcnt(7)
v_add_f32 v28, v28, v30
MAA 116,84,180
TR 12,16,8480
v_add_f32 v29, v29, v31
MAA 112,84,176
ds_read_b64 v[30:31], v2 offset:6656
s_waitcnt lgkmcnt(7)
v_add_f32 v28, v28, v18
MAA 128,88,176
TR 14,16,8992
v_add_f32 v29, v29, v19
MAA 132,88,180
ds_read_b64 v[18:19], v2 offset:7168
MAA 148,92,180
TR 16,16,64
MAA 144,92,176
buffer_load_dwordx4 v13, s[32:35], s54 offen offset:1056 lds
MAA 160,96,176
TR 18,16,576
MAA 164,96,180
TR 20,16,96
v_mfma_f32_16x16x32_bf16 v[24:27], v[20:23], a[212:215], v[24:27]
TR 22,16,608
MAA 180,100,180
TR 24,16,8512
s_waitcnt lgkmcnt(7)
v_add_f32 v28, v28, v30
MAA 176,100,176
TR 26,16,9024
v_add_f32 v29, v29, v31
MAA 192,104,176
ds_read_b64 v[30:31], v2 offset:7680
s_waitcnt lgkmcnt(7)
v_add_f32 v28, v28, v18
MAA 196,104,180
buffer_load_dwordx4 a[164:167], v10, s[16:19], s52 offen offset:1024 sc1
MAA 212,108,180
TR 28,16,8544
v_add_f32 v29, v29, v19
MAA 208,108,176
TR 30,16,9056
v_lshlrev_b32 v18, 4, v0
MAA 224,112,176
TR 32,16,128
v_add_u32 v18, 152576, v18
MAA 228,112,180
TR 34,16,640
MAA 236,116,180
TR 36,16,160
MAA 232,116,176
TR 38,16,672
MAA 240,120,176
buffer_load_dwordx4 v14, s[32:35], s54 offen offset:2112 lds
MAA 244,120,180
TR 40,16,8576
s_waitcnt lgkmcnt(7)
v_add_f32 v28, v28, v30
v_mfma_f32_16x16x32_bf16 v[24:27], v[20:23], a[216:219], v[24:27]
TR 42,16,9088
v_add_f32 v29, v29, v31
MAA 252,124,180
TR 44,16,8608
v_mul_f32 v28, 0xba800000, v28
MAA 248,124,176
TR 46,16,9120
v_mul_f32 v29, 0x3a800000, v29
MAA 220,108,188
ds_read_b64_tr_b16 a[48:49], v17
v_fma_f32 v29, -v28, v28, v29
MAA 216,108,184
TR 50,17,512
v_max_f32 v29, 0, v29
MAA 200,104,184
buffer_load_dwordx4 a[168:171], v11, s[16:19], s52 offen sc1
MAA 204,104,188
TR 52,17,32
v_add_f32 v29, 0x3727c5ac, v29
MAA 188,100,188
TR 54,17,544
v_rsq_f32 v30, v29
MAA 184,100,184
TR 56,17,8448
v_mul_f32 v30, 0xbfb8aa3b, v30
MAA 168,96,184
ds_write_b128 v18, v[28:31]
MAA 172,96,188
TR 58,17,8960
MAA 156,92,188
TR 60,17,8480
MAA 152,92,184
buffer_load_dwordx4 v15, s[32:35], s54 offen offset:3168 lds
v_mfma_f32_16x16x32_bf16 v[24:27], v[20:23], a[220:223], v[24:27]
s_add_u32 s54, s54, 229376
TR 62,17,8992
MAA 136,88,184
ds_read_b128 a[192:195], v9
MAA 140,88,188
RD 196,9,1056
MAA 124,84,188
RD 200,9,2112
MAA 120,84,184
RD 204,9,3168
MAA 104,80,184
MAA 108,80,188
buffer_load_dwordx4 a[172:175], v11, s[16:19], s52 offen offset:1024 sc1
MAA 92,76,188
s_add_u32 s52, s52, 0x20000
MAA 88,76,184
MAA 72,72,184
MAA 76,72,188
MAA 60,68,188
MAA 56,68,184
MAA 40,64,184
MAA 44,64,188
s_mov_b32 s58, -458752
s_sub_u32 s67, s59, 16896
s_mov_b32 s15, -6
.p2align 6
.Lk42:
s_waitcnt vmcnt(17) lgkmcnt(0)
s_barrier
MAA 32,0,128
TR 64,16,16896
s_add_u32 m0, s55, 84480
MAA 36,0,132
buffer_load_dwordx4 v12, s[32:35], s54 offen lds
MAA 52,4,132
s_sub_u32 s47, s47, 1
s_cbranch_scc1 .Lx43
.Lx43b:
MAA 48,4,128
TR 66,16,17408
MAA 64,8,128
TR 68,16,16928
MAA 68,8,132
TR 70,16,17440
v_mfma_f32_16x16x32_bf16 v[24:27], v[20:23], a[192:195], v[24:27]
MAA 84,12,132
buffer_load_dwordx4 a[176:179], v10, s[16:19], s52 offen sc1
MAA 80,12,128
TR 72,16,25344
MAA 96,16,128
TR 74,16,25856
MAA 100,16,132
TR 76,16,25376
MAA 116,20,132
TR 78,16,25888
MAA 112,20,128
MAA 128,24,128
buffer_load_dwordx4 v13, s[32:35], s54 offen offset:1056 lds
MAA 132,24,132
TR 80,16,16960
MAA 148,28,132
TR 82,16,17472
.Lpad3:
s_cbranch_execz .Lnopoll35r
MAA 144,28,128
TR 84,16,16992
MAA 160,32,128
TR 86,16,17504
MAA 164,32,132
v_mfma_f32_16x16x32_bf16 v[24:27], v[20:23], a[196:199], v[24:27]
TR 88,16,25408
MAA 180,36,132
buffer_load_dwordx4 a[180:183], v10, s[16:19], s52 offen offset:1024 sc1
MAA 176,36,128
TR 90,16,25920
MAA 192,40,128
TR 92,16,25440
MAA 196,40,132
TR 94,16,25952
MAA 212,44,132
MAA 208,44,128
TR 96,16,17024
MAA 224,48,128
buffer_load_dwordx4 v14, s[32:35], s54 offen offset:2112 lds
MAA 228,48,132
TR 98,16,17536
MAA 236,52,132
TR 100,16,17056
MAA 232,52,128
TR 102,16,17568
MAA 240,56,128
MAA 244,56,132
TR 104,16,25472
v_mfma_f32_16x16x32_bf16 v[24:27], v[20:23], a[200:203], v[24:27]
TR 106,16,25984
MAA 252,60,132
buffer_load_dwordx4 a[184:187], v11, s[16:19], s52 offen sc1
MAA 248,60,128
TR 108,16,25504
s_waitcnt vmcnt(22)
MAA 220,44,140
TR 110,16,26016
MAA 216,44,136
MAA 200,40,136
TR 112,17,16896
MAA 204,40,140
TR 114,17,17408
MAA 188,36,140
buffer_load_dwordx4 v15, s[32:35], s54 offen offset:3168 lds
MAA 184,36,136
TR 116,17,16928
s_add_u32 s54, s54, 229376
MAA 168,32,136
TR 118,17,17440
MAA 172,32,140
MAA 156,28,140
TR 120,17,25344
MAA 152,28,136
TR 122,17,25856
v_mfma_f32_16x16x32_bf16 v[24:27], v[20:23], a[204:207], v[24:27]
TR 124,17,25376
MAA 136,24,136
buffer_load_dwordx4 a[188:191], v11, s[16:19], s52 offen offset:1024 sc1
MAA 140,24,140
TR 126,17,25888
s_add_u32 s52, s52, 0x20000
MAA 124,20,140
MAA 120,20,136
RD 208,9,16896
MAA 104,16,136
RD 212,9,17952
MAA 108,16,140
RD 216,9,19008
s_max_i32 m0, s67, s59
MAA 92,12,140
buffer_load_dwordx4 v5, s[28:31], s58 offen lds
MAA 88,12,136
RD 220,9,20064
MAA 72,8,136
MAA 76,8,140
MAA 60,4,140
MAA 56,4,136
MAA 40,0,136
MAA 44,0,140
s_waitcnt vmcnt(18) lgkmcnt(0)
s_barrier
MAA 32,64,144
TR 0,16,33792
s_add_u32 m0, s55, 101376
MAA 36,64,148
buffer_load_dwordx4 v12, s[32:35], s54 offen lds
MAA 52,68,148
s_sub_u32 s47, s47, 1
s_cbranch_scc1 .Lx44
.Lx44b:
MAA 48,68,144
TR 2,16,34304
MAA 64,72,144
TR 4,16,33824
MAA 68,72,148
TR 6,16,34336
v_mfma_f32_16x16x32_bf16 v[24:27], v[20:23], a[208:211], v[24:27]
TR 8,16,42240
MAA 84,76,148
buffer_load_dwordx4 a[128:131], v10, s[16:19], s52 offen sc1
MAA 80,76,144
MAA 96,80,144
TR 10,16,42752
MAA 100,80,148
TR 12,16,42272
MAA 116,84,148
TR 14,16,42784
MAA 112,84,144
TR 16,16,33856
MAA 128,88,144
buffer_load_dwordx4 v13, s[32:35], s54 offen offset:1056 lds
MAA 132,88,148
MAA 148,92,148
TR 18,16,34368
MAA 144,92,144
TR 20,16,33888
MAA 160,96,144
TR 22,16,34400
MAA 164,96,148
TR 24,16,42304
v_mfma_f32_16x16x32_bf16 v[24:27], v[20:23], a[212:215], v[24:27]
TR 26,16,42816
MAA 180,100,148
buffer_load_dwordx4 a[132:135], v10, s[16:19], s52 offen offset:1024 sc1
MAA 176,100,144
MAA 192,104,144
TR 28,16,42336
MAA 196,104,148
TR 30,16,42848
MAA 212,108,148
TR 32,16,33920
MAA 208,108,144
TR 34,16,34432
MAA 224,112,144
buffer_load_dwordx4 v14, s[32:35], s54 offen offset:2112 lds
MAA 228,112,148
MAA 236,116,148
TR 36,16,33952
MAA 232,116,144
TR 38,16,34464
MAA 240,120,144
TR 40,16,42368
MAA 244,120,148
TR 42,16,42880
v_mfma_f32_16x16x32_bf16 v[24:27], v[20:23], a[216:219], v[24:27]
TR 44,16,42400
MAA 252,124,148
buffer_load_dwordx4 a[136:139], v11, s[16:19], s52 offen sc1
MAA 248,124,144
s_waitcnt vmcnt(23)
MAA 220,108,156
TR 46,16,42912
MAA 216,108,152
TR 48,17,33792
MAA 200,104,152
TR 50,17,34304
MAA 204,104,156
TR 52,17,33824
MAA 188,100,156
buffer_load_dwordx4 v15, s[32:35], s54 offen offset:3168 lds
MAA 184,100,152
s_add_u32 s54, s54, 229376
MAA 168,96,152
TR 54,17,34336
MAA 172,96,156
TR 56,17,42240
MAA 156,92,156
TR 58,17,42752
MAA 152,92,152
TR 60,17,42272
v_mfma_f32_16x16x32_bf16 v[24:27], v[20:23], a[220:223], v[24:27]
TR 62,17,42784
MAA 136,88,152
buffer_load_dwordx4 a[140:143], v11, s[16:19], s52 offen offset:1024 sc1
MAA 140,88,156
s_add_u32 s52, s52, 0x20000
MAA 124,84,156
RD 192,9,33792
MAA 120,84,152
RD 196,9,34848
MAA 104,80,152
RD 200,9,35904
MAA 108,80,156
RD 204,9,36960
s_max_i32 m0, s67, s59
MAA 92,76,156
buffer_load_dwordx4 v6, s[28:31], s58 offen offset:1056 lds
MAA 88,76,152
s_add_u32 s67, s67, 8448
s_add_u32 s58, s58, 262144
MAA 72,72,152
MAA 76,72,156
MAA 60,68,156
MAA 56,68,152
MAA 40,64,152
MAA 44,64,156
s_waitcnt vmcnt(19) lgkmcnt(0)
s_barrier
MAA 32,0,160
TR 64,16,50688
s_add_u32 m0, s55, 118272
MAA 36,0,164
buffer_load_dwordx4 v12, s[32:35], s54 offen lds
MAA 52,4,164
s_sub_u32 s47, s47, 1
s_cbranch_scc1 .Lx45
.Lx45b:
MAA 48,4,160
TR 66,16,51200
MAA 64,8,160
TR 68,16,50720
MAA 68,8,164
TR 70,16,51232
v_mfma_f32_16x16x32_bf16 v[24:27], v[20:23], a[192:195], v[24:27]
MAA 84,12,164
buffer_load_dwordx4 a[144:147], v10, s[16:19], s52 offen sc1
MAA 80,12,160
TR 72,16,59136
MAA 96,16,160
TR 74,16,59648
MAA 100,16,164
TR 76,16,59168
MAA 116,20,164
TR 78,16,59680
MAA 112,20,160
MAA 128,24,160
buffer_load_dwordx4 v13, s[32:35], s54 offen offset:1056 lds
MAA 132,24,164
TR 80,16,50752
MAA 148,28,164
TR 82,16,51264
MAA 144,28,160
TR 84,16,50784
MAA 160,32,160
TR 86,16,51296
MAA 164,32,164
v_mfma_f32_16x16x32_bf16 v[24:27], v[20:23], a[196:199], v[24:27]
TR 88,16,59200
MAA 180,36,164
buffer_load_dwordx4 a[148:151], v10, s[16:19], s52 offen offset:1024 sc1
MAA 176,36,160
TR 90,16,59712
MAA 192,40,160
TR 92,16,59232
MAA 196,40,164
TR 94,16,59744
MAA 212,44,164
MAA 208,44,160
TR 96,16,50816
MAA 224,48,160
buffer_load_dwordx4 v14, s[32:35], s54 offen offset:2112 lds
MAA 228,48,164
TR 98,16,51328
MAA 236,52,164
TR 100,16,50848
MAA 232,52,160
TR 102,16,51360
MAA 240,56,160
MAA 244,56,164
TR 104,16,59264
v_mfma_f32_16x16x32_bf16 v[24:27], v[20:23], a[200:203], v[24:27]
TR 106,16,59776
MAA 252,60,164
buffer_load_dwordx4 a[152:155], v11, s[16:19], s52 offen sc1
MAA 248,60,160
TR 108,16,59296
s_waitcnt vmcnt(24)
MAA 220,44,172
TR 110,16,59808
MAA 216,44,168
MAA 200,40,168
TR 112,17,50688
MAA 204,40,172
TR 114,17,51200
MAA 188,36,172
buffer_load_dwordx4 v15, s[32:35], s54 offen offset:3168 lds
MAA 184,36,168
TR 116,17,50720
s_add_u32 s54, s54, 229376
MAA 168,32,168
TR 118,17,51232
MAA 172,32,172
MAA 156,28,172
TR 120,17,59136
MAA 152,28,168
TR 122,17,59648
v_mfma_f32_16x16x32_bf16 v[24:27], v[20:23], a[204:207], v[24:27]
TR 124,17,59168
MAA 136,24,168
buffer_load_dwordx4 a[156:159], v11, s[16:19], s52 offen offset:1024 sc1
MAA 140,24,172
TR 126,17,59680
s_add_u32 s52, s52, 0x20000
MAA 124,20,172
MAA 120,20,168
RD 208,9,50688
MAA 104,16,168
RD 212,9,51744
MAA 108,16,172
RD 216,9,52800
s_max_i32 m0, s67, s59
MAA 92,12,172
buffer_load_dwordx4 v5, s[28:31], s58 offen lds
MAA 88,12,168
RD 220,9,53856
MAA 72,8,168
MAA 76,8,172
MAA 60,4,172
MAA 56,4,168
MAA 40,0,168
MAA 44,0,172
s_waitcnt vmcnt(20) lgkmcnt(0)
s_barrier
MAA 32,64,176
ds_read_b64_tr_b16 a[0:1], v16
s_add_u32 m0, s55, 135168
MAA 36,64,180
buffer_load_dwordx4 v12, s[32:35], s54 offen lds
MAA 52,68,180
s_sub_u32 s47, s47, 1
s_cbranch_scc1 .Lx46
.Lx46b:
MAA 48,68,176
TR 2,16,512
MAA 64,72,176
TR 4,16,32
MAA 68,72,180
TR 6,16,544
v_mfma_f32_16x16x32_bf16 v[24:27], v[20:23], a[208:211], v[24:27]
TR 8,16,8448
MAA 84,76,180
buffer_load_dwordx4 a[160:163], v10, s[16:19], s52 offen sc1
MAA 80,76,176
MAA 96,80,176
TR 10,16,8960
MAA 100,80,180
TR 12,16,8480
MAA 116,84,180
TR 14,16,8992
MAA 112,84,176
TR 16,16,64
MAA 128,88,176
buffer_load_dwordx4 v13, s[32:35], s54 offen offset:1056 lds
MAA 132,88,180
MAA 148,92,180
TR 18,16,576
MAA 144,92,176
TR 20,16,96
MAA 160,96,176
TR 22,16,608
MAA 164,96,180
TR 24,16,8512
v_mfma_f32_16x16x32_bf16 v[24:27], v[20:23], a[212:215], v[24:27]
TR 26,16,9024
MAA 180,100,180
buffer_load_dwordx4 a[164:167], v10, s[16:19], s52 offen offset:1024 sc1
MAA 176,100,176
MAA 192,104,176
TR 28,16,8544
MAA 196,104,180
TR 30,16,9056
MAA 212,108,180
TR 32,16,128
MAA 208,108,176
TR 34,16,640
MAA 224,112,176
buffer_load_dwordx4 v14, s[32:35], s54 offen offset:2112 lds
MAA 228,112,180
MAA 236,116,180
TR 36,16,160
MAA 232,116,176
TR 38,16,672
MAA 240,120,176
TR 40,16,8576
MAA 244,120,180
TR 42,16,9088
v_mfma_f32_16x16x32_bf16 v[24:27], v[20:23], a[216:219], v[24:27]
TR 44,16,8608
MAA 252,124,180
buffer_load_dwordx4 a[168:171], v11, s[16:19], s52 offen sc1
MAA 248,124,176
s_waitcnt vmcnt(25)
MAA 220,108,188
TR 46,16,9120
MAA 216,108,184
ds_read_b64_tr_b16 a[48:49], v17
MAA 200,104,184
TR 50,17,512
MAA 204,104,188
TR 52,17,32
MAA 188,100,188
buffer_load_dwordx4 v15, s[32:35], s54 offen offset:3168 lds
MAA 184,100,184
s_add_u32 s54, s54, 229376
MAA 168,96,184
TR 54,17,544
MAA 172,96,188
TR 56,17,8448
MAA 156,92,188
TR 58,17,8960
MAA 152,92,184
TR 60,17,8480
v_mfma_f32_16x16x32_bf16 v[24:27], v[20:23], a[220:223], v[24:27]
TR 62,17,8992
MAA 136,88,184
buffer_load_dwordx4 a[172:175], v11, s[16:19], s52 offen offset:1024 sc1
MAA 140,88,188
s_add_u32 s52, s52, 0x20000
MAA 124,84,188
ds_read_b128 a[192:195], v9
MAA 120,84,184
RD 196,9,1056
MAA 104,80,184
RD 200,9,2112
MAA 108,80,188
RD 204,9,3168
s_max_i32 m0, s67, s59
MAA 92,76,188
buffer_load_dwordx4 v6, s[28:31], s58 offen offset:1056 lds
MAA 88,76,184
s_add_u32 s67, s67, 8448
s_add_u32 s58, s58, 196608
MAA 72,72,184
MAA 76,72,188
MAA 60,68,188
MAA 56,68,184
MAA 40,64,184
s_add_u32 s15, s15, 1
MAA 44,64,188
s_cbranch_scc0 .Lk42
s_branch .Lj47
.Lx43:
buffer_load_dword v4, v8, s[32:35], s45 offen
buffer_load_dword v4, v7, s[28:31], s44 offen
s_add_u32 s44, s44, 655360
s_add_u32 s45, s45, 917504
s_mov_b32 s47, 3
s_branch .Lx43b
.Lx44:
buffer_load_dword v4, v8, s[32:35], s45 offen
buffer_load_dword v4, v7, s[28:31], s44 offen
s_add_u32 s44, s44, 655360
s_add_u32 s45, s45, 917504
s_mov_b32 s47, 3
s_branch .Lx44b
.Lx45:
buffer_load_dword v4, v8, s[32:35], s45 offen
buffer_load_dword v4, v7, s[28:31], s44 offen
s_add_u32 s44, s44, 655360
s_add_u32 s45, s45, 917504
s_mov_b32 s47, 3
s_branch .Lx45b
.Lx46:
buffer_load_dword v4, v8, s[32:35], s45 offen
buffer_load_dword v4, v7, s[28:31], s44 offen
s_add_u32 s44, s44, 655360
s_add_u32 s45, s45, 917504
s_mov_b32 s47, 3
s_branch .Lx46b
.Lj47:
s_waitcnt vmcnt(11) lgkmcnt(0)
s_barrier
v_mfma_f32_16x16x32_bf16 v[24:27], v[20:23], a[192:195], v[24:27]
buffer_load_dwordx4 a[176:179], v10, s[16:19], s52 offen sc1
v_mfma_f32_16x16x32_bf16 v[24:27], v[20:23], a[196:199], v[24:27]
TR 64,16,16896
v_mov_b32 v18, v5
v_mfma_f32_16x16x32_bf16 v[24:27], v[20:23], a[200:203], v[24:27]
TR 66,16,17408
v_mov_b32 v19, v6
v_mfma_f32_16x16x32_bf16 v[24:27], v[20:23], a[204:207], v[24:27]
TR 68,16,16928
s_lshl_b32 s74, s48, 10
MAA 32,0,128
buffer_load_dwordx4 a[180:183], v10, s[16:19], s52 offen offset:1024 sc1
MAA 48,4,128
TR 70,16,17440
s_lshl_b32 s75, s49, 9
MAA 64,8,128
TR 72,16,25344
s_add_u32 s74, s74, s75
MAA 80,12,128
TR 74,16,25856
s_add_u32 s74, s74, 159488
MAA 36,0,132
buffer_load_dwordx4 a[184:187], v11, s[16:19], s52 offen sc1
MAA 52,4,132
TR 76,16,25376
v_bfe_u32 v2, v1, 4, 1
MAA 68,8,132
TR 78,16,25888
s_lshl_b32 s75, s12, 9
MAA 84,12,132
TR 80,16,33792
s_mov_b32 s58, 2293760
MAA 40,0,136
buffer_load_dwordx4 a[188:191], v11, s[16:19], s52 offen offset:1024 sc1
MAA 56,4,136
s_add_u32 s52, s52, 0x20000
TR 82,16,34304
MAA 72,8,136
TR 84,16,33824
s_mov_b32 s54, 65536
MAA 88,12,136
TR 86,16,34336
s_mul_i32 s55, s3, 2112
MAA 44,0,140
TR 88,16,42240
s_mov_b32 s57, 67584
MAA 60,4,140
TR 90,16,42752
MAA 76,8,140
TR 92,16,42272
MAA 92,12,140
TR 94,16,42784
MAA 96,16,128
TR 112,16,16960
MAA 112,20,128
TR 114,16,17472
MAA 128,24,128
TR 116,16,16992
MAA 144,28,128
TR 118,16,17504
MAA 100,16,132
TR 120,16,25408
MAA 116,20,132
TR 122,16,25920
MAA 132,24,132
TR 124,16,25440
MAA 148,28,132
TR 126,16,25952
MAA 104,16,136
RD 208,9,16896
MAA 120,20,136
RD 212,9,17952
MAA 136,24,136
RD 216,9,19008
MAA 152,28,136
.Lpad4:
s_cbranch_execz .Lnopoll35r
RD 220,9,20064
MAA 108,16,140
RD 192,9,33792
MAA 124,20,140
RD 196,9,34848
MAA 140,24,140
RD 200,9,35904
MAA 156,28,140
RD 204,9,36960
MAA 160,32,128
TR 0,16,17024
s_waitcnt lgkmcnt(8)
v_mfma_f32_16x16x32_bf16 v[24:27], v[20:23], a[208:211], v[24:27]
TR 2,16,17536
s_waitcnt vmcnt(6)
s_barrier
s_waitcnt lgkmcnt(8)
v_mfma_f32_16x16x32_bf16 v[24:27], v[20:23], a[212:215], v[24:27]
TR 96,16,50688
s_waitcnt lgkmcnt(8)
v_mfma_f32_16x16x32_bf16 v[24:27], v[20:23], a[216:219], v[24:27]
TR 98,16,51200
s_waitcnt lgkmcnt(8)
v_mfma_f32_16x16x32_bf16 v[24:27], v[20:23], a[220:223], v[24:27]
TR 100,16,50720
s_waitcnt lgkmcnt(8)
v_mfma_f32_16x16x32_bf16 v[24:27], v[20:23], a[192:195], v[24:27]
TR 102,16,51232
s_waitcnt lgkmcnt(8)
v_mfma_f32_16x16x32_bf16 v[24:27], v[20:23], a[196:199], v[24:27]
TR 104,16,59136
s_waitcnt lgkmcnt(8)
v_mfma_f32_16x16x32_bf16 v[24:27], v[20:23], a[200:203], v[24:27]
TR 106,16,59648
s_waitcnt lgkmcnt(8)
v_mfma_f32_16x16x32_bf16 v[24:27], v[20:23], a[204:207], v[24:27]
TR 108,16,59168
MAA 176,36,128
TR 110,16,59680
MAA 192,40,128
RD 208,9,50688
MAA 208,44,128
RD 212,9,51744
MAA 164,32,132
RD 216,9,52800
MAA 180,36,132
RD 220,9,53856
v_and_b32 v9, 15, v1
MAA 196,40,132
TR 192,16,33856
v_lshl_add_u32 v9, v9, 5, s74
MAA 212,44,132
s_lshl_b32 s74, s3, 10
v_lshl_add_u32 v9, v2, 4, v9
v_bfe_u32 v2, v1, 5, 1
MAA 168,32,136
s_add_u32 s74, s74, s75
v_mul_u32_u24 v2, 2816, v2
v_sub_u32 v9, v9, v2
MAA 184,36,136
s_add_u32 s74, s74, 152576
v_and_b32 v2, 15, v1
v_lshl_add_u32 v2, v2, 4, s74
MAA 200,40,136
ds_read_b32 v28, v2 offset:8
v_xor_b32 v8, 512, v2
s_waitcnt lgkmcnt(5)
v_mfma_f32_16x16x32_bf16 v[24:27], v[20:23], a[208:211], v[24:27]
ds_read_b32 v29, v2 offset:264
s_lshl_b32 s74, s12, 7
s_waitcnt lgkmcnt(5)
v_mfma_f32_16x16x32_bf16 v[24:27], v[20:23], a[212:215], v[24:27]
ds_read_b32 v30, v8 offset:8
s_add_u32 s74, s74, 161536
s_waitcnt lgkmcnt(5)
v_mfma_f32_16x16x32_bf16 v[24:27], v[20:23], a[216:219], v[24:27]
ds_read_b32 v31, v8 offset:264
s_xor_b32 s75, s12, 1
s_waitcnt lgkmcnt(5)
v_mfma_f32_16x16x32_bf16 v[24:27], v[20:23], a[220:223], v[24:27]
s_mul_i32 s75, s75, 384
s_add_u32 s75, s75, 161536
MAA 216,44,136
TR 194,16,34368
MAA 172,32,140
s_nop 2
ds_write_b128 v9, v[24:27]
v_lshlrev_b32 v9, 4, v1
MAA 188,36,140
TR 196,16,33888
v_add_u32 v9, 159488, v9
MAA 204,40,140
TR 198,16,34400
MAA 220,44,140
TR 200,16,42304
MAA 224,48,128
TR 202,16,42816
MAA 232,52,128
TR 204,16,42336
MAA 240,56,128
TR 206,16,42848
MAA 248,60,128
TR 208,16,50752
MAA 228,48,132
s_waitcnt lgkmcnt(7)
s_barrier
ds_read_b128 v[20:23], v9
MAA 236,52,132
ds_read_b128 v[24:27], v9 offset:1024
MAA 244,56,132
TR 210,16,51264
MAA 252,60,132
TR 212,16,50784
MAA 32,64,144
TR 214,16,51296
MAA 48,68,144
TR 216,16,59200
MAA 64,72,144
TR 218,16,59712
MAA 80,76,144
TR 220,16,59232
MAA 32,80,160
TR 222,16,59744
MAA 48,84,160
TR 4,16,17056
s_waitcnt lgkmcnt(8)
v_add_f32 v20, v20, v24
MAA 64,88,160
TR 6,16,17568
v_add_f32 v21, v21, v25
MAA 80,92,160
ds_read_b64 v[24:25], v8
v_add_f32 v22, v22, v26
s_waitcnt vmcnt(3)
MAA 32,96,176
TR 8,16,25472
v_add_f32 v23, v23, v27
MAA 48,100,176
ds_write_b128 v9, v[20:23] offset:2048
v_lshrrev_b32 v9, 4, v1
MAA 64,104,176
ds_read_b64 v[20:21], v2
v_lshlrev_b32 v9, 4, v9
MAA 80,108,176
ds_read_b64 v[22:23], v2 offset:256
ds_read_b64 v[26:27], v8 offset:256
v_add_u32 v8, s75, v9
v_add_u32 v9, s74, v9
ds_read_b128 v[12:15], v9
ds_read_b128 v[4:7], v9 offset:64
s_lshl_b32 s74, s6, 13
s_lshl_b32 s75, s3, 11
s_add_u32 s74, s74, s75
v_lshrrev_b32 v2, 3, v1
v_cmp_eq_u32 vcc, 3, v2
TR 10,16,25984
TR 12,16,25504
TR 14,16,26016
TR 16,16,33920
TR 18,16,34432
TR 20,16,33952
TR 22,16,34464
TR 24,16,42368
TR 26,16,42880
TR 28,16,42400
TR 30,16,42912
TR 32,16,50816
s_waitcnt lgkmcnt(13)
v_pk_fma_f32 v[32:33], v[12:13], v[20:21], v[32:33] op_sel_hi:[1,0,1]
v_pk_fma_f32 v[34:35], v[14:15], v[20:21], v[34:35] op_sel_hi:[1,0,1]
v_pk_fma_f32 v[36:37], v[12:13], v[22:23], v[36:37] op_sel_hi:[1,0,1]
v_pk_fma_f32 v[38:39], v[14:15], v[22:23], v[38:39] op_sel_hi:[1,0,1]
v_pk_fma_f32 v[40:41], v[12:13], v[24:25], v[40:41] op_sel_hi:[1,0,1]
v_pk_fma_f32 v[42:43], v[14:15], v[24:25], v[42:43] op_sel_hi:[1,0,1]
v_pk_fma_f32 v[44:45], v[12:13], v[26:27], v[44:45] op_sel_hi:[1,0,1]
v_pk_fma_f32 v[46:47], v[14:15], v[26:27], v[46:47] op_sel_hi:[1,0,1]
ds_read_b128 v[12:15], v9 offset:512
s_waitcnt lgkmcnt(13)
v_pk_fma_f32 v[48:49], v[4:5], v[20:21], v[48:49] op_sel_hi:[1,0,1]
v_pk_fma_f32 v[50:51], v[6:7], v[20:21], v[50:51] op_sel_hi:[1,0,1]
v_pk_fma_f32 v[52:53], v[4:5], v[22:23], v[52:53] op_sel_hi:[1,0,1]
v_pk_fma_f32 v[54:55], v[6:7], v[22:23], v[54:55] op_sel_hi:[1,0,1]
v_pk_fma_f32 v[56:57], v[4:5], v[24:25], v[56:57] op_sel_hi:[1,0,1]
v_pk_fma_f32 v[58:59], v[6:7], v[24:25], v[58:59] op_sel_hi:[1,0,1]
v_pk_fma_f32 v[60:61], v[4:5], v[26:27], v[60:61] op_sel_hi:[1,0,1]
v_pk_fma_f32 v[62:63], v[6:7], v[26:27], v[62:63] op_sel_hi:[1,0,1]
ds_read_b128 v[4:7], v9 offset:576
TR 34,16,51328
TR 36,16,50848
TR 38,16,51360
TR 40,16,59264
TR 42,16,59776
TR 44,16,59296
TR 46,16,59808
TR 48,17,16896
TR 50,17,17408
TR 52,17,16928
s_waitcnt lgkmcnt(11)
v_pk_fma_f32 v[64:65], v[12:13], v[20:21], v[64:65] op_sel_hi:[1,0,1]
v_pk_fma_f32 v[66:67], v[14:15], v[20:21], v[66:67] op_sel_hi:[1,0,1]
v_pk_fma_f32 v[68:69], v[12:13], v[22:23], v[68:69] op_sel_hi:[1,0,1]
v_pk_fma_f32 v[70:71], v[14:15], v[22:23], v[70:71] op_sel_hi:[1,0,1]
v_pk_fma_f32 v[72:73], v[12:13], v[24:25], v[72:73] op_sel_hi:[1,0,1]
v_pk_fma_f32 v[74:75], v[14:15], v[24:25], v[74:75] op_sel_hi:[1,0,1]
v_pk_fma_f32 v[76:77], v[12:13], v[26:27], v[76:77] op_sel_hi:[1,0,1]
v_pk_fma_f32 v[78:79], v[14:15], v[26:27], v[78:79] op_sel_hi:[1,0,1]
ds_read_b128 v[12:15], v9 offset:832
s_waitcnt lgkmcnt(11)
v_pk_fma_f32 v[80:81], v[4:5], v[20:21], v[80:81] op_sel_hi:[1,0,1]
v_pk_fma_f32 v[82:83], v[6:7], v[20:21], v[82:83] op_sel_hi:[1,0,1]
v_pk_fma_f32 v[84:85], v[4:5], v[22:23], v[84:85] op_sel_hi:[1,0,1]
v_pk_fma_f32 v[86:87], v[6:7], v[22:23], v[86:87] op_sel_hi:[1,0,1]
v_pk_fma_f32 v[88:89], v[4:5], v[24:25], v[88:89] op_sel_hi:[1,0,1]
v_pk_fma_f32 v[90:91], v[6:7], v[24:25], v[90:91] op_sel_hi:[1,0,1]
v_pk_fma_f32 v[92:93], v[4:5], v[26:27], v[92:93] op_sel_hi:[1,0,1]
v_pk_fma_f32 v[94:95], v[6:7], v[26:27], v[94:95] op_sel_hi:[1,0,1]
ds_read_b128 v[4:7], v9 offset:704
v_pk_mul_f32 v[64:65], v[64:65], v[32:33]
v_pk_mul_f32 v[32:33], v[32:33], v[28:29] op_sel_hi:[1,0]
v_pk_mul_f32 v[66:67], v[66:67], v[34:35]
v_pk_mul_f32 v[34:35], v[34:35], v[28:29] op_sel_hi:[1,0]
v_pk_mul_f32 v[80:81], v[80:81], v[48:49]
v_pk_mul_f32 v[48:49], v[48:49], v[28:29] op_sel_hi:[1,0]
v_pk_mul_f32 v[82:83], v[82:83], v[50:51]
v_pk_mul_f32 v[50:51], v[50:51], v[28:29] op_sel_hi:[1,0]
v_exp_f32 v32, v32
s_nop 0
MAA 36,64,148
TR 54,17,17440
v_exp_f32 v33, v33
MAA 52,68,148
TR 56,17,25344
v_exp_f32 v34, v34
MAA 68,72,148
TR 58,17,25856
v_exp_f32 v35, v35
MAA 84,76,148
TR 60,17,25376
v_exp_f32 v48, v48
MAA 36,80,164
TR 62,17,25888
v_exp_f32 v49, v49
MAA 52,84,164
v_exp_f32 v50, v50
MAA 68,88,164
v_exp_f32 v51, v51
MAA 84,92,164
s_waitcnt vmcnt(2)
MAA 36,96,180
MAA 52,100,180
MAA 68,104,180
MAA 84,108,180
s_nop 6
v_pk_mul_f32 v[68:69], v[68:69], v[36:37]
v_pk_mul_f32 v[36:37], v[36:37], v[28:29] op_sel:[0,1] op_sel_hi:[1,1]
v_pk_mul_f32 v[70:71], v[70:71], v[38:39]
v_pk_mul_f32 v[38:39], v[38:39], v[28:29] op_sel:[0,1] op_sel_hi:[1,1]
v_pk_mul_f32 v[84:85], v[84:85], v[52:53]
v_pk_mul_f32 v[52:53], v[52:53], v[28:29] op_sel:[0,1] op_sel_hi:[1,1]
v_pk_mul_f32 v[86:87], v[86:87], v[54:55]
v_pk_mul_f32 v[54:55], v[54:55], v[28:29] op_sel:[0,1] op_sel_hi:[1,1]
v_pk_fma_f32 v[32:33], v[32:33], v[20:21], v[20:21] op_sel:[0,1,1] op_sel_hi:[1,1,1]
v_pk_fma_f32 v[34:35], v[34:35], v[20:21], v[20:21] op_sel:[0,1,1] op_sel_hi:[1,1,1]
v_pk_fma_f32 v[48:49], v[48:49], v[20:21], v[20:21] op_sel:[0,1,1] op_sel_hi:[1,1,1]
v_pk_fma_f32 v[50:51], v[50:51], v[20:21], v[20:21] op_sel:[0,1,1] op_sel_hi:[1,1,1]
v_rcp_f32 v32, v32
s_nop 0
MAA 40,64,152
v_rcp_f32 v33, v33
MAA 56,68,152
v_rcp_f32 v34, v34
MAA 72,72,152
v_rcp_f32 v35, v35
MAA 88,76,152
v_rcp_f32 v48, v48
MAA 40,80,168
v_rcp_f32 v49, v49
MAA 56,84,168
v_rcp_f32 v50, v50
MAA 72,88,168
v_rcp_f32 v51, v51
MAA 88,92,168
v_exp_f32 v36, v36
s_waitcnt vmcnt(1)
MAA 40,96,184
v_exp_f32 v37, v37
MAA 56,100,184
v_exp_f32 v38, v38
MAA 72,104,184
v_exp_f32 v39, v39
MAA 88,108,184
v_exp_f32 v52, v52
v_exp_f32 v53, v53
v_exp_f32 v54, v54
v_exp_f32 v55, v55
v_pk_mul_f32 v[64:65], v[64:65], v[32:33]
v_pk_mul_f32 v[66:67], v[66:67], v[34:35]
v_pk_mul_f32 v[80:81], v[80:81], v[48:49]
v_pk_mul_f32 v[82:83], v[82:83], v[50:51]
ds_read_b128 v[48:51], v9 offset:128
v_pk_mul_f32 v[72:73], v[72:73], v[40:41]
v_pk_mul_f32 v[40:41], v[40:41], v[30:31] op_sel_hi:[1,0]
v_pk_mul_f32 v[74:75], v[74:75], v[42:43]
v_pk_mul_f32 v[42:43], v[42:43], v[30:31] op_sel_hi:[1,0]
v_pk_mul_f32 v[88:89], v[88:89], v[56:57]
v_pk_mul_f32 v[56:57], v[56:57], v[30:31] op_sel_hi:[1,0]
v_pk_mul_f32 v[90:91], v[90:91], v[58:59]
v_pk_mul_f32 v[58:59], v[58:59], v[30:31] op_sel_hi:[1,0]
v_pk_fma_f32 v[36:37], v[36:37], v[22:23], v[22:23] op_sel:[0,1,1] op_sel_hi:[1,1,1]
v_pk_fma_f32 v[38:39], v[38:39], v[22:23], v[22:23] op_sel:[0,1,1] op_sel_hi:[1,1,1]
v_pk_fma_f32 v[52:53], v[52:53], v[22:23], v[22:23] op_sel:[0,1,1] op_sel_hi:[1,1,1]
v_pk_fma_f32 v[54:55], v[54:55], v[22:23], v[22:23] op_sel:[0,1,1] op_sel_hi:[1,1,1]
v_cvt_pk_bf16_f32 v32, v64, v65
v_cvt_pk_bf16_f32 v33, v66, v67
ds_read_b128 v[64:67], v9 offset:192
v_cvt_pk_bf16_f32 v34, v80, v81
v_cvt_pk_bf16_f32 v35, v82, v83
MAA 44,64,156
buffer_store_dwordx4 v[32:35], v10, s[16:19], s62 offen sc1
MAA 60,68,156
ds_read_b128 v[80:83], v9 offset:640
v_rcp_f32 v36, v36
MAA 76,72,156
TR 64,17,33792
v_rcp_f32 v37, v37
MAA 92,76,156
TR 66,17,34304
v_rcp_f32 v38, v38
MAA 44,80,172
TR 68,17,33824
v_rcp_f32 v39, v39
MAA 60,84,172
TR 70,17,34336
v_rcp_f32 v52, v52
MAA 76,88,172
TR 72,17,42240
v_rcp_f32 v53, v53
MAA 92,92,172
TR 74,17,42752
v_rcp_f32 v54, v54
s_waitcnt vmcnt(1)
MAA 44,96,188
TR 76,17,42272
v_rcp_f32 v55, v55
MAA 60,100,188
TR 78,17,42784
v_exp_f32 v40, v40
MAA 76,104,188
TR 80,17,50688
v_exp_f32 v41, v41
MAA 92,108,188
TR 82,17,51200
v_exp_f32 v42, v42
v_exp_f32 v43, v43
v_exp_f32 v56, v56
v_exp_f32 v57, v57
v_exp_f32 v58, v58
v_exp_f32 v59, v59
v_pk_mul_f32 v[68:69], v[68:69], v[36:37]
v_pk_mul_f32 v[70:71], v[70:71], v[38:39]
v_pk_mul_f32 v[84:85], v[84:85], v[52:53]
v_pk_mul_f32 v[86:87], v[86:87], v[54:55]
ds_read_b128 v[52:55], v8 offset:576
v_pk_mul_f32 v[76:77], v[76:77], v[44:45]
v_pk_mul_f32 v[44:45], v[44:45], v[30:31] op_sel:[0,1] op_sel_hi:[1,1]
v_pk_mul_f32 v[78:79], v[78:79], v[46:47]
v_pk_mul_f32 v[46:47], v[46:47], v[30:31] op_sel:[0,1] op_sel_hi:[1,1]
v_pk_mul_f32 v[92:93], v[92:93], v[60:61]
v_pk_mul_f32 v[60:61], v[60:61], v[30:31] op_sel:[0,1] op_sel_hi:[1,1]
v_pk_mul_f32 v[94:95], v[94:95], v[62:63]
v_pk_mul_f32 v[62:63], v[62:63], v[30:31] op_sel:[0,1] op_sel_hi:[1,1]
v_pk_fma_f32 v[40:41], v[40:41], v[24:25], v[24:25] op_sel:[0,1,1] op_sel_hi:[1,1,1]
v_pk_fma_f32 v[42:43], v[42:43], v[24:25], v[24:25] op_sel:[0,1,1] op_sel_hi:[1,1,1]
v_pk_fma_f32 v[56:57], v[56:57], v[24:25], v[24:25] op_sel:[0,1,1] op_sel_hi:[1,1,1]
v_pk_fma_f32 v[58:59], v[58:59], v[24:25], v[24:25] op_sel:[0,1,1] op_sel_hi:[1,1,1]
v_cvt_pk_bf16_f32 v36, v68, v69
v_cvt_pk_bf16_f32 v37, v70, v71
v_cvt_pk_bf16_f32 v38, v84, v85
v_cvt_pk_bf16_f32 v39, v86, v87
MAA 96,112,144
buffer_store_dwordx4 v[36:39], v10, s[16:19], s62 offen offset:1024 sc1
MAA 112,116,144
TR 84,17,50720
v_rcp_f32 v40, v40
MAA 128,120,144
TR 86,17,51232
v_rcp_f32 v41, v41
MAA 144,124,144
TR 88,17,59136
v_rcp_f32 v42, v42
MAA 96,192,160
TR 90,17,59648
v_rcp_f32 v43, v43
MAA 112,196,160
TR 92,17,59168
v_rcp_f32 v56, v56
MAA 128,200,160
TR 94,17,59680
v_rcp_f32 v57, v57
MAA 144,204,160
v_rcp_f32 v58, v58
MAA 96,208,176
v_rcp_f32 v59, v59
MAA 112,212,176
v_exp_f32 v44, v44
MAA 128,216,176
v_exp_f32 v45, v45
MAA 144,220,176
v_lshrrev_b32 v69, 2, v0
v_min_u32 v69, 1, v69
v_lshlrev_b32 v69, 28, v69
v_lshl_add_u32 v68, v0, 7, v69
v_xor_b32 v69, 64, v0
v_min_u32 v69, 1, v69
v_lshlrev_b32 v70, 4, v69
v_sub_u32 v70, 16, v70
v_lshlrev_b32 v69, 28, v69
v_mov_b32 v71, 1
s_waitcnt lgkmcnt(0)
s_barrier
v_mov_b32 v84, 0
v_exp_f32 v46, v46
v_exp_f32 v47, v47
v_exp_f32 v60, v60
v_exp_f32 v61, v61
v_exp_f32 v62, v62
v_exp_f32 v63, v63
v_pk_mul_f32 v[72:73], v[72:73], v[40:41]
v_pk_mul_f32 v[74:75], v[74:75], v[42:43]
v_pk_mul_f32 v[88:89], v[88:89], v[56:57]
v_pk_mul_f32 v[90:91], v[90:91], v[58:59]
v_pk_fma_f32 v[96:97], v[48:49], v[20:21], v[96:97] op_sel_hi:[1,0,1]
v_pk_fma_f32 v[98:99], v[50:51], v[20:21], v[98:99] op_sel_hi:[1,0,1]
v_pk_fma_f32 v[112:113], v[64:65], v[20:21], v[112:113] op_sel_hi:[1,0,1]
v_pk_fma_f32 v[114:115], v[66:67], v[20:21], v[114:115] op_sel_hi:[1,0,1]
v_pk_fma_f32 v[128:129], v[80:81], v[20:21], v[128:129] op_sel_hi:[1,0,1]
v_pk_fma_f32 v[130:131], v[82:83], v[20:21], v[130:131] op_sel_hi:[1,0,1]
v_pk_fma_f32 v[144:145], v[4:5], v[20:21], v[144:145] op_sel_hi:[1,0,1]
v_pk_fma_f32 v[146:147], v[6:7], v[20:21], v[146:147] op_sel_hi:[1,0,1]
v_pk_mul_f32 v[128:129], v[128:129], v[96:97]
v_pk_mul_f32 v[96:97], v[96:97], v[28:29] op_sel_hi:[1,0]
v_pk_mul_f32 v[130:131], v[130:131], v[98:99]
v_pk_mul_f32 v[98:99], v[98:99], v[28:29] op_sel_hi:[1,0]
v_pk_mul_f32 v[144:145], v[144:145], v[112:113]
v_pk_mul_f32 v[112:113], v[112:113], v[28:29] op_sel_hi:[1,0]
v_pk_mul_f32 v[146:147], v[146:147], v[114:115]
v_pk_mul_f32 v[114:115], v[114:115], v[28:29] op_sel_hi:[1,0]
v_pk_fma_f32 v[44:45], v[44:45], v[26:27], v[26:27] op_sel:[0,1,1] op_sel_hi:[1,1,1]
v_pk_fma_f32 v[46:47], v[46:47], v[26:27], v[26:27] op_sel:[0,1,1] op_sel_hi:[1,1,1]
v_pk_fma_f32 v[60:61], v[60:61], v[26:27], v[26:27] op_sel:[0,1,1] op_sel_hi:[1,1,1]
v_pk_fma_f32 v[62:63], v[62:63], v[26:27], v[26:27] op_sel:[0,1,1] op_sel_hi:[1,1,1]
v_cvt_pk_bf16_f32 v40, v72, v73
v_cvt_pk_bf16_f32 v41, v74, v75
v_cvt_pk_bf16_f32 v42, v88, v89
v_cvt_pk_bf16_f32 v43, v90, v91
MAA 100,112,148
buffer_store_dwordx4 v[40:43], v11, s[16:19], s62 offen sc1
MAA 116,116,148
s_add_u32 m0, s59, 84480
v_rcp_f32 v44, v44
MAA 132,120,148
v_rcp_f32 v45, v45
MAA 148,124,148
v_rcp_f32 v46, v46
MAA 100,192,164
buffer_load_dwordx4 v18, s[28:31], s58 offen lds
MAA 116,196,164
v_rcp_f32 v47, v47
MAA 132,200,164
v_rcp_f32 v60, v60
MAA 148,204,164
v_rcp_f32 v61, v61
MAA 100,208,180
buffer_load_dwordx4 v19, s[28:31], s58 offen offset:1056 lds
MAA 116,212,180
s_add_u32 m0, s59, 92928
s_mov_b32 s58, 2555904
v_rcp_f32 v62, v62
MAA 132,216,180
v_rcp_f32 v63, v63
MAA 148,220,180
v_exp_f32 v96, v96
v_exp_f32 v97, v97
v_exp_f32 v98, v98
v_exp_f32 v99, v99
v_exp_f32 v112, v112
v_exp_f32 v113, v113
v_exp_f32 v114, v114
v_exp_f32 v115, v115
v_pk_mul_f32 v[76:77], v[76:77], v[44:45]
v_pk_mul_f32 v[78:79], v[78:79], v[46:47]
v_pk_mul_f32 v[92:93], v[92:93], v[60:61]
v_pk_mul_f32 v[94:95], v[94:95], v[62:63]
v_pk_fma_f32 v[100:101], v[48:49], v[22:23], v[100:101] op_sel_hi:[1,0,1]
v_pk_fma_f32 v[102:103], v[50:51], v[22:23], v[102:103] op_sel_hi:[1,0,1]
v_pk_fma_f32 v[116:117], v[64:65], v[22:23], v[116:117] op_sel_hi:[1,0,1]
v_pk_fma_f32 v[118:119], v[66:67], v[22:23], v[118:119] op_sel_hi:[1,0,1]
v_pk_fma_f32 v[132:133], v[80:81], v[22:23], v[132:133] op_sel_hi:[1,0,1]
v_pk_fma_f32 v[134:135], v[82:83], v[22:23], v[134:135] op_sel_hi:[1,0,1]
v_pk_fma_f32 v[148:149], v[4:5], v[22:23], v[148:149] op_sel_hi:[1,0,1]
v_pk_fma_f32 v[150:151], v[6:7], v[22:23], v[150:151] op_sel_hi:[1,0,1]
v_pk_mul_f32 v[132:133], v[132:133], v[100:101]
v_pk_mul_f32 v[100:101], v[100:101], v[28:29] op_sel:[0,1] op_sel_hi:[1,1]
v_pk_mul_f32 v[134:135], v[134:135], v[102:103]
v_pk_mul_f32 v[102:103], v[102:103], v[28:29] op_sel:[0,1] op_sel_hi:[1,1]
v_pk_mul_f32 v[148:149], v[148:149], v[116:117]
v_pk_mul_f32 v[116:117], v[116:117], v[28:29] op_sel:[0,1] op_sel_hi:[1,1]
v_pk_mul_f32 v[150:151], v[150:151], v[118:119]
v_pk_mul_f32 v[118:119], v[118:119], v[28:29] op_sel:[0,1] op_sel_hi:[1,1]
v_pk_fma_f32 v[96:97], v[96:97], v[20:21], v[20:21] op_sel:[0,1,1] op_sel_hi:[1,1,1]
v_pk_fma_f32 v[98:99], v[98:99], v[20:21], v[20:21] op_sel:[0,1,1] op_sel_hi:[1,1,1]
v_pk_fma_f32 v[112:113], v[112:113], v[20:21], v[20:21] op_sel:[0,1,1] op_sel_hi:[1,1,1]
v_pk_fma_f32 v[114:115], v[114:115], v[20:21], v[20:21] op_sel:[0,1,1] op_sel_hi:[1,1,1]
v_cvt_pk_bf16_f32 v44, v76, v77
v_cvt_pk_bf16_f32 v45, v78, v79
v_cvt_pk_bf16_f32 v46, v92, v93
v_cvt_pk_bf16_f32 v47, v94, v95
MAA 104,112,152
buffer_store_dwordx4 v[44:47], v11, s[16:19], s62 offen offset:1024 sc1
MAA 120,116,152
v_rcp_f32 v96, v96
MAA 136,120,152
v_rcp_f32 v97, v97
MAA 152,124,152
v_rcp_f32 v98, v98
MAA 104,192,168
buffer_load_dwordx4 v18, s[28:31], s58 offen lds
MAA 120,196,168
v_rcp_f32 v99, v99
MAA 136,200,168
v_rcp_f32 v112, v112
MAA 152,204,168
v_rcp_f32 v113, v113
MAA 104,208,184
buffer_load_dwordx4 v19, s[28:31], s58 offen offset:1056 lds
MAA 120,212,184
s_add_u32 m0, s59, 101376
s_mov_b32 s58, 2752512
v_rcp_f32 v114, v114
MAA 136,216,184
v_rcp_f32 v115, v115
MAA 152,220,184
v_exp_f32 v100, v100
v_exp_f32 v101, v101
v_exp_f32 v102, v102
v_exp_f32 v103, v103
v_exp_f32 v116, v116
v_exp_f32 v117, v117
v_exp_f32 v118, v118
v_exp_f32 v119, v119
v_pk_mul_f32 v[128:129], v[128:129], v[96:97]
v_pk_mul_f32 v[130:131], v[130:131], v[98:99]
v_pk_mul_f32 v[144:145], v[144:145], v[112:113]
v_pk_mul_f32 v[146:147], v[146:147], v[114:115]
ds_read_b128 v[112:115], v9 offset:256
v_pk_fma_f32 v[104:105], v[48:49], v[24:25], v[104:105] op_sel_hi:[1,0,1]
v_pk_fma_f32 v[106:107], v[50:51], v[24:25], v[106:107] op_sel_hi:[1,0,1]
v_pk_fma_f32 v[120:121], v[64:65], v[24:25], v[120:121] op_sel_hi:[1,0,1]
v_pk_fma_f32 v[122:123], v[66:67], v[24:25], v[122:123] op_sel_hi:[1,0,1]
v_pk_fma_f32 v[136:137], v[80:81], v[24:25], v[136:137] op_sel_hi:[1,0,1]
v_pk_fma_f32 v[138:139], v[82:83], v[24:25], v[138:139] op_sel_hi:[1,0,1]
v_pk_fma_f32 v[152:153], v[4:5], v[24:25], v[152:153] op_sel_hi:[1,0,1]
v_pk_fma_f32 v[154:155], v[6:7], v[24:25], v[154:155] op_sel_hi:[1,0,1]
v_pk_mul_f32 v[136:137], v[136:137], v[104:105]
v_pk_mul_f32 v[104:105], v[104:105], v[30:31] op_sel_hi:[1,0]
v_pk_mul_f32 v[138:139], v[138:139], v[106:107]
v_pk_mul_f32 v[106:107], v[106:107], v[30:31] op_sel_hi:[1,0]
v_pk_mul_f32 v[152:153], v[152:153], v[120:121]
v_pk_mul_f32 v[120:121], v[120:121], v[30:31] op_sel_hi:[1,0]
v_pk_mul_f32 v[154:155], v[154:155], v[122:123]
v_pk_mul_f32 v[122:123], v[122:123], v[30:31] op_sel_hi:[1,0]
v_pk_fma_f32 v[100:101], v[100:101], v[22:23], v[22:23] op_sel:[0,1,1] op_sel_hi:[1,1,1]
v_pk_fma_f32 v[102:103], v[102:103], v[22:23], v[22:23] op_sel:[0,1,1] op_sel_hi:[1,1,1]
v_pk_fma_f32 v[116:117], v[116:117], v[22:23], v[22:23] op_sel:[0,1,1] op_sel_hi:[1,1,1]
v_pk_fma_f32 v[118:119], v[118:119], v[22:23], v[22:23] op_sel:[0,1,1] op_sel_hi:[1,1,1]
v_cvt_pk_bf16_f32 v96, v128, v129
v_cvt_pk_bf16_f32 v97, v130, v131
ds_read_b128 v[128:131], v9 offset:320
v_cvt_pk_bf16_f32 v98, v144, v145
v_cvt_pk_bf16_f32 v99, v146, v147
MAA 108,112,156
buffer_store_dwordx4 v[96:99], v10, s[16:19], s63 offen sc1
MAA 124,116,156
ds_read_b128 v[144:147], v9 offset:768
v_rcp_f32 v100, v100
MAA 140,120,156
v_rcp_f32 v101, v101
MAA 156,124,156
.Lpad5:
s_cbranch_execz .Lnopoll35r
v_rcp_f32 v102, v102
MAA 108,192,172
buffer_load_dwordx4 v18, s[28:31], s58 offen lds
MAA 124,196,172
v_rcp_f32 v103, v103
MAA 140,200,172
v_rcp_f32 v116, v116
MAA 156,204,172
v_rcp_f32 v117, v117
MAA 108,208,188
buffer_load_dwordx4 v19, s[28:31], s58 offen offset:1056 lds
MAA 124,212,188
s_add_u32 m0, s59, 109824
s_mov_b32 s58, 3014656
v_rcp_f32 v118, v118
MAA 140,216,188
v_rcp_f32 v119, v119
MAA 156,220,188
v_exp_f32 v104, v104
v_exp_f32 v105, v105
v_exp_f32 v106, v106
v_exp_f32 v107, v107
v_exp_f32 v120, v120
v_exp_f32 v121, v121
v_exp_f32 v122, v122
v_exp_f32 v123, v123
v_pk_mul_f32 v[132:133], v[132:133], v[100:101]
v_pk_mul_f32 v[134:135], v[134:135], v[102:103]
v_pk_mul_f32 v[148:149], v[148:149], v[116:117]
v_pk_mul_f32 v[150:151], v[150:151], v[118:119]
v_pk_fma_f32 v[108:109], v[48:49], v[26:27], v[108:109] op_sel_hi:[1,0,1]
v_pk_fma_f32 v[110:111], v[50:51], v[26:27], v[110:111] op_sel_hi:[1,0,1]
v_pk_fma_f32 v[124:125], v[64:65], v[26:27], v[124:125] op_sel_hi:[1,0,1]
v_pk_fma_f32 v[126:127], v[66:67], v[26:27], v[126:127] op_sel_hi:[1,0,1]
v_pk_fma_f32 v[140:141], v[80:81], v[26:27], v[140:141] op_sel_hi:[1,0,1]
v_pk_fma_f32 v[142:143], v[82:83], v[26:27], v[142:143] op_sel_hi:[1,0,1]
v_pk_fma_f32 v[156:157], v[4:5], v[26:27], v[156:157] op_sel_hi:[1,0,1]
v_pk_fma_f32 v[158:159], v[6:7], v[26:27], v[158:159] op_sel_hi:[1,0,1]
v_pk_mul_f32 v[140:141], v[140:141], v[108:109]
v_pk_mul_f32 v[108:109], v[108:109], v[30:31] op_sel:[0,1] op_sel_hi:[1,1]
v_pk_mul_f32 v[142:143], v[142:143], v[110:111]
v_pk_mul_f32 v[110:111], v[110:111], v[30:31] op_sel:[0,1] op_sel_hi:[1,1]
v_pk_mul_f32 v[156:157], v[156:157], v[124:125]
v_pk_mul_f32 v[124:125], v[124:125], v[30:31] op_sel:[0,1] op_sel_hi:[1,1]
v_pk_mul_f32 v[158:159], v[158:159], v[126:127]
v_pk_mul_f32 v[126:127], v[126:127], v[30:31] op_sel:[0,1] op_sel_hi:[1,1]
v_pk_fma_f32 v[104:105], v[104:105], v[24:25], v[24:25] op_sel:[0,1,1] op_sel_hi:[1,1,1]
v_pk_fma_f32 v[106:107], v[106:107], v[24:25], v[24:25] op_sel:[0,1,1] op_sel_hi:[1,1,1]
v_pk_fma_f32 v[120:121], v[120:121], v[24:25], v[24:25] op_sel:[0,1,1] op_sel_hi:[1,1,1]
v_pk_fma_f32 v[122:123], v[122:123], v[24:25], v[24:25] op_sel:[0,1,1] op_sel_hi:[1,1,1]
v_cvt_pk_bf16_f32 v100, v132, v133
v_cvt_pk_bf16_f32 v101, v134, v135
v_cvt_pk_bf16_f32 v102, v148, v149
v_cvt_pk_bf16_f32 v103, v150, v151
MAA 160,0,144
buffer_store_dwordx4 v[100:103], v10, s[16:19], s63 offen offset:1024 sc1
MAA 176,4,144
v_rcp_f32 v104, v104
MAA 192,8,144
v_rcp_f32 v105, v105
MAA 208,12,144
v_rcp_f32 v106, v106
MAA 160,16,160
buffer_load_dwordx4 v18, s[28:31], s58 offen lds
MAA 176,20,160
v_rcp_f32 v107, v107
MAA 192,24,160
v_rcp_f32 v120, v120
MAA 208,28,160
v_rcp_f32 v121, v121
MAA 160,32,176
buffer_load_dwordx4 v19, s[28:31], s58 offen offset:1056 lds
MAA 176,36,176
s_add_u32 m0, s59, 118272
s_mov_b32 s58, 3211264
s_waitcnt vmcnt(8)
s_barrier
MAA 192,40,176
v_rcp_f32 v122, v122
MAA 208,44,176
v_rcp_f32 v123, v123
v_exp_f32 v108, v108
v_exp_f32 v109, v109
v_exp_f32 v110, v110
v_exp_f32 v111, v111
v_exp_f32 v124, v124
v_exp_f32 v125, v125
v_exp_f32 v126, v126
v_exp_f32 v127, v127
v_pk_mul_f32 v[136:137], v[136:137], v[104:105]
buffer_atomic_add v71, v68, s[16:19], s72 offen offset:512
v_pk_mul_f32 v[138:139], v[138:139], v[106:107]
v_pk_mul_f32 v[152:153], v[152:153], v[120:121]
v_pk_mul_f32 v[154:155], v[154:155], v[122:123]
s_waitcnt lgkmcnt(2)
v_pk_fma_f32 v[160:161], v[112:113], v[20:21], v[160:161] op_sel_hi:[1,0,1]
v_pk_fma_f32 v[162:163], v[114:115], v[20:21], v[162:163] op_sel_hi:[1,0,1]
s_waitcnt lgkmcnt(1)
v_pk_fma_f32 v[176:177], v[128:129], v[20:21], v[176:177] op_sel_hi:[1,0,1]
v_pk_fma_f32 v[178:179], v[130:131], v[20:21], v[178:179] op_sel_hi:[1,0,1]
s_waitcnt lgkmcnt(0)
v_pk_fma_f32 v[192:193], v[144:145], v[20:21], v[192:193] op_sel_hi:[1,0,1]
v_pk_fma_f32 v[194:195], v[146:147], v[20:21], v[194:195] op_sel_hi:[1,0,1]
v_pk_fma_f32 v[208:209], v[12:13], v[20:21], v[208:209] op_sel_hi:[1,0,1]
v_pk_fma_f32 v[210:211], v[14:15], v[20:21], v[210:211] op_sel_hi:[1,0,1]
v_pk_mul_f32 v[192:193], v[192:193], v[160:161]
v_pk_mul_f32 v[160:161], v[160:161], v[28:29] op_sel_hi:[1,0]
v_pk_mul_f32 v[194:195], v[194:195], v[162:163]
v_pk_mul_f32 v[162:163], v[162:163], v[28:29] op_sel_hi:[1,0]
v_pk_mul_f32 v[208:209], v[208:209], v[176:177]
v_pk_mul_f32 v[176:177], v[176:177], v[28:29] op_sel_hi:[1,0]
v_pk_mul_f32 v[210:211], v[210:211], v[178:179]
v_pk_mul_f32 v[178:179], v[178:179], v[28:29] op_sel_hi:[1,0]
v_pk_fma_f32 v[108:109], v[108:109], v[26:27], v[26:27] op_sel:[0,1,1] op_sel_hi:[1,1,1]
v_pk_fma_f32 v[110:111], v[110:111], v[26:27], v[26:27] op_sel:[0,1,1] op_sel_hi:[1,1,1]
v_pk_fma_f32 v[124:125], v[124:125], v[26:27], v[26:27] op_sel:[0,1,1] op_sel_hi:[1,1,1]
v_pk_fma_f32 v[126:127], v[126:127], v[26:27], v[26:27] op_sel:[0,1,1] op_sel_hi:[1,1,1]
v_cvt_pk_bf16_f32 v104, v136, v137
v_cvt_pk_bf16_f32 v105, v138, v139
v_cvt_pk_bf16_f32 v106, v152, v153
v_cvt_pk_bf16_f32 v107, v154, v155
MAA 164,0,148
buffer_store_dwordx4 v[104:107], v11, s[16:19], s63 offen sc1
MAA 180,4,148
v_rcp_f32 v108, v108
MAA 196,8,148
v_rcp_f32 v109, v109
MAA 212,12,148
v_rcp_f32 v110, v110
MAA 164,16,164
buffer_load_dwordx4 v18, s[28:31], s58 offen lds
MAA 180,20,164
v_rcp_f32 v111, v111
MAA 196,24,164
v_rcp_f32 v124, v124
MAA 212,28,164
v_rcp_f32 v125, v125
MAA 164,32,180
buffer_load_dwordx4 v19, s[28:31], s58 offen offset:1056 lds
MAA 180,36,180
s_add_u32 m0, s59, 126720
s_mov_b32 s58, 3473408
v_rcp_f32 v126, v126
MAA 196,40,180
v_rcp_f32 v127, v127
MAA 212,44,180
v_lshl_add_u32 v4, v1, 4, s74
v_add_u32 v2, 67108480, v4
v_cndmask_b32 v4, v4, v2, vcc
s_and_b32 s74, s7, 1
s_mul_i32 s53, s74, 7340032
s_add_u32 s53, s53, 12582912
v_bfe_u32 v7, v1, 2, 3
v_mul_u32_u24 v7, 1056, v7
v_bfe_u32 v2, v1, 5, 1
v_lshl_add_u32 v7, v2, 8, v7
v_and_b32 v2, 3, v1
v_lshl_add_u32 v7, v2, 3, v7
s_lshl_b32 s74, s74, 7
s_xor_b32 s75, s74, 128
v_add_u32 v6, s75, v7
v_add_u32 v7, s74, v7
v_exp_f32 v160, v160
v_exp_f32 v161, v161
v_exp_f32 v162, v162
v_exp_f32 v163, v163
v_exp_f32 v176, v176
v_exp_f32 v177, v177
v_exp_f32 v178, v178
v_exp_f32 v179, v179
v_pk_mul_f32 v[140:141], v[140:141], v[108:109]
v_pk_mul_f32 v[142:143], v[142:143], v[110:111]
v_pk_mul_f32 v[156:157], v[156:157], v[124:125]
v_pk_mul_f32 v[158:159], v[158:159], v[126:127]
v_pk_fma_f32 v[164:165], v[112:113], v[22:23], v[164:165] op_sel_hi:[1,0,1]
v_pk_fma_f32 v[166:167], v[114:115], v[22:23], v[166:167] op_sel_hi:[1,0,1]
v_pk_fma_f32 v[180:181], v[128:129], v[22:23], v[180:181] op_sel_hi:[1,0,1]
v_pk_fma_f32 v[182:183], v[130:131], v[22:23], v[182:183] op_sel_hi:[1,0,1]
v_pk_fma_f32 v[196:197], v[144:145], v[22:23], v[196:197] op_sel_hi:[1,0,1]
v_pk_fma_f32 v[198:199], v[146:147], v[22:23], v[198:199] op_sel_hi:[1,0,1]
v_pk_fma_f32 v[212:213], v[12:13], v[22:23], v[212:213] op_sel_hi:[1,0,1]
v_pk_fma_f32 v[214:215], v[14:15], v[22:23], v[214:215] op_sel_hi:[1,0,1]
v_pk_mul_f32 v[196:197], v[196:197], v[164:165]
v_pk_mul_f32 v[164:165], v[164:165], v[28:29] op_sel:[0,1] op_sel_hi:[1,1]
v_pk_mul_f32 v[198:199], v[198:199], v[166:167]
v_pk_mul_f32 v[166:167], v[166:167], v[28:29] op_sel:[0,1] op_sel_hi:[1,1]
v_pk_mul_f32 v[212:213], v[212:213], v[180:181]
v_pk_mul_f32 v[180:181], v[180:181], v[28:29] op_sel:[0,1] op_sel_hi:[1,1]
v_pk_mul_f32 v[214:215], v[214:215], v[182:183]
v_pk_mul_f32 v[182:183], v[182:183], v[28:29] op_sel:[0,1] op_sel_hi:[1,1]
v_pk_fma_f32 v[160:161], v[160:161], v[20:21], v[20:21] op_sel:[0,1,1] op_sel_hi:[1,1,1]
v_pk_fma_f32 v[162:163], v[162:163], v[20:21], v[20:21] op_sel:[0,1,1] op_sel_hi:[1,1,1]
v_pk_fma_f32 v[176:177], v[176:177], v[20:21], v[20:21] op_sel:[0,1,1] op_sel_hi:[1,1,1]
v_pk_fma_f32 v[178:179], v[178:179], v[20:21], v[20:21] op_sel:[0,1,1] op_sel_hi:[1,1,1]
v_cvt_pk_bf16_f32 v108, v140, v141
v_cvt_pk_bf16_f32 v109, v142, v143
v_cvt_pk_bf16_f32 v110, v156, v157
v_cvt_pk_bf16_f32 v111, v158, v159
MAA 168,0,152
buffer_store_dwordx4 v[108:111], v11, s[16:19], s63 offen offset:1024 sc1
MAA 184,4,152
v_rcp_f32 v160, v160
MAA 200,8,152
v_rcp_f32 v161, v161
MAA 216,12,152
v_rcp_f32 v162, v162
MAA 168,16,168
buffer_load_dwordx4 v18, s[28:31], s58 offen lds
MAA 184,20,168
v_rcp_f32 v163, v163
MAA 200,24,168
v_rcp_f32 v176, v176
MAA 216,28,168
v_rcp_f32 v177, v177
MAA 168,32,184
buffer_load_dwordx4 v19, s[28:31], s58 offen offset:1056 lds
MAA 184,36,184
v_rcp_f32 v178, v178
MAA 200,40,184
v_rcp_f32 v179, v179
MAA 216,44,184
v_exp_f32 v164, v164
v_exp_f32 v165, v165
v_exp_f32 v166, v166
v_exp_f32 v167, v167
v_exp_f32 v180, v180
v_exp_f32 v181, v181
v_exp_f32 v182, v182
v_exp_f32 v183, v183
v_pk_mul_f32 v[192:193], v[192:193], v[160:161]
v_pk_mul_f32 v[194:195], v[194:195], v[162:163]
v_pk_mul_f32 v[208:209], v[208:209], v[176:177]
v_pk_mul_f32 v[210:211], v[210:211], v[178:179]
ds_read_b128 v[176:179], v8
v_pk_fma_f32 v[168:169], v[112:113], v[24:25], v[168:169] op_sel_hi:[1,0,1]
v_pk_fma_f32 v[170:171], v[114:115], v[24:25], v[170:171] op_sel_hi:[1,0,1]
v_pk_fma_f32 v[184:185], v[128:129], v[24:25], v[184:185] op_sel_hi:[1,0,1]
v_pk_fma_f32 v[186:187], v[130:131], v[24:25], v[186:187] op_sel_hi:[1,0,1]
v_pk_fma_f32 v[200:201], v[144:145], v[24:25], v[200:201] op_sel_hi:[1,0,1]
v_pk_fma_f32 v[202:203], v[146:147], v[24:25], v[202:203] op_sel_hi:[1,0,1]
v_pk_fma_f32 v[216:217], v[12:13], v[24:25], v[216:217] op_sel_hi:[1,0,1]
v_pk_fma_f32 v[218:219], v[14:15], v[24:25], v[218:219] op_sel_hi:[1,0,1]
v_pk_mul_f32 v[200:201], v[200:201], v[168:169]
v_pk_mul_f32 v[168:169], v[168:169], v[30:31] op_sel_hi:[1,0]
v_pk_mul_f32 v[202:203], v[202:203], v[170:171]
v_pk_mul_f32 v[170:171], v[170:171], v[30:31] op_sel_hi:[1,0]
v_pk_mul_f32 v[216:217], v[216:217], v[184:185]
v_pk_mul_f32 v[184:185], v[184:185], v[30:31] op_sel_hi:[1,0]
v_pk_mul_f32 v[218:219], v[218:219], v[186:187]
v_pk_mul_f32 v[186:187], v[186:187], v[30:31] op_sel_hi:[1,0]
v_pk_fma_f32 v[164:165], v[164:165], v[22:23], v[22:23] op_sel:[0,1,1] op_sel_hi:[1,1,1]
v_pk_fma_f32 v[166:167], v[166:167], v[22:23], v[22:23] op_sel:[0,1,1] op_sel_hi:[1,1,1]
v_pk_fma_f32 v[180:181], v[180:181], v[22:23], v[22:23] op_sel:[0,1,1] op_sel_hi:[1,1,1]
v_pk_fma_f32 v[182:183], v[182:183], v[22:23], v[22:23] op_sel:[0,1,1] op_sel_hi:[1,1,1]
v_cvt_pk_bf16_f32 v160, v192, v193
v_cvt_pk_bf16_f32 v161, v194, v195
ds_read_b128 v[192:195], v8 offset:64
v_cvt_pk_bf16_f32 v162, v208, v209
v_cvt_pk_bf16_f32 v163, v210, v211
MAA 172,0,156
buffer_store_dwordx4 v[160:163], v10, s[16:19], s64 offen sc1
MAA 188,4,156
ds_read_b128 v[208:211], v8 offset:512
v_rcp_f32 v164, v164
MAA 204,8,156
v_rcp_f32 v165, v165
MAA 220,12,156
v_rcp_f32 v166, v166
MAA 172,16,172
buffer_atomic_add v84, v69, s[16:19], s73 offen offset:512 sc0
MAA 188,20,172
v_rcp_f32 v167, v167
MAA 204,24,172
v_rcp_f32 v180, v180
MAA 220,28,172
v_rcp_f32 v181, v181
MAA 172,32,188
v_rcp_f32 v182, v182
MAA 188,36,188
v_rcp_f32 v183, v183
MAA 204,40,188
v_exp_f32 v168, v168
MAA 220,44,188
v_exp_f32 v169, v169
v_exp_f32 v170, v170
v_exp_f32 v171, v171
v_exp_f32 v184, v184
v_exp_f32 v185, v185
v_exp_f32 v186, v186
v_exp_f32 v187, v187
v_pk_mul_f32 v[196:197], v[196:197], v[164:165]
v_pk_mul_f32 v[198:199], v[198:199], v[166:167]
v_pk_mul_f32 v[212:213], v[212:213], v[180:181]
v_pk_mul_f32 v[214:215], v[214:215], v[182:183]
v_pk_fma_f32 v[172:173], v[112:113], v[26:27], v[172:173] op_sel_hi:[1,0,1]
v_pk_fma_f32 v[174:175], v[114:115], v[26:27], v[174:175] op_sel_hi:[1,0,1]
v_pk_fma_f32 v[188:189], v[128:129], v[26:27], v[188:189] op_sel_hi:[1,0,1]
v_pk_fma_f32 v[190:191], v[130:131], v[26:27], v[190:191] op_sel_hi:[1,0,1]
v_pk_fma_f32 v[204:205], v[144:145], v[26:27], v[204:205] op_sel_hi:[1,0,1]
v_pk_fma_f32 v[206:207], v[146:147], v[26:27], v[206:207] op_sel_hi:[1,0,1]
v_pk_fma_f32 v[220:221], v[12:13], v[26:27], v[220:221] op_sel_hi:[1,0,1]
v_pk_fma_f32 v[222:223], v[14:15], v[26:27], v[222:223] op_sel_hi:[1,0,1]
v_pk_mul_f32 v[204:205], v[204:205], v[172:173]
v_pk_mul_f32 v[172:173], v[172:173], v[30:31] op_sel:[0,1] op_sel_hi:[1,1]
v_pk_mul_f32 v[206:207], v[206:207], v[174:175]
v_pk_mul_f32 v[174:175], v[174:175], v[30:31] op_sel:[0,1] op_sel_hi:[1,1]
v_pk_mul_f32 v[220:221], v[220:221], v[188:189]
v_pk_mul_f32 v[188:189], v[188:189], v[30:31] op_sel:[0,1] op_sel_hi:[1,1]
v_pk_mul_f32 v[222:223], v[222:223], v[190:191]
v_pk_mul_f32 v[190:191], v[190:191], v[30:31] op_sel:[0,1] op_sel_hi:[1,1]
v_pk_fma_f32 v[168:169], v[168:169], v[24:25], v[24:25] op_sel:[0,1,1] op_sel_hi:[1,1,1]
v_pk_fma_f32 v[170:171], v[170:171], v[24:25], v[24:25] op_sel:[0,1,1] op_sel_hi:[1,1,1]
v_pk_fma_f32 v[184:185], v[184:185], v[24:25], v[24:25] op_sel:[0,1,1] op_sel_hi:[1,1,1]
v_pk_fma_f32 v[186:187], v[186:187], v[24:25], v[24:25] op_sel:[0,1,1] op_sel_hi:[1,1,1]
v_cvt_pk_bf16_f32 v164, v196, v197
v_cvt_pk_bf16_f32 v165, v198, v199
v_cvt_pk_bf16_f32 v166, v212, v213
v_cvt_pk_bf16_f32 v167, v214, v215
MAA 224,48,144
buffer_store_dwordx4 v[164:167], v10, s[16:19], s64 offen offset:1024 sc1
MAA 232,52,144
v_rcp_f32 v168, v168
MAA 240,56,144
v_rcp_f32 v169, v169
MAA 248,60,144
v_rcp_f32 v170, v170
MAA 224,64,160
v_rcp_f32 v171, v171
MAA 232,68,160
v_rcp_f32 v184, v184
MAA 240,72,160
v_rcp_f32 v185, v185
MAA 248,76,160
v_rcp_f32 v186, v186
MAA 224,80,176
v_rcp_f32 v187, v187
MAA 232,84,176
v_exp_f32 v172, v172
MAA 240,88,176
v_exp_f32 v173, v173
MAA 248,92,176
v_exp_f32 v174, v174
v_exp_f32 v175, v175
v_exp_f32 v188, v188
v_exp_f32 v189, v189
v_exp_f32 v190, v190
v_exp_f32 v191, v191
v_pk_mul_f32 v[200:201], v[200:201], v[168:169]
v_pk_mul_f32 v[202:203], v[202:203], v[170:171]
v_pk_mul_f32 v[216:217], v[216:217], v[184:185]
v_pk_mul_f32 v[218:219], v[218:219], v[186:187]
s_waitcnt lgkmcnt(2)
v_pk_fma_f32 v[224:225], v[176:177], v[20:21], v[224:225] op_sel_hi:[1,0,1]
v_pk_fma_f32 v[226:227], v[178:179], v[20:21], v[226:227] op_sel_hi:[1,0,1]
s_waitcnt lgkmcnt(1)
v_pk_fma_f32 v[232:233], v[192:193], v[20:21], v[232:233] op_sel_hi:[1,0,1]
v_pk_fma_f32 v[234:235], v[194:195], v[20:21], v[234:235] op_sel_hi:[1,0,1]
s_waitcnt lgkmcnt(0)
v_pk_fma_f32 v[240:241], v[208:209], v[20:21], v[240:241] op_sel_hi:[1,0,1]
v_pk_fma_f32 v[242:243], v[210:211], v[20:21], v[242:243] op_sel_hi:[1,0,1]
v_pk_fma_f32 v[248:249], v[52:53], v[20:21], v[248:249] op_sel_hi:[1,0,1]
v_pk_fma_f32 v[250:251], v[54:55], v[20:21], v[250:251] op_sel_hi:[1,0,1]
v_pk_mul_f32 v[240:241], v[240:241], v[224:225]
v_pk_mul_f32 v[224:225], v[224:225], v[28:29] op_sel_hi:[1,0]
v_pk_mul_f32 v[242:243], v[242:243], v[226:227]
v_pk_mul_f32 v[226:227], v[226:227], v[28:29] op_sel_hi:[1,0]
v_pk_mul_f32 v[248:249], v[248:249], v[232:233]
v_pk_mul_f32 v[232:233], v[232:233], v[28:29] op_sel_hi:[1,0]
v_pk_mul_f32 v[250:251], v[250:251], v[234:235]
v_pk_mul_f32 v[234:235], v[234:235], v[28:29] op_sel_hi:[1,0]
v_pk_fma_f32 v[172:173], v[172:173], v[26:27], v[26:27] op_sel:[0,1,1] op_sel_hi:[1,1,1]
v_pk_fma_f32 v[174:175], v[174:175], v[26:27], v[26:27] op_sel:[0,1,1] op_sel_hi:[1,1,1]
v_pk_fma_f32 v[188:189], v[188:189], v[26:27], v[26:27] op_sel:[0,1,1] op_sel_hi:[1,1,1]
v_pk_fma_f32 v[190:191], v[190:191], v[26:27], v[26:27] op_sel:[0,1,1] op_sel_hi:[1,1,1]
v_cvt_pk_bf16_f32 v168, v200, v201
v_cvt_pk_bf16_f32 v169, v202, v203
v_cvt_pk_bf16_f32 v170, v216, v217
v_cvt_pk_bf16_f32 v171, v218, v219
buffer_store_dwordx4 v[168:171], v11, s[16:19], s64 offen sc1
s_waitcnt vmcnt(2)
v_cmp_gt_u32 vcc, v70, v84
s_nop 0
s_cbranch_vccnz .Lsp48
.Lsp48b:
s_barrier
MAA 228,48,148
s_add_u32 s52, s53, 0
v_rcp_f32 v172, v172
MAA 236,52,148
buffer_load_dwordx4 v[96:99], v4, s[16:19], s52 offen sc1
MAA 244,56,148
ds_read_b64_tr_b16 a[0:1], v7
v_rcp_f32 v173, v173
MAA 252,60,148
TR 2,7,512
v_rcp_f32 v174, v174
MAA 228,64,164
TR 4,7,32
v_rcp_f32 v175, v175
MAA 236,68,164
buffer_load_dwordx4 v[100:103], v4, s[16:19], s52 offen offset:1024 sc1
MAA 244,72,164
s_add_u32 s52, s53, 524288
v_rcp_f32 v188, v188
MAA 252,76,164
TR 6,7,544
v_rcp_f32 v189, v189
MAA 228,80,180
TR 8,7,64
v_rcp_f32 v190, v190
MAA 236,84,180
buffer_load_dwordx4 v[104:107], v4, s[16:19], s52 offen sc1
MAA 244,88,180
TR 10,7,576
v_rcp_f32 v191, v191
MAA 252,92,180
TR 12,7,96
v_exp_f32 v224, v224
v_exp_f32 v225, v225
v_exp_f32 v226, v226
v_exp_f32 v227, v227
v_exp_f32 v232, v232
v_exp_f32 v233, v233
v_exp_f32 v234, v234
v_exp_f32 v235, v235
v_pk_mul_f32 v[204:205], v[204:205], v[172:173]
buffer_load_dwordx4 v[108:111], v4, s[16:19], s52 offen offset:1024 sc1
s_add_u32 s52, s53, 917504
v_pk_mul_f32 v[206:207], v[206:207], v[174:175]
v_pk_mul_f32 v[220:221], v[220:221], v[188:189]
v_pk_mul_f32 v[222:223], v[222:223], v[190:191]
v_pk_fma_f32 v[228:229], v[176:177], v[22:23], v[228:229] op_sel_hi:[1,0,1]
v_pk_fma_f32 v[230:231], v[178:179], v[22:23], v[230:231] op_sel_hi:[1,0,1]
v_pk_fma_f32 v[236:237], v[192:193], v[22:23], v[236:237] op_sel_hi:[1,0,1]
v_pk_fma_f32 v[238:239], v[194:195], v[22:23], v[238:239] op_sel_hi:[1,0,1]
v_pk_fma_f32 v[244:245], v[208:209], v[22:23], v[244:245] op_sel_hi:[1,0,1]
v_pk_fma_f32 v[246:247], v[210:211], v[22:23], v[246:247] op_sel_hi:[1,0,1]
v_pk_fma_f32 v[252:253], v[52:53], v[22:23], v[252:253] op_sel_hi:[1,0,1]
v_pk_fma_f32 v[254:255], v[54:55], v[22:23], v[254:255] op_sel_hi:[1,0,1]
v_pk_mul_f32 v[244:245], v[244:245], v[228:229]
buffer_load_dwordx4 v[112:115], v4, s[16:19], s52 offen sc1
v_pk_mul_f32 v[228:229], v[228:229], v[28:29] op_sel:[0,1] op_sel_hi:[1,1]
v_pk_mul_f32 v[246:247], v[246:247], v[230:231]
v_pk_mul_f32 v[230:231], v[230:231], v[28:29] op_sel:[0,1] op_sel_hi:[1,1]
v_pk_mul_f32 v[252:253], v[252:253], v[236:237]
v_pk_mul_f32 v[236:237], v[236:237], v[28:29] op_sel:[0,1] op_sel_hi:[1,1]
v_pk_mul_f32 v[254:255], v[254:255], v[238:239]
v_pk_mul_f32 v[238:239], v[238:239], v[28:29] op_sel:[0,1] op_sel_hi:[1,1]
v_pk_fma_f32 v[224:225], v[224:225], v[20:21], v[20:21] op_sel:[0,1,1] op_sel_hi:[1,1,1]
v_pk_fma_f32 v[226:227], v[226:227], v[20:21], v[20:21] op_sel:[0,1,1] op_sel_hi:[1,1,1]
v_pk_fma_f32 v[232:233], v[232:233], v[20:21], v[20:21] op_sel:[0,1,1] op_sel_hi:[1,1,1]
v_pk_fma_f32 v[234:235], v[234:235], v[20:21], v[20:21] op_sel:[0,1,1] op_sel_hi:[1,1,1]
v_cvt_pk_bf16_f32 v172, v204, v205
v_cvt_pk_bf16_f32 v173, v206, v207
buffer_load_dwordx4 v[116:119], v4, s[16:19], s52 offen offset:1024 sc1
s_add_u32 s52, s53, 1441792
v_cvt_pk_bf16_f32 v174, v220, v221
v_cvt_pk_bf16_f32 v175, v222, v223
TR 14,7,608
ds_read_b64_tr_b16 a[16:17], v6
TR 18,6,512
TR 20,6,32
TR 22,6,544
buffer_store_dwordx4 v[172:175], v11, s[16:19], s64 offen offset:1024 sc1
TR 24,6,64
TR 26,6,576
TR 28,6,96
TR 30,6,608
v_rcp_f32 v224, v224
v_rcp_f32 v225, v225
v_rcp_f32 v226, v226
v_rcp_f32 v227, v227
v_rcp_f32 v232, v232
v_rcp_f32 v233, v233
v_rcp_f32 v234, v234
v_rcp_f32 v235, v235
v_exp_f32 v228, v228
v_exp_f32 v229, v229
v_exp_f32 v230, v230
v_exp_f32 v231, v231
v_exp_f32 v236, v236
v_exp_f32 v237, v237
v_exp_f32 v238, v238
v_exp_f32 v239, v239
v_pk_mul_f32 v[240:241], v[240:241], v[224:225]
buffer_load_dwordx4 v[120:123], v4, s[16:19], s52 offen sc1
v_pk_mul_f32 v[242:243], v[242:243], v[226:227]
v_pk_mul_f32 v[248:249], v[248:249], v[232:233]
v_pk_mul_f32 v[250:251], v[250:251], v[234:235]
v_pk_fma_f32 v[228:229], v[228:229], v[22:23], v[22:23] op_sel:[0,1,1] op_sel_hi:[1,1,1]
v_pk_fma_f32 v[230:231], v[230:231], v[22:23], v[22:23] op_sel:[0,1,1] op_sel_hi:[1,1,1]
v_pk_fma_f32 v[236:237], v[236:237], v[22:23], v[22:23] op_sel:[0,1,1] op_sel_hi:[1,1,1]
v_pk_fma_f32 v[238:239], v[238:239], v[22:23], v[22:23] op_sel:[0,1,1] op_sel_hi:[1,1,1]
v_cvt_pk_bf16_f32 v224, v240, v241
v_cvt_pk_bf16_f32 v225, v242, v243
v_cvt_pk_bf16_f32 v226, v248, v249
v_cvt_pk_bf16_f32 v227, v250, v251
v_rcp_f32 v228, v228
v_rcp_f32 v229, v229
v_rcp_f32 v230, v230
v_rcp_f32 v231, v231
v_rcp_f32 v236, v236
v_rcp_f32 v237, v237
v_rcp_f32 v238, v238
v_rcp_f32 v239, v239
v_pk_mul_f32 v[244:245], v[244:245], v[228:229]
buffer_store_dwordx4 v[224:227], v10, s[16:19], s65 offen sc1
v_pk_mul_f32 v[246:247], v[246:247], v[230:231]
v_pk_mul_f32 v[252:253], v[252:253], v[236:237]
v_pk_mul_f32 v[254:255], v[254:255], v[238:239]
v_cvt_pk_bf16_f32 v228, v244, v245
v_cvt_pk_bf16_f32 v229, v246, v247
v_cvt_pk_bf16_f32 v230, v252, v253
v_cvt_pk_bf16_f32 v231, v254, v255
buffer_store_dwordx4 v[228:231], v10, s[16:19], s65 offen offset:1024 sc1
buffer_load_dwordx4 v[124:127], v4, s[16:19], s52 offen offset:1024 sc1
v_mov_b32 v21, v68
v_mov_b32 v22, v69
v_mov_b32 v23, v70
v_mov_b32 v24, v71
v_mov_b32 v25, 0
s_waitcnt vmcnt(9) lgkmcnt(0)
s_barrier
v_mfma_f32_16x16x32_bf16 v[32:35], a[0:3], v[96:99], 0
TR 32,7,8448
s_add_u32 s52, s53, 1835008
v_mfma_f32_16x16x32_bf16 v[48:51], a[0:3], v[100:103], 0
buffer_load_dwordx4 v[128:131], v4, s[16:19], s52 offen sc1
v_mfma_f32_16x16x32_bf16 v[52:55], a[4:7], v[100:103], 0
TR 34,7,8960
TR 36,7,8480
v_mfma_f32_16x16x32_bf16 v[36:39], a[4:7], v[96:99], 0
TR 38,7,8992
v_mfma_f32_16x16x32_bf16 v[40:43], a[8:11], v[96:99], 0
buffer_load_dwordx4 v[132:135], v4, s[16:19], s52 offen offset:1024 sc1
v_mfma_f32_16x16x32_bf16 v[56:59], a[8:11], v[100:103], 0
TR 40,7,8512
TR 42,7,9024
v_mfma_f32_16x16x32_bf16 v[60:63], a[12:15], v[100:103], 0
TR 44,7,8544
v_mfma_f32_16x16x32_bf16 v[44:47], a[12:15], v[96:99], 0
TR 46,7,9056
s_add_u32 s52, s53, 2359296
v_mfma_f32_16x16x32_bf16 v[64:67], a[16:19], v[96:99], 0
buffer_load_dwordx4 v[136:139], v4, s[16:19], s52 offen sc1
v_mfma_f32_16x16x32_bf16 v[80:83], a[16:19], v[100:103], 0
TR 48,6,8448
v_mfma_f32_16x16x32_bf16 v[84:87], a[20:23], v[100:103], 0
TR 50,6,8960
TR 52,6,8480
v_mfma_f32_16x16x32_bf16 v[68:71], a[20:23], v[96:99], 0
TR 54,6,8992
v_mfma_f32_16x16x32_bf16 v[72:75], a[24:27], v[96:99], 0
buffer_load_dwordx4 v[140:143], v4, s[16:19], s52 offen offset:1024 sc1
v_mfma_f32_16x16x32_bf16 v[88:91], a[24:27], v[100:103], 0
TR 56,6,8512
TR 58,6,9024
v_mfma_f32_16x16x32_bf16 v[92:95], a[28:31], v[100:103], 0
TR 60,6,8544
v_mfma_f32_16x16x32_bf16 v[76:79], a[28:31], v[96:99], 0
TR 62,6,9056
s_waitcnt vmcnt(11) lgkmcnt(8)
MAV 32,32,104
TR 0,7,16896
s_add_u32 s52, s53, 2752512
MAV 48,32,108
buffer_load_dwordx4 v[144:147], v4, s[16:19], s52 offen sc1
MAV 52,36,108
TR 2,7,17408
TR 4,7,16928
MAV 36,36,104
TR 6,7,17440
MAV 40,40,104
buffer_load_dwordx4 v[148:151], v4, s[16:19], s52 offen offset:1024 sc1
MAV 56,40,108
TR 8,7,16960
TR 10,7,17472
MAV 60,44,108
TR 12,7,16992
MAV 44,44,104
TR 14,7,17504
s_add_u32 s52, s53, 3276800
s_waitcnt lgkmcnt(8)
MAV 64,48,104
buffer_load_dwordx4 v[152:155], v4, s[16:19], s52 offen sc1
MAV 80,48,108
TR 16,6,16896
MAV 84,52,108
TR 18,6,17408
TR 20,6,16928
MAV 68,52,104
TR 22,6,17440
MAV 72,56,104
buffer_load_dwordx4 v[156:159], v4, s[16:19], s52 offen offset:1024 sc1
.Lpad6:
s_cbranch_execz .Lpad9
MAV 88,56,108
TR 24,6,16960
TR 26,6,17472
MAV 92,60,108
TR 28,6,16992
MAV 76,60,104
TR 30,6,17504
s_waitcnt vmcnt(9) lgkmcnt(8)
s_barrier
MAV 32,0,112
TR 32,7,25344
TR 34,7,25856
MAV 48,0,116
buffer_atomic_add v24, v21, s[16:19], s72 offen
MAV 52,4,116
TR 36,7,25376
TR 38,7,25888
MAV 36,4,112
TR 40,7,25408
s_add_u32 m0, s55, 0
MAV 40,8,112
buffer_load_dwordx4 v18, s[28:31], s54 offen lds
MAV 56,8,116
TR 42,7,25920
MAV 60,12,116
TR 44,7,25440
TR 46,7,25952
MAV 44,12,112
TR 48,6,25344
s_add_u32 s52, s53, 3670016
s_waitcnt lgkmcnt(9)
MAV 64,16,112
buffer_load_dwordx4 v[96:99], v4, s[16:19], s52 offen sc1
MAV 80,16,116
TR 50,6,25856
TR 52,6,25376
MAV 84,20,116
buffer_load_dwordx4 v19, s[28:31], s54 offen offset:1056 lds
MAV 68,20,112
s_mov_b32 s54, 327680
MAV 72,24,112
TR 54,6,25888
TR 56,6,25408
MAV 88,24,116
buffer_load_dwordx4 v[100:103], v4, s[16:19], s52 offen offset:1024 sc1
MAV 92,28,116
TR 58,6,25920
TR 60,6,25440
MAV 76,28,112
TR 62,6,25952
s_waitcnt vmcnt(13) lgkmcnt(8)
MAV 32,32,120
TR 0,7,33792
s_add_u32 m0, s55, 8448
MAV 48,32,124
buffer_load_dwordx4 v18, s[28:31], s54 offen lds
MAV 52,36,124
TR 2,7,34304
TR 4,7,33824
MAV 36,36,120
TR 6,7,34336
s_add_u32 s52, s53, 4194304
MAV 40,40,120
buffer_load_dwordx4 v[104:107], v4, s[16:19], s52 offen sc1
MAV 56,40,124
TR 8,7,33856
MAV 60,44,124
TR 10,7,34368
TR 12,7,33888
MAV 44,44,120
TR 14,7,34400
s_waitcnt lgkmcnt(8)
MAV 64,48,120
buffer_load_dwordx4 v19, s[28:31], s54 offen offset:1056 lds
MAV 80,48,124
s_mov_b32 s54, 524288
MAV 84,52,124
TR 16,6,33792
TR 18,6,34304
MAV 68,52,120
TR 20,6,33824
TR 22,6,34336
MAV 72,56,120
buffer_load_dwordx4 v[108:111], v4, s[16:19], s52 offen offset:1024 sc1
MAV 88,56,124
TR 24,6,33856
MAV 92,60,124
TR 26,6,34368
TR 28,6,33888
MAV 76,60,120
TR 30,6,34400
s_waitcnt vmcnt(15) lgkmcnt(8)
s_barrier
MAV 32,0,128
TR 32,7,42240
s_add_u32 m0, s55, 16896
MAV 48,0,132
buffer_load_dwordx4 v18, s[28:31], s54 offen lds
MAV 52,4,132
TR 34,7,42752
TR 36,7,42272
MAV 36,4,128
TR 38,7,42784
s_add_u32 s52, s53, 4587520
MAV 40,8,128
buffer_load_dwordx4 v[112:115], v4, s[16:19], s52 offen sc1
MAV 56,8,132
TR 40,7,42304
MAV 60,12,132
TR 42,7,42816
TR 44,7,42336
MAV 44,12,128
TR 46,7,42848
s_waitcnt lgkmcnt(8)
MAV 64,16,128
buffer_load_dwordx4 v19, s[28:31], s54 offen offset:1056 lds
MAV 80,16,132
s_mov_b32 s54, 786432
MAV 84,20,132
TR 48,6,42240
TR 50,6,42752
MAV 68,20,128
TR 52,6,42272
TR 54,6,42784
MAV 72,24,128
buffer_load_dwordx4 v[116:119], v4, s[16:19], s52 offen offset:1024 sc1
MAV 88,24,132
TR 56,6,42304
MAV 92,28,132
TR 58,6,42816
TR 60,6,42336
MAV 76,28,128
TR 62,6,42848
s_waitcnt vmcnt(17) lgkmcnt(8)
MAV 32,32,136
TR 0,7,50688
s_add_u32 m0, s55, 25344
MAV 48,32,140
buffer_load_dwordx4 v18, s[28:31], s54 offen lds
MAV 52,36,140
TR 2,7,51200
TR 4,7,50720
MAV 36,36,136
TR 6,7,51232
s_add_u32 s52, s53, 5111808
MAV 40,40,136
buffer_load_dwordx4 v[120:123], v4, s[16:19], s52 offen sc1
MAV 56,40,140
TR 8,7,50752
TR 10,7,51264
MAV 60,44,140
TR 12,7,50784
TR 14,7,51296
MAV 44,44,136
s_waitcnt lgkmcnt(8)
MAV 64,48,136
buffer_load_dwordx4 v19, s[28:31], s54 offen offset:1056 lds
MAV 80,48,140
TR 16,6,50688
s_mov_b32 s54, 983040
MAV 84,52,140
buffer_load_dwordx4 v[124:127], v4, s[16:19], s52 offen offset:1024 sc1
MAV 68,52,136
TR 18,6,51200
TR 20,6,50720
MAV 72,56,136
TR 22,6,51232
TR 24,6,50752
MAV 88,56,140
buffer_atomic_add v25, v22, s[16:19], s73 offen sc0
MAV 92,60,140
TR 26,6,51264
TR 28,6,50784
MAV 76,60,136
TR 30,6,51296
s_waitcnt vmcnt(20) lgkmcnt(8)
s_barrier
MAV 32,0,144
TR 32,7,59136
s_add_u32 m0, s55, 33792
MAV 48,0,148
buffer_load_dwordx4 v18, s[28:31], s54 offen lds
MAV 52,4,148
TR 34,7,59648
TR 36,7,59168
MAV 36,4,144
TR 38,7,59680
s_add_u32 s52, s53, 5505024
MAV 40,8,144
buffer_load_dwordx4 v[128:131], v4, s[16:19], s52 offen sc1
MAV 56,8,148
TR 40,7,59200
MAV 60,12,148
TR 42,7,59712
TR 44,7,59232
MAV 44,12,144
TR 46,7,59744
s_waitcnt lgkmcnt(8)
MAV 64,16,144
buffer_load_dwordx4 v19, s[28:31], s54 offen offset:1056 lds
MAV 80,16,148
s_mov_b32 s54, 1245184
MAV 84,20,148
TR 48,6,59136
TR 50,6,59648
MAV 68,20,144
TR 52,6,59168
TR 54,6,59680
MAV 72,24,144
buffer_load_dwordx4 v[132:135], v4, s[16:19], s52 offen offset:1024 sc1
MAV 88,24,148
TR 56,6,59200
MAV 92,28,148
TR 58,6,59712
TR 60,6,59232
MAV 76,28,144
TR 62,6,59744
v_add_u32 v7, s57, v7
v_add_u32 v6, s57, v6
s_sub_u32 s57, 0, s57
s_waitcnt vmcnt(22) lgkmcnt(8)
MAV 32,32,152
ds_read_b64_tr_b16 a[0:1], v7
s_add_u32 m0, s55, 42240
MAV 48,32,156
buffer_load_dwordx4 v18, s[28:31], s54 offen lds
MAV 52,36,156
TR 2,7,512
TR 4,7,32
MAV 36,36,152
TR 6,7,544
s_add_u32 s52, s53, 6029312
MAV 40,40,152
buffer_load_dwordx4 v[136:139], v4, s[16:19], s52 offen sc1
MAV 56,40,156
TR 8,7,64
MAV 60,44,156
TR 10,7,576
TR 12,7,96
MAV 44,44,152
TR 14,7,608
s_waitcnt lgkmcnt(8)
MAV 64,48,152
buffer_load_dwordx4 v19, s[28:31], s54 offen offset:1056 lds
MAV 80,48,156
s_mov_b32 s54, 1441792
MAV 84,52,156
ds_read_b64_tr_b16 a[16:17], v6
TR 18,6,512
MAV 68,52,152
TR 20,6,32
TR 22,6,544
MAV 72,56,152
buffer_load_dwordx4 v[140:143], v4, s[16:19], s52 offen offset:1024 sc1
MAV 88,56,156
TR 24,6,64
MAV 92,60,156
TR 26,6,576
TR 28,6,96
MAV 76,60,152
TR 30,6,608
s_waitcnt vmcnt(21) lgkmcnt(8)
s_barrier
MAV 32,0,96
TR 32,7,8448
s_add_u32 m0, s55, 50688
MAV 48,0,100
buffer_load_dwordx4 v18, s[28:31], s54 offen lds
MAV 52,4,100
TR 34,7,8960
TR 36,7,8480
MAV 36,4,96
TR 38,7,8992
s_add_u32 s52, s53, 6422528
MAV 40,8,96
buffer_load_dwordx4 v[144:147], v4, s[16:19], s52 offen sc1
MAV 56,8,100
TR 40,7,8512
MAV 60,12,100
TR 42,7,9024
TR 44,7,8544
MAV 44,12,96
TR 46,7,9056
s_waitcnt lgkmcnt(8)
MAV 64,16,96
buffer_load_dwordx4 v19, s[28:31], s54 offen offset:1056 lds
MAV 80,16,100
s_mov_b32 s54, 1703936
MAV 84,20,100
TR 48,6,8448
TR 50,6,8960
MAV 68,20,96
TR 52,6,8480
TR 54,6,8992
MAV 72,24,96
buffer_load_dwordx4 v[148:151], v4, s[16:19], s52 offen offset:1024 sc1
MAV 88,24,100
TR 56,6,8512
MAV 92,28,100
TR 58,6,9024
TR 60,6,8544
MAV 76,28,96
TR 62,6,9056
s_waitcnt vmcnt(21) lgkmcnt(8)
MAV 32,32,104
TR 0,7,16896
s_add_u32 m0, s55, 59136
MAV 48,32,108
buffer_load_dwordx4 v18, s[28:31], s54 offen lds
MAV 52,36,108
TR 2,7,17408
TR 4,7,16928
MAV 36,36,104
TR 6,7,17440
s_add_u32 s52, s53, 6946816
MAV 40,40,104
buffer_load_dwordx4 v[152:155], v4, s[16:19], s52 offen sc1
MAV 56,40,108
TR 8,7,16960
MAV 60,44,108
TR 10,7,17472
TR 12,7,16992
MAV 44,44,104
TR 14,7,17504
s_waitcnt lgkmcnt(8)
MAV 64,48,104
buffer_load_dwordx4 v19, s[28:31], s54 offen offset:1056 lds
MAV 80,48,108
s_mov_b32 s54, 1900544
MAV 84,52,108
TR 16,6,16896
TR 18,6,17408
MAV 68,52,104
TR 20,6,16928
TR 22,6,17440
MAV 72,56,104
buffer_load_dwordx4 v[156:159], v4, s[16:19], s52 offen offset:1024 sc1
MAV 88,56,108
TR 24,6,16960
MAV 92,60,108
TR 26,6,17472
TR 28,6,16992
MAV 76,60,104
TR 30,6,17504
s_waitcnt vmcnt(16)
v_cmp_gt_u32 vcc, v23, v25
s_nop 0
s_cbranch_vccnz .Lsp49
.Lsp49b:
s_waitcnt lgkmcnt(8)
s_barrier
MAV 32,0,112
TR 32,7,25344
s_add_u32 m0, s55, 67584
MAV 48,0,116
buffer_load_dwordx4 v18, s[28:31], s54 offen lds
MAV 52,4,116
TR 34,7,25856
TR 36,7,25376
MAV 36,4,112
TR 38,7,25888
s_add_u32 s52, s53, 131072
MAV 40,8,112
buffer_load_dwordx4 v[96:99], v4, s[16:19], s52 offen sc1
MAV 56,8,116
TR 40,7,25408
MAV 60,12,116
TR 42,7,25920
TR 44,7,25440
MAV 44,12,112
TR 46,7,25952
s_waitcnt lgkmcnt(8)
MAV 64,16,112
buffer_load_dwordx4 v19, s[28:31], s54 offen offset:1056 lds
MAV 80,16,116
s_mov_b32 s54, 2162688
MAV 84,20,116
TR 48,6,25344
TR 50,6,25856
MAV 68,20,112
TR 52,6,25376
TR 54,6,25888
MAV 72,24,112
buffer_load_dwordx4 v[100:103], v4, s[16:19], s52 offen offset:1024 sc1
MAV 88,24,116
TR 56,6,25408
MAV 92,28,116
TR 58,6,25920
TR 60,6,25440
MAV 76,28,112
TR 62,6,25952
s_waitcnt lgkmcnt(8)
MAV 32,32,120
TR 0,7,33792
s_add_u32 m0, s55, 76032
MAV 48,32,124
buffer_load_dwordx4 v18, s[28:31], s54 offen lds
MAV 52,36,124
TR 2,7,34304
TR 4,7,33824
MAV 36,36,120
TR 6,7,34336
s_add_u32 s52, s53, 655360
MAV 40,40,120
buffer_load_dwordx4 v[104:107], v4, s[16:19], s52 offen sc1
MAV 56,40,124
TR 8,7,33856
MAV 60,44,124
TR 10,7,34368
TR 12,7,33888
MAV 44,44,120
TR 14,7,34400
s_waitcnt lgkmcnt(8)
MAV 64,48,120
buffer_load_dwordx4 v19, s[28:31], s54 offen offset:1056 lds
MAV 80,48,124
s_mov_b32 s54, 2359296
MAV 84,52,124
TR 16,6,33792
TR 18,6,34304
MAV 68,52,120
TR 20,6,33824
TR 22,6,34336
MAV 72,56,120
buffer_load_dwordx4 v[108:111], v4, s[16:19], s52 offen offset:1024 sc1
MAV 88,56,124
TR 24,6,33856
MAV 92,60,124
TR 26,6,34368
TR 28,6,33888
MAV 76,60,120
TR 30,6,34400
s_waitcnt vmcnt(20) lgkmcnt(8)
s_barrier
MAV 32,0,128
TR 32,7,42240
s_add_u32 m0, s55, 84480
MAV 48,0,132
buffer_load_dwordx4 v18, s[28:31], s54 offen lds
MAV 52,4,132
TR 34,7,42752
TR 36,7,42272
MAV 36,4,128
TR 38,7,42784
s_add_u32 s52, s53, 1048576
MAV 40,8,128
buffer_load_dwordx4 v[112:115], v4, s[16:19], s52 offen sc1
MAV 56,8,132
TR 40,7,42304
MAV 60,12,132
TR 42,7,42816
TR 44,7,42336
MAV 44,12,128
TR 46,7,42848
s_waitcnt lgkmcnt(8)
MAV 64,16,128
buffer_load_dwordx4 v19, s[28:31], s54 offen offset:1056 lds
MAV 80,16,132
s_mov_b32 s54, 2621440
MAV 84,20,132
TR 48,6,42240
TR 50,6,42752
MAV 68,20,128
TR 52,6,42272
TR 54,6,42784
MAV 72,24,128
buffer_load_dwordx4 v[116:119], v4, s[16:19], s52 offen offset:1024 sc1
MAV 88,24,132
TR 56,6,42304
MAV 92,28,132
TR 58,6,42816
TR 60,6,42336
MAV 76,28,128
TR 62,6,42848
s_waitcnt vmcnt(20) lgkmcnt(8)
MAV 32,32,136
TR 0,7,50688
s_add_u32 m0, s55, 92928
MAV 48,32,140
buffer_load_dwordx4 v18, s[28:31], s54 offen lds
MAV 52,36,140
TR 2,7,51200
TR 4,7,50720
MAV 36,36,136
TR 6,7,51232
s_add_u32 s52, s53, 1572864
MAV 40,40,136
buffer_load_dwordx4 v[120:123], v4, s[16:19], s52 offen sc1
MAV 56,40,140
TR 8,7,50752
MAV 60,44,140
TR 10,7,51264
TR 12,7,50784
MAV 44,44,136
TR 14,7,51296
s_waitcnt lgkmcnt(8)
MAV 64,48,136
buffer_load_dwordx4 v19, s[28:31], s54 offen offset:1056 lds
MAV 80,48,140
s_mov_b32 s54, 2818048
MAV 84,52,140
TR 16,6,50688
TR 18,6,51200
MAV 68,52,136
TR 20,6,50720
TR 22,6,51232
MAV 72,56,136
buffer_load_dwordx4 v[124:127], v4, s[16:19], s52 offen offset:1024 sc1
MAV 88,56,140
TR 24,6,50752
MAV 92,60,140
TR 26,6,51264
TR 28,6,50784
MAV 76,60,136
TR 30,6,51296
s_waitcnt vmcnt(20) lgkmcnt(8)
s_barrier
MAV 32,0,144
TR 32,7,59136
s_add_u32 m0, s55, 101376
MAV 48,0,148
buffer_load_dwordx4 v18, s[28:31], s54 offen lds
MAV 52,4,148
TR 34,7,59648
TR 36,7,59168
MAV 36,4,144
TR 38,7,59680
s_add_u32 s52, s53, 1966080
MAV 40,8,144
buffer_load_dwordx4 v[128:131], v4, s[16:19], s52 offen sc1
MAV 56,8,148
TR 40,7,59200
.Lpad7:
s_cbranch_execz .Lpad10
MAV 60,12,148
TR 42,7,59712
TR 44,7,59232
MAV 44,12,144
TR 46,7,59744
s_waitcnt lgkmcnt(8)
MAV 64,16,144
buffer_load_dwordx4 v19, s[28:31], s54 offen offset:1056 lds
MAV 80,16,148
s_mov_b32 s54, 3080192
MAV 84,20,148
TR 48,6,59136
TR 50,6,59648
MAV 68,20,144
TR 52,6,59168
TR 54,6,59680
MAV 72,24,144
buffer_load_dwordx4 v[132:135], v4, s[16:19], s52 offen offset:1024 sc1
MAV 88,24,148
TR 56,6,59200
MAV 92,28,148
TR 58,6,59712
TR 60,6,59232
MAV 76,28,144
TR 62,6,59744
v_add_u32 v7, s57, v7
v_add_u32 v6, s57, v6
s_sub_u32 s57, 0, s57
s_waitcnt vmcnt(20) lgkmcnt(8)
MAV 32,32,152
ds_read_b64_tr_b16 a[0:1], v7
s_add_u32 m0, s55, 109824
MAV 48,32,156
buffer_load_dwordx4 v18, s[28:31], s54 offen lds
MAV 52,36,156
TR 2,7,512
TR 4,7,32
MAV 36,36,152
TR 6,7,544
s_add_u32 s52, s53, 2490368
MAV 40,40,152
buffer_load_dwordx4 v[136:139], v4, s[16:19], s52 offen sc1
MAV 56,40,156
TR 8,7,64
MAV 60,44,156
TR 10,7,576
TR 12,7,96
MAV 44,44,152
TR 14,7,608
s_waitcnt lgkmcnt(8)
MAV 64,48,152
buffer_load_dwordx4 v19, s[28:31], s54 offen offset:1056 lds
MAV 80,48,156
s_mov_b32 s54, 3276800
MAV 84,52,156
ds_read_b64_tr_b16 a[16:17], v6
TR 18,6,512
MAV 68,52,152
TR 20,6,32
TR 22,6,544
MAV 72,56,152
buffer_load_dwordx4 v[140:143], v4, s[16:19], s52 offen offset:1024 sc1
MAV 88,56,156
TR 24,6,64
MAV 92,60,156
TR 26,6,576
TR 28,6,96
MAV 76,60,152
TR 30,6,608
s_waitcnt vmcnt(20) lgkmcnt(8)
s_barrier
MAV 32,0,96
TR 32,7,8448
s_add_u32 m0, s55, 118272
MAV 48,0,100
buffer_load_dwordx4 v18, s[28:31], s54 offen lds
MAV 52,4,100
TR 34,7,8960
TR 36,7,8480
MAV 36,4,96
TR 38,7,8992
s_add_u32 s52, s53, 2883584
MAV 40,8,96
buffer_load_dwordx4 v[144:147], v4, s[16:19], s52 offen sc1
MAV 56,8,100
TR 40,7,8512
MAV 60,12,100
TR 42,7,9024
TR 44,7,8544
MAV 44,12,96
TR 46,7,9056
s_waitcnt lgkmcnt(8)
MAV 64,16,96
buffer_load_dwordx4 v19, s[28:31], s54 offen offset:1056 lds
MAV 80,16,100
s_mov_b32 s54, 3538944
MAV 84,20,100
TR 48,6,8448
TR 50,6,8960
MAV 68,20,96
TR 52,6,8480
TR 54,6,8992
MAV 72,24,96
buffer_load_dwordx4 v[148:151], v4, s[16:19], s52 offen offset:1024 sc1
MAV 88,24,100
TR 56,6,8512
MAV 92,28,100
TR 58,6,9024
TR 60,6,8544
MAV 76,28,96
TR 62,6,9056
s_waitcnt vmcnt(20) lgkmcnt(8)
MAV 32,32,104
TR 0,7,16896
s_add_u32 m0, s55, 126720
MAV 48,32,108
buffer_load_dwordx4 v18, s[28:31], s54 offen lds
MAV 52,36,108
TR 2,7,17408
TR 4,7,16928
MAV 36,36,104
TR 6,7,17440
s_add_u32 s52, s53, 3407872
MAV 40,40,104
buffer_load_dwordx4 v[152:155], v4, s[16:19], s52 offen sc1
MAV 56,40,108
TR 8,7,16960
MAV 60,44,108
TR 10,7,17472
TR 12,7,16992
MAV 44,44,104
TR 14,7,17504
s_waitcnt lgkmcnt(8)
MAV 64,48,104
buffer_load_dwordx4 v19, s[28:31], s54 offen offset:1056 lds
MAV 80,48,108
s_mov_b32 s54, 131072
MAV 84,52,108
TR 16,6,16896
TR 18,6,17408
MAV 68,52,104
TR 20,6,16928
TR 22,6,17440
MAV 72,56,104
buffer_load_dwordx4 v[156:159], v4, s[16:19], s52 offen offset:1024 sc1
MAV 88,56,108
TR 24,6,16960
MAV 92,60,108
TR 26,6,17472
TR 28,6,16992
MAV 76,60,104
TR 30,6,17504
s_waitcnt vmcnt(20) lgkmcnt(8)
s_barrier
MAV 32,0,112
TR 32,7,25344
s_add_u32 m0, s55, 0
MAV 48,0,116
buffer_load_dwordx4 v18, s[28:31], s54 offen lds
MAV 52,4,116
TR 34,7,25856
TR 36,7,25376
MAV 36,4,112
TR 38,7,25888
s_add_u32 s52, s53, 3801088
MAV 40,8,112
buffer_load_dwordx4 v[96:99], v4, s[16:19], s52 offen sc1
MAV 56,8,116
TR 40,7,25408
MAV 60,12,116
TR 42,7,25920
TR 44,7,25440
MAV 44,12,112
TR 46,7,25952
s_waitcnt lgkmcnt(8)
MAV 64,16,112
buffer_load_dwordx4 v19, s[28:31], s54 offen offset:1056 lds
MAV 80,16,116
s_mov_b32 s54, 393216
MAV 84,20,116
TR 48,6,25344
TR 50,6,25856
MAV 68,20,112
TR 52,6,25376
TR 54,6,25888
MAV 72,24,112
buffer_load_dwordx4 v[100:103], v4, s[16:19], s52 offen offset:1024 sc1
MAV 88,24,116
TR 56,6,25408
MAV 92,28,116
TR 58,6,25920
TR 60,6,25440
MAV 76,28,112
TR 62,6,25952
s_waitcnt vmcnt(20) lgkmcnt(8)
MAV 32,32,120
TR 0,7,33792
s_add_u32 m0, s55, 8448
MAV 48,32,124
buffer_load_dwordx4 v18, s[28:31], s54 offen lds
MAV 52,36,124
TR 2,7,34304
TR 4,7,33824
MAV 36,36,120
TR 6,7,34336
s_add_u32 s52, s53, 4325376
MAV 40,40,120
buffer_load_dwordx4 v[104:107], v4, s[16:19], s52 offen sc1
MAV 56,40,124
TR 8,7,33856
MAV 60,44,124
TR 10,7,34368
TR 12,7,33888
MAV 44,44,120
TR 14,7,34400
s_waitcnt lgkmcnt(8)
MAV 64,48,120
buffer_load_dwordx4 v19, s[28:31], s54 offen offset:1056 lds
MAV 80,48,124
s_mov_b32 s54, 589824
MAV 84,52,124
TR 16,6,33792
TR 18,6,34304
MAV 68,52,120
TR 20,6,33824
TR 22,6,34336
MAV 72,56,120
buffer_load_dwordx4 v[108:111], v4, s[16:19], s52 offen offset:1024 sc1
MAV 88,56,124
TR 24,6,33856
MAV 92,60,124
TR 26,6,34368
TR 28,6,33888
MAV 76,60,120
TR 30,6,34400
s_waitcnt vmcnt(20) lgkmcnt(8)
s_barrier
MAV 32,0,128
TR 32,7,42240
s_add_u32 m0, s55, 16896
MAV 48,0,132
buffer_load_dwordx4 v18, s[28:31], s54 offen lds
MAV 52,4,132
TR 34,7,42752
TR 36,7,42272
MAV 36,4,128
TR 38,7,42784
s_add_u32 s52, s53, 4718592
MAV 40,8,128
buffer_load_dwordx4 v[112:115], v4, s[16:19], s52 offen sc1
MAV 56,8,132
TR 40,7,42304
MAV 60,12,132
TR 42,7,42816
TR 44,7,42336
MAV 44,12,128
TR 46,7,42848
s_waitcnt lgkmcnt(8)
MAV 64,16,128
buffer_load_dwordx4 v19, s[28:31], s54 offen offset:1056 lds
MAV 80,16,132
s_mov_b32 s54, 851968
MAV 84,20,132
TR 48,6,42240
TR 50,6,42752
MAV 68,20,128
TR 52,6,42272
TR 54,6,42784
MAV 72,24,128
buffer_load_dwordx4 v[116:119], v4, s[16:19], s52 offen offset:1024 sc1
MAV 88,24,132
TR 56,6,42304
MAV 92,28,132
TR 58,6,42816
TR 60,6,42336
MAV 76,28,128
TR 62,6,42848
s_waitcnt vmcnt(20) lgkmcnt(8)
MAV 32,32,136
TR 0,7,50688
s_add_u32 m0, s55, 25344
MAV 48,32,140
buffer_load_dwordx4 v18, s[28:31], s54 offen lds
MAV 52,36,140
TR 2,7,51200
TR 4,7,50720
MAV 36,36,136
TR 6,7,51232
s_add_u32 s52, s53, 5242880
MAV 40,40,136
buffer_load_dwordx4 v[120:123], v4, s[16:19], s52 offen sc1
MAV 56,40,140
TR 8,7,50752
MAV 60,44,140
TR 10,7,51264
TR 12,7,50784
MAV 44,44,136
TR 14,7,51296
s_waitcnt lgkmcnt(8)
MAV 64,48,136
buffer_load_dwordx4 v19, s[28:31], s54 offen offset:1056 lds
MAV 80,48,140
s_mov_b32 s54, 1048576
MAV 84,52,140
TR 16,6,50688
TR 18,6,51200
MAV 68,52,136
TR 20,6,50720
TR 22,6,51232
MAV 72,56,136
buffer_load_dwordx4 v[124:127], v4, s[16:19], s52 offen offset:1024 sc1
MAV 88,56,140
TR 24,6,50752
MAV 92,60,140
TR 26,6,51264
TR 28,6,50784
MAV 76,60,136
TR 30,6,51296
s_waitcnt vmcnt(20) lgkmcnt(8)
s_barrier
MAV 32,0,144
TR 32,7,59136
s_add_u32 m0, s55, 33792
MAV 48,0,148
buffer_load_dwordx4 v18, s[28:31], s54 offen lds
MAV 52,4,148
TR 34,7,59648
TR 36,7,59168
MAV 36,4,144
TR 38,7,59680
s_add_u32 s52, s53, 5636096
MAV 40,8,144
buffer_load_dwordx4 v[128:131], v4, s[16:19], s52 offen sc1
MAV 56,8,148
TR 40,7,59200
MAV 60,12,148
TR 42,7,59712
TR 44,7,59232
MAV 44,12,144
TR 46,7,59744
s_waitcnt lgkmcnt(8)
MAV 64,16,144
buffer_load_dwordx4 v19, s[28:31], s54 offen offset:1056 lds
MAV 80,16,148
s_mov_b32 s54, 1310720
MAV 84,20,148
TR 48,6,59136
TR 50,6,59648
MAV 68,20,144
TR 52,6,59168
TR 54,6,59680
MAV 72,24,144
buffer_load_dwordx4 v[132:135], v4, s[16:19], s52 offen offset:1024 sc1
MAV 88,24,148
TR 56,6,59200
MAV 92,28,148
TR 58,6,59712
TR 60,6,59232
MAV 76,28,144
TR 62,6,59744
v_add_u32 v7, s57, v7
v_add_u32 v6, s57, v6
s_sub_u32 s57, 0, s57
s_waitcnt vmcnt(20) lgkmcnt(8)
MAV 32,32,152
ds_read_b64_tr_b16 a[0:1], v7
s_add_u32 m0, s55, 42240
MAV 48,32,156
buffer_load_dwordx4 v18, s[28:31], s54 offen lds
MAV 52,36,156
TR 2,7,512
TR 4,7,32
MAV 36,36,152
TR 6,7,544
s_add_u32 s52, s53, 6160384
MAV 40,40,152
buffer_load_dwordx4 v[136:139], v4, s[16:19], s52 offen sc1
MAV 56,40,156
TR 8,7,64
MAV 60,44,156
TR 10,7,576
TR 12,7,96
MAV 44,44,152
TR 14,7,608
s_waitcnt lgkmcnt(8)
MAV 64,48,152
buffer_load_dwordx4 v19, s[28:31], s54 offen offset:1056 lds
MAV 80,48,156
s_mov_b32 s54, 1507328
MAV 84,52,156
ds_read_b64_tr_b16 a[16:17], v6
TR 18,6,512
MAV 68,52,152
TR 20,6,32
TR 22,6,544
MAV 72,56,152
buffer_load_dwordx4 v[140:143], v4, s[16:19], s52 offen offset:1024 sc1
MAV 88,56,156
TR 24,6,64
MAV 92,60,156
TR 26,6,576
TR 28,6,96
MAV 76,60,152
TR 30,6,608
s_waitcnt vmcnt(20) lgkmcnt(8)
s_barrier
MAV 32,0,96
TR 32,7,8448
s_add_u32 m0, s55, 50688
MAV 48,0,100
buffer_load_dwordx4 v18, s[28:31], s54 offen lds
MAV 52,4,100
TR 34,7,8960
TR 36,7,8480
MAV 36,4,96
TR 38,7,8992
s_add_u32 s52, s53, 6553600
MAV 40,8,96
buffer_load_dwordx4 v[144:147], v4, s[16:19], s52 offen sc1
MAV 56,8,100
TR 40,7,8512
MAV 60,12,100
TR 42,7,9024
TR 44,7,8544
MAV 44,12,96
TR 46,7,9056
s_waitcnt lgkmcnt(8)
MAV 64,16,96
buffer_load_dwordx4 v19, s[28:31], s54 offen offset:1056 lds
MAV 80,16,100
s_mov_b32 s54, 1769472
MAV 84,20,100
TR 48,6,8448
TR 50,6,8960
MAV 68,20,96
TR 52,6,8480
TR 54,6,8992
MAV 72,24,96
buffer_load_dwordx4 v[148:151], v4, s[16:19], s52 offen offset:1024 sc1
MAV 88,24,100
TR 56,6,8512
MAV 92,28,100
TR 58,6,9024
TR 60,6,8544
MAV 76,28,96
TR 62,6,9056
s_waitcnt vmcnt(20) lgkmcnt(8)
MAV 32,32,104
TR 0,7,16896
s_add_u32 m0, s55, 59136
MAV 48,32,108
buffer_load_dwordx4 v18, s[28:31], s54 offen lds
MAV 52,36,108
TR 2,7,17408
TR 4,7,16928
MAV 36,36,104
TR 6,7,17440
s_add_u32 s52, s53, 7077888
MAV 40,40,104
buffer_load_dwordx4 v[152:155], v4, s[16:19], s52 offen sc1
MAV 56,40,108
TR 8,7,16960
MAV 60,44,108
TR 10,7,17472
TR 12,7,16992
MAV 44,44,104
TR 14,7,17504
s_waitcnt lgkmcnt(8)
MAV 64,48,104
buffer_load_dwordx4 v19, s[28:31], s54 offen offset:1056 lds
MAV 80,48,108
s_mov_b32 s54, 1966080
MAV 84,52,108
TR 16,6,16896
TR 18,6,17408
MAV 68,52,104
TR 20,6,16928
TR 22,6,17440
MAV 72,56,104
buffer_load_dwordx4 v[156:159], v4, s[16:19], s52 offen offset:1024 sc1
MAV 88,56,108
TR 24,6,16960
MAV 92,60,108
TR 26,6,17472
TR 28,6,16992
MAV 76,60,104
TR 30,6,17504
s_waitcnt vmcnt(20) lgkmcnt(8)
s_barrier
MAV 32,0,112
TR 32,7,25344
s_add_u32 m0, s55, 67584
MAV 48,0,116
buffer_load_dwordx4 v18, s[28:31], s54 offen lds
MAV 52,4,116
TR 34,7,25856
TR 36,7,25376
MAV 36,4,112
TR 38,7,25888
s_add_u32 s52, s53, 262144
MAV 40,8,112
buffer_load_dwordx4 v[96:99], v4, s[16:19], s52 offen sc1
MAV 56,8,116
TR 40,7,25408
MAV 60,12,116
TR 42,7,25920
TR 44,7,25440
MAV 44,12,112
TR 46,7,25952
s_waitcnt lgkmcnt(8)
MAV 64,16,112
buffer_load_dwordx4 v19, s[28:31], s54 offen offset:1056 lds
MAV 80,16,116
s_mov_b32 s54, 2228224
MAV 84,20,116
TR 48,6,25344
TR 50,6,25856
MAV 68,20,112
TR 52,6,25376
TR 54,6,25888
MAV 72,24,112
buffer_load_dwordx4 v[100:103], v4, s[16:19], s52 offen offset:1024 sc1
MAV 88,24,116
TR 56,6,25408
MAV 92,28,116
TR 58,6,25920
TR 60,6,25440
MAV 76,28,112
TR 62,6,25952
s_waitcnt vmcnt(20) lgkmcnt(8)
MAV 32,32,120
.Lpad8:
s_cbranch_execz .Lnopoll40r
TR 0,7,33792
s_add_u32 m0, s55, 76032
MAV 48,32,124
buffer_load_dwordx4 v18, s[28:31], s54 offen lds
MAV 52,36,124
TR 2,7,34304
TR 4,7,33824
MAV 36,36,120
TR 6,7,34336
s_add_u32 s52, s53, 786432
MAV 40,40,120
buffer_load_dwordx4 v[104:107], v4, s[16:19], s52 offen sc1
MAV 56,40,124
TR 8,7,33856
MAV 60,44,124
TR 10,7,34368
TR 12,7,33888
MAV 44,44,120
TR 14,7,34400
s_waitcnt lgkmcnt(8)
MAV 64,48,120
buffer_load_dwordx4 v19, s[28:31], s54 offen offset:1056 lds
MAV 80,48,124
s_mov_b32 s54, 2424832
MAV 84,52,124
TR 16,6,33792
TR 18,6,34304
MAV 68,52,120
TR 20,6,33824
TR 22,6,34336
MAV 72,56,120
buffer_load_dwordx4 v[108:111], v4, s[16:19], s52 offen offset:1024 sc1
MAV 88,56,124
TR 24,6,33856
MAV 92,60,124
TR 26,6,34368
TR 28,6,33888
MAV 76,60,120
TR 30,6,34400
s_waitcnt vmcnt(20) lgkmcnt(8)
s_barrier
MAV 32,0,128
TR 32,7,42240
s_add_u32 m0, s55, 84480
MAV 48,0,132
buffer_load_dwordx4 v18, s[28:31], s54 offen lds
MAV 52,4,132
TR 34,7,42752
TR 36,7,42272
MAV 36,4,128
TR 38,7,42784
s_add_u32 s52, s53, 1179648
MAV 40,8,128
buffer_load_dwordx4 v[112:115], v4, s[16:19], s52 offen sc1
MAV 56,8,132
TR 40,7,42304
MAV 60,12,132
TR 42,7,42816
TR 44,7,42336
MAV 44,12,128
TR 46,7,42848
s_waitcnt lgkmcnt(8)
MAV 64,16,128
buffer_load_dwordx4 v19, s[28:31], s54 offen offset:1056 lds
MAV 80,16,132
s_mov_b32 s54, 2686976
MAV 84,20,132
TR 48,6,42240
TR 50,6,42752
MAV 68,20,128
TR 52,6,42272
TR 54,6,42784
MAV 72,24,128
buffer_load_dwordx4 v[116:119], v4, s[16:19], s52 offen offset:1024 sc1
MAV 88,24,132
TR 56,6,42304
MAV 92,28,132
TR 58,6,42816
TR 60,6,42336
MAV 76,28,128
TR 62,6,42848
s_waitcnt vmcnt(20) lgkmcnt(8)
MAV 32,32,136
TR 0,7,50688
s_add_u32 m0, s55, 92928
MAV 48,32,140
buffer_load_dwordx4 v18, s[28:31], s54 offen lds
MAV 52,36,140
TR 2,7,51200
TR 4,7,50720
MAV 36,36,136
TR 6,7,51232
s_add_u32 s52, s53, 1703936
MAV 40,40,136
buffer_load_dwordx4 v[120:123], v4, s[16:19], s52 offen sc1
MAV 56,40,140
TR 8,7,50752
MAV 60,44,140
TR 10,7,51264
TR 12,7,50784
MAV 44,44,136
TR 14,7,51296
s_waitcnt lgkmcnt(8)
MAV 64,48,136
buffer_load_dwordx4 v19, s[28:31], s54 offen offset:1056 lds
MAV 80,48,140
s_mov_b32 s54, 2883584
MAV 84,52,140
TR 16,6,50688
TR 18,6,51200
MAV 68,52,136
TR 20,6,50720
TR 22,6,51232
MAV 72,56,136
buffer_load_dwordx4 v[124:127], v4, s[16:19], s52 offen offset:1024 sc1
MAV 88,56,140
TR 24,6,50752
MAV 92,60,140
TR 26,6,51264
TR 28,6,50784
MAV 76,60,136
TR 30,6,51296
s_waitcnt vmcnt(20) lgkmcnt(8)
s_barrier
MAV 32,0,144
TR 32,7,59136
s_add_u32 m0, s55, 101376
MAV 48,0,148
buffer_load_dwordx4 v18, s[28:31], s54 offen lds
MAV 52,4,148
TR 34,7,59648
TR 36,7,59168
MAV 36,4,144
TR 38,7,59680
s_add_u32 s52, s53, 2097152
MAV 40,8,144
buffer_load_dwordx4 v[128:131], v4, s[16:19], s52 offen sc1
MAV 56,8,148
TR 40,7,59200
MAV 60,12,148
TR 42,7,59712
TR 44,7,59232
MAV 44,12,144
TR 46,7,59744
s_waitcnt lgkmcnt(8)
MAV 64,16,144
buffer_load_dwordx4 v19, s[28:31], s54 offen offset:1056 lds
MAV 80,16,148
s_mov_b32 s54, 3145728
MAV 84,20,148
TR 48,6,59136
TR 50,6,59648
MAV 68,20,144
TR 52,6,59168
TR 54,6,59680
MAV 72,24,144
buffer_load_dwordx4 v[132:135], v4, s[16:19], s52 offen offset:1024 sc1
MAV 88,24,148
TR 56,6,59200
MAV 92,28,148
TR 58,6,59712
TR 60,6,59232
MAV 76,28,144
TR 62,6,59744
v_add_u32 v7, s57, v7
v_add_u32 v6, s57, v6
s_sub_u32 s57, 0, s57
s_waitcnt vmcnt(20) lgkmcnt(8)
MAV 32,32,152
ds_read_b64_tr_b16 a[0:1], v7
s_add_u32 m0, s55, 109824
MAV 48,32,156
buffer_load_dwordx4 v18, s[28:31], s54 offen lds
MAV 52,36,156
TR 2,7,512
TR 4,7,32
MAV 36,36,152
TR 6,7,544
s_add_u32 s52, s53, 2621440
MAV 40,40,152
buffer_load_dwordx4 v[136:139], v4, s[16:19], s52 offen sc1
MAV 56,40,156
TR 8,7,64
MAV 60,44,156
TR 10,7,576
TR 12,7,96
MAV 44,44,152
TR 14,7,608
s_waitcnt lgkmcnt(8)
MAV 64,48,152
buffer_load_dwordx4 v19, s[28:31], s54 offen offset:1056 lds
MAV 80,48,156
s_mov_b32 s54, 3342336
MAV 84,52,156
ds_read_b64_tr_b16 a[16:17], v6
TR 18,6,512
MAV 68,52,152
TR 20,6,32
TR 22,6,544
MAV 72,56,152
buffer_load_dwordx4 v[140:143], v4, s[16:19], s52 offen offset:1024 sc1
MAV 88,56,156
TR 24,6,64
MAV 92,60,156
TR 26,6,576
TR 28,6,96
MAV 76,60,152
TR 30,6,608
s_waitcnt vmcnt(20) lgkmcnt(8)
s_barrier
MAV 32,0,96
TR 32,7,8448
s_add_u32 m0, s55, 118272
MAV 48,0,100
buffer_load_dwordx4 v18, s[28:31], s54 offen lds
MAV 52,4,100
TR 34,7,8960
TR 36,7,8480
MAV 36,4,96
TR 38,7,8992
s_add_u32 s52, s53, 3014656
MAV 40,8,96
buffer_load_dwordx4 v[144:147], v4, s[16:19], s52 offen sc1
MAV 56,8,100
TR 40,7,8512
MAV 60,12,100
TR 42,7,9024
TR 44,7,8544
MAV 44,12,96
TR 46,7,9056
s_waitcnt lgkmcnt(8)
MAV 64,16,96
buffer_load_dwordx4 v19, s[28:31], s54 offen offset:1056 lds
MAV 80,16,100
s_mov_b32 s54, 3604480
MAV 84,20,100
TR 48,6,8448
TR 50,6,8960
MAV 68,20,96
TR 52,6,8480
TR 54,6,8992
MAV 72,24,96
buffer_load_dwordx4 v[148:151], v4, s[16:19], s52 offen offset:1024 sc1
MAV 88,24,100
TR 56,6,8512
MAV 92,28,100
TR 58,6,9024
TR 60,6,8544
MAV 76,28,96
TR 62,6,9056
s_waitcnt vmcnt(20) lgkmcnt(8)
MAV 32,32,104
TR 0,7,16896
s_add_u32 m0, s55, 126720
MAV 48,32,108
buffer_load_dwordx4 v18, s[28:31], s54 offen lds
MAV 52,36,108
TR 2,7,17408
TR 4,7,16928
MAV 36,36,104
TR 6,7,17440
s_add_u32 s52, s53, 3538944
MAV 40,40,104
buffer_load_dwordx4 v[152:155], v4, s[16:19], s52 offen sc1
MAV 56,40,108
TR 8,7,16960
MAV 60,44,108
TR 10,7,17472
TR 12,7,16992
MAV 44,44,104
TR 14,7,17504
s_waitcnt lgkmcnt(8)
MAV 64,48,104
buffer_load_dwordx4 v19, s[28:31], s54 offen offset:1056 lds
MAV 80,48,108
s_mov_b32 s54, 196608
MAV 84,52,108
TR 16,6,16896
TR 18,6,17408
MAV 68,52,104
TR 20,6,16928
TR 22,6,17440
MAV 72,56,104
buffer_load_dwordx4 v[156:159], v4, s[16:19], s52 offen offset:1024 sc1
MAV 88,56,108
TR 24,6,16960
MAV 92,60,108
TR 26,6,17472
TR 28,6,16992
MAV 76,60,104
TR 30,6,17504
s_waitcnt vmcnt(20) lgkmcnt(8)
s_barrier
MAV 32,0,112
TR 32,7,25344
s_add_u32 m0, s55, 0
MAV 48,0,116
buffer_load_dwordx4 v18, s[28:31], s54 offen lds
MAV 52,4,116
TR 34,7,25856
TR 36,7,25376
MAV 36,4,112
TR 38,7,25888
s_add_u32 s52, s53, 3932160
MAV 40,8,112
buffer_load_dwordx4 v[96:99], v4, s[16:19], s52 offen sc1
MAV 56,8,116
TR 40,7,25408
MAV 60,12,116
TR 42,7,25920
TR 44,7,25440
MAV 44,12,112
TR 46,7,25952
s_waitcnt lgkmcnt(8)
MAV 64,16,112
buffer_load_dwordx4 v19, s[28:31], s54 offen offset:1056 lds
MAV 80,16,116
s_mov_b32 s54, 655360
MAV 84,20,116
TR 48,6,25344
TR 50,6,25856
MAV 68,20,112
TR 52,6,25376
TR 54,6,25888
MAV 72,24,112
buffer_load_dwordx4 v[100:103], v4, s[16:19], s52 offen offset:1024 sc1
MAV 88,24,116
TR 56,6,25408
MAV 92,28,116
TR 58,6,25920
TR 60,6,25440
MAV 76,28,112
TR 62,6,25952
s_waitcnt vmcnt(20) lgkmcnt(8)
MAV 32,32,120
TR 0,7,33792
s_add_u32 m0, s55, 8448
MAV 48,32,124
buffer_load_dwordx4 v18, s[28:31], s54 offen lds
MAV 52,36,124
TR 2,7,34304
TR 4,7,33824
MAV 36,36,120
TR 6,7,34336
s_add_u32 s52, s53, 4456448
MAV 40,40,120
buffer_load_dwordx4 v[104:107], v4, s[16:19], s52 offen sc1
MAV 56,40,124
TR 8,7,33856
MAV 60,44,124
TR 10,7,34368
TR 12,7,33888
MAV 44,44,120
TR 14,7,34400
s_waitcnt lgkmcnt(8)
MAV 64,48,120
buffer_load_dwordx4 v19, s[28:31], s54 offen offset:1056 lds
MAV 80,48,124
s_mov_b32 s54, 1114112
MAV 84,52,124
TR 16,6,33792
TR 18,6,34304
MAV 68,52,120
TR 20,6,33824
TR 22,6,34336
MAV 72,56,120
buffer_load_dwordx4 v[108:111], v4, s[16:19], s52 offen offset:1024 sc1
MAV 88,56,124
TR 24,6,33856
MAV 92,60,124
TR 26,6,34368
TR 28,6,33888
MAV 76,60,120
TR 30,6,34400
s_waitcnt vmcnt(20) lgkmcnt(8)
s_barrier
MAV 32,0,128
TR 32,7,42240
s_add_u32 m0, s55, 16896
MAV 48,0,132
buffer_load_dwordx4 v18, s[28:31], s54 offen lds
MAV 52,4,132
TR 34,7,42752
TR 36,7,42272
MAV 36,4,128
TR 38,7,42784
s_add_u32 s52, s53, 4849664
MAV 40,8,128
buffer_load_dwordx4 v[112:115], v4, s[16:19], s52 offen sc1
MAV 56,8,132
TR 40,7,42304
MAV 60,12,132
TR 42,7,42816
TR 44,7,42336
MAV 44,12,128
TR 46,7,42848
s_waitcnt lgkmcnt(8)
MAV 64,16,128
buffer_load_dwordx4 v19, s[28:31], s54 offen offset:1056 lds
MAV 80,16,132
s_mov_b32 s54, 1572864
MAV 84,20,132
TR 48,6,42240
TR 50,6,42752
MAV 68,20,128
TR 52,6,42272
TR 54,6,42784
MAV 72,24,128
buffer_load_dwordx4 v[116:119], v4, s[16:19], s52 offen offset:1024 sc1
MAV 88,24,132
TR 56,6,42304
MAV 92,28,132
TR 58,6,42816
TR 60,6,42336
MAV 76,28,128
TR 62,6,42848
s_waitcnt vmcnt(20) lgkmcnt(8)
MAV 32,32,136
TR 0,7,50688
s_add_u32 m0, s55, 25344
MAV 48,32,140
buffer_load_dwordx4 v18, s[28:31], s54 offen lds
MAV 52,36,140
TR 2,7,51200
TR 4,7,50720
MAV 36,36,136
TR 6,7,51232
s_add_u32 s52, s53, 5373952
MAV 40,40,136
buffer_load_dwordx4 v[120:123], v4, s[16:19], s52 offen sc1
MAV 56,40,140
TR 8,7,50752
MAV 60,44,140
TR 10,7,51264
TR 12,7,50784
MAV 44,44,136
TR 14,7,51296
s_waitcnt lgkmcnt(8)
MAV 64,48,136
buffer_load_dwordx4 v19, s[28:31], s54 offen offset:1056 lds
MAV 80,48,140
s_mov_b32 s54, 2031616
MAV 84,52,140
TR 16,6,50688
TR 18,6,51200
MAV 68,52,136
TR 20,6,50720
TR 22,6,51232
MAV 72,56,136
buffer_load_dwordx4 v[124:127], v4, s[16:19], s52 offen offset:1024 sc1
MAV 88,56,140
TR 24,6,50752
MAV 92,60,140
TR 26,6,51264
TR 28,6,50784
MAV 76,60,136
TR 30,6,51296
s_waitcnt vmcnt(20) lgkmcnt(8)
s_barrier
MAV 32,0,144
TR 32,7,59136
s_add_u32 m0, s55, 33792
MAV 48,0,148
buffer_load_dwordx4 v18, s[28:31], s54 offen lds
MAV 52,4,148
TR 34,7,59648
TR 36,7,59168
MAV 36,4,144
TR 38,7,59680
s_add_u32 s52, s53, 5767168
MAV 40,8,144
buffer_load_dwordx4 v[128:131], v4, s[16:19], s52 offen sc1
MAV 56,8,148
TR 40,7,59200
MAV 60,12,148
TR 42,7,59712
TR 44,7,59232
MAV 44,12,144
TR 46,7,59744
s_waitcnt lgkmcnt(8)
MAV 64,16,144
buffer_load_dwordx4 v19, s[28:31], s54 offen offset:1056 lds
MAV 80,16,148
s_mov_b32 s54, 2490368
MAV 84,20,148
TR 48,6,59136
TR 50,6,59648
MAV 68,20,144
TR 52,6,59168
TR 54,6,59680
MAV 72,24,144
buffer_load_dwordx4 v[132:135], v4, s[16:19], s52 offen offset:1024 sc1
MAV 88,24,148
TR 56,6,59200
MAV 92,28,148
TR 58,6,59712
TR 60,6,59232
MAV 76,28,144
TR 62,6,59744
v_add_u32 v7, s57, v7
v_add_u32 v6, s57, v6
s_sub_u32 s57, 0, s57
s_waitcnt vmcnt(20) lgkmcnt(8)
MAV 32,32,152
ds_read_b64_tr_b16 a[0:1], v6
s_add_u32 m0, s55, 42240
MAV 48,32,156
buffer_load_dwordx4 v18, s[28:31], s54 offen lds
MAV 52,36,156
TR 2,6,512
TR 4,6,32
MAV 36,36,152
TR 6,6,544
s_add_u32 s52, s53, 6291456
MAV 40,40,152
buffer_load_dwordx4 v[136:139], v4, s[16:19], s52 offen sc1
MAV 56,40,156
TR 8,6,64
MAV 60,44,156
TR 10,6,576
TR 12,6,96
MAV 44,44,152
TR 14,6,608
s_waitcnt lgkmcnt(8)
MAV 64,48,152
buffer_load_dwordx4 v19, s[28:31], s54 offen offset:1056 lds
MAV 80,48,156
s_mov_b32 s54, 2949120
MAV 84,52,156
TR 16,6,8448
TR 18,6,8960
.Lpad9:
s_cbranch_execz .Lnopoll40r
MAV 68,52,152
TR 20,6,8480
TR 22,6,8992
MAV 72,56,152
buffer_load_dwordx4 v[140:143], v4, s[16:19], s52 offen offset:1024 sc1
MAV 88,56,156
TR 24,6,8512
MAV 92,60,156
TR 26,6,9024
TR 28,6,8544
MAV 76,60,152
TR 30,6,9056
s_waitcnt vmcnt(20) lgkmcnt(8)
s_barrier
MAV 64,0,96
TR 32,6,16896
TR 34,6,17408
s_add_u32 m0, s55, 50688
MAV 80,0,100
TR 36,6,16928
buffer_load_dwordx4 v18, s[28:31], s54 offen lds
MAV 84,4,100
buffer_load_dwordx4 v19, s[28:31], s54 offen offset:1056 lds
MAV 68,4,96
TR 38,6,17440
s_mov_b32 s54, 3407872
s_add_u32 s52, s53, 6684672
MAV 72,8,96
TR 40,6,16960
buffer_load_dwordx4 v[144:147], v4, s[16:19], s52 offen sc1
MAV 88,8,100
TR 42,6,17472
MAV 92,12,100
TR 44,6,16992
buffer_load_dwordx4 v[148:151], v4, s[16:19], s52 offen offset:1024 sc1
MAV 76,12,96
TR 46,6,17504
s_add_u32 m0, s55, 59136
s_waitcnt vmcnt(20) lgkmcnt(8)
MAV 64,16,104
buffer_load_dwordx4 v18, s[28:31], s54 offen lds
MAV 80,16,108
TR 48,6,25344
TR 50,6,25856
MAV 84,20,108
TR 52,6,25376
buffer_load_dwordx4 v19, s[28:31], s54 offen offset:1056 lds
MAV 68,20,104
TR 54,6,25888
s_add_u32 s52, s53, 7208960
MAV 72,24,104
TR 56,6,25408
buffer_load_dwordx4 v[152:155], v4, s[16:19], s52 offen sc1
MAV 88,24,108
TR 58,6,25920
MAV 92,28,108
TR 60,6,25440
buffer_load_dwordx4 v[156:159], v4, s[16:19], s52 offen offset:1024 sc1
MAV 76,28,104
TR 62,6,25952
s_waitcnt vmcnt(20) lgkmcnt(8)
MAV 64,32,112
TR 0,6,33792
s_add_u32 s52, s53, 393216
s_lshl_b32 s70, s2, 10
MAV 80,32,116
buffer_load_dwordx4 v[160:163], v4, s[16:19], s52 offen sc1
s_lshl_b32 s62, s3, 7
MAV 84,36,116
TR 2,6,34304
TR 4,6,33824
MAV 68,36,112
TR 6,6,34336
s_add_u32 s70, s70, s62
s_add_u32 s70, s70, 31457280
MAV 72,40,112
buffer_load_dwordx4 v[164:167], v4, s[16:19], s52 offen offset:1024 sc1
s_xor_b32 s71, s70, 1024
MAV 88,40,116
TR 8,6,33856
TR 10,6,34368
MAV 92,44,116
TR 12,6,33888
v_min_u32 v12, 1, v1
v_lshlrev_b32 v12, 28, v12
MAV 76,44,112
TR 14,6,34400
s_add_u32 s52, s53, 1310720
s_waitcnt vmcnt(18) lgkmcnt(8)
MAV 64,48,120
buffer_load_dwordx4 v[168:171], v4, s[16:19], s52 offen sc1
v_mov_b32 v13, 1
MAV 80,48,124
TR 16,6,42240
v_mov_b32 v15, 0
s_lshl_b32 s68, s7, 18
MAV 84,52,124
TR 18,6,42752
TR 20,6,42272
MAV 68,52,120
TR 22,6,42784
s_add_u32 s68, s68, 33554432
s_xor_b32 s69, s68, 262144
MAV 72,56,120
buffer_load_dwordx4 v[172:175], v4, s[16:19], s52 offen offset:1024 sc1
v_mov_b32 v11, v4
MAV 88,56,124
TR 24,6,42304
TR 26,6,42816
MAV 92,60,124
TR 28,6,42336
v_and_b32 v2, 1, v1
v_lshlrev_b32 v2, 4, v2
MAV 76,60,120
TR 30,6,42848
v_mov_b32 v224, 0x3f80
s_waitcnt vmcnt(16) lgkmcnt(8)
MAV 64,0,128
TR 32,6,50688
s_add_u32 s52, s53, 2228224
v_lshlrev_b32 v2, v2, v224
MAV 80,0,132
buffer_load_dwordx4 v[176:179], v4, s[16:19], s52 offen sc1
v_bfe_u32 v224, v1, 2, 2
MAV 84,4,132
TR 34,6,51200
TR 36,6,50720
MAV 68,4,128
TR 38,6,51232
v_lshrrev_b32 v225, 4, v1
v_cmp_eq_u32 vcc, v224, v225
MAV 72,8,128
buffer_load_dwordx4 v[180:183], v4, s[16:19], s52 offen offset:1024 sc1
v_cndmask_b32 v2, 0, v2, vcc
MAV 88,8,132
TR 40,6,50752
TR 42,6,51264
MAV 92,12,132
TR 44,6,50784
v_and_b32 v224, 2, v1
v_cmp_eq_u32 vcc, 0, v224
MAV 76,12,128
TR 46,6,51296
s_add_u32 s52, s53, 3145728
s_waitcnt vmcnt(14) lgkmcnt(8)
MAV 64,16,136
buffer_load_dwordx4 v[184:187], v4, s[16:19], s52 offen sc1
v_cndmask_b32 v226, 0, v2, vcc
MAV 80,16,140
TR 48,6,59136
v_cndmask_b32 v227, v2, 0, vcc
v_mov_b32 v224, 0
MAV 84,20,140
TR 50,6,59648
TR 52,6,59168
MAV 68,20,136
TR 54,6,59680
v_mov_b32 v225, 0
v_mov_b32 v228, 0
MAV 72,24,136
buffer_load_dwordx4 v[188:191], v4, s[16:19], s52 offen offset:1024 sc1
v_mov_b32 v229, 0
MAV 88,24,140
TR 56,6,59200
TR 58,6,59712
MAV 92,28,140
TR 60,6,59232
v_bfe_u32 v18, v1, 3, 1
v_lshrrev_b32 v2, 4, v1
MAV 76,28,136
TR 62,6,59744
v_lshl_add_u32 v18, v2, 3, v18
s_waitcnt vmcnt(10) lgkmcnt(8)
s_barrier
v_add_u32 v6, s57, v6
MAV 64,32,144
ds_read_b64_tr_b16 a[0:1], v6
s_add_u32 s52, s53, 4063232
s_lshl_b32 s62, s3, 1
MAV 80,32,148
buffer_load_dwordx4 v[192:195], v4, s[16:19], s52 offen sc1
v_add_u32 v18, s62, v18
MAV 84,36,148
TR 2,6,512
TR 4,6,32
MAV 68,36,144
TR 6,6,544
v_mul_u32_u24 v18, 6144, v18
v_and_b32 v2, 7, v1
MAV 72,40,144
buffer_load_dwordx4 v[196:199], v4, s[16:19], s52 offen offset:1024 sc1
v_lshl_add_u32 v18, v2, 4, v18
MAV 88,40,148
TR 8,6,64
TR 10,6,576
MAV 92,44,148
TR 12,6,96
s_lshl_b32 s62, s9, 7
v_add_u32 v18, s62, v18
MAV 76,44,144
TR 14,6,608
s_add_u32 s52, s53, 4980736
s_waitcnt vmcnt(10) lgkmcnt(8)
MAV 64,48,152
buffer_load_dwordx4 v[200:203], v4, s[16:19], s52 offen sc1
v_add_u32 v19, 1024, v18
MAV 80,48,156
TR 16,6,8448
v_add_u32 v20, 2048, v18
s_mul_i32 s59, s3, 3104
MAV 84,52,156
TR 18,6,8960
TR 20,6,8480
MAV 68,52,152
TR 22,6,8992
s_mov_b32 s58, 0
v_accvgpr_read_b32 v28, a224
MAV 72,56,152
buffer_load_dwordx4 v[204:207], v4, s[16:19], s52 offen offset:1024 sc1
v_add_f32 v32, v32, v28
MAV 88,56,156
TR 24,6,8512
TR 26,6,9024
MAV 92,60,156
TR 28,6,8544
v_accvgpr_read_b32 v29, a225
v_add_f32 v33, v33, v29
MAV 76,60,152
TR 30,6,9056
v_accvgpr_read_b32 v28, a226
s_waitcnt vmcnt(10) lgkmcnt(8)
MAV 64,0,160
TR 32,6,16896
s_add_u32 s52, s53, 5898240
v_add_f32 v34, v34, v28
MAV 80,0,164
buffer_load_dwordx4 v[208:211], v4, s[16:19], s52 offen sc1
v_accvgpr_read_b32 v29, a227
MAV 84,4,164
TR 34,6,17408
TR 36,6,16928
MAV 68,4,160
TR 38,6,17440
v_add_f32 v35, v35, v29
v_accvgpr_read_b32 v28, a228
MAV 72,8,160
buffer_load_dwordx4 v[212:215], v4, s[16:19], s52 offen offset:1024 sc1
v_add_f32 v36, v36, v28
MAV 88,8,164
TR 40,6,16960
TR 42,6,17472
MAV 92,12,164
TR 44,6,16992
v_accvgpr_read_b32 v29, a229
v_add_f32 v37, v37, v29
MAV 76,12,160
TR 46,6,17504
s_add_u32 s52, s53, 6815744
s_waitcnt vmcnt(10) lgkmcnt(8)
MAV 64,16,168
buffer_load_dwordx4 v[216:219], v4, s[16:19], s52 offen sc1
v_accvgpr_read_b32 v28, a230
MAV 80,16,172
TR 48,6,25344
v_add_f32 v38, v38, v28
v_accvgpr_read_b32 v29, a231
MAV 84,20,172
TR 50,6,25856
TR 52,6,25376
MAV 68,20,168
TR 54,6,25888
v_add_f32 v39, v39, v29
v_accvgpr_read_b32 v28, a232
MAV 72,24,168
buffer_load_dwordx4 v[220:223], v4, s[16:19], s52 offen offset:1024 sc1
v_add_f32 v40, v40, v28
MAV 88,24,172
TR 56,6,25408
TR 58,6,25920
MAV 92,28,172
TR 60,6,25440
v_accvgpr_read_b32 v29, a233
v_add_f32 v41, v41, v29
MAV 76,28,168
TR 62,6,25952
v_accvgpr_read_b32 v28, a234
s_waitcnt vmcnt(10) lgkmcnt(8)
MAV 64,32,176
TR 0,6,33792
v_add_f32 v42, v42, v28
v_accvgpr_read_b32 v29, a235
MAV 80,32,180
TR 2,6,34304
v_add_f32 v43, v43, v29
MAV 84,36,180
TR 4,6,33824
v_accvgpr_read_b32 v28, a236
MAV 68,36,176
TR 6,6,34336
v_add_f32 v44, v44, v28
MAV 72,40,176
TR 8,6,33856
v_accvgpr_read_b32 v29, a237
MAV 88,40,180
TR 10,6,34368
v_add_f32 v45, v45, v29
MAV 92,44,180
TR 12,6,33888
v_accvgpr_read_b32 v28, a238
MAV 76,44,176
TR 14,6,34400
s_waitcnt vmcnt(8) lgkmcnt(8)
MAV 64,48,184
TR 16,6,42240
v_add_f32 v46, v46, v28
MAV 80,48,188
TR 18,6,42752
v_accvgpr_read_b32 v29, a239
MAV 84,52,188
TR 20,6,42272
v_add_f32 v47, v47, v29
MAV 68,52,184
TR 22,6,42784
v_accvgpr_read_b32 v28, a240
MAV 72,56,184
TR 24,6,42304
v_add_f32 v48, v48, v28
MAV 88,56,188
TR 26,6,42816
v_accvgpr_read_b32 v29, a241
MAV 92,60,188
TR 28,6,42336
v_add_f32 v49, v49, v29
MAV 76,60,184
TR 30,6,42848
v_accvgpr_read_b32 v28, a242
s_waitcnt vmcnt(6) lgkmcnt(8)
MAV 64,0,192
TR 32,6,50688
v_add_f32 v50, v50, v28
v_accvgpr_read_b32 v29, a243
MAV 80,0,196
TR 34,6,51200
v_add_f32 v51, v51, v29
MAV 84,4,196
TR 36,6,50720
v_accvgpr_read_b32 v28, a244
MAV 68,4,192
TR 38,6,51232
v_add_f32 v52, v52, v28
MAV 72,8,192
TR 40,6,50752
v_accvgpr_read_b32 v29, a245
MAV 88,8,196
TR 42,6,51264
v_add_f32 v53, v53, v29
MAV 92,12,196
TR 44,6,50784
v_accvgpr_read_b32 v28, a246
MAV 76,12,192
TR 46,6,51296
s_waitcnt vmcnt(4) lgkmcnt(8)
MAV 64,16,200
TR 48,6,59136
v_add_f32 v54, v54, v28
MAV 80,16,204
TR 50,6,59648
v_accvgpr_read_b32 v29, a247
MAV 84,20,204
TR 52,6,59168
v_add_f32 v55, v55, v29
MAV 68,20,200
TR 54,6,59680
v_accvgpr_read_b32 v28, a248
MAV 72,24,200
TR 56,6,59200
v_add_f32 v56, v56, v28
MAV 88,24,204
TR 58,6,59712
v_accvgpr_read_b32 v29, a249
MAV 92,28,204
TR 60,6,59232
v_add_f32 v57, v57, v29
MAV 76,28,200
TR 62,6,59744
v_accvgpr_read_b32 v28, a250
s_waitcnt vmcnt(2) lgkmcnt(8)
MAV 64,32,208
ds_read_b64_tr_b16 a[0:1], v7
v_add_f32 v58, v58, v28
MAV 80,32,212
TR 2,7,512
v_accvgpr_read_b32 v29, a251
MAV 84,36,212
TR 4,7,32
v_add_f32 v59, v59, v29
MAV 68,36,208
TR 6,7,544
MAV 72,40,208
TR 8,7,64
v_accvgpr_read_b32 v28, a252
MAV 88,40,212
TR 10,7,576
v_add_f32 v60, v60, v28
MAV 92,44,212
TR 12,7,96
v_accvgpr_read_b32 v29, a253
MAV 76,44,208
TR 14,7,608
s_waitcnt vmcnt(0) lgkmcnt(8)
MAV 64,48,216
TR 16,7,8448
MAV 80,48,220
TR 18,7,8960
v_add_f32 v61, v61, v29
MAV 84,52,220
TR 20,7,8480
v_accvgpr_read_b32 v28, a254
MAV 68,52,216
TR 22,7,8992
v_add_f32 v62, v62, v28
MAV 72,56,216
TR 24,7,8512
MAV 88,56,220
TR 26,7,9024
v_accvgpr_read_b32 v29, a255
MAV 92,60,220
TR 28,7,8544
v_add_f32 v63, v63, v29
MAV 76,60,216
TR 30,7,9056
s_waitcnt lgkmcnt(8)
MAV 32,0,96
TR 32,7,16896
v_cvt_pk_bf16_f32 v232, v64, v65
v_cvt_pk_bf16_f32 v233, v66, v67
MAV 48,0,100
TR 34,7,17408
v_cvt_pk_bf16_f32 v234, v68, v69
MAV 52,4,100
TR 36,7,16928
v_cvt_pk_bf16_f32 v235, v70, v71
buffer_store_dwordx4 v[232:235], v11, s[16:19], s69 offen sc1
MAV 36,4,96
TR 38,7,17440
s_add_u32 s69, s69, 131072
MAV 40,8,96
TR 40,7,16960
v_cvt_pk_bf16_f32 v236, v72, v73
v_cvt_pk_bf16_f32 v237, v74, v75
MAV 56,8,100
TR 42,7,17472
v_cvt_pk_bf16_f32 v238, v76, v77
MAV 60,12,100
TR 44,7,16992
v_cvt_pk_bf16_f32 v239, v78, v79
buffer_store_dwordx4 v[236:239], v11, s[16:19], s69 offen sc1
MAV 44,12,96
TR 46,7,17504
s_add_u32 s69, s69, -130048
s_waitcnt lgkmcnt(8)
MAV 32,16,104
TR 48,7,25344
v_cvt_pk_bf16_f32 v240, v80, v81
MAV 48,16,108
TR 50,7,25856
v_cvt_pk_bf16_f32 v241, v82, v83
v_cvt_pk_bf16_f32 v242, v84, v85
MAV 52,20,108
TR 52,7,25376
v_cvt_pk_bf16_f32 v243, v86, v87
MAV 36,20,104
TR 54,7,25888
buffer_store_dwordx4 v[240:243], v11, s[16:19], s69 offen sc1
s_add_u32 s69, s69, 131072
MAV 40,24,104
TR 56,7,25408
v_cvt_pk_bf16_f32 v244, v88, v89
MAV 56,24,108
TR 58,7,25920
v_cvt_pk_bf16_f32 v245, v90, v91
v_cvt_pk_bf16_f32 v246, v92, v93
MAV 60,28,108
TR 60,7,25440
v_cvt_pk_bf16_f32 v247, v94, v95
MAV 44,28,104
TR 62,7,25952
buffer_store_dwordx4 v[244:247], v11, s[16:19], s69 offen sc1
s_waitcnt lgkmcnt(8)
MAV 32,32,112
TR 0,7,33792
MAV 48,32,116
TR 2,7,34304
MAV 52,36,116
TR 4,7,33824
MAV 36,36,112
TR 6,7,34336
MAV 40,40,112
TR 8,7,33856
MAV 56,40,116
TR 10,7,34368
MAV 60,44,116
TR 12,7,33888
MAV 44,44,112
TR 14,7,34400
s_waitcnt lgkmcnt(8)
MAV 32,48,120
TR 16,7,42240
MAV 48,48,124
TR 18,7,42752
MAV 52,52,124
TR 20,7,42272
MAV 36,52,120
TR 22,7,42784
MAV 40,56,120
TR 24,7,42304
MAV 56,56,124
TR 26,7,42816
MAV 60,60,124
TR 28,7,42336
MAV 44,60,120
TR 30,7,42848
s_waitcnt lgkmcnt(8)
MAV 32,0,128
TR 32,7,50688
MAV 48,0,132
TR 34,7,51200
MAV 52,4,132
TR 36,7,50720
MAV 36,4,128
TR 38,7,51232
MAV 40,8,128
TR 40,7,50752
MAV 56,8,132
TR 42,7,51264
MAV 60,12,132
TR 44,7,50784
MAV 44,12,128
TR 46,7,51296
s_waitcnt lgkmcnt(8)
MAV 32,16,136
TR 48,7,59136
MAV 48,16,140
TR 50,7,59648
MAV 52,20,140
TR 52,7,59168
MAV 36,20,136
TR 54,7,59680
MAV 40,24,136
TR 56,7,59200
MAV 56,24,140
TR 58,7,59712
MAV 60,28,140
TR 60,7,59232
.Lpad10:
s_cbranch_execz .Lnopoll40r
MAV 44,28,136
TR 62,7,59744
v_add_u32 v7, s57, v7
s_waitcnt lgkmcnt(8)
MAV 32,32,144
ds_read_b64_tr_b16 a[0:1], v7
TR 2,7,512
MAV 48,32,148
s_waitcnt vmcnt(0)
buffer_atomic_add v13, v12, s[16:19], s71 offen
MAV 52,36,148
TR 4,7,32
MAV 36,36,144
TR 6,7,544
MAV 40,40,144
TR 8,7,64
MAV 56,40,148
TR 10,7,576
MAV 60,44,148
TR 12,7,96
MAV 44,44,144
TR 14,7,608
s_waitcnt lgkmcnt(8)
MAV 32,48,152
TR 16,7,8448
MAV 48,48,156
TR 18,7,8960
MAV 52,52,156
TR 20,7,8480
MAV 36,52,152
TR 22,7,8992
MAV 40,56,152
TR 24,7,8512
MAV 56,56,156
TR 26,7,9024
MAV 60,60,156
TR 28,7,8544
MAV 44,60,152
TR 30,7,9056
s_waitcnt lgkmcnt(8)
s_barrier
MAV 32,0,160
TR 32,7,16896
TR 34,7,17408
MAV 48,0,164
buffer_atomic_add v15, v12, s[16:19], s70 offen sc0
MAV 52,4,164
TR 36,7,16928
TR 38,7,17440
MAV 36,4,160
TR 40,7,16960
s_add_u32 m0, s59, 117248
MAV 40,8,160
buffer_load_dwordx4 v18, s[20:23], s58 offen lds
MAV 56,8,164
TR 42,7,17472
TR 44,7,16992
MAV 60,12,164
TR 46,7,17504
MAV 44,12,160
TR 48,7,25344
s_waitcnt lgkmcnt(9)
MAV 32,16,168
buffer_load_dwordx4 v19, s[20:23], s58 offen offset:1024 lds
MAV 48,16,172
TR 50,7,25856
TR 52,7,25376
MAV 52,20,172
buffer_load_dwordx4 v20, s[20:23], s58 offen offset:2048 lds
MAV 36,20,168
TR 54,7,25888
s_add_u32 s58, s58, 196608
MAV 40,24,168
TR 56,7,25408
s_add_u32 m0, s59, 129664
MAV 56,24,172
buffer_load_dwordx4 v18, s[20:23], s58 offen lds
MAV 60,28,172
TR 58,7,25920
TR 60,7,25440
MAV 44,28,168
TR 62,7,25952
s_waitcnt lgkmcnt(8)
MAV 32,32,176
TR 0,7,33792
TR 2,7,34304
MAV 48,32,180
buffer_load_dwordx4 v19, s[20:23], s58 offen offset:1024 lds
MAV 52,36,180
TR 4,7,33824
MAV 36,36,176
TR 6,7,34336
TR 8,7,33856
MAV 40,40,176
buffer_load_dwordx4 v20, s[20:23], s58 offen offset:2048 lds
MAV 56,40,180
TR 10,7,34368
s_add_u32 s58, s58, 196608
MAV 60,44,180
TR 12,7,33888
MAV 44,44,176
TR 14,7,34400
s_add_u32 m0, s59, 67584
s_waitcnt lgkmcnt(8)
MAV 32,48,184
buffer_load_dwordx4 v18, s[20:23], s58 offen lds
MAV 48,48,188
TR 16,7,42240
MAV 52,52,188
TR 18,7,42752
TR 20,7,42272
MAV 36,52,184
TR 22,7,42784
MAV 40,56,184
buffer_load_dwordx4 v19, s[20:23], s58 offen offset:1024 lds
MAV 56,56,188
TR 24,7,42304
TR 26,7,42816
MAV 60,60,188
TR 28,7,42336
MAV 44,60,184
TR 30,7,42848
s_waitcnt vmcnt(8)
v_cmp_ne_u32 vcc, 0, v15
s_nop 0
s_cbranch_vccz .Lxs50
.Lxs50b:
s_waitcnt lgkmcnt(8)
MAV 32,0,192
TR 32,7,50688
TR 34,7,51200
MAV 48,0,196
TR 36,7,50720
buffer_load_dwordx4 v[232:235], v11, s[16:19], s68 offen sc1
MAV 52,4,196
TR 38,7,51232
s_add_u32 s68, s68, 131072
MAV 36,4,192
TR 40,7,50752
buffer_load_dwordx4 v[236:239], v11, s[16:19], s68 offen sc1
MAV 40,8,192
TR 42,7,51264
s_add_u32 s68, s68, -130048
MAV 56,8,196
TR 44,7,50784
buffer_load_dwordx4 v[240:243], v11, s[16:19], s68 offen sc1
MAV 60,12,196
TR 46,7,51296
s_add_u32 s68, s68, 131072
MAV 44,12,192
buffer_load_dwordx4 v[244:247], v11, s[16:19], s68 offen sc1
s_waitcnt lgkmcnt(8)
MAV 32,16,200
TR 48,7,59136
buffer_load_dwordx4 v20, s[20:23], s58 offen offset:2048 lds
MAV 48,16,204
TR 50,7,59648
s_add_u32 s58, s58, 196608
s_add_u32 m0, s59, 80000
MAV 52,20,204
TR 52,7,59168
buffer_load_dwordx4 v18, s[20:23], s58 offen lds
MAV 36,20,200
TR 54,7,59680
MAV 40,24,200
TR 56,7,59200
buffer_load_dwordx4 v19, s[20:23], s58 offen offset:1024 lds
MAV 56,24,204
TR 58,7,59712
MAV 60,28,204
TR 60,7,59232
buffer_load_dwordx4 v20, s[20:23], s58 offen offset:2048 lds
MAV 44,28,200
TR 62,7,59744
s_add_u32 s58, s58, 196608
s_waitcnt lgkmcnt(8)
MAV 32,32,208
s_add_u32 m0, s59, 92416
MAV 48,32,212
buffer_load_dwordx4 v18, s[20:23], s58 offen lds
MAV 52,36,212
MAV 36,36,208
MAV 40,40,208
MAV 56,40,212
MAV 60,44,212
buffer_load_dwordx4 v19, s[20:23], s58 offen offset:1024 lds
MAV 44,44,208
s_waitcnt lgkmcnt(0)
MAV 32,48,216
MAV 48,48,220
MAV 52,52,220
MAV 36,52,216
buffer_load_dwordx4 v20, s[20:23], s58 offen offset:2048 lds
MAV 40,56,216
s_add_u32 s58, s58, 196608
MAV 56,56,220
MAV 60,60,220
MAV 44,60,216
s_waitcnt vmcnt(10)
v_mfma_f32_16x16x32_bf16 v[32:35], v[226:229], v[232:235], v[32:35]
s_lshl_b32 s64, s6, 14
s_lshl_b32 s65, s49, 13
s_add_u32 s64, s64, s65
v_mfma_f32_16x16x32_bf16 v[36:39], v[224:227], v[232:235], v[36:39]
s_lshl_b32 s65, s7, 9
s_add_u32 s64, s64, s65
s_lshl_b32 s65, s48, 8
s_waitcnt vmcnt(9)
v_mfma_f32_16x16x32_bf16 v[40:43], v[226:229], v[236:239], v[40:43]
s_add_u32 s64, s64, s65
s_add_u32 s64, s64, 62914560
v_and_b32 v152, 31, v1
v_mfma_f32_16x16x32_bf16 v[44:47], v[224:227], v[236:239], v[44:47]
s_lshl_b32 s62, s7, 18
v_lshlrev_b32 v152, 3, v152
v_lshrrev_b32 v153, 5, v1
s_waitcnt vmcnt(8)
v_mfma_f32_16x16x32_bf16 v[48:51], v[226:229], v[240:243], v[48:51]
s_add_u32 s62, s62, 33554432
v_lshl_add_u32 v152, v153, 28, v152
s_add_u32 s63, s62, 0x20000
v_mfma_f32_16x16x32_bf16 v[52:55], v[224:227], v[240:243], v[52:55]
v_cvt_pk_bf16_f32 v128, v32, v33
v_cvt_pk_bf16_f32 v129, v34, v35
s_waitcnt vmcnt(7)
v_mfma_f32_16x16x32_bf16 v[56:59], v[226:229], v[244:247], v[56:59]
v_cvt_pk_bf16_f32 v130, v36, v37
v_cvt_pk_bf16_f32 v131, v38, v39
v_mfma_f32_16x16x32_bf16 v[60:63], v[224:227], v[244:247], v[60:63]
buffer_store_dwordx4 v[128:131], v4, s[16:19], s62 offen sc1
v_cvt_pk_bf16_f32 v132, v40, v41
v_cvt_pk_bf16_f32 v133, v42, v43
v_cvt_pk_bf16_f32 v134, v44, v45
v_cvt_pk_bf16_f32 v135, v46, v47
v_cvt_pk_bf16_f32 v136, v48, v49
v_cvt_pk_bf16_f32 v137, v50, v51
v_cvt_pk_bf16_f32 v138, v52, v53
v_cvt_pk_bf16_f32 v139, v54, v55
v_cvt_pk_bf16_f32 v140, v56, v57
v_cvt_pk_bf16_f32 v141, v58, v59
v_cvt_pk_bf16_f32 v142, v60, v61
v_cvt_pk_bf16_f32 v143, v62, v63
v_pk_mul_f32 v[146:147], v[32:33], v[32:33]
buffer_store_dwordx4 v[132:135], v4, s[16:19], s63 offen sc1
v_pk_mul_f32 v[150:151], v[48:49], v[48:49]
v_pk_fma_f32 v[146:147], v[34:35], v[34:35], v[146:147]
v_pk_add_f32 v[144:145], v[32:33], v[34:35]
v_pk_fma_f32 v[150:151], v[50:51], v[50:51], v[150:151]
v_pk_add_f32 v[148:149], v[48:49], v[50:51]
v_pk_fma_f32 v[146:147], v[36:37], v[36:37], v[146:147]
v_pk_add_f32 v[144:145], v[144:145], v[36:37]
v_pk_fma_f32 v[150:151], v[52:53], v[52:53], v[150:151]
v_pk_add_f32 v[148:149], v[148:149], v[52:53]
v_pk_fma_f32 v[146:147], v[38:39], v[38:39], v[146:147]
v_pk_add_f32 v[144:145], v[144:145], v[38:39]
v_pk_fma_f32 v[150:151], v[54:55], v[54:55], v[150:151]
v_pk_add_f32 v[148:149], v[148:149], v[54:55]
buffer_store_dwordx4 v[136:139], v4, s[16:19], s62 offen offset:1024 sc1
v_pk_fma_f32 v[146:147], v[40:41], v[40:41], v[146:147]
v_pk_add_f32 v[144:145], v[144:145], v[40:41]
v_pk_fma_f32 v[150:151], v[56:57], v[56:57], v[150:151]
v_pk_add_f32 v[148:149], v[148:149], v[56:57]
v_pk_fma_f32 v[146:147], v[42:43], v[42:43], v[146:147]
v_pk_add_f32 v[144:145], v[144:145], v[42:43]
v_pk_fma_f32 v[150:151], v[58:59], v[58:59], v[150:151]
v_pk_add_f32 v[148:149], v[148:149], v[58:59]
v_pk_fma_f32 v[146:147], v[44:45], v[44:45], v[146:147]
v_pk_add_f32 v[144:145], v[144:145], v[44:45]
v_pk_fma_f32 v[150:151], v[60:61], v[60:61], v[150:151]
v_pk_add_f32 v[148:149], v[148:149], v[60:61]
v_pk_fma_f32 v[146:147], v[46:47], v[46:47], v[146:147]
buffer_store_dwordx4 v[140:143], v4, s[16:19], s63 offen offset:1024 sc1
v_pk_add_f32 v[144:145], v[144:145], v[46:47]
v_pk_fma_f32 v[150:151], v[62:63], v[62:63], v[150:151]
v_pk_add_f32 v[148:149], v[148:149], v[62:63]
v_add_f32 v144, v144, v145
v_add_f32 v146, v146, v147
v_add_f32 v148, v148, v149
v_add_f32 v150, v150, v151
s_nop 0
v_permlane16_swap_b32 v144, v148
v_permlane16_swap_b32 v146, v150
v_add_f32 v144, v144, v148
v_add_f32 v146, v146, v150
s_nop 1
v_permlane32_swap_b32 v144, v146
v_add_f32 v144, v144, v146
s_nop 1
v_permlane32_swap_b32 v144, v145
buffer_store_dwordx2 v[144:145], v152, s[16:19], s64 offen sc1
s_nop 1
v_accvgpr_write_b32 a224, v32
v_accvgpr_write_b32 a225, v33
v_accvgpr_write_b32 a226, v34
v_accvgpr_write_b32 a227, v35
v_accvgpr_write_b32 a228, v36
v_accvgpr_write_b32 a229, v37
v_accvgpr_write_b32 a230, v38
v_accvgpr_write_b32 a231, v39
v_accvgpr_write_b32 a232, v40
v_accvgpr_write_b32 a233, v41
v_accvgpr_write_b32 a234, v42
v_accvgpr_write_b32 a235, v43
v_accvgpr_write_b32 a236, v44
v_accvgpr_write_b32 a237, v45
v_accvgpr_write_b32 a238, v46
v_accvgpr_write_b32 a239, v47
v_accvgpr_write_b32 a240, v48
v_accvgpr_write_b32 a241, v49
v_accvgpr_write_b32 a242, v50
v_accvgpr_write_b32 a243, v51
v_accvgpr_write_b32 a244, v52
v_accvgpr_write_b32 a245, v53
v_accvgpr_write_b32 a246, v54
v_accvgpr_write_b32 a247, v55
v_accvgpr_write_b32 a248, v56
v_accvgpr_write_b32 a249, v57
v_accvgpr_write_b32 a250, v58
v_accvgpr_write_b32 a251, v59
v_accvgpr_write_b32 a252, v60
v_accvgpr_write_b32 a253, v61
v_accvgpr_write_b32 a254, v62
v_accvgpr_write_b32 a255, v63
s_lshl_b32 s62, s8, 13
s_lshl_b32 s63, s3, 11
s_add_u32 s62, s62, s63
v_lshl_add_u32 v21, v1, 4, s62
v_lshrrev_b32 v2, 3, v1
v_cmp_eq_u32 vcc, 3, v2
v_add_u32 v2, 67108480, v21
s_nop 0
v_cndmask_b32 v21, v21, v2, vcc
s_lshl_b32 s62, s50, 10
s_sub_u32 s62, s62, 2048
v_lshl_add_u32 v22, v0, 2, s62
v_lshrrev_b32 v2, 5, v0
v_cmp_eq_u32 vcc, 3, v2
v_add_u32 v2, 67108480, v22
s_nop 0
v_cndmask_b32 v22, v22, v2, vcc
s_mul_i32 s62, s48, 4608
v_lshl_add_u32 v23, v1, 4, s62
v_lshrrev_b32 v24, 4, v1
v_mul_u32_u24 v24, 2304, v24
v_and_b32 v2, 15, v1
v_lshl_add_u32 v24, v2, 4, v24
s_mov_b32 s52, 33554432
s_mov_b32 s54, s58
s_mov_b32 s56, s59
s_mul_i32 s55, s3, 2304
v_bfe_u32 v25, v1, 3, 2
v_mul_u32_u24 v25, 3104, v25
v_bfe_u32 v2, v1, 2, 1
v_lshl_add_u32 v25, v2, 7, v25
v_bfe_u32 v2, v1, 5, 1
v_lshl_add_u32 v25, v2, 8, v25
v_and_b32 v2, 3, v1
v_lshl_add_u32 v25, v2, 3, v25
s_lshl_b32 s62, s49, 6
s_add_u32 s62, s62, 67584
v_add_u32 v25, s62, v25
s_lshl_b32 s62, s8, 1
s_add_u32 s62, s62, s3
s_lshr_b32 s63, s50, 2
s_cmp_lt_u32 s3, 2
s_cselect_b32 s62, s62, s63
s_lshl_b32 s62, s62, 13
s_cmp_eq_u32 s3, 3
s_cselect_b32 s62, 268435456, s62
v_lshl_add_u32 v26, v1, 4, s62
s_lshr_b32 s63, s20, 7
s_sub_u32 s63, 3, s63
s_and_b32 s63, s63, 7
s_and_b32 s62, s9, 8
s_add_u32 s63, s63, s62
s_lshl_b32 s62, s5, 2
s_add_u32 s62, s62, s3
s_mul_i32 s62, s62, 12288
s_lshl_b32 s64, s63, 7
s_add_u32 s62, s62, s64
s_xor_b32 s63, s63, s9
s_cmp_lt_u32 s63, 4
s_cselect_b32 s62, s62, 16777216
v_lshrrev_b32 v14, 3, v1
v_min_u32 v14, 5, v14
v_lshl_add_u32 v14, v14, 11, s62
s_mov_b32 s44, 983040
buffer_load_dword v27, v14, s[20:23], s44 offen
s_mov_b32 s44, 2555904
s_mul_i32 s59, s3, 2080
v_bfe_u32 v5, v1, 3, 1
v_lshrrev_b32 v2, 4, v1
v_lshl_add_u32 v5, v2, 3, v5
s_lshl_b32 s62, s3, 1
v_add_u32 v5, s62, v5
v_mul_u32_u24 v5, 2048, v5
v_and_b32 v2, 7, v1
v_lshl_add_u32 v5, v2, 4, v5
s_lshl_b32 s62, s7, 7
v_add_u32 v5, s62, v5
v_add_u32 v6, 64512, v5
s_lshl_b32 s62, s6, 10
s_add_u32 s62, s62, 30474240
s_lshl_b32 s64, s8, 10
s_add_u32 s64, s64, 30474240
s_lshr_b32 s67, s9, 1
s_and_b32 s67, s67, 3
s_lshl_b32 s67, s67, 7
s_add_u32 s64, s64, s67
s_lshr_b32 s65, s50, 3
s_lshl_b32 s65, s65, 10
s_add_u32 s65, s65, 30474240
s_lshr_b32 s67, s9, 1
s_and_b32 s67, s67, 3
s_lshl_b32 s67, s67, 7
s_add_u32 s65, s65, s67
v_lshl_add_u32 v252, v1, 7, s62
v_mov_b32 v253, s64
v_writelane_b32 v253, s65, 1
s_waitcnt vmcnt(1) lgkmcnt(0)
s_barrier
s_cmp_lg_u32 s3, 0
s_cbranch_scc1 .Lnosig51
v_mov_b32 v255, 1
s_mov_b64 exec, 15
buffer_atomic_add v255, v252, s[16:19], 0 offen
s_mov_b64 exec, -1
.Lnosig51:
s_cmp_lg_u32 s3, 1
s_cbranch_scc1 .Lfirst55
s_mov_b64 exec, 3
v_mov_b32 v254, 0
buffer_atomic_add v254, v253, s[16:19], 0 offen sc0
s_mov_b64 exec, -1
.Lfirst55:
TR 20,25,49664
TR 22,25,50176
TR 24,25,49696
TR 26,25,50208
TR 28,25,50688
TR 30,25,51200
TR 32,25,50720
TR 34,25,51232
TR 36,25,51712
TR 38,25,52224
TR 40,25,51744
TR 42,25,52256
v_lshrrev_b32 v2, 4, v1
v_lshlrev_b32 v2, 2, v2
v_and_b32 v13, 15, v1
v_sub_u32 v2, v13, v2
v_mov_b32 v13, 0xff61b1e6
v_subrev_u32 v54, 0, v2
v_cmp_gt_u32 vcc, 8, v54
s_nop 1
v_cndmask_b32 v50, v13, 0, vcc
v_cmp_gt_i32 vcc, -8, v54
s_nop 1
v_cndmask_b32 v46, v13, 0, vcc
v_subrev_u32 v54, 1, v2
v_cmp_gt_u32 vcc, 8, v54
s_nop 1
v_cndmask_b32 v51, v13, 0, vcc
v_cmp_gt_i32 vcc, -8, v54
s_nop 1
v_cndmask_b32 v47, v13, 0, vcc
v_subrev_u32 v54, 2, v2
v_cmp_gt_u32 vcc, 8, v54
s_nop 1
v_cndmask_b32 v52, v13, 0, vcc
v_cmp_gt_i32 vcc, -8, v54
s_nop 1
v_cndmask_b32 v48, v13, 0, vcc
v_subrev_u32 v54, 3, v2
v_cmp_gt_u32 vcc, 8, v54
s_nop 1
v_cndmask_b32 v53, v13, 0, vcc
v_cmp_gt_i32 vcc, -8, v54
s_nop 1
v_cndmask_b32 v49, v13, 0, vcc
s_cmp_lt_u32 s8, 2
s_cselect_b64 vcc, -1, 0
v_cndmask_b32 v54, v46, v13, vcc
v_cndmask_b32 v55, v47, v13, vcc
v_cndmask_b32 v56, v48, v13, vcc
v_cndmask_b32 v57, v49, v13, vcc
v_mov_b64 v[60:61], 0
v_mov_b64 v[62:63], 0
v_mov_b64 v[64:65], 0
v_mov_b64 v[66:67], 0
v_mov_b64 v[68:69], 0
v_mov_b64 v[70:71], 0
v_mov_b64 v[72:73], 0
v_mov_b64 v[74:75], 0
v_mov_b64 v[76:77], 0
v_mov_b64 v[78:79], 0
v_mov_b64 v[80:81], 0
v_mov_b64 v[82:83], 0
v_mov_b64 v[84:85], 0
v_mov_b64 v[86:87], 0
v_mov_b64 v[88:89], 0
v_mov_b64 v[90:91], 0
v_mov_b64 v[92:93], 0
v_mov_b64 v[94:95], 0
v_mov_b64 v[96:97], 0
v_mov_b64 v[98:99], 0
v_mov_b64 v[100:101], 0
v_mov_b64 v[102:103], 0
v_mov_b64 v[104:105], 0
v_mov_b64 v[106:107], 0
v_mov_b64 v[108:109], 0
v_mov_b64 v[110:111], 0
v_mov_b64 v[112:113], 0
v_mov_b64 v[114:115], 0
v_mov_b64 v[116:117], 0
v_mov_b64 v[118:119], 0
v_mov_b64 v[120:121], 0
v_mov_b64 v[122:123], 0
v_mov_b64 v[124:125], 0
v_mov_b64 v[126:127], 0
v_mov_b64 v[128:129], 0
v_mov_b64 v[130:131], 0
v_mov_b64 v[132:133], 0
v_mov_b64 v[134:135], 0
v_mov_b64 v[136:137], 0
v_mov_b64 v[138:139], 0
v_mov_b64 v[140:141], 0
v_mov_b64 v[142:143], 0
v_mov_b64 v[144:145], 0
v_mov_b64 v[146:147], 0
v_mov_b64 v[148:149], 0
v_mov_b64 v[150:151], 0
v_mov_b64 v[152:153], 0
v_mov_b64 v[154:155], 0
v_mov_b64 v[156:157], 0
v_mov_b64 v[158:159], 0
v_mov_b64 v[160:161], 0
v_mov_b64 v[162:163], 0
v_mov_b64 v[164:165], 0
v_mov_b64 v[166:167], 0
v_mov_b64 v[168:169], 0
v_mov_b64 v[170:171], 0
v_mov_b64 v[172:173], 0
v_mov_b64 v[174:175], 0
s_mov_b32 s75, 62914560
v_and_b32 v10, 15, v1
v_lshlrev_b32 v12, 2, v10
v_lshlrev_b32 v10, 4, v10
v_add_u32 v10, 152576, v10
v_lshrrev_b32 v11, 4, v1
v_lshlrev_b32 v11, 4, v11
s_lshl_b32 s62, s49, 7
s_add_u32 s62, s62, 158720
v_add_u32 v12, s62, v12
v_add_u32 v13, s62, v11
v_add_u32 v11, 156672, v11
s_lshl_b32 s62, s3, 11
s_add_u32 s62, s62, 143360
v_lshl_add_u32 v8, v1, 4, s62
v_xor_b32 v9, 2048, v8
v_mov_b32 v248, 0x3f803f80
v_mov_b32 v249, 0x3f803f80
v_mov_b32 v250, 0x3f803f80
v_mov_b32 v251, 0x3f803f80
v_and_b32 v7, 31, v1
v_lshrrev_b32 v2, 5, v1
v_lshl_add_u32 v7, v7, 1, v2
v_and_b32 v2, 0xc0, v0
v_add_u32 v7, v7, v2
v_lshlrev_b32 v17, 2, v7
v_add_u32 v17, 156672, v17
v_lshlrev_b32 v7, 4, v7
v_add_u32 v7, 152576, v7
s_lshl_b32 s74, s9, 1
s_add_u32 s74, s74, s49
s_lshl_b32 s74, s74, 17
s_lshl_b32 s63, s8, 13
s_add_u32 s74, s74, s63
s_lshl_b32 s63, s48, 12
s_add_u32 s74, s74, s63
s_add_u32 s74, s74, 37748736
s_mov_b32 s62, 0
v_lshl_add_u32 v4, v1, 4, s62
v_lshrrev_b32 v2, 3, v1
v_cmp_eq_u32 vcc, 3, v2
v_add_u32 v2, 67108480, v4
s_nop 0
v_cndmask_b32 v4, v4, v2, vcc
ds_read_b128 v[28:31], v13
ds_read_b128 v[32:35], v13 offset:64
ds_read_b128 v[36:39], v13 offset:256
ds_read_b128 v[40:43], v13 offset:320
ds_read_b32 v44, v12 offset:512
ds_read_b32 v45, v12 offset:576
s_waitcnt lgkmcnt(0)
s_cmp_lg_u32 s3, 1
s_cbranch_scc1 .Lnopoll54
s_mov_b64 exec, 3
s_mov_b32 s15, 0
.Lpoll52:
s_waitcnt vmcnt(0)
v_cmp_ne_u32 vcc, 16, v254
s_add_u32 s15, s15, 1
s_cbranch_vccz .Lnopoll54r
s_mov_b64 exec, 3
v_mov_b32 v254, 0
buffer_atomic_add v254, v253, s[16:19], 0 offen sc0
s_cmp_le_u32 s15, 100000
s_cbranch_scc1 .Lpoll52
.Lgot53:
s_waitcnt vmcnt(0)
s_branch .Lnopoll54r
.Lnopoll54:
s_mov_b64 exec, 0
s_cmp_eq_u32 s3, 2
s_cbranch_scc1 .Lpad11
s_cmp_eq_u32 s3, 3
s_cbranch_scc1 .Lpad12
s_branch .Lpad13
.Lnopoll54r:
s_mov_b64 exec, -1
s_barrier
s_cmp_eq_u32 s48, 1
s_cbranch_scc1 .Lqkv56
s_add_u32 m0, s55, 36864
s_nop 0
buffer_load_dwordx4 v21, s[16:19], s52 offen sc1 lds
buffer_load_dwordx4 v21, s[16:19], s52 offen offset:1024 sc1 lds
buffer_load_dword v22, s[16:19], s52 offen offset:2048 sc1 lds
s_add_u32 s52, s52, 0x20000
s_add_u32 m0, s55, 46080
s_nop 0
buffer_load_dwordx4 v21, s[16:19], s52 offen sc1 lds
buffer_load_dwordx4 v21, s[16:19], s52 offen offset:1024 sc1 lds
buffer_load_dword v22, s[16:19], s52 offen offset:2048 sc1 lds
s_add_u32 s52, s52, 0x20000
s_add_u32 m0, s55, 0
s_nop 0
buffer_load_dwordx4 v21, s[16:19], s52 offen sc1 lds
buffer_load_dwordx4 v21, s[16:19], s52 offen offset:1024 sc1 lds
buffer_load_dword v22, s[16:19], s52 offen offset:2048 sc1 lds
s_add_u32 s52, s52, 0x20000
s_add_u32 m0, s55, 9216
s_nop 0
buffer_load_dwordx4 v21, s[16:19], s52 offen sc1 lds
buffer_load_dwordx4 v21, s[16:19], s52 offen offset:1024 sc1 lds
buffer_load_dword v22, s[16:19], s52 offen offset:2048 sc1 lds
s_add_u32 s52, s52, 0x20000
s_add_u32 m0, s55, 18432
.Lpad11:
s_cbranch_execz .Lpad14
s_nop 0
buffer_load_dwordx4 v21, s[16:19], s52 offen sc1 lds
buffer_load_dwordx4 v21, s[16:19], s52 offen offset:1024 sc1 lds
buffer_load_dword v22, s[16:19], s52 offen offset:2048 sc1 lds
s_add_u32 s52, s52, 0x20000
s_waitcnt vmcnt(12)
s_barrier
RD 0,23,36864
RD 4,23,37888
RD 8,23,39168
RD 12,23,40192
RD 16,24,38912
s_waitcnt lgkmcnt(0)
s_mov_b32 s15, -4
.p2align 6
.Lk58:
s_waitcnt vmcnt(9) lgkmcnt(8)
s_barrier
MAA 60,20,0
RD 44,23,46080
s_add_u32 m0, s56, 104832
MAA 76,24,0
buffer_load_dwordx4 v18, s[20:23], s54 offen lds
MAA 80,24,4
RD 48,23,47104
v_add_f32 v164, v164, v168
MAA 64,20,4
RD 52,23,48384
MAA 68,20,8
buffer_load_dwordx4 v19, s[20:23], s54 offen offset:1024 lds
MAA 84,24,8
RD 56,23,49408
MAA 88,24,12
TR 64,25,62080
v_add_f32 v165, v165, v169
MAA 72,20,12
TR 66,25,62592
s_waitcnt lgkmcnt(6)
MAA 104,28,12
buffer_load_dwordx4 v20, s[20:23], s54 offen offset:2048 lds
MAA 120,32,12
TR 68,25,62112
s_add_u32 s54, s54, 196608
MAA 116,32,8
TR 70,25,62624
s_add_u32 m0, s55, 27648
MAA 100,28,8
buffer_load_dwordx4 v21, s[16:19], s52 offen sc1 lds
MAA 96,28,4
RD 60,24,48128
MAA 112,32,4
TR 72,25,63104
MAA 108,32,0
buffer_load_dwordx4 v21, s[16:19], s52 offen offset:1024 sc1 lds
MAA 92,28,0
TR 74,25,63616
v_add_f32 v166, v166, v170
MAA 156,28,16
TR 76,25,63136
MAA 160,32,16
TR 78,25,63648
MAA 124,0,36
buffer_load_dword v22, s[16:19], s52 offen offset:2048 sc1 lds
MAA 140,0,40
TR 80,25,64128
s_add_u32 s52, s52, 0x20000
MAA 144,4,40
TR 82,25,64640
v_add_f32 v167, v167, v171
MAA 128,4,36
buffer_load_dword v27, v14, s[20:23], s44 offen
MAA 132,8,36
TR 84,25,64160
s_add_u32 s44, s44, 1572864
MAA 148,8,40
TR 86,25,64672
MAA 152,12,40
MAA 136,12,36
s_waitcnt vmcnt(13) lgkmcnt(8)
s_barrier
MAA 60,64,44
ds_read_b128 a[0:3], v23
s_add_u32 m0, s56, 117248
MAA 76,68,44
buffer_load_dwordx4 v18, s[20:23], s54 offen lds
MAA 80,68,48
RD 4,23,1024
MAA 64,64,48
RD 8,23,2304
MAA 68,64,52
buffer_load_dwordx4 v19, s[20:23], s54 offen offset:1024 lds
MAA 84,68,52
RD 12,23,3328
MAA 88,68,56
ds_read_b64_tr_b16 a[20:21], v25
MAA 72,64,56
TR 22,25,512
s_waitcnt lgkmcnt(6)
MAA 104,72,56
buffer_load_dwordx4 v20, s[20:23], s54 offen offset:2048 lds
MAA 120,76,56
TR 24,25,32
s_add_u32 s54, s54, 196608
MAA 116,76,52
TR 26,25,544
s_add_u32 m0, s55, 36864
MAA 100,72,52
buffer_load_dwordx4 v21, s[16:19], s52 offen sc1 lds
MAA 96,72,48
RD 16,24,2048
MAA 112,76,48
TR 28,25,1024
MAA 108,76,44
buffer_load_dwordx4 v21, s[16:19], s52 offen offset:1024 sc1 lds
MAA 92,72,44
TR 30,25,1536
MAA 156,72,60
TR 32,25,1056
MAA 160,76,60
TR 34,25,1568
MAA 124,44,80
buffer_load_dword v22, s[16:19], s52 offen offset:2048 sc1 lds
MAA 140,44,84
TR 36,25,2048
s_add_u32 s52, s52, 0x20000
MAA 144,48,84
TR 38,25,2560
MAA 128,48,80
buffer_load_dwordx4 v[168:171], v26, s[16:19], s75 offen sc1
MAA 132,52,80
TR 40,25,2080
MAA 148,52,84
TR 42,25,2592
MAA 152,56,84
MAA 136,56,80
s_waitcnt vmcnt(17) lgkmcnt(8)
s_barrier
MAA 60,20,0
RD 44,23,9216
s_add_u32 m0, s56, 129664
MAA 76,24,0
buffer_load_dwordx4 v18, s[20:23], s54 offen lds
MAA 80,24,4
RD 48,23,10240
MAA 64,20,4
RD 52,23,11520
MAA 68,20,8
RD 56,23,12544
MAA 84,24,8
buffer_load_dwordx4 v19, s[20:23], s54 offen offset:1024 lds
MAA 88,24,12
TR 64,25,12416
MAA 72,20,12
TR 66,25,12928
s_waitcnt lgkmcnt(6)
MAA 104,28,12
TR 68,25,12448
MAA 120,32,12
buffer_load_dwordx4 v20, s[20:23], s54 offen offset:2048 lds
MAA 116,32,8
TR 70,25,12960
s_add_u32 s54, s54, 196608
MAA 100,28,8
RD 60,24,11264
MAA 96,28,4
s_add_u32 m0, s55, 46080
MAA 112,32,4
buffer_load_dwordx4 v21, s[16:19], s52 offen sc1 lds
MAA 108,32,0
TR 72,25,13440
MAA 92,28,0
TR 74,25,13952
MAA 156,28,16
TR 76,25,13472
MAA 160,32,16
buffer_load_dwordx4 v21, s[16:19], s52 offen offset:1024 sc1 lds
MAA 124,0,36
TR 78,25,13984
MAA 140,0,40
TR 80,25,14464
MAA 144,4,40
TR 82,25,14976
MAA 128,4,36
buffer_load_dword v22, s[16:19], s52 offen offset:2048 sc1 lds
MAA 132,8,36
TR 84,25,14496
s_add_u32 s52, s52, 0x20000
MAA 148,8,40
TR 86,25,15008
MAA 152,12,40
MAA 136,12,36
s_waitcnt vmcnt(20) lgkmcnt(8)
s_barrier
MAA 60,64,44
RD 0,23,18432
s_add_u32 m0, s56, 67584
MAA 76,68,44
buffer_load_dwordx4 v18, s[20:23], s54 offen lds
MAA 80,68,48
RD 4,23,19456
v_add_f32 v164, v164, v172
MAA 64,64,48
RD 8,23,20736
MAA 68,64,52
RD 12,23,21760
MAA 84,68,52
buffer_load_dwordx4 v19, s[20:23], s54 offen offset:1024 lds
MAA 88,68,56
TR 20,25,24832
MAA 72,64,56
TR 22,25,25344
s_waitcnt lgkmcnt(6)
MAA 104,72,56
TR 24,25,24864
v_add_f32 v165, v165, v173
MAA 120,76,56
buffer_load_dwordx4 v20, s[20:23], s54 offen offset:2048 lds
MAA 116,76,52
TR 26,25,25376
s_add_u32 s54, s54, 196608
MAA 100,72,52
RD 16,24,20480
MAA 96,72,48
s_add_u32 m0, s55, 0
MAA 112,76,48
buffer_load_dwordx4 v21, s[16:19], s52 offen sc1 lds
MAA 108,76,44
TR 28,25,25856
v_add_f32 v166, v166, v174
MAA 92,72,44
TR 30,25,26368
MAA 156,72,60
TR 32,25,25888
MAA 160,76,60
buffer_load_dwordx4 v21, s[16:19], s52 offen offset:1024 sc1 lds
MAA 124,44,80
TR 34,25,26400
MAA 140,44,84
TR 36,25,26880
v_add_f32 v167, v167, v175
MAA 144,48,84
TR 38,25,27392
MAA 128,48,80
buffer_load_dword v22, s[16:19], s52 offen offset:2048 sc1 lds
MAA 132,52,80
TR 40,25,26912
s_add_u32 s52, s52, 0x20000
MAA 148,52,84
TR 42,25,27424
MAA 152,56,84
MAA 136,56,80
s_waitcnt vmcnt(20) lgkmcnt(8)
s_barrier
MAA 60,20,0
RD 44,23,27648
s_add_u32 m0, s56, 80000
MAA 76,24,0
buffer_load_dwordx4 v18, s[20:23], s54 offen lds
MAA 80,24,4
RD 48,23,28672
MAA 64,20,4
RD 52,23,29952
MAA 68,20,8
buffer_load_dwordx4 v19, s[20:23], s54 offen offset:1024 lds
MAA 84,24,8
RD 56,23,30976
MAA 88,24,12
TR 64,25,37248
MAA 72,20,12
TR 66,25,37760
s_waitcnt lgkmcnt(6)
MAA 104,28,12
buffer_load_dwordx4 v20, s[20:23], s54 offen offset:2048 lds
MAA 120,32,12
TR 68,25,37280
s_add_u32 s54, s54, 196608
MAA 116,32,8
TR 70,25,37792
s_add_u32 m0, s55, 9216
MAA 100,28,8
buffer_load_dwordx4 v21, s[16:19], s52 offen sc1 lds
MAA 96,28,4
RD 60,24,29696
MAA 112,32,4
TR 72,25,38272
MAA 108,32,0
buffer_load_dwordx4 v21, s[16:19], s52 offen offset:1024 sc1 lds
MAA 92,28,0
TR 74,25,38784
MAA 156,28,16
TR 76,25,38304
MAA 160,32,16
TR 78,25,38816
MAA 124,0,36
buffer_load_dword v22, s[16:19], s52 offen offset:2048 sc1 lds
MAA 140,0,40
TR 80,25,39296
s_add_u32 s52, s52, 0x20000
MAA 144,4,40
TR 82,25,39808
MAA 128,4,36
buffer_load_dwordx4 v[172:175], v26, s[16:19], s75 offen offset:1024 sc1
MAA 132,8,36
TR 84,25,39328
s_add_u32 s75, s75, 2048
MAA 148,8,40
TR 86,25,39840
MAA 152,12,40
MAA 136,12,36
s_waitcnt vmcnt(20) lgkmcnt(8)
s_barrier
MAA 60,64,44
RD 0,23,36864
s_add_u32 m0, s56, 92416
MAA 76,68,44
buffer_load_dwordx4 v18, s[20:23], s54 offen lds
MAA 80,68,48
RD 4,23,37888
MAA 64,64,48
RD 8,23,39168
MAA 68,64,52
RD 12,23,40192
MAA 84,68,52
buffer_load_dwordx4 v19, s[20:23], s54 offen offset:1024 lds
MAA 88,68,56
TR 20,25,49664
MAA 72,64,56
TR 22,25,50176
s_waitcnt lgkmcnt(6)
MAA 104,72,56
TR 24,25,49696
MAA 120,76,56
buffer_load_dwordx4 v20, s[20:23], s54 offen offset:2048 lds
MAA 116,76,52
TR 26,25,50208
s_add_u32 s54, s54, 196608
MAA 100,72,52
RD 16,24,38912
MAA 96,72,48
s_add_u32 m0, s55, 18432
MAA 112,76,48
buffer_load_dwordx4 v21, s[16:19], s52 offen sc1 lds
MAA 108,76,44
TR 28,25,50688
MAA 92,72,44
TR 30,25,51200
MAA 156,72,60
TR 32,25,50720
MAA 160,76,60
buffer_load_dwordx4 v21, s[16:19], s52 offen offset:1024 sc1 lds
MAA 124,44,80
TR 34,25,51232
MAA 140,44,84
TR 36,25,51712
MAA 144,48,84
TR 38,25,52224
MAA 128,48,80
buffer_load_dword v22, s[16:19], s52 offen offset:2048 sc1 lds
MAA 132,52,80
TR 40,25,51744
s_add_u32 s52, s52, 0x20000
MAA 148,52,84
TR 42,25,52256
MAA 152,56,84
s_add_u32 s15, s15, 1
MAA 136,56,80
s_cbranch_scc0 .Lk58
s_waitcnt vmcnt(19) lgkmcnt(8)
s_barrier
MAA 60,20,0
RD 44,23,46080
s_add_u32 m0, s56, 104832
MAA 76,24,0
buffer_load_dwordx4 v18, s[20:23], s54 offen lds
MAA 80,24,4
RD 48,23,47104
v_add_f32 v164, v164, v168
MAA 64,20,4
RD 52,23,48384
MAA 68,20,8
RD 56,23,49408
MAA 84,24,8
buffer_load_dwordx4 v19, s[20:23], s54 offen offset:1024 lds
MAA 88,24,12
TR 64,25,62080
MAA 72,20,12
TR 66,25,62592
s_waitcnt lgkmcnt(6)
MAA 104,28,12
TR 68,25,62112
v_add_f32 v165, v165, v169
MAA 120,32,12
buffer_load_dwordx4 v20, s[20:23], s54 offen offset:2048 lds
MAA 116,32,8
TR 70,25,62624
s_add_u32 s54, s54, 196608
MAA 100,28,8
RD 60,24,48128
MAA 96,28,4
s_add_u32 m0, s55, 27648
MAA 112,32,4
buffer_load_dwordx4 v21, s[16:19], s52 offen sc1 lds
MAA 108,32,0
TR 72,25,63104
v_add_f32 v166, v166, v170
MAA 92,28,0
TR 74,25,63616
MAA 156,28,16
TR 76,25,63136
MAA 160,32,16
buffer_load_dwordx4 v21, s[16:19], s52 offen offset:1024 sc1 lds
MAA 124,0,36
TR 78,25,63648
MAA 140,0,40
TR 80,25,64128
v_add_f32 v167, v167, v171
MAA 144,4,40
TR 82,25,64640
MAA 128,4,36
buffer_load_dword v22, s[16:19], s52 offen offset:2048 sc1 lds
MAA 132,8,36
TR 84,25,64160
s_add_u32 s52, s52, 0x20000
MAA 148,8,40
TR 86,25,64672
MAA 152,12,40
MAA 136,12,36
s_waitcnt vmcnt(19) lgkmcnt(8)
s_barrier
MAA 60,64,44
ds_read_b128 a[0:3], v23
s_add_u32 m0, s56, 117248
MAA 76,68,44
buffer_load_dwordx4 v18, s[20:23], s54 offen lds
MAA 80,68,48
RD 4,23,1024
MAA 64,64,48
RD 8,23,2304
MAA 68,64,52
RD 12,23,3328
MAA 84,68,52
buffer_load_dwordx4 v19, s[20:23], s54 offen offset:1024 lds
MAA 88,68,56
ds_read_b64_tr_b16 a[20:21], v25
MAA 72,64,56
TR 22,25,512
s_waitcnt lgkmcnt(6)
MAA 104,72,56
TR 24,25,32
MAA 120,76,56
buffer_load_dwordx4 v20, s[20:23], s54 offen offset:2048 lds
MAA 116,76,52
TR 26,25,544
s_add_u32 s54, s54, 196608
MAA 100,72,52
RD 16,24,2048
MAA 96,72,48
s_add_u32 m0, s55, 36864
MAA 112,76,48
buffer_load_dwordx4 v21, s[16:19], s52 offen sc1 lds
MAA 108,76,44
TR 28,25,1024
MAA 92,72,44
TR 30,25,1536
MAA 156,72,60
TR 32,25,1056
MAA 160,76,60
buffer_load_dwordx4 v21, s[16:19], s52 offen offset:1024 sc1 lds
MAA 124,44,80
TR 34,25,1568
MAA 140,44,84
TR 36,25,2048
MAA 144,48,84
TR 38,25,2560
MAA 128,48,80
buffer_load_dword v22, s[16:19], s52 offen offset:2048 sc1 lds
MAA 132,52,80
TR 40,25,2080
s_add_u32 s52, s52, 0x20000
MAA 148,52,84
TR 42,25,2592
MAA 152,56,84
MAA 136,56,80
s_waitcnt vmcnt(19) lgkmcnt(8)
s_barrier
MAA 60,20,0
RD 44,23,9216
s_add_u32 m0, s56, 129664
MAA 76,24,0
buffer_load_dwordx4 v18, s[20:23], s54 offen lds
MAA 80,24,4
RD 48,23,10240
s_waitcnt vmcnt(19)
v_add_f32 v164, v164, v172
MAA 64,20,4
RD 52,23,11520
MAA 68,20,8
RD 56,23,12544
MAA 84,24,8
buffer_load_dwordx4 v19, s[20:23], s54 offen offset:1024 lds
MAA 88,24,12
TR 64,25,12416
MAA 72,20,12
TR 66,25,12928
s_waitcnt lgkmcnt(6)
MAA 104,28,12
TR 68,25,12448
v_add_f32 v165, v165, v173
MAA 120,32,12
buffer_load_dwordx4 v20, s[20:23], s54 offen offset:2048 lds
MAA 116,32,8
TR 70,25,12960
s_add_u32 s54, s54, 196608
MAA 100,28,8
RD 60,24,11264
MAA 96,28,4
s_add_u32 m0, s55, 46080
MAA 112,32,4
buffer_load_dwordx4 v21, s[16:19], s52 offen sc1 lds
MAA 108,32,0
TR 72,25,13440
v_add_f32 v166, v166, v174
MAA 92,28,0
TR 74,25,13952
MAA 156,28,16
TR 76,25,13472
MAA 160,32,16
buffer_load_dwordx4 v21, s[16:19], s52 offen offset:1024 sc1 lds
MAA 124,0,36
TR 78,25,13984
MAA 140,0,40
TR 80,25,14464
v_add_f32 v167, v167, v175
MAA 144,4,40
TR 82,25,14976
MAA 128,4,36
.Lpad12:
s_cbranch_execz .Lpad15
buffer_load_dword v22, s[16:19], s52 offen offset:2048 sc1 lds
MAA 132,8,36
TR 84,25,14496
s_add_u32 s52, s52, 0x20000
MAA 148,8,40
TR 86,25,15008
MAA 152,12,40
MAA 136,12,36
s_waitcnt vmcnt(18) lgkmcnt(8)
s_barrier
MAA 60,64,44
RD 0,23,18432
s_add_u32 m0, s59, 0
s_mov_b32 s58, 1048576
MAA 76,68,44
buffer_load_dwordx4 v5, s[24:27], s58 offen lds
MAA 80,68,48
RD 4,23,19456
v_permlane32_swap_b32 v164, v166
MAA 64,64,48
RD 8,23,20736
MAA 68,64,52
RD 12,23,21760
v_permlane32_swap_b32 v165, v167
MAA 84,68,52
buffer_load_dwordx4 v6, s[24:27], s58 offen offset:1024 lds
MAA 88,68,56
TR 20,25,24832
MAA 72,64,56
v_add_f32 v164, v164, v166
s_waitcnt lgkmcnt(5)
MAA 104,72,56
TR 22,25,25344
s_add_u32 m0, s59, 58240
s_mov_b32 s58, 1966080
MAA 120,76,56
buffer_load_dwordx4 v5, s[24:27], s58 offen lds
MAA 116,76,52
TR 24,25,24864
v_add_f32 v165, v165, v167
MAA 100,72,52
TR 26,25,25376
MAA 96,72,48
RD 16,24,20480
MAA 112,76,48
buffer_load_dwordx4 v6, s[24:27], s58 offen offset:1024 lds
MAA 108,76,44
TR 28,25,25856
v_mul_f32 v164, 0xba800000, v164
MAA 92,72,44
TR 30,25,26368
MAA 156,72,60
s_add_u32 m0, s59, 66560
s_mov_b32 s58, 0
v_mul_f32 v165, 0x3a800000, v165
MAA 160,76,60
buffer_load_dwordx4 v5, s[24:27], s58 offen lds
MAA 124,44,80
TR 32,25,25888
MAA 140,44,84
TR 34,25,26400
v_fma_f32 v165, -v164, v164, v165
MAA 144,48,84
TR 36,25,26880
MAA 128,48,80
buffer_load_dwordx4 v6, s[24:27], s58 offen offset:1024 lds
MAA 132,52,80
TR 38,25,27392
v_max_f32 v165, 0, v165
MAA 148,52,84
TR 40,25,26912
MAA 152,56,84
TR 42,25,27424
MAA 136,56,80
s_waitcnt vmcnt(18) lgkmcnt(8)
s_barrier
MAA 60,20,0
RD 44,23,27648
s_add_u32 m0, s59, 8320
s_mov_b32 s58, 1179648
MAA 76,24,0
buffer_load_dwordx4 v5, s[24:27], s58 offen lds
MAA 80,24,4
RD 48,23,28672
v_add_f32 v165, 0x3727c5ac, v165
MAA 64,20,4
RD 52,23,29952
MAA 68,20,8
RD 56,23,30976
MAA 84,24,8
buffer_load_dwordx4 v6, s[24:27], s58 offen offset:1024 lds
MAA 88,24,12
TR 64,25,37248
MAA 72,20,12
v_rsq_f32 v166, v165
s_waitcnt lgkmcnt(5)
MAA 104,28,12
TR 66,25,37760
s_add_u32 m0, s59, 74880
s_mov_b32 s58, 131072
MAA 120,32,12
buffer_load_dwordx4 v5, s[24:27], s58 offen lds
MAA 116,32,8
TR 68,25,37280
MAA 100,28,8
TR 70,25,37792
MAA 96,28,4
RD 60,24,29696
MAA 112,32,4
buffer_load_dwordx4 v6, s[24:27], s58 offen offset:1024 lds
MAA 108,32,0
TR 72,25,38272
v_mov_b32 v165, v166
MAA 92,28,0
TR 74,25,38784
MAA 156,28,16
s_add_u32 m0, s59, 83200
s_mov_b32 s58, 262144
MAA 160,32,16
buffer_load_dwordx4 v5, s[24:27], s58 offen lds
MAA 124,0,36
TR 76,25,38304
MAA 140,0,40
TR 78,25,38816
v_mul_f32 v166, 0x3e8293ee, v166
MAA 144,4,40
TR 80,25,39296
MAA 128,4,36
buffer_load_dwordx4 v6, s[24:27], s58 offen offset:1024 lds
MAA 132,8,36
TR 82,25,39808
MAA 148,8,40
TR 84,25,39328
MAA 152,12,40
TR 86,25,39840
MAA 136,12,36
s_waitcnt vmcnt(18) lgkmcnt(8)
s_barrier
MAA 60,64,44
s_add_u32 m0, s59, 16640
s_mov_b32 s58, 1310720
ds_write_b128 v7, v[164:167]
MAA 76,68,44
buffer_load_dwordx4 v5, s[24:27], s58 offen lds
MAA 80,68,48
RD 0,23,36864
MAA 64,64,48
RD 4,23,37888
MAA 68,64,52
RD 8,23,39168
MAA 84,68,52
RD 12,23,40192
MAA 88,68,56
TR 20,25,49664
MAA 72,64,56
TR 22,25,50176
s_waitcnt lgkmcnt(7)
MAA 104,72,56
buffer_load_dwordx4 v6, s[24:27], s58 offen offset:1024 lds
MAA 120,76,56
TR 24,25,49696
MAA 116,76,52
TR 26,25,50208
ds_write_b32 v17, v164
MAA 100,72,52
RD 16,24,38912
MAA 96,72,48
s_add_u32 m0, s59, 91520
s_mov_b32 s58, 393216
MAA 112,76,48
buffer_load_dwordx4 v5, s[24:27], s58 offen lds
MAA 108,76,44
MAA 92,72,44
TR 28,25,50688
MAA 156,72,60
TR 30,25,51200
MAA 160,76,60
TR 32,25,50720
ds_write_b32 v17, v165 offset:1024
MAA 124,44,80
TR 34,25,51232
MAA 140,44,84
buffer_load_dwordx4 v6, s[24:27], s58 offen offset:1024 lds
MAA 144,48,84
TR 36,25,51712
MAA 128,48,80
TR 38,25,52224
MAA 132,52,80
TR 40,25,51744
MAA 148,52,84
TR 42,25,52256
MAA 152,56,84
MAA 136,56,80
s_waitcnt vmcnt(16) lgkmcnt(9)
s_barrier
MAA 60,20,0
RD 44,23,46080
s_add_u32 m0, s59, 24960
s_mov_b32 s58, 1441792
MAA 76,24,0
buffer_load_dwordx4 v5, s[24:27], s58 offen lds
MAA 80,24,4
RD 48,23,47104
MAA 64,20,4
RD 52,23,48384
MAA 68,20,8
RD 56,23,49408
MAA 84,24,8
buffer_load_dwordx4 v6, s[24:27], s58 offen offset:1024 lds
MAA 88,24,12
TR 64,25,62080
MAA 72,20,12
s_waitcnt lgkmcnt(5)
MAA 104,28,12
TR 66,25,62592
s_add_u32 m0, s59, 99840
s_mov_b32 s58, 524288
MAA 120,32,12
buffer_load_dwordx4 v5, s[24:27], s58 offen lds
MAA 116,32,8
TR 68,25,62112
MAA 100,28,8
TR 70,25,62624
MAA 96,28,4
RD 60,24,48128
MAA 112,32,4
buffer_load_dwordx4 v6, s[24:27], s58 offen offset:1024 lds
MAA 108,32,0
TR 72,25,63104
MAA 92,28,0
TR 74,25,63616
MAA 156,28,16
s_add_u32 m0, s59, 108160
s_mov_b32 s58, 655360
MAA 160,32,16
buffer_load_dwordx4 v5, s[24:27], s58 offen lds
MAA 124,0,36
TR 76,25,63136
MAA 140,0,40
TR 78,25,63648
MAA 144,4,40
TR 80,25,64128
MAA 128,4,36
buffer_load_dwordx4 v6, s[24:27], s58 offen offset:1024 lds
MAA 132,8,36
TR 82,25,64640
MAA 148,8,40
TR 84,25,64160
MAA 152,12,40
TR 86,25,64672
MAA 136,12,36
s_waitcnt lgkmcnt(0)
s_barrier
MAA 156,72,60
ds_read_b128 v[232:235], v10 offset:768
s_add_u32 m0, s59, 33280
MAA 160,76,60
ds_read_b128 v[236:239], v10 offset:2816
s_mov_b32 s58, 1572864
MAA 104,72,56
ds_read_b128 v[228:231], v10 offset:512
MAA 120,76,56
ds_read_b128 v[224:227], v10 offset:256
MAA 136,56,80
ds_read_b128 v[220:223], v10
MAA 152,56,84
ds_read_b128 v[240:243], v11 offset:192
MAA 100,72,52
ds_read_b128 v[244:247], v11 offset:1216
MAA 116,76,52
buffer_load_dwordx4 v5, s[24:27], s58 offen lds
MAA 96,72,48
ds_read_b128 v[18:21], v11 offset:128
ds_read_b128 v[22:25], v11 offset:1152
s_waitcnt lgkmcnt(8)
v_pk_fma_f32 v[104:105], v[36:37], v[232:233], v[104:105] op_sel_hi:[1,0,1]
v_pk_mul_f32 v[104:105], v[104:105], v[232:233] op_sel:[0,1] op_sel_hi:[1,1]
v_pk_fma_f32 v[106:107], v[38:39], v[232:233], v[106:107] op_sel_hi:[1,0,1]
v_pk_mul_f32 v[106:107], v[106:107], v[232:233] op_sel:[0,1] op_sel_hi:[1,1]
v_pk_fma_f32 v[120:121], v[40:41], v[232:233], v[120:121] op_sel_hi:[1,0,1]
v_pk_mul_f32 v[120:121], v[120:121], v[232:233] op_sel:[0,1] op_sel_hi:[1,1]
v_pk_fma_f32 v[122:123], v[42:43], v[232:233], v[122:123] op_sel_hi:[1,0,1]
v_pk_mul_f32 v[122:123], v[122:123], v[232:233] op_sel:[0,1] op_sel_hi:[1,1]
s_waitcnt lgkmcnt(6)
v_pk_fma_f32 v[100:101], v[36:37], v[228:229], v[100:101] op_sel_hi:[1,0,1]
v_pk_mul_f32 v[100:101], v[100:101], v[228:229] op_sel:[0,1] op_sel_hi:[1,1]
v_pk_fma_f32 v[102:103], v[38:39], v[228:229], v[102:103] op_sel_hi:[1,0,1]
v_pk_mul_f32 v[102:103], v[102:103], v[228:229] op_sel:[0,1] op_sel_hi:[1,1]
v_pk_fma_f32 v[116:117], v[40:41], v[228:229], v[116:117] op_sel_hi:[1,0,1]
v_pk_mul_f32 v[116:117], v[116:117], v[228:229] op_sel:[0,1] op_sel_hi:[1,1]
s_waitcnt lgkmcnt(3)
v_pk_fma_f32 v[136:137], v[240:241], v[44:45], v[136:137] op_sel_hi:[1,0,1]
v_pk_fma_f32 v[138:139], v[242:243], v[44:45], v[138:139] op_sel_hi:[1,0,1]
v_pk_fma_f32 v[152:153], v[240:241], v[44:45], v[152:153] op_sel:[0,1,0] op_sel_hi:[1,1,1]
v_pk_fma_f32 v[154:155], v[242:243], v[44:45], v[154:155] op_sel:[0,1,0] op_sel_hi:[1,1,1]
s_waitcnt lgkmcnt(2)
v_pk_mul_f32 v[136:137], v[136:137], v[244:245]
v_pk_mul_f32 v[138:139], v[138:139], v[246:247]
v_pk_mul_f32 v[152:153], v[152:153], v[244:245]
v_pk_mul_f32 v[154:155], v[154:155], v[246:247]
v_pk_fma_f32 v[118:119], v[42:43], v[228:229], v[118:119] op_sel_hi:[1,0,1]
v_pk_mul_f32 v[118:119], v[118:119], v[228:229] op_sel:[0,1] op_sel_hi:[1,1]
v_pk_fma_f32 v[96:97], v[36:37], v[224:225], v[96:97] op_sel_hi:[1,0,1]
v_pk_mul_f32 v[96:97], v[96:97], v[224:225] op_sel:[0,1] op_sel_hi:[1,1]
v_pk_fma_f32 v[98:99], v[38:39], v[224:225], v[98:99] op_sel_hi:[1,0,1]
v_pk_mul_f32 v[98:99], v[98:99], v[224:225] op_sel:[0,1] op_sel_hi:[1,1]
v_pk_fma_f32 v[156:157], v[36:37], v[236:237], v[156:157] op_sel_hi:[1,0,1]
v_pk_mul_f32 v[156:157], v[156:157], v[236:237] op_sel:[0,1] op_sel_hi:[1,1]
v_pk_fma_f32 v[158:159], v[38:39], v[236:237], v[158:159] op_sel_hi:[1,0,1]
v_pk_mul_f32 v[158:159], v[158:159], v[236:237] op_sel:[0,1] op_sel_hi:[1,1]
v_pk_fma_f32 v[160:161], v[40:41], v[236:237], v[160:161] op_sel_hi:[1,0,1]
v_pk_mul_f32 v[160:161], v[160:161], v[236:237] op_sel:[0,1] op_sel_hi:[1,1]
v_pk_fma_f32 v[162:163], v[42:43], v[236:237], v[162:163] op_sel_hi:[1,0,1]
v_pk_mul_f32 v[162:163], v[162:163], v[236:237] op_sel:[0,1] op_sel_hi:[1,1]
v_cvt_pk_bf16_f32 v196, v104, v105
v_cvt_pk_bf16_f32 v197, v106, v107
MAA 112,76,48
buffer_load_dwordx4 v6, s[24:27], s58 offen offset:1024 lds
MAA 92,72,44
s_add_u32 m0, s59, 41600
v_cvt_pk_bf16_f32 v198, v120, v121
v_cvt_pk_bf16_f32 v199, v122, v123
MAA 108,76,44
ds_write_b128 v8, v[196:199]
v_cvt_pk_bf16_f32 v208, v136, v137
MAA 72,64,56
s_mov_b32 s58, 1703936
v_cvt_pk_bf16_f32 v209, v138, v139
v_cvt_pk_bf16_f32 v218, v152, v153
MAA 88,68,56
ds_write_b64 v8, v[208:209] offset:1024
v_cvt_pk_bf16_f32 v219, v154, v155
ds_write_b64 v8, v[218:219] offset:1032
v_cvt_pk_bf16_f32 v192, v100, v101
v_pk_fma_f32 v[72:73], v[28:29], v[232:233], v[72:73] op_sel_hi:[1,0,1]
v_pk_fma_f32 v[74:75], v[30:31], v[232:233], v[74:75] op_sel_hi:[1,0,1]
s_nop 1
v_pk_fma_f32 v[88:89], v[32:33], v[232:233], v[88:89] op_sel_hi:[1,0,1]
v_pk_fma_f32 v[90:91], v[34:35], v[232:233], v[90:91] op_sel_hi:[1,0,1]
v_pk_fma_f32 v[112:113], v[40:41], v[224:225], v[112:113] op_sel_hi:[1,0,1]
v_pk_mul_f32 v[112:113], v[112:113], v[224:225] op_sel:[0,1] op_sel_hi:[1,1]
v_pk_fma_f32 v[114:115], v[42:43], v[224:225], v[114:115] op_sel_hi:[1,0,1]
v_pk_mul_f32 v[114:115], v[114:115], v[224:225] op_sel:[0,1] op_sel_hi:[1,1]
v_pk_fma_f32 v[92:93], v[36:37], v[220:221], v[92:93] op_sel_hi:[1,0,1]
v_pk_mul_f32 v[92:93], v[92:93], v[220:221] op_sel:[0,1] op_sel_hi:[1,1]
v_pk_fma_f32 v[94:95], v[38:39], v[220:221], v[94:95] op_sel_hi:[1,0,1]
v_pk_mul_f32 v[94:95], v[94:95], v[220:221] op_sel:[0,1] op_sel_hi:[1,1]
v_pk_fma_f32 v[108:109], v[40:41], v[220:221], v[108:109] op_sel_hi:[1,0,1]
v_pk_mul_f32 v[108:109], v[108:109], v[220:221] op_sel:[0,1] op_sel_hi:[1,1]
v_pk_fma_f32 v[110:111], v[42:43], v[220:221], v[110:111] op_sel_hi:[1,0,1]
v_pk_mul_f32 v[110:111], v[110:111], v[220:221] op_sel:[0,1] op_sel_hi:[1,1]
v_cvt_pk_bf16_f32 v193, v102, v103
v_cvt_pk_bf16_f32 v194, v116, v117
MAA 132,52,80
buffer_load_dwordx4 v5, s[24:27], s58 offen lds
MAA 148,52,84
ds_read_b128 v[240:243], v11 offset:64
v_cvt_pk_bf16_f32 v195, v118, v119
MAA 68,64,52
ds_read_b128 v[244:247], v11 offset:1088
s_waitcnt lgkmcnt(2)
s_barrier
MAA 84,68,52
ds_read_b64 v[200:201], v9 offset:1024
v_cvt_pk_bf16_f32 v176, v72, v73
MAA 128,48,80
ds_read_b64 v[210:211], v9 offset:1032
buffer_load_dwordx4 v6, s[24:27], s58 offen offset:1024 lds
s_add_u32 m0, s59, 49920
v_pk_fma_f32 v[132:133], v[18:19], v[44:45], v[132:133] op_sel_hi:[1,0,1]
v_pk_mul_f32 v[132:133], v[132:133], v[22:23]
v_pk_fma_f32 v[134:135], v[20:21], v[44:45], v[134:135] op_sel_hi:[1,0,1]
v_pk_mul_f32 v[134:135], v[134:135], v[24:25]
v_pk_fma_f32 v[148:149], v[18:19], v[44:45], v[148:149] op_sel:[0,1,0] op_sel_hi:[1,1,1]
v_pk_mul_f32 v[148:149], v[148:149], v[22:23]
v_pk_fma_f32 v[150:151], v[20:21], v[44:45], v[150:151] op_sel:[0,1,0] op_sel_hi:[1,1,1]
v_pk_mul_f32 v[150:151], v[150:151], v[24:25]
v_pk_fma_f32 v[68:69], v[28:29], v[228:229], v[68:69] op_sel_hi:[1,0,1]
v_pk_fma_f32 v[70:71], v[30:31], v[228:229], v[70:71] op_sel_hi:[1,0,1]
v_pk_fma_f32 v[84:85], v[32:33], v[228:229], v[84:85] op_sel_hi:[1,0,1]
v_pk_fma_f32 v[86:87], v[34:35], v[228:229], v[86:87] op_sel_hi:[1,0,1]
s_mov_b32 s58, 1835008
v_cvt_pk_bf16_f32 v177, v74, v75
MAA 144,48,84
buffer_load_dwordx4 v5, s[24:27], s58 offen lds
MAA 64,64,48
ds_read_b128 v[18:21], v11
v_cvt_pk_bf16_f32 v178, v88, v89
MAA 80,68,48
ds_read_b128 v[22:25], v11 offset:1024
v_cvt_pk_bf16_f32 v179, v90, v91
MAA 124,44,80
v_cvt_pk_bf16_f32 v206, v132, v133
v_cvt_pk_bf16_f32 v207, v134, v135
v_cvt_pk_bf16_f32 v216, v148, v149
v_cvt_pk_bf16_f32 v217, v150, v151
v_cvt_pk_bf16_f32 v188, v96, v97
s_waitcnt lgkmcnt(5)
v_pk_fma_f32 v[128:129], v[240:241], v[44:45], v[128:129] op_sel_hi:[1,0,1]
s_waitcnt lgkmcnt(4)
v_pk_mul_f32 v[128:129], v[128:129], v[244:245]
v_pk_fma_f32 v[130:131], v[242:243], v[44:45], v[130:131] op_sel_hi:[1,0,1]
v_pk_mul_f32 v[130:131], v[130:131], v[246:247]
v_pk_fma_f32 v[144:145], v[240:241], v[44:45], v[144:145] op_sel:[0,1,0] op_sel_hi:[1,1,1]
v_pk_mul_f32 v[144:145], v[144:145], v[244:245]
v_pk_fma_f32 v[146:147], v[242:243], v[44:45], v[146:147] op_sel:[0,1,0] op_sel_hi:[1,1,1]
v_pk_mul_f32 v[146:147], v[146:147], v[246:247]
v_pk_fma_f32 v[64:65], v[28:29], v[224:225], v[64:65] op_sel_hi:[1,0,1]
v_pk_fma_f32 v[66:67], v[30:31], v[224:225], v[66:67] op_sel_hi:[1,0,1]
v_pk_fma_f32 v[80:81], v[32:33], v[224:225], v[80:81] op_sel_hi:[1,0,1]
v_pk_fma_f32 v[82:83], v[34:35], v[224:225], v[82:83] op_sel_hi:[1,0,1]
v_cvt_pk_bf16_f32 v189, v98, v99
v_cvt_pk_bf16_f32 v190, v112, v113
MAA 140,44,84
buffer_load_dwordx4 v6, s[24:27], s58 offen offset:1024 lds
MAA 60,64,44
s_add_u32 m0, s59, 116480
s_mov_b32 s58, 786432
v_cvt_pk_bf16_f32 v191, v114, v115
MAA 76,68,44
v_cvt_pk_bf16_f32 v172, v68, v69
v_cvt_pk_bf16_f32 v173, v70, v71
v_mfma_f32_16x16x32_bf16 v[104:107], v[192:195], v[176:179], v[46:49]
v_cvt_pk_bf16_f32 v174, v84, v85
v_cvt_pk_bf16_f32 v175, v86, v87
v_cvt_pk_bf16_f32 v204, v128, v129
v_cvt_pk_bf16_f32 v205, v130, v131
v_cvt_pk_bf16_f32 v214, v144, v145
s_waitcnt lgkmcnt(1)
v_pk_fma_f32 v[124:125], v[18:19], v[44:45], v[124:125] op_sel_hi:[1,0,1]
s_waitcnt lgkmcnt(0)
v_pk_mul_f32 v[124:125], v[124:125], v[22:23]
v_pk_fma_f32 v[126:127], v[20:21], v[44:45], v[126:127] op_sel_hi:[1,0,1]
v_pk_mul_f32 v[126:127], v[126:127], v[24:25]
v_pk_fma_f32 v[140:141], v[18:19], v[44:45], v[140:141] op_sel:[0,1,0] op_sel_hi:[1,1,1]
v_pk_mul_f32 v[140:141], v[140:141], v[22:23]
v_pk_fma_f32 v[142:143], v[20:21], v[44:45], v[142:143] op_sel:[0,1,0] op_sel_hi:[1,1,1]
v_pk_mul_f32 v[142:143], v[142:143], v[24:25]
v_pk_fma_f32 v[60:61], v[28:29], v[220:221], v[60:61] op_sel_hi:[1,0,1]
v_pk_fma_f32 v[62:63], v[30:31], v[220:221], v[62:63] op_sel_hi:[1,0,1]
v_pk_fma_f32 v[76:77], v[32:33], v[220:221], v[76:77] op_sel_hi:[1,0,1]
v_pk_fma_f32 v[78:79], v[34:35], v[220:221], v[78:79] op_sel_hi:[1,0,1]
v_max3_f32 v88, v104, v105, v106
v_cvt_pk_bf16_f32 v215, v146, v147
v_mfma_f32_16x16x32_bf16 v[120:123], v[196:199], v[176:179], v[50:53]
buffer_load_dwordx4 v5, s[24:27], s58 offen lds
v_mfma_f32_16x16x32_bf16 v[100:103], v[188:191], v[172:175], v[46:49]
v_cvt_pk_bf16_f32 v184, v92, v93
v_cvt_pk_bf16_f32 v185, v94, v95
v_mfma_f32_16x16x32_bf16 v[116:119], v[192:195], v[172:175], v[50:53]
s_nop 2
v_max3_f32 v89, v107, v120, v121
v_max3_f32 v88, v88, v122, v123
v_max_f32 v90, v88, v89
v_max_f32 v89, v88, v89
v_max3_f32 v84, v100, v101, v102
v_cvt_pk_bf16_f32 v186, v108, v109
v_permlane16_swap_b32 v90, v89
v_max3_f32 v85, v103, v116, v117
buffer_load_dwordx4 v6, s[24:27], s58 offen offset:1024 lds
s_add_u32 m0, s59, 124800
s_mov_b32 s58, 917504
v_max_f32 v88, v90, v89
v_max_f32 v89, v90, v89
v_max3_f32 v84, v84, v118, v119
v_max_f32 v86, v84, v85
v_permlane32_swap_b32 v88, v89
v_max_f32 v85, v84, v85
v_max_f32 v88, v88, v89
v_mul_f32 v88, v88, v234
v_pk_fma_f32 v[104:105], v[104:105], v[234:235], v[88:89] op_sel_hi:[1,0,0] neg_lo:[0,0,1] neg_hi:[0,0,1]
v_pk_fma_f32 v[106:107], v[106:107], v[234:235], v[88:89] op_sel_hi:[1,0,0] neg_lo:[0,0,1] neg_hi:[0,0,1]
buffer_load_dwordx4 v5, s[24:27], s58 offen lds
v_pk_fma_f32 v[120:121], v[120:121], v[234:235], v[88:89] op_sel_hi:[1,0,0] neg_lo:[0,0,1] neg_hi:[0,0,1]
v_pk_fma_f32 v[122:123], v[122:123], v[234:235], v[88:89] op_sel_hi:[1,0,0] neg_lo:[0,0,1] neg_hi:[0,0,1]
v_exp_f32 v104, v104
v_exp_f32 v105, v105
v_exp_f32 v106, v106
v_exp_f32 v107, v107
v_exp_f32 v120, v120
v_exp_f32 v121, v121
v_exp_f32 v122, v122
v_exp_f32 v123, v123
v_cvt_pk_bf16_f32 v72, v104, v105
buffer_load_dwordx4 v6, s[24:27], s58 offen offset:1024 lds
v_cvt_pk_bf16_f32 v73, v106, v107
v_cvt_pk_bf16_f32 v74, v120, v121
v_cvt_pk_bf16_f32 v75, v122, v123
v_permlane16_swap_b32 v86, v85
s_nop 0
v_mfma_f32_16x16x32_bf16 v[88:91], v[248:251], v[72:75], 0
v_max_f32 v84, v86, v85
v_max_f32 v85, v86, v85
v_mfma_f32_16x16x32_bf16 v[104:107], v[206:209], v[72:75], 0
s_nop 0
v_permlane32_swap_b32 v84, v85
v_mfma_f32_16x16x32_bf16 v[120:123], v[216:219], v[72:75], 0
s_nop 1
v_rcp_f32 v88, v88
v_max_f32 v84, v84, v85
v_mul_f32 v84, v84, v230
v_cvt_pk_bf16_f32 v187, v110, v111
v_pk_mul_f32 v[104:105], v[104:105], v[88:89] op_sel_hi:[1,0]
v_pk_mul_f32 v[106:107], v[106:107], v[88:89] op_sel_hi:[1,0]
v_pk_mul_f32 v[120:121], v[120:121], v[88:89] op_sel_hi:[1,0]
v_pk_mul_f32 v[122:123], v[122:123], v[88:89] op_sel_hi:[1,0]
v_cvt_pk_bf16_f32 v176, v104, v105
v_cvt_pk_bf16_f32 v177, v106, v107
v_cvt_pk_bf16_f32 v178, v120, v121
v_cvt_pk_bf16_f32 v179, v122, v123
buffer_store_dwordx4 v[176:179], v4, s[16:19], s74 offen offset:3072 sc1
v_pk_fma_f32 v[100:101], v[100:101], v[230:231], v[84:85] op_sel_hi:[1,0,0] neg_lo:[0,0,1] neg_hi:[0,0,1]
v_pk_fma_f32 v[102:103], v[102:103], v[230:231], v[84:85] op_sel_hi:[1,0,0] neg_lo:[0,0,1] neg_hi:[0,0,1]
v_pk_fma_f32 v[116:117], v[116:117], v[230:231], v[84:85] op_sel_hi:[1,0,0] neg_lo:[0,0,1] neg_hi:[0,0,1]
v_pk_fma_f32 v[118:119], v[118:119], v[230:231], v[84:85] op_sel_hi:[1,0,0] neg_lo:[0,0,1] neg_hi:[0,0,1]
v_exp_f32 v100, v100
v_exp_f32 v101, v101
v_exp_f32 v102, v102
v_exp_f32 v103, v103
v_exp_f32 v116, v116
v_exp_f32 v117, v117
v_exp_f32 v118, v118
v_exp_f32 v119, v119
v_cvt_pk_bf16_f32 v68, v100, v101
v_cvt_pk_bf16_f32 v69, v102, v103
v_cvt_pk_bf16_f32 v70, v116, v117
v_cvt_pk_bf16_f32 v71, v118, v119
v_cvt_pk_bf16_f32 v168, v64, v65
v_cvt_pk_bf16_f32 v169, v66, v67
v_mfma_f32_16x16x32_bf16 v[84:87], v[248:251], v[68:71], 0
v_cvt_pk_bf16_f32 v170, v80, v81
v_cvt_pk_bf16_f32 v171, v82, v83
v_mfma_f32_16x16x32_bf16 v[100:103], v[204:207], v[68:71], 0
v_cvt_pk_bf16_f32 v202, v124, v125
v_cvt_pk_bf16_f32 v203, v126, v127
v_mfma_f32_16x16x32_bf16 v[116:119], v[214:217], v[68:71], 0
s_nop 1
v_rcp_f32 v84, v84
v_mfma_f32_16x16x32_bf16 v[96:99], v[184:187], v[168:171], v[46:49]
v_cvt_pk_bf16_f32 v212, v140, v141
v_cvt_pk_bf16_f32 v213, v142, v143
v_mfma_f32_16x16x32_bf16 v[112:115], v[188:191], v[168:171], v[50:53]
v_cvt_pk_bf16_f32 v180, v156, v157
v_cvt_pk_bf16_f32 v181, v158, v159
v_cvt_pk_bf16_f32 v182, v160, v161
s_nop 1
v_max3_f32 v80, v96, v97, v98
v_cvt_pk_bf16_f32 v183, v162, v163
.Lpad13:
s_cbranch_execz .Lpad16
v_pk_mul_f32 v[100:101], v[100:101], v[84:85] op_sel_hi:[1,0]
v_pk_mul_f32 v[102:103], v[102:103], v[84:85] op_sel_hi:[1,0]
v_pk_mul_f32 v[116:117], v[116:117], v[84:85] op_sel_hi:[1,0]
v_pk_mul_f32 v[118:119], v[118:119], v[84:85] op_sel_hi:[1,0]
v_cvt_pk_bf16_f32 v172, v100, v101
v_cvt_pk_bf16_f32 v173, v102, v103
v_cvt_pk_bf16_f32 v174, v116, v117
v_cvt_pk_bf16_f32 v175, v118, v119
buffer_store_dwordx4 v[172:175], v4, s[16:19], s74 offen offset:2048 sc1
v_max3_f32 v81, v99, v112, v113
v_max3_f32 v80, v80, v114, v115
v_max_f32 v82, v80, v81
v_max_f32 v81, v80, v81
v_cvt_pk_bf16_f32 v164, v60, v61
v_cvt_pk_bf16_f32 v165, v62, v63
v_permlane16_swap_b32 v82, v81
v_cvt_pk_bf16_f32 v166, v76, v77
v_max_f32 v80, v82, v81
v_max_f32 v81, v82, v81
v_cvt_pk_bf16_f32 v167, v78, v79
s_nop 0
v_permlane32_swap_b32 v80, v81
v_mfma_f32_16x16x32_bf16 v[92:95], v[180:183], v[164:167], v[54:57]
v_max_f32 v80, v80, v81
v_mul_f32 v80, v80, v226
v_mfma_f32_16x16x32_bf16 v[108:111], v[184:187], v[164:167], v[50:53]
s_nop 4
v_max3_f32 v76, v92, v93, v94
v_pk_fma_f32 v[96:97], v[96:97], v[226:227], v[80:81] op_sel_hi:[1,0,0] neg_lo:[0,0,1] neg_hi:[0,0,1]
v_pk_fma_f32 v[98:99], v[98:99], v[226:227], v[80:81] op_sel_hi:[1,0,0] neg_lo:[0,0,1] neg_hi:[0,0,1]
v_pk_fma_f32 v[112:113], v[112:113], v[226:227], v[80:81] op_sel_hi:[1,0,0] neg_lo:[0,0,1] neg_hi:[0,0,1]
v_pk_fma_f32 v[114:115], v[114:115], v[226:227], v[80:81] op_sel_hi:[1,0,0] neg_lo:[0,0,1] neg_hi:[0,0,1]
v_exp_f32 v96, v96
v_exp_f32 v97, v97
v_exp_f32 v98, v98
v_exp_f32 v99, v99
v_exp_f32 v112, v112
v_exp_f32 v113, v113
v_exp_f32 v114, v114
v_exp_f32 v115, v115
v_cvt_pk_bf16_f32 v64, v96, v97
v_cvt_pk_bf16_f32 v65, v98, v99
v_cvt_pk_bf16_f32 v66, v112, v113
v_cvt_pk_bf16_f32 v67, v114, v115
v_max3_f32 v77, v95, v108, v109
v_max3_f32 v76, v76, v110, v111
v_mfma_f32_16x16x32_bf16 v[80:83], v[248:251], v[64:67], 0
v_max_f32 v78, v76, v77
v_max_f32 v77, v76, v77
v_mfma_f32_16x16x32_bf16 v[96:99], v[202:205], v[64:67], 0
s_nop 0
v_permlane16_swap_b32 v78, v77
v_mfma_f32_16x16x32_bf16 v[112:115], v[212:215], v[64:67], 0
s_nop 1
v_rcp_f32 v80, v80
v_max_f32 v76, v78, v77
v_max_f32 v77, v78, v77
v_pk_mul_f32 v[96:97], v[96:97], v[80:81] op_sel_hi:[1,0]
v_pk_mul_f32 v[98:99], v[98:99], v[80:81] op_sel_hi:[1,0]
s_nop 0
v_pk_mul_f32 v[112:113], v[112:113], v[80:81] op_sel_hi:[1,0]
v_pk_mul_f32 v[114:115], v[114:115], v[80:81] op_sel_hi:[1,0]
v_cvt_pk_bf16_f32 v168, v96, v97
v_cvt_pk_bf16_f32 v169, v98, v99
v_cvt_pk_bf16_f32 v170, v112, v113
v_cvt_pk_bf16_f32 v171, v114, v115
buffer_store_dwordx4 v[168:171], v4, s[16:19], s74 offen offset:1024 sc1
v_permlane32_swap_b32 v76, v77
v_max_f32 v76, v76, v77
v_mul_f32 v76, v76, v222
v_pk_fma_f32 v[92:93], v[92:93], v[222:223], v[76:77] op_sel_hi:[1,0,0] neg_lo:[0,0,1] neg_hi:[0,0,1]
v_pk_fma_f32 v[94:95], v[94:95], v[222:223], v[76:77] op_sel_hi:[1,0,0] neg_lo:[0,0,1] neg_hi:[0,0,1]
v_pk_fma_f32 v[108:109], v[108:109], v[222:223], v[76:77] op_sel_hi:[1,0,0] neg_lo:[0,0,1] neg_hi:[0,0,1]
v_pk_fma_f32 v[110:111], v[110:111], v[222:223], v[76:77] op_sel_hi:[1,0,0] neg_lo:[0,0,1] neg_hi:[0,0,1]
v_exp_f32 v92, v92
v_exp_f32 v93, v93
v_exp_f32 v94, v94
v_exp_f32 v95, v95
v_exp_f32 v108, v108
v_exp_f32 v109, v109
v_exp_f32 v110, v110
v_exp_f32 v111, v111
v_cvt_pk_bf16_f32 v60, v92, v93
v_cvt_pk_bf16_f32 v61, v94, v95
v_cvt_pk_bf16_f32 v62, v108, v109
v_cvt_pk_bf16_f32 v63, v110, v111
s_nop 1
v_mfma_f32_16x16x32_bf16 v[76:79], v[248:251], v[60:63], 0
v_mfma_f32_16x16x32_bf16 v[92:95], v[200:203], v[60:63], 0
v_mfma_f32_16x16x32_bf16 v[108:111], v[210:213], v[60:63], 0
s_nop 5
v_rcp_f32 v76, v76
s_nop 0
v_pk_mul_f32 v[92:93], v[92:93], v[76:77] op_sel_hi:[1,0]
v_pk_mul_f32 v[94:95], v[94:95], v[76:77] op_sel_hi:[1,0]
v_pk_mul_f32 v[108:109], v[108:109], v[76:77] op_sel_hi:[1,0]
v_pk_mul_f32 v[110:111], v[110:111], v[76:77] op_sel_hi:[1,0]
v_cvt_pk_bf16_f32 v164, v92, v93
v_cvt_pk_bf16_f32 v165, v94, v95
v_cvt_pk_bf16_f32 v166, v108, v109
v_cvt_pk_bf16_f32 v167, v110, v111
buffer_store_dwordx4 v[164:167], v4, s[16:19], s74 offen sc1
s_nop 1
s_branch .Lqkve57
.Lpad14:
s_cbranch_execz .Lpad17
.Lsp48:
s_mov_b32 s15, 0
.Lsp48l:
v_mov_b32 v84, 0
buffer_atomic_add v84, v69, s[16:19], s73 offen offset:512 sc0
s_add_u32 s15, s15, 1
s_cmp_gt_u32 s15, 100000
s_waitcnt vmcnt(0)
s_cbranch_scc1 .Lsp48b
v_cmp_gt_u32 vcc, v70, v84
s_nop 0
s_cbranch_vccnz .Lsp48l
s_branch .Lsp48b
.Lsp49:
s_mov_b32 s15, 0
.Lsp49l:
v_mov_b32 v25, 0
buffer_atomic_add v25, v22, s[16:19], s73 offen sc0
s_add_u32 s15, s15, 1
s_cmp_gt_u32 s15, 100000
s_waitcnt vmcnt(0)
s_cbranch_scc1 .Lsp49b
v_cmp_gt_u32 vcc, v23, v25
s_nop 0
s_cbranch_vccnz .Lsp49l
s_branch .Lsp49b
.Lxs50:
s_mov_b32 s15, 0
.Lxs50l:
v_mov_b32 v15, 0
buffer_atomic_add v15, v12, s[16:19], s70 offen sc0
s_add_u32 s15, s15, 1
s_cmp_gt_u32 s15, 100000
s_waitcnt vmcnt(0)
s_cbranch_scc1 .Lxs50b
v_cmp_ne_u32 vcc, 0, v15
s_nop 0
s_cbranch_vccz .Lxs50l
s_branch .Lxs50b
.Lqkv56:
.Lpad15:
s_cbranch_execz .Lpad18
s_add_u32 m0, s55, 36864
s_nop 0
buffer_load_dwordx4 v21, s[16:19], s52 offen sc1 lds
buffer_load_dwordx4 v21, s[16:19], s52 offen offset:1024 sc1 lds
buffer_load_dword v22, s[16:19], s52 offen offset:2048 sc1 lds
s_add_u32 s52, s52, 0x20000
s_add_u32 m0, s55, 46080
s_nop 0
buffer_load_dwordx4 v21, s[16:19], s52 offen sc1 lds
buffer_load_dwordx4 v21, s[16:19], s52 offen offset:1024 sc1 lds
buffer_load_dword v22, s[16:19], s52 offen offset:2048 sc1 lds
s_add_u32 s52, s52, 0x20000
s_add_u32 m0, s55, 0
s_nop 0
buffer_load_dwordx4 v21, s[16:19], s52 offen sc1 lds
buffer_load_dwordx4 v21, s[16:19], s52 offen offset:1024 sc1 lds
buffer_load_dword v22, s[16:19], s52 offen offset:2048 sc1 lds
s_add_u32 s52, s52, 0x20000
s_add_u32 m0, s55, 9216
s_nop 0
buffer_load_dwordx4 v21, s[16:19], s52 offen sc1 lds
buffer_load_dwordx4 v21, s[16:19], s52 offen offset:1024 sc1 lds
buffer_load_dword v22, s[16:19], s52 offen offset:2048 sc1 lds
s_add_u32 s52, s52, 0x20000
s_add_u32 m0, s55, 18432
s_nop 0
buffer_load_dwordx4 v21, s[16:19], s52 offen sc1 lds
buffer_load_dwordx4 v21, s[16:19], s52 offen offset:1024 sc1 lds
buffer_load_dword v22, s[16:19], s52 offen offset:2048 sc1 lds
s_add_u32 s52, s52, 0x20000
s_waitcnt vmcnt(12)
s_barrier
RD 0,23,36864
RD 4,23,37888
RD 8,23,39168
RD 12,23,40192
RD 16,24,38912
s_waitcnt lgkmcnt(0)
s_mov_b32 s15, -4
.p2align 6
.Lk59:
s_waitcnt vmcnt(9) lgkmcnt(8)
s_barrier
MAA 60,20,0
RD 44,23,46080
v_add_f32 v164, v164, v168
MAA 76,24,0
RD 48,23,47104
s_add_u32 m0, s56, 104832
MAA 80,24,4
buffer_load_dwordx4 v18, s[20:23], s54 offen lds
MAA 64,20,4
RD 52,23,48384
MAA 68,20,8
RD 56,23,49408
MAA 84,24,8
buffer_load_dwordx4 v19, s[20:23], s54 offen offset:1024 lds
MAA 88,24,12
TR 64,25,62080
v_add_f32 v165, v165, v169
MAA 72,20,12
TR 66,25,62592
s_waitcnt lgkmcnt(6)
MAA 104,28,12
buffer_load_dwordx4 v20, s[20:23], s54 offen offset:2048 lds
MAA 120,32,12
TR 68,25,62112
s_add_u32 s54, s54, 196608
MAA 116,32,8
TR 70,25,62624
MAA 100,28,8
RD 60,24,48128
s_add_u32 m0, s55, 27648
MAA 96,28,4
buffer_load_dwordx4 v21, s[16:19], s52 offen sc1 lds
MAA 112,32,4
TR 72,25,63104
MAA 108,32,0
TR 74,25,63616
v_add_f32 v166, v166, v170
MAA 92,28,0
buffer_load_dwordx4 v21, s[16:19], s52 offen offset:1024 sc1 lds
MAA 124,0,36
TR 76,25,63136
MAA 140,0,40
TR 78,25,63648
MAA 144,4,40
TR 80,25,64128
v_add_f32 v167, v167, v171
MAA 128,4,36
buffer_load_dword v22, s[16:19], s52 offen offset:2048 sc1 lds
MAA 132,8,36
TR 82,25,64640
s_add_u32 s52, s52, 0x20000
MAA 148,8,40
TR 84,25,64160
MAA 152,12,40
buffer_load_dword v27, v14, s[20:23], s44 offen
MAA 136,12,36
TR 86,25,64672
s_add_u32 s44, s44, 1572864
MAA 156,16,36
MAA 160,16,40
s_waitcnt vmcnt(13) lgkmcnt(8)
s_barrier
MAA 60,64,44
ds_read_b128 a[0:3], v23
MAA 76,68,44
RD 4,23,1024
s_add_u32 m0, s56, 117248
MAA 80,68,48
buffer_load_dwordx4 v18, s[20:23], s54 offen lds
MAA 64,64,48
RD 8,23,2304
MAA 68,64,52
RD 12,23,3328
MAA 84,68,52
buffer_load_dwordx4 v19, s[20:23], s54 offen offset:1024 lds
MAA 88,68,56
ds_read_b64_tr_b16 a[20:21], v25
MAA 72,64,56
TR 22,25,512
s_waitcnt lgkmcnt(6)
MAA 104,72,56
buffer_load_dwordx4 v20, s[20:23], s54 offen offset:2048 lds
MAA 120,76,56
TR 24,25,32
s_add_u32 s54, s54, 196608
MAA 116,76,52
TR 26,25,544
MAA 100,72,52
RD 16,24,2048
s_add_u32 m0, s55, 36864
MAA 96,72,48
buffer_load_dwordx4 v21, s[16:19], s52 offen sc1 lds
MAA 112,76,48
TR 28,25,1024
MAA 108,76,44
TR 30,25,1536
MAA 92,72,44
buffer_load_dwordx4 v21, s[16:19], s52 offen offset:1024 sc1 lds
MAA 124,44,80
TR 32,25,1056
MAA 140,44,84
TR 34,25,1568
MAA 144,48,84
TR 36,25,2048
MAA 128,48,80
buffer_load_dword v22, s[16:19], s52 offen offset:2048 sc1 lds
MAA 132,52,80
TR 38,25,2560
s_add_u32 s52, s52, 0x20000
MAA 148,52,84
TR 40,25,2080
MAA 152,56,84
buffer_load_dwordx4 v[168:171], v26, s[16:19], s75 offen sc1
MAA 136,56,80
TR 42,25,2592
MAA 156,60,80
MAA 160,60,84
s_waitcnt vmcnt(17) lgkmcnt(8)
s_barrier
MAA 60,20,0
RD 44,23,9216
MAA 76,24,0
RD 48,23,10240
s_add_u32 m0, s56, 129664
MAA 80,24,4
buffer_load_dwordx4 v18, s[20:23], s54 offen lds
MAA 64,20,4
RD 52,23,11520
MAA 68,20,8
RD 56,23,12544
MAA 84,24,8
TR 64,25,12416
MAA 88,24,12
buffer_load_dwordx4 v19, s[20:23], s54 offen offset:1024 lds
MAA 72,20,12
TR 66,25,12928
s_waitcnt lgkmcnt(6)
MAA 104,28,12
TR 68,25,12448
MAA 120,32,12
TR 70,25,12960
MAA 116,32,8
buffer_load_dwordx4 v20, s[20:23], s54 offen offset:2048 lds
MAA 100,28,8
RD 60,24,11264
s_add_u32 s54, s54, 196608
MAA 96,28,4
MAA 112,32,4
TR 72,25,13440
s_add_u32 m0, s55, 46080
MAA 108,32,0
buffer_load_dwordx4 v21, s[16:19], s52 offen sc1 lds
MAA 92,28,0
TR 74,25,13952
MAA 124,0,36
TR 76,25,13472
MAA 140,0,40
TR 78,25,13984
MAA 144,4,40
buffer_load_dwordx4 v21, s[16:19], s52 offen offset:1024 sc1 lds
MAA 128,4,36
TR 80,25,14464
MAA 132,8,36
TR 82,25,14976
MAA 148,8,40
TR 84,25,14496
MAA 152,12,40
buffer_load_dword v22, s[16:19], s52 offen offset:2048 sc1 lds
MAA 136,12,36
TR 86,25,15008
s_add_u32 s52, s52, 0x20000
MAA 156,16,36
MAA 160,16,40
s_waitcnt vmcnt(20) lgkmcnt(8)
s_barrier
MAA 60,64,44
RD 0,23,18432
v_add_f32 v164, v164, v172
MAA 76,68,44
RD 4,23,19456
s_add_u32 m0, s56, 67584
MAA 80,68,48
buffer_load_dwordx4 v18, s[20:23], s54 offen lds
MAA 64,64,48
RD 8,23,20736
MAA 68,64,52
RD 12,23,21760
MAA 84,68,52
TR 20,25,24832
MAA 88,68,56
buffer_load_dwordx4 v19, s[20:23], s54 offen offset:1024 lds
MAA 72,64,56
TR 22,25,25344
s_waitcnt lgkmcnt(6)
MAA 104,72,56
TR 24,25,24864
v_add_f32 v165, v165, v173
MAA 120,76,56
TR 26,25,25376
MAA 116,76,52
buffer_load_dwordx4 v20, s[20:23], s54 offen offset:2048 lds
MAA 100,72,52
RD 16,24,20480
s_add_u32 s54, s54, 196608
MAA 96,72,48
MAA 112,76,48
TR 28,25,25856
s_add_u32 m0, s55, 0
MAA 108,76,44
buffer_load_dwordx4 v21, s[16:19], s52 offen sc1 lds
MAA 92,72,44
TR 30,25,26368
v_add_f32 v166, v166, v174
MAA 124,44,80
TR 32,25,25888
MAA 140,44,84
TR 34,25,26400
MAA 144,48,84
buffer_load_dwordx4 v21, s[16:19], s52 offen offset:1024 sc1 lds
MAA 128,48,80
TR 36,25,26880
MAA 132,52,80
TR 38,25,27392
v_add_f32 v167, v167, v175
MAA 148,52,84
TR 40,25,26912
MAA 152,56,84
buffer_load_dword v22, s[16:19], s52 offen offset:2048 sc1 lds
MAA 136,56,80
TR 42,25,27424
s_add_u32 s52, s52, 0x20000
MAA 156,60,80
MAA 160,60,84
s_waitcnt vmcnt(20) lgkmcnt(8)
s_barrier
MAA 60,20,0
RD 44,23,27648
MAA 76,24,0
RD 48,23,28672
s_add_u32 m0, s56, 80000
MAA 80,24,4
buffer_load_dwordx4 v18, s[20:23], s54 offen lds
MAA 64,20,4
RD 52,23,29952
MAA 68,20,8
RD 56,23,30976
MAA 84,24,8
buffer_load_dwordx4 v19, s[20:23], s54 offen offset:1024 lds
MAA 88,24,12
TR 64,25,37248
MAA 72,20,12
TR 66,25,37760
s_waitcnt lgkmcnt(6)
MAA 104,28,12
buffer_load_dwordx4 v20, s[20:23], s54 offen offset:2048 lds
MAA 120,32,12
TR 68,25,37280
s_add_u32 s54, s54, 196608
MAA 116,32,8
TR 70,25,37792
MAA 100,28,8
RD 60,24,29696
s_add_u32 m0, s55, 9216
MAA 96,28,4
buffer_load_dwordx4 v21, s[16:19], s52 offen sc1 lds
MAA 112,32,4
TR 72,25,38272
MAA 108,32,0
TR 74,25,38784
MAA 92,28,0
buffer_load_dwordx4 v21, s[16:19], s52 offen offset:1024 sc1 lds
MAA 124,0,36
TR 76,25,38304
MAA 140,0,40
TR 78,25,38816
MAA 144,4,40
TR 80,25,39296
MAA 128,4,36
buffer_load_dword v22, s[16:19], s52 offen offset:2048 sc1 lds
MAA 132,8,36
TR 82,25,39808
s_add_u32 s52, s52, 0x20000
MAA 148,8,40
TR 84,25,39328
MAA 152,12,40
buffer_load_dwordx4 v[172:175], v26, s[16:19], s75 offen offset:1024 sc1
MAA 136,12,36
TR 86,25,39840
s_add_u32 s75, s75, 2048
MAA 156,16,36
MAA 160,16,40
s_waitcnt vmcnt(20) lgkmcnt(8)
s_barrier
MAA 60,64,44
RD 0,23,36864
MAA 76,68,44
RD 4,23,37888
s_add_u32 m0, s56, 92416
MAA 80,68,48
buffer_load_dwordx4 v18, s[20:23], s54 offen lds
MAA 64,64,48
RD 8,23,39168
MAA 68,64,52
RD 12,23,40192
MAA 84,68,52
TR 20,25,49664
MAA 88,68,56
buffer_load_dwordx4 v19, s[20:23], s54 offen offset:1024 lds
MAA 72,64,56
TR 22,25,50176
s_waitcnt lgkmcnt(6)
MAA 104,72,56
TR 24,25,49696
MAA 120,76,56
TR 26,25,50208
MAA 116,76,52
buffer_load_dwordx4 v20, s[20:23], s54 offen offset:2048 lds
MAA 100,72,52
RD 16,24,38912
s_add_u32 s54, s54, 196608
MAA 96,72,48
MAA 112,76,48
TR 28,25,50688
s_add_u32 m0, s55, 18432
MAA 108,76,44
buffer_load_dwordx4 v21, s[16:19], s52 offen sc1 lds
MAA 92,72,44
TR 30,25,51200
MAA 124,44,80
TR 32,25,50720
MAA 140,44,84
TR 34,25,51232
MAA 144,48,84
buffer_load_dwordx4 v21, s[16:19], s52 offen offset:1024 sc1 lds
MAA 128,48,80
TR 36,25,51712
MAA 132,52,80
TR 38,25,52224
MAA 148,52,84
TR 40,25,51744
MAA 152,56,84
buffer_load_dword v22, s[16:19], s52 offen offset:2048 sc1 lds
MAA 136,56,80
TR 42,25,52256
s_add_u32 s52, s52, 0x20000
MAA 156,60,80
s_add_u32 s15, s15, 1
MAA 160,60,84
s_cbranch_scc0 .Lk59
s_waitcnt vmcnt(19) lgkmcnt(8)
s_barrier
MAA 60,20,0
RD 44,23,46080
v_add_f32 v164, v164, v168
MAA 76,24,0
RD 48,23,47104
s_add_u32 m0, s56, 104832
MAA 80,24,4
buffer_load_dwordx4 v18, s[20:23], s54 offen lds
MAA 64,20,4
RD 52,23,48384
MAA 68,20,8
RD 56,23,49408
MAA 84,24,8
TR 64,25,62080
MAA 88,24,12
buffer_load_dwordx4 v19, s[20:23], s54 offen offset:1024 lds
MAA 72,20,12
TR 66,25,62592
s_waitcnt lgkmcnt(6)
MAA 104,28,12
TR 68,25,62112
v_add_f32 v165, v165, v169
MAA 120,32,12
TR 70,25,62624
MAA 116,32,8
buffer_load_dwordx4 v20, s[20:23], s54 offen offset:2048 lds
MAA 100,28,8
RD 60,24,48128
s_add_u32 s54, s54, 196608
MAA 96,28,4
MAA 112,32,4
TR 72,25,63104
.Lpad16:
s_cbranch_execz .Lnopoll54r
s_add_u32 m0, s55, 27648
MAA 108,32,0
buffer_load_dwordx4 v21, s[16:19], s52 offen sc1 lds
MAA 92,28,0
TR 74,25,63616
v_add_f32 v166, v166, v170
MAA 124,0,36
TR 76,25,63136
MAA 140,0,40
TR 78,25,63648
MAA 144,4,40
buffer_load_dwordx4 v21, s[16:19], s52 offen offset:1024 sc1 lds
MAA 128,4,36
TR 80,25,64128
MAA 132,8,36
TR 82,25,64640
v_add_f32 v167, v167, v171
MAA 148,8,40
TR 84,25,64160
MAA 152,12,40
buffer_load_dword v22, s[16:19], s52 offen offset:2048 sc1 lds
MAA 136,12,36
TR 86,25,64672
s_add_u32 s52, s52, 0x20000
MAA 156,16,36
MAA 160,16,40
s_waitcnt vmcnt(19) lgkmcnt(8)
s_barrier
MAA 60,64,44
ds_read_b128 a[0:3], v23
MAA 76,68,44
RD 4,23,1024
s_add_u32 m0, s56, 117248
MAA 80,68,48
buffer_load_dwordx4 v18, s[20:23], s54 offen lds
MAA 64,64,48
RD 8,23,2304
MAA 68,64,52
RD 12,23,3328
MAA 84,68,52
ds_read_b64_tr_b16 a[20:21], v25
MAA 88,68,56
buffer_load_dwordx4 v19, s[20:23], s54 offen offset:1024 lds
MAA 72,64,56
TR 22,25,512
s_waitcnt lgkmcnt(6)
MAA 104,72,56
TR 24,25,32
MAA 120,76,56
TR 26,25,544
MAA 116,76,52
buffer_load_dwordx4 v20, s[20:23], s54 offen offset:2048 lds
MAA 100,72,52
RD 16,24,2048
s_add_u32 s54, s54, 196608
MAA 96,72,48
MAA 112,76,48
TR 28,25,1024
s_add_u32 m0, s55, 36864
MAA 108,76,44
buffer_load_dwordx4 v21, s[16:19], s52 offen sc1 lds
MAA 92,72,44
TR 30,25,1536
MAA 124,44,80
TR 32,25,1056
MAA 140,44,84
TR 34,25,1568
MAA 144,48,84
buffer_load_dwordx4 v21, s[16:19], s52 offen offset:1024 sc1 lds
MAA 128,48,80
TR 36,25,2048
MAA 132,52,80
TR 38,25,2560
MAA 148,52,84
TR 40,25,2080
MAA 152,56,84
buffer_load_dword v22, s[16:19], s52 offen offset:2048 sc1 lds
MAA 136,56,80
TR 42,25,2592
s_add_u32 s52, s52, 0x20000
MAA 156,60,80
MAA 160,60,84
s_waitcnt vmcnt(19) lgkmcnt(8)
s_barrier
MAA 60,20,0
RD 44,23,9216
s_waitcnt vmcnt(18)
v_add_f32 v164, v164, v172
MAA 76,24,0
RD 48,23,10240
s_add_u32 m0, s56, 129664
MAA 80,24,4
buffer_load_dwordx4 v18, s[20:23], s54 offen lds
MAA 64,20,4
RD 52,23,11520
MAA 68,20,8
RD 56,23,12544
MAA 84,24,8
TR 64,25,12416
MAA 88,24,12
buffer_load_dwordx4 v19, s[20:23], s54 offen offset:1024 lds
MAA 72,20,12
TR 66,25,12928
s_waitcnt lgkmcnt(6)
MAA 104,28,12
TR 68,25,12448
v_add_f32 v165, v165, v173
MAA 120,32,12
TR 70,25,12960
MAA 116,32,8
buffer_load_dwordx4 v20, s[20:23], s54 offen offset:2048 lds
MAA 100,28,8
RD 60,24,11264
s_add_u32 s54, s54, 196608
MAA 96,28,4
MAA 112,32,4
TR 72,25,13440
s_add_u32 m0, s55, 46080
MAA 108,32,0
buffer_load_dwordx4 v21, s[16:19], s52 offen sc1 lds
MAA 92,28,0
TR 74,25,13952
v_add_f32 v166, v166, v174
MAA 124,0,36
TR 76,25,13472
MAA 140,0,40
TR 78,25,13984
MAA 144,4,40
buffer_load_dwordx4 v21, s[16:19], s52 offen offset:1024 sc1 lds
MAA 128,4,36
TR 80,25,14464
MAA 132,8,36
TR 82,25,14976
v_add_f32 v167, v167, v175
MAA 148,8,40
TR 84,25,14496
MAA 152,12,40
buffer_load_dword v22, s[16:19], s52 offen offset:2048 sc1 lds
MAA 136,12,36
TR 86,25,15008
s_add_u32 s52, s52, 0x20000
MAA 156,16,36
MAA 160,16,40
s_waitcnt vmcnt(18) lgkmcnt(8)
s_barrier
MAA 60,64,44
RD 0,23,18432
v_permlane32_swap_b32 v164, v166
MAA 76,68,44
RD 4,23,19456
s_add_u32 m0, s59, 0
s_mov_b32 s58, 1048576
MAA 80,68,48
buffer_load_dwordx4 v5, s[24:27], s58 offen lds
MAA 64,64,48
RD 8,23,20736
MAA 68,64,52
RD 12,23,21760
v_permlane32_swap_b32 v165, v167
MAA 84,68,52
TR 20,25,24832
MAA 88,68,56
buffer_load_dwordx4 v6, s[24:27], s58 offen offset:1024 lds
MAA 72,64,56
v_add_f32 v164, v164, v166
s_waitcnt lgkmcnt(5)
MAA 104,72,56
TR 22,25,25344
v_add_f32 v165, v165, v167
MAA 120,76,56
TR 24,25,24864
s_add_u32 m0, s59, 58240
s_mov_b32 s58, 1966080
MAA 116,76,52
buffer_load_dwordx4 v5, s[24:27], s58 offen lds
MAA 100,72,52
TR 26,25,25376
MAA 96,72,48
RD 16,24,20480
MAA 112,76,48
TR 28,25,25856
v_mul_f32 v164, 0xba800000, v164
MAA 108,76,44
buffer_load_dwordx4 v6, s[24:27], s58 offen offset:1024 lds
MAA 92,72,44
TR 30,25,26368
MAA 124,44,80
TR 32,25,25888
v_mul_f32 v165, 0x3a800000, v165
MAA 140,44,84
s_add_u32 m0, s59, 66560
s_mov_b32 s58, 0
MAA 144,48,84
buffer_load_dwordx4 v5, s[24:27], s58 offen lds
MAA 128,48,80
TR 34,25,26400
v_fma_f32 v165, -v164, v164, v165
MAA 132,52,80
TR 36,25,26880
MAA 148,52,84
TR 38,25,27392
v_max_f32 v165, 0, v165
MAA 152,56,84
buffer_load_dwordx4 v6, s[24:27], s58 offen offset:1024 lds
MAA 136,56,80
TR 40,25,26912
MAA 156,60,80
TR 42,25,27424
MAA 160,60,84
s_waitcnt vmcnt(18) lgkmcnt(8)
s_barrier
MAA 60,20,0
RD 44,23,27648
v_add_f32 v165, 0x3727c5ac, v165
MAA 76,24,0
RD 48,23,28672
s_add_u32 m0, s59, 8320
s_mov_b32 s58, 1179648
MAA 80,24,4
buffer_load_dwordx4 v5, s[24:27], s58 offen lds
MAA 64,20,4
RD 52,23,29952
MAA 68,20,8
RD 56,23,30976
MAA 84,24,8
TR 64,25,37248
MAA 88,24,12
buffer_load_dwordx4 v6, s[24:27], s58 offen offset:1024 lds
MAA 72,20,12
v_rsq_f32 v166, v165
s_waitcnt lgkmcnt(5)
MAA 104,28,12
TR 66,25,37760
MAA 120,32,12
TR 68,25,37280
s_add_u32 m0, s59, 74880
s_mov_b32 s58, 131072
MAA 116,32,8
buffer_load_dwordx4 v5, s[24:27], s58 offen lds
MAA 100,28,8
TR 70,25,37792
MAA 96,28,4
RD 60,24,29696
MAA 112,32,4
TR 72,25,38272
v_mov_b32 v165, v166
MAA 108,32,0
buffer_load_dwordx4 v6, s[24:27], s58 offen offset:1024 lds
MAA 92,28,0
TR 74,25,38784
MAA 124,0,36
TR 76,25,38304
MAA 140,0,40
s_add_u32 m0, s59, 83200
s_mov_b32 s58, 262144
MAA 144,4,40
buffer_load_dwordx4 v5, s[24:27], s58 offen lds
MAA 128,4,36
TR 78,25,38816
v_mul_f32 v166, 0x3e8293ee, v166
MAA 132,8,36
TR 80,25,39296
MAA 148,8,40
TR 82,25,39808
MAA 152,12,40
buffer_load_dwordx4 v6, s[24:27], s58 offen offset:1024 lds
MAA 136,12,36
TR 84,25,39328
MAA 156,16,36
TR 86,25,39840
MAA 160,16,40
s_waitcnt vmcnt(18) lgkmcnt(8)
s_barrier
MAA 60,64,44
RD 0,23,36864
ds_write_b128 v7, v[164:167]
MAA 76,68,44
s_add_u32 m0, s59, 16640
s_mov_b32 s58, 1310720
MAA 80,68,48
buffer_load_dwordx4 v5, s[24:27], s58 offen lds
MAA 64,64,48
RD 4,23,37888
MAA 68,64,52
RD 8,23,39168
MAA 84,68,52
RD 12,23,40192
MAA 88,68,56
TR 20,25,49664
MAA 72,64,56
TR 22,25,50176
s_waitcnt lgkmcnt(7)
MAA 104,72,56
buffer_load_dwordx4 v6, s[24:27], s58 offen offset:1024 lds
MAA 120,76,56
TR 24,25,49696
MAA 116,76,52
TR 26,25,50208
ds_write_b32 v17, v164
MAA 100,72,52
RD 16,24,38912
MAA 96,72,48
MAA 112,76,48
s_add_u32 m0, s59, 91520
s_mov_b32 s58, 393216
MAA 108,76,44
buffer_load_dwordx4 v5, s[24:27], s58 offen lds
MAA 92,72,44
TR 28,25,50688
MAA 124,44,80
TR 30,25,51200
MAA 140,44,84
TR 32,25,50720
ds_write_b32 v17, v165 offset:1024
MAA 144,48,84
TR 34,25,51232
MAA 128,48,80
TR 36,25,51712
MAA 132,52,80
buffer_load_dwordx4 v6, s[24:27], s58 offen offset:1024 lds
MAA 148,52,84
TR 38,25,52224
MAA 152,56,84
TR 40,25,51744
MAA 136,56,80
TR 42,25,52256
MAA 156,60,80
MAA 160,60,84
s_waitcnt vmcnt(16) lgkmcnt(9)
s_barrier
MAA 60,20,0
RD 44,23,46080
MAA 76,24,0
RD 48,23,47104
s_add_u32 m0, s59, 24960
s_mov_b32 s58, 1441792
MAA 80,24,4
buffer_load_dwordx4 v5, s[24:27], s58 offen lds
MAA 64,20,4
RD 52,23,48384
MAA 68,20,8
RD 56,23,49408
MAA 84,24,8
TR 64,25,62080
MAA 88,24,12
buffer_load_dwordx4 v6, s[24:27], s58 offen offset:1024 lds
MAA 72,20,12
s_waitcnt lgkmcnt(5)
MAA 104,28,12
TR 66,25,62592
MAA 120,32,12
TR 68,25,62112
s_add_u32 m0, s59, 99840
s_mov_b32 s58, 524288
MAA 116,32,8
buffer_load_dwordx4 v5, s[24:27], s58 offen lds
MAA 100,28,8
TR 70,25,62624
MAA 96,28,4
RD 60,24,48128
MAA 112,32,4
TR 72,25,63104
MAA 108,32,0
buffer_load_dwordx4 v6, s[24:27], s58 offen offset:1024 lds
MAA 92,28,0
TR 74,25,63616
MAA 124,0,36
TR 76,25,63136
MAA 140,0,40
s_add_u32 m0, s59, 108160
s_mov_b32 s58, 655360
MAA 144,4,40
buffer_load_dwordx4 v5, s[24:27], s58 offen lds
MAA 128,4,36
TR 78,25,63648
MAA 132,8,36
TR 80,25,64128
MAA 148,8,40
TR 82,25,64640
MAA 152,12,40
buffer_load_dwordx4 v6, s[24:27], s58 offen offset:1024 lds
MAA 136,12,36
TR 84,25,64160
MAA 156,16,36
TR 86,25,64672
MAA 160,16,40
s_waitcnt lgkmcnt(0)
s_barrier
MAA 156,60,80
ds_read_b128 v[232:235], v10 offset:1792
s_add_u32 m0, s59, 33280
MAA 160,60,84
ds_read_b128 v[228:231], v10 offset:1536
s_mov_b32 s58, 1572864
MAA 104,72,56
ds_read_b128 v[224:227], v10 offset:1280
MAA 120,76,56
ds_read_b128 v[220:223], v10 offset:1024
MAA 136,56,80
ds_read_b128 v[240:243], v11 offset:704
MAA 152,56,84
ds_read_b128 v[244:247], v11 offset:1728
MAA 100,72,52
buffer_load_dwordx4 v5, s[24:27], s58 offen lds
MAA 116,76,52
ds_read_b128 v[18:21], v11 offset:448
MAA 96,72,48
ds_read_b128 v[22:25], v11 offset:1472
s_waitcnt lgkmcnt(7)
v_pk_fma_f32 v[104:105], v[36:37], v[232:233], v[104:105] op_sel_hi:[1,0,1]
v_pk_mul_f32 v[104:105], v[104:105], v[232:233] op_sel:[0,1] op_sel_hi:[1,1]
v_pk_fma_f32 v[106:107], v[38:39], v[232:233], v[106:107] op_sel_hi:[1,0,1]
v_pk_mul_f32 v[106:107], v[106:107], v[232:233] op_sel:[0,1] op_sel_hi:[1,1]
v_pk_fma_f32 v[120:121], v[40:41], v[232:233], v[120:121] op_sel_hi:[1,0,1]
v_pk_mul_f32 v[120:121], v[120:121], v[232:233] op_sel:[0,1] op_sel_hi:[1,1]
v_pk_fma_f32 v[122:123], v[42:43], v[232:233], v[122:123] op_sel_hi:[1,0,1]
v_pk_mul_f32 v[122:123], v[122:123], v[232:233] op_sel:[0,1] op_sel_hi:[1,1]
s_waitcnt lgkmcnt(6)
v_pk_fma_f32 v[100:101], v[36:37], v[228:229], v[100:101] op_sel_hi:[1,0,1]
v_pk_mul_f32 v[100:101], v[100:101], v[228:229] op_sel:[0,1] op_sel_hi:[1,1]
s_waitcnt lgkmcnt(3)
v_pk_fma_f32 v[156:157], v[240:241], v[44:45], v[156:157] op_sel_hi:[1,0,1]
v_pk_fma_f32 v[158:159], v[242:243], v[44:45], v[158:159] op_sel_hi:[1,0,1]
v_pk_fma_f32 v[160:161], v[240:241], v[44:45], v[160:161] op_sel:[0,1,0] op_sel_hi:[1,1,1]
v_pk_fma_f32 v[162:163], v[242:243], v[44:45], v[162:163] op_sel:[0,1,0] op_sel_hi:[1,1,1]
s_waitcnt lgkmcnt(2)
v_pk_mul_f32 v[156:157], v[156:157], v[244:245]
v_pk_mul_f32 v[158:159], v[158:159], v[246:247]
v_pk_mul_f32 v[160:161], v[160:161], v[244:245]
v_pk_mul_f32 v[162:163], v[162:163], v[246:247]
v_pk_fma_f32 v[102:103], v[38:39], v[228:229], v[102:103] op_sel_hi:[1,0,1]
v_pk_mul_f32 v[102:103], v[102:103], v[228:229] op_sel:[0,1] op_sel_hi:[1,1]
v_pk_fma_f32 v[116:117], v[40:41], v[228:229], v[116:117] op_sel_hi:[1,0,1]
v_pk_mul_f32 v[116:117], v[116:117], v[228:229] op_sel:[0,1] op_sel_hi:[1,1]
s_waitcnt lgkmcnt(1)
v_pk_fma_f32 v[136:137], v[18:19], v[44:45], v[136:137] op_sel_hi:[1,0,1]
v_pk_fma_f32 v[138:139], v[20:21], v[44:45], v[138:139] op_sel_hi:[1,0,1]
v_pk_fma_f32 v[152:153], v[18:19], v[44:45], v[152:153] op_sel:[0,1,0] op_sel_hi:[1,1,1]
v_pk_fma_f32 v[154:155], v[20:21], v[44:45], v[154:155] op_sel:[0,1,0] op_sel_hi:[1,1,1]
s_waitcnt lgkmcnt(0)
v_pk_mul_f32 v[136:137], v[136:137], v[22:23]
v_pk_mul_f32 v[138:139], v[138:139], v[24:25]
v_pk_mul_f32 v[152:153], v[152:153], v[22:23]
v_pk_mul_f32 v[154:155], v[154:155], v[24:25]
v_pk_fma_f32 v[118:119], v[42:43], v[228:229], v[118:119] op_sel_hi:[1,0,1]
v_pk_mul_f32 v[118:119], v[118:119], v[228:229] op_sel:[0,1] op_sel_hi:[1,1]
v_pk_fma_f32 v[96:97], v[36:37], v[224:225], v[96:97] op_sel_hi:[1,0,1]
v_pk_mul_f32 v[96:97], v[96:97], v[224:225] op_sel:[0,1] op_sel_hi:[1,1]
v_pk_fma_f32 v[98:99], v[38:39], v[224:225], v[98:99] op_sel_hi:[1,0,1]
v_pk_mul_f32 v[98:99], v[98:99], v[224:225] op_sel:[0,1] op_sel_hi:[1,1]
v_cvt_pk_bf16_f32 v236, v156, v157
v_cvt_pk_bf16_f32 v237, v158, v159
MAA 112,76,48
buffer_load_dwordx4 v6, s[24:27], s58 offen offset:1024 lds
MAA 92,72,44
s_add_u32 m0, s59, 41600
v_cvt_pk_bf16_f32 v238, v160, v161
v_cvt_pk_bf16_f32 v239, v162, v163
MAA 108,76,44
ds_write_b128 v8, v[236:239] offset:1024
s_mov_b32 s58, 1703936
MAA 72,64,56
ds_read_b128 v[240:243], v11 offset:384
v_cvt_pk_bf16_f32 v196, v104, v105
MAA 88,68,56
buffer_load_dwordx4 v5, s[24:27], s58 offen lds
v_cvt_pk_bf16_f32 v197, v106, v107
v_cvt_pk_bf16_f32 v198, v120, v121
v_cvt_pk_bf16_f32 v199, v122, v123
s_nop 0
v_pk_fma_f32 v[72:73], v[28:29], v[232:233], v[72:73] op_sel_hi:[1,0,1]
v_pk_fma_f32 v[74:75], v[30:31], v[232:233], v[74:75] op_sel_hi:[1,0,1]
s_nop 0
v_pk_fma_f32 v[88:89], v[32:33], v[232:233], v[88:89] op_sel_hi:[1,0,1]
v_pk_fma_f32 v[90:91], v[34:35], v[232:233], v[90:91] op_sel_hi:[1,0,1]
v_pk_fma_f32 v[112:113], v[40:41], v[224:225], v[112:113] op_sel_hi:[1,0,1]
v_pk_mul_f32 v[112:113], v[112:113], v[224:225] op_sel:[0,1] op_sel_hi:[1,1]
v_pk_fma_f32 v[114:115], v[42:43], v[224:225], v[114:115] op_sel_hi:[1,0,1]
v_pk_mul_f32 v[114:115], v[114:115], v[224:225] op_sel:[0,1] op_sel_hi:[1,1]
v_pk_fma_f32 v[92:93], v[36:37], v[220:221], v[92:93] op_sel_hi:[1,0,1]
v_pk_mul_f32 v[92:93], v[92:93], v[220:221] op_sel:[0,1] op_sel_hi:[1,1]
v_pk_fma_f32 v[94:95], v[38:39], v[220:221], v[94:95] op_sel_hi:[1,0,1]
v_pk_mul_f32 v[94:95], v[94:95], v[220:221] op_sel:[0,1] op_sel_hi:[1,1]
v_pk_fma_f32 v[108:109], v[40:41], v[220:221], v[108:109] op_sel_hi:[1,0,1]
v_pk_mul_f32 v[108:109], v[108:109], v[220:221] op_sel:[0,1] op_sel_hi:[1,1]
v_pk_fma_f32 v[110:111], v[42:43], v[220:221], v[110:111] op_sel_hi:[1,0,1]
v_pk_mul_f32 v[110:111], v[110:111], v[220:221] op_sel:[0,1] op_sel_hi:[1,1]
v_cvt_pk_bf16_f32 v208, v136, v137
v_cvt_pk_bf16_f32 v209, v138, v139
MAA 132,52,80
s_waitcnt lgkmcnt(1)
s_barrier
ds_read_b128 v[180:183], v9
MAA 148,52,84
ds_read_b64 v[200:201], v9 offset:1024
v_cvt_pk_bf16_f32 v218, v152, v153
MAA 68,64,52
ds_read_b64 v[210:211], v9 offset:1032
v_cvt_pk_bf16_f32 v219, v154, v155
MAA 84,68,52
buffer_load_dwordx4 v6, s[24:27], s58 offen offset:1024 lds
MAA 128,48,80
s_add_u32 m0, s59, 49920
s_mov_b32 s58, 1835008
v_cvt_pk_bf16_f32 v192, v100, v101
v_cvt_pk_bf16_f32 v193, v102, v103
v_cvt_pk_bf16_f32 v194, v116, v117
v_cvt_pk_bf16_f32 v195, v118, v119
s_waitcnt lgkmcnt(3)
v_pk_fma_f32 v[132:133], v[240:241], v[44:45], v[132:133] op_sel_hi:[1,0,1]
v_pk_fma_f32 v[134:135], v[242:243], v[44:45], v[134:135] op_sel_hi:[1,0,1]
v_pk_fma_f32 v[148:149], v[240:241], v[44:45], v[148:149] op_sel:[0,1,0] op_sel_hi:[1,1,1]
v_pk_fma_f32 v[150:151], v[242:243], v[44:45], v[150:151] op_sel:[0,1,0] op_sel_hi:[1,1,1]
v_pk_fma_f32 v[68:69], v[28:29], v[228:229], v[68:69] op_sel_hi:[1,0,1]
v_pk_fma_f32 v[70:71], v[30:31], v[228:229], v[70:71] op_sel_hi:[1,0,1]
v_pk_fma_f32 v[84:85], v[32:33], v[228:229], v[84:85] op_sel_hi:[1,0,1]
v_pk_fma_f32 v[86:87], v[34:35], v[228:229], v[86:87] op_sel_hi:[1,0,1]
v_cvt_pk_bf16_f32 v176, v72, v73
v_cvt_pk_bf16_f32 v177, v74, v75
MAA 144,48,84
buffer_load_dwordx4 v5, s[24:27], s58 offen lds
MAA 64,64,48
ds_read_b128 v[244:247], v11 offset:1408
v_cvt_pk_bf16_f32 v178, v88, v89
MAA 80,68,48
ds_read_b128 v[18:21], v11 offset:320
v_cvt_pk_bf16_f32 v179, v90, v91
MAA 124,44,80
ds_read_b128 v[22:25], v11 offset:1344
v_cvt_pk_bf16_f32 v188, v96, v97
MAA 140,44,84
buffer_load_dwordx4 v6, s[24:27], s58 offen offset:1024 lds
MAA 60,64,44
s_add_u32 m0, s59, 116480
s_mov_b32 s58, 786432
.Lpad17:
s_cbranch_execz .Lnopoll54r
v_cvt_pk_bf16_f32 v189, v98, v99
MAA 76,68,44
ds_read_b128 v[240:243], v11 offset:256
v_cvt_pk_bf16_f32 v190, v112, v113
v_mfma_f32_16x16x32_bf16 v[104:107], v[192:195], v[176:179], v[46:49]
v_cvt_pk_bf16_f32 v191, v114, v115
v_cvt_pk_bf16_f32 v172, v68, v69
v_cvt_pk_bf16_f32 v173, v70, v71
v_cvt_pk_bf16_f32 v174, v84, v85
v_cvt_pk_bf16_f32 v175, v86, v87
v_pk_fma_f32 v[64:65], v[28:29], v[224:225], v[64:65] op_sel_hi:[1,0,1]
v_pk_fma_f32 v[66:67], v[30:31], v[224:225], v[66:67] op_sel_hi:[1,0,1]
s_waitcnt lgkmcnt(3)
v_pk_mul_f32 v[132:133], v[132:133], v[244:245]
v_pk_mul_f32 v[134:135], v[134:135], v[246:247]
v_pk_mul_f32 v[148:149], v[148:149], v[244:245]
v_pk_mul_f32 v[150:151], v[150:151], v[246:247]
s_waitcnt lgkmcnt(2)
v_pk_fma_f32 v[128:129], v[18:19], v[44:45], v[128:129] op_sel_hi:[1,0,1]
v_pk_fma_f32 v[130:131], v[20:21], v[44:45], v[130:131] op_sel_hi:[1,0,1]
v_pk_fma_f32 v[144:145], v[18:19], v[44:45], v[144:145] op_sel:[0,1,0] op_sel_hi:[1,1,1]
v_pk_fma_f32 v[146:147], v[20:21], v[44:45], v[146:147] op_sel:[0,1,0] op_sel_hi:[1,1,1]
s_waitcnt lgkmcnt(1)
v_pk_mul_f32 v[128:129], v[128:129], v[22:23]
v_pk_mul_f32 v[130:131], v[130:131], v[24:25]
v_pk_mul_f32 v[144:145], v[144:145], v[22:23]
v_pk_mul_f32 v[146:147], v[146:147], v[24:25]
v_pk_fma_f32 v[80:81], v[32:33], v[224:225], v[80:81] op_sel_hi:[1,0,1]
v_pk_fma_f32 v[82:83], v[34:35], v[224:225], v[82:83] op_sel_hi:[1,0,1]
v_pk_fma_f32 v[60:61], v[28:29], v[220:221], v[60:61] op_sel_hi:[1,0,1]
v_pk_fma_f32 v[62:63], v[30:31], v[220:221], v[62:63] op_sel_hi:[1,0,1]
v_pk_fma_f32 v[76:77], v[32:33], v[220:221], v[76:77] op_sel_hi:[1,0,1]
v_pk_fma_f32 v[78:79], v[34:35], v[220:221], v[78:79] op_sel_hi:[1,0,1]
v_cvt_pk_bf16_f32 v206, v132, v133
v_cvt_pk_bf16_f32 v207, v134, v135
v_mfma_f32_16x16x32_bf16 v[120:123], v[196:199], v[176:179], v[50:53]
buffer_load_dwordx4 v5, s[24:27], s58 offen lds
v_mfma_f32_16x16x32_bf16 v[100:103], v[188:191], v[172:175], v[46:49]
ds_read_b128 v[244:247], v11 offset:1280
v_cvt_pk_bf16_f32 v216, v148, v149
v_mfma_f32_16x16x32_bf16 v[116:119], v[192:195], v[172:175], v[50:53]
v_cvt_pk_bf16_f32 v217, v150, v151
v_max3_f32 v88, v104, v105, v106
s_nop 0
v_max3_f32 v89, v107, v120, v121
v_max3_f32 v88, v88, v122, v123
v_max_f32 v90, v88, v89
v_max_f32 v89, v88, v89
v_cvt_pk_bf16_f32 v204, v128, v129
buffer_load_dwordx4 v6, s[24:27], s58 offen offset:1024 lds
s_add_u32 m0, s59, 124800
s_mov_b32 s58, 917504
v_permlane16_swap_b32 v90, v89
v_cvt_pk_bf16_f32 v205, v130, v131
v_max_f32 v88, v90, v89
v_max_f32 v89, v90, v89
v_cvt_pk_bf16_f32 v214, v144, v145
v_cvt_pk_bf16_f32 v215, v146, v147
v_permlane32_swap_b32 v88, v89
v_max3_f32 v84, v100, v101, v102
v_max_f32 v88, v88, v89
buffer_load_dwordx4 v5, s[24:27], s58 offen lds
v_mul_f32 v88, v88, v234
v_pk_fma_f32 v[104:105], v[104:105], v[234:235], v[88:89] op_sel_hi:[1,0,0] neg_lo:[0,0,1] neg_hi:[0,0,1]
v_pk_fma_f32 v[106:107], v[106:107], v[234:235], v[88:89] op_sel_hi:[1,0,0] neg_lo:[0,0,1] neg_hi:[0,0,1]
v_pk_fma_f32 v[120:121], v[120:121], v[234:235], v[88:89] op_sel_hi:[1,0,0] neg_lo:[0,0,1] neg_hi:[0,0,1]
v_pk_fma_f32 v[122:123], v[122:123], v[234:235], v[88:89] op_sel_hi:[1,0,0] neg_lo:[0,0,1] neg_hi:[0,0,1]
v_exp_f32 v104, v104
v_exp_f32 v105, v105
v_exp_f32 v106, v106
v_exp_f32 v107, v107
v_exp_f32 v120, v120
v_exp_f32 v121, v121
v_exp_f32 v122, v122
v_exp_f32 v123, v123
v_cvt_pk_bf16_f32 v72, v104, v105
buffer_load_dwordx4 v6, s[24:27], s58 offen offset:1024 lds
v_cvt_pk_bf16_f32 v73, v106, v107
v_cvt_pk_bf16_f32 v74, v120, v121
v_cvt_pk_bf16_f32 v75, v122, v123
s_waitcnt lgkmcnt(1)
v_pk_fma_f32 v[124:125], v[240:241], v[44:45], v[124:125] op_sel_hi:[1,0,1]
s_waitcnt lgkmcnt(0)
v_pk_mul_f32 v[124:125], v[124:125], v[244:245]
v_pk_fma_f32 v[126:127], v[242:243], v[44:45], v[126:127] op_sel_hi:[1,0,1]
v_pk_mul_f32 v[126:127], v[126:127], v[246:247]
v_pk_fma_f32 v[140:141], v[240:241], v[44:45], v[140:141] op_sel:[0,1,0] op_sel_hi:[1,1,1]
v_pk_mul_f32 v[140:141], v[140:141], v[244:245]
v_pk_fma_f32 v[142:143], v[242:243], v[44:45], v[142:143] op_sel:[0,1,0] op_sel_hi:[1,1,1]
v_pk_mul_f32 v[142:143], v[142:143], v[246:247]
v_max3_f32 v85, v103, v116, v117
v_max3_f32 v84, v84, v118, v119
v_mfma_f32_16x16x32_bf16 v[88:91], v[248:251], v[72:75], 0
v_max_f32 v86, v84, v85
v_max_f32 v85, v84, v85
v_mfma_f32_16x16x32_bf16 v[104:107], v[206:209], v[72:75], 0
s_nop 0
v_permlane16_swap_b32 v86, v85
v_mfma_f32_16x16x32_bf16 v[120:123], v[216:219], v[72:75], 0
s_nop 1
v_rcp_f32 v88, v88
v_max_f32 v84, v86, v85
v_max_f32 v85, v86, v85
v_cvt_pk_bf16_f32 v184, v92, v93
v_pk_mul_f32 v[104:105], v[104:105], v[88:89] op_sel_hi:[1,0]
v_pk_mul_f32 v[106:107], v[106:107], v[88:89] op_sel_hi:[1,0]
v_pk_mul_f32 v[120:121], v[120:121], v[88:89] op_sel_hi:[1,0]
v_pk_mul_f32 v[122:123], v[122:123], v[88:89] op_sel_hi:[1,0]
v_cvt_pk_bf16_f32 v176, v104, v105
v_cvt_pk_bf16_f32 v177, v106, v107
v_cvt_pk_bf16_f32 v178, v120, v121
v_cvt_pk_bf16_f32 v179, v122, v123
buffer_store_dwordx4 v[176:179], v4, s[16:19], s74 offen offset:3072 sc1
v_permlane32_swap_b32 v84, v85
v_cvt_pk_bf16_f32 v185, v94, v95
v_max_f32 v84, v84, v85
v_mul_f32 v84, v84, v230
v_pk_fma_f32 v[100:101], v[100:101], v[230:231], v[84:85] op_sel_hi:[1,0,0] neg_lo:[0,0,1] neg_hi:[0,0,1]
v_pk_fma_f32 v[102:103], v[102:103], v[230:231], v[84:85] op_sel_hi:[1,0,0] neg_lo:[0,0,1] neg_hi:[0,0,1]
v_pk_fma_f32 v[116:117], v[116:117], v[230:231], v[84:85] op_sel_hi:[1,0,0] neg_lo:[0,0,1] neg_hi:[0,0,1]
v_pk_fma_f32 v[118:119], v[118:119], v[230:231], v[84:85] op_sel_hi:[1,0,0] neg_lo:[0,0,1] neg_hi:[0,0,1]
v_exp_f32 v100, v100
v_exp_f32 v101, v101
v_exp_f32 v102, v102
v_exp_f32 v103, v103
v_exp_f32 v116, v116
v_exp_f32 v117, v117
v_exp_f32 v118, v118
v_exp_f32 v119, v119
v_cvt_pk_bf16_f32 v68, v100, v101
v_cvt_pk_bf16_f32 v69, v102, v103
v_cvt_pk_bf16_f32 v70, v116, v117
v_cvt_pk_bf16_f32 v71, v118, v119
v_cvt_pk_bf16_f32 v186, v108, v109
v_cvt_pk_bf16_f32 v187, v110, v111
v_mfma_f32_16x16x32_bf16 v[84:87], v[248:251], v[68:71], 0
v_cvt_pk_bf16_f32 v168, v64, v65
v_cvt_pk_bf16_f32 v169, v66, v67
v_mfma_f32_16x16x32_bf16 v[100:103], v[204:207], v[68:71], 0
v_cvt_pk_bf16_f32 v170, v80, v81
v_cvt_pk_bf16_f32 v171, v82, v83
v_mfma_f32_16x16x32_bf16 v[116:119], v[214:217], v[68:71], 0
s_nop 1
v_rcp_f32 v84, v84
v_mfma_f32_16x16x32_bf16 v[96:99], v[184:187], v[168:171], v[46:49]
v_cvt_pk_bf16_f32 v202, v124, v125
v_cvt_pk_bf16_f32 v203, v126, v127
v_mfma_f32_16x16x32_bf16 v[112:115], v[188:191], v[168:171], v[50:53]
v_cvt_pk_bf16_f32 v212, v140, v141
v_cvt_pk_bf16_f32 v213, v142, v143
v_cvt_pk_bf16_f32 v164, v60, v61
s_nop 1
v_max3_f32 v80, v96, v97, v98
v_cvt_pk_bf16_f32 v165, v62, v63
v_pk_mul_f32 v[100:101], v[100:101], v[84:85] op_sel_hi:[1,0]
v_pk_mul_f32 v[102:103], v[102:103], v[84:85] op_sel_hi:[1,0]
v_pk_mul_f32 v[116:117], v[116:117], v[84:85] op_sel_hi:[1,0]
v_pk_mul_f32 v[118:119], v[118:119], v[84:85] op_sel_hi:[1,0]
v_cvt_pk_bf16_f32 v172, v100, v101
v_cvt_pk_bf16_f32 v173, v102, v103
v_cvt_pk_bf16_f32 v174, v116, v117
v_cvt_pk_bf16_f32 v175, v118, v119
buffer_store_dwordx4 v[172:175], v4, s[16:19], s74 offen offset:2048 sc1
v_max3_f32 v81, v99, v112, v113
v_max3_f32 v80, v80, v114, v115
v_max_f32 v82, v80, v81
v_max_f32 v81, v80, v81
v_cvt_pk_bf16_f32 v166, v76, v77
v_cvt_pk_bf16_f32 v167, v78, v79
v_permlane16_swap_b32 v82, v81
s_nop 0
v_mfma_f32_16x16x32_bf16 v[92:95], v[180:183], v[164:167], v[46:49]
v_max_f32 v80, v82, v81
v_max_f32 v81, v82, v81
v_mfma_f32_16x16x32_bf16 v[108:111], v[184:187], v[164:167], v[50:53]
s_nop 0
v_permlane32_swap_b32 v80, v81
v_max_f32 v80, v80, v81
v_mul_f32 v80, v80, v226
v_pk_fma_f32 v[96:97], v[96:97], v[226:227], v[80:81] op_sel_hi:[1,0,0] neg_lo:[0,0,1] neg_hi:[0,0,1]
v_pk_fma_f32 v[98:99], v[98:99], v[226:227], v[80:81] op_sel_hi:[1,0,0] neg_lo:[0,0,1] neg_hi:[0,0,1]
v_pk_fma_f32 v[112:113], v[112:113], v[226:227], v[80:81] op_sel_hi:[1,0,0] neg_lo:[0,0,1] neg_hi:[0,0,1]
v_pk_fma_f32 v[114:115], v[114:115], v[226:227], v[80:81] op_sel_hi:[1,0,0] neg_lo:[0,0,1] neg_hi:[0,0,1]
v_exp_f32 v96, v96
v_exp_f32 v97, v97
v_exp_f32 v98, v98
v_exp_f32 v99, v99
v_exp_f32 v112, v112
v_exp_f32 v113, v113
v_exp_f32 v114, v114
v_exp_f32 v115, v115
v_cvt_pk_bf16_f32 v64, v96, v97
v_cvt_pk_bf16_f32 v65, v98, v99
v_cvt_pk_bf16_f32 v66, v112, v113
v_cvt_pk_bf16_f32 v67, v114, v115
v_max3_f32 v76, v92, v93, v94
v_max3_f32 v77, v95, v108, v109
v_mfma_f32_16x16x32_bf16 v[80:83], v[248:251], v[64:67], 0
v_max3_f32 v76, v76, v110, v111
v_max_f32 v78, v76, v77
v_mfma_f32_16x16x32_bf16 v[96:99], v[202:205], v[64:67], 0
v_max_f32 v77, v76, v77
v_mfma_f32_16x16x32_bf16 v[112:115], v[212:215], v[64:67], 0
s_nop 2
v_rcp_f32 v80, v80
v_permlane16_swap_b32 v78, v77
s_nop 0
v_pk_mul_f32 v[96:97], v[96:97], v[80:81] op_sel_hi:[1,0]
v_pk_mul_f32 v[98:99], v[98:99], v[80:81] op_sel_hi:[1,0]
v_pk_mul_f32 v[112:113], v[112:113], v[80:81] op_sel_hi:[1,0]
v_pk_mul_f32 v[114:115], v[114:115], v[80:81] op_sel_hi:[1,0]
v_cvt_pk_bf16_f32 v168, v96, v97
v_cvt_pk_bf16_f32 v169, v98, v99
v_cvt_pk_bf16_f32 v170, v112, v113
v_cvt_pk_bf16_f32 v171, v114, v115
buffer_store_dwordx4 v[168:171], v4, s[16:19], s74 offen offset:1024 sc1
v_max_f32 v76, v78, v77
v_max_f32 v77, v78, v77
s_nop 1
v_permlane32_swap_b32 v76, v77
v_max_f32 v76, v76, v77
v_mul_f32 v76, v76, v222
v_pk_fma_f32 v[92:93], v[92:93], v[222:223], v[76:77] op_sel_hi:[1,0,0] neg_lo:[0,0,1] neg_hi:[0,0,1]
v_pk_fma_f32 v[94:95], v[94:95], v[222:223], v[76:77] op_sel_hi:[1,0,0] neg_lo:[0,0,1] neg_hi:[0,0,1]
v_pk_fma_f32 v[108:109], v[108:109], v[222:223], v[76:77] op_sel_hi:[1,0,0] neg_lo:[0,0,1] neg_hi:[0,0,1]
v_pk_fma_f32 v[110:111], v[110:111], v[222:223], v[76:77] op_sel_hi:[1,0,0] neg_lo:[0,0,1] neg_hi:[0,0,1]
v_exp_f32 v92, v92
v_exp_f32 v93, v93
v_exp_f32 v94, v94
v_exp_f32 v95, v95
v_exp_f32 v108, v108
v_exp_f32 v109, v109
v_exp_f32 v110, v110
v_exp_f32 v111, v111
v_cvt_pk_bf16_f32 v60, v92, v93
v_cvt_pk_bf16_f32 v61, v94, v95
v_cvt_pk_bf16_f32 v62, v108, v109
v_cvt_pk_bf16_f32 v63, v110, v111
s_nop 1
v_mfma_f32_16x16x32_bf16 v[76:79], v[248:251], v[60:63], 0
v_mfma_f32_16x16x32_bf16 v[92:95], v[200:203], v[60:63], 0
v_mfma_f32_16x16x32_bf16 v[108:111], v[210:213], v[60:63], 0
s_nop 5
v_rcp_f32 v76, v76
s_nop 0
v_pk_mul_f32 v[92:93], v[92:93], v[76:77] op_sel_hi:[1,0]
v_pk_mul_f32 v[94:95], v[94:95], v[76:77] op_sel_hi:[1,0]
v_pk_mul_f32 v[108:109], v[108:109], v[76:77] op_sel_hi:[1,0]
v_pk_mul_f32 v[110:111], v[110:111], v[76:77] op_sel_hi:[1,0]
v_cvt_pk_bf16_f32 v164, v92, v93
v_cvt_pk_bf16_f32 v165, v94, v95
v_cvt_pk_bf16_f32 v166, v108, v109
v_cvt_pk_bf16_f32 v167, v110, v111
buffer_store_dwordx4 v[164:167], v4, s[16:19], s74 offen sc1
s_nop 1
.Lqkve57:
.Lpad18:
s_cbranch_execz .Lnopoll54r
s_lshl_b32 s62, s6, 13
s_lshl_b32 s63, s3, 11
s_add_u32 s62, s62, s63
v_lshl_add_u32 v4, v1, 4, s62
v_lshrrev_b32 v2, 3, v1
v_cmp_eq_u32 vcc, 3, v2
v_add_u32 v2, 67108480, v4
s_nop 0
v_cndmask_b32 v4, v4, v2, vcc
v_bfe_u32 v5, v1, 3, 1
v_lshrrev_b32 v2, 4, v1
v_lshl_add_u32 v5, v2, 3, v5
s_lshl_b32 s62, s3, 1
v_add_u32 v5, s62, v5
v_mul_u32_u24 v5, 2048, v5
v_and_b32 v2, 7, v1
v_lshl_add_u32 v5, v2, 4, v5
s_lshl_b32 s62, s7, 7
v_add_u32 v5, s62, v5
v_add_u32 v6, 64512, v5
v_bfe_u32 v8, v1, 3, 2
v_mul_u32_u24 v8, 2080, v8
v_bfe_u32 v2, v1, 2, 1
v_lshl_add_u32 v8, v2, 7, v8
v_bfe_u32 v2, v1, 5, 1
v_lshl_add_u32 v8, v2, 8, v8
v_and_b32 v2, 3, v1
v_lshl_add_u32 v8, v2, 3, v8
s_mov_b32 s57, 66560
v_add_u32 v7, s57, v8
s_mov_b32 s52, 37748736
s_mov_b32 s53, 37879808
s_mov_b32 s54, 2097152
s_mul_i32 s56, s3, 2080
v_accvgpr_read_b32 v32, a224
v_accvgpr_read_b32 v33, a225
v_accvgpr_read_b32 v34, a226
v_accvgpr_read_b32 v35, a227
v_accvgpr_read_b32 v36, a228
v_accvgpr_read_b32 v37, a229
v_accvgpr_read_b32 v38, a230
v_accvgpr_read_b32 v39, a231
v_accvgpr_read_b32 v40, a232
v_accvgpr_read_b32 v41, a233
v_accvgpr_read_b32 v42, a234
v_accvgpr_read_b32 v43, a235
v_accvgpr_read_b32 v44, a236
v_accvgpr_read_b32 v45, a237
v_accvgpr_read_b32 v46, a238
v_accvgpr_read_b32 v47, a239
v_accvgpr_read_b32 v48, a240
v_accvgpr_read_b32 v49, a241
v_accvgpr_read_b32 v50, a242
v_accvgpr_read_b32 v51, a243
v_accvgpr_read_b32 v52, a244
v_accvgpr_read_b32 v53, a245
v_accvgpr_read_b32 v54, a246
v_accvgpr_read_b32 v55, a247
v_accvgpr_read_b32 v56, a248
v_accvgpr_read_b32 v57, a249
v_accvgpr_read_b32 v58, a250
v_accvgpr_read_b32 v59, a251
v_accvgpr_read_b32 v60, a252
v_accvgpr_read_b32 v61, a253
v_accvgpr_read_b32 v62, a254
v_accvgpr_read_b32 v63, a255
s_and_b32 s62, s3, 1
s_mul_i32 s62, s62, 28672
s_add_u32 s62, s62, s51
v_lshrrev_b32 v12, 4, v1
v_mul_u32_u24 v12, 57344, v12
v_and_b32 v2, 15, v1
v_lshl_add_u32 v12, v2, 4, v12
v_add_u32 v12, s62, v12
v_add_u32 v13, 6112, v12
v_add_u32 v14, 12224, v12
v_add_u32 v15, 18336, v12
s_mul_i32 s59, s3, 4224
s_mov_b32 s58, 0
s_lshl_b32 s62, s8, 10
s_add_u32 s62, s62, 30490624
s_lshl_b32 s64, s6, 10
s_add_u32 s64, s64, 30490624
s_lshr_b32 s67, s5, 2
s_and_b32 s67, s67, 3
s_lshl_b32 s67, s67, 7
s_add_u32 s64, s64, s67
v_lshl_add_u32 v252, v1, 7, s62
v_mov_b32 v253, s64
s_waitcnt vmcnt(0) lgkmcnt(0)
s_barrier
s_cmp_lg_u32 s3, 0
s_cbranch_scc1 .Lnosig60
v_mov_b32 v255, 1
s_mov_b64 exec, 15
buffer_atomic_add v255, v252, s[16:19], 0 offen
s_mov_b64 exec, -1
.Lnosig60:
s_cmp_lg_u32 s3, 1
s_cbranch_scc1 .Lnopoll63
s_mov_b64 exec, 1
s_mov_b32 s15, 0
s_mov_b64 exec, 1
v_mov_b32 v254, 0
buffer_atomic_add v254, v253, s[16:19], 0 offen sc0
.Lpoll61:
s_waitcnt vmcnt(0)
v_cmp_ne_u32 vcc, 16, v254
s_add_u32 s15, s15, 1
s_cbranch_vccz .Lnopoll63r
s_mov_b64 exec, 1
v_mov_b32 v254, 0
buffer_atomic_add v254, v253, s[16:19], 0 offen sc0
s_cmp_le_u32 s15, 100000
s_cbranch_scc1 .Lpoll61
.Lgot62:
s_waitcnt vmcnt(0)
s_branch .Lnopoll63r
.Lnopoll63:
s_mov_b64 exec, 0
s_cmp_eq_u32 s3, 2
s_cbranch_scc1 .Lpad19
s_cmp_eq_u32 s3, 3
s_cbranch_scc1 .Lpad20
s_branch .Lpad21
.Lnopoll63r:
s_mov_b64 exec, -1
s_barrier
buffer_load_dwordx4 v[64:67], v4, s[16:19], s52 offen sc1
buffer_load_dwordx4 v[68:71], v4, s[16:19], s52 offen offset:1024 sc1
s_add_u32 s52, s52, 0x40000
buffer_load_dwordx4 v[72:75], v4, s[16:19], s53 offen sc1
buffer_load_dwordx4 v[76:79], v4, s[16:19], s53 offen offset:1024 sc1
s_add_u32 s53, s53, 0x40000
buffer_load_dwordx4 v[80:83], v4, s[16:19], s52 offen sc1
buffer_load_dwordx4 v[84:87], v4, s[16:19], s52 offen offset:1024 sc1
s_add_u32 s52, s52, 0x40000
buffer_load_dwordx4 v[88:91], v4, s[16:19], s53 offen sc1
buffer_load_dwordx4 v[92:95], v4, s[16:19], s53 offen offset:1024 sc1
s_add_u32 s53, s53, 0x40000
buffer_load_dwordx4 v[96:99], v4, s[16:19], s52 offen sc1
buffer_load_dwordx4 v[100:103], v4, s[16:19], s52 offen offset:1024 sc1
s_add_u32 s52, s52, 0x40000
buffer_load_dwordx4 v[104:107], v4, s[16:19], s53 offen sc1
buffer_load_dwordx4 v[108:111], v4, s[16:19], s53 offen offset:1024 sc1
s_add_u32 s53, s53, 0x40000
ds_read_b64_tr_b16 a[0:1], v7
TR 2,7,512
TR 4,7,32
TR 6,7,544
TR 8,7,64
TR 10,7,576
TR 12,7,96
TR 14,7,608
TR 16,7,1024
TR 18,7,1536
TR 20,7,1056
TR 22,7,1568
TR 24,7,1088
TR 26,7,1600
TR 28,7,1120
TR 30,7,1632
s_waitcnt vmcnt(11) lgkmcnt(14)
MAV 32,0,64
TR 32,7,8320
TR 34,7,8832
s_waitcnt vmcnt(10)
MAV 48,0,68
buffer_load_dwordx4 v[112:115], v4, s[16:19], s52 offen sc1
s_waitcnt lgkmcnt(14)
MAV 52,4,68
TR 36,7,8352
TR 38,7,8864
MAV 36,4,64
TR 40,7,8384
TR 42,7,8896
s_waitcnt lgkmcnt(15)
MAV 40,8,64
buffer_load_dwordx4 v[116:119], v4, s[16:19], s52 offen offset:1024 sc1
MAV 56,8,68
TR 44,7,8416
s_add_u32 s52, s52, 0x40000
s_waitcnt lgkmcnt(15)
MAV 60,12,68
TR 46,7,8928
MAV 44,12,64
TR 48,7,9344
TR 50,7,9856
s_waitcnt vmcnt(11) lgkmcnt(15)
MAV 32,16,72
buffer_load_dwordx4 v[120:123], v4, s[16:19], s53 offen sc1
s_waitcnt vmcnt(11)
MAV 48,16,76
TR 52,7,9376
TR 54,7,9888
s_waitcnt lgkmcnt(15)
MAV 52,20,76
TR 56,7,9408
TR 58,7,9920
MAV 36,20,72
buffer_load_dwordx4 v[124:127], v4, s[16:19], s53 offen offset:1024 sc1
s_waitcnt lgkmcnt(15)
MAV 40,24,72
TR 60,7,9440
s_add_u32 s53, s53, 0x40000
MAV 56,24,76
TR 62,7,9952
s_waitcnt lgkmcnt(15)
MAV 60,28,76
MAV 44,28,72
s_waitcnt vmcnt(11) lgkmcnt(14)
MAV 32,32,80
TR 0,7,16640
TR 2,7,17152
s_waitcnt vmcnt(10)
MAV 48,32,84
buffer_load_dwordx4 v[64:67], v4, s[16:19], s52 offen sc1
s_waitcnt lgkmcnt(14)
MAV 52,36,84
TR 4,7,16672
TR 6,7,17184
MAV 36,36,80
TR 8,7,16704
TR 10,7,17216
s_waitcnt lgkmcnt(15)
MAV 40,40,80
buffer_load_dwordx4 v[68:71], v4, s[16:19], s52 offen offset:1024 sc1
MAV 56,40,84
TR 12,7,16736
s_add_u32 s52, s52, 0x40000
s_waitcnt lgkmcnt(15)
MAV 60,44,84
TR 14,7,17248
MAV 44,44,80
TR 16,7,17664
TR 18,7,18176
s_waitcnt vmcnt(11) lgkmcnt(15)
MAV 32,48,88
buffer_load_dwordx4 v[72:75], v4, s[16:19], s53 offen sc1
s_waitcnt vmcnt(11)
MAV 48,48,92
TR 20,7,17696
TR 22,7,18208
s_waitcnt lgkmcnt(15)
MAV 52,52,92
TR 24,7,17728
TR 26,7,18240
MAV 36,52,88
buffer_load_dwordx4 v[76:79], v4, s[16:19], s53 offen offset:1024 sc1
s_waitcnt lgkmcnt(15)
MAV 40,56,88
TR 28,7,17760
s_add_u32 s53, s53, 0x40000
MAV 56,56,92
TR 30,7,18272
s_waitcnt lgkmcnt(15)
MAV 60,60,92
MAV 44,60,88
s_waitcnt vmcnt(11) lgkmcnt(14)
MAV 32,0,96
TR 32,7,24960
TR 34,7,25472
s_waitcnt vmcnt(10)
MAV 48,0,100
buffer_load_dwordx4 v[80:83], v4, s[16:19], s52 offen sc1
s_waitcnt lgkmcnt(14)
MAV 52,4,100
TR 36,7,24992
TR 38,7,25504
MAV 36,4,96
TR 40,7,25024
TR 42,7,25536
s_waitcnt lgkmcnt(15)
MAV 40,8,96
buffer_load_dwordx4 v[84:87], v4, s[16:19], s52 offen offset:1024 sc1
MAV 56,8,100
TR 44,7,25056
s_add_u32 s52, s52, 0x40000
s_waitcnt lgkmcnt(15)
MAV 60,12,100
TR 46,7,25568
MAV 44,12,96
TR 48,7,25984
TR 50,7,26496
s_waitcnt vmcnt(11) lgkmcnt(15)
MAV 32,16,104
buffer_load_dwordx4 v[88:91], v4, s[16:19], s53 offen sc1
s_waitcnt vmcnt(11)
MAV 48,16,108
TR 52,7,26016
TR 54,7,26528
s_waitcnt lgkmcnt(15)
MAV 52,20,108
TR 56,7,26048
TR 58,7,26560
MAV 36,20,104
buffer_load_dwordx4 v[92:95], v4, s[16:19], s53 offen offset:1024 sc1
s_waitcnt lgkmcnt(15)
MAV 40,24,104
TR 60,7,26080
s_add_u32 s53, s53, 0x40000
MAV 56,24,108
TR 62,7,26592
s_waitcnt lgkmcnt(15)
MAV 60,28,108
MAV 44,28,104
s_waitcnt vmcnt(11) lgkmcnt(14)
MAV 32,32,112
TR 0,7,33280
TR 2,7,33792
s_waitcnt vmcnt(10)
MAV 48,32,116
buffer_load_dwordx4 v[96:99], v4, s[16:19], s52 offen sc1
s_waitcnt lgkmcnt(14)
MAV 52,36,116
TR 4,7,33312
TR 6,7,33824
MAV 36,36,112
TR 8,7,33344
TR 10,7,33856
s_waitcnt lgkmcnt(15)
MAV 40,40,112
buffer_load_dwordx4 v[100:103], v4, s[16:19], s52 offen offset:1024 sc1
MAV 56,40,116
TR 12,7,33376
s_add_u32 s52, s52, 0x40000
s_waitcnt lgkmcnt(15)
MAV 60,44,116
TR 14,7,33888
MAV 44,44,112
TR 16,7,34304
TR 18,7,34816
s_waitcnt vmcnt(11) lgkmcnt(15)
MAV 32,48,120
buffer_load_dwordx4 v[104:107], v4, s[16:19], s53 offen sc1
s_waitcnt vmcnt(11)
MAV 48,48,124
TR 20,7,34336
TR 22,7,34848
s_waitcnt lgkmcnt(15)
MAV 52,52,124
TR 24,7,34368
TR 26,7,34880
MAV 36,52,120
buffer_load_dwordx4 v[108:111], v4, s[16:19], s53 offen offset:1024 sc1
s_waitcnt lgkmcnt(15)
MAV 40,56,120
TR 28,7,34400
s_add_u32 s53, s53, 0x40000
MAV 56,56,124
TR 30,7,34912
s_waitcnt lgkmcnt(15)
MAV 60,60,124
MAV 44,60,120
.Lpad19:
s_cbranch_execz .Lpad22
s_waitcnt vmcnt(11) lgkmcnt(14)
MAV 32,0,64
TR 32,7,41600
TR 34,7,42112
s_waitcnt vmcnt(10)
MAV 48,0,68
buffer_load_dwordx4 v[112:115], v4, s[16:19], s52 offen sc1
s_waitcnt lgkmcnt(14)
MAV 52,4,68
TR 36,7,41632
TR 38,7,42144
MAV 36,4,64
TR 40,7,41664
TR 42,7,42176
s_waitcnt lgkmcnt(15)
MAV 40,8,64
buffer_load_dwordx4 v[116:119], v4, s[16:19], s52 offen offset:1024 sc1
MAV 56,8,68
TR 44,7,41696
s_add_u32 s52, s52, 0x40000
s_waitcnt lgkmcnt(15)
MAV 60,12,68
TR 46,7,42208
MAV 44,12,64
TR 48,7,42624
TR 50,7,43136
s_waitcnt vmcnt(11) lgkmcnt(15)
MAV 32,16,72
buffer_load_dwordx4 v[120:123], v4, s[16:19], s53 offen sc1
s_waitcnt vmcnt(11)
MAV 48,16,76
TR 52,7,42656
TR 54,7,43168
s_waitcnt lgkmcnt(15)
MAV 52,20,76
TR 56,7,42688
TR 58,7,43200
MAV 36,20,72
buffer_load_dwordx4 v[124:127], v4, s[16:19], s53 offen offset:1024 sc1
s_waitcnt lgkmcnt(15)
MAV 40,24,72
TR 60,7,42720
s_add_u32 s53, s53, 0x40000
MAV 56,24,76
TR 62,7,43232
s_waitcnt lgkmcnt(15)
MAV 60,28,76
MAV 44,28,72
s_waitcnt vmcnt(11) lgkmcnt(14)
MAV 32,32,80
TR 0,7,49920
TR 2,7,50432
s_waitcnt vmcnt(10)
MAV 48,32,84
buffer_load_dwordx4 v[64:67], v4, s[16:19], s52 offen sc1
s_waitcnt lgkmcnt(14)
MAV 52,36,84
TR 4,7,49952
TR 6,7,50464
MAV 36,36,80
TR 8,7,49984
TR 10,7,50496
s_waitcnt lgkmcnt(15)
MAV 40,40,80
buffer_load_dwordx4 v[68:71], v4, s[16:19], s52 offen offset:1024 sc1
MAV 56,40,84
TR 12,7,50016
s_add_u32 s52, s52, 0x40000
s_waitcnt lgkmcnt(15)
MAV 60,44,84
TR 14,7,50528
MAV 44,44,80
TR 16,7,50944
TR 18,7,51456
s_waitcnt vmcnt(11) lgkmcnt(15)
MAV 32,48,88
buffer_load_dwordx4 v[72:75], v4, s[16:19], s53 offen sc1
s_waitcnt vmcnt(11)
MAV 48,48,92
TR 20,7,50976
TR 22,7,51488
s_waitcnt lgkmcnt(15)
MAV 52,52,92
TR 24,7,51008
TR 26,7,51520
MAV 36,52,88
buffer_load_dwordx4 v[76:79], v4, s[16:19], s53 offen offset:1024 sc1
s_waitcnt lgkmcnt(15)
MAV 40,56,88
TR 28,7,51040
s_add_u32 s53, s53, 0x40000
MAV 56,56,92
TR 30,7,51552
s_waitcnt lgkmcnt(15)
MAV 60,60,92
MAV 44,60,88
s_waitcnt vmcnt(11) lgkmcnt(14)
MAV 32,0,96
TR 32,7,58240
TR 34,7,58752
s_waitcnt vmcnt(10)
MAV 48,0,100
buffer_load_dwordx4 v[80:83], v4, s[16:19], s52 offen sc1
s_waitcnt lgkmcnt(14)
MAV 52,4,100
TR 36,7,58272
TR 38,7,58784
MAV 36,4,96
TR 40,7,58304
TR 42,7,58816
s_waitcnt lgkmcnt(15)
MAV 40,8,96
buffer_load_dwordx4 v[84:87], v4, s[16:19], s52 offen offset:1024 sc1
MAV 56,8,100
TR 44,7,58336
s_add_u32 s52, s52, 0x40000
s_waitcnt lgkmcnt(15)
MAV 60,12,100
TR 46,7,58848
MAV 44,12,96
TR 48,7,59264
TR 50,7,59776
s_waitcnt vmcnt(11) lgkmcnt(15)
MAV 32,16,104
buffer_load_dwordx4 v[88:91], v4, s[16:19], s53 offen sc1
s_waitcnt vmcnt(11)
MAV 48,16,108
TR 52,7,59296
TR 54,7,59808
s_waitcnt lgkmcnt(15)
MAV 52,20,108
TR 56,7,59328
TR 58,7,59840
MAV 36,20,104
buffer_load_dwordx4 v[92:95], v4, s[16:19], s53 offen offset:1024 sc1
s_waitcnt lgkmcnt(15)
MAV 40,24,104
TR 60,7,59360
s_add_u32 s53, s53, 0x40000
MAV 56,24,108
TR 62,7,59872
s_waitcnt lgkmcnt(15)
MAV 60,28,108
MAV 44,28,104
s_xor_b32 s57, s57, 66560
v_add_u32 v7, s57, v8
s_waitcnt vmcnt(11) lgkmcnt(14)
MAV 32,32,112
ds_read_b64_tr_b16 a[0:1], v7
TR 2,7,512
s_waitcnt vmcnt(10)
MAV 48,32,116
buffer_load_dwordx4 v[96:99], v4, s[16:19], s52 offen sc1
s_waitcnt lgkmcnt(14)
MAV 52,36,116
TR 4,7,32
TR 6,7,544
MAV 36,36,112
TR 8,7,64
TR 10,7,576
s_waitcnt lgkmcnt(15)
MAV 40,40,112
buffer_load_dwordx4 v[100:103], v4, s[16:19], s52 offen offset:1024 sc1
MAV 56,40,116
TR 12,7,96
s_add_u32 s52, s52, 0x40000
s_waitcnt lgkmcnt(15)
MAV 60,44,116
TR 14,7,608
MAV 44,44,112
TR 16,7,1024
TR 18,7,1536
s_waitcnt vmcnt(11) lgkmcnt(15)
MAV 32,48,120
buffer_load_dwordx4 v[104:107], v4, s[16:19], s53 offen sc1
s_waitcnt vmcnt(11)
MAV 48,48,124
TR 20,7,1056
TR 22,7,1568
s_waitcnt lgkmcnt(15)
MAV 52,52,124
TR 24,7,1088
TR 26,7,1600
MAV 36,52,120
buffer_load_dwordx4 v[108:111], v4, s[16:19], s53 offen offset:1024 sc1
s_waitcnt lgkmcnt(15)
MAV 40,56,120
TR 28,7,1120
s_add_u32 s53, s53, 0x40000
MAV 56,56,124
TR 30,7,1632
s_waitcnt lgkmcnt(15)
MAV 60,60,124
MAV 44,60,120
s_waitcnt vmcnt(11) lgkmcnt(14)
MAV 32,0,64
TR 32,7,8320
TR 34,7,8832
s_waitcnt vmcnt(10)
MAV 48,0,68
buffer_load_dwordx4 v[112:115], v4, s[16:19], s52 offen sc1
s_waitcnt lgkmcnt(14)
MAV 52,4,68
TR 36,7,8352
TR 38,7,8864
MAV 36,4,64
TR 40,7,8384
TR 42,7,8896
s_waitcnt lgkmcnt(15)
MAV 40,8,64
buffer_load_dwordx4 v[116:119], v4, s[16:19], s52 offen offset:1024 sc1
MAV 56,8,68
TR 44,7,8416
s_add_u32 s52, s52, 0x40000
s_waitcnt lgkmcnt(15)
MAV 60,12,68
TR 46,7,8928
MAV 44,12,64
TR 48,7,9344
TR 50,7,9856
s_waitcnt vmcnt(11) lgkmcnt(15)
MAV 32,16,72
buffer_load_dwordx4 v[120:123], v4, s[16:19], s53 offen sc1
s_waitcnt vmcnt(11)
MAV 48,16,76
TR 52,7,9376
TR 54,7,9888
s_waitcnt lgkmcnt(15)
MAV 52,20,76
TR 56,7,9408
TR 58,7,9920
MAV 36,20,72
buffer_load_dwordx4 v[124:127], v4, s[16:19], s53 offen offset:1024 sc1
s_waitcnt lgkmcnt(15)
MAV 40,24,72
TR 60,7,9440
s_add_u32 s53, s53, 0x40000
MAV 56,24,76
TR 62,7,9952
s_waitcnt lgkmcnt(15)
MAV 60,28,76
MAV 44,28,72
s_waitcnt vmcnt(11) lgkmcnt(14)
MAV 32,32,80
TR 0,7,16640
TR 2,7,17152
s_waitcnt vmcnt(10)
MAV 48,32,84
buffer_load_dwordx4 v[64:67], v4, s[16:19], s52 offen sc1
s_waitcnt lgkmcnt(14)
MAV 52,36,84
TR 4,7,16672
TR 6,7,17184
MAV 36,36,80
TR 8,7,16704
TR 10,7,17216
s_waitcnt lgkmcnt(15)
MAV 40,40,80
buffer_load_dwordx4 v[68:71], v4, s[16:19], s52 offen offset:1024 sc1
MAV 56,40,84
TR 12,7,16736
s_add_u32 s52, s52, 0x40000
s_waitcnt lgkmcnt(15)
MAV 60,44,84
TR 14,7,17248
MAV 44,44,80
TR 16,7,17664
TR 18,7,18176
s_waitcnt vmcnt(11) lgkmcnt(15)
MAV 32,48,88
buffer_load_dwordx4 v[72:75], v4, s[16:19], s53 offen sc1
s_waitcnt vmcnt(11)
MAV 48,48,92
TR 20,7,17696
TR 22,7,18208
s_waitcnt lgkmcnt(15)
MAV 52,52,92
TR 24,7,17728
TR 26,7,18240
MAV 36,52,88
buffer_load_dwordx4 v[76:79], v4, s[16:19], s53 offen offset:1024 sc1
s_waitcnt lgkmcnt(15)
MAV 40,56,88
TR 28,7,17760
s_add_u32 s53, s53, 0x40000
MAV 56,56,92
TR 30,7,18272
s_waitcnt lgkmcnt(15)
MAV 60,60,92
MAV 44,60,88
s_waitcnt vmcnt(11) lgkmcnt(14)
MAV 32,0,96
TR 32,7,24960
TR 34,7,25472
s_waitcnt vmcnt(10)
MAV 48,0,100
buffer_load_dwordx4 v[80:83], v4, s[16:19], s52 offen sc1
s_waitcnt lgkmcnt(14)
MAV 52,4,100
TR 36,7,24992
TR 38,7,25504
MAV 36,4,96
TR 40,7,25024
TR 42,7,25536
s_waitcnt lgkmcnt(15)
MAV 40,8,96
buffer_load_dwordx4 v[84:87], v4, s[16:19], s52 offen offset:1024 sc1
MAV 56,8,100
TR 44,7,25056
s_add_u32 s52, s52, 0x40000
s_waitcnt lgkmcnt(15)
MAV 60,12,100
TR 46,7,25568
MAV 44,12,96
TR 48,7,25984
TR 50,7,26496
s_waitcnt vmcnt(11) lgkmcnt(15)
MAV 32,16,104
buffer_load_dwordx4 v[88:91], v4, s[16:19], s53 offen sc1
s_waitcnt vmcnt(11)
MAV 48,16,108
TR 52,7,26016
TR 54,7,26528
s_waitcnt lgkmcnt(15)
MAV 52,20,108
TR 56,7,26048
TR 58,7,26560
MAV 36,20,104
buffer_load_dwordx4 v[92:95], v4, s[16:19], s53 offen offset:1024 sc1
s_waitcnt lgkmcnt(15)
MAV 40,24,104
TR 60,7,26080
s_add_u32 s53, s53, 0x40000
MAV 56,24,108
TR 62,7,26592
s_waitcnt lgkmcnt(15)
MAV 60,28,108
MAV 44,28,104
s_waitcnt vmcnt(11) lgkmcnt(14)
MAV 32,32,112
TR 0,7,33280
TR 2,7,33792
s_waitcnt vmcnt(10)
MAV 48,32,116
buffer_load_dwordx4 v[96:99], v4, s[16:19], s52 offen sc1
s_waitcnt lgkmcnt(14)
MAV 52,36,116
TR 4,7,33312
TR 6,7,33824
MAV 36,36,112
TR 8,7,33344
TR 10,7,33856
s_waitcnt lgkmcnt(15)
MAV 40,40,112
buffer_load_dwordx4 v[100:103], v4, s[16:19], s52 offen offset:1024 sc1
MAV 56,40,116
TR 12,7,33376
s_add_u32 s52, s52, 0x40000
s_waitcnt lgkmcnt(15)
MAV 60,44,116
TR 14,7,33888
MAV 44,44,112
TR 16,7,34304
TR 18,7,34816
s_waitcnt vmcnt(11) lgkmcnt(15)
MAV 32,48,120
buffer_load_dwordx4 v[104:107], v4, s[16:19], s53 offen sc1
s_waitcnt vmcnt(11)
MAV 48,48,124
TR 20,7,34336
TR 22,7,34848
s_waitcnt lgkmcnt(15)
MAV 52,52,124
TR 24,7,34368
TR 26,7,34880
MAV 36,52,120
buffer_load_dwordx4 v[108:111], v4, s[16:19], s53 offen offset:1024 sc1
s_waitcnt lgkmcnt(15)
MAV 40,56,120
TR 28,7,34400
s_add_u32 s53, s53, 0x40000
MAV 56,56,124
TR 30,7,34912
s_waitcnt lgkmcnt(15)
MAV 60,60,124
MAV 44,60,120
s_waitcnt vmcnt(11) lgkmcnt(14)
MAV 32,0,64
TR 32,7,41600
TR 34,7,42112
s_waitcnt vmcnt(10)
MAV 48,0,68
buffer_load_dwordx4 v[112:115], v4, s[16:19], s52 offen sc1
s_waitcnt lgkmcnt(14)
MAV 52,4,68
TR 36,7,41632
TR 38,7,42144
MAV 36,4,64
TR 40,7,41664
TR 42,7,42176
s_waitcnt lgkmcnt(15)
MAV 40,8,64
buffer_load_dwordx4 v[116:119], v4, s[16:19], s52 offen offset:1024 sc1
MAV 56,8,68
TR 44,7,41696
s_add_u32 s52, s52, 0x40000
s_waitcnt lgkmcnt(15)
MAV 60,12,68
TR 46,7,42208
MAV 44,12,64
TR 48,7,42624
TR 50,7,43136
s_waitcnt vmcnt(11) lgkmcnt(15)
MAV 32,16,72
buffer_load_dwordx4 v[120:123], v4, s[16:19], s53 offen sc1
s_waitcnt vmcnt(11)
MAV 48,16,76
TR 52,7,42656
TR 54,7,43168
s_waitcnt lgkmcnt(15)
MAV 52,20,76
TR 56,7,42688
TR 58,7,43200
MAV 36,20,72
buffer_load_dwordx4 v[124:127], v4, s[16:19], s53 offen offset:1024 sc1
s_waitcnt lgkmcnt(15)
MAV 40,24,72
TR 60,7,42720
s_add_u32 s53, s53, 0x40000
MAV 56,24,76
TR 62,7,43232
s_waitcnt lgkmcnt(15)
MAV 60,28,76
MAV 44,28,72
s_waitcnt lgkmcnt(0)
s_barrier
s_waitcnt vmcnt(11)
MAV 32,32,80
TR 0,7,49920
TR 2,7,50432
s_add_u32 m0, s59, 84480
s_waitcnt vmcnt(10)
MAV 48,32,84
TR 4,7,49952
buffer_load_dwordx4 v12, s[32:35], s58 offen lds
MAV 52,36,84
TR 6,7,50464
TR 8,7,49984
MAV 36,36,80
TR 10,7,50496
MAV 40,40,80
TR 12,7,50016
buffer_load_dwordx4 v13, s[32:35], s58 offen offset:1056 lds
MAV 56,40,84
TR 14,7,50528
TR 16,7,50944
MAV 60,44,84
TR 18,7,51456
TR 20,7,50976
MAV 44,44,80
TR 22,7,51488
s_waitcnt vmcnt(11)
MAV 32,48,88
TR 24,7,51008
buffer_load_dwordx4 v14, s[32:35], s58 offen offset:2112 lds
s_waitcnt vmcnt(11)
MAV 48,48,92
TR 26,7,51520
TR 28,7,51040
MAV 52,52,92
TR 30,7,51552
MAV 36,52,88
buffer_load_dwordx4 v15, s[32:35], s58 offen offset:3168 lds
MAV 40,56,88
s_add_u32 s58, s58, 229376
MAV 56,56,92
MAV 60,60,92
MAV 44,60,88
s_waitcnt vmcnt(11) lgkmcnt(14)
MAV 32,0,96
TR 32,7,58240
s_add_u32 m0, s59, 101376
s_waitcnt vmcnt(10)
MAV 48,0,100
buffer_load_dwordx4 v12, s[32:35], s58 offen lds
s_waitcnt lgkmcnt(13)
MAV 52,4,100
TR 34,7,58752
TR 36,7,58272
MAV 36,4,96
TR 38,7,58784
TR 40,7,58304
s_waitcnt lgkmcnt(15)
MAV 40,8,96
buffer_load_dwordx4 v13, s[32:35], s58 offen offset:1056 lds
MAV 56,8,100
TR 42,7,58816
TR 44,7,58336
s_waitcnt lgkmcnt(15)
MAV 60,12,100
TR 46,7,58848
MAV 44,12,96
TR 48,7,59264
TR 50,7,59776
s_waitcnt vmcnt(11) lgkmcnt(15)
MAV 32,16,104
buffer_load_dwordx4 v14, s[32:35], s58 offen offset:2112 lds
s_waitcnt vmcnt(11)
MAV 48,16,108
TR 52,7,59296
TR 54,7,59808
s_waitcnt lgkmcnt(15)
MAV 52,20,108
TR 56,7,59328
TR 58,7,59840
MAV 36,20,104
buffer_load_dwordx4 v15, s[32:35], s58 offen offset:3168 lds
s_waitcnt lgkmcnt(15)
MAV 40,24,104
TR 60,7,59360
s_add_u32 s58, s58, 229376
MAV 56,24,108
TR 62,7,59872
s_waitcnt lgkmcnt(15)
MAV 60,28,108
MAV 44,28,104
s_waitcnt vmcnt(11) lgkmcnt(14)
MAV 32,32,112
s_add_u32 m0, s59, 118272
s_lshl_b32 s64, s6, 14
s_lshl_b32 s65, s49, 13
s_waitcnt vmcnt(10)
MAV 48,32,116
buffer_load_dwordx4 v12, s[32:35], s58 offen lds
s_waitcnt lgkmcnt(12)
MAV 52,36,116
s_add_u32 s64, s64, s65
s_lshl_b32 s65, s7, 9
s_add_u32 s64, s64, s65
MAV 36,36,112
s_lshl_b32 s65, s48, 8
s_add_u32 s64, s64, s65
s_add_u32 s64, s64, 63176704
s_waitcnt lgkmcnt(10)
MAV 40,40,112
s_lshl_b32 s62, s7, 18
v_and_b32 v152, 31, v1
v_lshlrev_b32 v152, 3, v152
MAV 56,40,116
buffer_load_dwordx4 v13, s[32:35], s58 offen offset:1056 lds
s_waitcnt lgkmcnt(8)
MAV 60,44,116
s_add_u32 s62, s62, 41943040
v_lshrrev_b32 v153, 5, v1
v_lshl_add_u32 v152, v153, 28, v152
MAV 44,44,112
s_add_u32 s63, s62, 0x20000
s_waitcnt vmcnt(11) lgkmcnt(6)
MAV 32,48,120
s_waitcnt vmcnt(10)
MAV 48,48,124
buffer_load_dwordx4 v14, s[32:35], s58 offen offset:2112 lds
s_waitcnt lgkmcnt(4)
MAV 52,52,124
s_nop 2
v_cvt_pk_bf16_f32 v128, v32, v33
v_cvt_pk_bf16_f32 v129, v34, v35
MAV 36,52,120
v_cvt_pk_bf16_f32 v136, v48, v49
v_cvt_pk_bf16_f32 v137, v50, v51
s_waitcnt lgkmcnt(2)
MAV 40,56,120
v_cvt_pk_bf16_f32 v138, v52, v53
v_cvt_pk_bf16_f32 v139, v54, v55
MAV 56,56,124
.Lpad20:
s_cbranch_execz .Lpad23
buffer_load_dwordx4 v15, s[32:35], s58 offen offset:3168 lds
s_waitcnt lgkmcnt(0)
MAV 60,60,124
s_add_u32 s58, s58, 229376
v_cvt_pk_bf16_f32 v130, v36, v37
v_cvt_pk_bf16_f32 v131, v38, v39
MAV 44,60,120
v_cvt_pk_bf16_f32 v132, v40, v41
v_cvt_pk_bf16_f32 v133, v42, v43
v_cvt_pk_bf16_f32 v140, v56, v57
v_cvt_pk_bf16_f32 v141, v58, v59
v_cvt_pk_bf16_f32 v142, v60, v61
v_cvt_pk_bf16_f32 v143, v62, v63
v_pk_mul_f32 v[146:147], v[32:33], v[32:33]
buffer_store_dwordx4 v[128:131], v4, s[16:19], s62 offen sc1
v_cvt_pk_bf16_f32 v134, v44, v45
v_cvt_pk_bf16_f32 v135, v46, v47
v_pk_mul_f32 v[150:151], v[48:49], v[48:49]
v_pk_fma_f32 v[146:147], v[34:35], v[34:35], v[146:147]
v_pk_add_f32 v[144:145], v[32:33], v[34:35]
v_pk_fma_f32 v[150:151], v[50:51], v[50:51], v[150:151]
v_pk_add_f32 v[148:149], v[48:49], v[50:51]
v_pk_fma_f32 v[146:147], v[36:37], v[36:37], v[146:147]
v_pk_add_f32 v[144:145], v[144:145], v[36:37]
v_pk_fma_f32 v[150:151], v[52:53], v[52:53], v[150:151]
v_pk_add_f32 v[148:149], v[148:149], v[52:53]
v_pk_fma_f32 v[146:147], v[38:39], v[38:39], v[146:147]
v_pk_add_f32 v[144:145], v[144:145], v[38:39]
buffer_store_dwordx4 v[132:135], v4, s[16:19], s63 offen sc1
v_pk_fma_f32 v[150:151], v[54:55], v[54:55], v[150:151]
v_pk_add_f32 v[148:149], v[148:149], v[54:55]
v_pk_fma_f32 v[146:147], v[40:41], v[40:41], v[146:147]
v_pk_add_f32 v[144:145], v[144:145], v[40:41]
v_pk_fma_f32 v[150:151], v[56:57], v[56:57], v[150:151]
v_pk_add_f32 v[148:149], v[148:149], v[56:57]
v_pk_fma_f32 v[146:147], v[42:43], v[42:43], v[146:147]
v_pk_add_f32 v[144:145], v[144:145], v[42:43]
v_pk_fma_f32 v[150:151], v[58:59], v[58:59], v[150:151]
v_pk_add_f32 v[148:149], v[148:149], v[58:59]
v_pk_fma_f32 v[146:147], v[44:45], v[44:45], v[146:147]
v_pk_add_f32 v[144:145], v[144:145], v[44:45]
v_pk_fma_f32 v[150:151], v[60:61], v[60:61], v[150:151]
buffer_store_dwordx4 v[136:139], v4, s[16:19], s62 offen offset:1024 sc1
v_pk_add_f32 v[148:149], v[148:149], v[60:61]
v_pk_fma_f32 v[146:147], v[46:47], v[46:47], v[146:147]
v_pk_add_f32 v[144:145], v[144:145], v[46:47]
v_pk_fma_f32 v[150:151], v[62:63], v[62:63], v[150:151]
v_pk_add_f32 v[148:149], v[148:149], v[62:63]
v_add_f32 v144, v144, v145
v_add_f32 v146, v146, v147
v_add_f32 v148, v148, v149
v_add_f32 v150, v150, v151
s_nop 0
v_permlane16_swap_b32 v144, v148
v_permlane16_swap_b32 v146, v150
v_add_f32 v144, v144, v148
buffer_store_dwordx4 v[140:143], v4, s[16:19], s63 offen offset:1024 sc1
v_add_f32 v146, v146, v150
s_nop 1
v_permlane32_swap_b32 v144, v146
v_add_f32 v144, v144, v146
s_nop 1
v_permlane32_swap_b32 v144, v145
buffer_store_dwordx2 v[144:145], v152, s[16:19], s64 offen sc1
s_nop 1
v_accvgpr_write_b32 a224, v32
v_accvgpr_write_b32 a225, v33
v_accvgpr_write_b32 a226, v34
v_accvgpr_write_b32 a227, v35
v_accvgpr_write_b32 a228, v36
v_accvgpr_write_b32 a229, v37
v_accvgpr_write_b32 a230, v38
v_accvgpr_write_b32 a231, v39
v_accvgpr_write_b32 a232, v40
v_accvgpr_write_b32 a233, v41
v_accvgpr_write_b32 a234, v42
v_accvgpr_write_b32 a235, v43
v_accvgpr_write_b32 a236, v44
v_accvgpr_write_b32 a237, v45
v_accvgpr_write_b32 a238, v46
v_accvgpr_write_b32 a239, v47
v_accvgpr_write_b32 a240, v48
v_accvgpr_write_b32 a241, v49
v_accvgpr_write_b32 a242, v50
v_accvgpr_write_b32 a243, v51
v_accvgpr_write_b32 a244, v52
v_accvgpr_write_b32 a245, v53
v_accvgpr_write_b32 a246, v54
v_accvgpr_write_b32 a247, v55
v_accvgpr_write_b32 a248, v56
v_accvgpr_write_b32 a249, v57
v_accvgpr_write_b32 a250, v58
v_accvgpr_write_b32 a251, v59
v_accvgpr_write_b32 a252, v60
v_accvgpr_write_b32 a253, v61
v_accvgpr_write_b32 a254, v62
v_accvgpr_write_b32 a255, v63
s_lshl_b32 s62, s10, 14
s_lshl_b32 s63, s3, 12
s_add_u32 s62, s62, s63
s_lshl_b32 s63, s12, 11
s_add_u32 s62, s62, s63
v_lshl_add_u32 v10, v1, 4, s62
v_lshrrev_b32 v2, 3, v1
v_cmp_eq_u32 vcc, 3, v2
v_add_u32 v2, 67108480, v10
s_nop 0
v_cndmask_b32 v10, v10, v2, vcc
v_xor_b32 v11, 2048, v10
v_bfe_u32 v16, v1, 2, 3
v_mul_u32_u24 v16, 1056, v16
v_bfe_u32 v2, v1, 5, 1
v_lshl_add_u32 v16, v2, 8, v16
v_and_b32 v2, 3, v1
v_lshl_add_u32 v16, v2, 3, v16
s_lshl_b32 s62, s12, 6
s_add_u32 s62, s62, 84480
s_xor_b32 s63, s12, 1
s_mul_i32 s63, s63, 192
s_add_u32 s63, s63, 84480
v_add_u32 v17, s63, v16
v_add_u32 v16, s62, v16
s_mov_b32 s52, 41943040
s_mov_b32 s54, s58
s_mov_b32 s55, s59
s_mul_i32 s59, s3, 2112
s_and_b32 s62, s7, 1
s_mul_i32 s62, s62, 3670016
s_lshr_b32 s63, s7, 1
s_lshl_b32 s63, s63, 8
s_add_u32 s62, s62, s63
s_lshl_b32 s63, s3, 12
s_add_u32 s62, s62, s63
v_lshrrev_b32 v5, 4, v1
v_lshlrev_b32 v5, 14, v5
v_and_b32 v2, 15, v1
v_lshl_add_u32 v5, v2, 4, v5
v_add_u32 v5, s62, v5
v_add_u32 v6, 992, v5
s_lshl_b32 s62, s10, 15
s_lshl_b32 s63, s3, 13
s_add_u32 s62, s62, s63
v_lshl_add_u32 v4, v1, 4, s62
s_lshl_b32 s62, s6, 10
s_add_u32 s62, s62, 30507008
s_lshl_b32 s64, s10, 1
s_lshl_b32 s64, s64, 10
s_add_u32 s64, s64, 30507008
s_lshr_b32 s67, s5, 2
s_and_b32 s67, s67, 3
s_lshl_b32 s67, s67, 7
s_add_u32 s64, s64, s67
s_add_u32 s65, s64, 1024
v_lshl_add_u32 v252, v1, 7, s62
v_mov_b32 v253, s64
v_writelane_b32 v253, s65, 1
s_waitcnt vmcnt(0) lgkmcnt(0)
s_barrier
s_cmp_lg_u32 s3, 0
s_cbranch_scc1 .Lnosig65
v_mov_b32 v255, 1
s_mov_b64 exec, 15
buffer_atomic_add v255, v252, s[16:19], 0 offen
s_mov_b64 exec, -1
.Lnosig65:
s_cmp_lg_u32 s3, 1
s_cbranch_scc1 .Lnopoll68
s_mov_b64 exec, 3
s_mov_b32 s15, 0
s_mov_b64 exec, 3
v_mov_b32 v254, 0
buffer_atomic_add v254, v253, s[16:19], 0 offen sc0
.Lpoll66:
s_waitcnt vmcnt(0)
v_cmp_ne_u32 vcc, 16, v254
s_add_u32 s15, s15, 1
s_cbranch_vccz .Lnopoll68r
s_mov_b64 exec, 3
v_mov_b32 v254, 0
buffer_atomic_add v254, v253, s[16:19], 0 offen sc0
s_cmp_le_u32 s15, 100000
s_cbranch_scc1 .Lpoll66
.Lgot67:
s_waitcnt vmcnt(0)
s_branch .Lnopoll68r
.Lnopoll68:
s_mov_b64 exec, 0
s_cmp_eq_u32 s3, 2
s_cbranch_scc1 .Lpad24
s_cmp_eq_u32 s3, 3
s_cbranch_scc1 .Lpad25
s_branch .Lpad26
.Lnopoll68r:
s_mov_b64 exec, -1
s_barrier
buffer_load_dwordx4 a[128:131], v10, s[16:19], s52 offen sc1
buffer_load_dwordx4 a[132:135], v10, s[16:19], s52 offen offset:1024 sc1
buffer_load_dwordx4 a[136:139], v11, s[16:19], s52 offen sc1
buffer_load_dwordx4 a[140:143], v11, s[16:19], s52 offen offset:1024 sc1
s_add_u32 s52, s52, 0x20000
buffer_load_dwordx4 a[144:147], v10, s[16:19], s52 offen sc1
buffer_load_dwordx4 a[148:151], v10, s[16:19], s52 offen offset:1024 sc1
buffer_load_dwordx4 a[152:155], v11, s[16:19], s52 offen sc1
buffer_load_dwordx4 a[156:159], v11, s[16:19], s52 offen offset:1024 sc1
s_add_u32 s52, s52, 0x20000
ds_read_b64_tr_b16 a[0:1], v16
TR 2,16,512
TR 4,16,32
TR 6,16,544
TR 8,16,8448
TR 10,16,8960
TR 12,16,8480
TR 14,16,8992
TR 16,16,64
TR 18,16,576
TR 20,16,96
TR 22,16,608
TR 24,16,8512
TR 26,16,9024
TR 28,16,8544
TR 30,16,9056
TR 32,16,128
TR 34,16,640
TR 36,16,160
TR 38,16,672
TR 40,16,8576
TR 42,16,9088
TR 44,16,8608
TR 46,16,9120
ds_read_b64_tr_b16 a[48:49], v17
TR 50,17,512
TR 52,17,32
TR 54,17,544
TR 56,17,8448
TR 58,17,8960
TR 60,17,8480
TR 62,17,8992
s_add_u32 m0, s55, 135168
s_nop 0
buffer_load_dwordx4 v12, s[32:35], s54 offen lds
buffer_load_dwordx4 v13, s[32:35], s54 offen offset:1056 lds
buffer_load_dwordx4 v14, s[32:35], s54 offen offset:2112 lds
buffer_load_dwordx4 v15, s[32:35], s54 offen offset:3168 lds
s_add_u32 s54, s54, 229376
s_mul_i32 s66, s13, 917504
s_add_u32 s66, s66, 46137344
s_add_u32 s65, s66, 393216
s_lshl_b32 s62, s12, 19
s_add_u32 s62, s62, s66
s_add_u32 s63, s62, 0x20000
s_add_u32 s64, s62, 0x40000
s_lshl_b32 s72, s10, 1
s_lshr_b32 s74, s11, 4
s_add_u32 s72, s72, s74
s_lshl_b32 s72, s72, 10
s_add_u32 s72, s72, 30523392
s_and_b32 s73, s6, 14
s_and_b32 s74, s7, 1
s_add_u32 s73, s73, s74
s_lshl_b32 s73, s73, 10
s_add_u32 s73, s73, 30523392
s_lshr_b32 s67, s5, 2
s_and_b32 s67, s67, 3
s_lshl_b32 s67, s67, 7
s_add_u32 s73, s73, s67
s_lshl_b32 s74, s3, 10
s_lshl_b32 s75, s12, 9
s_add_u32 s74, s74, s75
s_add_u32 s74, s74, 152576
v_and_b32 v18, 15, v1
v_lshl_add_u32 v18, v18, 4, s74
v_xor_b32 v19, 512, v18
s_lshl_b32 s74, s12, 7
s_add_u32 s74, s74, 161536
s_xor_b32 s75, s12, 1
s_mul_i32 s75, s75, 384
s_add_u32 s75, s75, 161536
v_lshrrev_b32 v9, 4, v1
v_lshlrev_b32 v9, 4, v9
v_add_u32 v8, s75, v9
v_add_u32 v9, s74, v9
s_lshl_b32 s74, s3, 13
s_add_u32 s74, s74, 49920
v_lshl_add_u32 v2, v1, 4, s74
s_waitcnt lgkmcnt(0)
s_barrier
s_waitcnt vmcnt(11)
v_mfma_f32_16x16x32_bf16 v[32:35], a[0:3], a[128:131], 0
buffer_load_dwordx4 a[160:163], v10, s[16:19], s52 offen sc1
s_waitcnt vmcnt(11)
v_mfma_f32_16x16x32_bf16 v[36:39], a[0:3], a[132:135], 0
TR 64,16,16896
v_mfma_f32_16x16x32_bf16 v[52:55], a[4:7], a[132:135], 0
TR 66,16,17408
v_mfma_f32_16x16x32_bf16 v[48:51], a[4:7], a[128:131], 0
TR 68,16,16928
v_mfma_f32_16x16x32_bf16 v[64:67], a[8:11], a[128:131], 0
buffer_load_dwordx4 a[164:167], v10, s[16:19], s52 offen offset:1024 sc1
v_mfma_f32_16x16x32_bf16 v[68:71], a[8:11], a[132:135], 0
TR 70,16,17440
v_mfma_f32_16x16x32_bf16 v[84:87], a[12:15], a[132:135], 0
TR 72,16,25344
v_mfma_f32_16x16x32_bf16 v[80:83], a[12:15], a[128:131], 0
TR 74,16,25856
v_mfma_f32_16x16x32_bf16 v[96:99], a[16:19], a[128:131], 0
buffer_load_dwordx4 a[168:171], v11, s[16:19], s52 offen sc1
v_mfma_f32_16x16x32_bf16 v[100:103], a[16:19], a[132:135], 0
TR 76,16,25376
v_mfma_f32_16x16x32_bf16 v[116:119], a[20:23], a[132:135], 0
TR 78,16,25888
v_mfma_f32_16x16x32_bf16 v[112:115], a[20:23], a[128:131], 0
TR 80,16,16960
v_mfma_f32_16x16x32_bf16 v[128:131], a[24:27], a[128:131], 0
buffer_load_dwordx4 a[172:175], v11, s[16:19], s52 offen offset:1024 sc1
v_mfma_f32_16x16x32_bf16 v[132:135], a[24:27], a[132:135], 0
s_add_u32 s52, s52, 0x20000
s_add_u32 m0, s55, 84480
v_mfma_f32_16x16x32_bf16 v[148:151], a[28:31], a[132:135], 0
TR 82,16,17472
v_mfma_f32_16x16x32_bf16 v[144:147], a[28:31], a[128:131], 0
TR 84,16,16992
v_mfma_f32_16x16x32_bf16 v[160:163], a[32:35], a[128:131], 0
buffer_load_dwordx4 v12, s[32:35], s54 offen lds
v_mfma_f32_16x16x32_bf16 v[164:167], a[32:35], a[132:135], 0
TR 86,16,17504
v_mfma_f32_16x16x32_bf16 v[180:183], a[36:39], a[132:135], 0
TR 88,16,25408
v_mfma_f32_16x16x32_bf16 v[176:179], a[36:39], a[128:131], 0
TR 90,16,25920
v_mfma_f32_16x16x32_bf16 v[192:195], a[40:43], a[128:131], 0
buffer_load_dwordx4 a[176:179], v10, s[16:19], s52 offen sc1
v_mfma_f32_16x16x32_bf16 v[196:199], a[40:43], a[132:135], 0
TR 92,16,25440
v_mfma_f32_16x16x32_bf16 v[212:215], a[44:47], a[132:135], 0
TR 94,16,25952
v_mfma_f32_16x16x32_bf16 v[208:211], a[44:47], a[128:131], 0
TR 96,16,17024
v_mfma_f32_16x16x32_bf16 v[224:227], a[48:51], a[128:131], 0
buffer_load_dwordx4 v13, s[32:35], s54 offen offset:1056 lds
v_mfma_f32_16x16x32_bf16 v[228:231], a[48:51], a[132:135], 0
TR 98,16,17536
v_mfma_f32_16x16x32_bf16 v[236:239], a[52:55], a[132:135], 0
TR 100,16,17056
v_mfma_f32_16x16x32_bf16 v[232:235], a[52:55], a[128:131], 0
TR 102,16,17568
v_mfma_f32_16x16x32_bf16 v[240:243], a[56:59], a[128:131], 0
buffer_load_dwordx4 a[180:183], v10, s[16:19], s52 offen offset:1024 sc1
v_mfma_f32_16x16x32_bf16 v[244:247], a[56:59], a[132:135], 0
TR 104,16,25472
v_mfma_f32_16x16x32_bf16 v[252:255], a[60:63], a[132:135], 0
TR 106,16,25984
v_mfma_f32_16x16x32_bf16 v[248:251], a[60:63], a[128:131], 0
TR 108,16,25504
s_waitcnt vmcnt(16)
v_mfma_f32_16x16x32_bf16 v[220:223], a[44:47], a[140:143], 0
buffer_load_dwordx4 v14, s[32:35], s54 offen offset:2112 lds
v_mfma_f32_16x16x32_bf16 v[216:219], a[44:47], a[136:139], 0
TR 110,16,26016
v_mfma_f32_16x16x32_bf16 v[200:203], a[40:43], a[136:139], 0
TR 112,17,16896
v_mfma_f32_16x16x32_bf16 v[204:207], a[40:43], a[140:143], 0
TR 114,17,17408
v_mfma_f32_16x16x32_bf16 v[188:191], a[36:39], a[140:143], 0
buffer_load_dwordx4 a[184:187], v11, s[16:19], s52 offen sc1
v_mfma_f32_16x16x32_bf16 v[184:187], a[36:39], a[136:139], 0
TR 116,17,16928
v_mfma_f32_16x16x32_bf16 v[168:171], a[32:35], a[136:139], 0
TR 118,17,17440
v_mfma_f32_16x16x32_bf16 v[172:175], a[32:35], a[140:143], 0
TR 120,17,25344
v_mfma_f32_16x16x32_bf16 v[156:159], a[28:31], a[140:143], 0
buffer_load_dwordx4 v15, s[32:35], s54 offen offset:3168 lds
v_mfma_f32_16x16x32_bf16 v[152:155], a[28:31], a[136:139], 0
s_add_u32 s54, s54, 229376
TR 122,17,25856
v_mfma_f32_16x16x32_bf16 v[136:139], a[24:27], a[136:139], 0
TR 124,17,25376
v_mfma_f32_16x16x32_bf16 v[140:143], a[24:27], a[140:143], 0
TR 126,17,25888
v_mfma_f32_16x16x32_bf16 v[124:127], a[20:23], a[140:143], 0
buffer_load_dwordx4 a[188:191], v11, s[16:19], s52 offen offset:1024 sc1
v_mfma_f32_16x16x32_bf16 v[120:123], a[20:23], a[136:139], 0
s_add_u32 s52, s52, 0x20000
v_mfma_f32_16x16x32_bf16 v[104:107], a[16:19], a[136:139], 0
v_mfma_f32_16x16x32_bf16 v[108:111], a[16:19], a[140:143], 0
v_mfma_f32_16x16x32_bf16 v[92:95], a[12:15], a[140:143], 0
v_mfma_f32_16x16x32_bf16 v[88:91], a[12:15], a[136:139], 0
v_mfma_f32_16x16x32_bf16 v[72:75], a[8:11], a[136:139], 0
v_mfma_f32_16x16x32_bf16 v[76:79], a[8:11], a[140:143], 0
v_mfma_f32_16x16x32_bf16 v[60:63], a[4:7], a[140:143], 0
v_mfma_f32_16x16x32_bf16 v[56:59], a[4:7], a[136:139], 0
v_mfma_f32_16x16x32_bf16 v[40:43], a[0:3], a[136:139], 0
v_mfma_f32_16x16x32_bf16 v[44:47], a[0:3], a[140:143], 0
s_waitcnt lgkmcnt(0)
s_barrier
s_waitcnt vmcnt(19)
MAA 32,64,144
s_add_u32 m0, s74, 0
s_mov_b32 s67, 63176704
s_waitcnt vmcnt(18)
MAA 36,64,148
buffer_load_dwordx4 v4, s[16:19], s67 offen sc1 lds
MAA 52,68,148
TR 0,16,33792
MAA 48,68,144
TR 2,16,34304
MAA 64,72,144
buffer_load_dwordx4 v4, s[16:19], s67 offen offset:1024 sc1 lds
MAA 68,72,148
TR 4,16,33824
MAA 84,76,148
TR 6,16,34336
MAA 80,76,144
buffer_load_dwordx4 v4, s[16:19], s67 offen offset:2048 sc1 lds
MAA 96,80,144
TR 8,16,42240
MAA 100,80,148
TR 10,16,42752
MAA 116,84,148
buffer_load_dwordx4 v4, s[16:19], s67 offen offset:3072 sc1 lds
MAA 112,84,144
s_add_u32 m0, s74, 4096
s_mov_b32 s67, 63180800
MAA 128,88,144
TR 12,16,42272
MAA 132,88,148
buffer_load_dwordx4 v4, s[16:19], s67 offen sc1 lds
MAA 148,92,148
TR 14,16,42784
MAA 144,92,144
TR 16,16,33856
MAA 160,96,144
buffer_load_dwordx4 v4, s[16:19], s67 offen offset:1024 sc1 lds
MAA 164,96,148
TR 18,16,34368
MAA 180,100,148
TR 20,16,33888
MAA 176,100,144
buffer_load_dwordx4 v4, s[16:19], s67 offen offset:2048 sc1 lds
MAA 192,104,144
TR 22,16,34400
MAA 196,104,148
TR 24,16,42304
MAA 212,108,148
buffer_load_dwordx4 v4, s[16:19], s67 offen offset:3072 sc1 lds
MAA 208,108,144
s_add_u32 m0, s55, 101376
TR 26,16,42816
MAA 224,112,144
TR 28,16,42336
MAA 228,112,148
buffer_load_dwordx4 v12, s[32:35], s54 offen lds
MAA 236,116,148
TR 30,16,42848
MAA 232,116,144
TR 32,16,33920
MAA 240,120,144
buffer_load_dwordx4 a[128:131], v10, s[16:19], s52 offen sc1
MAA 244,120,148
TR 34,16,34432
MAA 252,124,148
TR 36,16,33952
MAA 248,124,144
buffer_load_dwordx4 v13, s[32:35], s54 offen offset:1056 lds
s_waitcnt vmcnt(27)
MAA 220,108,156
TR 38,16,34464
MAA 216,108,152
TR 40,16,42368
MAA 200,104,152
buffer_load_dwordx4 a[132:135], v10, s[16:19], s52 offen offset:1024 sc1
MAA 204,104,156
TR 42,16,42880
MAA 188,100,156
TR 44,16,42400
MAA 184,100,152
buffer_load_dwordx4 v14, s[32:35], s54 offen offset:2112 lds
MAA 168,96,152
TR 46,16,42912
MAA 172,96,156
TR 48,17,33792
MAA 156,92,156
buffer_load_dwordx4 a[136:139], v11, s[16:19], s52 offen sc1
MAA 152,92,152
TR 50,17,34304
MAA 136,88,152
TR 52,17,33824
MAA 140,88,156
buffer_load_dwordx4 v15, s[32:35], s54 offen offset:3168 lds
MAA 124,84,156
s_add_u32 s54, s54, 229376
TR 54,17,34336
MAA 120,84,152
TR 56,17,42240
MAA 104,80,152
buffer_load_dwordx4 a[140:143], v11, s[16:19], s52 offen offset:1024 sc1
MAA 108,80,156
s_add_u32 s52, s52, 0x20000
TR 58,17,42752
MAA 92,76,156
TR 60,17,42272
MAA 88,76,152
TR 62,17,42784
MAA 72,72,152
MAA 76,72,156
MAA 60,68,156
MAA 56,68,152
MAA 40,64,152
MAA 44,64,156
s_waitcnt vmcnt(28) lgkmcnt(0)
s_barrier
s_waitcnt vmcnt(27)
MAA 32,0,160
s_add_u32 m0, s55, 118272
TR 64,16,50688
s_waitcnt vmcnt(26)
MAA 36,0,164
buffer_load_dwordx4 v12, s[32:35], s54 offen lds
MAA 52,4,164
TR 66,16,51200
MAA 48,4,160
TR 68,16,50720
MAA 64,8,160
TR 70,16,51232
MAA 68,8,164
TR 72,16,59136
MAA 84,12,164
TR 74,16,59648
MAA 80,12,160
buffer_load_dwordx4 a[144:147], v10, s[16:19], s52 offen sc1
MAA 96,16,160
TR 76,16,59168
MAA 100,16,164
TR 78,16,59680
MAA 116,20,164
TR 80,16,50752
MAA 112,20,160
TR 82,16,51264
MAA 128,24,160
TR 84,16,50784
MAA 132,24,164
s_waitcnt vmcnt(10)
ds_read_b128 v[20:23], v2
MAA 148,28,164
ds_read_b128 v[28:31], v2 offset:1024
MAA 144,28,160
ds_read_b128 v[24:27], v2 offset:2048
MAA 160,32,160
buffer_load_dwordx4 v13, s[32:35], s54 offen offset:1056 lds
MAA 164,32,164
TR 86,16,51296
MAA 180,36,164
TR 88,16,59200
MAA 176,36,160
TR 90,16,59712
MAA 192,40,160
TR 92,16,59232
MAA 196,40,164
TR 94,16,59744
MAA 212,44,164
buffer_load_dwordx4 a[148:151], v10, s[16:19], s52 offen offset:1024 sc1
MAA 208,44,160
TR 96,16,50816
s_waitcnt lgkmcnt(7)
v_add_f32 v20, v20, v28
MAA 224,48,160
TR 98,16,51328
v_add_f32 v21, v21, v29
MAA 228,48,164
TR 100,16,50848
v_add_f32 v22, v22, v30
MAA 236,52,164
TR 102,16,51360
v_add_f32 v23, v23, v31
MAA 232,52,160
ds_read_b128 v[28:31], v2 offset:3072
s_waitcnt lgkmcnt(10)
v_add_f32 v20, v20, v24
MAA 240,56,160
buffer_load_dwordx4 v14, s[32:35], s54 offen offset:2112 lds
MAA 244,56,164
TR 104,16,59264
v_add_f32 v21, v21, v25
.Lpad21:
s_cbranch_execz .Lnopoll63r
MAA 252,60,164
TR 106,16,59776
v_add_f32 v22, v22, v26
MAA 248,60,160
TR 108,16,59296
v_add_f32 v23, v23, v27
MAA 220,44,172
ds_read_b128 v[24:27], v2 offset:4096
MAA 216,44,168
TR 110,16,59808
MAA 200,40,168
buffer_load_dwordx4 a[152:155], v11, s[16:19], s52 offen sc1
MAA 204,40,172
TR 112,17,50688
s_waitcnt lgkmcnt(6)
v_add_f32 v20, v20, v28
MAA 188,36,172
TR 114,17,51200
v_add_f32 v21, v21, v29
MAA 184,36,168
TR 116,17,50720
v_add_f32 v22, v22, v30
MAA 168,32,168
TR 118,17,51232
v_add_f32 v23, v23, v31
MAA 172,32,172
ds_read_b128 v[28:31], v2 offset:5120
MAA 156,28,172
buffer_load_dwordx4 v15, s[32:35], s54 offen offset:3168 lds
MAA 152,28,168
s_add_u32 s54, s54, 229376
s_waitcnt lgkmcnt(6)
v_add_f32 v20, v20, v24
v_add_f32 v21, v21, v25
MAA 136,24,168
TR 120,17,59136
v_add_f32 v22, v22, v26
MAA 140,24,172
TR 122,17,59648
MAA 124,20,172
TR 124,17,59168
MAA 120,20,168
TR 126,17,59680
MAA 104,16,168
buffer_load_dwordx4 a[156:159], v11, s[16:19], s52 offen offset:1024 sc1
MAA 108,16,172
s_add_u32 s52, s52, 0x20000
MAA 92,12,172
MAA 88,12,168
MAA 72,8,168
MAA 76,8,172
MAA 60,4,172
MAA 56,4,168
MAA 40,0,168
MAA 44,0,172
s_waitcnt lgkmcnt(0)
s_barrier
MAA 32,64,176
s_add_u32 m0, s55, 135168
v_add_f32 v23, v23, v27
v_add_f32 v20, v20, v28
MAA 36,64,180
ds_read_b128 v[24:27], v2 offset:6144
v_add_f32 v21, v21, v29
MAA 52,68,180
buffer_load_dwordx4 v12, s[32:35], s54 offen lds
MAA 48,68,176
ds_read_b64_tr_b16 a[0:1], v16
v_add_f32 v22, v22, v30
MAA 64,72,176
TR 2,16,512
v_add_f32 v23, v23, v31
MAA 68,72,180
ds_read_b128 v[28:31], v2 offset:7168
MAA 84,76,180
TR 4,16,32
MAA 80,76,176
TR 6,16,544
MAA 96,80,176
buffer_load_dwordx4 a[160:163], v10, s[16:19], s52 offen sc1
MAA 100,80,180
TR 8,16,8448
s_waitcnt lgkmcnt(6)
v_add_f32 v20, v20, v24
MAA 116,84,180
TR 10,16,8960
v_add_f32 v21, v21, v25
MAA 112,84,176
TR 12,16,8480
v_add_f32 v22, v22, v26
MAA 128,88,176
TR 14,16,8992
v_add_f32 v23, v23, v27
MAA 132,88,180
TR 16,16,64
s_waitcnt lgkmcnt(7)
v_add_f32 v20, v20, v28
MAA 148,92,180
buffer_load_dwordx4 v13, s[32:35], s54 offen offset:1056 lds
MAA 144,92,176
TR 18,16,576
v_add_f32 v21, v21, v29
MAA 160,96,176
TR 20,16,96
v_add_f32 v22, v22, v30
MAA 164,96,180
TR 22,16,608
v_permlane32_swap_b32 v20, v22
MAA 180,100,180
TR 24,16,8512
v_add_f32 v23, v23, v31
MAA 176,100,176
TR 26,16,9024
v_permlane32_swap_b32 v21, v23
MAA 192,104,176
buffer_load_dwordx4 a[164:167], v10, s[16:19], s52 offen offset:1024 sc1
MAA 196,104,180
TR 28,16,8544
v_add_f32 v20, v20, v22
MAA 212,108,180
TR 30,16,9056
v_add_f32 v21, v21, v23
MAA 208,108,176
TR 32,16,128
v_mul_f32 v20, 0xba800000, v20
MAA 224,112,176
TR 34,16,640
v_mul_f32 v21, 0x3a800000, v21
MAA 228,112,180
TR 36,16,160
v_fma_f32 v21, -v20, v20, v21
MAA 236,116,180
buffer_load_dwordx4 v14, s[32:35], s54 offen offset:2112 lds
MAA 232,116,176
TR 38,16,672
v_max_f32 v21, 0, v21
MAA 240,120,176
TR 40,16,8576
v_add_f32 v21, 0x3727c5ac, v21
MAA 244,120,180
TR 42,16,9088
v_rsq_f32 v22, v21
MAA 252,124,180
TR 44,16,8608
v_and_b32 v24, 31, v1
MAA 248,124,176
TR 46,16,9120
v_lshrrev_b32 v25, 5, v1
MAA 220,108,188
buffer_load_dwordx4 a[168:171], v11, s[16:19], s52 offen sc1
MAA 216,108,184
ds_read_b64_tr_b16 a[48:49], v17
v_lshl_add_u32 v24, v24, 1, v25
MAA 200,104,184
TR 50,17,512
v_and_b32 v25, 0xc0, v0
MAA 204,104,188
TR 52,17,32
v_add_u32 v24, v24, v25
MAA 188,100,188
TR 54,17,544
v_lshlrev_b32 v24, 4, v24
MAA 184,100,184
TR 56,17,8448
v_add_u32 v24, 152576, v24
MAA 168,96,184
buffer_load_dwordx4 v15, s[32:35], s54 offen offset:3168 lds
MAA 172,96,188
s_add_u32 s54, s54, 229376
v_mul_f32 v22, 0xbfb8aa3b, v22
MAA 156,92,188
ds_write_b128 v24, v[20:23]
MAA 152,92,184
ds_read_b64 v[20:21], v18
MAA 136,88,184
ds_read_b64 v[22:23], v18 offset:256
MAA 140,88,188
ds_read_b64 v[24:25], v19
MAA 124,84,188
ds_read_b64 v[26:27], v19 offset:256
MAA 120,84,184
ds_read_b32 v28, v18 offset:8
MAA 104,80,184
ds_read_b32 v29, v18 offset:264
MAA 108,80,188
ds_read_b32 v30, v19 offset:8
MAA 92,76,188
ds_read_b32 v31, v19 offset:264
MAA 88,76,184
buffer_load_dwordx4 a[172:175], v11, s[16:19], s52 offen offset:1024 sc1
MAA 72,72,184
s_add_u32 s52, s52, 0x20000
TR 58,17,8960
MAA 76,72,188
TR 60,17,8480
MAA 60,68,188
TR 62,17,8992
MAA 56,68,184
MAA 40,64,184
MAA 44,64,188
s_mov_b32 s58, -458752
s_sub_u32 s67, s59, 16896
s_mov_b32 s15, -6
.p2align 6
.Lk70:
s_waitcnt vmcnt(17) lgkmcnt(0)
s_barrier
MAA 32,0,128
TR 64,16,16896
s_add_u32 m0, s55, 84480
MAA 36,0,132
buffer_load_dwordx4 v12, s[32:35], s54 offen lds
MAA 52,4,132
TR 66,16,17408
MAA 48,4,128
TR 68,16,16928
MAA 64,8,128
TR 70,16,17440
MAA 68,8,132
MAA 84,12,132
TR 72,16,25344
MAA 80,12,128
buffer_load_dwordx4 a[176:179], v10, s[16:19], s52 offen sc1
MAA 96,16,128
TR 74,16,25856
MAA 100,16,132
TR 76,16,25376
MAA 116,20,132
MAA 112,20,128
TR 78,16,25888
MAA 128,24,128
TR 80,16,16960
MAA 132,24,132
buffer_load_dwordx4 v13, s[32:35], s54 offen offset:1056 lds
MAA 148,28,132
TR 82,16,17472
MAA 144,28,128
MAA 160,32,128
TR 84,16,16992
MAA 164,32,132
TR 86,16,17504
MAA 180,36,132
TR 88,16,25408
MAA 176,36,128
buffer_load_dwordx4 a[180:183], v10, s[16:19], s52 offen offset:1024 sc1
MAA 192,40,128
MAA 196,40,132
TR 90,16,25920
MAA 212,44,132
TR 92,16,25440
MAA 208,44,128
TR 94,16,25952
MAA 224,48,128
MAA 228,48,132
buffer_load_dwordx4 v14, s[32:35], s54 offen offset:2112 lds
MAA 236,52,132
TR 96,16,17024
MAA 232,52,128
TR 98,16,17536
MAA 240,56,128
TR 100,16,17056
MAA 244,56,132
TR 102,16,17568
MAA 252,60,132
MAA 248,60,128
buffer_load_dwordx4 a[184:187], v11, s[16:19], s52 offen sc1
s_waitcnt vmcnt(22)
MAA 220,44,140
TR 104,16,25472
MAA 216,44,136
TR 106,16,25984
MAA 200,40,136
TR 108,16,25504
MAA 204,40,140
MAA 188,36,140
TR 110,16,26016
MAA 184,36,136
buffer_load_dwordx4 v15, s[32:35], s54 offen offset:3168 lds
MAA 168,32,136
TR 112,17,16896
s_add_u32 s54, s54, 229376
MAA 172,32,140
TR 114,17,17408
MAA 156,28,140
MAA 152,28,136
TR 116,17,16928
MAA 136,24,136
TR 118,17,17440
MAA 140,24,140
buffer_load_dwordx4 a[188:191], v11, s[16:19], s52 offen offset:1024 sc1
MAA 124,20,140
TR 120,17,25344
s_add_u32 s52, s52, 0x20000
MAA 120,20,136
MAA 104,16,136
TR 122,17,25856
MAA 108,16,140
TR 124,17,25376
MAA 92,12,140
TR 126,17,25888
s_max_i32 m0, s67, s59
MAA 88,12,136
buffer_load_dwordx4 v5, s[28:31], s58 offen lds
MAA 72,8,136
MAA 76,8,140
MAA 60,4,140
MAA 56,4,136
MAA 40,0,136
MAA 44,0,140
s_waitcnt vmcnt(18) lgkmcnt(0)
s_barrier
MAA 32,64,144
TR 0,16,33792
s_add_u32 m0, s55, 101376
MAA 36,64,148
buffer_load_dwordx4 v12, s[32:35], s54 offen lds
MAA 52,68,148
TR 2,16,34304
MAA 48,68,144
TR 4,16,33824
MAA 64,72,144
TR 6,16,34336
MAA 68,72,148
MAA 84,76,148
TR 8,16,42240
MAA 80,76,144
buffer_load_dwordx4 a[128:131], v10, s[16:19], s52 offen sc1
MAA 96,80,144
TR 10,16,42752
MAA 100,80,148
TR 12,16,42272
MAA 116,84,148
TR 14,16,42784
MAA 112,84,144
MAA 128,88,144
TR 16,16,33856
MAA 132,88,148
buffer_load_dwordx4 v13, s[32:35], s54 offen offset:1056 lds
MAA 148,92,148
TR 18,16,34368
MAA 144,92,144
TR 20,16,33888
MAA 160,96,144
MAA 164,96,148
TR 22,16,34400
MAA 180,100,148
TR 24,16,42304
MAA 176,100,144
buffer_load_dwordx4 a[132:135], v10, s[16:19], s52 offen offset:1024 sc1
MAA 192,104,144
TR 26,16,42816
MAA 196,104,148
TR 28,16,42336
MAA 212,108,148
MAA 208,108,144
TR 30,16,42848
MAA 224,112,144
TR 32,16,33920
MAA 228,112,148
buffer_load_dwordx4 v14, s[32:35], s54 offen offset:2112 lds
MAA 236,116,148
TR 34,16,34432
MAA 232,116,144
MAA 240,120,144
TR 36,16,33952
MAA 244,120,148
TR 38,16,34464
MAA 252,124,148
TR 40,16,42368
MAA 248,124,144
buffer_load_dwordx4 a[136:139], v11, s[16:19], s52 offen sc1
s_waitcnt vmcnt(23)
MAA 220,108,156
TR 42,16,42880
MAA 216,108,152
MAA 200,104,152
TR 44,16,42400
MAA 204,104,156
TR 46,16,42912
MAA 188,100,156
TR 48,17,33792
MAA 184,100,152
buffer_load_dwordx4 v15, s[32:35], s54 offen offset:3168 lds
MAA 168,96,152
s_add_u32 s54, s54, 229376
MAA 172,96,156
TR 50,17,34304
MAA 156,92,156
TR 52,17,33824
MAA 152,92,152
TR 54,17,34336
MAA 136,88,152
TR 56,17,42240
MAA 140,88,156
buffer_load_dwordx4 a[140:143], v11, s[16:19], s52 offen offset:1024 sc1
MAA 124,84,156
s_add_u32 s52, s52, 0x20000
MAA 120,84,152
TR 58,17,42752
MAA 104,80,152
TR 60,17,42272
MAA 108,80,156
TR 62,17,42784
MAA 92,76,156
s_max_i32 m0, s67, s59
MAA 88,76,152
buffer_load_dwordx4 v6, s[28:31], s58 offen offset:1056 lds
MAA 72,72,152
s_add_u32 s67, s67, 8448
s_add_u32 s58, s58, 262144
MAA 76,72,156
MAA 60,68,156
MAA 56,68,152
MAA 40,64,152
MAA 44,64,156
s_waitcnt vmcnt(19) lgkmcnt(0)
s_barrier
MAA 32,0,160
TR 64,16,50688
s_add_u32 m0, s55, 118272
MAA 36,0,164
buffer_load_dwordx4 v12, s[32:35], s54 offen lds
MAA 52,4,164
TR 66,16,51200
MAA 48,4,160
TR 68,16,50720
MAA 64,8,160
TR 70,16,51232
MAA 68,8,164
MAA 84,12,164
TR 72,16,59136
MAA 80,12,160
buffer_load_dwordx4 a[144:147], v10, s[16:19], s52 offen sc1
MAA 96,16,160
TR 74,16,59648
MAA 100,16,164
TR 76,16,59168
MAA 116,20,164
MAA 112,20,160
TR 78,16,59680
MAA 128,24,160
TR 80,16,50752
MAA 132,24,164
buffer_load_dwordx4 v13, s[32:35], s54 offen offset:1056 lds
MAA 148,28,164
TR 82,16,51264
MAA 144,28,160
MAA 160,32,160
TR 84,16,50784
MAA 164,32,164
TR 86,16,51296
MAA 180,36,164
TR 88,16,59200
MAA 176,36,160
buffer_load_dwordx4 a[148:151], v10, s[16:19], s52 offen offset:1024 sc1
MAA 192,40,160
MAA 196,40,164
TR 90,16,59712
MAA 212,44,164
TR 92,16,59232
MAA 208,44,160
TR 94,16,59744
MAA 224,48,160
MAA 228,48,164
buffer_load_dwordx4 v14, s[32:35], s54 offen offset:2112 lds
MAA 236,52,164
TR 96,16,50816
MAA 232,52,160
TR 98,16,51328
MAA 240,56,160
TR 100,16,50848
MAA 244,56,164
TR 102,16,51360
MAA 252,60,164
MAA 248,60,160
buffer_load_dwordx4 a[152:155], v11, s[16:19], s52 offen sc1
s_waitcnt vmcnt(24)
MAA 220,44,172
TR 104,16,59264
MAA 216,44,168
TR 106,16,59776
MAA 200,40,168
TR 108,16,59296
MAA 204,40,172
MAA 188,36,172
TR 110,16,59808
MAA 184,36,168
buffer_load_dwordx4 v15, s[32:35], s54 offen offset:3168 lds
MAA 168,32,168
TR 112,17,50688
s_add_u32 s54, s54, 229376
MAA 172,32,172
TR 114,17,51200
MAA 156,28,172
MAA 152,28,168
TR 116,17,50720
MAA 136,24,168
TR 118,17,51232
MAA 140,24,172
buffer_load_dwordx4 a[156:159], v11, s[16:19], s52 offen offset:1024 sc1
MAA 124,20,172
TR 120,17,59136
s_add_u32 s52, s52, 0x20000
MAA 120,20,168
MAA 104,16,168
TR 122,17,59648
MAA 108,16,172
TR 124,17,59168
MAA 92,12,172
TR 126,17,59680
s_max_i32 m0, s67, s59
MAA 88,12,168
buffer_load_dwordx4 v5, s[28:31], s58 offen lds
MAA 72,8,168
MAA 76,8,172
MAA 60,4,172
MAA 56,4,168
MAA 40,0,168
MAA 44,0,172
s_waitcnt vmcnt(20) lgkmcnt(0)
s_barrier
MAA 32,64,176
ds_read_b64_tr_b16 a[0:1], v16
s_add_u32 m0, s55, 135168
MAA 36,64,180
buffer_load_dwordx4 v12, s[32:35], s54 offen lds
MAA 52,68,180
TR 2,16,512
MAA 48,68,176
TR 4,16,32
MAA 64,72,176
TR 6,16,544
MAA 68,72,180
MAA 84,76,180
TR 8,16,8448
MAA 80,76,176
buffer_load_dwordx4 a[160:163], v10, s[16:19], s52 offen sc1
MAA 96,80,176
TR 10,16,8960
MAA 100,80,180
.Lpad22:
s_cbranch_execz .Lnopoll63r
TR 12,16,8480
MAA 116,84,180
TR 14,16,8992
MAA 112,84,176
MAA 128,88,176
TR 16,16,64
MAA 132,88,180
buffer_load_dwordx4 v13, s[32:35], s54 offen offset:1056 lds
MAA 148,92,180
TR 18,16,576
MAA 144,92,176
TR 20,16,96
MAA 160,96,176
MAA 164,96,180
TR 22,16,608
MAA 180,100,180
TR 24,16,8512
MAA 176,100,176
buffer_load_dwordx4 a[164:167], v10, s[16:19], s52 offen offset:1024 sc1
MAA 192,104,176
TR 26,16,9024
MAA 196,104,180
TR 28,16,8544
MAA 212,108,180
MAA 208,108,176
TR 30,16,9056
MAA 224,112,176
TR 32,16,128
MAA 228,112,180
buffer_load_dwordx4 v14, s[32:35], s54 offen offset:2112 lds
MAA 236,116,180
TR 34,16,640
MAA 232,116,176
MAA 240,120,176
TR 36,16,160
MAA 244,120,180
TR 38,16,672
MAA 252,124,180
TR 40,16,8576
MAA 248,124,176
buffer_load_dwordx4 a[168:171], v11, s[16:19], s52 offen sc1
s_waitcnt vmcnt(25)
MAA 220,108,188
TR 42,16,9088
MAA 216,108,184
MAA 200,104,184
TR 44,16,8608
MAA 204,104,188
TR 46,16,9120
MAA 188,100,188
ds_read_b64_tr_b16 a[48:49], v17
MAA 184,100,184
buffer_load_dwordx4 v15, s[32:35], s54 offen offset:3168 lds
MAA 168,96,184
s_add_u32 s54, s54, 229376
MAA 172,96,188
TR 50,17,512
MAA 156,92,188
TR 52,17,32
MAA 152,92,184
TR 54,17,544
MAA 136,88,184
TR 56,17,8448
MAA 140,88,188
buffer_load_dwordx4 a[172:175], v11, s[16:19], s52 offen offset:1024 sc1
MAA 124,84,188
s_add_u32 s52, s52, 0x20000
MAA 120,84,184
TR 58,17,8960
MAA 104,80,184
TR 60,17,8480
MAA 108,80,188
TR 62,17,8992
MAA 92,76,188
s_max_i32 m0, s67, s59
MAA 88,76,184
buffer_load_dwordx4 v6, s[28:31], s58 offen offset:1056 lds
MAA 72,72,184
s_add_u32 s67, s67, 8448
s_add_u32 s58, s58, 196608
MAA 76,72,188
MAA 60,68,188
MAA 56,68,184
MAA 40,64,184
s_add_u32 s15, s15, 1
MAA 44,64,188
s_cbranch_scc0 .Lk70
s_waitcnt vmcnt(11) lgkmcnt(0)
s_barrier
MAA 32,0,128
ds_read_b128 v[12:15], v9
v_mov_b32 v18, v5
MAA 48,4,128
buffer_load_dwordx4 a[176:179], v10, s[16:19], s52 offen sc1
MAA 64,8,128
TR 64,16,16896
v_mov_b32 v19, v6
MAA 80,12,128
ds_read_b128 v[4:7], v9 offset:64
s_mov_b32 s58, 2293760
MAA 36,0,132
TR 66,16,17408
s_lshl_b32 s74, s6, 13
MAA 52,4,132
buffer_load_dwordx4 a[180:183], v10, s[16:19], s52 offen offset:1024 sc1
MAA 68,8,132
TR 68,16,16928
s_lshl_b32 s75, s3, 11
MAA 84,12,132
TR 70,16,17440
s_add_u32 s74, s74, s75
MAA 40,0,136
TR 72,16,25344
s_waitcnt lgkmcnt(6)
v_fmac_f32 v32, v12, v20
MAA 56,4,136
buffer_load_dwordx4 a[184:187], v11, s[16:19], s52 offen sc1
MAA 72,8,136
TR 74,16,25856
v_fmac_f32 v33, v13, v20
MAA 88,12,136
TR 76,16,25376
v_fmac_f32 v34, v14, v20
MAA 44,0,140
TR 78,16,25888
v_fmac_f32 v35, v15, v20
MAA 60,4,140
buffer_load_dwordx4 a[188:191], v11, s[16:19], s52 offen offset:1024 sc1
MAA 76,8,140
s_add_u32 s52, s52, 0x20000
TR 80,16,33792
MAA 92,12,140
TR 82,16,34304
v_fmac_f32 v36, v12, v22
MAA 96,16,128
TR 84,16,33824
v_fmac_f32 v37, v13, v22
MAA 112,20,128
TR 86,16,34336
v_fmac_f32 v38, v14, v22
MAA 128,24,128
TR 88,16,42240
v_fmac_f32 v39, v15, v22
MAA 144,28,128
TR 90,16,42752
v_fmac_f32 v40, v12, v24
MAA 100,16,132
TR 92,16,42272
v_fmac_f32 v41, v13, v24
MAA 116,20,132
TR 94,16,42784
v_fmac_f32 v42, v14, v24
MAA 132,24,132
TR 112,16,16960
v_fmac_f32 v43, v15, v24
MAA 148,28,132
TR 114,16,17472
v_fmac_f32 v44, v12, v26
MAA 104,16,136
TR 116,16,16992
v_fmac_f32 v45, v13, v26
MAA 120,20,136
TR 118,16,17504
v_fmac_f32 v46, v14, v26
MAA 136,24,136
TR 120,16,25408
v_fmac_f32 v47, v15, v26
MAA 152,28,136
ds_read_b128 v[12:15], v9 offset:512
s_waitcnt lgkmcnt(15)
v_fmac_f32 v48, v4, v20
MAA 108,16,140
TR 122,16,25920
v_fmac_f32 v49, v5, v20
MAA 124,20,140
TR 124,16,25440
v_fmac_f32 v50, v6, v20
MAA 140,24,140
TR 126,16,25952
v_fmac_f32 v51, v7, v20
MAA 156,28,140
TR 192,16,33856
v_fmac_f32 v52, v4, v22
MAA 160,32,128
TR 194,16,34368
v_fmac_f32 v53, v5, v22
MAA 176,36,128
TR 196,16,33888
v_fmac_f32 v54, v6, v22
MAA 192,40,128
TR 198,16,34400
v_fmac_f32 v55, v7, v22
MAA 208,44,128
TR 200,16,42304
v_fmac_f32 v56, v4, v24
MAA 164,32,132
TR 202,16,42816
v_fmac_f32 v57, v5, v24
MAA 180,36,132
TR 204,16,42336
s_waitcnt vmcnt(6)
s_barrier
MAA 196,40,132
TR 96,16,50688
v_fmac_f32 v58, v6, v24
MAA 212,44,132
TR 98,16,51200
v_fmac_f32 v59, v7, v24
MAA 168,32,136
TR 100,16,50720
v_fmac_f32 v60, v4, v26
MAA 184,36,136
TR 102,16,51232
v_fmac_f32 v61, v5, v26
MAA 200,40,136
TR 104,16,59136
v_fmac_f32 v62, v6, v26
MAA 216,44,136
TR 106,16,59648
v_fmac_f32 v63, v7, v26
MAA 172,32,140
ds_read_b128 v[4:7], v9 offset:576
s_waitcnt lgkmcnt(15)
v_fmac_f32 v64, v12, v20
MAA 188,36,140
TR 108,16,59168
v_fmac_f32 v65, v13, v20
MAA 204,40,140
TR 110,16,59680
v_fmac_f32 v66, v14, v20
MAA 220,44,140
TR 206,16,42848
v_fmac_f32 v67, v15, v20
MAA 224,48,128
TR 208,16,50752
v_fmac_f32 v68, v12, v22
MAA 232,52,128
TR 210,16,51264
v_fmac_f32 v69, v13, v22
MAA 240,56,128
TR 212,16,50784
v_fmac_f32 v70, v14, v22
MAA 248,60,128
TR 214,16,51296
v_fmac_f32 v71, v15, v22
MAA 228,48,132
TR 216,16,59200
v_fmac_f32 v72, v12, v24
MAA 236,52,132
TR 218,16,59712
v_fmac_f32 v73, v13, v24
MAA 244,56,132
TR 220,16,59232
v_fmac_f32 v74, v14, v24
MAA 252,60,132
TR 222,16,59744
v_fmac_f32 v75, v15, v24
MAA 32,64,144
TR 0,16,17024
v_fmac_f32 v76, v12, v26
MAA 48,68,144
TR 2,16,17536
v_fmac_f32 v77, v13, v26
MAA 64,72,144
TR 4,16,17056
v_fmac_f32 v78, v14, v26
v_fmac_f32 v79, v15, v26
ds_read_b128 v[12:15], v9 offset:832
s_waitcnt lgkmcnt(15)
v_fmac_f32 v80, v4, v20
v_fmac_f32 v81, v5, v20
v_fmac_f32 v82, v6, v20
v_fmac_f32 v83, v7, v20
v_fmac_f32 v84, v4, v22
v_fmac_f32 v85, v5, v22
MAA 80,76,144
TR 6,16,17568
v_fmac_f32 v86, v6, v22
MAA 32,80,160
TR 8,16,25472
v_fmac_f32 v87, v7, v22
MAA 48,84,160
TR 10,16,25984
v_fmac_f32 v88, v4, v24
MAA 64,88,160
TR 12,16,25504
v_fmac_f32 v89, v5, v24
MAA 80,92,160
TR 14,16,26016
v_fmac_f32 v90, v6, v24
s_waitcnt vmcnt(3)
MAA 32,96,176
TR 16,16,33920
v_fmac_f32 v91, v7, v24
MAA 48,100,176
TR 18,16,34432
v_fmac_f32 v92, v4, v26
MAA 64,104,176
TR 20,16,33952
v_fmac_f32 v93, v5, v26
s_waitcnt lgkmcnt(15)
MAA 80,108,176
TR 22,16,34464
v_fmac_f32 v94, v6, v26
v_fmac_f32 v95, v7, v26
ds_read_b128 v[4:7], v9 offset:704
v_pk_mul_f32 v[64:65], v[64:65], v[32:33]
v_pk_mul_f32 v[32:33], v[32:33], v[28:29] op_sel_hi:[1,0]
v_pk_mul_f32 v[66:67], v[66:67], v[34:35]
v_pk_mul_f32 v[34:35], v[34:35], v[28:29] op_sel_hi:[1,0]
v_pk_mul_f32 v[80:81], v[80:81], v[48:49]
v_pk_mul_f32 v[48:49], v[48:49], v[28:29] op_sel_hi:[1,0]
v_pk_mul_f32 v[82:83], v[82:83], v[50:51]
v_pk_mul_f32 v[50:51], v[50:51], v[28:29] op_sel_hi:[1,0]
v_exp_f32 v32, v32
s_nop 0
MAA 36,64,148
TR 24,16,42368
v_exp_f32 v33, v33
MAA 52,68,148
TR 26,16,42880
v_exp_f32 v34, v34
MAA 68,72,148
TR 28,16,42400
v_exp_f32 v35, v35
MAA 84,76,148
TR 30,16,42912
v_exp_f32 v48, v48
MAA 36,80,164
TR 32,16,50816
v_exp_f32 v49, v49
MAA 52,84,164
TR 34,16,51328
v_exp_f32 v50, v50
MAA 68,88,164
TR 36,16,50848
v_exp_f32 v51, v51
MAA 84,92,164
TR 38,16,51360
v_lshrrev_b32 v2, 3, v1
s_waitcnt vmcnt(2)
MAA 36,96,180
TR 40,16,59264
v_cmp_eq_u32 vcc, 3, v2
MAA 52,100,180
TR 42,16,59776
s_mov_b32 s54, 65536
MAA 68,104,180
TR 44,16,59296
s_mul_i32 s55, s3, 2112
MAA 84,108,180
TR 46,16,59808
s_mov_b32 s57, 67584
s_nop 2
v_pk_mul_f32 v[68:69], v[68:69], v[36:37]
v_pk_mul_f32 v[36:37], v[36:37], v[28:29] op_sel:[0,1] op_sel_hi:[1,1]
v_pk_mul_f32 v[70:71], v[70:71], v[38:39]
v_pk_mul_f32 v[38:39], v[38:39], v[28:29] op_sel:[0,1] op_sel_hi:[1,1]
v_pk_mul_f32 v[84:85], v[84:85], v[52:53]
v_pk_mul_f32 v[52:53], v[52:53], v[28:29] op_sel:[0,1] op_sel_hi:[1,1]
v_pk_mul_f32 v[86:87], v[86:87], v[54:55]
v_pk_mul_f32 v[54:55], v[54:55], v[28:29] op_sel:[0,1] op_sel_hi:[1,1]
v_pk_fma_f32 v[32:33], v[32:33], v[20:21], v[20:21] op_sel:[0,1,1] op_sel_hi:[1,1,1]
v_pk_fma_f32 v[34:35], v[34:35], v[20:21], v[20:21] op_sel:[0,1,1] op_sel_hi:[1,1,1]
v_pk_fma_f32 v[48:49], v[48:49], v[20:21], v[20:21] op_sel:[0,1,1] op_sel_hi:[1,1,1]
v_pk_fma_f32 v[50:51], v[50:51], v[20:21], v[20:21] op_sel:[0,1,1] op_sel_hi:[1,1,1]
v_rcp_f32 v32, v32
s_nop 0
MAA 40,64,152
TR 48,17,16896
v_rcp_f32 v33, v33
MAA 56,68,152
TR 50,17,17408
v_rcp_f32 v34, v34
MAA 72,72,152
TR 52,17,16928
v_rcp_f32 v35, v35
MAA 88,76,152
TR 54,17,17440
v_rcp_f32 v48, v48
MAA 40,80,168
TR 56,17,25344
v_rcp_f32 v49, v49
MAA 56,84,168
TR 58,17,25856
v_rcp_f32 v50, v50
MAA 72,88,168
TR 60,17,25376
v_rcp_f32 v51, v51
MAA 88,92,168
TR 62,17,25888
v_exp_f32 v36, v36
s_waitcnt vmcnt(1)
MAA 40,96,184
v_exp_f32 v37, v37
MAA 56,100,184
v_exp_f32 v38, v38
MAA 72,104,184
v_exp_f32 v39, v39
MAA 88,108,184
v_exp_f32 v52, v52
v_exp_f32 v53, v53
v_exp_f32 v54, v54
v_exp_f32 v55, v55
v_pk_mul_f32 v[64:65], v[64:65], v[32:33]
v_pk_mul_f32 v[66:67], v[66:67], v[34:35]
v_pk_mul_f32 v[80:81], v[80:81], v[48:49]
v_pk_mul_f32 v[82:83], v[82:83], v[50:51]
ds_read_b128 v[48:51], v9 offset:128
v_pk_mul_f32 v[72:73], v[72:73], v[40:41]
v_pk_mul_f32 v[40:41], v[40:41], v[30:31] op_sel_hi:[1,0]
v_pk_mul_f32 v[74:75], v[74:75], v[42:43]
v_pk_mul_f32 v[42:43], v[42:43], v[30:31] op_sel_hi:[1,0]
v_pk_mul_f32 v[88:89], v[88:89], v[56:57]
v_pk_mul_f32 v[56:57], v[56:57], v[30:31] op_sel_hi:[1,0]
v_pk_mul_f32 v[90:91], v[90:91], v[58:59]
v_pk_mul_f32 v[58:59], v[58:59], v[30:31] op_sel_hi:[1,0]
v_pk_fma_f32 v[36:37], v[36:37], v[22:23], v[22:23] op_sel:[0,1,1] op_sel_hi:[1,1,1]
v_pk_fma_f32 v[38:39], v[38:39], v[22:23], v[22:23] op_sel:[0,1,1] op_sel_hi:[1,1,1]
v_pk_fma_f32 v[52:53], v[52:53], v[22:23], v[22:23] op_sel:[0,1,1] op_sel_hi:[1,1,1]
v_pk_fma_f32 v[54:55], v[54:55], v[22:23], v[22:23] op_sel:[0,1,1] op_sel_hi:[1,1,1]
v_cvt_pk_bf16_f32 v32, v64, v65
v_cvt_pk_bf16_f32 v33, v66, v67
ds_read_b128 v[64:67], v9 offset:192
v_cvt_pk_bf16_f32 v34, v80, v81
v_cvt_pk_bf16_f32 v35, v82, v83
MAA 44,64,156
buffer_store_dwordx4 v[32:35], v10, s[16:19], s62 offen sc1
MAA 60,68,156
ds_read_b128 v[80:83], v9 offset:640
v_rcp_f32 v36, v36
MAA 76,72,156
TR 64,17,33792
v_rcp_f32 v37, v37
MAA 92,76,156
TR 66,17,34304
v_rcp_f32 v38, v38
MAA 44,80,172
TR 68,17,33824
v_rcp_f32 v39, v39
MAA 60,84,172
TR 70,17,34336
v_rcp_f32 v52, v52
MAA 76,88,172
TR 72,17,42240
v_rcp_f32 v53, v53
MAA 92,92,172
TR 74,17,42752
v_rcp_f32 v54, v54
s_waitcnt vmcnt(1)
MAA 44,96,188
TR 76,17,42272
v_rcp_f32 v55, v55
MAA 60,100,188
TR 78,17,42784
v_exp_f32 v40, v40
MAA 76,104,188
TR 80,17,50688
v_exp_f32 v41, v41
MAA 92,108,188
TR 82,17,51200
v_exp_f32 v42, v42
v_exp_f32 v43, v43
v_exp_f32 v56, v56
v_exp_f32 v57, v57
v_exp_f32 v58, v58
v_exp_f32 v59, v59
v_pk_mul_f32 v[68:69], v[68:69], v[36:37]
v_pk_mul_f32 v[70:71], v[70:71], v[38:39]
v_pk_mul_f32 v[84:85], v[84:85], v[52:53]
v_pk_mul_f32 v[86:87], v[86:87], v[54:55]
ds_read_b128 v[52:55], v8 offset:576
v_pk_mul_f32 v[76:77], v[76:77], v[44:45]
v_pk_mul_f32 v[44:45], v[44:45], v[30:31] op_sel:[0,1] op_sel_hi:[1,1]
v_pk_mul_f32 v[78:79], v[78:79], v[46:47]
v_pk_mul_f32 v[46:47], v[46:47], v[30:31] op_sel:[0,1] op_sel_hi:[1,1]
v_pk_mul_f32 v[92:93], v[92:93], v[60:61]
v_pk_mul_f32 v[60:61], v[60:61], v[30:31] op_sel:[0,1] op_sel_hi:[1,1]
v_pk_mul_f32 v[94:95], v[94:95], v[62:63]
v_pk_mul_f32 v[62:63], v[62:63], v[30:31] op_sel:[0,1] op_sel_hi:[1,1]
v_pk_fma_f32 v[40:41], v[40:41], v[24:25], v[24:25] op_sel:[0,1,1] op_sel_hi:[1,1,1]
v_pk_fma_f32 v[42:43], v[42:43], v[24:25], v[24:25] op_sel:[0,1,1] op_sel_hi:[1,1,1]
v_pk_fma_f32 v[56:57], v[56:57], v[24:25], v[24:25] op_sel:[0,1,1] op_sel_hi:[1,1,1]
v_pk_fma_f32 v[58:59], v[58:59], v[24:25], v[24:25] op_sel:[0,1,1] op_sel_hi:[1,1,1]
v_cvt_pk_bf16_f32 v36, v68, v69
v_cvt_pk_bf16_f32 v37, v70, v71
v_cvt_pk_bf16_f32 v38, v84, v85
v_cvt_pk_bf16_f32 v39, v86, v87
MAA 96,112,144
buffer_store_dwordx4 v[36:39], v10, s[16:19], s62 offen offset:1024 sc1
MAA 112,116,144
TR 84,17,50720
v_rcp_f32 v40, v40
MAA 128,120,144
TR 86,17,51232
v_rcp_f32 v41, v41
MAA 144,124,144
TR 88,17,59136
v_rcp_f32 v42, v42
MAA 96,192,160
TR 90,17,59648
v_rcp_f32 v43, v43
MAA 112,196,160
TR 92,17,59168
v_rcp_f32 v56, v56
MAA 128,200,160
TR 94,17,59680
v_rcp_f32 v57, v57
MAA 144,204,160
v_rcp_f32 v58, v58
MAA 96,208,176
v_rcp_f32 v59, v59
MAA 112,212,176
v_exp_f32 v44, v44
s_waitcnt lgkmcnt(15)
MAA 128,216,176
v_exp_f32 v45, v45
MAA 144,220,176
v_lshrrev_b32 v69, 2, v0
v_min_u32 v69, 1, v69
v_lshlrev_b32 v69, 28, v69
v_lshl_add_u32 v68, v0, 7, v69
v_xor_b32 v69, 64, v0
v_min_u32 v69, 1, v69
v_lshlrev_b32 v70, 4, v69
v_sub_u32 v70, 16, v70
v_lshlrev_b32 v69, 28, v69
v_mov_b32 v71, 1
s_waitcnt lgkmcnt(0)
s_barrier
v_mov_b32 v84, 0
v_exp_f32 v46, v46
v_exp_f32 v47, v47
v_exp_f32 v60, v60
v_exp_f32 v61, v61
v_exp_f32 v62, v62
v_exp_f32 v63, v63
v_pk_mul_f32 v[72:73], v[72:73], v[40:41]
v_pk_mul_f32 v[74:75], v[74:75], v[42:43]
v_pk_mul_f32 v[88:89], v[88:89], v[56:57]
v_pk_mul_f32 v[90:91], v[90:91], v[58:59]
v_pk_fma_f32 v[96:97], v[48:49], v[20:21], v[96:97] op_sel_hi:[1,0,1]
v_pk_fma_f32 v[98:99], v[50:51], v[20:21], v[98:99] op_sel_hi:[1,0,1]
v_pk_fma_f32 v[112:113], v[64:65], v[20:21], v[112:113] op_sel_hi:[1,0,1]
v_pk_fma_f32 v[114:115], v[66:67], v[20:21], v[114:115] op_sel_hi:[1,0,1]
v_pk_fma_f32 v[128:129], v[80:81], v[20:21], v[128:129] op_sel_hi:[1,0,1]
v_pk_fma_f32 v[130:131], v[82:83], v[20:21], v[130:131] op_sel_hi:[1,0,1]
v_pk_fma_f32 v[144:145], v[4:5], v[20:21], v[144:145] op_sel_hi:[1,0,1]
v_pk_fma_f32 v[146:147], v[6:7], v[20:21], v[146:147] op_sel_hi:[1,0,1]
v_pk_mul_f32 v[128:129], v[128:129], v[96:97]
v_pk_mul_f32 v[96:97], v[96:97], v[28:29] op_sel_hi:[1,0]
v_pk_mul_f32 v[130:131], v[130:131], v[98:99]
v_pk_mul_f32 v[98:99], v[98:99], v[28:29] op_sel_hi:[1,0]
v_pk_mul_f32 v[144:145], v[144:145], v[112:113]
v_pk_mul_f32 v[112:113], v[112:113], v[28:29] op_sel_hi:[1,0]
v_pk_mul_f32 v[146:147], v[146:147], v[114:115]
v_pk_mul_f32 v[114:115], v[114:115], v[28:29] op_sel_hi:[1,0]
v_pk_fma_f32 v[44:45], v[44:45], v[26:27], v[26:27] op_sel:[0,1,1] op_sel_hi:[1,1,1]
v_pk_fma_f32 v[46:47], v[46:47], v[26:27], v[26:27] op_sel:[0,1,1] op_sel_hi:[1,1,1]
v_pk_fma_f32 v[60:61], v[60:61], v[26:27], v[26:27] op_sel:[0,1,1] op_sel_hi:[1,1,1]
v_pk_fma_f32 v[62:63], v[62:63], v[26:27], v[26:27] op_sel:[0,1,1] op_sel_hi:[1,1,1]
v_cvt_pk_bf16_f32 v40, v72, v73
v_cvt_pk_bf16_f32 v41, v74, v75
v_cvt_pk_bf16_f32 v42, v88, v89
v_cvt_pk_bf16_f32 v43, v90, v91
MAA 100,112,148
buffer_store_dwordx4 v[40:43], v11, s[16:19], s62 offen sc1
MAA 116,116,148
s_add_u32 m0, s59, 84480
v_rcp_f32 v44, v44
MAA 132,120,148
v_rcp_f32 v45, v45
MAA 148,124,148
v_rcp_f32 v46, v46
MAA 100,192,164
buffer_load_dwordx4 v18, s[28:31], s58 offen lds
MAA 116,196,164
v_rcp_f32 v47, v47
MAA 132,200,164
v_rcp_f32 v60, v60
MAA 148,204,164
v_rcp_f32 v61, v61
MAA 100,208,180
buffer_load_dwordx4 v19, s[28:31], s58 offen offset:1056 lds
MAA 116,212,180
s_add_u32 m0, s59, 92928
s_mov_b32 s58, 2555904
v_rcp_f32 v62, v62
MAA 132,216,180
v_rcp_f32 v63, v63
MAA 148,220,180
v_exp_f32 v96, v96
v_exp_f32 v97, v97
v_exp_f32 v98, v98
v_exp_f32 v99, v99
v_exp_f32 v112, v112
v_exp_f32 v113, v113
v_exp_f32 v114, v114
v_exp_f32 v115, v115
v_pk_mul_f32 v[76:77], v[76:77], v[44:45]
.Lpad23:
s_cbranch_execz .Lnopoll63r
v_pk_mul_f32 v[78:79], v[78:79], v[46:47]
v_pk_mul_f32 v[92:93], v[92:93], v[60:61]
v_pk_mul_f32 v[94:95], v[94:95], v[62:63]
v_pk_fma_f32 v[100:101], v[48:49], v[22:23], v[100:101] op_sel_hi:[1,0,1]
v_pk_fma_f32 v[102:103], v[50:51], v[22:23], v[102:103] op_sel_hi:[1,0,1]
v_pk_fma_f32 v[116:117], v[64:65], v[22:23], v[116:117] op_sel_hi:[1,0,1]
v_pk_fma_f32 v[118:119], v[66:67], v[22:23], v[118:119] op_sel_hi:[1,0,1]
v_pk_fma_f32 v[132:133], v[80:81], v[22:23], v[132:133] op_sel_hi:[1,0,1]
v_pk_fma_f32 v[134:135], v[82:83], v[22:23], v[134:135] op_sel_hi:[1,0,1]
v_pk_fma_f32 v[148:149], v[4:5], v[22:23], v[148:149] op_sel_hi:[1,0,1]
v_pk_fma_f32 v[150:151], v[6:7], v[22:23], v[150:151] op_sel_hi:[1,0,1]
v_pk_mul_f32 v[132:133], v[132:133], v[100:101]
v_pk_mul_f32 v[100:101], v[100:101], v[28:29] op_sel:[0,1] op_sel_hi:[1,1]
v_pk_mul_f32 v[134:135], v[134:135], v[102:103]
v_pk_mul_f32 v[102:103], v[102:103], v[28:29] op_sel:[0,1] op_sel_hi:[1,1]
v_pk_mul_f32 v[148:149], v[148:149], v[116:117]
v_pk_mul_f32 v[116:117], v[116:117], v[28:29] op_sel:[0,1] op_sel_hi:[1,1]
v_pk_mul_f32 v[150:151], v[150:151], v[118:119]
v_pk_mul_f32 v[118:119], v[118:119], v[28:29] op_sel:[0,1] op_sel_hi:[1,1]
v_pk_fma_f32 v[96:97], v[96:97], v[20:21], v[20:21] op_sel:[0,1,1] op_sel_hi:[1,1,1]
v_pk_fma_f32 v[98:99], v[98:99], v[20:21], v[20:21] op_sel:[0,1,1] op_sel_hi:[1,1,1]
v_pk_fma_f32 v[112:113], v[112:113], v[20:21], v[20:21] op_sel:[0,1,1] op_sel_hi:[1,1,1]
v_pk_fma_f32 v[114:115], v[114:115], v[20:21], v[20:21] op_sel:[0,1,1] op_sel_hi:[1,1,1]
v_cvt_pk_bf16_f32 v44, v76, v77
v_cvt_pk_bf16_f32 v45, v78, v79
v_cvt_pk_bf16_f32 v46, v92, v93
v_cvt_pk_bf16_f32 v47, v94, v95
MAA 104,112,152
buffer_store_dwordx4 v[44:47], v11, s[16:19], s62 offen offset:1024 sc1
MAA 120,116,152
v_rcp_f32 v96, v96
MAA 136,120,152
v_rcp_f32 v97, v97
MAA 152,124,152
v_rcp_f32 v98, v98
MAA 104,192,168
buffer_load_dwordx4 v18, s[28:31], s58 offen lds
MAA 120,196,168
v_rcp_f32 v99, v99
MAA 136,200,168
v_rcp_f32 v112, v112
MAA 152,204,168
v_rcp_f32 v113, v113
MAA 104,208,184
buffer_load_dwordx4 v19, s[28:31], s58 offen offset:1056 lds
MAA 120,212,184
s_add_u32 m0, s59, 101376
s_mov_b32 s58, 2752512
v_rcp_f32 v114, v114
MAA 136,216,184
v_rcp_f32 v115, v115
MAA 152,220,184
v_exp_f32 v100, v100
v_exp_f32 v101, v101
v_exp_f32 v102, v102
v_exp_f32 v103, v103
v_exp_f32 v116, v116
v_exp_f32 v117, v117
v_exp_f32 v118, v118
v_exp_f32 v119, v119
v_pk_mul_f32 v[128:129], v[128:129], v[96:97]
v_pk_mul_f32 v[130:131], v[130:131], v[98:99]
v_pk_mul_f32 v[144:145], v[144:145], v[112:113]
v_pk_mul_f32 v[146:147], v[146:147], v[114:115]
ds_read_b128 v[112:115], v9 offset:256
v_pk_fma_f32 v[104:105], v[48:49], v[24:25], v[104:105] op_sel_hi:[1,0,1]
v_pk_fma_f32 v[106:107], v[50:51], v[24:25], v[106:107] op_sel_hi:[1,0,1]
v_pk_fma_f32 v[120:121], v[64:65], v[24:25], v[120:121] op_sel_hi:[1,0,1]
v_pk_fma_f32 v[122:123], v[66:67], v[24:25], v[122:123] op_sel_hi:[1,0,1]
v_pk_fma_f32 v[136:137], v[80:81], v[24:25], v[136:137] op_sel_hi:[1,0,1]
v_pk_fma_f32 v[138:139], v[82:83], v[24:25], v[138:139] op_sel_hi:[1,0,1]
v_pk_fma_f32 v[152:153], v[4:5], v[24:25], v[152:153] op_sel_hi:[1,0,1]
v_pk_fma_f32 v[154:155], v[6:7], v[24:25], v[154:155] op_sel_hi:[1,0,1]
v_pk_mul_f32 v[136:137], v[136:137], v[104:105]
v_pk_mul_f32 v[104:105], v[104:105], v[30:31] op_sel_hi:[1,0]
v_pk_mul_f32 v[138:139], v[138:139], v[106:107]
v_pk_mul_f32 v[106:107], v[106:107], v[30:31] op_sel_hi:[1,0]
v_pk_mul_f32 v[152:153], v[152:153], v[120:121]
v_pk_mul_f32 v[120:121], v[120:121], v[30:31] op_sel_hi:[1,0]
v_pk_mul_f32 v[154:155], v[154:155], v[122:123]
v_pk_mul_f32 v[122:123], v[122:123], v[30:31] op_sel_hi:[1,0]
v_pk_fma_f32 v[100:101], v[100:101], v[22:23], v[22:23] op_sel:[0,1,1] op_sel_hi:[1,1,1]
v_pk_fma_f32 v[102:103], v[102:103], v[22:23], v[22:23] op_sel:[0,1,1] op_sel_hi:[1,1,1]
v_pk_fma_f32 v[116:117], v[116:117], v[22:23], v[22:23] op_sel:[0,1,1] op_sel_hi:[1,1,1]
v_pk_fma_f32 v[118:119], v[118:119], v[22:23], v[22:23] op_sel:[0,1,1] op_sel_hi:[1,1,1]
v_cvt_pk_bf16_f32 v96, v128, v129
v_cvt_pk_bf16_f32 v97, v130, v131
ds_read_b128 v[128:131], v9 offset:320
v_cvt_pk_bf16_f32 v98, v144, v145
v_cvt_pk_bf16_f32 v99, v146, v147
MAA 108,112,156
buffer_store_dwordx4 v[96:99], v10, s[16:19], s63 offen sc1
MAA 124,116,156
ds_read_b128 v[144:147], v9 offset:768
v_rcp_f32 v100, v100
MAA 140,120,156
v_rcp_f32 v101, v101
MAA 156,124,156
v_rcp_f32 v102, v102
MAA 108,192,172
buffer_load_dwordx4 v18, s[28:31], s58 offen lds
MAA 124,196,172
v_rcp_f32 v103, v103
MAA 140,200,172
v_rcp_f32 v116, v116
MAA 156,204,172
v_rcp_f32 v117, v117
MAA 108,208,188
buffer_load_dwordx4 v19, s[28:31], s58 offen offset:1056 lds
MAA 124,212,188
s_add_u32 m0, s59, 109824
s_mov_b32 s58, 3014656
v_rcp_f32 v118, v118
MAA 140,216,188
v_rcp_f32 v119, v119
MAA 156,220,188
v_exp_f32 v104, v104
v_exp_f32 v105, v105
v_exp_f32 v106, v106
v_exp_f32 v107, v107
v_exp_f32 v120, v120
v_exp_f32 v121, v121
v_exp_f32 v122, v122
v_exp_f32 v123, v123
v_pk_mul_f32 v[132:133], v[132:133], v[100:101]
v_pk_mul_f32 v[134:135], v[134:135], v[102:103]
v_pk_mul_f32 v[148:149], v[148:149], v[116:117]
v_pk_mul_f32 v[150:151], v[150:151], v[118:119]
v_pk_fma_f32 v[108:109], v[48:49], v[26:27], v[108:109] op_sel_hi:[1,0,1]
v_pk_fma_f32 v[110:111], v[50:51], v[26:27], v[110:111] op_sel_hi:[1,0,1]
v_pk_fma_f32 v[124:125], v[64:65], v[26:27], v[124:125] op_sel_hi:[1,0,1]
v_pk_fma_f32 v[126:127], v[66:67], v[26:27], v[126:127] op_sel_hi:[1,0,1]
v_pk_fma_f32 v[140:141], v[80:81], v[26:27], v[140:141] op_sel_hi:[1,0,1]
v_pk_fma_f32 v[142:143], v[82:83], v[26:27], v[142:143] op_sel_hi:[1,0,1]
v_pk_fma_f32 v[156:157], v[4:5], v[26:27], v[156:157] op_sel_hi:[1,0,1]
v_pk_fma_f32 v[158:159], v[6:7], v[26:27], v[158:159] op_sel_hi:[1,0,1]
v_pk_mul_f32 v[140:141], v[140:141], v[108:109]
v_pk_mul_f32 v[108:109], v[108:109], v[30:31] op_sel:[0,1] op_sel_hi:[1,1]
v_pk_mul_f32 v[142:143], v[142:143], v[110:111]
v_pk_mul_f32 v[110:111], v[110:111], v[30:31] op_sel:[0,1] op_sel_hi:[1,1]
v_pk_mul_f32 v[156:157], v[156:157], v[124:125]
v_pk_mul_f32 v[124:125], v[124:125], v[30:31] op_sel:[0,1] op_sel_hi:[1,1]
v_pk_mul_f32 v[158:159], v[158:159], v[126:127]
v_pk_mul_f32 v[126:127], v[126:127], v[30:31] op_sel:[0,1] op_sel_hi:[1,1]
v_pk_fma_f32 v[104:105], v[104:105], v[24:25], v[24:25] op_sel:[0,1,1] op_sel_hi:[1,1,1]
v_pk_fma_f32 v[106:107], v[106:107], v[24:25], v[24:25] op_sel:[0,1,1] op_sel_hi:[1,1,1]
v_pk_fma_f32 v[120:121], v[120:121], v[24:25], v[24:25] op_sel:[0,1,1] op_sel_hi:[1,1,1]
v_pk_fma_f32 v[122:123], v[122:123], v[24:25], v[24:25] op_sel:[0,1,1] op_sel_hi:[1,1,1]
v_cvt_pk_bf16_f32 v100, v132, v133
v_cvt_pk_bf16_f32 v101, v134, v135
v_cvt_pk_bf16_f32 v102, v148, v149
v_cvt_pk_bf16_f32 v103, v150, v151
MAA 160,0,144
buffer_store_dwordx4 v[100:103], v10, s[16:19], s63 offen offset:1024 sc1
MAA 176,4,144
v_rcp_f32 v104, v104
MAA 192,8,144
v_rcp_f32 v105, v105
MAA 208,12,144
v_rcp_f32 v106, v106
MAA 160,16,160
buffer_load_dwordx4 v18, s[28:31], s58 offen lds
MAA 176,20,160
v_rcp_f32 v107, v107
MAA 192,24,160
v_rcp_f32 v120, v120
MAA 208,28,160
v_rcp_f32 v121, v121
MAA 160,32,176
buffer_load_dwordx4 v19, s[28:31], s58 offen offset:1056 lds
MAA 176,36,176
s_add_u32 m0, s59, 118272
s_mov_b32 s58, 3211264
s_waitcnt vmcnt(8)
s_barrier
MAA 192,40,176
v_rcp_f32 v122, v122
MAA 208,44,176
v_rcp_f32 v123, v123
v_exp_f32 v108, v108
v_exp_f32 v109, v109
v_exp_f32 v110, v110
v_exp_f32 v111, v111
v_exp_f32 v124, v124
v_exp_f32 v125, v125
v_exp_f32 v126, v126
v_exp_f32 v127, v127
v_pk_mul_f32 v[136:137], v[136:137], v[104:105]
buffer_atomic_add v71, v68, s[16:19], s72 offen offset:512
v_pk_mul_f32 v[138:139], v[138:139], v[106:107]
v_pk_mul_f32 v[152:153], v[152:153], v[120:121]
v_pk_mul_f32 v[154:155], v[154:155], v[122:123]
s_waitcnt lgkmcnt(2)
v_pk_fma_f32 v[160:161], v[112:113], v[20:21], v[160:161] op_sel_hi:[1,0,1]
v_pk_fma_f32 v[162:163], v[114:115], v[20:21], v[162:163] op_sel_hi:[1,0,1]
s_waitcnt lgkmcnt(1)
v_pk_fma_f32 v[176:177], v[128:129], v[20:21], v[176:177] op_sel_hi:[1,0,1]
v_pk_fma_f32 v[178:179], v[130:131], v[20:21], v[178:179] op_sel_hi:[1,0,1]
s_waitcnt lgkmcnt(0)
v_pk_fma_f32 v[192:193], v[144:145], v[20:21], v[192:193] op_sel_hi:[1,0,1]
v_pk_fma_f32 v[194:195], v[146:147], v[20:21], v[194:195] op_sel_hi:[1,0,1]
v_pk_fma_f32 v[208:209], v[12:13], v[20:21], v[208:209] op_sel_hi:[1,0,1]
v_pk_fma_f32 v[210:211], v[14:15], v[20:21], v[210:211] op_sel_hi:[1,0,1]
v_pk_mul_f32 v[192:193], v[192:193], v[160:161]
v_pk_mul_f32 v[160:161], v[160:161], v[28:29] op_sel_hi:[1,0]
v_pk_mul_f32 v[194:195], v[194:195], v[162:163]
v_pk_mul_f32 v[162:163], v[162:163], v[28:29] op_sel_hi:[1,0]
v_pk_mul_f32 v[208:209], v[208:209], v[176:177]
v_pk_mul_f32 v[176:177], v[176:177], v[28:29] op_sel_hi:[1,0]
v_pk_mul_f32 v[210:211], v[210:211], v[178:179]
v_pk_mul_f32 v[178:179], v[178:179], v[28:29] op_sel_hi:[1,0]
v_pk_fma_f32 v[108:109], v[108:109], v[26:27], v[26:27] op_sel:[0,1,1] op_sel_hi:[1,1,1]
v_pk_fma_f32 v[110:111], v[110:111], v[26:27], v[26:27] op_sel:[0,1,1] op_sel_hi:[1,1,1]
v_pk_fma_f32 v[124:125], v[124:125], v[26:27], v[26:27] op_sel:[0,1,1] op_sel_hi:[1,1,1]
v_pk_fma_f32 v[126:127], v[126:127], v[26:27], v[26:27] op_sel:[0,1,1] op_sel_hi:[1,1,1]
v_cvt_pk_bf16_f32 v104, v136, v137
v_cvt_pk_bf16_f32 v105, v138, v139
v_cvt_pk_bf16_f32 v106, v152, v153
v_cvt_pk_bf16_f32 v107, v154, v155
MAA 164,0,148
buffer_store_dwordx4 v[104:107], v11, s[16:19], s63 offen sc1
MAA 180,4,148
v_rcp_f32 v108, v108
MAA 196,8,148
v_rcp_f32 v109, v109
MAA 212,12,148
v_rcp_f32 v110, v110
MAA 164,16,164
buffer_load_dwordx4 v18, s[28:31], s58 offen lds
MAA 180,20,164
v_rcp_f32 v111, v111
MAA 196,24,164
v_rcp_f32 v124, v124
MAA 212,28,164
v_rcp_f32 v125, v125
MAA 164,32,180
buffer_load_dwordx4 v19, s[28:31], s58 offen offset:1056 lds
MAA 180,36,180
s_add_u32 m0, s59, 126720
s_mov_b32 s58, 3473408
v_rcp_f32 v126, v126
MAA 196,40,180
v_rcp_f32 v127, v127
MAA 212,44,180
v_lshl_add_u32 v4, v1, 4, s74
v_add_u32 v2, 67108480, v4
v_cndmask_b32 v4, v4, v2, vcc
s_and_b32 s74, s7, 1
s_mul_i32 s53, s74, 7340032
s_add_u32 s53, s53, 46137344
v_bfe_u32 v7, v1, 2, 3
v_mul_u32_u24 v7, 1056, v7
v_bfe_u32 v2, v1, 5, 1
v_lshl_add_u32 v7, v2, 8, v7
v_and_b32 v2, 3, v1
v_lshl_add_u32 v7, v2, 3, v7
s_lshl_b32 s74, s74, 7
s_xor_b32 s75, s74, 128
v_add_u32 v6, s75, v7
v_add_u32 v7, s74, v7
v_exp_f32 v160, v160
v_exp_f32 v161, v161
v_exp_f32 v162, v162
v_exp_f32 v163, v163
v_exp_f32 v176, v176
v_exp_f32 v177, v177
v_exp_f32 v178, v178
v_exp_f32 v179, v179
v_pk_mul_f32 v[140:141], v[140:141], v[108:109]
v_pk_mul_f32 v[142:143], v[142:143], v[110:111]
v_pk_mul_f32 v[156:157], v[156:157], v[124:125]
v_pk_mul_f32 v[158:159], v[158:159], v[126:127]
v_pk_fma_f32 v[164:165], v[112:113], v[22:23], v[164:165] op_sel_hi:[1,0,1]
v_pk_fma_f32 v[166:167], v[114:115], v[22:23], v[166:167] op_sel_hi:[1,0,1]
v_pk_fma_f32 v[180:181], v[128:129], v[22:23], v[180:181] op_sel_hi:[1,0,1]
v_pk_fma_f32 v[182:183], v[130:131], v[22:23], v[182:183] op_sel_hi:[1,0,1]
v_pk_fma_f32 v[196:197], v[144:145], v[22:23], v[196:197] op_sel_hi:[1,0,1]
v_pk_fma_f32 v[198:199], v[146:147], v[22:23], v[198:199] op_sel_hi:[1,0,1]
v_pk_fma_f32 v[212:213], v[12:13], v[22:23], v[212:213] op_sel_hi:[1,0,1]
v_pk_fma_f32 v[214:215], v[14:15], v[22:23], v[214:215] op_sel_hi:[1,0,1]
v_pk_mul_f32 v[196:197], v[196:197], v[164:165]
v_pk_mul_f32 v[164:165], v[164:165], v[28:29] op_sel:[0,1] op_sel_hi:[1,1]
v_pk_mul_f32 v[198:199], v[198:199], v[166:167]
v_pk_mul_f32 v[166:167], v[166:167], v[28:29] op_sel:[0,1] op_sel_hi:[1,1]
v_pk_mul_f32 v[212:213], v[212:213], v[180:181]
v_pk_mul_f32 v[180:181], v[180:181], v[28:29] op_sel:[0,1] op_sel_hi:[1,1]
v_pk_mul_f32 v[214:215], v[214:215], v[182:183]
v_pk_mul_f32 v[182:183], v[182:183], v[28:29] op_sel:[0,1] op_sel_hi:[1,1]
v_pk_fma_f32 v[160:161], v[160:161], v[20:21], v[20:21] op_sel:[0,1,1] op_sel_hi:[1,1,1]
v_pk_fma_f32 v[162:163], v[162:163], v[20:21], v[20:21] op_sel:[0,1,1] op_sel_hi:[1,1,1]
v_pk_fma_f32 v[176:177], v[176:177], v[20:21], v[20:21] op_sel:[0,1,1] op_sel_hi:[1,1,1]
v_pk_fma_f32 v[178:179], v[178:179], v[20:21], v[20:21] op_sel:[0,1,1] op_sel_hi:[1,1,1]
v_cvt_pk_bf16_f32 v108, v140, v141
v_cvt_pk_bf16_f32 v109, v142, v143
v_cvt_pk_bf16_f32 v110, v156, v157
v_cvt_pk_bf16_f32 v111, v158, v159
MAA 168,0,152
buffer_store_dwordx4 v[108:111], v11, s[16:19], s63 offen offset:1024 sc1
MAA 184,4,152
v_rcp_f32 v160, v160
MAA 200,8,152
v_rcp_f32 v161, v161
MAA 216,12,152
v_rcp_f32 v162, v162
MAA 168,16,168
buffer_load_dwordx4 v18, s[28:31], s58 offen lds
MAA 184,20,168
v_rcp_f32 v163, v163
MAA 200,24,168
v_rcp_f32 v176, v176
MAA 216,28,168
v_rcp_f32 v177, v177
MAA 168,32,184
buffer_load_dwordx4 v19, s[28:31], s58 offen offset:1056 lds
MAA 184,36,184
v_rcp_f32 v178, v178
MAA 200,40,184
v_rcp_f32 v179, v179
MAA 216,44,184
v_exp_f32 v164, v164
v_exp_f32 v165, v165
v_exp_f32 v166, v166
v_exp_f32 v167, v167
v_exp_f32 v180, v180
v_exp_f32 v181, v181
v_exp_f32 v182, v182
v_exp_f32 v183, v183
v_pk_mul_f32 v[192:193], v[192:193], v[160:161]
v_pk_mul_f32 v[194:195], v[194:195], v[162:163]
v_pk_mul_f32 v[208:209], v[208:209], v[176:177]
v_pk_mul_f32 v[210:211], v[210:211], v[178:179]
ds_read_b128 v[176:179], v8
v_pk_fma_f32 v[168:169], v[112:113], v[24:25], v[168:169] op_sel_hi:[1,0,1]
v_pk_fma_f32 v[170:171], v[114:115], v[24:25], v[170:171] op_sel_hi:[1,0,1]
v_pk_fma_f32 v[184:185], v[128:129], v[24:25], v[184:185] op_sel_hi:[1,0,1]
v_pk_fma_f32 v[186:187], v[130:131], v[24:25], v[186:187] op_sel_hi:[1,0,1]
v_pk_fma_f32 v[200:201], v[144:145], v[24:25], v[200:201] op_sel_hi:[1,0,1]
v_pk_fma_f32 v[202:203], v[146:147], v[24:25], v[202:203] op_sel_hi:[1,0,1]
v_pk_fma_f32 v[216:217], v[12:13], v[24:25], v[216:217] op_sel_hi:[1,0,1]
v_pk_fma_f32 v[218:219], v[14:15], v[24:25], v[218:219] op_sel_hi:[1,0,1]
v_pk_mul_f32 v[200:201], v[200:201], v[168:169]
v_pk_mul_f32 v[168:169], v[168:169], v[30:31] op_sel_hi:[1,0]
v_pk_mul_f32 v[202:203], v[202:203], v[170:171]
v_pk_mul_f32 v[170:171], v[170:171], v[30:31] op_sel_hi:[1,0]
v_pk_mul_f32 v[216:217], v[216:217], v[184:185]
v_pk_mul_f32 v[184:185], v[184:185], v[30:31] op_sel_hi:[1,0]
v_pk_mul_f32 v[218:219], v[218:219], v[186:187]
v_pk_mul_f32 v[186:187], v[186:187], v[30:31] op_sel_hi:[1,0]
v_pk_fma_f32 v[164:165], v[164:165], v[22:23], v[22:23] op_sel:[0,1,1] op_sel_hi:[1,1,1]
v_pk_fma_f32 v[166:167], v[166:167], v[22:23], v[22:23] op_sel:[0,1,1] op_sel_hi:[1,1,1]
v_pk_fma_f32 v[180:181], v[180:181], v[22:23], v[22:23] op_sel:[0,1,1] op_sel_hi:[1,1,1]
v_pk_fma_f32 v[182:183], v[182:183], v[22:23], v[22:23] op_sel:[0,1,1] op_sel_hi:[1,1,1]
v_cvt_pk_bf16_f32 v160, v192, v193
v_cvt_pk_bf16_f32 v161, v194, v195
ds_read_b128 v[192:195], v8 offset:64
v_cvt_pk_bf16_f32 v162, v208, v209
v_cvt_pk_bf16_f32 v163, v210, v211
MAA 172,0,156
buffer_store_dwordx4 v[160:163], v10, s[16:19], s64 offen sc1
MAA 188,4,156
ds_read_b128 v[208:211], v8 offset:512
v_rcp_f32 v164, v164
MAA 204,8,156
v_rcp_f32 v165, v165
MAA 220,12,156
v_rcp_f32 v166, v166
MAA 172,16,172
buffer_atomic_add v84, v69, s[16:19], s73 offen offset:512 sc0
MAA 188,20,172
v_rcp_f32 v167, v167
MAA 204,24,172
v_rcp_f32 v180, v180
MAA 220,28,172
v_rcp_f32 v181, v181
MAA 172,32,188
v_rcp_f32 v182, v182
MAA 188,36,188
v_rcp_f32 v183, v183
MAA 204,40,188
v_exp_f32 v168, v168
MAA 220,44,188
v_exp_f32 v169, v169
v_exp_f32 v170, v170
v_exp_f32 v171, v171
v_exp_f32 v184, v184
v_exp_f32 v185, v185
v_exp_f32 v186, v186
v_exp_f32 v187, v187
v_pk_mul_f32 v[196:197], v[196:197], v[164:165]
v_pk_mul_f32 v[198:199], v[198:199], v[166:167]
v_pk_mul_f32 v[212:213], v[212:213], v[180:181]
v_pk_mul_f32 v[214:215], v[214:215], v[182:183]
v_pk_fma_f32 v[172:173], v[112:113], v[26:27], v[172:173] op_sel_hi:[1,0,1]
v_pk_fma_f32 v[174:175], v[114:115], v[26:27], v[174:175] op_sel_hi:[1,0,1]
v_pk_fma_f32 v[188:189], v[128:129], v[26:27], v[188:189] op_sel_hi:[1,0,1]
v_pk_fma_f32 v[190:191], v[130:131], v[26:27], v[190:191] op_sel_hi:[1,0,1]
v_pk_fma_f32 v[204:205], v[144:145], v[26:27], v[204:205] op_sel_hi:[1,0,1]
v_pk_fma_f32 v[206:207], v[146:147], v[26:27], v[206:207] op_sel_hi:[1,0,1]
v_pk_fma_f32 v[220:221], v[12:13], v[26:27], v[220:221] op_sel_hi:[1,0,1]
v_pk_fma_f32 v[222:223], v[14:15], v[26:27], v[222:223] op_sel_hi:[1,0,1]
v_pk_mul_f32 v[204:205], v[204:205], v[172:173]
v_pk_mul_f32 v[172:173], v[172:173], v[30:31] op_sel:[0,1] op_sel_hi:[1,1]
v_pk_mul_f32 v[206:207], v[206:207], v[174:175]
v_pk_mul_f32 v[174:175], v[174:175], v[30:31] op_sel:[0,1] op_sel_hi:[1,1]
v_pk_mul_f32 v[220:221], v[220:221], v[188:189]
v_pk_mul_f32 v[188:189], v[188:189], v[30:31] op_sel:[0,1] op_sel_hi:[1,1]
v_pk_mul_f32 v[222:223], v[222:223], v[190:191]
v_pk_mul_f32 v[190:191], v[190:191], v[30:31] op_sel:[0,1] op_sel_hi:[1,1]
v_pk_fma_f32 v[168:169], v[168:169], v[24:25], v[24:25] op_sel:[0,1,1] op_sel_hi:[1,1,1]
v_pk_fma_f32 v[170:171], v[170:171], v[24:25], v[24:25] op_sel:[0,1,1] op_sel_hi:[1,1,1]
v_pk_fma_f32 v[184:185], v[184:185], v[24:25], v[24:25] op_sel:[0,1,1] op_sel_hi:[1,1,1]
v_pk_fma_f32 v[186:187], v[186:187], v[24:25], v[24:25] op_sel:[0,1,1] op_sel_hi:[1,1,1]
v_cvt_pk_bf16_f32 v164, v196, v197
v_cvt_pk_bf16_f32 v165, v198, v199
v_cvt_pk_bf16_f32 v166, v212, v213
v_cvt_pk_bf16_f32 v167, v214, v215
MAA 224,48,144
buffer_store_dwordx4 v[164:167], v10, s[16:19], s64 offen offset:1024 sc1
MAA 232,52,144
v_rcp_f32 v168, v168
MAA 240,56,144
v_rcp_f32 v169, v169
MAA 248,60,144
v_rcp_f32 v170, v170
MAA 224,64,160
v_rcp_f32 v171, v171
MAA 232,68,160
v_rcp_f32 v184, v184
MAA 240,72,160
v_rcp_f32 v185, v185
MAA 248,76,160
v_rcp_f32 v186, v186
MAA 224,80,176
v_rcp_f32 v187, v187
MAA 232,84,176
v_exp_f32 v172, v172
MAA 240,88,176
v_exp_f32 v173, v173
MAA 248,92,176
v_exp_f32 v174, v174
v_exp_f32 v175, v175
v_exp_f32 v188, v188
v_exp_f32 v189, v189
v_exp_f32 v190, v190
v_exp_f32 v191, v191
v_pk_mul_f32 v[200:201], v[200:201], v[168:169]
v_pk_mul_f32 v[202:203], v[202:203], v[170:171]
v_pk_mul_f32 v[216:217], v[216:217], v[184:185]
v_pk_mul_f32 v[218:219], v[218:219], v[186:187]
s_waitcnt lgkmcnt(2)
v_pk_fma_f32 v[224:225], v[176:177], v[20:21], v[224:225] op_sel_hi:[1,0,1]
v_pk_fma_f32 v[226:227], v[178:179], v[20:21], v[226:227] op_sel_hi:[1,0,1]
s_waitcnt lgkmcnt(1)
v_pk_fma_f32 v[232:233], v[192:193], v[20:21], v[232:233] op_sel_hi:[1,0,1]
v_pk_fma_f32 v[234:235], v[194:195], v[20:21], v[234:235] op_sel_hi:[1,0,1]
s_waitcnt lgkmcnt(0)
v_pk_fma_f32 v[240:241], v[208:209], v[20:21], v[240:241] op_sel_hi:[1,0,1]
v_pk_fma_f32 v[242:243], v[210:211], v[20:21], v[242:243] op_sel_hi:[1,0,1]
v_pk_fma_f32 v[248:249], v[52:53], v[20:21], v[248:249] op_sel_hi:[1,0,1]
v_pk_fma_f32 v[250:251], v[54:55], v[20:21], v[250:251] op_sel_hi:[1,0,1]
v_pk_mul_f32 v[240:241], v[240:241], v[224:225]
v_pk_mul_f32 v[224:225], v[224:225], v[28:29] op_sel_hi:[1,0]
v_pk_mul_f32 v[242:243], v[242:243], v[226:227]
v_pk_mul_f32 v[226:227], v[226:227], v[28:29] op_sel_hi:[1,0]
v_pk_mul_f32 v[248:249], v[248:249], v[232:233]
v_pk_mul_f32 v[232:233], v[232:233], v[28:29] op_sel_hi:[1,0]
v_pk_mul_f32 v[250:251], v[250:251], v[234:235]
v_pk_mul_f32 v[234:235], v[234:235], v[28:29] op_sel_hi:[1,0]
v_pk_fma_f32 v[172:173], v[172:173], v[26:27], v[26:27] op_sel:[0,1,1] op_sel_hi:[1,1,1]
v_pk_fma_f32 v[174:175], v[174:175], v[26:27], v[26:27] op_sel:[0,1,1] op_sel_hi:[1,1,1]
v_pk_fma_f32 v[188:189], v[188:189], v[26:27], v[26:27] op_sel:[0,1,1] op_sel_hi:[1,1,1]
v_pk_fma_f32 v[190:191], v[190:191], v[26:27], v[26:27] op_sel:[0,1,1] op_sel_hi:[1,1,1]
v_cvt_pk_bf16_f32 v168, v200, v201
v_cvt_pk_bf16_f32 v169, v202, v203
v_cvt_pk_bf16_f32 v170, v216, v217
v_cvt_pk_bf16_f32 v171, v218, v219
buffer_store_dwordx4 v[168:171], v11, s[16:19], s64 offen sc1
s_waitcnt vmcnt(2)
v_cmp_gt_u32 vcc, v70, v84
s_nop 0
s_cbranch_vccnz .Lsp71
.Lsp71b:
s_barrier
MAA 228,48,148
s_add_u32 s52, s53, 0
v_rcp_f32 v172, v172
MAA 236,52,148
buffer_load_dwordx4 v[96:99], v4, s[16:19], s52 offen sc1
MAA 244,56,148
ds_read_b64_tr_b16 a[0:1], v7
v_rcp_f32 v173, v173
MAA 252,60,148
TR 2,7,512
v_rcp_f32 v174, v174
MAA 228,64,164
TR 4,7,32
v_rcp_f32 v175, v175
MAA 236,68,164
buffer_load_dwordx4 v[100:103], v4, s[16:19], s52 offen offset:1024 sc1
MAA 244,72,164
s_add_u32 s52, s53, 524288
v_rcp_f32 v188, v188
MAA 252,76,164
TR 6,7,544
v_rcp_f32 v189, v189
MAA 228,80,180
TR 8,7,64
v_rcp_f32 v190, v190
MAA 236,84,180
buffer_load_dwordx4 v[104:107], v4, s[16:19], s52 offen sc1
MAA 244,88,180
TR 10,7,576
v_rcp_f32 v191, v191
MAA 252,92,180
TR 12,7,96
v_exp_f32 v224, v224
v_exp_f32 v225, v225
v_exp_f32 v226, v226
v_exp_f32 v227, v227
v_exp_f32 v232, v232
v_exp_f32 v233, v233
v_exp_f32 v234, v234
v_exp_f32 v235, v235
v_pk_mul_f32 v[204:205], v[204:205], v[172:173]
buffer_load_dwordx4 v[108:111], v4, s[16:19], s52 offen offset:1024 sc1
s_add_u32 s52, s53, 917504
v_pk_mul_f32 v[206:207], v[206:207], v[174:175]
v_pk_mul_f32 v[220:221], v[220:221], v[188:189]
v_pk_mul_f32 v[222:223], v[222:223], v[190:191]
v_pk_fma_f32 v[228:229], v[176:177], v[22:23], v[228:229] op_sel_hi:[1,0,1]
v_pk_fma_f32 v[230:231], v[178:179], v[22:23], v[230:231] op_sel_hi:[1,0,1]
v_pk_fma_f32 v[236:237], v[192:193], v[22:23], v[236:237] op_sel_hi:[1,0,1]
v_pk_fma_f32 v[238:239], v[194:195], v[22:23], v[238:239] op_sel_hi:[1,0,1]
v_pk_fma_f32 v[244:245], v[208:209], v[22:23], v[244:245] op_sel_hi:[1,0,1]
v_pk_fma_f32 v[246:247], v[210:211], v[22:23], v[246:247] op_sel_hi:[1,0,1]
v_pk_fma_f32 v[252:253], v[52:53], v[22:23], v[252:253] op_sel_hi:[1,0,1]
v_pk_fma_f32 v[254:255], v[54:55], v[22:23], v[254:255] op_sel_hi:[1,0,1]
v_pk_mul_f32 v[244:245], v[244:245], v[228:229]
buffer_load_dwordx4 v[112:115], v4, s[16:19], s52 offen sc1
v_pk_mul_f32 v[228:229], v[228:229], v[28:29] op_sel:[0,1] op_sel_hi:[1,1]
v_pk_mul_f32 v[246:247], v[246:247], v[230:231]
v_pk_mul_f32 v[230:231], v[230:231], v[28:29] op_sel:[0,1] op_sel_hi:[1,1]
v_pk_mul_f32 v[252:253], v[252:253], v[236:237]
v_pk_mul_f32 v[236:237], v[236:237], v[28:29] op_sel:[0,1] op_sel_hi:[1,1]
v_pk_mul_f32 v[254:255], v[254:255], v[238:239]
v_pk_mul_f32 v[238:239], v[238:239], v[28:29] op_sel:[0,1] op_sel_hi:[1,1]
v_pk_fma_f32 v[224:225], v[224:225], v[20:21], v[20:21] op_sel:[0,1,1] op_sel_hi:[1,1,1]
v_pk_fma_f32 v[226:227], v[226:227], v[20:21], v[20:21] op_sel:[0,1,1] op_sel_hi:[1,1,1]
v_pk_fma_f32 v[232:233], v[232:233], v[20:21], v[20:21] op_sel:[0,1,1] op_sel_hi:[1,1,1]
v_pk_fma_f32 v[234:235], v[234:235], v[20:21], v[20:21] op_sel:[0,1,1] op_sel_hi:[1,1,1]
v_cvt_pk_bf16_f32 v172, v204, v205
v_cvt_pk_bf16_f32 v173, v206, v207
buffer_load_dwordx4 v[116:119], v4, s[16:19], s52 offen offset:1024 sc1
s_add_u32 s52, s53, 1441792
v_cvt_pk_bf16_f32 v174, v220, v221
v_cvt_pk_bf16_f32 v175, v222, v223
TR 14,7,608
ds_read_b64_tr_b16 a[16:17], v6
TR 18,6,512
TR 20,6,32
TR 22,6,544
buffer_store_dwordx4 v[172:175], v11, s[16:19], s64 offen offset:1024 sc1
TR 24,6,64
TR 26,6,576
TR 28,6,96
TR 30,6,608
v_rcp_f32 v224, v224
v_rcp_f32 v225, v225
v_rcp_f32 v226, v226
v_rcp_f32 v227, v227
v_rcp_f32 v232, v232
v_rcp_f32 v233, v233
v_rcp_f32 v234, v234
v_rcp_f32 v235, v235
v_exp_f32 v228, v228
v_exp_f32 v229, v229
v_exp_f32 v230, v230
v_exp_f32 v231, v231
v_exp_f32 v236, v236
v_exp_f32 v237, v237
v_exp_f32 v238, v238
v_exp_f32 v239, v239
v_pk_mul_f32 v[240:241], v[240:241], v[224:225]
buffer_load_dwordx4 v[120:123], v4, s[16:19], s52 offen sc1
v_pk_mul_f32 v[242:243], v[242:243], v[226:227]
v_pk_mul_f32 v[248:249], v[248:249], v[232:233]
v_pk_mul_f32 v[250:251], v[250:251], v[234:235]
v_pk_fma_f32 v[228:229], v[228:229], v[22:23], v[22:23] op_sel:[0,1,1] op_sel_hi:[1,1,1]
v_pk_fma_f32 v[230:231], v[230:231], v[22:23], v[22:23] op_sel:[0,1,1] op_sel_hi:[1,1,1]
v_pk_fma_f32 v[236:237], v[236:237], v[22:23], v[22:23] op_sel:[0,1,1] op_sel_hi:[1,1,1]
v_pk_fma_f32 v[238:239], v[238:239], v[22:23], v[22:23] op_sel:[0,1,1] op_sel_hi:[1,1,1]
v_cvt_pk_bf16_f32 v224, v240, v241
v_cvt_pk_bf16_f32 v225, v242, v243
v_cvt_pk_bf16_f32 v226, v248, v249
.Lpad24:
s_cbranch_execz .Lpad27
v_cvt_pk_bf16_f32 v227, v250, v251
v_rcp_f32 v228, v228
v_rcp_f32 v229, v229
v_rcp_f32 v230, v230
v_rcp_f32 v231, v231
v_rcp_f32 v236, v236
v_rcp_f32 v237, v237
v_rcp_f32 v238, v238
v_rcp_f32 v239, v239
v_pk_mul_f32 v[244:245], v[244:245], v[228:229]
buffer_store_dwordx4 v[224:227], v10, s[16:19], s65 offen sc1
v_pk_mul_f32 v[246:247], v[246:247], v[230:231]
v_pk_mul_f32 v[252:253], v[252:253], v[236:237]
v_pk_mul_f32 v[254:255], v[254:255], v[238:239]
v_cvt_pk_bf16_f32 v228, v244, v245
v_cvt_pk_bf16_f32 v229, v246, v247
v_cvt_pk_bf16_f32 v230, v252, v253
v_cvt_pk_bf16_f32 v231, v254, v255
buffer_store_dwordx4 v[228:231], v10, s[16:19], s65 offen offset:1024 sc1
buffer_load_dwordx4 v[124:127], v4, s[16:19], s52 offen offset:1024 sc1
v_mov_b32 v21, v68
v_mov_b32 v22, v69
v_mov_b32 v23, v70
v_mov_b32 v24, v71
v_mov_b32 v25, 0
s_waitcnt vmcnt(9) lgkmcnt(0)
s_barrier
v_mfma_f32_16x16x32_bf16 v[32:35], a[0:3], v[96:99], 0
TR 32,7,8448
s_add_u32 s52, s53, 1835008
v_mfma_f32_16x16x32_bf16 v[48:51], a[0:3], v[100:103], 0
buffer_load_dwordx4 v[128:131], v4, s[16:19], s52 offen sc1
v_mfma_f32_16x16x32_bf16 v[52:55], a[4:7], v[100:103], 0
TR 34,7,8960
TR 36,7,8480
v_mfma_f32_16x16x32_bf16 v[36:39], a[4:7], v[96:99], 0
TR 38,7,8992
v_mfma_f32_16x16x32_bf16 v[40:43], a[8:11], v[96:99], 0
buffer_load_dwordx4 v[132:135], v4, s[16:19], s52 offen offset:1024 sc1
v_mfma_f32_16x16x32_bf16 v[56:59], a[8:11], v[100:103], 0
TR 40,7,8512
TR 42,7,9024
v_mfma_f32_16x16x32_bf16 v[60:63], a[12:15], v[100:103], 0
TR 44,7,8544
v_mfma_f32_16x16x32_bf16 v[44:47], a[12:15], v[96:99], 0
TR 46,7,9056
s_add_u32 s52, s53, 2359296
v_mfma_f32_16x16x32_bf16 v[64:67], a[16:19], v[96:99], 0
buffer_load_dwordx4 v[136:139], v4, s[16:19], s52 offen sc1
v_mfma_f32_16x16x32_bf16 v[80:83], a[16:19], v[100:103], 0
TR 48,6,8448
v_mfma_f32_16x16x32_bf16 v[84:87], a[20:23], v[100:103], 0
TR 50,6,8960
TR 52,6,8480
v_mfma_f32_16x16x32_bf16 v[68:71], a[20:23], v[96:99], 0
TR 54,6,8992
v_mfma_f32_16x16x32_bf16 v[72:75], a[24:27], v[96:99], 0
buffer_load_dwordx4 v[140:143], v4, s[16:19], s52 offen offset:1024 sc1
v_mfma_f32_16x16x32_bf16 v[88:91], a[24:27], v[100:103], 0
TR 56,6,8512
TR 58,6,9024
v_mfma_f32_16x16x32_bf16 v[92:95], a[28:31], v[100:103], 0
TR 60,6,8544
v_mfma_f32_16x16x32_bf16 v[76:79], a[28:31], v[96:99], 0
TR 62,6,9056
s_waitcnt vmcnt(11) lgkmcnt(8)
MAV 32,32,104
TR 0,7,16896
s_add_u32 s52, s53, 2752512
MAV 48,32,108
buffer_load_dwordx4 v[144:147], v4, s[16:19], s52 offen sc1
MAV 52,36,108
TR 2,7,17408
TR 4,7,16928
MAV 36,36,104
TR 6,7,17440
MAV 40,40,104
buffer_load_dwordx4 v[148:151], v4, s[16:19], s52 offen offset:1024 sc1
MAV 56,40,108
TR 8,7,16960
TR 10,7,17472
MAV 60,44,108
TR 12,7,16992
MAV 44,44,104
TR 14,7,17504
s_add_u32 s52, s53, 3276800
s_waitcnt lgkmcnt(8)
MAV 64,48,104
buffer_load_dwordx4 v[152:155], v4, s[16:19], s52 offen sc1
MAV 80,48,108
TR 16,6,16896
MAV 84,52,108
TR 18,6,17408
TR 20,6,16928
MAV 68,52,104
TR 22,6,17440
MAV 72,56,104
buffer_load_dwordx4 v[156:159], v4, s[16:19], s52 offen offset:1024 sc1
MAV 88,56,108
TR 24,6,16960
TR 26,6,17472
MAV 92,60,108
TR 28,6,16992
MAV 76,60,104
TR 30,6,17504
s_waitcnt vmcnt(9) lgkmcnt(8)
s_barrier
MAV 32,0,112
TR 32,7,25344
TR 34,7,25856
MAV 48,0,116
buffer_atomic_add v24, v21, s[16:19], s72 offen
MAV 52,4,116
TR 36,7,25376
TR 38,7,25888
MAV 36,4,112
TR 40,7,25408
s_add_u32 m0, s55, 0
MAV 40,8,112
buffer_load_dwordx4 v18, s[28:31], s54 offen lds
MAV 56,8,116
TR 42,7,25920
MAV 60,12,116
TR 44,7,25440
TR 46,7,25952
MAV 44,12,112
TR 48,6,25344
s_add_u32 s52, s53, 3670016
s_waitcnt lgkmcnt(9)
MAV 64,16,112
buffer_load_dwordx4 v[96:99], v4, s[16:19], s52 offen sc1
MAV 80,16,116
TR 50,6,25856
TR 52,6,25376
MAV 84,20,116
buffer_load_dwordx4 v19, s[28:31], s54 offen offset:1056 lds
MAV 68,20,112
s_mov_b32 s54, 327680
MAV 72,24,112
TR 54,6,25888
TR 56,6,25408
MAV 88,24,116
buffer_load_dwordx4 v[100:103], v4, s[16:19], s52 offen offset:1024 sc1
MAV 92,28,116
TR 58,6,25920
TR 60,6,25440
MAV 76,28,112
TR 62,6,25952
s_waitcnt vmcnt(13) lgkmcnt(8)
MAV 32,32,120
TR 0,7,33792
s_add_u32 m0, s55, 8448
MAV 48,32,124
buffer_load_dwordx4 v18, s[28:31], s54 offen lds
MAV 52,36,124
TR 2,7,34304
TR 4,7,33824
MAV 36,36,120
TR 6,7,34336
s_add_u32 s52, s53, 4194304
MAV 40,40,120
buffer_load_dwordx4 v[104:107], v4, s[16:19], s52 offen sc1
MAV 56,40,124
TR 8,7,33856
MAV 60,44,124
TR 10,7,34368
TR 12,7,33888
MAV 44,44,120
TR 14,7,34400
s_waitcnt lgkmcnt(8)
MAV 64,48,120
buffer_load_dwordx4 v19, s[28:31], s54 offen offset:1056 lds
MAV 80,48,124
s_mov_b32 s54, 524288
MAV 84,52,124
TR 16,6,33792
TR 18,6,34304
MAV 68,52,120
TR 20,6,33824
TR 22,6,34336
MAV 72,56,120
buffer_load_dwordx4 v[108:111], v4, s[16:19], s52 offen offset:1024 sc1
MAV 88,56,124
TR 24,6,33856
MAV 92,60,124
TR 26,6,34368
TR 28,6,33888
MAV 76,60,120
TR 30,6,34400
s_waitcnt vmcnt(15) lgkmcnt(8)
s_barrier
MAV 32,0,128
TR 32,7,42240
s_add_u32 m0, s55, 16896
MAV 48,0,132
buffer_load_dwordx4 v18, s[28:31], s54 offen lds
MAV 52,4,132
TR 34,7,42752
TR 36,7,42272
MAV 36,4,128
TR 38,7,42784
s_add_u32 s52, s53, 4587520
MAV 40,8,128
buffer_load_dwordx4 v[112:115], v4, s[16:19], s52 offen sc1
MAV 56,8,132
TR 40,7,42304
MAV 60,12,132
TR 42,7,42816
TR 44,7,42336
MAV 44,12,128
TR 46,7,42848
s_waitcnt lgkmcnt(8)
MAV 64,16,128
buffer_load_dwordx4 v19, s[28:31], s54 offen offset:1056 lds
MAV 80,16,132
s_mov_b32 s54, 786432
MAV 84,20,132
TR 48,6,42240
TR 50,6,42752
MAV 68,20,128
TR 52,6,42272
TR 54,6,42784
MAV 72,24,128
buffer_load_dwordx4 v[116:119], v4, s[16:19], s52 offen offset:1024 sc1
MAV 88,24,132
TR 56,6,42304
MAV 92,28,132
TR 58,6,42816
TR 60,6,42336
MAV 76,28,128
TR 62,6,42848
s_waitcnt vmcnt(17) lgkmcnt(8)
MAV 32,32,136
TR 0,7,50688
s_add_u32 m0, s55, 25344
MAV 48,32,140
buffer_load_dwordx4 v18, s[28:31], s54 offen lds
MAV 52,36,140
TR 2,7,51200
TR 4,7,50720
MAV 36,36,136
TR 6,7,51232
s_add_u32 s52, s53, 5111808
MAV 40,40,136
buffer_load_dwordx4 v[120:123], v4, s[16:19], s52 offen sc1
MAV 56,40,140
TR 8,7,50752
TR 10,7,51264
MAV 60,44,140
TR 12,7,50784
TR 14,7,51296
MAV 44,44,136
s_waitcnt lgkmcnt(8)
MAV 64,48,136
buffer_load_dwordx4 v19, s[28:31], s54 offen offset:1056 lds
MAV 80,48,140
TR 16,6,50688
s_mov_b32 s54, 983040
MAV 84,52,140
buffer_load_dwordx4 v[124:127], v4, s[16:19], s52 offen offset:1024 sc1
MAV 68,52,136
TR 18,6,51200
TR 20,6,50720
MAV 72,56,136
TR 22,6,51232
TR 24,6,50752
MAV 88,56,140
buffer_atomic_add v25, v22, s[16:19], s73 offen sc0
MAV 92,60,140
TR 26,6,51264
TR 28,6,50784
MAV 76,60,136
TR 30,6,51296
s_waitcnt vmcnt(20) lgkmcnt(8)
s_barrier
MAV 32,0,144
TR 32,7,59136
s_add_u32 m0, s55, 33792
MAV 48,0,148
buffer_load_dwordx4 v18, s[28:31], s54 offen lds
MAV 52,4,148
TR 34,7,59648
TR 36,7,59168
MAV 36,4,144
TR 38,7,59680
s_add_u32 s52, s53, 5505024
MAV 40,8,144
buffer_load_dwordx4 v[128:131], v4, s[16:19], s52 offen sc1
MAV 56,8,148
TR 40,7,59200
MAV 60,12,148
TR 42,7,59712
TR 44,7,59232
MAV 44,12,144
TR 46,7,59744
s_waitcnt lgkmcnt(8)
MAV 64,16,144
buffer_load_dwordx4 v19, s[28:31], s54 offen offset:1056 lds
MAV 80,16,148
s_mov_b32 s54, 1245184
MAV 84,20,148
TR 48,6,59136
TR 50,6,59648
MAV 68,20,144
TR 52,6,59168
TR 54,6,59680
MAV 72,24,144
buffer_load_dwordx4 v[132:135], v4, s[16:19], s52 offen offset:1024 sc1
MAV 88,24,148
TR 56,6,59200
MAV 92,28,148
TR 58,6,59712
TR 60,6,59232
MAV 76,28,144
TR 62,6,59744
v_add_u32 v7, s57, v7
v_add_u32 v6, s57, v6
s_sub_u32 s57, 0, s57
s_waitcnt vmcnt(22) lgkmcnt(8)
MAV 32,32,152
ds_read_b64_tr_b16 a[0:1], v7
s_add_u32 m0, s55, 42240
MAV 48,32,156
buffer_load_dwordx4 v18, s[28:31], s54 offen lds
MAV 52,36,156
TR 2,7,512
TR 4,7,32
MAV 36,36,152
TR 6,7,544
s_add_u32 s52, s53, 6029312
MAV 40,40,152
buffer_load_dwordx4 v[136:139], v4, s[16:19], s52 offen sc1
MAV 56,40,156
TR 8,7,64
MAV 60,44,156
TR 10,7,576
TR 12,7,96
MAV 44,44,152
TR 14,7,608
s_waitcnt lgkmcnt(8)
MAV 64,48,152
buffer_load_dwordx4 v19, s[28:31], s54 offen offset:1056 lds
MAV 80,48,156
s_mov_b32 s54, 1441792
MAV 84,52,156
ds_read_b64_tr_b16 a[16:17], v6
TR 18,6,512
MAV 68,52,152
TR 20,6,32
TR 22,6,544
MAV 72,56,152
buffer_load_dwordx4 v[140:143], v4, s[16:19], s52 offen offset:1024 sc1
MAV 88,56,156
TR 24,6,64
MAV 92,60,156
TR 26,6,576
TR 28,6,96
MAV 76,60,152
TR 30,6,608
s_waitcnt vmcnt(21) lgkmcnt(8)
s_barrier
MAV 32,0,96
TR 32,7,8448
s_add_u32 m0, s55, 50688
MAV 48,0,100
buffer_load_dwordx4 v18, s[28:31], s54 offen lds
MAV 52,4,100
TR 34,7,8960
TR 36,7,8480
MAV 36,4,96
TR 38,7,8992
s_add_u32 s52, s53, 6422528
MAV 40,8,96
buffer_load_dwordx4 v[144:147], v4, s[16:19], s52 offen sc1
MAV 56,8,100
TR 40,7,8512
MAV 60,12,100
TR 42,7,9024
TR 44,7,8544
MAV 44,12,96
TR 46,7,9056
s_waitcnt lgkmcnt(8)
MAV 64,16,96
buffer_load_dwordx4 v19, s[28:31], s54 offen offset:1056 lds
MAV 80,16,100
s_mov_b32 s54, 1703936
MAV 84,20,100
TR 48,6,8448
TR 50,6,8960
MAV 68,20,96
TR 52,6,8480
TR 54,6,8992
MAV 72,24,96
buffer_load_dwordx4 v[148:151], v4, s[16:19], s52 offen offset:1024 sc1
MAV 88,24,100
TR 56,6,8512
MAV 92,28,100
TR 58,6,9024
TR 60,6,8544
MAV 76,28,96
TR 62,6,9056
s_waitcnt vmcnt(21) lgkmcnt(8)
MAV 32,32,104
TR 0,7,16896
s_add_u32 m0, s55, 59136
MAV 48,32,108
buffer_load_dwordx4 v18, s[28:31], s54 offen lds
MAV 52,36,108
TR 2,7,17408
TR 4,7,16928
MAV 36,36,104
TR 6,7,17440
s_add_u32 s52, s53, 6946816
MAV 40,40,104
buffer_load_dwordx4 v[152:155], v4, s[16:19], s52 offen sc1
MAV 56,40,108
TR 8,7,16960
MAV 60,44,108
TR 10,7,17472
TR 12,7,16992
MAV 44,44,104
TR 14,7,17504
s_waitcnt lgkmcnt(8)
MAV 64,48,104
buffer_load_dwordx4 v19, s[28:31], s54 offen offset:1056 lds
MAV 80,48,108
s_mov_b32 s54, 1900544
MAV 84,52,108
TR 16,6,16896
TR 18,6,17408
MAV 68,52,104
TR 20,6,16928
TR 22,6,17440
MAV 72,56,104
buffer_load_dwordx4 v[156:159], v4, s[16:19], s52 offen offset:1024 sc1
MAV 88,56,108
TR 24,6,16960
MAV 92,60,108
TR 26,6,17472
TR 28,6,16992
MAV 76,60,104
TR 30,6,17504
s_waitcnt vmcnt(16)
v_cmp_gt_u32 vcc, v23, v25
s_nop 0
s_cbranch_vccnz .Lsp72
.Lsp72b:
s_waitcnt lgkmcnt(8)
s_barrier
MAV 32,0,112
TR 32,7,25344
s_add_u32 m0, s55, 67584
MAV 48,0,116
buffer_load_dwordx4 v18, s[28:31], s54 offen lds
MAV 52,4,116
TR 34,7,25856
TR 36,7,25376
MAV 36,4,112
TR 38,7,25888
s_add_u32 s52, s53, 131072
MAV 40,8,112
buffer_load_dwordx4 v[96:99], v4, s[16:19], s52 offen sc1
MAV 56,8,116
TR 40,7,25408
MAV 60,12,116
TR 42,7,25920
TR 44,7,25440
MAV 44,12,112
TR 46,7,25952
s_waitcnt lgkmcnt(8)
MAV 64,16,112
buffer_load_dwordx4 v19, s[28:31], s54 offen offset:1056 lds
MAV 80,16,116
s_mov_b32 s54, 2162688
MAV 84,20,116
TR 48,6,25344
TR 50,6,25856
MAV 68,20,112
TR 52,6,25376
TR 54,6,25888
MAV 72,24,112
buffer_load_dwordx4 v[100:103], v4, s[16:19], s52 offen offset:1024 sc1
MAV 88,24,116
TR 56,6,25408
MAV 92,28,116
TR 58,6,25920
TR 60,6,25440
MAV 76,28,112
TR 62,6,25952
s_waitcnt lgkmcnt(8)
MAV 32,32,120
TR 0,7,33792
s_add_u32 m0, s55, 76032
MAV 48,32,124
buffer_load_dwordx4 v18, s[28:31], s54 offen lds
MAV 52,36,124
TR 2,7,34304
TR 4,7,33824
MAV 36,36,120
TR 6,7,34336
s_add_u32 s52, s53, 655360
MAV 40,40,120
buffer_load_dwordx4 v[104:107], v4, s[16:19], s52 offen sc1
MAV 56,40,124
TR 8,7,33856
MAV 60,44,124
TR 10,7,34368
TR 12,7,33888
MAV 44,44,120
TR 14,7,34400
s_waitcnt lgkmcnt(8)
MAV 64,48,120
buffer_load_dwordx4 v19, s[28:31], s54 offen offset:1056 lds
MAV 80,48,124
s_mov_b32 s54, 2359296
MAV 84,52,124
TR 16,6,33792
TR 18,6,34304
MAV 68,52,120
TR 20,6,33824
TR 22,6,34336
MAV 72,56,120
buffer_load_dwordx4 v[108:111], v4, s[16:19], s52 offen offset:1024 sc1
MAV 88,56,124
TR 24,6,33856
MAV 92,60,124
TR 26,6,34368
TR 28,6,33888
MAV 76,60,120
TR 30,6,34400
s_waitcnt vmcnt(20) lgkmcnt(8)
s_barrier
MAV 32,0,128
TR 32,7,42240
s_add_u32 m0, s55, 84480
MAV 48,0,132
buffer_load_dwordx4 v18, s[28:31], s54 offen lds
MAV 52,4,132
TR 34,7,42752
.Lpad25:
s_cbranch_execz .Lpad28
TR 36,7,42272
MAV 36,4,128
TR 38,7,42784
s_add_u32 s52, s53, 1048576
MAV 40,8,128
buffer_load_dwordx4 v[112:115], v4, s[16:19], s52 offen sc1
MAV 56,8,132
TR 40,7,42304
MAV 60,12,132
TR 42,7,42816
TR 44,7,42336
MAV 44,12,128
TR 46,7,42848
s_waitcnt lgkmcnt(8)
MAV 64,16,128
buffer_load_dwordx4 v19, s[28:31], s54 offen offset:1056 lds
MAV 80,16,132
s_mov_b32 s54, 2621440
MAV 84,20,132
TR 48,6,42240
TR 50,6,42752
MAV 68,20,128
TR 52,6,42272
TR 54,6,42784
MAV 72,24,128
buffer_load_dwordx4 v[116:119], v4, s[16:19], s52 offen offset:1024 sc1
MAV 88,24,132
TR 56,6,42304
MAV 92,28,132
TR 58,6,42816
TR 60,6,42336
MAV 76,28,128
TR 62,6,42848
s_waitcnt vmcnt(20) lgkmcnt(8)
MAV 32,32,136
TR 0,7,50688
s_add_u32 m0, s55, 92928
MAV 48,32,140
buffer_load_dwordx4 v18, s[28:31], s54 offen lds
MAV 52,36,140
TR 2,7,51200
TR 4,7,50720
MAV 36,36,136
TR 6,7,51232
s_add_u32 s52, s53, 1572864
MAV 40,40,136
buffer_load_dwordx4 v[120:123], v4, s[16:19], s52 offen sc1
MAV 56,40,140
TR 8,7,50752
MAV 60,44,140
TR 10,7,51264
TR 12,7,50784
MAV 44,44,136
TR 14,7,51296
s_waitcnt lgkmcnt(8)
MAV 64,48,136
buffer_load_dwordx4 v19, s[28:31], s54 offen offset:1056 lds
MAV 80,48,140
s_mov_b32 s54, 2818048
MAV 84,52,140
TR 16,6,50688
TR 18,6,51200
MAV 68,52,136
TR 20,6,50720
TR 22,6,51232
MAV 72,56,136
buffer_load_dwordx4 v[124:127], v4, s[16:19], s52 offen offset:1024 sc1
MAV 88,56,140
TR 24,6,50752
MAV 92,60,140
TR 26,6,51264
TR 28,6,50784
MAV 76,60,136
TR 30,6,51296
s_waitcnt vmcnt(20) lgkmcnt(8)
s_barrier
MAV 32,0,144
TR 32,7,59136
s_add_u32 m0, s55, 101376
MAV 48,0,148
buffer_load_dwordx4 v18, s[28:31], s54 offen lds
MAV 52,4,148
TR 34,7,59648
TR 36,7,59168
MAV 36,4,144
TR 38,7,59680
s_add_u32 s52, s53, 1966080
MAV 40,8,144
buffer_load_dwordx4 v[128:131], v4, s[16:19], s52 offen sc1
MAV 56,8,148
TR 40,7,59200
MAV 60,12,148
TR 42,7,59712
TR 44,7,59232
MAV 44,12,144
TR 46,7,59744
s_waitcnt lgkmcnt(8)
MAV 64,16,144
buffer_load_dwordx4 v19, s[28:31], s54 offen offset:1056 lds
MAV 80,16,148
s_mov_b32 s54, 3080192
MAV 84,20,148
TR 48,6,59136
TR 50,6,59648
MAV 68,20,144
TR 52,6,59168
TR 54,6,59680
MAV 72,24,144
buffer_load_dwordx4 v[132:135], v4, s[16:19], s52 offen offset:1024 sc1
MAV 88,24,148
TR 56,6,59200
MAV 92,28,148
TR 58,6,59712
TR 60,6,59232
MAV 76,28,144
TR 62,6,59744
v_add_u32 v7, s57, v7
v_add_u32 v6, s57, v6
s_sub_u32 s57, 0, s57
s_waitcnt vmcnt(20) lgkmcnt(8)
MAV 32,32,152
ds_read_b64_tr_b16 a[0:1], v7
s_add_u32 m0, s55, 109824
MAV 48,32,156
buffer_load_dwordx4 v18, s[28:31], s54 offen lds
MAV 52,36,156
TR 2,7,512
TR 4,7,32
MAV 36,36,152
TR 6,7,544
s_add_u32 s52, s53, 2490368
MAV 40,40,152
buffer_load_dwordx4 v[136:139], v4, s[16:19], s52 offen sc1
MAV 56,40,156
TR 8,7,64
MAV 60,44,156
TR 10,7,576
TR 12,7,96
MAV 44,44,152
TR 14,7,608
s_waitcnt lgkmcnt(8)
MAV 64,48,152
buffer_load_dwordx4 v19, s[28:31], s54 offen offset:1056 lds
MAV 80,48,156
s_mov_b32 s54, 3276800
MAV 84,52,156
ds_read_b64_tr_b16 a[16:17], v6
TR 18,6,512
MAV 68,52,152
TR 20,6,32
TR 22,6,544
MAV 72,56,152
buffer_load_dwordx4 v[140:143], v4, s[16:19], s52 offen offset:1024 sc1
MAV 88,56,156
TR 24,6,64
MAV 92,60,156
TR 26,6,576
TR 28,6,96
MAV 76,60,152
TR 30,6,608
s_waitcnt vmcnt(20) lgkmcnt(8)
s_barrier
MAV 32,0,96
TR 32,7,8448
s_add_u32 m0, s55, 118272
MAV 48,0,100
buffer_load_dwordx4 v18, s[28:31], s54 offen lds
MAV 52,4,100
TR 34,7,8960
TR 36,7,8480
MAV 36,4,96
TR 38,7,8992
s_add_u32 s52, s53, 2883584
MAV 40,8,96
buffer_load_dwordx4 v[144:147], v4, s[16:19], s52 offen sc1
MAV 56,8,100
TR 40,7,8512
MAV 60,12,100
TR 42,7,9024
TR 44,7,8544
MAV 44,12,96
TR 46,7,9056
s_waitcnt lgkmcnt(8)
MAV 64,16,96
buffer_load_dwordx4 v19, s[28:31], s54 offen offset:1056 lds
MAV 80,16,100
s_mov_b32 s54, 3538944
MAV 84,20,100
TR 48,6,8448
TR 50,6,8960
MAV 68,20,96
TR 52,6,8480
TR 54,6,8992
MAV 72,24,96
buffer_load_dwordx4 v[148:151], v4, s[16:19], s52 offen offset:1024 sc1
MAV 88,24,100
TR 56,6,8512
MAV 92,28,100
TR 58,6,9024
TR 60,6,8544
MAV 76,28,96
TR 62,6,9056
s_waitcnt vmcnt(20) lgkmcnt(8)
MAV 32,32,104
TR 0,7,16896
s_add_u32 m0, s55, 126720
MAV 48,32,108
buffer_load_dwordx4 v18, s[28:31], s54 offen lds
MAV 52,36,108
TR 2,7,17408
TR 4,7,16928
MAV 36,36,104
TR 6,7,17440
s_add_u32 s52, s53, 3407872
MAV 40,40,104
buffer_load_dwordx4 v[152:155], v4, s[16:19], s52 offen sc1
MAV 56,40,108
TR 8,7,16960
MAV 60,44,108
TR 10,7,17472
TR 12,7,16992
MAV 44,44,104
TR 14,7,17504
s_waitcnt lgkmcnt(8)
MAV 64,48,104
buffer_load_dwordx4 v19, s[28:31], s54 offen offset:1056 lds
MAV 80,48,108
s_mov_b32 s54, 131072
MAV 84,52,108
TR 16,6,16896
TR 18,6,17408
MAV 68,52,104
TR 20,6,16928
TR 22,6,17440
MAV 72,56,104
buffer_load_dwordx4 v[156:159], v4, s[16:19], s52 offen offset:1024 sc1
MAV 88,56,108
TR 24,6,16960
MAV 92,60,108
TR 26,6,17472
TR 28,6,16992
MAV 76,60,104
TR 30,6,17504
s_waitcnt vmcnt(20) lgkmcnt(8)
s_barrier
MAV 32,0,112
TR 32,7,25344
s_add_u32 m0, s55, 0
MAV 48,0,116
buffer_load_dwordx4 v18, s[28:31], s54 offen lds
MAV 52,4,116
TR 34,7,25856
TR 36,7,25376
MAV 36,4,112
TR 38,7,25888
s_add_u32 s52, s53, 3801088
MAV 40,8,112
buffer_load_dwordx4 v[96:99], v4, s[16:19], s52 offen sc1
MAV 56,8,116
TR 40,7,25408
MAV 60,12,116
TR 42,7,25920
TR 44,7,25440
MAV 44,12,112
TR 46,7,25952
s_waitcnt lgkmcnt(8)
MAV 64,16,112
buffer_load_dwordx4 v19, s[28:31], s54 offen offset:1056 lds
MAV 80,16,116
s_mov_b32 s54, 393216
MAV 84,20,116
TR 48,6,25344
TR 50,6,25856
MAV 68,20,112
TR 52,6,25376
TR 54,6,25888
MAV 72,24,112
buffer_load_dwordx4 v[100:103], v4, s[16:19], s52 offen offset:1024 sc1
MAV 88,24,116
TR 56,6,25408
MAV 92,28,116
TR 58,6,25920
TR 60,6,25440
MAV 76,28,112
TR 62,6,25952
s_waitcnt vmcnt(20) lgkmcnt(8)
MAV 32,32,120
TR 0,7,33792
s_add_u32 m0, s55, 8448
MAV 48,32,124
buffer_load_dwordx4 v18, s[28:31], s54 offen lds
MAV 52,36,124
TR 2,7,34304
TR 4,7,33824
MAV 36,36,120
TR 6,7,34336
s_add_u32 s52, s53, 4325376
MAV 40,40,120
buffer_load_dwordx4 v[104:107], v4, s[16:19], s52 offen sc1
MAV 56,40,124
TR 8,7,33856
MAV 60,44,124
TR 10,7,34368
TR 12,7,33888
MAV 44,44,120
TR 14,7,34400
s_waitcnt lgkmcnt(8)
MAV 64,48,120
buffer_load_dwordx4 v19, s[28:31], s54 offen offset:1056 lds
MAV 80,48,124
s_mov_b32 s54, 589824
MAV 84,52,124
TR 16,6,33792
TR 18,6,34304
MAV 68,52,120
TR 20,6,33824
TR 22,6,34336
MAV 72,56,120
buffer_load_dwordx4 v[108:111], v4, s[16:19], s52 offen offset:1024 sc1
MAV 88,56,124
TR 24,6,33856
MAV 92,60,124
TR 26,6,34368
TR 28,6,33888
MAV 76,60,120
TR 30,6,34400
s_waitcnt vmcnt(20) lgkmcnt(8)
s_barrier
MAV 32,0,128
TR 32,7,42240
s_add_u32 m0, s55, 16896
MAV 48,0,132
buffer_load_dwordx4 v18, s[28:31], s54 offen lds
MAV 52,4,132
TR 34,7,42752
TR 36,7,42272
MAV 36,4,128
TR 38,7,42784
s_add_u32 s52, s53, 4718592
MAV 40,8,128
buffer_load_dwordx4 v[112:115], v4, s[16:19], s52 offen sc1
MAV 56,8,132
TR 40,7,42304
MAV 60,12,132
TR 42,7,42816
TR 44,7,42336
MAV 44,12,128
TR 46,7,42848
s_waitcnt lgkmcnt(8)
MAV 64,16,128
buffer_load_dwordx4 v19, s[28:31], s54 offen offset:1056 lds
MAV 80,16,132
s_mov_b32 s54, 851968
MAV 84,20,132
TR 48,6,42240
TR 50,6,42752
MAV 68,20,128
TR 52,6,42272
TR 54,6,42784
MAV 72,24,128
buffer_load_dwordx4 v[116:119], v4, s[16:19], s52 offen offset:1024 sc1
MAV 88,24,132
TR 56,6,42304
MAV 92,28,132
TR 58,6,42816
TR 60,6,42336
MAV 76,28,128
TR 62,6,42848
s_waitcnt vmcnt(20) lgkmcnt(8)
MAV 32,32,136
TR 0,7,50688
s_add_u32 m0, s55, 25344
MAV 48,32,140
buffer_load_dwordx4 v18, s[28:31], s54 offen lds
MAV 52,36,140
TR 2,7,51200
TR 4,7,50720
MAV 36,36,136
TR 6,7,51232
s_add_u32 s52, s53, 5242880
MAV 40,40,136
buffer_load_dwordx4 v[120:123], v4, s[16:19], s52 offen sc1
MAV 56,40,140
TR 8,7,50752
MAV 60,44,140
TR 10,7,51264
TR 12,7,50784
MAV 44,44,136
TR 14,7,51296
s_waitcnt lgkmcnt(8)
MAV 64,48,136
buffer_load_dwordx4 v19, s[28:31], s54 offen offset:1056 lds
MAV 80,48,140
s_mov_b32 s54, 1048576
MAV 84,52,140
TR 16,6,50688
TR 18,6,51200
MAV 68,52,136
TR 20,6,50720
TR 22,6,51232
MAV 72,56,136
buffer_load_dwordx4 v[124:127], v4, s[16:19], s52 offen offset:1024 sc1
MAV 88,56,140
TR 24,6,50752
MAV 92,60,140
TR 26,6,51264
TR 28,6,50784
MAV 76,60,136
TR 30,6,51296
s_waitcnt vmcnt(20) lgkmcnt(8)
s_barrier
MAV 32,0,144
TR 32,7,59136
s_add_u32 m0, s55, 33792
MAV 48,0,148
buffer_load_dwordx4 v18, s[28:31], s54 offen lds
MAV 52,4,148
TR 34,7,59648
TR 36,7,59168
MAV 36,4,144
TR 38,7,59680
s_add_u32 s52, s53, 5636096
MAV 40,8,144
buffer_load_dwordx4 v[128:131], v4, s[16:19], s52 offen sc1
MAV 56,8,148
TR 40,7,59200
MAV 60,12,148
TR 42,7,59712
TR 44,7,59232
MAV 44,12,144
TR 46,7,59744
s_waitcnt lgkmcnt(8)
MAV 64,16,144
buffer_load_dwordx4 v19, s[28:31], s54 offen offset:1056 lds
MAV 80,16,148
s_mov_b32 s54, 1310720
MAV 84,20,148
TR 48,6,59136
TR 50,6,59648
MAV 68,20,144
TR 52,6,59168
TR 54,6,59680
MAV 72,24,144
buffer_load_dwordx4 v[132:135], v4, s[16:19], s52 offen offset:1024 sc1
MAV 88,24,148
TR 56,6,59200
MAV 92,28,148
TR 58,6,59712
TR 60,6,59232
MAV 76,28,144
TR 62,6,59744
v_add_u32 v7, s57, v7
v_add_u32 v6, s57, v6
s_sub_u32 s57, 0, s57
s_waitcnt vmcnt(20) lgkmcnt(8)
MAV 32,32,152
ds_read_b64_tr_b16 a[0:1], v7
s_add_u32 m0, s55, 42240
MAV 48,32,156
buffer_load_dwordx4 v18, s[28:31], s54 offen lds
MAV 52,36,156
TR 2,7,512
TR 4,7,32
MAV 36,36,152
TR 6,7,544
s_add_u32 s52, s53, 6160384
MAV 40,40,152
buffer_load_dwordx4 v[136:139], v4, s[16:19], s52 offen sc1
MAV 56,40,156
TR 8,7,64
MAV 60,44,156
TR 10,7,576
TR 12,7,96
MAV 44,44,152
TR 14,7,608
s_waitcnt lgkmcnt(8)
MAV 64,48,152
buffer_load_dwordx4 v19, s[28:31], s54 offen offset:1056 lds
MAV 80,48,156
s_mov_b32 s54, 1507328
MAV 84,52,156
ds_read_b64_tr_b16 a[16:17], v6
TR 18,6,512
MAV 68,52,152
TR 20,6,32
TR 22,6,544
MAV 72,56,152
buffer_load_dwordx4 v[140:143], v4, s[16:19], s52 offen offset:1024 sc1
MAV 88,56,156
TR 24,6,64
MAV 92,60,156
TR 26,6,576
TR 28,6,96
MAV 76,60,152
TR 30,6,608
s_waitcnt vmcnt(20) lgkmcnt(8)
s_barrier
MAV 32,0,96
TR 32,7,8448
s_add_u32 m0, s55, 50688
MAV 48,0,100
buffer_load_dwordx4 v18, s[28:31], s54 offen lds
MAV 52,4,100
TR 34,7,8960
TR 36,7,8480
MAV 36,4,96
TR 38,7,8992
s_add_u32 s52, s53, 6553600
MAV 40,8,96
buffer_load_dwordx4 v[144:147], v4, s[16:19], s52 offen sc1
MAV 56,8,100
TR 40,7,8512
MAV 60,12,100
TR 42,7,9024
TR 44,7,8544
MAV 44,12,96
TR 46,7,9056
s_waitcnt lgkmcnt(8)
MAV 64,16,96
buffer_load_dwordx4 v19, s[28:31], s54 offen offset:1056 lds
MAV 80,16,100
s_mov_b32 s54, 1769472
MAV 84,20,100
TR 48,6,8448
TR 50,6,8960
MAV 68,20,96
TR 52,6,8480
TR 54,6,8992
MAV 72,24,96
buffer_load_dwordx4 v[148:151], v4, s[16:19], s52 offen offset:1024 sc1
.Lpad26:
s_cbranch_execz .Lnopoll68r
MAV 88,24,100
TR 56,6,8512
MAV 92,28,100
TR 58,6,9024
TR 60,6,8544
MAV 76,28,96
TR 62,6,9056
s_waitcnt vmcnt(20) lgkmcnt(8)
MAV 32,32,104
TR 0,7,16896
s_add_u32 m0, s55, 59136
MAV 48,32,108
buffer_load_dwordx4 v18, s[28:31], s54 offen lds
MAV 52,36,108
TR 2,7,17408
TR 4,7,16928
MAV 36,36,104
TR 6,7,17440
s_add_u32 s52, s53, 7077888
MAV 40,40,104
buffer_load_dwordx4 v[152:155], v4, s[16:19], s52 offen sc1
MAV 56,40,108
TR 8,7,16960
MAV 60,44,108
TR 10,7,17472
TR 12,7,16992
MAV 44,44,104
TR 14,7,17504
s_waitcnt lgkmcnt(8)
MAV 64,48,104
buffer_load_dwordx4 v19, s[28:31], s54 offen offset:1056 lds
MAV 80,48,108
s_mov_b32 s54, 1966080
MAV 84,52,108
TR 16,6,16896
TR 18,6,17408
MAV 68,52,104
TR 20,6,16928
TR 22,6,17440
MAV 72,56,104
buffer_load_dwordx4 v[156:159], v4, s[16:19], s52 offen offset:1024 sc1
MAV 88,56,108
TR 24,6,16960
MAV 92,60,108
TR 26,6,17472
TR 28,6,16992
MAV 76,60,104
TR 30,6,17504
s_waitcnt vmcnt(20) lgkmcnt(8)
s_barrier
MAV 32,0,112
TR 32,7,25344
s_add_u32 m0, s55, 67584
MAV 48,0,116
buffer_load_dwordx4 v18, s[28:31], s54 offen lds
MAV 52,4,116
TR 34,7,25856
TR 36,7,25376
MAV 36,4,112
TR 38,7,25888
s_add_u32 s52, s53, 262144
MAV 40,8,112
buffer_load_dwordx4 v[96:99], v4, s[16:19], s52 offen sc1
MAV 56,8,116
TR 40,7,25408
MAV 60,12,116
TR 42,7,25920
TR 44,7,25440
MAV 44,12,112
TR 46,7,25952
s_waitcnt lgkmcnt(8)
MAV 64,16,112
buffer_load_dwordx4 v19, s[28:31], s54 offen offset:1056 lds
MAV 80,16,116
s_mov_b32 s54, 2228224
MAV 84,20,116
TR 48,6,25344
TR 50,6,25856
MAV 68,20,112
TR 52,6,25376
TR 54,6,25888
MAV 72,24,112
buffer_load_dwordx4 v[100:103], v4, s[16:19], s52 offen offset:1024 sc1
MAV 88,24,116
TR 56,6,25408
MAV 92,28,116
TR 58,6,25920
TR 60,6,25440
MAV 76,28,112
TR 62,6,25952
s_waitcnt vmcnt(20) lgkmcnt(8)
MAV 32,32,120
TR 0,7,33792
s_add_u32 m0, s55, 76032
MAV 48,32,124
buffer_load_dwordx4 v18, s[28:31], s54 offen lds
MAV 52,36,124
TR 2,7,34304
TR 4,7,33824
MAV 36,36,120
TR 6,7,34336
s_add_u32 s52, s53, 786432
MAV 40,40,120
buffer_load_dwordx4 v[104:107], v4, s[16:19], s52 offen sc1
MAV 56,40,124
TR 8,7,33856
MAV 60,44,124
TR 10,7,34368
TR 12,7,33888
MAV 44,44,120
TR 14,7,34400
s_waitcnt lgkmcnt(8)
MAV 64,48,120
buffer_load_dwordx4 v19, s[28:31], s54 offen offset:1056 lds
MAV 80,48,124
s_mov_b32 s54, 2424832
MAV 84,52,124
TR 16,6,33792
TR 18,6,34304
MAV 68,52,120
TR 20,6,33824
TR 22,6,34336
MAV 72,56,120
buffer_load_dwordx4 v[108:111], v4, s[16:19], s52 offen offset:1024 sc1
MAV 88,56,124
TR 24,6,33856
MAV 92,60,124
TR 26,6,34368
TR 28,6,33888
MAV 76,60,120
TR 30,6,34400
s_waitcnt vmcnt(20) lgkmcnt(8)
s_barrier
MAV 32,0,128
TR 32,7,42240
s_add_u32 m0, s55, 84480
MAV 48,0,132
buffer_load_dwordx4 v18, s[28:31], s54 offen lds
MAV 52,4,132
TR 34,7,42752
TR 36,7,42272
MAV 36,4,128
TR 38,7,42784
s_add_u32 s52, s53, 1179648
MAV 40,8,128
buffer_load_dwordx4 v[112:115], v4, s[16:19], s52 offen sc1
MAV 56,8,132
TR 40,7,42304
MAV 60,12,132
TR 42,7,42816
TR 44,7,42336
MAV 44,12,128
TR 46,7,42848
s_waitcnt lgkmcnt(8)
MAV 64,16,128
buffer_load_dwordx4 v19, s[28:31], s54 offen offset:1056 lds
MAV 80,16,132
s_mov_b32 s54, 2686976
MAV 84,20,132
TR 48,6,42240
TR 50,6,42752
MAV 68,20,128
TR 52,6,42272
TR 54,6,42784
MAV 72,24,128
buffer_load_dwordx4 v[116:119], v4, s[16:19], s52 offen offset:1024 sc1
MAV 88,24,132
TR 56,6,42304
MAV 92,28,132
TR 58,6,42816
TR 60,6,42336
MAV 76,28,128
TR 62,6,42848
s_waitcnt vmcnt(20) lgkmcnt(8)
MAV 32,32,136
TR 0,7,50688
s_add_u32 m0, s55, 92928
MAV 48,32,140
buffer_load_dwordx4 v18, s[28:31], s54 offen lds
MAV 52,36,140
TR 2,7,51200
TR 4,7,50720
MAV 36,36,136
TR 6,7,51232
s_add_u32 s52, s53, 1703936
MAV 40,40,136
buffer_load_dwordx4 v[120:123], v4, s[16:19], s52 offen sc1
MAV 56,40,140
TR 8,7,50752
MAV 60,44,140
TR 10,7,51264
TR 12,7,50784
MAV 44,44,136
TR 14,7,51296
s_waitcnt lgkmcnt(8)
MAV 64,48,136
buffer_load_dwordx4 v19, s[28:31], s54 offen offset:1056 lds
MAV 80,48,140
s_mov_b32 s54, 2883584
MAV 84,52,140
TR 16,6,50688
TR 18,6,51200
MAV 68,52,136
TR 20,6,50720
TR 22,6,51232
MAV 72,56,136
buffer_load_dwordx4 v[124:127], v4, s[16:19], s52 offen offset:1024 sc1
MAV 88,56,140
TR 24,6,50752
MAV 92,60,140
TR 26,6,51264
TR 28,6,50784
MAV 76,60,136
TR 30,6,51296
s_waitcnt vmcnt(20) lgkmcnt(8)
s_barrier
MAV 32,0,144
TR 32,7,59136
s_add_u32 m0, s55, 101376
MAV 48,0,148
buffer_load_dwordx4 v18, s[28:31], s54 offen lds
MAV 52,4,148
TR 34,7,59648
TR 36,7,59168
MAV 36,4,144
TR 38,7,59680
s_add_u32 s52, s53, 2097152
MAV 40,8,144
buffer_load_dwordx4 v[128:131], v4, s[16:19], s52 offen sc1
MAV 56,8,148
TR 40,7,59200
MAV 60,12,148
TR 42,7,59712
TR 44,7,59232
MAV 44,12,144
TR 46,7,59744
s_waitcnt lgkmcnt(8)
MAV 64,16,144
buffer_load_dwordx4 v19, s[28:31], s54 offen offset:1056 lds
MAV 80,16,148
s_mov_b32 s54, 3145728
MAV 84,20,148
TR 48,6,59136
TR 50,6,59648
MAV 68,20,144
TR 52,6,59168
TR 54,6,59680
MAV 72,24,144
buffer_load_dwordx4 v[132:135], v4, s[16:19], s52 offen offset:1024 sc1
MAV 88,24,148
TR 56,6,59200
MAV 92,28,148
TR 58,6,59712
TR 60,6,59232
MAV 76,28,144
TR 62,6,59744
v_add_u32 v7, s57, v7
v_add_u32 v6, s57, v6
s_sub_u32 s57, 0, s57
s_waitcnt vmcnt(20) lgkmcnt(8)
MAV 32,32,152
ds_read_b64_tr_b16 a[0:1], v7
s_add_u32 m0, s55, 109824
MAV 48,32,156
buffer_load_dwordx4 v18, s[28:31], s54 offen lds
MAV 52,36,156
TR 2,7,512
TR 4,7,32
MAV 36,36,152
TR 6,7,544
s_add_u32 s52, s53, 2621440
MAV 40,40,152
buffer_load_dwordx4 v[136:139], v4, s[16:19], s52 offen sc1
MAV 56,40,156
TR 8,7,64
MAV 60,44,156
TR 10,7,576
TR 12,7,96
MAV 44,44,152
TR 14,7,608
s_waitcnt lgkmcnt(8)
MAV 64,48,152
buffer_load_dwordx4 v19, s[28:31], s54 offen offset:1056 lds
MAV 80,48,156
s_mov_b32 s54, 3342336
MAV 84,52,156
ds_read_b64_tr_b16 a[16:17], v6
TR 18,6,512
MAV 68,52,152
TR 20,6,32
TR 22,6,544
MAV 72,56,152
buffer_load_dwordx4 v[140:143], v4, s[16:19], s52 offen offset:1024 sc1
MAV 88,56,156
TR 24,6,64
MAV 92,60,156
TR 26,6,576
TR 28,6,96
MAV 76,60,152
TR 30,6,608
s_waitcnt vmcnt(20) lgkmcnt(8)
s_barrier
MAV 32,0,96
TR 32,7,8448
s_add_u32 m0, s55, 118272
MAV 48,0,100
buffer_load_dwordx4 v18, s[28:31], s54 offen lds
MAV 52,4,100
TR 34,7,8960
TR 36,7,8480
MAV 36,4,96
TR 38,7,8992
s_add_u32 s52, s53, 3014656
MAV 40,8,96
buffer_load_dwordx4 v[144:147], v4, s[16:19], s52 offen sc1
MAV 56,8,100
TR 40,7,8512
MAV 60,12,100
TR 42,7,9024
TR 44,7,8544
MAV 44,12,96
TR 46,7,9056
s_waitcnt lgkmcnt(8)
MAV 64,16,96
buffer_load_dwordx4 v19, s[28:31], s54 offen offset:1056 lds
MAV 80,16,100
s_mov_b32 s54, 3604480
MAV 84,20,100
TR 48,6,8448
TR 50,6,8960
MAV 68,20,96
TR 52,6,8480
TR 54,6,8992
MAV 72,24,96
buffer_load_dwordx4 v[148:151], v4, s[16:19], s52 offen offset:1024 sc1
MAV 88,24,100
TR 56,6,8512
MAV 92,28,100
TR 58,6,9024
TR 60,6,8544
MAV 76,28,96
TR 62,6,9056
s_waitcnt vmcnt(20) lgkmcnt(8)
MAV 32,32,104
TR 0,7,16896
s_add_u32 m0, s55, 126720
MAV 48,32,108
buffer_load_dwordx4 v18, s[28:31], s54 offen lds
MAV 52,36,108
TR 2,7,17408
TR 4,7,16928
MAV 36,36,104
TR 6,7,17440
s_add_u32 s52, s53, 3538944
MAV 40,40,104
buffer_load_dwordx4 v[152:155], v4, s[16:19], s52 offen sc1
MAV 56,40,108
TR 8,7,16960
MAV 60,44,108
TR 10,7,17472
TR 12,7,16992
MAV 44,44,104
TR 14,7,17504
s_waitcnt lgkmcnt(8)
MAV 64,48,104
buffer_load_dwordx4 v19, s[28:31], s54 offen offset:1056 lds
MAV 80,48,108
s_mov_b32 s54, 196608
MAV 84,52,108
TR 16,6,16896
TR 18,6,17408
MAV 68,52,104
TR 20,6,16928
TR 22,6,17440
MAV 72,56,104
buffer_load_dwordx4 v[156:159], v4, s[16:19], s52 offen offset:1024 sc1
MAV 88,56,108
TR 24,6,16960
MAV 92,60,108
TR 26,6,17472
TR 28,6,16992
MAV 76,60,104
TR 30,6,17504
s_waitcnt vmcnt(20) lgkmcnt(8)
s_barrier
MAV 32,0,112
TR 32,7,25344
s_add_u32 m0, s55, 0
MAV 48,0,116
buffer_load_dwordx4 v18, s[28:31], s54 offen lds
MAV 52,4,116
TR 34,7,25856
TR 36,7,25376
MAV 36,4,112
TR 38,7,25888
s_add_u32 s52, s53, 3932160
MAV 40,8,112
buffer_load_dwordx4 v[96:99], v4, s[16:19], s52 offen sc1
MAV 56,8,116
TR 40,7,25408
MAV 60,12,116
TR 42,7,25920
TR 44,7,25440
MAV 44,12,112
TR 46,7,25952
s_waitcnt lgkmcnt(8)
MAV 64,16,112
buffer_load_dwordx4 v19, s[28:31], s54 offen offset:1056 lds
MAV 80,16,116
s_mov_b32 s54, 655360
MAV 84,20,116
TR 48,6,25344
TR 50,6,25856
MAV 68,20,112
TR 52,6,25376
TR 54,6,25888
MAV 72,24,112
buffer_load_dwordx4 v[100:103], v4, s[16:19], s52 offen offset:1024 sc1
MAV 88,24,116
TR 56,6,25408
MAV 92,28,116
TR 58,6,25920
TR 60,6,25440
MAV 76,28,112
TR 62,6,25952
s_waitcnt vmcnt(20) lgkmcnt(8)
MAV 32,32,120
TR 0,7,33792
s_add_u32 m0, s55, 8448
MAV 48,32,124
buffer_load_dwordx4 v18, s[28:31], s54 offen lds
MAV 52,36,124
TR 2,7,34304
TR 4,7,33824
MAV 36,36,120
TR 6,7,34336
s_add_u32 s52, s53, 4456448
MAV 40,40,120
buffer_load_dwordx4 v[104:107], v4, s[16:19], s52 offen sc1
MAV 56,40,124
TR 8,7,33856
MAV 60,44,124
TR 10,7,34368
TR 12,7,33888
MAV 44,44,120
TR 14,7,34400
s_waitcnt lgkmcnt(8)
MAV 64,48,120
buffer_load_dwordx4 v19, s[28:31], s54 offen offset:1056 lds
MAV 80,48,124
s_mov_b32 s54, 1114112
MAV 84,52,124
TR 16,6,33792
TR 18,6,34304
MAV 68,52,120
TR 20,6,33824
TR 22,6,34336
MAV 72,56,120
buffer_load_dwordx4 v[108:111], v4, s[16:19], s52 offen offset:1024 sc1
MAV 88,56,124
TR 24,6,33856
MAV 92,60,124
TR 26,6,34368
TR 28,6,33888
MAV 76,60,120
TR 30,6,34400
s_waitcnt vmcnt(20) lgkmcnt(8)
s_barrier
MAV 32,0,128
TR 32,7,42240
s_add_u32 m0, s55, 16896
MAV 48,0,132
buffer_load_dwordx4 v18, s[28:31], s54 offen lds
MAV 52,4,132
TR 34,7,42752
TR 36,7,42272
MAV 36,4,128
TR 38,7,42784
s_add_u32 s52, s53, 4849664
MAV 40,8,128
buffer_load_dwordx4 v[112:115], v4, s[16:19], s52 offen sc1
MAV 56,8,132
TR 40,7,42304
MAV 60,12,132
TR 42,7,42816
TR 44,7,42336
MAV 44,12,128
TR 46,7,42848
s_waitcnt lgkmcnt(8)
MAV 64,16,128
buffer_load_dwordx4 v19, s[28:31], s54 offen offset:1056 lds
MAV 80,16,132
s_mov_b32 s54, 1572864
MAV 84,20,132
TR 48,6,42240
TR 50,6,42752
MAV 68,20,128
TR 52,6,42272
TR 54,6,42784
MAV 72,24,128
buffer_load_dwordx4 v[116:119], v4, s[16:19], s52 offen offset:1024 sc1
MAV 88,24,132
TR 56,6,42304
MAV 92,28,132
TR 58,6,42816
TR 60,6,42336
MAV 76,28,128
TR 62,6,42848
s_waitcnt vmcnt(20) lgkmcnt(8)
MAV 32,32,136
TR 0,7,50688
s_add_u32 m0, s55, 25344
MAV 48,32,140
buffer_load_dwordx4 v18, s[28:31], s54 offen lds
MAV 52,36,140
TR 2,7,51200
TR 4,7,50720
MAV 36,36,136
TR 6,7,51232
s_add_u32 s52, s53, 5373952
MAV 40,40,136
buffer_load_dwordx4 v[120:123], v4, s[16:19], s52 offen sc1
MAV 56,40,140
TR 8,7,50752
MAV 60,44,140
TR 10,7,51264
TR 12,7,50784
MAV 44,44,136
TR 14,7,51296
.Lpad27:
s_cbranch_execz .Lnopoll68r
s_waitcnt lgkmcnt(8)
MAV 64,48,136
buffer_load_dwordx4 v19, s[28:31], s54 offen offset:1056 lds
MAV 80,48,140
s_mov_b32 s54, 2031616
MAV 84,52,140
TR 16,6,50688
TR 18,6,51200
MAV 68,52,136
TR 20,6,50720
TR 22,6,51232
MAV 72,56,136
buffer_load_dwordx4 v[124:127], v4, s[16:19], s52 offen offset:1024 sc1
MAV 88,56,140
TR 24,6,50752
MAV 92,60,140
TR 26,6,51264
TR 28,6,50784
MAV 76,60,136
TR 30,6,51296
s_waitcnt vmcnt(20) lgkmcnt(8)
s_barrier
MAV 32,0,144
TR 32,7,59136
s_add_u32 m0, s55, 33792
MAV 48,0,148
buffer_load_dwordx4 v18, s[28:31], s54 offen lds
MAV 52,4,148
TR 34,7,59648
TR 36,7,59168
MAV 36,4,144
TR 38,7,59680
s_add_u32 s52, s53, 5767168
MAV 40,8,144
buffer_load_dwordx4 v[128:131], v4, s[16:19], s52 offen sc1
MAV 56,8,148
TR 40,7,59200
MAV 60,12,148
TR 42,7,59712
TR 44,7,59232
MAV 44,12,144
TR 46,7,59744
s_waitcnt lgkmcnt(8)
MAV 64,16,144
buffer_load_dwordx4 v19, s[28:31], s54 offen offset:1056 lds
MAV 80,16,148
s_mov_b32 s54, 2490368
MAV 84,20,148
TR 48,6,59136
TR 50,6,59648
MAV 68,20,144
TR 52,6,59168
TR 54,6,59680
MAV 72,24,144
buffer_load_dwordx4 v[132:135], v4, s[16:19], s52 offen offset:1024 sc1
MAV 88,24,148
TR 56,6,59200
MAV 92,28,148
TR 58,6,59712
TR 60,6,59232
MAV 76,28,144
TR 62,6,59744
v_add_u32 v7, s57, v7
v_add_u32 v6, s57, v6
s_sub_u32 s57, 0, s57
s_waitcnt vmcnt(20) lgkmcnt(8)
MAV 32,32,152
ds_read_b64_tr_b16 a[0:1], v6
s_add_u32 m0, s55, 42240
MAV 48,32,156
buffer_load_dwordx4 v18, s[28:31], s54 offen lds
MAV 52,36,156
TR 2,6,512
TR 4,6,32
MAV 36,36,152
TR 6,6,544
s_add_u32 s52, s53, 6291456
MAV 40,40,152
buffer_load_dwordx4 v[136:139], v4, s[16:19], s52 offen sc1
MAV 56,40,156
TR 8,6,64
MAV 60,44,156
TR 10,6,576
TR 12,6,96
MAV 44,44,152
TR 14,6,608
s_waitcnt lgkmcnt(8)
MAV 64,48,152
buffer_load_dwordx4 v19, s[28:31], s54 offen offset:1056 lds
MAV 80,48,156
s_mov_b32 s54, 2949120
MAV 84,52,156
TR 16,6,8448
TR 18,6,8960
MAV 68,52,152
TR 20,6,8480
TR 22,6,8992
MAV 72,56,152
buffer_load_dwordx4 v[140:143], v4, s[16:19], s52 offen offset:1024 sc1
MAV 88,56,156
TR 24,6,8512
MAV 92,60,156
TR 26,6,9024
TR 28,6,8544
MAV 76,60,152
TR 30,6,9056
s_waitcnt vmcnt(20) lgkmcnt(8)
s_barrier
MAV 64,0,96
TR 32,6,16896
TR 34,6,17408
s_add_u32 m0, s55, 50688
MAV 80,0,100
TR 36,6,16928
buffer_load_dwordx4 v18, s[28:31], s54 offen lds
MAV 84,4,100
buffer_load_dwordx4 v19, s[28:31], s54 offen offset:1056 lds
MAV 68,4,96
TR 38,6,17440
s_mov_b32 s54, 3407872
s_add_u32 s52, s53, 6684672
MAV 72,8,96
TR 40,6,16960
buffer_load_dwordx4 v[144:147], v4, s[16:19], s52 offen sc1
MAV 88,8,100
TR 42,6,17472
MAV 92,12,100
TR 44,6,16992
buffer_load_dwordx4 v[148:151], v4, s[16:19], s52 offen offset:1024 sc1
MAV 76,12,96
TR 46,6,17504
s_add_u32 m0, s55, 59136
s_waitcnt vmcnt(20) lgkmcnt(8)
MAV 64,16,104
buffer_load_dwordx4 v18, s[28:31], s54 offen lds
MAV 80,16,108
TR 48,6,25344
TR 50,6,25856
MAV 84,20,108
TR 52,6,25376
buffer_load_dwordx4 v19, s[28:31], s54 offen offset:1056 lds
MAV 68,20,104
TR 54,6,25888
s_add_u32 s52, s53, 7208960
MAV 72,24,104
TR 56,6,25408
buffer_load_dwordx4 v[152:155], v4, s[16:19], s52 offen sc1
MAV 88,24,108
TR 58,6,25920
MAV 92,28,108
TR 60,6,25440
buffer_load_dwordx4 v[156:159], v4, s[16:19], s52 offen offset:1024 sc1
MAV 76,28,104
TR 62,6,25952
s_waitcnt vmcnt(20) lgkmcnt(8)
MAV 64,32,112
TR 0,6,33792
s_add_u32 s52, s53, 393216
s_lshl_b32 s70, s2, 10
MAV 80,32,116
buffer_load_dwordx4 v[160:163], v4, s[16:19], s52 offen sc1
s_lshl_b32 s62, s3, 7
MAV 84,36,116
TR 2,6,34304
TR 4,6,33824
MAV 68,36,112
TR 6,6,34336
s_add_u32 s70, s70, s62
s_add_u32 s70, s70, 31457792
MAV 72,40,112
buffer_load_dwordx4 v[164:167], v4, s[16:19], s52 offen offset:1024 sc1
s_xor_b32 s71, s70, 1024
MAV 88,40,116
TR 8,6,33856
TR 10,6,34368
MAV 92,44,116
TR 12,6,33888
v_min_u32 v12, 1, v1
v_lshlrev_b32 v12, 28, v12
MAV 76,44,112
TR 14,6,34400
s_add_u32 s52, s53, 1310720
s_waitcnt vmcnt(18) lgkmcnt(8)
MAV 64,48,120
buffer_load_dwordx4 v[168:171], v4, s[16:19], s52 offen sc1
v_mov_b32 v13, 1
MAV 80,48,124
TR 16,6,42240
v_mov_b32 v15, 0
s_lshl_b32 s68, s7, 18
MAV 84,52,124
TR 18,6,42752
TR 20,6,42272
MAV 68,52,120
TR 22,6,42784
s_add_u32 s68, s68, 146800640
s_xor_b32 s69, s68, 262144
MAV 72,56,120
buffer_load_dwordx4 v[172:175], v4, s[16:19], s52 offen offset:1024 sc1
v_mov_b32 v11, v4
MAV 88,56,124
TR 24,6,42304
TR 26,6,42816
MAV 92,60,124
TR 28,6,42336
v_and_b32 v2, 1, v1
v_lshlrev_b32 v2, 4, v2
MAV 76,60,120
TR 30,6,42848
v_mov_b32 v224, 0x3f80
s_waitcnt vmcnt(16) lgkmcnt(8)
MAV 64,0,128
TR 32,6,50688
s_add_u32 s52, s53, 2228224
v_lshlrev_b32 v2, v2, v224
MAV 80,0,132
buffer_load_dwordx4 v[176:179], v4, s[16:19], s52 offen sc1
v_bfe_u32 v224, v1, 2, 2
MAV 84,4,132
TR 34,6,51200
TR 36,6,50720
MAV 68,4,128
TR 38,6,51232
v_lshrrev_b32 v225, 4, v1
v_cmp_eq_u32 vcc, v224, v225
MAV 72,8,128
buffer_load_dwordx4 v[180:183], v4, s[16:19], s52 offen offset:1024 sc1
v_cndmask_b32 v2, 0, v2, vcc
MAV 88,8,132
TR 40,6,50752
TR 42,6,51264
MAV 92,12,132
TR 44,6,50784
v_and_b32 v224, 2, v1
v_cmp_eq_u32 vcc, 0, v224
MAV 76,12,128
TR 46,6,51296
s_add_u32 s52, s53, 3145728
s_waitcnt vmcnt(14) lgkmcnt(8)
MAV 64,16,136
buffer_load_dwordx4 v[184:187], v4, s[16:19], s52 offen sc1
v_cndmask_b32 v226, 0, v2, vcc
MAV 80,16,140
TR 48,6,59136
v_cndmask_b32 v227, v2, 0, vcc
v_mov_b32 v224, 0
MAV 84,20,140
TR 50,6,59648
TR 52,6,59168
MAV 68,20,136
TR 54,6,59680
v_mov_b32 v225, 0
v_mov_b32 v228, 0
MAV 72,24,136
buffer_load_dwordx4 v[188:191], v4, s[16:19], s52 offen offset:1024 sc1
v_mov_b32 v229, 0
MAV 88,24,140
TR 56,6,59200
TR 58,6,59712
MAV 92,28,140
TR 60,6,59232
s_lshr_b32 s62, s6, 1
s_lshl_b32 s62, s62, 8
MAV 76,28,136
TR 62,6,59744
s_and_b32 s63, s6, 1
s_waitcnt vmcnt(10) lgkmcnt(8)
s_barrier
v_add_u32 v6, s57, v6
MAV 64,32,144
ds_read_b64_tr_b16 a[0:1], v6
s_add_u32 s52, s53, 4063232
s_add_u32 s62, s62, s63
MAV 80,32,148
buffer_load_dwordx4 v[192:195], v4, s[16:19], s52 offen sc1
s_lshl_b32 s63, s3, 6
MAV 84,36,148
TR 2,6,512
TR 4,6,32
MAV 68,36,144
TR 6,6,544
s_add_u32 s62, s62, s63
s_lshl_b32 s62, s62, 11
MAV 72,40,144
buffer_load_dwordx4 v[196:199], v4, s[16:19], s52 offen offset:1024 sc1
s_lshl_b32 s63, s7, 7
MAV 88,40,148
TR 8,6,64
TR 10,6,576
MAV 92,44,148
TR 12,6,96
s_add_u32 s62, s62, s63
v_and_b32 v16, 15, v1
MAV 76,44,144
TR 14,6,608
s_add_u32 s52, s53, 4980736
s_waitcnt vmcnt(10) lgkmcnt(8)
MAV 64,48,152
buffer_load_dwordx4 v[200:203], v4, s[16:19], s52 offen sc1
v_lshlrev_b32 v16, 12, v16
MAV 80,48,156
TR 16,6,8448
v_bfe_u32 v2, v1, 4, 1
v_lshl_add_u32 v16, v2, 5, v16
MAV 84,52,156
TR 18,6,8960
TR 20,6,8480
MAV 68,52,152
TR 22,6,8992
v_bfe_u32 v2, v1, 5, 1
v_lshl_add_u32 v16, v2, 4, v16
MAV 72,56,152
buffer_load_dwordx4 v[204:207], v4, s[16:19], s52 offen offset:1024 sc1
v_add_u32 v16, s62, v16
MAV 88,56,156
TR 24,6,8512
TR 26,6,9024
MAV 92,60,156
TR 28,6,8544
v_add_u32 v17, 0x10000, v16
v_accvgpr_read_b32 v28, a224
MAV 76,60,152
TR 30,6,9056
v_add_f32 v32, v32, v28
s_waitcnt vmcnt(10) lgkmcnt(8)
MAV 64,0,160
TR 32,6,16896
s_add_u32 s52, s53, 5898240
v_accvgpr_read_b32 v29, a225
MAV 80,0,164
buffer_load_dwordx4 v[208:211], v4, s[16:19], s52 offen sc1
v_add_f32 v33, v33, v29
MAV 84,4,164
TR 34,6,17408
TR 36,6,16928
MAV 68,4,160
TR 38,6,17440
v_accvgpr_read_b32 v28, a226
v_add_f32 v34, v34, v28
MAV 72,8,160
buffer_load_dwordx4 v[212:215], v4, s[16:19], s52 offen offset:1024 sc1
v_accvgpr_read_b32 v29, a227
MAV 88,8,164
TR 40,6,16960
TR 42,6,17472
MAV 92,12,164
TR 44,6,16992
v_add_f32 v35, v35, v29
v_accvgpr_read_b32 v28, a228
MAV 76,12,160
TR 46,6,17504
s_add_u32 s52, s53, 6815744
s_waitcnt vmcnt(10) lgkmcnt(8)
MAV 64,16,168
buffer_load_dwordx4 v[216:219], v4, s[16:19], s52 offen sc1
v_add_f32 v36, v36, v28
MAV 80,16,172
TR 48,6,25344
v_accvgpr_read_b32 v29, a229
v_add_f32 v37, v37, v29
MAV 84,20,172
TR 50,6,25856
TR 52,6,25376
MAV 68,20,168
TR 54,6,25888
v_accvgpr_read_b32 v28, a230
v_add_f32 v38, v38, v28
MAV 72,24,168
buffer_load_dwordx4 v[220:223], v4, s[16:19], s52 offen offset:1024 sc1
v_accvgpr_read_b32 v29, a231
MAV 88,24,172
TR 56,6,25408
TR 58,6,25920
MAV 92,28,172
TR 60,6,25440
v_add_f32 v39, v39, v29
v_accvgpr_read_b32 v28, a232
MAV 76,28,168
TR 62,6,25952
v_add_f32 v40, v40, v28
s_waitcnt vmcnt(10) lgkmcnt(8)
MAV 64,32,176
TR 0,6,33792
v_accvgpr_read_b32 v29, a233
v_add_f32 v41, v41, v29
MAV 80,32,180
TR 2,6,34304
v_accvgpr_read_b32 v28, a234
MAV 84,36,180
TR 4,6,33824
v_add_f32 v42, v42, v28
MAV 68,36,176
TR 6,6,34336
v_accvgpr_read_b32 v29, a235
MAV 72,40,176
TR 8,6,33856
v_add_f32 v43, v43, v29
MAV 88,40,180
TR 10,6,34368
v_accvgpr_read_b32 v28, a236
MAV 92,44,180
TR 12,6,33888
v_add_f32 v44, v44, v28
MAV 76,44,176
TR 14,6,34400
s_waitcnt vmcnt(8) lgkmcnt(8)
MAV 64,48,184
TR 16,6,42240
v_accvgpr_read_b32 v29, a237
MAV 80,48,188
TR 18,6,42752
v_add_f32 v45, v45, v29
MAV 84,52,188
TR 20,6,42272
v_accvgpr_read_b32 v28, a238
MAV 68,52,184
TR 22,6,42784
v_add_f32 v46, v46, v28
MAV 72,56,184
TR 24,6,42304
v_accvgpr_read_b32 v29, a239
MAV 88,56,188
TR 26,6,42816
v_add_f32 v47, v47, v29
MAV 92,60,188
TR 28,6,42336
v_accvgpr_read_b32 v28, a240
MAV 76,60,184
TR 30,6,42848
v_add_f32 v48, v48, v28
s_waitcnt vmcnt(6) lgkmcnt(8)
MAV 64,0,192
TR 32,6,50688
v_accvgpr_read_b32 v29, a241
v_add_f32 v49, v49, v29
MAV 80,0,196
TR 34,6,51200
v_accvgpr_read_b32 v28, a242
MAV 84,4,196
TR 36,6,50720
v_add_f32 v50, v50, v28
MAV 68,4,192
TR 38,6,51232
v_accvgpr_read_b32 v29, a243
MAV 72,8,192
TR 40,6,50752
v_add_f32 v51, v51, v29
MAV 88,8,196
TR 42,6,51264
v_accvgpr_read_b32 v28, a244
MAV 92,12,196
TR 44,6,50784
v_add_f32 v52, v52, v28
MAV 76,12,192
TR 46,6,51296
s_waitcnt vmcnt(4) lgkmcnt(8)
MAV 64,16,200
TR 48,6,59136
v_accvgpr_read_b32 v29, a245
MAV 80,16,204
TR 50,6,59648
v_add_f32 v53, v53, v29
MAV 84,20,204
TR 52,6,59168
v_accvgpr_read_b32 v28, a246
MAV 68,20,200
TR 54,6,59680
v_add_f32 v54, v54, v28
MAV 72,24,200
TR 56,6,59200
v_accvgpr_read_b32 v29, a247
MAV 88,24,204
TR 58,6,59712
v_add_f32 v55, v55, v29
MAV 92,28,204
TR 60,6,59232
v_accvgpr_read_b32 v28, a248
MAV 76,28,200
TR 62,6,59744
v_add_f32 v56, v56, v28
s_waitcnt vmcnt(2) lgkmcnt(8)
MAV 64,32,208
ds_read_b64_tr_b16 a[0:1], v7
v_accvgpr_read_b32 v29, a249
MAV 80,32,212
TR 2,7,512
v_add_f32 v57, v57, v29
MAV 84,36,212
TR 4,7,32
v_accvgpr_read_b32 v28, a250
MAV 68,36,208
TR 6,7,544
v_add_f32 v58, v58, v28
MAV 72,40,208
TR 8,7,64
v_accvgpr_read_b32 v29, a251
MAV 88,40,212
TR 10,7,576
v_add_f32 v59, v59, v29
MAV 92,44,212
TR 12,7,96
v_accvgpr_read_b32 v28, a252
MAV 76,44,208
TR 14,7,608
s_waitcnt vmcnt(0) lgkmcnt(8)
MAV 64,48,216
TR 16,7,8448
v_add_f32 v60, v60, v28
MAV 80,48,220
TR 18,7,8960
v_accvgpr_read_b32 v29, a253
MAV 84,52,220
TR 20,7,8480
v_add_f32 v61, v61, v29
MAV 68,52,216
TR 22,7,8992
v_accvgpr_read_b32 v28, a254
MAV 72,56,216
TR 24,7,8512
v_add_f32 v62, v62, v28
MAV 88,56,220
TR 26,7,9024
v_accvgpr_read_b32 v29, a255
MAV 92,60,220
TR 28,7,8544
v_add_f32 v63, v63, v29
MAV 76,60,216
TR 30,7,9056
s_waitcnt lgkmcnt(8)
MAV 32,0,96
TR 32,7,16896
v_cvt_pk_bf16_f32 v232, v64, v65
v_cvt_pk_bf16_f32 v233, v66, v67
MAV 48,0,100
TR 34,7,17408
v_cvt_pk_bf16_f32 v234, v68, v69
MAV 52,4,100
TR 36,7,16928
v_cvt_pk_bf16_f32 v235, v70, v71
buffer_store_dwordx4 v[232:235], v11, s[16:19], s69 offen sc1
MAV 36,4,96
TR 38,7,17440
s_add_u32 s69, s69, 131072
MAV 40,8,96
TR 40,7,16960
v_cvt_pk_bf16_f32 v236, v72, v73
v_cvt_pk_bf16_f32 v237, v74, v75
MAV 56,8,100
TR 42,7,17472
v_cvt_pk_bf16_f32 v238, v76, v77
MAV 60,12,100
TR 44,7,16992
v_cvt_pk_bf16_f32 v239, v78, v79
buffer_store_dwordx4 v[236:239], v11, s[16:19], s69 offen sc1
MAV 44,12,96
TR 46,7,17504
s_add_u32 s69, s69, -130048
s_waitcnt lgkmcnt(8)
MAV 32,16,104
TR 48,7,25344
.Lpad28:
s_cbranch_execz .Lnopoll68r
v_cvt_pk_bf16_f32 v240, v80, v81
MAV 48,16,108
TR 50,7,25856
v_cvt_pk_bf16_f32 v241, v82, v83
v_cvt_pk_bf16_f32 v242, v84, v85
MAV 52,20,108
TR 52,7,25376
v_cvt_pk_bf16_f32 v243, v86, v87
MAV 36,20,104
TR 54,7,25888
buffer_store_dwordx4 v[240:243], v11, s[16:19], s69 offen sc1
s_add_u32 s69, s69, 131072
MAV 40,24,104
TR 56,7,25408
v_cvt_pk_bf16_f32 v244, v88, v89
MAV 56,24,108
TR 58,7,25920
v_cvt_pk_bf16_f32 v245, v90, v91
v_cvt_pk_bf16_f32 v246, v92, v93
MAV 60,28,108
TR 60,7,25440
v_cvt_pk_bf16_f32 v247, v94, v95
MAV 44,28,104
TR 62,7,25952
buffer_store_dwordx4 v[244:247], v11, s[16:19], s69 offen sc1
s_waitcnt lgkmcnt(8)
MAV 32,32,112
TR 0,7,33792
MAV 48,32,116
TR 2,7,34304
MAV 52,36,116
TR 4,7,33824
MAV 36,36,112
TR 6,7,34336
MAV 40,40,112
TR 8,7,33856
MAV 56,40,116
TR 10,7,34368
MAV 60,44,116
TR 12,7,33888
MAV 44,44,112
TR 14,7,34400
s_waitcnt lgkmcnt(8)
MAV 32,48,120
TR 16,7,42240
MAV 48,48,124
TR 18,7,42752
MAV 52,52,124
TR 20,7,42272
MAV 36,52,120
TR 22,7,42784
MAV 40,56,120
TR 24,7,42304
MAV 56,56,124
TR 26,7,42816
MAV 60,60,124
TR 28,7,42336
MAV 44,60,120
TR 30,7,42848
s_waitcnt lgkmcnt(8)
MAV 32,0,128
TR 32,7,50688
MAV 48,0,132
TR 34,7,51200
MAV 52,4,132
TR 36,7,50720
MAV 36,4,128
TR 38,7,51232
MAV 40,8,128
TR 40,7,50752
MAV 56,8,132
TR 42,7,51264
MAV 60,12,132
TR 44,7,50784
MAV 44,12,128
TR 46,7,51296
s_waitcnt lgkmcnt(8)
MAV 32,16,136
TR 48,7,59136
MAV 48,16,140
TR 50,7,59648
MAV 52,20,140
TR 52,7,59168
MAV 36,20,136
TR 54,7,59680
MAV 40,24,136
TR 56,7,59200
MAV 56,24,140
TR 58,7,59712
MAV 60,28,140
TR 60,7,59232
MAV 44,28,136
TR 62,7,59744
v_add_u32 v7, s57, v7
s_waitcnt lgkmcnt(8)
MAV 32,32,144
ds_read_b64_tr_b16 a[0:1], v7
TR 2,7,512
MAV 48,32,148
s_waitcnt vmcnt(0)
buffer_atomic_add v13, v12, s[16:19], s71 offen
MAV 52,36,148
TR 4,7,32
MAV 36,36,144
TR 6,7,544
MAV 40,40,144
TR 8,7,64
MAV 56,40,148
TR 10,7,576
MAV 60,44,148
TR 12,7,96
MAV 44,44,144
TR 14,7,608
s_waitcnt lgkmcnt(8)
MAV 32,48,152
TR 16,7,8448
MAV 48,48,156
TR 18,7,8960
MAV 52,52,156
TR 20,7,8480
MAV 36,52,152
TR 22,7,8992
MAV 40,56,152
TR 24,7,8512
MAV 56,56,156
TR 26,7,9024
MAV 60,60,156
TR 28,7,8544
MAV 44,60,152
TR 30,7,9056
s_waitcnt lgkmcnt(8)
MAV 32,0,160
TR 32,7,16896
TR 34,7,17408
MAV 48,0,164
buffer_atomic_add v15, v12, s[16:19], s70 offen sc0
MAV 52,4,164
TR 36,7,16928
MAV 36,4,160
TR 38,7,17440
MAV 40,8,160
TR 40,7,16960
MAV 56,8,164
TR 42,7,17472
MAV 60,12,164
TR 44,7,16992
MAV 44,12,160
TR 46,7,17504
s_waitcnt lgkmcnt(8)
MAV 32,16,168
TR 48,7,25344
MAV 48,16,172
TR 50,7,25856
MAV 52,20,172
TR 52,7,25376
MAV 36,20,168
TR 54,7,25888
MAV 40,24,168
TR 56,7,25408
MAV 56,24,172
TR 58,7,25920
MAV 60,28,172
TR 60,7,25440
MAV 44,28,168
TR 62,7,25952
s_waitcnt lgkmcnt(8)
MAV 32,32,176
TR 0,7,33792
MAV 48,32,180
TR 2,7,34304
MAV 52,36,180
TR 4,7,33824
MAV 36,36,176
TR 6,7,34336
MAV 40,40,176
TR 8,7,33856
MAV 56,40,180
TR 10,7,34368
MAV 60,44,180
TR 12,7,33888
MAV 44,44,176
TR 14,7,34400
s_waitcnt lgkmcnt(8)
MAV 32,48,184
TR 16,7,42240
MAV 48,48,188
TR 18,7,42752
MAV 52,52,188
TR 20,7,42272
MAV 36,52,184
TR 22,7,42784
MAV 40,56,184
TR 24,7,42304
MAV 56,56,188
TR 26,7,42816
MAV 60,60,188
TR 28,7,42336
MAV 44,60,184
TR 30,7,42848
s_waitcnt vmcnt(0)
v_cmp_ne_u32 vcc, 0, v15
s_nop 0
s_cbranch_vccz .Lxs73
.Lxs73b:
s_waitcnt lgkmcnt(8)
MAV 32,0,192
TR 32,7,50688
TR 34,7,51200
MAV 48,0,196
buffer_load_dwordx4 v[232:235], v11, s[16:19], s68 offen sc1
MAV 52,4,196
TR 36,7,50720
s_add_u32 s68, s68, 131072
MAV 36,4,192
TR 38,7,51232
MAV 40,8,192
buffer_load_dwordx4 v[236:239], v11, s[16:19], s68 offen sc1
MAV 56,8,196
TR 40,7,50752
s_add_u32 s68, s68, -130048
MAV 60,12,196
TR 42,7,51264
TR 44,7,50784
MAV 44,12,192
TR 46,7,51296
s_waitcnt lgkmcnt(8)
MAV 32,16,200
buffer_load_dwordx4 v[240:243], v11, s[16:19], s68 offen sc1
MAV 48,16,204
s_add_u32 s68, s68, 131072
MAV 52,20,204
TR 48,7,59136
TR 50,7,59648
MAV 36,20,200
TR 52,7,59168
TR 54,7,59680
MAV 40,24,200
buffer_load_dwordx4 v[244:247], v11, s[16:19], s68 offen sc1
MAV 56,24,204
TR 56,7,59200
MAV 60,28,204
TR 58,7,59712
TR 60,7,59232
MAV 44,28,200
TR 62,7,59744
s_waitcnt lgkmcnt(8)
MAV 32,32,208
MAV 48,32,212
MAV 52,36,212
MAV 36,36,208
MAV 40,40,208
MAV 56,40,212
MAV 60,44,212
MAV 44,44,208
s_waitcnt lgkmcnt(0)
MAV 32,48,216
MAV 48,48,220
MAV 52,52,220
MAV 36,52,216
MAV 40,56,216
MAV 56,56,220
MAV 60,60,220
MAV 44,60,216
s_waitcnt vmcnt(3)
v_mfma_f32_16x16x32_bf16 v[32:35], v[226:229], v[232:235], v[32:35]
v_mfma_f32_16x16x32_bf16 v[36:39], v[224:227], v[232:235], v[36:39]
s_waitcnt vmcnt(2)
v_mfma_f32_16x16x32_bf16 v[40:43], v[226:229], v[236:239], v[40:43]
s_nop 4
v_cvt_pk_bf16_f32 v128, v32, v33
v_cvt_pk_bf16_f32 v129, v34, v35
v_mfma_f32_16x16x32_bf16 v[44:47], v[224:227], v[236:239], v[44:47]
v_cvt_pk_bf16_f32 v130, v36, v37
v_cvt_pk_bf16_f32 v131, v38, v39
s_waitcnt vmcnt(1)
v_mfma_f32_16x16x32_bf16 v[48:51], v[226:229], v[240:243], v[48:51]
v_permlane16_swap_b32 v128, v130
v_mfma_f32_16x16x32_bf16 v[52:55], v[224:227], v[240:243], v[52:55]
v_permlane16_swap_b32 v129, v131
s_waitcnt vmcnt(0)
v_mfma_f32_16x16x32_bf16 v[56:59], v[226:229], v[244:247], v[56:59]
buffer_store_dwordx4 v[128:131], v16, s[36:39], 0 offen sc1
v_mfma_f32_16x16x32_bf16 v[60:63], v[224:227], v[244:247], v[60:63]
v_cvt_pk_bf16_f32 v132, v40, v41
v_cvt_pk_bf16_f32 v133, v42, v43
v_cvt_pk_bf16_f32 v134, v44, v45
v_cvt_pk_bf16_f32 v135, v46, v47
v_cvt_pk_bf16_f32 v136, v48, v49
v_permlane16_swap_b32 v132, v134
v_permlane16_swap_b32 v133, v135
v_cvt_pk_bf16_f32 v137, v50, v51
v_cvt_pk_bf16_f32 v138, v52, v53
buffer_store_dwordx4 v[132:135], v16, s[36:39], 0 offen offset:64 sc1
v_cvt_pk_bf16_f32 v139, v54, v55
v_permlane16_swap_b32 v136, v138
s_nop 0
v_permlane16_swap_b32 v137, v139
v_cvt_pk_bf16_f32 v140, v56, v57
v_cvt_pk_bf16_f32 v141, v58, v59
v_cvt_pk_bf16_f32 v142, v60, v61
v_cvt_pk_bf16_f32 v143, v62, v63
s_nop 0
v_permlane16_swap_b32 v140, v142
v_permlane16_swap_b32 v141, v143
buffer_store_dwordx4 v[136:139], v17, s[36:39], 0 offen sc1
buffer_store_dwordx4 v[140:143], v17, s[36:39], 0 offen offset:64 sc1
s_nop 1
.Lend:
s_endpgm
.Lsp71:
s_mov_b32 s15, 0
.Lsp71l:
v_mov_b32 v84, 0
buffer_atomic_add v84, v69, s[16:19], s73 offen offset:512 sc0
s_add_u32 s15, s15, 1
s_cmp_gt_u32 s15, 100000
s_waitcnt vmcnt(0)
s_cbranch_scc1 .Lsp71b
v_cmp_gt_u32 vcc, v70, v84
s_nop 0
s_cbranch_vccnz .Lsp71l
s_branch .Lsp71b
.Lsp72:
s_mov_b32 s15, 0
.Lsp72l:
v_mov_b32 v25, 0
buffer_atomic_add v25, v22, s[16:19], s73 offen sc0
s_add_u32 s15, s15, 1
s_cmp_gt_u32 s15, 100000
s_waitcnt vmcnt(0)
s_cbranch_scc1 .Lsp72b
v_cmp_gt_u32 vcc, v23, v25
s_nop 0
s_cbranch_vccnz .Lsp72l
s_branch .Lsp72b
.Lxs73:
s_mov_b32 s15, 0
.Lxs73l:
v_mov_b32 v15, 0
buffer_atomic_add v15, v12, s[16:19], s70 offen sc0
s_add_u32 s15, s15, 1
s_cmp_gt_u32 s15, 100000
s_waitcnt vmcnt(0)
s_cbranch_scc1 .Lxs73b
v_cmp_ne_u32 vcc, 0, v15
s_nop 0
s_cbranch_vccz .Lxs73l
s_branch .Lxs73b
.section .rodata,"a"
.p2align 6
.amdhsa_kernel interleave_layers__sliding_local_dilated__swiglu_ffn__prompt_kernel
  .amdhsa_next_free_vgpr 512
  .amdhsa_next_free_sgpr 102
  .amdhsa_accum_offset 256
  .amdhsa_group_segment_fixed_size 0
  .amdhsa_kernarg_size 80
  .amdhsa_user_sgpr_count 2
  .amdhsa_user_sgpr_kernarg_segment_ptr 1
  .amdhsa_system_sgpr_workgroup_id_x 1
  .amdhsa_float_denorm_mode_32 3
.end_amdhsa_kernel
```

```asm
; @launch grid=(256,1,1) block=(256,1,1) lds=162560
.amdgcn_target "amdgcn-amd-amdhsa--gfx950"
.macro MAA d,a,b
v_mfma_f32_16x16x32_bf16 v[\d:\d+3], a[\a:\a+3], a[\b:\b+3], v[\d:\d+3]
.endm
.macro MAV d,a,b
v_mfma_f32_16x16x32_bf16 v[\d:\d+3], a[\a:\a+3], v[\b:\b+3], v[\d:\d+3]
.endm
.macro TR d,v,o
ds_read_b64_tr_b16 a[\d:\d+1], v\v offset:\o
.endm
.macro RD d,v,o
ds_read_b128 a[\d:\d+3], v\v offset:\o
.endm
.text
.globl interleave_layers__sliding_local_dilated__swiglu_ffn__prompt_kernel
.p2align 8
.type interleave_layers__sliding_local_dilated__swiglu_ffn__prompt_kernel,@function
interleave_layers__sliding_local_dilated__swiglu_ffn__prompt_kernel:
s_load_dwordx4 s[68:71], s[0:1], 0
s_load_dwordx2 s[72:73], s[0:1], 16
s_load_dwordx8 s[76:83], s[0:1], 32
s_load_dwordx4 s[84:87], s[0:1], 64
s_cmp_lt_u32 s2, 256
s_cbranch_scc1 .Lgo
s_endpgm
.p2align 12
.Lgo:
v_lshrrev_b32 v2, 6, v0
v_and_b32 v1, 63, v0
v_readfirstlane_b32 s3, v2
s_and_b32 s4, s2, 7
s_lshr_b32 s5, s2, 3
s_lshr_b32 s6, s4, 1
s_lshl_b32 s6, s6, 2
s_and_b32 s62, s5, 3
s_add_u32 s6, s6, s62
s_and_b32 s7, s4, 1
s_lshr_b32 s62, s5, 2
s_lshl_b32 s62, s62, 1
s_add_u32 s7, s7, s62
s_lshr_b32 s8, s4, 2
s_lshl_b32 s8, s8, 3
s_and_b32 s62, s5, 7
s_add_u32 s8, s8, s62
s_and_b32 s9, s4, 3
s_lshl_b32 s9, s9, 2
s_lshr_b32 s62, s5, 3
s_add_u32 s9, s9, s62
s_lshr_b32 s62, s6, 1
s_lshl_b32 s62, s62, 8
s_and_b32 s63, s6, 1
s_add_u32 s62, s62, s63
s_lshl_b32 s63, s3, 6
s_add_u32 s62, s62, s63
s_lshl_b32 s62, s62, 11
s_lshl_b32 s63, s7, 7
s_add_u32 s62, s62, s63
v_and_b32 v160, 15, v1
v_lshlrev_b32 v160, 12, v160
v_bfe_u32 v2, v1, 4, 1
v_lshl_add_u32 v160, v2, 5, v160
v_bfe_u32 v2, v1, 5, 1
v_lshl_add_u32 v160, v2, 4, v160
v_add_u32 v160, s62, v160
v_add_u32 v161, 0x10000, v160
s_sub_u32 s64, s3, 1
s_max_i32 s64, s64, 0
s_lshl_b32 s64, s64, 11
s_lshl_b32 s66, s9, 7
s_add_u32 s66, s66, s64
s_cmp_eq_u32 s3, 1
s_cselect_b32 s66, 8388608, s66
s_mul_i32 s65, s8, 122880
s_add_u32 s65, s65, s66
v_lshrrev_b32 v9, 1, v1
v_min_u32 v9, 19, v9
v_mul_u32_u24 v9, 6144, v9
s_waitcnt lgkmcnt(0)
s_mov_b32 s36, s68
s_mov_b32 s37, s69
s_mov_b32 s38, 4194304
s_mov_b32 s39, 0x20000
s_mov_b32 s16, s86
s_mov_b32 s17, s87
s_mov_b32 s18, 268435456
s_mov_b32 s19, 0x20000
s_xor_b32 s14, s3, 3
s_lshl_b32 s14, s14, 8
s_add_u32 s14, s14, s2
v_lshlrev_b32 v27, 4, v1
v_mov_b64 v[156:157], 0
v_mov_b64 v[158:159], 0
s_cmp_ge_u32 s14, 16
s_cbranch_scc1 .Lz1
s_lshl_b32 s62, s2, 13
s_add_u32 s62, s62, 30408704
s_add_u32 s63, s62, 4096
buffer_store_dwordx4 v[156:159], v27, s[16:19], s62 offen sc1
buffer_store_dwordx4 v[156:159], v27, s[16:19], s62 offen offset:1024 sc1
buffer_store_dwordx4 v[156:159], v27, s[16:19], s62 offen offset:2048 sc1
buffer_store_dwordx4 v[156:159], v27, s[16:19], s62 offen offset:3072 sc1
buffer_store_dwordx4 v[156:159], v27, s[16:19], s63 offen sc1
buffer_store_dwordx4 v[156:159], v27, s[16:19], s63 offen offset:1024 sc1
buffer_store_dwordx4 v[156:159], v27, s[16:19], s63 offen offset:2048 sc1
buffer_store_dwordx4 v[156:159], v27, s[16:19], s63 offen offset:3072 sc1
.Lz1:
buffer_load_dwordx4 v[128:131], v160, s[36:39], 0 offen
buffer_load_dwordx4 v[132:135], v160, s[36:39], 0 offen offset:64
buffer_load_dwordx4 v[136:139], v161, s[36:39], 0 offen
buffer_load_dwordx4 v[140:143], v161, s[36:39], 0 offen offset:64
s_mov_b32 s20, s70
s_mov_b32 s21, s71
s_mov_b32 s22, 6291456
s_mov_b32 s23, 0x20000
buffer_load_dword v58, v9, s[20:23], s65 offen
s_mov_b32 s40, s84
s_mov_b32 s41, s85
s_mov_b32 s42, 256
s_mov_b32 s43, 0x20000
s_getpc_b64 s[62:63]
.Lpc:
s_lshl_b32 s64, s5, 12
v_lshrrev_b32 v59, 3, v0
v_lshl_add_u32 v59, v59, 7, s64
v_add_u32 v2, 0x20000, v59
v_min_u32 v2, .Lend-.Lpc, v2
v_min_u32 v59, .Lend-.Lpc, v59
global_load_dword v59, v59, s[62:63]
global_load_dword v58, v2, s[62:63]
s_mov_b32 s24, s72
s_mov_b32 s25, s73
s_mov_b32 s26, 2097152
s_mov_b32 s27, 0x20000
s_mov_b32 s28, s80
s_mov_b32 s29, s81
s_mov_b32 s30, 7340032
s_mov_b32 s31, 0x20000
s_cmp_lt_u32 s3, 2
s_cselect_b32 s32, s76, s78
s_cselect_b32 s33, s77, s79
s_mov_b32 s34, 7340032
s_mov_b32 s35, 0x20000
s_lshr_b32 s10, s4, 2
s_lshl_b32 s10, s10, 2
s_and_b32 s62, s5, 3
s_add_u32 s10, s10, s62
s_and_b32 s11, s4, 3
s_lshl_b32 s11, s11, 3
s_lshr_b32 s62, s5, 2
s_add_u32 s11, s11, s62
s_and_b32 s12, s11, 1
s_lshr_b32 s13, s11, 1
s_mul_i32 s51, s13, 448
s_mul_i32 s62, s12, 192
s_add_u32 s51, s51, s62
s_and_b32 s48, s3, 1
s_lshr_b32 s49, s3, 1
s_lshl_b32 s50, s8, 3
s_sub_u32 s50, s50, 9
s_cmp_lt_u32 s8, 2
s_cselect_b32 s50, 7, s50
s_lshl_b32 s62, s6, 3
s_lshr_b32 s84, s62, 4
s_lshl_b32 s84, s84, 19
s_and_b32 s62, s62, 15
s_lshl_b32 s62, s62, 10
s_add_u32 s84, s84, s62
s_lshl_b32 s62, s8, 3
s_lshr_b32 s85, s62, 4
s_lshl_b32 s85, s85, 19
s_and_b32 s62, s62, 15
s_lshl_b32 s62, s62, 10
s_add_u32 s85, s85, s62
s_lshl_b32 s62, s50, 0
s_lshr_b32 s86, s62, 4
s_lshl_b32 s86, s86, 19
s_and_b32 s62, s62, 15
s_lshl_b32 s62, s62, 10
s_add_u32 s86, s86, s62
s_mul_i32 s62, s8, 393216
s_add_u32 s62, s62, s66
v_mul_u32_u24 v14, 6144, v1
v_add_u32 v14, s62, v14
s_lshl_b32 s62, s8, 4
s_add_u32 s62, s62, s9
s_lshl_b32 s62, s62, 2
s_add_u32 s62, s62, s3
s_mul_i32 s62, s62, 6656
v_min_u32 v15, 51, v1
v_lshl_add_u32 v15, v15, 7, s62
s_sub_u32 s63, s8, 4
s_lshl_b32 s64, s8, 1
s_add_u32 s64, s64, 1
s_cmp_lt_u32 s8, 5
s_cselect_b64 vcc, -1, 0
s_cselect_b32 s46, s64, s63
v_cndmask_b32 v14, v14, v15, vcc
s_lshl_b32 s62, s2, 1
s_add_u32 s62, s62, s48
s_mul_i32 s62, s62, 5376
v_min_u32 v16, 41, v1
v_lshl_add_u32 v16, v16, 7, s62
s_cmp_lt_u32 s46, 6
s_cselect_b64 vcc, -1, 0
v_cndmask_b32 v15, v14, v16, vcc
v_cndmask_b32 v14, v16, v14, vcc
s_cmp_lt_u32 s8, 5
s_cselect_b32 s62, s24, s20
s_cselect_b32 s63, s25, s21
s_cselect_b32 s64, s26, s22
s_sub_u32 s47, s46, 6
s_cmp_lt_u32 s46, 6
s_cselect_b32 s47, s46, s47
s_cselect_b32 s76, s62, s32
s_cselect_b32 s98, s32, s62
s_cselect_b32 s77, s63, s33
s_cselect_b32 s99, s33, s63
s_cselect_b32 s78, s64, s34
s_cselect_b32 s100, s34, s64
s_mov_b32 s79, 0x20000
v_bfe_u32 v18, v1, 3, 1
v_bfe_u32 v2, v1, 5, 1
v_lshl_add_u32 v18, v2, 2, v18
v_and_b32 v2, 16, v1
v_add_u32 v18, v18, v2
s_lshl_b32 s62, s49, 2
s_add_u32 s62, s62, s48
s_lshl_b32 s62, s62, 1
v_add_u32 v18, s62, v18
v_mul_u32_u24 v18, 6144, v18
v_and_b32 v2, 7, v1
v_lshl_add_u32 v18, v2, 4, v18
s_lshl_b32 s62, s9, 7
v_add_u32 v18, s62, v18
v_add_u32 v19, 1024, v18
v_add_u32 v20, 2048, v18
s_mul_i32 s59, s3, 3104
s_mov_b32 s58, 0
s_lshr_b32 s62, s8, 1
s_lshl_b32 s62, s62, 8
s_and_b32 s67, s8, 1
s_add_u32 s62, s62, s67
s_lshl_b32 s62, s62, 11
s_lshl_b32 s63, s3, 17
s_add_u32 s62, s62, s63
v_lshrrev_b32 v2, 4, v1
v_xor_b32 v2, v2, v1
v_and_b32 v2, 7, v2
v_lshlrev_b32 v2, 4, v2
v_lshrrev_b32 v21, 3, v1
v_lshl_add_u32 v21, v21, 12, v2
v_add_u32 v21, s62, v21
v_xor_b32 v28, 64, v21
v_add_u32 v28, 31744, v28
s_lshr_b32 s63, s50, 3
s_lshr_b32 s62, s63, 1
s_lshl_b32 s62, s62, 8
s_and_b32 s67, s63, 1
s_add_u32 s62, s62, s67
s_lshl_b32 s62, s62, 11
s_lshl_b32 s63, s3, 14
s_add_u32 s62, s62, s63
s_add_u32 s62, s62, 456704
s_lshl_b32 s63, s3, 5
v_and_b32 v2, 31, v1
v_lshlrev_b32 v2, 2, v2
v_xor_b32 v2, s63, v2
v_lshrrev_b32 v22, 5, v1
v_lshl_add_u32 v22, v22, 12, v2
v_add_u32 v22, s62, v22
v_xor_b32 v29, 16, v22
v_add_u32 v29, -57344, v29
s_mov_b32 s52, 0
s_mov_b32 s53, 65536
s_mul_i32 s55, s3, 4608
s_mov_b32 s54, 0
s_mul_i32 s56, s3, 3104
v_bfe_u32 v24, v1, 1, 3
v_lshrrev_b32 v2, 4, v1
v_xor_b32 v2, v2, v24
v_lshlrev_b32 v2, 4, v2
v_and_b32 v23, 15, v1
v_lshl_add_u32 v23, v23, 7, v2
s_mul_i32 s62, s48, 9216
v_add_u32 v23, s62, v23
v_xor_b32 v30, 64, v23
v_mul_u32_u24 v24, 2304, v24
v_add_u32 v24, v24, v2
v_and_b32 v2, 1, v1
v_lshl_add_u32 v24, v2, 7, v24
v_add_u32 v24, 2048, v24
v_xor_b32 v31, 64, v24
v_and_b32 v2, 15, v1
v_cmp_eq_u32 vcc, 0, v2
v_mov_b32 v2, 18432
s_nop 0
v_cndmask_b32 v24, v24, v2, vcc
v_cndmask_b32 v31, v31, v2, vcc
v_bfe_u32 v25, v1, 3, 2
v_mul_u32_u24 v25, 3104, v25
v_bfe_u32 v2, v1, 2, 1
v_lshl_add_u32 v25, v2, 7, v25
v_bfe_u32 v2, v1, 5, 1
v_lshl_add_u32 v25, v2, 8, v25
v_and_b32 v2, 3, v1
v_lshl_add_u32 v25, v2, 3, v25
s_lshl_b32 s62, s49, 6
s_add_u32 s62, s62, 73984
v_add_u32 v25, s62, v25
s_lshl_b32 s62, s8, 1
s_add_u32 s62, s62, s3
s_lshr_b32 s63, s50, 2
s_cmp_lt_u32 s3, 2
s_cselect_b32 s62, s62, s63
s_lshl_b32 s62, s62, 13
s_cmp_eq_u32 s3, 3
s_cselect_b32 s62, 268435456, s62
v_lshl_add_u32 v26, v1, 4, s62
s_mul_i32 s59, s3, 2080
v_bfe_u32 v5, v1, 3, 1
v_lshrrev_b32 v2, 4, v1
v_lshl_add_u32 v5, v2, 3, v5
s_lshl_b32 s62, s3, 1
v_add_u32 v5, s62, v5
v_mul_u32_u24 v5, 2048, v5
v_and_b32 v2, 7, v1
v_lshl_add_u32 v5, v2, 4, v5
s_lshl_b32 s62, s7, 7
v_add_u32 v5, s62, v5
v_add_u32 v6, 64512, v5
s_lshl_b32 s62, s6, 10
s_add_u32 s62, s62, 30408704
s_lshl_b32 s64, s8, 10
s_add_u32 s64, s64, 30408704
s_lshr_b32 s67, s9, 1
s_and_b32 s67, s67, 3
s_lshl_b32 s67, s67, 7
s_add_u32 s64, s64, s67
s_lshr_b32 s65, s50, 3
s_lshl_b32 s65, s65, 10
s_add_u32 s65, s65, 30408704
s_lshr_b32 s67, s9, 1
s_and_b32 s67, s67, 3
s_lshl_b32 s67, s67, 7
s_add_u32 s65, s65, s67
v_mov_b32 v2, 268435456
v_cmp_eq_u32 vcc, 65, v0
v_mov_b32 v33, s65
s_nop 0
v_cndmask_b32 v33, v2, v33, vcc
v_cndmask_b32 v36, 0, 16, vcc
v_cmp_eq_u32 vcc, 64, v0
v_mov_b32 v32, s64
s_nop 0
v_cndmask_b32 v33, v33, v32, vcc
v_lshl_add_u32 v32, v1, 7, s62
v_cndmask_b32 v34, v2, 0, vcc
v_cndmask_b32 v35, 0, 16, vcc
v_cndmask_b32 v36, v36, 16, vcc
v_lshrrev_b32 v37, 3, v0
v_cmp_eq_u32 vcc, 8, v37
s_nop 1
v_cndmask_b32 v32, v2, v32, vcc
v_mov_b32 v38, 1
v_lshrrev_b32 v2, 4, v1
v_lshlrev_b32 v2, 2, v2
v_and_b32 v13, 15, v1
v_sub_u32 v2, v13, v2
v_mov_b32 v13, 0xff61b1e6
v_subrev_u32 v54, 0, v2
v_cmp_gt_u32 vcc, 8, v54
s_nop 1
v_cndmask_b32 v50, v13, 0, vcc
v_cmp_gt_i32 vcc, -8, v54
s_nop 1
v_cndmask_b32 v46, v13, 0, vcc
v_subrev_u32 v54, 1, v2
v_cmp_gt_u32 vcc, 8, v54
s_nop 1
v_cndmask_b32 v51, v13, 0, vcc
v_cmp_gt_i32 vcc, -8, v54
s_nop 1
v_cndmask_b32 v47, v13, 0, vcc
v_subrev_u32 v54, 2, v2
v_cmp_gt_u32 vcc, 8, v54
s_nop 1
v_cndmask_b32 v52, v13, 0, vcc
v_cmp_gt_i32 vcc, -8, v54
s_nop 1
v_cndmask_b32 v48, v13, 0, vcc
v_subrev_u32 v54, 3, v2
v_cmp_gt_u32 vcc, 8, v54
s_nop 1
v_cndmask_b32 v53, v13, 0, vcc
v_cmp_gt_i32 vcc, -8, v54
s_nop 1
v_cndmask_b32 v49, v13, 0, vcc
s_cmp_lt_u32 s8, 2
s_cselect_b64 vcc, -1, 0
v_cndmask_b32 v54, v46, v13, vcc
v_cndmask_b32 v55, v47, v13, vcc
v_cndmask_b32 v56, v48, v13, vcc
v_cndmask_b32 v57, v49, v13, vcc
s_mov_b32 s75, 29360128
v_and_b32 v10, 15, v1
v_lshlrev_b32 v12, 2, v10
v_lshlrev_b32 v10, 4, v10
v_add_u32 v10, 152576, v10
v_lshrrev_b32 v11, 4, v1
v_lshlrev_b32 v11, 4, v11
s_lshl_b32 s62, s49, 7
s_add_u32 s62, s62, 158720
v_add_u32 v12, s62, v12
v_add_u32 v13, s62, v11
v_add_u32 v11, 156672, v11
s_lshl_b32 s62, s3, 11
s_add_u32 s62, s62, 143360
v_lshl_add_u32 v8, v1, 4, s62
v_xor_b32 v9, 2048, v8
v_mov_b32 v248, 0x3f803f80
v_mov_b32 v249, 0x3f803f80
v_mov_b32 v250, 0x3f803f80
v_mov_b32 v251, 0x3f803f80
s_mul_i32 s62, s3, 18496
s_add_u32 s62, s62, 18432
v_mov_b32 v2, s62
ds_write_b128 v2, v[248:251]
v_and_b32 v7, 31, v1
v_lshrrev_b32 v2, 5, v1
v_lshl_add_u32 v7, v7, 1, v2
v_and_b32 v2, 0xc0, v0
v_add_u32 v7, v7, v2
v_lshlrev_b32 v17, 2, v7
v_add_u32 v17, 156672, v17
v_lshlrev_b32 v7, 4, v7
v_add_u32 v7, 152576, v7
s_lshl_b32 s74, s9, 1
s_add_u32 s74, s74, s49
s_lshl_b32 s74, s74, 14
s_add_u32 s74, s74, s85
s_lshl_b32 s63, s48, 12
s_add_u32 s74, s74, s63
s_add_u32 s74, s74, 4194304
s_mov_b32 s62, 0
v_lshl_add_u32 v4, v1, 4, s62
v_lshrrev_b32 v2, 3, v1
v_cmp_eq_u32 vcc, 3, v2
v_add_u32 v2, 67108480, v4
s_nop 0
v_cndmask_b32 v4, v4, v2, vcc
s_nop 1
s_cmp_eq_u32 s48, 1
s_cbranch_scc1 .Lqkv2
s_add_u32 m0, s55, 0
s_nop 0
buffer_load_dwordx4 v21, s[36:39], s52 offen lds
buffer_load_dwordx4 v28, s[36:39], s52 offen offset:1024 lds
buffer_load_dword v22, s[36:39], s52 offen offset:2048 lds
s_add_u32 s52, s52, 128
s_add_u32 m0, s55, 2304
s_nop 0
buffer_load_dwordx4 v21, s[36:39], s53 offen lds
buffer_load_dwordx4 v28, s[36:39], s53 offen offset:1024 lds
buffer_load_dword v29, s[36:39], s53 offen offset:2048 lds
s_add_u32 s53, s53, 128
s_add_u32 m0, s56, 123648
s_nop 0
buffer_load_dwordx4 v18, s[20:23], s54 offen lds
buffer_load_dwordx4 v19, s[20:23], s54 offen offset:1024 lds
buffer_load_dwordx4 v20, s[20:23], s54 offen offset:2048 lds
s_add_u32 s54, s54, 196608
s_add_u32 m0, s56, 136064
s_nop 0
buffer_load_dwordx4 v18, s[20:23], s54 offen lds
buffer_load_dwordx4 v19, s[20:23], s54 offen offset:1024 lds
buffer_load_dwordx4 v20, s[20:23], s54 offen offset:2048 lds
s_add_u32 s54, s54, 196608
s_waitcnt vmcnt(12)
s_cmp_lt_u32 s14, 16
s_cselect_b32 s62, 0, 4096
v_mov_b32 v154, 1
v_lshlrev_b32 v155, 8, v1
v_permlane16_swap_b32 v128, v130
v_permlane16_swap_b32 v129, v131
v_permlane16_swap_b32 v132, v134
v_permlane16_swap_b32 v133, v135
v_permlane16_swap_b32 v136, v138
v_permlane16_swap_b32 v137, v139
v_permlane16_swap_b32 v140, v142
v_permlane16_swap_b32 v141, v143
buffer_atomic_add v154, v155, s[40:43], s62 offen
v_lshlrev_b32 v64, 16, v128
v_and_b32 v65, 0xffff0000, v128
v_lshlrev_b32 v66, 16, v129
v_and_b32 v67, 0xffff0000, v129
v_lshlrev_b32 v68, 16, v130
v_and_b32 v69, 0xffff0000, v130
v_lshlrev_b32 v70, 16, v131
v_and_b32 v71, 0xffff0000, v131
v_lshlrev_b32 v72, 16, v132
v_and_b32 v73, 0xffff0000, v132
v_lshlrev_b32 v74, 16, v133
v_and_b32 v75, 0xffff0000, v133
v_lshlrev_b32 v76, 16, v134
v_and_b32 v77, 0xffff0000, v134
v_lshlrev_b32 v78, 16, v135
v_and_b32 v79, 0xffff0000, v135
v_lshlrev_b32 v80, 16, v136
v_and_b32 v81, 0xffff0000, v136
v_lshlrev_b32 v82, 16, v137
v_and_b32 v83, 0xffff0000, v137
v_lshlrev_b32 v84, 16, v138
v_and_b32 v85, 0xffff0000, v138
v_lshlrev_b32 v86, 16, v139
v_and_b32 v87, 0xffff0000, v139
v_lshlrev_b32 v88, 16, v140
v_and_b32 v89, 0xffff0000, v140
v_lshlrev_b32 v90, 16, v141
v_and_b32 v91, 0xffff0000, v141
v_lshlrev_b32 v92, 16, v142
v_and_b32 v93, 0xffff0000, v142
v_lshlrev_b32 v94, 16, v143
v_and_b32 v95, 0xffff0000, v143
s_lshl_b32 s64, s6, 14
s_lshl_b32 s65, s49, 13
s_add_u32 s64, s64, s65
s_lshl_b32 s65, s7, 9
s_add_u32 s64, s64, s65
s_lshl_b32 s65, s48, 8
s_add_u32 s64, s64, s65
s_add_u32 s64, s64, 29360128
v_and_b32 v152, 31, v1
v_lshlrev_b32 v152, 3, v152
v_lshrrev_b32 v153, 5, v1
v_lshl_add_u32 v152, v153, 28, v152
s_lshl_b32 s62, s7, 15
s_add_u32 s62, s62, 0
s_add_u32 s63, s62, 16384
v_pk_mul_f32 v[146:147], v[64:65], v[64:65]
v_pk_mul_f32 v[150:151], v[80:81], v[80:81]
v_pk_fma_f32 v[146:147], v[66:67], v[66:67], v[146:147]
v_pk_add_f32 v[144:145], v[64:65], v[66:67]
v_pk_fma_f32 v[150:151], v[82:83], v[82:83], v[150:151]
v_pk_add_f32 v[148:149], v[80:81], v[82:83]
v_pk_fma_f32 v[146:147], v[68:69], v[68:69], v[146:147]
v_pk_add_f32 v[144:145], v[144:145], v[68:69]
v_pk_fma_f32 v[150:151], v[84:85], v[84:85], v[150:151]
v_pk_add_f32 v[148:149], v[148:149], v[84:85]
v_pk_fma_f32 v[146:147], v[70:71], v[70:71], v[146:147]
v_pk_add_f32 v[144:145], v[144:145], v[70:71]
v_pk_fma_f32 v[150:151], v[86:87], v[86:87], v[150:151]
v_pk_add_f32 v[148:149], v[148:149], v[86:87]
v_pk_fma_f32 v[146:147], v[72:73], v[72:73], v[146:147]
v_pk_add_f32 v[144:145], v[144:145], v[72:73]
v_pk_fma_f32 v[150:151], v[88:89], v[88:89], v[150:151]
v_pk_add_f32 v[148:149], v[148:149], v[88:89]
v_pk_fma_f32 v[146:147], v[74:75], v[74:75], v[146:147]
v_pk_add_f32 v[144:145], v[144:145], v[74:75]
v_pk_fma_f32 v[150:151], v[90:91], v[90:91], v[150:151]
v_pk_add_f32 v[148:149], v[148:149], v[90:91]
v_pk_fma_f32 v[146:147], v[76:77], v[76:77], v[146:147]
v_pk_add_f32 v[144:145], v[144:145], v[76:77]
v_pk_fma_f32 v[150:151], v[92:93], v[92:93], v[150:151]
v_pk_add_f32 v[148:149], v[148:149], v[92:93]
v_pk_fma_f32 v[146:147], v[78:79], v[78:79], v[146:147]
v_pk_add_f32 v[144:145], v[144:145], v[78:79]
v_pk_fma_f32 v[150:151], v[94:95], v[94:95], v[150:151]
v_pk_add_f32 v[148:149], v[148:149], v[94:95]
v_add_f32 v144, v144, v145
v_add_f32 v146, v146, v147
v_add_f32 v148, v148, v149
v_add_f32 v150, v150, v151
s_nop 0
v_permlane16_swap_b32 v144, v148
v_permlane16_swap_b32 v146, v150
v_add_f32 v144, v144, v148
v_add_f32 v146, v146, v150
s_nop 1
v_permlane32_swap_b32 v144, v146
v_add_f32 v144, v144, v146
s_nop 1
v_permlane32_swap_b32 v144, v145
buffer_store_dwordx2 v[144:145], v152, s[16:19], s64 offen sc1
s_lshl_b32 s62, s2, 10
s_add_u32 s62, s62, 31457280
s_cmp_eq_u32 s3, 0
s_cselect_b32 s62, s62, 268435456
buffer_store_dwordx4 v[156:159], v27, s[16:19], s62 offen sc1
v_accvgpr_write_b32 a224, v64
v_accvgpr_write_b32 a225, v65
v_accvgpr_write_b32 a226, v66
v_accvgpr_write_b32 a227, v67
v_accvgpr_write_b32 a228, v68
v_accvgpr_write_b32 a229, v69
v_accvgpr_write_b32 a230, v70
v_accvgpr_write_b32 a231, v71
v_accvgpr_write_b32 a232, v72
v_accvgpr_write_b32 a233, v73
v_accvgpr_write_b32 a234, v74
v_accvgpr_write_b32 a235, v75
v_accvgpr_write_b32 a236, v76
v_accvgpr_write_b32 a237, v77
v_accvgpr_write_b32 a238, v78
v_accvgpr_write_b32 a239, v79
v_accvgpr_write_b32 a240, v80
v_accvgpr_write_b32 a241, v81
v_accvgpr_write_b32 a242, v82
v_accvgpr_write_b32 a243, v83
v_accvgpr_write_b32 a244, v84
v_accvgpr_write_b32 a245, v85
v_accvgpr_write_b32 a246, v86
v_accvgpr_write_b32 a247, v87
v_accvgpr_write_b32 a248, v88
v_accvgpr_write_b32 a249, v89
v_accvgpr_write_b32 a250, v90
v_accvgpr_write_b32 a251, v91
v_accvgpr_write_b32 a252, v92
v_accvgpr_write_b32 a253, v93
v_accvgpr_write_b32 a254, v94
v_accvgpr_write_b32 a255, v95
s_add_u32 m0, s55, 18496
s_nop 0
buffer_load_dwordx4 v21, s[36:39], s52 offen lds
buffer_load_dwordx4 v28, s[36:39], s52 offen offset:1024 lds
buffer_load_dword v22, s[36:39], s52 offen offset:2048 lds
s_add_u32 s52, s52, 128
s_add_u32 m0, s55, 20800
s_nop 0
buffer_load_dwordx4 v21, s[36:39], s53 offen lds
buffer_load_dwordx4 v28, s[36:39], s53 offen offset:1024 lds
buffer_load_dword v29, s[36:39], s53 offen offset:2048 lds
s_add_u32 s53, s53, 128
s_add_u32 m0, s56, 73984
s_nop 0
buffer_load_dwordx4 v18, s[20:23], s54 offen lds
buffer_load_dwordx4 v19, s[20:23], s54 offen offset:1024 lds
buffer_load_dwordx4 v20, s[20:23], s54 offen offset:2048 lds
s_add_u32 s54, s54, 196608
s_waitcnt vmcnt(15) lgkmcnt(0)
s_barrier
ds_read_b128 a[0:3], v23
RD 4,23,2304
RD 8,23,4608
RD 12,23,6912
TR 20,25,49664
TR 22,25,50176
TR 24,25,49696
TR 26,25,50208
ds_read_b128 a[16:19], v24
TR 28,25,50688
TR 30,25,51200
TR 32,25,50720
TR 34,25,51232
TR 36,25,51712
TR 38,25,52224
TR 40,25,51744
TR 42,25,52256
s_waitcnt vmcnt(12) lgkmcnt(8)
s_barrier
v_mfma_f32_16x16x32_bf16 v[60:63], a[20:23], a[0:3], 0
ds_read_b128 a[44:47], v30
s_add_u32 m0, s56, 86400
v_mfma_f32_16x16x32_bf16 v[76:79], a[24:27], a[0:3], 0
buffer_load_dwordx4 v18, s[20:23], s54 offen lds
v_mfma_f32_16x16x32_bf16 v[80:83], a[24:27], a[4:7], 0
s_sub_u32 s47, s47, 1
s_cbranch_scc1 .Lx4
.Lx4b:
v_mfma_f32_16x16x32_bf16 v[64:67], a[20:23], a[4:7], 0
buffer_load_dwordx4 v19, s[20:23], s54 offen offset:1024 lds
v_mfma_f32_16x16x32_bf16 v[68:71], a[20:23], a[8:11], 0
RD 48,30,2304
v_mfma_f32_16x16x32_bf16 v[84:87], a[24:27], a[8:11], 0
RD 52,30,4608
RD 56,30,6912
v_mfma_f32_16x16x32_bf16 v[88:91], a[24:27], a[12:15], 0
buffer_load_dwordx4 v20, s[20:23], s54 offen offset:2048 lds
v_mfma_f32_16x16x32_bf16 v[72:75], a[20:23], a[12:15], 0
s_add_u32 s54, s54, 196608
s_waitcnt lgkmcnt(4)
v_mfma_f32_16x16x32_bf16 v[244:247], a[20:23], a[16:19], 0
TR 64,25,62080
s_add_u32 m0, s55, 36992
v_mfma_f32_16x16x32_bf16 v[104:107], a[28:31], a[12:15], 0
buffer_load_dwordx4 v21, s[36:39], s52 offen lds
v_mfma_f32_16x16x32_bf16 v[120:123], a[32:35], a[12:15], 0
TR 66,25,62592
v_mfma_f32_16x16x32_bf16 v[116:119], a[32:35], a[8:11], 0
TR 68,25,62112
TR 70,25,62624
v_mfma_f32_16x16x32_bf16 v[100:103], a[28:31], a[8:11], 0
buffer_load_dwordx4 v28, s[36:39], s52 offen offset:1024 lds
v_mfma_f32_16x16x32_bf16 v[96:99], a[28:31], a[4:7], 0
ds_read_b128 a[60:63], v31
v_mfma_f32_16x16x32_bf16 v[112:115], a[32:35], a[4:7], 0
buffer_load_dword v22, s[36:39], s52 offen offset:2048 lds
v_mfma_f32_16x16x32_bf16 v[108:111], a[32:35], a[0:3], 0
TR 72,25,63104
s_add_u32 s52, s52, 128
v_mfma_f32_16x16x32_bf16 v[92:95], a[28:31], a[0:3], 0
s_add_u32 m0, s55, 39296
v_mfma_f32_16x16x32_bf16 v[156:159], a[28:31], a[16:19], 0
buffer_load_dwordx4 v21, s[36:39], s53 offen lds
v_mfma_f32_16x16x32_bf16 v[160:163], a[32:35], a[16:19], 0
TR 74,25,63616
TR 76,25,63136
v_mfma_f32_16x16x32_bf16 v[124:127], a[0:3], a[36:39], 0
TR 78,25,63648
v_mfma_f32_16x16x32_bf16 v[140:143], a[0:3], a[40:43], 0
buffer_load_dwordx4 v28, s[36:39], s53 offen offset:1024 lds
v_mfma_f32_16x16x32_bf16 v[144:147], a[4:7], a[40:43], 0
TR 80,25,64128
v_mfma_f32_16x16x32_bf16 v[128:131], a[4:7], a[36:39], 0
TR 82,25,64640
TR 84,25,64160
v_mfma_f32_16x16x32_bf16 v[132:135], a[8:11], a[36:39], 0
buffer_load_dword v29, s[36:39], s53 offen offset:2048 lds
v_mfma_f32_16x16x32_bf16 v[148:151], a[8:11], a[40:43], 0
s_add_u32 s53, s53, 128
v_mfma_f32_16x16x32_bf16 v[152:155], a[12:15], a[40:43], 0
TR 86,25,64672
v_mfma_f32_16x16x32_bf16 v[136:139], a[12:15], a[36:39], 0
s_waitcnt vmcnt(9) lgkmcnt(8)
s_barrier
MAA 60,64,44
RD 0,23,18496
s_add_u32 m0, s56, 98816
MAA 76,68,44
buffer_load_dwordx4 v18, s[20:23], s54 offen lds
MAA 80,68,48
RD 4,23,20800
MAA 64,64,48
buffer_load_dwordx4 v19, s[20:23], s54 offen offset:1024 lds
MAA 68,64,52
RD 8,23,23104
RD 12,23,25408
MAA 84,68,52
ds_read_b64_tr_b16 a[20:21], v25
MAA 88,68,56
buffer_load_dwordx4 v20, s[20:23], s54 offen offset:2048 lds
MAA 72,64,56
s_add_u32 s54, s54, 196608
s_waitcnt lgkmcnt(5)
MAA 244,64,60
TR 22,25,512
s_add_u32 m0, s56, 111232
MAA 104,72,56
buffer_load_dwordx4 v18, s[20:23], s54 offen lds
MAA 120,76,56
TR 24,25,32
MAA 116,76,52
TR 26,25,544
MAA 100,72,52
buffer_load_dwordx4 v19, s[20:23], s54 offen offset:1024 lds
MAA 96,72,48
RD 16,24,18496
TR 28,25,1024
MAA 112,76,48
buffer_load_dwordx4 v20, s[20:23], s54 offen offset:2048 lds
MAA 108,76,44
s_add_u32 s54, s54, 196608
MAA 92,72,44
TR 30,25,1536
s_add_u32 m0, s55, 55488
MAA 156,72,60
buffer_load_dwordx4 v21, s[36:39], s52 offen lds
MAA 160,76,60
TR 32,25,1056
MAA 124,44,80
TR 34,25,1568
MAA 140,44,84
buffer_load_dwordx4 v28, s[36:39], s52 offen offset:1024 lds
MAA 144,48,84
TR 36,25,2048
MAA 128,48,80
TR 38,25,2560
TR 40,25,2080
MAA 132,52,80
buffer_load_dword v22, s[36:39], s52 offen offset:2048 lds
MAA 148,52,84
s_add_u32 s52, s52, 128
MAA 152,56,84
TR 42,25,2592
MAA 136,56,80
s_waitcnt vmcnt(15) lgkmcnt(8)
s_barrier
MAA 60,20,0
RD 44,30,18496
s_add_u32 m0, s55, 57792
MAA 76,24,0
buffer_load_dwordx4 v21, s[36:39], s53 offen lds
MAA 80,24,4
s_sub_u32 s47, s47, 1
s_cbranch_scc1 .Lx5
.Lx5b:
MAA 64,20,4
buffer_load_dwordx4 v28, s[36:39], s53 offen offset:1024 lds
MAA 68,20,8
RD 48,30,20800
MAA 84,24,8
RD 52,30,23104
RD 56,30,25408
MAA 88,24,12
buffer_load_dword v29, s[36:39], s53 offen offset:2048 lds
MAA 72,20,12
s_add_u32 s53, s53, 128
s_waitcnt lgkmcnt(4)
MAA 244,20,16
TR 64,25,12416
s_add_u32 m0, s56, 123648
MAA 104,28,12
buffer_load_dwordx4 v18, s[20:23], s54 offen lds
MAA 120,32,12
TR 66,25,12928
MAA 116,32,8
TR 68,25,12448
TR 70,25,12960
MAA 100,28,8
buffer_load_dwordx4 v19, s[20:23], s54 offen offset:1024 lds
MAA 96,28,4
RD 60,31,18496
MAA 112,32,4
buffer_load_dwordx4 v20, s[20:23], s54 offen offset:2048 lds
MAA 108,32,0
TR 72,25,13440
s_add_u32 s54, s54, 196608
MAA 92,28,0
s_add_u32 m0, s56, 136064
MAA 156,28,16
buffer_load_dwordx4 v18, s[20:23], s54 offen lds
MAA 160,32,16
TR 74,25,13952
TR 76,25,13472
MAA 124,0,36
TR 78,25,13984
MAA 140,0,40
buffer_load_dwordx4 v19, s[20:23], s54 offen offset:1024 lds
MAA 144,4,40
TR 80,25,14464
MAA 128,4,36
TR 82,25,14976
TR 84,25,14496
MAA 132,8,36
buffer_load_dwordx4 v20, s[20:23], s54 offen offset:2048 lds
MAA 148,8,40
s_add_u32 s54, s54, 196608
MAA 152,12,40
TR 86,25,15008
MAA 136,12,36
s_waitcnt vmcnt(15) lgkmcnt(8)
s_barrier
MAA 60,64,44
RD 0,23,36992
s_add_u32 m0, s55, 0
MAA 76,68,44
buffer_load_dwordx4 v21, s[36:39], s52 offen lds
MAA 80,68,48
RD 4,23,39296
MAA 64,64,48
buffer_load_dwordx4 v28, s[36:39], s52 offen offset:1024 lds
MAA 68,64,52
RD 8,23,41600
RD 12,23,43904
MAA 84,68,52
TR 20,25,24832
MAA 88,68,56
buffer_load_dword v22, s[36:39], s52 offen offset:2048 lds
MAA 72,64,56
s_add_u32 s52, s52, 128
s_add_u32 m0, s55, 2304
s_waitcnt lgkmcnt(5)
MAA 244,64,60
buffer_load_dwordx4 v21, s[36:39], s53 offen lds
MAA 104,72,56
TR 22,25,25344
MAA 120,76,56
TR 24,25,24864
TR 26,25,25376
MAA 116,76,52
buffer_load_dwordx4 v28, s[36:39], s53 offen offset:1024 lds
MAA 100,72,52
RD 16,24,36992
MAA 96,72,48
buffer_load_dword v29, s[36:39], s53 offen offset:2048 lds
MAA 112,76,48
TR 28,25,25856
s_add_u32 s53, s53, 128
MAA 108,76,44
s_add_u32 m0, s56, 73984
MAA 92,72,44
buffer_load_dwordx4 v18, s[20:23], s54 offen lds
MAA 156,72,60
TR 30,25,26368
TR 32,25,25888
MAA 160,76,60
buffer_load_dwordx4 v19, s[20:23], s54 offen offset:1024 lds
MAA 124,44,80
TR 34,25,26400
MAA 140,44,84
TR 36,25,26880
MAA 144,48,84
buffer_load_dwordx4 v20, s[20:23], s54 offen offset:2048 lds
MAA 128,48,80
TR 38,25,27392
s_add_u32 s54, s54, 196608
MAA 132,52,80
buffer_load_dword v37, v34, s[40:43], 0 offen sc1
MAA 148,52,84
TR 40,25,26912
MAA 152,56,84
TR 42,25,27424
MAA 136,56,80
s_waitcnt vmcnt(22) lgkmcnt(8)
s_barrier
MAA 60,20,0
RD 44,30,36992
s_add_u32 m0, s56, 86400
MAA 76,24,0
buffer_load_dwordx4 v18, s[20:23], s54 offen lds
MAA 80,24,4
s_sub_u32 s47, s47, 1
s_cbranch_scc1 .Lx6
.Lx6b:
MAA 64,20,4
buffer_load_dwordx4 v19, s[20:23], s54 offen offset:1024 lds
MAA 68,20,8
RD 48,30,39296
MAA 84,24,8
RD 52,30,41600
RD 56,30,43904
MAA 88,24,12
buffer_load_dwordx4 v20, s[20:23], s54 offen offset:2048 lds
MAA 72,20,12
s_add_u32 s54, s54, 196608
s_waitcnt lgkmcnt(4)
MAA 244,20,16
TR 64,25,37248
s_add_u32 m0, s55, 18496
MAA 104,28,12
buffer_load_dwordx4 v21, s[36:39], s52 offen lds
MAA 120,32,12
TR 66,25,37760
MAA 116,32,8
TR 68,25,37280
TR 70,25,37792
MAA 100,28,8
buffer_load_dwordx4 v28, s[36:39], s52 offen offset:1024 lds
MAA 96,28,4
RD 60,31,36992
MAA 112,32,4
buffer_load_dword v22, s[36:39], s52 offen offset:2048 lds
MAA 108,32,0
TR 72,25,38272
s_add_u32 s52, s52, 128
MAA 92,28,0
s_add_u32 m0, s55, 20800
MAA 156,28,16
buffer_load_dwordx4 v21, s[36:39], s53 offen lds
MAA 160,32,16
TR 74,25,38784
TR 76,25,38304
MAA 124,0,36
TR 78,25,38816
MAA 140,0,40
buffer_load_dwordx4 v28, s[36:39], s53 offen offset:1024 lds
MAA 144,4,40
TR 80,25,39296
MAA 128,4,36
TR 82,25,39808
TR 84,25,39328
MAA 132,8,36
buffer_load_dword v29, s[36:39], s53 offen offset:2048 lds
MAA 148,8,40
s_add_u32 s53, s53, 128
MAA 152,12,40
TR 86,25,39840
MAA 136,12,36
s_waitcnt vmcnt(22) lgkmcnt(8)
s_barrier
MAA 60,64,44
RD 0,23,55488
s_add_u32 m0, s56, 98816
MAA 76,68,44
buffer_load_dwordx4 v18, s[20:23], s54 offen lds
MAA 80,68,48
RD 4,23,57792
MAA 64,64,48
RD 8,23,60096
MAA 68,64,52
RD 12,23,62400
MAA 84,68,52
buffer_load_dwordx4 v19, s[20:23], s54 offen offset:1024 lds
MAA 88,68,56
TR 20,25,49664
MAA 72,64,56
TR 22,25,50176
s_waitcnt lgkmcnt(6)
MAA 244,64,60
MAA 104,72,56
buffer_load_dwordx4 v20, s[20:23], s54 offen offset:2048 lds
MAA 120,76,56
TR 24,25,49696
s_add_u32 s54, s54, 196608
MAA 116,76,52
TR 26,25,50208
MAA 100,72,52
RD 16,24,55488
s_add_u32 m0, s55, 36992
MAA 96,72,48
buffer_load_dwordx4 v21, s[36:39], s52 offen lds
MAA 112,76,48
TR 28,25,50688
MAA 108,76,44
TR 30,25,51200
MAA 92,72,44
TR 32,25,50720
MAA 156,72,60
buffer_load_dwordx4 v28, s[36:39], s52 offen offset:1024 lds
MAA 160,76,60
MAA 124,44,80
TR 34,25,51232
MAA 140,44,84
TR 36,25,51712
MAA 144,48,84
buffer_load_dword v22, s[36:39], s52 offen offset:2048 lds
MAA 128,48,80
TR 38,25,52224
s_add_u32 s52, s52, 128
MAA 132,52,80
TR 40,25,51744
MAA 148,52,84
TR 42,25,52256
MAA 152,56,84
MAA 136,56,80
s_waitcnt vmcnt(25) lgkmcnt(8)
s_barrier
MAA 60,20,0
RD 44,30,55488
s_add_u32 m0, s56, 111232
MAA 76,24,0
buffer_load_dwordx4 v18, s[20:23], s54 offen lds
MAA 80,24,4
s_sub_u32 s47, s47, 1
s_cbranch_scc1 .Lx7
.Lx7b:
MAA 64,20,4
RD 48,30,57792
MAA 68,20,8
RD 52,30,60096
MAA 84,24,8
buffer_load_dwordx4 v19, s[20:23], s54 offen offset:1024 lds
MAA 88,24,12
RD 56,30,62400
MAA 72,20,12
TR 64,25,62080
s_waitcnt lgkmcnt(5)
MAA 244,20,16
TR 66,25,62592
MAA 104,28,12
buffer_load_dwordx4 v20, s[20:23], s54 offen offset:2048 lds
MAA 120,32,12
TR 68,25,62112
s_add_u32 s54, s54, 196608
MAA 116,32,8
TR 70,25,62624
MAA 100,28,8
RD 60,31,55488
s_add_u32 m0, s55, 39296
MAA 96,28,4
buffer_load_dwordx4 v21, s[36:39], s53 offen lds
MAA 112,32,4
MAA 108,32,0
TR 72,25,63104
MAA 92,28,0
TR 74,25,63616
MAA 156,28,16
buffer_load_dwordx4 v28, s[36:39], s53 offen offset:1024 lds
MAA 160,32,16
TR 76,25,63136
MAA 124,0,36
TR 78,25,63648
MAA 140,0,40
TR 80,25,64128
MAA 144,4,40
buffer_load_dword v29, s[36:39], s53 offen offset:2048 lds
MAA 128,4,36
TR 82,25,64640
s_add_u32 s53, s53, 128
MAA 132,8,36
TR 84,25,64160
MAA 148,8,40
TR 86,25,64672
MAA 152,12,40
MAA 136,12,36
s_waitcnt vmcnt(22) lgkmcnt(8)
s_barrier
s_waitcnt vmcnt(21)
v_cmp_gt_u32 vcc, v35, v37
s_nop 0
s_cbranch_vccnz .Lsp8
.Lsp8b:
v_mov_b32 v37, 0
MAA 60,64,44
ds_read_b128 a[0:3], v23
MAA 76,68,44
buffer_atomic_add v38, v32, s[16:19], 0 offen
MAA 80,68,48
RD 4,23,2304
MAA 64,64,48
RD 8,23,4608
s_add_u32 m0, s56, 123648
MAA 68,64,52
buffer_load_dwordx4 v18, s[20:23], s54 offen lds
MAA 84,68,52
RD 12,23,6912
MAA 88,68,56
ds_read_b64_tr_b16 a[20:21], v25
MAA 72,64,56
TR 22,25,512
s_waitcnt lgkmcnt(6)
MAA 244,64,60
buffer_load_dwordx4 v19, s[20:23], s54 offen offset:1024 lds
MAA 104,72,56
TR 24,25,32
MAA 120,76,56
TR 26,25,544
MAA 116,76,52
buffer_load_dwordx4 v20, s[20:23], s54 offen offset:2048 lds
MAA 100,72,52
ds_read_b128 a[16:19], v24
s_add_u32 s54, s54, 196608
MAA 96,72,48
MAA 112,76,48
TR 28,25,1024
s_add_u32 m0, s55, 55488
MAA 108,76,44
buffer_load_dwordx4 v21, s[36:39], s52 offen lds
MAA 92,72,44
TR 30,25,1536
MAA 156,72,60
TR 32,25,1056
MAA 160,76,60
buffer_load_dwordx4 v28, s[36:39], s52 offen offset:1024 lds
MAA 124,44,80
TR 34,25,1568
MAA 140,44,84
TR 36,25,2048
MAA 144,48,84
TR 38,25,2560
MAA 128,48,80
buffer_load_dword v22, s[36:39], s52 offen offset:2048 lds
MAA 132,52,80
TR 40,25,2080
s_add_u32 s52, s52, 128
MAA 148,52,84
TR 42,25,2592
MAA 152,56,84
MAA 136,56,80
s_waitcnt vmcnt(25) lgkmcnt(8)
s_barrier
MAA 60,20,0
ds_read_b128 a[44:47], v30
s_add_u32 m0, s56, 136064
MAA 76,24,0
buffer_load_dwordx4 v18, s[20:23], s54 offen lds
MAA 80,24,4
s_sub_u32 s47, s47, 1
s_cbranch_scc1 .Lx9
.Lx9b:
MAA 64,20,4
RD 48,30,2304
MAA 68,20,8
RD 52,30,4608
MAA 84,24,8
buffer_load_dwordx4 v19, s[20:23], s54 offen offset:1024 lds
MAA 88,24,12
RD 56,30,6912
MAA 72,20,12
TR 64,25,12416
s_waitcnt lgkmcnt(5)
MAA 244,20,16
TR 66,25,12928
MAA 104,28,12
buffer_load_dwordx4 v20, s[20:23], s54 offen offset:2048 lds
MAA 120,32,12
TR 68,25,12448
s_add_u32 s54, s54, 196608
MAA 116,32,8
TR 70,25,12960
MAA 100,28,8
ds_read_b128 a[60:63], v31
s_add_u32 m0, s55, 57792
MAA 96,28,4
buffer_load_dwordx4 v21, s[36:39], s53 offen lds
MAA 112,32,4
MAA 108,32,0
TR 72,25,13440
MAA 92,28,0
TR 74,25,13952
MAA 156,28,16
buffer_load_dwordx4 v28, s[36:39], s53 offen offset:1024 lds
MAA 160,32,16
TR 76,25,13472
MAA 124,0,36
TR 78,25,13984
MAA 140,0,40
TR 80,25,14464
MAA 144,4,40
buffer_load_dword v29, s[36:39], s53 offen offset:2048 lds
MAA 128,4,36
TR 82,25,14976
s_add_u32 s53, s53, 128
MAA 132,8,36
TR 84,25,14496
MAA 148,8,40
TR 86,25,15008
MAA 152,12,40
MAA 136,12,36
s_waitcnt vmcnt(22) lgkmcnt(8)
s_barrier
MAA 60,64,44
RD 0,23,18496
s_add_u32 m0, s56, 73984
MAA 76,68,44
buffer_load_dwordx4 v18, s[20:23], s54 offen lds
MAA 80,68,48
RD 4,23,20800
MAA 64,64,48
RD 8,23,23104
MAA 68,64,52
RD 12,23,25408
MAA 84,68,52
buffer_load_dwordx4 v19, s[20:23], s54 offen offset:1024 lds
MAA 88,68,56
TR 20,25,24832
MAA 72,64,56
TR 22,25,25344
s_waitcnt lgkmcnt(6)
MAA 244,64,60
MAA 104,72,56
buffer_load_dwordx4 v20, s[20:23], s54 offen offset:2048 lds
MAA 120,76,56
TR 24,25,24864
s_add_u32 s54, s54, 196608
MAA 116,76,52
TR 26,25,25376
MAA 100,72,52
RD 16,24,18496
s_add_u32 m0, s55, 0
MAA 96,72,48
buffer_load_dwordx4 v21, s[36:39], s52 offen lds
MAA 112,76,48
TR 28,25,25856
MAA 108,76,44
TR 30,25,26368
MAA 92,72,44
TR 32,25,25888
MAA 156,72,60
buffer_load_dwordx4 v28, s[36:39], s52 offen offset:1024 lds
MAA 160,76,60
MAA 124,44,80
TR 34,25,26400
MAA 140,44,84
TR 36,25,26880
MAA 144,48,84
buffer_load_dword v22, s[36:39], s52 offen offset:2048 lds
MAA 128,48,80
TR 38,25,27392
s_add_u32 s52, s52, 128
MAA 132,52,80
TR 40,25,26912
MAA 148,52,84
TR 42,25,27424
MAA 152,56,84
MAA 136,56,80
s_waitcnt vmcnt(22) lgkmcnt(8)
s_barrier
MAA 60,20,0
RD 44,30,18496
s_add_u32 m0, s56, 86400
MAA 76,24,0
buffer_load_dwordx4 v18, s[20:23], s54 offen lds
MAA 80,24,4
s_sub_u32 s47, s47, 1
s_cbranch_scc1 .Lx10
.Lx10b:
MAA 64,20,4
RD 48,30,20800
MAA 68,20,8
RD 52,30,23104
MAA 84,24,8
buffer_load_dwordx4 v19, s[20:23], s54 offen offset:1024 lds
MAA 88,24,12
RD 56,30,25408
MAA 72,20,12
TR 64,25,37248
s_waitcnt lgkmcnt(5)
MAA 244,20,16
TR 66,25,37760
MAA 104,28,12
buffer_load_dwordx4 v20, s[20:23], s54 offen offset:2048 lds
MAA 120,32,12
TR 68,25,37280
s_add_u32 s54, s54, 196608
MAA 116,32,8
TR 70,25,37792
MAA 100,28,8
RD 60,31,18496
s_add_u32 m0, s55, 2304
MAA 96,28,4
buffer_load_dwordx4 v21, s[36:39], s53 offen lds
MAA 112,32,4
MAA 108,32,0
TR 72,25,38272
MAA 92,28,0
TR 74,25,38784
MAA 156,28,16
buffer_load_dwordx4 v28, s[36:39], s53 offen offset:1024 lds
MAA 160,32,16
TR 76,25,38304
MAA 124,0,36
TR 78,25,38816
MAA 140,0,40
TR 80,25,39296
MAA 144,4,40
buffer_load_dword v29, s[36:39], s53 offen offset:2048 lds
MAA 128,4,36
TR 82,25,39808
s_add_u32 s53, s53, 128
MAA 132,8,36
TR 84,25,39328
MAA 148,8,40
TR 86,25,39840
MAA 152,12,40
MAA 136,12,36
s_waitcnt vmcnt(21) lgkmcnt(8)
s_barrier
MAA 60,64,44
RD 0,23,36992
s_add_u32 m0, s56, 98816
MAA 76,68,44
buffer_load_dwordx4 v18, s[20:23], s54 offen lds
MAA 80,68,48
RD 4,23,39296
MAA 64,64,48
RD 8,23,41600
MAA 68,64,52
RD 12,23,43904
MAA 84,68,52
buffer_load_dwordx4 v19, s[20:23], s54 offen offset:1024 lds
MAA 88,68,56
TR 20,25,49664
MAA 72,64,56
TR 22,25,50176
s_waitcnt lgkmcnt(6)
MAA 244,64,60
MAA 104,72,56
buffer_load_dwordx4 v20, s[20:23], s54 offen offset:2048 lds
MAA 120,76,56
TR 24,25,49696
s_add_u32 s54, s54, 196608
MAA 116,76,52
TR 26,25,50208
MAA 100,72,52
RD 16,24,36992
s_add_u32 m0, s55, 18496
MAA 96,72,48
buffer_load_dwordx4 v21, s[36:39], s52 offen lds
MAA 112,76,48
TR 28,25,50688
MAA 108,76,44
TR 30,25,51200
MAA 92,72,44
TR 32,25,50720
MAA 156,72,60
buffer_load_dwordx4 v28, s[36:39], s52 offen offset:1024 lds
MAA 160,76,60
MAA 124,44,80
TR 34,25,51232
MAA 140,44,84
TR 36,25,51712
MAA 144,48,84
buffer_load_dword v22, s[36:39], s52 offen offset:2048 lds
MAA 128,48,80
TR 38,25,52224
s_add_u32 s52, s52, 128
MAA 132,52,80
TR 40,25,51744
MAA 148,52,84
TR 42,25,52256
MAA 152,56,84
MAA 136,56,80
s_waitcnt vmcnt(21) lgkmcnt(8)
s_barrier
MAA 60,20,0
RD 44,30,36992
s_add_u32 m0, s56, 111232
MAA 76,24,0
buffer_load_dwordx4 v18, s[20:23], s54 offen lds
MAA 80,24,4
s_sub_u32 s47, s47, 1
s_cbranch_scc1 .Lx11
.Lx11b:
MAA 64,20,4
RD 48,30,39296
MAA 68,20,8
buffer_load_dwordx4 v19, s[20:23], s54 offen offset:1024 lds
MAA 84,24,8
RD 52,30,41600
MAA 88,24,12
RD 56,30,43904
MAA 72,20,12
TR 64,25,62080
s_waitcnt lgkmcnt(5)
MAA 244,20,16
buffer_load_dwordx4 v20, s[20:23], s54 offen offset:2048 lds
MAA 104,28,12
TR 66,25,62592
s_add_u32 s54, s54, 196608
MAA 120,32,12
TR 68,25,62112
s_add_u32 m0, s55, 20800
MAA 116,32,8
buffer_load_dwordx4 v21, s[36:39], s53 offen lds
MAA 100,28,8
TR 70,25,62624
MAA 96,28,4
RD 60,31,36992
MAA 112,32,4
TR 72,25,63104
MAA 108,32,0
buffer_load_dwordx4 v28, s[36:39], s53 offen offset:1024 lds
MAA 92,28,0
TR 74,25,63616
MAA 156,28,16
TR 76,25,63136
MAA 160,32,16
buffer_load_dword v29, s[36:39], s53 offen offset:2048 lds
MAA 124,0,36
TR 78,25,63648
s_add_u32 s53, s53, 128
MAA 140,0,40
TR 80,25,64128
MAA 144,4,40
TR 82,25,64640
MAA 128,4,36
buffer_atomic_add v37, v33, s[16:19], 0 offen sc0
MAA 132,8,36
TR 84,25,64160
MAA 148,8,40
TR 86,25,64672
MAA 152,12,40
MAA 136,12,36
s_waitcnt vmcnt(22) lgkmcnt(8)
s_barrier
MAA 60,64,44
RD 0,23,55488
s_add_u32 m0, s56, 123648
MAA 76,68,44
buffer_load_dwordx4 v18, s[20:23], s54 offen lds
MAA 80,68,48
RD 4,23,57792
MAA 64,64,48
RD 8,23,60096
MAA 68,64,52
RD 12,23,62400
MAA 84,68,52
buffer_load_dwordx4 v19, s[20:23], s54 offen offset:1024 lds
MAA 88,68,56
ds_read_b64_tr_b16 a[20:21], v25
MAA 72,64,56
TR 22,25,512
s_waitcnt lgkmcnt(6)
MAA 244,64,60
MAA 104,72,56
buffer_load_dwordx4 v20, s[20:23], s54 offen offset:2048 lds
MAA 120,76,56
TR 24,25,32
s_add_u32 s54, s54, 196608
MAA 116,76,52
TR 26,25,544
MAA 100,72,52
RD 16,24,55488
s_add_u32 m0, s55, 36992
MAA 96,72,48
buffer_load_dwordx4 v21, s[36:39], s52 offen lds
MAA 112,76,48
TR 28,25,1024
MAA 108,76,44
TR 30,25,1536
MAA 92,72,44
TR 32,25,1056
MAA 156,72,60
buffer_load_dwordx4 v28, s[36:39], s52 offen offset:1024 lds
MAA 160,76,60
MAA 124,44,80
TR 34,25,1568
MAA 140,44,84
TR 36,25,2048
MAA 144,48,84
buffer_load_dword v22, s[36:39], s52 offen offset:2048 lds
MAA 128,48,80
TR 38,25,2560
s_add_u32 s52, s52, 128
MAA 132,52,80
TR 40,25,2080
MAA 148,52,84
TR 42,25,2592
MAA 152,56,84
MAA 136,56,80
s_waitcnt vmcnt(22) lgkmcnt(8)
s_barrier
MAA 60,20,0
RD 44,30,55488
s_add_u32 m0, s56, 136064
MAA 76,24,0
buffer_load_dwordx4 v18, s[20:23], s54 offen lds
MAA 80,24,4
s_sub_u32 s47, s47, 1
s_cbranch_scc1 .Lx12
.Lx12b:
MAA 64,20,4
RD 48,30,57792
MAA 68,20,8
RD 52,30,60096
MAA 84,24,8
buffer_load_dwordx4 v19, s[20:23], s54 offen offset:1024 lds
MAA 88,24,12
RD 56,30,62400
MAA 72,20,12
TR 64,25,12416
s_waitcnt lgkmcnt(5)
MAA 244,20,16
TR 66,25,12928
MAA 104,28,12
buffer_load_dwordx4 v20, s[20:23], s54 offen offset:2048 lds
MAA 120,32,12
TR 68,25,12448
s_add_u32 s54, s54, 196608
MAA 116,32,8
TR 70,25,12960
MAA 100,28,8
RD 60,31,55488
s_add_u32 m0, s55, 39296
MAA 96,28,4
buffer_load_dwordx4 v21, s[36:39], s53 offen lds
MAA 112,32,4
MAA 108,32,0
TR 72,25,13440
MAA 92,28,0
TR 74,25,13952
MAA 156,28,16
buffer_load_dwordx4 v28, s[36:39], s53 offen offset:1024 lds
MAA 160,32,16
TR 76,25,13472
MAA 124,0,36
TR 78,25,13984
MAA 140,0,40
TR 80,25,14464
MAA 144,4,40
buffer_load_dword v29, s[36:39], s53 offen offset:2048 lds
MAA 128,4,36
TR 82,25,14976
s_add_u32 s53, s53, 128
MAA 132,8,36
TR 84,25,14496
MAA 148,8,40
TR 86,25,15008
MAA 152,12,40
MAA 136,12,36
s_waitcnt vmcnt(22) lgkmcnt(8)
s_barrier
MAA 60,64,44
ds_read_b128 a[0:3], v23
s_add_u32 m0, s56, 73984
MAA 76,68,44
buffer_load_dwordx4 v18, s[20:23], s54 offen lds
MAA 80,68,48
RD 4,23,2304
MAA 64,64,48
RD 8,23,4608
MAA 68,64,52
RD 12,23,6912
MAA 84,68,52
buffer_load_dwordx4 v19, s[20:23], s54 offen offset:1024 lds
MAA 88,68,56
TR 20,25,24832
MAA 72,64,56
TR 22,25,25344
s_waitcnt lgkmcnt(6)
MAA 244,64,60
MAA 104,72,56
buffer_load_dwordx4 v20, s[20:23], s54 offen offset:2048 lds
MAA 120,76,56
TR 24,25,24864
s_add_u32 s54, s54, 196608
MAA 116,76,52
TR 26,25,25376
MAA 100,72,52
ds_read_b128 a[16:19], v24
s_add_u32 m0, s55, 55488
MAA 96,72,48
buffer_load_dwordx4 v21, s[36:39], s52 offen lds
MAA 112,76,48
TR 28,25,25856
MAA 108,76,44
TR 30,25,26368
MAA 92,72,44
TR 32,25,25888
MAA 156,72,60
buffer_load_dwordx4 v28, s[36:39], s52 offen offset:1024 lds
MAA 160,76,60
MAA 124,44,80
TR 34,25,26400
MAA 140,44,84
TR 36,25,26880
MAA 144,48,84
buffer_load_dword v22, s[36:39], s52 offen offset:2048 lds
MAA 128,48,80
TR 38,25,27392
s_add_u32 s52, s52, 128
MAA 132,52,80
TR 40,25,26912
MAA 148,52,84
TR 42,25,27424
MAA 152,56,84
MAA 136,56,80
s_waitcnt vmcnt(22) lgkmcnt(8)
s_barrier
MAA 60,20,0
ds_read_b128 a[44:47], v30
s_add_u32 m0, s56, 86400
MAA 76,24,0
buffer_load_dwordx4 v18, s[20:23], s54 offen lds
MAA 80,24,4
s_sub_u32 s47, s47, 1
s_cbranch_scc1 .Lx13
.Lx13b:
MAA 64,20,4
RD 48,30,2304
MAA 68,20,8
RD 52,30,4608
MAA 84,24,8
buffer_load_dwordx4 v19, s[20:23], s54 offen offset:1024 lds
MAA 88,24,12
RD 56,30,6912
MAA 72,20,12
TR 64,25,37248
s_waitcnt lgkmcnt(5)
MAA 244,20,16
TR 66,25,37760
MAA 104,28,12
buffer_load_dwordx4 v20, s[20:23], s54 offen offset:2048 lds
MAA 120,32,12
TR 68,25,37280
s_add_u32 s54, s54, 196608
MAA 116,32,8
TR 70,25,37792
MAA 100,28,8
ds_read_b128 a[60:63], v31
s_add_u32 m0, s55, 57792
MAA 96,28,4
buffer_load_dwordx4 v21, s[36:39], s53 offen lds
MAA 112,32,4
MAA 108,32,0
TR 72,25,38272
MAA 92,28,0
TR 74,25,38784
MAA 156,28,16
buffer_load_dwordx4 v28, s[36:39], s53 offen offset:1024 lds
MAA 160,32,16
TR 76,25,38304
MAA 124,0,36
TR 78,25,38816
MAA 140,0,40
TR 80,25,39296
MAA 144,4,40
buffer_load_dword v29, s[36:39], s53 offen offset:2048 lds
MAA 128,4,36
TR 82,25,39808
s_add_u32 s53, s53, 128
MAA 132,8,36
TR 84,25,39328
MAA 148,8,40
TR 86,25,39840
MAA 152,12,40
MAA 136,12,36
s_waitcnt vmcnt(24)
v_cmp_gt_u32 vcc, v36, v37
s_nop 0
s_cbranch_vccnz .Lsp14
.Lsp14b:
s_waitcnt vmcnt(21) lgkmcnt(8)
s_barrier
MAA 60,64,44
RD 0,23,18496
s_add_u32 m0, s56, 98816
MAA 76,68,44
buffer_load_dwordx4 v18, s[20:23], s54 offen lds
MAA 80,68,48
RD 4,23,20800
MAA 64,64,48
RD 8,23,23104
MAA 68,64,52
buffer_load_dwordx4 v19, s[20:23], s54 offen offset:1024 lds
MAA 84,68,52
RD 12,23,25408
MAA 88,68,56
TR 20,25,49664
MAA 72,64,56
TR 22,25,50176
s_waitcnt lgkmcnt(6)
MAA 244,64,60
buffer_load_dwordx4 v20, s[20:23], s54 offen offset:2048 lds
MAA 104,72,56
TR 24,25,49696
s_add_u32 s54, s54, 196608
MAA 120,76,56
TR 26,25,50208
s_add_u32 m0, s55, 0
MAA 116,76,52
buffer_load_dwordx4 v21, s[36:39], s52 offen lds
MAA 100,72,52
RD 16,24,18496
MAA 96,72,48
MAA 112,76,48
TR 28,25,50688
MAA 108,76,44
buffer_load_dwordx4 v28, s[36:39], s52 offen offset:1024 lds
MAA 92,72,44
TR 30,25,51200
MAA 156,72,60
TR 32,25,50720
MAA 160,76,60
buffer_load_dword v22, s[36:39], s52 offen offset:2048 lds
MAA 124,44,80
TR 34,25,51232
s_add_u32 s52, s52, 128
MAA 140,44,84
TR 36,25,51712
MAA 144,48,84
TR 38,25,52224
MAA 128,48,80
buffer_load_dwordx4 v[164:167], v26, s[16:19], s75 offen sc1
MAA 132,52,80
TR 40,25,51744
MAA 148,52,84
TR 42,25,52256
MAA 152,56,84
MAA 136,56,80
s_waitcnt vmcnt(22) lgkmcnt(8)
s_barrier
MAA 60,20,0
RD 44,30,18496
s_add_u32 m0, s56, 111232
MAA 76,24,0
buffer_load_dwordx4 v18, s[20:23], s54 offen lds
MAA 80,24,4
s_sub_u32 s47, s47, 1
s_cbranch_scc1 .Lx15
.Lx15b:
MAA 64,20,4
RD 48,30,20800
MAA 68,20,8
buffer_load_dwordx4 v19, s[20:23], s54 offen offset:1024 lds
MAA 84,24,8
RD 52,30,23104
MAA 88,24,12
RD 56,30,25408
MAA 72,20,12
TR 64,25,62080
s_waitcnt lgkmcnt(5)
MAA 244,20,16
buffer_load_dwordx4 v20, s[20:23], s54 offen offset:2048 lds
MAA 104,28,12
TR 66,25,62592
s_add_u32 s54, s54, 196608
MAA 120,32,12
TR 68,25,62112
s_add_u32 m0, s55, 2304
MAA 116,32,8
buffer_load_dwordx4 v21, s[36:39], s53 offen lds
MAA 100,28,8
TR 70,25,62624
MAA 96,28,4
RD 60,31,18496
MAA 112,32,4
TR 72,25,63104
MAA 108,32,0
buffer_load_dwordx4 v28, s[36:39], s53 offen offset:1024 lds
MAA 92,28,0
TR 74,25,63616
MAA 156,28,16
TR 76,25,63136
MAA 160,32,16
buffer_load_dword v29, s[36:39], s53 offen offset:2048 lds
MAA 124,0,36
TR 78,25,63648
s_add_u32 s53, s53, 128
MAA 140,0,40
TR 80,25,64128
MAA 144,4,40
TR 82,25,64640
MAA 128,4,36
buffer_load_dwordx4 v[168:171], v26, s[16:19], s75 offen offset:1024 sc1
MAA 132,8,36
TR 84,25,64160
MAA 148,8,40
TR 86,25,64672
MAA 152,12,40
MAA 136,12,36
s_waitcnt vmcnt(23) lgkmcnt(8)
s_barrier
MAA 60,64,44
RD 0,23,36992
s_add_u32 m0, s56, 123648
MAA 76,68,44
buffer_load_dwordx4 v18, s[20:23], s54 offen lds
MAA 80,68,48
RD 4,23,39296
MAA 64,64,48
RD 8,23,41600
MAA 68,64,52
buffer_load_dwordx4 v19, s[20:23], s54 offen offset:1024 lds
MAA 84,68,52
RD 12,23,43904
MAA 88,68,56
ds_read_b64_tr_b16 a[20:21], v25
MAA 72,64,56
TR 22,25,512
s_waitcnt lgkmcnt(6)
MAA 244,64,60
buffer_load_dwordx4 v20, s[20:23], s54 offen offset:2048 lds
MAA 104,72,56
TR 24,25,32
s_add_u32 s54, s54, 196608
MAA 120,76,56
TR 26,25,544
s_add_u32 m0, s55, 18496
MAA 116,76,52
buffer_load_dwordx4 v21, s[36:39], s52 offen lds
MAA 100,72,52
RD 16,24,36992
MAA 96,72,48
MAA 112,76,48
TR 28,25,1024
MAA 108,76,44
buffer_load_dwordx4 v28, s[36:39], s52 offen offset:1024 lds
MAA 92,72,44
TR 30,25,1536
MAA 156,72,60
TR 32,25,1056
MAA 160,76,60
buffer_load_dword v22, s[36:39], s52 offen offset:2048 lds
MAA 124,44,80
TR 34,25,1568
s_add_u32 s52, s52, 128
MAA 140,44,84
TR 36,25,2048
MAA 144,48,84
TR 38,25,2560
MAA 128,48,80
buffer_load_dwordx4 v[172:175], v26, s[16:19], s75 offen offset:2048 sc1
MAA 132,52,80
TR 40,25,2080
MAA 148,52,84
TR 42,25,2592
MAA 152,56,84
MAA 136,56,80
s_waitcnt vmcnt(24) lgkmcnt(8)
s_barrier
MAA 60,20,0
RD 44,30,36992
s_add_u32 m0, s56, 136064
MAA 76,24,0
buffer_load_dwordx4 v18, s[20:23], s54 offen lds
MAA 80,24,4
s_sub_u32 s47, s47, 1
s_cbranch_scc1 .Lx16
.Lx16b:
MAA 64,20,4
RD 48,30,39296
MAA 68,20,8
buffer_load_dwordx4 v19, s[20:23], s54 offen offset:1024 lds
MAA 84,24,8
RD 52,30,41600
MAA 88,24,12
RD 56,30,43904
MAA 72,20,12
TR 64,25,12416
s_waitcnt lgkmcnt(5)
MAA 244,20,16
buffer_load_dwordx4 v20, s[20:23], s54 offen offset:2048 lds
MAA 104,28,12
TR 66,25,12928
s_add_u32 s54, s54, 196608
MAA 120,32,12
TR 68,25,12448
s_add_u32 m0, s55, 20800
MAA 116,32,8
buffer_load_dwordx4 v21, s[36:39], s53 offen lds
MAA 100,28,8
TR 70,25,12960
MAA 96,28,4
RD 60,31,36992
MAA 112,32,4
TR 72,25,13440
MAA 108,32,0
buffer_load_dwordx4 v28, s[36:39], s53 offen offset:1024 lds
MAA 92,28,0
TR 74,25,13952
MAA 156,28,16
TR 76,25,13472
MAA 160,32,16
buffer_load_dword v29, s[36:39], s53 offen offset:2048 lds
MAA 124,0,36
TR 78,25,13984
s_add_u32 s53, s53, 128
MAA 140,0,40
TR 80,25,14464
MAA 144,4,40
TR 82,25,14976
MAA 128,4,36
buffer_load_dwordx4 v[176:179], v26, s[16:19], s75 offen offset:3072 sc1
MAA 132,8,36
TR 84,25,14496
s_add_u32 s75, s75, 4096
MAA 148,8,40
TR 86,25,15008
MAA 152,12,40
MAA 136,12,36
s_waitcnt vmcnt(25) lgkmcnt(8)
s_barrier
MAA 60,64,44
RD 0,23,55488
s_add_u32 m0, s56, 73984
MAA 76,68,44
buffer_load_dwordx4 v18, s[20:23], s54 offen lds
MAA 80,68,48
RD 4,23,57792
MAA 64,64,48
RD 8,23,60096
MAA 68,64,52
buffer_load_dwordx4 v19, s[20:23], s54 offen offset:1024 lds
MAA 84,68,52
RD 12,23,62400
MAA 88,68,56
TR 20,25,24832
MAA 72,64,56
TR 22,25,25344
s_waitcnt lgkmcnt(6)
MAA 244,64,60
buffer_load_dwordx4 v20, s[20:23], s54 offen offset:2048 lds
MAA 104,72,56
TR 24,25,24864
s_add_u32 s54, s54, 196608
MAA 120,76,56
TR 26,25,25376
s_add_u32 m0, s55, 36992
MAA 116,76,52
buffer_load_dwordx4 v21, s[36:39], s52 offen lds
MAA 100,72,52
RD 16,24,55488
MAA 96,72,48
MAA 112,76,48
TR 28,25,25856
MAA 108,76,44
buffer_load_dwordx4 v28, s[36:39], s52 offen offset:1024 lds
MAA 92,72,44
TR 30,25,26368
MAA 156,72,60
TR 32,25,25888
MAA 160,76,60
buffer_load_dword v22, s[36:39], s52 offen offset:2048 lds
MAA 124,44,80
TR 34,25,26400
s_add_u32 s52, s52, 128
MAA 140,44,84
TR 36,25,26880
MAA 144,48,84
TR 38,25,27392
MAA 128,48,80
buffer_load_dwordx4 v[180:183], v26, s[16:19], s75 offen sc1
MAA 132,52,80
TR 40,25,26912
MAA 148,52,84
TR 42,25,27424
MAA 152,56,84
MAA 136,56,80
s_waitcnt vmcnt(25) lgkmcnt(8)
s_barrier
MAA 60,20,0
RD 44,30,55488
s_add_u32 m0, s56, 86400
MAA 76,24,0
buffer_load_dwordx4 v18, s[20:23], s54 offen lds
MAA 80,24,4
s_sub_u32 s47, s47, 1
s_cbranch_scc1 .Lx17
.Lx17b:
MAA 64,20,4
RD 48,30,57792
s_waitcnt vmcnt(22)
v_add_f32 v164, v164, v168
MAA 68,20,8
buffer_load_dwordx4 v19, s[20:23], s54 offen offset:1024 lds
MAA 84,24,8
RD 52,30,60096
MAA 88,24,12
RD 56,30,62400
MAA 72,20,12
TR 64,25,37248
s_waitcnt lgkmcnt(5)
MAA 244,20,16
buffer_load_dwordx4 v20, s[20:23], s54 offen offset:2048 lds
MAA 104,28,12
TR 66,25,37760
s_add_u32 s54, s54, 196608
MAA 120,32,12
TR 68,25,37280
s_add_u32 m0, s55, 39296
MAA 116,32,8
buffer_load_dwordx4 v21, s[36:39], s53 offen lds
MAA 100,28,8
TR 70,25,37792
v_add_f32 v165, v165, v169
MAA 96,28,4
RD 60,31,55488
MAA 112,32,4
TR 72,25,38272
MAA 108,32,0
buffer_load_dwordx4 v28, s[36:39], s53 offen offset:1024 lds
MAA 92,28,0
TR 74,25,38784
MAA 156,28,16
TR 76,25,38304
v_add_f32 v166, v166, v170
MAA 160,32,16
buffer_load_dword v29, s[36:39], s53 offen offset:2048 lds
MAA 124,0,36
TR 78,25,38816
s_add_u32 s53, s53, 128
MAA 140,0,40
TR 80,25,39296
MAA 144,4,40
TR 82,25,39808
MAA 128,4,36
buffer_load_dwordx4 v[184:187], v26, s[16:19], s75 offen offset:1024 sc1
MAA 132,8,36
TR 84,25,39328
v_add_f32 v167, v167, v171
MAA 148,8,40
TR 86,25,39840
MAA 152,12,40
MAA 136,12,36
s_waitcnt vmcnt(25) lgkmcnt(8)
s_barrier
MAA 60,64,44
ds_read_b128 a[0:3], v23
s_add_u32 m0, s56, 98816
MAA 76,68,44
buffer_load_dwordx4 v18, s[20:23], s54 offen lds
MAA 80,68,48
RD 4,23,2304
s_waitcnt vmcnt(22)
v_add_f32 v164, v164, v172
MAA 64,64,48
RD 8,23,4608
v_add_f32 v165, v165, v173
MAA 68,64,52
buffer_load_dwordx4 v19, s[20:23], s54 offen offset:1024 lds
MAA 84,68,52
RD 12,23,6912
v_add_f32 v166, v166, v174
MAA 88,68,56
TR 20,25,49664
v_add_f32 v167, v167, v175
MAA 72,64,56
buffer_load_dwordx4 v20, s[20:23], s54 offen offset:2048 lds
s_waitcnt lgkmcnt(5)
MAA 244,64,60
TR 22,25,50176
s_add_u32 s54, s54, 196608
MAA 104,72,56
TR 24,25,49696
s_add_u32 m0, s55, 55488
MAA 120,76,56
buffer_load_dwordx4 v21, s[36:39], s52 offen lds
MAA 116,76,52
TR 26,25,50208
MAA 100,72,52
ds_read_b128 a[16:19], v24
MAA 96,72,48
buffer_load_dwordx4 v28, s[36:39], s52 offen offset:1024 lds
MAA 112,76,48
TR 28,25,50688
MAA 108,76,44
TR 30,25,51200
MAA 92,72,44
buffer_load_dword v22, s[36:39], s52 offen offset:2048 lds
MAA 156,72,60
TR 32,25,50720
s_add_u32 s52, s52, 128
MAA 160,76,60
TR 34,25,51232
MAA 124,44,80
buffer_load_dwordx4 v[188:191], v26, s[16:19], s75 offen offset:2048 sc1
MAA 140,44,84
TR 36,25,51712
MAA 144,48,84
TR 38,25,52224
MAA 128,48,80
TR 40,25,51744
MAA 132,52,80
TR 42,25,52256
MAA 148,52,84
MAA 152,56,84
MAA 136,56,80
s_waitcnt vmcnt(25) lgkmcnt(8)
s_barrier
MAA 60,20,0
ds_read_b128 a[44:47], v30
s_add_u32 m0, s56, 111232
MAA 76,24,0
buffer_load_dwordx4 v18, s[20:23], s54 offen lds
MAA 80,24,4
RD 48,30,2304
s_waitcnt vmcnt(22)
v_add_f32 v164, v164, v176
MAA 64,20,4
RD 52,30,4608
v_add_f32 v165, v165, v177
MAA 68,20,8
buffer_load_dwordx4 v19, s[20:23], s54 offen offset:1024 lds
MAA 84,24,8
RD 56,30,6912
v_add_f32 v166, v166, v178
MAA 88,24,12
TR 64,25,62080
v_add_f32 v167, v167, v179
MAA 72,20,12
buffer_load_dwordx4 v20, s[20:23], s54 offen offset:2048 lds
s_waitcnt lgkmcnt(5)
MAA 244,20,16
TR 66,25,62592
s_add_u32 s54, s54, 196608
MAA 104,28,12
TR 68,25,62112
s_add_u32 m0, s55, 57792
MAA 120,32,12
buffer_load_dwordx4 v21, s[36:39], s53 offen lds
MAA 116,32,8
TR 70,25,62624
MAA 100,28,8
ds_read_b128 a[60:63], v31
MAA 96,28,4
buffer_load_dwordx4 v28, s[36:39], s53 offen offset:1024 lds
MAA 112,32,4
TR 72,25,63104
MAA 108,32,0
TR 74,25,63616
MAA 92,28,0
buffer_load_dword v29, s[36:39], s53 offen offset:2048 lds
MAA 156,28,16
TR 76,25,63136
s_add_u32 s53, s53, 128
MAA 160,32,16
TR 78,25,63648
MAA 124,0,36
buffer_load_dwordx4 v[192:195], v26, s[16:19], s75 offen offset:3072 sc1
MAA 140,0,40
TR 80,25,64128
MAA 144,4,40
TR 82,25,64640
MAA 128,4,36
TR 84,25,64160
MAA 132,8,36
TR 86,25,64672
MAA 148,8,40
MAA 152,12,40
MAA 136,12,36
s_waitcnt vmcnt(25) lgkmcnt(8)
s_barrier
MAA 60,64,44
RD 0,23,18496
s_add_u32 m0, s56, 123648
MAA 76,68,44
buffer_load_dwordx4 v18, s[20:23], s54 offen lds
MAA 80,68,48
RD 4,23,20800
s_waitcnt vmcnt(22)
v_add_f32 v164, v164, v180
MAA 64,64,48
RD 8,23,23104
v_add_f32 v165, v165, v181
MAA 68,64,52
RD 12,23,25408
v_add_f32 v166, v166, v182
MAA 84,68,52
ds_read_b64_tr_b16 a[20:21], v25
v_add_f32 v167, v167, v183
MAA 88,68,56
TR 22,25,512
MAA 72,64,56
TR 24,25,32
s_waitcnt lgkmcnt(7)
MAA 244,64,60
TR 26,25,544
MAA 104,72,56
buffer_load_dwordx4 v19, s[20:23], s54 offen offset:1024 lds
MAA 120,76,56
RD 16,24,18496
MAA 116,76,52
TR 28,25,1024
MAA 100,72,52
TR 30,25,1536
MAA 96,72,48
TR 32,25,1056
MAA 112,76,48
TR 34,25,1568
MAA 108,76,44
TR 36,25,2048
MAA 92,72,44
TR 38,25,2560
MAA 156,72,60
buffer_load_dwordx4 v20, s[20:23], s54 offen offset:2048 lds
MAA 160,76,60
TR 40,25,2080
s_add_u32 s54, s54, 196608
MAA 124,44,80
TR 42,25,2592
MAA 140,44,84
MAA 144,48,84
MAA 128,48,80
MAA 132,52,80
MAA 148,52,84
MAA 152,56,84
MAA 136,56,80
s_waitcnt vmcnt(21) lgkmcnt(8)
s_barrier
MAA 60,20,0
RD 44,30,18496
s_add_u32 m0, s56, 136064
MAA 76,24,0
buffer_load_dwordx4 v18, s[20:23], s54 offen lds
MAA 80,24,4
RD 48,30,20800
s_waitcnt vmcnt(18)
v_add_f32 v164, v164, v184
MAA 64,20,4
RD 52,30,23104
v_add_f32 v165, v165, v185
MAA 68,20,8
RD 56,30,25408
v_add_f32 v166, v166, v186
MAA 84,24,8
TR 64,25,12416
v_add_f32 v167, v167, v187
MAA 88,24,12
TR 66,25,12928
MAA 72,20,12
TR 68,25,12448
s_waitcnt lgkmcnt(7)
MAA 244,20,16
TR 70,25,12960
MAA 104,28,12
buffer_load_dwordx4 v19, s[20:23], s54 offen offset:1024 lds
MAA 120,32,12
RD 60,31,18496
MAA 116,32,8
TR 72,25,13440
MAA 100,28,8
TR 74,25,13952
MAA 96,28,4
TR 76,25,13472
MAA 112,32,4
TR 78,25,13984
MAA 108,32,0
TR 80,25,14464
MAA 92,28,0
TR 82,25,14976
MAA 156,28,16
buffer_load_dwordx4 v20, s[20:23], s54 offen offset:2048 lds
MAA 160,32,16
TR 84,25,14496
s_add_u32 s54, s54, 196608
MAA 124,0,36
TR 86,25,15008
MAA 140,0,40
MAA 144,4,40
MAA 128,4,36
MAA 132,8,36
MAA 148,8,40
MAA 152,12,40
MAA 136,12,36
s_waitcnt vmcnt(17) lgkmcnt(8)
s_barrier
MAA 60,64,44
RD 0,23,36992
s_add_u32 m0, s59, 0
MAA 76,68,44
RD 4,23,39296
s_mov_b32 s58, 1048576
MAA 80,68,48
buffer_load_dwordx4 v5, s[24:27], s58 offen lds
MAA 64,64,48
RD 8,23,41600
s_waitcnt vmcnt(14)
v_add_f32 v164, v164, v188
MAA 68,64,52
RD 12,23,43904
v_add_f32 v165, v165, v189
MAA 84,68,52
TR 20,25,24832
v_add_f32 v166, v166, v190
MAA 88,68,56
buffer_load_dwordx4 v6, s[24:27], s58 offen offset:1024 lds
MAA 72,64,56
TR 22,25,25344
s_add_u32 m0, s59, 8320
s_waitcnt lgkmcnt(6)
MAA 244,64,60
TR 24,25,24864
s_mov_b32 s58, 1179648
MAA 104,72,56
TR 26,25,25376
v_add_f32 v167, v167, v191
MAA 120,76,56
buffer_load_dwordx4 v5, s[24:27], s58 offen lds
MAA 116,76,52
RD 16,24,36992
MAA 100,72,52
TR 28,25,25856
MAA 96,72,48
TR 30,25,26368
MAA 112,76,48
buffer_load_dwordx4 v6, s[24:27], s58 offen offset:1024 lds
MAA 108,76,44
TR 32,25,25888
s_add_u32 m0, s59, 16640
MAA 92,72,44
TR 34,25,26400
s_mov_b32 s58, 1310720
MAA 156,72,60
TR 36,25,26880
MAA 160,76,60
buffer_load_dwordx4 v5, s[24:27], s58 offen lds
MAA 124,44,80
TR 38,25,27392
MAA 140,44,84
TR 40,25,26912
MAA 144,48,84
TR 42,25,27424
MAA 128,48,80
buffer_load_dwordx4 v6, s[24:27], s58 offen offset:1024 lds
MAA 132,52,80
MAA 148,52,84
MAA 152,56,84
MAA 136,56,80
s_waitcnt vmcnt(16) lgkmcnt(8)
s_barrier
MAA 60,20,0
RD 44,30,36992
s_add_u32 m0, s59, 24960
MAA 76,24,0
RD 48,30,39296
s_mov_b32 s58, 1441792
MAA 80,24,4
buffer_load_dwordx4 v5, s[24:27], s58 offen lds
MAA 64,20,4
RD 52,30,41600
s_waitcnt vmcnt(13)
v_add_f32 v164, v164, v192
MAA 68,20,8
RD 56,30,43904
v_add_f32 v165, v165, v193
MAA 84,24,8
TR 64,25,37248
v_add_f32 v166, v166, v194
MAA 88,24,12
buffer_load_dwordx4 v6, s[24:27], s58 offen offset:1024 lds
MAA 72,20,12
TR 66,25,37760
s_add_u32 m0, s59, 74880
s_waitcnt lgkmcnt(6)
MAA 244,20,16
TR 68,25,37280
s_mov_b32 s58, 131072
MAA 104,28,12
TR 70,25,37792
v_add_f32 v167, v167, v195
MAA 120,32,12
buffer_load_dwordx4 v5, s[24:27], s58 offen lds
MAA 116,32,8
RD 60,31,36992
MAA 100,28,8
TR 72,25,38272
MAA 96,28,4
TR 74,25,38784
MAA 112,32,4
buffer_load_dwordx4 v6, s[24:27], s58 offen offset:1024 lds
MAA 108,32,0
TR 76,25,38304
s_add_u32 m0, s59, 83200
MAA 92,28,0
TR 78,25,38816
s_mov_b32 s58, 262144
MAA 156,28,16
TR 80,25,39296
MAA 160,32,16
buffer_load_dwordx4 v5, s[24:27], s58 offen lds
MAA 124,0,36
TR 82,25,39808
MAA 140,0,40
TR 84,25,39328
MAA 144,4,40
TR 86,25,39840
MAA 128,4,36
buffer_load_dwordx4 v6, s[24:27], s58 offen offset:1024 lds
MAA 132,8,36
MAA 148,8,40
MAA 152,12,40
MAA 136,12,36
s_waitcnt vmcnt(15) lgkmcnt(8)
s_barrier
MAA 60,64,44
RD 0,23,55488
s_add_u32 m0, s59, 33280
MAA 76,68,44
RD 4,23,57792
s_mov_b32 s58, 1572864
MAA 80,68,48
buffer_load_dwordx4 v5, s[24:27], s58 offen lds
MAA 64,64,48
RD 8,23,60096
MAA 68,64,52
RD 12,23,62400
MAA 84,68,52
TR 20,25,49664
MAA 88,68,56
buffer_load_dwordx4 v6, s[24:27], s58 offen offset:1024 lds
MAA 72,64,56
TR 22,25,50176
s_add_u32 m0, s59, 41600
s_waitcnt lgkmcnt(6)
MAA 244,64,60
TR 24,25,49696
s_mov_b32 s58, 1703936
MAA 104,72,56
TR 26,25,50208
MAA 120,76,56
buffer_load_dwordx4 v5, s[24:27], s58 offen lds
MAA 116,76,52
RD 16,24,55488
MAA 100,72,52
TR 28,25,50688
MAA 96,72,48
TR 30,25,51200
MAA 112,76,48
buffer_load_dwordx4 v6, s[24:27], s58 offen offset:1024 lds
MAA 108,76,44
TR 32,25,50720
s_add_u32 m0, s59, 91520
MAA 92,72,44
TR 34,25,51232
s_mov_b32 s58, 393216
MAA 156,72,60
TR 36,25,51712
MAA 160,76,60
buffer_load_dwordx4 v5, s[24:27], s58 offen lds
MAA 124,44,80
TR 38,25,52224
MAA 140,44,84
TR 40,25,51744
MAA 144,48,84
TR 42,25,52256
MAA 128,48,80
buffer_load_dwordx4 v6, s[24:27], s58 offen offset:1024 lds
MAA 132,52,80
v_permlane32_swap_b32 v164, v166
MAA 148,52,84
v_permlane32_swap_b32 v165, v167
MAA 152,56,84
v_add_f32 v164, v164, v166
v_add_f32 v165, v165, v167
MAA 136,56,80
v_mul_f32 v164, 0xba800000, v164
v_mul_f32 v165, 0x3a800000, v165
v_fma_f32 v165, -v164, v164, v165
v_max_f32 v165, 0, v165
v_add_f32 v165, 0x3727c5ac, v165
s_waitcnt vmcnt(18) lgkmcnt(8)
s_barrier
MAA 60,20,0
ds_write_b32 v17, v164
s_add_u32 m0, s59, 99840
MAA 76,24,0
RD 44,30,55488
s_mov_b32 s58, 524288
MAA 80,24,4
buffer_load_dwordx4 v5, s[24:27], s58 offen lds
MAA 64,20,4
RD 48,30,57792
MAA 68,20,8
RD 52,30,60096
MAA 84,24,8
RD 56,30,62400
MAA 88,24,12
TR 64,25,62080
MAA 72,20,12
TR 66,25,62592
s_waitcnt lgkmcnt(7)
MAA 244,20,16
buffer_load_dwordx4 v6, s[24:27], s58 offen offset:1024 lds
MAA 104,28,12
TR 68,25,62112
s_add_u32 m0, s59, 108160
MAA 120,32,12
TR 70,25,62624
s_mov_b32 s58, 655360
MAA 116,32,8
RD 60,31,55488
MAA 100,28,8
TR 72,25,63104
MAA 96,28,4
TR 74,25,63616
MAA 112,32,4
buffer_load_dwordx4 v5, s[24:27], s58 offen lds
MAA 108,32,0
TR 76,25,63136
MAA 92,28,0
TR 78,25,63648
MAA 156,28,16
TR 80,25,64128
MAA 160,32,16
TR 82,25,64640
MAA 124,0,36
TR 84,25,64160
MAA 140,0,40
buffer_load_dwordx4 v6, s[24:27], s58 offen offset:1024 lds
MAA 144,4,40
TR 86,25,64672
MAA 128,4,36
v_rsq_f32 v166, v165
MAA 132,8,36
v_mov_b32 v165, v166
v_mul_f32 v166, 0x3e8293ee, v166
MAA 148,8,40
ds_write_b128 v7, v[164:167]
MAA 152,12,40
ds_write_b32 v17, v165 offset:1024
MAA 136,12,36
s_waitcnt lgkmcnt(0)
s_barrier
MAA 244,64,60
ds_read_b128 v[232:235], v10 offset:768
MAA 156,72,60
ds_read_b128 v[236:239], v10 offset:2816
MAA 160,76,60
ds_read_b128 v[228:231], v10 offset:512
MAA 104,72,56
ds_read_b128 v[224:227], v10 offset:256
MAA 120,76,56
ds_read_b128 v[220:223], v10
MAA 136,56,80
MAA 152,56,84
MAA 100,72,52
MAA 116,76,52
s_mov_b32 exec_lo, 0x10001
s_mov_b32 exec_hi, 0x10001
ds_write_b128 v13, v[244:247]
ds_write_b128 v13, v[156:159] offset:256
ds_write_b128 v13, v[160:163] offset:320
s_mov_b64 exec, -1
MAA 96,72,48
MAA 112,76,48
MAA 92,72,44
MAA 108,76,44
MAA 72,64,56
MAA 88,68,56
s_waitcnt lgkmcnt(0)
s_barrier
MAA 132,52,80
ds_read_b128 v[28:31], v13
s_add_u32 m0, s59, 49920
MAA 148,52,84
ds_read_b128 v[32:35], v13 offset:64
s_mov_b32 s58, 1835008
MAA 68,64,52
ds_read_b128 v[36:39], v13 offset:256
MAA 84,68,52
ds_read_b128 v[40:43], v13 offset:320
MAA 128,48,80
ds_read_b32 v44, v12 offset:512
MAA 144,48,84
ds_read_b32 v45, v12 offset:576
MAA 64,64,48
ds_read_b128 v[240:243], v11 offset:192
MAA 80,68,48
ds_read_b128 v[244:247], v11 offset:1216
MAA 124,44,80
buffer_load_dwordx4 v5, s[24:27], s58 offen lds
ds_read_b128 v[18:21], v11 offset:128
s_waitcnt lgkmcnt(8)
v_pk_fma_f32 v[72:73], v[28:29], v[232:233], v[72:73] op_sel_hi:[1,0,1]
v_pk_fma_f32 v[74:75], v[30:31], v[232:233], v[74:75] op_sel_hi:[1,0,1]
s_waitcnt lgkmcnt(6)
v_pk_fma_f32 v[104:105], v[36:37], v[232:233], v[104:105] op_sel_hi:[1,0,1]
v_pk_mul_f32 v[104:105], v[104:105], v[232:233] op_sel:[0,1] op_sel_hi:[1,1]
v_pk_fma_f32 v[106:107], v[38:39], v[232:233], v[106:107] op_sel_hi:[1,0,1]
v_pk_mul_f32 v[106:107], v[106:107], v[232:233] op_sel:[0,1] op_sel_hi:[1,1]
s_waitcnt lgkmcnt(5)
v_pk_fma_f32 v[120:121], v[40:41], v[232:233], v[120:121] op_sel_hi:[1,0,1]
v_pk_mul_f32 v[120:121], v[120:121], v[232:233] op_sel:[0,1] op_sel_hi:[1,1]
v_pk_fma_f32 v[122:123], v[42:43], v[232:233], v[122:123] op_sel_hi:[1,0,1]
v_pk_mul_f32 v[122:123], v[122:123], v[232:233] op_sel:[0,1] op_sel_hi:[1,1]
v_pk_fma_f32 v[100:101], v[36:37], v[228:229], v[100:101] op_sel_hi:[1,0,1]
v_pk_mul_f32 v[100:101], v[100:101], v[228:229] op_sel:[0,1] op_sel_hi:[1,1]
v_pk_fma_f32 v[102:103], v[38:39], v[228:229], v[102:103] op_sel_hi:[1,0,1]
v_pk_mul_f32 v[102:103], v[102:103], v[228:229] op_sel:[0,1] op_sel_hi:[1,1]
v_pk_fma_f32 v[116:117], v[40:41], v[228:229], v[116:117] op_sel_hi:[1,0,1]
v_pk_mul_f32 v[116:117], v[116:117], v[228:229] op_sel:[0,1] op_sel_hi:[1,1]
v_pk_fma_f32 v[118:119], v[42:43], v[228:229], v[118:119] op_sel_hi:[1,0,1]
v_pk_mul_f32 v[118:119], v[118:119], v[228:229] op_sel:[0,1] op_sel_hi:[1,1]
s_waitcnt lgkmcnt(2)
v_pk_fma_f32 v[136:137], v[240:241], v[44:45], v[136:137] op_sel_hi:[1,0,1]
v_pk_fma_f32 v[138:139], v[242:243], v[44:45], v[138:139] op_sel_hi:[1,0,1]
v_pk_fma_f32 v[152:153], v[240:241], v[44:45], v[152:153] op_sel:[0,1,0] op_sel_hi:[1,1,1]
v_pk_fma_f32 v[154:155], v[242:243], v[44:45], v[154:155] op_sel:[0,1,0] op_sel_hi:[1,1,1]
s_waitcnt lgkmcnt(1)
v_pk_mul_f32 v[136:137], v[136:137], v[244:245]
v_pk_mul_f32 v[138:139], v[138:139], v[246:247]
v_pk_mul_f32 v[152:153], v[152:153], v[244:245]
v_pk_mul_f32 v[154:155], v[154:155], v[246:247]
v_pk_fma_f32 v[88:89], v[32:33], v[232:233], v[88:89] op_sel_hi:[1,0,1]
v_pk_fma_f32 v[90:91], v[34:35], v[232:233], v[90:91] op_sel_hi:[1,0,1]
v_pk_fma_f32 v[96:97], v[36:37], v[224:225], v[96:97] op_sel_hi:[1,0,1]
s_waitcnt lgkmcnt(0)
v_pk_fma_f32 v[132:133], v[18:19], v[44:45], v[132:133] op_sel_hi:[1,0,1]
v_pk_fma_f32 v[134:135], v[20:21], v[44:45], v[134:135] op_sel_hi:[1,0,1]
v_pk_fma_f32 v[148:149], v[18:19], v[44:45], v[148:149] op_sel:[0,1,0] op_sel_hi:[1,1,1]
v_pk_fma_f32 v[150:151], v[20:21], v[44:45], v[150:151] op_sel:[0,1,0] op_sel_hi:[1,1,1]
v_pk_mul_f32 v[96:97], v[96:97], v[224:225] op_sel:[0,1] op_sel_hi:[1,1]
v_pk_fma_f32 v[98:99], v[38:39], v[224:225], v[98:99] op_sel_hi:[1,0,1]
v_pk_mul_f32 v[98:99], v[98:99], v[224:225] op_sel:[0,1] op_sel_hi:[1,1]
v_pk_fma_f32 v[112:113], v[40:41], v[224:225], v[112:113] op_sel_hi:[1,0,1]
v_pk_mul_f32 v[112:113], v[112:113], v[224:225] op_sel:[0,1] op_sel_hi:[1,1]
v_pk_fma_f32 v[114:115], v[42:43], v[224:225], v[114:115] op_sel_hi:[1,0,1]
v_pk_mul_f32 v[114:115], v[114:115], v[224:225] op_sel:[0,1] op_sel_hi:[1,1]
v_pk_fma_f32 v[68:69], v[28:29], v[228:229], v[68:69] op_sel_hi:[1,0,1]
v_pk_fma_f32 v[70:71], v[30:31], v[228:229], v[70:71] op_sel_hi:[1,0,1]
v_pk_fma_f32 v[84:85], v[32:33], v[228:229], v[84:85] op_sel_hi:[1,0,1]
v_pk_fma_f32 v[86:87], v[34:35], v[228:229], v[86:87] op_sel_hi:[1,0,1]
v_pk_fma_f32 v[92:93], v[36:37], v[220:221], v[92:93] op_sel_hi:[1,0,1]
v_pk_mul_f32 v[92:93], v[92:93], v[220:221] op_sel:[0,1] op_sel_hi:[1,1]
v_pk_fma_f32 v[94:95], v[38:39], v[220:221], v[94:95] op_sel_hi:[1,0,1]
v_pk_mul_f32 v[94:95], v[94:95], v[220:221] op_sel:[0,1] op_sel_hi:[1,1]
v_pk_fma_f32 v[108:109], v[40:41], v[220:221], v[108:109] op_sel_hi:[1,0,1]
v_pk_mul_f32 v[108:109], v[108:109], v[220:221] op_sel:[0,1] op_sel_hi:[1,1]
v_pk_fma_f32 v[110:111], v[42:43], v[220:221], v[110:111] op_sel_hi:[1,0,1]
v_pk_mul_f32 v[110:111], v[110:111], v[220:221] op_sel:[0,1] op_sel_hi:[1,1]
v_pk_fma_f32 v[64:65], v[28:29], v[224:225], v[64:65] op_sel_hi:[1,0,1]
v_pk_fma_f32 v[66:67], v[30:31], v[224:225], v[66:67] op_sel_hi:[1,0,1]
v_pk_fma_f32 v[80:81], v[32:33], v[224:225], v[80:81] op_sel_hi:[1,0,1]
v_pk_fma_f32 v[82:83], v[34:35], v[224:225], v[82:83] op_sel_hi:[1,0,1]
v_pk_fma_f32 v[156:157], v[36:37], v[236:237], v[156:157] op_sel_hi:[1,0,1]
v_pk_mul_f32 v[156:157], v[156:157], v[236:237] op_sel:[0,1] op_sel_hi:[1,1]
v_pk_fma_f32 v[158:159], v[38:39], v[236:237], v[158:159] op_sel_hi:[1,0,1]
v_pk_mul_f32 v[158:159], v[158:159], v[236:237] op_sel:[0,1] op_sel_hi:[1,1]
v_pk_fma_f32 v[160:161], v[40:41], v[236:237], v[160:161] op_sel_hi:[1,0,1]
v_pk_mul_f32 v[160:161], v[160:161], v[236:237] op_sel:[0,1] op_sel_hi:[1,1]
v_pk_fma_f32 v[162:163], v[42:43], v[236:237], v[162:163] op_sel_hi:[1,0,1]
v_pk_mul_f32 v[162:163], v[162:163], v[236:237] op_sel:[0,1] op_sel_hi:[1,1]
v_cvt_pk_bf16_f32 v196, v104, v105
v_cvt_pk_bf16_f32 v197, v106, v107
MAA 140,44,84
buffer_load_dwordx4 v6, s[24:27], s58 offen offset:1024 lds
MAA 60,64,44
ds_read_b128 v[22:25], v11 offset:1152
v_cvt_pk_bf16_f32 v198, v120, v121
MAA 76,68,44
ds_read_b128 v[240:243], v11 offset:64
v_cvt_pk_bf16_f32 v199, v122, v123
v_cvt_pk_bf16_f32 v208, v136, v137
v_cvt_pk_bf16_f32 v209, v138, v139
v_cvt_pk_bf16_f32 v218, v152, v153
v_cvt_pk_bf16_f32 v219, v154, v155
ds_write_b128 v8, v[196:199]
ds_write_b64 v8, v[208:209] offset:1024
ds_write_b64 v8, v[218:219] offset:1032
s_add_u32 m0, s59, 58240
s_mov_b32 s58, 1966080
buffer_load_dwordx4 v5, s[24:27], s58 offen lds
v_cvt_pk_bf16_f32 v192, v100, v101
v_cvt_pk_bf16_f32 v193, v102, v103
v_cvt_pk_bf16_f32 v194, v116, v117
v_cvt_pk_bf16_f32 v195, v118, v119
v_cvt_pk_bf16_f32 v176, v72, v73
v_cvt_pk_bf16_f32 v177, v74, v75
v_cvt_pk_bf16_f32 v178, v88, v89
v_cvt_pk_bf16_f32 v179, v90, v91
v_pk_fma_f32 v[60:61], v[28:29], v[220:221], v[60:61] op_sel_hi:[1,0,1]
v_pk_fma_f32 v[62:63], v[30:31], v[220:221], v[62:63] op_sel_hi:[1,0,1]
s_waitcnt lgkmcnt(4)
v_pk_mul_f32 v[132:133], v[132:133], v[22:23]
v_pk_mul_f32 v[134:135], v[134:135], v[24:25]
v_pk_mul_f32 v[148:149], v[148:149], v[22:23]
v_pk_mul_f32 v[150:151], v[150:151], v[24:25]
s_waitcnt lgkmcnt(3)
v_pk_fma_f32 v[128:129], v[240:241], v[44:45], v[128:129] op_sel_hi:[1,0,1]
v_pk_fma_f32 v[130:131], v[242:243], v[44:45], v[130:131] op_sel_hi:[1,0,1]
v_pk_fma_f32 v[144:145], v[240:241], v[44:45], v[144:145] op_sel:[0,1,0] op_sel_hi:[1,1,1]
v_pk_fma_f32 v[146:147], v[242:243], v[44:45], v[146:147] op_sel:[0,1,0] op_sel_hi:[1,1,1]
v_pk_fma_f32 v[76:77], v[32:33], v[220:221], v[76:77] op_sel_hi:[1,0,1]
v_pk_fma_f32 v[78:79], v[34:35], v[220:221], v[78:79] op_sel_hi:[1,0,1]
v_cvt_pk_bf16_f32 v206, v132, v133
v_cvt_pk_bf16_f32 v207, v134, v135
v_mfma_f32_16x16x32_bf16 v[104:107], v[192:195], v[176:179], v[46:49]
buffer_load_dwordx4 v6, s[24:27], s58 offen offset:1024 lds
v_mfma_f32_16x16x32_bf16 v[120:123], v[196:199], v[176:179], v[50:53]
s_waitcnt lgkmcnt(0)
s_barrier
ds_read_b64 v[200:201], v9 offset:1024
ds_read_b64 v[210:211], v9 offset:1032
s_add_u32 m0, s59, 66560
s_mov_b32 s58, 0
v_cvt_pk_bf16_f32 v216, v148, v149
v_cvt_pk_bf16_f32 v217, v150, v151
v_max3_f32 v88, v104, v105, v106
v_max3_f32 v89, v107, v120, v121
v_max3_f32 v88, v88, v122, v123
buffer_load_dwordx4 v5, s[24:27], s58 offen lds
v_max_f32 v90, v88, v89
v_max_f32 v89, v88, v89
v_cvt_pk_bf16_f32 v188, v96, v97
v_cvt_pk_bf16_f32 v189, v98, v99
v_permlane16_swap_b32 v90, v89
v_cvt_pk_bf16_f32 v190, v112, v113
v_max_f32 v88, v90, v89
v_max_f32 v89, v90, v89
v_cvt_pk_bf16_f32 v191, v114, v115
v_cvt_pk_bf16_f32 v172, v68, v69
v_permlane32_swap_b32 v88, v89
v_cvt_pk_bf16_f32 v173, v70, v71
buffer_load_dwordx4 v6, s[24:27], s58 offen offset:1024 lds
s_add_u32 m0, s59, 116480
s_mov_b32 s58, 786432
v_max_f32 v88, v88, v89
v_mul_f32 v88, v88, v234
v_pk_fma_f32 v[104:105], v[104:105], v[234:235], v[88:89] op_sel_hi:[1,0,0] neg_lo:[0,0,1] neg_hi:[0,0,1]
v_pk_fma_f32 v[106:107], v[106:107], v[234:235], v[88:89] op_sel_hi:[1,0,0] neg_lo:[0,0,1] neg_hi:[0,0,1]
v_pk_fma_f32 v[120:121], v[120:121], v[234:235], v[88:89] op_sel_hi:[1,0,0] neg_lo:[0,0,1] neg_hi:[0,0,1]
v_pk_fma_f32 v[122:123], v[122:123], v[234:235], v[88:89] op_sel_hi:[1,0,0] neg_lo:[0,0,1] neg_hi:[0,0,1]
v_exp_f32 v104, v104
v_exp_f32 v105, v105
v_exp_f32 v106, v106
v_exp_f32 v107, v107
v_exp_f32 v120, v120
v_exp_f32 v121, v121
v_exp_f32 v122, v122
v_exp_f32 v123, v123
v_cvt_pk_bf16_f32 v72, v104, v105
buffer_load_dwordx4 v5, s[24:27], s58 offen lds
v_cvt_pk_bf16_f32 v73, v106, v107
v_cvt_pk_bf16_f32 v74, v120, v121
v_cvt_pk_bf16_f32 v75, v122, v123
v_cvt_pk_bf16_f32 v174, v84, v85
v_cvt_pk_bf16_f32 v175, v86, v87
v_mfma_f32_16x16x32_bf16 v[88:91], v[248:251], v[72:75], 0
ds_read_b128 v[244:247], v11 offset:1088
v_cvt_pk_bf16_f32 v184, v92, v93
v_mfma_f32_16x16x32_bf16 v[104:107], v[206:209], v[72:75], 0
ds_read_b128 v[18:21], v11
v_cvt_pk_bf16_f32 v185, v94, v95
v_mfma_f32_16x16x32_bf16 v[120:123], v[216:219], v[72:75], 0
buffer_load_dwordx4 v6, s[24:27], s58 offen offset:1024 lds
v_mfma_f32_16x16x32_bf16 v[100:103], v[188:191], v[172:175], v[46:49]
ds_read_b128 v[22:25], v11 offset:1024
s_add_u32 m0, s59, 124800
v_mfma_f32_16x16x32_bf16 v[116:119], v[192:195], v[172:175], v[50:53]
s_mov_b32 s58, 917504
v_rcp_f32 v88, v88
v_cvt_pk_bf16_f32 v186, v108, v109
s_nop 1
v_max3_f32 v84, v100, v101, v102
v_cvt_pk_bf16_f32 v187, v110, v111
v_pk_mul_f32 v[104:105], v[104:105], v[88:89] op_sel_hi:[1,0]
v_pk_mul_f32 v[106:107], v[106:107], v[88:89] op_sel_hi:[1,0]
buffer_load_dwordx4 v5, s[24:27], s58 offen lds
v_pk_mul_f32 v[120:121], v[120:121], v[88:89] op_sel_hi:[1,0]
v_pk_mul_f32 v[122:123], v[122:123], v[88:89] op_sel_hi:[1,0]
v_cvt_pk_bf16_f32 v176, v104, v105
v_cvt_pk_bf16_f32 v177, v106, v107
v_cvt_pk_bf16_f32 v178, v120, v121
v_cvt_pk_bf16_f32 v179, v122, v123
s_waitcnt lgkmcnt(2)
v_pk_mul_f32 v[128:129], v[128:129], v[244:245]
v_cvt_pk_bf16_f32 v204, v128, v129
v_pk_mul_f32 v[130:131], v[130:131], v[246:247]
v_cvt_pk_bf16_f32 v205, v130, v131
v_pk_mul_f32 v[144:145], v[144:145], v[244:245]
v_cvt_pk_bf16_f32 v214, v144, v145
v_pk_mul_f32 v[146:147], v[146:147], v[246:247]
buffer_load_dwordx4 v6, s[24:27], s58 offen offset:1024 lds
v_cvt_pk_bf16_f32 v215, v146, v147
v_max3_f32 v85, v103, v116, v117
v_max3_f32 v84, v84, v118, v119
v_max_f32 v86, v84, v85
v_max_f32 v85, v84, v85
v_cvt_pk_bf16_f32 v168, v64, v65
v_cvt_pk_bf16_f32 v169, v66, v67
v_permlane16_swap_b32 v86, v85
v_cvt_pk_bf16_f32 v170, v80, v81
v_max_f32 v84, v86, v85
v_max_f32 v85, v86, v85
v_cvt_pk_bf16_f32 v171, v82, v83
s_waitcnt lgkmcnt(1)
v_pk_fma_f32 v[124:125], v[18:19], v[44:45], v[124:125] op_sel_hi:[1,0,1]
s_waitcnt lgkmcnt(0)
v_pk_mul_f32 v[124:125], v[124:125], v[22:23]
v_pk_fma_f32 v[126:127], v[20:21], v[44:45], v[126:127] op_sel_hi:[1,0,1]
v_pk_mul_f32 v[126:127], v[126:127], v[24:25]
v_pk_fma_f32 v[140:141], v[18:19], v[44:45], v[140:141] op_sel:[0,1,0] op_sel_hi:[1,1,1]
v_pk_mul_f32 v[140:141], v[140:141], v[22:23]
v_pk_fma_f32 v[142:143], v[20:21], v[44:45], v[142:143] op_sel:[0,1,0] op_sel_hi:[1,1,1]
v_pk_mul_f32 v[142:143], v[142:143], v[24:25]
v_permlane32_swap_b32 v84, v85
s_nop 0
v_mfma_f32_16x16x32_bf16 v[96:99], v[184:187], v[168:171], v[46:49]
buffer_store_dwordx4 v[176:179], v4, s[16:19], s74 offen offset:3072 sc1
v_mfma_f32_16x16x32_bf16 v[112:115], v[188:191], v[168:171], v[50:53]
v_max_f32 v84, v84, v85
v_mul_f32 v84, v84, v230
v_cvt_pk_bf16_f32 v202, v124, v125
v_cvt_pk_bf16_f32 v203, v126, v127
v_cvt_pk_bf16_f32 v212, v140, v141
v_pk_fma_f32 v[100:101], v[100:101], v[230:231], v[84:85] op_sel_hi:[1,0,0] neg_lo:[0,0,1] neg_hi:[0,0,1]
v_pk_fma_f32 v[102:103], v[102:103], v[230:231], v[84:85] op_sel_hi:[1,0,0] neg_lo:[0,0,1] neg_hi:[0,0,1]
v_pk_fma_f32 v[116:117], v[116:117], v[230:231], v[84:85] op_sel_hi:[1,0,0] neg_lo:[0,0,1] neg_hi:[0,0,1]
v_pk_fma_f32 v[118:119], v[118:119], v[230:231], v[84:85] op_sel_hi:[1,0,0] neg_lo:[0,0,1] neg_hi:[0,0,1]
v_exp_f32 v100, v100
v_exp_f32 v101, v101
v_exp_f32 v102, v102
v_exp_f32 v103, v103
v_exp_f32 v116, v116
v_exp_f32 v117, v117
v_exp_f32 v118, v118
v_exp_f32 v119, v119
v_cvt_pk_bf16_f32 v68, v100, v101
v_cvt_pk_bf16_f32 v69, v102, v103
v_cvt_pk_bf16_f32 v70, v116, v117
v_cvt_pk_bf16_f32 v71, v118, v119
v_cvt_pk_bf16_f32 v213, v142, v143
v_max3_f32 v80, v96, v97, v98
v_mfma_f32_16x16x32_bf16 v[84:87], v[248:251], v[68:71], 0
v_max3_f32 v81, v99, v112, v113
v_max3_f32 v80, v80, v114, v115
v_mfma_f32_16x16x32_bf16 v[100:103], v[204:207], v[68:71], 0
v_max_f32 v82, v80, v81
v_max_f32 v81, v80, v81
v_mfma_f32_16x16x32_bf16 v[116:119], v[214:217], v[68:71], 0
s_nop 1
v_rcp_f32 v84, v84
v_permlane16_swap_b32 v82, v81
v_cvt_pk_bf16_f32 v180, v156, v157
v_pk_mul_f32 v[100:101], v[100:101], v[84:85] op_sel_hi:[1,0]
v_pk_mul_f32 v[102:103], v[102:103], v[84:85] op_sel_hi:[1,0]
s_nop 0
v_pk_mul_f32 v[116:117], v[116:117], v[84:85] op_sel_hi:[1,0]
v_pk_mul_f32 v[118:119], v[118:119], v[84:85] op_sel_hi:[1,0]
v_cvt_pk_bf16_f32 v172, v100, v101
v_cvt_pk_bf16_f32 v173, v102, v103
v_cvt_pk_bf16_f32 v174, v116, v117
v_cvt_pk_bf16_f32 v175, v118, v119
buffer_store_dwordx4 v[172:175], v4, s[16:19], s74 offen offset:2048 sc1
v_max_f32 v80, v82, v81
v_max_f32 v81, v82, v81
v_cvt_pk_bf16_f32 v181, v158, v159
v_cvt_pk_bf16_f32 v182, v160, v161
v_permlane32_swap_b32 v80, v81
v_cvt_pk_bf16_f32 v183, v162, v163
v_max_f32 v80, v80, v81
v_mul_f32 v80, v80, v226
v_pk_fma_f32 v[96:97], v[96:97], v[226:227], v[80:81] op_sel_hi:[1,0,0] neg_lo:[0,0,1] neg_hi:[0,0,1]
v_pk_fma_f32 v[98:99], v[98:99], v[226:227], v[80:81] op_sel_hi:[1,0,0] neg_lo:[0,0,1] neg_hi:[0,0,1]
v_pk_fma_f32 v[112:113], v[112:113], v[226:227], v[80:81] op_sel_hi:[1,0,0] neg_lo:[0,0,1] neg_hi:[0,0,1]
v_pk_fma_f32 v[114:115], v[114:115], v[226:227], v[80:81] op_sel_hi:[1,0,0] neg_lo:[0,0,1] neg_hi:[0,0,1]
v_exp_f32 v96, v96
v_exp_f32 v97, v97
v_exp_f32 v98, v98
v_exp_f32 v99, v99
v_exp_f32 v112, v112
v_exp_f32 v113, v113
v_exp_f32 v114, v114
v_exp_f32 v115, v115
v_cvt_pk_bf16_f32 v64, v96, v97
v_cvt_pk_bf16_f32 v65, v98, v99
v_cvt_pk_bf16_f32 v66, v112, v113
v_cvt_pk_bf16_f32 v67, v114, v115
v_cvt_pk_bf16_f32 v164, v60, v61
v_cvt_pk_bf16_f32 v165, v62, v63
v_mfma_f32_16x16x32_bf16 v[80:83], v[248:251], v[64:67], 0
v_cvt_pk_bf16_f32 v166, v76, v77
v_cvt_pk_bf16_f32 v167, v78, v79
v_mfma_f32_16x16x32_bf16 v[96:99], v[202:205], v[64:67], 0
v_mfma_f32_16x16x32_bf16 v[112:115], v[212:215], v[64:67], 0
s_nop 3
v_rcp_f32 v80, v80
v_mfma_f32_16x16x32_bf16 v[92:95], v[180:183], v[164:167], v[54:57]
v_mfma_f32_16x16x32_bf16 v[108:111], v[184:187], v[164:167], v[50:53]
s_nop 6
v_max3_f32 v76, v92, v93, v94
v_pk_mul_f32 v[96:97], v[96:97], v[80:81] op_sel_hi:[1,0]
v_pk_mul_f32 v[98:99], v[98:99], v[80:81] op_sel_hi:[1,0]
v_pk_mul_f32 v[112:113], v[112:113], v[80:81] op_sel_hi:[1,0]
v_pk_mul_f32 v[114:115], v[114:115], v[80:81] op_sel_hi:[1,0]
v_cvt_pk_bf16_f32 v168, v96, v97
v_cvt_pk_bf16_f32 v169, v98, v99
v_cvt_pk_bf16_f32 v170, v112, v113
v_cvt_pk_bf16_f32 v171, v114, v115
buffer_store_dwordx4 v[168:171], v4, s[16:19], s74 offen offset:1024 sc1
v_max3_f32 v77, v95, v108, v109
v_max3_f32 v76, v76, v110, v111
v_max_f32 v78, v76, v77
v_max_f32 v77, v76, v77
s_nop 1
v_permlane16_swap_b32 v78, v77
v_max_f32 v76, v78, v77
v_max_f32 v77, v78, v77
s_nop 1
v_permlane32_swap_b32 v76, v77
v_max_f32 v76, v76, v77
v_mul_f32 v76, v76, v222
v_pk_fma_f32 v[92:93], v[92:93], v[222:223], v[76:77] op_sel_hi:[1,0,0] neg_lo:[0,0,1] neg_hi:[0,0,1]
v_pk_fma_f32 v[94:95], v[94:95], v[222:223], v[76:77] op_sel_hi:[1,0,0] neg_lo:[0,0,1] neg_hi:[0,0,1]
v_pk_fma_f32 v[108:109], v[108:109], v[222:223], v[76:77] op_sel_hi:[1,0,0] neg_lo:[0,0,1] neg_hi:[0,0,1]
v_pk_fma_f32 v[110:111], v[110:111], v[222:223], v[76:77] op_sel_hi:[1,0,0] neg_lo:[0,0,1] neg_hi:[0,0,1]
v_exp_f32 v92, v92
v_exp_f32 v93, v93
v_exp_f32 v94, v94
v_exp_f32 v95, v95
v_exp_f32 v108, v108
v_exp_f32 v109, v109
v_exp_f32 v110, v110
v_exp_f32 v111, v111
v_cvt_pk_bf16_f32 v60, v92, v93
v_cvt_pk_bf16_f32 v61, v94, v95
v_cvt_pk_bf16_f32 v62, v108, v109
v_cvt_pk_bf16_f32 v63, v110, v111
s_nop 1
v_mfma_f32_16x16x32_bf16 v[76:79], v[248:251], v[60:63], 0
v_mfma_f32_16x16x32_bf16 v[92:95], v[200:203], v[60:63], 0
v_mfma_f32_16x16x32_bf16 v[108:111], v[210:213], v[60:63], 0
s_nop 5
v_rcp_f32 v76, v76
s_nop 0
v_pk_mul_f32 v[92:93], v[92:93], v[76:77] op_sel_hi:[1,0]
v_pk_mul_f32 v[94:95], v[94:95], v[76:77] op_sel_hi:[1,0]
v_pk_mul_f32 v[108:109], v[108:109], v[76:77] op_sel_hi:[1,0]
v_pk_mul_f32 v[110:111], v[110:111], v[76:77] op_sel_hi:[1,0]
v_cvt_pk_bf16_f32 v164, v92, v93
v_cvt_pk_bf16_f32 v165, v94, v95
v_cvt_pk_bf16_f32 v166, v108, v109
v_cvt_pk_bf16_f32 v167, v110, v111
buffer_store_dwordx4 v[164:167], v4, s[16:19], s74 offen sc1
s_nop 1
s_branch .Lqkve3
.Lx4:
buffer_load_dword v27, v14, s[76:79], 0 offen
s_mov_b32 s76, s98
s_mov_b32 s77, s99
s_mov_b32 s78, s100
v_mov_b32 v14, v15
s_mov_b32 s47, 5
s_branch .Lx4b
.Lx5:
buffer_load_dword v27, v14, s[76:79], 0 offen
s_mov_b32 s76, s98
s_mov_b32 s77, s99
s_mov_b32 s78, s100
v_mov_b32 v14, v15
s_mov_b32 s47, 5
s_branch .Lx5b
.Lx6:
buffer_load_dword v27, v14, s[76:79], 0 offen
s_mov_b32 s76, s98
s_mov_b32 s77, s99
s_mov_b32 s78, s100
v_mov_b32 v14, v15
s_mov_b32 s47, 5
s_branch .Lx6b
.Lx7:
buffer_load_dword v27, v14, s[76:79], 0 offen
s_mov_b32 s76, s98
s_mov_b32 s77, s99
s_mov_b32 s78, s100
v_mov_b32 v14, v15
s_mov_b32 s47, 5
s_branch .Lx7b
.Lsp8:
s_mov_b32 s15, 0
.Lsp8l:
v_mov_b32 v37, 0
buffer_atomic_add v37, v34, s[40:43], 0 offen sc0
s_add_u32 s15, s15, 1
s_cmp_gt_u32 s15, 100000
s_waitcnt vmcnt(0)
s_cbranch_scc1 .Lsp8b
v_cmp_gt_u32 vcc, v35, v37
s_nop 0
s_cbranch_vccnz .Lsp8l
s_branch .Lsp8b
.Lx9:
buffer_load_dword v27, v14, s[76:79], 0 offen
s_mov_b32 s76, s98
s_mov_b32 s77, s99
s_mov_b32 s78, s100
v_mov_b32 v14, v15
s_mov_b32 s47, 5
s_branch .Lx9b
.Lx10:
buffer_load_dword v27, v14, s[76:79], 0 offen
s_mov_b32 s76, s98
s_mov_b32 s77, s99
s_mov_b32 s78, s100
v_mov_b32 v14, v15
s_mov_b32 s47, 5
s_branch .Lx10b
.Lx11:
buffer_load_dword v27, v14, s[76:79], 0 offen
s_mov_b32 s76, s98
s_mov_b32 s77, s99
s_mov_b32 s78, s100
v_mov_b32 v14, v15
s_mov_b32 s47, 5
s_branch .Lx11b
.Lx12:
buffer_load_dword v27, v14, s[76:79], 0 offen
s_mov_b32 s76, s98
s_mov_b32 s77, s99
s_mov_b32 s78, s100
v_mov_b32 v14, v15
s_mov_b32 s47, 5
s_branch .Lx12b
.Lx13:
buffer_load_dword v27, v14, s[76:79], 0 offen
s_mov_b32 s76, s98
s_mov_b32 s77, s99
s_mov_b32 s78, s100
v_mov_b32 v14, v15
s_mov_b32 s47, 5
s_branch .Lx13b
.Lsp14:
s_mov_b32 s15, 0
.Lsp14l:
v_mov_b32 v37, 0
buffer_atomic_add v37, v33, s[16:19], 0 offen sc0
s_add_u32 s15, s15, 1
s_cmp_gt_u32 s15, 100000
s_waitcnt vmcnt(0)
s_cbranch_scc1 .Lsp14b
v_cmp_gt_u32 vcc, v36, v37
s_nop 0
s_cbranch_vccnz .Lsp14l
s_branch .Lsp14b
.Lx15:
buffer_load_dword v27, v14, s[76:79], 0 offen
s_mov_b32 s76, s98
s_mov_b32 s77, s99
s_mov_b32 s78, s100
v_mov_b32 v14, v15
s_mov_b32 s47, 5
s_branch .Lx15b
.Lx16:
buffer_load_dword v27, v14, s[76:79], 0 offen
s_mov_b32 s76, s98
s_mov_b32 s77, s99
s_mov_b32 s78, s100
v_mov_b32 v14, v15
s_mov_b32 s47, 5
s_branch .Lx16b
.Lx17:
buffer_load_dword v27, v14, s[76:79], 0 offen
s_mov_b32 s76, s98
s_mov_b32 s77, s99
s_mov_b32 s78, s100
v_mov_b32 v14, v15
s_mov_b32 s47, 5
s_branch .Lx17b
.Lx18:
buffer_load_dword v27, v14, s[76:79], 0 offen
s_mov_b32 s76, s98
s_mov_b32 s77, s99
s_mov_b32 s78, s100
v_mov_b32 v14, v15
s_mov_b32 s47, 5
s_branch .Lx18b
.Lx19:
buffer_load_dword v27, v14, s[76:79], 0 offen
s_mov_b32 s76, s98
s_mov_b32 s77, s99
s_mov_b32 s78, s100
v_mov_b32 v14, v15
s_mov_b32 s47, 5
s_branch .Lx19b
.Lx20:
buffer_load_dword v27, v14, s[76:79], 0 offen
s_mov_b32 s76, s98
s_mov_b32 s77, s99
s_mov_b32 s78, s100
v_mov_b32 v14, v15
s_mov_b32 s47, 5
s_branch .Lx20b
.Lx21:
buffer_load_dword v27, v14, s[76:79], 0 offen
s_mov_b32 s76, s98
s_mov_b32 s77, s99
s_mov_b32 s78, s100
v_mov_b32 v14, v15
s_mov_b32 s47, 5
s_branch .Lx21b
.Lsp22:
s_mov_b32 s15, 0
.Lsp22l:
v_mov_b32 v37, 0
buffer_atomic_add v37, v34, s[40:43], 0 offen sc0
s_add_u32 s15, s15, 1
s_cmp_gt_u32 s15, 100000
s_waitcnt vmcnt(0)
s_cbranch_scc1 .Lsp22b
v_cmp_gt_u32 vcc, v35, v37
s_nop 0
s_cbranch_vccnz .Lsp22l
s_branch .Lsp22b
.Lx23:
buffer_load_dword v27, v14, s[76:79], 0 offen
s_mov_b32 s76, s98
s_mov_b32 s77, s99
s_mov_b32 s78, s100
v_mov_b32 v14, v15
s_mov_b32 s47, 5
s_branch .Lx23b
.Lx24:
buffer_load_dword v27, v14, s[76:79], 0 offen
s_mov_b32 s76, s98
s_mov_b32 s77, s99
s_mov_b32 s78, s100
v_mov_b32 v14, v15
s_mov_b32 s47, 5
s_branch .Lx24b
.Lx25:
buffer_load_dword v27, v14, s[76:79], 0 offen
s_mov_b32 s76, s98
s_mov_b32 s77, s99
s_mov_b32 s78, s100
v_mov_b32 v14, v15
s_mov_b32 s47, 5
s_branch .Lx25b
.Lx26:
buffer_load_dword v27, v14, s[76:79], 0 offen
s_mov_b32 s76, s98
s_mov_b32 s77, s99
s_mov_b32 s78, s100
v_mov_b32 v14, v15
s_mov_b32 s47, 5
s_branch .Lx26b
.Lx27:
buffer_load_dword v27, v14, s[76:79], 0 offen
s_mov_b32 s76, s98
s_mov_b32 s77, s99
s_mov_b32 s78, s100
v_mov_b32 v14, v15
s_mov_b32 s47, 5
s_branch .Lx27b
.Lsp28:
s_mov_b32 s15, 0
.Lsp28l:
v_mov_b32 v37, 0
buffer_atomic_add v37, v33, s[16:19], 0 offen sc0
s_add_u32 s15, s15, 1
s_cmp_gt_u32 s15, 100000
s_waitcnt vmcnt(0)
s_cbranch_scc1 .Lsp28b
v_cmp_gt_u32 vcc, v36, v37
s_nop 0
s_cbranch_vccnz .Lsp28l
s_branch .Lsp28b
.Lx29:
buffer_load_dword v27, v14, s[76:79], 0 offen
s_mov_b32 s76, s98
s_mov_b32 s77, s99
s_mov_b32 s78, s100
v_mov_b32 v14, v15
s_mov_b32 s47, 5
s_branch .Lx29b
.Lx30:
buffer_load_dword v27, v14, s[76:79], 0 offen
s_mov_b32 s76, s98
s_mov_b32 s77, s99
s_mov_b32 s78, s100
v_mov_b32 v14, v15
s_mov_b32 s47, 5
s_branch .Lx30b
.Lx31:
buffer_load_dword v27, v14, s[76:79], 0 offen
s_mov_b32 s76, s98
s_mov_b32 s77, s99
s_mov_b32 s78, s100
v_mov_b32 v14, v15
s_mov_b32 s47, 5
s_branch .Lx31b
.Lqkv2:
s_add_u32 m0, s55, 0
s_nop 0
buffer_load_dwordx4 v21, s[36:39], s52 offen lds
buffer_load_dwordx4 v28, s[36:39], s52 offen offset:1024 lds
buffer_load_dword v22, s[36:39], s52 offen offset:2048 lds
s_add_u32 s52, s52, 128
s_add_u32 m0, s55, 2304
s_nop 0
buffer_load_dwordx4 v21, s[36:39], s53 offen lds
buffer_load_dwordx4 v28, s[36:39], s53 offen offset:1024 lds
buffer_load_dword v29, s[36:39], s53 offen offset:2048 lds
s_add_u32 s53, s53, 128
s_add_u32 m0, s56, 123648
s_nop 0
buffer_load_dwordx4 v18, s[20:23], s54 offen lds
buffer_load_dwordx4 v19, s[20:23], s54 offen offset:1024 lds
buffer_load_dwordx4 v20, s[20:23], s54 offen offset:2048 lds
s_add_u32 s54, s54, 196608
s_add_u32 m0, s56, 136064
s_nop 0
buffer_load_dwordx4 v18, s[20:23], s54 offen lds
buffer_load_dwordx4 v19, s[20:23], s54 offen offset:1024 lds
buffer_load_dwordx4 v20, s[20:23], s54 offen offset:2048 lds
s_add_u32 s54, s54, 196608
s_waitcnt vmcnt(12)
s_cmp_lt_u32 s14, 16
s_cselect_b32 s62, 0, 4096
v_mov_b32 v154, 1
v_lshlrev_b32 v155, 8, v1
v_permlane16_swap_b32 v128, v130
v_permlane16_swap_b32 v129, v131
v_permlane16_swap_b32 v132, v134
v_permlane16_swap_b32 v133, v135
v_permlane16_swap_b32 v136, v138
v_permlane16_swap_b32 v137, v139
v_permlane16_swap_b32 v140, v142
v_permlane16_swap_b32 v141, v143
buffer_atomic_add v154, v155, s[40:43], s62 offen
v_lshlrev_b32 v64, 16, v128
v_and_b32 v65, 0xffff0000, v128
v_lshlrev_b32 v66, 16, v129
v_and_b32 v67, 0xffff0000, v129
v_lshlrev_b32 v68, 16, v130
v_and_b32 v69, 0xffff0000, v130
v_lshlrev_b32 v70, 16, v131
v_and_b32 v71, 0xffff0000, v131
v_lshlrev_b32 v72, 16, v132
v_and_b32 v73, 0xffff0000, v132
v_lshlrev_b32 v74, 16, v133
v_and_b32 v75, 0xffff0000, v133
v_lshlrev_b32 v76, 16, v134
v_and_b32 v77, 0xffff0000, v134
v_lshlrev_b32 v78, 16, v135
v_and_b32 v79, 0xffff0000, v135
v_lshlrev_b32 v80, 16, v136
v_and_b32 v81, 0xffff0000, v136
v_lshlrev_b32 v82, 16, v137
v_and_b32 v83, 0xffff0000, v137
v_lshlrev_b32 v84, 16, v138
v_and_b32 v85, 0xffff0000, v138
v_lshlrev_b32 v86, 16, v139
v_and_b32 v87, 0xffff0000, v139
v_lshlrev_b32 v88, 16, v140
v_and_b32 v89, 0xffff0000, v140
v_lshlrev_b32 v90, 16, v141
v_and_b32 v91, 0xffff0000, v141
v_lshlrev_b32 v92, 16, v142
v_and_b32 v93, 0xffff0000, v142
v_lshlrev_b32 v94, 16, v143
v_and_b32 v95, 0xffff0000, v143
s_lshl_b32 s64, s6, 14
s_lshl_b32 s65, s49, 13
s_add_u32 s64, s64, s65
s_lshl_b32 s65, s7, 9
s_add_u32 s64, s64, s65
s_lshl_b32 s65, s48, 8
s_add_u32 s64, s64, s65
s_add_u32 s64, s64, 29360128
v_and_b32 v152, 31, v1
v_lshlrev_b32 v152, 3, v152
v_lshrrev_b32 v153, 5, v1
v_lshl_add_u32 v152, v153, 28, v152
s_lshl_b32 s62, s7, 15
s_add_u32 s62, s62, 0
s_add_u32 s63, s62, 16384
v_pk_mul_f32 v[146:147], v[64:65], v[64:65]
v_pk_mul_f32 v[150:151], v[80:81], v[80:81]
v_pk_fma_f32 v[146:147], v[66:67], v[66:67], v[146:147]
v_pk_add_f32 v[144:145], v[64:65], v[66:67]
v_pk_fma_f32 v[150:151], v[82:83], v[82:83], v[150:151]
v_pk_add_f32 v[148:149], v[80:81], v[82:83]
v_pk_fma_f32 v[146:147], v[68:69], v[68:69], v[146:147]
v_pk_add_f32 v[144:145], v[144:145], v[68:69]
v_pk_fma_f32 v[150:151], v[84:85], v[84:85], v[150:151]
v_pk_add_f32 v[148:149], v[148:149], v[84:85]
v_pk_fma_f32 v[146:147], v[70:71], v[70:71], v[146:147]
v_pk_add_f32 v[144:145], v[144:145], v[70:71]
v_pk_fma_f32 v[150:151], v[86:87], v[86:87], v[150:151]
v_pk_add_f32 v[148:149], v[148:149], v[86:87]
v_pk_fma_f32 v[146:147], v[72:73], v[72:73], v[146:147]
v_pk_add_f32 v[144:145], v[144:145], v[72:73]
v_pk_fma_f32 v[150:151], v[88:89], v[88:89], v[150:151]
v_pk_add_f32 v[148:149], v[148:149], v[88:89]
v_pk_fma_f32 v[146:147], v[74:75], v[74:75], v[146:147]
v_pk_add_f32 v[144:145], v[144:145], v[74:75]
v_pk_fma_f32 v[150:151], v[90:91], v[90:91], v[150:151]
v_pk_add_f32 v[148:149], v[148:149], v[90:91]
v_pk_fma_f32 v[146:147], v[76:77], v[76:77], v[146:147]
v_pk_add_f32 v[144:145], v[144:145], v[76:77]
v_pk_fma_f32 v[150:151], v[92:93], v[92:93], v[150:151]
v_pk_add_f32 v[148:149], v[148:149], v[92:93]
v_pk_fma_f32 v[146:147], v[78:79], v[78:79], v[146:147]
v_pk_add_f32 v[144:145], v[144:145], v[78:79]
v_pk_fma_f32 v[150:151], v[94:95], v[94:95], v[150:151]
v_pk_add_f32 v[148:149], v[148:149], v[94:95]
v_add_f32 v144, v144, v145
v_add_f32 v146, v146, v147
v_add_f32 v148, v148, v149
v_add_f32 v150, v150, v151
s_nop 0
v_permlane16_swap_b32 v144, v148
v_permlane16_swap_b32 v146, v150
v_add_f32 v144, v144, v148
v_add_f32 v146, v146, v150
s_nop 1
v_permlane32_swap_b32 v144, v146
v_add_f32 v144, v144, v146
s_nop 1
v_permlane32_swap_b32 v144, v145
buffer_store_dwordx2 v[144:145], v152, s[16:19], s64 offen sc1
s_lshl_b32 s62, s2, 10
s_add_u32 s62, s62, 31457280
s_cmp_eq_u32 s3, 0
s_cselect_b32 s62, s62, 268435456
buffer_store_dwordx4 v[156:159], v27, s[16:19], s62 offen sc1
v_accvgpr_write_b32 a224, v64
v_accvgpr_write_b32 a225, v65
v_accvgpr_write_b32 a226, v66
v_accvgpr_write_b32 a227, v67
v_accvgpr_write_b32 a228, v68
v_accvgpr_write_b32 a229, v69
v_accvgpr_write_b32 a230, v70
v_accvgpr_write_b32 a231, v71
v_accvgpr_write_b32 a232, v72
v_accvgpr_write_b32 a233, v73
v_accvgpr_write_b32 a234, v74
v_accvgpr_write_b32 a235, v75
v_accvgpr_write_b32 a236, v76
v_accvgpr_write_b32 a237, v77
v_accvgpr_write_b32 a238, v78
v_accvgpr_write_b32 a239, v79
v_accvgpr_write_b32 a240, v80
v_accvgpr_write_b32 a241, v81
v_accvgpr_write_b32 a242, v82
v_accvgpr_write_b32 a243, v83
v_accvgpr_write_b32 a244, v84
v_accvgpr_write_b32 a245, v85
v_accvgpr_write_b32 a246, v86
v_accvgpr_write_b32 a247, v87
v_accvgpr_write_b32 a248, v88
v_accvgpr_write_b32 a249, v89
v_accvgpr_write_b32 a250, v90
v_accvgpr_write_b32 a251, v91
v_accvgpr_write_b32 a252, v92
v_accvgpr_write_b32 a253, v93
v_accvgpr_write_b32 a254, v94
v_accvgpr_write_b32 a255, v95
s_add_u32 m0, s55, 18496
s_nop 0
buffer_load_dwordx4 v21, s[36:39], s52 offen lds
buffer_load_dwordx4 v28, s[36:39], s52 offen offset:1024 lds
buffer_load_dword v22, s[36:39], s52 offen offset:2048 lds
s_add_u32 s52, s52, 128
s_add_u32 m0, s55, 20800
s_nop 0
buffer_load_dwordx4 v21, s[36:39], s53 offen lds
buffer_load_dwordx4 v28, s[36:39], s53 offen offset:1024 lds
buffer_load_dword v29, s[36:39], s53 offen offset:2048 lds
s_add_u32 s53, s53, 128
s_add_u32 m0, s56, 73984
s_nop 0
buffer_load_dwordx4 v18, s[20:23], s54 offen lds
buffer_load_dwordx4 v19, s[20:23], s54 offen offset:1024 lds
buffer_load_dwordx4 v20, s[20:23], s54 offen offset:2048 lds
s_add_u32 s54, s54, 196608
s_waitcnt vmcnt(15) lgkmcnt(0)
s_barrier
ds_read_b128 a[0:3], v23
RD 4,23,2304
RD 8,23,4608
RD 12,23,6912
TR 20,25,49664
TR 22,25,50176
TR 24,25,49696
TR 26,25,50208
ds_read_b128 a[16:19], v24
TR 28,25,50688
TR 30,25,51200
TR 32,25,50720
TR 34,25,51232
TR 36,25,51712
TR 38,25,52224
TR 40,25,51744
TR 42,25,52256
s_waitcnt vmcnt(12) lgkmcnt(8)
s_barrier
v_mfma_f32_16x16x32_bf16 v[60:63], a[20:23], a[0:3], 0
ds_read_b128 a[44:47], v30
RD 48,30,2304
v_mfma_f32_16x16x32_bf16 v[76:79], a[24:27], a[0:3], 0
s_add_u32 m0, s56, 86400
v_mfma_f32_16x16x32_bf16 v[80:83], a[24:27], a[4:7], 0
buffer_load_dwordx4 v18, s[20:23], s54 offen lds
v_mfma_f32_16x16x32_bf16 v[64:67], a[20:23], a[4:7], 0
s_sub_u32 s47, s47, 1
s_cbranch_scc1 .Lx18
.Lx18b:
v_mfma_f32_16x16x32_bf16 v[68:71], a[20:23], a[8:11], 0
buffer_load_dwordx4 v19, s[20:23], s54 offen offset:1024 lds
v_mfma_f32_16x16x32_bf16 v[84:87], a[24:27], a[8:11], 0
RD 52,30,4608
RD 56,30,6912
v_mfma_f32_16x16x32_bf16 v[88:91], a[24:27], a[12:15], 0
TR 64,25,62080
v_mfma_f32_16x16x32_bf16 v[72:75], a[20:23], a[12:15], 0
TR 66,25,62592
s_waitcnt lgkmcnt(6)
v_mfma_f32_16x16x32_bf16 v[244:247], a[24:27], a[16:19], 0
buffer_load_dwordx4 v20, s[20:23], s54 offen offset:2048 lds
v_mfma_f32_16x16x32_bf16 v[104:107], a[28:31], a[12:15], 0
s_add_u32 s54, s54, 196608
s_add_u32 m0, s55, 36992
v_mfma_f32_16x16x32_bf16 v[120:123], a[32:35], a[12:15], 0
buffer_load_dwordx4 v21, s[36:39], s52 offen lds
v_mfma_f32_16x16x32_bf16 v[116:119], a[32:35], a[8:11], 0
TR 68,25,62112
TR 70,25,62624
v_mfma_f32_16x16x32_bf16 v[100:103], a[28:31], a[8:11], 0
ds_read_b128 a[60:63], v31
v_mfma_f32_16x16x32_bf16 v[96:99], a[28:31], a[4:7], 0
buffer_load_dwordx4 v28, s[36:39], s52 offen offset:1024 lds
v_mfma_f32_16x16x32_bf16 v[112:115], a[32:35], a[4:7], 0
TR 72,25,63104
v_mfma_f32_16x16x32_bf16 v[108:111], a[32:35], a[0:3], 0
buffer_load_dword v22, s[36:39], s52 offen offset:2048 lds
v_mfma_f32_16x16x32_bf16 v[92:95], a[28:31], a[0:3], 0
TR 74,25,63616
s_add_u32 s52, s52, 128
v_mfma_f32_16x16x32_bf16 v[124:127], a[0:3], a[36:39], 0
TR 76,25,63136
s_add_u32 m0, s55, 39296
v_mfma_f32_16x16x32_bf16 v[140:143], a[0:3], a[40:43], 0
buffer_load_dwordx4 v21, s[36:39], s53 offen lds
v_mfma_f32_16x16x32_bf16 v[144:147], a[4:7], a[40:43], 0
TR 78,25,63648
v_mfma_f32_16x16x32_bf16 v[128:131], a[4:7], a[36:39], 0
TR 80,25,64128
v_mfma_f32_16x16x32_bf16 v[132:135], a[8:11], a[36:39], 0
buffer_load_dwordx4 v28, s[36:39], s53 offen offset:1024 lds
v_mfma_f32_16x16x32_bf16 v[148:151], a[8:11], a[40:43], 0
TR 82,25,64640
TR 84,25,64160
v_mfma_f32_16x16x32_bf16 v[152:155], a[12:15], a[40:43], 0
TR 86,25,64672
v_mfma_f32_16x16x32_bf16 v[136:139], a[12:15], a[36:39], 0
buffer_load_dword v29, s[36:39], s53 offen offset:2048 lds
v_mfma_f32_16x16x32_bf16 v[156:159], a[16:19], a[36:39], 0
s_add_u32 s53, s53, 128
v_mfma_f32_16x16x32_bf16 v[160:163], a[16:19], a[40:43], 0
s_waitcnt vmcnt(9) lgkmcnt(8)
s_barrier
MAA 60,64,44
RD 0,23,18496
RD 4,23,20800
MAA 76,68,44
s_add_u32 m0, s56, 98816
MAA 80,68,48
buffer_load_dwordx4 v18, s[20:23], s54 offen lds
MAA 64,64,48
RD 8,23,23104
RD 12,23,25408
MAA 68,64,52
buffer_load_dwordx4 v19, s[20:23], s54 offen offset:1024 lds
MAA 84,68,52
ds_read_b64_tr_b16 a[20:21], v25
MAA 88,68,56
TR 22,25,512
MAA 72,64,56
TR 24,25,32
s_waitcnt lgkmcnt(7)
MAA 244,68,60
buffer_load_dwordx4 v20, s[20:23], s54 offen offset:2048 lds
MAA 104,72,56
s_add_u32 s54, s54, 196608
s_add_u32 m0, s56, 111232
MAA 120,76,56
buffer_load_dwordx4 v18, s[20:23], s54 offen lds
MAA 116,76,52
TR 26,25,544
MAA 100,72,52
RD 16,24,18496
TR 28,25,1024
MAA 96,72,48
buffer_load_dwordx4 v19, s[20:23], s54 offen offset:1024 lds
MAA 112,76,48
TR 30,25,1536
MAA 108,76,44
buffer_load_dwordx4 v20, s[20:23], s54 offen offset:2048 lds
MAA 92,72,44
s_add_u32 s54, s54, 196608
MAA 124,44,80
TR 32,25,1056
s_add_u32 m0, s55, 55488
MAA 140,44,84
buffer_load_dwordx4 v21, s[36:39], s52 offen lds
MAA 144,48,84
TR 34,25,1568
MAA 128,48,80
TR 36,25,2048
MAA 132,52,80
buffer_load_dwordx4 v28, s[36:39], s52 offen offset:1024 lds
MAA 148,52,84
TR 38,25,2560
TR 40,25,2080
MAA 152,56,84
TR 42,25,2592
MAA 136,56,80
buffer_load_dword v22, s[36:39], s52 offen offset:2048 lds
MAA 156,60,80
s_add_u32 s52, s52, 128
MAA 160,60,84
s_waitcnt vmcnt(15) lgkmcnt(8)
s_barrier
MAA 60,20,0
RD 44,30,18496
RD 48,30,20800
MAA 76,24,0
s_add_u32 m0, s55, 57792
MAA 80,24,4
buffer_load_dwordx4 v21, s[36:39], s53 offen lds
MAA 64,20,4
s_sub_u32 s47, s47, 1
s_cbranch_scc1 .Lx19
.Lx19b:
MAA 68,20,8
buffer_load_dwordx4 v28, s[36:39], s53 offen offset:1024 lds
MAA 84,24,8
RD 52,30,23104
RD 56,30,25408
MAA 88,24,12
TR 64,25,12416
MAA 72,20,12
TR 66,25,12928
s_waitcnt lgkmcnt(6)
MAA 244,24,16
buffer_load_dword v29, s[36:39], s53 offen offset:2048 lds
MAA 104,28,12
s_add_u32 s53, s53, 128
s_add_u32 m0, s56, 123648
MAA 120,32,12
buffer_load_dwordx4 v18, s[20:23], s54 offen lds
MAA 116,32,8
TR 68,25,12448
TR 70,25,12960
MAA 100,28,8
RD 60,31,18496
MAA 96,28,4
buffer_load_dwordx4 v19, s[20:23], s54 offen offset:1024 lds
MAA 112,32,4
TR 72,25,13440
MAA 108,32,0
buffer_load_dwordx4 v20, s[20:23], s54 offen offset:2048 lds
MAA 92,28,0
TR 74,25,13952
s_add_u32 s54, s54, 196608
MAA 124,0,36
TR 76,25,13472
s_add_u32 m0, s56, 136064
MAA 140,0,40
buffer_load_dwordx4 v18, s[20:23], s54 offen lds
MAA 144,4,40
TR 78,25,13984
MAA 128,4,36
TR 80,25,14464
MAA 132,8,36
buffer_load_dwordx4 v19, s[20:23], s54 offen offset:1024 lds
MAA 148,8,40
TR 82,25,14976
TR 84,25,14496
MAA 152,12,40
TR 86,25,15008
MAA 136,12,36
buffer_load_dwordx4 v20, s[20:23], s54 offen offset:2048 lds
MAA 156,16,36
s_add_u32 s54, s54, 196608
MAA 160,16,40
s_waitcnt vmcnt(15) lgkmcnt(8)
s_barrier
MAA 60,64,44
RD 0,23,36992
RD 4,23,39296
MAA 76,68,44
s_add_u32 m0, s55, 0
MAA 80,68,48
buffer_load_dwordx4 v21, s[36:39], s52 offen lds
MAA 64,64,48
RD 8,23,41600
RD 12,23,43904
MAA 68,64,52
buffer_load_dwordx4 v28, s[36:39], s52 offen offset:1024 lds
MAA 84,68,52
TR 20,25,24832
MAA 88,68,56
TR 22,25,25344
MAA 72,64,56
TR 24,25,24864
s_waitcnt lgkmcnt(7)
MAA 244,68,60
buffer_load_dword v22, s[36:39], s52 offen offset:2048 lds
MAA 104,72,56
TR 26,25,25376
s_add_u32 s52, s52, 128
s_add_u32 m0, s55, 2304
MAA 120,76,56
buffer_load_dwordx4 v21, s[36:39], s53 offen lds
MAA 116,76,52
RD 16,24,36992
MAA 100,72,52
buffer_load_dwordx4 v28, s[36:39], s53 offen offset:1024 lds
MAA 96,72,48
TR 28,25,25856
MAA 112,76,48
buffer_load_dword v29, s[36:39], s53 offen offset:2048 lds
MAA 108,76,44
TR 30,25,26368
s_add_u32 s53, s53, 128
MAA 92,72,44
TR 32,25,25888
s_add_u32 m0, s56, 73984
MAA 124,44,80
buffer_load_dwordx4 v18, s[20:23], s54 offen lds
MAA 140,44,84
TR 34,25,26400
MAA 144,48,84
buffer_load_dwordx4 v19, s[20:23], s54 offen offset:1024 lds
MAA 128,48,80
TR 36,25,26880
MAA 132,52,80
TR 38,25,27392
TR 40,25,26912
MAA 148,52,84
buffer_load_dwordx4 v20, s[20:23], s54 offen offset:2048 lds
MAA 152,56,84
s_add_u32 s54, s54, 196608
MAA 136,56,80
buffer_load_dword v37, v34, s[40:43], 0 offen sc1
MAA 156,60,80
TR 42,25,27424
MAA 160,60,84
s_waitcnt vmcnt(22) lgkmcnt(8)
s_barrier
MAA 60,20,0
RD 44,30,36992
RD 48,30,39296
MAA 76,24,0
s_add_u32 m0, s56, 86400
MAA 80,24,4
buffer_load_dwordx4 v18, s[20:23], s54 offen lds
MAA 64,20,4
s_sub_u32 s47, s47, 1
s_cbranch_scc1 .Lx20
.Lx20b:
MAA 68,20,8
buffer_load_dwordx4 v19, s[20:23], s54 offen offset:1024 lds
MAA 84,24,8
RD 52,30,41600
RD 56,30,43904
MAA 88,24,12
TR 64,25,37248
MAA 72,20,12
TR 66,25,37760
s_waitcnt lgkmcnt(6)
MAA 244,24,16
buffer_load_dwordx4 v20, s[20:23], s54 offen offset:2048 lds
MAA 104,28,12
s_add_u32 s54, s54, 196608
s_add_u32 m0, s55, 18496
MAA 120,32,12
buffer_load_dwordx4 v21, s[36:39], s52 offen lds
MAA 116,32,8
TR 68,25,37280
TR 70,25,37792
MAA 100,28,8
RD 60,31,36992
MAA 96,28,4
buffer_load_dwordx4 v28, s[36:39], s52 offen offset:1024 lds
MAA 112,32,4
TR 72,25,38272
MAA 108,32,0
buffer_load_dword v22, s[36:39], s52 offen offset:2048 lds
MAA 92,28,0
TR 74,25,38784
s_add_u32 s52, s52, 128
MAA 124,0,36
TR 76,25,38304
s_add_u32 m0, s55, 20800
MAA 140,0,40
buffer_load_dwordx4 v21, s[36:39], s53 offen lds
MAA 144,4,40
TR 78,25,38816
MAA 128,4,36
TR 80,25,39296
MAA 132,8,36
buffer_load_dwordx4 v28, s[36:39], s53 offen offset:1024 lds
MAA 148,8,40
TR 82,25,39808
TR 84,25,39328
MAA 152,12,40
TR 86,25,39840
MAA 136,12,36
buffer_load_dword v29, s[36:39], s53 offen offset:2048 lds
MAA 156,16,36
s_add_u32 s53, s53, 128
MAA 160,16,40
s_waitcnt vmcnt(22) lgkmcnt(8)
s_barrier
MAA 60,64,44
RD 0,23,55488
MAA 76,68,44
RD 4,23,57792
s_add_u32 m0, s56, 98816
MAA 80,68,48
buffer_load_dwordx4 v18, s[20:23], s54 offen lds
MAA 64,64,48
RD 8,23,60096
MAA 68,64,52
RD 12,23,62400
MAA 84,68,52
TR 20,25,49664
MAA 88,68,56
buffer_load_dwordx4 v19, s[20:23], s54 offen offset:1024 lds
MAA 72,64,56
TR 22,25,50176
s_waitcnt lgkmcnt(6)
MAA 244,68,60
MAA 104,72,56
TR 24,25,49696
MAA 120,76,56
buffer_load_dwordx4 v20, s[20:23], s54 offen offset:2048 lds
MAA 116,76,52
TR 26,25,50208
s_add_u32 s54, s54, 196608
MAA 100,72,52
RD 16,24,55488
MAA 96,72,48
TR 28,25,50688
s_add_u32 m0, s55, 36992
MAA 112,76,48
buffer_load_dwordx4 v21, s[36:39], s52 offen lds
MAA 108,76,44
TR 30,25,51200
MAA 92,72,44
TR 32,25,50720
MAA 124,44,80
MAA 140,44,84
buffer_load_dwordx4 v28, s[36:39], s52 offen offset:1024 lds
MAA 144,48,84
TR 34,25,51232
MAA 128,48,80
TR 36,25,51712
MAA 132,52,80
TR 38,25,52224
MAA 148,52,84
buffer_load_dword v22, s[36:39], s52 offen offset:2048 lds
MAA 152,56,84
TR 40,25,51744
s_add_u32 s52, s52, 128
MAA 136,56,80
TR 42,25,52256
MAA 156,60,80
MAA 160,60,84
s_waitcnt vmcnt(25) lgkmcnt(8)
s_barrier
MAA 60,20,0
RD 44,30,55488
MAA 76,24,0
RD 48,30,57792
s_add_u32 m0, s56, 111232
MAA 80,24,4
buffer_load_dwordx4 v18, s[20:23], s54 offen lds
MAA 64,20,4
s_sub_u32 s47, s47, 1
s_cbranch_scc1 .Lx21
.Lx21b:
MAA 68,20,8
RD 52,30,60096
MAA 84,24,8
RD 56,30,62400
MAA 88,24,12
buffer_load_dwordx4 v19, s[20:23], s54 offen offset:1024 lds
MAA 72,20,12
TR 64,25,62080
s_waitcnt lgkmcnt(5)
MAA 244,24,16
TR 66,25,62592
MAA 104,28,12
TR 68,25,62112
MAA 120,32,12
buffer_load_dwordx4 v20, s[20:23], s54 offen offset:2048 lds
MAA 116,32,8
TR 70,25,62624
s_add_u32 s54, s54, 196608
MAA 100,28,8
RD 60,31,55488
MAA 96,28,4
s_add_u32 m0, s55, 39296
MAA 112,32,4
buffer_load_dwordx4 v21, s[36:39], s53 offen lds
MAA 108,32,0
TR 72,25,63104
MAA 92,28,0
TR 74,25,63616
MAA 124,0,36
TR 76,25,63136
MAA 140,0,40
buffer_load_dwordx4 v28, s[36:39], s53 offen offset:1024 lds
MAA 144,4,40
TR 78,25,63648
MAA 128,4,36
TR 80,25,64128
MAA 132,8,36
TR 82,25,64640
MAA 148,8,40
buffer_load_dword v29, s[36:39], s53 offen offset:2048 lds
MAA 152,12,40
TR 84,25,64160
s_add_u32 s53, s53, 128
MAA 136,12,36
TR 86,25,64672
MAA 156,16,36
MAA 160,16,40
s_waitcnt vmcnt(22) lgkmcnt(8)
s_barrier
s_waitcnt vmcnt(21)
v_cmp_gt_u32 vcc, v35, v37
s_nop 0
s_cbranch_vccnz .Lsp22
.Lsp22b:
v_mov_b32 v37, 0
MAA 60,64,44
ds_read_b128 a[0:3], v23
MAA 76,68,44
RD 4,23,2304
MAA 80,68,48
buffer_atomic_add v38, v32, s[16:19], 0 offen
MAA 64,64,48
RD 8,23,4608
MAA 68,64,52
RD 12,23,6912
s_add_u32 m0, s56, 123648
MAA 84,68,52
buffer_load_dwordx4 v18, s[20:23], s54 offen lds
MAA 88,68,56
ds_read_b64_tr_b16 a[20:21], v25
MAA 72,64,56
TR 22,25,512
s_waitcnt lgkmcnt(6)
MAA 244,68,60
TR 24,25,32
MAA 104,72,56
buffer_load_dwordx4 v19, s[20:23], s54 offen offset:1024 lds
MAA 120,76,56
TR 26,25,544
MAA 116,76,52
ds_read_b128 a[16:19], v24
MAA 100,72,52
buffer_load_dwordx4 v20, s[20:23], s54 offen offset:2048 lds
MAA 96,72,48
s_add_u32 s54, s54, 196608
MAA 112,76,48
TR 28,25,1024
MAA 108,76,44
TR 30,25,1536
s_add_u32 m0, s55, 55488
MAA 92,72,44
buffer_load_dwordx4 v21, s[36:39], s52 offen lds
MAA 124,44,80
TR 32,25,1056
MAA 140,44,84
TR 34,25,1568
MAA 144,48,84
buffer_load_dwordx4 v28, s[36:39], s52 offen offset:1024 lds
MAA 128,48,80
TR 36,25,2048
MAA 132,52,80
TR 38,25,2560
MAA 148,52,84
TR 40,25,2080
MAA 152,56,84
buffer_load_dword v22, s[36:39], s52 offen offset:2048 lds
MAA 136,56,80
TR 42,25,2592
s_add_u32 s52, s52, 128
MAA 156,60,80
MAA 160,60,84
s_waitcnt vmcnt(25) lgkmcnt(8)
s_barrier
MAA 60,20,0
ds_read_b128 a[44:47], v30
MAA 76,24,0
RD 48,30,2304
s_add_u32 m0, s56, 136064
MAA 80,24,4
buffer_load_dwordx4 v18, s[20:23], s54 offen lds
MAA 64,20,4
s_sub_u32 s47, s47, 1
s_cbranch_scc1 .Lx23
.Lx23b:
MAA 68,20,8
RD 52,30,4608
MAA 84,24,8
RD 56,30,6912
MAA 88,24,12
buffer_load_dwordx4 v19, s[20:23], s54 offen offset:1024 lds
MAA 72,20,12
TR 64,25,12416
s_waitcnt lgkmcnt(5)
MAA 244,24,16
TR 66,25,12928
MAA 104,28,12
TR 68,25,12448
MAA 120,32,12
buffer_load_dwordx4 v20, s[20:23], s54 offen offset:2048 lds
MAA 116,32,8
TR 70,25,12960
s_add_u32 s54, s54, 196608
MAA 100,28,8
ds_read_b128 a[60:63], v31
MAA 96,28,4
s_add_u32 m0, s55, 57792
MAA 112,32,4
buffer_load_dwordx4 v21, s[36:39], s53 offen lds
MAA 108,32,0
TR 72,25,13440
MAA 92,28,0
TR 74,25,13952
MAA 124,0,36
TR 76,25,13472
MAA 140,0,40
buffer_load_dwordx4 v28, s[36:39], s53 offen offset:1024 lds
MAA 144,4,40
TR 78,25,13984
MAA 128,4,36
TR 80,25,14464
MAA 132,8,36
TR 82,25,14976
MAA 148,8,40
buffer_load_dword v29, s[36:39], s53 offen offset:2048 lds
MAA 152,12,40
TR 84,25,14496
s_add_u32 s53, s53, 128
MAA 136,12,36
TR 86,25,15008
MAA 156,16,36
MAA 160,16,40
s_waitcnt vmcnt(22) lgkmcnt(8)
s_barrier
MAA 60,64,44
RD 0,23,18496
MAA 76,68,44
RD 4,23,20800
s_add_u32 m0, s56, 73984
MAA 80,68,48
buffer_load_dwordx4 v18, s[20:23], s54 offen lds
MAA 64,64,48
RD 8,23,23104
MAA 68,64,52
RD 12,23,25408
MAA 84,68,52
TR 20,25,24832
MAA 88,68,56
buffer_load_dwordx4 v19, s[20:23], s54 offen offset:1024 lds
MAA 72,64,56
TR 22,25,25344
s_waitcnt lgkmcnt(6)
MAA 244,68,60
MAA 104,72,56
TR 24,25,24864
MAA 120,76,56
buffer_load_dwordx4 v20, s[20:23], s54 offen offset:2048 lds
MAA 116,76,52
TR 26,25,25376
s_add_u32 s54, s54, 196608
MAA 100,72,52
RD 16,24,18496
MAA 96,72,48
TR 28,25,25856
s_add_u32 m0, s55, 0
MAA 112,76,48
buffer_load_dwordx4 v21, s[36:39], s52 offen lds
MAA 108,76,44
TR 30,25,26368
MAA 92,72,44
TR 32,25,25888
MAA 124,44,80
MAA 140,44,84
buffer_load_dwordx4 v28, s[36:39], s52 offen offset:1024 lds
MAA 144,48,84
TR 34,25,26400
MAA 128,48,80
TR 36,25,26880
MAA 132,52,80
TR 38,25,27392
MAA 148,52,84
buffer_load_dword v22, s[36:39], s52 offen offset:2048 lds
MAA 152,56,84
TR 40,25,26912
s_add_u32 s52, s52, 128
MAA 136,56,80
TR 42,25,27424
MAA 156,60,80
MAA 160,60,84
s_waitcnt vmcnt(22) lgkmcnt(8)
s_barrier
MAA 60,20,0
RD 44,30,18496
MAA 76,24,0
RD 48,30,20800
s_add_u32 m0, s56, 86400
MAA 80,24,4
buffer_load_dwordx4 v18, s[20:23], s54 offen lds
MAA 64,20,4
s_sub_u32 s47, s47, 1
s_cbranch_scc1 .Lx24
.Lx24b:
MAA 68,20,8
RD 52,30,23104
MAA 84,24,8
RD 56,30,25408
MAA 88,24,12
buffer_load_dwordx4 v19, s[20:23], s54 offen offset:1024 lds
MAA 72,20,12
TR 64,25,37248
s_waitcnt lgkmcnt(5)
MAA 244,24,16
TR 66,25,37760
MAA 104,28,12
TR 68,25,37280
MAA 120,32,12
buffer_load_dwordx4 v20, s[20:23], s54 offen offset:2048 lds
MAA 116,32,8
TR 70,25,37792
s_add_u32 s54, s54, 196608
MAA 100,28,8
RD 60,31,18496
MAA 96,28,4
s_add_u32 m0, s55, 2304
MAA 112,32,4
buffer_load_dwordx4 v21, s[36:39], s53 offen lds
MAA 108,32,0
TR 72,25,38272
MAA 92,28,0
TR 74,25,38784
MAA 124,0,36
TR 76,25,38304
MAA 140,0,40
buffer_load_dwordx4 v28, s[36:39], s53 offen offset:1024 lds
MAA 144,4,40
TR 78,25,38816
MAA 128,4,36
TR 80,25,39296
MAA 132,8,36
TR 82,25,39808
MAA 148,8,40
buffer_load_dword v29, s[36:39], s53 offen offset:2048 lds
MAA 152,12,40
TR 84,25,39328
s_add_u32 s53, s53, 128
MAA 136,12,36
TR 86,25,39840
MAA 156,16,36
MAA 160,16,40
s_waitcnt vmcnt(21) lgkmcnt(8)
s_barrier
MAA 60,64,44
RD 0,23,36992
MAA 76,68,44
RD 4,23,39296
s_add_u32 m0, s56, 98816
MAA 80,68,48
buffer_load_dwordx4 v18, s[20:23], s54 offen lds
MAA 64,64,48
RD 8,23,41600
MAA 68,64,52
RD 12,23,43904
MAA 84,68,52
TR 20,25,49664
MAA 88,68,56
buffer_load_dwordx4 v19, s[20:23], s54 offen offset:1024 lds
MAA 72,64,56
TR 22,25,50176
s_waitcnt lgkmcnt(6)
MAA 244,68,60
MAA 104,72,56
TR 24,25,49696
MAA 120,76,56
buffer_load_dwordx4 v20, s[20:23], s54 offen offset:2048 lds
MAA 116,76,52
TR 26,25,50208
s_add_u32 s54, s54, 196608
MAA 100,72,52
RD 16,24,36992
MAA 96,72,48
TR 28,25,50688
s_add_u32 m0, s55, 18496
MAA 112,76,48
buffer_load_dwordx4 v21, s[36:39], s52 offen lds
MAA 108,76,44
TR 30,25,51200
MAA 92,72,44
TR 32,25,50720
MAA 124,44,80
MAA 140,44,84
buffer_load_dwordx4 v28, s[36:39], s52 offen offset:1024 lds
MAA 144,48,84
TR 34,25,51232
MAA 128,48,80
TR 36,25,51712
MAA 132,52,80
TR 38,25,52224
MAA 148,52,84
buffer_load_dword v22, s[36:39], s52 offen offset:2048 lds
MAA 152,56,84
TR 40,25,51744
s_add_u32 s52, s52, 128
MAA 136,56,80
TR 42,25,52256
MAA 156,60,80
MAA 160,60,84
s_waitcnt vmcnt(21) lgkmcnt(8)
s_barrier
MAA 60,20,0
RD 44,30,36992
MAA 76,24,0
RD 48,30,39296
s_add_u32 m0, s56, 111232
MAA 80,24,4
buffer_load_dwordx4 v18, s[20:23], s54 offen lds
MAA 64,20,4
s_sub_u32 s47, s47, 1
s_cbranch_scc1 .Lx25
.Lx25b:
MAA 68,20,8
RD 52,30,41600
MAA 84,24,8
buffer_load_dwordx4 v19, s[20:23], s54 offen offset:1024 lds
MAA 88,24,12
RD 56,30,43904
MAA 72,20,12
TR 64,25,62080
s_waitcnt lgkmcnt(5)
MAA 244,24,16
TR 66,25,62592
MAA 104,28,12
buffer_load_dwordx4 v20, s[20:23], s54 offen offset:2048 lds
MAA 120,32,12
TR 68,25,62112
s_add_u32 s54, s54, 196608
MAA 116,32,8
TR 70,25,62624
s_add_u32 m0, s55, 20800
MAA 100,28,8
buffer_load_dwordx4 v21, s[36:39], s53 offen lds
MAA 96,28,4
RD 60,31,36992
MAA 112,32,4
TR 72,25,63104
MAA 108,32,0
TR 74,25,63616
MAA 92,28,0
buffer_load_dwordx4 v28, s[36:39], s53 offen offset:1024 lds
MAA 124,0,36
TR 76,25,63136
MAA 140,0,40
TR 78,25,63648
MAA 144,4,40
buffer_load_dword v29, s[36:39], s53 offen offset:2048 lds
MAA 128,4,36
TR 80,25,64128
s_add_u32 s53, s53, 128
MAA 132,8,36
TR 82,25,64640
MAA 148,8,40
TR 84,25,64160
MAA 152,12,40
buffer_atomic_add v37, v33, s[16:19], 0 offen sc0
MAA 136,12,36
TR 86,25,64672
MAA 156,16,36
MAA 160,16,40
s_waitcnt vmcnt(22) lgkmcnt(8)
s_barrier
MAA 60,64,44
RD 0,23,55488
MAA 76,68,44
RD 4,23,57792
s_add_u32 m0, s56, 123648
MAA 80,68,48
buffer_load_dwordx4 v18, s[20:23], s54 offen lds
MAA 64,64,48
RD 8,23,60096
MAA 68,64,52
RD 12,23,62400
MAA 84,68,52
ds_read_b64_tr_b16 a[20:21], v25
MAA 88,68,56
buffer_load_dwordx4 v19, s[20:23], s54 offen offset:1024 lds
MAA 72,64,56
TR 22,25,512
s_waitcnt lgkmcnt(6)
MAA 244,68,60
MAA 104,72,56
TR 24,25,32
MAA 120,76,56
buffer_load_dwordx4 v20, s[20:23], s54 offen offset:2048 lds
MAA 116,76,52
TR 26,25,544
s_add_u32 s54, s54, 196608
MAA 100,72,52
RD 16,24,55488
MAA 96,72,48
TR 28,25,1024
s_add_u32 m0, s55, 36992
MAA 112,76,48
buffer_load_dwordx4 v21, s[36:39], s52 offen lds
MAA 108,76,44
TR 30,25,1536
MAA 92,72,44
TR 32,25,1056
MAA 124,44,80
MAA 140,44,84
buffer_load_dwordx4 v28, s[36:39], s52 offen offset:1024 lds
MAA 144,48,84
TR 34,25,1568
MAA 128,48,80
TR 36,25,2048
MAA 132,52,80
TR 38,25,2560
MAA 148,52,84
buffer_load_dword v22, s[36:39], s52 offen offset:2048 lds
MAA 152,56,84
TR 40,25,2080
s_add_u32 s52, s52, 128
MAA 136,56,80
TR 42,25,2592
MAA 156,60,80
MAA 160,60,84
s_waitcnt vmcnt(22) lgkmcnt(8)
s_barrier
MAA 60,20,0
RD 44,30,55488
MAA 76,24,0
RD 48,30,57792
s_add_u32 m0, s56, 136064
MAA 80,24,4
buffer_load_dwordx4 v18, s[20:23], s54 offen lds
MAA 64,20,4
s_sub_u32 s47, s47, 1
s_cbranch_scc1 .Lx26
.Lx26b:
MAA 68,20,8
RD 52,30,60096
MAA 84,24,8
RD 56,30,62400
MAA 88,24,12
buffer_load_dwordx4 v19, s[20:23], s54 offen offset:1024 lds
MAA 72,20,12
TR 64,25,12416
s_waitcnt lgkmcnt(5)
MAA 244,24,16
TR 66,25,12928
MAA 104,28,12
TR 68,25,12448
MAA 120,32,12
buffer_load_dwordx4 v20, s[20:23], s54 offen offset:2048 lds
MAA 116,32,8
TR 70,25,12960
s_add_u32 s54, s54, 196608
MAA 100,28,8
RD 60,31,55488
MAA 96,28,4
s_add_u32 m0, s55, 39296
MAA 112,32,4
buffer_load_dwordx4 v21, s[36:39], s53 offen lds
MAA 108,32,0
TR 72,25,13440
MAA 92,28,0
TR 74,25,13952
MAA 124,0,36
TR 76,25,13472
MAA 140,0,40
buffer_load_dwordx4 v28, s[36:39], s53 offen offset:1024 lds
MAA 144,4,40
TR 78,25,13984
MAA 128,4,36
TR 80,25,14464
MAA 132,8,36
TR 82,25,14976
MAA 148,8,40
buffer_load_dword v29, s[36:39], s53 offen offset:2048 lds
MAA 152,12,40
TR 84,25,14496
s_add_u32 s53, s53, 128
MAA 136,12,36
TR 86,25,15008
MAA 156,16,36
MAA 160,16,40
s_waitcnt vmcnt(22) lgkmcnt(8)
s_barrier
MAA 60,64,44
ds_read_b128 a[0:3], v23
MAA 76,68,44
RD 4,23,2304
s_add_u32 m0, s56, 73984
MAA 80,68,48
buffer_load_dwordx4 v18, s[20:23], s54 offen lds
MAA 64,64,48
RD 8,23,4608
MAA 68,64,52
RD 12,23,6912
MAA 84,68,52
TR 20,25,24832
MAA 88,68,56
buffer_load_dwordx4 v19, s[20:23], s54 offen offset:1024 lds
MAA 72,64,56
TR 22,25,25344
s_waitcnt lgkmcnt(6)
MAA 244,68,60
MAA 104,72,56
TR 24,25,24864
MAA 120,76,56
buffer_load_dwordx4 v20, s[20:23], s54 offen offset:2048 lds
MAA 116,76,52
TR 26,25,25376
s_add_u32 s54, s54, 196608
MAA 100,72,52
ds_read_b128 a[16:19], v24
MAA 96,72,48
TR 28,25,25856
s_add_u32 m0, s55, 55488
MAA 112,76,48
buffer_load_dwordx4 v21, s[36:39], s52 offen lds
MAA 108,76,44
TR 30,25,26368
MAA 92,72,44
TR 32,25,25888
MAA 124,44,80
MAA 140,44,84
buffer_load_dwordx4 v28, s[36:39], s52 offen offset:1024 lds
MAA 144,48,84
TR 34,25,26400
MAA 128,48,80
TR 36,25,26880
MAA 132,52,80
TR 38,25,27392
MAA 148,52,84
buffer_load_dword v22, s[36:39], s52 offen offset:2048 lds
MAA 152,56,84
TR 40,25,26912
s_add_u32 s52, s52, 128
MAA 136,56,80
TR 42,25,27424
MAA 156,60,80
MAA 160,60,84
s_waitcnt vmcnt(22) lgkmcnt(8)
s_barrier
MAA 60,20,0
ds_read_b128 a[44:47], v30
MAA 76,24,0
RD 48,30,2304
s_add_u32 m0, s56, 86400
MAA 80,24,4
buffer_load_dwordx4 v18, s[20:23], s54 offen lds
MAA 64,20,4
s_sub_u32 s47, s47, 1
s_cbranch_scc1 .Lx27
.Lx27b:
MAA 68,20,8
RD 52,30,4608
MAA 84,24,8
RD 56,30,6912
MAA 88,24,12
buffer_load_dwordx4 v19, s[20:23], s54 offen offset:1024 lds
MAA 72,20,12
TR 64,25,37248
s_waitcnt lgkmcnt(5)
MAA 244,24,16
TR 66,25,37760
MAA 104,28,12
TR 68,25,37280
MAA 120,32,12
buffer_load_dwordx4 v20, s[20:23], s54 offen offset:2048 lds
MAA 116,32,8
TR 70,25,37792
s_add_u32 s54, s54, 196608
MAA 100,28,8
ds_read_b128 a[60:63], v31
MAA 96,28,4
s_add_u32 m0, s55, 57792
MAA 112,32,4
buffer_load_dwordx4 v21, s[36:39], s53 offen lds
MAA 108,32,0
TR 72,25,38272
MAA 92,28,0
TR 74,25,38784
MAA 124,0,36
TR 76,25,38304
MAA 140,0,40
buffer_load_dwordx4 v28, s[36:39], s53 offen offset:1024 lds
MAA 144,4,40
TR 78,25,38816
MAA 128,4,36
TR 80,25,39296
MAA 132,8,36
TR 82,25,39808
MAA 148,8,40
buffer_load_dword v29, s[36:39], s53 offen offset:2048 lds
MAA 152,12,40
TR 84,25,39328
s_add_u32 s53, s53, 128
MAA 136,12,36
TR 86,25,39840
MAA 156,16,36
MAA 160,16,40
s_waitcnt vmcnt(24)
v_cmp_gt_u32 vcc, v36, v37
s_nop 0
s_cbranch_vccnz .Lsp28
.Lsp28b:
s_waitcnt vmcnt(21) lgkmcnt(8)
s_barrier
MAA 60,64,44
RD 0,23,18496
MAA 76,68,44
RD 4,23,20800
s_add_u32 m0, s56, 98816
MAA 80,68,48
buffer_load_dwordx4 v18, s[20:23], s54 offen lds
MAA 64,64,48
RD 8,23,23104
MAA 68,64,52
RD 12,23,25408
MAA 84,68,52
buffer_load_dwordx4 v19, s[20:23], s54 offen offset:1024 lds
MAA 88,68,56
TR 20,25,49664
MAA 72,64,56
TR 22,25,50176
s_waitcnt lgkmcnt(6)
MAA 244,68,60
TR 24,25,49696
MAA 104,72,56
buffer_load_dwordx4 v20, s[20:23], s54 offen offset:2048 lds
MAA 120,76,56
TR 26,25,50208
s_add_u32 s54, s54, 196608
MAA 116,76,52
RD 16,24,18496
s_add_u32 m0, s55, 0
MAA 100,72,52
buffer_load_dwordx4 v21, s[36:39], s52 offen lds
MAA 96,72,48
MAA 112,76,48
TR 28,25,50688
MAA 108,76,44
TR 30,25,51200
MAA 92,72,44
buffer_load_dwordx4 v28, s[36:39], s52 offen offset:1024 lds
MAA 124,44,80
TR 32,25,50720
MAA 140,44,84
TR 34,25,51232
MAA 144,48,84
buffer_load_dword v22, s[36:39], s52 offen offset:2048 lds
MAA 128,48,80
TR 36,25,51712
s_add_u32 s52, s52, 128
MAA 132,52,80
TR 38,25,52224
MAA 148,52,84
TR 40,25,51744
MAA 152,56,84
buffer_load_dwordx4 v[164:167], v26, s[16:19], s75 offen sc1
MAA 136,56,80
TR 42,25,52256
MAA 156,60,80
MAA 160,60,84
s_waitcnt vmcnt(22) lgkmcnt(8)
s_barrier
MAA 60,20,0
RD 44,30,18496
MAA 76,24,0
RD 48,30,20800
s_add_u32 m0, s56, 111232
MAA 80,24,4
buffer_load_dwordx4 v18, s[20:23], s54 offen lds
MAA 64,20,4
s_sub_u32 s47, s47, 1
s_cbranch_scc1 .Lx29
.Lx29b:
MAA 68,20,8
RD 52,30,23104
MAA 84,24,8
buffer_load_dwordx4 v19, s[20:23], s54 offen offset:1024 lds
MAA 88,24,12
RD 56,30,25408
MAA 72,20,12
TR 64,25,62080
s_waitcnt lgkmcnt(5)
MAA 244,24,16
TR 66,25,62592
MAA 104,28,12
buffer_load_dwordx4 v20, s[20:23], s54 offen offset:2048 lds
MAA 120,32,12
TR 68,25,62112
s_add_u32 s54, s54, 196608
MAA 116,32,8
TR 70,25,62624
s_add_u32 m0, s55, 2304
MAA 100,28,8
buffer_load_dwordx4 v21, s[36:39], s53 offen lds
MAA 96,28,4
RD 60,31,18496
MAA 112,32,4
TR 72,25,63104
MAA 108,32,0
TR 74,25,63616
MAA 92,28,0
buffer_load_dwordx4 v28, s[36:39], s53 offen offset:1024 lds
MAA 124,0,36
TR 76,25,63136
MAA 140,0,40
TR 78,25,63648
MAA 144,4,40
buffer_load_dword v29, s[36:39], s53 offen offset:2048 lds
MAA 128,4,36
TR 80,25,64128
s_add_u32 s53, s53, 128
MAA 132,8,36
TR 82,25,64640
MAA 148,8,40
TR 84,25,64160
MAA 152,12,40
buffer_load_dwordx4 v[168:171], v26, s[16:19], s75 offen offset:1024 sc1
MAA 136,12,36
TR 86,25,64672
MAA 156,16,36
MAA 160,16,40
s_waitcnt vmcnt(23) lgkmcnt(8)
s_barrier
MAA 60,64,44
RD 0,23,36992
MAA 76,68,44
RD 4,23,39296
s_add_u32 m0, s56, 123648
MAA 80,68,48
buffer_load_dwordx4 v18, s[20:23], s54 offen lds
MAA 64,64,48
RD 8,23,41600
MAA 68,64,52
RD 12,23,43904
MAA 84,68,52
buffer_load_dwordx4 v19, s[20:23], s54 offen offset:1024 lds
MAA 88,68,56
ds_read_b64_tr_b16 a[20:21], v25
MAA 72,64,56
TR 22,25,512
s_waitcnt lgkmcnt(6)
MAA 244,68,60
TR 24,25,32
MAA 104,72,56
buffer_load_dwordx4 v20, s[20:23], s54 offen offset:2048 lds
MAA 120,76,56
TR 26,25,544
s_add_u32 s54, s54, 196608
MAA 116,76,52
RD 16,24,36992
s_add_u32 m0, s55, 18496
MAA 100,72,52
buffer_load_dwordx4 v21, s[36:39], s52 offen lds
MAA 96,72,48
MAA 112,76,48
TR 28,25,1024
MAA 108,76,44
TR 30,25,1536
MAA 92,72,44
buffer_load_dwordx4 v28, s[36:39], s52 offen offset:1024 lds
MAA 124,44,80
TR 32,25,1056
MAA 140,44,84
TR 34,25,1568
MAA 144,48,84
buffer_load_dword v22, s[36:39], s52 offen offset:2048 lds
MAA 128,48,80
TR 36,25,2048
s_add_u32 s52, s52, 128
MAA 132,52,80
TR 38,25,2560
MAA 148,52,84
TR 40,25,2080
MAA 152,56,84
buffer_load_dwordx4 v[172:175], v26, s[16:19], s75 offen offset:2048 sc1
MAA 136,56,80
TR 42,25,2592
MAA 156,60,80
MAA 160,60,84
s_waitcnt vmcnt(24) lgkmcnt(8)
s_barrier
MAA 60,20,0
RD 44,30,36992
MAA 76,24,0
RD 48,30,39296
s_add_u32 m0, s56, 136064
MAA 80,24,4
buffer_load_dwordx4 v18, s[20:23], s54 offen lds
MAA 64,20,4
s_sub_u32 s47, s47, 1
s_cbranch_scc1 .Lx30
.Lx30b:
MAA 68,20,8
RD 52,30,41600
MAA 84,24,8
buffer_load_dwordx4 v19, s[20:23], s54 offen offset:1024 lds
MAA 88,24,12
RD 56,30,43904
MAA 72,20,12
TR 64,25,12416
s_waitcnt lgkmcnt(5)
MAA 244,24,16
TR 66,25,12928
MAA 104,28,12
buffer_load_dwordx4 v20, s[20:23], s54 offen offset:2048 lds
MAA 120,32,12
TR 68,25,12448
s_add_u32 s54, s54, 196608
MAA 116,32,8
TR 70,25,12960
s_add_u32 m0, s55, 20800
MAA 100,28,8
buffer_load_dwordx4 v21, s[36:39], s53 offen lds
MAA 96,28,4
RD 60,31,36992
MAA 112,32,4
TR 72,25,13440
MAA 108,32,0
TR 74,25,13952
MAA 92,28,0
buffer_load_dwordx4 v28, s[36:39], s53 offen offset:1024 lds
MAA 124,0,36
TR 76,25,13472
MAA 140,0,40
TR 78,25,13984
MAA 144,4,40
buffer_load_dword v29, s[36:39], s53 offen offset:2048 lds
MAA 128,4,36
TR 80,25,14464
s_add_u32 s53, s53, 128
MAA 132,8,36
TR 82,25,14976
MAA 148,8,40
TR 84,25,14496
MAA 152,12,40
buffer_load_dwordx4 v[176:179], v26, s[16:19], s75 offen offset:3072 sc1
MAA 136,12,36
TR 86,25,15008
s_add_u32 s75, s75, 4096
MAA 156,16,36
MAA 160,16,40
s_waitcnt vmcnt(25) lgkmcnt(8)
s_barrier
MAA 60,64,44
RD 0,23,55488
MAA 76,68,44
RD 4,23,57792
s_add_u32 m0, s56, 73984
MAA 80,68,48
buffer_load_dwordx4 v18, s[20:23], s54 offen lds
MAA 64,64,48
RD 8,23,60096
MAA 68,64,52
RD 12,23,62400
MAA 84,68,52
buffer_load_dwordx4 v19, s[20:23], s54 offen offset:1024 lds
MAA 88,68,56
TR 20,25,24832
MAA 72,64,56
TR 22,25,25344
s_waitcnt lgkmcnt(6)
MAA 244,68,60
TR 24,25,24864
MAA 104,72,56
buffer_load_dwordx4 v20, s[20:23], s54 offen offset:2048 lds
MAA 120,76,56
TR 26,25,25376
s_add_u32 s54, s54, 196608
MAA 116,76,52
RD 16,24,55488
s_add_u32 m0, s55, 36992
MAA 100,72,52
buffer_load_dwordx4 v21, s[36:39], s52 offen lds
MAA 96,72,48
MAA 112,76,48
TR 28,25,25856
MAA 108,76,44
TR 30,25,26368
MAA 92,72,44
buffer_load_dwordx4 v28, s[36:39], s52 offen offset:1024 lds
MAA 124,44,80
TR 32,25,25888
MAA 140,44,84
TR 34,25,26400
MAA 144,48,84
buffer_load_dword v22, s[36:39], s52 offen offset:2048 lds
MAA 128,48,80
TR 36,25,26880
s_add_u32 s52, s52, 128
MAA 132,52,80
TR 38,25,27392
MAA 148,52,84
TR 40,25,26912
MAA 152,56,84
buffer_load_dwordx4 v[180:183], v26, s[16:19], s75 offen sc1
MAA 136,56,80
TR 42,25,27424
MAA 156,60,80
MAA 160,60,84
s_waitcnt vmcnt(25) lgkmcnt(8)
s_barrier
MAA 60,20,0
RD 44,30,55488
s_waitcnt vmcnt(21)
v_add_f32 v164, v164, v168
MAA 76,24,0
RD 48,30,57792
s_add_u32 m0, s56, 86400
MAA 80,24,4
buffer_load_dwordx4 v18, s[20:23], s54 offen lds
MAA 64,20,4
s_sub_u32 s47, s47, 1
s_cbranch_scc1 .Lx31
.Lx31b:
MAA 68,20,8
RD 52,30,60096
MAA 84,24,8
buffer_load_dwordx4 v19, s[20:23], s54 offen offset:1024 lds
MAA 88,24,12
RD 56,30,62400
MAA 72,20,12
TR 64,25,37248
s_waitcnt lgkmcnt(5)
MAA 244,24,16
TR 66,25,37760
v_add_f32 v165, v165, v169
MAA 104,28,12
buffer_load_dwordx4 v20, s[20:23], s54 offen offset:2048 lds
MAA 120,32,12
TR 68,25,37280
s_add_u32 s54, s54, 196608
MAA 116,32,8
TR 70,25,37792
s_add_u32 m0, s55, 39296
MAA 100,28,8
buffer_load_dwordx4 v21, s[36:39], s53 offen lds
MAA 96,28,4
RD 60,31,55488
MAA 112,32,4
TR 72,25,38272
MAA 108,32,0
TR 74,25,38784
MAA 92,28,0
buffer_load_dwordx4 v28, s[36:39], s53 offen offset:1024 lds
MAA 124,0,36
TR 76,25,38304
v_add_f32 v166, v166, v170
MAA 140,0,40
TR 78,25,38816
MAA 144,4,40
buffer_load_dword v29, s[36:39], s53 offen offset:2048 lds
MAA 128,4,36
TR 80,25,39296
s_add_u32 s53, s53, 128
MAA 132,8,36
TR 82,25,39808
MAA 148,8,40
TR 84,25,39328
v_add_f32 v167, v167, v171
MAA 152,12,40
buffer_load_dwordx4 v[184:187], v26, s[16:19], s75 offen offset:1024 sc1
MAA 136,12,36
TR 86,25,39840
MAA 156,16,36
MAA 160,16,40
s_waitcnt vmcnt(25) lgkmcnt(8)
s_barrier
MAA 60,64,44
ds_read_b128 a[0:3], v23
s_waitcnt vmcnt(21)
v_add_f32 v164, v164, v172
MAA 76,68,44
RD 4,23,2304
s_add_u32 m0, s56, 98816
MAA 80,68,48
buffer_load_dwordx4 v18, s[20:23], s54 offen lds
MAA 64,64,48
RD 8,23,4608
v_add_f32 v165, v165, v173
MAA 68,64,52
RD 12,23,6912
v_add_f32 v166, v166, v174
MAA 84,68,52
buffer_load_dwordx4 v19, s[20:23], s54 offen offset:1024 lds
MAA 88,68,56
TR 20,25,49664
v_add_f32 v167, v167, v175
MAA 72,64,56
TR 22,25,50176
s_waitcnt lgkmcnt(6)
MAA 244,68,60
buffer_load_dwordx4 v20, s[20:23], s54 offen offset:2048 lds
MAA 104,72,56
TR 24,25,49696
s_add_u32 s54, s54, 196608
MAA 120,76,56
TR 26,25,50208
s_add_u32 m0, s55, 55488
MAA 116,76,52
buffer_load_dwordx4 v21, s[36:39], s52 offen lds
MAA 100,72,52
ds_read_b128 a[16:19], v24
MAA 96,72,48
TR 28,25,50688
MAA 112,76,48
buffer_load_dwordx4 v28, s[36:39], s52 offen offset:1024 lds
MAA 108,76,44
TR 30,25,51200
MAA 92,72,44
TR 32,25,50720
MAA 124,44,80
buffer_load_dword v22, s[36:39], s52 offen offset:2048 lds
MAA 140,44,84
TR 34,25,51232
s_add_u32 s52, s52, 128
MAA 144,48,84
TR 36,25,51712
MAA 128,48,80
buffer_load_dwordx4 v[188:191], v26, s[16:19], s75 offen offset:2048 sc1
MAA 132,52,80
TR 38,25,52224
MAA 148,52,84
TR 40,25,51744
MAA 152,56,84
TR 42,25,52256
MAA 136,56,80
MAA 156,60,80
MAA 160,60,84
s_waitcnt vmcnt(25) lgkmcnt(8)
s_barrier
MAA 60,20,0
ds_read_b128 a[44:47], v30
s_waitcnt vmcnt(21)
v_add_f32 v164, v164, v176
MAA 76,24,0
RD 48,30,2304
s_add_u32 m0, s56, 111232
MAA 80,24,4
buffer_load_dwordx4 v18, s[20:23], s54 offen lds
MAA 64,20,4
RD 52,30,4608
v_add_f32 v165, v165, v177
MAA 68,20,8
RD 56,30,6912
v_add_f32 v166, v166, v178
MAA 84,24,8
buffer_load_dwordx4 v19, s[20:23], s54 offen offset:1024 lds
MAA 88,24,12
TR 64,25,62080
v_add_f32 v167, v167, v179
MAA 72,20,12
TR 66,25,62592
s_waitcnt lgkmcnt(6)
MAA 244,24,16
buffer_load_dwordx4 v20, s[20:23], s54 offen offset:2048 lds
MAA 104,28,12
TR 68,25,62112
s_add_u32 s54, s54, 196608
MAA 120,32,12
TR 70,25,62624
s_add_u32 m0, s55, 57792
MAA 116,32,8
buffer_load_dwordx4 v21, s[36:39], s53 offen lds
MAA 100,28,8
ds_read_b128 a[60:63], v31
MAA 96,28,4
TR 72,25,63104
MAA 112,32,4
buffer_load_dwordx4 v28, s[36:39], s53 offen offset:1024 lds
MAA 108,32,0
TR 74,25,63616
MAA 92,28,0
TR 76,25,63136
MAA 124,0,36
buffer_load_dword v29, s[36:39], s53 offen offset:2048 lds
MAA 140,0,40
TR 78,25,63648
s_add_u32 s53, s53, 128
MAA 144,4,40
TR 80,25,64128
MAA 128,4,36
buffer_load_dwordx4 v[192:195], v26, s[16:19], s75 offen offset:3072 sc1
MAA 132,8,36
TR 82,25,64640
MAA 148,8,40
TR 84,25,64160
MAA 152,12,40
TR 86,25,64672
MAA 136,12,36
MAA 156,16,36
MAA 160,16,40
s_waitcnt vmcnt(25) lgkmcnt(8)
s_barrier
MAA 60,64,44
RD 0,23,18496
s_waitcnt vmcnt(21)
v_add_f32 v164, v164, v180
MAA 76,68,44
RD 4,23,20800
s_add_u32 m0, s56, 123648
MAA 80,68,48
buffer_load_dwordx4 v18, s[20:23], s54 offen lds
MAA 64,64,48
RD 8,23,23104
v_add_f32 v165, v165, v181
MAA 68,64,52
RD 12,23,25408
v_add_f32 v166, v166, v182
MAA 84,68,52
ds_read_b64_tr_b16 a[20:21], v25
v_add_f32 v167, v167, v183
MAA 88,68,56
TR 22,25,512
MAA 72,64,56
TR 24,25,32
s_waitcnt lgkmcnt(7)
MAA 244,68,60
TR 26,25,544
MAA 104,72,56
RD 16,24,18496
MAA 120,76,56
buffer_load_dwordx4 v19, s[20:23], s54 offen offset:1024 lds
MAA 116,76,52
TR 28,25,1024
MAA 100,72,52
TR 30,25,1536
MAA 96,72,48
TR 32,25,1056
MAA 112,76,48
TR 34,25,1568
MAA 108,76,44
TR 36,25,2048
MAA 92,72,44
TR 38,25,2560
MAA 124,44,80
TR 40,25,2080
MAA 140,44,84
buffer_load_dwordx4 v20, s[20:23], s54 offen offset:2048 lds
MAA 144,48,84
TR 42,25,2592
s_add_u32 s54, s54, 196608
MAA 128,48,80
MAA 132,52,80
MAA 148,52,84
MAA 152,56,84
MAA 136,56,80
MAA 156,60,80
MAA 160,60,84
s_waitcnt vmcnt(21) lgkmcnt(8)
s_barrier
MAA 60,20,0
RD 44,30,18496
s_waitcnt vmcnt(17)
v_add_f32 v164, v164, v184
MAA 76,24,0
RD 48,30,20800
s_add_u32 m0, s56, 136064
MAA 80,24,4
buffer_load_dwordx4 v18, s[20:23], s54 offen lds
MAA 64,20,4
RD 52,30,23104
v_add_f32 v165, v165, v185
MAA 68,20,8
RD 56,30,25408
v_add_f32 v166, v166, v186
MAA 84,24,8
TR 64,25,12416
v_add_f32 v167, v167, v187
MAA 88,24,12
TR 66,25,12928
MAA 72,20,12
TR 68,25,12448
s_waitcnt lgkmcnt(7)
MAA 244,24,16
TR 70,25,12960
MAA 104,28,12
RD 60,31,18496
MAA 120,32,12
buffer_load_dwordx4 v19, s[20:23], s54 offen offset:1024 lds
MAA 116,32,8
TR 72,25,13440
MAA 100,28,8
TR 74,25,13952
MAA 96,28,4
TR 76,25,13472
MAA 112,32,4
TR 78,25,13984
MAA 108,32,0
TR 80,25,14464
MAA 92,28,0
TR 82,25,14976
MAA 124,0,36
TR 84,25,14496
MAA 140,0,40
buffer_load_dwordx4 v20, s[20:23], s54 offen offset:2048 lds
MAA 144,4,40
TR 86,25,15008
s_add_u32 s54, s54, 196608
MAA 128,4,36
MAA 132,8,36
MAA 148,8,40
MAA 152,12,40
MAA 136,12,36
MAA 156,16,36
MAA 160,16,40
s_waitcnt vmcnt(17) lgkmcnt(8)
s_barrier
MAA 60,64,44
RD 0,23,36992
s_waitcnt vmcnt(13)
v_add_f32 v164, v164, v188
MAA 76,68,44
RD 4,23,39296
s_add_u32 m0, s59, 0
MAA 80,68,48
RD 8,23,41600
s_mov_b32 s58, 1048576
MAA 64,64,48
buffer_load_dwordx4 v5, s[24:27], s58 offen lds
MAA 68,64,52
RD 12,23,43904
v_add_f32 v165, v165, v189
MAA 84,68,52
TR 20,25,24832
v_add_f32 v166, v166, v190
MAA 88,68,56
TR 22,25,25344
v_add_f32 v167, v167, v191
MAA 72,64,56
buffer_load_dwordx4 v6, s[24:27], s58 offen offset:1024 lds
s_waitcnt lgkmcnt(6)
MAA 244,68,60
TR 24,25,24864
s_add_u32 m0, s59, 8320
MAA 104,72,56
TR 26,25,25376
s_mov_b32 s58, 1179648
MAA 120,76,56
RD 16,24,36992
MAA 116,76,52
buffer_load_dwordx4 v5, s[24:27], s58 offen lds
MAA 100,72,52
TR 28,25,25856
MAA 96,72,48
TR 30,25,26368
MAA 112,76,48
TR 32,25,25888
MAA 108,76,44
buffer_load_dwordx4 v6, s[24:27], s58 offen offset:1024 lds
MAA 92,72,44
TR 34,25,26400
s_add_u32 m0, s59, 16640
MAA 124,44,80
TR 36,25,26880
s_mov_b32 s58, 1310720
MAA 140,44,84
TR 38,25,27392
MAA 144,48,84
buffer_load_dwordx4 v5, s[24:27], s58 offen lds
MAA 128,48,80
TR 40,25,26912
MAA 132,52,80
TR 42,25,27424
MAA 148,52,84
MAA 152,56,84
buffer_load_dwordx4 v6, s[24:27], s58 offen offset:1024 lds
MAA 136,56,80
MAA 156,60,80
MAA 160,60,84
s_waitcnt vmcnt(16) lgkmcnt(8)
s_barrier
MAA 60,20,0
RD 44,30,36992
s_waitcnt vmcnt(12)
v_add_f32 v164, v164, v192
MAA 76,24,0
RD 48,30,39296
s_add_u32 m0, s59, 24960
MAA 80,24,4
RD 52,30,41600
s_mov_b32 s58, 1441792
MAA 64,20,4
buffer_load_dwordx4 v5, s[24:27], s58 offen lds
MAA 68,20,8
RD 56,30,43904
v_add_f32 v165, v165, v193
MAA 84,24,8
TR 64,25,37248
v_add_f32 v166, v166, v194
MAA 88,24,12
TR 66,25,37760
v_add_f32 v167, v167, v195
MAA 72,20,12
buffer_load_dwordx4 v6, s[24:27], s58 offen offset:1024 lds
s_waitcnt lgkmcnt(6)
MAA 244,24,16
TR 68,25,37280
s_add_u32 m0, s59, 74880
MAA 104,28,12
TR 70,25,37792
s_mov_b32 s58, 131072
MAA 120,32,12
RD 60,31,36992
MAA 116,32,8
buffer_load_dwordx4 v5, s[24:27], s58 offen lds
MAA 100,28,8
TR 72,25,38272
MAA 96,28,4
TR 74,25,38784
MAA 112,32,4
TR 76,25,38304
MAA 108,32,0
buffer_load_dwordx4 v6, s[24:27], s58 offen offset:1024 lds
MAA 92,28,0
TR 78,25,38816
s_add_u32 m0, s59, 83200
MAA 124,0,36
TR 80,25,39296
s_mov_b32 s58, 262144
MAA 140,0,40
TR 82,25,39808
MAA 144,4,40
buffer_load_dwordx4 v5, s[24:27], s58 offen lds
MAA 128,4,36
TR 84,25,39328
MAA 132,8,36
TR 86,25,39840
MAA 148,8,40
MAA 152,12,40
buffer_load_dwordx4 v6, s[24:27], s58 offen offset:1024 lds
MAA 136,12,36
MAA 156,16,36
MAA 160,16,40
s_waitcnt vmcnt(15) lgkmcnt(8)
s_barrier
MAA 60,64,44
RD 0,23,55488
MAA 76,68,44
RD 4,23,57792
s_add_u32 m0, s59, 33280
MAA 80,68,48
RD 8,23,60096
s_mov_b32 s58, 1572864
MAA 64,64,48
buffer_load_dwordx4 v5, s[24:27], s58 offen lds
MAA 68,64,52
RD 12,23,62400
MAA 84,68,52
TR 20,25,49664
MAA 88,68,56
TR 22,25,50176
MAA 72,64,56
buffer_load_dwordx4 v6, s[24:27], s58 offen offset:1024 lds
s_waitcnt lgkmcnt(6)
MAA 244,68,60
TR 24,25,49696
s_add_u32 m0, s59, 41600
MAA 104,72,56
TR 26,25,50208
s_mov_b32 s58, 1703936
MAA 120,76,56
RD 16,24,55488
MAA 116,76,52
buffer_load_dwordx4 v5, s[24:27], s58 offen lds
MAA 100,72,52
TR 28,25,50688
MAA 96,72,48
TR 30,25,51200
MAA 112,76,48
TR 32,25,50720
MAA 108,76,44
buffer_load_dwordx4 v6, s[24:27], s58 offen offset:1024 lds
MAA 92,72,44
TR 34,25,51232
s_add_u32 m0, s59, 91520
MAA 124,44,80
TR 36,25,51712
s_mov_b32 s58, 393216
MAA 140,44,84
TR 38,25,52224
MAA 144,48,84
buffer_load_dwordx4 v5, s[24:27], s58 offen lds
MAA 128,48,80
TR 40,25,51744
MAA 132,52,80
TR 42,25,52256
MAA 148,52,84
v_permlane32_swap_b32 v164, v166
MAA 152,56,84
buffer_load_dwordx4 v6, s[24:27], s58 offen offset:1024 lds
MAA 136,56,80
v_permlane32_swap_b32 v165, v167
MAA 156,60,80
v_add_f32 v164, v164, v166
v_add_f32 v165, v165, v167
MAA 160,60,84
v_mul_f32 v164, 0xba800000, v164
v_mul_f32 v165, 0x3a800000, v165
v_fma_f32 v165, -v164, v164, v165
v_max_f32 v165, 0, v165
v_add_f32 v165, 0x3727c5ac, v165
s_waitcnt vmcnt(18) lgkmcnt(8)
s_barrier
MAA 60,20,0
ds_write_b32 v17, v164
MAA 76,24,0
RD 44,30,55488
s_add_u32 m0, s59, 99840
MAA 80,24,4
RD 48,30,57792
s_mov_b32 s58, 524288
MAA 64,20,4
buffer_load_dwordx4 v5, s[24:27], s58 offen lds
MAA 68,20,8
RD 52,30,60096
MAA 84,24,8
RD 56,30,62400
MAA 88,24,12
TR 64,25,62080
MAA 72,20,12
TR 66,25,62592
s_waitcnt lgkmcnt(7)
MAA 244,24,16
TR 68,25,62112
MAA 104,28,12
buffer_load_dwordx4 v6, s[24:27], s58 offen offset:1024 lds
MAA 120,32,12
TR 70,25,62624
s_add_u32 m0, s59, 108160
MAA 116,32,8
RD 60,31,55488
s_mov_b32 s58, 655360
MAA 100,28,8
TR 72,25,63104
MAA 96,28,4
TR 74,25,63616
MAA 112,32,4
TR 76,25,63136
MAA 108,32,0
buffer_load_dwordx4 v5, s[24:27], s58 offen lds
MAA 92,28,0
TR 78,25,63648
MAA 124,0,36
TR 80,25,64128
MAA 140,0,40
TR 82,25,64640
MAA 144,4,40
TR 84,25,64160
MAA 128,4,36
TR 86,25,64672
MAA 132,8,36
buffer_load_dwordx4 v6, s[24:27], s58 offen offset:1024 lds
MAA 148,8,40
v_rsq_f32 v166, v165
MAA 152,12,40
v_mov_b32 v165, v166
v_mul_f32 v166, 0x3e8293ee, v166
MAA 136,12,36
ds_write_b128 v7, v[164:167]
MAA 156,16,36
ds_write_b32 v17, v165 offset:1024
MAA 160,16,40
s_waitcnt lgkmcnt(0)
s_barrier
MAA 244,68,60
ds_read_b128 v[232:235], v10 offset:1792
MAA 156,60,80
ds_read_b128 v[228:231], v10 offset:1536
MAA 160,60,84
ds_read_b128 v[224:227], v10 offset:1280
MAA 104,72,56
ds_read_b128 v[220:223], v10 offset:1024
MAA 120,76,56
MAA 136,56,80
MAA 152,56,84
MAA 100,72,52
MAA 116,76,52
s_mov_b32 exec_lo, 0x10001
s_mov_b32 exec_hi, 0x10001
ds_write_b128 v13, v[244:247] offset:64
s_mov_b64 exec, 0xffff
ds_write_b32 v12, v156 offset:512
ds_write_b32 v12, v160 offset:576
s_mov_b64 exec, -1
MAA 96,72,48
MAA 112,76,48
MAA 92,72,44
MAA 108,76,44
MAA 72,64,56
MAA 88,68,56
s_waitcnt lgkmcnt(0)
s_barrier
MAA 132,52,80
ds_read_b128 v[28:31], v13
s_add_u32 m0, s59, 49920
MAA 148,52,84
ds_read_b128 v[32:35], v13 offset:64
s_mov_b32 s58, 1835008
MAA 68,64,52
ds_read_b128 v[36:39], v13 offset:256
MAA 84,68,52
ds_read_b128 v[40:43], v13 offset:320
MAA 128,48,80
ds_read_b32 v44, v12 offset:512
MAA 144,48,84
ds_read_b32 v45, v12 offset:576
MAA 64,64,48
ds_read_b128 v[240:243], v11 offset:704
MAA 80,68,48
ds_read_b128 v[244:247], v11 offset:1728
MAA 124,44,80
buffer_load_dwordx4 v5, s[24:27], s58 offen lds
ds_read_b128 v[18:21], v11 offset:448
s_waitcnt lgkmcnt(8)
v_pk_fma_f32 v[72:73], v[28:29], v[232:233], v[72:73] op_sel_hi:[1,0,1]
v_pk_fma_f32 v[74:75], v[30:31], v[232:233], v[74:75] op_sel_hi:[1,0,1]
s_waitcnt lgkmcnt(6)
v_pk_fma_f32 v[104:105], v[36:37], v[232:233], v[104:105] op_sel_hi:[1,0,1]
v_pk_mul_f32 v[104:105], v[104:105], v[232:233] op_sel:[0,1] op_sel_hi:[1,1]
v_pk_fma_f32 v[106:107], v[38:39], v[232:233], v[106:107] op_sel_hi:[1,0,1]
v_pk_mul_f32 v[106:107], v[106:107], v[232:233] op_sel:[0,1] op_sel_hi:[1,1]
s_waitcnt lgkmcnt(5)
v_pk_fma_f32 v[120:121], v[40:41], v[232:233], v[120:121] op_sel_hi:[1,0,1]
v_pk_mul_f32 v[120:121], v[120:121], v[232:233] op_sel:[0,1] op_sel_hi:[1,1]
v_pk_fma_f32 v[122:123], v[42:43], v[232:233], v[122:123] op_sel_hi:[1,0,1]
v_pk_mul_f32 v[122:123], v[122:123], v[232:233] op_sel:[0,1] op_sel_hi:[1,1]
v_pk_fma_f32 v[100:101], v[36:37], v[228:229], v[100:101] op_sel_hi:[1,0,1]
v_pk_mul_f32 v[100:101], v[100:101], v[228:229] op_sel:[0,1] op_sel_hi:[1,1]
v_pk_fma_f32 v[102:103], v[38:39], v[228:229], v[102:103] op_sel_hi:[1,0,1]
v_pk_mul_f32 v[102:103], v[102:103], v[228:229] op_sel:[0,1] op_sel_hi:[1,1]
v_pk_fma_f32 v[116:117], v[40:41], v[228:229], v[116:117] op_sel_hi:[1,0,1]
v_pk_mul_f32 v[116:117], v[116:117], v[228:229] op_sel:[0,1] op_sel_hi:[1,1]
v_pk_fma_f32 v[118:119], v[42:43], v[228:229], v[118:119] op_sel_hi:[1,0,1]
v_pk_mul_f32 v[118:119], v[118:119], v[228:229] op_sel:[0,1] op_sel_hi:[1,1]
s_waitcnt lgkmcnt(2)
v_pk_fma_f32 v[156:157], v[240:241], v[44:45], v[156:157] op_sel_hi:[1,0,1]
v_pk_fma_f32 v[158:159], v[242:243], v[44:45], v[158:159] op_sel_hi:[1,0,1]
v_pk_fma_f32 v[160:161], v[240:241], v[44:45], v[160:161] op_sel:[0,1,0] op_sel_hi:[1,1,1]
v_pk_fma_f32 v[162:163], v[242:243], v[44:45], v[162:163] op_sel:[0,1,0] op_sel_hi:[1,1,1]
s_waitcnt lgkmcnt(1)
v_pk_mul_f32 v[156:157], v[156:157], v[244:245]
v_pk_mul_f32 v[158:159], v[158:159], v[246:247]
v_pk_mul_f32 v[160:161], v[160:161], v[244:245]
v_pk_mul_f32 v[162:163], v[162:163], v[246:247]
v_pk_fma_f32 v[88:89], v[32:33], v[232:233], v[88:89] op_sel_hi:[1,0,1]
v_pk_fma_f32 v[90:91], v[34:35], v[232:233], v[90:91] op_sel_hi:[1,0,1]
v_pk_fma_f32 v[96:97], v[36:37], v[224:225], v[96:97] op_sel_hi:[1,0,1]
s_waitcnt lgkmcnt(0)
v_pk_fma_f32 v[136:137], v[18:19], v[44:45], v[136:137] op_sel_hi:[1,0,1]
v_pk_fma_f32 v[138:139], v[20:21], v[44:45], v[138:139] op_sel_hi:[1,0,1]
v_pk_fma_f32 v[152:153], v[18:19], v[44:45], v[152:153] op_sel:[0,1,0] op_sel_hi:[1,1,1]
v_pk_fma_f32 v[154:155], v[20:21], v[44:45], v[154:155] op_sel:[0,1,0] op_sel_hi:[1,1,1]
v_pk_mul_f32 v[96:97], v[96:97], v[224:225] op_sel:[0,1] op_sel_hi:[1,1]
v_pk_fma_f32 v[98:99], v[38:39], v[224:225], v[98:99] op_sel_hi:[1,0,1]
v_pk_mul_f32 v[98:99], v[98:99], v[224:225] op_sel:[0,1] op_sel_hi:[1,1]
v_pk_fma_f32 v[112:113], v[40:41], v[224:225], v[112:113] op_sel_hi:[1,0,1]
v_pk_mul_f32 v[112:113], v[112:113], v[224:225] op_sel:[0,1] op_sel_hi:[1,1]
v_pk_fma_f32 v[114:115], v[42:43], v[224:225], v[114:115] op_sel_hi:[1,0,1]
v_pk_mul_f32 v[114:115], v[114:115], v[224:225] op_sel:[0,1] op_sel_hi:[1,1]
v_pk_fma_f32 v[68:69], v[28:29], v[228:229], v[68:69] op_sel_hi:[1,0,1]
v_pk_fma_f32 v[70:71], v[30:31], v[228:229], v[70:71] op_sel_hi:[1,0,1]
v_pk_fma_f32 v[84:85], v[32:33], v[228:229], v[84:85] op_sel_hi:[1,0,1]
v_pk_fma_f32 v[86:87], v[34:35], v[228:229], v[86:87] op_sel_hi:[1,0,1]
v_pk_fma_f32 v[92:93], v[36:37], v[220:221], v[92:93] op_sel_hi:[1,0,1]
v_pk_mul_f32 v[92:93], v[92:93], v[220:221] op_sel:[0,1] op_sel_hi:[1,1]
v_pk_fma_f32 v[94:95], v[38:39], v[220:221], v[94:95] op_sel_hi:[1,0,1]
v_pk_mul_f32 v[94:95], v[94:95], v[220:221] op_sel:[0,1] op_sel_hi:[1,1]
v_pk_fma_f32 v[108:109], v[40:41], v[220:221], v[108:109] op_sel_hi:[1,0,1]
v_pk_mul_f32 v[108:109], v[108:109], v[220:221] op_sel:[0,1] op_sel_hi:[1,1]
v_pk_fma_f32 v[110:111], v[42:43], v[220:221], v[110:111] op_sel_hi:[1,0,1]
v_pk_mul_f32 v[110:111], v[110:111], v[220:221] op_sel:[0,1] op_sel_hi:[1,1]
v_pk_fma_f32 v[64:65], v[28:29], v[224:225], v[64:65] op_sel_hi:[1,0,1]
v_pk_fma_f32 v[66:67], v[30:31], v[224:225], v[66:67] op_sel_hi:[1,0,1]
v_pk_fma_f32 v[80:81], v[32:33], v[224:225], v[80:81] op_sel_hi:[1,0,1]
v_pk_fma_f32 v[82:83], v[34:35], v[224:225], v[82:83] op_sel_hi:[1,0,1]
v_cvt_pk_bf16_f32 v236, v156, v157
v_cvt_pk_bf16_f32 v237, v158, v159
MAA 140,44,84
buffer_load_dwordx4 v6, s[24:27], s58 offen offset:1024 lds
MAA 60,64,44
ds_read_b128 v[22:25], v11 offset:1472
v_cvt_pk_bf16_f32 v238, v160, v161
MAA 76,68,44
ds_read_b128 v[240:243], v11 offset:384
v_cvt_pk_bf16_f32 v239, v162, v163
ds_write_b128 v8, v[236:239] offset:1024
s_add_u32 m0, s59, 58240
s_mov_b32 s58, 1966080
v_cvt_pk_bf16_f32 v196, v104, v105
buffer_load_dwordx4 v5, s[24:27], s58 offen lds
v_cvt_pk_bf16_f32 v197, v106, v107
v_cvt_pk_bf16_f32 v198, v120, v121
v_cvt_pk_bf16_f32 v199, v122, v123
v_cvt_pk_bf16_f32 v192, v100, v101
v_cvt_pk_bf16_f32 v193, v102, v103
v_cvt_pk_bf16_f32 v194, v116, v117
v_cvt_pk_bf16_f32 v195, v118, v119
v_cvt_pk_bf16_f32 v176, v72, v73
v_cvt_pk_bf16_f32 v177, v74, v75
v_cvt_pk_bf16_f32 v178, v88, v89
v_cvt_pk_bf16_f32 v179, v90, v91
v_pk_fma_f32 v[60:61], v[28:29], v[220:221], v[60:61] op_sel_hi:[1,0,1]
v_pk_fma_f32 v[62:63], v[30:31], v[220:221], v[62:63] op_sel_hi:[1,0,1]
v_pk_fma_f32 v[76:77], v[32:33], v[220:221], v[76:77] op_sel_hi:[1,0,1]
v_pk_fma_f32 v[78:79], v[34:35], v[220:221], v[78:79] op_sel_hi:[1,0,1]
ds_read_b128 v[244:247], v11 offset:1408
s_nop 0
v_mfma_f32_16x16x32_bf16 v[104:107], v[192:195], v[176:179], v[46:49]
buffer_load_dwordx4 v6, s[24:27], s58 offen offset:1024 lds
s_add_u32 m0, s59, 66560
s_mov_b32 s58, 0
v_cvt_pk_bf16_f32 v188, v96, v97
s_waitcnt lgkmcnt(3)
v_pk_mul_f32 v[136:137], v[136:137], v[22:23]
v_pk_mul_f32 v[138:139], v[138:139], v[24:25]
v_pk_mul_f32 v[152:153], v[152:153], v[22:23]
v_pk_mul_f32 v[154:155], v[154:155], v[24:25]
s_waitcnt lgkmcnt(2)
v_pk_fma_f32 v[132:133], v[240:241], v[44:45], v[132:133] op_sel_hi:[1,0,1]
v_pk_fma_f32 v[134:135], v[242:243], v[44:45], v[134:135] op_sel_hi:[1,0,1]
v_pk_fma_f32 v[148:149], v[240:241], v[44:45], v[148:149] op_sel:[0,1,0] op_sel_hi:[1,1,1]
v_pk_fma_f32 v[150:151], v[242:243], v[44:45], v[150:151] op_sel:[0,1,0] op_sel_hi:[1,1,1]
s_waitcnt lgkmcnt(1)
s_barrier
v_cvt_pk_bf16_f32 v208, v136, v137
v_mfma_f32_16x16x32_bf16 v[120:123], v[196:199], v[176:179], v[50:53]
ds_read_b128 v[180:183], v9
ds_read_b64 v[200:201], v9 offset:1024
ds_read_b64 v[210:211], v9 offset:1032
buffer_load_dwordx4 v5, s[24:27], s58 offen lds
v_cvt_pk_bf16_f32 v209, v138, v139
v_cvt_pk_bf16_f32 v218, v152, v153
v_cvt_pk_bf16_f32 v219, v154, v155
s_waitcnt lgkmcnt(3)
v_pk_mul_f32 v[132:133], v[132:133], v[244:245]
v_cvt_pk_bf16_f32 v206, v132, v133
v_pk_mul_f32 v[134:135], v[134:135], v[246:247]
v_cvt_pk_bf16_f32 v207, v134, v135
v_pk_mul_f32 v[148:149], v[148:149], v[244:245]
v_cvt_pk_bf16_f32 v216, v148, v149
v_pk_mul_f32 v[150:151], v[150:151], v[246:247]
v_cvt_pk_bf16_f32 v217, v150, v151
v_max3_f32 v88, v104, v105, v106
v_max3_f32 v89, v107, v120, v121
buffer_load_dwordx4 v6, s[24:27], s58 offen offset:1024 lds
s_add_u32 m0, s59, 116480
s_mov_b32 s58, 786432
v_max3_f32 v88, v88, v122, v123
v_max_f32 v90, v88, v89
v_max_f32 v89, v88, v89
v_cvt_pk_bf16_f32 v189, v98, v99
v_cvt_pk_bf16_f32 v190, v112, v113
v_permlane16_swap_b32 v90, v89
v_cvt_pk_bf16_f32 v191, v114, v115
v_max_f32 v88, v90, v89
v_max_f32 v89, v90, v89
v_cvt_pk_bf16_f32 v172, v68, v69
buffer_load_dwordx4 v5, s[24:27], s58 offen lds
v_permlane32_swap_b32 v88, v89
v_cvt_pk_bf16_f32 v173, v70, v71
v_max_f32 v88, v88, v89
v_mul_f32 v88, v88, v234
v_pk_fma_f32 v[104:105], v[104:105], v[234:235], v[88:89] op_sel_hi:[1,0,0] neg_lo:[0,0,1] neg_hi:[0,0,1]
v_pk_fma_f32 v[106:107], v[106:107], v[234:235], v[88:89] op_sel_hi:[1,0,0] neg_lo:[0,0,1] neg_hi:[0,0,1]
v_pk_fma_f32 v[120:121], v[120:121], v[234:235], v[88:89] op_sel_hi:[1,0,0] neg_lo:[0,0,1] neg_hi:[0,0,1]
v_pk_fma_f32 v[122:123], v[122:123], v[234:235], v[88:89] op_sel_hi:[1,0,0] neg_lo:[0,0,1] neg_hi:[0,0,1]
v_exp_f32 v104, v104
v_exp_f32 v105, v105
v_exp_f32 v106, v106
v_exp_f32 v107, v107
v_exp_f32 v120, v120
v_exp_f32 v121, v121
v_exp_f32 v122, v122
v_exp_f32 v123, v123
v_cvt_pk_bf16_f32 v72, v104, v105
buffer_load_dwordx4 v6, s[24:27], s58 offen offset:1024 lds
s_add_u32 m0, s59, 124800
s_mov_b32 s58, 917504
v_cvt_pk_bf16_f32 v73, v106, v107
v_cvt_pk_bf16_f32 v74, v120, v121
v_cvt_pk_bf16_f32 v75, v122, v123
v_cvt_pk_bf16_f32 v174, v84, v85
v_cvt_pk_bf16_f32 v175, v86, v87
v_mfma_f32_16x16x32_bf16 v[88:91], v[248:251], v[72:75], 0
ds_read_b128 v[18:21], v11 offset:320
v_cvt_pk_bf16_f32 v184, v92, v93
v_mfma_f32_16x16x32_bf16 v[104:107], v[206:209], v[72:75], 0
ds_read_b128 v[22:25], v11 offset:1344
v_cvt_pk_bf16_f32 v185, v94, v95
v_mfma_f32_16x16x32_bf16 v[120:123], v[216:219], v[72:75], 0
buffer_load_dwordx4 v5, s[24:27], s58 offen lds
v_mfma_f32_16x16x32_bf16 v[100:103], v[188:191], v[172:175], v[46:49]
ds_read_b128 v[240:243], v11 offset:256
v_rcp_f32 v88, v88
v_mfma_f32_16x16x32_bf16 v[116:119], v[192:195], v[172:175], v[50:53]
ds_read_b128 v[244:247], v11 offset:1280
v_cvt_pk_bf16_f32 v186, v108, v109
s_nop 2
v_max3_f32 v84, v100, v101, v102
v_cvt_pk_bf16_f32 v187, v110, v111
v_cvt_pk_bf16_f32 v168, v64, v65
v_pk_mul_f32 v[104:105], v[104:105], v[88:89] op_sel_hi:[1,0]
buffer_load_dwordx4 v6, s[24:27], s58 offen offset:1024 lds
v_pk_mul_f32 v[106:107], v[106:107], v[88:89] op_sel_hi:[1,0]
v_pk_mul_f32 v[120:121], v[120:121], v[88:89] op_sel_hi:[1,0]
v_pk_mul_f32 v[122:123], v[122:123], v[88:89] op_sel_hi:[1,0]
v_cvt_pk_bf16_f32 v176, v104, v105
v_cvt_pk_bf16_f32 v177, v106, v107
v_cvt_pk_bf16_f32 v178, v120, v121
v_cvt_pk_bf16_f32 v179, v122, v123
s_waitcnt lgkmcnt(3)
v_pk_fma_f32 v[128:129], v[18:19], v[44:45], v[128:129] op_sel_hi:[1,0,1]
v_pk_fma_f32 v[130:131], v[20:21], v[44:45], v[130:131] op_sel_hi:[1,0,1]
s_waitcnt lgkmcnt(2)
v_pk_mul_f32 v[128:129], v[128:129], v[22:23]
v_cvt_pk_bf16_f32 v204, v128, v129
v_pk_mul_f32 v[130:131], v[130:131], v[24:25]
v_cvt_pk_bf16_f32 v205, v130, v131
buffer_store_dwordx4 v[176:179], v4, s[16:19], s74 offen offset:3072 sc1
v_pk_fma_f32 v[144:145], v[18:19], v[44:45], v[144:145] op_sel:[0,1,0] op_sel_hi:[1,1,1]
v_pk_mul_f32 v[144:145], v[144:145], v[22:23]
v_cvt_pk_bf16_f32 v214, v144, v145
v_pk_fma_f32 v[146:147], v[20:21], v[44:45], v[146:147] op_sel:[0,1,0] op_sel_hi:[1,1,1]
v_pk_mul_f32 v[146:147], v[146:147], v[24:25]
v_cvt_pk_bf16_f32 v215, v146, v147
v_max3_f32 v85, v103, v116, v117
v_max3_f32 v84, v84, v118, v119
v_max_f32 v86, v84, v85
v_max_f32 v85, v84, v85
v_cvt_pk_bf16_f32 v169, v66, v67
v_cvt_pk_bf16_f32 v170, v80, v81
v_permlane16_swap_b32 v86, v85
v_cvt_pk_bf16_f32 v171, v82, v83
s_waitcnt lgkmcnt(1)
v_pk_fma_f32 v[124:125], v[240:241], v[44:45], v[124:125] op_sel_hi:[1,0,1]
s_waitcnt lgkmcnt(0)
v_pk_mul_f32 v[124:125], v[124:125], v[244:245]
v_pk_fma_f32 v[126:127], v[242:243], v[44:45], v[126:127] op_sel_hi:[1,0,1]
v_pk_mul_f32 v[126:127], v[126:127], v[246:247]
v_pk_fma_f32 v[140:141], v[240:241], v[44:45], v[140:141] op_sel:[0,1,0] op_sel_hi:[1,1,1]
v_pk_mul_f32 v[140:141], v[140:141], v[244:245]
v_pk_fma_f32 v[142:143], v[242:243], v[44:45], v[142:143] op_sel:[0,1,0] op_sel_hi:[1,1,1]
v_pk_mul_f32 v[142:143], v[142:143], v[246:247]
v_max_f32 v84, v86, v85
v_max_f32 v85, v86, v85
v_mfma_f32_16x16x32_bf16 v[96:99], v[184:187], v[168:171], v[46:49]
s_nop 0
v_permlane32_swap_b32 v84, v85
v_mfma_f32_16x16x32_bf16 v[112:115], v[188:191], v[168:171], v[50:53]
v_max_f32 v84, v84, v85
v_mul_f32 v84, v84, v230
v_cvt_pk_bf16_f32 v202, v124, v125
v_cvt_pk_bf16_f32 v203, v126, v127
v_cvt_pk_bf16_f32 v212, v140, v141
v_pk_fma_f32 v[100:101], v[100:101], v[230:231], v[84:85] op_sel_hi:[1,0,0] neg_lo:[0,0,1] neg_hi:[0,0,1]
v_pk_fma_f32 v[102:103], v[102:103], v[230:231], v[84:85] op_sel_hi:[1,0,0] neg_lo:[0,0,1] neg_hi:[0,0,1]
v_pk_fma_f32 v[116:117], v[116:117], v[230:231], v[84:85] op_sel_hi:[1,0,0] neg_lo:[0,0,1] neg_hi:[0,0,1]
v_pk_fma_f32 v[118:119], v[118:119], v[230:231], v[84:85] op_sel_hi:[1,0,0] neg_lo:[0,0,1] neg_hi:[0,0,1]
v_exp_f32 v100, v100
v_exp_f32 v101, v101
v_exp_f32 v102, v102
v_exp_f32 v103, v103
v_exp_f32 v116, v116
v_exp_f32 v117, v117
v_exp_f32 v118, v118
v_exp_f32 v119, v119
v_cvt_pk_bf16_f32 v68, v100, v101
v_cvt_pk_bf16_f32 v69, v102, v103
v_cvt_pk_bf16_f32 v70, v116, v117
v_cvt_pk_bf16_f32 v71, v118, v119
v_cvt_pk_bf16_f32 v213, v142, v143
v_max3_f32 v80, v96, v97, v98
v_mfma_f32_16x16x32_bf16 v[84:87], v[248:251], v[68:71], 0
v_max3_f32 v81, v99, v112, v113
v_max3_f32 v80, v80, v114, v115
v_mfma_f32_16x16x32_bf16 v[100:103], v[204:207], v[68:71], 0
v_max_f32 v82, v80, v81
v_max_f32 v81, v80, v81
v_mfma_f32_16x16x32_bf16 v[116:119], v[214:217], v[68:71], 0
s_nop 1
v_rcp_f32 v84, v84
v_permlane16_swap_b32 v82, v81
v_cvt_pk_bf16_f32 v164, v60, v61
v_pk_mul_f32 v[100:101], v[100:101], v[84:85] op_sel_hi:[1,0]
v_pk_mul_f32 v[102:103], v[102:103], v[84:85] op_sel_hi:[1,0]
s_nop 0
v_pk_mul_f32 v[116:117], v[116:117], v[84:85] op_sel_hi:[1,0]
v_pk_mul_f32 v[118:119], v[118:119], v[84:85] op_sel_hi:[1,0]
v_cvt_pk_bf16_f32 v172, v100, v101
v_cvt_pk_bf16_f32 v173, v102, v103
v_cvt_pk_bf16_f32 v174, v116, v117
v_cvt_pk_bf16_f32 v175, v118, v119
buffer_store_dwordx4 v[172:175], v4, s[16:19], s74 offen offset:2048 sc1
v_max_f32 v80, v82, v81
v_max_f32 v81, v82, v81
v_cvt_pk_bf16_f32 v165, v62, v63
v_cvt_pk_bf16_f32 v166, v76, v77
v_permlane32_swap_b32 v80, v81
v_cvt_pk_bf16_f32 v167, v78, v79
v_max_f32 v80, v80, v81
v_mul_f32 v80, v80, v226
v_mfma_f32_16x16x32_bf16 v[92:95], v[180:183], v[164:167], v[46:49]
v_mfma_f32_16x16x32_bf16 v[108:111], v[184:187], v[164:167], v[50:53]
s_nop 6
v_max3_f32 v76, v92, v93, v94
v_pk_fma_f32 v[96:97], v[96:97], v[226:227], v[80:81] op_sel_hi:[1,0,0] neg_lo:[0,0,1] neg_hi:[0,0,1]
v_pk_fma_f32 v[98:99], v[98:99], v[226:227], v[80:81] op_sel_hi:[1,0,0] neg_lo:[0,0,1] neg_hi:[0,0,1]
v_pk_fma_f32 v[112:113], v[112:113], v[226:227], v[80:81] op_sel_hi:[1,0,0] neg_lo:[0,0,1] neg_hi:[0,0,1]
v_pk_fma_f32 v[114:115], v[114:115], v[226:227], v[80:81] op_sel_hi:[1,0,0] neg_lo:[0,0,1] neg_hi:[0,0,1]
v_exp_f32 v96, v96
v_exp_f32 v97, v97
v_exp_f32 v98, v98
v_exp_f32 v99, v99
v_exp_f32 v112, v112
v_exp_f32 v113, v113
v_exp_f32 v114, v114
v_exp_f32 v115, v115
v_cvt_pk_bf16_f32 v64, v96, v97
v_cvt_pk_bf16_f32 v65, v98, v99
v_cvt_pk_bf16_f32 v66, v112, v113
v_cvt_pk_bf16_f32 v67, v114, v115
v_max3_f32 v77, v95, v108, v109
v_max3_f32 v76, v76, v110, v111
v_mfma_f32_16x16x32_bf16 v[80:83], v[248:251], v[64:67], 0
v_max_f32 v78, v76, v77
v_max_f32 v77, v76, v77
v_mfma_f32_16x16x32_bf16 v[96:99], v[202:205], v[64:67], 0
s_nop 0
v_permlane16_swap_b32 v78, v77
v_mfma_f32_16x16x32_bf16 v[112:115], v[212:215], v[64:67], 0
s_nop 1
v_rcp_f32 v80, v80
v_max_f32 v76, v78, v77
v_max_f32 v77, v78, v77
v_pk_mul_f32 v[96:97], v[96:97], v[80:81] op_sel_hi:[1,0]
v_pk_mul_f32 v[98:99], v[98:99], v[80:81] op_sel_hi:[1,0]
s_nop 0
v_pk_mul_f32 v[112:113], v[112:113], v[80:81] op_sel_hi:[1,0]
v_pk_mul_f32 v[114:115], v[114:115], v[80:81] op_sel_hi:[1,0]
v_cvt_pk_bf16_f32 v168, v96, v97
v_cvt_pk_bf16_f32 v169, v98, v99
v_cvt_pk_bf16_f32 v170, v112, v113
v_cvt_pk_bf16_f32 v171, v114, v115
buffer_store_dwordx4 v[168:171], v4, s[16:19], s74 offen offset:1024 sc1
v_permlane32_swap_b32 v76, v77
v_max_f32 v76, v76, v77
v_mul_f32 v76, v76, v222
v_pk_fma_f32 v[92:93], v[92:93], v[222:223], v[76:77] op_sel_hi:[1,0,0] neg_lo:[0,0,1] neg_hi:[0,0,1]
v_pk_fma_f32 v[94:95], v[94:95], v[222:223], v[76:77] op_sel_hi:[1,0,0] neg_lo:[0,0,1] neg_hi:[0,0,1]
v_pk_fma_f32 v[108:109], v[108:109], v[222:223], v[76:77] op_sel_hi:[1,0,0] neg_lo:[0,0,1] neg_hi:[0,0,1]
v_pk_fma_f32 v[110:111], v[110:111], v[222:223], v[76:77] op_sel_hi:[1,0,0] neg_lo:[0,0,1] neg_hi:[0,0,1]
v_exp_f32 v92, v92
v_exp_f32 v93, v93
v_exp_f32 v94, v94
v_exp_f32 v95, v95
v_exp_f32 v108, v108
v_exp_f32 v109, v109
v_exp_f32 v110, v110
v_exp_f32 v111, v111
v_cvt_pk_bf16_f32 v60, v92, v93
v_cvt_pk_bf16_f32 v61, v94, v95
v_cvt_pk_bf16_f32 v62, v108, v109
v_cvt_pk_bf16_f32 v63, v110, v111
s_nop 1
v_mfma_f32_16x16x32_bf16 v[76:79], v[248:251], v[60:63], 0
v_mfma_f32_16x16x32_bf16 v[92:95], v[200:203], v[60:63], 0
v_mfma_f32_16x16x32_bf16 v[108:111], v[210:213], v[60:63], 0
s_nop 5
v_rcp_f32 v76, v76
s_nop 0
v_pk_mul_f32 v[92:93], v[92:93], v[76:77] op_sel_hi:[1,0]
v_pk_mul_f32 v[94:95], v[94:95], v[76:77] op_sel_hi:[1,0]
v_pk_mul_f32 v[108:109], v[108:109], v[76:77] op_sel_hi:[1,0]
v_pk_mul_f32 v[110:111], v[110:111], v[76:77] op_sel_hi:[1,0]
v_cvt_pk_bf16_f32 v164, v92, v93
v_cvt_pk_bf16_f32 v165, v94, v95
v_cvt_pk_bf16_f32 v166, v108, v109
v_cvt_pk_bf16_f32 v167, v110, v111
buffer_store_dwordx4 v[164:167], v4, s[16:19], s74 offen sc1
s_nop 1
.Lqkve3:
s_lshl_b32 s62, s3, 11
s_add_u32 s62, s62, s84
v_lshl_add_u32 v4, v1, 4, s62
v_lshrrev_b32 v2, 3, v1
v_cmp_eq_u32 vcc, 3, v2
v_add_u32 v2, 67108480, v4
s_nop 0
v_cndmask_b32 v4, v4, v2, vcc
v_bfe_u32 v5, v1, 3, 1
v_lshrrev_b32 v2, 4, v1
v_lshl_add_u32 v5, v2, 3, v5
s_lshl_b32 s62, s3, 1
v_add_u32 v5, s62, v5
v_mul_u32_u24 v5, 2048, v5
v_and_b32 v2, 7, v1
v_lshl_add_u32 v5, v2, 4, v5
s_lshl_b32 s62, s7, 7
v_add_u32 v5, s62, v5
v_add_u32 v6, 64512, v5
v_bfe_u32 v8, v1, 3, 2
v_mul_u32_u24 v8, 2080, v8
v_bfe_u32 v2, v1, 2, 1
v_lshl_add_u32 v8, v2, 7, v8
v_bfe_u32 v2, v1, 5, 1
v_lshl_add_u32 v8, v2, 8, v8
v_and_b32 v2, 3, v1
v_lshl_add_u32 v8, v2, 3, v8
s_mov_b32 s57, 66560
v_add_u32 v7, s57, v8
s_mov_b32 s52, 4194304
s_mov_b32 s53, 4210688
s_mov_b32 s54, 2097152
s_mul_i32 s56, s3, 2080
v_accvgpr_read_b32 v32, a224
v_accvgpr_read_b32 v33, a225
v_accvgpr_read_b32 v34, a226
v_accvgpr_read_b32 v35, a227
v_accvgpr_read_b32 v36, a228
v_accvgpr_read_b32 v37, a229
v_accvgpr_read_b32 v38, a230
v_accvgpr_read_b32 v39, a231
v_accvgpr_read_b32 v40, a232
v_accvgpr_read_b32 v41, a233
v_accvgpr_read_b32 v42, a234
v_accvgpr_read_b32 v43, a235
v_accvgpr_read_b32 v44, a236
v_accvgpr_read_b32 v45, a237
v_accvgpr_read_b32 v46, a238
v_accvgpr_read_b32 v47, a239
v_accvgpr_read_b32 v48, a240
v_accvgpr_read_b32 v49, a241
v_accvgpr_read_b32 v50, a242
v_accvgpr_read_b32 v51, a243
v_accvgpr_read_b32 v52, a244
v_accvgpr_read_b32 v53, a245
v_accvgpr_read_b32 v54, a246
v_accvgpr_read_b32 v55, a247
v_accvgpr_read_b32 v56, a248
v_accvgpr_read_b32 v57, a249
v_accvgpr_read_b32 v58, a250
v_accvgpr_read_b32 v59, a251
v_accvgpr_read_b32 v60, a252
v_accvgpr_read_b32 v61, a253
v_accvgpr_read_b32 v62, a254
v_accvgpr_read_b32 v63, a255
s_and_b32 s62, s3, 1
s_mul_i32 s62, s62, 28672
s_add_u32 s62, s62, s51
v_lshrrev_b32 v12, 4, v1
v_mul_u32_u24 v12, 57344, v12
v_and_b32 v2, 15, v1
v_lshl_add_u32 v12, v2, 4, v12
v_add_u32 v12, s62, v12
v_add_u32 v13, 6112, v12
v_add_u32 v14, 12224, v12
v_add_u32 v15, 18336, v12
s_mul_i32 s59, s3, 4224
s_mov_b32 s58, 0
s_mov_b32 s36, s82
s_mov_b32 s37, s83
s_lshl_b32 s62, s8, 10
s_add_u32 s62, s62, 30425088
s_lshl_b32 s64, s6, 10
s_add_u32 s64, s64, 30425088
s_lshr_b32 s67, s5, 2
s_and_b32 s67, s67, 3
s_lshl_b32 s67, s67, 7
s_add_u32 s64, s64, s67
v_lshl_add_u32 v252, v1, 7, s62
v_mov_b32 v253, s64
v_mov_b32 v255, 1
s_waitcnt vmcnt(0) lgkmcnt(0)
s_cmp_lg_u32 s3, 1
s_barrier
s_cbranch_scc1 .Lnopoll33
s_mov_b64 exec, 15
buffer_atomic_add v255, v252, s[16:19], 0 offen
s_mov_b64 exec, 1
v_mov_b32 v254, 0
buffer_atomic_add v254, v253, s[16:19], 0 offen sc0
s_sleep 5
s_mov_b32 s15, 0
.Lpoll32:
v_mov_b32 v255, 0
buffer_atomic_add v255, v253, s[16:19], 0 offen sc0
s_waitcnt vmcnt(1)
v_cmp_gt_u32 vcc, 16, v254
s_add_u32 s15, s15, 1
s_cbranch_vccz .Lnopoll33r
v_mov_b32 v254, 0
buffer_atomic_add v254, v253, s[16:19], 0 offen sc0
s_waitcnt vmcnt(1)
v_cmp_gt_u32 vcc, 16, v255
s_add_u32 s15, s15, 1
s_cbranch_vccz .Lnopoll33r
s_cmp_le_u32 s15, 100000
s_cbranch_scc1 .Lpoll32
s_branch .Lnopoll33r
.Lnopoll33:
s_mov_b64 exec, 0
s_cmp_eq_u32 s3, 2
s_cbranch_scc1 .Lpad1
s_cmp_eq_u32 s3, 3
s_cbranch_scc1 .Lpad2
s_branch .Lpad3
.Lnopoll33r:
s_mov_b64 exec, -1
s_barrier
buffer_load_dwordx4 v[64:67], v4, s[16:19], s52 offen sc1
buffer_load_dwordx4 v[68:71], v4, s[16:19], s52 offen offset:1024 sc1
s_add_u32 s52, s52, 32768
buffer_load_dwordx4 v[72:75], v4, s[16:19], s53 offen sc1
buffer_load_dwordx4 v[76:79], v4, s[16:19], s53 offen offset:1024 sc1
s_add_u32 s53, s53, 32768
buffer_load_dwordx4 v[80:83], v4, s[16:19], s52 offen sc1
buffer_load_dwordx4 v[84:87], v4, s[16:19], s52 offen offset:1024 sc1
s_add_u32 s52, s52, 32768
buffer_load_dwordx4 v[88:91], v4, s[16:19], s53 offen sc1
buffer_load_dwordx4 v[92:95], v4, s[16:19], s53 offen offset:1024 sc1
s_add_u32 s53, s53, 32768
buffer_load_dwordx4 v[96:99], v4, s[16:19], s52 offen sc1
buffer_load_dwordx4 v[100:103], v4, s[16:19], s52 offen offset:1024 sc1
s_add_u32 s52, s52, 32768
buffer_load_dwordx4 v[104:107], v4, s[16:19], s53 offen sc1
buffer_load_dwordx4 v[108:111], v4, s[16:19], s53 offen offset:1024 sc1
s_add_u32 s53, s53, 32768
ds_read_b64_tr_b16 a[0:1], v7
TR 2,7,512
TR 4,7,32
TR 6,7,544
TR 8,7,64
TR 10,7,576
TR 12,7,96
TR 14,7,608
TR 16,7,1024
TR 18,7,1536
TR 20,7,1056
TR 22,7,1568
TR 24,7,1088
TR 26,7,1600
TR 28,7,1120
TR 30,7,1632
s_waitcnt vmcnt(11) lgkmcnt(14)
MAV 32,0,64
TR 32,7,8320
TR 34,7,8832
s_waitcnt vmcnt(10)
MAV 48,0,68
buffer_load_dwordx4 v[112:115], v4, s[16:19], s52 offen sc1
s_waitcnt lgkmcnt(14)
MAV 52,4,68
TR 36,7,8352
TR 38,7,8864
MAV 36,4,64
TR 40,7,8384
TR 42,7,8896
s_waitcnt lgkmcnt(15)
MAV 40,8,64
buffer_load_dwordx4 v[116:119], v4, s[16:19], s52 offen offset:1024 sc1
MAV 56,8,68
TR 44,7,8416
s_add_u32 s52, s52, 32768
s_waitcnt lgkmcnt(15)
MAV 60,12,68
TR 46,7,8928
MAV 44,12,64
TR 48,7,9344
TR 50,7,9856
s_waitcnt vmcnt(11) lgkmcnt(15)
MAV 32,16,72
buffer_load_dwordx4 v[120:123], v4, s[16:19], s53 offen sc1
s_waitcnt vmcnt(11)
MAV 48,16,76
TR 52,7,9376
TR 54,7,9888
s_waitcnt lgkmcnt(15)
MAV 52,20,76
TR 56,7,9408
TR 58,7,9920
MAV 36,20,72
buffer_load_dwordx4 v[124:127], v4, s[16:19], s53 offen offset:1024 sc1
s_waitcnt lgkmcnt(15)
MAV 40,24,72
TR 60,7,9440
s_add_u32 s53, s53, 32768
MAV 56,24,76
TR 62,7,9952
s_waitcnt lgkmcnt(15)
MAV 60,28,76
MAV 44,28,72
s_waitcnt vmcnt(11) lgkmcnt(14)
MAV 32,32,80
TR 0,7,16640
TR 2,7,17152
s_waitcnt vmcnt(10)
MAV 48,32,84
buffer_load_dwordx4 v[64:67], v4, s[16:19], s52 offen sc1
s_waitcnt lgkmcnt(14)
MAV 52,36,84
TR 4,7,16672
TR 6,7,17184
MAV 36,36,80
TR 8,7,16704
TR 10,7,17216
s_waitcnt lgkmcnt(15)
MAV 40,40,80
buffer_load_dwordx4 v[68:71], v4, s[16:19], s52 offen offset:1024 sc1
MAV 56,40,84
TR 12,7,16736
s_add_u32 s52, s52, 32768
s_waitcnt lgkmcnt(15)
MAV 60,44,84
TR 14,7,17248
MAV 44,44,80
TR 16,7,17664
TR 18,7,18176
s_waitcnt vmcnt(11) lgkmcnt(15)
MAV 32,48,88
buffer_load_dwordx4 v[72:75], v4, s[16:19], s53 offen sc1
s_waitcnt vmcnt(11)
MAV 48,48,92
TR 20,7,17696
TR 22,7,18208
s_waitcnt lgkmcnt(15)
MAV 52,52,92
TR 24,7,17728
TR 26,7,18240
MAV 36,52,88
buffer_load_dwordx4 v[76:79], v4, s[16:19], s53 offen offset:1024 sc1
s_waitcnt lgkmcnt(15)
MAV 40,56,88
TR 28,7,17760
s_add_u32 s53, s53, 32768
MAV 56,56,92
TR 30,7,18272
s_waitcnt lgkmcnt(15)
MAV 60,60,92
MAV 44,60,88
s_waitcnt vmcnt(11) lgkmcnt(14)
MAV 32,0,96
TR 32,7,24960
TR 34,7,25472
s_waitcnt vmcnt(10)
MAV 48,0,100
buffer_load_dwordx4 v[80:83], v4, s[16:19], s52 offen sc1
s_waitcnt lgkmcnt(14)
MAV 52,4,100
TR 36,7,24992
TR 38,7,25504
MAV 36,4,96
TR 40,7,25024
TR 42,7,25536
s_waitcnt lgkmcnt(15)
MAV 40,8,96
buffer_load_dwordx4 v[84:87], v4, s[16:19], s52 offen offset:1024 sc1
MAV 56,8,100
TR 44,7,25056
s_add_u32 s52, s52, 32768
s_waitcnt lgkmcnt(15)
MAV 60,12,100
TR 46,7,25568
MAV 44,12,96
TR 48,7,25984
TR 50,7,26496
s_waitcnt vmcnt(11) lgkmcnt(15)
MAV 32,16,104
buffer_load_dwordx4 v[88:91], v4, s[16:19], s53 offen sc1
s_waitcnt vmcnt(11)
MAV 48,16,108
TR 52,7,26016
TR 54,7,26528
s_waitcnt lgkmcnt(15)
MAV 52,20,108
TR 56,7,26048
TR 58,7,26560
MAV 36,20,104
buffer_load_dwordx4 v[92:95], v4, s[16:19], s53 offen offset:1024 sc1
s_waitcnt lgkmcnt(15)
MAV 40,24,104
TR 60,7,26080
s_add_u32 s53, s53, 32768
MAV 56,24,108
TR 62,7,26592
s_waitcnt lgkmcnt(15)
MAV 60,28,108
MAV 44,28,104
s_waitcnt vmcnt(11) lgkmcnt(14)
MAV 32,32,112
TR 0,7,33280
TR 2,7,33792
s_waitcnt vmcnt(10)
MAV 48,32,116
buffer_load_dwordx4 v[96:99], v4, s[16:19], s52 offen sc1
s_waitcnt lgkmcnt(14)
MAV 52,36,116
TR 4,7,33312
TR 6,7,33824
MAV 36,36,112
TR 8,7,33344
TR 10,7,33856
s_waitcnt lgkmcnt(15)
MAV 40,40,112
buffer_load_dwordx4 v[100:103], v4, s[16:19], s52 offen offset:1024 sc1
MAV 56,40,116
TR 12,7,33376
s_add_u32 s52, s52, 32768
s_waitcnt lgkmcnt(15)
MAV 60,44,116
TR 14,7,33888
MAV 44,44,112
TR 16,7,34304
TR 18,7,34816
s_waitcnt vmcnt(11) lgkmcnt(15)
MAV 32,48,120
buffer_load_dwordx4 v[104:107], v4, s[16:19], s53 offen sc1
s_waitcnt vmcnt(11)
MAV 48,48,124
TR 20,7,34336
TR 22,7,34848
s_waitcnt lgkmcnt(15)
MAV 52,52,124
TR 24,7,34368
TR 26,7,34880
MAV 36,52,120
buffer_load_dwordx4 v[108:111], v4, s[16:19], s53 offen offset:1024 sc1
s_waitcnt lgkmcnt(15)
MAV 40,56,120
TR 28,7,34400
s_add_u32 s53, s53, 32768
MAV 56,56,124
TR 30,7,34912
s_waitcnt lgkmcnt(15)
MAV 60,60,124
MAV 44,60,120
s_waitcnt vmcnt(11) lgkmcnt(14)
MAV 32,0,64
TR 32,7,41600
TR 34,7,42112
s_waitcnt vmcnt(10)
MAV 48,0,68
buffer_load_dwordx4 v[112:115], v4, s[16:19], s52 offen sc1
s_waitcnt lgkmcnt(14)
MAV 52,4,68
TR 36,7,41632
TR 38,7,42144
MAV 36,4,64
TR 40,7,41664
TR 42,7,42176
s_waitcnt lgkmcnt(15)
MAV 40,8,64
buffer_load_dwordx4 v[116:119], v4, s[16:19], s52 offen offset:1024 sc1
MAV 56,8,68
TR 44,7,41696
s_add_u32 s52, s52, 32768
s_waitcnt lgkmcnt(15)
MAV 60,12,68
TR 46,7,42208
MAV 44,12,64
TR 48,7,42624
TR 50,7,43136
s_waitcnt vmcnt(11) lgkmcnt(15)
MAV 32,16,72
buffer_load_dwordx4 v[120:123], v4, s[16:19], s53 offen sc1
s_waitcnt vmcnt(11)
MAV 48,16,76
TR 52,7,42656
TR 54,7,43168
s_waitcnt lgkmcnt(15)
MAV 52,20,76
TR 56,7,42688
TR 58,7,43200
MAV 36,20,72
buffer_load_dwordx4 v[124:127], v4, s[16:19], s53 offen offset:1024 sc1
s_waitcnt lgkmcnt(15)
MAV 40,24,72
TR 60,7,42720
s_add_u32 s53, s53, 32768
MAV 56,24,76
TR 62,7,43232
s_waitcnt lgkmcnt(15)
MAV 60,28,76
MAV 44,28,72
s_waitcnt vmcnt(11) lgkmcnt(14)
MAV 32,32,80
TR 0,7,49920
TR 2,7,50432
s_waitcnt vmcnt(10)
MAV 48,32,84
buffer_load_dwordx4 v[64:67], v4, s[16:19], s52 offen sc1
s_waitcnt lgkmcnt(14)
MAV 52,36,84
TR 4,7,49952
TR 6,7,50464
MAV 36,36,80
TR 8,7,49984
TR 10,7,50496
s_waitcnt lgkmcnt(15)
MAV 40,40,80
buffer_load_dwordx4 v[68:71], v4, s[16:19], s52 offen offset:1024 sc1
MAV 56,40,84
TR 12,7,50016
s_add_u32 s52, s52, 32768
s_waitcnt lgkmcnt(15)
MAV 60,44,84
TR 14,7,50528
MAV 44,44,80
TR 16,7,50944
TR 18,7,51456
s_waitcnt vmcnt(11) lgkmcnt(15)
MAV 32,48,88
buffer_load_dwordx4 v[72:75], v4, s[16:19], s53 offen sc1
s_waitcnt vmcnt(11)
MAV 48,48,92
TR 20,7,50976
TR 22,7,51488
s_waitcnt lgkmcnt(15)
MAV 52,52,92
TR 24,7,51008
TR 26,7,51520
MAV 36,52,88
buffer_load_dwordx4 v[76:79], v4, s[16:19], s53 offen offset:1024 sc1
s_waitcnt lgkmcnt(15)
MAV 40,56,88
TR 28,7,51040
s_add_u32 s53, s53, 32768
MAV 56,56,92
TR 30,7,51552
s_waitcnt lgkmcnt(15)
MAV 60,60,92
MAV 44,60,88
s_waitcnt vmcnt(11) lgkmcnt(14)
MAV 32,0,96
TR 32,7,58240
TR 34,7,58752
s_waitcnt vmcnt(10)
MAV 48,0,100
buffer_load_dwordx4 v[80:83], v4, s[16:19], s52 offen sc1
s_waitcnt lgkmcnt(14)
MAV 52,4,100
TR 36,7,58272
TR 38,7,58784
MAV 36,4,96
TR 40,7,58304
TR 42,7,58816
s_waitcnt lgkmcnt(15)
MAV 40,8,96
buffer_load_dwordx4 v[84:87], v4, s[16:19], s52 offen offset:1024 sc1
MAV 56,8,100
TR 44,7,58336
s_add_u32 s52, s52, 32768
s_waitcnt lgkmcnt(15)
MAV 60,12,100
TR 46,7,58848
MAV 44,12,96
TR 48,7,59264
TR 50,7,59776
s_waitcnt vmcnt(11) lgkmcnt(15)
MAV 32,16,104
buffer_load_dwordx4 v[88:91], v4, s[16:19], s53 offen sc1
s_waitcnt vmcnt(11)
MAV 48,16,108
TR 52,7,59296
TR 54,7,59808
s_waitcnt lgkmcnt(15)
MAV 52,20,108
TR 56,7,59328
TR 58,7,59840
MAV 36,20,104
buffer_load_dwordx4 v[92:95], v4, s[16:19], s53 offen offset:1024 sc1
s_waitcnt lgkmcnt(15)
MAV 40,24,104
TR 60,7,59360
s_add_u32 s53, s53, 32768
MAV 56,24,108
TR 62,7,59872
s_waitcnt lgkmcnt(15)
MAV 60,28,108
MAV 44,28,104
s_xor_b32 s57, s57, 66560
v_add_u32 v7, s57, v8
s_waitcnt vmcnt(11) lgkmcnt(14)
MAV 32,32,112
ds_read_b64_tr_b16 a[0:1], v7
TR 2,7,512
s_waitcnt vmcnt(10)
MAV 48,32,116
buffer_load_dwordx4 v[96:99], v4, s[16:19], s52 offen sc1
s_waitcnt lgkmcnt(14)
MAV 52,36,116
TR 4,7,32
TR 6,7,544
MAV 36,36,112
TR 8,7,64
TR 10,7,576
s_waitcnt lgkmcnt(15)
MAV 40,40,112
buffer_load_dwordx4 v[100:103], v4, s[16:19], s52 offen offset:1024 sc1
MAV 56,40,116
TR 12,7,96
s_add_u32 s52, s52, 32768
s_waitcnt lgkmcnt(15)
MAV 60,44,116
TR 14,7,608
MAV 44,44,112
TR 16,7,1024
TR 18,7,1536
s_waitcnt vmcnt(11) lgkmcnt(15)
MAV 32,48,120
buffer_load_dwordx4 v[104:107], v4, s[16:19], s53 offen sc1
s_waitcnt vmcnt(11)
MAV 48,48,124
TR 20,7,1056
TR 22,7,1568
s_waitcnt lgkmcnt(15)
MAV 52,52,124
TR 24,7,1088
TR 26,7,1600
MAV 36,52,120
buffer_load_dwordx4 v[108:111], v4, s[16:19], s53 offen offset:1024 sc1
s_waitcnt lgkmcnt(15)
MAV 40,56,120
TR 28,7,1120
s_add_u32 s53, s53, 32768
MAV 56,56,124
TR 30,7,1632
s_waitcnt lgkmcnt(15)
MAV 60,60,124
MAV 44,60,120
s_waitcnt vmcnt(11) lgkmcnt(14)
MAV 32,0,64
TR 32,7,8320
TR 34,7,8832
s_waitcnt vmcnt(10)
MAV 48,0,68
buffer_load_dwordx4 v[112:115], v4, s[16:19], s52 offen sc1
s_waitcnt lgkmcnt(14)
MAV 52,4,68
TR 36,7,8352
TR 38,7,8864
MAV 36,4,64
TR 40,7,8384
TR 42,7,8896
s_waitcnt lgkmcnt(15)
MAV 40,8,64
buffer_load_dwordx4 v[116:119], v4, s[16:19], s52 offen offset:1024 sc1
MAV 56,8,68
TR 44,7,8416
s_add_u32 s52, s52, 32768
s_waitcnt lgkmcnt(15)
MAV 60,12,68
TR 46,7,8928
MAV 44,12,64
TR 48,7,9344
TR 50,7,9856
s_waitcnt vmcnt(11) lgkmcnt(15)
MAV 32,16,72
buffer_load_dwordx4 v[120:123], v4, s[16:19], s53 offen sc1
s_waitcnt vmcnt(11)
MAV 48,16,76
TR 52,7,9376
TR 54,7,9888
s_waitcnt lgkmcnt(15)
MAV 52,20,76
TR 56,7,9408
TR 58,7,9920
MAV 36,20,72
buffer_load_dwordx4 v[124:127], v4, s[16:19], s53 offen offset:1024 sc1
s_waitcnt lgkmcnt(15)
MAV 40,24,72
TR 60,7,9440
s_add_u32 s53, s53, 32768
MAV 56,24,76
TR 62,7,9952
s_waitcnt lgkmcnt(15)
MAV 60,28,76
MAV 44,28,72
s_waitcnt vmcnt(11) lgkmcnt(14)
MAV 32,32,80
TR 0,7,16640
TR 2,7,17152
s_waitcnt vmcnt(10)
MAV 48,32,84
buffer_load_dwordx4 v[64:67], v4, s[16:19], s52 offen sc1
s_waitcnt lgkmcnt(14)
MAV 52,36,84
TR 4,7,16672
TR 6,7,17184
MAV 36,36,80
TR 8,7,16704
TR 10,7,17216
s_waitcnt lgkmcnt(15)
MAV 40,40,80
buffer_load_dwordx4 v[68:71], v4, s[16:19], s52 offen offset:1024 sc1
MAV 56,40,84
TR 12,7,16736
s_add_u32 s52, s52, 32768
s_waitcnt lgkmcnt(15)
MAV 60,44,84
TR 14,7,17248
MAV 44,44,80
TR 16,7,17664
TR 18,7,18176
s_waitcnt vmcnt(11) lgkmcnt(15)
MAV 32,48,88
buffer_load_dwordx4 v[72:75], v4, s[16:19], s53 offen sc1
s_waitcnt vmcnt(11)
MAV 48,48,92
TR 20,7,17696
TR 22,7,18208
s_waitcnt lgkmcnt(15)
MAV 52,52,92
TR 24,7,17728
TR 26,7,18240
MAV 36,52,88
buffer_load_dwordx4 v[76:79], v4, s[16:19], s53 offen offset:1024 sc1
s_waitcnt lgkmcnt(15)
MAV 40,56,88
TR 28,7,17760
s_add_u32 s53, s53, 32768
MAV 56,56,92
TR 30,7,18272
s_waitcnt lgkmcnt(15)
MAV 60,60,92
MAV 44,60,88
s_waitcnt vmcnt(11) lgkmcnt(14)
MAV 32,0,96
TR 32,7,24960
TR 34,7,25472
s_waitcnt vmcnt(10)
MAV 48,0,100
buffer_load_dwordx4 v[80:83], v4, s[16:19], s52 offen sc1
s_waitcnt lgkmcnt(14)
MAV 52,4,100
.Lpad1:
s_cbranch_execz .Lpad4
TR 36,7,24992
TR 38,7,25504
MAV 36,4,96
TR 40,7,25024
TR 42,7,25536
s_waitcnt lgkmcnt(15)
MAV 40,8,96
buffer_load_dwordx4 v[84:87], v4, s[16:19], s52 offen offset:1024 sc1
MAV 56,8,100
TR 44,7,25056
s_add_u32 s52, s52, 32768
s_waitcnt lgkmcnt(15)
MAV 60,12,100
TR 46,7,25568
MAV 44,12,96
TR 48,7,25984
TR 50,7,26496
s_waitcnt vmcnt(11) lgkmcnt(15)
MAV 32,16,104
buffer_load_dwordx4 v[88:91], v4, s[16:19], s53 offen sc1
s_waitcnt vmcnt(11)
MAV 48,16,108
TR 52,7,26016
TR 54,7,26528
s_waitcnt lgkmcnt(15)
MAV 52,20,108
TR 56,7,26048
TR 58,7,26560
MAV 36,20,104
buffer_load_dwordx4 v[92:95], v4, s[16:19], s53 offen offset:1024 sc1
s_waitcnt lgkmcnt(15)
MAV 40,24,104
TR 60,7,26080
s_add_u32 s53, s53, 32768
MAV 56,24,108
TR 62,7,26592
s_waitcnt lgkmcnt(15)
MAV 60,28,108
MAV 44,28,104
s_waitcnt vmcnt(11) lgkmcnt(14)
MAV 32,32,112
TR 0,7,33280
TR 2,7,33792
s_waitcnt vmcnt(10)
MAV 48,32,116
buffer_load_dwordx4 v[96:99], v4, s[16:19], s52 offen sc1
s_waitcnt lgkmcnt(14)
MAV 52,36,116
TR 4,7,33312
TR 6,7,33824
MAV 36,36,112
TR 8,7,33344
TR 10,7,33856
s_waitcnt lgkmcnt(15)
MAV 40,40,112
buffer_load_dwordx4 v[100:103], v4, s[16:19], s52 offen offset:1024 sc1
MAV 56,40,116
TR 12,7,33376
s_add_u32 s52, s52, 32768
s_waitcnt lgkmcnt(15)
MAV 60,44,116
TR 14,7,33888
MAV 44,44,112
TR 16,7,34304
TR 18,7,34816
s_waitcnt vmcnt(11) lgkmcnt(15)
MAV 32,48,120
buffer_load_dwordx4 v[104:107], v4, s[16:19], s53 offen sc1
s_waitcnt vmcnt(11)
MAV 48,48,124
TR 20,7,34336
TR 22,7,34848
s_waitcnt lgkmcnt(15)
MAV 52,52,124
TR 24,7,34368
TR 26,7,34880
MAV 36,52,120
buffer_load_dwordx4 v[108:111], v4, s[16:19], s53 offen offset:1024 sc1
s_waitcnt lgkmcnt(15)
MAV 40,56,120
TR 28,7,34400
s_add_u32 s53, s53, 32768
MAV 56,56,124
TR 30,7,34912
s_waitcnt lgkmcnt(15)
MAV 60,60,124
MAV 44,60,120
s_waitcnt vmcnt(11) lgkmcnt(14)
MAV 32,0,64
TR 32,7,41600
TR 34,7,42112
s_waitcnt vmcnt(10)
MAV 48,0,68
buffer_load_dwordx4 v[112:115], v4, s[16:19], s52 offen sc1
s_waitcnt lgkmcnt(14)
MAV 52,4,68
TR 36,7,41632
TR 38,7,42144
MAV 36,4,64
TR 40,7,41664
TR 42,7,42176
s_waitcnt lgkmcnt(15)
MAV 40,8,64
buffer_load_dwordx4 v[116:119], v4, s[16:19], s52 offen offset:1024 sc1
MAV 56,8,68
TR 44,7,41696
s_add_u32 s52, s52, 32768
s_waitcnt lgkmcnt(15)
MAV 60,12,68
TR 46,7,42208
MAV 44,12,64
TR 48,7,42624
TR 50,7,43136
s_waitcnt vmcnt(11) lgkmcnt(15)
MAV 32,16,72
buffer_load_dwordx4 v[120:123], v4, s[16:19], s53 offen sc1
s_waitcnt vmcnt(11)
MAV 48,16,76
TR 52,7,42656
TR 54,7,43168
s_waitcnt lgkmcnt(15)
MAV 52,20,76
TR 56,7,42688
TR 58,7,43200
MAV 36,20,72
buffer_load_dwordx4 v[124:127], v4, s[16:19], s53 offen offset:1024 sc1
s_waitcnt lgkmcnt(15)
MAV 40,24,72
TR 60,7,42720
s_add_u32 s53, s53, 32768
MAV 56,24,76
TR 62,7,43232
s_waitcnt lgkmcnt(15)
MAV 60,28,76
MAV 44,28,72
s_waitcnt lgkmcnt(0)
s_barrier
s_waitcnt vmcnt(11)
MAV 32,32,80
TR 0,7,49920
TR 2,7,50432
s_add_u32 m0, s59, 84480
s_waitcnt vmcnt(10)
MAV 48,32,84
TR 4,7,49952
buffer_load_dwordx4 v12, s[32:35], s58 offen   lds
MAV 52,36,84
TR 6,7,50464
TR 8,7,49984
MAV 36,36,80
TR 10,7,50496
MAV 40,40,80
TR 12,7,50016
buffer_load_dwordx4 v13, s[32:35], s58 offen offset:1056   lds
MAV 56,40,84
TR 14,7,50528
TR 16,7,50944
MAV 60,44,84
TR 18,7,51456
TR 20,7,50976
MAV 44,44,80
TR 22,7,51488
s_waitcnt vmcnt(11)
MAV 32,48,88
TR 24,7,51008
buffer_load_dwordx4 v14, s[32:35], s58 offen offset:2112   lds
s_waitcnt vmcnt(11)
MAV 48,48,92
TR 26,7,51520
TR 28,7,51040
MAV 52,52,92
TR 30,7,51552
MAV 36,52,88
buffer_load_dwordx4 v15, s[32:35], s58 offen offset:3168   lds
MAV 40,56,88
s_add_u32 s58, s58, 229376
MAV 56,56,92
MAV 60,60,92
MAV 44,60,88
s_waitcnt vmcnt(11) lgkmcnt(14)
MAV 32,0,96
TR 32,7,58240
s_add_u32 m0, s59, 101376
s_waitcnt vmcnt(10)
MAV 48,0,100
buffer_load_dwordx4 v12, s[32:35], s58 offen   lds
s_waitcnt lgkmcnt(13)
MAV 52,4,100
TR 34,7,58752
TR 36,7,58272
MAV 36,4,96
TR 38,7,58784
TR 40,7,58304
s_waitcnt lgkmcnt(15)
MAV 40,8,96
buffer_load_dwordx4 v13, s[32:35], s58 offen offset:1056   lds
MAV 56,8,100
TR 42,7,58816
TR 44,7,58336
s_waitcnt lgkmcnt(15)
MAV 60,12,100
TR 46,7,58848
MAV 44,12,96
TR 48,7,59264
TR 50,7,59776
s_waitcnt vmcnt(11) lgkmcnt(15)
MAV 32,16,104
buffer_load_dwordx4 v14, s[32:35], s58 offen offset:2112   lds
s_waitcnt vmcnt(11)
MAV 48,16,108
TR 52,7,59296
TR 54,7,59808
s_waitcnt lgkmcnt(15)
MAV 52,20,108
TR 56,7,59328
TR 58,7,59840
MAV 36,20,104
buffer_load_dwordx4 v15, s[32:35], s58 offen offset:3168   lds
s_waitcnt lgkmcnt(15)
MAV 40,24,104
TR 60,7,59360
s_add_u32 s58, s58, 229376
MAV 56,24,108
TR 62,7,59872
s_waitcnt lgkmcnt(15)
MAV 60,28,108
MAV 44,28,104
s_waitcnt vmcnt(11) lgkmcnt(14)
MAV 32,32,112
s_add_u32 m0, s59, 118272
s_lshl_b32 s64, s6, 14
s_lshl_b32 s65, s49, 13
s_waitcnt vmcnt(10)
MAV 48,32,116
buffer_load_dwordx4 v12, s[32:35], s58 offen   lds
s_waitcnt lgkmcnt(12)
MAV 52,36,116
s_add_u32 s64, s64, s65
s_lshl_b32 s65, s7, 9
s_add_u32 s64, s64, s65
MAV 36,36,112
s_lshl_b32 s65, s48, 8
s_add_u32 s64, s64, s65
s_add_u32 s64, s64, 29622272
s_waitcnt lgkmcnt(10)
MAV 40,40,112
s_lshl_b32 s62, s7, 15
v_and_b32 v152, 31, v1
v_lshlrev_b32 v152, 3, v152
MAV 56,40,116
buffer_load_dwordx4 v13, s[32:35], s58 offen offset:1056   lds
s_waitcnt lgkmcnt(8)
MAV 60,44,116
s_add_u32 s62, s62, 8388608
v_lshrrev_b32 v153, 5, v1
v_lshl_add_u32 v152, v153, 28, v152
MAV 44,44,112
s_add_u32 s63, s62, 16384
s_waitcnt vmcnt(11) lgkmcnt(6)
MAV 32,48,120
s_waitcnt vmcnt(10)
MAV 48,48,124
buffer_load_dwordx4 v14, s[32:35], s58 offen offset:2112   lds
s_waitcnt lgkmcnt(4)
MAV 52,52,124
s_nop 2
v_cvt_pk_bf16_f32 v128, v32, v33
v_cvt_pk_bf16_f32 v129, v34, v35
MAV 36,52,120
v_cvt_pk_bf16_f32 v136, v48, v49
v_cvt_pk_bf16_f32 v137, v50, v51
s_waitcnt lgkmcnt(2)
MAV 40,56,120
v_cvt_pk_bf16_f32 v138, v52, v53
v_cvt_pk_bf16_f32 v139, v54, v55
MAV 56,56,124
buffer_load_dwordx4 v15, s[32:35], s58 offen offset:3168   lds
s_waitcnt lgkmcnt(0)
MAV 60,60,124
s_add_u32 s58, s58, 229376
v_cvt_pk_bf16_f32 v130, v36, v37
v_cvt_pk_bf16_f32 v131, v38, v39
MAV 44,60,120
v_cvt_pk_bf16_f32 v132, v40, v41
v_cvt_pk_bf16_f32 v133, v42, v43
v_cvt_pk_bf16_f32 v140, v56, v57
v_cvt_pk_bf16_f32 v141, v58, v59
v_cvt_pk_bf16_f32 v142, v60, v61
v_cvt_pk_bf16_f32 v143, v62, v63
v_pk_mul_f32 v[146:147], v[32:33], v[32:33]
buffer_store_dwordx4 v[128:131], v4, s[16:19], s62 offen sc1
v_cvt_pk_bf16_f32 v134, v44, v45
v_cvt_pk_bf16_f32 v135, v46, v47
v_pk_mul_f32 v[150:151], v[48:49], v[48:49]
v_pk_fma_f32 v[146:147], v[34:35], v[34:35], v[146:147]
v_pk_add_f32 v[144:145], v[32:33], v[34:35]
v_pk_fma_f32 v[150:151], v[50:51], v[50:51], v[150:151]
v_pk_add_f32 v[148:149], v[48:49], v[50:51]
v_pk_fma_f32 v[146:147], v[36:37], v[36:37], v[146:147]
v_pk_add_f32 v[144:145], v[144:145], v[36:37]
v_pk_fma_f32 v[150:151], v[52:53], v[52:53], v[150:151]
v_pk_add_f32 v[148:149], v[148:149], v[52:53]
v_pk_fma_f32 v[146:147], v[38:39], v[38:39], v[146:147]
v_pk_add_f32 v[144:145], v[144:145], v[38:39]
buffer_store_dwordx4 v[132:135], v4, s[16:19], s63 offen sc1
v_pk_fma_f32 v[150:151], v[54:55], v[54:55], v[150:151]
v_pk_add_f32 v[148:149], v[148:149], v[54:55]
v_pk_fma_f32 v[146:147], v[40:41], v[40:41], v[146:147]
v_pk_add_f32 v[144:145], v[144:145], v[40:41]
v_pk_fma_f32 v[150:151], v[56:57], v[56:57], v[150:151]
v_pk_add_f32 v[148:149], v[148:149], v[56:57]
v_pk_fma_f32 v[146:147], v[42:43], v[42:43], v[146:147]
v_pk_add_f32 v[144:145], v[144:145], v[42:43]
v_pk_fma_f32 v[150:151], v[58:59], v[58:59], v[150:151]
v_pk_add_f32 v[148:149], v[148:149], v[58:59]
v_pk_fma_f32 v[146:147], v[44:45], v[44:45], v[146:147]
v_pk_add_f32 v[144:145], v[144:145], v[44:45]
v_pk_fma_f32 v[150:151], v[60:61], v[60:61], v[150:151]
buffer_store_dwordx4 v[136:139], v4, s[16:19], s62 offen offset:1024 sc1
v_pk_add_f32 v[148:149], v[148:149], v[60:61]
v_pk_fma_f32 v[146:147], v[46:47], v[46:47], v[146:147]
v_pk_add_f32 v[144:145], v[144:145], v[46:47]
v_pk_fma_f32 v[150:151], v[62:63], v[62:63], v[150:151]
v_pk_add_f32 v[148:149], v[148:149], v[62:63]
v_add_f32 v144, v144, v145
v_add_f32 v146, v146, v147
v_add_f32 v148, v148, v149
v_add_f32 v150, v150, v151
s_nop 0
v_permlane16_swap_b32 v144, v148
v_permlane16_swap_b32 v146, v150
v_add_f32 v144, v144, v148
buffer_store_dwordx4 v[140:143], v4, s[16:19], s63 offen offset:1024 sc1
v_add_f32 v146, v146, v150
s_nop 1
v_permlane32_swap_b32 v144, v146
v_add_f32 v144, v144, v146
s_nop 1
v_permlane32_swap_b32 v144, v145
buffer_store_dwordx2 v[144:145], v152, s[16:19], s64 offen sc1
s_nop 1
v_accvgpr_write_b32 a224, v32
v_accvgpr_write_b32 a225, v33
v_accvgpr_write_b32 a226, v34
v_accvgpr_write_b32 a227, v35
v_accvgpr_write_b32 a228, v36
v_accvgpr_write_b32 a229, v37
v_accvgpr_write_b32 a230, v38
v_accvgpr_write_b32 a231, v39
v_accvgpr_write_b32 a232, v40
v_accvgpr_write_b32 a233, v41
v_accvgpr_write_b32 a234, v42
v_accvgpr_write_b32 a235, v43
v_accvgpr_write_b32 a236, v44
v_accvgpr_write_b32 a237, v45
v_accvgpr_write_b32 a238, v46
v_accvgpr_write_b32 a239, v47
v_accvgpr_write_b32 a240, v48
v_accvgpr_write_b32 a241, v49
v_accvgpr_write_b32 a242, v50
v_accvgpr_write_b32 a243, v51
v_accvgpr_write_b32 a244, v52
v_accvgpr_write_b32 a245, v53
v_accvgpr_write_b32 a246, v54
v_accvgpr_write_b32 a247, v55
v_accvgpr_write_b32 a248, v56
v_accvgpr_write_b32 a249, v57
v_accvgpr_write_b32 a250, v58
v_accvgpr_write_b32 a251, v59
v_accvgpr_write_b32 a252, v60
v_accvgpr_write_b32 a253, v61
v_accvgpr_write_b32 a254, v62
v_accvgpr_write_b32 a255, v63
s_lshl_b32 s62, s10, 19
s_lshl_b32 s63, s3, 12
s_add_u32 s62, s62, s63
s_lshl_b32 s63, s12, 11
s_add_u32 s62, s62, s63
v_lshl_add_u32 v10, v1, 4, s62
v_lshrrev_b32 v2, 3, v1
v_cmp_eq_u32 vcc, 3, v2
v_add_u32 v2, 67108480, v10
s_nop 0
v_cndmask_b32 v10, v10, v2, vcc
v_xor_b32 v11, 2048, v10
v_bfe_u32 v16, v1, 2, 3
v_mul_u32_u24 v16, 1056, v16
v_bfe_u32 v2, v1, 5, 1
v_lshl_add_u32 v16, v2, 8, v16
v_and_b32 v2, 3, v1
v_lshl_add_u32 v16, v2, 3, v16
s_lshl_b32 s62, s12, 6
s_add_u32 s62, s62, 84480
s_xor_b32 s63, s12, 1
s_mul_i32 s63, s63, 192
s_add_u32 s63, s63, 84480
v_add_u32 v17, s63, v16
v_add_u32 v16, s62, v16
s_mov_b32 s52, 8388608
s_mov_b32 s54, s58
s_mov_b32 s55, s59
s_mul_i32 s59, s3, 2112
s_and_b32 s62, s7, 1
s_mul_i32 s62, s62, 3670016
s_lshr_b32 s63, s7, 1
s_lshl_b32 s63, s63, 8
s_add_u32 s62, s62, s63
s_lshl_b32 s63, s3, 12
s_add_u32 s62, s62, s63
v_lshrrev_b32 v5, 4, v1
v_lshlrev_b32 v5, 14, v5
v_and_b32 v2, 15, v1
v_lshl_add_u32 v5, v2, 4, v5
v_add_u32 v5, s62, v5
v_add_u32 v6, 992, v5
s_lshl_b32 s62, s10, 15
s_lshl_b32 s63, s3, 13
s_add_u32 s62, s62, s63
v_lshl_add_u32 v4, v1, 4, s62
s_and_b32 s47, s5, 3
s_lshr_b32 s63, s5, 2
s_lshl_b32 s63, s63, 3
s_add_u32 s63, s63, s4
s_lshl_b32 s62, s63, 1
s_add_u32 s62, s62, s48
s_mul_i32 s62, s62, 1792
v_lshrrev_b32 v7, 2, v1
v_min_u32 v8, 13, v7
v_lshl_add_u32 v8, v8, 7, s62
s_lshl_b32 s62, s63, 2
s_add_u32 s62, s62, s3
s_mul_i32 s62, s62, 640
v_and_b32 v7, 7, v7
v_min_u32 v7, 4, v7
v_lshl_add_u32 v7, v7, 7, s62
v_lshrrev_b32 v2, 5, v1
v_mul_u32_u24 v2, 3670016, v2
v_add_u32 v7, v7, v2
s_mul_i32 s44, s47, 163840
s_add_u32 s45, s47, 12
s_mul_i32 s45, s45, 229376
v_and_b32 v2, 1, v1
v_lshlrev_b32 v2, 4, v2
v_mov_b32 v9, 0x3f80
v_lshlrev_b32 v2, v2, v9
v_bfe_u32 v9, v1, 1, 3
v_cmp_eq_u32 vcc, 0, v9
s_nop 1
v_cndmask_b32 v20, 0, v2, vcc
v_cmp_eq_u32 vcc, 1, v9
s_nop 1
v_cndmask_b32 v21, 0, v2, vcc
v_cmp_eq_u32 vcc, 2, v9
s_nop 1
v_cndmask_b32 v22, 0, v2, vcc
v_cmp_eq_u32 vcc, 3, v9
s_nop 1
v_cndmask_b32 v23, 0, v2, vcc
s_add_u32 s62, s55, 84480
v_lshl_add_u32 v9, v1, 4, s62
v_mov_b64 v[24:25], 0
v_mov_b64 v[26:27], 0
s_lshl_b32 s62, s6, 10
s_add_u32 s62, s62, 30441472
s_lshl_b32 s64, s10, 1
s_lshl_b32 s64, s64, 10
s_add_u32 s64, s64, 30441472
s_lshr_b32 s67, s5, 2
s_and_b32 s67, s67, 3
s_lshl_b32 s67, s67, 7
s_add_u32 s64, s64, s67
s_add_u32 s65, s64, 1024
v_lshl_add_u32 v252, v1, 7, s62
v_mov_b32 v253, s64
v_mov_b32 v255, 1
v_writelane_b32 v253, s65, 1
s_waitcnt vmcnt(0) lgkmcnt(0)
s_cmp_lg_u32 s3, 1
s_barrier
s_cbranch_scc1 .Lnopoll36
s_mov_b64 exec, 15
buffer_atomic_add v255, v252, s[16:19], 0 offen
s_mov_b64 exec, 3
v_mov_b32 v254, 0
buffer_atomic_add v254, v253, s[16:19], 0 offen sc0
s_sleep 5
s_mov_b32 s15, 0
.Lpoll35:
v_mov_b32 v255, 0
buffer_atomic_add v255, v253, s[16:19], 0 offen sc0
s_waitcnt vmcnt(1)
v_cmp_gt_u32 vcc, 16, v254
s_add_u32 s15, s15, 1
s_cbranch_vccz .Lnopoll36r
v_mov_b32 v254, 0
buffer_atomic_add v254, v253, s[16:19], 0 offen sc0
s_waitcnt vmcnt(1)
v_cmp_gt_u32 vcc, 16, v255
s_add_u32 s15, s15, 1
s_cbranch_vccz .Lnopoll36r
s_cmp_le_u32 s15, 100000
s_cbranch_scc1 .Lpoll35
s_branch .Lnopoll36r
.Lnopoll36:
s_mov_b64 exec, 0
s_cmp_eq_u32 s3, 2
s_cbranch_scc1 .Lpad6
s_cmp_eq_u32 s3, 3
s_cbranch_scc1 .Lpad7
s_branch .Lpad8
.Lnopoll36r:
s_mov_b64 exec, -1
s_barrier
buffer_load_dwordx4 a[128:131], v10, s[16:19], s52 offen sc1
buffer_load_dwordx4 a[132:135], v10, s[16:19], s52 offen offset:1024 sc1
buffer_load_dwordx4 a[136:139], v11, s[16:19], s52 offen sc1
buffer_load_dwordx4 a[140:143], v11, s[16:19], s52 offen offset:1024 sc1
s_add_u32 s52, s52, 16384
buffer_load_dwordx4 a[144:147], v10, s[16:19], s52 offen sc1
buffer_load_dwordx4 a[148:151], v10, s[16:19], s52 offen offset:1024 sc1
buffer_load_dwordx4 a[152:155], v11, s[16:19], s52 offen sc1
buffer_load_dwordx4 a[156:159], v11, s[16:19], s52 offen offset:1024 sc1
s_add_u32 s52, s52, 16384
ds_read_b64_tr_b16 a[0:1], v16
TR 2,16,512
TR 4,16,32
TR 6,16,544
TR 8,16,8448
TR 10,16,8960
TR 12,16,8480
TR 14,16,8992
TR 16,16,64
TR 18,16,576
TR 20,16,96
TR 22,16,608
TR 24,16,8512
TR 26,16,9024
TR 28,16,8544
TR 30,16,9056
TR 32,16,128
TR 34,16,640
TR 36,16,160
TR 38,16,672
TR 40,16,8576
TR 42,16,9088
TR 44,16,8608
TR 46,16,9120
ds_read_b64_tr_b16 a[48:49], v17
TR 50,17,512
TR 52,17,32
TR 54,17,544
TR 56,17,8448
TR 58,17,8960
TR 60,17,8480
TR 62,17,8992
ds_read_b128 a[192:195], v9
RD 196,9,1056
RD 200,9,2112
RD 204,9,3168
s_add_u32 m0, s55, 135168
s_nop 0
buffer_load_dwordx4 v12, s[32:35], s54 offen   lds
buffer_load_dwordx4 v13, s[32:35], s54 offen offset:1056   lds
buffer_load_dwordx4 v14, s[32:35], s54 offen offset:2112   lds
buffer_load_dwordx4 v15, s[32:35], s54 offen offset:3168   lds
s_add_u32 s54, s54, 229376
s_mul_i32 s66, s13, 114688
s_mul_i32 s65, s10, 1310720
s_add_u32 s66, s66, s65
s_add_u32 s66, s66, 12582912
s_add_u32 s65, s66, 49152
s_lshl_b32 s62, s12, 16
s_add_u32 s62, s62, s66
s_add_u32 s63, s62, 16384
s_add_u32 s64, s62, 32768
s_lshl_b32 s72, s10, 1
s_lshr_b32 s74, s11, 4
s_add_u32 s72, s72, s74
s_lshl_b32 s72, s72, 10
s_add_u32 s72, s72, 30457856
s_and_b32 s73, s6, 14
s_and_b32 s74, s7, 1
s_add_u32 s73, s73, s74
s_lshl_b32 s73, s73, 10
s_add_u32 s73, s73, 30457856
s_lshr_b32 s67, s5, 2
s_and_b32 s67, s67, 3
s_lshl_b32 s67, s67, 7
s_add_u32 s73, s73, s67
s_and_b32 s74, s7, 1
s_mul_i32 s53, s74, 917504
s_lshr_b32 s75, s6, 1
s_mul_i32 s75, s75, 1310720
s_add_u32 s53, s53, s75
s_add_u32 s53, s53, 12582912
s_and_b32 s74, s6, 3
s_xor_b32 s75, s74, 0
s_sub_u32 s75, s75, 0
s_mul_i32 s98, s75, 458752
s_mul_i32 s75, s75, 114688
s_add_u32 s76, s53, s75
s_xor_b32 s75, s74, 1
s_sub_u32 s75, s75, 1
s_mul_i32 s99, s75, 458752
s_mul_i32 s75, s75, 114688
s_add_u32 s77, s53, s75
s_xor_b32 s75, s74, 2
s_sub_u32 s75, s75, 2
s_mul_i32 s100, s75, 458752
s_mul_i32 s75, s75, 114688
s_add_u32 s78, s53, s75
s_xor_b32 s75, s74, 3
s_sub_u32 s75, s75, 3
s_mul_i32 s101, s75, 458752
s_mul_i32 s75, s75, 114688
s_add_u32 s79, s53, s75
s_and_b32 s53, s6, 3
s_mov_b32 s46, 0
s_lshl_b32 s74, s3, 13
s_add_u32 s74, s74, 49920
v_lshl_add_u32 v2, v1, 3, s74
s_waitcnt lgkmcnt(0)
.Lpad2:
s_cbranch_execz .Lpad5
s_barrier
s_waitcnt vmcnt(11)
v_mfma_f32_16x16x32_bf16 v[32:35], a[0:3], a[128:131], 0
buffer_load_dwordx4 a[160:163], v10, s[16:19], s52 offen sc1
s_waitcnt vmcnt(11)
v_mfma_f32_16x16x32_bf16 v[36:39], a[0:3], a[132:135], 0
TR 64,16,16896
v_mfma_f32_16x16x32_bf16 v[52:55], a[4:7], a[132:135], 0
TR 66,16,17408
v_mfma_f32_16x16x32_bf16 v[48:51], a[4:7], a[128:131], 0
TR 68,16,16928
v_mfma_f32_16x16x32_bf16 v[64:67], a[8:11], a[128:131], 0
buffer_load_dwordx4 a[164:167], v10, s[16:19], s52 offen offset:1024 sc1
v_mfma_f32_16x16x32_bf16 v[68:71], a[8:11], a[132:135], 0
TR 70,16,17440
v_mfma_f32_16x16x32_bf16 v[24:27], v[20:23], a[192:195], v[24:27]
TR 72,16,25344
v_mfma_f32_16x16x32_bf16 v[84:87], a[12:15], a[132:135], 0
TR 74,16,25856
v_mfma_f32_16x16x32_bf16 v[80:83], a[12:15], a[128:131], 0
buffer_load_dwordx4 a[168:171], v11, s[16:19], s52 offen sc1
v_mfma_f32_16x16x32_bf16 v[96:99], a[16:19], a[128:131], 0
TR 76,16,25376
v_mfma_f32_16x16x32_bf16 v[100:103], a[16:19], a[132:135], 0
TR 78,16,25888
v_mfma_f32_16x16x32_bf16 v[116:119], a[20:23], a[132:135], 0
TR 80,16,16960
v_mfma_f32_16x16x32_bf16 v[112:115], a[20:23], a[128:131], 0
buffer_load_dwordx4 a[172:175], v11, s[16:19], s52 offen offset:1024 sc1
v_mfma_f32_16x16x32_bf16 v[128:131], a[24:27], a[128:131], 0
TR 82,16,17472
s_add_u32 s52, s52, 16384
v_mfma_f32_16x16x32_bf16 v[132:135], a[24:27], a[132:135], 0
TR 84,16,16992
s_add_u32 m0, s55, 84480
v_mfma_f32_16x16x32_bf16 v[148:151], a[28:31], a[132:135], 0
TR 86,16,17504
v_mfma_f32_16x16x32_bf16 v[144:147], a[28:31], a[128:131], 0
buffer_load_dwordx4 v12, s[32:35], s54 offen   lds
v_mfma_f32_16x16x32_bf16 v[160:163], a[32:35], a[128:131], 0
TR 88,16,25408
v_mfma_f32_16x16x32_bf16 v[164:167], a[32:35], a[132:135], 0
TR 90,16,25920
v_mfma_f32_16x16x32_bf16 v[24:27], v[20:23], a[196:199], v[24:27]
TR 92,16,25440
v_mfma_f32_16x16x32_bf16 v[180:183], a[36:39], a[132:135], 0
buffer_load_dwordx4 a[176:179], v10, s[16:19], s52 offen sc1
v_mfma_f32_16x16x32_bf16 v[176:179], a[36:39], a[128:131], 0
TR 94,16,25952
v_mfma_f32_16x16x32_bf16 v[192:195], a[40:43], a[128:131], 0
TR 96,16,17024
v_mfma_f32_16x16x32_bf16 v[196:199], a[40:43], a[132:135], 0
TR 98,16,17536
v_mfma_f32_16x16x32_bf16 v[212:215], a[44:47], a[132:135], 0
buffer_load_dwordx4 v13, s[32:35], s54 offen offset:1056   lds
v_mfma_f32_16x16x32_bf16 v[208:211], a[44:47], a[128:131], 0
TR 100,16,17056
v_mfma_f32_16x16x32_bf16 v[224:227], a[48:51], a[128:131], 0
TR 102,16,17568
v_mfma_f32_16x16x32_bf16 v[228:231], a[48:51], a[132:135], 0
TR 104,16,25472
v_mfma_f32_16x16x32_bf16 v[236:239], a[52:55], a[132:135], 0
buffer_load_dwordx4 a[180:183], v10, s[16:19], s52 offen offset:1024 sc1
v_mfma_f32_16x16x32_bf16 v[232:235], a[52:55], a[128:131], 0
TR 106,16,25984
v_mfma_f32_16x16x32_bf16 v[240:243], a[56:59], a[128:131], 0
TR 108,16,25504
v_mfma_f32_16x16x32_bf16 v[244:247], a[56:59], a[132:135], 0
TR 110,16,26016
v_mfma_f32_16x16x32_bf16 v[24:27], v[20:23], a[200:203], v[24:27]
buffer_load_dwordx4 v14, s[32:35], s54 offen offset:2112   lds
v_mfma_f32_16x16x32_bf16 v[252:255], a[60:63], a[132:135], 0
TR 112,17,16896
v_mfma_f32_16x16x32_bf16 v[248:251], a[60:63], a[128:131], 0
TR 114,17,17408
s_waitcnt vmcnt(17)
v_mfma_f32_16x16x32_bf16 v[220:223], a[44:47], a[140:143], 0
TR 116,17,16928
v_mfma_f32_16x16x32_bf16 v[216:219], a[44:47], a[136:139], 0
buffer_load_dwordx4 a[184:187], v11, s[16:19], s52 offen sc1
v_mfma_f32_16x16x32_bf16 v[200:203], a[40:43], a[136:139], 0
TR 118,17,17440
v_mfma_f32_16x16x32_bf16 v[204:207], a[40:43], a[140:143], 0
TR 120,17,25344
v_mfma_f32_16x16x32_bf16 v[188:191], a[36:39], a[140:143], 0
TR 122,17,25856
v_mfma_f32_16x16x32_bf16 v[184:187], a[36:39], a[136:139], 0
buffer_load_dwordx4 v15, s[32:35], s54 offen offset:3168   lds
v_mfma_f32_16x16x32_bf16 v[168:171], a[32:35], a[136:139], 0
TR 124,17,25376
s_add_u32 s54, s54, 229376
v_mfma_f32_16x16x32_bf16 v[172:175], a[32:35], a[140:143], 0
TR 126,17,25888
v_mfma_f32_16x16x32_bf16 v[156:159], a[28:31], a[140:143], 0
RD 208,9,16896
v_mfma_f32_16x16x32_bf16 v[152:155], a[28:31], a[136:139], 0
buffer_load_dwordx4 a[188:191], v11, s[16:19], s52 offen offset:1024 sc1
v_mfma_f32_16x16x32_bf16 v[24:27], v[20:23], a[204:207], v[24:27]
RD 212,9,17952
s_add_u32 s52, s52, 16384
v_mfma_f32_16x16x32_bf16 v[136:139], a[24:27], a[136:139], 0
RD 216,9,19008
v_mfma_f32_16x16x32_bf16 v[140:143], a[24:27], a[140:143], 0
RD 220,9,20064
v_mfma_f32_16x16x32_bf16 v[124:127], a[20:23], a[140:143], 0
v_mfma_f32_16x16x32_bf16 v[120:123], a[20:23], a[136:139], 0
v_mfma_f32_16x16x32_bf16 v[104:107], a[16:19], a[136:139], 0
v_mfma_f32_16x16x32_bf16 v[108:111], a[16:19], a[140:143], 0
v_mfma_f32_16x16x32_bf16 v[92:95], a[12:15], a[140:143], 0
v_mfma_f32_16x16x32_bf16 v[88:91], a[12:15], a[136:139], 0
v_mfma_f32_16x16x32_bf16 v[72:75], a[8:11], a[136:139], 0
v_mfma_f32_16x16x32_bf16 v[76:79], a[8:11], a[140:143], 0
v_mfma_f32_16x16x32_bf16 v[60:63], a[4:7], a[140:143], 0
v_mfma_f32_16x16x32_bf16 v[56:59], a[4:7], a[136:139], 0
v_mfma_f32_16x16x32_bf16 v[40:43], a[0:3], a[136:139], 0
v_mfma_f32_16x16x32_bf16 v[44:47], a[0:3], a[140:143], 0
s_waitcnt lgkmcnt(0)
s_barrier
s_waitcnt vmcnt(19)
MAA 32,64,144
TR 0,16,33792
s_add_u32 m0, s74, 0
s_waitcnt vmcnt(18)
MAA 36,64,148
TR 2,16,34304
s_mov_b32 s67, 29622272
MAA 52,68,148
buffer_load_dwordx4 v4, s[16:19], s67 offen sc1 lds
MAA 48,68,144
TR 4,16,33824
MAA 64,72,144
TR 6,16,34336
MAA 68,72,148
TR 8,16,42240
v_mfma_f32_16x16x32_bf16 v[24:27], v[20:23], a[208:211], v[24:27]
buffer_load_dwordx4 v4, s[16:19], s67 offen offset:1024 sc1 lds
MAA 84,76,148
TR 10,16,42752
MAA 80,76,144
TR 12,16,42272
MAA 96,80,144
TR 14,16,42784
MAA 100,80,148
buffer_load_dwordx4 v4, s[16:19], s67 offen offset:2048 sc1 lds
MAA 116,84,148
TR 16,16,33856
MAA 112,84,144
TR 18,16,34368
MAA 128,88,144
TR 20,16,33888
MAA 132,88,148
buffer_load_dwordx4 v4, s[16:19], s67 offen offset:3072 sc1 lds
MAA 148,92,148
TR 22,16,34400
s_add_u32 m0, s55, 101376
MAA 144,92,144
TR 24,16,42304
MAA 160,96,144
TR 26,16,42816
MAA 164,96,148
buffer_load_dwordx4 v12, s[32:35], s54 offen   lds
v_mfma_f32_16x16x32_bf16 v[24:27], v[20:23], a[212:215], v[24:27]
TR 28,16,42336
MAA 180,100,148
TR 30,16,42848
MAA 176,100,144
TR 32,16,33920
MAA 192,104,144
buffer_load_dwordx4 a[128:131], v10, s[16:19], s52 offen sc1
MAA 196,104,148
TR 34,16,34432
MAA 212,108,148
TR 36,16,33952
MAA 208,108,144
TR 38,16,34464
MAA 224,112,144
buffer_load_dwordx4 v13, s[32:35], s54 offen offset:1056   lds
MAA 228,112,148
TR 40,16,42368
MAA 236,116,148
TR 42,16,42880
MAA 232,116,144
TR 44,16,42400
MAA 240,120,144
buffer_load_dwordx4 a[132:135], v10, s[16:19], s52 offen offset:1024 sc1
MAA 244,120,148
TR 46,16,42912
v_mfma_f32_16x16x32_bf16 v[24:27], v[20:23], a[216:219], v[24:27]
TR 48,17,33792
MAA 252,124,148
TR 50,17,34304
MAA 248,124,144
buffer_load_dwordx4 v14, s[32:35], s54 offen offset:2112   lds
s_waitcnt vmcnt(25)
MAA 220,108,156
TR 52,17,33824
MAA 216,108,152
TR 54,17,34336
MAA 200,104,152
TR 56,17,42240
MAA 204,104,156
buffer_load_dwordx4 a[136:139], v11, s[16:19], s52 offen sc1
MAA 188,100,156
TR 58,17,42752
MAA 184,100,152
TR 60,17,42272
MAA 168,96,152
TR 62,17,42784
MAA 172,96,156
buffer_load_dwordx4 v15, s[32:35], s54 offen offset:3168   lds
MAA 156,92,156
RD 192,9,33792
s_add_u32 s54, s54, 229376
MAA 152,92,152
RD 196,9,34848
v_mfma_f32_16x16x32_bf16 v[24:27], v[20:23], a[220:223], v[24:27]
RD 200,9,35904
MAA 136,88,152
buffer_load_dwordx4 a[140:143], v11, s[16:19], s52 offen offset:1024 sc1
MAA 140,88,156
RD 204,9,36960
s_add_u32 s52, s52, 16384
MAA 124,84,156
MAA 120,84,152
MAA 104,80,152
MAA 108,80,156
MAA 92,76,156
MAA 88,76,152
MAA 72,72,152
MAA 76,72,156
MAA 60,68,156
MAA 56,68,152
MAA 40,64,152
MAA 44,64,156
s_waitcnt vmcnt(24) lgkmcnt(0)
s_barrier
s_waitcnt vmcnt(23)
MAA 32,0,160
TR 64,16,50688
s_add_u32 m0, s74, 4096
s_waitcnt vmcnt(22)
MAA 36,0,164
TR 66,16,51200
s_mov_b32 s67, 29626368
MAA 52,4,164
buffer_load_dwordx4 v4, s[16:19], s67 offen sc1 lds
MAA 48,4,160
TR 68,16,50720
MAA 64,8,160
TR 70,16,51232
MAA 68,8,164
TR 72,16,59136
v_mfma_f32_16x16x32_bf16 v[24:27], v[20:23], a[192:195], v[24:27]
buffer_load_dwordx4 v4, s[16:19], s67 offen offset:1024 sc1 lds
MAA 84,12,164
TR 74,16,59648
MAA 80,12,160
TR 76,16,59168
MAA 96,16,160
TR 78,16,59680
MAA 100,16,164
buffer_load_dwordx4 v4, s[16:19], s67 offen offset:2048 sc1 lds
MAA 116,20,164
TR 80,16,50752
MAA 112,20,160
TR 82,16,51264
MAA 128,24,160
TR 84,16,50784
MAA 132,24,164
buffer_load_dwordx4 v4, s[16:19], s67 offen offset:3072 sc1 lds
MAA 148,28,164
TR 86,16,51296
s_add_u32 m0, s55, 118272
MAA 144,28,160
TR 88,16,59200
MAA 160,32,160
TR 90,16,59712
MAA 164,32,164
buffer_load_dwordx4 v12, s[32:35], s54 offen   lds
v_mfma_f32_16x16x32_bf16 v[24:27], v[20:23], a[196:199], v[24:27]
TR 92,16,59232
MAA 180,36,164
TR 94,16,59744
MAA 176,36,160
TR 96,16,50816
MAA 192,40,160
buffer_load_dwordx4 a[144:147], v10, s[16:19], s52 offen sc1
MAA 196,40,164
TR 98,16,51328
MAA 212,44,164
TR 100,16,50848
MAA 208,44,160
TR 102,16,51360
MAA 224,48,160
buffer_load_dwordx4 v13, s[32:35], s54 offen offset:1056   lds
MAA 228,48,164
TR 104,16,59264
MAA 236,52,164
TR 106,16,59776
MAA 232,52,160
TR 108,16,59296
MAA 240,56,160
buffer_load_dwordx4 a[148:151], v10, s[16:19], s52 offen offset:1024 sc1
MAA 244,56,164
TR 110,16,59808
v_mfma_f32_16x16x32_bf16 v[24:27], v[20:23], a[200:203], v[24:27]
TR 112,17,50688
MAA 252,60,164
TR 114,17,51200
MAA 248,60,160
buffer_load_dwordx4 v14, s[32:35], s54 offen offset:2112   lds
s_waitcnt vmcnt(29)
MAA 220,44,172
TR 116,17,50720
MAA 216,44,168
TR 118,17,51232
MAA 200,40,168
TR 120,17,59136
MAA 204,40,172
buffer_load_dwordx4 a[152:155], v11, s[16:19], s52 offen sc1
MAA 188,36,172
TR 122,17,59648
MAA 184,36,168
TR 124,17,59168
MAA 168,32,168
TR 126,17,59680
MAA 172,32,172
buffer_load_dwordx4 v15, s[32:35], s54 offen offset:3168   lds
MAA 156,28,172
RD 208,9,50688
s_add_u32 s54, s54, 229376
MAA 152,28,168
RD 212,9,51744
v_mfma_f32_16x16x32_bf16 v[24:27], v[20:23], a[204:207], v[24:27]
RD 216,9,52800
MAA 136,24,168
buffer_load_dwordx4 a[156:159], v11, s[16:19], s52 offen offset:1024 sc1
MAA 140,24,172
RD 220,9,53856
s_add_u32 s52, s52, 16384
MAA 124,20,172
MAA 120,20,168
MAA 104,16,168
MAA 108,16,172
MAA 92,12,172
MAA 88,12,168
MAA 72,8,168
MAA 76,8,172
MAA 60,4,172
MAA 56,4,168
MAA 40,0,168
MAA 44,0,172
s_waitcnt vmcnt(25) lgkmcnt(0)
s_barrier
MAA 32,64,176
s_waitcnt vmcnt(20)
ds_read_b64 v[28:29], v2
s_add_u32 m0, s55, 135168
MAA 36,64,180
buffer_load_dwordx4 v12, s[32:35], s54 offen   lds
MAA 52,68,180
ds_read_b64 v[30:31], v2 offset:512
MAA 48,68,176
ds_read_b64 v[18:19], v2 offset:1024
MAA 64,72,176
ds_read_b64_tr_b16 a[0:1], v16
MAA 68,72,180
TR 2,16,512
v_mfma_f32_16x16x32_bf16 v[24:27], v[20:23], a[208:211], v[24:27]
TR 4,16,32
MAA 84,76,180
TR 6,16,544
MAA 80,76,176
buffer_load_dwordx4 a[160:163], v10, s[16:19], s52 offen sc1
MAA 96,80,176
TR 8,16,8448
MAA 100,80,180
TR 10,16,8960
s_waitcnt lgkmcnt(7)
v_add_f32 v28, v28, v30
MAA 116,84,180
TR 12,16,8480
v_add_f32 v29, v29, v31
MAA 112,84,176
ds_read_b64 v[30:31], v2 offset:1536
s_waitcnt lgkmcnt(8)
v_add_f32 v28, v28, v18
MAA 128,88,176
TR 14,16,8992
v_add_f32 v29, v29, v19
MAA 132,88,180
ds_read_b64 v[18:19], v2 offset:2048
MAA 148,92,180
buffer_load_dwordx4 v13, s[32:35], s54 offen offset:1056   lds
MAA 144,92,176
TR 16,16,64
MAA 160,96,176
TR 18,16,576
MAA 164,96,180
TR 20,16,96
v_mfma_f32_16x16x32_bf16 v[24:27], v[20:23], a[212:215], v[24:27]
TR 22,16,608
MAA 180,100,180
TR 24,16,8512
s_waitcnt lgkmcnt(7)
v_add_f32 v28, v28, v30
MAA 176,100,176
TR 26,16,9024
v_add_f32 v29, v29, v31
MAA 192,104,176
buffer_load_dwordx4 a[164:167], v10, s[16:19], s52 offen offset:1024 sc1
MAA 196,104,180
ds_read_b64 v[30:31], v2 offset:2560
s_waitcnt lgkmcnt(7)
v_add_f32 v28, v28, v18
MAA 212,108,180
TR 28,16,8544
v_add_f32 v29, v29, v19
MAA 208,108,176
ds_read_b64 v[18:19], v2 offset:3072
MAA 224,112,176
TR 30,16,9056
MAA 228,112,180
TR 32,16,128
MAA 236,116,180
TR 34,16,640
MAA 232,116,176
buffer_load_dwordx4 v14, s[32:35], s54 offen offset:2112   lds
MAA 240,120,176
TR 36,16,160
MAA 244,120,180
TR 38,16,672
s_waitcnt lgkmcnt(7)
v_add_f32 v28, v28, v30
v_mfma_f32_16x16x32_bf16 v[24:27], v[20:23], a[216:219], v[24:27]
TR 40,16,8576
v_add_f32 v29, v29, v31
MAA 252,124,180
ds_read_b64 v[30:31], v2 offset:3584
s_waitcnt lgkmcnt(7)
v_add_f32 v28, v28, v18
MAA 248,124,176
TR 42,16,9088
v_add_f32 v29, v29, v19
MAA 220,108,188
s_waitcnt vmcnt(13)
ds_read_b64 v[18:19], v2 offset:4096
MAA 216,108,184
buffer_load_dwordx4 a[168:171], v11, s[16:19], s52 offen sc1
MAA 200,104,184
TR 44,16,8608
MAA 204,104,188
TR 46,16,9120
MAA 188,100,188
ds_read_b64_tr_b16 a[48:49], v17
MAA 184,100,184
TR 50,17,512
MAA 168,96,184
TR 52,17,32
MAA 172,96,188
TR 54,17,544
MAA 156,92,188
buffer_load_dwordx4 v15, s[32:35], s54 offen offset:3168   lds
MAA 152,92,184
TR 56,17,8448
s_add_u32 s54, s54, 229376
v_mfma_f32_16x16x32_bf16 v[24:27], v[20:23], a[220:223], v[24:27]
TR 58,17,8960
MAA 136,88,184
TR 60,17,8480
MAA 140,88,188
TR 62,17,8992
MAA 124,84,188
ds_read_b128 a[192:195], v9
MAA 120,84,184
RD 196,9,1056
MAA 104,80,184
buffer_load_dwordx4 a[172:175], v11, s[16:19], s52 offen offset:1024 sc1
MAA 108,80,188
RD 200,9,2112
s_add_u32 s52, s52, 16384
MAA 92,76,188
RD 204,9,3168
MAA 88,76,184
MAA 72,72,184
MAA 76,72,188
MAA 60,68,188
MAA 56,68,184
MAA 40,64,184
MAA 44,64,188
s_waitcnt lgkmcnt(0)
s_barrier
MAA 32,0,128
TR 64,16,16896
s_add_u32 m0, s55, 84480
MAA 36,0,132
buffer_load_dwordx4 v12, s[32:35], s54 offen   lds
MAA 52,4,132
TR 66,16,17408
v_add_f32 v28, v28, v30
MAA 48,4,128
TR 68,16,16928
v_add_f32 v29, v29, v31
MAA 64,8,128
ds_read_b64 v[30:31], v2 offset:4608
v_add_f32 v28, v28, v18
MAA 68,8,132
TR 70,16,17440
v_add_f32 v29, v29, v19
v_mfma_f32_16x16x32_bf16 v[24:27], v[20:23], a[192:195], v[24:27]
ds_read_b64 v[18:19], v2 offset:5120
MAA 84,12,132
TR 72,16,25344
MAA 80,12,128
buffer_load_dwordx4 a[176:179], v10, s[16:19], s52 offen sc1
MAA 96,16,128
TR 74,16,25856
MAA 100,16,132
TR 76,16,25376
MAA 116,20,132
TR 78,16,25888
MAA 112,20,128
TR 80,16,16960
s_waitcnt lgkmcnt(7)
v_add_f32 v28, v28, v30
MAA 128,24,128
TR 82,16,17472
v_add_f32 v29, v29, v31
MAA 132,24,132
ds_read_b64 v[30:31], v2 offset:5632
s_waitcnt lgkmcnt(7)
v_add_f32 v28, v28, v18
MAA 148,28,132
buffer_load_dwordx4 v13, s[32:35], s54 offen offset:1056   lds
MAA 144,28,128
TR 84,16,16992
.Lpad3:
s_cbranch_execz .Lnopoll33r
v_add_f32 v29, v29, v19
MAA 160,32,128
ds_read_b64 v[18:19], v2 offset:6144
MAA 164,32,132
TR 86,16,17504
v_mfma_f32_16x16x32_bf16 v[24:27], v[20:23], a[196:199], v[24:27]
TR 88,16,25408
MAA 180,36,132
TR 90,16,25920
MAA 176,36,128
TR 92,16,25440
MAA 192,40,128
buffer_load_dwordx4 a[180:183], v10, s[16:19], s52 offen offset:1024 sc1
MAA 196,40,132
TR 94,16,25952
s_waitcnt lgkmcnt(7)
v_add_f32 v28, v28, v30
MAA 212,44,132
TR 96,16,17024
v_add_f32 v29, v29, v31
MAA 208,44,128
ds_read_b64 v[30:31], v2 offset:6656
s_waitcnt lgkmcnt(7)
v_add_f32 v28, v28, v18
MAA 224,48,128
TR 98,16,17536
v_add_f32 v29, v29, v19
MAA 228,48,132
ds_read_b64 v[18:19], v2 offset:7168
MAA 236,52,132
TR 100,16,17056
MAA 232,52,128
buffer_load_dwordx4 v14, s[32:35], s54 offen offset:2112   lds
MAA 240,56,128
TR 102,16,17568
MAA 244,56,132
TR 104,16,25472
v_mfma_f32_16x16x32_bf16 v[24:27], v[20:23], a[200:203], v[24:27]
TR 106,16,25984
MAA 252,60,132
TR 108,16,25504
s_waitcnt lgkmcnt(7)
v_add_f32 v28, v28, v30
MAA 248,60,128
TR 110,16,26016
v_add_f32 v29, v29, v31
MAA 220,44,140
ds_read_b64 v[30:31], v2 offset:7680
s_waitcnt lgkmcnt(7)
v_add_f32 v28, v28, v18
MAA 216,44,136
buffer_load_dwordx4 a[184:187], v11, s[16:19], s52 offen sc1
MAA 200,40,136
TR 112,17,16896
v_add_f32 v29, v29, v19
MAA 204,40,140
TR 114,17,17408
MAA 188,36,140
TR 116,17,16928
MAA 184,36,136
TR 118,17,17440
MAA 168,32,136
TR 120,17,25344
MAA 172,32,140
TR 122,17,25856
MAA 156,28,140
buffer_load_dwordx4 v15, s[32:35], s54 offen offset:3168   lds
MAA 152,28,136
TR 124,17,25376
s_add_u32 s54, s54, 229376
v_mfma_f32_16x16x32_bf16 v[24:27], v[20:23], a[204:207], v[24:27]
TR 126,17,25888
s_waitcnt lgkmcnt(8)
v_add_f32 v28, v28, v30
MAA 136,24,136
RD 208,9,16896
v_add_f32 v29, v29, v31
MAA 140,24,140
RD 212,9,17952
MAA 124,20,140
RD 216,9,19008
MAA 120,20,136
RD 220,9,20064
MAA 104,16,136
buffer_load_dwordx4 a[188:191], v11, s[16:19], s52 offen offset:1024 sc1
MAA 108,16,140
s_add_u32 s52, s52, 16384
MAA 92,12,140
MAA 88,12,136
MAA 72,8,136
MAA 76,8,140
MAA 60,4,140
MAA 56,4,136
MAA 40,0,136
s_sub_u32 s47, s47, 1
s_cbranch_scc1 .Lx38
.Lx38b:
MAA 44,0,140
s_waitcnt vmcnt(17) lgkmcnt(0)
s_barrier
MAA 32,64,144
TR 0,16,33792
s_add_u32 m0, s55, 101376
MAA 36,64,148
buffer_load_dwordx4 v12, s[32:35], s54 offen   lds
MAA 52,68,148
TR 2,16,34304
v_mul_f32 v28, 0xba800000, v28
MAA 48,68,144
TR 4,16,33824
v_mul_f32 v29, 0x3a800000, v29
MAA 64,72,144
TR 6,16,34336
v_fma_f32 v29, -v28, v28, v29
MAA 68,72,148
TR 8,16,42240
v_max_f32 v29, 0, v29
v_mfma_f32_16x16x32_bf16 v[24:27], v[20:23], a[208:211], v[24:27]
TR 10,16,42752
v_add_f32 v29, 0x3727c5ac, v29
MAA 84,76,148
TR 12,16,42272
v_rsq_f32 v30, v29
MAA 80,76,144
buffer_load_dwordx4 a[128:131], v10, s[16:19], s52 offen sc1
MAA 96,80,144
TR 14,16,42784
v_lshlrev_b32 v18, 4, v0
MAA 100,80,148
TR 16,16,33856
v_add_u32 v18, 152576, v18
MAA 116,84,148
TR 18,16,34368
v_mul_f32 v30, 0xbfb8aa3b, v30
MAA 112,84,144
ds_write_b128 v18, v[28:31]
v_mov_b32 v18, v5
MAA 128,88,144
TR 20,16,33888
v_mov_b32 v19, v6
MAA 132,88,148
TR 22,16,34400
s_mov_b32 s58, s98
MAA 148,92,148
buffer_load_dwordx4 v13, s[32:35], s54 offen offset:1056   lds
MAA 144,92,144
TR 24,16,42304
s_mov_b32 s67, s59
MAA 160,96,144
TR 26,16,42816
MAA 164,96,148
TR 28,16,42336
v_mfma_f32_16x16x32_bf16 v[24:27], v[20:23], a[212:215], v[24:27]
TR 30,16,42848
MAA 180,100,148
TR 32,16,33920
MAA 176,100,144
TR 34,16,34432
MAA 192,104,144
buffer_load_dwordx4 a[132:135], v10, s[16:19], s52 offen offset:1024 sc1
MAA 196,104,148
TR 36,16,33952
MAA 212,108,148
TR 38,16,34464
MAA 208,108,144
TR 40,16,42368
MAA 224,112,144
TR 42,16,42880
MAA 228,112,148
TR 44,16,42400
MAA 236,116,148
TR 46,16,42912
MAA 232,116,144
buffer_load_dwordx4 v14, s[32:35], s54 offen offset:2112   lds
MAA 240,120,144
TR 48,17,33792
MAA 244,120,148
TR 50,17,34304
v_mfma_f32_16x16x32_bf16 v[24:27], v[20:23], a[216:219], v[24:27]
TR 52,17,33824
MAA 252,124,148
TR 54,17,34336
MAA 248,124,144
TR 56,17,42240
s_waitcnt vmcnt(21)
MAA 220,108,156
TR 58,17,42752
MAA 216,108,152
buffer_load_dwordx4 a[136:139], v11, s[16:19], s52 offen sc1
MAA 200,104,152
TR 60,17,42272
MAA 204,104,156
TR 62,17,42784
MAA 188,100,156
RD 192,9,33792
MAA 184,100,152
RD 196,9,34848
MAA 168,96,152
RD 200,9,35904
MAA 172,96,156
RD 204,9,36960
MAA 156,92,156
buffer_load_dwordx4 v15, s[32:35], s54 offen offset:3168   lds
MAA 152,92,152
s_add_u32 s54, s54, 229376
v_mfma_f32_16x16x32_bf16 v[24:27], v[20:23], a[220:223], v[24:27]
MAA 136,88,152
MAA 140,88,156
MAA 124,84,156
MAA 120,84,152
MAA 104,80,152
buffer_load_dwordx4 a[140:143], v11, s[16:19], s52 offen offset:1024 sc1
MAA 108,80,156
s_add_u32 s52, s52, 16384
MAA 92,76,156
MAA 88,76,152
MAA 72,72,152
MAA 76,72,156
MAA 60,68,156
MAA 56,68,152
MAA 40,64,152
s_sub_u32 s47, s47, 1
s_cbranch_scc1 .Lx39
.Lx39b:
MAA 44,64,156
s_waitcnt vmcnt(17) lgkmcnt(0)
s_barrier
MAA 32,0,160
TR 64,16,50688
s_add_u32 m0, s55, 118272
MAA 36,0,164
buffer_load_dwordx4 v12, s[32:35], s54 offen   lds
MAA 52,4,164
TR 66,16,51200
MAA 48,4,160
TR 68,16,50720
MAA 64,8,160
TR 70,16,51232
MAA 68,8,164
TR 72,16,59136
v_mfma_f32_16x16x32_bf16 v[24:27], v[20:23], a[192:195], v[24:27]
TR 74,16,59648
MAA 84,12,164
TR 76,16,59168
MAA 80,12,160
buffer_load_dwordx4 a[144:147], v10, s[16:19], s52 offen sc1
MAA 96,16,160
TR 78,16,59680
MAA 100,16,164
TR 80,16,50752
MAA 116,20,164
TR 82,16,51264
MAA 112,20,160
TR 84,16,50784
MAA 128,24,160
TR 86,16,51296
MAA 132,24,164
TR 88,16,59200
MAA 148,28,164
buffer_load_dwordx4 v13, s[32:35], s54 offen offset:1056   lds
MAA 144,28,160
TR 90,16,59712
MAA 160,32,160
TR 92,16,59232
MAA 164,32,164
TR 94,16,59744
v_mfma_f32_16x16x32_bf16 v[24:27], v[20:23], a[196:199], v[24:27]
TR 96,16,50816
MAA 180,36,164
TR 98,16,51328
MAA 176,36,160
TR 100,16,50848
MAA 192,40,160
buffer_load_dwordx4 a[148:151], v10, s[16:19], s52 offen offset:1024 sc1
MAA 196,40,164
TR 102,16,51360
MAA 212,44,164
TR 104,16,59264
MAA 208,44,160
TR 106,16,59776
MAA 224,48,160
TR 108,16,59296
MAA 228,48,164
TR 110,16,59808
MAA 236,52,164
TR 112,17,50688
MAA 232,52,160
buffer_load_dwordx4 v14, s[32:35], s54 offen offset:2112   lds
MAA 240,56,160
TR 114,17,51200
MAA 244,56,164
TR 116,17,50720
v_mfma_f32_16x16x32_bf16 v[24:27], v[20:23], a[200:203], v[24:27]
TR 118,17,51232
MAA 252,60,164
TR 120,17,59136
MAA 248,60,160
TR 122,17,59648
s_waitcnt vmcnt(21)
MAA 220,44,172
TR 124,17,59168
MAA 216,44,168
buffer_load_dwordx4 a[152:155], v11, s[16:19], s52 offen sc1
MAA 200,40,168
TR 126,17,59680
MAA 204,40,172
RD 208,9,50688
MAA 188,36,172
RD 212,9,51744
MAA 184,36,168
RD 216,9,52800
MAA 168,32,168
RD 220,9,53856
MAA 172,32,172
MAA 156,28,172
buffer_load_dwordx4 v15, s[32:35], s54 offen offset:3168   lds
MAA 152,28,168
s_add_u32 s54, s54, 229376
v_mfma_f32_16x16x32_bf16 v[24:27], v[20:23], a[204:207], v[24:27]
MAA 136,24,168
MAA 140,24,172
MAA 124,20,172
MAA 120,20,168
MAA 104,16,168
buffer_load_dwordx4 a[156:159], v11, s[16:19], s52 offen offset:1024 sc1
MAA 108,16,172
s_add_u32 s52, s52, 16384
MAA 92,12,172
MAA 88,12,168
MAA 72,8,168
MAA 76,8,172
MAA 60,4,172
MAA 56,4,168
MAA 40,0,168
s_sub_u32 s47, s47, 1
s_cbranch_scc1 .Lx40
.Lx40b:
MAA 44,0,172
s_waitcnt vmcnt(17) lgkmcnt(0)
s_barrier
MAA 32,64,176
ds_read_b64_tr_b16 a[0:1], v16
s_add_u32 m0, s55, 135168
MAA 36,64,180
buffer_load_dwordx4 v12, s[32:35], s54 offen   lds
MAA 52,68,180
TR 2,16,512
MAA 48,68,176
TR 4,16,32
MAA 64,72,176
TR 6,16,544
MAA 68,72,180
TR 8,16,8448
v_mfma_f32_16x16x32_bf16 v[24:27], v[20:23], a[208:211], v[24:27]
TR 10,16,8960
MAA 84,76,180
TR 12,16,8480
MAA 80,76,176
buffer_load_dwordx4 a[160:163], v10, s[16:19], s52 offen sc1
MAA 96,80,176
TR 14,16,8992
MAA 100,80,180
TR 16,16,64
MAA 116,84,180
TR 18,16,576
MAA 112,84,176
TR 20,16,96
MAA 128,88,176
TR 22,16,608
MAA 132,88,180
TR 24,16,8512
MAA 148,92,180
buffer_load_dwordx4 v13, s[32:35], s54 offen offset:1056   lds
MAA 144,92,176
TR 26,16,9024
MAA 160,96,176
TR 28,16,8544
MAA 164,96,180
TR 30,16,9056
v_mfma_f32_16x16x32_bf16 v[24:27], v[20:23], a[212:215], v[24:27]
TR 32,16,128
MAA 180,100,180
TR 34,16,640
MAA 176,100,176
TR 36,16,160
MAA 192,104,176
buffer_load_dwordx4 a[164:167], v10, s[16:19], s52 offen offset:1024 sc1
MAA 196,104,180
TR 38,16,672
MAA 212,108,180
TR 40,16,8576
MAA 208,108,176
TR 42,16,9088
MAA 224,112,176
TR 44,16,8608
MAA 228,112,180
TR 46,16,9120
MAA 236,116,180
ds_read_b64_tr_b16 a[48:49], v17
MAA 232,116,176
buffer_load_dwordx4 v14, s[32:35], s54 offen offset:2112   lds
MAA 240,120,176
TR 50,17,512
MAA 244,120,180
TR 52,17,32
v_mfma_f32_16x16x32_bf16 v[24:27], v[20:23], a[216:219], v[24:27]
TR 54,17,544
MAA 252,124,180
TR 56,17,8448
MAA 248,124,176
TR 58,17,8960
s_waitcnt vmcnt(21)
MAA 220,108,188
TR 60,17,8480
MAA 216,108,184
buffer_load_dwordx4 a[168:171], v11, s[16:19], s52 offen sc1
MAA 200,104,184
TR 62,17,8992
MAA 204,104,188
ds_read_b128 a[192:195], v9
MAA 188,100,188
RD 196,9,1056
MAA 184,100,184
RD 200,9,2112
MAA 168,96,184
RD 204,9,3168
MAA 172,96,188
MAA 156,92,188
buffer_load_dwordx4 v15, s[32:35], s54 offen offset:3168   lds
MAA 152,92,184
s_add_u32 s54, s54, 229376
v_mfma_f32_16x16x32_bf16 v[24:27], v[20:23], a[220:223], v[24:27]
MAA 136,88,184
MAA 140,88,188
MAA 124,84,188
MAA 120,84,184
MAA 104,80,184
buffer_load_dwordx4 a[172:175], v11, s[16:19], s52 offen offset:1024 sc1
MAA 108,80,188
s_add_u32 s52, s52, 16384
MAA 92,76,188
MAA 88,76,184
MAA 72,72,184
MAA 76,72,188
MAA 60,68,188
MAA 56,68,184
MAA 40,64,184
s_sub_u32 s47, s47, 1
s_cbranch_scc1 .Lx41
.Lx41b:
MAA 44,64,188
s_mov_b32 s15, -5
.p2align 6
.Lk42:
s_waitcnt vmcnt(17) lgkmcnt(0)
s_barrier
MAA 32,0,128
TR 64,16,16896
s_add_u32 m0, s55, 84480
MAA 36,0,132
buffer_load_dwordx4 v12, s[32:35], s54 offen   lds
MAA 52,4,132
s_sub_u32 s47, s47, 1
s_cbranch_scc1 .Lx43
.Lx43b:
MAA 48,4,128
TR 66,16,17408
MAA 64,8,128
TR 68,16,16928
MAA 68,8,132
TR 70,16,17440
v_mfma_f32_16x16x32_bf16 v[24:27], v[20:23], a[192:195], v[24:27]
MAA 84,12,132
buffer_load_dwordx4 a[176:179], v10, s[16:19], s52 offen sc1
MAA 80,12,128
TR 72,16,25344
MAA 96,16,128
TR 74,16,25856
MAA 100,16,132
TR 76,16,25376
MAA 116,20,132
TR 78,16,25888
MAA 112,20,128
MAA 128,24,128
buffer_load_dwordx4 v13, s[32:35], s54 offen offset:1056   lds
MAA 132,24,132
TR 80,16,16960
MAA 148,28,132
TR 82,16,17472
MAA 144,28,128
TR 84,16,16992
MAA 160,32,128
TR 86,16,17504
MAA 164,32,132
v_mfma_f32_16x16x32_bf16 v[24:27], v[20:23], a[196:199], v[24:27]
TR 88,16,25408
MAA 180,36,132
buffer_load_dwordx4 a[180:183], v10, s[16:19], s52 offen offset:1024 sc1
MAA 176,36,128
TR 90,16,25920
MAA 192,40,128
TR 92,16,25440
MAA 196,40,132
TR 94,16,25952
MAA 212,44,132
MAA 208,44,128
TR 96,16,17024
MAA 224,48,128
buffer_load_dwordx4 v14, s[32:35], s54 offen offset:2112   lds
MAA 228,48,132
TR 98,16,17536
MAA 236,52,132
TR 100,16,17056
MAA 232,52,128
TR 102,16,17568
MAA 240,56,128
MAA 244,56,132
TR 104,16,25472
v_mfma_f32_16x16x32_bf16 v[24:27], v[20:23], a[200:203], v[24:27]
TR 106,16,25984
MAA 252,60,132
buffer_load_dwordx4 a[184:187], v11, s[16:19], s52 offen sc1
MAA 248,60,128
TR 108,16,25504
s_waitcnt vmcnt(22)
MAA 220,44,140
TR 110,16,26016
MAA 216,44,136
MAA 200,40,136
TR 112,17,16896
MAA 204,40,140
TR 114,17,17408
MAA 188,36,140
buffer_load_dwordx4 v15, s[32:35], s54 offen offset:3168   lds
MAA 184,36,136
TR 116,17,16928
s_add_u32 s54, s54, 229376
MAA 168,32,136
.Lpad4:
s_cbranch_execz .Lnopoll33r
TR 118,17,17440
MAA 172,32,140
MAA 156,28,140
TR 120,17,25344
MAA 152,28,136
TR 122,17,25856
v_mfma_f32_16x16x32_bf16 v[24:27], v[20:23], a[204:207], v[24:27]
TR 124,17,25376
MAA 136,24,136
buffer_load_dwordx4 a[188:191], v11, s[16:19], s52 offen offset:1024 sc1
MAA 140,24,140
TR 126,17,25888
s_add_u32 s52, s52, 16384
MAA 124,20,140
MAA 120,20,136
RD 208,9,16896
MAA 104,16,136
RD 212,9,17952
MAA 108,16,140
RD 216,9,19008
s_mov_b32 m0, s67
MAA 92,12,140
buffer_load_dwordx4 v18, s[28:31], s58 offen lds
MAA 88,12,136
RD 220,9,20064
MAA 72,8,136
MAA 76,8,140
MAA 60,4,140
MAA 56,4,136
MAA 40,0,136
MAA 44,0,140
s_waitcnt vmcnt(18) lgkmcnt(0)
s_barrier
MAA 32,64,144
TR 0,16,33792
s_add_u32 m0, s55, 101376
MAA 36,64,148
buffer_load_dwordx4 v12, s[32:35], s54 offen   lds
MAA 52,68,148
s_sub_u32 s47, s47, 1
s_cbranch_scc1 .Lx44
.Lx44b:
MAA 48,68,144
TR 2,16,34304
MAA 64,72,144
TR 4,16,33824
MAA 68,72,148
TR 6,16,34336
v_mfma_f32_16x16x32_bf16 v[24:27], v[20:23], a[208:211], v[24:27]
TR 8,16,42240
MAA 84,76,148
buffer_load_dwordx4 a[128:131], v10, s[16:19], s52 offen sc1
MAA 80,76,144
MAA 96,80,144
TR 10,16,42752
MAA 100,80,148
TR 12,16,42272
MAA 116,84,148
TR 14,16,42784
MAA 112,84,144
TR 16,16,33856
MAA 128,88,144
buffer_load_dwordx4 v13, s[32:35], s54 offen offset:1056   lds
MAA 132,88,148
MAA 148,92,148
TR 18,16,34368
MAA 144,92,144
TR 20,16,33888
MAA 160,96,144
TR 22,16,34400
MAA 164,96,148
TR 24,16,42304
v_mfma_f32_16x16x32_bf16 v[24:27], v[20:23], a[212:215], v[24:27]
TR 26,16,42816
MAA 180,100,148
buffer_load_dwordx4 a[132:135], v10, s[16:19], s52 offen offset:1024 sc1
MAA 176,100,144
MAA 192,104,144
TR 28,16,42336
MAA 196,104,148
TR 30,16,42848
MAA 212,108,148
TR 32,16,33920
MAA 208,108,144
TR 34,16,34432
MAA 224,112,144
buffer_load_dwordx4 v14, s[32:35], s54 offen offset:2112   lds
MAA 228,112,148
MAA 236,116,148
TR 36,16,33952
MAA 232,116,144
TR 38,16,34464
MAA 240,120,144
TR 40,16,42368
MAA 244,120,148
TR 42,16,42880
v_mfma_f32_16x16x32_bf16 v[24:27], v[20:23], a[216:219], v[24:27]
TR 44,16,42400
MAA 252,124,148
buffer_load_dwordx4 a[136:139], v11, s[16:19], s52 offen sc1
MAA 248,124,144
s_waitcnt vmcnt(23)
MAA 220,108,156
TR 46,16,42912
MAA 216,108,152
TR 48,17,33792
MAA 200,104,152
TR 50,17,34304
MAA 204,104,156
TR 52,17,33824
MAA 188,100,156
buffer_load_dwordx4 v15, s[32:35], s54 offen offset:3168   lds
MAA 184,100,152
s_add_u32 s54, s54, 229376
MAA 168,96,152
TR 54,17,34336
MAA 172,96,156
TR 56,17,42240
MAA 156,92,156
TR 58,17,42752
MAA 152,92,152
TR 60,17,42272
v_mfma_f32_16x16x32_bf16 v[24:27], v[20:23], a[220:223], v[24:27]
TR 62,17,42784
MAA 136,88,152
buffer_load_dwordx4 a[140:143], v11, s[16:19], s52 offen offset:1024 sc1
MAA 140,88,156
s_add_u32 s52, s52, 16384
MAA 124,84,156
RD 192,9,33792
MAA 120,84,152
RD 196,9,34848
MAA 104,80,152
RD 200,9,35904
MAA 108,80,156
RD 204,9,36960
s_mov_b32 m0, s67
MAA 92,76,156
buffer_load_dwordx4 v19, s[28:31], s58 offen offset:1056 lds
MAA 88,76,152
s_add_u32 s67, s67, 8448
s_add_u32 s58, s58, 0x40000
MAA 72,72,152
MAA 76,72,156
MAA 60,68,156
MAA 56,68,152
MAA 40,64,152
MAA 44,64,156
s_waitcnt vmcnt(19) lgkmcnt(0)
s_barrier
MAA 32,0,160
TR 64,16,50688
s_add_u32 m0, s55, 118272
MAA 36,0,164
buffer_load_dwordx4 v12, s[32:35], s54 offen   lds
MAA 52,4,164
s_sub_u32 s47, s47, 1
s_cbranch_scc1 .Lx45
.Lx45b:
MAA 48,4,160
TR 66,16,51200
MAA 64,8,160
TR 68,16,50720
MAA 68,8,164
TR 70,16,51232
v_mfma_f32_16x16x32_bf16 v[24:27], v[20:23], a[192:195], v[24:27]
MAA 84,12,164
buffer_load_dwordx4 a[144:147], v10, s[16:19], s52 offen sc1
MAA 80,12,160
TR 72,16,59136
MAA 96,16,160
TR 74,16,59648
MAA 100,16,164
TR 76,16,59168
MAA 116,20,164
TR 78,16,59680
MAA 112,20,160
MAA 128,24,160
buffer_load_dwordx4 v13, s[32:35], s54 offen offset:1056   lds
MAA 132,24,164
TR 80,16,50752
MAA 148,28,164
TR 82,16,51264
MAA 144,28,160
TR 84,16,50784
MAA 160,32,160
TR 86,16,51296
MAA 164,32,164
v_mfma_f32_16x16x32_bf16 v[24:27], v[20:23], a[196:199], v[24:27]
TR 88,16,59200
MAA 180,36,164
buffer_load_dwordx4 a[148:151], v10, s[16:19], s52 offen offset:1024 sc1
MAA 176,36,160
TR 90,16,59712
MAA 192,40,160
TR 92,16,59232
MAA 196,40,164
TR 94,16,59744
MAA 212,44,164
MAA 208,44,160
TR 96,16,50816
MAA 224,48,160
buffer_load_dwordx4 v14, s[32:35], s54 offen offset:2112   lds
MAA 228,48,164
TR 98,16,51328
MAA 236,52,164
TR 100,16,50848
MAA 232,52,160
TR 102,16,51360
MAA 240,56,160
MAA 244,56,164
TR 104,16,59264
v_mfma_f32_16x16x32_bf16 v[24:27], v[20:23], a[200:203], v[24:27]
TR 106,16,59776
MAA 252,60,164
buffer_load_dwordx4 a[152:155], v11, s[16:19], s52 offen sc1
MAA 248,60,160
TR 108,16,59296
s_waitcnt vmcnt(24)
MAA 220,44,172
TR 110,16,59808
MAA 216,44,168
MAA 200,40,168
TR 112,17,50688
MAA 204,40,172
TR 114,17,51200
MAA 188,36,172
buffer_load_dwordx4 v15, s[32:35], s54 offen offset:3168   lds
MAA 184,36,168
TR 116,17,50720
s_add_u32 s54, s54, 229376
MAA 168,32,168
TR 118,17,51232
MAA 172,32,172
MAA 156,28,172
TR 120,17,59136
MAA 152,28,168
TR 122,17,59648
v_mfma_f32_16x16x32_bf16 v[24:27], v[20:23], a[204:207], v[24:27]
TR 124,17,59168
MAA 136,24,168
buffer_load_dwordx4 a[156:159], v11, s[16:19], s52 offen offset:1024 sc1
MAA 140,24,172
TR 126,17,59680
s_add_u32 s52, s52, 16384
MAA 124,20,172
MAA 120,20,168
RD 208,9,50688
MAA 104,16,168
RD 212,9,51744
MAA 108,16,172
RD 216,9,52800
s_mov_b32 m0, s67
MAA 92,12,172
buffer_load_dwordx4 v18, s[28:31], s58 offen lds
MAA 88,12,168
RD 220,9,53856
MAA 72,8,168
MAA 76,8,172
MAA 60,4,172
MAA 56,4,168
MAA 40,0,168
MAA 44,0,172
s_waitcnt vmcnt(20) lgkmcnt(0)
s_barrier
MAA 32,64,176
ds_read_b64_tr_b16 a[0:1], v16
s_add_u32 m0, s55, 135168
MAA 36,64,180
buffer_load_dwordx4 v12, s[32:35], s54 offen   lds
MAA 52,68,180
s_sub_u32 s47, s47, 1
s_cbranch_scc1 .Lx46
.Lx46b:
MAA 48,68,176
TR 2,16,512
MAA 64,72,176
TR 4,16,32
MAA 68,72,180
TR 6,16,544
v_mfma_f32_16x16x32_bf16 v[24:27], v[20:23], a[208:211], v[24:27]
TR 8,16,8448
MAA 84,76,180
buffer_load_dwordx4 a[160:163], v10, s[16:19], s52 offen sc1
MAA 80,76,176
MAA 96,80,176
TR 10,16,8960
MAA 100,80,180
TR 12,16,8480
MAA 116,84,180
TR 14,16,8992
MAA 112,84,176
TR 16,16,64
MAA 128,88,176
buffer_load_dwordx4 v13, s[32:35], s54 offen offset:1056   lds
MAA 132,88,180
MAA 148,92,180
TR 18,16,576
MAA 144,92,176
TR 20,16,96
MAA 160,96,176
TR 22,16,608
MAA 164,96,180
TR 24,16,8512
v_mfma_f32_16x16x32_bf16 v[24:27], v[20:23], a[212:215], v[24:27]
TR 26,16,9024
MAA 180,100,180
buffer_load_dwordx4 a[164:167], v10, s[16:19], s52 offen offset:1024 sc1
MAA 176,100,176
MAA 192,104,176
TR 28,16,8544
MAA 196,104,180
TR 30,16,9056
MAA 212,108,180
TR 32,16,128
MAA 208,108,176
TR 34,16,640
MAA 224,112,176
buffer_load_dwordx4 v14, s[32:35], s54 offen offset:2112   lds
MAA 228,112,180
MAA 236,116,180
TR 36,16,160
MAA 232,116,176
TR 38,16,672
MAA 240,120,176
TR 40,16,8576
MAA 244,120,180
TR 42,16,9088
v_mfma_f32_16x16x32_bf16 v[24:27], v[20:23], a[216:219], v[24:27]
TR 44,16,8608
MAA 252,124,180
buffer_load_dwordx4 a[168:171], v11, s[16:19], s52 offen sc1
MAA 248,124,176
s_waitcnt vmcnt(25)
MAA 220,108,188
TR 46,16,9120
MAA 216,108,184
ds_read_b64_tr_b16 a[48:49], v17
MAA 200,104,184
TR 50,17,512
MAA 204,104,188
TR 52,17,32
MAA 188,100,188
buffer_load_dwordx4 v15, s[32:35], s54 offen offset:3168   lds
MAA 184,100,184
s_add_u32 s54, s54, 229376
MAA 168,96,184
TR 54,17,544
MAA 172,96,188
TR 56,17,8448
MAA 156,92,188
TR 58,17,8960
MAA 152,92,184
TR 60,17,8480
v_mfma_f32_16x16x32_bf16 v[24:27], v[20:23], a[220:223], v[24:27]
TR 62,17,8992
MAA 136,88,184
buffer_load_dwordx4 a[172:175], v11, s[16:19], s52 offen offset:1024 sc1
MAA 140,88,188
s_add_u32 s52, s52, 16384
MAA 124,84,188
ds_read_b128 a[192:195], v9
MAA 120,84,184
RD 196,9,1056
MAA 104,80,184
RD 200,9,2112
MAA 108,80,188
RD 204,9,3168
s_mov_b32 m0, s67
MAA 92,76,188
buffer_load_dwordx4 v19, s[28:31], s58 offen offset:1056 lds
MAA 88,76,184
s_add_u32 s67, s67, 8448
s_add_u32 s46, s46, 1
s_xor_b32 s58, s46, s53
s_mul_i32 s58, s58, 458752
MAA 72,72,184
MAA 76,72,188
MAA 60,68,188
MAA 56,68,184
MAA 40,64,184
s_add_u32 s15, s15, 1
MAA 44,64,188
s_cbranch_scc0 .Lk42
s_branch .Lj47
.Lx38:
buffer_load_dword v4, v8, s[32:35], s45 offen
buffer_load_dword v4, v7, s[28:31], s44 offen
s_add_u32 s44, s44, 655360
s_add_u32 s45, s45, 917504
s_mov_b32 s47, 3
s_branch .Lx38b
.Lx39:
buffer_load_dword v4, v8, s[32:35], s45 offen
buffer_load_dword v4, v7, s[28:31], s44 offen
s_add_u32 s44, s44, 655360
s_add_u32 s45, s45, 917504
s_mov_b32 s47, 3
s_branch .Lx39b
.Lx40:
buffer_load_dword v4, v8, s[32:35], s45 offen
buffer_load_dword v4, v7, s[28:31], s44 offen
s_add_u32 s44, s44, 655360
s_add_u32 s45, s45, 917504
s_mov_b32 s47, 3
s_branch .Lx40b
.Lx41:
buffer_load_dword v4, v8, s[32:35], s45 offen
buffer_load_dword v4, v7, s[28:31], s44 offen
s_add_u32 s44, s44, 655360
s_add_u32 s45, s45, 917504
s_mov_b32 s47, 3
s_branch .Lx41b
.Lx43:
buffer_load_dword v4, v8, s[32:35], s45 offen
buffer_load_dword v4, v7, s[28:31], s44 offen
s_add_u32 s44, s44, 655360
s_add_u32 s45, s45, 917504
s_mov_b32 s47, 3
s_branch .Lx43b
.Lx44:
buffer_load_dword v4, v8, s[32:35], s45 offen
buffer_load_dword v4, v7, s[28:31], s44 offen
s_add_u32 s44, s44, 655360
s_add_u32 s45, s45, 917504
s_mov_b32 s47, 3
s_branch .Lx44b
.Lx45:
buffer_load_dword v4, v8, s[32:35], s45 offen
buffer_load_dword v4, v7, s[28:31], s44 offen
s_add_u32 s44, s44, 655360
s_add_u32 s45, s45, 917504
s_mov_b32 s47, 3
s_branch .Lx45b
.Lx46:
buffer_load_dword v4, v8, s[32:35], s45 offen
buffer_load_dword v4, v7, s[28:31], s44 offen
s_add_u32 s44, s44, 655360
s_add_u32 s45, s45, 917504
s_mov_b32 s47, 3
s_branch .Lx46b
.Lj47:
s_waitcnt vmcnt(11) lgkmcnt(0)
s_barrier
v_mfma_f32_16x16x32_bf16 v[24:27], v[20:23], a[192:195], v[24:27]
buffer_load_dwordx4 a[176:179], v10, s[16:19], s52 offen sc1
v_mfma_f32_16x16x32_bf16 v[24:27], v[20:23], a[196:199], v[24:27]
TR 64,16,16896
s_lshl_b32 s74, s48, 10
v_mfma_f32_16x16x32_bf16 v[24:27], v[20:23], a[200:203], v[24:27]
TR 66,16,17408
s_lshl_b32 s75, s49, 9
v_mfma_f32_16x16x32_bf16 v[24:27], v[20:23], a[204:207], v[24:27]
TR 68,16,16928
s_add_u32 s74, s74, s75
MAA 32,0,128
buffer_load_dwordx4 a[180:183], v10, s[16:19], s52 offen offset:1024 sc1
MAA 48,4,128
TR 70,16,17440
s_add_u32 s74, s74, 159488
MAA 64,8,128
TR 72,16,25344
v_bfe_u32 v2, v1, 4, 1
MAA 80,12,128
TR 74,16,25856
s_lshl_b32 s75, s12, 9
MAA 36,0,132
buffer_load_dwordx4 a[184:187], v11, s[16:19], s52 offen sc1
MAA 52,4,132
TR 76,16,25376
s_add_u32 s58, s99, 2293760
MAA 68,8,132
TR 78,16,25888
s_add_u32 s54, s98, 65536
MAA 84,12,132
TR 80,16,33792
s_mul_i32 s55, s3, 2112
MAA 40,0,136
buffer_load_dwordx4 a[188:191], v11, s[16:19], s52 offen offset:1024 sc1
MAA 56,4,136
TR 82,16,34304
s_add_u32 s52, s52, 16384
MAA 72,8,136
TR 84,16,33824
s_mov_b32 s57, 67584
MAA 88,12,136
TR 86,16,34336
MAA 44,0,140
TR 88,16,42240
MAA 60,4,140
TR 90,16,42752
MAA 76,8,140
TR 92,16,42272
MAA 92,12,140
TR 94,16,42784
MAA 96,16,128
TR 112,16,16960
MAA 112,20,128
TR 114,16,17472
MAA 128,24,128
TR 116,16,16992
MAA 144,28,128
TR 118,16,17504
MAA 100,16,132
TR 120,16,25408
MAA 116,20,132
TR 122,16,25920
MAA 132,24,132
TR 124,16,25440
MAA 148,28,132
TR 126,16,25952
MAA 104,16,136
RD 208,9,16896
MAA 120,20,136
RD 212,9,17952
MAA 136,24,136
RD 216,9,19008
MAA 152,28,136
RD 220,9,20064
MAA 108,16,140
RD 192,9,33792
MAA 124,20,140
RD 196,9,34848
MAA 140,24,140
RD 200,9,35904
MAA 156,28,140
RD 204,9,36960
MAA 160,32,128
TR 0,16,17024
s_waitcnt lgkmcnt(8)
v_mfma_f32_16x16x32_bf16 v[24:27], v[20:23], a[208:211], v[24:27]
TR 2,16,17536
s_waitcnt vmcnt(6)
s_barrier
s_waitcnt lgkmcnt(8)
v_mfma_f32_16x16x32_bf16 v[24:27], v[20:23], a[212:215], v[24:27]
TR 96,16,50688
s_waitcnt lgkmcnt(8)
v_mfma_f32_16x16x32_bf16 v[24:27], v[20:23], a[216:219], v[24:27]
TR 98,16,51200
s_waitcnt lgkmcnt(8)
v_mfma_f32_16x16x32_bf16 v[24:27], v[20:23], a[220:223], v[24:27]
TR 100,16,50720
s_waitcnt lgkmcnt(8)
v_mfma_f32_16x16x32_bf16 v[24:27], v[20:23], a[192:195], v[24:27]
TR 102,16,51232
s_waitcnt lgkmcnt(8)
v_mfma_f32_16x16x32_bf16 v[24:27], v[20:23], a[196:199], v[24:27]
TR 104,16,59136
s_waitcnt lgkmcnt(8)
v_mfma_f32_16x16x32_bf16 v[24:27], v[20:23], a[200:203], v[24:27]
.Lpad5:
s_cbranch_execz .Lnopoll33r
TR 106,16,59648
s_waitcnt lgkmcnt(8)
v_mfma_f32_16x16x32_bf16 v[24:27], v[20:23], a[204:207], v[24:27]
TR 108,16,59168
MAA 176,36,128
TR 110,16,59680
MAA 192,40,128
RD 208,9,50688
MAA 208,44,128
RD 212,9,51744
MAA 164,32,132
RD 216,9,52800
MAA 180,36,132
RD 220,9,53856
v_and_b32 v9, 15, v1
MAA 196,40,132
TR 192,16,33856
v_lshl_add_u32 v9, v9, 5, s74
MAA 212,44,132
TR 194,16,34368
v_lshl_add_u32 v9, v2, 4, v9
MAA 168,32,136
TR 196,16,33888
v_bfe_u32 v2, v1, 5, 1
MAA 184,36,136
TR 198,16,34400
v_mul_u32_u24 v2, 2816, v2
MAA 200,40,136
TR 200,16,42304
v_sub_u32 v9, v9, v2
s_waitcnt lgkmcnt(8)
v_mfma_f32_16x16x32_bf16 v[24:27], v[20:23], a[208:211], v[24:27]
TR 202,16,42816
s_lshl_b32 s74, s3, 10
s_waitcnt lgkmcnt(8)
v_mfma_f32_16x16x32_bf16 v[24:27], v[20:23], a[212:215], v[24:27]
TR 204,16,42336
s_add_u32 s74, s74, s75
s_waitcnt lgkmcnt(8)
v_mfma_f32_16x16x32_bf16 v[24:27], v[20:23], a[216:219], v[24:27]
TR 206,16,42848
s_add_u32 s74, s74, 152576
s_waitcnt lgkmcnt(8)
v_mfma_f32_16x16x32_bf16 v[24:27], v[20:23], a[220:223], v[24:27]
TR 208,16,50752
v_and_b32 v2, 15, v1
MAA 216,44,136
TR 210,16,51264
v_lshl_add_u32 v2, v2, 4, s74
MAA 172,32,140
s_nop 1
ds_write_b128 v9, v[24:27]
v_lshlrev_b32 v9, 4, v1
MAA 188,36,140
ds_read_b32 v28, v2 offset:8
v_add_u32 v9, 159488, v9
MAA 204,40,140
ds_read_b32 v29, v2 offset:264
v_xor_b32 v8, 512, v2
MAA 220,44,140
ds_read_b32 v30, v8 offset:8
s_lshl_b32 s74, s12, 7
MAA 224,48,128
ds_read_b32 v31, v8 offset:264
s_add_u32 s74, s74, 161536
MAA 232,52,128
TR 212,16,50784
s_xor_b32 s75, s12, 1
MAA 240,56,128
TR 214,16,51296
s_mul_i32 s75, s75, 384
MAA 248,60,128
TR 216,16,59200
s_add_u32 s75, s75, 161536
MAA 228,48,132
s_waitcnt lgkmcnt(7)
s_barrier
ds_read_b128 v[20:23], v9
MAA 236,52,132
ds_read_b128 v[24:27], v9 offset:1024
MAA 244,56,132
TR 218,16,59712
MAA 252,60,132
TR 220,16,59232
MAA 32,64,144
TR 222,16,59744
MAA 48,68,144
TR 4,16,17056
MAA 64,72,144
TR 6,16,17568
MAA 80,76,144
TR 8,16,25472
MAA 32,80,160
TR 10,16,25984
MAA 48,84,160
TR 12,16,25504
s_waitcnt lgkmcnt(8)
v_add_f32 v20, v20, v24
MAA 64,88,160
TR 14,16,26016
v_add_f32 v21, v21, v25
MAA 80,92,160
ds_read_b64 v[24:25], v8
v_add_f32 v22, v22, v26
s_waitcnt vmcnt(3)
MAA 32,96,176
TR 16,16,33920
v_add_f32 v23, v23, v27
MAA 48,100,176
ds_write_b128 v9, v[20:23] offset:2048
v_lshrrev_b32 v9, 4, v1
MAA 64,104,176
ds_read_b64 v[20:21], v2
v_lshlrev_b32 v9, 4, v9
MAA 80,108,176
ds_read_b64 v[22:23], v2 offset:256
ds_read_b64 v[26:27], v8 offset:256
v_add_u32 v8, s75, v9
v_add_u32 v9, s74, v9
ds_read_b128 v[12:15], v9
ds_read_b128 v[4:7], v9 offset:64
s_lshl_b32 s74, s3, 11
s_add_u32 s74, s74, s84
v_lshrrev_b32 v2, 3, v1
v_cmp_eq_u32 vcc, 3, v2
TR 18,16,34432
TR 20,16,33952
TR 22,16,34464
TR 24,16,42368
TR 26,16,42880
TR 28,16,42400
TR 30,16,42912
TR 32,16,50816
TR 34,16,51328
TR 36,16,50848
TR 38,16,51360
TR 40,16,59264
s_waitcnt lgkmcnt(13)
v_pk_fma_f32 v[32:33], v[12:13], v[20:21], v[32:33] op_sel_hi:[1,0,1]
v_pk_fma_f32 v[34:35], v[14:15], v[20:21], v[34:35] op_sel_hi:[1,0,1]
v_pk_fma_f32 v[36:37], v[12:13], v[22:23], v[36:37] op_sel_hi:[1,0,1]
v_pk_fma_f32 v[38:39], v[14:15], v[22:23], v[38:39] op_sel_hi:[1,0,1]
v_pk_fma_f32 v[40:41], v[12:13], v[24:25], v[40:41] op_sel_hi:[1,0,1]
v_pk_fma_f32 v[42:43], v[14:15], v[24:25], v[42:43] op_sel_hi:[1,0,1]
v_pk_fma_f32 v[44:45], v[12:13], v[26:27], v[44:45] op_sel_hi:[1,0,1]
v_pk_fma_f32 v[46:47], v[14:15], v[26:27], v[46:47] op_sel_hi:[1,0,1]
ds_read_b128 v[12:15], v9 offset:512
s_waitcnt lgkmcnt(13)
v_pk_fma_f32 v[48:49], v[4:5], v[20:21], v[48:49] op_sel_hi:[1,0,1]
v_pk_fma_f32 v[50:51], v[6:7], v[20:21], v[50:51] op_sel_hi:[1,0,1]
v_pk_fma_f32 v[52:53], v[4:5], v[22:23], v[52:53] op_sel_hi:[1,0,1]
v_pk_fma_f32 v[54:55], v[6:7], v[22:23], v[54:55] op_sel_hi:[1,0,1]
v_pk_fma_f32 v[56:57], v[4:5], v[24:25], v[56:57] op_sel_hi:[1,0,1]
v_pk_fma_f32 v[58:59], v[6:7], v[24:25], v[58:59] op_sel_hi:[1,0,1]
v_pk_fma_f32 v[60:61], v[4:5], v[26:27], v[60:61] op_sel_hi:[1,0,1]
v_pk_fma_f32 v[62:63], v[6:7], v[26:27], v[62:63] op_sel_hi:[1,0,1]
ds_read_b128 v[4:7], v9 offset:576
TR 42,16,59776
TR 44,16,59296
TR 46,16,59808
TR 48,17,16896
TR 50,17,17408
TR 52,17,16928
TR 54,17,17440
TR 56,17,25344
TR 58,17,25856
TR 60,17,25376
s_waitcnt lgkmcnt(11)
v_pk_fma_f32 v[64:65], v[12:13], v[20:21], v[64:65] op_sel_hi:[1,0,1]
v_pk_fma_f32 v[66:67], v[14:15], v[20:21], v[66:67] op_sel_hi:[1,0,1]
v_pk_fma_f32 v[68:69], v[12:13], v[22:23], v[68:69] op_sel_hi:[1,0,1]
v_pk_fma_f32 v[70:71], v[14:15], v[22:23], v[70:71] op_sel_hi:[1,0,1]
v_pk_fma_f32 v[72:73], v[12:13], v[24:25], v[72:73] op_sel_hi:[1,0,1]
v_pk_fma_f32 v[74:75], v[14:15], v[24:25], v[74:75] op_sel_hi:[1,0,1]
v_pk_fma_f32 v[76:77], v[12:13], v[26:27], v[76:77] op_sel_hi:[1,0,1]
v_pk_fma_f32 v[78:79], v[14:15], v[26:27], v[78:79] op_sel_hi:[1,0,1]
ds_read_b128 v[12:15], v9 offset:832
s_waitcnt lgkmcnt(11)
v_pk_fma_f32 v[80:81], v[4:5], v[20:21], v[80:81] op_sel_hi:[1,0,1]
v_pk_fma_f32 v[82:83], v[6:7], v[20:21], v[82:83] op_sel_hi:[1,0,1]
v_pk_fma_f32 v[84:85], v[4:5], v[22:23], v[84:85] op_sel_hi:[1,0,1]
v_pk_fma_f32 v[86:87], v[6:7], v[22:23], v[86:87] op_sel_hi:[1,0,1]
v_pk_fma_f32 v[88:89], v[4:5], v[24:25], v[88:89] op_sel_hi:[1,0,1]
v_pk_fma_f32 v[90:91], v[6:7], v[24:25], v[90:91] op_sel_hi:[1,0,1]
v_pk_fma_f32 v[92:93], v[4:5], v[26:27], v[92:93] op_sel_hi:[1,0,1]
v_pk_fma_f32 v[94:95], v[6:7], v[26:27], v[94:95] op_sel_hi:[1,0,1]
ds_read_b128 v[4:7], v9 offset:704
v_pk_mul_f32 v[64:65], v[64:65], v[32:33]
v_pk_mul_f32 v[32:33], v[32:33], v[28:29] op_sel_hi:[1,0]
v_pk_mul_f32 v[66:67], v[66:67], v[34:35]
v_pk_mul_f32 v[34:35], v[34:35], v[28:29] op_sel_hi:[1,0]
v_pk_mul_f32 v[80:81], v[80:81], v[48:49]
v_pk_mul_f32 v[48:49], v[48:49], v[28:29] op_sel_hi:[1,0]
v_pk_mul_f32 v[82:83], v[82:83], v[50:51]
v_pk_mul_f32 v[50:51], v[50:51], v[28:29] op_sel_hi:[1,0]
v_exp_f32 v32, v32
s_nop 0
MAA 36,64,148
TR 62,17,25888
v_exp_f32 v33, v33
MAA 52,68,148
v_exp_f32 v34, v34
MAA 68,72,148
v_exp_f32 v35, v35
MAA 84,76,148
v_exp_f32 v48, v48
MAA 36,80,164
v_exp_f32 v49, v49
MAA 52,84,164
v_exp_f32 v50, v50
MAA 68,88,164
v_exp_f32 v51, v51
MAA 84,92,164
s_waitcnt vmcnt(2)
MAA 36,96,180
MAA 52,100,180
MAA 68,104,180
MAA 84,108,180
s_nop 6
v_pk_mul_f32 v[68:69], v[68:69], v[36:37]
v_pk_mul_f32 v[36:37], v[36:37], v[28:29] op_sel:[0,1] op_sel_hi:[1,1]
v_pk_mul_f32 v[70:71], v[70:71], v[38:39]
v_pk_mul_f32 v[38:39], v[38:39], v[28:29] op_sel:[0,1] op_sel_hi:[1,1]
v_pk_mul_f32 v[84:85], v[84:85], v[52:53]
v_pk_mul_f32 v[52:53], v[52:53], v[28:29] op_sel:[0,1] op_sel_hi:[1,1]
v_pk_mul_f32 v[86:87], v[86:87], v[54:55]
v_pk_mul_f32 v[54:55], v[54:55], v[28:29] op_sel:[0,1] op_sel_hi:[1,1]
v_pk_fma_f32 v[32:33], v[32:33], v[20:21], v[20:21] op_sel:[0,1,1] op_sel_hi:[1,1,1]
v_pk_fma_f32 v[34:35], v[34:35], v[20:21], v[20:21] op_sel:[0,1,1] op_sel_hi:[1,1,1]
v_pk_fma_f32 v[48:49], v[48:49], v[20:21], v[20:21] op_sel:[0,1,1] op_sel_hi:[1,1,1]
v_pk_fma_f32 v[50:51], v[50:51], v[20:21], v[20:21] op_sel:[0,1,1] op_sel_hi:[1,1,1]
v_rcp_f32 v32, v32
s_nop 0
MAA 40,64,152
v_rcp_f32 v33, v33
MAA 56,68,152
v_rcp_f32 v34, v34
MAA 72,72,152
v_rcp_f32 v35, v35
MAA 88,76,152
v_rcp_f32 v48, v48
MAA 40,80,168
v_rcp_f32 v49, v49
MAA 56,84,168
v_rcp_f32 v50, v50
MAA 72,88,168
v_rcp_f32 v51, v51
MAA 88,92,168
v_exp_f32 v36, v36
s_waitcnt vmcnt(1)
MAA 40,96,184
v_exp_f32 v37, v37
MAA 56,100,184
v_exp_f32 v38, v38
MAA 72,104,184
v_exp_f32 v39, v39
MAA 88,108,184
v_exp_f32 v52, v52
v_exp_f32 v53, v53
v_exp_f32 v54, v54
v_exp_f32 v55, v55
v_pk_mul_f32 v[64:65], v[64:65], v[32:33]
v_pk_mul_f32 v[66:67], v[66:67], v[34:35]
v_pk_mul_f32 v[80:81], v[80:81], v[48:49]
v_pk_mul_f32 v[82:83], v[82:83], v[50:51]
ds_read_b128 v[48:51], v9 offset:128
v_pk_mul_f32 v[72:73], v[72:73], v[40:41]
v_pk_mul_f32 v[40:41], v[40:41], v[30:31] op_sel_hi:[1,0]
v_pk_mul_f32 v[74:75], v[74:75], v[42:43]
v_pk_mul_f32 v[42:43], v[42:43], v[30:31] op_sel_hi:[1,0]
v_pk_mul_f32 v[88:89], v[88:89], v[56:57]
v_pk_mul_f32 v[56:57], v[56:57], v[30:31] op_sel_hi:[1,0]
v_pk_mul_f32 v[90:91], v[90:91], v[58:59]
v_pk_mul_f32 v[58:59], v[58:59], v[30:31] op_sel_hi:[1,0]
v_pk_fma_f32 v[36:37], v[36:37], v[22:23], v[22:23] op_sel:[0,1,1] op_sel_hi:[1,1,1]
v_pk_fma_f32 v[38:39], v[38:39], v[22:23], v[22:23] op_sel:[0,1,1] op_sel_hi:[1,1,1]
v_pk_fma_f32 v[52:53], v[52:53], v[22:23], v[22:23] op_sel:[0,1,1] op_sel_hi:[1,1,1]
v_pk_fma_f32 v[54:55], v[54:55], v[22:23], v[22:23] op_sel:[0,1,1] op_sel_hi:[1,1,1]
v_cvt_pk_bf16_f32 v32, v64, v65
v_cvt_pk_bf16_f32 v33, v66, v67
ds_read_b128 v[64:67], v9 offset:192
v_cvt_pk_bf16_f32 v34, v80, v81
v_cvt_pk_bf16_f32 v35, v82, v83
MAA 44,64,156
buffer_store_dwordx4 v[32:35], v10, s[16:19], s62 offen sc1
MAA 60,68,156
ds_read_b128 v[80:83], v9 offset:640
v_rcp_f32 v36, v36
MAA 76,72,156
TR 64,17,33792
v_rcp_f32 v37, v37
MAA 92,76,156
TR 66,17,34304
v_rcp_f32 v38, v38
MAA 44,80,172
TR 68,17,33824
v_rcp_f32 v39, v39
MAA 60,84,172
TR 70,17,34336
v_rcp_f32 v52, v52
MAA 76,88,172
TR 72,17,42240
v_rcp_f32 v53, v53
MAA 92,92,172
TR 74,17,42752
v_rcp_f32 v54, v54
s_waitcnt vmcnt(1)
MAA 44,96,188
TR 76,17,42272
v_rcp_f32 v55, v55
MAA 60,100,188
TR 78,17,42784
v_exp_f32 v40, v40
MAA 76,104,188
TR 80,17,50688
v_exp_f32 v41, v41
MAA 92,108,188
TR 82,17,51200
v_exp_f32 v42, v42
v_exp_f32 v43, v43
v_exp_f32 v56, v56
v_exp_f32 v57, v57
v_exp_f32 v58, v58
v_exp_f32 v59, v59
v_pk_mul_f32 v[68:69], v[68:69], v[36:37]
v_pk_mul_f32 v[70:71], v[70:71], v[38:39]
v_pk_mul_f32 v[84:85], v[84:85], v[52:53]
v_pk_mul_f32 v[86:87], v[86:87], v[54:55]
ds_read_b128 v[52:55], v8 offset:576
v_pk_mul_f32 v[76:77], v[76:77], v[44:45]
v_pk_mul_f32 v[44:45], v[44:45], v[30:31] op_sel:[0,1] op_sel_hi:[1,1]
v_pk_mul_f32 v[78:79], v[78:79], v[46:47]
v_pk_mul_f32 v[46:47], v[46:47], v[30:31] op_sel:[0,1] op_sel_hi:[1,1]
v_pk_mul_f32 v[92:93], v[92:93], v[60:61]
v_pk_mul_f32 v[60:61], v[60:61], v[30:31] op_sel:[0,1] op_sel_hi:[1,1]
v_pk_mul_f32 v[94:95], v[94:95], v[62:63]
v_pk_mul_f32 v[62:63], v[62:63], v[30:31] op_sel:[0,1] op_sel_hi:[1,1]
v_pk_fma_f32 v[40:41], v[40:41], v[24:25], v[24:25] op_sel:[0,1,1] op_sel_hi:[1,1,1]
v_pk_fma_f32 v[42:43], v[42:43], v[24:25], v[24:25] op_sel:[0,1,1] op_sel_hi:[1,1,1]
v_pk_fma_f32 v[56:57], v[56:57], v[24:25], v[24:25] op_sel:[0,1,1] op_sel_hi:[1,1,1]
v_pk_fma_f32 v[58:59], v[58:59], v[24:25], v[24:25] op_sel:[0,1,1] op_sel_hi:[1,1,1]
v_cvt_pk_bf16_f32 v36, v68, v69
v_cvt_pk_bf16_f32 v37, v70, v71
v_cvt_pk_bf16_f32 v38, v84, v85
v_cvt_pk_bf16_f32 v39, v86, v87
MAA 96,112,144
buffer_store_dwordx4 v[36:39], v10, s[16:19], s62 offen offset:1024 sc1
MAA 112,116,144
TR 84,17,50720
v_rcp_f32 v40, v40
MAA 128,120,144
TR 86,17,51232
v_rcp_f32 v41, v41
MAA 144,124,144
TR 88,17,59136
v_rcp_f32 v42, v42
MAA 96,192,160
TR 90,17,59648
v_rcp_f32 v43, v43
MAA 112,196,160
TR 92,17,59168
v_rcp_f32 v56, v56
MAA 128,200,160
TR 94,17,59680
v_rcp_f32 v57, v57
MAA 144,204,160
v_rcp_f32 v58, v58
MAA 96,208,176
v_rcp_f32 v59, v59
MAA 112,212,176
v_exp_f32 v44, v44
MAA 128,216,176
v_exp_f32 v45, v45
MAA 144,220,176
v_lshrrev_b32 v69, 2, v0
v_min_u32 v69, 1, v69
v_lshlrev_b32 v69, 28, v69
v_lshl_add_u32 v68, v0, 7, v69
v_xor_b32 v69, 64, v0
v_min_u32 v69, 1, v69
v_lshlrev_b32 v70, 4, v69
v_sub_u32 v70, 16, v70
v_lshlrev_b32 v69, 28, v69
v_mov_b32 v71, 1
s_waitcnt lgkmcnt(0)
s_barrier
v_mov_b32 v84, 0
v_mov_b32 v85, 0
v_mov_b32 v86, 0
v_exp_f32 v46, v46
v_exp_f32 v47, v47
v_exp_f32 v60, v60
v_exp_f32 v61, v61
v_exp_f32 v62, v62
v_exp_f32 v63, v63
v_pk_mul_f32 v[72:73], v[72:73], v[40:41]
v_pk_mul_f32 v[74:75], v[74:75], v[42:43]
v_pk_mul_f32 v[88:89], v[88:89], v[56:57]
v_pk_mul_f32 v[90:91], v[90:91], v[58:59]
v_pk_fma_f32 v[96:97], v[48:49], v[20:21], v[96:97] op_sel_hi:[1,0,1]
v_pk_fma_f32 v[98:99], v[50:51], v[20:21], v[98:99] op_sel_hi:[1,0,1]
v_pk_fma_f32 v[112:113], v[64:65], v[20:21], v[112:113] op_sel_hi:[1,0,1]
v_pk_fma_f32 v[114:115], v[66:67], v[20:21], v[114:115] op_sel_hi:[1,0,1]
v_pk_fma_f32 v[128:129], v[80:81], v[20:21], v[128:129] op_sel_hi:[1,0,1]
v_pk_fma_f32 v[130:131], v[82:83], v[20:21], v[130:131] op_sel_hi:[1,0,1]
v_pk_fma_f32 v[144:145], v[4:5], v[20:21], v[144:145] op_sel_hi:[1,0,1]
v_pk_fma_f32 v[146:147], v[6:7], v[20:21], v[146:147] op_sel_hi:[1,0,1]
v_pk_mul_f32 v[128:129], v[128:129], v[96:97]
v_pk_mul_f32 v[96:97], v[96:97], v[28:29] op_sel_hi:[1,0]
v_pk_mul_f32 v[130:131], v[130:131], v[98:99]
v_pk_mul_f32 v[98:99], v[98:99], v[28:29] op_sel_hi:[1,0]
v_pk_mul_f32 v[144:145], v[144:145], v[112:113]
v_pk_mul_f32 v[112:113], v[112:113], v[28:29] op_sel_hi:[1,0]
v_pk_mul_f32 v[146:147], v[146:147], v[114:115]
v_pk_mul_f32 v[114:115], v[114:115], v[28:29] op_sel_hi:[1,0]
v_pk_fma_f32 v[44:45], v[44:45], v[26:27], v[26:27] op_sel:[0,1,1] op_sel_hi:[1,1,1]
v_pk_fma_f32 v[46:47], v[46:47], v[26:27], v[26:27] op_sel:[0,1,1] op_sel_hi:[1,1,1]
v_pk_fma_f32 v[60:61], v[60:61], v[26:27], v[26:27] op_sel:[0,1,1] op_sel_hi:[1,1,1]
v_pk_fma_f32 v[62:63], v[62:63], v[26:27], v[26:27] op_sel:[0,1,1] op_sel_hi:[1,1,1]
v_cvt_pk_bf16_f32 v40, v72, v73
v_cvt_pk_bf16_f32 v41, v74, v75
v_cvt_pk_bf16_f32 v42, v88, v89
v_cvt_pk_bf16_f32 v43, v90, v91
MAA 100,112,148
buffer_store_dwordx4 v[40:43], v11, s[16:19], s62 offen sc1
MAA 116,116,148
s_add_u32 m0, s59, 84480
v_rcp_f32 v44, v44
MAA 132,120,148
v_rcp_f32 v45, v45
MAA 148,124,148
v_rcp_f32 v46, v46
MAA 100,192,164
buffer_load_dwordx4 v18, s[28:31], s58 offen lds
MAA 116,196,164
v_rcp_f32 v47, v47
MAA 132,200,164
v_rcp_f32 v60, v60
MAA 148,204,164
v_rcp_f32 v61, v61
MAA 100,208,180
buffer_load_dwordx4 v19, s[28:31], s58 offen offset:1056 lds
MAA 116,212,180
s_add_u32 m0, s59, 92928
s_add_u32 s58, s99, 2555904
v_rcp_f32 v62, v62
MAA 132,216,180
v_rcp_f32 v63, v63
MAA 148,220,180
v_exp_f32 v96, v96
v_exp_f32 v97, v97
v_exp_f32 v98, v98
v_exp_f32 v99, v99
v_exp_f32 v112, v112
v_exp_f32 v113, v113
v_exp_f32 v114, v114
v_exp_f32 v115, v115
v_pk_mul_f32 v[76:77], v[76:77], v[44:45]
v_pk_mul_f32 v[78:79], v[78:79], v[46:47]
v_pk_mul_f32 v[92:93], v[92:93], v[60:61]
v_pk_mul_f32 v[94:95], v[94:95], v[62:63]
v_pk_fma_f32 v[100:101], v[48:49], v[22:23], v[100:101] op_sel_hi:[1,0,1]
v_pk_fma_f32 v[102:103], v[50:51], v[22:23], v[102:103] op_sel_hi:[1,0,1]
v_pk_fma_f32 v[116:117], v[64:65], v[22:23], v[116:117] op_sel_hi:[1,0,1]
v_pk_fma_f32 v[118:119], v[66:67], v[22:23], v[118:119] op_sel_hi:[1,0,1]
v_pk_fma_f32 v[132:133], v[80:81], v[22:23], v[132:133] op_sel_hi:[1,0,1]
v_pk_fma_f32 v[134:135], v[82:83], v[22:23], v[134:135] op_sel_hi:[1,0,1]
v_pk_fma_f32 v[148:149], v[4:5], v[22:23], v[148:149] op_sel_hi:[1,0,1]
v_pk_fma_f32 v[150:151], v[6:7], v[22:23], v[150:151] op_sel_hi:[1,0,1]
v_pk_mul_f32 v[132:133], v[132:133], v[100:101]
v_pk_mul_f32 v[100:101], v[100:101], v[28:29] op_sel:[0,1] op_sel_hi:[1,1]
v_pk_mul_f32 v[134:135], v[134:135], v[102:103]
v_pk_mul_f32 v[102:103], v[102:103], v[28:29] op_sel:[0,1] op_sel_hi:[1,1]
v_pk_mul_f32 v[148:149], v[148:149], v[116:117]
v_pk_mul_f32 v[116:117], v[116:117], v[28:29] op_sel:[0,1] op_sel_hi:[1,1]
v_pk_mul_f32 v[150:151], v[150:151], v[118:119]
v_pk_mul_f32 v[118:119], v[118:119], v[28:29] op_sel:[0,1] op_sel_hi:[1,1]
v_pk_fma_f32 v[96:97], v[96:97], v[20:21], v[20:21] op_sel:[0,1,1] op_sel_hi:[1,1,1]
v_pk_fma_f32 v[98:99], v[98:99], v[20:21], v[20:21] op_sel:[0,1,1] op_sel_hi:[1,1,1]
v_pk_fma_f32 v[112:113], v[112:113], v[20:21], v[20:21] op_sel:[0,1,1] op_sel_hi:[1,1,1]
v_pk_fma_f32 v[114:115], v[114:115], v[20:21], v[20:21] op_sel:[0,1,1] op_sel_hi:[1,1,1]
v_cvt_pk_bf16_f32 v44, v76, v77
v_cvt_pk_bf16_f32 v45, v78, v79
v_cvt_pk_bf16_f32 v46, v92, v93
v_cvt_pk_bf16_f32 v47, v94, v95
MAA 104,112,152
buffer_store_dwordx4 v[44:47], v11, s[16:19], s62 offen offset:1024 sc1
MAA 120,116,152
v_rcp_f32 v96, v96
MAA 136,120,152
v_rcp_f32 v97, v97
MAA 152,124,152
v_rcp_f32 v98, v98
MAA 104,192,168
buffer_load_dwordx4 v18, s[28:31], s58 offen lds
MAA 120,196,168
v_rcp_f32 v99, v99
MAA 136,200,168
v_rcp_f32 v112, v112
MAA 152,204,168
v_rcp_f32 v113, v113
MAA 104,208,184
buffer_load_dwordx4 v19, s[28:31], s58 offen offset:1056 lds
MAA 120,212,184
s_add_u32 m0, s59, 101376
s_add_u32 s58, s100, 2752512
v_rcp_f32 v114, v114
MAA 136,216,184
v_rcp_f32 v115, v115
MAA 152,220,184
v_exp_f32 v100, v100
v_exp_f32 v101, v101
v_exp_f32 v102, v102
v_exp_f32 v103, v103
v_exp_f32 v116, v116
v_exp_f32 v117, v117
v_exp_f32 v118, v118
v_exp_f32 v119, v119
v_pk_mul_f32 v[128:129], v[128:129], v[96:97]
v_pk_mul_f32 v[130:131], v[130:131], v[98:99]
v_pk_mul_f32 v[144:145], v[144:145], v[112:113]
v_pk_mul_f32 v[146:147], v[146:147], v[114:115]
ds_read_b128 v[112:115], v9 offset:256
v_pk_fma_f32 v[104:105], v[48:49], v[24:25], v[104:105] op_sel_hi:[1,0,1]
v_pk_fma_f32 v[106:107], v[50:51], v[24:25], v[106:107] op_sel_hi:[1,0,1]
v_pk_fma_f32 v[120:121], v[64:65], v[24:25], v[120:121] op_sel_hi:[1,0,1]
v_pk_fma_f32 v[122:123], v[66:67], v[24:25], v[122:123] op_sel_hi:[1,0,1]
v_pk_fma_f32 v[136:137], v[80:81], v[24:25], v[136:137] op_sel_hi:[1,0,1]
v_pk_fma_f32 v[138:139], v[82:83], v[24:25], v[138:139] op_sel_hi:[1,0,1]
v_pk_fma_f32 v[152:153], v[4:5], v[24:25], v[152:153] op_sel_hi:[1,0,1]
v_pk_fma_f32 v[154:155], v[6:7], v[24:25], v[154:155] op_sel_hi:[1,0,1]
v_pk_mul_f32 v[136:137], v[136:137], v[104:105]
v_pk_mul_f32 v[104:105], v[104:105], v[30:31] op_sel_hi:[1,0]
v_pk_mul_f32 v[138:139], v[138:139], v[106:107]
v_pk_mul_f32 v[106:107], v[106:107], v[30:31] op_sel_hi:[1,0]
v_pk_mul_f32 v[152:153], v[152:153], v[120:121]
v_pk_mul_f32 v[120:121], v[120:121], v[30:31] op_sel_hi:[1,0]
v_pk_mul_f32 v[154:155], v[154:155], v[122:123]
v_pk_mul_f32 v[122:123], v[122:123], v[30:31] op_sel_hi:[1,0]
v_pk_fma_f32 v[100:101], v[100:101], v[22:23], v[22:23] op_sel:[0,1,1] op_sel_hi:[1,1,1]
v_pk_fma_f32 v[102:103], v[102:103], v[22:23], v[22:23] op_sel:[0,1,1] op_sel_hi:[1,1,1]
v_pk_fma_f32 v[116:117], v[116:117], v[22:23], v[22:23] op_sel:[0,1,1] op_sel_hi:[1,1,1]
v_pk_fma_f32 v[118:119], v[118:119], v[22:23], v[22:23] op_sel:[0,1,1] op_sel_hi:[1,1,1]
v_cvt_pk_bf16_f32 v96, v128, v129
v_cvt_pk_bf16_f32 v97, v130, v131
ds_read_b128 v[128:131], v9 offset:320
v_cvt_pk_bf16_f32 v98, v144, v145
v_cvt_pk_bf16_f32 v99, v146, v147
MAA 108,112,156
buffer_store_dwordx4 v[96:99], v10, s[16:19], s63 offen sc1
MAA 124,116,156
ds_read_b128 v[144:147], v9 offset:768
v_rcp_f32 v100, v100
MAA 140,120,156
v_rcp_f32 v101, v101
MAA 156,124,156
v_rcp_f32 v102, v102
MAA 108,192,172
buffer_load_dwordx4 v18, s[28:31], s58 offen lds
MAA 124,196,172
v_rcp_f32 v103, v103
MAA 140,200,172
v_rcp_f32 v116, v116
MAA 156,204,172
v_rcp_f32 v117, v117
MAA 108,208,188
buffer_load_dwordx4 v19, s[28:31], s58 offen offset:1056 lds
MAA 124,212,188
s_add_u32 m0, s59, 109824
s_add_u32 s58, s100, 3014656
v_rcp_f32 v118, v118
MAA 140,216,188
v_rcp_f32 v119, v119
MAA 156,220,188
v_exp_f32 v104, v104
v_exp_f32 v105, v105
v_exp_f32 v106, v106
v_exp_f32 v107, v107
v_exp_f32 v120, v120
v_exp_f32 v121, v121
v_exp_f32 v122, v122
v_exp_f32 v123, v123
v_pk_mul_f32 v[132:133], v[132:133], v[100:101]
v_pk_mul_f32 v[134:135], v[134:135], v[102:103]
v_pk_mul_f32 v[148:149], v[148:149], v[116:117]
v_pk_mul_f32 v[150:151], v[150:151], v[118:119]
v_pk_fma_f32 v[108:109], v[48:49], v[26:27], v[108:109] op_sel_hi:[1,0,1]
v_pk_fma_f32 v[110:111], v[50:51], v[26:27], v[110:111] op_sel_hi:[1,0,1]
v_pk_fma_f32 v[124:125], v[64:65], v[26:27], v[124:125] op_sel_hi:[1,0,1]
v_pk_fma_f32 v[126:127], v[66:67], v[26:27], v[126:127] op_sel_hi:[1,0,1]
.Lpad6:
s_cbranch_execz .Lpad9
v_pk_fma_f32 v[140:141], v[80:81], v[26:27], v[140:141] op_sel_hi:[1,0,1]
v_pk_fma_f32 v[142:143], v[82:83], v[26:27], v[142:143] op_sel_hi:[1,0,1]
v_pk_fma_f32 v[156:157], v[4:5], v[26:27], v[156:157] op_sel_hi:[1,0,1]
v_pk_fma_f32 v[158:159], v[6:7], v[26:27], v[158:159] op_sel_hi:[1,0,1]
v_pk_mul_f32 v[140:141], v[140:141], v[108:109]
v_pk_mul_f32 v[108:109], v[108:109], v[30:31] op_sel:[0,1] op_sel_hi:[1,1]
v_pk_mul_f32 v[142:143], v[142:143], v[110:111]
v_pk_mul_f32 v[110:111], v[110:111], v[30:31] op_sel:[0,1] op_sel_hi:[1,1]
v_pk_mul_f32 v[156:157], v[156:157], v[124:125]
s_waitcnt vmcnt(5)
s_barrier
buffer_atomic_add v71, v68, s[16:19], s72 offen offset:512
v_pk_mul_f32 v[124:125], v[124:125], v[30:31] op_sel:[0,1] op_sel_hi:[1,1]
v_pk_mul_f32 v[158:159], v[158:159], v[126:127]
v_pk_mul_f32 v[126:127], v[126:127], v[30:31] op_sel:[0,1] op_sel_hi:[1,1]
v_pk_fma_f32 v[104:105], v[104:105], v[24:25], v[24:25] op_sel:[0,1,1] op_sel_hi:[1,1,1]
v_pk_fma_f32 v[106:107], v[106:107], v[24:25], v[24:25] op_sel:[0,1,1] op_sel_hi:[1,1,1]
v_pk_fma_f32 v[120:121], v[120:121], v[24:25], v[24:25] op_sel:[0,1,1] op_sel_hi:[1,1,1]
v_pk_fma_f32 v[122:123], v[122:123], v[24:25], v[24:25] op_sel:[0,1,1] op_sel_hi:[1,1,1]
v_cvt_pk_bf16_f32 v100, v132, v133
v_cvt_pk_bf16_f32 v101, v134, v135
v_cvt_pk_bf16_f32 v102, v148, v149
v_cvt_pk_bf16_f32 v103, v150, v151
MAA 160,0,144
v_rcp_f32 v104, v104
MAA 176,4,144
buffer_store_dwordx4 v[100:103], v10, s[16:19], s63 offen offset:1024 sc1
MAA 192,8,144
v_rcp_f32 v105, v105
MAA 208,12,144
v_rcp_f32 v106, v106
MAA 160,16,160
v_rcp_f32 v107, v107
MAA 176,20,160
buffer_load_dwordx4 v18, s[28:31], s58 offen lds
MAA 192,24,160
v_rcp_f32 v120, v120
MAA 208,28,160
v_rcp_f32 v121, v121
MAA 160,32,176
v_rcp_f32 v122, v122
MAA 176,36,176
buffer_load_dwordx4 v19, s[28:31], s58 offen offset:1056 lds
MAA 192,40,176
s_add_u32 m0, s59, 118272
s_add_u32 s58, s101, 3211264
v_rcp_f32 v123, v123
MAA 208,44,176
v_exp_f32 v108, v108
v_exp_f32 v109, v109
v_exp_f32 v110, v110
v_exp_f32 v111, v111
v_exp_f32 v124, v124
v_exp_f32 v125, v125
v_exp_f32 v126, v126
v_exp_f32 v127, v127
v_pk_mul_f32 v[136:137], v[136:137], v[104:105]
v_pk_mul_f32 v[138:139], v[138:139], v[106:107]
v_pk_mul_f32 v[152:153], v[152:153], v[120:121]
v_pk_mul_f32 v[154:155], v[154:155], v[122:123]
s_waitcnt lgkmcnt(2)
v_pk_fma_f32 v[160:161], v[112:113], v[20:21], v[160:161] op_sel_hi:[1,0,1]
v_pk_fma_f32 v[162:163], v[114:115], v[20:21], v[162:163] op_sel_hi:[1,0,1]
s_waitcnt lgkmcnt(1)
v_pk_fma_f32 v[176:177], v[128:129], v[20:21], v[176:177] op_sel_hi:[1,0,1]
v_pk_fma_f32 v[178:179], v[130:131], v[20:21], v[178:179] op_sel_hi:[1,0,1]
s_waitcnt lgkmcnt(0)
v_pk_fma_f32 v[192:193], v[144:145], v[20:21], v[192:193] op_sel_hi:[1,0,1]
v_pk_fma_f32 v[194:195], v[146:147], v[20:21], v[194:195] op_sel_hi:[1,0,1]
v_pk_fma_f32 v[208:209], v[12:13], v[20:21], v[208:209] op_sel_hi:[1,0,1]
v_pk_fma_f32 v[210:211], v[14:15], v[20:21], v[210:211] op_sel_hi:[1,0,1]
v_pk_mul_f32 v[192:193], v[192:193], v[160:161]
v_pk_mul_f32 v[160:161], v[160:161], v[28:29] op_sel_hi:[1,0]
v_pk_mul_f32 v[194:195], v[194:195], v[162:163]
v_pk_mul_f32 v[162:163], v[162:163], v[28:29] op_sel_hi:[1,0]
v_pk_mul_f32 v[208:209], v[208:209], v[176:177]
v_pk_mul_f32 v[176:177], v[176:177], v[28:29] op_sel_hi:[1,0]
v_pk_mul_f32 v[210:211], v[210:211], v[178:179]
v_pk_mul_f32 v[178:179], v[178:179], v[28:29] op_sel_hi:[1,0]
v_pk_fma_f32 v[108:109], v[108:109], v[26:27], v[26:27] op_sel:[0,1,1] op_sel_hi:[1,1,1]
v_pk_fma_f32 v[110:111], v[110:111], v[26:27], v[26:27] op_sel:[0,1,1] op_sel_hi:[1,1,1]
v_pk_fma_f32 v[124:125], v[124:125], v[26:27], v[26:27] op_sel:[0,1,1] op_sel_hi:[1,1,1]
v_pk_fma_f32 v[126:127], v[126:127], v[26:27], v[26:27] op_sel:[0,1,1] op_sel_hi:[1,1,1]
v_cvt_pk_bf16_f32 v104, v136, v137
v_cvt_pk_bf16_f32 v105, v138, v139
v_cvt_pk_bf16_f32 v106, v152, v153
v_cvt_pk_bf16_f32 v107, v154, v155
MAA 164,0,148
buffer_store_dwordx4 v[104:107], v11, s[16:19], s63 offen sc1
MAA 180,4,148
v_rcp_f32 v108, v108
MAA 196,8,148
v_rcp_f32 v109, v109
MAA 212,12,148
v_rcp_f32 v110, v110
MAA 164,16,164
buffer_load_dwordx4 v18, s[28:31], s58 offen lds
MAA 180,20,164
v_rcp_f32 v111, v111
MAA 196,24,164
v_rcp_f32 v124, v124
MAA 212,28,164
v_rcp_f32 v125, v125
MAA 164,32,180
buffer_load_dwordx4 v19, s[28:31], s58 offen offset:1056 lds
MAA 180,36,180
s_add_u32 m0, s59, 126720
s_add_u32 s58, s101, 3473408
v_rcp_f32 v126, v126
MAA 196,40,180
v_rcp_f32 v127, v127
MAA 212,44,180
v_lshl_add_u32 v4, v1, 4, s74
v_add_u32 v2, 67108480, v4
v_cndmask_b32 v4, v4, v2, vcc
s_and_b32 s74, s7, 1
v_bfe_u32 v7, v1, 2, 3
v_mul_u32_u24 v7, 1056, v7
v_bfe_u32 v2, v1, 5, 1
v_lshl_add_u32 v7, v2, 8, v7
v_and_b32 v2, 3, v1
v_lshl_add_u32 v7, v2, 3, v7
s_lshl_b32 s74, s74, 7
s_xor_b32 s75, s74, 128
v_add_u32 v6, s75, v7
v_add_u32 v7, s74, v7
v_exp_f32 v160, v160
v_exp_f32 v161, v161
v_exp_f32 v162, v162
v_exp_f32 v163, v163
v_exp_f32 v176, v176
v_exp_f32 v177, v177
v_exp_f32 v178, v178
v_exp_f32 v179, v179
v_pk_mul_f32 v[140:141], v[140:141], v[108:109]
v_pk_mul_f32 v[142:143], v[142:143], v[110:111]
v_pk_mul_f32 v[156:157], v[156:157], v[124:125]
v_pk_mul_f32 v[158:159], v[158:159], v[126:127]
v_pk_fma_f32 v[164:165], v[112:113], v[22:23], v[164:165] op_sel_hi:[1,0,1]
v_pk_fma_f32 v[166:167], v[114:115], v[22:23], v[166:167] op_sel_hi:[1,0,1]
v_pk_fma_f32 v[180:181], v[128:129], v[22:23], v[180:181] op_sel_hi:[1,0,1]
v_pk_fma_f32 v[182:183], v[130:131], v[22:23], v[182:183] op_sel_hi:[1,0,1]
v_pk_fma_f32 v[196:197], v[144:145], v[22:23], v[196:197] op_sel_hi:[1,0,1]
v_pk_fma_f32 v[198:199], v[146:147], v[22:23], v[198:199] op_sel_hi:[1,0,1]
v_pk_fma_f32 v[212:213], v[12:13], v[22:23], v[212:213] op_sel_hi:[1,0,1]
v_pk_fma_f32 v[214:215], v[14:15], v[22:23], v[214:215] op_sel_hi:[1,0,1]
v_pk_mul_f32 v[196:197], v[196:197], v[164:165]
v_pk_mul_f32 v[164:165], v[164:165], v[28:29] op_sel:[0,1] op_sel_hi:[1,1]
v_pk_mul_f32 v[198:199], v[198:199], v[166:167]
v_pk_mul_f32 v[166:167], v[166:167], v[28:29] op_sel:[0,1] op_sel_hi:[1,1]
v_pk_mul_f32 v[212:213], v[212:213], v[180:181]
v_pk_mul_f32 v[180:181], v[180:181], v[28:29] op_sel:[0,1] op_sel_hi:[1,1]
v_pk_mul_f32 v[214:215], v[214:215], v[182:183]
v_pk_mul_f32 v[182:183], v[182:183], v[28:29] op_sel:[0,1] op_sel_hi:[1,1]
v_pk_fma_f32 v[160:161], v[160:161], v[20:21], v[20:21] op_sel:[0,1,1] op_sel_hi:[1,1,1]
v_pk_fma_f32 v[162:163], v[162:163], v[20:21], v[20:21] op_sel:[0,1,1] op_sel_hi:[1,1,1]
v_pk_fma_f32 v[176:177], v[176:177], v[20:21], v[20:21] op_sel:[0,1,1] op_sel_hi:[1,1,1]
v_pk_fma_f32 v[178:179], v[178:179], v[20:21], v[20:21] op_sel:[0,1,1] op_sel_hi:[1,1,1]
v_cvt_pk_bf16_f32 v108, v140, v141
v_cvt_pk_bf16_f32 v109, v142, v143
v_cvt_pk_bf16_f32 v110, v156, v157
v_cvt_pk_bf16_f32 v111, v158, v159
MAA 168,0,152
buffer_store_dwordx4 v[108:111], v11, s[16:19], s63 offen offset:1024 sc1
MAA 184,4,152
v_rcp_f32 v160, v160
MAA 200,8,152
v_rcp_f32 v161, v161
MAA 216,12,152
v_rcp_f32 v162, v162
MAA 168,16,168
buffer_load_dwordx4 v18, s[28:31], s58 offen lds
MAA 184,20,168
v_rcp_f32 v163, v163
MAA 200,24,168
v_rcp_f32 v176, v176
MAA 216,28,168
v_rcp_f32 v177, v177
MAA 168,32,184
buffer_load_dwordx4 v19, s[28:31], s58 offen offset:1056 lds
MAA 184,36,184
v_rcp_f32 v178, v178
MAA 200,40,184
v_rcp_f32 v179, v179
MAA 216,44,184
v_exp_f32 v164, v164
v_exp_f32 v165, v165
v_exp_f32 v166, v166
v_exp_f32 v167, v167
v_exp_f32 v180, v180
v_exp_f32 v181, v181
v_exp_f32 v182, v182
v_exp_f32 v183, v183
v_pk_mul_f32 v[192:193], v[192:193], v[160:161]
v_pk_mul_f32 v[194:195], v[194:195], v[162:163]
v_pk_mul_f32 v[208:209], v[208:209], v[176:177]
v_pk_mul_f32 v[210:211], v[210:211], v[178:179]
ds_read_b128 v[176:179], v8
v_pk_fma_f32 v[168:169], v[112:113], v[24:25], v[168:169] op_sel_hi:[1,0,1]
v_pk_fma_f32 v[170:171], v[114:115], v[24:25], v[170:171] op_sel_hi:[1,0,1]
v_pk_fma_f32 v[184:185], v[128:129], v[24:25], v[184:185] op_sel_hi:[1,0,1]
v_pk_fma_f32 v[186:187], v[130:131], v[24:25], v[186:187] op_sel_hi:[1,0,1]
v_pk_fma_f32 v[200:201], v[144:145], v[24:25], v[200:201] op_sel_hi:[1,0,1]
v_pk_fma_f32 v[202:203], v[146:147], v[24:25], v[202:203] op_sel_hi:[1,0,1]
v_pk_fma_f32 v[216:217], v[12:13], v[24:25], v[216:217] op_sel_hi:[1,0,1]
v_pk_fma_f32 v[218:219], v[14:15], v[24:25], v[218:219] op_sel_hi:[1,0,1]
v_pk_mul_f32 v[200:201], v[200:201], v[168:169]
v_pk_mul_f32 v[168:169], v[168:169], v[30:31] op_sel_hi:[1,0]
v_pk_mul_f32 v[202:203], v[202:203], v[170:171]
v_pk_mul_f32 v[170:171], v[170:171], v[30:31] op_sel_hi:[1,0]
v_pk_mul_f32 v[216:217], v[216:217], v[184:185]
v_pk_mul_f32 v[184:185], v[184:185], v[30:31] op_sel_hi:[1,0]
v_pk_mul_f32 v[218:219], v[218:219], v[186:187]
v_pk_mul_f32 v[186:187], v[186:187], v[30:31] op_sel_hi:[1,0]
v_pk_fma_f32 v[164:165], v[164:165], v[22:23], v[22:23] op_sel:[0,1,1] op_sel_hi:[1,1,1]
v_pk_fma_f32 v[166:167], v[166:167], v[22:23], v[22:23] op_sel:[0,1,1] op_sel_hi:[1,1,1]
v_pk_fma_f32 v[180:181], v[180:181], v[22:23], v[22:23] op_sel:[0,1,1] op_sel_hi:[1,1,1]
v_pk_fma_f32 v[182:183], v[182:183], v[22:23], v[22:23] op_sel:[0,1,1] op_sel_hi:[1,1,1]
v_cvt_pk_bf16_f32 v160, v192, v193
v_cvt_pk_bf16_f32 v161, v194, v195
ds_read_b128 v[192:195], v8 offset:64
v_cvt_pk_bf16_f32 v162, v208, v209
v_cvt_pk_bf16_f32 v163, v210, v211
MAA 172,0,156
buffer_store_dwordx4 v[160:163], v10, s[16:19], s64 offen sc1
MAA 188,4,156
ds_read_b128 v[208:211], v8 offset:512
v_rcp_f32 v164, v164
MAA 204,8,156
v_rcp_f32 v165, v165
MAA 220,12,156
v_rcp_f32 v166, v166
MAA 172,16,172
buffer_atomic_add v84, v69, s[16:19], s73 offen offset:512 sc0
MAA 188,20,172
v_rcp_f32 v167, v167
MAA 204,24,172
v_rcp_f32 v180, v180
MAA 220,28,172
v_rcp_f32 v181, v181
MAA 172,32,188
v_rcp_f32 v182, v182
MAA 188,36,188
v_rcp_f32 v183, v183
MAA 204,40,188
v_exp_f32 v168, v168
MAA 220,44,188
v_exp_f32 v169, v169
v_exp_f32 v170, v170
v_exp_f32 v171, v171
v_exp_f32 v184, v184
v_exp_f32 v185, v185
v_exp_f32 v186, v186
v_exp_f32 v187, v187
v_pk_mul_f32 v[196:197], v[196:197], v[164:165]
v_pk_mul_f32 v[198:199], v[198:199], v[166:167]
v_pk_mul_f32 v[212:213], v[212:213], v[180:181]
v_pk_mul_f32 v[214:215], v[214:215], v[182:183]
v_pk_fma_f32 v[172:173], v[112:113], v[26:27], v[172:173] op_sel_hi:[1,0,1]
v_pk_fma_f32 v[174:175], v[114:115], v[26:27], v[174:175] op_sel_hi:[1,0,1]
v_pk_fma_f32 v[188:189], v[128:129], v[26:27], v[188:189] op_sel_hi:[1,0,1]
v_pk_fma_f32 v[190:191], v[130:131], v[26:27], v[190:191] op_sel_hi:[1,0,1]
v_pk_fma_f32 v[204:205], v[144:145], v[26:27], v[204:205] op_sel_hi:[1,0,1]
v_pk_fma_f32 v[206:207], v[146:147], v[26:27], v[206:207] op_sel_hi:[1,0,1]
v_pk_fma_f32 v[220:221], v[12:13], v[26:27], v[220:221] op_sel_hi:[1,0,1]
v_pk_fma_f32 v[222:223], v[14:15], v[26:27], v[222:223] op_sel_hi:[1,0,1]
v_pk_mul_f32 v[204:205], v[204:205], v[172:173]
v_pk_mul_f32 v[172:173], v[172:173], v[30:31] op_sel:[0,1] op_sel_hi:[1,1]
v_pk_mul_f32 v[206:207], v[206:207], v[174:175]
v_pk_mul_f32 v[174:175], v[174:175], v[30:31] op_sel:[0,1] op_sel_hi:[1,1]
v_pk_mul_f32 v[220:221], v[220:221], v[188:189]
v_pk_mul_f32 v[188:189], v[188:189], v[30:31] op_sel:[0,1] op_sel_hi:[1,1]
v_pk_mul_f32 v[222:223], v[222:223], v[190:191]
v_pk_mul_f32 v[190:191], v[190:191], v[30:31] op_sel:[0,1] op_sel_hi:[1,1]
v_pk_fma_f32 v[168:169], v[168:169], v[24:25], v[24:25] op_sel:[0,1,1] op_sel_hi:[1,1,1]
v_pk_fma_f32 v[170:171], v[170:171], v[24:25], v[24:25] op_sel:[0,1,1] op_sel_hi:[1,1,1]
v_pk_fma_f32 v[184:185], v[184:185], v[24:25], v[24:25] op_sel:[0,1,1] op_sel_hi:[1,1,1]
v_pk_fma_f32 v[186:187], v[186:187], v[24:25], v[24:25] op_sel:[0,1,1] op_sel_hi:[1,1,1]
v_cvt_pk_bf16_f32 v164, v196, v197
v_cvt_pk_bf16_f32 v165, v198, v199
v_cvt_pk_bf16_f32 v166, v212, v213
v_cvt_pk_bf16_f32 v167, v214, v215
MAA 224,48,144
buffer_store_dwordx4 v[164:167], v10, s[16:19], s64 offen offset:1024 sc1
MAA 232,52,144
v_rcp_f32 v168, v168
MAA 240,56,144
v_rcp_f32 v169, v169
MAA 248,60,144
v_rcp_f32 v170, v170
MAA 224,64,160
buffer_atomic_add v85, v69, s[16:19], s73 offen offset:512 sc0
MAA 232,68,160
v_rcp_f32 v171, v171
MAA 240,72,160
v_rcp_f32 v184, v184
MAA 248,76,160
v_rcp_f32 v185, v185
MAA 224,80,176
v_rcp_f32 v186, v186
MAA 232,84,176
v_rcp_f32 v187, v187
MAA 240,88,176
v_exp_f32 v172, v172
MAA 248,92,176
v_exp_f32 v173, v173
v_exp_f32 v174, v174
v_exp_f32 v175, v175
v_exp_f32 v188, v188
v_exp_f32 v189, v189
v_exp_f32 v190, v190
v_exp_f32 v191, v191
v_pk_mul_f32 v[200:201], v[200:201], v[168:169]
v_pk_mul_f32 v[202:203], v[202:203], v[170:171]
v_pk_mul_f32 v[216:217], v[216:217], v[184:185]
v_pk_mul_f32 v[218:219], v[218:219], v[186:187]
s_waitcnt lgkmcnt(2)
v_pk_fma_f32 v[224:225], v[176:177], v[20:21], v[224:225] op_sel_hi:[1,0,1]
v_pk_fma_f32 v[226:227], v[178:179], v[20:21], v[226:227] op_sel_hi:[1,0,1]
s_waitcnt lgkmcnt(1)
v_pk_fma_f32 v[232:233], v[192:193], v[20:21], v[232:233] op_sel_hi:[1,0,1]
v_pk_fma_f32 v[234:235], v[194:195], v[20:21], v[234:235] op_sel_hi:[1,0,1]
s_waitcnt lgkmcnt(0)
v_pk_fma_f32 v[240:241], v[208:209], v[20:21], v[240:241] op_sel_hi:[1,0,1]
v_pk_fma_f32 v[242:243], v[210:211], v[20:21], v[242:243] op_sel_hi:[1,0,1]
v_pk_fma_f32 v[248:249], v[52:53], v[20:21], v[248:249] op_sel_hi:[1,0,1]
v_pk_fma_f32 v[250:251], v[54:55], v[20:21], v[250:251] op_sel_hi:[1,0,1]
v_pk_mul_f32 v[240:241], v[240:241], v[224:225]
v_pk_mul_f32 v[224:225], v[224:225], v[28:29] op_sel_hi:[1,0]
v_pk_mul_f32 v[242:243], v[242:243], v[226:227]
v_pk_mul_f32 v[226:227], v[226:227], v[28:29] op_sel_hi:[1,0]
v_pk_mul_f32 v[248:249], v[248:249], v[232:233]
v_pk_mul_f32 v[232:233], v[232:233], v[28:29] op_sel_hi:[1,0]
v_pk_mul_f32 v[250:251], v[250:251], v[234:235]
v_pk_mul_f32 v[234:235], v[234:235], v[28:29] op_sel_hi:[1,0]
v_pk_fma_f32 v[172:173], v[172:173], v[26:27], v[26:27] op_sel:[0,1,1] op_sel_hi:[1,1,1]
v_pk_fma_f32 v[174:175], v[174:175], v[26:27], v[26:27] op_sel:[0,1,1] op_sel_hi:[1,1,1]
v_pk_fma_f32 v[188:189], v[188:189], v[26:27], v[26:27] op_sel:[0,1,1] op_sel_hi:[1,1,1]
v_pk_fma_f32 v[190:191], v[190:191], v[26:27], v[26:27] op_sel:[0,1,1] op_sel_hi:[1,1,1]
v_cvt_pk_bf16_f32 v168, v200, v201
v_cvt_pk_bf16_f32 v169, v202, v203
v_cvt_pk_bf16_f32 v170, v216, v217
v_cvt_pk_bf16_f32 v171, v218, v219
buffer_store_dwordx4 v[168:171], v11, s[16:19], s64 offen sc1
buffer_atomic_add v86, v69, s[16:19], s73 offen offset:512 sc0
s_waitcnt vmcnt(4)
v_cmp_gt_u32 vcc, v70, v84
s_nop 0
s_cbranch_vccz .Lok48
s_waitcnt vmcnt(2)
v_cmp_gt_u32 vcc, v70, v85
s_nop 0
s_cbranch_vccz .Lok48
s_waitcnt vmcnt(0)
v_cmp_gt_u32 vcc, v70, v86
s_nop 0
s_cbranch_vccz .Lok48
s_mov_b32 s15, 0
.Lok48l:
v_mov_b32 v84, 0
buffer_atomic_add v84, v69, s[16:19], s73 offen offset:512 sc0
s_add_u32 s15, s15, 1
s_cmp_gt_u32 s15, 100000
s_waitcnt vmcnt(0)
s_cbranch_scc1 .Lok48
v_cmp_gt_u32 vcc, v70, v84
s_nop 0
s_cbranch_vccnz .Lok48l
.Lok48:
s_barrier
MAA 228,48,148
ds_read_b64_tr_b16 a[0:1], v7
s_add_u32 s52, s76, 0
MAA 236,52,148
buffer_load_dwordx4 v[96:99], v4, s[16:19], s52 offen sc1
MAA 244,56,148
TR 2,7,512
v_rcp_f32 v172, v172
MAA 252,60,148
TR 4,7,32
v_rcp_f32 v173, v173
MAA 228,64,164
TR 6,7,544
v_rcp_f32 v174, v174
MAA 236,68,164
buffer_load_dwordx4 v[100:103], v4, s[16:19], s52 offen offset:1024 sc1
MAA 244,72,164
TR 8,7,64
s_add_u32 s52, s76, 65536
MAA 252,76,164
TR 10,7,576
v_rcp_f32 v175, v175
MAA 228,80,180
TR 12,7,96
v_rcp_f32 v188, v188
MAA 236,84,180
buffer_load_dwordx4 v[104:107], v4, s[16:19], s52 offen sc1
MAA 244,88,180
TR 14,7,608
v_rcp_f32 v189, v189
MAA 252,92,180
ds_read_b64_tr_b16 a[16:17], v6
v_rcp_f32 v190, v190
v_rcp_f32 v191, v191
v_exp_f32 v224, v224
v_exp_f32 v225, v225
v_exp_f32 v226, v226
v_exp_f32 v227, v227
v_exp_f32 v232, v232
v_exp_f32 v233, v233
v_exp_f32 v234, v234
v_exp_f32 v235, v235
v_pk_mul_f32 v[204:205], v[204:205], v[172:173]
buffer_load_dwordx4 v[108:111], v4, s[16:19], s52 offen offset:1024 sc1
s_add_u32 s52, s77, 114688
v_pk_mul_f32 v[206:207], v[206:207], v[174:175]
v_pk_mul_f32 v[220:221], v[220:221], v[188:189]
v_pk_mul_f32 v[222:223], v[222:223], v[190:191]
v_pk_fma_f32 v[228:229], v[176:177], v[22:23], v[228:229] op_sel_hi:[1,0,1]
v_pk_fma_f32 v[230:231], v[178:179], v[22:23], v[230:231] op_sel_hi:[1,0,1]
v_pk_fma_f32 v[236:237], v[192:193], v[22:23], v[236:237] op_sel_hi:[1,0,1]
v_pk_fma_f32 v[238:239], v[194:195], v[22:23], v[238:239] op_sel_hi:[1,0,1]
v_pk_fma_f32 v[244:245], v[208:209], v[22:23], v[244:245] op_sel_hi:[1,0,1]
v_pk_fma_f32 v[246:247], v[210:211], v[22:23], v[246:247] op_sel_hi:[1,0,1]
v_pk_fma_f32 v[252:253], v[52:53], v[22:23], v[252:253] op_sel_hi:[1,0,1]
v_pk_fma_f32 v[254:255], v[54:55], v[22:23], v[254:255] op_sel_hi:[1,0,1]
v_pk_mul_f32 v[244:245], v[244:245], v[228:229]
buffer_load_dwordx4 v[112:115], v4, s[16:19], s52 offen sc1
v_pk_mul_f32 v[228:229], v[228:229], v[28:29] op_sel:[0,1] op_sel_hi:[1,1]
v_pk_mul_f32 v[246:247], v[246:247], v[230:231]
v_pk_mul_f32 v[230:231], v[230:231], v[28:29] op_sel:[0,1] op_sel_hi:[1,1]
v_pk_mul_f32 v[252:253], v[252:253], v[236:237]
v_pk_mul_f32 v[236:237], v[236:237], v[28:29] op_sel:[0,1] op_sel_hi:[1,1]
v_pk_mul_f32 v[254:255], v[254:255], v[238:239]
v_pk_mul_f32 v[238:239], v[238:239], v[28:29] op_sel:[0,1] op_sel_hi:[1,1]
v_pk_fma_f32 v[224:225], v[224:225], v[20:21], v[20:21] op_sel:[0,1,1] op_sel_hi:[1,1,1]
v_pk_fma_f32 v[226:227], v[226:227], v[20:21], v[20:21] op_sel:[0,1,1] op_sel_hi:[1,1,1]
v_pk_fma_f32 v[232:233], v[232:233], v[20:21], v[20:21] op_sel:[0,1,1] op_sel_hi:[1,1,1]
v_pk_fma_f32 v[234:235], v[234:235], v[20:21], v[20:21] op_sel:[0,1,1] op_sel_hi:[1,1,1]
v_cvt_pk_bf16_f32 v172, v204, v205
v_cvt_pk_bf16_f32 v173, v206, v207
buffer_load_dwordx4 v[116:119], v4, s[16:19], s52 offen offset:1024 sc1
s_add_u32 s52, s77, 180224
v_cvt_pk_bf16_f32 v174, v220, v221
v_cvt_pk_bf16_f32 v175, v222, v223
TR 18,6,512
TR 20,6,32
TR 22,6,544
TR 24,6,64
TR 26,6,576
buffer_store_dwordx4 v[172:175], v11, s[16:19], s64 offen offset:1024 sc1
TR 28,6,96
TR 30,6,608
v_rcp_f32 v224, v224
v_rcp_f32 v225, v225
v_rcp_f32 v226, v226
v_rcp_f32 v227, v227
v_rcp_f32 v232, v232
v_rcp_f32 v233, v233
v_rcp_f32 v234, v234
v_rcp_f32 v235, v235
v_exp_f32 v228, v228
v_exp_f32 v229, v229
v_exp_f32 v230, v230
v_exp_f32 v231, v231
v_exp_f32 v236, v236
v_exp_f32 v237, v237
v_exp_f32 v238, v238
v_exp_f32 v239, v239
v_pk_mul_f32 v[240:241], v[240:241], v[224:225]
buffer_load_dwordx4 v[120:123], v4, s[16:19], s52 offen sc1
v_pk_mul_f32 v[242:243], v[242:243], v[226:227]
v_pk_mul_f32 v[248:249], v[248:249], v[232:233]
v_pk_mul_f32 v[250:251], v[250:251], v[234:235]
v_pk_fma_f32 v[228:229], v[228:229], v[22:23], v[22:23] op_sel:[0,1,1] op_sel_hi:[1,1,1]
v_pk_fma_f32 v[230:231], v[230:231], v[22:23], v[22:23] op_sel:[0,1,1] op_sel_hi:[1,1,1]
v_pk_fma_f32 v[236:237], v[236:237], v[22:23], v[22:23] op_sel:[0,1,1] op_sel_hi:[1,1,1]
v_pk_fma_f32 v[238:239], v[238:239], v[22:23], v[22:23] op_sel:[0,1,1] op_sel_hi:[1,1,1]
v_cvt_pk_bf16_f32 v224, v240, v241
v_cvt_pk_bf16_f32 v225, v242, v243
v_cvt_pk_bf16_f32 v226, v248, v249
v_cvt_pk_bf16_f32 v227, v250, v251
v_rcp_f32 v228, v228
v_rcp_f32 v229, v229
v_rcp_f32 v230, v230
v_rcp_f32 v231, v231
v_rcp_f32 v236, v236
v_rcp_f32 v237, v237
v_rcp_f32 v238, v238
v_rcp_f32 v239, v239
v_pk_mul_f32 v[244:245], v[244:245], v[228:229]
buffer_store_dwordx4 v[224:227], v10, s[16:19], s65 offen sc1
v_pk_mul_f32 v[246:247], v[246:247], v[230:231]
v_pk_mul_f32 v[252:253], v[252:253], v[236:237]
v_pk_mul_f32 v[254:255], v[254:255], v[238:239]
v_cvt_pk_bf16_f32 v228, v244, v245
v_cvt_pk_bf16_f32 v229, v246, v247
v_cvt_pk_bf16_f32 v230, v252, v253
v_cvt_pk_bf16_f32 v231, v254, v255
buffer_store_dwordx4 v[228:231], v10, s[16:19], s65 offen offset:1024 sc1
buffer_load_dwordx4 v[124:127], v4, s[16:19], s52 offen offset:1024 sc1
v_mov_b32 v21, v68
v_mov_b32 v22, v69
v_mov_b32 v23, v70
v_mov_b32 v24, v71
v_mov_b32 v25, 0
s_waitcnt vmcnt(9) lgkmcnt(0)
s_barrier
v_mfma_f32_16x16x32_bf16 v[32:35], a[0:3], v[96:99], 0
TR 32,7,8448
s_add_u32 s52, s78, 229376
v_mfma_f32_16x16x32_bf16 v[48:51], a[0:3], v[100:103], 0
buffer_load_dwordx4 v[128:131], v4, s[16:19], s52 offen sc1
v_mfma_f32_16x16x32_bf16 v[52:55], a[4:7], v[100:103], 0
TR 34,7,8960
TR 36,7,8480
v_mfma_f32_16x16x32_bf16 v[36:39], a[4:7], v[96:99], 0
TR 38,7,8992
v_mfma_f32_16x16x32_bf16 v[40:43], a[8:11], v[96:99], 0
buffer_load_dwordx4 v[132:135], v4, s[16:19], s52 offen offset:1024 sc1
v_mfma_f32_16x16x32_bf16 v[56:59], a[8:11], v[100:103], 0
TR 40,7,8512
TR 42,7,9024
v_mfma_f32_16x16x32_bf16 v[60:63], a[12:15], v[100:103], 0
TR 44,7,8544
v_mfma_f32_16x16x32_bf16 v[44:47], a[12:15], v[96:99], 0
TR 46,7,9056
s_add_u32 s52, s78, 294912
v_mfma_f32_16x16x32_bf16 v[64:67], a[16:19], v[96:99], 0
buffer_load_dwordx4 v[136:139], v4, s[16:19], s52 offen sc1
v_mfma_f32_16x16x32_bf16 v[80:83], a[16:19], v[100:103], 0
TR 48,6,8448
v_mfma_f32_16x16x32_bf16 v[84:87], a[20:23], v[100:103], 0
TR 50,6,8960
TR 52,6,8480
v_mfma_f32_16x16x32_bf16 v[68:71], a[20:23], v[96:99], 0
TR 54,6,8992
v_mfma_f32_16x16x32_bf16 v[72:75], a[24:27], v[96:99], 0
buffer_load_dwordx4 v[140:143], v4, s[16:19], s52 offen offset:1024 sc1
v_mfma_f32_16x16x32_bf16 v[88:91], a[24:27], v[100:103], 0
TR 56,6,8512
TR 58,6,9024
v_mfma_f32_16x16x32_bf16 v[92:95], a[28:31], v[100:103], 0
TR 60,6,8544
v_mfma_f32_16x16x32_bf16 v[76:79], a[28:31], v[96:99], 0
TR 62,6,9056
s_waitcnt vmcnt(11) lgkmcnt(8)
MAV 32,32,104
TR 0,7,16896
s_add_u32 s52, s79, 344064
MAV 48,32,108
buffer_load_dwordx4 v[144:147], v4, s[16:19], s52 offen sc1
MAV 52,36,108
TR 2,7,17408
TR 4,7,16928
MAV 36,36,104
TR 6,7,17440
MAV 40,40,104
buffer_load_dwordx4 v[148:151], v4, s[16:19], s52 offen offset:1024 sc1
MAV 56,40,108
TR 8,7,16960
TR 10,7,17472
MAV 60,44,108
TR 12,7,16992
MAV 44,44,104
TR 14,7,17504
s_add_u32 s52, s79, 409600
s_waitcnt lgkmcnt(8)
MAV 64,48,104
buffer_load_dwordx4 v[152:155], v4, s[16:19], s52 offen sc1
MAV 80,48,108
TR 16,6,16896
MAV 84,52,108
TR 18,6,17408
TR 20,6,16928
MAV 68,52,104
TR 22,6,17440
MAV 72,56,104
buffer_load_dwordx4 v[156:159], v4, s[16:19], s52 offen offset:1024 sc1
MAV 88,56,108
TR 24,6,16960
TR 26,6,17472
MAV 92,60,108
TR 28,6,16992
MAV 76,60,104
TR 30,6,17504
s_waitcnt vmcnt(9) lgkmcnt(8)
s_barrier
MAV 32,0,112
TR 32,7,25344
TR 34,7,25856
MAV 48,0,116
buffer_atomic_add v24, v21, s[16:19], s72 offen
MAV 52,4,116
TR 36,7,25376
TR 38,7,25888
MAV 36,4,112
.Lpad7:
s_cbranch_execz .Lpad10
TR 40,7,25408
s_add_u32 m0, s55, 0
MAV 40,8,112
buffer_load_dwordx4 v18, s[28:31], s54 offen lds
MAV 56,8,116
TR 42,7,25920
MAV 60,12,116
TR 44,7,25440
TR 46,7,25952
MAV 44,12,112
TR 48,6,25344
s_add_u32 s52, s76, 458752
s_waitcnt lgkmcnt(9)
MAV 64,16,112
buffer_load_dwordx4 v[96:99], v4, s[16:19], s52 offen sc1
MAV 80,16,116
TR 50,6,25856
TR 52,6,25376
MAV 84,20,116
buffer_load_dwordx4 v19, s[28:31], s54 offen offset:1056 lds
MAV 68,20,112
s_add_u32 s54, s98, 327680
MAV 72,24,112
TR 54,6,25888
TR 56,6,25408
MAV 88,24,116
buffer_load_dwordx4 v[100:103], v4, s[16:19], s52 offen offset:1024 sc1
MAV 92,28,116
TR 58,6,25920
TR 60,6,25440
MAV 76,28,112
TR 62,6,25952
s_waitcnt vmcnt(13) lgkmcnt(8)
MAV 32,32,120
TR 0,7,33792
s_add_u32 m0, s55, 8448
MAV 48,32,124
buffer_load_dwordx4 v18, s[28:31], s54 offen lds
MAV 52,36,124
TR 2,7,34304
TR 4,7,33824
MAV 36,36,120
TR 6,7,34336
s_add_u32 s52, s76, 524288
MAV 40,40,120
buffer_load_dwordx4 v[104:107], v4, s[16:19], s52 offen sc1
MAV 56,40,124
TR 8,7,33856
MAV 60,44,124
TR 10,7,34368
TR 12,7,33888
MAV 44,44,120
TR 14,7,34400
s_waitcnt lgkmcnt(8)
MAV 64,48,120
buffer_load_dwordx4 v19, s[28:31], s54 offen offset:1056 lds
MAV 80,48,124
s_add_u32 s54, s99, 524288
MAV 84,52,124
TR 16,6,33792
TR 18,6,34304
MAV 68,52,120
TR 20,6,33824
TR 22,6,34336
MAV 72,56,120
buffer_load_dwordx4 v[108:111], v4, s[16:19], s52 offen offset:1024 sc1
MAV 88,56,124
TR 24,6,33856
MAV 92,60,124
TR 26,6,34368
TR 28,6,33888
MAV 76,60,120
TR 30,6,34400
s_waitcnt vmcnt(15) lgkmcnt(8)
s_barrier
MAV 32,0,128
TR 32,7,42240
s_add_u32 m0, s55, 16896
MAV 48,0,132
buffer_load_dwordx4 v18, s[28:31], s54 offen lds
MAV 52,4,132
TR 34,7,42752
TR 36,7,42272
MAV 36,4,128
TR 38,7,42784
s_add_u32 s52, s77, 573440
MAV 40,8,128
buffer_load_dwordx4 v[112:115], v4, s[16:19], s52 offen sc1
MAV 56,8,132
TR 40,7,42304
MAV 60,12,132
TR 42,7,42816
TR 44,7,42336
MAV 44,12,128
TR 46,7,42848
s_waitcnt lgkmcnt(8)
MAV 64,16,128
buffer_load_dwordx4 v19, s[28:31], s54 offen offset:1056 lds
MAV 80,16,132
s_add_u32 s54, s99, 786432
MAV 84,20,132
TR 48,6,42240
TR 50,6,42752
MAV 68,20,128
TR 52,6,42272
TR 54,6,42784
MAV 72,24,128
buffer_load_dwordx4 v[116:119], v4, s[16:19], s52 offen offset:1024 sc1
MAV 88,24,132
TR 56,6,42304
MAV 92,28,132
TR 58,6,42816
TR 60,6,42336
MAV 76,28,128
TR 62,6,42848
s_waitcnt vmcnt(17) lgkmcnt(8)
MAV 32,32,136
TR 0,7,50688
s_add_u32 m0, s55, 25344
MAV 48,32,140
buffer_load_dwordx4 v18, s[28:31], s54 offen lds
MAV 52,36,140
TR 2,7,51200
TR 4,7,50720
MAV 36,36,136
TR 6,7,51232
s_add_u32 s52, s77, 638976
MAV 40,40,136
buffer_load_dwordx4 v[120:123], v4, s[16:19], s52 offen sc1
MAV 56,40,140
TR 8,7,50752
TR 10,7,51264
MAV 60,44,140
TR 12,7,50784
TR 14,7,51296
MAV 44,44,136
s_waitcnt lgkmcnt(8)
MAV 64,48,136
buffer_load_dwordx4 v19, s[28:31], s54 offen offset:1056 lds
MAV 80,48,140
TR 16,6,50688
s_add_u32 s54, s100, 983040
MAV 84,52,140
buffer_load_dwordx4 v[124:127], v4, s[16:19], s52 offen offset:1024 sc1
MAV 68,52,136
TR 18,6,51200
TR 20,6,50720
MAV 72,56,136
TR 22,6,51232
TR 24,6,50752
MAV 88,56,140
buffer_atomic_add v25, v22, s[16:19], s73 offen sc0
MAV 92,60,140
TR 26,6,51264
TR 28,6,50784
MAV 76,60,136
TR 30,6,51296
s_waitcnt vmcnt(20) lgkmcnt(8)
s_barrier
MAV 32,0,144
TR 32,7,59136
s_add_u32 m0, s55, 33792
MAV 48,0,148
buffer_load_dwordx4 v18, s[28:31], s54 offen lds
MAV 52,4,148
TR 34,7,59648
TR 36,7,59168
MAV 36,4,144
TR 38,7,59680
s_add_u32 s52, s78, 688128
MAV 40,8,144
buffer_load_dwordx4 v[128:131], v4, s[16:19], s52 offen sc1
MAV 56,8,148
TR 40,7,59200
MAV 60,12,148
TR 42,7,59712
TR 44,7,59232
MAV 44,12,144
TR 46,7,59744
s_waitcnt lgkmcnt(8)
MAV 64,16,144
buffer_load_dwordx4 v19, s[28:31], s54 offen offset:1056 lds
MAV 80,16,148
s_add_u32 s54, s100, 1245184
MAV 84,20,148
TR 48,6,59136
TR 50,6,59648
MAV 68,20,144
TR 52,6,59168
TR 54,6,59680
MAV 72,24,144
buffer_load_dwordx4 v[132:135], v4, s[16:19], s52 offen offset:1024 sc1
MAV 88,24,148
TR 56,6,59200
MAV 92,28,148
TR 58,6,59712
TR 60,6,59232
MAV 76,28,144
TR 62,6,59744
v_add_u32 v7, s57, v7
v_add_u32 v6, s57, v6
s_sub_u32 s57, 0, s57
s_waitcnt vmcnt(22) lgkmcnt(8)
MAV 32,32,152
ds_read_b64_tr_b16 a[0:1], v7
s_add_u32 m0, s55, 42240
MAV 48,32,156
buffer_load_dwordx4 v18, s[28:31], s54 offen lds
MAV 52,36,156
TR 2,7,512
TR 4,7,32
MAV 36,36,152
TR 6,7,544
s_add_u32 s52, s78, 753664
MAV 40,40,152
buffer_load_dwordx4 v[136:139], v4, s[16:19], s52 offen sc1
MAV 56,40,156
TR 8,7,64
MAV 60,44,156
TR 10,7,576
TR 12,7,96
MAV 44,44,152
TR 14,7,608
s_waitcnt lgkmcnt(8)
MAV 64,48,152
buffer_load_dwordx4 v19, s[28:31], s54 offen offset:1056 lds
MAV 80,48,156
s_add_u32 s54, s101, 1441792
MAV 84,52,156
ds_read_b64_tr_b16 a[16:17], v6
TR 18,6,512
MAV 68,52,152
TR 20,6,32
TR 22,6,544
MAV 72,56,152
buffer_load_dwordx4 v[140:143], v4, s[16:19], s52 offen offset:1024 sc1
MAV 88,56,156
TR 24,6,64
MAV 92,60,156
TR 26,6,576
TR 28,6,96
MAV 76,60,152
TR 30,6,608
s_waitcnt vmcnt(21) lgkmcnt(8)
s_barrier
MAV 32,0,96
TR 32,7,8448
s_add_u32 m0, s55, 50688
MAV 48,0,100
buffer_load_dwordx4 v18, s[28:31], s54 offen lds
MAV 52,4,100
TR 34,7,8960
TR 36,7,8480
MAV 36,4,96
TR 38,7,8992
s_add_u32 s52, s79, 802816
MAV 40,8,96
buffer_load_dwordx4 v[144:147], v4, s[16:19], s52 offen sc1
MAV 56,8,100
TR 40,7,8512
MAV 60,12,100
TR 42,7,9024
TR 44,7,8544
MAV 44,12,96
TR 46,7,9056
s_waitcnt lgkmcnt(8)
MAV 64,16,96
buffer_load_dwordx4 v19, s[28:31], s54 offen offset:1056 lds
MAV 80,16,100
s_add_u32 s54, s101, 1703936
MAV 84,20,100
TR 48,6,8448
TR 50,6,8960
MAV 68,20,96
TR 52,6,8480
TR 54,6,8992
MAV 72,24,96
buffer_load_dwordx4 v[148:151], v4, s[16:19], s52 offen offset:1024 sc1
MAV 88,24,100
TR 56,6,8512
MAV 92,28,100
TR 58,6,9024
TR 60,6,8544
MAV 76,28,96
TR 62,6,9056
s_waitcnt vmcnt(21) lgkmcnt(8)
MAV 32,32,104
TR 0,7,16896
s_add_u32 m0, s55, 59136
MAV 48,32,108
buffer_load_dwordx4 v18, s[28:31], s54 offen lds
MAV 52,36,108
TR 2,7,17408
TR 4,7,16928
MAV 36,36,104
TR 6,7,17440
s_add_u32 s52, s79, 868352
MAV 40,40,104
buffer_load_dwordx4 v[152:155], v4, s[16:19], s52 offen sc1
MAV 56,40,108
TR 8,7,16960
MAV 60,44,108
TR 10,7,17472
TR 12,7,16992
MAV 44,44,104
TR 14,7,17504
s_waitcnt lgkmcnt(8)
MAV 64,48,104
buffer_load_dwordx4 v19, s[28:31], s54 offen offset:1056 lds
MAV 80,48,108
s_add_u32 s54, s98, 1900544
MAV 84,52,108
TR 16,6,16896
TR 18,6,17408
MAV 68,52,104
TR 20,6,16928
TR 22,6,17440
MAV 72,56,104
buffer_load_dwordx4 v[156:159], v4, s[16:19], s52 offen offset:1024 sc1
MAV 88,56,108
TR 24,6,16960
MAV 92,60,108
TR 26,6,17472
TR 28,6,16992
MAV 76,60,104
TR 30,6,17504
s_waitcnt vmcnt(16)
v_cmp_gt_u32 vcc, v23, v25
s_nop 0
s_cbranch_vccnz .Lsp49
.Lsp49b:
s_waitcnt lgkmcnt(8)
s_barrier
MAV 32,0,112
TR 32,7,25344
s_add_u32 m0, s55, 67584
MAV 48,0,116
buffer_load_dwordx4 v18, s[28:31], s54 offen lds
MAV 52,4,116
TR 34,7,25856
TR 36,7,25376
MAV 36,4,112
TR 38,7,25888
s_add_u32 s52, s76, 16384
MAV 40,8,112
buffer_load_dwordx4 v[96:99], v4, s[16:19], s52 offen sc1
MAV 56,8,116
TR 40,7,25408
MAV 60,12,116
TR 42,7,25920
TR 44,7,25440
MAV 44,12,112
TR 46,7,25952
s_waitcnt lgkmcnt(8)
MAV 64,16,112
buffer_load_dwordx4 v19, s[28:31], s54 offen offset:1056 lds
MAV 80,16,116
s_add_u32 s54, s98, 2162688
MAV 84,20,116
TR 48,6,25344
TR 50,6,25856
MAV 68,20,112
TR 52,6,25376
TR 54,6,25888
MAV 72,24,112
buffer_load_dwordx4 v[100:103], v4, s[16:19], s52 offen offset:1024 sc1
MAV 88,24,116
TR 56,6,25408
MAV 92,28,116
TR 58,6,25920
TR 60,6,25440
MAV 76,28,112
TR 62,6,25952
s_waitcnt lgkmcnt(8)
MAV 32,32,120
TR 0,7,33792
s_add_u32 m0, s55, 76032
MAV 48,32,124
buffer_load_dwordx4 v18, s[28:31], s54 offen lds
MAV 52,36,124
TR 2,7,34304
TR 4,7,33824
MAV 36,36,120
TR 6,7,34336
s_add_u32 s52, s76, 81920
MAV 40,40,120
buffer_load_dwordx4 v[104:107], v4, s[16:19], s52 offen sc1
MAV 56,40,124
TR 8,7,33856
MAV 60,44,124
TR 10,7,34368
TR 12,7,33888
MAV 44,44,120
TR 14,7,34400
s_waitcnt lgkmcnt(8)
MAV 64,48,120
buffer_load_dwordx4 v19, s[28:31], s54 offen offset:1056 lds
MAV 80,48,124
s_add_u32 s54, s99, 2359296
MAV 84,52,124
TR 16,6,33792
TR 18,6,34304
MAV 68,52,120
TR 20,6,33824
TR 22,6,34336
MAV 72,56,120
buffer_load_dwordx4 v[108:111], v4, s[16:19], s52 offen offset:1024 sc1
MAV 88,56,124
TR 24,6,33856
MAV 92,60,124
TR 26,6,34368
TR 28,6,33888
MAV 76,60,120
TR 30,6,34400
s_waitcnt vmcnt(20) lgkmcnt(8)
s_barrier
MAV 32,0,128
TR 32,7,42240
s_add_u32 m0, s55, 84480
MAV 48,0,132
buffer_load_dwordx4 v18, s[28:31], s54 offen lds
MAV 52,4,132
TR 34,7,42752
TR 36,7,42272
MAV 36,4,128
TR 38,7,42784
s_add_u32 s52, s77, 131072
MAV 40,8,128
buffer_load_dwordx4 v[112:115], v4, s[16:19], s52 offen sc1
MAV 56,8,132
TR 40,7,42304
MAV 60,12,132
TR 42,7,42816
TR 44,7,42336
MAV 44,12,128
TR 46,7,42848
s_waitcnt lgkmcnt(8)
MAV 64,16,128
buffer_load_dwordx4 v19, s[28:31], s54 offen offset:1056 lds
MAV 80,16,132
s_add_u32 s54, s99, 2621440
MAV 84,20,132
TR 48,6,42240
TR 50,6,42752
MAV 68,20,128
TR 52,6,42272
TR 54,6,42784
MAV 72,24,128
buffer_load_dwordx4 v[116:119], v4, s[16:19], s52 offen offset:1024 sc1
MAV 88,24,132
TR 56,6,42304
MAV 92,28,132
TR 58,6,42816
TR 60,6,42336
MAV 76,28,128
TR 62,6,42848
s_waitcnt vmcnt(20) lgkmcnt(8)
MAV 32,32,136
TR 0,7,50688
s_add_u32 m0, s55, 92928
MAV 48,32,140
buffer_load_dwordx4 v18, s[28:31], s54 offen lds
MAV 52,36,140
TR 2,7,51200
TR 4,7,50720
MAV 36,36,136
TR 6,7,51232
s_add_u32 s52, s77, 196608
MAV 40,40,136
buffer_load_dwordx4 v[120:123], v4, s[16:19], s52 offen sc1
MAV 56,40,140
TR 8,7,50752
MAV 60,44,140
TR 10,7,51264
TR 12,7,50784
MAV 44,44,136
TR 14,7,51296
s_waitcnt lgkmcnt(8)
MAV 64,48,136
buffer_load_dwordx4 v19, s[28:31], s54 offen offset:1056 lds
MAV 80,48,140
s_add_u32 s54, s100, 2818048
MAV 84,52,140
TR 16,6,50688
TR 18,6,51200
MAV 68,52,136
TR 20,6,50720
TR 22,6,51232
MAV 72,56,136
buffer_load_dwordx4 v[124:127], v4, s[16:19], s52 offen offset:1024 sc1
MAV 88,56,140
TR 24,6,50752
MAV 92,60,140
TR 26,6,51264
TR 28,6,50784
MAV 76,60,136
TR 30,6,51296
s_waitcnt vmcnt(20) lgkmcnt(8)
s_barrier
MAV 32,0,144
TR 32,7,59136
s_add_u32 m0, s55, 101376
MAV 48,0,148
buffer_load_dwordx4 v18, s[28:31], s54 offen lds
MAV 52,4,148
TR 34,7,59648
TR 36,7,59168
MAV 36,4,144
TR 38,7,59680
s_add_u32 s52, s78, 245760
MAV 40,8,144
buffer_load_dwordx4 v[128:131], v4, s[16:19], s52 offen sc1
MAV 56,8,148
TR 40,7,59200
MAV 60,12,148
TR 42,7,59712
TR 44,7,59232
MAV 44,12,144
TR 46,7,59744
s_waitcnt lgkmcnt(8)
MAV 64,16,144
buffer_load_dwordx4 v19, s[28:31], s54 offen offset:1056 lds
MAV 80,16,148
s_add_u32 s54, s100, 3080192
MAV 84,20,148
TR 48,6,59136
TR 50,6,59648
MAV 68,20,144
TR 52,6,59168
TR 54,6,59680
MAV 72,24,144
buffer_load_dwordx4 v[132:135], v4, s[16:19], s52 offen offset:1024 sc1
.Lpad8:
s_cbranch_execz .Lpad11
MAV 88,24,148
TR 56,6,59200
MAV 92,28,148
TR 58,6,59712
TR 60,6,59232
MAV 76,28,144
TR 62,6,59744
v_add_u32 v7, s57, v7
v_add_u32 v6, s57, v6
s_sub_u32 s57, 0, s57
s_waitcnt vmcnt(20) lgkmcnt(8)
MAV 32,32,152
ds_read_b64_tr_b16 a[0:1], v7
s_add_u32 m0, s55, 109824
MAV 48,32,156
buffer_load_dwordx4 v18, s[28:31], s54 offen lds
MAV 52,36,156
TR 2,7,512
TR 4,7,32
MAV 36,36,152
TR 6,7,544
s_add_u32 s52, s78, 311296
MAV 40,40,152
buffer_load_dwordx4 v[136:139], v4, s[16:19], s52 offen sc1
MAV 56,40,156
TR 8,7,64
MAV 60,44,156
TR 10,7,576
TR 12,7,96
MAV 44,44,152
TR 14,7,608
s_waitcnt lgkmcnt(8)
MAV 64,48,152
buffer_load_dwordx4 v19, s[28:31], s54 offen offset:1056 lds
MAV 80,48,156
s_add_u32 s54, s101, 3276800
MAV 84,52,156
ds_read_b64_tr_b16 a[16:17], v6
TR 18,6,512
MAV 68,52,152
TR 20,6,32
TR 22,6,544
MAV 72,56,152
buffer_load_dwordx4 v[140:143], v4, s[16:19], s52 offen offset:1024 sc1
MAV 88,56,156
TR 24,6,64
MAV 92,60,156
TR 26,6,576
TR 28,6,96
MAV 76,60,152
TR 30,6,608
s_waitcnt vmcnt(20) lgkmcnt(8)
s_barrier
MAV 32,0,96
TR 32,7,8448
s_add_u32 m0, s55, 118272
MAV 48,0,100
buffer_load_dwordx4 v18, s[28:31], s54 offen lds
MAV 52,4,100
TR 34,7,8960
TR 36,7,8480
MAV 36,4,96
TR 38,7,8992
s_add_u32 s52, s79, 360448
MAV 40,8,96
buffer_load_dwordx4 v[144:147], v4, s[16:19], s52 offen sc1
MAV 56,8,100
TR 40,7,8512
MAV 60,12,100
TR 42,7,9024
TR 44,7,8544
MAV 44,12,96
TR 46,7,9056
s_waitcnt lgkmcnt(8)
MAV 64,16,96
buffer_load_dwordx4 v19, s[28:31], s54 offen offset:1056 lds
MAV 80,16,100
s_add_u32 s54, s101, 3538944
MAV 84,20,100
TR 48,6,8448
TR 50,6,8960
MAV 68,20,96
TR 52,6,8480
TR 54,6,8992
MAV 72,24,96
buffer_load_dwordx4 v[148:151], v4, s[16:19], s52 offen offset:1024 sc1
MAV 88,24,100
TR 56,6,8512
MAV 92,28,100
TR 58,6,9024
TR 60,6,8544
MAV 76,28,96
TR 62,6,9056
s_waitcnt vmcnt(20) lgkmcnt(8)
MAV 32,32,104
TR 0,7,16896
s_add_u32 m0, s55, 126720
MAV 48,32,108
buffer_load_dwordx4 v18, s[28:31], s54 offen lds
MAV 52,36,108
TR 2,7,17408
TR 4,7,16928
MAV 36,36,104
TR 6,7,17440
s_add_u32 s52, s79, 425984
MAV 40,40,104
buffer_load_dwordx4 v[152:155], v4, s[16:19], s52 offen sc1
MAV 56,40,108
TR 8,7,16960
MAV 60,44,108
TR 10,7,17472
TR 12,7,16992
MAV 44,44,104
TR 14,7,17504
s_waitcnt lgkmcnt(8)
MAV 64,48,104
buffer_load_dwordx4 v19, s[28:31], s54 offen offset:1056 lds
MAV 80,48,108
s_add_u32 s54, s98, 131072
MAV 84,52,108
TR 16,6,16896
TR 18,6,17408
MAV 68,52,104
TR 20,6,16928
TR 22,6,17440
MAV 72,56,104
buffer_load_dwordx4 v[156:159], v4, s[16:19], s52 offen offset:1024 sc1
MAV 88,56,108
TR 24,6,16960
MAV 92,60,108
TR 26,6,17472
TR 28,6,16992
MAV 76,60,104
TR 30,6,17504
s_waitcnt vmcnt(20) lgkmcnt(8)
s_barrier
MAV 32,0,112
TR 32,7,25344
s_add_u32 m0, s55, 0
MAV 48,0,116
buffer_load_dwordx4 v18, s[28:31], s54 offen lds
MAV 52,4,116
TR 34,7,25856
TR 36,7,25376
MAV 36,4,112
TR 38,7,25888
s_add_u32 s52, s76, 475136
MAV 40,8,112
buffer_load_dwordx4 v[96:99], v4, s[16:19], s52 offen sc1
MAV 56,8,116
TR 40,7,25408
MAV 60,12,116
TR 42,7,25920
TR 44,7,25440
MAV 44,12,112
TR 46,7,25952
s_waitcnt lgkmcnt(8)
MAV 64,16,112
buffer_load_dwordx4 v19, s[28:31], s54 offen offset:1056 lds
MAV 80,16,116
s_add_u32 s54, s98, 393216
MAV 84,20,116
TR 48,6,25344
TR 50,6,25856
MAV 68,20,112
TR 52,6,25376
TR 54,6,25888
MAV 72,24,112
buffer_load_dwordx4 v[100:103], v4, s[16:19], s52 offen offset:1024 sc1
MAV 88,24,116
TR 56,6,25408
MAV 92,28,116
TR 58,6,25920
TR 60,6,25440
MAV 76,28,112
TR 62,6,25952
s_waitcnt vmcnt(20) lgkmcnt(8)
MAV 32,32,120
TR 0,7,33792
s_add_u32 m0, s55, 8448
MAV 48,32,124
buffer_load_dwordx4 v18, s[28:31], s54 offen lds
MAV 52,36,124
TR 2,7,34304
TR 4,7,33824
MAV 36,36,120
TR 6,7,34336
s_add_u32 s52, s76, 540672
MAV 40,40,120
buffer_load_dwordx4 v[104:107], v4, s[16:19], s52 offen sc1
MAV 56,40,124
TR 8,7,33856
MAV 60,44,124
TR 10,7,34368
TR 12,7,33888
MAV 44,44,120
TR 14,7,34400
s_waitcnt lgkmcnt(8)
MAV 64,48,120
buffer_load_dwordx4 v19, s[28:31], s54 offen offset:1056 lds
MAV 80,48,124
s_add_u32 s54, s99, 589824
MAV 84,52,124
TR 16,6,33792
TR 18,6,34304
MAV 68,52,120
TR 20,6,33824
TR 22,6,34336
MAV 72,56,120
buffer_load_dwordx4 v[108:111], v4, s[16:19], s52 offen offset:1024 sc1
MAV 88,56,124
TR 24,6,33856
MAV 92,60,124
TR 26,6,34368
TR 28,6,33888
MAV 76,60,120
TR 30,6,34400
s_waitcnt vmcnt(20) lgkmcnt(8)
s_barrier
MAV 32,0,128
TR 32,7,42240
s_add_u32 m0, s55, 16896
MAV 48,0,132
buffer_load_dwordx4 v18, s[28:31], s54 offen lds
MAV 52,4,132
TR 34,7,42752
TR 36,7,42272
MAV 36,4,128
TR 38,7,42784
s_add_u32 s52, s77, 589824
MAV 40,8,128
buffer_load_dwordx4 v[112:115], v4, s[16:19], s52 offen sc1
MAV 56,8,132
TR 40,7,42304
MAV 60,12,132
TR 42,7,42816
TR 44,7,42336
MAV 44,12,128
TR 46,7,42848
s_waitcnt lgkmcnt(8)
MAV 64,16,128
buffer_load_dwordx4 v19, s[28:31], s54 offen offset:1056 lds
MAV 80,16,132
s_add_u32 s54, s99, 851968
MAV 84,20,132
TR 48,6,42240
TR 50,6,42752
MAV 68,20,128
TR 52,6,42272
TR 54,6,42784
MAV 72,24,128
buffer_load_dwordx4 v[116:119], v4, s[16:19], s52 offen offset:1024 sc1
MAV 88,24,132
TR 56,6,42304
MAV 92,28,132
TR 58,6,42816
TR 60,6,42336
MAV 76,28,128
TR 62,6,42848
s_waitcnt vmcnt(20) lgkmcnt(8)
MAV 32,32,136
TR 0,7,50688
s_add_u32 m0, s55, 25344
MAV 48,32,140
buffer_load_dwordx4 v18, s[28:31], s54 offen lds
MAV 52,36,140
TR 2,7,51200
TR 4,7,50720
MAV 36,36,136
TR 6,7,51232
s_add_u32 s52, s77, 655360
MAV 40,40,136
buffer_load_dwordx4 v[120:123], v4, s[16:19], s52 offen sc1
MAV 56,40,140
TR 8,7,50752
MAV 60,44,140
TR 10,7,51264
TR 12,7,50784
MAV 44,44,136
TR 14,7,51296
s_waitcnt lgkmcnt(8)
MAV 64,48,136
buffer_load_dwordx4 v19, s[28:31], s54 offen offset:1056 lds
MAV 80,48,140
s_add_u32 s54, s100, 1048576
MAV 84,52,140
TR 16,6,50688
TR 18,6,51200
MAV 68,52,136
TR 20,6,50720
TR 22,6,51232
MAV 72,56,136
buffer_load_dwordx4 v[124:127], v4, s[16:19], s52 offen offset:1024 sc1
MAV 88,56,140
TR 24,6,50752
MAV 92,60,140
TR 26,6,51264
TR 28,6,50784
MAV 76,60,136
TR 30,6,51296
s_waitcnt vmcnt(20) lgkmcnt(8)
s_barrier
MAV 32,0,144
TR 32,7,59136
s_add_u32 m0, s55, 33792
MAV 48,0,148
buffer_load_dwordx4 v18, s[28:31], s54 offen lds
MAV 52,4,148
TR 34,7,59648
TR 36,7,59168
MAV 36,4,144
TR 38,7,59680
s_add_u32 s52, s78, 704512
MAV 40,8,144
buffer_load_dwordx4 v[128:131], v4, s[16:19], s52 offen sc1
MAV 56,8,148
TR 40,7,59200
MAV 60,12,148
TR 42,7,59712
TR 44,7,59232
MAV 44,12,144
TR 46,7,59744
s_waitcnt lgkmcnt(8)
MAV 64,16,144
buffer_load_dwordx4 v19, s[28:31], s54 offen offset:1056 lds
MAV 80,16,148
s_add_u32 s54, s100, 1310720
MAV 84,20,148
TR 48,6,59136
TR 50,6,59648
MAV 68,20,144
TR 52,6,59168
TR 54,6,59680
MAV 72,24,144
buffer_load_dwordx4 v[132:135], v4, s[16:19], s52 offen offset:1024 sc1
MAV 88,24,148
TR 56,6,59200
MAV 92,28,148
TR 58,6,59712
TR 60,6,59232
MAV 76,28,144
TR 62,6,59744
v_add_u32 v7, s57, v7
v_add_u32 v6, s57, v6
s_sub_u32 s57, 0, s57
s_waitcnt vmcnt(20) lgkmcnt(8)
MAV 32,32,152
ds_read_b64_tr_b16 a[0:1], v7
s_add_u32 m0, s55, 42240
MAV 48,32,156
buffer_load_dwordx4 v18, s[28:31], s54 offen lds
MAV 52,36,156
TR 2,7,512
TR 4,7,32
MAV 36,36,152
TR 6,7,544
s_add_u32 s52, s78, 770048
MAV 40,40,152
buffer_load_dwordx4 v[136:139], v4, s[16:19], s52 offen sc1
MAV 56,40,156
TR 8,7,64
MAV 60,44,156
TR 10,7,576
TR 12,7,96
MAV 44,44,152
TR 14,7,608
s_waitcnt lgkmcnt(8)
MAV 64,48,152
buffer_load_dwordx4 v19, s[28:31], s54 offen offset:1056 lds
MAV 80,48,156
s_add_u32 s54, s101, 1507328
MAV 84,52,156
ds_read_b64_tr_b16 a[16:17], v6
TR 18,6,512
MAV 68,52,152
TR 20,6,32
TR 22,6,544
MAV 72,56,152
buffer_load_dwordx4 v[140:143], v4, s[16:19], s52 offen offset:1024 sc1
MAV 88,56,156
TR 24,6,64
MAV 92,60,156
TR 26,6,576
TR 28,6,96
MAV 76,60,152
TR 30,6,608
s_waitcnt vmcnt(20) lgkmcnt(8)
s_barrier
MAV 32,0,96
TR 32,7,8448
s_add_u32 m0, s55, 50688
MAV 48,0,100
buffer_load_dwordx4 v18, s[28:31], s54 offen lds
MAV 52,4,100
TR 34,7,8960
TR 36,7,8480
MAV 36,4,96
TR 38,7,8992
s_add_u32 s52, s79, 819200
MAV 40,8,96
buffer_load_dwordx4 v[144:147], v4, s[16:19], s52 offen sc1
MAV 56,8,100
TR 40,7,8512
MAV 60,12,100
TR 42,7,9024
TR 44,7,8544
MAV 44,12,96
TR 46,7,9056
s_waitcnt lgkmcnt(8)
MAV 64,16,96
buffer_load_dwordx4 v19, s[28:31], s54 offen offset:1056 lds
MAV 80,16,100
s_add_u32 s54, s101, 1769472
MAV 84,20,100
TR 48,6,8448
TR 50,6,8960
MAV 68,20,96
TR 52,6,8480
TR 54,6,8992
MAV 72,24,96
buffer_load_dwordx4 v[148:151], v4, s[16:19], s52 offen offset:1024 sc1
MAV 88,24,100
TR 56,6,8512
MAV 92,28,100
TR 58,6,9024
TR 60,6,8544
MAV 76,28,96
TR 62,6,9056
s_waitcnt vmcnt(20) lgkmcnt(8)
MAV 32,32,104
TR 0,7,16896
s_add_u32 m0, s55, 59136
MAV 48,32,108
buffer_load_dwordx4 v18, s[28:31], s54 offen lds
MAV 52,36,108
TR 2,7,17408
TR 4,7,16928
MAV 36,36,104
TR 6,7,17440
s_add_u32 s52, s79, 884736
MAV 40,40,104
buffer_load_dwordx4 v[152:155], v4, s[16:19], s52 offen sc1
MAV 56,40,108
TR 8,7,16960
MAV 60,44,108
TR 10,7,17472
TR 12,7,16992
MAV 44,44,104
TR 14,7,17504
s_waitcnt lgkmcnt(8)
MAV 64,48,104
buffer_load_dwordx4 v19, s[28:31], s54 offen offset:1056 lds
MAV 80,48,108
s_add_u32 s54, s98, 1966080
MAV 84,52,108
TR 16,6,16896
TR 18,6,17408
MAV 68,52,104
TR 20,6,16928
TR 22,6,17440
MAV 72,56,104
buffer_load_dwordx4 v[156:159], v4, s[16:19], s52 offen offset:1024 sc1
MAV 88,56,108
TR 24,6,16960
MAV 92,60,108
TR 26,6,17472
TR 28,6,16992
MAV 76,60,104
TR 30,6,17504
s_waitcnt vmcnt(20) lgkmcnt(8)
s_barrier
MAV 32,0,112
TR 32,7,25344
s_add_u32 m0, s55, 67584
MAV 48,0,116
buffer_load_dwordx4 v18, s[28:31], s54 offen lds
MAV 52,4,116
TR 34,7,25856
TR 36,7,25376
MAV 36,4,112
TR 38,7,25888
s_add_u32 s52, s76, 32768
MAV 40,8,112
buffer_load_dwordx4 v[96:99], v4, s[16:19], s52 offen sc1
MAV 56,8,116
TR 40,7,25408
MAV 60,12,116
TR 42,7,25920
TR 44,7,25440
MAV 44,12,112
TR 46,7,25952
s_waitcnt lgkmcnt(8)
MAV 64,16,112
buffer_load_dwordx4 v19, s[28:31], s54 offen offset:1056 lds
MAV 80,16,116
s_add_u32 s54, s98, 2228224
MAV 84,20,116
TR 48,6,25344
TR 50,6,25856
MAV 68,20,112
TR 52,6,25376
TR 54,6,25888
MAV 72,24,112
buffer_load_dwordx4 v[100:103], v4, s[16:19], s52 offen offset:1024 sc1
MAV 88,24,116
TR 56,6,25408
MAV 92,28,116
TR 58,6,25920
TR 60,6,25440
MAV 76,28,112
TR 62,6,25952
s_waitcnt vmcnt(20) lgkmcnt(8)
MAV 32,32,120
TR 0,7,33792
s_add_u32 m0, s55, 76032
MAV 48,32,124
buffer_load_dwordx4 v18, s[28:31], s54 offen lds
MAV 52,36,124
TR 2,7,34304
TR 4,7,33824
MAV 36,36,120
TR 6,7,34336
s_add_u32 s52, s76, 98304
MAV 40,40,120
buffer_load_dwordx4 v[104:107], v4, s[16:19], s52 offen sc1
MAV 56,40,124
TR 8,7,33856
MAV 60,44,124
TR 10,7,34368
TR 12,7,33888
MAV 44,44,120
.Lpad9:
s_cbranch_execz .Lnopoll36r
TR 14,7,34400
s_waitcnt lgkmcnt(8)
MAV 64,48,120
buffer_load_dwordx4 v19, s[28:31], s54 offen offset:1056 lds
MAV 80,48,124
s_add_u32 s54, s99, 2424832
MAV 84,52,124
TR 16,6,33792
TR 18,6,34304
MAV 68,52,120
TR 20,6,33824
TR 22,6,34336
MAV 72,56,120
buffer_load_dwordx4 v[108:111], v4, s[16:19], s52 offen offset:1024 sc1
MAV 88,56,124
TR 24,6,33856
MAV 92,60,124
TR 26,6,34368
TR 28,6,33888
MAV 76,60,120
TR 30,6,34400
s_waitcnt vmcnt(20) lgkmcnt(8)
s_barrier
MAV 32,0,128
TR 32,7,42240
s_add_u32 m0, s55, 84480
MAV 48,0,132
buffer_load_dwordx4 v18, s[28:31], s54 offen lds
MAV 52,4,132
TR 34,7,42752
TR 36,7,42272
MAV 36,4,128
TR 38,7,42784
s_add_u32 s52, s77, 147456
MAV 40,8,128
buffer_load_dwordx4 v[112:115], v4, s[16:19], s52 offen sc1
MAV 56,8,132
TR 40,7,42304
MAV 60,12,132
TR 42,7,42816
TR 44,7,42336
MAV 44,12,128
TR 46,7,42848
s_waitcnt lgkmcnt(8)
MAV 64,16,128
buffer_load_dwordx4 v19, s[28:31], s54 offen offset:1056 lds
MAV 80,16,132
s_add_u32 s54, s99, 2686976
MAV 84,20,132
TR 48,6,42240
TR 50,6,42752
MAV 68,20,128
TR 52,6,42272
TR 54,6,42784
MAV 72,24,128
buffer_load_dwordx4 v[116:119], v4, s[16:19], s52 offen offset:1024 sc1
MAV 88,24,132
TR 56,6,42304
MAV 92,28,132
TR 58,6,42816
TR 60,6,42336
MAV 76,28,128
TR 62,6,42848
s_waitcnt vmcnt(20) lgkmcnt(8)
MAV 32,32,136
TR 0,7,50688
s_add_u32 m0, s55, 92928
MAV 48,32,140
buffer_load_dwordx4 v18, s[28:31], s54 offen lds
MAV 52,36,140
TR 2,7,51200
TR 4,7,50720
MAV 36,36,136
TR 6,7,51232
s_add_u32 s52, s77, 212992
MAV 40,40,136
buffer_load_dwordx4 v[120:123], v4, s[16:19], s52 offen sc1
MAV 56,40,140
TR 8,7,50752
MAV 60,44,140
TR 10,7,51264
TR 12,7,50784
MAV 44,44,136
TR 14,7,51296
s_waitcnt lgkmcnt(8)
MAV 64,48,136
buffer_load_dwordx4 v19, s[28:31], s54 offen offset:1056 lds
MAV 80,48,140
s_add_u32 s54, s100, 2883584
MAV 84,52,140
TR 16,6,50688
TR 18,6,51200
MAV 68,52,136
TR 20,6,50720
TR 22,6,51232
MAV 72,56,136
buffer_load_dwordx4 v[124:127], v4, s[16:19], s52 offen offset:1024 sc1
MAV 88,56,140
TR 24,6,50752
MAV 92,60,140
TR 26,6,51264
TR 28,6,50784
MAV 76,60,136
TR 30,6,51296
s_waitcnt vmcnt(20) lgkmcnt(8)
s_barrier
MAV 32,0,144
TR 32,7,59136
s_add_u32 m0, s55, 101376
MAV 48,0,148
buffer_load_dwordx4 v18, s[28:31], s54 offen lds
MAV 52,4,148
TR 34,7,59648
TR 36,7,59168
MAV 36,4,144
TR 38,7,59680
s_add_u32 s52, s78, 262144
MAV 40,8,144
buffer_load_dwordx4 v[128:131], v4, s[16:19], s52 offen sc1
MAV 56,8,148
TR 40,7,59200
MAV 60,12,148
TR 42,7,59712
TR 44,7,59232
MAV 44,12,144
TR 46,7,59744
s_waitcnt lgkmcnt(8)
MAV 64,16,144
buffer_load_dwordx4 v19, s[28:31], s54 offen offset:1056 lds
MAV 80,16,148
s_add_u32 s54, s100, 3145728
MAV 84,20,148
TR 48,6,59136
TR 50,6,59648
MAV 68,20,144
TR 52,6,59168
TR 54,6,59680
MAV 72,24,144
buffer_load_dwordx4 v[132:135], v4, s[16:19], s52 offen offset:1024 sc1
MAV 88,24,148
TR 56,6,59200
MAV 92,28,148
TR 58,6,59712
TR 60,6,59232
MAV 76,28,144
TR 62,6,59744
v_add_u32 v7, s57, v7
v_add_u32 v6, s57, v6
s_sub_u32 s57, 0, s57
s_waitcnt vmcnt(20) lgkmcnt(8)
MAV 32,32,152
ds_read_b64_tr_b16 a[0:1], v7
s_add_u32 m0, s55, 109824
MAV 48,32,156
buffer_load_dwordx4 v18, s[28:31], s54 offen lds
MAV 52,36,156
TR 2,7,512
TR 4,7,32
MAV 36,36,152
TR 6,7,544
s_add_u32 s52, s78, 327680
MAV 40,40,152
buffer_load_dwordx4 v[136:139], v4, s[16:19], s52 offen sc1
MAV 56,40,156
TR 8,7,64
MAV 60,44,156
TR 10,7,576
TR 12,7,96
MAV 44,44,152
TR 14,7,608
s_waitcnt lgkmcnt(8)
MAV 64,48,152
buffer_load_dwordx4 v19, s[28:31], s54 offen offset:1056 lds
MAV 80,48,156
s_add_u32 s54, s101, 3342336
MAV 84,52,156
ds_read_b64_tr_b16 a[16:17], v6
TR 18,6,512
MAV 68,52,152
TR 20,6,32
TR 22,6,544
MAV 72,56,152
buffer_load_dwordx4 v[140:143], v4, s[16:19], s52 offen offset:1024 sc1
MAV 88,56,156
TR 24,6,64
MAV 92,60,156
TR 26,6,576
TR 28,6,96
MAV 76,60,152
TR 30,6,608
s_waitcnt vmcnt(20) lgkmcnt(8)
s_barrier
MAV 32,0,96
TR 32,7,8448
s_add_u32 m0, s55, 118272
MAV 48,0,100
buffer_load_dwordx4 v18, s[28:31], s54 offen lds
MAV 52,4,100
TR 34,7,8960
TR 36,7,8480
MAV 36,4,96
TR 38,7,8992
s_add_u32 s52, s79, 376832
MAV 40,8,96
buffer_load_dwordx4 v[144:147], v4, s[16:19], s52 offen sc1
MAV 56,8,100
TR 40,7,8512
MAV 60,12,100
TR 42,7,9024
TR 44,7,8544
MAV 44,12,96
TR 46,7,9056
s_waitcnt lgkmcnt(8)
MAV 64,16,96
buffer_load_dwordx4 v19, s[28:31], s54 offen offset:1056 lds
MAV 80,16,100
s_add_u32 s54, s101, 3604480
MAV 84,20,100
TR 48,6,8448
TR 50,6,8960
MAV 68,20,96
TR 52,6,8480
TR 54,6,8992
MAV 72,24,96
buffer_load_dwordx4 v[148:151], v4, s[16:19], s52 offen offset:1024 sc1
MAV 88,24,100
TR 56,6,8512
MAV 92,28,100
TR 58,6,9024
TR 60,6,8544
MAV 76,28,96
TR 62,6,9056
s_waitcnt vmcnt(20) lgkmcnt(8)
MAV 32,32,104
TR 0,7,16896
s_add_u32 m0, s55, 126720
MAV 48,32,108
buffer_load_dwordx4 v18, s[28:31], s54 offen lds
MAV 52,36,108
TR 2,7,17408
TR 4,7,16928
MAV 36,36,104
TR 6,7,17440
s_add_u32 s52, s79, 442368
MAV 40,40,104
buffer_load_dwordx4 v[152:155], v4, s[16:19], s52 offen sc1
MAV 56,40,108
TR 8,7,16960
MAV 60,44,108
TR 10,7,17472
TR 12,7,16992
MAV 44,44,104
TR 14,7,17504
s_waitcnt lgkmcnt(8)
MAV 64,48,104
buffer_load_dwordx4 v19, s[28:31], s54 offen offset:1056 lds
MAV 80,48,108
s_add_u32 s54, s98, 196608
MAV 84,52,108
TR 16,6,16896
TR 18,6,17408
MAV 68,52,104
TR 20,6,16928
TR 22,6,17440
MAV 72,56,104
buffer_load_dwordx4 v[156:159], v4, s[16:19], s52 offen offset:1024 sc1
MAV 88,56,108
TR 24,6,16960
MAV 92,60,108
TR 26,6,17472
TR 28,6,16992
MAV 76,60,104
TR 30,6,17504
s_waitcnt vmcnt(20) lgkmcnt(8)
s_barrier
MAV 32,0,112
TR 32,7,25344
s_add_u32 m0, s55, 0
MAV 48,0,116
buffer_load_dwordx4 v18, s[28:31], s54 offen lds
MAV 52,4,116
TR 34,7,25856
TR 36,7,25376
MAV 36,4,112
TR 38,7,25888
s_add_u32 s52, s76, 491520
MAV 40,8,112
buffer_load_dwordx4 v[96:99], v4, s[16:19], s52 offen sc1
MAV 56,8,116
TR 40,7,25408
MAV 60,12,116
TR 42,7,25920
TR 44,7,25440
MAV 44,12,112
TR 46,7,25952
s_waitcnt lgkmcnt(8)
MAV 64,16,112
buffer_load_dwordx4 v19, s[28:31], s54 offen offset:1056 lds
MAV 80,16,116
s_add_u32 s54, s99, 655360
MAV 84,20,116
TR 48,6,25344
TR 50,6,25856
MAV 68,20,112
TR 52,6,25376
TR 54,6,25888
MAV 72,24,112
buffer_load_dwordx4 v[100:103], v4, s[16:19], s52 offen offset:1024 sc1
MAV 88,24,116
TR 56,6,25408
MAV 92,28,116
TR 58,6,25920
TR 60,6,25440
MAV 76,28,112
TR 62,6,25952
s_waitcnt vmcnt(20) lgkmcnt(8)
MAV 32,32,120
TR 0,7,33792
s_add_u32 m0, s55, 8448
MAV 48,32,124
buffer_load_dwordx4 v18, s[28:31], s54 offen lds
MAV 52,36,124
TR 2,7,34304
TR 4,7,33824
MAV 36,36,120
TR 6,7,34336
s_add_u32 s52, s76, 557056
MAV 40,40,120
buffer_load_dwordx4 v[104:107], v4, s[16:19], s52 offen sc1
MAV 56,40,124
TR 8,7,33856
MAV 60,44,124
TR 10,7,34368
TR 12,7,33888
MAV 44,44,120
TR 14,7,34400
s_waitcnt lgkmcnt(8)
MAV 64,48,120
buffer_load_dwordx4 v19, s[28:31], s54 offen offset:1056 lds
MAV 80,48,124
s_add_u32 s54, s100, 1114112
MAV 84,52,124
TR 16,6,33792
TR 18,6,34304
MAV 68,52,120
TR 20,6,33824
TR 22,6,34336
MAV 72,56,120
buffer_load_dwordx4 v[108:111], v4, s[16:19], s52 offen offset:1024 sc1
MAV 88,56,124
TR 24,6,33856
MAV 92,60,124
TR 26,6,34368
TR 28,6,33888
MAV 76,60,120
TR 30,6,34400
s_waitcnt vmcnt(20) lgkmcnt(8)
s_barrier
MAV 32,0,128
TR 32,7,42240
s_add_u32 m0, s55, 16896
MAV 48,0,132
buffer_load_dwordx4 v18, s[28:31], s54 offen lds
MAV 52,4,132
TR 34,7,42752
TR 36,7,42272
MAV 36,4,128
TR 38,7,42784
s_add_u32 s52, s77, 606208
MAV 40,8,128
buffer_load_dwordx4 v[112:115], v4, s[16:19], s52 offen sc1
MAV 56,8,132
TR 40,7,42304
MAV 60,12,132
TR 42,7,42816
TR 44,7,42336
MAV 44,12,128
TR 46,7,42848
s_waitcnt lgkmcnt(8)
MAV 64,16,128
buffer_load_dwordx4 v19, s[28:31], s54 offen offset:1056 lds
MAV 80,16,132
s_add_u32 s54, s101, 1572864
MAV 84,20,132
TR 48,6,42240
TR 50,6,42752
MAV 68,20,128
TR 52,6,42272
TR 54,6,42784
MAV 72,24,128
buffer_load_dwordx4 v[116:119], v4, s[16:19], s52 offen offset:1024 sc1
MAV 88,24,132
TR 56,6,42304
MAV 92,28,132
TR 58,6,42816
TR 60,6,42336
MAV 76,28,128
TR 62,6,42848
s_waitcnt vmcnt(20) lgkmcnt(8)
MAV 32,32,136
TR 0,7,50688
s_add_u32 m0, s55, 25344
MAV 48,32,140
buffer_load_dwordx4 v18, s[28:31], s54 offen lds
MAV 52,36,140
TR 2,7,51200
TR 4,7,50720
MAV 36,36,136
TR 6,7,51232
s_add_u32 s52, s77, 671744
MAV 40,40,136
buffer_load_dwordx4 v[120:123], v4, s[16:19], s52 offen sc1
MAV 56,40,140
TR 8,7,50752
MAV 60,44,140
TR 10,7,51264
TR 12,7,50784
MAV 44,44,136
TR 14,7,51296
s_waitcnt lgkmcnt(8)
MAV 64,48,136
buffer_load_dwordx4 v19, s[28:31], s54 offen offset:1056 lds
MAV 80,48,140
s_add_u32 s54, s98, 2031616
MAV 84,52,140
TR 16,6,50688
TR 18,6,51200
MAV 68,52,136
TR 20,6,50720
TR 22,6,51232
MAV 72,56,136
buffer_load_dwordx4 v[124:127], v4, s[16:19], s52 offen offset:1024 sc1
MAV 88,56,140
TR 24,6,50752
MAV 92,60,140
TR 26,6,51264
TR 28,6,50784
MAV 76,60,136
TR 30,6,51296
s_waitcnt vmcnt(20) lgkmcnt(8)
s_barrier
MAV 32,0,144
TR 32,7,59136
s_add_u32 m0, s55, 33792
MAV 48,0,148
buffer_load_dwordx4 v18, s[28:31], s54 offen lds
MAV 52,4,148
TR 34,7,59648
TR 36,7,59168
MAV 36,4,144
TR 38,7,59680
s_add_u32 s52, s78, 720896
MAV 40,8,144
buffer_load_dwordx4 v[128:131], v4, s[16:19], s52 offen sc1
MAV 56,8,148
TR 40,7,59200
MAV 60,12,148
TR 42,7,59712
TR 44,7,59232
MAV 44,12,144
TR 46,7,59744
s_waitcnt lgkmcnt(8)
MAV 64,16,144
buffer_load_dwordx4 v19, s[28:31], s54 offen offset:1056 lds
MAV 80,16,148
s_add_u32 s54, s99, 2490368
MAV 84,20,148
TR 48,6,59136
TR 50,6,59648
MAV 68,20,144
TR 52,6,59168
TR 54,6,59680
MAV 72,24,144
buffer_load_dwordx4 v[132:135], v4, s[16:19], s52 offen offset:1024 sc1
MAV 88,24,148
TR 56,6,59200
MAV 92,28,148
TR 58,6,59712
TR 60,6,59232
MAV 76,28,144
TR 62,6,59744
v_add_u32 v7, s57, v7
v_add_u32 v6, s57, v6
s_sub_u32 s57, 0, s57
s_waitcnt vmcnt(20) lgkmcnt(8)
MAV 32,32,152
ds_read_b64_tr_b16 a[0:1], v6
s_add_u32 m0, s55, 42240
MAV 48,32,156
buffer_load_dwordx4 v18, s[28:31], s54 offen lds
MAV 52,36,156
TR 2,6,512
TR 4,6,32
MAV 36,36,152
TR 6,6,544
s_add_u32 s52, s78, 786432
MAV 40,40,152
buffer_load_dwordx4 v[136:139], v4, s[16:19], s52 offen sc1
MAV 56,40,156
TR 8,6,64
MAV 60,44,156
TR 10,6,576
TR 12,6,96
MAV 44,44,152
TR 14,6,608
s_waitcnt lgkmcnt(8)
MAV 64,48,152
buffer_load_dwordx4 v19, s[28:31], s54 offen offset:1056 lds
MAV 80,48,156
s_add_u32 s54, s100, 2949120
MAV 84,52,156
TR 16,6,8448
TR 18,6,8960
MAV 68,52,152
TR 20,6,8480
TR 22,6,8992
MAV 72,56,152
buffer_load_dwordx4 v[140:143], v4, s[16:19], s52 offen offset:1024 sc1
MAV 88,56,156
TR 24,6,8512
MAV 92,60,156
TR 26,6,9024
TR 28,6,8544
MAV 76,60,152
TR 30,6,9056
s_waitcnt vmcnt(20) lgkmcnt(8)
s_barrier
MAV 64,0,96
TR 32,6,16896
TR 34,6,17408
s_add_u32 m0, s55, 50688
.Lpad10:
s_cbranch_execz .Lnopoll36r
MAV 80,0,100
TR 36,6,16928
buffer_load_dwordx4 v18, s[28:31], s54 offen lds
MAV 84,4,100
buffer_load_dwordx4 v19, s[28:31], s54 offen offset:1056 lds
MAV 68,4,96
TR 38,6,17440
s_add_u32 s54, s101, 3407872
s_add_u32 s52, s79, 835584
MAV 72,8,96
TR 40,6,16960
buffer_load_dwordx4 v[144:147], v4, s[16:19], s52 offen sc1
MAV 88,8,100
TR 42,6,17472
MAV 92,12,100
TR 44,6,16992
buffer_load_dwordx4 v[148:151], v4, s[16:19], s52 offen offset:1024 sc1
MAV 76,12,96
TR 46,6,17504
s_add_u32 m0, s55, 59136
s_waitcnt vmcnt(20) lgkmcnt(8)
MAV 64,16,104
buffer_load_dwordx4 v18, s[28:31], s54 offen lds
MAV 80,16,108
TR 48,6,25344
TR 50,6,25856
MAV 84,20,108
TR 52,6,25376
buffer_load_dwordx4 v19, s[28:31], s54 offen offset:1056 lds
MAV 68,20,104
TR 54,6,25888
s_add_u32 s52, s79, 901120
MAV 72,24,104
TR 56,6,25408
buffer_load_dwordx4 v[152:155], v4, s[16:19], s52 offen sc1
MAV 88,24,108
TR 58,6,25920
MAV 92,28,108
TR 60,6,25440
buffer_load_dwordx4 v[156:159], v4, s[16:19], s52 offen offset:1024 sc1
MAV 76,28,104
TR 62,6,25952
s_waitcnt vmcnt(20) lgkmcnt(8)
MAV 64,32,112
TR 0,6,33792
s_add_u32 s52, s76, 49152
s_lshl_b32 s70, s2, 10
MAV 80,32,116
buffer_load_dwordx4 v[160:163], v4, s[16:19], s52 offen sc1
s_lshl_b32 s62, s3, 7
MAV 84,36,116
TR 2,6,34304
TR 4,6,33824
MAV 68,36,112
TR 6,6,34336
s_add_u32 s70, s70, s62
s_add_u32 s70, s70, 31457280
MAV 72,40,112
buffer_load_dwordx4 v[164:167], v4, s[16:19], s52 offen offset:1024 sc1
s_xor_b32 s71, s70, 1024
MAV 88,40,116
TR 8,6,33856
TR 10,6,34368
MAV 92,44,116
TR 12,6,33888
v_min_u32 v12, 1, v1
v_lshlrev_b32 v12, 28, v12
MAV 76,44,112
TR 14,6,34400
s_add_u32 s52, s77, 163840
s_waitcnt vmcnt(18) lgkmcnt(8)
MAV 64,48,120
buffer_load_dwordx4 v[168:171], v4, s[16:19], s52 offen sc1
v_mov_b32 v13, 1
MAV 80,48,124
TR 16,6,42240
v_mov_b32 v15, 0
s_lshl_b32 s68, s7, 15
MAV 84,52,124
TR 18,6,42752
TR 20,6,42272
MAV 68,52,120
TR 22,6,42784
s_add_u32 s68, s68, 33554432
s_xor_b32 s69, s68, 32768
MAV 72,56,120
buffer_load_dwordx4 v[172:175], v4, s[16:19], s52 offen offset:1024 sc1
v_mov_b32 v11, v4
MAV 88,56,124
TR 24,6,42304
TR 26,6,42816
MAV 92,60,124
TR 28,6,42336
v_and_b32 v2, 1, v1
v_lshlrev_b32 v2, 4, v2
MAV 76,60,120
TR 30,6,42848
v_mov_b32 v224, 0x3f80
s_waitcnt vmcnt(16) lgkmcnt(8)
MAV 64,0,128
TR 32,6,50688
s_add_u32 s52, s78, 278528
v_lshlrev_b32 v2, v2, v224
MAV 80,0,132
buffer_load_dwordx4 v[176:179], v4, s[16:19], s52 offen sc1
v_bfe_u32 v224, v1, 2, 2
MAV 84,4,132
TR 34,6,51200
TR 36,6,50720
MAV 68,4,128
TR 38,6,51232
v_lshrrev_b32 v225, 4, v1
v_cmp_eq_u32 vcc, v224, v225
MAV 72,8,128
buffer_load_dwordx4 v[180:183], v4, s[16:19], s52 offen offset:1024 sc1
v_cndmask_b32 v2, 0, v2, vcc
MAV 88,8,132
TR 40,6,50752
TR 42,6,51264
MAV 92,12,132
TR 44,6,50784
v_and_b32 v224, 2, v1
v_cmp_eq_u32 vcc, 0, v224
MAV 76,12,128
TR 46,6,51296
s_add_u32 s52, s79, 393216
s_waitcnt vmcnt(14) lgkmcnt(8)
MAV 64,16,136
buffer_load_dwordx4 v[184:187], v4, s[16:19], s52 offen sc1
v_cndmask_b32 v226, 0, v2, vcc
MAV 80,16,140
TR 48,6,59136
v_cndmask_b32 v227, v2, 0, vcc
v_mov_b32 v224, 0
MAV 84,20,140
TR 50,6,59648
TR 52,6,59168
MAV 68,20,136
TR 54,6,59680
v_mov_b32 v225, 0
v_mov_b32 v228, 0
MAV 72,24,136
buffer_load_dwordx4 v[188:191], v4, s[16:19], s52 offen offset:1024 sc1
v_mov_b32 v229, 0
MAV 88,24,140
TR 56,6,59200
TR 58,6,59712
MAV 92,28,140
TR 60,6,59232
v_bfe_u32 v18, v1, 3, 1
v_lshrrev_b32 v2, 4, v1
MAV 76,28,136
TR 62,6,59744
v_lshl_add_u32 v18, v2, 3, v18
s_waitcnt vmcnt(10) lgkmcnt(8)
s_barrier
v_add_u32 v6, s57, v6
MAV 64,32,144
ds_read_b64_tr_b16 a[0:1], v6
s_add_u32 s52, s76, 507904
s_lshl_b32 s62, s3, 1
MAV 80,32,148
buffer_load_dwordx4 v[192:195], v4, s[16:19], s52 offen sc1
v_add_u32 v18, s62, v18
MAV 84,36,148
TR 2,6,512
TR 4,6,32
MAV 68,36,144
TR 6,6,544
v_mul_u32_u24 v18, 6144, v18
v_and_b32 v2, 7, v1
MAV 72,40,144
buffer_load_dwordx4 v[196:199], v4, s[16:19], s52 offen offset:1024 sc1
v_lshl_add_u32 v18, v2, 4, v18
MAV 88,40,148
TR 8,6,64
TR 10,6,576
MAV 92,44,148
TR 12,6,96
s_lshl_b32 s62, s9, 7
v_add_u32 v18, s62, v18
MAV 76,44,144
TR 14,6,608
s_add_u32 s52, s77, 622592
s_waitcnt vmcnt(10) lgkmcnt(8)
MAV 64,48,152
buffer_load_dwordx4 v[200:203], v4, s[16:19], s52 offen sc1
v_add_u32 v19, 1024, v18
MAV 80,48,156
TR 16,6,8448
v_add_u32 v20, 2048, v18
s_mul_i32 s59, s3, 3104
MAV 84,52,156
TR 18,6,8960
TR 20,6,8480
MAV 68,52,152
TR 22,6,8992
s_mov_b32 s58, 0
v_accvgpr_read_b32 v28, a224
MAV 72,56,152
buffer_load_dwordx4 v[204:207], v4, s[16:19], s52 offen offset:1024 sc1
v_add_f32 v32, v32, v28
MAV 88,56,156
TR 24,6,8512
TR 26,6,9024
MAV 92,60,156
TR 28,6,8544
v_accvgpr_read_b32 v29, a225
v_add_f32 v33, v33, v29
MAV 76,60,152
TR 30,6,9056
v_accvgpr_read_b32 v28, a226
s_waitcnt vmcnt(10) lgkmcnt(8)
MAV 64,0,160
TR 32,6,16896
s_add_u32 s52, s78, 737280
v_add_f32 v34, v34, v28
MAV 80,0,164
buffer_load_dwordx4 v[208:211], v4, s[16:19], s52 offen sc1
v_accvgpr_read_b32 v29, a227
MAV 84,4,164
TR 34,6,17408
TR 36,6,16928
MAV 68,4,160
TR 38,6,17440
v_add_f32 v35, v35, v29
v_accvgpr_read_b32 v28, a228
MAV 72,8,160
buffer_load_dwordx4 v[212:215], v4, s[16:19], s52 offen offset:1024 sc1
v_add_f32 v36, v36, v28
MAV 88,8,164
TR 40,6,16960
TR 42,6,17472
MAV 92,12,164
TR 44,6,16992
v_accvgpr_read_b32 v29, a229
v_add_f32 v37, v37, v29
MAV 76,12,160
TR 46,6,17504
s_add_u32 s52, s79, 851968
s_waitcnt vmcnt(10) lgkmcnt(8)
MAV 64,16,168
buffer_load_dwordx4 v[216:219], v4, s[16:19], s52 offen sc1
v_accvgpr_read_b32 v28, a230
MAV 80,16,172
TR 48,6,25344
v_add_f32 v38, v38, v28
v_accvgpr_read_b32 v29, a231
MAV 84,20,172
TR 50,6,25856
TR 52,6,25376
MAV 68,20,168
TR 54,6,25888
v_add_f32 v39, v39, v29
v_accvgpr_read_b32 v28, a232
MAV 72,24,168
buffer_load_dwordx4 v[220:223], v4, s[16:19], s52 offen offset:1024 sc1
v_add_f32 v40, v40, v28
MAV 88,24,172
TR 56,6,25408
TR 58,6,25920
MAV 92,28,172
TR 60,6,25440
v_accvgpr_read_b32 v29, a233
v_add_f32 v41, v41, v29
MAV 76,28,168
TR 62,6,25952
v_accvgpr_read_b32 v28, a234
s_waitcnt vmcnt(10) lgkmcnt(8)
MAV 64,32,176
TR 0,6,33792
v_add_f32 v42, v42, v28
v_accvgpr_read_b32 v29, a235
MAV 80,32,180
TR 2,6,34304
v_add_f32 v43, v43, v29
MAV 84,36,180
TR 4,6,33824
v_accvgpr_read_b32 v28, a236
MAV 68,36,176
TR 6,6,34336
v_add_f32 v44, v44, v28
MAV 72,40,176
TR 8,6,33856
v_accvgpr_read_b32 v29, a237
MAV 88,40,180
TR 10,6,34368
v_add_f32 v45, v45, v29
MAV 92,44,180
TR 12,6,33888
v_accvgpr_read_b32 v28, a238
MAV 76,44,176
TR 14,6,34400
s_waitcnt vmcnt(8) lgkmcnt(8)
MAV 64,48,184
TR 16,6,42240
v_add_f32 v46, v46, v28
MAV 80,48,188
TR 18,6,42752
v_accvgpr_read_b32 v29, a239
MAV 84,52,188
TR 20,6,42272
v_add_f32 v47, v47, v29
MAV 68,52,184
TR 22,6,42784
v_accvgpr_read_b32 v28, a240
MAV 72,56,184
TR 24,6,42304
v_add_f32 v48, v48, v28
MAV 88,56,188
TR 26,6,42816
v_accvgpr_read_b32 v29, a241
MAV 92,60,188
TR 28,6,42336
v_add_f32 v49, v49, v29
MAV 76,60,184
TR 30,6,42848
v_accvgpr_read_b32 v28, a242
s_waitcnt vmcnt(6) lgkmcnt(8)
MAV 64,0,192
TR 32,6,50688
v_add_f32 v50, v50, v28
v_accvgpr_read_b32 v29, a243
MAV 80,0,196
TR 34,6,51200
v_add_f32 v51, v51, v29
MAV 84,4,196
TR 36,6,50720
v_accvgpr_read_b32 v28, a244
MAV 68,4,192
TR 38,6,51232
v_add_f32 v52, v52, v28
MAV 72,8,192
TR 40,6,50752
v_accvgpr_read_b32 v29, a245
MAV 88,8,196
TR 42,6,51264
v_add_f32 v53, v53, v29
MAV 92,12,196
TR 44,6,50784
v_accvgpr_read_b32 v28, a246
MAV 76,12,192
TR 46,6,51296
s_waitcnt vmcnt(4) lgkmcnt(8)
MAV 64,16,200
TR 48,6,59136
v_add_f32 v54, v54, v28
MAV 80,16,204
TR 50,6,59648
v_accvgpr_read_b32 v29, a247
MAV 84,20,204
TR 52,6,59168
v_add_f32 v55, v55, v29
MAV 68,20,200
TR 54,6,59680
v_accvgpr_read_b32 v28, a248
MAV 72,24,200
TR 56,6,59200
v_add_f32 v56, v56, v28
MAV 88,24,204
TR 58,6,59712
v_accvgpr_read_b32 v29, a249
MAV 92,28,204
TR 60,6,59232
v_add_f32 v57, v57, v29
MAV 76,28,200
TR 62,6,59744
v_accvgpr_read_b32 v28, a250
s_waitcnt vmcnt(2) lgkmcnt(8)
MAV 64,32,208
ds_read_b64_tr_b16 a[0:1], v7
v_add_f32 v58, v58, v28
MAV 80,32,212
TR 2,7,512
v_accvgpr_read_b32 v29, a251
MAV 84,36,212
TR 4,7,32
v_add_f32 v59, v59, v29
MAV 68,36,208
TR 6,7,544
MAV 72,40,208
TR 8,7,64
v_accvgpr_read_b32 v28, a252
MAV 88,40,212
TR 10,7,576
v_add_f32 v60, v60, v28
MAV 92,44,212
TR 12,7,96
v_accvgpr_read_b32 v29, a253
MAV 76,44,208
TR 14,7,608
s_waitcnt vmcnt(0) lgkmcnt(8)
MAV 64,48,216
TR 16,7,8448
MAV 80,48,220
TR 18,7,8960
v_add_f32 v61, v61, v29
MAV 84,52,220
TR 20,7,8480
v_accvgpr_read_b32 v28, a254
MAV 68,52,216
TR 22,7,8992
v_add_f32 v62, v62, v28
MAV 72,56,216
TR 24,7,8512
MAV 88,56,220
TR 26,7,9024
v_accvgpr_read_b32 v29, a255
MAV 92,60,220
TR 28,7,8544
v_add_f32 v63, v63, v29
MAV 76,60,216
TR 30,7,9056
s_waitcnt lgkmcnt(8)
MAV 32,0,96
TR 32,7,16896
v_cvt_pk_bf16_f32 v232, v64, v65
v_cvt_pk_bf16_f32 v233, v66, v67
MAV 48,0,100
TR 34,7,17408
v_cvt_pk_bf16_f32 v234, v68, v69
MAV 52,4,100
TR 36,7,16928
v_cvt_pk_bf16_f32 v235, v70, v71
buffer_store_dwordx4 v[232:235], v11, s[16:19], s69 offen sc1
MAV 36,4,96
TR 38,7,17440
s_add_u32 s69, s69, 16384
MAV 40,8,96
TR 40,7,16960
v_cvt_pk_bf16_f32 v236, v72, v73
v_cvt_pk_bf16_f32 v237, v74, v75
MAV 56,8,100
TR 42,7,17472
v_cvt_pk_bf16_f32 v238, v76, v77
MAV 60,12,100
TR 44,7,16992
v_cvt_pk_bf16_f32 v239, v78, v79
buffer_store_dwordx4 v[236:239], v11, s[16:19], s69 offen sc1
MAV 44,12,96
TR 46,7,17504
s_add_u32 s69, s69, -15360
s_waitcnt lgkmcnt(8)
MAV 32,16,104
TR 48,7,25344
v_cvt_pk_bf16_f32 v240, v80, v81
MAV 48,16,108
TR 50,7,25856
v_cvt_pk_bf16_f32 v241, v82, v83
v_cvt_pk_bf16_f32 v242, v84, v85
MAV 52,20,108
TR 52,7,25376
v_cvt_pk_bf16_f32 v243, v86, v87
MAV 36,20,104
TR 54,7,25888
buffer_store_dwordx4 v[240:243], v11, s[16:19], s69 offen sc1
s_add_u32 s69, s69, 16384
MAV 40,24,104
TR 56,7,25408
v_cvt_pk_bf16_f32 v244, v88, v89
MAV 56,24,108
TR 58,7,25920
v_cvt_pk_bf16_f32 v245, v90, v91
v_cvt_pk_bf16_f32 v246, v92, v93
MAV 60,28,108
TR 60,7,25440
v_cvt_pk_bf16_f32 v247, v94, v95
MAV 44,28,104
TR 62,7,25952
buffer_store_dwordx4 v[244:247], v11, s[16:19], s69 offen sc1
s_waitcnt lgkmcnt(8)
MAV 32,32,112
TR 0,7,33792
MAV 48,32,116
TR 2,7,34304
MAV 52,36,116
TR 4,7,33824
MAV 36,36,112
TR 6,7,34336
MAV 40,40,112
TR 8,7,33856
MAV 56,40,116
TR 10,7,34368
MAV 60,44,116
TR 12,7,33888
MAV 44,44,112
TR 14,7,34400
s_waitcnt lgkmcnt(8)
MAV 32,48,120
TR 16,7,42240
MAV 48,48,124
TR 18,7,42752
MAV 52,52,124
TR 20,7,42272
MAV 36,52,120
TR 22,7,42784
MAV 40,56,120
TR 24,7,42304
MAV 56,56,124
TR 26,7,42816
MAV 60,60,124
TR 28,7,42336
MAV 44,60,120
TR 30,7,42848
s_waitcnt lgkmcnt(8)
MAV 32,0,128
TR 32,7,50688
MAV 48,0,132
TR 34,7,51200
MAV 52,4,132
TR 36,7,50720
MAV 36,4,128
TR 38,7,51232
MAV 40,8,128
TR 40,7,50752
MAV 56,8,132
TR 42,7,51264
MAV 60,12,132
TR 44,7,50784
MAV 44,12,128
TR 46,7,51296
s_waitcnt lgkmcnt(8)
MAV 32,16,136
TR 48,7,59136
MAV 48,16,140
TR 50,7,59648
MAV 52,20,140
TR 52,7,59168
MAV 36,20,136
TR 54,7,59680
MAV 40,24,136
TR 56,7,59200
MAV 56,24,140
TR 58,7,59712
MAV 60,28,140
TR 60,7,59232
MAV 44,28,136
TR 62,7,59744
v_add_u32 v7, s57, v7
s_waitcnt lgkmcnt(8)
MAV 32,32,144
ds_read_b64_tr_b16 a[0:1], v7
TR 2,7,512
MAV 48,32,148
s_waitcnt vmcnt(0)
buffer_atomic_add v13, v12, s[16:19], s71 offen
MAV 52,36,148
TR 4,7,32
MAV 36,36,144
TR 6,7,544
MAV 40,40,144
TR 8,7,64
MAV 56,40,148
TR 10,7,576
MAV 60,44,148
.Lpad11:
s_cbranch_execz .Lnopoll36r
TR 12,7,96
MAV 44,44,144
TR 14,7,608
s_waitcnt lgkmcnt(8)
MAV 32,48,152
TR 16,7,8448
MAV 48,48,156
TR 18,7,8960
MAV 52,52,156
TR 20,7,8480
MAV 36,52,152
TR 22,7,8992
MAV 40,56,152
TR 24,7,8512
MAV 56,56,156
TR 26,7,9024
MAV 60,60,156
TR 28,7,8544
MAV 44,60,152
TR 30,7,9056
s_waitcnt lgkmcnt(8)
s_barrier
MAV 32,0,160
TR 32,7,16896
TR 34,7,17408
MAV 48,0,164
buffer_atomic_add v15, v12, s[16:19], s70 offen sc0
MAV 52,4,164
TR 36,7,16928
TR 38,7,17440
MAV 36,4,160
TR 40,7,16960
s_add_u32 m0, s59, 117248
MAV 40,8,160
buffer_load_dwordx4 v18, s[20:23], s58 offen lds
MAV 56,8,164
TR 42,7,17472
TR 44,7,16992
MAV 60,12,164
TR 46,7,17504
MAV 44,12,160
TR 48,7,25344
s_waitcnt lgkmcnt(9)
MAV 32,16,168
buffer_load_dwordx4 v19, s[20:23], s58 offen offset:1024 lds
MAV 48,16,172
TR 50,7,25856
TR 52,7,25376
MAV 52,20,172
buffer_load_dwordx4 v20, s[20:23], s58 offen offset:2048 lds
MAV 36,20,168
TR 54,7,25888
s_add_u32 s58, s58, 196608
MAV 40,24,168
TR 56,7,25408
s_add_u32 m0, s59, 129664
MAV 56,24,172
buffer_load_dwordx4 v18, s[20:23], s58 offen lds
MAV 60,28,172
TR 58,7,25920
TR 60,7,25440
MAV 44,28,168
TR 62,7,25952
s_waitcnt lgkmcnt(8)
MAV 32,32,176
TR 0,7,33792
TR 2,7,34304
MAV 48,32,180
buffer_load_dwordx4 v19, s[20:23], s58 offen offset:1024 lds
MAV 52,36,180
TR 4,7,33824
MAV 36,36,176
TR 6,7,34336
TR 8,7,33856
MAV 40,40,176
buffer_load_dwordx4 v20, s[20:23], s58 offen offset:2048 lds
MAV 56,40,180
TR 10,7,34368
s_add_u32 s58, s58, 196608
MAV 60,44,180
TR 12,7,33888
MAV 44,44,176
TR 14,7,34400
s_add_u32 m0, s59, 67584
s_waitcnt lgkmcnt(8)
MAV 32,48,184
buffer_load_dwordx4 v18, s[20:23], s58 offen lds
MAV 48,48,188
TR 16,7,42240
MAV 52,52,188
TR 18,7,42752
TR 20,7,42272
MAV 36,52,184
TR 22,7,42784
MAV 40,56,184
buffer_load_dwordx4 v19, s[20:23], s58 offen offset:1024 lds
MAV 56,56,188
TR 24,7,42304
TR 26,7,42816
MAV 60,60,188
TR 28,7,42336
MAV 44,60,184
TR 30,7,42848
s_waitcnt vmcnt(8)
v_cmp_ne_u32 vcc, 0, v15
s_nop 0
s_cbranch_vccz .Lxs50
.Lxs50b:
s_waitcnt lgkmcnt(8)
MAV 32,0,192
TR 32,7,50688
TR 34,7,51200
MAV 48,0,196
TR 36,7,50720
buffer_load_dwordx4 v[232:235], v11, s[16:19], s68 offen sc1
MAV 52,4,196
TR 38,7,51232
s_add_u32 s68, s68, 16384
MAV 36,4,192
TR 40,7,50752
buffer_load_dwordx4 v[236:239], v11, s[16:19], s68 offen sc1
MAV 40,8,192
TR 42,7,51264
s_add_u32 s68, s68, -15360
MAV 56,8,196
TR 44,7,50784
buffer_load_dwordx4 v[240:243], v11, s[16:19], s68 offen sc1
MAV 60,12,196
TR 46,7,51296
s_add_u32 s68, s68, 16384
MAV 44,12,192
buffer_load_dwordx4 v[244:247], v11, s[16:19], s68 offen sc1
s_waitcnt lgkmcnt(8)
MAV 32,16,200
TR 48,7,59136
buffer_load_dwordx4 v20, s[20:23], s58 offen offset:2048 lds
MAV 48,16,204
TR 50,7,59648
s_add_u32 s58, s58, 196608
s_add_u32 m0, s59, 80000
MAV 52,20,204
TR 52,7,59168
buffer_load_dwordx4 v18, s[20:23], s58 offen lds
MAV 36,20,200
TR 54,7,59680
MAV 40,24,200
TR 56,7,59200
buffer_load_dwordx4 v19, s[20:23], s58 offen offset:1024 lds
MAV 56,24,204
TR 58,7,59712
MAV 60,28,204
TR 60,7,59232
buffer_load_dwordx4 v20, s[20:23], s58 offen offset:2048 lds
MAV 44,28,200
TR 62,7,59744
s_add_u32 s58, s58, 196608
s_waitcnt lgkmcnt(8)
MAV 32,32,208
s_add_u32 m0, s59, 92416
MAV 48,32,212
buffer_load_dwordx4 v18, s[20:23], s58 offen lds
MAV 52,36,212
MAV 36,36,208
MAV 40,40,208
MAV 56,40,212
MAV 60,44,212
buffer_load_dwordx4 v19, s[20:23], s58 offen offset:1024 lds
MAV 44,44,208
s_waitcnt lgkmcnt(0)
MAV 32,48,216
MAV 48,48,220
MAV 52,52,220
MAV 36,52,216
buffer_load_dwordx4 v20, s[20:23], s58 offen offset:2048 lds
MAV 40,56,216
s_add_u32 s58, s58, 196608
MAV 56,56,220
MAV 60,60,220
MAV 44,60,216
s_waitcnt vmcnt(10)
v_mfma_f32_16x16x32_bf16 v[32:35], v[226:229], v[232:235], v[32:35]
s_lshl_b32 s64, s6, 14
s_lshl_b32 s65, s49, 13
s_add_u32 s64, s64, s65
v_mfma_f32_16x16x32_bf16 v[36:39], v[224:227], v[232:235], v[36:39]
s_lshl_b32 s65, s7, 9
s_add_u32 s64, s64, s65
s_lshl_b32 s65, s48, 8
s_waitcnt vmcnt(9)
v_mfma_f32_16x16x32_bf16 v[40:43], v[226:229], v[236:239], v[40:43]
s_add_u32 s64, s64, s65
s_add_u32 s64, s64, 62914560
v_and_b32 v152, 31, v1
v_mfma_f32_16x16x32_bf16 v[44:47], v[224:227], v[236:239], v[44:47]
s_lshl_b32 s62, s7, 15
v_lshlrev_b32 v152, 3, v152
v_lshrrev_b32 v153, 5, v1
s_waitcnt vmcnt(8)
v_mfma_f32_16x16x32_bf16 v[48:51], v[226:229], v[240:243], v[48:51]
s_add_u32 s62, s62, 33554432
v_lshl_add_u32 v152, v153, 28, v152
s_add_u32 s63, s62, 16384
v_mfma_f32_16x16x32_bf16 v[52:55], v[224:227], v[240:243], v[52:55]
v_cvt_pk_bf16_f32 v128, v32, v33
v_cvt_pk_bf16_f32 v129, v34, v35
s_waitcnt vmcnt(7)
v_mfma_f32_16x16x32_bf16 v[56:59], v[226:229], v[244:247], v[56:59]
v_cvt_pk_bf16_f32 v130, v36, v37
v_cvt_pk_bf16_f32 v131, v38, v39
v_mfma_f32_16x16x32_bf16 v[60:63], v[224:227], v[244:247], v[60:63]
buffer_store_dwordx4 v[128:131], v4, s[16:19], s62 offen sc1
v_cvt_pk_bf16_f32 v132, v40, v41
v_cvt_pk_bf16_f32 v133, v42, v43
v_cvt_pk_bf16_f32 v134, v44, v45
v_cvt_pk_bf16_f32 v135, v46, v47
v_cvt_pk_bf16_f32 v136, v48, v49
v_cvt_pk_bf16_f32 v137, v50, v51
v_cvt_pk_bf16_f32 v138, v52, v53
v_cvt_pk_bf16_f32 v139, v54, v55
v_cvt_pk_bf16_f32 v140, v56, v57
v_cvt_pk_bf16_f32 v141, v58, v59
v_cvt_pk_bf16_f32 v142, v60, v61
v_cvt_pk_bf16_f32 v143, v62, v63
v_pk_mul_f32 v[146:147], v[32:33], v[32:33]
buffer_store_dwordx4 v[132:135], v4, s[16:19], s63 offen sc1
v_pk_mul_f32 v[150:151], v[48:49], v[48:49]
v_pk_fma_f32 v[146:147], v[34:35], v[34:35], v[146:147]
v_pk_add_f32 v[144:145], v[32:33], v[34:35]
v_pk_fma_f32 v[150:151], v[50:51], v[50:51], v[150:151]
v_pk_add_f32 v[148:149], v[48:49], v[50:51]
v_pk_fma_f32 v[146:147], v[36:37], v[36:37], v[146:147]
v_pk_add_f32 v[144:145], v[144:145], v[36:37]
v_pk_fma_f32 v[150:151], v[52:53], v[52:53], v[150:151]
v_pk_add_f32 v[148:149], v[148:149], v[52:53]
v_pk_fma_f32 v[146:147], v[38:39], v[38:39], v[146:147]
v_pk_add_f32 v[144:145], v[144:145], v[38:39]
v_pk_fma_f32 v[150:151], v[54:55], v[54:55], v[150:151]
v_pk_add_f32 v[148:149], v[148:149], v[54:55]
buffer_store_dwordx4 v[136:139], v4, s[16:19], s62 offen offset:1024 sc1
v_pk_fma_f32 v[146:147], v[40:41], v[40:41], v[146:147]
v_pk_add_f32 v[144:145], v[144:145], v[40:41]
v_pk_fma_f32 v[150:151], v[56:57], v[56:57], v[150:151]
v_pk_add_f32 v[148:149], v[148:149], v[56:57]
v_pk_fma_f32 v[146:147], v[42:43], v[42:43], v[146:147]
v_pk_add_f32 v[144:145], v[144:145], v[42:43]
v_pk_fma_f32 v[150:151], v[58:59], v[58:59], v[150:151]
v_pk_add_f32 v[148:149], v[148:149], v[58:59]
v_pk_fma_f32 v[146:147], v[44:45], v[44:45], v[146:147]
v_pk_add_f32 v[144:145], v[144:145], v[44:45]
v_pk_fma_f32 v[150:151], v[60:61], v[60:61], v[150:151]
v_pk_add_f32 v[148:149], v[148:149], v[60:61]
v_pk_fma_f32 v[146:147], v[46:47], v[46:47], v[146:147]
buffer_store_dwordx4 v[140:143], v4, s[16:19], s63 offen offset:1024 sc1
v_pk_add_f32 v[144:145], v[144:145], v[46:47]
v_pk_fma_f32 v[150:151], v[62:63], v[62:63], v[150:151]
v_pk_add_f32 v[148:149], v[148:149], v[62:63]
v_add_f32 v144, v144, v145
v_add_f32 v146, v146, v147
v_add_f32 v148, v148, v149
v_add_f32 v150, v150, v151
s_nop 0
v_permlane16_swap_b32 v144, v148
v_permlane16_swap_b32 v146, v150
v_add_f32 v144, v144, v148
v_add_f32 v146, v146, v150
s_nop 1
v_permlane32_swap_b32 v144, v146
v_add_f32 v144, v144, v146
s_nop 1
v_permlane32_swap_b32 v144, v145
buffer_store_dwordx2 v[144:145], v152, s[16:19], s64 offen sc1
s_nop 1
v_accvgpr_write_b32 a224, v32
v_accvgpr_write_b32 a225, v33
v_accvgpr_write_b32 a226, v34
v_accvgpr_write_b32 a227, v35
v_accvgpr_write_b32 a228, v36
v_accvgpr_write_b32 a229, v37
v_accvgpr_write_b32 a230, v38
v_accvgpr_write_b32 a231, v39
v_accvgpr_write_b32 a232, v40
v_accvgpr_write_b32 a233, v41
v_accvgpr_write_b32 a234, v42
v_accvgpr_write_b32 a235, v43
v_accvgpr_write_b32 a236, v44
v_accvgpr_write_b32 a237, v45
v_accvgpr_write_b32 a238, v46
v_accvgpr_write_b32 a239, v47
v_accvgpr_write_b32 a240, v48
v_accvgpr_write_b32 a241, v49
v_accvgpr_write_b32 a242, v50
v_accvgpr_write_b32 a243, v51
v_accvgpr_write_b32 a244, v52
v_accvgpr_write_b32 a245, v53
v_accvgpr_write_b32 a246, v54
v_accvgpr_write_b32 a247, v55
v_accvgpr_write_b32 a248, v56
v_accvgpr_write_b32 a249, v57
v_accvgpr_write_b32 a250, v58
v_accvgpr_write_b32 a251, v59
v_accvgpr_write_b32 a252, v60
v_accvgpr_write_b32 a253, v61
v_accvgpr_write_b32 a254, v62
v_accvgpr_write_b32 a255, v63
s_lshl_b32 s62, s3, 11
s_add_u32 s62, s62, s85
v_lshl_add_u32 v21, v1, 4, s62
v_lshrrev_b32 v2, 3, v1
v_cmp_eq_u32 vcc, 3, v2
v_add_u32 v2, 67108480, v21
s_nop 0
v_cndmask_b32 v21, v21, v2, vcc
s_sub_u32 s62, s86, 2048
v_lshl_add_u32 v22, v0, 2, s62
v_lshrrev_b32 v2, 5, v0
v_cmp_eq_u32 vcc, 3, v2
v_add_u32 v2, 67108480, v22
s_nop 0
v_cndmask_b32 v22, v22, v2, vcc
s_mul_i32 s62, s48, 4608
v_lshl_add_u32 v23, v1, 4, s62
v_lshrrev_b32 v24, 4, v1
v_mul_u32_u24 v24, 2304, v24
v_and_b32 v2, 15, v1
v_lshl_add_u32 v24, v2, 4, v24
s_mov_b32 s52, 33554432
s_mov_b32 s54, s58
s_mov_b32 s56, s59
s_mul_i32 s55, s3, 2304
v_bfe_u32 v25, v1, 3, 2
v_mul_u32_u24 v25, 3104, v25
v_bfe_u32 v2, v1, 2, 1
v_lshl_add_u32 v25, v2, 7, v25
v_bfe_u32 v2, v1, 5, 1
v_lshl_add_u32 v25, v2, 8, v25
v_and_b32 v2, 3, v1
v_lshl_add_u32 v25, v2, 3, v25
s_lshl_b32 s62, s49, 6
s_add_u32 s62, s62, 67584
v_add_u32 v25, s62, v25
s_lshl_b32 s62, s8, 1
s_add_u32 s62, s62, s3
s_lshr_b32 s63, s50, 2
s_cmp_lt_u32 s3, 2
s_cselect_b32 s62, s62, s63
s_lshl_b32 s62, s62, 13
s_cmp_eq_u32 s3, 3
s_cselect_b32 s62, 268435456, s62
v_lshl_add_u32 v26, v1, 4, s62
s_lshr_b32 s63, s20, 7
s_sub_u32 s63, 3, s63
s_and_b32 s63, s63, 7
s_and_b32 s62, s9, 8
s_add_u32 s63, s63, s62
s_lshl_b32 s62, s5, 2
s_add_u32 s62, s62, s3
s_mul_i32 s62, s62, 12288
s_lshl_b32 s64, s63, 7
s_add_u32 s62, s62, s64
s_xor_b32 s63, s63, s9
s_cmp_lt_u32 s63, 4
s_cselect_b32 s62, s62, 16777216
v_lshrrev_b32 v14, 3, v1
v_min_u32 v14, 5, v14
v_lshl_add_u32 v14, v14, 11, s62
s_mov_b32 s44, 983040
buffer_load_dword v27, v14, s[20:23], s44 offen
s_mov_b32 s44, 2555904
s_mul_i32 s59, s3, 2080
v_bfe_u32 v5, v1, 3, 1
v_lshrrev_b32 v2, 4, v1
v_lshl_add_u32 v5, v2, 3, v5
s_lshl_b32 s62, s3, 1
v_add_u32 v5, s62, v5
v_mul_u32_u24 v5, 2048, v5
v_and_b32 v2, 7, v1
v_lshl_add_u32 v5, v2, 4, v5
s_lshl_b32 s62, s7, 7
v_add_u32 v5, s62, v5
v_add_u32 v6, 64512, v5
s_lshl_b32 s62, s6, 10
s_add_u32 s62, s62, 30474240
s_lshl_b32 s64, s8, 10
s_add_u32 s64, s64, 30474240
s_lshr_b32 s67, s9, 1
s_and_b32 s67, s67, 3
s_lshl_b32 s67, s67, 7
s_add_u32 s64, s64, s67
s_lshr_b32 s65, s50, 3
s_lshl_b32 s65, s65, 10
s_add_u32 s65, s65, 30474240
s_lshr_b32 s67, s9, 1
s_and_b32 s67, s67, 3
s_lshl_b32 s67, s67, 7
s_add_u32 s65, s65, s67
v_lshl_add_u32 v252, v1, 7, s62
v_mov_b32 v253, s64
v_mov_b32 v255, 1
v_writelane_b32 v253, s65, 1
s_waitcnt vmcnt(1) lgkmcnt(0)
s_cmp_lg_u32 s3, 1
s_barrier
s_cbranch_scc1 .Lfirst53
s_mov_b64 exec, 15
buffer_atomic_add v255, v252, s[16:19], 0 offen
s_mov_b64 exec, 3
v_mov_b32 v254, 0
buffer_atomic_add v254, v253, s[16:19], 0 offen sc0
s_mov_b64 exec, -1
.Lfirst53:
TR 20,25,49664
TR 22,25,50176
TR 24,25,49696
TR 26,25,50208
TR 28,25,50688
TR 30,25,51200
TR 32,25,50720
TR 34,25,51232
TR 36,25,51712
TR 38,25,52224
TR 40,25,51744
TR 42,25,52256
v_lshrrev_b32 v2, 4, v1
v_lshlrev_b32 v2, 2, v2
v_and_b32 v13, 15, v1
v_sub_u32 v2, v13, v2
v_mov_b32 v13, 0xff61b1e6
v_subrev_u32 v54, 0, v2
v_cmp_gt_u32 vcc, 8, v54
s_nop 1
v_cndmask_b32 v50, v13, 0, vcc
v_cmp_gt_i32 vcc, -8, v54
s_nop 1
v_cndmask_b32 v46, v13, 0, vcc
v_subrev_u32 v54, 1, v2
v_cmp_gt_u32 vcc, 8, v54
s_nop 1
v_cndmask_b32 v51, v13, 0, vcc
v_cmp_gt_i32 vcc, -8, v54
s_nop 1
v_cndmask_b32 v47, v13, 0, vcc
v_subrev_u32 v54, 2, v2
v_cmp_gt_u32 vcc, 8, v54
s_nop 1
v_cndmask_b32 v52, v13, 0, vcc
v_cmp_gt_i32 vcc, -8, v54
s_nop 1
v_cndmask_b32 v48, v13, 0, vcc
v_subrev_u32 v54, 3, v2
v_cmp_gt_u32 vcc, 8, v54
s_nop 1
v_cndmask_b32 v53, v13, 0, vcc
v_cmp_gt_i32 vcc, -8, v54
s_nop 1
v_cndmask_b32 v49, v13, 0, vcc
s_cmp_lt_u32 s8, 2
s_cselect_b64 vcc, -1, 0
v_cndmask_b32 v54, v46, v13, vcc
v_cndmask_b32 v55, v47, v13, vcc
v_cndmask_b32 v56, v48, v13, vcc
v_cndmask_b32 v57, v49, v13, vcc
v_mov_b64 v[60:61], 0
v_mov_b64 v[62:63], 0
v_mov_b64 v[64:65], 0
v_mov_b64 v[66:67], 0
v_mov_b64 v[68:69], 0
v_mov_b64 v[70:71], 0
v_mov_b64 v[72:73], 0
v_mov_b64 v[74:75], 0
v_mov_b64 v[76:77], 0
v_mov_b64 v[78:79], 0
v_mov_b64 v[80:81], 0
v_mov_b64 v[82:83], 0
v_mov_b64 v[84:85], 0
v_mov_b64 v[86:87], 0
v_mov_b64 v[88:89], 0
v_mov_b64 v[90:91], 0
v_mov_b64 v[92:93], 0
v_mov_b64 v[94:95], 0
v_mov_b64 v[96:97], 0
v_mov_b64 v[98:99], 0
v_mov_b64 v[100:101], 0
v_mov_b64 v[102:103], 0
v_mov_b64 v[104:105], 0
v_mov_b64 v[106:107], 0
v_mov_b64 v[108:109], 0
v_mov_b64 v[110:111], 0
v_mov_b64 v[112:113], 0
v_mov_b64 v[114:115], 0
v_mov_b64 v[116:117], 0
v_mov_b64 v[118:119], 0
v_mov_b64 v[120:121], 0
v_mov_b64 v[122:123], 0
v_mov_b64 v[124:125], 0
v_mov_b64 v[126:127], 0
v_mov_b64 v[128:129], 0
v_mov_b64 v[130:131], 0
v_mov_b64 v[132:133], 0
v_mov_b64 v[134:135], 0
v_mov_b64 v[136:137], 0
v_mov_b64 v[138:139], 0
v_mov_b64 v[140:141], 0
v_mov_b64 v[142:143], 0
v_mov_b64 v[144:145], 0
v_mov_b64 v[146:147], 0
v_mov_b64 v[148:149], 0
v_mov_b64 v[150:151], 0
v_mov_b64 v[152:153], 0
v_mov_b64 v[154:155], 0
v_mov_b64 v[156:157], 0
v_mov_b64 v[158:159], 0
v_mov_b64 v[160:161], 0
v_mov_b64 v[162:163], 0
v_mov_b64 v[164:165], 0
v_mov_b64 v[166:167], 0
v_mov_b64 v[168:169], 0
v_mov_b64 v[170:171], 0
v_mov_b64 v[172:173], 0
v_mov_b64 v[174:175], 0
s_mov_b32 s75, 62914560
v_and_b32 v10, 15, v1
v_lshlrev_b32 v12, 2, v10
v_lshlrev_b32 v10, 4, v10
v_add_u32 v10, 152576, v10
v_lshrrev_b32 v11, 4, v1
v_lshlrev_b32 v11, 4, v11
s_lshl_b32 s62, s49, 7
s_add_u32 s62, s62, 158720
v_add_u32 v12, s62, v12
v_add_u32 v13, s62, v11
v_add_u32 v11, 156672, v11
s_lshl_b32 s62, s3, 11
s_add_u32 s62, s62, 143360
v_lshl_add_u32 v8, v1, 4, s62
v_xor_b32 v9, 2048, v8
v_mov_b32 v248, 0x3f803f80
v_mov_b32 v249, 0x3f803f80
v_mov_b32 v250, 0x3f803f80
v_mov_b32 v251, 0x3f803f80
v_and_b32 v7, 31, v1
v_lshrrev_b32 v2, 5, v1
v_lshl_add_u32 v7, v7, 1, v2
v_and_b32 v2, 0xc0, v0
v_add_u32 v7, v7, v2
v_lshlrev_b32 v17, 2, v7
v_add_u32 v17, 156672, v17
v_lshlrev_b32 v7, 4, v7
v_add_u32 v7, 152576, v7
s_lshl_b32 s74, s9, 1
s_add_u32 s74, s74, s49
s_lshl_b32 s74, s74, 14
s_add_u32 s74, s74, s85
s_lshl_b32 s63, s48, 12
s_add_u32 s74, s74, s63
s_add_u32 s74, s74, 37748736
s_mov_b32 s62, 0
v_lshl_add_u32 v4, v1, 4, s62
v_lshrrev_b32 v2, 3, v1
v_cmp_eq_u32 vcc, 3, v2
v_add_u32 v2, 67108480, v4
s_nop 0
v_cndmask_b32 v4, v4, v2, vcc
ds_read_b128 v[28:31], v13
ds_read_b128 v[32:35], v13 offset:64
ds_read_b128 v[36:39], v13 offset:256
ds_read_b128 v[40:43], v13 offset:320
ds_read_b32 v44, v12 offset:512
ds_read_b32 v45, v12 offset:576
s_waitcnt lgkmcnt(0)
s_cmp_lg_u32 s3, 1
s_cbranch_scc1 .Lnopoll52
s_mov_b64 exec, 3
s_mov_b32 s15, 0
.Lpoll51:
v_mov_b32 v255, 0
buffer_atomic_add v255, v253, s[16:19], 0 offen sc0
s_waitcnt vmcnt(1)
v_cmp_gt_u32 vcc, 16, v254
s_add_u32 s15, s15, 1
s_cbranch_vccz .Lnopoll52r
v_mov_b32 v254, 0
buffer_atomic_add v254, v253, s[16:19], 0 offen sc0
s_waitcnt vmcnt(1)
v_cmp_gt_u32 vcc, 16, v255
s_add_u32 s15, s15, 1
s_cbranch_vccz .Lnopoll52r
s_cmp_le_u32 s15, 100000
s_cbranch_scc1 .Lpoll51
s_branch .Lnopoll52r
.Lnopoll52:
s_mov_b64 exec, 0
s_cmp_eq_u32 s3, 2
s_cbranch_scc1 .Lpad12
s_cmp_eq_u32 s3, 3
s_cbranch_scc1 .Lpad13
s_branch .Lpad14
.Lnopoll52r:
s_mov_b64 exec, -1
s_barrier
s_cmp_eq_u32 s48, 1
s_cbranch_scc1 .Lqkv54
s_add_u32 m0, s55, 36864
s_nop 0
buffer_load_dwordx4 v21, s[16:19], s52 offen sc1 lds
buffer_load_dwordx4 v21, s[16:19], s52 offen offset:1024 sc1 lds
buffer_load_dword v22, s[16:19], s52 offen offset:2048 sc1 lds
s_add_u32 s52, s52, 16384
s_add_u32 m0, s55, 46080
s_nop 0
buffer_load_dwordx4 v21, s[16:19], s52 offen sc1 lds
buffer_load_dwordx4 v21, s[16:19], s52 offen offset:1024 sc1 lds
buffer_load_dword v22, s[16:19], s52 offen offset:2048 sc1 lds
s_add_u32 s52, s52, 16384
s_add_u32 m0, s55, 0
s_nop 0
buffer_load_dwordx4 v21, s[16:19], s52 offen sc1 lds
buffer_load_dwordx4 v21, s[16:19], s52 offen offset:1024 sc1 lds
buffer_load_dword v22, s[16:19], s52 offen offset:2048 sc1 lds
s_add_u32 s52, s52, 16384
s_add_u32 m0, s55, 9216
s_nop 0
buffer_load_dwordx4 v21, s[16:19], s52 offen sc1 lds
buffer_load_dwordx4 v21, s[16:19], s52 offen offset:1024 sc1 lds
buffer_load_dword v22, s[16:19], s52 offen offset:2048 sc1 lds
s_add_u32 s52, s52, 16384
s_add_u32 m0, s55, 18432
s_nop 0
buffer_load_dwordx4 v21, s[16:19], s52 offen sc1 lds
buffer_load_dwordx4 v21, s[16:19], s52 offen offset:1024 sc1 lds
buffer_load_dword v22, s[16:19], s52 offen offset:2048 sc1 lds
s_add_u32 s52, s52, 16384
s_waitcnt vmcnt(12)
s_barrier
RD 0,23,36864
RD 4,23,37888
RD 8,23,39168
RD 12,23,40192
RD 16,24,38912
s_waitcnt lgkmcnt(0)
s_mov_b32 s15, -4
.p2align 6
.Lk56:
.Lpad12:
s_cbranch_execz .Lpad15
s_waitcnt vmcnt(9) lgkmcnt(8)
s_barrier
MAA 60,20,0
RD 44,23,46080
s_add_u32 m0, s56, 104832
MAA 76,24,0
buffer_load_dwordx4 v18, s[20:23], s54 offen lds
MAA 80,24,4
RD 48,23,47104
v_add_f32 v164, v164, v168
MAA 64,20,4
RD 52,23,48384
MAA 68,20,8
buffer_load_dwordx4 v19, s[20:23], s54 offen offset:1024 lds
MAA 84,24,8
RD 56,23,49408
MAA 88,24,12
TR 64,25,62080
v_add_f32 v165, v165, v169
MAA 72,20,12
TR 66,25,62592
s_waitcnt lgkmcnt(6)
MAA 104,28,12
buffer_load_dwordx4 v20, s[20:23], s54 offen offset:2048 lds
MAA 120,32,12
TR 68,25,62112
s_add_u32 s54, s54, 196608
MAA 116,32,8
TR 70,25,62624
s_add_u32 m0, s55, 27648
MAA 100,28,8
buffer_load_dwordx4 v21, s[16:19], s52 offen sc1 lds
MAA 96,28,4
RD 60,24,48128
MAA 112,32,4
TR 72,25,63104
MAA 108,32,0
buffer_load_dwordx4 v21, s[16:19], s52 offen offset:1024 sc1 lds
MAA 92,28,0
TR 74,25,63616
v_add_f32 v166, v166, v170
MAA 156,28,16
TR 76,25,63136
MAA 160,32,16
TR 78,25,63648
MAA 124,0,36
buffer_load_dword v22, s[16:19], s52 offen offset:2048 sc1 lds
MAA 140,0,40
TR 80,25,64128
s_add_u32 s52, s52, 16384
MAA 144,4,40
TR 82,25,64640
v_add_f32 v167, v167, v171
MAA 128,4,36
buffer_load_dword v27, v14, s[20:23], s44 offen
MAA 132,8,36
TR 84,25,64160
s_add_u32 s44, s44, 1572864
MAA 148,8,40
TR 86,25,64672
MAA 152,12,40
MAA 136,12,36
s_waitcnt vmcnt(13) lgkmcnt(8)
s_barrier
MAA 60,64,44
ds_read_b128 a[0:3], v23
s_add_u32 m0, s56, 117248
MAA 76,68,44
buffer_load_dwordx4 v18, s[20:23], s54 offen lds
MAA 80,68,48
RD 4,23,1024
MAA 64,64,48
RD 8,23,2304
MAA 68,64,52
buffer_load_dwordx4 v19, s[20:23], s54 offen offset:1024 lds
MAA 84,68,52
RD 12,23,3328
MAA 88,68,56
ds_read_b64_tr_b16 a[20:21], v25
MAA 72,64,56
TR 22,25,512
s_waitcnt lgkmcnt(6)
MAA 104,72,56
buffer_load_dwordx4 v20, s[20:23], s54 offen offset:2048 lds
MAA 120,76,56
TR 24,25,32
s_add_u32 s54, s54, 196608
MAA 116,76,52
TR 26,25,544
s_add_u32 m0, s55, 36864
MAA 100,72,52
buffer_load_dwordx4 v21, s[16:19], s52 offen sc1 lds
MAA 96,72,48
RD 16,24,2048
MAA 112,76,48
TR 28,25,1024
MAA 108,76,44
buffer_load_dwordx4 v21, s[16:19], s52 offen offset:1024 sc1 lds
MAA 92,72,44
TR 30,25,1536
MAA 156,72,60
TR 32,25,1056
MAA 160,76,60
TR 34,25,1568
MAA 124,44,80
buffer_load_dword v22, s[16:19], s52 offen offset:2048 sc1 lds
MAA 140,44,84
TR 36,25,2048
s_add_u32 s52, s52, 16384
MAA 144,48,84
TR 38,25,2560
MAA 128,48,80
buffer_load_dwordx4 v[168:171], v26, s[16:19], s75 offen sc1
MAA 132,52,80
TR 40,25,2080
MAA 148,52,84
TR 42,25,2592
MAA 152,56,84
MAA 136,56,80
s_waitcnt vmcnt(17) lgkmcnt(8)
s_barrier
MAA 60,20,0
RD 44,23,9216
s_add_u32 m0, s56, 129664
MAA 76,24,0
buffer_load_dwordx4 v18, s[20:23], s54 offen lds
MAA 80,24,4
RD 48,23,10240
MAA 64,20,4
RD 52,23,11520
MAA 68,20,8
RD 56,23,12544
MAA 84,24,8
buffer_load_dwordx4 v19, s[20:23], s54 offen offset:1024 lds
MAA 88,24,12
TR 64,25,12416
MAA 72,20,12
TR 66,25,12928
s_waitcnt lgkmcnt(6)
MAA 104,28,12
TR 68,25,12448
MAA 120,32,12
buffer_load_dwordx4 v20, s[20:23], s54 offen offset:2048 lds
MAA 116,32,8
TR 70,25,12960
s_add_u32 s54, s54, 196608
MAA 100,28,8
RD 60,24,11264
MAA 96,28,4
s_add_u32 m0, s55, 46080
MAA 112,32,4
buffer_load_dwordx4 v21, s[16:19], s52 offen sc1 lds
MAA 108,32,0
TR 72,25,13440
MAA 92,28,0
TR 74,25,13952
MAA 156,28,16
TR 76,25,13472
MAA 160,32,16
buffer_load_dwordx4 v21, s[16:19], s52 offen offset:1024 sc1 lds
MAA 124,0,36
TR 78,25,13984
MAA 140,0,40
TR 80,25,14464
MAA 144,4,40
TR 82,25,14976
MAA 128,4,36
buffer_load_dword v22, s[16:19], s52 offen offset:2048 sc1 lds
MAA 132,8,36
TR 84,25,14496
s_add_u32 s52, s52, 16384
MAA 148,8,40
TR 86,25,15008
MAA 152,12,40
MAA 136,12,36
s_waitcnt vmcnt(20) lgkmcnt(8)
s_barrier
MAA 60,64,44
RD 0,23,18432
s_add_u32 m0, s56, 67584
MAA 76,68,44
buffer_load_dwordx4 v18, s[20:23], s54 offen lds
MAA 80,68,48
RD 4,23,19456
v_add_f32 v164, v164, v172
MAA 64,64,48
RD 8,23,20736
MAA 68,64,52
RD 12,23,21760
MAA 84,68,52
buffer_load_dwordx4 v19, s[20:23], s54 offen offset:1024 lds
MAA 88,68,56
TR 20,25,24832
MAA 72,64,56
TR 22,25,25344
s_waitcnt lgkmcnt(6)
MAA 104,72,56
TR 24,25,24864
v_add_f32 v165, v165, v173
MAA 120,76,56
buffer_load_dwordx4 v20, s[20:23], s54 offen offset:2048 lds
MAA 116,76,52
TR 26,25,25376
s_add_u32 s54, s54, 196608
MAA 100,72,52
RD 16,24,20480
MAA 96,72,48
s_add_u32 m0, s55, 0
MAA 112,76,48
buffer_load_dwordx4 v21, s[16:19], s52 offen sc1 lds
MAA 108,76,44
TR 28,25,25856
v_add_f32 v166, v166, v174
MAA 92,72,44
TR 30,25,26368
MAA 156,72,60
TR 32,25,25888
MAA 160,76,60
buffer_load_dwordx4 v21, s[16:19], s52 offen offset:1024 sc1 lds
MAA 124,44,80
TR 34,25,26400
MAA 140,44,84
TR 36,25,26880
v_add_f32 v167, v167, v175
MAA 144,48,84
TR 38,25,27392
MAA 128,48,80
buffer_load_dword v22, s[16:19], s52 offen offset:2048 sc1 lds
MAA 132,52,80
TR 40,25,26912
s_add_u32 s52, s52, 16384
MAA 148,52,84
TR 42,25,27424
MAA 152,56,84
MAA 136,56,80
s_waitcnt vmcnt(20) lgkmcnt(8)
s_barrier
MAA 60,20,0
RD 44,23,27648
s_add_u32 m0, s56, 80000
MAA 76,24,0
buffer_load_dwordx4 v18, s[20:23], s54 offen lds
MAA 80,24,4
RD 48,23,28672
MAA 64,20,4
RD 52,23,29952
MAA 68,20,8
buffer_load_dwordx4 v19, s[20:23], s54 offen offset:1024 lds
MAA 84,24,8
RD 56,23,30976
MAA 88,24,12
TR 64,25,37248
MAA 72,20,12
TR 66,25,37760
s_waitcnt lgkmcnt(6)
MAA 104,28,12
buffer_load_dwordx4 v20, s[20:23], s54 offen offset:2048 lds
MAA 120,32,12
TR 68,25,37280
s_add_u32 s54, s54, 196608
MAA 116,32,8
TR 70,25,37792
s_add_u32 m0, s55, 9216
MAA 100,28,8
buffer_load_dwordx4 v21, s[16:19], s52 offen sc1 lds
MAA 96,28,4
RD 60,24,29696
MAA 112,32,4
TR 72,25,38272
MAA 108,32,0
buffer_load_dwordx4 v21, s[16:19], s52 offen offset:1024 sc1 lds
MAA 92,28,0
TR 74,25,38784
MAA 156,28,16
TR 76,25,38304
MAA 160,32,16
TR 78,25,38816
MAA 124,0,36
buffer_load_dword v22, s[16:19], s52 offen offset:2048 sc1 lds
MAA 140,0,40
TR 80,25,39296
s_add_u32 s52, s52, 16384
MAA 144,4,40
TR 82,25,39808
MAA 128,4,36
buffer_load_dwordx4 v[172:175], v26, s[16:19], s75 offen offset:1024 sc1
MAA 132,8,36
TR 84,25,39328
s_add_u32 s75, s75, 2048
MAA 148,8,40
TR 86,25,39840
MAA 152,12,40
MAA 136,12,36
s_waitcnt vmcnt(20) lgkmcnt(8)
s_barrier
MAA 60,64,44
RD 0,23,36864
s_add_u32 m0, s56, 92416
MAA 76,68,44
buffer_load_dwordx4 v18, s[20:23], s54 offen lds
MAA 80,68,48
RD 4,23,37888
MAA 64,64,48
RD 8,23,39168
MAA 68,64,52
RD 12,23,40192
MAA 84,68,52
buffer_load_dwordx4 v19, s[20:23], s54 offen offset:1024 lds
MAA 88,68,56
TR 20,25,49664
MAA 72,64,56
TR 22,25,50176
s_waitcnt lgkmcnt(6)
MAA 104,72,56
TR 24,25,49696
MAA 120,76,56
buffer_load_dwordx4 v20, s[20:23], s54 offen offset:2048 lds
MAA 116,76,52
TR 26,25,50208
s_add_u32 s54, s54, 196608
MAA 100,72,52
RD 16,24,38912
MAA 96,72,48
s_add_u32 m0, s55, 18432
MAA 112,76,48
buffer_load_dwordx4 v21, s[16:19], s52 offen sc1 lds
MAA 108,76,44
TR 28,25,50688
MAA 92,72,44
TR 30,25,51200
MAA 156,72,60
TR 32,25,50720
MAA 160,76,60
buffer_load_dwordx4 v21, s[16:19], s52 offen offset:1024 sc1 lds
MAA 124,44,80
TR 34,25,51232
MAA 140,44,84
TR 36,25,51712
MAA 144,48,84
TR 38,25,52224
MAA 128,48,80
buffer_load_dword v22, s[16:19], s52 offen offset:2048 sc1 lds
MAA 132,52,80
TR 40,25,51744
s_add_u32 s52, s52, 16384
MAA 148,52,84
TR 42,25,52256
MAA 152,56,84
s_add_u32 s15, s15, 1
MAA 136,56,80
s_cbranch_scc0 .Lk56
s_waitcnt vmcnt(19) lgkmcnt(8)
s_barrier
MAA 60,20,0
RD 44,23,46080
s_add_u32 m0, s56, 104832
MAA 76,24,0
buffer_load_dwordx4 v18, s[20:23], s54 offen lds
MAA 80,24,4
RD 48,23,47104
v_add_f32 v164, v164, v168
MAA 64,20,4
RD 52,23,48384
v_add_f32 v165, v165, v169
MAA 68,20,8
RD 56,23,49408
v_add_f32 v166, v166, v170
MAA 84,24,8
buffer_load_dwordx4 v19, s[20:23], s54 offen offset:1024 lds
MAA 88,24,12
TR 64,25,62080
v_add_f32 v167, v167, v171
MAA 72,20,12
TR 66,25,62592
s_waitcnt lgkmcnt(6)
MAA 104,28,12
TR 68,25,62112
MAA 120,32,12
buffer_load_dwordx4 v20, s[20:23], s54 offen offset:2048 lds
MAA 116,32,8
TR 70,25,62624
s_add_u32 s54, s54, 196608
MAA 100,28,8
RD 60,24,48128
s_add_u32 m0, s55, 27648
MAA 96,28,4
TR 72,25,63104
MAA 112,32,4
buffer_load_dwordx4 v21, s[16:19], s52 offen sc1 lds
MAA 108,32,0
TR 74,25,63616
MAA 92,28,0
TR 76,25,63136
MAA 156,28,16
TR 78,25,63648
MAA 160,32,16
buffer_load_dwordx4 v21, s[16:19], s52 offen offset:1024 sc1 lds
MAA 124,0,36
TR 80,25,64128
MAA 140,0,40
TR 82,25,64640
MAA 144,4,40
TR 84,25,64160
MAA 128,4,36
buffer_load_dword v22, s[16:19], s52 offen offset:2048 sc1 lds
MAA 132,8,36
TR 86,25,64672
s_add_u32 s52, s52, 16384
MAA 148,8,40
MAA 152,12,40
MAA 136,12,36
s_waitcnt vmcnt(19) lgkmcnt(8)
s_barrier
MAA 60,64,44
ds_read_b128 a[0:3], v23
s_add_u32 m0, s56, 117248
MAA 76,68,44
buffer_load_dwordx4 v18, s[20:23], s54 offen lds
MAA 80,68,48
RD 4,23,1024
MAA 64,64,48
RD 8,23,2304
MAA 68,64,52
RD 12,23,3328
MAA 84,68,52
buffer_load_dwordx4 v19, s[20:23], s54 offen offset:1024 lds
MAA 88,68,56
ds_read_b64_tr_b16 a[20:21], v25
MAA 72,64,56
TR 22,25,512
s_waitcnt lgkmcnt(6)
MAA 104,72,56
TR 24,25,32
MAA 120,76,56
buffer_load_dwordx4 v20, s[20:23], s54 offen offset:2048 lds
MAA 116,76,52
TR 26,25,544
s_add_u32 s54, s54, 196608
MAA 100,72,52
RD 16,24,2048
MAA 96,72,48
s_add_u32 m0, s55, 36864
MAA 112,76,48
buffer_load_dwordx4 v21, s[16:19], s52 offen sc1 lds
MAA 108,76,44
TR 28,25,1024
MAA 92,72,44
TR 30,25,1536
MAA 156,72,60
TR 32,25,1056
MAA 160,76,60
buffer_load_dwordx4 v21, s[16:19], s52 offen offset:1024 sc1 lds
MAA 124,44,80
TR 34,25,1568
MAA 140,44,84
TR 36,25,2048
MAA 144,48,84
TR 38,25,2560
MAA 128,48,80
buffer_load_dword v22, s[16:19], s52 offen offset:2048 sc1 lds
MAA 132,52,80
TR 40,25,2080
s_add_u32 s52, s52, 16384
MAA 148,52,84
TR 42,25,2592
MAA 152,56,84
MAA 136,56,80
s_waitcnt vmcnt(19) lgkmcnt(8)
s_barrier
MAA 60,20,0
RD 44,23,9216
s_add_u32 m0, s56, 129664
MAA 76,24,0
buffer_load_dwordx4 v18, s[20:23], s54 offen lds
MAA 80,24,4
RD 48,23,10240
s_waitcnt vmcnt(19)
v_add_f32 v164, v164, v172
MAA 64,20,4
RD 52,23,11520
v_add_f32 v165, v165, v173
MAA 68,20,8
RD 56,23,12544
v_add_f32 v166, v166, v174
MAA 84,24,8
buffer_load_dwordx4 v19, s[20:23], s54 offen offset:1024 lds
MAA 88,24,12
TR 64,25,12416
v_add_f32 v167, v167, v175
MAA 72,20,12
TR 66,25,12928
s_waitcnt lgkmcnt(6)
MAA 104,28,12
TR 68,25,12448
MAA 120,32,12
buffer_load_dwordx4 v20, s[20:23], s54 offen offset:2048 lds
MAA 116,32,8
TR 70,25,12960
s_add_u32 s54, s54, 196608
MAA 100,28,8
RD 60,24,11264
s_add_u32 m0, s55, 46080
MAA 96,28,4
TR 72,25,13440
MAA 112,32,4
buffer_load_dwordx4 v21, s[16:19], s52 offen sc1 lds
MAA 108,32,0
TR 74,25,13952
MAA 92,28,0
TR 76,25,13472
MAA 156,28,16
TR 78,25,13984
MAA 160,32,16
buffer_load_dwordx4 v21, s[16:19], s52 offen offset:1024 sc1 lds
MAA 124,0,36
TR 80,25,14464
MAA 140,0,40
TR 82,25,14976
MAA 144,4,40
TR 84,25,14496
MAA 128,4,36
buffer_load_dword v22, s[16:19], s52 offen offset:2048 sc1 lds
MAA 132,8,36
TR 86,25,15008
s_add_u32 s52, s52, 16384
MAA 148,8,40
v_permlane32_swap_b32 v164, v166
MAA 152,12,40
v_permlane32_swap_b32 v165, v167
MAA 136,12,36
s_waitcnt vmcnt(18) lgkmcnt(8)
s_barrier
MAA 60,64,44
RD 0,23,18432
s_add_u32 m0, s59, 0
MAA 76,68,44
RD 4,23,19456
s_mov_b32 s58, 1048576
.Lpad13:
s_cbranch_execz .Lpad16
MAA 80,68,48
buffer_load_dwordx4 v5, s[24:27], s58 offen lds
MAA 64,64,48
RD 8,23,20736
v_add_f32 v164, v164, v166
MAA 68,64,52
RD 12,23,21760
v_add_f32 v165, v165, v167
MAA 84,68,52
TR 20,25,24832
v_mul_f32 v164, 0xba800000, v164
MAA 88,68,56
buffer_load_dwordx4 v6, s[24:27], s58 offen offset:1024 lds
MAA 72,64,56
TR 22,25,25344
s_add_u32 m0, s59, 58240
s_waitcnt lgkmcnt(6)
MAA 104,72,56
TR 24,25,24864
s_mov_b32 s58, 1966080
MAA 120,76,56
TR 26,25,25376
v_mul_f32 v165, 0x3a800000, v165
MAA 116,76,52
buffer_load_dwordx4 v5, s[24:27], s58 offen lds
MAA 100,72,52
RD 16,24,20480
v_fma_f32 v165, -v164, v164, v165
MAA 96,72,48
TR 28,25,25856
v_max_f32 v165, 0, v165
MAA 112,76,48
TR 30,25,26368
v_add_f32 v165, 0x3727c5ac, v165
MAA 108,76,44
buffer_load_dwordx4 v6, s[24:27], s58 offen offset:1024 lds
MAA 92,72,44
TR 32,25,25888
s_add_u32 m0, s59, 66560
MAA 156,72,60
TR 34,25,26400
s_mov_b32 s58, 0
MAA 160,76,60
TR 36,25,26880
MAA 124,44,80
buffer_load_dwordx4 v5, s[24:27], s58 offen lds
MAA 140,44,84
TR 38,25,27392
MAA 144,48,84
TR 40,25,26912
MAA 128,48,80
TR 42,25,27424
MAA 132,52,80
buffer_load_dwordx4 v6, s[24:27], s58 offen offset:1024 lds
MAA 148,52,84
v_rsq_f32 v166, v165
MAA 152,56,84
MAA 136,56,80
s_waitcnt vmcnt(18) lgkmcnt(8)
s_barrier
MAA 60,20,0
RD 44,23,27648
s_add_u32 m0, s59, 8320
MAA 76,24,0
RD 48,23,28672
s_mov_b32 s58, 1179648
MAA 80,24,4
buffer_load_dwordx4 v5, s[24:27], s58 offen lds
MAA 64,20,4
RD 52,23,29952
v_mov_b32 v165, v166
MAA 68,20,8
RD 56,23,30976
v_mul_f32 v166, 0x3e8293ee, v166
MAA 84,24,8
ds_write_b128 v7, v[164:167]
MAA 88,24,12
buffer_load_dwordx4 v6, s[24:27], s58 offen offset:1024 lds
MAA 72,20,12
TR 64,25,37248
s_add_u32 m0, s59, 74880
s_waitcnt lgkmcnt(6)
MAA 104,28,12
TR 66,25,37760
s_mov_b32 s58, 131072
MAA 120,32,12
TR 68,25,37280
MAA 116,32,8
buffer_load_dwordx4 v5, s[24:27], s58 offen lds
MAA 100,28,8
TR 70,25,37792
MAA 96,28,4
RD 60,24,29696
MAA 112,32,4
TR 72,25,38272
MAA 108,32,0
buffer_load_dwordx4 v6, s[24:27], s58 offen offset:1024 lds
MAA 92,28,0
TR 74,25,38784
s_add_u32 m0, s59, 83200
MAA 156,28,16
TR 76,25,38304
s_mov_b32 s58, 262144
MAA 160,32,16
TR 78,25,38816
MAA 124,0,36
buffer_load_dwordx4 v5, s[24:27], s58 offen lds
MAA 140,0,40
TR 80,25,39296
MAA 144,4,40
TR 82,25,39808
MAA 128,4,36
TR 84,25,39328
MAA 132,8,36
buffer_load_dwordx4 v6, s[24:27], s58 offen offset:1024 lds
MAA 148,8,40
TR 86,25,39840
MAA 152,12,40
MAA 136,12,36
s_waitcnt vmcnt(18) lgkmcnt(8)
s_barrier
MAA 60,64,44
ds_write_b32 v17, v164
s_add_u32 m0, s59, 16640
MAA 76,68,44
ds_write_b32 v17, v165 offset:1024
s_mov_b32 s58, 1310720
MAA 80,68,48
buffer_load_dwordx4 v5, s[24:27], s58 offen lds
MAA 64,64,48
RD 0,23,36864
MAA 68,64,52
RD 4,23,37888
MAA 84,68,52
RD 8,23,39168
MAA 88,68,56
RD 12,23,40192
MAA 72,64,56
TR 20,25,49664
s_waitcnt lgkmcnt(7)
MAA 104,72,56
buffer_load_dwordx4 v6, s[24:27], s58 offen offset:1024 lds
MAA 120,76,56
TR 22,25,50176
s_add_u32 m0, s59, 91520
MAA 116,76,52
TR 24,25,49696
s_mov_b32 s58, 393216
MAA 100,72,52
TR 26,25,50208
MAA 96,72,48
RD 16,24,38912
MAA 112,76,48
TR 28,25,50688
MAA 108,76,44
buffer_load_dwordx4 v5, s[24:27], s58 offen lds
MAA 92,72,44
TR 30,25,51200
MAA 156,72,60
TR 32,25,50720
MAA 160,76,60
TR 34,25,51232
MAA 124,44,80
TR 36,25,51712
MAA 140,44,84
TR 38,25,52224
MAA 144,48,84
buffer_load_dwordx4 v6, s[24:27], s58 offen offset:1024 lds
MAA 128,48,80
TR 40,25,51744
MAA 132,52,80
TR 42,25,52256
MAA 148,52,84
MAA 152,56,84
MAA 136,56,80
s_waitcnt vmcnt(16) lgkmcnt(8)
s_barrier
MAA 60,20,0
RD 44,23,46080
s_add_u32 m0, s59, 24960
MAA 76,24,0
RD 48,23,47104
s_mov_b32 s58, 1441792
MAA 80,24,4
buffer_load_dwordx4 v5, s[24:27], s58 offen lds
MAA 64,20,4
RD 52,23,48384
MAA 68,20,8
RD 56,23,49408
MAA 84,24,8
TR 64,25,62080
MAA 88,24,12
buffer_load_dwordx4 v6, s[24:27], s58 offen offset:1024 lds
MAA 72,20,12
TR 66,25,62592
s_add_u32 m0, s59, 99840
s_waitcnt lgkmcnt(6)
MAA 104,28,12
TR 68,25,62112
s_mov_b32 s58, 524288
MAA 120,32,12
TR 70,25,62624
MAA 116,32,8
buffer_load_dwordx4 v5, s[24:27], s58 offen lds
MAA 100,28,8
RD 60,24,48128
MAA 96,28,4
TR 72,25,63104
MAA 112,32,4
TR 74,25,63616
MAA 108,32,0
buffer_load_dwordx4 v6, s[24:27], s58 offen offset:1024 lds
MAA 92,28,0
TR 76,25,63136
s_add_u32 m0, s59, 108160
MAA 156,28,16
TR 78,25,63648
s_mov_b32 s58, 655360
MAA 160,32,16
TR 80,25,64128
MAA 124,0,36
buffer_load_dwordx4 v5, s[24:27], s58 offen lds
MAA 140,0,40
TR 82,25,64640
MAA 144,4,40
TR 84,25,64160
MAA 128,4,36
TR 86,25,64672
MAA 132,8,36
buffer_load_dwordx4 v6, s[24:27], s58 offen offset:1024 lds
MAA 148,8,40
MAA 152,12,40
MAA 136,12,36
s_waitcnt lgkmcnt(0)
s_barrier
MAA 156,72,60
ds_read_b128 v[232:235], v10 offset:768
s_add_u32 m0, s59, 33280
MAA 160,76,60
ds_read_b128 v[236:239], v10 offset:2816
s_mov_b32 s58, 1572864
MAA 104,72,56
ds_read_b128 v[228:231], v10 offset:512
MAA 120,76,56
ds_read_b128 v[224:227], v10 offset:256
MAA 136,56,80
ds_read_b128 v[220:223], v10
MAA 152,56,84
ds_read_b128 v[240:243], v11 offset:192
MAA 100,72,52
ds_read_b128 v[244:247], v11 offset:1216
MAA 116,76,52
buffer_load_dwordx4 v5, s[24:27], s58 offen lds
MAA 96,72,48
ds_read_b128 v[18:21], v11 offset:128
ds_read_b128 v[22:25], v11 offset:1152
s_waitcnt lgkmcnt(8)
v_pk_fma_f32 v[104:105], v[36:37], v[232:233], v[104:105] op_sel_hi:[1,0,1]
v_pk_mul_f32 v[104:105], v[104:105], v[232:233] op_sel:[0,1] op_sel_hi:[1,1]
v_pk_fma_f32 v[106:107], v[38:39], v[232:233], v[106:107] op_sel_hi:[1,0,1]
v_pk_mul_f32 v[106:107], v[106:107], v[232:233] op_sel:[0,1] op_sel_hi:[1,1]
v_pk_fma_f32 v[120:121], v[40:41], v[232:233], v[120:121] op_sel_hi:[1,0,1]
v_pk_mul_f32 v[120:121], v[120:121], v[232:233] op_sel:[0,1] op_sel_hi:[1,1]
v_pk_fma_f32 v[122:123], v[42:43], v[232:233], v[122:123] op_sel_hi:[1,0,1]
v_pk_mul_f32 v[122:123], v[122:123], v[232:233] op_sel:[0,1] op_sel_hi:[1,1]
s_waitcnt lgkmcnt(6)
v_pk_fma_f32 v[100:101], v[36:37], v[228:229], v[100:101] op_sel_hi:[1,0,1]
v_pk_mul_f32 v[100:101], v[100:101], v[228:229] op_sel:[0,1] op_sel_hi:[1,1]
v_pk_fma_f32 v[102:103], v[38:39], v[228:229], v[102:103] op_sel_hi:[1,0,1]
v_pk_mul_f32 v[102:103], v[102:103], v[228:229] op_sel:[0,1] op_sel_hi:[1,1]
v_pk_fma_f32 v[116:117], v[40:41], v[228:229], v[116:117] op_sel_hi:[1,0,1]
v_pk_mul_f32 v[116:117], v[116:117], v[228:229] op_sel:[0,1] op_sel_hi:[1,1]
s_waitcnt lgkmcnt(3)
v_pk_fma_f32 v[136:137], v[240:241], v[44:45], v[136:137] op_sel_hi:[1,0,1]
v_pk_fma_f32 v[138:139], v[242:243], v[44:45], v[138:139] op_sel_hi:[1,0,1]
v_pk_fma_f32 v[152:153], v[240:241], v[44:45], v[152:153] op_sel:[0,1,0] op_sel_hi:[1,1,1]
v_pk_fma_f32 v[154:155], v[242:243], v[44:45], v[154:155] op_sel:[0,1,0] op_sel_hi:[1,1,1]
s_waitcnt lgkmcnt(2)
v_pk_mul_f32 v[136:137], v[136:137], v[244:245]
v_pk_mul_f32 v[138:139], v[138:139], v[246:247]
v_pk_mul_f32 v[152:153], v[152:153], v[244:245]
v_pk_mul_f32 v[154:155], v[154:155], v[246:247]
v_pk_fma_f32 v[118:119], v[42:43], v[228:229], v[118:119] op_sel_hi:[1,0,1]
v_pk_mul_f32 v[118:119], v[118:119], v[228:229] op_sel:[0,1] op_sel_hi:[1,1]
v_pk_fma_f32 v[96:97], v[36:37], v[224:225], v[96:97] op_sel_hi:[1,0,1]
v_pk_mul_f32 v[96:97], v[96:97], v[224:225] op_sel:[0,1] op_sel_hi:[1,1]
v_pk_fma_f32 v[98:99], v[38:39], v[224:225], v[98:99] op_sel_hi:[1,0,1]
v_pk_mul_f32 v[98:99], v[98:99], v[224:225] op_sel:[0,1] op_sel_hi:[1,1]
v_pk_fma_f32 v[156:157], v[36:37], v[236:237], v[156:157] op_sel_hi:[1,0,1]
v_pk_mul_f32 v[156:157], v[156:157], v[236:237] op_sel:[0,1] op_sel_hi:[1,1]
v_pk_fma_f32 v[158:159], v[38:39], v[236:237], v[158:159] op_sel_hi:[1,0,1]
v_pk_mul_f32 v[158:159], v[158:159], v[236:237] op_sel:[0,1] op_sel_hi:[1,1]
v_pk_fma_f32 v[160:161], v[40:41], v[236:237], v[160:161] op_sel_hi:[1,0,1]
v_pk_mul_f32 v[160:161], v[160:161], v[236:237] op_sel:[0,1] op_sel_hi:[1,1]
v_pk_fma_f32 v[162:163], v[42:43], v[236:237], v[162:163] op_sel_hi:[1,0,1]
v_pk_mul_f32 v[162:163], v[162:163], v[236:237] op_sel:[0,1] op_sel_hi:[1,1]
v_cvt_pk_bf16_f32 v196, v104, v105
v_cvt_pk_bf16_f32 v197, v106, v107
MAA 112,76,48
buffer_load_dwordx4 v6, s[24:27], s58 offen offset:1024 lds
MAA 92,72,44
ds_read_b128 v[240:243], v11 offset:64
v_cvt_pk_bf16_f32 v198, v120, v121
MAA 108,76,44
ds_read_b128 v[244:247], v11 offset:1088
v_cvt_pk_bf16_f32 v199, v122, v123
MAA 72,64,56
ds_write_b128 v8, v[196:199]
v_cvt_pk_bf16_f32 v208, v136, v137
MAA 88,68,56
s_add_u32 m0, s59, 41600
v_cvt_pk_bf16_f32 v209, v138, v139
v_cvt_pk_bf16_f32 v218, v152, v153
v_cvt_pk_bf16_f32 v219, v154, v155
ds_write_b64 v8, v[208:209] offset:1024
v_pk_fma_f32 v[72:73], v[28:29], v[232:233], v[72:73] op_sel_hi:[1,0,1]
v_pk_fma_f32 v[74:75], v[30:31], v[232:233], v[74:75] op_sel_hi:[1,0,1]
s_nop 0
v_pk_fma_f32 v[88:89], v[32:33], v[232:233], v[88:89] op_sel_hi:[1,0,1]
v_pk_fma_f32 v[90:91], v[34:35], v[232:233], v[90:91] op_sel_hi:[1,0,1]
v_pk_fma_f32 v[112:113], v[40:41], v[224:225], v[112:113] op_sel_hi:[1,0,1]
v_pk_mul_f32 v[112:113], v[112:113], v[224:225] op_sel:[0,1] op_sel_hi:[1,1]
v_pk_fma_f32 v[114:115], v[42:43], v[224:225], v[114:115] op_sel_hi:[1,0,1]
v_pk_mul_f32 v[114:115], v[114:115], v[224:225] op_sel:[0,1] op_sel_hi:[1,1]
v_pk_fma_f32 v[92:93], v[36:37], v[220:221], v[92:93] op_sel_hi:[1,0,1]
v_pk_mul_f32 v[92:93], v[92:93], v[220:221] op_sel:[0,1] op_sel_hi:[1,1]
v_pk_fma_f32 v[94:95], v[38:39], v[220:221], v[94:95] op_sel_hi:[1,0,1]
v_pk_mul_f32 v[94:95], v[94:95], v[220:221] op_sel:[0,1] op_sel_hi:[1,1]
v_pk_fma_f32 v[108:109], v[40:41], v[220:221], v[108:109] op_sel_hi:[1,0,1]
v_pk_mul_f32 v[108:109], v[108:109], v[220:221] op_sel:[0,1] op_sel_hi:[1,1]
v_pk_fma_f32 v[110:111], v[42:43], v[220:221], v[110:111] op_sel_hi:[1,0,1]
v_pk_mul_f32 v[110:111], v[110:111], v[220:221] op_sel:[0,1] op_sel_hi:[1,1]
ds_write_b64 v8, v[218:219] offset:1032
s_nop 0
MAA 132,52,80
s_mov_b32 s58, 1703936
v_cvt_pk_bf16_f32 v192, v100, v101
v_cvt_pk_bf16_f32 v193, v102, v103
MAA 148,52,84
buffer_load_dwordx4 v5, s[24:27], s58 offen lds
MAA 68,64,52
v_cvt_pk_bf16_f32 v194, v116, v117
v_cvt_pk_bf16_f32 v195, v118, v119
MAA 84,68,52
v_cvt_pk_bf16_f32 v176, v72, v73
v_cvt_pk_bf16_f32 v177, v74, v75
MAA 128,48,80
v_cvt_pk_bf16_f32 v178, v88, v89
v_cvt_pk_bf16_f32 v179, v90, v91
v_cvt_pk_bf16_f32 v188, v96, v97
v_cvt_pk_bf16_f32 v189, v98, v99
v_cvt_pk_bf16_f32 v190, v112, v113
s_waitcnt lgkmcnt(6)
v_pk_fma_f32 v[132:133], v[18:19], v[44:45], v[132:133] op_sel_hi:[1,0,1]
s_waitcnt lgkmcnt(5)
v_pk_mul_f32 v[132:133], v[132:133], v[22:23]
v_pk_fma_f32 v[134:135], v[20:21], v[44:45], v[134:135] op_sel_hi:[1,0,1]
v_pk_mul_f32 v[134:135], v[134:135], v[24:25]
v_pk_fma_f32 v[148:149], v[18:19], v[44:45], v[148:149] op_sel:[0,1,0] op_sel_hi:[1,1,1]
v_pk_mul_f32 v[148:149], v[148:149], v[22:23]
v_pk_fma_f32 v[150:151], v[20:21], v[44:45], v[150:151] op_sel:[0,1,0] op_sel_hi:[1,1,1]
v_pk_mul_f32 v[150:151], v[150:151], v[24:25]
v_pk_fma_f32 v[68:69], v[28:29], v[228:229], v[68:69] op_sel_hi:[1,0,1]
v_pk_fma_f32 v[70:71], v[30:31], v[228:229], v[70:71] op_sel_hi:[1,0,1]
v_pk_fma_f32 v[84:85], v[32:33], v[228:229], v[84:85] op_sel_hi:[1,0,1]
v_pk_fma_f32 v[86:87], v[34:35], v[228:229], v[86:87] op_sel_hi:[1,0,1]
s_waitcnt lgkmcnt(4)
v_pk_fma_f32 v[128:129], v[240:241], v[44:45], v[128:129] op_sel_hi:[1,0,1]
s_waitcnt lgkmcnt(3)
v_pk_mul_f32 v[128:129], v[128:129], v[244:245]
v_pk_fma_f32 v[130:131], v[242:243], v[44:45], v[130:131] op_sel_hi:[1,0,1]
v_pk_mul_f32 v[130:131], v[130:131], v[246:247]
s_waitcnt lgkmcnt(0)
s_barrier
v_cvt_pk_bf16_f32 v206, v132, v133
MAA 144,48,84
ds_read_b64 v[200:201], v9 offset:1024
v_cvt_pk_bf16_f32 v207, v134, v135
MAA 64,64,48
ds_read_b64 v[210:211], v9 offset:1032
v_cvt_pk_bf16_f32 v216, v148, v149
MAA 80,68,48
buffer_load_dwordx4 v6, s[24:27], s58 offen offset:1024 lds
MAA 124,44,80
ds_read_b128 v[18:21], v11
s_add_u32 m0, s59, 49920
MAA 140,44,84
ds_read_b128 v[22:25], v11 offset:1024
s_mov_b32 s58, 1835008
MAA 60,64,44
v_cvt_pk_bf16_f32 v217, v150, v151
v_cvt_pk_bf16_f32 v191, v114, v115
MAA 76,68,44
buffer_load_dwordx4 v5, s[24:27], s58 offen lds
v_cvt_pk_bf16_f32 v172, v68, v69
v_cvt_pk_bf16_f32 v173, v70, v71
v_cvt_pk_bf16_f32 v174, v84, v85
v_pk_fma_f32 v[144:145], v[240:241], v[44:45], v[144:145] op_sel:[0,1,0] op_sel_hi:[1,1,1]
v_pk_mul_f32 v[144:145], v[144:145], v[244:245]
v_pk_fma_f32 v[146:147], v[242:243], v[44:45], v[146:147] op_sel:[0,1,0] op_sel_hi:[1,1,1]
v_pk_mul_f32 v[146:147], v[146:147], v[246:247]
v_pk_fma_f32 v[64:65], v[28:29], v[224:225], v[64:65] op_sel_hi:[1,0,1]
v_pk_fma_f32 v[66:67], v[30:31], v[224:225], v[66:67] op_sel_hi:[1,0,1]
v_pk_fma_f32 v[80:81], v[32:33], v[224:225], v[80:81] op_sel_hi:[1,0,1]
v_pk_fma_f32 v[82:83], v[34:35], v[224:225], v[82:83] op_sel_hi:[1,0,1]
v_pk_fma_f32 v[60:61], v[28:29], v[220:221], v[60:61] op_sel_hi:[1,0,1]
v_pk_fma_f32 v[62:63], v[30:31], v[220:221], v[62:63] op_sel_hi:[1,0,1]
v_pk_fma_f32 v[76:77], v[32:33], v[220:221], v[76:77] op_sel_hi:[1,0,1]
v_pk_fma_f32 v[78:79], v[34:35], v[220:221], v[78:79] op_sel_hi:[1,0,1]
v_cvt_pk_bf16_f32 v175, v86, v87
v_cvt_pk_bf16_f32 v204, v128, v129
v_mfma_f32_16x16x32_bf16 v[104:107], v[192:195], v[176:179], v[46:49]
buffer_load_dwordx4 v6, s[24:27], s58 offen offset:1024 lds
v_mfma_f32_16x16x32_bf16 v[120:123], v[196:199], v[176:179], v[50:53]
s_add_u32 m0, s59, 116480
s_mov_b32 s58, 786432
v_cvt_pk_bf16_f32 v205, v130, v131
v_mfma_f32_16x16x32_bf16 v[100:103], v[188:191], v[172:175], v[46:49]
s_nop 1
v_max3_f32 v88, v104, v105, v106
v_cvt_pk_bf16_f32 v214, v144, v145
v_mfma_f32_16x16x32_bf16 v[116:119], v[192:195], v[172:175], v[50:53]
v_max3_f32 v89, v107, v120, v121
v_max3_f32 v88, v88, v122, v123
v_max_f32 v90, v88, v89
buffer_load_dwordx4 v5, s[24:27], s58 offen lds
v_max_f32 v89, v88, v89
v_cvt_pk_bf16_f32 v215, v146, v147
v_max3_f32 v84, v100, v101, v102
v_permlane16_swap_b32 v90, v89
v_max3_f32 v85, v103, v116, v117
v_max_f32 v88, v90, v89
v_max_f32 v89, v90, v89
v_max3_f32 v84, v84, v118, v119
v_max_f32 v86, v84, v85
v_permlane32_swap_b32 v88, v89
v_max_f32 v85, v84, v85
buffer_load_dwordx4 v6, s[24:27], s58 offen offset:1024 lds
s_add_u32 m0, s59, 124800
s_mov_b32 s58, 917504
v_max_f32 v88, v88, v89
v_mul_f32 v88, v88, v234
v_pk_fma_f32 v[104:105], v[104:105], v[234:235], v[88:89] op_sel_hi:[1,0,0] neg_lo:[0,0,1] neg_hi:[0,0,1]
v_pk_fma_f32 v[106:107], v[106:107], v[234:235], v[88:89] op_sel_hi:[1,0,0] neg_lo:[0,0,1] neg_hi:[0,0,1]
v_pk_fma_f32 v[120:121], v[120:121], v[234:235], v[88:89] op_sel_hi:[1,0,0] neg_lo:[0,0,1] neg_hi:[0,0,1]
v_pk_fma_f32 v[122:123], v[122:123], v[234:235], v[88:89] op_sel_hi:[1,0,0] neg_lo:[0,0,1] neg_hi:[0,0,1]
v_exp_f32 v104, v104
v_exp_f32 v105, v105
v_exp_f32 v106, v106
v_exp_f32 v107, v107
v_exp_f32 v120, v120
v_exp_f32 v121, v121
v_exp_f32 v122, v122
v_exp_f32 v123, v123
v_cvt_pk_bf16_f32 v72, v104, v105
buffer_load_dwordx4 v5, s[24:27], s58 offen lds
v_cvt_pk_bf16_f32 v73, v106, v107
v_cvt_pk_bf16_f32 v74, v120, v121
v_cvt_pk_bf16_f32 v75, v122, v123
s_waitcnt lgkmcnt(1)
v_pk_fma_f32 v[124:125], v[18:19], v[44:45], v[124:125] op_sel_hi:[1,0,1]
s_waitcnt lgkmcnt(0)
v_pk_mul_f32 v[124:125], v[124:125], v[22:23]
v_pk_fma_f32 v[126:127], v[20:21], v[44:45], v[126:127] op_sel_hi:[1,0,1]
v_pk_mul_f32 v[126:127], v[126:127], v[24:25]
v_pk_fma_f32 v[140:141], v[18:19], v[44:45], v[140:141] op_sel:[0,1,0] op_sel_hi:[1,1,1]
v_pk_mul_f32 v[140:141], v[140:141], v[22:23]
v_pk_fma_f32 v[142:143], v[20:21], v[44:45], v[142:143] op_sel:[0,1,0] op_sel_hi:[1,1,1]
v_pk_mul_f32 v[142:143], v[142:143], v[24:25]
v_permlane16_swap_b32 v86, v85
s_nop 0
v_mfma_f32_16x16x32_bf16 v[88:91], v[248:251], v[72:75], 0
buffer_load_dwordx4 v6, s[24:27], s58 offen offset:1024 lds
v_mfma_f32_16x16x32_bf16 v[104:107], v[206:209], v[72:75], 0
v_max_f32 v84, v86, v85
v_max_f32 v85, v86, v85
v_mfma_f32_16x16x32_bf16 v[120:123], v[216:219], v[72:75], 0
s_nop 2
v_rcp_f32 v88, v88
v_permlane32_swap_b32 v84, v85
v_cvt_pk_bf16_f32 v184, v92, v93
v_pk_mul_f32 v[104:105], v[104:105], v[88:89] op_sel_hi:[1,0]
v_pk_mul_f32 v[106:107], v[106:107], v[88:89] op_sel_hi:[1,0]
v_pk_mul_f32 v[120:121], v[120:121], v[88:89] op_sel_hi:[1,0]
v_pk_mul_f32 v[122:123], v[122:123], v[88:89] op_sel_hi:[1,0]
v_cvt_pk_bf16_f32 v176, v104, v105
v_cvt_pk_bf16_f32 v177, v106, v107
v_cvt_pk_bf16_f32 v178, v120, v121
v_cvt_pk_bf16_f32 v179, v122, v123
buffer_store_dwordx4 v[176:179], v4, s[16:19], s74 offen offset:3072 sc1
v_max_f32 v84, v84, v85
v_mul_f32 v84, v84, v230
v_pk_fma_f32 v[100:101], v[100:101], v[230:231], v[84:85] op_sel_hi:[1,0,0] neg_lo:[0,0,1] neg_hi:[0,0,1]
v_pk_fma_f32 v[102:103], v[102:103], v[230:231], v[84:85] op_sel_hi:[1,0,0] neg_lo:[0,0,1] neg_hi:[0,0,1]
v_pk_fma_f32 v[116:117], v[116:117], v[230:231], v[84:85] op_sel_hi:[1,0,0] neg_lo:[0,0,1] neg_hi:[0,0,1]
v_pk_fma_f32 v[118:119], v[118:119], v[230:231], v[84:85] op_sel_hi:[1,0,0] neg_lo:[0,0,1] neg_hi:[0,0,1]
v_exp_f32 v100, v100
v_exp_f32 v101, v101
v_exp_f32 v102, v102
v_exp_f32 v103, v103
v_exp_f32 v116, v116
v_exp_f32 v117, v117
v_exp_f32 v118, v118
v_exp_f32 v119, v119
v_cvt_pk_bf16_f32 v68, v100, v101
v_cvt_pk_bf16_f32 v69, v102, v103
v_cvt_pk_bf16_f32 v70, v116, v117
v_cvt_pk_bf16_f32 v71, v118, v119
v_cvt_pk_bf16_f32 v185, v94, v95
v_cvt_pk_bf16_f32 v186, v108, v109
v_mfma_f32_16x16x32_bf16 v[84:87], v[248:251], v[68:71], 0
v_cvt_pk_bf16_f32 v187, v110, v111
v_cvt_pk_bf16_f32 v168, v64, v65
v_mfma_f32_16x16x32_bf16 v[100:103], v[204:207], v[68:71], 0
v_cvt_pk_bf16_f32 v169, v66, v67
v_cvt_pk_bf16_f32 v170, v80, v81
v_mfma_f32_16x16x32_bf16 v[116:119], v[214:217], v[68:71], 0
s_nop 1
v_rcp_f32 v84, v84
v_cvt_pk_bf16_f32 v171, v82, v83
v_cvt_pk_bf16_f32 v202, v124, v125
v_cvt_pk_bf16_f32 v203, v126, v127
v_pk_mul_f32 v[100:101], v[100:101], v[84:85] op_sel_hi:[1,0]
v_pk_mul_f32 v[102:103], v[102:103], v[84:85] op_sel_hi:[1,0]
v_pk_mul_f32 v[116:117], v[116:117], v[84:85] op_sel_hi:[1,0]
v_pk_mul_f32 v[118:119], v[118:119], v[84:85] op_sel_hi:[1,0]
v_cvt_pk_bf16_f32 v172, v100, v101
v_cvt_pk_bf16_f32 v173, v102, v103
v_mfma_f32_16x16x32_bf16 v[96:99], v[184:187], v[168:171], v[46:49]
v_cvt_pk_bf16_f32 v174, v116, v117
v_cvt_pk_bf16_f32 v175, v118, v119
v_mfma_f32_16x16x32_bf16 v[112:115], v[188:191], v[168:171], v[50:53]
buffer_store_dwordx4 v[172:175], v4, s[16:19], s74 offen offset:2048 sc1
v_cvt_pk_bf16_f32 v212, v140, v141
v_cvt_pk_bf16_f32 v213, v142, v143
s_nop 1
v_max3_f32 v80, v96, v97, v98
v_cvt_pk_bf16_f32 v180, v156, v157
v_cvt_pk_bf16_f32 v181, v158, v159
v_max3_f32 v81, v99, v112, v113
v_max3_f32 v80, v80, v114, v115
v_max_f32 v82, v80, v81
v_max_f32 v81, v80, v81
v_cvt_pk_bf16_f32 v182, v160, v161
v_cvt_pk_bf16_f32 v183, v162, v163
v_permlane16_swap_b32 v82, v81
v_cvt_pk_bf16_f32 v164, v60, v61
v_max_f32 v80, v82, v81
v_max_f32 v81, v82, v81
.Lpad14:
s_cbranch_execz .Lpad17
v_cvt_pk_bf16_f32 v165, v62, v63
v_cvt_pk_bf16_f32 v166, v76, v77
v_permlane32_swap_b32 v80, v81
v_cvt_pk_bf16_f32 v167, v78, v79
v_max_f32 v80, v80, v81
v_mul_f32 v80, v80, v226
v_mfma_f32_16x16x32_bf16 v[92:95], v[180:183], v[164:167], v[54:57]
v_mfma_f32_16x16x32_bf16 v[108:111], v[184:187], v[164:167], v[50:53]
s_nop 6
v_max3_f32 v76, v92, v93, v94
v_pk_fma_f32 v[96:97], v[96:97], v[226:227], v[80:81] op_sel_hi:[1,0,0] neg_lo:[0,0,1] neg_hi:[0,0,1]
v_pk_fma_f32 v[98:99], v[98:99], v[226:227], v[80:81] op_sel_hi:[1,0,0] neg_lo:[0,0,1] neg_hi:[0,0,1]
v_pk_fma_f32 v[112:113], v[112:113], v[226:227], v[80:81] op_sel_hi:[1,0,0] neg_lo:[0,0,1] neg_hi:[0,0,1]
v_pk_fma_f32 v[114:115], v[114:115], v[226:227], v[80:81] op_sel_hi:[1,0,0] neg_lo:[0,0,1] neg_hi:[0,0,1]
v_exp_f32 v96, v96
v_exp_f32 v97, v97
v_exp_f32 v98, v98
v_exp_f32 v99, v99
v_exp_f32 v112, v112
v_exp_f32 v113, v113
v_exp_f32 v114, v114
v_exp_f32 v115, v115
v_cvt_pk_bf16_f32 v64, v96, v97
v_cvt_pk_bf16_f32 v65, v98, v99
v_cvt_pk_bf16_f32 v66, v112, v113
v_cvt_pk_bf16_f32 v67, v114, v115
v_max3_f32 v77, v95, v108, v109
v_max3_f32 v76, v76, v110, v111
v_mfma_f32_16x16x32_bf16 v[80:83], v[248:251], v[64:67], 0
v_max_f32 v78, v76, v77
v_max_f32 v77, v76, v77
v_mfma_f32_16x16x32_bf16 v[96:99], v[202:205], v[64:67], 0
s_nop 0
v_permlane16_swap_b32 v78, v77
v_mfma_f32_16x16x32_bf16 v[112:115], v[212:215], v[64:67], 0
s_nop 1
v_rcp_f32 v80, v80
v_max_f32 v76, v78, v77
v_max_f32 v77, v78, v77
v_pk_mul_f32 v[96:97], v[96:97], v[80:81] op_sel_hi:[1,0]
v_pk_mul_f32 v[98:99], v[98:99], v[80:81] op_sel_hi:[1,0]
s_nop 0
v_pk_mul_f32 v[112:113], v[112:113], v[80:81] op_sel_hi:[1,0]
v_pk_mul_f32 v[114:115], v[114:115], v[80:81] op_sel_hi:[1,0]
v_cvt_pk_bf16_f32 v168, v96, v97
v_cvt_pk_bf16_f32 v169, v98, v99
v_cvt_pk_bf16_f32 v170, v112, v113
v_cvt_pk_bf16_f32 v171, v114, v115
buffer_store_dwordx4 v[168:171], v4, s[16:19], s74 offen offset:1024 sc1
v_permlane32_swap_b32 v76, v77
v_max_f32 v76, v76, v77
v_mul_f32 v76, v76, v222
v_pk_fma_f32 v[92:93], v[92:93], v[222:223], v[76:77] op_sel_hi:[1,0,0] neg_lo:[0,0,1] neg_hi:[0,0,1]
v_pk_fma_f32 v[94:95], v[94:95], v[222:223], v[76:77] op_sel_hi:[1,0,0] neg_lo:[0,0,1] neg_hi:[0,0,1]
v_pk_fma_f32 v[108:109], v[108:109], v[222:223], v[76:77] op_sel_hi:[1,0,0] neg_lo:[0,0,1] neg_hi:[0,0,1]
v_pk_fma_f32 v[110:111], v[110:111], v[222:223], v[76:77] op_sel_hi:[1,0,0] neg_lo:[0,0,1] neg_hi:[0,0,1]
v_exp_f32 v92, v92
v_exp_f32 v93, v93
v_exp_f32 v94, v94
v_exp_f32 v95, v95
v_exp_f32 v108, v108
v_exp_f32 v109, v109
v_exp_f32 v110, v110
v_exp_f32 v111, v111
v_cvt_pk_bf16_f32 v60, v92, v93
v_cvt_pk_bf16_f32 v61, v94, v95
v_cvt_pk_bf16_f32 v62, v108, v109
v_cvt_pk_bf16_f32 v63, v110, v111
s_nop 1
v_mfma_f32_16x16x32_bf16 v[76:79], v[248:251], v[60:63], 0
v_mfma_f32_16x16x32_bf16 v[92:95], v[200:203], v[60:63], 0
v_mfma_f32_16x16x32_bf16 v[108:111], v[210:213], v[60:63], 0
s_nop 5
v_rcp_f32 v76, v76
s_nop 0
v_pk_mul_f32 v[92:93], v[92:93], v[76:77] op_sel_hi:[1,0]
v_pk_mul_f32 v[94:95], v[94:95], v[76:77] op_sel_hi:[1,0]
v_pk_mul_f32 v[108:109], v[108:109], v[76:77] op_sel_hi:[1,0]
v_pk_mul_f32 v[110:111], v[110:111], v[76:77] op_sel_hi:[1,0]
v_cvt_pk_bf16_f32 v164, v92, v93
v_cvt_pk_bf16_f32 v165, v94, v95
v_cvt_pk_bf16_f32 v166, v108, v109
v_cvt_pk_bf16_f32 v167, v110, v111
buffer_store_dwordx4 v[164:167], v4, s[16:19], s74 offen sc1
s_nop 1
s_branch .Lqkve55
.Lpad15:
s_cbranch_execz .Lpad18
.Lsp49:
s_mov_b32 s15, 0
.Lsp49l:
v_mov_b32 v25, 0
buffer_atomic_add v25, v22, s[16:19], s73 offen sc0
s_add_u32 s15, s15, 1
s_cmp_gt_u32 s15, 100000
s_waitcnt vmcnt(0)
s_cbranch_scc1 .Lsp49b
v_cmp_gt_u32 vcc, v23, v25
s_nop 0
s_cbranch_vccnz .Lsp49l
s_branch .Lsp49b
.Lxs50:
s_mov_b32 s15, 0
.Lxs50l:
v_mov_b32 v15, 0
buffer_atomic_add v15, v12, s[16:19], s70 offen sc0
s_add_u32 s15, s15, 1
s_cmp_gt_u32 s15, 100000
s_waitcnt vmcnt(0)
s_cbranch_scc1 .Lxs50b
v_cmp_ne_u32 vcc, 0, v15
s_nop 0
s_cbranch_vccz .Lxs50l
s_branch .Lxs50b
.Lqkv54:
.Lpad16:
s_cbranch_execz .Lpad19
s_add_u32 m0, s55, 36864
s_nop 0
buffer_load_dwordx4 v21, s[16:19], s52 offen sc1 lds
buffer_load_dwordx4 v21, s[16:19], s52 offen offset:1024 sc1 lds
buffer_load_dword v22, s[16:19], s52 offen offset:2048 sc1 lds
s_add_u32 s52, s52, 16384
s_add_u32 m0, s55, 46080
s_nop 0
buffer_load_dwordx4 v21, s[16:19], s52 offen sc1 lds
buffer_load_dwordx4 v21, s[16:19], s52 offen offset:1024 sc1 lds
buffer_load_dword v22, s[16:19], s52 offen offset:2048 sc1 lds
s_add_u32 s52, s52, 16384
s_add_u32 m0, s55, 0
s_nop 0
buffer_load_dwordx4 v21, s[16:19], s52 offen sc1 lds
buffer_load_dwordx4 v21, s[16:19], s52 offen offset:1024 sc1 lds
buffer_load_dword v22, s[16:19], s52 offen offset:2048 sc1 lds
s_add_u32 s52, s52, 16384
s_add_u32 m0, s55, 9216
s_nop 0
buffer_load_dwordx4 v21, s[16:19], s52 offen sc1 lds
buffer_load_dwordx4 v21, s[16:19], s52 offen offset:1024 sc1 lds
buffer_load_dword v22, s[16:19], s52 offen offset:2048 sc1 lds
s_add_u32 s52, s52, 16384
s_add_u32 m0, s55, 18432
s_nop 0
buffer_load_dwordx4 v21, s[16:19], s52 offen sc1 lds
buffer_load_dwordx4 v21, s[16:19], s52 offen offset:1024 sc1 lds
buffer_load_dword v22, s[16:19], s52 offen offset:2048 sc1 lds
s_add_u32 s52, s52, 16384
s_waitcnt vmcnt(12)
s_barrier
RD 0,23,36864
RD 4,23,37888
RD 8,23,39168
RD 12,23,40192
RD 16,24,38912
s_waitcnt lgkmcnt(0)
s_mov_b32 s15, -4
.p2align 6
.Lk57:
s_waitcnt vmcnt(9) lgkmcnt(8)
s_barrier
MAA 60,20,0
RD 44,23,46080
v_add_f32 v164, v164, v168
MAA 76,24,0
RD 48,23,47104
s_add_u32 m0, s56, 104832
MAA 80,24,4
buffer_load_dwordx4 v18, s[20:23], s54 offen lds
MAA 64,20,4
RD 52,23,48384
MAA 68,20,8
RD 56,23,49408
MAA 84,24,8
buffer_load_dwordx4 v19, s[20:23], s54 offen offset:1024 lds
MAA 88,24,12
TR 64,25,62080
v_add_f32 v165, v165, v169
MAA 72,20,12
TR 66,25,62592
s_waitcnt lgkmcnt(6)
MAA 104,28,12
buffer_load_dwordx4 v20, s[20:23], s54 offen offset:2048 lds
MAA 120,32,12
TR 68,25,62112
s_add_u32 s54, s54, 196608
MAA 116,32,8
TR 70,25,62624
MAA 100,28,8
RD 60,24,48128
s_add_u32 m0, s55, 27648
MAA 96,28,4
buffer_load_dwordx4 v21, s[16:19], s52 offen sc1 lds
MAA 112,32,4
TR 72,25,63104
MAA 108,32,0
TR 74,25,63616
v_add_f32 v166, v166, v170
MAA 92,28,0
buffer_load_dwordx4 v21, s[16:19], s52 offen offset:1024 sc1 lds
MAA 124,0,36
TR 76,25,63136
MAA 140,0,40
TR 78,25,63648
MAA 144,4,40
TR 80,25,64128
v_add_f32 v167, v167, v171
MAA 128,4,36
buffer_load_dword v22, s[16:19], s52 offen offset:2048 sc1 lds
MAA 132,8,36
TR 82,25,64640
s_add_u32 s52, s52, 16384
MAA 148,8,40
TR 84,25,64160
MAA 152,12,40
buffer_load_dword v27, v14, s[20:23], s44 offen
MAA 136,12,36
TR 86,25,64672
s_add_u32 s44, s44, 1572864
MAA 156,16,36
MAA 160,16,40
s_waitcnt vmcnt(13) lgkmcnt(8)
s_barrier
MAA 60,64,44
ds_read_b128 a[0:3], v23
MAA 76,68,44
RD 4,23,1024
s_add_u32 m0, s56, 117248
MAA 80,68,48
buffer_load_dwordx4 v18, s[20:23], s54 offen lds
MAA 64,64,48
RD 8,23,2304
MAA 68,64,52
RD 12,23,3328
MAA 84,68,52
buffer_load_dwordx4 v19, s[20:23], s54 offen offset:1024 lds
MAA 88,68,56
ds_read_b64_tr_b16 a[20:21], v25
MAA 72,64,56
TR 22,25,512
s_waitcnt lgkmcnt(6)
MAA 104,72,56
buffer_load_dwordx4 v20, s[20:23], s54 offen offset:2048 lds
MAA 120,76,56
TR 24,25,32
s_add_u32 s54, s54, 196608
MAA 116,76,52
TR 26,25,544
MAA 100,72,52
RD 16,24,2048
s_add_u32 m0, s55, 36864
MAA 96,72,48
buffer_load_dwordx4 v21, s[16:19], s52 offen sc1 lds
MAA 112,76,48
TR 28,25,1024
MAA 108,76,44
TR 30,25,1536
MAA 92,72,44
buffer_load_dwordx4 v21, s[16:19], s52 offen offset:1024 sc1 lds
MAA 124,44,80
TR 32,25,1056
MAA 140,44,84
TR 34,25,1568
MAA 144,48,84
TR 36,25,2048
MAA 128,48,80
buffer_load_dword v22, s[16:19], s52 offen offset:2048 sc1 lds
MAA 132,52,80
TR 38,25,2560
s_add_u32 s52, s52, 16384
MAA 148,52,84
TR 40,25,2080
MAA 152,56,84
buffer_load_dwordx4 v[168:171], v26, s[16:19], s75 offen sc1
MAA 136,56,80
TR 42,25,2592
MAA 156,60,80
MAA 160,60,84
s_waitcnt vmcnt(17) lgkmcnt(8)
s_barrier
MAA 60,20,0
RD 44,23,9216
MAA 76,24,0
RD 48,23,10240
s_add_u32 m0, s56, 129664
MAA 80,24,4
buffer_load_dwordx4 v18, s[20:23], s54 offen lds
MAA 64,20,4
RD 52,23,11520
MAA 68,20,8
RD 56,23,12544
MAA 84,24,8
TR 64,25,12416
MAA 88,24,12
buffer_load_dwordx4 v19, s[20:23], s54 offen offset:1024 lds
MAA 72,20,12
TR 66,25,12928
s_waitcnt lgkmcnt(6)
MAA 104,28,12
TR 68,25,12448
MAA 120,32,12
TR 70,25,12960
MAA 116,32,8
buffer_load_dwordx4 v20, s[20:23], s54 offen offset:2048 lds
MAA 100,28,8
RD 60,24,11264
s_add_u32 s54, s54, 196608
MAA 96,28,4
MAA 112,32,4
TR 72,25,13440
s_add_u32 m0, s55, 46080
MAA 108,32,0
buffer_load_dwordx4 v21, s[16:19], s52 offen sc1 lds
MAA 92,28,0
TR 74,25,13952
MAA 124,0,36
TR 76,25,13472
MAA 140,0,40
TR 78,25,13984
MAA 144,4,40
buffer_load_dwordx4 v21, s[16:19], s52 offen offset:1024 sc1 lds
MAA 128,4,36
TR 80,25,14464
MAA 132,8,36
TR 82,25,14976
MAA 148,8,40
TR 84,25,14496
MAA 152,12,40
buffer_load_dword v22, s[16:19], s52 offen offset:2048 sc1 lds
MAA 136,12,36
TR 86,25,15008
s_add_u32 s52, s52, 16384
MAA 156,16,36
MAA 160,16,40
s_waitcnt vmcnt(20) lgkmcnt(8)
s_barrier
MAA 60,64,44
RD 0,23,18432
v_add_f32 v164, v164, v172
MAA 76,68,44
RD 4,23,19456
s_add_u32 m0, s56, 67584
MAA 80,68,48
buffer_load_dwordx4 v18, s[20:23], s54 offen lds
MAA 64,64,48
RD 8,23,20736
MAA 68,64,52
RD 12,23,21760
MAA 84,68,52
TR 20,25,24832
MAA 88,68,56
buffer_load_dwordx4 v19, s[20:23], s54 offen offset:1024 lds
MAA 72,64,56
TR 22,25,25344
s_waitcnt lgkmcnt(6)
MAA 104,72,56
TR 24,25,24864
v_add_f32 v165, v165, v173
MAA 120,76,56
TR 26,25,25376
MAA 116,76,52
buffer_load_dwordx4 v20, s[20:23], s54 offen offset:2048 lds
MAA 100,72,52
RD 16,24,20480
s_add_u32 s54, s54, 196608
MAA 96,72,48
MAA 112,76,48
TR 28,25,25856
s_add_u32 m0, s55, 0
MAA 108,76,44
buffer_load_dwordx4 v21, s[16:19], s52 offen sc1 lds
MAA 92,72,44
TR 30,25,26368
v_add_f32 v166, v166, v174
MAA 124,44,80
TR 32,25,25888
MAA 140,44,84
TR 34,25,26400
MAA 144,48,84
buffer_load_dwordx4 v21, s[16:19], s52 offen offset:1024 sc1 lds
MAA 128,48,80
TR 36,25,26880
MAA 132,52,80
TR 38,25,27392
v_add_f32 v167, v167, v175
MAA 148,52,84
TR 40,25,26912
MAA 152,56,84
buffer_load_dword v22, s[16:19], s52 offen offset:2048 sc1 lds
MAA 136,56,80
TR 42,25,27424
s_add_u32 s52, s52, 16384
MAA 156,60,80
MAA 160,60,84
s_waitcnt vmcnt(20) lgkmcnt(8)
s_barrier
MAA 60,20,0
RD 44,23,27648
MAA 76,24,0
RD 48,23,28672
s_add_u32 m0, s56, 80000
MAA 80,24,4
buffer_load_dwordx4 v18, s[20:23], s54 offen lds
MAA 64,20,4
RD 52,23,29952
MAA 68,20,8
RD 56,23,30976
MAA 84,24,8
buffer_load_dwordx4 v19, s[20:23], s54 offen offset:1024 lds
MAA 88,24,12
TR 64,25,37248
MAA 72,20,12
TR 66,25,37760
s_waitcnt lgkmcnt(6)
MAA 104,28,12
buffer_load_dwordx4 v20, s[20:23], s54 offen offset:2048 lds
MAA 120,32,12
TR 68,25,37280
s_add_u32 s54, s54, 196608
MAA 116,32,8
TR 70,25,37792
MAA 100,28,8
RD 60,24,29696
s_add_u32 m0, s55, 9216
MAA 96,28,4
buffer_load_dwordx4 v21, s[16:19], s52 offen sc1 lds
MAA 112,32,4
TR 72,25,38272
MAA 108,32,0
TR 74,25,38784
MAA 92,28,0
buffer_load_dwordx4 v21, s[16:19], s52 offen offset:1024 sc1 lds
MAA 124,0,36
TR 76,25,38304
MAA 140,0,40
TR 78,25,38816
MAA 144,4,40
TR 80,25,39296
MAA 128,4,36
buffer_load_dword v22, s[16:19], s52 offen offset:2048 sc1 lds
MAA 132,8,36
TR 82,25,39808
s_add_u32 s52, s52, 16384
MAA 148,8,40
TR 84,25,39328
MAA 152,12,40
buffer_load_dwordx4 v[172:175], v26, s[16:19], s75 offen offset:1024 sc1
MAA 136,12,36
TR 86,25,39840
s_add_u32 s75, s75, 2048
MAA 156,16,36
MAA 160,16,40
s_waitcnt vmcnt(20) lgkmcnt(8)
s_barrier
MAA 60,64,44
RD 0,23,36864
MAA 76,68,44
RD 4,23,37888
s_add_u32 m0, s56, 92416
MAA 80,68,48
buffer_load_dwordx4 v18, s[20:23], s54 offen lds
MAA 64,64,48
RD 8,23,39168
MAA 68,64,52
RD 12,23,40192
MAA 84,68,52
TR 20,25,49664
MAA 88,68,56
buffer_load_dwordx4 v19, s[20:23], s54 offen offset:1024 lds
MAA 72,64,56
TR 22,25,50176
s_waitcnt lgkmcnt(6)
MAA 104,72,56
TR 24,25,49696
MAA 120,76,56
TR 26,25,50208
MAA 116,76,52
buffer_load_dwordx4 v20, s[20:23], s54 offen offset:2048 lds
MAA 100,72,52
RD 16,24,38912
s_add_u32 s54, s54, 196608
MAA 96,72,48
MAA 112,76,48
TR 28,25,50688
s_add_u32 m0, s55, 18432
MAA 108,76,44
buffer_load_dwordx4 v21, s[16:19], s52 offen sc1 lds
MAA 92,72,44
TR 30,25,51200
MAA 124,44,80
TR 32,25,50720
MAA 140,44,84
TR 34,25,51232
MAA 144,48,84
buffer_load_dwordx4 v21, s[16:19], s52 offen offset:1024 sc1 lds
MAA 128,48,80
TR 36,25,51712
MAA 132,52,80
TR 38,25,52224
MAA 148,52,84
TR 40,25,51744
MAA 152,56,84
buffer_load_dword v22, s[16:19], s52 offen offset:2048 sc1 lds
MAA 136,56,80
TR 42,25,52256
s_add_u32 s52, s52, 16384
MAA 156,60,80
s_add_u32 s15, s15, 1
MAA 160,60,84
s_cbranch_scc0 .Lk57
s_waitcnt vmcnt(19) lgkmcnt(8)
s_barrier
MAA 60,20,0
RD 44,23,46080
v_add_f32 v164, v164, v168
MAA 76,24,0
RD 48,23,47104
s_add_u32 m0, s56, 104832
MAA 80,24,4
buffer_load_dwordx4 v18, s[20:23], s54 offen lds
MAA 64,20,4
RD 52,23,48384
v_add_f32 v165, v165, v169
MAA 68,20,8
RD 56,23,49408
v_add_f32 v166, v166, v170
MAA 84,24,8
TR 64,25,62080
v_add_f32 v167, v167, v171
MAA 88,24,12
buffer_load_dwordx4 v19, s[20:23], s54 offen offset:1024 lds
MAA 72,20,12
TR 66,25,62592
s_waitcnt lgkmcnt(6)
MAA 104,28,12
TR 68,25,62112
MAA 120,32,12
TR 70,25,62624
MAA 116,32,8
buffer_load_dwordx4 v20, s[20:23], s54 offen offset:2048 lds
MAA 100,28,8
RD 60,24,48128
s_add_u32 s54, s54, 196608
MAA 96,28,4
TR 72,25,63104
s_add_u32 m0, s55, 27648
MAA 112,32,4
TR 74,25,63616
MAA 108,32,0
buffer_load_dwordx4 v21, s[16:19], s52 offen sc1 lds
MAA 92,28,0
TR 76,25,63136
MAA 124,0,36
TR 78,25,63648
MAA 140,0,40
TR 80,25,64128
MAA 144,4,40
buffer_load_dwordx4 v21, s[16:19], s52 offen offset:1024 sc1 lds
MAA 128,4,36
TR 82,25,64640
MAA 132,8,36
TR 84,25,64160
MAA 148,8,40
TR 86,25,64672
MAA 152,12,40
buffer_load_dword v22, s[16:19], s52 offen offset:2048 sc1 lds
MAA 136,12,36
s_add_u32 s52, s52, 16384
MAA 156,16,36
.Lpad17:
s_cbranch_execz .Lnopoll52r
MAA 160,16,40
s_waitcnt vmcnt(19) lgkmcnt(8)
s_barrier
MAA 60,64,44
ds_read_b128 a[0:3], v23
MAA 76,68,44
RD 4,23,1024
s_add_u32 m0, s56, 117248
MAA 80,68,48
buffer_load_dwordx4 v18, s[20:23], s54 offen lds
MAA 64,64,48
RD 8,23,2304
MAA 68,64,52
RD 12,23,3328
MAA 84,68,52
ds_read_b64_tr_b16 a[20:21], v25
MAA 88,68,56
buffer_load_dwordx4 v19, s[20:23], s54 offen offset:1024 lds
MAA 72,64,56
TR 22,25,512
s_waitcnt lgkmcnt(6)
MAA 104,72,56
TR 24,25,32
MAA 120,76,56
TR 26,25,544
MAA 116,76,52
buffer_load_dwordx4 v20, s[20:23], s54 offen offset:2048 lds
MAA 100,72,52
RD 16,24,2048
s_add_u32 s54, s54, 196608
MAA 96,72,48
MAA 112,76,48
TR 28,25,1024
s_add_u32 m0, s55, 36864
MAA 108,76,44
buffer_load_dwordx4 v21, s[16:19], s52 offen sc1 lds
MAA 92,72,44
TR 30,25,1536
MAA 124,44,80
TR 32,25,1056
MAA 140,44,84
TR 34,25,1568
MAA 144,48,84
buffer_load_dwordx4 v21, s[16:19], s52 offen offset:1024 sc1 lds
MAA 128,48,80
TR 36,25,2048
MAA 132,52,80
TR 38,25,2560
MAA 148,52,84
TR 40,25,2080
MAA 152,56,84
buffer_load_dword v22, s[16:19], s52 offen offset:2048 sc1 lds
MAA 136,56,80
TR 42,25,2592
s_add_u32 s52, s52, 16384
MAA 156,60,80
MAA 160,60,84
s_waitcnt vmcnt(19) lgkmcnt(8)
s_barrier
MAA 60,20,0
RD 44,23,9216
s_waitcnt vmcnt(18)
v_add_f32 v164, v164, v172
MAA 76,24,0
RD 48,23,10240
s_add_u32 m0, s56, 129664
MAA 80,24,4
buffer_load_dwordx4 v18, s[20:23], s54 offen lds
MAA 64,20,4
RD 52,23,11520
v_add_f32 v165, v165, v173
MAA 68,20,8
RD 56,23,12544
v_add_f32 v166, v166, v174
MAA 84,24,8
TR 64,25,12416
v_add_f32 v167, v167, v175
MAA 88,24,12
buffer_load_dwordx4 v19, s[20:23], s54 offen offset:1024 lds
MAA 72,20,12
TR 66,25,12928
s_waitcnt lgkmcnt(6)
MAA 104,28,12
TR 68,25,12448
MAA 120,32,12
TR 70,25,12960
MAA 116,32,8
buffer_load_dwordx4 v20, s[20:23], s54 offen offset:2048 lds
MAA 100,28,8
RD 60,24,11264
s_add_u32 s54, s54, 196608
MAA 96,28,4
TR 72,25,13440
s_add_u32 m0, s55, 46080
MAA 112,32,4
TR 74,25,13952
MAA 108,32,0
buffer_load_dwordx4 v21, s[16:19], s52 offen sc1 lds
MAA 92,28,0
TR 76,25,13472
MAA 124,0,36
TR 78,25,13984
MAA 140,0,40
TR 80,25,14464
MAA 144,4,40
buffer_load_dwordx4 v21, s[16:19], s52 offen offset:1024 sc1 lds
MAA 128,4,36
TR 82,25,14976
MAA 132,8,36
TR 84,25,14496
MAA 148,8,40
TR 86,25,15008
MAA 152,12,40
buffer_load_dword v22, s[16:19], s52 offen offset:2048 sc1 lds
MAA 136,12,36
s_add_u32 s52, s52, 16384
v_permlane32_swap_b32 v164, v166
MAA 156,16,36
v_permlane32_swap_b32 v165, v167
MAA 160,16,40
s_waitcnt vmcnt(18) lgkmcnt(8)
s_barrier
MAA 60,64,44
RD 0,23,18432
v_add_f32 v164, v164, v166
MAA 76,68,44
RD 4,23,19456
s_add_u32 m0, s59, 0
MAA 80,68,48
RD 8,23,20736
s_mov_b32 s58, 1048576
MAA 64,64,48
buffer_load_dwordx4 v5, s[24:27], s58 offen lds
MAA 68,64,52
RD 12,23,21760
v_add_f32 v165, v165, v167
MAA 84,68,52
TR 20,25,24832
v_mul_f32 v164, 0xba800000, v164
MAA 88,68,56
TR 22,25,25344
v_mul_f32 v165, 0x3a800000, v165
MAA 72,64,56
buffer_load_dwordx4 v6, s[24:27], s58 offen offset:1024 lds
s_waitcnt lgkmcnt(6)
MAA 104,72,56
TR 24,25,24864
s_add_u32 m0, s59, 58240
MAA 120,76,56
TR 26,25,25376
s_mov_b32 s58, 1966080
MAA 116,76,52
RD 16,24,20480
v_fma_f32 v165, -v164, v164, v165
MAA 100,72,52
buffer_load_dwordx4 v5, s[24:27], s58 offen lds
MAA 96,72,48
TR 28,25,25856
v_max_f32 v165, 0, v165
MAA 112,76,48
TR 30,25,26368
v_add_f32 v165, 0x3727c5ac, v165
MAA 108,76,44
TR 32,25,25888
MAA 92,72,44
buffer_load_dwordx4 v6, s[24:27], s58 offen offset:1024 lds
MAA 124,44,80
TR 34,25,26400
s_add_u32 m0, s59, 66560
MAA 140,44,84
TR 36,25,26880
s_mov_b32 s58, 0
MAA 144,48,84
TR 38,25,27392
MAA 128,48,80
buffer_load_dwordx4 v5, s[24:27], s58 offen lds
MAA 132,52,80
TR 40,25,26912
MAA 148,52,84
TR 42,25,27424
MAA 152,56,84
v_rsq_f32 v166, v165
MAA 136,56,80
buffer_load_dwordx4 v6, s[24:27], s58 offen offset:1024 lds
MAA 156,60,80
MAA 160,60,84
s_waitcnt vmcnt(18) lgkmcnt(8)
s_barrier
MAA 60,20,0
RD 44,23,27648
v_mov_b32 v165, v166
MAA 76,24,0
RD 48,23,28672
s_add_u32 m0, s59, 8320
MAA 80,24,4
RD 52,23,29952
s_mov_b32 s58, 1179648
MAA 64,20,4
buffer_load_dwordx4 v5, s[24:27], s58 offen lds
MAA 68,20,8
RD 56,23,30976
v_mul_f32 v166, 0x3e8293ee, v166
MAA 84,24,8
ds_write_b128 v7, v[164:167]
MAA 88,24,12
TR 64,25,37248
MAA 72,20,12
buffer_load_dwordx4 v6, s[24:27], s58 offen offset:1024 lds
s_waitcnt lgkmcnt(6)
MAA 104,28,12
TR 66,25,37760
s_add_u32 m0, s59, 74880
MAA 120,32,12
TR 68,25,37280
s_mov_b32 s58, 131072
MAA 116,32,8
TR 70,25,37792
MAA 100,28,8
buffer_load_dwordx4 v5, s[24:27], s58 offen lds
MAA 96,28,4
RD 60,24,29696
MAA 112,32,4
TR 72,25,38272
MAA 108,32,0
TR 74,25,38784
MAA 92,28,0
buffer_load_dwordx4 v6, s[24:27], s58 offen offset:1024 lds
MAA 124,0,36
TR 76,25,38304
s_add_u32 m0, s59, 83200
MAA 140,0,40
TR 78,25,38816
s_mov_b32 s58, 262144
MAA 144,4,40
TR 80,25,39296
MAA 128,4,36
buffer_load_dwordx4 v5, s[24:27], s58 offen lds
MAA 132,8,36
TR 82,25,39808
MAA 148,8,40
TR 84,25,39328
MAA 152,12,40
TR 86,25,39840
MAA 136,12,36
buffer_load_dwordx4 v6, s[24:27], s58 offen offset:1024 lds
MAA 156,16,36
MAA 160,16,40
s_waitcnt vmcnt(18) lgkmcnt(8)
s_barrier
MAA 60,64,44
ds_write_b32 v17, v164
MAA 76,68,44
ds_write_b32 v17, v165 offset:1024
s_add_u32 m0, s59, 16640
MAA 80,68,48
RD 0,23,36864
s_mov_b32 s58, 1310720
MAA 64,64,48
buffer_load_dwordx4 v5, s[24:27], s58 offen lds
MAA 68,64,52
RD 4,23,37888
MAA 84,68,52
RD 8,23,39168
MAA 88,68,56
RD 12,23,40192
MAA 72,64,56
TR 20,25,49664
s_waitcnt lgkmcnt(7)
MAA 104,72,56
TR 22,25,50176
MAA 120,76,56
buffer_load_dwordx4 v6, s[24:27], s58 offen offset:1024 lds
MAA 116,76,52
TR 24,25,49696
s_add_u32 m0, s59, 91520
MAA 100,72,52
TR 26,25,50208
s_mov_b32 s58, 393216
MAA 96,72,48
RD 16,24,38912
MAA 112,76,48
TR 28,25,50688
MAA 108,76,44
TR 30,25,51200
MAA 92,72,44
buffer_load_dwordx4 v5, s[24:27], s58 offen lds
MAA 124,44,80
TR 32,25,50720
MAA 140,44,84
TR 34,25,51232
MAA 144,48,84
TR 36,25,51712
MAA 128,48,80
TR 38,25,52224
MAA 132,52,80
TR 40,25,51744
MAA 148,52,84
buffer_load_dwordx4 v6, s[24:27], s58 offen offset:1024 lds
MAA 152,56,84
TR 42,25,52256
MAA 136,56,80
MAA 156,60,80
MAA 160,60,84
s_waitcnt vmcnt(16) lgkmcnt(8)
s_barrier
MAA 60,20,0
RD 44,23,46080
MAA 76,24,0
RD 48,23,47104
s_add_u32 m0, s59, 24960
MAA 80,24,4
RD 52,23,48384
s_mov_b32 s58, 1441792
MAA 64,20,4
buffer_load_dwordx4 v5, s[24:27], s58 offen lds
MAA 68,20,8
RD 56,23,49408
MAA 84,24,8
TR 64,25,62080
MAA 88,24,12
TR 66,25,62592
MAA 72,20,12
buffer_load_dwordx4 v6, s[24:27], s58 offen offset:1024 lds
s_waitcnt lgkmcnt(6)
MAA 104,28,12
TR 68,25,62112
s_add_u32 m0, s59, 99840
MAA 120,32,12
TR 70,25,62624
s_mov_b32 s58, 524288
MAA 116,32,8
RD 60,24,48128
MAA 100,28,8
buffer_load_dwordx4 v5, s[24:27], s58 offen lds
MAA 96,28,4
TR 72,25,63104
MAA 112,32,4
TR 74,25,63616
MAA 108,32,0
TR 76,25,63136
MAA 92,28,0
buffer_load_dwordx4 v6, s[24:27], s58 offen offset:1024 lds
MAA 124,0,36
TR 78,25,63648
s_add_u32 m0, s59, 108160
MAA 140,0,40
TR 80,25,64128
s_mov_b32 s58, 655360
MAA 144,4,40
TR 82,25,64640
MAA 128,4,36
buffer_load_dwordx4 v5, s[24:27], s58 offen lds
MAA 132,8,36
TR 84,25,64160
MAA 148,8,40
TR 86,25,64672
MAA 152,12,40
MAA 136,12,36
buffer_load_dwordx4 v6, s[24:27], s58 offen offset:1024 lds
MAA 156,16,36
MAA 160,16,40
s_waitcnt lgkmcnt(0)
s_barrier
MAA 156,60,80
ds_read_b128 v[232:235], v10 offset:1792
s_add_u32 m0, s59, 33280
MAA 160,60,84
ds_read_b128 v[228:231], v10 offset:1536
s_mov_b32 s58, 1572864
MAA 104,72,56
ds_read_b128 v[224:227], v10 offset:1280
MAA 120,76,56
ds_read_b128 v[220:223], v10 offset:1024
MAA 136,56,80
ds_read_b128 v[240:243], v11 offset:704
MAA 152,56,84
ds_read_b128 v[244:247], v11 offset:1728
MAA 100,72,52
buffer_load_dwordx4 v5, s[24:27], s58 offen lds
MAA 116,76,52
ds_read_b128 v[18:21], v11 offset:448
MAA 96,72,48
ds_read_b128 v[22:25], v11 offset:1472
s_waitcnt lgkmcnt(7)
v_pk_fma_f32 v[104:105], v[36:37], v[232:233], v[104:105] op_sel_hi:[1,0,1]
v_pk_mul_f32 v[104:105], v[104:105], v[232:233] op_sel:[0,1] op_sel_hi:[1,1]
v_pk_fma_f32 v[106:107], v[38:39], v[232:233], v[106:107] op_sel_hi:[1,0,1]
v_pk_mul_f32 v[106:107], v[106:107], v[232:233] op_sel:[0,1] op_sel_hi:[1,1]
v_pk_fma_f32 v[120:121], v[40:41], v[232:233], v[120:121] op_sel_hi:[1,0,1]
v_pk_mul_f32 v[120:121], v[120:121], v[232:233] op_sel:[0,1] op_sel_hi:[1,1]
v_pk_fma_f32 v[122:123], v[42:43], v[232:233], v[122:123] op_sel_hi:[1,0,1]
v_pk_mul_f32 v[122:123], v[122:123], v[232:233] op_sel:[0,1] op_sel_hi:[1,1]
s_waitcnt lgkmcnt(6)
v_pk_fma_f32 v[100:101], v[36:37], v[228:229], v[100:101] op_sel_hi:[1,0,1]
v_pk_mul_f32 v[100:101], v[100:101], v[228:229] op_sel:[0,1] op_sel_hi:[1,1]
s_waitcnt lgkmcnt(3)
v_pk_fma_f32 v[156:157], v[240:241], v[44:45], v[156:157] op_sel_hi:[1,0,1]
v_pk_fma_f32 v[158:159], v[242:243], v[44:45], v[158:159] op_sel_hi:[1,0,1]
v_pk_fma_f32 v[160:161], v[240:241], v[44:45], v[160:161] op_sel:[0,1,0] op_sel_hi:[1,1,1]
v_pk_fma_f32 v[162:163], v[242:243], v[44:45], v[162:163] op_sel:[0,1,0] op_sel_hi:[1,1,1]
s_waitcnt lgkmcnt(2)
v_pk_mul_f32 v[156:157], v[156:157], v[244:245]
v_pk_mul_f32 v[158:159], v[158:159], v[246:247]
v_pk_mul_f32 v[160:161], v[160:161], v[244:245]
v_pk_mul_f32 v[162:163], v[162:163], v[246:247]
v_pk_fma_f32 v[102:103], v[38:39], v[228:229], v[102:103] op_sel_hi:[1,0,1]
v_pk_mul_f32 v[102:103], v[102:103], v[228:229] op_sel:[0,1] op_sel_hi:[1,1]
v_pk_fma_f32 v[116:117], v[40:41], v[228:229], v[116:117] op_sel_hi:[1,0,1]
v_pk_mul_f32 v[116:117], v[116:117], v[228:229] op_sel:[0,1] op_sel_hi:[1,1]
s_waitcnt lgkmcnt(1)
v_pk_fma_f32 v[136:137], v[18:19], v[44:45], v[136:137] op_sel_hi:[1,0,1]
v_pk_fma_f32 v[138:139], v[20:21], v[44:45], v[138:139] op_sel_hi:[1,0,1]
v_pk_fma_f32 v[152:153], v[18:19], v[44:45], v[152:153] op_sel:[0,1,0] op_sel_hi:[1,1,1]
v_pk_fma_f32 v[154:155], v[20:21], v[44:45], v[154:155] op_sel:[0,1,0] op_sel_hi:[1,1,1]
s_waitcnt lgkmcnt(0)
v_pk_mul_f32 v[136:137], v[136:137], v[22:23]
v_pk_mul_f32 v[138:139], v[138:139], v[24:25]
v_pk_mul_f32 v[152:153], v[152:153], v[22:23]
v_pk_mul_f32 v[154:155], v[154:155], v[24:25]
v_pk_fma_f32 v[118:119], v[42:43], v[228:229], v[118:119] op_sel_hi:[1,0,1]
v_pk_mul_f32 v[118:119], v[118:119], v[228:229] op_sel:[0,1] op_sel_hi:[1,1]
v_pk_fma_f32 v[96:97], v[36:37], v[224:225], v[96:97] op_sel_hi:[1,0,1]
v_pk_mul_f32 v[96:97], v[96:97], v[224:225] op_sel:[0,1] op_sel_hi:[1,1]
v_pk_fma_f32 v[98:99], v[38:39], v[224:225], v[98:99] op_sel_hi:[1,0,1]
v_pk_mul_f32 v[98:99], v[98:99], v[224:225] op_sel:[0,1] op_sel_hi:[1,1]
v_cvt_pk_bf16_f32 v236, v156, v157
v_cvt_pk_bf16_f32 v237, v158, v159
MAA 112,76,48
buffer_load_dwordx4 v6, s[24:27], s58 offen offset:1024 lds
MAA 92,72,44
ds_read_b128 v[240:243], v11 offset:384
v_cvt_pk_bf16_f32 v238, v160, v161
MAA 108,76,44
ds_read_b128 v[244:247], v11 offset:1408
v_cvt_pk_bf16_f32 v239, v162, v163
MAA 72,64,56
ds_write_b128 v8, v[236:239] offset:1024
s_add_u32 m0, s59, 41600
MAA 88,68,56
ds_read_b128 v[18:21], v11 offset:320
s_mov_b32 s58, 1703936
buffer_load_dwordx4 v5, s[24:27], s58 offen lds
s_nop 1
v_pk_fma_f32 v[72:73], v[28:29], v[232:233], v[72:73] op_sel_hi:[1,0,1]
v_pk_fma_f32 v[74:75], v[30:31], v[232:233], v[74:75] op_sel_hi:[1,0,1]
s_nop 0
v_pk_fma_f32 v[88:89], v[32:33], v[232:233], v[88:89] op_sel_hi:[1,0,1]
v_pk_fma_f32 v[90:91], v[34:35], v[232:233], v[90:91] op_sel_hi:[1,0,1]
v_pk_fma_f32 v[112:113], v[40:41], v[224:225], v[112:113] op_sel_hi:[1,0,1]
v_pk_mul_f32 v[112:113], v[112:113], v[224:225] op_sel:[0,1] op_sel_hi:[1,1]
v_pk_fma_f32 v[114:115], v[42:43], v[224:225], v[114:115] op_sel_hi:[1,0,1]
v_pk_mul_f32 v[114:115], v[114:115], v[224:225] op_sel:[0,1] op_sel_hi:[1,1]
v_pk_fma_f32 v[92:93], v[36:37], v[220:221], v[92:93] op_sel_hi:[1,0,1]
v_pk_mul_f32 v[92:93], v[92:93], v[220:221] op_sel:[0,1] op_sel_hi:[1,1]
v_pk_fma_f32 v[94:95], v[38:39], v[220:221], v[94:95] op_sel_hi:[1,0,1]
v_pk_mul_f32 v[94:95], v[94:95], v[220:221] op_sel:[0,1] op_sel_hi:[1,1]
v_pk_fma_f32 v[108:109], v[40:41], v[220:221], v[108:109] op_sel_hi:[1,0,1]
v_pk_mul_f32 v[108:109], v[108:109], v[220:221] op_sel:[0,1] op_sel_hi:[1,1]
v_pk_fma_f32 v[110:111], v[42:43], v[220:221], v[110:111] op_sel_hi:[1,0,1]
v_pk_mul_f32 v[110:111], v[110:111], v[220:221] op_sel:[0,1] op_sel_hi:[1,1]
v_cvt_pk_bf16_f32 v196, v104, v105
v_cvt_pk_bf16_f32 v197, v106, v107
MAA 132,52,80
buffer_load_dwordx4 v6, s[24:27], s58 offen offset:1024 lds
MAA 148,52,84
s_waitcnt lgkmcnt(1)
s_barrier
ds_read_b128 v[180:183], v9
MAA 68,64,52
ds_read_b64 v[200:201], v9 offset:1024
s_add_u32 m0, s59, 49920
MAA 84,68,52
ds_read_b64 v[210:211], v9 offset:1032
s_mov_b32 s58, 1835008
MAA 128,48,80
buffer_load_dwordx4 v5, s[24:27], s58 offen lds
v_cvt_pk_bf16_f32 v198, v120, v121
v_cvt_pk_bf16_f32 v199, v122, v123
v_cvt_pk_bf16_f32 v208, v136, v137
v_pk_fma_f32 v[132:133], v[240:241], v[44:45], v[132:133] op_sel_hi:[1,0,1]
v_pk_mul_f32 v[132:133], v[132:133], v[244:245]
v_pk_fma_f32 v[134:135], v[242:243], v[44:45], v[134:135] op_sel_hi:[1,0,1]
v_pk_mul_f32 v[134:135], v[134:135], v[246:247]
v_pk_fma_f32 v[148:149], v[240:241], v[44:45], v[148:149] op_sel:[0,1,0] op_sel_hi:[1,1,1]
v_pk_mul_f32 v[148:149], v[148:149], v[244:245]
v_pk_fma_f32 v[150:151], v[242:243], v[44:45], v[150:151] op_sel:[0,1,0] op_sel_hi:[1,1,1]
v_pk_mul_f32 v[150:151], v[150:151], v[246:247]
v_pk_fma_f32 v[68:69], v[28:29], v[228:229], v[68:69] op_sel_hi:[1,0,1]
v_pk_fma_f32 v[70:71], v[30:31], v[228:229], v[70:71] op_sel_hi:[1,0,1]
v_pk_fma_f32 v[84:85], v[32:33], v[228:229], v[84:85] op_sel_hi:[1,0,1]
v_pk_fma_f32 v[86:87], v[34:35], v[228:229], v[86:87] op_sel_hi:[1,0,1]
s_waitcnt lgkmcnt(3)
v_pk_fma_f32 v[128:129], v[18:19], v[44:45], v[128:129] op_sel_hi:[1,0,1]
v_pk_fma_f32 v[130:131], v[20:21], v[44:45], v[130:131] op_sel_hi:[1,0,1]
v_cvt_pk_bf16_f32 v209, v138, v139
v_cvt_pk_bf16_f32 v218, v152, v153
MAA 144,48,84
buffer_load_dwordx4 v6, s[24:27], s58 offen offset:1024 lds
MAA 64,64,48
ds_read_b128 v[22:25], v11 offset:1344
s_add_u32 m0, s59, 116480
MAA 80,68,48
ds_read_b128 v[240:243], v11 offset:256
s_mov_b32 s58, 786432
MAA 124,44,80
ds_read_b128 v[244:247], v11 offset:1280
v_cvt_pk_bf16_f32 v219, v154, v155
MAA 140,44,84
buffer_load_dwordx4 v5, s[24:27], s58 offen lds
MAA 60,64,44
v_cvt_pk_bf16_f32 v192, v100, v101
v_cvt_pk_bf16_f32 v193, v102, v103
MAA 76,68,44
v_cvt_pk_bf16_f32 v194, v116, v117
v_cvt_pk_bf16_f32 v195, v118, v119
v_cvt_pk_bf16_f32 v176, v72, v73
v_cvt_pk_bf16_f32 v177, v74, v75
v_cvt_pk_bf16_f32 v178, v88, v89
v_cvt_pk_bf16_f32 v179, v90, v91
v_pk_fma_f32 v[144:145], v[18:19], v[44:45], v[144:145] op_sel:[0,1,0] op_sel_hi:[1,1,1]
v_pk_fma_f32 v[146:147], v[20:21], v[44:45], v[146:147] op_sel:[0,1,0] op_sel_hi:[1,1,1]
v_pk_fma_f32 v[64:65], v[28:29], v[224:225], v[64:65] op_sel_hi:[1,0,1]
v_pk_fma_f32 v[66:67], v[30:31], v[224:225], v[66:67] op_sel_hi:[1,0,1]
v_pk_fma_f32 v[80:81], v[32:33], v[224:225], v[80:81] op_sel_hi:[1,0,1]
s_waitcnt lgkmcnt(2)
v_pk_mul_f32 v[128:129], v[128:129], v[22:23]
v_pk_mul_f32 v[130:131], v[130:131], v[24:25]
v_pk_mul_f32 v[144:145], v[144:145], v[22:23]
v_pk_mul_f32 v[146:147], v[146:147], v[24:25]
v_pk_fma_f32 v[82:83], v[34:35], v[224:225], v[82:83] op_sel_hi:[1,0,1]
s_waitcnt lgkmcnt(1)
v_pk_fma_f32 v[124:125], v[240:241], v[44:45], v[124:125] op_sel_hi:[1,0,1]
v_pk_fma_f32 v[126:127], v[242:243], v[44:45], v[126:127] op_sel_hi:[1,0,1]
v_pk_fma_f32 v[140:141], v[240:241], v[44:45], v[140:141] op_sel:[0,1,0] op_sel_hi:[1,1,1]
s_waitcnt lgkmcnt(0)
v_pk_mul_f32 v[124:125], v[124:125], v[244:245]
.Lpad18:
s_cbranch_execz .Lnopoll52r
v_pk_mul_f32 v[126:127], v[126:127], v[246:247]
v_pk_mul_f32 v[140:141], v[140:141], v[244:245]
v_pk_fma_f32 v[142:143], v[242:243], v[44:45], v[142:143] op_sel:[0,1,0] op_sel_hi:[1,1,1]
v_pk_mul_f32 v[142:143], v[142:143], v[246:247]
v_pk_fma_f32 v[60:61], v[28:29], v[220:221], v[60:61] op_sel_hi:[1,0,1]
v_pk_fma_f32 v[62:63], v[30:31], v[220:221], v[62:63] op_sel_hi:[1,0,1]
v_pk_fma_f32 v[76:77], v[32:33], v[220:221], v[76:77] op_sel_hi:[1,0,1]
v_pk_fma_f32 v[78:79], v[34:35], v[220:221], v[78:79] op_sel_hi:[1,0,1]
v_cvt_pk_bf16_f32 v206, v132, v133
v_cvt_pk_bf16_f32 v207, v134, v135
v_mfma_f32_16x16x32_bf16 v[104:107], v[192:195], v[176:179], v[46:49]
buffer_load_dwordx4 v6, s[24:27], s58 offen offset:1024 lds
v_mfma_f32_16x16x32_bf16 v[120:123], v[196:199], v[176:179], v[50:53]
s_add_u32 m0, s59, 124800
s_mov_b32 s58, 917504
v_cvt_pk_bf16_f32 v216, v148, v149
v_cvt_pk_bf16_f32 v217, v150, v151
s_nop 1
v_max3_f32 v88, v104, v105, v106
v_cvt_pk_bf16_f32 v188, v96, v97
v_cvt_pk_bf16_f32 v189, v98, v99
v_cvt_pk_bf16_f32 v190, v112, v113
v_max3_f32 v89, v107, v120, v121
v_max3_f32 v88, v88, v122, v123
v_max_f32 v90, v88, v89
v_max_f32 v89, v88, v89
buffer_load_dwordx4 v5, s[24:27], s58 offen lds
s_nop 0
v_permlane16_swap_b32 v90, v89
v_cvt_pk_bf16_f32 v191, v114, v115
v_max_f32 v88, v90, v89
v_max_f32 v89, v90, v89
v_cvt_pk_bf16_f32 v172, v68, v69
v_cvt_pk_bf16_f32 v173, v70, v71
v_permlane32_swap_b32 v88, v89
v_cvt_pk_bf16_f32 v174, v84, v85
v_max_f32 v88, v88, v89
v_mul_f32 v88, v88, v234
v_pk_fma_f32 v[104:105], v[104:105], v[234:235], v[88:89] op_sel_hi:[1,0,0] neg_lo:[0,0,1] neg_hi:[0,0,1]
buffer_load_dwordx4 v6, s[24:27], s58 offen offset:1024 lds
v_pk_fma_f32 v[106:107], v[106:107], v[234:235], v[88:89] op_sel_hi:[1,0,0] neg_lo:[0,0,1] neg_hi:[0,0,1]
v_pk_fma_f32 v[120:121], v[120:121], v[234:235], v[88:89] op_sel_hi:[1,0,0] neg_lo:[0,0,1] neg_hi:[0,0,1]
v_pk_fma_f32 v[122:123], v[122:123], v[234:235], v[88:89] op_sel_hi:[1,0,0] neg_lo:[0,0,1] neg_hi:[0,0,1]
v_exp_f32 v104, v104
v_exp_f32 v105, v105
v_exp_f32 v106, v106
v_exp_f32 v107, v107
v_exp_f32 v120, v120
v_exp_f32 v121, v121
v_exp_f32 v122, v122
v_exp_f32 v123, v123
v_cvt_pk_bf16_f32 v72, v104, v105
v_cvt_pk_bf16_f32 v73, v106, v107
v_cvt_pk_bf16_f32 v74, v120, v121
v_cvt_pk_bf16_f32 v75, v122, v123
v_cvt_pk_bf16_f32 v175, v86, v87
v_cvt_pk_bf16_f32 v204, v128, v129
v_mfma_f32_16x16x32_bf16 v[88:91], v[248:251], v[72:75], 0
v_cvt_pk_bf16_f32 v205, v130, v131
v_cvt_pk_bf16_f32 v214, v144, v145
v_mfma_f32_16x16x32_bf16 v[104:107], v[206:209], v[72:75], 0
v_cvt_pk_bf16_f32 v215, v146, v147
v_cvt_pk_bf16_f32 v184, v92, v93
v_mfma_f32_16x16x32_bf16 v[120:123], v[216:219], v[72:75], 0
s_nop 1
v_rcp_f32 v88, v88
v_mfma_f32_16x16x32_bf16 v[100:103], v[188:191], v[172:175], v[46:49]
v_cvt_pk_bf16_f32 v185, v94, v95
v_cvt_pk_bf16_f32 v186, v108, v109
v_mfma_f32_16x16x32_bf16 v[116:119], v[192:195], v[172:175], v[50:53]
v_cvt_pk_bf16_f32 v187, v110, v111
v_cvt_pk_bf16_f32 v168, v64, v65
v_cvt_pk_bf16_f32 v169, v66, v67
s_nop 1
v_max3_f32 v84, v100, v101, v102
v_cvt_pk_bf16_f32 v170, v80, v81
v_pk_mul_f32 v[104:105], v[104:105], v[88:89] op_sel_hi:[1,0]
v_pk_mul_f32 v[106:107], v[106:107], v[88:89] op_sel_hi:[1,0]
v_pk_mul_f32 v[120:121], v[120:121], v[88:89] op_sel_hi:[1,0]
v_pk_mul_f32 v[122:123], v[122:123], v[88:89] op_sel_hi:[1,0]
v_cvt_pk_bf16_f32 v176, v104, v105
v_cvt_pk_bf16_f32 v177, v106, v107
v_cvt_pk_bf16_f32 v178, v120, v121
v_cvt_pk_bf16_f32 v179, v122, v123
buffer_store_dwordx4 v[176:179], v4, s[16:19], s74 offen offset:3072 sc1
v_max3_f32 v85, v103, v116, v117
v_max3_f32 v84, v84, v118, v119
v_max_f32 v86, v84, v85
v_max_f32 v85, v84, v85
v_cvt_pk_bf16_f32 v171, v82, v83
v_cvt_pk_bf16_f32 v202, v124, v125
v_permlane16_swap_b32 v86, v85
v_mfma_f32_16x16x32_bf16 v[96:99], v[184:187], v[168:171], v[46:49]
v_max_f32 v84, v86, v85
v_max_f32 v85, v86, v85
v_mfma_f32_16x16x32_bf16 v[112:115], v[188:191], v[168:171], v[50:53]
s_nop 0
v_permlane32_swap_b32 v84, v85
v_cvt_pk_bf16_f32 v203, v126, v127
v_max_f32 v84, v84, v85
v_mul_f32 v84, v84, v230
v_pk_fma_f32 v[100:101], v[100:101], v[230:231], v[84:85] op_sel_hi:[1,0,0] neg_lo:[0,0,1] neg_hi:[0,0,1]
v_pk_fma_f32 v[102:103], v[102:103], v[230:231], v[84:85] op_sel_hi:[1,0,0] neg_lo:[0,0,1] neg_hi:[0,0,1]
v_pk_fma_f32 v[116:117], v[116:117], v[230:231], v[84:85] op_sel_hi:[1,0,0] neg_lo:[0,0,1] neg_hi:[0,0,1]
v_pk_fma_f32 v[118:119], v[118:119], v[230:231], v[84:85] op_sel_hi:[1,0,0] neg_lo:[0,0,1] neg_hi:[0,0,1]
v_exp_f32 v100, v100
v_exp_f32 v101, v101
v_exp_f32 v102, v102
v_exp_f32 v103, v103
v_exp_f32 v116, v116
v_exp_f32 v117, v117
v_exp_f32 v118, v118
v_exp_f32 v119, v119
v_cvt_pk_bf16_f32 v68, v100, v101
v_cvt_pk_bf16_f32 v69, v102, v103
v_cvt_pk_bf16_f32 v70, v116, v117
v_cvt_pk_bf16_f32 v71, v118, v119
v_cvt_pk_bf16_f32 v212, v140, v141
v_cvt_pk_bf16_f32 v213, v142, v143
v_mfma_f32_16x16x32_bf16 v[84:87], v[248:251], v[68:71], 0
v_max3_f32 v80, v96, v97, v98
v_max3_f32 v81, v99, v112, v113
v_mfma_f32_16x16x32_bf16 v[100:103], v[204:207], v[68:71], 0
v_max3_f32 v80, v80, v114, v115
v_max_f32 v82, v80, v81
v_mfma_f32_16x16x32_bf16 v[116:119], v[214:217], v[68:71], 0
s_nop 1
v_rcp_f32 v84, v84
v_max_f32 v81, v80, v81
v_cvt_pk_bf16_f32 v164, v60, v61
v_cvt_pk_bf16_f32 v165, v62, v63
v_pk_mul_f32 v[100:101], v[100:101], v[84:85] op_sel_hi:[1,0]
v_pk_mul_f32 v[102:103], v[102:103], v[84:85] op_sel_hi:[1,0]
v_pk_mul_f32 v[116:117], v[116:117], v[84:85] op_sel_hi:[1,0]
v_pk_mul_f32 v[118:119], v[118:119], v[84:85] op_sel_hi:[1,0]
v_cvt_pk_bf16_f32 v172, v100, v101
v_cvt_pk_bf16_f32 v173, v102, v103
v_cvt_pk_bf16_f32 v174, v116, v117
v_cvt_pk_bf16_f32 v175, v118, v119
buffer_store_dwordx4 v[172:175], v4, s[16:19], s74 offen offset:2048 sc1
v_permlane16_swap_b32 v82, v81
v_cvt_pk_bf16_f32 v166, v76, v77
v_max_f32 v80, v82, v81
v_max_f32 v81, v82, v81
v_cvt_pk_bf16_f32 v167, v78, v79
s_nop 0
v_permlane32_swap_b32 v80, v81
v_mfma_f32_16x16x32_bf16 v[92:95], v[180:183], v[164:167], v[46:49]
v_max_f32 v80, v80, v81
v_mul_f32 v80, v80, v226
v_mfma_f32_16x16x32_bf16 v[108:111], v[184:187], v[164:167], v[50:53]
s_nop 4
v_max3_f32 v76, v92, v93, v94
v_pk_fma_f32 v[96:97], v[96:97], v[226:227], v[80:81] op_sel_hi:[1,0,0] neg_lo:[0,0,1] neg_hi:[0,0,1]
v_pk_fma_f32 v[98:99], v[98:99], v[226:227], v[80:81] op_sel_hi:[1,0,0] neg_lo:[0,0,1] neg_hi:[0,0,1]
v_pk_fma_f32 v[112:113], v[112:113], v[226:227], v[80:81] op_sel_hi:[1,0,0] neg_lo:[0,0,1] neg_hi:[0,0,1]
v_pk_fma_f32 v[114:115], v[114:115], v[226:227], v[80:81] op_sel_hi:[1,0,0] neg_lo:[0,0,1] neg_hi:[0,0,1]
v_exp_f32 v96, v96
v_exp_f32 v97, v97
v_exp_f32 v98, v98
v_exp_f32 v99, v99
v_exp_f32 v112, v112
v_exp_f32 v113, v113
v_exp_f32 v114, v114
v_exp_f32 v115, v115
v_cvt_pk_bf16_f32 v64, v96, v97
v_cvt_pk_bf16_f32 v65, v98, v99
v_cvt_pk_bf16_f32 v66, v112, v113
v_cvt_pk_bf16_f32 v67, v114, v115
v_max3_f32 v77, v95, v108, v109
v_max3_f32 v76, v76, v110, v111
v_mfma_f32_16x16x32_bf16 v[80:83], v[248:251], v[64:67], 0
v_max_f32 v78, v76, v77
v_max_f32 v77, v76, v77
v_mfma_f32_16x16x32_bf16 v[96:99], v[202:205], v[64:67], 0
s_nop 0
v_permlane16_swap_b32 v78, v77
v_mfma_f32_16x16x32_bf16 v[112:115], v[212:215], v[64:67], 0
s_nop 1
v_rcp_f32 v80, v80
v_max_f32 v76, v78, v77
v_max_f32 v77, v78, v77
v_pk_mul_f32 v[96:97], v[96:97], v[80:81] op_sel_hi:[1,0]
v_pk_mul_f32 v[98:99], v[98:99], v[80:81] op_sel_hi:[1,0]
s_nop 0
v_pk_mul_f32 v[112:113], v[112:113], v[80:81] op_sel_hi:[1,0]
v_pk_mul_f32 v[114:115], v[114:115], v[80:81] op_sel_hi:[1,0]
v_cvt_pk_bf16_f32 v168, v96, v97
v_cvt_pk_bf16_f32 v169, v98, v99
v_cvt_pk_bf16_f32 v170, v112, v113
v_cvt_pk_bf16_f32 v171, v114, v115
buffer_store_dwordx4 v[168:171], v4, s[16:19], s74 offen offset:1024 sc1
v_permlane32_swap_b32 v76, v77
v_max_f32 v76, v76, v77
v_mul_f32 v76, v76, v222
v_pk_fma_f32 v[92:93], v[92:93], v[222:223], v[76:77] op_sel_hi:[1,0,0] neg_lo:[0,0,1] neg_hi:[0,0,1]
v_pk_fma_f32 v[94:95], v[94:95], v[222:223], v[76:77] op_sel_hi:[1,0,0] neg_lo:[0,0,1] neg_hi:[0,0,1]
v_pk_fma_f32 v[108:109], v[108:109], v[222:223], v[76:77] op_sel_hi:[1,0,0] neg_lo:[0,0,1] neg_hi:[0,0,1]
v_pk_fma_f32 v[110:111], v[110:111], v[222:223], v[76:77] op_sel_hi:[1,0,0] neg_lo:[0,0,1] neg_hi:[0,0,1]
v_exp_f32 v92, v92
v_exp_f32 v93, v93
v_exp_f32 v94, v94
v_exp_f32 v95, v95
v_exp_f32 v108, v108
v_exp_f32 v109, v109
v_exp_f32 v110, v110
v_exp_f32 v111, v111
v_cvt_pk_bf16_f32 v60, v92, v93
v_cvt_pk_bf16_f32 v61, v94, v95
v_cvt_pk_bf16_f32 v62, v108, v109
v_cvt_pk_bf16_f32 v63, v110, v111
s_nop 1
v_mfma_f32_16x16x32_bf16 v[76:79], v[248:251], v[60:63], 0
v_mfma_f32_16x16x32_bf16 v[92:95], v[200:203], v[60:63], 0
v_mfma_f32_16x16x32_bf16 v[108:111], v[210:213], v[60:63], 0
s_nop 5
v_rcp_f32 v76, v76
s_nop 0
v_pk_mul_f32 v[92:93], v[92:93], v[76:77] op_sel_hi:[1,0]
v_pk_mul_f32 v[94:95], v[94:95], v[76:77] op_sel_hi:[1,0]
v_pk_mul_f32 v[108:109], v[108:109], v[76:77] op_sel_hi:[1,0]
v_pk_mul_f32 v[110:111], v[110:111], v[76:77] op_sel_hi:[1,0]
v_cvt_pk_bf16_f32 v164, v92, v93
v_cvt_pk_bf16_f32 v165, v94, v95
v_cvt_pk_bf16_f32 v166, v108, v109
v_cvt_pk_bf16_f32 v167, v110, v111
buffer_store_dwordx4 v[164:167], v4, s[16:19], s74 offen sc1
s_nop 1
.Lqkve55:
.Lpad19:
s_cbranch_execz .Lnopoll52r
s_lshl_b32 s62, s3, 11
s_add_u32 s62, s62, s84
v_lshl_add_u32 v4, v1, 4, s62
v_lshrrev_b32 v2, 3, v1
v_cmp_eq_u32 vcc, 3, v2
v_add_u32 v2, 67108480, v4
s_nop 0
v_cndmask_b32 v4, v4, v2, vcc
v_bfe_u32 v5, v1, 3, 1
v_lshrrev_b32 v2, 4, v1
v_lshl_add_u32 v5, v2, 3, v5
s_lshl_b32 s62, s3, 1
v_add_u32 v5, s62, v5
v_mul_u32_u24 v5, 2048, v5
v_and_b32 v2, 7, v1
v_lshl_add_u32 v5, v2, 4, v5
s_lshl_b32 s62, s7, 7
v_add_u32 v5, s62, v5
v_add_u32 v6, 64512, v5
v_bfe_u32 v8, v1, 3, 2
v_mul_u32_u24 v8, 2080, v8
v_bfe_u32 v2, v1, 2, 1
v_lshl_add_u32 v8, v2, 7, v8
v_bfe_u32 v2, v1, 5, 1
v_lshl_add_u32 v8, v2, 8, v8
v_and_b32 v2, 3, v1
v_lshl_add_u32 v8, v2, 3, v8
s_mov_b32 s57, 66560
v_add_u32 v7, s57, v8
s_mov_b32 s52, 37748736
s_mov_b32 s53, 37765120
s_mov_b32 s54, 2097152
s_mul_i32 s56, s3, 2080
v_accvgpr_read_b32 v32, a224
v_accvgpr_read_b32 v33, a225
v_accvgpr_read_b32 v34, a226
v_accvgpr_read_b32 v35, a227
v_accvgpr_read_b32 v36, a228
v_accvgpr_read_b32 v37, a229
v_accvgpr_read_b32 v38, a230
v_accvgpr_read_b32 v39, a231
v_accvgpr_read_b32 v40, a232
v_accvgpr_read_b32 v41, a233
v_accvgpr_read_b32 v42, a234
v_accvgpr_read_b32 v43, a235
v_accvgpr_read_b32 v44, a236
v_accvgpr_read_b32 v45, a237
v_accvgpr_read_b32 v46, a238
v_accvgpr_read_b32 v47, a239
v_accvgpr_read_b32 v48, a240
v_accvgpr_read_b32 v49, a241
v_accvgpr_read_b32 v50, a242
v_accvgpr_read_b32 v51, a243
v_accvgpr_read_b32 v52, a244
v_accvgpr_read_b32 v53, a245
v_accvgpr_read_b32 v54, a246
v_accvgpr_read_b32 v55, a247
v_accvgpr_read_b32 v56, a248
v_accvgpr_read_b32 v57, a249
v_accvgpr_read_b32 v58, a250
v_accvgpr_read_b32 v59, a251
v_accvgpr_read_b32 v60, a252
v_accvgpr_read_b32 v61, a253
v_accvgpr_read_b32 v62, a254
v_accvgpr_read_b32 v63, a255
s_and_b32 s62, s3, 1
s_mul_i32 s62, s62, 28672
s_add_u32 s62, s62, s51
v_lshrrev_b32 v12, 4, v1
v_mul_u32_u24 v12, 57344, v12
v_and_b32 v2, 15, v1
v_lshl_add_u32 v12, v2, 4, v12
v_add_u32 v12, s62, v12
v_add_u32 v13, 6112, v12
v_add_u32 v14, 12224, v12
v_add_u32 v15, 18336, v12
s_mul_i32 s59, s3, 4224
s_mov_b32 s58, 0
s_lshl_b32 s62, s8, 10
s_add_u32 s62, s62, 30490624
s_lshl_b32 s64, s6, 10
s_add_u32 s64, s64, 30490624
s_lshr_b32 s67, s5, 2
s_and_b32 s67, s67, 3
s_lshl_b32 s67, s67, 7
s_add_u32 s64, s64, s67
v_lshl_add_u32 v252, v1, 7, s62
v_mov_b32 v253, s64
v_mov_b32 v255, 1
s_waitcnt vmcnt(0) lgkmcnt(0)
s_cmp_lg_u32 s3, 1
s_barrier
s_cbranch_scc1 .Lnopoll59
s_mov_b64 exec, 15
buffer_atomic_add v255, v252, s[16:19], 0 offen
s_mov_b64 exec, 1
v_mov_b32 v254, 0
buffer_atomic_add v254, v253, s[16:19], 0 offen sc0
s_sleep 5
s_mov_b32 s15, 0
.Lpoll58:
v_mov_b32 v255, 0
buffer_atomic_add v255, v253, s[16:19], 0 offen sc0
s_waitcnt vmcnt(1)
v_cmp_gt_u32 vcc, 16, v254
s_add_u32 s15, s15, 1
s_cbranch_vccz .Lnopoll59r
v_mov_b32 v254, 0
buffer_atomic_add v254, v253, s[16:19], 0 offen sc0
s_waitcnt vmcnt(1)
v_cmp_gt_u32 vcc, 16, v255
s_add_u32 s15, s15, 1
s_cbranch_vccz .Lnopoll59r
s_cmp_le_u32 s15, 100000
s_cbranch_scc1 .Lpoll58
s_branch .Lnopoll59r
.Lnopoll59:
s_mov_b64 exec, 0
s_cmp_eq_u32 s3, 2
s_cbranch_scc1 .Lpad20
s_cmp_eq_u32 s3, 3
s_cbranch_scc1 .Lpad21
s_branch .Lpad22
.Lnopoll59r:
s_mov_b64 exec, -1
s_barrier
buffer_load_dwordx4 v[64:67], v4, s[16:19], s52 offen sc1
buffer_load_dwordx4 v[68:71], v4, s[16:19], s52 offen offset:1024 sc1
s_add_u32 s52, s52, 32768
buffer_load_dwordx4 v[72:75], v4, s[16:19], s53 offen sc1
buffer_load_dwordx4 v[76:79], v4, s[16:19], s53 offen offset:1024 sc1
s_add_u32 s53, s53, 32768
buffer_load_dwordx4 v[80:83], v4, s[16:19], s52 offen sc1
buffer_load_dwordx4 v[84:87], v4, s[16:19], s52 offen offset:1024 sc1
s_add_u32 s52, s52, 32768
buffer_load_dwordx4 v[88:91], v4, s[16:19], s53 offen sc1
buffer_load_dwordx4 v[92:95], v4, s[16:19], s53 offen offset:1024 sc1
s_add_u32 s53, s53, 32768
buffer_load_dwordx4 v[96:99], v4, s[16:19], s52 offen sc1
buffer_load_dwordx4 v[100:103], v4, s[16:19], s52 offen offset:1024 sc1
s_add_u32 s52, s52, 32768
buffer_load_dwordx4 v[104:107], v4, s[16:19], s53 offen sc1
buffer_load_dwordx4 v[108:111], v4, s[16:19], s53 offen offset:1024 sc1
s_add_u32 s53, s53, 32768
ds_read_b64_tr_b16 a[0:1], v7
TR 2,7,512
TR 4,7,32
TR 6,7,544
TR 8,7,64
TR 10,7,576
TR 12,7,96
TR 14,7,608
TR 16,7,1024
TR 18,7,1536
TR 20,7,1056
TR 22,7,1568
TR 24,7,1088
TR 26,7,1600
TR 28,7,1120
TR 30,7,1632
s_waitcnt vmcnt(11) lgkmcnt(14)
MAV 32,0,64
TR 32,7,8320
TR 34,7,8832
s_waitcnt vmcnt(10)
MAV 48,0,68
buffer_load_dwordx4 v[112:115], v4, s[16:19], s52 offen sc1
s_waitcnt lgkmcnt(14)
MAV 52,4,68
TR 36,7,8352
TR 38,7,8864
MAV 36,4,64
TR 40,7,8384
TR 42,7,8896
s_waitcnt lgkmcnt(15)
MAV 40,8,64
buffer_load_dwordx4 v[116:119], v4, s[16:19], s52 offen offset:1024 sc1
MAV 56,8,68
TR 44,7,8416
s_add_u32 s52, s52, 32768
s_waitcnt lgkmcnt(15)
MAV 60,12,68
TR 46,7,8928
MAV 44,12,64
TR 48,7,9344
TR 50,7,9856
s_waitcnt vmcnt(11) lgkmcnt(15)
MAV 32,16,72
buffer_load_dwordx4 v[120:123], v4, s[16:19], s53 offen sc1
s_waitcnt vmcnt(11)
MAV 48,16,76
TR 52,7,9376
TR 54,7,9888
s_waitcnt lgkmcnt(15)
MAV 52,20,76
TR 56,7,9408
TR 58,7,9920
MAV 36,20,72
buffer_load_dwordx4 v[124:127], v4, s[16:19], s53 offen offset:1024 sc1
s_waitcnt lgkmcnt(15)
MAV 40,24,72
TR 60,7,9440
s_add_u32 s53, s53, 32768
MAV 56,24,76
TR 62,7,9952
s_waitcnt lgkmcnt(15)
MAV 60,28,76
MAV 44,28,72
s_waitcnt vmcnt(11) lgkmcnt(14)
MAV 32,32,80
TR 0,7,16640
TR 2,7,17152
s_waitcnt vmcnt(10)
MAV 48,32,84
buffer_load_dwordx4 v[64:67], v4, s[16:19], s52 offen sc1
s_waitcnt lgkmcnt(14)
MAV 52,36,84
TR 4,7,16672
TR 6,7,17184
MAV 36,36,80
TR 8,7,16704
TR 10,7,17216
s_waitcnt lgkmcnt(15)
MAV 40,40,80
buffer_load_dwordx4 v[68:71], v4, s[16:19], s52 offen offset:1024 sc1
MAV 56,40,84
TR 12,7,16736
s_add_u32 s52, s52, 32768
s_waitcnt lgkmcnt(15)
MAV 60,44,84
TR 14,7,17248
MAV 44,44,80
TR 16,7,17664
TR 18,7,18176
s_waitcnt vmcnt(11) lgkmcnt(15)
MAV 32,48,88
buffer_load_dwordx4 v[72:75], v4, s[16:19], s53 offen sc1
s_waitcnt vmcnt(11)
MAV 48,48,92
TR 20,7,17696
TR 22,7,18208
s_waitcnt lgkmcnt(15)
MAV 52,52,92
TR 24,7,17728
TR 26,7,18240
MAV 36,52,88
buffer_load_dwordx4 v[76:79], v4, s[16:19], s53 offen offset:1024 sc1
s_waitcnt lgkmcnt(15)
MAV 40,56,88
TR 28,7,17760
s_add_u32 s53, s53, 32768
MAV 56,56,92
TR 30,7,18272
s_waitcnt lgkmcnt(15)
MAV 60,60,92
MAV 44,60,88
s_waitcnt vmcnt(11) lgkmcnt(14)
MAV 32,0,96
TR 32,7,24960
TR 34,7,25472
s_waitcnt vmcnt(10)
MAV 48,0,100
buffer_load_dwordx4 v[80:83], v4, s[16:19], s52 offen sc1
s_waitcnt lgkmcnt(14)
MAV 52,4,100
TR 36,7,24992
TR 38,7,25504
MAV 36,4,96
TR 40,7,25024
TR 42,7,25536
s_waitcnt lgkmcnt(15)
MAV 40,8,96
buffer_load_dwordx4 v[84:87], v4, s[16:19], s52 offen offset:1024 sc1
MAV 56,8,100
TR 44,7,25056
s_add_u32 s52, s52, 32768
s_waitcnt lgkmcnt(15)
MAV 60,12,100
TR 46,7,25568
MAV 44,12,96
TR 48,7,25984
TR 50,7,26496
s_waitcnt vmcnt(11) lgkmcnt(15)
MAV 32,16,104
buffer_load_dwordx4 v[88:91], v4, s[16:19], s53 offen sc1
s_waitcnt vmcnt(11)
MAV 48,16,108
TR 52,7,26016
TR 54,7,26528
s_waitcnt lgkmcnt(15)
MAV 52,20,108
TR 56,7,26048
TR 58,7,26560
MAV 36,20,104
buffer_load_dwordx4 v[92:95], v4, s[16:19], s53 offen offset:1024 sc1
s_waitcnt lgkmcnt(15)
MAV 40,24,104
TR 60,7,26080
s_add_u32 s53, s53, 32768
MAV 56,24,108
TR 62,7,26592
s_waitcnt lgkmcnt(15)
MAV 60,28,108
MAV 44,28,104
s_waitcnt vmcnt(11) lgkmcnt(14)
MAV 32,32,112
TR 0,7,33280
TR 2,7,33792
s_waitcnt vmcnt(10)
MAV 48,32,116
buffer_load_dwordx4 v[96:99], v4, s[16:19], s52 offen sc1
s_waitcnt lgkmcnt(14)
MAV 52,36,116
TR 4,7,33312
TR 6,7,33824
MAV 36,36,112
TR 8,7,33344
TR 10,7,33856
s_waitcnt lgkmcnt(15)
MAV 40,40,112
buffer_load_dwordx4 v[100:103], v4, s[16:19], s52 offen offset:1024 sc1
MAV 56,40,116
TR 12,7,33376
s_add_u32 s52, s52, 32768
s_waitcnt lgkmcnt(15)
MAV 60,44,116
TR 14,7,33888
MAV 44,44,112
TR 16,7,34304
TR 18,7,34816
s_waitcnt vmcnt(11) lgkmcnt(15)
MAV 32,48,120
buffer_load_dwordx4 v[104:107], v4, s[16:19], s53 offen sc1
s_waitcnt vmcnt(11)
MAV 48,48,124
TR 20,7,34336
TR 22,7,34848
s_waitcnt lgkmcnt(15)
MAV 52,52,124
TR 24,7,34368
TR 26,7,34880
MAV 36,52,120
buffer_load_dwordx4 v[108:111], v4, s[16:19], s53 offen offset:1024 sc1
s_waitcnt lgkmcnt(15)
MAV 40,56,120
TR 28,7,34400
s_add_u32 s53, s53, 32768
MAV 56,56,124
TR 30,7,34912
s_waitcnt lgkmcnt(15)
MAV 60,60,124
MAV 44,60,120
s_waitcnt vmcnt(11) lgkmcnt(14)
MAV 32,0,64
TR 32,7,41600
TR 34,7,42112
s_waitcnt vmcnt(10)
MAV 48,0,68
buffer_load_dwordx4 v[112:115], v4, s[16:19], s52 offen sc1
s_waitcnt lgkmcnt(14)
MAV 52,4,68
TR 36,7,41632
TR 38,7,42144
MAV 36,4,64
TR 40,7,41664
TR 42,7,42176
s_waitcnt lgkmcnt(15)
MAV 40,8,64
buffer_load_dwordx4 v[116:119], v4, s[16:19], s52 offen offset:1024 sc1
MAV 56,8,68
TR 44,7,41696
s_add_u32 s52, s52, 32768
s_waitcnt lgkmcnt(15)
MAV 60,12,68
TR 46,7,42208
MAV 44,12,64
TR 48,7,42624
TR 50,7,43136
.Lpad20:
s_cbranch_execz .Lpad23
s_waitcnt vmcnt(11) lgkmcnt(15)
MAV 32,16,72
buffer_load_dwordx4 v[120:123], v4, s[16:19], s53 offen sc1
s_waitcnt vmcnt(11)
MAV 48,16,76
TR 52,7,42656
TR 54,7,43168
s_waitcnt lgkmcnt(15)
MAV 52,20,76
TR 56,7,42688
TR 58,7,43200
MAV 36,20,72
buffer_load_dwordx4 v[124:127], v4, s[16:19], s53 offen offset:1024 sc1
s_waitcnt lgkmcnt(15)
MAV 40,24,72
TR 60,7,42720
s_add_u32 s53, s53, 32768
MAV 56,24,76
TR 62,7,43232
s_waitcnt lgkmcnt(15)
MAV 60,28,76
MAV 44,28,72
s_waitcnt vmcnt(11) lgkmcnt(14)
MAV 32,32,80
TR 0,7,49920
TR 2,7,50432
s_waitcnt vmcnt(10)
MAV 48,32,84
buffer_load_dwordx4 v[64:67], v4, s[16:19], s52 offen sc1
s_waitcnt lgkmcnt(14)
MAV 52,36,84
TR 4,7,49952
TR 6,7,50464
MAV 36,36,80
TR 8,7,49984
TR 10,7,50496
s_waitcnt lgkmcnt(15)
MAV 40,40,80
buffer_load_dwordx4 v[68:71], v4, s[16:19], s52 offen offset:1024 sc1
MAV 56,40,84
TR 12,7,50016
s_add_u32 s52, s52, 32768
s_waitcnt lgkmcnt(15)
MAV 60,44,84
TR 14,7,50528
MAV 44,44,80
TR 16,7,50944
TR 18,7,51456
s_waitcnt vmcnt(11) lgkmcnt(15)
MAV 32,48,88
buffer_load_dwordx4 v[72:75], v4, s[16:19], s53 offen sc1
s_waitcnt vmcnt(11)
MAV 48,48,92
TR 20,7,50976
TR 22,7,51488
s_waitcnt lgkmcnt(15)
MAV 52,52,92
TR 24,7,51008
TR 26,7,51520
MAV 36,52,88
buffer_load_dwordx4 v[76:79], v4, s[16:19], s53 offen offset:1024 sc1
s_waitcnt lgkmcnt(15)
MAV 40,56,88
TR 28,7,51040
s_add_u32 s53, s53, 32768
MAV 56,56,92
TR 30,7,51552
s_waitcnt lgkmcnt(15)
MAV 60,60,92
MAV 44,60,88
s_waitcnt vmcnt(11) lgkmcnt(14)
MAV 32,0,96
TR 32,7,58240
TR 34,7,58752
s_waitcnt vmcnt(10)
MAV 48,0,100
buffer_load_dwordx4 v[80:83], v4, s[16:19], s52 offen sc1
s_waitcnt lgkmcnt(14)
MAV 52,4,100
TR 36,7,58272
TR 38,7,58784
MAV 36,4,96
TR 40,7,58304
TR 42,7,58816
s_waitcnt lgkmcnt(15)
MAV 40,8,96
buffer_load_dwordx4 v[84:87], v4, s[16:19], s52 offen offset:1024 sc1
MAV 56,8,100
TR 44,7,58336
s_add_u32 s52, s52, 32768
s_waitcnt lgkmcnt(15)
MAV 60,12,100
TR 46,7,58848
MAV 44,12,96
TR 48,7,59264
TR 50,7,59776
s_waitcnt vmcnt(11) lgkmcnt(15)
MAV 32,16,104
buffer_load_dwordx4 v[88:91], v4, s[16:19], s53 offen sc1
s_waitcnt vmcnt(11)
MAV 48,16,108
TR 52,7,59296
TR 54,7,59808
s_waitcnt lgkmcnt(15)
MAV 52,20,108
TR 56,7,59328
TR 58,7,59840
MAV 36,20,104
buffer_load_dwordx4 v[92:95], v4, s[16:19], s53 offen offset:1024 sc1
s_waitcnt lgkmcnt(15)
MAV 40,24,104
TR 60,7,59360
s_add_u32 s53, s53, 32768
MAV 56,24,108
TR 62,7,59872
s_waitcnt lgkmcnt(15)
MAV 60,28,108
MAV 44,28,104
s_xor_b32 s57, s57, 66560
v_add_u32 v7, s57, v8
s_waitcnt vmcnt(11) lgkmcnt(14)
MAV 32,32,112
ds_read_b64_tr_b16 a[0:1], v7
TR 2,7,512
s_waitcnt vmcnt(10)
MAV 48,32,116
buffer_load_dwordx4 v[96:99], v4, s[16:19], s52 offen sc1
s_waitcnt lgkmcnt(14)
MAV 52,36,116
TR 4,7,32
TR 6,7,544
MAV 36,36,112
TR 8,7,64
TR 10,7,576
s_waitcnt lgkmcnt(15)
MAV 40,40,112
buffer_load_dwordx4 v[100:103], v4, s[16:19], s52 offen offset:1024 sc1
MAV 56,40,116
TR 12,7,96
s_add_u32 s52, s52, 32768
s_waitcnt lgkmcnt(15)
MAV 60,44,116
TR 14,7,608
MAV 44,44,112
TR 16,7,1024
TR 18,7,1536
s_waitcnt vmcnt(11) lgkmcnt(15)
MAV 32,48,120
buffer_load_dwordx4 v[104:107], v4, s[16:19], s53 offen sc1
s_waitcnt vmcnt(11)
MAV 48,48,124
TR 20,7,1056
TR 22,7,1568
s_waitcnt lgkmcnt(15)
MAV 52,52,124
TR 24,7,1088
TR 26,7,1600
MAV 36,52,120
buffer_load_dwordx4 v[108:111], v4, s[16:19], s53 offen offset:1024 sc1
s_waitcnt lgkmcnt(15)
MAV 40,56,120
TR 28,7,1120
s_add_u32 s53, s53, 32768
MAV 56,56,124
TR 30,7,1632
s_waitcnt lgkmcnt(15)
MAV 60,60,124
MAV 44,60,120
s_waitcnt vmcnt(11) lgkmcnt(14)
MAV 32,0,64
TR 32,7,8320
TR 34,7,8832
s_waitcnt vmcnt(10)
MAV 48,0,68
buffer_load_dwordx4 v[112:115], v4, s[16:19], s52 offen sc1
s_waitcnt lgkmcnt(14)
MAV 52,4,68
TR 36,7,8352
TR 38,7,8864
MAV 36,4,64
TR 40,7,8384
TR 42,7,8896
s_waitcnt lgkmcnt(15)
MAV 40,8,64
buffer_load_dwordx4 v[116:119], v4, s[16:19], s52 offen offset:1024 sc1
MAV 56,8,68
TR 44,7,8416
s_add_u32 s52, s52, 32768
s_waitcnt lgkmcnt(15)
MAV 60,12,68
TR 46,7,8928
MAV 44,12,64
TR 48,7,9344
TR 50,7,9856
s_waitcnt vmcnt(11) lgkmcnt(15)
MAV 32,16,72
buffer_load_dwordx4 v[120:123], v4, s[16:19], s53 offen sc1
s_waitcnt vmcnt(11)
MAV 48,16,76
TR 52,7,9376
TR 54,7,9888
s_waitcnt lgkmcnt(15)
MAV 52,20,76
TR 56,7,9408
TR 58,7,9920
MAV 36,20,72
buffer_load_dwordx4 v[124:127], v4, s[16:19], s53 offen offset:1024 sc1
s_waitcnt lgkmcnt(15)
MAV 40,24,72
TR 60,7,9440
s_add_u32 s53, s53, 32768
MAV 56,24,76
TR 62,7,9952
s_waitcnt lgkmcnt(15)
MAV 60,28,76
MAV 44,28,72
s_waitcnt vmcnt(11) lgkmcnt(14)
MAV 32,32,80
TR 0,7,16640
TR 2,7,17152
s_waitcnt vmcnt(10)
MAV 48,32,84
buffer_load_dwordx4 v[64:67], v4, s[16:19], s52 offen sc1
s_waitcnt lgkmcnt(14)
MAV 52,36,84
TR 4,7,16672
TR 6,7,17184
MAV 36,36,80
TR 8,7,16704
TR 10,7,17216
s_waitcnt lgkmcnt(15)
MAV 40,40,80
buffer_load_dwordx4 v[68:71], v4, s[16:19], s52 offen offset:1024 sc1
MAV 56,40,84
TR 12,7,16736
s_add_u32 s52, s52, 32768
s_waitcnt lgkmcnt(15)
MAV 60,44,84
TR 14,7,17248
MAV 44,44,80
TR 16,7,17664
TR 18,7,18176
s_waitcnt vmcnt(11) lgkmcnt(15)
MAV 32,48,88
buffer_load_dwordx4 v[72:75], v4, s[16:19], s53 offen sc1
s_waitcnt vmcnt(11)
MAV 48,48,92
TR 20,7,17696
TR 22,7,18208
s_waitcnt lgkmcnt(15)
MAV 52,52,92
TR 24,7,17728
TR 26,7,18240
MAV 36,52,88
buffer_load_dwordx4 v[76:79], v4, s[16:19], s53 offen offset:1024 sc1
s_waitcnt lgkmcnt(15)
MAV 40,56,88
TR 28,7,17760
s_add_u32 s53, s53, 32768
MAV 56,56,92
TR 30,7,18272
s_waitcnt lgkmcnt(15)
MAV 60,60,92
MAV 44,60,88
s_waitcnt vmcnt(11) lgkmcnt(14)
MAV 32,0,96
TR 32,7,24960
TR 34,7,25472
s_waitcnt vmcnt(10)
MAV 48,0,100
buffer_load_dwordx4 v[80:83], v4, s[16:19], s52 offen sc1
s_waitcnt lgkmcnt(14)
MAV 52,4,100
TR 36,7,24992
TR 38,7,25504
MAV 36,4,96
TR 40,7,25024
TR 42,7,25536
s_waitcnt lgkmcnt(15)
MAV 40,8,96
buffer_load_dwordx4 v[84:87], v4, s[16:19], s52 offen offset:1024 sc1
MAV 56,8,100
TR 44,7,25056
s_add_u32 s52, s52, 32768
s_waitcnt lgkmcnt(15)
MAV 60,12,100
TR 46,7,25568
MAV 44,12,96
TR 48,7,25984
TR 50,7,26496
s_waitcnt vmcnt(11) lgkmcnt(15)
MAV 32,16,104
buffer_load_dwordx4 v[88:91], v4, s[16:19], s53 offen sc1
s_waitcnt vmcnt(11)
MAV 48,16,108
TR 52,7,26016
TR 54,7,26528
s_waitcnt lgkmcnt(15)
MAV 52,20,108
TR 56,7,26048
TR 58,7,26560
MAV 36,20,104
buffer_load_dwordx4 v[92:95], v4, s[16:19], s53 offen offset:1024 sc1
s_waitcnt lgkmcnt(15)
MAV 40,24,104
TR 60,7,26080
s_add_u32 s53, s53, 32768
MAV 56,24,108
TR 62,7,26592
s_waitcnt lgkmcnt(15)
MAV 60,28,108
MAV 44,28,104
s_waitcnt vmcnt(11) lgkmcnt(14)
MAV 32,32,112
TR 0,7,33280
TR 2,7,33792
s_waitcnt vmcnt(10)
MAV 48,32,116
buffer_load_dwordx4 v[96:99], v4, s[16:19], s52 offen sc1
s_waitcnt lgkmcnt(14)
MAV 52,36,116
TR 4,7,33312
TR 6,7,33824
MAV 36,36,112
TR 8,7,33344
TR 10,7,33856
s_waitcnt lgkmcnt(15)
MAV 40,40,112
buffer_load_dwordx4 v[100:103], v4, s[16:19], s52 offen offset:1024 sc1
MAV 56,40,116
TR 12,7,33376
s_add_u32 s52, s52, 32768
s_waitcnt lgkmcnt(15)
MAV 60,44,116
TR 14,7,33888
MAV 44,44,112
TR 16,7,34304
TR 18,7,34816
s_waitcnt vmcnt(11) lgkmcnt(15)
MAV 32,48,120
buffer_load_dwordx4 v[104:107], v4, s[16:19], s53 offen sc1
s_waitcnt vmcnt(11)
MAV 48,48,124
TR 20,7,34336
TR 22,7,34848
s_waitcnt lgkmcnt(15)
MAV 52,52,124
TR 24,7,34368
TR 26,7,34880
MAV 36,52,120
buffer_load_dwordx4 v[108:111], v4, s[16:19], s53 offen offset:1024 sc1
s_waitcnt lgkmcnt(15)
MAV 40,56,120
TR 28,7,34400
s_add_u32 s53, s53, 32768
MAV 56,56,124
TR 30,7,34912
s_waitcnt lgkmcnt(15)
MAV 60,60,124
MAV 44,60,120
s_waitcnt vmcnt(11) lgkmcnt(14)
MAV 32,0,64
TR 32,7,41600
TR 34,7,42112
s_waitcnt vmcnt(10)
MAV 48,0,68
buffer_load_dwordx4 v[112:115], v4, s[16:19], s52 offen sc1
s_waitcnt lgkmcnt(14)
MAV 52,4,68
TR 36,7,41632
TR 38,7,42144
MAV 36,4,64
TR 40,7,41664
TR 42,7,42176
s_waitcnt lgkmcnt(15)
MAV 40,8,64
buffer_load_dwordx4 v[116:119], v4, s[16:19], s52 offen offset:1024 sc1
MAV 56,8,68
TR 44,7,41696
s_add_u32 s52, s52, 32768
s_waitcnt lgkmcnt(15)
MAV 60,12,68
TR 46,7,42208
MAV 44,12,64
TR 48,7,42624
TR 50,7,43136
s_waitcnt vmcnt(11) lgkmcnt(15)
MAV 32,16,72
buffer_load_dwordx4 v[120:123], v4, s[16:19], s53 offen sc1
s_waitcnt vmcnt(11)
MAV 48,16,76
TR 52,7,42656
TR 54,7,43168
s_waitcnt lgkmcnt(15)
MAV 52,20,76
TR 56,7,42688
TR 58,7,43200
MAV 36,20,72
buffer_load_dwordx4 v[124:127], v4, s[16:19], s53 offen offset:1024 sc1
s_waitcnt lgkmcnt(15)
MAV 40,24,72
TR 60,7,42720
s_add_u32 s53, s53, 32768
MAV 56,24,76
TR 62,7,43232
s_waitcnt lgkmcnt(15)
MAV 60,28,76
MAV 44,28,72
s_waitcnt lgkmcnt(0)
s_barrier
s_waitcnt vmcnt(11)
MAV 32,32,80
TR 0,7,49920
TR 2,7,50432
s_add_u32 m0, s59, 84480
s_waitcnt vmcnt(10)
MAV 48,32,84
TR 4,7,49952
buffer_load_dwordx4 v12, s[32:35], s58 offen   lds
MAV 52,36,84
TR 6,7,50464
TR 8,7,49984
MAV 36,36,80
TR 10,7,50496
MAV 40,40,80
TR 12,7,50016
buffer_load_dwordx4 v13, s[32:35], s58 offen offset:1056   lds
MAV 56,40,84
TR 14,7,50528
TR 16,7,50944
MAV 60,44,84
TR 18,7,51456
TR 20,7,50976
MAV 44,44,80
TR 22,7,51488
s_waitcnt vmcnt(11)
MAV 32,48,88
TR 24,7,51008
buffer_load_dwordx4 v14, s[32:35], s58 offen offset:2112   lds
s_waitcnt vmcnt(11)
MAV 48,48,92
TR 26,7,51520
TR 28,7,51040
MAV 52,52,92
TR 30,7,51552
MAV 36,52,88
buffer_load_dwordx4 v15, s[32:35], s58 offen offset:3168   lds
MAV 40,56,88
s_add_u32 s58, s58, 229376
MAV 56,56,92
MAV 60,60,92
MAV 44,60,88
s_waitcnt vmcnt(11) lgkmcnt(14)
MAV 32,0,96
TR 32,7,58240
s_add_u32 m0, s59, 101376
s_waitcnt vmcnt(10)
MAV 48,0,100
buffer_load_dwordx4 v12, s[32:35], s58 offen   lds
s_waitcnt lgkmcnt(13)
MAV 52,4,100
TR 34,7,58752
TR 36,7,58272
MAV 36,4,96
TR 38,7,58784
TR 40,7,58304
s_waitcnt lgkmcnt(15)
MAV 40,8,96
buffer_load_dwordx4 v13, s[32:35], s58 offen offset:1056   lds
MAV 56,8,100
TR 42,7,58816
TR 44,7,58336
s_waitcnt lgkmcnt(15)
MAV 60,12,100
TR 46,7,58848
MAV 44,12,96
TR 48,7,59264
TR 50,7,59776
s_waitcnt vmcnt(11) lgkmcnt(15)
MAV 32,16,104
buffer_load_dwordx4 v14, s[32:35], s58 offen offset:2112   lds
s_waitcnt vmcnt(11)
MAV 48,16,108
TR 52,7,59296
TR 54,7,59808
s_waitcnt lgkmcnt(15)
MAV 52,20,108
TR 56,7,59328
TR 58,7,59840
MAV 36,20,104
buffer_load_dwordx4 v15, s[32:35], s58 offen offset:3168   lds
s_waitcnt lgkmcnt(15)
MAV 40,24,104
TR 60,7,59360
s_add_u32 s58, s58, 229376
MAV 56,24,108
TR 62,7,59872
s_waitcnt lgkmcnt(15)
MAV 60,28,108
MAV 44,28,104
s_waitcnt vmcnt(11) lgkmcnt(14)
MAV 32,32,112
s_add_u32 m0, s59, 118272
s_lshl_b32 s64, s6, 14
s_lshl_b32 s65, s49, 13
s_waitcnt vmcnt(10)
MAV 48,32,116
buffer_load_dwordx4 v12, s[32:35], s58 offen   lds
s_waitcnt lgkmcnt(12)
MAV 52,36,116
s_add_u32 s64, s64, s65
s_lshl_b32 s65, s7, 9
s_add_u32 s64, s64, s65
MAV 36,36,112
s_lshl_b32 s65, s48, 8
s_add_u32 s64, s64, s65
s_add_u32 s64, s64, 63176704
s_waitcnt lgkmcnt(10)
MAV 40,40,112
s_lshl_b32 s62, s7, 15
v_and_b32 v152, 31, v1
v_lshlrev_b32 v152, 3, v152
MAV 56,40,116
buffer_load_dwordx4 v13, s[32:35], s58 offen offset:1056   lds
s_waitcnt lgkmcnt(8)
MAV 60,44,116
s_add_u32 s62, s62, 41943040
v_lshrrev_b32 v153, 5, v1
v_lshl_add_u32 v152, v153, 28, v152
MAV 44,44,112
s_add_u32 s63, s62, 16384
s_waitcnt vmcnt(11) lgkmcnt(6)
MAV 32,48,120
s_waitcnt vmcnt(10)
MAV 48,48,124
buffer_load_dwordx4 v14, s[32:35], s58 offen offset:2112   lds
s_waitcnt lgkmcnt(4)
MAV 52,52,124
s_nop 2
v_cvt_pk_bf16_f32 v128, v32, v33
v_cvt_pk_bf16_f32 v129, v34, v35
MAV 36,52,120
v_cvt_pk_bf16_f32 v136, v48, v49
v_cvt_pk_bf16_f32 v137, v50, v51
s_waitcnt lgkmcnt(2)
MAV 40,56,120
v_cvt_pk_bf16_f32 v138, v52, v53
v_cvt_pk_bf16_f32 v139, v54, v55
MAV 56,56,124
buffer_load_dwordx4 v15, s[32:35], s58 offen offset:3168   lds
s_waitcnt lgkmcnt(0)
MAV 60,60,124
s_add_u32 s58, s58, 229376
v_cvt_pk_bf16_f32 v130, v36, v37
v_cvt_pk_bf16_f32 v131, v38, v39
MAV 44,60,120
v_cvt_pk_bf16_f32 v132, v40, v41
v_cvt_pk_bf16_f32 v133, v42, v43
v_cvt_pk_bf16_f32 v140, v56, v57
v_cvt_pk_bf16_f32 v141, v58, v59
v_cvt_pk_bf16_f32 v142, v60, v61
v_cvt_pk_bf16_f32 v143, v62, v63
v_pk_mul_f32 v[146:147], v[32:33], v[32:33]
buffer_store_dwordx4 v[128:131], v4, s[16:19], s62 offen sc1
v_cvt_pk_bf16_f32 v134, v44, v45
v_cvt_pk_bf16_f32 v135, v46, v47
v_pk_mul_f32 v[150:151], v[48:49], v[48:49]
v_pk_fma_f32 v[146:147], v[34:35], v[34:35], v[146:147]
v_pk_add_f32 v[144:145], v[32:33], v[34:35]
v_pk_fma_f32 v[150:151], v[50:51], v[50:51], v[150:151]
v_pk_add_f32 v[148:149], v[48:49], v[50:51]
v_pk_fma_f32 v[146:147], v[36:37], v[36:37], v[146:147]
v_pk_add_f32 v[144:145], v[144:145], v[36:37]
v_pk_fma_f32 v[150:151], v[52:53], v[52:53], v[150:151]
.Lpad21:
s_cbranch_execz .Lpad24
v_pk_add_f32 v[148:149], v[148:149], v[52:53]
v_pk_fma_f32 v[146:147], v[38:39], v[38:39], v[146:147]
v_pk_add_f32 v[144:145], v[144:145], v[38:39]
buffer_store_dwordx4 v[132:135], v4, s[16:19], s63 offen sc1
v_pk_fma_f32 v[150:151], v[54:55], v[54:55], v[150:151]
v_pk_add_f32 v[148:149], v[148:149], v[54:55]
v_pk_fma_f32 v[146:147], v[40:41], v[40:41], v[146:147]
v_pk_add_f32 v[144:145], v[144:145], v[40:41]
v_pk_fma_f32 v[150:151], v[56:57], v[56:57], v[150:151]
v_pk_add_f32 v[148:149], v[148:149], v[56:57]
v_pk_fma_f32 v[146:147], v[42:43], v[42:43], v[146:147]
v_pk_add_f32 v[144:145], v[144:145], v[42:43]
v_pk_fma_f32 v[150:151], v[58:59], v[58:59], v[150:151]
v_pk_add_f32 v[148:149], v[148:149], v[58:59]
v_pk_fma_f32 v[146:147], v[44:45], v[44:45], v[146:147]
v_pk_add_f32 v[144:145], v[144:145], v[44:45]
v_pk_fma_f32 v[150:151], v[60:61], v[60:61], v[150:151]
buffer_store_dwordx4 v[136:139], v4, s[16:19], s62 offen offset:1024 sc1
v_pk_add_f32 v[148:149], v[148:149], v[60:61]
v_pk_fma_f32 v[146:147], v[46:47], v[46:47], v[146:147]
v_pk_add_f32 v[144:145], v[144:145], v[46:47]
v_pk_fma_f32 v[150:151], v[62:63], v[62:63], v[150:151]
v_pk_add_f32 v[148:149], v[148:149], v[62:63]
v_add_f32 v144, v144, v145
v_add_f32 v146, v146, v147
v_add_f32 v148, v148, v149
v_add_f32 v150, v150, v151
s_nop 0
v_permlane16_swap_b32 v144, v148
v_permlane16_swap_b32 v146, v150
v_add_f32 v144, v144, v148
buffer_store_dwordx4 v[140:143], v4, s[16:19], s63 offen offset:1024 sc1
v_add_f32 v146, v146, v150
s_nop 1
v_permlane32_swap_b32 v144, v146
v_add_f32 v144, v144, v146
s_nop 1
v_permlane32_swap_b32 v144, v145
buffer_store_dwordx2 v[144:145], v152, s[16:19], s64 offen sc1
s_nop 1
v_accvgpr_write_b32 a224, v32
v_accvgpr_write_b32 a225, v33
v_accvgpr_write_b32 a226, v34
v_accvgpr_write_b32 a227, v35
v_accvgpr_write_b32 a228, v36
v_accvgpr_write_b32 a229, v37
v_accvgpr_write_b32 a230, v38
v_accvgpr_write_b32 a231, v39
v_accvgpr_write_b32 a232, v40
v_accvgpr_write_b32 a233, v41
v_accvgpr_write_b32 a234, v42
v_accvgpr_write_b32 a235, v43
v_accvgpr_write_b32 a236, v44
v_accvgpr_write_b32 a237, v45
v_accvgpr_write_b32 a238, v46
v_accvgpr_write_b32 a239, v47
v_accvgpr_write_b32 a240, v48
v_accvgpr_write_b32 a241, v49
v_accvgpr_write_b32 a242, v50
v_accvgpr_write_b32 a243, v51
v_accvgpr_write_b32 a244, v52
v_accvgpr_write_b32 a245, v53
v_accvgpr_write_b32 a246, v54
v_accvgpr_write_b32 a247, v55
v_accvgpr_write_b32 a248, v56
v_accvgpr_write_b32 a249, v57
v_accvgpr_write_b32 a250, v58
v_accvgpr_write_b32 a251, v59
v_accvgpr_write_b32 a252, v60
v_accvgpr_write_b32 a253, v61
v_accvgpr_write_b32 a254, v62
v_accvgpr_write_b32 a255, v63
s_lshl_b32 s62, s10, 19
s_lshl_b32 s63, s3, 12
s_add_u32 s62, s62, s63
s_lshl_b32 s63, s12, 11
s_add_u32 s62, s62, s63
v_lshl_add_u32 v10, v1, 4, s62
v_lshrrev_b32 v2, 3, v1
v_cmp_eq_u32 vcc, 3, v2
v_add_u32 v2, 67108480, v10
s_nop 0
v_cndmask_b32 v10, v10, v2, vcc
v_xor_b32 v11, 2048, v10
v_bfe_u32 v16, v1, 2, 3
v_mul_u32_u24 v16, 1056, v16
v_bfe_u32 v2, v1, 5, 1
v_lshl_add_u32 v16, v2, 8, v16
v_and_b32 v2, 3, v1
v_lshl_add_u32 v16, v2, 3, v16
s_lshl_b32 s62, s12, 6
s_add_u32 s62, s62, 84480
s_xor_b32 s63, s12, 1
s_mul_i32 s63, s63, 192
s_add_u32 s63, s63, 84480
v_add_u32 v17, s63, v16
v_add_u32 v16, s62, v16
s_mov_b32 s52, 41943040
s_mov_b32 s54, s58
s_mov_b32 s55, s59
s_mul_i32 s59, s3, 2112
s_and_b32 s62, s7, 1
s_mul_i32 s62, s62, 3670016
s_lshr_b32 s63, s7, 1
s_lshl_b32 s63, s63, 8
s_add_u32 s62, s62, s63
s_lshl_b32 s63, s3, 12
s_add_u32 s62, s62, s63
v_lshrrev_b32 v5, 4, v1
v_lshlrev_b32 v5, 14, v5
v_and_b32 v2, 15, v1
v_lshl_add_u32 v5, v2, 4, v5
v_add_u32 v5, s62, v5
v_add_u32 v6, 992, v5
s_lshl_b32 s62, s10, 15
s_lshl_b32 s63, s3, 13
s_add_u32 s62, s62, s63
v_lshl_add_u32 v4, v1, 4, s62
s_lshl_b32 s62, s6, 10
s_add_u32 s62, s62, 30507008
s_lshl_b32 s64, s10, 1
s_lshl_b32 s64, s64, 10
s_add_u32 s64, s64, 30507008
s_lshr_b32 s67, s5, 2
s_and_b32 s67, s67, 3
s_lshl_b32 s67, s67, 7
s_add_u32 s64, s64, s67
s_add_u32 s65, s64, 1024
v_lshl_add_u32 v252, v1, 7, s62
v_mov_b32 v253, s64
v_mov_b32 v255, 1
v_writelane_b32 v253, s65, 1
s_waitcnt vmcnt(0) lgkmcnt(0)
s_cmp_lg_u32 s3, 1
s_barrier
s_cbranch_scc1 .Lnopoll62
s_mov_b64 exec, 15
buffer_atomic_add v255, v252, s[16:19], 0 offen
s_mov_b64 exec, 3
v_mov_b32 v254, 0
buffer_atomic_add v254, v253, s[16:19], 0 offen sc0
s_sleep 5
s_mov_b32 s15, 0
.Lpoll61:
v_mov_b32 v255, 0
buffer_atomic_add v255, v253, s[16:19], 0 offen sc0
s_waitcnt vmcnt(1)
v_cmp_gt_u32 vcc, 16, v254
s_add_u32 s15, s15, 1
s_cbranch_vccz .Lnopoll62r
v_mov_b32 v254, 0
buffer_atomic_add v254, v253, s[16:19], 0 offen sc0
s_waitcnt vmcnt(1)
v_cmp_gt_u32 vcc, 16, v255
s_add_u32 s15, s15, 1
s_cbranch_vccz .Lnopoll62r
s_cmp_le_u32 s15, 100000
s_cbranch_scc1 .Lpoll61
s_branch .Lnopoll62r
.Lnopoll62:
s_mov_b64 exec, 0
s_cmp_eq_u32 s3, 2
s_cbranch_scc1 .Lpad26
s_cmp_eq_u32 s3, 3
s_cbranch_scc1 .Lpad27
s_branch .Lpad28
.Lnopoll62r:
s_mov_b64 exec, -1
s_barrier
buffer_load_dwordx4 a[128:131], v10, s[16:19], s52 offen sc1
buffer_load_dwordx4 a[132:135], v10, s[16:19], s52 offen offset:1024 sc1
buffer_load_dwordx4 a[136:139], v11, s[16:19], s52 offen sc1
buffer_load_dwordx4 a[140:143], v11, s[16:19], s52 offen offset:1024 sc1
s_add_u32 s52, s52, 16384
buffer_load_dwordx4 a[144:147], v10, s[16:19], s52 offen sc1
buffer_load_dwordx4 a[148:151], v10, s[16:19], s52 offen offset:1024 sc1
buffer_load_dwordx4 a[152:155], v11, s[16:19], s52 offen sc1
buffer_load_dwordx4 a[156:159], v11, s[16:19], s52 offen offset:1024 sc1
s_add_u32 s52, s52, 16384
ds_read_b64_tr_b16 a[0:1], v16
TR 2,16,512
TR 4,16,32
TR 6,16,544
TR 8,16,8448
TR 10,16,8960
TR 12,16,8480
TR 14,16,8992
TR 16,16,64
TR 18,16,576
TR 20,16,96
TR 22,16,608
TR 24,16,8512
TR 26,16,9024
TR 28,16,8544
TR 30,16,9056
TR 32,16,128
TR 34,16,640
TR 36,16,160
TR 38,16,672
TR 40,16,8576
TR 42,16,9088
TR 44,16,8608
TR 46,16,9120
ds_read_b64_tr_b16 a[48:49], v17
TR 50,17,512
TR 52,17,32
TR 54,17,544
TR 56,17,8448
TR 58,17,8960
TR 60,17,8480
TR 62,17,8992
s_add_u32 m0, s55, 135168
s_nop 0
buffer_load_dwordx4 v12, s[32:35], s54 offen   lds
buffer_load_dwordx4 v13, s[32:35], s54 offen offset:1056   lds
buffer_load_dwordx4 v14, s[32:35], s54 offen offset:2112   lds
buffer_load_dwordx4 v15, s[32:35], s54 offen offset:3168   lds
s_add_u32 s54, s54, 229376
s_mul_i32 s66, s13, 114688
s_mul_i32 s65, s10, 1310720
s_add_u32 s66, s66, s65
s_add_u32 s66, s66, 46137344
s_add_u32 s65, s66, 49152
s_lshl_b32 s62, s12, 16
s_add_u32 s62, s62, s66
s_add_u32 s63, s62, 16384
s_add_u32 s64, s62, 32768
s_lshl_b32 s72, s10, 1
s_lshr_b32 s74, s11, 4
s_add_u32 s72, s72, s74
s_lshl_b32 s72, s72, 10
s_add_u32 s72, s72, 30523392
s_and_b32 s73, s6, 14
s_and_b32 s74, s7, 1
s_add_u32 s73, s73, s74
s_lshl_b32 s73, s73, 10
s_add_u32 s73, s73, 30523392
s_lshr_b32 s67, s5, 2
s_and_b32 s67, s67, 3
s_lshl_b32 s67, s67, 7
s_add_u32 s73, s73, s67
s_and_b32 s74, s7, 1
s_mul_i32 s53, s74, 917504
s_lshr_b32 s75, s6, 1
s_mul_i32 s75, s75, 1310720
s_add_u32 s53, s53, s75
s_add_u32 s53, s53, 46137344
s_and_b32 s74, s6, 3
s_xor_b32 s75, s74, 0
s_sub_u32 s75, s75, 0
s_mul_i32 s98, s75, 458752
s_mul_i32 s75, s75, 114688
s_add_u32 s76, s53, s75
s_xor_b32 s75, s74, 1
s_sub_u32 s75, s75, 1
s_mul_i32 s99, s75, 458752
s_mul_i32 s75, s75, 114688
s_add_u32 s77, s53, s75
s_xor_b32 s75, s74, 2
s_sub_u32 s75, s75, 2
s_mul_i32 s100, s75, 458752
s_mul_i32 s75, s75, 114688
s_add_u32 s78, s53, s75
s_xor_b32 s75, s74, 3
s_sub_u32 s75, s75, 3
s_mul_i32 s101, s75, 458752
s_mul_i32 s75, s75, 114688
s_add_u32 s79, s53, s75
s_and_b32 s53, s6, 3
s_mov_b32 s46, 0
s_lshl_b32 s74, s3, 10
s_lshl_b32 s75, s12, 9
s_add_u32 s74, s74, s75
s_add_u32 s74, s74, 152576
v_and_b32 v18, 15, v1
v_lshl_add_u32 v18, v18, 4, s74
v_xor_b32 v19, 512, v18
s_lshl_b32 s74, s12, 7
s_add_u32 s74, s74, 161536
s_xor_b32 s75, s12, 1
s_mul_i32 s75, s75, 384
s_add_u32 s75, s75, 161536
v_lshrrev_b32 v9, 4, v1
v_lshlrev_b32 v9, 4, v9
v_add_u32 v8, s75, v9
v_add_u32 v9, s74, v9
s_lshl_b32 s74, s3, 13
s_add_u32 s74, s74, 49920
v_lshl_add_u32 v2, v1, 4, s74
s_waitcnt lgkmcnt(0)
s_barrier
s_waitcnt vmcnt(11)
v_mfma_f32_16x16x32_bf16 v[32:35], a[0:3], a[128:131], 0
buffer_load_dwordx4 a[160:163], v10, s[16:19], s52 offen sc1
s_waitcnt vmcnt(11)
v_mfma_f32_16x16x32_bf16 v[36:39], a[0:3], a[132:135], 0
TR 64,16,16896
v_mfma_f32_16x16x32_bf16 v[52:55], a[4:7], a[132:135], 0
TR 66,16,17408
v_mfma_f32_16x16x32_bf16 v[48:51], a[4:7], a[128:131], 0
TR 68,16,16928
v_mfma_f32_16x16x32_bf16 v[64:67], a[8:11], a[128:131], 0
buffer_load_dwordx4 a[164:167], v10, s[16:19], s52 offen offset:1024 sc1
v_mfma_f32_16x16x32_bf16 v[68:71], a[8:11], a[132:135], 0
TR 70,16,17440
v_mfma_f32_16x16x32_bf16 v[84:87], a[12:15], a[132:135], 0
TR 72,16,25344
v_mfma_f32_16x16x32_bf16 v[80:83], a[12:15], a[128:131], 0
TR 74,16,25856
v_mfma_f32_16x16x32_bf16 v[96:99], a[16:19], a[128:131], 0
buffer_load_dwordx4 a[168:171], v11, s[16:19], s52 offen sc1
v_mfma_f32_16x16x32_bf16 v[100:103], a[16:19], a[132:135], 0
TR 76,16,25376
v_mfma_f32_16x16x32_bf16 v[116:119], a[20:23], a[132:135], 0
TR 78,16,25888
v_mfma_f32_16x16x32_bf16 v[112:115], a[20:23], a[128:131], 0
TR 80,16,16960
v_mfma_f32_16x16x32_bf16 v[128:131], a[24:27], a[128:131], 0
buffer_load_dwordx4 a[172:175], v11, s[16:19], s52 offen offset:1024 sc1
v_mfma_f32_16x16x32_bf16 v[132:135], a[24:27], a[132:135], 0
TR 82,16,17472
s_add_u32 s52, s52, 16384
v_mfma_f32_16x16x32_bf16 v[148:151], a[28:31], a[132:135], 0
TR 84,16,16992
s_add_u32 m0, s55, 84480
v_mfma_f32_16x16x32_bf16 v[144:147], a[28:31], a[128:131], 0
TR 86,16,17504
v_mfma_f32_16x16x32_bf16 v[160:163], a[32:35], a[128:131], 0
buffer_load_dwordx4 v12, s[32:35], s54 offen   lds
v_mfma_f32_16x16x32_bf16 v[164:167], a[32:35], a[132:135], 0
TR 88,16,25408
v_mfma_f32_16x16x32_bf16 v[180:183], a[36:39], a[132:135], 0
TR 90,16,25920
v_mfma_f32_16x16x32_bf16 v[176:179], a[36:39], a[128:131], 0
TR 92,16,25440
v_mfma_f32_16x16x32_bf16 v[192:195], a[40:43], a[128:131], 0
buffer_load_dwordx4 a[176:179], v10, s[16:19], s52 offen sc1
v_mfma_f32_16x16x32_bf16 v[196:199], a[40:43], a[132:135], 0
TR 94,16,25952
v_mfma_f32_16x16x32_bf16 v[212:215], a[44:47], a[132:135], 0
TR 96,16,17024
v_mfma_f32_16x16x32_bf16 v[208:211], a[44:47], a[128:131], 0
TR 98,16,17536
v_mfma_f32_16x16x32_bf16 v[224:227], a[48:51], a[128:131], 0
buffer_load_dwordx4 v13, s[32:35], s54 offen offset:1056   lds
v_mfma_f32_16x16x32_bf16 v[228:231], a[48:51], a[132:135], 0
TR 100,16,17056
v_mfma_f32_16x16x32_bf16 v[236:239], a[52:55], a[132:135], 0
TR 102,16,17568
v_mfma_f32_16x16x32_bf16 v[232:235], a[52:55], a[128:131], 0
TR 104,16,25472
v_mfma_f32_16x16x32_bf16 v[240:243], a[56:59], a[128:131], 0
buffer_load_dwordx4 a[180:183], v10, s[16:19], s52 offen offset:1024 sc1
v_mfma_f32_16x16x32_bf16 v[244:247], a[56:59], a[132:135], 0
TR 106,16,25984
v_mfma_f32_16x16x32_bf16 v[252:255], a[60:63], a[132:135], 0
TR 108,16,25504
v_mfma_f32_16x16x32_bf16 v[248:251], a[60:63], a[128:131], 0
TR 110,16,26016
s_waitcnt vmcnt(16)
v_mfma_f32_16x16x32_bf16 v[220:223], a[44:47], a[140:143], 0
buffer_load_dwordx4 v14, s[32:35], s54 offen offset:2112   lds
v_mfma_f32_16x16x32_bf16 v[216:219], a[44:47], a[136:139], 0
TR 112,17,16896
v_mfma_f32_16x16x32_bf16 v[200:203], a[40:43], a[136:139], 0
TR 114,17,17408
v_mfma_f32_16x16x32_bf16 v[204:207], a[40:43], a[140:143], 0
TR 116,17,16928
v_mfma_f32_16x16x32_bf16 v[188:191], a[36:39], a[140:143], 0
buffer_load_dwordx4 a[184:187], v11, s[16:19], s52 offen sc1
v_mfma_f32_16x16x32_bf16 v[184:187], a[36:39], a[136:139], 0
TR 118,17,17440
v_mfma_f32_16x16x32_bf16 v[168:171], a[32:35], a[136:139], 0
TR 120,17,25344
v_mfma_f32_16x16x32_bf16 v[172:175], a[32:35], a[140:143], 0
TR 122,17,25856
v_mfma_f32_16x16x32_bf16 v[156:159], a[28:31], a[140:143], 0
buffer_load_dwordx4 v15, s[32:35], s54 offen offset:3168   lds
v_mfma_f32_16x16x32_bf16 v[152:155], a[28:31], a[136:139], 0
TR 124,17,25376
s_add_u32 s54, s54, 229376
v_mfma_f32_16x16x32_bf16 v[136:139], a[24:27], a[136:139], 0
TR 126,17,25888
v_mfma_f32_16x16x32_bf16 v[140:143], a[24:27], a[140:143], 0
v_mfma_f32_16x16x32_bf16 v[124:127], a[20:23], a[140:143], 0
buffer_load_dwordx4 a[188:191], v11, s[16:19], s52 offen offset:1024 sc1
v_mfma_f32_16x16x32_bf16 v[120:123], a[20:23], a[136:139], 0
s_add_u32 s52, s52, 16384
v_mfma_f32_16x16x32_bf16 v[104:107], a[16:19], a[136:139], 0
v_mfma_f32_16x16x32_bf16 v[108:111], a[16:19], a[140:143], 0
v_mfma_f32_16x16x32_bf16 v[92:95], a[12:15], a[140:143], 0
v_mfma_f32_16x16x32_bf16 v[88:91], a[12:15], a[136:139], 0
v_mfma_f32_16x16x32_bf16 v[72:75], a[8:11], a[136:139], 0
v_mfma_f32_16x16x32_bf16 v[76:79], a[8:11], a[140:143], 0
v_mfma_f32_16x16x32_bf16 v[60:63], a[4:7], a[140:143], 0
v_mfma_f32_16x16x32_bf16 v[56:59], a[4:7], a[136:139], 0
v_mfma_f32_16x16x32_bf16 v[40:43], a[0:3], a[136:139], 0
v_mfma_f32_16x16x32_bf16 v[44:47], a[0:3], a[140:143], 0
s_waitcnt lgkmcnt(0)
s_barrier
s_waitcnt vmcnt(19)
MAA 32,64,144
TR 0,16,33792
s_add_u32 m0, s74, 0
s_waitcnt vmcnt(18)
MAA 36,64,148
TR 2,16,34304
s_mov_b32 s67, 63176704
MAA 52,68,148
buffer_load_dwordx4 v4, s[16:19], s67 offen sc1 lds
MAA 48,68,144
TR 4,16,33824
MAA 64,72,144
TR 6,16,34336
MAA 68,72,148
TR 8,16,42240
MAA 84,76,148
buffer_load_dwordx4 v4, s[16:19], s67 offen offset:1024 sc1 lds
MAA 80,76,144
TR 10,16,42752
MAA 96,80,144
TR 12,16,42272
MAA 100,80,148
TR 14,16,42784
MAA 116,84,148
buffer_load_dwordx4 v4, s[16:19], s67 offen offset:2048 sc1 lds
MAA 112,84,144
TR 16,16,33856
MAA 128,88,144
TR 18,16,34368
MAA 132,88,148
TR 20,16,33888
MAA 148,92,148
buffer_load_dwordx4 v4, s[16:19], s67 offen offset:3072 sc1 lds
MAA 144,92,144
TR 22,16,34400
s_add_u32 m0, s55, 101376
MAA 160,96,144
TR 24,16,42304
MAA 164,96,148
TR 26,16,42816
MAA 180,100,148
buffer_load_dwordx4 v12, s[32:35], s54 offen   lds
MAA 176,100,144
TR 28,16,42336
MAA 192,104,144
TR 30,16,42848
MAA 196,104,148
TR 32,16,33920
MAA 212,108,148
buffer_load_dwordx4 a[128:131], v10, s[16:19], s52 offen sc1
MAA 208,108,144
TR 34,16,34432
MAA 224,112,144
TR 36,16,33952
MAA 228,112,148
TR 38,16,34464
MAA 236,116,148
buffer_load_dwordx4 v13, s[32:35], s54 offen offset:1056   lds
MAA 232,116,144
TR 40,16,42368
MAA 240,120,144
TR 42,16,42880
MAA 244,120,148
TR 44,16,42400
MAA 252,124,148
buffer_load_dwordx4 a[132:135], v10, s[16:19], s52 offen offset:1024 sc1
MAA 248,124,144
TR 46,16,42912
s_waitcnt vmcnt(24)
MAA 220,108,156
TR 48,17,33792
MAA 216,108,152
TR 50,17,34304
MAA 200,104,152
buffer_load_dwordx4 v14, s[32:35], s54 offen offset:2112   lds
MAA 204,104,156
TR 52,17,33824
MAA 188,100,156
TR 54,17,34336
MAA 184,100,152
TR 56,17,42240
MAA 168,96,152
buffer_load_dwordx4 a[136:139], v11, s[16:19], s52 offen sc1
MAA 172,96,156
TR 58,17,42752
MAA 156,92,156
TR 60,17,42272
MAA 152,92,152
TR 62,17,42784
MAA 136,88,152
buffer_load_dwordx4 v15, s[32:35], s54 offen offset:3168   lds
MAA 140,88,156
s_add_u32 s54, s54, 229376
MAA 124,84,156
MAA 120,84,152
MAA 104,80,152
buffer_load_dwordx4 a[140:143], v11, s[16:19], s52 offen offset:1024 sc1
MAA 108,80,156
s_add_u32 s52, s52, 16384
MAA 92,76,156
MAA 88,76,152
MAA 72,72,152
MAA 76,72,156
MAA 60,68,156
MAA 56,68,152
MAA 40,64,152
MAA 44,64,156
s_waitcnt vmcnt(24) lgkmcnt(0)
s_barrier
s_waitcnt vmcnt(23)
MAA 32,0,160
TR 64,16,50688
s_add_u32 m0, s74, 4096
s_waitcnt vmcnt(22)
MAA 36,0,164
TR 66,16,51200
s_mov_b32 s67, 63180800
MAA 52,4,164
buffer_load_dwordx4 v4, s[16:19], s67 offen sc1 lds
MAA 48,4,160
TR 68,16,50720
MAA 64,8,160
TR 70,16,51232
MAA 68,8,164
TR 72,16,59136
MAA 84,12,164
buffer_load_dwordx4 v4, s[16:19], s67 offen offset:1024 sc1 lds
MAA 80,12,160
TR 74,16,59648
MAA 96,16,160
TR 76,16,59168
MAA 100,16,164
TR 78,16,59680
MAA 116,20,164
buffer_load_dwordx4 v4, s[16:19], s67 offen offset:2048 sc1 lds
MAA 112,20,160
TR 80,16,50752
MAA 128,24,160
TR 82,16,51264
MAA 132,24,164
TR 84,16,50784
MAA 148,28,164
buffer_load_dwordx4 v4, s[16:19], s67 offen offset:3072 sc1 lds
MAA 144,28,160
TR 86,16,51296
s_add_u32 m0, s55, 118272
MAA 160,32,160
TR 88,16,59200
MAA 164,32,164
TR 90,16,59712
MAA 180,36,164
buffer_load_dwordx4 v12, s[32:35], s54 offen   lds
MAA 176,36,160
TR 92,16,59232
MAA 192,40,160
TR 94,16,59744
MAA 196,40,164
TR 96,16,50816
MAA 212,44,164
buffer_load_dwordx4 a[144:147], v10, s[16:19], s52 offen sc1
MAA 208,44,160
TR 98,16,51328
MAA 224,48,160
TR 100,16,50848
MAA 228,48,164
TR 102,16,51360
MAA 236,52,164
buffer_load_dwordx4 v13, s[32:35], s54 offen offset:1056   lds
MAA 232,52,160
TR 104,16,59264
MAA 240,56,160
TR 106,16,59776
MAA 244,56,164
TR 108,16,59296
MAA 252,60,164
buffer_load_dwordx4 a[148:151], v10, s[16:19], s52 offen offset:1024 sc1
MAA 248,60,160
TR 110,16,59808
s_waitcnt vmcnt(28)
MAA 220,44,172
TR 112,17,50688
MAA 216,44,168
TR 114,17,51200
MAA 200,40,168
buffer_load_dwordx4 v14, s[32:35], s54 offen offset:2112   lds
.Lpad22:
s_cbranch_execz .Lpad25
MAA 204,40,172
TR 116,17,50720
MAA 188,36,172
TR 118,17,51232
MAA 184,36,168
TR 120,17,59136
MAA 168,32,168
buffer_load_dwordx4 a[152:155], v11, s[16:19], s52 offen sc1
MAA 172,32,172
TR 122,17,59648
MAA 156,28,172
TR 124,17,59168
MAA 152,28,168
TR 126,17,59680
MAA 136,24,168
buffer_load_dwordx4 v15, s[32:35], s54 offen offset:3168   lds
MAA 140,24,172
s_add_u32 s54, s54, 229376
MAA 124,20,172
MAA 120,20,168
MAA 104,16,168
buffer_load_dwordx4 a[156:159], v11, s[16:19], s52 offen offset:1024 sc1
MAA 108,16,172
s_add_u32 s52, s52, 16384
MAA 92,12,172
MAA 88,12,168
MAA 72,8,168
MAA 76,8,172
MAA 60,4,172
MAA 56,4,168
MAA 40,0,168
MAA 44,0,172
s_waitcnt vmcnt(25) lgkmcnt(0)
s_barrier
MAA 32,64,176
s_waitcnt vmcnt(20)
ds_read_b128 v[20:23], v2
s_add_u32 m0, s55, 135168
MAA 36,64,180
buffer_load_dwordx4 v12, s[32:35], s54 offen   lds
MAA 52,68,180
ds_read_b128 v[28:31], v2 offset:1024
MAA 48,68,176
ds_read_b128 v[24:27], v2 offset:2048
MAA 64,72,176
ds_read_b64_tr_b16 a[0:1], v16
MAA 68,72,180
TR 2,16,512
MAA 84,76,180
TR 4,16,32
MAA 80,76,176
buffer_load_dwordx4 a[160:163], v10, s[16:19], s52 offen sc1
MAA 96,80,176
TR 6,16,544
MAA 100,80,180
TR 8,16,8448
MAA 116,84,180
TR 10,16,8960
s_waitcnt lgkmcnt(7)
v_add_f32 v20, v20, v28
MAA 112,84,176
TR 12,16,8480
v_add_f32 v21, v21, v29
MAA 128,88,176
TR 14,16,8992
v_add_f32 v22, v22, v30
MAA 132,88,180
buffer_load_dwordx4 v13, s[32:35], s54 offen offset:1056   lds
MAA 148,92,180
TR 16,16,64
v_add_f32 v23, v23, v31
MAA 144,92,176
ds_read_b128 v[28:31], v2 offset:3072
s_waitcnt lgkmcnt(10)
v_add_f32 v20, v20, v24
MAA 160,96,176
TR 18,16,576
v_add_f32 v21, v21, v25
MAA 164,96,180
TR 20,16,96
v_add_f32 v22, v22, v26
MAA 180,100,180
TR 22,16,608
v_add_f32 v23, v23, v27
MAA 176,100,176
buffer_load_dwordx4 a[164:167], v10, s[16:19], s52 offen offset:1024 sc1
MAA 192,104,176
s_waitcnt vmcnt(12)
ds_read_b128 v[24:27], v2 offset:4096
MAA 196,104,180
TR 24,16,8512
MAA 212,108,180
TR 26,16,9024
MAA 208,108,176
TR 28,16,8544
s_waitcnt lgkmcnt(7)
v_add_f32 v20, v20, v28
MAA 224,112,176
TR 30,16,9056
v_add_f32 v21, v21, v29
MAA 228,112,180
buffer_load_dwordx4 v14, s[32:35], s54 offen offset:2112   lds
MAA 236,116,180
TR 32,16,128
v_add_f32 v22, v22, v30
MAA 232,116,176
TR 34,16,640
MAA 240,120,176
TR 36,16,160
MAA 244,120,180
TR 38,16,672
MAA 252,124,180
TR 40,16,8576
MAA 248,124,176
buffer_load_dwordx4 a[168:171], v11, s[16:19], s52 offen sc1
MAA 220,108,188
TR 42,16,9088
MAA 216,108,184
TR 44,16,8608
MAA 200,104,184
TR 46,16,9120
MAA 204,104,188
ds_read_b64_tr_b16 a[48:49], v17
MAA 188,100,188
TR 50,17,512
MAA 184,100,184
buffer_load_dwordx4 v15, s[32:35], s54 offen offset:3168   lds
MAA 168,96,184
TR 52,17,32
s_add_u32 s54, s54, 229376
MAA 172,96,188
TR 54,17,544
MAA 156,92,188
TR 56,17,8448
MAA 152,92,184
TR 58,17,8960
MAA 136,88,184
TR 60,17,8480
MAA 140,88,188
buffer_load_dwordx4 a[172:175], v11, s[16:19], s52 offen offset:1024 sc1
MAA 124,84,188
TR 62,17,8992
s_add_u32 s52, s52, 16384
MAA 120,84,184
MAA 104,80,184
MAA 108,80,188
MAA 92,76,188
MAA 88,76,184
MAA 72,72,184
MAA 76,72,188
MAA 60,68,188
MAA 56,68,184
MAA 40,64,184
MAA 44,64,188
s_waitcnt lgkmcnt(0)
s_barrier
MAA 32,0,128
TR 64,16,16896
s_add_u32 m0, s55, 84480
MAA 36,0,132
buffer_load_dwordx4 v12, s[32:35], s54 offen   lds
MAA 52,4,132
TR 66,16,17408
v_add_f32 v23, v23, v31
MAA 48,4,128
ds_read_b128 v[28:31], v2 offset:5120
v_add_f32 v20, v20, v24
MAA 64,8,128
TR 68,16,16928
v_add_f32 v21, v21, v25
MAA 68,8,132
TR 70,16,17440
v_add_f32 v22, v22, v26
MAA 84,12,132
TR 72,16,25344
v_add_f32 v23, v23, v27
MAA 80,12,128
buffer_load_dwordx4 a[176:179], v10, s[16:19], s52 offen sc1
MAA 96,16,128
ds_read_b128 v[24:27], v2 offset:6144
MAA 100,16,132
TR 74,16,25856
MAA 116,20,132
TR 76,16,25376
MAA 112,20,128
TR 78,16,25888
s_waitcnt lgkmcnt(7)
v_add_f32 v20, v20, v28
MAA 128,24,128
TR 80,16,16960
v_add_f32 v21, v21, v29
MAA 132,24,132
buffer_load_dwordx4 v13, s[32:35], s54 offen offset:1056   lds
MAA 148,28,132
TR 82,16,17472
v_add_f32 v22, v22, v30
MAA 144,28,128
TR 84,16,16992
v_add_f32 v23, v23, v31
MAA 160,32,128
ds_read_b128 v[28:31], v2 offset:7168
s_waitcnt lgkmcnt(7)
v_add_f32 v20, v20, v24
MAA 164,32,132
TR 86,16,17504
v_add_f32 v21, v21, v25
MAA 180,36,132
TR 88,16,25408
v_add_f32 v22, v22, v26
MAA 176,36,128
buffer_load_dwordx4 a[180:183], v10, s[16:19], s52 offen offset:1024 sc1
MAA 192,40,128
TR 90,16,25920
v_add_f32 v23, v23, v27
MAA 196,40,132
TR 92,16,25440
MAA 212,44,132
TR 94,16,25952
MAA 208,44,128
TR 96,16,17024
MAA 224,48,128
TR 98,16,17536
s_waitcnt lgkmcnt(7)
v_add_f32 v20, v20, v28
MAA 228,48,132
buffer_load_dwordx4 v14, s[32:35], s54 offen offset:2112   lds
MAA 236,52,132
TR 100,16,17056
v_add_f32 v21, v21, v29
MAA 232,52,128
TR 102,16,17568
v_add_f32 v22, v22, v30
MAA 240,56,128
TR 104,16,25472
v_add_f32 v23, v23, v31
MAA 244,56,132
TR 106,16,25984
MAA 252,60,132
TR 108,16,25504
MAA 248,60,128
buffer_load_dwordx4 a[184:187], v11, s[16:19], s52 offen sc1
MAA 220,44,140
TR 110,16,26016
MAA 216,44,136
TR 112,17,16896
MAA 200,40,136
TR 114,17,17408
MAA 204,40,140
TR 116,17,16928
MAA 188,36,140
TR 118,17,17440
MAA 184,36,136
buffer_load_dwordx4 v15, s[32:35], s54 offen offset:3168   lds
MAA 168,32,136
TR 120,17,25344
s_add_u32 s54, s54, 229376
MAA 172,32,140
TR 122,17,25856
MAA 156,28,140
TR 124,17,25376
MAA 152,28,136
TR 126,17,25888
MAA 136,24,136
MAA 140,24,140
buffer_load_dwordx4 a[188:191], v11, s[16:19], s52 offen offset:1024 sc1
MAA 124,20,140
s_add_u32 s52, s52, 16384
MAA 120,20,136
MAA 104,16,136
MAA 108,16,140
MAA 92,12,140
MAA 88,12,136
MAA 72,8,136
MAA 76,8,140
MAA 60,4,140
MAA 56,4,136
MAA 40,0,136
MAA 44,0,140
s_waitcnt vmcnt(17) lgkmcnt(0)
s_barrier
MAA 32,64,144
TR 0,16,33792
s_add_u32 m0, s55, 101376
MAA 36,64,148
buffer_load_dwordx4 v12, s[32:35], s54 offen   lds
MAA 52,68,148
TR 2,16,34304
v_permlane32_swap_b32 v20, v22
MAA 48,68,144
TR 4,16,33824
v_permlane32_swap_b32 v21, v23
MAA 64,72,144
TR 6,16,34336
v_add_f32 v20, v20, v22
MAA 68,72,148
TR 8,16,42240
v_add_f32 v21, v21, v23
MAA 84,76,148
TR 10,16,42752
v_mul_f32 v20, 0xba800000, v20
MAA 80,76,144
buffer_load_dwordx4 a[128:131], v10, s[16:19], s52 offen sc1
MAA 96,80,144
TR 12,16,42272
v_mul_f32 v21, 0x3a800000, v21
MAA 100,80,148
TR 14,16,42784
v_fma_f32 v21, -v20, v20, v21
MAA 116,84,148
TR 16,16,33856
v_max_f32 v21, 0, v21
MAA 112,84,144
TR 18,16,34368
v_add_f32 v21, 0x3727c5ac, v21
MAA 128,88,144
TR 20,16,33888
v_rsq_f32 v22, v21
MAA 132,88,148
buffer_load_dwordx4 v13, s[32:35], s54 offen offset:1056   lds
MAA 148,92,148
TR 22,16,34400
v_and_b32 v24, 31, v1
MAA 144,92,144
TR 24,16,42304
v_lshrrev_b32 v25, 5, v1
MAA 160,96,144
TR 26,16,42816
v_lshl_add_u32 v24, v24, 1, v25
MAA 164,96,148
TR 28,16,42336
v_and_b32 v25, 0xc0, v0
MAA 180,100,148
TR 30,16,42848
v_add_u32 v24, v24, v25
MAA 176,100,144
buffer_load_dwordx4 a[132:135], v10, s[16:19], s52 offen offset:1024 sc1
MAA 192,104,144
TR 32,16,33920
v_lshlrev_b32 v24, 4, v24
MAA 196,104,148
TR 34,16,34432
v_add_u32 v24, 152576, v24
MAA 212,108,148
TR 36,16,33952
v_mul_f32 v22, 0xbfb8aa3b, v22
MAA 208,108,144
ds_write_b128 v24, v[20:23]
s_mov_b32 s58, s98
MAA 224,112,144
ds_read_b64 v[20:21], v18
s_mov_b32 s67, s59
MAA 228,112,148
buffer_load_dwordx4 v14, s[32:35], s54 offen offset:2112   lds
MAA 236,116,148
ds_read_b64 v[22:23], v18 offset:256
MAA 232,116,144
ds_read_b64 v[24:25], v19
MAA 240,120,144
ds_read_b64 v[26:27], v19 offset:256
MAA 244,120,148
ds_read_b32 a192, v18 offset:8
MAA 252,124,148
ds_read_b32 a193, v18 offset:264
v_mov_b32 v18, v5
MAA 248,124,144
buffer_load_dwordx4 a[136:139], v11, s[16:19], s52 offen sc1
s_waitcnt vmcnt(22)
MAA 220,108,156
ds_read_b32 a194, v19 offset:8
MAA 216,108,152
ds_read_b32 a195, v19 offset:264
v_mov_b32 v19, v6
MAA 200,104,152
TR 38,16,34464
MAA 204,104,156
TR 40,16,42368
MAA 188,100,156
TR 42,16,42880
MAA 184,100,152
buffer_load_dwordx4 v15, s[32:35], s54 offen offset:3168   lds
MAA 168,96,152
TR 44,16,42400
s_add_u32 s54, s54, 229376
MAA 172,96,156
TR 46,16,42912
MAA 156,92,156
TR 48,17,33792
MAA 152,92,152
TR 50,17,34304
MAA 136,88,152
TR 52,17,33824
MAA 140,88,156
buffer_load_dwordx4 a[140:143], v11, s[16:19], s52 offen offset:1024 sc1
MAA 124,84,156
TR 54,17,34336
s_add_u32 s52, s52, 16384
MAA 120,84,152
TR 56,17,42240
MAA 104,80,152
TR 58,17,42752
MAA 108,80,156
TR 60,17,42272
MAA 92,76,156
TR 62,17,42784
MAA 88,76,152
MAA 72,72,152
MAA 76,72,156
MAA 60,68,156
MAA 56,68,152
MAA 40,64,152
MAA 44,64,156
s_waitcnt vmcnt(17) lgkmcnt(0)
s_barrier
MAA 32,0,160
ds_read_b128 v[4:7], v9
s_add_u32 m0, s55, 118272
MAA 36,0,164
buffer_load_dwordx4 v12, s[32:35], s54 offen   lds
MAA 52,4,164
ds_read_b128 v[28:31], v8
MAA 48,4,160
TR 64,16,50688
MAA 64,8,160
TR 66,16,51200
MAA 68,8,164
TR 68,16,50720
MAA 84,12,164
TR 70,16,51232
MAA 80,12,160
buffer_load_dwordx4 a[144:147], v10, s[16:19], s52 offen sc1
MAA 96,16,160
TR 72,16,59136
s_waitcnt lgkmcnt(6)
v_fmac_f32 v40, v4, v24
MAA 100,16,164
TR 74,16,59648
v_fmac_f32 v41, v5, v24
MAA 116,20,164
TR 76,16,59168
s_waitcnt lgkmcnt(7)
v_fmac_f32 v224, v28, v20
MAA 112,20,160
TR 78,16,59680
v_fmac_f32 v225, v29, v20
MAA 128,24,160
TR 80,16,50752
v_fmac_f32 v226, v30, v20
MAA 132,24,164
buffer_load_dwordx4 v13, s[32:35], s54 offen offset:1056   lds
MAA 148,28,164
TR 82,16,51264
v_fmac_f32 v227, v31, v20
MAA 144,28,160
TR 84,16,50784
v_fmac_f32 v228, v28, v22
MAA 160,32,160
TR 86,16,51296
v_fmac_f32 v229, v29, v22
MAA 164,32,164
TR 88,16,59200
v_fmac_f32 v230, v30, v22
MAA 180,36,164
TR 90,16,59712
v_fmac_f32 v231, v31, v22
MAA 176,36,160
buffer_load_dwordx4 a[148:151], v10, s[16:19], s52 offen offset:1024 sc1
MAA 192,40,160
ds_read_b128 v[28:31], v9 offset:64
v_fmac_f32 v42, v6, v24
MAA 196,40,164
TR 92,16,59232
v_fmac_f32 v43, v7, v24
MAA 212,44,164
TR 94,16,59744
v_fmac_f32 v44, v4, v26
MAA 208,44,160
TR 96,16,50816
v_fmac_f32 v45, v5, v26
MAA 224,48,160
TR 98,16,51328
v_fmac_f32 v46, v6, v26
MAA 228,48,164
buffer_load_dwordx4 v14, s[32:35], s54 offen offset:2112   lds
MAA 236,52,164
TR 100,16,50848
v_fmac_f32 v47, v7, v26
MAA 232,52,160
TR 102,16,51360
v_fmac_f32 v32, v4, v20
MAA 240,56,160
TR 104,16,59264
s_waitcnt lgkmcnt(7)
v_fmac_f32 v56, v28, v24
MAA 244,56,164
TR 106,16,59776
v_fmac_f32 v57, v29, v24
MAA 252,60,164
TR 108,16,59296
v_fmac_f32 v58, v30, v24
MAA 248,60,160
buffer_load_dwordx4 a[152:155], v11, s[16:19], s52 offen sc1
s_waitcnt vmcnt(22)
MAA 220,44,172
TR 110,16,59808
v_fmac_f32 v59, v31, v24
MAA 216,44,168
TR 112,17,50688
v_fmac_f32 v60, v28, v26
MAA 200,40,168
TR 114,17,51200
v_fmac_f32 v61, v29, v26
MAA 204,40,172
TR 116,17,50720
v_fmac_f32 v62, v30, v26
MAA 188,36,172
TR 118,17,51232
v_fmac_f32 v63, v31, v26
MAA 184,36,168
buffer_load_dwordx4 v15, s[32:35], s54 offen offset:3168   lds
MAA 168,32,168
TR 120,17,59136
s_add_u32 s54, s54, 229376
MAA 172,32,172
TR 122,17,59648
v_fmac_f32 v33, v5, v20
MAA 156,28,172
TR 124,17,59168
v_fmac_f32 v34, v6, v20
MAA 152,28,168
TR 126,17,59680
v_fmac_f32 v35, v7, v20
MAA 136,24,168
v_fmac_f32 v36, v4, v22
v_fmac_f32 v37, v5, v22
MAA 140,24,172
buffer_load_dwordx4 a[156:159], v11, s[16:19], s52 offen offset:1024 sc1
MAA 124,20,172
s_add_u32 s52, s52, 16384
v_fmac_f32 v38, v6, v22
v_fmac_f32 v39, v7, v22
MAA 120,20,168
v_fmac_f32 v48, v28, v20
v_fmac_f32 v49, v29, v20
MAA 104,16,168
v_fmac_f32 v50, v30, v20
v_fmac_f32 v51, v31, v20
MAA 108,16,172
v_fmac_f32 v52, v28, v22
v_fmac_f32 v53, v29, v22
MAA 92,12,172
v_fmac_f32 v54, v30, v22
v_fmac_f32 v55, v31, v22
MAA 88,12,168
MAA 72,8,168
MAA 76,8,172
MAA 60,4,172
MAA 56,4,168
MAA 40,0,168
MAA 44,0,172
s_waitcnt vmcnt(17) lgkmcnt(0)
s_barrier
MAA 32,64,176
ds_read_b128 v[4:7], v9 offset:512
s_add_u32 m0, s55, 135168
.Lpad23:
s_cbranch_execz .Lnopoll59r
MAA 36,64,180
buffer_load_dwordx4 v12, s[32:35], s54 offen   lds
MAA 52,68,180
ds_read_b128 v[28:31], v8 offset:64
MAA 48,68,176
ds_read_b64_tr_b16 a[0:1], v16
MAA 64,72,176
TR 2,16,512
MAA 68,72,180
TR 4,16,32
MAA 84,76,180
TR 6,16,544
MAA 80,76,176
buffer_load_dwordx4 a[160:163], v10, s[16:19], s52 offen sc1
MAA 96,80,176
TR 8,16,8448
s_waitcnt lgkmcnt(6)
v_fmac_f32 v72, v4, v24
MAA 100,80,180
TR 10,16,8960
v_fmac_f32 v73, v5, v24
MAA 116,84,180
TR 12,16,8480
s_waitcnt lgkmcnt(7)
v_fmac_f32 v232, v28, v20
MAA 112,84,176
TR 14,16,8992
v_fmac_f32 v233, v29, v20
MAA 128,88,176
TR 16,16,64
v_fmac_f32 v234, v30, v20
MAA 132,88,180
buffer_load_dwordx4 v13, s[32:35], s54 offen offset:1056   lds
MAA 148,92,180
TR 18,16,576
v_fmac_f32 v235, v31, v20
MAA 144,92,176
TR 20,16,96
v_fmac_f32 v236, v28, v22
MAA 160,96,176
TR 22,16,608
v_fmac_f32 v237, v29, v22
MAA 164,96,180
TR 24,16,8512
v_fmac_f32 v238, v30, v22
MAA 180,100,180
TR 26,16,9024
v_fmac_f32 v239, v31, v22
MAA 176,100,176
buffer_load_dwordx4 a[164:167], v10, s[16:19], s52 offen offset:1024 sc1
MAA 192,104,176
ds_read_b128 v[28:31], v9 offset:576
v_fmac_f32 v74, v6, v24
MAA 196,104,180
TR 28,16,8544
v_fmac_f32 v75, v7, v24
MAA 212,108,180
TR 30,16,9056
v_fmac_f32 v76, v4, v26
MAA 208,108,176
TR 32,16,128
v_fmac_f32 v77, v5, v26
MAA 224,112,176
TR 34,16,640
v_fmac_f32 v78, v6, v26
MAA 228,112,180
buffer_load_dwordx4 v14, s[32:35], s54 offen offset:2112   lds
MAA 236,116,180
TR 36,16,160
v_fmac_f32 v79, v7, v26
MAA 232,116,176
TR 38,16,672
v_fmac_f32 v64, v4, v20
MAA 240,120,176
TR 40,16,8576
s_waitcnt lgkmcnt(7)
v_fmac_f32 v88, v28, v24
MAA 244,120,180
TR 42,16,9088
v_fmac_f32 v89, v29, v24
MAA 252,124,180
TR 44,16,8608
v_fmac_f32 v90, v30, v24
MAA 248,124,176
buffer_load_dwordx4 a[168:171], v11, s[16:19], s52 offen sc1
s_waitcnt vmcnt(22)
MAA 220,108,188
TR 46,16,9120
v_fmac_f32 v91, v31, v24
MAA 216,108,184
ds_read_b64_tr_b16 a[48:49], v17
v_fmac_f32 v92, v28, v26
MAA 200,104,184
TR 50,17,512
v_fmac_f32 v93, v29, v26
MAA 204,104,188
TR 52,17,32
v_fmac_f32 v94, v30, v26
MAA 188,100,188
TR 54,17,544
v_fmac_f32 v95, v31, v26
MAA 184,100,184
buffer_load_dwordx4 v15, s[32:35], s54 offen offset:3168   lds
MAA 168,96,184
TR 56,17,8448
s_add_u32 s54, s54, 229376
MAA 172,96,188
TR 58,17,8960
v_fmac_f32 v65, v5, v20
MAA 156,92,188
TR 60,17,8480
v_fmac_f32 v66, v6, v20
MAA 152,92,184
TR 62,17,8992
v_fmac_f32 v67, v7, v20
MAA 136,88,184
v_fmac_f32 v68, v4, v22
v_fmac_f32 v69, v5, v22
MAA 140,88,188
buffer_load_dwordx4 a[172:175], v11, s[16:19], s52 offen offset:1024 sc1
MAA 124,84,188
s_add_u32 s52, s52, 16384
v_fmac_f32 v70, v6, v22
v_fmac_f32 v71, v7, v22
MAA 120,84,184
v_fmac_f32 v80, v28, v20
v_fmac_f32 v81, v29, v20
MAA 104,80,184
v_fmac_f32 v82, v30, v20
v_fmac_f32 v83, v31, v20
MAA 108,80,188
v_fmac_f32 v84, v28, v22
v_fmac_f32 v85, v29, v22
MAA 92,76,188
v_fmac_f32 v86, v30, v22
v_fmac_f32 v87, v31, v22
MAA 88,76,184
MAA 72,72,184
MAA 76,72,188
MAA 60,68,188
MAA 56,68,184
MAA 40,64,184
MAA 44,64,188
s_waitcnt vmcnt(17) lgkmcnt(0)
s_barrier
MAA 32,0,128
ds_read_b128 v[4:7], v9 offset:128
s_add_u32 m0, s55, 84480
MAA 36,0,132
buffer_load_dwordx4 v12, s[32:35], s54 offen   lds
MAA 52,4,132
ds_read_b128 v[28:31], v8 offset:512
MAA 48,4,128
TR 64,16,16896
MAA 64,8,128
TR 66,16,17408
MAA 68,8,132
TR 68,16,16928
MAA 84,12,132
buffer_load_dwordx4 a[176:179], v10, s[16:19], s52 offen sc1
MAA 80,12,128
TR 70,16,17440
MAA 96,16,128
TR 72,16,25344
s_waitcnt lgkmcnt(6)
v_fmac_f32 v104, v4, v24
MAA 100,16,132
TR 74,16,25856
v_fmac_f32 v105, v5, v24
MAA 116,20,132
TR 76,16,25376
s_waitcnt lgkmcnt(7)
v_fmac_f32 v240, v28, v20
MAA 112,20,128
buffer_load_dwordx4 v13, s[32:35], s54 offen offset:1056   lds
MAA 128,24,128
TR 78,16,25888
v_fmac_f32 v241, v29, v20
MAA 132,24,132
TR 80,16,16960
v_fmac_f32 v242, v30, v20
MAA 148,28,132
TR 82,16,17472
v_fmac_f32 v243, v31, v20
MAA 144,28,128
TR 84,16,16992
v_fmac_f32 v244, v28, v22
MAA 160,32,128
buffer_load_dwordx4 a[180:183], v10, s[16:19], s52 offen offset:1024 sc1
MAA 164,32,132
TR 86,16,17504
v_fmac_f32 v245, v29, v22
MAA 180,36,132
TR 88,16,25408
v_fmac_f32 v246, v30, v22
MAA 176,36,128
TR 90,16,25920
v_fmac_f32 v247, v31, v22
MAA 192,40,128
ds_read_b128 v[28:31], v9 offset:192
v_fmac_f32 v106, v6, v24
MAA 196,40,132
buffer_load_dwordx4 v14, s[32:35], s54 offen offset:2112   lds
MAA 212,44,132
TR 92,16,25440
v_fmac_f32 v107, v7, v24
MAA 208,44,128
TR 94,16,25952
v_fmac_f32 v108, v4, v26
MAA 224,48,128
TR 96,16,17024
v_fmac_f32 v109, v5, v26
MAA 228,48,132
TR 98,16,17536
v_fmac_f32 v110, v6, v26
MAA 236,52,132
buffer_load_dwordx4 a[184:187], v11, s[16:19], s52 offen sc1
MAA 232,52,128
TR 100,16,17056
v_fmac_f32 v111, v7, v26
MAA 240,56,128
TR 102,16,17568
s_waitcnt lgkmcnt(6)
v_fmac_f32 v120, v28, v24
MAA 244,56,132
TR 104,16,25472
v_fmac_f32 v121, v29, v24
MAA 252,60,132
TR 106,16,25984
v_fmac_f32 v122, v30, v24
MAA 248,60,128
buffer_load_dwordx4 v15, s[32:35], s54 offen offset:3168   lds
s_waitcnt vmcnt(23)
MAA 220,44,140
TR 108,16,25504
s_add_u32 s54, s54, 229376
MAA 216,44,136
TR 110,16,26016
v_fmac_f32 v123, v31, v24
MAA 200,40,136
TR 112,17,16896
v_fmac_f32 v124, v28, v26
MAA 204,40,140
TR 114,17,17408
v_fmac_f32 v125, v29, v26
MAA 188,36,140
buffer_load_dwordx4 a[188:191], v11, s[16:19], s52 offen offset:1024 sc1
MAA 184,36,136
TR 116,17,16928
s_add_u32 s52, s52, 16384
MAA 168,32,136
TR 118,17,17440
s_mov_b32 m0, s67
MAA 172,32,140
TR 120,17,25344
v_fmac_f32 v126, v30, v26
MAA 156,28,140
TR 122,17,25856
v_fmac_f32 v127, v31, v26
MAA 152,28,136
buffer_load_dwordx4 v18, s[28:31], s58 offen lds
MAA 136,24,136
TR 124,17,25376
v_fmac_f32 v96, v4, v20
MAA 140,24,140
TR 126,17,25888
v_fmac_f32 v97, v5, v20
MAA 124,20,140
v_fmac_f32 v98, v6, v20
v_fmac_f32 v99, v7, v20
MAA 120,20,136
v_fmac_f32 v100, v4, v22
v_fmac_f32 v101, v5, v22
MAA 104,16,136
v_fmac_f32 v102, v6, v22
v_fmac_f32 v103, v7, v22
MAA 108,16,140
v_fmac_f32 v112, v28, v20
v_fmac_f32 v113, v29, v20
MAA 92,12,140
v_fmac_f32 v114, v30, v20
v_fmac_f32 v115, v31, v20
MAA 88,12,136
v_fmac_f32 v116, v28, v22
v_fmac_f32 v117, v29, v22
MAA 72,8,136
v_fmac_f32 v118, v30, v22
v_fmac_f32 v119, v31, v22
MAA 76,8,140
MAA 60,4,140
MAA 56,4,136
MAA 40,0,136
MAA 44,0,140
s_waitcnt vmcnt(18) lgkmcnt(0)
s_barrier
MAA 32,64,144
ds_read_b128 v[4:7], v9 offset:640
s_add_u32 m0, s55, 101376
MAA 36,64,148
buffer_load_dwordx4 v12, s[32:35], s54 offen   lds
MAA 52,68,148
ds_read_b128 v[28:31], v8 offset:576
MAA 48,68,144
TR 0,16,33792
MAA 64,72,144
TR 2,16,34304
MAA 68,72,148
TR 4,16,33824
MAA 84,76,148
buffer_load_dwordx4 a[128:131], v10, s[16:19], s52 offen sc1
MAA 80,76,144
TR 6,16,34336
MAA 96,80,144
TR 8,16,42240
s_waitcnt lgkmcnt(6)
v_fmac_f32 v136, v4, v24
MAA 100,80,148
TR 10,16,42752
v_fmac_f32 v137, v5, v24
MAA 116,84,148
TR 12,16,42272
s_waitcnt lgkmcnt(7)
v_fmac_f32 v248, v28, v20
MAA 112,84,144
buffer_load_dwordx4 v13, s[32:35], s54 offen offset:1056   lds
MAA 128,88,144
TR 14,16,42784
v_fmac_f32 v249, v29, v20
MAA 132,88,148
TR 16,16,33856
v_fmac_f32 v250, v30, v20
MAA 148,92,148
TR 18,16,34368
v_fmac_f32 v251, v31, v20
MAA 144,92,144
TR 20,16,33888
v_fmac_f32 v252, v28, v22
MAA 160,96,144
buffer_load_dwordx4 a[132:135], v10, s[16:19], s52 offen offset:1024 sc1
MAA 164,96,148
TR 22,16,34400
v_fmac_f32 v253, v29, v22
MAA 180,100,148
TR 24,16,42304
v_fmac_f32 v254, v30, v22
MAA 176,100,144
TR 26,16,42816
v_fmac_f32 v255, v31, v22
MAA 192,104,144
ds_read_b128 v[28:31], v9 offset:704
v_fmac_f32 v138, v6, v24
MAA 196,104,148
buffer_load_dwordx4 v14, s[32:35], s54 offen offset:2112   lds
MAA 212,108,148
TR 28,16,42336
v_fmac_f32 v139, v7, v24
MAA 208,108,144
TR 30,16,42848
v_fmac_f32 v140, v4, v26
MAA 224,112,144
TR 32,16,33920
v_fmac_f32 v141, v5, v26
MAA 228,112,148
TR 34,16,34432
v_fmac_f32 v142, v6, v26
MAA 236,116,148
buffer_load_dwordx4 a[136:139], v11, s[16:19], s52 offen sc1
MAA 232,116,144
TR 36,16,33952
v_fmac_f32 v143, v7, v26
MAA 240,120,144
TR 38,16,34464
s_waitcnt lgkmcnt(6)
v_fmac_f32 v152, v28, v24
MAA 244,120,148
TR 40,16,42368
v_fmac_f32 v153, v29, v24
MAA 252,124,148
TR 42,16,42880
v_fmac_f32 v154, v30, v24
MAA 248,124,144
buffer_load_dwordx4 v15, s[32:35], s54 offen offset:3168   lds
s_waitcnt vmcnt(24)
MAA 220,108,156
TR 44,16,42400
s_add_u32 s54, s54, 229376
MAA 216,108,152
TR 46,16,42912
v_fmac_f32 v155, v31, v24
MAA 200,104,152
TR 48,17,33792
v_fmac_f32 v156, v28, v26
MAA 204,104,156
TR 50,17,34304
v_fmac_f32 v157, v29, v26
MAA 188,100,156
buffer_load_dwordx4 a[140:143], v11, s[16:19], s52 offen offset:1024 sc1
MAA 184,100,152
TR 52,17,33824
s_add_u32 s52, s52, 16384
MAA 168,96,152
TR 54,17,34336
s_mov_b32 m0, s67
MAA 172,96,156
TR 56,17,42240
v_fmac_f32 v158, v30, v26
v_fmac_f32 v159, v31, v26
v_fmac_f32 v128, v4, v20
v_fmac_f32 v129, v5, v20
MAA 156,92,156
TR 58,17,42752
v_fmac_f32 v130, v6, v20
MAA 152,92,152
buffer_load_dwordx4 v19, s[28:31], s58 offen offset:1056 lds
MAA 136,88,152
TR 60,17,42272
s_add_u32 s67, s67, 8448
MAA 140,88,156
TR 62,17,42784
s_add_u32 s58, s58, 0x40000
MAA 124,84,156
v_fmac_f32 v131, v7, v20
v_fmac_f32 v132, v4, v22
MAA 120,84,152
v_fmac_f32 v133, v5, v22
v_fmac_f32 v134, v6, v22
MAA 104,80,152
v_fmac_f32 v135, v7, v22
v_fmac_f32 v144, v28, v20
MAA 108,80,156
v_fmac_f32 v145, v29, v20
v_fmac_f32 v146, v30, v20
MAA 92,76,156
v_fmac_f32 v147, v31, v20
v_fmac_f32 v148, v28, v22
MAA 88,76,152
v_fmac_f32 v149, v29, v22
v_fmac_f32 v150, v30, v22
MAA 72,72,152
v_fmac_f32 v151, v31, v22
MAA 76,72,156
MAA 60,68,156
MAA 56,68,152
MAA 40,64,152
MAA 44,64,156
s_waitcnt vmcnt(19) lgkmcnt(0)
s_barrier
MAA 32,0,160
ds_read_b128 v[4:7], v9 offset:256
s_add_u32 m0, s55, 118272
MAA 36,0,164
buffer_load_dwordx4 v12, s[32:35], s54 offen   lds
MAA 52,4,164
ds_read_b128 v[28:31], v9 offset:320
MAA 48,4,160
TR 64,16,50688
MAA 64,8,160
TR 66,16,51200
MAA 68,8,164
TR 68,16,50720
MAA 84,12,164
buffer_load_dwordx4 a[144:147], v10, s[16:19], s52 offen sc1
MAA 80,12,160
TR 70,16,51232
MAA 96,16,160
TR 72,16,59136
s_waitcnt lgkmcnt(6)
v_fmac_f32 v168, v4, v24
MAA 100,16,164
TR 74,16,59648
v_fmac_f32 v169, v5, v24
MAA 116,20,164
TR 76,16,59168
v_fmac_f32 v170, v6, v24
MAA 112,20,160
buffer_load_dwordx4 v13, s[32:35], s54 offen offset:1056   lds
MAA 128,24,160
TR 78,16,59680
v_fmac_f32 v171, v7, v24
MAA 132,24,164
TR 80,16,50752
v_fmac_f32 v172, v4, v26
MAA 148,28,164
TR 82,16,51264
v_fmac_f32 v173, v5, v26
MAA 144,28,160
TR 84,16,50784
v_fmac_f32 v174, v6, v26
MAA 160,32,160
buffer_load_dwordx4 a[148:151], v10, s[16:19], s52 offen offset:1024 sc1
MAA 164,32,164
TR 86,16,51296
v_fmac_f32 v175, v7, v26
MAA 180,36,164
TR 88,16,59200
s_waitcnt lgkmcnt(13)
v_fmac_f32 v184, v28, v24
MAA 176,36,160
TR 90,16,59712
v_fmac_f32 v185, v29, v24
MAA 192,40,160
TR 92,16,59232
v_fmac_f32 v186, v30, v24
MAA 196,40,164
buffer_load_dwordx4 v14, s[32:35], s54 offen offset:2112   lds
MAA 212,44,164
TR 94,16,59744
v_fmac_f32 v187, v31, v24
MAA 208,44,160
TR 96,16,50816
v_fmac_f32 v188, v28, v26
MAA 224,48,160
TR 98,16,51328
v_fmac_f32 v189, v29, v26
MAA 228,48,164
TR 100,16,50848
v_fmac_f32 v190, v30, v26
MAA 236,52,164
buffer_load_dwordx4 a[152:155], v11, s[16:19], s52 offen sc1
MAA 232,52,160
TR 102,16,51360
v_fmac_f32 v191, v31, v26
MAA 240,56,160
TR 104,16,59264
v_fmac_f32 v160, v4, v20
MAA 244,56,164
TR 106,16,59776
v_fmac_f32 v161, v5, v20
MAA 252,60,164
TR 108,16,59296
v_fmac_f32 v162, v6, v20
MAA 248,60,160
buffer_load_dwordx4 v15, s[32:35], s54 offen offset:3168   lds
s_waitcnt vmcnt(25)
MAA 220,44,172
TR 110,16,59808
s_add_u32 s54, s54, 229376
MAA 216,44,168
TR 112,17,50688
v_fmac_f32 v163, v7, v20
MAA 200,40,168
TR 114,17,51200
v_fmac_f32 v164, v4, v22
MAA 204,40,172
TR 116,17,50720
v_fmac_f32 v165, v5, v22
MAA 188,36,172
buffer_load_dwordx4 a[156:159], v11, s[16:19], s52 offen offset:1024 sc1
MAA 184,36,168
TR 118,17,51232
s_add_u32 s52, s52, 16384
MAA 168,32,168
TR 120,17,59136
s_mov_b32 m0, s67
MAA 172,32,172
TR 122,17,59648
v_fmac_f32 v166, v6, v22
MAA 156,28,172
TR 124,17,59168
v_fmac_f32 v167, v7, v22
MAA 152,28,168
buffer_load_dwordx4 v18, s[28:31], s58 offen lds
MAA 136,24,168
TR 126,17,59680
v_fmac_f32 v176, v28, v20
MAA 140,24,172
v_fmac_f32 v177, v29, v20
v_fmac_f32 v178, v30, v20
MAA 124,20,172
v_fmac_f32 v179, v31, v20
v_fmac_f32 v180, v28, v22
MAA 120,20,168
v_fmac_f32 v181, v29, v22
v_fmac_f32 v182, v30, v22
MAA 104,16,168
v_fmac_f32 v183, v31, v22
MAA 108,16,172
MAA 92,12,172
MAA 88,12,168
MAA 72,8,168
MAA 76,8,172
MAA 60,4,172
MAA 56,4,168
MAA 40,0,168
MAA 44,0,172
s_waitcnt vmcnt(20) lgkmcnt(0)
s_barrier
MAA 32,64,176
ds_read_b128 v[4:7], v9 offset:768
s_add_u32 m0, s55, 135168
MAA 36,64,180
buffer_load_dwordx4 v12, s[32:35], s54 offen   lds
MAA 52,68,180
ds_read_b128 v[28:31], v9 offset:832
MAA 48,68,176
ds_read_b64_tr_b16 a[0:1], v16
MAA 64,72,176
TR 2,16,512
MAA 68,72,180
TR 4,16,32
.Lpad24:
s_cbranch_execz .Lnopoll59r
MAA 84,76,180
buffer_load_dwordx4 a[160:163], v10, s[16:19], s52 offen sc1
MAA 80,76,176
TR 6,16,544
MAA 96,80,176
TR 8,16,8448
s_waitcnt lgkmcnt(6)
v_fmac_f32 v200, v4, v24
MAA 100,80,180
TR 10,16,8960
v_fmac_f32 v201, v5, v24
MAA 116,84,180
TR 12,16,8480
v_fmac_f32 v202, v6, v24
MAA 112,84,176
buffer_load_dwordx4 v13, s[32:35], s54 offen offset:1056   lds
MAA 128,88,176
TR 14,16,8992
v_fmac_f32 v203, v7, v24
MAA 132,88,180
TR 16,16,64
v_fmac_f32 v204, v4, v26
MAA 148,92,180
TR 18,16,576
v_fmac_f32 v205, v5, v26
MAA 144,92,176
TR 20,16,96
v_fmac_f32 v206, v6, v26
MAA 160,96,176
buffer_load_dwordx4 a[164:167], v10, s[16:19], s52 offen offset:1024 sc1
MAA 164,96,180
TR 22,16,608
v_fmac_f32 v207, v7, v26
MAA 180,100,180
TR 24,16,8512
s_waitcnt lgkmcnt(13)
v_fmac_f32 v216, v28, v24
MAA 176,100,176
TR 26,16,9024
v_fmac_f32 v217, v29, v24
MAA 192,104,176
TR 28,16,8544
v_fmac_f32 v218, v30, v24
MAA 196,104,180
buffer_load_dwordx4 v14, s[32:35], s54 offen offset:2112   lds
MAA 212,108,180
TR 30,16,9056
v_fmac_f32 v219, v31, v24
MAA 208,108,176
TR 32,16,128
v_fmac_f32 v220, v28, v26
MAA 224,112,176
TR 34,16,640
v_fmac_f32 v221, v29, v26
MAA 228,112,180
TR 36,16,160
v_fmac_f32 v222, v30, v26
MAA 236,116,180
buffer_load_dwordx4 a[168:171], v11, s[16:19], s52 offen sc1
MAA 232,116,176
TR 38,16,672
v_fmac_f32 v223, v31, v26
MAA 240,120,176
TR 40,16,8576
v_fmac_f32 v192, v4, v20
MAA 244,120,180
TR 42,16,9088
v_fmac_f32 v193, v5, v20
MAA 252,124,180
TR 44,16,8608
v_fmac_f32 v194, v6, v20
MAA 248,124,176
buffer_load_dwordx4 v15, s[32:35], s54 offen offset:3168   lds
s_waitcnt vmcnt(26)
MAA 220,108,188
TR 46,16,9120
s_add_u32 s54, s54, 229376
MAA 216,108,184
ds_read_b64_tr_b16 a[48:49], v17
v_fmac_f32 v195, v7, v20
MAA 200,104,184
TR 50,17,512
v_fmac_f32 v196, v4, v22
MAA 204,104,188
TR 52,17,32
v_fmac_f32 v197, v5, v22
MAA 188,100,188
buffer_load_dwordx4 a[172:175], v11, s[16:19], s52 offen offset:1024 sc1
MAA 184,100,184
TR 54,17,544
s_add_u32 s52, s52, 16384
MAA 168,96,184
TR 56,17,8448
s_mov_b32 m0, s67
MAA 172,96,188
TR 58,17,8960
v_fmac_f32 v198, v6, v22
MAA 156,92,188
TR 60,17,8480
v_fmac_f32 v199, v7, v22
MAA 152,92,184
buffer_load_dwordx4 v19, s[28:31], s58 offen offset:1056 lds
MAA 136,88,184
TR 62,17,8992
s_add_u32 s67, s67, 8448
MAA 140,88,188
s_add_u32 s46, s46, 1
s_xor_b32 s58, s46, s53
s_mul_i32 s58, s58, 458752
MAA 124,84,188
v_fmac_f32 v208, v28, v20
v_fmac_f32 v209, v29, v20
MAA 120,84,184
v_fmac_f32 v210, v30, v20
v_fmac_f32 v211, v31, v20
MAA 104,80,184
v_fmac_f32 v212, v28, v22
v_fmac_f32 v213, v29, v22
MAA 108,80,188
v_fmac_f32 v214, v30, v22
v_fmac_f32 v215, v31, v22
MAA 92,76,188
v_accvgpr_read_b32 v28, a192
v_accvgpr_read_b32 v29, a193
MAA 88,76,184
v_accvgpr_read_b32 v30, a194
v_accvgpr_read_b32 v31, a195
MAA 72,72,184
MAA 76,72,188
MAA 60,68,188
MAA 56,68,184
MAA 40,64,184
MAA 44,64,188
s_mov_b32 s15, -4
.p2align 6
.Lk64:
s_waitcnt vmcnt(20) lgkmcnt(0)
s_barrier
MAA 32,0,128
TR 64,16,16896
s_add_u32 m0, s55, 84480
MAA 36,0,132
buffer_load_dwordx4 v12, s[32:35], s54 offen   lds
MAA 52,4,132
TR 66,16,17408
MAA 48,4,128
TR 68,16,16928
MAA 64,8,128
TR 70,16,17440
MAA 68,8,132
MAA 84,12,132
TR 72,16,25344
MAA 80,12,128
buffer_load_dwordx4 a[176:179], v10, s[16:19], s52 offen sc1
MAA 96,16,128
TR 74,16,25856
MAA 100,16,132
TR 76,16,25376
MAA 116,20,132
MAA 112,20,128
TR 78,16,25888
MAA 128,24,128
TR 80,16,16960
MAA 132,24,132
buffer_load_dwordx4 v13, s[32:35], s54 offen offset:1056   lds
MAA 148,28,132
TR 82,16,17472
MAA 144,28,128
MAA 160,32,128
TR 84,16,16992
MAA 164,32,132
TR 86,16,17504
MAA 180,36,132
TR 88,16,25408
MAA 176,36,128
buffer_load_dwordx4 a[180:183], v10, s[16:19], s52 offen offset:1024 sc1
MAA 192,40,128
MAA 196,40,132
TR 90,16,25920
MAA 212,44,132
TR 92,16,25440
MAA 208,44,128
TR 94,16,25952
MAA 224,48,128
MAA 228,48,132
buffer_load_dwordx4 v14, s[32:35], s54 offen offset:2112   lds
MAA 236,52,132
TR 96,16,17024
MAA 232,52,128
TR 98,16,17536
MAA 240,56,128
TR 100,16,17056
MAA 244,56,132
TR 102,16,17568
MAA 252,60,132
MAA 248,60,128
buffer_load_dwordx4 a[184:187], v11, s[16:19], s52 offen sc1
s_waitcnt vmcnt(25)
MAA 220,44,140
TR 104,16,25472
MAA 216,44,136
TR 106,16,25984
MAA 200,40,136
TR 108,16,25504
MAA 204,40,140
MAA 188,36,140
TR 110,16,26016
MAA 184,36,136
buffer_load_dwordx4 v15, s[32:35], s54 offen offset:3168   lds
MAA 168,32,136
TR 112,17,16896
s_add_u32 s54, s54, 229376
MAA 172,32,140
TR 114,17,17408
MAA 156,28,140
MAA 152,28,136
TR 116,17,16928
MAA 136,24,136
TR 118,17,17440
MAA 140,24,140
buffer_load_dwordx4 a[188:191], v11, s[16:19], s52 offen offset:1024 sc1
MAA 124,20,140
TR 120,17,25344
s_add_u32 s52, s52, 16384
MAA 120,20,136
MAA 104,16,136
TR 122,17,25856
MAA 108,16,140
TR 124,17,25376
MAA 92,12,140
TR 126,17,25888
s_mov_b32 m0, s67
MAA 88,12,136
buffer_load_dwordx4 v18, s[28:31], s58 offen lds
MAA 72,8,136
MAA 76,8,140
MAA 60,4,140
MAA 56,4,136
MAA 40,0,136
MAA 44,0,140
s_waitcnt vmcnt(20) lgkmcnt(0)
s_barrier
MAA 32,64,144
TR 0,16,33792
s_add_u32 m0, s55, 101376
MAA 36,64,148
buffer_load_dwordx4 v12, s[32:35], s54 offen   lds
MAA 52,68,148
TR 2,16,34304
MAA 48,68,144
TR 4,16,33824
MAA 64,72,144
TR 6,16,34336
MAA 68,72,148
MAA 84,76,148
TR 8,16,42240
MAA 80,76,144
buffer_load_dwordx4 a[128:131], v10, s[16:19], s52 offen sc1
MAA 96,80,144
TR 10,16,42752
MAA 100,80,148
TR 12,16,42272
MAA 116,84,148
TR 14,16,42784
MAA 112,84,144
MAA 128,88,144
TR 16,16,33856
MAA 132,88,148
buffer_load_dwordx4 v13, s[32:35], s54 offen offset:1056   lds
MAA 148,92,148
TR 18,16,34368
MAA 144,92,144
TR 20,16,33888
MAA 160,96,144
MAA 164,96,148
TR 22,16,34400
MAA 180,100,148
TR 24,16,42304
MAA 176,100,144
buffer_load_dwordx4 a[132:135], v10, s[16:19], s52 offen offset:1024 sc1
MAA 192,104,144
TR 26,16,42816
MAA 196,104,148
TR 28,16,42336
MAA 212,108,148
MAA 208,108,144
TR 30,16,42848
MAA 224,112,144
TR 32,16,33920
MAA 228,112,148
buffer_load_dwordx4 v14, s[32:35], s54 offen offset:2112   lds
MAA 236,116,148
TR 34,16,34432
MAA 232,116,144
MAA 240,120,144
TR 36,16,33952
MAA 244,120,148
TR 38,16,34464
MAA 252,124,148
TR 40,16,42368
MAA 248,124,144
buffer_load_dwordx4 a[136:139], v11, s[16:19], s52 offen sc1
s_waitcnt vmcnt(25)
MAA 220,108,156
TR 42,16,42880
MAA 216,108,152
MAA 200,104,152
TR 44,16,42400
MAA 204,104,156
TR 46,16,42912
MAA 188,100,156
TR 48,17,33792
MAA 184,100,152
buffer_load_dwordx4 v15, s[32:35], s54 offen offset:3168   lds
MAA 168,96,152
s_add_u32 s54, s54, 229376
MAA 172,96,156
TR 50,17,34304
MAA 156,92,156
TR 52,17,33824
MAA 152,92,152
TR 54,17,34336
MAA 136,88,152
TR 56,17,42240
MAA 140,88,156
buffer_load_dwordx4 a[140:143], v11, s[16:19], s52 offen offset:1024 sc1
MAA 124,84,156
s_add_u32 s52, s52, 16384
MAA 120,84,152
TR 58,17,42752
MAA 104,80,152
TR 60,17,42272
MAA 108,80,156
TR 62,17,42784
MAA 92,76,156
s_mov_b32 m0, s67
MAA 88,76,152
buffer_load_dwordx4 v19, s[28:31], s58 offen offset:1056 lds
MAA 72,72,152
s_add_u32 s67, s67, 8448
s_add_u32 s58, s58, 0x40000
MAA 76,72,156
MAA 60,68,156
MAA 56,68,152
MAA 40,64,152
MAA 44,64,156
s_waitcnt vmcnt(20) lgkmcnt(0)
s_barrier
MAA 32,0,160
TR 64,16,50688
s_add_u32 m0, s55, 118272
MAA 36,0,164
buffer_load_dwordx4 v12, s[32:35], s54 offen   lds
MAA 52,4,164
TR 66,16,51200
MAA 48,4,160
TR 68,16,50720
MAA 64,8,160
TR 70,16,51232
MAA 68,8,164
MAA 84,12,164
TR 72,16,59136
MAA 80,12,160
buffer_load_dwordx4 a[144:147], v10, s[16:19], s52 offen sc1
MAA 96,16,160
TR 74,16,59648
MAA 100,16,164
TR 76,16,59168
MAA 116,20,164
MAA 112,20,160
TR 78,16,59680
MAA 128,24,160
TR 80,16,50752
MAA 132,24,164
buffer_load_dwordx4 v13, s[32:35], s54 offen offset:1056   lds
MAA 148,28,164
TR 82,16,51264
MAA 144,28,160
MAA 160,32,160
TR 84,16,50784
MAA 164,32,164
TR 86,16,51296
MAA 180,36,164
TR 88,16,59200
MAA 176,36,160
buffer_load_dwordx4 a[148:151], v10, s[16:19], s52 offen offset:1024 sc1
MAA 192,40,160
MAA 196,40,164
TR 90,16,59712
MAA 212,44,164
TR 92,16,59232
MAA 208,44,160
TR 94,16,59744
MAA 224,48,160
MAA 228,48,164
buffer_load_dwordx4 v14, s[32:35], s54 offen offset:2112   lds
MAA 236,52,164
TR 96,16,50816
MAA 232,52,160
TR 98,16,51328
MAA 240,56,160
TR 100,16,50848
MAA 244,56,164
TR 102,16,51360
MAA 252,60,164
MAA 248,60,160
buffer_load_dwordx4 a[152:155], v11, s[16:19], s52 offen sc1
s_waitcnt vmcnt(25)
MAA 220,44,172
TR 104,16,59264
MAA 216,44,168
TR 106,16,59776
MAA 200,40,168
TR 108,16,59296
MAA 204,40,172
MAA 188,36,172
TR 110,16,59808
MAA 184,36,168
buffer_load_dwordx4 v15, s[32:35], s54 offen offset:3168   lds
MAA 168,32,168
TR 112,17,50688
s_add_u32 s54, s54, 229376
MAA 172,32,172
TR 114,17,51200
MAA 156,28,172
MAA 152,28,168
TR 116,17,50720
MAA 136,24,168
TR 118,17,51232
MAA 140,24,172
buffer_load_dwordx4 a[156:159], v11, s[16:19], s52 offen offset:1024 sc1
MAA 124,20,172
TR 120,17,59136
s_add_u32 s52, s52, 16384
MAA 120,20,168
MAA 104,16,168
TR 122,17,59648
MAA 108,16,172
TR 124,17,59168
MAA 92,12,172
TR 126,17,59680
s_mov_b32 m0, s67
MAA 88,12,168
buffer_load_dwordx4 v18, s[28:31], s58 offen lds
MAA 72,8,168
MAA 76,8,172
MAA 60,4,172
MAA 56,4,168
MAA 40,0,168
MAA 44,0,172
s_waitcnt vmcnt(20) lgkmcnt(0)
s_barrier
MAA 32,64,176
ds_read_b64_tr_b16 a[0:1], v16
s_add_u32 m0, s55, 135168
MAA 36,64,180
buffer_load_dwordx4 v12, s[32:35], s54 offen   lds
MAA 52,68,180
TR 2,16,512
MAA 48,68,176
TR 4,16,32
MAA 64,72,176
TR 6,16,544
MAA 68,72,180
MAA 84,76,180
TR 8,16,8448
MAA 80,76,176
buffer_load_dwordx4 a[160:163], v10, s[16:19], s52 offen sc1
MAA 96,80,176
TR 10,16,8960
MAA 100,80,180
TR 12,16,8480
MAA 116,84,180
TR 14,16,8992
MAA 112,84,176
MAA 128,88,176
TR 16,16,64
MAA 132,88,180
buffer_load_dwordx4 v13, s[32:35], s54 offen offset:1056   lds
MAA 148,92,180
TR 18,16,576
MAA 144,92,176
TR 20,16,96
MAA 160,96,176
MAA 164,96,180
TR 22,16,608
MAA 180,100,180
TR 24,16,8512
MAA 176,100,176
buffer_load_dwordx4 a[164:167], v10, s[16:19], s52 offen offset:1024 sc1
MAA 192,104,176
TR 26,16,9024
MAA 196,104,180
TR 28,16,8544
MAA 212,108,180
MAA 208,108,176
TR 30,16,9056
MAA 224,112,176
TR 32,16,128
MAA 228,112,180
buffer_load_dwordx4 v14, s[32:35], s54 offen offset:2112   lds
MAA 236,116,180
TR 34,16,640
MAA 232,116,176
MAA 240,120,176
TR 36,16,160
MAA 244,120,180
TR 38,16,672
MAA 252,124,180
TR 40,16,8576
MAA 248,124,176
buffer_load_dwordx4 a[168:171], v11, s[16:19], s52 offen sc1
s_waitcnt vmcnt(25)
MAA 220,108,188
TR 42,16,9088
MAA 216,108,184
MAA 200,104,184
TR 44,16,8608
MAA 204,104,188
TR 46,16,9120
MAA 188,100,188
ds_read_b64_tr_b16 a[48:49], v17
MAA 184,100,184
buffer_load_dwordx4 v15, s[32:35], s54 offen offset:3168   lds
MAA 168,96,184
s_add_u32 s54, s54, 229376
MAA 172,96,188
TR 50,17,512
MAA 156,92,188
TR 52,17,32
MAA 152,92,184
TR 54,17,544
MAA 136,88,184
TR 56,17,8448
MAA 140,88,188
buffer_load_dwordx4 a[172:175], v11, s[16:19], s52 offen offset:1024 sc1
.Lpad25:
s_cbranch_execz .Lnopoll59r
MAA 124,84,188
s_add_u32 s52, s52, 16384
MAA 120,84,184
TR 58,17,8960
MAA 104,80,184
TR 60,17,8480
MAA 108,80,188
TR 62,17,8992
MAA 92,76,188
s_mov_b32 m0, s67
MAA 88,76,184
buffer_load_dwordx4 v19, s[28:31], s58 offen offset:1056 lds
MAA 72,72,184
s_add_u32 s67, s67, 8448
s_add_u32 s46, s46, 1
s_xor_b32 s58, s46, s53
s_mul_i32 s58, s58, 458752
MAA 76,72,188
MAA 60,68,188
MAA 56,68,184
MAA 40,64,184
s_add_u32 s15, s15, 1
MAA 44,64,188
s_cbranch_scc0 .Lk64
s_waitcnt vmcnt(11) lgkmcnt(0)
s_barrier
MAA 32,0,128
buffer_load_dwordx4 a[176:179], v10, s[16:19], s52 offen sc1
MAA 48,4,128
TR 64,16,16896
s_add_u32 s58, s99, 2293760
MAA 64,8,128
TR 66,16,17408
s_lshl_b32 s74, s3, 11
MAA 80,12,128
TR 68,16,16928
s_add_u32 s74, s74, s84
MAA 36,0,132
buffer_load_dwordx4 a[180:183], v10, s[16:19], s52 offen offset:1024 sc1
MAA 52,4,132
TR 70,16,17440
v_lshl_add_u32 v4, v1, 4, s74
MAA 68,8,132
TR 72,16,25344
v_lshrrev_b32 v2, 3, v1
MAA 84,12,132
TR 74,16,25856
v_cmp_eq_u32 vcc, 3, v2
MAA 40,0,136
buffer_load_dwordx4 a[184:187], v11, s[16:19], s52 offen sc1
MAA 56,4,136
TR 76,16,25376
v_add_u32 v2, 67108480, v4
MAA 72,8,136
TR 78,16,25888
v_cndmask_b32 v4, v4, v2, vcc
MAA 88,12,136
TR 80,16,33792
s_and_b32 s74, s7, 1
MAA 44,0,140
buffer_load_dwordx4 a[188:191], v11, s[16:19], s52 offen offset:1024 sc1
MAA 60,4,140
TR 82,16,34304
s_add_u32 s52, s52, 16384
MAA 76,8,140
TR 84,16,33824
s_add_u32 s54, s98, 65536
MAA 92,12,140
TR 86,16,34336
v_bfe_u32 v7, v1, 2, 3
MAA 96,16,128
TR 88,16,42240
v_mul_u32_u24 v7, 1056, v7
MAA 112,20,128
TR 90,16,42752
v_bfe_u32 v2, v1, 5, 1
MAA 128,24,128
TR 92,16,42272
v_lshl_add_u32 v7, v2, 8, v7
MAA 144,28,128
TR 94,16,42784
v_and_b32 v2, 3, v1
MAA 100,16,132
TR 112,16,16960
v_lshl_add_u32 v7, v2, 3, v7
MAA 116,20,132
TR 114,16,17472
s_lshl_b32 s74, s74, 7
MAA 132,24,132
TR 116,16,16992
s_xor_b32 s75, s74, 128
MAA 148,28,132
TR 118,16,17504
v_add_u32 v6, s75, v7
MAA 104,16,136
TR 120,16,25408
v_add_u32 v7, s74, v7
MAA 120,20,136
TR 122,16,25920
s_mul_i32 s55, s3, 2112
MAA 136,24,136
TR 124,16,25440
s_mov_b32 s57, 67584
MAA 152,28,136
TR 126,16,25952
MAA 108,16,140
TR 192,16,33856
MAA 124,20,140
TR 194,16,34368
MAA 140,24,140
TR 196,16,33888
MAA 156,28,140
TR 198,16,34400
MAA 160,32,128
TR 200,16,42304
MAA 176,36,128
TR 202,16,42816
MAA 192,40,128
TR 204,16,42336
MAA 208,44,128
TR 206,16,42848
MAA 164,32,132
TR 0,16,17024
MAA 180,36,132
TR 2,16,17536
s_waitcnt vmcnt(6)
s_barrier
MAA 196,40,132
TR 96,16,50688
MAA 212,44,132
TR 98,16,51200
MAA 168,32,136
TR 100,16,50720
MAA 184,36,136
TR 102,16,51232
MAA 200,40,136
TR 104,16,59136
MAA 216,44,136
TR 106,16,59648
MAA 172,32,140
TR 108,16,59168
MAA 188,36,140
TR 110,16,59680
MAA 204,40,140
TR 208,16,50752
MAA 220,44,140
TR 210,16,51264
MAA 224,48,128
TR 212,16,50784
MAA 232,52,128
TR 214,16,51296
MAA 240,56,128
TR 216,16,59200
MAA 248,60,128
TR 218,16,59712
MAA 228,48,132
TR 220,16,59232
MAA 236,52,132
TR 222,16,59744
MAA 244,56,132
TR 4,16,17056
MAA 252,60,132
TR 6,16,17568
s_waitcnt lgkmcnt(15)
MAA 32,64,144
TR 8,16,25472
MAA 48,68,144
TR 10,16,25984
MAA 64,72,144
TR 12,16,25504
MAA 80,76,144
TR 14,16,26016
MAA 32,80,160
TR 16,16,33920
MAA 48,84,160
TR 18,16,34432
MAA 64,88,160
TR 20,16,33952
MAA 80,92,160
TR 22,16,34464
s_waitcnt vmcnt(3)
MAA 32,96,176
TR 24,16,42368
s_waitcnt lgkmcnt(15)
MAA 48,100,176
TR 26,16,42880
MAA 64,104,176
TR 28,16,42400
MAA 80,108,176
TR 30,16,42912
s_nop 4
v_pk_mul_f32 v[64:65], v[64:65], v[32:33]
v_pk_mul_f32 v[32:33], v[32:33], v[28:29] op_sel_hi:[1,0]
v_pk_mul_f32 v[66:67], v[66:67], v[34:35]
v_pk_mul_f32 v[34:35], v[34:35], v[28:29] op_sel_hi:[1,0]
v_pk_mul_f32 v[80:81], v[80:81], v[48:49]
v_pk_mul_f32 v[48:49], v[48:49], v[28:29] op_sel_hi:[1,0]
v_pk_mul_f32 v[82:83], v[82:83], v[50:51]
v_pk_mul_f32 v[50:51], v[50:51], v[28:29] op_sel_hi:[1,0]
v_exp_f32 v32, v32
s_nop 0
MAA 36,64,148
TR 32,16,50816
v_exp_f32 v33, v33
MAA 52,68,148
TR 34,16,51328
v_exp_f32 v34, v34
MAA 68,72,148
TR 36,16,50848
v_exp_f32 v35, v35
MAA 84,76,148
TR 38,16,51360
v_exp_f32 v48, v48
MAA 36,80,164
TR 40,16,59264
v_exp_f32 v49, v49
MAA 52,84,164
TR 42,16,59776
v_exp_f32 v50, v50
MAA 68,88,164
TR 44,16,59296
v_exp_f32 v51, v51
MAA 84,92,164
TR 46,16,59808
s_waitcnt vmcnt(2)
MAA 36,96,180
TR 48,17,16896
MAA 52,100,180
TR 50,17,17408
MAA 68,104,180
TR 52,17,16928
MAA 84,108,180
TR 54,17,17440
s_nop 4
v_pk_mul_f32 v[68:69], v[68:69], v[36:37]
v_pk_mul_f32 v[36:37], v[36:37], v[28:29] op_sel:[0,1] op_sel_hi:[1,1]
v_pk_mul_f32 v[70:71], v[70:71], v[38:39]
v_pk_mul_f32 v[38:39], v[38:39], v[28:29] op_sel:[0,1] op_sel_hi:[1,1]
v_pk_mul_f32 v[84:85], v[84:85], v[52:53]
v_pk_mul_f32 v[52:53], v[52:53], v[28:29] op_sel:[0,1] op_sel_hi:[1,1]
v_pk_mul_f32 v[86:87], v[86:87], v[54:55]
v_pk_mul_f32 v[54:55], v[54:55], v[28:29] op_sel:[0,1] op_sel_hi:[1,1]
v_pk_fma_f32 v[32:33], v[32:33], v[20:21], v[20:21] op_sel:[0,1,1] op_sel_hi:[1,1,1]
v_pk_fma_f32 v[34:35], v[34:35], v[20:21], v[20:21] op_sel:[0,1,1] op_sel_hi:[1,1,1]
v_pk_fma_f32 v[48:49], v[48:49], v[20:21], v[20:21] op_sel:[0,1,1] op_sel_hi:[1,1,1]
v_pk_fma_f32 v[50:51], v[50:51], v[20:21], v[20:21] op_sel:[0,1,1] op_sel_hi:[1,1,1]
v_rcp_f32 v32, v32
s_nop 0
MAA 40,64,152
TR 56,17,25344
v_rcp_f32 v33, v33
MAA 56,68,152
TR 58,17,25856
v_rcp_f32 v34, v34
MAA 72,72,152
TR 60,17,25376
v_rcp_f32 v35, v35
MAA 88,76,152
TR 62,17,25888
v_rcp_f32 v48, v48
MAA 40,80,168
v_rcp_f32 v49, v49
MAA 56,84,168
v_rcp_f32 v50, v50
MAA 72,88,168
v_rcp_f32 v51, v51
MAA 88,92,168
v_exp_f32 v36, v36
s_waitcnt vmcnt(1)
MAA 40,96,184
v_exp_f32 v37, v37
MAA 56,100,184
v_exp_f32 v38, v38
MAA 72,104,184
v_exp_f32 v39, v39
MAA 88,108,184
v_exp_f32 v52, v52
v_exp_f32 v53, v53
v_exp_f32 v54, v54
v_exp_f32 v55, v55
v_pk_mul_f32 v[64:65], v[64:65], v[32:33]
v_pk_mul_f32 v[66:67], v[66:67], v[34:35]
v_pk_mul_f32 v[80:81], v[80:81], v[48:49]
v_pk_mul_f32 v[82:83], v[82:83], v[50:51]
v_pk_mul_f32 v[72:73], v[72:73], v[40:41]
v_pk_mul_f32 v[40:41], v[40:41], v[30:31] op_sel_hi:[1,0]
v_pk_mul_f32 v[74:75], v[74:75], v[42:43]
v_pk_mul_f32 v[42:43], v[42:43], v[30:31] op_sel_hi:[1,0]
v_pk_mul_f32 v[88:89], v[88:89], v[56:57]
v_pk_mul_f32 v[56:57], v[56:57], v[30:31] op_sel_hi:[1,0]
v_pk_mul_f32 v[90:91], v[90:91], v[58:59]
v_pk_mul_f32 v[58:59], v[58:59], v[30:31] op_sel_hi:[1,0]
v_pk_fma_f32 v[36:37], v[36:37], v[22:23], v[22:23] op_sel:[0,1,1] op_sel_hi:[1,1,1]
v_pk_fma_f32 v[38:39], v[38:39], v[22:23], v[22:23] op_sel:[0,1,1] op_sel_hi:[1,1,1]
v_pk_fma_f32 v[52:53], v[52:53], v[22:23], v[22:23] op_sel:[0,1,1] op_sel_hi:[1,1,1]
v_pk_fma_f32 v[54:55], v[54:55], v[22:23], v[22:23] op_sel:[0,1,1] op_sel_hi:[1,1,1]
v_cvt_pk_bf16_f32 v32, v64, v65
v_cvt_pk_bf16_f32 v33, v66, v67
v_cvt_pk_bf16_f32 v34, v80, v81
v_cvt_pk_bf16_f32 v35, v82, v83
MAA 44,64,156
buffer_store_dwordx4 v[32:35], v10, s[16:19], s62 offen sc1
MAA 60,68,156
TR 64,17,33792
v_rcp_f32 v36, v36
MAA 76,72,156
TR 66,17,34304
v_rcp_f32 v37, v37
MAA 92,76,156
TR 68,17,33824
v_rcp_f32 v38, v38
MAA 44,80,172
TR 70,17,34336
v_rcp_f32 v39, v39
MAA 60,84,172
TR 72,17,42240
v_rcp_f32 v52, v52
MAA 76,88,172
TR 74,17,42752
v_rcp_f32 v53, v53
MAA 92,92,172
TR 76,17,42272
v_rcp_f32 v54, v54
s_waitcnt vmcnt(1)
MAA 44,96,188
TR 78,17,42784
v_rcp_f32 v55, v55
MAA 60,100,188
TR 80,17,50688
v_exp_f32 v40, v40
MAA 76,104,188
TR 82,17,51200
v_exp_f32 v41, v41
MAA 92,108,188
TR 84,17,50720
v_exp_f32 v42, v42
v_exp_f32 v43, v43
v_exp_f32 v56, v56
v_exp_f32 v57, v57
v_exp_f32 v58, v58
v_exp_f32 v59, v59
v_pk_mul_f32 v[68:69], v[68:69], v[36:37]
v_pk_mul_f32 v[70:71], v[70:71], v[38:39]
v_pk_mul_f32 v[84:85], v[84:85], v[52:53]
v_pk_mul_f32 v[86:87], v[86:87], v[54:55]
v_pk_mul_f32 v[76:77], v[76:77], v[44:45]
v_pk_mul_f32 v[44:45], v[44:45], v[30:31] op_sel:[0,1] op_sel_hi:[1,1]
v_pk_mul_f32 v[78:79], v[78:79], v[46:47]
v_pk_mul_f32 v[46:47], v[46:47], v[30:31] op_sel:[0,1] op_sel_hi:[1,1]
v_pk_mul_f32 v[92:93], v[92:93], v[60:61]
v_pk_mul_f32 v[60:61], v[60:61], v[30:31] op_sel:[0,1] op_sel_hi:[1,1]
v_pk_mul_f32 v[94:95], v[94:95], v[62:63]
v_pk_mul_f32 v[62:63], v[62:63], v[30:31] op_sel:[0,1] op_sel_hi:[1,1]
v_pk_fma_f32 v[40:41], v[40:41], v[24:25], v[24:25] op_sel:[0,1,1] op_sel_hi:[1,1,1]
v_pk_fma_f32 v[42:43], v[42:43], v[24:25], v[24:25] op_sel:[0,1,1] op_sel_hi:[1,1,1]
v_pk_fma_f32 v[56:57], v[56:57], v[24:25], v[24:25] op_sel:[0,1,1] op_sel_hi:[1,1,1]
v_pk_fma_f32 v[58:59], v[58:59], v[24:25], v[24:25] op_sel:[0,1,1] op_sel_hi:[1,1,1]
v_cvt_pk_bf16_f32 v36, v68, v69
v_cvt_pk_bf16_f32 v37, v70, v71
v_cvt_pk_bf16_f32 v38, v84, v85
v_cvt_pk_bf16_f32 v39, v86, v87
MAA 96,112,144
buffer_store_dwordx4 v[36:39], v10, s[16:19], s62 offen offset:1024 sc1
MAA 112,116,144
TR 86,17,51232
v_rcp_f32 v40, v40
MAA 128,120,144
TR 88,17,59136
v_rcp_f32 v41, v41
MAA 144,124,144
TR 90,17,59648
v_rcp_f32 v42, v42
MAA 96,192,160
TR 92,17,59168
v_rcp_f32 v43, v43
MAA 112,196,160
TR 94,17,59680
v_rcp_f32 v56, v56
MAA 128,200,160
v_rcp_f32 v57, v57
MAA 144,204,160
v_rcp_f32 v58, v58
MAA 96,208,176
v_rcp_f32 v59, v59
MAA 112,212,176
v_exp_f32 v44, v44
s_waitcnt lgkmcnt(15)
MAA 128,216,176
v_exp_f32 v45, v45
MAA 144,220,176
v_lshrrev_b32 v69, 2, v0
v_min_u32 v69, 1, v69
v_lshlrev_b32 v69, 28, v69
v_lshl_add_u32 v68, v0, 7, v69
v_xor_b32 v69, 64, v0
v_min_u32 v69, 1, v69
s_waitcnt lgkmcnt(0)
s_barrier
v_lshlrev_b32 v70, 4, v69
v_sub_u32 v70, 16, v70
v_lshlrev_b32 v69, 28, v69
v_mov_b32 v71, 1
v_mov_b32 v84, 0
v_mov_b32 v85, 0
v_mov_b32 v86, 0
v_exp_f32 v46, v46
v_exp_f32 v47, v47
v_exp_f32 v60, v60
v_exp_f32 v61, v61
v_exp_f32 v62, v62
v_exp_f32 v63, v63
v_pk_mul_f32 v[72:73], v[72:73], v[40:41]
v_pk_mul_f32 v[74:75], v[74:75], v[42:43]
v_pk_mul_f32 v[88:89], v[88:89], v[56:57]
v_pk_mul_f32 v[90:91], v[90:91], v[58:59]
v_pk_mul_f32 v[128:129], v[128:129], v[96:97]
v_pk_mul_f32 v[96:97], v[96:97], v[28:29] op_sel_hi:[1,0]
v_pk_mul_f32 v[130:131], v[130:131], v[98:99]
v_pk_mul_f32 v[98:99], v[98:99], v[28:29] op_sel_hi:[1,0]
v_pk_mul_f32 v[144:145], v[144:145], v[112:113]
v_pk_mul_f32 v[112:113], v[112:113], v[28:29] op_sel_hi:[1,0]
v_pk_mul_f32 v[146:147], v[146:147], v[114:115]
v_pk_mul_f32 v[114:115], v[114:115], v[28:29] op_sel_hi:[1,0]
v_pk_fma_f32 v[44:45], v[44:45], v[26:27], v[26:27] op_sel:[0,1,1] op_sel_hi:[1,1,1]
v_pk_fma_f32 v[46:47], v[46:47], v[26:27], v[26:27] op_sel:[0,1,1] op_sel_hi:[1,1,1]
v_pk_fma_f32 v[60:61], v[60:61], v[26:27], v[26:27] op_sel:[0,1,1] op_sel_hi:[1,1,1]
v_pk_fma_f32 v[62:63], v[62:63], v[26:27], v[26:27] op_sel:[0,1,1] op_sel_hi:[1,1,1]
v_cvt_pk_bf16_f32 v40, v72, v73
v_cvt_pk_bf16_f32 v41, v74, v75
v_cvt_pk_bf16_f32 v42, v88, v89
v_cvt_pk_bf16_f32 v43, v90, v91
MAA 100,112,148
buffer_store_dwordx4 v[40:43], v11, s[16:19], s62 offen sc1
MAA 116,116,148
s_add_u32 m0, s59, 84480
v_rcp_f32 v44, v44
MAA 132,120,148
v_rcp_f32 v45, v45
MAA 148,124,148
v_rcp_f32 v46, v46
MAA 100,192,164
buffer_load_dwordx4 v18, s[28:31], s58 offen lds
MAA 116,196,164
v_rcp_f32 v47, v47
MAA 132,200,164
v_rcp_f32 v60, v60
MAA 148,204,164
v_rcp_f32 v61, v61
MAA 100,208,180
buffer_load_dwordx4 v19, s[28:31], s58 offen offset:1056 lds
MAA 116,212,180
s_add_u32 m0, s59, 92928
s_add_u32 s58, s99, 2555904
v_rcp_f32 v62, v62
MAA 132,216,180
v_rcp_f32 v63, v63
MAA 148,220,180
v_exp_f32 v96, v96
v_exp_f32 v97, v97
v_exp_f32 v98, v98
v_exp_f32 v99, v99
v_exp_f32 v112, v112
v_exp_f32 v113, v113
v_exp_f32 v114, v114
v_exp_f32 v115, v115
v_pk_mul_f32 v[76:77], v[76:77], v[44:45]
v_pk_mul_f32 v[78:79], v[78:79], v[46:47]
v_pk_mul_f32 v[92:93], v[92:93], v[60:61]
v_pk_mul_f32 v[94:95], v[94:95], v[62:63]
v_pk_mul_f32 v[132:133], v[132:133], v[100:101]
v_pk_mul_f32 v[100:101], v[100:101], v[28:29] op_sel:[0,1] op_sel_hi:[1,1]
v_pk_mul_f32 v[134:135], v[134:135], v[102:103]
v_pk_mul_f32 v[102:103], v[102:103], v[28:29] op_sel:[0,1] op_sel_hi:[1,1]
v_pk_mul_f32 v[148:149], v[148:149], v[116:117]
v_pk_mul_f32 v[116:117], v[116:117], v[28:29] op_sel:[0,1] op_sel_hi:[1,1]
v_pk_mul_f32 v[150:151], v[150:151], v[118:119]
v_pk_mul_f32 v[118:119], v[118:119], v[28:29] op_sel:[0,1] op_sel_hi:[1,1]
v_pk_fma_f32 v[96:97], v[96:97], v[20:21], v[20:21] op_sel:[0,1,1] op_sel_hi:[1,1,1]
v_pk_fma_f32 v[98:99], v[98:99], v[20:21], v[20:21] op_sel:[0,1,1] op_sel_hi:[1,1,1]
v_pk_fma_f32 v[112:113], v[112:113], v[20:21], v[20:21] op_sel:[0,1,1] op_sel_hi:[1,1,1]
v_pk_fma_f32 v[114:115], v[114:115], v[20:21], v[20:21] op_sel:[0,1,1] op_sel_hi:[1,1,1]
v_cvt_pk_bf16_f32 v44, v76, v77
v_cvt_pk_bf16_f32 v45, v78, v79
v_cvt_pk_bf16_f32 v46, v92, v93
v_cvt_pk_bf16_f32 v47, v94, v95
MAA 104,112,152
buffer_store_dwordx4 v[44:47], v11, s[16:19], s62 offen offset:1024 sc1
MAA 120,116,152
v_rcp_f32 v96, v96
MAA 136,120,152
v_rcp_f32 v97, v97
MAA 152,124,152
v_rcp_f32 v98, v98
MAA 104,192,168
buffer_load_dwordx4 v18, s[28:31], s58 offen lds
MAA 120,196,168
v_rcp_f32 v99, v99
MAA 136,200,168
v_rcp_f32 v112, v112
MAA 152,204,168
v_rcp_f32 v113, v113
MAA 104,208,184
buffer_load_dwordx4 v19, s[28:31], s58 offen offset:1056 lds
MAA 120,212,184
s_add_u32 m0, s59, 101376
s_add_u32 s58, s100, 2752512
v_rcp_f32 v114, v114
MAA 136,216,184
v_rcp_f32 v115, v115
MAA 152,220,184
v_exp_f32 v100, v100
v_exp_f32 v101, v101
v_exp_f32 v102, v102
v_exp_f32 v103, v103
v_exp_f32 v116, v116
v_exp_f32 v117, v117
v_exp_f32 v118, v118
v_exp_f32 v119, v119
v_pk_mul_f32 v[128:129], v[128:129], v[96:97]
v_pk_mul_f32 v[130:131], v[130:131], v[98:99]
v_pk_mul_f32 v[144:145], v[144:145], v[112:113]
v_pk_mul_f32 v[146:147], v[146:147], v[114:115]
v_pk_mul_f32 v[136:137], v[136:137], v[104:105]
v_pk_mul_f32 v[104:105], v[104:105], v[30:31] op_sel_hi:[1,0]
v_pk_mul_f32 v[138:139], v[138:139], v[106:107]
v_pk_mul_f32 v[106:107], v[106:107], v[30:31] op_sel_hi:[1,0]
v_pk_mul_f32 v[152:153], v[152:153], v[120:121]
v_pk_mul_f32 v[120:121], v[120:121], v[30:31] op_sel_hi:[1,0]
v_pk_mul_f32 v[154:155], v[154:155], v[122:123]
v_pk_mul_f32 v[122:123], v[122:123], v[30:31] op_sel_hi:[1,0]
v_pk_fma_f32 v[100:101], v[100:101], v[22:23], v[22:23] op_sel:[0,1,1] op_sel_hi:[1,1,1]
v_pk_fma_f32 v[102:103], v[102:103], v[22:23], v[22:23] op_sel:[0,1,1] op_sel_hi:[1,1,1]
v_pk_fma_f32 v[116:117], v[116:117], v[22:23], v[22:23] op_sel:[0,1,1] op_sel_hi:[1,1,1]
v_pk_fma_f32 v[118:119], v[118:119], v[22:23], v[22:23] op_sel:[0,1,1] op_sel_hi:[1,1,1]
v_cvt_pk_bf16_f32 v96, v128, v129
v_cvt_pk_bf16_f32 v97, v130, v131
v_cvt_pk_bf16_f32 v98, v144, v145
v_cvt_pk_bf16_f32 v99, v146, v147
MAA 108,112,156
buffer_store_dwordx4 v[96:99], v10, s[16:19], s63 offen sc1
MAA 124,116,156
v_rcp_f32 v100, v100
MAA 140,120,156
v_rcp_f32 v101, v101
MAA 156,124,156
v_rcp_f32 v102, v102
MAA 108,192,172
buffer_load_dwordx4 v18, s[28:31], s58 offen lds
MAA 124,196,172
v_rcp_f32 v103, v103
MAA 140,200,172
v_rcp_f32 v116, v116
MAA 156,204,172
v_rcp_f32 v117, v117
MAA 108,208,188
buffer_load_dwordx4 v19, s[28:31], s58 offen offset:1056 lds
MAA 124,212,188
s_add_u32 m0, s59, 109824
s_add_u32 s58, s100, 3014656
v_rcp_f32 v118, v118
MAA 140,216,188
v_rcp_f32 v119, v119
MAA 156,220,188
v_exp_f32 v104, v104
v_exp_f32 v105, v105
v_exp_f32 v106, v106
v_exp_f32 v107, v107
v_exp_f32 v120, v120
v_exp_f32 v121, v121
v_exp_f32 v122, v122
v_exp_f32 v123, v123
v_pk_mul_f32 v[132:133], v[132:133], v[100:101]
v_pk_mul_f32 v[134:135], v[134:135], v[102:103]
v_pk_mul_f32 v[148:149], v[148:149], v[116:117]
v_pk_mul_f32 v[150:151], v[150:151], v[118:119]
v_pk_mul_f32 v[140:141], v[140:141], v[108:109]
v_pk_mul_f32 v[108:109], v[108:109], v[30:31] op_sel:[0,1] op_sel_hi:[1,1]
v_pk_mul_f32 v[142:143], v[142:143], v[110:111]
v_pk_mul_f32 v[110:111], v[110:111], v[30:31] op_sel:[0,1] op_sel_hi:[1,1]
v_pk_mul_f32 v[156:157], v[156:157], v[124:125]
v_pk_mul_f32 v[124:125], v[124:125], v[30:31] op_sel:[0,1] op_sel_hi:[1,1]
v_pk_mul_f32 v[158:159], v[158:159], v[126:127]
v_pk_mul_f32 v[126:127], v[126:127], v[30:31] op_sel:[0,1] op_sel_hi:[1,1]
v_pk_fma_f32 v[104:105], v[104:105], v[24:25], v[24:25] op_sel:[0,1,1] op_sel_hi:[1,1,1]
v_pk_fma_f32 v[106:107], v[106:107], v[24:25], v[24:25] op_sel:[0,1,1] op_sel_hi:[1,1,1]
.Lpad26:
s_cbranch_execz .Lpad29
v_pk_fma_f32 v[120:121], v[120:121], v[24:25], v[24:25] op_sel:[0,1,1] op_sel_hi:[1,1,1]
v_pk_fma_f32 v[122:123], v[122:123], v[24:25], v[24:25] op_sel:[0,1,1] op_sel_hi:[1,1,1]
v_cvt_pk_bf16_f32 v100, v132, v133
v_cvt_pk_bf16_f32 v101, v134, v135
v_cvt_pk_bf16_f32 v102, v148, v149
v_cvt_pk_bf16_f32 v103, v150, v151
MAA 160,0,144
buffer_store_dwordx4 v[100:103], v10, s[16:19], s63 offen offset:1024 sc1
MAA 176,4,144
v_rcp_f32 v104, v104
MAA 192,8,144
s_waitcnt vmcnt(6)
s_barrier
v_rcp_f32 v105, v105
MAA 208,12,144
v_rcp_f32 v106, v106
MAA 160,16,160
buffer_atomic_add v71, v68, s[16:19], s72 offen offset:512
MAA 176,20,160
v_rcp_f32 v107, v107
MAA 192,24,160
v_rcp_f32 v120, v120
MAA 208,28,160
v_rcp_f32 v121, v121
MAA 160,32,176
buffer_load_dwordx4 v18, s[28:31], s58 offen lds
MAA 176,36,176
v_rcp_f32 v122, v122
MAA 192,40,176
v_rcp_f32 v123, v123
MAA 208,44,176
v_exp_f32 v108, v108
v_exp_f32 v109, v109
v_exp_f32 v110, v110
v_exp_f32 v111, v111
v_exp_f32 v124, v124
v_exp_f32 v125, v125
v_exp_f32 v126, v126
v_exp_f32 v127, v127
v_pk_mul_f32 v[136:137], v[136:137], v[104:105]
v_pk_mul_f32 v[138:139], v[138:139], v[106:107]
v_pk_mul_f32 v[152:153], v[152:153], v[120:121]
v_pk_mul_f32 v[154:155], v[154:155], v[122:123]
v_pk_mul_f32 v[192:193], v[192:193], v[160:161]
v_pk_mul_f32 v[160:161], v[160:161], v[28:29] op_sel_hi:[1,0]
v_pk_mul_f32 v[194:195], v[194:195], v[162:163]
v_pk_mul_f32 v[162:163], v[162:163], v[28:29] op_sel_hi:[1,0]
v_pk_mul_f32 v[208:209], v[208:209], v[176:177]
v_pk_mul_f32 v[176:177], v[176:177], v[28:29] op_sel_hi:[1,0]
v_pk_mul_f32 v[210:211], v[210:211], v[178:179]
v_pk_mul_f32 v[178:179], v[178:179], v[28:29] op_sel_hi:[1,0]
v_pk_fma_f32 v[108:109], v[108:109], v[26:27], v[26:27] op_sel:[0,1,1] op_sel_hi:[1,1,1]
v_pk_fma_f32 v[110:111], v[110:111], v[26:27], v[26:27] op_sel:[0,1,1] op_sel_hi:[1,1,1]
v_pk_fma_f32 v[124:125], v[124:125], v[26:27], v[26:27] op_sel:[0,1,1] op_sel_hi:[1,1,1]
v_pk_fma_f32 v[126:127], v[126:127], v[26:27], v[26:27] op_sel:[0,1,1] op_sel_hi:[1,1,1]
v_cvt_pk_bf16_f32 v104, v136, v137
v_cvt_pk_bf16_f32 v105, v138, v139
v_cvt_pk_bf16_f32 v106, v152, v153
v_cvt_pk_bf16_f32 v107, v154, v155
MAA 164,0,148
buffer_store_dwordx4 v[104:107], v11, s[16:19], s63 offen sc1
MAA 180,4,148
v_rcp_f32 v108, v108
MAA 196,8,148
v_rcp_f32 v109, v109
MAA 212,12,148
v_rcp_f32 v110, v110
MAA 164,16,164
buffer_load_dwordx4 v19, s[28:31], s58 offen offset:1056 lds
MAA 180,20,164
s_add_u32 m0, s59, 118272
s_add_u32 s58, s101, 3211264
v_rcp_f32 v111, v111
MAA 196,24,164
v_rcp_f32 v124, v124
MAA 212,28,164
v_rcp_f32 v125, v125
MAA 164,32,180
buffer_load_dwordx4 v18, s[28:31], s58 offen lds
MAA 180,36,180
v_rcp_f32 v126, v126
MAA 196,40,180
v_rcp_f32 v127, v127
MAA 212,44,180
v_exp_f32 v160, v160
v_exp_f32 v161, v161
v_exp_f32 v162, v162
v_exp_f32 v163, v163
v_exp_f32 v176, v176
v_exp_f32 v177, v177
v_exp_f32 v178, v178
v_exp_f32 v179, v179
v_pk_mul_f32 v[140:141], v[140:141], v[108:109]
v_pk_mul_f32 v[142:143], v[142:143], v[110:111]
v_pk_mul_f32 v[156:157], v[156:157], v[124:125]
v_pk_mul_f32 v[158:159], v[158:159], v[126:127]
v_pk_mul_f32 v[196:197], v[196:197], v[164:165]
v_pk_mul_f32 v[164:165], v[164:165], v[28:29] op_sel:[0,1] op_sel_hi:[1,1]
v_pk_mul_f32 v[198:199], v[198:199], v[166:167]
v_pk_mul_f32 v[166:167], v[166:167], v[28:29] op_sel:[0,1] op_sel_hi:[1,1]
v_pk_mul_f32 v[212:213], v[212:213], v[180:181]
v_pk_mul_f32 v[180:181], v[180:181], v[28:29] op_sel:[0,1] op_sel_hi:[1,1]
v_pk_mul_f32 v[214:215], v[214:215], v[182:183]
v_pk_mul_f32 v[182:183], v[182:183], v[28:29] op_sel:[0,1] op_sel_hi:[1,1]
v_pk_fma_f32 v[160:161], v[160:161], v[20:21], v[20:21] op_sel:[0,1,1] op_sel_hi:[1,1,1]
v_pk_fma_f32 v[162:163], v[162:163], v[20:21], v[20:21] op_sel:[0,1,1] op_sel_hi:[1,1,1]
v_pk_fma_f32 v[176:177], v[176:177], v[20:21], v[20:21] op_sel:[0,1,1] op_sel_hi:[1,1,1]
v_pk_fma_f32 v[178:179], v[178:179], v[20:21], v[20:21] op_sel:[0,1,1] op_sel_hi:[1,1,1]
v_cvt_pk_bf16_f32 v108, v140, v141
v_cvt_pk_bf16_f32 v109, v142, v143
v_cvt_pk_bf16_f32 v110, v156, v157
v_cvt_pk_bf16_f32 v111, v158, v159
MAA 168,0,152
buffer_store_dwordx4 v[108:111], v11, s[16:19], s63 offen offset:1024 sc1
MAA 184,4,152
v_rcp_f32 v160, v160
MAA 200,8,152
v_rcp_f32 v161, v161
MAA 216,12,152
v_rcp_f32 v162, v162
MAA 168,16,168
buffer_load_dwordx4 v19, s[28:31], s58 offen offset:1056 lds
MAA 184,20,168
s_add_u32 m0, s59, 126720
s_add_u32 s58, s101, 3473408
v_rcp_f32 v163, v163
MAA 200,24,168
v_rcp_f32 v176, v176
MAA 216,28,168
v_rcp_f32 v177, v177
MAA 168,32,184
buffer_load_dwordx4 v18, s[28:31], s58 offen lds
MAA 184,36,184
v_rcp_f32 v178, v178
MAA 200,40,184
v_rcp_f32 v179, v179
MAA 216,44,184
v_exp_f32 v164, v164
v_exp_f32 v165, v165
v_exp_f32 v166, v166
v_exp_f32 v167, v167
v_exp_f32 v180, v180
v_exp_f32 v181, v181
v_exp_f32 v182, v182
v_exp_f32 v183, v183
v_pk_mul_f32 v[192:193], v[192:193], v[160:161]
v_pk_mul_f32 v[194:195], v[194:195], v[162:163]
v_pk_mul_f32 v[208:209], v[208:209], v[176:177]
v_pk_mul_f32 v[210:211], v[210:211], v[178:179]
v_pk_mul_f32 v[200:201], v[200:201], v[168:169]
v_pk_mul_f32 v[168:169], v[168:169], v[30:31] op_sel_hi:[1,0]
v_pk_mul_f32 v[202:203], v[202:203], v[170:171]
v_pk_mul_f32 v[170:171], v[170:171], v[30:31] op_sel_hi:[1,0]
v_pk_mul_f32 v[216:217], v[216:217], v[184:185]
v_pk_mul_f32 v[184:185], v[184:185], v[30:31] op_sel_hi:[1,0]
v_pk_mul_f32 v[218:219], v[218:219], v[186:187]
v_pk_mul_f32 v[186:187], v[186:187], v[30:31] op_sel_hi:[1,0]
v_pk_fma_f32 v[164:165], v[164:165], v[22:23], v[22:23] op_sel:[0,1,1] op_sel_hi:[1,1,1]
v_pk_fma_f32 v[166:167], v[166:167], v[22:23], v[22:23] op_sel:[0,1,1] op_sel_hi:[1,1,1]
v_pk_fma_f32 v[180:181], v[180:181], v[22:23], v[22:23] op_sel:[0,1,1] op_sel_hi:[1,1,1]
v_pk_fma_f32 v[182:183], v[182:183], v[22:23], v[22:23] op_sel:[0,1,1] op_sel_hi:[1,1,1]
v_cvt_pk_bf16_f32 v160, v192, v193
v_cvt_pk_bf16_f32 v161, v194, v195
v_cvt_pk_bf16_f32 v162, v208, v209
v_cvt_pk_bf16_f32 v163, v210, v211
MAA 172,0,156
buffer_store_dwordx4 v[160:163], v10, s[16:19], s64 offen sc1
MAA 188,4,156
v_rcp_f32 v164, v164
MAA 204,8,156
v_rcp_f32 v165, v165
MAA 220,12,156
v_rcp_f32 v166, v166
MAA 172,16,172
buffer_atomic_add v84, v69, s[16:19], s73 offen offset:512 sc0
MAA 188,20,172
v_rcp_f32 v167, v167
MAA 204,24,172
v_rcp_f32 v180, v180
MAA 220,28,172
v_rcp_f32 v181, v181
MAA 172,32,188
buffer_load_dwordx4 v19, s[28:31], s58 offen offset:1056 lds
MAA 188,36,188
v_rcp_f32 v182, v182
MAA 204,40,188
v_rcp_f32 v183, v183
MAA 220,44,188
v_exp_f32 v168, v168
v_exp_f32 v169, v169
v_exp_f32 v170, v170
v_exp_f32 v171, v171
v_exp_f32 v184, v184
v_exp_f32 v185, v185
v_exp_f32 v186, v186
v_exp_f32 v187, v187
v_pk_mul_f32 v[196:197], v[196:197], v[164:165]
v_pk_mul_f32 v[198:199], v[198:199], v[166:167]
v_pk_mul_f32 v[212:213], v[212:213], v[180:181]
v_pk_mul_f32 v[214:215], v[214:215], v[182:183]
v_pk_mul_f32 v[204:205], v[204:205], v[172:173]
v_pk_mul_f32 v[172:173], v[172:173], v[30:31] op_sel:[0,1] op_sel_hi:[1,1]
v_pk_mul_f32 v[206:207], v[206:207], v[174:175]
v_pk_mul_f32 v[174:175], v[174:175], v[30:31] op_sel:[0,1] op_sel_hi:[1,1]
v_pk_mul_f32 v[220:221], v[220:221], v[188:189]
v_pk_mul_f32 v[188:189], v[188:189], v[30:31] op_sel:[0,1] op_sel_hi:[1,1]
v_pk_mul_f32 v[222:223], v[222:223], v[190:191]
v_pk_mul_f32 v[190:191], v[190:191], v[30:31] op_sel:[0,1] op_sel_hi:[1,1]
v_pk_fma_f32 v[168:169], v[168:169], v[24:25], v[24:25] op_sel:[0,1,1] op_sel_hi:[1,1,1]
v_pk_fma_f32 v[170:171], v[170:171], v[24:25], v[24:25] op_sel:[0,1,1] op_sel_hi:[1,1,1]
v_pk_fma_f32 v[184:185], v[184:185], v[24:25], v[24:25] op_sel:[0,1,1] op_sel_hi:[1,1,1]
v_pk_fma_f32 v[186:187], v[186:187], v[24:25], v[24:25] op_sel:[0,1,1] op_sel_hi:[1,1,1]
v_cvt_pk_bf16_f32 v164, v196, v197
v_cvt_pk_bf16_f32 v165, v198, v199
v_cvt_pk_bf16_f32 v166, v212, v213
v_cvt_pk_bf16_f32 v167, v214, v215
MAA 224,48,144
buffer_store_dwordx4 v[164:167], v10, s[16:19], s64 offen offset:1024 sc1
MAA 232,52,144
v_rcp_f32 v168, v168
MAA 240,56,144
v_rcp_f32 v169, v169
MAA 248,60,144
v_rcp_f32 v170, v170
MAA 224,64,160
buffer_atomic_add v85, v69, s[16:19], s73 offen offset:512 sc0
MAA 232,68,160
v_rcp_f32 v171, v171
MAA 240,72,160
v_rcp_f32 v184, v184
MAA 248,76,160
v_rcp_f32 v185, v185
MAA 224,80,176
v_rcp_f32 v186, v186
MAA 232,84,176
v_rcp_f32 v187, v187
MAA 240,88,176
v_exp_f32 v172, v172
MAA 248,92,176
v_exp_f32 v173, v173
v_exp_f32 v174, v174
v_exp_f32 v175, v175
v_exp_f32 v188, v188
v_exp_f32 v189, v189
v_exp_f32 v190, v190
v_exp_f32 v191, v191
v_pk_mul_f32 v[200:201], v[200:201], v[168:169]
v_pk_mul_f32 v[202:203], v[202:203], v[170:171]
v_pk_mul_f32 v[216:217], v[216:217], v[184:185]
v_pk_mul_f32 v[218:219], v[218:219], v[186:187]
v_pk_mul_f32 v[240:241], v[240:241], v[224:225]
v_pk_mul_f32 v[224:225], v[224:225], v[28:29] op_sel_hi:[1,0]
v_pk_mul_f32 v[242:243], v[242:243], v[226:227]
v_pk_mul_f32 v[226:227], v[226:227], v[28:29] op_sel_hi:[1,0]
v_pk_mul_f32 v[248:249], v[248:249], v[232:233]
v_pk_mul_f32 v[232:233], v[232:233], v[28:29] op_sel_hi:[1,0]
v_pk_mul_f32 v[250:251], v[250:251], v[234:235]
v_pk_mul_f32 v[234:235], v[234:235], v[28:29] op_sel_hi:[1,0]
v_pk_fma_f32 v[172:173], v[172:173], v[26:27], v[26:27] op_sel:[0,1,1] op_sel_hi:[1,1,1]
v_pk_fma_f32 v[174:175], v[174:175], v[26:27], v[26:27] op_sel:[0,1,1] op_sel_hi:[1,1,1]
v_pk_fma_f32 v[188:189], v[188:189], v[26:27], v[26:27] op_sel:[0,1,1] op_sel_hi:[1,1,1]
v_pk_fma_f32 v[190:191], v[190:191], v[26:27], v[26:27] op_sel:[0,1,1] op_sel_hi:[1,1,1]
v_cvt_pk_bf16_f32 v168, v200, v201
v_cvt_pk_bf16_f32 v169, v202, v203
v_cvt_pk_bf16_f32 v170, v216, v217
v_cvt_pk_bf16_f32 v171, v218, v219
buffer_store_dwordx4 v[168:171], v11, s[16:19], s64 offen sc1
buffer_atomic_add v86, v69, s[16:19], s73 offen offset:512 sc0
s_waitcnt vmcnt(5)
v_cmp_gt_u32 vcc, v70, v84
s_nop 0
s_cbranch_vccz .Lok65
s_waitcnt vmcnt(2)
v_cmp_gt_u32 vcc, v70, v85
s_nop 0
s_cbranch_vccz .Lok65
s_waitcnt vmcnt(0)
v_cmp_gt_u32 vcc, v70, v86
s_nop 0
s_cbranch_vccz .Lok65
s_mov_b32 s15, 0
.Lok65l:
v_mov_b32 v84, 0
buffer_atomic_add v84, v69, s[16:19], s73 offen offset:512 sc0
s_add_u32 s15, s15, 1
s_cmp_gt_u32 s15, 100000
s_waitcnt vmcnt(0)
s_cbranch_scc1 .Lok65
v_cmp_gt_u32 vcc, v70, v84
s_nop 0
s_cbranch_vccnz .Lok65l
.Lok65:
s_waitcnt vmcnt(4)
s_barrier
MAA 228,48,148
ds_read_b64_tr_b16 a[0:1], v7
s_add_u32 s52, s76, 0
MAA 236,52,148
buffer_load_dwordx4 v[96:99], v4, s[16:19], s52 offen sc1
MAA 244,56,148
TR 2,7,512
v_rcp_f32 v172, v172
MAA 252,60,148
TR 4,7,32
v_rcp_f32 v173, v173
MAA 228,64,164
TR 6,7,544
v_rcp_f32 v174, v174
MAA 236,68,164
buffer_load_dwordx4 v[100:103], v4, s[16:19], s52 offen offset:1024 sc1
MAA 244,72,164
TR 8,7,64
s_add_u32 s52, s76, 65536
MAA 252,76,164
TR 10,7,576
v_rcp_f32 v175, v175
MAA 228,80,180
TR 12,7,96
v_rcp_f32 v188, v188
MAA 236,84,180
buffer_load_dwordx4 v[104:107], v4, s[16:19], s52 offen sc1
MAA 244,88,180
TR 14,7,608
v_rcp_f32 v189, v189
MAA 252,92,180
ds_read_b64_tr_b16 a[16:17], v6
v_rcp_f32 v190, v190
v_rcp_f32 v191, v191
v_exp_f32 v224, v224
v_exp_f32 v225, v225
v_exp_f32 v226, v226
v_exp_f32 v227, v227
v_exp_f32 v232, v232
v_exp_f32 v233, v233
v_exp_f32 v234, v234
v_exp_f32 v235, v235
v_pk_mul_f32 v[204:205], v[204:205], v[172:173]
buffer_load_dwordx4 v[108:111], v4, s[16:19], s52 offen offset:1024 sc1
s_add_u32 s52, s77, 114688
v_pk_mul_f32 v[206:207], v[206:207], v[174:175]
v_pk_mul_f32 v[220:221], v[220:221], v[188:189]
v_pk_mul_f32 v[222:223], v[222:223], v[190:191]
v_pk_mul_f32 v[244:245], v[244:245], v[228:229]
v_pk_mul_f32 v[228:229], v[228:229], v[28:29] op_sel:[0,1] op_sel_hi:[1,1]
v_pk_mul_f32 v[246:247], v[246:247], v[230:231]
v_pk_mul_f32 v[230:231], v[230:231], v[28:29] op_sel:[0,1] op_sel_hi:[1,1]
v_pk_mul_f32 v[252:253], v[252:253], v[236:237]
v_pk_mul_f32 v[236:237], v[236:237], v[28:29] op_sel:[0,1] op_sel_hi:[1,1]
v_pk_mul_f32 v[254:255], v[254:255], v[238:239]
v_pk_mul_f32 v[238:239], v[238:239], v[28:29] op_sel:[0,1] op_sel_hi:[1,1]
v_pk_fma_f32 v[224:225], v[224:225], v[20:21], v[20:21] op_sel:[0,1,1] op_sel_hi:[1,1,1]
buffer_load_dwordx4 v[112:115], v4, s[16:19], s52 offen sc1
v_pk_fma_f32 v[226:227], v[226:227], v[20:21], v[20:21] op_sel:[0,1,1] op_sel_hi:[1,1,1]
v_pk_fma_f32 v[232:233], v[232:233], v[20:21], v[20:21] op_sel:[0,1,1] op_sel_hi:[1,1,1]
v_pk_fma_f32 v[234:235], v[234:235], v[20:21], v[20:21] op_sel:[0,1,1] op_sel_hi:[1,1,1]
v_cvt_pk_bf16_f32 v172, v204, v205
v_cvt_pk_bf16_f32 v173, v206, v207
v_cvt_pk_bf16_f32 v174, v220, v221
v_cvt_pk_bf16_f32 v175, v222, v223
TR 18,6,512
TR 20,6,32
TR 22,6,544
buffer_store_dwordx4 v[172:175], v11, s[16:19], s64 offen offset:1024 sc1
TR 24,6,64
TR 26,6,576
TR 28,6,96
TR 30,6,608
v_rcp_f32 v224, v224
v_rcp_f32 v225, v225
v_rcp_f32 v226, v226
v_rcp_f32 v227, v227
v_rcp_f32 v232, v232
v_rcp_f32 v233, v233
v_rcp_f32 v234, v234
v_rcp_f32 v235, v235
v_exp_f32 v228, v228
v_exp_f32 v229, v229
v_exp_f32 v230, v230
v_exp_f32 v231, v231
v_exp_f32 v236, v236
v_exp_f32 v237, v237
v_exp_f32 v238, v238
v_exp_f32 v239, v239
v_pk_mul_f32 v[240:241], v[240:241], v[224:225]
buffer_load_dwordx4 v[116:119], v4, s[16:19], s52 offen offset:1024 sc1
s_add_u32 s52, s77, 180224
v_pk_mul_f32 v[242:243], v[242:243], v[226:227]
v_pk_mul_f32 v[248:249], v[248:249], v[232:233]
v_pk_mul_f32 v[250:251], v[250:251], v[234:235]
v_pk_fma_f32 v[228:229], v[228:229], v[22:23], v[22:23] op_sel:[0,1,1] op_sel_hi:[1,1,1]
v_pk_fma_f32 v[230:231], v[230:231], v[22:23], v[22:23] op_sel:[0,1,1] op_sel_hi:[1,1,1]
v_pk_fma_f32 v[236:237], v[236:237], v[22:23], v[22:23] op_sel:[0,1,1] op_sel_hi:[1,1,1]
v_pk_fma_f32 v[238:239], v[238:239], v[22:23], v[22:23] op_sel:[0,1,1] op_sel_hi:[1,1,1]
v_cvt_pk_bf16_f32 v224, v240, v241
v_cvt_pk_bf16_f32 v225, v242, v243
v_cvt_pk_bf16_f32 v226, v248, v249
v_cvt_pk_bf16_f32 v227, v250, v251
v_rcp_f32 v228, v228
v_rcp_f32 v229, v229
v_rcp_f32 v230, v230
v_rcp_f32 v231, v231
v_rcp_f32 v236, v236
v_rcp_f32 v237, v237
v_rcp_f32 v238, v238
v_rcp_f32 v239, v239
v_pk_mul_f32 v[244:245], v[244:245], v[228:229]
buffer_store_dwordx4 v[224:227], v10, s[16:19], s65 offen sc1
v_pk_mul_f32 v[246:247], v[246:247], v[230:231]
v_pk_mul_f32 v[252:253], v[252:253], v[236:237]
v_pk_mul_f32 v[254:255], v[254:255], v[238:239]
v_cvt_pk_bf16_f32 v228, v244, v245
v_cvt_pk_bf16_f32 v229, v246, v247
v_cvt_pk_bf16_f32 v230, v252, v253
v_cvt_pk_bf16_f32 v231, v254, v255
buffer_store_dwordx4 v[228:231], v10, s[16:19], s65 offen offset:1024 sc1
buffer_load_dwordx4 v[120:123], v4, s[16:19], s52 offen sc1
buffer_load_dwordx4 v[124:127], v4, s[16:19], s52 offen offset:1024 sc1
v_mov_b32 v21, v68
v_mov_b32 v22, v69
v_mov_b32 v23, v70
v_mov_b32 v24, v71
v_mov_b32 v25, 0
s_waitcnt vmcnt(9) lgkmcnt(0)
s_barrier
v_mfma_f32_16x16x32_bf16 v[32:35], a[0:3], v[96:99], 0
TR 32,7,8448
s_add_u32 s52, s78, 229376
v_mfma_f32_16x16x32_bf16 v[48:51], a[0:3], v[100:103], 0
buffer_load_dwordx4 v[128:131], v4, s[16:19], s52 offen sc1
v_mfma_f32_16x16x32_bf16 v[52:55], a[4:7], v[100:103], 0
TR 34,7,8960
TR 36,7,8480
v_mfma_f32_16x16x32_bf16 v[36:39], a[4:7], v[96:99], 0
TR 38,7,8992
v_mfma_f32_16x16x32_bf16 v[40:43], a[8:11], v[96:99], 0
buffer_load_dwordx4 v[132:135], v4, s[16:19], s52 offen offset:1024 sc1
v_mfma_f32_16x16x32_bf16 v[56:59], a[8:11], v[100:103], 0
TR 40,7,8512
TR 42,7,9024
v_mfma_f32_16x16x32_bf16 v[60:63], a[12:15], v[100:103], 0
TR 44,7,8544
v_mfma_f32_16x16x32_bf16 v[44:47], a[12:15], v[96:99], 0
TR 46,7,9056
s_add_u32 s52, s78, 294912
v_mfma_f32_16x16x32_bf16 v[64:67], a[16:19], v[96:99], 0
buffer_load_dwordx4 v[136:139], v4, s[16:19], s52 offen sc1
v_mfma_f32_16x16x32_bf16 v[80:83], a[16:19], v[100:103], 0
TR 48,6,8448
v_mfma_f32_16x16x32_bf16 v[84:87], a[20:23], v[100:103], 0
TR 50,6,8960
TR 52,6,8480
v_mfma_f32_16x16x32_bf16 v[68:71], a[20:23], v[96:99], 0
TR 54,6,8992
v_mfma_f32_16x16x32_bf16 v[72:75], a[24:27], v[96:99], 0
buffer_load_dwordx4 v[140:143], v4, s[16:19], s52 offen offset:1024 sc1
v_mfma_f32_16x16x32_bf16 v[88:91], a[24:27], v[100:103], 0
TR 56,6,8512
TR 58,6,9024
v_mfma_f32_16x16x32_bf16 v[92:95], a[28:31], v[100:103], 0
TR 60,6,8544
v_mfma_f32_16x16x32_bf16 v[76:79], a[28:31], v[96:99], 0
TR 62,6,9056
s_waitcnt vmcnt(11) lgkmcnt(8)
MAV 32,32,104
TR 0,7,16896
s_add_u32 s52, s79, 344064
MAV 48,32,108
buffer_load_dwordx4 v[144:147], v4, s[16:19], s52 offen sc1
MAV 52,36,108
TR 2,7,17408
TR 4,7,16928
MAV 36,36,104
TR 6,7,17440
MAV 40,40,104
buffer_load_dwordx4 v[148:151], v4, s[16:19], s52 offen offset:1024 sc1
MAV 56,40,108
TR 8,7,16960
TR 10,7,17472
MAV 60,44,108
TR 12,7,16992
MAV 44,44,104
TR 14,7,17504
s_add_u32 s52, s79, 409600
s_waitcnt lgkmcnt(8)
MAV 64,48,104
buffer_load_dwordx4 v[152:155], v4, s[16:19], s52 offen sc1
MAV 80,48,108
TR 16,6,16896
MAV 84,52,108
TR 18,6,17408
TR 20,6,16928
MAV 68,52,104
TR 22,6,17440
MAV 72,56,104
buffer_load_dwordx4 v[156:159], v4, s[16:19], s52 offen offset:1024 sc1
MAV 88,56,108
TR 24,6,16960
TR 26,6,17472
MAV 92,60,108
TR 28,6,16992
MAV 76,60,104
TR 30,6,17504
s_waitcnt vmcnt(10) lgkmcnt(8)
s_barrier
MAV 32,0,112
TR 32,7,25344
TR 34,7,25856
MAV 48,0,116
buffer_atomic_add v24, v21, s[16:19], s72 offen
MAV 52,4,116
TR 36,7,25376
TR 38,7,25888
MAV 36,4,112
TR 40,7,25408
s_add_u32 m0, s55, 0
MAV 40,8,112
buffer_load_dwordx4 v18, s[28:31], s54 offen lds
MAV 56,8,116
TR 42,7,25920
MAV 60,12,116
TR 44,7,25440
TR 46,7,25952
MAV 44,12,112
TR 48,6,25344
s_add_u32 s52, s76, 458752
s_waitcnt lgkmcnt(9)
MAV 64,16,112
buffer_load_dwordx4 v[96:99], v4, s[16:19], s52 offen sc1
MAV 80,16,116
TR 50,6,25856
TR 52,6,25376
MAV 84,20,116
buffer_load_dwordx4 v19, s[28:31], s54 offen offset:1056 lds
MAV 68,20,112
s_add_u32 s54, s98, 327680
MAV 72,24,112
TR 54,6,25888
TR 56,6,25408
MAV 88,24,116
buffer_load_dwordx4 v[100:103], v4, s[16:19], s52 offen offset:1024 sc1
MAV 92,28,116
TR 58,6,25920
TR 60,6,25440
MAV 76,28,112
TR 62,6,25952
s_waitcnt vmcnt(13) lgkmcnt(8)
MAV 32,32,120
TR 0,7,33792
s_add_u32 m0, s55, 8448
MAV 48,32,124
buffer_load_dwordx4 v18, s[28:31], s54 offen lds
MAV 52,36,124
TR 2,7,34304
TR 4,7,33824
MAV 36,36,120
TR 6,7,34336
s_add_u32 s52, s76, 524288
MAV 40,40,120
buffer_load_dwordx4 v[104:107], v4, s[16:19], s52 offen sc1
MAV 56,40,124
TR 8,7,33856
MAV 60,44,124
TR 10,7,34368
TR 12,7,33888
MAV 44,44,120
TR 14,7,34400
s_waitcnt lgkmcnt(8)
MAV 64,48,120
buffer_load_dwordx4 v19, s[28:31], s54 offen offset:1056 lds
MAV 80,48,124
s_add_u32 s54, s99, 524288
MAV 84,52,124
TR 16,6,33792
TR 18,6,34304
MAV 68,52,120
TR 20,6,33824
TR 22,6,34336
MAV 72,56,120
buffer_load_dwordx4 v[108:111], v4, s[16:19], s52 offen offset:1024 sc1
MAV 88,56,124
TR 24,6,33856
MAV 92,60,124
TR 26,6,34368
TR 28,6,33888
MAV 76,60,120
TR 30,6,34400
s_waitcnt vmcnt(15) lgkmcnt(8)
s_barrier
MAV 32,0,128
TR 32,7,42240
s_add_u32 m0, s55, 16896
MAV 48,0,132
buffer_load_dwordx4 v18, s[28:31], s54 offen lds
MAV 52,4,132
TR 34,7,42752
.Lpad27:
s_cbranch_execz .Lpad30
TR 36,7,42272
MAV 36,4,128
TR 38,7,42784
s_add_u32 s52, s77, 573440
MAV 40,8,128
buffer_load_dwordx4 v[112:115], v4, s[16:19], s52 offen sc1
MAV 56,8,132
TR 40,7,42304
MAV 60,12,132
TR 42,7,42816
TR 44,7,42336
MAV 44,12,128
TR 46,7,42848
s_waitcnt lgkmcnt(8)
MAV 64,16,128
buffer_load_dwordx4 v19, s[28:31], s54 offen offset:1056 lds
MAV 80,16,132
s_add_u32 s54, s99, 786432
MAV 84,20,132
TR 48,6,42240
TR 50,6,42752
MAV 68,20,128
TR 52,6,42272
TR 54,6,42784
MAV 72,24,128
buffer_load_dwordx4 v[116:119], v4, s[16:19], s52 offen offset:1024 sc1
MAV 88,24,132
TR 56,6,42304
MAV 92,28,132
TR 58,6,42816
TR 60,6,42336
MAV 76,28,128
TR 62,6,42848
s_waitcnt vmcnt(17) lgkmcnt(8)
MAV 32,32,136
TR 0,7,50688
s_add_u32 m0, s55, 25344
MAV 48,32,140
buffer_load_dwordx4 v18, s[28:31], s54 offen lds
MAV 52,36,140
TR 2,7,51200
TR 4,7,50720
MAV 36,36,136
TR 6,7,51232
s_add_u32 s52, s77, 638976
MAV 40,40,136
buffer_load_dwordx4 v[120:123], v4, s[16:19], s52 offen sc1
MAV 56,40,140
TR 8,7,50752
TR 10,7,51264
MAV 60,44,140
TR 12,7,50784
TR 14,7,51296
MAV 44,44,136
s_waitcnt lgkmcnt(8)
MAV 64,48,136
buffer_load_dwordx4 v19, s[28:31], s54 offen offset:1056 lds
MAV 80,48,140
TR 16,6,50688
s_add_u32 s54, s100, 983040
MAV 84,52,140
buffer_load_dwordx4 v[124:127], v4, s[16:19], s52 offen offset:1024 sc1
MAV 68,52,136
TR 18,6,51200
TR 20,6,50720
MAV 72,56,136
TR 22,6,51232
TR 24,6,50752
MAV 88,56,140
buffer_atomic_add v25, v22, s[16:19], s73 offen sc0
MAV 92,60,140
TR 26,6,51264
TR 28,6,50784
MAV 76,60,136
TR 30,6,51296
s_waitcnt vmcnt(20) lgkmcnt(8)
s_barrier
MAV 32,0,144
TR 32,7,59136
s_add_u32 m0, s55, 33792
MAV 48,0,148
buffer_load_dwordx4 v18, s[28:31], s54 offen lds
MAV 52,4,148
TR 34,7,59648
TR 36,7,59168
MAV 36,4,144
TR 38,7,59680
s_add_u32 s52, s78, 688128
MAV 40,8,144
buffer_load_dwordx4 v[128:131], v4, s[16:19], s52 offen sc1
MAV 56,8,148
TR 40,7,59200
MAV 60,12,148
TR 42,7,59712
TR 44,7,59232
MAV 44,12,144
TR 46,7,59744
s_waitcnt lgkmcnt(8)
MAV 64,16,144
buffer_load_dwordx4 v19, s[28:31], s54 offen offset:1056 lds
MAV 80,16,148
s_add_u32 s54, s100, 1245184
MAV 84,20,148
TR 48,6,59136
TR 50,6,59648
MAV 68,20,144
TR 52,6,59168
TR 54,6,59680
MAV 72,24,144
buffer_load_dwordx4 v[132:135], v4, s[16:19], s52 offen offset:1024 sc1
MAV 88,24,148
TR 56,6,59200
MAV 92,28,148
TR 58,6,59712
TR 60,6,59232
MAV 76,28,144
TR 62,6,59744
v_add_u32 v7, s57, v7
v_add_u32 v6, s57, v6
s_sub_u32 s57, 0, s57
s_waitcnt vmcnt(22) lgkmcnt(8)
MAV 32,32,152
ds_read_b64_tr_b16 a[0:1], v7
s_add_u32 m0, s55, 42240
MAV 48,32,156
buffer_load_dwordx4 v18, s[28:31], s54 offen lds
MAV 52,36,156
TR 2,7,512
TR 4,7,32
MAV 36,36,152
TR 6,7,544
s_add_u32 s52, s78, 753664
MAV 40,40,152
buffer_load_dwordx4 v[136:139], v4, s[16:19], s52 offen sc1
MAV 56,40,156
TR 8,7,64
MAV 60,44,156
TR 10,7,576
TR 12,7,96
MAV 44,44,152
TR 14,7,608
s_waitcnt lgkmcnt(8)
MAV 64,48,152
buffer_load_dwordx4 v19, s[28:31], s54 offen offset:1056 lds
MAV 80,48,156
s_add_u32 s54, s101, 1441792
MAV 84,52,156
ds_read_b64_tr_b16 a[16:17], v6
TR 18,6,512
MAV 68,52,152
TR 20,6,32
TR 22,6,544
MAV 72,56,152
buffer_load_dwordx4 v[140:143], v4, s[16:19], s52 offen offset:1024 sc1
MAV 88,56,156
TR 24,6,64
MAV 92,60,156
TR 26,6,576
TR 28,6,96
MAV 76,60,152
TR 30,6,608
s_waitcnt vmcnt(21) lgkmcnt(8)
s_barrier
MAV 32,0,96
TR 32,7,8448
s_add_u32 m0, s55, 50688
MAV 48,0,100
buffer_load_dwordx4 v18, s[28:31], s54 offen lds
MAV 52,4,100
TR 34,7,8960
TR 36,7,8480
MAV 36,4,96
TR 38,7,8992
s_add_u32 s52, s79, 802816
MAV 40,8,96
buffer_load_dwordx4 v[144:147], v4, s[16:19], s52 offen sc1
MAV 56,8,100
TR 40,7,8512
MAV 60,12,100
TR 42,7,9024
TR 44,7,8544
MAV 44,12,96
TR 46,7,9056
s_waitcnt lgkmcnt(8)
MAV 64,16,96
buffer_load_dwordx4 v19, s[28:31], s54 offen offset:1056 lds
MAV 80,16,100
s_add_u32 s54, s101, 1703936
MAV 84,20,100
TR 48,6,8448
TR 50,6,8960
MAV 68,20,96
TR 52,6,8480
TR 54,6,8992
MAV 72,24,96
buffer_load_dwordx4 v[148:151], v4, s[16:19], s52 offen offset:1024 sc1
MAV 88,24,100
TR 56,6,8512
MAV 92,28,100
TR 58,6,9024
TR 60,6,8544
MAV 76,28,96
TR 62,6,9056
s_waitcnt vmcnt(21) lgkmcnt(8)
MAV 32,32,104
TR 0,7,16896
s_add_u32 m0, s55, 59136
MAV 48,32,108
buffer_load_dwordx4 v18, s[28:31], s54 offen lds
MAV 52,36,108
TR 2,7,17408
TR 4,7,16928
MAV 36,36,104
TR 6,7,17440
s_add_u32 s52, s79, 868352
MAV 40,40,104
buffer_load_dwordx4 v[152:155], v4, s[16:19], s52 offen sc1
MAV 56,40,108
TR 8,7,16960
MAV 60,44,108
TR 10,7,17472
TR 12,7,16992
MAV 44,44,104
TR 14,7,17504
s_waitcnt lgkmcnt(8)
MAV 64,48,104
buffer_load_dwordx4 v19, s[28:31], s54 offen offset:1056 lds
MAV 80,48,108
s_add_u32 s54, s98, 1900544
MAV 84,52,108
TR 16,6,16896
TR 18,6,17408
MAV 68,52,104
TR 20,6,16928
TR 22,6,17440
MAV 72,56,104
buffer_load_dwordx4 v[156:159], v4, s[16:19], s52 offen offset:1024 sc1
MAV 88,56,108
TR 24,6,16960
MAV 92,60,108
TR 26,6,17472
TR 28,6,16992
MAV 76,60,104
TR 30,6,17504
s_waitcnt vmcnt(16)
v_cmp_gt_u32 vcc, v23, v25
s_nop 0
s_cbranch_vccnz .Lsp66
.Lsp66b:
s_waitcnt lgkmcnt(8)
s_barrier
MAV 32,0,112
TR 32,7,25344
s_add_u32 m0, s55, 67584
MAV 48,0,116
buffer_load_dwordx4 v18, s[28:31], s54 offen lds
MAV 52,4,116
TR 34,7,25856
TR 36,7,25376
MAV 36,4,112
TR 38,7,25888
s_add_u32 s52, s76, 16384
MAV 40,8,112
buffer_load_dwordx4 v[96:99], v4, s[16:19], s52 offen sc1
MAV 56,8,116
TR 40,7,25408
MAV 60,12,116
TR 42,7,25920
TR 44,7,25440
MAV 44,12,112
TR 46,7,25952
s_waitcnt lgkmcnt(8)
MAV 64,16,112
buffer_load_dwordx4 v19, s[28:31], s54 offen offset:1056 lds
MAV 80,16,116
s_add_u32 s54, s98, 2162688
MAV 84,20,116
TR 48,6,25344
TR 50,6,25856
MAV 68,20,112
TR 52,6,25376
TR 54,6,25888
MAV 72,24,112
buffer_load_dwordx4 v[100:103], v4, s[16:19], s52 offen offset:1024 sc1
MAV 88,24,116
TR 56,6,25408
MAV 92,28,116
TR 58,6,25920
TR 60,6,25440
MAV 76,28,112
TR 62,6,25952
s_waitcnt lgkmcnt(8)
MAV 32,32,120
TR 0,7,33792
s_add_u32 m0, s55, 76032
MAV 48,32,124
buffer_load_dwordx4 v18, s[28:31], s54 offen lds
MAV 52,36,124
TR 2,7,34304
TR 4,7,33824
MAV 36,36,120
TR 6,7,34336
s_add_u32 s52, s76, 81920
MAV 40,40,120
buffer_load_dwordx4 v[104:107], v4, s[16:19], s52 offen sc1
MAV 56,40,124
TR 8,7,33856
MAV 60,44,124
TR 10,7,34368
TR 12,7,33888
MAV 44,44,120
TR 14,7,34400
s_waitcnt lgkmcnt(8)
MAV 64,48,120
buffer_load_dwordx4 v19, s[28:31], s54 offen offset:1056 lds
MAV 80,48,124
s_add_u32 s54, s99, 2359296
MAV 84,52,124
TR 16,6,33792
TR 18,6,34304
MAV 68,52,120
TR 20,6,33824
TR 22,6,34336
MAV 72,56,120
buffer_load_dwordx4 v[108:111], v4, s[16:19], s52 offen offset:1024 sc1
MAV 88,56,124
TR 24,6,33856
MAV 92,60,124
TR 26,6,34368
TR 28,6,33888
MAV 76,60,120
TR 30,6,34400
s_waitcnt vmcnt(20) lgkmcnt(8)
s_barrier
MAV 32,0,128
TR 32,7,42240
s_add_u32 m0, s55, 84480
MAV 48,0,132
buffer_load_dwordx4 v18, s[28:31], s54 offen lds
MAV 52,4,132
TR 34,7,42752
TR 36,7,42272
MAV 36,4,128
TR 38,7,42784
s_add_u32 s52, s77, 131072
MAV 40,8,128
buffer_load_dwordx4 v[112:115], v4, s[16:19], s52 offen sc1
MAV 56,8,132
TR 40,7,42304
MAV 60,12,132
TR 42,7,42816
TR 44,7,42336
MAV 44,12,128
TR 46,7,42848
s_waitcnt lgkmcnt(8)
MAV 64,16,128
buffer_load_dwordx4 v19, s[28:31], s54 offen offset:1056 lds
MAV 80,16,132
s_add_u32 s54, s99, 2621440
MAV 84,20,132
TR 48,6,42240
TR 50,6,42752
MAV 68,20,128
TR 52,6,42272
TR 54,6,42784
MAV 72,24,128
buffer_load_dwordx4 v[116:119], v4, s[16:19], s52 offen offset:1024 sc1
MAV 88,24,132
TR 56,6,42304
MAV 92,28,132
TR 58,6,42816
TR 60,6,42336
MAV 76,28,128
TR 62,6,42848
s_waitcnt vmcnt(20) lgkmcnt(8)
MAV 32,32,136
TR 0,7,50688
s_add_u32 m0, s55, 92928
MAV 48,32,140
buffer_load_dwordx4 v18, s[28:31], s54 offen lds
MAV 52,36,140
TR 2,7,51200
TR 4,7,50720
MAV 36,36,136
TR 6,7,51232
s_add_u32 s52, s77, 196608
MAV 40,40,136
buffer_load_dwordx4 v[120:123], v4, s[16:19], s52 offen sc1
MAV 56,40,140
TR 8,7,50752
MAV 60,44,140
TR 10,7,51264
TR 12,7,50784
MAV 44,44,136
TR 14,7,51296
s_waitcnt lgkmcnt(8)
MAV 64,48,136
buffer_load_dwordx4 v19, s[28:31], s54 offen offset:1056 lds
MAV 80,48,140
s_add_u32 s54, s100, 2818048
MAV 84,52,140
TR 16,6,50688
TR 18,6,51200
MAV 68,52,136
TR 20,6,50720
TR 22,6,51232
MAV 72,56,136
buffer_load_dwordx4 v[124:127], v4, s[16:19], s52 offen offset:1024 sc1
MAV 88,56,140
TR 24,6,50752
MAV 92,60,140
TR 26,6,51264
TR 28,6,50784
MAV 76,60,136
TR 30,6,51296
s_waitcnt vmcnt(20) lgkmcnt(8)
s_barrier
MAV 32,0,144
TR 32,7,59136
s_add_u32 m0, s55, 101376
MAV 48,0,148
buffer_load_dwordx4 v18, s[28:31], s54 offen lds
MAV 52,4,148
TR 34,7,59648
TR 36,7,59168
MAV 36,4,144
TR 38,7,59680
s_add_u32 s52, s78, 245760
MAV 40,8,144
buffer_load_dwordx4 v[128:131], v4, s[16:19], s52 offen sc1
MAV 56,8,148
TR 40,7,59200
MAV 60,12,148
TR 42,7,59712
TR 44,7,59232
MAV 44,12,144
TR 46,7,59744
s_waitcnt lgkmcnt(8)
MAV 64,16,144
buffer_load_dwordx4 v19, s[28:31], s54 offen offset:1056 lds
MAV 80,16,148
s_add_u32 s54, s100, 3080192
MAV 84,20,148
TR 48,6,59136
TR 50,6,59648
MAV 68,20,144
TR 52,6,59168
TR 54,6,59680
MAV 72,24,144
buffer_load_dwordx4 v[132:135], v4, s[16:19], s52 offen offset:1024 sc1
MAV 88,24,148
TR 56,6,59200
MAV 92,28,148
TR 58,6,59712
TR 60,6,59232
MAV 76,28,144
TR 62,6,59744
v_add_u32 v7, s57, v7
v_add_u32 v6, s57, v6
s_sub_u32 s57, 0, s57
s_waitcnt vmcnt(20) lgkmcnt(8)
MAV 32,32,152
ds_read_b64_tr_b16 a[0:1], v7
s_add_u32 m0, s55, 109824
MAV 48,32,156
buffer_load_dwordx4 v18, s[28:31], s54 offen lds
MAV 52,36,156
TR 2,7,512
TR 4,7,32
MAV 36,36,152
TR 6,7,544
s_add_u32 s52, s78, 311296
MAV 40,40,152
buffer_load_dwordx4 v[136:139], v4, s[16:19], s52 offen sc1
MAV 56,40,156
TR 8,7,64
MAV 60,44,156
TR 10,7,576
TR 12,7,96
MAV 44,44,152
TR 14,7,608
s_waitcnt lgkmcnt(8)
MAV 64,48,152
buffer_load_dwordx4 v19, s[28:31], s54 offen offset:1056 lds
MAV 80,48,156
s_add_u32 s54, s101, 3276800
MAV 84,52,156
ds_read_b64_tr_b16 a[16:17], v6
TR 18,6,512
MAV 68,52,152
TR 20,6,32
TR 22,6,544
MAV 72,56,152
buffer_load_dwordx4 v[140:143], v4, s[16:19], s52 offen offset:1024 sc1
MAV 88,56,156
TR 24,6,64
MAV 92,60,156
TR 26,6,576
TR 28,6,96
MAV 76,60,152
TR 30,6,608
s_waitcnt vmcnt(20) lgkmcnt(8)
s_barrier
MAV 32,0,96
TR 32,7,8448
s_add_u32 m0, s55, 118272
MAV 48,0,100
buffer_load_dwordx4 v18, s[28:31], s54 offen lds
MAV 52,4,100
TR 34,7,8960
TR 36,7,8480
MAV 36,4,96
TR 38,7,8992
s_add_u32 s52, s79, 360448
MAV 40,8,96
buffer_load_dwordx4 v[144:147], v4, s[16:19], s52 offen sc1
MAV 56,8,100
TR 40,7,8512
MAV 60,12,100
TR 42,7,9024
TR 44,7,8544
MAV 44,12,96
TR 46,7,9056
s_waitcnt lgkmcnt(8)
MAV 64,16,96
buffer_load_dwordx4 v19, s[28:31], s54 offen offset:1056 lds
MAV 80,16,100
s_add_u32 s54, s101, 3538944
MAV 84,20,100
TR 48,6,8448
TR 50,6,8960
MAV 68,20,96
TR 52,6,8480
.Lpad28:
s_cbranch_execz .Lpad31
TR 54,6,8992
MAV 72,24,96
buffer_load_dwordx4 v[148:151], v4, s[16:19], s52 offen offset:1024 sc1
MAV 88,24,100
TR 56,6,8512
MAV 92,28,100
TR 58,6,9024
TR 60,6,8544
MAV 76,28,96
TR 62,6,9056
s_waitcnt vmcnt(20) lgkmcnt(8)
MAV 32,32,104
TR 0,7,16896
s_add_u32 m0, s55, 126720
MAV 48,32,108
buffer_load_dwordx4 v18, s[28:31], s54 offen lds
MAV 52,36,108
TR 2,7,17408
TR 4,7,16928
MAV 36,36,104
TR 6,7,17440
s_add_u32 s52, s79, 425984
MAV 40,40,104
buffer_load_dwordx4 v[152:155], v4, s[16:19], s52 offen sc1
MAV 56,40,108
TR 8,7,16960
MAV 60,44,108
TR 10,7,17472
TR 12,7,16992
MAV 44,44,104
TR 14,7,17504
s_waitcnt lgkmcnt(8)
MAV 64,48,104
buffer_load_dwordx4 v19, s[28:31], s54 offen offset:1056 lds
MAV 80,48,108
s_add_u32 s54, s98, 131072
MAV 84,52,108
TR 16,6,16896
TR 18,6,17408
MAV 68,52,104
TR 20,6,16928
TR 22,6,17440
MAV 72,56,104
buffer_load_dwordx4 v[156:159], v4, s[16:19], s52 offen offset:1024 sc1
MAV 88,56,108
TR 24,6,16960
MAV 92,60,108
TR 26,6,17472
TR 28,6,16992
MAV 76,60,104
TR 30,6,17504
s_waitcnt vmcnt(20) lgkmcnt(8)
s_barrier
MAV 32,0,112
TR 32,7,25344
s_add_u32 m0, s55, 0
MAV 48,0,116
buffer_load_dwordx4 v18, s[28:31], s54 offen lds
MAV 52,4,116
TR 34,7,25856
TR 36,7,25376
MAV 36,4,112
TR 38,7,25888
s_add_u32 s52, s76, 475136
MAV 40,8,112
buffer_load_dwordx4 v[96:99], v4, s[16:19], s52 offen sc1
MAV 56,8,116
TR 40,7,25408
MAV 60,12,116
TR 42,7,25920
TR 44,7,25440
MAV 44,12,112
TR 46,7,25952
s_waitcnt lgkmcnt(8)
MAV 64,16,112
buffer_load_dwordx4 v19, s[28:31], s54 offen offset:1056 lds
MAV 80,16,116
s_add_u32 s54, s98, 393216
MAV 84,20,116
TR 48,6,25344
TR 50,6,25856
MAV 68,20,112
TR 52,6,25376
TR 54,6,25888
MAV 72,24,112
buffer_load_dwordx4 v[100:103], v4, s[16:19], s52 offen offset:1024 sc1
MAV 88,24,116
TR 56,6,25408
MAV 92,28,116
TR 58,6,25920
TR 60,6,25440
MAV 76,28,112
TR 62,6,25952
s_waitcnt vmcnt(20) lgkmcnt(8)
MAV 32,32,120
TR 0,7,33792
s_add_u32 m0, s55, 8448
MAV 48,32,124
buffer_load_dwordx4 v18, s[28:31], s54 offen lds
MAV 52,36,124
TR 2,7,34304
TR 4,7,33824
MAV 36,36,120
TR 6,7,34336
s_add_u32 s52, s76, 540672
MAV 40,40,120
buffer_load_dwordx4 v[104:107], v4, s[16:19], s52 offen sc1
MAV 56,40,124
TR 8,7,33856
MAV 60,44,124
TR 10,7,34368
TR 12,7,33888
MAV 44,44,120
TR 14,7,34400
s_waitcnt lgkmcnt(8)
MAV 64,48,120
buffer_load_dwordx4 v19, s[28:31], s54 offen offset:1056 lds
MAV 80,48,124
s_add_u32 s54, s99, 589824
MAV 84,52,124
TR 16,6,33792
TR 18,6,34304
MAV 68,52,120
TR 20,6,33824
TR 22,6,34336
MAV 72,56,120
buffer_load_dwordx4 v[108:111], v4, s[16:19], s52 offen offset:1024 sc1
MAV 88,56,124
TR 24,6,33856
MAV 92,60,124
TR 26,6,34368
TR 28,6,33888
MAV 76,60,120
TR 30,6,34400
s_waitcnt vmcnt(20) lgkmcnt(8)
s_barrier
MAV 32,0,128
TR 32,7,42240
s_add_u32 m0, s55, 16896
MAV 48,0,132
buffer_load_dwordx4 v18, s[28:31], s54 offen lds
MAV 52,4,132
TR 34,7,42752
TR 36,7,42272
MAV 36,4,128
TR 38,7,42784
s_add_u32 s52, s77, 589824
MAV 40,8,128
buffer_load_dwordx4 v[112:115], v4, s[16:19], s52 offen sc1
MAV 56,8,132
TR 40,7,42304
MAV 60,12,132
TR 42,7,42816
TR 44,7,42336
MAV 44,12,128
TR 46,7,42848
s_waitcnt lgkmcnt(8)
MAV 64,16,128
buffer_load_dwordx4 v19, s[28:31], s54 offen offset:1056 lds
MAV 80,16,132
s_add_u32 s54, s99, 851968
MAV 84,20,132
TR 48,6,42240
TR 50,6,42752
MAV 68,20,128
TR 52,6,42272
TR 54,6,42784
MAV 72,24,128
buffer_load_dwordx4 v[116:119], v4, s[16:19], s52 offen offset:1024 sc1
MAV 88,24,132
TR 56,6,42304
MAV 92,28,132
TR 58,6,42816
TR 60,6,42336
MAV 76,28,128
TR 62,6,42848
s_waitcnt vmcnt(20) lgkmcnt(8)
MAV 32,32,136
TR 0,7,50688
s_add_u32 m0, s55, 25344
MAV 48,32,140
buffer_load_dwordx4 v18, s[28:31], s54 offen lds
MAV 52,36,140
TR 2,7,51200
TR 4,7,50720
MAV 36,36,136
TR 6,7,51232
s_add_u32 s52, s77, 655360
MAV 40,40,136
buffer_load_dwordx4 v[120:123], v4, s[16:19], s52 offen sc1
MAV 56,40,140
TR 8,7,50752
MAV 60,44,140
TR 10,7,51264
TR 12,7,50784
MAV 44,44,136
TR 14,7,51296
s_waitcnt lgkmcnt(8)
MAV 64,48,136
buffer_load_dwordx4 v19, s[28:31], s54 offen offset:1056 lds
MAV 80,48,140
s_add_u32 s54, s100, 1048576
MAV 84,52,140
TR 16,6,50688
TR 18,6,51200
MAV 68,52,136
TR 20,6,50720
TR 22,6,51232
MAV 72,56,136
buffer_load_dwordx4 v[124:127], v4, s[16:19], s52 offen offset:1024 sc1
MAV 88,56,140
TR 24,6,50752
MAV 92,60,140
TR 26,6,51264
TR 28,6,50784
MAV 76,60,136
TR 30,6,51296
s_waitcnt vmcnt(20) lgkmcnt(8)
s_barrier
MAV 32,0,144
TR 32,7,59136
s_add_u32 m0, s55, 33792
MAV 48,0,148
buffer_load_dwordx4 v18, s[28:31], s54 offen lds
MAV 52,4,148
TR 34,7,59648
TR 36,7,59168
MAV 36,4,144
TR 38,7,59680
s_add_u32 s52, s78, 704512
MAV 40,8,144
buffer_load_dwordx4 v[128:131], v4, s[16:19], s52 offen sc1
MAV 56,8,148
TR 40,7,59200
MAV 60,12,148
TR 42,7,59712
TR 44,7,59232
MAV 44,12,144
TR 46,7,59744
s_waitcnt lgkmcnt(8)
MAV 64,16,144
buffer_load_dwordx4 v19, s[28:31], s54 offen offset:1056 lds
MAV 80,16,148
s_add_u32 s54, s100, 1310720
MAV 84,20,148
TR 48,6,59136
TR 50,6,59648
MAV 68,20,144
TR 52,6,59168
TR 54,6,59680
MAV 72,24,144
buffer_load_dwordx4 v[132:135], v4, s[16:19], s52 offen offset:1024 sc1
MAV 88,24,148
TR 56,6,59200
MAV 92,28,148
TR 58,6,59712
TR 60,6,59232
MAV 76,28,144
TR 62,6,59744
v_add_u32 v7, s57, v7
v_add_u32 v6, s57, v6
s_sub_u32 s57, 0, s57
s_waitcnt vmcnt(20) lgkmcnt(8)
MAV 32,32,152
ds_read_b64_tr_b16 a[0:1], v7
s_add_u32 m0, s55, 42240
MAV 48,32,156
buffer_load_dwordx4 v18, s[28:31], s54 offen lds
MAV 52,36,156
TR 2,7,512
TR 4,7,32
MAV 36,36,152
TR 6,7,544
s_add_u32 s52, s78, 770048
MAV 40,40,152
buffer_load_dwordx4 v[136:139], v4, s[16:19], s52 offen sc1
MAV 56,40,156
TR 8,7,64
MAV 60,44,156
TR 10,7,576
TR 12,7,96
MAV 44,44,152
TR 14,7,608
s_waitcnt lgkmcnt(8)
MAV 64,48,152
buffer_load_dwordx4 v19, s[28:31], s54 offen offset:1056 lds
MAV 80,48,156
s_add_u32 s54, s101, 1507328
MAV 84,52,156
ds_read_b64_tr_b16 a[16:17], v6
TR 18,6,512
MAV 68,52,152
TR 20,6,32
TR 22,6,544
MAV 72,56,152
buffer_load_dwordx4 v[140:143], v4, s[16:19], s52 offen offset:1024 sc1
MAV 88,56,156
TR 24,6,64
MAV 92,60,156
TR 26,6,576
TR 28,6,96
MAV 76,60,152
TR 30,6,608
s_waitcnt vmcnt(20) lgkmcnt(8)
s_barrier
MAV 32,0,96
TR 32,7,8448
s_add_u32 m0, s55, 50688
MAV 48,0,100
buffer_load_dwordx4 v18, s[28:31], s54 offen lds
MAV 52,4,100
TR 34,7,8960
TR 36,7,8480
MAV 36,4,96
TR 38,7,8992
s_add_u32 s52, s79, 819200
MAV 40,8,96
buffer_load_dwordx4 v[144:147], v4, s[16:19], s52 offen sc1
MAV 56,8,100
TR 40,7,8512
MAV 60,12,100
TR 42,7,9024
TR 44,7,8544
MAV 44,12,96
TR 46,7,9056
s_waitcnt lgkmcnt(8)
MAV 64,16,96
buffer_load_dwordx4 v19, s[28:31], s54 offen offset:1056 lds
MAV 80,16,100
s_add_u32 s54, s101, 1769472
MAV 84,20,100
TR 48,6,8448
TR 50,6,8960
MAV 68,20,96
TR 52,6,8480
TR 54,6,8992
MAV 72,24,96
buffer_load_dwordx4 v[148:151], v4, s[16:19], s52 offen offset:1024 sc1
MAV 88,24,100
TR 56,6,8512
MAV 92,28,100
TR 58,6,9024
TR 60,6,8544
MAV 76,28,96
TR 62,6,9056
s_waitcnt vmcnt(20) lgkmcnt(8)
MAV 32,32,104
TR 0,7,16896
s_add_u32 m0, s55, 59136
MAV 48,32,108
buffer_load_dwordx4 v18, s[28:31], s54 offen lds
MAV 52,36,108
TR 2,7,17408
TR 4,7,16928
MAV 36,36,104
TR 6,7,17440
s_add_u32 s52, s79, 884736
MAV 40,40,104
buffer_load_dwordx4 v[152:155], v4, s[16:19], s52 offen sc1
MAV 56,40,108
TR 8,7,16960
MAV 60,44,108
TR 10,7,17472
TR 12,7,16992
MAV 44,44,104
TR 14,7,17504
s_waitcnt lgkmcnt(8)
MAV 64,48,104
buffer_load_dwordx4 v19, s[28:31], s54 offen offset:1056 lds
MAV 80,48,108
s_add_u32 s54, s98, 1966080
MAV 84,52,108
TR 16,6,16896
TR 18,6,17408
MAV 68,52,104
TR 20,6,16928
TR 22,6,17440
MAV 72,56,104
buffer_load_dwordx4 v[156:159], v4, s[16:19], s52 offen offset:1024 sc1
MAV 88,56,108
TR 24,6,16960
MAV 92,60,108
TR 26,6,17472
TR 28,6,16992
MAV 76,60,104
TR 30,6,17504
s_waitcnt vmcnt(20) lgkmcnt(8)
s_barrier
MAV 32,0,112
TR 32,7,25344
s_add_u32 m0, s55, 67584
MAV 48,0,116
buffer_load_dwordx4 v18, s[28:31], s54 offen lds
MAV 52,4,116
TR 34,7,25856
TR 36,7,25376
MAV 36,4,112
TR 38,7,25888
s_add_u32 s52, s76, 32768
MAV 40,8,112
buffer_load_dwordx4 v[96:99], v4, s[16:19], s52 offen sc1
MAV 56,8,116
TR 40,7,25408
MAV 60,12,116
TR 42,7,25920
TR 44,7,25440
MAV 44,12,112
TR 46,7,25952
s_waitcnt lgkmcnt(8)
MAV 64,16,112
buffer_load_dwordx4 v19, s[28:31], s54 offen offset:1056 lds
MAV 80,16,116
s_add_u32 s54, s98, 2228224
MAV 84,20,116
TR 48,6,25344
TR 50,6,25856
MAV 68,20,112
TR 52,6,25376
TR 54,6,25888
MAV 72,24,112
buffer_load_dwordx4 v[100:103], v4, s[16:19], s52 offen offset:1024 sc1
MAV 88,24,116
TR 56,6,25408
MAV 92,28,116
TR 58,6,25920
TR 60,6,25440
MAV 76,28,112
TR 62,6,25952
s_waitcnt vmcnt(20) lgkmcnt(8)
MAV 32,32,120
TR 0,7,33792
s_add_u32 m0, s55, 76032
MAV 48,32,124
buffer_load_dwordx4 v18, s[28:31], s54 offen lds
MAV 52,36,124
TR 2,7,34304
TR 4,7,33824
MAV 36,36,120
TR 6,7,34336
s_add_u32 s52, s76, 98304
MAV 40,40,120
buffer_load_dwordx4 v[104:107], v4, s[16:19], s52 offen sc1
MAV 56,40,124
TR 8,7,33856
MAV 60,44,124
TR 10,7,34368
TR 12,7,33888
MAV 44,44,120
TR 14,7,34400
s_waitcnt lgkmcnt(8)
MAV 64,48,120
buffer_load_dwordx4 v19, s[28:31], s54 offen offset:1056 lds
MAV 80,48,124
s_add_u32 s54, s99, 2424832
MAV 84,52,124
TR 16,6,33792
TR 18,6,34304
MAV 68,52,120
TR 20,6,33824
TR 22,6,34336
MAV 72,56,120
buffer_load_dwordx4 v[108:111], v4, s[16:19], s52 offen offset:1024 sc1
MAV 88,56,124
TR 24,6,33856
MAV 92,60,124
TR 26,6,34368
TR 28,6,33888
MAV 76,60,120
TR 30,6,34400
s_waitcnt vmcnt(20) lgkmcnt(8)
s_barrier
MAV 32,0,128
TR 32,7,42240
s_add_u32 m0, s55, 84480
MAV 48,0,132
buffer_load_dwordx4 v18, s[28:31], s54 offen lds
MAV 52,4,132
TR 34,7,42752
TR 36,7,42272
MAV 36,4,128
TR 38,7,42784
s_add_u32 s52, s77, 147456
MAV 40,8,128
buffer_load_dwordx4 v[112:115], v4, s[16:19], s52 offen sc1
MAV 56,8,132
TR 40,7,42304
MAV 60,12,132
TR 42,7,42816
TR 44,7,42336
MAV 44,12,128
TR 46,7,42848
s_waitcnt lgkmcnt(8)
MAV 64,16,128
buffer_load_dwordx4 v19, s[28:31], s54 offen offset:1056 lds
MAV 80,16,132
s_add_u32 s54, s99, 2686976
MAV 84,20,132
TR 48,6,42240
TR 50,6,42752
MAV 68,20,128
TR 52,6,42272
TR 54,6,42784
MAV 72,24,128
buffer_load_dwordx4 v[116:119], v4, s[16:19], s52 offen offset:1024 sc1
MAV 88,24,132
TR 56,6,42304
MAV 92,28,132
TR 58,6,42816
TR 60,6,42336
MAV 76,28,128
TR 62,6,42848
s_waitcnt vmcnt(20) lgkmcnt(8)
MAV 32,32,136
TR 0,7,50688
s_add_u32 m0, s55, 92928
MAV 48,32,140
buffer_load_dwordx4 v18, s[28:31], s54 offen lds
MAV 52,36,140
TR 2,7,51200
TR 4,7,50720
MAV 36,36,136
TR 6,7,51232
s_add_u32 s52, s77, 212992
MAV 40,40,136
buffer_load_dwordx4 v[120:123], v4, s[16:19], s52 offen sc1
MAV 56,40,140
TR 8,7,50752
MAV 60,44,140
TR 10,7,51264
.Lpad29:
s_cbranch_execz .Lnopoll62r
TR 12,7,50784
MAV 44,44,136
TR 14,7,51296
s_waitcnt lgkmcnt(8)
MAV 64,48,136
buffer_load_dwordx4 v19, s[28:31], s54 offen offset:1056 lds
MAV 80,48,140
s_add_u32 s54, s100, 2883584
MAV 84,52,140
TR 16,6,50688
TR 18,6,51200
MAV 68,52,136
TR 20,6,50720
TR 22,6,51232
MAV 72,56,136
buffer_load_dwordx4 v[124:127], v4, s[16:19], s52 offen offset:1024 sc1
MAV 88,56,140
TR 24,6,50752
MAV 92,60,140
TR 26,6,51264
TR 28,6,50784
MAV 76,60,136
TR 30,6,51296
s_waitcnt vmcnt(20) lgkmcnt(8)
s_barrier
MAV 32,0,144
TR 32,7,59136
s_add_u32 m0, s55, 101376
MAV 48,0,148
buffer_load_dwordx4 v18, s[28:31], s54 offen lds
MAV 52,4,148
TR 34,7,59648
TR 36,7,59168
MAV 36,4,144
TR 38,7,59680
s_add_u32 s52, s78, 262144
MAV 40,8,144
buffer_load_dwordx4 v[128:131], v4, s[16:19], s52 offen sc1
MAV 56,8,148
TR 40,7,59200
MAV 60,12,148
TR 42,7,59712
TR 44,7,59232
MAV 44,12,144
TR 46,7,59744
s_waitcnt lgkmcnt(8)
MAV 64,16,144
buffer_load_dwordx4 v19, s[28:31], s54 offen offset:1056 lds
MAV 80,16,148
s_add_u32 s54, s100, 3145728
MAV 84,20,148
TR 48,6,59136
TR 50,6,59648
MAV 68,20,144
TR 52,6,59168
TR 54,6,59680
MAV 72,24,144
buffer_load_dwordx4 v[132:135], v4, s[16:19], s52 offen offset:1024 sc1
MAV 88,24,148
TR 56,6,59200
MAV 92,28,148
TR 58,6,59712
TR 60,6,59232
MAV 76,28,144
TR 62,6,59744
v_add_u32 v7, s57, v7
v_add_u32 v6, s57, v6
s_sub_u32 s57, 0, s57
s_waitcnt vmcnt(20) lgkmcnt(8)
MAV 32,32,152
ds_read_b64_tr_b16 a[0:1], v7
s_add_u32 m0, s55, 109824
MAV 48,32,156
buffer_load_dwordx4 v18, s[28:31], s54 offen lds
MAV 52,36,156
TR 2,7,512
TR 4,7,32
MAV 36,36,152
TR 6,7,544
s_add_u32 s52, s78, 327680
MAV 40,40,152
buffer_load_dwordx4 v[136:139], v4, s[16:19], s52 offen sc1
MAV 56,40,156
TR 8,7,64
MAV 60,44,156
TR 10,7,576
TR 12,7,96
MAV 44,44,152
TR 14,7,608
s_waitcnt lgkmcnt(8)
MAV 64,48,152
buffer_load_dwordx4 v19, s[28:31], s54 offen offset:1056 lds
MAV 80,48,156
s_add_u32 s54, s101, 3342336
MAV 84,52,156
ds_read_b64_tr_b16 a[16:17], v6
TR 18,6,512
MAV 68,52,152
TR 20,6,32
TR 22,6,544
MAV 72,56,152
buffer_load_dwordx4 v[140:143], v4, s[16:19], s52 offen offset:1024 sc1
MAV 88,56,156
TR 24,6,64
MAV 92,60,156
TR 26,6,576
TR 28,6,96
MAV 76,60,152
TR 30,6,608
s_waitcnt vmcnt(20) lgkmcnt(8)
s_barrier
MAV 32,0,96
TR 32,7,8448
s_add_u32 m0, s55, 118272
MAV 48,0,100
buffer_load_dwordx4 v18, s[28:31], s54 offen lds
MAV 52,4,100
TR 34,7,8960
TR 36,7,8480
MAV 36,4,96
TR 38,7,8992
s_add_u32 s52, s79, 376832
MAV 40,8,96
buffer_load_dwordx4 v[144:147], v4, s[16:19], s52 offen sc1
MAV 56,8,100
TR 40,7,8512
MAV 60,12,100
TR 42,7,9024
TR 44,7,8544
MAV 44,12,96
TR 46,7,9056
s_waitcnt lgkmcnt(8)
MAV 64,16,96
buffer_load_dwordx4 v19, s[28:31], s54 offen offset:1056 lds
MAV 80,16,100
s_add_u32 s54, s101, 3604480
MAV 84,20,100
TR 48,6,8448
TR 50,6,8960
MAV 68,20,96
TR 52,6,8480
TR 54,6,8992
MAV 72,24,96
buffer_load_dwordx4 v[148:151], v4, s[16:19], s52 offen offset:1024 sc1
MAV 88,24,100
TR 56,6,8512
MAV 92,28,100
TR 58,6,9024
TR 60,6,8544
MAV 76,28,96
TR 62,6,9056
s_waitcnt vmcnt(20) lgkmcnt(8)
MAV 32,32,104
TR 0,7,16896
s_add_u32 m0, s55, 126720
MAV 48,32,108
buffer_load_dwordx4 v18, s[28:31], s54 offen lds
MAV 52,36,108
TR 2,7,17408
TR 4,7,16928
MAV 36,36,104
TR 6,7,17440
s_add_u32 s52, s79, 442368
MAV 40,40,104
buffer_load_dwordx4 v[152:155], v4, s[16:19], s52 offen sc1
MAV 56,40,108
TR 8,7,16960
MAV 60,44,108
TR 10,7,17472
TR 12,7,16992
MAV 44,44,104
TR 14,7,17504
s_waitcnt lgkmcnt(8)
MAV 64,48,104
buffer_load_dwordx4 v19, s[28:31], s54 offen offset:1056 lds
MAV 80,48,108
s_add_u32 s54, s98, 196608
MAV 84,52,108
TR 16,6,16896
TR 18,6,17408
MAV 68,52,104
TR 20,6,16928
TR 22,6,17440
MAV 72,56,104
buffer_load_dwordx4 v[156:159], v4, s[16:19], s52 offen offset:1024 sc1
MAV 88,56,108
TR 24,6,16960
MAV 92,60,108
TR 26,6,17472
TR 28,6,16992
MAV 76,60,104
TR 30,6,17504
s_waitcnt vmcnt(20) lgkmcnt(8)
s_barrier
MAV 32,0,112
TR 32,7,25344
s_add_u32 m0, s55, 0
MAV 48,0,116
buffer_load_dwordx4 v18, s[28:31], s54 offen lds
MAV 52,4,116
TR 34,7,25856
TR 36,7,25376
MAV 36,4,112
TR 38,7,25888
s_add_u32 s52, s76, 491520
MAV 40,8,112
buffer_load_dwordx4 v[96:99], v4, s[16:19], s52 offen sc1
MAV 56,8,116
TR 40,7,25408
MAV 60,12,116
TR 42,7,25920
TR 44,7,25440
MAV 44,12,112
TR 46,7,25952
s_waitcnt lgkmcnt(8)
MAV 64,16,112
buffer_load_dwordx4 v19, s[28:31], s54 offen offset:1056 lds
MAV 80,16,116
s_add_u32 s54, s99, 655360
MAV 84,20,116
TR 48,6,25344
TR 50,6,25856
MAV 68,20,112
TR 52,6,25376
TR 54,6,25888
MAV 72,24,112
buffer_load_dwordx4 v[100:103], v4, s[16:19], s52 offen offset:1024 sc1
MAV 88,24,116
TR 56,6,25408
MAV 92,28,116
TR 58,6,25920
TR 60,6,25440
MAV 76,28,112
TR 62,6,25952
s_waitcnt vmcnt(20) lgkmcnt(8)
MAV 32,32,120
TR 0,7,33792
s_add_u32 m0, s55, 8448
MAV 48,32,124
buffer_load_dwordx4 v18, s[28:31], s54 offen lds
MAV 52,36,124
TR 2,7,34304
TR 4,7,33824
MAV 36,36,120
TR 6,7,34336
s_add_u32 s52, s76, 557056
MAV 40,40,120
buffer_load_dwordx4 v[104:107], v4, s[16:19], s52 offen sc1
MAV 56,40,124
TR 8,7,33856
MAV 60,44,124
TR 10,7,34368
TR 12,7,33888
MAV 44,44,120
TR 14,7,34400
s_waitcnt lgkmcnt(8)
MAV 64,48,120
buffer_load_dwordx4 v19, s[28:31], s54 offen offset:1056 lds
MAV 80,48,124
s_add_u32 s54, s100, 1114112
MAV 84,52,124
TR 16,6,33792
TR 18,6,34304
MAV 68,52,120
TR 20,6,33824
TR 22,6,34336
MAV 72,56,120
buffer_load_dwordx4 v[108:111], v4, s[16:19], s52 offen offset:1024 sc1
MAV 88,56,124
TR 24,6,33856
MAV 92,60,124
TR 26,6,34368
TR 28,6,33888
MAV 76,60,120
TR 30,6,34400
s_waitcnt vmcnt(20) lgkmcnt(8)
s_barrier
MAV 32,0,128
TR 32,7,42240
s_add_u32 m0, s55, 16896
MAV 48,0,132
buffer_load_dwordx4 v18, s[28:31], s54 offen lds
MAV 52,4,132
TR 34,7,42752
TR 36,7,42272
MAV 36,4,128
TR 38,7,42784
s_add_u32 s52, s77, 606208
MAV 40,8,128
buffer_load_dwordx4 v[112:115], v4, s[16:19], s52 offen sc1
MAV 56,8,132
TR 40,7,42304
MAV 60,12,132
TR 42,7,42816
TR 44,7,42336
MAV 44,12,128
TR 46,7,42848
s_waitcnt lgkmcnt(8)
MAV 64,16,128
buffer_load_dwordx4 v19, s[28:31], s54 offen offset:1056 lds
MAV 80,16,132
s_add_u32 s54, s101, 1572864
MAV 84,20,132
TR 48,6,42240
TR 50,6,42752
MAV 68,20,128
TR 52,6,42272
TR 54,6,42784
MAV 72,24,128
buffer_load_dwordx4 v[116:119], v4, s[16:19], s52 offen offset:1024 sc1
MAV 88,24,132
TR 56,6,42304
MAV 92,28,132
TR 58,6,42816
TR 60,6,42336
MAV 76,28,128
TR 62,6,42848
s_waitcnt vmcnt(20) lgkmcnt(8)
MAV 32,32,136
TR 0,7,50688
s_add_u32 m0, s55, 25344
MAV 48,32,140
buffer_load_dwordx4 v18, s[28:31], s54 offen lds
MAV 52,36,140
TR 2,7,51200
TR 4,7,50720
MAV 36,36,136
TR 6,7,51232
s_add_u32 s52, s77, 671744
MAV 40,40,136
buffer_load_dwordx4 v[120:123], v4, s[16:19], s52 offen sc1
MAV 56,40,140
TR 8,7,50752
MAV 60,44,140
TR 10,7,51264
TR 12,7,50784
MAV 44,44,136
TR 14,7,51296
s_waitcnt lgkmcnt(8)
MAV 64,48,136
buffer_load_dwordx4 v19, s[28:31], s54 offen offset:1056 lds
MAV 80,48,140
s_add_u32 s54, s98, 2031616
MAV 84,52,140
TR 16,6,50688
TR 18,6,51200
MAV 68,52,136
TR 20,6,50720
TR 22,6,51232
MAV 72,56,136
buffer_load_dwordx4 v[124:127], v4, s[16:19], s52 offen offset:1024 sc1
MAV 88,56,140
TR 24,6,50752
MAV 92,60,140
TR 26,6,51264
TR 28,6,50784
MAV 76,60,136
TR 30,6,51296
s_waitcnt vmcnt(20) lgkmcnt(8)
s_barrier
MAV 32,0,144
TR 32,7,59136
s_add_u32 m0, s55, 33792
MAV 48,0,148
buffer_load_dwordx4 v18, s[28:31], s54 offen lds
MAV 52,4,148
TR 34,7,59648
TR 36,7,59168
MAV 36,4,144
TR 38,7,59680
s_add_u32 s52, s78, 720896
MAV 40,8,144
buffer_load_dwordx4 v[128:131], v4, s[16:19], s52 offen sc1
MAV 56,8,148
TR 40,7,59200
MAV 60,12,148
TR 42,7,59712
TR 44,7,59232
MAV 44,12,144
TR 46,7,59744
s_waitcnt lgkmcnt(8)
MAV 64,16,144
buffer_load_dwordx4 v19, s[28:31], s54 offen offset:1056 lds
MAV 80,16,148
s_add_u32 s54, s99, 2490368
MAV 84,20,148
TR 48,6,59136
TR 50,6,59648
MAV 68,20,144
TR 52,6,59168
TR 54,6,59680
MAV 72,24,144
buffer_load_dwordx4 v[132:135], v4, s[16:19], s52 offen offset:1024 sc1
MAV 88,24,148
TR 56,6,59200
MAV 92,28,148
TR 58,6,59712
TR 60,6,59232
MAV 76,28,144
TR 62,6,59744
v_add_u32 v7, s57, v7
v_add_u32 v6, s57, v6
s_sub_u32 s57, 0, s57
s_waitcnt vmcnt(20) lgkmcnt(8)
MAV 32,32,152
ds_read_b64_tr_b16 a[0:1], v6
s_add_u32 m0, s55, 42240
MAV 48,32,156
buffer_load_dwordx4 v18, s[28:31], s54 offen lds
MAV 52,36,156
TR 2,6,512
TR 4,6,32
MAV 36,36,152
TR 6,6,544
s_add_u32 s52, s78, 786432
MAV 40,40,152
buffer_load_dwordx4 v[136:139], v4, s[16:19], s52 offen sc1
MAV 56,40,156
TR 8,6,64
MAV 60,44,156
TR 10,6,576
TR 12,6,96
MAV 44,44,152
TR 14,6,608
s_waitcnt lgkmcnt(8)
MAV 64,48,152
buffer_load_dwordx4 v19, s[28:31], s54 offen offset:1056 lds
MAV 80,48,156
s_add_u32 s54, s100, 2949120
MAV 84,52,156
TR 16,6,8448
TR 18,6,8960
MAV 68,52,152
TR 20,6,8480
TR 22,6,8992
MAV 72,56,152
buffer_load_dwordx4 v[140:143], v4, s[16:19], s52 offen offset:1024 sc1
MAV 88,56,156
TR 24,6,8512
MAV 92,60,156
TR 26,6,9024
TR 28,6,8544
MAV 76,60,152
TR 30,6,9056
s_waitcnt vmcnt(20) lgkmcnt(8)
s_barrier
MAV 64,0,96
TR 32,6,16896
TR 34,6,17408
s_add_u32 m0, s55, 50688
MAV 80,0,100
TR 36,6,16928
buffer_load_dwordx4 v18, s[28:31], s54 offen lds
MAV 84,4,100
buffer_load_dwordx4 v19, s[28:31], s54 offen offset:1056 lds
MAV 68,4,96
TR 38,6,17440
s_add_u32 s54, s101, 3407872
s_add_u32 s52, s79, 835584
MAV 72,8,96
TR 40,6,16960
buffer_load_dwordx4 v[144:147], v4, s[16:19], s52 offen sc1
MAV 88,8,100
TR 42,6,17472
MAV 92,12,100
TR 44,6,16992
buffer_load_dwordx4 v[148:151], v4, s[16:19], s52 offen offset:1024 sc1
MAV 76,12,96
TR 46,6,17504
s_add_u32 m0, s55, 59136
s_waitcnt vmcnt(20) lgkmcnt(8)
MAV 64,16,104
buffer_load_dwordx4 v18, s[28:31], s54 offen lds
MAV 80,16,108
TR 48,6,25344
TR 50,6,25856
MAV 84,20,108
TR 52,6,25376
buffer_load_dwordx4 v19, s[28:31], s54 offen offset:1056 lds
MAV 68,20,104
TR 54,6,25888
s_add_u32 s52, s79, 901120
MAV 72,24,104
TR 56,6,25408
buffer_load_dwordx4 v[152:155], v4, s[16:19], s52 offen sc1
MAV 88,24,108
TR 58,6,25920
MAV 92,28,108
TR 60,6,25440
buffer_load_dwordx4 v[156:159], v4, s[16:19], s52 offen offset:1024 sc1
MAV 76,28,104
TR 62,6,25952
s_waitcnt vmcnt(20) lgkmcnt(8)
MAV 64,32,112
TR 0,6,33792
s_add_u32 s52, s76, 49152
s_lshl_b32 s70, s2, 10
MAV 80,32,116
buffer_load_dwordx4 v[160:163], v4, s[16:19], s52 offen sc1
s_lshl_b32 s62, s3, 7
MAV 84,36,116
TR 2,6,34304
TR 4,6,33824
MAV 68,36,112
TR 6,6,34336
s_add_u32 s70, s70, s62
s_add_u32 s70, s70, 31457792
MAV 72,40,112
buffer_load_dwordx4 v[164:167], v4, s[16:19], s52 offen offset:1024 sc1
s_xor_b32 s71, s70, 1024
MAV 88,40,116
TR 8,6,33856
TR 10,6,34368
MAV 92,44,116
TR 12,6,33888
v_min_u32 v12, 1, v1
v_lshlrev_b32 v12, 28, v12
MAV 76,44,112
TR 14,6,34400
s_add_u32 s52, s77, 163840
s_waitcnt vmcnt(18) lgkmcnt(8)
MAV 64,48,120
buffer_load_dwordx4 v[168:171], v4, s[16:19], s52 offen sc1
v_mov_b32 v13, 1
MAV 80,48,124
TR 16,6,42240
v_mov_b32 v15, 0
s_lshl_b32 s68, s7, 15
MAV 84,52,124
TR 18,6,42752
TR 20,6,42272
MAV 68,52,120
TR 22,6,42784
s_add_u32 s68, s68, 146800640
.Lpad30:
s_cbranch_execz .Lnopoll62r
s_xor_b32 s69, s68, 32768
MAV 72,56,120
buffer_load_dwordx4 v[172:175], v4, s[16:19], s52 offen offset:1024 sc1
v_mov_b32 v11, v4
MAV 88,56,124
TR 24,6,42304
TR 26,6,42816
MAV 92,60,124
TR 28,6,42336
v_and_b32 v2, 1, v1
v_lshlrev_b32 v2, 4, v2
MAV 76,60,120
TR 30,6,42848
v_mov_b32 v224, 0x3f80
s_waitcnt vmcnt(16) lgkmcnt(8)
MAV 64,0,128
TR 32,6,50688
s_add_u32 s52, s78, 278528
v_lshlrev_b32 v2, v2, v224
MAV 80,0,132
buffer_load_dwordx4 v[176:179], v4, s[16:19], s52 offen sc1
v_bfe_u32 v224, v1, 2, 2
MAV 84,4,132
TR 34,6,51200
TR 36,6,50720
MAV 68,4,128
TR 38,6,51232
v_lshrrev_b32 v225, 4, v1
v_cmp_eq_u32 vcc, v224, v225
MAV 72,8,128
buffer_load_dwordx4 v[180:183], v4, s[16:19], s52 offen offset:1024 sc1
v_cndmask_b32 v2, 0, v2, vcc
MAV 88,8,132
TR 40,6,50752
TR 42,6,51264
MAV 92,12,132
TR 44,6,50784
v_and_b32 v224, 2, v1
v_cmp_eq_u32 vcc, 0, v224
MAV 76,12,128
TR 46,6,51296
s_add_u32 s52, s79, 393216
s_waitcnt vmcnt(14) lgkmcnt(8)
MAV 64,16,136
buffer_load_dwordx4 v[184:187], v4, s[16:19], s52 offen sc1
v_cndmask_b32 v226, 0, v2, vcc
MAV 80,16,140
TR 48,6,59136
v_cndmask_b32 v227, v2, 0, vcc
v_mov_b32 v224, 0
MAV 84,20,140
TR 50,6,59648
TR 52,6,59168
MAV 68,20,136
TR 54,6,59680
v_mov_b32 v225, 0
v_mov_b32 v228, 0
MAV 72,24,136
buffer_load_dwordx4 v[188:191], v4, s[16:19], s52 offen offset:1024 sc1
v_mov_b32 v229, 0
MAV 88,24,140
TR 56,6,59200
TR 58,6,59712
MAV 92,28,140
TR 60,6,59232
s_lshr_b32 s62, s6, 1
s_lshl_b32 s62, s62, 8
MAV 76,28,136
TR 62,6,59744
s_and_b32 s63, s6, 1
s_waitcnt vmcnt(10) lgkmcnt(8)
s_barrier
v_add_u32 v6, s57, v6
MAV 64,32,144
ds_read_b64_tr_b16 a[0:1], v6
s_add_u32 s52, s76, 507904
s_add_u32 s62, s62, s63
MAV 80,32,148
buffer_load_dwordx4 v[192:195], v4, s[16:19], s52 offen sc1
s_lshl_b32 s63, s3, 6
MAV 84,36,148
TR 2,6,512
TR 4,6,32
MAV 68,36,144
TR 6,6,544
s_add_u32 s62, s62, s63
s_lshl_b32 s62, s62, 11
MAV 72,40,144
buffer_load_dwordx4 v[196:199], v4, s[16:19], s52 offen offset:1024 sc1
s_lshl_b32 s63, s7, 7
MAV 88,40,148
TR 8,6,64
TR 10,6,576
MAV 92,44,148
TR 12,6,96
s_add_u32 s62, s62, s63
v_and_b32 v16, 15, v1
MAV 76,44,144
TR 14,6,608
s_add_u32 s52, s77, 622592
s_waitcnt vmcnt(10) lgkmcnt(8)
MAV 64,48,152
buffer_load_dwordx4 v[200:203], v4, s[16:19], s52 offen sc1
v_lshlrev_b32 v16, 12, v16
MAV 80,48,156
TR 16,6,8448
v_bfe_u32 v2, v1, 4, 1
v_lshl_add_u32 v16, v2, 5, v16
MAV 84,52,156
TR 18,6,8960
TR 20,6,8480
MAV 68,52,152
TR 22,6,8992
v_bfe_u32 v2, v1, 5, 1
v_lshl_add_u32 v16, v2, 4, v16
MAV 72,56,152
buffer_load_dwordx4 v[204:207], v4, s[16:19], s52 offen offset:1024 sc1
v_add_u32 v16, s62, v16
MAV 88,56,156
TR 24,6,8512
TR 26,6,9024
MAV 92,60,156
TR 28,6,8544
v_add_u32 v17, 0x10000, v16
v_accvgpr_read_b32 v28, a224
MAV 76,60,152
TR 30,6,9056
v_add_f32 v32, v32, v28
s_waitcnt vmcnt(10) lgkmcnt(8)
MAV 64,0,160
TR 32,6,16896
s_add_u32 s52, s78, 737280
v_accvgpr_read_b32 v29, a225
MAV 80,0,164
buffer_load_dwordx4 v[208:211], v4, s[16:19], s52 offen sc1
v_add_f32 v33, v33, v29
MAV 84,4,164
TR 34,6,17408
TR 36,6,16928
MAV 68,4,160
TR 38,6,17440
v_accvgpr_read_b32 v28, a226
v_add_f32 v34, v34, v28
MAV 72,8,160
buffer_load_dwordx4 v[212:215], v4, s[16:19], s52 offen offset:1024 sc1
v_accvgpr_read_b32 v29, a227
MAV 88,8,164
TR 40,6,16960
TR 42,6,17472
MAV 92,12,164
TR 44,6,16992
v_add_f32 v35, v35, v29
v_accvgpr_read_b32 v28, a228
MAV 76,12,160
TR 46,6,17504
s_add_u32 s52, s79, 851968
s_waitcnt vmcnt(10) lgkmcnt(8)
MAV 64,16,168
buffer_load_dwordx4 v[216:219], v4, s[16:19], s52 offen sc1
v_add_f32 v36, v36, v28
MAV 80,16,172
TR 48,6,25344
v_accvgpr_read_b32 v29, a229
v_add_f32 v37, v37, v29
MAV 84,20,172
TR 50,6,25856
TR 52,6,25376
MAV 68,20,168
TR 54,6,25888
v_accvgpr_read_b32 v28, a230
v_add_f32 v38, v38, v28
MAV 72,24,168
buffer_load_dwordx4 v[220:223], v4, s[16:19], s52 offen offset:1024 sc1
v_accvgpr_read_b32 v29, a231
MAV 88,24,172
TR 56,6,25408
TR 58,6,25920
MAV 92,28,172
TR 60,6,25440
v_add_f32 v39, v39, v29
v_accvgpr_read_b32 v28, a232
MAV 76,28,168
TR 62,6,25952
v_add_f32 v40, v40, v28
s_waitcnt vmcnt(10) lgkmcnt(8)
MAV 64,32,176
TR 0,6,33792
v_accvgpr_read_b32 v29, a233
v_add_f32 v41, v41, v29
MAV 80,32,180
TR 2,6,34304
v_accvgpr_read_b32 v28, a234
MAV 84,36,180
TR 4,6,33824
v_add_f32 v42, v42, v28
MAV 68,36,176
TR 6,6,34336
v_accvgpr_read_b32 v29, a235
MAV 72,40,176
TR 8,6,33856
v_add_f32 v43, v43, v29
MAV 88,40,180
TR 10,6,34368
v_accvgpr_read_b32 v28, a236
MAV 92,44,180
TR 12,6,33888
v_add_f32 v44, v44, v28
MAV 76,44,176
TR 14,6,34400
s_waitcnt vmcnt(8) lgkmcnt(8)
MAV 64,48,184
TR 16,6,42240
v_accvgpr_read_b32 v29, a237
MAV 80,48,188
TR 18,6,42752
v_add_f32 v45, v45, v29
MAV 84,52,188
TR 20,6,42272
v_accvgpr_read_b32 v28, a238
MAV 68,52,184
TR 22,6,42784
v_add_f32 v46, v46, v28
MAV 72,56,184
TR 24,6,42304
v_accvgpr_read_b32 v29, a239
MAV 88,56,188
TR 26,6,42816
v_add_f32 v47, v47, v29
MAV 92,60,188
TR 28,6,42336
v_accvgpr_read_b32 v28, a240
MAV 76,60,184
TR 30,6,42848
v_add_f32 v48, v48, v28
s_waitcnt vmcnt(6) lgkmcnt(8)
MAV 64,0,192
TR 32,6,50688
v_accvgpr_read_b32 v29, a241
v_add_f32 v49, v49, v29
MAV 80,0,196
TR 34,6,51200
v_accvgpr_read_b32 v28, a242
MAV 84,4,196
TR 36,6,50720
v_add_f32 v50, v50, v28
MAV 68,4,192
TR 38,6,51232
v_accvgpr_read_b32 v29, a243
MAV 72,8,192
TR 40,6,50752
v_add_f32 v51, v51, v29
MAV 88,8,196
TR 42,6,51264
v_accvgpr_read_b32 v28, a244
MAV 92,12,196
TR 44,6,50784
v_add_f32 v52, v52, v28
MAV 76,12,192
TR 46,6,51296
s_waitcnt vmcnt(4) lgkmcnt(8)
MAV 64,16,200
TR 48,6,59136
v_accvgpr_read_b32 v29, a245
MAV 80,16,204
TR 50,6,59648
v_add_f32 v53, v53, v29
MAV 84,20,204
TR 52,6,59168
v_accvgpr_read_b32 v28, a246
MAV 68,20,200
TR 54,6,59680
v_add_f32 v54, v54, v28
MAV 72,24,200
TR 56,6,59200
v_accvgpr_read_b32 v29, a247
MAV 88,24,204
TR 58,6,59712
v_add_f32 v55, v55, v29
MAV 92,28,204
TR 60,6,59232
v_accvgpr_read_b32 v28, a248
MAV 76,28,200
TR 62,6,59744
v_add_f32 v56, v56, v28
s_waitcnt vmcnt(2) lgkmcnt(8)
MAV 64,32,208
ds_read_b64_tr_b16 a[0:1], v7
v_accvgpr_read_b32 v29, a249
MAV 80,32,212
TR 2,7,512
v_add_f32 v57, v57, v29
MAV 84,36,212
TR 4,7,32
v_accvgpr_read_b32 v28, a250
MAV 68,36,208
TR 6,7,544
v_add_f32 v58, v58, v28
MAV 72,40,208
TR 8,7,64
v_accvgpr_read_b32 v29, a251
MAV 88,40,212
TR 10,7,576
v_add_f32 v59, v59, v29
MAV 92,44,212
TR 12,7,96
v_accvgpr_read_b32 v28, a252
MAV 76,44,208
TR 14,7,608
s_waitcnt vmcnt(0) lgkmcnt(8)
MAV 64,48,216
TR 16,7,8448
v_add_f32 v60, v60, v28
MAV 80,48,220
TR 18,7,8960
v_accvgpr_read_b32 v29, a253
MAV 84,52,220
TR 20,7,8480
v_add_f32 v61, v61, v29
MAV 68,52,216
TR 22,7,8992
v_accvgpr_read_b32 v28, a254
MAV 72,56,216
TR 24,7,8512
v_add_f32 v62, v62, v28
MAV 88,56,220
TR 26,7,9024
v_accvgpr_read_b32 v29, a255
MAV 92,60,220
TR 28,7,8544
v_add_f32 v63, v63, v29
MAV 76,60,216
TR 30,7,9056
s_waitcnt lgkmcnt(8)
MAV 32,0,96
TR 32,7,16896
v_cvt_pk_bf16_f32 v232, v64, v65
v_cvt_pk_bf16_f32 v233, v66, v67
MAV 48,0,100
TR 34,7,17408
v_cvt_pk_bf16_f32 v234, v68, v69
MAV 52,4,100
TR 36,7,16928
v_cvt_pk_bf16_f32 v235, v70, v71
buffer_store_dwordx4 v[232:235], v11, s[16:19], s69 offen sc1
MAV 36,4,96
TR 38,7,17440
s_add_u32 s69, s69, 16384
MAV 40,8,96
TR 40,7,16960
v_cvt_pk_bf16_f32 v236, v72, v73
v_cvt_pk_bf16_f32 v237, v74, v75
MAV 56,8,100
TR 42,7,17472
v_cvt_pk_bf16_f32 v238, v76, v77
MAV 60,12,100
TR 44,7,16992
v_cvt_pk_bf16_f32 v239, v78, v79
buffer_store_dwordx4 v[236:239], v11, s[16:19], s69 offen sc1
MAV 44,12,96
TR 46,7,17504
s_add_u32 s69, s69, -15360
s_waitcnt lgkmcnt(8)
MAV 32,16,104
TR 48,7,25344
v_cvt_pk_bf16_f32 v240, v80, v81
MAV 48,16,108
TR 50,7,25856
v_cvt_pk_bf16_f32 v241, v82, v83
v_cvt_pk_bf16_f32 v242, v84, v85
MAV 52,20,108
TR 52,7,25376
v_cvt_pk_bf16_f32 v243, v86, v87
MAV 36,20,104
TR 54,7,25888
buffer_store_dwordx4 v[240:243], v11, s[16:19], s69 offen sc1
s_add_u32 s69, s69, 16384
MAV 40,24,104
TR 56,7,25408
v_cvt_pk_bf16_f32 v244, v88, v89
MAV 56,24,108
TR 58,7,25920
v_cvt_pk_bf16_f32 v245, v90, v91
v_cvt_pk_bf16_f32 v246, v92, v93
MAV 60,28,108
TR 60,7,25440
v_cvt_pk_bf16_f32 v247, v94, v95
MAV 44,28,104
TR 62,7,25952
buffer_store_dwordx4 v[244:247], v11, s[16:19], s69 offen sc1
s_waitcnt lgkmcnt(8)
MAV 32,32,112
TR 0,7,33792
MAV 48,32,116
TR 2,7,34304
MAV 52,36,116
TR 4,7,33824
MAV 36,36,112
TR 6,7,34336
MAV 40,40,112
TR 8,7,33856
MAV 56,40,116
TR 10,7,34368
MAV 60,44,116
TR 12,7,33888
MAV 44,44,112
TR 14,7,34400
s_waitcnt lgkmcnt(8)
MAV 32,48,120
TR 16,7,42240
MAV 48,48,124
TR 18,7,42752
MAV 52,52,124
TR 20,7,42272
MAV 36,52,120
TR 22,7,42784
MAV 40,56,120
TR 24,7,42304
MAV 56,56,124
TR 26,7,42816
MAV 60,60,124
TR 28,7,42336
MAV 44,60,120
TR 30,7,42848
s_waitcnt lgkmcnt(8)
MAV 32,0,128
TR 32,7,50688
MAV 48,0,132
TR 34,7,51200
MAV 52,4,132
TR 36,7,50720
MAV 36,4,128
TR 38,7,51232
MAV 40,8,128
TR 40,7,50752
MAV 56,8,132
TR 42,7,51264
MAV 60,12,132
TR 44,7,50784
MAV 44,12,128
TR 46,7,51296
s_waitcnt lgkmcnt(8)
MAV 32,16,136
TR 48,7,59136
MAV 48,16,140
TR 50,7,59648
MAV 52,20,140
TR 52,7,59168
MAV 36,20,136
TR 54,7,59680
MAV 40,24,136
TR 56,7,59200
MAV 56,24,140
TR 58,7,59712
MAV 60,28,140
TR 60,7,59232
MAV 44,28,136
TR 62,7,59744
v_add_u32 v7, s57, v7
s_waitcnt lgkmcnt(8)
MAV 32,32,144
ds_read_b64_tr_b16 a[0:1], v7
TR 2,7,512
MAV 48,32,148
s_waitcnt vmcnt(0)
buffer_atomic_add v13, v12, s[16:19], s71 offen
MAV 52,36,148
TR 4,7,32
MAV 36,36,144
TR 6,7,544
MAV 40,40,144
TR 8,7,64
MAV 56,40,148
TR 10,7,576
MAV 60,44,148
TR 12,7,96
MAV 44,44,144
TR 14,7,608
s_waitcnt lgkmcnt(8)
MAV 32,48,152
TR 16,7,8448
MAV 48,48,156
TR 18,7,8960
MAV 52,52,156
TR 20,7,8480
MAV 36,52,152
TR 22,7,8992
MAV 40,56,152
TR 24,7,8512
MAV 56,56,156
TR 26,7,9024
MAV 60,60,156
TR 28,7,8544
MAV 44,60,152
TR 30,7,9056
s_waitcnt lgkmcnt(8)
MAV 32,0,160
TR 32,7,16896
TR 34,7,17408
MAV 48,0,164
buffer_atomic_add v15, v12, s[16:19], s70 offen sc0
MAV 52,4,164
TR 36,7,16928
MAV 36,4,160
TR 38,7,17440
MAV 40,8,160
TR 40,7,16960
MAV 56,8,164
TR 42,7,17472
MAV 60,12,164
TR 44,7,16992
MAV 44,12,160
TR 46,7,17504
s_waitcnt lgkmcnt(8)
MAV 32,16,168
TR 48,7,25344
MAV 48,16,172
TR 50,7,25856
MAV 52,20,172
TR 52,7,25376
MAV 36,20,168
TR 54,7,25888
MAV 40,24,168
TR 56,7,25408
MAV 56,24,172
TR 58,7,25920
MAV 60,28,172
TR 60,7,25440
MAV 44,28,168
TR 62,7,25952
s_waitcnt lgkmcnt(8)
MAV 32,32,176
TR 0,7,33792
MAV 48,32,180
TR 2,7,34304
MAV 52,36,180
TR 4,7,33824
MAV 36,36,176
TR 6,7,34336
MAV 40,40,176
TR 8,7,33856
MAV 56,40,180
TR 10,7,34368
MAV 60,44,180
TR 12,7,33888
MAV 44,44,176
TR 14,7,34400
s_waitcnt lgkmcnt(8)
MAV 32,48,184
TR 16,7,42240
MAV 48,48,188
TR 18,7,42752
MAV 52,52,188
TR 20,7,42272
MAV 36,52,184
TR 22,7,42784
.Lpad31:
s_cbranch_execz .Lnopoll62r
MAV 40,56,184
TR 24,7,42304
MAV 56,56,188
TR 26,7,42816
MAV 60,60,188
TR 28,7,42336
MAV 44,60,184
TR 30,7,42848
s_waitcnt vmcnt(0)
v_cmp_ne_u32 vcc, 0, v15
s_nop 0
s_cbranch_vccz .Lxs67
.Lxs67b:
s_waitcnt lgkmcnt(8)
MAV 32,0,192
TR 32,7,50688
TR 34,7,51200
MAV 48,0,196
buffer_load_dwordx4 v[232:235], v11, s[16:19], s68 offen sc1
MAV 52,4,196
TR 36,7,50720
s_add_u32 s68, s68, 16384
MAV 36,4,192
TR 38,7,51232
MAV 40,8,192
buffer_load_dwordx4 v[236:239], v11, s[16:19], s68 offen sc1
MAV 56,8,196
TR 40,7,50752
s_add_u32 s68, s68, -15360
MAV 60,12,196
TR 42,7,51264
TR 44,7,50784
MAV 44,12,192
TR 46,7,51296
s_waitcnt lgkmcnt(8)
MAV 32,16,200
buffer_load_dwordx4 v[240:243], v11, s[16:19], s68 offen sc1
MAV 48,16,204
s_add_u32 s68, s68, 16384
MAV 52,20,204
TR 48,7,59136
TR 50,7,59648
MAV 36,20,200
TR 52,7,59168
TR 54,7,59680
MAV 40,24,200
buffer_load_dwordx4 v[244:247], v11, s[16:19], s68 offen sc1
MAV 56,24,204
TR 56,7,59200
MAV 60,28,204
TR 58,7,59712
TR 60,7,59232
MAV 44,28,200
TR 62,7,59744
s_waitcnt lgkmcnt(8)
MAV 32,32,208
MAV 48,32,212
MAV 52,36,212
MAV 36,36,208
MAV 40,40,208
MAV 56,40,212
MAV 60,44,212
MAV 44,44,208
s_waitcnt lgkmcnt(0)
MAV 32,48,216
MAV 48,48,220
MAV 52,52,220
MAV 36,52,216
MAV 40,56,216
MAV 56,56,220
MAV 60,60,220
MAV 44,60,216
s_waitcnt vmcnt(3)
v_mfma_f32_16x16x32_bf16 v[32:35], v[226:229], v[232:235], v[32:35]
v_mfma_f32_16x16x32_bf16 v[36:39], v[224:227], v[232:235], v[36:39]
s_waitcnt vmcnt(2)
v_mfma_f32_16x16x32_bf16 v[40:43], v[226:229], v[236:239], v[40:43]
s_nop 4
v_cvt_pk_bf16_f32 v128, v32, v33
v_cvt_pk_bf16_f32 v129, v34, v35
v_mfma_f32_16x16x32_bf16 v[44:47], v[224:227], v[236:239], v[44:47]
v_cvt_pk_bf16_f32 v130, v36, v37
v_cvt_pk_bf16_f32 v131, v38, v39
s_waitcnt vmcnt(1)
v_mfma_f32_16x16x32_bf16 v[48:51], v[226:229], v[240:243], v[48:51]
v_permlane16_swap_b32 v128, v130
v_mfma_f32_16x16x32_bf16 v[52:55], v[224:227], v[240:243], v[52:55]
v_permlane16_swap_b32 v129, v131
s_waitcnt vmcnt(0)
v_mfma_f32_16x16x32_bf16 v[56:59], v[226:229], v[244:247], v[56:59]
buffer_store_dwordx4 v[128:131], v16, s[36:39], 0 offen sc1
v_mfma_f32_16x16x32_bf16 v[60:63], v[224:227], v[244:247], v[60:63]
v_cvt_pk_bf16_f32 v132, v40, v41
v_cvt_pk_bf16_f32 v133, v42, v43
v_cvt_pk_bf16_f32 v134, v44, v45
v_cvt_pk_bf16_f32 v135, v46, v47
v_cvt_pk_bf16_f32 v136, v48, v49
v_permlane16_swap_b32 v132, v134
v_permlane16_swap_b32 v133, v135
v_cvt_pk_bf16_f32 v137, v50, v51
v_cvt_pk_bf16_f32 v138, v52, v53
buffer_store_dwordx4 v[132:135], v16, s[36:39], 0 offen offset:64 sc1
v_cvt_pk_bf16_f32 v139, v54, v55
v_permlane16_swap_b32 v136, v138
s_nop 0
v_permlane16_swap_b32 v137, v139
v_cvt_pk_bf16_f32 v140, v56, v57
v_cvt_pk_bf16_f32 v141, v58, v59
v_cvt_pk_bf16_f32 v142, v60, v61
v_cvt_pk_bf16_f32 v143, v62, v63
s_nop 0
v_permlane16_swap_b32 v140, v142
v_permlane16_swap_b32 v141, v143
buffer_store_dwordx4 v[136:139], v17, s[36:39], 0 offen sc1
buffer_store_dwordx4 v[140:143], v17, s[36:39], 0 offen offset:64 sc1
s_nop 1
.Lend:
s_endpgm
.Lsp66:
s_mov_b32 s15, 0
.Lsp66l:
v_mov_b32 v25, 0
buffer_atomic_add v25, v22, s[16:19], s73 offen sc0
s_add_u32 s15, s15, 1
s_cmp_gt_u32 s15, 100000
s_waitcnt vmcnt(0)
s_cbranch_scc1 .Lsp66b
v_cmp_gt_u32 vcc, v23, v25
s_nop 0
s_cbranch_vccnz .Lsp66l
s_branch .Lsp66b
.Lxs67:
s_mov_b32 s15, 0
.Lxs67l:
v_mov_b32 v15, 0
buffer_atomic_add v15, v12, s[16:19], s70 offen sc0
s_add_u32 s15, s15, 1
s_cmp_gt_u32 s15, 100000
s_waitcnt vmcnt(0)
s_cbranch_scc1 .Lxs67b
v_cmp_ne_u32 vcc, 0, v15
s_nop 0
s_cbranch_vccz .Lxs67l
s_branch .Lxs67b
.section .rodata,"a"
.p2align 6
.amdhsa_kernel interleave_layers__sliding_local_dilated__swiglu_ffn__prompt_kernel
  .amdhsa_next_free_vgpr 512
  .amdhsa_next_free_sgpr 102
  .amdhsa_accum_offset 256
  .amdhsa_group_segment_fixed_size 0
  .amdhsa_kernarg_size 80
  .amdhsa_user_sgpr_count 2
  .amdhsa_user_sgpr_kernarg_segment_ptr 1
  .amdhsa_system_sgpr_workgroup_id_x 1
  .amdhsa_float_denorm_mode_32 3
.end_amdhsa_kernel
```

```asm
; @launch grid=(256,1,1) block=(256,1,1) lds=162560
.amdgcn_target "amdgcn-amd-amdhsa--gfx950"
.macro MAA d,a,b
v_mfma_f32_16x16x32_bf16 v[\d:\d+3], a[\a:\a+3], a[\b:\b+3], v[\d:\d+3]
.endm
.macro MAV d,a,b
v_mfma_f32_16x16x32_bf16 v[\d:\d+3], a[\a:\a+3], v[\b:\b+3], v[\d:\d+3]
.endm
.macro TR d,v,o
ds_read_b64_tr_b16 a[\d:\d+1], v\v offset:\o
.endm
.macro RD d,v,o
ds_read_b128 a[\d:\d+3], v\v offset:\o
.endm
.text
.globl interleave_layers__sliding_local_dilated__swiglu_ffn__prompt_kernel
.p2align 8
.type interleave_layers__sliding_local_dilated__swiglu_ffn__prompt_kernel,@function
interleave_layers__sliding_local_dilated__swiglu_ffn__prompt_kernel:
s_load_dwordx4 s[68:71], s[0:1], 0
s_load_dwordx2 s[72:73], s[0:1], 16
s_load_dwordx8 s[76:83], s[0:1], 32
s_load_dwordx4 s[84:87], s[0:1], 64
s_cmp_lt_u32 s2, 256
s_cbranch_scc1 .Lgo
s_endpgm
.p2align 12
.Lgo:
v_lshrrev_b32 v2, 6, v0
v_and_b32 v1, 63, v0
v_readfirstlane_b32 s3, v2
s_and_b32 s4, s2, 7
s_lshr_b32 s5, s2, 3
s_lshr_b32 s6, s4, 1
s_lshl_b32 s6, s6, 2
s_and_b32 s62, s5, 3
s_add_u32 s6, s6, s62
s_and_b32 s7, s4, 1
s_lshr_b32 s62, s5, 2
s_lshl_b32 s62, s62, 1
s_add_u32 s7, s7, s62
s_lshr_b32 s8, s4, 2
s_lshl_b32 s8, s8, 3
s_and_b32 s62, s5, 7
s_add_u32 s8, s8, s62
s_and_b32 s9, s4, 3
s_lshl_b32 s9, s9, 2
s_lshr_b32 s62, s5, 3
s_add_u32 s9, s9, s62
s_lshr_b32 s62, s6, 1
s_lshl_b32 s62, s62, 8
s_and_b32 s63, s6, 1
s_add_u32 s62, s62, s63
s_lshl_b32 s63, s3, 6
s_add_u32 s62, s62, s63
s_lshl_b32 s62, s62, 11
s_lshl_b32 s63, s7, 7
s_add_u32 s62, s62, s63
v_and_b32 v160, 15, v1
v_lshlrev_b32 v160, 12, v160
v_bfe_u32 v2, v1, 4, 1
v_lshl_add_u32 v160, v2, 5, v160
v_bfe_u32 v2, v1, 5, 1
v_lshl_add_u32 v160, v2, 4, v160
v_add_u32 v160, s62, v160
v_add_u32 v161, 0x10000, v160
s_sub_u32 s64, s3, 1
s_max_i32 s64, s64, 0
s_lshl_b32 s64, s64, 11
s_lshl_b32 s66, s9, 7
s_add_u32 s66, s66, s64
s_cmp_eq_u32 s3, 1
s_cselect_b32 s66, 8388608, s66
s_mul_i32 s65, s8, 122880
s_add_u32 s65, s65, s66
v_lshrrev_b32 v9, 1, v1
v_min_u32 v9, 19, v9
v_mul_u32_u24 v9, 6144, v9
s_waitcnt lgkmcnt(0)
s_mov_b32 s36, s68
s_mov_b32 s37, s69
s_mov_b32 s38, 4194304
s_mov_b32 s39, 0x20000
s_mov_b32 s16, s86
s_mov_b32 s17, s87
s_mov_b32 s18, 268435456
s_mov_b32 s19, 0x20000
s_xor_b32 s14, s3, 3
s_lshl_b32 s14, s14, 8
s_add_u32 s14, s14, s2
v_lshlrev_b32 v27, 4, v1
v_mov_b64 v[156:157], 0
v_mov_b64 v[158:159], 0
s_cmp_ge_u32 s14, 16
s_cbranch_scc1 .Lz1
s_lshl_b32 s62, s2, 13
s_add_u32 s62, s62, 30408704
s_add_u32 s63, s62, 4096
buffer_store_dwordx4 v[156:159], v27, s[16:19], s62 offen sc1
buffer_store_dwordx4 v[156:159], v27, s[16:19], s62 offen offset:1024 sc1
buffer_store_dwordx4 v[156:159], v27, s[16:19], s62 offen offset:2048 sc1
buffer_store_dwordx4 v[156:159], v27, s[16:19], s62 offen offset:3072 sc1
buffer_store_dwordx4 v[156:159], v27, s[16:19], s63 offen sc1
buffer_store_dwordx4 v[156:159], v27, s[16:19], s63 offen offset:1024 sc1
buffer_store_dwordx4 v[156:159], v27, s[16:19], s63 offen offset:2048 sc1
buffer_store_dwordx4 v[156:159], v27, s[16:19], s63 offen offset:3072 sc1
.Lz1:
buffer_load_dwordx4 v[128:131], v160, s[36:39], 0 offen
buffer_load_dwordx4 v[132:135], v160, s[36:39], 0 offen offset:64
buffer_load_dwordx4 v[136:139], v161, s[36:39], 0 offen
buffer_load_dwordx4 v[140:143], v161, s[36:39], 0 offen offset:64
s_mov_b32 s20, s70
s_mov_b32 s21, s71
s_mov_b32 s22, 6291456
s_mov_b32 s23, 0x20000
buffer_load_dword v58, v9, s[20:23], s65 offen
s_mov_b32 s40, s84
s_mov_b32 s41, s85
s_mov_b32 s42, 256
s_mov_b32 s43, 0x20000
s_getpc_b64 s[62:63]
.Lpc:
s_lshl_b32 s64, s5, 12
v_lshrrev_b32 v59, 3, v0
v_lshl_add_u32 v59, v59, 7, s64
v_add_u32 v2, 0x20000, v59
v_min_u32 v2, .Lend-.Lpc, v2
v_min_u32 v59, .Lend-.Lpc, v59
global_load_dword v59, v59, s[62:63]
global_load_dword v58, v2, s[62:63]
s_mov_b32 s24, s72
s_mov_b32 s25, s73
s_mov_b32 s26, 2097152
s_mov_b32 s27, 0x20000
s_mov_b32 s28, s80
s_mov_b32 s29, s81
s_mov_b32 s30, 7340032
s_mov_b32 s31, 0x20000
s_mov_b32 s0, s82
s_mov_b32 s1, s83
s_mov_b32 s32, s76
s_mov_b32 s33, s77
s_mov_b32 s34, 7340032
s_mov_b32 s35, 0x20000
s_mov_b32 s80, s78
s_mov_b32 s81, s79
s_mov_b32 s82, 7340032
s_mov_b32 s83, 0x20000
s_lshr_b32 s10, s4, 2
s_lshl_b32 s10, s10, 2
s_and_b32 s62, s5, 3
s_add_u32 s10, s10, s62
s_and_b32 s11, s4, 3
s_lshl_b32 s11, s11, 3
s_lshr_b32 s62, s5, 2
s_add_u32 s11, s11, s62
s_and_b32 s12, s11, 1
s_lshr_b32 s13, s11, 1
s_mul_i32 s51, s13, 448
s_mul_i32 s62, s12, 192
s_add_u32 s51, s51, s62
s_and_b32 s48, s3, 1
s_lshr_b32 s49, s3, 1
s_lshl_b32 s50, s8, 3
s_sub_u32 s50, s50, 9
s_cmp_lt_u32 s8, 2
s_cselect_b32 s50, 7, s50
s_lshl_b32 s62, s6, 3
s_lshr_b32 s84, s62, 4
s_lshl_b32 s84, s84, 19
s_and_b32 s62, s62, 15
s_lshl_b32 s62, s62, 10
s_add_u32 s84, s84, s62
s_lshl_b32 s62, s8, 3
s_lshr_b32 s85, s62, 4
s_lshl_b32 s85, s85, 19
s_and_b32 s62, s62, 15
s_lshl_b32 s62, s62, 10
s_add_u32 s85, s85, s62
s_lshl_b32 s62, s50, 0
s_lshr_b32 s86, s62, 4
s_lshl_b32 s86, s86, 19
s_and_b32 s62, s62, 15
s_lshl_b32 s62, s62, 10
s_add_u32 s86, s86, s62
s_mul_i32 s62, s8, 393216
s_add_u32 s62, s62, s66
v_mul_u32_u24 v14, 6144, v1
v_add_u32 v14, s62, v14
s_lshl_b32 s62, s8, 4
s_add_u32 s62, s62, s9
s_lshl_b32 s62, s62, 2
s_add_u32 s62, s62, s3
s_mul_i32 s62, s62, 6656
v_min_u32 v15, 51, v1
v_lshl_add_u32 v15, v15, 7, s62
s_sub_u32 s63, s8, 4
s_lshl_b32 s64, s8, 1
s_add_u32 s64, s64, 1
s_cmp_lt_u32 s8, 5
s_cselect_b64 vcc, -1, 0
s_cselect_b32 s46, s64, s63
v_cndmask_b32 v14, v14, v15, vcc
s_lshl_b32 s62, s2, 1
s_add_u32 s62, s62, s48
s_mul_i32 s62, s62, 5376
v_min_u32 v16, 41, v1
v_lshl_add_u32 v16, v16, 7, s62
s_cmp_lt_u32 s46, 6
s_cselect_b64 vcc, -1, 0
v_cndmask_b32 v15, v14, v16, vcc
v_cndmask_b32 v14, v16, v14, vcc
s_cmp_lt_u32 s3, 2
s_cselect_b32 s65, s32, s80
s_cselect_b32 s66, s33, s81
s_cselect_b32 s67, s34, s82
s_cmp_lt_u32 s8, 5
s_cselect_b32 s62, s24, s20
s_cselect_b32 s63, s25, s21
s_cselect_b32 s64, s26, s22
s_sub_u32 s47, s46, 6
s_cmp_lt_u32 s46, 6
s_cselect_b32 s47, s46, s47
s_cselect_b32 s76, s62, s65
s_cselect_b32 s98, s65, s62
s_cselect_b32 s77, s63, s66
s_cselect_b32 s99, s66, s63
s_cselect_b32 s78, s64, s67
s_cselect_b32 s100, s67, s64
s_mov_b32 s79, 0x20000
v_bfe_u32 v18, v1, 3, 1
v_bfe_u32 v2, v1, 5, 1
v_lshl_add_u32 v18, v2, 2, v18
v_and_b32 v2, 16, v1
v_add_u32 v18, v18, v2
s_lshl_b32 s62, s49, 2
s_add_u32 s62, s62, s48
s_lshl_b32 s62, s62, 1
v_add_u32 v18, s62, v18
v_mul_u32_u24 v18, 6144, v18
v_and_b32 v2, 7, v1
v_lshl_add_u32 v18, v2, 4, v18
s_lshl_b32 s62, s9, 7
v_add_u32 v18, s62, v18
v_add_u32 v19, 1024, v18
v_add_u32 v20, 2048, v18
s_mul_i32 s59, s3, 3104
s_mov_b32 s58, 0
s_lshr_b32 s62, s8, 1
s_lshl_b32 s62, s62, 8
s_and_b32 s67, s8, 1
s_add_u32 s62, s62, s67
s_lshl_b32 s62, s62, 11
s_lshl_b32 s63, s3, 17
s_add_u32 s62, s62, s63
v_lshrrev_b32 v2, 4, v1
v_xor_b32 v2, v2, v1
v_and_b32 v2, 7, v2
v_lshlrev_b32 v2, 4, v2
v_lshrrev_b32 v21, 3, v1
v_lshl_add_u32 v21, v21, 12, v2
v_add_u32 v21, s62, v21
v_xor_b32 v28, 64, v21
v_add_u32 v28, 31744, v28
s_lshr_b32 s63, s50, 3
s_lshr_b32 s62, s63, 1
s_lshl_b32 s62, s62, 8
s_and_b32 s67, s63, 1
s_add_u32 s62, s62, s67
s_lshl_b32 s62, s62, 11
s_lshl_b32 s63, s3, 14
s_add_u32 s62, s62, s63
s_add_u32 s62, s62, 456704
s_lshl_b32 s63, s3, 5
v_and_b32 v2, 31, v1
v_lshlrev_b32 v2, 2, v2
v_xor_b32 v2, s63, v2
v_lshrrev_b32 v22, 5, v1
v_lshl_add_u32 v22, v22, 12, v2
v_add_u32 v22, s62, v22
v_xor_b32 v29, 16, v22
v_add_u32 v29, -57344, v29
s_mov_b32 s52, 0
s_mov_b32 s53, 65536
s_mul_i32 s55, s3, 4608
s_mov_b32 s54, 0
s_mul_i32 s56, s3, 3104
v_bfe_u32 v24, v1, 1, 3
v_lshrrev_b32 v2, 4, v1
v_xor_b32 v2, v2, v24
v_lshlrev_b32 v2, 4, v2
v_and_b32 v23, 15, v1
v_lshl_add_u32 v23, v23, 7, v2
s_mul_i32 s62, s48, 9216
v_add_u32 v23, s62, v23
v_xor_b32 v30, 64, v23
v_mul_u32_u24 v24, 2304, v24
v_add_u32 v24, v24, v2
v_and_b32 v2, 1, v1
v_lshl_add_u32 v24, v2, 7, v24
v_add_u32 v24, 2048, v24
v_xor_b32 v31, 64, v24
v_and_b32 v2, 15, v1
v_cmp_eq_u32 vcc, 0, v2
v_mov_b32 v2, 18432
s_nop 0
v_cndmask_b32 v24, v24, v2, vcc
v_cndmask_b32 v31, v31, v2, vcc
v_bfe_u32 v25, v1, 3, 2
v_mul_u32_u24 v25, 3104, v25
v_bfe_u32 v2, v1, 2, 1
v_lshl_add_u32 v25, v2, 7, v25
v_bfe_u32 v2, v1, 5, 1
v_lshl_add_u32 v25, v2, 8, v25
v_and_b32 v2, 3, v1
v_lshl_add_u32 v25, v2, 3, v25
s_lshl_b32 s62, s49, 6
s_add_u32 s62, s62, 73984
v_add_u32 v25, s62, v25
s_lshl_b32 s62, s8, 1
s_add_u32 s62, s62, s3
s_lshr_b32 s63, s50, 2
s_cmp_lt_u32 s3, 2
s_cselect_b32 s62, s62, s63
s_lshl_b32 s62, s62, 13
s_cmp_eq_u32 s3, 3
s_cselect_b32 s62, 268435456, s62
v_lshl_add_u32 v26, v1, 4, s62
s_mul_i32 s59, s3, 2080
v_bfe_u32 v5, v1, 3, 1
v_lshrrev_b32 v2, 4, v1
v_lshl_add_u32 v5, v2, 3, v5
s_lshl_b32 s62, s3, 1
v_add_u32 v5, s62, v5
v_mul_u32_u24 v5, 2048, v5
v_and_b32 v2, 7, v1
v_lshl_add_u32 v5, v2, 4, v5
s_lshl_b32 s62, s7, 7
v_add_u32 v5, s62, v5
v_add_u32 v6, 64512, v5
s_lshl_b32 s62, s6, 10
s_add_u32 s62, s62, 30408704
s_lshl_b32 s64, s8, 10
s_add_u32 s64, s64, 30408704
s_lshr_b32 s67, s9, 1
s_and_b32 s67, s67, 3
s_lshl_b32 s67, s67, 7
s_add_u32 s64, s64, s67
s_lshr_b32 s65, s50, 3
s_lshl_b32 s65, s65, 10
s_add_u32 s65, s65, 30408704
s_lshr_b32 s67, s9, 1
s_and_b32 s67, s67, 3
s_lshl_b32 s67, s67, 7
s_add_u32 s65, s65, s67
v_mov_b32 v2, 268435456
v_cmp_eq_u32 vcc, 65, v0
v_mov_b32 v33, s65
s_nop 0
v_cndmask_b32 v33, v2, v33, vcc
v_cndmask_b32 v36, 0, 16, vcc
v_cmp_eq_u32 vcc, 64, v0
v_mov_b32 v32, s64
s_nop 0
v_cndmask_b32 v33, v33, v32, vcc
v_lshl_add_u32 v32, v1, 7, s62
v_cndmask_b32 v34, v2, 0, vcc
v_cndmask_b32 v35, 0, 16, vcc
v_cndmask_b32 v36, v36, 16, vcc
v_lshrrev_b32 v37, 3, v0
v_cmp_eq_u32 vcc, 8, v37
s_nop 1
v_cndmask_b32 v32, v2, v32, vcc
v_mov_b32 v38, 1
v_lshrrev_b32 v2, 4, v1
v_lshlrev_b32 v2, 2, v2
v_and_b32 v13, 15, v1
v_sub_u32 v2, v13, v2
v_mov_b32 v13, 0xff61b1e6
v_subrev_u32 v54, 0, v2
v_cmp_gt_u32 vcc, 8, v54
s_nop 1
v_cndmask_b32 v50, v13, 0, vcc
v_cmp_gt_i32 vcc, -8, v54
s_nop 1
v_cndmask_b32 v46, v13, 0, vcc
v_subrev_u32 v54, 1, v2
v_cmp_gt_u32 vcc, 8, v54
s_nop 1
v_cndmask_b32 v51, v13, 0, vcc
v_cmp_gt_i32 vcc, -8, v54
s_nop 1
v_cndmask_b32 v47, v13, 0, vcc
v_subrev_u32 v54, 2, v2
v_cmp_gt_u32 vcc, 8, v54
s_nop 1
v_cndmask_b32 v52, v13, 0, vcc
v_cmp_gt_i32 vcc, -8, v54
s_nop 1
v_cndmask_b32 v48, v13, 0, vcc
v_subrev_u32 v54, 3, v2
v_cmp_gt_u32 vcc, 8, v54
s_nop 1
v_cndmask_b32 v53, v13, 0, vcc
v_cmp_gt_i32 vcc, -8, v54
s_nop 1
v_cndmask_b32 v49, v13, 0, vcc
s_cmp_lt_u32 s8, 2
s_cselect_b64 vcc, -1, 0
v_cndmask_b32 v54, v46, v13, vcc
v_cndmask_b32 v55, v47, v13, vcc
v_cndmask_b32 v56, v48, v13, vcc
v_cndmask_b32 v57, v49, v13, vcc
s_mov_b32 s75, 29360128
v_and_b32 v10, 15, v1
v_lshlrev_b32 v12, 2, v10
v_lshlrev_b32 v10, 4, v10
v_add_u32 v10, 152576, v10
v_lshrrev_b32 v11, 4, v1
v_lshlrev_b32 v11, 4, v11
s_lshl_b32 s62, s49, 7
s_add_u32 s62, s62, 158720
v_add_u32 v12, s62, v12
v_add_u32 v13, s62, v11
v_add_u32 v11, 156672, v11
s_lshl_b32 s62, s3, 11
s_add_u32 s62, s62, 143360
v_lshl_add_u32 v8, v1, 4, s62
v_xor_b32 v9, 2048, v8
v_mov_b32 v248, 0x3f803f80
v_mov_b32 v249, 0x3f803f80
v_mov_b32 v250, 0x3f803f80
v_mov_b32 v251, 0x3f803f80
s_mul_i32 s62, s3, 18496
s_add_u32 s62, s62, 18432
v_mov_b32 v2, s62
ds_write_b128 v2, v[248:251]
v_and_b32 v7, 31, v1
v_lshrrev_b32 v2, 5, v1
v_lshl_add_u32 v7, v7, 1, v2
v_and_b32 v2, 0xc0, v0
v_add_u32 v7, v7, v2
v_lshlrev_b32 v17, 2, v7
v_add_u32 v17, 156672, v17
v_lshlrev_b32 v7, 4, v7
v_add_u32 v7, 152576, v7
s_lshl_b32 s74, s9, 1
s_add_u32 s74, s74, s49
s_lshl_b32 s74, s74, 14
s_add_u32 s74, s74, s85
s_lshl_b32 s63, s48, 12
s_add_u32 s74, s74, s63
s_add_u32 s74, s74, 4194304
s_mov_b32 s62, 0
v_lshl_add_u32 v4, v1, 4, s62
v_lshrrev_b32 v2, 3, v1
v_cmp_eq_u32 vcc, 3, v2
v_add_u32 v2, 67108480, v4
s_nop 0
v_cndmask_b32 v4, v4, v2, vcc
s_nop 1
s_cmp_eq_u32 s48, 1
s_cbranch_scc1 .Lqkv2
s_add_u32 m0, s55, 0
s_nop 0
buffer_load_dwordx4 v21, s[36:39], s52 offen lds
buffer_load_dwordx4 v28, s[36:39], s52 offen offset:1024 lds
buffer_load_dword v22, s[36:39], s52 offen offset:2048 lds
s_add_u32 s52, s52, 128
s_add_u32 m0, s55, 2304
s_nop 0
buffer_load_dwordx4 v21, s[36:39], s53 offen lds
buffer_load_dwordx4 v28, s[36:39], s53 offen offset:1024 lds
buffer_load_dword v29, s[36:39], s53 offen offset:2048 lds
s_add_u32 s53, s53, 128
s_add_u32 m0, s56, 123648
s_nop 0
buffer_load_dwordx4 v18, s[20:23], s54 offen lds
buffer_load_dwordx4 v19, s[20:23], s54 offen offset:1024 lds
buffer_load_dwordx4 v20, s[20:23], s54 offen offset:2048 lds
s_add_u32 s54, s54, 196608
s_add_u32 m0, s56, 136064
s_nop 0
buffer_load_dwordx4 v18, s[20:23], s54 offen lds
buffer_load_dwordx4 v19, s[20:23], s54 offen offset:1024 lds
buffer_load_dwordx4 v20, s[20:23], s54 offen offset:2048 lds
s_add_u32 s54, s54, 196608
s_waitcnt vmcnt(12)
s_cmp_lt_u32 s14, 16
s_cselect_b32 s62, 0, 4096
v_mov_b32 v154, 1
v_lshlrev_b32 v155, 8, v1
v_permlane16_swap_b32 v128, v130
v_permlane16_swap_b32 v129, v131
v_permlane16_swap_b32 v132, v134
v_permlane16_swap_b32 v133, v135
v_permlane16_swap_b32 v136, v138
v_permlane16_swap_b32 v137, v139
v_permlane16_swap_b32 v140, v142
v_permlane16_swap_b32 v141, v143
buffer_atomic_add v154, v155, s[40:43], s62 offen
v_lshlrev_b32 v64, 16, v128
v_and_b32 v65, 0xffff0000, v128
v_lshlrev_b32 v66, 16, v129
v_and_b32 v67, 0xffff0000, v129
v_lshlrev_b32 v68, 16, v130
v_and_b32 v69, 0xffff0000, v130
v_lshlrev_b32 v70, 16, v131
v_and_b32 v71, 0xffff0000, v131
v_lshlrev_b32 v72, 16, v132
v_and_b32 v73, 0xffff0000, v132
v_lshlrev_b32 v74, 16, v133
v_and_b32 v75, 0xffff0000, v133
v_lshlrev_b32 v76, 16, v134
v_and_b32 v77, 0xffff0000, v134
v_lshlrev_b32 v78, 16, v135
v_and_b32 v79, 0xffff0000, v135
v_lshlrev_b32 v80, 16, v136
v_and_b32 v81, 0xffff0000, v136
v_lshlrev_b32 v82, 16, v137
v_and_b32 v83, 0xffff0000, v137
v_lshlrev_b32 v84, 16, v138
v_and_b32 v85, 0xffff0000, v138
v_lshlrev_b32 v86, 16, v139
v_and_b32 v87, 0xffff0000, v139
v_lshlrev_b32 v88, 16, v140
v_and_b32 v89, 0xffff0000, v140
v_lshlrev_b32 v90, 16, v141
v_and_b32 v91, 0xffff0000, v141
v_lshlrev_b32 v92, 16, v142
v_and_b32 v93, 0xffff0000, v142
v_lshlrev_b32 v94, 16, v143
v_and_b32 v95, 0xffff0000, v143
s_lshl_b32 s64, s6, 14
s_lshl_b32 s65, s49, 13
s_add_u32 s64, s64, s65
s_lshl_b32 s65, s7, 9
s_add_u32 s64, s64, s65
s_lshl_b32 s65, s48, 8
s_add_u32 s64, s64, s65
s_add_u32 s64, s64, 29360128
v_and_b32 v152, 31, v1
v_lshlrev_b32 v152, 3, v152
v_lshrrev_b32 v153, 5, v1
v_lshl_add_u32 v152, v153, 28, v152
s_lshl_b32 s62, s7, 15
s_add_u32 s62, s62, 0
s_add_u32 s63, s62, 16384
v_pk_mul_f32 v[146:147], v[64:65], v[64:65]
v_pk_mul_f32 v[150:151], v[80:81], v[80:81]
v_pk_fma_f32 v[146:147], v[66:67], v[66:67], v[146:147]
v_pk_add_f32 v[144:145], v[64:65], v[66:67]
v_pk_fma_f32 v[150:151], v[82:83], v[82:83], v[150:151]
v_pk_add_f32 v[148:149], v[80:81], v[82:83]
v_pk_fma_f32 v[146:147], v[68:69], v[68:69], v[146:147]
v_pk_add_f32 v[144:145], v[144:145], v[68:69]
v_pk_fma_f32 v[150:151], v[84:85], v[84:85], v[150:151]
v_pk_add_f32 v[148:149], v[148:149], v[84:85]
v_pk_fma_f32 v[146:147], v[70:71], v[70:71], v[146:147]
v_pk_add_f32 v[144:145], v[144:145], v[70:71]
v_pk_fma_f32 v[150:151], v[86:87], v[86:87], v[150:151]
v_pk_add_f32 v[148:149], v[148:149], v[86:87]
v_pk_fma_f32 v[146:147], v[72:73], v[72:73], v[146:147]
v_pk_add_f32 v[144:145], v[144:145], v[72:73]
v_pk_fma_f32 v[150:151], v[88:89], v[88:89], v[150:151]
v_pk_add_f32 v[148:149], v[148:149], v[88:89]
v_pk_fma_f32 v[146:147], v[74:75], v[74:75], v[146:147]
v_pk_add_f32 v[144:145], v[144:145], v[74:75]
v_pk_fma_f32 v[150:151], v[90:91], v[90:91], v[150:151]
v_pk_add_f32 v[148:149], v[148:149], v[90:91]
v_pk_fma_f32 v[146:147], v[76:77], v[76:77], v[146:147]
v_pk_add_f32 v[144:145], v[144:145], v[76:77]
v_pk_fma_f32 v[150:151], v[92:93], v[92:93], v[150:151]
v_pk_add_f32 v[148:149], v[148:149], v[92:93]
v_pk_fma_f32 v[146:147], v[78:79], v[78:79], v[146:147]
v_pk_add_f32 v[144:145], v[144:145], v[78:79]
v_pk_fma_f32 v[150:151], v[94:95], v[94:95], v[150:151]
v_pk_add_f32 v[148:149], v[148:149], v[94:95]
v_add_f32 v144, v144, v145
v_add_f32 v146, v146, v147
v_add_f32 v148, v148, v149
v_add_f32 v150, v150, v151
s_nop 0
v_permlane16_swap_b32 v144, v148
v_permlane16_swap_b32 v146, v150
v_add_f32 v144, v144, v148
v_add_f32 v146, v146, v150
s_nop 1
v_permlane32_swap_b32 v144, v146
v_add_f32 v144, v144, v146
s_nop 1
v_permlane32_swap_b32 v144, v145
buffer_store_dwordx2 v[144:145], v152, s[16:19], s64 offen sc1
s_lshl_b32 s62, s2, 10
s_add_u32 s62, s62, 31457280
s_cmp_eq_u32 s3, 0
s_cselect_b32 s62, s62, 268435456
buffer_store_dwordx4 v[156:159], v27, s[16:19], s62 offen sc1
v_accvgpr_write_b32 a224, v64
v_accvgpr_write_b32 a225, v65
v_accvgpr_write_b32 a226, v66
v_accvgpr_write_b32 a227, v67
v_accvgpr_write_b32 a228, v68
v_accvgpr_write_b32 a229, v69
v_accvgpr_write_b32 a230, v70
v_accvgpr_write_b32 a231, v71
v_accvgpr_write_b32 a232, v72
v_accvgpr_write_b32 a233, v73
v_accvgpr_write_b32 a234, v74
v_accvgpr_write_b32 a235, v75
v_accvgpr_write_b32 a236, v76
v_accvgpr_write_b32 a237, v77
v_accvgpr_write_b32 a238, v78
v_accvgpr_write_b32 a239, v79
v_accvgpr_write_b32 a240, v80
v_accvgpr_write_b32 a241, v81
v_accvgpr_write_b32 a242, v82
v_accvgpr_write_b32 a243, v83
v_accvgpr_write_b32 a244, v84
v_accvgpr_write_b32 a245, v85
v_accvgpr_write_b32 a246, v86
v_accvgpr_write_b32 a247, v87
v_accvgpr_write_b32 a248, v88
v_accvgpr_write_b32 a249, v89
v_accvgpr_write_b32 a250, v90
v_accvgpr_write_b32 a251, v91
v_accvgpr_write_b32 a252, v92
v_accvgpr_write_b32 a253, v93
v_accvgpr_write_b32 a254, v94
v_accvgpr_write_b32 a255, v95
s_add_u32 m0, s55, 18496
s_nop 0
buffer_load_dwordx4 v21, s[36:39], s52 offen lds
buffer_load_dwordx4 v28, s[36:39], s52 offen offset:1024 lds
buffer_load_dword v22, s[36:39], s52 offen offset:2048 lds
s_add_u32 s52, s52, 128
s_add_u32 m0, s55, 20800
s_nop 0
buffer_load_dwordx4 v21, s[36:39], s53 offen lds
buffer_load_dwordx4 v28, s[36:39], s53 offen offset:1024 lds
buffer_load_dword v29, s[36:39], s53 offen offset:2048 lds
s_add_u32 s53, s53, 128
s_add_u32 m0, s56, 73984
s_nop 0
buffer_load_dwordx4 v18, s[20:23], s54 offen lds
buffer_load_dwordx4 v19, s[20:23], s54 offen offset:1024 lds
buffer_load_dwordx4 v20, s[20:23], s54 offen offset:2048 lds
s_add_u32 s54, s54, 196608
s_waitcnt vmcnt(15) lgkmcnt(0)
s_barrier
ds_read_b128 a[0:3], v23
RD 4,23,2304
RD 8,23,4608
RD 12,23,6912
TR 20,25,49664
TR 22,25,50176
TR 24,25,49696
TR 26,25,50208
ds_read_b128 a[16:19], v24
TR 28,25,50688
TR 30,25,51200
TR 32,25,50720
TR 34,25,51232
TR 36,25,51712
TR 38,25,52224
TR 40,25,51744
TR 42,25,52256
s_waitcnt vmcnt(12) lgkmcnt(8)
s_barrier
v_mfma_f32_16x16x32_bf16 v[60:63], a[20:23], a[0:3], 0
ds_read_b128 a[44:47], v30
s_add_u32 m0, s56, 86400
v_mfma_f32_16x16x32_bf16 v[76:79], a[24:27], a[0:3], 0
buffer_load_dwordx4 v18, s[20:23], s54 offen lds
v_mfma_f32_16x16x32_bf16 v[80:83], a[24:27], a[4:7], 0
s_sub_u32 s47, s47, 1
s_cbranch_scc1 .Lx4
.Lx4b:
v_mfma_f32_16x16x32_bf16 v[64:67], a[20:23], a[4:7], 0
buffer_load_dwordx4 v19, s[20:23], s54 offen offset:1024 lds
v_mfma_f32_16x16x32_bf16 v[68:71], a[20:23], a[8:11], 0
RD 48,30,2304
v_mfma_f32_16x16x32_bf16 v[84:87], a[24:27], a[8:11], 0
RD 52,30,4608
RD 56,30,6912
v_mfma_f32_16x16x32_bf16 v[88:91], a[24:27], a[12:15], 0
buffer_load_dwordx4 v20, s[20:23], s54 offen offset:2048 lds
v_mfma_f32_16x16x32_bf16 v[72:75], a[20:23], a[12:15], 0
s_add_u32 s54, s54, 196608
s_waitcnt lgkmcnt(4)
v_mfma_f32_16x16x32_bf16 v[244:247], a[20:23], a[16:19], 0
TR 64,25,62080
s_add_u32 m0, s55, 36992
v_mfma_f32_16x16x32_bf16 v[104:107], a[28:31], a[12:15], 0
buffer_load_dwordx4 v21, s[36:39], s52 offen lds
v_mfma_f32_16x16x32_bf16 v[120:123], a[32:35], a[12:15], 0
TR 66,25,62592
v_mfma_f32_16x16x32_bf16 v[116:119], a[32:35], a[8:11], 0
TR 68,25,62112
TR 70,25,62624
v_mfma_f32_16x16x32_bf16 v[100:103], a[28:31], a[8:11], 0
buffer_load_dwordx4 v28, s[36:39], s52 offen offset:1024 lds
v_mfma_f32_16x16x32_bf16 v[96:99], a[28:31], a[4:7], 0
ds_read_b128 a[60:63], v31
v_mfma_f32_16x16x32_bf16 v[112:115], a[32:35], a[4:7], 0
buffer_load_dword v22, s[36:39], s52 offen offset:2048 lds
v_mfma_f32_16x16x32_bf16 v[108:111], a[32:35], a[0:3], 0
TR 72,25,63104
s_add_u32 s52, s52, 128
v_mfma_f32_16x16x32_bf16 v[92:95], a[28:31], a[0:3], 0
s_add_u32 m0, s55, 39296
v_mfma_f32_16x16x32_bf16 v[156:159], a[28:31], a[16:19], 0
buffer_load_dwordx4 v21, s[36:39], s53 offen lds
v_mfma_f32_16x16x32_bf16 v[160:163], a[32:35], a[16:19], 0
TR 74,25,63616
TR 76,25,63136
v_mfma_f32_16x16x32_bf16 v[124:127], a[0:3], a[36:39], 0
TR 78,25,63648
v_mfma_f32_16x16x32_bf16 v[140:143], a[0:3], a[40:43], 0
buffer_load_dwordx4 v28, s[36:39], s53 offen offset:1024 lds
v_mfma_f32_16x16x32_bf16 v[144:147], a[4:7], a[40:43], 0
TR 80,25,64128
v_mfma_f32_16x16x32_bf16 v[128:131], a[4:7], a[36:39], 0
TR 82,25,64640
TR 84,25,64160
v_mfma_f32_16x16x32_bf16 v[132:135], a[8:11], a[36:39], 0
buffer_load_dword v29, s[36:39], s53 offen offset:2048 lds
v_mfma_f32_16x16x32_bf16 v[148:151], a[8:11], a[40:43], 0
s_add_u32 s53, s53, 128
v_mfma_f32_16x16x32_bf16 v[152:155], a[12:15], a[40:43], 0
TR 86,25,64672
v_mfma_f32_16x16x32_bf16 v[136:139], a[12:15], a[36:39], 0
s_waitcnt vmcnt(9) lgkmcnt(8)
s_barrier
MAA 60,64,44
RD 0,23,18496
s_add_u32 m0, s56, 98816
MAA 76,68,44
buffer_load_dwordx4 v18, s[20:23], s54 offen lds
MAA 80,68,48
RD 4,23,20800
MAA 64,64,48
buffer_load_dwordx4 v19, s[20:23], s54 offen offset:1024 lds
MAA 68,64,52
RD 8,23,23104
RD 12,23,25408
MAA 84,68,52
ds_read_b64_tr_b16 a[20:21], v25
MAA 88,68,56
buffer_load_dwordx4 v20, s[20:23], s54 offen offset:2048 lds
MAA 72,64,56
s_add_u32 s54, s54, 196608
s_waitcnt lgkmcnt(5)
MAA 244,64,60
TR 22,25,512
s_add_u32 m0, s56, 111232
MAA 104,72,56
buffer_load_dwordx4 v18, s[20:23], s54 offen lds
MAA 120,76,56
TR 24,25,32
MAA 116,76,52
TR 26,25,544
MAA 100,72,52
buffer_load_dwordx4 v19, s[20:23], s54 offen offset:1024 lds
MAA 96,72,48
RD 16,24,18496
TR 28,25,1024
MAA 112,76,48
buffer_load_dwordx4 v20, s[20:23], s54 offen offset:2048 lds
MAA 108,76,44
s_add_u32 s54, s54, 196608
MAA 92,72,44
TR 30,25,1536
s_add_u32 m0, s55, 55488
MAA 156,72,60
buffer_load_dwordx4 v21, s[36:39], s52 offen lds
MAA 160,76,60
TR 32,25,1056
MAA 124,44,80
TR 34,25,1568
MAA 140,44,84
buffer_load_dwordx4 v28, s[36:39], s52 offen offset:1024 lds
MAA 144,48,84
TR 36,25,2048
MAA 128,48,80
TR 38,25,2560
TR 40,25,2080
MAA 132,52,80
buffer_load_dword v22, s[36:39], s52 offen offset:2048 lds
MAA 148,52,84
s_add_u32 s52, s52, 128
MAA 152,56,84
TR 42,25,2592
MAA 136,56,80
s_waitcnt vmcnt(15) lgkmcnt(8)
s_barrier
MAA 60,20,0
RD 44,30,18496
s_add_u32 m0, s55, 57792
MAA 76,24,0
buffer_load_dwordx4 v21, s[36:39], s53 offen lds
MAA 80,24,4
s_sub_u32 s47, s47, 1
s_cbranch_scc1 .Lx5
.Lx5b:
MAA 64,20,4
buffer_load_dwordx4 v28, s[36:39], s53 offen offset:1024 lds
MAA 68,20,8
RD 48,30,20800
MAA 84,24,8
RD 52,30,23104
RD 56,30,25408
MAA 88,24,12
buffer_load_dword v29, s[36:39], s53 offen offset:2048 lds
MAA 72,20,12
s_add_u32 s53, s53, 128
s_waitcnt lgkmcnt(4)
MAA 244,20,16
TR 64,25,12416
s_add_u32 m0, s56, 123648
MAA 104,28,12
buffer_load_dwordx4 v18, s[20:23], s54 offen lds
MAA 120,32,12
TR 66,25,12928
MAA 116,32,8
TR 68,25,12448
TR 70,25,12960
MAA 100,28,8
buffer_load_dwordx4 v19, s[20:23], s54 offen offset:1024 lds
MAA 96,28,4
RD 60,31,18496
MAA 112,32,4
buffer_load_dwordx4 v20, s[20:23], s54 offen offset:2048 lds
MAA 108,32,0
TR 72,25,13440
s_add_u32 s54, s54, 196608
MAA 92,28,0
s_add_u32 m0, s56, 136064
MAA 156,28,16
buffer_load_dwordx4 v18, s[20:23], s54 offen lds
MAA 160,32,16
TR 74,25,13952
TR 76,25,13472
MAA 124,0,36
TR 78,25,13984
MAA 140,0,40
buffer_load_dwordx4 v19, s[20:23], s54 offen offset:1024 lds
MAA 144,4,40
TR 80,25,14464
MAA 128,4,36
TR 82,25,14976
TR 84,25,14496
MAA 132,8,36
buffer_load_dwordx4 v20, s[20:23], s54 offen offset:2048 lds
MAA 148,8,40
s_add_u32 s54, s54, 196608
MAA 152,12,40
TR 86,25,15008
MAA 136,12,36
s_waitcnt vmcnt(15) lgkmcnt(8)
s_barrier
MAA 60,64,44
RD 0,23,36992
s_add_u32 m0, s55, 0
MAA 76,68,44
buffer_load_dwordx4 v21, s[36:39], s52 offen lds
MAA 80,68,48
RD 4,23,39296
MAA 64,64,48
buffer_load_dwordx4 v28, s[36:39], s52 offen offset:1024 lds
MAA 68,64,52
RD 8,23,41600
RD 12,23,43904
MAA 84,68,52
TR 20,25,24832
MAA 88,68,56
buffer_load_dword v22, s[36:39], s52 offen offset:2048 lds
MAA 72,64,56
s_add_u32 s52, s52, 128
s_add_u32 m0, s55, 2304
s_waitcnt lgkmcnt(5)
MAA 244,64,60
buffer_load_dwordx4 v21, s[36:39], s53 offen lds
MAA 104,72,56
TR 22,25,25344
MAA 120,76,56
TR 24,25,24864
TR 26,25,25376
MAA 116,76,52
buffer_load_dwordx4 v28, s[36:39], s53 offen offset:1024 lds
MAA 100,72,52
RD 16,24,36992
MAA 96,72,48
buffer_load_dword v29, s[36:39], s53 offen offset:2048 lds
MAA 112,76,48
TR 28,25,25856
s_add_u32 s53, s53, 128
MAA 108,76,44
s_add_u32 m0, s56, 73984
MAA 92,72,44
buffer_load_dwordx4 v18, s[20:23], s54 offen lds
MAA 156,72,60
TR 30,25,26368
TR 32,25,25888
MAA 160,76,60
buffer_load_dwordx4 v19, s[20:23], s54 offen offset:1024 lds
MAA 124,44,80
TR 34,25,26400
MAA 140,44,84
TR 36,25,26880
MAA 144,48,84
buffer_load_dwordx4 v20, s[20:23], s54 offen offset:2048 lds
MAA 128,48,80
TR 38,25,27392
s_add_u32 s54, s54, 196608
MAA 132,52,80
buffer_load_dword v37, v34, s[40:43], 0 offen sc1
MAA 148,52,84
TR 40,25,26912
MAA 152,56,84
TR 42,25,27424
MAA 136,56,80
s_waitcnt vmcnt(22) lgkmcnt(8)
s_barrier
MAA 60,20,0
RD 44,30,36992
s_add_u32 m0, s56, 86400
MAA 76,24,0
buffer_load_dwordx4 v18, s[20:23], s54 offen lds
MAA 80,24,4
s_sub_u32 s47, s47, 1
s_cbranch_scc1 .Lx6
.Lx6b:
MAA 64,20,4
buffer_load_dwordx4 v19, s[20:23], s54 offen offset:1024 lds
MAA 68,20,8
RD 48,30,39296
MAA 84,24,8
RD 52,30,41600
RD 56,30,43904
MAA 88,24,12
buffer_load_dwordx4 v20, s[20:23], s54 offen offset:2048 lds
MAA 72,20,12
s_add_u32 s54, s54, 196608
s_waitcnt lgkmcnt(4)
MAA 244,20,16
TR 64,25,37248
s_add_u32 m0, s55, 18496
MAA 104,28,12
buffer_load_dwordx4 v21, s[36:39], s52 offen lds
MAA 120,32,12
TR 66,25,37760
MAA 116,32,8
TR 68,25,37280
TR 70,25,37792
MAA 100,28,8
buffer_load_dwordx4 v28, s[36:39], s52 offen offset:1024 lds
MAA 96,28,4
RD 60,31,36992
MAA 112,32,4
buffer_load_dword v22, s[36:39], s52 offen offset:2048 lds
MAA 108,32,0
TR 72,25,38272
s_add_u32 s52, s52, 128
MAA 92,28,0
s_add_u32 m0, s55, 20800
MAA 156,28,16
buffer_load_dwordx4 v21, s[36:39], s53 offen lds
MAA 160,32,16
TR 74,25,38784
TR 76,25,38304
MAA 124,0,36
TR 78,25,38816
MAA 140,0,40
buffer_load_dwordx4 v28, s[36:39], s53 offen offset:1024 lds
MAA 144,4,40
TR 80,25,39296
MAA 128,4,36
TR 82,25,39808
TR 84,25,39328
MAA 132,8,36
buffer_load_dword v29, s[36:39], s53 offen offset:2048 lds
MAA 148,8,40
s_add_u32 s53, s53, 128
MAA 152,12,40
TR 86,25,39840
MAA 136,12,36
s_waitcnt vmcnt(22) lgkmcnt(8)
s_barrier
MAA 60,64,44
RD 0,23,55488
s_add_u32 m0, s56, 98816
MAA 76,68,44
buffer_load_dwordx4 v18, s[20:23], s54 offen lds
MAA 80,68,48
RD 4,23,57792
MAA 64,64,48
RD 8,23,60096
MAA 68,64,52
RD 12,23,62400
MAA 84,68,52
buffer_load_dwordx4 v19, s[20:23], s54 offen offset:1024 lds
MAA 88,68,56
TR 20,25,49664
MAA 72,64,56
TR 22,25,50176
s_waitcnt lgkmcnt(6)
MAA 244,64,60
MAA 104,72,56
buffer_load_dwordx4 v20, s[20:23], s54 offen offset:2048 lds
MAA 120,76,56
TR 24,25,49696
s_add_u32 s54, s54, 196608
MAA 116,76,52
TR 26,25,50208
MAA 100,72,52
RD 16,24,55488
s_add_u32 m0, s55, 36992
MAA 96,72,48
buffer_load_dwordx4 v21, s[36:39], s52 offen lds
MAA 112,76,48
TR 28,25,50688
MAA 108,76,44
TR 30,25,51200
MAA 92,72,44
TR 32,25,50720
MAA 156,72,60
buffer_load_dwordx4 v28, s[36:39], s52 offen offset:1024 lds
MAA 160,76,60
MAA 124,44,80
TR 34,25,51232
MAA 140,44,84
TR 36,25,51712
MAA 144,48,84
buffer_load_dword v22, s[36:39], s52 offen offset:2048 lds
MAA 128,48,80
TR 38,25,52224
s_add_u32 s52, s52, 128
MAA 132,52,80
TR 40,25,51744
MAA 148,52,84
TR 42,25,52256
MAA 152,56,84
MAA 136,56,80
s_waitcnt vmcnt(25) lgkmcnt(8)
s_barrier
MAA 60,20,0
RD 44,30,55488
s_add_u32 m0, s56, 111232
MAA 76,24,0
buffer_load_dwordx4 v18, s[20:23], s54 offen lds
MAA 80,24,4
s_sub_u32 s47, s47, 1
s_cbranch_scc1 .Lx7
.Lx7b:
MAA 64,20,4
RD 48,30,57792
MAA 68,20,8
RD 52,30,60096
MAA 84,24,8
buffer_load_dwordx4 v19, s[20:23], s54 offen offset:1024 lds
MAA 88,24,12
RD 56,30,62400
MAA 72,20,12
TR 64,25,62080
s_waitcnt lgkmcnt(5)
MAA 244,20,16
TR 66,25,62592
MAA 104,28,12
buffer_load_dwordx4 v20, s[20:23], s54 offen offset:2048 lds
MAA 120,32,12
TR 68,25,62112
s_add_u32 s54, s54, 196608
MAA 116,32,8
TR 70,25,62624
MAA 100,28,8
RD 60,31,55488
s_add_u32 m0, s55, 39296
MAA 96,28,4
buffer_load_dwordx4 v21, s[36:39], s53 offen lds
MAA 112,32,4
MAA 108,32,0
TR 72,25,63104
MAA 92,28,0
TR 74,25,63616
MAA 156,28,16
buffer_load_dwordx4 v28, s[36:39], s53 offen offset:1024 lds
MAA 160,32,16
TR 76,25,63136
MAA 124,0,36
TR 78,25,63648
MAA 140,0,40
TR 80,25,64128
MAA 144,4,40
buffer_load_dword v29, s[36:39], s53 offen offset:2048 lds
MAA 128,4,36
TR 82,25,64640
s_add_u32 s53, s53, 128
MAA 132,8,36
TR 84,25,64160
MAA 148,8,40
TR 86,25,64672
MAA 152,12,40
MAA 136,12,36
s_waitcnt vmcnt(22) lgkmcnt(8)
s_barrier
s_waitcnt vmcnt(21)
v_cmp_gt_u32 vcc, v35, v37
s_nop 0
s_cbranch_vccnz .Lsp8
.Lsp8b:
v_mov_b32 v37, 0
MAA 60,64,44
ds_read_b128 a[0:3], v23
MAA 76,68,44
buffer_atomic_add v38, v32, s[16:19], 0 offen
MAA 80,68,48
RD 4,23,2304
MAA 64,64,48
RD 8,23,4608
s_add_u32 m0, s56, 123648
MAA 68,64,52
buffer_load_dwordx4 v18, s[20:23], s54 offen lds
MAA 84,68,52
RD 12,23,6912
MAA 88,68,56
ds_read_b64_tr_b16 a[20:21], v25
MAA 72,64,56
TR 22,25,512
s_waitcnt lgkmcnt(6)
MAA 244,64,60
buffer_load_dwordx4 v19, s[20:23], s54 offen offset:1024 lds
MAA 104,72,56
TR 24,25,32
MAA 120,76,56
TR 26,25,544
MAA 116,76,52
buffer_load_dwordx4 v20, s[20:23], s54 offen offset:2048 lds
MAA 100,72,52
ds_read_b128 a[16:19], v24
s_add_u32 s54, s54, 196608
MAA 96,72,48
MAA 112,76,48
TR 28,25,1024
s_add_u32 m0, s55, 55488
MAA 108,76,44
buffer_load_dwordx4 v21, s[36:39], s52 offen lds
MAA 92,72,44
TR 30,25,1536
MAA 156,72,60
TR 32,25,1056
MAA 160,76,60
buffer_load_dwordx4 v28, s[36:39], s52 offen offset:1024 lds
MAA 124,44,80
TR 34,25,1568
MAA 140,44,84
TR 36,25,2048
MAA 144,48,84
TR 38,25,2560
MAA 128,48,80
buffer_load_dword v22, s[36:39], s52 offen offset:2048 lds
MAA 132,52,80
TR 40,25,2080
s_add_u32 s52, s52, 128
MAA 148,52,84
TR 42,25,2592
MAA 152,56,84
MAA 136,56,80
s_waitcnt vmcnt(25) lgkmcnt(8)
s_barrier
MAA 60,20,0
ds_read_b128 a[44:47], v30
s_add_u32 m0, s56, 136064
MAA 76,24,0
buffer_load_dwordx4 v18, s[20:23], s54 offen lds
MAA 80,24,4
s_sub_u32 s47, s47, 1
s_cbranch_scc1 .Lx9
.Lx9b:
MAA 64,20,4
RD 48,30,2304
MAA 68,20,8
RD 52,30,4608
MAA 84,24,8
buffer_load_dwordx4 v19, s[20:23], s54 offen offset:1024 lds
MAA 88,24,12
RD 56,30,6912
MAA 72,20,12
TR 64,25,12416
s_waitcnt lgkmcnt(5)
MAA 244,20,16
TR 66,25,12928
MAA 104,28,12
buffer_load_dwordx4 v20, s[20:23], s54 offen offset:2048 lds
MAA 120,32,12
TR 68,25,12448
s_add_u32 s54, s54, 196608
MAA 116,32,8
TR 70,25,12960
MAA 100,28,8
ds_read_b128 a[60:63], v31
s_add_u32 m0, s55, 57792
MAA 96,28,4
buffer_load_dwordx4 v21, s[36:39], s53 offen lds
MAA 112,32,4
MAA 108,32,0
TR 72,25,13440
MAA 92,28,0
TR 74,25,13952
MAA 156,28,16
buffer_load_dwordx4 v28, s[36:39], s53 offen offset:1024 lds
MAA 160,32,16
TR 76,25,13472
MAA 124,0,36
TR 78,25,13984
MAA 140,0,40
TR 80,25,14464
MAA 144,4,40
buffer_load_dword v29, s[36:39], s53 offen offset:2048 lds
MAA 128,4,36
TR 82,25,14976
s_add_u32 s53, s53, 128
MAA 132,8,36
TR 84,25,14496
MAA 148,8,40
TR 86,25,15008
MAA 152,12,40
MAA 136,12,36
s_waitcnt vmcnt(22) lgkmcnt(8)
s_barrier
MAA 60,64,44
RD 0,23,18496
s_add_u32 m0, s56, 73984
MAA 76,68,44
buffer_load_dwordx4 v18, s[20:23], s54 offen lds
MAA 80,68,48
RD 4,23,20800
MAA 64,64,48
RD 8,23,23104
MAA 68,64,52
RD 12,23,25408
MAA 84,68,52
buffer_load_dwordx4 v19, s[20:23], s54 offen offset:1024 lds
MAA 88,68,56
TR 20,25,24832
MAA 72,64,56
TR 22,25,25344
s_waitcnt lgkmcnt(6)
MAA 244,64,60
MAA 104,72,56
buffer_load_dwordx4 v20, s[20:23], s54 offen offset:2048 lds
MAA 120,76,56
TR 24,25,24864
s_add_u32 s54, s54, 196608
MAA 116,76,52
TR 26,25,25376
MAA 100,72,52
RD 16,24,18496
s_add_u32 m0, s55, 0
MAA 96,72,48
buffer_load_dwordx4 v21, s[36:39], s52 offen lds
MAA 112,76,48
TR 28,25,25856
MAA 108,76,44
TR 30,25,26368
MAA 92,72,44
TR 32,25,25888
MAA 156,72,60
buffer_load_dwordx4 v28, s[36:39], s52 offen offset:1024 lds
MAA 160,76,60
MAA 124,44,80
TR 34,25,26400
MAA 140,44,84
TR 36,25,26880
MAA 144,48,84
buffer_load_dword v22, s[36:39], s52 offen offset:2048 lds
MAA 128,48,80
TR 38,25,27392
s_add_u32 s52, s52, 128
MAA 132,52,80
TR 40,25,26912
MAA 148,52,84
TR 42,25,27424
MAA 152,56,84
MAA 136,56,80
s_waitcnt vmcnt(22) lgkmcnt(8)
s_barrier
MAA 60,20,0
RD 44,30,18496
s_add_u32 m0, s56, 86400
MAA 76,24,0
buffer_load_dwordx4 v18, s[20:23], s54 offen lds
MAA 80,24,4
s_sub_u32 s47, s47, 1
s_cbranch_scc1 .Lx10
.Lx10b:
MAA 64,20,4
RD 48,30,20800
MAA 68,20,8
RD 52,30,23104
MAA 84,24,8
buffer_load_dwordx4 v19, s[20:23], s54 offen offset:1024 lds
MAA 88,24,12
RD 56,30,25408
MAA 72,20,12
TR 64,25,37248
s_waitcnt lgkmcnt(5)
MAA 244,20,16
TR 66,25,37760
MAA 104,28,12
buffer_load_dwordx4 v20, s[20:23], s54 offen offset:2048 lds
MAA 120,32,12
TR 68,25,37280
s_add_u32 s54, s54, 196608
MAA 116,32,8
TR 70,25,37792
MAA 100,28,8
RD 60,31,18496
s_add_u32 m0, s55, 2304
MAA 96,28,4
buffer_load_dwordx4 v21, s[36:39], s53 offen lds
MAA 112,32,4
MAA 108,32,0
TR 72,25,38272
MAA 92,28,0
TR 74,25,38784
MAA 156,28,16
buffer_load_dwordx4 v28, s[36:39], s53 offen offset:1024 lds
MAA 160,32,16
TR 76,25,38304
MAA 124,0,36
TR 78,25,38816
MAA 140,0,40
TR 80,25,39296
MAA 144,4,40
buffer_load_dword v29, s[36:39], s53 offen offset:2048 lds
MAA 128,4,36
TR 82,25,39808
s_add_u32 s53, s53, 128
MAA 132,8,36
TR 84,25,39328
MAA 148,8,40
TR 86,25,39840
MAA 152,12,40
MAA 136,12,36
s_waitcnt vmcnt(21) lgkmcnt(8)
s_barrier
MAA 60,64,44
RD 0,23,36992
s_add_u32 m0, s56, 98816
MAA 76,68,44
buffer_load_dwordx4 v18, s[20:23], s54 offen lds
MAA 80,68,48
RD 4,23,39296
MAA 64,64,48
RD 8,23,41600
MAA 68,64,52
RD 12,23,43904
MAA 84,68,52
buffer_load_dwordx4 v19, s[20:23], s54 offen offset:1024 lds
MAA 88,68,56
TR 20,25,49664
MAA 72,64,56
TR 22,25,50176
s_waitcnt lgkmcnt(6)
MAA 244,64,60
MAA 104,72,56
buffer_load_dwordx4 v20, s[20:23], s54 offen offset:2048 lds
MAA 120,76,56
TR 24,25,49696
s_add_u32 s54, s54, 196608
MAA 116,76,52
TR 26,25,50208
MAA 100,72,52
RD 16,24,36992
s_add_u32 m0, s55, 18496
MAA 96,72,48
buffer_load_dwordx4 v21, s[36:39], s52 offen lds
MAA 112,76,48
TR 28,25,50688
MAA 108,76,44
TR 30,25,51200
MAA 92,72,44
TR 32,25,50720
MAA 156,72,60
buffer_load_dwordx4 v28, s[36:39], s52 offen offset:1024 lds
MAA 160,76,60
MAA 124,44,80
TR 34,25,51232
MAA 140,44,84
TR 36,25,51712
MAA 144,48,84
buffer_load_dword v22, s[36:39], s52 offen offset:2048 lds
MAA 128,48,80
TR 38,25,52224
s_add_u32 s52, s52, 128
MAA 132,52,80
TR 40,25,51744
MAA 148,52,84
TR 42,25,52256
MAA 152,56,84
MAA 136,56,80
s_waitcnt vmcnt(21) lgkmcnt(8)
s_barrier
MAA 60,20,0
RD 44,30,36992
s_add_u32 m0, s56, 111232
MAA 76,24,0
buffer_load_dwordx4 v18, s[20:23], s54 offen lds
MAA 80,24,4
s_sub_u32 s47, s47, 1
s_cbranch_scc1 .Lx11
.Lx11b:
MAA 64,20,4
RD 48,30,39296
MAA 68,20,8
buffer_load_dwordx4 v19, s[20:23], s54 offen offset:1024 lds
MAA 84,24,8
RD 52,30,41600
MAA 88,24,12
RD 56,30,43904
MAA 72,20,12
TR 64,25,62080
s_waitcnt lgkmcnt(5)
MAA 244,20,16
buffer_load_dwordx4 v20, s[20:23], s54 offen offset:2048 lds
MAA 104,28,12
TR 66,25,62592
s_add_u32 s54, s54, 196608
MAA 120,32,12
TR 68,25,62112
s_add_u32 m0, s55, 20800
MAA 116,32,8
buffer_load_dwordx4 v21, s[36:39], s53 offen lds
MAA 100,28,8
TR 70,25,62624
MAA 96,28,4
RD 60,31,36992
MAA 112,32,4
TR 72,25,63104
MAA 108,32,0
buffer_load_dwordx4 v28, s[36:39], s53 offen offset:1024 lds
MAA 92,28,0
TR 74,25,63616
MAA 156,28,16
TR 76,25,63136
MAA 160,32,16
buffer_load_dword v29, s[36:39], s53 offen offset:2048 lds
MAA 124,0,36
TR 78,25,63648
s_add_u32 s53, s53, 128
MAA 140,0,40
TR 80,25,64128
MAA 144,4,40
TR 82,25,64640
MAA 128,4,36
buffer_atomic_add v37, v33, s[16:19], 0 offen sc0
MAA 132,8,36
TR 84,25,64160
MAA 148,8,40
TR 86,25,64672
MAA 152,12,40
MAA 136,12,36
s_waitcnt vmcnt(22) lgkmcnt(8)
s_barrier
MAA 60,64,44
RD 0,23,55488
s_add_u32 m0, s56, 123648
MAA 76,68,44
buffer_load_dwordx4 v18, s[20:23], s54 offen lds
MAA 80,68,48
RD 4,23,57792
MAA 64,64,48
RD 8,23,60096
MAA 68,64,52
RD 12,23,62400
MAA 84,68,52
buffer_load_dwordx4 v19, s[20:23], s54 offen offset:1024 lds
MAA 88,68,56
ds_read_b64_tr_b16 a[20:21], v25
MAA 72,64,56
TR 22,25,512
s_waitcnt lgkmcnt(6)
MAA 244,64,60
MAA 104,72,56
buffer_load_dwordx4 v20, s[20:23], s54 offen offset:2048 lds
MAA 120,76,56
TR 24,25,32
s_add_u32 s54, s54, 196608
MAA 116,76,52
TR 26,25,544
MAA 100,72,52
RD 16,24,55488
s_add_u32 m0, s55, 36992
MAA 96,72,48
buffer_load_dwordx4 v21, s[36:39], s52 offen lds
MAA 112,76,48
TR 28,25,1024
MAA 108,76,44
TR 30,25,1536
MAA 92,72,44
TR 32,25,1056
MAA 156,72,60
buffer_load_dwordx4 v28, s[36:39], s52 offen offset:1024 lds
MAA 160,76,60
MAA 124,44,80
TR 34,25,1568
MAA 140,44,84
TR 36,25,2048
MAA 144,48,84
buffer_load_dword v22, s[36:39], s52 offen offset:2048 lds
MAA 128,48,80
TR 38,25,2560
s_add_u32 s52, s52, 128
MAA 132,52,80
TR 40,25,2080
MAA 148,52,84
TR 42,25,2592
MAA 152,56,84
MAA 136,56,80
s_waitcnt vmcnt(22) lgkmcnt(8)
s_barrier
MAA 60,20,0
RD 44,30,55488
s_add_u32 m0, s56, 136064
MAA 76,24,0
buffer_load_dwordx4 v18, s[20:23], s54 offen lds
MAA 80,24,4
s_sub_u32 s47, s47, 1
s_cbranch_scc1 .Lx12
.Lx12b:
MAA 64,20,4
RD 48,30,57792
MAA 68,20,8
RD 52,30,60096
MAA 84,24,8
buffer_load_dwordx4 v19, s[20:23], s54 offen offset:1024 lds
MAA 88,24,12
RD 56,30,62400
MAA 72,20,12
TR 64,25,12416
s_waitcnt lgkmcnt(5)
MAA 244,20,16
TR 66,25,12928
MAA 104,28,12
buffer_load_dwordx4 v20, s[20:23], s54 offen offset:2048 lds
MAA 120,32,12
TR 68,25,12448
s_add_u32 s54, s54, 196608
MAA 116,32,8
TR 70,25,12960
MAA 100,28,8
RD 60,31,55488
s_add_u32 m0, s55, 39296
MAA 96,28,4
buffer_load_dwordx4 v21, s[36:39], s53 offen lds
MAA 112,32,4
MAA 108,32,0
TR 72,25,13440
MAA 92,28,0
TR 74,25,13952
MAA 156,28,16
buffer_load_dwordx4 v28, s[36:39], s53 offen offset:1024 lds
MAA 160,32,16
TR 76,25,13472
MAA 124,0,36
TR 78,25,13984
MAA 140,0,40
TR 80,25,14464
MAA 144,4,40
buffer_load_dword v29, s[36:39], s53 offen offset:2048 lds
MAA 128,4,36
TR 82,25,14976
s_add_u32 s53, s53, 128
MAA 132,8,36
TR 84,25,14496
MAA 148,8,40
TR 86,25,15008
MAA 152,12,40
MAA 136,12,36
s_waitcnt vmcnt(22) lgkmcnt(8)
s_barrier
MAA 60,64,44
ds_read_b128 a[0:3], v23
s_add_u32 m0, s56, 73984
MAA 76,68,44
buffer_load_dwordx4 v18, s[20:23], s54 offen lds
MAA 80,68,48
RD 4,23,2304
MAA 64,64,48
RD 8,23,4608
MAA 68,64,52
RD 12,23,6912
MAA 84,68,52
buffer_load_dwordx4 v19, s[20:23], s54 offen offset:1024 lds
MAA 88,68,56
TR 20,25,24832
MAA 72,64,56
TR 22,25,25344
s_waitcnt lgkmcnt(6)
MAA 244,64,60
MAA 104,72,56
buffer_load_dwordx4 v20, s[20:23], s54 offen offset:2048 lds
MAA 120,76,56
TR 24,25,24864
s_add_u32 s54, s54, 196608
MAA 116,76,52
TR 26,25,25376
MAA 100,72,52
ds_read_b128 a[16:19], v24
s_add_u32 m0, s55, 55488
MAA 96,72,48
buffer_load_dwordx4 v21, s[36:39], s52 offen lds
MAA 112,76,48
TR 28,25,25856
MAA 108,76,44
TR 30,25,26368
MAA 92,72,44
TR 32,25,25888
MAA 156,72,60
buffer_load_dwordx4 v28, s[36:39], s52 offen offset:1024 lds
MAA 160,76,60
MAA 124,44,80
TR 34,25,26400
MAA 140,44,84
TR 36,25,26880
MAA 144,48,84
buffer_load_dword v22, s[36:39], s52 offen offset:2048 lds
MAA 128,48,80
TR 38,25,27392
s_add_u32 s52, s52, 128
MAA 132,52,80
TR 40,25,26912
MAA 148,52,84
TR 42,25,27424
MAA 152,56,84
MAA 136,56,80
s_waitcnt vmcnt(22) lgkmcnt(8)
s_barrier
MAA 60,20,0
ds_read_b128 a[44:47], v30
s_add_u32 m0, s56, 86400
MAA 76,24,0
buffer_load_dwordx4 v18, s[20:23], s54 offen lds
MAA 80,24,4
s_sub_u32 s47, s47, 1
s_cbranch_scc1 .Lx13
.Lx13b:
MAA 64,20,4
RD 48,30,2304
MAA 68,20,8
RD 52,30,4608
MAA 84,24,8
buffer_load_dwordx4 v19, s[20:23], s54 offen offset:1024 lds
MAA 88,24,12
RD 56,30,6912
MAA 72,20,12
TR 64,25,37248
s_waitcnt lgkmcnt(5)
MAA 244,20,16
TR 66,25,37760
MAA 104,28,12
buffer_load_dwordx4 v20, s[20:23], s54 offen offset:2048 lds
MAA 120,32,12
TR 68,25,37280
s_add_u32 s54, s54, 196608
MAA 116,32,8
TR 70,25,37792
MAA 100,28,8
ds_read_b128 a[60:63], v31
s_add_u32 m0, s55, 57792
MAA 96,28,4
buffer_load_dwordx4 v21, s[36:39], s53 offen lds
MAA 112,32,4
MAA 108,32,0
TR 72,25,38272
MAA 92,28,0
TR 74,25,38784
MAA 156,28,16
buffer_load_dwordx4 v28, s[36:39], s53 offen offset:1024 lds
MAA 160,32,16
TR 76,25,38304
MAA 124,0,36
TR 78,25,38816
MAA 140,0,40
TR 80,25,39296
MAA 144,4,40
buffer_load_dword v29, s[36:39], s53 offen offset:2048 lds
MAA 128,4,36
TR 82,25,39808
s_add_u32 s53, s53, 128
MAA 132,8,36
TR 84,25,39328
MAA 148,8,40
TR 86,25,39840
MAA 152,12,40
MAA 136,12,36
s_waitcnt vmcnt(24)
v_cmp_gt_u32 vcc, v36, v37
s_nop 0
s_cbranch_vccnz .Lsp14
.Lsp14b:
s_waitcnt vmcnt(21) lgkmcnt(8)
s_barrier
MAA 60,64,44
RD 0,23,18496
s_add_u32 m0, s56, 98816
MAA 76,68,44
buffer_load_dwordx4 v18, s[20:23], s54 offen lds
MAA 80,68,48
RD 4,23,20800
MAA 64,64,48
RD 8,23,23104
MAA 68,64,52
buffer_load_dwordx4 v19, s[20:23], s54 offen offset:1024 lds
MAA 84,68,52
RD 12,23,25408
MAA 88,68,56
TR 20,25,49664
MAA 72,64,56
TR 22,25,50176
s_waitcnt lgkmcnt(6)
MAA 244,64,60
buffer_load_dwordx4 v20, s[20:23], s54 offen offset:2048 lds
MAA 104,72,56
TR 24,25,49696
s_add_u32 s54, s54, 196608
MAA 120,76,56
TR 26,25,50208
s_add_u32 m0, s55, 0
MAA 116,76,52
buffer_load_dwordx4 v21, s[36:39], s52 offen lds
MAA 100,72,52
RD 16,24,18496
MAA 96,72,48
MAA 112,76,48
TR 28,25,50688
MAA 108,76,44
buffer_load_dwordx4 v28, s[36:39], s52 offen offset:1024 lds
MAA 92,72,44
TR 30,25,51200
MAA 156,72,60
TR 32,25,50720
MAA 160,76,60
buffer_load_dword v22, s[36:39], s52 offen offset:2048 lds
MAA 124,44,80
TR 34,25,51232
s_add_u32 s52, s52, 128
MAA 140,44,84
TR 36,25,51712
MAA 144,48,84
TR 38,25,52224
MAA 128,48,80
buffer_load_dwordx4 v[164:167], v26, s[16:19], s75 offen sc1
MAA 132,52,80
TR 40,25,51744
MAA 148,52,84
TR 42,25,52256
MAA 152,56,84
MAA 136,56,80
s_waitcnt vmcnt(22) lgkmcnt(8)
s_barrier
MAA 60,20,0
RD 44,30,18496
s_add_u32 m0, s56, 111232
MAA 76,24,0
buffer_load_dwordx4 v18, s[20:23], s54 offen lds
MAA 80,24,4
s_sub_u32 s47, s47, 1
s_cbranch_scc1 .Lx15
.Lx15b:
MAA 64,20,4
RD 48,30,20800
MAA 68,20,8
buffer_load_dwordx4 v19, s[20:23], s54 offen offset:1024 lds
MAA 84,24,8
RD 52,30,23104
MAA 88,24,12
RD 56,30,25408
MAA 72,20,12
TR 64,25,62080
s_waitcnt lgkmcnt(5)
MAA 244,20,16
buffer_load_dwordx4 v20, s[20:23], s54 offen offset:2048 lds
MAA 104,28,12
TR 66,25,62592
s_add_u32 s54, s54, 196608
MAA 120,32,12
TR 68,25,62112
s_add_u32 m0, s55, 2304
MAA 116,32,8
buffer_load_dwordx4 v21, s[36:39], s53 offen lds
MAA 100,28,8
TR 70,25,62624
MAA 96,28,4
RD 60,31,18496
MAA 112,32,4
TR 72,25,63104
MAA 108,32,0
buffer_load_dwordx4 v28, s[36:39], s53 offen offset:1024 lds
MAA 92,28,0
TR 74,25,63616
MAA 156,28,16
TR 76,25,63136
MAA 160,32,16
buffer_load_dword v29, s[36:39], s53 offen offset:2048 lds
MAA 124,0,36
TR 78,25,63648
s_add_u32 s53, s53, 128
MAA 140,0,40
TR 80,25,64128
MAA 144,4,40
TR 82,25,64640
MAA 128,4,36
buffer_load_dwordx4 v[168:171], v26, s[16:19], s75 offen offset:1024 sc1
MAA 132,8,36
TR 84,25,64160
MAA 148,8,40
TR 86,25,64672
MAA 152,12,40
MAA 136,12,36
s_waitcnt vmcnt(23) lgkmcnt(8)
s_barrier
MAA 60,64,44
RD 0,23,36992
s_add_u32 m0, s56, 123648
MAA 76,68,44
buffer_load_dwordx4 v18, s[20:23], s54 offen lds
MAA 80,68,48
RD 4,23,39296
MAA 64,64,48
RD 8,23,41600
MAA 68,64,52
buffer_load_dwordx4 v19, s[20:23], s54 offen offset:1024 lds
MAA 84,68,52
RD 12,23,43904
MAA 88,68,56
ds_read_b64_tr_b16 a[20:21], v25
MAA 72,64,56
TR 22,25,512
s_waitcnt lgkmcnt(6)
MAA 244,64,60
buffer_load_dwordx4 v20, s[20:23], s54 offen offset:2048 lds
MAA 104,72,56
TR 24,25,32
s_add_u32 s54, s54, 196608
MAA 120,76,56
TR 26,25,544
s_add_u32 m0, s55, 18496
MAA 116,76,52
buffer_load_dwordx4 v21, s[36:39], s52 offen lds
MAA 100,72,52
RD 16,24,36992
MAA 96,72,48
MAA 112,76,48
TR 28,25,1024
MAA 108,76,44
buffer_load_dwordx4 v28, s[36:39], s52 offen offset:1024 lds
MAA 92,72,44
TR 30,25,1536
MAA 156,72,60
TR 32,25,1056
MAA 160,76,60
buffer_load_dword v22, s[36:39], s52 offen offset:2048 lds
MAA 124,44,80
TR 34,25,1568
s_add_u32 s52, s52, 128
MAA 140,44,84
TR 36,25,2048
MAA 144,48,84
TR 38,25,2560
MAA 128,48,80
buffer_load_dwordx4 v[172:175], v26, s[16:19], s75 offen offset:2048 sc1
MAA 132,52,80
TR 40,25,2080
MAA 148,52,84
TR 42,25,2592
MAA 152,56,84
MAA 136,56,80
s_waitcnt vmcnt(24) lgkmcnt(8)
s_barrier
MAA 60,20,0
RD 44,30,36992
s_add_u32 m0, s56, 136064
MAA 76,24,0
buffer_load_dwordx4 v18, s[20:23], s54 offen lds
MAA 80,24,4
s_sub_u32 s47, s47, 1
s_cbranch_scc1 .Lx16
.Lx16b:
MAA 64,20,4
RD 48,30,39296
MAA 68,20,8
buffer_load_dwordx4 v19, s[20:23], s54 offen offset:1024 lds
MAA 84,24,8
RD 52,30,41600
MAA 88,24,12
RD 56,30,43904
MAA 72,20,12
TR 64,25,12416
s_waitcnt lgkmcnt(5)
MAA 244,20,16
buffer_load_dwordx4 v20, s[20:23], s54 offen offset:2048 lds
MAA 104,28,12
TR 66,25,12928
s_add_u32 s54, s54, 196608
MAA 120,32,12
TR 68,25,12448
s_add_u32 m0, s55, 20800
MAA 116,32,8
buffer_load_dwordx4 v21, s[36:39], s53 offen lds
MAA 100,28,8
TR 70,25,12960
MAA 96,28,4
RD 60,31,36992
MAA 112,32,4
TR 72,25,13440
MAA 108,32,0
buffer_load_dwordx4 v28, s[36:39], s53 offen offset:1024 lds
MAA 92,28,0
TR 74,25,13952
MAA 156,28,16
TR 76,25,13472
MAA 160,32,16
buffer_load_dword v29, s[36:39], s53 offen offset:2048 lds
MAA 124,0,36
TR 78,25,13984
s_add_u32 s53, s53, 128
MAA 140,0,40
TR 80,25,14464
MAA 144,4,40
TR 82,25,14976
MAA 128,4,36
buffer_load_dwordx4 v[176:179], v26, s[16:19], s75 offen offset:3072 sc1
MAA 132,8,36
TR 84,25,14496
s_add_u32 s75, s75, 4096
MAA 148,8,40
TR 86,25,15008
MAA 152,12,40
MAA 136,12,36
s_waitcnt vmcnt(25) lgkmcnt(8)
s_barrier
MAA 60,64,44
RD 0,23,55488
s_add_u32 m0, s56, 73984
MAA 76,68,44
buffer_load_dwordx4 v18, s[20:23], s54 offen lds
MAA 80,68,48
RD 4,23,57792
MAA 64,64,48
RD 8,23,60096
MAA 68,64,52
buffer_load_dwordx4 v19, s[20:23], s54 offen offset:1024 lds
MAA 84,68,52
RD 12,23,62400
MAA 88,68,56
TR 20,25,24832
MAA 72,64,56
TR 22,25,25344
s_waitcnt lgkmcnt(6)
MAA 244,64,60
buffer_load_dwordx4 v20, s[20:23], s54 offen offset:2048 lds
MAA 104,72,56
TR 24,25,24864
s_add_u32 s54, s54, 196608
MAA 120,76,56
TR 26,25,25376
s_add_u32 m0, s55, 36992
MAA 116,76,52
buffer_load_dwordx4 v21, s[36:39], s52 offen lds
MAA 100,72,52
RD 16,24,55488
MAA 96,72,48
MAA 112,76,48
TR 28,25,25856
MAA 108,76,44
buffer_load_dwordx4 v28, s[36:39], s52 offen offset:1024 lds
MAA 92,72,44
TR 30,25,26368
MAA 156,72,60
TR 32,25,25888
MAA 160,76,60
buffer_load_dword v22, s[36:39], s52 offen offset:2048 lds
MAA 124,44,80
TR 34,25,26400
s_add_u32 s52, s52, 128
MAA 140,44,84
TR 36,25,26880
MAA 144,48,84
TR 38,25,27392
MAA 128,48,80
buffer_load_dwordx4 v[180:183], v26, s[16:19], s75 offen sc1
MAA 132,52,80
TR 40,25,26912
MAA 148,52,84
TR 42,25,27424
MAA 152,56,84
MAA 136,56,80
s_waitcnt vmcnt(25) lgkmcnt(8)
s_barrier
MAA 60,20,0
RD 44,30,55488
s_add_u32 m0, s56, 86400
MAA 76,24,0
buffer_load_dwordx4 v18, s[20:23], s54 offen lds
MAA 80,24,4
s_sub_u32 s47, s47, 1
s_cbranch_scc1 .Lx17
.Lx17b:
MAA 64,20,4
RD 48,30,57792
s_waitcnt vmcnt(22)
v_add_f32 v164, v164, v168
MAA 68,20,8
buffer_load_dwordx4 v19, s[20:23], s54 offen offset:1024 lds
MAA 84,24,8
RD 52,30,60096
MAA 88,24,12
RD 56,30,62400
MAA 72,20,12
TR 64,25,37248
s_waitcnt lgkmcnt(5)
MAA 244,20,16
buffer_load_dwordx4 v20, s[20:23], s54 offen offset:2048 lds
MAA 104,28,12
TR 66,25,37760
s_add_u32 s54, s54, 196608
MAA 120,32,12
TR 68,25,37280
s_add_u32 m0, s55, 39296
MAA 116,32,8
buffer_load_dwordx4 v21, s[36:39], s53 offen lds
MAA 100,28,8
TR 70,25,37792
v_add_f32 v165, v165, v169
MAA 96,28,4
RD 60,31,55488
MAA 112,32,4
TR 72,25,38272
MAA 108,32,0
buffer_load_dwordx4 v28, s[36:39], s53 offen offset:1024 lds
MAA 92,28,0
TR 74,25,38784
MAA 156,28,16
TR 76,25,38304
v_add_f32 v166, v166, v170
MAA 160,32,16
buffer_load_dword v29, s[36:39], s53 offen offset:2048 lds
MAA 124,0,36
TR 78,25,38816
s_add_u32 s53, s53, 128
MAA 140,0,40
TR 80,25,39296
MAA 144,4,40
TR 82,25,39808
MAA 128,4,36
buffer_load_dwordx4 v[184:187], v26, s[16:19], s75 offen offset:1024 sc1
MAA 132,8,36
TR 84,25,39328
v_add_f32 v167, v167, v171
MAA 148,8,40
TR 86,25,39840
MAA 152,12,40
MAA 136,12,36
s_waitcnt vmcnt(25) lgkmcnt(8)
s_barrier
MAA 60,64,44
ds_read_b128 a[0:3], v23
s_add_u32 m0, s56, 98816
MAA 76,68,44
buffer_load_dwordx4 v18, s[20:23], s54 offen lds
MAA 80,68,48
RD 4,23,2304
s_waitcnt vmcnt(22)
v_add_f32 v164, v164, v172
MAA 64,64,48
RD 8,23,4608
v_add_f32 v165, v165, v173
MAA 68,64,52
buffer_load_dwordx4 v19, s[20:23], s54 offen offset:1024 lds
MAA 84,68,52
RD 12,23,6912
v_add_f32 v166, v166, v174
MAA 88,68,56
TR 20,25,49664
v_add_f32 v167, v167, v175
MAA 72,64,56
buffer_load_dwordx4 v20, s[20:23], s54 offen offset:2048 lds
s_waitcnt lgkmcnt(5)
MAA 244,64,60
TR 22,25,50176
s_add_u32 s54, s54, 196608
MAA 104,72,56
TR 24,25,49696
s_add_u32 m0, s55, 55488
MAA 120,76,56
buffer_load_dwordx4 v21, s[36:39], s52 offen lds
MAA 116,76,52
TR 26,25,50208
MAA 100,72,52
ds_read_b128 a[16:19], v24
MAA 96,72,48
buffer_load_dwordx4 v28, s[36:39], s52 offen offset:1024 lds
MAA 112,76,48
TR 28,25,50688
MAA 108,76,44
TR 30,25,51200
MAA 92,72,44
buffer_load_dword v22, s[36:39], s52 offen offset:2048 lds
MAA 156,72,60
TR 32,25,50720
s_add_u32 s52, s52, 128
MAA 160,76,60
TR 34,25,51232
MAA 124,44,80
buffer_load_dwordx4 v[188:191], v26, s[16:19], s75 offen offset:2048 sc1
MAA 140,44,84
TR 36,25,51712
MAA 144,48,84
TR 38,25,52224
MAA 128,48,80
TR 40,25,51744
MAA 132,52,80
TR 42,25,52256
MAA 148,52,84
MAA 152,56,84
MAA 136,56,80
s_waitcnt vmcnt(25) lgkmcnt(8)
s_barrier
MAA 60,20,0
ds_read_b128 a[44:47], v30
s_add_u32 m0, s56, 111232
MAA 76,24,0
buffer_load_dwordx4 v18, s[20:23], s54 offen lds
MAA 80,24,4
RD 48,30,2304
s_waitcnt vmcnt(22)
v_add_f32 v164, v164, v176
MAA 64,20,4
RD 52,30,4608
v_add_f32 v165, v165, v177
MAA 68,20,8
buffer_load_dwordx4 v19, s[20:23], s54 offen offset:1024 lds
MAA 84,24,8
RD 56,30,6912
v_add_f32 v166, v166, v178
MAA 88,24,12
TR 64,25,62080
v_add_f32 v167, v167, v179
MAA 72,20,12
buffer_load_dwordx4 v20, s[20:23], s54 offen offset:2048 lds
s_waitcnt lgkmcnt(5)
MAA 244,20,16
TR 66,25,62592
s_add_u32 s54, s54, 196608
MAA 104,28,12
TR 68,25,62112
s_add_u32 m0, s55, 57792
MAA 120,32,12
buffer_load_dwordx4 v21, s[36:39], s53 offen lds
MAA 116,32,8
TR 70,25,62624
MAA 100,28,8
ds_read_b128 a[60:63], v31
MAA 96,28,4
buffer_load_dwordx4 v28, s[36:39], s53 offen offset:1024 lds
MAA 112,32,4
TR 72,25,63104
MAA 108,32,0
TR 74,25,63616
MAA 92,28,0
buffer_load_dword v29, s[36:39], s53 offen offset:2048 lds
MAA 156,28,16
TR 76,25,63136
s_add_u32 s53, s53, 128
MAA 160,32,16
TR 78,25,63648
MAA 124,0,36
buffer_load_dwordx4 v[192:195], v26, s[16:19], s75 offen offset:3072 sc1
MAA 140,0,40
TR 80,25,64128
MAA 144,4,40
TR 82,25,64640
MAA 128,4,36
TR 84,25,64160
MAA 132,8,36
TR 86,25,64672
MAA 148,8,40
MAA 152,12,40
MAA 136,12,36
s_waitcnt vmcnt(25) lgkmcnt(8)
s_barrier
MAA 60,64,44
RD 0,23,18496
s_add_u32 m0, s56, 123648
MAA 76,68,44
buffer_load_dwordx4 v18, s[20:23], s54 offen lds
MAA 80,68,48
RD 4,23,20800
s_waitcnt vmcnt(22)
v_add_f32 v164, v164, v180
MAA 64,64,48
RD 8,23,23104
v_add_f32 v165, v165, v181
MAA 68,64,52
RD 12,23,25408
v_add_f32 v166, v166, v182
MAA 84,68,52
ds_read_b64_tr_b16 a[20:21], v25
v_add_f32 v167, v167, v183
MAA 88,68,56
TR 22,25,512
MAA 72,64,56
TR 24,25,32
s_waitcnt lgkmcnt(7)
MAA 244,64,60
TR 26,25,544
MAA 104,72,56
buffer_load_dwordx4 v19, s[20:23], s54 offen offset:1024 lds
MAA 120,76,56
RD 16,24,18496
MAA 116,76,52
TR 28,25,1024
MAA 100,72,52
TR 30,25,1536
MAA 96,72,48
TR 32,25,1056
MAA 112,76,48
TR 34,25,1568
MAA 108,76,44
TR 36,25,2048
MAA 92,72,44
TR 38,25,2560
MAA 156,72,60
buffer_load_dwordx4 v20, s[20:23], s54 offen offset:2048 lds
MAA 160,76,60
TR 40,25,2080
s_add_u32 s54, s54, 196608
MAA 124,44,80
TR 42,25,2592
MAA 140,44,84
MAA 144,48,84
MAA 128,48,80
MAA 132,52,80
MAA 148,52,84
MAA 152,56,84
MAA 136,56,80
s_waitcnt vmcnt(21) lgkmcnt(8)
s_barrier
MAA 60,20,0
RD 44,30,18496
s_add_u32 m0, s56, 136064
MAA 76,24,0
buffer_load_dwordx4 v18, s[20:23], s54 offen lds
MAA 80,24,4
RD 48,30,20800
s_waitcnt vmcnt(18)
v_add_f32 v164, v164, v184
MAA 64,20,4
RD 52,30,23104
v_add_f32 v165, v165, v185
MAA 68,20,8
RD 56,30,25408
v_add_f32 v166, v166, v186
MAA 84,24,8
TR 64,25,12416
v_add_f32 v167, v167, v187
MAA 88,24,12
TR 66,25,12928
MAA 72,20,12
TR 68,25,12448
s_waitcnt lgkmcnt(7)
MAA 244,20,16
TR 70,25,12960
MAA 104,28,12
buffer_load_dwordx4 v19, s[20:23], s54 offen offset:1024 lds
MAA 120,32,12
RD 60,31,18496
MAA 116,32,8
TR 72,25,13440
MAA 100,28,8
TR 74,25,13952
MAA 96,28,4
TR 76,25,13472
MAA 112,32,4
TR 78,25,13984
MAA 108,32,0
TR 80,25,14464
MAA 92,28,0
TR 82,25,14976
MAA 156,28,16
buffer_load_dwordx4 v20, s[20:23], s54 offen offset:2048 lds
MAA 160,32,16
TR 84,25,14496
s_add_u32 s54, s54, 196608
MAA 124,0,36
TR 86,25,15008
MAA 140,0,40
MAA 144,4,40
MAA 128,4,36
MAA 132,8,36
MAA 148,8,40
MAA 152,12,40
MAA 136,12,36
s_waitcnt vmcnt(17) lgkmcnt(8)
s_barrier
MAA 60,64,44
RD 0,23,36992
s_add_u32 m0, s59, 0
MAA 76,68,44
RD 4,23,39296
s_mov_b32 s58, 1048576
MAA 80,68,48
buffer_load_dwordx4 v5, s[24:27], s58 offen lds
MAA 64,64,48
RD 8,23,41600
s_waitcnt vmcnt(14)
v_add_f32 v164, v164, v188
MAA 68,64,52
RD 12,23,43904
v_add_f32 v165, v165, v189
MAA 84,68,52
TR 20,25,24832
v_add_f32 v166, v166, v190
MAA 88,68,56
buffer_load_dwordx4 v6, s[24:27], s58 offen offset:1024 lds
MAA 72,64,56
TR 22,25,25344
s_add_u32 m0, s59, 8320
s_waitcnt lgkmcnt(6)
MAA 244,64,60
TR 24,25,24864
s_mov_b32 s58, 1179648
MAA 104,72,56
TR 26,25,25376
v_add_f32 v167, v167, v191
MAA 120,76,56
buffer_load_dwordx4 v5, s[24:27], s58 offen lds
MAA 116,76,52
RD 16,24,36992
MAA 100,72,52
TR 28,25,25856
MAA 96,72,48
TR 30,25,26368
MAA 112,76,48
buffer_load_dwordx4 v6, s[24:27], s58 offen offset:1024 lds
MAA 108,76,44
TR 32,25,25888
s_add_u32 m0, s59, 16640
MAA 92,72,44
TR 34,25,26400
s_mov_b32 s58, 1310720
MAA 156,72,60
TR 36,25,26880
MAA 160,76,60
buffer_load_dwordx4 v5, s[24:27], s58 offen lds
MAA 124,44,80
TR 38,25,27392
MAA 140,44,84
TR 40,25,26912
MAA 144,48,84
TR 42,25,27424
MAA 128,48,80
buffer_load_dwordx4 v6, s[24:27], s58 offen offset:1024 lds
MAA 132,52,80
MAA 148,52,84
MAA 152,56,84
MAA 136,56,80
s_waitcnt vmcnt(16) lgkmcnt(8)
s_barrier
MAA 60,20,0
RD 44,30,36992
s_add_u32 m0, s59, 24960
MAA 76,24,0
RD 48,30,39296
s_mov_b32 s58, 1441792
MAA 80,24,4
buffer_load_dwordx4 v5, s[24:27], s58 offen lds
MAA 64,20,4
RD 52,30,41600
s_waitcnt vmcnt(13)
v_add_f32 v164, v164, v192
MAA 68,20,8
RD 56,30,43904
v_add_f32 v165, v165, v193
MAA 84,24,8
TR 64,25,37248
v_add_f32 v166, v166, v194
MAA 88,24,12
buffer_load_dwordx4 v6, s[24:27], s58 offen offset:1024 lds
MAA 72,20,12
TR 66,25,37760
s_add_u32 m0, s59, 74880
s_waitcnt lgkmcnt(6)
MAA 244,20,16
TR 68,25,37280
s_mov_b32 s58, 131072
MAA 104,28,12
TR 70,25,37792
v_add_f32 v167, v167, v195
MAA 120,32,12
buffer_load_dwordx4 v5, s[24:27], s58 offen lds
MAA 116,32,8
RD 60,31,36992
MAA 100,28,8
TR 72,25,38272
MAA 96,28,4
TR 74,25,38784
MAA 112,32,4
buffer_load_dwordx4 v6, s[24:27], s58 offen offset:1024 lds
MAA 108,32,0
TR 76,25,38304
s_add_u32 m0, s59, 83200
MAA 92,28,0
TR 78,25,38816
s_mov_b32 s58, 262144
MAA 156,28,16
TR 80,25,39296
MAA 160,32,16
buffer_load_dwordx4 v5, s[24:27], s58 offen lds
MAA 124,0,36
TR 82,25,39808
MAA 140,0,40
TR 84,25,39328
MAA 144,4,40
TR 86,25,39840
MAA 128,4,36
buffer_load_dwordx4 v6, s[24:27], s58 offen offset:1024 lds
MAA 132,8,36
MAA 148,8,40
MAA 152,12,40
MAA 136,12,36
s_waitcnt vmcnt(15) lgkmcnt(8)
s_barrier
MAA 60,64,44
RD 0,23,55488
s_add_u32 m0, s59, 33280
MAA 76,68,44
RD 4,23,57792
s_mov_b32 s58, 1572864
MAA 80,68,48
buffer_load_dwordx4 v5, s[24:27], s58 offen lds
MAA 64,64,48
RD 8,23,60096
MAA 68,64,52
RD 12,23,62400
MAA 84,68,52
TR 20,25,49664
MAA 88,68,56
buffer_load_dwordx4 v6, s[24:27], s58 offen offset:1024 lds
MAA 72,64,56
TR 22,25,50176
s_add_u32 m0, s59, 41600
s_waitcnt lgkmcnt(6)
MAA 244,64,60
TR 24,25,49696
s_mov_b32 s58, 1703936
MAA 104,72,56
TR 26,25,50208
MAA 120,76,56
buffer_load_dwordx4 v5, s[24:27], s58 offen lds
MAA 116,76,52
RD 16,24,55488
MAA 100,72,52
TR 28,25,50688
MAA 96,72,48
TR 30,25,51200
MAA 112,76,48
buffer_load_dwordx4 v6, s[24:27], s58 offen offset:1024 lds
MAA 108,76,44
TR 32,25,50720
s_add_u32 m0, s59, 91520
MAA 92,72,44
TR 34,25,51232
s_mov_b32 s58, 393216
MAA 156,72,60
TR 36,25,51712
MAA 160,76,60
buffer_load_dwordx4 v5, s[24:27], s58 offen lds
MAA 124,44,80
TR 38,25,52224
MAA 140,44,84
TR 40,25,51744
MAA 144,48,84
TR 42,25,52256
MAA 128,48,80
buffer_load_dwordx4 v6, s[24:27], s58 offen offset:1024 lds
MAA 132,52,80
v_permlane32_swap_b32 v164, v166
MAA 148,52,84
v_permlane32_swap_b32 v165, v167
MAA 152,56,84
v_add_f32 v164, v164, v166
v_add_f32 v165, v165, v167
MAA 136,56,80
v_mul_f32 v164, 0xba800000, v164
v_mul_f32 v165, 0x3a800000, v165
v_fma_f32 v165, -v164, v164, v165
v_max_f32 v165, 0, v165
v_add_f32 v165, 0x3727c5ac, v165
s_waitcnt vmcnt(18) lgkmcnt(8)
s_barrier
MAA 60,20,0
ds_write_b32 v17, v164
s_add_u32 m0, s59, 99840
MAA 76,24,0
RD 44,30,55488
s_mov_b32 s58, 524288
MAA 80,24,4
buffer_load_dwordx4 v5, s[24:27], s58 offen lds
MAA 64,20,4
RD 48,30,57792
MAA 68,20,8
RD 52,30,60096
MAA 84,24,8
RD 56,30,62400
MAA 88,24,12
TR 64,25,62080
MAA 72,20,12
TR 66,25,62592
s_waitcnt lgkmcnt(7)
MAA 244,20,16
buffer_load_dwordx4 v6, s[24:27], s58 offen offset:1024 lds
MAA 104,28,12
TR 68,25,62112
s_add_u32 m0, s59, 108160
MAA 120,32,12
TR 70,25,62624
s_mov_b32 s58, 655360
MAA 116,32,8
RD 60,31,55488
MAA 100,28,8
TR 72,25,63104
MAA 96,28,4
TR 74,25,63616
MAA 112,32,4
buffer_load_dwordx4 v5, s[24:27], s58 offen lds
MAA 108,32,0
TR 76,25,63136
MAA 92,28,0
TR 78,25,63648
MAA 156,28,16
TR 80,25,64128
MAA 160,32,16
TR 82,25,64640
MAA 124,0,36
TR 84,25,64160
MAA 140,0,40
buffer_load_dwordx4 v6, s[24:27], s58 offen offset:1024 lds
MAA 144,4,40
TR 86,25,64672
MAA 128,4,36
v_rsq_f32 v166, v165
MAA 132,8,36
v_mov_b32 v165, v166
v_mul_f32 v166, 0x3e8293ee, v166
MAA 148,8,40
ds_write_b128 v7, v[164:167]
MAA 152,12,40
ds_write_b32 v17, v165 offset:1024
MAA 136,12,36
s_waitcnt lgkmcnt(0)
s_barrier
MAA 244,64,60
ds_read_b128 v[232:235], v10 offset:768
MAA 156,72,60
ds_read_b128 v[236:239], v10 offset:2816
MAA 160,76,60
ds_read_b128 v[228:231], v10 offset:512
MAA 104,72,56
ds_read_b128 v[224:227], v10 offset:256
MAA 120,76,56
ds_read_b128 v[220:223], v10
MAA 136,56,80
MAA 152,56,84
MAA 100,72,52
MAA 116,76,52
s_mov_b32 exec_lo, 0x10001
s_mov_b32 exec_hi, 0x10001
ds_write_b128 v13, v[244:247]
ds_write_b128 v13, v[156:159] offset:256
ds_write_b128 v13, v[160:163] offset:320
s_mov_b64 exec, -1
MAA 96,72,48
MAA 112,76,48
MAA 92,72,44
MAA 108,76,44
MAA 72,64,56
MAA 88,68,56
s_waitcnt lgkmcnt(0)
s_barrier
MAA 132,52,80
ds_read_b128 v[28:31], v13
s_add_u32 m0, s59, 49920
MAA 148,52,84
ds_read_b128 v[32:35], v13 offset:64
s_mov_b32 s58, 1835008
MAA 68,64,52
ds_read_b128 v[36:39], v13 offset:256
MAA 84,68,52
ds_read_b128 v[40:43], v13 offset:320
MAA 128,48,80
ds_read_b32 v44, v12 offset:512
MAA 144,48,84
ds_read_b32 v45, v12 offset:576
MAA 64,64,48
ds_read_b128 v[240:243], v11 offset:192
MAA 80,68,48
ds_read_b128 v[244:247], v11 offset:1216
MAA 124,44,80
buffer_load_dwordx4 v5, s[24:27], s58 offen lds
ds_read_b128 v[18:21], v11 offset:128
s_waitcnt lgkmcnt(8)
v_pk_fma_f32 v[72:73], v[28:29], v[232:233], v[72:73] op_sel_hi:[1,0,1]
v_pk_fma_f32 v[74:75], v[30:31], v[232:233], v[74:75] op_sel_hi:[1,0,1]
s_waitcnt lgkmcnt(6)
v_pk_fma_f32 v[104:105], v[36:37], v[232:233], v[104:105] op_sel_hi:[1,0,1]
v_pk_mul_f32 v[104:105], v[104:105], v[232:233] op_sel:[0,1] op_sel_hi:[1,1]
v_pk_fma_f32 v[106:107], v[38:39], v[232:233], v[106:107] op_sel_hi:[1,0,1]
v_pk_mul_f32 v[106:107], v[106:107], v[232:233] op_sel:[0,1] op_sel_hi:[1,1]
s_waitcnt lgkmcnt(5)
v_pk_fma_f32 v[120:121], v[40:41], v[232:233], v[120:121] op_sel_hi:[1,0,1]
v_pk_mul_f32 v[120:121], v[120:121], v[232:233] op_sel:[0,1] op_sel_hi:[1,1]
v_pk_fma_f32 v[122:123], v[42:43], v[232:233], v[122:123] op_sel_hi:[1,0,1]
v_pk_mul_f32 v[122:123], v[122:123], v[232:233] op_sel:[0,1] op_sel_hi:[1,1]
v_pk_fma_f32 v[100:101], v[36:37], v[228:229], v[100:101] op_sel_hi:[1,0,1]
v_pk_mul_f32 v[100:101], v[100:101], v[228:229] op_sel:[0,1] op_sel_hi:[1,1]
v_pk_fma_f32 v[102:103], v[38:39], v[228:229], v[102:103] op_sel_hi:[1,0,1]
v_pk_mul_f32 v[102:103], v[102:103], v[228:229] op_sel:[0,1] op_sel_hi:[1,1]
v_pk_fma_f32 v[116:117], v[40:41], v[228:229], v[116:117] op_sel_hi:[1,0,1]
v_pk_mul_f32 v[116:117], v[116:117], v[228:229] op_sel:[0,1] op_sel_hi:[1,1]
v_pk_fma_f32 v[118:119], v[42:43], v[228:229], v[118:119] op_sel_hi:[1,0,1]
v_pk_mul_f32 v[118:119], v[118:119], v[228:229] op_sel:[0,1] op_sel_hi:[1,1]
s_waitcnt lgkmcnt(2)
v_pk_fma_f32 v[136:137], v[240:241], v[44:45], v[136:137] op_sel_hi:[1,0,1]
v_pk_fma_f32 v[138:139], v[242:243], v[44:45], v[138:139] op_sel_hi:[1,0,1]
v_pk_fma_f32 v[152:153], v[240:241], v[44:45], v[152:153] op_sel:[0,1,0] op_sel_hi:[1,1,1]
v_pk_fma_f32 v[154:155], v[242:243], v[44:45], v[154:155] op_sel:[0,1,0] op_sel_hi:[1,1,1]
s_waitcnt lgkmcnt(1)
v_pk_mul_f32 v[136:137], v[136:137], v[244:245]
v_pk_mul_f32 v[138:139], v[138:139], v[246:247]
v_pk_mul_f32 v[152:153], v[152:153], v[244:245]
v_pk_mul_f32 v[154:155], v[154:155], v[246:247]
v_pk_fma_f32 v[88:89], v[32:33], v[232:233], v[88:89] op_sel_hi:[1,0,1]
v_pk_fma_f32 v[90:91], v[34:35], v[232:233], v[90:91] op_sel_hi:[1,0,1]
v_pk_fma_f32 v[96:97], v[36:37], v[224:225], v[96:97] op_sel_hi:[1,0,1]
s_waitcnt lgkmcnt(0)
v_pk_fma_f32 v[132:133], v[18:19], v[44:45], v[132:133] op_sel_hi:[1,0,1]
v_pk_fma_f32 v[134:135], v[20:21], v[44:45], v[134:135] op_sel_hi:[1,0,1]
v_pk_fma_f32 v[148:149], v[18:19], v[44:45], v[148:149] op_sel:[0,1,0] op_sel_hi:[1,1,1]
v_pk_fma_f32 v[150:151], v[20:21], v[44:45], v[150:151] op_sel:[0,1,0] op_sel_hi:[1,1,1]
v_pk_mul_f32 v[96:97], v[96:97], v[224:225] op_sel:[0,1] op_sel_hi:[1,1]
v_pk_fma_f32 v[98:99], v[38:39], v[224:225], v[98:99] op_sel_hi:[1,0,1]
v_pk_mul_f32 v[98:99], v[98:99], v[224:225] op_sel:[0,1] op_sel_hi:[1,1]
v_pk_fma_f32 v[112:113], v[40:41], v[224:225], v[112:113] op_sel_hi:[1,0,1]
v_pk_mul_f32 v[112:113], v[112:113], v[224:225] op_sel:[0,1] op_sel_hi:[1,1]
v_pk_fma_f32 v[114:115], v[42:43], v[224:225], v[114:115] op_sel_hi:[1,0,1]
v_pk_mul_f32 v[114:115], v[114:115], v[224:225] op_sel:[0,1] op_sel_hi:[1,1]
v_pk_fma_f32 v[68:69], v[28:29], v[228:229], v[68:69] op_sel_hi:[1,0,1]
v_pk_fma_f32 v[70:71], v[30:31], v[228:229], v[70:71] op_sel_hi:[1,0,1]
v_pk_fma_f32 v[84:85], v[32:33], v[228:229], v[84:85] op_sel_hi:[1,0,1]
v_pk_fma_f32 v[86:87], v[34:35], v[228:229], v[86:87] op_sel_hi:[1,0,1]
v_pk_fma_f32 v[92:93], v[36:37], v[220:221], v[92:93] op_sel_hi:[1,0,1]
v_pk_mul_f32 v[92:93], v[92:93], v[220:221] op_sel:[0,1] op_sel_hi:[1,1]
v_pk_fma_f32 v[94:95], v[38:39], v[220:221], v[94:95] op_sel_hi:[1,0,1]
v_pk_mul_f32 v[94:95], v[94:95], v[220:221] op_sel:[0,1] op_sel_hi:[1,1]
v_pk_fma_f32 v[108:109], v[40:41], v[220:221], v[108:109] op_sel_hi:[1,0,1]
v_pk_mul_f32 v[108:109], v[108:109], v[220:221] op_sel:[0,1] op_sel_hi:[1,1]
v_pk_fma_f32 v[110:111], v[42:43], v[220:221], v[110:111] op_sel_hi:[1,0,1]
v_pk_mul_f32 v[110:111], v[110:111], v[220:221] op_sel:[0,1] op_sel_hi:[1,1]
v_pk_fma_f32 v[64:65], v[28:29], v[224:225], v[64:65] op_sel_hi:[1,0,1]
v_pk_fma_f32 v[66:67], v[30:31], v[224:225], v[66:67] op_sel_hi:[1,0,1]
v_pk_fma_f32 v[80:81], v[32:33], v[224:225], v[80:81] op_sel_hi:[1,0,1]
v_pk_fma_f32 v[82:83], v[34:35], v[224:225], v[82:83] op_sel_hi:[1,0,1]
v_pk_fma_f32 v[156:157], v[36:37], v[236:237], v[156:157] op_sel_hi:[1,0,1]
v_pk_mul_f32 v[156:157], v[156:157], v[236:237] op_sel:[0,1] op_sel_hi:[1,1]
v_pk_fma_f32 v[158:159], v[38:39], v[236:237], v[158:159] op_sel_hi:[1,0,1]
v_pk_mul_f32 v[158:159], v[158:159], v[236:237] op_sel:[0,1] op_sel_hi:[1,1]
v_pk_fma_f32 v[160:161], v[40:41], v[236:237], v[160:161] op_sel_hi:[1,0,1]
v_pk_mul_f32 v[160:161], v[160:161], v[236:237] op_sel:[0,1] op_sel_hi:[1,1]
v_pk_fma_f32 v[162:163], v[42:43], v[236:237], v[162:163] op_sel_hi:[1,0,1]
v_pk_mul_f32 v[162:163], v[162:163], v[236:237] op_sel:[0,1] op_sel_hi:[1,1]
v_cvt_pk_bf16_f32 v196, v104, v105
v_cvt_pk_bf16_f32 v197, v106, v107
MAA 140,44,84
buffer_load_dwordx4 v6, s[24:27], s58 offen offset:1024 lds
MAA 60,64,44
ds_read_b128 v[22:25], v11 offset:1152
v_cvt_pk_bf16_f32 v198, v120, v121
MAA 76,68,44
ds_read_b128 v[240:243], v11 offset:64
v_cvt_pk_bf16_f32 v199, v122, v123
v_cvt_pk_bf16_f32 v208, v136, v137
v_cvt_pk_bf16_f32 v209, v138, v139
v_cvt_pk_bf16_f32 v218, v152, v153
v_cvt_pk_bf16_f32 v219, v154, v155
ds_write_b128 v8, v[196:199]
ds_write_b64 v8, v[208:209] offset:1024
ds_write_b64 v8, v[218:219] offset:1032
s_add_u32 m0, s59, 58240
s_mov_b32 s58, 1966080
buffer_load_dwordx4 v5, s[24:27], s58 offen lds
v_cvt_pk_bf16_f32 v192, v100, v101
v_cvt_pk_bf16_f32 v193, v102, v103
v_cvt_pk_bf16_f32 v194, v116, v117
v_cvt_pk_bf16_f32 v195, v118, v119
v_cvt_pk_bf16_f32 v176, v72, v73
v_cvt_pk_bf16_f32 v177, v74, v75
v_cvt_pk_bf16_f32 v178, v88, v89
v_cvt_pk_bf16_f32 v179, v90, v91
v_pk_fma_f32 v[60:61], v[28:29], v[220:221], v[60:61] op_sel_hi:[1,0,1]
v_pk_fma_f32 v[62:63], v[30:31], v[220:221], v[62:63] op_sel_hi:[1,0,1]
s_waitcnt lgkmcnt(4)
v_pk_mul_f32 v[132:133], v[132:133], v[22:23]
v_pk_mul_f32 v[134:135], v[134:135], v[24:25]
v_pk_mul_f32 v[148:149], v[148:149], v[22:23]
v_pk_mul_f32 v[150:151], v[150:151], v[24:25]
s_waitcnt lgkmcnt(3)
v_pk_fma_f32 v[128:129], v[240:241], v[44:45], v[128:129] op_sel_hi:[1,0,1]
v_pk_fma_f32 v[130:131], v[242:243], v[44:45], v[130:131] op_sel_hi:[1,0,1]
v_pk_fma_f32 v[144:145], v[240:241], v[44:45], v[144:145] op_sel:[0,1,0] op_sel_hi:[1,1,1]
v_pk_fma_f32 v[146:147], v[242:243], v[44:45], v[146:147] op_sel:[0,1,0] op_sel_hi:[1,1,1]
v_pk_fma_f32 v[76:77], v[32:33], v[220:221], v[76:77] op_sel_hi:[1,0,1]
v_pk_fma_f32 v[78:79], v[34:35], v[220:221], v[78:79] op_sel_hi:[1,0,1]
v_cvt_pk_bf16_f32 v206, v132, v133
v_cvt_pk_bf16_f32 v207, v134, v135
v_mfma_f32_16x16x32_bf16 v[104:107], v[192:195], v[176:179], v[46:49]
buffer_load_dwordx4 v6, s[24:27], s58 offen offset:1024 lds
v_mfma_f32_16x16x32_bf16 v[120:123], v[196:199], v[176:179], v[50:53]
s_waitcnt lgkmcnt(0)
s_barrier
ds_read_b64 v[200:201], v9 offset:1024
ds_read_b64 v[210:211], v9 offset:1032
s_add_u32 m0, s59, 66560
s_mov_b32 s58, 0
v_cvt_pk_bf16_f32 v216, v148, v149
v_cvt_pk_bf16_f32 v217, v150, v151
v_max3_f32 v88, v104, v105, v106
v_max3_f32 v89, v107, v120, v121
v_max3_f32 v88, v88, v122, v123
buffer_load_dwordx4 v5, s[24:27], s58 offen lds
v_max_f32 v90, v88, v89
v_max_f32 v89, v88, v89
v_cvt_pk_bf16_f32 v188, v96, v97
v_cvt_pk_bf16_f32 v189, v98, v99
v_permlane16_swap_b32 v90, v89
v_cvt_pk_bf16_f32 v190, v112, v113
v_max_f32 v88, v90, v89
v_max_f32 v89, v90, v89
v_cvt_pk_bf16_f32 v191, v114, v115
v_cvt_pk_bf16_f32 v172, v68, v69
v_permlane32_swap_b32 v88, v89
v_cvt_pk_bf16_f32 v173, v70, v71
buffer_load_dwordx4 v6, s[24:27], s58 offen offset:1024 lds
s_add_u32 m0, s59, 116480
s_mov_b32 s58, 786432
v_max_f32 v88, v88, v89
v_mul_f32 v88, v88, v234
v_pk_fma_f32 v[104:105], v[104:105], v[234:235], v[88:89] op_sel_hi:[1,0,0] neg_lo:[0,0,1] neg_hi:[0,0,1]
v_pk_fma_f32 v[106:107], v[106:107], v[234:235], v[88:89] op_sel_hi:[1,0,0] neg_lo:[0,0,1] neg_hi:[0,0,1]
v_pk_fma_f32 v[120:121], v[120:121], v[234:235], v[88:89] op_sel_hi:[1,0,0] neg_lo:[0,0,1] neg_hi:[0,0,1]
v_pk_fma_f32 v[122:123], v[122:123], v[234:235], v[88:89] op_sel_hi:[1,0,0] neg_lo:[0,0,1] neg_hi:[0,0,1]
v_exp_f32 v104, v104
v_exp_f32 v105, v105
v_exp_f32 v106, v106
v_exp_f32 v107, v107
v_exp_f32 v120, v120
v_exp_f32 v121, v121
v_exp_f32 v122, v122
v_exp_f32 v123, v123
v_cvt_pk_bf16_f32 v72, v104, v105
buffer_load_dwordx4 v5, s[24:27], s58 offen lds
v_cvt_pk_bf16_f32 v73, v106, v107
v_cvt_pk_bf16_f32 v74, v120, v121
v_cvt_pk_bf16_f32 v75, v122, v123
v_cvt_pk_bf16_f32 v174, v84, v85
v_cvt_pk_bf16_f32 v175, v86, v87
v_mfma_f32_16x16x32_bf16 v[88:91], v[248:251], v[72:75], 0
ds_read_b128 v[244:247], v11 offset:1088
v_cvt_pk_bf16_f32 v184, v92, v93
v_mfma_f32_16x16x32_bf16 v[104:107], v[206:209], v[72:75], 0
ds_read_b128 v[18:21], v11
v_cvt_pk_bf16_f32 v185, v94, v95
v_mfma_f32_16x16x32_bf16 v[120:123], v[216:219], v[72:75], 0
buffer_load_dwordx4 v6, s[24:27], s58 offen offset:1024 lds
v_mfma_f32_16x16x32_bf16 v[100:103], v[188:191], v[172:175], v[46:49]
ds_read_b128 v[22:25], v11 offset:1024
s_add_u32 m0, s59, 124800
v_mfma_f32_16x16x32_bf16 v[116:119], v[192:195], v[172:175], v[50:53]
s_mov_b32 s58, 917504
v_rcp_f32 v88, v88
v_cvt_pk_bf16_f32 v186, v108, v109
s_nop 1
v_max3_f32 v84, v100, v101, v102
v_cvt_pk_bf16_f32 v187, v110, v111
v_pk_mul_f32 v[104:105], v[104:105], v[88:89] op_sel_hi:[1,0]
v_pk_mul_f32 v[106:107], v[106:107], v[88:89] op_sel_hi:[1,0]
buffer_load_dwordx4 v5, s[24:27], s58 offen lds
v_pk_mul_f32 v[120:121], v[120:121], v[88:89] op_sel_hi:[1,0]
v_pk_mul_f32 v[122:123], v[122:123], v[88:89] op_sel_hi:[1,0]
v_cvt_pk_bf16_f32 v176, v104, v105
v_cvt_pk_bf16_f32 v177, v106, v107
v_cvt_pk_bf16_f32 v178, v120, v121
v_cvt_pk_bf16_f32 v179, v122, v123
s_waitcnt lgkmcnt(2)
v_pk_mul_f32 v[128:129], v[128:129], v[244:245]
v_cvt_pk_bf16_f32 v204, v128, v129
v_pk_mul_f32 v[130:131], v[130:131], v[246:247]
v_cvt_pk_bf16_f32 v205, v130, v131
v_pk_mul_f32 v[144:145], v[144:145], v[244:245]
v_cvt_pk_bf16_f32 v214, v144, v145
v_pk_mul_f32 v[146:147], v[146:147], v[246:247]
buffer_load_dwordx4 v6, s[24:27], s58 offen offset:1024 lds
v_cvt_pk_bf16_f32 v215, v146, v147
v_max3_f32 v85, v103, v116, v117
v_max3_f32 v84, v84, v118, v119
v_max_f32 v86, v84, v85
v_max_f32 v85, v84, v85
v_cvt_pk_bf16_f32 v168, v64, v65
v_cvt_pk_bf16_f32 v169, v66, v67
v_permlane16_swap_b32 v86, v85
v_cvt_pk_bf16_f32 v170, v80, v81
v_max_f32 v84, v86, v85
v_max_f32 v85, v86, v85
v_cvt_pk_bf16_f32 v171, v82, v83
s_waitcnt lgkmcnt(1)
v_pk_fma_f32 v[124:125], v[18:19], v[44:45], v[124:125] op_sel_hi:[1,0,1]
s_waitcnt lgkmcnt(0)
v_pk_mul_f32 v[124:125], v[124:125], v[22:23]
v_pk_fma_f32 v[126:127], v[20:21], v[44:45], v[126:127] op_sel_hi:[1,0,1]
v_pk_mul_f32 v[126:127], v[126:127], v[24:25]
v_pk_fma_f32 v[140:141], v[18:19], v[44:45], v[140:141] op_sel:[0,1,0] op_sel_hi:[1,1,1]
v_pk_mul_f32 v[140:141], v[140:141], v[22:23]
v_pk_fma_f32 v[142:143], v[20:21], v[44:45], v[142:143] op_sel:[0,1,0] op_sel_hi:[1,1,1]
v_pk_mul_f32 v[142:143], v[142:143], v[24:25]
v_permlane32_swap_b32 v84, v85
s_nop 0
v_mfma_f32_16x16x32_bf16 v[96:99], v[184:187], v[168:171], v[46:49]
buffer_store_dwordx4 v[176:179], v4, s[16:19], s74 offen offset:3072 sc1
v_mfma_f32_16x16x32_bf16 v[112:115], v[188:191], v[168:171], v[50:53]
v_max_f32 v84, v84, v85
v_mul_f32 v84, v84, v230
v_cvt_pk_bf16_f32 v202, v124, v125
v_cvt_pk_bf16_f32 v203, v126, v127
v_cvt_pk_bf16_f32 v212, v140, v141
v_pk_fma_f32 v[100:101], v[100:101], v[230:231], v[84:85] op_sel_hi:[1,0,0] neg_lo:[0,0,1] neg_hi:[0,0,1]
v_pk_fma_f32 v[102:103], v[102:103], v[230:231], v[84:85] op_sel_hi:[1,0,0] neg_lo:[0,0,1] neg_hi:[0,0,1]
v_pk_fma_f32 v[116:117], v[116:117], v[230:231], v[84:85] op_sel_hi:[1,0,0] neg_lo:[0,0,1] neg_hi:[0,0,1]
v_pk_fma_f32 v[118:119], v[118:119], v[230:231], v[84:85] op_sel_hi:[1,0,0] neg_lo:[0,0,1] neg_hi:[0,0,1]
v_exp_f32 v100, v100
v_exp_f32 v101, v101
v_exp_f32 v102, v102
v_exp_f32 v103, v103
v_exp_f32 v116, v116
v_exp_f32 v117, v117
v_exp_f32 v118, v118
v_exp_f32 v119, v119
v_cvt_pk_bf16_f32 v68, v100, v101
v_cvt_pk_bf16_f32 v69, v102, v103
v_cvt_pk_bf16_f32 v70, v116, v117
v_cvt_pk_bf16_f32 v71, v118, v119
v_cvt_pk_bf16_f32 v213, v142, v143
v_max3_f32 v80, v96, v97, v98
v_mfma_f32_16x16x32_bf16 v[84:87], v[248:251], v[68:71], 0
v_max3_f32 v81, v99, v112, v113
v_max3_f32 v80, v80, v114, v115
v_mfma_f32_16x16x32_bf16 v[100:103], v[204:207], v[68:71], 0
v_max_f32 v82, v80, v81
v_max_f32 v81, v80, v81
v_mfma_f32_16x16x32_bf16 v[116:119], v[214:217], v[68:71], 0
s_nop 1
v_rcp_f32 v84, v84
v_permlane16_swap_b32 v82, v81
v_cvt_pk_bf16_f32 v180, v156, v157
v_pk_mul_f32 v[100:101], v[100:101], v[84:85] op_sel_hi:[1,0]
v_pk_mul_f32 v[102:103], v[102:103], v[84:85] op_sel_hi:[1,0]
s_nop 0
v_pk_mul_f32 v[116:117], v[116:117], v[84:85] op_sel_hi:[1,0]
v_pk_mul_f32 v[118:119], v[118:119], v[84:85] op_sel_hi:[1,0]
v_cvt_pk_bf16_f32 v172, v100, v101
v_cvt_pk_bf16_f32 v173, v102, v103
v_cvt_pk_bf16_f32 v174, v116, v117
v_cvt_pk_bf16_f32 v175, v118, v119
buffer_store_dwordx4 v[172:175], v4, s[16:19], s74 offen offset:2048 sc1
v_max_f32 v80, v82, v81
v_max_f32 v81, v82, v81
v_cvt_pk_bf16_f32 v181, v158, v159
v_cvt_pk_bf16_f32 v182, v160, v161
v_permlane32_swap_b32 v80, v81
v_cvt_pk_bf16_f32 v183, v162, v163
v_max_f32 v80, v80, v81
v_mul_f32 v80, v80, v226
v_pk_fma_f32 v[96:97], v[96:97], v[226:227], v[80:81] op_sel_hi:[1,0,0] neg_lo:[0,0,1] neg_hi:[0,0,1]
v_pk_fma_f32 v[98:99], v[98:99], v[226:227], v[80:81] op_sel_hi:[1,0,0] neg_lo:[0,0,1] neg_hi:[0,0,1]
v_pk_fma_f32 v[112:113], v[112:113], v[226:227], v[80:81] op_sel_hi:[1,0,0] neg_lo:[0,0,1] neg_hi:[0,0,1]
v_pk_fma_f32 v[114:115], v[114:115], v[226:227], v[80:81] op_sel_hi:[1,0,0] neg_lo:[0,0,1] neg_hi:[0,0,1]
v_exp_f32 v96, v96
v_exp_f32 v97, v97
v_exp_f32 v98, v98
v_exp_f32 v99, v99
v_exp_f32 v112, v112
v_exp_f32 v113, v113
v_exp_f32 v114, v114
v_exp_f32 v115, v115
v_cvt_pk_bf16_f32 v64, v96, v97
v_cvt_pk_bf16_f32 v65, v98, v99
v_cvt_pk_bf16_f32 v66, v112, v113
v_cvt_pk_bf16_f32 v67, v114, v115
v_cvt_pk_bf16_f32 v164, v60, v61
v_cvt_pk_bf16_f32 v165, v62, v63
v_mfma_f32_16x16x32_bf16 v[80:83], v[248:251], v[64:67], 0
v_cvt_pk_bf16_f32 v166, v76, v77
v_cvt_pk_bf16_f32 v167, v78, v79
v_mfma_f32_16x16x32_bf16 v[96:99], v[202:205], v[64:67], 0
v_mfma_f32_16x16x32_bf16 v[112:115], v[212:215], v[64:67], 0
s_nop 3
v_rcp_f32 v80, v80
v_mfma_f32_16x16x32_bf16 v[92:95], v[180:183], v[164:167], v[54:57]
v_mfma_f32_16x16x32_bf16 v[108:111], v[184:187], v[164:167], v[50:53]
s_nop 6
v_max3_f32 v76, v92, v93, v94
v_pk_mul_f32 v[96:97], v[96:97], v[80:81] op_sel_hi:[1,0]
v_pk_mul_f32 v[98:99], v[98:99], v[80:81] op_sel_hi:[1,0]
v_pk_mul_f32 v[112:113], v[112:113], v[80:81] op_sel_hi:[1,0]
v_pk_mul_f32 v[114:115], v[114:115], v[80:81] op_sel_hi:[1,0]
v_cvt_pk_bf16_f32 v168, v96, v97
v_cvt_pk_bf16_f32 v169, v98, v99
v_cvt_pk_bf16_f32 v170, v112, v113
v_cvt_pk_bf16_f32 v171, v114, v115
buffer_store_dwordx4 v[168:171], v4, s[16:19], s74 offen offset:1024 sc1
v_max3_f32 v77, v95, v108, v109
v_max3_f32 v76, v76, v110, v111
v_max_f32 v78, v76, v77
v_max_f32 v77, v76, v77
s_nop 1
v_permlane16_swap_b32 v78, v77
v_max_f32 v76, v78, v77
v_max_f32 v77, v78, v77
s_nop 1
v_permlane32_swap_b32 v76, v77
v_max_f32 v76, v76, v77
v_mul_f32 v76, v76, v222
v_pk_fma_f32 v[92:93], v[92:93], v[222:223], v[76:77] op_sel_hi:[1,0,0] neg_lo:[0,0,1] neg_hi:[0,0,1]
v_pk_fma_f32 v[94:95], v[94:95], v[222:223], v[76:77] op_sel_hi:[1,0,0] neg_lo:[0,0,1] neg_hi:[0,0,1]
v_pk_fma_f32 v[108:109], v[108:109], v[222:223], v[76:77] op_sel_hi:[1,0,0] neg_lo:[0,0,1] neg_hi:[0,0,1]
v_pk_fma_f32 v[110:111], v[110:111], v[222:223], v[76:77] op_sel_hi:[1,0,0] neg_lo:[0,0,1] neg_hi:[0,0,1]
v_exp_f32 v92, v92
v_exp_f32 v93, v93
v_exp_f32 v94, v94
v_exp_f32 v95, v95
v_exp_f32 v108, v108
v_exp_f32 v109, v109
v_exp_f32 v110, v110
v_exp_f32 v111, v111
v_cvt_pk_bf16_f32 v60, v92, v93
v_cvt_pk_bf16_f32 v61, v94, v95
v_cvt_pk_bf16_f32 v62, v108, v109
v_cvt_pk_bf16_f32 v63, v110, v111
s_nop 1
v_mfma_f32_16x16x32_bf16 v[76:79], v[248:251], v[60:63], 0
v_mfma_f32_16x16x32_bf16 v[92:95], v[200:203], v[60:63], 0
v_mfma_f32_16x16x32_bf16 v[108:111], v[210:213], v[60:63], 0
s_nop 5
v_rcp_f32 v76, v76
s_nop 0
v_pk_mul_f32 v[92:93], v[92:93], v[76:77] op_sel_hi:[1,0]
v_pk_mul_f32 v[94:95], v[94:95], v[76:77] op_sel_hi:[1,0]
v_pk_mul_f32 v[108:109], v[108:109], v[76:77] op_sel_hi:[1,0]
v_pk_mul_f32 v[110:111], v[110:111], v[76:77] op_sel_hi:[1,0]
v_cvt_pk_bf16_f32 v164, v92, v93
v_cvt_pk_bf16_f32 v165, v94, v95
v_cvt_pk_bf16_f32 v166, v108, v109
v_cvt_pk_bf16_f32 v167, v110, v111
buffer_store_dwordx4 v[164:167], v4, s[16:19], s74 offen sc1
s_nop 1
s_branch .Lqkve3
.Lx4:
buffer_load_dword v27, v14, s[76:79], 0 offen
s_mov_b32 s76, s98
s_mov_b32 s77, s99
s_mov_b32 s78, s100
v_mov_b32 v14, v15
s_mov_b32 s47, 5
s_branch .Lx4b
.Lx5:
buffer_load_dword v27, v14, s[76:79], 0 offen
s_mov_b32 s76, s98
s_mov_b32 s77, s99
s_mov_b32 s78, s100
v_mov_b32 v14, v15
s_mov_b32 s47, 5
s_branch .Lx5b
.Lx6:
buffer_load_dword v27, v14, s[76:79], 0 offen
s_mov_b32 s76, s98
s_mov_b32 s77, s99
s_mov_b32 s78, s100
v_mov_b32 v14, v15
s_mov_b32 s47, 5
s_branch .Lx6b
.Lx7:
buffer_load_dword v27, v14, s[76:79], 0 offen
s_mov_b32 s76, s98
s_mov_b32 s77, s99
s_mov_b32 s78, s100
v_mov_b32 v14, v15
s_mov_b32 s47, 5
s_branch .Lx7b
.Lsp8:
s_mov_b32 s15, 0
.Lsp8l:
v_mov_b32 v37, 0
buffer_atomic_add v37, v34, s[40:43], 0 offen sc0
s_add_u32 s15, s15, 1
s_cmp_gt_u32 s15, 100000
s_waitcnt vmcnt(0)
s_cbranch_scc1 .Lsp8b
v_cmp_gt_u32 vcc, v35, v37
s_nop 0
s_cbranch_vccnz .Lsp8l
s_branch .Lsp8b
.Lx9:
buffer_load_dword v27, v14, s[76:79], 0 offen
s_mov_b32 s76, s98
s_mov_b32 s77, s99
s_mov_b32 s78, s100
v_mov_b32 v14, v15
s_mov_b32 s47, 5
s_branch .Lx9b
.Lx10:
buffer_load_dword v27, v14, s[76:79], 0 offen
s_mov_b32 s76, s98
s_mov_b32 s77, s99
s_mov_b32 s78, s100
v_mov_b32 v14, v15
s_mov_b32 s47, 5
s_branch .Lx10b
.Lx11:
buffer_load_dword v27, v14, s[76:79], 0 offen
s_mov_b32 s76, s98
s_mov_b32 s77, s99
s_mov_b32 s78, s100
v_mov_b32 v14, v15
s_mov_b32 s47, 5
s_branch .Lx11b
.Lx12:
buffer_load_dword v27, v14, s[76:79], 0 offen
s_mov_b32 s76, s98
s_mov_b32 s77, s99
s_mov_b32 s78, s100
v_mov_b32 v14, v15
s_mov_b32 s47, 5
s_branch .Lx12b
.Lx13:
buffer_load_dword v27, v14, s[76:79], 0 offen
s_mov_b32 s76, s98
s_mov_b32 s77, s99
s_mov_b32 s78, s100
v_mov_b32 v14, v15
s_mov_b32 s47, 5
s_branch .Lx13b
.Lsp14:
s_mov_b32 s15, 0
.Lsp14l:
v_mov_b32 v37, 0
buffer_atomic_add v37, v33, s[16:19], 0 offen sc0
s_add_u32 s15, s15, 1
s_cmp_gt_u32 s15, 100000
s_waitcnt vmcnt(0)
s_cbranch_scc1 .Lsp14b
v_cmp_gt_u32 vcc, v36, v37
s_nop 0
s_cbranch_vccnz .Lsp14l
s_branch .Lsp14b
.Lx15:
buffer_load_dword v27, v14, s[76:79], 0 offen
s_mov_b32 s76, s98
s_mov_b32 s77, s99
s_mov_b32 s78, s100
v_mov_b32 v14, v15
s_mov_b32 s47, 5
s_branch .Lx15b
.Lx16:
buffer_load_dword v27, v14, s[76:79], 0 offen
s_mov_b32 s76, s98
s_mov_b32 s77, s99
s_mov_b32 s78, s100
v_mov_b32 v14, v15
s_mov_b32 s47, 5
s_branch .Lx16b
.Lx17:
buffer_load_dword v27, v14, s[76:79], 0 offen
s_mov_b32 s76, s98
s_mov_b32 s77, s99
s_mov_b32 s78, s100
v_mov_b32 v14, v15
s_mov_b32 s47, 5
s_branch .Lx17b
.Lx18:
buffer_load_dword v27, v14, s[76:79], 0 offen
s_mov_b32 s76, s98
s_mov_b32 s77, s99
s_mov_b32 s78, s100
v_mov_b32 v14, v15
s_mov_b32 s47, 5
s_branch .Lx18b
.Lx19:
buffer_load_dword v27, v14, s[76:79], 0 offen
s_mov_b32 s76, s98
s_mov_b32 s77, s99
s_mov_b32 s78, s100
v_mov_b32 v14, v15
s_mov_b32 s47, 5
s_branch .Lx19b
.Lx20:
buffer_load_dword v27, v14, s[76:79], 0 offen
s_mov_b32 s76, s98
s_mov_b32 s77, s99
s_mov_b32 s78, s100
v_mov_b32 v14, v15
s_mov_b32 s47, 5
s_branch .Lx20b
.Lx21:
buffer_load_dword v27, v14, s[76:79], 0 offen
s_mov_b32 s76, s98
s_mov_b32 s77, s99
s_mov_b32 s78, s100
v_mov_b32 v14, v15
s_mov_b32 s47, 5
s_branch .Lx21b
.Lsp22:
s_mov_b32 s15, 0
.Lsp22l:
v_mov_b32 v37, 0
buffer_atomic_add v37, v34, s[40:43], 0 offen sc0
s_add_u32 s15, s15, 1
s_cmp_gt_u32 s15, 100000
s_waitcnt vmcnt(0)
s_cbranch_scc1 .Lsp22b
v_cmp_gt_u32 vcc, v35, v37
s_nop 0
s_cbranch_vccnz .Lsp22l
s_branch .Lsp22b
.Lx23:
buffer_load_dword v27, v14, s[76:79], 0 offen
s_mov_b32 s76, s98
s_mov_b32 s77, s99
s_mov_b32 s78, s100
v_mov_b32 v14, v15
s_mov_b32 s47, 5
s_branch .Lx23b
.Lx24:
buffer_load_dword v27, v14, s[76:79], 0 offen
s_mov_b32 s76, s98
s_mov_b32 s77, s99
s_mov_b32 s78, s100
v_mov_b32 v14, v15
s_mov_b32 s47, 5
s_branch .Lx24b
.Lx25:
buffer_load_dword v27, v14, s[76:79], 0 offen
s_mov_b32 s76, s98
s_mov_b32 s77, s99
s_mov_b32 s78, s100
v_mov_b32 v14, v15
s_mov_b32 s47, 5
s_branch .Lx25b
.Lx26:
buffer_load_dword v27, v14, s[76:79], 0 offen
s_mov_b32 s76, s98
s_mov_b32 s77, s99
s_mov_b32 s78, s100
v_mov_b32 v14, v15
s_mov_b32 s47, 5
s_branch .Lx26b
.Lx27:
buffer_load_dword v27, v14, s[76:79], 0 offen
s_mov_b32 s76, s98
s_mov_b32 s77, s99
s_mov_b32 s78, s100
v_mov_b32 v14, v15
s_mov_b32 s47, 5
s_branch .Lx27b
.Lsp28:
s_mov_b32 s15, 0
.Lsp28l:
v_mov_b32 v37, 0
buffer_atomic_add v37, v33, s[16:19], 0 offen sc0
s_add_u32 s15, s15, 1
s_cmp_gt_u32 s15, 100000
s_waitcnt vmcnt(0)
s_cbranch_scc1 .Lsp28b
v_cmp_gt_u32 vcc, v36, v37
s_nop 0
s_cbranch_vccnz .Lsp28l
s_branch .Lsp28b
.Lx29:
buffer_load_dword v27, v14, s[76:79], 0 offen
s_mov_b32 s76, s98
s_mov_b32 s77, s99
s_mov_b32 s78, s100
v_mov_b32 v14, v15
s_mov_b32 s47, 5
s_branch .Lx29b
.Lx30:
buffer_load_dword v27, v14, s[76:79], 0 offen
s_mov_b32 s76, s98
s_mov_b32 s77, s99
s_mov_b32 s78, s100
v_mov_b32 v14, v15
s_mov_b32 s47, 5
s_branch .Lx30b
.Lx31:
buffer_load_dword v27, v14, s[76:79], 0 offen
s_mov_b32 s76, s98
s_mov_b32 s77, s99
s_mov_b32 s78, s100
v_mov_b32 v14, v15
s_mov_b32 s47, 5
s_branch .Lx31b
.Lqkv2:
s_add_u32 m0, s55, 0
s_nop 0
buffer_load_dwordx4 v21, s[36:39], s52 offen lds
buffer_load_dwordx4 v28, s[36:39], s52 offen offset:1024 lds
buffer_load_dword v22, s[36:39], s52 offen offset:2048 lds
s_add_u32 s52, s52, 128
s_add_u32 m0, s55, 2304
s_nop 0
buffer_load_dwordx4 v21, s[36:39], s53 offen lds
buffer_load_dwordx4 v28, s[36:39], s53 offen offset:1024 lds
buffer_load_dword v29, s[36:39], s53 offen offset:2048 lds
s_add_u32 s53, s53, 128
s_add_u32 m0, s56, 123648
s_nop 0
buffer_load_dwordx4 v18, s[20:23], s54 offen lds
buffer_load_dwordx4 v19, s[20:23], s54 offen offset:1024 lds
buffer_load_dwordx4 v20, s[20:23], s54 offen offset:2048 lds
s_add_u32 s54, s54, 196608
s_add_u32 m0, s56, 136064
s_nop 0
buffer_load_dwordx4 v18, s[20:23], s54 offen lds
buffer_load_dwordx4 v19, s[20:23], s54 offen offset:1024 lds
buffer_load_dwordx4 v20, s[20:23], s54 offen offset:2048 lds
s_add_u32 s54, s54, 196608
s_waitcnt vmcnt(12)
s_cmp_lt_u32 s14, 16
s_cselect_b32 s62, 0, 4096
v_mov_b32 v154, 1
v_lshlrev_b32 v155, 8, v1
v_permlane16_swap_b32 v128, v130
v_permlane16_swap_b32 v129, v131
v_permlane16_swap_b32 v132, v134
v_permlane16_swap_b32 v133, v135
v_permlane16_swap_b32 v136, v138
v_permlane16_swap_b32 v137, v139
v_permlane16_swap_b32 v140, v142
v_permlane16_swap_b32 v141, v143
buffer_atomic_add v154, v155, s[40:43], s62 offen
v_lshlrev_b32 v64, 16, v128
v_and_b32 v65, 0xffff0000, v128
v_lshlrev_b32 v66, 16, v129
v_and_b32 v67, 0xffff0000, v129
v_lshlrev_b32 v68, 16, v130
v_and_b32 v69, 0xffff0000, v130
v_lshlrev_b32 v70, 16, v131
v_and_b32 v71, 0xffff0000, v131
v_lshlrev_b32 v72, 16, v132
v_and_b32 v73, 0xffff0000, v132
v_lshlrev_b32 v74, 16, v133
v_and_b32 v75, 0xffff0000, v133
v_lshlrev_b32 v76, 16, v134
v_and_b32 v77, 0xffff0000, v134
v_lshlrev_b32 v78, 16, v135
v_and_b32 v79, 0xffff0000, v135
v_lshlrev_b32 v80, 16, v136
v_and_b32 v81, 0xffff0000, v136
v_lshlrev_b32 v82, 16, v137
v_and_b32 v83, 0xffff0000, v137
v_lshlrev_b32 v84, 16, v138
v_and_b32 v85, 0xffff0000, v138
v_lshlrev_b32 v86, 16, v139
v_and_b32 v87, 0xffff0000, v139
v_lshlrev_b32 v88, 16, v140
v_and_b32 v89, 0xffff0000, v140
v_lshlrev_b32 v90, 16, v141
v_and_b32 v91, 0xffff0000, v141
v_lshlrev_b32 v92, 16, v142
v_and_b32 v93, 0xffff0000, v142
v_lshlrev_b32 v94, 16, v143
v_and_b32 v95, 0xffff0000, v143
s_lshl_b32 s64, s6, 14
s_lshl_b32 s65, s49, 13
s_add_u32 s64, s64, s65
s_lshl_b32 s65, s7, 9
s_add_u32 s64, s64, s65
s_lshl_b32 s65, s48, 8
s_add_u32 s64, s64, s65
s_add_u32 s64, s64, 29360128
v_and_b32 v152, 31, v1
v_lshlrev_b32 v152, 3, v152
v_lshrrev_b32 v153, 5, v1
v_lshl_add_u32 v152, v153, 28, v152
s_lshl_b32 s62, s7, 15
s_add_u32 s62, s62, 0
s_add_u32 s63, s62, 16384
v_pk_mul_f32 v[146:147], v[64:65], v[64:65]
v_pk_mul_f32 v[150:151], v[80:81], v[80:81]
v_pk_fma_f32 v[146:147], v[66:67], v[66:67], v[146:147]
v_pk_add_f32 v[144:145], v[64:65], v[66:67]
v_pk_fma_f32 v[150:151], v[82:83], v[82:83], v[150:151]
v_pk_add_f32 v[148:149], v[80:81], v[82:83]
v_pk_fma_f32 v[146:147], v[68:69], v[68:69], v[146:147]
v_pk_add_f32 v[144:145], v[144:145], v[68:69]
v_pk_fma_f32 v[150:151], v[84:85], v[84:85], v[150:151]
v_pk_add_f32 v[148:149], v[148:149], v[84:85]
v_pk_fma_f32 v[146:147], v[70:71], v[70:71], v[146:147]
v_pk_add_f32 v[144:145], v[144:145], v[70:71]
v_pk_fma_f32 v[150:151], v[86:87], v[86:87], v[150:151]
v_pk_add_f32 v[148:149], v[148:149], v[86:87]
v_pk_fma_f32 v[146:147], v[72:73], v[72:73], v[146:147]
v_pk_add_f32 v[144:145], v[144:145], v[72:73]
v_pk_fma_f32 v[150:151], v[88:89], v[88:89], v[150:151]
v_pk_add_f32 v[148:149], v[148:149], v[88:89]
v_pk_fma_f32 v[146:147], v[74:75], v[74:75], v[146:147]
v_pk_add_f32 v[144:145], v[144:145], v[74:75]
v_pk_fma_f32 v[150:151], v[90:91], v[90:91], v[150:151]
v_pk_add_f32 v[148:149], v[148:149], v[90:91]
v_pk_fma_f32 v[146:147], v[76:77], v[76:77], v[146:147]
v_pk_add_f32 v[144:145], v[144:145], v[76:77]
v_pk_fma_f32 v[150:151], v[92:93], v[92:93], v[150:151]
v_pk_add_f32 v[148:149], v[148:149], v[92:93]
v_pk_fma_f32 v[146:147], v[78:79], v[78:79], v[146:147]
v_pk_add_f32 v[144:145], v[144:145], v[78:79]
v_pk_fma_f32 v[150:151], v[94:95], v[94:95], v[150:151]
v_pk_add_f32 v[148:149], v[148:149], v[94:95]
v_add_f32 v144, v144, v145
v_add_f32 v146, v146, v147
v_add_f32 v148, v148, v149
v_add_f32 v150, v150, v151
s_nop 0
v_permlane16_swap_b32 v144, v148
v_permlane16_swap_b32 v146, v150
v_add_f32 v144, v144, v148
v_add_f32 v146, v146, v150
s_nop 1
v_permlane32_swap_b32 v144, v146
v_add_f32 v144, v144, v146
s_nop 1
v_permlane32_swap_b32 v144, v145
buffer_store_dwordx2 v[144:145], v152, s[16:19], s64 offen sc1
s_lshl_b32 s62, s2, 10
s_add_u32 s62, s62, 31457280
s_cmp_eq_u32 s3, 0
s_cselect_b32 s62, s62, 268435456
buffer_store_dwordx4 v[156:159], v27, s[16:19], s62 offen sc1
v_accvgpr_write_b32 a224, v64
v_accvgpr_write_b32 a225, v65
v_accvgpr_write_b32 a226, v66
v_accvgpr_write_b32 a227, v67
v_accvgpr_write_b32 a228, v68
v_accvgpr_write_b32 a229, v69
v_accvgpr_write_b32 a230, v70
v_accvgpr_write_b32 a231, v71
v_accvgpr_write_b32 a232, v72
v_accvgpr_write_b32 a233, v73
v_accvgpr_write_b32 a234, v74
v_accvgpr_write_b32 a235, v75
v_accvgpr_write_b32 a236, v76
v_accvgpr_write_b32 a237, v77
v_accvgpr_write_b32 a238, v78
v_accvgpr_write_b32 a239, v79
v_accvgpr_write_b32 a240, v80
v_accvgpr_write_b32 a241, v81
v_accvgpr_write_b32 a242, v82
v_accvgpr_write_b32 a243, v83
v_accvgpr_write_b32 a244, v84
v_accvgpr_write_b32 a245, v85
v_accvgpr_write_b32 a246, v86
v_accvgpr_write_b32 a247, v87
v_accvgpr_write_b32 a248, v88
v_accvgpr_write_b32 a249, v89
v_accvgpr_write_b32 a250, v90
v_accvgpr_write_b32 a251, v91
v_accvgpr_write_b32 a252, v92
v_accvgpr_write_b32 a253, v93
v_accvgpr_write_b32 a254, v94
v_accvgpr_write_b32 a255, v95
s_add_u32 m0, s55, 18496
s_nop 0
buffer_load_dwordx4 v21, s[36:39], s52 offen lds
buffer_load_dwordx4 v28, s[36:39], s52 offen offset:1024 lds
buffer_load_dword v22, s[36:39], s52 offen offset:2048 lds
s_add_u32 s52, s52, 128
s_add_u32 m0, s55, 20800
s_nop 0
buffer_load_dwordx4 v21, s[36:39], s53 offen lds
buffer_load_dwordx4 v28, s[36:39], s53 offen offset:1024 lds
buffer_load_dword v29, s[36:39], s53 offen offset:2048 lds
s_add_u32 s53, s53, 128
s_add_u32 m0, s56, 73984
s_nop 0
buffer_load_dwordx4 v18, s[20:23], s54 offen lds
buffer_load_dwordx4 v19, s[20:23], s54 offen offset:1024 lds
buffer_load_dwordx4 v20, s[20:23], s54 offen offset:2048 lds
s_add_u32 s54, s54, 196608
s_waitcnt vmcnt(15) lgkmcnt(0)
s_barrier
ds_read_b128 a[0:3], v23
RD 4,23,2304
RD 8,23,4608
RD 12,23,6912
TR 20,25,49664
TR 22,25,50176
TR 24,25,49696
TR 26,25,50208
ds_read_b128 a[16:19], v24
TR 28,25,50688
TR 30,25,51200
TR 32,25,50720
TR 34,25,51232
TR 36,25,51712
TR 38,25,52224
TR 40,25,51744
TR 42,25,52256
s_waitcnt vmcnt(12) lgkmcnt(8)
s_barrier
v_mfma_f32_16x16x32_bf16 v[60:63], a[20:23], a[0:3], 0
ds_read_b128 a[44:47], v30
RD 48,30,2304
v_mfma_f32_16x16x32_bf16 v[76:79], a[24:27], a[0:3], 0
s_add_u32 m0, s56, 86400
v_mfma_f32_16x16x32_bf16 v[80:83], a[24:27], a[4:7], 0
buffer_load_dwordx4 v18, s[20:23], s54 offen lds
v_mfma_f32_16x16x32_bf16 v[64:67], a[20:23], a[4:7], 0
s_sub_u32 s47, s47, 1
s_cbranch_scc1 .Lx18
.Lx18b:
v_mfma_f32_16x16x32_bf16 v[68:71], a[20:23], a[8:11], 0
buffer_load_dwordx4 v19, s[20:23], s54 offen offset:1024 lds
v_mfma_f32_16x16x32_bf16 v[84:87], a[24:27], a[8:11], 0
RD 52,30,4608
RD 56,30,6912
v_mfma_f32_16x16x32_bf16 v[88:91], a[24:27], a[12:15], 0
TR 64,25,62080
v_mfma_f32_16x16x32_bf16 v[72:75], a[20:23], a[12:15], 0
TR 66,25,62592
s_waitcnt lgkmcnt(6)
v_mfma_f32_16x16x32_bf16 v[244:247], a[24:27], a[16:19], 0
buffer_load_dwordx4 v20, s[20:23], s54 offen offset:2048 lds
v_mfma_f32_16x16x32_bf16 v[104:107], a[28:31], a[12:15], 0
s_add_u32 s54, s54, 196608
s_add_u32 m0, s55, 36992
v_mfma_f32_16x16x32_bf16 v[120:123], a[32:35], a[12:15], 0
buffer_load_dwordx4 v21, s[36:39], s52 offen lds
v_mfma_f32_16x16x32_bf16 v[116:119], a[32:35], a[8:11], 0
TR 68,25,62112
TR 70,25,62624
v_mfma_f32_16x16x32_bf16 v[100:103], a[28:31], a[8:11], 0
ds_read_b128 a[60:63], v31
v_mfma_f32_16x16x32_bf16 v[96:99], a[28:31], a[4:7], 0
buffer_load_dwordx4 v28, s[36:39], s52 offen offset:1024 lds
v_mfma_f32_16x16x32_bf16 v[112:115], a[32:35], a[4:7], 0
TR 72,25,63104
v_mfma_f32_16x16x32_bf16 v[108:111], a[32:35], a[0:3], 0
buffer_load_dword v22, s[36:39], s52 offen offset:2048 lds
v_mfma_f32_16x16x32_bf16 v[92:95], a[28:31], a[0:3], 0
TR 74,25,63616
s_add_u32 s52, s52, 128
v_mfma_f32_16x16x32_bf16 v[124:127], a[0:3], a[36:39], 0
TR 76,25,63136
s_add_u32 m0, s55, 39296
v_mfma_f32_16x16x32_bf16 v[140:143], a[0:3], a[40:43], 0
buffer_load_dwordx4 v21, s[36:39], s53 offen lds
v_mfma_f32_16x16x32_bf16 v[144:147], a[4:7], a[40:43], 0
TR 78,25,63648
v_mfma_f32_16x16x32_bf16 v[128:131], a[4:7], a[36:39], 0
TR 80,25,64128
v_mfma_f32_16x16x32_bf16 v[132:135], a[8:11], a[36:39], 0
buffer_load_dwordx4 v28, s[36:39], s53 offen offset:1024 lds
v_mfma_f32_16x16x32_bf16 v[148:151], a[8:11], a[40:43], 0
TR 82,25,64640
TR 84,25,64160
v_mfma_f32_16x16x32_bf16 v[152:155], a[12:15], a[40:43], 0
TR 86,25,64672
v_mfma_f32_16x16x32_bf16 v[136:139], a[12:15], a[36:39], 0
buffer_load_dword v29, s[36:39], s53 offen offset:2048 lds
v_mfma_f32_16x16x32_bf16 v[156:159], a[16:19], a[36:39], 0
s_add_u32 s53, s53, 128
v_mfma_f32_16x16x32_bf16 v[160:163], a[16:19], a[40:43], 0
s_waitcnt vmcnt(9) lgkmcnt(8)
s_barrier
MAA 60,64,44
RD 0,23,18496
RD 4,23,20800
MAA 76,68,44
s_add_u32 m0, s56, 98816
MAA 80,68,48
buffer_load_dwordx4 v18, s[20:23], s54 offen lds
MAA 64,64,48
RD 8,23,23104
RD 12,23,25408
MAA 68,64,52
buffer_load_dwordx4 v19, s[20:23], s54 offen offset:1024 lds
MAA 84,68,52
ds_read_b64_tr_b16 a[20:21], v25
MAA 88,68,56
TR 22,25,512
MAA 72,64,56
TR 24,25,32
s_waitcnt lgkmcnt(7)
MAA 244,68,60
buffer_load_dwordx4 v20, s[20:23], s54 offen offset:2048 lds
MAA 104,72,56
s_add_u32 s54, s54, 196608
s_add_u32 m0, s56, 111232
MAA 120,76,56
buffer_load_dwordx4 v18, s[20:23], s54 offen lds
MAA 116,76,52
TR 26,25,544
MAA 100,72,52
RD 16,24,18496
TR 28,25,1024
MAA 96,72,48
buffer_load_dwordx4 v19, s[20:23], s54 offen offset:1024 lds
MAA 112,76,48
TR 30,25,1536
MAA 108,76,44
buffer_load_dwordx4 v20, s[20:23], s54 offen offset:2048 lds
MAA 92,72,44
s_add_u32 s54, s54, 196608
MAA 124,44,80
TR 32,25,1056
s_add_u32 m0, s55, 55488
MAA 140,44,84
buffer_load_dwordx4 v21, s[36:39], s52 offen lds
MAA 144,48,84
TR 34,25,1568
MAA 128,48,80
TR 36,25,2048
MAA 132,52,80
buffer_load_dwordx4 v28, s[36:39], s52 offen offset:1024 lds
MAA 148,52,84
TR 38,25,2560
TR 40,25,2080
MAA 152,56,84
TR 42,25,2592
MAA 136,56,80
buffer_load_dword v22, s[36:39], s52 offen offset:2048 lds
MAA 156,60,80
s_add_u32 s52, s52, 128
MAA 160,60,84
s_waitcnt vmcnt(15) lgkmcnt(8)
s_barrier
MAA 60,20,0
RD 44,30,18496
RD 48,30,20800
MAA 76,24,0
s_add_u32 m0, s55, 57792
MAA 80,24,4
buffer_load_dwordx4 v21, s[36:39], s53 offen lds
MAA 64,20,4
s_sub_u32 s47, s47, 1
s_cbranch_scc1 .Lx19
.Lx19b:
MAA 68,20,8
buffer_load_dwordx4 v28, s[36:39], s53 offen offset:1024 lds
MAA 84,24,8
RD 52,30,23104
RD 56,30,25408
MAA 88,24,12
TR 64,25,12416
MAA 72,20,12
TR 66,25,12928
s_waitcnt lgkmcnt(6)
MAA 244,24,16
buffer_load_dword v29, s[36:39], s53 offen offset:2048 lds
MAA 104,28,12
s_add_u32 s53, s53, 128
s_add_u32 m0, s56, 123648
MAA 120,32,12
buffer_load_dwordx4 v18, s[20:23], s54 offen lds
MAA 116,32,8
TR 68,25,12448
TR 70,25,12960
MAA 100,28,8
RD 60,31,18496
MAA 96,28,4
buffer_load_dwordx4 v19, s[20:23], s54 offen offset:1024 lds
MAA 112,32,4
TR 72,25,13440
MAA 108,32,0
buffer_load_dwordx4 v20, s[20:23], s54 offen offset:2048 lds
MAA 92,28,0
TR 74,25,13952
s_add_u32 s54, s54, 196608
MAA 124,0,36
TR 76,25,13472
s_add_u32 m0, s56, 136064
MAA 140,0,40
buffer_load_dwordx4 v18, s[20:23], s54 offen lds
MAA 144,4,40
TR 78,25,13984
MAA 128,4,36
TR 80,25,14464
MAA 132,8,36
buffer_load_dwordx4 v19, s[20:23], s54 offen offset:1024 lds
MAA 148,8,40
TR 82,25,14976
TR 84,25,14496
MAA 152,12,40
TR 86,25,15008
MAA 136,12,36
buffer_load_dwordx4 v20, s[20:23], s54 offen offset:2048 lds
MAA 156,16,36
s_add_u32 s54, s54, 196608
MAA 160,16,40
s_waitcnt vmcnt(15) lgkmcnt(8)
s_barrier
MAA 60,64,44
RD 0,23,36992
RD 4,23,39296
MAA 76,68,44
s_add_u32 m0, s55, 0
MAA 80,68,48
buffer_load_dwordx4 v21, s[36:39], s52 offen lds
MAA 64,64,48
RD 8,23,41600
RD 12,23,43904
MAA 68,64,52
buffer_load_dwordx4 v28, s[36:39], s52 offen offset:1024 lds
MAA 84,68,52
TR 20,25,24832
MAA 88,68,56
TR 22,25,25344
MAA 72,64,56
TR 24,25,24864
s_waitcnt lgkmcnt(7)
MAA 244,68,60
buffer_load_dword v22, s[36:39], s52 offen offset:2048 lds
MAA 104,72,56
TR 26,25,25376
s_add_u32 s52, s52, 128
s_add_u32 m0, s55, 2304
MAA 120,76,56
buffer_load_dwordx4 v21, s[36:39], s53 offen lds
MAA 116,76,52
RD 16,24,36992
MAA 100,72,52
buffer_load_dwordx4 v28, s[36:39], s53 offen offset:1024 lds
MAA 96,72,48
TR 28,25,25856
MAA 112,76,48
buffer_load_dword v29, s[36:39], s53 offen offset:2048 lds
MAA 108,76,44
TR 30,25,26368
s_add_u32 s53, s53, 128
MAA 92,72,44
TR 32,25,25888
s_add_u32 m0, s56, 73984
MAA 124,44,80
buffer_load_dwordx4 v18, s[20:23], s54 offen lds
MAA 140,44,84
TR 34,25,26400
MAA 144,48,84
buffer_load_dwordx4 v19, s[20:23], s54 offen offset:1024 lds
MAA 128,48,80
TR 36,25,26880
MAA 132,52,80
TR 38,25,27392
TR 40,25,26912
MAA 148,52,84
buffer_load_dwordx4 v20, s[20:23], s54 offen offset:2048 lds
MAA 152,56,84
s_add_u32 s54, s54, 196608
MAA 136,56,80
buffer_load_dword v37, v34, s[40:43], 0 offen sc1
MAA 156,60,80
TR 42,25,27424
MAA 160,60,84
s_waitcnt vmcnt(22) lgkmcnt(8)
s_barrier
MAA 60,20,0
RD 44,30,36992
RD 48,30,39296
MAA 76,24,0
s_add_u32 m0, s56, 86400
MAA 80,24,4
buffer_load_dwordx4 v18, s[20:23], s54 offen lds
MAA 64,20,4
s_sub_u32 s47, s47, 1
s_cbranch_scc1 .Lx20
.Lx20b:
MAA 68,20,8
buffer_load_dwordx4 v19, s[20:23], s54 offen offset:1024 lds
MAA 84,24,8
RD 52,30,41600
RD 56,30,43904
MAA 88,24,12
TR 64,25,37248
MAA 72,20,12
TR 66,25,37760
s_waitcnt lgkmcnt(6)
MAA 244,24,16
buffer_load_dwordx4 v20, s[20:23], s54 offen offset:2048 lds
MAA 104,28,12
s_add_u32 s54, s54, 196608
s_add_u32 m0, s55, 18496
MAA 120,32,12
buffer_load_dwordx4 v21, s[36:39], s52 offen lds
MAA 116,32,8
TR 68,25,37280
TR 70,25,37792
MAA 100,28,8
RD 60,31,36992
MAA 96,28,4
buffer_load_dwordx4 v28, s[36:39], s52 offen offset:1024 lds
MAA 112,32,4
TR 72,25,38272
MAA 108,32,0
buffer_load_dword v22, s[36:39], s52 offen offset:2048 lds
MAA 92,28,0
TR 74,25,38784
s_add_u32 s52, s52, 128
MAA 124,0,36
TR 76,25,38304
s_add_u32 m0, s55, 20800
MAA 140,0,40
buffer_load_dwordx4 v21, s[36:39], s53 offen lds
MAA 144,4,40
TR 78,25,38816
MAA 128,4,36
TR 80,25,39296
MAA 132,8,36
buffer_load_dwordx4 v28, s[36:39], s53 offen offset:1024 lds
MAA 148,8,40
TR 82,25,39808
TR 84,25,39328
MAA 152,12,40
TR 86,25,39840
MAA 136,12,36
buffer_load_dword v29, s[36:39], s53 offen offset:2048 lds
MAA 156,16,36
s_add_u32 s53, s53, 128
MAA 160,16,40
s_waitcnt vmcnt(22) lgkmcnt(8)
s_barrier
MAA 60,64,44
RD 0,23,55488
MAA 76,68,44
RD 4,23,57792
s_add_u32 m0, s56, 98816
MAA 80,68,48
buffer_load_dwordx4 v18, s[20:23], s54 offen lds
MAA 64,64,48
RD 8,23,60096
MAA 68,64,52
RD 12,23,62400
MAA 84,68,52
TR 20,25,49664
MAA 88,68,56
buffer_load_dwordx4 v19, s[20:23], s54 offen offset:1024 lds
MAA 72,64,56
TR 22,25,50176
s_waitcnt lgkmcnt(6)
MAA 244,68,60
MAA 104,72,56
TR 24,25,49696
MAA 120,76,56
buffer_load_dwordx4 v20, s[20:23], s54 offen offset:2048 lds
MAA 116,76,52
TR 26,25,50208
s_add_u32 s54, s54, 196608
MAA 100,72,52
RD 16,24,55488
MAA 96,72,48
TR 28,25,50688
s_add_u32 m0, s55, 36992
MAA 112,76,48
buffer_load_dwordx4 v21, s[36:39], s52 offen lds
MAA 108,76,44
TR 30,25,51200
MAA 92,72,44
TR 32,25,50720
MAA 124,44,80
MAA 140,44,84
buffer_load_dwordx4 v28, s[36:39], s52 offen offset:1024 lds
MAA 144,48,84
TR 34,25,51232
MAA 128,48,80
TR 36,25,51712
MAA 132,52,80
TR 38,25,52224
MAA 148,52,84
buffer_load_dword v22, s[36:39], s52 offen offset:2048 lds
MAA 152,56,84
TR 40,25,51744
s_add_u32 s52, s52, 128
MAA 136,56,80
TR 42,25,52256
MAA 156,60,80
MAA 160,60,84
s_waitcnt vmcnt(25) lgkmcnt(8)
s_barrier
MAA 60,20,0
RD 44,30,55488
MAA 76,24,0
RD 48,30,57792
s_add_u32 m0, s56, 111232
MAA 80,24,4
buffer_load_dwordx4 v18, s[20:23], s54 offen lds
MAA 64,20,4
s_sub_u32 s47, s47, 1
s_cbranch_scc1 .Lx21
.Lx21b:
MAA 68,20,8
RD 52,30,60096
MAA 84,24,8
RD 56,30,62400
MAA 88,24,12
buffer_load_dwordx4 v19, s[20:23], s54 offen offset:1024 lds
MAA 72,20,12
TR 64,25,62080
s_waitcnt lgkmcnt(5)
MAA 244,24,16
TR 66,25,62592
MAA 104,28,12
TR 68,25,62112
MAA 120,32,12
buffer_load_dwordx4 v20, s[20:23], s54 offen offset:2048 lds
MAA 116,32,8
TR 70,25,62624
s_add_u32 s54, s54, 196608
MAA 100,28,8
RD 60,31,55488
MAA 96,28,4
s_add_u32 m0, s55, 39296
MAA 112,32,4
buffer_load_dwordx4 v21, s[36:39], s53 offen lds
MAA 108,32,0
TR 72,25,63104
MAA 92,28,0
TR 74,25,63616
MAA 124,0,36
TR 76,25,63136
MAA 140,0,40
buffer_load_dwordx4 v28, s[36:39], s53 offen offset:1024 lds
MAA 144,4,40
TR 78,25,63648
MAA 128,4,36
TR 80,25,64128
MAA 132,8,36
TR 82,25,64640
MAA 148,8,40
buffer_load_dword v29, s[36:39], s53 offen offset:2048 lds
MAA 152,12,40
TR 84,25,64160
s_add_u32 s53, s53, 128
MAA 136,12,36
TR 86,25,64672
MAA 156,16,36
MAA 160,16,40
s_waitcnt vmcnt(22) lgkmcnt(8)
s_barrier
s_waitcnt vmcnt(21)
v_cmp_gt_u32 vcc, v35, v37
s_nop 0
s_cbranch_vccnz .Lsp22
.Lsp22b:
v_mov_b32 v37, 0
MAA 60,64,44
ds_read_b128 a[0:3], v23
MAA 76,68,44
RD 4,23,2304
MAA 80,68,48
buffer_atomic_add v38, v32, s[16:19], 0 offen
MAA 64,64,48
RD 8,23,4608
MAA 68,64,52
RD 12,23,6912
s_add_u32 m0, s56, 123648
MAA 84,68,52
buffer_load_dwordx4 v18, s[20:23], s54 offen lds
MAA 88,68,56
ds_read_b64_tr_b16 a[20:21], v25
MAA 72,64,56
TR 22,25,512
s_waitcnt lgkmcnt(6)
MAA 244,68,60
TR 24,25,32
MAA 104,72,56
buffer_load_dwordx4 v19, s[20:23], s54 offen offset:1024 lds
MAA 120,76,56
TR 26,25,544
MAA 116,76,52
ds_read_b128 a[16:19], v24
MAA 100,72,52
buffer_load_dwordx4 v20, s[20:23], s54 offen offset:2048 lds
MAA 96,72,48
s_add_u32 s54, s54, 196608
MAA 112,76,48
TR 28,25,1024
MAA 108,76,44
TR 30,25,1536
s_add_u32 m0, s55, 55488
MAA 92,72,44
buffer_load_dwordx4 v21, s[36:39], s52 offen lds
MAA 124,44,80
TR 32,25,1056
MAA 140,44,84
TR 34,25,1568
MAA 144,48,84
buffer_load_dwordx4 v28, s[36:39], s52 offen offset:1024 lds
MAA 128,48,80
TR 36,25,2048
MAA 132,52,80
TR 38,25,2560
MAA 148,52,84
TR 40,25,2080
MAA 152,56,84
buffer_load_dword v22, s[36:39], s52 offen offset:2048 lds
MAA 136,56,80
TR 42,25,2592
s_add_u32 s52, s52, 128
MAA 156,60,80
MAA 160,60,84
s_waitcnt vmcnt(25) lgkmcnt(8)
s_barrier
MAA 60,20,0
ds_read_b128 a[44:47], v30
MAA 76,24,0
RD 48,30,2304
s_add_u32 m0, s56, 136064
MAA 80,24,4
buffer_load_dwordx4 v18, s[20:23], s54 offen lds
MAA 64,20,4
s_sub_u32 s47, s47, 1
s_cbranch_scc1 .Lx23
.Lx23b:
MAA 68,20,8
RD 52,30,4608
MAA 84,24,8
RD 56,30,6912
MAA 88,24,12
buffer_load_dwordx4 v19, s[20:23], s54 offen offset:1024 lds
MAA 72,20,12
TR 64,25,12416
s_waitcnt lgkmcnt(5)
MAA 244,24,16
TR 66,25,12928
MAA 104,28,12
TR 68,25,12448
MAA 120,32,12
buffer_load_dwordx4 v20, s[20:23], s54 offen offset:2048 lds
MAA 116,32,8
TR 70,25,12960
s_add_u32 s54, s54, 196608
MAA 100,28,8
ds_read_b128 a[60:63], v31
MAA 96,28,4
s_add_u32 m0, s55, 57792
MAA 112,32,4
buffer_load_dwordx4 v21, s[36:39], s53 offen lds
MAA 108,32,0
TR 72,25,13440
MAA 92,28,0
TR 74,25,13952
MAA 124,0,36
TR 76,25,13472
MAA 140,0,40
buffer_load_dwordx4 v28, s[36:39], s53 offen offset:1024 lds
MAA 144,4,40
TR 78,25,13984
MAA 128,4,36
TR 80,25,14464
MAA 132,8,36
TR 82,25,14976
MAA 148,8,40
buffer_load_dword v29, s[36:39], s53 offen offset:2048 lds
MAA 152,12,40
TR 84,25,14496
s_add_u32 s53, s53, 128
MAA 136,12,36
TR 86,25,15008
MAA 156,16,36
MAA 160,16,40
s_waitcnt vmcnt(22) lgkmcnt(8)
s_barrier
MAA 60,64,44
RD 0,23,18496
MAA 76,68,44
RD 4,23,20800
s_add_u32 m0, s56, 73984
MAA 80,68,48
buffer_load_dwordx4 v18, s[20:23], s54 offen lds
MAA 64,64,48
RD 8,23,23104
MAA 68,64,52
RD 12,23,25408
MAA 84,68,52
TR 20,25,24832
MAA 88,68,56
buffer_load_dwordx4 v19, s[20:23], s54 offen offset:1024 lds
MAA 72,64,56
TR 22,25,25344
s_waitcnt lgkmcnt(6)
MAA 244,68,60
MAA 104,72,56
TR 24,25,24864
MAA 120,76,56
buffer_load_dwordx4 v20, s[20:23], s54 offen offset:2048 lds
MAA 116,76,52
TR 26,25,25376
s_add_u32 s54, s54, 196608
MAA 100,72,52
RD 16,24,18496
MAA 96,72,48
TR 28,25,25856
s_add_u32 m0, s55, 0
MAA 112,76,48
buffer_load_dwordx4 v21, s[36:39], s52 offen lds
MAA 108,76,44
TR 30,25,26368
MAA 92,72,44
TR 32,25,25888
MAA 124,44,80
MAA 140,44,84
buffer_load_dwordx4 v28, s[36:39], s52 offen offset:1024 lds
MAA 144,48,84
TR 34,25,26400
MAA 128,48,80
TR 36,25,26880
MAA 132,52,80
TR 38,25,27392
MAA 148,52,84
buffer_load_dword v22, s[36:39], s52 offen offset:2048 lds
MAA 152,56,84
TR 40,25,26912
s_add_u32 s52, s52, 128
MAA 136,56,80
TR 42,25,27424
MAA 156,60,80
MAA 160,60,84
s_waitcnt vmcnt(22) lgkmcnt(8)
s_barrier
MAA 60,20,0
RD 44,30,18496
MAA 76,24,0
RD 48,30,20800
s_add_u32 m0, s56, 86400
MAA 80,24,4
buffer_load_dwordx4 v18, s[20:23], s54 offen lds
MAA 64,20,4
s_sub_u32 s47, s47, 1
s_cbranch_scc1 .Lx24
.Lx24b:
MAA 68,20,8
RD 52,30,23104
MAA 84,24,8
RD 56,30,25408
MAA 88,24,12
buffer_load_dwordx4 v19, s[20:23], s54 offen offset:1024 lds
MAA 72,20,12
TR 64,25,37248
s_waitcnt lgkmcnt(5)
MAA 244,24,16
TR 66,25,37760
MAA 104,28,12
TR 68,25,37280
MAA 120,32,12
buffer_load_dwordx4 v20, s[20:23], s54 offen offset:2048 lds
MAA 116,32,8
TR 70,25,37792
s_add_u32 s54, s54, 196608
MAA 100,28,8
RD 60,31,18496
MAA 96,28,4
s_add_u32 m0, s55, 2304
MAA 112,32,4
buffer_load_dwordx4 v21, s[36:39], s53 offen lds
MAA 108,32,0
TR 72,25,38272
MAA 92,28,0
TR 74,25,38784
MAA 124,0,36
TR 76,25,38304
MAA 140,0,40
buffer_load_dwordx4 v28, s[36:39], s53 offen offset:1024 lds
MAA 144,4,40
TR 78,25,38816
MAA 128,4,36
TR 80,25,39296
MAA 132,8,36
TR 82,25,39808
MAA 148,8,40
buffer_load_dword v29, s[36:39], s53 offen offset:2048 lds
MAA 152,12,40
TR 84,25,39328
s_add_u32 s53, s53, 128
MAA 136,12,36
TR 86,25,39840
MAA 156,16,36
MAA 160,16,40
s_waitcnt vmcnt(21) lgkmcnt(8)
s_barrier
MAA 60,64,44
RD 0,23,36992
MAA 76,68,44
RD 4,23,39296
s_add_u32 m0, s56, 98816
MAA 80,68,48
buffer_load_dwordx4 v18, s[20:23], s54 offen lds
MAA 64,64,48
RD 8,23,41600
MAA 68,64,52
RD 12,23,43904
MAA 84,68,52
TR 20,25,49664
MAA 88,68,56
buffer_load_dwordx4 v19, s[20:23], s54 offen offset:1024 lds
MAA 72,64,56
TR 22,25,50176
s_waitcnt lgkmcnt(6)
MAA 244,68,60
MAA 104,72,56
TR 24,25,49696
MAA 120,76,56
buffer_load_dwordx4 v20, s[20:23], s54 offen offset:2048 lds
MAA 116,76,52
TR 26,25,50208
s_add_u32 s54, s54, 196608
MAA 100,72,52
RD 16,24,36992
MAA 96,72,48
TR 28,25,50688
s_add_u32 m0, s55, 18496
MAA 112,76,48
buffer_load_dwordx4 v21, s[36:39], s52 offen lds
MAA 108,76,44
TR 30,25,51200
MAA 92,72,44
TR 32,25,50720
MAA 124,44,80
MAA 140,44,84
buffer_load_dwordx4 v28, s[36:39], s52 offen offset:1024 lds
MAA 144,48,84
TR 34,25,51232
MAA 128,48,80
TR 36,25,51712
MAA 132,52,80
TR 38,25,52224
MAA 148,52,84
buffer_load_dword v22, s[36:39], s52 offen offset:2048 lds
MAA 152,56,84
TR 40,25,51744
s_add_u32 s52, s52, 128
MAA 136,56,80
TR 42,25,52256
MAA 156,60,80
MAA 160,60,84
s_waitcnt vmcnt(21) lgkmcnt(8)
s_barrier
MAA 60,20,0
RD 44,30,36992
MAA 76,24,0
RD 48,30,39296
s_add_u32 m0, s56, 111232
MAA 80,24,4
buffer_load_dwordx4 v18, s[20:23], s54 offen lds
MAA 64,20,4
s_sub_u32 s47, s47, 1
s_cbranch_scc1 .Lx25
.Lx25b:
MAA 68,20,8
RD 52,30,41600
MAA 84,24,8
buffer_load_dwordx4 v19, s[20:23], s54 offen offset:1024 lds
MAA 88,24,12
RD 56,30,43904
MAA 72,20,12
TR 64,25,62080
s_waitcnt lgkmcnt(5)
MAA 244,24,16
TR 66,25,62592
MAA 104,28,12
buffer_load_dwordx4 v20, s[20:23], s54 offen offset:2048 lds
MAA 120,32,12
TR 68,25,62112
s_add_u32 s54, s54, 196608
MAA 116,32,8
TR 70,25,62624
s_add_u32 m0, s55, 20800
MAA 100,28,8
buffer_load_dwordx4 v21, s[36:39], s53 offen lds
MAA 96,28,4
RD 60,31,36992
MAA 112,32,4
TR 72,25,63104
MAA 108,32,0
TR 74,25,63616
MAA 92,28,0
buffer_load_dwordx4 v28, s[36:39], s53 offen offset:1024 lds
MAA 124,0,36
TR 76,25,63136
MAA 140,0,40
TR 78,25,63648
MAA 144,4,40
buffer_load_dword v29, s[36:39], s53 offen offset:2048 lds
MAA 128,4,36
TR 80,25,64128
s_add_u32 s53, s53, 128
MAA 132,8,36
TR 82,25,64640
MAA 148,8,40
TR 84,25,64160
MAA 152,12,40
buffer_atomic_add v37, v33, s[16:19], 0 offen sc0
MAA 136,12,36
TR 86,25,64672
MAA 156,16,36
MAA 160,16,40
s_waitcnt vmcnt(22) lgkmcnt(8)
s_barrier
MAA 60,64,44
RD 0,23,55488
MAA 76,68,44
RD 4,23,57792
s_add_u32 m0, s56, 123648
MAA 80,68,48
buffer_load_dwordx4 v18, s[20:23], s54 offen lds
MAA 64,64,48
RD 8,23,60096
MAA 68,64,52
RD 12,23,62400
MAA 84,68,52
ds_read_b64_tr_b16 a[20:21], v25
MAA 88,68,56
buffer_load_dwordx4 v19, s[20:23], s54 offen offset:1024 lds
MAA 72,64,56
TR 22,25,512
s_waitcnt lgkmcnt(6)
MAA 244,68,60
MAA 104,72,56
TR 24,25,32
MAA 120,76,56
buffer_load_dwordx4 v20, s[20:23], s54 offen offset:2048 lds
MAA 116,76,52
TR 26,25,544
s_add_u32 s54, s54, 196608
MAA 100,72,52
RD 16,24,55488
MAA 96,72,48
TR 28,25,1024
s_add_u32 m0, s55, 36992
MAA 112,76,48
buffer_load_dwordx4 v21, s[36:39], s52 offen lds
MAA 108,76,44
TR 30,25,1536
MAA 92,72,44
TR 32,25,1056
MAA 124,44,80
MAA 140,44,84
buffer_load_dwordx4 v28, s[36:39], s52 offen offset:1024 lds
MAA 144,48,84
TR 34,25,1568
MAA 128,48,80
TR 36,25,2048
MAA 132,52,80
TR 38,25,2560
MAA 148,52,84
buffer_load_dword v22, s[36:39], s52 offen offset:2048 lds
MAA 152,56,84
TR 40,25,2080
s_add_u32 s52, s52, 128
MAA 136,56,80
TR 42,25,2592
MAA 156,60,80
MAA 160,60,84
s_waitcnt vmcnt(22) lgkmcnt(8)
s_barrier
MAA 60,20,0
RD 44,30,55488
MAA 76,24,0
RD 48,30,57792
s_add_u32 m0, s56, 136064
MAA 80,24,4
buffer_load_dwordx4 v18, s[20:23], s54 offen lds
MAA 64,20,4
s_sub_u32 s47, s47, 1
s_cbranch_scc1 .Lx26
.Lx26b:
MAA 68,20,8
RD 52,30,60096
MAA 84,24,8
RD 56,30,62400
MAA 88,24,12
buffer_load_dwordx4 v19, s[20:23], s54 offen offset:1024 lds
MAA 72,20,12
TR 64,25,12416
s_waitcnt lgkmcnt(5)
MAA 244,24,16
TR 66,25,12928
MAA 104,28,12
TR 68,25,12448
MAA 120,32,12
buffer_load_dwordx4 v20, s[20:23], s54 offen offset:2048 lds
MAA 116,32,8
TR 70,25,12960
s_add_u32 s54, s54, 196608
MAA 100,28,8
RD 60,31,55488
MAA 96,28,4
s_add_u32 m0, s55, 39296
MAA 112,32,4
buffer_load_dwordx4 v21, s[36:39], s53 offen lds
MAA 108,32,0
TR 72,25,13440
MAA 92,28,0
TR 74,25,13952
MAA 124,0,36
TR 76,25,13472
MAA 140,0,40
buffer_load_dwordx4 v28, s[36:39], s53 offen offset:1024 lds
MAA 144,4,40
TR 78,25,13984
MAA 128,4,36
TR 80,25,14464
MAA 132,8,36
TR 82,25,14976
MAA 148,8,40
buffer_load_dword v29, s[36:39], s53 offen offset:2048 lds
MAA 152,12,40
TR 84,25,14496
s_add_u32 s53, s53, 128
MAA 136,12,36
TR 86,25,15008
MAA 156,16,36
MAA 160,16,40
s_waitcnt vmcnt(22) lgkmcnt(8)
s_barrier
MAA 60,64,44
ds_read_b128 a[0:3], v23
MAA 76,68,44
RD 4,23,2304
s_add_u32 m0, s56, 73984
MAA 80,68,48
buffer_load_dwordx4 v18, s[20:23], s54 offen lds
MAA 64,64,48
RD 8,23,4608
MAA 68,64,52
RD 12,23,6912
MAA 84,68,52
TR 20,25,24832
MAA 88,68,56
buffer_load_dwordx4 v19, s[20:23], s54 offen offset:1024 lds
MAA 72,64,56
TR 22,25,25344
s_waitcnt lgkmcnt(6)
MAA 244,68,60
MAA 104,72,56
TR 24,25,24864
MAA 120,76,56
buffer_load_dwordx4 v20, s[20:23], s54 offen offset:2048 lds
MAA 116,76,52
TR 26,25,25376
s_add_u32 s54, s54, 196608
MAA 100,72,52
ds_read_b128 a[16:19], v24
MAA 96,72,48
TR 28,25,25856
s_add_u32 m0, s55, 55488
MAA 112,76,48
buffer_load_dwordx4 v21, s[36:39], s52 offen lds
MAA 108,76,44
TR 30,25,26368
MAA 92,72,44
TR 32,25,25888
MAA 124,44,80
MAA 140,44,84
buffer_load_dwordx4 v28, s[36:39], s52 offen offset:1024 lds
MAA 144,48,84
TR 34,25,26400
MAA 128,48,80
TR 36,25,26880
MAA 132,52,80
TR 38,25,27392
MAA 148,52,84
buffer_load_dword v22, s[36:39], s52 offen offset:2048 lds
MAA 152,56,84
TR 40,25,26912
s_add_u32 s52, s52, 128
MAA 136,56,80
TR 42,25,27424
MAA 156,60,80
MAA 160,60,84
s_waitcnt vmcnt(22) lgkmcnt(8)
s_barrier
MAA 60,20,0
ds_read_b128 a[44:47], v30
MAA 76,24,0
RD 48,30,2304
s_add_u32 m0, s56, 86400
MAA 80,24,4
buffer_load_dwordx4 v18, s[20:23], s54 offen lds
MAA 64,20,4
s_sub_u32 s47, s47, 1
s_cbranch_scc1 .Lx27
.Lx27b:
MAA 68,20,8
RD 52,30,4608
MAA 84,24,8
RD 56,30,6912
MAA 88,24,12
buffer_load_dwordx4 v19, s[20:23], s54 offen offset:1024 lds
MAA 72,20,12
TR 64,25,37248
s_waitcnt lgkmcnt(5)
MAA 244,24,16
TR 66,25,37760
MAA 104,28,12
TR 68,25,37280
MAA 120,32,12
buffer_load_dwordx4 v20, s[20:23], s54 offen offset:2048 lds
MAA 116,32,8
TR 70,25,37792
s_add_u32 s54, s54, 196608
MAA 100,28,8
ds_read_b128 a[60:63], v31
MAA 96,28,4
s_add_u32 m0, s55, 57792
MAA 112,32,4
buffer_load_dwordx4 v21, s[36:39], s53 offen lds
MAA 108,32,0
TR 72,25,38272
MAA 92,28,0
TR 74,25,38784
MAA 124,0,36
TR 76,25,38304
MAA 140,0,40
buffer_load_dwordx4 v28, s[36:39], s53 offen offset:1024 lds
MAA 144,4,40
TR 78,25,38816
MAA 128,4,36
TR 80,25,39296
MAA 132,8,36
TR 82,25,39808
MAA 148,8,40
buffer_load_dword v29, s[36:39], s53 offen offset:2048 lds
MAA 152,12,40
TR 84,25,39328
s_add_u32 s53, s53, 128
MAA 136,12,36
TR 86,25,39840
MAA 156,16,36
MAA 160,16,40
s_waitcnt vmcnt(24)
v_cmp_gt_u32 vcc, v36, v37
s_nop 0
s_cbranch_vccnz .Lsp28
.Lsp28b:
s_waitcnt vmcnt(21) lgkmcnt(8)
s_barrier
MAA 60,64,44
RD 0,23,18496
MAA 76,68,44
RD 4,23,20800
s_add_u32 m0, s56, 98816
MAA 80,68,48
buffer_load_dwordx4 v18, s[20:23], s54 offen lds
MAA 64,64,48
RD 8,23,23104
MAA 68,64,52
RD 12,23,25408
MAA 84,68,52
buffer_load_dwordx4 v19, s[20:23], s54 offen offset:1024 lds
MAA 88,68,56
TR 20,25,49664
MAA 72,64,56
TR 22,25,50176
s_waitcnt lgkmcnt(6)
MAA 244,68,60
TR 24,25,49696
MAA 104,72,56
buffer_load_dwordx4 v20, s[20:23], s54 offen offset:2048 lds
MAA 120,76,56
TR 26,25,50208
s_add_u32 s54, s54, 196608
MAA 116,76,52
RD 16,24,18496
s_add_u32 m0, s55, 0
MAA 100,72,52
buffer_load_dwordx4 v21, s[36:39], s52 offen lds
MAA 96,72,48
MAA 112,76,48
TR 28,25,50688
MAA 108,76,44
TR 30,25,51200
MAA 92,72,44
buffer_load_dwordx4 v28, s[36:39], s52 offen offset:1024 lds
MAA 124,44,80
TR 32,25,50720
MAA 140,44,84
TR 34,25,51232
MAA 144,48,84
buffer_load_dword v22, s[36:39], s52 offen offset:2048 lds
MAA 128,48,80
TR 36,25,51712
s_add_u32 s52, s52, 128
MAA 132,52,80
TR 38,25,52224
MAA 148,52,84
TR 40,25,51744
MAA 152,56,84
buffer_load_dwordx4 v[164:167], v26, s[16:19], s75 offen sc1
MAA 136,56,80
TR 42,25,52256
MAA 156,60,80
MAA 160,60,84
s_waitcnt vmcnt(22) lgkmcnt(8)
s_barrier
MAA 60,20,0
RD 44,30,18496
MAA 76,24,0
RD 48,30,20800
s_add_u32 m0, s56, 111232
MAA 80,24,4
buffer_load_dwordx4 v18, s[20:23], s54 offen lds
MAA 64,20,4
s_sub_u32 s47, s47, 1
s_cbranch_scc1 .Lx29
.Lx29b:
MAA 68,20,8
RD 52,30,23104
MAA 84,24,8
buffer_load_dwordx4 v19, s[20:23], s54 offen offset:1024 lds
MAA 88,24,12
RD 56,30,25408
MAA 72,20,12
TR 64,25,62080
s_waitcnt lgkmcnt(5)
MAA 244,24,16
TR 66,25,62592
MAA 104,28,12
buffer_load_dwordx4 v20, s[20:23], s54 offen offset:2048 lds
MAA 120,32,12
TR 68,25,62112
s_add_u32 s54, s54, 196608
MAA 116,32,8
TR 70,25,62624
s_add_u32 m0, s55, 2304
MAA 100,28,8
buffer_load_dwordx4 v21, s[36:39], s53 offen lds
MAA 96,28,4
RD 60,31,18496
MAA 112,32,4
TR 72,25,63104
MAA 108,32,0
TR 74,25,63616
MAA 92,28,0
buffer_load_dwordx4 v28, s[36:39], s53 offen offset:1024 lds
MAA 124,0,36
TR 76,25,63136
MAA 140,0,40
TR 78,25,63648
MAA 144,4,40
buffer_load_dword v29, s[36:39], s53 offen offset:2048 lds
MAA 128,4,36
TR 80,25,64128
s_add_u32 s53, s53, 128
MAA 132,8,36
TR 82,25,64640
MAA 148,8,40
TR 84,25,64160
MAA 152,12,40
buffer_load_dwordx4 v[168:171], v26, s[16:19], s75 offen offset:1024 sc1
MAA 136,12,36
TR 86,25,64672
MAA 156,16,36
MAA 160,16,40
s_waitcnt vmcnt(23) lgkmcnt(8)
s_barrier
MAA 60,64,44
RD 0,23,36992
MAA 76,68,44
RD 4,23,39296
s_add_u32 m0, s56, 123648
MAA 80,68,48
buffer_load_dwordx4 v18, s[20:23], s54 offen lds
MAA 64,64,48
RD 8,23,41600
MAA 68,64,52
RD 12,23,43904
MAA 84,68,52
buffer_load_dwordx4 v19, s[20:23], s54 offen offset:1024 lds
MAA 88,68,56
ds_read_b64_tr_b16 a[20:21], v25
MAA 72,64,56
TR 22,25,512
s_waitcnt lgkmcnt(6)
MAA 244,68,60
TR 24,25,32
MAA 104,72,56
buffer_load_dwordx4 v20, s[20:23], s54 offen offset:2048 lds
MAA 120,76,56
TR 26,25,544
s_add_u32 s54, s54, 196608
MAA 116,76,52
RD 16,24,36992
s_add_u32 m0, s55, 18496
MAA 100,72,52
buffer_load_dwordx4 v21, s[36:39], s52 offen lds
MAA 96,72,48
MAA 112,76,48
TR 28,25,1024
MAA 108,76,44
TR 30,25,1536
MAA 92,72,44
buffer_load_dwordx4 v28, s[36:39], s52 offen offset:1024 lds
MAA 124,44,80
TR 32,25,1056
MAA 140,44,84
TR 34,25,1568
MAA 144,48,84
buffer_load_dword v22, s[36:39], s52 offen offset:2048 lds
MAA 128,48,80
TR 36,25,2048
s_add_u32 s52, s52, 128
MAA 132,52,80
TR 38,25,2560
MAA 148,52,84
TR 40,25,2080
MAA 152,56,84
buffer_load_dwordx4 v[172:175], v26, s[16:19], s75 offen offset:2048 sc1
MAA 136,56,80
TR 42,25,2592
MAA 156,60,80
MAA 160,60,84
s_waitcnt vmcnt(24) lgkmcnt(8)
s_barrier
MAA 60,20,0
RD 44,30,36992
MAA 76,24,0
RD 48,30,39296
s_add_u32 m0, s56, 136064
MAA 80,24,4
buffer_load_dwordx4 v18, s[20:23], s54 offen lds
MAA 64,20,4
s_sub_u32 s47, s47, 1
s_cbranch_scc1 .Lx30
.Lx30b:
MAA 68,20,8
RD 52,30,41600
MAA 84,24,8
buffer_load_dwordx4 v19, s[20:23], s54 offen offset:1024 lds
MAA 88,24,12
RD 56,30,43904
MAA 72,20,12
TR 64,25,12416
s_waitcnt lgkmcnt(5)
MAA 244,24,16
TR 66,25,12928
MAA 104,28,12
buffer_load_dwordx4 v20, s[20:23], s54 offen offset:2048 lds
MAA 120,32,12
TR 68,25,12448
s_add_u32 s54, s54, 196608
MAA 116,32,8
TR 70,25,12960
s_add_u32 m0, s55, 20800
MAA 100,28,8
buffer_load_dwordx4 v21, s[36:39], s53 offen lds
MAA 96,28,4
RD 60,31,36992
MAA 112,32,4
TR 72,25,13440
MAA 108,32,0
TR 74,25,13952
MAA 92,28,0
buffer_load_dwordx4 v28, s[36:39], s53 offen offset:1024 lds
MAA 124,0,36
TR 76,25,13472
MAA 140,0,40
TR 78,25,13984
MAA 144,4,40
buffer_load_dword v29, s[36:39], s53 offen offset:2048 lds
MAA 128,4,36
TR 80,25,14464
s_add_u32 s53, s53, 128
MAA 132,8,36
TR 82,25,14976
MAA 148,8,40
TR 84,25,14496
MAA 152,12,40
buffer_load_dwordx4 v[176:179], v26, s[16:19], s75 offen offset:3072 sc1
MAA 136,12,36
TR 86,25,15008
s_add_u32 s75, s75, 4096
MAA 156,16,36
MAA 160,16,40
s_waitcnt vmcnt(25) lgkmcnt(8)
s_barrier
MAA 60,64,44
RD 0,23,55488
MAA 76,68,44
RD 4,23,57792
s_add_u32 m0, s56, 73984
MAA 80,68,48
buffer_load_dwordx4 v18, s[20:23], s54 offen lds
MAA 64,64,48
RD 8,23,60096
MAA 68,64,52
RD 12,23,62400
MAA 84,68,52
buffer_load_dwordx4 v19, s[20:23], s54 offen offset:1024 lds
MAA 88,68,56
TR 20,25,24832
MAA 72,64,56
TR 22,25,25344
s_waitcnt lgkmcnt(6)
MAA 244,68,60
TR 24,25,24864
MAA 104,72,56
buffer_load_dwordx4 v20, s[20:23], s54 offen offset:2048 lds
MAA 120,76,56
TR 26,25,25376
s_add_u32 s54, s54, 196608
MAA 116,76,52
RD 16,24,55488
s_add_u32 m0, s55, 36992
MAA 100,72,52
buffer_load_dwordx4 v21, s[36:39], s52 offen lds
MAA 96,72,48
MAA 112,76,48
TR 28,25,25856
MAA 108,76,44
TR 30,25,26368
MAA 92,72,44
buffer_load_dwordx4 v28, s[36:39], s52 offen offset:1024 lds
MAA 124,44,80
TR 32,25,25888
MAA 140,44,84
TR 34,25,26400
MAA 144,48,84
buffer_load_dword v22, s[36:39], s52 offen offset:2048 lds
MAA 128,48,80
TR 36,25,26880
s_add_u32 s52, s52, 128
MAA 132,52,80
TR 38,25,27392
MAA 148,52,84
TR 40,25,26912
MAA 152,56,84
buffer_load_dwordx4 v[180:183], v26, s[16:19], s75 offen sc1
MAA 136,56,80
TR 42,25,27424
MAA 156,60,80
MAA 160,60,84
s_waitcnt vmcnt(25) lgkmcnt(8)
s_barrier
MAA 60,20,0
RD 44,30,55488
s_waitcnt vmcnt(21)
v_add_f32 v164, v164, v168
MAA 76,24,0
RD 48,30,57792
s_add_u32 m0, s56, 86400
MAA 80,24,4
buffer_load_dwordx4 v18, s[20:23], s54 offen lds
MAA 64,20,4
s_sub_u32 s47, s47, 1
s_cbranch_scc1 .Lx31
.Lx31b:
MAA 68,20,8
RD 52,30,60096
MAA 84,24,8
buffer_load_dwordx4 v19, s[20:23], s54 offen offset:1024 lds
MAA 88,24,12
RD 56,30,62400
MAA 72,20,12
TR 64,25,37248
s_waitcnt lgkmcnt(5)
MAA 244,24,16
TR 66,25,37760
v_add_f32 v165, v165, v169
MAA 104,28,12
buffer_load_dwordx4 v20, s[20:23], s54 offen offset:2048 lds
MAA 120,32,12
TR 68,25,37280
s_add_u32 s54, s54, 196608
MAA 116,32,8
TR 70,25,37792
s_add_u32 m0, s55, 39296
MAA 100,28,8
buffer_load_dwordx4 v21, s[36:39], s53 offen lds
MAA 96,28,4
RD 60,31,55488
MAA 112,32,4
TR 72,25,38272
MAA 108,32,0
TR 74,25,38784
MAA 92,28,0
buffer_load_dwordx4 v28, s[36:39], s53 offen offset:1024 lds
MAA 124,0,36
TR 76,25,38304
v_add_f32 v166, v166, v170
MAA 140,0,40
TR 78,25,38816
MAA 144,4,40
buffer_load_dword v29, s[36:39], s53 offen offset:2048 lds
MAA 128,4,36
TR 80,25,39296
s_add_u32 s53, s53, 128
MAA 132,8,36
TR 82,25,39808
MAA 148,8,40
TR 84,25,39328
v_add_f32 v167, v167, v171
MAA 152,12,40
buffer_load_dwordx4 v[184:187], v26, s[16:19], s75 offen offset:1024 sc1
MAA 136,12,36
TR 86,25,39840
MAA 156,16,36
MAA 160,16,40
s_waitcnt vmcnt(25) lgkmcnt(8)
s_barrier
MAA 60,64,44
ds_read_b128 a[0:3], v23
s_waitcnt vmcnt(21)
v_add_f32 v164, v164, v172
MAA 76,68,44
RD 4,23,2304
s_add_u32 m0, s56, 98816
MAA 80,68,48
buffer_load_dwordx4 v18, s[20:23], s54 offen lds
MAA 64,64,48
RD 8,23,4608
v_add_f32 v165, v165, v173
MAA 68,64,52
RD 12,23,6912
v_add_f32 v166, v166, v174
MAA 84,68,52
buffer_load_dwordx4 v19, s[20:23], s54 offen offset:1024 lds
MAA 88,68,56
TR 20,25,49664
v_add_f32 v167, v167, v175
MAA 72,64,56
TR 22,25,50176
s_waitcnt lgkmcnt(6)
MAA 244,68,60
buffer_load_dwordx4 v20, s[20:23], s54 offen offset:2048 lds
MAA 104,72,56
TR 24,25,49696
s_add_u32 s54, s54, 196608
MAA 120,76,56
TR 26,25,50208
s_add_u32 m0, s55, 55488
MAA 116,76,52
buffer_load_dwordx4 v21, s[36:39], s52 offen lds
MAA 100,72,52
ds_read_b128 a[16:19], v24
MAA 96,72,48
TR 28,25,50688
MAA 112,76,48
buffer_load_dwordx4 v28, s[36:39], s52 offen offset:1024 lds
MAA 108,76,44
TR 30,25,51200
MAA 92,72,44
TR 32,25,50720
MAA 124,44,80
buffer_load_dword v22, s[36:39], s52 offen offset:2048 lds
MAA 140,44,84
TR 34,25,51232
s_add_u32 s52, s52, 128
MAA 144,48,84
TR 36,25,51712
MAA 128,48,80
buffer_load_dwordx4 v[188:191], v26, s[16:19], s75 offen offset:2048 sc1
MAA 132,52,80
TR 38,25,52224
MAA 148,52,84
TR 40,25,51744
MAA 152,56,84
TR 42,25,52256
MAA 136,56,80
MAA 156,60,80
MAA 160,60,84
s_waitcnt vmcnt(25) lgkmcnt(8)
s_barrier
MAA 60,20,0
ds_read_b128 a[44:47], v30
s_waitcnt vmcnt(21)
v_add_f32 v164, v164, v176
MAA 76,24,0
RD 48,30,2304
s_add_u32 m0, s56, 111232
MAA 80,24,4
buffer_load_dwordx4 v18, s[20:23], s54 offen lds
MAA 64,20,4
RD 52,30,4608
v_add_f32 v165, v165, v177
MAA 68,20,8
RD 56,30,6912
v_add_f32 v166, v166, v178
MAA 84,24,8
buffer_load_dwordx4 v19, s[20:23], s54 offen offset:1024 lds
MAA 88,24,12
TR 64,25,62080
v_add_f32 v167, v167, v179
MAA 72,20,12
TR 66,25,62592
s_waitcnt lgkmcnt(6)
MAA 244,24,16
buffer_load_dwordx4 v20, s[20:23], s54 offen offset:2048 lds
MAA 104,28,12
TR 68,25,62112
s_add_u32 s54, s54, 196608
MAA 120,32,12
TR 70,25,62624
s_add_u32 m0, s55, 57792
MAA 116,32,8
buffer_load_dwordx4 v21, s[36:39], s53 offen lds
MAA 100,28,8
ds_read_b128 a[60:63], v31
MAA 96,28,4
TR 72,25,63104
MAA 112,32,4
buffer_load_dwordx4 v28, s[36:39], s53 offen offset:1024 lds
MAA 108,32,0
TR 74,25,63616
MAA 92,28,0
TR 76,25,63136
MAA 124,0,36
buffer_load_dword v29, s[36:39], s53 offen offset:2048 lds
MAA 140,0,40
TR 78,25,63648
s_add_u32 s53, s53, 128
MAA 144,4,40
TR 80,25,64128
MAA 128,4,36
buffer_load_dwordx4 v[192:195], v26, s[16:19], s75 offen offset:3072 sc1
MAA 132,8,36
TR 82,25,64640
MAA 148,8,40
TR 84,25,64160
MAA 152,12,40
TR 86,25,64672
MAA 136,12,36
MAA 156,16,36
MAA 160,16,40
s_waitcnt vmcnt(25) lgkmcnt(8)
s_barrier
MAA 60,64,44
RD 0,23,18496
s_waitcnt vmcnt(21)
v_add_f32 v164, v164, v180
MAA 76,68,44
RD 4,23,20800
s_add_u32 m0, s56, 123648
MAA 80,68,48
buffer_load_dwordx4 v18, s[20:23], s54 offen lds
MAA 64,64,48
RD 8,23,23104
v_add_f32 v165, v165, v181
MAA 68,64,52
RD 12,23,25408
v_add_f32 v166, v166, v182
MAA 84,68,52
ds_read_b64_tr_b16 a[20:21], v25
v_add_f32 v167, v167, v183
MAA 88,68,56
TR 22,25,512
MAA 72,64,56
TR 24,25,32
s_waitcnt lgkmcnt(7)
MAA 244,68,60
TR 26,25,544
MAA 104,72,56
RD 16,24,18496
MAA 120,76,56
buffer_load_dwordx4 v19, s[20:23], s54 offen offset:1024 lds
MAA 116,76,52
TR 28,25,1024
MAA 100,72,52
TR 30,25,1536
MAA 96,72,48
TR 32,25,1056
MAA 112,76,48
TR 34,25,1568
MAA 108,76,44
TR 36,25,2048
MAA 92,72,44
TR 38,25,2560
MAA 124,44,80
TR 40,25,2080
MAA 140,44,84
buffer_load_dwordx4 v20, s[20:23], s54 offen offset:2048 lds
MAA 144,48,84
TR 42,25,2592
s_add_u32 s54, s54, 196608
MAA 128,48,80
MAA 132,52,80
MAA 148,52,84
MAA 152,56,84
MAA 136,56,80
MAA 156,60,80
MAA 160,60,84
s_waitcnt vmcnt(21) lgkmcnt(8)
s_barrier
MAA 60,20,0
RD 44,30,18496
s_waitcnt vmcnt(17)
v_add_f32 v164, v164, v184
MAA 76,24,0
RD 48,30,20800
s_add_u32 m0, s56, 136064
MAA 80,24,4
buffer_load_dwordx4 v18, s[20:23], s54 offen lds
MAA 64,20,4
RD 52,30,23104
v_add_f32 v165, v165, v185
MAA 68,20,8
RD 56,30,25408
v_add_f32 v166, v166, v186
MAA 84,24,8
TR 64,25,12416
v_add_f32 v167, v167, v187
MAA 88,24,12
TR 66,25,12928
MAA 72,20,12
TR 68,25,12448
s_waitcnt lgkmcnt(7)
MAA 244,24,16
TR 70,25,12960
MAA 104,28,12
RD 60,31,18496
MAA 120,32,12
buffer_load_dwordx4 v19, s[20:23], s54 offen offset:1024 lds
MAA 116,32,8
TR 72,25,13440
MAA 100,28,8
TR 74,25,13952
MAA 96,28,4
TR 76,25,13472
MAA 112,32,4
TR 78,25,13984
MAA 108,32,0
TR 80,25,14464
MAA 92,28,0
TR 82,25,14976
MAA 124,0,36
TR 84,25,14496
MAA 140,0,40
buffer_load_dwordx4 v20, s[20:23], s54 offen offset:2048 lds
MAA 144,4,40
TR 86,25,15008
s_add_u32 s54, s54, 196608
MAA 128,4,36
MAA 132,8,36
MAA 148,8,40
MAA 152,12,40
MAA 136,12,36
MAA 156,16,36
MAA 160,16,40
s_waitcnt vmcnt(17) lgkmcnt(8)
s_barrier
MAA 60,64,44
RD 0,23,36992
s_waitcnt vmcnt(13)
v_add_f32 v164, v164, v188
MAA 76,68,44
RD 4,23,39296
s_add_u32 m0, s59, 0
MAA 80,68,48
RD 8,23,41600
s_mov_b32 s58, 1048576
MAA 64,64,48
buffer_load_dwordx4 v5, s[24:27], s58 offen lds
MAA 68,64,52
RD 12,23,43904
v_add_f32 v165, v165, v189
MAA 84,68,52
TR 20,25,24832
v_add_f32 v166, v166, v190
MAA 88,68,56
TR 22,25,25344
v_add_f32 v167, v167, v191
MAA 72,64,56
buffer_load_dwordx4 v6, s[24:27], s58 offen offset:1024 lds
s_waitcnt lgkmcnt(6)
MAA 244,68,60
TR 24,25,24864
s_add_u32 m0, s59, 8320
MAA 104,72,56
TR 26,25,25376
s_mov_b32 s58, 1179648
MAA 120,76,56
RD 16,24,36992
MAA 116,76,52
buffer_load_dwordx4 v5, s[24:27], s58 offen lds
MAA 100,72,52
TR 28,25,25856
MAA 96,72,48
TR 30,25,26368
MAA 112,76,48
TR 32,25,25888
MAA 108,76,44
buffer_load_dwordx4 v6, s[24:27], s58 offen offset:1024 lds
MAA 92,72,44
TR 34,25,26400
s_add_u32 m0, s59, 16640
MAA 124,44,80
TR 36,25,26880
s_mov_b32 s58, 1310720
MAA 140,44,84
TR 38,25,27392
MAA 144,48,84
buffer_load_dwordx4 v5, s[24:27], s58 offen lds
MAA 128,48,80
TR 40,25,26912
MAA 132,52,80
TR 42,25,27424
MAA 148,52,84
MAA 152,56,84
buffer_load_dwordx4 v6, s[24:27], s58 offen offset:1024 lds
MAA 136,56,80
MAA 156,60,80
MAA 160,60,84
s_waitcnt vmcnt(16) lgkmcnt(8)
s_barrier
MAA 60,20,0
RD 44,30,36992
s_waitcnt vmcnt(12)
v_add_f32 v164, v164, v192
MAA 76,24,0
RD 48,30,39296
s_add_u32 m0, s59, 24960
MAA 80,24,4
RD 52,30,41600
s_mov_b32 s58, 1441792
MAA 64,20,4
buffer_load_dwordx4 v5, s[24:27], s58 offen lds
MAA 68,20,8
RD 56,30,43904
v_add_f32 v165, v165, v193
MAA 84,24,8
TR 64,25,37248
v_add_f32 v166, v166, v194
MAA 88,24,12
TR 66,25,37760
v_add_f32 v167, v167, v195
MAA 72,20,12
buffer_load_dwordx4 v6, s[24:27], s58 offen offset:1024 lds
s_waitcnt lgkmcnt(6)
MAA 244,24,16
TR 68,25,37280
s_add_u32 m0, s59, 74880
MAA 104,28,12
TR 70,25,37792
s_mov_b32 s58, 131072
MAA 120,32,12
RD 60,31,36992
MAA 116,32,8
buffer_load_dwordx4 v5, s[24:27], s58 offen lds
MAA 100,28,8
TR 72,25,38272
MAA 96,28,4
TR 74,25,38784
MAA 112,32,4
TR 76,25,38304
MAA 108,32,0
buffer_load_dwordx4 v6, s[24:27], s58 offen offset:1024 lds
MAA 92,28,0
TR 78,25,38816
s_add_u32 m0, s59, 83200
MAA 124,0,36
TR 80,25,39296
s_mov_b32 s58, 262144
MAA 140,0,40
TR 82,25,39808
MAA 144,4,40
buffer_load_dwordx4 v5, s[24:27], s58 offen lds
MAA 128,4,36
TR 84,25,39328
MAA 132,8,36
TR 86,25,39840
MAA 148,8,40
MAA 152,12,40
buffer_load_dwordx4 v6, s[24:27], s58 offen offset:1024 lds
MAA 136,12,36
MAA 156,16,36
MAA 160,16,40
s_waitcnt vmcnt(15) lgkmcnt(8)
s_barrier
MAA 60,64,44
RD 0,23,55488
MAA 76,68,44
RD 4,23,57792
s_add_u32 m0, s59, 33280
MAA 80,68,48
RD 8,23,60096
s_mov_b32 s58, 1572864
MAA 64,64,48
buffer_load_dwordx4 v5, s[24:27], s58 offen lds
MAA 68,64,52
RD 12,23,62400
MAA 84,68,52
TR 20,25,49664
MAA 88,68,56
TR 22,25,50176
MAA 72,64,56
buffer_load_dwordx4 v6, s[24:27], s58 offen offset:1024 lds
s_waitcnt lgkmcnt(6)
MAA 244,68,60
TR 24,25,49696
s_add_u32 m0, s59, 41600
MAA 104,72,56
TR 26,25,50208
s_mov_b32 s58, 1703936
MAA 120,76,56
RD 16,24,55488
MAA 116,76,52
buffer_load_dwordx4 v5, s[24:27], s58 offen lds
MAA 100,72,52
TR 28,25,50688
MAA 96,72,48
TR 30,25,51200
MAA 112,76,48
TR 32,25,50720
MAA 108,76,44
buffer_load_dwordx4 v6, s[24:27], s58 offen offset:1024 lds
MAA 92,72,44
TR 34,25,51232
s_add_u32 m0, s59, 91520
MAA 124,44,80
TR 36,25,51712
s_mov_b32 s58, 393216
MAA 140,44,84
TR 38,25,52224
MAA 144,48,84
buffer_load_dwordx4 v5, s[24:27], s58 offen lds
MAA 128,48,80
TR 40,25,51744
MAA 132,52,80
TR 42,25,52256
MAA 148,52,84
v_permlane32_swap_b32 v164, v166
MAA 152,56,84
buffer_load_dwordx4 v6, s[24:27], s58 offen offset:1024 lds
MAA 136,56,80
v_permlane32_swap_b32 v165, v167
MAA 156,60,80
v_add_f32 v164, v164, v166
v_add_f32 v165, v165, v167
MAA 160,60,84
v_mul_f32 v164, 0xba800000, v164
v_mul_f32 v165, 0x3a800000, v165
v_fma_f32 v165, -v164, v164, v165
v_max_f32 v165, 0, v165
v_add_f32 v165, 0x3727c5ac, v165
s_waitcnt vmcnt(18) lgkmcnt(8)
s_barrier
MAA 60,20,0
ds_write_b32 v17, v164
MAA 76,24,0
RD 44,30,55488
s_add_u32 m0, s59, 99840
MAA 80,24,4
RD 48,30,57792
s_mov_b32 s58, 524288
MAA 64,20,4
buffer_load_dwordx4 v5, s[24:27], s58 offen lds
MAA 68,20,8
RD 52,30,60096
MAA 84,24,8
RD 56,30,62400
MAA 88,24,12
TR 64,25,62080
MAA 72,20,12
TR 66,25,62592
s_waitcnt lgkmcnt(7)
MAA 244,24,16
TR 68,25,62112
MAA 104,28,12
buffer_load_dwordx4 v6, s[24:27], s58 offen offset:1024 lds
MAA 120,32,12
TR 70,25,62624
s_add_u32 m0, s59, 108160
MAA 116,32,8
RD 60,31,55488
s_mov_b32 s58, 655360
MAA 100,28,8
TR 72,25,63104
MAA 96,28,4
TR 74,25,63616
MAA 112,32,4
TR 76,25,63136
MAA 108,32,0
buffer_load_dwordx4 v5, s[24:27], s58 offen lds
MAA 92,28,0
TR 78,25,63648
MAA 124,0,36
TR 80,25,64128
MAA 140,0,40
TR 82,25,64640
MAA 144,4,40
TR 84,25,64160
MAA 128,4,36
TR 86,25,64672
MAA 132,8,36
buffer_load_dwordx4 v6, s[24:27], s58 offen offset:1024 lds
MAA 148,8,40
v_rsq_f32 v166, v165
MAA 152,12,40
v_mov_b32 v165, v166
v_mul_f32 v166, 0x3e8293ee, v166
MAA 136,12,36
ds_write_b128 v7, v[164:167]
MAA 156,16,36
ds_write_b32 v17, v165 offset:1024
MAA 160,16,40
s_waitcnt lgkmcnt(0)
s_barrier
MAA 244,68,60
ds_read_b128 v[232:235], v10 offset:1792
MAA 156,60,80
ds_read_b128 v[228:231], v10 offset:1536
MAA 160,60,84
ds_read_b128 v[224:227], v10 offset:1280
MAA 104,72,56
ds_read_b128 v[220:223], v10 offset:1024
MAA 120,76,56
MAA 136,56,80
MAA 152,56,84
MAA 100,72,52
MAA 116,76,52
s_mov_b32 exec_lo, 0x10001
s_mov_b32 exec_hi, 0x10001
ds_write_b128 v13, v[244:247] offset:64
s_mov_b64 exec, 0xffff
ds_write_b32 v12, v156 offset:512
ds_write_b32 v12, v160 offset:576
s_mov_b64 exec, -1
MAA 96,72,48
MAA 112,76,48
MAA 92,72,44
MAA 108,76,44
MAA 72,64,56
MAA 88,68,56
s_waitcnt lgkmcnt(0)
s_barrier
MAA 132,52,80
ds_read_b128 v[28:31], v13
s_add_u32 m0, s59, 49920
MAA 148,52,84
ds_read_b128 v[32:35], v13 offset:64
s_mov_b32 s58, 1835008
MAA 68,64,52
ds_read_b128 v[36:39], v13 offset:256
MAA 84,68,52
ds_read_b128 v[40:43], v13 offset:320
MAA 128,48,80
ds_read_b32 v44, v12 offset:512
MAA 144,48,84
ds_read_b32 v45, v12 offset:576
MAA 64,64,48
ds_read_b128 v[240:243], v11 offset:704
MAA 80,68,48
ds_read_b128 v[244:247], v11 offset:1728
MAA 124,44,80
buffer_load_dwordx4 v5, s[24:27], s58 offen lds
ds_read_b128 v[18:21], v11 offset:448
s_waitcnt lgkmcnt(8)
v_pk_fma_f32 v[72:73], v[28:29], v[232:233], v[72:73] op_sel_hi:[1,0,1]
v_pk_fma_f32 v[74:75], v[30:31], v[232:233], v[74:75] op_sel_hi:[1,0,1]
s_waitcnt lgkmcnt(6)
v_pk_fma_f32 v[104:105], v[36:37], v[232:233], v[104:105] op_sel_hi:[1,0,1]
v_pk_mul_f32 v[104:105], v[104:105], v[232:233] op_sel:[0,1] op_sel_hi:[1,1]
v_pk_fma_f32 v[106:107], v[38:39], v[232:233], v[106:107] op_sel_hi:[1,0,1]
v_pk_mul_f32 v[106:107], v[106:107], v[232:233] op_sel:[0,1] op_sel_hi:[1,1]
s_waitcnt lgkmcnt(5)
v_pk_fma_f32 v[120:121], v[40:41], v[232:233], v[120:121] op_sel_hi:[1,0,1]
v_pk_mul_f32 v[120:121], v[120:121], v[232:233] op_sel:[0,1] op_sel_hi:[1,1]
v_pk_fma_f32 v[122:123], v[42:43], v[232:233], v[122:123] op_sel_hi:[1,0,1]
v_pk_mul_f32 v[122:123], v[122:123], v[232:233] op_sel:[0,1] op_sel_hi:[1,1]
v_pk_fma_f32 v[100:101], v[36:37], v[228:229], v[100:101] op_sel_hi:[1,0,1]
v_pk_mul_f32 v[100:101], v[100:101], v[228:229] op_sel:[0,1] op_sel_hi:[1,1]
v_pk_fma_f32 v[102:103], v[38:39], v[228:229], v[102:103] op_sel_hi:[1,0,1]
v_pk_mul_f32 v[102:103], v[102:103], v[228:229] op_sel:[0,1] op_sel_hi:[1,1]
v_pk_fma_f32 v[116:117], v[40:41], v[228:229], v[116:117] op_sel_hi:[1,0,1]
v_pk_mul_f32 v[116:117], v[116:117], v[228:229] op_sel:[0,1] op_sel_hi:[1,1]
v_pk_fma_f32 v[118:119], v[42:43], v[228:229], v[118:119] op_sel_hi:[1,0,1]
v_pk_mul_f32 v[118:119], v[118:119], v[228:229] op_sel:[0,1] op_sel_hi:[1,1]
s_waitcnt lgkmcnt(2)
v_pk_fma_f32 v[156:157], v[240:241], v[44:45], v[156:157] op_sel_hi:[1,0,1]
v_pk_fma_f32 v[158:159], v[242:243], v[44:45], v[158:159] op_sel_hi:[1,0,1]
v_pk_fma_f32 v[160:161], v[240:241], v[44:45], v[160:161] op_sel:[0,1,0] op_sel_hi:[1,1,1]
v_pk_fma_f32 v[162:163], v[242:243], v[44:45], v[162:163] op_sel:[0,1,0] op_sel_hi:[1,1,1]
s_waitcnt lgkmcnt(1)
v_pk_mul_f32 v[156:157], v[156:157], v[244:245]
v_pk_mul_f32 v[158:159], v[158:159], v[246:247]
v_pk_mul_f32 v[160:161], v[160:161], v[244:245]
v_pk_mul_f32 v[162:163], v[162:163], v[246:247]
v_pk_fma_f32 v[88:89], v[32:33], v[232:233], v[88:89] op_sel_hi:[1,0,1]
v_pk_fma_f32 v[90:91], v[34:35], v[232:233], v[90:91] op_sel_hi:[1,0,1]
v_pk_fma_f32 v[96:97], v[36:37], v[224:225], v[96:97] op_sel_hi:[1,0,1]
s_waitcnt lgkmcnt(0)
v_pk_fma_f32 v[136:137], v[18:19], v[44:45], v[136:137] op_sel_hi:[1,0,1]
v_pk_fma_f32 v[138:139], v[20:21], v[44:45], v[138:139] op_sel_hi:[1,0,1]
v_pk_fma_f32 v[152:153], v[18:19], v[44:45], v[152:153] op_sel:[0,1,0] op_sel_hi:[1,1,1]
v_pk_fma_f32 v[154:155], v[20:21], v[44:45], v[154:155] op_sel:[0,1,0] op_sel_hi:[1,1,1]
v_pk_mul_f32 v[96:97], v[96:97], v[224:225] op_sel:[0,1] op_sel_hi:[1,1]
v_pk_fma_f32 v[98:99], v[38:39], v[224:225], v[98:99] op_sel_hi:[1,0,1]
v_pk_mul_f32 v[98:99], v[98:99], v[224:225] op_sel:[0,1] op_sel_hi:[1,1]
v_pk_fma_f32 v[112:113], v[40:41], v[224:225], v[112:113] op_sel_hi:[1,0,1]
v_pk_mul_f32 v[112:113], v[112:113], v[224:225] op_sel:[0,1] op_sel_hi:[1,1]
v_pk_fma_f32 v[114:115], v[42:43], v[224:225], v[114:115] op_sel_hi:[1,0,1]
v_pk_mul_f32 v[114:115], v[114:115], v[224:225] op_sel:[0,1] op_sel_hi:[1,1]
v_pk_fma_f32 v[68:69], v[28:29], v[228:229], v[68:69] op_sel_hi:[1,0,1]
v_pk_fma_f32 v[70:71], v[30:31], v[228:229], v[70:71] op_sel_hi:[1,0,1]
v_pk_fma_f32 v[84:85], v[32:33], v[228:229], v[84:85] op_sel_hi:[1,0,1]
v_pk_fma_f32 v[86:87], v[34:35], v[228:229], v[86:87] op_sel_hi:[1,0,1]
v_pk_fma_f32 v[92:93], v[36:37], v[220:221], v[92:93] op_sel_hi:[1,0,1]
v_pk_mul_f32 v[92:93], v[92:93], v[220:221] op_sel:[0,1] op_sel_hi:[1,1]
v_pk_fma_f32 v[94:95], v[38:39], v[220:221], v[94:95] op_sel_hi:[1,0,1]
v_pk_mul_f32 v[94:95], v[94:95], v[220:221] op_sel:[0,1] op_sel_hi:[1,1]
v_pk_fma_f32 v[108:109], v[40:41], v[220:221], v[108:109] op_sel_hi:[1,0,1]
v_pk_mul_f32 v[108:109], v[108:109], v[220:221] op_sel:[0,1] op_sel_hi:[1,1]
v_pk_fma_f32 v[110:111], v[42:43], v[220:221], v[110:111] op_sel_hi:[1,0,1]
v_pk_mul_f32 v[110:111], v[110:111], v[220:221] op_sel:[0,1] op_sel_hi:[1,1]
v_pk_fma_f32 v[64:65], v[28:29], v[224:225], v[64:65] op_sel_hi:[1,0,1]
v_pk_fma_f32 v[66:67], v[30:31], v[224:225], v[66:67] op_sel_hi:[1,0,1]
v_pk_fma_f32 v[80:81], v[32:33], v[224:225], v[80:81] op_sel_hi:[1,0,1]
v_pk_fma_f32 v[82:83], v[34:35], v[224:225], v[82:83] op_sel_hi:[1,0,1]
v_cvt_pk_bf16_f32 v236, v156, v157
v_cvt_pk_bf16_f32 v237, v158, v159
MAA 140,44,84
buffer_load_dwordx4 v6, s[24:27], s58 offen offset:1024 lds
MAA 60,64,44
ds_read_b128 v[22:25], v11 offset:1472
v_cvt_pk_bf16_f32 v238, v160, v161
MAA 76,68,44
ds_read_b128 v[240:243], v11 offset:384
v_cvt_pk_bf16_f32 v239, v162, v163
ds_write_b128 v8, v[236:239] offset:1024
s_add_u32 m0, s59, 58240
s_mov_b32 s58, 1966080
v_cvt_pk_bf16_f32 v196, v104, v105
buffer_load_dwordx4 v5, s[24:27], s58 offen lds
v_cvt_pk_bf16_f32 v197, v106, v107
v_cvt_pk_bf16_f32 v198, v120, v121
v_cvt_pk_bf16_f32 v199, v122, v123
v_cvt_pk_bf16_f32 v192, v100, v101
v_cvt_pk_bf16_f32 v193, v102, v103
v_cvt_pk_bf16_f32 v194, v116, v117
v_cvt_pk_bf16_f32 v195, v118, v119
v_cvt_pk_bf16_f32 v176, v72, v73
v_cvt_pk_bf16_f32 v177, v74, v75
v_cvt_pk_bf16_f32 v178, v88, v89
v_cvt_pk_bf16_f32 v179, v90, v91
v_pk_fma_f32 v[60:61], v[28:29], v[220:221], v[60:61] op_sel_hi:[1,0,1]
v_pk_fma_f32 v[62:63], v[30:31], v[220:221], v[62:63] op_sel_hi:[1,0,1]
v_pk_fma_f32 v[76:77], v[32:33], v[220:221], v[76:77] op_sel_hi:[1,0,1]
v_pk_fma_f32 v[78:79], v[34:35], v[220:221], v[78:79] op_sel_hi:[1,0,1]
ds_read_b128 v[244:247], v11 offset:1408
s_nop 0
v_mfma_f32_16x16x32_bf16 v[104:107], v[192:195], v[176:179], v[46:49]
buffer_load_dwordx4 v6, s[24:27], s58 offen offset:1024 lds
s_add_u32 m0, s59, 66560
s_mov_b32 s58, 0
v_cvt_pk_bf16_f32 v188, v96, v97
s_waitcnt lgkmcnt(3)
v_pk_mul_f32 v[136:137], v[136:137], v[22:23]
v_pk_mul_f32 v[138:139], v[138:139], v[24:25]
v_pk_mul_f32 v[152:153], v[152:153], v[22:23]
v_pk_mul_f32 v[154:155], v[154:155], v[24:25]
s_waitcnt lgkmcnt(2)
v_pk_fma_f32 v[132:133], v[240:241], v[44:45], v[132:133] op_sel_hi:[1,0,1]
v_pk_fma_f32 v[134:135], v[242:243], v[44:45], v[134:135] op_sel_hi:[1,0,1]
v_pk_fma_f32 v[148:149], v[240:241], v[44:45], v[148:149] op_sel:[0,1,0] op_sel_hi:[1,1,1]
v_pk_fma_f32 v[150:151], v[242:243], v[44:45], v[150:151] op_sel:[0,1,0] op_sel_hi:[1,1,1]
s_waitcnt lgkmcnt(1)
s_barrier
v_cvt_pk_bf16_f32 v208, v136, v137
v_mfma_f32_16x16x32_bf16 v[120:123], v[196:199], v[176:179], v[50:53]
ds_read_b128 v[180:183], v9
ds_read_b64 v[200:201], v9 offset:1024
ds_read_b64 v[210:211], v9 offset:1032
buffer_load_dwordx4 v5, s[24:27], s58 offen lds
v_cvt_pk_bf16_f32 v209, v138, v139
v_cvt_pk_bf16_f32 v218, v152, v153
v_cvt_pk_bf16_f32 v219, v154, v155
s_waitcnt lgkmcnt(3)
v_pk_mul_f32 v[132:133], v[132:133], v[244:245]
v_cvt_pk_bf16_f32 v206, v132, v133
v_pk_mul_f32 v[134:135], v[134:135], v[246:247]
v_cvt_pk_bf16_f32 v207, v134, v135
v_pk_mul_f32 v[148:149], v[148:149], v[244:245]
v_cvt_pk_bf16_f32 v216, v148, v149
v_pk_mul_f32 v[150:151], v[150:151], v[246:247]
v_cvt_pk_bf16_f32 v217, v150, v151
v_max3_f32 v88, v104, v105, v106
v_max3_f32 v89, v107, v120, v121
buffer_load_dwordx4 v6, s[24:27], s58 offen offset:1024 lds
s_add_u32 m0, s59, 116480
s_mov_b32 s58, 786432
v_max3_f32 v88, v88, v122, v123
v_max_f32 v90, v88, v89
v_max_f32 v89, v88, v89
v_cvt_pk_bf16_f32 v189, v98, v99
v_cvt_pk_bf16_f32 v190, v112, v113
v_permlane16_swap_b32 v90, v89
v_cvt_pk_bf16_f32 v191, v114, v115
v_max_f32 v88, v90, v89
v_max_f32 v89, v90, v89
v_cvt_pk_bf16_f32 v172, v68, v69
buffer_load_dwordx4 v5, s[24:27], s58 offen lds
v_permlane32_swap_b32 v88, v89
v_cvt_pk_bf16_f32 v173, v70, v71
v_max_f32 v88, v88, v89
v_mul_f32 v88, v88, v234
v_pk_fma_f32 v[104:105], v[104:105], v[234:235], v[88:89] op_sel_hi:[1,0,0] neg_lo:[0,0,1] neg_hi:[0,0,1]
v_pk_fma_f32 v[106:107], v[106:107], v[234:235], v[88:89] op_sel_hi:[1,0,0] neg_lo:[0,0,1] neg_hi:[0,0,1]
v_pk_fma_f32 v[120:121], v[120:121], v[234:235], v[88:89] op_sel_hi:[1,0,0] neg_lo:[0,0,1] neg_hi:[0,0,1]
v_pk_fma_f32 v[122:123], v[122:123], v[234:235], v[88:89] op_sel_hi:[1,0,0] neg_lo:[0,0,1] neg_hi:[0,0,1]
v_exp_f32 v104, v104
v_exp_f32 v105, v105
v_exp_f32 v106, v106
v_exp_f32 v107, v107
v_exp_f32 v120, v120
v_exp_f32 v121, v121
v_exp_f32 v122, v122
v_exp_f32 v123, v123
v_cvt_pk_bf16_f32 v72, v104, v105
buffer_load_dwordx4 v6, s[24:27], s58 offen offset:1024 lds
s_add_u32 m0, s59, 124800
s_mov_b32 s58, 917504
v_cvt_pk_bf16_f32 v73, v106, v107
v_cvt_pk_bf16_f32 v74, v120, v121
v_cvt_pk_bf16_f32 v75, v122, v123
v_cvt_pk_bf16_f32 v174, v84, v85
v_cvt_pk_bf16_f32 v175, v86, v87
v_mfma_f32_16x16x32_bf16 v[88:91], v[248:251], v[72:75], 0
ds_read_b128 v[18:21], v11 offset:320
v_cvt_pk_bf16_f32 v184, v92, v93
v_mfma_f32_16x16x32_bf16 v[104:107], v[206:209], v[72:75], 0
ds_read_b128 v[22:25], v11 offset:1344
v_cvt_pk_bf16_f32 v185, v94, v95
v_mfma_f32_16x16x32_bf16 v[120:123], v[216:219], v[72:75], 0
buffer_load_dwordx4 v5, s[24:27], s58 offen lds
v_mfma_f32_16x16x32_bf16 v[100:103], v[188:191], v[172:175], v[46:49]
ds_read_b128 v[240:243], v11 offset:256
v_rcp_f32 v88, v88
v_mfma_f32_16x16x32_bf16 v[116:119], v[192:195], v[172:175], v[50:53]
ds_read_b128 v[244:247], v11 offset:1280
v_cvt_pk_bf16_f32 v186, v108, v109
s_nop 2
v_max3_f32 v84, v100, v101, v102
v_cvt_pk_bf16_f32 v187, v110, v111
v_cvt_pk_bf16_f32 v168, v64, v65
v_pk_mul_f32 v[104:105], v[104:105], v[88:89] op_sel_hi:[1,0]
buffer_load_dwordx4 v6, s[24:27], s58 offen offset:1024 lds
v_pk_mul_f32 v[106:107], v[106:107], v[88:89] op_sel_hi:[1,0]
v_pk_mul_f32 v[120:121], v[120:121], v[88:89] op_sel_hi:[1,0]
v_pk_mul_f32 v[122:123], v[122:123], v[88:89] op_sel_hi:[1,0]
v_cvt_pk_bf16_f32 v176, v104, v105
v_cvt_pk_bf16_f32 v177, v106, v107
v_cvt_pk_bf16_f32 v178, v120, v121
v_cvt_pk_bf16_f32 v179, v122, v123
s_waitcnt lgkmcnt(3)
v_pk_fma_f32 v[128:129], v[18:19], v[44:45], v[128:129] op_sel_hi:[1,0,1]
v_pk_fma_f32 v[130:131], v[20:21], v[44:45], v[130:131] op_sel_hi:[1,0,1]
s_waitcnt lgkmcnt(2)
v_pk_mul_f32 v[128:129], v[128:129], v[22:23]
v_cvt_pk_bf16_f32 v204, v128, v129
v_pk_mul_f32 v[130:131], v[130:131], v[24:25]
v_cvt_pk_bf16_f32 v205, v130, v131
buffer_store_dwordx4 v[176:179], v4, s[16:19], s74 offen offset:3072 sc1
v_pk_fma_f32 v[144:145], v[18:19], v[44:45], v[144:145] op_sel:[0,1,0] op_sel_hi:[1,1,1]
v_pk_mul_f32 v[144:145], v[144:145], v[22:23]
v_cvt_pk_bf16_f32 v214, v144, v145
v_pk_fma_f32 v[146:147], v[20:21], v[44:45], v[146:147] op_sel:[0,1,0] op_sel_hi:[1,1,1]
v_pk_mul_f32 v[146:147], v[146:147], v[24:25]
v_cvt_pk_bf16_f32 v215, v146, v147
v_max3_f32 v85, v103, v116, v117
v_max3_f32 v84, v84, v118, v119
v_max_f32 v86, v84, v85
v_max_f32 v85, v84, v85
v_cvt_pk_bf16_f32 v169, v66, v67
v_cvt_pk_bf16_f32 v170, v80, v81
v_permlane16_swap_b32 v86, v85
v_cvt_pk_bf16_f32 v171, v82, v83
s_waitcnt lgkmcnt(1)
v_pk_fma_f32 v[124:125], v[240:241], v[44:45], v[124:125] op_sel_hi:[1,0,1]
s_waitcnt lgkmcnt(0)
v_pk_mul_f32 v[124:125], v[124:125], v[244:245]
v_pk_fma_f32 v[126:127], v[242:243], v[44:45], v[126:127] op_sel_hi:[1,0,1]
v_pk_mul_f32 v[126:127], v[126:127], v[246:247]
v_pk_fma_f32 v[140:141], v[240:241], v[44:45], v[140:141] op_sel:[0,1,0] op_sel_hi:[1,1,1]
v_pk_mul_f32 v[140:141], v[140:141], v[244:245]
v_pk_fma_f32 v[142:143], v[242:243], v[44:45], v[142:143] op_sel:[0,1,0] op_sel_hi:[1,1,1]
v_pk_mul_f32 v[142:143], v[142:143], v[246:247]
v_max_f32 v84, v86, v85
v_max_f32 v85, v86, v85
v_mfma_f32_16x16x32_bf16 v[96:99], v[184:187], v[168:171], v[46:49]
s_nop 0
v_permlane32_swap_b32 v84, v85
v_mfma_f32_16x16x32_bf16 v[112:115], v[188:191], v[168:171], v[50:53]
v_max_f32 v84, v84, v85
v_mul_f32 v84, v84, v230
v_cvt_pk_bf16_f32 v202, v124, v125
v_cvt_pk_bf16_f32 v203, v126, v127
v_cvt_pk_bf16_f32 v212, v140, v141
v_pk_fma_f32 v[100:101], v[100:101], v[230:231], v[84:85] op_sel_hi:[1,0,0] neg_lo:[0,0,1] neg_hi:[0,0,1]
v_pk_fma_f32 v[102:103], v[102:103], v[230:231], v[84:85] op_sel_hi:[1,0,0] neg_lo:[0,0,1] neg_hi:[0,0,1]
v_pk_fma_f32 v[116:117], v[116:117], v[230:231], v[84:85] op_sel_hi:[1,0,0] neg_lo:[0,0,1] neg_hi:[0,0,1]
v_pk_fma_f32 v[118:119], v[118:119], v[230:231], v[84:85] op_sel_hi:[1,0,0] neg_lo:[0,0,1] neg_hi:[0,0,1]
v_exp_f32 v100, v100
v_exp_f32 v101, v101
v_exp_f32 v102, v102
v_exp_f32 v103, v103
v_exp_f32 v116, v116
v_exp_f32 v117, v117
v_exp_f32 v118, v118
v_exp_f32 v119, v119
v_cvt_pk_bf16_f32 v68, v100, v101
v_cvt_pk_bf16_f32 v69, v102, v103
v_cvt_pk_bf16_f32 v70, v116, v117
v_cvt_pk_bf16_f32 v71, v118, v119
v_cvt_pk_bf16_f32 v213, v142, v143
v_max3_f32 v80, v96, v97, v98
v_mfma_f32_16x16x32_bf16 v[84:87], v[248:251], v[68:71], 0
v_max3_f32 v81, v99, v112, v113
v_max3_f32 v80, v80, v114, v115
v_mfma_f32_16x16x32_bf16 v[100:103], v[204:207], v[68:71], 0
v_max_f32 v82, v80, v81
v_max_f32 v81, v80, v81
v_mfma_f32_16x16x32_bf16 v[116:119], v[214:217], v[68:71], 0
s_nop 1
v_rcp_f32 v84, v84
v_permlane16_swap_b32 v82, v81
v_cvt_pk_bf16_f32 v164, v60, v61
v_pk_mul_f32 v[100:101], v[100:101], v[84:85] op_sel_hi:[1,0]
v_pk_mul_f32 v[102:103], v[102:103], v[84:85] op_sel_hi:[1,0]
s_nop 0
v_pk_mul_f32 v[116:117], v[116:117], v[84:85] op_sel_hi:[1,0]
v_pk_mul_f32 v[118:119], v[118:119], v[84:85] op_sel_hi:[1,0]
v_cvt_pk_bf16_f32 v172, v100, v101
v_cvt_pk_bf16_f32 v173, v102, v103
v_cvt_pk_bf16_f32 v174, v116, v117
v_cvt_pk_bf16_f32 v175, v118, v119
buffer_store_dwordx4 v[172:175], v4, s[16:19], s74 offen offset:2048 sc1
v_max_f32 v80, v82, v81
v_max_f32 v81, v82, v81
v_cvt_pk_bf16_f32 v165, v62, v63
v_cvt_pk_bf16_f32 v166, v76, v77
v_permlane32_swap_b32 v80, v81
v_cvt_pk_bf16_f32 v167, v78, v79
v_max_f32 v80, v80, v81
v_mul_f32 v80, v80, v226
v_mfma_f32_16x16x32_bf16 v[92:95], v[180:183], v[164:167], v[46:49]
v_mfma_f32_16x16x32_bf16 v[108:111], v[184:187], v[164:167], v[50:53]
s_nop 6
v_max3_f32 v76, v92, v93, v94
v_pk_fma_f32 v[96:97], v[96:97], v[226:227], v[80:81] op_sel_hi:[1,0,0] neg_lo:[0,0,1] neg_hi:[0,0,1]
v_pk_fma_f32 v[98:99], v[98:99], v[226:227], v[80:81] op_sel_hi:[1,0,0] neg_lo:[0,0,1] neg_hi:[0,0,1]
v_pk_fma_f32 v[112:113], v[112:113], v[226:227], v[80:81] op_sel_hi:[1,0,0] neg_lo:[0,0,1] neg_hi:[0,0,1]
v_pk_fma_f32 v[114:115], v[114:115], v[226:227], v[80:81] op_sel_hi:[1,0,0] neg_lo:[0,0,1] neg_hi:[0,0,1]
v_exp_f32 v96, v96
v_exp_f32 v97, v97
v_exp_f32 v98, v98
v_exp_f32 v99, v99
v_exp_f32 v112, v112
v_exp_f32 v113, v113
v_exp_f32 v114, v114
v_exp_f32 v115, v115
v_cvt_pk_bf16_f32 v64, v96, v97
v_cvt_pk_bf16_f32 v65, v98, v99
v_cvt_pk_bf16_f32 v66, v112, v113
v_cvt_pk_bf16_f32 v67, v114, v115
v_max3_f32 v77, v95, v108, v109
v_max3_f32 v76, v76, v110, v111
v_mfma_f32_16x16x32_bf16 v[80:83], v[248:251], v[64:67], 0
v_max_f32 v78, v76, v77
v_max_f32 v77, v76, v77
v_mfma_f32_16x16x32_bf16 v[96:99], v[202:205], v[64:67], 0
s_nop 0
v_permlane16_swap_b32 v78, v77
v_mfma_f32_16x16x32_bf16 v[112:115], v[212:215], v[64:67], 0
s_nop 1
v_rcp_f32 v80, v80
v_max_f32 v76, v78, v77
v_max_f32 v77, v78, v77
v_pk_mul_f32 v[96:97], v[96:97], v[80:81] op_sel_hi:[1,0]
v_pk_mul_f32 v[98:99], v[98:99], v[80:81] op_sel_hi:[1,0]
s_nop 0
v_pk_mul_f32 v[112:113], v[112:113], v[80:81] op_sel_hi:[1,0]
v_pk_mul_f32 v[114:115], v[114:115], v[80:81] op_sel_hi:[1,0]
v_cvt_pk_bf16_f32 v168, v96, v97
v_cvt_pk_bf16_f32 v169, v98, v99
v_cvt_pk_bf16_f32 v170, v112, v113
v_cvt_pk_bf16_f32 v171, v114, v115
buffer_store_dwordx4 v[168:171], v4, s[16:19], s74 offen offset:1024 sc1
v_permlane32_swap_b32 v76, v77
v_max_f32 v76, v76, v77
v_mul_f32 v76, v76, v222
v_pk_fma_f32 v[92:93], v[92:93], v[222:223], v[76:77] op_sel_hi:[1,0,0] neg_lo:[0,0,1] neg_hi:[0,0,1]
v_pk_fma_f32 v[94:95], v[94:95], v[222:223], v[76:77] op_sel_hi:[1,0,0] neg_lo:[0,0,1] neg_hi:[0,0,1]
v_pk_fma_f32 v[108:109], v[108:109], v[222:223], v[76:77] op_sel_hi:[1,0,0] neg_lo:[0,0,1] neg_hi:[0,0,1]
v_pk_fma_f32 v[110:111], v[110:111], v[222:223], v[76:77] op_sel_hi:[1,0,0] neg_lo:[0,0,1] neg_hi:[0,0,1]
v_exp_f32 v92, v92
v_exp_f32 v93, v93
v_exp_f32 v94, v94
v_exp_f32 v95, v95
v_exp_f32 v108, v108
v_exp_f32 v109, v109
v_exp_f32 v110, v110
v_exp_f32 v111, v111
v_cvt_pk_bf16_f32 v60, v92, v93
v_cvt_pk_bf16_f32 v61, v94, v95
v_cvt_pk_bf16_f32 v62, v108, v109
v_cvt_pk_bf16_f32 v63, v110, v111
s_nop 1
v_mfma_f32_16x16x32_bf16 v[76:79], v[248:251], v[60:63], 0
v_mfma_f32_16x16x32_bf16 v[92:95], v[200:203], v[60:63], 0
v_mfma_f32_16x16x32_bf16 v[108:111], v[210:213], v[60:63], 0
s_nop 5
v_rcp_f32 v76, v76
s_nop 0
v_pk_mul_f32 v[92:93], v[92:93], v[76:77] op_sel_hi:[1,0]
v_pk_mul_f32 v[94:95], v[94:95], v[76:77] op_sel_hi:[1,0]
v_pk_mul_f32 v[108:109], v[108:109], v[76:77] op_sel_hi:[1,0]
v_pk_mul_f32 v[110:111], v[110:111], v[76:77] op_sel_hi:[1,0]
v_cvt_pk_bf16_f32 v164, v92, v93
v_cvt_pk_bf16_f32 v165, v94, v95
v_cvt_pk_bf16_f32 v166, v108, v109
v_cvt_pk_bf16_f32 v167, v110, v111
buffer_store_dwordx4 v[164:167], v4, s[16:19], s74 offen sc1
s_nop 1
.Lqkve3:
s_lshl_b32 s62, s3, 11
s_add_u32 s62, s62, s84
v_lshl_add_u32 v4, v1, 4, s62
v_lshrrev_b32 v2, 3, v1
v_cmp_eq_u32 vcc, 3, v2
v_add_u32 v2, 67108480, v4
s_nop 0
v_cndmask_b32 v4, v4, v2, vcc
v_bfe_u32 v5, v1, 3, 1
v_lshrrev_b32 v2, 4, v1
v_lshl_add_u32 v5, v2, 3, v5
s_lshl_b32 s62, s3, 1
v_add_u32 v5, s62, v5
v_mul_u32_u24 v5, 2048, v5
v_and_b32 v2, 7, v1
v_lshl_add_u32 v5, v2, 4, v5
s_lshl_b32 s62, s7, 7
v_add_u32 v5, s62, v5
v_add_u32 v6, 64512, v5
v_bfe_u32 v8, v1, 3, 2
v_mul_u32_u24 v8, 2080, v8
v_bfe_u32 v2, v1, 2, 1
v_lshl_add_u32 v8, v2, 7, v8
v_bfe_u32 v2, v1, 5, 1
v_lshl_add_u32 v8, v2, 8, v8
v_and_b32 v2, 3, v1
v_lshl_add_u32 v8, v2, 3, v8
s_mov_b32 s57, 66560
v_add_u32 v7, s57, v8
s_mov_b32 s52, 4194304
s_mov_b32 s53, 4210688
s_mov_b32 s54, 2097152
s_mul_i32 s56, s3, 2080
v_accvgpr_read_b32 v32, a224
v_accvgpr_read_b32 v33, a225
v_accvgpr_read_b32 v34, a226
v_accvgpr_read_b32 v35, a227
v_accvgpr_read_b32 v36, a228
v_accvgpr_read_b32 v37, a229
v_accvgpr_read_b32 v38, a230
v_accvgpr_read_b32 v39, a231
v_accvgpr_read_b32 v40, a232
v_accvgpr_read_b32 v41, a233
v_accvgpr_read_b32 v42, a234
v_accvgpr_read_b32 v43, a235
v_accvgpr_read_b32 v44, a236
v_accvgpr_read_b32 v45, a237
v_accvgpr_read_b32 v46, a238
v_accvgpr_read_b32 v47, a239
v_accvgpr_read_b32 v48, a240
v_accvgpr_read_b32 v49, a241
v_accvgpr_read_b32 v50, a242
v_accvgpr_read_b32 v51, a243
v_accvgpr_read_b32 v52, a244
v_accvgpr_read_b32 v53, a245
v_accvgpr_read_b32 v54, a246
v_accvgpr_read_b32 v55, a247
v_accvgpr_read_b32 v56, a248
v_accvgpr_read_b32 v57, a249
v_accvgpr_read_b32 v58, a250
v_accvgpr_read_b32 v59, a251
v_accvgpr_read_b32 v60, a252
v_accvgpr_read_b32 v61, a253
v_accvgpr_read_b32 v62, a254
v_accvgpr_read_b32 v63, a255
s_lshl_b32 s62, s49, 3
s_add_u32 s62, s62, s48
s_mul_i32 s62, s62, 28672
s_add_u32 s62, s62, s51
v_lshrrev_b32 v12, 4, v1
v_mul_u32_u24 v12, 57344, v12
v_and_b32 v2, 15, v1
v_lshl_add_u32 v12, v2, 4, v12
v_add_u32 v12, s62, v12
v_add_u32 v13, 6112, v12
v_add_u32 v14, 12224, v12
v_add_u32 v15, 18336, v12
s_mul_i32 s59, s3, 4224
s_mov_b32 s58, 0
s_mov_b32 s36, s0
s_mov_b32 s37, s1
s_lshl_b32 s62, s8, 10
s_add_u32 s62, s62, 30425088
s_lshl_b32 s64, s6, 10
s_add_u32 s64, s64, 30425088
s_lshr_b32 s67, s5, 2
s_and_b32 s67, s67, 3
s_lshl_b32 s67, s67, 7
s_add_u32 s64, s64, s67
v_lshl_add_u32 v252, v1, 7, s62
v_mov_b32 v253, s64
v_mov_b32 v255, 1
s_waitcnt vmcnt(0) lgkmcnt(0)
s_cmp_lg_u32 s3, 1
s_barrier
s_cbranch_scc1 .Lnopoll33
s_mov_b64 exec, 15
buffer_atomic_add v255, v252, s[16:19], 0 offen
s_mov_b64 exec, 1
v_mov_b32 v254, 0
buffer_atomic_add v254, v253, s[16:19], 0 offen sc0
s_sleep 5
s_mov_b32 s15, 0
.Lpoll32:
v_mov_b32 v255, 0
buffer_atomic_add v255, v253, s[16:19], 0 offen sc0
s_waitcnt vmcnt(1)
v_cmp_gt_u32 vcc, 16, v254
s_add_u32 s15, s15, 1
s_cbranch_vccz .Lnopoll33r
v_mov_b32 v254, 0
buffer_atomic_add v254, v253, s[16:19], 0 offen sc0
s_waitcnt vmcnt(1)
v_cmp_gt_u32 vcc, 16, v255
s_add_u32 s15, s15, 1
s_cbranch_vccz .Lnopoll33r
s_cmp_le_u32 s15, 100000
s_cbranch_scc1 .Lpoll32
s_branch .Lnopoll33r
.Lnopoll33:
s_mov_b64 exec, 0
s_cmp_eq_u32 s3, 2
s_cbranch_scc1 .Lpad1
s_cmp_eq_u32 s3, 3
s_cbranch_scc1 .Lpad2
s_branch .Lpad3
.Lnopoll33r:
s_mov_b64 exec, -1
s_barrier
buffer_load_dwordx4 v[64:67], v4, s[16:19], s52 offen sc1
buffer_load_dwordx4 v[68:71], v4, s[16:19], s52 offen offset:1024 sc1
s_add_u32 s52, s52, 32768
buffer_load_dwordx4 v[72:75], v4, s[16:19], s53 offen sc1
buffer_load_dwordx4 v[76:79], v4, s[16:19], s53 offen offset:1024 sc1
s_add_u32 s53, s53, 32768
buffer_load_dwordx4 v[80:83], v4, s[16:19], s52 offen sc1
buffer_load_dwordx4 v[84:87], v4, s[16:19], s52 offen offset:1024 sc1
s_add_u32 s52, s52, 32768
buffer_load_dwordx4 v[88:91], v4, s[16:19], s53 offen sc1
buffer_load_dwordx4 v[92:95], v4, s[16:19], s53 offen offset:1024 sc1
s_add_u32 s53, s53, 32768
buffer_load_dwordx4 v[96:99], v4, s[16:19], s52 offen sc1
buffer_load_dwordx4 v[100:103], v4, s[16:19], s52 offen offset:1024 sc1
s_add_u32 s52, s52, 32768
buffer_load_dwordx4 v[104:107], v4, s[16:19], s53 offen sc1
buffer_load_dwordx4 v[108:111], v4, s[16:19], s53 offen offset:1024 sc1
s_add_u32 s53, s53, 32768
ds_read_b64_tr_b16 a[0:1], v7
TR 2,7,512
TR 16,7,1024
TR 18,7,1536
TR 4,7,32
TR 6,7,544
TR 20,7,1056
TR 22,7,1568
TR 8,7,64
TR 10,7,576
TR 24,7,1088
TR 26,7,1600
TR 12,7,96
TR 14,7,608
TR 28,7,1120
TR 30,7,1632
s_waitcnt vmcnt(8) lgkmcnt(14)
MAV 32,0,64
TR 32,7,8320
TR 34,7,8832
s_waitcnt lgkmcnt(14)
MAV 32,16,72
buffer_load_dwordx4 v[112:115], v4, s[16:19], s52 offen sc1
MAV 48,16,76
TR 48,7,9344
TR 50,7,9856
MAV 48,0,68
TR 36,7,8352
s_waitcnt lgkmcnt(15)
MAV 52,4,68
buffer_load_dwordx4 v[116:119], v4, s[16:19], s52 offen offset:1024 sc1
s_waitcnt lgkmcnt(13)
MAV 52,20,76
TR 38,7,8864
s_add_u32 s52, s52, 32768
MAV 36,20,72
TR 52,7,9376
MAV 36,4,64
TR 54,7,9888
s_waitcnt lgkmcnt(14)
MAV 40,8,64
buffer_load_dwordx4 v[120:123], v4, s[16:19], s53 offen sc1
s_waitcnt lgkmcnt(12)
MAV 40,24,72
TR 40,7,8384
TR 42,7,8896
MAV 56,24,76
TR 56,7,9408
MAV 56,8,68
TR 58,7,9920
TR 44,7,8416
s_waitcnt lgkmcnt(15)
MAV 60,12,68
buffer_load_dwordx4 v[124:127], v4, s[16:19], s53 offen offset:1024 sc1
s_waitcnt lgkmcnt(13)
MAV 60,28,76
s_add_u32 s53, s53, 32768
MAV 44,28,72
TR 46,7,8928
TR 60,7,9440
MAV 44,12,64
TR 62,7,9952
s_waitcnt vmcnt(8) lgkmcnt(8)
MAV 32,32,80
TR 0,7,16640
TR 2,7,17152
MAV 32,48,88
buffer_load_dwordx4 v[64:67], v4, s[16:19], s52 offen sc1
MAV 48,48,92
TR 16,7,17664
TR 18,7,18176
MAV 48,32,84
TR 4,7,16672
MAV 52,36,84
buffer_load_dwordx4 v[68:71], v4, s[16:19], s52 offen offset:1024 sc1
MAV 52,52,92
TR 6,7,17184
s_add_u32 s52, s52, 32768
MAV 36,52,88
TR 20,7,17696
MAV 36,36,80
TR 22,7,18208
s_waitcnt lgkmcnt(8)
MAV 40,40,80
buffer_load_dwordx4 v[72:75], v4, s[16:19], s53 offen sc1
MAV 40,56,88
TR 8,7,16704
TR 10,7,17216
MAV 56,56,92
TR 24,7,17728
MAV 56,40,84
TR 26,7,18240
TR 12,7,16736
MAV 60,44,84
buffer_load_dwordx4 v[76:79], v4, s[16:19], s53 offen offset:1024 sc1
MAV 60,60,92
s_add_u32 s53, s53, 32768
MAV 44,60,88
TR 14,7,17248
TR 28,7,17760
MAV 44,44,80
TR 30,7,18272
s_waitcnt vmcnt(8) lgkmcnt(8)
MAV 32,0,96
TR 32,7,24960
TR 34,7,25472
MAV 32,16,104
buffer_load_dwordx4 v[80:83], v4, s[16:19], s52 offen sc1
MAV 48,16,108
TR 48,7,25984
TR 50,7,26496
MAV 48,0,100
TR 36,7,24992
MAV 52,4,100
buffer_load_dwordx4 v[84:87], v4, s[16:19], s52 offen offset:1024 sc1
MAV 52,20,108
TR 38,7,25504
s_add_u32 s52, s52, 32768
MAV 36,20,104
TR 52,7,26016
MAV 36,4,96
TR 54,7,26528
s_waitcnt lgkmcnt(8)
MAV 40,8,96
buffer_load_dwordx4 v[88:91], v4, s[16:19], s53 offen sc1
MAV 40,24,104
TR 40,7,25024
TR 42,7,25536
MAV 56,24,108
TR 56,7,26048
MAV 56,8,100
TR 58,7,26560
TR 44,7,25056
MAV 60,12,100
buffer_load_dwordx4 v[92:95], v4, s[16:19], s53 offen offset:1024 sc1
MAV 60,28,108
s_add_u32 s53, s53, 32768
MAV 44,28,104
TR 46,7,25568
TR 60,7,26080
MAV 44,12,96
TR 62,7,26592
s_waitcnt vmcnt(8) lgkmcnt(8)
MAV 32,32,112
TR 0,7,33280
TR 2,7,33792
MAV 32,48,120
buffer_load_dwordx4 v[96:99], v4, s[16:19], s52 offen sc1
MAV 48,48,124
TR 16,7,34304
TR 18,7,34816
MAV 48,32,116
TR 4,7,33312
MAV 52,36,116
buffer_load_dwordx4 v[100:103], v4, s[16:19], s52 offen offset:1024 sc1
MAV 52,52,124
TR 6,7,33824
s_add_u32 s52, s52, 32768
MAV 36,52,120
TR 20,7,34336
MAV 36,36,112
TR 22,7,34848
s_waitcnt lgkmcnt(8)
MAV 40,40,112
buffer_load_dwordx4 v[104:107], v4, s[16:19], s53 offen sc1
MAV 40,56,120
TR 8,7,33344
TR 10,7,33856
MAV 56,56,124
TR 24,7,34368
MAV 56,40,116
TR 26,7,34880
TR 12,7,33376
MAV 60,44,116
buffer_load_dwordx4 v[108:111], v4, s[16:19], s53 offen offset:1024 sc1
MAV 60,60,124
s_add_u32 s53, s53, 32768
MAV 44,60,120
TR 14,7,33888
TR 28,7,34400
MAV 44,44,112
TR 30,7,34912
s_waitcnt vmcnt(8) lgkmcnt(8)
MAV 32,0,64
TR 32,7,41600
TR 34,7,42112
MAV 32,16,72
buffer_load_dwordx4 v[112:115], v4, s[16:19], s52 offen sc1
MAV 48,16,76
TR 48,7,42624
TR 50,7,43136
MAV 48,0,68
TR 36,7,41632
MAV 52,4,68
buffer_load_dwordx4 v[116:119], v4, s[16:19], s52 offen offset:1024 sc1
MAV 52,20,76
TR 38,7,42144
s_add_u32 s52, s52, 32768
MAV 36,20,72
TR 52,7,42656
MAV 36,4,64
TR 54,7,43168
s_waitcnt lgkmcnt(8)
MAV 40,8,64
buffer_load_dwordx4 v[120:123], v4, s[16:19], s53 offen sc1
MAV 40,24,72
TR 40,7,41664
TR 42,7,42176
MAV 56,24,76
TR 56,7,42688
MAV 56,8,68
TR 58,7,43200
TR 44,7,41696
MAV 60,12,68
buffer_load_dwordx4 v[124:127], v4, s[16:19], s53 offen offset:1024 sc1
MAV 60,28,76
s_add_u32 s53, s53, 32768
MAV 44,28,72
TR 46,7,42208
TR 60,7,42720
MAV 44,12,64
TR 62,7,43232
s_waitcnt vmcnt(8) lgkmcnt(8)
MAV 32,32,80
TR 0,7,49920
TR 2,7,50432
MAV 32,48,88
buffer_load_dwordx4 v[64:67], v4, s[16:19], s52 offen sc1
MAV 48,48,92
TR 16,7,50944
TR 18,7,51456
MAV 48,32,84
TR 4,7,49952
MAV 52,36,84
buffer_load_dwordx4 v[68:71], v4, s[16:19], s52 offen offset:1024 sc1
MAV 52,52,92
TR 6,7,50464
s_add_u32 s52, s52, 32768
MAV 36,52,88
TR 20,7,50976
MAV 36,36,80
TR 22,7,51488
s_waitcnt lgkmcnt(8)
MAV 40,40,80
buffer_load_dwordx4 v[72:75], v4, s[16:19], s53 offen sc1
MAV 40,56,88
TR 8,7,49984
TR 10,7,50496
MAV 56,56,92
TR 24,7,51008
MAV 56,40,84
TR 26,7,51520
TR 12,7,50016
MAV 60,44,84
buffer_load_dwordx4 v[76:79], v4, s[16:19], s53 offen offset:1024 sc1
MAV 60,60,92
s_add_u32 s53, s53, 32768
MAV 44,60,88
TR 14,7,50528
TR 28,7,51040
MAV 44,44,80
TR 30,7,51552
s_waitcnt vmcnt(8) lgkmcnt(8)
MAV 32,0,96
TR 32,7,58240
TR 34,7,58752
MAV 32,16,104
buffer_load_dwordx4 v[80:83], v4, s[16:19], s52 offen sc1
MAV 48,16,108
TR 48,7,59264
TR 50,7,59776
MAV 48,0,100
TR 36,7,58272
MAV 52,4,100
buffer_load_dwordx4 v[84:87], v4, s[16:19], s52 offen offset:1024 sc1
MAV 52,20,108
TR 38,7,58784
s_add_u32 s52, s52, 32768
MAV 36,20,104
TR 52,7,59296
MAV 36,4,96
TR 54,7,59808
s_waitcnt lgkmcnt(8)
MAV 40,8,96
buffer_load_dwordx4 v[88:91], v4, s[16:19], s53 offen sc1
MAV 40,24,104
TR 40,7,58304
TR 42,7,58816
MAV 56,24,108
TR 56,7,59328
MAV 56,8,100
TR 58,7,59840
TR 44,7,58336
MAV 60,12,100
buffer_load_dwordx4 v[92:95], v4, s[16:19], s53 offen offset:1024 sc1
MAV 60,28,108
s_add_u32 s53, s53, 32768
MAV 44,28,104
TR 46,7,58848
TR 60,7,59360
MAV 44,12,96
TR 62,7,59872
s_xor_b32 s57, s57, 66560
v_add_u32 v7, s57, v8
s_waitcnt vmcnt(8) lgkmcnt(8)
MAV 32,32,112
ds_read_b64_tr_b16 a[0:1], v7
TR 2,7,512
MAV 32,48,120
buffer_load_dwordx4 v[96:99], v4, s[16:19], s52 offen sc1
MAV 48,48,124
TR 16,7,1024
TR 18,7,1536
MAV 48,32,116
TR 4,7,32
MAV 52,36,116
buffer_load_dwordx4 v[100:103], v4, s[16:19], s52 offen offset:1024 sc1
MAV 52,52,124
TR 6,7,544
s_add_u32 s52, s52, 32768
MAV 36,52,120
TR 20,7,1056
MAV 36,36,112
TR 22,7,1568
s_waitcnt lgkmcnt(8)
MAV 40,40,112
buffer_load_dwordx4 v[104:107], v4, s[16:19], s53 offen sc1
MAV 40,56,120
TR 8,7,64
TR 10,7,576
MAV 56,56,124
TR 24,7,1088
MAV 56,40,116
TR 26,7,1600
TR 12,7,96
MAV 60,44,116
buffer_load_dwordx4 v[108:111], v4, s[16:19], s53 offen offset:1024 sc1
MAV 60,60,124
s_add_u32 s53, s53, 32768
MAV 44,60,120
TR 14,7,608
TR 28,7,1120
MAV 44,44,112
TR 30,7,1632
s_waitcnt vmcnt(8) lgkmcnt(8)
MAV 32,0,64
TR 32,7,8320
TR 34,7,8832
MAV 32,16,72
buffer_load_dwordx4 v[112:115], v4, s[16:19], s52 offen sc1
MAV 48,16,76
TR 48,7,9344
TR 50,7,9856
MAV 48,0,68
TR 36,7,8352
MAV 52,4,68
buffer_load_dwordx4 v[116:119], v4, s[16:19], s52 offen offset:1024 sc1
MAV 52,20,76
TR 38,7,8864
s_add_u32 s52, s52, 32768
MAV 36,20,72
TR 52,7,9376
MAV 36,4,64
TR 54,7,9888
s_waitcnt lgkmcnt(8)
MAV 40,8,64
buffer_load_dwordx4 v[120:123], v4, s[16:19], s53 offen sc1
MAV 40,24,72
TR 40,7,8384
TR 42,7,8896
MAV 56,24,76
TR 56,7,9408
MAV 56,8,68
TR 58,7,9920
TR 44,7,8416
MAV 60,12,68
buffer_load_dwordx4 v[124:127], v4, s[16:19], s53 offen offset:1024 sc1
MAV 60,28,76
s_add_u32 s53, s53, 32768
MAV 44,28,72
TR 46,7,8928
TR 60,7,9440
MAV 44,12,64
TR 62,7,9952
s_waitcnt vmcnt(8) lgkmcnt(8)
MAV 32,32,80
TR 0,7,16640
TR 2,7,17152
MAV 32,48,88
buffer_load_dwordx4 v[64:67], v4, s[16:19], s52 offen sc1
MAV 48,48,92
TR 16,7,17664
TR 18,7,18176
MAV 48,32,84
TR 4,7,16672
MAV 52,36,84
buffer_load_dwordx4 v[68:71], v4, s[16:19], s52 offen offset:1024 sc1
MAV 52,52,92
TR 6,7,17184
s_add_u32 s52, s52, 32768
MAV 36,52,88
TR 20,7,17696
MAV 36,36,80
TR 22,7,18208
s_waitcnt lgkmcnt(8)
MAV 40,40,80
buffer_load_dwordx4 v[72:75], v4, s[16:19], s53 offen sc1
MAV 40,56,88
TR 8,7,16704
TR 10,7,17216
MAV 56,56,92
TR 24,7,17728
MAV 56,40,84
TR 26,7,18240
TR 12,7,16736
MAV 60,44,84
buffer_load_dwordx4 v[76:79], v4, s[16:19], s53 offen offset:1024 sc1
MAV 60,60,92
s_add_u32 s53, s53, 32768
MAV 44,60,88
TR 14,7,17248
TR 28,7,17760
MAV 44,44,80
TR 30,7,18272
s_waitcnt vmcnt(8) lgkmcnt(8)
MAV 32,0,96
TR 32,7,24960
TR 34,7,25472
MAV 32,16,104
buffer_load_dwordx4 v[80:83], v4, s[16:19], s52 offen sc1
MAV 48,16,108
TR 48,7,25984
TR 50,7,26496
MAV 48,0,100
TR 36,7,24992
MAV 52,4,100
buffer_load_dwordx4 v[84:87], v4, s[16:19], s52 offen offset:1024 sc1
MAV 52,20,108
TR 38,7,25504
s_add_u32 s52, s52, 32768
MAV 36,20,104
TR 52,7,26016
MAV 36,4,96
TR 54,7,26528
s_waitcnt lgkmcnt(8)
MAV 40,8,96
buffer_load_dwordx4 v[88:91], v4, s[16:19], s53 offen sc1
MAV 40,24,104
TR 40,7,25024
TR 42,7,25536
MAV 56,24,108
TR 56,7,26048
MAV 56,8,100
TR 58,7,26560
TR 44,7,25056
MAV 60,12,100
buffer_load_dwordx4 v[92:95], v4, s[16:19], s53 offen offset:1024 sc1
MAV 60,28,108
s_add_u32 s53, s53, 32768
MAV 44,28,104
TR 46,7,25568
TR 60,7,26080
MAV 44,12,96
TR 62,7,26592
.Lpad1:
s_cbranch_execz .Lpad4
s_waitcnt vmcnt(8) lgkmcnt(8)
MAV 32,32,112
TR 0,7,33280
TR 2,7,33792
MAV 32,48,120
buffer_load_dwordx4 v[96:99], v4, s[16:19], s52 offen sc1
MAV 48,48,124
TR 16,7,34304
TR 18,7,34816
MAV 48,32,116
TR 4,7,33312
MAV 52,36,116
buffer_load_dwordx4 v[100:103], v4, s[16:19], s52 offen offset:1024 sc1
MAV 52,52,124
TR 6,7,33824
s_add_u32 s52, s52, 32768
MAV 36,52,120
TR 20,7,34336
MAV 36,36,112
TR 22,7,34848
s_waitcnt lgkmcnt(8)
MAV 40,40,112
buffer_load_dwordx4 v[104:107], v4, s[16:19], s53 offen sc1
MAV 40,56,120
TR 8,7,33344
TR 10,7,33856
MAV 56,56,124
TR 24,7,34368
MAV 56,40,116
TR 26,7,34880
TR 12,7,33376
MAV 60,44,116
buffer_load_dwordx4 v[108:111], v4, s[16:19], s53 offen offset:1024 sc1
MAV 60,60,124
s_add_u32 s53, s53, 32768
MAV 44,60,120
TR 14,7,33888
TR 28,7,34400
MAV 44,44,112
TR 30,7,34912
s_waitcnt vmcnt(8) lgkmcnt(8)
MAV 32,0,64
TR 32,7,41600
TR 34,7,42112
MAV 32,16,72
buffer_load_dwordx4 v[112:115], v4, s[16:19], s52 offen sc1
MAV 48,16,76
TR 48,7,42624
TR 50,7,43136
MAV 48,0,68
TR 36,7,41632
MAV 52,4,68
buffer_load_dwordx4 v[116:119], v4, s[16:19], s52 offen offset:1024 sc1
MAV 52,20,76
TR 38,7,42144
s_add_u32 s52, s52, 32768
MAV 36,20,72
TR 52,7,42656
MAV 36,4,64
TR 54,7,43168
s_waitcnt lgkmcnt(8)
MAV 40,8,64
buffer_load_dwordx4 v[120:123], v4, s[16:19], s53 offen sc1
MAV 40,24,72
TR 40,7,41664
TR 42,7,42176
MAV 56,24,76
TR 56,7,42688
MAV 56,8,68
TR 58,7,43200
TR 44,7,41696
MAV 60,12,68
buffer_load_dwordx4 v[124:127], v4, s[16:19], s53 offen offset:1024 sc1
MAV 60,28,76
s_add_u32 s53, s53, 32768
MAV 44,28,72
TR 46,7,42208
TR 60,7,42720
MAV 44,12,64
TR 62,7,43232
s_barrier
s_waitcnt vmcnt(8) lgkmcnt(8)
MAV 32,32,80
TR 0,7,49920
s_add_u32 m0, s59, 84480
MAV 32,48,88
buffer_load_dwordx4 v12, s[32:35], s58 offen   lds
MAV 48,48,92
TR 2,7,50432
TR 16,7,50944
MAV 48,32,84
TR 18,7,51456
MAV 52,36,84
buffer_load_dwordx4 v13, s[32:35], s58 offen offset:1056   lds
MAV 52,52,92
TR 4,7,49952
TR 6,7,50464
MAV 36,52,88
TR 20,7,50976
MAV 36,36,80
TR 22,7,51488
s_waitcnt lgkmcnt(8)
MAV 40,40,80
buffer_load_dwordx4 v14, s[32:35], s58 offen offset:2112   lds
MAV 40,56,88
TR 8,7,49984
MAV 56,56,92
TR 10,7,50496
TR 24,7,51008
MAV 56,40,84
TR 26,7,51520
MAV 60,44,84
buffer_load_dwordx4 v15, s[32:35], s58 offen offset:3168   lds
MAV 60,60,92
TR 12,7,50016
TR 14,7,50528
MAV 44,60,88
TR 28,7,51040
MAV 44,44,80
TR 30,7,51552
s_waitcnt vmcnt(8) lgkmcnt(8)
MAV 32,0,96
TR 32,7,58240
s_add_u32 m0, s59, 101376
MAV 32,16,104
buffer_load_dwordx4 v12, s[80:83], s58 offen   lds
MAV 48,16,108
TR 34,7,58752
TR 48,7,59264
MAV 48,0,100
TR 50,7,59776
MAV 52,4,100
buffer_load_dwordx4 v13, s[80:83], s58 offen offset:1056   lds
MAV 52,20,108
TR 36,7,58272
TR 38,7,58784
MAV 36,20,104
TR 52,7,59296
MAV 36,4,96
TR 54,7,59808
s_waitcnt lgkmcnt(8)
MAV 40,8,96
buffer_load_dwordx4 v14, s[80:83], s58 offen offset:2112   lds
MAV 40,24,104
TR 40,7,58304
TR 42,7,58816
MAV 56,24,108
TR 56,7,59328
MAV 56,8,100
TR 58,7,59840
TR 44,7,58336
MAV 60,12,100
buffer_load_dwordx4 v15, s[80:83], s58 offen offset:3168   lds
MAV 60,28,108
s_add_u32 s58, s58, 458752
MAV 44,28,104
TR 46,7,58848
TR 60,7,59360
MAV 44,12,96
TR 62,7,59872
s_waitcnt vmcnt(11) lgkmcnt(14)
MAV 32,32,112
s_add_u32 m0, s59, 118272
s_lshl_b32 s64, s6, 14
s_lshl_b32 s65, s49, 13
s_waitcnt vmcnt(9) lgkmcnt(12)
MAV 32,48,120
buffer_load_dwordx4 v12, s[32:35], s58 offen   lds
s_waitcnt vmcnt(9)
MAV 48,48,124
s_add_u32 s64, s64, s65
s_lshl_b32 s65, s7, 9
s_add_u32 s64, s64, s65
MAV 48,32,116
s_lshl_b32 s65, s48, 8
s_add_u32 s64, s64, s65
s_add_u32 s64, s64, 29622272
s_waitcnt lgkmcnt(10)
MAV 52,36,116
s_lshl_b32 s62, s7, 15
v_and_b32 v152, 31, v1
v_lshlrev_b32 v152, 3, v152
s_waitcnt lgkmcnt(8)
MAV 52,52,124
buffer_load_dwordx4 v13, s[32:35], s58 offen offset:1056   lds
MAV 36,52,120
s_add_u32 s62, s62, 8388608
v_lshrrev_b32 v153, 5, v1
v_lshl_add_u32 v152, v153, 28, v152
MAV 36,36,112
s_add_u32 s63, s62, 16384
v_cvt_pk_bf16_f32 v128, v32, v33
v_cvt_pk_bf16_f32 v129, v34, v35
s_waitcnt lgkmcnt(6)
MAV 40,40,112
v_cvt_pk_bf16_f32 v136, v48, v49
v_cvt_pk_bf16_f32 v137, v50, v51
s_waitcnt lgkmcnt(4)
MAV 40,56,120
buffer_load_dwordx4 v14, s[32:35], s58 offen offset:2112   lds
MAV 56,56,124
v_cvt_pk_bf16_f32 v130, v36, v37
v_cvt_pk_bf16_f32 v131, v38, v39
MAV 56,40,116
s_nop 2
v_cvt_pk_bf16_f32 v132, v40, v41
v_cvt_pk_bf16_f32 v133, v42, v43
s_waitcnt lgkmcnt(2)
MAV 60,44,116
v_cvt_pk_bf16_f32 v138, v52, v53
v_cvt_pk_bf16_f32 v139, v54, v55
s_waitcnt lgkmcnt(0)
MAV 60,60,124
buffer_load_dwordx4 v15, s[32:35], s58 offen offset:3168   lds
MAV 44,60,120
v_cvt_pk_bf16_f32 v140, v56, v57
v_cvt_pk_bf16_f32 v141, v58, v59
MAV 44,44,112
s_nop 2
v_cvt_pk_bf16_f32 v142, v60, v61
v_cvt_pk_bf16_f32 v143, v62, v63
v_pk_mul_f32 v[146:147], v[32:33], v[32:33]
v_pk_mul_f32 v[150:151], v[48:49], v[48:49]
buffer_store_dwordx4 v[128:131], v4, s[16:19], s62 offen sc1
v_cvt_pk_bf16_f32 v134, v44, v45
v_cvt_pk_bf16_f32 v135, v46, v47
v_pk_fma_f32 v[146:147], v[34:35], v[34:35], v[146:147]
v_pk_add_f32 v[144:145], v[32:33], v[34:35]
v_pk_fma_f32 v[150:151], v[50:51], v[50:51], v[150:151]
v_pk_add_f32 v[148:149], v[48:49], v[50:51]
v_pk_fma_f32 v[146:147], v[36:37], v[36:37], v[146:147]
v_pk_add_f32 v[144:145], v[144:145], v[36:37]
v_pk_fma_f32 v[150:151], v[52:53], v[52:53], v[150:151]
v_pk_add_f32 v[148:149], v[148:149], v[52:53]
v_pk_fma_f32 v[146:147], v[38:39], v[38:39], v[146:147]
v_pk_add_f32 v[144:145], v[144:145], v[38:39]
v_pk_fma_f32 v[150:151], v[54:55], v[54:55], v[150:151]
buffer_store_dwordx4 v[132:135], v4, s[16:19], s63 offen sc1
v_pk_add_f32 v[148:149], v[148:149], v[54:55]
v_pk_fma_f32 v[146:147], v[40:41], v[40:41], v[146:147]
v_pk_add_f32 v[144:145], v[144:145], v[40:41]
v_pk_fma_f32 v[150:151], v[56:57], v[56:57], v[150:151]
v_pk_add_f32 v[148:149], v[148:149], v[56:57]
v_pk_fma_f32 v[146:147], v[42:43], v[42:43], v[146:147]
v_pk_add_f32 v[144:145], v[144:145], v[42:43]
v_pk_fma_f32 v[150:151], v[58:59], v[58:59], v[150:151]
v_pk_add_f32 v[148:149], v[148:149], v[58:59]
v_pk_fma_f32 v[146:147], v[44:45], v[44:45], v[146:147]
v_pk_add_f32 v[144:145], v[144:145], v[44:45]
v_pk_fma_f32 v[150:151], v[60:61], v[60:61], v[150:151]
v_pk_add_f32 v[148:149], v[148:149], v[60:61]
buffer_store_dwordx4 v[136:139], v4, s[16:19], s62 offen offset:1024 sc1
v_pk_fma_f32 v[146:147], v[46:47], v[46:47], v[146:147]
v_pk_add_f32 v[144:145], v[144:145], v[46:47]
v_pk_fma_f32 v[150:151], v[62:63], v[62:63], v[150:151]
v_pk_add_f32 v[148:149], v[148:149], v[62:63]
v_add_f32 v144, v144, v145
v_add_f32 v146, v146, v147
v_add_f32 v148, v148, v149
v_add_f32 v150, v150, v151
s_nop 0
v_permlane16_swap_b32 v144, v148
v_permlane16_swap_b32 v146, v150
v_add_f32 v144, v144, v148
buffer_store_dwordx4 v[140:143], v4, s[16:19], s63 offen offset:1024 sc1
v_add_f32 v146, v146, v150
s_nop 1
v_permlane32_swap_b32 v144, v146
v_add_f32 v144, v144, v146
s_nop 1
v_permlane32_swap_b32 v144, v145
buffer_store_dwordx2 v[144:145], v152, s[16:19], s64 offen sc1
s_nop 1
v_accvgpr_write_b32 a224, v32
v_accvgpr_write_b32 a225, v33
v_accvgpr_write_b32 a226, v34
v_accvgpr_write_b32 a227, v35
v_accvgpr_write_b32 a228, v36
v_accvgpr_write_b32 a229, v37
v_accvgpr_write_b32 a230, v38
v_accvgpr_write_b32 a231, v39
v_accvgpr_write_b32 a232, v40
v_accvgpr_write_b32 a233, v41
v_accvgpr_write_b32 a234, v42
v_accvgpr_write_b32 a235, v43
v_accvgpr_write_b32 a236, v44
v_accvgpr_write_b32 a237, v45
v_accvgpr_write_b32 a238, v46
v_accvgpr_write_b32 a239, v47
v_accvgpr_write_b32 a240, v48
v_accvgpr_write_b32 a241, v49
v_accvgpr_write_b32 a242, v50
v_accvgpr_write_b32 a243, v51
v_accvgpr_write_b32 a244, v52
v_accvgpr_write_b32 a245, v53
v_accvgpr_write_b32 a246, v54
v_accvgpr_write_b32 a247, v55
v_accvgpr_write_b32 a248, v56
v_accvgpr_write_b32 a249, v57
v_accvgpr_write_b32 a250, v58
v_accvgpr_write_b32 a251, v59
v_accvgpr_write_b32 a252, v60
v_accvgpr_write_b32 a253, v61
v_accvgpr_write_b32 a254, v62
v_accvgpr_write_b32 a255, v63
s_lshl_b32 s62, s10, 19
s_lshl_b32 s63, s3, 12
s_add_u32 s62, s62, s63
s_lshl_b32 s63, s12, 11
s_add_u32 s62, s62, s63
v_lshl_add_u32 v10, v1, 4, s62
v_lshrrev_b32 v2, 3, v1
v_cmp_eq_u32 vcc, 3, v2
v_add_u32 v2, 67108480, v10
s_nop 0
v_cndmask_b32 v10, v10, v2, vcc
v_xor_b32 v11, 2048, v10
v_bfe_u32 v16, v1, 2, 3
v_mul_u32_u24 v16, 1056, v16
v_bfe_u32 v2, v1, 5, 1
v_lshl_add_u32 v16, v2, 8, v16
v_and_b32 v2, 3, v1
v_lshl_add_u32 v16, v2, 3, v16
s_lshl_b32 s62, s12, 6
s_add_u32 s62, s62, 84480
s_xor_b32 s63, s12, 1
s_mul_i32 s63, s63, 192
s_add_u32 s63, s63, 84480
v_add_u32 v17, s63, v16
v_add_u32 v16, s62, v16
s_mov_b32 s52, 8388608
s_mov_b32 s53, 8388608
s_mov_b32 s54, s58
s_mov_b32 s55, s59
s_mul_i32 s59, s3, 2112
s_and_b32 s62, s7, 1
s_mul_i32 s62, s62, 3670016
s_lshr_b32 s63, s7, 1
s_lshl_b32 s63, s63, 8
s_add_u32 s62, s62, s63
s_lshl_b32 s63, s3, 12
s_add_u32 s62, s62, s63
v_lshrrev_b32 v5, 4, v1
v_lshlrev_b32 v5, 14, v5
v_and_b32 v2, 15, v1
v_lshl_add_u32 v5, v2, 4, v5
v_add_u32 v5, s62, v5
v_add_u32 v6, 992, v5
s_lshl_b32 s62, s10, 15
s_lshl_b32 s63, s3, 13
s_add_u32 s62, s62, s63
v_lshl_add_u32 v4, v1, 4, s62
s_and_b32 s47, s5, 3
s_lshr_b32 s63, s5, 2
s_lshl_b32 s63, s63, 3
s_add_u32 s63, s63, s4
s_lshl_b32 s62, s63, 1
s_add_u32 s62, s62, s48
s_mul_i32 s62, s62, 1792
v_lshrrev_b32 v7, 2, v1
v_min_u32 v8, 13, v7
v_lshl_add_u32 v8, v8, 7, s62
s_lshl_b32 s62, s63, 2
s_add_u32 s62, s62, s3
s_mul_i32 s62, s62, 640
v_and_b32 v7, 7, v7
v_min_u32 v7, 4, v7
v_lshl_add_u32 v7, v7, 7, s62
v_lshrrev_b32 v2, 5, v1
v_mul_u32_u24 v2, 3670016, v2
v_add_u32 v7, v7, v2
s_mul_i32 s44, s47, 163840
s_add_u32 s45, s47, 12
s_mul_i32 s45, s45, 229376
v_and_b32 v2, 1, v1
v_lshlrev_b32 v2, 4, v2
v_mov_b32 v9, 0x3f80
v_lshlrev_b32 v2, v2, v9
v_bfe_u32 v9, v1, 1, 3
v_cmp_eq_u32 vcc, 0, v9
s_nop 1
v_cndmask_b32 v20, 0, v2, vcc
v_cmp_eq_u32 vcc, 1, v9
s_nop 1
v_cndmask_b32 v21, 0, v2, vcc
v_cmp_eq_u32 vcc, 2, v9
s_nop 1
v_cndmask_b32 v22, 0, v2, vcc
v_cmp_eq_u32 vcc, 3, v9
s_nop 1
v_cndmask_b32 v23, 0, v2, vcc
v_accvgpr_write_b32 a208, v20
v_accvgpr_write_b32 a209, v21
v_accvgpr_write_b32 a210, v22
v_accvgpr_write_b32 a211, v23
s_cmp_lt_u32 s3, 2
s_cselect_b32 s40, s32, s80
s_cselect_b32 s41, s33, s81
s_cselect_b32 s42, s34, s82
s_add_u32 s62, s55, 84480
v_lshl_add_u32 v9, v1, 4, s62
s_lshl_b32 s62, s6, 10
s_add_u32 s62, s62, 30441472
s_lshl_b32 s64, s10, 1
s_lshl_b32 s64, s64, 10
s_add_u32 s64, s64, 30441472
s_lshr_b32 s67, s5, 2
s_and_b32 s67, s67, 3
s_lshl_b32 s67, s67, 7
s_add_u32 s64, s64, s67
s_add_u32 s65, s64, 1024
v_lshl_add_u32 v252, v1, 7, s62
v_mov_b32 v253, s64
v_mov_b32 v255, 1
v_writelane_b32 v253, s65, 1
s_waitcnt vmcnt(0) lgkmcnt(0)
s_cmp_lg_u32 s3, 1
s_barrier
s_cbranch_scc1 .Lnopoll36
s_mov_b64 exec, 15
buffer_atomic_add v255, v252, s[16:19], 0 offen
s_mov_b64 exec, 3
v_mov_b32 v254, 0
buffer_atomic_add v254, v253, s[16:19], 0 offen sc0
s_sleep 5
s_mov_b32 s15, 0
.Lpoll35:
v_mov_b32 v255, 0
buffer_atomic_add v255, v253, s[16:19], 0 offen sc0
s_waitcnt vmcnt(1)
v_cmp_gt_u32 vcc, 16, v254
s_add_u32 s15, s15, 1
s_cbranch_vccz .Lnopoll36r
v_mov_b32 v254, 0
buffer_atomic_add v254, v253, s[16:19], 0 offen sc0
s_waitcnt vmcnt(1)
v_cmp_gt_u32 vcc, 16, v255
s_add_u32 s15, s15, 1
s_cbranch_vccz .Lnopoll36r
s_cmp_le_u32 s15, 100000
s_cbranch_scc1 .Lpoll35
s_branch .Lnopoll36r
.Lnopoll36:
s_mov_b64 exec, 0
s_cmp_eq_u32 s3, 2
s_cbranch_scc1 .Lpad6
s_cmp_eq_u32 s3, 3
s_cbranch_scc1 .Lpad7
s_branch .Lpad8
.Lnopoll36r:
s_mov_b64 exec, -1
s_barrier
buffer_load_dwordx4 a[128:131], v10, s[16:19], s52 offen sc1
buffer_load_dwordx4 a[132:135], v10, s[16:19], s52 offen offset:1024 sc1
s_add_u32 s52, s52, 16384
buffer_load_dwordx4 a[144:147], v10, s[16:19], s52 offen sc1
buffer_load_dwordx4 a[148:151], v10, s[16:19], s52 offen offset:1024 sc1
s_add_u32 s52, s52, 16384
buffer_load_dwordx4 a[136:139], v11, s[16:19], s53 offen sc1
buffer_load_dwordx4 a[140:143], v11, s[16:19], s53 offen offset:1024 sc1
s_add_u32 s53, s53, 16384
buffer_load_dwordx4 a[152:155], v11, s[16:19], s53 offen sc1
buffer_load_dwordx4 a[156:159], v11, s[16:19], s53 offen offset:1024 sc1
s_add_u32 s53, s53, 16384
ds_read_b64_tr_b16 a[0:1], v16
TR 2,16,512
TR 4,16,8448
TR 6,16,8960
TR 8,16,32
TR 10,16,544
TR 12,16,8480
TR 14,16,8992
TR 16,16,64
TR 18,16,576
TR 20,16,8512
TR 22,16,9024
TR 24,16,96
TR 26,16,608
TR 28,16,8544
TR 30,16,9056
TR 32,16,128
TR 34,16,640
TR 36,16,8576
TR 38,16,9088
TR 40,16,160
TR 42,16,672
TR 44,16,8608
TR 46,16,9120
ds_read_b64_tr_b16 a[48:49], v17
TR 50,17,512
TR 52,17,8448
TR 54,17,8960
TR 56,17,32
TR 58,17,544
TR 60,17,8480
TR 62,17,8992
ds_read_b128 a[192:195], v9
RD 196,9,1056
RD 200,9,2112
RD 204,9,3168
s_add_u32 m0, s55, 135168
s_nop 0
buffer_load_dwordx4 v12, s[80:83], s54 offen   lds
buffer_load_dwordx4 v13, s[80:83], s54 offen offset:1056   lds
buffer_load_dwordx4 v14, s[80:83], s54 offen offset:2112   lds
buffer_load_dwordx4 v15, s[80:83], s54 offen offset:3168   lds
s_add_u32 s54, s54, 458752
s_mul_i32 s66, s13, 114688
s_mul_i32 s65, s10, 1310720
s_add_u32 s66, s66, s65
s_add_u32 s66, s66, 12582912
s_add_u32 s65, s66, 49152
s_lshl_b32 s62, s12, 16
s_add_u32 s62, s62, s66
s_add_u32 s63, s62, 16384
s_add_u32 s64, s62, 32768
s_lshl_b32 s72, s10, 1
s_lshr_b32 s74, s11, 4
s_add_u32 s72, s72, s74
s_lshl_b32 s72, s72, 10
s_add_u32 s72, s72, 30457856
s_and_b32 s73, s6, 14
s_and_b32 s74, s7, 1
s_add_u32 s73, s73, s74
s_lshl_b32 s73, s73, 10
s_add_u32 s73, s73, 30457856
s_lshr_b32 s67, s5, 2
s_and_b32 s67, s67, 3
s_lshl_b32 s67, s67, 7
s_add_u32 s73, s73, s67
s_and_b32 s74, s7, 1
s_mul_i32 s87, s74, 917504
s_lshr_b32 s75, s6, 1
s_mul_i32 s75, s75, 1310720
s_add_u32 s87, s87, s75
s_add_u32 s87, s87, 12582912
s_and_b32 s74, s6, 3
s_xor_b32 s75, s74, 0
s_sub_u32 s75, s75, 0
s_mul_i32 s98, s75, 458752
s_mul_i32 s75, s75, 114688
s_add_u32 s76, s87, s75
s_xor_b32 s75, s74, 1
s_sub_u32 s75, s75, 1
s_mul_i32 s99, s75, 458752
s_mul_i32 s75, s75, 114688
s_add_u32 s77, s87, s75
s_xor_b32 s75, s74, 2
s_sub_u32 s75, s75, 2
s_mul_i32 s100, s75, 458752
s_mul_i32 s75, s75, 114688
s_add_u32 s78, s87, s75
s_xor_b32 s75, s74, 3
s_sub_u32 s75, s75, 3
s_mul_i32 s101, s75, 458752
s_mul_i32 s75, s75, 114688
s_add_u32 s79, s87, s75
s_and_b32 s87, s6, 3
s_mov_b32 s46, 0
s_lshl_b32 s74, s3, 10
s_lshl_b32 s75, s12, 9
s_add_u32 s74, s74, s75
s_add_u32 s74, s74, 152576
v_and_b32 v18, 15, v1
v_lshl_add_u32 v18, v18, 4, s74
v_xor_b32 v19, 512, v18
s_lshl_b32 s74, s3, 13
s_add_u32 s74, s74, 49920
v_lshl_add_u32 v2, v1, 4, s74
s_waitcnt lgkmcnt(0)
s_barrier
s_waitcnt vmcnt(11)
v_mfma_f32_16x16x32_bf16 v[32:35], a[0:3], a[128:131], 0
buffer_load_dwordx4 a[160:163], v10, s[16:19], s52 offen sc1
s_waitcnt vmcnt(10)
MAA 32,4,144
TR 64,16,16896
v_mfma_f32_16x16x32_bf16 a[212:215], a[208:211], a[192:195], 0
TR 66,16,17408
v_mfma_f32_16x16x32_bf16 a[212:215], a[208:211], a[196:199], a[212:215]
TR 68,16,25344
v_mfma_f32_16x16x32_bf16 a[212:215], a[208:211], a[200:203], a[212:215]
buffer_load_dwordx4 a[164:167], v10, s[16:19], s52 offen offset:1024 sc1
v_mfma_f32_16x16x32_bf16 a[212:215], a[208:211], a[204:207], a[212:215]
TR 70,16,25856
s_add_u32 s52, s52, 16384
v_mfma_f32_16x16x32_bf16 v[36:39], a[0:3], a[132:135], 0
TR 72,16,16928
s_waitcnt vmcnt(10)
MAA 36,4,148
TR 74,16,17440
v_mfma_f32_16x16x32_bf16 v[52:55], a[8:11], a[132:135], 0
buffer_load_dwordx4 a[176:179], v10, s[16:19], s52 offen sc1
MAA 52,12,148
TR 76,16,25376
v_mfma_f32_16x16x32_bf16 v[48:51], a[8:11], a[128:131], 0
TR 78,16,25888
MAA 48,12,144
TR 80,16,16960
v_mfma_f32_16x16x32_bf16 v[96:99], a[16:19], a[128:131], 0
buffer_load_dwordx4 a[180:183], v10, s[16:19], s52 offen offset:1024 sc1
MAA 96,20,144
TR 82,16,17472
s_add_u32 s52, s52, 16384
v_mfma_f32_16x16x32_bf16 v[100:103], a[16:19], a[132:135], 0
TR 84,16,25408
MAA 100,20,148
TR 86,16,25920
v_mfma_f32_16x16x32_bf16 v[116:119], a[24:27], a[132:135], 0
buffer_load_dwordx4 a[168:171], v11, s[16:19], s53 offen sc1
.Lpad2:
s_cbranch_execz .Lpad5
MAA 116,28,148
TR 88,16,16992
v_mfma_f32_16x16x32_bf16 v[112:115], a[24:27], a[128:131], 0
TR 90,16,17504
MAA 112,28,144
TR 92,16,25440
v_mfma_f32_16x16x32_bf16 v[160:163], a[32:35], a[128:131], 0
buffer_load_dwordx4 a[172:175], v11, s[16:19], s53 offen offset:1024 sc1
MAA 160,36,144
TR 94,16,25952
s_add_u32 s53, s53, 16384
v_mfma_f32_16x16x32_bf16 v[164:167], a[32:35], a[132:135], 0
TR 96,16,17024
MAA 164,36,148
TR 98,16,17536
v_mfma_f32_16x16x32_bf16 v[180:183], a[40:43], a[132:135], 0
buffer_load_dwordx4 a[184:187], v11, s[16:19], s53 offen sc1
MAA 180,44,148
TR 100,16,25472
v_mfma_f32_16x16x32_bf16 v[176:179], a[40:43], a[128:131], 0
TR 102,16,25984
MAA 176,44,144
TR 104,16,17056
v_mfma_f32_16x16x32_bf16 v[224:227], a[48:51], a[128:131], 0
buffer_load_dwordx4 a[188:191], v11, s[16:19], s53 offen offset:1024 sc1
MAA 224,52,144
TR 106,16,17568
s_add_u32 s53, s53, 16384
v_mfma_f32_16x16x32_bf16 v[228:231], a[48:51], a[132:135], 0
TR 108,16,25504
s_add_u32 m0, s55, 84480
MAA 228,52,148
TR 110,16,26016
v_mfma_f32_16x16x32_bf16 v[236:239], a[56:59], a[132:135], 0
buffer_load_dwordx4 v12, s[32:35], s54 offen   lds
MAA 236,60,148
TR 112,17,16896
v_mfma_f32_16x16x32_bf16 v[232:235], a[56:59], a[128:131], 0
TR 114,17,17408
MAA 232,60,144
TR 116,17,25344
s_waitcnt vmcnt(13)
v_mfma_f32_16x16x32_bf16 v[188:191], a[40:43], a[140:143], 0
buffer_load_dwordx4 v13, s[32:35], s54 offen offset:1056   lds
MAA 188,44,156
TR 118,17,25856
v_mfma_f32_16x16x32_bf16 v[184:187], a[40:43], a[136:139], 0
TR 120,17,16928
MAA 184,44,152
TR 122,17,17440
v_mfma_f32_16x16x32_bf16 v[168:171], a[32:35], a[136:139], 0
buffer_load_dwordx4 v14, s[32:35], s54 offen offset:2112   lds
MAA 168,36,152
TR 124,17,25376
v_mfma_f32_16x16x32_bf16 v[172:175], a[32:35], a[140:143], 0
TR 126,17,25888
MAA 172,36,156
RD 192,9,16896
v_mfma_f32_16x16x32_bf16 v[124:127], a[24:27], a[140:143], 0
buffer_load_dwordx4 v15, s[32:35], s54 offen offset:3168   lds
MAA 124,28,156
RD 196,9,17952
v_mfma_f32_16x16x32_bf16 v[120:123], a[24:27], a[136:139], 0
RD 200,9,19008
MAA 120,28,152
RD 204,9,20064
v_mfma_f32_16x16x32_bf16 v[104:107], a[16:19], a[136:139], 0
MAA 104,20,152
v_mfma_f32_16x16x32_bf16 v[108:111], a[16:19], a[140:143], 0
MAA 108,20,156
v_mfma_f32_16x16x32_bf16 v[60:63], a[8:11], a[140:143], 0
MAA 60,12,156
v_mfma_f32_16x16x32_bf16 v[56:59], a[8:11], a[136:139], 0
MAA 56,12,152
v_mfma_f32_16x16x32_bf16 v[40:43], a[0:3], a[136:139], 0
MAA 40,4,152
v_mfma_f32_16x16x32_bf16 v[44:47], a[0:3], a[140:143], 0
MAA 44,4,156
s_waitcnt lgkmcnt(0)
s_barrier
v_mfma_f32_16x16x32_bf16 v[64:67], a[64:67], a[128:131], 0
TR 0,16,33792
s_add_u32 m0, s74, 0
MAA 64,68,144
TR 2,16,34304
s_mov_b32 s67, 29622272
v_mfma_f32_16x16x32_bf16 a[216:219], a[208:211], a[192:195], 0
buffer_load_dwordx4 v4, s[16:19], s67 offen sc1 lds
v_mfma_f32_16x16x32_bf16 a[216:219], a[208:211], a[196:199], a[216:219]
TR 4,16,42240
v_mfma_f32_16x16x32_bf16 a[216:219], a[208:211], a[200:203], a[216:219]
TR 6,16,42752
v_mfma_f32_16x16x32_bf16 a[216:219], a[208:211], a[204:207], a[216:219]
TR 8,16,33824
v_mfma_f32_16x16x32_bf16 v[68:71], a[64:67], a[132:135], 0
buffer_load_dwordx4 v4, s[16:19], s67 offen offset:1024 sc1 lds
MAA 68,68,148
TR 10,16,34336
v_mfma_f32_16x16x32_bf16 v[84:87], a[72:75], a[132:135], 0
TR 12,16,42272
MAA 84,76,148
TR 14,16,42784
v_mfma_f32_16x16x32_bf16 v[80:83], a[72:75], a[128:131], 0
buffer_load_dwordx4 v4, s[16:19], s67 offen offset:2048 sc1 lds
MAA 80,76,144
TR 16,16,33856
v_mfma_f32_16x16x32_bf16 v[128:131], a[80:83], a[128:131], 0
TR 18,16,34368
MAA 128,84,144
TR 20,16,42304
v_mfma_f32_16x16x32_bf16 v[132:135], a[80:83], a[132:135], 0
buffer_load_dwordx4 v4, s[16:19], s67 offen offset:3072 sc1 lds
MAA 132,84,148
TR 22,16,42816
s_add_u32 m0, s55, 101376
v_mfma_f32_16x16x32_bf16 v[148:151], a[88:91], a[132:135], 0
TR 24,16,33888
MAA 148,92,148
TR 26,16,34400
v_mfma_f32_16x16x32_bf16 v[144:147], a[88:91], a[128:131], 0
buffer_load_dwordx4 v12, s[80:83], s54 offen   lds
MAA 144,92,144
TR 28,16,42336
v_mfma_f32_16x16x32_bf16 v[192:195], a[96:99], a[128:131], 0
TR 30,16,42848
MAA 192,100,144
TR 32,16,33920
v_mfma_f32_16x16x32_bf16 v[196:199], a[96:99], a[132:135], 0
buffer_load_dwordx4 v13, s[80:83], s54 offen offset:1056   lds
MAA 196,100,148
TR 34,16,34432
v_mfma_f32_16x16x32_bf16 v[212:215], a[104:107], a[132:135], 0
TR 36,16,42368
MAA 212,108,148
TR 38,16,42880
v_mfma_f32_16x16x32_bf16 v[208:211], a[104:107], a[128:131], 0
buffer_load_dwordx4 v14, s[80:83], s54 offen offset:2112   lds
MAA 208,108,144
TR 40,16,33952
v_mfma_f32_16x16x32_bf16 v[240:243], a[112:115], a[128:131], 0
TR 42,16,34464
MAA 240,116,144
TR 44,16,42400
v_mfma_f32_16x16x32_bf16 v[244:247], a[112:115], a[132:135], 0
buffer_load_dwordx4 v15, s[80:83], s54 offen offset:3168   lds
MAA 244,116,148
TR 46,16,42912
s_add_u32 s54, s54, 458752
v_mfma_f32_16x16x32_bf16 v[252:255], a[120:123], a[132:135], 0
TR 48,17,33792
MAA 252,124,148
TR 50,17,34304
v_mfma_f32_16x16x32_bf16 v[248:251], a[120:123], a[128:131], 0
buffer_load_dwordx4 a[128:131], v10, s[16:19], s52 offen sc1
MAA 248,124,144
TR 52,17,42240
v_mfma_f32_16x16x32_bf16 v[220:223], a[104:107], a[140:143], 0
TR 54,17,42752
MAA 220,108,156
TR 56,17,33824
v_mfma_f32_16x16x32_bf16 v[216:219], a[104:107], a[136:139], 0
buffer_load_dwordx4 a[132:135], v10, s[16:19], s52 offen offset:1024 sc1
MAA 216,108,152
TR 58,17,34336
s_add_u32 s52, s52, 16384
v_mfma_f32_16x16x32_bf16 v[200:203], a[96:99], a[136:139], 0
TR 60,17,42272
MAA 200,100,152
TR 62,17,42784
v_mfma_f32_16x16x32_bf16 v[204:207], a[96:99], a[140:143], 0
buffer_load_dwordx4 a[144:147], v10, s[16:19], s52 offen sc1
MAA 204,100,156
RD 192,9,33792
v_mfma_f32_16x16x32_bf16 v[156:159], a[88:91], a[140:143], 0
RD 196,9,34848
MAA 156,92,156
RD 200,9,35904
v_mfma_f32_16x16x32_bf16 v[152:155], a[88:91], a[136:139], 0
buffer_load_dwordx4 a[148:151], v10, s[16:19], s52 offen offset:1024 sc1
MAA 152,92,152
RD 204,9,36960
s_add_u32 s52, s52, 16384
v_mfma_f32_16x16x32_bf16 v[136:139], a[80:83], a[136:139], 0
MAA 136,84,152
v_mfma_f32_16x16x32_bf16 v[140:143], a[80:83], a[140:143], 0
MAA 140,84,156
v_mfma_f32_16x16x32_bf16 v[92:95], a[72:75], a[140:143], 0
MAA 92,76,156
v_mfma_f32_16x16x32_bf16 v[88:91], a[72:75], a[136:139], 0
MAA 88,76,152
v_mfma_f32_16x16x32_bf16 v[72:75], a[64:67], a[136:139], 0
MAA 72,68,152
v_mfma_f32_16x16x32_bf16 v[76:79], a[64:67], a[140:143], 0
MAA 76,68,156
s_waitcnt vmcnt(20) lgkmcnt(0)
s_barrier
MAA 32,0,160
buffer_load_dwordx4 a[136:139], v11, s[16:19], s53 offen sc1
MAA 32,4,176
TR 64,16,50688
v_mfma_f32_16x16x32_bf16 a[212:215], a[208:211], a[192:195], a[212:215]
TR 66,16,51200
v_mfma_f32_16x16x32_bf16 a[212:215], a[208:211], a[196:199], a[212:215]
TR 68,16,59136
v_mfma_f32_16x16x32_bf16 a[212:215], a[208:211], a[200:203], a[212:215]
buffer_load_dwordx4 a[140:143], v11, s[16:19], s53 offen offset:1024 sc1
v_mfma_f32_16x16x32_bf16 a[212:215], a[208:211], a[204:207], a[212:215]
TR 70,16,59648
s_add_u32 s53, s53, 16384
MAA 36,4,180
TR 72,16,50720
MAA 36,0,164
TR 74,16,51232
MAA 52,8,164
buffer_load_dwordx4 a[152:155], v11, s[16:19], s53 offen sc1
MAA 52,12,180
TR 76,16,59168
MAA 48,12,176
TR 78,16,59680
MAA 48,8,160
TR 80,16,50752
MAA 96,16,160
buffer_load_dwordx4 a[156:159], v11, s[16:19], s53 offen offset:1024 sc1
MAA 96,20,176
TR 82,16,51264
s_add_u32 s53, s53, 16384
MAA 100,20,180
TR 84,16,59200
s_add_u32 m0, s55, 118272
MAA 100,16,164
TR 86,16,59712
MAA 116,24,164
buffer_load_dwordx4 v12, s[32:35], s54 offen   lds
MAA 116,28,180
TR 88,16,50784
MAA 112,28,176
TR 90,16,51296
MAA 112,24,160
TR 92,16,59232
MAA 160,32,160
buffer_load_dwordx4 v13, s[32:35], s54 offen offset:1056   lds
MAA 160,36,176
TR 94,16,59744
MAA 164,36,180
TR 96,16,50816
MAA 164,32,164
TR 98,16,51328
MAA 180,40,164
buffer_load_dwordx4 v14, s[32:35], s54 offen offset:2112   lds
MAA 180,44,180
TR 100,16,59264
MAA 176,44,176
TR 102,16,59776
MAA 176,40,160
TR 104,16,50848
MAA 224,48,160
buffer_load_dwordx4 v15, s[32:35], s54 offen offset:3168   lds
MAA 224,52,176
TR 106,16,51360
s_add_u32 m0, s74, 4096
MAA 228,52,180
TR 108,16,59296
s_mov_b32 s67, 29626368
MAA 228,48,164
TR 110,16,59808
MAA 236,56,164
buffer_load_dwordx4 v4, s[16:19], s67 offen sc1 lds
MAA 236,60,180
TR 112,17,50688
MAA 232,60,176
TR 114,17,51200
MAA 232,56,160
TR 116,17,59136
s_waitcnt vmcnt(25)
MAA 188,40,172
buffer_load_dwordx4 v4, s[16:19], s67 offen offset:1024 sc1 lds
MAA 188,44,188
TR 118,17,59648
MAA 184,44,184
TR 120,17,50720
MAA 184,40,168
TR 122,17,51232
MAA 168,32,168
buffer_load_dwordx4 v4, s[16:19], s67 offen offset:2048 sc1 lds
MAA 168,36,184
TR 124,17,59168
MAA 172,36,188
TR 126,17,59680
MAA 172,32,172
RD 192,9,50688
MAA 124,24,172
buffer_load_dwordx4 v4, s[16:19], s67 offen offset:3072 sc1 lds
MAA 124,28,188
RD 196,9,51744
MAA 120,28,184
RD 200,9,52800
MAA 120,24,168
RD 204,9,53856
MAA 104,16,168
MAA 104,20,184
MAA 108,20,188
MAA 108,16,172
MAA 60,8,172
MAA 60,12,188
MAA 56,12,184
MAA 56,8,168
MAA 40,0,168
MAA 40,4,184
MAA 44,4,188
MAA 44,0,172
s_waitcnt vmcnt(24) lgkmcnt(0)
s_barrier
MAA 64,64,160
s_waitcnt vmcnt(20)
ds_read_b128 v[20:23], v2
s_add_u32 m0, s55, 135168
MAA 64,68,176
buffer_load_dwordx4 v12, s[80:83], s54 offen   lds
v_mfma_f32_16x16x32_bf16 a[216:219], a[208:211], a[192:195], a[216:219]
ds_read_b128 v[28:31], v2 offset:1024
v_mfma_f32_16x16x32_bf16 a[216:219], a[208:211], a[196:199], a[216:219]
ds_read_b128 v[24:27], v2 offset:2048
v_mfma_f32_16x16x32_bf16 a[216:219], a[208:211], a[200:203], a[216:219]
ds_read_b64_tr_b16 a[0:1], v16
v_mfma_f32_16x16x32_bf16 a[216:219], a[208:211], a[204:207], a[216:219]
TR 2,16,512
MAA 68,68,180
TR 4,16,8448
MAA 68,64,164
TR 6,16,8960
MAA 84,72,164
buffer_load_dwordx4 v13, s[80:83], s54 offen offset:1056   lds
MAA 84,76,180
TR 8,16,32
MAA 80,76,176
TR 10,16,544
s_waitcnt lgkmcnt(7)
v_add_f32 v20, v20, v28
MAA 80,72,160
TR 12,16,8480
v_add_f32 v21, v21, v29
MAA 128,80,160
TR 14,16,8992
v_add_f32 v22, v22, v30
MAA 128,84,176
TR 16,16,64
v_add_f32 v23, v23, v31
MAA 132,84,180
ds_read_b128 v[28:31], v2 offset:3072
s_waitcnt lgkmcnt(10)
v_add_f32 v20, v20, v24
MAA 132,80,164
buffer_load_dwordx4 v14, s[80:83], s54 offen offset:2112   lds
MAA 148,88,164
TR 18,16,576
v_add_f32 v21, v21, v25
MAA 148,92,180
TR 20,16,8512
v_add_f32 v22, v22, v26
MAA 144,92,176
TR 22,16,9024
v_add_f32 v23, v23, v27
MAA 144,88,160
TR 24,16,96
MAA 192,96,160
TR 26,16,608
MAA 192,100,176
TR 28,16,8544
MAA 196,100,180
buffer_load_dwordx4 v15, s[80:83], s54 offen offset:3168   lds
MAA 196,96,164
TR 30,16,9056
s_add_u32 s54, s54, 458752
MAA 212,104,164
TR 32,16,128
MAA 212,108,180
TR 34,16,640
MAA 208,108,176
TR 36,16,8576
MAA 208,104,160
TR 38,16,9088
MAA 240,112,160
TR 40,16,160
MAA 240,116,176
TR 42,16,672
MAA 244,116,180
TR 44,16,8608
MAA 244,112,164
TR 46,16,9120
MAA 252,120,164
ds_read_b64_tr_b16 a[48:49], v17
MAA 252,124,180
TR 50,17,512
MAA 248,124,176
TR 52,17,8448
MAA 248,120,160
buffer_load_dwordx4 a[160:163], v10, s[16:19], s52 offen sc1
MAA 220,104,172
TR 54,17,8960
MAA 220,108,188
TR 56,17,32
MAA 216,108,184
TR 58,17,544
MAA 216,104,168
TR 60,17,8480
MAA 200,96,168
TR 62,17,8992
MAA 200,100,184
ds_read_b128 a[192:195], v9
MAA 204,100,188
buffer_load_dwordx4 a[164:167], v10, s[16:19], s52 offen offset:1024 sc1
MAA 204,96,172
RD 196,9,1056
s_add_u32 s52, s52, 16384
MAA 156,88,172
RD 200,9,2112
MAA 156,92,188
RD 204,9,3168
MAA 152,92,184
MAA 152,88,168
MAA 136,80,168
MAA 136,84,184
buffer_load_dwordx4 a[176:179], v10, s[16:19], s52 offen sc1
MAA 140,84,188
MAA 140,80,172
MAA 92,72,172
MAA 92,76,188
MAA 88,76,184
MAA 88,72,168
MAA 72,64,168
buffer_load_dwordx4 a[180:183], v10, s[16:19], s52 offen offset:1024 sc1
MAA 72,68,184
s_add_u32 s52, s52, 16384
MAA 76,68,188
MAA 76,64,172
s_waitcnt vmcnt(20) lgkmcnt(0)
s_barrier
MAA 32,0,128
buffer_load_dwordx4 a[168:171], v11, s[16:19], s53 offen sc1
MAA 32,4,144
s_waitcnt vmcnt(9)
ds_read_b128 v[24:27], v2 offset:4096
v_add_f32 v20, v20, v28
v_mfma_f32_16x16x32_bf16 a[212:215], a[208:211], a[192:195], a[212:215]
TR 64,16,16896
v_add_f32 v21, v21, v29
v_mfma_f32_16x16x32_bf16 a[212:215], a[208:211], a[196:199], a[212:215]
TR 66,16,17408
v_add_f32 v22, v22, v30
v_mfma_f32_16x16x32_bf16 a[212:215], a[208:211], a[200:203], a[212:215]
TR 68,16,25344
v_add_f32 v23, v23, v31
v_mfma_f32_16x16x32_bf16 a[212:215], a[208:211], a[204:207], a[212:215]
ds_read_b128 v[28:31], v2 offset:5120
MAA 36,4,148
TR 70,16,25856
MAA 36,0,132
buffer_load_dwordx4 a[172:175], v11, s[16:19], s53 offen offset:1024 sc1
MAA 52,8,132
TR 72,16,16928
s_add_u32 s53, s53, 16384
MAA 52,12,148
TR 74,16,17440
s_waitcnt lgkmcnt(7)
v_add_f32 v20, v20, v24
MAA 48,12,144
TR 76,16,25376
v_add_f32 v21, v21, v25
MAA 48,8,128
TR 78,16,25888
v_add_f32 v22, v22, v26
MAA 96,16,128
TR 80,16,16960
v_add_f32 v23, v23, v27
MAA 96,20,144
ds_read_b128 v[24:27], v2 offset:6144
s_waitcnt lgkmcnt(7)
v_add_f32 v20, v20, v28
MAA 100,20,148
buffer_load_dwordx4 a[184:187], v11, s[16:19], s53 offen sc1
MAA 100,16,132
TR 82,16,17472
v_add_f32 v21, v21, v29
MAA 116,24,132
TR 84,16,25408
v_add_f32 v22, v22, v30
MAA 116,28,148
TR 86,16,25920
v_add_f32 v23, v23, v31
MAA 112,28,144
ds_read_b128 v[28:31], v2 offset:7168
MAA 112,24,128
TR 88,16,16992
MAA 160,32,128
TR 90,16,17504
MAA 160,36,144
buffer_load_dwordx4 a[188:191], v11, s[16:19], s53 offen offset:1024 sc1
MAA 164,36,148
TR 92,16,25440
s_add_u32 s53, s53, 16384
MAA 164,32,132
TR 94,16,25952
s_add_u32 m0, s55, 84480
MAA 180,40,132
TR 96,16,17024
s_waitcnt lgkmcnt(9)
v_add_f32 v20, v20, v24
MAA 180,44,148
TR 98,16,17536
v_add_f32 v21, v21, v25
MAA 176,44,144
TR 100,16,25472
v_add_f32 v22, v22, v26
MAA 176,40,128
TR 102,16,25984
v_add_f32 v23, v23, v27
MAA 224,48,128
buffer_load_dwordx4 v12, s[32:35], s54 offen   lds
MAA 224,52,144
TR 104,16,17056
s_waitcnt lgkmcnt(9)
v_add_f32 v20, v20, v28
MAA 228,52,148
TR 106,16,17568
v_add_f32 v21, v21, v29
MAA 228,48,132
TR 108,16,25504
v_add_f32 v22, v22, v30
MAA 236,56,132
TR 110,16,26016
v_add_f32 v23, v23, v31
MAA 236,60,148
TR 112,17,16896
MAA 232,60,144
TR 114,17,17408
.Lpad3:
s_cbranch_execz .Lnopoll33r
MAA 232,56,128
buffer_load_dwordx4 v13, s[32:35], s54 offen offset:1056   lds
MAA 188,40,140
TR 116,17,25344
MAA 188,44,156
TR 118,17,25856
MAA 184,44,152
TR 120,17,16928
MAA 184,40,136
TR 122,17,17440
MAA 168,32,136
TR 124,17,25376
MAA 168,36,152
TR 126,17,25888
MAA 172,36,156
buffer_load_dwordx4 v14, s[32:35], s54 offen offset:2112   lds
MAA 172,32,140
RD 192,9,16896
MAA 124,24,140
RD 196,9,17952
MAA 124,28,156
RD 200,9,19008
MAA 120,28,152
RD 204,9,20064
MAA 120,24,136
MAA 104,16,136
MAA 104,20,152
buffer_load_dwordx4 v15, s[32:35], s54 offen offset:3168   lds
MAA 108,20,156
MAA 108,16,140
MAA 60,8,140
MAA 60,12,156
MAA 56,12,152
MAA 56,8,136
MAA 40,0,136
MAA 40,4,152
MAA 44,4,156
s_sub_u32 s47, s47, 1
s_cbranch_scc1 .Lx38
.Lx38b:
MAA 44,0,140
s_waitcnt lgkmcnt(0)
s_barrier
MAA 64,64,128
TR 0,16,33792
s_add_u32 m0, s55, 101376
MAA 64,68,144
buffer_load_dwordx4 v12, s[80:83], s54 offen   lds
v_mfma_f32_16x16x32_bf16 a[216:219], a[208:211], a[192:195], a[216:219]
TR 2,16,34304
v_permlane32_swap_b32 v20, v22
v_mfma_f32_16x16x32_bf16 a[216:219], a[208:211], a[196:199], a[216:219]
TR 4,16,42240
v_permlane32_swap_b32 v21, v23
v_mfma_f32_16x16x32_bf16 a[216:219], a[208:211], a[200:203], a[216:219]
TR 6,16,42752
v_add_f32 v20, v20, v22
v_mfma_f32_16x16x32_bf16 a[216:219], a[208:211], a[204:207], a[216:219]
TR 8,16,33824
v_add_f32 v21, v21, v23
MAA 68,68,148
TR 10,16,34336
v_mul_f32 v20, 0xba800000, v20
MAA 68,64,132
TR 12,16,42272
v_mul_f32 v21, 0x3a800000, v21
MAA 84,72,132
buffer_load_dwordx4 v13, s[80:83], s54 offen offset:1056   lds
MAA 84,76,148
TR 14,16,42784
v_fma_f32 v21, -v20, v20, v21
MAA 80,76,144
TR 16,16,33856
v_max_f32 v21, 0, v21
MAA 80,72,128
TR 18,16,34368
v_add_f32 v21, 0x3727c5ac, v21
MAA 128,80,128
TR 20,16,42304
v_rsq_f32 v22, v21
MAA 128,84,144
TR 22,16,42816
v_and_b32 v24, 31, v1
MAA 132,84,148
TR 24,16,33888
v_lshrrev_b32 v25, 5, v1
MAA 132,80,132
buffer_load_dwordx4 v14, s[80:83], s54 offen offset:2112   lds
MAA 148,88,132
TR 26,16,34400
v_lshl_add_u32 v24, v24, 1, v25
MAA 148,92,148
TR 28,16,42336
v_and_b32 v25, 0xc0, v0
MAA 144,92,144
TR 30,16,42848
v_add_u32 v24, v24, v25
MAA 144,88,128
TR 32,16,33920
v_lshlrev_b32 v24, 4, v24
MAA 192,96,128
TR 34,16,34432
v_add_u32 v24, 152576, v24
MAA 192,100,144
TR 36,16,42368
v_mul_f32 v22, 0xbfb8aa3b, v22
MAA 196,100,148
buffer_load_dwordx4 v15, s[80:83], s54 offen offset:3168   lds
MAA 196,96,132
ds_write_b128 v24, v[20:23]
s_add_u32 s54, s54, 458752
MAA 212,104,132
ds_read_b64 v[20:21], v18
s_mov_b32 s58, s98
MAA 212,108,148
ds_read_b64 v[22:23], v18 offset:256
s_mov_b32 s67, s59
MAA 208,108,144
ds_read_b64 v[24:25], v19
MAA 208,104,128
ds_read_b64 v[26:27], v19 offset:256
MAA 240,112,128
ds_read_b32 v28, v18 offset:8
MAA 240,116,144
ds_read_b32 v29, v18 offset:264
v_mov_b32 v18, v5
MAA 244,116,148
ds_read_b32 v30, v19 offset:8
MAA 244,112,132
ds_read_b32 v31, v19 offset:264
v_mov_b32 v19, v6
MAA 252,120,132
TR 38,16,42880
MAA 252,124,148
TR 40,16,33952
MAA 248,124,144
TR 42,16,34464
MAA 248,120,128
buffer_load_dwordx4 a[128:131], v10, s[16:19], s52 offen sc1
MAA 220,104,140
TR 44,16,42400
MAA 220,108,156
TR 46,16,42912
MAA 216,108,152
TR 48,17,33792
MAA 216,104,136
TR 50,17,34304
MAA 200,96,136
TR 52,17,42240
MAA 200,100,152
TR 54,17,42752
MAA 204,100,156
buffer_load_dwordx4 a[132:135], v10, s[16:19], s52 offen offset:1024 sc1
MAA 204,96,140
TR 56,17,33824
s_add_u32 s52, s52, 16384
MAA 156,88,140
TR 58,17,34336
MAA 156,92,156
TR 60,17,42272
MAA 152,92,152
TR 62,17,42784
MAA 152,88,136
RD 192,9,33792
MAA 136,80,136
RD 196,9,34848
MAA 136,84,152
buffer_load_dwordx4 a[144:147], v10, s[16:19], s52 offen sc1
MAA 140,84,156
RD 200,9,35904
MAA 140,80,140
RD 204,9,36960
MAA 92,72,140
MAA 92,76,156
MAA 88,76,152
MAA 88,72,136
MAA 72,64,136
buffer_load_dwordx4 a[148:151], v10, s[16:19], s52 offen offset:1024 sc1
MAA 72,68,152
s_add_u32 s52, s52, 16384
MAA 76,68,156
s_sub_u32 s47, s47, 1
s_cbranch_scc1 .Lx39
.Lx39b:
MAA 76,64,140
s_waitcnt vmcnt(16) lgkmcnt(0)
s_barrier
MAA 32,0,160
buffer_load_dwordx4 a[136:139], v11, s[16:19], s53 offen sc1
MAA 32,4,176
TR 64,16,50688
v_mfma_f32_16x16x32_bf16 a[212:215], a[208:211], a[192:195], a[212:215]
TR 66,16,51200
v_mfma_f32_16x16x32_bf16 a[212:215], a[208:211], a[196:199], a[212:215]
TR 68,16,59136
v_mfma_f32_16x16x32_bf16 a[212:215], a[208:211], a[200:203], a[212:215]
TR 70,16,59648
v_mfma_f32_16x16x32_bf16 a[212:215], a[208:211], a[204:207], a[212:215]
TR 72,16,50720
MAA 36,4,180
TR 74,16,51232
MAA 36,0,164
buffer_load_dwordx4 a[140:143], v11, s[16:19], s53 offen offset:1024 sc1
MAA 52,8,164
TR 76,16,59168
s_add_u32 s53, s53, 16384
MAA 52,12,180
TR 78,16,59680
MAA 48,12,176
TR 80,16,50752
MAA 48,8,160
TR 82,16,51264
MAA 96,16,160
TR 84,16,59200
MAA 96,20,176
TR 86,16,59712
MAA 100,20,180
buffer_load_dwordx4 a[152:155], v11, s[16:19], s53 offen sc1
MAA 100,16,164
TR 88,16,50784
MAA 116,24,164
TR 90,16,51296
MAA 116,28,180
TR 92,16,59232
MAA 112,28,176
TR 94,16,59744
MAA 112,24,160
TR 96,16,50816
MAA 160,32,160
TR 98,16,51328
MAA 160,36,176
buffer_load_dwordx4 a[156:159], v11, s[16:19], s53 offen offset:1024 sc1
MAA 164,36,180
TR 100,16,59264
s_add_u32 s53, s53, 16384
MAA 164,32,164
TR 102,16,59776
s_add_u32 m0, s55, 118272
MAA 180,40,164
TR 104,16,50848
MAA 180,44,180
TR 106,16,51360
MAA 176,44,176
TR 108,16,59296
MAA 176,40,160
TR 110,16,59808
MAA 224,48,160
buffer_load_dwordx4 v12, s[32:35], s54 offen   lds
MAA 224,52,176
TR 112,17,50688
MAA 228,52,180
TR 114,17,51200
MAA 228,48,164
TR 116,17,59136
MAA 236,56,164
TR 118,17,59648
MAA 236,60,180
TR 120,17,50720
MAA 232,60,176
TR 122,17,51232
MAA 232,56,160
buffer_load_dwordx4 v13, s[32:35], s54 offen offset:1056   lds
s_waitcnt vmcnt(18)
MAA 188,40,172
TR 124,17,59168
MAA 188,44,188
TR 126,17,59680
MAA 184,44,184
RD 192,9,50688
MAA 184,40,168
RD 196,9,51744
MAA 168,32,168
RD 200,9,52800
MAA 168,36,184
RD 204,9,53856
MAA 172,36,188
buffer_load_dwordx4 v14, s[32:35], s54 offen offset:2112   lds
MAA 172,32,172
MAA 124,24,172
MAA 124,28,188
MAA 120,28,184
MAA 120,24,168
MAA 104,16,168
MAA 104,20,184
buffer_load_dwordx4 v15, s[32:35], s54 offen offset:3168   lds
MAA 108,20,188
MAA 108,16,172
MAA 60,8,172
MAA 60,12,188
MAA 56,12,184
MAA 56,8,168
MAA 40,0,168
MAA 40,4,184
MAA 44,4,188
s_sub_u32 s47, s47, 1
s_cbranch_scc1 .Lx40
.Lx40b:
MAA 44,0,172
s_waitcnt vmcnt(16) lgkmcnt(0)
s_barrier
MAA 64,64,160
ds_read_b64_tr_b16 a[0:1], v16
s_add_u32 m0, s55, 135168
MAA 64,68,176
buffer_load_dwordx4 v12, s[80:83], s54 offen   lds
v_mfma_f32_16x16x32_bf16 a[216:219], a[208:211], a[192:195], a[216:219]
TR 2,16,512
v_mfma_f32_16x16x32_bf16 a[216:219], a[208:211], a[196:199], a[216:219]
TR 4,16,8448
v_mfma_f32_16x16x32_bf16 a[216:219], a[208:211], a[200:203], a[216:219]
TR 6,16,8960
v_mfma_f32_16x16x32_bf16 a[216:219], a[208:211], a[204:207], a[216:219]
TR 8,16,32
MAA 68,68,180
TR 10,16,544
MAA 68,64,164
TR 12,16,8480
MAA 84,72,164
buffer_load_dwordx4 v13, s[80:83], s54 offen offset:1056   lds
MAA 84,76,180
TR 14,16,8992
MAA 80,76,176
TR 16,16,64
MAA 80,72,160
TR 18,16,576
MAA 128,80,160
TR 20,16,8512
MAA 128,84,176
TR 22,16,9024
MAA 132,84,180
TR 24,16,96
MAA 132,80,164
buffer_load_dwordx4 v14, s[80:83], s54 offen offset:2112   lds
MAA 148,88,164
TR 26,16,608
MAA 148,92,180
TR 28,16,8544
MAA 144,92,176
TR 30,16,9056
MAA 144,88,160
TR 32,16,128
MAA 192,96,160
TR 34,16,640
MAA 192,100,176
TR 36,16,8576
MAA 196,100,180
buffer_load_dwordx4 v15, s[80:83], s54 offen offset:3168   lds
MAA 196,96,164
TR 38,16,9088
s_add_u32 s54, s54, 458752
MAA 212,104,164
TR 40,16,160
MAA 212,108,180
TR 42,16,672
MAA 208,108,176
TR 44,16,8608
MAA 208,104,160
TR 46,16,9120
MAA 240,112,160
ds_read_b64_tr_b16 a[48:49], v17
MAA 240,116,176
TR 50,17,512
MAA 244,116,180
TR 52,17,8448
MAA 244,112,164
TR 54,17,8960
MAA 252,120,164
TR 56,17,32
MAA 252,124,180
TR 58,17,544
MAA 248,124,176
TR 60,17,8480
MAA 248,120,160
buffer_load_dwordx4 a[160:163], v10, s[16:19], s52 offen sc1
MAA 220,104,172
TR 62,17,8992
MAA 220,108,188
ds_read_b128 a[192:195], v9
MAA 216,108,184
RD 196,9,1056
MAA 216,104,168
RD 200,9,2112
MAA 200,96,168
RD 204,9,3168
MAA 200,100,184
MAA 204,100,188
buffer_load_dwordx4 a[164:167], v10, s[16:19], s52 offen offset:1024 sc1
MAA 204,96,172
s_add_u32 s52, s52, 16384
MAA 156,88,172
MAA 156,92,188
MAA 152,92,184
MAA 152,88,168
MAA 136,80,168
MAA 136,84,184
buffer_load_dwordx4 a[176:179], v10, s[16:19], s52 offen sc1
MAA 140,84,188
MAA 140,80,172
MAA 92,72,172
MAA 92,76,188
MAA 88,76,184
MAA 88,72,168
MAA 72,64,168
buffer_load_dwordx4 a[180:183], v10, s[16:19], s52 offen offset:1024 sc1
MAA 72,68,184
s_add_u32 s52, s52, 16384
MAA 76,68,188
s_sub_u32 s47, s47, 1
s_cbranch_scc1 .Lx41
.Lx41b:
MAA 76,64,172
s_mov_b32 s15, -5
.p2align 6
.Lk42:
s_waitcnt vmcnt(16) lgkmcnt(0)
s_barrier
MAA 32,0,128
TR 64,16,16896
MAA 32,4,144
buffer_load_dwordx4 a[168:171], v11, s[16:19], s53 offen sc1
v_mfma_f32_16x16x32_bf16 a[212:215], a[208:211], a[192:195], a[212:215]
s_sub_u32 s47, s47, 1
s_cbranch_scc1 .Lx43
.Lx43b:
v_mfma_f32_16x16x32_bf16 a[212:215], a[208:211], a[196:199], a[212:215]
TR 66,16,17408
v_mfma_f32_16x16x32_bf16 a[212:215], a[208:211], a[200:203], a[212:215]
TR 68,16,25344
v_mfma_f32_16x16x32_bf16 a[212:215], a[208:211], a[204:207], a[212:215]
TR 70,16,25856
MAA 36,4,148
MAA 36,0,132
buffer_load_dwordx4 a[172:175], v11, s[16:19], s53 offen offset:1024 sc1
MAA 52,8,132
TR 72,16,16928
s_add_u32 s53, s53, 16384
MAA 52,12,148
TR 74,16,17440
MAA 48,12,144
TR 76,16,25376
MAA 48,8,128
TR 78,16,25888
MAA 96,16,128
MAA 96,20,144
buffer_load_dwordx4 a[184:187], v11, s[16:19], s53 offen sc1
MAA 100,20,148
TR 80,16,16960
MAA 100,16,132
TR 82,16,17472
MAA 116,24,132
TR 84,16,25408
MAA 116,28,148
TR 86,16,25920
MAA 112,28,144
MAA 112,24,128
TR 88,16,16992
MAA 160,32,128
buffer_load_dwordx4 a[188:191], v11, s[16:19], s53 offen offset:1024 sc1
MAA 160,36,144
TR 90,16,17504
s_add_u32 s53, s53, 16384
MAA 164,36,148
TR 92,16,25440
MAA 164,32,132
TR 94,16,25952
MAA 180,40,132
MAA 180,44,148
TR 96,16,17024
s_add_u32 m0, s55, 84480
MAA 176,44,144
buffer_load_dwordx4 v12, s[32:35], s54 offen   lds
MAA 176,40,128
TR 98,16,17536
MAA 224,48,128
TR 100,16,25472
MAA 224,52,144
TR 102,16,25984
MAA 228,52,148
MAA 228,48,132
TR 104,16,17056
MAA 236,56,132
TR 106,16,17568
MAA 236,60,148
buffer_load_dwordx4 v13, s[32:35], s54 offen offset:1056   lds
MAA 232,60,144
TR 108,16,25504
MAA 232,56,128
TR 110,16,26016
s_waitcnt vmcnt(18)
MAA 188,40,140
MAA 188,44,156
TR 112,17,16896
MAA 184,44,152
TR 114,17,17408
MAA 184,40,136
buffer_load_dwordx4 v14, s[32:35], s54 offen offset:2112   lds
MAA 168,32,136
TR 116,17,25344
MAA 168,36,152
TR 118,17,25856
MAA 172,36,156
MAA 172,32,140
TR 120,17,16928
MAA 124,24,140
TR 122,17,17440
MAA 124,28,156
TR 124,17,25376
MAA 120,28,152
buffer_load_dwordx4 v15, s[32:35], s54 offen offset:3168   lds
MAA 120,24,136
TR 126,17,25888
MAA 104,16,136
MAA 104,20,152
RD 192,9,16896
MAA 108,20,156
RD 196,9,17952
MAA 108,16,140
RD 200,9,19008
s_mov_b32 m0, s67
MAA 60,8,140
buffer_load_dwordx4 v18, s[28:31], s58 offen lds
MAA 60,12,156
RD 204,9,20064
MAA 56,12,152
MAA 56,8,136
MAA 40,0,136
MAA 40,4,152
MAA 44,4,156
MAA 44,0,140
s_waitcnt vmcnt(17) lgkmcnt(0)
s_barrier
.Lpad4:
s_cbranch_execz .Lnopoll33r
MAA 64,64,128
TR 0,16,33792
s_add_u32 m0, s55, 101376
MAA 64,68,144
buffer_load_dwordx4 v12, s[80:83], s54 offen   lds
v_mfma_f32_16x16x32_bf16 a[216:219], a[208:211], a[192:195], a[216:219]
s_sub_u32 s47, s47, 1
s_cbranch_scc1 .Lx44
.Lx44b:
v_mfma_f32_16x16x32_bf16 a[216:219], a[208:211], a[196:199], a[216:219]
TR 2,16,34304
v_mfma_f32_16x16x32_bf16 a[216:219], a[208:211], a[200:203], a[216:219]
TR 4,16,42240
v_mfma_f32_16x16x32_bf16 a[216:219], a[208:211], a[204:207], a[216:219]
TR 6,16,42752
MAA 68,68,148
TR 8,16,33824
MAA 68,64,132
buffer_load_dwordx4 v13, s[80:83], s54 offen offset:1056   lds
MAA 84,72,132
MAA 84,76,148
TR 10,16,34336
MAA 80,76,144
TR 12,16,42272
MAA 80,72,128
TR 14,16,42784
MAA 128,80,128
TR 16,16,33856
MAA 128,84,144
buffer_load_dwordx4 v14, s[80:83], s54 offen offset:2112   lds
MAA 132,84,148
MAA 132,80,132
TR 18,16,34368
MAA 148,88,132
TR 20,16,42304
MAA 148,92,148
TR 22,16,42816
MAA 144,92,144
TR 24,16,33888
MAA 144,88,128
TR 26,16,34400
MAA 192,96,128
buffer_load_dwordx4 v15, s[80:83], s54 offen offset:3168   lds
MAA 192,100,144
s_add_u32 s54, s54, 458752
MAA 196,100,148
TR 28,16,42336
MAA 196,96,132
TR 30,16,42848
MAA 212,104,132
TR 32,16,33920
MAA 212,108,148
TR 34,16,34432
s_mov_b32 m0, s67
MAA 208,108,144
buffer_load_dwordx4 v19, s[28:31], s58 offen offset:1056 lds
MAA 208,104,128
s_add_u32 s67, s67, 8448
s_add_u32 s58, s58, 0x40000
MAA 240,112,128
MAA 240,116,144
TR 36,16,42368
MAA 244,116,148
TR 38,16,42880
MAA 244,112,132
TR 40,16,33952
MAA 252,120,132
TR 42,16,34464
MAA 252,124,148
TR 44,16,42400
MAA 248,124,144
MAA 248,120,128
buffer_load_dwordx4 a[128:131], v10, s[16:19], s52 offen sc1
MAA 220,104,140
TR 46,16,42912
MAA 220,108,156
TR 48,17,33792
MAA 216,108,152
TR 50,17,34304
MAA 216,104,136
buffer_load_dwordx4 a[132:135], v10, s[16:19], s52 offen offset:1024 sc1
MAA 200,96,136
TR 52,17,42240
s_add_u32 s52, s52, 16384
MAA 200,100,152
MAA 204,100,156
TR 54,17,42752
MAA 204,96,140
TR 56,17,33824
MAA 156,88,140
TR 58,17,34336
MAA 156,92,156
TR 60,17,42272
MAA 152,92,152
buffer_load_dwordx4 a[144:147], v10, s[16:19], s52 offen sc1
MAA 152,88,136
TR 62,17,42784
MAA 136,80,136
MAA 136,84,152
RD 192,9,33792
MAA 140,84,156
RD 196,9,34848
MAA 140,80,140
RD 200,9,35904
MAA 92,72,140
buffer_load_dwordx4 a[148:151], v10, s[16:19], s52 offen offset:1024 sc1
MAA 92,76,156
RD 204,9,36960
s_add_u32 s52, s52, 16384
MAA 88,76,152
MAA 88,72,136
MAA 72,64,136
MAA 72,68,152
MAA 76,68,156
MAA 76,64,140
s_waitcnt vmcnt(18) lgkmcnt(0)
s_barrier
MAA 32,0,160
TR 64,16,50688
MAA 32,4,176
buffer_load_dwordx4 a[136:139], v11, s[16:19], s53 offen sc1
v_mfma_f32_16x16x32_bf16 a[212:215], a[208:211], a[192:195], a[212:215]
s_sub_u32 s47, s47, 1
s_cbranch_scc1 .Lx45
.Lx45b:
v_mfma_f32_16x16x32_bf16 a[212:215], a[208:211], a[196:199], a[212:215]
TR 66,16,51200
v_mfma_f32_16x16x32_bf16 a[212:215], a[208:211], a[200:203], a[212:215]
TR 68,16,59136
v_mfma_f32_16x16x32_bf16 a[212:215], a[208:211], a[204:207], a[212:215]
TR 70,16,59648
MAA 36,4,180
MAA 36,0,164
buffer_load_dwordx4 a[140:143], v11, s[16:19], s53 offen offset:1024 sc1
MAA 52,8,164
TR 72,16,50720
s_add_u32 s53, s53, 16384
MAA 52,12,180
TR 74,16,51232
MAA 48,12,176
TR 76,16,59168
MAA 48,8,160
TR 78,16,59680
MAA 96,16,160
MAA 96,20,176
buffer_load_dwordx4 a[152:155], v11, s[16:19], s53 offen sc1
MAA 100,20,180
TR 80,16,50752
MAA 100,16,164
TR 82,16,51264
MAA 116,24,164
TR 84,16,59200
MAA 116,28,180
TR 86,16,59712
MAA 112,28,176
MAA 112,24,160
TR 88,16,50784
MAA 160,32,160
buffer_load_dwordx4 a[156:159], v11, s[16:19], s53 offen offset:1024 sc1
MAA 160,36,176
TR 90,16,51296
s_add_u32 s53, s53, 16384
MAA 164,36,180
TR 92,16,59232
MAA 164,32,164
TR 94,16,59744
MAA 180,40,164
MAA 180,44,180
TR 96,16,50816
s_add_u32 m0, s55, 118272
MAA 176,44,176
buffer_load_dwordx4 v12, s[32:35], s54 offen   lds
MAA 176,40,160
TR 98,16,51328
MAA 224,48,160
TR 100,16,59264
MAA 224,52,176
TR 102,16,59776
MAA 228,52,180
MAA 228,48,164
TR 104,16,50848
MAA 236,56,164
TR 106,16,51360
MAA 236,60,180
buffer_load_dwordx4 v13, s[32:35], s54 offen offset:1056   lds
MAA 232,60,176
TR 108,16,59296
MAA 232,56,160
TR 110,16,59808
s_waitcnt vmcnt(20)
MAA 188,40,172
MAA 188,44,188
TR 112,17,50688
MAA 184,44,184
TR 114,17,51200
MAA 184,40,168
buffer_load_dwordx4 v14, s[32:35], s54 offen offset:2112   lds
MAA 168,32,168
TR 116,17,59136
MAA 168,36,184
TR 118,17,59648
MAA 172,36,188
MAA 172,32,172
TR 120,17,50720
MAA 124,24,172
TR 122,17,51232
MAA 124,28,188
TR 124,17,59168
MAA 120,28,184
buffer_load_dwordx4 v15, s[32:35], s54 offen offset:3168   lds
MAA 120,24,168
TR 126,17,59680
MAA 104,16,168
MAA 104,20,184
RD 192,9,50688
MAA 108,20,188
RD 196,9,51744
MAA 108,16,172
RD 200,9,52800
s_mov_b32 m0, s67
MAA 60,8,172
buffer_load_dwordx4 v18, s[28:31], s58 offen lds
MAA 60,12,188
RD 204,9,53856
MAA 56,12,184
MAA 56,8,168
MAA 40,0,168
MAA 40,4,184
MAA 44,4,188
MAA 44,0,172
s_waitcnt vmcnt(19) lgkmcnt(0)
s_barrier
MAA 64,64,160
ds_read_b64_tr_b16 a[0:1], v16
s_add_u32 m0, s55, 135168
MAA 64,68,176
buffer_load_dwordx4 v12, s[80:83], s54 offen   lds
v_mfma_f32_16x16x32_bf16 a[216:219], a[208:211], a[192:195], a[216:219]
s_sub_u32 s47, s47, 1
s_cbranch_scc1 .Lx46
.Lx46b:
v_mfma_f32_16x16x32_bf16 a[216:219], a[208:211], a[196:199], a[216:219]
TR 2,16,512
v_mfma_f32_16x16x32_bf16 a[216:219], a[208:211], a[200:203], a[216:219]
TR 4,16,8448
v_mfma_f32_16x16x32_bf16 a[216:219], a[208:211], a[204:207], a[216:219]
TR 6,16,8960
MAA 68,68,180
TR 8,16,32
MAA 68,64,164
buffer_load_dwordx4 v13, s[80:83], s54 offen offset:1056   lds
MAA 84,72,164
MAA 84,76,180
TR 10,16,544
MAA 80,76,176
TR 12,16,8480
MAA 80,72,160
TR 14,16,8992
MAA 128,80,160
TR 16,16,64
MAA 128,84,176
buffer_load_dwordx4 v14, s[80:83], s54 offen offset:2112   lds
MAA 132,84,180
MAA 132,80,164
TR 18,16,576
MAA 148,88,164
TR 20,16,8512
MAA 148,92,180
TR 22,16,9024
MAA 144,92,176
TR 24,16,96
MAA 144,88,160
TR 26,16,608
MAA 192,96,160
buffer_load_dwordx4 v15, s[80:83], s54 offen offset:3168   lds
MAA 192,100,176
s_add_u32 s54, s54, 458752
MAA 196,100,180
TR 28,16,8544
MAA 196,96,164
TR 30,16,9056
MAA 212,104,164
TR 32,16,128
MAA 212,108,180
TR 34,16,640
s_mov_b32 m0, s67
MAA 208,108,176
buffer_load_dwordx4 v19, s[28:31], s58 offen offset:1056 lds
MAA 208,104,160
s_add_u32 s67, s67, 8448
s_add_u32 s46, s46, 1
s_xor_b32 s58, s46, s87
s_mul_i32 s58, s58, 458752
MAA 240,112,160
MAA 240,116,176
TR 36,16,8576
MAA 244,116,180
TR 38,16,9088
MAA 244,112,164
TR 40,16,160
MAA 252,120,164
TR 42,16,672
MAA 252,124,180
TR 44,16,8608
MAA 248,124,176
MAA 248,120,160
buffer_load_dwordx4 a[160:163], v10, s[16:19], s52 offen sc1
MAA 220,104,172
TR 46,16,9120
MAA 220,108,188
ds_read_b64_tr_b16 a[48:49], v17
MAA 216,108,184
TR 50,17,512
MAA 216,104,168
buffer_load_dwordx4 a[164:167], v10, s[16:19], s52 offen offset:1024 sc1
MAA 200,96,168
TR 52,17,8448
s_add_u32 s52, s52, 16384
MAA 200,100,184
MAA 204,100,188
TR 54,17,8960
MAA 204,96,172
TR 56,17,32
MAA 156,88,172
TR 58,17,544
MAA 156,92,188
TR 60,17,8480
MAA 152,92,184
buffer_load_dwordx4 a[176:179], v10, s[16:19], s52 offen sc1
MAA 152,88,168
TR 62,17,8992
MAA 136,80,168
MAA 136,84,184
ds_read_b128 a[192:195], v9
MAA 140,84,188
RD 196,9,1056
MAA 140,80,172
RD 200,9,2112
MAA 92,72,172
buffer_load_dwordx4 a[180:183], v10, s[16:19], s52 offen offset:1024 sc1
MAA 92,76,188
RD 204,9,3168
s_add_u32 s52, s52, 16384
MAA 88,76,184
MAA 88,72,168
MAA 72,64,168
MAA 72,68,184
MAA 76,68,188
s_add_u32 s15, s15, 1
MAA 76,64,172
s_cbranch_scc0 .Lk42
s_branch .Lj47
.Lx38:
buffer_load_dword v4, v8, s[40:43], s45 offen
buffer_load_dword v4, v7, s[28:31], s44 offen
s_add_u32 s44, s44, 655360
s_add_u32 s45, s45, 917504
s_mov_b32 s47, 3
s_branch .Lx38b
.Lx39:
buffer_load_dword v4, v8, s[40:43], s45 offen
buffer_load_dword v4, v7, s[28:31], s44 offen
s_add_u32 s44, s44, 655360
s_add_u32 s45, s45, 917504
s_mov_b32 s47, 3
s_branch .Lx39b
.Lx40:
buffer_load_dword v4, v8, s[40:43], s45 offen
buffer_load_dword v4, v7, s[28:31], s44 offen
s_add_u32 s44, s44, 655360
s_add_u32 s45, s45, 917504
s_mov_b32 s47, 3
s_branch .Lx40b
.Lx41:
buffer_load_dword v4, v8, s[40:43], s45 offen
buffer_load_dword v4, v7, s[28:31], s44 offen
s_add_u32 s44, s44, 655360
s_add_u32 s45, s45, 917504
s_mov_b32 s47, 3
s_branch .Lx41b
.Lx43:
buffer_load_dword v4, v8, s[40:43], s45 offen
buffer_load_dword v4, v7, s[28:31], s44 offen
s_add_u32 s44, s44, 655360
s_add_u32 s45, s45, 917504
s_mov_b32 s47, 3
s_branch .Lx43b
.Lx44:
buffer_load_dword v4, v8, s[40:43], s45 offen
buffer_load_dword v4, v7, s[28:31], s44 offen
s_add_u32 s44, s44, 655360
s_add_u32 s45, s45, 917504
s_mov_b32 s47, 3
s_branch .Lx44b
.Lx45:
buffer_load_dword v4, v8, s[40:43], s45 offen
buffer_load_dword v4, v7, s[28:31], s44 offen
s_add_u32 s44, s44, 655360
s_add_u32 s45, s45, 917504
s_mov_b32 s47, 3
s_branch .Lx45b
.Lx46:
buffer_load_dword v4, v8, s[40:43], s45 offen
buffer_load_dword v4, v7, s[28:31], s44 offen
s_add_u32 s44, s44, 655360
s_add_u32 s45, s45, 917504
s_mov_b32 s47, 3
s_branch .Lx46b
.Lj47:
s_waitcnt vmcnt(10) lgkmcnt(0)
s_barrier
v_mfma_f32_16x16x32_bf16 a[212:215], a[208:211], a[192:195], a[212:215]
RD 112,9,16896
s_lshl_b32 s74, s3, 10
v_mfma_f32_16x16x32_bf16 a[212:215], a[208:211], a[196:199], a[212:215]
RD 116,9,17952
s_add_u32 s74, s74, 152576
v_mfma_f32_16x16x32_bf16 a[212:215], a[208:211], a[200:203], a[212:215]
RD 120,9,19008
s_sub_u32 s75, 156672, s74
v_mfma_f32_16x16x32_bf16 a[212:215], a[208:211], a[204:207], a[212:215]
RD 124,9,20064
v_and_b32 v7, 15, v1
MAA 32,0,128
RD 192,9,33792
v_lshl_add_u32 v7, v7, 5, s74
MAA 32,4,144
RD 196,9,34848
v_bfe_u32 v2, v1, 4, 1
MAA 48,12,144
RD 200,9,35904
v_lshl_add_u32 v7, v2, 4, v7
MAA 48,8,128
RD 204,9,36960
v_bfe_u32 v2, v1, 5, 1
MAA 36,0,132
buffer_load_dwordx4 a[168:171], v11, s[16:19], s53 offen sc1
s_waitcnt lgkmcnt(7)
v_mfma_f32_16x16x32_bf16 a[216:219], a[208:211], a[112:115], a[216:219]
TR 64,16,16896
v_mul_u32_u24 v2, s75, v2
s_waitcnt lgkmcnt(7)
v_mfma_f32_16x16x32_bf16 a[216:219], a[208:211], a[116:119], a[216:219]
TR 66,16,17408
v_add_u32 v7, v7, v2
s_waitcnt lgkmcnt(7)
v_mfma_f32_16x16x32_bf16 a[216:219], a[208:211], a[120:123], a[216:219]
TR 68,16,25344
v_lshlrev_b32 v2, 4, v1
s_waitcnt lgkmcnt(7)
v_mfma_f32_16x16x32_bf16 a[216:219], a[208:211], a[124:127], a[216:219]
buffer_load_dwordx4 a[172:175], v11, s[16:19], s53 offen offset:1024 sc1
s_waitcnt lgkmcnt(6)
v_mfma_f32_16x16x32_bf16 a[212:215], a[208:211], a[192:195], a[212:215]
TR 70,16,25856
s_add_u32 s53, s53, 16384
s_waitcnt lgkmcnt(6)
v_mfma_f32_16x16x32_bf16 a[212:215], a[208:211], a[196:199], a[212:215]
TR 72,16,16928
v_add_u32 v2, 152576, v2
s_waitcnt lgkmcnt(6)
v_mfma_f32_16x16x32_bf16 a[212:215], a[208:211], a[200:203], a[212:215]
TR 74,16,17440
s_lshl_b32 s74, s12, 7
s_waitcnt lgkmcnt(6)
v_mfma_f32_16x16x32_bf16 a[212:215], a[208:211], a[204:207], a[212:215]
buffer_load_dwordx4 a[184:187], v11, s[16:19], s53 offen sc1
MAA 36,4,148
TR 76,16,25376
s_add_u32 s74, s74, 161536
MAA 52,12,148
s_nop 2
ds_write_b128 v7, a[212:215]
s_xor_b32 s75, s12, 1
MAA 52,8,132
TR 78,16,25888
s_mul_i32 s75, s75, 384
MAA 40,0,136
buffer_load_dwordx4 a[188:191], v11, s[16:19], s53 offen offset:1024 sc1
MAA 40,4,152
TR 80,16,33792
s_add_u32 s53, s53, 16384
MAA 56,12,152
TR 82,16,34304
s_add_u32 s75, s75, 161536
MAA 56,8,136
TR 84,16,42240
s_add_u32 s58, s99, 2293760
MAA 44,0,140
TR 86,16,42752
s_add_u32 s54, s98, 65536
MAA 44,4,156
TR 88,16,33824
s_mul_i32 s55, s3, 2112
MAA 60,12,156
TR 90,16,34336
s_mov_b32 s57, 67584
MAA 60,8,140
TR 92,16,42272
MAA 96,16,128
TR 94,16,42784
MAA 96,20,144
TR 192,16,16960
MAA 112,28,144
TR 194,16,17472
MAA 112,24,128
TR 196,16,25408
MAA 100,16,132
TR 198,16,25920
MAA 100,20,148
TR 200,16,16992
MAA 116,28,148
TR 202,16,17504
MAA 116,24,132
TR 204,16,25440
MAA 104,16,136
TR 206,16,25952
MAA 104,20,152
s_waitcnt vmcnt(9)
s_barrier
MAA 120,28,152
RD 112,9,50688
MAA 120,24,136
RD 116,9,51744
MAA 108,16,140
RD 120,9,52800
MAA 108,20,156
RD 124,9,53856
v_lshrrev_b32 v9, 4, v1
MAA 124,28,156
TR 96,16,50688
v_lshlrev_b32 v9, 4, v9
MAA 124,24,140
TR 98,16,51200
v_add_u32 v8, s75, v9
MAA 160,32,128
TR 100,16,59136
v_add_u32 v9, s74, v9
MAA 160,36,144
TR 102,16,59648
s_lshl_b32 s74, s3, 11
MAA 176,44,144
TR 104,16,50720
s_add_u32 s74, s74, s84
s_waitcnt lgkmcnt(8)
v_mfma_f32_16x16x32_bf16 a[216:219], a[208:211], a[112:115], a[216:219]
TR 106,16,51232
s_waitcnt lgkmcnt(8)
v_mfma_f32_16x16x32_bf16 a[216:219], a[208:211], a[116:119], a[216:219]
TR 108,16,59168
s_waitcnt lgkmcnt(8)
v_mfma_f32_16x16x32_bf16 a[216:219], a[208:211], a[120:123], a[216:219]
TR 110,16,59680
s_waitcnt lgkmcnt(8)
v_mfma_f32_16x16x32_bf16 a[216:219], a[208:211], a[124:127], a[216:219]
TR 112,16,33856
.Lpad5:
s_cbranch_execz .Lnopoll33r
MAA 176,40,128
TR 114,16,34368
MAA 164,32,132
s_nop 3
ds_write_b128 v7, a[216:219] offset:512
MAA 164,36,148
TR 116,16,42304
MAA 180,44,148
TR 118,16,42816
MAA 180,40,132
TR 120,16,33888
MAA 168,32,136
TR 122,16,34400
MAA 168,36,152
TR 124,16,42336
MAA 184,44,152
TR 126,16,42848
MAA 184,40,136
TR 0,16,50752
MAA 172,32,140
s_waitcnt lgkmcnt(7)
s_barrier
ds_read_b128 v[12:15], v2
MAA 172,36,156
ds_read_b128 v[4:7], v2 offset:1024
MAA 188,44,156
TR 2,16,51264
MAA 188,40,140
TR 4,16,59200
MAA 224,48,128
TR 6,16,59712
MAA 224,52,144
TR 8,16,50784
MAA 232,60,144
TR 10,16,51296
MAA 232,56,128
TR 12,16,59232
MAA 228,48,132
TR 14,16,59744
MAA 228,52,148
TR 16,16,17024
s_waitcnt lgkmcnt(8)
v_add_f32 v12, v12, v4
MAA 236,60,148
TR 18,16,17536
v_add_f32 v13, v13, v5
MAA 236,56,132
TR 20,16,25472
v_add_f32 v14, v14, v6
MAA 64,64,128
TR 22,16,25984
v_add_f32 v15, v15, v7
MAA 64,68,144
ds_read_b128 v[4:7], v2 offset:2048
s_waitcnt vmcnt(7)
MAA 64,96,160
TR 24,16,17056
s_waitcnt vmcnt(5)
MAA 64,100,176
TR 26,16,17568
MAA 80,108,176
TR 28,16,25504
MAA 80,104,160
TR 30,16,26016
MAA 80,76,144
TR 32,16,33920
MAA 80,72,128
TR 34,16,34432
MAA 32,80,160
TR 36,16,42368
MAA 32,84,176
TR 38,16,42880
s_waitcnt lgkmcnt(8)
v_add_f32 v12, v12, v4
MAA 48,92,176
TR 40,16,33952
v_add_f32 v13, v13, v5
MAA 48,88,160
TR 42,16,34464
v_add_f32 v14, v14, v6
v_add_f32 v15, v15, v7
ds_read_b128 v[4:7], v2 offset:3072
TR 44,16,42400
TR 46,16,42912
TR 48,16,50816
TR 50,16,51328
TR 52,16,59264
TR 54,16,59776
TR 56,16,50848
TR 58,16,51360
TR 60,16,59296
TR 62,16,59808
s_waitcnt lgkmcnt(10)
v_add_f32 v12, v12, v4
v_add_f32 v13, v13, v5
v_add_f32 v14, v14, v6
v_add_f32 v15, v15, v7
ds_write_b128 v2, v[12:15] offset:8960
ds_read_b128 v[12:15], v9
ds_read_b128 v[4:7], v9 offset:64
v_lshrrev_b32 v2, 3, v1
v_cmp_eq_u32 vcc, 3, v2
s_waitcnt lgkmcnt(1)
v_pk_fma_f32 v[32:33], v[12:13], v[20:21], v[32:33] op_sel_hi:[1,0,1]
v_pk_fma_f32 v[34:35], v[14:15], v[20:21], v[34:35] op_sel_hi:[1,0,1]
v_pk_fma_f32 v[36:37], v[12:13], v[22:23], v[36:37] op_sel_hi:[1,0,1]
v_pk_fma_f32 v[38:39], v[14:15], v[22:23], v[38:39] op_sel_hi:[1,0,1]
v_pk_fma_f32 v[40:41], v[12:13], v[24:25], v[40:41] op_sel_hi:[1,0,1]
v_pk_fma_f32 v[42:43], v[14:15], v[24:25], v[42:43] op_sel_hi:[1,0,1]
v_pk_fma_f32 v[44:45], v[12:13], v[26:27], v[44:45] op_sel_hi:[1,0,1]
v_pk_fma_f32 v[46:47], v[14:15], v[26:27], v[46:47] op_sel_hi:[1,0,1]
ds_read_b128 v[12:15], v9 offset:512
s_waitcnt lgkmcnt(1)
v_pk_fma_f32 v[48:49], v[4:5], v[20:21], v[48:49] op_sel_hi:[1,0,1]
v_pk_fma_f32 v[50:51], v[6:7], v[20:21], v[50:51] op_sel_hi:[1,0,1]
v_pk_fma_f32 v[52:53], v[4:5], v[22:23], v[52:53] op_sel_hi:[1,0,1]
v_pk_fma_f32 v[54:55], v[6:7], v[22:23], v[54:55] op_sel_hi:[1,0,1]
v_pk_fma_f32 v[56:57], v[4:5], v[24:25], v[56:57] op_sel_hi:[1,0,1]
v_pk_fma_f32 v[58:59], v[6:7], v[24:25], v[58:59] op_sel_hi:[1,0,1]
v_pk_fma_f32 v[60:61], v[4:5], v[26:27], v[60:61] op_sel_hi:[1,0,1]
v_pk_fma_f32 v[62:63], v[6:7], v[26:27], v[62:63] op_sel_hi:[1,0,1]
ds_read_b128 v[4:7], v9 offset:576
s_waitcnt lgkmcnt(1)
v_pk_fma_f32 v[64:65], v[12:13], v[20:21], v[64:65] op_sel_hi:[1,0,1]
v_pk_fma_f32 v[66:67], v[14:15], v[20:21], v[66:67] op_sel_hi:[1,0,1]
v_pk_fma_f32 v[68:69], v[12:13], v[22:23], v[68:69] op_sel_hi:[1,0,1]
v_pk_fma_f32 v[70:71], v[14:15], v[22:23], v[70:71] op_sel_hi:[1,0,1]
v_pk_fma_f32 v[72:73], v[12:13], v[24:25], v[72:73] op_sel_hi:[1,0,1]
v_pk_fma_f32 v[74:75], v[14:15], v[24:25], v[74:75] op_sel_hi:[1,0,1]
v_pk_fma_f32 v[76:77], v[12:13], v[26:27], v[76:77] op_sel_hi:[1,0,1]
v_pk_fma_f32 v[78:79], v[14:15], v[26:27], v[78:79] op_sel_hi:[1,0,1]
ds_read_b128 v[12:15], v9 offset:832
s_waitcnt lgkmcnt(1)
v_pk_fma_f32 v[80:81], v[4:5], v[20:21], v[80:81] op_sel_hi:[1,0,1]
v_pk_fma_f32 v[82:83], v[6:7], v[20:21], v[82:83] op_sel_hi:[1,0,1]
v_pk_fma_f32 v[84:85], v[4:5], v[22:23], v[84:85] op_sel_hi:[1,0,1]
v_pk_fma_f32 v[86:87], v[6:7], v[22:23], v[86:87] op_sel_hi:[1,0,1]
v_pk_fma_f32 v[88:89], v[4:5], v[24:25], v[88:89] op_sel_hi:[1,0,1]
v_pk_fma_f32 v[90:91], v[6:7], v[24:25], v[90:91] op_sel_hi:[1,0,1]
v_pk_fma_f32 v[92:93], v[4:5], v[26:27], v[92:93] op_sel_hi:[1,0,1]
v_pk_fma_f32 v[94:95], v[6:7], v[26:27], v[94:95] op_sel_hi:[1,0,1]
ds_read_b128 v[4:7], v9 offset:704
v_pk_mul_f32 v[64:65], v[64:65], v[32:33]
v_pk_mul_f32 v[32:33], v[32:33], v[28:29] op_sel_hi:[1,0]
v_pk_mul_f32 v[66:67], v[66:67], v[34:35]
v_pk_mul_f32 v[34:35], v[34:35], v[28:29] op_sel_hi:[1,0]
v_pk_mul_f32 v[80:81], v[80:81], v[48:49]
v_pk_mul_f32 v[48:49], v[48:49], v[28:29] op_sel_hi:[1,0]
v_pk_mul_f32 v[82:83], v[82:83], v[50:51]
v_pk_mul_f32 v[50:51], v[50:51], v[28:29] op_sel_hi:[1,0]
v_exp_f32 v32, v32
s_nop 0
MAA 68,64,132
v_exp_f32 v33, v33
MAA 68,68,148
v_exp_f32 v34, v34
MAA 68,96,164
v_exp_f32 v35, v35
s_waitcnt vmcnt(4)
MAA 68,100,180
v_exp_f32 v48, v48
MAA 84,108,180
v_exp_f32 v49, v49
MAA 84,104,164
v_exp_f32 v50, v50
MAA 84,76,148
v_exp_f32 v51, v51
MAA 84,72,132
MAA 36,80,164
MAA 36,84,180
MAA 52,92,180
MAA 52,88,164
s_nop 5
v_pk_mul_f32 v[68:69], v[68:69], v[36:37]
v_pk_mul_f32 v[36:37], v[36:37], v[28:29] op_sel:[0,1] op_sel_hi:[1,1]
v_pk_mul_f32 v[70:71], v[70:71], v[38:39]
v_pk_mul_f32 v[38:39], v[38:39], v[28:29] op_sel:[0,1] op_sel_hi:[1,1]
v_pk_mul_f32 v[84:85], v[84:85], v[52:53]
v_pk_mul_f32 v[52:53], v[52:53], v[28:29] op_sel:[0,1] op_sel_hi:[1,1]
v_pk_mul_f32 v[86:87], v[86:87], v[54:55]
v_pk_mul_f32 v[54:55], v[54:55], v[28:29] op_sel:[0,1] op_sel_hi:[1,1]
v_pk_fma_f32 v[32:33], v[32:33], v[20:21], v[20:21] op_sel:[0,1,1] op_sel_hi:[1,1,1]
v_pk_fma_f32 v[34:35], v[34:35], v[20:21], v[20:21] op_sel:[0,1,1] op_sel_hi:[1,1,1]
v_pk_fma_f32 v[48:49], v[48:49], v[20:21], v[20:21] op_sel:[0,1,1] op_sel_hi:[1,1,1]
v_pk_fma_f32 v[50:51], v[50:51], v[20:21], v[20:21] op_sel:[0,1,1] op_sel_hi:[1,1,1]
v_rcp_f32 v32, v32
s_nop 0
MAA 72,64,136
v_rcp_f32 v33, v33
MAA 72,68,152
v_rcp_f32 v34, v34
s_waitcnt vmcnt(3)
MAA 72,96,168
v_rcp_f32 v35, v35
s_waitcnt vmcnt(1)
MAA 72,100,184
v_rcp_f32 v48, v48
MAA 88,108,184
v_rcp_f32 v49, v49
MAA 88,104,168
v_rcp_f32 v50, v50
MAA 88,76,152
v_rcp_f32 v51, v51
MAA 88,72,136
v_exp_f32 v36, v36
MAA 40,80,168
v_exp_f32 v37, v37
MAA 40,84,184
v_exp_f32 v38, v38
MAA 56,92,184
v_exp_f32 v39, v39
MAA 56,88,168
v_exp_f32 v52, v52
v_exp_f32 v53, v53
v_exp_f32 v54, v54
v_exp_f32 v55, v55
v_pk_mul_f32 v[64:65], v[64:65], v[32:33]
v_pk_mul_f32 v[66:67], v[66:67], v[34:35]
v_pk_mul_f32 v[80:81], v[80:81], v[48:49]
v_pk_mul_f32 v[82:83], v[82:83], v[50:51]
ds_read_b128 v[48:51], v9 offset:128
v_pk_mul_f32 v[72:73], v[72:73], v[40:41]
v_pk_mul_f32 v[40:41], v[40:41], v[30:31] op_sel_hi:[1,0]
v_pk_mul_f32 v[74:75], v[74:75], v[42:43]
v_pk_mul_f32 v[42:43], v[42:43], v[30:31] op_sel_hi:[1,0]
v_pk_mul_f32 v[88:89], v[88:89], v[56:57]
v_pk_mul_f32 v[56:57], v[56:57], v[30:31] op_sel_hi:[1,0]
v_pk_mul_f32 v[90:91], v[90:91], v[58:59]
v_pk_mul_f32 v[58:59], v[58:59], v[30:31] op_sel_hi:[1,0]
v_pk_fma_f32 v[36:37], v[36:37], v[22:23], v[22:23] op_sel:[0,1,1] op_sel_hi:[1,1,1]
v_pk_fma_f32 v[38:39], v[38:39], v[22:23], v[22:23] op_sel:[0,1,1] op_sel_hi:[1,1,1]
v_pk_fma_f32 v[52:53], v[52:53], v[22:23], v[22:23] op_sel:[0,1,1] op_sel_hi:[1,1,1]
v_pk_fma_f32 v[54:55], v[54:55], v[22:23], v[22:23] op_sel:[0,1,1] op_sel_hi:[1,1,1]
v_cvt_pk_bf16_f32 v32, v64, v65
v_cvt_pk_bf16_f32 v33, v66, v67
ds_read_b128 v[64:67], v9 offset:192
v_cvt_pk_bf16_f32 v34, v80, v81
v_cvt_pk_bf16_f32 v35, v82, v83
MAA 76,64,140
buffer_store_dwordx4 v[32:35], v10, s[16:19], s62 offen sc1
MAA 76,68,156
ds_read_b128 v[80:83], v9 offset:640
v_rcp_f32 v36, v36
MAA 76,96,172
TR 64,17,16896
v_rcp_f32 v37, v37
s_waitcnt vmcnt(1)
MAA 76,100,188
TR 66,17,17408
v_rcp_f32 v38, v38
MAA 92,108,188
TR 68,17,25344
v_rcp_f32 v39, v39
MAA 92,104,172
TR 70,17,25856
v_rcp_f32 v52, v52
MAA 92,76,156
TR 76,17,25376
v_rcp_f32 v53, v53
MAA 92,72,140
TR 72,17,16928
v_rcp_f32 v54, v54
MAA 44,80,172
TR 74,17,17440
v_rcp_f32 v55, v55
MAA 44,84,188
TR 78,17,25888
v_exp_f32 v40, v40
MAA 60,92,188
TR 80,17,33792
v_exp_f32 v41, v41
MAA 60,88,172
TR 82,17,34304
v_exp_f32 v42, v42
v_exp_f32 v43, v43
v_exp_f32 v56, v56
v_exp_f32 v57, v57
v_exp_f32 v58, v58
v_exp_f32 v59, v59
v_pk_mul_f32 v[68:69], v[68:69], v[36:37]
v_pk_mul_f32 v[70:71], v[70:71], v[38:39]
v_pk_mul_f32 v[84:85], v[84:85], v[52:53]
v_pk_mul_f32 v[86:87], v[86:87], v[54:55]
ds_read_b128 v[52:55], v8 offset:576
v_pk_mul_f32 v[76:77], v[76:77], v[44:45]
v_pk_mul_f32 v[44:45], v[44:45], v[30:31] op_sel:[0,1] op_sel_hi:[1,1]
v_pk_mul_f32 v[78:79], v[78:79], v[46:47]
v_pk_mul_f32 v[46:47], v[46:47], v[30:31] op_sel:[0,1] op_sel_hi:[1,1]
v_pk_mul_f32 v[92:93], v[92:93], v[60:61]
v_pk_mul_f32 v[60:61], v[60:61], v[30:31] op_sel:[0,1] op_sel_hi:[1,1]
v_pk_mul_f32 v[94:95], v[94:95], v[62:63]
v_pk_mul_f32 v[62:63], v[62:63], v[30:31] op_sel:[0,1] op_sel_hi:[1,1]
v_pk_fma_f32 v[40:41], v[40:41], v[24:25], v[24:25] op_sel:[0,1,1] op_sel_hi:[1,1,1]
v_pk_fma_f32 v[42:43], v[42:43], v[24:25], v[24:25] op_sel:[0,1,1] op_sel_hi:[1,1,1]
v_pk_fma_f32 v[56:57], v[56:57], v[24:25], v[24:25] op_sel:[0,1,1] op_sel_hi:[1,1,1]
v_pk_fma_f32 v[58:59], v[58:59], v[24:25], v[24:25] op_sel:[0,1,1] op_sel_hi:[1,1,1]
v_cvt_pk_bf16_f32 v36, v68, v69
v_cvt_pk_bf16_f32 v37, v70, v71
v_cvt_pk_bf16_f32 v38, v84, v85
v_cvt_pk_bf16_f32 v39, v86, v87
MAA 128,192,128
buffer_store_dwordx4 v[36:39], v10, s[16:19], s62 offen offset:1024 sc1
MAA 128,196,144
TR 84,17,42240
v_rcp_f32 v40, v40
MAA 128,0,160
TR 86,17,42752
v_rcp_f32 v41, v41
MAA 128,4,176
TR 88,17,33824
v_rcp_f32 v42, v42
MAA 144,12,176
TR 90,17,34336
v_rcp_f32 v43, v43
MAA 144,8,160
TR 92,17,42272
v_rcp_f32 v56, v56
MAA 144,204,144
TR 94,17,42784
v_rcp_f32 v57, v57
MAA 144,200,128
TR 96,17,50688
v_rcp_f32 v58, v58
MAA 96,112,160
TR 98,17,51200
v_rcp_f32 v59, v59
MAA 96,116,176
TR 100,17,59136
v_exp_f32 v44, v44
MAA 112,124,176
TR 102,17,59648
v_exp_f32 v45, v45
MAA 112,120,160
TR 104,17,50720
v_lshrrev_b32 v69, 2, v0
v_min_u32 v69, 1, v69
v_lshlrev_b32 v69, 28, v69
v_lshl_add_u32 v68, v0, 7, v69
v_xor_b32 v69, 64, v0
v_min_u32 v69, 1, v69
v_lshlrev_b32 v70, 4, v69
v_sub_u32 v70, 16, v70
v_lshlrev_b32 v69, 28, v69
v_mov_b32 v71, 1
v_mov_b32 v84, 0
v_mov_b32 v85, 0
v_mov_b32 v86, 0
v_exp_f32 v46, v46
v_exp_f32 v47, v47
v_exp_f32 v60, v60
v_exp_f32 v61, v61
v_exp_f32 v62, v62
v_exp_f32 v63, v63
v_pk_mul_f32 v[72:73], v[72:73], v[40:41]
v_pk_mul_f32 v[74:75], v[74:75], v[42:43]
v_pk_mul_f32 v[88:89], v[88:89], v[56:57]
v_pk_mul_f32 v[90:91], v[90:91], v[58:59]
s_waitcnt lgkmcnt(15)
v_pk_fma_f32 v[96:97], v[48:49], v[20:21], v[96:97] op_sel_hi:[1,0,1]
v_pk_fma_f32 v[98:99], v[50:51], v[20:21], v[98:99] op_sel_hi:[1,0,1]
v_pk_fma_f32 v[112:113], v[64:65], v[20:21], v[112:113] op_sel_hi:[1,0,1]
v_pk_fma_f32 v[114:115], v[66:67], v[20:21], v[114:115] op_sel_hi:[1,0,1]
v_pk_fma_f32 v[128:129], v[80:81], v[20:21], v[128:129] op_sel_hi:[1,0,1]
v_pk_fma_f32 v[130:131], v[82:83], v[20:21], v[130:131] op_sel_hi:[1,0,1]
v_pk_fma_f32 v[144:145], v[4:5], v[20:21], v[144:145] op_sel_hi:[1,0,1]
v_pk_fma_f32 v[146:147], v[6:7], v[20:21], v[146:147] op_sel_hi:[1,0,1]
v_pk_mul_f32 v[128:129], v[128:129], v[96:97]
v_pk_mul_f32 v[96:97], v[96:97], v[28:29] op_sel_hi:[1,0]
v_pk_mul_f32 v[130:131], v[130:131], v[98:99]
v_pk_mul_f32 v[98:99], v[98:99], v[28:29] op_sel_hi:[1,0]
v_pk_mul_f32 v[144:145], v[144:145], v[112:113]
v_pk_mul_f32 v[112:113], v[112:113], v[28:29] op_sel_hi:[1,0]
v_pk_mul_f32 v[146:147], v[146:147], v[114:115]
v_pk_mul_f32 v[114:115], v[114:115], v[28:29] op_sel_hi:[1,0]
v_pk_fma_f32 v[44:45], v[44:45], v[26:27], v[26:27] op_sel:[0,1,1] op_sel_hi:[1,1,1]
v_pk_fma_f32 v[46:47], v[46:47], v[26:27], v[26:27] op_sel:[0,1,1] op_sel_hi:[1,1,1]
v_pk_fma_f32 v[60:61], v[60:61], v[26:27], v[26:27] op_sel:[0,1,1] op_sel_hi:[1,1,1]
v_pk_fma_f32 v[62:63], v[62:63], v[26:27], v[26:27] op_sel:[0,1,1] op_sel_hi:[1,1,1]
v_cvt_pk_bf16_f32 v40, v72, v73
v_cvt_pk_bf16_f32 v41, v74, v75
v_cvt_pk_bf16_f32 v42, v88, v89
v_cvt_pk_bf16_f32 v43, v90, v91
MAA 132,192,132
buffer_store_dwordx4 v[40:43], v11, s[16:19], s62 offen sc1
MAA 132,196,148
TR 106,17,51232
v_rcp_f32 v44, v44
MAA 132,0,164
TR 108,17,59168
v_rcp_f32 v45, v45
MAA 132,4,180
TR 110,17,59680
v_rcp_f32 v46, v46
MAA 148,12,180
v_rcp_f32 v47, v47
MAA 148,8,164
v_rcp_f32 v60, v60
MAA 148,204,148
v_rcp_f32 v61, v61
MAA 148,200,132
v_rcp_f32 v62, v62
MAA 100,112,164
v_rcp_f32 v63, v63
MAA 100,116,180
v_exp_f32 v96, v96
MAA 116,124,180
v_exp_f32 v97, v97
MAA 116,120,164
s_waitcnt lgkmcnt(0)
s_barrier
s_add_u32 m0, s59, 84480
v_exp_f32 v98, v98
v_exp_f32 v99, v99
v_exp_f32 v112, v112
v_exp_f32 v113, v113
v_exp_f32 v114, v114
v_exp_f32 v115, v115
v_pk_mul_f32 v[76:77], v[76:77], v[44:45]
v_pk_mul_f32 v[78:79], v[78:79], v[46:47]
v_pk_mul_f32 v[92:93], v[92:93], v[60:61]
v_pk_mul_f32 v[94:95], v[94:95], v[62:63]
v_pk_fma_f32 v[100:101], v[48:49], v[22:23], v[100:101] op_sel_hi:[1,0,1]
v_pk_fma_f32 v[102:103], v[50:51], v[22:23], v[102:103] op_sel_hi:[1,0,1]
v_pk_fma_f32 v[116:117], v[64:65], v[22:23], v[116:117] op_sel_hi:[1,0,1]
v_pk_fma_f32 v[118:119], v[66:67], v[22:23], v[118:119] op_sel_hi:[1,0,1]
v_pk_fma_f32 v[132:133], v[80:81], v[22:23], v[132:133] op_sel_hi:[1,0,1]
v_pk_fma_f32 v[134:135], v[82:83], v[22:23], v[134:135] op_sel_hi:[1,0,1]
v_pk_fma_f32 v[148:149], v[4:5], v[22:23], v[148:149] op_sel_hi:[1,0,1]
v_pk_fma_f32 v[150:151], v[6:7], v[22:23], v[150:151] op_sel_hi:[1,0,1]
v_pk_mul_f32 v[132:133], v[132:133], v[100:101]
v_pk_mul_f32 v[100:101], v[100:101], v[28:29] op_sel:[0,1] op_sel_hi:[1,1]
v_pk_mul_f32 v[134:135], v[134:135], v[102:103]
v_pk_mul_f32 v[102:103], v[102:103], v[28:29] op_sel:[0,1] op_sel_hi:[1,1]
v_pk_mul_f32 v[148:149], v[148:149], v[116:117]
v_pk_mul_f32 v[116:117], v[116:117], v[28:29] op_sel:[0,1] op_sel_hi:[1,1]
v_pk_mul_f32 v[150:151], v[150:151], v[118:119]
v_pk_mul_f32 v[118:119], v[118:119], v[28:29] op_sel:[0,1] op_sel_hi:[1,1]
v_pk_fma_f32 v[96:97], v[96:97], v[20:21], v[20:21] op_sel:[0,1,1] op_sel_hi:[1,1,1]
v_pk_fma_f32 v[98:99], v[98:99], v[20:21], v[20:21] op_sel:[0,1,1] op_sel_hi:[1,1,1]
v_pk_fma_f32 v[112:113], v[112:113], v[20:21], v[20:21] op_sel:[0,1,1] op_sel_hi:[1,1,1]
v_pk_fma_f32 v[114:115], v[114:115], v[20:21], v[20:21] op_sel:[0,1,1] op_sel_hi:[1,1,1]
v_cvt_pk_bf16_f32 v44, v76, v77
v_cvt_pk_bf16_f32 v45, v78, v79
v_cvt_pk_bf16_f32 v46, v92, v93
v_cvt_pk_bf16_f32 v47, v94, v95
MAA 136,192,136
buffer_store_dwordx4 v[44:47], v11, s[16:19], s62 offen offset:1024 sc1
MAA 136,196,152
v_rcp_f32 v96, v96
MAA 136,0,168
v_rcp_f32 v97, v97
MAA 136,4,184
v_rcp_f32 v98, v98
MAA 152,12,184
buffer_load_dwordx4 v18, s[28:31], s58 offen lds
MAA 152,8,168
v_rcp_f32 v99, v99
MAA 152,204,152
v_rcp_f32 v112, v112
MAA 152,200,136
v_rcp_f32 v113, v113
MAA 104,112,168
buffer_load_dwordx4 v19, s[28:31], s58 offen offset:1056 lds
MAA 104,116,184
s_add_u32 m0, s59, 92928
s_add_u32 s58, s99, 2555904
v_rcp_f32 v114, v114
MAA 120,124,184
v_rcp_f32 v115, v115
MAA 120,120,168
v_exp_f32 v100, v100
v_exp_f32 v101, v101
v_exp_f32 v102, v102
v_exp_f32 v103, v103
v_exp_f32 v116, v116
v_exp_f32 v117, v117
v_exp_f32 v118, v118
v_exp_f32 v119, v119
v_pk_mul_f32 v[128:129], v[128:129], v[96:97]
v_pk_mul_f32 v[130:131], v[130:131], v[98:99]
v_pk_mul_f32 v[144:145], v[144:145], v[112:113]
v_pk_mul_f32 v[146:147], v[146:147], v[114:115]
ds_read_b128 v[112:115], v9 offset:256
v_pk_fma_f32 v[104:105], v[48:49], v[24:25], v[104:105] op_sel_hi:[1,0,1]
v_pk_fma_f32 v[106:107], v[50:51], v[24:25], v[106:107] op_sel_hi:[1,0,1]
v_pk_fma_f32 v[120:121], v[64:65], v[24:25], v[120:121] op_sel_hi:[1,0,1]
v_pk_fma_f32 v[122:123], v[66:67], v[24:25], v[122:123] op_sel_hi:[1,0,1]
v_pk_fma_f32 v[136:137], v[80:81], v[24:25], v[136:137] op_sel_hi:[1,0,1]
v_pk_fma_f32 v[138:139], v[82:83], v[24:25], v[138:139] op_sel_hi:[1,0,1]
v_pk_fma_f32 v[152:153], v[4:5], v[24:25], v[152:153] op_sel_hi:[1,0,1]
v_pk_fma_f32 v[154:155], v[6:7], v[24:25], v[154:155] op_sel_hi:[1,0,1]
v_pk_mul_f32 v[136:137], v[136:137], v[104:105]
v_pk_mul_f32 v[104:105], v[104:105], v[30:31] op_sel_hi:[1,0]
v_pk_mul_f32 v[138:139], v[138:139], v[106:107]
v_pk_mul_f32 v[106:107], v[106:107], v[30:31] op_sel_hi:[1,0]
v_pk_mul_f32 v[152:153], v[152:153], v[120:121]
v_pk_mul_f32 v[120:121], v[120:121], v[30:31] op_sel_hi:[1,0]
v_pk_mul_f32 v[154:155], v[154:155], v[122:123]
v_pk_mul_f32 v[122:123], v[122:123], v[30:31] op_sel_hi:[1,0]
v_pk_fma_f32 v[100:101], v[100:101], v[22:23], v[22:23] op_sel:[0,1,1] op_sel_hi:[1,1,1]
v_pk_fma_f32 v[102:103], v[102:103], v[22:23], v[22:23] op_sel:[0,1,1] op_sel_hi:[1,1,1]
v_pk_fma_f32 v[116:117], v[116:117], v[22:23], v[22:23] op_sel:[0,1,1] op_sel_hi:[1,1,1]
v_pk_fma_f32 v[118:119], v[118:119], v[22:23], v[22:23] op_sel:[0,1,1] op_sel_hi:[1,1,1]
v_cvt_pk_bf16_f32 v96, v128, v129
v_cvt_pk_bf16_f32 v97, v130, v131
ds_read_b128 v[128:131], v9 offset:320
v_cvt_pk_bf16_f32 v98, v144, v145
v_cvt_pk_bf16_f32 v99, v146, v147
MAA 140,192,140
buffer_store_dwordx4 v[96:99], v10, s[16:19], s63 offen sc1
MAA 140,196,156
ds_read_b128 v[144:147], v9 offset:768
v_rcp_f32 v100, v100
MAA 140,0,172
v_rcp_f32 v101, v101
MAA 140,4,188
v_rcp_f32 v102, v102
MAA 156,12,188
buffer_load_dwordx4 v18, s[28:31], s58 offen lds
MAA 156,8,172
v_rcp_f32 v103, v103
MAA 156,204,156
v_rcp_f32 v116, v116
MAA 156,200,140
v_rcp_f32 v117, v117
MAA 108,112,172
buffer_load_dwordx4 v19, s[28:31], s58 offen offset:1056 lds
MAA 108,116,188
s_add_u32 m0, s59, 101376
s_add_u32 s58, s100, 2752512
v_rcp_f32 v118, v118
MAA 124,124,188
v_rcp_f32 v119, v119
MAA 124,120,172
v_exp_f32 v104, v104
v_exp_f32 v105, v105
v_exp_f32 v106, v106
v_exp_f32 v107, v107
v_exp_f32 v120, v120
v_exp_f32 v121, v121
v_exp_f32 v122, v122
v_exp_f32 v123, v123
v_pk_mul_f32 v[132:133], v[132:133], v[100:101]
v_pk_mul_f32 v[134:135], v[134:135], v[102:103]
v_pk_mul_f32 v[148:149], v[148:149], v[116:117]
v_pk_mul_f32 v[150:151], v[150:151], v[118:119]
v_pk_fma_f32 v[108:109], v[48:49], v[26:27], v[108:109] op_sel_hi:[1,0,1]
v_pk_fma_f32 v[110:111], v[50:51], v[26:27], v[110:111] op_sel_hi:[1,0,1]
v_pk_fma_f32 v[124:125], v[64:65], v[26:27], v[124:125] op_sel_hi:[1,0,1]
v_pk_fma_f32 v[126:127], v[66:67], v[26:27], v[126:127] op_sel_hi:[1,0,1]
v_pk_fma_f32 v[140:141], v[80:81], v[26:27], v[140:141] op_sel_hi:[1,0,1]
v_pk_fma_f32 v[142:143], v[82:83], v[26:27], v[142:143] op_sel_hi:[1,0,1]
v_pk_fma_f32 v[156:157], v[4:5], v[26:27], v[156:157] op_sel_hi:[1,0,1]
v_pk_fma_f32 v[158:159], v[6:7], v[26:27], v[158:159] op_sel_hi:[1,0,1]
v_pk_mul_f32 v[140:141], v[140:141], v[108:109]
v_pk_mul_f32 v[108:109], v[108:109], v[30:31] op_sel:[0,1] op_sel_hi:[1,1]
v_pk_mul_f32 v[142:143], v[142:143], v[110:111]
v_pk_mul_f32 v[110:111], v[110:111], v[30:31] op_sel:[0,1] op_sel_hi:[1,1]
v_pk_mul_f32 v[156:157], v[156:157], v[124:125]
s_waitcnt vmcnt(5)
s_barrier
buffer_atomic_add v71, v68, s[16:19], s72 offen offset:512
v_pk_mul_f32 v[124:125], v[124:125], v[30:31] op_sel:[0,1] op_sel_hi:[1,1]
v_pk_mul_f32 v[158:159], v[158:159], v[126:127]
v_pk_mul_f32 v[126:127], v[126:127], v[30:31] op_sel:[0,1] op_sel_hi:[1,1]
v_pk_fma_f32 v[104:105], v[104:105], v[24:25], v[24:25] op_sel:[0,1,1] op_sel_hi:[1,1,1]
v_pk_fma_f32 v[106:107], v[106:107], v[24:25], v[24:25] op_sel:[0,1,1] op_sel_hi:[1,1,1]
v_pk_fma_f32 v[120:121], v[120:121], v[24:25], v[24:25] op_sel:[0,1,1] op_sel_hi:[1,1,1]
v_pk_fma_f32 v[122:123], v[122:123], v[24:25], v[24:25] op_sel:[0,1,1] op_sel_hi:[1,1,1]
v_cvt_pk_bf16_f32 v100, v132, v133
v_cvt_pk_bf16_f32 v101, v134, v135
v_cvt_pk_bf16_f32 v102, v148, v149
v_cvt_pk_bf16_f32 v103, v150, v151
MAA 192,16,128
v_rcp_f32 v104, v104
MAA 192,20,144
buffer_store_dwordx4 v[100:103], v10, s[16:19], s63 offen offset:1024 sc1
MAA 192,48,160
v_rcp_f32 v105, v105
MAA 192,52,176
v_rcp_f32 v106, v106
MAA 208,60,176
v_rcp_f32 v107, v107
MAA 208,56,160
buffer_load_dwordx4 v18, s[28:31], s58 offen lds
MAA 208,28,144
v_rcp_f32 v120, v120
MAA 208,24,128
v_rcp_f32 v121, v121
MAA 160,32,160
v_rcp_f32 v122, v122
MAA 160,36,176
.Lpad6:
s_cbranch_execz .Lpad9
buffer_load_dwordx4 v19, s[28:31], s58 offen offset:1056 lds
MAA 176,44,176
s_add_u32 m0, s59, 109824
s_add_u32 s58, s100, 3014656
v_rcp_f32 v123, v123
MAA 176,40,160
v_exp_f32 v108, v108
v_exp_f32 v109, v109
v_exp_f32 v110, v110
v_exp_f32 v111, v111
v_exp_f32 v124, v124
v_exp_f32 v125, v125
v_exp_f32 v126, v126
v_exp_f32 v127, v127
v_pk_mul_f32 v[136:137], v[136:137], v[104:105]
v_pk_mul_f32 v[138:139], v[138:139], v[106:107]
v_pk_mul_f32 v[152:153], v[152:153], v[120:121]
v_pk_mul_f32 v[154:155], v[154:155], v[122:123]
s_waitcnt lgkmcnt(2)
v_pk_fma_f32 v[160:161], v[112:113], v[20:21], v[160:161] op_sel_hi:[1,0,1]
v_pk_fma_f32 v[162:163], v[114:115], v[20:21], v[162:163] op_sel_hi:[1,0,1]
s_waitcnt lgkmcnt(1)
v_pk_fma_f32 v[176:177], v[128:129], v[20:21], v[176:177] op_sel_hi:[1,0,1]
v_pk_fma_f32 v[178:179], v[130:131], v[20:21], v[178:179] op_sel_hi:[1,0,1]
s_waitcnt lgkmcnt(0)
v_pk_fma_f32 v[192:193], v[144:145], v[20:21], v[192:193] op_sel_hi:[1,0,1]
v_pk_fma_f32 v[194:195], v[146:147], v[20:21], v[194:195] op_sel_hi:[1,0,1]
v_pk_fma_f32 v[208:209], v[12:13], v[20:21], v[208:209] op_sel_hi:[1,0,1]
v_pk_fma_f32 v[210:211], v[14:15], v[20:21], v[210:211] op_sel_hi:[1,0,1]
v_pk_mul_f32 v[192:193], v[192:193], v[160:161]
v_pk_mul_f32 v[160:161], v[160:161], v[28:29] op_sel_hi:[1,0]
v_pk_mul_f32 v[194:195], v[194:195], v[162:163]
v_pk_mul_f32 v[162:163], v[162:163], v[28:29] op_sel_hi:[1,0]
v_pk_mul_f32 v[208:209], v[208:209], v[176:177]
v_pk_mul_f32 v[176:177], v[176:177], v[28:29] op_sel_hi:[1,0]
v_pk_mul_f32 v[210:211], v[210:211], v[178:179]
v_pk_mul_f32 v[178:179], v[178:179], v[28:29] op_sel_hi:[1,0]
v_pk_fma_f32 v[108:109], v[108:109], v[26:27], v[26:27] op_sel:[0,1,1] op_sel_hi:[1,1,1]
v_pk_fma_f32 v[110:111], v[110:111], v[26:27], v[26:27] op_sel:[0,1,1] op_sel_hi:[1,1,1]
v_pk_fma_f32 v[124:125], v[124:125], v[26:27], v[26:27] op_sel:[0,1,1] op_sel_hi:[1,1,1]
v_pk_fma_f32 v[126:127], v[126:127], v[26:27], v[26:27] op_sel:[0,1,1] op_sel_hi:[1,1,1]
v_cvt_pk_bf16_f32 v104, v136, v137
v_cvt_pk_bf16_f32 v105, v138, v139
v_cvt_pk_bf16_f32 v106, v152, v153
v_cvt_pk_bf16_f32 v107, v154, v155
MAA 196,16,132
buffer_store_dwordx4 v[104:107], v11, s[16:19], s63 offen sc1
MAA 196,20,148
v_rcp_f32 v108, v108
MAA 196,48,164
v_rcp_f32 v109, v109
MAA 196,52,180
v_rcp_f32 v110, v110
MAA 212,60,180
buffer_load_dwordx4 v18, s[28:31], s58 offen lds
MAA 212,56,164
v_rcp_f32 v111, v111
MAA 212,28,148
v_rcp_f32 v124, v124
MAA 212,24,132
v_rcp_f32 v125, v125
MAA 164,32,164
buffer_load_dwordx4 v19, s[28:31], s58 offen offset:1056 lds
MAA 164,36,180
s_add_u32 m0, s59, 118272
s_add_u32 s58, s101, 3211264
v_rcp_f32 v126, v126
MAA 180,44,180
v_rcp_f32 v127, v127
MAA 180,40,164
v_lshl_add_u32 v4, v1, 4, s74
v_add_u32 v2, 67108480, v4
v_cndmask_b32 v4, v4, v2, vcc
s_and_b32 s74, s7, 1
v_bfe_u32 v7, v1, 2, 3
v_mul_u32_u24 v7, 1056, v7
v_bfe_u32 v2, v1, 5, 1
v_lshl_add_u32 v7, v2, 8, v7
v_and_b32 v2, 3, v1
v_lshl_add_u32 v7, v2, 3, v7
s_lshl_b32 s74, s74, 7
s_xor_b32 s75, s74, 128
v_add_u32 v6, s75, v7
v_add_u32 v7, s74, v7
v_exp_f32 v160, v160
v_exp_f32 v161, v161
v_exp_f32 v162, v162
v_exp_f32 v163, v163
v_exp_f32 v176, v176
v_exp_f32 v177, v177
v_exp_f32 v178, v178
v_exp_f32 v179, v179
v_pk_mul_f32 v[140:141], v[140:141], v[108:109]
v_pk_mul_f32 v[142:143], v[142:143], v[110:111]
v_pk_mul_f32 v[156:157], v[156:157], v[124:125]
v_pk_mul_f32 v[158:159], v[158:159], v[126:127]
v_pk_fma_f32 v[164:165], v[112:113], v[22:23], v[164:165] op_sel_hi:[1,0,1]
v_pk_fma_f32 v[166:167], v[114:115], v[22:23], v[166:167] op_sel_hi:[1,0,1]
v_pk_fma_f32 v[180:181], v[128:129], v[22:23], v[180:181] op_sel_hi:[1,0,1]
v_pk_fma_f32 v[182:183], v[130:131], v[22:23], v[182:183] op_sel_hi:[1,0,1]
v_pk_fma_f32 v[196:197], v[144:145], v[22:23], v[196:197] op_sel_hi:[1,0,1]
v_pk_fma_f32 v[198:199], v[146:147], v[22:23], v[198:199] op_sel_hi:[1,0,1]
v_pk_fma_f32 v[212:213], v[12:13], v[22:23], v[212:213] op_sel_hi:[1,0,1]
v_pk_fma_f32 v[214:215], v[14:15], v[22:23], v[214:215] op_sel_hi:[1,0,1]
v_pk_mul_f32 v[196:197], v[196:197], v[164:165]
v_pk_mul_f32 v[164:165], v[164:165], v[28:29] op_sel:[0,1] op_sel_hi:[1,1]
v_pk_mul_f32 v[198:199], v[198:199], v[166:167]
v_pk_mul_f32 v[166:167], v[166:167], v[28:29] op_sel:[0,1] op_sel_hi:[1,1]
v_pk_mul_f32 v[212:213], v[212:213], v[180:181]
v_pk_mul_f32 v[180:181], v[180:181], v[28:29] op_sel:[0,1] op_sel_hi:[1,1]
v_pk_mul_f32 v[214:215], v[214:215], v[182:183]
v_pk_mul_f32 v[182:183], v[182:183], v[28:29] op_sel:[0,1] op_sel_hi:[1,1]
v_pk_fma_f32 v[160:161], v[160:161], v[20:21], v[20:21] op_sel:[0,1,1] op_sel_hi:[1,1,1]
v_pk_fma_f32 v[162:163], v[162:163], v[20:21], v[20:21] op_sel:[0,1,1] op_sel_hi:[1,1,1]
v_pk_fma_f32 v[176:177], v[176:177], v[20:21], v[20:21] op_sel:[0,1,1] op_sel_hi:[1,1,1]
v_pk_fma_f32 v[178:179], v[178:179], v[20:21], v[20:21] op_sel:[0,1,1] op_sel_hi:[1,1,1]
v_cvt_pk_bf16_f32 v108, v140, v141
v_cvt_pk_bf16_f32 v109, v142, v143
v_cvt_pk_bf16_f32 v110, v156, v157
v_cvt_pk_bf16_f32 v111, v158, v159
MAA 200,16,136
buffer_store_dwordx4 v[108:111], v11, s[16:19], s63 offen offset:1024 sc1
MAA 200,20,152
v_rcp_f32 v160, v160
MAA 200,48,168
v_rcp_f32 v161, v161
MAA 200,52,184
v_rcp_f32 v162, v162
MAA 216,60,184
buffer_load_dwordx4 v18, s[28:31], s58 offen lds
MAA 216,56,168
v_rcp_f32 v163, v163
MAA 216,28,152
v_rcp_f32 v176, v176
MAA 216,24,136
v_rcp_f32 v177, v177
MAA 168,32,168
buffer_load_dwordx4 v19, s[28:31], s58 offen offset:1056 lds
MAA 168,36,184
s_add_u32 m0, s59, 126720
s_add_u32 s58, s101, 3473408
v_rcp_f32 v178, v178
MAA 184,44,184
v_rcp_f32 v179, v179
MAA 184,40,168
v_exp_f32 v164, v164
v_exp_f32 v165, v165
v_exp_f32 v166, v166
v_exp_f32 v167, v167
v_exp_f32 v180, v180
v_exp_f32 v181, v181
v_exp_f32 v182, v182
v_exp_f32 v183, v183
v_pk_mul_f32 v[192:193], v[192:193], v[160:161]
v_pk_mul_f32 v[194:195], v[194:195], v[162:163]
v_pk_mul_f32 v[208:209], v[208:209], v[176:177]
v_pk_mul_f32 v[210:211], v[210:211], v[178:179]
ds_read_b128 v[176:179], v8
v_pk_fma_f32 v[168:169], v[112:113], v[24:25], v[168:169] op_sel_hi:[1,0,1]
v_pk_fma_f32 v[170:171], v[114:115], v[24:25], v[170:171] op_sel_hi:[1,0,1]
v_pk_fma_f32 v[184:185], v[128:129], v[24:25], v[184:185] op_sel_hi:[1,0,1]
v_pk_fma_f32 v[186:187], v[130:131], v[24:25], v[186:187] op_sel_hi:[1,0,1]
v_pk_fma_f32 v[200:201], v[144:145], v[24:25], v[200:201] op_sel_hi:[1,0,1]
v_pk_fma_f32 v[202:203], v[146:147], v[24:25], v[202:203] op_sel_hi:[1,0,1]
v_pk_fma_f32 v[216:217], v[12:13], v[24:25], v[216:217] op_sel_hi:[1,0,1]
v_pk_fma_f32 v[218:219], v[14:15], v[24:25], v[218:219] op_sel_hi:[1,0,1]
v_pk_mul_f32 v[200:201], v[200:201], v[168:169]
v_pk_mul_f32 v[168:169], v[168:169], v[30:31] op_sel_hi:[1,0]
v_pk_mul_f32 v[202:203], v[202:203], v[170:171]
v_pk_mul_f32 v[170:171], v[170:171], v[30:31] op_sel_hi:[1,0]
v_pk_mul_f32 v[216:217], v[216:217], v[184:185]
v_pk_mul_f32 v[184:185], v[184:185], v[30:31] op_sel_hi:[1,0]
v_pk_mul_f32 v[218:219], v[218:219], v[186:187]
v_pk_mul_f32 v[186:187], v[186:187], v[30:31] op_sel_hi:[1,0]
v_pk_fma_f32 v[164:165], v[164:165], v[22:23], v[22:23] op_sel:[0,1,1] op_sel_hi:[1,1,1]
v_pk_fma_f32 v[166:167], v[166:167], v[22:23], v[22:23] op_sel:[0,1,1] op_sel_hi:[1,1,1]
v_pk_fma_f32 v[180:181], v[180:181], v[22:23], v[22:23] op_sel:[0,1,1] op_sel_hi:[1,1,1]
v_pk_fma_f32 v[182:183], v[182:183], v[22:23], v[22:23] op_sel:[0,1,1] op_sel_hi:[1,1,1]
v_cvt_pk_bf16_f32 v160, v192, v193
v_cvt_pk_bf16_f32 v161, v194, v195
ds_read_b128 v[192:195], v8 offset:64
v_cvt_pk_bf16_f32 v162, v208, v209
v_cvt_pk_bf16_f32 v163, v210, v211
MAA 204,16,140
buffer_store_dwordx4 v[160:163], v10, s[16:19], s64 offen sc1
MAA 204,20,156
ds_read_b128 v[208:211], v8 offset:512
v_rcp_f32 v164, v164
MAA 204,48,172
v_rcp_f32 v165, v165
MAA 204,52,188
v_rcp_f32 v166, v166
MAA 220,60,188
buffer_atomic_add v84, v69, s[16:19], s73 offen offset:512 sc0
MAA 220,56,172
v_rcp_f32 v167, v167
MAA 220,28,156
v_rcp_f32 v180, v180
MAA 220,24,140
v_rcp_f32 v181, v181
MAA 172,32,172
buffer_load_dwordx4 v18, s[28:31], s58 offen lds
MAA 172,36,188
v_rcp_f32 v182, v182
MAA 188,44,188
v_rcp_f32 v183, v183
MAA 188,40,172
v_exp_f32 v168, v168
v_exp_f32 v169, v169
v_exp_f32 v170, v170
v_exp_f32 v171, v171
v_exp_f32 v184, v184
v_exp_f32 v185, v185
v_exp_f32 v186, v186
v_exp_f32 v187, v187
v_pk_mul_f32 v[196:197], v[196:197], v[164:165]
v_pk_mul_f32 v[198:199], v[198:199], v[166:167]
v_pk_mul_f32 v[212:213], v[212:213], v[180:181]
v_pk_mul_f32 v[214:215], v[214:215], v[182:183]
v_pk_fma_f32 v[172:173], v[112:113], v[26:27], v[172:173] op_sel_hi:[1,0,1]
v_pk_fma_f32 v[174:175], v[114:115], v[26:27], v[174:175] op_sel_hi:[1,0,1]
v_pk_fma_f32 v[188:189], v[128:129], v[26:27], v[188:189] op_sel_hi:[1,0,1]
v_pk_fma_f32 v[190:191], v[130:131], v[26:27], v[190:191] op_sel_hi:[1,0,1]
v_pk_fma_f32 v[204:205], v[144:145], v[26:27], v[204:205] op_sel_hi:[1,0,1]
v_pk_fma_f32 v[206:207], v[146:147], v[26:27], v[206:207] op_sel_hi:[1,0,1]
v_pk_fma_f32 v[220:221], v[12:13], v[26:27], v[220:221] op_sel_hi:[1,0,1]
v_pk_fma_f32 v[222:223], v[14:15], v[26:27], v[222:223] op_sel_hi:[1,0,1]
v_pk_mul_f32 v[204:205], v[204:205], v[172:173]
v_pk_mul_f32 v[172:173], v[172:173], v[30:31] op_sel:[0,1] op_sel_hi:[1,1]
v_pk_mul_f32 v[206:207], v[206:207], v[174:175]
v_pk_mul_f32 v[174:175], v[174:175], v[30:31] op_sel:[0,1] op_sel_hi:[1,1]
v_pk_mul_f32 v[220:221], v[220:221], v[188:189]
v_pk_mul_f32 v[188:189], v[188:189], v[30:31] op_sel:[0,1] op_sel_hi:[1,1]
v_pk_mul_f32 v[222:223], v[222:223], v[190:191]
v_pk_mul_f32 v[190:191], v[190:191], v[30:31] op_sel:[0,1] op_sel_hi:[1,1]
v_pk_fma_f32 v[168:169], v[168:169], v[24:25], v[24:25] op_sel:[0,1,1] op_sel_hi:[1,1,1]
v_pk_fma_f32 v[170:171], v[170:171], v[24:25], v[24:25] op_sel:[0,1,1] op_sel_hi:[1,1,1]
v_pk_fma_f32 v[184:185], v[184:185], v[24:25], v[24:25] op_sel:[0,1,1] op_sel_hi:[1,1,1]
v_pk_fma_f32 v[186:187], v[186:187], v[24:25], v[24:25] op_sel:[0,1,1] op_sel_hi:[1,1,1]
v_cvt_pk_bf16_f32 v164, v196, v197
v_cvt_pk_bf16_f32 v165, v198, v199
v_cvt_pk_bf16_f32 v166, v212, v213
v_cvt_pk_bf16_f32 v167, v214, v215
MAA 240,64,128
buffer_store_dwordx4 v[164:167], v10, s[16:19], s64 offen offset:1024 sc1
MAA 240,68,144
v_rcp_f32 v168, v168
MAA 240,96,160
v_rcp_f32 v169, v169
MAA 240,100,176
v_rcp_f32 v170, v170
MAA 248,108,176
buffer_atomic_add v85, v69, s[16:19], s73 offen offset:512 sc0
MAA 248,104,160
v_rcp_f32 v171, v171
MAA 248,76,144
v_rcp_f32 v184, v184
MAA 248,72,128
v_rcp_f32 v185, v185
MAA 224,80,160
buffer_load_dwordx4 v19, s[28:31], s58 offen offset:1056 lds
MAA 224,84,176
v_rcp_f32 v186, v186
MAA 232,92,176
v_rcp_f32 v187, v187
MAA 232,88,160
v_exp_f32 v172, v172
v_exp_f32 v173, v173
v_exp_f32 v174, v174
v_exp_f32 v175, v175
v_exp_f32 v188, v188
v_exp_f32 v189, v189
v_exp_f32 v190, v190
v_exp_f32 v191, v191
v_pk_mul_f32 v[200:201], v[200:201], v[168:169]
v_pk_mul_f32 v[202:203], v[202:203], v[170:171]
v_pk_mul_f32 v[216:217], v[216:217], v[184:185]
v_pk_mul_f32 v[218:219], v[218:219], v[186:187]
s_waitcnt lgkmcnt(2)
v_pk_fma_f32 v[224:225], v[176:177], v[20:21], v[224:225] op_sel_hi:[1,0,1]
v_pk_fma_f32 v[226:227], v[178:179], v[20:21], v[226:227] op_sel_hi:[1,0,1]
s_waitcnt lgkmcnt(1)
v_pk_fma_f32 v[232:233], v[192:193], v[20:21], v[232:233] op_sel_hi:[1,0,1]
v_pk_fma_f32 v[234:235], v[194:195], v[20:21], v[234:235] op_sel_hi:[1,0,1]
s_waitcnt lgkmcnt(0)
v_pk_fma_f32 v[240:241], v[208:209], v[20:21], v[240:241] op_sel_hi:[1,0,1]
v_pk_fma_f32 v[242:243], v[210:211], v[20:21], v[242:243] op_sel_hi:[1,0,1]
v_pk_fma_f32 v[248:249], v[52:53], v[20:21], v[248:249] op_sel_hi:[1,0,1]
v_pk_fma_f32 v[250:251], v[54:55], v[20:21], v[250:251] op_sel_hi:[1,0,1]
v_pk_mul_f32 v[240:241], v[240:241], v[224:225]
v_pk_mul_f32 v[224:225], v[224:225], v[28:29] op_sel_hi:[1,0]
v_pk_mul_f32 v[242:243], v[242:243], v[226:227]
v_pk_mul_f32 v[226:227], v[226:227], v[28:29] op_sel_hi:[1,0]
v_pk_mul_f32 v[248:249], v[248:249], v[232:233]
v_pk_mul_f32 v[232:233], v[232:233], v[28:29] op_sel_hi:[1,0]
v_pk_mul_f32 v[250:251], v[250:251], v[234:235]
v_pk_mul_f32 v[234:235], v[234:235], v[28:29] op_sel_hi:[1,0]
v_pk_fma_f32 v[172:173], v[172:173], v[26:27], v[26:27] op_sel:[0,1,1] op_sel_hi:[1,1,1]
v_pk_fma_f32 v[174:175], v[174:175], v[26:27], v[26:27] op_sel:[0,1,1] op_sel_hi:[1,1,1]
v_pk_fma_f32 v[188:189], v[188:189], v[26:27], v[26:27] op_sel:[0,1,1] op_sel_hi:[1,1,1]
v_pk_fma_f32 v[190:191], v[190:191], v[26:27], v[26:27] op_sel:[0,1,1] op_sel_hi:[1,1,1]
v_cvt_pk_bf16_f32 v168, v200, v201
v_cvt_pk_bf16_f32 v169, v202, v203
v_cvt_pk_bf16_f32 v170, v216, v217
v_cvt_pk_bf16_f32 v171, v218, v219
buffer_store_dwordx4 v[168:171], v11, s[16:19], s64 offen sc1
buffer_atomic_add v86, v69, s[16:19], s73 offen offset:512 sc0
s_waitcnt vmcnt(6)
v_cmp_gt_u32 vcc, v70, v84
s_nop 0
s_cbranch_vccz .Lok48
s_waitcnt vmcnt(3)
v_cmp_gt_u32 vcc, v70, v85
s_nop 0
s_cbranch_vccz .Lok48
s_waitcnt vmcnt(0)
v_cmp_gt_u32 vcc, v70, v86
s_nop 0
s_cbranch_vccz .Lok48
s_mov_b32 s15, 0
.Lok48l:
v_mov_b32 v84, 0
buffer_atomic_add v84, v69, s[16:19], s73 offen offset:512 sc0
s_add_u32 s15, s15, 1
s_cmp_gt_u32 s15, 100000
s_waitcnt vmcnt(0)
s_cbranch_scc1 .Lok48
v_cmp_gt_u32 vcc, v70, v84
s_nop 0
s_cbranch_vccnz .Lok48l
.Lok48:
s_waitcnt vmcnt(2)
s_barrier
MAA 244,64,132
ds_read_b64_tr_b16 a[0:1], v7
s_add_u32 s52, s76, 0
MAA 244,68,148
buffer_load_dwordx4 v[96:99], v4, s[16:19], s52 offen sc1
MAA 244,96,164
TR 2,7,512
v_rcp_f32 v172, v172
MAA 244,100,180
TR 4,7,32
v_rcp_f32 v173, v173
MAA 252,108,180
TR 6,7,544
v_rcp_f32 v174, v174
MAA 252,104,164
buffer_load_dwordx4 v[100:103], v4, s[16:19], s52 offen offset:1024 sc1
MAA 252,76,148
TR 8,7,64
s_add_u32 s52, s76, 65536
MAA 252,72,132
TR 10,7,576
v_rcp_f32 v175, v175
MAA 228,80,164
TR 12,7,96
v_rcp_f32 v188, v188
MAA 228,84,180
buffer_load_dwordx4 v[104:107], v4, s[16:19], s52 offen sc1
MAA 236,92,180
TR 14,7,608
v_rcp_f32 v189, v189
MAA 236,88,164
TR 16,7,8448
v_rcp_f32 v190, v190
v_rcp_f32 v191, v191
v_exp_f32 v224, v224
v_exp_f32 v225, v225
v_exp_f32 v226, v226
v_exp_f32 v227, v227
v_exp_f32 v232, v232
v_exp_f32 v233, v233
v_exp_f32 v234, v234
v_exp_f32 v235, v235
v_pk_mul_f32 v[204:205], v[204:205], v[172:173]
buffer_load_dwordx4 v[108:111], v4, s[16:19], s52 offen offset:1024 sc1
s_add_u32 s52, s77, 114688
v_pk_mul_f32 v[206:207], v[206:207], v[174:175]
v_pk_mul_f32 v[220:221], v[220:221], v[188:189]
v_pk_mul_f32 v[222:223], v[222:223], v[190:191]
v_pk_fma_f32 v[228:229], v[176:177], v[22:23], v[228:229] op_sel_hi:[1,0,1]
v_pk_fma_f32 v[230:231], v[178:179], v[22:23], v[230:231] op_sel_hi:[1,0,1]
v_pk_fma_f32 v[236:237], v[192:193], v[22:23], v[236:237] op_sel_hi:[1,0,1]
v_pk_fma_f32 v[238:239], v[194:195], v[22:23], v[238:239] op_sel_hi:[1,0,1]
v_pk_fma_f32 v[244:245], v[208:209], v[22:23], v[244:245] op_sel_hi:[1,0,1]
v_pk_fma_f32 v[246:247], v[210:211], v[22:23], v[246:247] op_sel_hi:[1,0,1]
v_pk_fma_f32 v[252:253], v[52:53], v[22:23], v[252:253] op_sel_hi:[1,0,1]
v_pk_fma_f32 v[254:255], v[54:55], v[22:23], v[254:255] op_sel_hi:[1,0,1]
v_pk_mul_f32 v[244:245], v[244:245], v[228:229]
buffer_load_dwordx4 v[112:115], v4, s[16:19], s52 offen sc1
v_pk_mul_f32 v[228:229], v[228:229], v[28:29] op_sel:[0,1] op_sel_hi:[1,1]
v_pk_mul_f32 v[246:247], v[246:247], v[230:231]
v_pk_mul_f32 v[230:231], v[230:231], v[28:29] op_sel:[0,1] op_sel_hi:[1,1]
v_pk_mul_f32 v[252:253], v[252:253], v[236:237]
v_pk_mul_f32 v[236:237], v[236:237], v[28:29] op_sel:[0,1] op_sel_hi:[1,1]
v_pk_mul_f32 v[254:255], v[254:255], v[238:239]
v_pk_mul_f32 v[238:239], v[238:239], v[28:29] op_sel:[0,1] op_sel_hi:[1,1]
v_pk_fma_f32 v[224:225], v[224:225], v[20:21], v[20:21] op_sel:[0,1,1] op_sel_hi:[1,1,1]
v_pk_fma_f32 v[226:227], v[226:227], v[20:21], v[20:21] op_sel:[0,1,1] op_sel_hi:[1,1,1]
v_pk_fma_f32 v[232:233], v[232:233], v[20:21], v[20:21] op_sel:[0,1,1] op_sel_hi:[1,1,1]
v_pk_fma_f32 v[234:235], v[234:235], v[20:21], v[20:21] op_sel:[0,1,1] op_sel_hi:[1,1,1]
v_cvt_pk_bf16_f32 v172, v204, v205
v_cvt_pk_bf16_f32 v173, v206, v207
buffer_load_dwordx4 v[116:119], v4, s[16:19], s52 offen offset:1024 sc1
s_add_u32 s52, s77, 180224
v_cvt_pk_bf16_f32 v174, v220, v221
v_cvt_pk_bf16_f32 v175, v222, v223
TR 18,7,8960
TR 20,7,8480
TR 22,7,8992
TR 24,7,8512
TR 26,7,9024
buffer_store_dwordx4 v[172:175], v11, s[16:19], s64 offen offset:1024 sc1
TR 28,7,8544
TR 30,7,9056
v_rcp_f32 v224, v224
v_rcp_f32 v225, v225
v_rcp_f32 v226, v226
v_rcp_f32 v227, v227
v_rcp_f32 v232, v232
v_rcp_f32 v233, v233
v_rcp_f32 v234, v234
v_rcp_f32 v235, v235
v_exp_f32 v228, v228
v_exp_f32 v229, v229
v_exp_f32 v230, v230
v_exp_f32 v231, v231
v_exp_f32 v236, v236
v_exp_f32 v237, v237
v_exp_f32 v238, v238
v_exp_f32 v239, v239
v_pk_mul_f32 v[240:241], v[240:241], v[224:225]
buffer_load_dwordx4 v[120:123], v4, s[16:19], s52 offen sc1
v_pk_mul_f32 v[242:243], v[242:243], v[226:227]
v_pk_mul_f32 v[248:249], v[248:249], v[232:233]
v_pk_mul_f32 v[250:251], v[250:251], v[234:235]
v_pk_fma_f32 v[228:229], v[228:229], v[22:23], v[22:23] op_sel:[0,1,1] op_sel_hi:[1,1,1]
v_pk_fma_f32 v[230:231], v[230:231], v[22:23], v[22:23] op_sel:[0,1,1] op_sel_hi:[1,1,1]
v_pk_fma_f32 v[236:237], v[236:237], v[22:23], v[22:23] op_sel:[0,1,1] op_sel_hi:[1,1,1]
v_pk_fma_f32 v[238:239], v[238:239], v[22:23], v[22:23] op_sel:[0,1,1] op_sel_hi:[1,1,1]
v_cvt_pk_bf16_f32 v224, v240, v241
v_cvt_pk_bf16_f32 v225, v242, v243
v_cvt_pk_bf16_f32 v226, v248, v249
v_cvt_pk_bf16_f32 v227, v250, v251
v_rcp_f32 v228, v228
v_rcp_f32 v229, v229
v_rcp_f32 v230, v230
v_rcp_f32 v231, v231
v_rcp_f32 v236, v236
v_rcp_f32 v237, v237
v_rcp_f32 v238, v238
v_rcp_f32 v239, v239
v_pk_mul_f32 v[244:245], v[244:245], v[228:229]
buffer_store_dwordx4 v[224:227], v10, s[16:19], s65 offen sc1
v_pk_mul_f32 v[246:247], v[246:247], v[230:231]
v_pk_mul_f32 v[252:253], v[252:253], v[236:237]
v_pk_mul_f32 v[254:255], v[254:255], v[238:239]
v_cvt_pk_bf16_f32 v228, v244, v245
v_cvt_pk_bf16_f32 v229, v246, v247
v_cvt_pk_bf16_f32 v230, v252, v253
v_cvt_pk_bf16_f32 v231, v254, v255
buffer_store_dwordx4 v[228:231], v10, s[16:19], s65 offen offset:1024 sc1
buffer_load_dwordx4 v[124:127], v4, s[16:19], s52 offen offset:1024 sc1
v_mov_b32 v21, v68
v_mov_b32 v22, v69
v_mov_b32 v23, v70
v_mov_b32 v24, v71
v_mov_b32 v25, 0
s_waitcnt vmcnt(7) lgkmcnt(0)
s_barrier
v_mfma_f32_16x16x32_bf16 v[32:35], a[0:3], v[96:99], 0
ds_read_b64_tr_b16 a[32:33], v6
s_add_u32 s52, s78, 229376
MAV 32,16,104
buffer_load_dwordx4 v[128:131], v4, s[16:19], s52 offen sc1
v_mfma_f32_16x16x32_bf16 v[48:51], a[0:3], v[100:103], 0
TR 34,6,512
TR 36,6,32
MAV 48,16,108
TR 38,6,544
v_mfma_f32_16x16x32_bf16 v[52:55], a[4:7], v[100:103], 0
buffer_load_dwordx4 v[132:135], v4, s[16:19], s52 offen offset:1024 sc1
MAV 52,20,108
TR 48,6,8448
TR 50,6,8960
v_mfma_f32_16x16x32_bf16 v[36:39], a[4:7], v[96:99], 0
TR 52,6,8480
MAV 36,20,104
TR 54,6,8992
s_add_u32 s52, s78, 294912
v_mfma_f32_16x16x32_bf16 v[40:43], a[8:11], v[96:99], 0
buffer_load_dwordx4 v[136:139], v4, s[16:19], s52 offen sc1
MAV 40,24,104
TR 40,6,64
v_mfma_f32_16x16x32_bf16 v[56:59], a[8:11], v[100:103], 0
TR 42,6,576
TR 44,6,96
MAV 56,24,108
TR 46,6,608
v_mfma_f32_16x16x32_bf16 v[60:63], a[12:15], v[100:103], 0
buffer_load_dwordx4 v[140:143], v4, s[16:19], s52 offen offset:1024 sc1
MAV 60,28,108
TR 56,6,8512
TR 58,6,9024
v_mfma_f32_16x16x32_bf16 v[44:47], a[12:15], v[96:99], 0
TR 60,6,8544
MAV 44,28,104
TR 62,6,9056
s_waitcnt lgkmcnt(8)
v_mfma_f32_16x16x32_bf16 v[64:67], a[32:35], v[96:99], 0
TR 0,7,16896
s_add_u32 s52, s79, 344064
MAV 64,48,104
buffer_load_dwordx4 v[144:147], v4, s[16:19], s52 offen sc1
v_mfma_f32_16x16x32_bf16 v[80:83], a[32:35], v[100:103], 0
TR 2,7,17408
TR 4,7,16928
MAV 80,48,108
TR 6,7,17440
v_mfma_f32_16x16x32_bf16 v[84:87], a[36:39], v[100:103], 0
buffer_load_dwordx4 v[148:151], v4, s[16:19], s52 offen offset:1024 sc1
MAV 84,52,108
TR 16,7,25344
TR 18,7,25856
v_mfma_f32_16x16x32_bf16 v[68:71], a[36:39], v[96:99], 0
TR 20,7,25376
MAV 68,52,104
TR 22,7,25888
s_add_u32 s52, s79, 409600
s_waitcnt lgkmcnt(8)
v_mfma_f32_16x16x32_bf16 v[72:75], a[40:43], v[96:99], 0
buffer_load_dwordx4 v[152:155], v4, s[16:19], s52 offen sc1
MAV 72,56,104
TR 8,7,16960
v_mfma_f32_16x16x32_bf16 v[88:91], a[40:43], v[100:103], 0
TR 10,7,17472
TR 12,7,16992
MAV 88,56,108
TR 14,7,17504
v_mfma_f32_16x16x32_bf16 v[92:95], a[44:47], v[100:103], 0
buffer_load_dwordx4 v[156:159], v4, s[16:19], s52 offen offset:1024 sc1
MAV 92,60,108
TR 24,7,25408
TR 26,7,25920
v_mfma_f32_16x16x32_bf16 v[76:79], a[44:47], v[96:99], 0
TR 28,7,25440
MAV 76,60,104
TR 30,7,25952
s_waitcnt vmcnt(8) lgkmcnt(8)
s_barrier
MAV 32,0,112
TR 32,6,16896
TR 34,6,17408
MAV 32,16,120
buffer_atomic_add v24, v21, s[16:19], s72 offen
MAV 48,16,124
TR 36,6,16928
TR 38,6,17440
MAV 48,0,116
TR 48,6,25344
s_add_u32 m0, s55, 0
MAV 52,4,116
buffer_load_dwordx4 v18, s[28:31], s54 offen lds
MAV 52,20,124
TR 50,6,25856
MAV 36,20,120
TR 52,6,25376
TR 54,6,25888
MAV 36,4,112
TR 40,6,16960
s_add_u32 s52, s76, 458752
s_waitcnt lgkmcnt(9)
MAV 40,8,112
buffer_load_dwordx4 v[96:99], v4, s[16:19], s52 offen sc1
MAV 40,24,120
TR 42,6,17472
TR 44,6,16992
MAV 56,24,124
buffer_load_dwordx4 v19, s[28:31], s54 offen offset:1056 lds
MAV 56,8,116
s_add_u32 s54, s98, 327680
MAV 60,12,116
TR 46,6,17504
TR 56,6,25408
MAV 60,28,124
buffer_load_dwordx4 v[100:103], v4, s[16:19], s52 offen offset:1024 sc1
MAV 44,28,120
TR 58,6,25920
TR 60,6,25440
MAV 44,12,112
TR 62,6,25952
s_waitcnt lgkmcnt(8)
MAV 64,32,112
TR 0,7,33792
.Lpad7:
s_cbranch_execz .Lpad10
s_add_u32 m0, s55, 8448
MAV 64,48,120
buffer_load_dwordx4 v18, s[28:31], s54 offen lds
MAV 80,48,124
TR 2,7,34304
TR 4,7,33824
MAV 80,32,116
TR 6,7,34336
s_add_u32 s52, s76, 524288
MAV 84,36,116
buffer_load_dwordx4 v[104:107], v4, s[16:19], s52 offen sc1
MAV 84,52,124
TR 16,7,42240
MAV 68,52,120
TR 18,7,42752
TR 20,7,42272
MAV 68,36,112
TR 22,7,42784
s_waitcnt lgkmcnt(8)
MAV 72,40,112
buffer_load_dwordx4 v19, s[28:31], s54 offen offset:1056 lds
MAV 72,56,120
s_add_u32 s54, s99, 524288
MAV 88,56,124
TR 8,7,33856
TR 10,7,34368
MAV 88,40,116
TR 12,7,33888
TR 14,7,34400
MAV 92,44,116
buffer_load_dwordx4 v[108:111], v4, s[16:19], s52 offen offset:1024 sc1
MAV 92,60,124
TR 24,7,42304
MAV 76,60,120
TR 26,7,42816
TR 28,7,42336
MAV 76,44,112
TR 30,7,42848
s_waitcnt vmcnt(13) lgkmcnt(8)
s_barrier
MAV 32,0,128
TR 32,6,33792
s_add_u32 m0, s55, 16896
MAV 32,16,136
buffer_load_dwordx4 v18, s[28:31], s54 offen lds
MAV 48,16,140
TR 34,6,34304
TR 36,6,33824
MAV 48,0,132
TR 38,6,34336
s_add_u32 s52, s77, 573440
MAV 52,4,132
buffer_load_dwordx4 v[112:115], v4, s[16:19], s52 offen sc1
MAV 52,20,140
TR 48,6,42240
MAV 36,20,136
TR 50,6,42752
TR 52,6,42272
MAV 36,4,128
TR 54,6,42784
s_waitcnt lgkmcnt(8)
MAV 40,8,128
buffer_load_dwordx4 v19, s[28:31], s54 offen offset:1056 lds
MAV 40,24,136
s_add_u32 s54, s99, 786432
MAV 56,24,140
TR 40,6,33856
TR 42,6,34368
MAV 56,8,132
TR 44,6,33888
TR 46,6,34400
MAV 60,12,132
buffer_load_dwordx4 v[116:119], v4, s[16:19], s52 offen offset:1024 sc1
MAV 60,28,140
TR 56,6,42304
MAV 44,28,136
TR 58,6,42816
TR 60,6,42336
MAV 44,12,128
TR 62,6,42848
s_waitcnt lgkmcnt(8)
MAV 64,32,128
TR 0,7,50688
s_add_u32 m0, s55, 25344
MAV 64,48,136
buffer_load_dwordx4 v18, s[28:31], s54 offen lds
MAV 80,48,140
TR 2,7,51200
TR 4,7,50720
MAV 80,32,132
TR 6,7,51232
s_add_u32 s52, s77, 638976
MAV 84,36,132
buffer_load_dwordx4 v[120:123], v4, s[16:19], s52 offen sc1
MAV 84,52,140
TR 16,7,59136
TR 18,7,59648
MAV 68,52,136
TR 20,7,59168
TR 22,7,59680
MAV 68,36,128
s_waitcnt lgkmcnt(8)
MAV 72,40,128
buffer_load_dwordx4 v19, s[28:31], s54 offen offset:1056 lds
MAV 72,56,136
TR 8,7,50752
s_add_u32 s54, s100, 983040
MAV 88,56,140
buffer_load_dwordx4 v[124:127], v4, s[16:19], s52 offen offset:1024 sc1
MAV 88,40,132
TR 10,7,51264
TR 12,7,50784
MAV 92,44,132
TR 14,7,51296
TR 24,7,59200
MAV 92,60,140
buffer_atomic_add v25, v22, s[16:19], s73 offen sc0
MAV 76,60,136
TR 26,7,59712
TR 28,7,59232
MAV 76,44,128
TR 30,7,59744
s_waitcnt vmcnt(18) lgkmcnt(8)
s_barrier
MAV 32,0,144
TR 32,6,50688
s_add_u32 m0, s55, 33792
MAV 32,16,152
buffer_load_dwordx4 v18, s[28:31], s54 offen lds
MAV 48,16,156
TR 34,6,51200
TR 36,6,50720
MAV 48,0,148
TR 38,6,51232
s_add_u32 s52, s78, 688128
MAV 52,4,148
buffer_load_dwordx4 v[128:131], v4, s[16:19], s52 offen sc1
MAV 52,20,156
TR 48,6,59136
MAV 36,20,152
TR 50,6,59648
TR 52,6,59168
MAV 36,4,144
TR 54,6,59680
s_waitcnt lgkmcnt(8)
MAV 40,8,144
buffer_load_dwordx4 v19, s[28:31], s54 offen offset:1056 lds
MAV 40,24,152
s_add_u32 s54, s100, 1245184
MAV 56,24,156
TR 40,6,50752
TR 42,6,51264
MAV 56,8,148
TR 44,6,50784
TR 46,6,51296
MAV 60,12,148
buffer_load_dwordx4 v[132:135], v4, s[16:19], s52 offen offset:1024 sc1
MAV 60,28,156
TR 56,6,59200
MAV 44,28,152
TR 58,6,59712
TR 60,6,59232
MAV 44,12,144
TR 62,6,59744
v_add_u32 v7, s57, v7
v_add_u32 v6, s57, v6
s_sub_u32 s57, 0, s57
s_waitcnt lgkmcnt(8)
MAV 64,32,144
ds_read_b64_tr_b16 a[0:1], v7
s_add_u32 m0, s55, 42240
MAV 64,48,152
buffer_load_dwordx4 v18, s[28:31], s54 offen lds
MAV 80,48,156
TR 2,7,512
TR 4,7,32
MAV 80,32,148
TR 6,7,544
s_add_u32 s52, s78, 753664
MAV 84,36,148
buffer_load_dwordx4 v[136:139], v4, s[16:19], s52 offen sc1
MAV 84,52,156
TR 16,7,8448
MAV 68,52,152
TR 18,7,8960
TR 20,7,8480
MAV 68,36,144
TR 22,7,8992
s_waitcnt lgkmcnt(8)
MAV 72,40,144
buffer_load_dwordx4 v19, s[28:31], s54 offen offset:1056 lds
MAV 72,56,152
s_add_u32 s54, s101, 1441792
MAV 88,56,156
TR 8,7,64
TR 10,7,576
MAV 88,40,148
TR 12,7,96
TR 14,7,608
MAV 92,44,148
buffer_load_dwordx4 v[140:143], v4, s[16:19], s52 offen offset:1024 sc1
MAV 92,60,156
TR 24,7,8512
MAV 76,60,152
TR 26,7,9024
TR 28,7,8544
MAV 76,44,144
TR 30,7,9056
s_waitcnt vmcnt(17) lgkmcnt(8)
s_barrier
MAV 32,0,96
ds_read_b64_tr_b16 a[32:33], v6
s_add_u32 m0, s55, 50688
MAV 32,16,104
buffer_load_dwordx4 v18, s[28:31], s54 offen lds
MAV 48,16,108
TR 34,6,512
TR 36,6,32
MAV 48,0,100
TR 38,6,544
s_add_u32 s52, s79, 802816
MAV 52,4,100
buffer_load_dwordx4 v[144:147], v4, s[16:19], s52 offen sc1
MAV 52,20,108
TR 48,6,8448
MAV 36,20,104
TR 50,6,8960
TR 52,6,8480
MAV 36,4,96
TR 54,6,8992
s_waitcnt lgkmcnt(8)
MAV 40,8,96
buffer_load_dwordx4 v19, s[28:31], s54 offen offset:1056 lds
MAV 40,24,104
s_add_u32 s54, s101, 1703936
MAV 56,24,108
TR 40,6,64
TR 42,6,576
MAV 56,8,100
TR 44,6,96
TR 46,6,608
MAV 60,12,100
buffer_load_dwordx4 v[148:151], v4, s[16:19], s52 offen offset:1024 sc1
MAV 60,28,108
TR 56,6,8512
MAV 44,28,104
TR 58,6,9024
TR 60,6,8544
MAV 44,12,96
TR 62,6,9056
s_waitcnt lgkmcnt(8)
MAV 64,32,96
TR 0,7,16896
s_add_u32 m0, s55, 59136
MAV 64,48,104
buffer_load_dwordx4 v18, s[28:31], s54 offen lds
MAV 80,48,108
TR 2,7,17408
TR 4,7,16928
MAV 80,32,100
TR 6,7,17440
s_add_u32 s52, s79, 868352
MAV 84,36,100
buffer_load_dwordx4 v[152:155], v4, s[16:19], s52 offen sc1
MAV 84,52,108
TR 16,7,25344
MAV 68,52,104
TR 18,7,25856
TR 20,7,25376
MAV 68,36,96
TR 22,7,25888
s_waitcnt lgkmcnt(8)
MAV 72,40,96
buffer_load_dwordx4 v19, s[28:31], s54 offen offset:1056 lds
MAV 72,56,104
s_add_u32 s54, s98, 1900544
MAV 88,56,108
TR 8,7,16960
TR 10,7,17472
MAV 88,40,100
TR 12,7,16992
TR 14,7,17504
MAV 92,44,100
buffer_load_dwordx4 v[156:159], v4, s[16:19], s52 offen offset:1024 sc1
MAV 92,60,108
TR 24,7,25408
MAV 76,60,104
TR 26,7,25920
TR 28,7,25440
MAV 76,44,96
TR 30,7,25952
s_waitcnt vmcnt(16)
v_cmp_gt_u32 vcc, v23, v25
s_nop 0
s_cbranch_vccnz .Lsp49
.Lsp49b:
s_waitcnt lgkmcnt(8)
s_barrier
MAV 32,0,112
TR 32,6,16896
s_add_u32 m0, s55, 67584
MAV 32,16,120
buffer_load_dwordx4 v18, s[28:31], s54 offen lds
MAV 48,16,124
TR 34,6,17408
TR 36,6,16928
MAV 48,0,116
TR 38,6,17440
s_add_u32 s52, s76, 16384
MAV 52,4,116
buffer_load_dwordx4 v[96:99], v4, s[16:19], s52 offen sc1
MAV 52,20,124
TR 48,6,25344
MAV 36,20,120
TR 50,6,25856
TR 52,6,25376
MAV 36,4,112
TR 54,6,25888
s_waitcnt lgkmcnt(8)
MAV 40,8,112
buffer_load_dwordx4 v19, s[28:31], s54 offen offset:1056 lds
MAV 40,24,120
s_add_u32 s54, s98, 2162688
MAV 56,24,124
TR 40,6,16960
TR 42,6,17472
MAV 56,8,116
TR 44,6,16992
TR 46,6,17504
MAV 60,12,116
buffer_load_dwordx4 v[100:103], v4, s[16:19], s52 offen offset:1024 sc1
MAV 60,28,124
TR 56,6,25408
MAV 44,28,120
TR 58,6,25920
TR 60,6,25440
MAV 44,12,112
TR 62,6,25952
s_waitcnt lgkmcnt(8)
MAV 64,32,112
TR 0,7,33792
s_add_u32 m0, s55, 76032
MAV 64,48,120
buffer_load_dwordx4 v18, s[28:31], s54 offen lds
MAV 80,48,124
TR 2,7,34304
TR 4,7,33824
MAV 80,32,116
TR 6,7,34336
s_add_u32 s52, s76, 81920
MAV 84,36,116
buffer_load_dwordx4 v[104:107], v4, s[16:19], s52 offen sc1
MAV 84,52,124
TR 16,7,42240
MAV 68,52,120
TR 18,7,42752
TR 20,7,42272
MAV 68,36,112
TR 22,7,42784
s_waitcnt lgkmcnt(8)
MAV 72,40,112
buffer_load_dwordx4 v19, s[28:31], s54 offen offset:1056 lds
MAV 72,56,120
s_add_u32 s54, s99, 2359296
MAV 88,56,124
TR 8,7,33856
TR 10,7,34368
MAV 88,40,116
TR 12,7,33888
TR 14,7,34400
MAV 92,44,116
buffer_load_dwordx4 v[108:111], v4, s[16:19], s52 offen offset:1024 sc1
MAV 92,60,124
TR 24,7,42304
MAV 76,60,120
TR 26,7,42816
TR 28,7,42336
MAV 76,44,112
TR 30,7,42848
s_waitcnt vmcnt(16) lgkmcnt(8)
s_barrier
MAV 32,0,128
TR 32,6,33792
s_add_u32 m0, s55, 84480
MAV 32,16,136
buffer_load_dwordx4 v18, s[28:31], s54 offen lds
MAV 48,16,140
TR 34,6,34304
TR 36,6,33824
MAV 48,0,132
TR 38,6,34336
s_add_u32 s52, s77, 131072
MAV 52,4,132
buffer_load_dwordx4 v[112:115], v4, s[16:19], s52 offen sc1
MAV 52,20,140
TR 48,6,42240
MAV 36,20,136
TR 50,6,42752
TR 52,6,42272
MAV 36,4,128
TR 54,6,42784
s_waitcnt lgkmcnt(8)
MAV 40,8,128
buffer_load_dwordx4 v19, s[28:31], s54 offen offset:1056 lds
MAV 40,24,136
s_add_u32 s54, s99, 2621440
MAV 56,24,140
TR 40,6,33856
TR 42,6,34368
MAV 56,8,132
TR 44,6,33888
TR 46,6,34400
MAV 60,12,132
buffer_load_dwordx4 v[116:119], v4, s[16:19], s52 offen offset:1024 sc1
MAV 60,28,140
TR 56,6,42304
MAV 44,28,136
TR 58,6,42816
TR 60,6,42336
MAV 44,12,128
TR 62,6,42848
s_waitcnt lgkmcnt(8)
MAV 64,32,128
TR 0,7,50688
s_add_u32 m0, s55, 92928
MAV 64,48,136
buffer_load_dwordx4 v18, s[28:31], s54 offen lds
MAV 80,48,140
TR 2,7,51200
TR 4,7,50720
MAV 80,32,132
TR 6,7,51232
s_add_u32 s52, s77, 196608
MAV 84,36,132
buffer_load_dwordx4 v[120:123], v4, s[16:19], s52 offen sc1
MAV 84,52,140
TR 16,7,59136
MAV 68,52,136
TR 18,7,59648
TR 20,7,59168
MAV 68,36,128
TR 22,7,59680
s_waitcnt lgkmcnt(8)
MAV 72,40,128
buffer_load_dwordx4 v19, s[28:31], s54 offen offset:1056 lds
MAV 72,56,136
s_add_u32 s54, s100, 2818048
MAV 88,56,140
TR 8,7,50752
TR 10,7,51264
MAV 88,40,132
TR 12,7,50784
TR 14,7,51296
MAV 92,44,132
buffer_load_dwordx4 v[124:127], v4, s[16:19], s52 offen offset:1024 sc1
MAV 92,60,140
TR 24,7,59200
MAV 76,60,136
TR 26,7,59712
TR 28,7,59232
MAV 76,44,128
TR 30,7,59744
s_waitcnt vmcnt(16) lgkmcnt(8)
s_barrier
MAV 32,0,144
TR 32,6,50688
s_add_u32 m0, s55, 101376
MAV 32,16,152
buffer_load_dwordx4 v18, s[28:31], s54 offen lds
MAV 48,16,156
TR 34,6,51200
TR 36,6,50720
MAV 48,0,148
TR 38,6,51232
s_add_u32 s52, s78, 245760
MAV 52,4,148
buffer_load_dwordx4 v[128:131], v4, s[16:19], s52 offen sc1
MAV 52,20,156
TR 48,6,59136
MAV 36,20,152
TR 50,6,59648
TR 52,6,59168
MAV 36,4,144
TR 54,6,59680
s_waitcnt lgkmcnt(8)
MAV 40,8,144
buffer_load_dwordx4 v19, s[28:31], s54 offen offset:1056 lds
MAV 40,24,152
s_add_u32 s54, s100, 3080192
MAV 56,24,156
TR 40,6,50752
TR 42,6,51264
MAV 56,8,148
TR 44,6,50784
TR 46,6,51296
MAV 60,12,148
buffer_load_dwordx4 v[132:135], v4, s[16:19], s52 offen offset:1024 sc1
MAV 60,28,156
TR 56,6,59200
MAV 44,28,152
TR 58,6,59712
TR 60,6,59232
MAV 44,12,144
TR 62,6,59744
v_add_u32 v7, s57, v7
v_add_u32 v6, s57, v6
s_sub_u32 s57, 0, s57
s_waitcnt lgkmcnt(8)
MAV 64,32,144
ds_read_b64_tr_b16 a[0:1], v7
s_add_u32 m0, s55, 109824
MAV 64,48,152
buffer_load_dwordx4 v18, s[28:31], s54 offen lds
MAV 80,48,156
TR 2,7,512
TR 4,7,32
MAV 80,32,148
TR 6,7,544
s_add_u32 s52, s78, 311296
MAV 84,36,148
buffer_load_dwordx4 v[136:139], v4, s[16:19], s52 offen sc1
MAV 84,52,156
TR 16,7,8448
MAV 68,52,152
TR 18,7,8960
TR 20,7,8480
MAV 68,36,144
TR 22,7,8992
s_waitcnt lgkmcnt(8)
MAV 72,40,144
buffer_load_dwordx4 v19, s[28:31], s54 offen offset:1056 lds
MAV 72,56,152
s_add_u32 s54, s101, 3276800
.Lpad8:
s_cbranch_execz .Lpad11
MAV 88,56,156
TR 8,7,64
TR 10,7,576
MAV 88,40,148
TR 12,7,96
TR 14,7,608
MAV 92,44,148
buffer_load_dwordx4 v[140:143], v4, s[16:19], s52 offen offset:1024 sc1
MAV 92,60,156
TR 24,7,8512
MAV 76,60,152
TR 26,7,9024
TR 28,7,8544
MAV 76,44,144
TR 30,7,9056
s_waitcnt vmcnt(16) lgkmcnt(8)
s_barrier
MAV 32,0,96
ds_read_b64_tr_b16 a[32:33], v6
s_add_u32 m0, s55, 118272
MAV 32,16,104
buffer_load_dwordx4 v18, s[28:31], s54 offen lds
MAV 48,16,108
TR 34,6,512
TR 36,6,32
MAV 48,0,100
TR 38,6,544
s_add_u32 s52, s79, 360448
MAV 52,4,100
buffer_load_dwordx4 v[144:147], v4, s[16:19], s52 offen sc1
MAV 52,20,108
TR 48,6,8448
MAV 36,20,104
TR 50,6,8960
TR 52,6,8480
MAV 36,4,96
TR 54,6,8992
s_waitcnt lgkmcnt(8)
MAV 40,8,96
buffer_load_dwordx4 v19, s[28:31], s54 offen offset:1056 lds
MAV 40,24,104
s_add_u32 s54, s101, 3538944
MAV 56,24,108
TR 40,6,64
TR 42,6,576
MAV 56,8,100
TR 44,6,96
TR 46,6,608
MAV 60,12,100
buffer_load_dwordx4 v[148:151], v4, s[16:19], s52 offen offset:1024 sc1
MAV 60,28,108
TR 56,6,8512
MAV 44,28,104
TR 58,6,9024
TR 60,6,8544
MAV 44,12,96
TR 62,6,9056
s_waitcnt lgkmcnt(8)
MAV 64,32,96
TR 0,7,16896
s_add_u32 m0, s55, 126720
MAV 64,48,104
buffer_load_dwordx4 v18, s[28:31], s54 offen lds
MAV 80,48,108
TR 2,7,17408
TR 4,7,16928
MAV 80,32,100
TR 6,7,17440
s_add_u32 s52, s79, 425984
MAV 84,36,100
buffer_load_dwordx4 v[152:155], v4, s[16:19], s52 offen sc1
MAV 84,52,108
TR 16,7,25344
MAV 68,52,104
TR 18,7,25856
TR 20,7,25376
MAV 68,36,96
TR 22,7,25888
s_waitcnt lgkmcnt(8)
MAV 72,40,96
buffer_load_dwordx4 v19, s[28:31], s54 offen offset:1056 lds
MAV 72,56,104
s_add_u32 s54, s98, 131072
MAV 88,56,108
TR 8,7,16960
TR 10,7,17472
MAV 88,40,100
TR 12,7,16992
TR 14,7,17504
MAV 92,44,100
buffer_load_dwordx4 v[156:159], v4, s[16:19], s52 offen offset:1024 sc1
MAV 92,60,108
TR 24,7,25408
MAV 76,60,104
TR 26,7,25920
TR 28,7,25440
MAV 76,44,96
TR 30,7,25952
s_waitcnt vmcnt(16) lgkmcnt(8)
s_barrier
MAV 32,0,112
TR 32,6,16896
s_add_u32 m0, s55, 0
MAV 32,16,120
buffer_load_dwordx4 v18, s[28:31], s54 offen lds
MAV 48,16,124
TR 34,6,17408
TR 36,6,16928
MAV 48,0,116
TR 38,6,17440
s_add_u32 s52, s76, 475136
MAV 52,4,116
buffer_load_dwordx4 v[96:99], v4, s[16:19], s52 offen sc1
MAV 52,20,124
TR 48,6,25344
MAV 36,20,120
TR 50,6,25856
TR 52,6,25376
MAV 36,4,112
TR 54,6,25888
s_waitcnt lgkmcnt(8)
MAV 40,8,112
buffer_load_dwordx4 v19, s[28:31], s54 offen offset:1056 lds
MAV 40,24,120
s_add_u32 s54, s98, 393216
MAV 56,24,124
TR 40,6,16960
TR 42,6,17472
MAV 56,8,116
TR 44,6,16992
TR 46,6,17504
MAV 60,12,116
buffer_load_dwordx4 v[100:103], v4, s[16:19], s52 offen offset:1024 sc1
MAV 60,28,124
TR 56,6,25408
MAV 44,28,120
TR 58,6,25920
TR 60,6,25440
MAV 44,12,112
TR 62,6,25952
s_waitcnt lgkmcnt(8)
MAV 64,32,112
TR 0,7,33792
s_add_u32 m0, s55, 8448
MAV 64,48,120
buffer_load_dwordx4 v18, s[28:31], s54 offen lds
MAV 80,48,124
TR 2,7,34304
TR 4,7,33824
MAV 80,32,116
TR 6,7,34336
s_add_u32 s52, s76, 540672
MAV 84,36,116
buffer_load_dwordx4 v[104:107], v4, s[16:19], s52 offen sc1
MAV 84,52,124
TR 16,7,42240
MAV 68,52,120
TR 18,7,42752
TR 20,7,42272
MAV 68,36,112
TR 22,7,42784
s_waitcnt lgkmcnt(8)
MAV 72,40,112
buffer_load_dwordx4 v19, s[28:31], s54 offen offset:1056 lds
MAV 72,56,120
s_add_u32 s54, s99, 589824
MAV 88,56,124
TR 8,7,33856
TR 10,7,34368
MAV 88,40,116
TR 12,7,33888
TR 14,7,34400
MAV 92,44,116
buffer_load_dwordx4 v[108:111], v4, s[16:19], s52 offen offset:1024 sc1
MAV 92,60,124
TR 24,7,42304
MAV 76,60,120
TR 26,7,42816
TR 28,7,42336
MAV 76,44,112
TR 30,7,42848
s_waitcnt vmcnt(16) lgkmcnt(8)
s_barrier
MAV 32,0,128
TR 32,6,33792
s_add_u32 m0, s55, 16896
MAV 32,16,136
buffer_load_dwordx4 v18, s[28:31], s54 offen lds
MAV 48,16,140
TR 34,6,34304
TR 36,6,33824
MAV 48,0,132
TR 38,6,34336
s_add_u32 s52, s77, 589824
MAV 52,4,132
buffer_load_dwordx4 v[112:115], v4, s[16:19], s52 offen sc1
MAV 52,20,140
TR 48,6,42240
MAV 36,20,136
TR 50,6,42752
TR 52,6,42272
MAV 36,4,128
TR 54,6,42784
s_waitcnt lgkmcnt(8)
MAV 40,8,128
buffer_load_dwordx4 v19, s[28:31], s54 offen offset:1056 lds
MAV 40,24,136
s_add_u32 s54, s99, 851968
MAV 56,24,140
TR 40,6,33856
TR 42,6,34368
MAV 56,8,132
TR 44,6,33888
TR 46,6,34400
MAV 60,12,132
buffer_load_dwordx4 v[116:119], v4, s[16:19], s52 offen offset:1024 sc1
MAV 60,28,140
TR 56,6,42304
MAV 44,28,136
TR 58,6,42816
TR 60,6,42336
MAV 44,12,128
TR 62,6,42848
s_waitcnt lgkmcnt(8)
MAV 64,32,128
TR 0,7,50688
s_add_u32 m0, s55, 25344
MAV 64,48,136
buffer_load_dwordx4 v18, s[28:31], s54 offen lds
MAV 80,48,140
TR 2,7,51200
TR 4,7,50720
MAV 80,32,132
TR 6,7,51232
s_add_u32 s52, s77, 655360
MAV 84,36,132
buffer_load_dwordx4 v[120:123], v4, s[16:19], s52 offen sc1
MAV 84,52,140
TR 16,7,59136
MAV 68,52,136
TR 18,7,59648
TR 20,7,59168
MAV 68,36,128
TR 22,7,59680
s_waitcnt lgkmcnt(8)
MAV 72,40,128
buffer_load_dwordx4 v19, s[28:31], s54 offen offset:1056 lds
MAV 72,56,136
s_add_u32 s54, s100, 1048576
MAV 88,56,140
TR 8,7,50752
TR 10,7,51264
MAV 88,40,132
TR 12,7,50784
TR 14,7,51296
MAV 92,44,132
buffer_load_dwordx4 v[124:127], v4, s[16:19], s52 offen offset:1024 sc1
MAV 92,60,140
TR 24,7,59200
MAV 76,60,136
TR 26,7,59712
TR 28,7,59232
MAV 76,44,128
TR 30,7,59744
s_waitcnt vmcnt(16) lgkmcnt(8)
s_barrier
MAV 32,0,144
TR 32,6,50688
s_add_u32 m0, s55, 33792
MAV 32,16,152
buffer_load_dwordx4 v18, s[28:31], s54 offen lds
MAV 48,16,156
TR 34,6,51200
TR 36,6,50720
MAV 48,0,148
TR 38,6,51232
s_add_u32 s52, s78, 704512
MAV 52,4,148
buffer_load_dwordx4 v[128:131], v4, s[16:19], s52 offen sc1
MAV 52,20,156
TR 48,6,59136
MAV 36,20,152
TR 50,6,59648
TR 52,6,59168
MAV 36,4,144
TR 54,6,59680
s_waitcnt lgkmcnt(8)
MAV 40,8,144
buffer_load_dwordx4 v19, s[28:31], s54 offen offset:1056 lds
MAV 40,24,152
s_add_u32 s54, s100, 1310720
MAV 56,24,156
TR 40,6,50752
TR 42,6,51264
MAV 56,8,148
TR 44,6,50784
TR 46,6,51296
MAV 60,12,148
buffer_load_dwordx4 v[132:135], v4, s[16:19], s52 offen offset:1024 sc1
MAV 60,28,156
TR 56,6,59200
MAV 44,28,152
TR 58,6,59712
TR 60,6,59232
MAV 44,12,144
TR 62,6,59744
v_add_u32 v7, s57, v7
v_add_u32 v6, s57, v6
s_sub_u32 s57, 0, s57
s_waitcnt lgkmcnt(8)
MAV 64,32,144
ds_read_b64_tr_b16 a[0:1], v7
s_add_u32 m0, s55, 42240
MAV 64,48,152
buffer_load_dwordx4 v18, s[28:31], s54 offen lds
MAV 80,48,156
TR 2,7,512
TR 4,7,32
MAV 80,32,148
TR 6,7,544
s_add_u32 s52, s78, 770048
MAV 84,36,148
buffer_load_dwordx4 v[136:139], v4, s[16:19], s52 offen sc1
MAV 84,52,156
TR 16,7,8448
MAV 68,52,152
TR 18,7,8960
TR 20,7,8480
MAV 68,36,144
TR 22,7,8992
s_waitcnt lgkmcnt(8)
MAV 72,40,144
buffer_load_dwordx4 v19, s[28:31], s54 offen offset:1056 lds
MAV 72,56,152
s_add_u32 s54, s101, 1507328
MAV 88,56,156
TR 8,7,64
TR 10,7,576
MAV 88,40,148
TR 12,7,96
TR 14,7,608
MAV 92,44,148
buffer_load_dwordx4 v[140:143], v4, s[16:19], s52 offen offset:1024 sc1
MAV 92,60,156
TR 24,7,8512
MAV 76,60,152
TR 26,7,9024
TR 28,7,8544
MAV 76,44,144
TR 30,7,9056
s_waitcnt vmcnt(16) lgkmcnt(8)
s_barrier
MAV 32,0,96
ds_read_b64_tr_b16 a[32:33], v6
s_add_u32 m0, s55, 50688
MAV 32,16,104
buffer_load_dwordx4 v18, s[28:31], s54 offen lds
MAV 48,16,108
TR 34,6,512
TR 36,6,32
MAV 48,0,100
TR 38,6,544
s_add_u32 s52, s79, 819200
MAV 52,4,100
buffer_load_dwordx4 v[144:147], v4, s[16:19], s52 offen sc1
MAV 52,20,108
TR 48,6,8448
MAV 36,20,104
TR 50,6,8960
TR 52,6,8480
MAV 36,4,96
TR 54,6,8992
s_waitcnt lgkmcnt(8)
MAV 40,8,96
buffer_load_dwordx4 v19, s[28:31], s54 offen offset:1056 lds
MAV 40,24,104
s_add_u32 s54, s101, 1769472
MAV 56,24,108
TR 40,6,64
TR 42,6,576
MAV 56,8,100
TR 44,6,96
TR 46,6,608
MAV 60,12,100
buffer_load_dwordx4 v[148:151], v4, s[16:19], s52 offen offset:1024 sc1
MAV 60,28,108
TR 56,6,8512
MAV 44,28,104
TR 58,6,9024
TR 60,6,8544
MAV 44,12,96
TR 62,6,9056
s_waitcnt lgkmcnt(8)
MAV 64,32,96
TR 0,7,16896
s_add_u32 m0, s55, 59136
MAV 64,48,104
buffer_load_dwordx4 v18, s[28:31], s54 offen lds
MAV 80,48,108
TR 2,7,17408
TR 4,7,16928
MAV 80,32,100
TR 6,7,17440
s_add_u32 s52, s79, 884736
MAV 84,36,100
buffer_load_dwordx4 v[152:155], v4, s[16:19], s52 offen sc1
MAV 84,52,108
TR 16,7,25344
MAV 68,52,104
TR 18,7,25856
TR 20,7,25376
MAV 68,36,96
TR 22,7,25888
s_waitcnt lgkmcnt(8)
MAV 72,40,96
buffer_load_dwordx4 v19, s[28:31], s54 offen offset:1056 lds
MAV 72,56,104
s_add_u32 s54, s98, 1966080
MAV 88,56,108
TR 8,7,16960
TR 10,7,17472
MAV 88,40,100
TR 12,7,16992
TR 14,7,17504
MAV 92,44,100
buffer_load_dwordx4 v[156:159], v4, s[16:19], s52 offen offset:1024 sc1
MAV 92,60,108
TR 24,7,25408
MAV 76,60,104
TR 26,7,25920
TR 28,7,25440
MAV 76,44,96
TR 30,7,25952
s_waitcnt vmcnt(16) lgkmcnt(8)
s_barrier
MAV 32,0,112
TR 32,6,16896
s_add_u32 m0, s55, 67584
MAV 32,16,120
buffer_load_dwordx4 v18, s[28:31], s54 offen lds
MAV 48,16,124
TR 34,6,17408
TR 36,6,16928
MAV 48,0,116
TR 38,6,17440
s_add_u32 s52, s76, 32768
MAV 52,4,116
buffer_load_dwordx4 v[96:99], v4, s[16:19], s52 offen sc1
MAV 52,20,124
TR 48,6,25344
MAV 36,20,120
TR 50,6,25856
TR 52,6,25376
MAV 36,4,112
TR 54,6,25888
s_waitcnt lgkmcnt(8)
MAV 40,8,112
buffer_load_dwordx4 v19, s[28:31], s54 offen offset:1056 lds
MAV 40,24,120
s_add_u32 s54, s98, 2228224
MAV 56,24,124
TR 40,6,16960
TR 42,6,17472
MAV 56,8,116
TR 44,6,16992
TR 46,6,17504
MAV 60,12,116
buffer_load_dwordx4 v[100:103], v4, s[16:19], s52 offen offset:1024 sc1
MAV 60,28,124
TR 56,6,25408
MAV 44,28,120
TR 58,6,25920
TR 60,6,25440
MAV 44,12,112
TR 62,6,25952
s_waitcnt lgkmcnt(8)
MAV 64,32,112
TR 0,7,33792
s_add_u32 m0, s55, 76032
MAV 64,48,120
buffer_load_dwordx4 v18, s[28:31], s54 offen lds
MAV 80,48,124
TR 2,7,34304
TR 4,7,33824
MAV 80,32,116
TR 6,7,34336
s_add_u32 s52, s76, 98304
MAV 84,36,116
buffer_load_dwordx4 v[104:107], v4, s[16:19], s52 offen sc1
MAV 84,52,124
TR 16,7,42240
MAV 68,52,120
TR 18,7,42752
TR 20,7,42272
MAV 68,36,112
TR 22,7,42784
s_waitcnt lgkmcnt(8)
MAV 72,40,112
buffer_load_dwordx4 v19, s[28:31], s54 offen offset:1056 lds
MAV 72,56,120
s_add_u32 s54, s99, 2424832
MAV 88,56,124
TR 8,7,33856
TR 10,7,34368
MAV 88,40,116
TR 12,7,33888
TR 14,7,34400
MAV 92,44,116
buffer_load_dwordx4 v[108:111], v4, s[16:19], s52 offen offset:1024 sc1
MAV 92,60,124
TR 24,7,42304
MAV 76,60,120
TR 26,7,42816
TR 28,7,42336
MAV 76,44,112
TR 30,7,42848
s_waitcnt vmcnt(16) lgkmcnt(8)
s_barrier
MAV 32,0,128
TR 32,6,33792
s_add_u32 m0, s55, 84480
MAV 32,16,136
buffer_load_dwordx4 v18, s[28:31], s54 offen lds
MAV 48,16,140
TR 34,6,34304
TR 36,6,33824
MAV 48,0,132
TR 38,6,34336
s_add_u32 s52, s77, 147456
.Lpad9:
s_cbranch_execz .Lnopoll36r
MAV 52,4,132
buffer_load_dwordx4 v[112:115], v4, s[16:19], s52 offen sc1
MAV 52,20,140
TR 48,6,42240
MAV 36,20,136
TR 50,6,42752
TR 52,6,42272
MAV 36,4,128
TR 54,6,42784
s_waitcnt lgkmcnt(8)
MAV 40,8,128
buffer_load_dwordx4 v19, s[28:31], s54 offen offset:1056 lds
MAV 40,24,136
s_add_u32 s54, s99, 2686976
MAV 56,24,140
TR 40,6,33856
TR 42,6,34368
MAV 56,8,132
TR 44,6,33888
TR 46,6,34400
MAV 60,12,132
buffer_load_dwordx4 v[116:119], v4, s[16:19], s52 offen offset:1024 sc1
MAV 60,28,140
TR 56,6,42304
MAV 44,28,136
TR 58,6,42816
TR 60,6,42336
MAV 44,12,128
TR 62,6,42848
s_waitcnt lgkmcnt(8)
MAV 64,32,128
TR 0,7,50688
s_add_u32 m0, s55, 92928
MAV 64,48,136
buffer_load_dwordx4 v18, s[28:31], s54 offen lds
MAV 80,48,140
TR 2,7,51200
TR 4,7,50720
MAV 80,32,132
TR 6,7,51232
s_add_u32 s52, s77, 212992
MAV 84,36,132
buffer_load_dwordx4 v[120:123], v4, s[16:19], s52 offen sc1
MAV 84,52,140
TR 16,7,59136
MAV 68,52,136
TR 18,7,59648
TR 20,7,59168
MAV 68,36,128
TR 22,7,59680
s_waitcnt lgkmcnt(8)
MAV 72,40,128
buffer_load_dwordx4 v19, s[28:31], s54 offen offset:1056 lds
MAV 72,56,136
s_add_u32 s54, s100, 2883584
MAV 88,56,140
TR 8,7,50752
TR 10,7,51264
MAV 88,40,132
TR 12,7,50784
TR 14,7,51296
MAV 92,44,132
buffer_load_dwordx4 v[124:127], v4, s[16:19], s52 offen offset:1024 sc1
MAV 92,60,140
TR 24,7,59200
MAV 76,60,136
TR 26,7,59712
TR 28,7,59232
MAV 76,44,128
TR 30,7,59744
s_waitcnt vmcnt(16) lgkmcnt(8)
s_barrier
MAV 32,0,144
TR 32,6,50688
s_add_u32 m0, s55, 101376
MAV 32,16,152
buffer_load_dwordx4 v18, s[28:31], s54 offen lds
MAV 48,16,156
TR 34,6,51200
TR 36,6,50720
MAV 48,0,148
TR 38,6,51232
s_add_u32 s52, s78, 262144
MAV 52,4,148
buffer_load_dwordx4 v[128:131], v4, s[16:19], s52 offen sc1
MAV 52,20,156
TR 48,6,59136
MAV 36,20,152
TR 50,6,59648
TR 52,6,59168
MAV 36,4,144
TR 54,6,59680
s_waitcnt lgkmcnt(8)
MAV 40,8,144
buffer_load_dwordx4 v19, s[28:31], s54 offen offset:1056 lds
MAV 40,24,152
s_add_u32 s54, s100, 3145728
MAV 56,24,156
TR 40,6,50752
TR 42,6,51264
MAV 56,8,148
TR 44,6,50784
TR 46,6,51296
MAV 60,12,148
buffer_load_dwordx4 v[132:135], v4, s[16:19], s52 offen offset:1024 sc1
MAV 60,28,156
TR 56,6,59200
MAV 44,28,152
TR 58,6,59712
TR 60,6,59232
MAV 44,12,144
TR 62,6,59744
v_add_u32 v7, s57, v7
v_add_u32 v6, s57, v6
s_sub_u32 s57, 0, s57
s_waitcnt lgkmcnt(8)
MAV 64,32,144
ds_read_b64_tr_b16 a[0:1], v7
s_add_u32 m0, s55, 109824
MAV 64,48,152
buffer_load_dwordx4 v18, s[28:31], s54 offen lds
MAV 80,48,156
TR 2,7,512
TR 4,7,32
MAV 80,32,148
TR 6,7,544
s_add_u32 s52, s78, 327680
MAV 84,36,148
buffer_load_dwordx4 v[136:139], v4, s[16:19], s52 offen sc1
MAV 84,52,156
TR 16,7,8448
MAV 68,52,152
TR 18,7,8960
TR 20,7,8480
MAV 68,36,144
TR 22,7,8992
s_waitcnt lgkmcnt(8)
MAV 72,40,144
buffer_load_dwordx4 v19, s[28:31], s54 offen offset:1056 lds
MAV 72,56,152
s_add_u32 s54, s101, 3342336
MAV 88,56,156
TR 8,7,64
TR 10,7,576
MAV 88,40,148
TR 12,7,96
TR 14,7,608
MAV 92,44,148
buffer_load_dwordx4 v[140:143], v4, s[16:19], s52 offen offset:1024 sc1
MAV 92,60,156
TR 24,7,8512
MAV 76,60,152
TR 26,7,9024
TR 28,7,8544
MAV 76,44,144
TR 30,7,9056
s_waitcnt vmcnt(16) lgkmcnt(8)
s_barrier
MAV 32,0,96
ds_read_b64_tr_b16 a[32:33], v6
s_add_u32 m0, s55, 118272
MAV 32,16,104
buffer_load_dwordx4 v18, s[28:31], s54 offen lds
MAV 48,16,108
TR 34,6,512
TR 36,6,32
MAV 48,0,100
TR 38,6,544
s_add_u32 s52, s79, 376832
MAV 52,4,100
buffer_load_dwordx4 v[144:147], v4, s[16:19], s52 offen sc1
MAV 52,20,108
TR 48,6,8448
MAV 36,20,104
TR 50,6,8960
TR 52,6,8480
MAV 36,4,96
TR 54,6,8992
s_waitcnt lgkmcnt(8)
MAV 40,8,96
buffer_load_dwordx4 v19, s[28:31], s54 offen offset:1056 lds
MAV 40,24,104
s_add_u32 s54, s101, 3604480
MAV 56,24,108
TR 40,6,64
TR 42,6,576
MAV 56,8,100
TR 44,6,96
TR 46,6,608
MAV 60,12,100
buffer_load_dwordx4 v[148:151], v4, s[16:19], s52 offen offset:1024 sc1
MAV 60,28,108
TR 56,6,8512
MAV 44,28,104
TR 58,6,9024
TR 60,6,8544
MAV 44,12,96
TR 62,6,9056
s_waitcnt lgkmcnt(8)
MAV 64,32,96
TR 0,7,16896
s_add_u32 m0, s55, 126720
MAV 64,48,104
buffer_load_dwordx4 v18, s[28:31], s54 offen lds
MAV 80,48,108
TR 2,7,17408
TR 4,7,16928
MAV 80,32,100
TR 6,7,17440
s_add_u32 s52, s79, 442368
MAV 84,36,100
buffer_load_dwordx4 v[152:155], v4, s[16:19], s52 offen sc1
MAV 84,52,108
TR 16,7,25344
MAV 68,52,104
TR 18,7,25856
TR 20,7,25376
MAV 68,36,96
TR 22,7,25888
s_waitcnt lgkmcnt(8)
MAV 72,40,96
buffer_load_dwordx4 v19, s[28:31], s54 offen offset:1056 lds
MAV 72,56,104
s_add_u32 s54, s98, 196608
MAV 88,56,108
TR 8,7,16960
TR 10,7,17472
MAV 88,40,100
TR 12,7,16992
TR 14,7,17504
MAV 92,44,100
buffer_load_dwordx4 v[156:159], v4, s[16:19], s52 offen offset:1024 sc1
MAV 92,60,108
TR 24,7,25408
MAV 76,60,104
TR 26,7,25920
TR 28,7,25440
MAV 76,44,96
TR 30,7,25952
s_waitcnt vmcnt(16) lgkmcnt(8)
s_barrier
MAV 32,0,112
TR 32,6,16896
s_add_u32 m0, s55, 0
MAV 32,16,120
buffer_load_dwordx4 v18, s[28:31], s54 offen lds
MAV 48,16,124
TR 34,6,17408
TR 36,6,16928
MAV 48,0,116
TR 38,6,17440
s_add_u32 s52, s76, 491520
MAV 52,4,116
buffer_load_dwordx4 v[96:99], v4, s[16:19], s52 offen sc1
MAV 52,20,124
TR 48,6,25344
MAV 36,20,120
TR 50,6,25856
TR 52,6,25376
MAV 36,4,112
TR 54,6,25888
s_waitcnt lgkmcnt(8)
MAV 40,8,112
buffer_load_dwordx4 v19, s[28:31], s54 offen offset:1056 lds
MAV 40,24,120
s_add_u32 s54, s99, 655360
MAV 56,24,124
TR 40,6,16960
TR 42,6,17472
MAV 56,8,116
TR 44,6,16992
TR 46,6,17504
MAV 60,12,116
buffer_load_dwordx4 v[100:103], v4, s[16:19], s52 offen offset:1024 sc1
MAV 60,28,124
TR 56,6,25408
MAV 44,28,120
TR 58,6,25920
TR 60,6,25440
MAV 44,12,112
TR 62,6,25952
s_waitcnt lgkmcnt(8)
MAV 64,32,112
TR 0,7,33792
s_add_u32 m0, s55, 8448
MAV 64,48,120
buffer_load_dwordx4 v18, s[28:31], s54 offen lds
MAV 80,48,124
TR 2,7,34304
TR 4,7,33824
MAV 80,32,116
TR 6,7,34336
s_add_u32 s52, s76, 557056
MAV 84,36,116
buffer_load_dwordx4 v[104:107], v4, s[16:19], s52 offen sc1
MAV 84,52,124
TR 16,7,42240
MAV 68,52,120
TR 18,7,42752
TR 20,7,42272
MAV 68,36,112
TR 22,7,42784
s_waitcnt lgkmcnt(8)
MAV 72,40,112
buffer_load_dwordx4 v19, s[28:31], s54 offen offset:1056 lds
MAV 72,56,120
s_add_u32 s54, s100, 1114112
MAV 88,56,124
TR 8,7,33856
TR 10,7,34368
MAV 88,40,116
TR 12,7,33888
TR 14,7,34400
MAV 92,44,116
buffer_load_dwordx4 v[108:111], v4, s[16:19], s52 offen offset:1024 sc1
MAV 92,60,124
TR 24,7,42304
MAV 76,60,120
TR 26,7,42816
TR 28,7,42336
MAV 76,44,112
TR 30,7,42848
s_waitcnt vmcnt(16) lgkmcnt(8)
s_barrier
MAV 32,0,128
TR 32,6,33792
s_add_u32 m0, s55, 16896
MAV 32,16,136
buffer_load_dwordx4 v18, s[28:31], s54 offen lds
MAV 48,16,140
TR 34,6,34304
TR 36,6,33824
MAV 48,0,132
TR 38,6,34336
s_add_u32 s52, s77, 606208
MAV 52,4,132
buffer_load_dwordx4 v[112:115], v4, s[16:19], s52 offen sc1
MAV 52,20,140
TR 48,6,42240
MAV 36,20,136
TR 50,6,42752
TR 52,6,42272
MAV 36,4,128
TR 54,6,42784
s_waitcnt lgkmcnt(8)
MAV 40,8,128
buffer_load_dwordx4 v19, s[28:31], s54 offen offset:1056 lds
MAV 40,24,136
s_add_u32 s54, s101, 1572864
MAV 56,24,140
TR 40,6,33856
TR 42,6,34368
MAV 56,8,132
TR 44,6,33888
TR 46,6,34400
MAV 60,12,132
buffer_load_dwordx4 v[116:119], v4, s[16:19], s52 offen offset:1024 sc1
MAV 60,28,140
TR 56,6,42304
MAV 44,28,136
TR 58,6,42816
TR 60,6,42336
MAV 44,12,128
TR 62,6,42848
s_waitcnt lgkmcnt(8)
MAV 64,32,128
TR 0,7,50688
s_add_u32 m0, s55, 25344
MAV 64,48,136
buffer_load_dwordx4 v18, s[28:31], s54 offen lds
MAV 80,48,140
TR 2,7,51200
TR 4,7,50720
MAV 80,32,132
TR 6,7,51232
s_add_u32 s52, s77, 671744
MAV 84,36,132
buffer_load_dwordx4 v[120:123], v4, s[16:19], s52 offen sc1
MAV 84,52,140
TR 16,7,59136
MAV 68,52,136
TR 18,7,59648
TR 20,7,59168
MAV 68,36,128
TR 22,7,59680
s_waitcnt lgkmcnt(8)
MAV 72,40,128
buffer_load_dwordx4 v19, s[28:31], s54 offen offset:1056 lds
MAV 72,56,136
s_add_u32 s54, s98, 2031616
MAV 88,56,140
TR 8,7,50752
TR 10,7,51264
MAV 88,40,132
TR 12,7,50784
TR 14,7,51296
MAV 92,44,132
buffer_load_dwordx4 v[124:127], v4, s[16:19], s52 offen offset:1024 sc1
MAV 92,60,140
TR 24,7,59200
MAV 76,60,136
TR 26,7,59712
TR 28,7,59232
MAV 76,44,128
TR 30,7,59744
s_waitcnt vmcnt(16) lgkmcnt(8)
s_barrier
MAV 32,0,144
TR 32,6,50688
s_add_u32 m0, s55, 33792
MAV 32,16,152
buffer_load_dwordx4 v18, s[28:31], s54 offen lds
MAV 48,16,156
TR 34,6,51200
TR 36,6,50720
MAV 48,0,148
TR 38,6,51232
s_add_u32 s52, s78, 720896
MAV 52,4,148
buffer_load_dwordx4 v[128:131], v4, s[16:19], s52 offen sc1
MAV 52,20,156
TR 48,6,59136
MAV 36,20,152
TR 50,6,59648
TR 52,6,59168
MAV 36,4,144
TR 54,6,59680
s_waitcnt lgkmcnt(8)
MAV 40,8,144
buffer_load_dwordx4 v19, s[28:31], s54 offen offset:1056 lds
MAV 40,24,152
s_add_u32 s54, s99, 2490368
MAV 56,24,156
TR 40,6,50752
TR 42,6,51264
MAV 56,8,148
TR 44,6,50784
TR 46,6,51296
MAV 60,12,148
buffer_load_dwordx4 v[132:135], v4, s[16:19], s52 offen offset:1024 sc1
MAV 60,28,156
TR 56,6,59200
MAV 44,28,152
TR 58,6,59712
TR 60,6,59232
MAV 44,12,144
TR 62,6,59744
v_add_u32 v7, s57, v7
v_add_u32 v6, s57, v6
s_sub_u32 s57, 0, s57
s_waitcnt lgkmcnt(8)
MAV 64,32,144
ds_read_b64_tr_b16 a[0:1], v6
s_add_u32 m0, s55, 42240
MAV 64,48,152
buffer_load_dwordx4 v18, s[28:31], s54 offen lds
MAV 80,48,156
TR 2,6,512
TR 4,6,32
MAV 80,32,148
TR 6,6,544
s_add_u32 s52, s78, 786432
MAV 84,36,148
buffer_load_dwordx4 v[136:139], v4, s[16:19], s52 offen sc1
MAV 84,52,156
TR 16,6,8448
MAV 68,52,152
TR 18,6,8960
TR 20,6,8480
MAV 68,36,144
TR 22,6,8992
s_waitcnt lgkmcnt(8)
MAV 72,40,144
buffer_load_dwordx4 v19, s[28:31], s54 offen offset:1056 lds
MAV 72,56,152
s_add_u32 s54, s100, 2949120
MAV 88,56,156
TR 8,6,64
TR 10,6,576
MAV 88,40,148
TR 12,6,96
TR 14,6,608
MAV 92,44,148
buffer_load_dwordx4 v[140:143], v4, s[16:19], s52 offen offset:1024 sc1
MAV 92,60,156
TR 24,6,8512
MAV 76,60,152
TR 26,6,9024
TR 28,6,8544
MAV 76,44,144
TR 30,6,9056
s_waitcnt vmcnt(16) lgkmcnt(8)
s_barrier
MAV 64,0,96
TR 32,6,16896
TR 34,6,17408
s_add_u32 m0, s55, 50688
MAV 64,16,104
TR 36,6,16928
buffer_load_dwordx4 v18, s[28:31], s54 offen lds
MAV 80,16,108
buffer_load_dwordx4 v19, s[28:31], s54 offen offset:1056 lds
MAV 80,0,100
TR 38,6,17440
s_add_u32 s54, s101, 3407872
s_add_u32 s52, s79, 835584
MAV 84,4,100
TR 48,6,25344
buffer_load_dwordx4 v[144:147], v4, s[16:19], s52 offen sc1
MAV 84,20,108
TR 50,6,25856
MAV 68,20,104
TR 52,6,25376
buffer_load_dwordx4 v[148:151], v4, s[16:19], s52 offen offset:1024 sc1
MAV 68,4,96
TR 54,6,25888
s_add_u32 m0, s55, 59136
s_waitcnt lgkmcnt(8)
MAV 72,8,96
buffer_load_dwordx4 v18, s[28:31], s54 offen lds
MAV 72,24,104
TR 40,6,16960
TR 42,6,17472
MAV 88,24,108
TR 44,6,16992
buffer_load_dwordx4 v19, s[28:31], s54 offen offset:1056 lds
MAV 88,8,100
TR 46,6,17504
s_add_u32 s52, s79, 901120
MAV 92,12,100
TR 56,6,25408
.Lpad10:
s_cbranch_execz .Lnopoll36r
buffer_load_dwordx4 v[152:155], v4, s[16:19], s52 offen sc1
MAV 92,28,108
TR 58,6,25920
MAV 76,28,104
TR 60,6,25440
buffer_load_dwordx4 v[156:159], v4, s[16:19], s52 offen offset:1024 sc1
MAV 76,12,96
TR 62,6,25952
s_waitcnt vmcnt(16) lgkmcnt(8)
MAV 64,32,112
TR 0,6,33792
s_add_u32 s52, s76, 49152
s_lshl_b32 s70, s2, 10
MAV 64,48,120
buffer_load_dwordx4 v[160:163], v4, s[16:19], s52 offen sc1
s_lshl_b32 s62, s3, 7
MAV 80,48,124
TR 2,6,34304
TR 4,6,33824
MAV 80,32,116
TR 6,6,34336
s_add_u32 s70, s70, s62
s_add_u32 s70, s70, 31457280
MAV 84,36,116
buffer_load_dwordx4 v[164:167], v4, s[16:19], s52 offen offset:1024 sc1
s_xor_b32 s71, s70, 1024
MAV 84,52,124
TR 16,6,42240
TR 18,6,42752
MAV 68,52,120
TR 20,6,42272
v_min_u32 v12, 1, v1
v_lshlrev_b32 v12, 28, v12
MAV 68,36,112
TR 22,6,42784
s_add_u32 s52, s77, 163840
s_waitcnt lgkmcnt(8)
MAV 72,40,112
buffer_load_dwordx4 v[168:171], v4, s[16:19], s52 offen sc1
v_mov_b32 v13, 1
MAV 72,56,120
TR 8,6,33856
v_mov_b32 v15, 0
s_lshl_b32 s68, s7, 15
MAV 88,56,124
TR 10,6,34368
TR 12,6,33888
MAV 88,40,116
TR 14,6,34400
s_add_u32 s68, s68, 33554432
s_xor_b32 s69, s68, 32768
MAV 92,44,116
buffer_load_dwordx4 v[172:175], v4, s[16:19], s52 offen offset:1024 sc1
v_mov_b32 v11, v4
MAV 92,60,124
TR 24,6,42304
TR 26,6,42816
MAV 76,60,120
TR 28,6,42336
v_and_b32 v2, 1, v1
v_lshlrev_b32 v2, 4, v2
MAV 76,44,112
TR 30,6,42848
v_mov_b32 v224, 0x3f80
s_waitcnt vmcnt(12) lgkmcnt(8)
MAV 64,0,128
TR 32,6,50688
s_add_u32 s52, s78, 278528
v_lshlrev_b32 v2, v2, v224
MAV 64,16,136
buffer_load_dwordx4 v[176:179], v4, s[16:19], s52 offen sc1
v_bfe_u32 v224, v1, 2, 2
MAV 80,16,140
TR 34,6,51200
TR 36,6,50720
MAV 80,0,132
TR 38,6,51232
v_lshrrev_b32 v225, 4, v1
v_cmp_eq_u32 vcc, v224, v225
MAV 84,4,132
buffer_load_dwordx4 v[180:183], v4, s[16:19], s52 offen offset:1024 sc1
v_cndmask_b32 v2, 0, v2, vcc
MAV 84,20,140
TR 48,6,59136
TR 50,6,59648
MAV 68,20,136
TR 52,6,59168
v_and_b32 v224, 2, v1
v_cmp_eq_u32 vcc, 0, v224
MAV 68,4,128
TR 54,6,59680
s_add_u32 s52, s79, 393216
s_waitcnt lgkmcnt(8)
MAV 72,8,128
buffer_load_dwordx4 v[184:187], v4, s[16:19], s52 offen sc1
v_cndmask_b32 v226, 0, v2, vcc
MAV 72,24,136
TR 40,6,50752
v_cndmask_b32 v227, v2, 0, vcc
v_mov_b32 v224, 0
MAV 88,24,140
TR 42,6,51264
TR 44,6,50784
MAV 88,8,132
TR 46,6,51296
v_mov_b32 v225, 0
v_mov_b32 v228, 0
MAV 92,12,132
buffer_load_dwordx4 v[188:191], v4, s[16:19], s52 offen offset:1024 sc1
v_mov_b32 v229, 0
MAV 92,28,140
TR 56,6,59200
TR 58,6,59712
MAV 76,28,136
TR 60,6,59232
v_bfe_u32 v18, v1, 3, 1
v_lshrrev_b32 v2, 4, v1
MAV 76,12,128
TR 62,6,59744
v_lshl_add_u32 v18, v2, 3, v18
s_waitcnt vmcnt(8) lgkmcnt(8)
s_barrier
v_add_u32 v6, s57, v6
MAV 64,32,144
ds_read_b64_tr_b16 a[0:1], v6
s_add_u32 s52, s76, 507904
s_lshl_b32 s62, s3, 1
MAV 64,48,152
buffer_load_dwordx4 v[192:195], v4, s[16:19], s52 offen sc1
v_add_u32 v18, s62, v18
MAV 80,48,156
TR 2,6,512
TR 4,6,32
MAV 80,32,148
TR 6,6,544
v_mul_u32_u24 v18, 6144, v18
v_and_b32 v2, 7, v1
MAV 84,36,148
buffer_load_dwordx4 v[196:199], v4, s[16:19], s52 offen offset:1024 sc1
v_lshl_add_u32 v18, v2, 4, v18
MAV 84,52,156
TR 16,6,8448
TR 18,6,8960
MAV 68,52,152
TR 20,6,8480
s_lshl_b32 s62, s9, 7
v_add_u32 v18, s62, v18
MAV 68,36,144
TR 22,6,8992
s_add_u32 s52, s77, 622592
s_waitcnt lgkmcnt(8)
MAV 72,40,144
buffer_load_dwordx4 v[200:203], v4, s[16:19], s52 offen sc1
v_add_u32 v19, 1024, v18
MAV 72,56,152
TR 8,6,64
v_add_u32 v20, 2048, v18
s_mul_i32 s59, s3, 3104
MAV 88,56,156
TR 10,6,576
TR 12,6,96
MAV 88,40,148
TR 14,6,608
s_mov_b32 s58, 0
v_accvgpr_read_b32 v28, a224
MAV 92,44,148
buffer_load_dwordx4 v[204:207], v4, s[16:19], s52 offen offset:1024 sc1
v_add_f32 v32, v32, v28
MAV 92,60,156
TR 24,6,8512
TR 26,6,9024
MAV 76,60,152
TR 28,6,8544
v_accvgpr_read_b32 v29, a225
v_add_f32 v33, v33, v29
MAV 76,44,144
TR 30,6,9056
v_accvgpr_read_b32 v28, a226
s_waitcnt vmcnt(8) lgkmcnt(8)
MAV 64,0,160
TR 32,6,16896
s_add_u32 s52, s78, 737280
v_add_f32 v34, v34, v28
MAV 64,16,168
buffer_load_dwordx4 v[208:211], v4, s[16:19], s52 offen sc1
v_accvgpr_read_b32 v29, a227
MAV 80,16,172
TR 34,6,17408
TR 36,6,16928
MAV 80,0,164
TR 38,6,17440
v_add_f32 v35, v35, v29
v_accvgpr_read_b32 v28, a228
MAV 84,4,164
buffer_load_dwordx4 v[212:215], v4, s[16:19], s52 offen offset:1024 sc1
v_add_f32 v36, v36, v28
MAV 84,20,172
TR 48,6,25344
TR 50,6,25856
MAV 68,20,168
TR 52,6,25376
v_accvgpr_read_b32 v29, a229
v_add_f32 v37, v37, v29
MAV 68,4,160
TR 54,6,25888
s_add_u32 s52, s79, 851968
s_waitcnt lgkmcnt(8)
MAV 72,8,160
buffer_load_dwordx4 v[216:219], v4, s[16:19], s52 offen sc1
v_accvgpr_read_b32 v28, a230
MAV 72,24,168
TR 40,6,16960
v_add_f32 v38, v38, v28
v_accvgpr_read_b32 v29, a231
MAV 88,24,172
TR 42,6,17472
TR 44,6,16992
MAV 88,8,164
TR 46,6,17504
v_add_f32 v39, v39, v29
v_accvgpr_read_b32 v28, a232
MAV 92,12,164
buffer_load_dwordx4 v[220:223], v4, s[16:19], s52 offen offset:1024 sc1
v_add_f32 v40, v40, v28
MAV 92,28,172
TR 56,6,25408
TR 58,6,25920
MAV 76,28,168
TR 60,6,25440
v_accvgpr_read_b32 v29, a233
v_add_f32 v41, v41, v29
MAV 76,12,160
TR 62,6,25952
v_accvgpr_read_b32 v28, a234
s_waitcnt vmcnt(8) lgkmcnt(8)
MAV 64,32,176
TR 0,6,33792
v_add_f32 v42, v42, v28
v_accvgpr_read_b32 v29, a235
MAV 64,48,184
TR 2,6,34304
v_add_f32 v43, v43, v29
MAV 80,48,188
TR 4,6,33824
v_accvgpr_read_b32 v28, a236
MAV 80,32,180
TR 6,6,34336
v_add_f32 v44, v44, v28
MAV 84,36,180
TR 16,6,42240
v_accvgpr_read_b32 v29, a237
MAV 84,52,188
TR 18,6,42752
v_add_f32 v45, v45, v29
MAV 68,52,184
TR 20,6,42272
v_accvgpr_read_b32 v28, a238
MAV 68,36,176
TR 22,6,42784
s_waitcnt lgkmcnt(8)
MAV 72,40,176
TR 8,6,33856
v_add_f32 v46, v46, v28
MAV 72,56,184
TR 10,6,34368
v_accvgpr_read_b32 v29, a239
MAV 88,56,188
TR 12,6,33888
v_add_f32 v47, v47, v29
MAV 88,40,180
TR 14,6,34400
v_accvgpr_read_b32 v28, a240
MAV 92,44,180
TR 24,6,42304
v_add_f32 v48, v48, v28
MAV 92,60,188
TR 26,6,42816
v_accvgpr_read_b32 v29, a241
MAV 76,60,184
TR 28,6,42336
v_add_f32 v49, v49, v29
MAV 76,44,176
TR 30,6,42848
v_accvgpr_read_b32 v28, a242
s_waitcnt vmcnt(4) lgkmcnt(8)
MAV 64,0,192
TR 32,6,50688
v_add_f32 v50, v50, v28
v_accvgpr_read_b32 v29, a243
MAV 64,16,200
TR 34,6,51200
v_add_f32 v51, v51, v29
MAV 80,16,204
TR 36,6,50720
v_accvgpr_read_b32 v28, a244
MAV 80,0,196
TR 38,6,51232
v_add_f32 v52, v52, v28
MAV 84,4,196
TR 48,6,59136
v_accvgpr_read_b32 v29, a245
MAV 84,20,204
TR 50,6,59648
v_add_f32 v53, v53, v29
MAV 68,20,200
TR 52,6,59168
v_accvgpr_read_b32 v28, a246
MAV 68,4,192
TR 54,6,59680
s_waitcnt lgkmcnt(8)
MAV 72,8,192
TR 40,6,50752
v_add_f32 v54, v54, v28
MAV 72,24,200
TR 42,6,51264
v_accvgpr_read_b32 v29, a247
MAV 88,24,204
TR 44,6,50784
v_add_f32 v55, v55, v29
MAV 88,8,196
TR 46,6,51296
v_accvgpr_read_b32 v28, a248
MAV 92,12,196
TR 56,6,59200
v_add_f32 v56, v56, v28
MAV 92,28,204
TR 58,6,59712
v_accvgpr_read_b32 v29, a249
MAV 76,28,200
TR 60,6,59232
v_add_f32 v57, v57, v29
MAV 76,12,192
TR 62,6,59744
v_accvgpr_read_b32 v28, a250
s_waitcnt vmcnt(0) lgkmcnt(8)
MAV 64,32,208
ds_read_b64_tr_b16 a[0:1], v7
v_add_f32 v58, v58, v28
MAV 64,48,216
TR 2,7,512
v_accvgpr_read_b32 v29, a251
MAV 80,48,220
TR 4,7,32
v_add_f32 v59, v59, v29
MAV 80,32,212
TR 6,7,544
MAV 84,36,212
TR 16,7,8448
v_accvgpr_read_b32 v28, a252
MAV 84,52,220
TR 18,7,8960
v_add_f32 v60, v60, v28
MAV 68,52,216
TR 20,7,8480
v_accvgpr_read_b32 v29, a253
MAV 68,36,208
TR 22,7,8992
s_waitcnt lgkmcnt(8)
MAV 72,40,208
TR 8,7,64
MAV 72,56,216
TR 10,7,576
v_add_f32 v61, v61, v29
MAV 88,56,220
TR 12,7,96
v_accvgpr_read_b32 v28, a254
MAV 88,40,212
TR 14,7,608
v_add_f32 v62, v62, v28
MAV 92,44,212
TR 24,7,8512
MAV 92,60,220
TR 26,7,9024
v_accvgpr_read_b32 v29, a255
MAV 76,60,216
TR 28,7,8544
v_add_f32 v63, v63, v29
MAV 76,44,208
TR 30,7,9056
s_waitcnt lgkmcnt(8)
MAV 32,0,96
TR 32,7,16896
v_cvt_pk_bf16_f32 v232, v64, v65
v_cvt_pk_bf16_f32 v233, v66, v67
MAV 32,16,104
TR 34,7,17408
v_cvt_pk_bf16_f32 v234, v68, v69
MAV 48,16,108
TR 36,7,16928
v_cvt_pk_bf16_f32 v235, v70, v71
buffer_store_dwordx4 v[232:235], v11, s[16:19], s69 offen sc1
MAV 48,0,100
TR 38,7,17440
s_add_u32 s69, s69, 16384
MAV 52,4,100
TR 48,7,25344
v_cvt_pk_bf16_f32 v236, v72, v73
v_cvt_pk_bf16_f32 v237, v74, v75
MAV 52,20,108
TR 50,7,25856
v_cvt_pk_bf16_f32 v238, v76, v77
MAV 36,20,104
TR 52,7,25376
v_cvt_pk_bf16_f32 v239, v78, v79
buffer_store_dwordx4 v[236:239], v11, s[16:19], s69 offen sc1
MAV 36,4,96
TR 54,7,25888
s_add_u32 s69, s69, -15360
s_waitcnt lgkmcnt(8)
MAV 40,8,96
TR 40,7,16960
v_cvt_pk_bf16_f32 v240, v80, v81
MAV 40,24,104
TR 42,7,17472
v_cvt_pk_bf16_f32 v241, v82, v83
v_cvt_pk_bf16_f32 v242, v84, v85
MAV 56,24,108
TR 44,7,16992
v_cvt_pk_bf16_f32 v243, v86, v87
MAV 56,8,100
TR 46,7,17504
buffer_store_dwordx4 v[240:243], v11, s[16:19], s69 offen sc1
s_add_u32 s69, s69, 16384
MAV 60,12,100
TR 56,7,25408
v_cvt_pk_bf16_f32 v244, v88, v89
MAV 60,28,108
TR 58,7,25920
v_cvt_pk_bf16_f32 v245, v90, v91
v_cvt_pk_bf16_f32 v246, v92, v93
MAV 44,28,104
TR 60,7,25440
v_cvt_pk_bf16_f32 v247, v94, v95
MAV 44,12,96
TR 62,7,25952
buffer_store_dwordx4 v[244:247], v11, s[16:19], s69 offen sc1
s_waitcnt lgkmcnt(8)
MAV 32,32,112
TR 0,7,33792
MAV 32,48,120
TR 2,7,34304
MAV 48,48,124
TR 4,7,33824
MAV 48,32,116
TR 6,7,34336
MAV 52,36,116
TR 16,7,42240
MAV 52,52,124
TR 18,7,42752
MAV 36,52,120
TR 20,7,42272
MAV 36,36,112
TR 22,7,42784
s_waitcnt lgkmcnt(8)
MAV 40,40,112
TR 8,7,33856
MAV 40,56,120
TR 10,7,34368
MAV 56,56,124
TR 12,7,33888
MAV 56,40,116
TR 14,7,34400
MAV 60,44,116
TR 24,7,42304
MAV 60,60,124
TR 26,7,42816
MAV 44,60,120
TR 28,7,42336
MAV 44,44,112
TR 30,7,42848
s_waitcnt lgkmcnt(8)
MAV 32,0,128
TR 32,7,50688
MAV 32,16,136
TR 34,7,51200
MAV 48,16,140
TR 36,7,50720
MAV 48,0,132
TR 38,7,51232
MAV 52,4,132
TR 48,7,59136
MAV 52,20,140
TR 50,7,59648
MAV 36,20,136
TR 52,7,59168
MAV 36,4,128
TR 54,7,59680
s_waitcnt lgkmcnt(8)
MAV 40,8,128
TR 40,7,50752
MAV 40,24,136
TR 42,7,51264
MAV 56,24,140
TR 44,7,50784
MAV 56,8,132
TR 46,7,51296
MAV 60,12,132
TR 56,7,59200
MAV 60,28,140
TR 58,7,59712
MAV 44,28,136
TR 60,7,59232
MAV 44,12,128
TR 62,7,59744
v_add_u32 v7, s57, v7
s_waitcnt lgkmcnt(8)
MAV 32,32,144
ds_read_b64_tr_b16 a[0:1], v7
TR 2,7,512
MAV 32,48,152
s_waitcnt vmcnt(0)
buffer_atomic_add v13, v12, s[16:19], s71 offen
MAV 48,48,156
TR 4,7,32
MAV 48,32,148
TR 6,7,544
MAV 52,36,148
TR 16,7,8448
MAV 52,52,156
TR 18,7,8960
MAV 36,52,152
TR 20,7,8480
MAV 36,36,144
TR 22,7,8992
s_waitcnt lgkmcnt(8)
MAV 40,40,144
TR 8,7,64
MAV 40,56,152
TR 10,7,576
MAV 56,56,156
TR 12,7,96
MAV 56,40,148
TR 14,7,608
MAV 60,44,148
TR 24,7,8512
MAV 60,60,156
TR 26,7,9024
MAV 44,60,152
TR 28,7,8544
MAV 44,44,144
TR 30,7,9056
s_waitcnt lgkmcnt(8)
s_barrier
MAV 32,0,160
TR 32,7,16896
TR 34,7,17408
MAV 32,16,168
buffer_atomic_add v15, v12, s[16:19], s70 offen sc0
MAV 48,16,172
TR 36,7,16928
TR 38,7,17440
MAV 48,0,164
TR 48,7,25344
s_add_u32 m0, s59, 117248
MAV 52,4,164
buffer_load_dwordx4 v18, s[20:23], s58 offen lds
.Lpad11:
s_cbranch_execz .Lnopoll36r
MAV 52,20,172
TR 50,7,25856
TR 52,7,25376
MAV 36,20,168
TR 54,7,25888
MAV 36,4,160
TR 40,7,16960
s_waitcnt lgkmcnt(9)
MAV 40,8,160
buffer_load_dwordx4 v19, s[20:23], s58 offen offset:1024 lds
MAV 40,24,168
TR 42,7,17472
TR 44,7,16992
MAV 56,24,172
buffer_load_dwordx4 v20, s[20:23], s58 offen offset:2048 lds
MAV 56,8,164
TR 46,7,17504
s_add_u32 s58, s58, 196608
MAV 60,12,164
TR 56,7,25408
s_add_u32 m0, s59, 129664
MAV 60,28,172
buffer_load_dwordx4 v18, s[20:23], s58 offen lds
MAV 44,28,168
TR 58,7,25920
TR 60,7,25440
MAV 44,12,160
TR 62,7,25952
s_waitcnt lgkmcnt(8)
MAV 32,32,176
TR 0,7,33792
TR 2,7,34304
MAV 32,48,184
buffer_load_dwordx4 v19, s[20:23], s58 offen offset:1024 lds
MAV 48,48,188
TR 4,7,33824
MAV 48,32,180
TR 6,7,34336
TR 16,7,42240
MAV 52,36,180
buffer_load_dwordx4 v20, s[20:23], s58 offen offset:2048 lds
MAV 52,52,188
TR 18,7,42752
s_add_u32 s58, s58, 196608
MAV 36,52,184
TR 20,7,42272
MAV 36,36,176
TR 22,7,42784
s_add_u32 m0, s59, 67584
s_waitcnt lgkmcnt(8)
MAV 40,40,176
buffer_load_dwordx4 v18, s[20:23], s58 offen lds
MAV 40,56,184
TR 8,7,33856
MAV 56,56,188
TR 10,7,34368
TR 12,7,33888
MAV 56,40,180
TR 14,7,34400
MAV 60,44,180
buffer_load_dwordx4 v19, s[20:23], s58 offen offset:1024 lds
MAV 60,60,188
TR 24,7,42304
TR 26,7,42816
MAV 44,60,184
TR 28,7,42336
MAV 44,44,176
TR 30,7,42848
s_waitcnt vmcnt(8)
v_cmp_ne_u32 vcc, 0, v15
s_nop 0
s_cbranch_vccz .Lxs50
.Lxs50b:
s_waitcnt lgkmcnt(8)
MAV 32,0,192
TR 32,7,50688
TR 34,7,51200
MAV 32,16,200
TR 36,7,50720
buffer_load_dwordx4 v[232:235], v11, s[16:19], s68 offen sc1
MAV 48,16,204
TR 38,7,51232
s_add_u32 s68, s68, 16384
MAV 48,0,196
TR 48,7,59136
buffer_load_dwordx4 v[236:239], v11, s[16:19], s68 offen sc1
MAV 52,4,196
TR 50,7,59648
s_add_u32 s68, s68, -15360
MAV 52,20,204
TR 52,7,59168
buffer_load_dwordx4 v[240:243], v11, s[16:19], s68 offen sc1
MAV 36,20,200
TR 54,7,59680
s_add_u32 s68, s68, 16384
MAV 36,4,192
buffer_load_dwordx4 v[244:247], v11, s[16:19], s68 offen sc1
s_waitcnt lgkmcnt(8)
MAV 40,8,192
TR 40,7,50752
buffer_load_dwordx4 v20, s[20:23], s58 offen offset:2048 lds
MAV 40,24,200
TR 42,7,51264
s_add_u32 s58, s58, 196608
s_add_u32 m0, s59, 80000
MAV 56,24,204
TR 44,7,50784
buffer_load_dwordx4 v18, s[20:23], s58 offen lds
MAV 56,8,196
TR 46,7,51296
MAV 60,12,196
TR 56,7,59200
buffer_load_dwordx4 v19, s[20:23], s58 offen offset:1024 lds
MAV 60,28,204
TR 58,7,59712
MAV 44,28,200
TR 60,7,59232
buffer_load_dwordx4 v20, s[20:23], s58 offen offset:2048 lds
MAV 44,12,192
TR 62,7,59744
s_add_u32 s58, s58, 196608
s_waitcnt lgkmcnt(8)
MAV 32,32,208
s_add_u32 m0, s59, 92416
MAV 32,48,216
buffer_load_dwordx4 v18, s[20:23], s58 offen lds
MAV 48,48,220
MAV 48,32,212
MAV 52,36,212
MAV 52,52,220
MAV 36,52,216
buffer_load_dwordx4 v19, s[20:23], s58 offen offset:1024 lds
MAV 36,36,208
s_waitcnt lgkmcnt(0)
MAV 40,40,208
MAV 40,56,216
MAV 56,56,220
MAV 56,40,212
buffer_load_dwordx4 v20, s[20:23], s58 offen offset:2048 lds
MAV 60,44,212
s_add_u32 s58, s58, 196608
MAV 60,60,220
MAV 44,60,216
MAV 44,44,208
s_waitcnt vmcnt(10)
v_mfma_f32_16x16x32_bf16 v[32:35], v[226:229], v[232:235], v[32:35]
s_lshl_b32 s64, s6, 14
s_lshl_b32 s65, s49, 13
s_add_u32 s64, s64, s65
v_mfma_f32_16x16x32_bf16 v[36:39], v[224:227], v[232:235], v[36:39]
s_lshl_b32 s65, s7, 9
s_add_u32 s64, s64, s65
s_lshl_b32 s65, s48, 8
s_waitcnt vmcnt(9)
v_mfma_f32_16x16x32_bf16 v[40:43], v[226:229], v[236:239], v[40:43]
s_add_u32 s64, s64, s65
s_add_u32 s64, s64, 62914560
v_and_b32 v152, 31, v1
v_mfma_f32_16x16x32_bf16 v[44:47], v[224:227], v[236:239], v[44:47]
s_lshl_b32 s62, s7, 15
v_lshlrev_b32 v152, 3, v152
v_lshrrev_b32 v153, 5, v1
s_waitcnt vmcnt(8)
v_mfma_f32_16x16x32_bf16 v[48:51], v[226:229], v[240:243], v[48:51]
s_add_u32 s62, s62, 33554432
v_lshl_add_u32 v152, v153, 28, v152
s_add_u32 s63, s62, 16384
v_mfma_f32_16x16x32_bf16 v[52:55], v[224:227], v[240:243], v[52:55]
v_cvt_pk_bf16_f32 v128, v32, v33
v_cvt_pk_bf16_f32 v129, v34, v35
s_waitcnt vmcnt(7)
v_mfma_f32_16x16x32_bf16 v[56:59], v[226:229], v[244:247], v[56:59]
v_cvt_pk_bf16_f32 v130, v36, v37
v_cvt_pk_bf16_f32 v131, v38, v39
v_mfma_f32_16x16x32_bf16 v[60:63], v[224:227], v[244:247], v[60:63]
buffer_store_dwordx4 v[128:131], v4, s[16:19], s62 offen sc1
v_cvt_pk_bf16_f32 v132, v40, v41
v_cvt_pk_bf16_f32 v133, v42, v43
v_cvt_pk_bf16_f32 v134, v44, v45
v_cvt_pk_bf16_f32 v135, v46, v47
v_cvt_pk_bf16_f32 v136, v48, v49
v_cvt_pk_bf16_f32 v137, v50, v51
v_cvt_pk_bf16_f32 v138, v52, v53
v_cvt_pk_bf16_f32 v139, v54, v55
v_cvt_pk_bf16_f32 v140, v56, v57
v_cvt_pk_bf16_f32 v141, v58, v59
v_cvt_pk_bf16_f32 v142, v60, v61
v_cvt_pk_bf16_f32 v143, v62, v63
v_pk_mul_f32 v[146:147], v[32:33], v[32:33]
buffer_store_dwordx4 v[132:135], v4, s[16:19], s63 offen sc1
v_pk_mul_f32 v[150:151], v[48:49], v[48:49]
v_pk_fma_f32 v[146:147], v[34:35], v[34:35], v[146:147]
v_pk_add_f32 v[144:145], v[32:33], v[34:35]
v_pk_fma_f32 v[150:151], v[50:51], v[50:51], v[150:151]
v_pk_add_f32 v[148:149], v[48:49], v[50:51]
v_pk_fma_f32 v[146:147], v[36:37], v[36:37], v[146:147]
v_pk_add_f32 v[144:145], v[144:145], v[36:37]
v_pk_fma_f32 v[150:151], v[52:53], v[52:53], v[150:151]
v_pk_add_f32 v[148:149], v[148:149], v[52:53]
v_pk_fma_f32 v[146:147], v[38:39], v[38:39], v[146:147]
v_pk_add_f32 v[144:145], v[144:145], v[38:39]
v_pk_fma_f32 v[150:151], v[54:55], v[54:55], v[150:151]
v_pk_add_f32 v[148:149], v[148:149], v[54:55]
buffer_store_dwordx4 v[136:139], v4, s[16:19], s62 offen offset:1024 sc1
v_pk_fma_f32 v[146:147], v[40:41], v[40:41], v[146:147]
v_pk_add_f32 v[144:145], v[144:145], v[40:41]
v_pk_fma_f32 v[150:151], v[56:57], v[56:57], v[150:151]
v_pk_add_f32 v[148:149], v[148:149], v[56:57]
v_pk_fma_f32 v[146:147], v[42:43], v[42:43], v[146:147]
v_pk_add_f32 v[144:145], v[144:145], v[42:43]
v_pk_fma_f32 v[150:151], v[58:59], v[58:59], v[150:151]
v_pk_add_f32 v[148:149], v[148:149], v[58:59]
v_pk_fma_f32 v[146:147], v[44:45], v[44:45], v[146:147]
v_pk_add_f32 v[144:145], v[144:145], v[44:45]
v_pk_fma_f32 v[150:151], v[60:61], v[60:61], v[150:151]
v_pk_add_f32 v[148:149], v[148:149], v[60:61]
v_pk_fma_f32 v[146:147], v[46:47], v[46:47], v[146:147]
buffer_store_dwordx4 v[140:143], v4, s[16:19], s63 offen offset:1024 sc1
v_pk_add_f32 v[144:145], v[144:145], v[46:47]
v_pk_fma_f32 v[150:151], v[62:63], v[62:63], v[150:151]
v_pk_add_f32 v[148:149], v[148:149], v[62:63]
v_add_f32 v144, v144, v145
v_add_f32 v146, v146, v147
v_add_f32 v148, v148, v149
v_add_f32 v150, v150, v151
s_nop 0
v_permlane16_swap_b32 v144, v148
v_permlane16_swap_b32 v146, v150
v_add_f32 v144, v144, v148
v_add_f32 v146, v146, v150
s_nop 1
v_permlane32_swap_b32 v144, v146
v_add_f32 v144, v144, v146
s_nop 1
v_permlane32_swap_b32 v144, v145
buffer_store_dwordx2 v[144:145], v152, s[16:19], s64 offen sc1
s_nop 1
v_accvgpr_write_b32 a224, v32
v_accvgpr_write_b32 a225, v33
v_accvgpr_write_b32 a226, v34
v_accvgpr_write_b32 a227, v35
v_accvgpr_write_b32 a228, v36
v_accvgpr_write_b32 a229, v37
v_accvgpr_write_b32 a230, v38
v_accvgpr_write_b32 a231, v39
v_accvgpr_write_b32 a232, v40
v_accvgpr_write_b32 a233, v41
v_accvgpr_write_b32 a234, v42
v_accvgpr_write_b32 a235, v43
v_accvgpr_write_b32 a236, v44
v_accvgpr_write_b32 a237, v45
v_accvgpr_write_b32 a238, v46
v_accvgpr_write_b32 a239, v47
v_accvgpr_write_b32 a240, v48
v_accvgpr_write_b32 a241, v49
v_accvgpr_write_b32 a242, v50
v_accvgpr_write_b32 a243, v51
v_accvgpr_write_b32 a244, v52
v_accvgpr_write_b32 a245, v53
v_accvgpr_write_b32 a246, v54
v_accvgpr_write_b32 a247, v55
v_accvgpr_write_b32 a248, v56
v_accvgpr_write_b32 a249, v57
v_accvgpr_write_b32 a250, v58
v_accvgpr_write_b32 a251, v59
v_accvgpr_write_b32 a252, v60
v_accvgpr_write_b32 a253, v61
v_accvgpr_write_b32 a254, v62
v_accvgpr_write_b32 a255, v63
s_lshl_b32 s62, s3, 11
s_add_u32 s62, s62, s85
v_lshl_add_u32 v21, v1, 4, s62
v_lshrrev_b32 v2, 3, v1
v_cmp_eq_u32 vcc, 3, v2
v_add_u32 v2, 67108480, v21
s_nop 0
v_cndmask_b32 v21, v21, v2, vcc
s_sub_u32 s62, s86, 2048
v_lshl_add_u32 v22, v0, 2, s62
v_lshrrev_b32 v2, 5, v0
v_cmp_eq_u32 vcc, 3, v2
v_add_u32 v2, 67108480, v22
s_nop 0
v_cndmask_b32 v22, v22, v2, vcc
s_mul_i32 s62, s48, 4608
v_lshl_add_u32 v23, v1, 4, s62
v_lshrrev_b32 v24, 4, v1
v_mul_u32_u24 v24, 2304, v24
v_and_b32 v2, 15, v1
v_lshl_add_u32 v24, v2, 4, v24
s_mov_b32 s52, 33554432
s_mov_b32 s54, s58
s_mov_b32 s56, s59
s_mul_i32 s55, s3, 2304
v_bfe_u32 v25, v1, 3, 2
v_mul_u32_u24 v25, 3104, v25
v_bfe_u32 v2, v1, 2, 1
v_lshl_add_u32 v25, v2, 7, v25
v_bfe_u32 v2, v1, 5, 1
v_lshl_add_u32 v25, v2, 8, v25
v_and_b32 v2, 3, v1
v_lshl_add_u32 v25, v2, 3, v25
s_lshl_b32 s62, s49, 6
s_add_u32 s62, s62, 67584
v_add_u32 v25, s62, v25
s_lshl_b32 s62, s8, 1
s_add_u32 s62, s62, s3
s_lshr_b32 s63, s50, 2
s_cmp_lt_u32 s3, 2
s_cselect_b32 s62, s62, s63
s_lshl_b32 s62, s62, 13
s_cmp_eq_u32 s3, 3
s_cselect_b32 s62, 268435456, s62
v_lshl_add_u32 v26, v1, 4, s62
s_lshr_b32 s63, s20, 7
s_sub_u32 s63, 3, s63
s_and_b32 s63, s63, 7
s_and_b32 s62, s9, 8
s_add_u32 s63, s63, s62
s_lshl_b32 s62, s5, 2
s_add_u32 s62, s62, s3
s_mul_i32 s62, s62, 12288
s_lshl_b32 s64, s63, 7
s_add_u32 s62, s62, s64
s_xor_b32 s63, s63, s9
s_cmp_lt_u32 s63, 4
s_cselect_b32 s62, s62, 16777216
v_lshrrev_b32 v14, 3, v1
v_min_u32 v14, 5, v14
v_lshl_add_u32 v14, v14, 11, s62
s_mov_b32 s44, 983040
buffer_load_dword v27, v14, s[20:23], s44 offen
s_mov_b32 s44, 2555904
s_mul_i32 s59, s3, 2080
v_bfe_u32 v5, v1, 3, 1
v_lshrrev_b32 v2, 4, v1
v_lshl_add_u32 v5, v2, 3, v5
s_lshl_b32 s62, s3, 1
v_add_u32 v5, s62, v5
v_mul_u32_u24 v5, 2048, v5
v_and_b32 v2, 7, v1
v_lshl_add_u32 v5, v2, 4, v5
s_lshl_b32 s62, s7, 7
v_add_u32 v5, s62, v5
v_add_u32 v6, 64512, v5
s_lshl_b32 s62, s6, 10
s_add_u32 s62, s62, 30474240
s_lshl_b32 s64, s8, 10
s_add_u32 s64, s64, 30474240
s_lshr_b32 s67, s9, 1
s_and_b32 s67, s67, 3
s_lshl_b32 s67, s67, 7
s_add_u32 s64, s64, s67
s_lshr_b32 s65, s50, 3
s_lshl_b32 s65, s65, 10
s_add_u32 s65, s65, 30474240
s_lshr_b32 s67, s9, 1
s_and_b32 s67, s67, 3
s_lshl_b32 s67, s67, 7
s_add_u32 s65, s65, s67
v_lshl_add_u32 v252, v1, 7, s62
v_mov_b32 v253, s64
v_mov_b32 v255, 1
v_writelane_b32 v253, s65, 1
s_waitcnt vmcnt(1) lgkmcnt(0)
s_cmp_lg_u32 s3, 1
s_barrier
s_cbranch_scc1 .Lfirst53
s_mov_b64 exec, 15
buffer_atomic_add v255, v252, s[16:19], 0 offen
s_mov_b64 exec, 3
v_mov_b32 v254, 0
buffer_atomic_add v254, v253, s[16:19], 0 offen sc0
s_mov_b64 exec, -1
.Lfirst53:
TR 20,25,49664
TR 22,25,50176
TR 24,25,49696
TR 26,25,50208
TR 28,25,50688
TR 30,25,51200
TR 32,25,50720
TR 34,25,51232
TR 36,25,51712
TR 38,25,52224
TR 40,25,51744
TR 42,25,52256
v_lshrrev_b32 v2, 4, v1
v_lshlrev_b32 v2, 2, v2
v_and_b32 v13, 15, v1
v_sub_u32 v2, v13, v2
v_mov_b32 v13, 0xff61b1e6
v_subrev_u32 v54, 0, v2
v_cmp_gt_u32 vcc, 8, v54
s_nop 1
v_cndmask_b32 v50, v13, 0, vcc
v_cmp_gt_i32 vcc, -8, v54
s_nop 1
v_cndmask_b32 v46, v13, 0, vcc
v_subrev_u32 v54, 1, v2
v_cmp_gt_u32 vcc, 8, v54
s_nop 1
v_cndmask_b32 v51, v13, 0, vcc
v_cmp_gt_i32 vcc, -8, v54
s_nop 1
v_cndmask_b32 v47, v13, 0, vcc
v_subrev_u32 v54, 2, v2
v_cmp_gt_u32 vcc, 8, v54
s_nop 1
v_cndmask_b32 v52, v13, 0, vcc
v_cmp_gt_i32 vcc, -8, v54
s_nop 1
v_cndmask_b32 v48, v13, 0, vcc
v_subrev_u32 v54, 3, v2
v_cmp_gt_u32 vcc, 8, v54
s_nop 1
v_cndmask_b32 v53, v13, 0, vcc
v_cmp_gt_i32 vcc, -8, v54
s_nop 1
v_cndmask_b32 v49, v13, 0, vcc
s_cmp_lt_u32 s8, 2
s_cselect_b64 vcc, -1, 0
v_cndmask_b32 v54, v46, v13, vcc
v_cndmask_b32 v55, v47, v13, vcc
v_cndmask_b32 v56, v48, v13, vcc
v_cndmask_b32 v57, v49, v13, vcc
v_mov_b64 v[60:61], 0
v_mov_b64 v[62:63], 0
v_mov_b64 v[64:65], 0
v_mov_b64 v[66:67], 0
v_mov_b64 v[68:69], 0
v_mov_b64 v[70:71], 0
v_mov_b64 v[72:73], 0
v_mov_b64 v[74:75], 0
v_mov_b64 v[76:77], 0
v_mov_b64 v[78:79], 0
v_mov_b64 v[80:81], 0
v_mov_b64 v[82:83], 0
v_mov_b64 v[84:85], 0
v_mov_b64 v[86:87], 0
v_mov_b64 v[88:89], 0
v_mov_b64 v[90:91], 0
v_mov_b64 v[92:93], 0
v_mov_b64 v[94:95], 0
v_mov_b64 v[96:97], 0
v_mov_b64 v[98:99], 0
v_mov_b64 v[100:101], 0
v_mov_b64 v[102:103], 0
v_mov_b64 v[104:105], 0
v_mov_b64 v[106:107], 0
v_mov_b64 v[108:109], 0
v_mov_b64 v[110:111], 0
v_mov_b64 v[112:113], 0
v_mov_b64 v[114:115], 0
v_mov_b64 v[116:117], 0
v_mov_b64 v[118:119], 0
v_mov_b64 v[120:121], 0
v_mov_b64 v[122:123], 0
v_mov_b64 v[124:125], 0
v_mov_b64 v[126:127], 0
v_mov_b64 v[128:129], 0
v_mov_b64 v[130:131], 0
v_mov_b64 v[132:133], 0
v_mov_b64 v[134:135], 0
v_mov_b64 v[136:137], 0
v_mov_b64 v[138:139], 0
v_mov_b64 v[140:141], 0
v_mov_b64 v[142:143], 0
v_mov_b64 v[144:145], 0
v_mov_b64 v[146:147], 0
v_mov_b64 v[148:149], 0
v_mov_b64 v[150:151], 0
v_mov_b64 v[152:153], 0
v_mov_b64 v[154:155], 0
v_mov_b64 v[156:157], 0
v_mov_b64 v[158:159], 0
v_mov_b64 v[160:161], 0
v_mov_b64 v[162:163], 0
v_mov_b64 v[164:165], 0
v_mov_b64 v[166:167], 0
v_mov_b64 v[168:169], 0
v_mov_b64 v[170:171], 0
v_mov_b64 v[172:173], 0
v_mov_b64 v[174:175], 0
s_mov_b32 s75, 62914560
v_and_b32 v10, 15, v1
v_lshlrev_b32 v12, 2, v10
v_lshlrev_b32 v10, 4, v10
v_add_u32 v10, 152576, v10
v_lshrrev_b32 v11, 4, v1
v_lshlrev_b32 v11, 4, v11
s_lshl_b32 s62, s49, 7
s_add_u32 s62, s62, 158720
v_add_u32 v12, s62, v12
v_add_u32 v13, s62, v11
v_add_u32 v11, 156672, v11
s_lshl_b32 s62, s3, 11
s_add_u32 s62, s62, 143360
v_lshl_add_u32 v8, v1, 4, s62
v_xor_b32 v9, 2048, v8
v_mov_b32 v248, 0x3f803f80
v_mov_b32 v249, 0x3f803f80
v_mov_b32 v250, 0x3f803f80
v_mov_b32 v251, 0x3f803f80
v_and_b32 v7, 31, v1
v_lshrrev_b32 v2, 5, v1
v_lshl_add_u32 v7, v7, 1, v2
v_and_b32 v2, 0xc0, v0
v_add_u32 v7, v7, v2
v_lshlrev_b32 v17, 2, v7
v_add_u32 v17, 156672, v17
v_lshlrev_b32 v7, 4, v7
v_add_u32 v7, 152576, v7
s_lshl_b32 s74, s9, 1
s_add_u32 s74, s74, s49
s_lshl_b32 s74, s74, 14
s_add_u32 s74, s74, s85
s_lshl_b32 s63, s48, 12
s_add_u32 s74, s74, s63
s_add_u32 s74, s74, 37748736
s_mov_b32 s62, 0
v_lshl_add_u32 v4, v1, 4, s62
v_lshrrev_b32 v2, 3, v1
v_cmp_eq_u32 vcc, 3, v2
v_add_u32 v2, 67108480, v4
s_nop 0
v_cndmask_b32 v4, v4, v2, vcc
ds_read_b128 v[28:31], v13
ds_read_b128 v[32:35], v13 offset:64
ds_read_b128 v[36:39], v13 offset:256
ds_read_b128 v[40:43], v13 offset:320
ds_read_b32 v44, v12 offset:512
ds_read_b32 v45, v12 offset:576
s_waitcnt lgkmcnt(0)
s_cmp_lg_u32 s3, 1
s_cbranch_scc1 .Lnopoll52
s_mov_b64 exec, 3
s_mov_b32 s15, 0
.Lpoll51:
v_mov_b32 v255, 0
buffer_atomic_add v255, v253, s[16:19], 0 offen sc0
s_waitcnt vmcnt(1)
v_cmp_gt_u32 vcc, 16, v254
s_add_u32 s15, s15, 1
s_cbranch_vccz .Lnopoll52r
v_mov_b32 v254, 0
buffer_atomic_add v254, v253, s[16:19], 0 offen sc0
s_waitcnt vmcnt(1)
v_cmp_gt_u32 vcc, 16, v255
s_add_u32 s15, s15, 1
s_cbranch_vccz .Lnopoll52r
s_cmp_le_u32 s15, 100000
s_cbranch_scc1 .Lpoll51
s_branch .Lnopoll52r
.Lnopoll52:
s_mov_b64 exec, 0
s_cmp_eq_u32 s3, 2
s_cbranch_scc1 .Lpad12
s_cmp_eq_u32 s3, 3
s_cbranch_scc1 .Lpad13
s_branch .Lpad14
.Lnopoll52r:
s_mov_b64 exec, -1
s_barrier
s_cmp_eq_u32 s48, 1
s_cbranch_scc1 .Lqkv54
s_add_u32 m0, s55, 36864
s_nop 0
buffer_load_dwordx4 v21, s[16:19], s52 offen sc1 lds
buffer_load_dwordx4 v21, s[16:19], s52 offen offset:1024 sc1 lds
buffer_load_dword v22, s[16:19], s52 offen offset:2048 sc1 lds
s_add_u32 s52, s52, 16384
s_add_u32 m0, s55, 46080
s_nop 0
buffer_load_dwordx4 v21, s[16:19], s52 offen sc1 lds
buffer_load_dwordx4 v21, s[16:19], s52 offen offset:1024 sc1 lds
buffer_load_dword v22, s[16:19], s52 offen offset:2048 sc1 lds
s_add_u32 s52, s52, 16384
s_add_u32 m0, s55, 0
s_nop 0
buffer_load_dwordx4 v21, s[16:19], s52 offen sc1 lds
buffer_load_dwordx4 v21, s[16:19], s52 offen offset:1024 sc1 lds
buffer_load_dword v22, s[16:19], s52 offen offset:2048 sc1 lds
s_add_u32 s52, s52, 16384
s_add_u32 m0, s55, 9216
s_nop 0
buffer_load_dwordx4 v21, s[16:19], s52 offen sc1 lds
buffer_load_dwordx4 v21, s[16:19], s52 offen offset:1024 sc1 lds
buffer_load_dword v22, s[16:19], s52 offen offset:2048 sc1 lds
s_add_u32 s52, s52, 16384
s_add_u32 m0, s55, 18432
s_nop 0
buffer_load_dwordx4 v21, s[16:19], s52 offen sc1 lds
buffer_load_dwordx4 v21, s[16:19], s52 offen offset:1024 sc1 lds
buffer_load_dword v22, s[16:19], s52 offen offset:2048 sc1 lds
s_add_u32 s52, s52, 16384
s_waitcnt vmcnt(12)
s_barrier
RD 0,23,36864
RD 4,23,37888
RD 8,23,39168
RD 12,23,40192
RD 16,24,38912
s_waitcnt lgkmcnt(0)
s_mov_b32 s15, -4
.p2align 6
.Lk56:
s_waitcnt vmcnt(9) lgkmcnt(8)
s_barrier
MAA 60,20,0
RD 44,23,46080
s_add_u32 m0, s56, 104832
MAA 76,24,0
buffer_load_dwordx4 v18, s[20:23], s54 offen lds
MAA 80,24,4
RD 48,23,47104
v_add_f32 v164, v164, v168
MAA 64,20,4
RD 52,23,48384
MAA 68,20,8
buffer_load_dwordx4 v19, s[20:23], s54 offen offset:1024 lds
MAA 84,24,8
RD 56,23,49408
MAA 88,24,12
TR 64,25,62080
v_add_f32 v165, v165, v169
MAA 72,20,12
TR 66,25,62592
s_waitcnt lgkmcnt(6)
MAA 104,28,12
buffer_load_dwordx4 v20, s[20:23], s54 offen offset:2048 lds
MAA 120,32,12
TR 68,25,62112
s_add_u32 s54, s54, 196608
MAA 116,32,8
TR 70,25,62624
s_add_u32 m0, s55, 27648
MAA 100,28,8
buffer_load_dwordx4 v21, s[16:19], s52 offen sc1 lds
MAA 96,28,4
RD 60,24,48128
MAA 112,32,4
.Lpad12:
s_cbranch_execz .Lpad15
TR 72,25,63104
MAA 108,32,0
buffer_load_dwordx4 v21, s[16:19], s52 offen offset:1024 sc1 lds
MAA 92,28,0
TR 74,25,63616
v_add_f32 v166, v166, v170
MAA 156,28,16
TR 76,25,63136
MAA 160,32,16
TR 78,25,63648
MAA 124,0,36
buffer_load_dword v22, s[16:19], s52 offen offset:2048 sc1 lds
MAA 140,0,40
TR 80,25,64128
s_add_u32 s52, s52, 16384
MAA 144,4,40
TR 82,25,64640
v_add_f32 v167, v167, v171
MAA 128,4,36
buffer_load_dword v27, v14, s[20:23], s44 offen
MAA 132,8,36
TR 84,25,64160
s_add_u32 s44, s44, 1572864
MAA 148,8,40
TR 86,25,64672
MAA 152,12,40
MAA 136,12,36
s_waitcnt vmcnt(13) lgkmcnt(8)
s_barrier
MAA 60,64,44
ds_read_b128 a[0:3], v23
s_add_u32 m0, s56, 117248
MAA 76,68,44
buffer_load_dwordx4 v18, s[20:23], s54 offen lds
MAA 80,68,48
RD 4,23,1024
MAA 64,64,48
RD 8,23,2304
MAA 68,64,52
buffer_load_dwordx4 v19, s[20:23], s54 offen offset:1024 lds
MAA 84,68,52
RD 12,23,3328
MAA 88,68,56
ds_read_b64_tr_b16 a[20:21], v25
MAA 72,64,56
TR 22,25,512
s_waitcnt lgkmcnt(6)
MAA 104,72,56
buffer_load_dwordx4 v20, s[20:23], s54 offen offset:2048 lds
MAA 120,76,56
TR 24,25,32
s_add_u32 s54, s54, 196608
MAA 116,76,52
TR 26,25,544
s_add_u32 m0, s55, 36864
MAA 100,72,52
buffer_load_dwordx4 v21, s[16:19], s52 offen sc1 lds
MAA 96,72,48
RD 16,24,2048
MAA 112,76,48
TR 28,25,1024
MAA 108,76,44
buffer_load_dwordx4 v21, s[16:19], s52 offen offset:1024 sc1 lds
MAA 92,72,44
TR 30,25,1536
MAA 156,72,60
TR 32,25,1056
MAA 160,76,60
TR 34,25,1568
MAA 124,44,80
buffer_load_dword v22, s[16:19], s52 offen offset:2048 sc1 lds
MAA 140,44,84
TR 36,25,2048
s_add_u32 s52, s52, 16384
MAA 144,48,84
TR 38,25,2560
MAA 128,48,80
buffer_load_dwordx4 v[168:171], v26, s[16:19], s75 offen sc1
MAA 132,52,80
TR 40,25,2080
MAA 148,52,84
TR 42,25,2592
MAA 152,56,84
MAA 136,56,80
s_waitcnt vmcnt(17) lgkmcnt(8)
s_barrier
MAA 60,20,0
RD 44,23,9216
s_add_u32 m0, s56, 129664
MAA 76,24,0
buffer_load_dwordx4 v18, s[20:23], s54 offen lds
MAA 80,24,4
RD 48,23,10240
MAA 64,20,4
RD 52,23,11520
MAA 68,20,8
RD 56,23,12544
MAA 84,24,8
buffer_load_dwordx4 v19, s[20:23], s54 offen offset:1024 lds
MAA 88,24,12
TR 64,25,12416
MAA 72,20,12
TR 66,25,12928
s_waitcnt lgkmcnt(6)
MAA 104,28,12
TR 68,25,12448
MAA 120,32,12
buffer_load_dwordx4 v20, s[20:23], s54 offen offset:2048 lds
MAA 116,32,8
TR 70,25,12960
s_add_u32 s54, s54, 196608
MAA 100,28,8
RD 60,24,11264
MAA 96,28,4
s_add_u32 m0, s55, 46080
MAA 112,32,4
buffer_load_dwordx4 v21, s[16:19], s52 offen sc1 lds
MAA 108,32,0
TR 72,25,13440
MAA 92,28,0
TR 74,25,13952
MAA 156,28,16
TR 76,25,13472
MAA 160,32,16
buffer_load_dwordx4 v21, s[16:19], s52 offen offset:1024 sc1 lds
MAA 124,0,36
TR 78,25,13984
MAA 140,0,40
TR 80,25,14464
MAA 144,4,40
TR 82,25,14976
MAA 128,4,36
buffer_load_dword v22, s[16:19], s52 offen offset:2048 sc1 lds
MAA 132,8,36
TR 84,25,14496
s_add_u32 s52, s52, 16384
MAA 148,8,40
TR 86,25,15008
MAA 152,12,40
MAA 136,12,36
s_waitcnt vmcnt(20) lgkmcnt(8)
s_barrier
MAA 60,64,44
RD 0,23,18432
s_add_u32 m0, s56, 67584
MAA 76,68,44
buffer_load_dwordx4 v18, s[20:23], s54 offen lds
MAA 80,68,48
RD 4,23,19456
v_add_f32 v164, v164, v172
MAA 64,64,48
RD 8,23,20736
MAA 68,64,52
RD 12,23,21760
MAA 84,68,52
buffer_load_dwordx4 v19, s[20:23], s54 offen offset:1024 lds
MAA 88,68,56
TR 20,25,24832
MAA 72,64,56
TR 22,25,25344
s_waitcnt lgkmcnt(6)
MAA 104,72,56
TR 24,25,24864
v_add_f32 v165, v165, v173
MAA 120,76,56
buffer_load_dwordx4 v20, s[20:23], s54 offen offset:2048 lds
MAA 116,76,52
TR 26,25,25376
s_add_u32 s54, s54, 196608
MAA 100,72,52
RD 16,24,20480
MAA 96,72,48
s_add_u32 m0, s55, 0
MAA 112,76,48
buffer_load_dwordx4 v21, s[16:19], s52 offen sc1 lds
MAA 108,76,44
TR 28,25,25856
v_add_f32 v166, v166, v174
MAA 92,72,44
TR 30,25,26368
MAA 156,72,60
TR 32,25,25888
MAA 160,76,60
buffer_load_dwordx4 v21, s[16:19], s52 offen offset:1024 sc1 lds
MAA 124,44,80
TR 34,25,26400
MAA 140,44,84
TR 36,25,26880
v_add_f32 v167, v167, v175
MAA 144,48,84
TR 38,25,27392
MAA 128,48,80
buffer_load_dword v22, s[16:19], s52 offen offset:2048 sc1 lds
MAA 132,52,80
TR 40,25,26912
s_add_u32 s52, s52, 16384
MAA 148,52,84
TR 42,25,27424
MAA 152,56,84
MAA 136,56,80
s_waitcnt vmcnt(20) lgkmcnt(8)
s_barrier
MAA 60,20,0
RD 44,23,27648
s_add_u32 m0, s56, 80000
MAA 76,24,0
buffer_load_dwordx4 v18, s[20:23], s54 offen lds
MAA 80,24,4
RD 48,23,28672
MAA 64,20,4
RD 52,23,29952
MAA 68,20,8
buffer_load_dwordx4 v19, s[20:23], s54 offen offset:1024 lds
MAA 84,24,8
RD 56,23,30976
MAA 88,24,12
TR 64,25,37248
MAA 72,20,12
TR 66,25,37760
s_waitcnt lgkmcnt(6)
MAA 104,28,12
buffer_load_dwordx4 v20, s[20:23], s54 offen offset:2048 lds
MAA 120,32,12
TR 68,25,37280
s_add_u32 s54, s54, 196608
MAA 116,32,8
TR 70,25,37792
s_add_u32 m0, s55, 9216
MAA 100,28,8
buffer_load_dwordx4 v21, s[16:19], s52 offen sc1 lds
MAA 96,28,4
RD 60,24,29696
MAA 112,32,4
TR 72,25,38272
MAA 108,32,0
buffer_load_dwordx4 v21, s[16:19], s52 offen offset:1024 sc1 lds
MAA 92,28,0
TR 74,25,38784
MAA 156,28,16
TR 76,25,38304
MAA 160,32,16
TR 78,25,38816
MAA 124,0,36
buffer_load_dword v22, s[16:19], s52 offen offset:2048 sc1 lds
MAA 140,0,40
TR 80,25,39296
s_add_u32 s52, s52, 16384
MAA 144,4,40
TR 82,25,39808
MAA 128,4,36
buffer_load_dwordx4 v[172:175], v26, s[16:19], s75 offen offset:1024 sc1
MAA 132,8,36
TR 84,25,39328
s_add_u32 s75, s75, 2048
MAA 148,8,40
TR 86,25,39840
MAA 152,12,40
MAA 136,12,36
s_waitcnt vmcnt(20) lgkmcnt(8)
s_barrier
MAA 60,64,44
RD 0,23,36864
s_add_u32 m0, s56, 92416
MAA 76,68,44
buffer_load_dwordx4 v18, s[20:23], s54 offen lds
MAA 80,68,48
RD 4,23,37888
MAA 64,64,48
RD 8,23,39168
MAA 68,64,52
RD 12,23,40192
MAA 84,68,52
buffer_load_dwordx4 v19, s[20:23], s54 offen offset:1024 lds
MAA 88,68,56
TR 20,25,49664
MAA 72,64,56
TR 22,25,50176
s_waitcnt lgkmcnt(6)
MAA 104,72,56
TR 24,25,49696
MAA 120,76,56
buffer_load_dwordx4 v20, s[20:23], s54 offen offset:2048 lds
MAA 116,76,52
TR 26,25,50208
s_add_u32 s54, s54, 196608
MAA 100,72,52
RD 16,24,38912
MAA 96,72,48
s_add_u32 m0, s55, 18432
MAA 112,76,48
buffer_load_dwordx4 v21, s[16:19], s52 offen sc1 lds
MAA 108,76,44
TR 28,25,50688
MAA 92,72,44
TR 30,25,51200
MAA 156,72,60
TR 32,25,50720
MAA 160,76,60
buffer_load_dwordx4 v21, s[16:19], s52 offen offset:1024 sc1 lds
MAA 124,44,80
TR 34,25,51232
MAA 140,44,84
TR 36,25,51712
MAA 144,48,84
TR 38,25,52224
MAA 128,48,80
buffer_load_dword v22, s[16:19], s52 offen offset:2048 sc1 lds
MAA 132,52,80
TR 40,25,51744
s_add_u32 s52, s52, 16384
MAA 148,52,84
TR 42,25,52256
MAA 152,56,84
s_add_u32 s15, s15, 1
MAA 136,56,80
s_cbranch_scc0 .Lk56
s_waitcnt vmcnt(19) lgkmcnt(8)
s_barrier
MAA 60,20,0
RD 44,23,46080
s_add_u32 m0, s56, 104832
MAA 76,24,0
buffer_load_dwordx4 v18, s[20:23], s54 offen lds
MAA 80,24,4
RD 48,23,47104
v_add_f32 v164, v164, v168
MAA 64,20,4
RD 52,23,48384
v_add_f32 v165, v165, v169
MAA 68,20,8
RD 56,23,49408
v_add_f32 v166, v166, v170
MAA 84,24,8
buffer_load_dwordx4 v19, s[20:23], s54 offen offset:1024 lds
MAA 88,24,12
TR 64,25,62080
v_add_f32 v167, v167, v171
MAA 72,20,12
TR 66,25,62592
s_waitcnt lgkmcnt(6)
MAA 104,28,12
TR 68,25,62112
MAA 120,32,12
buffer_load_dwordx4 v20, s[20:23], s54 offen offset:2048 lds
MAA 116,32,8
TR 70,25,62624
s_add_u32 s54, s54, 196608
MAA 100,28,8
RD 60,24,48128
s_add_u32 m0, s55, 27648
MAA 96,28,4
TR 72,25,63104
MAA 112,32,4
buffer_load_dwordx4 v21, s[16:19], s52 offen sc1 lds
MAA 108,32,0
TR 74,25,63616
MAA 92,28,0
TR 76,25,63136
MAA 156,28,16
TR 78,25,63648
MAA 160,32,16
buffer_load_dwordx4 v21, s[16:19], s52 offen offset:1024 sc1 lds
MAA 124,0,36
TR 80,25,64128
MAA 140,0,40
TR 82,25,64640
MAA 144,4,40
TR 84,25,64160
MAA 128,4,36
buffer_load_dword v22, s[16:19], s52 offen offset:2048 sc1 lds
MAA 132,8,36
TR 86,25,64672
s_add_u32 s52, s52, 16384
MAA 148,8,40
MAA 152,12,40
MAA 136,12,36
s_waitcnt vmcnt(19) lgkmcnt(8)
s_barrier
MAA 60,64,44
ds_read_b128 a[0:3], v23
s_add_u32 m0, s56, 117248
MAA 76,68,44
buffer_load_dwordx4 v18, s[20:23], s54 offen lds
MAA 80,68,48
RD 4,23,1024
MAA 64,64,48
RD 8,23,2304
MAA 68,64,52
RD 12,23,3328
MAA 84,68,52
buffer_load_dwordx4 v19, s[20:23], s54 offen offset:1024 lds
MAA 88,68,56
ds_read_b64_tr_b16 a[20:21], v25
MAA 72,64,56
TR 22,25,512
s_waitcnt lgkmcnt(6)
MAA 104,72,56
TR 24,25,32
MAA 120,76,56
buffer_load_dwordx4 v20, s[20:23], s54 offen offset:2048 lds
MAA 116,76,52
TR 26,25,544
s_add_u32 s54, s54, 196608
MAA 100,72,52
RD 16,24,2048
MAA 96,72,48
s_add_u32 m0, s55, 36864
MAA 112,76,48
buffer_load_dwordx4 v21, s[16:19], s52 offen sc1 lds
MAA 108,76,44
TR 28,25,1024
MAA 92,72,44
TR 30,25,1536
MAA 156,72,60
TR 32,25,1056
MAA 160,76,60
buffer_load_dwordx4 v21, s[16:19], s52 offen offset:1024 sc1 lds
MAA 124,44,80
TR 34,25,1568
MAA 140,44,84
TR 36,25,2048
MAA 144,48,84
TR 38,25,2560
MAA 128,48,80
buffer_load_dword v22, s[16:19], s52 offen offset:2048 sc1 lds
MAA 132,52,80
TR 40,25,2080
s_add_u32 s52, s52, 16384
MAA 148,52,84
TR 42,25,2592
MAA 152,56,84
MAA 136,56,80
s_waitcnt vmcnt(19) lgkmcnt(8)
s_barrier
MAA 60,20,0
RD 44,23,9216
s_add_u32 m0, s56, 129664
MAA 76,24,0
buffer_load_dwordx4 v18, s[20:23], s54 offen lds
MAA 80,24,4
RD 48,23,10240
s_waitcnt vmcnt(19)
v_add_f32 v164, v164, v172
MAA 64,20,4
RD 52,23,11520
v_add_f32 v165, v165, v173
MAA 68,20,8
RD 56,23,12544
v_add_f32 v166, v166, v174
MAA 84,24,8
buffer_load_dwordx4 v19, s[20:23], s54 offen offset:1024 lds
MAA 88,24,12
TR 64,25,12416
v_add_f32 v167, v167, v175
MAA 72,20,12
TR 66,25,12928
s_waitcnt lgkmcnt(6)
MAA 104,28,12
TR 68,25,12448
MAA 120,32,12
buffer_load_dwordx4 v20, s[20:23], s54 offen offset:2048 lds
MAA 116,32,8
TR 70,25,12960
s_add_u32 s54, s54, 196608
MAA 100,28,8
RD 60,24,11264
s_add_u32 m0, s55, 46080
MAA 96,28,4
TR 72,25,13440
MAA 112,32,4
buffer_load_dwordx4 v21, s[16:19], s52 offen sc1 lds
MAA 108,32,0
TR 74,25,13952
MAA 92,28,0
TR 76,25,13472
MAA 156,28,16
TR 78,25,13984
MAA 160,32,16
buffer_load_dwordx4 v21, s[16:19], s52 offen offset:1024 sc1 lds
MAA 124,0,36
TR 80,25,14464
MAA 140,0,40
TR 82,25,14976
MAA 144,4,40
TR 84,25,14496
MAA 128,4,36
buffer_load_dword v22, s[16:19], s52 offen offset:2048 sc1 lds
MAA 132,8,36
TR 86,25,15008
s_add_u32 s52, s52, 16384
MAA 148,8,40
v_permlane32_swap_b32 v164, v166
MAA 152,12,40
v_permlane32_swap_b32 v165, v167
MAA 136,12,36
s_waitcnt vmcnt(18) lgkmcnt(8)
s_barrier
MAA 60,64,44
RD 0,23,18432
s_add_u32 m0, s59, 0
MAA 76,68,44
RD 4,23,19456
s_mov_b32 s58, 1048576
MAA 80,68,48
buffer_load_dwordx4 v5, s[24:27], s58 offen lds
MAA 64,64,48
RD 8,23,20736
v_add_f32 v164, v164, v166
MAA 68,64,52
RD 12,23,21760
v_add_f32 v165, v165, v167
MAA 84,68,52
TR 20,25,24832
v_mul_f32 v164, 0xba800000, v164
MAA 88,68,56
buffer_load_dwordx4 v6, s[24:27], s58 offen offset:1024 lds
MAA 72,64,56
TR 22,25,25344
s_add_u32 m0, s59, 58240
s_waitcnt lgkmcnt(6)
MAA 104,72,56
TR 24,25,24864
s_mov_b32 s58, 1966080
MAA 120,76,56
TR 26,25,25376
v_mul_f32 v165, 0x3a800000, v165
MAA 116,76,52
buffer_load_dwordx4 v5, s[24:27], s58 offen lds
MAA 100,72,52
RD 16,24,20480
v_fma_f32 v165, -v164, v164, v165
MAA 96,72,48
TR 28,25,25856
v_max_f32 v165, 0, v165
MAA 112,76,48
TR 30,25,26368
v_add_f32 v165, 0x3727c5ac, v165
.Lpad13:
s_cbranch_execz .Lpad16
MAA 108,76,44
buffer_load_dwordx4 v6, s[24:27], s58 offen offset:1024 lds
MAA 92,72,44
TR 32,25,25888
s_add_u32 m0, s59, 66560
MAA 156,72,60
TR 34,25,26400
s_mov_b32 s58, 0
MAA 160,76,60
TR 36,25,26880
MAA 124,44,80
buffer_load_dwordx4 v5, s[24:27], s58 offen lds
MAA 140,44,84
TR 38,25,27392
MAA 144,48,84
TR 40,25,26912
MAA 128,48,80
TR 42,25,27424
MAA 132,52,80
buffer_load_dwordx4 v6, s[24:27], s58 offen offset:1024 lds
MAA 148,52,84
v_rsq_f32 v166, v165
MAA 152,56,84
MAA 136,56,80
s_waitcnt vmcnt(18) lgkmcnt(8)
s_barrier
MAA 60,20,0
RD 44,23,27648
s_add_u32 m0, s59, 8320
MAA 76,24,0
RD 48,23,28672
s_mov_b32 s58, 1179648
MAA 80,24,4
buffer_load_dwordx4 v5, s[24:27], s58 offen lds
MAA 64,20,4
RD 52,23,29952
v_mov_b32 v165, v166
MAA 68,20,8
RD 56,23,30976
v_mul_f32 v166, 0x3e8293ee, v166
MAA 84,24,8
ds_write_b128 v7, v[164:167]
MAA 88,24,12
buffer_load_dwordx4 v6, s[24:27], s58 offen offset:1024 lds
MAA 72,20,12
TR 64,25,37248
s_add_u32 m0, s59, 74880
s_waitcnt lgkmcnt(6)
MAA 104,28,12
TR 66,25,37760
s_mov_b32 s58, 131072
MAA 120,32,12
TR 68,25,37280
MAA 116,32,8
buffer_load_dwordx4 v5, s[24:27], s58 offen lds
MAA 100,28,8
TR 70,25,37792
MAA 96,28,4
RD 60,24,29696
MAA 112,32,4
TR 72,25,38272
MAA 108,32,0
buffer_load_dwordx4 v6, s[24:27], s58 offen offset:1024 lds
MAA 92,28,0
TR 74,25,38784
s_add_u32 m0, s59, 83200
MAA 156,28,16
TR 76,25,38304
s_mov_b32 s58, 262144
MAA 160,32,16
TR 78,25,38816
MAA 124,0,36
buffer_load_dwordx4 v5, s[24:27], s58 offen lds
MAA 140,0,40
TR 80,25,39296
MAA 144,4,40
TR 82,25,39808
MAA 128,4,36
TR 84,25,39328
MAA 132,8,36
buffer_load_dwordx4 v6, s[24:27], s58 offen offset:1024 lds
MAA 148,8,40
TR 86,25,39840
MAA 152,12,40
MAA 136,12,36
s_waitcnt vmcnt(18) lgkmcnt(8)
s_barrier
MAA 60,64,44
ds_write_b32 v17, v164
s_add_u32 m0, s59, 16640
MAA 76,68,44
ds_write_b32 v17, v165 offset:1024
s_mov_b32 s58, 1310720
MAA 80,68,48
buffer_load_dwordx4 v5, s[24:27], s58 offen lds
MAA 64,64,48
RD 0,23,36864
MAA 68,64,52
RD 4,23,37888
MAA 84,68,52
RD 8,23,39168
MAA 88,68,56
RD 12,23,40192
MAA 72,64,56
TR 20,25,49664
s_waitcnt lgkmcnt(7)
MAA 104,72,56
buffer_load_dwordx4 v6, s[24:27], s58 offen offset:1024 lds
MAA 120,76,56
TR 22,25,50176
s_add_u32 m0, s59, 91520
MAA 116,76,52
TR 24,25,49696
s_mov_b32 s58, 393216
MAA 100,72,52
TR 26,25,50208
MAA 96,72,48
RD 16,24,38912
MAA 112,76,48
TR 28,25,50688
MAA 108,76,44
buffer_load_dwordx4 v5, s[24:27], s58 offen lds
MAA 92,72,44
TR 30,25,51200
MAA 156,72,60
TR 32,25,50720
MAA 160,76,60
TR 34,25,51232
MAA 124,44,80
TR 36,25,51712
MAA 140,44,84
TR 38,25,52224
MAA 144,48,84
buffer_load_dwordx4 v6, s[24:27], s58 offen offset:1024 lds
MAA 128,48,80
TR 40,25,51744
MAA 132,52,80
TR 42,25,52256
MAA 148,52,84
MAA 152,56,84
MAA 136,56,80
s_waitcnt vmcnt(16) lgkmcnt(8)
s_barrier
MAA 60,20,0
RD 44,23,46080
s_add_u32 m0, s59, 24960
MAA 76,24,0
RD 48,23,47104
s_mov_b32 s58, 1441792
MAA 80,24,4
buffer_load_dwordx4 v5, s[24:27], s58 offen lds
MAA 64,20,4
RD 52,23,48384
MAA 68,20,8
RD 56,23,49408
MAA 84,24,8
TR 64,25,62080
MAA 88,24,12
buffer_load_dwordx4 v6, s[24:27], s58 offen offset:1024 lds
MAA 72,20,12
TR 66,25,62592
s_add_u32 m0, s59, 99840
s_waitcnt lgkmcnt(6)
MAA 104,28,12
TR 68,25,62112
s_mov_b32 s58, 524288
MAA 120,32,12
TR 70,25,62624
MAA 116,32,8
buffer_load_dwordx4 v5, s[24:27], s58 offen lds
MAA 100,28,8
RD 60,24,48128
MAA 96,28,4
TR 72,25,63104
MAA 112,32,4
TR 74,25,63616
MAA 108,32,0
buffer_load_dwordx4 v6, s[24:27], s58 offen offset:1024 lds
MAA 92,28,0
TR 76,25,63136
s_add_u32 m0, s59, 108160
MAA 156,28,16
TR 78,25,63648
s_mov_b32 s58, 655360
MAA 160,32,16
TR 80,25,64128
MAA 124,0,36
buffer_load_dwordx4 v5, s[24:27], s58 offen lds
MAA 140,0,40
TR 82,25,64640
MAA 144,4,40
TR 84,25,64160
MAA 128,4,36
TR 86,25,64672
MAA 132,8,36
buffer_load_dwordx4 v6, s[24:27], s58 offen offset:1024 lds
MAA 148,8,40
MAA 152,12,40
MAA 136,12,36
s_waitcnt lgkmcnt(0)
s_barrier
MAA 156,72,60
ds_read_b128 v[232:235], v10 offset:768
s_add_u32 m0, s59, 33280
MAA 160,76,60
ds_read_b128 v[236:239], v10 offset:2816
s_mov_b32 s58, 1572864
MAA 104,72,56
ds_read_b128 v[228:231], v10 offset:512
MAA 120,76,56
ds_read_b128 v[224:227], v10 offset:256
MAA 136,56,80
ds_read_b128 v[220:223], v10
MAA 152,56,84
ds_read_b128 v[240:243], v11 offset:192
MAA 100,72,52
ds_read_b128 v[244:247], v11 offset:1216
MAA 116,76,52
buffer_load_dwordx4 v5, s[24:27], s58 offen lds
MAA 96,72,48
ds_read_b128 v[18:21], v11 offset:128
ds_read_b128 v[22:25], v11 offset:1152
s_waitcnt lgkmcnt(8)
v_pk_fma_f32 v[104:105], v[36:37], v[232:233], v[104:105] op_sel_hi:[1,0,1]
v_pk_mul_f32 v[104:105], v[104:105], v[232:233] op_sel:[0,1] op_sel_hi:[1,1]
v_pk_fma_f32 v[106:107], v[38:39], v[232:233], v[106:107] op_sel_hi:[1,0,1]
v_pk_mul_f32 v[106:107], v[106:107], v[232:233] op_sel:[0,1] op_sel_hi:[1,1]
v_pk_fma_f32 v[120:121], v[40:41], v[232:233], v[120:121] op_sel_hi:[1,0,1]
v_pk_mul_f32 v[120:121], v[120:121], v[232:233] op_sel:[0,1] op_sel_hi:[1,1]
v_pk_fma_f32 v[122:123], v[42:43], v[232:233], v[122:123] op_sel_hi:[1,0,1]
v_pk_mul_f32 v[122:123], v[122:123], v[232:233] op_sel:[0,1] op_sel_hi:[1,1]
s_waitcnt lgkmcnt(6)
v_pk_fma_f32 v[100:101], v[36:37], v[228:229], v[100:101] op_sel_hi:[1,0,1]
v_pk_mul_f32 v[100:101], v[100:101], v[228:229] op_sel:[0,1] op_sel_hi:[1,1]
v_pk_fma_f32 v[102:103], v[38:39], v[228:229], v[102:103] op_sel_hi:[1,0,1]
v_pk_mul_f32 v[102:103], v[102:103], v[228:229] op_sel:[0,1] op_sel_hi:[1,1]
v_pk_fma_f32 v[116:117], v[40:41], v[228:229], v[116:117] op_sel_hi:[1,0,1]
v_pk_mul_f32 v[116:117], v[116:117], v[228:229] op_sel:[0,1] op_sel_hi:[1,1]
s_waitcnt lgkmcnt(3)
v_pk_fma_f32 v[136:137], v[240:241], v[44:45], v[136:137] op_sel_hi:[1,0,1]
v_pk_fma_f32 v[138:139], v[242:243], v[44:45], v[138:139] op_sel_hi:[1,0,1]
v_pk_fma_f32 v[152:153], v[240:241], v[44:45], v[152:153] op_sel:[0,1,0] op_sel_hi:[1,1,1]
v_pk_fma_f32 v[154:155], v[242:243], v[44:45], v[154:155] op_sel:[0,1,0] op_sel_hi:[1,1,1]
s_waitcnt lgkmcnt(2)
v_pk_mul_f32 v[136:137], v[136:137], v[244:245]
v_pk_mul_f32 v[138:139], v[138:139], v[246:247]
v_pk_mul_f32 v[152:153], v[152:153], v[244:245]
v_pk_mul_f32 v[154:155], v[154:155], v[246:247]
v_pk_fma_f32 v[118:119], v[42:43], v[228:229], v[118:119] op_sel_hi:[1,0,1]
v_pk_mul_f32 v[118:119], v[118:119], v[228:229] op_sel:[0,1] op_sel_hi:[1,1]
v_pk_fma_f32 v[96:97], v[36:37], v[224:225], v[96:97] op_sel_hi:[1,0,1]
v_pk_mul_f32 v[96:97], v[96:97], v[224:225] op_sel:[0,1] op_sel_hi:[1,1]
v_pk_fma_f32 v[98:99], v[38:39], v[224:225], v[98:99] op_sel_hi:[1,0,1]
v_pk_mul_f32 v[98:99], v[98:99], v[224:225] op_sel:[0,1] op_sel_hi:[1,1]
v_pk_fma_f32 v[156:157], v[36:37], v[236:237], v[156:157] op_sel_hi:[1,0,1]
v_pk_mul_f32 v[156:157], v[156:157], v[236:237] op_sel:[0,1] op_sel_hi:[1,1]
v_pk_fma_f32 v[158:159], v[38:39], v[236:237], v[158:159] op_sel_hi:[1,0,1]
v_pk_mul_f32 v[158:159], v[158:159], v[236:237] op_sel:[0,1] op_sel_hi:[1,1]
v_pk_fma_f32 v[160:161], v[40:41], v[236:237], v[160:161] op_sel_hi:[1,0,1]
v_pk_mul_f32 v[160:161], v[160:161], v[236:237] op_sel:[0,1] op_sel_hi:[1,1]
v_pk_fma_f32 v[162:163], v[42:43], v[236:237], v[162:163] op_sel_hi:[1,0,1]
v_pk_mul_f32 v[162:163], v[162:163], v[236:237] op_sel:[0,1] op_sel_hi:[1,1]
v_cvt_pk_bf16_f32 v196, v104, v105
v_cvt_pk_bf16_f32 v197, v106, v107
MAA 112,76,48
buffer_load_dwordx4 v6, s[24:27], s58 offen offset:1024 lds
MAA 92,72,44
ds_read_b128 v[240:243], v11 offset:64
v_cvt_pk_bf16_f32 v198, v120, v121
MAA 108,76,44
ds_read_b128 v[244:247], v11 offset:1088
v_cvt_pk_bf16_f32 v199, v122, v123
MAA 72,64,56
ds_write_b128 v8, v[196:199]
v_cvt_pk_bf16_f32 v208, v136, v137
MAA 88,68,56
s_add_u32 m0, s59, 41600
v_cvt_pk_bf16_f32 v209, v138, v139
v_cvt_pk_bf16_f32 v218, v152, v153
v_cvt_pk_bf16_f32 v219, v154, v155
ds_write_b64 v8, v[208:209] offset:1024
v_pk_fma_f32 v[72:73], v[28:29], v[232:233], v[72:73] op_sel_hi:[1,0,1]
v_pk_fma_f32 v[74:75], v[30:31], v[232:233], v[74:75] op_sel_hi:[1,0,1]
s_nop 0
v_pk_fma_f32 v[88:89], v[32:33], v[232:233], v[88:89] op_sel_hi:[1,0,1]
v_pk_fma_f32 v[90:91], v[34:35], v[232:233], v[90:91] op_sel_hi:[1,0,1]
v_pk_fma_f32 v[112:113], v[40:41], v[224:225], v[112:113] op_sel_hi:[1,0,1]
v_pk_mul_f32 v[112:113], v[112:113], v[224:225] op_sel:[0,1] op_sel_hi:[1,1]
v_pk_fma_f32 v[114:115], v[42:43], v[224:225], v[114:115] op_sel_hi:[1,0,1]
v_pk_mul_f32 v[114:115], v[114:115], v[224:225] op_sel:[0,1] op_sel_hi:[1,1]
v_pk_fma_f32 v[92:93], v[36:37], v[220:221], v[92:93] op_sel_hi:[1,0,1]
v_pk_mul_f32 v[92:93], v[92:93], v[220:221] op_sel:[0,1] op_sel_hi:[1,1]
v_pk_fma_f32 v[94:95], v[38:39], v[220:221], v[94:95] op_sel_hi:[1,0,1]
v_pk_mul_f32 v[94:95], v[94:95], v[220:221] op_sel:[0,1] op_sel_hi:[1,1]
v_pk_fma_f32 v[108:109], v[40:41], v[220:221], v[108:109] op_sel_hi:[1,0,1]
v_pk_mul_f32 v[108:109], v[108:109], v[220:221] op_sel:[0,1] op_sel_hi:[1,1]
v_pk_fma_f32 v[110:111], v[42:43], v[220:221], v[110:111] op_sel_hi:[1,0,1]
v_pk_mul_f32 v[110:111], v[110:111], v[220:221] op_sel:[0,1] op_sel_hi:[1,1]
ds_write_b64 v8, v[218:219] offset:1032
s_nop 0
MAA 132,52,80
s_mov_b32 s58, 1703936
v_cvt_pk_bf16_f32 v192, v100, v101
v_cvt_pk_bf16_f32 v193, v102, v103
MAA 148,52,84
buffer_load_dwordx4 v5, s[24:27], s58 offen lds
MAA 68,64,52
v_cvt_pk_bf16_f32 v194, v116, v117
v_cvt_pk_bf16_f32 v195, v118, v119
MAA 84,68,52
v_cvt_pk_bf16_f32 v176, v72, v73
v_cvt_pk_bf16_f32 v177, v74, v75
MAA 128,48,80
v_cvt_pk_bf16_f32 v178, v88, v89
v_cvt_pk_bf16_f32 v179, v90, v91
v_cvt_pk_bf16_f32 v188, v96, v97
v_cvt_pk_bf16_f32 v189, v98, v99
v_cvt_pk_bf16_f32 v190, v112, v113
s_waitcnt lgkmcnt(6)
v_pk_fma_f32 v[132:133], v[18:19], v[44:45], v[132:133] op_sel_hi:[1,0,1]
s_waitcnt lgkmcnt(5)
v_pk_mul_f32 v[132:133], v[132:133], v[22:23]
v_pk_fma_f32 v[134:135], v[20:21], v[44:45], v[134:135] op_sel_hi:[1,0,1]
v_pk_mul_f32 v[134:135], v[134:135], v[24:25]
v_pk_fma_f32 v[148:149], v[18:19], v[44:45], v[148:149] op_sel:[0,1,0] op_sel_hi:[1,1,1]
v_pk_mul_f32 v[148:149], v[148:149], v[22:23]
v_pk_fma_f32 v[150:151], v[20:21], v[44:45], v[150:151] op_sel:[0,1,0] op_sel_hi:[1,1,1]
v_pk_mul_f32 v[150:151], v[150:151], v[24:25]
v_pk_fma_f32 v[68:69], v[28:29], v[228:229], v[68:69] op_sel_hi:[1,0,1]
v_pk_fma_f32 v[70:71], v[30:31], v[228:229], v[70:71] op_sel_hi:[1,0,1]
v_pk_fma_f32 v[84:85], v[32:33], v[228:229], v[84:85] op_sel_hi:[1,0,1]
v_pk_fma_f32 v[86:87], v[34:35], v[228:229], v[86:87] op_sel_hi:[1,0,1]
s_waitcnt lgkmcnt(4)
v_pk_fma_f32 v[128:129], v[240:241], v[44:45], v[128:129] op_sel_hi:[1,0,1]
s_waitcnt lgkmcnt(3)
v_pk_mul_f32 v[128:129], v[128:129], v[244:245]
v_pk_fma_f32 v[130:131], v[242:243], v[44:45], v[130:131] op_sel_hi:[1,0,1]
v_pk_mul_f32 v[130:131], v[130:131], v[246:247]
s_waitcnt lgkmcnt(0)
s_barrier
v_cvt_pk_bf16_f32 v206, v132, v133
MAA 144,48,84
ds_read_b64 v[200:201], v9 offset:1024
v_cvt_pk_bf16_f32 v207, v134, v135
MAA 64,64,48
ds_read_b64 v[210:211], v9 offset:1032
v_cvt_pk_bf16_f32 v216, v148, v149
MAA 80,68,48
buffer_load_dwordx4 v6, s[24:27], s58 offen offset:1024 lds
MAA 124,44,80
ds_read_b128 v[18:21], v11
s_add_u32 m0, s59, 49920
MAA 140,44,84
ds_read_b128 v[22:25], v11 offset:1024
s_mov_b32 s58, 1835008
MAA 60,64,44
v_cvt_pk_bf16_f32 v217, v150, v151
v_cvt_pk_bf16_f32 v191, v114, v115
MAA 76,68,44
buffer_load_dwordx4 v5, s[24:27], s58 offen lds
v_cvt_pk_bf16_f32 v172, v68, v69
v_cvt_pk_bf16_f32 v173, v70, v71
v_cvt_pk_bf16_f32 v174, v84, v85
v_pk_fma_f32 v[144:145], v[240:241], v[44:45], v[144:145] op_sel:[0,1,0] op_sel_hi:[1,1,1]
v_pk_mul_f32 v[144:145], v[144:145], v[244:245]
v_pk_fma_f32 v[146:147], v[242:243], v[44:45], v[146:147] op_sel:[0,1,0] op_sel_hi:[1,1,1]
v_pk_mul_f32 v[146:147], v[146:147], v[246:247]
v_pk_fma_f32 v[64:65], v[28:29], v[224:225], v[64:65] op_sel_hi:[1,0,1]
v_pk_fma_f32 v[66:67], v[30:31], v[224:225], v[66:67] op_sel_hi:[1,0,1]
v_pk_fma_f32 v[80:81], v[32:33], v[224:225], v[80:81] op_sel_hi:[1,0,1]
v_pk_fma_f32 v[82:83], v[34:35], v[224:225], v[82:83] op_sel_hi:[1,0,1]
v_pk_fma_f32 v[60:61], v[28:29], v[220:221], v[60:61] op_sel_hi:[1,0,1]
v_pk_fma_f32 v[62:63], v[30:31], v[220:221], v[62:63] op_sel_hi:[1,0,1]
v_pk_fma_f32 v[76:77], v[32:33], v[220:221], v[76:77] op_sel_hi:[1,0,1]
v_pk_fma_f32 v[78:79], v[34:35], v[220:221], v[78:79] op_sel_hi:[1,0,1]
v_cvt_pk_bf16_f32 v175, v86, v87
v_cvt_pk_bf16_f32 v204, v128, v129
v_mfma_f32_16x16x32_bf16 v[104:107], v[192:195], v[176:179], v[46:49]
buffer_load_dwordx4 v6, s[24:27], s58 offen offset:1024 lds
v_mfma_f32_16x16x32_bf16 v[120:123], v[196:199], v[176:179], v[50:53]
s_add_u32 m0, s59, 116480
s_mov_b32 s58, 786432
v_cvt_pk_bf16_f32 v205, v130, v131
v_mfma_f32_16x16x32_bf16 v[100:103], v[188:191], v[172:175], v[46:49]
s_nop 1
v_max3_f32 v88, v104, v105, v106
v_cvt_pk_bf16_f32 v214, v144, v145
v_mfma_f32_16x16x32_bf16 v[116:119], v[192:195], v[172:175], v[50:53]
v_max3_f32 v89, v107, v120, v121
v_max3_f32 v88, v88, v122, v123
v_max_f32 v90, v88, v89
buffer_load_dwordx4 v5, s[24:27], s58 offen lds
v_max_f32 v89, v88, v89
v_cvt_pk_bf16_f32 v215, v146, v147
v_max3_f32 v84, v100, v101, v102
v_permlane16_swap_b32 v90, v89
v_max3_f32 v85, v103, v116, v117
v_max_f32 v88, v90, v89
v_max_f32 v89, v90, v89
v_max3_f32 v84, v84, v118, v119
v_max_f32 v86, v84, v85
v_permlane32_swap_b32 v88, v89
v_max_f32 v85, v84, v85
buffer_load_dwordx4 v6, s[24:27], s58 offen offset:1024 lds
s_add_u32 m0, s59, 124800
s_mov_b32 s58, 917504
v_max_f32 v88, v88, v89
v_mul_f32 v88, v88, v234
v_pk_fma_f32 v[104:105], v[104:105], v[234:235], v[88:89] op_sel_hi:[1,0,0] neg_lo:[0,0,1] neg_hi:[0,0,1]
v_pk_fma_f32 v[106:107], v[106:107], v[234:235], v[88:89] op_sel_hi:[1,0,0] neg_lo:[0,0,1] neg_hi:[0,0,1]
v_pk_fma_f32 v[120:121], v[120:121], v[234:235], v[88:89] op_sel_hi:[1,0,0] neg_lo:[0,0,1] neg_hi:[0,0,1]
v_pk_fma_f32 v[122:123], v[122:123], v[234:235], v[88:89] op_sel_hi:[1,0,0] neg_lo:[0,0,1] neg_hi:[0,0,1]
v_exp_f32 v104, v104
v_exp_f32 v105, v105
v_exp_f32 v106, v106
v_exp_f32 v107, v107
v_exp_f32 v120, v120
v_exp_f32 v121, v121
v_exp_f32 v122, v122
v_exp_f32 v123, v123
v_cvt_pk_bf16_f32 v72, v104, v105
buffer_load_dwordx4 v5, s[24:27], s58 offen lds
v_cvt_pk_bf16_f32 v73, v106, v107
v_cvt_pk_bf16_f32 v74, v120, v121
v_cvt_pk_bf16_f32 v75, v122, v123
s_waitcnt lgkmcnt(1)
v_pk_fma_f32 v[124:125], v[18:19], v[44:45], v[124:125] op_sel_hi:[1,0,1]
s_waitcnt lgkmcnt(0)
v_pk_mul_f32 v[124:125], v[124:125], v[22:23]
v_pk_fma_f32 v[126:127], v[20:21], v[44:45], v[126:127] op_sel_hi:[1,0,1]
v_pk_mul_f32 v[126:127], v[126:127], v[24:25]
v_pk_fma_f32 v[140:141], v[18:19], v[44:45], v[140:141] op_sel:[0,1,0] op_sel_hi:[1,1,1]
v_pk_mul_f32 v[140:141], v[140:141], v[22:23]
v_pk_fma_f32 v[142:143], v[20:21], v[44:45], v[142:143] op_sel:[0,1,0] op_sel_hi:[1,1,1]
v_pk_mul_f32 v[142:143], v[142:143], v[24:25]
v_permlane16_swap_b32 v86, v85
s_nop 0
v_mfma_f32_16x16x32_bf16 v[88:91], v[248:251], v[72:75], 0
buffer_load_dwordx4 v6, s[24:27], s58 offen offset:1024 lds
v_mfma_f32_16x16x32_bf16 v[104:107], v[206:209], v[72:75], 0
v_max_f32 v84, v86, v85
v_max_f32 v85, v86, v85
v_mfma_f32_16x16x32_bf16 v[120:123], v[216:219], v[72:75], 0
s_nop 2
v_rcp_f32 v88, v88
v_permlane32_swap_b32 v84, v85
v_cvt_pk_bf16_f32 v184, v92, v93
v_pk_mul_f32 v[104:105], v[104:105], v[88:89] op_sel_hi:[1,0]
v_pk_mul_f32 v[106:107], v[106:107], v[88:89] op_sel_hi:[1,0]
v_pk_mul_f32 v[120:121], v[120:121], v[88:89] op_sel_hi:[1,0]
v_pk_mul_f32 v[122:123], v[122:123], v[88:89] op_sel_hi:[1,0]
v_cvt_pk_bf16_f32 v176, v104, v105
v_cvt_pk_bf16_f32 v177, v106, v107
v_cvt_pk_bf16_f32 v178, v120, v121
v_cvt_pk_bf16_f32 v179, v122, v123
buffer_store_dwordx4 v[176:179], v4, s[16:19], s74 offen offset:3072 sc1
v_max_f32 v84, v84, v85
v_mul_f32 v84, v84, v230
v_pk_fma_f32 v[100:101], v[100:101], v[230:231], v[84:85] op_sel_hi:[1,0,0] neg_lo:[0,0,1] neg_hi:[0,0,1]
v_pk_fma_f32 v[102:103], v[102:103], v[230:231], v[84:85] op_sel_hi:[1,0,0] neg_lo:[0,0,1] neg_hi:[0,0,1]
v_pk_fma_f32 v[116:117], v[116:117], v[230:231], v[84:85] op_sel_hi:[1,0,0] neg_lo:[0,0,1] neg_hi:[0,0,1]
v_pk_fma_f32 v[118:119], v[118:119], v[230:231], v[84:85] op_sel_hi:[1,0,0] neg_lo:[0,0,1] neg_hi:[0,0,1]
v_exp_f32 v100, v100
v_exp_f32 v101, v101
v_exp_f32 v102, v102
v_exp_f32 v103, v103
v_exp_f32 v116, v116
v_exp_f32 v117, v117
v_exp_f32 v118, v118
v_exp_f32 v119, v119
v_cvt_pk_bf16_f32 v68, v100, v101
v_cvt_pk_bf16_f32 v69, v102, v103
v_cvt_pk_bf16_f32 v70, v116, v117
v_cvt_pk_bf16_f32 v71, v118, v119
v_cvt_pk_bf16_f32 v185, v94, v95
v_cvt_pk_bf16_f32 v186, v108, v109
v_mfma_f32_16x16x32_bf16 v[84:87], v[248:251], v[68:71], 0
v_cvt_pk_bf16_f32 v187, v110, v111
v_cvt_pk_bf16_f32 v168, v64, v65
v_mfma_f32_16x16x32_bf16 v[100:103], v[204:207], v[68:71], 0
v_cvt_pk_bf16_f32 v169, v66, v67
v_cvt_pk_bf16_f32 v170, v80, v81
v_mfma_f32_16x16x32_bf16 v[116:119], v[214:217], v[68:71], 0
s_nop 1
v_rcp_f32 v84, v84
v_cvt_pk_bf16_f32 v171, v82, v83
v_cvt_pk_bf16_f32 v202, v124, v125
v_cvt_pk_bf16_f32 v203, v126, v127
v_pk_mul_f32 v[100:101], v[100:101], v[84:85] op_sel_hi:[1,0]
v_pk_mul_f32 v[102:103], v[102:103], v[84:85] op_sel_hi:[1,0]
v_pk_mul_f32 v[116:117], v[116:117], v[84:85] op_sel_hi:[1,0]
v_pk_mul_f32 v[118:119], v[118:119], v[84:85] op_sel_hi:[1,0]
v_cvt_pk_bf16_f32 v172, v100, v101
v_cvt_pk_bf16_f32 v173, v102, v103
v_mfma_f32_16x16x32_bf16 v[96:99], v[184:187], v[168:171], v[46:49]
v_cvt_pk_bf16_f32 v174, v116, v117
v_cvt_pk_bf16_f32 v175, v118, v119
v_mfma_f32_16x16x32_bf16 v[112:115], v[188:191], v[168:171], v[50:53]
buffer_store_dwordx4 v[172:175], v4, s[16:19], s74 offen offset:2048 sc1
v_cvt_pk_bf16_f32 v212, v140, v141
v_cvt_pk_bf16_f32 v213, v142, v143
s_nop 1
v_max3_f32 v80, v96, v97, v98
v_cvt_pk_bf16_f32 v180, v156, v157
v_cvt_pk_bf16_f32 v181, v158, v159
v_max3_f32 v81, v99, v112, v113
v_max3_f32 v80, v80, v114, v115
v_max_f32 v82, v80, v81
v_max_f32 v81, v80, v81
v_cvt_pk_bf16_f32 v182, v160, v161
v_cvt_pk_bf16_f32 v183, v162, v163
v_permlane16_swap_b32 v82, v81
v_cvt_pk_bf16_f32 v164, v60, v61
v_max_f32 v80, v82, v81
v_max_f32 v81, v82, v81
v_cvt_pk_bf16_f32 v165, v62, v63
v_cvt_pk_bf16_f32 v166, v76, v77
v_permlane32_swap_b32 v80, v81
v_cvt_pk_bf16_f32 v167, v78, v79
v_max_f32 v80, v80, v81
v_mul_f32 v80, v80, v226
v_mfma_f32_16x16x32_bf16 v[92:95], v[180:183], v[164:167], v[54:57]
v_mfma_f32_16x16x32_bf16 v[108:111], v[184:187], v[164:167], v[50:53]
s_nop 6
v_max3_f32 v76, v92, v93, v94
v_pk_fma_f32 v[96:97], v[96:97], v[226:227], v[80:81] op_sel_hi:[1,0,0] neg_lo:[0,0,1] neg_hi:[0,0,1]
v_pk_fma_f32 v[98:99], v[98:99], v[226:227], v[80:81] op_sel_hi:[1,0,0] neg_lo:[0,0,1] neg_hi:[0,0,1]
v_pk_fma_f32 v[112:113], v[112:113], v[226:227], v[80:81] op_sel_hi:[1,0,0] neg_lo:[0,0,1] neg_hi:[0,0,1]
v_pk_fma_f32 v[114:115], v[114:115], v[226:227], v[80:81] op_sel_hi:[1,0,0] neg_lo:[0,0,1] neg_hi:[0,0,1]
v_exp_f32 v96, v96
v_exp_f32 v97, v97
v_exp_f32 v98, v98
v_exp_f32 v99, v99
v_exp_f32 v112, v112
v_exp_f32 v113, v113
v_exp_f32 v114, v114
v_exp_f32 v115, v115
v_cvt_pk_bf16_f32 v64, v96, v97
v_cvt_pk_bf16_f32 v65, v98, v99
v_cvt_pk_bf16_f32 v66, v112, v113
v_cvt_pk_bf16_f32 v67, v114, v115
v_max3_f32 v77, v95, v108, v109
v_max3_f32 v76, v76, v110, v111
v_mfma_f32_16x16x32_bf16 v[80:83], v[248:251], v[64:67], 0
v_max_f32 v78, v76, v77
v_max_f32 v77, v76, v77
v_mfma_f32_16x16x32_bf16 v[96:99], v[202:205], v[64:67], 0
s_nop 0
v_permlane16_swap_b32 v78, v77
v_mfma_f32_16x16x32_bf16 v[112:115], v[212:215], v[64:67], 0
s_nop 1
v_rcp_f32 v80, v80
v_max_f32 v76, v78, v77
v_max_f32 v77, v78, v77
v_pk_mul_f32 v[96:97], v[96:97], v[80:81] op_sel_hi:[1,0]
v_pk_mul_f32 v[98:99], v[98:99], v[80:81] op_sel_hi:[1,0]
s_nop 0
v_pk_mul_f32 v[112:113], v[112:113], v[80:81] op_sel_hi:[1,0]
.Lpad14:
s_cbranch_execz .Lpad17
v_pk_mul_f32 v[114:115], v[114:115], v[80:81] op_sel_hi:[1,0]
v_cvt_pk_bf16_f32 v168, v96, v97
v_cvt_pk_bf16_f32 v169, v98, v99
v_cvt_pk_bf16_f32 v170, v112, v113
v_cvt_pk_bf16_f32 v171, v114, v115
buffer_store_dwordx4 v[168:171], v4, s[16:19], s74 offen offset:1024 sc1
v_permlane32_swap_b32 v76, v77
v_max_f32 v76, v76, v77
v_mul_f32 v76, v76, v222
v_pk_fma_f32 v[92:93], v[92:93], v[222:223], v[76:77] op_sel_hi:[1,0,0] neg_lo:[0,0,1] neg_hi:[0,0,1]
v_pk_fma_f32 v[94:95], v[94:95], v[222:223], v[76:77] op_sel_hi:[1,0,0] neg_lo:[0,0,1] neg_hi:[0,0,1]
v_pk_fma_f32 v[108:109], v[108:109], v[222:223], v[76:77] op_sel_hi:[1,0,0] neg_lo:[0,0,1] neg_hi:[0,0,1]
v_pk_fma_f32 v[110:111], v[110:111], v[222:223], v[76:77] op_sel_hi:[1,0,0] neg_lo:[0,0,1] neg_hi:[0,0,1]
v_exp_f32 v92, v92
v_exp_f32 v93, v93
v_exp_f32 v94, v94
v_exp_f32 v95, v95
v_exp_f32 v108, v108
v_exp_f32 v109, v109
v_exp_f32 v110, v110
v_exp_f32 v111, v111
v_cvt_pk_bf16_f32 v60, v92, v93
v_cvt_pk_bf16_f32 v61, v94, v95
v_cvt_pk_bf16_f32 v62, v108, v109
v_cvt_pk_bf16_f32 v63, v110, v111
s_nop 1
v_mfma_f32_16x16x32_bf16 v[76:79], v[248:251], v[60:63], 0
v_mfma_f32_16x16x32_bf16 v[92:95], v[200:203], v[60:63], 0
v_mfma_f32_16x16x32_bf16 v[108:111], v[210:213], v[60:63], 0
s_nop 5
v_rcp_f32 v76, v76
s_nop 0
v_pk_mul_f32 v[92:93], v[92:93], v[76:77] op_sel_hi:[1,0]
v_pk_mul_f32 v[94:95], v[94:95], v[76:77] op_sel_hi:[1,0]
v_pk_mul_f32 v[108:109], v[108:109], v[76:77] op_sel_hi:[1,0]
v_pk_mul_f32 v[110:111], v[110:111], v[76:77] op_sel_hi:[1,0]
v_cvt_pk_bf16_f32 v164, v92, v93
v_cvt_pk_bf16_f32 v165, v94, v95
v_cvt_pk_bf16_f32 v166, v108, v109
v_cvt_pk_bf16_f32 v167, v110, v111
buffer_store_dwordx4 v[164:167], v4, s[16:19], s74 offen sc1
s_nop 1
s_branch .Lqkve55
.Lpad15:
s_cbranch_execz .Lpad18
.Lsp49:
s_mov_b32 s15, 0
.Lsp49l:
v_mov_b32 v25, 0
buffer_atomic_add v25, v22, s[16:19], s73 offen sc0
s_add_u32 s15, s15, 1
s_cmp_gt_u32 s15, 100000
s_waitcnt vmcnt(0)
s_cbranch_scc1 .Lsp49b
v_cmp_gt_u32 vcc, v23, v25
s_nop 0
s_cbranch_vccnz .Lsp49l
s_branch .Lsp49b
.Lxs50:
s_mov_b32 s15, 0
.Lxs50l:
v_mov_b32 v15, 0
buffer_atomic_add v15, v12, s[16:19], s70 offen sc0
s_add_u32 s15, s15, 1
s_cmp_gt_u32 s15, 100000
s_waitcnt vmcnt(0)
s_cbranch_scc1 .Lxs50b
v_cmp_ne_u32 vcc, 0, v15
s_nop 0
s_cbranch_vccz .Lxs50l
s_branch .Lxs50b
.Lqkv54:
.Lpad16:
s_cbranch_execz .Lpad19
s_add_u32 m0, s55, 36864
s_nop 0
buffer_load_dwordx4 v21, s[16:19], s52 offen sc1 lds
buffer_load_dwordx4 v21, s[16:19], s52 offen offset:1024 sc1 lds
buffer_load_dword v22, s[16:19], s52 offen offset:2048 sc1 lds
s_add_u32 s52, s52, 16384
s_add_u32 m0, s55, 46080
s_nop 0
buffer_load_dwordx4 v21, s[16:19], s52 offen sc1 lds
buffer_load_dwordx4 v21, s[16:19], s52 offen offset:1024 sc1 lds
buffer_load_dword v22, s[16:19], s52 offen offset:2048 sc1 lds
s_add_u32 s52, s52, 16384
s_add_u32 m0, s55, 0
s_nop 0
buffer_load_dwordx4 v21, s[16:19], s52 offen sc1 lds
buffer_load_dwordx4 v21, s[16:19], s52 offen offset:1024 sc1 lds
buffer_load_dword v22, s[16:19], s52 offen offset:2048 sc1 lds
s_add_u32 s52, s52, 16384
s_add_u32 m0, s55, 9216
s_nop 0
buffer_load_dwordx4 v21, s[16:19], s52 offen sc1 lds
buffer_load_dwordx4 v21, s[16:19], s52 offen offset:1024 sc1 lds
buffer_load_dword v22, s[16:19], s52 offen offset:2048 sc1 lds
s_add_u32 s52, s52, 16384
s_add_u32 m0, s55, 18432
s_nop 0
buffer_load_dwordx4 v21, s[16:19], s52 offen sc1 lds
buffer_load_dwordx4 v21, s[16:19], s52 offen offset:1024 sc1 lds
buffer_load_dword v22, s[16:19], s52 offen offset:2048 sc1 lds
s_add_u32 s52, s52, 16384
s_waitcnt vmcnt(12)
s_barrier
RD 0,23,36864
RD 4,23,37888
RD 8,23,39168
RD 12,23,40192
RD 16,24,38912
s_waitcnt lgkmcnt(0)
s_mov_b32 s15, -4
.p2align 6
.Lk57:
s_waitcnt vmcnt(9) lgkmcnt(8)
s_barrier
MAA 60,20,0
RD 44,23,46080
v_add_f32 v164, v164, v168
MAA 76,24,0
RD 48,23,47104
s_add_u32 m0, s56, 104832
MAA 80,24,4
buffer_load_dwordx4 v18, s[20:23], s54 offen lds
MAA 64,20,4
RD 52,23,48384
MAA 68,20,8
RD 56,23,49408
MAA 84,24,8
buffer_load_dwordx4 v19, s[20:23], s54 offen offset:1024 lds
MAA 88,24,12
TR 64,25,62080
v_add_f32 v165, v165, v169
MAA 72,20,12
TR 66,25,62592
s_waitcnt lgkmcnt(6)
MAA 104,28,12
buffer_load_dwordx4 v20, s[20:23], s54 offen offset:2048 lds
MAA 120,32,12
TR 68,25,62112
s_add_u32 s54, s54, 196608
MAA 116,32,8
TR 70,25,62624
MAA 100,28,8
RD 60,24,48128
s_add_u32 m0, s55, 27648
MAA 96,28,4
buffer_load_dwordx4 v21, s[16:19], s52 offen sc1 lds
MAA 112,32,4
TR 72,25,63104
MAA 108,32,0
TR 74,25,63616
v_add_f32 v166, v166, v170
MAA 92,28,0
buffer_load_dwordx4 v21, s[16:19], s52 offen offset:1024 sc1 lds
MAA 124,0,36
TR 76,25,63136
MAA 140,0,40
TR 78,25,63648
MAA 144,4,40
TR 80,25,64128
v_add_f32 v167, v167, v171
MAA 128,4,36
buffer_load_dword v22, s[16:19], s52 offen offset:2048 sc1 lds
MAA 132,8,36
TR 82,25,64640
s_add_u32 s52, s52, 16384
MAA 148,8,40
TR 84,25,64160
MAA 152,12,40
buffer_load_dword v27, v14, s[20:23], s44 offen
MAA 136,12,36
TR 86,25,64672
s_add_u32 s44, s44, 1572864
MAA 156,16,36
MAA 160,16,40
s_waitcnt vmcnt(13) lgkmcnt(8)
s_barrier
MAA 60,64,44
ds_read_b128 a[0:3], v23
MAA 76,68,44
RD 4,23,1024
s_add_u32 m0, s56, 117248
MAA 80,68,48
buffer_load_dwordx4 v18, s[20:23], s54 offen lds
MAA 64,64,48
RD 8,23,2304
MAA 68,64,52
RD 12,23,3328
MAA 84,68,52
buffer_load_dwordx4 v19, s[20:23], s54 offen offset:1024 lds
MAA 88,68,56
ds_read_b64_tr_b16 a[20:21], v25
MAA 72,64,56
TR 22,25,512
s_waitcnt lgkmcnt(6)
MAA 104,72,56
buffer_load_dwordx4 v20, s[20:23], s54 offen offset:2048 lds
MAA 120,76,56
TR 24,25,32
s_add_u32 s54, s54, 196608
MAA 116,76,52
TR 26,25,544
MAA 100,72,52
RD 16,24,2048
s_add_u32 m0, s55, 36864
MAA 96,72,48
buffer_load_dwordx4 v21, s[16:19], s52 offen sc1 lds
MAA 112,76,48
TR 28,25,1024
MAA 108,76,44
TR 30,25,1536
MAA 92,72,44
buffer_load_dwordx4 v21, s[16:19], s52 offen offset:1024 sc1 lds
MAA 124,44,80
TR 32,25,1056
MAA 140,44,84
TR 34,25,1568
MAA 144,48,84
TR 36,25,2048
MAA 128,48,80
buffer_load_dword v22, s[16:19], s52 offen offset:2048 sc1 lds
MAA 132,52,80
TR 38,25,2560
s_add_u32 s52, s52, 16384
MAA 148,52,84
TR 40,25,2080
MAA 152,56,84
buffer_load_dwordx4 v[168:171], v26, s[16:19], s75 offen sc1
MAA 136,56,80
TR 42,25,2592
MAA 156,60,80
MAA 160,60,84
s_waitcnt vmcnt(17) lgkmcnt(8)
s_barrier
MAA 60,20,0
RD 44,23,9216
MAA 76,24,0
RD 48,23,10240
s_add_u32 m0, s56, 129664
MAA 80,24,4
buffer_load_dwordx4 v18, s[20:23], s54 offen lds
MAA 64,20,4
RD 52,23,11520
MAA 68,20,8
RD 56,23,12544
MAA 84,24,8
TR 64,25,12416
MAA 88,24,12
buffer_load_dwordx4 v19, s[20:23], s54 offen offset:1024 lds
MAA 72,20,12
TR 66,25,12928
s_waitcnt lgkmcnt(6)
MAA 104,28,12
TR 68,25,12448
MAA 120,32,12
TR 70,25,12960
MAA 116,32,8
buffer_load_dwordx4 v20, s[20:23], s54 offen offset:2048 lds
MAA 100,28,8
RD 60,24,11264
s_add_u32 s54, s54, 196608
MAA 96,28,4
MAA 112,32,4
TR 72,25,13440
s_add_u32 m0, s55, 46080
MAA 108,32,0
buffer_load_dwordx4 v21, s[16:19], s52 offen sc1 lds
MAA 92,28,0
TR 74,25,13952
MAA 124,0,36
TR 76,25,13472
MAA 140,0,40
TR 78,25,13984
MAA 144,4,40
buffer_load_dwordx4 v21, s[16:19], s52 offen offset:1024 sc1 lds
MAA 128,4,36
TR 80,25,14464
MAA 132,8,36
TR 82,25,14976
MAA 148,8,40
TR 84,25,14496
MAA 152,12,40
buffer_load_dword v22, s[16:19], s52 offen offset:2048 sc1 lds
MAA 136,12,36
TR 86,25,15008
s_add_u32 s52, s52, 16384
MAA 156,16,36
MAA 160,16,40
s_waitcnt vmcnt(20) lgkmcnt(8)
s_barrier
MAA 60,64,44
RD 0,23,18432
v_add_f32 v164, v164, v172
MAA 76,68,44
RD 4,23,19456
s_add_u32 m0, s56, 67584
MAA 80,68,48
buffer_load_dwordx4 v18, s[20:23], s54 offen lds
MAA 64,64,48
RD 8,23,20736
MAA 68,64,52
RD 12,23,21760
MAA 84,68,52
TR 20,25,24832
MAA 88,68,56
buffer_load_dwordx4 v19, s[20:23], s54 offen offset:1024 lds
MAA 72,64,56
TR 22,25,25344
s_waitcnt lgkmcnt(6)
MAA 104,72,56
TR 24,25,24864
v_add_f32 v165, v165, v173
MAA 120,76,56
TR 26,25,25376
MAA 116,76,52
buffer_load_dwordx4 v20, s[20:23], s54 offen offset:2048 lds
MAA 100,72,52
RD 16,24,20480
s_add_u32 s54, s54, 196608
MAA 96,72,48
MAA 112,76,48
TR 28,25,25856
s_add_u32 m0, s55, 0
MAA 108,76,44
buffer_load_dwordx4 v21, s[16:19], s52 offen sc1 lds
MAA 92,72,44
TR 30,25,26368
v_add_f32 v166, v166, v174
MAA 124,44,80
TR 32,25,25888
MAA 140,44,84
TR 34,25,26400
MAA 144,48,84
buffer_load_dwordx4 v21, s[16:19], s52 offen offset:1024 sc1 lds
MAA 128,48,80
TR 36,25,26880
MAA 132,52,80
TR 38,25,27392
v_add_f32 v167, v167, v175
MAA 148,52,84
TR 40,25,26912
MAA 152,56,84
buffer_load_dword v22, s[16:19], s52 offen offset:2048 sc1 lds
MAA 136,56,80
TR 42,25,27424
s_add_u32 s52, s52, 16384
MAA 156,60,80
MAA 160,60,84
s_waitcnt vmcnt(20) lgkmcnt(8)
s_barrier
MAA 60,20,0
RD 44,23,27648
MAA 76,24,0
RD 48,23,28672
s_add_u32 m0, s56, 80000
MAA 80,24,4
buffer_load_dwordx4 v18, s[20:23], s54 offen lds
MAA 64,20,4
RD 52,23,29952
MAA 68,20,8
RD 56,23,30976
MAA 84,24,8
buffer_load_dwordx4 v19, s[20:23], s54 offen offset:1024 lds
MAA 88,24,12
TR 64,25,37248
MAA 72,20,12
TR 66,25,37760
s_waitcnt lgkmcnt(6)
MAA 104,28,12
buffer_load_dwordx4 v20, s[20:23], s54 offen offset:2048 lds
MAA 120,32,12
TR 68,25,37280
s_add_u32 s54, s54, 196608
MAA 116,32,8
TR 70,25,37792
MAA 100,28,8
RD 60,24,29696
s_add_u32 m0, s55, 9216
MAA 96,28,4
buffer_load_dwordx4 v21, s[16:19], s52 offen sc1 lds
MAA 112,32,4
TR 72,25,38272
MAA 108,32,0
TR 74,25,38784
MAA 92,28,0
buffer_load_dwordx4 v21, s[16:19], s52 offen offset:1024 sc1 lds
MAA 124,0,36
TR 76,25,38304
MAA 140,0,40
TR 78,25,38816
MAA 144,4,40
TR 80,25,39296
MAA 128,4,36
buffer_load_dword v22, s[16:19], s52 offen offset:2048 sc1 lds
MAA 132,8,36
TR 82,25,39808
s_add_u32 s52, s52, 16384
MAA 148,8,40
TR 84,25,39328
MAA 152,12,40
buffer_load_dwordx4 v[172:175], v26, s[16:19], s75 offen offset:1024 sc1
MAA 136,12,36
TR 86,25,39840
s_add_u32 s75, s75, 2048
MAA 156,16,36
MAA 160,16,40
s_waitcnt vmcnt(20) lgkmcnt(8)
s_barrier
MAA 60,64,44
RD 0,23,36864
MAA 76,68,44
RD 4,23,37888
s_add_u32 m0, s56, 92416
MAA 80,68,48
buffer_load_dwordx4 v18, s[20:23], s54 offen lds
MAA 64,64,48
RD 8,23,39168
MAA 68,64,52
RD 12,23,40192
MAA 84,68,52
TR 20,25,49664
MAA 88,68,56
buffer_load_dwordx4 v19, s[20:23], s54 offen offset:1024 lds
MAA 72,64,56
TR 22,25,50176
s_waitcnt lgkmcnt(6)
MAA 104,72,56
TR 24,25,49696
MAA 120,76,56
TR 26,25,50208
MAA 116,76,52
buffer_load_dwordx4 v20, s[20:23], s54 offen offset:2048 lds
MAA 100,72,52
RD 16,24,38912
s_add_u32 s54, s54, 196608
MAA 96,72,48
MAA 112,76,48
TR 28,25,50688
s_add_u32 m0, s55, 18432
MAA 108,76,44
buffer_load_dwordx4 v21, s[16:19], s52 offen sc1 lds
MAA 92,72,44
TR 30,25,51200
MAA 124,44,80
TR 32,25,50720
MAA 140,44,84
TR 34,25,51232
MAA 144,48,84
buffer_load_dwordx4 v21, s[16:19], s52 offen offset:1024 sc1 lds
MAA 128,48,80
TR 36,25,51712
MAA 132,52,80
TR 38,25,52224
MAA 148,52,84
TR 40,25,51744
MAA 152,56,84
buffer_load_dword v22, s[16:19], s52 offen offset:2048 sc1 lds
MAA 136,56,80
TR 42,25,52256
s_add_u32 s52, s52, 16384
MAA 156,60,80
s_add_u32 s15, s15, 1
MAA 160,60,84
s_cbranch_scc0 .Lk57
s_waitcnt vmcnt(19) lgkmcnt(8)
s_barrier
MAA 60,20,0
RD 44,23,46080
v_add_f32 v164, v164, v168
MAA 76,24,0
RD 48,23,47104
s_add_u32 m0, s56, 104832
MAA 80,24,4
buffer_load_dwordx4 v18, s[20:23], s54 offen lds
MAA 64,20,4
RD 52,23,48384
v_add_f32 v165, v165, v169
MAA 68,20,8
RD 56,23,49408
v_add_f32 v166, v166, v170
MAA 84,24,8
TR 64,25,62080
v_add_f32 v167, v167, v171
MAA 88,24,12
buffer_load_dwordx4 v19, s[20:23], s54 offen offset:1024 lds
MAA 72,20,12
TR 66,25,62592
s_waitcnt lgkmcnt(6)
MAA 104,28,12
TR 68,25,62112
MAA 120,32,12
TR 70,25,62624
MAA 116,32,8
buffer_load_dwordx4 v20, s[20:23], s54 offen offset:2048 lds
MAA 100,28,8
RD 60,24,48128
s_add_u32 s54, s54, 196608
MAA 96,28,4
TR 72,25,63104
s_add_u32 m0, s55, 27648
MAA 112,32,4
TR 74,25,63616
MAA 108,32,0
buffer_load_dwordx4 v21, s[16:19], s52 offen sc1 lds
MAA 92,28,0
TR 76,25,63136
MAA 124,0,36
TR 78,25,63648
MAA 140,0,40
TR 80,25,64128
MAA 144,4,40
buffer_load_dwordx4 v21, s[16:19], s52 offen offset:1024 sc1 lds
MAA 128,4,36
TR 82,25,64640
MAA 132,8,36
TR 84,25,64160
MAA 148,8,40
TR 86,25,64672
MAA 152,12,40
buffer_load_dword v22, s[16:19], s52 offen offset:2048 sc1 lds
MAA 136,12,36
s_add_u32 s52, s52, 16384
MAA 156,16,36
MAA 160,16,40
s_waitcnt vmcnt(19) lgkmcnt(8)
s_barrier
MAA 60,64,44
ds_read_b128 a[0:3], v23
MAA 76,68,44
RD 4,23,1024
s_add_u32 m0, s56, 117248
MAA 80,68,48
buffer_load_dwordx4 v18, s[20:23], s54 offen lds
MAA 64,64,48
RD 8,23,2304
MAA 68,64,52
RD 12,23,3328
MAA 84,68,52
ds_read_b64_tr_b16 a[20:21], v25
MAA 88,68,56
buffer_load_dwordx4 v19, s[20:23], s54 offen offset:1024 lds
MAA 72,64,56
TR 22,25,512
s_waitcnt lgkmcnt(6)
MAA 104,72,56
TR 24,25,32
MAA 120,76,56
TR 26,25,544
MAA 116,76,52
buffer_load_dwordx4 v20, s[20:23], s54 offen offset:2048 lds
MAA 100,72,52
RD 16,24,2048
s_add_u32 s54, s54, 196608
MAA 96,72,48
MAA 112,76,48
TR 28,25,1024
s_add_u32 m0, s55, 36864
.Lpad17:
s_cbranch_execz .Lnopoll52r
MAA 108,76,44
buffer_load_dwordx4 v21, s[16:19], s52 offen sc1 lds
MAA 92,72,44
TR 30,25,1536
MAA 124,44,80
TR 32,25,1056
MAA 140,44,84
TR 34,25,1568
MAA 144,48,84
buffer_load_dwordx4 v21, s[16:19], s52 offen offset:1024 sc1 lds
MAA 128,48,80
TR 36,25,2048
MAA 132,52,80
TR 38,25,2560
MAA 148,52,84
TR 40,25,2080
MAA 152,56,84
buffer_load_dword v22, s[16:19], s52 offen offset:2048 sc1 lds
MAA 136,56,80
TR 42,25,2592
s_add_u32 s52, s52, 16384
MAA 156,60,80
MAA 160,60,84
s_waitcnt vmcnt(19) lgkmcnt(8)
s_barrier
MAA 60,20,0
RD 44,23,9216
s_waitcnt vmcnt(18)
v_add_f32 v164, v164, v172
MAA 76,24,0
RD 48,23,10240
s_add_u32 m0, s56, 129664
MAA 80,24,4
buffer_load_dwordx4 v18, s[20:23], s54 offen lds
MAA 64,20,4
RD 52,23,11520
v_add_f32 v165, v165, v173
MAA 68,20,8
RD 56,23,12544
v_add_f32 v166, v166, v174
MAA 84,24,8
TR 64,25,12416
v_add_f32 v167, v167, v175
MAA 88,24,12
buffer_load_dwordx4 v19, s[20:23], s54 offen offset:1024 lds
MAA 72,20,12
TR 66,25,12928
s_waitcnt lgkmcnt(6)
MAA 104,28,12
TR 68,25,12448
MAA 120,32,12
TR 70,25,12960
MAA 116,32,8
buffer_load_dwordx4 v20, s[20:23], s54 offen offset:2048 lds
MAA 100,28,8
RD 60,24,11264
s_add_u32 s54, s54, 196608
MAA 96,28,4
TR 72,25,13440
s_add_u32 m0, s55, 46080
MAA 112,32,4
TR 74,25,13952
MAA 108,32,0
buffer_load_dwordx4 v21, s[16:19], s52 offen sc1 lds
MAA 92,28,0
TR 76,25,13472
MAA 124,0,36
TR 78,25,13984
MAA 140,0,40
TR 80,25,14464
MAA 144,4,40
buffer_load_dwordx4 v21, s[16:19], s52 offen offset:1024 sc1 lds
MAA 128,4,36
TR 82,25,14976
MAA 132,8,36
TR 84,25,14496
MAA 148,8,40
TR 86,25,15008
MAA 152,12,40
buffer_load_dword v22, s[16:19], s52 offen offset:2048 sc1 lds
MAA 136,12,36
s_add_u32 s52, s52, 16384
v_permlane32_swap_b32 v164, v166
MAA 156,16,36
v_permlane32_swap_b32 v165, v167
MAA 160,16,40
s_waitcnt vmcnt(18) lgkmcnt(8)
s_barrier
MAA 60,64,44
RD 0,23,18432
v_add_f32 v164, v164, v166
MAA 76,68,44
RD 4,23,19456
s_add_u32 m0, s59, 0
MAA 80,68,48
RD 8,23,20736
s_mov_b32 s58, 1048576
MAA 64,64,48
buffer_load_dwordx4 v5, s[24:27], s58 offen lds
MAA 68,64,52
RD 12,23,21760
v_add_f32 v165, v165, v167
MAA 84,68,52
TR 20,25,24832
v_mul_f32 v164, 0xba800000, v164
MAA 88,68,56
TR 22,25,25344
v_mul_f32 v165, 0x3a800000, v165
MAA 72,64,56
buffer_load_dwordx4 v6, s[24:27], s58 offen offset:1024 lds
s_waitcnt lgkmcnt(6)
MAA 104,72,56
TR 24,25,24864
s_add_u32 m0, s59, 58240
MAA 120,76,56
TR 26,25,25376
s_mov_b32 s58, 1966080
MAA 116,76,52
RD 16,24,20480
v_fma_f32 v165, -v164, v164, v165
MAA 100,72,52
buffer_load_dwordx4 v5, s[24:27], s58 offen lds
MAA 96,72,48
TR 28,25,25856
v_max_f32 v165, 0, v165
MAA 112,76,48
TR 30,25,26368
v_add_f32 v165, 0x3727c5ac, v165
MAA 108,76,44
TR 32,25,25888
MAA 92,72,44
buffer_load_dwordx4 v6, s[24:27], s58 offen offset:1024 lds
MAA 124,44,80
TR 34,25,26400
s_add_u32 m0, s59, 66560
MAA 140,44,84
TR 36,25,26880
s_mov_b32 s58, 0
MAA 144,48,84
TR 38,25,27392
MAA 128,48,80
buffer_load_dwordx4 v5, s[24:27], s58 offen lds
MAA 132,52,80
TR 40,25,26912
MAA 148,52,84
TR 42,25,27424
MAA 152,56,84
v_rsq_f32 v166, v165
MAA 136,56,80
buffer_load_dwordx4 v6, s[24:27], s58 offen offset:1024 lds
MAA 156,60,80
MAA 160,60,84
s_waitcnt vmcnt(18) lgkmcnt(8)
s_barrier
MAA 60,20,0
RD 44,23,27648
v_mov_b32 v165, v166
MAA 76,24,0
RD 48,23,28672
s_add_u32 m0, s59, 8320
MAA 80,24,4
RD 52,23,29952
s_mov_b32 s58, 1179648
MAA 64,20,4
buffer_load_dwordx4 v5, s[24:27], s58 offen lds
MAA 68,20,8
RD 56,23,30976
v_mul_f32 v166, 0x3e8293ee, v166
MAA 84,24,8
ds_write_b128 v7, v[164:167]
MAA 88,24,12
TR 64,25,37248
MAA 72,20,12
buffer_load_dwordx4 v6, s[24:27], s58 offen offset:1024 lds
s_waitcnt lgkmcnt(6)
MAA 104,28,12
TR 66,25,37760
s_add_u32 m0, s59, 74880
MAA 120,32,12
TR 68,25,37280
s_mov_b32 s58, 131072
MAA 116,32,8
TR 70,25,37792
MAA 100,28,8
buffer_load_dwordx4 v5, s[24:27], s58 offen lds
MAA 96,28,4
RD 60,24,29696
MAA 112,32,4
TR 72,25,38272
MAA 108,32,0
TR 74,25,38784
MAA 92,28,0
buffer_load_dwordx4 v6, s[24:27], s58 offen offset:1024 lds
MAA 124,0,36
TR 76,25,38304
s_add_u32 m0, s59, 83200
MAA 140,0,40
TR 78,25,38816
s_mov_b32 s58, 262144
MAA 144,4,40
TR 80,25,39296
MAA 128,4,36
buffer_load_dwordx4 v5, s[24:27], s58 offen lds
MAA 132,8,36
TR 82,25,39808
MAA 148,8,40
TR 84,25,39328
MAA 152,12,40
TR 86,25,39840
MAA 136,12,36
buffer_load_dwordx4 v6, s[24:27], s58 offen offset:1024 lds
MAA 156,16,36
MAA 160,16,40
s_waitcnt vmcnt(18) lgkmcnt(8)
s_barrier
MAA 60,64,44
ds_write_b32 v17, v164
MAA 76,68,44
ds_write_b32 v17, v165 offset:1024
s_add_u32 m0, s59, 16640
MAA 80,68,48
RD 0,23,36864
s_mov_b32 s58, 1310720
MAA 64,64,48
buffer_load_dwordx4 v5, s[24:27], s58 offen lds
MAA 68,64,52
RD 4,23,37888
MAA 84,68,52
RD 8,23,39168
MAA 88,68,56
RD 12,23,40192
MAA 72,64,56
TR 20,25,49664
s_waitcnt lgkmcnt(7)
MAA 104,72,56
TR 22,25,50176
MAA 120,76,56
buffer_load_dwordx4 v6, s[24:27], s58 offen offset:1024 lds
MAA 116,76,52
TR 24,25,49696
s_add_u32 m0, s59, 91520
MAA 100,72,52
TR 26,25,50208
s_mov_b32 s58, 393216
MAA 96,72,48
RD 16,24,38912
MAA 112,76,48
TR 28,25,50688
MAA 108,76,44
TR 30,25,51200
MAA 92,72,44
buffer_load_dwordx4 v5, s[24:27], s58 offen lds
MAA 124,44,80
TR 32,25,50720
MAA 140,44,84
TR 34,25,51232
MAA 144,48,84
TR 36,25,51712
MAA 128,48,80
TR 38,25,52224
MAA 132,52,80
TR 40,25,51744
MAA 148,52,84
buffer_load_dwordx4 v6, s[24:27], s58 offen offset:1024 lds
MAA 152,56,84
TR 42,25,52256
MAA 136,56,80
MAA 156,60,80
MAA 160,60,84
s_waitcnt vmcnt(16) lgkmcnt(8)
s_barrier
MAA 60,20,0
RD 44,23,46080
MAA 76,24,0
RD 48,23,47104
s_add_u32 m0, s59, 24960
MAA 80,24,4
RD 52,23,48384
s_mov_b32 s58, 1441792
MAA 64,20,4
buffer_load_dwordx4 v5, s[24:27], s58 offen lds
MAA 68,20,8
RD 56,23,49408
MAA 84,24,8
TR 64,25,62080
MAA 88,24,12
TR 66,25,62592
MAA 72,20,12
buffer_load_dwordx4 v6, s[24:27], s58 offen offset:1024 lds
s_waitcnt lgkmcnt(6)
MAA 104,28,12
TR 68,25,62112
s_add_u32 m0, s59, 99840
MAA 120,32,12
TR 70,25,62624
s_mov_b32 s58, 524288
MAA 116,32,8
RD 60,24,48128
MAA 100,28,8
buffer_load_dwordx4 v5, s[24:27], s58 offen lds
MAA 96,28,4
TR 72,25,63104
MAA 112,32,4
TR 74,25,63616
MAA 108,32,0
TR 76,25,63136
MAA 92,28,0
buffer_load_dwordx4 v6, s[24:27], s58 offen offset:1024 lds
MAA 124,0,36
TR 78,25,63648
s_add_u32 m0, s59, 108160
MAA 140,0,40
TR 80,25,64128
s_mov_b32 s58, 655360
MAA 144,4,40
TR 82,25,64640
MAA 128,4,36
buffer_load_dwordx4 v5, s[24:27], s58 offen lds
MAA 132,8,36
TR 84,25,64160
MAA 148,8,40
TR 86,25,64672
MAA 152,12,40
MAA 136,12,36
buffer_load_dwordx4 v6, s[24:27], s58 offen offset:1024 lds
MAA 156,16,36
MAA 160,16,40
s_waitcnt lgkmcnt(0)
s_barrier
MAA 156,60,80
ds_read_b128 v[232:235], v10 offset:1792
s_add_u32 m0, s59, 33280
MAA 160,60,84
ds_read_b128 v[228:231], v10 offset:1536
s_mov_b32 s58, 1572864
MAA 104,72,56
ds_read_b128 v[224:227], v10 offset:1280
MAA 120,76,56
ds_read_b128 v[220:223], v10 offset:1024
MAA 136,56,80
ds_read_b128 v[240:243], v11 offset:704
MAA 152,56,84
ds_read_b128 v[244:247], v11 offset:1728
MAA 100,72,52
buffer_load_dwordx4 v5, s[24:27], s58 offen lds
MAA 116,76,52
ds_read_b128 v[18:21], v11 offset:448
MAA 96,72,48
ds_read_b128 v[22:25], v11 offset:1472
s_waitcnt lgkmcnt(7)
v_pk_fma_f32 v[104:105], v[36:37], v[232:233], v[104:105] op_sel_hi:[1,0,1]
v_pk_mul_f32 v[104:105], v[104:105], v[232:233] op_sel:[0,1] op_sel_hi:[1,1]
v_pk_fma_f32 v[106:107], v[38:39], v[232:233], v[106:107] op_sel_hi:[1,0,1]
v_pk_mul_f32 v[106:107], v[106:107], v[232:233] op_sel:[0,1] op_sel_hi:[1,1]
v_pk_fma_f32 v[120:121], v[40:41], v[232:233], v[120:121] op_sel_hi:[1,0,1]
v_pk_mul_f32 v[120:121], v[120:121], v[232:233] op_sel:[0,1] op_sel_hi:[1,1]
v_pk_fma_f32 v[122:123], v[42:43], v[232:233], v[122:123] op_sel_hi:[1,0,1]
v_pk_mul_f32 v[122:123], v[122:123], v[232:233] op_sel:[0,1] op_sel_hi:[1,1]
s_waitcnt lgkmcnt(6)
v_pk_fma_f32 v[100:101], v[36:37], v[228:229], v[100:101] op_sel_hi:[1,0,1]
v_pk_mul_f32 v[100:101], v[100:101], v[228:229] op_sel:[0,1] op_sel_hi:[1,1]
s_waitcnt lgkmcnt(3)
v_pk_fma_f32 v[156:157], v[240:241], v[44:45], v[156:157] op_sel_hi:[1,0,1]
v_pk_fma_f32 v[158:159], v[242:243], v[44:45], v[158:159] op_sel_hi:[1,0,1]
v_pk_fma_f32 v[160:161], v[240:241], v[44:45], v[160:161] op_sel:[0,1,0] op_sel_hi:[1,1,1]
v_pk_fma_f32 v[162:163], v[242:243], v[44:45], v[162:163] op_sel:[0,1,0] op_sel_hi:[1,1,1]
s_waitcnt lgkmcnt(2)
v_pk_mul_f32 v[156:157], v[156:157], v[244:245]
v_pk_mul_f32 v[158:159], v[158:159], v[246:247]
v_pk_mul_f32 v[160:161], v[160:161], v[244:245]
v_pk_mul_f32 v[162:163], v[162:163], v[246:247]
v_pk_fma_f32 v[102:103], v[38:39], v[228:229], v[102:103] op_sel_hi:[1,0,1]
v_pk_mul_f32 v[102:103], v[102:103], v[228:229] op_sel:[0,1] op_sel_hi:[1,1]
v_pk_fma_f32 v[116:117], v[40:41], v[228:229], v[116:117] op_sel_hi:[1,0,1]
v_pk_mul_f32 v[116:117], v[116:117], v[228:229] op_sel:[0,1] op_sel_hi:[1,1]
s_waitcnt lgkmcnt(1)
v_pk_fma_f32 v[136:137], v[18:19], v[44:45], v[136:137] op_sel_hi:[1,0,1]
v_pk_fma_f32 v[138:139], v[20:21], v[44:45], v[138:139] op_sel_hi:[1,0,1]
v_pk_fma_f32 v[152:153], v[18:19], v[44:45], v[152:153] op_sel:[0,1,0] op_sel_hi:[1,1,1]
v_pk_fma_f32 v[154:155], v[20:21], v[44:45], v[154:155] op_sel:[0,1,0] op_sel_hi:[1,1,1]
s_waitcnt lgkmcnt(0)
v_pk_mul_f32 v[136:137], v[136:137], v[22:23]
v_pk_mul_f32 v[138:139], v[138:139], v[24:25]
v_pk_mul_f32 v[152:153], v[152:153], v[22:23]
v_pk_mul_f32 v[154:155], v[154:155], v[24:25]
v_pk_fma_f32 v[118:119], v[42:43], v[228:229], v[118:119] op_sel_hi:[1,0,1]
v_pk_mul_f32 v[118:119], v[118:119], v[228:229] op_sel:[0,1] op_sel_hi:[1,1]
v_pk_fma_f32 v[96:97], v[36:37], v[224:225], v[96:97] op_sel_hi:[1,0,1]
v_pk_mul_f32 v[96:97], v[96:97], v[224:225] op_sel:[0,1] op_sel_hi:[1,1]
v_pk_fma_f32 v[98:99], v[38:39], v[224:225], v[98:99] op_sel_hi:[1,0,1]
v_pk_mul_f32 v[98:99], v[98:99], v[224:225] op_sel:[0,1] op_sel_hi:[1,1]
v_cvt_pk_bf16_f32 v236, v156, v157
v_cvt_pk_bf16_f32 v237, v158, v159
MAA 112,76,48
buffer_load_dwordx4 v6, s[24:27], s58 offen offset:1024 lds
MAA 92,72,44
ds_read_b128 v[240:243], v11 offset:384
v_cvt_pk_bf16_f32 v238, v160, v161
MAA 108,76,44
ds_read_b128 v[244:247], v11 offset:1408
v_cvt_pk_bf16_f32 v239, v162, v163
MAA 72,64,56
ds_write_b128 v8, v[236:239] offset:1024
s_add_u32 m0, s59, 41600
MAA 88,68,56
ds_read_b128 v[18:21], v11 offset:320
s_mov_b32 s58, 1703936
buffer_load_dwordx4 v5, s[24:27], s58 offen lds
s_nop 1
v_pk_fma_f32 v[72:73], v[28:29], v[232:233], v[72:73] op_sel_hi:[1,0,1]
v_pk_fma_f32 v[74:75], v[30:31], v[232:233], v[74:75] op_sel_hi:[1,0,1]
s_nop 0
v_pk_fma_f32 v[88:89], v[32:33], v[232:233], v[88:89] op_sel_hi:[1,0,1]
v_pk_fma_f32 v[90:91], v[34:35], v[232:233], v[90:91] op_sel_hi:[1,0,1]
v_pk_fma_f32 v[112:113], v[40:41], v[224:225], v[112:113] op_sel_hi:[1,0,1]
v_pk_mul_f32 v[112:113], v[112:113], v[224:225] op_sel:[0,1] op_sel_hi:[1,1]
v_pk_fma_f32 v[114:115], v[42:43], v[224:225], v[114:115] op_sel_hi:[1,0,1]
v_pk_mul_f32 v[114:115], v[114:115], v[224:225] op_sel:[0,1] op_sel_hi:[1,1]
v_pk_fma_f32 v[92:93], v[36:37], v[220:221], v[92:93] op_sel_hi:[1,0,1]
v_pk_mul_f32 v[92:93], v[92:93], v[220:221] op_sel:[0,1] op_sel_hi:[1,1]
v_pk_fma_f32 v[94:95], v[38:39], v[220:221], v[94:95] op_sel_hi:[1,0,1]
v_pk_mul_f32 v[94:95], v[94:95], v[220:221] op_sel:[0,1] op_sel_hi:[1,1]
v_pk_fma_f32 v[108:109], v[40:41], v[220:221], v[108:109] op_sel_hi:[1,0,1]
v_pk_mul_f32 v[108:109], v[108:109], v[220:221] op_sel:[0,1] op_sel_hi:[1,1]
v_pk_fma_f32 v[110:111], v[42:43], v[220:221], v[110:111] op_sel_hi:[1,0,1]
v_pk_mul_f32 v[110:111], v[110:111], v[220:221] op_sel:[0,1] op_sel_hi:[1,1]
v_cvt_pk_bf16_f32 v196, v104, v105
v_cvt_pk_bf16_f32 v197, v106, v107
MAA 132,52,80
buffer_load_dwordx4 v6, s[24:27], s58 offen offset:1024 lds
MAA 148,52,84
s_waitcnt lgkmcnt(1)
s_barrier
ds_read_b128 v[180:183], v9
MAA 68,64,52
ds_read_b64 v[200:201], v9 offset:1024
s_add_u32 m0, s59, 49920
MAA 84,68,52
ds_read_b64 v[210:211], v9 offset:1032
s_mov_b32 s58, 1835008
MAA 128,48,80
buffer_load_dwordx4 v5, s[24:27], s58 offen lds
v_cvt_pk_bf16_f32 v198, v120, v121
v_cvt_pk_bf16_f32 v199, v122, v123
v_cvt_pk_bf16_f32 v208, v136, v137
v_pk_fma_f32 v[132:133], v[240:241], v[44:45], v[132:133] op_sel_hi:[1,0,1]
v_pk_mul_f32 v[132:133], v[132:133], v[244:245]
v_pk_fma_f32 v[134:135], v[242:243], v[44:45], v[134:135] op_sel_hi:[1,0,1]
v_pk_mul_f32 v[134:135], v[134:135], v[246:247]
v_pk_fma_f32 v[148:149], v[240:241], v[44:45], v[148:149] op_sel:[0,1,0] op_sel_hi:[1,1,1]
v_pk_mul_f32 v[148:149], v[148:149], v[244:245]
v_pk_fma_f32 v[150:151], v[242:243], v[44:45], v[150:151] op_sel:[0,1,0] op_sel_hi:[1,1,1]
v_pk_mul_f32 v[150:151], v[150:151], v[246:247]
v_pk_fma_f32 v[68:69], v[28:29], v[228:229], v[68:69] op_sel_hi:[1,0,1]
v_pk_fma_f32 v[70:71], v[30:31], v[228:229], v[70:71] op_sel_hi:[1,0,1]
v_pk_fma_f32 v[84:85], v[32:33], v[228:229], v[84:85] op_sel_hi:[1,0,1]
v_pk_fma_f32 v[86:87], v[34:35], v[228:229], v[86:87] op_sel_hi:[1,0,1]
s_waitcnt lgkmcnt(3)
v_pk_fma_f32 v[128:129], v[18:19], v[44:45], v[128:129] op_sel_hi:[1,0,1]
v_pk_fma_f32 v[130:131], v[20:21], v[44:45], v[130:131] op_sel_hi:[1,0,1]
v_cvt_pk_bf16_f32 v209, v138, v139
v_cvt_pk_bf16_f32 v218, v152, v153
MAA 144,48,84
buffer_load_dwordx4 v6, s[24:27], s58 offen offset:1024 lds
MAA 64,64,48
ds_read_b128 v[22:25], v11 offset:1344
s_add_u32 m0, s59, 116480
MAA 80,68,48
ds_read_b128 v[240:243], v11 offset:256
s_mov_b32 s58, 786432
MAA 124,44,80
ds_read_b128 v[244:247], v11 offset:1280
v_cvt_pk_bf16_f32 v219, v154, v155
MAA 140,44,84
buffer_load_dwordx4 v5, s[24:27], s58 offen lds
MAA 60,64,44
v_cvt_pk_bf16_f32 v192, v100, v101
v_cvt_pk_bf16_f32 v193, v102, v103
MAA 76,68,44
v_cvt_pk_bf16_f32 v194, v116, v117
v_cvt_pk_bf16_f32 v195, v118, v119
v_cvt_pk_bf16_f32 v176, v72, v73
v_cvt_pk_bf16_f32 v177, v74, v75
v_cvt_pk_bf16_f32 v178, v88, v89
v_cvt_pk_bf16_f32 v179, v90, v91
v_pk_fma_f32 v[144:145], v[18:19], v[44:45], v[144:145] op_sel:[0,1,0] op_sel_hi:[1,1,1]
v_pk_fma_f32 v[146:147], v[20:21], v[44:45], v[146:147] op_sel:[0,1,0] op_sel_hi:[1,1,1]
v_pk_fma_f32 v[64:65], v[28:29], v[224:225], v[64:65] op_sel_hi:[1,0,1]
v_pk_fma_f32 v[66:67], v[30:31], v[224:225], v[66:67] op_sel_hi:[1,0,1]
v_pk_fma_f32 v[80:81], v[32:33], v[224:225], v[80:81] op_sel_hi:[1,0,1]
s_waitcnt lgkmcnt(2)
v_pk_mul_f32 v[128:129], v[128:129], v[22:23]
v_pk_mul_f32 v[130:131], v[130:131], v[24:25]
v_pk_mul_f32 v[144:145], v[144:145], v[22:23]
v_pk_mul_f32 v[146:147], v[146:147], v[24:25]
v_pk_fma_f32 v[82:83], v[34:35], v[224:225], v[82:83] op_sel_hi:[1,0,1]
s_waitcnt lgkmcnt(1)
v_pk_fma_f32 v[124:125], v[240:241], v[44:45], v[124:125] op_sel_hi:[1,0,1]
v_pk_fma_f32 v[126:127], v[242:243], v[44:45], v[126:127] op_sel_hi:[1,0,1]
v_pk_fma_f32 v[140:141], v[240:241], v[44:45], v[140:141] op_sel:[0,1,0] op_sel_hi:[1,1,1]
s_waitcnt lgkmcnt(0)
v_pk_mul_f32 v[124:125], v[124:125], v[244:245]
v_pk_mul_f32 v[126:127], v[126:127], v[246:247]
v_pk_mul_f32 v[140:141], v[140:141], v[244:245]
v_pk_fma_f32 v[142:143], v[242:243], v[44:45], v[142:143] op_sel:[0,1,0] op_sel_hi:[1,1,1]
v_pk_mul_f32 v[142:143], v[142:143], v[246:247]
v_pk_fma_f32 v[60:61], v[28:29], v[220:221], v[60:61] op_sel_hi:[1,0,1]
v_pk_fma_f32 v[62:63], v[30:31], v[220:221], v[62:63] op_sel_hi:[1,0,1]
v_pk_fma_f32 v[76:77], v[32:33], v[220:221], v[76:77] op_sel_hi:[1,0,1]
v_pk_fma_f32 v[78:79], v[34:35], v[220:221], v[78:79] op_sel_hi:[1,0,1]
v_cvt_pk_bf16_f32 v206, v132, v133
v_cvt_pk_bf16_f32 v207, v134, v135
v_mfma_f32_16x16x32_bf16 v[104:107], v[192:195], v[176:179], v[46:49]
buffer_load_dwordx4 v6, s[24:27], s58 offen offset:1024 lds
v_mfma_f32_16x16x32_bf16 v[120:123], v[196:199], v[176:179], v[50:53]
s_add_u32 m0, s59, 124800
s_mov_b32 s58, 917504
v_cvt_pk_bf16_f32 v216, v148, v149
v_cvt_pk_bf16_f32 v217, v150, v151
s_nop 1
v_max3_f32 v88, v104, v105, v106
v_cvt_pk_bf16_f32 v188, v96, v97
v_cvt_pk_bf16_f32 v189, v98, v99
v_cvt_pk_bf16_f32 v190, v112, v113
v_max3_f32 v89, v107, v120, v121
v_max3_f32 v88, v88, v122, v123
v_max_f32 v90, v88, v89
v_max_f32 v89, v88, v89
buffer_load_dwordx4 v5, s[24:27], s58 offen lds
s_nop 0
v_permlane16_swap_b32 v90, v89
v_cvt_pk_bf16_f32 v191, v114, v115
v_max_f32 v88, v90, v89
v_max_f32 v89, v90, v89
v_cvt_pk_bf16_f32 v172, v68, v69
v_cvt_pk_bf16_f32 v173, v70, v71
v_permlane32_swap_b32 v88, v89
v_cvt_pk_bf16_f32 v174, v84, v85
.Lpad18:
s_cbranch_execz .Lnopoll52r
v_max_f32 v88, v88, v89
v_mul_f32 v88, v88, v234
v_pk_fma_f32 v[104:105], v[104:105], v[234:235], v[88:89] op_sel_hi:[1,0,0] neg_lo:[0,0,1] neg_hi:[0,0,1]
buffer_load_dwordx4 v6, s[24:27], s58 offen offset:1024 lds
v_pk_fma_f32 v[106:107], v[106:107], v[234:235], v[88:89] op_sel_hi:[1,0,0] neg_lo:[0,0,1] neg_hi:[0,0,1]
v_pk_fma_f32 v[120:121], v[120:121], v[234:235], v[88:89] op_sel_hi:[1,0,0] neg_lo:[0,0,1] neg_hi:[0,0,1]
v_pk_fma_f32 v[122:123], v[122:123], v[234:235], v[88:89] op_sel_hi:[1,0,0] neg_lo:[0,0,1] neg_hi:[0,0,1]
v_exp_f32 v104, v104
v_exp_f32 v105, v105
v_exp_f32 v106, v106
v_exp_f32 v107, v107
v_exp_f32 v120, v120
v_exp_f32 v121, v121
v_exp_f32 v122, v122
v_exp_f32 v123, v123
v_cvt_pk_bf16_f32 v72, v104, v105
v_cvt_pk_bf16_f32 v73, v106, v107
v_cvt_pk_bf16_f32 v74, v120, v121
v_cvt_pk_bf16_f32 v75, v122, v123
v_cvt_pk_bf16_f32 v175, v86, v87
v_cvt_pk_bf16_f32 v204, v128, v129
v_mfma_f32_16x16x32_bf16 v[88:91], v[248:251], v[72:75], 0
v_cvt_pk_bf16_f32 v205, v130, v131
v_cvt_pk_bf16_f32 v214, v144, v145
v_mfma_f32_16x16x32_bf16 v[104:107], v[206:209], v[72:75], 0
v_cvt_pk_bf16_f32 v215, v146, v147
v_cvt_pk_bf16_f32 v184, v92, v93
v_mfma_f32_16x16x32_bf16 v[120:123], v[216:219], v[72:75], 0
s_nop 1
v_rcp_f32 v88, v88
v_mfma_f32_16x16x32_bf16 v[100:103], v[188:191], v[172:175], v[46:49]
v_cvt_pk_bf16_f32 v185, v94, v95
v_cvt_pk_bf16_f32 v186, v108, v109
v_mfma_f32_16x16x32_bf16 v[116:119], v[192:195], v[172:175], v[50:53]
v_cvt_pk_bf16_f32 v187, v110, v111
v_cvt_pk_bf16_f32 v168, v64, v65
v_cvt_pk_bf16_f32 v169, v66, v67
s_nop 1
v_max3_f32 v84, v100, v101, v102
v_cvt_pk_bf16_f32 v170, v80, v81
v_pk_mul_f32 v[104:105], v[104:105], v[88:89] op_sel_hi:[1,0]
v_pk_mul_f32 v[106:107], v[106:107], v[88:89] op_sel_hi:[1,0]
v_pk_mul_f32 v[120:121], v[120:121], v[88:89] op_sel_hi:[1,0]
v_pk_mul_f32 v[122:123], v[122:123], v[88:89] op_sel_hi:[1,0]
v_cvt_pk_bf16_f32 v176, v104, v105
v_cvt_pk_bf16_f32 v177, v106, v107
v_cvt_pk_bf16_f32 v178, v120, v121
v_cvt_pk_bf16_f32 v179, v122, v123
buffer_store_dwordx4 v[176:179], v4, s[16:19], s74 offen offset:3072 sc1
v_max3_f32 v85, v103, v116, v117
v_max3_f32 v84, v84, v118, v119
v_max_f32 v86, v84, v85
v_max_f32 v85, v84, v85
v_cvt_pk_bf16_f32 v171, v82, v83
v_cvt_pk_bf16_f32 v202, v124, v125
v_permlane16_swap_b32 v86, v85
v_mfma_f32_16x16x32_bf16 v[96:99], v[184:187], v[168:171], v[46:49]
v_max_f32 v84, v86, v85
v_max_f32 v85, v86, v85
v_mfma_f32_16x16x32_bf16 v[112:115], v[188:191], v[168:171], v[50:53]
s_nop 0
v_permlane32_swap_b32 v84, v85
v_cvt_pk_bf16_f32 v203, v126, v127
v_max_f32 v84, v84, v85
v_mul_f32 v84, v84, v230
v_pk_fma_f32 v[100:101], v[100:101], v[230:231], v[84:85] op_sel_hi:[1,0,0] neg_lo:[0,0,1] neg_hi:[0,0,1]
v_pk_fma_f32 v[102:103], v[102:103], v[230:231], v[84:85] op_sel_hi:[1,0,0] neg_lo:[0,0,1] neg_hi:[0,0,1]
v_pk_fma_f32 v[116:117], v[116:117], v[230:231], v[84:85] op_sel_hi:[1,0,0] neg_lo:[0,0,1] neg_hi:[0,0,1]
v_pk_fma_f32 v[118:119], v[118:119], v[230:231], v[84:85] op_sel_hi:[1,0,0] neg_lo:[0,0,1] neg_hi:[0,0,1]
v_exp_f32 v100, v100
v_exp_f32 v101, v101
v_exp_f32 v102, v102
v_exp_f32 v103, v103
v_exp_f32 v116, v116
v_exp_f32 v117, v117
v_exp_f32 v118, v118
v_exp_f32 v119, v119
v_cvt_pk_bf16_f32 v68, v100, v101
v_cvt_pk_bf16_f32 v69, v102, v103
v_cvt_pk_bf16_f32 v70, v116, v117
v_cvt_pk_bf16_f32 v71, v118, v119
v_cvt_pk_bf16_f32 v212, v140, v141
v_cvt_pk_bf16_f32 v213, v142, v143
v_mfma_f32_16x16x32_bf16 v[84:87], v[248:251], v[68:71], 0
v_max3_f32 v80, v96, v97, v98
v_max3_f32 v81, v99, v112, v113
v_mfma_f32_16x16x32_bf16 v[100:103], v[204:207], v[68:71], 0
v_max3_f32 v80, v80, v114, v115
v_max_f32 v82, v80, v81
v_mfma_f32_16x16x32_bf16 v[116:119], v[214:217], v[68:71], 0
s_nop 1
v_rcp_f32 v84, v84
v_max_f32 v81, v80, v81
v_cvt_pk_bf16_f32 v164, v60, v61
v_cvt_pk_bf16_f32 v165, v62, v63
v_pk_mul_f32 v[100:101], v[100:101], v[84:85] op_sel_hi:[1,0]
v_pk_mul_f32 v[102:103], v[102:103], v[84:85] op_sel_hi:[1,0]
v_pk_mul_f32 v[116:117], v[116:117], v[84:85] op_sel_hi:[1,0]
v_pk_mul_f32 v[118:119], v[118:119], v[84:85] op_sel_hi:[1,0]
v_cvt_pk_bf16_f32 v172, v100, v101
v_cvt_pk_bf16_f32 v173, v102, v103
v_cvt_pk_bf16_f32 v174, v116, v117
v_cvt_pk_bf16_f32 v175, v118, v119
buffer_store_dwordx4 v[172:175], v4, s[16:19], s74 offen offset:2048 sc1
v_permlane16_swap_b32 v82, v81
v_cvt_pk_bf16_f32 v166, v76, v77
v_max_f32 v80, v82, v81
v_max_f32 v81, v82, v81
v_cvt_pk_bf16_f32 v167, v78, v79
s_nop 0
v_permlane32_swap_b32 v80, v81
v_mfma_f32_16x16x32_bf16 v[92:95], v[180:183], v[164:167], v[46:49]
v_max_f32 v80, v80, v81
v_mul_f32 v80, v80, v226
v_mfma_f32_16x16x32_bf16 v[108:111], v[184:187], v[164:167], v[50:53]
s_nop 4
v_max3_f32 v76, v92, v93, v94
v_pk_fma_f32 v[96:97], v[96:97], v[226:227], v[80:81] op_sel_hi:[1,0,0] neg_lo:[0,0,1] neg_hi:[0,0,1]
v_pk_fma_f32 v[98:99], v[98:99], v[226:227], v[80:81] op_sel_hi:[1,0,0] neg_lo:[0,0,1] neg_hi:[0,0,1]
v_pk_fma_f32 v[112:113], v[112:113], v[226:227], v[80:81] op_sel_hi:[1,0,0] neg_lo:[0,0,1] neg_hi:[0,0,1]
v_pk_fma_f32 v[114:115], v[114:115], v[226:227], v[80:81] op_sel_hi:[1,0,0] neg_lo:[0,0,1] neg_hi:[0,0,1]
v_exp_f32 v96, v96
v_exp_f32 v97, v97
v_exp_f32 v98, v98
v_exp_f32 v99, v99
v_exp_f32 v112, v112
v_exp_f32 v113, v113
v_exp_f32 v114, v114
v_exp_f32 v115, v115
v_cvt_pk_bf16_f32 v64, v96, v97
v_cvt_pk_bf16_f32 v65, v98, v99
v_cvt_pk_bf16_f32 v66, v112, v113
v_cvt_pk_bf16_f32 v67, v114, v115
v_max3_f32 v77, v95, v108, v109
v_max3_f32 v76, v76, v110, v111
v_mfma_f32_16x16x32_bf16 v[80:83], v[248:251], v[64:67], 0
v_max_f32 v78, v76, v77
v_max_f32 v77, v76, v77
v_mfma_f32_16x16x32_bf16 v[96:99], v[202:205], v[64:67], 0
s_nop 0
v_permlane16_swap_b32 v78, v77
v_mfma_f32_16x16x32_bf16 v[112:115], v[212:215], v[64:67], 0
s_nop 1
v_rcp_f32 v80, v80
v_max_f32 v76, v78, v77
v_max_f32 v77, v78, v77
v_pk_mul_f32 v[96:97], v[96:97], v[80:81] op_sel_hi:[1,0]
v_pk_mul_f32 v[98:99], v[98:99], v[80:81] op_sel_hi:[1,0]
s_nop 0
v_pk_mul_f32 v[112:113], v[112:113], v[80:81] op_sel_hi:[1,0]
v_pk_mul_f32 v[114:115], v[114:115], v[80:81] op_sel_hi:[1,0]
v_cvt_pk_bf16_f32 v168, v96, v97
v_cvt_pk_bf16_f32 v169, v98, v99
v_cvt_pk_bf16_f32 v170, v112, v113
v_cvt_pk_bf16_f32 v171, v114, v115
buffer_store_dwordx4 v[168:171], v4, s[16:19], s74 offen offset:1024 sc1
v_permlane32_swap_b32 v76, v77
v_max_f32 v76, v76, v77
v_mul_f32 v76, v76, v222
v_pk_fma_f32 v[92:93], v[92:93], v[222:223], v[76:77] op_sel_hi:[1,0,0] neg_lo:[0,0,1] neg_hi:[0,0,1]
v_pk_fma_f32 v[94:95], v[94:95], v[222:223], v[76:77] op_sel_hi:[1,0,0] neg_lo:[0,0,1] neg_hi:[0,0,1]
v_pk_fma_f32 v[108:109], v[108:109], v[222:223], v[76:77] op_sel_hi:[1,0,0] neg_lo:[0,0,1] neg_hi:[0,0,1]
v_pk_fma_f32 v[110:111], v[110:111], v[222:223], v[76:77] op_sel_hi:[1,0,0] neg_lo:[0,0,1] neg_hi:[0,0,1]
v_exp_f32 v92, v92
v_exp_f32 v93, v93
v_exp_f32 v94, v94
v_exp_f32 v95, v95
v_exp_f32 v108, v108
v_exp_f32 v109, v109
v_exp_f32 v110, v110
v_exp_f32 v111, v111
v_cvt_pk_bf16_f32 v60, v92, v93
v_cvt_pk_bf16_f32 v61, v94, v95
v_cvt_pk_bf16_f32 v62, v108, v109
v_cvt_pk_bf16_f32 v63, v110, v111
s_nop 1
v_mfma_f32_16x16x32_bf16 v[76:79], v[248:251], v[60:63], 0
v_mfma_f32_16x16x32_bf16 v[92:95], v[200:203], v[60:63], 0
v_mfma_f32_16x16x32_bf16 v[108:111], v[210:213], v[60:63], 0
s_nop 5
v_rcp_f32 v76, v76
s_nop 0
v_pk_mul_f32 v[92:93], v[92:93], v[76:77] op_sel_hi:[1,0]
v_pk_mul_f32 v[94:95], v[94:95], v[76:77] op_sel_hi:[1,0]
v_pk_mul_f32 v[108:109], v[108:109], v[76:77] op_sel_hi:[1,0]
v_pk_mul_f32 v[110:111], v[110:111], v[76:77] op_sel_hi:[1,0]
v_cvt_pk_bf16_f32 v164, v92, v93
v_cvt_pk_bf16_f32 v165, v94, v95
v_cvt_pk_bf16_f32 v166, v108, v109
v_cvt_pk_bf16_f32 v167, v110, v111
buffer_store_dwordx4 v[164:167], v4, s[16:19], s74 offen sc1
s_nop 1
.Lqkve55:
.Lpad19:
s_cbranch_execz .Lnopoll52r
s_lshl_b32 s62, s3, 11
s_add_u32 s62, s62, s84
v_lshl_add_u32 v4, v1, 4, s62
v_lshrrev_b32 v2, 3, v1
v_cmp_eq_u32 vcc, 3, v2
v_add_u32 v2, 67108480, v4
s_nop 0
v_cndmask_b32 v4, v4, v2, vcc
v_bfe_u32 v5, v1, 3, 1
v_lshrrev_b32 v2, 4, v1
v_lshl_add_u32 v5, v2, 3, v5
s_lshl_b32 s62, s3, 1
v_add_u32 v5, s62, v5
v_mul_u32_u24 v5, 2048, v5
v_and_b32 v2, 7, v1
v_lshl_add_u32 v5, v2, 4, v5
s_lshl_b32 s62, s7, 7
v_add_u32 v5, s62, v5
v_add_u32 v6, 64512, v5
v_bfe_u32 v8, v1, 3, 2
v_mul_u32_u24 v8, 2080, v8
v_bfe_u32 v2, v1, 2, 1
v_lshl_add_u32 v8, v2, 7, v8
v_bfe_u32 v2, v1, 5, 1
v_lshl_add_u32 v8, v2, 8, v8
v_and_b32 v2, 3, v1
v_lshl_add_u32 v8, v2, 3, v8
s_mov_b32 s57, 66560
v_add_u32 v7, s57, v8
s_mov_b32 s52, 37748736
s_mov_b32 s53, 37765120
s_mov_b32 s54, 2097152
s_mul_i32 s56, s3, 2080
v_accvgpr_read_b32 v32, a224
v_accvgpr_read_b32 v33, a225
v_accvgpr_read_b32 v34, a226
v_accvgpr_read_b32 v35, a227
v_accvgpr_read_b32 v36, a228
v_accvgpr_read_b32 v37, a229
v_accvgpr_read_b32 v38, a230
v_accvgpr_read_b32 v39, a231
v_accvgpr_read_b32 v40, a232
v_accvgpr_read_b32 v41, a233
v_accvgpr_read_b32 v42, a234
v_accvgpr_read_b32 v43, a235
v_accvgpr_read_b32 v44, a236
v_accvgpr_read_b32 v45, a237
v_accvgpr_read_b32 v46, a238
v_accvgpr_read_b32 v47, a239
v_accvgpr_read_b32 v48, a240
v_accvgpr_read_b32 v49, a241
v_accvgpr_read_b32 v50, a242
v_accvgpr_read_b32 v51, a243
v_accvgpr_read_b32 v52, a244
v_accvgpr_read_b32 v53, a245
v_accvgpr_read_b32 v54, a246
v_accvgpr_read_b32 v55, a247
v_accvgpr_read_b32 v56, a248
v_accvgpr_read_b32 v57, a249
v_accvgpr_read_b32 v58, a250
v_accvgpr_read_b32 v59, a251
v_accvgpr_read_b32 v60, a252
v_accvgpr_read_b32 v61, a253
v_accvgpr_read_b32 v62, a254
v_accvgpr_read_b32 v63, a255
s_lshl_b32 s62, s49, 3
s_add_u32 s62, s62, s48
s_mul_i32 s62, s62, 28672
s_add_u32 s62, s62, s51
v_lshrrev_b32 v12, 4, v1
v_mul_u32_u24 v12, 57344, v12
v_and_b32 v2, 15, v1
v_lshl_add_u32 v12, v2, 4, v12
v_add_u32 v12, s62, v12
v_add_u32 v13, 6112, v12
v_add_u32 v14, 12224, v12
v_add_u32 v15, 18336, v12
s_mul_i32 s59, s3, 4224
s_mov_b32 s58, 0
s_lshl_b32 s62, s8, 10
s_add_u32 s62, s62, 30490624
s_lshl_b32 s64, s6, 10
s_add_u32 s64, s64, 30490624
s_lshr_b32 s67, s5, 2
s_and_b32 s67, s67, 3
s_lshl_b32 s67, s67, 7
s_add_u32 s64, s64, s67
v_lshl_add_u32 v252, v1, 7, s62
v_mov_b32 v253, s64
v_mov_b32 v255, 1
s_waitcnt vmcnt(0) lgkmcnt(0)
s_cmp_lg_u32 s3, 1
s_barrier
s_cbranch_scc1 .Lnopoll59
s_mov_b64 exec, 15
buffer_atomic_add v255, v252, s[16:19], 0 offen
s_mov_b64 exec, 1
v_mov_b32 v254, 0
buffer_atomic_add v254, v253, s[16:19], 0 offen sc0
s_sleep 5
s_mov_b32 s15, 0
.Lpoll58:
v_mov_b32 v255, 0
buffer_atomic_add v255, v253, s[16:19], 0 offen sc0
s_waitcnt vmcnt(1)
v_cmp_gt_u32 vcc, 16, v254
s_add_u32 s15, s15, 1
s_cbranch_vccz .Lnopoll59r
v_mov_b32 v254, 0
buffer_atomic_add v254, v253, s[16:19], 0 offen sc0
s_waitcnt vmcnt(1)
v_cmp_gt_u32 vcc, 16, v255
s_add_u32 s15, s15, 1
s_cbranch_vccz .Lnopoll59r
s_cmp_le_u32 s15, 100000
s_cbranch_scc1 .Lpoll58
s_branch .Lnopoll59r
.Lnopoll59:
s_mov_b64 exec, 0
s_cmp_eq_u32 s3, 2
s_cbranch_scc1 .Lpad20
s_cmp_eq_u32 s3, 3
s_cbranch_scc1 .Lpad21
s_branch .Lpad22
.Lnopoll59r:
s_mov_b64 exec, -1
s_barrier
buffer_load_dwordx4 v[64:67], v4, s[16:19], s52 offen sc1
buffer_load_dwordx4 v[68:71], v4, s[16:19], s52 offen offset:1024 sc1
s_add_u32 s52, s52, 32768
buffer_load_dwordx4 v[72:75], v4, s[16:19], s53 offen sc1
buffer_load_dwordx4 v[76:79], v4, s[16:19], s53 offen offset:1024 sc1
s_add_u32 s53, s53, 32768
buffer_load_dwordx4 v[80:83], v4, s[16:19], s52 offen sc1
buffer_load_dwordx4 v[84:87], v4, s[16:19], s52 offen offset:1024 sc1
s_add_u32 s52, s52, 32768
buffer_load_dwordx4 v[88:91], v4, s[16:19], s53 offen sc1
buffer_load_dwordx4 v[92:95], v4, s[16:19], s53 offen offset:1024 sc1
s_add_u32 s53, s53, 32768
buffer_load_dwordx4 v[96:99], v4, s[16:19], s52 offen sc1
buffer_load_dwordx4 v[100:103], v4, s[16:19], s52 offen offset:1024 sc1
s_add_u32 s52, s52, 32768
buffer_load_dwordx4 v[104:107], v4, s[16:19], s53 offen sc1
buffer_load_dwordx4 v[108:111], v4, s[16:19], s53 offen offset:1024 sc1
s_add_u32 s53, s53, 32768
ds_read_b64_tr_b16 a[0:1], v7
TR 2,7,512
TR 16,7,1024
TR 18,7,1536
TR 4,7,32
TR 6,7,544
TR 20,7,1056
TR 22,7,1568
TR 8,7,64
TR 10,7,576
TR 24,7,1088
TR 26,7,1600
TR 12,7,96
TR 14,7,608
TR 28,7,1120
TR 30,7,1632
s_waitcnt vmcnt(8) lgkmcnt(14)
MAV 32,0,64
TR 32,7,8320
TR 34,7,8832
s_waitcnt lgkmcnt(14)
MAV 32,16,72
buffer_load_dwordx4 v[112:115], v4, s[16:19], s52 offen sc1
MAV 48,16,76
TR 48,7,9344
TR 50,7,9856
MAV 48,0,68
TR 36,7,8352
s_waitcnt lgkmcnt(15)
MAV 52,4,68
buffer_load_dwordx4 v[116:119], v4, s[16:19], s52 offen offset:1024 sc1
s_waitcnt lgkmcnt(13)
MAV 52,20,76
TR 38,7,8864
s_add_u32 s52, s52, 32768
MAV 36,20,72
TR 52,7,9376
MAV 36,4,64
TR 54,7,9888
s_waitcnt lgkmcnt(14)
MAV 40,8,64
buffer_load_dwordx4 v[120:123], v4, s[16:19], s53 offen sc1
s_waitcnt lgkmcnt(12)
MAV 40,24,72
TR 40,7,8384
TR 42,7,8896
MAV 56,24,76
TR 56,7,9408
MAV 56,8,68
TR 58,7,9920
TR 44,7,8416
s_waitcnt lgkmcnt(15)
MAV 60,12,68
buffer_load_dwordx4 v[124:127], v4, s[16:19], s53 offen offset:1024 sc1
s_waitcnt lgkmcnt(13)
MAV 60,28,76
s_add_u32 s53, s53, 32768
MAV 44,28,72
TR 46,7,8928
TR 60,7,9440
MAV 44,12,64
TR 62,7,9952
s_waitcnt vmcnt(8) lgkmcnt(8)
MAV 32,32,80
TR 0,7,16640
TR 2,7,17152
MAV 32,48,88
buffer_load_dwordx4 v[64:67], v4, s[16:19], s52 offen sc1
MAV 48,48,92
TR 16,7,17664
TR 18,7,18176
MAV 48,32,84
TR 4,7,16672
MAV 52,36,84
buffer_load_dwordx4 v[68:71], v4, s[16:19], s52 offen offset:1024 sc1
MAV 52,52,92
TR 6,7,17184
s_add_u32 s52, s52, 32768
MAV 36,52,88
TR 20,7,17696
MAV 36,36,80
TR 22,7,18208
s_waitcnt lgkmcnt(8)
MAV 40,40,80
buffer_load_dwordx4 v[72:75], v4, s[16:19], s53 offen sc1
MAV 40,56,88
TR 8,7,16704
TR 10,7,17216
MAV 56,56,92
TR 24,7,17728
MAV 56,40,84
TR 26,7,18240
TR 12,7,16736
MAV 60,44,84
buffer_load_dwordx4 v[76:79], v4, s[16:19], s53 offen offset:1024 sc1
MAV 60,60,92
s_add_u32 s53, s53, 32768
MAV 44,60,88
TR 14,7,17248
TR 28,7,17760
MAV 44,44,80
TR 30,7,18272
s_waitcnt vmcnt(8) lgkmcnt(8)
MAV 32,0,96
TR 32,7,24960
TR 34,7,25472
MAV 32,16,104
buffer_load_dwordx4 v[80:83], v4, s[16:19], s52 offen sc1
MAV 48,16,108
TR 48,7,25984
TR 50,7,26496
MAV 48,0,100
TR 36,7,24992
MAV 52,4,100
buffer_load_dwordx4 v[84:87], v4, s[16:19], s52 offen offset:1024 sc1
MAV 52,20,108
TR 38,7,25504
s_add_u32 s52, s52, 32768
MAV 36,20,104
TR 52,7,26016
MAV 36,4,96
TR 54,7,26528
s_waitcnt lgkmcnt(8)
MAV 40,8,96
buffer_load_dwordx4 v[88:91], v4, s[16:19], s53 offen sc1
MAV 40,24,104
TR 40,7,25024
TR 42,7,25536
MAV 56,24,108
TR 56,7,26048
MAV 56,8,100
TR 58,7,26560
TR 44,7,25056
MAV 60,12,100
buffer_load_dwordx4 v[92:95], v4, s[16:19], s53 offen offset:1024 sc1
MAV 60,28,108
s_add_u32 s53, s53, 32768
MAV 44,28,104
TR 46,7,25568
TR 60,7,26080
MAV 44,12,96
TR 62,7,26592
s_waitcnt vmcnt(8) lgkmcnt(8)
MAV 32,32,112
TR 0,7,33280
TR 2,7,33792
MAV 32,48,120
buffer_load_dwordx4 v[96:99], v4, s[16:19], s52 offen sc1
MAV 48,48,124
TR 16,7,34304
TR 18,7,34816
MAV 48,32,116
TR 4,7,33312
MAV 52,36,116
buffer_load_dwordx4 v[100:103], v4, s[16:19], s52 offen offset:1024 sc1
MAV 52,52,124
TR 6,7,33824
s_add_u32 s52, s52, 32768
MAV 36,52,120
TR 20,7,34336
MAV 36,36,112
TR 22,7,34848
s_waitcnt lgkmcnt(8)
MAV 40,40,112
buffer_load_dwordx4 v[104:107], v4, s[16:19], s53 offen sc1
MAV 40,56,120
TR 8,7,33344
TR 10,7,33856
MAV 56,56,124
TR 24,7,34368
MAV 56,40,116
TR 26,7,34880
TR 12,7,33376
MAV 60,44,116
buffer_load_dwordx4 v[108:111], v4, s[16:19], s53 offen offset:1024 sc1
MAV 60,60,124
s_add_u32 s53, s53, 32768
MAV 44,60,120
TR 14,7,33888
TR 28,7,34400
MAV 44,44,112
TR 30,7,34912
s_waitcnt vmcnt(8) lgkmcnt(8)
MAV 32,0,64
TR 32,7,41600
TR 34,7,42112
MAV 32,16,72
buffer_load_dwordx4 v[112:115], v4, s[16:19], s52 offen sc1
MAV 48,16,76
TR 48,7,42624
TR 50,7,43136
MAV 48,0,68
TR 36,7,41632
MAV 52,4,68
buffer_load_dwordx4 v[116:119], v4, s[16:19], s52 offen offset:1024 sc1
MAV 52,20,76
TR 38,7,42144
s_add_u32 s52, s52, 32768
MAV 36,20,72
TR 52,7,42656
MAV 36,4,64
TR 54,7,43168
s_waitcnt lgkmcnt(8)
MAV 40,8,64
buffer_load_dwordx4 v[120:123], v4, s[16:19], s53 offen sc1
MAV 40,24,72
TR 40,7,41664
TR 42,7,42176
MAV 56,24,76
TR 56,7,42688
MAV 56,8,68
TR 58,7,43200
TR 44,7,41696
MAV 60,12,68
buffer_load_dwordx4 v[124:127], v4, s[16:19], s53 offen offset:1024 sc1
MAV 60,28,76
s_add_u32 s53, s53, 32768
MAV 44,28,72
TR 46,7,42208
TR 60,7,42720
MAV 44,12,64
TR 62,7,43232
s_waitcnt vmcnt(8) lgkmcnt(8)
MAV 32,32,80
TR 0,7,49920
TR 2,7,50432
MAV 32,48,88
buffer_load_dwordx4 v[64:67], v4, s[16:19], s52 offen sc1
MAV 48,48,92
TR 16,7,50944
TR 18,7,51456
MAV 48,32,84
TR 4,7,49952
MAV 52,36,84
buffer_load_dwordx4 v[68:71], v4, s[16:19], s52 offen offset:1024 sc1
MAV 52,52,92
TR 6,7,50464
s_add_u32 s52, s52, 32768
MAV 36,52,88
TR 20,7,50976
MAV 36,36,80
TR 22,7,51488
s_waitcnt lgkmcnt(8)
MAV 40,40,80
buffer_load_dwordx4 v[72:75], v4, s[16:19], s53 offen sc1
MAV 40,56,88
TR 8,7,49984
TR 10,7,50496
MAV 56,56,92
TR 24,7,51008
MAV 56,40,84
TR 26,7,51520
.Lpad20:
s_cbranch_execz .Lpad23
TR 12,7,50016
MAV 60,44,84
buffer_load_dwordx4 v[76:79], v4, s[16:19], s53 offen offset:1024 sc1
MAV 60,60,92
s_add_u32 s53, s53, 32768
MAV 44,60,88
TR 14,7,50528
TR 28,7,51040
MAV 44,44,80
TR 30,7,51552
s_waitcnt vmcnt(8) lgkmcnt(8)
MAV 32,0,96
TR 32,7,58240
TR 34,7,58752
MAV 32,16,104
buffer_load_dwordx4 v[80:83], v4, s[16:19], s52 offen sc1
MAV 48,16,108
TR 48,7,59264
TR 50,7,59776
MAV 48,0,100
TR 36,7,58272
MAV 52,4,100
buffer_load_dwordx4 v[84:87], v4, s[16:19], s52 offen offset:1024 sc1
MAV 52,20,108
TR 38,7,58784
s_add_u32 s52, s52, 32768
MAV 36,20,104
TR 52,7,59296
MAV 36,4,96
TR 54,7,59808
s_waitcnt lgkmcnt(8)
MAV 40,8,96
buffer_load_dwordx4 v[88:91], v4, s[16:19], s53 offen sc1
MAV 40,24,104
TR 40,7,58304
TR 42,7,58816
MAV 56,24,108
TR 56,7,59328
MAV 56,8,100
TR 58,7,59840
TR 44,7,58336
MAV 60,12,100
buffer_load_dwordx4 v[92:95], v4, s[16:19], s53 offen offset:1024 sc1
MAV 60,28,108
s_add_u32 s53, s53, 32768
MAV 44,28,104
TR 46,7,58848
TR 60,7,59360
MAV 44,12,96
TR 62,7,59872
s_xor_b32 s57, s57, 66560
v_add_u32 v7, s57, v8
s_waitcnt vmcnt(8) lgkmcnt(8)
MAV 32,32,112
ds_read_b64_tr_b16 a[0:1], v7
TR 2,7,512
MAV 32,48,120
buffer_load_dwordx4 v[96:99], v4, s[16:19], s52 offen sc1
MAV 48,48,124
TR 16,7,1024
TR 18,7,1536
MAV 48,32,116
TR 4,7,32
MAV 52,36,116
buffer_load_dwordx4 v[100:103], v4, s[16:19], s52 offen offset:1024 sc1
MAV 52,52,124
TR 6,7,544
s_add_u32 s52, s52, 32768
MAV 36,52,120
TR 20,7,1056
MAV 36,36,112
TR 22,7,1568
s_waitcnt lgkmcnt(8)
MAV 40,40,112
buffer_load_dwordx4 v[104:107], v4, s[16:19], s53 offen sc1
MAV 40,56,120
TR 8,7,64
TR 10,7,576
MAV 56,56,124
TR 24,7,1088
MAV 56,40,116
TR 26,7,1600
TR 12,7,96
MAV 60,44,116
buffer_load_dwordx4 v[108:111], v4, s[16:19], s53 offen offset:1024 sc1
MAV 60,60,124
s_add_u32 s53, s53, 32768
MAV 44,60,120
TR 14,7,608
TR 28,7,1120
MAV 44,44,112
TR 30,7,1632
s_waitcnt vmcnt(8) lgkmcnt(8)
MAV 32,0,64
TR 32,7,8320
TR 34,7,8832
MAV 32,16,72
buffer_load_dwordx4 v[112:115], v4, s[16:19], s52 offen sc1
MAV 48,16,76
TR 48,7,9344
TR 50,7,9856
MAV 48,0,68
TR 36,7,8352
MAV 52,4,68
buffer_load_dwordx4 v[116:119], v4, s[16:19], s52 offen offset:1024 sc1
MAV 52,20,76
TR 38,7,8864
s_add_u32 s52, s52, 32768
MAV 36,20,72
TR 52,7,9376
MAV 36,4,64
TR 54,7,9888
s_waitcnt lgkmcnt(8)
MAV 40,8,64
buffer_load_dwordx4 v[120:123], v4, s[16:19], s53 offen sc1
MAV 40,24,72
TR 40,7,8384
TR 42,7,8896
MAV 56,24,76
TR 56,7,9408
MAV 56,8,68
TR 58,7,9920
TR 44,7,8416
MAV 60,12,68
buffer_load_dwordx4 v[124:127], v4, s[16:19], s53 offen offset:1024 sc1
MAV 60,28,76
s_add_u32 s53, s53, 32768
MAV 44,28,72
TR 46,7,8928
TR 60,7,9440
MAV 44,12,64
TR 62,7,9952
s_waitcnt vmcnt(8) lgkmcnt(8)
MAV 32,32,80
TR 0,7,16640
TR 2,7,17152
MAV 32,48,88
buffer_load_dwordx4 v[64:67], v4, s[16:19], s52 offen sc1
MAV 48,48,92
TR 16,7,17664
TR 18,7,18176
MAV 48,32,84
TR 4,7,16672
MAV 52,36,84
buffer_load_dwordx4 v[68:71], v4, s[16:19], s52 offen offset:1024 sc1
MAV 52,52,92
TR 6,7,17184
s_add_u32 s52, s52, 32768
MAV 36,52,88
TR 20,7,17696
MAV 36,36,80
TR 22,7,18208
s_waitcnt lgkmcnt(8)
MAV 40,40,80
buffer_load_dwordx4 v[72:75], v4, s[16:19], s53 offen sc1
MAV 40,56,88
TR 8,7,16704
TR 10,7,17216
MAV 56,56,92
TR 24,7,17728
MAV 56,40,84
TR 26,7,18240
TR 12,7,16736
MAV 60,44,84
buffer_load_dwordx4 v[76:79], v4, s[16:19], s53 offen offset:1024 sc1
MAV 60,60,92
s_add_u32 s53, s53, 32768
MAV 44,60,88
TR 14,7,17248
TR 28,7,17760
MAV 44,44,80
TR 30,7,18272
s_waitcnt vmcnt(8) lgkmcnt(8)
MAV 32,0,96
TR 32,7,24960
TR 34,7,25472
MAV 32,16,104
buffer_load_dwordx4 v[80:83], v4, s[16:19], s52 offen sc1
MAV 48,16,108
TR 48,7,25984
TR 50,7,26496
MAV 48,0,100
TR 36,7,24992
MAV 52,4,100
buffer_load_dwordx4 v[84:87], v4, s[16:19], s52 offen offset:1024 sc1
MAV 52,20,108
TR 38,7,25504
s_add_u32 s52, s52, 32768
MAV 36,20,104
TR 52,7,26016
MAV 36,4,96
TR 54,7,26528
s_waitcnt lgkmcnt(8)
MAV 40,8,96
buffer_load_dwordx4 v[88:91], v4, s[16:19], s53 offen sc1
MAV 40,24,104
TR 40,7,25024
TR 42,7,25536
MAV 56,24,108
TR 56,7,26048
MAV 56,8,100
TR 58,7,26560
TR 44,7,25056
MAV 60,12,100
buffer_load_dwordx4 v[92:95], v4, s[16:19], s53 offen offset:1024 sc1
MAV 60,28,108
s_add_u32 s53, s53, 32768
MAV 44,28,104
TR 46,7,25568
TR 60,7,26080
MAV 44,12,96
TR 62,7,26592
s_waitcnt vmcnt(8) lgkmcnt(8)
MAV 32,32,112
TR 0,7,33280
TR 2,7,33792
MAV 32,48,120
buffer_load_dwordx4 v[96:99], v4, s[16:19], s52 offen sc1
MAV 48,48,124
TR 16,7,34304
TR 18,7,34816
MAV 48,32,116
TR 4,7,33312
MAV 52,36,116
buffer_load_dwordx4 v[100:103], v4, s[16:19], s52 offen offset:1024 sc1
MAV 52,52,124
TR 6,7,33824
s_add_u32 s52, s52, 32768
MAV 36,52,120
TR 20,7,34336
MAV 36,36,112
TR 22,7,34848
s_waitcnt lgkmcnt(8)
MAV 40,40,112
buffer_load_dwordx4 v[104:107], v4, s[16:19], s53 offen sc1
MAV 40,56,120
TR 8,7,33344
TR 10,7,33856
MAV 56,56,124
TR 24,7,34368
MAV 56,40,116
TR 26,7,34880
TR 12,7,33376
MAV 60,44,116
buffer_load_dwordx4 v[108:111], v4, s[16:19], s53 offen offset:1024 sc1
MAV 60,60,124
s_add_u32 s53, s53, 32768
MAV 44,60,120
TR 14,7,33888
TR 28,7,34400
MAV 44,44,112
TR 30,7,34912
s_waitcnt vmcnt(8) lgkmcnt(8)
MAV 32,0,64
TR 32,7,41600
TR 34,7,42112
MAV 32,16,72
buffer_load_dwordx4 v[112:115], v4, s[16:19], s52 offen sc1
MAV 48,16,76
TR 48,7,42624
TR 50,7,43136
MAV 48,0,68
TR 36,7,41632
MAV 52,4,68
buffer_load_dwordx4 v[116:119], v4, s[16:19], s52 offen offset:1024 sc1
MAV 52,20,76
TR 38,7,42144
s_add_u32 s52, s52, 32768
MAV 36,20,72
TR 52,7,42656
MAV 36,4,64
TR 54,7,43168
s_waitcnt lgkmcnt(8)
MAV 40,8,64
buffer_load_dwordx4 v[120:123], v4, s[16:19], s53 offen sc1
MAV 40,24,72
TR 40,7,41664
TR 42,7,42176
MAV 56,24,76
TR 56,7,42688
MAV 56,8,68
TR 58,7,43200
TR 44,7,41696
MAV 60,12,68
buffer_load_dwordx4 v[124:127], v4, s[16:19], s53 offen offset:1024 sc1
MAV 60,28,76
s_add_u32 s53, s53, 32768
MAV 44,28,72
TR 46,7,42208
TR 60,7,42720
MAV 44,12,64
TR 62,7,43232
s_barrier
s_waitcnt vmcnt(8) lgkmcnt(8)
MAV 32,32,80
TR 0,7,49920
s_add_u32 m0, s59, 84480
MAV 32,48,88
buffer_load_dwordx4 v12, s[32:35], s58 offen   lds
MAV 48,48,92
TR 2,7,50432
TR 16,7,50944
MAV 48,32,84
TR 18,7,51456
MAV 52,36,84
buffer_load_dwordx4 v13, s[32:35], s58 offen offset:1056   lds
MAV 52,52,92
TR 4,7,49952
TR 6,7,50464
MAV 36,52,88
TR 20,7,50976
MAV 36,36,80
TR 22,7,51488
s_waitcnt lgkmcnt(8)
MAV 40,40,80
buffer_load_dwordx4 v14, s[32:35], s58 offen offset:2112   lds
MAV 40,56,88
TR 8,7,49984
MAV 56,56,92
TR 10,7,50496
TR 24,7,51008
MAV 56,40,84
TR 26,7,51520
MAV 60,44,84
buffer_load_dwordx4 v15, s[32:35], s58 offen offset:3168   lds
MAV 60,60,92
TR 12,7,50016
TR 14,7,50528
MAV 44,60,88
TR 28,7,51040
MAV 44,44,80
TR 30,7,51552
s_waitcnt vmcnt(8) lgkmcnt(8)
MAV 32,0,96
TR 32,7,58240
s_add_u32 m0, s59, 101376
MAV 32,16,104
buffer_load_dwordx4 v12, s[80:83], s58 offen   lds
MAV 48,16,108
TR 34,7,58752
TR 48,7,59264
MAV 48,0,100
TR 50,7,59776
MAV 52,4,100
buffer_load_dwordx4 v13, s[80:83], s58 offen offset:1056   lds
MAV 52,20,108
TR 36,7,58272
TR 38,7,58784
MAV 36,20,104
TR 52,7,59296
MAV 36,4,96
TR 54,7,59808
s_waitcnt lgkmcnt(8)
MAV 40,8,96
buffer_load_dwordx4 v14, s[80:83], s58 offen offset:2112   lds
MAV 40,24,104
TR 40,7,58304
TR 42,7,58816
MAV 56,24,108
TR 56,7,59328
MAV 56,8,100
TR 58,7,59840
TR 44,7,58336
MAV 60,12,100
buffer_load_dwordx4 v15, s[80:83], s58 offen offset:3168   lds
MAV 60,28,108
s_add_u32 s58, s58, 458752
MAV 44,28,104
TR 46,7,58848
TR 60,7,59360
MAV 44,12,96
TR 62,7,59872
s_waitcnt vmcnt(11) lgkmcnt(14)
MAV 32,32,112
s_add_u32 m0, s59, 118272
s_lshl_b32 s64, s6, 14
s_lshl_b32 s65, s49, 13
s_waitcnt vmcnt(9) lgkmcnt(12)
MAV 32,48,120
buffer_load_dwordx4 v12, s[32:35], s58 offen   lds
s_waitcnt vmcnt(9)
MAV 48,48,124
s_add_u32 s64, s64, s65
s_lshl_b32 s65, s7, 9
s_add_u32 s64, s64, s65
MAV 48,32,116
s_lshl_b32 s65, s48, 8
s_add_u32 s64, s64, s65
s_add_u32 s64, s64, 63176704
s_waitcnt lgkmcnt(10)
MAV 52,36,116
s_lshl_b32 s62, s7, 15
v_and_b32 v152, 31, v1
v_lshlrev_b32 v152, 3, v152
s_waitcnt lgkmcnt(8)
MAV 52,52,124
buffer_load_dwordx4 v13, s[32:35], s58 offen offset:1056   lds
MAV 36,52,120
s_add_u32 s62, s62, 41943040
v_lshrrev_b32 v153, 5, v1
v_lshl_add_u32 v152, v153, 28, v152
MAV 36,36,112
s_add_u32 s63, s62, 16384
v_cvt_pk_bf16_f32 v128, v32, v33
v_cvt_pk_bf16_f32 v129, v34, v35
s_waitcnt lgkmcnt(6)
MAV 40,40,112
v_cvt_pk_bf16_f32 v136, v48, v49
v_cvt_pk_bf16_f32 v137, v50, v51
s_waitcnt lgkmcnt(4)
MAV 40,56,120
buffer_load_dwordx4 v14, s[32:35], s58 offen offset:2112   lds
MAV 56,56,124
v_cvt_pk_bf16_f32 v130, v36, v37
v_cvt_pk_bf16_f32 v131, v38, v39
MAV 56,40,116
s_nop 2
v_cvt_pk_bf16_f32 v132, v40, v41
v_cvt_pk_bf16_f32 v133, v42, v43
s_waitcnt lgkmcnt(2)
MAV 60,44,116
v_cvt_pk_bf16_f32 v138, v52, v53
v_cvt_pk_bf16_f32 v139, v54, v55
s_waitcnt lgkmcnt(0)
MAV 60,60,124
buffer_load_dwordx4 v15, s[32:35], s58 offen offset:3168   lds
MAV 44,60,120
v_cvt_pk_bf16_f32 v140, v56, v57
v_cvt_pk_bf16_f32 v141, v58, v59
MAV 44,44,112
s_nop 2
v_cvt_pk_bf16_f32 v142, v60, v61
v_cvt_pk_bf16_f32 v143, v62, v63
v_pk_mul_f32 v[146:147], v[32:33], v[32:33]
v_pk_mul_f32 v[150:151], v[48:49], v[48:49]
buffer_store_dwordx4 v[128:131], v4, s[16:19], s62 offen sc1
v_cvt_pk_bf16_f32 v134, v44, v45
v_cvt_pk_bf16_f32 v135, v46, v47
v_pk_fma_f32 v[146:147], v[34:35], v[34:35], v[146:147]
v_pk_add_f32 v[144:145], v[32:33], v[34:35]
v_pk_fma_f32 v[150:151], v[50:51], v[50:51], v[150:151]
v_pk_add_f32 v[148:149], v[48:49], v[50:51]
v_pk_fma_f32 v[146:147], v[36:37], v[36:37], v[146:147]
v_pk_add_f32 v[144:145], v[144:145], v[36:37]
v_pk_fma_f32 v[150:151], v[52:53], v[52:53], v[150:151]
v_pk_add_f32 v[148:149], v[148:149], v[52:53]
v_pk_fma_f32 v[146:147], v[38:39], v[38:39], v[146:147]
v_pk_add_f32 v[144:145], v[144:145], v[38:39]
v_pk_fma_f32 v[150:151], v[54:55], v[54:55], v[150:151]
buffer_store_dwordx4 v[132:135], v4, s[16:19], s63 offen sc1
v_pk_add_f32 v[148:149], v[148:149], v[54:55]
v_pk_fma_f32 v[146:147], v[40:41], v[40:41], v[146:147]
v_pk_add_f32 v[144:145], v[144:145], v[40:41]
v_pk_fma_f32 v[150:151], v[56:57], v[56:57], v[150:151]
v_pk_add_f32 v[148:149], v[148:149], v[56:57]
v_pk_fma_f32 v[146:147], v[42:43], v[42:43], v[146:147]
v_pk_add_f32 v[144:145], v[144:145], v[42:43]
v_pk_fma_f32 v[150:151], v[58:59], v[58:59], v[150:151]
v_pk_add_f32 v[148:149], v[148:149], v[58:59]
v_pk_fma_f32 v[146:147], v[44:45], v[44:45], v[146:147]
v_pk_add_f32 v[144:145], v[144:145], v[44:45]
v_pk_fma_f32 v[150:151], v[60:61], v[60:61], v[150:151]
v_pk_add_f32 v[148:149], v[148:149], v[60:61]
buffer_store_dwordx4 v[136:139], v4, s[16:19], s62 offen offset:1024 sc1
v_pk_fma_f32 v[146:147], v[46:47], v[46:47], v[146:147]
v_pk_add_f32 v[144:145], v[144:145], v[46:47]
v_pk_fma_f32 v[150:151], v[62:63], v[62:63], v[150:151]
v_pk_add_f32 v[148:149], v[148:149], v[62:63]
v_add_f32 v144, v144, v145
v_add_f32 v146, v146, v147
v_add_f32 v148, v148, v149
v_add_f32 v150, v150, v151
s_nop 0
v_permlane16_swap_b32 v144, v148
v_permlane16_swap_b32 v146, v150
v_add_f32 v144, v144, v148
buffer_store_dwordx4 v[140:143], v4, s[16:19], s63 offen offset:1024 sc1
v_add_f32 v146, v146, v150
s_nop 1
v_permlane32_swap_b32 v144, v146
v_add_f32 v144, v144, v146
s_nop 1
v_permlane32_swap_b32 v144, v145
buffer_store_dwordx2 v[144:145], v152, s[16:19], s64 offen sc1
s_nop 1
v_accvgpr_write_b32 a224, v32
v_accvgpr_write_b32 a225, v33
v_accvgpr_write_b32 a226, v34
v_accvgpr_write_b32 a227, v35
v_accvgpr_write_b32 a228, v36
v_accvgpr_write_b32 a229, v37
v_accvgpr_write_b32 a230, v38
v_accvgpr_write_b32 a231, v39
v_accvgpr_write_b32 a232, v40
v_accvgpr_write_b32 a233, v41
v_accvgpr_write_b32 a234, v42
v_accvgpr_write_b32 a235, v43
v_accvgpr_write_b32 a236, v44
v_accvgpr_write_b32 a237, v45
v_accvgpr_write_b32 a238, v46
v_accvgpr_write_b32 a239, v47
v_accvgpr_write_b32 a240, v48
v_accvgpr_write_b32 a241, v49
v_accvgpr_write_b32 a242, v50
v_accvgpr_write_b32 a243, v51
v_accvgpr_write_b32 a244, v52
v_accvgpr_write_b32 a245, v53
v_accvgpr_write_b32 a246, v54
v_accvgpr_write_b32 a247, v55
v_accvgpr_write_b32 a248, v56
v_accvgpr_write_b32 a249, v57
v_accvgpr_write_b32 a250, v58
v_accvgpr_write_b32 a251, v59
v_accvgpr_write_b32 a252, v60
v_accvgpr_write_b32 a253, v61
v_accvgpr_write_b32 a254, v62
v_accvgpr_write_b32 a255, v63
s_lshl_b32 s62, s10, 19
s_lshl_b32 s63, s3, 12
s_add_u32 s62, s62, s63
s_lshl_b32 s63, s12, 11
s_add_u32 s62, s62, s63
v_lshl_add_u32 v10, v1, 4, s62
v_lshrrev_b32 v2, 3, v1
v_cmp_eq_u32 vcc, 3, v2
v_add_u32 v2, 67108480, v10
s_nop 0
v_cndmask_b32 v10, v10, v2, vcc
v_xor_b32 v11, 2048, v10
v_bfe_u32 v16, v1, 2, 3
v_mul_u32_u24 v16, 1056, v16
v_bfe_u32 v2, v1, 5, 1
v_lshl_add_u32 v16, v2, 8, v16
v_and_b32 v2, 3, v1
v_lshl_add_u32 v16, v2, 3, v16
s_lshl_b32 s62, s12, 6
s_add_u32 s62, s62, 84480
s_xor_b32 s63, s12, 1
s_mul_i32 s63, s63, 192
s_add_u32 s63, s63, 84480
v_add_u32 v17, s63, v16
v_add_u32 v16, s62, v16
s_mov_b32 s52, 41943040
s_mov_b32 s53, 41943040
s_mov_b32 s54, s58
s_mov_b32 s55, s59
s_mul_i32 s59, s3, 2112
s_and_b32 s62, s7, 1
s_mul_i32 s62, s62, 3670016
.Lpad21:
s_cbranch_execz .Lpad24
s_lshr_b32 s63, s7, 1
s_lshl_b32 s63, s63, 8
s_add_u32 s62, s62, s63
s_lshl_b32 s63, s3, 12
s_add_u32 s62, s62, s63
v_lshrrev_b32 v5, 4, v1
v_lshlrev_b32 v5, 14, v5
v_and_b32 v2, 15, v1
v_lshl_add_u32 v5, v2, 4, v5
v_add_u32 v5, s62, v5
v_add_u32 v6, 992, v5
s_lshl_b32 s62, s10, 15
s_lshl_b32 s63, s3, 13
s_add_u32 s62, s62, s63
v_lshl_add_u32 v4, v1, 4, s62
s_lshl_b32 s62, s6, 10
s_add_u32 s62, s62, 30507008
s_lshl_b32 s64, s10, 1
s_lshl_b32 s64, s64, 10
s_add_u32 s64, s64, 30507008
s_lshr_b32 s67, s5, 2
s_and_b32 s67, s67, 3
s_lshl_b32 s67, s67, 7
s_add_u32 s64, s64, s67
s_add_u32 s65, s64, 1024
v_lshl_add_u32 v252, v1, 7, s62
v_mov_b32 v253, s64
v_mov_b32 v255, 1
v_writelane_b32 v253, s65, 1
s_waitcnt vmcnt(0) lgkmcnt(0)
s_cmp_lg_u32 s3, 1
s_barrier
s_cbranch_scc1 .Lnopoll62
s_mov_b64 exec, 15
buffer_atomic_add v255, v252, s[16:19], 0 offen
s_mov_b64 exec, 3
v_mov_b32 v254, 0
buffer_atomic_add v254, v253, s[16:19], 0 offen sc0
s_sleep 5
s_mov_b32 s15, 0
.Lpoll61:
v_mov_b32 v255, 0
buffer_atomic_add v255, v253, s[16:19], 0 offen sc0
s_waitcnt vmcnt(1)
v_cmp_gt_u32 vcc, 16, v254
s_add_u32 s15, s15, 1
s_cbranch_vccz .Lnopoll62r
v_mov_b32 v254, 0
buffer_atomic_add v254, v253, s[16:19], 0 offen sc0
s_waitcnt vmcnt(1)
v_cmp_gt_u32 vcc, 16, v255
s_add_u32 s15, s15, 1
s_cbranch_vccz .Lnopoll62r
s_cmp_le_u32 s15, 100000
s_cbranch_scc1 .Lpoll61
s_branch .Lnopoll62r
.Lnopoll62:
s_mov_b64 exec, 0
s_cmp_eq_u32 s3, 2
s_cbranch_scc1 .Lpad26
s_cmp_eq_u32 s3, 3
s_cbranch_scc1 .Lpad27
s_branch .Lpad28
.Lnopoll62r:
s_mov_b64 exec, -1
s_barrier
buffer_load_dwordx4 a[128:131], v10, s[16:19], s52 offen sc1
buffer_load_dwordx4 a[132:135], v10, s[16:19], s52 offen offset:1024 sc1
s_add_u32 s52, s52, 16384
buffer_load_dwordx4 a[144:147], v10, s[16:19], s52 offen sc1
buffer_load_dwordx4 a[148:151], v10, s[16:19], s52 offen offset:1024 sc1
s_add_u32 s52, s52, 16384
buffer_load_dwordx4 a[136:139], v11, s[16:19], s53 offen sc1
buffer_load_dwordx4 a[140:143], v11, s[16:19], s53 offen offset:1024 sc1
s_add_u32 s53, s53, 16384
buffer_load_dwordx4 a[152:155], v11, s[16:19], s53 offen sc1
buffer_load_dwordx4 a[156:159], v11, s[16:19], s53 offen offset:1024 sc1
s_add_u32 s53, s53, 16384
ds_read_b64_tr_b16 a[0:1], v16
TR 2,16,512
TR 4,16,8448
TR 6,16,8960
TR 8,16,32
TR 10,16,544
TR 12,16,8480
TR 14,16,8992
TR 16,16,64
TR 18,16,576
TR 20,16,8512
TR 22,16,9024
TR 24,16,96
TR 26,16,608
TR 28,16,8544
TR 30,16,9056
TR 32,16,128
TR 34,16,640
TR 36,16,8576
TR 38,16,9088
TR 40,16,160
TR 42,16,672
TR 44,16,8608
TR 46,16,9120
ds_read_b64_tr_b16 a[48:49], v17
TR 50,17,512
TR 52,17,8448
TR 54,17,8960
TR 56,17,32
TR 58,17,544
TR 60,17,8480
TR 62,17,8992
s_add_u32 m0, s55, 135168
s_nop 0
buffer_load_dwordx4 v12, s[80:83], s54 offen   lds
buffer_load_dwordx4 v13, s[80:83], s54 offen offset:1056   lds
buffer_load_dwordx4 v14, s[80:83], s54 offen offset:2112   lds
buffer_load_dwordx4 v15, s[80:83], s54 offen offset:3168   lds
s_add_u32 s54, s54, 458752
s_mul_i32 s66, s13, 114688
s_mul_i32 s65, s10, 1310720
s_add_u32 s66, s66, s65
s_add_u32 s66, s66, 46137344
s_add_u32 s65, s66, 49152
s_lshl_b32 s62, s12, 16
s_add_u32 s62, s62, s66
s_add_u32 s63, s62, 16384
s_add_u32 s64, s62, 32768
s_lshl_b32 s72, s10, 1
s_lshr_b32 s74, s11, 4
s_add_u32 s72, s72, s74
s_lshl_b32 s72, s72, 10
s_add_u32 s72, s72, 30523392
s_and_b32 s73, s6, 14
s_and_b32 s74, s7, 1
s_add_u32 s73, s73, s74
s_lshl_b32 s73, s73, 10
s_add_u32 s73, s73, 30523392
s_lshr_b32 s67, s5, 2
s_and_b32 s67, s67, 3
s_lshl_b32 s67, s67, 7
s_add_u32 s73, s73, s67
s_and_b32 s74, s7, 1
s_mul_i32 s87, s74, 917504
s_lshr_b32 s75, s6, 1
s_mul_i32 s75, s75, 1310720
s_add_u32 s87, s87, s75
s_add_u32 s87, s87, 46137344
s_and_b32 s74, s6, 3
s_xor_b32 s75, s74, 0
s_sub_u32 s75, s75, 0
s_mul_i32 s98, s75, 458752
s_mul_i32 s75, s75, 114688
s_add_u32 s76, s87, s75
s_xor_b32 s75, s74, 1
s_sub_u32 s75, s75, 1
s_mul_i32 s99, s75, 458752
s_mul_i32 s75, s75, 114688
s_add_u32 s77, s87, s75
s_xor_b32 s75, s74, 2
s_sub_u32 s75, s75, 2
s_mul_i32 s100, s75, 458752
s_mul_i32 s75, s75, 114688
s_add_u32 s78, s87, s75
s_xor_b32 s75, s74, 3
s_sub_u32 s75, s75, 3
s_mul_i32 s101, s75, 458752
s_mul_i32 s75, s75, 114688
s_add_u32 s79, s87, s75
s_and_b32 s87, s6, 3
s_mov_b32 s46, 0
s_lshl_b32 s74, s3, 10
s_lshl_b32 s75, s12, 9
s_add_u32 s74, s74, s75
s_add_u32 s74, s74, 152576
v_and_b32 v18, 15, v1
v_lshl_add_u32 v18, v18, 4, s74
v_xor_b32 v19, 512, v18
s_lshl_b32 s74, s12, 7
s_add_u32 s74, s74, 161536
s_xor_b32 s75, s12, 1
s_mul_i32 s75, s75, 384
s_add_u32 s75, s75, 161536
v_lshrrev_b32 v9, 4, v1
v_lshlrev_b32 v9, 4, v9
v_add_u32 v8, s75, v9
v_add_u32 v9, s74, v9
s_lshl_b32 s74, s3, 13
s_add_u32 s74, s74, 49920
v_lshl_add_u32 v2, v1, 4, s74
s_waitcnt lgkmcnt(0)
s_barrier
s_waitcnt vmcnt(11)
v_mfma_f32_16x16x32_bf16 v[32:35], a[0:3], a[128:131], 0
buffer_load_dwordx4 a[160:163], v10, s[16:19], s52 offen sc1
s_waitcnt vmcnt(10)
MAA 32,4,144
TR 64,16,16896
v_mfma_f32_16x16x32_bf16 v[36:39], a[0:3], a[132:135], 0
TR 66,16,17408
s_waitcnt vmcnt(9)
MAA 36,4,148
TR 68,16,25344
v_mfma_f32_16x16x32_bf16 v[52:55], a[8:11], a[132:135], 0
buffer_load_dwordx4 a[164:167], v10, s[16:19], s52 offen offset:1024 sc1
MAA 52,12,148
TR 70,16,25856
s_add_u32 s52, s52, 16384
v_mfma_f32_16x16x32_bf16 v[48:51], a[8:11], a[128:131], 0
TR 72,16,16928
MAA 48,12,144
TR 74,16,17440
v_mfma_f32_16x16x32_bf16 v[96:99], a[16:19], a[128:131], 0
buffer_load_dwordx4 a[176:179], v10, s[16:19], s52 offen sc1
MAA 96,20,144
TR 76,16,25376
v_mfma_f32_16x16x32_bf16 v[100:103], a[16:19], a[132:135], 0
TR 78,16,25888
MAA 100,20,148
TR 80,16,16960
v_mfma_f32_16x16x32_bf16 v[116:119], a[24:27], a[132:135], 0
buffer_load_dwordx4 a[180:183], v10, s[16:19], s52 offen offset:1024 sc1
MAA 116,28,148
TR 82,16,17472
s_add_u32 s52, s52, 16384
v_mfma_f32_16x16x32_bf16 v[112:115], a[24:27], a[128:131], 0
TR 84,16,25408
MAA 112,28,144
TR 86,16,25920
v_mfma_f32_16x16x32_bf16 v[160:163], a[32:35], a[128:131], 0
buffer_load_dwordx4 a[168:171], v11, s[16:19], s53 offen sc1
MAA 160,36,144
TR 88,16,16992
v_mfma_f32_16x16x32_bf16 v[164:167], a[32:35], a[132:135], 0
TR 90,16,17504
MAA 164,36,148
TR 92,16,25440
v_mfma_f32_16x16x32_bf16 v[180:183], a[40:43], a[132:135], 0
buffer_load_dwordx4 a[172:175], v11, s[16:19], s53 offen offset:1024 sc1
MAA 180,44,148
TR 94,16,25952
s_add_u32 s53, s53, 16384
v_mfma_f32_16x16x32_bf16 v[176:179], a[40:43], a[128:131], 0
TR 96,16,17024
MAA 176,44,144
TR 98,16,17536
v_mfma_f32_16x16x32_bf16 v[224:227], a[48:51], a[128:131], 0
buffer_load_dwordx4 a[184:187], v11, s[16:19], s53 offen sc1
MAA 224,52,144
TR 100,16,25472
v_mfma_f32_16x16x32_bf16 v[228:231], a[48:51], a[132:135], 0
TR 102,16,25984
MAA 228,52,148
TR 104,16,17056
v_mfma_f32_16x16x32_bf16 v[236:239], a[56:59], a[132:135], 0
buffer_load_dwordx4 a[188:191], v11, s[16:19], s53 offen offset:1024 sc1
MAA 236,60,148
TR 106,16,17568
s_add_u32 s53, s53, 16384
v_mfma_f32_16x16x32_bf16 v[232:235], a[56:59], a[128:131], 0
TR 108,16,25504
s_add_u32 m0, s55, 84480
MAA 232,60,144
TR 110,16,26016
s_waitcnt vmcnt(12)
v_mfma_f32_16x16x32_bf16 v[188:191], a[40:43], a[140:143], 0
buffer_load_dwordx4 v12, s[32:35], s54 offen   lds
MAA 188,44,156
TR 112,17,16896
v_mfma_f32_16x16x32_bf16 v[184:187], a[40:43], a[136:139], 0
TR 114,17,17408
MAA 184,44,152
TR 116,17,25344
v_mfma_f32_16x16x32_bf16 v[168:171], a[32:35], a[136:139], 0
buffer_load_dwordx4 v13, s[32:35], s54 offen offset:1056   lds
MAA 168,36,152
TR 118,17,25856
v_mfma_f32_16x16x32_bf16 v[172:175], a[32:35], a[140:143], 0
TR 120,17,16928
MAA 172,36,156
TR 122,17,17440
v_mfma_f32_16x16x32_bf16 v[124:127], a[24:27], a[140:143], 0
buffer_load_dwordx4 v14, s[32:35], s54 offen offset:2112   lds
MAA 124,28,156
TR 124,17,25376
v_mfma_f32_16x16x32_bf16 v[120:123], a[24:27], a[136:139], 0
TR 126,17,25888
MAA 120,28,152
v_mfma_f32_16x16x32_bf16 v[104:107], a[16:19], a[136:139], 0
buffer_load_dwordx4 v15, s[32:35], s54 offen offset:3168   lds
MAA 104,20,152
v_mfma_f32_16x16x32_bf16 v[108:111], a[16:19], a[140:143], 0
MAA 108,20,156
v_mfma_f32_16x16x32_bf16 v[60:63], a[8:11], a[140:143], 0
MAA 60,12,156
v_mfma_f32_16x16x32_bf16 v[56:59], a[8:11], a[136:139], 0
MAA 56,12,152
v_mfma_f32_16x16x32_bf16 v[40:43], a[0:3], a[136:139], 0
MAA 40,4,152
v_mfma_f32_16x16x32_bf16 v[44:47], a[0:3], a[140:143], 0
MAA 44,4,156
s_waitcnt lgkmcnt(0)
s_barrier
v_mfma_f32_16x16x32_bf16 v[64:67], a[64:67], a[128:131], 0
TR 0,16,33792
s_add_u32 m0, s74, 0
MAA 64,68,144
TR 2,16,34304
s_mov_b32 s67, 63176704
v_mfma_f32_16x16x32_bf16 v[68:71], a[64:67], a[132:135], 0
buffer_load_dwordx4 v4, s[16:19], s67 offen sc1 lds
MAA 68,68,148
TR 4,16,42240
v_mfma_f32_16x16x32_bf16 v[84:87], a[72:75], a[132:135], 0
TR 6,16,42752
MAA 84,76,148
TR 8,16,33824
v_mfma_f32_16x16x32_bf16 v[80:83], a[72:75], a[128:131], 0
buffer_load_dwordx4 v4, s[16:19], s67 offen offset:1024 sc1 lds
MAA 80,76,144
TR 10,16,34336
v_mfma_f32_16x16x32_bf16 v[128:131], a[80:83], a[128:131], 0
TR 12,16,42272
MAA 128,84,144
TR 14,16,42784
v_mfma_f32_16x16x32_bf16 v[132:135], a[80:83], a[132:135], 0
buffer_load_dwordx4 v4, s[16:19], s67 offen offset:2048 sc1 lds
MAA 132,84,148
TR 16,16,33856
v_mfma_f32_16x16x32_bf16 v[148:151], a[88:91], a[132:135], 0
TR 18,16,34368
MAA 148,92,148
TR 20,16,42304
v_mfma_f32_16x16x32_bf16 v[144:147], a[88:91], a[128:131], 0
buffer_load_dwordx4 v4, s[16:19], s67 offen offset:3072 sc1 lds
MAA 144,92,144
TR 22,16,42816
s_add_u32 m0, s55, 101376
v_mfma_f32_16x16x32_bf16 v[192:195], a[96:99], a[128:131], 0
TR 24,16,33888
MAA 192,100,144
TR 26,16,34400
v_mfma_f32_16x16x32_bf16 v[196:199], a[96:99], a[132:135], 0
buffer_load_dwordx4 v12, s[80:83], s54 offen   lds
MAA 196,100,148
TR 28,16,42336
v_mfma_f32_16x16x32_bf16 v[212:215], a[104:107], a[132:135], 0
TR 30,16,42848
MAA 212,108,148
TR 32,16,33920
v_mfma_f32_16x16x32_bf16 v[208:211], a[104:107], a[128:131], 0
buffer_load_dwordx4 v13, s[80:83], s54 offen offset:1056   lds
MAA 208,108,144
TR 34,16,34432
v_mfma_f32_16x16x32_bf16 v[240:243], a[112:115], a[128:131], 0
TR 36,16,42368
MAA 240,116,144
TR 38,16,42880
v_mfma_f32_16x16x32_bf16 v[244:247], a[112:115], a[132:135], 0
buffer_load_dwordx4 v14, s[80:83], s54 offen offset:2112   lds
MAA 244,116,148
TR 40,16,33952
v_mfma_f32_16x16x32_bf16 v[252:255], a[120:123], a[132:135], 0
TR 42,16,34464
MAA 252,124,148
TR 44,16,42400
v_mfma_f32_16x16x32_bf16 v[248:251], a[120:123], a[128:131], 0
buffer_load_dwordx4 v15, s[80:83], s54 offen offset:3168   lds
MAA 248,124,144
TR 46,16,42912
s_add_u32 s54, s54, 458752
v_mfma_f32_16x16x32_bf16 v[220:223], a[104:107], a[140:143], 0
TR 48,17,33792
MAA 220,108,156
TR 50,17,34304
v_mfma_f32_16x16x32_bf16 v[216:219], a[104:107], a[136:139], 0
buffer_load_dwordx4 a[128:131], v10, s[16:19], s52 offen sc1
MAA 216,108,152
TR 52,17,42240
v_mfma_f32_16x16x32_bf16 v[200:203], a[96:99], a[136:139], 0
TR 54,17,42752
MAA 200,100,152
TR 56,17,33824
v_mfma_f32_16x16x32_bf16 v[204:207], a[96:99], a[140:143], 0
buffer_load_dwordx4 a[132:135], v10, s[16:19], s52 offen offset:1024 sc1
MAA 204,100,156
TR 58,17,34336
s_add_u32 s52, s52, 16384
v_mfma_f32_16x16x32_bf16 v[156:159], a[88:91], a[140:143], 0
TR 60,17,42272
MAA 156,92,156
TR 62,17,42784
v_mfma_f32_16x16x32_bf16 v[152:155], a[88:91], a[136:139], 0
buffer_load_dwordx4 a[144:147], v10, s[16:19], s52 offen sc1
MAA 152,92,152
v_mfma_f32_16x16x32_bf16 v[136:139], a[80:83], a[136:139], 0
MAA 136,84,152
v_mfma_f32_16x16x32_bf16 v[140:143], a[80:83], a[140:143], 0
buffer_load_dwordx4 a[148:151], v10, s[16:19], s52 offen offset:1024 sc1
MAA 140,84,156
s_add_u32 s52, s52, 16384
v_mfma_f32_16x16x32_bf16 v[92:95], a[72:75], a[140:143], 0
MAA 92,76,156
v_mfma_f32_16x16x32_bf16 v[88:91], a[72:75], a[136:139], 0
MAA 88,76,152
v_mfma_f32_16x16x32_bf16 v[72:75], a[64:67], a[136:139], 0
MAA 72,68,152
v_mfma_f32_16x16x32_bf16 v[76:79], a[64:67], a[140:143], 0
MAA 76,68,156
s_waitcnt vmcnt(20) lgkmcnt(0)
s_barrier
MAA 32,0,160
buffer_load_dwordx4 a[136:139], v11, s[16:19], s53 offen sc1
MAA 32,4,176
TR 64,16,50688
MAA 36,4,180
TR 66,16,51200
MAA 36,0,164
TR 68,16,59136
MAA 52,8,164
buffer_load_dwordx4 a[140:143], v11, s[16:19], s53 offen offset:1024 sc1
MAA 52,12,180
TR 70,16,59648
s_add_u32 s53, s53, 16384
MAA 48,12,176
TR 72,16,50720
MAA 48,8,160
TR 74,16,51232
MAA 96,16,160
buffer_load_dwordx4 a[152:155], v11, s[16:19], s53 offen sc1
MAA 96,20,176
TR 76,16,59168
MAA 100,20,180
TR 78,16,59680
MAA 100,16,164
TR 80,16,50752
MAA 116,24,164
buffer_load_dwordx4 a[156:159], v11, s[16:19], s53 offen offset:1024 sc1
MAA 116,28,180
TR 82,16,51264
s_add_u32 s53, s53, 16384
MAA 112,28,176
TR 84,16,59200
s_add_u32 m0, s55, 118272
MAA 112,24,160
TR 86,16,59712
MAA 160,32,160
buffer_load_dwordx4 v12, s[32:35], s54 offen   lds
MAA 160,36,176
TR 88,16,50784
MAA 164,36,180
TR 90,16,51296
MAA 164,32,164
TR 92,16,59232
MAA 180,40,164
buffer_load_dwordx4 v13, s[32:35], s54 offen offset:1056   lds
MAA 180,44,180
TR 94,16,59744
MAA 176,44,176
TR 96,16,50816
MAA 176,40,160
TR 98,16,51328
MAA 224,48,160
buffer_load_dwordx4 v14, s[32:35], s54 offen offset:2112   lds
MAA 224,52,176
TR 100,16,59264
MAA 228,52,180
TR 102,16,59776
MAA 228,48,164
TR 104,16,50848
MAA 236,56,164
buffer_load_dwordx4 v15, s[32:35], s54 offen offset:3168   lds
MAA 236,60,180
TR 106,16,51360
s_add_u32 m0, s74, 4096
MAA 232,60,176
TR 108,16,59296
s_mov_b32 s67, 63180800
MAA 232,56,160
TR 110,16,59808
s_waitcnt vmcnt(24)
MAA 188,40,172
buffer_load_dwordx4 v4, s[16:19], s67 offen sc1 lds
MAA 188,44,188
TR 112,17,50688
MAA 184,44,184
TR 114,17,51200
MAA 184,40,168
TR 116,17,59136
MAA 168,32,168
buffer_load_dwordx4 v4, s[16:19], s67 offen offset:1024 sc1 lds
MAA 168,36,184
TR 118,17,59648
MAA 172,36,188
TR 120,17,50720
MAA 172,32,172
TR 122,17,51232
MAA 124,24,172
buffer_load_dwordx4 v4, s[16:19], s67 offen offset:2048 sc1 lds
MAA 124,28,188
TR 124,17,59168
MAA 120,28,184
TR 126,17,59680
MAA 120,24,168
MAA 104,16,168
buffer_load_dwordx4 v4, s[16:19], s67 offen offset:3072 sc1 lds
MAA 104,20,184
MAA 108,20,188
MAA 108,16,172
MAA 60,8,172
MAA 60,12,188
MAA 56,12,184
MAA 56,8,168
MAA 40,0,168
MAA 40,4,184
MAA 44,4,188
MAA 44,0,172
s_waitcnt vmcnt(24) lgkmcnt(0)
s_barrier
MAA 64,64,160
s_waitcnt vmcnt(20)
ds_read_b128 v[20:23], v2
s_add_u32 m0, s55, 135168
MAA 64,68,176
buffer_load_dwordx4 v12, s[80:83], s54 offen   lds
MAA 68,68,180
ds_read_b128 v[28:31], v2 offset:1024
MAA 68,64,164
ds_read_b128 v[24:27], v2 offset:2048
MAA 84,72,164
ds_read_b64_tr_b16 a[0:1], v16
MAA 84,76,180
TR 2,16,512
MAA 80,76,176
TR 4,16,8448
MAA 80,72,160
buffer_load_dwordx4 v13, s[80:83], s54 offen offset:1056   lds
MAA 128,80,160
TR 6,16,8960
MAA 128,84,176
TR 8,16,32
MAA 132,84,180
TR 10,16,544
s_waitcnt lgkmcnt(7)
v_add_f32 v20, v20, v28
MAA 132,80,164
TR 12,16,8480
v_add_f32 v21, v21, v29
MAA 148,88,164
TR 14,16,8992
v_add_f32 v22, v22, v30
MAA 148,92,180
buffer_load_dwordx4 v14, s[80:83], s54 offen offset:2112   lds
MAA 144,92,176
TR 16,16,64
v_add_f32 v23, v23, v31
MAA 144,88,160
ds_read_b128 v[28:31], v2 offset:3072
s_waitcnt lgkmcnt(10)
v_add_f32 v20, v20, v24
MAA 192,96,160
TR 18,16,576
v_add_f32 v21, v21, v25
MAA 192,100,176
TR 20,16,8512
v_add_f32 v22, v22, v26
MAA 196,100,180
TR 22,16,9024
v_add_f32 v23, v23, v27
MAA 196,96,164
buffer_load_dwordx4 v15, s[80:83], s54 offen offset:3168   lds
MAA 212,104,164
TR 24,16,96
s_add_u32 s54, s54, 458752
MAA 212,108,180
TR 26,16,608
.Lpad22:
s_cbranch_execz .Lpad25
MAA 208,108,176
TR 28,16,8544
MAA 208,104,160
TR 30,16,9056
MAA 240,112,160
TR 32,16,128
MAA 240,116,176
TR 34,16,640
MAA 244,116,180
TR 36,16,8576
MAA 244,112,164
TR 38,16,9088
MAA 252,120,164
TR 40,16,160
MAA 252,124,180
TR 42,16,672
MAA 248,124,176
TR 44,16,8608
MAA 248,120,160
buffer_load_dwordx4 a[160:163], v10, s[16:19], s52 offen sc1
MAA 220,104,172
TR 46,16,9120
MAA 220,108,188
ds_read_b64_tr_b16 a[48:49], v17
MAA 216,108,184
TR 50,17,512
MAA 216,104,168
TR 52,17,8448
MAA 200,96,168
TR 54,17,8960
MAA 200,100,184
buffer_load_dwordx4 a[164:167], v10, s[16:19], s52 offen offset:1024 sc1
MAA 204,100,188
TR 56,17,32
s_add_u32 s52, s52, 16384
MAA 204,96,172
TR 58,17,544
MAA 156,88,172
TR 60,17,8480
MAA 156,92,188
TR 62,17,8992
MAA 152,92,184
MAA 152,88,168
buffer_load_dwordx4 a[176:179], v10, s[16:19], s52 offen sc1
MAA 136,80,168
MAA 136,84,184
MAA 140,84,188
MAA 140,80,172
MAA 92,72,172
MAA 92,76,188
buffer_load_dwordx4 a[180:183], v10, s[16:19], s52 offen offset:1024 sc1
MAA 88,76,184
s_add_u32 s52, s52, 16384
MAA 88,72,168
MAA 72,64,168
MAA 72,68,184
MAA 76,68,188
MAA 76,64,172
s_waitcnt vmcnt(20) lgkmcnt(0)
s_barrier
MAA 32,0,128
buffer_load_dwordx4 a[168:171], v11, s[16:19], s53 offen sc1
MAA 32,4,144
s_waitcnt vmcnt(9)
ds_read_b128 v[24:27], v2 offset:4096
v_add_f32 v20, v20, v28
MAA 36,4,148
TR 64,16,16896
v_add_f32 v21, v21, v29
MAA 36,0,132
TR 66,16,17408
v_add_f32 v22, v22, v30
MAA 52,8,132
TR 68,16,25344
v_add_f32 v23, v23, v31
MAA 52,12,148
ds_read_b128 v[28:31], v2 offset:5120
MAA 48,12,144
buffer_load_dwordx4 a[172:175], v11, s[16:19], s53 offen offset:1024 sc1
MAA 48,8,128
TR 70,16,25856
s_add_u32 s53, s53, 16384
MAA 96,16,128
TR 72,16,16928
MAA 96,20,144
TR 74,16,17440
s_waitcnt lgkmcnt(7)
v_add_f32 v20, v20, v24
MAA 100,20,148
TR 76,16,25376
v_add_f32 v21, v21, v25
MAA 100,16,132
TR 78,16,25888
v_add_f32 v22, v22, v26
MAA 116,24,132
buffer_load_dwordx4 a[184:187], v11, s[16:19], s53 offen sc1
MAA 116,28,148
TR 80,16,16960
v_add_f32 v23, v23, v27
MAA 112,28,144
ds_read_b128 v[24:27], v2 offset:6144
s_waitcnt lgkmcnt(7)
v_add_f32 v20, v20, v28
MAA 112,24,128
TR 82,16,17472
v_add_f32 v21, v21, v29
MAA 160,32,128
TR 84,16,25408
v_add_f32 v22, v22, v30
MAA 160,36,144
TR 86,16,25920
v_add_f32 v23, v23, v31
MAA 164,36,148
buffer_load_dwordx4 a[188:191], v11, s[16:19], s53 offen offset:1024 sc1
MAA 164,32,132
ds_read_b128 v[28:31], v2 offset:7168
s_add_u32 s53, s53, 16384
MAA 180,40,132
TR 88,16,16992
s_add_u32 m0, s55, 84480
MAA 180,44,148
TR 90,16,17504
MAA 176,44,144
TR 92,16,25440
s_waitcnt lgkmcnt(7)
v_add_f32 v20, v20, v24
MAA 176,40,128
TR 94,16,25952
v_add_f32 v21, v21, v25
MAA 224,48,128
buffer_load_dwordx4 v12, s[32:35], s54 offen   lds
MAA 224,52,144
TR 96,16,17024
v_add_f32 v22, v22, v26
MAA 228,52,148
TR 98,16,17536
v_add_f32 v23, v23, v27
MAA 228,48,132
TR 100,16,25472
s_waitcnt lgkmcnt(7)
v_add_f32 v20, v20, v28
MAA 236,56,132
TR 102,16,25984
v_add_f32 v21, v21, v29
MAA 236,60,148
TR 104,16,17056
v_add_f32 v22, v22, v30
MAA 232,60,144
buffer_load_dwordx4 v13, s[32:35], s54 offen offset:1056   lds
MAA 232,56,128
TR 106,16,17568
v_add_f32 v23, v23, v31
MAA 188,40,140
TR 108,16,25504
MAA 188,44,156
TR 110,16,26016
MAA 184,44,152
TR 112,17,16896
MAA 184,40,136
TR 114,17,17408
MAA 168,32,136
buffer_load_dwordx4 v14, s[32:35], s54 offen offset:2112   lds
MAA 168,36,152
TR 116,17,25344
MAA 172,36,156
TR 118,17,25856
MAA 172,32,140
TR 120,17,16928
MAA 124,24,140
TR 122,17,17440
MAA 124,28,156
TR 124,17,25376
MAA 120,28,152
buffer_load_dwordx4 v15, s[32:35], s54 offen offset:3168   lds
MAA 120,24,136
TR 126,17,25888
MAA 104,16,136
MAA 104,20,152
MAA 108,20,156
MAA 108,16,140
MAA 60,8,140
MAA 60,12,156
MAA 56,12,152
MAA 56,8,136
MAA 40,0,136
MAA 40,4,152
MAA 44,4,156
MAA 44,0,140
s_waitcnt lgkmcnt(0)
s_barrier
MAA 64,64,128
TR 0,16,33792
s_add_u32 m0, s55, 101376
MAA 64,68,144
buffer_load_dwordx4 v12, s[80:83], s54 offen   lds
MAA 68,68,148
TR 2,16,34304
v_permlane32_swap_b32 v20, v22
MAA 68,64,132
TR 4,16,42240
v_permlane32_swap_b32 v21, v23
MAA 84,72,132
TR 6,16,42752
v_add_f32 v20, v20, v22
MAA 84,76,148
TR 8,16,33824
v_add_f32 v21, v21, v23
MAA 80,76,144
TR 10,16,34336
v_mul_f32 v20, 0xba800000, v20
MAA 80,72,128
buffer_load_dwordx4 v13, s[80:83], s54 offen offset:1056   lds
MAA 128,80,128
TR 12,16,42272
v_mul_f32 v21, 0x3a800000, v21
MAA 128,84,144
TR 14,16,42784
v_fma_f32 v21, -v20, v20, v21
MAA 132,84,148
TR 16,16,33856
v_max_f32 v21, 0, v21
MAA 132,80,132
TR 18,16,34368
v_add_f32 v21, 0x3727c5ac, v21
MAA 148,88,132
TR 20,16,42304
v_rsq_f32 v22, v21
MAA 148,92,148
buffer_load_dwordx4 v14, s[80:83], s54 offen offset:2112   lds
MAA 144,92,144
TR 22,16,42816
v_and_b32 v24, 31, v1
MAA 144,88,128
TR 24,16,33888
v_lshrrev_b32 v25, 5, v1
MAA 192,96,128
TR 26,16,34400
v_lshl_add_u32 v24, v24, 1, v25
MAA 192,100,144
TR 28,16,42336
v_and_b32 v25, 0xc0, v0
MAA 196,100,148
TR 30,16,42848
v_add_u32 v24, v24, v25
MAA 196,96,132
buffer_load_dwordx4 v15, s[80:83], s54 offen offset:3168   lds
MAA 212,104,132
TR 32,16,33920
s_add_u32 s54, s54, 458752
MAA 212,108,148
TR 34,16,34432
v_lshlrev_b32 v24, 4, v24
MAA 208,108,144
TR 36,16,42368
v_add_u32 v24, 152576, v24
MAA 208,104,128
TR 38,16,42880
v_mul_f32 v22, 0xbfb8aa3b, v22
MAA 240,112,128
ds_write_b128 v24, v[20:23]
s_mov_b32 s58, s98
MAA 240,116,144
ds_read_b64 v[20:21], v18
s_mov_b32 s67, s59
MAA 244,116,148
ds_read_b64 v[22:23], v18 offset:256
MAA 244,112,132
ds_read_b64 v[24:25], v19
MAA 252,120,132
ds_read_b64 v[26:27], v19 offset:256
MAA 252,124,148
ds_read_b32 a192, v18 offset:8
MAA 248,124,144
ds_read_b32 a193, v18 offset:264
v_mov_b32 v18, v5
MAA 248,120,128
buffer_load_dwordx4 a[128:131], v10, s[16:19], s52 offen sc1
MAA 220,104,140
ds_read_b32 a194, v19 offset:8
MAA 220,108,156
ds_read_b32 a195, v19 offset:264
v_mov_b32 v19, v6
MAA 216,108,152
TR 40,16,33952
MAA 216,104,136
TR 42,16,34464
MAA 200,96,136
TR 44,16,42400
MAA 200,100,152
buffer_load_dwordx4 a[132:135], v10, s[16:19], s52 offen offset:1024 sc1
MAA 204,100,156
TR 46,16,42912
s_add_u32 s52, s52, 16384
MAA 204,96,140
TR 48,17,33792
MAA 156,88,140
TR 50,17,34304
MAA 156,92,156
TR 52,17,42240
MAA 152,92,152
TR 54,17,42752
MAA 152,88,136
buffer_load_dwordx4 a[144:147], v10, s[16:19], s52 offen sc1
MAA 136,80,136
TR 56,17,33824
MAA 136,84,152
TR 58,17,34336
MAA 140,84,156
TR 60,17,42272
MAA 140,80,140
TR 62,17,42784
MAA 92,72,140
MAA 92,76,156
buffer_load_dwordx4 a[148:151], v10, s[16:19], s52 offen offset:1024 sc1
MAA 88,76,152
s_add_u32 s52, s52, 16384
MAA 88,72,136
MAA 72,64,136
MAA 72,68,152
MAA 76,68,156
MAA 76,64,140
s_waitcnt vmcnt(16) lgkmcnt(0)
s_barrier
MAA 32,0,160
buffer_load_dwordx4 a[136:139], v11, s[16:19], s53 offen sc1
MAA 32,4,176
ds_read_b128 v[4:7], v9 offset:512
MAA 36,4,180
ds_read_b128 v[28:31], v9 offset:576
MAA 36,0,164
TR 64,16,50688
MAA 52,8,164
TR 66,16,51200
MAA 52,12,180
TR 68,16,59136
MAA 48,12,176
buffer_load_dwordx4 a[140:143], v11, s[16:19], s53 offen offset:1024 sc1
MAA 48,8,160
TR 70,16,59648
s_add_u32 s53, s53, 16384
MAA 96,16,160
TR 72,16,50720
MAA 96,20,176
TR 74,16,51232
s_waitcnt lgkmcnt(7)
v_fmac_f32 v64, v4, v20
MAA 100,20,180
TR 76,16,59168
v_fmac_f32 v65, v5, v20
MAA 100,16,164
TR 78,16,59680
v_fmac_f32 v66, v6, v20
MAA 116,24,164
buffer_load_dwordx4 a[152:155], v11, s[16:19], s53 offen sc1
MAA 116,28,180
TR 80,16,50752
v_fmac_f32 v67, v7, v20
MAA 112,28,176
TR 82,16,51264
v_fmac_f32 v68, v4, v22
MAA 112,24,160
TR 84,16,59200
v_fmac_f32 v69, v5, v22
MAA 160,32,160
TR 86,16,59712
v_fmac_f32 v70, v6, v22
MAA 160,36,176
TR 88,16,50784
v_fmac_f32 v71, v7, v22
MAA 164,36,180
buffer_load_dwordx4 a[156:159], v11, s[16:19], s53 offen offset:1024 sc1
MAA 164,32,164
TR 90,16,51296
s_add_u32 s53, s53, 16384
MAA 180,40,164
TR 92,16,59232
s_add_u32 m0, s55, 118272
MAA 180,44,180
TR 94,16,59744
v_fmac_f32 v72, v4, v24
MAA 176,44,176
TR 96,16,50816
v_fmac_f32 v73, v5, v24
MAA 176,40,160
TR 98,16,51328
v_fmac_f32 v74, v6, v24
MAA 224,48,160
buffer_load_dwordx4 v12, s[32:35], s54 offen   lds
MAA 224,52,176
TR 100,16,59264
v_fmac_f32 v75, v7, v24
MAA 228,52,180
TR 102,16,59776
v_fmac_f32 v76, v4, v26
MAA 228,48,164
TR 104,16,50848
v_fmac_f32 v77, v5, v26
MAA 236,56,164
TR 106,16,51360
v_fmac_f32 v78, v6, v26
MAA 236,60,180
TR 108,16,59296
v_fmac_f32 v79, v7, v26
MAA 232,60,176
buffer_load_dwordx4 v13, s[32:35], s54 offen offset:1056   lds
MAA 232,56,160
ds_read_b128 v[4:7], v8 offset:512
s_waitcnt lgkmcnt(15)
v_fmac_f32 v80, v28, v20
s_waitcnt vmcnt(18)
MAA 188,40,172
TR 110,16,59808
v_fmac_f32 v81, v29, v20
MAA 188,44,188
TR 112,17,50688
v_fmac_f32 v82, v30, v20
MAA 184,44,184
TR 114,17,51200
v_fmac_f32 v83, v31, v20
MAA 184,40,168
TR 116,17,59136
v_fmac_f32 v84, v28, v22
MAA 168,32,168
buffer_load_dwordx4 v14, s[32:35], s54 offen offset:2112   lds
MAA 168,36,184
TR 118,17,59648
v_fmac_f32 v85, v29, v22
MAA 172,36,188
TR 120,17,50720
v_fmac_f32 v86, v30, v22
MAA 172,32,172
TR 122,17,51232
v_fmac_f32 v87, v31, v22
MAA 124,24,172
TR 124,17,59168
v_fmac_f32 v88, v28, v24
MAA 124,28,188
TR 126,17,59680
v_fmac_f32 v89, v29, v24
MAA 120,28,184
buffer_load_dwordx4 v15, s[32:35], s54 offen offset:3168   lds
MAA 120,24,168
v_fmac_f32 v90, v30, v24
v_fmac_f32 v91, v31, v24
MAA 104,16,168
v_fmac_f32 v92, v28, v26
v_fmac_f32 v93, v29, v26
MAA 104,20,184
v_fmac_f32 v94, v30, v26
v_fmac_f32 v95, v31, v26
MAA 108,20,188
s_waitcnt lgkmcnt(9)
v_fmac_f32 v240, v4, v20
v_fmac_f32 v241, v5, v20
MAA 108,16,172
v_fmac_f32 v242, v6, v20
v_fmac_f32 v243, v7, v20
MAA 60,8,172
v_fmac_f32 v244, v4, v22
v_fmac_f32 v245, v5, v22
MAA 60,12,188
v_fmac_f32 v246, v6, v22
v_fmac_f32 v247, v7, v22
MAA 56,12,184
MAA 56,8,168
MAA 40,0,168
MAA 40,4,184
MAA 44,4,188
MAA 44,0,172
s_waitcnt vmcnt(16) lgkmcnt(0)
s_barrier
MAA 64,64,160
ds_read_b128 v[4:7], v9
s_add_u32 m0, s55, 135168
MAA 64,68,176
buffer_load_dwordx4 v12, s[80:83], s54 offen   lds
MAA 68,68,180
ds_read_b128 v[28:31], v9 offset:64
MAA 68,64,164
ds_read_b64_tr_b16 a[0:1], v16
MAA 84,72,164
TR 2,16,512
MAA 84,76,180
TR 4,16,8448
MAA 80,76,176
TR 6,16,8960
MAA 80,72,160
buffer_load_dwordx4 v13, s[80:83], s54 offen offset:1056   lds
MAA 128,80,160
TR 8,16,32
s_waitcnt lgkmcnt(6)
v_fmac_f32 v32, v4, v20
MAA 128,84,176
TR 10,16,544
v_fmac_f32 v33, v5, v20
MAA 132,84,180
TR 12,16,8480
v_fmac_f32 v34, v6, v20
MAA 132,80,164
TR 14,16,8992
v_fmac_f32 v35, v7, v20
MAA 148,88,164
TR 16,16,64
v_fmac_f32 v36, v4, v22
MAA 148,92,180
buffer_load_dwordx4 v14, s[80:83], s54 offen offset:2112   lds
MAA 144,92,176
TR 18,16,576
v_fmac_f32 v37, v5, v22
MAA 144,88,160
TR 20,16,8512
v_fmac_f32 v38, v6, v22
MAA 192,96,160
TR 22,16,9024
v_fmac_f32 v39, v7, v22
MAA 192,100,176
TR 24,16,96
v_fmac_f32 v40, v4, v24
MAA 196,100,180
TR 26,16,608
v_fmac_f32 v41, v5, v24
MAA 196,96,164
buffer_load_dwordx4 v15, s[80:83], s54 offen offset:3168   lds
MAA 212,104,164
TR 28,16,8544
s_add_u32 s54, s54, 458752
MAA 212,108,180
TR 30,16,9056
v_fmac_f32 v42, v6, v24
MAA 208,108,176
TR 32,16,128
v_fmac_f32 v43, v7, v24
MAA 208,104,160
TR 34,16,640
v_fmac_f32 v44, v4, v26
MAA 240,112,160
TR 36,16,8576
v_fmac_f32 v45, v5, v26
MAA 240,116,176
TR 38,16,9088
v_fmac_f32 v46, v6, v26
MAA 244,116,180
TR 40,16,160
v_fmac_f32 v47, v7, v26
MAA 244,112,164
ds_read_b128 v[4:7], v8
s_waitcnt lgkmcnt(15)
v_fmac_f32 v48, v28, v20
MAA 252,120,164
TR 42,16,672
v_fmac_f32 v49, v29, v20
MAA 252,124,180
TR 44,16,8608
v_fmac_f32 v50, v30, v20
MAA 248,124,176
TR 46,16,9120
v_fmac_f32 v51, v31, v20
MAA 248,120,160
buffer_load_dwordx4 a[160:163], v10, s[16:19], s52 offen sc1
MAA 220,104,172
ds_read_b64_tr_b16 a[48:49], v17
v_fmac_f32 v52, v28, v22
MAA 220,108,188
TR 50,17,512
v_fmac_f32 v53, v29, v22
MAA 216,108,184
TR 52,17,8448
v_fmac_f32 v54, v30, v22
MAA 216,104,168
TR 54,17,8960
.Lpad23:
s_cbranch_execz .Lnopoll59r
v_fmac_f32 v55, v31, v22
MAA 200,96,168
TR 56,17,32
v_fmac_f32 v56, v28, v24
MAA 200,100,184
buffer_load_dwordx4 a[164:167], v10, s[16:19], s52 offen offset:1024 sc1
MAA 204,100,188
TR 58,17,544
s_add_u32 s52, s52, 16384
MAA 204,96,172
TR 60,17,8480
v_fmac_f32 v57, v29, v24
MAA 156,88,172
TR 62,17,8992
v_fmac_f32 v58, v30, v24
MAA 156,92,188
v_fmac_f32 v59, v31, v24
v_fmac_f32 v60, v28, v26
MAA 152,92,184
v_fmac_f32 v61, v29, v26
v_fmac_f32 v62, v30, v26
MAA 152,88,168
buffer_load_dwordx4 a[176:179], v10, s[16:19], s52 offen sc1
MAA 136,80,168
v_fmac_f32 v63, v31, v26
s_waitcnt lgkmcnt(11)
v_fmac_f32 v224, v4, v20
MAA 136,84,184
v_fmac_f32 v225, v5, v20
v_fmac_f32 v226, v6, v20
MAA 140,84,188
v_fmac_f32 v227, v7, v20
v_fmac_f32 v228, v4, v22
MAA 140,80,172
v_fmac_f32 v229, v5, v22
v_fmac_f32 v230, v6, v22
MAA 92,72,172
v_fmac_f32 v231, v7, v22
MAA 92,76,188
buffer_load_dwordx4 a[180:183], v10, s[16:19], s52 offen offset:1024 sc1
MAA 88,76,184
s_add_u32 s52, s52, 16384
MAA 88,72,168
MAA 72,64,168
MAA 72,68,184
MAA 76,68,188
MAA 76,64,172
s_waitcnt vmcnt(16) lgkmcnt(0)
s_barrier
MAA 32,0,128
buffer_load_dwordx4 a[168:171], v11, s[16:19], s53 offen sc1
MAA 32,4,144
ds_read_b128 v[4:7], v9 offset:640
MAA 36,4,148
ds_read_b128 v[28:31], v9 offset:704
MAA 36,0,132
TR 64,16,16896
MAA 52,8,132
TR 66,16,17408
MAA 52,12,148
buffer_load_dwordx4 a[172:175], v11, s[16:19], s53 offen offset:1024 sc1
MAA 48,12,144
TR 68,16,25344
s_add_u32 s53, s53, 16384
MAA 48,8,128
TR 70,16,25856
MAA 96,16,128
TR 72,16,16928
MAA 96,20,144
TR 74,16,17440
s_waitcnt lgkmcnt(7)
v_fmac_f32 v128, v4, v20
MAA 100,20,148
buffer_load_dwordx4 a[184:187], v11, s[16:19], s53 offen sc1
MAA 100,16,132
TR 76,16,25376
v_fmac_f32 v129, v5, v20
MAA 116,24,132
TR 78,16,25888
v_fmac_f32 v130, v6, v20
MAA 116,28,148
TR 80,16,16960
v_fmac_f32 v131, v7, v20
MAA 112,28,144
TR 82,16,17472
v_fmac_f32 v132, v4, v22
MAA 112,24,128
buffer_load_dwordx4 a[188:191], v11, s[16:19], s53 offen offset:1024 sc1
MAA 160,32,128
TR 84,16,25408
s_add_u32 s53, s53, 16384
MAA 160,36,144
TR 86,16,25920
s_add_u32 m0, s55, 84480
MAA 164,36,148
TR 88,16,16992
v_fmac_f32 v133, v5, v22
MAA 164,32,132
TR 90,16,17504
v_fmac_f32 v134, v6, v22
MAA 180,40,132
buffer_load_dwordx4 v12, s[32:35], s54 offen   lds
MAA 180,44,148
TR 92,16,25440
v_fmac_f32 v135, v7, v22
MAA 176,44,144
TR 94,16,25952
v_fmac_f32 v136, v4, v24
MAA 176,40,128
TR 96,16,17024
v_fmac_f32 v137, v5, v24
MAA 224,48,128
TR 98,16,17536
v_fmac_f32 v138, v6, v24
MAA 224,52,144
buffer_load_dwordx4 v13, s[32:35], s54 offen offset:1056   lds
MAA 228,52,148
TR 100,16,25472
v_fmac_f32 v139, v7, v24
MAA 228,48,132
TR 102,16,25984
v_fmac_f32 v140, v4, v26
MAA 236,56,132
TR 104,16,17056
v_fmac_f32 v141, v5, v26
MAA 236,60,148
TR 106,16,17568
v_fmac_f32 v142, v6, v26
MAA 232,60,144
buffer_load_dwordx4 v14, s[32:35], s54 offen offset:2112   lds
MAA 232,56,128
TR 108,16,25504
v_fmac_f32 v143, v7, v26
s_waitcnt vmcnt(19)
MAA 188,40,140
ds_read_b128 v[4:7], v8 offset:576
s_waitcnt lgkmcnt(15)
v_fmac_f32 v144, v28, v20
MAA 188,44,156
TR 110,16,26016
v_fmac_f32 v145, v29, v20
MAA 184,44,152
TR 112,17,16896
v_fmac_f32 v146, v30, v20
MAA 184,40,136
buffer_load_dwordx4 v15, s[32:35], s54 offen offset:3168   lds
MAA 168,32,136
TR 114,17,17408
s_mov_b32 m0, s67
MAA 168,36,152
TR 116,17,25344
v_fmac_f32 v147, v31, v20
MAA 172,36,156
TR 118,17,25856
v_fmac_f32 v148, v28, v22
MAA 172,32,140
TR 120,17,16928
v_fmac_f32 v149, v29, v22
MAA 124,24,140
buffer_load_dwordx4 v18, s[28:31], s58 offen lds
MAA 124,28,156
TR 122,17,17440
v_fmac_f32 v150, v30, v22
MAA 120,28,152
TR 124,17,25376
v_fmac_f32 v151, v31, v22
MAA 120,24,136
TR 126,17,25888
v_fmac_f32 v152, v28, v24
MAA 104,16,136
v_fmac_f32 v153, v29, v24
v_fmac_f32 v154, v30, v24
MAA 104,20,152
v_fmac_f32 v155, v31, v24
v_fmac_f32 v156, v28, v26
MAA 108,20,156
v_fmac_f32 v157, v29, v26
v_fmac_f32 v158, v30, v26
MAA 108,16,140
v_fmac_f32 v159, v31, v26
s_waitcnt lgkmcnt(9)
v_fmac_f32 v248, v4, v20
MAA 60,8,140
v_fmac_f32 v249, v5, v20
v_fmac_f32 v250, v6, v20
MAA 60,12,156
v_fmac_f32 v251, v7, v20
v_fmac_f32 v252, v4, v22
MAA 56,12,152
v_fmac_f32 v253, v5, v22
v_fmac_f32 v254, v6, v22
MAA 56,8,136
v_fmac_f32 v255, v7, v22
MAA 40,0,136
MAA 40,4,152
MAA 44,4,156
MAA 44,0,140
s_waitcnt vmcnt(17) lgkmcnt(0)
s_barrier
MAA 64,64,128
ds_read_b128 v[4:7], v9 offset:128
s_add_u32 m0, s55, 101376
MAA 64,68,144
buffer_load_dwordx4 v12, s[80:83], s54 offen   lds
MAA 68,68,148
ds_read_b128 v[28:31], v9 offset:192
MAA 68,64,132
TR 0,16,33792
MAA 84,72,132
TR 2,16,34304
MAA 84,76,148
TR 4,16,42240
MAA 80,76,144
buffer_load_dwordx4 v13, s[80:83], s54 offen offset:1056   lds
MAA 80,72,128
TR 6,16,42752
MAA 128,80,128
TR 8,16,33824
s_waitcnt lgkmcnt(6)
v_fmac_f32 v96, v4, v20
MAA 128,84,144
TR 10,16,34336
v_fmac_f32 v97, v5, v20
MAA 132,84,148
TR 12,16,42272
v_fmac_f32 v98, v6, v20
MAA 132,80,132
buffer_load_dwordx4 v14, s[80:83], s54 offen offset:2112   lds
MAA 148,88,132
TR 14,16,42784
v_fmac_f32 v99, v7, v20
MAA 148,92,148
TR 16,16,33856
v_fmac_f32 v100, v4, v22
MAA 144,92,144
TR 18,16,34368
v_fmac_f32 v101, v5, v22
MAA 144,88,128
TR 20,16,42304
v_fmac_f32 v102, v6, v22
MAA 192,96,128
buffer_load_dwordx4 v15, s[80:83], s54 offen offset:3168   lds
MAA 192,100,144
TR 22,16,42816
s_add_u32 s54, s54, 458752
MAA 196,100,148
TR 24,16,33888
s_mov_b32 m0, s67
MAA 196,96,132
TR 26,16,34400
v_fmac_f32 v103, v7, v22
MAA 212,104,132
TR 28,16,42336
v_fmac_f32 v104, v4, v24
MAA 212,108,148
buffer_load_dwordx4 v19, s[28:31], s58 offen offset:1056 lds
MAA 208,108,144
TR 30,16,42848
s_add_u32 s67, s67, 8448
MAA 208,104,128
TR 32,16,33920
s_add_u32 s58, s58, 0x40000
MAA 240,112,128
TR 34,16,34432
v_fmac_f32 v105, v5, v24
MAA 240,116,144
TR 36,16,42368
v_fmac_f32 v106, v6, v24
MAA 244,116,148
TR 38,16,42880
v_fmac_f32 v107, v7, v24
MAA 244,112,132
TR 40,16,33952
v_fmac_f32 v108, v4, v26
MAA 252,120,132
TR 42,16,34464
v_fmac_f32 v109, v5, v26
MAA 252,124,148
TR 44,16,42400
v_fmac_f32 v110, v6, v26
MAA 248,124,144
TR 46,16,42912
v_fmac_f32 v111, v7, v26
MAA 248,120,128
buffer_load_dwordx4 a[128:131], v10, s[16:19], s52 offen sc1
MAA 220,104,140
ds_read_b128 v[4:7], v8 offset:64
s_waitcnt lgkmcnt(15)
v_fmac_f32 v112, v28, v20
MAA 220,108,156
TR 48,17,33792
v_fmac_f32 v113, v29, v20
MAA 216,108,152
TR 50,17,34304
v_fmac_f32 v114, v30, v20
MAA 216,104,136
TR 52,17,42240
v_fmac_f32 v115, v31, v20
MAA 200,96,136
buffer_load_dwordx4 a[132:135], v10, s[16:19], s52 offen offset:1024 sc1
MAA 200,100,152
TR 54,17,42752
s_add_u32 s52, s52, 16384
MAA 204,100,156
TR 56,17,33824
v_fmac_f32 v116, v28, v22
MAA 204,96,140
TR 58,17,34336
v_fmac_f32 v117, v29, v22
MAA 156,88,140
TR 60,17,42272
v_fmac_f32 v118, v30, v22
MAA 156,92,156
buffer_load_dwordx4 a[144:147], v10, s[16:19], s52 offen sc1
MAA 152,92,152
TR 62,17,42784
v_fmac_f32 v119, v31, v22
MAA 152,88,136
v_fmac_f32 v120, v28, v24
v_fmac_f32 v121, v29, v24
MAA 136,80,136
v_fmac_f32 v122, v30, v24
v_fmac_f32 v123, v31, v24
MAA 136,84,152
v_fmac_f32 v124, v28, v26
v_fmac_f32 v125, v29, v26
MAA 140,84,156
buffer_load_dwordx4 a[148:151], v10, s[16:19], s52 offen offset:1024 sc1
MAA 140,80,140
s_add_u32 s52, s52, 16384
v_fmac_f32 v126, v30, v26
v_fmac_f32 v127, v31, v26
MAA 92,72,140
s_waitcnt lgkmcnt(8)
v_fmac_f32 v232, v4, v20
v_fmac_f32 v233, v5, v20
MAA 92,76,156
v_fmac_f32 v234, v6, v20
v_fmac_f32 v235, v7, v20
MAA 88,76,152
v_fmac_f32 v236, v4, v22
v_fmac_f32 v237, v5, v22
MAA 88,72,136
v_fmac_f32 v238, v6, v22
v_fmac_f32 v239, v7, v22
MAA 72,64,136
MAA 72,68,152
MAA 76,68,156
MAA 76,64,140
s_waitcnt vmcnt(18) lgkmcnt(0)
s_barrier
MAA 32,0,160
buffer_load_dwordx4 a[136:139], v11, s[16:19], s53 offen sc1
MAA 32,4,176
ds_read_b128 v[4:7], v9 offset:768
MAA 36,4,180
ds_read_b128 v[28:31], v9 offset:832
MAA 36,0,164
TR 64,16,50688
MAA 52,8,164
TR 66,16,51200
MAA 52,12,180
buffer_load_dwordx4 a[140:143], v11, s[16:19], s53 offen offset:1024 sc1
MAA 48,12,176
TR 68,16,59136
s_add_u32 s53, s53, 16384
MAA 48,8,160
TR 70,16,59648
MAA 96,16,160
TR 72,16,50720
MAA 96,20,176
TR 74,16,51232
s_waitcnt lgkmcnt(7)
v_fmac_f32 v192, v4, v20
MAA 100,20,180
buffer_load_dwordx4 a[152:155], v11, s[16:19], s53 offen sc1
MAA 100,16,164
TR 76,16,59168
v_fmac_f32 v193, v5, v20
MAA 116,24,164
TR 78,16,59680
v_fmac_f32 v194, v6, v20
MAA 116,28,180
TR 80,16,50752
v_fmac_f32 v195, v7, v20
MAA 112,28,176
TR 82,16,51264
v_fmac_f32 v196, v4, v22
MAA 112,24,160
buffer_load_dwordx4 a[156:159], v11, s[16:19], s53 offen offset:1024 sc1
MAA 160,32,160
TR 84,16,59200
s_add_u32 s53, s53, 16384
MAA 160,36,176
TR 86,16,59712
s_add_u32 m0, s55, 118272
MAA 164,36,180
TR 88,16,50784
v_fmac_f32 v197, v5, v22
MAA 164,32,164
TR 90,16,51296
v_fmac_f32 v198, v6, v22
MAA 180,40,164
buffer_load_dwordx4 v12, s[32:35], s54 offen   lds
MAA 180,44,180
TR 92,16,59232
v_fmac_f32 v199, v7, v22
MAA 176,44,176
TR 94,16,59744
v_fmac_f32 v200, v4, v24
MAA 176,40,160
TR 96,16,50816
v_fmac_f32 v201, v5, v24
MAA 224,48,160
TR 98,16,51328
v_fmac_f32 v202, v6, v24
MAA 224,52,176
buffer_load_dwordx4 v13, s[32:35], s54 offen offset:1056   lds
MAA 228,52,180
TR 100,16,59264
v_fmac_f32 v203, v7, v24
MAA 228,48,164
TR 102,16,59776
v_fmac_f32 v204, v4, v26
MAA 236,56,164
TR 104,16,50848
v_fmac_f32 v205, v5, v26
MAA 236,60,180
TR 106,16,51360
v_fmac_f32 v206, v6, v26
MAA 232,60,176
buffer_load_dwordx4 v14, s[32:35], s54 offen offset:2112   lds
MAA 232,56,160
TR 108,16,59296
v_fmac_f32 v207, v7, v26
s_waitcnt vmcnt(21)
MAA 188,40,172
TR 110,16,59808
s_waitcnt lgkmcnt(15)
v_fmac_f32 v208, v28, v20
MAA 188,44,188
TR 112,17,50688
v_fmac_f32 v209, v29, v20
MAA 184,44,184
TR 114,17,51200
v_fmac_f32 v210, v30, v20
MAA 184,40,168
buffer_load_dwordx4 v15, s[32:35], s54 offen offset:3168   lds
MAA 168,32,168
TR 116,17,59136
s_mov_b32 m0, s67
MAA 168,36,184
TR 118,17,59648
v_fmac_f32 v211, v31, v20
MAA 172,36,188
TR 120,17,50720
v_fmac_f32 v212, v28, v22
MAA 172,32,172
TR 122,17,51232
v_fmac_f32 v213, v29, v22
MAA 124,24,172
buffer_load_dwordx4 v18, s[28:31], s58 offen lds
MAA 124,28,188
TR 124,17,59168
v_fmac_f32 v214, v30, v22
MAA 120,28,184
TR 126,17,59680
v_fmac_f32 v215, v31, v22
MAA 120,24,168
v_fmac_f32 v216, v28, v24
v_fmac_f32 v217, v29, v24
MAA 104,16,168
v_fmac_f32 v218, v30, v24
v_fmac_f32 v219, v31, v24
MAA 104,20,184
v_fmac_f32 v220, v28, v26
v_fmac_f32 v221, v29, v26
MAA 108,20,188
v_fmac_f32 v222, v30, v26
v_fmac_f32 v223, v31, v26
MAA 108,16,172
MAA 60,8,172
MAA 60,12,188
MAA 56,12,184
MAA 56,8,168
MAA 40,0,168
MAA 40,4,184
MAA 44,4,188
MAA 44,0,172
s_waitcnt vmcnt(19) lgkmcnt(0)
s_barrier
MAA 64,64,160
ds_read_b128 v[4:7], v9 offset:256
s_add_u32 m0, s55, 135168
MAA 64,68,176
buffer_load_dwordx4 v12, s[80:83], s54 offen   lds
MAA 68,68,180
ds_read_b128 v[28:31], v9 offset:320
MAA 68,64,164
ds_read_b64_tr_b16 a[0:1], v16
MAA 84,72,164
TR 2,16,512
MAA 84,76,180
TR 4,16,8448
MAA 80,76,176
buffer_load_dwordx4 v13, s[80:83], s54 offen offset:1056   lds
MAA 80,72,160
TR 6,16,8960
MAA 128,80,160
TR 8,16,32
s_waitcnt lgkmcnt(6)
v_fmac_f32 v160, v4, v20
MAA 128,84,176
TR 10,16,544
v_fmac_f32 v161, v5, v20
MAA 132,84,180
TR 12,16,8480
v_fmac_f32 v162, v6, v20
MAA 132,80,164
buffer_load_dwordx4 v14, s[80:83], s54 offen offset:2112   lds
MAA 148,88,164
TR 14,16,8992
v_fmac_f32 v163, v7, v20
MAA 148,92,180
TR 16,16,64
v_fmac_f32 v164, v4, v22
MAA 144,92,176
TR 18,16,576
v_fmac_f32 v165, v5, v22
MAA 144,88,160
TR 20,16,8512
v_fmac_f32 v166, v6, v22
MAA 192,96,160
buffer_load_dwordx4 v15, s[80:83], s54 offen offset:3168   lds
MAA 192,100,176
TR 22,16,9024
s_add_u32 s54, s54, 458752
MAA 196,100,180
TR 24,16,96
s_mov_b32 m0, s67
MAA 196,96,164
TR 26,16,608
v_fmac_f32 v167, v7, v22
MAA 212,104,164
TR 28,16,8544
v_fmac_f32 v168, v4, v24
MAA 212,108,180
buffer_load_dwordx4 v19, s[28:31], s58 offen offset:1056 lds
MAA 208,108,176
TR 30,16,9056
s_add_u32 s67, s67, 8448
MAA 208,104,160
TR 32,16,128
s_add_u32 s46, s46, 1
MAA 240,112,160
TR 34,16,640
s_xor_b32 s58, s46, s87
MAA 240,116,176
TR 36,16,8576
s_mul_i32 s58, s58, 458752
MAA 244,116,180
TR 38,16,9088
v_fmac_f32 v169, v5, v24
MAA 244,112,164
TR 40,16,160
v_fmac_f32 v170, v6, v24
MAA 252,120,164
TR 42,16,672
v_fmac_f32 v171, v7, v24
MAA 252,124,180
TR 44,16,8608
v_fmac_f32 v172, v4, v26
MAA 248,124,176
TR 46,16,9120
v_fmac_f32 v173, v5, v26
MAA 248,120,160
buffer_load_dwordx4 a[160:163], v10, s[16:19], s52 offen sc1
MAA 220,104,172
ds_read_b64_tr_b16 a[48:49], v17
v_fmac_f32 v174, v6, v26
MAA 220,108,188
TR 50,17,512
v_fmac_f32 v175, v7, v26
MAA 216,108,184
TR 52,17,8448
s_waitcnt lgkmcnt(15)
v_fmac_f32 v176, v28, v20
MAA 216,104,168
TR 54,17,8960
v_fmac_f32 v177, v29, v20
MAA 200,96,168
buffer_load_dwordx4 a[164:167], v10, s[16:19], s52 offen offset:1024 sc1
MAA 200,100,184
TR 56,17,32
s_add_u32 s52, s52, 16384
MAA 204,100,188
TR 58,17,544
v_fmac_f32 v178, v30, v20
MAA 204,96,172
.Lpad24:
s_cbranch_execz .Lnopoll59r
TR 60,17,8480
v_fmac_f32 v179, v31, v20
MAA 156,88,172
TR 62,17,8992
v_fmac_f32 v180, v28, v22
MAA 156,92,188
buffer_load_dwordx4 a[176:179], v10, s[16:19], s52 offen sc1
MAA 152,92,184
v_fmac_f32 v181, v29, v22
v_fmac_f32 v182, v30, v22
MAA 152,88,168
v_fmac_f32 v183, v31, v22
v_fmac_f32 v184, v28, v24
MAA 136,80,168
v_fmac_f32 v185, v29, v24
v_fmac_f32 v186, v30, v24
MAA 136,84,184
v_fmac_f32 v187, v31, v24
v_fmac_f32 v188, v28, v26
MAA 140,84,188
buffer_load_dwordx4 a[180:183], v10, s[16:19], s52 offen offset:1024 sc1
MAA 140,80,172
s_add_u32 s52, s52, 16384
v_fmac_f32 v189, v29, v26
v_fmac_f32 v190, v30, v26
MAA 92,72,172
v_fmac_f32 v191, v31, v26
v_accvgpr_read_b32 v28, a192
MAA 92,76,188
v_accvgpr_read_b32 v29, a193
v_accvgpr_read_b32 v30, a194
MAA 88,76,184
v_accvgpr_read_b32 v31, a195
MAA 88,72,168
MAA 72,64,168
MAA 72,68,184
MAA 76,68,188
MAA 76,64,172
s_mov_b32 s15, -4
.p2align 6
.Lk64:
s_waitcnt vmcnt(18) lgkmcnt(0)
s_barrier
MAA 32,0,128
TR 64,16,16896
MAA 32,4,144
buffer_load_dwordx4 a[168:171], v11, s[16:19], s53 offen sc1
MAA 36,4,148
TR 66,16,17408
MAA 36,0,132
TR 68,16,25344
MAA 52,8,132
TR 70,16,25856
MAA 52,12,148
MAA 48,12,144
TR 72,16,16928
MAA 48,8,128
buffer_load_dwordx4 a[172:175], v11, s[16:19], s53 offen offset:1024 sc1
MAA 96,16,128
TR 74,16,17440
s_add_u32 s53, s53, 16384
MAA 96,20,144
TR 76,16,25376
MAA 100,20,148
MAA 100,16,132
TR 78,16,25888
MAA 116,24,132
TR 80,16,16960
MAA 116,28,148
buffer_load_dwordx4 a[184:187], v11, s[16:19], s53 offen sc1
MAA 112,28,144
TR 82,16,17472
MAA 112,24,128
MAA 160,32,128
TR 84,16,25408
MAA 160,36,144
TR 86,16,25920
MAA 164,36,148
TR 88,16,16992
MAA 164,32,132
buffer_load_dwordx4 a[188:191], v11, s[16:19], s53 offen offset:1024 sc1
MAA 180,40,132
s_add_u32 s53, s53, 16384
MAA 180,44,148
TR 90,16,17504
MAA 176,44,144
TR 92,16,25440
MAA 176,40,128
TR 94,16,25952
MAA 224,48,128
s_add_u32 m0, s55, 84480
MAA 224,52,144
buffer_load_dwordx4 v12, s[32:35], s54 offen   lds
MAA 228,52,148
TR 96,16,17024
MAA 228,48,132
TR 98,16,17536
MAA 236,56,132
TR 100,16,25472
MAA 236,60,148
TR 102,16,25984
MAA 232,60,144
MAA 232,56,128
TR 104,16,17056
s_waitcnt vmcnt(19)
MAA 188,40,140
buffer_load_dwordx4 v13, s[32:35], s54 offen offset:1056   lds
MAA 188,44,156
TR 106,16,17568
MAA 184,44,152
TR 108,16,25504
MAA 184,40,136
MAA 168,32,136
TR 110,16,26016
MAA 168,36,152
buffer_load_dwordx4 v14, s[32:35], s54 offen offset:2112   lds
MAA 172,36,156
TR 112,17,16896
MAA 172,32,140
TR 114,17,17408
MAA 124,24,140
MAA 124,28,156
TR 116,17,25344
MAA 120,28,152
TR 118,17,25856
MAA 120,24,136
buffer_load_dwordx4 v15, s[32:35], s54 offen offset:3168   lds
MAA 104,16,136
TR 120,17,16928
MAA 104,20,152
MAA 108,20,156
TR 122,17,17440
MAA 108,16,140
TR 124,17,25376
MAA 60,8,140
TR 126,17,25888
s_mov_b32 m0, s67
MAA 60,12,156
buffer_load_dwordx4 v18, s[28:31], s58 offen lds
MAA 56,12,152
MAA 56,8,136
MAA 40,0,136
MAA 40,4,152
MAA 44,4,156
MAA 44,0,140
s_waitcnt vmcnt(19) lgkmcnt(0)
s_barrier
MAA 64,64,128
TR 0,16,33792
s_add_u32 m0, s55, 101376
MAA 64,68,144
buffer_load_dwordx4 v12, s[80:83], s54 offen   lds
MAA 68,68,148
TR 2,16,34304
MAA 68,64,132
TR 4,16,42240
MAA 84,72,132
TR 6,16,42752
MAA 84,76,148
MAA 80,76,144
TR 8,16,33824
MAA 80,72,128
buffer_load_dwordx4 v13, s[80:83], s54 offen offset:1056   lds
MAA 128,80,128
TR 10,16,34336
MAA 128,84,144
TR 12,16,42272
MAA 132,84,148
TR 14,16,42784
MAA 132,80,132
MAA 148,88,132
TR 16,16,33856
MAA 148,92,148
buffer_load_dwordx4 v14, s[80:83], s54 offen offset:2112   lds
MAA 144,92,144
TR 18,16,34368
MAA 144,88,128
TR 20,16,42304
MAA 192,96,128
MAA 192,100,144
TR 22,16,42816
MAA 196,100,148
TR 24,16,33888
MAA 196,96,132
buffer_load_dwordx4 v15, s[80:83], s54 offen offset:3168   lds
MAA 212,104,132
TR 26,16,34400
s_add_u32 s54, s54, 458752
MAA 212,108,148
TR 28,16,42336
MAA 208,108,144
MAA 208,104,128
TR 30,16,42848
MAA 240,112,128
TR 32,16,33920
s_mov_b32 m0, s67
MAA 240,116,144
buffer_load_dwordx4 v19, s[28:31], s58 offen offset:1056 lds
MAA 244,116,148
s_add_u32 s67, s67, 8448
s_add_u32 s58, s58, 0x40000
MAA 244,112,132
TR 34,16,34432
MAA 252,120,132
MAA 252,124,148
TR 36,16,42368
MAA 248,124,144
TR 38,16,42880
MAA 248,120,128
buffer_load_dwordx4 a[128:131], v10, s[16:19], s52 offen sc1
MAA 220,104,140
TR 40,16,33952
MAA 220,108,156
TR 42,16,34464
MAA 216,108,152
MAA 216,104,136
TR 44,16,42400
MAA 200,96,136
TR 46,16,42912
MAA 200,100,152
buffer_load_dwordx4 a[132:135], v10, s[16:19], s52 offen offset:1024 sc1
MAA 204,100,156
TR 48,17,33792
s_add_u32 s52, s52, 16384
MAA 204,96,140
MAA 156,88,140
TR 50,17,34304
MAA 156,92,156
TR 52,17,42240
MAA 152,92,152
TR 54,17,42752
MAA 152,88,136
buffer_load_dwordx4 a[144:147], v10, s[16:19], s52 offen sc1
MAA 136,80,136
TR 56,17,33824
MAA 136,84,152
MAA 140,84,156
TR 58,17,34336
MAA 140,80,140
TR 60,17,42272
MAA 92,72,140
TR 62,17,42784
MAA 92,76,156
buffer_load_dwordx4 a[148:151], v10, s[16:19], s52 offen offset:1024 sc1
MAA 88,76,152
s_add_u32 s52, s52, 16384
MAA 88,72,136
MAA 72,64,136
MAA 72,68,152
MAA 76,68,156
MAA 76,64,140
s_waitcnt vmcnt(18) lgkmcnt(0)
s_barrier
MAA 32,0,160
TR 64,16,50688
MAA 32,4,176
buffer_load_dwordx4 a[136:139], v11, s[16:19], s53 offen sc1
MAA 36,4,180
TR 66,16,51200
MAA 36,0,164
TR 68,16,59136
MAA 52,8,164
TR 70,16,59648
MAA 52,12,180
MAA 48,12,176
TR 72,16,50720
MAA 48,8,160
buffer_load_dwordx4 a[140:143], v11, s[16:19], s53 offen offset:1024 sc1
MAA 96,16,160
TR 74,16,51232
s_add_u32 s53, s53, 16384
MAA 96,20,176
TR 76,16,59168
MAA 100,20,180
MAA 100,16,164
TR 78,16,59680
MAA 116,24,164
TR 80,16,50752
MAA 116,28,180
buffer_load_dwordx4 a[152:155], v11, s[16:19], s53 offen sc1
MAA 112,28,176
TR 82,16,51264
MAA 112,24,160
MAA 160,32,160
TR 84,16,59200
MAA 160,36,176
TR 86,16,59712
MAA 164,36,180
TR 88,16,50784
MAA 164,32,164
buffer_load_dwordx4 a[156:159], v11, s[16:19], s53 offen offset:1024 sc1
MAA 180,40,164
s_add_u32 s53, s53, 16384
MAA 180,44,180
TR 90,16,51296
MAA 176,44,176
TR 92,16,59232
MAA 176,40,160
TR 94,16,59744
MAA 224,48,160
s_add_u32 m0, s55, 118272
MAA 224,52,176
buffer_load_dwordx4 v12, s[32:35], s54 offen   lds
MAA 228,52,180
TR 96,16,50816
MAA 228,48,164
TR 98,16,51328
MAA 236,56,164
TR 100,16,59264
MAA 236,60,180
TR 102,16,59776
MAA 232,60,176
MAA 232,56,160
TR 104,16,50848
s_waitcnt vmcnt(19)
MAA 188,40,172
buffer_load_dwordx4 v13, s[32:35], s54 offen offset:1056   lds
MAA 188,44,188
TR 106,16,51360
MAA 184,44,184
TR 108,16,59296
MAA 184,40,168
MAA 168,32,168
TR 110,16,59808
MAA 168,36,184
buffer_load_dwordx4 v14, s[32:35], s54 offen offset:2112   lds
MAA 172,36,188
TR 112,17,50688
MAA 172,32,172
TR 114,17,51200
MAA 124,24,172
MAA 124,28,188
TR 116,17,59136
MAA 120,28,184
TR 118,17,59648
MAA 120,24,168
buffer_load_dwordx4 v15, s[32:35], s54 offen offset:3168   lds
MAA 104,16,168
TR 120,17,50720
MAA 104,20,184
MAA 108,20,188
TR 122,17,51232
MAA 108,16,172
TR 124,17,59168
MAA 60,8,172
TR 126,17,59680
s_mov_b32 m0, s67
MAA 60,12,188
buffer_load_dwordx4 v18, s[28:31], s58 offen lds
MAA 56,12,184
MAA 56,8,168
MAA 40,0,168
MAA 40,4,184
MAA 44,4,188
MAA 44,0,172
s_waitcnt vmcnt(19) lgkmcnt(0)
s_barrier
MAA 64,64,160
ds_read_b64_tr_b16 a[0:1], v16
s_add_u32 m0, s55, 135168
MAA 64,68,176
buffer_load_dwordx4 v12, s[80:83], s54 offen   lds
MAA 68,68,180
TR 2,16,512
MAA 68,64,164
TR 4,16,8448
MAA 84,72,164
TR 6,16,8960
MAA 84,76,180
MAA 80,76,176
TR 8,16,32
MAA 80,72,160
buffer_load_dwordx4 v13, s[80:83], s54 offen offset:1056   lds
MAA 128,80,160
TR 10,16,544
MAA 128,84,176
TR 12,16,8480
MAA 132,84,180
TR 14,16,8992
MAA 132,80,164
MAA 148,88,164
TR 16,16,64
MAA 148,92,180
buffer_load_dwordx4 v14, s[80:83], s54 offen offset:2112   lds
MAA 144,92,176
TR 18,16,576
MAA 144,88,160
TR 20,16,8512
MAA 192,96,160
MAA 192,100,176
TR 22,16,9024
MAA 196,100,180
TR 24,16,96
MAA 196,96,164
buffer_load_dwordx4 v15, s[80:83], s54 offen offset:3168   lds
MAA 212,104,164
TR 26,16,608
s_add_u32 s54, s54, 458752
MAA 212,108,180
TR 28,16,8544
MAA 208,108,176
MAA 208,104,160
TR 30,16,9056
MAA 240,112,160
TR 32,16,128
s_mov_b32 m0, s67
MAA 240,116,176
buffer_load_dwordx4 v19, s[28:31], s58 offen offset:1056 lds
MAA 244,116,180
s_add_u32 s67, s67, 8448
s_add_u32 s46, s46, 1
s_xor_b32 s58, s46, s87
s_mul_i32 s58, s58, 458752
MAA 244,112,164
TR 34,16,640
MAA 252,120,164
MAA 252,124,180
TR 36,16,8576
MAA 248,124,176
TR 38,16,9088
MAA 248,120,160
buffer_load_dwordx4 a[160:163], v10, s[16:19], s52 offen sc1
MAA 220,104,172
TR 40,16,160
MAA 220,108,188
TR 42,16,672
MAA 216,108,184
MAA 216,104,168
TR 44,16,8608
MAA 200,96,168
TR 46,16,9120
MAA 200,100,184
buffer_load_dwordx4 a[164:167], v10, s[16:19], s52 offen offset:1024 sc1
MAA 204,100,188
ds_read_b64_tr_b16 a[48:49], v17
s_add_u32 s52, s52, 16384
MAA 204,96,172
MAA 156,88,172
TR 50,17,512
MAA 156,92,188
TR 52,17,8448
MAA 152,92,184
TR 54,17,8960
MAA 152,88,168
buffer_load_dwordx4 a[176:179], v10, s[16:19], s52 offen sc1
MAA 136,80,168
TR 56,17,32
MAA 136,84,184
MAA 140,84,188
TR 58,17,544
MAA 140,80,172
TR 60,17,8480
MAA 92,72,172
TR 62,17,8992
MAA 92,76,188
buffer_load_dwordx4 a[180:183], v10, s[16:19], s52 offen offset:1024 sc1
MAA 88,76,184
s_add_u32 s52, s52, 16384
MAA 88,72,168
MAA 72,64,168
MAA 72,68,184
MAA 76,68,188
s_add_u32 s15, s15, 1
MAA 76,64,172
s_cbranch_scc0 .Lk64
s_waitcnt vmcnt(10) lgkmcnt(0)
s_barrier
MAA 32,0,128
buffer_load_dwordx4 a[168:171], v11, s[16:19], s53 offen sc1
MAA 32,4,144
TR 64,16,16896
s_add_u32 s58, s99, 2293760
MAA 48,12,144
TR 66,16,17408
s_lshl_b32 s74, s3, 11
MAA 48,8,128
TR 68,16,25344
s_add_u32 s74, s74, s84
MAA 36,0,132
buffer_load_dwordx4 a[172:175], v11, s[16:19], s53 offen offset:1024 sc1
MAA 36,4,148
TR 70,16,25856
s_add_u32 s53, s53, 16384
MAA 52,12,148
TR 72,16,16928
v_lshl_add_u32 v4, v1, 4, s74
MAA 52,8,132
TR 74,16,17440
v_lshrrev_b32 v2, 3, v1
MAA 40,0,136
buffer_load_dwordx4 a[184:187], v11, s[16:19], s53 offen sc1
MAA 40,4,152
TR 76,16,25376
v_cmp_eq_u32 vcc, 3, v2
MAA 56,12,152
TR 78,16,25888
v_add_u32 v2, 67108480, v4
MAA 56,8,136
TR 80,16,33792
v_cndmask_b32 v4, v4, v2, vcc
MAA 44,0,140
buffer_load_dwordx4 a[188:191], v11, s[16:19], s53 offen offset:1024 sc1
MAA 44,4,156
TR 82,16,34304
s_add_u32 s53, s53, 16384
MAA 60,12,156
TR 84,16,42240
s_and_b32 s74, s7, 1
MAA 60,8,140
TR 86,16,42752
s_add_u32 s54, s98, 65536
MAA 96,16,128
TR 88,16,33824
v_bfe_u32 v7, v1, 2, 3
MAA 96,20,144
TR 90,16,34336
v_mul_u32_u24 v7, 1056, v7
MAA 112,28,144
TR 92,16,42272
v_bfe_u32 v2, v1, 5, 1
MAA 112,24,128
TR 94,16,42784
v_lshl_add_u32 v7, v2, 8, v7
MAA 100,16,132
TR 112,16,16960
v_and_b32 v2, 3, v1
MAA 100,20,148
.Lpad25:
s_cbranch_execz .Lnopoll59r
TR 114,16,17472
v_lshl_add_u32 v7, v2, 3, v7
MAA 116,28,148
TR 116,16,25408
s_lshl_b32 s74, s74, 7
MAA 116,24,132
TR 118,16,25920
s_xor_b32 s75, s74, 128
MAA 104,16,136
TR 120,16,16992
v_add_u32 v6, s75, v7
MAA 104,20,152
TR 122,16,17504
v_add_u32 v7, s74, v7
MAA 120,28,152
TR 124,16,25440
s_mul_i32 s55, s3, 2112
MAA 120,24,136
TR 126,16,25952
s_mov_b32 s57, 67584
MAA 108,16,140
TR 192,16,33856
MAA 108,20,156
TR 194,16,34368
MAA 124,28,156
TR 196,16,42304
MAA 124,24,140
TR 198,16,42816
MAA 160,32,128
TR 200,16,33888
MAA 160,36,144
TR 202,16,34400
MAA 176,44,144
TR 204,16,42336
MAA 176,40,128
TR 206,16,42848
MAA 164,32,132
TR 0,16,17024
MAA 164,36,148
TR 2,16,17536
s_waitcnt vmcnt(9)
s_barrier
MAA 180,44,148
TR 96,16,50688
MAA 180,40,132
TR 98,16,51200
MAA 168,32,136
TR 100,16,59136
MAA 168,36,152
TR 102,16,59648
MAA 184,44,152
TR 104,16,50720
MAA 184,40,136
TR 106,16,51232
MAA 172,32,140
TR 108,16,59168
MAA 172,36,156
TR 110,16,59680
MAA 188,44,156
TR 208,16,50752
MAA 188,40,140
TR 210,16,51264
MAA 224,48,128
TR 212,16,59200
MAA 224,52,144
TR 214,16,59712
MAA 232,60,144
TR 216,16,50784
MAA 232,56,128
TR 218,16,51296
MAA 228,48,132
TR 220,16,59232
MAA 228,52,148
TR 222,16,59744
MAA 236,60,148
TR 4,16,25472
MAA 236,56,132
TR 6,16,25984
s_waitcnt lgkmcnt(15)
MAA 64,64,128
TR 8,16,17056
MAA 64,68,144
TR 10,16,17568
s_waitcnt vmcnt(7)
MAA 64,96,160
TR 12,16,25504
s_waitcnt vmcnt(5) lgkmcnt(15)
MAA 64,100,176
TR 14,16,26016
s_waitcnt lgkmcnt(14)
MAA 80,108,176
TR 16,16,33920
MAA 80,104,160
TR 18,16,34432
MAA 80,76,144
TR 20,16,42368
MAA 80,72,128
TR 22,16,42880
MAA 32,80,160
TR 24,16,33952
MAA 32,84,176
TR 26,16,34464
MAA 48,92,176
TR 28,16,42400
MAA 48,88,160
TR 30,16,42912
s_nop 2
v_pk_mul_f32 v[64:65], v[64:65], v[32:33]
v_pk_mul_f32 v[32:33], v[32:33], v[28:29] op_sel_hi:[1,0]
v_pk_mul_f32 v[66:67], v[66:67], v[34:35]
v_pk_mul_f32 v[34:35], v[34:35], v[28:29] op_sel_hi:[1,0]
v_pk_mul_f32 v[80:81], v[80:81], v[48:49]
v_pk_mul_f32 v[48:49], v[48:49], v[28:29] op_sel_hi:[1,0]
v_pk_mul_f32 v[82:83], v[82:83], v[50:51]
v_pk_mul_f32 v[50:51], v[50:51], v[28:29] op_sel_hi:[1,0]
v_exp_f32 v32, v32
s_nop 0
MAA 68,64,132
TR 32,16,50816
v_exp_f32 v33, v33
MAA 68,68,148
TR 34,16,51328
v_exp_f32 v34, v34
MAA 68,96,164
TR 36,16,59264
v_exp_f32 v35, v35
s_waitcnt vmcnt(4)
MAA 68,100,180
TR 38,16,59776
v_exp_f32 v48, v48
MAA 84,108,180
TR 40,16,50848
v_exp_f32 v49, v49
MAA 84,104,164
TR 42,16,51360
v_exp_f32 v50, v50
MAA 84,76,148
TR 44,16,59296
v_exp_f32 v51, v51
MAA 84,72,132
TR 46,16,59808
MAA 36,80,164
TR 48,17,16896
MAA 36,84,180
TR 50,17,17408
MAA 52,92,180
TR 52,17,25344
MAA 52,88,164
TR 54,17,25856
s_nop 2
v_pk_mul_f32 v[68:69], v[68:69], v[36:37]
v_pk_mul_f32 v[36:37], v[36:37], v[28:29] op_sel:[0,1] op_sel_hi:[1,1]
v_pk_mul_f32 v[70:71], v[70:71], v[38:39]
v_pk_mul_f32 v[38:39], v[38:39], v[28:29] op_sel:[0,1] op_sel_hi:[1,1]
v_pk_mul_f32 v[84:85], v[84:85], v[52:53]
v_pk_mul_f32 v[52:53], v[52:53], v[28:29] op_sel:[0,1] op_sel_hi:[1,1]
v_pk_mul_f32 v[86:87], v[86:87], v[54:55]
v_pk_mul_f32 v[54:55], v[54:55], v[28:29] op_sel:[0,1] op_sel_hi:[1,1]
v_pk_fma_f32 v[32:33], v[32:33], v[20:21], v[20:21] op_sel:[0,1,1] op_sel_hi:[1,1,1]
v_pk_fma_f32 v[34:35], v[34:35], v[20:21], v[20:21] op_sel:[0,1,1] op_sel_hi:[1,1,1]
v_pk_fma_f32 v[48:49], v[48:49], v[20:21], v[20:21] op_sel:[0,1,1] op_sel_hi:[1,1,1]
v_pk_fma_f32 v[50:51], v[50:51], v[20:21], v[20:21] op_sel:[0,1,1] op_sel_hi:[1,1,1]
v_rcp_f32 v32, v32
s_nop 0
MAA 72,64,136
TR 56,17,16928
v_rcp_f32 v33, v33
MAA 72,68,152
TR 58,17,17440
v_rcp_f32 v34, v34
s_waitcnt vmcnt(3)
MAA 72,96,168
TR 60,17,25376
v_rcp_f32 v35, v35
s_waitcnt vmcnt(1)
MAA 72,100,184
TR 62,17,25888
v_rcp_f32 v48, v48
MAA 88,108,184
v_rcp_f32 v49, v49
MAA 88,104,168
v_rcp_f32 v50, v50
MAA 88,76,152
v_rcp_f32 v51, v51
MAA 88,72,136
v_exp_f32 v36, v36
MAA 40,80,168
v_exp_f32 v37, v37
MAA 40,84,184
v_exp_f32 v38, v38
MAA 56,92,184
v_exp_f32 v39, v39
MAA 56,88,168
v_exp_f32 v52, v52
v_exp_f32 v53, v53
v_exp_f32 v54, v54
v_exp_f32 v55, v55
v_pk_mul_f32 v[64:65], v[64:65], v[32:33]
v_pk_mul_f32 v[66:67], v[66:67], v[34:35]
v_pk_mul_f32 v[80:81], v[80:81], v[48:49]
v_pk_mul_f32 v[82:83], v[82:83], v[50:51]
v_pk_mul_f32 v[72:73], v[72:73], v[40:41]
v_pk_mul_f32 v[40:41], v[40:41], v[30:31] op_sel_hi:[1,0]
v_pk_mul_f32 v[74:75], v[74:75], v[42:43]
v_pk_mul_f32 v[42:43], v[42:43], v[30:31] op_sel_hi:[1,0]
v_pk_mul_f32 v[88:89], v[88:89], v[56:57]
v_pk_mul_f32 v[56:57], v[56:57], v[30:31] op_sel_hi:[1,0]
v_pk_mul_f32 v[90:91], v[90:91], v[58:59]
v_pk_mul_f32 v[58:59], v[58:59], v[30:31] op_sel_hi:[1,0]
v_pk_fma_f32 v[36:37], v[36:37], v[22:23], v[22:23] op_sel:[0,1,1] op_sel_hi:[1,1,1]
v_pk_fma_f32 v[38:39], v[38:39], v[22:23], v[22:23] op_sel:[0,1,1] op_sel_hi:[1,1,1]
v_pk_fma_f32 v[52:53], v[52:53], v[22:23], v[22:23] op_sel:[0,1,1] op_sel_hi:[1,1,1]
v_pk_fma_f32 v[54:55], v[54:55], v[22:23], v[22:23] op_sel:[0,1,1] op_sel_hi:[1,1,1]
v_cvt_pk_bf16_f32 v32, v64, v65
v_cvt_pk_bf16_f32 v33, v66, v67
v_cvt_pk_bf16_f32 v34, v80, v81
v_cvt_pk_bf16_f32 v35, v82, v83
MAA 76,64,140
buffer_store_dwordx4 v[32:35], v10, s[16:19], s62 offen sc1
MAA 76,68,156
TR 64,17,33792
v_rcp_f32 v36, v36
MAA 76,96,172
TR 66,17,34304
v_rcp_f32 v37, v37
s_waitcnt vmcnt(1)
MAA 76,100,188
TR 68,17,42240
v_rcp_f32 v38, v38
MAA 92,108,188
TR 70,17,42752
v_rcp_f32 v39, v39
MAA 92,104,172
v_rcp_f32 v52, v52
MAA 92,76,156
TR 76,17,42272
v_rcp_f32 v53, v53
MAA 92,72,140
TR 72,17,33824
v_rcp_f32 v54, v54
MAA 44,80,172
TR 74,17,34336
v_rcp_f32 v55, v55
MAA 44,84,188
TR 78,17,42784
v_exp_f32 v40, v40
MAA 60,92,188
TR 80,17,50688
v_exp_f32 v41, v41
MAA 60,88,172
TR 82,17,51200
v_exp_f32 v42, v42
v_exp_f32 v43, v43
v_exp_f32 v56, v56
v_exp_f32 v57, v57
v_exp_f32 v58, v58
v_exp_f32 v59, v59
v_pk_mul_f32 v[68:69], v[68:69], v[36:37]
v_pk_mul_f32 v[70:71], v[70:71], v[38:39]
v_pk_mul_f32 v[84:85], v[84:85], v[52:53]
v_pk_mul_f32 v[86:87], v[86:87], v[54:55]
v_pk_mul_f32 v[76:77], v[76:77], v[44:45]
v_pk_mul_f32 v[44:45], v[44:45], v[30:31] op_sel:[0,1] op_sel_hi:[1,1]
v_pk_mul_f32 v[78:79], v[78:79], v[46:47]
v_pk_mul_f32 v[46:47], v[46:47], v[30:31] op_sel:[0,1] op_sel_hi:[1,1]
v_pk_mul_f32 v[92:93], v[92:93], v[60:61]
v_pk_mul_f32 v[60:61], v[60:61], v[30:31] op_sel:[0,1] op_sel_hi:[1,1]
v_pk_mul_f32 v[94:95], v[94:95], v[62:63]
v_pk_mul_f32 v[62:63], v[62:63], v[30:31] op_sel:[0,1] op_sel_hi:[1,1]
v_pk_fma_f32 v[40:41], v[40:41], v[24:25], v[24:25] op_sel:[0,1,1] op_sel_hi:[1,1,1]
v_pk_fma_f32 v[42:43], v[42:43], v[24:25], v[24:25] op_sel:[0,1,1] op_sel_hi:[1,1,1]
v_pk_fma_f32 v[56:57], v[56:57], v[24:25], v[24:25] op_sel:[0,1,1] op_sel_hi:[1,1,1]
v_pk_fma_f32 v[58:59], v[58:59], v[24:25], v[24:25] op_sel:[0,1,1] op_sel_hi:[1,1,1]
v_cvt_pk_bf16_f32 v36, v68, v69
v_cvt_pk_bf16_f32 v37, v70, v71
v_cvt_pk_bf16_f32 v38, v84, v85
v_cvt_pk_bf16_f32 v39, v86, v87
MAA 128,112,128
buffer_store_dwordx4 v[36:39], v10, s[16:19], s62 offen offset:1024 sc1
MAA 128,116,144
TR 84,17,59136
v_rcp_f32 v40, v40
s_waitcnt lgkmcnt(15)
MAA 128,208,160
TR 86,17,59648
v_rcp_f32 v41, v41
MAA 128,212,176
TR 88,17,50720
v_rcp_f32 v42, v42
MAA 144,220,176
TR 90,17,51232
v_rcp_f32 v43, v43
MAA 144,216,160
TR 92,17,59168
v_rcp_f32 v56, v56
MAA 144,124,144
TR 94,17,59680
v_rcp_f32 v57, v57
MAA 144,120,128
v_rcp_f32 v58, v58
MAA 96,192,160
v_rcp_f32 v59, v59
MAA 96,196,176
v_exp_f32 v44, v44
MAA 112,204,176
v_exp_f32 v45, v45
MAA 112,200,160
v_lshrrev_b32 v69, 2, v0
v_min_u32 v69, 1, v69
v_lshlrev_b32 v69, 28, v69
v_lshl_add_u32 v68, v0, 7, v69
v_xor_b32 v69, 64, v0
v_min_u32 v69, 1, v69
v_lshlrev_b32 v70, 4, v69
v_sub_u32 v70, 16, v70
v_lshlrev_b32 v69, 28, v69
v_mov_b32 v71, 1
s_waitcnt lgkmcnt(0)
s_barrier
v_mov_b32 v84, 0
v_mov_b32 v85, 0
v_mov_b32 v86, 0
v_exp_f32 v46, v46
v_exp_f32 v47, v47
v_exp_f32 v60, v60
v_exp_f32 v61, v61
v_exp_f32 v62, v62
v_exp_f32 v63, v63
v_pk_mul_f32 v[72:73], v[72:73], v[40:41]
v_pk_mul_f32 v[74:75], v[74:75], v[42:43]
v_pk_mul_f32 v[88:89], v[88:89], v[56:57]
v_pk_mul_f32 v[90:91], v[90:91], v[58:59]
v_pk_mul_f32 v[128:129], v[128:129], v[96:97]
v_pk_mul_f32 v[96:97], v[96:97], v[28:29] op_sel_hi:[1,0]
v_pk_mul_f32 v[130:131], v[130:131], v[98:99]
v_pk_mul_f32 v[98:99], v[98:99], v[28:29] op_sel_hi:[1,0]
v_pk_mul_f32 v[144:145], v[144:145], v[112:113]
v_pk_mul_f32 v[112:113], v[112:113], v[28:29] op_sel_hi:[1,0]
v_pk_mul_f32 v[146:147], v[146:147], v[114:115]
v_pk_mul_f32 v[114:115], v[114:115], v[28:29] op_sel_hi:[1,0]
v_pk_fma_f32 v[44:45], v[44:45], v[26:27], v[26:27] op_sel:[0,1,1] op_sel_hi:[1,1,1]
v_pk_fma_f32 v[46:47], v[46:47], v[26:27], v[26:27] op_sel:[0,1,1] op_sel_hi:[1,1,1]
v_pk_fma_f32 v[60:61], v[60:61], v[26:27], v[26:27] op_sel:[0,1,1] op_sel_hi:[1,1,1]
v_pk_fma_f32 v[62:63], v[62:63], v[26:27], v[26:27] op_sel:[0,1,1] op_sel_hi:[1,1,1]
v_cvt_pk_bf16_f32 v40, v72, v73
v_cvt_pk_bf16_f32 v41, v74, v75
v_cvt_pk_bf16_f32 v42, v88, v89
v_cvt_pk_bf16_f32 v43, v90, v91
MAA 132,112,132
buffer_store_dwordx4 v[40:43], v11, s[16:19], s62 offen sc1
MAA 132,116,148
s_add_u32 m0, s59, 84480
v_rcp_f32 v44, v44
MAA 132,208,164
v_rcp_f32 v45, v45
MAA 132,212,180
v_rcp_f32 v46, v46
MAA 148,220,180
buffer_load_dwordx4 v18, s[28:31], s58 offen lds
MAA 148,216,164
v_rcp_f32 v47, v47
MAA 148,124,148
v_rcp_f32 v60, v60
MAA 148,120,132
v_rcp_f32 v61, v61
MAA 100,192,164
buffer_load_dwordx4 v19, s[28:31], s58 offen offset:1056 lds
MAA 100,196,180
s_add_u32 m0, s59, 92928
s_add_u32 s58, s99, 2555904
v_rcp_f32 v62, v62
MAA 116,204,180
v_rcp_f32 v63, v63
MAA 116,200,164
v_exp_f32 v96, v96
v_exp_f32 v97, v97
v_exp_f32 v98, v98
v_exp_f32 v99, v99
v_exp_f32 v112, v112
v_exp_f32 v113, v113
v_exp_f32 v114, v114
v_exp_f32 v115, v115
v_pk_mul_f32 v[76:77], v[76:77], v[44:45]
v_pk_mul_f32 v[78:79], v[78:79], v[46:47]
v_pk_mul_f32 v[92:93], v[92:93], v[60:61]
v_pk_mul_f32 v[94:95], v[94:95], v[62:63]
v_pk_mul_f32 v[132:133], v[132:133], v[100:101]
v_pk_mul_f32 v[100:101], v[100:101], v[28:29] op_sel:[0,1] op_sel_hi:[1,1]
v_pk_mul_f32 v[134:135], v[134:135], v[102:103]
v_pk_mul_f32 v[102:103], v[102:103], v[28:29] op_sel:[0,1] op_sel_hi:[1,1]
v_pk_mul_f32 v[148:149], v[148:149], v[116:117]
v_pk_mul_f32 v[116:117], v[116:117], v[28:29] op_sel:[0,1] op_sel_hi:[1,1]
v_pk_mul_f32 v[150:151], v[150:151], v[118:119]
v_pk_mul_f32 v[118:119], v[118:119], v[28:29] op_sel:[0,1] op_sel_hi:[1,1]
v_pk_fma_f32 v[96:97], v[96:97], v[20:21], v[20:21] op_sel:[0,1,1] op_sel_hi:[1,1,1]
v_pk_fma_f32 v[98:99], v[98:99], v[20:21], v[20:21] op_sel:[0,1,1] op_sel_hi:[1,1,1]
v_pk_fma_f32 v[112:113], v[112:113], v[20:21], v[20:21] op_sel:[0,1,1] op_sel_hi:[1,1,1]
v_pk_fma_f32 v[114:115], v[114:115], v[20:21], v[20:21] op_sel:[0,1,1] op_sel_hi:[1,1,1]
v_cvt_pk_bf16_f32 v44, v76, v77
v_cvt_pk_bf16_f32 v45, v78, v79
v_cvt_pk_bf16_f32 v46, v92, v93
v_cvt_pk_bf16_f32 v47, v94, v95
MAA 136,112,136
buffer_store_dwordx4 v[44:47], v11, s[16:19], s62 offen offset:1024 sc1
MAA 136,116,152
v_rcp_f32 v96, v96
MAA 136,208,168
v_rcp_f32 v97, v97
MAA 136,212,184
v_rcp_f32 v98, v98
MAA 152,220,184
buffer_load_dwordx4 v18, s[28:31], s58 offen lds
MAA 152,216,168
v_rcp_f32 v99, v99
MAA 152,124,152
v_rcp_f32 v112, v112
MAA 152,120,136
v_rcp_f32 v113, v113
MAA 104,192,168
buffer_load_dwordx4 v19, s[28:31], s58 offen offset:1056 lds
MAA 104,196,184
s_add_u32 m0, s59, 101376
s_add_u32 s58, s100, 2752512
v_rcp_f32 v114, v114
MAA 120,204,184
v_rcp_f32 v115, v115
MAA 120,200,168
v_exp_f32 v100, v100
v_exp_f32 v101, v101
v_exp_f32 v102, v102
v_exp_f32 v103, v103
v_exp_f32 v116, v116
v_exp_f32 v117, v117
v_exp_f32 v118, v118
v_exp_f32 v119, v119
v_pk_mul_f32 v[128:129], v[128:129], v[96:97]
v_pk_mul_f32 v[130:131], v[130:131], v[98:99]
v_pk_mul_f32 v[144:145], v[144:145], v[112:113]
v_pk_mul_f32 v[146:147], v[146:147], v[114:115]
v_pk_mul_f32 v[136:137], v[136:137], v[104:105]
v_pk_mul_f32 v[104:105], v[104:105], v[30:31] op_sel_hi:[1,0]
v_pk_mul_f32 v[138:139], v[138:139], v[106:107]
v_pk_mul_f32 v[106:107], v[106:107], v[30:31] op_sel_hi:[1,0]
v_pk_mul_f32 v[152:153], v[152:153], v[120:121]
v_pk_mul_f32 v[120:121], v[120:121], v[30:31] op_sel_hi:[1,0]
v_pk_mul_f32 v[154:155], v[154:155], v[122:123]
v_pk_mul_f32 v[122:123], v[122:123], v[30:31] op_sel_hi:[1,0]
v_pk_fma_f32 v[100:101], v[100:101], v[22:23], v[22:23] op_sel:[0,1,1] op_sel_hi:[1,1,1]
v_pk_fma_f32 v[102:103], v[102:103], v[22:23], v[22:23] op_sel:[0,1,1] op_sel_hi:[1,1,1]
v_pk_fma_f32 v[116:117], v[116:117], v[22:23], v[22:23] op_sel:[0,1,1] op_sel_hi:[1,1,1]
v_pk_fma_f32 v[118:119], v[118:119], v[22:23], v[22:23] op_sel:[0,1,1] op_sel_hi:[1,1,1]
v_cvt_pk_bf16_f32 v96, v128, v129
v_cvt_pk_bf16_f32 v97, v130, v131
v_cvt_pk_bf16_f32 v98, v144, v145
v_cvt_pk_bf16_f32 v99, v146, v147
MAA 140,112,140
buffer_store_dwordx4 v[96:99], v10, s[16:19], s63 offen sc1
MAA 140,116,156
v_rcp_f32 v100, v100
MAA 140,208,172
v_rcp_f32 v101, v101
MAA 140,212,188
v_rcp_f32 v102, v102
MAA 156,220,188
buffer_load_dwordx4 v18, s[28:31], s58 offen lds
MAA 156,216,172
v_rcp_f32 v103, v103
MAA 156,124,156
v_rcp_f32 v116, v116
MAA 156,120,140
v_rcp_f32 v117, v117
MAA 108,192,172
buffer_load_dwordx4 v19, s[28:31], s58 offen offset:1056 lds
MAA 108,196,188
s_add_u32 m0, s59, 109824
s_add_u32 s58, s100, 3014656
v_rcp_f32 v118, v118
MAA 124,204,188
v_rcp_f32 v119, v119
MAA 124,200,172
v_exp_f32 v104, v104
v_exp_f32 v105, v105
v_exp_f32 v106, v106
v_exp_f32 v107, v107
v_exp_f32 v120, v120
v_exp_f32 v121, v121
v_exp_f32 v122, v122
v_exp_f32 v123, v123
v_pk_mul_f32 v[132:133], v[132:133], v[100:101]
v_pk_mul_f32 v[134:135], v[134:135], v[102:103]
v_pk_mul_f32 v[148:149], v[148:149], v[116:117]
v_pk_mul_f32 v[150:151], v[150:151], v[118:119]
v_pk_mul_f32 v[140:141], v[140:141], v[108:109]
v_pk_mul_f32 v[108:109], v[108:109], v[30:31] op_sel:[0,1] op_sel_hi:[1,1]
v_pk_mul_f32 v[142:143], v[142:143], v[110:111]
v_pk_mul_f32 v[110:111], v[110:111], v[30:31] op_sel:[0,1] op_sel_hi:[1,1]
v_pk_mul_f32 v[156:157], v[156:157], v[124:125]
v_pk_mul_f32 v[124:125], v[124:125], v[30:31] op_sel:[0,1] op_sel_hi:[1,1]
v_pk_mul_f32 v[158:159], v[158:159], v[126:127]
v_pk_mul_f32 v[126:127], v[126:127], v[30:31] op_sel:[0,1] op_sel_hi:[1,1]
v_pk_fma_f32 v[104:105], v[104:105], v[24:25], v[24:25] op_sel:[0,1,1] op_sel_hi:[1,1,1]
v_pk_fma_f32 v[106:107], v[106:107], v[24:25], v[24:25] op_sel:[0,1,1] op_sel_hi:[1,1,1]
v_pk_fma_f32 v[120:121], v[120:121], v[24:25], v[24:25] op_sel:[0,1,1] op_sel_hi:[1,1,1]
v_pk_fma_f32 v[122:123], v[122:123], v[24:25], v[24:25] op_sel:[0,1,1] op_sel_hi:[1,1,1]
v_cvt_pk_bf16_f32 v100, v132, v133
v_cvt_pk_bf16_f32 v101, v134, v135
v_cvt_pk_bf16_f32 v102, v148, v149
v_cvt_pk_bf16_f32 v103, v150, v151
MAA 192,0,128
buffer_store_dwordx4 v[100:103], v10, s[16:19], s63 offen offset:1024 sc1
MAA 192,4,144
v_rcp_f32 v104, v104
MAA 192,32,160
s_waitcnt vmcnt(6)
s_barrier
v_rcp_f32 v105, v105
MAA 192,36,176
v_rcp_f32 v106, v106
MAA 208,44,176
buffer_atomic_add v71, v68, s[16:19], s72 offen offset:512
MAA 208,40,160
v_rcp_f32 v107, v107
MAA 208,12,144
v_rcp_f32 v120, v120
MAA 208,8,128
v_rcp_f32 v121, v121
MAA 160,16,160
buffer_load_dwordx4 v18, s[28:31], s58 offen lds
MAA 160,20,176
v_rcp_f32 v122, v122
MAA 176,28,176
v_rcp_f32 v123, v123
MAA 176,24,160
v_exp_f32 v108, v108
v_exp_f32 v109, v109
v_exp_f32 v110, v110
v_exp_f32 v111, v111
v_exp_f32 v124, v124
v_exp_f32 v125, v125
v_exp_f32 v126, v126
v_exp_f32 v127, v127
v_pk_mul_f32 v[136:137], v[136:137], v[104:105]
v_pk_mul_f32 v[138:139], v[138:139], v[106:107]
v_pk_mul_f32 v[152:153], v[152:153], v[120:121]
v_pk_mul_f32 v[154:155], v[154:155], v[122:123]
v_pk_mul_f32 v[192:193], v[192:193], v[160:161]
v_pk_mul_f32 v[160:161], v[160:161], v[28:29] op_sel_hi:[1,0]
v_pk_mul_f32 v[194:195], v[194:195], v[162:163]
v_pk_mul_f32 v[162:163], v[162:163], v[28:29] op_sel_hi:[1,0]
v_pk_mul_f32 v[208:209], v[208:209], v[176:177]
v_pk_mul_f32 v[176:177], v[176:177], v[28:29] op_sel_hi:[1,0]
v_pk_mul_f32 v[210:211], v[210:211], v[178:179]
v_pk_mul_f32 v[178:179], v[178:179], v[28:29] op_sel_hi:[1,0]
v_pk_fma_f32 v[108:109], v[108:109], v[26:27], v[26:27] op_sel:[0,1,1] op_sel_hi:[1,1,1]
v_pk_fma_f32 v[110:111], v[110:111], v[26:27], v[26:27] op_sel:[0,1,1] op_sel_hi:[1,1,1]
v_pk_fma_f32 v[124:125], v[124:125], v[26:27], v[26:27] op_sel:[0,1,1] op_sel_hi:[1,1,1]
v_pk_fma_f32 v[126:127], v[126:127], v[26:27], v[26:27] op_sel:[0,1,1] op_sel_hi:[1,1,1]
v_cvt_pk_bf16_f32 v104, v136, v137
v_cvt_pk_bf16_f32 v105, v138, v139
v_cvt_pk_bf16_f32 v106, v152, v153
v_cvt_pk_bf16_f32 v107, v154, v155
MAA 196,0,132
buffer_store_dwordx4 v[104:107], v11, s[16:19], s63 offen sc1
MAA 196,4,148
v_rcp_f32 v108, v108
MAA 196,32,164
v_rcp_f32 v109, v109
MAA 196,36,180
v_rcp_f32 v110, v110
MAA 212,44,180
buffer_load_dwordx4 v19, s[28:31], s58 offen offset:1056 lds
MAA 212,40,164
s_add_u32 m0, s59, 118272
s_add_u32 s58, s101, 3211264
v_rcp_f32 v111, v111
MAA 212,12,148
v_rcp_f32 v124, v124
MAA 212,8,132
v_rcp_f32 v125, v125
MAA 164,16,164
buffer_load_dwordx4 v18, s[28:31], s58 offen lds
MAA 164,20,180
v_rcp_f32 v126, v126
MAA 180,28,180
v_rcp_f32 v127, v127
MAA 180,24,164
v_exp_f32 v160, v160
v_exp_f32 v161, v161
v_exp_f32 v162, v162
v_exp_f32 v163, v163
v_exp_f32 v176, v176
v_exp_f32 v177, v177
v_exp_f32 v178, v178
v_exp_f32 v179, v179
v_pk_mul_f32 v[140:141], v[140:141], v[108:109]
v_pk_mul_f32 v[142:143], v[142:143], v[110:111]
.Lpad26:
s_cbranch_execz .Lpad29
v_pk_mul_f32 v[156:157], v[156:157], v[124:125]
v_pk_mul_f32 v[158:159], v[158:159], v[126:127]
v_pk_mul_f32 v[196:197], v[196:197], v[164:165]
v_pk_mul_f32 v[164:165], v[164:165], v[28:29] op_sel:[0,1] op_sel_hi:[1,1]
v_pk_mul_f32 v[198:199], v[198:199], v[166:167]
v_pk_mul_f32 v[166:167], v[166:167], v[28:29] op_sel:[0,1] op_sel_hi:[1,1]
v_pk_mul_f32 v[212:213], v[212:213], v[180:181]
v_pk_mul_f32 v[180:181], v[180:181], v[28:29] op_sel:[0,1] op_sel_hi:[1,1]
v_pk_mul_f32 v[214:215], v[214:215], v[182:183]
v_pk_mul_f32 v[182:183], v[182:183], v[28:29] op_sel:[0,1] op_sel_hi:[1,1]
v_pk_fma_f32 v[160:161], v[160:161], v[20:21], v[20:21] op_sel:[0,1,1] op_sel_hi:[1,1,1]
v_pk_fma_f32 v[162:163], v[162:163], v[20:21], v[20:21] op_sel:[0,1,1] op_sel_hi:[1,1,1]
v_pk_fma_f32 v[176:177], v[176:177], v[20:21], v[20:21] op_sel:[0,1,1] op_sel_hi:[1,1,1]
v_pk_fma_f32 v[178:179], v[178:179], v[20:21], v[20:21] op_sel:[0,1,1] op_sel_hi:[1,1,1]
v_cvt_pk_bf16_f32 v108, v140, v141
v_cvt_pk_bf16_f32 v109, v142, v143
v_cvt_pk_bf16_f32 v110, v156, v157
v_cvt_pk_bf16_f32 v111, v158, v159
MAA 200,0,136
buffer_store_dwordx4 v[108:111], v11, s[16:19], s63 offen offset:1024 sc1
MAA 200,4,152
v_rcp_f32 v160, v160
MAA 200,32,168
v_rcp_f32 v161, v161
MAA 200,36,184
v_rcp_f32 v162, v162
MAA 216,44,184
buffer_load_dwordx4 v19, s[28:31], s58 offen offset:1056 lds
MAA 216,40,168
s_add_u32 m0, s59, 126720
s_add_u32 s58, s101, 3473408
v_rcp_f32 v163, v163
MAA 216,12,152
v_rcp_f32 v176, v176
MAA 216,8,136
v_rcp_f32 v177, v177
MAA 168,16,168
buffer_load_dwordx4 v18, s[28:31], s58 offen lds
MAA 168,20,184
v_rcp_f32 v178, v178
MAA 184,28,184
v_rcp_f32 v179, v179
MAA 184,24,168
v_exp_f32 v164, v164
v_exp_f32 v165, v165
v_exp_f32 v166, v166
v_exp_f32 v167, v167
v_exp_f32 v180, v180
v_exp_f32 v181, v181
v_exp_f32 v182, v182
v_exp_f32 v183, v183
v_pk_mul_f32 v[192:193], v[192:193], v[160:161]
v_pk_mul_f32 v[194:195], v[194:195], v[162:163]
v_pk_mul_f32 v[208:209], v[208:209], v[176:177]
v_pk_mul_f32 v[210:211], v[210:211], v[178:179]
v_pk_mul_f32 v[200:201], v[200:201], v[168:169]
v_pk_mul_f32 v[168:169], v[168:169], v[30:31] op_sel_hi:[1,0]
v_pk_mul_f32 v[202:203], v[202:203], v[170:171]
v_pk_mul_f32 v[170:171], v[170:171], v[30:31] op_sel_hi:[1,0]
v_pk_mul_f32 v[216:217], v[216:217], v[184:185]
v_pk_mul_f32 v[184:185], v[184:185], v[30:31] op_sel_hi:[1,0]
v_pk_mul_f32 v[218:219], v[218:219], v[186:187]
v_pk_mul_f32 v[186:187], v[186:187], v[30:31] op_sel_hi:[1,0]
v_pk_fma_f32 v[164:165], v[164:165], v[22:23], v[22:23] op_sel:[0,1,1] op_sel_hi:[1,1,1]
v_pk_fma_f32 v[166:167], v[166:167], v[22:23], v[22:23] op_sel:[0,1,1] op_sel_hi:[1,1,1]
v_pk_fma_f32 v[180:181], v[180:181], v[22:23], v[22:23] op_sel:[0,1,1] op_sel_hi:[1,1,1]
v_pk_fma_f32 v[182:183], v[182:183], v[22:23], v[22:23] op_sel:[0,1,1] op_sel_hi:[1,1,1]
v_cvt_pk_bf16_f32 v160, v192, v193
v_cvt_pk_bf16_f32 v161, v194, v195
v_cvt_pk_bf16_f32 v162, v208, v209
v_cvt_pk_bf16_f32 v163, v210, v211
MAA 204,0,140
buffer_store_dwordx4 v[160:163], v10, s[16:19], s64 offen sc1
MAA 204,4,156
v_rcp_f32 v164, v164
MAA 204,32,172
v_rcp_f32 v165, v165
MAA 204,36,188
v_rcp_f32 v166, v166
MAA 220,44,188
buffer_atomic_add v84, v69, s[16:19], s73 offen offset:512 sc0
MAA 220,40,172
v_rcp_f32 v167, v167
MAA 220,12,156
v_rcp_f32 v180, v180
MAA 220,8,140
v_rcp_f32 v181, v181
MAA 172,16,172
buffer_load_dwordx4 v19, s[28:31], s58 offen offset:1056 lds
MAA 172,20,188
v_rcp_f32 v182, v182
MAA 188,28,188
v_rcp_f32 v183, v183
MAA 188,24,172
v_exp_f32 v168, v168
v_exp_f32 v169, v169
v_exp_f32 v170, v170
v_exp_f32 v171, v171
v_exp_f32 v184, v184
v_exp_f32 v185, v185
v_exp_f32 v186, v186
v_exp_f32 v187, v187
v_pk_mul_f32 v[196:197], v[196:197], v[164:165]
v_pk_mul_f32 v[198:199], v[198:199], v[166:167]
v_pk_mul_f32 v[212:213], v[212:213], v[180:181]
v_pk_mul_f32 v[214:215], v[214:215], v[182:183]
v_pk_mul_f32 v[204:205], v[204:205], v[172:173]
v_pk_mul_f32 v[172:173], v[172:173], v[30:31] op_sel:[0,1] op_sel_hi:[1,1]
v_pk_mul_f32 v[206:207], v[206:207], v[174:175]
v_pk_mul_f32 v[174:175], v[174:175], v[30:31] op_sel:[0,1] op_sel_hi:[1,1]
v_pk_mul_f32 v[220:221], v[220:221], v[188:189]
v_pk_mul_f32 v[188:189], v[188:189], v[30:31] op_sel:[0,1] op_sel_hi:[1,1]
v_pk_mul_f32 v[222:223], v[222:223], v[190:191]
v_pk_mul_f32 v[190:191], v[190:191], v[30:31] op_sel:[0,1] op_sel_hi:[1,1]
v_pk_fma_f32 v[168:169], v[168:169], v[24:25], v[24:25] op_sel:[0,1,1] op_sel_hi:[1,1,1]
v_pk_fma_f32 v[170:171], v[170:171], v[24:25], v[24:25] op_sel:[0,1,1] op_sel_hi:[1,1,1]
v_pk_fma_f32 v[184:185], v[184:185], v[24:25], v[24:25] op_sel:[0,1,1] op_sel_hi:[1,1,1]
v_pk_fma_f32 v[186:187], v[186:187], v[24:25], v[24:25] op_sel:[0,1,1] op_sel_hi:[1,1,1]
v_cvt_pk_bf16_f32 v164, v196, v197
v_cvt_pk_bf16_f32 v165, v198, v199
v_cvt_pk_bf16_f32 v166, v212, v213
v_cvt_pk_bf16_f32 v167, v214, v215
MAA 240,48,128
buffer_store_dwordx4 v[164:167], v10, s[16:19], s64 offen offset:1024 sc1
MAA 240,52,144
v_rcp_f32 v168, v168
MAA 240,80,160
v_rcp_f32 v169, v169
MAA 240,84,176
v_rcp_f32 v170, v170
MAA 248,92,176
buffer_atomic_add v85, v69, s[16:19], s73 offen offset:512 sc0
MAA 248,88,160
v_rcp_f32 v171, v171
MAA 248,60,144
v_rcp_f32 v184, v184
MAA 248,56,128
v_rcp_f32 v185, v185
MAA 224,64,160
v_rcp_f32 v186, v186
MAA 224,68,176
v_rcp_f32 v187, v187
MAA 232,76,176
v_exp_f32 v172, v172
MAA 232,72,160
v_exp_f32 v173, v173
v_exp_f32 v174, v174
v_exp_f32 v175, v175
v_exp_f32 v188, v188
v_exp_f32 v189, v189
v_exp_f32 v190, v190
v_exp_f32 v191, v191
v_pk_mul_f32 v[200:201], v[200:201], v[168:169]
v_pk_mul_f32 v[202:203], v[202:203], v[170:171]
v_pk_mul_f32 v[216:217], v[216:217], v[184:185]
v_pk_mul_f32 v[218:219], v[218:219], v[186:187]
v_pk_mul_f32 v[240:241], v[240:241], v[224:225]
v_pk_mul_f32 v[224:225], v[224:225], v[28:29] op_sel_hi:[1,0]
v_pk_mul_f32 v[242:243], v[242:243], v[226:227]
v_pk_mul_f32 v[226:227], v[226:227], v[28:29] op_sel_hi:[1,0]
v_pk_mul_f32 v[248:249], v[248:249], v[232:233]
v_pk_mul_f32 v[232:233], v[232:233], v[28:29] op_sel_hi:[1,0]
v_pk_mul_f32 v[250:251], v[250:251], v[234:235]
v_pk_mul_f32 v[234:235], v[234:235], v[28:29] op_sel_hi:[1,0]
v_pk_fma_f32 v[172:173], v[172:173], v[26:27], v[26:27] op_sel:[0,1,1] op_sel_hi:[1,1,1]
v_pk_fma_f32 v[174:175], v[174:175], v[26:27], v[26:27] op_sel:[0,1,1] op_sel_hi:[1,1,1]
v_pk_fma_f32 v[188:189], v[188:189], v[26:27], v[26:27] op_sel:[0,1,1] op_sel_hi:[1,1,1]
v_pk_fma_f32 v[190:191], v[190:191], v[26:27], v[26:27] op_sel:[0,1,1] op_sel_hi:[1,1,1]
v_cvt_pk_bf16_f32 v168, v200, v201
v_cvt_pk_bf16_f32 v169, v202, v203
v_cvt_pk_bf16_f32 v170, v216, v217
v_cvt_pk_bf16_f32 v171, v218, v219
buffer_store_dwordx4 v[168:171], v11, s[16:19], s64 offen sc1
buffer_atomic_add v86, v69, s[16:19], s73 offen offset:512 sc0
s_waitcnt vmcnt(5)
v_cmp_gt_u32 vcc, v70, v84
s_nop 0
s_cbranch_vccz .Lok65
s_waitcnt vmcnt(2)
v_cmp_gt_u32 vcc, v70, v85
s_nop 0
s_cbranch_vccz .Lok65
s_waitcnt vmcnt(0)
v_cmp_gt_u32 vcc, v70, v86
s_nop 0
s_cbranch_vccz .Lok65
s_mov_b32 s15, 0
.Lok65l:
v_mov_b32 v84, 0
buffer_atomic_add v84, v69, s[16:19], s73 offen offset:512 sc0
s_add_u32 s15, s15, 1
s_cmp_gt_u32 s15, 100000
s_waitcnt vmcnt(0)
s_cbranch_scc1 .Lok65
v_cmp_gt_u32 vcc, v70, v84
s_nop 0
s_cbranch_vccnz .Lok65l
.Lok65:
s_waitcnt vmcnt(4)
s_barrier
MAA 244,48,132
ds_read_b64_tr_b16 a[0:1], v7
s_add_u32 s52, s76, 0
MAA 244,52,148
buffer_load_dwordx4 v[96:99], v4, s[16:19], s52 offen sc1
MAA 244,80,164
TR 2,7,512
v_rcp_f32 v172, v172
MAA 244,84,180
TR 4,7,32
v_rcp_f32 v173, v173
MAA 252,92,180
TR 6,7,544
v_rcp_f32 v174, v174
MAA 252,88,164
buffer_load_dwordx4 v[100:103], v4, s[16:19], s52 offen offset:1024 sc1
MAA 252,60,148
TR 8,7,64
s_add_u32 s52, s76, 65536
MAA 252,56,132
TR 10,7,576
v_rcp_f32 v175, v175
MAA 228,64,164
TR 12,7,96
v_rcp_f32 v188, v188
MAA 228,68,180
buffer_load_dwordx4 v[104:107], v4, s[16:19], s52 offen sc1
MAA 236,76,180
TR 14,7,608
v_rcp_f32 v189, v189
MAA 236,72,164
TR 16,7,8448
v_rcp_f32 v190, v190
v_rcp_f32 v191, v191
v_exp_f32 v224, v224
v_exp_f32 v225, v225
v_exp_f32 v226, v226
v_exp_f32 v227, v227
v_exp_f32 v232, v232
v_exp_f32 v233, v233
v_exp_f32 v234, v234
v_exp_f32 v235, v235
v_pk_mul_f32 v[204:205], v[204:205], v[172:173]
buffer_load_dwordx4 v[108:111], v4, s[16:19], s52 offen offset:1024 sc1
s_add_u32 s52, s77, 114688
v_pk_mul_f32 v[206:207], v[206:207], v[174:175]
v_pk_mul_f32 v[220:221], v[220:221], v[188:189]
v_pk_mul_f32 v[222:223], v[222:223], v[190:191]
v_pk_mul_f32 v[244:245], v[244:245], v[228:229]
v_pk_mul_f32 v[228:229], v[228:229], v[28:29] op_sel:[0,1] op_sel_hi:[1,1]
v_pk_mul_f32 v[246:247], v[246:247], v[230:231]
v_pk_mul_f32 v[230:231], v[230:231], v[28:29] op_sel:[0,1] op_sel_hi:[1,1]
v_pk_mul_f32 v[252:253], v[252:253], v[236:237]
v_pk_mul_f32 v[236:237], v[236:237], v[28:29] op_sel:[0,1] op_sel_hi:[1,1]
v_pk_mul_f32 v[254:255], v[254:255], v[238:239]
v_pk_mul_f32 v[238:239], v[238:239], v[28:29] op_sel:[0,1] op_sel_hi:[1,1]
v_pk_fma_f32 v[224:225], v[224:225], v[20:21], v[20:21] op_sel:[0,1,1] op_sel_hi:[1,1,1]
buffer_load_dwordx4 v[112:115], v4, s[16:19], s52 offen sc1
v_pk_fma_f32 v[226:227], v[226:227], v[20:21], v[20:21] op_sel:[0,1,1] op_sel_hi:[1,1,1]
v_pk_fma_f32 v[232:233], v[232:233], v[20:21], v[20:21] op_sel:[0,1,1] op_sel_hi:[1,1,1]
v_pk_fma_f32 v[234:235], v[234:235], v[20:21], v[20:21] op_sel:[0,1,1] op_sel_hi:[1,1,1]
v_cvt_pk_bf16_f32 v172, v204, v205
v_cvt_pk_bf16_f32 v173, v206, v207
v_cvt_pk_bf16_f32 v174, v220, v221
v_cvt_pk_bf16_f32 v175, v222, v223
TR 18,7,8960
TR 20,7,8480
TR 22,7,8992
buffer_store_dwordx4 v[172:175], v11, s[16:19], s64 offen offset:1024 sc1
TR 24,7,8512
TR 26,7,9024
TR 28,7,8544
TR 30,7,9056
v_rcp_f32 v224, v224
v_rcp_f32 v225, v225
v_rcp_f32 v226, v226
v_rcp_f32 v227, v227
v_rcp_f32 v232, v232
v_rcp_f32 v233, v233
v_rcp_f32 v234, v234
v_rcp_f32 v235, v235
v_exp_f32 v228, v228
v_exp_f32 v229, v229
v_exp_f32 v230, v230
v_exp_f32 v231, v231
v_exp_f32 v236, v236
v_exp_f32 v237, v237
v_exp_f32 v238, v238
v_exp_f32 v239, v239
v_pk_mul_f32 v[240:241], v[240:241], v[224:225]
buffer_load_dwordx4 v[116:119], v4, s[16:19], s52 offen offset:1024 sc1
s_add_u32 s52, s77, 180224
v_pk_mul_f32 v[242:243], v[242:243], v[226:227]
v_pk_mul_f32 v[248:249], v[248:249], v[232:233]
v_pk_mul_f32 v[250:251], v[250:251], v[234:235]
v_pk_fma_f32 v[228:229], v[228:229], v[22:23], v[22:23] op_sel:[0,1,1] op_sel_hi:[1,1,1]
v_pk_fma_f32 v[230:231], v[230:231], v[22:23], v[22:23] op_sel:[0,1,1] op_sel_hi:[1,1,1]
v_pk_fma_f32 v[236:237], v[236:237], v[22:23], v[22:23] op_sel:[0,1,1] op_sel_hi:[1,1,1]
v_pk_fma_f32 v[238:239], v[238:239], v[22:23], v[22:23] op_sel:[0,1,1] op_sel_hi:[1,1,1]
v_cvt_pk_bf16_f32 v224, v240, v241
v_cvt_pk_bf16_f32 v225, v242, v243
v_cvt_pk_bf16_f32 v226, v248, v249
v_cvt_pk_bf16_f32 v227, v250, v251
v_rcp_f32 v228, v228
v_rcp_f32 v229, v229
v_rcp_f32 v230, v230
v_rcp_f32 v231, v231
v_rcp_f32 v236, v236
v_rcp_f32 v237, v237
v_rcp_f32 v238, v238
v_rcp_f32 v239, v239
v_pk_mul_f32 v[244:245], v[244:245], v[228:229]
buffer_store_dwordx4 v[224:227], v10, s[16:19], s65 offen sc1
v_pk_mul_f32 v[246:247], v[246:247], v[230:231]
v_pk_mul_f32 v[252:253], v[252:253], v[236:237]
v_pk_mul_f32 v[254:255], v[254:255], v[238:239]
v_cvt_pk_bf16_f32 v228, v244, v245
v_cvt_pk_bf16_f32 v229, v246, v247
v_cvt_pk_bf16_f32 v230, v252, v253
v_cvt_pk_bf16_f32 v231, v254, v255
buffer_store_dwordx4 v[228:231], v10, s[16:19], s65 offen offset:1024 sc1
buffer_load_dwordx4 v[120:123], v4, s[16:19], s52 offen sc1
buffer_load_dwordx4 v[124:127], v4, s[16:19], s52 offen offset:1024 sc1
v_mov_b32 v21, v68
v_mov_b32 v22, v69
v_mov_b32 v23, v70
v_mov_b32 v24, v71
v_mov_b32 v25, 0
s_waitcnt vmcnt(7) lgkmcnt(0)
s_barrier
v_mfma_f32_16x16x32_bf16 v[32:35], a[0:3], v[96:99], 0
ds_read_b64_tr_b16 a[32:33], v6
s_add_u32 s52, s78, 229376
MAV 32,16,104
buffer_load_dwordx4 v[128:131], v4, s[16:19], s52 offen sc1
v_mfma_f32_16x16x32_bf16 v[48:51], a[0:3], v[100:103], 0
TR 34,6,512
TR 36,6,32
MAV 48,16,108
TR 38,6,544
v_mfma_f32_16x16x32_bf16 v[52:55], a[4:7], v[100:103], 0
buffer_load_dwordx4 v[132:135], v4, s[16:19], s52 offen offset:1024 sc1
MAV 52,20,108
TR 48,6,8448
TR 50,6,8960
v_mfma_f32_16x16x32_bf16 v[36:39], a[4:7], v[96:99], 0
TR 52,6,8480
MAV 36,20,104
TR 54,6,8992
s_add_u32 s52, s78, 294912
v_mfma_f32_16x16x32_bf16 v[40:43], a[8:11], v[96:99], 0
buffer_load_dwordx4 v[136:139], v4, s[16:19], s52 offen sc1
MAV 40,24,104
TR 40,6,64
v_mfma_f32_16x16x32_bf16 v[56:59], a[8:11], v[100:103], 0
TR 42,6,576
TR 44,6,96
MAV 56,24,108
TR 46,6,608
v_mfma_f32_16x16x32_bf16 v[60:63], a[12:15], v[100:103], 0
buffer_load_dwordx4 v[140:143], v4, s[16:19], s52 offen offset:1024 sc1
MAV 60,28,108
TR 56,6,8512
TR 58,6,9024
v_mfma_f32_16x16x32_bf16 v[44:47], a[12:15], v[96:99], 0
TR 60,6,8544
MAV 44,28,104
TR 62,6,9056
s_waitcnt lgkmcnt(8)
v_mfma_f32_16x16x32_bf16 v[64:67], a[32:35], v[96:99], 0
TR 0,7,16896
s_add_u32 s52, s79, 344064
MAV 64,48,104
buffer_load_dwordx4 v[144:147], v4, s[16:19], s52 offen sc1
v_mfma_f32_16x16x32_bf16 v[80:83], a[32:35], v[100:103], 0
TR 2,7,17408
TR 4,7,16928
MAV 80,48,108
TR 6,7,17440
v_mfma_f32_16x16x32_bf16 v[84:87], a[36:39], v[100:103], 0
buffer_load_dwordx4 v[148:151], v4, s[16:19], s52 offen offset:1024 sc1
MAV 84,52,108
TR 16,7,25344
TR 18,7,25856
v_mfma_f32_16x16x32_bf16 v[68:71], a[36:39], v[96:99], 0
TR 20,7,25376
MAV 68,52,104
TR 22,7,25888
s_add_u32 s52, s79, 409600
s_waitcnt lgkmcnt(8)
v_mfma_f32_16x16x32_bf16 v[72:75], a[40:43], v[96:99], 0
buffer_load_dwordx4 v[152:155], v4, s[16:19], s52 offen sc1
MAV 72,56,104
TR 8,7,16960
v_mfma_f32_16x16x32_bf16 v[88:91], a[40:43], v[100:103], 0
TR 10,7,17472
TR 12,7,16992
MAV 88,56,108
TR 14,7,17504
v_mfma_f32_16x16x32_bf16 v[92:95], a[44:47], v[100:103], 0
buffer_load_dwordx4 v[156:159], v4, s[16:19], s52 offen offset:1024 sc1
MAV 92,60,108
TR 24,7,25408
TR 26,7,25920
v_mfma_f32_16x16x32_bf16 v[76:79], a[44:47], v[96:99], 0
TR 28,7,25440
MAV 76,60,104
TR 30,7,25952
s_waitcnt vmcnt(8) lgkmcnt(8)
s_barrier
MAV 32,0,112
TR 32,6,16896
TR 34,6,17408
MAV 32,16,120
buffer_atomic_add v24, v21, s[16:19], s72 offen
MAV 48,16,124
TR 36,6,16928
TR 38,6,17440
MAV 48,0,116
TR 48,6,25344
s_add_u32 m0, s55, 0
MAV 52,4,116
buffer_load_dwordx4 v18, s[28:31], s54 offen lds
MAV 52,20,124
TR 50,6,25856
MAV 36,20,120
TR 52,6,25376
TR 54,6,25888
MAV 36,4,112
TR 40,6,16960
s_add_u32 s52, s76, 458752
s_waitcnt lgkmcnt(9)
MAV 40,8,112
buffer_load_dwordx4 v[96:99], v4, s[16:19], s52 offen sc1
MAV 40,24,120
TR 42,6,17472
TR 44,6,16992
MAV 56,24,124
buffer_load_dwordx4 v19, s[28:31], s54 offen offset:1056 lds
MAV 56,8,116
s_add_u32 s54, s98, 327680
MAV 60,12,116
TR 46,6,17504
TR 56,6,25408
MAV 60,28,124
buffer_load_dwordx4 v[100:103], v4, s[16:19], s52 offen offset:1024 sc1
MAV 44,28,120
TR 58,6,25920
TR 60,6,25440
MAV 44,12,112
TR 62,6,25952
s_waitcnt lgkmcnt(8)
MAV 64,32,112
TR 0,7,33792
s_add_u32 m0, s55, 8448
MAV 64,48,120
buffer_load_dwordx4 v18, s[28:31], s54 offen lds
MAV 80,48,124
TR 2,7,34304
TR 4,7,33824
MAV 80,32,116
TR 6,7,34336
s_add_u32 s52, s76, 524288
MAV 84,36,116
buffer_load_dwordx4 v[104:107], v4, s[16:19], s52 offen sc1
MAV 84,52,124
TR 16,7,42240
MAV 68,52,120
TR 18,7,42752
TR 20,7,42272
MAV 68,36,112
TR 22,7,42784
s_waitcnt lgkmcnt(8)
MAV 72,40,112
buffer_load_dwordx4 v19, s[28:31], s54 offen offset:1056 lds
MAV 72,56,120
s_add_u32 s54, s99, 524288
MAV 88,56,124
TR 8,7,33856
TR 10,7,34368
MAV 88,40,116
TR 12,7,33888
TR 14,7,34400
MAV 92,44,116
buffer_load_dwordx4 v[108:111], v4, s[16:19], s52 offen offset:1024 sc1
MAV 92,60,124
TR 24,7,42304
MAV 76,60,120
TR 26,7,42816
TR 28,7,42336
MAV 76,44,112
TR 30,7,42848
s_waitcnt vmcnt(13) lgkmcnt(8)
s_barrier
MAV 32,0,128
TR 32,6,33792
s_add_u32 m0, s55, 16896
MAV 32,16,136
buffer_load_dwordx4 v18, s[28:31], s54 offen lds
MAV 48,16,140
TR 34,6,34304
TR 36,6,33824
MAV 48,0,132
TR 38,6,34336
s_add_u32 s52, s77, 573440
MAV 52,4,132
buffer_load_dwordx4 v[112:115], v4, s[16:19], s52 offen sc1
MAV 52,20,140
TR 48,6,42240
MAV 36,20,136
TR 50,6,42752
TR 52,6,42272
MAV 36,4,128
TR 54,6,42784
s_waitcnt lgkmcnt(8)
MAV 40,8,128
buffer_load_dwordx4 v19, s[28:31], s54 offen offset:1056 lds
MAV 40,24,136
s_add_u32 s54, s99, 786432
MAV 56,24,140
TR 40,6,33856
TR 42,6,34368
MAV 56,8,132
TR 44,6,33888
TR 46,6,34400
MAV 60,12,132
buffer_load_dwordx4 v[116:119], v4, s[16:19], s52 offen offset:1024 sc1
MAV 60,28,140
TR 56,6,42304
MAV 44,28,136
TR 58,6,42816
TR 60,6,42336
MAV 44,12,128
TR 62,6,42848
s_waitcnt lgkmcnt(8)
MAV 64,32,128
TR 0,7,50688
s_add_u32 m0, s55, 25344
MAV 64,48,136
buffer_load_dwordx4 v18, s[28:31], s54 offen lds
MAV 80,48,140
TR 2,7,51200
TR 4,7,50720
MAV 80,32,132
TR 6,7,51232
s_add_u32 s52, s77, 638976
MAV 84,36,132
buffer_load_dwordx4 v[120:123], v4, s[16:19], s52 offen sc1
MAV 84,52,140
TR 16,7,59136
TR 18,7,59648
MAV 68,52,136
TR 20,7,59168
TR 22,7,59680
MAV 68,36,128
s_waitcnt lgkmcnt(8)
MAV 72,40,128
buffer_load_dwordx4 v19, s[28:31], s54 offen offset:1056 lds
MAV 72,56,136
TR 8,7,50752
s_add_u32 s54, s100, 983040
MAV 88,56,140
buffer_load_dwordx4 v[124:127], v4, s[16:19], s52 offen offset:1024 sc1
MAV 88,40,132
TR 10,7,51264
TR 12,7,50784
MAV 92,44,132
TR 14,7,51296
TR 24,7,59200
MAV 92,60,140
buffer_atomic_add v25, v22, s[16:19], s73 offen sc0
MAV 76,60,136
TR 26,7,59712
TR 28,7,59232
MAV 76,44,128
TR 30,7,59744
s_waitcnt vmcnt(18) lgkmcnt(8)
s_barrier
MAV 32,0,144
TR 32,6,50688
.Lpad27:
s_cbranch_execz .Lpad30
s_add_u32 m0, s55, 33792
MAV 32,16,152
buffer_load_dwordx4 v18, s[28:31], s54 offen lds
MAV 48,16,156
TR 34,6,51200
TR 36,6,50720
MAV 48,0,148
TR 38,6,51232
s_add_u32 s52, s78, 688128
MAV 52,4,148
buffer_load_dwordx4 v[128:131], v4, s[16:19], s52 offen sc1
MAV 52,20,156
TR 48,6,59136
MAV 36,20,152
TR 50,6,59648
TR 52,6,59168
MAV 36,4,144
TR 54,6,59680
s_waitcnt lgkmcnt(8)
MAV 40,8,144
buffer_load_dwordx4 v19, s[28:31], s54 offen offset:1056 lds
MAV 40,24,152
s_add_u32 s54, s100, 1245184
MAV 56,24,156
TR 40,6,50752
TR 42,6,51264
MAV 56,8,148
TR 44,6,50784
TR 46,6,51296
MAV 60,12,148
buffer_load_dwordx4 v[132:135], v4, s[16:19], s52 offen offset:1024 sc1
MAV 60,28,156
TR 56,6,59200
MAV 44,28,152
TR 58,6,59712
TR 60,6,59232
MAV 44,12,144
TR 62,6,59744
v_add_u32 v7, s57, v7
v_add_u32 v6, s57, v6
s_sub_u32 s57, 0, s57
s_waitcnt lgkmcnt(8)
MAV 64,32,144
ds_read_b64_tr_b16 a[0:1], v7
s_add_u32 m0, s55, 42240
MAV 64,48,152
buffer_load_dwordx4 v18, s[28:31], s54 offen lds
MAV 80,48,156
TR 2,7,512
TR 4,7,32
MAV 80,32,148
TR 6,7,544
s_add_u32 s52, s78, 753664
MAV 84,36,148
buffer_load_dwordx4 v[136:139], v4, s[16:19], s52 offen sc1
MAV 84,52,156
TR 16,7,8448
MAV 68,52,152
TR 18,7,8960
TR 20,7,8480
MAV 68,36,144
TR 22,7,8992
s_waitcnt lgkmcnt(8)
MAV 72,40,144
buffer_load_dwordx4 v19, s[28:31], s54 offen offset:1056 lds
MAV 72,56,152
s_add_u32 s54, s101, 1441792
MAV 88,56,156
TR 8,7,64
TR 10,7,576
MAV 88,40,148
TR 12,7,96
TR 14,7,608
MAV 92,44,148
buffer_load_dwordx4 v[140:143], v4, s[16:19], s52 offen offset:1024 sc1
MAV 92,60,156
TR 24,7,8512
MAV 76,60,152
TR 26,7,9024
TR 28,7,8544
MAV 76,44,144
TR 30,7,9056
s_waitcnt vmcnt(17) lgkmcnt(8)
s_barrier
MAV 32,0,96
ds_read_b64_tr_b16 a[32:33], v6
s_add_u32 m0, s55, 50688
MAV 32,16,104
buffer_load_dwordx4 v18, s[28:31], s54 offen lds
MAV 48,16,108
TR 34,6,512
TR 36,6,32
MAV 48,0,100
TR 38,6,544
s_add_u32 s52, s79, 802816
MAV 52,4,100
buffer_load_dwordx4 v[144:147], v4, s[16:19], s52 offen sc1
MAV 52,20,108
TR 48,6,8448
MAV 36,20,104
TR 50,6,8960
TR 52,6,8480
MAV 36,4,96
TR 54,6,8992
s_waitcnt lgkmcnt(8)
MAV 40,8,96
buffer_load_dwordx4 v19, s[28:31], s54 offen offset:1056 lds
MAV 40,24,104
s_add_u32 s54, s101, 1703936
MAV 56,24,108
TR 40,6,64
TR 42,6,576
MAV 56,8,100
TR 44,6,96
TR 46,6,608
MAV 60,12,100
buffer_load_dwordx4 v[148:151], v4, s[16:19], s52 offen offset:1024 sc1
MAV 60,28,108
TR 56,6,8512
MAV 44,28,104
TR 58,6,9024
TR 60,6,8544
MAV 44,12,96
TR 62,6,9056
s_waitcnt lgkmcnt(8)
MAV 64,32,96
TR 0,7,16896
s_add_u32 m0, s55, 59136
MAV 64,48,104
buffer_load_dwordx4 v18, s[28:31], s54 offen lds
MAV 80,48,108
TR 2,7,17408
TR 4,7,16928
MAV 80,32,100
TR 6,7,17440
s_add_u32 s52, s79, 868352
MAV 84,36,100
buffer_load_dwordx4 v[152:155], v4, s[16:19], s52 offen sc1
MAV 84,52,108
TR 16,7,25344
MAV 68,52,104
TR 18,7,25856
TR 20,7,25376
MAV 68,36,96
TR 22,7,25888
s_waitcnt lgkmcnt(8)
MAV 72,40,96
buffer_load_dwordx4 v19, s[28:31], s54 offen offset:1056 lds
MAV 72,56,104
s_add_u32 s54, s98, 1900544
MAV 88,56,108
TR 8,7,16960
TR 10,7,17472
MAV 88,40,100
TR 12,7,16992
TR 14,7,17504
MAV 92,44,100
buffer_load_dwordx4 v[156:159], v4, s[16:19], s52 offen offset:1024 sc1
MAV 92,60,108
TR 24,7,25408
MAV 76,60,104
TR 26,7,25920
TR 28,7,25440
MAV 76,44,96
TR 30,7,25952
s_waitcnt vmcnt(16)
v_cmp_gt_u32 vcc, v23, v25
s_nop 0
s_cbranch_vccnz .Lsp66
.Lsp66b:
s_waitcnt lgkmcnt(8)
s_barrier
MAV 32,0,112
TR 32,6,16896
s_add_u32 m0, s55, 67584
MAV 32,16,120
buffer_load_dwordx4 v18, s[28:31], s54 offen lds
MAV 48,16,124
TR 34,6,17408
TR 36,6,16928
MAV 48,0,116
TR 38,6,17440
s_add_u32 s52, s76, 16384
MAV 52,4,116
buffer_load_dwordx4 v[96:99], v4, s[16:19], s52 offen sc1
MAV 52,20,124
TR 48,6,25344
MAV 36,20,120
TR 50,6,25856
TR 52,6,25376
MAV 36,4,112
TR 54,6,25888
s_waitcnt lgkmcnt(8)
MAV 40,8,112
buffer_load_dwordx4 v19, s[28:31], s54 offen offset:1056 lds
MAV 40,24,120
s_add_u32 s54, s98, 2162688
MAV 56,24,124
TR 40,6,16960
TR 42,6,17472
MAV 56,8,116
TR 44,6,16992
TR 46,6,17504
MAV 60,12,116
buffer_load_dwordx4 v[100:103], v4, s[16:19], s52 offen offset:1024 sc1
MAV 60,28,124
TR 56,6,25408
MAV 44,28,120
TR 58,6,25920
TR 60,6,25440
MAV 44,12,112
TR 62,6,25952
s_waitcnt lgkmcnt(8)
MAV 64,32,112
TR 0,7,33792
s_add_u32 m0, s55, 76032
MAV 64,48,120
buffer_load_dwordx4 v18, s[28:31], s54 offen lds
MAV 80,48,124
TR 2,7,34304
TR 4,7,33824
MAV 80,32,116
TR 6,7,34336
s_add_u32 s52, s76, 81920
MAV 84,36,116
buffer_load_dwordx4 v[104:107], v4, s[16:19], s52 offen sc1
MAV 84,52,124
TR 16,7,42240
MAV 68,52,120
TR 18,7,42752
TR 20,7,42272
MAV 68,36,112
TR 22,7,42784
s_waitcnt lgkmcnt(8)
MAV 72,40,112
buffer_load_dwordx4 v19, s[28:31], s54 offen offset:1056 lds
MAV 72,56,120
s_add_u32 s54, s99, 2359296
MAV 88,56,124
TR 8,7,33856
TR 10,7,34368
MAV 88,40,116
TR 12,7,33888
TR 14,7,34400
MAV 92,44,116
buffer_load_dwordx4 v[108:111], v4, s[16:19], s52 offen offset:1024 sc1
MAV 92,60,124
TR 24,7,42304
MAV 76,60,120
TR 26,7,42816
TR 28,7,42336
MAV 76,44,112
TR 30,7,42848
s_waitcnt vmcnt(16) lgkmcnt(8)
s_barrier
MAV 32,0,128
TR 32,6,33792
s_add_u32 m0, s55, 84480
MAV 32,16,136
buffer_load_dwordx4 v18, s[28:31], s54 offen lds
MAV 48,16,140
TR 34,6,34304
TR 36,6,33824
MAV 48,0,132
TR 38,6,34336
s_add_u32 s52, s77, 131072
MAV 52,4,132
buffer_load_dwordx4 v[112:115], v4, s[16:19], s52 offen sc1
MAV 52,20,140
TR 48,6,42240
MAV 36,20,136
TR 50,6,42752
TR 52,6,42272
MAV 36,4,128
TR 54,6,42784
s_waitcnt lgkmcnt(8)
MAV 40,8,128
buffer_load_dwordx4 v19, s[28:31], s54 offen offset:1056 lds
MAV 40,24,136
s_add_u32 s54, s99, 2621440
MAV 56,24,140
TR 40,6,33856
TR 42,6,34368
MAV 56,8,132
TR 44,6,33888
TR 46,6,34400
MAV 60,12,132
buffer_load_dwordx4 v[116:119], v4, s[16:19], s52 offen offset:1024 sc1
MAV 60,28,140
TR 56,6,42304
MAV 44,28,136
TR 58,6,42816
TR 60,6,42336
MAV 44,12,128
TR 62,6,42848
s_waitcnt lgkmcnt(8)
MAV 64,32,128
TR 0,7,50688
s_add_u32 m0, s55, 92928
MAV 64,48,136
buffer_load_dwordx4 v18, s[28:31], s54 offen lds
MAV 80,48,140
TR 2,7,51200
TR 4,7,50720
MAV 80,32,132
TR 6,7,51232
s_add_u32 s52, s77, 196608
MAV 84,36,132
buffer_load_dwordx4 v[120:123], v4, s[16:19], s52 offen sc1
MAV 84,52,140
TR 16,7,59136
MAV 68,52,136
TR 18,7,59648
TR 20,7,59168
MAV 68,36,128
TR 22,7,59680
s_waitcnt lgkmcnt(8)
MAV 72,40,128
buffer_load_dwordx4 v19, s[28:31], s54 offen offset:1056 lds
MAV 72,56,136
s_add_u32 s54, s100, 2818048
MAV 88,56,140
TR 8,7,50752
TR 10,7,51264
MAV 88,40,132
TR 12,7,50784
TR 14,7,51296
MAV 92,44,132
buffer_load_dwordx4 v[124:127], v4, s[16:19], s52 offen offset:1024 sc1
MAV 92,60,140
TR 24,7,59200
MAV 76,60,136
TR 26,7,59712
TR 28,7,59232
MAV 76,44,128
TR 30,7,59744
s_waitcnt vmcnt(16) lgkmcnt(8)
s_barrier
MAV 32,0,144
TR 32,6,50688
s_add_u32 m0, s55, 101376
MAV 32,16,152
buffer_load_dwordx4 v18, s[28:31], s54 offen lds
MAV 48,16,156
TR 34,6,51200
TR 36,6,50720
MAV 48,0,148
TR 38,6,51232
s_add_u32 s52, s78, 245760
MAV 52,4,148
buffer_load_dwordx4 v[128:131], v4, s[16:19], s52 offen sc1
MAV 52,20,156
TR 48,6,59136
MAV 36,20,152
TR 50,6,59648
TR 52,6,59168
MAV 36,4,144
TR 54,6,59680
s_waitcnt lgkmcnt(8)
MAV 40,8,144
buffer_load_dwordx4 v19, s[28:31], s54 offen offset:1056 lds
MAV 40,24,152
s_add_u32 s54, s100, 3080192
MAV 56,24,156
TR 40,6,50752
TR 42,6,51264
MAV 56,8,148
TR 44,6,50784
TR 46,6,51296
MAV 60,12,148
buffer_load_dwordx4 v[132:135], v4, s[16:19], s52 offen offset:1024 sc1
MAV 60,28,156
TR 56,6,59200
MAV 44,28,152
TR 58,6,59712
TR 60,6,59232
MAV 44,12,144
TR 62,6,59744
v_add_u32 v7, s57, v7
v_add_u32 v6, s57, v6
s_sub_u32 s57, 0, s57
s_waitcnt lgkmcnt(8)
MAV 64,32,144
ds_read_b64_tr_b16 a[0:1], v7
s_add_u32 m0, s55, 109824
MAV 64,48,152
buffer_load_dwordx4 v18, s[28:31], s54 offen lds
MAV 80,48,156
TR 2,7,512
TR 4,7,32
MAV 80,32,148
TR 6,7,544
s_add_u32 s52, s78, 311296
MAV 84,36,148
buffer_load_dwordx4 v[136:139], v4, s[16:19], s52 offen sc1
MAV 84,52,156
TR 16,7,8448
MAV 68,52,152
TR 18,7,8960
TR 20,7,8480
MAV 68,36,144
TR 22,7,8992
s_waitcnt lgkmcnt(8)
MAV 72,40,144
buffer_load_dwordx4 v19, s[28:31], s54 offen offset:1056 lds
MAV 72,56,152
s_add_u32 s54, s101, 3276800
MAV 88,56,156
TR 8,7,64
TR 10,7,576
MAV 88,40,148
TR 12,7,96
TR 14,7,608
MAV 92,44,148
buffer_load_dwordx4 v[140:143], v4, s[16:19], s52 offen offset:1024 sc1
MAV 92,60,156
TR 24,7,8512
MAV 76,60,152
TR 26,7,9024
TR 28,7,8544
MAV 76,44,144
TR 30,7,9056
s_waitcnt vmcnt(16) lgkmcnt(8)
s_barrier
MAV 32,0,96
ds_read_b64_tr_b16 a[32:33], v6
s_add_u32 m0, s55, 118272
MAV 32,16,104
buffer_load_dwordx4 v18, s[28:31], s54 offen lds
MAV 48,16,108
TR 34,6,512
TR 36,6,32
MAV 48,0,100
TR 38,6,544
s_add_u32 s52, s79, 360448
MAV 52,4,100
buffer_load_dwordx4 v[144:147], v4, s[16:19], s52 offen sc1
MAV 52,20,108
TR 48,6,8448
MAV 36,20,104
TR 50,6,8960
TR 52,6,8480
MAV 36,4,96
TR 54,6,8992
s_waitcnt lgkmcnt(8)
MAV 40,8,96
buffer_load_dwordx4 v19, s[28:31], s54 offen offset:1056 lds
MAV 40,24,104
s_add_u32 s54, s101, 3538944
MAV 56,24,108
TR 40,6,64
TR 42,6,576
MAV 56,8,100
TR 44,6,96
TR 46,6,608
MAV 60,12,100
buffer_load_dwordx4 v[148:151], v4, s[16:19], s52 offen offset:1024 sc1
MAV 60,28,108
TR 56,6,8512
MAV 44,28,104
TR 58,6,9024
TR 60,6,8544
MAV 44,12,96
TR 62,6,9056
s_waitcnt lgkmcnt(8)
MAV 64,32,96
TR 0,7,16896
s_add_u32 m0, s55, 126720
MAV 64,48,104
buffer_load_dwordx4 v18, s[28:31], s54 offen lds
MAV 80,48,108
TR 2,7,17408
TR 4,7,16928
MAV 80,32,100
TR 6,7,17440
s_add_u32 s52, s79, 425984
MAV 84,36,100
buffer_load_dwordx4 v[152:155], v4, s[16:19], s52 offen sc1
MAV 84,52,108
TR 16,7,25344
MAV 68,52,104
TR 18,7,25856
TR 20,7,25376
MAV 68,36,96
TR 22,7,25888
s_waitcnt lgkmcnt(8)
MAV 72,40,96
buffer_load_dwordx4 v19, s[28:31], s54 offen offset:1056 lds
MAV 72,56,104
s_add_u32 s54, s98, 131072
MAV 88,56,108
TR 8,7,16960
TR 10,7,17472
MAV 88,40,100
TR 12,7,16992
TR 14,7,17504
MAV 92,44,100
buffer_load_dwordx4 v[156:159], v4, s[16:19], s52 offen offset:1024 sc1
MAV 92,60,108
TR 24,7,25408
MAV 76,60,104
TR 26,7,25920
TR 28,7,25440
MAV 76,44,96
TR 30,7,25952
s_waitcnt vmcnt(16) lgkmcnt(8)
s_barrier
MAV 32,0,112
TR 32,6,16896
s_add_u32 m0, s55, 0
MAV 32,16,120
buffer_load_dwordx4 v18, s[28:31], s54 offen lds
MAV 48,16,124
TR 34,6,17408
TR 36,6,16928
MAV 48,0,116
TR 38,6,17440
s_add_u32 s52, s76, 475136
MAV 52,4,116
buffer_load_dwordx4 v[96:99], v4, s[16:19], s52 offen sc1
MAV 52,20,124
TR 48,6,25344
MAV 36,20,120
TR 50,6,25856
TR 52,6,25376
MAV 36,4,112
TR 54,6,25888
s_waitcnt lgkmcnt(8)
MAV 40,8,112
buffer_load_dwordx4 v19, s[28:31], s54 offen offset:1056 lds
MAV 40,24,120
s_add_u32 s54, s98, 393216
MAV 56,24,124
TR 40,6,16960
.Lpad28:
s_cbranch_execz .Lpad31
TR 42,6,17472
MAV 56,8,116
TR 44,6,16992
TR 46,6,17504
MAV 60,12,116
buffer_load_dwordx4 v[100:103], v4, s[16:19], s52 offen offset:1024 sc1
MAV 60,28,124
TR 56,6,25408
MAV 44,28,120
TR 58,6,25920
TR 60,6,25440
MAV 44,12,112
TR 62,6,25952
s_waitcnt lgkmcnt(8)
MAV 64,32,112
TR 0,7,33792
s_add_u32 m0, s55, 8448
MAV 64,48,120
buffer_load_dwordx4 v18, s[28:31], s54 offen lds
MAV 80,48,124
TR 2,7,34304
TR 4,7,33824
MAV 80,32,116
TR 6,7,34336
s_add_u32 s52, s76, 540672
MAV 84,36,116
buffer_load_dwordx4 v[104:107], v4, s[16:19], s52 offen sc1
MAV 84,52,124
TR 16,7,42240
MAV 68,52,120
TR 18,7,42752
TR 20,7,42272
MAV 68,36,112
TR 22,7,42784
s_waitcnt lgkmcnt(8)
MAV 72,40,112
buffer_load_dwordx4 v19, s[28:31], s54 offen offset:1056 lds
MAV 72,56,120
s_add_u32 s54, s99, 589824
MAV 88,56,124
TR 8,7,33856
TR 10,7,34368
MAV 88,40,116
TR 12,7,33888
TR 14,7,34400
MAV 92,44,116
buffer_load_dwordx4 v[108:111], v4, s[16:19], s52 offen offset:1024 sc1
MAV 92,60,124
TR 24,7,42304
MAV 76,60,120
TR 26,7,42816
TR 28,7,42336
MAV 76,44,112
TR 30,7,42848
s_waitcnt vmcnt(16) lgkmcnt(8)
s_barrier
MAV 32,0,128
TR 32,6,33792
s_add_u32 m0, s55, 16896
MAV 32,16,136
buffer_load_dwordx4 v18, s[28:31], s54 offen lds
MAV 48,16,140
TR 34,6,34304
TR 36,6,33824
MAV 48,0,132
TR 38,6,34336
s_add_u32 s52, s77, 589824
MAV 52,4,132
buffer_load_dwordx4 v[112:115], v4, s[16:19], s52 offen sc1
MAV 52,20,140
TR 48,6,42240
MAV 36,20,136
TR 50,6,42752
TR 52,6,42272
MAV 36,4,128
TR 54,6,42784
s_waitcnt lgkmcnt(8)
MAV 40,8,128
buffer_load_dwordx4 v19, s[28:31], s54 offen offset:1056 lds
MAV 40,24,136
s_add_u32 s54, s99, 851968
MAV 56,24,140
TR 40,6,33856
TR 42,6,34368
MAV 56,8,132
TR 44,6,33888
TR 46,6,34400
MAV 60,12,132
buffer_load_dwordx4 v[116:119], v4, s[16:19], s52 offen offset:1024 sc1
MAV 60,28,140
TR 56,6,42304
MAV 44,28,136
TR 58,6,42816
TR 60,6,42336
MAV 44,12,128
TR 62,6,42848
s_waitcnt lgkmcnt(8)
MAV 64,32,128
TR 0,7,50688
s_add_u32 m0, s55, 25344
MAV 64,48,136
buffer_load_dwordx4 v18, s[28:31], s54 offen lds
MAV 80,48,140
TR 2,7,51200
TR 4,7,50720
MAV 80,32,132
TR 6,7,51232
s_add_u32 s52, s77, 655360
MAV 84,36,132
buffer_load_dwordx4 v[120:123], v4, s[16:19], s52 offen sc1
MAV 84,52,140
TR 16,7,59136
MAV 68,52,136
TR 18,7,59648
TR 20,7,59168
MAV 68,36,128
TR 22,7,59680
s_waitcnt lgkmcnt(8)
MAV 72,40,128
buffer_load_dwordx4 v19, s[28:31], s54 offen offset:1056 lds
MAV 72,56,136
s_add_u32 s54, s100, 1048576
MAV 88,56,140
TR 8,7,50752
TR 10,7,51264
MAV 88,40,132
TR 12,7,50784
TR 14,7,51296
MAV 92,44,132
buffer_load_dwordx4 v[124:127], v4, s[16:19], s52 offen offset:1024 sc1
MAV 92,60,140
TR 24,7,59200
MAV 76,60,136
TR 26,7,59712
TR 28,7,59232
MAV 76,44,128
TR 30,7,59744
s_waitcnt vmcnt(16) lgkmcnt(8)
s_barrier
MAV 32,0,144
TR 32,6,50688
s_add_u32 m0, s55, 33792
MAV 32,16,152
buffer_load_dwordx4 v18, s[28:31], s54 offen lds
MAV 48,16,156
TR 34,6,51200
TR 36,6,50720
MAV 48,0,148
TR 38,6,51232
s_add_u32 s52, s78, 704512
MAV 52,4,148
buffer_load_dwordx4 v[128:131], v4, s[16:19], s52 offen sc1
MAV 52,20,156
TR 48,6,59136
MAV 36,20,152
TR 50,6,59648
TR 52,6,59168
MAV 36,4,144
TR 54,6,59680
s_waitcnt lgkmcnt(8)
MAV 40,8,144
buffer_load_dwordx4 v19, s[28:31], s54 offen offset:1056 lds
MAV 40,24,152
s_add_u32 s54, s100, 1310720
MAV 56,24,156
TR 40,6,50752
TR 42,6,51264
MAV 56,8,148
TR 44,6,50784
TR 46,6,51296
MAV 60,12,148
buffer_load_dwordx4 v[132:135], v4, s[16:19], s52 offen offset:1024 sc1
MAV 60,28,156
TR 56,6,59200
MAV 44,28,152
TR 58,6,59712
TR 60,6,59232
MAV 44,12,144
TR 62,6,59744
v_add_u32 v7, s57, v7
v_add_u32 v6, s57, v6
s_sub_u32 s57, 0, s57
s_waitcnt lgkmcnt(8)
MAV 64,32,144
ds_read_b64_tr_b16 a[0:1], v7
s_add_u32 m0, s55, 42240
MAV 64,48,152
buffer_load_dwordx4 v18, s[28:31], s54 offen lds
MAV 80,48,156
TR 2,7,512
TR 4,7,32
MAV 80,32,148
TR 6,7,544
s_add_u32 s52, s78, 770048
MAV 84,36,148
buffer_load_dwordx4 v[136:139], v4, s[16:19], s52 offen sc1
MAV 84,52,156
TR 16,7,8448
MAV 68,52,152
TR 18,7,8960
TR 20,7,8480
MAV 68,36,144
TR 22,7,8992
s_waitcnt lgkmcnt(8)
MAV 72,40,144
buffer_load_dwordx4 v19, s[28:31], s54 offen offset:1056 lds
MAV 72,56,152
s_add_u32 s54, s101, 1507328
MAV 88,56,156
TR 8,7,64
TR 10,7,576
MAV 88,40,148
TR 12,7,96
TR 14,7,608
MAV 92,44,148
buffer_load_dwordx4 v[140:143], v4, s[16:19], s52 offen offset:1024 sc1
MAV 92,60,156
TR 24,7,8512
MAV 76,60,152
TR 26,7,9024
TR 28,7,8544
MAV 76,44,144
TR 30,7,9056
s_waitcnt vmcnt(16) lgkmcnt(8)
s_barrier
MAV 32,0,96
ds_read_b64_tr_b16 a[32:33], v6
s_add_u32 m0, s55, 50688
MAV 32,16,104
buffer_load_dwordx4 v18, s[28:31], s54 offen lds
MAV 48,16,108
TR 34,6,512
TR 36,6,32
MAV 48,0,100
TR 38,6,544
s_add_u32 s52, s79, 819200
MAV 52,4,100
buffer_load_dwordx4 v[144:147], v4, s[16:19], s52 offen sc1
MAV 52,20,108
TR 48,6,8448
MAV 36,20,104
TR 50,6,8960
TR 52,6,8480
MAV 36,4,96
TR 54,6,8992
s_waitcnt lgkmcnt(8)
MAV 40,8,96
buffer_load_dwordx4 v19, s[28:31], s54 offen offset:1056 lds
MAV 40,24,104
s_add_u32 s54, s101, 1769472
MAV 56,24,108
TR 40,6,64
TR 42,6,576
MAV 56,8,100
TR 44,6,96
TR 46,6,608
MAV 60,12,100
buffer_load_dwordx4 v[148:151], v4, s[16:19], s52 offen offset:1024 sc1
MAV 60,28,108
TR 56,6,8512
MAV 44,28,104
TR 58,6,9024
TR 60,6,8544
MAV 44,12,96
TR 62,6,9056
s_waitcnt lgkmcnt(8)
MAV 64,32,96
TR 0,7,16896
s_add_u32 m0, s55, 59136
MAV 64,48,104
buffer_load_dwordx4 v18, s[28:31], s54 offen lds
MAV 80,48,108
TR 2,7,17408
TR 4,7,16928
MAV 80,32,100
TR 6,7,17440
s_add_u32 s52, s79, 884736
MAV 84,36,100
buffer_load_dwordx4 v[152:155], v4, s[16:19], s52 offen sc1
MAV 84,52,108
TR 16,7,25344
MAV 68,52,104
TR 18,7,25856
TR 20,7,25376
MAV 68,36,96
TR 22,7,25888
s_waitcnt lgkmcnt(8)
MAV 72,40,96
buffer_load_dwordx4 v19, s[28:31], s54 offen offset:1056 lds
MAV 72,56,104
s_add_u32 s54, s98, 1966080
MAV 88,56,108
TR 8,7,16960
TR 10,7,17472
MAV 88,40,100
TR 12,7,16992
TR 14,7,17504
MAV 92,44,100
buffer_load_dwordx4 v[156:159], v4, s[16:19], s52 offen offset:1024 sc1
MAV 92,60,108
TR 24,7,25408
MAV 76,60,104
TR 26,7,25920
TR 28,7,25440
MAV 76,44,96
TR 30,7,25952
s_waitcnt vmcnt(16) lgkmcnt(8)
s_barrier
MAV 32,0,112
TR 32,6,16896
s_add_u32 m0, s55, 67584
MAV 32,16,120
buffer_load_dwordx4 v18, s[28:31], s54 offen lds
MAV 48,16,124
TR 34,6,17408
TR 36,6,16928
MAV 48,0,116
TR 38,6,17440
s_add_u32 s52, s76, 32768
MAV 52,4,116
buffer_load_dwordx4 v[96:99], v4, s[16:19], s52 offen sc1
MAV 52,20,124
TR 48,6,25344
MAV 36,20,120
TR 50,6,25856
TR 52,6,25376
MAV 36,4,112
TR 54,6,25888
s_waitcnt lgkmcnt(8)
MAV 40,8,112
buffer_load_dwordx4 v19, s[28:31], s54 offen offset:1056 lds
MAV 40,24,120
s_add_u32 s54, s98, 2228224
MAV 56,24,124
TR 40,6,16960
TR 42,6,17472
MAV 56,8,116
TR 44,6,16992
TR 46,6,17504
MAV 60,12,116
buffer_load_dwordx4 v[100:103], v4, s[16:19], s52 offen offset:1024 sc1
MAV 60,28,124
TR 56,6,25408
MAV 44,28,120
TR 58,6,25920
TR 60,6,25440
MAV 44,12,112
TR 62,6,25952
s_waitcnt lgkmcnt(8)
MAV 64,32,112
TR 0,7,33792
s_add_u32 m0, s55, 76032
MAV 64,48,120
buffer_load_dwordx4 v18, s[28:31], s54 offen lds
MAV 80,48,124
TR 2,7,34304
TR 4,7,33824
MAV 80,32,116
TR 6,7,34336
s_add_u32 s52, s76, 98304
MAV 84,36,116
buffer_load_dwordx4 v[104:107], v4, s[16:19], s52 offen sc1
MAV 84,52,124
TR 16,7,42240
MAV 68,52,120
TR 18,7,42752
TR 20,7,42272
MAV 68,36,112
TR 22,7,42784
s_waitcnt lgkmcnt(8)
MAV 72,40,112
buffer_load_dwordx4 v19, s[28:31], s54 offen offset:1056 lds
MAV 72,56,120
s_add_u32 s54, s99, 2424832
MAV 88,56,124
TR 8,7,33856
TR 10,7,34368
MAV 88,40,116
TR 12,7,33888
TR 14,7,34400
MAV 92,44,116
buffer_load_dwordx4 v[108:111], v4, s[16:19], s52 offen offset:1024 sc1
MAV 92,60,124
TR 24,7,42304
MAV 76,60,120
TR 26,7,42816
TR 28,7,42336
MAV 76,44,112
TR 30,7,42848
s_waitcnt vmcnt(16) lgkmcnt(8)
s_barrier
MAV 32,0,128
TR 32,6,33792
s_add_u32 m0, s55, 84480
MAV 32,16,136
buffer_load_dwordx4 v18, s[28:31], s54 offen lds
MAV 48,16,140
TR 34,6,34304
TR 36,6,33824
MAV 48,0,132
TR 38,6,34336
s_add_u32 s52, s77, 147456
MAV 52,4,132
buffer_load_dwordx4 v[112:115], v4, s[16:19], s52 offen sc1
MAV 52,20,140
TR 48,6,42240
MAV 36,20,136
TR 50,6,42752
TR 52,6,42272
MAV 36,4,128
TR 54,6,42784
s_waitcnt lgkmcnt(8)
MAV 40,8,128
buffer_load_dwordx4 v19, s[28:31], s54 offen offset:1056 lds
MAV 40,24,136
s_add_u32 s54, s99, 2686976
MAV 56,24,140
TR 40,6,33856
TR 42,6,34368
MAV 56,8,132
TR 44,6,33888
TR 46,6,34400
MAV 60,12,132
buffer_load_dwordx4 v[116:119], v4, s[16:19], s52 offen offset:1024 sc1
MAV 60,28,140
TR 56,6,42304
MAV 44,28,136
TR 58,6,42816
TR 60,6,42336
MAV 44,12,128
TR 62,6,42848
s_waitcnt lgkmcnt(8)
MAV 64,32,128
TR 0,7,50688
s_add_u32 m0, s55, 92928
MAV 64,48,136
buffer_load_dwordx4 v18, s[28:31], s54 offen lds
MAV 80,48,140
TR 2,7,51200
TR 4,7,50720
MAV 80,32,132
TR 6,7,51232
s_add_u32 s52, s77, 212992
MAV 84,36,132
buffer_load_dwordx4 v[120:123], v4, s[16:19], s52 offen sc1
MAV 84,52,140
TR 16,7,59136
MAV 68,52,136
TR 18,7,59648
TR 20,7,59168
MAV 68,36,128
TR 22,7,59680
s_waitcnt lgkmcnt(8)
MAV 72,40,128
buffer_load_dwordx4 v19, s[28:31], s54 offen offset:1056 lds
MAV 72,56,136
s_add_u32 s54, s100, 2883584
MAV 88,56,140
TR 8,7,50752
TR 10,7,51264
MAV 88,40,132
TR 12,7,50784
TR 14,7,51296
MAV 92,44,132
buffer_load_dwordx4 v[124:127], v4, s[16:19], s52 offen offset:1024 sc1
MAV 92,60,140
TR 24,7,59200
MAV 76,60,136
TR 26,7,59712
TR 28,7,59232
MAV 76,44,128
TR 30,7,59744
s_waitcnt vmcnt(16) lgkmcnt(8)
s_barrier
MAV 32,0,144
TR 32,6,50688
s_add_u32 m0, s55, 101376
MAV 32,16,152
buffer_load_dwordx4 v18, s[28:31], s54 offen lds
MAV 48,16,156
TR 34,6,51200
TR 36,6,50720
MAV 48,0,148
TR 38,6,51232
s_add_u32 s52, s78, 262144
MAV 52,4,148
buffer_load_dwordx4 v[128:131], v4, s[16:19], s52 offen sc1
MAV 52,20,156
TR 48,6,59136
MAV 36,20,152
TR 50,6,59648
TR 52,6,59168
MAV 36,4,144
TR 54,6,59680
s_waitcnt lgkmcnt(8)
MAV 40,8,144
buffer_load_dwordx4 v19, s[28:31], s54 offen offset:1056 lds
MAV 40,24,152
s_add_u32 s54, s100, 3145728
MAV 56,24,156
TR 40,6,50752
TR 42,6,51264
MAV 56,8,148
TR 44,6,50784
TR 46,6,51296
MAV 60,12,148
buffer_load_dwordx4 v[132:135], v4, s[16:19], s52 offen offset:1024 sc1
MAV 60,28,156
TR 56,6,59200
MAV 44,28,152
TR 58,6,59712
TR 60,6,59232
MAV 44,12,144
TR 62,6,59744
v_add_u32 v7, s57, v7
v_add_u32 v6, s57, v6
s_sub_u32 s57, 0, s57
s_waitcnt lgkmcnt(8)
MAV 64,32,144
ds_read_b64_tr_b16 a[0:1], v7
s_add_u32 m0, s55, 109824
MAV 64,48,152
buffer_load_dwordx4 v18, s[28:31], s54 offen lds
MAV 80,48,156
TR 2,7,512
TR 4,7,32
MAV 80,32,148
TR 6,7,544
s_add_u32 s52, s78, 327680
MAV 84,36,148
.Lpad29:
s_cbranch_execz .Lnopoll62r
buffer_load_dwordx4 v[136:139], v4, s[16:19], s52 offen sc1
MAV 84,52,156
TR 16,7,8448
MAV 68,52,152
TR 18,7,8960
TR 20,7,8480
MAV 68,36,144
TR 22,7,8992
s_waitcnt lgkmcnt(8)
MAV 72,40,144
buffer_load_dwordx4 v19, s[28:31], s54 offen offset:1056 lds
MAV 72,56,152
s_add_u32 s54, s101, 3342336
MAV 88,56,156
TR 8,7,64
TR 10,7,576
MAV 88,40,148
TR 12,7,96
TR 14,7,608
MAV 92,44,148
buffer_load_dwordx4 v[140:143], v4, s[16:19], s52 offen offset:1024 sc1
MAV 92,60,156
TR 24,7,8512
MAV 76,60,152
TR 26,7,9024
TR 28,7,8544
MAV 76,44,144
TR 30,7,9056
s_waitcnt vmcnt(16) lgkmcnt(8)
s_barrier
MAV 32,0,96
ds_read_b64_tr_b16 a[32:33], v6
s_add_u32 m0, s55, 118272
MAV 32,16,104
buffer_load_dwordx4 v18, s[28:31], s54 offen lds
MAV 48,16,108
TR 34,6,512
TR 36,6,32
MAV 48,0,100
TR 38,6,544
s_add_u32 s52, s79, 376832
MAV 52,4,100
buffer_load_dwordx4 v[144:147], v4, s[16:19], s52 offen sc1
MAV 52,20,108
TR 48,6,8448
MAV 36,20,104
TR 50,6,8960
TR 52,6,8480
MAV 36,4,96
TR 54,6,8992
s_waitcnt lgkmcnt(8)
MAV 40,8,96
buffer_load_dwordx4 v19, s[28:31], s54 offen offset:1056 lds
MAV 40,24,104
s_add_u32 s54, s101, 3604480
MAV 56,24,108
TR 40,6,64
TR 42,6,576
MAV 56,8,100
TR 44,6,96
TR 46,6,608
MAV 60,12,100
buffer_load_dwordx4 v[148:151], v4, s[16:19], s52 offen offset:1024 sc1
MAV 60,28,108
TR 56,6,8512
MAV 44,28,104
TR 58,6,9024
TR 60,6,8544
MAV 44,12,96
TR 62,6,9056
s_waitcnt lgkmcnt(8)
MAV 64,32,96
TR 0,7,16896
s_add_u32 m0, s55, 126720
MAV 64,48,104
buffer_load_dwordx4 v18, s[28:31], s54 offen lds
MAV 80,48,108
TR 2,7,17408
TR 4,7,16928
MAV 80,32,100
TR 6,7,17440
s_add_u32 s52, s79, 442368
MAV 84,36,100
buffer_load_dwordx4 v[152:155], v4, s[16:19], s52 offen sc1
MAV 84,52,108
TR 16,7,25344
MAV 68,52,104
TR 18,7,25856
TR 20,7,25376
MAV 68,36,96
TR 22,7,25888
s_waitcnt lgkmcnt(8)
MAV 72,40,96
buffer_load_dwordx4 v19, s[28:31], s54 offen offset:1056 lds
MAV 72,56,104
s_add_u32 s54, s98, 196608
MAV 88,56,108
TR 8,7,16960
TR 10,7,17472
MAV 88,40,100
TR 12,7,16992
TR 14,7,17504
MAV 92,44,100
buffer_load_dwordx4 v[156:159], v4, s[16:19], s52 offen offset:1024 sc1
MAV 92,60,108
TR 24,7,25408
MAV 76,60,104
TR 26,7,25920
TR 28,7,25440
MAV 76,44,96
TR 30,7,25952
s_waitcnt vmcnt(16) lgkmcnt(8)
s_barrier
MAV 32,0,112
TR 32,6,16896
s_add_u32 m0, s55, 0
MAV 32,16,120
buffer_load_dwordx4 v18, s[28:31], s54 offen lds
MAV 48,16,124
TR 34,6,17408
TR 36,6,16928
MAV 48,0,116
TR 38,6,17440
s_add_u32 s52, s76, 491520
MAV 52,4,116
buffer_load_dwordx4 v[96:99], v4, s[16:19], s52 offen sc1
MAV 52,20,124
TR 48,6,25344
MAV 36,20,120
TR 50,6,25856
TR 52,6,25376
MAV 36,4,112
TR 54,6,25888
s_waitcnt lgkmcnt(8)
MAV 40,8,112
buffer_load_dwordx4 v19, s[28:31], s54 offen offset:1056 lds
MAV 40,24,120
s_add_u32 s54, s99, 655360
MAV 56,24,124
TR 40,6,16960
TR 42,6,17472
MAV 56,8,116
TR 44,6,16992
TR 46,6,17504
MAV 60,12,116
buffer_load_dwordx4 v[100:103], v4, s[16:19], s52 offen offset:1024 sc1
MAV 60,28,124
TR 56,6,25408
MAV 44,28,120
TR 58,6,25920
TR 60,6,25440
MAV 44,12,112
TR 62,6,25952
s_waitcnt lgkmcnt(8)
MAV 64,32,112
TR 0,7,33792
s_add_u32 m0, s55, 8448
MAV 64,48,120
buffer_load_dwordx4 v18, s[28:31], s54 offen lds
MAV 80,48,124
TR 2,7,34304
TR 4,7,33824
MAV 80,32,116
TR 6,7,34336
s_add_u32 s52, s76, 557056
MAV 84,36,116
buffer_load_dwordx4 v[104:107], v4, s[16:19], s52 offen sc1
MAV 84,52,124
TR 16,7,42240
MAV 68,52,120
TR 18,7,42752
TR 20,7,42272
MAV 68,36,112
TR 22,7,42784
s_waitcnt lgkmcnt(8)
MAV 72,40,112
buffer_load_dwordx4 v19, s[28:31], s54 offen offset:1056 lds
MAV 72,56,120
s_add_u32 s54, s100, 1114112
MAV 88,56,124
TR 8,7,33856
TR 10,7,34368
MAV 88,40,116
TR 12,7,33888
TR 14,7,34400
MAV 92,44,116
buffer_load_dwordx4 v[108:111], v4, s[16:19], s52 offen offset:1024 sc1
MAV 92,60,124
TR 24,7,42304
MAV 76,60,120
TR 26,7,42816
TR 28,7,42336
MAV 76,44,112
TR 30,7,42848
s_waitcnt vmcnt(16) lgkmcnt(8)
s_barrier
MAV 32,0,128
TR 32,6,33792
s_add_u32 m0, s55, 16896
MAV 32,16,136
buffer_load_dwordx4 v18, s[28:31], s54 offen lds
MAV 48,16,140
TR 34,6,34304
TR 36,6,33824
MAV 48,0,132
TR 38,6,34336
s_add_u32 s52, s77, 606208
MAV 52,4,132
buffer_load_dwordx4 v[112:115], v4, s[16:19], s52 offen sc1
MAV 52,20,140
TR 48,6,42240
MAV 36,20,136
TR 50,6,42752
TR 52,6,42272
MAV 36,4,128
TR 54,6,42784
s_waitcnt lgkmcnt(8)
MAV 40,8,128
buffer_load_dwordx4 v19, s[28:31], s54 offen offset:1056 lds
MAV 40,24,136
s_add_u32 s54, s101, 1572864
MAV 56,24,140
TR 40,6,33856
TR 42,6,34368
MAV 56,8,132
TR 44,6,33888
TR 46,6,34400
MAV 60,12,132
buffer_load_dwordx4 v[116:119], v4, s[16:19], s52 offen offset:1024 sc1
MAV 60,28,140
TR 56,6,42304
MAV 44,28,136
TR 58,6,42816
TR 60,6,42336
MAV 44,12,128
TR 62,6,42848
s_waitcnt lgkmcnt(8)
MAV 64,32,128
TR 0,7,50688
s_add_u32 m0, s55, 25344
MAV 64,48,136
buffer_load_dwordx4 v18, s[28:31], s54 offen lds
MAV 80,48,140
TR 2,7,51200
TR 4,7,50720
MAV 80,32,132
TR 6,7,51232
s_add_u32 s52, s77, 671744
MAV 84,36,132
buffer_load_dwordx4 v[120:123], v4, s[16:19], s52 offen sc1
MAV 84,52,140
TR 16,7,59136
MAV 68,52,136
TR 18,7,59648
TR 20,7,59168
MAV 68,36,128
TR 22,7,59680
s_waitcnt lgkmcnt(8)
MAV 72,40,128
buffer_load_dwordx4 v19, s[28:31], s54 offen offset:1056 lds
MAV 72,56,136
s_add_u32 s54, s98, 2031616
MAV 88,56,140
TR 8,7,50752
TR 10,7,51264
MAV 88,40,132
TR 12,7,50784
TR 14,7,51296
MAV 92,44,132
buffer_load_dwordx4 v[124:127], v4, s[16:19], s52 offen offset:1024 sc1
MAV 92,60,140
TR 24,7,59200
MAV 76,60,136
TR 26,7,59712
TR 28,7,59232
MAV 76,44,128
TR 30,7,59744
s_waitcnt vmcnt(16) lgkmcnt(8)
s_barrier
MAV 32,0,144
TR 32,6,50688
s_add_u32 m0, s55, 33792
MAV 32,16,152
buffer_load_dwordx4 v18, s[28:31], s54 offen lds
MAV 48,16,156
TR 34,6,51200
TR 36,6,50720
MAV 48,0,148
TR 38,6,51232
s_add_u32 s52, s78, 720896
MAV 52,4,148
buffer_load_dwordx4 v[128:131], v4, s[16:19], s52 offen sc1
MAV 52,20,156
TR 48,6,59136
MAV 36,20,152
TR 50,6,59648
TR 52,6,59168
MAV 36,4,144
TR 54,6,59680
s_waitcnt lgkmcnt(8)
MAV 40,8,144
buffer_load_dwordx4 v19, s[28:31], s54 offen offset:1056 lds
MAV 40,24,152
s_add_u32 s54, s99, 2490368
MAV 56,24,156
TR 40,6,50752
TR 42,6,51264
MAV 56,8,148
TR 44,6,50784
TR 46,6,51296
MAV 60,12,148
buffer_load_dwordx4 v[132:135], v4, s[16:19], s52 offen offset:1024 sc1
MAV 60,28,156
TR 56,6,59200
MAV 44,28,152
TR 58,6,59712
TR 60,6,59232
MAV 44,12,144
TR 62,6,59744
v_add_u32 v7, s57, v7
v_add_u32 v6, s57, v6
s_sub_u32 s57, 0, s57
s_waitcnt lgkmcnt(8)
MAV 64,32,144
ds_read_b64_tr_b16 a[0:1], v6
s_add_u32 m0, s55, 42240
MAV 64,48,152
buffer_load_dwordx4 v18, s[28:31], s54 offen lds
MAV 80,48,156
TR 2,6,512
TR 4,6,32
MAV 80,32,148
TR 6,6,544
s_add_u32 s52, s78, 786432
MAV 84,36,148
buffer_load_dwordx4 v[136:139], v4, s[16:19], s52 offen sc1
MAV 84,52,156
TR 16,6,8448
MAV 68,52,152
TR 18,6,8960
TR 20,6,8480
MAV 68,36,144
TR 22,6,8992
s_waitcnt lgkmcnt(8)
MAV 72,40,144
buffer_load_dwordx4 v19, s[28:31], s54 offen offset:1056 lds
MAV 72,56,152
s_add_u32 s54, s100, 2949120
MAV 88,56,156
TR 8,6,64
TR 10,6,576
MAV 88,40,148
TR 12,6,96
TR 14,6,608
MAV 92,44,148
buffer_load_dwordx4 v[140:143], v4, s[16:19], s52 offen offset:1024 sc1
MAV 92,60,156
TR 24,6,8512
MAV 76,60,152
TR 26,6,9024
TR 28,6,8544
MAV 76,44,144
TR 30,6,9056
s_waitcnt vmcnt(16) lgkmcnt(8)
s_barrier
MAV 64,0,96
TR 32,6,16896
TR 34,6,17408
s_add_u32 m0, s55, 50688
MAV 64,16,104
TR 36,6,16928
buffer_load_dwordx4 v18, s[28:31], s54 offen lds
MAV 80,16,108
buffer_load_dwordx4 v19, s[28:31], s54 offen offset:1056 lds
MAV 80,0,100
TR 38,6,17440
s_add_u32 s54, s101, 3407872
s_add_u32 s52, s79, 835584
MAV 84,4,100
TR 48,6,25344
buffer_load_dwordx4 v[144:147], v4, s[16:19], s52 offen sc1
MAV 84,20,108
TR 50,6,25856
MAV 68,20,104
TR 52,6,25376
buffer_load_dwordx4 v[148:151], v4, s[16:19], s52 offen offset:1024 sc1
MAV 68,4,96
TR 54,6,25888
s_add_u32 m0, s55, 59136
s_waitcnt lgkmcnt(8)
MAV 72,8,96
buffer_load_dwordx4 v18, s[28:31], s54 offen lds
MAV 72,24,104
TR 40,6,16960
TR 42,6,17472
MAV 88,24,108
TR 44,6,16992
buffer_load_dwordx4 v19, s[28:31], s54 offen offset:1056 lds
MAV 88,8,100
TR 46,6,17504
s_add_u32 s52, s79, 901120
MAV 92,12,100
TR 56,6,25408
buffer_load_dwordx4 v[152:155], v4, s[16:19], s52 offen sc1
MAV 92,28,108
TR 58,6,25920
MAV 76,28,104
TR 60,6,25440
buffer_load_dwordx4 v[156:159], v4, s[16:19], s52 offen offset:1024 sc1
MAV 76,12,96
TR 62,6,25952
s_waitcnt vmcnt(16) lgkmcnt(8)
MAV 64,32,112
TR 0,6,33792
s_add_u32 s52, s76, 49152
s_lshl_b32 s70, s2, 10
MAV 64,48,120
buffer_load_dwordx4 v[160:163], v4, s[16:19], s52 offen sc1
s_lshl_b32 s62, s3, 7
MAV 80,48,124
TR 2,6,34304
TR 4,6,33824
MAV 80,32,116
TR 6,6,34336
s_add_u32 s70, s70, s62
s_add_u32 s70, s70, 31457792
MAV 84,36,116
buffer_load_dwordx4 v[164:167], v4, s[16:19], s52 offen offset:1024 sc1
s_xor_b32 s71, s70, 1024
MAV 84,52,124
TR 16,6,42240
TR 18,6,42752
MAV 68,52,120
TR 20,6,42272
v_min_u32 v12, 1, v1
v_lshlrev_b32 v12, 28, v12
MAV 68,36,112
TR 22,6,42784
s_add_u32 s52, s77, 163840
s_waitcnt lgkmcnt(8)
MAV 72,40,112
buffer_load_dwordx4 v[168:171], v4, s[16:19], s52 offen sc1
v_mov_b32 v13, 1
MAV 72,56,120
TR 8,6,33856
v_mov_b32 v15, 0
s_lshl_b32 s68, s7, 15
MAV 88,56,124
TR 10,6,34368
TR 12,6,33888
MAV 88,40,116
TR 14,6,34400
s_add_u32 s68, s68, 146800640
s_xor_b32 s69, s68, 32768
MAV 92,44,116
buffer_load_dwordx4 v[172:175], v4, s[16:19], s52 offen offset:1024 sc1
v_mov_b32 v11, v4
MAV 92,60,124
TR 24,6,42304
TR 26,6,42816
MAV 76,60,120
TR 28,6,42336
v_and_b32 v2, 1, v1
v_lshlrev_b32 v2, 4, v2
MAV 76,44,112
TR 30,6,42848
v_mov_b32 v224, 0x3f80
s_waitcnt vmcnt(12) lgkmcnt(8)
MAV 64,0,128
TR 32,6,50688
s_add_u32 s52, s78, 278528
v_lshlrev_b32 v2, v2, v224
MAV 64,16,136
buffer_load_dwordx4 v[176:179], v4, s[16:19], s52 offen sc1
v_bfe_u32 v224, v1, 2, 2
MAV 80,16,140
TR 34,6,51200
TR 36,6,50720
MAV 80,0,132
TR 38,6,51232
v_lshrrev_b32 v225, 4, v1
v_cmp_eq_u32 vcc, v224, v225
MAV 84,4,132
buffer_load_dwordx4 v[180:183], v4, s[16:19], s52 offen offset:1024 sc1
v_cndmask_b32 v2, 0, v2, vcc
MAV 84,20,140
TR 48,6,59136
TR 50,6,59648
MAV 68,20,136
TR 52,6,59168
v_and_b32 v224, 2, v1
v_cmp_eq_u32 vcc, 0, v224
MAV 68,4,128
TR 54,6,59680
s_add_u32 s52, s79, 393216
s_waitcnt lgkmcnt(8)
MAV 72,8,128
buffer_load_dwordx4 v[184:187], v4, s[16:19], s52 offen sc1
v_cndmask_b32 v226, 0, v2, vcc
MAV 72,24,136
TR 40,6,50752
v_cndmask_b32 v227, v2, 0, vcc
v_mov_b32 v224, 0
MAV 88,24,140
TR 42,6,51264
TR 44,6,50784
MAV 88,8,132
TR 46,6,51296
v_mov_b32 v225, 0
v_mov_b32 v228, 0
MAV 92,12,132
buffer_load_dwordx4 v[188:191], v4, s[16:19], s52 offen offset:1024 sc1
v_mov_b32 v229, 0
MAV 92,28,140
TR 56,6,59200
TR 58,6,59712
MAV 76,28,136
TR 60,6,59232
s_lshr_b32 s62, s6, 1
s_lshl_b32 s62, s62, 8
MAV 76,12,128
TR 62,6,59744
s_and_b32 s63, s6, 1
s_waitcnt vmcnt(8) lgkmcnt(8)
s_barrier
v_add_u32 v6, s57, v6
MAV 64,32,144
ds_read_b64_tr_b16 a[0:1], v6
s_add_u32 s52, s76, 507904
s_add_u32 s62, s62, s63
MAV 64,48,152
buffer_load_dwordx4 v[192:195], v4, s[16:19], s52 offen sc1
s_lshl_b32 s63, s3, 6
MAV 80,48,156
TR 2,6,512
TR 4,6,32
MAV 80,32,148
TR 6,6,544
s_add_u32 s62, s62, s63
s_lshl_b32 s62, s62, 11
MAV 84,36,148
buffer_load_dwordx4 v[196:199], v4, s[16:19], s52 offen offset:1024 sc1
s_lshl_b32 s63, s7, 7
MAV 84,52,156
.Lpad30:
s_cbranch_execz .Lnopoll62r
TR 16,6,8448
TR 18,6,8960
MAV 68,52,152
TR 20,6,8480
s_add_u32 s62, s62, s63
v_and_b32 v16, 15, v1
MAV 68,36,144
TR 22,6,8992
s_add_u32 s52, s77, 622592
s_waitcnt lgkmcnt(8)
MAV 72,40,144
buffer_load_dwordx4 v[200:203], v4, s[16:19], s52 offen sc1
v_lshlrev_b32 v16, 12, v16
MAV 72,56,152
TR 8,6,64
v_bfe_u32 v2, v1, 4, 1
v_lshl_add_u32 v16, v2, 5, v16
MAV 88,56,156
TR 10,6,576
TR 12,6,96
MAV 88,40,148
TR 14,6,608
v_bfe_u32 v2, v1, 5, 1
v_lshl_add_u32 v16, v2, 4, v16
MAV 92,44,148
buffer_load_dwordx4 v[204:207], v4, s[16:19], s52 offen offset:1024 sc1
v_add_u32 v16, s62, v16
MAV 92,60,156
TR 24,6,8512
TR 26,6,9024
MAV 76,60,152
TR 28,6,8544
v_add_u32 v17, 0x10000, v16
v_accvgpr_read_b32 v28, a224
MAV 76,44,144
TR 30,6,9056
v_add_f32 v32, v32, v28
s_waitcnt vmcnt(8) lgkmcnt(8)
MAV 64,0,160
TR 32,6,16896
s_add_u32 s52, s78, 737280
v_accvgpr_read_b32 v29, a225
MAV 64,16,168
buffer_load_dwordx4 v[208:211], v4, s[16:19], s52 offen sc1
v_add_f32 v33, v33, v29
MAV 80,16,172
TR 34,6,17408
TR 36,6,16928
MAV 80,0,164
TR 38,6,17440
v_accvgpr_read_b32 v28, a226
v_add_f32 v34, v34, v28
MAV 84,4,164
buffer_load_dwordx4 v[212:215], v4, s[16:19], s52 offen offset:1024 sc1
v_accvgpr_read_b32 v29, a227
MAV 84,20,172
TR 48,6,25344
TR 50,6,25856
MAV 68,20,168
TR 52,6,25376
v_add_f32 v35, v35, v29
v_accvgpr_read_b32 v28, a228
MAV 68,4,160
TR 54,6,25888
s_add_u32 s52, s79, 851968
s_waitcnt lgkmcnt(8)
MAV 72,8,160
buffer_load_dwordx4 v[216:219], v4, s[16:19], s52 offen sc1
v_add_f32 v36, v36, v28
MAV 72,24,168
TR 40,6,16960
v_accvgpr_read_b32 v29, a229
v_add_f32 v37, v37, v29
MAV 88,24,172
TR 42,6,17472
TR 44,6,16992
MAV 88,8,164
TR 46,6,17504
v_accvgpr_read_b32 v28, a230
v_add_f32 v38, v38, v28
MAV 92,12,164
buffer_load_dwordx4 v[220:223], v4, s[16:19], s52 offen offset:1024 sc1
v_accvgpr_read_b32 v29, a231
MAV 92,28,172
TR 56,6,25408
TR 58,6,25920
MAV 76,28,168
TR 60,6,25440
v_add_f32 v39, v39, v29
v_accvgpr_read_b32 v28, a232
MAV 76,12,160
TR 62,6,25952
v_add_f32 v40, v40, v28
s_waitcnt vmcnt(8) lgkmcnt(8)
MAV 64,32,176
TR 0,6,33792
v_accvgpr_read_b32 v29, a233
v_add_f32 v41, v41, v29
MAV 64,48,184
TR 2,6,34304
v_accvgpr_read_b32 v28, a234
MAV 80,48,188
TR 4,6,33824
v_add_f32 v42, v42, v28
MAV 80,32,180
TR 6,6,34336
v_accvgpr_read_b32 v29, a235
MAV 84,36,180
TR 16,6,42240
v_add_f32 v43, v43, v29
MAV 84,52,188
TR 18,6,42752
v_accvgpr_read_b32 v28, a236
MAV 68,52,184
TR 20,6,42272
v_add_f32 v44, v44, v28
MAV 68,36,176
TR 22,6,42784
s_waitcnt lgkmcnt(8)
MAV 72,40,176
TR 8,6,33856
v_accvgpr_read_b32 v29, a237
MAV 72,56,184
TR 10,6,34368
v_add_f32 v45, v45, v29
MAV 88,56,188
TR 12,6,33888
v_accvgpr_read_b32 v28, a238
MAV 88,40,180
TR 14,6,34400
v_add_f32 v46, v46, v28
MAV 92,44,180
TR 24,6,42304
v_accvgpr_read_b32 v29, a239
MAV 92,60,188
TR 26,6,42816
v_add_f32 v47, v47, v29
MAV 76,60,184
TR 28,6,42336
v_accvgpr_read_b32 v28, a240
MAV 76,44,176
TR 30,6,42848
v_add_f32 v48, v48, v28
s_waitcnt vmcnt(4) lgkmcnt(8)
MAV 64,0,192
TR 32,6,50688
v_accvgpr_read_b32 v29, a241
v_add_f32 v49, v49, v29
MAV 64,16,200
TR 34,6,51200
v_accvgpr_read_b32 v28, a242
MAV 80,16,204
TR 36,6,50720
v_add_f32 v50, v50, v28
MAV 80,0,196
TR 38,6,51232
v_accvgpr_read_b32 v29, a243
MAV 84,4,196
TR 48,6,59136
v_add_f32 v51, v51, v29
MAV 84,20,204
TR 50,6,59648
v_accvgpr_read_b32 v28, a244
MAV 68,20,200
TR 52,6,59168
v_add_f32 v52, v52, v28
MAV 68,4,192
TR 54,6,59680
s_waitcnt lgkmcnt(8)
MAV 72,8,192
TR 40,6,50752
v_accvgpr_read_b32 v29, a245
MAV 72,24,200
TR 42,6,51264
v_add_f32 v53, v53, v29
MAV 88,24,204
TR 44,6,50784
v_accvgpr_read_b32 v28, a246
MAV 88,8,196
TR 46,6,51296
v_add_f32 v54, v54, v28
MAV 92,12,196
TR 56,6,59200
v_accvgpr_read_b32 v29, a247
MAV 92,28,204
TR 58,6,59712
v_add_f32 v55, v55, v29
MAV 76,28,200
TR 60,6,59232
v_accvgpr_read_b32 v28, a248
MAV 76,12,192
TR 62,6,59744
v_add_f32 v56, v56, v28
s_waitcnt vmcnt(0) lgkmcnt(8)
MAV 64,32,208
ds_read_b64_tr_b16 a[0:1], v7
v_accvgpr_read_b32 v29, a249
MAV 64,48,216
TR 2,7,512
v_add_f32 v57, v57, v29
MAV 80,48,220
TR 4,7,32
v_accvgpr_read_b32 v28, a250
MAV 80,32,212
TR 6,7,544
v_add_f32 v58, v58, v28
MAV 84,36,212
TR 16,7,8448
v_accvgpr_read_b32 v29, a251
MAV 84,52,220
TR 18,7,8960
v_add_f32 v59, v59, v29
MAV 68,52,216
TR 20,7,8480
v_accvgpr_read_b32 v28, a252
MAV 68,36,208
TR 22,7,8992
s_waitcnt lgkmcnt(8)
MAV 72,40,208
TR 8,7,64
v_add_f32 v60, v60, v28
MAV 72,56,216
TR 10,7,576
v_accvgpr_read_b32 v29, a253
MAV 88,56,220
TR 12,7,96
v_add_f32 v61, v61, v29
MAV 88,40,212
TR 14,7,608
v_accvgpr_read_b32 v28, a254
MAV 92,44,212
TR 24,7,8512
v_add_f32 v62, v62, v28
MAV 92,60,220
TR 26,7,9024
v_accvgpr_read_b32 v29, a255
MAV 76,60,216
TR 28,7,8544
v_add_f32 v63, v63, v29
MAV 76,44,208
TR 30,7,9056
s_waitcnt lgkmcnt(8)
MAV 32,0,96
TR 32,7,16896
v_cvt_pk_bf16_f32 v232, v64, v65
v_cvt_pk_bf16_f32 v233, v66, v67
MAV 32,16,104
TR 34,7,17408
v_cvt_pk_bf16_f32 v234, v68, v69
MAV 48,16,108
TR 36,7,16928
v_cvt_pk_bf16_f32 v235, v70, v71
buffer_store_dwordx4 v[232:235], v11, s[16:19], s69 offen sc1
MAV 48,0,100
TR 38,7,17440
s_add_u32 s69, s69, 16384
MAV 52,4,100
TR 48,7,25344
v_cvt_pk_bf16_f32 v236, v72, v73
v_cvt_pk_bf16_f32 v237, v74, v75
MAV 52,20,108
TR 50,7,25856
v_cvt_pk_bf16_f32 v238, v76, v77
MAV 36,20,104
TR 52,7,25376
v_cvt_pk_bf16_f32 v239, v78, v79
buffer_store_dwordx4 v[236:239], v11, s[16:19], s69 offen sc1
MAV 36,4,96
TR 54,7,25888
s_add_u32 s69, s69, -15360
s_waitcnt lgkmcnt(8)
MAV 40,8,96
TR 40,7,16960
v_cvt_pk_bf16_f32 v240, v80, v81
MAV 40,24,104
TR 42,7,17472
v_cvt_pk_bf16_f32 v241, v82, v83
v_cvt_pk_bf16_f32 v242, v84, v85
MAV 56,24,108
TR 44,7,16992
v_cvt_pk_bf16_f32 v243, v86, v87
MAV 56,8,100
TR 46,7,17504
buffer_store_dwordx4 v[240:243], v11, s[16:19], s69 offen sc1
s_add_u32 s69, s69, 16384
MAV 60,12,100
TR 56,7,25408
v_cvt_pk_bf16_f32 v244, v88, v89
MAV 60,28,108
TR 58,7,25920
v_cvt_pk_bf16_f32 v245, v90, v91
v_cvt_pk_bf16_f32 v246, v92, v93
MAV 44,28,104
TR 60,7,25440
v_cvt_pk_bf16_f32 v247, v94, v95
MAV 44,12,96
TR 62,7,25952
buffer_store_dwordx4 v[244:247], v11, s[16:19], s69 offen sc1
s_waitcnt lgkmcnt(8)
MAV 32,32,112
TR 0,7,33792
MAV 32,48,120
TR 2,7,34304
MAV 48,48,124
TR 4,7,33824
MAV 48,32,116
TR 6,7,34336
MAV 52,36,116
TR 16,7,42240
MAV 52,52,124
TR 18,7,42752
MAV 36,52,120
TR 20,7,42272
MAV 36,36,112
TR 22,7,42784
s_waitcnt lgkmcnt(8)
MAV 40,40,112
TR 8,7,33856
MAV 40,56,120
TR 10,7,34368
MAV 56,56,124
TR 12,7,33888
MAV 56,40,116
TR 14,7,34400
MAV 60,44,116
TR 24,7,42304
MAV 60,60,124
TR 26,7,42816
MAV 44,60,120
TR 28,7,42336
MAV 44,44,112
TR 30,7,42848
s_waitcnt lgkmcnt(8)
MAV 32,0,128
TR 32,7,50688
MAV 32,16,136
TR 34,7,51200
MAV 48,16,140
TR 36,7,50720
MAV 48,0,132
TR 38,7,51232
MAV 52,4,132
TR 48,7,59136
MAV 52,20,140
TR 50,7,59648
MAV 36,20,136
TR 52,7,59168
MAV 36,4,128
TR 54,7,59680
s_waitcnt lgkmcnt(8)
MAV 40,8,128
TR 40,7,50752
MAV 40,24,136
TR 42,7,51264
MAV 56,24,140
TR 44,7,50784
MAV 56,8,132
TR 46,7,51296
MAV 60,12,132
TR 56,7,59200
MAV 60,28,140
TR 58,7,59712
MAV 44,28,136
TR 60,7,59232
MAV 44,12,128
TR 62,7,59744
v_add_u32 v7, s57, v7
s_waitcnt lgkmcnt(8)
MAV 32,32,144
ds_read_b64_tr_b16 a[0:1], v7
TR 2,7,512
MAV 32,48,152
s_waitcnt vmcnt(0)
buffer_atomic_add v13, v12, s[16:19], s71 offen
MAV 48,48,156
TR 4,7,32
MAV 48,32,148
TR 6,7,544
MAV 52,36,148
TR 16,7,8448
MAV 52,52,156
TR 18,7,8960
MAV 36,52,152
TR 20,7,8480
MAV 36,36,144
TR 22,7,8992
s_waitcnt lgkmcnt(8)
MAV 40,40,144
TR 8,7,64
MAV 40,56,152
TR 10,7,576
MAV 56,56,156
TR 12,7,96
MAV 56,40,148
TR 14,7,608
MAV 60,44,148
TR 24,7,8512
MAV 60,60,156
TR 26,7,9024
MAV 44,60,152
TR 28,7,8544
MAV 44,44,144
TR 30,7,9056
s_waitcnt lgkmcnt(8)
MAV 32,0,160
TR 32,7,16896
TR 34,7,17408
MAV 32,16,168
buffer_atomic_add v15, v12, s[16:19], s70 offen sc0
MAV 48,16,172
TR 36,7,16928
MAV 48,0,164
TR 38,7,17440
MAV 52,4,164
TR 48,7,25344
MAV 52,20,172
TR 50,7,25856
MAV 36,20,168
TR 52,7,25376
MAV 36,4,160
TR 54,7,25888
s_waitcnt lgkmcnt(8)
MAV 40,8,160
TR 40,7,16960
MAV 40,24,168
TR 42,7,17472
MAV 56,24,172
TR 44,7,16992
MAV 56,8,164
TR 46,7,17504
MAV 60,12,164
TR 56,7,25408
MAV 60,28,172
TR 58,7,25920
MAV 44,28,168
TR 60,7,25440
MAV 44,12,160
TR 62,7,25952
s_waitcnt lgkmcnt(8)
MAV 32,32,176
TR 0,7,33792
MAV 32,48,184
TR 2,7,34304
MAV 48,48,188
TR 4,7,33824
MAV 48,32,180
TR 6,7,34336
MAV 52,36,180
TR 16,7,42240
MAV 52,52,188
TR 18,7,42752
MAV 36,52,184
TR 20,7,42272
MAV 36,36,176
TR 22,7,42784
s_waitcnt lgkmcnt(8)
MAV 40,40,176
TR 8,7,33856
MAV 40,56,184
TR 10,7,34368
MAV 56,56,188
TR 12,7,33888
MAV 56,40,180
TR 14,7,34400
MAV 60,44,180
TR 24,7,42304
MAV 60,60,188
TR 26,7,42816
MAV 44,60,184
TR 28,7,42336
MAV 44,44,176
TR 30,7,42848
s_waitcnt vmcnt(0)
v_cmp_ne_u32 vcc, 0, v15
s_nop 0
s_cbranch_vccz .Lxs67
.Lxs67b:
s_waitcnt lgkmcnt(8)
MAV 32,0,192
TR 32,7,50688
TR 34,7,51200
MAV 32,16,200
buffer_load_dwordx4 v[232:235], v11, s[16:19], s68 offen sc1
MAV 48,16,204
TR 36,7,50720
s_add_u32 s68, s68, 16384
MAV 48,0,196
TR 38,7,51232
MAV 52,4,196
buffer_load_dwordx4 v[236:239], v11, s[16:19], s68 offen sc1
MAV 52,20,204
TR 48,7,59136
s_add_u32 s68, s68, -15360
MAV 36,20,200
TR 50,7,59648
TR 52,7,59168
MAV 36,4,192
TR 54,7,59680
s_waitcnt lgkmcnt(8)
MAV 40,8,192
buffer_load_dwordx4 v[240:243], v11, s[16:19], s68 offen sc1
MAV 40,24,200
s_add_u32 s68, s68, 16384
MAV 56,24,204
TR 40,7,50752
TR 42,7,51264
MAV 56,8,196
TR 44,7,50784
TR 46,7,51296
MAV 60,12,196
buffer_load_dwordx4 v[244:247], v11, s[16:19], s68 offen sc1
MAV 60,28,204
TR 56,7,59200
MAV 44,28,200
TR 58,7,59712
TR 60,7,59232
MAV 44,12,192
TR 62,7,59744
s_waitcnt lgkmcnt(8)
MAV 32,32,208
MAV 32,48,216
MAV 48,48,220
MAV 48,32,212
MAV 52,36,212
MAV 52,52,220
MAV 36,52,216
MAV 36,36,208
s_waitcnt lgkmcnt(0)
MAV 40,40,208
MAV 40,56,216
MAV 56,56,220
MAV 56,40,212
MAV 60,44,212
MAV 60,60,220
MAV 44,60,216
MAV 44,44,208
s_waitcnt vmcnt(3)
v_mfma_f32_16x16x32_bf16 v[32:35], v[226:229], v[232:235], v[32:35]
v_mfma_f32_16x16x32_bf16 v[36:39], v[224:227], v[232:235], v[36:39]
s_waitcnt vmcnt(2)
v_mfma_f32_16x16x32_bf16 v[40:43], v[226:229], v[236:239], v[40:43]
s_nop 4
v_cvt_pk_bf16_f32 v128, v32, v33
v_cvt_pk_bf16_f32 v129, v34, v35
v_mfma_f32_16x16x32_bf16 v[44:47], v[224:227], v[236:239], v[44:47]
v_cvt_pk_bf16_f32 v130, v36, v37
v_cvt_pk_bf16_f32 v131, v38, v39
.Lpad31:
s_cbranch_execz .Lnopoll62r
s_waitcnt vmcnt(1)
v_mfma_f32_16x16x32_bf16 v[48:51], v[226:229], v[240:243], v[48:51]
v_permlane16_swap_b32 v128, v130
v_mfma_f32_16x16x32_bf16 v[52:55], v[224:227], v[240:243], v[52:55]
v_permlane16_swap_b32 v129, v131
s_waitcnt vmcnt(0)
v_mfma_f32_16x16x32_bf16 v[56:59], v[226:229], v[244:247], v[56:59]
buffer_store_dwordx4 v[128:131], v16, s[36:39], 0 offen sc1
v_mfma_f32_16x16x32_bf16 v[60:63], v[224:227], v[244:247], v[60:63]
v_cvt_pk_bf16_f32 v132, v40, v41
v_cvt_pk_bf16_f32 v133, v42, v43
v_cvt_pk_bf16_f32 v134, v44, v45
v_cvt_pk_bf16_f32 v135, v46, v47
v_cvt_pk_bf16_f32 v136, v48, v49
v_permlane16_swap_b32 v132, v134
v_permlane16_swap_b32 v133, v135
v_cvt_pk_bf16_f32 v137, v50, v51
v_cvt_pk_bf16_f32 v138, v52, v53
buffer_store_dwordx4 v[132:135], v16, s[36:39], 0 offen offset:64 sc1
v_cvt_pk_bf16_f32 v139, v54, v55
v_permlane16_swap_b32 v136, v138
s_nop 0
v_permlane16_swap_b32 v137, v139
v_cvt_pk_bf16_f32 v140, v56, v57
v_cvt_pk_bf16_f32 v141, v58, v59
v_cvt_pk_bf16_f32 v142, v60, v61
v_cvt_pk_bf16_f32 v143, v62, v63
s_nop 0
v_permlane16_swap_b32 v140, v142
v_permlane16_swap_b32 v141, v143
buffer_store_dwordx4 v[136:139], v17, s[36:39], 0 offen sc1
buffer_store_dwordx4 v[140:143], v17, s[36:39], 0 offen offset:64 sc1
s_nop 1
.Lend:
s_endpgm
.Lsp66:
s_mov_b32 s15, 0
.Lsp66l:
v_mov_b32 v25, 0
buffer_atomic_add v25, v22, s[16:19], s73 offen sc0
s_add_u32 s15, s15, 1
s_cmp_gt_u32 s15, 100000
s_waitcnt vmcnt(0)
s_cbranch_scc1 .Lsp66b
v_cmp_gt_u32 vcc, v23, v25
s_nop 0
s_cbranch_vccnz .Lsp66l
s_branch .Lsp66b
.Lxs67:
s_mov_b32 s15, 0
.Lxs67l:
v_mov_b32 v15, 0
buffer_atomic_add v15, v12, s[16:19], s70 offen sc0
s_add_u32 s15, s15, 1
s_cmp_gt_u32 s15, 100000
s_waitcnt vmcnt(0)
s_cbranch_scc1 .Lxs67b
v_cmp_ne_u32 vcc, 0, v15
s_nop 0
s_cbranch_vccz .Lxs67l
s_branch .Lxs67b
.section .rodata,"a"
.p2align 6
.amdhsa_kernel interleave_layers__sliding_local_dilated__swiglu_ffn__prompt_kernel
  .amdhsa_next_free_vgpr 512
  .amdhsa_next_free_sgpr 102
  .amdhsa_accum_offset 256
  .amdhsa_group_segment_fixed_size 0
  .amdhsa_kernarg_size 80
  .amdhsa_user_sgpr_count 2
  .amdhsa_user_sgpr_kernarg_segment_ptr 1
  .amdhsa_system_sgpr_workgroup_id_x 1
  .amdhsa_float_denorm_mode_32 3
.end_amdhsa_kernel
```

```asm
; @launch grid=(256,1,1) block=(256,1,1) lds=162560
.amdgcn_target "amdgcn-amd-amdhsa--gfx950"
.macro MAA d,a,b
v_mfma_f32_16x16x32_bf16 v[\d:\d+3], a[\a:\a+3], a[\b:\b+3], v[\d:\d+3]
.endm
.macro MAV d,a,b
v_mfma_f32_16x16x32_bf16 v[\d:\d+3], a[\a:\a+3], v[\b:\b+3], v[\d:\d+3]
.endm
.macro TR d,v,o
ds_read_b64_tr_b16 a[\d:\d+1], v\v offset:\o
.endm
.macro RD d,v,o
ds_read_b128 a[\d:\d+3], v\v offset:\o
.endm
.text
.globl interleave_layers__sliding_local_dilated__swiglu_ffn__prompt_kernel
.p2align 8
.type interleave_layers__sliding_local_dilated__swiglu_ffn__prompt_kernel,@function
interleave_layers__sliding_local_dilated__swiglu_ffn__prompt_kernel:
s_load_dwordx4 s[68:71], s[0:1], 0
s_load_dwordx2 s[72:73], s[0:1], 16
s_load_dwordx8 s[76:83], s[0:1], 32
s_load_dwordx4 s[84:87], s[0:1], 64
s_cmp_lt_u32 s2, 256
s_cbranch_scc1 .Lgo
s_endpgm
.p2align 12
.Lgo:
v_lshrrev_b32 v2, 6, v0
v_and_b32 v1, 63, v0
v_readfirstlane_b32 s3, v2
s_and_b32 s4, s2, 7
s_lshr_b32 s5, s2, 3
s_lshr_b32 s6, s4, 1
s_lshl_b32 s6, s6, 2
s_and_b32 s62, s5, 3
s_add_u32 s6, s6, s62
s_and_b32 s7, s4, 1
s_lshr_b32 s62, s5, 2
s_lshl_b32 s62, s62, 1
s_add_u32 s7, s7, s62
s_lshr_b32 s8, s4, 2
s_lshl_b32 s8, s8, 3
s_and_b32 s62, s5, 7
s_add_u32 s8, s8, s62
s_and_b32 s9, s4, 3
s_lshl_b32 s9, s9, 2
s_lshr_b32 s62, s5, 3
s_add_u32 s9, s9, s62
s_lshr_b32 s62, s6, 1
s_lshl_b32 s62, s62, 8
s_and_b32 s63, s6, 1
s_add_u32 s62, s62, s63
s_lshl_b32 s63, s3, 6
s_add_u32 s62, s62, s63
s_lshl_b32 s62, s62, 11
s_lshl_b32 s63, s7, 7
s_add_u32 s62, s62, s63
v_and_b32 v160, 15, v1
v_lshlrev_b32 v160, 12, v160
v_bfe_u32 v2, v1, 4, 1
v_lshl_add_u32 v160, v2, 5, v160
v_bfe_u32 v2, v1, 5, 1
v_lshl_add_u32 v160, v2, 4, v160
v_add_u32 v160, s62, v160
v_add_u32 v161, 0x10000, v160
s_sub_u32 s64, s3, 1
s_max_i32 s64, s64, 0
s_lshl_b32 s64, s64, 11
s_lshl_b32 s66, s9, 7
s_add_u32 s66, s66, s64
s_cmp_eq_u32 s3, 1
s_cselect_b32 s66, 8388608, s66
s_mul_i32 s65, s8, 122880
s_add_u32 s65, s65, s66
v_lshrrev_b32 v9, 1, v1
v_min_u32 v9, 19, v9
v_mul_u32_u24 v9, 6144, v9
s_waitcnt lgkmcnt(0)
s_mov_b32 s36, s68
s_mov_b32 s37, s69
s_mov_b32 s38, 4194304
s_mov_b32 s39, 0x20000
s_mov_b32 s16, s86
s_mov_b32 s17, s87
s_mov_b32 s18, 268435456
s_mov_b32 s19, 0x20000
s_xor_b32 s14, s3, 3
s_lshl_b32 s14, s14, 8
s_add_u32 s14, s14, s2
v_lshlrev_b32 v27, 4, v1
v_mov_b64 v[156:157], 0
v_mov_b64 v[158:159], 0
s_cmp_ge_u32 s14, 16
s_cbranch_scc1 .Lz1
s_lshl_b32 s62, s2, 13
s_add_u32 s62, s62, 30408704
s_add_u32 s63, s62, 4096
buffer_store_dwordx4 v[156:159], v27, s[16:19], s62 offen sc1
buffer_store_dwordx4 v[156:159], v27, s[16:19], s62 offen offset:1024 sc1
buffer_store_dwordx4 v[156:159], v27, s[16:19], s62 offen offset:2048 sc1
buffer_store_dwordx4 v[156:159], v27, s[16:19], s62 offen offset:3072 sc1
buffer_store_dwordx4 v[156:159], v27, s[16:19], s63 offen sc1
buffer_store_dwordx4 v[156:159], v27, s[16:19], s63 offen offset:1024 sc1
buffer_store_dwordx4 v[156:159], v27, s[16:19], s63 offen offset:2048 sc1
buffer_store_dwordx4 v[156:159], v27, s[16:19], s63 offen offset:3072 sc1
.Lz1:
buffer_load_dwordx4 v[128:131], v160, s[36:39], 0 offen
buffer_load_dwordx4 v[132:135], v160, s[36:39], 0 offen offset:64
buffer_load_dwordx4 v[136:139], v161, s[36:39], 0 offen
buffer_load_dwordx4 v[140:143], v161, s[36:39], 0 offen offset:64
s_mov_b32 s20, s70
s_mov_b32 s21, s71
s_mov_b32 s22, 6291456
s_mov_b32 s23, 0x20000
buffer_load_dword v58, v9, s[20:23], s65 offen
s_mov_b32 s40, s84
s_mov_b32 s41, s85
s_mov_b32 s42, 256
s_mov_b32 s43, 0x20000
s_getpc_b64 s[62:63]
.Lpc:
s_lshl_b32 s64, s5, 12
v_lshrrev_b32 v59, 3, v0
v_lshl_add_u32 v59, v59, 7, s64
v_add_u32 v2, 0x20000, v59
v_min_u32 v2, .Lend-.Lpc, v2
v_min_u32 v59, .Lend-.Lpc, v59
global_load_dword v59, v59, s[62:63]
global_load_dword v58, v2, s[62:63]
s_mov_b32 s24, s72
s_mov_b32 s25, s73
s_mov_b32 s26, 2097152
s_mov_b32 s27, 0x20000
s_mov_b32 s28, s80
s_mov_b32 s29, s81
s_mov_b32 s30, 7340032
s_mov_b32 s31, 0x20000
s_mov_b32 s0, s82
s_mov_b32 s1, s83
s_mov_b32 s32, s76
s_mov_b32 s33, s77
s_mov_b32 s34, 7340032
s_mov_b32 s35, 0x20000
s_mov_b32 s80, s78
s_mov_b32 s81, s79
s_mov_b32 s82, 7340032
s_mov_b32 s83, 0x20000
s_lshr_b32 s10, s4, 2
s_lshl_b32 s10, s10, 2
s_and_b32 s62, s5, 3
s_add_u32 s10, s10, s62
s_and_b32 s11, s4, 3
s_lshl_b32 s11, s11, 3
s_lshr_b32 s62, s5, 2
s_add_u32 s11, s11, s62
s_and_b32 s12, s11, 1
s_lshr_b32 s13, s11, 1
s_mul_i32 s51, s13, 448
s_mul_i32 s62, s12, 192
s_add_u32 s51, s51, s62
s_and_b32 s48, s3, 1
s_lshr_b32 s49, s3, 1
s_lshl_b32 s50, s8, 3
s_sub_u32 s50, s50, 9
s_cmp_lt_u32 s8, 2
s_cselect_b32 s50, 7, s50
s_lshl_b32 s62, s6, 3
s_lshr_b32 s84, s62, 4
s_lshl_b32 s84, s84, 14
s_and_b32 s62, s62, 15
s_lshl_b32 s62, s62, 10
s_add_u32 s84, s84, s62
s_lshl_b32 s62, s8, 3
s_lshr_b32 s85, s62, 4
s_lshl_b32 s85, s85, 14
s_and_b32 s62, s62, 15
s_lshl_b32 s62, s62, 10
s_add_u32 s85, s85, s62
s_lshl_b32 s62, s50, 0
s_lshr_b32 s86, s62, 4
s_lshl_b32 s86, s86, 14
s_and_b32 s62, s62, 15
s_lshl_b32 s62, s62, 10
s_add_u32 s86, s86, s62
s_mul_i32 s62, s8, 393216
s_add_u32 s62, s62, s66
v_mul_u32_u24 v14, 6144, v1
v_add_u32 v14, s62, v14
s_lshl_b32 s62, s8, 4
s_add_u32 s62, s62, s9
s_lshl_b32 s62, s62, 2
s_add_u32 s62, s62, s3
s_mul_i32 s62, s62, 6656
v_min_u32 v15, 51, v1
v_lshl_add_u32 v15, v15, 7, s62
s_sub_u32 s63, s8, 4
s_lshl_b32 s64, s8, 1
s_add_u32 s64, s64, 1
s_cmp_lt_u32 s8, 5
s_cselect_b64 vcc, -1, 0
s_cselect_b32 s46, s64, s63
v_cndmask_b32 v14, v14, v15, vcc
s_lshl_b32 s62, s2, 1
s_add_u32 s62, s62, s48
s_mul_i32 s62, s62, 5376
v_min_u32 v16, 41, v1
v_lshl_add_u32 v16, v16, 7, s62
s_cmp_lt_u32 s46, 6
s_cselect_b64 vcc, -1, 0
v_cndmask_b32 v15, v14, v16, vcc
v_cndmask_b32 v14, v16, v14, vcc
s_cmp_lt_u32 s3, 2
s_cselect_b32 s65, s32, s80
s_cselect_b32 s66, s33, s81
s_cselect_b32 s67, s34, s82
s_cmp_lt_u32 s8, 5
s_cselect_b32 s62, s24, s20
s_cselect_b32 s63, s25, s21
s_cselect_b32 s64, s26, s22
s_sub_u32 s47, s46, 6
s_cmp_lt_u32 s46, 6
s_cselect_b32 s47, s46, s47
s_cselect_b32 s76, s62, s65
s_cselect_b32 s98, s65, s62
s_cselect_b32 s77, s63, s66
s_cselect_b32 s99, s66, s63
s_cselect_b32 s78, s64, s67
s_cselect_b32 s100, s67, s64
s_mov_b32 s79, 0x20000
v_bfe_u32 v18, v1, 3, 1
v_bfe_u32 v2, v1, 5, 1
v_lshl_add_u32 v18, v2, 2, v18
v_and_b32 v2, 16, v1
v_add_u32 v18, v18, v2
s_lshl_b32 s62, s49, 2
s_add_u32 s62, s62, s48
s_lshl_b32 s62, s62, 1
v_add_u32 v18, s62, v18
v_mul_u32_u24 v18, 6144, v18
v_and_b32 v2, 7, v1
v_lshl_add_u32 v18, v2, 4, v18
s_lshl_b32 s62, s9, 7
v_add_u32 v18, s62, v18
v_add_u32 v19, 1024, v18
v_add_u32 v20, 2048, v18
s_mul_i32 s59, s3, 3104
s_mov_b32 s58, 0
s_lshr_b32 s62, s8, 1
s_lshl_b32 s62, s62, 8
s_and_b32 s67, s8, 1
s_add_u32 s62, s62, s67
s_lshl_b32 s62, s62, 11
s_lshl_b32 s63, s3, 17
s_add_u32 s62, s62, s63
v_lshrrev_b32 v2, 4, v1
v_xor_b32 v2, v2, v1
v_and_b32 v2, 7, v2
v_lshlrev_b32 v2, 4, v2
v_lshrrev_b32 v21, 3, v1
v_lshl_add_u32 v21, v21, 12, v2
v_add_u32 v21, s62, v21
v_xor_b32 v28, 64, v21
v_add_u32 v28, 31744, v28
s_lshr_b32 s63, s50, 3
s_lshr_b32 s62, s63, 1
s_lshl_b32 s62, s62, 8
s_and_b32 s67, s63, 1
s_add_u32 s62, s62, s67
s_lshl_b32 s62, s62, 11
s_lshl_b32 s63, s3, 14
s_add_u32 s62, s62, s63
s_add_u32 s62, s62, 456704
s_lshl_b32 s63, s3, 5
v_and_b32 v2, 31, v1
v_lshlrev_b32 v2, 2, v2
v_xor_b32 v2, s63, v2
v_lshrrev_b32 v22, 5, v1
v_lshl_add_u32 v22, v22, 12, v2
v_add_u32 v22, s62, v22
v_xor_b32 v29, 16, v22
v_add_u32 v29, -57344, v29
s_mov_b32 s52, 0
s_mov_b32 s53, 65536
s_mul_i32 s55, s3, 4608
s_mov_b32 s54, 0
s_mul_i32 s56, s3, 3104
v_bfe_u32 v24, v1, 1, 3
v_lshrrev_b32 v2, 4, v1
v_xor_b32 v2, v2, v24
v_lshlrev_b32 v2, 4, v2
v_and_b32 v23, 15, v1
v_lshl_add_u32 v23, v23, 7, v2
s_mul_i32 s62, s48, 9216
v_add_u32 v23, s62, v23
v_xor_b32 v30, 64, v23
v_mul_u32_u24 v24, 2304, v24
v_add_u32 v24, v24, v2
v_and_b32 v2, 1, v1
v_lshl_add_u32 v24, v2, 7, v24
v_add_u32 v24, 2048, v24
v_xor_b32 v31, 64, v24
v_and_b32 v2, 15, v1
v_cmp_eq_u32 vcc, 0, v2
v_mov_b32 v2, 18432
s_nop 0
v_cndmask_b32 v24, v24, v2, vcc
v_cndmask_b32 v31, v31, v2, vcc
v_bfe_u32 v25, v1, 3, 2
v_mul_u32_u24 v25, 3104, v25
v_bfe_u32 v2, v1, 2, 1
v_lshl_add_u32 v25, v2, 7, v25
v_bfe_u32 v2, v1, 5, 1
v_lshl_add_u32 v25, v2, 8, v25
v_and_b32 v2, 3, v1
v_lshl_add_u32 v25, v2, 3, v25
s_lshl_b32 s62, s49, 6
s_add_u32 s62, s62, 73984
v_add_u32 v25, s62, v25
s_lshl_b32 s62, s8, 1
s_add_u32 s62, s62, s3
s_lshr_b32 s63, s50, 2
s_cmp_lt_u32 s3, 2
s_cselect_b32 s62, s62, s63
s_lshl_b32 s62, s62, 13
s_cmp_eq_u32 s3, 3
s_cselect_b32 s62, 268435456, s62
v_lshl_add_u32 v26, v1, 4, s62
s_mul_i32 s59, s3, 2080
v_bfe_u32 v5, v1, 3, 1
v_lshrrev_b32 v2, 4, v1
v_lshl_add_u32 v5, v2, 3, v5
s_lshl_b32 s62, s3, 1
v_add_u32 v5, s62, v5
v_mul_u32_u24 v5, 2048, v5
v_and_b32 v2, 7, v1
v_lshl_add_u32 v5, v2, 4, v5
s_lshl_b32 s62, s7, 7
v_add_u32 v5, s62, v5
v_add_u32 v6, 64512, v5
s_lshl_b32 s62, s6, 10
s_add_u32 s62, s62, 30408704
s_lshl_b32 s64, s8, 10
s_add_u32 s64, s64, 30408704
s_lshr_b32 s67, s9, 1
s_and_b32 s67, s67, 3
s_lshl_b32 s67, s67, 7
s_add_u32 s64, s64, s67
s_lshr_b32 s65, s50, 3
s_lshl_b32 s65, s65, 10
s_add_u32 s65, s65, 30408704
s_lshr_b32 s67, s9, 1
s_and_b32 s67, s67, 3
s_lshl_b32 s67, s67, 7
s_add_u32 s65, s65, s67
v_mov_b32 v2, 268435456
v_cmp_eq_u32 vcc, 65, v0
v_mov_b32 v33, s65
s_nop 0
v_cndmask_b32 v33, v2, v33, vcc
v_cndmask_b32 v36, 0, 16, vcc
v_cmp_eq_u32 vcc, 64, v0
v_mov_b32 v32, s64
s_nop 0
v_cndmask_b32 v33, v33, v32, vcc
v_lshl_add_u32 v32, v1, 7, s62
v_cndmask_b32 v34, v2, 0, vcc
v_cndmask_b32 v35, 0, 16, vcc
v_cndmask_b32 v36, v36, 16, vcc
v_lshrrev_b32 v37, 3, v0
v_cmp_eq_u32 vcc, 8, v37
s_nop 1
v_cndmask_b32 v32, v2, v32, vcc
v_mov_b32 v38, 1
v_lshrrev_b32 v2, 4, v1
v_lshlrev_b32 v2, 2, v2
v_and_b32 v13, 15, v1
v_sub_u32 v2, v13, v2
v_mov_b32 v13, 0xff61b1e6
v_subrev_u32 v54, 0, v2
v_cmp_gt_u32 vcc, 8, v54
s_nop 1
v_cndmask_b32 v50, v13, 0, vcc
v_cmp_gt_i32 vcc, -8, v54
s_nop 1
v_cndmask_b32 v46, v13, 0, vcc
v_subrev_u32 v54, 1, v2
v_cmp_gt_u32 vcc, 8, v54
s_nop 1
v_cndmask_b32 v51, v13, 0, vcc
v_cmp_gt_i32 vcc, -8, v54
s_nop 1
v_cndmask_b32 v47, v13, 0, vcc
v_subrev_u32 v54, 2, v2
v_cmp_gt_u32 vcc, 8, v54
s_nop 1
v_cndmask_b32 v52, v13, 0, vcc
v_cmp_gt_i32 vcc, -8, v54
s_nop 1
v_cndmask_b32 v48, v13, 0, vcc
v_subrev_u32 v54, 3, v2
v_cmp_gt_u32 vcc, 8, v54
s_nop 1
v_cndmask_b32 v53, v13, 0, vcc
v_cmp_gt_i32 vcc, -8, v54
s_nop 1
v_cndmask_b32 v49, v13, 0, vcc
s_cmp_lt_u32 s8, 2
s_cselect_b64 vcc, -1, 0
v_cndmask_b32 v54, v46, v13, vcc
v_cndmask_b32 v55, v47, v13, vcc
v_cndmask_b32 v56, v48, v13, vcc
v_cndmask_b32 v57, v49, v13, vcc
s_mov_b32 s75, 29360128
v_and_b32 v10, 15, v1
v_lshlrev_b32 v12, 2, v10
v_lshlrev_b32 v10, 4, v10
v_add_u32 v10, 152576, v10
v_lshrrev_b32 v11, 4, v1
v_lshlrev_b32 v11, 4, v11
s_lshl_b32 s62, s49, 7
s_add_u32 s62, s62, 158720
v_add_u32 v12, s62, v12
v_add_u32 v13, s62, v11
v_add_u32 v11, 156672, v11
s_lshl_b32 s62, s3, 11
s_add_u32 s62, s62, 143360
v_lshl_add_u32 v8, v1, 4, s62
v_xor_b32 v9, 2048, v8
v_mov_b32 v248, 0x3f803f80
v_mov_b32 v249, 0x3f803f80
v_mov_b32 v250, 0x3f803f80
v_mov_b32 v251, 0x3f803f80
s_mul_i32 s62, s3, 18496
s_add_u32 s62, s62, 18432
v_mov_b32 v2, s62
ds_write_b128 v2, v[248:251]
v_and_b32 v7, 31, v1
v_lshrrev_b32 v2, 5, v1
v_lshl_add_u32 v7, v7, 1, v2
v_and_b32 v2, 0xc0, v0
v_add_u32 v7, v7, v2
v_lshlrev_b32 v17, 2, v7
v_add_u32 v17, 156672, v17
v_lshlrev_b32 v7, 4, v7
v_add_u32 v7, 152576, v7
s_lshl_b32 s74, s9, 1
s_add_u32 s74, s74, s49
s_lshl_b32 s74, s74, 17
s_add_u32 s74, s74, s85
s_lshl_b32 s63, s48, 12
s_add_u32 s74, s74, s63
s_add_u32 s74, s74, 4194304
s_mov_b32 s62, 0
v_lshl_add_u32 v4, v1, 4, s62
v_lshrrev_b32 v2, 3, v1
v_cmp_eq_u32 vcc, 3, v2
v_add_u32 v2, 67108480, v4
s_nop 0
v_cndmask_b32 v4, v4, v2, vcc
s_nop 1
s_cmp_eq_u32 s48, 1
s_cbranch_scc1 .Lqkv2
s_add_u32 m0, s55, 0
s_nop 0
buffer_load_dwordx4 v21, s[36:39], s52 offen lds
buffer_load_dwordx4 v28, s[36:39], s52 offen offset:1024 lds
buffer_load_dword v22, s[36:39], s52 offen offset:2048 lds
s_add_u32 s52, s52, 128
s_add_u32 m0, s55, 2304
s_nop 0
buffer_load_dwordx4 v21, s[36:39], s53 offen lds
buffer_load_dwordx4 v28, s[36:39], s53 offen offset:1024 lds
buffer_load_dword v29, s[36:39], s53 offen offset:2048 lds
s_add_u32 s53, s53, 128
s_add_u32 m0, s56, 123648
s_nop 0
buffer_load_dwordx4 v18, s[20:23], s54 offen lds
buffer_load_dwordx4 v19, s[20:23], s54 offen offset:1024 lds
buffer_load_dwordx4 v20, s[20:23], s54 offen offset:2048 lds
s_add_u32 s54, s54, 196608
s_add_u32 m0, s56, 136064
s_nop 0
buffer_load_dwordx4 v18, s[20:23], s54 offen lds
buffer_load_dwordx4 v19, s[20:23], s54 offen offset:1024 lds
buffer_load_dwordx4 v20, s[20:23], s54 offen offset:2048 lds
s_add_u32 s54, s54, 196608
s_waitcnt vmcnt(12)
s_cmp_lt_u32 s14, 16
s_cselect_b32 s62, 0, 4096
v_mov_b32 v154, 1
v_lshlrev_b32 v155, 8, v1
v_permlane16_swap_b32 v128, v130
v_permlane16_swap_b32 v129, v131
v_permlane16_swap_b32 v132, v134
v_permlane16_swap_b32 v133, v135
v_permlane16_swap_b32 v136, v138
v_permlane16_swap_b32 v137, v139
v_permlane16_swap_b32 v140, v142
v_permlane16_swap_b32 v141, v143
buffer_atomic_add v154, v155, s[40:43], s62 offen
v_lshlrev_b32 v64, 16, v128
v_and_b32 v65, 0xffff0000, v128
v_lshlrev_b32 v66, 16, v129
v_and_b32 v67, 0xffff0000, v129
v_lshlrev_b32 v68, 16, v130
v_and_b32 v69, 0xffff0000, v130
v_lshlrev_b32 v70, 16, v131
v_and_b32 v71, 0xffff0000, v131
v_lshlrev_b32 v72, 16, v132
v_and_b32 v73, 0xffff0000, v132
v_lshlrev_b32 v74, 16, v133
v_and_b32 v75, 0xffff0000, v133
v_lshlrev_b32 v76, 16, v134
v_and_b32 v77, 0xffff0000, v134
v_lshlrev_b32 v78, 16, v135
v_and_b32 v79, 0xffff0000, v135
v_lshlrev_b32 v80, 16, v136
v_and_b32 v81, 0xffff0000, v136
v_lshlrev_b32 v82, 16, v137
v_and_b32 v83, 0xffff0000, v137
v_lshlrev_b32 v84, 16, v138
v_and_b32 v85, 0xffff0000, v138
v_lshlrev_b32 v86, 16, v139
v_and_b32 v87, 0xffff0000, v139
v_lshlrev_b32 v88, 16, v140
v_and_b32 v89, 0xffff0000, v140
v_lshlrev_b32 v90, 16, v141
v_and_b32 v91, 0xffff0000, v141
v_lshlrev_b32 v92, 16, v142
v_and_b32 v93, 0xffff0000, v142
v_lshlrev_b32 v94, 16, v143
v_and_b32 v95, 0xffff0000, v143
s_lshl_b32 s64, s6, 14
s_lshl_b32 s65, s49, 13
s_add_u32 s64, s64, s65
s_lshl_b32 s65, s7, 9
s_add_u32 s64, s64, s65
s_lshl_b32 s65, s48, 8
s_add_u32 s64, s64, s65
s_add_u32 s64, s64, 29360128
v_and_b32 v152, 31, v1
v_lshlrev_b32 v152, 3, v152
v_lshrrev_b32 v153, 5, v1
v_lshl_add_u32 v152, v153, 28, v152
s_lshl_b32 s62, s7, 18
s_add_u32 s62, s62, 0
s_add_u32 s63, s62, 131072
v_pk_mul_f32 v[146:147], v[64:65], v[64:65]
v_pk_mul_f32 v[150:151], v[80:81], v[80:81]
v_pk_fma_f32 v[146:147], v[66:67], v[66:67], v[146:147]
v_pk_add_f32 v[144:145], v[64:65], v[66:67]
v_pk_fma_f32 v[150:151], v[82:83], v[82:83], v[150:151]
v_pk_add_f32 v[148:149], v[80:81], v[82:83]
v_pk_fma_f32 v[146:147], v[68:69], v[68:69], v[146:147]
v_pk_add_f32 v[144:145], v[144:145], v[68:69]
v_pk_fma_f32 v[150:151], v[84:85], v[84:85], v[150:151]
v_pk_add_f32 v[148:149], v[148:149], v[84:85]
v_pk_fma_f32 v[146:147], v[70:71], v[70:71], v[146:147]
v_pk_add_f32 v[144:145], v[144:145], v[70:71]
v_pk_fma_f32 v[150:151], v[86:87], v[86:87], v[150:151]
v_pk_add_f32 v[148:149], v[148:149], v[86:87]
v_pk_fma_f32 v[146:147], v[72:73], v[72:73], v[146:147]
v_pk_add_f32 v[144:145], v[144:145], v[72:73]
v_pk_fma_f32 v[150:151], v[88:89], v[88:89], v[150:151]
v_pk_add_f32 v[148:149], v[148:149], v[88:89]
v_pk_fma_f32 v[146:147], v[74:75], v[74:75], v[146:147]
v_pk_add_f32 v[144:145], v[144:145], v[74:75]
v_pk_fma_f32 v[150:151], v[90:91], v[90:91], v[150:151]
v_pk_add_f32 v[148:149], v[148:149], v[90:91]
v_pk_fma_f32 v[146:147], v[76:77], v[76:77], v[146:147]
v_pk_add_f32 v[144:145], v[144:145], v[76:77]
v_pk_fma_f32 v[150:151], v[92:93], v[92:93], v[150:151]
v_pk_add_f32 v[148:149], v[148:149], v[92:93]
v_pk_fma_f32 v[146:147], v[78:79], v[78:79], v[146:147]
v_pk_add_f32 v[144:145], v[144:145], v[78:79]
v_pk_fma_f32 v[150:151], v[94:95], v[94:95], v[150:151]
v_pk_add_f32 v[148:149], v[148:149], v[94:95]
v_add_f32 v144, v144, v145
v_add_f32 v146, v146, v147
v_add_f32 v148, v148, v149
v_add_f32 v150, v150, v151
s_nop 0
v_permlane16_swap_b32 v144, v148
v_permlane16_swap_b32 v146, v150
v_add_f32 v144, v144, v148
v_add_f32 v146, v146, v150
s_nop 1
v_permlane32_swap_b32 v144, v146
v_add_f32 v144, v144, v146
s_nop 1
v_permlane32_swap_b32 v144, v145
buffer_store_dwordx2 v[144:145], v152, s[16:19], s64 offen sc1
s_lshl_b32 s62, s2, 10
s_add_u32 s62, s62, 31457280
s_cmp_eq_u32 s3, 0
s_cselect_b32 s62, s62, 268435456
buffer_store_dwordx4 v[156:159], v27, s[16:19], s62 offen sc1
v_accvgpr_write_b32 a224, v64
v_accvgpr_write_b32 a225, v65
v_accvgpr_write_b32 a226, v66
v_accvgpr_write_b32 a227, v67
v_accvgpr_write_b32 a228, v68
v_accvgpr_write_b32 a229, v69
v_accvgpr_write_b32 a230, v70
v_accvgpr_write_b32 a231, v71
v_accvgpr_write_b32 a232, v72
v_accvgpr_write_b32 a233, v73
v_accvgpr_write_b32 a234, v74
v_accvgpr_write_b32 a235, v75
v_accvgpr_write_b32 a236, v76
v_accvgpr_write_b32 a237, v77
v_accvgpr_write_b32 a238, v78
v_accvgpr_write_b32 a239, v79
v_accvgpr_write_b32 a240, v80
v_accvgpr_write_b32 a241, v81
v_accvgpr_write_b32 a242, v82
v_accvgpr_write_b32 a243, v83
v_accvgpr_write_b32 a244, v84
v_accvgpr_write_b32 a245, v85
v_accvgpr_write_b32 a246, v86
v_accvgpr_write_b32 a247, v87
v_accvgpr_write_b32 a248, v88
v_accvgpr_write_b32 a249, v89
v_accvgpr_write_b32 a250, v90
v_accvgpr_write_b32 a251, v91
v_accvgpr_write_b32 a252, v92
v_accvgpr_write_b32 a253, v93
v_accvgpr_write_b32 a254, v94
v_accvgpr_write_b32 a255, v95
s_add_u32 m0, s55, 18496
s_nop 0
buffer_load_dwordx4 v21, s[36:39], s52 offen lds
buffer_load_dwordx4 v28, s[36:39], s52 offen offset:1024 lds
buffer_load_dword v22, s[36:39], s52 offen offset:2048 lds
s_add_u32 s52, s52, 128
s_add_u32 m0, s55, 20800
s_nop 0
buffer_load_dwordx4 v21, s[36:39], s53 offen lds
buffer_load_dwordx4 v28, s[36:39], s53 offen offset:1024 lds
buffer_load_dword v29, s[36:39], s53 offen offset:2048 lds
s_add_u32 s53, s53, 128
s_add_u32 m0, s56, 73984
s_nop 0
buffer_load_dwordx4 v18, s[20:23], s54 offen lds
buffer_load_dwordx4 v19, s[20:23], s54 offen offset:1024 lds
buffer_load_dwordx4 v20, s[20:23], s54 offen offset:2048 lds
s_add_u32 s54, s54, 196608
s_waitcnt vmcnt(15) lgkmcnt(0)
s_barrier
ds_read_b128 a[0:3], v23
RD 4,23,2304
RD 8,23,4608
RD 12,23,6912
TR 20,25,49664
TR 22,25,50176
TR 24,25,49696
TR 26,25,50208
ds_read_b128 a[16:19], v24
TR 28,25,50688
TR 30,25,51200
TR 32,25,50720
TR 34,25,51232
TR 36,25,51712
TR 38,25,52224
TR 40,25,51744
TR 42,25,52256
s_waitcnt vmcnt(12) lgkmcnt(8)
s_barrier
v_mfma_f32_16x16x32_bf16 v[60:63], a[20:23], a[0:3], 0
ds_read_b128 a[44:47], v30
s_add_u32 m0, s56, 86400
v_mfma_f32_16x16x32_bf16 v[76:79], a[24:27], a[0:3], 0
buffer_load_dwordx4 v18, s[20:23], s54 offen lds
v_mfma_f32_16x16x32_bf16 v[80:83], a[24:27], a[4:7], 0
s_sub_u32 s47, s47, 1
s_cbranch_scc1 .Lx4
.Lx4b:
v_mfma_f32_16x16x32_bf16 v[64:67], a[20:23], a[4:7], 0
buffer_load_dwordx4 v19, s[20:23], s54 offen offset:1024 lds
v_mfma_f32_16x16x32_bf16 v[68:71], a[20:23], a[8:11], 0
RD 48,30,2304
v_mfma_f32_16x16x32_bf16 v[84:87], a[24:27], a[8:11], 0
RD 52,30,4608
RD 56,30,6912
v_mfma_f32_16x16x32_bf16 v[88:91], a[24:27], a[12:15], 0
buffer_load_dwordx4 v20, s[20:23], s54 offen offset:2048 lds
v_mfma_f32_16x16x32_bf16 v[72:75], a[20:23], a[12:15], 0
s_add_u32 s54, s54, 196608
s_waitcnt lgkmcnt(4)
v_mfma_f32_16x16x32_bf16 v[244:247], a[20:23], a[16:19], 0
TR 64,25,62080
s_add_u32 m0, s55, 36992
v_mfma_f32_16x16x32_bf16 v[104:107], a[28:31], a[12:15], 0
buffer_load_dwordx4 v21, s[36:39], s52 offen lds
v_mfma_f32_16x16x32_bf16 v[120:123], a[32:35], a[12:15], 0
TR 66,25,62592
v_mfma_f32_16x16x32_bf16 v[116:119], a[32:35], a[8:11], 0
TR 68,25,62112
TR 70,25,62624
v_mfma_f32_16x16x32_bf16 v[100:103], a[28:31], a[8:11], 0
buffer_load_dwordx4 v28, s[36:39], s52 offen offset:1024 lds
v_mfma_f32_16x16x32_bf16 v[96:99], a[28:31], a[4:7], 0
ds_read_b128 a[60:63], v31
v_mfma_f32_16x16x32_bf16 v[112:115], a[32:35], a[4:7], 0
buffer_load_dword v22, s[36:39], s52 offen offset:2048 lds
v_mfma_f32_16x16x32_bf16 v[108:111], a[32:35], a[0:3], 0
TR 72,25,63104
s_add_u32 s52, s52, 128
v_mfma_f32_16x16x32_bf16 v[92:95], a[28:31], a[0:3], 0
s_add_u32 m0, s55, 39296
v_mfma_f32_16x16x32_bf16 v[156:159], a[28:31], a[16:19], 0
buffer_load_dwordx4 v21, s[36:39], s53 offen lds
v_mfma_f32_16x16x32_bf16 v[160:163], a[32:35], a[16:19], 0
TR 74,25,63616
TR 76,25,63136
v_mfma_f32_16x16x32_bf16 v[124:127], a[0:3], a[36:39], 0
TR 78,25,63648
v_mfma_f32_16x16x32_bf16 v[140:143], a[0:3], a[40:43], 0
buffer_load_dwordx4 v28, s[36:39], s53 offen offset:1024 lds
v_mfma_f32_16x16x32_bf16 v[144:147], a[4:7], a[40:43], 0
TR 80,25,64128
v_mfma_f32_16x16x32_bf16 v[128:131], a[4:7], a[36:39], 0
TR 82,25,64640
TR 84,25,64160
v_mfma_f32_16x16x32_bf16 v[132:135], a[8:11], a[36:39], 0
buffer_load_dword v29, s[36:39], s53 offen offset:2048 lds
v_mfma_f32_16x16x32_bf16 v[148:151], a[8:11], a[40:43], 0
s_add_u32 s53, s53, 128
v_mfma_f32_16x16x32_bf16 v[152:155], a[12:15], a[40:43], 0
TR 86,25,64672
v_mfma_f32_16x16x32_bf16 v[136:139], a[12:15], a[36:39], 0
s_waitcnt vmcnt(9) lgkmcnt(8)
s_barrier
MAA 60,64,44
RD 0,23,18496
s_add_u32 m0, s56, 98816
MAA 76,68,44
buffer_load_dwordx4 v18, s[20:23], s54 offen lds
MAA 80,68,48
RD 4,23,20800
MAA 64,64,48
buffer_load_dwordx4 v19, s[20:23], s54 offen offset:1024 lds
MAA 68,64,52
RD 8,23,23104
RD 12,23,25408
MAA 84,68,52
ds_read_b64_tr_b16 a[20:21], v25
MAA 88,68,56
buffer_load_dwordx4 v20, s[20:23], s54 offen offset:2048 lds
MAA 72,64,56
s_add_u32 s54, s54, 196608
s_waitcnt lgkmcnt(5)
MAA 244,64,60
TR 22,25,512
s_add_u32 m0, s56, 111232
MAA 104,72,56
buffer_load_dwordx4 v18, s[20:23], s54 offen lds
MAA 120,76,56
TR 24,25,32
MAA 116,76,52
TR 26,25,544
MAA 100,72,52
buffer_load_dwordx4 v19, s[20:23], s54 offen offset:1024 lds
MAA 96,72,48
RD 16,24,18496
TR 28,25,1024
MAA 112,76,48
buffer_load_dwordx4 v20, s[20:23], s54 offen offset:2048 lds
MAA 108,76,44
s_add_u32 s54, s54, 196608
MAA 92,72,44
TR 30,25,1536
s_add_u32 m0, s55, 55488
MAA 156,72,60
buffer_load_dwordx4 v21, s[36:39], s52 offen lds
MAA 160,76,60
TR 32,25,1056
MAA 124,44,80
TR 34,25,1568
MAA 140,44,84
buffer_load_dwordx4 v28, s[36:39], s52 offen offset:1024 lds
MAA 144,48,84
TR 36,25,2048
MAA 128,48,80
TR 38,25,2560
TR 40,25,2080
MAA 132,52,80
buffer_load_dword v22, s[36:39], s52 offen offset:2048 lds
MAA 148,52,84
s_add_u32 s52, s52, 128
MAA 152,56,84
TR 42,25,2592
MAA 136,56,80
s_waitcnt vmcnt(15) lgkmcnt(8)
s_barrier
MAA 60,20,0
RD 44,30,18496
s_add_u32 m0, s55, 57792
MAA 76,24,0
buffer_load_dwordx4 v21, s[36:39], s53 offen lds
MAA 80,24,4
s_sub_u32 s47, s47, 1
s_cbranch_scc1 .Lx5
.Lx5b:
MAA 64,20,4
buffer_load_dwordx4 v28, s[36:39], s53 offen offset:1024 lds
MAA 68,20,8
RD 48,30,20800
MAA 84,24,8
RD 52,30,23104
RD 56,30,25408
MAA 88,24,12
buffer_load_dword v29, s[36:39], s53 offen offset:2048 lds
MAA 72,20,12
s_add_u32 s53, s53, 128
s_waitcnt lgkmcnt(4)
MAA 244,20,16
TR 64,25,12416
s_add_u32 m0, s56, 123648
MAA 104,28,12
buffer_load_dwordx4 v18, s[20:23], s54 offen lds
MAA 120,32,12
TR 66,25,12928
MAA 116,32,8
TR 68,25,12448
TR 70,25,12960
MAA 100,28,8
buffer_load_dwordx4 v19, s[20:23], s54 offen offset:1024 lds
MAA 96,28,4
RD 60,31,18496
MAA 112,32,4
buffer_load_dwordx4 v20, s[20:23], s54 offen offset:2048 lds
MAA 108,32,0
TR 72,25,13440
s_add_u32 s54, s54, 196608
MAA 92,28,0
s_add_u32 m0, s56, 136064
MAA 156,28,16
buffer_load_dwordx4 v18, s[20:23], s54 offen lds
MAA 160,32,16
TR 74,25,13952
TR 76,25,13472
MAA 124,0,36
TR 78,25,13984
MAA 140,0,40
buffer_load_dwordx4 v19, s[20:23], s54 offen offset:1024 lds
MAA 144,4,40
TR 80,25,14464
MAA 128,4,36
TR 82,25,14976
TR 84,25,14496
MAA 132,8,36
buffer_load_dwordx4 v20, s[20:23], s54 offen offset:2048 lds
MAA 148,8,40
s_add_u32 s54, s54, 196608
MAA 152,12,40
TR 86,25,15008
MAA 136,12,36
s_waitcnt vmcnt(15) lgkmcnt(8)
s_barrier
MAA 60,64,44
RD 0,23,36992
s_add_u32 m0, s55, 0
MAA 76,68,44
buffer_load_dwordx4 v21, s[36:39], s52 offen lds
MAA 80,68,48
RD 4,23,39296
MAA 64,64,48
buffer_load_dwordx4 v28, s[36:39], s52 offen offset:1024 lds
MAA 68,64,52
RD 8,23,41600
RD 12,23,43904
MAA 84,68,52
TR 20,25,24832
MAA 88,68,56
buffer_load_dword v22, s[36:39], s52 offen offset:2048 lds
MAA 72,64,56
s_add_u32 s52, s52, 128
s_add_u32 m0, s55, 2304
s_waitcnt lgkmcnt(5)
MAA 244,64,60
buffer_load_dwordx4 v21, s[36:39], s53 offen lds
MAA 104,72,56
TR 22,25,25344
MAA 120,76,56
TR 24,25,24864
TR 26,25,25376
MAA 116,76,52
buffer_load_dwordx4 v28, s[36:39], s53 offen offset:1024 lds
MAA 100,72,52
RD 16,24,36992
MAA 96,72,48
buffer_load_dword v29, s[36:39], s53 offen offset:2048 lds
MAA 112,76,48
TR 28,25,25856
s_add_u32 s53, s53, 128
MAA 108,76,44
s_add_u32 m0, s56, 73984
MAA 92,72,44
buffer_load_dwordx4 v18, s[20:23], s54 offen lds
MAA 156,72,60
TR 30,25,26368
TR 32,25,25888
MAA 160,76,60
buffer_load_dwordx4 v19, s[20:23], s54 offen offset:1024 lds
MAA 124,44,80
TR 34,25,26400
MAA 140,44,84
TR 36,25,26880
MAA 144,48,84
buffer_load_dwordx4 v20, s[20:23], s54 offen offset:2048 lds
MAA 128,48,80
TR 38,25,27392
s_add_u32 s54, s54, 196608
MAA 132,52,80
buffer_load_dword v37, v34, s[40:43], 0 offen sc1
MAA 148,52,84
TR 40,25,26912
MAA 152,56,84
TR 42,25,27424
MAA 136,56,80
s_waitcnt vmcnt(22) lgkmcnt(8)
s_barrier
MAA 60,20,0
RD 44,30,36992
s_add_u32 m0, s56, 86400
MAA 76,24,0
buffer_load_dwordx4 v18, s[20:23], s54 offen lds
MAA 80,24,4
s_sub_u32 s47, s47, 1
s_cbranch_scc1 .Lx6
.Lx6b:
MAA 64,20,4
buffer_load_dwordx4 v19, s[20:23], s54 offen offset:1024 lds
MAA 68,20,8
RD 48,30,39296
MAA 84,24,8
RD 52,30,41600
RD 56,30,43904
MAA 88,24,12
buffer_load_dwordx4 v20, s[20:23], s54 offen offset:2048 lds
MAA 72,20,12
s_add_u32 s54, s54, 196608
s_waitcnt lgkmcnt(4)
MAA 244,20,16
TR 64,25,37248
s_add_u32 m0, s55, 18496
MAA 104,28,12
buffer_load_dwordx4 v21, s[36:39], s52 offen lds
MAA 120,32,12
TR 66,25,37760
MAA 116,32,8
TR 68,25,37280
TR 70,25,37792
MAA 100,28,8
buffer_load_dwordx4 v28, s[36:39], s52 offen offset:1024 lds
MAA 96,28,4
RD 60,31,36992
MAA 112,32,4
buffer_load_dword v22, s[36:39], s52 offen offset:2048 lds
MAA 108,32,0
TR 72,25,38272
s_add_u32 s52, s52, 128
MAA 92,28,0
s_add_u32 m0, s55, 20800
MAA 156,28,16
buffer_load_dwordx4 v21, s[36:39], s53 offen lds
MAA 160,32,16
TR 74,25,38784
TR 76,25,38304
MAA 124,0,36
TR 78,25,38816
MAA 140,0,40
buffer_load_dwordx4 v28, s[36:39], s53 offen offset:1024 lds
MAA 144,4,40
TR 80,25,39296
MAA 128,4,36
TR 82,25,39808
TR 84,25,39328
MAA 132,8,36
buffer_load_dword v29, s[36:39], s53 offen offset:2048 lds
MAA 148,8,40
s_add_u32 s53, s53, 128
MAA 152,12,40
TR 86,25,39840
MAA 136,12,36
s_waitcnt vmcnt(22) lgkmcnt(8)
s_barrier
MAA 60,64,44
RD 0,23,55488
s_add_u32 m0, s56, 98816
MAA 76,68,44
buffer_load_dwordx4 v18, s[20:23], s54 offen lds
MAA 80,68,48
RD 4,23,57792
MAA 64,64,48
RD 8,23,60096
MAA 68,64,52
RD 12,23,62400
MAA 84,68,52
buffer_load_dwordx4 v19, s[20:23], s54 offen offset:1024 lds
MAA 88,68,56
TR 20,25,49664
MAA 72,64,56
TR 22,25,50176
s_waitcnt lgkmcnt(6)
MAA 244,64,60
MAA 104,72,56
buffer_load_dwordx4 v20, s[20:23], s54 offen offset:2048 lds
MAA 120,76,56
TR 24,25,49696
s_add_u32 s54, s54, 196608
MAA 116,76,52
TR 26,25,50208
MAA 100,72,52
RD 16,24,55488
s_add_u32 m0, s55, 36992
MAA 96,72,48
buffer_load_dwordx4 v21, s[36:39], s52 offen lds
MAA 112,76,48
TR 28,25,50688
MAA 108,76,44
TR 30,25,51200
MAA 92,72,44
TR 32,25,50720
MAA 156,72,60
buffer_load_dwordx4 v28, s[36:39], s52 offen offset:1024 lds
MAA 160,76,60
MAA 124,44,80
TR 34,25,51232
MAA 140,44,84
TR 36,25,51712
MAA 144,48,84
buffer_load_dword v22, s[36:39], s52 offen offset:2048 lds
MAA 128,48,80
TR 38,25,52224
s_add_u32 s52, s52, 128
MAA 132,52,80
TR 40,25,51744
MAA 148,52,84
TR 42,25,52256
MAA 152,56,84
MAA 136,56,80
s_waitcnt vmcnt(25) lgkmcnt(8)
s_barrier
MAA 60,20,0
RD 44,30,55488
s_add_u32 m0, s56, 111232
MAA 76,24,0
buffer_load_dwordx4 v18, s[20:23], s54 offen lds
MAA 80,24,4
s_sub_u32 s47, s47, 1
s_cbranch_scc1 .Lx7
.Lx7b:
MAA 64,20,4
RD 48,30,57792
MAA 68,20,8
RD 52,30,60096
MAA 84,24,8
buffer_load_dwordx4 v19, s[20:23], s54 offen offset:1024 lds
MAA 88,24,12
RD 56,30,62400
MAA 72,20,12
TR 64,25,62080
s_waitcnt lgkmcnt(5)
MAA 244,20,16
TR 66,25,62592
MAA 104,28,12
buffer_load_dwordx4 v20, s[20:23], s54 offen offset:2048 lds
MAA 120,32,12
TR 68,25,62112
s_add_u32 s54, s54, 196608
MAA 116,32,8
TR 70,25,62624
MAA 100,28,8
RD 60,31,55488
s_add_u32 m0, s55, 39296
MAA 96,28,4
buffer_load_dwordx4 v21, s[36:39], s53 offen lds
MAA 112,32,4
MAA 108,32,0
TR 72,25,63104
MAA 92,28,0
TR 74,25,63616
MAA 156,28,16
buffer_load_dwordx4 v28, s[36:39], s53 offen offset:1024 lds
MAA 160,32,16
TR 76,25,63136
MAA 124,0,36
TR 78,25,63648
MAA 140,0,40
TR 80,25,64128
MAA 144,4,40
buffer_load_dword v29, s[36:39], s53 offen offset:2048 lds
MAA 128,4,36
TR 82,25,64640
s_add_u32 s53, s53, 128
MAA 132,8,36
TR 84,25,64160
MAA 148,8,40
TR 86,25,64672
MAA 152,12,40
MAA 136,12,36
s_waitcnt vmcnt(22) lgkmcnt(8)
s_barrier
s_waitcnt vmcnt(21)
v_cmp_gt_u32 vcc, v35, v37
s_nop 0
s_cbranch_vccnz .Lsp8
.Lsp8b:
v_mov_b32 v37, 0
MAA 60,64,44
ds_read_b128 a[0:3], v23
MAA 76,68,44
buffer_atomic_add v38, v32, s[16:19], 0 offen
MAA 80,68,48
RD 4,23,2304
MAA 64,64,48
RD 8,23,4608
s_add_u32 m0, s56, 123648
MAA 68,64,52
buffer_load_dwordx4 v18, s[20:23], s54 offen lds
MAA 84,68,52
RD 12,23,6912
MAA 88,68,56
ds_read_b64_tr_b16 a[20:21], v25
MAA 72,64,56
TR 22,25,512
s_waitcnt lgkmcnt(6)
MAA 244,64,60
buffer_load_dwordx4 v19, s[20:23], s54 offen offset:1024 lds
MAA 104,72,56
TR 24,25,32
MAA 120,76,56
TR 26,25,544
MAA 116,76,52
buffer_load_dwordx4 v20, s[20:23], s54 offen offset:2048 lds
MAA 100,72,52
ds_read_b128 a[16:19], v24
s_add_u32 s54, s54, 196608
MAA 96,72,48
MAA 112,76,48
TR 28,25,1024
s_add_u32 m0, s55, 55488
MAA 108,76,44
buffer_load_dwordx4 v21, s[36:39], s52 offen lds
MAA 92,72,44
TR 30,25,1536
MAA 156,72,60
TR 32,25,1056
MAA 160,76,60
buffer_load_dwordx4 v28, s[36:39], s52 offen offset:1024 lds
MAA 124,44,80
TR 34,25,1568
MAA 140,44,84
TR 36,25,2048
MAA 144,48,84
TR 38,25,2560
MAA 128,48,80
buffer_load_dword v22, s[36:39], s52 offen offset:2048 lds
MAA 132,52,80
TR 40,25,2080
s_add_u32 s52, s52, 128
MAA 148,52,84
TR 42,25,2592
MAA 152,56,84
MAA 136,56,80
s_waitcnt vmcnt(25) lgkmcnt(8)
s_barrier
MAA 60,20,0
ds_read_b128 a[44:47], v30
s_add_u32 m0, s56, 136064
MAA 76,24,0
buffer_load_dwordx4 v18, s[20:23], s54 offen lds
MAA 80,24,4
s_sub_u32 s47, s47, 1
s_cbranch_scc1 .Lx9
.Lx9b:
MAA 64,20,4
RD 48,30,2304
MAA 68,20,8
RD 52,30,4608
MAA 84,24,8
buffer_load_dwordx4 v19, s[20:23], s54 offen offset:1024 lds
MAA 88,24,12
RD 56,30,6912
MAA 72,20,12
TR 64,25,12416
s_waitcnt lgkmcnt(5)
MAA 244,20,16
TR 66,25,12928
MAA 104,28,12
buffer_load_dwordx4 v20, s[20:23], s54 offen offset:2048 lds
MAA 120,32,12
TR 68,25,12448
s_add_u32 s54, s54, 196608
MAA 116,32,8
TR 70,25,12960
MAA 100,28,8
ds_read_b128 a[60:63], v31
s_add_u32 m0, s55, 57792
MAA 96,28,4
buffer_load_dwordx4 v21, s[36:39], s53 offen lds
MAA 112,32,4
MAA 108,32,0
TR 72,25,13440
MAA 92,28,0
TR 74,25,13952
MAA 156,28,16
buffer_load_dwordx4 v28, s[36:39], s53 offen offset:1024 lds
MAA 160,32,16
TR 76,25,13472
MAA 124,0,36
TR 78,25,13984
MAA 140,0,40
TR 80,25,14464
MAA 144,4,40
buffer_load_dword v29, s[36:39], s53 offen offset:2048 lds
MAA 128,4,36
TR 82,25,14976
s_add_u32 s53, s53, 128
MAA 132,8,36
TR 84,25,14496
MAA 148,8,40
TR 86,25,15008
MAA 152,12,40
MAA 136,12,36
s_waitcnt vmcnt(22) lgkmcnt(8)
s_barrier
MAA 60,64,44
RD 0,23,18496
s_add_u32 m0, s56, 73984
MAA 76,68,44
buffer_load_dwordx4 v18, s[20:23], s54 offen lds
MAA 80,68,48
RD 4,23,20800
MAA 64,64,48
RD 8,23,23104
MAA 68,64,52
RD 12,23,25408
MAA 84,68,52
buffer_load_dwordx4 v19, s[20:23], s54 offen offset:1024 lds
MAA 88,68,56
TR 20,25,24832
MAA 72,64,56
TR 22,25,25344
s_waitcnt lgkmcnt(6)
MAA 244,64,60
MAA 104,72,56
buffer_load_dwordx4 v20, s[20:23], s54 offen offset:2048 lds
MAA 120,76,56
TR 24,25,24864
s_add_u32 s54, s54, 196608
MAA 116,76,52
TR 26,25,25376
MAA 100,72,52
RD 16,24,18496
s_add_u32 m0, s55, 0
MAA 96,72,48
buffer_load_dwordx4 v21, s[36:39], s52 offen lds
MAA 112,76,48
TR 28,25,25856
MAA 108,76,44
TR 30,25,26368
MAA 92,72,44
TR 32,25,25888
MAA 156,72,60
buffer_load_dwordx4 v28, s[36:39], s52 offen offset:1024 lds
MAA 160,76,60
MAA 124,44,80
TR 34,25,26400
MAA 140,44,84
TR 36,25,26880
MAA 144,48,84
buffer_load_dword v22, s[36:39], s52 offen offset:2048 lds
MAA 128,48,80
TR 38,25,27392
s_add_u32 s52, s52, 128
MAA 132,52,80
TR 40,25,26912
MAA 148,52,84
TR 42,25,27424
MAA 152,56,84
MAA 136,56,80
s_waitcnt vmcnt(22) lgkmcnt(8)
s_barrier
MAA 60,20,0
RD 44,30,18496
s_add_u32 m0, s56, 86400
MAA 76,24,0
buffer_load_dwordx4 v18, s[20:23], s54 offen lds
MAA 80,24,4
s_sub_u32 s47, s47, 1
s_cbranch_scc1 .Lx10
.Lx10b:
MAA 64,20,4
RD 48,30,20800
MAA 68,20,8
RD 52,30,23104
MAA 84,24,8
buffer_load_dwordx4 v19, s[20:23], s54 offen offset:1024 lds
MAA 88,24,12
RD 56,30,25408
MAA 72,20,12
TR 64,25,37248
s_waitcnt lgkmcnt(5)
MAA 244,20,16
TR 66,25,37760
MAA 104,28,12
buffer_load_dwordx4 v20, s[20:23], s54 offen offset:2048 lds
MAA 120,32,12
TR 68,25,37280
s_add_u32 s54, s54, 196608
MAA 116,32,8
TR 70,25,37792
MAA 100,28,8
RD 60,31,18496
s_add_u32 m0, s55, 2304
MAA 96,28,4
buffer_load_dwordx4 v21, s[36:39], s53 offen lds
MAA 112,32,4
MAA 108,32,0
TR 72,25,38272
MAA 92,28,0
TR 74,25,38784
MAA 156,28,16
buffer_load_dwordx4 v28, s[36:39], s53 offen offset:1024 lds
MAA 160,32,16
TR 76,25,38304
MAA 124,0,36
TR 78,25,38816
MAA 140,0,40
TR 80,25,39296
MAA 144,4,40
buffer_load_dword v29, s[36:39], s53 offen offset:2048 lds
MAA 128,4,36
TR 82,25,39808
s_add_u32 s53, s53, 128
MAA 132,8,36
TR 84,25,39328
MAA 148,8,40
TR 86,25,39840
MAA 152,12,40
MAA 136,12,36
s_waitcnt vmcnt(21) lgkmcnt(8)
s_barrier
MAA 60,64,44
RD 0,23,36992
s_add_u32 m0, s56, 98816
MAA 76,68,44
buffer_load_dwordx4 v18, s[20:23], s54 offen lds
MAA 80,68,48
RD 4,23,39296
MAA 64,64,48
RD 8,23,41600
MAA 68,64,52
RD 12,23,43904
MAA 84,68,52
buffer_load_dwordx4 v19, s[20:23], s54 offen offset:1024 lds
MAA 88,68,56
TR 20,25,49664
MAA 72,64,56
TR 22,25,50176
s_waitcnt lgkmcnt(6)
MAA 244,64,60
MAA 104,72,56
buffer_load_dwordx4 v20, s[20:23], s54 offen offset:2048 lds
MAA 120,76,56
TR 24,25,49696
s_add_u32 s54, s54, 196608
MAA 116,76,52
TR 26,25,50208
MAA 100,72,52
RD 16,24,36992
s_add_u32 m0, s55, 18496
MAA 96,72,48
buffer_load_dwordx4 v21, s[36:39], s52 offen lds
MAA 112,76,48
TR 28,25,50688
MAA 108,76,44
TR 30,25,51200
MAA 92,72,44
TR 32,25,50720
MAA 156,72,60
buffer_load_dwordx4 v28, s[36:39], s52 offen offset:1024 lds
MAA 160,76,60
MAA 124,44,80
TR 34,25,51232
MAA 140,44,84
TR 36,25,51712
MAA 144,48,84
buffer_load_dword v22, s[36:39], s52 offen offset:2048 lds
MAA 128,48,80
TR 38,25,52224
s_add_u32 s52, s52, 128
MAA 132,52,80
TR 40,25,51744
MAA 148,52,84
TR 42,25,52256
MAA 152,56,84
MAA 136,56,80
s_waitcnt vmcnt(21) lgkmcnt(8)
s_barrier
MAA 60,20,0
RD 44,30,36992
s_add_u32 m0, s56, 111232
MAA 76,24,0
buffer_load_dwordx4 v18, s[20:23], s54 offen lds
MAA 80,24,4
s_sub_u32 s47, s47, 1
s_cbranch_scc1 .Lx11
.Lx11b:
MAA 64,20,4
RD 48,30,39296
MAA 68,20,8
buffer_load_dwordx4 v19, s[20:23], s54 offen offset:1024 lds
MAA 84,24,8
RD 52,30,41600
MAA 88,24,12
RD 56,30,43904
MAA 72,20,12
TR 64,25,62080
s_waitcnt lgkmcnt(5)
MAA 244,20,16
buffer_load_dwordx4 v20, s[20:23], s54 offen offset:2048 lds
MAA 104,28,12
TR 66,25,62592
s_add_u32 s54, s54, 196608
MAA 120,32,12
TR 68,25,62112
s_add_u32 m0, s55, 20800
MAA 116,32,8
buffer_load_dwordx4 v21, s[36:39], s53 offen lds
MAA 100,28,8
TR 70,25,62624
MAA 96,28,4
RD 60,31,36992
MAA 112,32,4
TR 72,25,63104
MAA 108,32,0
buffer_load_dwordx4 v28, s[36:39], s53 offen offset:1024 lds
MAA 92,28,0
TR 74,25,63616
MAA 156,28,16
TR 76,25,63136
MAA 160,32,16
buffer_load_dword v29, s[36:39], s53 offen offset:2048 lds
MAA 124,0,36
TR 78,25,63648
s_add_u32 s53, s53, 128
MAA 140,0,40
TR 80,25,64128
MAA 144,4,40
TR 82,25,64640
MAA 128,4,36
buffer_atomic_add v37, v33, s[16:19], 0 offen sc0
MAA 132,8,36
TR 84,25,64160
MAA 148,8,40
TR 86,25,64672
MAA 152,12,40
MAA 136,12,36
s_waitcnt vmcnt(22) lgkmcnt(8)
s_barrier
MAA 60,64,44
RD 0,23,55488
s_add_u32 m0, s56, 123648
MAA 76,68,44
buffer_load_dwordx4 v18, s[20:23], s54 offen lds
MAA 80,68,48
RD 4,23,57792
MAA 64,64,48
RD 8,23,60096
MAA 68,64,52
RD 12,23,62400
MAA 84,68,52
buffer_load_dwordx4 v19, s[20:23], s54 offen offset:1024 lds
MAA 88,68,56
ds_read_b64_tr_b16 a[20:21], v25
MAA 72,64,56
TR 22,25,512
s_waitcnt lgkmcnt(6)
MAA 244,64,60
MAA 104,72,56
buffer_load_dwordx4 v20, s[20:23], s54 offen offset:2048 lds
MAA 120,76,56
TR 24,25,32
s_add_u32 s54, s54, 196608
MAA 116,76,52
TR 26,25,544
MAA 100,72,52
RD 16,24,55488
s_add_u32 m0, s55, 36992
MAA 96,72,48
buffer_load_dwordx4 v21, s[36:39], s52 offen lds
MAA 112,76,48
TR 28,25,1024
MAA 108,76,44
TR 30,25,1536
MAA 92,72,44
TR 32,25,1056
MAA 156,72,60
buffer_load_dwordx4 v28, s[36:39], s52 offen offset:1024 lds
MAA 160,76,60
MAA 124,44,80
TR 34,25,1568
MAA 140,44,84
TR 36,25,2048
MAA 144,48,84
buffer_load_dword v22, s[36:39], s52 offen offset:2048 lds
MAA 128,48,80
TR 38,25,2560
s_add_u32 s52, s52, 128
MAA 132,52,80
TR 40,25,2080
MAA 148,52,84
TR 42,25,2592
MAA 152,56,84
MAA 136,56,80
s_waitcnt vmcnt(22) lgkmcnt(8)
s_barrier
MAA 60,20,0
RD 44,30,55488
s_add_u32 m0, s56, 136064
MAA 76,24,0
buffer_load_dwordx4 v18, s[20:23], s54 offen lds
MAA 80,24,4
s_sub_u32 s47, s47, 1
s_cbranch_scc1 .Lx12
.Lx12b:
MAA 64,20,4
RD 48,30,57792
MAA 68,20,8
RD 52,30,60096
MAA 84,24,8
buffer_load_dwordx4 v19, s[20:23], s54 offen offset:1024 lds
MAA 88,24,12
RD 56,30,62400
MAA 72,20,12
TR 64,25,12416
s_waitcnt lgkmcnt(5)
MAA 244,20,16
TR 66,25,12928
MAA 104,28,12
buffer_load_dwordx4 v20, s[20:23], s54 offen offset:2048 lds
MAA 120,32,12
TR 68,25,12448
s_add_u32 s54, s54, 196608
MAA 116,32,8
TR 70,25,12960
MAA 100,28,8
RD 60,31,55488
s_add_u32 m0, s55, 39296
MAA 96,28,4
buffer_load_dwordx4 v21, s[36:39], s53 offen lds
MAA 112,32,4
MAA 108,32,0
TR 72,25,13440
MAA 92,28,0
TR 74,25,13952
MAA 156,28,16
buffer_load_dwordx4 v28, s[36:39], s53 offen offset:1024 lds
MAA 160,32,16
TR 76,25,13472
MAA 124,0,36
TR 78,25,13984
MAA 140,0,40
TR 80,25,14464
MAA 144,4,40
buffer_load_dword v29, s[36:39], s53 offen offset:2048 lds
MAA 128,4,36
TR 82,25,14976
s_add_u32 s53, s53, 128
MAA 132,8,36
TR 84,25,14496
MAA 148,8,40
TR 86,25,15008
MAA 152,12,40
MAA 136,12,36
s_waitcnt vmcnt(22) lgkmcnt(8)
s_barrier
MAA 60,64,44
ds_read_b128 a[0:3], v23
s_add_u32 m0, s56, 73984
MAA 76,68,44
buffer_load_dwordx4 v18, s[20:23], s54 offen lds
MAA 80,68,48
RD 4,23,2304
MAA 64,64,48
RD 8,23,4608
MAA 68,64,52
RD 12,23,6912
MAA 84,68,52
buffer_load_dwordx4 v19, s[20:23], s54 offen offset:1024 lds
MAA 88,68,56
TR 20,25,24832
MAA 72,64,56
TR 22,25,25344
s_waitcnt lgkmcnt(6)
MAA 244,64,60
MAA 104,72,56
buffer_load_dwordx4 v20, s[20:23], s54 offen offset:2048 lds
MAA 120,76,56
TR 24,25,24864
s_add_u32 s54, s54, 196608
MAA 116,76,52
TR 26,25,25376
MAA 100,72,52
ds_read_b128 a[16:19], v24
s_add_u32 m0, s55, 55488
MAA 96,72,48
buffer_load_dwordx4 v21, s[36:39], s52 offen lds
MAA 112,76,48
TR 28,25,25856
MAA 108,76,44
TR 30,25,26368
MAA 92,72,44
TR 32,25,25888
MAA 156,72,60
buffer_load_dwordx4 v28, s[36:39], s52 offen offset:1024 lds
MAA 160,76,60
MAA 124,44,80
TR 34,25,26400
MAA 140,44,84
TR 36,25,26880
MAA 144,48,84
buffer_load_dword v22, s[36:39], s52 offen offset:2048 lds
MAA 128,48,80
TR 38,25,27392
s_add_u32 s52, s52, 128
MAA 132,52,80
TR 40,25,26912
MAA 148,52,84
TR 42,25,27424
MAA 152,56,84
MAA 136,56,80
s_waitcnt vmcnt(22) lgkmcnt(8)
s_barrier
MAA 60,20,0
ds_read_b128 a[44:47], v30
s_add_u32 m0, s56, 86400
MAA 76,24,0
buffer_load_dwordx4 v18, s[20:23], s54 offen lds
MAA 80,24,4
s_sub_u32 s47, s47, 1
s_cbranch_scc1 .Lx13
.Lx13b:
MAA 64,20,4
RD 48,30,2304
MAA 68,20,8
RD 52,30,4608
MAA 84,24,8
buffer_load_dwordx4 v19, s[20:23], s54 offen offset:1024 lds
MAA 88,24,12
RD 56,30,6912
MAA 72,20,12
TR 64,25,37248
s_waitcnt lgkmcnt(5)
MAA 244,20,16
TR 66,25,37760
MAA 104,28,12
buffer_load_dwordx4 v20, s[20:23], s54 offen offset:2048 lds
MAA 120,32,12
TR 68,25,37280
s_add_u32 s54, s54, 196608
MAA 116,32,8
TR 70,25,37792
MAA 100,28,8
ds_read_b128 a[60:63], v31
s_add_u32 m0, s55, 57792
MAA 96,28,4
buffer_load_dwordx4 v21, s[36:39], s53 offen lds
MAA 112,32,4
MAA 108,32,0
TR 72,25,38272
MAA 92,28,0
TR 74,25,38784
MAA 156,28,16
buffer_load_dwordx4 v28, s[36:39], s53 offen offset:1024 lds
MAA 160,32,16
TR 76,25,38304
MAA 124,0,36
TR 78,25,38816
MAA 140,0,40
TR 80,25,39296
MAA 144,4,40
buffer_load_dword v29, s[36:39], s53 offen offset:2048 lds
MAA 128,4,36
TR 82,25,39808
s_add_u32 s53, s53, 128
MAA 132,8,36
TR 84,25,39328
MAA 148,8,40
TR 86,25,39840
MAA 152,12,40
MAA 136,12,36
s_waitcnt vmcnt(24)
v_cmp_gt_u32 vcc, v36, v37
s_nop 0
s_cbranch_vccnz .Lsp14
.Lsp14b:
s_waitcnt vmcnt(21) lgkmcnt(8)
s_barrier
MAA 60,64,44
RD 0,23,18496
s_add_u32 m0, s56, 98816
MAA 76,68,44
buffer_load_dwordx4 v18, s[20:23], s54 offen lds
MAA 80,68,48
RD 4,23,20800
MAA 64,64,48
RD 8,23,23104
MAA 68,64,52
buffer_load_dwordx4 v19, s[20:23], s54 offen offset:1024 lds
MAA 84,68,52
RD 12,23,25408
MAA 88,68,56
TR 20,25,49664
MAA 72,64,56
TR 22,25,50176
s_waitcnt lgkmcnt(6)
MAA 244,64,60
buffer_load_dwordx4 v20, s[20:23], s54 offen offset:2048 lds
MAA 104,72,56
TR 24,25,49696
s_add_u32 s54, s54, 196608
MAA 120,76,56
TR 26,25,50208
s_add_u32 m0, s55, 0
MAA 116,76,52
buffer_load_dwordx4 v21, s[36:39], s52 offen lds
MAA 100,72,52
RD 16,24,18496
MAA 96,72,48
MAA 112,76,48
TR 28,25,50688
MAA 108,76,44
buffer_load_dwordx4 v28, s[36:39], s52 offen offset:1024 lds
MAA 92,72,44
TR 30,25,51200
MAA 156,72,60
TR 32,25,50720
MAA 160,76,60
buffer_load_dword v22, s[36:39], s52 offen offset:2048 lds
MAA 124,44,80
TR 34,25,51232
s_add_u32 s52, s52, 128
MAA 140,44,84
TR 36,25,51712
MAA 144,48,84
TR 38,25,52224
MAA 128,48,80
buffer_load_dwordx4 v[164:167], v26, s[16:19], s75 offen sc1
MAA 132,52,80
TR 40,25,51744
MAA 148,52,84
TR 42,25,52256
MAA 152,56,84
MAA 136,56,80
s_waitcnt vmcnt(22) lgkmcnt(8)
s_barrier
MAA 60,20,0
RD 44,30,18496
s_add_u32 m0, s56, 111232
MAA 76,24,0
buffer_load_dwordx4 v18, s[20:23], s54 offen lds
MAA 80,24,4
s_sub_u32 s47, s47, 1
s_cbranch_scc1 .Lx15
.Lx15b:
MAA 64,20,4
RD 48,30,20800
MAA 68,20,8
buffer_load_dwordx4 v19, s[20:23], s54 offen offset:1024 lds
MAA 84,24,8
RD 52,30,23104
MAA 88,24,12
RD 56,30,25408
MAA 72,20,12
TR 64,25,62080
s_waitcnt lgkmcnt(5)
MAA 244,20,16
buffer_load_dwordx4 v20, s[20:23], s54 offen offset:2048 lds
MAA 104,28,12
TR 66,25,62592
s_add_u32 s54, s54, 196608
MAA 120,32,12
TR 68,25,62112
s_add_u32 m0, s55, 2304
MAA 116,32,8
buffer_load_dwordx4 v21, s[36:39], s53 offen lds
MAA 100,28,8
TR 70,25,62624
MAA 96,28,4
RD 60,31,18496
MAA 112,32,4
TR 72,25,63104
MAA 108,32,0
buffer_load_dwordx4 v28, s[36:39], s53 offen offset:1024 lds
MAA 92,28,0
TR 74,25,63616
MAA 156,28,16
TR 76,25,63136
MAA 160,32,16
buffer_load_dword v29, s[36:39], s53 offen offset:2048 lds
MAA 124,0,36
TR 78,25,63648
s_add_u32 s53, s53, 128
MAA 140,0,40
TR 80,25,64128
MAA 144,4,40
TR 82,25,64640
MAA 128,4,36
buffer_load_dwordx4 v[168:171], v26, s[16:19], s75 offen offset:1024 sc1
MAA 132,8,36
TR 84,25,64160
MAA 148,8,40
TR 86,25,64672
MAA 152,12,40
MAA 136,12,36
s_waitcnt vmcnt(23) lgkmcnt(8)
s_barrier
MAA 60,64,44
RD 0,23,36992
s_add_u32 m0, s56, 123648
MAA 76,68,44
buffer_load_dwordx4 v18, s[20:23], s54 offen lds
MAA 80,68,48
RD 4,23,39296
MAA 64,64,48
RD 8,23,41600
MAA 68,64,52
buffer_load_dwordx4 v19, s[20:23], s54 offen offset:1024 lds
MAA 84,68,52
RD 12,23,43904
MAA 88,68,56
ds_read_b64_tr_b16 a[20:21], v25
MAA 72,64,56
TR 22,25,512
s_waitcnt lgkmcnt(6)
MAA 244,64,60
buffer_load_dwordx4 v20, s[20:23], s54 offen offset:2048 lds
MAA 104,72,56
TR 24,25,32
s_add_u32 s54, s54, 196608
MAA 120,76,56
TR 26,25,544
s_add_u32 m0, s55, 18496
MAA 116,76,52
buffer_load_dwordx4 v21, s[36:39], s52 offen lds
MAA 100,72,52
RD 16,24,36992
MAA 96,72,48
MAA 112,76,48
TR 28,25,1024
MAA 108,76,44
buffer_load_dwordx4 v28, s[36:39], s52 offen offset:1024 lds
MAA 92,72,44
TR 30,25,1536
MAA 156,72,60
TR 32,25,1056
MAA 160,76,60
buffer_load_dword v22, s[36:39], s52 offen offset:2048 lds
MAA 124,44,80
TR 34,25,1568
s_add_u32 s52, s52, 128
MAA 140,44,84
TR 36,25,2048
MAA 144,48,84
TR 38,25,2560
MAA 128,48,80
buffer_load_dwordx4 v[172:175], v26, s[16:19], s75 offen offset:2048 sc1
MAA 132,52,80
TR 40,25,2080
MAA 148,52,84
TR 42,25,2592
MAA 152,56,84
MAA 136,56,80
s_waitcnt vmcnt(24) lgkmcnt(8)
s_barrier
MAA 60,20,0
RD 44,30,36992
s_add_u32 m0, s56, 136064
MAA 76,24,0
buffer_load_dwordx4 v18, s[20:23], s54 offen lds
MAA 80,24,4
s_sub_u32 s47, s47, 1
s_cbranch_scc1 .Lx16
.Lx16b:
MAA 64,20,4
RD 48,30,39296
MAA 68,20,8
buffer_load_dwordx4 v19, s[20:23], s54 offen offset:1024 lds
MAA 84,24,8
RD 52,30,41600
MAA 88,24,12
RD 56,30,43904
MAA 72,20,12
TR 64,25,12416
s_waitcnt lgkmcnt(5)
MAA 244,20,16
buffer_load_dwordx4 v20, s[20:23], s54 offen offset:2048 lds
MAA 104,28,12
TR 66,25,12928
s_add_u32 s54, s54, 196608
MAA 120,32,12
TR 68,25,12448
s_add_u32 m0, s55, 20800
MAA 116,32,8
buffer_load_dwordx4 v21, s[36:39], s53 offen lds
MAA 100,28,8
TR 70,25,12960
MAA 96,28,4
RD 60,31,36992
MAA 112,32,4
TR 72,25,13440
MAA 108,32,0
buffer_load_dwordx4 v28, s[36:39], s53 offen offset:1024 lds
MAA 92,28,0
TR 74,25,13952
MAA 156,28,16
TR 76,25,13472
MAA 160,32,16
buffer_load_dword v29, s[36:39], s53 offen offset:2048 lds
MAA 124,0,36
TR 78,25,13984
s_add_u32 s53, s53, 128
MAA 140,0,40
TR 80,25,14464
MAA 144,4,40
TR 82,25,14976
MAA 128,4,36
buffer_load_dwordx4 v[176:179], v26, s[16:19], s75 offen offset:3072 sc1
MAA 132,8,36
TR 84,25,14496
s_add_u32 s75, s75, 4096
MAA 148,8,40
TR 86,25,15008
MAA 152,12,40
MAA 136,12,36
s_waitcnt vmcnt(25) lgkmcnt(8)
s_barrier
MAA 60,64,44
RD 0,23,55488
s_add_u32 m0, s56, 73984
MAA 76,68,44
buffer_load_dwordx4 v18, s[20:23], s54 offen lds
MAA 80,68,48
RD 4,23,57792
MAA 64,64,48
RD 8,23,60096
MAA 68,64,52
buffer_load_dwordx4 v19, s[20:23], s54 offen offset:1024 lds
MAA 84,68,52
RD 12,23,62400
MAA 88,68,56
TR 20,25,24832
MAA 72,64,56
TR 22,25,25344
s_waitcnt lgkmcnt(6)
MAA 244,64,60
buffer_load_dwordx4 v20, s[20:23], s54 offen offset:2048 lds
MAA 104,72,56
TR 24,25,24864
s_add_u32 s54, s54, 196608
MAA 120,76,56
TR 26,25,25376
s_add_u32 m0, s55, 36992
MAA 116,76,52
buffer_load_dwordx4 v21, s[36:39], s52 offen lds
MAA 100,72,52
RD 16,24,55488
MAA 96,72,48
MAA 112,76,48
TR 28,25,25856
MAA 108,76,44
buffer_load_dwordx4 v28, s[36:39], s52 offen offset:1024 lds
MAA 92,72,44
TR 30,25,26368
MAA 156,72,60
TR 32,25,25888
MAA 160,76,60
buffer_load_dword v22, s[36:39], s52 offen offset:2048 lds
MAA 124,44,80
TR 34,25,26400
s_add_u32 s52, s52, 128
MAA 140,44,84
TR 36,25,26880
MAA 144,48,84
TR 38,25,27392
MAA 128,48,80
buffer_load_dwordx4 v[180:183], v26, s[16:19], s75 offen sc1
MAA 132,52,80
TR 40,25,26912
MAA 148,52,84
TR 42,25,27424
MAA 152,56,84
MAA 136,56,80
s_waitcnt vmcnt(25) lgkmcnt(8)
s_barrier
MAA 60,20,0
RD 44,30,55488
s_add_u32 m0, s56, 86400
MAA 76,24,0
buffer_load_dwordx4 v18, s[20:23], s54 offen lds
MAA 80,24,4
s_sub_u32 s47, s47, 1
s_cbranch_scc1 .Lx17
.Lx17b:
MAA 64,20,4
RD 48,30,57792
s_waitcnt vmcnt(22)
v_add_f32 v164, v164, v168
MAA 68,20,8
buffer_load_dwordx4 v19, s[20:23], s54 offen offset:1024 lds
MAA 84,24,8
RD 52,30,60096
MAA 88,24,12
RD 56,30,62400
MAA 72,20,12
TR 64,25,37248
s_waitcnt lgkmcnt(5)
MAA 244,20,16
buffer_load_dwordx4 v20, s[20:23], s54 offen offset:2048 lds
MAA 104,28,12
TR 66,25,37760
s_add_u32 s54, s54, 196608
MAA 120,32,12
TR 68,25,37280
s_add_u32 m0, s55, 39296
MAA 116,32,8
buffer_load_dwordx4 v21, s[36:39], s53 offen lds
MAA 100,28,8
TR 70,25,37792
v_add_f32 v165, v165, v169
MAA 96,28,4
RD 60,31,55488
MAA 112,32,4
TR 72,25,38272
MAA 108,32,0
buffer_load_dwordx4 v28, s[36:39], s53 offen offset:1024 lds
MAA 92,28,0
TR 74,25,38784
MAA 156,28,16
TR 76,25,38304
v_add_f32 v166, v166, v170
MAA 160,32,16
buffer_load_dword v29, s[36:39], s53 offen offset:2048 lds
MAA 124,0,36
TR 78,25,38816
s_add_u32 s53, s53, 128
MAA 140,0,40
TR 80,25,39296
MAA 144,4,40
TR 82,25,39808
MAA 128,4,36
buffer_load_dwordx4 v[184:187], v26, s[16:19], s75 offen offset:1024 sc1
MAA 132,8,36
TR 84,25,39328
v_add_f32 v167, v167, v171
MAA 148,8,40
TR 86,25,39840
MAA 152,12,40
MAA 136,12,36
s_waitcnt vmcnt(25) lgkmcnt(8)
s_barrier
MAA 60,64,44
ds_read_b128 a[0:3], v23
s_add_u32 m0, s56, 98816
MAA 76,68,44
buffer_load_dwordx4 v18, s[20:23], s54 offen lds
MAA 80,68,48
RD 4,23,2304
s_waitcnt vmcnt(22)
v_add_f32 v164, v164, v172
MAA 64,64,48
RD 8,23,4608
v_add_f32 v165, v165, v173
MAA 68,64,52
buffer_load_dwordx4 v19, s[20:23], s54 offen offset:1024 lds
MAA 84,68,52
RD 12,23,6912
v_add_f32 v166, v166, v174
MAA 88,68,56
TR 20,25,49664
v_add_f32 v167, v167, v175
MAA 72,64,56
buffer_load_dwordx4 v20, s[20:23], s54 offen offset:2048 lds
s_waitcnt lgkmcnt(5)
MAA 244,64,60
TR 22,25,50176
s_add_u32 s54, s54, 196608
MAA 104,72,56
TR 24,25,49696
s_add_u32 m0, s55, 55488
MAA 120,76,56
buffer_load_dwordx4 v21, s[36:39], s52 offen lds
MAA 116,76,52
TR 26,25,50208
MAA 100,72,52
ds_read_b128 a[16:19], v24
MAA 96,72,48
buffer_load_dwordx4 v28, s[36:39], s52 offen offset:1024 lds
MAA 112,76,48
TR 28,25,50688
MAA 108,76,44
TR 30,25,51200
MAA 92,72,44
buffer_load_dword v22, s[36:39], s52 offen offset:2048 lds
MAA 156,72,60
TR 32,25,50720
s_add_u32 s52, s52, 128
MAA 160,76,60
TR 34,25,51232
MAA 124,44,80
buffer_load_dwordx4 v[188:191], v26, s[16:19], s75 offen offset:2048 sc1
MAA 140,44,84
TR 36,25,51712
MAA 144,48,84
TR 38,25,52224
MAA 128,48,80
TR 40,25,51744
MAA 132,52,80
TR 42,25,52256
MAA 148,52,84
MAA 152,56,84
MAA 136,56,80
s_waitcnt vmcnt(25) lgkmcnt(8)
s_barrier
MAA 60,20,0
ds_read_b128 a[44:47], v30
s_add_u32 m0, s56, 111232
MAA 76,24,0
buffer_load_dwordx4 v18, s[20:23], s54 offen lds
MAA 80,24,4
RD 48,30,2304
s_waitcnt vmcnt(22)
v_add_f32 v164, v164, v176
MAA 64,20,4
RD 52,30,4608
v_add_f32 v165, v165, v177
MAA 68,20,8
buffer_load_dwordx4 v19, s[20:23], s54 offen offset:1024 lds
MAA 84,24,8
RD 56,30,6912
v_add_f32 v166, v166, v178
MAA 88,24,12
TR 64,25,62080
v_add_f32 v167, v167, v179
MAA 72,20,12
buffer_load_dwordx4 v20, s[20:23], s54 offen offset:2048 lds
s_waitcnt lgkmcnt(5)
MAA 244,20,16
TR 66,25,62592
s_add_u32 s54, s54, 196608
MAA 104,28,12
TR 68,25,62112
s_add_u32 m0, s55, 57792
MAA 120,32,12
buffer_load_dwordx4 v21, s[36:39], s53 offen lds
MAA 116,32,8
TR 70,25,62624
MAA 100,28,8
ds_read_b128 a[60:63], v31
MAA 96,28,4
buffer_load_dwordx4 v28, s[36:39], s53 offen offset:1024 lds
MAA 112,32,4
TR 72,25,63104
MAA 108,32,0
TR 74,25,63616
MAA 92,28,0
buffer_load_dword v29, s[36:39], s53 offen offset:2048 lds
MAA 156,28,16
TR 76,25,63136
s_add_u32 s53, s53, 128
MAA 160,32,16
TR 78,25,63648
MAA 124,0,36
buffer_load_dwordx4 v[192:195], v26, s[16:19], s75 offen offset:3072 sc1
MAA 140,0,40
TR 80,25,64128
MAA 144,4,40
TR 82,25,64640
MAA 128,4,36
TR 84,25,64160
MAA 132,8,36
TR 86,25,64672
MAA 148,8,40
MAA 152,12,40
MAA 136,12,36
s_waitcnt vmcnt(25) lgkmcnt(8)
s_barrier
MAA 60,64,44
RD 0,23,18496
s_add_u32 m0, s56, 123648
MAA 76,68,44
buffer_load_dwordx4 v18, s[20:23], s54 offen lds
MAA 80,68,48
RD 4,23,20800
s_waitcnt vmcnt(22)
v_add_f32 v164, v164, v180
MAA 64,64,48
RD 8,23,23104
v_add_f32 v165, v165, v181
MAA 68,64,52
RD 12,23,25408
v_add_f32 v166, v166, v182
MAA 84,68,52
ds_read_b64_tr_b16 a[20:21], v25
v_add_f32 v167, v167, v183
MAA 88,68,56
TR 22,25,512
MAA 72,64,56
TR 24,25,32
s_waitcnt lgkmcnt(7)
MAA 244,64,60
TR 26,25,544
MAA 104,72,56
buffer_load_dwordx4 v19, s[20:23], s54 offen offset:1024 lds
MAA 120,76,56
RD 16,24,18496
MAA 116,76,52
TR 28,25,1024
MAA 100,72,52
TR 30,25,1536
MAA 96,72,48
TR 32,25,1056
MAA 112,76,48
TR 34,25,1568
MAA 108,76,44
TR 36,25,2048
MAA 92,72,44
TR 38,25,2560
MAA 156,72,60
buffer_load_dwordx4 v20, s[20:23], s54 offen offset:2048 lds
MAA 160,76,60
TR 40,25,2080
s_add_u32 s54, s54, 196608
MAA 124,44,80
TR 42,25,2592
MAA 140,44,84
MAA 144,48,84
MAA 128,48,80
MAA 132,52,80
MAA 148,52,84
MAA 152,56,84
MAA 136,56,80
s_waitcnt vmcnt(21) lgkmcnt(8)
s_barrier
MAA 60,20,0
RD 44,30,18496
s_add_u32 m0, s56, 136064
MAA 76,24,0
buffer_load_dwordx4 v18, s[20:23], s54 offen lds
MAA 80,24,4
RD 48,30,20800
s_waitcnt vmcnt(18)
v_add_f32 v164, v164, v184
MAA 64,20,4
RD 52,30,23104
v_add_f32 v165, v165, v185
MAA 68,20,8
RD 56,30,25408
v_add_f32 v166, v166, v186
MAA 84,24,8
TR 64,25,12416
v_add_f32 v167, v167, v187
MAA 88,24,12
TR 66,25,12928
MAA 72,20,12
TR 68,25,12448
s_waitcnt lgkmcnt(7)
MAA 244,20,16
TR 70,25,12960
MAA 104,28,12
buffer_load_dwordx4 v19, s[20:23], s54 offen offset:1024 lds
MAA 120,32,12
RD 60,31,18496
MAA 116,32,8
TR 72,25,13440
MAA 100,28,8
TR 74,25,13952
MAA 96,28,4
TR 76,25,13472
MAA 112,32,4
TR 78,25,13984
MAA 108,32,0
TR 80,25,14464
MAA 92,28,0
TR 82,25,14976
MAA 156,28,16
buffer_load_dwordx4 v20, s[20:23], s54 offen offset:2048 lds
MAA 160,32,16
TR 84,25,14496
s_add_u32 s54, s54, 196608
MAA 124,0,36
TR 86,25,15008
MAA 140,0,40
MAA 144,4,40
MAA 128,4,36
MAA 132,8,36
MAA 148,8,40
MAA 152,12,40
MAA 136,12,36
s_waitcnt vmcnt(17) lgkmcnt(8)
s_barrier
MAA 60,64,44
RD 0,23,36992
s_add_u32 m0, s59, 0
MAA 76,68,44
RD 4,23,39296
s_mov_b32 s58, 1048576
MAA 80,68,48
buffer_load_dwordx4 v5, s[24:27], s58 offen lds
MAA 64,64,48
RD 8,23,41600
s_waitcnt vmcnt(14)
v_add_f32 v164, v164, v188
MAA 68,64,52
RD 12,23,43904
v_add_f32 v165, v165, v189
MAA 84,68,52
TR 20,25,24832
v_add_f32 v166, v166, v190
MAA 88,68,56
buffer_load_dwordx4 v6, s[24:27], s58 offen offset:1024 lds
MAA 72,64,56
TR 22,25,25344
s_add_u32 m0, s59, 8320
s_waitcnt lgkmcnt(6)
MAA 244,64,60
TR 24,25,24864
s_mov_b32 s58, 1179648
MAA 104,72,56
TR 26,25,25376
v_add_f32 v167, v167, v191
MAA 120,76,56
buffer_load_dwordx4 v5, s[24:27], s58 offen lds
MAA 116,76,52
RD 16,24,36992
MAA 100,72,52
TR 28,25,25856
MAA 96,72,48
TR 30,25,26368
MAA 112,76,48
buffer_load_dwordx4 v6, s[24:27], s58 offen offset:1024 lds
MAA 108,76,44
TR 32,25,25888
s_add_u32 m0, s59, 16640
MAA 92,72,44
TR 34,25,26400
s_mov_b32 s58, 1310720
MAA 156,72,60
TR 36,25,26880
MAA 160,76,60
buffer_load_dwordx4 v5, s[24:27], s58 offen lds
MAA 124,44,80
TR 38,25,27392
MAA 140,44,84
TR 40,25,26912
MAA 144,48,84
TR 42,25,27424
MAA 128,48,80
buffer_load_dwordx4 v6, s[24:27], s58 offen offset:1024 lds
MAA 132,52,80
MAA 148,52,84
MAA 152,56,84
MAA 136,56,80
s_waitcnt vmcnt(16) lgkmcnt(8)
s_barrier
MAA 60,20,0
RD 44,30,36992
s_add_u32 m0, s59, 24960
MAA 76,24,0
RD 48,30,39296
s_mov_b32 s58, 1441792
MAA 80,24,4
buffer_load_dwordx4 v5, s[24:27], s58 offen lds
MAA 64,20,4
RD 52,30,41600
s_waitcnt vmcnt(13)
v_add_f32 v164, v164, v192
MAA 68,20,8
RD 56,30,43904
v_add_f32 v165, v165, v193
MAA 84,24,8
TR 64,25,37248
v_add_f32 v166, v166, v194
MAA 88,24,12
buffer_load_dwordx4 v6, s[24:27], s58 offen offset:1024 lds
MAA 72,20,12
TR 66,25,37760
s_add_u32 m0, s59, 74880
s_waitcnt lgkmcnt(6)
MAA 244,20,16
TR 68,25,37280
s_mov_b32 s58, 131072
MAA 104,28,12
TR 70,25,37792
v_add_f32 v167, v167, v195
MAA 120,32,12
buffer_load_dwordx4 v5, s[24:27], s58 offen lds
MAA 116,32,8
RD 60,31,36992
MAA 100,28,8
TR 72,25,38272
MAA 96,28,4
TR 74,25,38784
MAA 112,32,4
buffer_load_dwordx4 v6, s[24:27], s58 offen offset:1024 lds
MAA 108,32,0
TR 76,25,38304
s_add_u32 m0, s59, 83200
MAA 92,28,0
TR 78,25,38816
s_mov_b32 s58, 262144
MAA 156,28,16
TR 80,25,39296
MAA 160,32,16
buffer_load_dwordx4 v5, s[24:27], s58 offen lds
MAA 124,0,36
TR 82,25,39808
MAA 140,0,40
TR 84,25,39328
MAA 144,4,40
TR 86,25,39840
MAA 128,4,36
buffer_load_dwordx4 v6, s[24:27], s58 offen offset:1024 lds
MAA 132,8,36
MAA 148,8,40
MAA 152,12,40
MAA 136,12,36
s_waitcnt vmcnt(15) lgkmcnt(8)
s_barrier
MAA 60,64,44
RD 0,23,55488
s_add_u32 m0, s59, 33280
MAA 76,68,44
RD 4,23,57792
s_mov_b32 s58, 1572864
MAA 80,68,48
buffer_load_dwordx4 v5, s[24:27], s58 offen lds
MAA 64,64,48
RD 8,23,60096
MAA 68,64,52
RD 12,23,62400
MAA 84,68,52
TR 20,25,49664
MAA 88,68,56
buffer_load_dwordx4 v6, s[24:27], s58 offen offset:1024 lds
MAA 72,64,56
TR 22,25,50176
s_add_u32 m0, s59, 41600
s_waitcnt lgkmcnt(6)
MAA 244,64,60
TR 24,25,49696
s_mov_b32 s58, 1703936
MAA 104,72,56
TR 26,25,50208
MAA 120,76,56
buffer_load_dwordx4 v5, s[24:27], s58 offen lds
MAA 116,76,52
RD 16,24,55488
MAA 100,72,52
TR 28,25,50688
MAA 96,72,48
TR 30,25,51200
MAA 112,76,48
buffer_load_dwordx4 v6, s[24:27], s58 offen offset:1024 lds
MAA 108,76,44
TR 32,25,50720
s_add_u32 m0, s59, 91520
MAA 92,72,44
TR 34,25,51232
s_mov_b32 s58, 393216
MAA 156,72,60
TR 36,25,51712
MAA 160,76,60
buffer_load_dwordx4 v5, s[24:27], s58 offen lds
MAA 124,44,80
TR 38,25,52224
MAA 140,44,84
TR 40,25,51744
MAA 144,48,84
TR 42,25,52256
MAA 128,48,80
buffer_load_dwordx4 v6, s[24:27], s58 offen offset:1024 lds
MAA 132,52,80
v_permlane32_swap_b32 v164, v166
MAA 148,52,84
v_permlane32_swap_b32 v165, v167
MAA 152,56,84
v_add_f32 v164, v164, v166
v_add_f32 v165, v165, v167
MAA 136,56,80
v_mul_f32 v164, 0xba800000, v164
v_mul_f32 v165, 0x3a800000, v165
v_fma_f32 v165, -v164, v164, v165
v_max_f32 v165, 0, v165
v_add_f32 v165, 0x3727c5ac, v165
s_waitcnt vmcnt(18) lgkmcnt(8)
s_barrier
MAA 60,20,0
ds_write_b32 v17, v164
s_add_u32 m0, s59, 99840
MAA 76,24,0
RD 44,30,55488
s_mov_b32 s58, 524288
MAA 80,24,4
buffer_load_dwordx4 v5, s[24:27], s58 offen lds
MAA 64,20,4
RD 48,30,57792
MAA 68,20,8
RD 52,30,60096
MAA 84,24,8
RD 56,30,62400
MAA 88,24,12
TR 64,25,62080
MAA 72,20,12
TR 66,25,62592
s_waitcnt lgkmcnt(7)
MAA 244,20,16
buffer_load_dwordx4 v6, s[24:27], s58 offen offset:1024 lds
MAA 104,28,12
TR 68,25,62112
s_add_u32 m0, s59, 108160
MAA 120,32,12
TR 70,25,62624
s_mov_b32 s58, 655360
MAA 116,32,8
RD 60,31,55488
MAA 100,28,8
TR 72,25,63104
MAA 96,28,4
TR 74,25,63616
MAA 112,32,4
buffer_load_dwordx4 v5, s[24:27], s58 offen lds
MAA 108,32,0
TR 76,25,63136
MAA 92,28,0
TR 78,25,63648
MAA 156,28,16
TR 80,25,64128
MAA 160,32,16
TR 82,25,64640
MAA 124,0,36
TR 84,25,64160
MAA 140,0,40
buffer_load_dwordx4 v6, s[24:27], s58 offen offset:1024 lds
MAA 144,4,40
TR 86,25,64672
MAA 128,4,36
v_rsq_f32 v166, v165
MAA 132,8,36
v_mov_b32 v165, v166
v_mul_f32 v166, 0x3e8293ee, v166
MAA 148,8,40
ds_write_b128 v7, v[164:167]
MAA 152,12,40
ds_write_b32 v17, v165 offset:1024
MAA 136,12,36
s_waitcnt lgkmcnt(0)
s_barrier
MAA 244,64,60
ds_read_b128 v[232:235], v10 offset:768
MAA 156,72,60
ds_read_b128 v[236:239], v10 offset:2816
MAA 160,76,60
ds_read_b128 v[228:231], v10 offset:512
MAA 104,72,56
ds_read_b128 v[224:227], v10 offset:256
MAA 120,76,56
ds_read_b128 v[220:223], v10
MAA 136,56,80
MAA 152,56,84
MAA 100,72,52
MAA 116,76,52
s_mov_b32 exec_lo, 0x10001
s_mov_b32 exec_hi, 0x10001
ds_write_b128 v13, v[244:247]
ds_write_b128 v13, v[156:159] offset:256
ds_write_b128 v13, v[160:163] offset:320
s_mov_b64 exec, -1
MAA 96,72,48
MAA 112,76,48
MAA 92,72,44
MAA 108,76,44
MAA 72,64,56
MAA 88,68,56
s_waitcnt lgkmcnt(0)
s_barrier
MAA 132,52,80
ds_read_b128 v[28:31], v13
s_add_u32 m0, s59, 49920
MAA 148,52,84
ds_read_b128 v[32:35], v13 offset:64
s_mov_b32 s58, 1835008
MAA 68,64,52
ds_read_b128 v[36:39], v13 offset:256
MAA 84,68,52
ds_read_b128 v[40:43], v13 offset:320
MAA 128,48,80
ds_read_b32 v44, v12 offset:512
MAA 144,48,84
ds_read_b32 v45, v12 offset:576
MAA 64,64,48
ds_read_b128 v[240:243], v11 offset:192
MAA 80,68,48
ds_read_b128 v[244:247], v11 offset:1216
MAA 124,44,80
buffer_load_dwordx4 v5, s[24:27], s58 offen lds
ds_read_b128 v[18:21], v11 offset:128
s_waitcnt lgkmcnt(8)
v_pk_fma_f32 v[72:73], v[28:29], v[232:233], v[72:73] op_sel_hi:[1,0,1]
v_pk_fma_f32 v[74:75], v[30:31], v[232:233], v[74:75] op_sel_hi:[1,0,1]
s_waitcnt lgkmcnt(6)
v_pk_fma_f32 v[104:105], v[36:37], v[232:233], v[104:105] op_sel_hi:[1,0,1]
v_pk_mul_f32 v[104:105], v[104:105], v[232:233] op_sel:[0,1] op_sel_hi:[1,1]
v_pk_fma_f32 v[106:107], v[38:39], v[232:233], v[106:107] op_sel_hi:[1,0,1]
v_pk_mul_f32 v[106:107], v[106:107], v[232:233] op_sel:[0,1] op_sel_hi:[1,1]
s_waitcnt lgkmcnt(5)
v_pk_fma_f32 v[120:121], v[40:41], v[232:233], v[120:121] op_sel_hi:[1,0,1]
v_pk_mul_f32 v[120:121], v[120:121], v[232:233] op_sel:[0,1] op_sel_hi:[1,1]
v_pk_fma_f32 v[122:123], v[42:43], v[232:233], v[122:123] op_sel_hi:[1,0,1]
v_pk_mul_f32 v[122:123], v[122:123], v[232:233] op_sel:[0,1] op_sel_hi:[1,1]
v_pk_fma_f32 v[100:101], v[36:37], v[228:229], v[100:101] op_sel_hi:[1,0,1]
v_pk_mul_f32 v[100:101], v[100:101], v[228:229] op_sel:[0,1] op_sel_hi:[1,1]
v_pk_fma_f32 v[102:103], v[38:39], v[228:229], v[102:103] op_sel_hi:[1,0,1]
v_pk_mul_f32 v[102:103], v[102:103], v[228:229] op_sel:[0,1] op_sel_hi:[1,1]
v_pk_fma_f32 v[116:117], v[40:41], v[228:229], v[116:117] op_sel_hi:[1,0,1]
v_pk_mul_f32 v[116:117], v[116:117], v[228:229] op_sel:[0,1] op_sel_hi:[1,1]
v_pk_fma_f32 v[118:119], v[42:43], v[228:229], v[118:119] op_sel_hi:[1,0,1]
v_pk_mul_f32 v[118:119], v[118:119], v[228:229] op_sel:[0,1] op_sel_hi:[1,1]
s_waitcnt lgkmcnt(2)
v_pk_fma_f32 v[136:137], v[240:241], v[44:45], v[136:137] op_sel_hi:[1,0,1]
v_pk_fma_f32 v[138:139], v[242:243], v[44:45], v[138:139] op_sel_hi:[1,0,1]
v_pk_fma_f32 v[152:153], v[240:241], v[44:45], v[152:153] op_sel:[0,1,0] op_sel_hi:[1,1,1]
v_pk_fma_f32 v[154:155], v[242:243], v[44:45], v[154:155] op_sel:[0,1,0] op_sel_hi:[1,1,1]
s_waitcnt lgkmcnt(1)
v_pk_mul_f32 v[136:137], v[136:137], v[244:245]
v_pk_mul_f32 v[138:139], v[138:139], v[246:247]
v_pk_mul_f32 v[152:153], v[152:153], v[244:245]
v_pk_mul_f32 v[154:155], v[154:155], v[246:247]
v_pk_fma_f32 v[88:89], v[32:33], v[232:233], v[88:89] op_sel_hi:[1,0,1]
v_pk_fma_f32 v[90:91], v[34:35], v[232:233], v[90:91] op_sel_hi:[1,0,1]
v_pk_fma_f32 v[96:97], v[36:37], v[224:225], v[96:97] op_sel_hi:[1,0,1]
s_waitcnt lgkmcnt(0)
v_pk_fma_f32 v[132:133], v[18:19], v[44:45], v[132:133] op_sel_hi:[1,0,1]
v_pk_fma_f32 v[134:135], v[20:21], v[44:45], v[134:135] op_sel_hi:[1,0,1]
v_pk_fma_f32 v[148:149], v[18:19], v[44:45], v[148:149] op_sel:[0,1,0] op_sel_hi:[1,1,1]
v_pk_fma_f32 v[150:151], v[20:21], v[44:45], v[150:151] op_sel:[0,1,0] op_sel_hi:[1,1,1]
v_pk_mul_f32 v[96:97], v[96:97], v[224:225] op_sel:[0,1] op_sel_hi:[1,1]
v_pk_fma_f32 v[98:99], v[38:39], v[224:225], v[98:99] op_sel_hi:[1,0,1]
v_pk_mul_f32 v[98:99], v[98:99], v[224:225] op_sel:[0,1] op_sel_hi:[1,1]
v_pk_fma_f32 v[112:113], v[40:41], v[224:225], v[112:113] op_sel_hi:[1,0,1]
v_pk_mul_f32 v[112:113], v[112:113], v[224:225] op_sel:[0,1] op_sel_hi:[1,1]
v_pk_fma_f32 v[114:115], v[42:43], v[224:225], v[114:115] op_sel_hi:[1,0,1]
v_pk_mul_f32 v[114:115], v[114:115], v[224:225] op_sel:[0,1] op_sel_hi:[1,1]
v_pk_fma_f32 v[68:69], v[28:29], v[228:229], v[68:69] op_sel_hi:[1,0,1]
v_pk_fma_f32 v[70:71], v[30:31], v[228:229], v[70:71] op_sel_hi:[1,0,1]
v_pk_fma_f32 v[84:85], v[32:33], v[228:229], v[84:85] op_sel_hi:[1,0,1]
v_pk_fma_f32 v[86:87], v[34:35], v[228:229], v[86:87] op_sel_hi:[1,0,1]
v_pk_fma_f32 v[92:93], v[36:37], v[220:221], v[92:93] op_sel_hi:[1,0,1]
v_pk_mul_f32 v[92:93], v[92:93], v[220:221] op_sel:[0,1] op_sel_hi:[1,1]
v_pk_fma_f32 v[94:95], v[38:39], v[220:221], v[94:95] op_sel_hi:[1,0,1]
v_pk_mul_f32 v[94:95], v[94:95], v[220:221] op_sel:[0,1] op_sel_hi:[1,1]
v_pk_fma_f32 v[108:109], v[40:41], v[220:221], v[108:109] op_sel_hi:[1,0,1]
v_pk_mul_f32 v[108:109], v[108:109], v[220:221] op_sel:[0,1] op_sel_hi:[1,1]
v_pk_fma_f32 v[110:111], v[42:43], v[220:221], v[110:111] op_sel_hi:[1,0,1]
v_pk_mul_f32 v[110:111], v[110:111], v[220:221] op_sel:[0,1] op_sel_hi:[1,1]
v_pk_fma_f32 v[64:65], v[28:29], v[224:225], v[64:65] op_sel_hi:[1,0,1]
v_pk_fma_f32 v[66:67], v[30:31], v[224:225], v[66:67] op_sel_hi:[1,0,1]
v_pk_fma_f32 v[80:81], v[32:33], v[224:225], v[80:81] op_sel_hi:[1,0,1]
v_pk_fma_f32 v[82:83], v[34:35], v[224:225], v[82:83] op_sel_hi:[1,0,1]
v_pk_fma_f32 v[156:157], v[36:37], v[236:237], v[156:157] op_sel_hi:[1,0,1]
v_pk_mul_f32 v[156:157], v[156:157], v[236:237] op_sel:[0,1] op_sel_hi:[1,1]
v_pk_fma_f32 v[158:159], v[38:39], v[236:237], v[158:159] op_sel_hi:[1,0,1]
v_pk_mul_f32 v[158:159], v[158:159], v[236:237] op_sel:[0,1] op_sel_hi:[1,1]
v_pk_fma_f32 v[160:161], v[40:41], v[236:237], v[160:161] op_sel_hi:[1,0,1]
v_pk_mul_f32 v[160:161], v[160:161], v[236:237] op_sel:[0,1] op_sel_hi:[1,1]
v_pk_fma_f32 v[162:163], v[42:43], v[236:237], v[162:163] op_sel_hi:[1,0,1]
v_pk_mul_f32 v[162:163], v[162:163], v[236:237] op_sel:[0,1] op_sel_hi:[1,1]
v_cvt_pk_bf16_f32 v196, v104, v105
v_cvt_pk_bf16_f32 v197, v106, v107
MAA 140,44,84
buffer_load_dwordx4 v6, s[24:27], s58 offen offset:1024 lds
MAA 60,64,44
ds_read_b128 v[22:25], v11 offset:1152
v_cvt_pk_bf16_f32 v198, v120, v121
MAA 76,68,44
ds_read_b128 v[240:243], v11 offset:64
v_cvt_pk_bf16_f32 v199, v122, v123
v_cvt_pk_bf16_f32 v208, v136, v137
v_cvt_pk_bf16_f32 v209, v138, v139
v_cvt_pk_bf16_f32 v218, v152, v153
v_cvt_pk_bf16_f32 v219, v154, v155
ds_write_b128 v8, v[196:199]
ds_write_b64 v8, v[208:209] offset:1024
ds_write_b64 v8, v[218:219] offset:1032
s_add_u32 m0, s59, 58240
s_mov_b32 s58, 1966080
buffer_load_dwordx4 v5, s[24:27], s58 offen lds
v_cvt_pk_bf16_f32 v192, v100, v101
v_cvt_pk_bf16_f32 v193, v102, v103
v_cvt_pk_bf16_f32 v194, v116, v117
v_cvt_pk_bf16_f32 v195, v118, v119
v_cvt_pk_bf16_f32 v176, v72, v73
v_cvt_pk_bf16_f32 v177, v74, v75
v_cvt_pk_bf16_f32 v178, v88, v89
v_cvt_pk_bf16_f32 v179, v90, v91
v_pk_fma_f32 v[60:61], v[28:29], v[220:221], v[60:61] op_sel_hi:[1,0,1]
v_pk_fma_f32 v[62:63], v[30:31], v[220:221], v[62:63] op_sel_hi:[1,0,1]
s_waitcnt lgkmcnt(4)
v_pk_mul_f32 v[132:133], v[132:133], v[22:23]
v_pk_mul_f32 v[134:135], v[134:135], v[24:25]
v_pk_mul_f32 v[148:149], v[148:149], v[22:23]
v_pk_mul_f32 v[150:151], v[150:151], v[24:25]
s_waitcnt lgkmcnt(3)
v_pk_fma_f32 v[128:129], v[240:241], v[44:45], v[128:129] op_sel_hi:[1,0,1]
v_pk_fma_f32 v[130:131], v[242:243], v[44:45], v[130:131] op_sel_hi:[1,0,1]
v_pk_fma_f32 v[144:145], v[240:241], v[44:45], v[144:145] op_sel:[0,1,0] op_sel_hi:[1,1,1]
v_pk_fma_f32 v[146:147], v[242:243], v[44:45], v[146:147] op_sel:[0,1,0] op_sel_hi:[1,1,1]
v_pk_fma_f32 v[76:77], v[32:33], v[220:221], v[76:77] op_sel_hi:[1,0,1]
v_pk_fma_f32 v[78:79], v[34:35], v[220:221], v[78:79] op_sel_hi:[1,0,1]
v_cvt_pk_bf16_f32 v206, v132, v133
v_cvt_pk_bf16_f32 v207, v134, v135
v_mfma_f32_16x16x32_bf16 v[104:107], v[192:195], v[176:179], v[46:49]
buffer_load_dwordx4 v6, s[24:27], s58 offen offset:1024 lds
v_mfma_f32_16x16x32_bf16 v[120:123], v[196:199], v[176:179], v[50:53]
s_waitcnt lgkmcnt(0)
s_barrier
ds_read_b64 v[200:201], v9 offset:1024
ds_read_b64 v[210:211], v9 offset:1032
s_add_u32 m0, s59, 66560
s_mov_b32 s58, 0
v_cvt_pk_bf16_f32 v216, v148, v149
v_cvt_pk_bf16_f32 v217, v150, v151
v_max3_f32 v88, v104, v105, v106
v_max3_f32 v89, v107, v120, v121
v_max3_f32 v88, v88, v122, v123
buffer_load_dwordx4 v5, s[24:27], s58 offen lds
v_max_f32 v90, v88, v89
v_max_f32 v89, v88, v89
v_cvt_pk_bf16_f32 v188, v96, v97
v_cvt_pk_bf16_f32 v189, v98, v99
v_permlane16_swap_b32 v90, v89
v_cvt_pk_bf16_f32 v190, v112, v113
v_max_f32 v88, v90, v89
v_max_f32 v89, v90, v89
v_cvt_pk_bf16_f32 v191, v114, v115
v_cvt_pk_bf16_f32 v172, v68, v69
v_permlane32_swap_b32 v88, v89
v_cvt_pk_bf16_f32 v173, v70, v71
buffer_load_dwordx4 v6, s[24:27], s58 offen offset:1024 lds
s_add_u32 m0, s59, 116480
s_mov_b32 s58, 786432
v_max_f32 v88, v88, v89
v_mul_f32 v88, v88, v234
v_pk_fma_f32 v[104:105], v[104:105], v[234:235], v[88:89] op_sel_hi:[1,0,0] neg_lo:[0,0,1] neg_hi:[0,0,1]
v_pk_fma_f32 v[106:107], v[106:107], v[234:235], v[88:89] op_sel_hi:[1,0,0] neg_lo:[0,0,1] neg_hi:[0,0,1]
v_pk_fma_f32 v[120:121], v[120:121], v[234:235], v[88:89] op_sel_hi:[1,0,0] neg_lo:[0,0,1] neg_hi:[0,0,1]
v_pk_fma_f32 v[122:123], v[122:123], v[234:235], v[88:89] op_sel_hi:[1,0,0] neg_lo:[0,0,1] neg_hi:[0,0,1]
v_exp_f32 v104, v104
v_exp_f32 v105, v105
v_exp_f32 v106, v106
v_exp_f32 v107, v107
v_exp_f32 v120, v120
v_exp_f32 v121, v121
v_exp_f32 v122, v122
v_exp_f32 v123, v123
v_cvt_pk_bf16_f32 v72, v104, v105
buffer_load_dwordx4 v5, s[24:27], s58 offen lds
v_cvt_pk_bf16_f32 v73, v106, v107
v_cvt_pk_bf16_f32 v74, v120, v121
v_cvt_pk_bf16_f32 v75, v122, v123
v_cvt_pk_bf16_f32 v174, v84, v85
v_cvt_pk_bf16_f32 v175, v86, v87
v_mfma_f32_16x16x32_bf16 v[88:91], v[248:251], v[72:75], 0
ds_read_b128 v[244:247], v11 offset:1088
v_cvt_pk_bf16_f32 v184, v92, v93
v_mfma_f32_16x16x32_bf16 v[104:107], v[206:209], v[72:75], 0
ds_read_b128 v[18:21], v11
v_cvt_pk_bf16_f32 v185, v94, v95
v_mfma_f32_16x16x32_bf16 v[120:123], v[216:219], v[72:75], 0
buffer_load_dwordx4 v6, s[24:27], s58 offen offset:1024 lds
v_mfma_f32_16x16x32_bf16 v[100:103], v[188:191], v[172:175], v[46:49]
ds_read_b128 v[22:25], v11 offset:1024
s_add_u32 m0, s59, 124800
v_mfma_f32_16x16x32_bf16 v[116:119], v[192:195], v[172:175], v[50:53]
s_mov_b32 s58, 917504
v_rcp_f32 v88, v88
v_cvt_pk_bf16_f32 v186, v108, v109
s_nop 1
v_max3_f32 v84, v100, v101, v102
v_cvt_pk_bf16_f32 v187, v110, v111
v_pk_mul_f32 v[104:105], v[104:105], v[88:89] op_sel_hi:[1,0]
v_pk_mul_f32 v[106:107], v[106:107], v[88:89] op_sel_hi:[1,0]
buffer_load_dwordx4 v5, s[24:27], s58 offen lds
v_pk_mul_f32 v[120:121], v[120:121], v[88:89] op_sel_hi:[1,0]
v_pk_mul_f32 v[122:123], v[122:123], v[88:89] op_sel_hi:[1,0]
v_cvt_pk_bf16_f32 v176, v104, v105
v_cvt_pk_bf16_f32 v177, v106, v107
v_cvt_pk_bf16_f32 v178, v120, v121
v_cvt_pk_bf16_f32 v179, v122, v123
s_waitcnt lgkmcnt(2)
v_pk_mul_f32 v[128:129], v[128:129], v[244:245]
v_cvt_pk_bf16_f32 v204, v128, v129
v_pk_mul_f32 v[130:131], v[130:131], v[246:247]
v_cvt_pk_bf16_f32 v205, v130, v131
v_pk_mul_f32 v[144:145], v[144:145], v[244:245]
v_cvt_pk_bf16_f32 v214, v144, v145
v_pk_mul_f32 v[146:147], v[146:147], v[246:247]
buffer_load_dwordx4 v6, s[24:27], s58 offen offset:1024 lds
v_cvt_pk_bf16_f32 v215, v146, v147
v_max3_f32 v85, v103, v116, v117
v_max3_f32 v84, v84, v118, v119
v_max_f32 v86, v84, v85
v_max_f32 v85, v84, v85
v_cvt_pk_bf16_f32 v168, v64, v65
v_cvt_pk_bf16_f32 v169, v66, v67
v_permlane16_swap_b32 v86, v85
v_cvt_pk_bf16_f32 v170, v80, v81
v_max_f32 v84, v86, v85
v_max_f32 v85, v86, v85
v_cvt_pk_bf16_f32 v171, v82, v83
s_waitcnt lgkmcnt(1)
v_pk_fma_f32 v[124:125], v[18:19], v[44:45], v[124:125] op_sel_hi:[1,0,1]
s_waitcnt lgkmcnt(0)
v_pk_mul_f32 v[124:125], v[124:125], v[22:23]
v_pk_fma_f32 v[126:127], v[20:21], v[44:45], v[126:127] op_sel_hi:[1,0,1]
v_pk_mul_f32 v[126:127], v[126:127], v[24:25]
v_pk_fma_f32 v[140:141], v[18:19], v[44:45], v[140:141] op_sel:[0,1,0] op_sel_hi:[1,1,1]
v_pk_mul_f32 v[140:141], v[140:141], v[22:23]
v_pk_fma_f32 v[142:143], v[20:21], v[44:45], v[142:143] op_sel:[0,1,0] op_sel_hi:[1,1,1]
v_pk_mul_f32 v[142:143], v[142:143], v[24:25]
v_permlane32_swap_b32 v84, v85
s_nop 0
v_mfma_f32_16x16x32_bf16 v[96:99], v[184:187], v[168:171], v[46:49]
buffer_store_dwordx4 v[176:179], v4, s[16:19], s74 offen offset:3072 sc1
v_mfma_f32_16x16x32_bf16 v[112:115], v[188:191], v[168:171], v[50:53]
v_max_f32 v84, v84, v85
v_mul_f32 v84, v84, v230
v_cvt_pk_bf16_f32 v202, v124, v125
v_cvt_pk_bf16_f32 v203, v126, v127
v_cvt_pk_bf16_f32 v212, v140, v141
v_pk_fma_f32 v[100:101], v[100:101], v[230:231], v[84:85] op_sel_hi:[1,0,0] neg_lo:[0,0,1] neg_hi:[0,0,1]
v_pk_fma_f32 v[102:103], v[102:103], v[230:231], v[84:85] op_sel_hi:[1,0,0] neg_lo:[0,0,1] neg_hi:[0,0,1]
v_pk_fma_f32 v[116:117], v[116:117], v[230:231], v[84:85] op_sel_hi:[1,0,0] neg_lo:[0,0,1] neg_hi:[0,0,1]
v_pk_fma_f32 v[118:119], v[118:119], v[230:231], v[84:85] op_sel_hi:[1,0,0] neg_lo:[0,0,1] neg_hi:[0,0,1]
v_exp_f32 v100, v100
v_exp_f32 v101, v101
v_exp_f32 v102, v102
v_exp_f32 v103, v103
v_exp_f32 v116, v116
v_exp_f32 v117, v117
v_exp_f32 v118, v118
v_exp_f32 v119, v119
v_cvt_pk_bf16_f32 v68, v100, v101
v_cvt_pk_bf16_f32 v69, v102, v103
v_cvt_pk_bf16_f32 v70, v116, v117
v_cvt_pk_bf16_f32 v71, v118, v119
v_cvt_pk_bf16_f32 v213, v142, v143
v_max3_f32 v80, v96, v97, v98
v_mfma_f32_16x16x32_bf16 v[84:87], v[248:251], v[68:71], 0
v_max3_f32 v81, v99, v112, v113
v_max3_f32 v80, v80, v114, v115
v_mfma_f32_16x16x32_bf16 v[100:103], v[204:207], v[68:71], 0
v_max_f32 v82, v80, v81
v_max_f32 v81, v80, v81
v_mfma_f32_16x16x32_bf16 v[116:119], v[214:217], v[68:71], 0
s_nop 1
v_rcp_f32 v84, v84
v_permlane16_swap_b32 v82, v81
v_cvt_pk_bf16_f32 v180, v156, v157
v_pk_mul_f32 v[100:101], v[100:101], v[84:85] op_sel_hi:[1,0]
v_pk_mul_f32 v[102:103], v[102:103], v[84:85] op_sel_hi:[1,0]
s_nop 0
v_pk_mul_f32 v[116:117], v[116:117], v[84:85] op_sel_hi:[1,0]
v_pk_mul_f32 v[118:119], v[118:119], v[84:85] op_sel_hi:[1,0]
v_cvt_pk_bf16_f32 v172, v100, v101
v_cvt_pk_bf16_f32 v173, v102, v103
v_cvt_pk_bf16_f32 v174, v116, v117
v_cvt_pk_bf16_f32 v175, v118, v119
buffer_store_dwordx4 v[172:175], v4, s[16:19], s74 offen offset:2048 sc1
v_max_f32 v80, v82, v81
v_max_f32 v81, v82, v81
v_cvt_pk_bf16_f32 v181, v158, v159
v_cvt_pk_bf16_f32 v182, v160, v161
v_permlane32_swap_b32 v80, v81
v_cvt_pk_bf16_f32 v183, v162, v163
v_max_f32 v80, v80, v81
v_mul_f32 v80, v80, v226
v_pk_fma_f32 v[96:97], v[96:97], v[226:227], v[80:81] op_sel_hi:[1,0,0] neg_lo:[0,0,1] neg_hi:[0,0,1]
v_pk_fma_f32 v[98:99], v[98:99], v[226:227], v[80:81] op_sel_hi:[1,0,0] neg_lo:[0,0,1] neg_hi:[0,0,1]
v_pk_fma_f32 v[112:113], v[112:113], v[226:227], v[80:81] op_sel_hi:[1,0,0] neg_lo:[0,0,1] neg_hi:[0,0,1]
v_pk_fma_f32 v[114:115], v[114:115], v[226:227], v[80:81] op_sel_hi:[1,0,0] neg_lo:[0,0,1] neg_hi:[0,0,1]
v_exp_f32 v96, v96
v_exp_f32 v97, v97
v_exp_f32 v98, v98
v_exp_f32 v99, v99
v_exp_f32 v112, v112
v_exp_f32 v113, v113
v_exp_f32 v114, v114
v_exp_f32 v115, v115
v_cvt_pk_bf16_f32 v64, v96, v97
v_cvt_pk_bf16_f32 v65, v98, v99
v_cvt_pk_bf16_f32 v66, v112, v113
v_cvt_pk_bf16_f32 v67, v114, v115
v_cvt_pk_bf16_f32 v164, v60, v61
v_cvt_pk_bf16_f32 v165, v62, v63
v_mfma_f32_16x16x32_bf16 v[80:83], v[248:251], v[64:67], 0
v_cvt_pk_bf16_f32 v166, v76, v77
v_cvt_pk_bf16_f32 v167, v78, v79
v_mfma_f32_16x16x32_bf16 v[96:99], v[202:205], v[64:67], 0
v_mfma_f32_16x16x32_bf16 v[112:115], v[212:215], v[64:67], 0
s_nop 3
v_rcp_f32 v80, v80
v_mfma_f32_16x16x32_bf16 v[92:95], v[180:183], v[164:167], v[54:57]
v_mfma_f32_16x16x32_bf16 v[108:111], v[184:187], v[164:167], v[50:53]
s_nop 6
v_max3_f32 v76, v92, v93, v94
v_pk_mul_f32 v[96:97], v[96:97], v[80:81] op_sel_hi:[1,0]
v_pk_mul_f32 v[98:99], v[98:99], v[80:81] op_sel_hi:[1,0]
v_pk_mul_f32 v[112:113], v[112:113], v[80:81] op_sel_hi:[1,0]
v_pk_mul_f32 v[114:115], v[114:115], v[80:81] op_sel_hi:[1,0]
v_cvt_pk_bf16_f32 v168, v96, v97
v_cvt_pk_bf16_f32 v169, v98, v99
v_cvt_pk_bf16_f32 v170, v112, v113
v_cvt_pk_bf16_f32 v171, v114, v115
buffer_store_dwordx4 v[168:171], v4, s[16:19], s74 offen offset:1024 sc1
v_max3_f32 v77, v95, v108, v109
v_max3_f32 v76, v76, v110, v111
v_max_f32 v78, v76, v77
v_max_f32 v77, v76, v77
s_nop 1
v_permlane16_swap_b32 v78, v77
v_max_f32 v76, v78, v77
v_max_f32 v77, v78, v77
s_nop 1
v_permlane32_swap_b32 v76, v77
v_max_f32 v76, v76, v77
v_mul_f32 v76, v76, v222
v_pk_fma_f32 v[92:93], v[92:93], v[222:223], v[76:77] op_sel_hi:[1,0,0] neg_lo:[0,0,1] neg_hi:[0,0,1]
v_pk_fma_f32 v[94:95], v[94:95], v[222:223], v[76:77] op_sel_hi:[1,0,0] neg_lo:[0,0,1] neg_hi:[0,0,1]
v_pk_fma_f32 v[108:109], v[108:109], v[222:223], v[76:77] op_sel_hi:[1,0,0] neg_lo:[0,0,1] neg_hi:[0,0,1]
v_pk_fma_f32 v[110:111], v[110:111], v[222:223], v[76:77] op_sel_hi:[1,0,0] neg_lo:[0,0,1] neg_hi:[0,0,1]
v_exp_f32 v92, v92
v_exp_f32 v93, v93
v_exp_f32 v94, v94
v_exp_f32 v95, v95
v_exp_f32 v108, v108
v_exp_f32 v109, v109
v_exp_f32 v110, v110
v_exp_f32 v111, v111
v_cvt_pk_bf16_f32 v60, v92, v93
v_cvt_pk_bf16_f32 v61, v94, v95
v_cvt_pk_bf16_f32 v62, v108, v109
v_cvt_pk_bf16_f32 v63, v110, v111
s_nop 1
v_mfma_f32_16x16x32_bf16 v[76:79], v[248:251], v[60:63], 0
v_mfma_f32_16x16x32_bf16 v[92:95], v[200:203], v[60:63], 0
v_mfma_f32_16x16x32_bf16 v[108:111], v[210:213], v[60:63], 0
s_nop 5
v_rcp_f32 v76, v76
s_nop 0
v_pk_mul_f32 v[92:93], v[92:93], v[76:77] op_sel_hi:[1,0]
v_pk_mul_f32 v[94:95], v[94:95], v[76:77] op_sel_hi:[1,0]
v_pk_mul_f32 v[108:109], v[108:109], v[76:77] op_sel_hi:[1,0]
v_pk_mul_f32 v[110:111], v[110:111], v[76:77] op_sel_hi:[1,0]
v_cvt_pk_bf16_f32 v164, v92, v93
v_cvt_pk_bf16_f32 v165, v94, v95
v_cvt_pk_bf16_f32 v166, v108, v109
v_cvt_pk_bf16_f32 v167, v110, v111
buffer_store_dwordx4 v[164:167], v4, s[16:19], s74 offen sc1
s_nop 1
s_branch .Lqkve3
.Lx4:
buffer_load_dword v27, v14, s[76:79], 0 offen
s_mov_b32 s76, s98
s_mov_b32 s77, s99
s_mov_b32 s78, s100
v_mov_b32 v14, v15
s_mov_b32 s47, 5
s_branch .Lx4b
.Lx5:
buffer_load_dword v27, v14, s[76:79], 0 offen
s_mov_b32 s76, s98
s_mov_b32 s77, s99
s_mov_b32 s78, s100
v_mov_b32 v14, v15
s_mov_b32 s47, 5
s_branch .Lx5b
.Lx6:
buffer_load_dword v27, v14, s[76:79], 0 offen
s_mov_b32 s76, s98
s_mov_b32 s77, s99
s_mov_b32 s78, s100
v_mov_b32 v14, v15
s_mov_b32 s47, 5
s_branch .Lx6b
.Lx7:
buffer_load_dword v27, v14, s[76:79], 0 offen
s_mov_b32 s76, s98
s_mov_b32 s77, s99
s_mov_b32 s78, s100
v_mov_b32 v14, v15
s_mov_b32 s47, 5
s_branch .Lx7b
.Lsp8:
s_mov_b32 s15, 0
.Lsp8l:
v_mov_b32 v37, 0
buffer_atomic_add v37, v34, s[40:43], 0 offen sc0
s_add_u32 s15, s15, 1
s_cmp_gt_u32 s15, 100000
s_waitcnt vmcnt(0)
s_cbranch_scc1 .Lsp8b
v_cmp_gt_u32 vcc, v35, v37
s_nop 0
s_cbranch_vccnz .Lsp8l
s_branch .Lsp8b
.Lx9:
buffer_load_dword v27, v14, s[76:79], 0 offen
s_mov_b32 s76, s98
s_mov_b32 s77, s99
s_mov_b32 s78, s100
v_mov_b32 v14, v15
s_mov_b32 s47, 5
s_branch .Lx9b
.Lx10:
buffer_load_dword v27, v14, s[76:79], 0 offen
s_mov_b32 s76, s98
s_mov_b32 s77, s99
s_mov_b32 s78, s100
v_mov_b32 v14, v15
s_mov_b32 s47, 5
s_branch .Lx10b
.Lx11:
buffer_load_dword v27, v14, s[76:79], 0 offen
s_mov_b32 s76, s98
s_mov_b32 s77, s99
s_mov_b32 s78, s100
v_mov_b32 v14, v15
s_mov_b32 s47, 5
s_branch .Lx11b
.Lx12:
buffer_load_dword v27, v14, s[76:79], 0 offen
s_mov_b32 s76, s98
s_mov_b32 s77, s99
s_mov_b32 s78, s100
v_mov_b32 v14, v15
s_mov_b32 s47, 5
s_branch .Lx12b
.Lx13:
buffer_load_dword v27, v14, s[76:79], 0 offen
s_mov_b32 s76, s98
s_mov_b32 s77, s99
s_mov_b32 s78, s100
v_mov_b32 v14, v15
s_mov_b32 s47, 5
s_branch .Lx13b
.Lsp14:
s_mov_b32 s15, 0
.Lsp14l:
v_mov_b32 v37, 0
buffer_atomic_add v37, v33, s[16:19], 0 offen sc0
s_add_u32 s15, s15, 1
s_cmp_gt_u32 s15, 100000
s_waitcnt vmcnt(0)
s_cbranch_scc1 .Lsp14b
v_cmp_gt_u32 vcc, v36, v37
s_nop 0
s_cbranch_vccnz .Lsp14l
s_branch .Lsp14b
.Lx15:
buffer_load_dword v27, v14, s[76:79], 0 offen
s_mov_b32 s76, s98
s_mov_b32 s77, s99
s_mov_b32 s78, s100
v_mov_b32 v14, v15
s_mov_b32 s47, 5
s_branch .Lx15b
.Lx16:
buffer_load_dword v27, v14, s[76:79], 0 offen
s_mov_b32 s76, s98
s_mov_b32 s77, s99
s_mov_b32 s78, s100
v_mov_b32 v14, v15
s_mov_b32 s47, 5
s_branch .Lx16b
.Lx17:
buffer_load_dword v27, v14, s[76:79], 0 offen
s_mov_b32 s76, s98
s_mov_b32 s77, s99
s_mov_b32 s78, s100
v_mov_b32 v14, v15
s_mov_b32 s47, 5
s_branch .Lx17b
.Lx18:
buffer_load_dword v27, v14, s[76:79], 0 offen
s_mov_b32 s76, s98
s_mov_b32 s77, s99
s_mov_b32 s78, s100
v_mov_b32 v14, v15
s_mov_b32 s47, 5
s_branch .Lx18b
.Lx19:
buffer_load_dword v27, v14, s[76:79], 0 offen
s_mov_b32 s76, s98
s_mov_b32 s77, s99
s_mov_b32 s78, s100
v_mov_b32 v14, v15
s_mov_b32 s47, 5
s_branch .Lx19b
.Lx20:
buffer_load_dword v27, v14, s[76:79], 0 offen
s_mov_b32 s76, s98
s_mov_b32 s77, s99
s_mov_b32 s78, s100
v_mov_b32 v14, v15
s_mov_b32 s47, 5
s_branch .Lx20b
.Lx21:
buffer_load_dword v27, v14, s[76:79], 0 offen
s_mov_b32 s76, s98
s_mov_b32 s77, s99
s_mov_b32 s78, s100
v_mov_b32 v14, v15
s_mov_b32 s47, 5
s_branch .Lx21b
.Lsp22:
s_mov_b32 s15, 0
.Lsp22l:
v_mov_b32 v37, 0
buffer_atomic_add v37, v34, s[40:43], 0 offen sc0
s_add_u32 s15, s15, 1
s_cmp_gt_u32 s15, 100000
s_waitcnt vmcnt(0)
s_cbranch_scc1 .Lsp22b
v_cmp_gt_u32 vcc, v35, v37
s_nop 0
s_cbranch_vccnz .Lsp22l
s_branch .Lsp22b
.Lx23:
buffer_load_dword v27, v14, s[76:79], 0 offen
s_mov_b32 s76, s98
s_mov_b32 s77, s99
s_mov_b32 s78, s100
v_mov_b32 v14, v15
s_mov_b32 s47, 5
s_branch .Lx23b
.Lx24:
buffer_load_dword v27, v14, s[76:79], 0 offen
s_mov_b32 s76, s98
s_mov_b32 s77, s99
s_mov_b32 s78, s100
v_mov_b32 v14, v15
s_mov_b32 s47, 5
s_branch .Lx24b
.Lx25:
buffer_load_dword v27, v14, s[76:79], 0 offen
s_mov_b32 s76, s98
s_mov_b32 s77, s99
s_mov_b32 s78, s100
v_mov_b32 v14, v15
s_mov_b32 s47, 5
s_branch .Lx25b
.Lx26:
buffer_load_dword v27, v14, s[76:79], 0 offen
s_mov_b32 s76, s98
s_mov_b32 s77, s99
s_mov_b32 s78, s100
v_mov_b32 v14, v15
s_mov_b32 s47, 5
s_branch .Lx26b
.Lx27:
buffer_load_dword v27, v14, s[76:79], 0 offen
s_mov_b32 s76, s98
s_mov_b32 s77, s99
s_mov_b32 s78, s100
v_mov_b32 v14, v15
s_mov_b32 s47, 5
s_branch .Lx27b
.Lsp28:
s_mov_b32 s15, 0
.Lsp28l:
v_mov_b32 v37, 0
buffer_atomic_add v37, v33, s[16:19], 0 offen sc0
s_add_u32 s15, s15, 1
s_cmp_gt_u32 s15, 100000
s_waitcnt vmcnt(0)
s_cbranch_scc1 .Lsp28b
v_cmp_gt_u32 vcc, v36, v37
s_nop 0
s_cbranch_vccnz .Lsp28l
s_branch .Lsp28b
.Lx29:
buffer_load_dword v27, v14, s[76:79], 0 offen
s_mov_b32 s76, s98
s_mov_b32 s77, s99
s_mov_b32 s78, s100
v_mov_b32 v14, v15
s_mov_b32 s47, 5
s_branch .Lx29b
.Lx30:
buffer_load_dword v27, v14, s[76:79], 0 offen
s_mov_b32 s76, s98
s_mov_b32 s77, s99
s_mov_b32 s78, s100
v_mov_b32 v14, v15
s_mov_b32 s47, 5
s_branch .Lx30b
.Lx31:
buffer_load_dword v27, v14, s[76:79], 0 offen
s_mov_b32 s76, s98
s_mov_b32 s77, s99
s_mov_b32 s78, s100
v_mov_b32 v14, v15
s_mov_b32 s47, 5
s_branch .Lx31b
.Lqkv2:
s_add_u32 m0, s55, 0
s_nop 0
buffer_load_dwordx4 v21, s[36:39], s52 offen lds
buffer_load_dwordx4 v28, s[36:39], s52 offen offset:1024 lds
buffer_load_dword v22, s[36:39], s52 offen offset:2048 lds
s_add_u32 s52, s52, 128
s_add_u32 m0, s55, 2304
s_nop 0
buffer_load_dwordx4 v21, s[36:39], s53 offen lds
buffer_load_dwordx4 v28, s[36:39], s53 offen offset:1024 lds
buffer_load_dword v29, s[36:39], s53 offen offset:2048 lds
s_add_u32 s53, s53, 128
s_add_u32 m0, s56, 123648
s_nop 0
buffer_load_dwordx4 v18, s[20:23], s54 offen lds
buffer_load_dwordx4 v19, s[20:23], s54 offen offset:1024 lds
buffer_load_dwordx4 v20, s[20:23], s54 offen offset:2048 lds
s_add_u32 s54, s54, 196608
s_add_u32 m0, s56, 136064
s_nop 0
buffer_load_dwordx4 v18, s[20:23], s54 offen lds
buffer_load_dwordx4 v19, s[20:23], s54 offen offset:1024 lds
buffer_load_dwordx4 v20, s[20:23], s54 offen offset:2048 lds
s_add_u32 s54, s54, 196608
s_waitcnt vmcnt(12)
s_cmp_lt_u32 s14, 16
s_cselect_b32 s62, 0, 4096
v_mov_b32 v154, 1
v_lshlrev_b32 v155, 8, v1
v_permlane16_swap_b32 v128, v130
v_permlane16_swap_b32 v129, v131
v_permlane16_swap_b32 v132, v134
v_permlane16_swap_b32 v133, v135
v_permlane16_swap_b32 v136, v138
v_permlane16_swap_b32 v137, v139
v_permlane16_swap_b32 v140, v142
v_permlane16_swap_b32 v141, v143
buffer_atomic_add v154, v155, s[40:43], s62 offen
v_lshlrev_b32 v64, 16, v128
v_and_b32 v65, 0xffff0000, v128
v_lshlrev_b32 v66, 16, v129
v_and_b32 v67, 0xffff0000, v129
v_lshlrev_b32 v68, 16, v130
v_and_b32 v69, 0xffff0000, v130
v_lshlrev_b32 v70, 16, v131
v_and_b32 v71, 0xffff0000, v131
v_lshlrev_b32 v72, 16, v132
v_and_b32 v73, 0xffff0000, v132
v_lshlrev_b32 v74, 16, v133
v_and_b32 v75, 0xffff0000, v133
v_lshlrev_b32 v76, 16, v134
v_and_b32 v77, 0xffff0000, v134
v_lshlrev_b32 v78, 16, v135
v_and_b32 v79, 0xffff0000, v135
v_lshlrev_b32 v80, 16, v136
v_and_b32 v81, 0xffff0000, v136
v_lshlrev_b32 v82, 16, v137
v_and_b32 v83, 0xffff0000, v137
v_lshlrev_b32 v84, 16, v138
v_and_b32 v85, 0xffff0000, v138
v_lshlrev_b32 v86, 16, v139
v_and_b32 v87, 0xffff0000, v139
v_lshlrev_b32 v88, 16, v140
v_and_b32 v89, 0xffff0000, v140
v_lshlrev_b32 v90, 16, v141
v_and_b32 v91, 0xffff0000, v141
v_lshlrev_b32 v92, 16, v142
v_and_b32 v93, 0xffff0000, v142
v_lshlrev_b32 v94, 16, v143
v_and_b32 v95, 0xffff0000, v143
s_lshl_b32 s64, s6, 14
s_lshl_b32 s65, s49, 13
s_add_u32 s64, s64, s65
s_lshl_b32 s65, s7, 9
s_add_u32 s64, s64, s65
s_lshl_b32 s65, s48, 8
s_add_u32 s64, s64, s65
s_add_u32 s64, s64, 29360128
v_and_b32 v152, 31, v1
v_lshlrev_b32 v152, 3, v152
v_lshrrev_b32 v153, 5, v1
v_lshl_add_u32 v152, v153, 28, v152
s_lshl_b32 s62, s7, 18
s_add_u32 s62, s62, 0
s_add_u32 s63, s62, 131072
v_pk_mul_f32 v[146:147], v[64:65], v[64:65]
v_pk_mul_f32 v[150:151], v[80:81], v[80:81]
v_pk_fma_f32 v[146:147], v[66:67], v[66:67], v[146:147]
v_pk_add_f32 v[144:145], v[64:65], v[66:67]
v_pk_fma_f32 v[150:151], v[82:83], v[82:83], v[150:151]
v_pk_add_f32 v[148:149], v[80:81], v[82:83]
v_pk_fma_f32 v[146:147], v[68:69], v[68:69], v[146:147]
v_pk_add_f32 v[144:145], v[144:145], v[68:69]
v_pk_fma_f32 v[150:151], v[84:85], v[84:85], v[150:151]
v_pk_add_f32 v[148:149], v[148:149], v[84:85]
v_pk_fma_f32 v[146:147], v[70:71], v[70:71], v[146:147]
v_pk_add_f32 v[144:145], v[144:145], v[70:71]
v_pk_fma_f32 v[150:151], v[86:87], v[86:87], v[150:151]
v_pk_add_f32 v[148:149], v[148:149], v[86:87]
v_pk_fma_f32 v[146:147], v[72:73], v[72:73], v[146:147]
v_pk_add_f32 v[144:145], v[144:145], v[72:73]
v_pk_fma_f32 v[150:151], v[88:89], v[88:89], v[150:151]
v_pk_add_f32 v[148:149], v[148:149], v[88:89]
v_pk_fma_f32 v[146:147], v[74:75], v[74:75], v[146:147]
v_pk_add_f32 v[144:145], v[144:145], v[74:75]
v_pk_fma_f32 v[150:151], v[90:91], v[90:91], v[150:151]
v_pk_add_f32 v[148:149], v[148:149], v[90:91]
v_pk_fma_f32 v[146:147], v[76:77], v[76:77], v[146:147]
v_pk_add_f32 v[144:145], v[144:145], v[76:77]
v_pk_fma_f32 v[150:151], v[92:93], v[92:93], v[150:151]
v_pk_add_f32 v[148:149], v[148:149], v[92:93]
v_pk_fma_f32 v[146:147], v[78:79], v[78:79], v[146:147]
v_pk_add_f32 v[144:145], v[144:145], v[78:79]
v_pk_fma_f32 v[150:151], v[94:95], v[94:95], v[150:151]
v_pk_add_f32 v[148:149], v[148:149], v[94:95]
v_add_f32 v144, v144, v145
v_add_f32 v146, v146, v147
v_add_f32 v148, v148, v149
v_add_f32 v150, v150, v151
s_nop 0
v_permlane16_swap_b32 v144, v148
v_permlane16_swap_b32 v146, v150
v_add_f32 v144, v144, v148
v_add_f32 v146, v146, v150
s_nop 1
v_permlane32_swap_b32 v144, v146
v_add_f32 v144, v144, v146
s_nop 1
v_permlane32_swap_b32 v144, v145
buffer_store_dwordx2 v[144:145], v152, s[16:19], s64 offen sc1
s_lshl_b32 s62, s2, 10
s_add_u32 s62, s62, 31457280
s_cmp_eq_u32 s3, 0
s_cselect_b32 s62, s62, 268435456
buffer_store_dwordx4 v[156:159], v27, s[16:19], s62 offen sc1
v_accvgpr_write_b32 a224, v64
v_accvgpr_write_b32 a225, v65
v_accvgpr_write_b32 a226, v66
v_accvgpr_write_b32 a227, v67
v_accvgpr_write_b32 a228, v68
v_accvgpr_write_b32 a229, v69
v_accvgpr_write_b32 a230, v70
v_accvgpr_write_b32 a231, v71
v_accvgpr_write_b32 a232, v72
v_accvgpr_write_b32 a233, v73
v_accvgpr_write_b32 a234, v74
v_accvgpr_write_b32 a235, v75
v_accvgpr_write_b32 a236, v76
v_accvgpr_write_b32 a237, v77
v_accvgpr_write_b32 a238, v78
v_accvgpr_write_b32 a239, v79
v_accvgpr_write_b32 a240, v80
v_accvgpr_write_b32 a241, v81
v_accvgpr_write_b32 a242, v82
v_accvgpr_write_b32 a243, v83
v_accvgpr_write_b32 a244, v84
v_accvgpr_write_b32 a245, v85
v_accvgpr_write_b32 a246, v86
v_accvgpr_write_b32 a247, v87
v_accvgpr_write_b32 a248, v88
v_accvgpr_write_b32 a249, v89
v_accvgpr_write_b32 a250, v90
v_accvgpr_write_b32 a251, v91
v_accvgpr_write_b32 a252, v92
v_accvgpr_write_b32 a253, v93
v_accvgpr_write_b32 a254, v94
v_accvgpr_write_b32 a255, v95
s_add_u32 m0, s55, 18496
s_nop 0
buffer_load_dwordx4 v21, s[36:39], s52 offen lds
buffer_load_dwordx4 v28, s[36:39], s52 offen offset:1024 lds
buffer_load_dword v22, s[36:39], s52 offen offset:2048 lds
s_add_u32 s52, s52, 128
s_add_u32 m0, s55, 20800
s_nop 0
buffer_load_dwordx4 v21, s[36:39], s53 offen lds
buffer_load_dwordx4 v28, s[36:39], s53 offen offset:1024 lds
buffer_load_dword v29, s[36:39], s53 offen offset:2048 lds
s_add_u32 s53, s53, 128
s_add_u32 m0, s56, 73984
s_nop 0
buffer_load_dwordx4 v18, s[20:23], s54 offen lds
buffer_load_dwordx4 v19, s[20:23], s54 offen offset:1024 lds
buffer_load_dwordx4 v20, s[20:23], s54 offen offset:2048 lds
s_add_u32 s54, s54, 196608
s_waitcnt vmcnt(15) lgkmcnt(0)
s_barrier
ds_read_b128 a[0:3], v23
RD 4,23,2304
RD 8,23,4608
RD 12,23,6912
TR 20,25,49664
TR 22,25,50176
TR 24,25,49696
TR 26,25,50208
ds_read_b128 a[16:19], v24
TR 28,25,50688
TR 30,25,51200
TR 32,25,50720
TR 34,25,51232
TR 36,25,51712
TR 38,25,52224
TR 40,25,51744
TR 42,25,52256
s_waitcnt vmcnt(12) lgkmcnt(8)
s_barrier
v_mfma_f32_16x16x32_bf16 v[60:63], a[20:23], a[0:3], 0
ds_read_b128 a[44:47], v30
RD 48,30,2304
v_mfma_f32_16x16x32_bf16 v[76:79], a[24:27], a[0:3], 0
s_add_u32 m0, s56, 86400
v_mfma_f32_16x16x32_bf16 v[80:83], a[24:27], a[4:7], 0
buffer_load_dwordx4 v18, s[20:23], s54 offen lds
v_mfma_f32_16x16x32_bf16 v[64:67], a[20:23], a[4:7], 0
s_sub_u32 s47, s47, 1
s_cbranch_scc1 .Lx18
.Lx18b:
v_mfma_f32_16x16x32_bf16 v[68:71], a[20:23], a[8:11], 0
buffer_load_dwordx4 v19, s[20:23], s54 offen offset:1024 lds
v_mfma_f32_16x16x32_bf16 v[84:87], a[24:27], a[8:11], 0
RD 52,30,4608
RD 56,30,6912
v_mfma_f32_16x16x32_bf16 v[88:91], a[24:27], a[12:15], 0
TR 64,25,62080
v_mfma_f32_16x16x32_bf16 v[72:75], a[20:23], a[12:15], 0
TR 66,25,62592
s_waitcnt lgkmcnt(6)
v_mfma_f32_16x16x32_bf16 v[244:247], a[24:27], a[16:19], 0
buffer_load_dwordx4 v20, s[20:23], s54 offen offset:2048 lds
v_mfma_f32_16x16x32_bf16 v[104:107], a[28:31], a[12:15], 0
s_add_u32 s54, s54, 196608
s_add_u32 m0, s55, 36992
v_mfma_f32_16x16x32_bf16 v[120:123], a[32:35], a[12:15], 0
buffer_load_dwordx4 v21, s[36:39], s52 offen lds
v_mfma_f32_16x16x32_bf16 v[116:119], a[32:35], a[8:11], 0
TR 68,25,62112
TR 70,25,62624
v_mfma_f32_16x16x32_bf16 v[100:103], a[28:31], a[8:11], 0
ds_read_b128 a[60:63], v31
v_mfma_f32_16x16x32_bf16 v[96:99], a[28:31], a[4:7], 0
buffer_load_dwordx4 v28, s[36:39], s52 offen offset:1024 lds
v_mfma_f32_16x16x32_bf16 v[112:115], a[32:35], a[4:7], 0
TR 72,25,63104
v_mfma_f32_16x16x32_bf16 v[108:111], a[32:35], a[0:3], 0
buffer_load_dword v22, s[36:39], s52 offen offset:2048 lds
v_mfma_f32_16x16x32_bf16 v[92:95], a[28:31], a[0:3], 0
TR 74,25,63616
s_add_u32 s52, s52, 128
v_mfma_f32_16x16x32_bf16 v[124:127], a[0:3], a[36:39], 0
TR 76,25,63136
s_add_u32 m0, s55, 39296
v_mfma_f32_16x16x32_bf16 v[140:143], a[0:3], a[40:43], 0
buffer_load_dwordx4 v21, s[36:39], s53 offen lds
v_mfma_f32_16x16x32_bf16 v[144:147], a[4:7], a[40:43], 0
TR 78,25,63648
v_mfma_f32_16x16x32_bf16 v[128:131], a[4:7], a[36:39], 0
TR 80,25,64128
v_mfma_f32_16x16x32_bf16 v[132:135], a[8:11], a[36:39], 0
buffer_load_dwordx4 v28, s[36:39], s53 offen offset:1024 lds
v_mfma_f32_16x16x32_bf16 v[148:151], a[8:11], a[40:43], 0
TR 82,25,64640
TR 84,25,64160
v_mfma_f32_16x16x32_bf16 v[152:155], a[12:15], a[40:43], 0
TR 86,25,64672
v_mfma_f32_16x16x32_bf16 v[136:139], a[12:15], a[36:39], 0
buffer_load_dword v29, s[36:39], s53 offen offset:2048 lds
v_mfma_f32_16x16x32_bf16 v[156:159], a[16:19], a[36:39], 0
s_add_u32 s53, s53, 128
v_mfma_f32_16x16x32_bf16 v[160:163], a[16:19], a[40:43], 0
s_waitcnt vmcnt(9) lgkmcnt(8)
s_barrier
MAA 60,64,44
RD 0,23,18496
RD 4,23,20800
MAA 76,68,44
s_add_u32 m0, s56, 98816
MAA 80,68,48
buffer_load_dwordx4 v18, s[20:23], s54 offen lds
MAA 64,64,48
RD 8,23,23104
RD 12,23,25408
MAA 68,64,52
buffer_load_dwordx4 v19, s[20:23], s54 offen offset:1024 lds
MAA 84,68,52
ds_read_b64_tr_b16 a[20:21], v25
MAA 88,68,56
TR 22,25,512
MAA 72,64,56
TR 24,25,32
s_waitcnt lgkmcnt(7)
MAA 244,68,60
buffer_load_dwordx4 v20, s[20:23], s54 offen offset:2048 lds
MAA 104,72,56
s_add_u32 s54, s54, 196608
s_add_u32 m0, s56, 111232
MAA 120,76,56
buffer_load_dwordx4 v18, s[20:23], s54 offen lds
MAA 116,76,52
TR 26,25,544
MAA 100,72,52
RD 16,24,18496
TR 28,25,1024
MAA 96,72,48
buffer_load_dwordx4 v19, s[20:23], s54 offen offset:1024 lds
MAA 112,76,48
TR 30,25,1536
MAA 108,76,44
buffer_load_dwordx4 v20, s[20:23], s54 offen offset:2048 lds
MAA 92,72,44
s_add_u32 s54, s54, 196608
MAA 124,44,80
TR 32,25,1056
s_add_u32 m0, s55, 55488
MAA 140,44,84
buffer_load_dwordx4 v21, s[36:39], s52 offen lds
MAA 144,48,84
TR 34,25,1568
MAA 128,48,80
TR 36,25,2048
MAA 132,52,80
buffer_load_dwordx4 v28, s[36:39], s52 offen offset:1024 lds
MAA 148,52,84
TR 38,25,2560
TR 40,25,2080
MAA 152,56,84
TR 42,25,2592
MAA 136,56,80
buffer_load_dword v22, s[36:39], s52 offen offset:2048 lds
MAA 156,60,80
s_add_u32 s52, s52, 128
MAA 160,60,84
s_waitcnt vmcnt(15) lgkmcnt(8)
s_barrier
MAA 60,20,0
RD 44,30,18496
RD 48,30,20800
MAA 76,24,0
s_add_u32 m0, s55, 57792
MAA 80,24,4
buffer_load_dwordx4 v21, s[36:39], s53 offen lds
MAA 64,20,4
s_sub_u32 s47, s47, 1
s_cbranch_scc1 .Lx19
.Lx19b:
MAA 68,20,8
buffer_load_dwordx4 v28, s[36:39], s53 offen offset:1024 lds
MAA 84,24,8
RD 52,30,23104
RD 56,30,25408
MAA 88,24,12
TR 64,25,12416
MAA 72,20,12
TR 66,25,12928
s_waitcnt lgkmcnt(6)
MAA 244,24,16
buffer_load_dword v29, s[36:39], s53 offen offset:2048 lds
MAA 104,28,12
s_add_u32 s53, s53, 128
s_add_u32 m0, s56, 123648
MAA 120,32,12
buffer_load_dwordx4 v18, s[20:23], s54 offen lds
MAA 116,32,8
TR 68,25,12448
TR 70,25,12960
MAA 100,28,8
RD 60,31,18496
MAA 96,28,4
buffer_load_dwordx4 v19, s[20:23], s54 offen offset:1024 lds
MAA 112,32,4
TR 72,25,13440
MAA 108,32,0
buffer_load_dwordx4 v20, s[20:23], s54 offen offset:2048 lds
MAA 92,28,0
TR 74,25,13952
s_add_u32 s54, s54, 196608
MAA 124,0,36
TR 76,25,13472
s_add_u32 m0, s56, 136064
MAA 140,0,40
buffer_load_dwordx4 v18, s[20:23], s54 offen lds
MAA 144,4,40
TR 78,25,13984
MAA 128,4,36
TR 80,25,14464
MAA 132,8,36
buffer_load_dwordx4 v19, s[20:23], s54 offen offset:1024 lds
MAA 148,8,40
TR 82,25,14976
TR 84,25,14496
MAA 152,12,40
TR 86,25,15008
MAA 136,12,36
buffer_load_dwordx4 v20, s[20:23], s54 offen offset:2048 lds
MAA 156,16,36
s_add_u32 s54, s54, 196608
MAA 160,16,40
s_waitcnt vmcnt(15) lgkmcnt(8)
s_barrier
MAA 60,64,44
RD 0,23,36992
RD 4,23,39296
MAA 76,68,44
s_add_u32 m0, s55, 0
MAA 80,68,48
buffer_load_dwordx4 v21, s[36:39], s52 offen lds
MAA 64,64,48
RD 8,23,41600
RD 12,23,43904
MAA 68,64,52
buffer_load_dwordx4 v28, s[36:39], s52 offen offset:1024 lds
MAA 84,68,52
TR 20,25,24832
MAA 88,68,56
TR 22,25,25344
MAA 72,64,56
TR 24,25,24864
s_waitcnt lgkmcnt(7)
MAA 244,68,60
buffer_load_dword v22, s[36:39], s52 offen offset:2048 lds
MAA 104,72,56
TR 26,25,25376
s_add_u32 s52, s52, 128
s_add_u32 m0, s55, 2304
MAA 120,76,56
buffer_load_dwordx4 v21, s[36:39], s53 offen lds
MAA 116,76,52
RD 16,24,36992
MAA 100,72,52
buffer_load_dwordx4 v28, s[36:39], s53 offen offset:1024 lds
MAA 96,72,48
TR 28,25,25856
MAA 112,76,48
buffer_load_dword v29, s[36:39], s53 offen offset:2048 lds
MAA 108,76,44
TR 30,25,26368
s_add_u32 s53, s53, 128
MAA 92,72,44
TR 32,25,25888
s_add_u32 m0, s56, 73984
MAA 124,44,80
buffer_load_dwordx4 v18, s[20:23], s54 offen lds
MAA 140,44,84
TR 34,25,26400
MAA 144,48,84
buffer_load_dwordx4 v19, s[20:23], s54 offen offset:1024 lds
MAA 128,48,80
TR 36,25,26880
MAA 132,52,80
TR 38,25,27392
TR 40,25,26912
MAA 148,52,84
buffer_load_dwordx4 v20, s[20:23], s54 offen offset:2048 lds
MAA 152,56,84
s_add_u32 s54, s54, 196608
MAA 136,56,80
buffer_load_dword v37, v34, s[40:43], 0 offen sc1
MAA 156,60,80
TR 42,25,27424
MAA 160,60,84
s_waitcnt vmcnt(22) lgkmcnt(8)
s_barrier
MAA 60,20,0
RD 44,30,36992
RD 48,30,39296
MAA 76,24,0
s_add_u32 m0, s56, 86400
MAA 80,24,4
buffer_load_dwordx4 v18, s[20:23], s54 offen lds
MAA 64,20,4
s_sub_u32 s47, s47, 1
s_cbranch_scc1 .Lx20
.Lx20b:
MAA 68,20,8
buffer_load_dwordx4 v19, s[20:23], s54 offen offset:1024 lds
MAA 84,24,8
RD 52,30,41600
RD 56,30,43904
MAA 88,24,12
TR 64,25,37248
MAA 72,20,12
TR 66,25,37760
s_waitcnt lgkmcnt(6)
MAA 244,24,16
buffer_load_dwordx4 v20, s[20:23], s54 offen offset:2048 lds
MAA 104,28,12
s_add_u32 s54, s54, 196608
s_add_u32 m0, s55, 18496
MAA 120,32,12
buffer_load_dwordx4 v21, s[36:39], s52 offen lds
MAA 116,32,8
TR 68,25,37280
TR 70,25,37792
MAA 100,28,8
RD 60,31,36992
MAA 96,28,4
buffer_load_dwordx4 v28, s[36:39], s52 offen offset:1024 lds
MAA 112,32,4
TR 72,25,38272
MAA 108,32,0
buffer_load_dword v22, s[36:39], s52 offen offset:2048 lds
MAA 92,28,0
TR 74,25,38784
s_add_u32 s52, s52, 128
MAA 124,0,36
TR 76,25,38304
s_add_u32 m0, s55, 20800
MAA 140,0,40
buffer_load_dwordx4 v21, s[36:39], s53 offen lds
MAA 144,4,40
TR 78,25,38816
MAA 128,4,36
TR 80,25,39296
MAA 132,8,36
buffer_load_dwordx4 v28, s[36:39], s53 offen offset:1024 lds
MAA 148,8,40
TR 82,25,39808
TR 84,25,39328
MAA 152,12,40
TR 86,25,39840
MAA 136,12,36
buffer_load_dword v29, s[36:39], s53 offen offset:2048 lds
MAA 156,16,36
s_add_u32 s53, s53, 128
MAA 160,16,40
s_waitcnt vmcnt(22) lgkmcnt(8)
s_barrier
MAA 60,64,44
RD 0,23,55488
MAA 76,68,44
RD 4,23,57792
s_add_u32 m0, s56, 98816
MAA 80,68,48
buffer_load_dwordx4 v18, s[20:23], s54 offen lds
MAA 64,64,48
RD 8,23,60096
MAA 68,64,52
RD 12,23,62400
MAA 84,68,52
TR 20,25,49664
MAA 88,68,56
buffer_load_dwordx4 v19, s[20:23], s54 offen offset:1024 lds
MAA 72,64,56
TR 22,25,50176
s_waitcnt lgkmcnt(6)
MAA 244,68,60
MAA 104,72,56
TR 24,25,49696
MAA 120,76,56
buffer_load_dwordx4 v20, s[20:23], s54 offen offset:2048 lds
MAA 116,76,52
TR 26,25,50208
s_add_u32 s54, s54, 196608
MAA 100,72,52
RD 16,24,55488
MAA 96,72,48
TR 28,25,50688
s_add_u32 m0, s55, 36992
MAA 112,76,48
buffer_load_dwordx4 v21, s[36:39], s52 offen lds
MAA 108,76,44
TR 30,25,51200
MAA 92,72,44
TR 32,25,50720
MAA 124,44,80
MAA 140,44,84
buffer_load_dwordx4 v28, s[36:39], s52 offen offset:1024 lds
MAA 144,48,84
TR 34,25,51232
MAA 128,48,80
TR 36,25,51712
MAA 132,52,80
TR 38,25,52224
MAA 148,52,84
buffer_load_dword v22, s[36:39], s52 offen offset:2048 lds
MAA 152,56,84
TR 40,25,51744
s_add_u32 s52, s52, 128
MAA 136,56,80
TR 42,25,52256
MAA 156,60,80
MAA 160,60,84
s_waitcnt vmcnt(25) lgkmcnt(8)
s_barrier
MAA 60,20,0
RD 44,30,55488
MAA 76,24,0
RD 48,30,57792
s_add_u32 m0, s56, 111232
MAA 80,24,4
buffer_load_dwordx4 v18, s[20:23], s54 offen lds
MAA 64,20,4
s_sub_u32 s47, s47, 1
s_cbranch_scc1 .Lx21
.Lx21b:
MAA 68,20,8
RD 52,30,60096
MAA 84,24,8
RD 56,30,62400
MAA 88,24,12
buffer_load_dwordx4 v19, s[20:23], s54 offen offset:1024 lds
MAA 72,20,12
TR 64,25,62080
s_waitcnt lgkmcnt(5)
MAA 244,24,16
TR 66,25,62592
MAA 104,28,12
TR 68,25,62112
MAA 120,32,12
buffer_load_dwordx4 v20, s[20:23], s54 offen offset:2048 lds
MAA 116,32,8
TR 70,25,62624
s_add_u32 s54, s54, 196608
MAA 100,28,8
RD 60,31,55488
MAA 96,28,4
s_add_u32 m0, s55, 39296
MAA 112,32,4
buffer_load_dwordx4 v21, s[36:39], s53 offen lds
MAA 108,32,0
TR 72,25,63104
MAA 92,28,0
TR 74,25,63616
MAA 124,0,36
TR 76,25,63136
MAA 140,0,40
buffer_load_dwordx4 v28, s[36:39], s53 offen offset:1024 lds
MAA 144,4,40
TR 78,25,63648
MAA 128,4,36
TR 80,25,64128
MAA 132,8,36
TR 82,25,64640
MAA 148,8,40
buffer_load_dword v29, s[36:39], s53 offen offset:2048 lds
MAA 152,12,40
TR 84,25,64160
s_add_u32 s53, s53, 128
MAA 136,12,36
TR 86,25,64672
MAA 156,16,36
MAA 160,16,40
s_waitcnt vmcnt(22) lgkmcnt(8)
s_barrier
s_waitcnt vmcnt(21)
v_cmp_gt_u32 vcc, v35, v37
s_nop 0
s_cbranch_vccnz .Lsp22
.Lsp22b:
v_mov_b32 v37, 0
MAA 60,64,44
ds_read_b128 a[0:3], v23
MAA 76,68,44
RD 4,23,2304
MAA 80,68,48
buffer_atomic_add v38, v32, s[16:19], 0 offen
MAA 64,64,48
RD 8,23,4608
MAA 68,64,52
RD 12,23,6912
s_add_u32 m0, s56, 123648
MAA 84,68,52
buffer_load_dwordx4 v18, s[20:23], s54 offen lds
MAA 88,68,56
ds_read_b64_tr_b16 a[20:21], v25
MAA 72,64,56
TR 22,25,512
s_waitcnt lgkmcnt(6)
MAA 244,68,60
TR 24,25,32
MAA 104,72,56
buffer_load_dwordx4 v19, s[20:23], s54 offen offset:1024 lds
MAA 120,76,56
TR 26,25,544
MAA 116,76,52
ds_read_b128 a[16:19], v24
MAA 100,72,52
buffer_load_dwordx4 v20, s[20:23], s54 offen offset:2048 lds
MAA 96,72,48
s_add_u32 s54, s54, 196608
MAA 112,76,48
TR 28,25,1024
MAA 108,76,44
TR 30,25,1536
s_add_u32 m0, s55, 55488
MAA 92,72,44
buffer_load_dwordx4 v21, s[36:39], s52 offen lds
MAA 124,44,80
TR 32,25,1056
MAA 140,44,84
TR 34,25,1568
MAA 144,48,84
buffer_load_dwordx4 v28, s[36:39], s52 offen offset:1024 lds
MAA 128,48,80
TR 36,25,2048
MAA 132,52,80
TR 38,25,2560
MAA 148,52,84
TR 40,25,2080
MAA 152,56,84
buffer_load_dword v22, s[36:39], s52 offen offset:2048 lds
MAA 136,56,80
TR 42,25,2592
s_add_u32 s52, s52, 128
MAA 156,60,80
MAA 160,60,84
s_waitcnt vmcnt(25) lgkmcnt(8)
s_barrier
MAA 60,20,0
ds_read_b128 a[44:47], v30
MAA 76,24,0
RD 48,30,2304
s_add_u32 m0, s56, 136064
MAA 80,24,4
buffer_load_dwordx4 v18, s[20:23], s54 offen lds
MAA 64,20,4
s_sub_u32 s47, s47, 1
s_cbranch_scc1 .Lx23
.Lx23b:
MAA 68,20,8
RD 52,30,4608
MAA 84,24,8
RD 56,30,6912
MAA 88,24,12
buffer_load_dwordx4 v19, s[20:23], s54 offen offset:1024 lds
MAA 72,20,12
TR 64,25,12416
s_waitcnt lgkmcnt(5)
MAA 244,24,16
TR 66,25,12928
MAA 104,28,12
TR 68,25,12448
MAA 120,32,12
buffer_load_dwordx4 v20, s[20:23], s54 offen offset:2048 lds
MAA 116,32,8
TR 70,25,12960
s_add_u32 s54, s54, 196608
MAA 100,28,8
ds_read_b128 a[60:63], v31
MAA 96,28,4
s_add_u32 m0, s55, 57792
MAA 112,32,4
buffer_load_dwordx4 v21, s[36:39], s53 offen lds
MAA 108,32,0
TR 72,25,13440
MAA 92,28,0
TR 74,25,13952
MAA 124,0,36
TR 76,25,13472
MAA 140,0,40
buffer_load_dwordx4 v28, s[36:39], s53 offen offset:1024 lds
MAA 144,4,40
TR 78,25,13984
MAA 128,4,36
TR 80,25,14464
MAA 132,8,36
TR 82,25,14976
MAA 148,8,40
buffer_load_dword v29, s[36:39], s53 offen offset:2048 lds
MAA 152,12,40
TR 84,25,14496
s_add_u32 s53, s53, 128
MAA 136,12,36
TR 86,25,15008
MAA 156,16,36
MAA 160,16,40
s_waitcnt vmcnt(22) lgkmcnt(8)
s_barrier
MAA 60,64,44
RD 0,23,18496
MAA 76,68,44
RD 4,23,20800
s_add_u32 m0, s56, 73984
MAA 80,68,48
buffer_load_dwordx4 v18, s[20:23], s54 offen lds
MAA 64,64,48
RD 8,23,23104
MAA 68,64,52
RD 12,23,25408
MAA 84,68,52
TR 20,25,24832
MAA 88,68,56
buffer_load_dwordx4 v19, s[20:23], s54 offen offset:1024 lds
MAA 72,64,56
TR 22,25,25344
s_waitcnt lgkmcnt(6)
MAA 244,68,60
MAA 104,72,56
TR 24,25,24864
MAA 120,76,56
buffer_load_dwordx4 v20, s[20:23], s54 offen offset:2048 lds
MAA 116,76,52
TR 26,25,25376
s_add_u32 s54, s54, 196608
MAA 100,72,52
RD 16,24,18496
MAA 96,72,48
TR 28,25,25856
s_add_u32 m0, s55, 0
MAA 112,76,48
buffer_load_dwordx4 v21, s[36:39], s52 offen lds
MAA 108,76,44
TR 30,25,26368
MAA 92,72,44
TR 32,25,25888
MAA 124,44,80
MAA 140,44,84
buffer_load_dwordx4 v28, s[36:39], s52 offen offset:1024 lds
MAA 144,48,84
TR 34,25,26400
MAA 128,48,80
TR 36,25,26880
MAA 132,52,80
TR 38,25,27392
MAA 148,52,84
buffer_load_dword v22, s[36:39], s52 offen offset:2048 lds
MAA 152,56,84
TR 40,25,26912
s_add_u32 s52, s52, 128
MAA 136,56,80
TR 42,25,27424
MAA 156,60,80
MAA 160,60,84
s_waitcnt vmcnt(22) lgkmcnt(8)
s_barrier
MAA 60,20,0
RD 44,30,18496
MAA 76,24,0
RD 48,30,20800
s_add_u32 m0, s56, 86400
MAA 80,24,4
buffer_load_dwordx4 v18, s[20:23], s54 offen lds
MAA 64,20,4
s_sub_u32 s47, s47, 1
s_cbranch_scc1 .Lx24
.Lx24b:
MAA 68,20,8
RD 52,30,23104
MAA 84,24,8
RD 56,30,25408
MAA 88,24,12
buffer_load_dwordx4 v19, s[20:23], s54 offen offset:1024 lds
MAA 72,20,12
TR 64,25,37248
s_waitcnt lgkmcnt(5)
MAA 244,24,16
TR 66,25,37760
MAA 104,28,12
TR 68,25,37280
MAA 120,32,12
buffer_load_dwordx4 v20, s[20:23], s54 offen offset:2048 lds
MAA 116,32,8
TR 70,25,37792
s_add_u32 s54, s54, 196608
MAA 100,28,8
RD 60,31,18496
MAA 96,28,4
s_add_u32 m0, s55, 2304
MAA 112,32,4
buffer_load_dwordx4 v21, s[36:39], s53 offen lds
MAA 108,32,0
TR 72,25,38272
MAA 92,28,0
TR 74,25,38784
MAA 124,0,36
TR 76,25,38304
MAA 140,0,40
buffer_load_dwordx4 v28, s[36:39], s53 offen offset:1024 lds
MAA 144,4,40
TR 78,25,38816
MAA 128,4,36
TR 80,25,39296
MAA 132,8,36
TR 82,25,39808
MAA 148,8,40
buffer_load_dword v29, s[36:39], s53 offen offset:2048 lds
MAA 152,12,40
TR 84,25,39328
s_add_u32 s53, s53, 128
MAA 136,12,36
TR 86,25,39840
MAA 156,16,36
MAA 160,16,40
s_waitcnt vmcnt(21) lgkmcnt(8)
s_barrier
MAA 60,64,44
RD 0,23,36992
MAA 76,68,44
RD 4,23,39296
s_add_u32 m0, s56, 98816
MAA 80,68,48
buffer_load_dwordx4 v18, s[20:23], s54 offen lds
MAA 64,64,48
RD 8,23,41600
MAA 68,64,52
RD 12,23,43904
MAA 84,68,52
TR 20,25,49664
MAA 88,68,56
buffer_load_dwordx4 v19, s[20:23], s54 offen offset:1024 lds
MAA 72,64,56
TR 22,25,50176
s_waitcnt lgkmcnt(6)
MAA 244,68,60
MAA 104,72,56
TR 24,25,49696
MAA 120,76,56
buffer_load_dwordx4 v20, s[20:23], s54 offen offset:2048 lds
MAA 116,76,52
TR 26,25,50208
s_add_u32 s54, s54, 196608
MAA 100,72,52
RD 16,24,36992
MAA 96,72,48
TR 28,25,50688
s_add_u32 m0, s55, 18496
MAA 112,76,48
buffer_load_dwordx4 v21, s[36:39], s52 offen lds
MAA 108,76,44
TR 30,25,51200
MAA 92,72,44
TR 32,25,50720
MAA 124,44,80
MAA 140,44,84
buffer_load_dwordx4 v28, s[36:39], s52 offen offset:1024 lds
MAA 144,48,84
TR 34,25,51232
MAA 128,48,80
TR 36,25,51712
MAA 132,52,80
TR 38,25,52224
MAA 148,52,84
buffer_load_dword v22, s[36:39], s52 offen offset:2048 lds
MAA 152,56,84
TR 40,25,51744
s_add_u32 s52, s52, 128
MAA 136,56,80
TR 42,25,52256
MAA 156,60,80
MAA 160,60,84
s_waitcnt vmcnt(21) lgkmcnt(8)
s_barrier
MAA 60,20,0
RD 44,30,36992
MAA 76,24,0
RD 48,30,39296
s_add_u32 m0, s56, 111232
MAA 80,24,4
buffer_load_dwordx4 v18, s[20:23], s54 offen lds
MAA 64,20,4
s_sub_u32 s47, s47, 1
s_cbranch_scc1 .Lx25
.Lx25b:
MAA 68,20,8
RD 52,30,41600
MAA 84,24,8
buffer_load_dwordx4 v19, s[20:23], s54 offen offset:1024 lds
MAA 88,24,12
RD 56,30,43904
MAA 72,20,12
TR 64,25,62080
s_waitcnt lgkmcnt(5)
MAA 244,24,16
TR 66,25,62592
MAA 104,28,12
buffer_load_dwordx4 v20, s[20:23], s54 offen offset:2048 lds
MAA 120,32,12
TR 68,25,62112
s_add_u32 s54, s54, 196608
MAA 116,32,8
TR 70,25,62624
s_add_u32 m0, s55, 20800
MAA 100,28,8
buffer_load_dwordx4 v21, s[36:39], s53 offen lds
MAA 96,28,4
RD 60,31,36992
MAA 112,32,4
TR 72,25,63104
MAA 108,32,0
TR 74,25,63616
MAA 92,28,0
buffer_load_dwordx4 v28, s[36:39], s53 offen offset:1024 lds
MAA 124,0,36
TR 76,25,63136
MAA 140,0,40
TR 78,25,63648
MAA 144,4,40
buffer_load_dword v29, s[36:39], s53 offen offset:2048 lds
MAA 128,4,36
TR 80,25,64128
s_add_u32 s53, s53, 128
MAA 132,8,36
TR 82,25,64640
MAA 148,8,40
TR 84,25,64160
MAA 152,12,40
buffer_atomic_add v37, v33, s[16:19], 0 offen sc0
MAA 136,12,36
TR 86,25,64672
MAA 156,16,36
MAA 160,16,40
s_waitcnt vmcnt(22) lgkmcnt(8)
s_barrier
MAA 60,64,44
RD 0,23,55488
MAA 76,68,44
RD 4,23,57792
s_add_u32 m0, s56, 123648
MAA 80,68,48
buffer_load_dwordx4 v18, s[20:23], s54 offen lds
MAA 64,64,48
RD 8,23,60096
MAA 68,64,52
RD 12,23,62400
MAA 84,68,52
ds_read_b64_tr_b16 a[20:21], v25
MAA 88,68,56
buffer_load_dwordx4 v19, s[20:23], s54 offen offset:1024 lds
MAA 72,64,56
TR 22,25,512
s_waitcnt lgkmcnt(6)
MAA 244,68,60
MAA 104,72,56
TR 24,25,32
MAA 120,76,56
buffer_load_dwordx4 v20, s[20:23], s54 offen offset:2048 lds
MAA 116,76,52
TR 26,25,544
s_add_u32 s54, s54, 196608
MAA 100,72,52
RD 16,24,55488
MAA 96,72,48
TR 28,25,1024
s_add_u32 m0, s55, 36992
MAA 112,76,48
buffer_load_dwordx4 v21, s[36:39], s52 offen lds
MAA 108,76,44
TR 30,25,1536
MAA 92,72,44
TR 32,25,1056
MAA 124,44,80
MAA 140,44,84
buffer_load_dwordx4 v28, s[36:39], s52 offen offset:1024 lds
MAA 144,48,84
TR 34,25,1568
MAA 128,48,80
TR 36,25,2048
MAA 132,52,80
TR 38,25,2560
MAA 148,52,84
buffer_load_dword v22, s[36:39], s52 offen offset:2048 lds
MAA 152,56,84
TR 40,25,2080
s_add_u32 s52, s52, 128
MAA 136,56,80
TR 42,25,2592
MAA 156,60,80
MAA 160,60,84
s_waitcnt vmcnt(22) lgkmcnt(8)
s_barrier
MAA 60,20,0
RD 44,30,55488
MAA 76,24,0
RD 48,30,57792
s_add_u32 m0, s56, 136064
MAA 80,24,4
buffer_load_dwordx4 v18, s[20:23], s54 offen lds
MAA 64,20,4
s_sub_u32 s47, s47, 1
s_cbranch_scc1 .Lx26
.Lx26b:
MAA 68,20,8
RD 52,30,60096
MAA 84,24,8
RD 56,30,62400
MAA 88,24,12
buffer_load_dwordx4 v19, s[20:23], s54 offen offset:1024 lds
MAA 72,20,12
TR 64,25,12416
s_waitcnt lgkmcnt(5)
MAA 244,24,16
TR 66,25,12928
MAA 104,28,12
TR 68,25,12448
MAA 120,32,12
buffer_load_dwordx4 v20, s[20:23], s54 offen offset:2048 lds
MAA 116,32,8
TR 70,25,12960
s_add_u32 s54, s54, 196608
MAA 100,28,8
RD 60,31,55488
MAA 96,28,4
s_add_u32 m0, s55, 39296
MAA 112,32,4
buffer_load_dwordx4 v21, s[36:39], s53 offen lds
MAA 108,32,0
TR 72,25,13440
MAA 92,28,0
TR 74,25,13952
MAA 124,0,36
TR 76,25,13472
MAA 140,0,40
buffer_load_dwordx4 v28, s[36:39], s53 offen offset:1024 lds
MAA 144,4,40
TR 78,25,13984
MAA 128,4,36
TR 80,25,14464
MAA 132,8,36
TR 82,25,14976
MAA 148,8,40
buffer_load_dword v29, s[36:39], s53 offen offset:2048 lds
MAA 152,12,40
TR 84,25,14496
s_add_u32 s53, s53, 128
MAA 136,12,36
TR 86,25,15008
MAA 156,16,36
MAA 160,16,40
s_waitcnt vmcnt(22) lgkmcnt(8)
s_barrier
MAA 60,64,44
ds_read_b128 a[0:3], v23
MAA 76,68,44
RD 4,23,2304
s_add_u32 m0, s56, 73984
MAA 80,68,48
buffer_load_dwordx4 v18, s[20:23], s54 offen lds
MAA 64,64,48
RD 8,23,4608
MAA 68,64,52
RD 12,23,6912
MAA 84,68,52
TR 20,25,24832
MAA 88,68,56
buffer_load_dwordx4 v19, s[20:23], s54 offen offset:1024 lds
MAA 72,64,56
TR 22,25,25344
s_waitcnt lgkmcnt(6)
MAA 244,68,60
MAA 104,72,56
TR 24,25,24864
MAA 120,76,56
buffer_load_dwordx4 v20, s[20:23], s54 offen offset:2048 lds
MAA 116,76,52
TR 26,25,25376
s_add_u32 s54, s54, 196608
MAA 100,72,52
ds_read_b128 a[16:19], v24
MAA 96,72,48
TR 28,25,25856
s_add_u32 m0, s55, 55488
MAA 112,76,48
buffer_load_dwordx4 v21, s[36:39], s52 offen lds
MAA 108,76,44
TR 30,25,26368
MAA 92,72,44
TR 32,25,25888
MAA 124,44,80
MAA 140,44,84
buffer_load_dwordx4 v28, s[36:39], s52 offen offset:1024 lds
MAA 144,48,84
TR 34,25,26400
MAA 128,48,80
TR 36,25,26880
MAA 132,52,80
TR 38,25,27392
MAA 148,52,84
buffer_load_dword v22, s[36:39], s52 offen offset:2048 lds
MAA 152,56,84
TR 40,25,26912
s_add_u32 s52, s52, 128
MAA 136,56,80
TR 42,25,27424
MAA 156,60,80
MAA 160,60,84
s_waitcnt vmcnt(22) lgkmcnt(8)
s_barrier
MAA 60,20,0
ds_read_b128 a[44:47], v30
MAA 76,24,0
RD 48,30,2304
s_add_u32 m0, s56, 86400
MAA 80,24,4
buffer_load_dwordx4 v18, s[20:23], s54 offen lds
MAA 64,20,4
s_sub_u32 s47, s47, 1
s_cbranch_scc1 .Lx27
.Lx27b:
MAA 68,20,8
RD 52,30,4608
MAA 84,24,8
RD 56,30,6912
MAA 88,24,12
buffer_load_dwordx4 v19, s[20:23], s54 offen offset:1024 lds
MAA 72,20,12
TR 64,25,37248
s_waitcnt lgkmcnt(5)
MAA 244,24,16
TR 66,25,37760
MAA 104,28,12
TR 68,25,37280
MAA 120,32,12
buffer_load_dwordx4 v20, s[20:23], s54 offen offset:2048 lds
MAA 116,32,8
TR 70,25,37792
s_add_u32 s54, s54, 196608
MAA 100,28,8
ds_read_b128 a[60:63], v31
MAA 96,28,4
s_add_u32 m0, s55, 57792
MAA 112,32,4
buffer_load_dwordx4 v21, s[36:39], s53 offen lds
MAA 108,32,0
TR 72,25,38272
MAA 92,28,0
TR 74,25,38784
MAA 124,0,36
TR 76,25,38304
MAA 140,0,40
buffer_load_dwordx4 v28, s[36:39], s53 offen offset:1024 lds
MAA 144,4,40
TR 78,25,38816
MAA 128,4,36
TR 80,25,39296
MAA 132,8,36
TR 82,25,39808
MAA 148,8,40
buffer_load_dword v29, s[36:39], s53 offen offset:2048 lds
MAA 152,12,40
TR 84,25,39328
s_add_u32 s53, s53, 128
MAA 136,12,36
TR 86,25,39840
MAA 156,16,36
MAA 160,16,40
s_waitcnt vmcnt(24)
v_cmp_gt_u32 vcc, v36, v37
s_nop 0
s_cbranch_vccnz .Lsp28
.Lsp28b:
s_waitcnt vmcnt(21) lgkmcnt(8)
s_barrier
MAA 60,64,44
RD 0,23,18496
MAA 76,68,44
RD 4,23,20800
s_add_u32 m0, s56, 98816
MAA 80,68,48
buffer_load_dwordx4 v18, s[20:23], s54 offen lds
MAA 64,64,48
RD 8,23,23104
MAA 68,64,52
RD 12,23,25408
MAA 84,68,52
buffer_load_dwordx4 v19, s[20:23], s54 offen offset:1024 lds
MAA 88,68,56
TR 20,25,49664
MAA 72,64,56
TR 22,25,50176
s_waitcnt lgkmcnt(6)
MAA 244,68,60
TR 24,25,49696
MAA 104,72,56
buffer_load_dwordx4 v20, s[20:23], s54 offen offset:2048 lds
MAA 120,76,56
TR 26,25,50208
s_add_u32 s54, s54, 196608
MAA 116,76,52
RD 16,24,18496
s_add_u32 m0, s55, 0
MAA 100,72,52
buffer_load_dwordx4 v21, s[36:39], s52 offen lds
MAA 96,72,48
MAA 112,76,48
TR 28,25,50688
MAA 108,76,44
TR 30,25,51200
MAA 92,72,44
buffer_load_dwordx4 v28, s[36:39], s52 offen offset:1024 lds
MAA 124,44,80
TR 32,25,50720
MAA 140,44,84
TR 34,25,51232
MAA 144,48,84
buffer_load_dword v22, s[36:39], s52 offen offset:2048 lds
MAA 128,48,80
TR 36,25,51712
s_add_u32 s52, s52, 128
MAA 132,52,80
TR 38,25,52224
MAA 148,52,84
TR 40,25,51744
MAA 152,56,84
buffer_load_dwordx4 v[164:167], v26, s[16:19], s75 offen sc1
MAA 136,56,80
TR 42,25,52256
MAA 156,60,80
MAA 160,60,84
s_waitcnt vmcnt(22) lgkmcnt(8)
s_barrier
MAA 60,20,0
RD 44,30,18496
MAA 76,24,0
RD 48,30,20800
s_add_u32 m0, s56, 111232
MAA 80,24,4
buffer_load_dwordx4 v18, s[20:23], s54 offen lds
MAA 64,20,4
s_sub_u32 s47, s47, 1
s_cbranch_scc1 .Lx29
.Lx29b:
MAA 68,20,8
RD 52,30,23104
MAA 84,24,8
buffer_load_dwordx4 v19, s[20:23], s54 offen offset:1024 lds
MAA 88,24,12
RD 56,30,25408
MAA 72,20,12
TR 64,25,62080
s_waitcnt lgkmcnt(5)
MAA 244,24,16
TR 66,25,62592
MAA 104,28,12
buffer_load_dwordx4 v20, s[20:23], s54 offen offset:2048 lds
MAA 120,32,12
TR 68,25,62112
s_add_u32 s54, s54, 196608
MAA 116,32,8
TR 70,25,62624
s_add_u32 m0, s55, 2304
MAA 100,28,8
buffer_load_dwordx4 v21, s[36:39], s53 offen lds
MAA 96,28,4
RD 60,31,18496
MAA 112,32,4
TR 72,25,63104
MAA 108,32,0
TR 74,25,63616
MAA 92,28,0
buffer_load_dwordx4 v28, s[36:39], s53 offen offset:1024 lds
MAA 124,0,36
TR 76,25,63136
MAA 140,0,40
TR 78,25,63648
MAA 144,4,40
buffer_load_dword v29, s[36:39], s53 offen offset:2048 lds
MAA 128,4,36
TR 80,25,64128
s_add_u32 s53, s53, 128
MAA 132,8,36
TR 82,25,64640
MAA 148,8,40
TR 84,25,64160
MAA 152,12,40
buffer_load_dwordx4 v[168:171], v26, s[16:19], s75 offen offset:1024 sc1
MAA 136,12,36
TR 86,25,64672
MAA 156,16,36
MAA 160,16,40
s_waitcnt vmcnt(23) lgkmcnt(8)
s_barrier
MAA 60,64,44
RD 0,23,36992
MAA 76,68,44
RD 4,23,39296
s_add_u32 m0, s56, 123648
MAA 80,68,48
buffer_load_dwordx4 v18, s[20:23], s54 offen lds
MAA 64,64,48
RD 8,23,41600
MAA 68,64,52
RD 12,23,43904
MAA 84,68,52
buffer_load_dwordx4 v19, s[20:23], s54 offen offset:1024 lds
MAA 88,68,56
ds_read_b64_tr_b16 a[20:21], v25
MAA 72,64,56
TR 22,25,512
s_waitcnt lgkmcnt(6)
MAA 244,68,60
TR 24,25,32
MAA 104,72,56
buffer_load_dwordx4 v20, s[20:23], s54 offen offset:2048 lds
MAA 120,76,56
TR 26,25,544
s_add_u32 s54, s54, 196608
MAA 116,76,52
RD 16,24,36992
s_add_u32 m0, s55, 18496
MAA 100,72,52
buffer_load_dwordx4 v21, s[36:39], s52 offen lds
MAA 96,72,48
MAA 112,76,48
TR 28,25,1024
MAA 108,76,44
TR 30,25,1536
MAA 92,72,44
buffer_load_dwordx4 v28, s[36:39], s52 offen offset:1024 lds
MAA 124,44,80
TR 32,25,1056
MAA 140,44,84
TR 34,25,1568
MAA 144,48,84
buffer_load_dword v22, s[36:39], s52 offen offset:2048 lds
MAA 128,48,80
TR 36,25,2048
s_add_u32 s52, s52, 128
MAA 132,52,80
TR 38,25,2560
MAA 148,52,84
TR 40,25,2080
MAA 152,56,84
buffer_load_dwordx4 v[172:175], v26, s[16:19], s75 offen offset:2048 sc1
MAA 136,56,80
TR 42,25,2592
MAA 156,60,80
MAA 160,60,84
s_waitcnt vmcnt(24) lgkmcnt(8)
s_barrier
MAA 60,20,0
RD 44,30,36992
MAA 76,24,0
RD 48,30,39296
s_add_u32 m0, s56, 136064
MAA 80,24,4
buffer_load_dwordx4 v18, s[20:23], s54 offen lds
MAA 64,20,4
s_sub_u32 s47, s47, 1
s_cbranch_scc1 .Lx30
.Lx30b:
MAA 68,20,8
RD 52,30,41600
MAA 84,24,8
buffer_load_dwordx4 v19, s[20:23], s54 offen offset:1024 lds
MAA 88,24,12
RD 56,30,43904
MAA 72,20,12
TR 64,25,12416
s_waitcnt lgkmcnt(5)
MAA 244,24,16
TR 66,25,12928
MAA 104,28,12
buffer_load_dwordx4 v20, s[20:23], s54 offen offset:2048 lds
MAA 120,32,12
TR 68,25,12448
s_add_u32 s54, s54, 196608
MAA 116,32,8
TR 70,25,12960
s_add_u32 m0, s55, 20800
MAA 100,28,8
buffer_load_dwordx4 v21, s[36:39], s53 offen lds
MAA 96,28,4
RD 60,31,36992
MAA 112,32,4
TR 72,25,13440
MAA 108,32,0
TR 74,25,13952
MAA 92,28,0
buffer_load_dwordx4 v28, s[36:39], s53 offen offset:1024 lds
MAA 124,0,36
TR 76,25,13472
MAA 140,0,40
TR 78,25,13984
MAA 144,4,40
buffer_load_dword v29, s[36:39], s53 offen offset:2048 lds
MAA 128,4,36
TR 80,25,14464
s_add_u32 s53, s53, 128
MAA 132,8,36
TR 82,25,14976
MAA 148,8,40
TR 84,25,14496
MAA 152,12,40
buffer_load_dwordx4 v[176:179], v26, s[16:19], s75 offen offset:3072 sc1
MAA 136,12,36
TR 86,25,15008
s_add_u32 s75, s75, 4096
MAA 156,16,36
MAA 160,16,40
s_waitcnt vmcnt(25) lgkmcnt(8)
s_barrier
MAA 60,64,44
RD 0,23,55488
MAA 76,68,44
RD 4,23,57792
s_add_u32 m0, s56, 73984
MAA 80,68,48
buffer_load_dwordx4 v18, s[20:23], s54 offen lds
MAA 64,64,48
RD 8,23,60096
MAA 68,64,52
RD 12,23,62400
MAA 84,68,52
buffer_load_dwordx4 v19, s[20:23], s54 offen offset:1024 lds
MAA 88,68,56
TR 20,25,24832
MAA 72,64,56
TR 22,25,25344
s_waitcnt lgkmcnt(6)
MAA 244,68,60
TR 24,25,24864
MAA 104,72,56
buffer_load_dwordx4 v20, s[20:23], s54 offen offset:2048 lds
MAA 120,76,56
TR 26,25,25376
s_add_u32 s54, s54, 196608
MAA 116,76,52
RD 16,24,55488
s_add_u32 m0, s55, 36992
MAA 100,72,52
buffer_load_dwordx4 v21, s[36:39], s52 offen lds
MAA 96,72,48
MAA 112,76,48
TR 28,25,25856
MAA 108,76,44
TR 30,25,26368
MAA 92,72,44
buffer_load_dwordx4 v28, s[36:39], s52 offen offset:1024 lds
MAA 124,44,80
TR 32,25,25888
MAA 140,44,84
TR 34,25,26400
MAA 144,48,84
buffer_load_dword v22, s[36:39], s52 offen offset:2048 lds
MAA 128,48,80
TR 36,25,26880
s_add_u32 s52, s52, 128
MAA 132,52,80
TR 38,25,27392
MAA 148,52,84
TR 40,25,26912
MAA 152,56,84
buffer_load_dwordx4 v[180:183], v26, s[16:19], s75 offen sc1
MAA 136,56,80
TR 42,25,27424
MAA 156,60,80
MAA 160,60,84
s_waitcnt vmcnt(25) lgkmcnt(8)
s_barrier
MAA 60,20,0
RD 44,30,55488
s_waitcnt vmcnt(21)
v_add_f32 v164, v164, v168
MAA 76,24,0
RD 48,30,57792
s_add_u32 m0, s56, 86400
MAA 80,24,4
buffer_load_dwordx4 v18, s[20:23], s54 offen lds
MAA 64,20,4
s_sub_u32 s47, s47, 1
s_cbranch_scc1 .Lx31
.Lx31b:
MAA 68,20,8
RD 52,30,60096
MAA 84,24,8
buffer_load_dwordx4 v19, s[20:23], s54 offen offset:1024 lds
MAA 88,24,12
RD 56,30,62400
MAA 72,20,12
TR 64,25,37248
s_waitcnt lgkmcnt(5)
MAA 244,24,16
TR 66,25,37760
v_add_f32 v165, v165, v169
MAA 104,28,12
buffer_load_dwordx4 v20, s[20:23], s54 offen offset:2048 lds
MAA 120,32,12
TR 68,25,37280
s_add_u32 s54, s54, 196608
MAA 116,32,8
TR 70,25,37792
s_add_u32 m0, s55, 39296
MAA 100,28,8
buffer_load_dwordx4 v21, s[36:39], s53 offen lds
MAA 96,28,4
RD 60,31,55488
MAA 112,32,4
TR 72,25,38272
MAA 108,32,0
TR 74,25,38784
MAA 92,28,0
buffer_load_dwordx4 v28, s[36:39], s53 offen offset:1024 lds
MAA 124,0,36
TR 76,25,38304
v_add_f32 v166, v166, v170
MAA 140,0,40
TR 78,25,38816
MAA 144,4,40
buffer_load_dword v29, s[36:39], s53 offen offset:2048 lds
MAA 128,4,36
TR 80,25,39296
s_add_u32 s53, s53, 128
MAA 132,8,36
TR 82,25,39808
MAA 148,8,40
TR 84,25,39328
v_add_f32 v167, v167, v171
MAA 152,12,40
buffer_load_dwordx4 v[184:187], v26, s[16:19], s75 offen offset:1024 sc1
MAA 136,12,36
TR 86,25,39840
MAA 156,16,36
MAA 160,16,40
s_waitcnt vmcnt(25) lgkmcnt(8)
s_barrier
MAA 60,64,44
ds_read_b128 a[0:3], v23
s_waitcnt vmcnt(21)
v_add_f32 v164, v164, v172
MAA 76,68,44
RD 4,23,2304
s_add_u32 m0, s56, 98816
MAA 80,68,48
buffer_load_dwordx4 v18, s[20:23], s54 offen lds
MAA 64,64,48
RD 8,23,4608
v_add_f32 v165, v165, v173
MAA 68,64,52
RD 12,23,6912
v_add_f32 v166, v166, v174
MAA 84,68,52
buffer_load_dwordx4 v19, s[20:23], s54 offen offset:1024 lds
MAA 88,68,56
TR 20,25,49664
v_add_f32 v167, v167, v175
MAA 72,64,56
TR 22,25,50176
s_waitcnt lgkmcnt(6)
MAA 244,68,60
buffer_load_dwordx4 v20, s[20:23], s54 offen offset:2048 lds
MAA 104,72,56
TR 24,25,49696
s_add_u32 s54, s54, 196608
MAA 120,76,56
TR 26,25,50208
s_add_u32 m0, s55, 55488
MAA 116,76,52
buffer_load_dwordx4 v21, s[36:39], s52 offen lds
MAA 100,72,52
ds_read_b128 a[16:19], v24
MAA 96,72,48
TR 28,25,50688
MAA 112,76,48
buffer_load_dwordx4 v28, s[36:39], s52 offen offset:1024 lds
MAA 108,76,44
TR 30,25,51200
MAA 92,72,44
TR 32,25,50720
MAA 124,44,80
buffer_load_dword v22, s[36:39], s52 offen offset:2048 lds
MAA 140,44,84
TR 34,25,51232
s_add_u32 s52, s52, 128
MAA 144,48,84
TR 36,25,51712
MAA 128,48,80
buffer_load_dwordx4 v[188:191], v26, s[16:19], s75 offen offset:2048 sc1
MAA 132,52,80
TR 38,25,52224
MAA 148,52,84
TR 40,25,51744
MAA 152,56,84
TR 42,25,52256
MAA 136,56,80
MAA 156,60,80
MAA 160,60,84
s_waitcnt vmcnt(25) lgkmcnt(8)
s_barrier
MAA 60,20,0
ds_read_b128 a[44:47], v30
s_waitcnt vmcnt(21)
v_add_f32 v164, v164, v176
MAA 76,24,0
RD 48,30,2304
s_add_u32 m0, s56, 111232
MAA 80,24,4
buffer_load_dwordx4 v18, s[20:23], s54 offen lds
MAA 64,20,4
RD 52,30,4608
v_add_f32 v165, v165, v177
MAA 68,20,8
RD 56,30,6912
v_add_f32 v166, v166, v178
MAA 84,24,8
buffer_load_dwordx4 v19, s[20:23], s54 offen offset:1024 lds
MAA 88,24,12
TR 64,25,62080
v_add_f32 v167, v167, v179
MAA 72,20,12
TR 66,25,62592
s_waitcnt lgkmcnt(6)
MAA 244,24,16
buffer_load_dwordx4 v20, s[20:23], s54 offen offset:2048 lds
MAA 104,28,12
TR 68,25,62112
s_add_u32 s54, s54, 196608
MAA 120,32,12
TR 70,25,62624
s_add_u32 m0, s55, 57792
MAA 116,32,8
buffer_load_dwordx4 v21, s[36:39], s53 offen lds
MAA 100,28,8
ds_read_b128 a[60:63], v31
MAA 96,28,4
TR 72,25,63104
MAA 112,32,4
buffer_load_dwordx4 v28, s[36:39], s53 offen offset:1024 lds
MAA 108,32,0
TR 74,25,63616
MAA 92,28,0
TR 76,25,63136
MAA 124,0,36
buffer_load_dword v29, s[36:39], s53 offen offset:2048 lds
MAA 140,0,40
TR 78,25,63648
s_add_u32 s53, s53, 128
MAA 144,4,40
TR 80,25,64128
MAA 128,4,36
buffer_load_dwordx4 v[192:195], v26, s[16:19], s75 offen offset:3072 sc1
MAA 132,8,36
TR 82,25,64640
MAA 148,8,40
TR 84,25,64160
MAA 152,12,40
TR 86,25,64672
MAA 136,12,36
MAA 156,16,36
MAA 160,16,40
s_waitcnt vmcnt(25) lgkmcnt(8)
s_barrier
MAA 60,64,44
RD 0,23,18496
s_waitcnt vmcnt(21)
v_add_f32 v164, v164, v180
MAA 76,68,44
RD 4,23,20800
s_add_u32 m0, s56, 123648
MAA 80,68,48
buffer_load_dwordx4 v18, s[20:23], s54 offen lds
MAA 64,64,48
RD 8,23,23104
v_add_f32 v165, v165, v181
MAA 68,64,52
RD 12,23,25408
v_add_f32 v166, v166, v182
MAA 84,68,52
ds_read_b64_tr_b16 a[20:21], v25
v_add_f32 v167, v167, v183
MAA 88,68,56
TR 22,25,512
MAA 72,64,56
TR 24,25,32
s_waitcnt lgkmcnt(7)
MAA 244,68,60
TR 26,25,544
MAA 104,72,56
RD 16,24,18496
MAA 120,76,56
buffer_load_dwordx4 v19, s[20:23], s54 offen offset:1024 lds
MAA 116,76,52
TR 28,25,1024
MAA 100,72,52
TR 30,25,1536
MAA 96,72,48
TR 32,25,1056
MAA 112,76,48
TR 34,25,1568
MAA 108,76,44
TR 36,25,2048
MAA 92,72,44
TR 38,25,2560
MAA 124,44,80
TR 40,25,2080
MAA 140,44,84
buffer_load_dwordx4 v20, s[20:23], s54 offen offset:2048 lds
MAA 144,48,84
TR 42,25,2592
s_add_u32 s54, s54, 196608
MAA 128,48,80
MAA 132,52,80
MAA 148,52,84
MAA 152,56,84
MAA 136,56,80
MAA 156,60,80
MAA 160,60,84
s_waitcnt vmcnt(21) lgkmcnt(8)
s_barrier
MAA 60,20,0
RD 44,30,18496
s_waitcnt vmcnt(17)
v_add_f32 v164, v164, v184
MAA 76,24,0
RD 48,30,20800
s_add_u32 m0, s56, 136064
MAA 80,24,4
buffer_load_dwordx4 v18, s[20:23], s54 offen lds
MAA 64,20,4
RD 52,30,23104
v_add_f32 v165, v165, v185
MAA 68,20,8
RD 56,30,25408
v_add_f32 v166, v166, v186
MAA 84,24,8
TR 64,25,12416
v_add_f32 v167, v167, v187
MAA 88,24,12
TR 66,25,12928
MAA 72,20,12
TR 68,25,12448
s_waitcnt lgkmcnt(7)
MAA 244,24,16
TR 70,25,12960
MAA 104,28,12
RD 60,31,18496
MAA 120,32,12
buffer_load_dwordx4 v19, s[20:23], s54 offen offset:1024 lds
MAA 116,32,8
TR 72,25,13440
MAA 100,28,8
TR 74,25,13952
MAA 96,28,4
TR 76,25,13472
MAA 112,32,4
TR 78,25,13984
MAA 108,32,0
TR 80,25,14464
MAA 92,28,0
TR 82,25,14976
MAA 124,0,36
TR 84,25,14496
MAA 140,0,40
buffer_load_dwordx4 v20, s[20:23], s54 offen offset:2048 lds
MAA 144,4,40
TR 86,25,15008
s_add_u32 s54, s54, 196608
MAA 128,4,36
MAA 132,8,36
MAA 148,8,40
MAA 152,12,40
MAA 136,12,36
MAA 156,16,36
MAA 160,16,40
s_waitcnt vmcnt(17) lgkmcnt(8)
s_barrier
MAA 60,64,44
RD 0,23,36992
s_waitcnt vmcnt(13)
v_add_f32 v164, v164, v188
MAA 76,68,44
RD 4,23,39296
s_add_u32 m0, s59, 0
MAA 80,68,48
RD 8,23,41600
s_mov_b32 s58, 1048576
MAA 64,64,48
buffer_load_dwordx4 v5, s[24:27], s58 offen lds
MAA 68,64,52
RD 12,23,43904
v_add_f32 v165, v165, v189
MAA 84,68,52
TR 20,25,24832
v_add_f32 v166, v166, v190
MAA 88,68,56
TR 22,25,25344
v_add_f32 v167, v167, v191
MAA 72,64,56
buffer_load_dwordx4 v6, s[24:27], s58 offen offset:1024 lds
s_waitcnt lgkmcnt(6)
MAA 244,68,60
TR 24,25,24864
s_add_u32 m0, s59, 8320
MAA 104,72,56
TR 26,25,25376
s_mov_b32 s58, 1179648
MAA 120,76,56
RD 16,24,36992
MAA 116,76,52
buffer_load_dwordx4 v5, s[24:27], s58 offen lds
MAA 100,72,52
TR 28,25,25856
MAA 96,72,48
TR 30,25,26368
MAA 112,76,48
TR 32,25,25888
MAA 108,76,44
buffer_load_dwordx4 v6, s[24:27], s58 offen offset:1024 lds
MAA 92,72,44
TR 34,25,26400
s_add_u32 m0, s59, 16640
MAA 124,44,80
TR 36,25,26880
s_mov_b32 s58, 1310720
MAA 140,44,84
TR 38,25,27392
MAA 144,48,84
buffer_load_dwordx4 v5, s[24:27], s58 offen lds
MAA 128,48,80
TR 40,25,26912
MAA 132,52,80
TR 42,25,27424
MAA 148,52,84
MAA 152,56,84
buffer_load_dwordx4 v6, s[24:27], s58 offen offset:1024 lds
MAA 136,56,80
MAA 156,60,80
MAA 160,60,84
s_waitcnt vmcnt(16) lgkmcnt(8)
s_barrier
MAA 60,20,0
RD 44,30,36992
s_waitcnt vmcnt(12)
v_add_f32 v164, v164, v192
MAA 76,24,0
RD 48,30,39296
s_add_u32 m0, s59, 24960
MAA 80,24,4
RD 52,30,41600
s_mov_b32 s58, 1441792
MAA 64,20,4
buffer_load_dwordx4 v5, s[24:27], s58 offen lds
MAA 68,20,8
RD 56,30,43904
v_add_f32 v165, v165, v193
MAA 84,24,8
TR 64,25,37248
v_add_f32 v166, v166, v194
MAA 88,24,12
TR 66,25,37760
v_add_f32 v167, v167, v195
MAA 72,20,12
buffer_load_dwordx4 v6, s[24:27], s58 offen offset:1024 lds
s_waitcnt lgkmcnt(6)
MAA 244,24,16
TR 68,25,37280
s_add_u32 m0, s59, 74880
MAA 104,28,12
TR 70,25,37792
s_mov_b32 s58, 131072
MAA 120,32,12
RD 60,31,36992
MAA 116,32,8
buffer_load_dwordx4 v5, s[24:27], s58 offen lds
MAA 100,28,8
TR 72,25,38272
MAA 96,28,4
TR 74,25,38784
MAA 112,32,4
TR 76,25,38304
MAA 108,32,0
buffer_load_dwordx4 v6, s[24:27], s58 offen offset:1024 lds
MAA 92,28,0
TR 78,25,38816
s_add_u32 m0, s59, 83200
MAA 124,0,36
TR 80,25,39296
s_mov_b32 s58, 262144
MAA 140,0,40
TR 82,25,39808
MAA 144,4,40
buffer_load_dwordx4 v5, s[24:27], s58 offen lds
MAA 128,4,36
TR 84,25,39328
MAA 132,8,36
TR 86,25,39840
MAA 148,8,40
MAA 152,12,40
buffer_load_dwordx4 v6, s[24:27], s58 offen offset:1024 lds
MAA 136,12,36
MAA 156,16,36
MAA 160,16,40
s_waitcnt vmcnt(15) lgkmcnt(8)
s_barrier
MAA 60,64,44
RD 0,23,55488
MAA 76,68,44
RD 4,23,57792
s_add_u32 m0, s59, 33280
MAA 80,68,48
RD 8,23,60096
s_mov_b32 s58, 1572864
MAA 64,64,48
buffer_load_dwordx4 v5, s[24:27], s58 offen lds
MAA 68,64,52
RD 12,23,62400
MAA 84,68,52
TR 20,25,49664
MAA 88,68,56
TR 22,25,50176
MAA 72,64,56
buffer_load_dwordx4 v6, s[24:27], s58 offen offset:1024 lds
s_waitcnt lgkmcnt(6)
MAA 244,68,60
TR 24,25,49696
s_add_u32 m0, s59, 41600
MAA 104,72,56
TR 26,25,50208
s_mov_b32 s58, 1703936
MAA 120,76,56
RD 16,24,55488
MAA 116,76,52
buffer_load_dwordx4 v5, s[24:27], s58 offen lds
MAA 100,72,52
TR 28,25,50688
MAA 96,72,48
TR 30,25,51200
MAA 112,76,48
TR 32,25,50720
MAA 108,76,44
buffer_load_dwordx4 v6, s[24:27], s58 offen offset:1024 lds
MAA 92,72,44
TR 34,25,51232
s_add_u32 m0, s59, 91520
MAA 124,44,80
TR 36,25,51712
s_mov_b32 s58, 393216
MAA 140,44,84
TR 38,25,52224
MAA 144,48,84
buffer_load_dwordx4 v5, s[24:27], s58 offen lds
MAA 128,48,80
TR 40,25,51744
MAA 132,52,80
TR 42,25,52256
MAA 148,52,84
v_permlane32_swap_b32 v164, v166
MAA 152,56,84
buffer_load_dwordx4 v6, s[24:27], s58 offen offset:1024 lds
MAA 136,56,80
v_permlane32_swap_b32 v165, v167
MAA 156,60,80
v_add_f32 v164, v164, v166
v_add_f32 v165, v165, v167
MAA 160,60,84
v_mul_f32 v164, 0xba800000, v164
v_mul_f32 v165, 0x3a800000, v165
v_fma_f32 v165, -v164, v164, v165
v_max_f32 v165, 0, v165
v_add_f32 v165, 0x3727c5ac, v165
s_waitcnt vmcnt(18) lgkmcnt(8)
s_barrier
MAA 60,20,0
ds_write_b32 v17, v164
MAA 76,24,0
RD 44,30,55488
s_add_u32 m0, s59, 99840
MAA 80,24,4
RD 48,30,57792
s_mov_b32 s58, 524288
MAA 64,20,4
buffer_load_dwordx4 v5, s[24:27], s58 offen lds
MAA 68,20,8
RD 52,30,60096
MAA 84,24,8
RD 56,30,62400
MAA 88,24,12
TR 64,25,62080
MAA 72,20,12
TR 66,25,62592
s_waitcnt lgkmcnt(7)
MAA 244,24,16
TR 68,25,62112
MAA 104,28,12
buffer_load_dwordx4 v6, s[24:27], s58 offen offset:1024 lds
MAA 120,32,12
TR 70,25,62624
s_add_u32 m0, s59, 108160
MAA 116,32,8
RD 60,31,55488
s_mov_b32 s58, 655360
MAA 100,28,8
TR 72,25,63104
MAA 96,28,4
TR 74,25,63616
MAA 112,32,4
TR 76,25,63136
MAA 108,32,0
buffer_load_dwordx4 v5, s[24:27], s58 offen lds
MAA 92,28,0
TR 78,25,63648
MAA 124,0,36
TR 80,25,64128
MAA 140,0,40
TR 82,25,64640
MAA 144,4,40
TR 84,25,64160
MAA 128,4,36
TR 86,25,64672
MAA 132,8,36
buffer_load_dwordx4 v6, s[24:27], s58 offen offset:1024 lds
MAA 148,8,40
v_rsq_f32 v166, v165
MAA 152,12,40
v_mov_b32 v165, v166
v_mul_f32 v166, 0x3e8293ee, v166
MAA 136,12,36
ds_write_b128 v7, v[164:167]
MAA 156,16,36
ds_write_b32 v17, v165 offset:1024
MAA 160,16,40
s_waitcnt lgkmcnt(0)
s_barrier
MAA 244,68,60
ds_read_b128 v[232:235], v10 offset:1792
MAA 156,60,80
ds_read_b128 v[228:231], v10 offset:1536
MAA 160,60,84
ds_read_b128 v[224:227], v10 offset:1280
MAA 104,72,56
ds_read_b128 v[220:223], v10 offset:1024
MAA 120,76,56
MAA 136,56,80
MAA 152,56,84
MAA 100,72,52
MAA 116,76,52
s_mov_b32 exec_lo, 0x10001
s_mov_b32 exec_hi, 0x10001
ds_write_b128 v13, v[244:247] offset:64
s_mov_b64 exec, 0xffff
ds_write_b32 v12, v156 offset:512
ds_write_b32 v12, v160 offset:576
s_mov_b64 exec, -1
MAA 96,72,48
MAA 112,76,48
MAA 92,72,44
MAA 108,76,44
MAA 72,64,56
MAA 88,68,56
s_waitcnt lgkmcnt(0)
s_barrier
MAA 132,52,80
ds_read_b128 v[28:31], v13
s_add_u32 m0, s59, 49920
MAA 148,52,84
ds_read_b128 v[32:35], v13 offset:64
s_mov_b32 s58, 1835008
MAA 68,64,52
ds_read_b128 v[36:39], v13 offset:256
MAA 84,68,52
ds_read_b128 v[40:43], v13 offset:320
MAA 128,48,80
ds_read_b32 v44, v12 offset:512
MAA 144,48,84
ds_read_b32 v45, v12 offset:576
MAA 64,64,48
ds_read_b128 v[240:243], v11 offset:704
MAA 80,68,48
ds_read_b128 v[244:247], v11 offset:1728
MAA 124,44,80
buffer_load_dwordx4 v5, s[24:27], s58 offen lds
ds_read_b128 v[18:21], v11 offset:448
s_waitcnt lgkmcnt(8)
v_pk_fma_f32 v[72:73], v[28:29], v[232:233], v[72:73] op_sel_hi:[1,0,1]
v_pk_fma_f32 v[74:75], v[30:31], v[232:233], v[74:75] op_sel_hi:[1,0,1]
s_waitcnt lgkmcnt(6)
v_pk_fma_f32 v[104:105], v[36:37], v[232:233], v[104:105] op_sel_hi:[1,0,1]
v_pk_mul_f32 v[104:105], v[104:105], v[232:233] op_sel:[0,1] op_sel_hi:[1,1]
v_pk_fma_f32 v[106:107], v[38:39], v[232:233], v[106:107] op_sel_hi:[1,0,1]
v_pk_mul_f32 v[106:107], v[106:107], v[232:233] op_sel:[0,1] op_sel_hi:[1,1]
s_waitcnt lgkmcnt(5)
v_pk_fma_f32 v[120:121], v[40:41], v[232:233], v[120:121] op_sel_hi:[1,0,1]
v_pk_mul_f32 v[120:121], v[120:121], v[232:233] op_sel:[0,1] op_sel_hi:[1,1]
v_pk_fma_f32 v[122:123], v[42:43], v[232:233], v[122:123] op_sel_hi:[1,0,1]
v_pk_mul_f32 v[122:123], v[122:123], v[232:233] op_sel:[0,1] op_sel_hi:[1,1]
v_pk_fma_f32 v[100:101], v[36:37], v[228:229], v[100:101] op_sel_hi:[1,0,1]
v_pk_mul_f32 v[100:101], v[100:101], v[228:229] op_sel:[0,1] op_sel_hi:[1,1]
v_pk_fma_f32 v[102:103], v[38:39], v[228:229], v[102:103] op_sel_hi:[1,0,1]
v_pk_mul_f32 v[102:103], v[102:103], v[228:229] op_sel:[0,1] op_sel_hi:[1,1]
v_pk_fma_f32 v[116:117], v[40:41], v[228:229], v[116:117] op_sel_hi:[1,0,1]
v_pk_mul_f32 v[116:117], v[116:117], v[228:229] op_sel:[0,1] op_sel_hi:[1,1]
v_pk_fma_f32 v[118:119], v[42:43], v[228:229], v[118:119] op_sel_hi:[1,0,1]
v_pk_mul_f32 v[118:119], v[118:119], v[228:229] op_sel:[0,1] op_sel_hi:[1,1]
s_waitcnt lgkmcnt(2)
v_pk_fma_f32 v[156:157], v[240:241], v[44:45], v[156:157] op_sel_hi:[1,0,1]
v_pk_fma_f32 v[158:159], v[242:243], v[44:45], v[158:159] op_sel_hi:[1,0,1]
v_pk_fma_f32 v[160:161], v[240:241], v[44:45], v[160:161] op_sel:[0,1,0] op_sel_hi:[1,1,1]
v_pk_fma_f32 v[162:163], v[242:243], v[44:45], v[162:163] op_sel:[0,1,0] op_sel_hi:[1,1,1]
s_waitcnt lgkmcnt(1)
v_pk_mul_f32 v[156:157], v[156:157], v[244:245]
v_pk_mul_f32 v[158:159], v[158:159], v[246:247]
v_pk_mul_f32 v[160:161], v[160:161], v[244:245]
v_pk_mul_f32 v[162:163], v[162:163], v[246:247]
v_pk_fma_f32 v[88:89], v[32:33], v[232:233], v[88:89] op_sel_hi:[1,0,1]
v_pk_fma_f32 v[90:91], v[34:35], v[232:233], v[90:91] op_sel_hi:[1,0,1]
v_pk_fma_f32 v[96:97], v[36:37], v[224:225], v[96:97] op_sel_hi:[1,0,1]
s_waitcnt lgkmcnt(0)
v_pk_fma_f32 v[136:137], v[18:19], v[44:45], v[136:137] op_sel_hi:[1,0,1]
v_pk_fma_f32 v[138:139], v[20:21], v[44:45], v[138:139] op_sel_hi:[1,0,1]
v_pk_fma_f32 v[152:153], v[18:19], v[44:45], v[152:153] op_sel:[0,1,0] op_sel_hi:[1,1,1]
v_pk_fma_f32 v[154:155], v[20:21], v[44:45], v[154:155] op_sel:[0,1,0] op_sel_hi:[1,1,1]
v_pk_mul_f32 v[96:97], v[96:97], v[224:225] op_sel:[0,1] op_sel_hi:[1,1]
v_pk_fma_f32 v[98:99], v[38:39], v[224:225], v[98:99] op_sel_hi:[1,0,1]
v_pk_mul_f32 v[98:99], v[98:99], v[224:225] op_sel:[0,1] op_sel_hi:[1,1]
v_pk_fma_f32 v[112:113], v[40:41], v[224:225], v[112:113] op_sel_hi:[1,0,1]
v_pk_mul_f32 v[112:113], v[112:113], v[224:225] op_sel:[0,1] op_sel_hi:[1,1]
v_pk_fma_f32 v[114:115], v[42:43], v[224:225], v[114:115] op_sel_hi:[1,0,1]
v_pk_mul_f32 v[114:115], v[114:115], v[224:225] op_sel:[0,1] op_sel_hi:[1,1]
v_pk_fma_f32 v[68:69], v[28:29], v[228:229], v[68:69] op_sel_hi:[1,0,1]
v_pk_fma_f32 v[70:71], v[30:31], v[228:229], v[70:71] op_sel_hi:[1,0,1]
v_pk_fma_f32 v[84:85], v[32:33], v[228:229], v[84:85] op_sel_hi:[1,0,1]
v_pk_fma_f32 v[86:87], v[34:35], v[228:229], v[86:87] op_sel_hi:[1,0,1]
v_pk_fma_f32 v[92:93], v[36:37], v[220:221], v[92:93] op_sel_hi:[1,0,1]
v_pk_mul_f32 v[92:93], v[92:93], v[220:221] op_sel:[0,1] op_sel_hi:[1,1]
v_pk_fma_f32 v[94:95], v[38:39], v[220:221], v[94:95] op_sel_hi:[1,0,1]
v_pk_mul_f32 v[94:95], v[94:95], v[220:221] op_sel:[0,1] op_sel_hi:[1,1]
v_pk_fma_f32 v[108:109], v[40:41], v[220:221], v[108:109] op_sel_hi:[1,0,1]
v_pk_mul_f32 v[108:109], v[108:109], v[220:221] op_sel:[0,1] op_sel_hi:[1,1]
v_pk_fma_f32 v[110:111], v[42:43], v[220:221], v[110:111] op_sel_hi:[1,0,1]
v_pk_mul_f32 v[110:111], v[110:111], v[220:221] op_sel:[0,1] op_sel_hi:[1,1]
v_pk_fma_f32 v[64:65], v[28:29], v[224:225], v[64:65] op_sel_hi:[1,0,1]
v_pk_fma_f32 v[66:67], v[30:31], v[224:225], v[66:67] op_sel_hi:[1,0,1]
v_pk_fma_f32 v[80:81], v[32:33], v[224:225], v[80:81] op_sel_hi:[1,0,1]
v_pk_fma_f32 v[82:83], v[34:35], v[224:225], v[82:83] op_sel_hi:[1,0,1]
v_cvt_pk_bf16_f32 v236, v156, v157
v_cvt_pk_bf16_f32 v237, v158, v159
MAA 140,44,84
buffer_load_dwordx4 v6, s[24:27], s58 offen offset:1024 lds
MAA 60,64,44
ds_read_b128 v[22:25], v11 offset:1472
v_cvt_pk_bf16_f32 v238, v160, v161
MAA 76,68,44
ds_read_b128 v[240:243], v11 offset:384
v_cvt_pk_bf16_f32 v239, v162, v163
ds_write_b128 v8, v[236:239] offset:1024
s_add_u32 m0, s59, 58240
s_mov_b32 s58, 1966080
v_cvt_pk_bf16_f32 v196, v104, v105
buffer_load_dwordx4 v5, s[24:27], s58 offen lds
v_cvt_pk_bf16_f32 v197, v106, v107
v_cvt_pk_bf16_f32 v198, v120, v121
v_cvt_pk_bf16_f32 v199, v122, v123
v_cvt_pk_bf16_f32 v192, v100, v101
v_cvt_pk_bf16_f32 v193, v102, v103
v_cvt_pk_bf16_f32 v194, v116, v117
v_cvt_pk_bf16_f32 v195, v118, v119
v_cvt_pk_bf16_f32 v176, v72, v73
v_cvt_pk_bf16_f32 v177, v74, v75
v_cvt_pk_bf16_f32 v178, v88, v89
v_cvt_pk_bf16_f32 v179, v90, v91
v_pk_fma_f32 v[60:61], v[28:29], v[220:221], v[60:61] op_sel_hi:[1,0,1]
v_pk_fma_f32 v[62:63], v[30:31], v[220:221], v[62:63] op_sel_hi:[1,0,1]
v_pk_fma_f32 v[76:77], v[32:33], v[220:221], v[76:77] op_sel_hi:[1,0,1]
v_pk_fma_f32 v[78:79], v[34:35], v[220:221], v[78:79] op_sel_hi:[1,0,1]
ds_read_b128 v[244:247], v11 offset:1408
s_nop 0
v_mfma_f32_16x16x32_bf16 v[104:107], v[192:195], v[176:179], v[46:49]
buffer_load_dwordx4 v6, s[24:27], s58 offen offset:1024 lds
s_add_u32 m0, s59, 66560
s_mov_b32 s58, 0
v_cvt_pk_bf16_f32 v188, v96, v97
s_waitcnt lgkmcnt(3)
v_pk_mul_f32 v[136:137], v[136:137], v[22:23]
v_pk_mul_f32 v[138:139], v[138:139], v[24:25]
v_pk_mul_f32 v[152:153], v[152:153], v[22:23]
v_pk_mul_f32 v[154:155], v[154:155], v[24:25]
s_waitcnt lgkmcnt(2)
v_pk_fma_f32 v[132:133], v[240:241], v[44:45], v[132:133] op_sel_hi:[1,0,1]
v_pk_fma_f32 v[134:135], v[242:243], v[44:45], v[134:135] op_sel_hi:[1,0,1]
v_pk_fma_f32 v[148:149], v[240:241], v[44:45], v[148:149] op_sel:[0,1,0] op_sel_hi:[1,1,1]
v_pk_fma_f32 v[150:151], v[242:243], v[44:45], v[150:151] op_sel:[0,1,0] op_sel_hi:[1,1,1]
s_waitcnt lgkmcnt(1)
s_barrier
v_cvt_pk_bf16_f32 v208, v136, v137
v_mfma_f32_16x16x32_bf16 v[120:123], v[196:199], v[176:179], v[50:53]
ds_read_b128 v[180:183], v9
ds_read_b64 v[200:201], v9 offset:1024
ds_read_b64 v[210:211], v9 offset:1032
buffer_load_dwordx4 v5, s[24:27], s58 offen lds
v_cvt_pk_bf16_f32 v209, v138, v139
v_cvt_pk_bf16_f32 v218, v152, v153
v_cvt_pk_bf16_f32 v219, v154, v155
s_waitcnt lgkmcnt(3)
v_pk_mul_f32 v[132:133], v[132:133], v[244:245]
v_cvt_pk_bf16_f32 v206, v132, v133
v_pk_mul_f32 v[134:135], v[134:135], v[246:247]
v_cvt_pk_bf16_f32 v207, v134, v135
v_pk_mul_f32 v[148:149], v[148:149], v[244:245]
v_cvt_pk_bf16_f32 v216, v148, v149
v_pk_mul_f32 v[150:151], v[150:151], v[246:247]
v_cvt_pk_bf16_f32 v217, v150, v151
v_max3_f32 v88, v104, v105, v106
v_max3_f32 v89, v107, v120, v121
buffer_load_dwordx4 v6, s[24:27], s58 offen offset:1024 lds
s_add_u32 m0, s59, 116480
s_mov_b32 s58, 786432
v_max3_f32 v88, v88, v122, v123
v_max_f32 v90, v88, v89
v_max_f32 v89, v88, v89
v_cvt_pk_bf16_f32 v189, v98, v99
v_cvt_pk_bf16_f32 v190, v112, v113
v_permlane16_swap_b32 v90, v89
v_cvt_pk_bf16_f32 v191, v114, v115
v_max_f32 v88, v90, v89
v_max_f32 v89, v90, v89
v_cvt_pk_bf16_f32 v172, v68, v69
buffer_load_dwordx4 v5, s[24:27], s58 offen lds
v_permlane32_swap_b32 v88, v89
v_cvt_pk_bf16_f32 v173, v70, v71
v_max_f32 v88, v88, v89
v_mul_f32 v88, v88, v234
v_pk_fma_f32 v[104:105], v[104:105], v[234:235], v[88:89] op_sel_hi:[1,0,0] neg_lo:[0,0,1] neg_hi:[0,0,1]
v_pk_fma_f32 v[106:107], v[106:107], v[234:235], v[88:89] op_sel_hi:[1,0,0] neg_lo:[0,0,1] neg_hi:[0,0,1]
v_pk_fma_f32 v[120:121], v[120:121], v[234:235], v[88:89] op_sel_hi:[1,0,0] neg_lo:[0,0,1] neg_hi:[0,0,1]
v_pk_fma_f32 v[122:123], v[122:123], v[234:235], v[88:89] op_sel_hi:[1,0,0] neg_lo:[0,0,1] neg_hi:[0,0,1]
v_exp_f32 v104, v104
v_exp_f32 v105, v105
v_exp_f32 v106, v106
v_exp_f32 v107, v107
v_exp_f32 v120, v120
v_exp_f32 v121, v121
v_exp_f32 v122, v122
v_exp_f32 v123, v123
v_cvt_pk_bf16_f32 v72, v104, v105
buffer_load_dwordx4 v6, s[24:27], s58 offen offset:1024 lds
s_add_u32 m0, s59, 124800
s_mov_b32 s58, 917504
v_cvt_pk_bf16_f32 v73, v106, v107
v_cvt_pk_bf16_f32 v74, v120, v121
v_cvt_pk_bf16_f32 v75, v122, v123
v_cvt_pk_bf16_f32 v174, v84, v85
v_cvt_pk_bf16_f32 v175, v86, v87
v_mfma_f32_16x16x32_bf16 v[88:91], v[248:251], v[72:75], 0
ds_read_b128 v[18:21], v11 offset:320
v_cvt_pk_bf16_f32 v184, v92, v93
v_mfma_f32_16x16x32_bf16 v[104:107], v[206:209], v[72:75], 0
ds_read_b128 v[22:25], v11 offset:1344
v_cvt_pk_bf16_f32 v185, v94, v95
v_mfma_f32_16x16x32_bf16 v[120:123], v[216:219], v[72:75], 0
buffer_load_dwordx4 v5, s[24:27], s58 offen lds
v_mfma_f32_16x16x32_bf16 v[100:103], v[188:191], v[172:175], v[46:49]
ds_read_b128 v[240:243], v11 offset:256
v_rcp_f32 v88, v88
v_mfma_f32_16x16x32_bf16 v[116:119], v[192:195], v[172:175], v[50:53]
ds_read_b128 v[244:247], v11 offset:1280
v_cvt_pk_bf16_f32 v186, v108, v109
s_nop 2
v_max3_f32 v84, v100, v101, v102
v_cvt_pk_bf16_f32 v187, v110, v111
v_cvt_pk_bf16_f32 v168, v64, v65
v_pk_mul_f32 v[104:105], v[104:105], v[88:89] op_sel_hi:[1,0]
buffer_load_dwordx4 v6, s[24:27], s58 offen offset:1024 lds
v_pk_mul_f32 v[106:107], v[106:107], v[88:89] op_sel_hi:[1,0]
v_pk_mul_f32 v[120:121], v[120:121], v[88:89] op_sel_hi:[1,0]
v_pk_mul_f32 v[122:123], v[122:123], v[88:89] op_sel_hi:[1,0]
v_cvt_pk_bf16_f32 v176, v104, v105
v_cvt_pk_bf16_f32 v177, v106, v107
v_cvt_pk_bf16_f32 v178, v120, v121
v_cvt_pk_bf16_f32 v179, v122, v123
s_waitcnt lgkmcnt(3)
v_pk_fma_f32 v[128:129], v[18:19], v[44:45], v[128:129] op_sel_hi:[1,0,1]
v_pk_fma_f32 v[130:131], v[20:21], v[44:45], v[130:131] op_sel_hi:[1,0,1]
s_waitcnt lgkmcnt(2)
v_pk_mul_f32 v[128:129], v[128:129], v[22:23]
v_cvt_pk_bf16_f32 v204, v128, v129
v_pk_mul_f32 v[130:131], v[130:131], v[24:25]
v_cvt_pk_bf16_f32 v205, v130, v131
buffer_store_dwordx4 v[176:179], v4, s[16:19], s74 offen offset:3072 sc1
v_pk_fma_f32 v[144:145], v[18:19], v[44:45], v[144:145] op_sel:[0,1,0] op_sel_hi:[1,1,1]
v_pk_mul_f32 v[144:145], v[144:145], v[22:23]
v_cvt_pk_bf16_f32 v214, v144, v145
v_pk_fma_f32 v[146:147], v[20:21], v[44:45], v[146:147] op_sel:[0,1,0] op_sel_hi:[1,1,1]
v_pk_mul_f32 v[146:147], v[146:147], v[24:25]
v_cvt_pk_bf16_f32 v215, v146, v147
v_max3_f32 v85, v103, v116, v117
v_max3_f32 v84, v84, v118, v119
v_max_f32 v86, v84, v85
v_max_f32 v85, v84, v85
v_cvt_pk_bf16_f32 v169, v66, v67
v_cvt_pk_bf16_f32 v170, v80, v81
v_permlane16_swap_b32 v86, v85
v_cvt_pk_bf16_f32 v171, v82, v83
s_waitcnt lgkmcnt(1)
v_pk_fma_f32 v[124:125], v[240:241], v[44:45], v[124:125] op_sel_hi:[1,0,1]
s_waitcnt lgkmcnt(0)
v_pk_mul_f32 v[124:125], v[124:125], v[244:245]
v_pk_fma_f32 v[126:127], v[242:243], v[44:45], v[126:127] op_sel_hi:[1,0,1]
v_pk_mul_f32 v[126:127], v[126:127], v[246:247]
v_pk_fma_f32 v[140:141], v[240:241], v[44:45], v[140:141] op_sel:[0,1,0] op_sel_hi:[1,1,1]
v_pk_mul_f32 v[140:141], v[140:141], v[244:245]
v_pk_fma_f32 v[142:143], v[242:243], v[44:45], v[142:143] op_sel:[0,1,0] op_sel_hi:[1,1,1]
v_pk_mul_f32 v[142:143], v[142:143], v[246:247]
v_max_f32 v84, v86, v85
v_max_f32 v85, v86, v85
v_mfma_f32_16x16x32_bf16 v[96:99], v[184:187], v[168:171], v[46:49]
s_nop 0
v_permlane32_swap_b32 v84, v85
v_mfma_f32_16x16x32_bf16 v[112:115], v[188:191], v[168:171], v[50:53]
v_max_f32 v84, v84, v85
v_mul_f32 v84, v84, v230
v_cvt_pk_bf16_f32 v202, v124, v125
v_cvt_pk_bf16_f32 v203, v126, v127
v_cvt_pk_bf16_f32 v212, v140, v141
v_pk_fma_f32 v[100:101], v[100:101], v[230:231], v[84:85] op_sel_hi:[1,0,0] neg_lo:[0,0,1] neg_hi:[0,0,1]
v_pk_fma_f32 v[102:103], v[102:103], v[230:231], v[84:85] op_sel_hi:[1,0,0] neg_lo:[0,0,1] neg_hi:[0,0,1]
v_pk_fma_f32 v[116:117], v[116:117], v[230:231], v[84:85] op_sel_hi:[1,0,0] neg_lo:[0,0,1] neg_hi:[0,0,1]
v_pk_fma_f32 v[118:119], v[118:119], v[230:231], v[84:85] op_sel_hi:[1,0,0] neg_lo:[0,0,1] neg_hi:[0,0,1]
v_exp_f32 v100, v100
v_exp_f32 v101, v101
v_exp_f32 v102, v102
v_exp_f32 v103, v103
v_exp_f32 v116, v116
v_exp_f32 v117, v117
v_exp_f32 v118, v118
v_exp_f32 v119, v119
v_cvt_pk_bf16_f32 v68, v100, v101
v_cvt_pk_bf16_f32 v69, v102, v103
v_cvt_pk_bf16_f32 v70, v116, v117
v_cvt_pk_bf16_f32 v71, v118, v119
v_cvt_pk_bf16_f32 v213, v142, v143
v_max3_f32 v80, v96, v97, v98
v_mfma_f32_16x16x32_bf16 v[84:87], v[248:251], v[68:71], 0
v_max3_f32 v81, v99, v112, v113
v_max3_f32 v80, v80, v114, v115
v_mfma_f32_16x16x32_bf16 v[100:103], v[204:207], v[68:71], 0
v_max_f32 v82, v80, v81
v_max_f32 v81, v80, v81
v_mfma_f32_16x16x32_bf16 v[116:119], v[214:217], v[68:71], 0
s_nop 1
v_rcp_f32 v84, v84
v_permlane16_swap_b32 v82, v81
v_cvt_pk_bf16_f32 v164, v60, v61
v_pk_mul_f32 v[100:101], v[100:101], v[84:85] op_sel_hi:[1,0]
v_pk_mul_f32 v[102:103], v[102:103], v[84:85] op_sel_hi:[1,0]
s_nop 0
v_pk_mul_f32 v[116:117], v[116:117], v[84:85] op_sel_hi:[1,0]
v_pk_mul_f32 v[118:119], v[118:119], v[84:85] op_sel_hi:[1,0]
v_cvt_pk_bf16_f32 v172, v100, v101
v_cvt_pk_bf16_f32 v173, v102, v103
v_cvt_pk_bf16_f32 v174, v116, v117
v_cvt_pk_bf16_f32 v175, v118, v119
buffer_store_dwordx4 v[172:175], v4, s[16:19], s74 offen offset:2048 sc1
v_max_f32 v80, v82, v81
v_max_f32 v81, v82, v81
v_cvt_pk_bf16_f32 v165, v62, v63
v_cvt_pk_bf16_f32 v166, v76, v77
v_permlane32_swap_b32 v80, v81
v_cvt_pk_bf16_f32 v167, v78, v79
v_max_f32 v80, v80, v81
v_mul_f32 v80, v80, v226
v_mfma_f32_16x16x32_bf16 v[92:95], v[180:183], v[164:167], v[46:49]
v_mfma_f32_16x16x32_bf16 v[108:111], v[184:187], v[164:167], v[50:53]
s_nop 6
v_max3_f32 v76, v92, v93, v94
v_pk_fma_f32 v[96:97], v[96:97], v[226:227], v[80:81] op_sel_hi:[1,0,0] neg_lo:[0,0,1] neg_hi:[0,0,1]
v_pk_fma_f32 v[98:99], v[98:99], v[226:227], v[80:81] op_sel_hi:[1,0,0] neg_lo:[0,0,1] neg_hi:[0,0,1]
v_pk_fma_f32 v[112:113], v[112:113], v[226:227], v[80:81] op_sel_hi:[1,0,0] neg_lo:[0,0,1] neg_hi:[0,0,1]
v_pk_fma_f32 v[114:115], v[114:115], v[226:227], v[80:81] op_sel_hi:[1,0,0] neg_lo:[0,0,1] neg_hi:[0,0,1]
v_exp_f32 v96, v96
v_exp_f32 v97, v97
v_exp_f32 v98, v98
v_exp_f32 v99, v99
v_exp_f32 v112, v112
v_exp_f32 v113, v113
v_exp_f32 v114, v114
v_exp_f32 v115, v115
v_cvt_pk_bf16_f32 v64, v96, v97
v_cvt_pk_bf16_f32 v65, v98, v99
v_cvt_pk_bf16_f32 v66, v112, v113
v_cvt_pk_bf16_f32 v67, v114, v115
v_max3_f32 v77, v95, v108, v109
v_max3_f32 v76, v76, v110, v111
v_mfma_f32_16x16x32_bf16 v[80:83], v[248:251], v[64:67], 0
v_max_f32 v78, v76, v77
v_max_f32 v77, v76, v77
v_mfma_f32_16x16x32_bf16 v[96:99], v[202:205], v[64:67], 0
s_nop 0
v_permlane16_swap_b32 v78, v77
v_mfma_f32_16x16x32_bf16 v[112:115], v[212:215], v[64:67], 0
s_nop 1
v_rcp_f32 v80, v80
v_max_f32 v76, v78, v77
v_max_f32 v77, v78, v77
v_pk_mul_f32 v[96:97], v[96:97], v[80:81] op_sel_hi:[1,0]
v_pk_mul_f32 v[98:99], v[98:99], v[80:81] op_sel_hi:[1,0]
s_nop 0
v_pk_mul_f32 v[112:113], v[112:113], v[80:81] op_sel_hi:[1,0]
v_pk_mul_f32 v[114:115], v[114:115], v[80:81] op_sel_hi:[1,0]
v_cvt_pk_bf16_f32 v168, v96, v97
v_cvt_pk_bf16_f32 v169, v98, v99
v_cvt_pk_bf16_f32 v170, v112, v113
v_cvt_pk_bf16_f32 v171, v114, v115
buffer_store_dwordx4 v[168:171], v4, s[16:19], s74 offen offset:1024 sc1
v_permlane32_swap_b32 v76, v77
v_max_f32 v76, v76, v77
v_mul_f32 v76, v76, v222
v_pk_fma_f32 v[92:93], v[92:93], v[222:223], v[76:77] op_sel_hi:[1,0,0] neg_lo:[0,0,1] neg_hi:[0,0,1]
v_pk_fma_f32 v[94:95], v[94:95], v[222:223], v[76:77] op_sel_hi:[1,0,0] neg_lo:[0,0,1] neg_hi:[0,0,1]
v_pk_fma_f32 v[108:109], v[108:109], v[222:223], v[76:77] op_sel_hi:[1,0,0] neg_lo:[0,0,1] neg_hi:[0,0,1]
v_pk_fma_f32 v[110:111], v[110:111], v[222:223], v[76:77] op_sel_hi:[1,0,0] neg_lo:[0,0,1] neg_hi:[0,0,1]
v_exp_f32 v92, v92
v_exp_f32 v93, v93
v_exp_f32 v94, v94
v_exp_f32 v95, v95
v_exp_f32 v108, v108
v_exp_f32 v109, v109
v_exp_f32 v110, v110
v_exp_f32 v111, v111
v_cvt_pk_bf16_f32 v60, v92, v93
v_cvt_pk_bf16_f32 v61, v94, v95
v_cvt_pk_bf16_f32 v62, v108, v109
v_cvt_pk_bf16_f32 v63, v110, v111
s_nop 1
v_mfma_f32_16x16x32_bf16 v[76:79], v[248:251], v[60:63], 0
v_mfma_f32_16x16x32_bf16 v[92:95], v[200:203], v[60:63], 0
v_mfma_f32_16x16x32_bf16 v[108:111], v[210:213], v[60:63], 0
s_nop 5
v_rcp_f32 v76, v76
s_nop 0
v_pk_mul_f32 v[92:93], v[92:93], v[76:77] op_sel_hi:[1,0]
v_pk_mul_f32 v[94:95], v[94:95], v[76:77] op_sel_hi:[1,0]
v_pk_mul_f32 v[108:109], v[108:109], v[76:77] op_sel_hi:[1,0]
v_pk_mul_f32 v[110:111], v[110:111], v[76:77] op_sel_hi:[1,0]
v_cvt_pk_bf16_f32 v164, v92, v93
v_cvt_pk_bf16_f32 v165, v94, v95
v_cvt_pk_bf16_f32 v166, v108, v109
v_cvt_pk_bf16_f32 v167, v110, v111
buffer_store_dwordx4 v[164:167], v4, s[16:19], s74 offen sc1
s_nop 1
.Lqkve3:
s_lshl_b32 s62, s3, 11
s_add_u32 s62, s62, s84
v_lshl_add_u32 v4, v1, 4, s62
v_lshrrev_b32 v2, 3, v1
v_cmp_eq_u32 vcc, 3, v2
v_add_u32 v2, 67108480, v4
s_nop 0
v_cndmask_b32 v4, v4, v2, vcc
v_bfe_u32 v5, v1, 3, 1
v_lshrrev_b32 v2, 4, v1
v_lshl_add_u32 v5, v2, 3, v5
s_lshl_b32 s62, s3, 1
v_add_u32 v5, s62, v5
v_mul_u32_u24 v5, 2048, v5
v_and_b32 v2, 7, v1
v_lshl_add_u32 v5, v2, 4, v5
s_lshl_b32 s62, s7, 7
v_add_u32 v5, s62, v5
v_add_u32 v6, 64512, v5
v_bfe_u32 v8, v1, 3, 2
v_mul_u32_u24 v8, 2080, v8
v_bfe_u32 v2, v1, 2, 1
v_lshl_add_u32 v8, v2, 7, v8
v_bfe_u32 v2, v1, 5, 1
v_lshl_add_u32 v8, v2, 8, v8
v_and_b32 v2, 3, v1
v_lshl_add_u32 v8, v2, 3, v8
s_mov_b32 s57, 66560
v_add_u32 v7, s57, v8
s_mov_b32 s52, 4194304
s_mov_b32 s53, 4325376
s_mov_b32 s54, 2097152
s_mul_i32 s56, s3, 2080
v_accvgpr_read_b32 v32, a224
v_accvgpr_read_b32 v33, a225
v_accvgpr_read_b32 v34, a226
v_accvgpr_read_b32 v35, a227
v_accvgpr_read_b32 v36, a228
v_accvgpr_read_b32 v37, a229
v_accvgpr_read_b32 v38, a230
v_accvgpr_read_b32 v39, a231
v_accvgpr_read_b32 v40, a232
v_accvgpr_read_b32 v41, a233
v_accvgpr_read_b32 v42, a234
v_accvgpr_read_b32 v43, a235
v_accvgpr_read_b32 v44, a236
v_accvgpr_read_b32 v45, a237
v_accvgpr_read_b32 v46, a238
v_accvgpr_read_b32 v47, a239
v_accvgpr_read_b32 v48, a240
v_accvgpr_read_b32 v49, a241
v_accvgpr_read_b32 v50, a242
v_accvgpr_read_b32 v51, a243
v_accvgpr_read_b32 v52, a244
v_accvgpr_read_b32 v53, a245
v_accvgpr_read_b32 v54, a246
v_accvgpr_read_b32 v55, a247
v_accvgpr_read_b32 v56, a248
v_accvgpr_read_b32 v57, a249
v_accvgpr_read_b32 v58, a250
v_accvgpr_read_b32 v59, a251
v_accvgpr_read_b32 v60, a252
v_accvgpr_read_b32 v61, a253
v_accvgpr_read_b32 v62, a254
v_accvgpr_read_b32 v63, a255
s_lshl_b32 s62, s49, 3
s_add_u32 s62, s62, s48
s_mul_i32 s62, s62, 28672
s_add_u32 s62, s62, s51
v_lshrrev_b32 v12, 4, v1
v_mul_u32_u24 v12, 57344, v12
v_and_b32 v2, 15, v1
v_lshl_add_u32 v12, v2, 4, v12
v_add_u32 v12, s62, v12
v_add_u32 v13, 6112, v12
v_add_u32 v14, 12224, v12
v_add_u32 v15, 18336, v12
s_mul_i32 s59, s3, 4224
s_mov_b32 s58, 0
s_mov_b32 s36, s0
s_mov_b32 s37, s1
s_lshl_b32 s62, s8, 10
s_add_u32 s62, s62, 30425088
s_lshl_b32 s64, s6, 10
s_add_u32 s64, s64, 30425088
s_lshr_b32 s67, s5, 2
s_and_b32 s67, s67, 3
s_lshl_b32 s67, s67, 7
s_add_u32 s64, s64, s67
v_lshl_add_u32 v252, v1, 7, s62
v_mov_b32 v253, s64
v_mov_b32 v255, 1
s_waitcnt vmcnt(0) lgkmcnt(0)
s_cmp_lg_u32 s3, 1
s_barrier
s_cbranch_scc1 .Lnopoll33
s_mov_b64 exec, 15
buffer_atomic_add v255, v252, s[16:19], 0 offen
s_mov_b64 exec, 1
v_mov_b32 v254, 0
buffer_atomic_add v254, v253, s[16:19], 0 offen sc0
s_sleep 5
s_mov_b32 s15, 0
.Lpoll32:
v_mov_b32 v255, 0
buffer_atomic_add v255, v253, s[16:19], 0 offen sc0
s_waitcnt vmcnt(1)
v_cmp_gt_u32 vcc, 16, v254
s_add_u32 s15, s15, 1
s_cbranch_vccz .Lnopoll33r
v_mov_b32 v254, 0
buffer_atomic_add v254, v253, s[16:19], 0 offen sc0
s_waitcnt vmcnt(1)
v_cmp_gt_u32 vcc, 16, v255
s_add_u32 s15, s15, 1
s_cbranch_vccz .Lnopoll33r
s_cmp_le_u32 s15, 100000
s_cbranch_scc1 .Lpoll32
s_branch .Lnopoll33r
.Lnopoll33:
s_mov_b64 exec, 0
s_cmp_eq_u32 s3, 2
s_cbranch_scc1 .Lpad1
s_cmp_eq_u32 s3, 3
s_cbranch_scc1 .Lpad2
s_branch .Lpad3
.Lnopoll33r:
s_mov_b64 exec, -1
s_barrier
buffer_load_dwordx4 v[64:67], v4, s[16:19], s52 offen sc1
buffer_load_dwordx4 v[68:71], v4, s[16:19], s52 offen offset:1024 sc1
s_add_u32 s52, s52, 262144
buffer_load_dwordx4 v[72:75], v4, s[16:19], s53 offen sc1
buffer_load_dwordx4 v[76:79], v4, s[16:19], s53 offen offset:1024 sc1
s_add_u32 s53, s53, 262144
buffer_load_dwordx4 v[80:83], v4, s[16:19], s52 offen sc1
buffer_load_dwordx4 v[84:87], v4, s[16:19], s52 offen offset:1024 sc1
s_add_u32 s52, s52, 262144
buffer_load_dwordx4 v[88:91], v4, s[16:19], s53 offen sc1
buffer_load_dwordx4 v[92:95], v4, s[16:19], s53 offen offset:1024 sc1
s_add_u32 s53, s53, 262144
buffer_load_dwordx4 v[96:99], v4, s[16:19], s52 offen sc1
buffer_load_dwordx4 v[100:103], v4, s[16:19], s52 offen offset:1024 sc1
s_add_u32 s52, s52, 262144
buffer_load_dwordx4 v[104:107], v4, s[16:19], s53 offen sc1
buffer_load_dwordx4 v[108:111], v4, s[16:19], s53 offen offset:1024 sc1
s_add_u32 s53, s53, 262144
ds_read_b64_tr_b16 a[0:1], v7
TR 2,7,512
TR 16,7,1024
TR 18,7,1536
TR 4,7,32
TR 6,7,544
TR 20,7,1056
TR 22,7,1568
TR 8,7,64
TR 10,7,576
TR 24,7,1088
TR 26,7,1600
TR 12,7,96
TR 14,7,608
TR 28,7,1120
TR 30,7,1632
s_waitcnt vmcnt(8) lgkmcnt(14)
MAV 32,0,64
TR 32,7,8320
TR 34,7,8832
s_waitcnt lgkmcnt(14)
MAV 32,16,72
buffer_load_dwordx4 v[112:115], v4, s[16:19], s52 offen sc1
MAV 48,16,76
TR 48,7,9344
TR 50,7,9856
MAV 48,0,68
TR 36,7,8352
s_waitcnt lgkmcnt(15)
MAV 52,4,68
buffer_load_dwordx4 v[116:119], v4, s[16:19], s52 offen offset:1024 sc1
s_waitcnt lgkmcnt(13)
MAV 52,20,76
TR 38,7,8864
s_add_u32 s52, s52, 262144
MAV 36,20,72
TR 52,7,9376
MAV 36,4,64
TR 54,7,9888
s_waitcnt lgkmcnt(14)
MAV 40,8,64
buffer_load_dwordx4 v[120:123], v4, s[16:19], s53 offen sc1
s_waitcnt lgkmcnt(12)
MAV 40,24,72
TR 40,7,8384
TR 42,7,8896
MAV 56,24,76
TR 56,7,9408
MAV 56,8,68
TR 58,7,9920
TR 44,7,8416
s_waitcnt lgkmcnt(15)
MAV 60,12,68
buffer_load_dwordx4 v[124:127], v4, s[16:19], s53 offen offset:1024 sc1
s_waitcnt lgkmcnt(13)
MAV 60,28,76
s_add_u32 s53, s53, 262144
MAV 44,28,72
TR 46,7,8928
TR 60,7,9440
MAV 44,12,64
TR 62,7,9952
s_waitcnt vmcnt(8) lgkmcnt(8)
MAV 32,32,80
TR 0,7,16640
TR 2,7,17152
MAV 32,48,88
buffer_load_dwordx4 v[64:67], v4, s[16:19], s52 offen sc1
MAV 48,48,92
TR 16,7,17664
TR 18,7,18176
MAV 48,32,84
TR 4,7,16672
MAV 52,36,84
buffer_load_dwordx4 v[68:71], v4, s[16:19], s52 offen offset:1024 sc1
MAV 52,52,92
TR 6,7,17184
s_add_u32 s52, s52, 262144
MAV 36,52,88
TR 20,7,17696
MAV 36,36,80
TR 22,7,18208
s_waitcnt lgkmcnt(8)
MAV 40,40,80
buffer_load_dwordx4 v[72:75], v4, s[16:19], s53 offen sc1
MAV 40,56,88
TR 8,7,16704
TR 10,7,17216
MAV 56,56,92
TR 24,7,17728
MAV 56,40,84
TR 26,7,18240
TR 12,7,16736
MAV 60,44,84
buffer_load_dwordx4 v[76:79], v4, s[16:19], s53 offen offset:1024 sc1
MAV 60,60,92
s_add_u32 s53, s53, 262144
MAV 44,60,88
TR 14,7,17248
TR 28,7,17760
MAV 44,44,80
TR 30,7,18272
s_waitcnt vmcnt(8) lgkmcnt(8)
MAV 32,0,96
TR 32,7,24960
TR 34,7,25472
MAV 32,16,104
buffer_load_dwordx4 v[80:83], v4, s[16:19], s52 offen sc1
MAV 48,16,108
TR 48,7,25984
TR 50,7,26496
MAV 48,0,100
TR 36,7,24992
MAV 52,4,100
buffer_load_dwordx4 v[84:87], v4, s[16:19], s52 offen offset:1024 sc1
MAV 52,20,108
TR 38,7,25504
s_add_u32 s52, s52, 262144
MAV 36,20,104
TR 52,7,26016
MAV 36,4,96
TR 54,7,26528
s_waitcnt lgkmcnt(8)
MAV 40,8,96
buffer_load_dwordx4 v[88:91], v4, s[16:19], s53 offen sc1
MAV 40,24,104
TR 40,7,25024
TR 42,7,25536
MAV 56,24,108
TR 56,7,26048
MAV 56,8,100
TR 58,7,26560
TR 44,7,25056
MAV 60,12,100
buffer_load_dwordx4 v[92:95], v4, s[16:19], s53 offen offset:1024 sc1
MAV 60,28,108
s_add_u32 s53, s53, 262144
MAV 44,28,104
TR 46,7,25568
TR 60,7,26080
MAV 44,12,96
TR 62,7,26592
s_waitcnt vmcnt(8) lgkmcnt(8)
MAV 32,32,112
TR 0,7,33280
TR 2,7,33792
MAV 32,48,120
buffer_load_dwordx4 v[96:99], v4, s[16:19], s52 offen sc1
MAV 48,48,124
TR 16,7,34304
TR 18,7,34816
MAV 48,32,116
TR 4,7,33312
MAV 52,36,116
buffer_load_dwordx4 v[100:103], v4, s[16:19], s52 offen offset:1024 sc1
MAV 52,52,124
TR 6,7,33824
s_add_u32 s52, s52, 262144
MAV 36,52,120
TR 20,7,34336
MAV 36,36,112
TR 22,7,34848
s_waitcnt lgkmcnt(8)
MAV 40,40,112
buffer_load_dwordx4 v[104:107], v4, s[16:19], s53 offen sc1
MAV 40,56,120
TR 8,7,33344
TR 10,7,33856
MAV 56,56,124
TR 24,7,34368
MAV 56,40,116
TR 26,7,34880
TR 12,7,33376
MAV 60,44,116
buffer_load_dwordx4 v[108:111], v4, s[16:19], s53 offen offset:1024 sc1
MAV 60,60,124
s_add_u32 s53, s53, 262144
MAV 44,60,120
TR 14,7,33888
TR 28,7,34400
MAV 44,44,112
TR 30,7,34912
s_waitcnt vmcnt(8) lgkmcnt(8)
MAV 32,0,64
TR 32,7,41600
TR 34,7,42112
MAV 32,16,72
buffer_load_dwordx4 v[112:115], v4, s[16:19], s52 offen sc1
MAV 48,16,76
TR 48,7,42624
TR 50,7,43136
MAV 48,0,68
TR 36,7,41632
MAV 52,4,68
buffer_load_dwordx4 v[116:119], v4, s[16:19], s52 offen offset:1024 sc1
MAV 52,20,76
TR 38,7,42144
s_add_u32 s52, s52, 262144
MAV 36,20,72
TR 52,7,42656
MAV 36,4,64
TR 54,7,43168
s_waitcnt lgkmcnt(8)
MAV 40,8,64
buffer_load_dwordx4 v[120:123], v4, s[16:19], s53 offen sc1
MAV 40,24,72
TR 40,7,41664
TR 42,7,42176
MAV 56,24,76
TR 56,7,42688
MAV 56,8,68
TR 58,7,43200
TR 44,7,41696
MAV 60,12,68
buffer_load_dwordx4 v[124:127], v4, s[16:19], s53 offen offset:1024 sc1
MAV 60,28,76
s_add_u32 s53, s53, 262144
MAV 44,28,72
TR 46,7,42208
TR 60,7,42720
MAV 44,12,64
TR 62,7,43232
s_waitcnt vmcnt(8) lgkmcnt(8)
MAV 32,32,80
TR 0,7,49920
TR 2,7,50432
MAV 32,48,88
buffer_load_dwordx4 v[64:67], v4, s[16:19], s52 offen sc1
MAV 48,48,92
TR 16,7,50944
TR 18,7,51456
MAV 48,32,84
TR 4,7,49952
MAV 52,36,84
buffer_load_dwordx4 v[68:71], v4, s[16:19], s52 offen offset:1024 sc1
MAV 52,52,92
TR 6,7,50464
s_add_u32 s52, s52, 262144
MAV 36,52,88
TR 20,7,50976
MAV 36,36,80
TR 22,7,51488
s_waitcnt lgkmcnt(8)
MAV 40,40,80
buffer_load_dwordx4 v[72:75], v4, s[16:19], s53 offen sc1
MAV 40,56,88
TR 8,7,49984
TR 10,7,50496
MAV 56,56,92
TR 24,7,51008
MAV 56,40,84
TR 26,7,51520
TR 12,7,50016
MAV 60,44,84
buffer_load_dwordx4 v[76:79], v4, s[16:19], s53 offen offset:1024 sc1
MAV 60,60,92
s_add_u32 s53, s53, 262144
MAV 44,60,88
TR 14,7,50528
TR 28,7,51040
MAV 44,44,80
TR 30,7,51552
s_waitcnt vmcnt(8) lgkmcnt(8)
MAV 32,0,96
TR 32,7,58240
TR 34,7,58752
MAV 32,16,104
buffer_load_dwordx4 v[80:83], v4, s[16:19], s52 offen sc1
MAV 48,16,108
TR 48,7,59264
TR 50,7,59776
MAV 48,0,100
TR 36,7,58272
MAV 52,4,100
buffer_load_dwordx4 v[84:87], v4, s[16:19], s52 offen offset:1024 sc1
MAV 52,20,108
TR 38,7,58784
s_add_u32 s52, s52, 262144
MAV 36,20,104
TR 52,7,59296
MAV 36,4,96
TR 54,7,59808
s_waitcnt lgkmcnt(8)
MAV 40,8,96
buffer_load_dwordx4 v[88:91], v4, s[16:19], s53 offen sc1
MAV 40,24,104
TR 40,7,58304
TR 42,7,58816
MAV 56,24,108
TR 56,7,59328
MAV 56,8,100
TR 58,7,59840
TR 44,7,58336
MAV 60,12,100
buffer_load_dwordx4 v[92:95], v4, s[16:19], s53 offen offset:1024 sc1
MAV 60,28,108
s_add_u32 s53, s53, 262144
MAV 44,28,104
TR 46,7,58848
TR 60,7,59360
MAV 44,12,96
TR 62,7,59872
s_xor_b32 s57, s57, 66560
v_add_u32 v7, s57, v8
s_waitcnt vmcnt(8) lgkmcnt(8)
MAV 32,32,112
ds_read_b64_tr_b16 a[0:1], v7
TR 2,7,512
MAV 32,48,120
buffer_load_dwordx4 v[96:99], v4, s[16:19], s52 offen sc1
MAV 48,48,124
TR 16,7,1024
TR 18,7,1536
MAV 48,32,116
TR 4,7,32
MAV 52,36,116
buffer_load_dwordx4 v[100:103], v4, s[16:19], s52 offen offset:1024 sc1
MAV 52,52,124
TR 6,7,544
s_add_u32 s52, s52, 262144
MAV 36,52,120
TR 20,7,1056
MAV 36,36,112
TR 22,7,1568
s_waitcnt lgkmcnt(8)
MAV 40,40,112
buffer_load_dwordx4 v[104:107], v4, s[16:19], s53 offen sc1
MAV 40,56,120
TR 8,7,64
TR 10,7,576
MAV 56,56,124
TR 24,7,1088
MAV 56,40,116
TR 26,7,1600
TR 12,7,96
MAV 60,44,116
buffer_load_dwordx4 v[108:111], v4, s[16:19], s53 offen offset:1024 sc1
MAV 60,60,124
s_add_u32 s53, s53, 262144
MAV 44,60,120
TR 14,7,608
TR 28,7,1120
MAV 44,44,112
TR 30,7,1632
s_waitcnt vmcnt(8) lgkmcnt(8)
MAV 32,0,64
TR 32,7,8320
TR 34,7,8832
MAV 32,16,72
buffer_load_dwordx4 v[112:115], v4, s[16:19], s52 offen sc1
MAV 48,16,76
TR 48,7,9344
TR 50,7,9856
MAV 48,0,68
TR 36,7,8352
MAV 52,4,68
buffer_load_dwordx4 v[116:119], v4, s[16:19], s52 offen offset:1024 sc1
MAV 52,20,76
TR 38,7,8864
s_add_u32 s52, s52, 262144
MAV 36,20,72
TR 52,7,9376
MAV 36,4,64
TR 54,7,9888
s_waitcnt lgkmcnt(8)
MAV 40,8,64
buffer_load_dwordx4 v[120:123], v4, s[16:19], s53 offen sc1
MAV 40,24,72
TR 40,7,8384
TR 42,7,8896
MAV 56,24,76
TR 56,7,9408
MAV 56,8,68
TR 58,7,9920
TR 44,7,8416
MAV 60,12,68
buffer_load_dwordx4 v[124:127], v4, s[16:19], s53 offen offset:1024 sc1
MAV 60,28,76
s_add_u32 s53, s53, 262144
MAV 44,28,72
TR 46,7,8928
TR 60,7,9440
MAV 44,12,64
TR 62,7,9952
s_waitcnt vmcnt(8) lgkmcnt(8)
MAV 32,32,80
TR 0,7,16640
TR 2,7,17152
MAV 32,48,88
buffer_load_dwordx4 v[64:67], v4, s[16:19], s52 offen sc1
MAV 48,48,92
TR 16,7,17664
TR 18,7,18176
MAV 48,32,84
TR 4,7,16672
MAV 52,36,84
buffer_load_dwordx4 v[68:71], v4, s[16:19], s52 offen offset:1024 sc1
MAV 52,52,92
TR 6,7,17184
s_add_u32 s52, s52, 262144
MAV 36,52,88
TR 20,7,17696
MAV 36,36,80
TR 22,7,18208
s_waitcnt lgkmcnt(8)
MAV 40,40,80
buffer_load_dwordx4 v[72:75], v4, s[16:19], s53 offen sc1
MAV 40,56,88
TR 8,7,16704
TR 10,7,17216
MAV 56,56,92
TR 24,7,17728
MAV 56,40,84
TR 26,7,18240
TR 12,7,16736
MAV 60,44,84
buffer_load_dwordx4 v[76:79], v4, s[16:19], s53 offen offset:1024 sc1
MAV 60,60,92
s_add_u32 s53, s53, 262144
MAV 44,60,88
TR 14,7,17248
TR 28,7,17760
MAV 44,44,80
TR 30,7,18272
s_waitcnt vmcnt(8) lgkmcnt(8)
MAV 32,0,96
TR 32,7,24960
TR 34,7,25472
MAV 32,16,104
buffer_load_dwordx4 v[80:83], v4, s[16:19], s52 offen sc1
MAV 48,16,108
TR 48,7,25984
TR 50,7,26496
MAV 48,0,100
TR 36,7,24992
MAV 52,4,100
buffer_load_dwordx4 v[84:87], v4, s[16:19], s52 offen offset:1024 sc1
MAV 52,20,108
TR 38,7,25504
s_add_u32 s52, s52, 262144
MAV 36,20,104
TR 52,7,26016
MAV 36,4,96
TR 54,7,26528
s_waitcnt lgkmcnt(8)
MAV 40,8,96
buffer_load_dwordx4 v[88:91], v4, s[16:19], s53 offen sc1
MAV 40,24,104
TR 40,7,25024
TR 42,7,25536
MAV 56,24,108
TR 56,7,26048
MAV 56,8,100
TR 58,7,26560
TR 44,7,25056
MAV 60,12,100
buffer_load_dwordx4 v[92:95], v4, s[16:19], s53 offen offset:1024 sc1
MAV 60,28,108
s_add_u32 s53, s53, 262144
MAV 44,28,104
TR 46,7,25568
TR 60,7,26080
MAV 44,12,96
TR 62,7,26592
.Lpad1:
s_cbranch_execz .Lpad4
s_waitcnt vmcnt(8) lgkmcnt(8)
MAV 32,32,112
TR 0,7,33280
TR 2,7,33792
MAV 32,48,120
buffer_load_dwordx4 v[96:99], v4, s[16:19], s52 offen sc1
MAV 48,48,124
TR 16,7,34304
TR 18,7,34816
MAV 48,32,116
TR 4,7,33312
MAV 52,36,116
buffer_load_dwordx4 v[100:103], v4, s[16:19], s52 offen offset:1024 sc1
MAV 52,52,124
TR 6,7,33824
s_add_u32 s52, s52, 262144
MAV 36,52,120
TR 20,7,34336
MAV 36,36,112
TR 22,7,34848
s_waitcnt lgkmcnt(8)
MAV 40,40,112
buffer_load_dwordx4 v[104:107], v4, s[16:19], s53 offen sc1
MAV 40,56,120
TR 8,7,33344
TR 10,7,33856
MAV 56,56,124
TR 24,7,34368
MAV 56,40,116
TR 26,7,34880
TR 12,7,33376
MAV 60,44,116
buffer_load_dwordx4 v[108:111], v4, s[16:19], s53 offen offset:1024 sc1
MAV 60,60,124
s_add_u32 s53, s53, 262144
MAV 44,60,120
TR 14,7,33888
TR 28,7,34400
MAV 44,44,112
TR 30,7,34912
s_waitcnt vmcnt(8) lgkmcnt(8)
MAV 32,0,64
TR 32,7,41600
TR 34,7,42112
MAV 32,16,72
buffer_load_dwordx4 v[112:115], v4, s[16:19], s52 offen sc1
MAV 48,16,76
TR 48,7,42624
TR 50,7,43136
MAV 48,0,68
TR 36,7,41632
MAV 52,4,68
buffer_load_dwordx4 v[116:119], v4, s[16:19], s52 offen offset:1024 sc1
MAV 52,20,76
TR 38,7,42144
s_add_u32 s52, s52, 262144
MAV 36,20,72
TR 52,7,42656
MAV 36,4,64
TR 54,7,43168
s_waitcnt lgkmcnt(8)
MAV 40,8,64
buffer_load_dwordx4 v[120:123], v4, s[16:19], s53 offen sc1
MAV 40,24,72
TR 40,7,41664
TR 42,7,42176
MAV 56,24,76
TR 56,7,42688
MAV 56,8,68
TR 58,7,43200
TR 44,7,41696
MAV 60,12,68
buffer_load_dwordx4 v[124:127], v4, s[16:19], s53 offen offset:1024 sc1
MAV 60,28,76
s_add_u32 s53, s53, 262144
MAV 44,28,72
TR 46,7,42208
TR 60,7,42720
MAV 44,12,64
TR 62,7,43232
s_barrier
s_waitcnt vmcnt(8) lgkmcnt(8)
MAV 32,32,80
TR 0,7,49920
s_add_u32 m0, s59, 84480
MAV 32,48,88
buffer_load_dwordx4 v12, s[32:35], s58 offen   lds
MAV 48,48,92
TR 2,7,50432
TR 16,7,50944
MAV 48,32,84
TR 18,7,51456
MAV 52,36,84
buffer_load_dwordx4 v13, s[32:35], s58 offen offset:1056   lds
MAV 52,52,92
TR 4,7,49952
TR 6,7,50464
MAV 36,52,88
TR 20,7,50976
MAV 36,36,80
TR 22,7,51488
s_waitcnt lgkmcnt(8)
MAV 40,40,80
buffer_load_dwordx4 v14, s[32:35], s58 offen offset:2112   lds
MAV 40,56,88
TR 8,7,49984
MAV 56,56,92
TR 10,7,50496
TR 24,7,51008
MAV 56,40,84
TR 26,7,51520
MAV 60,44,84
buffer_load_dwordx4 v15, s[32:35], s58 offen offset:3168   lds
MAV 60,60,92
TR 12,7,50016
TR 14,7,50528
MAV 44,60,88
TR 28,7,51040
MAV 44,44,80
TR 30,7,51552
s_waitcnt vmcnt(8) lgkmcnt(8)
MAV 32,0,96
TR 32,7,58240
s_add_u32 m0, s59, 101376
MAV 32,16,104
buffer_load_dwordx4 v12, s[80:83], s58 offen   lds
MAV 48,16,108
TR 34,7,58752
TR 48,7,59264
MAV 48,0,100
TR 50,7,59776
MAV 52,4,100
buffer_load_dwordx4 v13, s[80:83], s58 offen offset:1056   lds
MAV 52,20,108
TR 36,7,58272
TR 38,7,58784
MAV 36,20,104
TR 52,7,59296
MAV 36,4,96
TR 54,7,59808
s_waitcnt lgkmcnt(8)
MAV 40,8,96
buffer_load_dwordx4 v14, s[80:83], s58 offen offset:2112   lds
MAV 40,24,104
TR 40,7,58304
TR 42,7,58816
MAV 56,24,108
TR 56,7,59328
MAV 56,8,100
TR 58,7,59840
TR 44,7,58336
MAV 60,12,100
buffer_load_dwordx4 v15, s[80:83], s58 offen offset:3168   lds
MAV 60,28,108
s_add_u32 s58, s58, 458752
MAV 44,28,104
TR 46,7,58848
TR 60,7,59360
MAV 44,12,96
TR 62,7,59872
s_waitcnt vmcnt(11) lgkmcnt(14)
MAV 32,32,112
s_add_u32 m0, s59, 118272
s_lshl_b32 s64, s6, 14
s_lshl_b32 s65, s49, 13
s_waitcnt vmcnt(9) lgkmcnt(12)
MAV 32,48,120
buffer_load_dwordx4 v12, s[32:35], s58 offen   lds
s_waitcnt vmcnt(9)
MAV 48,48,124
s_add_u32 s64, s64, s65
s_lshl_b32 s65, s7, 9
s_add_u32 s64, s64, s65
MAV 48,32,116
s_lshl_b32 s65, s48, 8
s_add_u32 s64, s64, s65
s_add_u32 s64, s64, 29622272
s_waitcnt lgkmcnt(10)
MAV 52,36,116
s_lshl_b32 s62, s7, 18
v_and_b32 v152, 31, v1
v_lshlrev_b32 v152, 3, v152
s_waitcnt lgkmcnt(8)
MAV 52,52,124
buffer_load_dwordx4 v13, s[32:35], s58 offen offset:1056   lds
MAV 36,52,120
s_add_u32 s62, s62, 8388608
v_lshrrev_b32 v153, 5, v1
v_lshl_add_u32 v152, v153, 28, v152
MAV 36,36,112
s_add_u32 s63, s62, 131072
v_cvt_pk_bf16_f32 v128, v32, v33
v_cvt_pk_bf16_f32 v129, v34, v35
s_waitcnt lgkmcnt(6)
MAV 40,40,112
v_cvt_pk_bf16_f32 v136, v48, v49
v_cvt_pk_bf16_f32 v137, v50, v51
s_waitcnt lgkmcnt(4)
MAV 40,56,120
buffer_load_dwordx4 v14, s[32:35], s58 offen offset:2112   lds
MAV 56,56,124
v_cvt_pk_bf16_f32 v130, v36, v37
v_cvt_pk_bf16_f32 v131, v38, v39
MAV 56,40,116
s_nop 2
v_cvt_pk_bf16_f32 v132, v40, v41
v_cvt_pk_bf16_f32 v133, v42, v43
s_waitcnt lgkmcnt(2)
MAV 60,44,116
v_cvt_pk_bf16_f32 v138, v52, v53
v_cvt_pk_bf16_f32 v139, v54, v55
s_waitcnt lgkmcnt(0)
MAV 60,60,124
buffer_load_dwordx4 v15, s[32:35], s58 offen offset:3168   lds
MAV 44,60,120
v_cvt_pk_bf16_f32 v140, v56, v57
v_cvt_pk_bf16_f32 v141, v58, v59
MAV 44,44,112
s_nop 2
v_cvt_pk_bf16_f32 v142, v60, v61
v_cvt_pk_bf16_f32 v143, v62, v63
v_pk_mul_f32 v[146:147], v[32:33], v[32:33]
v_pk_mul_f32 v[150:151], v[48:49], v[48:49]
buffer_store_dwordx4 v[128:131], v4, s[16:19], s62 offen sc1
v_cvt_pk_bf16_f32 v134, v44, v45
v_cvt_pk_bf16_f32 v135, v46, v47
v_pk_fma_f32 v[146:147], v[34:35], v[34:35], v[146:147]
v_pk_add_f32 v[144:145], v[32:33], v[34:35]
v_pk_fma_f32 v[150:151], v[50:51], v[50:51], v[150:151]
v_pk_add_f32 v[148:149], v[48:49], v[50:51]
v_pk_fma_f32 v[146:147], v[36:37], v[36:37], v[146:147]
v_pk_add_f32 v[144:145], v[144:145], v[36:37]
v_pk_fma_f32 v[150:151], v[52:53], v[52:53], v[150:151]
v_pk_add_f32 v[148:149], v[148:149], v[52:53]
v_pk_fma_f32 v[146:147], v[38:39], v[38:39], v[146:147]
v_pk_add_f32 v[144:145], v[144:145], v[38:39]
v_pk_fma_f32 v[150:151], v[54:55], v[54:55], v[150:151]
buffer_store_dwordx4 v[132:135], v4, s[16:19], s63 offen sc1
v_pk_add_f32 v[148:149], v[148:149], v[54:55]
v_pk_fma_f32 v[146:147], v[40:41], v[40:41], v[146:147]
v_pk_add_f32 v[144:145], v[144:145], v[40:41]
v_pk_fma_f32 v[150:151], v[56:57], v[56:57], v[150:151]
v_pk_add_f32 v[148:149], v[148:149], v[56:57]
v_pk_fma_f32 v[146:147], v[42:43], v[42:43], v[146:147]
v_pk_add_f32 v[144:145], v[144:145], v[42:43]
v_pk_fma_f32 v[150:151], v[58:59], v[58:59], v[150:151]
v_pk_add_f32 v[148:149], v[148:149], v[58:59]
v_pk_fma_f32 v[146:147], v[44:45], v[44:45], v[146:147]
v_pk_add_f32 v[144:145], v[144:145], v[44:45]
v_pk_fma_f32 v[150:151], v[60:61], v[60:61], v[150:151]
v_pk_add_f32 v[148:149], v[148:149], v[60:61]
buffer_store_dwordx4 v[136:139], v4, s[16:19], s62 offen offset:1024 sc1
v_pk_fma_f32 v[146:147], v[46:47], v[46:47], v[146:147]
v_pk_add_f32 v[144:145], v[144:145], v[46:47]
v_pk_fma_f32 v[150:151], v[62:63], v[62:63], v[150:151]
v_pk_add_f32 v[148:149], v[148:149], v[62:63]
v_add_f32 v144, v144, v145
v_add_f32 v146, v146, v147
v_add_f32 v148, v148, v149
v_add_f32 v150, v150, v151
s_nop 0
v_permlane16_swap_b32 v144, v148
v_permlane16_swap_b32 v146, v150
v_add_f32 v144, v144, v148
buffer_store_dwordx4 v[140:143], v4, s[16:19], s63 offen offset:1024 sc1
v_add_f32 v146, v146, v150
s_nop 1
v_permlane32_swap_b32 v144, v146
v_add_f32 v144, v144, v146
s_nop 1
v_permlane32_swap_b32 v144, v145
buffer_store_dwordx2 v[144:145], v152, s[16:19], s64 offen sc1
s_nop 1
v_accvgpr_write_b32 a224, v32
v_accvgpr_write_b32 a225, v33
v_accvgpr_write_b32 a226, v34
v_accvgpr_write_b32 a227, v35
v_accvgpr_write_b32 a228, v36
v_accvgpr_write_b32 a229, v37
v_accvgpr_write_b32 a230, v38
v_accvgpr_write_b32 a231, v39
v_accvgpr_write_b32 a232, v40
v_accvgpr_write_b32 a233, v41
v_accvgpr_write_b32 a234, v42
v_accvgpr_write_b32 a235, v43
v_accvgpr_write_b32 a236, v44
v_accvgpr_write_b32 a237, v45
v_accvgpr_write_b32 a238, v46
v_accvgpr_write_b32 a239, v47
v_accvgpr_write_b32 a240, v48
v_accvgpr_write_b32 a241, v49
v_accvgpr_write_b32 a242, v50
v_accvgpr_write_b32 a243, v51
v_accvgpr_write_b32 a244, v52
v_accvgpr_write_b32 a245, v53
v_accvgpr_write_b32 a246, v54
v_accvgpr_write_b32 a247, v55
v_accvgpr_write_b32 a248, v56
v_accvgpr_write_b32 a249, v57
v_accvgpr_write_b32 a250, v58
v_accvgpr_write_b32 a251, v59
v_accvgpr_write_b32 a252, v60
v_accvgpr_write_b32 a253, v61
v_accvgpr_write_b32 a254, v62
v_accvgpr_write_b32 a255, v63
s_lshl_b32 s62, s10, 14
s_lshl_b32 s63, s3, 12
s_add_u32 s62, s62, s63
s_lshl_b32 s63, s12, 11
s_add_u32 s62, s62, s63
v_lshl_add_u32 v10, v1, 4, s62
v_lshrrev_b32 v2, 3, v1
v_cmp_eq_u32 vcc, 3, v2
v_add_u32 v2, 67108480, v10
s_nop 0
v_cndmask_b32 v10, v10, v2, vcc
v_xor_b32 v11, 2048, v10
v_bfe_u32 v16, v1, 2, 3
v_mul_u32_u24 v16, 1056, v16
v_bfe_u32 v2, v1, 5, 1
v_lshl_add_u32 v16, v2, 8, v16
v_and_b32 v2, 3, v1
v_lshl_add_u32 v16, v2, 3, v16
s_lshl_b32 s62, s12, 6
s_add_u32 s62, s62, 84480
s_xor_b32 s63, s12, 1
s_mul_i32 s63, s63, 192
s_add_u32 s63, s63, 84480
v_add_u32 v17, s63, v16
v_add_u32 v16, s62, v16
s_mov_b32 s52, 8388608
s_mov_b32 s53, 8388608
s_mov_b32 s54, s58
s_mov_b32 s55, s59
s_mul_i32 s59, s3, 2112
s_and_b32 s62, s7, 1
s_mul_i32 s62, s62, 3670016
s_lshr_b32 s63, s7, 1
s_lshl_b32 s63, s63, 8
s_add_u32 s62, s62, s63
s_lshl_b32 s63, s3, 12
s_add_u32 s62, s62, s63
v_lshrrev_b32 v5, 4, v1
v_lshlrev_b32 v5, 14, v5
v_and_b32 v2, 15, v1
v_lshl_add_u32 v5, v2, 4, v5
v_add_u32 v5, s62, v5
v_add_u32 v6, 992, v5
s_lshl_b32 s62, s10, 15
s_lshl_b32 s63, s3, 13
s_add_u32 s62, s62, s63
v_lshl_add_u32 v4, v1, 4, s62
s_and_b32 s47, s5, 3
s_lshr_b32 s63, s5, 2
s_lshl_b32 s63, s63, 3
s_add_u32 s63, s63, s4
s_lshl_b32 s62, s63, 1
s_add_u32 s62, s62, s48
s_mul_i32 s62, s62, 1792
v_lshrrev_b32 v7, 2, v1
v_min_u32 v8, 13, v7
v_lshl_add_u32 v8, v8, 7, s62
s_lshl_b32 s62, s63, 2
s_add_u32 s62, s62, s3
s_mul_i32 s62, s62, 640
v_and_b32 v7, 7, v7
v_min_u32 v7, 4, v7
v_lshl_add_u32 v7, v7, 7, s62
v_lshrrev_b32 v2, 5, v1
v_mul_u32_u24 v2, 3670016, v2
v_add_u32 v7, v7, v2
s_mul_i32 s44, s47, 163840
s_add_u32 s45, s47, 12
s_mul_i32 s45, s45, 229376
v_and_b32 v2, 1, v1
v_lshlrev_b32 v2, 4, v2
v_mov_b32 v9, 0x3f80
v_lshlrev_b32 v2, v2, v9
v_bfe_u32 v9, v1, 1, 3
v_cmp_eq_u32 vcc, 0, v9
s_nop 1
v_cndmask_b32 v20, 0, v2, vcc
v_cmp_eq_u32 vcc, 1, v9
s_nop 1
v_cndmask_b32 v21, 0, v2, vcc
v_cmp_eq_u32 vcc, 2, v9
s_nop 1
v_cndmask_b32 v22, 0, v2, vcc
v_cmp_eq_u32 vcc, 3, v9
s_nop 1
v_cndmask_b32 v23, 0, v2, vcc
v_accvgpr_write_b32 a208, v20
v_accvgpr_write_b32 a209, v21
v_accvgpr_write_b32 a210, v22
v_accvgpr_write_b32 a211, v23
s_cmp_lt_u32 s3, 2
s_cselect_b32 s40, s32, s80
s_cselect_b32 s41, s33, s81
s_cselect_b32 s42, s34, s82
s_add_u32 s62, s55, 84480
v_lshl_add_u32 v9, v1, 4, s62
s_lshl_b32 s62, s6, 10
s_add_u32 s62, s62, 30441472
s_lshl_b32 s64, s10, 1
s_lshl_b32 s64, s64, 10
s_add_u32 s64, s64, 30441472
s_lshr_b32 s67, s5, 2
s_and_b32 s67, s67, 3
s_lshl_b32 s67, s67, 7
s_add_u32 s64, s64, s67
s_add_u32 s65, s64, 1024
v_lshl_add_u32 v252, v1, 7, s62
v_mov_b32 v253, s64
v_mov_b32 v255, 1
v_writelane_b32 v253, s65, 1
s_waitcnt vmcnt(0) lgkmcnt(0)
s_cmp_lg_u32 s3, 1
s_barrier
s_cbranch_scc1 .Lnopoll36
s_mov_b64 exec, 15
buffer_atomic_add v255, v252, s[16:19], 0 offen
s_mov_b64 exec, 3
v_mov_b32 v254, 0
buffer_atomic_add v254, v253, s[16:19], 0 offen sc0
s_sleep 5
s_mov_b32 s15, 0
.Lpoll35:
v_mov_b32 v255, 0
buffer_atomic_add v255, v253, s[16:19], 0 offen sc0
s_waitcnt vmcnt(1)
v_cmp_gt_u32 vcc, 16, v254
s_add_u32 s15, s15, 1
s_cbranch_vccz .Lnopoll36r
v_mov_b32 v254, 0
buffer_atomic_add v254, v253, s[16:19], 0 offen sc0
s_waitcnt vmcnt(1)
v_cmp_gt_u32 vcc, 16, v255
s_add_u32 s15, s15, 1
s_cbranch_vccz .Lnopoll36r
s_cmp_le_u32 s15, 100000
s_cbranch_scc1 .Lpoll35
s_branch .Lnopoll36r
.Lnopoll36:
s_mov_b64 exec, 0
s_cmp_eq_u32 s3, 2
s_cbranch_scc1 .Lpad6
s_cmp_eq_u32 s3, 3
s_cbranch_scc1 .Lpad7
s_branch .Lpad8
.Lnopoll36r:
s_mov_b64 exec, -1
s_barrier
buffer_load_dwordx4 a[128:131], v10, s[16:19], s52 offen sc1
buffer_load_dwordx4 a[132:135], v10, s[16:19], s52 offen offset:1024 sc1
s_add_u32 s52, s52, 131072
buffer_load_dwordx4 a[144:147], v10, s[16:19], s52 offen sc1
buffer_load_dwordx4 a[148:151], v10, s[16:19], s52 offen offset:1024 sc1
s_add_u32 s52, s52, 131072
buffer_load_dwordx4 a[136:139], v11, s[16:19], s53 offen sc1
buffer_load_dwordx4 a[140:143], v11, s[16:19], s53 offen offset:1024 sc1
s_add_u32 s53, s53, 131072
buffer_load_dwordx4 a[152:155], v11, s[16:19], s53 offen sc1
buffer_load_dwordx4 a[156:159], v11, s[16:19], s53 offen offset:1024 sc1
s_add_u32 s53, s53, 131072
ds_read_b64_tr_b16 a[0:1], v16
TR 2,16,512
TR 4,16,8448
TR 6,16,8960
TR 8,16,32
TR 10,16,544
TR 12,16,8480
TR 14,16,8992
TR 16,16,64
TR 18,16,576
TR 20,16,8512
TR 22,16,9024
TR 24,16,96
TR 26,16,608
TR 28,16,8544
TR 30,16,9056
TR 32,16,128
TR 34,16,640
TR 36,16,8576
TR 38,16,9088
TR 40,16,160
TR 42,16,672
TR 44,16,8608
TR 46,16,9120
ds_read_b64_tr_b16 a[48:49], v17
TR 50,17,512
TR 52,17,8448
TR 54,17,8960
TR 56,17,32
TR 58,17,544
TR 60,17,8480
TR 62,17,8992
ds_read_b128 a[192:195], v9
RD 196,9,1056
RD 200,9,2112
RD 204,9,3168
s_add_u32 m0, s55, 135168
s_nop 0
buffer_load_dwordx4 v12, s[80:83], s54 offen   lds
buffer_load_dwordx4 v13, s[80:83], s54 offen offset:1056   lds
buffer_load_dwordx4 v14, s[80:83], s54 offen offset:2112   lds
buffer_load_dwordx4 v15, s[80:83], s54 offen offset:3168   lds
s_add_u32 s54, s54, 458752
s_lshl_b32 s57, s3, 13
s_add_u32 s57, s57, 49920
v_lshl_add_u32 v2, v1, 4, s57
s_waitcnt lgkmcnt(0)
s_barrier
s_waitcnt vmcnt(11)
v_mfma_f32_16x16x32_bf16 v[32:35], a[0:3], a[128:131], 0
buffer_load_dwordx4 a[160:163], v10, s[16:19], s52 offen sc1
s_waitcnt vmcnt(10)
MAA 32,4,144
TR 64,16,16896
v_mfma_f32_16x16x32_bf16 a[212:215], a[208:211], a[192:195], 0
TR 66,16,17408
v_mfma_f32_16x16x32_bf16 a[212:215], a[208:211], a[196:199], a[212:215]
TR 68,16,25344
v_mfma_f32_16x16x32_bf16 a[212:215], a[208:211], a[200:203], a[212:215]
TR 70,16,25856
v_mfma_f32_16x16x32_bf16 a[212:215], a[208:211], a[204:207], a[212:215]
buffer_load_dwordx4 a[164:167], v10, s[16:19], s52 offen offset:1024 sc1
v_mfma_f32_16x16x32_bf16 v[36:39], a[0:3], a[132:135], 0
TR 72,16,16928
s_add_u32 s52, s52, 131072
s_waitcnt vmcnt(10)
MAA 36,4,148
TR 74,16,17440
v_mfma_f32_16x16x32_bf16 v[52:55], a[8:11], a[132:135], 0
TR 76,16,25376
MAA 52,12,148
TR 78,16,25888
v_mfma_f32_16x16x32_bf16 v[48:51], a[8:11], a[128:131], 0
buffer_load_dwordx4 a[176:179], v10, s[16:19], s52 offen sc1
MAA 48,12,144
TR 80,16,16960
v_mfma_f32_16x16x32_bf16 v[96:99], a[16:19], a[128:131], 0
TR 82,16,17472
MAA 96,20,144
TR 84,16,25408
v_mfma_f32_16x16x32_bf16 v[100:103], a[16:19], a[132:135], 0
TR 86,16,25920
MAA 100,20,148
buffer_load_dwordx4 a[180:183], v10, s[16:19], s52 offen offset:1024 sc1
v_mfma_f32_16x16x32_bf16 v[116:119], a[24:27], a[132:135], 0
TR 88,16,16992
s_add_u32 s52, s52, 131072
MAA 116,28,148
TR 90,16,17504
v_mfma_f32_16x16x32_bf16 v[112:115], a[24:27], a[128:131], 0
TR 92,16,25440
MAA 112,28,144
TR 94,16,25952
v_mfma_f32_16x16x32_bf16 v[160:163], a[32:35], a[128:131], 0
buffer_load_dwordx4 a[168:171], v11, s[16:19], s53 offen sc1
MAA 160,36,144
TR 96,16,17024
v_mfma_f32_16x16x32_bf16 v[164:167], a[32:35], a[132:135], 0
TR 98,16,17536
MAA 164,36,148
TR 100,16,25472
v_mfma_f32_16x16x32_bf16 v[180:183], a[40:43], a[132:135], 0
TR 102,16,25984
MAA 180,44,148
buffer_load_dwordx4 a[172:175], v11, s[16:19], s53 offen offset:1024 sc1
v_mfma_f32_16x16x32_bf16 v[176:179], a[40:43], a[128:131], 0
TR 104,16,17056
s_add_u32 s53, s53, 131072
MAA 176,44,144
TR 106,16,17568
v_mfma_f32_16x16x32_bf16 v[224:227], a[48:51], a[128:131], 0
TR 108,16,25504
MAA 224,52,144
TR 110,16,26016
v_mfma_f32_16x16x32_bf16 v[228:231], a[48:51], a[132:135], 0
buffer_load_dwordx4 a[184:187], v11, s[16:19], s53 offen sc1
MAA 228,52,148
TR 112,17,16896
v_mfma_f32_16x16x32_bf16 v[236:239], a[56:59], a[132:135], 0
TR 114,17,17408
MAA 236,60,148
TR 116,17,25344
v_mfma_f32_16x16x32_bf16 v[232:235], a[56:59], a[128:131], 0
TR 118,17,25856
MAA 232,60,144
buffer_load_dwordx4 a[188:191], v11, s[16:19], s53 offen offset:1024 sc1
s_waitcnt vmcnt(12)
v_mfma_f32_16x16x32_bf16 v[188:191], a[40:43], a[140:143], 0
.Lpad2:
s_cbranch_execz .Lpad5
TR 120,17,16928
s_add_u32 s53, s53, 131072
MAA 188,44,156
TR 122,17,17440
s_add_u32 m0, s55, 84480
v_mfma_f32_16x16x32_bf16 v[184:187], a[40:43], a[136:139], 0
TR 124,17,25376
MAA 184,44,152
TR 126,17,25888
v_mfma_f32_16x16x32_bf16 v[168:171], a[32:35], a[136:139], 0
buffer_load_dwordx4 v12, s[32:35], s54 offen   lds
MAA 168,36,152
RD 192,9,16896
v_mfma_f32_16x16x32_bf16 v[172:175], a[32:35], a[140:143], 0
RD 196,9,17952
MAA 172,36,156
RD 200,9,19008
v_mfma_f32_16x16x32_bf16 v[124:127], a[24:27], a[140:143], 0
RD 204,9,20064
MAA 124,28,156
buffer_load_dwordx4 v13, s[32:35], s54 offen offset:1056   lds
v_mfma_f32_16x16x32_bf16 v[120:123], a[24:27], a[136:139], 0
MAA 120,28,152
v_mfma_f32_16x16x32_bf16 v[104:107], a[16:19], a[136:139], 0
MAA 104,20,152
v_mfma_f32_16x16x32_bf16 v[108:111], a[16:19], a[140:143], 0
buffer_load_dwordx4 v14, s[32:35], s54 offen offset:2112   lds
MAA 108,20,156
v_mfma_f32_16x16x32_bf16 v[60:63], a[8:11], a[140:143], 0
MAA 60,12,156
v_mfma_f32_16x16x32_bf16 v[56:59], a[8:11], a[136:139], 0
MAA 56,12,152
buffer_load_dwordx4 v15, s[32:35], s54 offen offset:3168   lds
v_mfma_f32_16x16x32_bf16 v[40:43], a[0:3], a[136:139], 0
MAA 40,4,152
v_mfma_f32_16x16x32_bf16 v[44:47], a[0:3], a[140:143], 0
MAA 44,4,156
s_waitcnt lgkmcnt(0)
s_barrier
v_mfma_f32_16x16x32_bf16 v[64:67], a[64:67], a[128:131], 0
TR 0,16,33792
s_add_u32 m0, s55, 101376
MAA 64,68,144
buffer_load_dwordx4 v12, s[80:83], s54 offen   lds
v_mfma_f32_16x16x32_bf16 a[216:219], a[208:211], a[192:195], 0
TR 2,16,34304
s_mul_i32 s66, s13, 114688
v_mfma_f32_16x16x32_bf16 a[216:219], a[208:211], a[196:199], a[216:219]
TR 4,16,42240
s_mul_i32 s65, s10, 1818624
v_mfma_f32_16x16x32_bf16 a[216:219], a[208:211], a[200:203], a[216:219]
TR 6,16,42752
s_add_u32 s66, s66, s65
v_mfma_f32_16x16x32_bf16 a[216:219], a[208:211], a[204:207], a[216:219]
TR 8,16,33824
s_add_u32 s66, s66, 12582912
v_mfma_f32_16x16x32_bf16 v[68:71], a[64:67], a[132:135], 0
TR 10,16,34336
s_add_u32 s65, s66, 49152
MAA 68,68,148
buffer_load_dwordx4 v13, s[80:83], s54 offen offset:1056   lds
v_mfma_f32_16x16x32_bf16 v[84:87], a[72:75], a[132:135], 0
TR 12,16,42272
s_lshl_b32 s62, s12, 16
MAA 84,76,148
TR 14,16,42784
s_add_u32 s62, s62, s66
v_mfma_f32_16x16x32_bf16 v[80:83], a[72:75], a[128:131], 0
TR 16,16,33856
s_add_u32 s63, s62, 16384
MAA 80,76,144
TR 18,16,34368
s_add_u32 s64, s62, 32768
v_mfma_f32_16x16x32_bf16 v[128:131], a[80:83], a[128:131], 0
TR 20,16,42304
s_lshl_b32 s72, s10, 1
MAA 128,84,144
buffer_load_dwordx4 v14, s[80:83], s54 offen offset:2112   lds
v_mfma_f32_16x16x32_bf16 v[132:135], a[80:83], a[132:135], 0
TR 22,16,42816
s_lshr_b32 s74, s11, 4
MAA 132,84,148
TR 24,16,33888
s_add_u32 s72, s72, s74
v_mfma_f32_16x16x32_bf16 v[148:151], a[88:91], a[132:135], 0
TR 26,16,34400
s_lshl_b32 s72, s72, 10
MAA 148,92,148
TR 28,16,42336
s_add_u32 s72, s72, 30457856
v_mfma_f32_16x16x32_bf16 v[144:147], a[88:91], a[128:131], 0
TR 30,16,42848
s_and_b32 s73, s6, 14
MAA 144,92,144
buffer_load_dwordx4 v15, s[80:83], s54 offen offset:3168   lds
v_mfma_f32_16x16x32_bf16 v[192:195], a[96:99], a[128:131], 0
TR 32,16,33920
s_add_u32 s54, s54, 458752
MAA 192,100,144
TR 34,16,34432
s_add_u32 m0, s57, 0
v_mfma_f32_16x16x32_bf16 v[196:199], a[96:99], a[132:135], 0
TR 36,16,42368
s_mov_b32 s58, 29622272
MAA 196,100,148
TR 38,16,42880
s_and_b32 s74, s7, 1
v_mfma_f32_16x16x32_bf16 v[212:215], a[104:107], a[132:135], 0
TR 40,16,33952
s_add_u32 s73, s73, s74
MAA 212,108,148
buffer_load_dwordx4 v4, s[16:19], s58 offen sc1 lds
v_mfma_f32_16x16x32_bf16 v[208:211], a[104:107], a[128:131], 0
TR 42,16,34464
s_lshl_b32 s73, s73, 10
MAA 208,108,144
TR 44,16,42400
s_add_u32 s73, s73, 30457856
v_mfma_f32_16x16x32_bf16 v[240:243], a[112:115], a[128:131], 0
TR 46,16,42912
s_lshr_b32 s67, s5, 2
MAA 240,116,144
TR 48,17,33792
v_mfma_f32_16x16x32_bf16 v[244:247], a[112:115], a[132:135], 0
TR 50,17,34304
MAA 244,116,148
buffer_load_dwordx4 v4, s[16:19], s58 offen offset:1024 sc1 lds
v_mfma_f32_16x16x32_bf16 v[252:255], a[120:123], a[132:135], 0
TR 52,17,42240
MAA 252,124,148
TR 54,17,42752
v_mfma_f32_16x16x32_bf16 v[248:251], a[120:123], a[128:131], 0
TR 56,17,33824
MAA 248,124,144
TR 58,17,34336
v_mfma_f32_16x16x32_bf16 v[220:223], a[104:107], a[140:143], 0
TR 60,17,42272
MAA 220,108,156
buffer_load_dwordx4 a[128:131], v10, s[16:19], s52 offen sc1
v_mfma_f32_16x16x32_bf16 v[216:219], a[104:107], a[136:139], 0
TR 62,17,42784
MAA 216,108,152
RD 192,9,33792
v_mfma_f32_16x16x32_bf16 v[200:203], a[96:99], a[136:139], 0
RD 196,9,34848
MAA 200,100,152
RD 200,9,35904
v_mfma_f32_16x16x32_bf16 v[204:207], a[96:99], a[140:143], 0
RD 204,9,36960
MAA 204,100,156
buffer_load_dwordx4 a[132:135], v10, s[16:19], s52 offen offset:1024 sc1
v_mfma_f32_16x16x32_bf16 v[156:159], a[88:91], a[140:143], 0
s_add_u32 s52, s52, 131072
MAA 156,92,156
v_mfma_f32_16x16x32_bf16 v[152:155], a[88:91], a[136:139], 0
MAA 152,92,152
v_mfma_f32_16x16x32_bf16 v[136:139], a[80:83], a[136:139], 0
MAA 136,84,152
buffer_load_dwordx4 a[144:147], v10, s[16:19], s52 offen sc1
v_mfma_f32_16x16x32_bf16 v[140:143], a[80:83], a[140:143], 0
MAA 140,84,156
v_mfma_f32_16x16x32_bf16 v[92:95], a[72:75], a[140:143], 0
MAA 92,76,156
v_mfma_f32_16x16x32_bf16 v[88:91], a[72:75], a[136:139], 0
MAA 88,76,152
buffer_load_dwordx4 a[148:151], v10, s[16:19], s52 offen offset:1024 sc1
v_mfma_f32_16x16x32_bf16 v[72:75], a[64:67], a[136:139], 0
s_add_u32 s52, s52, 131072
MAA 72,68,152
v_mfma_f32_16x16x32_bf16 v[76:79], a[64:67], a[140:143], 0
MAA 76,68,156
s_waitcnt vmcnt(18) lgkmcnt(0)
s_barrier
MAA 32,0,160
buffer_load_dwordx4 a[136:139], v11, s[16:19], s53 offen sc1
MAA 32,4,176
TR 64,16,50688
s_and_b32 s67, s67, 3
v_mfma_f32_16x16x32_bf16 a[212:215], a[208:211], a[192:195], a[212:215]
TR 66,16,51200
s_lshl_b32 s67, s67, 7
v_mfma_f32_16x16x32_bf16 a[212:215], a[208:211], a[196:199], a[212:215]
TR 68,16,59136
s_add_u32 s73, s73, s67
v_mfma_f32_16x16x32_bf16 a[212:215], a[208:211], a[200:203], a[212:215]
TR 70,16,59648
s_and_b32 s74, s7, 1
v_mfma_f32_16x16x32_bf16 a[212:215], a[208:211], a[204:207], a[212:215]
TR 72,16,50720
s_mul_i32 s87, s74, 917504
MAA 36,4,180
buffer_load_dwordx4 a[140:143], v11, s[16:19], s53 offen offset:1024 sc1
MAA 36,0,164
TR 74,16,51232
s_add_u32 s53, s53, 131072
MAA 52,8,164
TR 76,16,59168
s_lshr_b32 s75, s6, 1
MAA 52,12,180
TR 78,16,59680
s_mul_i32 s75, s75, 1818624
MAA 48,12,176
TR 80,16,50752
s_add_u32 s87, s87, s75
MAA 48,8,160
TR 82,16,51264
s_add_u32 s87, s87, 12582912
MAA 96,16,160
buffer_load_dwordx4 a[152:155], v11, s[16:19], s53 offen sc1
MAA 96,20,176
TR 84,16,59200
s_and_b32 s74, s6, 3
MAA 100,20,180
TR 86,16,59712
s_xor_b32 s75, s74, 0
MAA 100,16,164
TR 88,16,50784
s_sub_u32 s75, s75, 0
MAA 116,24,164
TR 90,16,51296
s_mul_i32 s98, s75, 458752
MAA 116,28,180
TR 92,16,59232
s_mul_i32 s75, s75, 114688
MAA 112,28,176
buffer_load_dwordx4 a[156:159], v11, s[16:19], s53 offen offset:1024 sc1
MAA 112,24,160
TR 94,16,59744
s_add_u32 s53, s53, 131072
MAA 160,32,160
TR 96,16,50816
s_add_u32 m0, s55, 118272
MAA 160,36,176
TR 98,16,51328
s_add_u32 s76, s87, s75
MAA 164,36,180
TR 100,16,59264
s_xor_b32 s75, s74, 1
MAA 164,32,164
TR 102,16,59776
s_sub_u32 s75, s75, 1
MAA 180,40,164
buffer_load_dwordx4 v12, s[32:35], s54 offen   lds
MAA 180,44,180
TR 104,16,50848
s_mul_i32 s99, s75, 458752
MAA 176,44,176
TR 106,16,51360
s_mul_i32 s75, s75, 114688
MAA 176,40,160
TR 108,16,59296
s_add_u32 s77, s87, s75
MAA 224,48,160
TR 110,16,59808
MAA 224,52,176
TR 112,17,50688
MAA 228,52,180
buffer_load_dwordx4 v13, s[32:35], s54 offen offset:1056   lds
MAA 228,48,164
TR 114,17,51200
MAA 236,56,164
TR 116,17,59136
MAA 236,60,180
TR 118,17,59648
MAA 232,60,176
TR 120,17,50720
MAA 232,56,160
TR 122,17,51232
s_waitcnt vmcnt(20)
MAA 188,40,172
buffer_load_dwordx4 v14, s[32:35], s54 offen offset:2112   lds
MAA 188,44,188
TR 124,17,59168
MAA 184,44,184
TR 126,17,59680
MAA 184,40,168
RD 192,9,50688
MAA 168,32,168
RD 196,9,51744
MAA 168,36,184
RD 200,9,52800
MAA 172,36,188
buffer_load_dwordx4 v15, s[32:35], s54 offen offset:3168   lds
MAA 172,32,172
RD 204,9,53856
s_add_u32 m0, s57, 2048
MAA 124,24,172
s_mov_b32 s58, 29624320
MAA 124,28,188
MAA 120,28,184
MAA 120,24,168
MAA 104,16,168
buffer_load_dwordx4 v4, s[16:19], s58 offen sc1 lds
MAA 104,20,184
MAA 108,20,188
MAA 108,16,172
MAA 60,8,172
MAA 60,12,188
MAA 56,12,184
buffer_load_dwordx4 v4, s[16:19], s58 offen offset:1024 sc1 lds
MAA 56,8,168
MAA 40,0,168
MAA 40,4,184
MAA 44,4,188
MAA 44,0,172
s_waitcnt vmcnt(20) lgkmcnt(0)
s_barrier
MAA 64,64,160
ds_read_b64_tr_b16 a[0:1], v16
s_add_u32 m0, s55, 135168
MAA 64,68,176
buffer_load_dwordx4 v12, s[80:83], s54 offen   lds
v_mfma_f32_16x16x32_bf16 a[216:219], a[208:211], a[192:195], a[216:219]
TR 2,16,512
s_xor_b32 s75, s74, 2
v_mfma_f32_16x16x32_bf16 a[216:219], a[208:211], a[196:199], a[216:219]
TR 4,16,8448
s_sub_u32 s75, s75, 2
v_mfma_f32_16x16x32_bf16 a[216:219], a[208:211], a[200:203], a[216:219]
TR 6,16,8960
s_mul_i32 s100, s75, 458752
v_mfma_f32_16x16x32_bf16 a[216:219], a[208:211], a[204:207], a[216:219]
TR 8,16,32
s_mul_i32 s75, s75, 114688
MAA 68,68,180
TR 10,16,544
s_add_u32 s78, s87, s75
MAA 68,64,164
buffer_load_dwordx4 v13, s[80:83], s54 offen offset:1056   lds
MAA 84,72,164
TR 12,16,8480
s_xor_b32 s75, s74, 3
MAA 84,76,180
TR 14,16,8992
s_sub_u32 s75, s75, 3
MAA 80,76,176
TR 16,16,64
s_mul_i32 s101, s75, 458752
MAA 80,72,160
TR 18,16,576
s_mul_i32 s75, s75, 114688
MAA 128,80,160
TR 20,16,8512
s_add_u32 s79, s87, s75
MAA 128,84,176
buffer_load_dwordx4 v14, s[80:83], s54 offen offset:2112   lds
MAA 132,84,180
TR 22,16,9024
s_and_b32 s87, s6, 3
MAA 132,80,164
TR 24,16,96
s_mov_b32 s46, 0
MAA 148,88,164
TR 26,16,608
s_lshl_b32 s74, s3, 10
MAA 148,92,180
TR 28,16,8544
s_lshl_b32 s75, s12, 9
MAA 144,92,176
TR 30,16,9056
s_add_u32 s74, s74, s75
MAA 144,88,160
buffer_load_dwordx4 v15, s[80:83], s54 offen offset:3168   lds
MAA 192,96,160
TR 32,16,128
s_add_u32 s54, s54, 458752
MAA 192,100,176
TR 34,16,640
s_add_u32 m0, s57, 4096
MAA 196,100,180
TR 36,16,8576
s_mov_b32 s58, 29626368
MAA 196,96,164
TR 38,16,9088
s_add_u32 s74, s74, 152576
MAA 212,104,164
TR 40,16,160
v_and_b32 v18, 15, v1
MAA 212,108,180
buffer_load_dwordx4 v4, s[16:19], s58 offen sc1 lds
MAA 208,108,176
TR 42,16,672
v_lshl_add_u32 v18, v18, 4, s74
MAA 208,104,160
TR 44,16,8608
v_xor_b32 v19, 512, v18
MAA 240,112,160
TR 46,16,9120
MAA 240,116,176
ds_read_b64_tr_b16 a[48:49], v17
MAA 244,116,180
TR 50,17,512
MAA 244,112,164
buffer_load_dwordx4 v4, s[16:19], s58 offen offset:1024 sc1 lds
MAA 252,120,164
TR 52,17,8448
MAA 252,124,180
TR 54,17,8960
MAA 248,124,176
TR 56,17,32
MAA 248,120,160
TR 58,17,544
MAA 220,104,172
TR 60,17,8480
MAA 220,108,188
buffer_load_dwordx4 a[160:163], v10, s[16:19], s52 offen sc1
MAA 216,108,184
TR 62,17,8992
MAA 216,104,168
ds_read_b128 a[192:195], v9
MAA 200,96,168
RD 196,9,1056
MAA 200,100,184
RD 200,9,2112
MAA 204,100,188
RD 204,9,3168
MAA 204,96,172
buffer_load_dwordx4 a[164:167], v10, s[16:19], s52 offen offset:1024 sc1
MAA 156,88,172
s_add_u32 s52, s52, 131072
MAA 156,92,188
MAA 152,92,184
MAA 152,88,168
MAA 136,80,168
MAA 136,84,184
buffer_load_dwordx4 a[176:179], v10, s[16:19], s52 offen sc1
MAA 140,84,188
MAA 140,80,172
MAA 92,72,172
MAA 92,76,188
MAA 88,76,184
MAA 88,72,168
buffer_load_dwordx4 a[180:183], v10, s[16:19], s52 offen offset:1024 sc1
MAA 72,64,168
s_add_u32 s52, s52, 131072
MAA 72,68,184
MAA 76,68,188
MAA 76,64,172
s_waitcnt vmcnt(20) lgkmcnt(0)
s_barrier
MAA 32,0,128
buffer_load_dwordx4 a[168:171], v11, s[16:19], s53 offen sc1
MAA 32,4,144
ds_read_b128 v[20:23], v2
v_mfma_f32_16x16x32_bf16 a[212:215], a[208:211], a[192:195], a[212:215]
ds_read_b128 v[28:31], v2 offset:1024
v_mfma_f32_16x16x32_bf16 a[212:215], a[208:211], a[196:199], a[212:215]
s_waitcnt vmcnt(11)
ds_read_b128 v[24:27], v2 offset:2048
v_mfma_f32_16x16x32_bf16 a[212:215], a[208:211], a[200:203], a[212:215]
TR 64,16,16896
v_mfma_f32_16x16x32_bf16 a[212:215], a[208:211], a[204:207], a[212:215]
TR 66,16,17408
MAA 36,4,148
buffer_load_dwordx4 a[172:175], v11, s[16:19], s53 offen offset:1024 sc1
MAA 36,0,132
TR 68,16,25344
s_add_u32 s53, s53, 131072
MAA 52,8,132
TR 70,16,25856
MAA 52,12,148
TR 72,16,16928
MAA 48,12,144
TR 74,16,17440
s_waitcnt lgkmcnt(7)
v_add_f32 v20, v20, v28
MAA 48,8,128
TR 76,16,25376
v_add_f32 v21, v21, v29
MAA 96,16,128
buffer_load_dwordx4 a[184:187], v11, s[16:19], s53 offen sc1
MAA 96,20,144
TR 78,16,25888
v_add_f32 v22, v22, v30
MAA 100,20,148
TR 80,16,16960
v_add_f32 v23, v23, v31
MAA 100,16,132
ds_read_b128 v[28:31], v2 offset:3072
s_waitcnt lgkmcnt(10)
v_add_f32 v20, v20, v24
MAA 116,24,132
TR 82,16,17472
v_add_f32 v21, v21, v25
MAA 116,28,148
TR 84,16,25408
v_add_f32 v22, v22, v26
MAA 112,28,144
buffer_load_dwordx4 a[188:191], v11, s[16:19], s53 offen offset:1024 sc1
MAA 112,24,128
TR 86,16,25920
s_add_u32 s53, s53, 131072
MAA 160,32,128
TR 88,16,16992
s_add_u32 m0, s55, 84480
MAA 160,36,144
TR 90,16,17504
v_add_f32 v23, v23, v27
MAA 164,36,148
TR 92,16,25440
MAA 164,32,132
TR 94,16,25952
MAA 180,40,132
buffer_load_dwordx4 v12, s[32:35], s54 offen   lds
MAA 180,44,148
TR 96,16,17024
MAA 176,44,144
TR 98,16,17536
MAA 176,40,128
TR 100,16,25472
MAA 224,48,128
TR 102,16,25984
MAA 224,52,144
TR 104,16,17056
MAA 228,52,148
buffer_load_dwordx4 v13, s[32:35], s54 offen offset:1056   lds
MAA 228,48,132
TR 106,16,17568
MAA 236,56,132
TR 108,16,25504
MAA 236,60,148
TR 110,16,26016
MAA 232,60,144
TR 112,17,16896
MAA 232,56,128
TR 114,17,17408
MAA 188,40,140
buffer_load_dwordx4 v14, s[32:35], s54 offen offset:2112   lds
MAA 188,44,156
TR 116,17,25344
MAA 184,44,152
TR 118,17,25856
MAA 184,40,136
TR 120,17,16928
MAA 168,32,136
TR 122,17,17440
MAA 168,36,152
TR 124,17,25376
MAA 172,36,156
buffer_load_dwordx4 v15, s[32:35], s54 offen offset:3168   lds
.Lpad3:
s_cbranch_execz .Lnopoll33r
MAA 172,32,140
TR 126,17,25888
s_add_u32 m0, s57, 6144
MAA 124,24,140
RD 192,9,16896
s_mov_b32 s58, 29628416
MAA 124,28,156
RD 196,9,17952
MAA 120,28,152
RD 200,9,19008
MAA 120,24,136
RD 204,9,20064
MAA 104,16,136
buffer_load_dwordx4 v4, s[16:19], s58 offen sc1 lds
MAA 104,20,152
MAA 108,20,156
MAA 108,16,140
MAA 60,8,140
MAA 60,12,156
MAA 56,12,152
buffer_load_dwordx4 v4, s[16:19], s58 offen offset:1024 sc1 lds
MAA 56,8,136
MAA 40,0,136
MAA 40,4,152
MAA 44,4,156
s_sub_u32 s47, s47, 1
s_cbranch_scc1 .Lx38
.Lx38b:
MAA 44,0,140
s_waitcnt lgkmcnt(0)
s_barrier
MAA 64,64,128
s_waitcnt vmcnt(14)
ds_read_b128 v[24:27], v2 offset:4096
s_add_u32 m0, s55, 101376
MAA 64,68,144
buffer_load_dwordx4 v12, s[80:83], s54 offen   lds
v_mfma_f32_16x16x32_bf16 a[216:219], a[208:211], a[192:195], a[216:219]
TR 0,16,33792
v_add_f32 v20, v20, v28
v_mfma_f32_16x16x32_bf16 a[216:219], a[208:211], a[196:199], a[216:219]
TR 2,16,34304
v_add_f32 v21, v21, v29
v_mfma_f32_16x16x32_bf16 a[216:219], a[208:211], a[200:203], a[216:219]
TR 4,16,42240
v_add_f32 v22, v22, v30
v_mfma_f32_16x16x32_bf16 a[216:219], a[208:211], a[204:207], a[216:219]
TR 6,16,42752
v_add_f32 v23, v23, v31
MAA 68,68,148
ds_read_b128 v[28:31], v2 offset:5120
MAA 68,64,132
TR 8,16,33824
MAA 84,72,132
buffer_load_dwordx4 v13, s[80:83], s54 offen offset:1056   lds
MAA 84,76,148
TR 10,16,34336
s_waitcnt lgkmcnt(7)
v_add_f32 v20, v20, v24
MAA 80,76,144
TR 12,16,42272
v_add_f32 v21, v21, v25
MAA 80,72,128
TR 14,16,42784
v_add_f32 v22, v22, v26
MAA 128,80,128
TR 16,16,33856
v_add_f32 v23, v23, v27
MAA 128,84,144
TR 18,16,34368
MAA 132,84,148
TR 20,16,42304
MAA 132,80,132
buffer_load_dwordx4 v14, s[80:83], s54 offen offset:2112   lds
MAA 148,88,132
TR 22,16,42816
MAA 148,92,148
TR 24,16,33888
MAA 144,92,144
TR 26,16,34400
MAA 144,88,128
TR 28,16,42336
MAA 192,96,128
TR 30,16,42848
MAA 192,100,144
TR 32,16,33920
MAA 196,100,148
buffer_load_dwordx4 v15, s[80:83], s54 offen offset:3168   lds
MAA 196,96,132
TR 34,16,34432
s_add_u32 s54, s54, 458752
MAA 212,104,132
TR 36,16,42368
MAA 212,108,148
TR 38,16,42880
MAA 208,108,144
TR 40,16,33952
MAA 208,104,128
TR 42,16,34464
MAA 240,112,128
TR 44,16,42400
MAA 240,116,144
TR 46,16,42912
MAA 244,116,148
TR 48,17,33792
MAA 244,112,132
TR 50,17,34304
MAA 252,120,132
TR 52,17,42240
MAA 252,124,148
TR 54,17,42752
MAA 248,124,144
TR 56,17,33824
MAA 248,120,128
buffer_load_dwordx4 a[128:131], v10, s[16:19], s52 offen sc1
MAA 220,104,140
TR 58,17,34336
MAA 220,108,156
TR 60,17,42272
MAA 216,108,152
TR 62,17,42784
MAA 216,104,136
RD 192,9,33792
MAA 200,96,136
RD 196,9,34848
MAA 200,100,152
RD 200,9,35904
MAA 204,100,156
buffer_load_dwordx4 a[132:135], v10, s[16:19], s52 offen offset:1024 sc1
MAA 204,96,140
RD 204,9,36960
s_add_u32 s52, s52, 131072
MAA 156,88,140
MAA 156,92,156
MAA 152,92,152
MAA 152,88,136
MAA 136,80,136
MAA 136,84,152
buffer_load_dwordx4 a[144:147], v10, s[16:19], s52 offen sc1
MAA 140,84,156
MAA 140,80,140
MAA 92,72,140
MAA 92,76,156
MAA 88,76,152
MAA 88,72,136
MAA 72,64,136
buffer_load_dwordx4 a[148:151], v10, s[16:19], s52 offen offset:1024 sc1
MAA 72,68,152
s_add_u32 s52, s52, 131072
MAA 76,68,156
s_sub_u32 s47, s47, 1
s_cbranch_scc1 .Lx39
.Lx39b:
MAA 76,64,140
s_waitcnt vmcnt(18) lgkmcnt(0)
s_barrier
MAA 32,0,160
buffer_load_dwordx4 a[136:139], v11, s[16:19], s53 offen sc1
MAA 32,4,176
s_waitcnt vmcnt(9)
ds_read_b128 v[24:27], v2 offset:6144
v_add_f32 v20, v20, v28
v_mfma_f32_16x16x32_bf16 a[212:215], a[208:211], a[192:195], a[212:215]
TR 64,16,50688
v_add_f32 v21, v21, v29
v_mfma_f32_16x16x32_bf16 a[212:215], a[208:211], a[196:199], a[212:215]
TR 66,16,51200
v_add_f32 v22, v22, v30
v_mfma_f32_16x16x32_bf16 a[212:215], a[208:211], a[200:203], a[212:215]
TR 68,16,59136
v_add_f32 v23, v23, v31
v_mfma_f32_16x16x32_bf16 a[212:215], a[208:211], a[204:207], a[212:215]
ds_read_b128 v[28:31], v2 offset:7168
MAA 36,4,180
TR 70,16,59648
MAA 36,0,164
buffer_load_dwordx4 a[140:143], v11, s[16:19], s53 offen offset:1024 sc1
MAA 52,8,164
TR 72,16,50720
s_add_u32 s53, s53, 131072
MAA 52,12,180
TR 74,16,51232
s_waitcnt lgkmcnt(7)
v_add_f32 v20, v20, v24
MAA 48,12,176
TR 76,16,59168
v_add_f32 v21, v21, v25
MAA 48,8,160
TR 78,16,59680
v_add_f32 v22, v22, v26
MAA 96,16,160
TR 80,16,50752
v_add_f32 v23, v23, v27
MAA 96,20,176
TR 82,16,51264
s_waitcnt lgkmcnt(7)
v_add_f32 v20, v20, v28
MAA 100,20,180
buffer_load_dwordx4 a[152:155], v11, s[16:19], s53 offen sc1
MAA 100,16,164
TR 84,16,59200
v_add_f32 v21, v21, v29
MAA 116,24,164
TR 86,16,59712
v_add_f32 v22, v22, v30
MAA 116,28,180
TR 88,16,50784
v_add_f32 v23, v23, v31
MAA 112,28,176
TR 90,16,51296
MAA 112,24,160
TR 92,16,59232
MAA 160,32,160
TR 94,16,59744
MAA 160,36,176
buffer_load_dwordx4 a[156:159], v11, s[16:19], s53 offen offset:1024 sc1
MAA 164,36,180
TR 96,16,50816
s_add_u32 s53, s53, 131072
MAA 164,32,164
TR 98,16,51328
s_add_u32 m0, s55, 118272
MAA 180,40,164
TR 100,16,59264
MAA 180,44,180
TR 102,16,59776
MAA 176,44,176
TR 104,16,50848
MAA 176,40,160
TR 106,16,51360
MAA 224,48,160
buffer_load_dwordx4 v12, s[32:35], s54 offen   lds
MAA 224,52,176
TR 108,16,59296
MAA 228,52,180
TR 110,16,59808
MAA 228,48,164
TR 112,17,50688
MAA 236,56,164
TR 114,17,51200
MAA 236,60,180
TR 116,17,59136
MAA 232,60,176
TR 118,17,59648
MAA 232,56,160
buffer_load_dwordx4 v13, s[32:35], s54 offen offset:1056   lds
MAA 188,40,172
TR 120,17,50720
MAA 188,44,188
TR 122,17,51232
MAA 184,44,184
TR 124,17,59168
MAA 184,40,168
TR 126,17,59680
MAA 168,32,168
RD 192,9,50688
MAA 168,36,184
RD 196,9,51744
MAA 172,36,188
buffer_load_dwordx4 v14, s[32:35], s54 offen offset:2112   lds
MAA 172,32,172
RD 200,9,52800
MAA 124,24,172
RD 204,9,53856
MAA 124,28,188
MAA 120,28,184
MAA 120,24,168
MAA 104,16,168
MAA 104,20,184
buffer_load_dwordx4 v15, s[32:35], s54 offen offset:3168   lds
MAA 108,20,188
MAA 108,16,172
MAA 60,8,172
MAA 60,12,188
MAA 56,12,184
MAA 56,8,168
MAA 40,0,168
MAA 40,4,184
MAA 44,4,188
s_sub_u32 s47, s47, 1
s_cbranch_scc1 .Lx40
.Lx40b:
MAA 44,0,172
s_waitcnt lgkmcnt(0)
s_barrier
MAA 64,64,160
ds_read_b64_tr_b16 a[0:1], v16
s_add_u32 m0, s55, 135168
MAA 64,68,176
buffer_load_dwordx4 v12, s[80:83], s54 offen   lds
v_mfma_f32_16x16x32_bf16 a[216:219], a[208:211], a[192:195], a[216:219]
TR 2,16,512
v_permlane32_swap_b32 v20, v22
v_mfma_f32_16x16x32_bf16 a[216:219], a[208:211], a[196:199], a[216:219]
TR 4,16,8448
v_permlane32_swap_b32 v21, v23
v_mfma_f32_16x16x32_bf16 a[216:219], a[208:211], a[200:203], a[216:219]
TR 6,16,8960
v_add_f32 v20, v20, v22
v_mfma_f32_16x16x32_bf16 a[216:219], a[208:211], a[204:207], a[216:219]
TR 8,16,32
v_add_f32 v21, v21, v23
MAA 68,68,180
TR 10,16,544
v_mul_f32 v20, 0xba800000, v20
MAA 68,64,164
TR 12,16,8480
v_mul_f32 v21, 0x3a800000, v21
MAA 84,72,164
buffer_load_dwordx4 v13, s[80:83], s54 offen offset:1056   lds
MAA 84,76,180
TR 14,16,8992
v_fma_f32 v21, -v20, v20, v21
MAA 80,76,176
TR 16,16,64
v_max_f32 v21, 0, v21
MAA 80,72,160
TR 18,16,576
v_add_f32 v21, 0x3727c5ac, v21
MAA 128,80,160
TR 20,16,8512
v_rsq_f32 v22, v21
MAA 128,84,176
TR 22,16,9024
v_and_b32 v24, 31, v1
MAA 132,84,180
TR 24,16,96
v_lshrrev_b32 v25, 5, v1
MAA 132,80,164
buffer_load_dwordx4 v14, s[80:83], s54 offen offset:2112   lds
MAA 148,88,164
TR 26,16,608
v_lshl_add_u32 v24, v24, 1, v25
MAA 148,92,180
TR 28,16,8544
v_and_b32 v25, 0xc0, v0
MAA 144,92,176
TR 30,16,9056
v_add_u32 v24, v24, v25
MAA 144,88,160
TR 32,16,128
v_lshlrev_b32 v24, 4, v24
MAA 192,96,160
TR 34,16,640
v_add_u32 v24, 152576, v24
MAA 192,100,176
TR 36,16,8576
v_mul_f32 v22, 0xbfb8aa3b, v22
MAA 196,100,180
buffer_load_dwordx4 v15, s[80:83], s54 offen offset:3168   lds
MAA 196,96,164
ds_write_b128 v24, v[20:23]
s_add_u32 s54, s54, 458752
MAA 212,104,164
ds_read_b64 v[20:21], v18
s_mov_b32 s58, s98
MAA 212,108,180
ds_read_b64 v[22:23], v18 offset:256
s_mov_b32 s67, s59
MAA 208,108,176
ds_read_b64 v[24:25], v19
MAA 208,104,160
ds_read_b64 v[26:27], v19 offset:256
MAA 240,112,160
ds_read_b32 v28, v18 offset:8
MAA 240,116,176
ds_read_b32 v29, v18 offset:264
v_mov_b32 v18, v5
MAA 244,116,180
ds_read_b32 v30, v19 offset:8
MAA 244,112,164
ds_read_b32 v31, v19 offset:264
v_mov_b32 v19, v6
MAA 252,120,164
TR 38,16,9088
MAA 252,124,180
TR 40,16,160
MAA 248,124,176
TR 42,16,672
MAA 248,120,160
buffer_load_dwordx4 a[160:163], v10, s[16:19], s52 offen sc1
MAA 220,104,172
TR 44,16,8608
MAA 220,108,188
TR 46,16,9120
MAA 216,108,184
ds_read_b64_tr_b16 a[48:49], v17
MAA 216,104,168
TR 50,17,512
MAA 200,96,168
TR 52,17,8448
MAA 200,100,184
TR 54,17,8960
MAA 204,100,188
buffer_load_dwordx4 a[164:167], v10, s[16:19], s52 offen offset:1024 sc1
MAA 204,96,172
TR 56,17,32
s_add_u32 s52, s52, 131072
MAA 156,88,172
TR 58,17,544
MAA 156,92,188
TR 60,17,8480
MAA 152,92,184
TR 62,17,8992
MAA 152,88,168
ds_read_b128 a[192:195], v9
MAA 136,80,168
RD 196,9,1056
MAA 136,84,184
buffer_load_dwordx4 a[176:179], v10, s[16:19], s52 offen sc1
MAA 140,84,188
RD 200,9,2112
MAA 140,80,172
RD 204,9,3168
MAA 92,72,172
MAA 92,76,188
MAA 88,76,184
MAA 88,72,168
MAA 72,64,168
buffer_load_dwordx4 a[180:183], v10, s[16:19], s52 offen offset:1024 sc1
MAA 72,68,184
s_add_u32 s52, s52, 131072
MAA 76,68,188
s_sub_u32 s47, s47, 1
s_cbranch_scc1 .Lx41
.Lx41b:
MAA 76,64,172
s_mov_b32 s15, -5
.p2align 6
.Lk42:
s_waitcnt vmcnt(16) lgkmcnt(0)
s_barrier
MAA 32,0,128
TR 64,16,16896
MAA 32,4,144
buffer_load_dwordx4 a[168:171], v11, s[16:19], s53 offen sc1
v_mfma_f32_16x16x32_bf16 a[212:215], a[208:211], a[192:195], a[212:215]
s_sub_u32 s47, s47, 1
s_cbranch_scc1 .Lx43
.Lx43b:
v_mfma_f32_16x16x32_bf16 a[212:215], a[208:211], a[196:199], a[212:215]
TR 66,16,17408
v_mfma_f32_16x16x32_bf16 a[212:215], a[208:211], a[200:203], a[212:215]
TR 68,16,25344
v_mfma_f32_16x16x32_bf16 a[212:215], a[208:211], a[204:207], a[212:215]
TR 70,16,25856
MAA 36,4,148
MAA 36,0,132
buffer_load_dwordx4 a[172:175], v11, s[16:19], s53 offen offset:1024 sc1
MAA 52,8,132
TR 72,16,16928
s_add_u32 s53, s53, 131072
MAA 52,12,148
TR 74,16,17440
MAA 48,12,144
TR 76,16,25376
MAA 48,8,128
TR 78,16,25888
MAA 96,16,128
MAA 96,20,144
buffer_load_dwordx4 a[184:187], v11, s[16:19], s53 offen sc1
MAA 100,20,148
TR 80,16,16960
MAA 100,16,132
TR 82,16,17472
MAA 116,24,132
TR 84,16,25408
MAA 116,28,148
TR 86,16,25920
MAA 112,28,144
MAA 112,24,128
TR 88,16,16992
MAA 160,32,128
buffer_load_dwordx4 a[188:191], v11, s[16:19], s53 offen offset:1024 sc1
MAA 160,36,144
TR 90,16,17504
s_add_u32 s53, s53, 131072
MAA 164,36,148
TR 92,16,25440
MAA 164,32,132
TR 94,16,25952
MAA 180,40,132
MAA 180,44,148
TR 96,16,17024
s_add_u32 m0, s55, 84480
MAA 176,44,144
buffer_load_dwordx4 v12, s[32:35], s54 offen   lds
MAA 176,40,128
TR 98,16,17536
MAA 224,48,128
TR 100,16,25472
MAA 224,52,144
TR 102,16,25984
MAA 228,52,148
MAA 228,48,132
TR 104,16,17056
MAA 236,56,132
TR 106,16,17568
MAA 236,60,148
buffer_load_dwordx4 v13, s[32:35], s54 offen offset:1056   lds
MAA 232,60,144
TR 108,16,25504
MAA 232,56,128
TR 110,16,26016
s_waitcnt vmcnt(18)
MAA 188,40,140
MAA 188,44,156
TR 112,17,16896
MAA 184,44,152
TR 114,17,17408
MAA 184,40,136
buffer_load_dwordx4 v14, s[32:35], s54 offen offset:2112   lds
MAA 168,32,136
TR 116,17,25344
MAA 168,36,152
TR 118,17,25856
MAA 172,36,156
MAA 172,32,140
TR 120,17,16928
MAA 124,24,140
TR 122,17,17440
MAA 124,28,156
TR 124,17,25376
MAA 120,28,152
buffer_load_dwordx4 v15, s[32:35], s54 offen offset:3168   lds
MAA 120,24,136
TR 126,17,25888
MAA 104,16,136
MAA 104,20,152
RD 192,9,16896
MAA 108,20,156
RD 196,9,17952
MAA 108,16,140
RD 200,9,19008
s_mov_b32 m0, s67
MAA 60,8,140
buffer_load_dwordx4 v18, s[28:31], s58 offen lds
MAA 60,12,156
RD 204,9,20064
MAA 56,12,152
MAA 56,8,136
MAA 40,0,136
MAA 40,4,152
MAA 44,4,156
MAA 44,0,140
s_waitcnt vmcnt(17) lgkmcnt(0)
s_barrier
.Lpad4:
s_cbranch_execz .Lnopoll33r
MAA 64,64,128
TR 0,16,33792
s_add_u32 m0, s55, 101376
MAA 64,68,144
buffer_load_dwordx4 v12, s[80:83], s54 offen   lds
v_mfma_f32_16x16x32_bf16 a[216:219], a[208:211], a[192:195], a[216:219]
s_sub_u32 s47, s47, 1
s_cbranch_scc1 .Lx44
.Lx44b:
v_mfma_f32_16x16x32_bf16 a[216:219], a[208:211], a[196:199], a[216:219]
TR 2,16,34304
v_mfma_f32_16x16x32_bf16 a[216:219], a[208:211], a[200:203], a[216:219]
TR 4,16,42240
v_mfma_f32_16x16x32_bf16 a[216:219], a[208:211], a[204:207], a[216:219]
TR 6,16,42752
MAA 68,68,148
TR 8,16,33824
MAA 68,64,132
buffer_load_dwordx4 v13, s[80:83], s54 offen offset:1056   lds
MAA 84,72,132
MAA 84,76,148
TR 10,16,34336
MAA 80,76,144
TR 12,16,42272
MAA 80,72,128
TR 14,16,42784
MAA 128,80,128
TR 16,16,33856
MAA 128,84,144
buffer_load_dwordx4 v14, s[80:83], s54 offen offset:2112   lds
MAA 132,84,148
MAA 132,80,132
TR 18,16,34368
MAA 148,88,132
TR 20,16,42304
MAA 148,92,148
TR 22,16,42816
MAA 144,92,144
TR 24,16,33888
MAA 144,88,128
TR 26,16,34400
MAA 192,96,128
buffer_load_dwordx4 v15, s[80:83], s54 offen offset:3168   lds
MAA 192,100,144
s_add_u32 s54, s54, 458752
MAA 196,100,148
TR 28,16,42336
MAA 196,96,132
TR 30,16,42848
MAA 212,104,132
TR 32,16,33920
MAA 212,108,148
TR 34,16,34432
s_mov_b32 m0, s67
MAA 208,108,144
buffer_load_dwordx4 v19, s[28:31], s58 offen offset:1056 lds
MAA 208,104,128
s_add_u32 s67, s67, 8448
s_add_u32 s58, s58, 0x40000
MAA 240,112,128
MAA 240,116,144
TR 36,16,42368
MAA 244,116,148
TR 38,16,42880
MAA 244,112,132
TR 40,16,33952
MAA 252,120,132
TR 42,16,34464
MAA 252,124,148
TR 44,16,42400
MAA 248,124,144
MAA 248,120,128
buffer_load_dwordx4 a[128:131], v10, s[16:19], s52 offen sc1
MAA 220,104,140
TR 46,16,42912
MAA 220,108,156
TR 48,17,33792
MAA 216,108,152
TR 50,17,34304
MAA 216,104,136
buffer_load_dwordx4 a[132:135], v10, s[16:19], s52 offen offset:1024 sc1
MAA 200,96,136
TR 52,17,42240
s_add_u32 s52, s52, 131072
MAA 200,100,152
MAA 204,100,156
TR 54,17,42752
MAA 204,96,140
TR 56,17,33824
MAA 156,88,140
TR 58,17,34336
MAA 156,92,156
TR 60,17,42272
MAA 152,92,152
buffer_load_dwordx4 a[144:147], v10, s[16:19], s52 offen sc1
MAA 152,88,136
TR 62,17,42784
MAA 136,80,136
MAA 136,84,152
RD 192,9,33792
MAA 140,84,156
RD 196,9,34848
MAA 140,80,140
RD 200,9,35904
MAA 92,72,140
buffer_load_dwordx4 a[148:151], v10, s[16:19], s52 offen offset:1024 sc1
MAA 92,76,156
RD 204,9,36960
s_add_u32 s52, s52, 131072
MAA 88,76,152
MAA 88,72,136
MAA 72,64,136
MAA 72,68,152
MAA 76,68,156
MAA 76,64,140
s_waitcnt vmcnt(18) lgkmcnt(0)
s_barrier
MAA 32,0,160
TR 64,16,50688
MAA 32,4,176
buffer_load_dwordx4 a[136:139], v11, s[16:19], s53 offen sc1
v_mfma_f32_16x16x32_bf16 a[212:215], a[208:211], a[192:195], a[212:215]
s_sub_u32 s47, s47, 1
s_cbranch_scc1 .Lx45
.Lx45b:
v_mfma_f32_16x16x32_bf16 a[212:215], a[208:211], a[196:199], a[212:215]
TR 66,16,51200
v_mfma_f32_16x16x32_bf16 a[212:215], a[208:211], a[200:203], a[212:215]
TR 68,16,59136
v_mfma_f32_16x16x32_bf16 a[212:215], a[208:211], a[204:207], a[212:215]
TR 70,16,59648
MAA 36,4,180
MAA 36,0,164
buffer_load_dwordx4 a[140:143], v11, s[16:19], s53 offen offset:1024 sc1
MAA 52,8,164
TR 72,16,50720
s_add_u32 s53, s53, 131072
MAA 52,12,180
TR 74,16,51232
MAA 48,12,176
TR 76,16,59168
MAA 48,8,160
TR 78,16,59680
MAA 96,16,160
MAA 96,20,176
buffer_load_dwordx4 a[152:155], v11, s[16:19], s53 offen sc1
MAA 100,20,180
TR 80,16,50752
MAA 100,16,164
TR 82,16,51264
MAA 116,24,164
TR 84,16,59200
MAA 116,28,180
TR 86,16,59712
MAA 112,28,176
MAA 112,24,160
TR 88,16,50784
MAA 160,32,160
buffer_load_dwordx4 a[156:159], v11, s[16:19], s53 offen offset:1024 sc1
MAA 160,36,176
TR 90,16,51296
s_add_u32 s53, s53, 131072
MAA 164,36,180
TR 92,16,59232
MAA 164,32,164
TR 94,16,59744
MAA 180,40,164
MAA 180,44,180
TR 96,16,50816
s_add_u32 m0, s55, 118272
MAA 176,44,176
buffer_load_dwordx4 v12, s[32:35], s54 offen   lds
MAA 176,40,160
TR 98,16,51328
MAA 224,48,160
TR 100,16,59264
MAA 224,52,176
TR 102,16,59776
MAA 228,52,180
MAA 228,48,164
TR 104,16,50848
MAA 236,56,164
TR 106,16,51360
MAA 236,60,180
buffer_load_dwordx4 v13, s[32:35], s54 offen offset:1056   lds
MAA 232,60,176
TR 108,16,59296
MAA 232,56,160
TR 110,16,59808
s_waitcnt vmcnt(20)
MAA 188,40,172
MAA 188,44,188
TR 112,17,50688
MAA 184,44,184
TR 114,17,51200
MAA 184,40,168
buffer_load_dwordx4 v14, s[32:35], s54 offen offset:2112   lds
MAA 168,32,168
TR 116,17,59136
MAA 168,36,184
TR 118,17,59648
MAA 172,36,188
MAA 172,32,172
TR 120,17,50720
MAA 124,24,172
TR 122,17,51232
MAA 124,28,188
TR 124,17,59168
MAA 120,28,184
buffer_load_dwordx4 v15, s[32:35], s54 offen offset:3168   lds
MAA 120,24,168
TR 126,17,59680
MAA 104,16,168
MAA 104,20,184
RD 192,9,50688
MAA 108,20,188
RD 196,9,51744
MAA 108,16,172
RD 200,9,52800
s_mov_b32 m0, s67
MAA 60,8,172
buffer_load_dwordx4 v18, s[28:31], s58 offen lds
MAA 60,12,188
RD 204,9,53856
MAA 56,12,184
MAA 56,8,168
MAA 40,0,168
MAA 40,4,184
MAA 44,4,188
MAA 44,0,172
s_waitcnt vmcnt(19) lgkmcnt(0)
s_barrier
MAA 64,64,160
ds_read_b64_tr_b16 a[0:1], v16
s_add_u32 m0, s55, 135168
MAA 64,68,176
buffer_load_dwordx4 v12, s[80:83], s54 offen   lds
v_mfma_f32_16x16x32_bf16 a[216:219], a[208:211], a[192:195], a[216:219]
s_sub_u32 s47, s47, 1
s_cbranch_scc1 .Lx46
.Lx46b:
v_mfma_f32_16x16x32_bf16 a[216:219], a[208:211], a[196:199], a[216:219]
TR 2,16,512
v_mfma_f32_16x16x32_bf16 a[216:219], a[208:211], a[200:203], a[216:219]
TR 4,16,8448
v_mfma_f32_16x16x32_bf16 a[216:219], a[208:211], a[204:207], a[216:219]
TR 6,16,8960
MAA 68,68,180
TR 8,16,32
MAA 68,64,164
buffer_load_dwordx4 v13, s[80:83], s54 offen offset:1056   lds
MAA 84,72,164
MAA 84,76,180
TR 10,16,544
MAA 80,76,176
TR 12,16,8480
MAA 80,72,160
TR 14,16,8992
MAA 128,80,160
TR 16,16,64
MAA 128,84,176
buffer_load_dwordx4 v14, s[80:83], s54 offen offset:2112   lds
MAA 132,84,180
MAA 132,80,164
TR 18,16,576
MAA 148,88,164
TR 20,16,8512
MAA 148,92,180
TR 22,16,9024
MAA 144,92,176
TR 24,16,96
MAA 144,88,160
TR 26,16,608
MAA 192,96,160
buffer_load_dwordx4 v15, s[80:83], s54 offen offset:3168   lds
MAA 192,100,176
s_add_u32 s54, s54, 458752
MAA 196,100,180
TR 28,16,8544
MAA 196,96,164
TR 30,16,9056
MAA 212,104,164
TR 32,16,128
MAA 212,108,180
TR 34,16,640
s_mov_b32 m0, s67
MAA 208,108,176
buffer_load_dwordx4 v19, s[28:31], s58 offen offset:1056 lds
MAA 208,104,160
s_add_u32 s67, s67, 8448
s_add_u32 s46, s46, 1
s_xor_b32 s58, s46, s87
s_mul_i32 s58, s58, 458752
MAA 240,112,160
MAA 240,116,176
TR 36,16,8576
MAA 244,116,180
TR 38,16,9088
MAA 244,112,164
TR 40,16,160
MAA 252,120,164
TR 42,16,672
MAA 252,124,180
TR 44,16,8608
MAA 248,124,176
MAA 248,120,160
buffer_load_dwordx4 a[160:163], v10, s[16:19], s52 offen sc1
MAA 220,104,172
TR 46,16,9120
MAA 220,108,188
ds_read_b64_tr_b16 a[48:49], v17
MAA 216,108,184
TR 50,17,512
MAA 216,104,168
buffer_load_dwordx4 a[164:167], v10, s[16:19], s52 offen offset:1024 sc1
MAA 200,96,168
TR 52,17,8448
s_add_u32 s52, s52, 131072
MAA 200,100,184
MAA 204,100,188
TR 54,17,8960
MAA 204,96,172
TR 56,17,32
MAA 156,88,172
TR 58,17,544
MAA 156,92,188
TR 60,17,8480
MAA 152,92,184
buffer_load_dwordx4 a[176:179], v10, s[16:19], s52 offen sc1
MAA 152,88,168
TR 62,17,8992
MAA 136,80,168
MAA 136,84,184
ds_read_b128 a[192:195], v9
MAA 140,84,188
RD 196,9,1056
MAA 140,80,172
RD 200,9,2112
MAA 92,72,172
buffer_load_dwordx4 a[180:183], v10, s[16:19], s52 offen offset:1024 sc1
MAA 92,76,188
RD 204,9,3168
s_add_u32 s52, s52, 131072
MAA 88,76,184
MAA 88,72,168
MAA 72,64,168
MAA 72,68,184
MAA 76,68,188
s_add_u32 s15, s15, 1
MAA 76,64,172
s_cbranch_scc0 .Lk42
s_branch .Lj47
.Lx38:
buffer_load_dword a220, v8, s[40:43], s45 offen
buffer_load_dword a220, v7, s[28:31], s44 offen
s_add_u32 s44, s44, 655360
s_add_u32 s45, s45, 917504
s_mov_b32 s47, 3
s_branch .Lx38b
.Lx39:
buffer_load_dword a220, v8, s[40:43], s45 offen
buffer_load_dword a220, v7, s[28:31], s44 offen
s_add_u32 s44, s44, 655360
s_add_u32 s45, s45, 917504
s_mov_b32 s47, 3
s_branch .Lx39b
.Lx40:
buffer_load_dword a220, v8, s[40:43], s45 offen
buffer_load_dword a220, v7, s[28:31], s44 offen
s_add_u32 s44, s44, 655360
s_add_u32 s45, s45, 917504
s_mov_b32 s47, 3
s_branch .Lx40b
.Lx41:
buffer_load_dword a220, v8, s[40:43], s45 offen
buffer_load_dword a220, v7, s[28:31], s44 offen
s_add_u32 s44, s44, 655360
s_add_u32 s45, s45, 917504
s_mov_b32 s47, 3
s_branch .Lx41b
.Lx43:
buffer_load_dword a220, v8, s[40:43], s45 offen
buffer_load_dword a220, v7, s[28:31], s44 offen
s_add_u32 s44, s44, 655360
s_add_u32 s45, s45, 917504
s_mov_b32 s47, 3
s_branch .Lx43b
.Lx44:
buffer_load_dword a220, v8, s[40:43], s45 offen
buffer_load_dword a220, v7, s[28:31], s44 offen
s_add_u32 s44, s44, 655360
s_add_u32 s45, s45, 917504
s_mov_b32 s47, 3
s_branch .Lx44b
.Lx45:
buffer_load_dword a220, v8, s[40:43], s45 offen
buffer_load_dword a220, v7, s[28:31], s44 offen
s_add_u32 s44, s44, 655360
s_add_u32 s45, s45, 917504
s_mov_b32 s47, 3
s_branch .Lx45b
.Lx46:
buffer_load_dword a220, v8, s[40:43], s45 offen
buffer_load_dword a220, v7, s[28:31], s44 offen
s_add_u32 s44, s44, 655360
s_add_u32 s45, s45, 917504
s_mov_b32 s47, 3
s_branch .Lx46b
.Lj47:
s_waitcnt vmcnt(10) lgkmcnt(0)
s_barrier
v_mfma_f32_16x16x32_bf16 a[212:215], a[208:211], a[192:195], a[212:215]
RD 112,9,16896
s_lshl_b32 s74, s3, 10
v_mfma_f32_16x16x32_bf16 a[212:215], a[208:211], a[196:199], a[212:215]
RD 116,9,17952
s_add_u32 s74, s74, 152576
v_mfma_f32_16x16x32_bf16 a[212:215], a[208:211], a[200:203], a[212:215]
RD 120,9,19008
s_sub_u32 s75, 156672, s74
v_mfma_f32_16x16x32_bf16 a[212:215], a[208:211], a[204:207], a[212:215]
RD 124,9,20064
v_and_b32 v7, 15, v1
MAA 32,0,128
RD 192,9,33792
v_lshl_add_u32 v7, v7, 5, s74
MAA 32,4,144
RD 196,9,34848
v_bfe_u32 v2, v1, 4, 1
MAA 48,12,144
RD 200,9,35904
v_lshl_add_u32 v7, v2, 4, v7
MAA 48,8,128
RD 204,9,36960
v_bfe_u32 v2, v1, 5, 1
MAA 36,0,132
buffer_load_dwordx4 a[168:171], v11, s[16:19], s53 offen sc1
s_waitcnt lgkmcnt(7)
v_mfma_f32_16x16x32_bf16 a[216:219], a[208:211], a[112:115], a[216:219]
TR 64,16,16896
v_mul_u32_u24 v2, s75, v2
s_waitcnt lgkmcnt(7)
v_mfma_f32_16x16x32_bf16 a[216:219], a[208:211], a[116:119], a[216:219]
TR 66,16,17408
v_add_u32 v7, v7, v2
s_waitcnt lgkmcnt(7)
v_mfma_f32_16x16x32_bf16 a[216:219], a[208:211], a[120:123], a[216:219]
TR 68,16,25344
v_lshlrev_b32 v2, 4, v1
s_waitcnt lgkmcnt(7)
v_mfma_f32_16x16x32_bf16 a[216:219], a[208:211], a[124:127], a[216:219]
buffer_load_dwordx4 a[172:175], v11, s[16:19], s53 offen offset:1024 sc1
s_waitcnt lgkmcnt(6)
v_mfma_f32_16x16x32_bf16 a[212:215], a[208:211], a[192:195], a[212:215]
TR 70,16,25856
s_add_u32 s53, s53, 131072
s_waitcnt lgkmcnt(6)
v_mfma_f32_16x16x32_bf16 a[212:215], a[208:211], a[196:199], a[212:215]
TR 72,16,16928
v_add_u32 v2, 152576, v2
s_waitcnt lgkmcnt(6)
v_mfma_f32_16x16x32_bf16 a[212:215], a[208:211], a[200:203], a[212:215]
TR 74,16,17440
s_lshl_b32 s74, s12, 7
s_waitcnt lgkmcnt(6)
v_mfma_f32_16x16x32_bf16 a[212:215], a[208:211], a[204:207], a[212:215]
buffer_load_dwordx4 a[184:187], v11, s[16:19], s53 offen sc1
MAA 36,4,148
TR 76,16,25376
s_add_u32 s74, s74, 161536
MAA 52,12,148
s_nop 2
ds_write_b128 v7, a[212:215]
s_waitcnt vmcnt(8)
s_barrier
MAA 52,8,132
RD 112,9,50688
s_xor_b32 s75, s12, 1
MAA 40,0,136
RD 116,9,51744
s_mul_i32 s75, s75, 384
MAA 40,4,152
RD 120,9,52800
s_add_u32 s75, s75, 161536
MAA 56,12,152
RD 124,9,53856
v_lshrrev_b32 v9, 4, v1
MAA 56,8,136
buffer_load_dwordx4 a[188:191], v11, s[16:19], s53 offen offset:1024 sc1
MAA 44,0,140
TR 78,16,25888
s_add_u32 s53, s53, 131072
MAA 44,4,156
TR 80,16,33792
v_lshlrev_b32 v9, 4, v9
MAA 60,12,156
TR 82,16,34304
v_add_u32 v8, s75, v9
MAA 60,8,140
TR 84,16,42240
v_add_u32 v9, s74, v9
s_waitcnt lgkmcnt(7)
v_mfma_f32_16x16x32_bf16 a[216:219], a[208:211], a[112:115], a[216:219]
TR 86,16,42752
s_add_u32 s58, s99, 2293760
s_waitcnt lgkmcnt(7)
v_mfma_f32_16x16x32_bf16 a[216:219], a[208:211], a[116:119], a[216:219]
TR 88,16,33824
s_lshl_b32 s74, s3, 11
s_waitcnt lgkmcnt(7)
v_mfma_f32_16x16x32_bf16 a[216:219], a[208:211], a[120:123], a[216:219]
TR 90,16,34336
s_add_u32 s74, s74, s84
s_waitcnt lgkmcnt(7)
v_mfma_f32_16x16x32_bf16 a[216:219], a[208:211], a[124:127], a[216:219]
TR 92,16,42272
s_add_u32 s54, s98, 65536
MAA 96,16,128
TR 94,16,42784
s_mul_i32 s55, s3, 2112
MAA 96,20,144
s_nop 1
ds_write_b128 v7, a[216:219] offset:512
s_mov_b32 s57, 67584
MAA 112,28,144
TR 96,16,50688
MAA 112,24,128
TR 98,16,51200
MAA 100,16,132
TR 100,16,59136
MAA 100,20,148
TR 102,16,59648
MAA 116,28,148
TR 104,16,50720
MAA 116,24,132
TR 106,16,51232
MAA 104,16,136
TR 108,16,59168
MAA 104,20,152
s_waitcnt lgkmcnt(7)
s_barrier
ds_read_b128 v[12:15], v2
MAA 120,28,152
ds_read_b128 v[4:7], v2 offset:1024
MAA 120,24,136
TR 110,16,59680
MAA 108,16,140
TR 192,16,16960
MAA 108,20,156
TR 194,16,17472
MAA 124,28,156
TR 196,16,25408
MAA 124,24,140
TR 198,16,25920
MAA 160,32,128
TR 200,16,16992
MAA 160,36,144
TR 202,16,17504
.Lpad5:
s_cbranch_execz .Lnopoll33r
MAA 176,44,144
TR 204,16,25440
s_waitcnt lgkmcnt(8)
v_add_f32 v12, v12, v4
MAA 176,40,128
TR 206,16,25952
v_add_f32 v13, v13, v5
MAA 164,32,132
TR 112,16,33856
v_add_f32 v14, v14, v6
MAA 164,36,148
TR 114,16,34368
v_add_f32 v15, v15, v7
MAA 180,44,148
ds_read_b128 v[4:7], v2 offset:2048
MAA 180,40,132
TR 116,16,42304
MAA 168,32,136
TR 118,16,42816
MAA 168,36,152
TR 120,16,33888
MAA 184,44,152
TR 122,16,34400
MAA 184,40,136
TR 124,16,42336
MAA 172,32,140
TR 126,16,42848
MAA 172,36,156
TR 0,16,50752
MAA 188,44,156
TR 2,16,51264
s_waitcnt lgkmcnt(8)
v_add_f32 v12, v12, v4
MAA 188,40,140
TR 4,16,59200
v_add_f32 v13, v13, v5
MAA 224,48,128
TR 6,16,59712
v_add_f32 v14, v14, v6
MAA 224,52,144
TR 8,16,50784
v_add_f32 v15, v15, v7
MAA 232,60,144
ds_read_b128 v[4:7], v2 offset:3072
MAA 232,56,128
TR 10,16,51296
MAA 228,48,132
TR 12,16,59232
MAA 228,52,148
TR 14,16,59744
MAA 236,60,148
TR 16,16,17024
MAA 236,56,132
TR 18,16,17536
MAA 64,64,128
TR 20,16,25472
MAA 64,68,144
TR 22,16,25984
s_waitcnt vmcnt(7)
MAA 64,96,160
TR 24,16,17056
s_waitcnt lgkmcnt(8)
v_add_f32 v12, v12, v4
s_waitcnt vmcnt(5)
MAA 64,100,176
TR 26,16,17568
v_add_f32 v13, v13, v5
MAA 80,108,176
TR 28,16,25504
v_add_f32 v14, v14, v6
MAA 80,104,160
TR 30,16,26016
v_add_f32 v15, v15, v7
MAA 80,76,144
ds_write_b128 v2, v[12:15] offset:8960
v_lshrrev_b32 v2, 3, v1
MAA 80,72,128
ds_read_b128 v[12:15], v9
v_cmp_eq_u32 vcc, 3, v2
MAA 32,80,160
ds_read_b128 v[4:7], v9 offset:64
MAA 32,84,176
TR 32,16,33920
MAA 48,92,176
TR 34,16,34432
MAA 48,88,160
TR 36,16,42368
TR 38,16,42880
TR 40,16,33952
TR 42,16,34464
TR 44,16,42400
TR 46,16,42912
TR 48,16,50816
TR 50,16,51328
s_waitcnt lgkmcnt(11)
v_pk_fma_f32 v[32:33], v[12:13], v[20:21], v[32:33] op_sel_hi:[1,0,1]
v_pk_fma_f32 v[34:35], v[14:15], v[20:21], v[34:35] op_sel_hi:[1,0,1]
v_pk_fma_f32 v[36:37], v[12:13], v[22:23], v[36:37] op_sel_hi:[1,0,1]
v_pk_fma_f32 v[38:39], v[14:15], v[22:23], v[38:39] op_sel_hi:[1,0,1]
v_pk_fma_f32 v[40:41], v[12:13], v[24:25], v[40:41] op_sel_hi:[1,0,1]
v_pk_fma_f32 v[42:43], v[14:15], v[24:25], v[42:43] op_sel_hi:[1,0,1]
v_pk_fma_f32 v[44:45], v[12:13], v[26:27], v[44:45] op_sel_hi:[1,0,1]
v_pk_fma_f32 v[46:47], v[14:15], v[26:27], v[46:47] op_sel_hi:[1,0,1]
ds_read_b128 v[12:15], v9 offset:512
s_waitcnt lgkmcnt(11)
v_pk_fma_f32 v[48:49], v[4:5], v[20:21], v[48:49] op_sel_hi:[1,0,1]
v_pk_fma_f32 v[50:51], v[6:7], v[20:21], v[50:51] op_sel_hi:[1,0,1]
v_pk_fma_f32 v[52:53], v[4:5], v[22:23], v[52:53] op_sel_hi:[1,0,1]
v_pk_fma_f32 v[54:55], v[6:7], v[22:23], v[54:55] op_sel_hi:[1,0,1]
v_pk_fma_f32 v[56:57], v[4:5], v[24:25], v[56:57] op_sel_hi:[1,0,1]
v_pk_fma_f32 v[58:59], v[6:7], v[24:25], v[58:59] op_sel_hi:[1,0,1]
v_pk_fma_f32 v[60:61], v[4:5], v[26:27], v[60:61] op_sel_hi:[1,0,1]
v_pk_fma_f32 v[62:63], v[6:7], v[26:27], v[62:63] op_sel_hi:[1,0,1]
ds_read_b128 v[4:7], v9 offset:576
TR 52,16,59264
TR 54,16,59776
TR 56,16,50848
TR 58,16,51360
TR 60,16,59296
TR 62,16,59808
s_waitcnt lgkmcnt(7)
v_pk_fma_f32 v[64:65], v[12:13], v[20:21], v[64:65] op_sel_hi:[1,0,1]
v_pk_fma_f32 v[66:67], v[14:15], v[20:21], v[66:67] op_sel_hi:[1,0,1]
v_pk_fma_f32 v[68:69], v[12:13], v[22:23], v[68:69] op_sel_hi:[1,0,1]
v_pk_fma_f32 v[70:71], v[14:15], v[22:23], v[70:71] op_sel_hi:[1,0,1]
v_pk_fma_f32 v[72:73], v[12:13], v[24:25], v[72:73] op_sel_hi:[1,0,1]
v_pk_fma_f32 v[74:75], v[14:15], v[24:25], v[74:75] op_sel_hi:[1,0,1]
v_pk_fma_f32 v[76:77], v[12:13], v[26:27], v[76:77] op_sel_hi:[1,0,1]
v_pk_fma_f32 v[78:79], v[14:15], v[26:27], v[78:79] op_sel_hi:[1,0,1]
ds_read_b128 v[12:15], v9 offset:832
s_waitcnt lgkmcnt(7)
v_pk_fma_f32 v[80:81], v[4:5], v[20:21], v[80:81] op_sel_hi:[1,0,1]
v_pk_fma_f32 v[82:83], v[6:7], v[20:21], v[82:83] op_sel_hi:[1,0,1]
v_pk_fma_f32 v[84:85], v[4:5], v[22:23], v[84:85] op_sel_hi:[1,0,1]
v_pk_fma_f32 v[86:87], v[6:7], v[22:23], v[86:87] op_sel_hi:[1,0,1]
v_pk_fma_f32 v[88:89], v[4:5], v[24:25], v[88:89] op_sel_hi:[1,0,1]
v_pk_fma_f32 v[90:91], v[6:7], v[24:25], v[90:91] op_sel_hi:[1,0,1]
v_pk_fma_f32 v[92:93], v[4:5], v[26:27], v[92:93] op_sel_hi:[1,0,1]
v_pk_fma_f32 v[94:95], v[6:7], v[26:27], v[94:95] op_sel_hi:[1,0,1]
ds_read_b128 v[4:7], v9 offset:704
v_pk_mul_f32 v[64:65], v[64:65], v[32:33]
v_pk_mul_f32 v[32:33], v[32:33], v[28:29] op_sel_hi:[1,0]
v_pk_mul_f32 v[66:67], v[66:67], v[34:35]
v_pk_mul_f32 v[34:35], v[34:35], v[28:29] op_sel_hi:[1,0]
v_pk_mul_f32 v[80:81], v[80:81], v[48:49]
v_pk_mul_f32 v[48:49], v[48:49], v[28:29] op_sel_hi:[1,0]
v_pk_mul_f32 v[82:83], v[82:83], v[50:51]
v_pk_mul_f32 v[50:51], v[50:51], v[28:29] op_sel_hi:[1,0]
v_exp_f32 v32, v32
s_nop 0
MAA 68,64,132
v_exp_f32 v33, v33
MAA 68,68,148
v_exp_f32 v34, v34
MAA 68,96,164
v_exp_f32 v35, v35
s_waitcnt vmcnt(4)
MAA 68,100,180
v_exp_f32 v48, v48
MAA 84,108,180
v_exp_f32 v49, v49
MAA 84,104,164
v_exp_f32 v50, v50
MAA 84,76,148
v_exp_f32 v51, v51
MAA 84,72,132
MAA 36,80,164
MAA 36,84,180
MAA 52,92,180
MAA 52,88,164
s_nop 5
v_pk_mul_f32 v[68:69], v[68:69], v[36:37]
v_pk_mul_f32 v[36:37], v[36:37], v[28:29] op_sel:[0,1] op_sel_hi:[1,1]
v_pk_mul_f32 v[70:71], v[70:71], v[38:39]
v_pk_mul_f32 v[38:39], v[38:39], v[28:29] op_sel:[0,1] op_sel_hi:[1,1]
v_pk_mul_f32 v[84:85], v[84:85], v[52:53]
v_pk_mul_f32 v[52:53], v[52:53], v[28:29] op_sel:[0,1] op_sel_hi:[1,1]
v_pk_mul_f32 v[86:87], v[86:87], v[54:55]
v_pk_mul_f32 v[54:55], v[54:55], v[28:29] op_sel:[0,1] op_sel_hi:[1,1]
v_pk_fma_f32 v[32:33], v[32:33], v[20:21], v[20:21] op_sel:[0,1,1] op_sel_hi:[1,1,1]
v_pk_fma_f32 v[34:35], v[34:35], v[20:21], v[20:21] op_sel:[0,1,1] op_sel_hi:[1,1,1]
v_pk_fma_f32 v[48:49], v[48:49], v[20:21], v[20:21] op_sel:[0,1,1] op_sel_hi:[1,1,1]
v_pk_fma_f32 v[50:51], v[50:51], v[20:21], v[20:21] op_sel:[0,1,1] op_sel_hi:[1,1,1]
v_rcp_f32 v32, v32
s_nop 0
MAA 72,64,136
v_rcp_f32 v33, v33
MAA 72,68,152
v_rcp_f32 v34, v34
s_waitcnt vmcnt(3)
MAA 72,96,168
v_rcp_f32 v35, v35
s_waitcnt vmcnt(1)
MAA 72,100,184
v_rcp_f32 v48, v48
MAA 88,108,184
v_rcp_f32 v49, v49
MAA 88,104,168
v_rcp_f32 v50, v50
MAA 88,76,152
v_rcp_f32 v51, v51
MAA 88,72,136
v_exp_f32 v36, v36
MAA 40,80,168
v_exp_f32 v37, v37
MAA 40,84,184
v_exp_f32 v38, v38
MAA 56,92,184
v_exp_f32 v39, v39
MAA 56,88,168
v_exp_f32 v52, v52
v_exp_f32 v53, v53
v_exp_f32 v54, v54
v_exp_f32 v55, v55
v_pk_mul_f32 v[64:65], v[64:65], v[32:33]
v_pk_mul_f32 v[66:67], v[66:67], v[34:35]
v_pk_mul_f32 v[80:81], v[80:81], v[48:49]
v_pk_mul_f32 v[82:83], v[82:83], v[50:51]
ds_read_b128 v[48:51], v9 offset:128
v_pk_mul_f32 v[72:73], v[72:73], v[40:41]
v_pk_mul_f32 v[40:41], v[40:41], v[30:31] op_sel_hi:[1,0]
v_pk_mul_f32 v[74:75], v[74:75], v[42:43]
v_pk_mul_f32 v[42:43], v[42:43], v[30:31] op_sel_hi:[1,0]
v_pk_mul_f32 v[88:89], v[88:89], v[56:57]
v_pk_mul_f32 v[56:57], v[56:57], v[30:31] op_sel_hi:[1,0]
v_pk_mul_f32 v[90:91], v[90:91], v[58:59]
v_pk_mul_f32 v[58:59], v[58:59], v[30:31] op_sel_hi:[1,0]
v_pk_fma_f32 v[36:37], v[36:37], v[22:23], v[22:23] op_sel:[0,1,1] op_sel_hi:[1,1,1]
v_pk_fma_f32 v[38:39], v[38:39], v[22:23], v[22:23] op_sel:[0,1,1] op_sel_hi:[1,1,1]
v_pk_fma_f32 v[52:53], v[52:53], v[22:23], v[22:23] op_sel:[0,1,1] op_sel_hi:[1,1,1]
v_pk_fma_f32 v[54:55], v[54:55], v[22:23], v[22:23] op_sel:[0,1,1] op_sel_hi:[1,1,1]
v_cvt_pk_bf16_f32 v32, v64, v65
v_cvt_pk_bf16_f32 v33, v66, v67
ds_read_b128 v[64:67], v9 offset:192
v_cvt_pk_bf16_f32 v34, v80, v81
v_cvt_pk_bf16_f32 v35, v82, v83
MAA 76,64,140
buffer_store_dwordx4 v[32:35], v10, s[16:19], s62 offen sc1
MAA 76,68,156
ds_read_b128 v[80:83], v9 offset:640
v_rcp_f32 v36, v36
MAA 76,96,172
TR 64,17,16896
v_rcp_f32 v37, v37
s_waitcnt vmcnt(1)
MAA 76,100,188
TR 66,17,17408
v_rcp_f32 v38, v38
MAA 92,108,188
TR 68,17,25344
v_rcp_f32 v39, v39
MAA 92,104,172
TR 70,17,25856
v_rcp_f32 v52, v52
MAA 92,76,156
TR 76,17,25376
v_rcp_f32 v53, v53
MAA 92,72,140
TR 72,17,16928
v_rcp_f32 v54, v54
MAA 44,80,172
TR 74,17,17440
v_rcp_f32 v55, v55
MAA 44,84,188
TR 78,17,25888
v_exp_f32 v40, v40
MAA 60,92,188
TR 80,17,33792
v_exp_f32 v41, v41
MAA 60,88,172
TR 82,17,34304
v_exp_f32 v42, v42
v_exp_f32 v43, v43
v_exp_f32 v56, v56
v_exp_f32 v57, v57
v_exp_f32 v58, v58
v_exp_f32 v59, v59
v_pk_mul_f32 v[68:69], v[68:69], v[36:37]
v_pk_mul_f32 v[70:71], v[70:71], v[38:39]
v_pk_mul_f32 v[84:85], v[84:85], v[52:53]
v_pk_mul_f32 v[86:87], v[86:87], v[54:55]
ds_read_b128 v[52:55], v8 offset:576
v_pk_mul_f32 v[76:77], v[76:77], v[44:45]
v_pk_mul_f32 v[44:45], v[44:45], v[30:31] op_sel:[0,1] op_sel_hi:[1,1]
v_pk_mul_f32 v[78:79], v[78:79], v[46:47]
v_pk_mul_f32 v[46:47], v[46:47], v[30:31] op_sel:[0,1] op_sel_hi:[1,1]
v_pk_mul_f32 v[92:93], v[92:93], v[60:61]
v_pk_mul_f32 v[60:61], v[60:61], v[30:31] op_sel:[0,1] op_sel_hi:[1,1]
v_pk_mul_f32 v[94:95], v[94:95], v[62:63]
v_pk_mul_f32 v[62:63], v[62:63], v[30:31] op_sel:[0,1] op_sel_hi:[1,1]
v_pk_fma_f32 v[40:41], v[40:41], v[24:25], v[24:25] op_sel:[0,1,1] op_sel_hi:[1,1,1]
v_pk_fma_f32 v[42:43], v[42:43], v[24:25], v[24:25] op_sel:[0,1,1] op_sel_hi:[1,1,1]
v_pk_fma_f32 v[56:57], v[56:57], v[24:25], v[24:25] op_sel:[0,1,1] op_sel_hi:[1,1,1]
v_pk_fma_f32 v[58:59], v[58:59], v[24:25], v[24:25] op_sel:[0,1,1] op_sel_hi:[1,1,1]
v_cvt_pk_bf16_f32 v36, v68, v69
v_cvt_pk_bf16_f32 v37, v70, v71
v_cvt_pk_bf16_f32 v38, v84, v85
v_cvt_pk_bf16_f32 v39, v86, v87
MAA 128,192,128
buffer_store_dwordx4 v[36:39], v10, s[16:19], s62 offen offset:1024 sc1
MAA 128,196,144
TR 84,17,42240
v_rcp_f32 v40, v40
MAA 128,0,160
TR 86,17,42752
v_rcp_f32 v41, v41
MAA 128,4,176
TR 88,17,33824
v_rcp_f32 v42, v42
MAA 144,12,176
TR 90,17,34336
v_rcp_f32 v43, v43
MAA 144,8,160
TR 92,17,42272
v_rcp_f32 v56, v56
MAA 144,204,144
TR 94,17,42784
v_rcp_f32 v57, v57
MAA 144,200,128
TR 96,17,50688
v_rcp_f32 v58, v58
MAA 96,112,160
TR 98,17,51200
v_rcp_f32 v59, v59
MAA 96,116,176
TR 100,17,59136
v_exp_f32 v44, v44
MAA 112,124,176
TR 102,17,59648
v_exp_f32 v45, v45
MAA 112,120,160
TR 104,17,50720
v_lshrrev_b32 v69, 2, v0
v_min_u32 v69, 1, v69
v_lshlrev_b32 v69, 28, v69
v_lshl_add_u32 v68, v0, 7, v69
v_xor_b32 v69, 64, v0
v_min_u32 v69, 1, v69
v_lshlrev_b32 v70, 4, v69
v_sub_u32 v70, 16, v70
v_lshlrev_b32 v69, 28, v69
v_mov_b32 v71, 1
v_mov_b32 v84, 0
v_mov_b32 v85, 0
v_mov_b32 v86, 0
v_exp_f32 v46, v46
v_exp_f32 v47, v47
v_exp_f32 v60, v60
v_exp_f32 v61, v61
v_exp_f32 v62, v62
v_exp_f32 v63, v63
v_pk_mul_f32 v[72:73], v[72:73], v[40:41]
v_pk_mul_f32 v[74:75], v[74:75], v[42:43]
v_pk_mul_f32 v[88:89], v[88:89], v[56:57]
v_pk_mul_f32 v[90:91], v[90:91], v[58:59]
s_waitcnt lgkmcnt(15)
v_pk_fma_f32 v[96:97], v[48:49], v[20:21], v[96:97] op_sel_hi:[1,0,1]
v_pk_fma_f32 v[98:99], v[50:51], v[20:21], v[98:99] op_sel_hi:[1,0,1]
v_pk_fma_f32 v[112:113], v[64:65], v[20:21], v[112:113] op_sel_hi:[1,0,1]
v_pk_fma_f32 v[114:115], v[66:67], v[20:21], v[114:115] op_sel_hi:[1,0,1]
v_pk_fma_f32 v[128:129], v[80:81], v[20:21], v[128:129] op_sel_hi:[1,0,1]
v_pk_fma_f32 v[130:131], v[82:83], v[20:21], v[130:131] op_sel_hi:[1,0,1]
v_pk_fma_f32 v[144:145], v[4:5], v[20:21], v[144:145] op_sel_hi:[1,0,1]
v_pk_fma_f32 v[146:147], v[6:7], v[20:21], v[146:147] op_sel_hi:[1,0,1]
v_pk_mul_f32 v[128:129], v[128:129], v[96:97]
v_pk_mul_f32 v[96:97], v[96:97], v[28:29] op_sel_hi:[1,0]
v_pk_mul_f32 v[130:131], v[130:131], v[98:99]
v_pk_mul_f32 v[98:99], v[98:99], v[28:29] op_sel_hi:[1,0]
v_pk_mul_f32 v[144:145], v[144:145], v[112:113]
v_pk_mul_f32 v[112:113], v[112:113], v[28:29] op_sel_hi:[1,0]
v_pk_mul_f32 v[146:147], v[146:147], v[114:115]
v_pk_mul_f32 v[114:115], v[114:115], v[28:29] op_sel_hi:[1,0]
v_pk_fma_f32 v[44:45], v[44:45], v[26:27], v[26:27] op_sel:[0,1,1] op_sel_hi:[1,1,1]
v_pk_fma_f32 v[46:47], v[46:47], v[26:27], v[26:27] op_sel:[0,1,1] op_sel_hi:[1,1,1]
v_pk_fma_f32 v[60:61], v[60:61], v[26:27], v[26:27] op_sel:[0,1,1] op_sel_hi:[1,1,1]
v_pk_fma_f32 v[62:63], v[62:63], v[26:27], v[26:27] op_sel:[0,1,1] op_sel_hi:[1,1,1]
v_cvt_pk_bf16_f32 v40, v72, v73
v_cvt_pk_bf16_f32 v41, v74, v75
v_cvt_pk_bf16_f32 v42, v88, v89
v_cvt_pk_bf16_f32 v43, v90, v91
MAA 132,192,132
buffer_store_dwordx4 v[40:43], v11, s[16:19], s62 offen sc1
MAA 132,196,148
TR 106,17,51232
v_rcp_f32 v44, v44
MAA 132,0,164
TR 108,17,59168
v_rcp_f32 v45, v45
MAA 132,4,180
TR 110,17,59680
v_rcp_f32 v46, v46
MAA 148,12,180
v_rcp_f32 v47, v47
MAA 148,8,164
v_rcp_f32 v60, v60
MAA 148,204,148
v_rcp_f32 v61, v61
MAA 148,200,132
v_rcp_f32 v62, v62
MAA 100,112,164
v_rcp_f32 v63, v63
MAA 100,116,180
v_exp_f32 v96, v96
MAA 116,124,180
v_exp_f32 v97, v97
MAA 116,120,164
s_waitcnt lgkmcnt(0)
s_barrier
s_add_u32 m0, s59, 84480
v_exp_f32 v98, v98
v_exp_f32 v99, v99
v_exp_f32 v112, v112
v_exp_f32 v113, v113
v_exp_f32 v114, v114
v_exp_f32 v115, v115
v_pk_mul_f32 v[76:77], v[76:77], v[44:45]
v_pk_mul_f32 v[78:79], v[78:79], v[46:47]
v_pk_mul_f32 v[92:93], v[92:93], v[60:61]
v_pk_mul_f32 v[94:95], v[94:95], v[62:63]
v_pk_fma_f32 v[100:101], v[48:49], v[22:23], v[100:101] op_sel_hi:[1,0,1]
v_pk_fma_f32 v[102:103], v[50:51], v[22:23], v[102:103] op_sel_hi:[1,0,1]
v_pk_fma_f32 v[116:117], v[64:65], v[22:23], v[116:117] op_sel_hi:[1,0,1]
v_pk_fma_f32 v[118:119], v[66:67], v[22:23], v[118:119] op_sel_hi:[1,0,1]
v_pk_fma_f32 v[132:133], v[80:81], v[22:23], v[132:133] op_sel_hi:[1,0,1]
v_pk_fma_f32 v[134:135], v[82:83], v[22:23], v[134:135] op_sel_hi:[1,0,1]
v_pk_fma_f32 v[148:149], v[4:5], v[22:23], v[148:149] op_sel_hi:[1,0,1]
v_pk_fma_f32 v[150:151], v[6:7], v[22:23], v[150:151] op_sel_hi:[1,0,1]
v_pk_mul_f32 v[132:133], v[132:133], v[100:101]
v_pk_mul_f32 v[100:101], v[100:101], v[28:29] op_sel:[0,1] op_sel_hi:[1,1]
v_pk_mul_f32 v[134:135], v[134:135], v[102:103]
v_pk_mul_f32 v[102:103], v[102:103], v[28:29] op_sel:[0,1] op_sel_hi:[1,1]
v_pk_mul_f32 v[148:149], v[148:149], v[116:117]
v_pk_mul_f32 v[116:117], v[116:117], v[28:29] op_sel:[0,1] op_sel_hi:[1,1]
v_pk_mul_f32 v[150:151], v[150:151], v[118:119]
v_pk_mul_f32 v[118:119], v[118:119], v[28:29] op_sel:[0,1] op_sel_hi:[1,1]
v_pk_fma_f32 v[96:97], v[96:97], v[20:21], v[20:21] op_sel:[0,1,1] op_sel_hi:[1,1,1]
v_pk_fma_f32 v[98:99], v[98:99], v[20:21], v[20:21] op_sel:[0,1,1] op_sel_hi:[1,1,1]
v_pk_fma_f32 v[112:113], v[112:113], v[20:21], v[20:21] op_sel:[0,1,1] op_sel_hi:[1,1,1]
v_pk_fma_f32 v[114:115], v[114:115], v[20:21], v[20:21] op_sel:[0,1,1] op_sel_hi:[1,1,1]
v_cvt_pk_bf16_f32 v44, v76, v77
v_cvt_pk_bf16_f32 v45, v78, v79
v_cvt_pk_bf16_f32 v46, v92, v93
v_cvt_pk_bf16_f32 v47, v94, v95
MAA 136,192,136
buffer_store_dwordx4 v[44:47], v11, s[16:19], s62 offen offset:1024 sc1
MAA 136,196,152
v_rcp_f32 v96, v96
MAA 136,0,168
v_rcp_f32 v97, v97
MAA 136,4,184
v_rcp_f32 v98, v98
MAA 152,12,184
buffer_load_dwordx4 v18, s[28:31], s58 offen lds
MAA 152,8,168
v_rcp_f32 v99, v99
MAA 152,204,152
v_rcp_f32 v112, v112
MAA 152,200,136
v_rcp_f32 v113, v113
MAA 104,112,168
buffer_load_dwordx4 v19, s[28:31], s58 offen offset:1056 lds
MAA 104,116,184
s_add_u32 m0, s59, 92928
s_add_u32 s58, s99, 2555904
v_rcp_f32 v114, v114
MAA 120,124,184
v_rcp_f32 v115, v115
MAA 120,120,168
v_exp_f32 v100, v100
v_exp_f32 v101, v101
v_exp_f32 v102, v102
v_exp_f32 v103, v103
v_exp_f32 v116, v116
v_exp_f32 v117, v117
v_exp_f32 v118, v118
v_exp_f32 v119, v119
v_pk_mul_f32 v[128:129], v[128:129], v[96:97]
v_pk_mul_f32 v[130:131], v[130:131], v[98:99]
v_pk_mul_f32 v[144:145], v[144:145], v[112:113]
v_pk_mul_f32 v[146:147], v[146:147], v[114:115]
ds_read_b128 v[112:115], v9 offset:256
v_pk_fma_f32 v[104:105], v[48:49], v[24:25], v[104:105] op_sel_hi:[1,0,1]
v_pk_fma_f32 v[106:107], v[50:51], v[24:25], v[106:107] op_sel_hi:[1,0,1]
v_pk_fma_f32 v[120:121], v[64:65], v[24:25], v[120:121] op_sel_hi:[1,0,1]
v_pk_fma_f32 v[122:123], v[66:67], v[24:25], v[122:123] op_sel_hi:[1,0,1]
v_pk_fma_f32 v[136:137], v[80:81], v[24:25], v[136:137] op_sel_hi:[1,0,1]
v_pk_fma_f32 v[138:139], v[82:83], v[24:25], v[138:139] op_sel_hi:[1,0,1]
v_pk_fma_f32 v[152:153], v[4:5], v[24:25], v[152:153] op_sel_hi:[1,0,1]
v_pk_fma_f32 v[154:155], v[6:7], v[24:25], v[154:155] op_sel_hi:[1,0,1]
v_pk_mul_f32 v[136:137], v[136:137], v[104:105]
v_pk_mul_f32 v[104:105], v[104:105], v[30:31] op_sel_hi:[1,0]
v_pk_mul_f32 v[138:139], v[138:139], v[106:107]
v_pk_mul_f32 v[106:107], v[106:107], v[30:31] op_sel_hi:[1,0]
v_pk_mul_f32 v[152:153], v[152:153], v[120:121]
v_pk_mul_f32 v[120:121], v[120:121], v[30:31] op_sel_hi:[1,0]
v_pk_mul_f32 v[154:155], v[154:155], v[122:123]
v_pk_mul_f32 v[122:123], v[122:123], v[30:31] op_sel_hi:[1,0]
v_pk_fma_f32 v[100:101], v[100:101], v[22:23], v[22:23] op_sel:[0,1,1] op_sel_hi:[1,1,1]
v_pk_fma_f32 v[102:103], v[102:103], v[22:23], v[22:23] op_sel:[0,1,1] op_sel_hi:[1,1,1]
v_pk_fma_f32 v[116:117], v[116:117], v[22:23], v[22:23] op_sel:[0,1,1] op_sel_hi:[1,1,1]
v_pk_fma_f32 v[118:119], v[118:119], v[22:23], v[22:23] op_sel:[0,1,1] op_sel_hi:[1,1,1]
v_cvt_pk_bf16_f32 v96, v128, v129
v_cvt_pk_bf16_f32 v97, v130, v131
ds_read_b128 v[128:131], v9 offset:320
v_cvt_pk_bf16_f32 v98, v144, v145
v_cvt_pk_bf16_f32 v99, v146, v147
MAA 140,192,140
buffer_store_dwordx4 v[96:99], v10, s[16:19], s63 offen sc1
MAA 140,196,156
ds_read_b128 v[144:147], v9 offset:768
v_rcp_f32 v100, v100
MAA 140,0,172
v_rcp_f32 v101, v101
MAA 140,4,188
v_rcp_f32 v102, v102
MAA 156,12,188
buffer_load_dwordx4 v18, s[28:31], s58 offen lds
MAA 156,8,172
v_rcp_f32 v103, v103
MAA 156,204,156
v_rcp_f32 v116, v116
MAA 156,200,140
v_rcp_f32 v117, v117
MAA 108,112,172
buffer_load_dwordx4 v19, s[28:31], s58 offen offset:1056 lds
MAA 108,116,188
s_add_u32 m0, s59, 101376
s_add_u32 s58, s100, 2752512
v_rcp_f32 v118, v118
MAA 124,124,188
v_rcp_f32 v119, v119
MAA 124,120,172
v_exp_f32 v104, v104
v_exp_f32 v105, v105
v_exp_f32 v106, v106
v_exp_f32 v107, v107
v_exp_f32 v120, v120
v_exp_f32 v121, v121
v_exp_f32 v122, v122
v_exp_f32 v123, v123
v_pk_mul_f32 v[132:133], v[132:133], v[100:101]
v_pk_mul_f32 v[134:135], v[134:135], v[102:103]
v_pk_mul_f32 v[148:149], v[148:149], v[116:117]
v_pk_mul_f32 v[150:151], v[150:151], v[118:119]
v_pk_fma_f32 v[108:109], v[48:49], v[26:27], v[108:109] op_sel_hi:[1,0,1]
v_pk_fma_f32 v[110:111], v[50:51], v[26:27], v[110:111] op_sel_hi:[1,0,1]
v_pk_fma_f32 v[124:125], v[64:65], v[26:27], v[124:125] op_sel_hi:[1,0,1]
v_pk_fma_f32 v[126:127], v[66:67], v[26:27], v[126:127] op_sel_hi:[1,0,1]
v_pk_fma_f32 v[140:141], v[80:81], v[26:27], v[140:141] op_sel_hi:[1,0,1]
v_pk_fma_f32 v[142:143], v[82:83], v[26:27], v[142:143] op_sel_hi:[1,0,1]
v_pk_fma_f32 v[156:157], v[4:5], v[26:27], v[156:157] op_sel_hi:[1,0,1]
v_pk_fma_f32 v[158:159], v[6:7], v[26:27], v[158:159] op_sel_hi:[1,0,1]
v_pk_mul_f32 v[140:141], v[140:141], v[108:109]
v_pk_mul_f32 v[108:109], v[108:109], v[30:31] op_sel:[0,1] op_sel_hi:[1,1]
v_pk_mul_f32 v[142:143], v[142:143], v[110:111]
v_pk_mul_f32 v[110:111], v[110:111], v[30:31] op_sel:[0,1] op_sel_hi:[1,1]
v_pk_mul_f32 v[156:157], v[156:157], v[124:125]
s_waitcnt vmcnt(5)
s_barrier
buffer_atomic_add v71, v68, s[16:19], s72 offen offset:512
v_pk_mul_f32 v[124:125], v[124:125], v[30:31] op_sel:[0,1] op_sel_hi:[1,1]
v_pk_mul_f32 v[158:159], v[158:159], v[126:127]
v_pk_mul_f32 v[126:127], v[126:127], v[30:31] op_sel:[0,1] op_sel_hi:[1,1]
v_pk_fma_f32 v[104:105], v[104:105], v[24:25], v[24:25] op_sel:[0,1,1] op_sel_hi:[1,1,1]
v_pk_fma_f32 v[106:107], v[106:107], v[24:25], v[24:25] op_sel:[0,1,1] op_sel_hi:[1,1,1]
v_pk_fma_f32 v[120:121], v[120:121], v[24:25], v[24:25] op_sel:[0,1,1] op_sel_hi:[1,1,1]
v_pk_fma_f32 v[122:123], v[122:123], v[24:25], v[24:25] op_sel:[0,1,1] op_sel_hi:[1,1,1]
v_cvt_pk_bf16_f32 v100, v132, v133
v_cvt_pk_bf16_f32 v101, v134, v135
v_cvt_pk_bf16_f32 v102, v148, v149
v_cvt_pk_bf16_f32 v103, v150, v151
MAA 192,16,128
v_rcp_f32 v104, v104
MAA 192,20,144
buffer_store_dwordx4 v[100:103], v10, s[16:19], s63 offen offset:1024 sc1
MAA 192,48,160
v_rcp_f32 v105, v105
MAA 192,52,176
v_rcp_f32 v106, v106
MAA 208,60,176
v_rcp_f32 v107, v107
MAA 208,56,160
buffer_load_dwordx4 v18, s[28:31], s58 offen lds
MAA 208,28,144
v_rcp_f32 v120, v120
MAA 208,24,128
v_rcp_f32 v121, v121
MAA 160,32,160
v_rcp_f32 v122, v122
MAA 160,36,176
.Lpad6:
s_cbranch_execz .Lpad9
buffer_load_dwordx4 v19, s[28:31], s58 offen offset:1056 lds
MAA 176,44,176
s_add_u32 m0, s59, 109824
s_add_u32 s58, s100, 3014656
v_rcp_f32 v123, v123
MAA 176,40,160
v_exp_f32 v108, v108
v_exp_f32 v109, v109
v_exp_f32 v110, v110
v_exp_f32 v111, v111
v_exp_f32 v124, v124
v_exp_f32 v125, v125
v_exp_f32 v126, v126
v_exp_f32 v127, v127
v_pk_mul_f32 v[136:137], v[136:137], v[104:105]
v_pk_mul_f32 v[138:139], v[138:139], v[106:107]
v_pk_mul_f32 v[152:153], v[152:153], v[120:121]
v_pk_mul_f32 v[154:155], v[154:155], v[122:123]
s_waitcnt lgkmcnt(2)
v_pk_fma_f32 v[160:161], v[112:113], v[20:21], v[160:161] op_sel_hi:[1,0,1]
v_pk_fma_f32 v[162:163], v[114:115], v[20:21], v[162:163] op_sel_hi:[1,0,1]
s_waitcnt lgkmcnt(1)
v_pk_fma_f32 v[176:177], v[128:129], v[20:21], v[176:177] op_sel_hi:[1,0,1]
v_pk_fma_f32 v[178:179], v[130:131], v[20:21], v[178:179] op_sel_hi:[1,0,1]
s_waitcnt lgkmcnt(0)
v_pk_fma_f32 v[192:193], v[144:145], v[20:21], v[192:193] op_sel_hi:[1,0,1]
v_pk_fma_f32 v[194:195], v[146:147], v[20:21], v[194:195] op_sel_hi:[1,0,1]
v_pk_fma_f32 v[208:209], v[12:13], v[20:21], v[208:209] op_sel_hi:[1,0,1]
v_pk_fma_f32 v[210:211], v[14:15], v[20:21], v[210:211] op_sel_hi:[1,0,1]
v_pk_mul_f32 v[192:193], v[192:193], v[160:161]
v_pk_mul_f32 v[160:161], v[160:161], v[28:29] op_sel_hi:[1,0]
v_pk_mul_f32 v[194:195], v[194:195], v[162:163]
v_pk_mul_f32 v[162:163], v[162:163], v[28:29] op_sel_hi:[1,0]
v_pk_mul_f32 v[208:209], v[208:209], v[176:177]
v_pk_mul_f32 v[176:177], v[176:177], v[28:29] op_sel_hi:[1,0]
v_pk_mul_f32 v[210:211], v[210:211], v[178:179]
v_pk_mul_f32 v[178:179], v[178:179], v[28:29] op_sel_hi:[1,0]
v_pk_fma_f32 v[108:109], v[108:109], v[26:27], v[26:27] op_sel:[0,1,1] op_sel_hi:[1,1,1]
v_pk_fma_f32 v[110:111], v[110:111], v[26:27], v[26:27] op_sel:[0,1,1] op_sel_hi:[1,1,1]
v_pk_fma_f32 v[124:125], v[124:125], v[26:27], v[26:27] op_sel:[0,1,1] op_sel_hi:[1,1,1]
v_pk_fma_f32 v[126:127], v[126:127], v[26:27], v[26:27] op_sel:[0,1,1] op_sel_hi:[1,1,1]
v_cvt_pk_bf16_f32 v104, v136, v137
v_cvt_pk_bf16_f32 v105, v138, v139
v_cvt_pk_bf16_f32 v106, v152, v153
v_cvt_pk_bf16_f32 v107, v154, v155
MAA 196,16,132
buffer_store_dwordx4 v[104:107], v11, s[16:19], s63 offen sc1
MAA 196,20,148
v_rcp_f32 v108, v108
MAA 196,48,164
v_rcp_f32 v109, v109
MAA 196,52,180
v_rcp_f32 v110, v110
MAA 212,60,180
buffer_load_dwordx4 v18, s[28:31], s58 offen lds
MAA 212,56,164
v_rcp_f32 v111, v111
MAA 212,28,148
v_rcp_f32 v124, v124
MAA 212,24,132
v_rcp_f32 v125, v125
MAA 164,32,164
buffer_load_dwordx4 v19, s[28:31], s58 offen offset:1056 lds
MAA 164,36,180
s_add_u32 m0, s59, 118272
s_add_u32 s58, s101, 3211264
v_rcp_f32 v126, v126
MAA 180,44,180
v_rcp_f32 v127, v127
MAA 180,40,164
v_lshl_add_u32 v4, v1, 4, s74
v_add_u32 v2, 67108480, v4
v_cndmask_b32 v4, v4, v2, vcc
s_and_b32 s74, s7, 1
v_bfe_u32 v7, v1, 2, 3
v_mul_u32_u24 v7, 1056, v7
v_bfe_u32 v2, v1, 5, 1
v_lshl_add_u32 v7, v2, 8, v7
v_and_b32 v2, 3, v1
v_lshl_add_u32 v7, v2, 3, v7
s_lshl_b32 s74, s74, 7
s_xor_b32 s75, s74, 128
v_add_u32 v6, s75, v7
v_add_u32 v7, s74, v7
v_exp_f32 v160, v160
v_exp_f32 v161, v161
v_exp_f32 v162, v162
v_exp_f32 v163, v163
v_exp_f32 v176, v176
v_exp_f32 v177, v177
v_exp_f32 v178, v178
v_exp_f32 v179, v179
v_pk_mul_f32 v[140:141], v[140:141], v[108:109]
v_pk_mul_f32 v[142:143], v[142:143], v[110:111]
v_pk_mul_f32 v[156:157], v[156:157], v[124:125]
v_pk_mul_f32 v[158:159], v[158:159], v[126:127]
v_pk_fma_f32 v[164:165], v[112:113], v[22:23], v[164:165] op_sel_hi:[1,0,1]
v_pk_fma_f32 v[166:167], v[114:115], v[22:23], v[166:167] op_sel_hi:[1,0,1]
v_pk_fma_f32 v[180:181], v[128:129], v[22:23], v[180:181] op_sel_hi:[1,0,1]
v_pk_fma_f32 v[182:183], v[130:131], v[22:23], v[182:183] op_sel_hi:[1,0,1]
v_pk_fma_f32 v[196:197], v[144:145], v[22:23], v[196:197] op_sel_hi:[1,0,1]
v_pk_fma_f32 v[198:199], v[146:147], v[22:23], v[198:199] op_sel_hi:[1,0,1]
v_pk_fma_f32 v[212:213], v[12:13], v[22:23], v[212:213] op_sel_hi:[1,0,1]
v_pk_fma_f32 v[214:215], v[14:15], v[22:23], v[214:215] op_sel_hi:[1,0,1]
v_pk_mul_f32 v[196:197], v[196:197], v[164:165]
v_pk_mul_f32 v[164:165], v[164:165], v[28:29] op_sel:[0,1] op_sel_hi:[1,1]
v_pk_mul_f32 v[198:199], v[198:199], v[166:167]
v_pk_mul_f32 v[166:167], v[166:167], v[28:29] op_sel:[0,1] op_sel_hi:[1,1]
v_pk_mul_f32 v[212:213], v[212:213], v[180:181]
v_pk_mul_f32 v[180:181], v[180:181], v[28:29] op_sel:[0,1] op_sel_hi:[1,1]
v_pk_mul_f32 v[214:215], v[214:215], v[182:183]
v_pk_mul_f32 v[182:183], v[182:183], v[28:29] op_sel:[0,1] op_sel_hi:[1,1]
v_pk_fma_f32 v[160:161], v[160:161], v[20:21], v[20:21] op_sel:[0,1,1] op_sel_hi:[1,1,1]
v_pk_fma_f32 v[162:163], v[162:163], v[20:21], v[20:21] op_sel:[0,1,1] op_sel_hi:[1,1,1]
v_pk_fma_f32 v[176:177], v[176:177], v[20:21], v[20:21] op_sel:[0,1,1] op_sel_hi:[1,1,1]
v_pk_fma_f32 v[178:179], v[178:179], v[20:21], v[20:21] op_sel:[0,1,1] op_sel_hi:[1,1,1]
v_cvt_pk_bf16_f32 v108, v140, v141
v_cvt_pk_bf16_f32 v109, v142, v143
v_cvt_pk_bf16_f32 v110, v156, v157
v_cvt_pk_bf16_f32 v111, v158, v159
MAA 200,16,136
buffer_store_dwordx4 v[108:111], v11, s[16:19], s63 offen offset:1024 sc1
MAA 200,20,152
v_rcp_f32 v160, v160
MAA 200,48,168
v_rcp_f32 v161, v161
MAA 200,52,184
v_rcp_f32 v162, v162
MAA 216,60,184
buffer_load_dwordx4 v18, s[28:31], s58 offen lds
MAA 216,56,168
v_rcp_f32 v163, v163
MAA 216,28,152
v_rcp_f32 v176, v176
MAA 216,24,136
v_rcp_f32 v177, v177
MAA 168,32,168
buffer_load_dwordx4 v19, s[28:31], s58 offen offset:1056 lds
MAA 168,36,184
s_add_u32 m0, s59, 126720
s_add_u32 s58, s101, 3473408
v_rcp_f32 v178, v178
MAA 184,44,184
v_rcp_f32 v179, v179
MAA 184,40,168
v_exp_f32 v164, v164
v_exp_f32 v165, v165
v_exp_f32 v166, v166
v_exp_f32 v167, v167
v_exp_f32 v180, v180
v_exp_f32 v181, v181
v_exp_f32 v182, v182
v_exp_f32 v183, v183
v_pk_mul_f32 v[192:193], v[192:193], v[160:161]
v_pk_mul_f32 v[194:195], v[194:195], v[162:163]
v_pk_mul_f32 v[208:209], v[208:209], v[176:177]
v_pk_mul_f32 v[210:211], v[210:211], v[178:179]
ds_read_b128 v[176:179], v8
v_pk_fma_f32 v[168:169], v[112:113], v[24:25], v[168:169] op_sel_hi:[1,0,1]
v_pk_fma_f32 v[170:171], v[114:115], v[24:25], v[170:171] op_sel_hi:[1,0,1]
v_pk_fma_f32 v[184:185], v[128:129], v[24:25], v[184:185] op_sel_hi:[1,0,1]
v_pk_fma_f32 v[186:187], v[130:131], v[24:25], v[186:187] op_sel_hi:[1,0,1]
v_pk_fma_f32 v[200:201], v[144:145], v[24:25], v[200:201] op_sel_hi:[1,0,1]
v_pk_fma_f32 v[202:203], v[146:147], v[24:25], v[202:203] op_sel_hi:[1,0,1]
v_pk_fma_f32 v[216:217], v[12:13], v[24:25], v[216:217] op_sel_hi:[1,0,1]
v_pk_fma_f32 v[218:219], v[14:15], v[24:25], v[218:219] op_sel_hi:[1,0,1]
v_pk_mul_f32 v[200:201], v[200:201], v[168:169]
v_pk_mul_f32 v[168:169], v[168:169], v[30:31] op_sel_hi:[1,0]
v_pk_mul_f32 v[202:203], v[202:203], v[170:171]
v_pk_mul_f32 v[170:171], v[170:171], v[30:31] op_sel_hi:[1,0]
v_pk_mul_f32 v[216:217], v[216:217], v[184:185]
v_pk_mul_f32 v[184:185], v[184:185], v[30:31] op_sel_hi:[1,0]
v_pk_mul_f32 v[218:219], v[218:219], v[186:187]
v_pk_mul_f32 v[186:187], v[186:187], v[30:31] op_sel_hi:[1,0]
v_pk_fma_f32 v[164:165], v[164:165], v[22:23], v[22:23] op_sel:[0,1,1] op_sel_hi:[1,1,1]
v_pk_fma_f32 v[166:167], v[166:167], v[22:23], v[22:23] op_sel:[0,1,1] op_sel_hi:[1,1,1]
v_pk_fma_f32 v[180:181], v[180:181], v[22:23], v[22:23] op_sel:[0,1,1] op_sel_hi:[1,1,1]
v_pk_fma_f32 v[182:183], v[182:183], v[22:23], v[22:23] op_sel:[0,1,1] op_sel_hi:[1,1,1]
v_cvt_pk_bf16_f32 v160, v192, v193
v_cvt_pk_bf16_f32 v161, v194, v195
ds_read_b128 v[192:195], v8 offset:64
v_cvt_pk_bf16_f32 v162, v208, v209
v_cvt_pk_bf16_f32 v163, v210, v211
MAA 204,16,140
buffer_store_dwordx4 v[160:163], v10, s[16:19], s64 offen sc1
MAA 204,20,156
ds_read_b128 v[208:211], v8 offset:512
v_rcp_f32 v164, v164
MAA 204,48,172
v_rcp_f32 v165, v165
MAA 204,52,188
v_rcp_f32 v166, v166
MAA 220,60,188
buffer_atomic_add v84, v69, s[16:19], s73 offen offset:512 sc0
MAA 220,56,172
v_rcp_f32 v167, v167
MAA 220,28,156
v_rcp_f32 v180, v180
MAA 220,24,140
v_rcp_f32 v181, v181
MAA 172,32,172
buffer_load_dwordx4 v18, s[28:31], s58 offen lds
MAA 172,36,188
v_rcp_f32 v182, v182
MAA 188,44,188
v_rcp_f32 v183, v183
MAA 188,40,172
v_exp_f32 v168, v168
v_exp_f32 v169, v169
v_exp_f32 v170, v170
v_exp_f32 v171, v171
v_exp_f32 v184, v184
v_exp_f32 v185, v185
v_exp_f32 v186, v186
v_exp_f32 v187, v187
v_pk_mul_f32 v[196:197], v[196:197], v[164:165]
v_pk_mul_f32 v[198:199], v[198:199], v[166:167]
v_pk_mul_f32 v[212:213], v[212:213], v[180:181]
v_pk_mul_f32 v[214:215], v[214:215], v[182:183]
v_pk_fma_f32 v[172:173], v[112:113], v[26:27], v[172:173] op_sel_hi:[1,0,1]
v_pk_fma_f32 v[174:175], v[114:115], v[26:27], v[174:175] op_sel_hi:[1,0,1]
v_pk_fma_f32 v[188:189], v[128:129], v[26:27], v[188:189] op_sel_hi:[1,0,1]
v_pk_fma_f32 v[190:191], v[130:131], v[26:27], v[190:191] op_sel_hi:[1,0,1]
v_pk_fma_f32 v[204:205], v[144:145], v[26:27], v[204:205] op_sel_hi:[1,0,1]
v_pk_fma_f32 v[206:207], v[146:147], v[26:27], v[206:207] op_sel_hi:[1,0,1]
v_pk_fma_f32 v[220:221], v[12:13], v[26:27], v[220:221] op_sel_hi:[1,0,1]
v_pk_fma_f32 v[222:223], v[14:15], v[26:27], v[222:223] op_sel_hi:[1,0,1]
v_pk_mul_f32 v[204:205], v[204:205], v[172:173]
v_pk_mul_f32 v[172:173], v[172:173], v[30:31] op_sel:[0,1] op_sel_hi:[1,1]
v_pk_mul_f32 v[206:207], v[206:207], v[174:175]
v_pk_mul_f32 v[174:175], v[174:175], v[30:31] op_sel:[0,1] op_sel_hi:[1,1]
v_pk_mul_f32 v[220:221], v[220:221], v[188:189]
v_pk_mul_f32 v[188:189], v[188:189], v[30:31] op_sel:[0,1] op_sel_hi:[1,1]
v_pk_mul_f32 v[222:223], v[222:223], v[190:191]
v_pk_mul_f32 v[190:191], v[190:191], v[30:31] op_sel:[0,1] op_sel_hi:[1,1]
v_pk_fma_f32 v[168:169], v[168:169], v[24:25], v[24:25] op_sel:[0,1,1] op_sel_hi:[1,1,1]
v_pk_fma_f32 v[170:171], v[170:171], v[24:25], v[24:25] op_sel:[0,1,1] op_sel_hi:[1,1,1]
v_pk_fma_f32 v[184:185], v[184:185], v[24:25], v[24:25] op_sel:[0,1,1] op_sel_hi:[1,1,1]
v_pk_fma_f32 v[186:187], v[186:187], v[24:25], v[24:25] op_sel:[0,1,1] op_sel_hi:[1,1,1]
v_cvt_pk_bf16_f32 v164, v196, v197
v_cvt_pk_bf16_f32 v165, v198, v199
v_cvt_pk_bf16_f32 v166, v212, v213
v_cvt_pk_bf16_f32 v167, v214, v215
MAA 240,64,128
buffer_store_dwordx4 v[164:167], v10, s[16:19], s64 offen offset:1024 sc1
MAA 240,68,144
v_rcp_f32 v168, v168
MAA 240,96,160
v_rcp_f32 v169, v169
MAA 240,100,176
v_rcp_f32 v170, v170
MAA 248,108,176
buffer_atomic_add v85, v69, s[16:19], s73 offen offset:512 sc0
MAA 248,104,160
v_rcp_f32 v171, v171
MAA 248,76,144
v_rcp_f32 v184, v184
MAA 248,72,128
v_rcp_f32 v185, v185
MAA 224,80,160
buffer_load_dwordx4 v19, s[28:31], s58 offen offset:1056 lds
MAA 224,84,176
v_rcp_f32 v186, v186
MAA 232,92,176
v_rcp_f32 v187, v187
MAA 232,88,160
v_exp_f32 v172, v172
v_exp_f32 v173, v173
v_exp_f32 v174, v174
v_exp_f32 v175, v175
v_exp_f32 v188, v188
v_exp_f32 v189, v189
v_exp_f32 v190, v190
v_exp_f32 v191, v191
v_pk_mul_f32 v[200:201], v[200:201], v[168:169]
v_pk_mul_f32 v[202:203], v[202:203], v[170:171]
v_pk_mul_f32 v[216:217], v[216:217], v[184:185]
v_pk_mul_f32 v[218:219], v[218:219], v[186:187]
s_waitcnt lgkmcnt(2)
v_pk_fma_f32 v[224:225], v[176:177], v[20:21], v[224:225] op_sel_hi:[1,0,1]
v_pk_fma_f32 v[226:227], v[178:179], v[20:21], v[226:227] op_sel_hi:[1,0,1]
s_waitcnt lgkmcnt(1)
v_pk_fma_f32 v[232:233], v[192:193], v[20:21], v[232:233] op_sel_hi:[1,0,1]
v_pk_fma_f32 v[234:235], v[194:195], v[20:21], v[234:235] op_sel_hi:[1,0,1]
s_waitcnt lgkmcnt(0)
v_pk_fma_f32 v[240:241], v[208:209], v[20:21], v[240:241] op_sel_hi:[1,0,1]
v_pk_fma_f32 v[242:243], v[210:211], v[20:21], v[242:243] op_sel_hi:[1,0,1]
v_pk_fma_f32 v[248:249], v[52:53], v[20:21], v[248:249] op_sel_hi:[1,0,1]
v_pk_fma_f32 v[250:251], v[54:55], v[20:21], v[250:251] op_sel_hi:[1,0,1]
v_pk_mul_f32 v[240:241], v[240:241], v[224:225]
v_pk_mul_f32 v[224:225], v[224:225], v[28:29] op_sel_hi:[1,0]
v_pk_mul_f32 v[242:243], v[242:243], v[226:227]
v_pk_mul_f32 v[226:227], v[226:227], v[28:29] op_sel_hi:[1,0]
v_pk_mul_f32 v[248:249], v[248:249], v[232:233]
v_pk_mul_f32 v[232:233], v[232:233], v[28:29] op_sel_hi:[1,0]
v_pk_mul_f32 v[250:251], v[250:251], v[234:235]
v_pk_mul_f32 v[234:235], v[234:235], v[28:29] op_sel_hi:[1,0]
v_pk_fma_f32 v[172:173], v[172:173], v[26:27], v[26:27] op_sel:[0,1,1] op_sel_hi:[1,1,1]
v_pk_fma_f32 v[174:175], v[174:175], v[26:27], v[26:27] op_sel:[0,1,1] op_sel_hi:[1,1,1]
v_pk_fma_f32 v[188:189], v[188:189], v[26:27], v[26:27] op_sel:[0,1,1] op_sel_hi:[1,1,1]
v_pk_fma_f32 v[190:191], v[190:191], v[26:27], v[26:27] op_sel:[0,1,1] op_sel_hi:[1,1,1]
v_cvt_pk_bf16_f32 v168, v200, v201
v_cvt_pk_bf16_f32 v169, v202, v203
v_cvt_pk_bf16_f32 v170, v216, v217
v_cvt_pk_bf16_f32 v171, v218, v219
buffer_store_dwordx4 v[168:171], v11, s[16:19], s64 offen sc1
buffer_atomic_add v86, v69, s[16:19], s73 offen offset:512 sc0
s_waitcnt vmcnt(6)
v_cmp_gt_u32 vcc, v70, v84
s_nop 0
s_cbranch_vccz .Lok48
s_waitcnt vmcnt(3)
v_cmp_gt_u32 vcc, v70, v85
s_nop 0
s_cbranch_vccz .Lok48
s_waitcnt vmcnt(0)
v_cmp_gt_u32 vcc, v70, v86
s_nop 0
s_cbranch_vccz .Lok48
s_mov_b32 s15, 0
.Lok48l:
v_mov_b32 v84, 0
buffer_atomic_add v84, v69, s[16:19], s73 offen offset:512 sc0
s_add_u32 s15, s15, 1
s_cmp_gt_u32 s15, 100000
s_waitcnt vmcnt(0)
s_cbranch_scc1 .Lok48
v_cmp_gt_u32 vcc, v70, v84
s_nop 0
s_cbranch_vccnz .Lok48l
.Lok48:
s_waitcnt vmcnt(2)
s_barrier
MAA 244,64,132
ds_read_b64_tr_b16 a[0:1], v7
s_add_u32 s52, s76, 0
MAA 244,68,148
buffer_load_dwordx4 v[96:99], v4, s[16:19], s52 offen sc1
MAA 244,96,164
TR 2,7,512
v_rcp_f32 v172, v172
MAA 244,100,180
TR 4,7,32
v_rcp_f32 v173, v173
MAA 252,108,180
TR 6,7,544
v_rcp_f32 v174, v174
MAA 252,104,164
buffer_load_dwordx4 v[100:103], v4, s[16:19], s52 offen offset:1024 sc1
MAA 252,76,148
TR 8,7,64
s_add_u32 s52, s76, 65536
MAA 252,72,132
TR 10,7,576
v_rcp_f32 v175, v175
MAA 228,80,164
TR 12,7,96
v_rcp_f32 v188, v188
MAA 228,84,180
buffer_load_dwordx4 v[104:107], v4, s[16:19], s52 offen sc1
MAA 236,92,180
TR 14,7,608
v_rcp_f32 v189, v189
MAA 236,88,164
TR 16,7,8448
v_rcp_f32 v190, v190
v_rcp_f32 v191, v191
v_exp_f32 v224, v224
v_exp_f32 v225, v225
v_exp_f32 v226, v226
v_exp_f32 v227, v227
v_exp_f32 v232, v232
v_exp_f32 v233, v233
v_exp_f32 v234, v234
v_exp_f32 v235, v235
v_pk_mul_f32 v[204:205], v[204:205], v[172:173]
buffer_load_dwordx4 v[108:111], v4, s[16:19], s52 offen offset:1024 sc1
s_add_u32 s52, s77, 114688
v_pk_mul_f32 v[206:207], v[206:207], v[174:175]
v_pk_mul_f32 v[220:221], v[220:221], v[188:189]
v_pk_mul_f32 v[222:223], v[222:223], v[190:191]
v_pk_fma_f32 v[228:229], v[176:177], v[22:23], v[228:229] op_sel_hi:[1,0,1]
v_pk_fma_f32 v[230:231], v[178:179], v[22:23], v[230:231] op_sel_hi:[1,0,1]
v_pk_fma_f32 v[236:237], v[192:193], v[22:23], v[236:237] op_sel_hi:[1,0,1]
v_pk_fma_f32 v[238:239], v[194:195], v[22:23], v[238:239] op_sel_hi:[1,0,1]
v_pk_fma_f32 v[244:245], v[208:209], v[22:23], v[244:245] op_sel_hi:[1,0,1]
v_pk_fma_f32 v[246:247], v[210:211], v[22:23], v[246:247] op_sel_hi:[1,0,1]
v_pk_fma_f32 v[252:253], v[52:53], v[22:23], v[252:253] op_sel_hi:[1,0,1]
v_pk_fma_f32 v[254:255], v[54:55], v[22:23], v[254:255] op_sel_hi:[1,0,1]
v_pk_mul_f32 v[244:245], v[244:245], v[228:229]
buffer_load_dwordx4 v[112:115], v4, s[16:19], s52 offen sc1
v_pk_mul_f32 v[228:229], v[228:229], v[28:29] op_sel:[0,1] op_sel_hi:[1,1]
v_pk_mul_f32 v[246:247], v[246:247], v[230:231]
v_pk_mul_f32 v[230:231], v[230:231], v[28:29] op_sel:[0,1] op_sel_hi:[1,1]
v_pk_mul_f32 v[252:253], v[252:253], v[236:237]
v_pk_mul_f32 v[236:237], v[236:237], v[28:29] op_sel:[0,1] op_sel_hi:[1,1]
v_pk_mul_f32 v[254:255], v[254:255], v[238:239]
v_pk_mul_f32 v[238:239], v[238:239], v[28:29] op_sel:[0,1] op_sel_hi:[1,1]
v_pk_fma_f32 v[224:225], v[224:225], v[20:21], v[20:21] op_sel:[0,1,1] op_sel_hi:[1,1,1]
v_pk_fma_f32 v[226:227], v[226:227], v[20:21], v[20:21] op_sel:[0,1,1] op_sel_hi:[1,1,1]
v_pk_fma_f32 v[232:233], v[232:233], v[20:21], v[20:21] op_sel:[0,1,1] op_sel_hi:[1,1,1]
v_pk_fma_f32 v[234:235], v[234:235], v[20:21], v[20:21] op_sel:[0,1,1] op_sel_hi:[1,1,1]
v_cvt_pk_bf16_f32 v172, v204, v205
v_cvt_pk_bf16_f32 v173, v206, v207
buffer_load_dwordx4 v[116:119], v4, s[16:19], s52 offen offset:1024 sc1
s_add_u32 s52, s77, 180224
v_cvt_pk_bf16_f32 v174, v220, v221
v_cvt_pk_bf16_f32 v175, v222, v223
TR 18,7,8960
TR 20,7,8480
TR 22,7,8992
TR 24,7,8512
TR 26,7,9024
buffer_store_dwordx4 v[172:175], v11, s[16:19], s64 offen offset:1024 sc1
TR 28,7,8544
TR 30,7,9056
v_rcp_f32 v224, v224
v_rcp_f32 v225, v225
v_rcp_f32 v226, v226
v_rcp_f32 v227, v227
v_rcp_f32 v232, v232
v_rcp_f32 v233, v233
v_rcp_f32 v234, v234
v_rcp_f32 v235, v235
v_exp_f32 v228, v228
v_exp_f32 v229, v229
v_exp_f32 v230, v230
v_exp_f32 v231, v231
v_exp_f32 v236, v236
v_exp_f32 v237, v237
v_exp_f32 v238, v238
v_exp_f32 v239, v239
v_pk_mul_f32 v[240:241], v[240:241], v[224:225]
buffer_load_dwordx4 v[120:123], v4, s[16:19], s52 offen sc1
v_pk_mul_f32 v[242:243], v[242:243], v[226:227]
v_pk_mul_f32 v[248:249], v[248:249], v[232:233]
v_pk_mul_f32 v[250:251], v[250:251], v[234:235]
v_pk_fma_f32 v[228:229], v[228:229], v[22:23], v[22:23] op_sel:[0,1,1] op_sel_hi:[1,1,1]
v_pk_fma_f32 v[230:231], v[230:231], v[22:23], v[22:23] op_sel:[0,1,1] op_sel_hi:[1,1,1]
v_pk_fma_f32 v[236:237], v[236:237], v[22:23], v[22:23] op_sel:[0,1,1] op_sel_hi:[1,1,1]
v_pk_fma_f32 v[238:239], v[238:239], v[22:23], v[22:23] op_sel:[0,1,1] op_sel_hi:[1,1,1]
v_cvt_pk_bf16_f32 v224, v240, v241
v_cvt_pk_bf16_f32 v225, v242, v243
v_cvt_pk_bf16_f32 v226, v248, v249
v_cvt_pk_bf16_f32 v227, v250, v251
v_rcp_f32 v228, v228
v_rcp_f32 v229, v229
v_rcp_f32 v230, v230
v_rcp_f32 v231, v231
v_rcp_f32 v236, v236
v_rcp_f32 v237, v237
v_rcp_f32 v238, v238
v_rcp_f32 v239, v239
v_pk_mul_f32 v[244:245], v[244:245], v[228:229]
buffer_store_dwordx4 v[224:227], v10, s[16:19], s65 offen sc1
v_pk_mul_f32 v[246:247], v[246:247], v[230:231]
v_pk_mul_f32 v[252:253], v[252:253], v[236:237]
v_pk_mul_f32 v[254:255], v[254:255], v[238:239]
v_cvt_pk_bf16_f32 v228, v244, v245
v_cvt_pk_bf16_f32 v229, v246, v247
v_cvt_pk_bf16_f32 v230, v252, v253
v_cvt_pk_bf16_f32 v231, v254, v255
buffer_store_dwordx4 v[228:231], v10, s[16:19], s65 offen offset:1024 sc1
buffer_load_dwordx4 v[124:127], v4, s[16:19], s52 offen offset:1024 sc1
v_mov_b32 v21, v68
v_mov_b32 v22, v69
v_mov_b32 v23, v70
v_mov_b32 v24, v71
v_mov_b32 v25, 0
s_waitcnt vmcnt(7) lgkmcnt(0)
s_barrier
v_mfma_f32_16x16x32_bf16 v[32:35], a[0:3], v[96:99], 0
ds_read_b64_tr_b16 a[32:33], v6
s_add_u32 s52, s78, 229376
MAV 32,16,104
buffer_load_dwordx4 v[128:131], v4, s[16:19], s52 offen sc1
v_mfma_f32_16x16x32_bf16 v[48:51], a[0:3], v[100:103], 0
TR 34,6,512
TR 36,6,32
MAV 48,16,108
TR 38,6,544
v_mfma_f32_16x16x32_bf16 v[52:55], a[4:7], v[100:103], 0
buffer_load_dwordx4 v[132:135], v4, s[16:19], s52 offen offset:1024 sc1
MAV 52,20,108
TR 48,6,8448
TR 50,6,8960
v_mfma_f32_16x16x32_bf16 v[36:39], a[4:7], v[96:99], 0
TR 52,6,8480
MAV 36,20,104
TR 54,6,8992
s_add_u32 s52, s78, 294912
v_mfma_f32_16x16x32_bf16 v[40:43], a[8:11], v[96:99], 0
buffer_load_dwordx4 v[136:139], v4, s[16:19], s52 offen sc1
MAV 40,24,104
TR 40,6,64
v_mfma_f32_16x16x32_bf16 v[56:59], a[8:11], v[100:103], 0
TR 42,6,576
TR 44,6,96
MAV 56,24,108
TR 46,6,608
v_mfma_f32_16x16x32_bf16 v[60:63], a[12:15], v[100:103], 0
buffer_load_dwordx4 v[140:143], v4, s[16:19], s52 offen offset:1024 sc1
MAV 60,28,108
TR 56,6,8512
TR 58,6,9024
v_mfma_f32_16x16x32_bf16 v[44:47], a[12:15], v[96:99], 0
TR 60,6,8544
MAV 44,28,104
TR 62,6,9056
s_waitcnt lgkmcnt(8)
v_mfma_f32_16x16x32_bf16 v[64:67], a[32:35], v[96:99], 0
TR 0,7,16896
s_add_u32 s52, s79, 344064
MAV 64,48,104
buffer_load_dwordx4 v[144:147], v4, s[16:19], s52 offen sc1
v_mfma_f32_16x16x32_bf16 v[80:83], a[32:35], v[100:103], 0
TR 2,7,17408
TR 4,7,16928
MAV 80,48,108
TR 6,7,17440
v_mfma_f32_16x16x32_bf16 v[84:87], a[36:39], v[100:103], 0
buffer_load_dwordx4 v[148:151], v4, s[16:19], s52 offen offset:1024 sc1
MAV 84,52,108
TR 16,7,25344
TR 18,7,25856
v_mfma_f32_16x16x32_bf16 v[68:71], a[36:39], v[96:99], 0
TR 20,7,25376
MAV 68,52,104
TR 22,7,25888
s_add_u32 s52, s79, 409600
s_waitcnt lgkmcnt(8)
v_mfma_f32_16x16x32_bf16 v[72:75], a[40:43], v[96:99], 0
buffer_load_dwordx4 v[152:155], v4, s[16:19], s52 offen sc1
MAV 72,56,104
TR 8,7,16960
v_mfma_f32_16x16x32_bf16 v[88:91], a[40:43], v[100:103], 0
TR 10,7,17472
TR 12,7,16992
MAV 88,56,108
TR 14,7,17504
v_mfma_f32_16x16x32_bf16 v[92:95], a[44:47], v[100:103], 0
buffer_load_dwordx4 v[156:159], v4, s[16:19], s52 offen offset:1024 sc1
MAV 92,60,108
TR 24,7,25408
TR 26,7,25920
v_mfma_f32_16x16x32_bf16 v[76:79], a[44:47], v[96:99], 0
TR 28,7,25440
MAV 76,60,104
TR 30,7,25952
s_waitcnt vmcnt(8) lgkmcnt(8)
s_barrier
MAV 32,0,112
TR 32,6,16896
TR 34,6,17408
MAV 32,16,120
buffer_atomic_add v24, v21, s[16:19], s72 offen
MAV 48,16,124
TR 36,6,16928
TR 38,6,17440
MAV 48,0,116
TR 48,6,25344
s_add_u32 m0, s55, 0
MAV 52,4,116
buffer_load_dwordx4 v18, s[28:31], s54 offen lds
MAV 52,20,124
TR 50,6,25856
MAV 36,20,120
TR 52,6,25376
TR 54,6,25888
MAV 36,4,112
TR 40,6,16960
s_add_u32 s52, s76, 458752
s_waitcnt lgkmcnt(9)
MAV 40,8,112
buffer_load_dwordx4 v[96:99], v4, s[16:19], s52 offen sc1
MAV 40,24,120
TR 42,6,17472
TR 44,6,16992
MAV 56,24,124
buffer_load_dwordx4 v19, s[28:31], s54 offen offset:1056 lds
MAV 56,8,116
s_add_u32 s54, s98, 327680
MAV 60,12,116
TR 46,6,17504
TR 56,6,25408
MAV 60,28,124
buffer_load_dwordx4 v[100:103], v4, s[16:19], s52 offen offset:1024 sc1
MAV 44,28,120
TR 58,6,25920
TR 60,6,25440
MAV 44,12,112
TR 62,6,25952
s_waitcnt lgkmcnt(8)
MAV 64,32,112
TR 0,7,33792
.Lpad7:
s_cbranch_execz .Lpad10
s_add_u32 m0, s55, 8448
MAV 64,48,120
buffer_load_dwordx4 v18, s[28:31], s54 offen lds
MAV 80,48,124
TR 2,7,34304
TR 4,7,33824
MAV 80,32,116
TR 6,7,34336
s_add_u32 s52, s76, 524288
MAV 84,36,116
buffer_load_dwordx4 v[104:107], v4, s[16:19], s52 offen sc1
MAV 84,52,124
TR 16,7,42240
MAV 68,52,120
TR 18,7,42752
TR 20,7,42272
MAV 68,36,112
TR 22,7,42784
s_waitcnt lgkmcnt(8)
MAV 72,40,112
buffer_load_dwordx4 v19, s[28:31], s54 offen offset:1056 lds
MAV 72,56,120
s_add_u32 s54, s99, 524288
MAV 88,56,124
TR 8,7,33856
TR 10,7,34368
MAV 88,40,116
TR 12,7,33888
TR 14,7,34400
MAV 92,44,116
buffer_load_dwordx4 v[108:111], v4, s[16:19], s52 offen offset:1024 sc1
MAV 92,60,124
TR 24,7,42304
MAV 76,60,120
TR 26,7,42816
TR 28,7,42336
MAV 76,44,112
TR 30,7,42848
s_waitcnt vmcnt(13) lgkmcnt(8)
s_barrier
MAV 32,0,128
TR 32,6,33792
s_add_u32 m0, s55, 16896
MAV 32,16,136
buffer_load_dwordx4 v18, s[28:31], s54 offen lds
MAV 48,16,140
TR 34,6,34304
TR 36,6,33824
MAV 48,0,132
TR 38,6,34336
s_add_u32 s52, s77, 573440
MAV 52,4,132
buffer_load_dwordx4 v[112:115], v4, s[16:19], s52 offen sc1
MAV 52,20,140
TR 48,6,42240
MAV 36,20,136
TR 50,6,42752
TR 52,6,42272
MAV 36,4,128
TR 54,6,42784
s_waitcnt lgkmcnt(8)
MAV 40,8,128
buffer_load_dwordx4 v19, s[28:31], s54 offen offset:1056 lds
MAV 40,24,136
s_add_u32 s54, s99, 786432
MAV 56,24,140
TR 40,6,33856
TR 42,6,34368
MAV 56,8,132
TR 44,6,33888
TR 46,6,34400
MAV 60,12,132
buffer_load_dwordx4 v[116:119], v4, s[16:19], s52 offen offset:1024 sc1
MAV 60,28,140
TR 56,6,42304
MAV 44,28,136
TR 58,6,42816
TR 60,6,42336
MAV 44,12,128
TR 62,6,42848
s_waitcnt lgkmcnt(8)
MAV 64,32,128
TR 0,7,50688
s_add_u32 m0, s55, 25344
MAV 64,48,136
buffer_load_dwordx4 v18, s[28:31], s54 offen lds
MAV 80,48,140
TR 2,7,51200
TR 4,7,50720
MAV 80,32,132
TR 6,7,51232
s_add_u32 s52, s77, 638976
MAV 84,36,132
buffer_load_dwordx4 v[120:123], v4, s[16:19], s52 offen sc1
MAV 84,52,140
TR 16,7,59136
TR 18,7,59648
MAV 68,52,136
TR 20,7,59168
TR 22,7,59680
MAV 68,36,128
s_waitcnt lgkmcnt(8)
MAV 72,40,128
buffer_load_dwordx4 v19, s[28:31], s54 offen offset:1056 lds
MAV 72,56,136
TR 8,7,50752
s_add_u32 s54, s100, 983040
MAV 88,56,140
buffer_load_dwordx4 v[124:127], v4, s[16:19], s52 offen offset:1024 sc1
MAV 88,40,132
TR 10,7,51264
TR 12,7,50784
MAV 92,44,132
TR 14,7,51296
TR 24,7,59200
MAV 92,60,140
buffer_atomic_add v25, v22, s[16:19], s73 offen sc0
MAV 76,60,136
TR 26,7,59712
TR 28,7,59232
MAV 76,44,128
TR 30,7,59744
s_waitcnt vmcnt(18) lgkmcnt(8)
s_barrier
MAV 32,0,144
TR 32,6,50688
s_add_u32 m0, s55, 33792
MAV 32,16,152
buffer_load_dwordx4 v18, s[28:31], s54 offen lds
MAV 48,16,156
TR 34,6,51200
TR 36,6,50720
MAV 48,0,148
TR 38,6,51232
s_add_u32 s52, s78, 688128
MAV 52,4,148
buffer_load_dwordx4 v[128:131], v4, s[16:19], s52 offen sc1
MAV 52,20,156
TR 48,6,59136
MAV 36,20,152
TR 50,6,59648
TR 52,6,59168
MAV 36,4,144
TR 54,6,59680
s_waitcnt lgkmcnt(8)
MAV 40,8,144
buffer_load_dwordx4 v19, s[28:31], s54 offen offset:1056 lds
MAV 40,24,152
s_add_u32 s54, s100, 1245184
MAV 56,24,156
TR 40,6,50752
TR 42,6,51264
MAV 56,8,148
TR 44,6,50784
TR 46,6,51296
MAV 60,12,148
buffer_load_dwordx4 v[132:135], v4, s[16:19], s52 offen offset:1024 sc1
MAV 60,28,156
TR 56,6,59200
MAV 44,28,152
TR 58,6,59712
TR 60,6,59232
MAV 44,12,144
TR 62,6,59744
v_add_u32 v7, s57, v7
v_add_u32 v6, s57, v6
s_sub_u32 s57, 0, s57
s_waitcnt lgkmcnt(8)
MAV 64,32,144
ds_read_b64_tr_b16 a[0:1], v7
s_add_u32 m0, s55, 42240
MAV 64,48,152
buffer_load_dwordx4 v18, s[28:31], s54 offen lds
MAV 80,48,156
TR 2,7,512
TR 4,7,32
MAV 80,32,148
TR 6,7,544
s_add_u32 s52, s78, 753664
MAV 84,36,148
buffer_load_dwordx4 v[136:139], v4, s[16:19], s52 offen sc1
MAV 84,52,156
TR 16,7,8448
MAV 68,52,152
TR 18,7,8960
TR 20,7,8480
MAV 68,36,144
TR 22,7,8992
s_waitcnt lgkmcnt(8)
MAV 72,40,144
buffer_load_dwordx4 v19, s[28:31], s54 offen offset:1056 lds
MAV 72,56,152
s_add_u32 s54, s101, 1441792
MAV 88,56,156
TR 8,7,64
TR 10,7,576
MAV 88,40,148
TR 12,7,96
TR 14,7,608
MAV 92,44,148
buffer_load_dwordx4 v[140:143], v4, s[16:19], s52 offen offset:1024 sc1
MAV 92,60,156
TR 24,7,8512
MAV 76,60,152
TR 26,7,9024
TR 28,7,8544
MAV 76,44,144
TR 30,7,9056
s_waitcnt vmcnt(17) lgkmcnt(8)
s_barrier
MAV 32,0,96
ds_read_b64_tr_b16 a[32:33], v6
s_add_u32 m0, s55, 50688
MAV 32,16,104
buffer_load_dwordx4 v18, s[28:31], s54 offen lds
MAV 48,16,108
TR 34,6,512
TR 36,6,32
MAV 48,0,100
TR 38,6,544
s_add_u32 s52, s79, 802816
MAV 52,4,100
buffer_load_dwordx4 v[144:147], v4, s[16:19], s52 offen sc1
MAV 52,20,108
TR 48,6,8448
MAV 36,20,104
TR 50,6,8960
TR 52,6,8480
MAV 36,4,96
TR 54,6,8992
s_waitcnt lgkmcnt(8)
MAV 40,8,96
buffer_load_dwordx4 v19, s[28:31], s54 offen offset:1056 lds
MAV 40,24,104
s_add_u32 s54, s101, 1703936
MAV 56,24,108
TR 40,6,64
TR 42,6,576
MAV 56,8,100
TR 44,6,96
TR 46,6,608
MAV 60,12,100
buffer_load_dwordx4 v[148:151], v4, s[16:19], s52 offen offset:1024 sc1
MAV 60,28,108
TR 56,6,8512
MAV 44,28,104
TR 58,6,9024
TR 60,6,8544
MAV 44,12,96
TR 62,6,9056
s_waitcnt lgkmcnt(8)
MAV 64,32,96
TR 0,7,16896
s_add_u32 m0, s55, 59136
MAV 64,48,104
buffer_load_dwordx4 v18, s[28:31], s54 offen lds
MAV 80,48,108
TR 2,7,17408
TR 4,7,16928
MAV 80,32,100
TR 6,7,17440
s_add_u32 s52, s79, 868352
MAV 84,36,100
buffer_load_dwordx4 v[152:155], v4, s[16:19], s52 offen sc1
MAV 84,52,108
TR 16,7,25344
MAV 68,52,104
TR 18,7,25856
TR 20,7,25376
MAV 68,36,96
TR 22,7,25888
s_waitcnt lgkmcnt(8)
MAV 72,40,96
buffer_load_dwordx4 v19, s[28:31], s54 offen offset:1056 lds
MAV 72,56,104
s_add_u32 s54, s98, 1900544
MAV 88,56,108
TR 8,7,16960
TR 10,7,17472
MAV 88,40,100
TR 12,7,16992
TR 14,7,17504
MAV 92,44,100
buffer_load_dwordx4 v[156:159], v4, s[16:19], s52 offen offset:1024 sc1
MAV 92,60,108
TR 24,7,25408
MAV 76,60,104
TR 26,7,25920
TR 28,7,25440
MAV 76,44,96
TR 30,7,25952
s_waitcnt vmcnt(16)
v_cmp_gt_u32 vcc, v23, v25
s_nop 0
s_cbranch_vccnz .Lsp49
.Lsp49b:
s_waitcnt lgkmcnt(8)
s_barrier
MAV 32,0,112
TR 32,6,16896
s_add_u32 m0, s55, 67584
MAV 32,16,120
buffer_load_dwordx4 v18, s[28:31], s54 offen lds
MAV 48,16,124
TR 34,6,17408
TR 36,6,16928
MAV 48,0,116
TR 38,6,17440
s_add_u32 s52, s76, 16384
MAV 52,4,116
buffer_load_dwordx4 v[96:99], v4, s[16:19], s52 offen sc1
MAV 52,20,124
TR 48,6,25344
MAV 36,20,120
TR 50,6,25856
TR 52,6,25376
MAV 36,4,112
TR 54,6,25888
s_waitcnt lgkmcnt(8)
MAV 40,8,112
buffer_load_dwordx4 v19, s[28:31], s54 offen offset:1056 lds
MAV 40,24,120
s_add_u32 s54, s98, 2162688
MAV 56,24,124
TR 40,6,16960
TR 42,6,17472
MAV 56,8,116
TR 44,6,16992
TR 46,6,17504
MAV 60,12,116
buffer_load_dwordx4 v[100:103], v4, s[16:19], s52 offen offset:1024 sc1
MAV 60,28,124
TR 56,6,25408
MAV 44,28,120
TR 58,6,25920
TR 60,6,25440
MAV 44,12,112
TR 62,6,25952
s_waitcnt lgkmcnt(8)
MAV 64,32,112
TR 0,7,33792
s_add_u32 m0, s55, 76032
MAV 64,48,120
buffer_load_dwordx4 v18, s[28:31], s54 offen lds
MAV 80,48,124
TR 2,7,34304
TR 4,7,33824
MAV 80,32,116
TR 6,7,34336
s_add_u32 s52, s76, 81920
MAV 84,36,116
buffer_load_dwordx4 v[104:107], v4, s[16:19], s52 offen sc1
MAV 84,52,124
TR 16,7,42240
MAV 68,52,120
TR 18,7,42752
TR 20,7,42272
MAV 68,36,112
TR 22,7,42784
s_waitcnt lgkmcnt(8)
MAV 72,40,112
buffer_load_dwordx4 v19, s[28:31], s54 offen offset:1056 lds
MAV 72,56,120
s_add_u32 s54, s99, 2359296
MAV 88,56,124
TR 8,7,33856
TR 10,7,34368
MAV 88,40,116
TR 12,7,33888
TR 14,7,34400
MAV 92,44,116
buffer_load_dwordx4 v[108:111], v4, s[16:19], s52 offen offset:1024 sc1
MAV 92,60,124
TR 24,7,42304
MAV 76,60,120
TR 26,7,42816
TR 28,7,42336
MAV 76,44,112
TR 30,7,42848
s_waitcnt vmcnt(16) lgkmcnt(8)
s_barrier
MAV 32,0,128
TR 32,6,33792
s_add_u32 m0, s55, 84480
MAV 32,16,136
buffer_load_dwordx4 v18, s[28:31], s54 offen lds
MAV 48,16,140
TR 34,6,34304
TR 36,6,33824
MAV 48,0,132
TR 38,6,34336
s_add_u32 s52, s77, 131072
MAV 52,4,132
buffer_load_dwordx4 v[112:115], v4, s[16:19], s52 offen sc1
MAV 52,20,140
TR 48,6,42240
MAV 36,20,136
TR 50,6,42752
TR 52,6,42272
MAV 36,4,128
TR 54,6,42784
s_waitcnt lgkmcnt(8)
MAV 40,8,128
buffer_load_dwordx4 v19, s[28:31], s54 offen offset:1056 lds
MAV 40,24,136
s_add_u32 s54, s99, 2621440
MAV 56,24,140
TR 40,6,33856
TR 42,6,34368
MAV 56,8,132
TR 44,6,33888
TR 46,6,34400
MAV 60,12,132
buffer_load_dwordx4 v[116:119], v4, s[16:19], s52 offen offset:1024 sc1
MAV 60,28,140
TR 56,6,42304
MAV 44,28,136
TR 58,6,42816
TR 60,6,42336
MAV 44,12,128
TR 62,6,42848
s_waitcnt lgkmcnt(8)
MAV 64,32,128
TR 0,7,50688
s_add_u32 m0, s55, 92928
MAV 64,48,136
buffer_load_dwordx4 v18, s[28:31], s54 offen lds
MAV 80,48,140
TR 2,7,51200
TR 4,7,50720
MAV 80,32,132
TR 6,7,51232
s_add_u32 s52, s77, 196608
MAV 84,36,132
buffer_load_dwordx4 v[120:123], v4, s[16:19], s52 offen sc1
MAV 84,52,140
TR 16,7,59136
MAV 68,52,136
TR 18,7,59648
TR 20,7,59168
MAV 68,36,128
TR 22,7,59680
s_waitcnt lgkmcnt(8)
MAV 72,40,128
buffer_load_dwordx4 v19, s[28:31], s54 offen offset:1056 lds
MAV 72,56,136
s_add_u32 s54, s100, 2818048
MAV 88,56,140
TR 8,7,50752
TR 10,7,51264
MAV 88,40,132
TR 12,7,50784
TR 14,7,51296
MAV 92,44,132
buffer_load_dwordx4 v[124:127], v4, s[16:19], s52 offen offset:1024 sc1
MAV 92,60,140
TR 24,7,59200
MAV 76,60,136
TR 26,7,59712
TR 28,7,59232
MAV 76,44,128
TR 30,7,59744
s_waitcnt vmcnt(16) lgkmcnt(8)
s_barrier
MAV 32,0,144
TR 32,6,50688
s_add_u32 m0, s55, 101376
MAV 32,16,152
buffer_load_dwordx4 v18, s[28:31], s54 offen lds
MAV 48,16,156
TR 34,6,51200
TR 36,6,50720
MAV 48,0,148
TR 38,6,51232
s_add_u32 s52, s78, 245760
MAV 52,4,148
buffer_load_dwordx4 v[128:131], v4, s[16:19], s52 offen sc1
MAV 52,20,156
TR 48,6,59136
MAV 36,20,152
TR 50,6,59648
TR 52,6,59168
MAV 36,4,144
TR 54,6,59680
s_waitcnt lgkmcnt(8)
MAV 40,8,144
buffer_load_dwordx4 v19, s[28:31], s54 offen offset:1056 lds
MAV 40,24,152
s_add_u32 s54, s100, 3080192
MAV 56,24,156
TR 40,6,50752
TR 42,6,51264
MAV 56,8,148
TR 44,6,50784
TR 46,6,51296
MAV 60,12,148
buffer_load_dwordx4 v[132:135], v4, s[16:19], s52 offen offset:1024 sc1
MAV 60,28,156
TR 56,6,59200
MAV 44,28,152
TR 58,6,59712
TR 60,6,59232
MAV 44,12,144
TR 62,6,59744
v_add_u32 v7, s57, v7
v_add_u32 v6, s57, v6
s_sub_u32 s57, 0, s57
s_waitcnt lgkmcnt(8)
MAV 64,32,144
ds_read_b64_tr_b16 a[0:1], v7
s_add_u32 m0, s55, 109824
MAV 64,48,152
buffer_load_dwordx4 v18, s[28:31], s54 offen lds
MAV 80,48,156
TR 2,7,512
TR 4,7,32
MAV 80,32,148
TR 6,7,544
s_add_u32 s52, s78, 311296
MAV 84,36,148
buffer_load_dwordx4 v[136:139], v4, s[16:19], s52 offen sc1
MAV 84,52,156
TR 16,7,8448
MAV 68,52,152
TR 18,7,8960
TR 20,7,8480
MAV 68,36,144
TR 22,7,8992
s_waitcnt lgkmcnt(8)
MAV 72,40,144
buffer_load_dwordx4 v19, s[28:31], s54 offen offset:1056 lds
MAV 72,56,152
s_add_u32 s54, s101, 3276800
.Lpad8:
s_cbranch_execz .Lpad11
MAV 88,56,156
TR 8,7,64
TR 10,7,576
MAV 88,40,148
TR 12,7,96
TR 14,7,608
MAV 92,44,148
buffer_load_dwordx4 v[140:143], v4, s[16:19], s52 offen offset:1024 sc1
MAV 92,60,156
TR 24,7,8512
MAV 76,60,152
TR 26,7,9024
TR 28,7,8544
MAV 76,44,144
TR 30,7,9056
s_waitcnt vmcnt(16) lgkmcnt(8)
s_barrier
MAV 32,0,96
ds_read_b64_tr_b16 a[32:33], v6
s_add_u32 m0, s55, 118272
MAV 32,16,104
buffer_load_dwordx4 v18, s[28:31], s54 offen lds
MAV 48,16,108
TR 34,6,512
TR 36,6,32
MAV 48,0,100
TR 38,6,544
s_add_u32 s52, s79, 360448
MAV 52,4,100
buffer_load_dwordx4 v[144:147], v4, s[16:19], s52 offen sc1
MAV 52,20,108
TR 48,6,8448
MAV 36,20,104
TR 50,6,8960
TR 52,6,8480
MAV 36,4,96
TR 54,6,8992
s_waitcnt lgkmcnt(8)
MAV 40,8,96
buffer_load_dwordx4 v19, s[28:31], s54 offen offset:1056 lds
MAV 40,24,104
s_add_u32 s54, s101, 3538944
MAV 56,24,108
TR 40,6,64
TR 42,6,576
MAV 56,8,100
TR 44,6,96
TR 46,6,608
MAV 60,12,100
buffer_load_dwordx4 v[148:151], v4, s[16:19], s52 offen offset:1024 sc1
MAV 60,28,108
TR 56,6,8512
MAV 44,28,104
TR 58,6,9024
TR 60,6,8544
MAV 44,12,96
TR 62,6,9056
s_waitcnt lgkmcnt(8)
MAV 64,32,96
TR 0,7,16896
s_add_u32 m0, s55, 126720
MAV 64,48,104
buffer_load_dwordx4 v18, s[28:31], s54 offen lds
MAV 80,48,108
TR 2,7,17408
TR 4,7,16928
MAV 80,32,100
TR 6,7,17440
s_add_u32 s52, s79, 425984
MAV 84,36,100
buffer_load_dwordx4 v[152:155], v4, s[16:19], s52 offen sc1
MAV 84,52,108
TR 16,7,25344
MAV 68,52,104
TR 18,7,25856
TR 20,7,25376
MAV 68,36,96
TR 22,7,25888
s_waitcnt lgkmcnt(8)
MAV 72,40,96
buffer_load_dwordx4 v19, s[28:31], s54 offen offset:1056 lds
MAV 72,56,104
s_add_u32 s54, s98, 131072
MAV 88,56,108
TR 8,7,16960
TR 10,7,17472
MAV 88,40,100
TR 12,7,16992
TR 14,7,17504
MAV 92,44,100
buffer_load_dwordx4 v[156:159], v4, s[16:19], s52 offen offset:1024 sc1
MAV 92,60,108
TR 24,7,25408
MAV 76,60,104
TR 26,7,25920
TR 28,7,25440
MAV 76,44,96
TR 30,7,25952
s_waitcnt vmcnt(16) lgkmcnt(8)
s_barrier
MAV 32,0,112
TR 32,6,16896
s_add_u32 m0, s55, 0
MAV 32,16,120
buffer_load_dwordx4 v18, s[28:31], s54 offen lds
MAV 48,16,124
TR 34,6,17408
TR 36,6,16928
MAV 48,0,116
TR 38,6,17440
s_add_u32 s52, s76, 475136
MAV 52,4,116
buffer_load_dwordx4 v[96:99], v4, s[16:19], s52 offen sc1
MAV 52,20,124
TR 48,6,25344
MAV 36,20,120
TR 50,6,25856
TR 52,6,25376
MAV 36,4,112
TR 54,6,25888
s_waitcnt lgkmcnt(8)
MAV 40,8,112
buffer_load_dwordx4 v19, s[28:31], s54 offen offset:1056 lds
MAV 40,24,120
s_add_u32 s54, s98, 393216
MAV 56,24,124
TR 40,6,16960
TR 42,6,17472
MAV 56,8,116
TR 44,6,16992
TR 46,6,17504
MAV 60,12,116
buffer_load_dwordx4 v[100:103], v4, s[16:19], s52 offen offset:1024 sc1
MAV 60,28,124
TR 56,6,25408
MAV 44,28,120
TR 58,6,25920
TR 60,6,25440
MAV 44,12,112
TR 62,6,25952
s_waitcnt lgkmcnt(8)
MAV 64,32,112
TR 0,7,33792
s_add_u32 m0, s55, 8448
MAV 64,48,120
buffer_load_dwordx4 v18, s[28:31], s54 offen lds
MAV 80,48,124
TR 2,7,34304
TR 4,7,33824
MAV 80,32,116
TR 6,7,34336
s_add_u32 s52, s76, 540672
MAV 84,36,116
buffer_load_dwordx4 v[104:107], v4, s[16:19], s52 offen sc1
MAV 84,52,124
TR 16,7,42240
MAV 68,52,120
TR 18,7,42752
TR 20,7,42272
MAV 68,36,112
TR 22,7,42784
s_waitcnt lgkmcnt(8)
MAV 72,40,112
buffer_load_dwordx4 v19, s[28:31], s54 offen offset:1056 lds
MAV 72,56,120
s_add_u32 s54, s99, 589824
MAV 88,56,124
TR 8,7,33856
TR 10,7,34368
MAV 88,40,116
TR 12,7,33888
TR 14,7,34400
MAV 92,44,116
buffer_load_dwordx4 v[108:111], v4, s[16:19], s52 offen offset:1024 sc1
MAV 92,60,124
TR 24,7,42304
MAV 76,60,120
TR 26,7,42816
TR 28,7,42336
MAV 76,44,112
TR 30,7,42848
s_waitcnt vmcnt(16) lgkmcnt(8)
s_barrier
MAV 32,0,128
TR 32,6,33792
s_add_u32 m0, s55, 16896
MAV 32,16,136
buffer_load_dwordx4 v18, s[28:31], s54 offen lds
MAV 48,16,140
TR 34,6,34304
TR 36,6,33824
MAV 48,0,132
TR 38,6,34336
s_add_u32 s52, s77, 589824
MAV 52,4,132
buffer_load_dwordx4 v[112:115], v4, s[16:19], s52 offen sc1
MAV 52,20,140
TR 48,6,42240
MAV 36,20,136
TR 50,6,42752
TR 52,6,42272
MAV 36,4,128
TR 54,6,42784
s_waitcnt lgkmcnt(8)
MAV 40,8,128
buffer_load_dwordx4 v19, s[28:31], s54 offen offset:1056 lds
MAV 40,24,136
s_add_u32 s54, s99, 851968
MAV 56,24,140
TR 40,6,33856
TR 42,6,34368
MAV 56,8,132
TR 44,6,33888
TR 46,6,34400
MAV 60,12,132
buffer_load_dwordx4 v[116:119], v4, s[16:19], s52 offen offset:1024 sc1
MAV 60,28,140
TR 56,6,42304
MAV 44,28,136
TR 58,6,42816
TR 60,6,42336
MAV 44,12,128
TR 62,6,42848
s_waitcnt lgkmcnt(8)
MAV 64,32,128
TR 0,7,50688
s_add_u32 m0, s55, 25344
MAV 64,48,136
buffer_load_dwordx4 v18, s[28:31], s54 offen lds
MAV 80,48,140
TR 2,7,51200
TR 4,7,50720
MAV 80,32,132
TR 6,7,51232
s_add_u32 s52, s77, 655360
MAV 84,36,132
buffer_load_dwordx4 v[120:123], v4, s[16:19], s52 offen sc1
MAV 84,52,140
TR 16,7,59136
MAV 68,52,136
TR 18,7,59648
TR 20,7,59168
MAV 68,36,128
TR 22,7,59680
s_waitcnt lgkmcnt(8)
MAV 72,40,128
buffer_load_dwordx4 v19, s[28:31], s54 offen offset:1056 lds
MAV 72,56,136
s_add_u32 s54, s100, 1048576
MAV 88,56,140
TR 8,7,50752
TR 10,7,51264
MAV 88,40,132
TR 12,7,50784
TR 14,7,51296
MAV 92,44,132
buffer_load_dwordx4 v[124:127], v4, s[16:19], s52 offen offset:1024 sc1
MAV 92,60,140
TR 24,7,59200
MAV 76,60,136
TR 26,7,59712
TR 28,7,59232
MAV 76,44,128
TR 30,7,59744
s_waitcnt vmcnt(16) lgkmcnt(8)
s_barrier
MAV 32,0,144
TR 32,6,50688
s_add_u32 m0, s55, 33792
MAV 32,16,152
buffer_load_dwordx4 v18, s[28:31], s54 offen lds
MAV 48,16,156
TR 34,6,51200
TR 36,6,50720
MAV 48,0,148
TR 38,6,51232
s_add_u32 s52, s78, 704512
MAV 52,4,148
buffer_load_dwordx4 v[128:131], v4, s[16:19], s52 offen sc1
MAV 52,20,156
TR 48,6,59136
MAV 36,20,152
TR 50,6,59648
TR 52,6,59168
MAV 36,4,144
TR 54,6,59680
s_waitcnt lgkmcnt(8)
MAV 40,8,144
buffer_load_dwordx4 v19, s[28:31], s54 offen offset:1056 lds
MAV 40,24,152
s_add_u32 s54, s100, 1310720
MAV 56,24,156
TR 40,6,50752
TR 42,6,51264
MAV 56,8,148
TR 44,6,50784
TR 46,6,51296
MAV 60,12,148
buffer_load_dwordx4 v[132:135], v4, s[16:19], s52 offen offset:1024 sc1
MAV 60,28,156
TR 56,6,59200
MAV 44,28,152
TR 58,6,59712
TR 60,6,59232
MAV 44,12,144
TR 62,6,59744
v_add_u32 v7, s57, v7
v_add_u32 v6, s57, v6
s_sub_u32 s57, 0, s57
s_waitcnt lgkmcnt(8)
MAV 64,32,144
ds_read_b64_tr_b16 a[0:1], v7
s_add_u32 m0, s55, 42240
MAV 64,48,152
buffer_load_dwordx4 v18, s[28:31], s54 offen lds
MAV 80,48,156
TR 2,7,512
TR 4,7,32
MAV 80,32,148
TR 6,7,544
s_add_u32 s52, s78, 770048
MAV 84,36,148
buffer_load_dwordx4 v[136:139], v4, s[16:19], s52 offen sc1
MAV 84,52,156
TR 16,7,8448
MAV 68,52,152
TR 18,7,8960
TR 20,7,8480
MAV 68,36,144
TR 22,7,8992
s_waitcnt lgkmcnt(8)
MAV 72,40,144
buffer_load_dwordx4 v19, s[28:31], s54 offen offset:1056 lds
MAV 72,56,152
s_add_u32 s54, s101, 1507328
MAV 88,56,156
TR 8,7,64
TR 10,7,576
MAV 88,40,148
TR 12,7,96
TR 14,7,608
MAV 92,44,148
buffer_load_dwordx4 v[140:143], v4, s[16:19], s52 offen offset:1024 sc1
MAV 92,60,156
TR 24,7,8512
MAV 76,60,152
TR 26,7,9024
TR 28,7,8544
MAV 76,44,144
TR 30,7,9056
s_waitcnt vmcnt(16) lgkmcnt(8)
s_barrier
MAV 32,0,96
ds_read_b64_tr_b16 a[32:33], v6
s_add_u32 m0, s55, 50688
MAV 32,16,104
buffer_load_dwordx4 v18, s[28:31], s54 offen lds
MAV 48,16,108
TR 34,6,512
TR 36,6,32
MAV 48,0,100
TR 38,6,544
s_add_u32 s52, s79, 819200
MAV 52,4,100
buffer_load_dwordx4 v[144:147], v4, s[16:19], s52 offen sc1
MAV 52,20,108
TR 48,6,8448
MAV 36,20,104
TR 50,6,8960
TR 52,6,8480
MAV 36,4,96
TR 54,6,8992
s_waitcnt lgkmcnt(8)
MAV 40,8,96
buffer_load_dwordx4 v19, s[28:31], s54 offen offset:1056 lds
MAV 40,24,104
s_add_u32 s54, s101, 1769472
MAV 56,24,108
TR 40,6,64
TR 42,6,576
MAV 56,8,100
TR 44,6,96
TR 46,6,608
MAV 60,12,100
buffer_load_dwordx4 v[148:151], v4, s[16:19], s52 offen offset:1024 sc1
MAV 60,28,108
TR 56,6,8512
MAV 44,28,104
TR 58,6,9024
TR 60,6,8544
MAV 44,12,96
TR 62,6,9056
s_waitcnt lgkmcnt(8)
MAV 64,32,96
TR 0,7,16896
s_add_u32 m0, s55, 59136
MAV 64,48,104
buffer_load_dwordx4 v18, s[28:31], s54 offen lds
MAV 80,48,108
TR 2,7,17408
TR 4,7,16928
MAV 80,32,100
TR 6,7,17440
s_add_u32 s52, s79, 884736
MAV 84,36,100
buffer_load_dwordx4 v[152:155], v4, s[16:19], s52 offen sc1
MAV 84,52,108
TR 16,7,25344
MAV 68,52,104
TR 18,7,25856
TR 20,7,25376
MAV 68,36,96
TR 22,7,25888
s_waitcnt lgkmcnt(8)
MAV 72,40,96
buffer_load_dwordx4 v19, s[28:31], s54 offen offset:1056 lds
MAV 72,56,104
s_add_u32 s54, s98, 1966080
MAV 88,56,108
TR 8,7,16960
TR 10,7,17472
MAV 88,40,100
TR 12,7,16992
TR 14,7,17504
MAV 92,44,100
buffer_load_dwordx4 v[156:159], v4, s[16:19], s52 offen offset:1024 sc1
MAV 92,60,108
TR 24,7,25408
MAV 76,60,104
TR 26,7,25920
TR 28,7,25440
MAV 76,44,96
TR 30,7,25952
s_waitcnt vmcnt(16) lgkmcnt(8)
s_barrier
MAV 32,0,112
TR 32,6,16896
s_add_u32 m0, s55, 67584
MAV 32,16,120
buffer_load_dwordx4 v18, s[28:31], s54 offen lds
MAV 48,16,124
TR 34,6,17408
TR 36,6,16928
MAV 48,0,116
TR 38,6,17440
s_add_u32 s52, s76, 32768
MAV 52,4,116
buffer_load_dwordx4 v[96:99], v4, s[16:19], s52 offen sc1
MAV 52,20,124
TR 48,6,25344
MAV 36,20,120
TR 50,6,25856
TR 52,6,25376
MAV 36,4,112
TR 54,6,25888
s_waitcnt lgkmcnt(8)
MAV 40,8,112
buffer_load_dwordx4 v19, s[28:31], s54 offen offset:1056 lds
MAV 40,24,120
s_add_u32 s54, s98, 2228224
MAV 56,24,124
TR 40,6,16960
TR 42,6,17472
MAV 56,8,116
TR 44,6,16992
TR 46,6,17504
MAV 60,12,116
buffer_load_dwordx4 v[100:103], v4, s[16:19], s52 offen offset:1024 sc1
MAV 60,28,124
TR 56,6,25408
MAV 44,28,120
TR 58,6,25920
TR 60,6,25440
MAV 44,12,112
TR 62,6,25952
s_waitcnt lgkmcnt(8)
MAV 64,32,112
TR 0,7,33792
s_add_u32 m0, s55, 76032
MAV 64,48,120
buffer_load_dwordx4 v18, s[28:31], s54 offen lds
MAV 80,48,124
TR 2,7,34304
TR 4,7,33824
MAV 80,32,116
TR 6,7,34336
s_add_u32 s52, s76, 98304
MAV 84,36,116
buffer_load_dwordx4 v[104:107], v4, s[16:19], s52 offen sc1
MAV 84,52,124
TR 16,7,42240
MAV 68,52,120
TR 18,7,42752
TR 20,7,42272
MAV 68,36,112
TR 22,7,42784
s_waitcnt lgkmcnt(8)
MAV 72,40,112
buffer_load_dwordx4 v19, s[28:31], s54 offen offset:1056 lds
MAV 72,56,120
s_add_u32 s54, s99, 2424832
MAV 88,56,124
TR 8,7,33856
TR 10,7,34368
MAV 88,40,116
TR 12,7,33888
TR 14,7,34400
MAV 92,44,116
buffer_load_dwordx4 v[108:111], v4, s[16:19], s52 offen offset:1024 sc1
MAV 92,60,124
TR 24,7,42304
MAV 76,60,120
TR 26,7,42816
TR 28,7,42336
MAV 76,44,112
TR 30,7,42848
s_waitcnt vmcnt(16) lgkmcnt(8)
s_barrier
MAV 32,0,128
TR 32,6,33792
s_add_u32 m0, s55, 84480
MAV 32,16,136
buffer_load_dwordx4 v18, s[28:31], s54 offen lds
MAV 48,16,140
TR 34,6,34304
TR 36,6,33824
MAV 48,0,132
TR 38,6,34336
s_add_u32 s52, s77, 147456
.Lpad9:
s_cbranch_execz .Lnopoll36r
MAV 52,4,132
buffer_load_dwordx4 v[112:115], v4, s[16:19], s52 offen sc1
MAV 52,20,140
TR 48,6,42240
MAV 36,20,136
TR 50,6,42752
TR 52,6,42272
MAV 36,4,128
TR 54,6,42784
s_waitcnt lgkmcnt(8)
MAV 40,8,128
buffer_load_dwordx4 v19, s[28:31], s54 offen offset:1056 lds
MAV 40,24,136
s_add_u32 s54, s99, 2686976
MAV 56,24,140
TR 40,6,33856
TR 42,6,34368
MAV 56,8,132
TR 44,6,33888
TR 46,6,34400
MAV 60,12,132
buffer_load_dwordx4 v[116:119], v4, s[16:19], s52 offen offset:1024 sc1
MAV 60,28,140
TR 56,6,42304
MAV 44,28,136
TR 58,6,42816
TR 60,6,42336
MAV 44,12,128
TR 62,6,42848
s_waitcnt lgkmcnt(8)
MAV 64,32,128
TR 0,7,50688
s_add_u32 m0, s55, 92928
MAV 64,48,136
buffer_load_dwordx4 v18, s[28:31], s54 offen lds
MAV 80,48,140
TR 2,7,51200
TR 4,7,50720
MAV 80,32,132
TR 6,7,51232
s_add_u32 s52, s77, 212992
MAV 84,36,132
buffer_load_dwordx4 v[120:123], v4, s[16:19], s52 offen sc1
MAV 84,52,140
TR 16,7,59136
MAV 68,52,136
TR 18,7,59648
TR 20,7,59168
MAV 68,36,128
TR 22,7,59680
s_waitcnt lgkmcnt(8)
MAV 72,40,128
buffer_load_dwordx4 v19, s[28:31], s54 offen offset:1056 lds
MAV 72,56,136
s_add_u32 s54, s100, 2883584
MAV 88,56,140
TR 8,7,50752
TR 10,7,51264
MAV 88,40,132
TR 12,7,50784
TR 14,7,51296
MAV 92,44,132
buffer_load_dwordx4 v[124:127], v4, s[16:19], s52 offen offset:1024 sc1
MAV 92,60,140
TR 24,7,59200
MAV 76,60,136
TR 26,7,59712
TR 28,7,59232
MAV 76,44,128
TR 30,7,59744
s_waitcnt vmcnt(16) lgkmcnt(8)
s_barrier
MAV 32,0,144
TR 32,6,50688
s_add_u32 m0, s55, 101376
MAV 32,16,152
buffer_load_dwordx4 v18, s[28:31], s54 offen lds
MAV 48,16,156
TR 34,6,51200
TR 36,6,50720
MAV 48,0,148
TR 38,6,51232
s_add_u32 s52, s78, 262144
MAV 52,4,148
buffer_load_dwordx4 v[128:131], v4, s[16:19], s52 offen sc1
MAV 52,20,156
TR 48,6,59136
MAV 36,20,152
TR 50,6,59648
TR 52,6,59168
MAV 36,4,144
TR 54,6,59680
s_waitcnt lgkmcnt(8)
MAV 40,8,144
buffer_load_dwordx4 v19, s[28:31], s54 offen offset:1056 lds
MAV 40,24,152
s_add_u32 s54, s100, 3145728
MAV 56,24,156
TR 40,6,50752
TR 42,6,51264
MAV 56,8,148
TR 44,6,50784
TR 46,6,51296
MAV 60,12,148
buffer_load_dwordx4 v[132:135], v4, s[16:19], s52 offen offset:1024 sc1
MAV 60,28,156
TR 56,6,59200
MAV 44,28,152
TR 58,6,59712
TR 60,6,59232
MAV 44,12,144
TR 62,6,59744
v_add_u32 v7, s57, v7
v_add_u32 v6, s57, v6
s_sub_u32 s57, 0, s57
s_waitcnt lgkmcnt(8)
MAV 64,32,144
ds_read_b64_tr_b16 a[0:1], v7
s_add_u32 m0, s55, 109824
MAV 64,48,152
buffer_load_dwordx4 v18, s[28:31], s54 offen lds
MAV 80,48,156
TR 2,7,512
TR 4,7,32
MAV 80,32,148
TR 6,7,544
s_add_u32 s52, s78, 327680
MAV 84,36,148
buffer_load_dwordx4 v[136:139], v4, s[16:19], s52 offen sc1
MAV 84,52,156
TR 16,7,8448
MAV 68,52,152
TR 18,7,8960
TR 20,7,8480
MAV 68,36,144
TR 22,7,8992
s_waitcnt lgkmcnt(8)
MAV 72,40,144
buffer_load_dwordx4 v19, s[28:31], s54 offen offset:1056 lds
MAV 72,56,152
s_add_u32 s54, s101, 3342336
MAV 88,56,156
TR 8,7,64
TR 10,7,576
MAV 88,40,148
TR 12,7,96
TR 14,7,608
MAV 92,44,148
buffer_load_dwordx4 v[140:143], v4, s[16:19], s52 offen offset:1024 sc1
MAV 92,60,156
TR 24,7,8512
MAV 76,60,152
TR 26,7,9024
TR 28,7,8544
MAV 76,44,144
TR 30,7,9056
s_waitcnt vmcnt(16) lgkmcnt(8)
s_barrier
MAV 32,0,96
ds_read_b64_tr_b16 a[32:33], v6
s_add_u32 m0, s55, 118272
MAV 32,16,104
buffer_load_dwordx4 v18, s[28:31], s54 offen lds
MAV 48,16,108
TR 34,6,512
TR 36,6,32
MAV 48,0,100
TR 38,6,544
s_add_u32 s52, s79, 376832
MAV 52,4,100
buffer_load_dwordx4 v[144:147], v4, s[16:19], s52 offen sc1
MAV 52,20,108
TR 48,6,8448
MAV 36,20,104
TR 50,6,8960
TR 52,6,8480
MAV 36,4,96
TR 54,6,8992
s_waitcnt lgkmcnt(8)
MAV 40,8,96
buffer_load_dwordx4 v19, s[28:31], s54 offen offset:1056 lds
MAV 40,24,104
s_add_u32 s54, s101, 3604480
MAV 56,24,108
TR 40,6,64
TR 42,6,576
MAV 56,8,100
TR 44,6,96
TR 46,6,608
MAV 60,12,100
buffer_load_dwordx4 v[148:151], v4, s[16:19], s52 offen offset:1024 sc1
MAV 60,28,108
TR 56,6,8512
MAV 44,28,104
TR 58,6,9024
TR 60,6,8544
MAV 44,12,96
TR 62,6,9056
s_waitcnt lgkmcnt(8)
MAV 64,32,96
TR 0,7,16896
s_add_u32 m0, s55, 126720
MAV 64,48,104
buffer_load_dwordx4 v18, s[28:31], s54 offen lds
MAV 80,48,108
TR 2,7,17408
TR 4,7,16928
MAV 80,32,100
TR 6,7,17440
s_add_u32 s52, s79, 442368
MAV 84,36,100
buffer_load_dwordx4 v[152:155], v4, s[16:19], s52 offen sc1
MAV 84,52,108
TR 16,7,25344
MAV 68,52,104
TR 18,7,25856
TR 20,7,25376
MAV 68,36,96
TR 22,7,25888
s_waitcnt lgkmcnt(8)
MAV 72,40,96
buffer_load_dwordx4 v19, s[28:31], s54 offen offset:1056 lds
MAV 72,56,104
s_add_u32 s54, s98, 196608
MAV 88,56,108
TR 8,7,16960
TR 10,7,17472
MAV 88,40,100
TR 12,7,16992
TR 14,7,17504
MAV 92,44,100
buffer_load_dwordx4 v[156:159], v4, s[16:19], s52 offen offset:1024 sc1
MAV 92,60,108
TR 24,7,25408
MAV 76,60,104
TR 26,7,25920
TR 28,7,25440
MAV 76,44,96
TR 30,7,25952
s_waitcnt vmcnt(16) lgkmcnt(8)
s_barrier
MAV 32,0,112
TR 32,6,16896
s_add_u32 m0, s55, 0
MAV 32,16,120
buffer_load_dwordx4 v18, s[28:31], s54 offen lds
MAV 48,16,124
TR 34,6,17408
TR 36,6,16928
MAV 48,0,116
TR 38,6,17440
s_add_u32 s52, s76, 491520
MAV 52,4,116
buffer_load_dwordx4 v[96:99], v4, s[16:19], s52 offen sc1
MAV 52,20,124
TR 48,6,25344
MAV 36,20,120
TR 50,6,25856
TR 52,6,25376
MAV 36,4,112
TR 54,6,25888
s_waitcnt lgkmcnt(8)
MAV 40,8,112
buffer_load_dwordx4 v19, s[28:31], s54 offen offset:1056 lds
MAV 40,24,120
s_add_u32 s54, s99, 655360
MAV 56,24,124
TR 40,6,16960
TR 42,6,17472
MAV 56,8,116
TR 44,6,16992
TR 46,6,17504
MAV 60,12,116
buffer_load_dwordx4 v[100:103], v4, s[16:19], s52 offen offset:1024 sc1
MAV 60,28,124
TR 56,6,25408
MAV 44,28,120
TR 58,6,25920
TR 60,6,25440
MAV 44,12,112
TR 62,6,25952
s_waitcnt lgkmcnt(8)
MAV 64,32,112
TR 0,7,33792
s_add_u32 m0, s55, 8448
MAV 64,48,120
buffer_load_dwordx4 v18, s[28:31], s54 offen lds
MAV 80,48,124
TR 2,7,34304
TR 4,7,33824
MAV 80,32,116
TR 6,7,34336
s_add_u32 s52, s76, 557056
MAV 84,36,116
buffer_load_dwordx4 v[104:107], v4, s[16:19], s52 offen sc1
MAV 84,52,124
TR 16,7,42240
MAV 68,52,120
TR 18,7,42752
TR 20,7,42272
MAV 68,36,112
TR 22,7,42784
s_waitcnt lgkmcnt(8)
MAV 72,40,112
buffer_load_dwordx4 v19, s[28:31], s54 offen offset:1056 lds
MAV 72,56,120
s_add_u32 s54, s100, 1114112
MAV 88,56,124
TR 8,7,33856
TR 10,7,34368
MAV 88,40,116
TR 12,7,33888
TR 14,7,34400
MAV 92,44,116
buffer_load_dwordx4 v[108:111], v4, s[16:19], s52 offen offset:1024 sc1
MAV 92,60,124
TR 24,7,42304
MAV 76,60,120
TR 26,7,42816
TR 28,7,42336
MAV 76,44,112
TR 30,7,42848
s_waitcnt vmcnt(16) lgkmcnt(8)
s_barrier
MAV 32,0,128
TR 32,6,33792
s_add_u32 m0, s55, 16896
MAV 32,16,136
buffer_load_dwordx4 v18, s[28:31], s54 offen lds
MAV 48,16,140
TR 34,6,34304
TR 36,6,33824
MAV 48,0,132
TR 38,6,34336
s_add_u32 s52, s77, 606208
MAV 52,4,132
buffer_load_dwordx4 v[112:115], v4, s[16:19], s52 offen sc1
MAV 52,20,140
TR 48,6,42240
MAV 36,20,136
TR 50,6,42752
TR 52,6,42272
MAV 36,4,128
TR 54,6,42784
s_waitcnt lgkmcnt(8)
MAV 40,8,128
buffer_load_dwordx4 v19, s[28:31], s54 offen offset:1056 lds
MAV 40,24,136
s_add_u32 s54, s101, 1572864
MAV 56,24,140
TR 40,6,33856
TR 42,6,34368
MAV 56,8,132
TR 44,6,33888
TR 46,6,34400
MAV 60,12,132
buffer_load_dwordx4 v[116:119], v4, s[16:19], s52 offen offset:1024 sc1
MAV 60,28,140
TR 56,6,42304
MAV 44,28,136
TR 58,6,42816
TR 60,6,42336
MAV 44,12,128
TR 62,6,42848
s_waitcnt lgkmcnt(8)
MAV 64,32,128
TR 0,7,50688
s_add_u32 m0, s55, 25344
MAV 64,48,136
buffer_load_dwordx4 v18, s[28:31], s54 offen lds
MAV 80,48,140
TR 2,7,51200
TR 4,7,50720
MAV 80,32,132
TR 6,7,51232
s_add_u32 s52, s77, 671744
MAV 84,36,132
buffer_load_dwordx4 v[120:123], v4, s[16:19], s52 offen sc1
MAV 84,52,140
TR 16,7,59136
MAV 68,52,136
TR 18,7,59648
TR 20,7,59168
MAV 68,36,128
TR 22,7,59680
s_waitcnt lgkmcnt(8)
MAV 72,40,128
buffer_load_dwordx4 v19, s[28:31], s54 offen offset:1056 lds
MAV 72,56,136
s_add_u32 s54, s98, 2031616
MAV 88,56,140
TR 8,7,50752
TR 10,7,51264
MAV 88,40,132
TR 12,7,50784
TR 14,7,51296
MAV 92,44,132
buffer_load_dwordx4 v[124:127], v4, s[16:19], s52 offen offset:1024 sc1
MAV 92,60,140
TR 24,7,59200
MAV 76,60,136
TR 26,7,59712
TR 28,7,59232
MAV 76,44,128
TR 30,7,59744
s_waitcnt vmcnt(16) lgkmcnt(8)
s_barrier
MAV 32,0,144
TR 32,6,50688
s_add_u32 m0, s55, 33792
MAV 32,16,152
buffer_load_dwordx4 v18, s[28:31], s54 offen lds
MAV 48,16,156
TR 34,6,51200
TR 36,6,50720
MAV 48,0,148
TR 38,6,51232
s_add_u32 s52, s78, 720896
MAV 52,4,148
buffer_load_dwordx4 v[128:131], v4, s[16:19], s52 offen sc1
MAV 52,20,156
TR 48,6,59136
MAV 36,20,152
TR 50,6,59648
TR 52,6,59168
MAV 36,4,144
TR 54,6,59680
s_waitcnt lgkmcnt(8)
MAV 40,8,144
buffer_load_dwordx4 v19, s[28:31], s54 offen offset:1056 lds
MAV 40,24,152
s_add_u32 s54, s99, 2490368
MAV 56,24,156
TR 40,6,50752
TR 42,6,51264
MAV 56,8,148
TR 44,6,50784
TR 46,6,51296
MAV 60,12,148
buffer_load_dwordx4 v[132:135], v4, s[16:19], s52 offen offset:1024 sc1
MAV 60,28,156
TR 56,6,59200
MAV 44,28,152
TR 58,6,59712
TR 60,6,59232
MAV 44,12,144
TR 62,6,59744
v_add_u32 v7, s57, v7
v_add_u32 v6, s57, v6
s_sub_u32 s57, 0, s57
s_waitcnt lgkmcnt(8)
MAV 64,32,144
ds_read_b64_tr_b16 a[0:1], v6
s_add_u32 m0, s55, 42240
MAV 64,48,152
buffer_load_dwordx4 v18, s[28:31], s54 offen lds
MAV 80,48,156
TR 2,6,512
TR 4,6,32
MAV 80,32,148
TR 6,6,544
s_add_u32 s52, s78, 786432
MAV 84,36,148
buffer_load_dwordx4 v[136:139], v4, s[16:19], s52 offen sc1
MAV 84,52,156
TR 16,6,8448
MAV 68,52,152
TR 18,6,8960
TR 20,6,8480
MAV 68,36,144
TR 22,6,8992
s_waitcnt lgkmcnt(8)
MAV 72,40,144
buffer_load_dwordx4 v19, s[28:31], s54 offen offset:1056 lds
MAV 72,56,152
s_add_u32 s54, s100, 2949120
MAV 88,56,156
TR 8,6,64
TR 10,6,576
MAV 88,40,148
TR 12,6,96
TR 14,6,608
MAV 92,44,148
buffer_load_dwordx4 v[140:143], v4, s[16:19], s52 offen offset:1024 sc1
MAV 92,60,156
TR 24,6,8512
MAV 76,60,152
TR 26,6,9024
TR 28,6,8544
MAV 76,44,144
TR 30,6,9056
s_waitcnt vmcnt(16) lgkmcnt(8)
s_barrier
MAV 64,0,96
TR 32,6,16896
TR 34,6,17408
s_add_u32 m0, s55, 50688
MAV 64,16,104
TR 36,6,16928
buffer_load_dwordx4 v18, s[28:31], s54 offen lds
MAV 80,16,108
buffer_load_dwordx4 v19, s[28:31], s54 offen offset:1056 lds
MAV 80,0,100
TR 38,6,17440
s_add_u32 s54, s101, 3407872
s_add_u32 s52, s79, 835584
MAV 84,4,100
TR 48,6,25344
buffer_load_dwordx4 v[144:147], v4, s[16:19], s52 offen sc1
MAV 84,20,108
TR 50,6,25856
MAV 68,20,104
TR 52,6,25376
buffer_load_dwordx4 v[148:151], v4, s[16:19], s52 offen offset:1024 sc1
MAV 68,4,96
TR 54,6,25888
s_add_u32 m0, s55, 59136
s_waitcnt lgkmcnt(8)
MAV 72,8,96
buffer_load_dwordx4 v18, s[28:31], s54 offen lds
MAV 72,24,104
TR 40,6,16960
TR 42,6,17472
MAV 88,24,108
TR 44,6,16992
buffer_load_dwordx4 v19, s[28:31], s54 offen offset:1056 lds
MAV 88,8,100
TR 46,6,17504
s_add_u32 s52, s79, 901120
MAV 92,12,100
TR 56,6,25408
.Lpad10:
s_cbranch_execz .Lnopoll36r
buffer_load_dwordx4 v[152:155], v4, s[16:19], s52 offen sc1
MAV 92,28,108
TR 58,6,25920
MAV 76,28,104
TR 60,6,25440
buffer_load_dwordx4 v[156:159], v4, s[16:19], s52 offen offset:1024 sc1
MAV 76,12,96
TR 62,6,25952
s_waitcnt vmcnt(16) lgkmcnt(8)
MAV 64,32,112
TR 0,6,33792
s_add_u32 s52, s76, 49152
s_lshl_b32 s70, s2, 10
MAV 64,48,120
buffer_load_dwordx4 v[160:163], v4, s[16:19], s52 offen sc1
s_lshl_b32 s62, s3, 7
MAV 80,48,124
TR 2,6,34304
TR 4,6,33824
MAV 80,32,116
TR 6,6,34336
s_add_u32 s70, s70, s62
s_add_u32 s70, s70, 31457280
MAV 84,36,116
buffer_load_dwordx4 v[164:167], v4, s[16:19], s52 offen offset:1024 sc1
s_xor_b32 s71, s70, 1024
MAV 84,52,124
TR 16,6,42240
TR 18,6,42752
MAV 68,52,120
TR 20,6,42272
v_min_u32 v12, 1, v1
v_lshlrev_b32 v12, 28, v12
MAV 68,36,112
TR 22,6,42784
s_add_u32 s52, s77, 163840
s_waitcnt lgkmcnt(8)
MAV 72,40,112
buffer_load_dwordx4 v[168:171], v4, s[16:19], s52 offen sc1
v_mov_b32 v13, 1
MAV 72,56,120
TR 8,6,33856
v_mov_b32 v15, 0
s_lshl_b32 s68, s7, 18
MAV 88,56,124
TR 10,6,34368
TR 12,6,33888
MAV 88,40,116
TR 14,6,34400
s_add_u32 s68, s68, 33554432
s_xor_b32 s69, s68, 262144
MAV 92,44,116
buffer_load_dwordx4 v[172:175], v4, s[16:19], s52 offen offset:1024 sc1
v_mov_b32 v11, v4
MAV 92,60,124
TR 24,6,42304
TR 26,6,42816
MAV 76,60,120
TR 28,6,42336
v_and_b32 v2, 1, v1
v_lshlrev_b32 v2, 4, v2
MAV 76,44,112
TR 30,6,42848
v_mov_b32 v224, 0x3f80
s_waitcnt vmcnt(12) lgkmcnt(8)
MAV 64,0,128
TR 32,6,50688
s_add_u32 s52, s78, 278528
v_lshlrev_b32 v2, v2, v224
MAV 64,16,136
buffer_load_dwordx4 v[176:179], v4, s[16:19], s52 offen sc1
v_bfe_u32 v224, v1, 2, 2
MAV 80,16,140
TR 34,6,51200
TR 36,6,50720
MAV 80,0,132
TR 38,6,51232
v_lshrrev_b32 v225, 4, v1
v_cmp_eq_u32 vcc, v224, v225
MAV 84,4,132
buffer_load_dwordx4 v[180:183], v4, s[16:19], s52 offen offset:1024 sc1
v_cndmask_b32 v2, 0, v2, vcc
MAV 84,20,140
TR 48,6,59136
TR 50,6,59648
MAV 68,20,136
TR 52,6,59168
v_and_b32 v224, 2, v1
v_cmp_eq_u32 vcc, 0, v224
MAV 68,4,128
TR 54,6,59680
s_add_u32 s52, s79, 393216
s_waitcnt lgkmcnt(8)
MAV 72,8,128
buffer_load_dwordx4 v[184:187], v4, s[16:19], s52 offen sc1
v_cndmask_b32 v226, 0, v2, vcc
MAV 72,24,136
TR 40,6,50752
v_cndmask_b32 v227, v2, 0, vcc
v_mov_b32 v224, 0
MAV 88,24,140
TR 42,6,51264
TR 44,6,50784
MAV 88,8,132
TR 46,6,51296
v_mov_b32 v225, 0
v_mov_b32 v228, 0
MAV 92,12,132
buffer_load_dwordx4 v[188:191], v4, s[16:19], s52 offen offset:1024 sc1
v_mov_b32 v229, 0
MAV 92,28,140
TR 56,6,59200
TR 58,6,59712
MAV 76,28,136
TR 60,6,59232
v_bfe_u32 v18, v1, 3, 1
v_lshrrev_b32 v2, 4, v1
MAV 76,12,128
TR 62,6,59744
v_lshl_add_u32 v18, v2, 3, v18
s_waitcnt vmcnt(8) lgkmcnt(8)
s_barrier
v_add_u32 v6, s57, v6
MAV 64,32,144
ds_read_b64_tr_b16 a[0:1], v6
s_add_u32 s52, s76, 507904
s_lshl_b32 s62, s3, 1
MAV 64,48,152
buffer_load_dwordx4 v[192:195], v4, s[16:19], s52 offen sc1
v_add_u32 v18, s62, v18
MAV 80,48,156
TR 2,6,512
TR 4,6,32
MAV 80,32,148
TR 6,6,544
v_mul_u32_u24 v18, 6144, v18
v_and_b32 v2, 7, v1
MAV 84,36,148
buffer_load_dwordx4 v[196:199], v4, s[16:19], s52 offen offset:1024 sc1
v_lshl_add_u32 v18, v2, 4, v18
MAV 84,52,156
TR 16,6,8448
TR 18,6,8960
MAV 68,52,152
TR 20,6,8480
s_lshl_b32 s62, s9, 7
v_add_u32 v18, s62, v18
MAV 68,36,144
TR 22,6,8992
s_add_u32 s52, s77, 622592
s_waitcnt lgkmcnt(8)
MAV 72,40,144
buffer_load_dwordx4 v[200:203], v4, s[16:19], s52 offen sc1
v_add_u32 v19, 1024, v18
MAV 72,56,152
TR 8,6,64
v_add_u32 v20, 2048, v18
s_mul_i32 s59, s3, 3104
MAV 88,56,156
TR 10,6,576
TR 12,6,96
MAV 88,40,148
TR 14,6,608
s_mov_b32 s58, 0
v_accvgpr_read_b32 v28, a224
MAV 92,44,148
buffer_load_dwordx4 v[204:207], v4, s[16:19], s52 offen offset:1024 sc1
v_add_f32 v32, v32, v28
MAV 92,60,156
TR 24,6,8512
TR 26,6,9024
MAV 76,60,152
TR 28,6,8544
v_accvgpr_read_b32 v29, a225
v_add_f32 v33, v33, v29
MAV 76,44,144
TR 30,6,9056
v_accvgpr_read_b32 v28, a226
s_waitcnt vmcnt(8) lgkmcnt(8)
MAV 64,0,160
TR 32,6,16896
s_add_u32 s52, s78, 737280
v_add_f32 v34, v34, v28
MAV 64,16,168
buffer_load_dwordx4 v[208:211], v4, s[16:19], s52 offen sc1
v_accvgpr_read_b32 v29, a227
MAV 80,16,172
TR 34,6,17408
TR 36,6,16928
MAV 80,0,164
TR 38,6,17440
v_add_f32 v35, v35, v29
v_accvgpr_read_b32 v28, a228
MAV 84,4,164
buffer_load_dwordx4 v[212:215], v4, s[16:19], s52 offen offset:1024 sc1
v_add_f32 v36, v36, v28
MAV 84,20,172
TR 48,6,25344
TR 50,6,25856
MAV 68,20,168
TR 52,6,25376
v_accvgpr_read_b32 v29, a229
v_add_f32 v37, v37, v29
MAV 68,4,160
TR 54,6,25888
s_add_u32 s52, s79, 851968
s_waitcnt lgkmcnt(8)
MAV 72,8,160
buffer_load_dwordx4 v[216:219], v4, s[16:19], s52 offen sc1
v_accvgpr_read_b32 v28, a230
MAV 72,24,168
TR 40,6,16960
v_add_f32 v38, v38, v28
v_accvgpr_read_b32 v29, a231
MAV 88,24,172
TR 42,6,17472
TR 44,6,16992
MAV 88,8,164
TR 46,6,17504
v_add_f32 v39, v39, v29
v_accvgpr_read_b32 v28, a232
MAV 92,12,164
buffer_load_dwordx4 v[220:223], v4, s[16:19], s52 offen offset:1024 sc1
v_add_f32 v40, v40, v28
MAV 92,28,172
TR 56,6,25408
TR 58,6,25920
MAV 76,28,168
TR 60,6,25440
v_accvgpr_read_b32 v29, a233
v_add_f32 v41, v41, v29
MAV 76,12,160
TR 62,6,25952
v_accvgpr_read_b32 v28, a234
s_waitcnt vmcnt(8) lgkmcnt(8)
MAV 64,32,176
TR 0,6,33792
v_add_f32 v42, v42, v28
v_accvgpr_read_b32 v29, a235
MAV 64,48,184
TR 2,6,34304
v_add_f32 v43, v43, v29
MAV 80,48,188
TR 4,6,33824
v_accvgpr_read_b32 v28, a236
MAV 80,32,180
TR 6,6,34336
v_add_f32 v44, v44, v28
MAV 84,36,180
TR 16,6,42240
v_accvgpr_read_b32 v29, a237
MAV 84,52,188
TR 18,6,42752
v_add_f32 v45, v45, v29
MAV 68,52,184
TR 20,6,42272
v_accvgpr_read_b32 v28, a238
MAV 68,36,176
TR 22,6,42784
s_waitcnt lgkmcnt(8)
MAV 72,40,176
TR 8,6,33856
v_add_f32 v46, v46, v28
MAV 72,56,184
TR 10,6,34368
v_accvgpr_read_b32 v29, a239
MAV 88,56,188
TR 12,6,33888
v_add_f32 v47, v47, v29
MAV 88,40,180
TR 14,6,34400
v_accvgpr_read_b32 v28, a240
MAV 92,44,180
TR 24,6,42304
v_add_f32 v48, v48, v28
MAV 92,60,188
TR 26,6,42816
v_accvgpr_read_b32 v29, a241
MAV 76,60,184
TR 28,6,42336
v_add_f32 v49, v49, v29
MAV 76,44,176
TR 30,6,42848
v_accvgpr_read_b32 v28, a242
s_waitcnt vmcnt(4) lgkmcnt(8)
MAV 64,0,192
TR 32,6,50688
v_add_f32 v50, v50, v28
v_accvgpr_read_b32 v29, a243
MAV 64,16,200
TR 34,6,51200
v_add_f32 v51, v51, v29
MAV 80,16,204
TR 36,6,50720
v_accvgpr_read_b32 v28, a244
MAV 80,0,196
TR 38,6,51232
v_add_f32 v52, v52, v28
MAV 84,4,196
TR 48,6,59136
v_accvgpr_read_b32 v29, a245
MAV 84,20,204
TR 50,6,59648
v_add_f32 v53, v53, v29
MAV 68,20,200
TR 52,6,59168
v_accvgpr_read_b32 v28, a246
MAV 68,4,192
TR 54,6,59680
s_waitcnt lgkmcnt(8)
MAV 72,8,192
TR 40,6,50752
v_add_f32 v54, v54, v28
MAV 72,24,200
TR 42,6,51264
v_accvgpr_read_b32 v29, a247
MAV 88,24,204
TR 44,6,50784
v_add_f32 v55, v55, v29
MAV 88,8,196
TR 46,6,51296
v_accvgpr_read_b32 v28, a248
MAV 92,12,196
TR 56,6,59200
v_add_f32 v56, v56, v28
MAV 92,28,204
TR 58,6,59712
v_accvgpr_read_b32 v29, a249
MAV 76,28,200
TR 60,6,59232
v_add_f32 v57, v57, v29
MAV 76,12,192
TR 62,6,59744
v_accvgpr_read_b32 v28, a250
s_waitcnt vmcnt(0) lgkmcnt(8)
MAV 64,32,208
ds_read_b64_tr_b16 a[0:1], v7
v_add_f32 v58, v58, v28
MAV 64,48,216
TR 2,7,512
v_accvgpr_read_b32 v29, a251
MAV 80,48,220
TR 4,7,32
v_add_f32 v59, v59, v29
MAV 80,32,212
TR 6,7,544
MAV 84,36,212
TR 16,7,8448
v_accvgpr_read_b32 v28, a252
MAV 84,52,220
TR 18,7,8960
v_add_f32 v60, v60, v28
MAV 68,52,216
TR 20,7,8480
v_accvgpr_read_b32 v29, a253
MAV 68,36,208
TR 22,7,8992
s_waitcnt lgkmcnt(8)
MAV 72,40,208
TR 8,7,64
MAV 72,56,216
TR 10,7,576
v_add_f32 v61, v61, v29
MAV 88,56,220
TR 12,7,96
v_accvgpr_read_b32 v28, a254
MAV 88,40,212
TR 14,7,608
v_add_f32 v62, v62, v28
MAV 92,44,212
TR 24,7,8512
MAV 92,60,220
TR 26,7,9024
v_accvgpr_read_b32 v29, a255
MAV 76,60,216
TR 28,7,8544
v_add_f32 v63, v63, v29
MAV 76,44,208
TR 30,7,9056
s_waitcnt lgkmcnt(8)
MAV 32,0,96
TR 32,7,16896
v_cvt_pk_bf16_f32 v232, v64, v65
v_cvt_pk_bf16_f32 v233, v66, v67
MAV 32,16,104
TR 34,7,17408
v_cvt_pk_bf16_f32 v234, v68, v69
MAV 48,16,108
TR 36,7,16928
v_cvt_pk_bf16_f32 v235, v70, v71
buffer_store_dwordx4 v[232:235], v11, s[16:19], s69 offen sc1
MAV 48,0,100
TR 38,7,17440
s_add_u32 s69, s69, 131072
MAV 52,4,100
TR 48,7,25344
v_cvt_pk_bf16_f32 v236, v72, v73
v_cvt_pk_bf16_f32 v237, v74, v75
MAV 52,20,108
TR 50,7,25856
v_cvt_pk_bf16_f32 v238, v76, v77
MAV 36,20,104
TR 52,7,25376
v_cvt_pk_bf16_f32 v239, v78, v79
buffer_store_dwordx4 v[236:239], v11, s[16:19], s69 offen sc1
MAV 36,4,96
TR 54,7,25888
s_add_u32 s69, s69, -130048
s_waitcnt lgkmcnt(8)
MAV 40,8,96
TR 40,7,16960
v_cvt_pk_bf16_f32 v240, v80, v81
MAV 40,24,104
TR 42,7,17472
v_cvt_pk_bf16_f32 v241, v82, v83
v_cvt_pk_bf16_f32 v242, v84, v85
MAV 56,24,108
TR 44,7,16992
v_cvt_pk_bf16_f32 v243, v86, v87
MAV 56,8,100
TR 46,7,17504
buffer_store_dwordx4 v[240:243], v11, s[16:19], s69 offen sc1
s_add_u32 s69, s69, 131072
MAV 60,12,100
TR 56,7,25408
v_cvt_pk_bf16_f32 v244, v88, v89
MAV 60,28,108
TR 58,7,25920
v_cvt_pk_bf16_f32 v245, v90, v91
v_cvt_pk_bf16_f32 v246, v92, v93
MAV 44,28,104
TR 60,7,25440
v_cvt_pk_bf16_f32 v247, v94, v95
MAV 44,12,96
TR 62,7,25952
buffer_store_dwordx4 v[244:247], v11, s[16:19], s69 offen sc1
s_waitcnt lgkmcnt(8)
MAV 32,32,112
TR 0,7,33792
MAV 32,48,120
TR 2,7,34304
MAV 48,48,124
TR 4,7,33824
MAV 48,32,116
TR 6,7,34336
MAV 52,36,116
TR 16,7,42240
MAV 52,52,124
TR 18,7,42752
MAV 36,52,120
TR 20,7,42272
MAV 36,36,112
TR 22,7,42784
s_waitcnt lgkmcnt(8)
MAV 40,40,112
TR 8,7,33856
MAV 40,56,120
TR 10,7,34368
MAV 56,56,124
TR 12,7,33888
MAV 56,40,116
TR 14,7,34400
MAV 60,44,116
TR 24,7,42304
MAV 60,60,124
TR 26,7,42816
MAV 44,60,120
TR 28,7,42336
MAV 44,44,112
TR 30,7,42848
s_waitcnt lgkmcnt(8)
MAV 32,0,128
TR 32,7,50688
MAV 32,16,136
TR 34,7,51200
MAV 48,16,140
TR 36,7,50720
MAV 48,0,132
TR 38,7,51232
MAV 52,4,132
TR 48,7,59136
MAV 52,20,140
TR 50,7,59648
MAV 36,20,136
TR 52,7,59168
MAV 36,4,128
TR 54,7,59680
s_waitcnt lgkmcnt(8)
MAV 40,8,128
TR 40,7,50752
MAV 40,24,136
TR 42,7,51264
MAV 56,24,140
TR 44,7,50784
MAV 56,8,132
TR 46,7,51296
MAV 60,12,132
TR 56,7,59200
MAV 60,28,140
TR 58,7,59712
MAV 44,28,136
TR 60,7,59232
MAV 44,12,128
TR 62,7,59744
v_add_u32 v7, s57, v7
s_waitcnt lgkmcnt(8)
MAV 32,32,144
ds_read_b64_tr_b16 a[0:1], v7
TR 2,7,512
MAV 32,48,152
s_waitcnt vmcnt(0)
buffer_atomic_add v13, v12, s[16:19], s71 offen
MAV 48,48,156
TR 4,7,32
MAV 48,32,148
TR 6,7,544
MAV 52,36,148
TR 16,7,8448
MAV 52,52,156
TR 18,7,8960
MAV 36,52,152
TR 20,7,8480
MAV 36,36,144
TR 22,7,8992
s_waitcnt lgkmcnt(8)
MAV 40,40,144
TR 8,7,64
MAV 40,56,152
TR 10,7,576
MAV 56,56,156
TR 12,7,96
MAV 56,40,148
TR 14,7,608
MAV 60,44,148
TR 24,7,8512
MAV 60,60,156
TR 26,7,9024
MAV 44,60,152
TR 28,7,8544
MAV 44,44,144
TR 30,7,9056
s_waitcnt lgkmcnt(8)
s_barrier
MAV 32,0,160
TR 32,7,16896
TR 34,7,17408
MAV 32,16,168
buffer_atomic_add v15, v12, s[16:19], s70 offen sc0
MAV 48,16,172
TR 36,7,16928
TR 38,7,17440
MAV 48,0,164
TR 48,7,25344
s_add_u32 m0, s59, 117248
MAV 52,4,164
buffer_load_dwordx4 v18, s[20:23], s58 offen lds
.Lpad11:
s_cbranch_execz .Lnopoll36r
MAV 52,20,172
TR 50,7,25856
TR 52,7,25376
MAV 36,20,168
TR 54,7,25888
MAV 36,4,160
TR 40,7,16960
s_waitcnt lgkmcnt(9)
MAV 40,8,160
buffer_load_dwordx4 v19, s[20:23], s58 offen offset:1024 lds
MAV 40,24,168
TR 42,7,17472
TR 44,7,16992
MAV 56,24,172
buffer_load_dwordx4 v20, s[20:23], s58 offen offset:2048 lds
MAV 56,8,164
TR 46,7,17504
s_add_u32 s58, s58, 196608
MAV 60,12,164
TR 56,7,25408
s_add_u32 m0, s59, 129664
MAV 60,28,172
buffer_load_dwordx4 v18, s[20:23], s58 offen lds
MAV 44,28,168
TR 58,7,25920
TR 60,7,25440
MAV 44,12,160
TR 62,7,25952
s_waitcnt lgkmcnt(8)
MAV 32,32,176
TR 0,7,33792
TR 2,7,34304
MAV 32,48,184
buffer_load_dwordx4 v19, s[20:23], s58 offen offset:1024 lds
MAV 48,48,188
TR 4,7,33824
MAV 48,32,180
TR 6,7,34336
TR 16,7,42240
MAV 52,36,180
buffer_load_dwordx4 v20, s[20:23], s58 offen offset:2048 lds
MAV 52,52,188
TR 18,7,42752
s_add_u32 s58, s58, 196608
MAV 36,52,184
TR 20,7,42272
MAV 36,36,176
TR 22,7,42784
s_add_u32 m0, s59, 67584
s_waitcnt lgkmcnt(8)
MAV 40,40,176
buffer_load_dwordx4 v18, s[20:23], s58 offen lds
MAV 40,56,184
TR 8,7,33856
MAV 56,56,188
TR 10,7,34368
TR 12,7,33888
MAV 56,40,180
TR 14,7,34400
MAV 60,44,180
buffer_load_dwordx4 v19, s[20:23], s58 offen offset:1024 lds
MAV 60,60,188
TR 24,7,42304
TR 26,7,42816
MAV 44,60,184
TR 28,7,42336
MAV 44,44,176
TR 30,7,42848
s_waitcnt vmcnt(8)
v_cmp_ne_u32 vcc, 0, v15
s_nop 0
s_cbranch_vccz .Lxs50
.Lxs50b:
s_waitcnt lgkmcnt(8)
MAV 32,0,192
TR 32,7,50688
TR 34,7,51200
MAV 32,16,200
TR 36,7,50720
buffer_load_dwordx4 v[232:235], v11, s[16:19], s68 offen sc1
MAV 48,16,204
TR 38,7,51232
s_add_u32 s68, s68, 131072
MAV 48,0,196
TR 48,7,59136
buffer_load_dwordx4 v[236:239], v11, s[16:19], s68 offen sc1
MAV 52,4,196
TR 50,7,59648
s_add_u32 s68, s68, -130048
MAV 52,20,204
TR 52,7,59168
buffer_load_dwordx4 v[240:243], v11, s[16:19], s68 offen sc1
MAV 36,20,200
TR 54,7,59680
s_add_u32 s68, s68, 131072
MAV 36,4,192
buffer_load_dwordx4 v[244:247], v11, s[16:19], s68 offen sc1
s_waitcnt lgkmcnt(8)
MAV 40,8,192
TR 40,7,50752
buffer_load_dwordx4 v20, s[20:23], s58 offen offset:2048 lds
MAV 40,24,200
TR 42,7,51264
s_add_u32 s58, s58, 196608
s_add_u32 m0, s59, 80000
MAV 56,24,204
TR 44,7,50784
buffer_load_dwordx4 v18, s[20:23], s58 offen lds
MAV 56,8,196
TR 46,7,51296
MAV 60,12,196
TR 56,7,59200
buffer_load_dwordx4 v19, s[20:23], s58 offen offset:1024 lds
MAV 60,28,204
TR 58,7,59712
MAV 44,28,200
TR 60,7,59232
buffer_load_dwordx4 v20, s[20:23], s58 offen offset:2048 lds
MAV 44,12,192
TR 62,7,59744
s_add_u32 s58, s58, 196608
s_waitcnt lgkmcnt(8)
MAV 32,32,208
s_add_u32 m0, s59, 92416
MAV 32,48,216
buffer_load_dwordx4 v18, s[20:23], s58 offen lds
MAV 48,48,220
MAV 48,32,212
MAV 52,36,212
MAV 52,52,220
MAV 36,52,216
buffer_load_dwordx4 v19, s[20:23], s58 offen offset:1024 lds
MAV 36,36,208
s_waitcnt lgkmcnt(0)
MAV 40,40,208
MAV 40,56,216
MAV 56,56,220
MAV 56,40,212
buffer_load_dwordx4 v20, s[20:23], s58 offen offset:2048 lds
MAV 60,44,212
s_add_u32 s58, s58, 196608
MAV 60,60,220
MAV 44,60,216
MAV 44,44,208
s_waitcnt vmcnt(10)
v_mfma_f32_16x16x32_bf16 v[32:35], v[226:229], v[232:235], v[32:35]
s_lshl_b32 s64, s6, 14
s_lshl_b32 s65, s49, 13
s_add_u32 s64, s64, s65
v_mfma_f32_16x16x32_bf16 v[36:39], v[224:227], v[232:235], v[36:39]
s_lshl_b32 s65, s7, 9
s_add_u32 s64, s64, s65
s_lshl_b32 s65, s48, 8
s_waitcnt vmcnt(9)
v_mfma_f32_16x16x32_bf16 v[40:43], v[226:229], v[236:239], v[40:43]
s_add_u32 s64, s64, s65
s_add_u32 s64, s64, 62914560
v_and_b32 v152, 31, v1
v_mfma_f32_16x16x32_bf16 v[44:47], v[224:227], v[236:239], v[44:47]
s_lshl_b32 s62, s7, 18
v_lshlrev_b32 v152, 3, v152
v_lshrrev_b32 v153, 5, v1
s_waitcnt vmcnt(8)
v_mfma_f32_16x16x32_bf16 v[48:51], v[226:229], v[240:243], v[48:51]
s_add_u32 s62, s62, 33554432
v_lshl_add_u32 v152, v153, 28, v152
s_add_u32 s63, s62, 131072
v_mfma_f32_16x16x32_bf16 v[52:55], v[224:227], v[240:243], v[52:55]
v_cvt_pk_bf16_f32 v128, v32, v33
v_cvt_pk_bf16_f32 v129, v34, v35
s_waitcnt vmcnt(7)
v_mfma_f32_16x16x32_bf16 v[56:59], v[226:229], v[244:247], v[56:59]
v_cvt_pk_bf16_f32 v130, v36, v37
v_cvt_pk_bf16_f32 v131, v38, v39
v_mfma_f32_16x16x32_bf16 v[60:63], v[224:227], v[244:247], v[60:63]
buffer_store_dwordx4 v[128:131], v4, s[16:19], s62 offen sc1
v_cvt_pk_bf16_f32 v132, v40, v41
v_cvt_pk_bf16_f32 v133, v42, v43
v_cvt_pk_bf16_f32 v134, v44, v45
v_cvt_pk_bf16_f32 v135, v46, v47
v_cvt_pk_bf16_f32 v136, v48, v49
v_cvt_pk_bf16_f32 v137, v50, v51
v_cvt_pk_bf16_f32 v138, v52, v53
v_cvt_pk_bf16_f32 v139, v54, v55
v_cvt_pk_bf16_f32 v140, v56, v57
v_cvt_pk_bf16_f32 v141, v58, v59
v_cvt_pk_bf16_f32 v142, v60, v61
v_cvt_pk_bf16_f32 v143, v62, v63
v_pk_mul_f32 v[146:147], v[32:33], v[32:33]
buffer_store_dwordx4 v[132:135], v4, s[16:19], s63 offen sc1
v_pk_mul_f32 v[150:151], v[48:49], v[48:49]
v_pk_fma_f32 v[146:147], v[34:35], v[34:35], v[146:147]
v_pk_add_f32 v[144:145], v[32:33], v[34:35]
v_pk_fma_f32 v[150:151], v[50:51], v[50:51], v[150:151]
v_pk_add_f32 v[148:149], v[48:49], v[50:51]
v_pk_fma_f32 v[146:147], v[36:37], v[36:37], v[146:147]
v_pk_add_f32 v[144:145], v[144:145], v[36:37]
v_pk_fma_f32 v[150:151], v[52:53], v[52:53], v[150:151]
v_pk_add_f32 v[148:149], v[148:149], v[52:53]
v_pk_fma_f32 v[146:147], v[38:39], v[38:39], v[146:147]
v_pk_add_f32 v[144:145], v[144:145], v[38:39]
v_pk_fma_f32 v[150:151], v[54:55], v[54:55], v[150:151]
v_pk_add_f32 v[148:149], v[148:149], v[54:55]
buffer_store_dwordx4 v[136:139], v4, s[16:19], s62 offen offset:1024 sc1
v_pk_fma_f32 v[146:147], v[40:41], v[40:41], v[146:147]
v_pk_add_f32 v[144:145], v[144:145], v[40:41]
v_pk_fma_f32 v[150:151], v[56:57], v[56:57], v[150:151]
v_pk_add_f32 v[148:149], v[148:149], v[56:57]
v_pk_fma_f32 v[146:147], v[42:43], v[42:43], v[146:147]
v_pk_add_f32 v[144:145], v[144:145], v[42:43]
v_pk_fma_f32 v[150:151], v[58:59], v[58:59], v[150:151]
v_pk_add_f32 v[148:149], v[148:149], v[58:59]
v_pk_fma_f32 v[146:147], v[44:45], v[44:45], v[146:147]
v_pk_add_f32 v[144:145], v[144:145], v[44:45]
v_pk_fma_f32 v[150:151], v[60:61], v[60:61], v[150:151]
v_pk_add_f32 v[148:149], v[148:149], v[60:61]
v_pk_fma_f32 v[146:147], v[46:47], v[46:47], v[146:147]
buffer_store_dwordx4 v[140:143], v4, s[16:19], s63 offen offset:1024 sc1
v_pk_add_f32 v[144:145], v[144:145], v[46:47]
v_pk_fma_f32 v[150:151], v[62:63], v[62:63], v[150:151]
v_pk_add_f32 v[148:149], v[148:149], v[62:63]
v_add_f32 v144, v144, v145
v_add_f32 v146, v146, v147
v_add_f32 v148, v148, v149
v_add_f32 v150, v150, v151
s_nop 0
v_permlane16_swap_b32 v144, v148
v_permlane16_swap_b32 v146, v150
v_add_f32 v144, v144, v148
v_add_f32 v146, v146, v150
s_nop 1
v_permlane32_swap_b32 v144, v146
v_add_f32 v144, v144, v146
s_nop 1
v_permlane32_swap_b32 v144, v145
buffer_store_dwordx2 v[144:145], v152, s[16:19], s64 offen sc1
s_nop 1
v_accvgpr_write_b32 a224, v32
v_accvgpr_write_b32 a225, v33
v_accvgpr_write_b32 a226, v34
v_accvgpr_write_b32 a227, v35
v_accvgpr_write_b32 a228, v36
v_accvgpr_write_b32 a229, v37
v_accvgpr_write_b32 a230, v38
v_accvgpr_write_b32 a231, v39
v_accvgpr_write_b32 a232, v40
v_accvgpr_write_b32 a233, v41
v_accvgpr_write_b32 a234, v42
v_accvgpr_write_b32 a235, v43
v_accvgpr_write_b32 a236, v44
v_accvgpr_write_b32 a237, v45
v_accvgpr_write_b32 a238, v46
v_accvgpr_write_b32 a239, v47
v_accvgpr_write_b32 a240, v48
v_accvgpr_write_b32 a241, v49
v_accvgpr_write_b32 a242, v50
v_accvgpr_write_b32 a243, v51
v_accvgpr_write_b32 a244, v52
v_accvgpr_write_b32 a245, v53
v_accvgpr_write_b32 a246, v54
v_accvgpr_write_b32 a247, v55
v_accvgpr_write_b32 a248, v56
v_accvgpr_write_b32 a249, v57
v_accvgpr_write_b32 a250, v58
v_accvgpr_write_b32 a251, v59
v_accvgpr_write_b32 a252, v60
v_accvgpr_write_b32 a253, v61
v_accvgpr_write_b32 a254, v62
v_accvgpr_write_b32 a255, v63
s_lshl_b32 s62, s3, 11
s_add_u32 s62, s62, s85
v_lshl_add_u32 v21, v1, 4, s62
v_lshrrev_b32 v2, 3, v1
v_cmp_eq_u32 vcc, 3, v2
v_add_u32 v2, 67108480, v21
s_nop 0
v_cndmask_b32 v21, v21, v2, vcc
s_sub_u32 s62, s86, 2048
v_lshl_add_u32 v22, v0, 2, s62
v_lshrrev_b32 v2, 5, v0
v_cmp_eq_u32 vcc, 3, v2
v_add_u32 v2, 67108480, v22
s_nop 0
v_cndmask_b32 v22, v22, v2, vcc
s_mul_i32 s62, s48, 4608
v_lshl_add_u32 v23, v1, 4, s62
v_lshrrev_b32 v24, 4, v1
v_mul_u32_u24 v24, 2304, v24
v_and_b32 v2, 15, v1
v_lshl_add_u32 v24, v2, 4, v24
s_mov_b32 s52, 33554432
s_mov_b32 s54, s58
s_mov_b32 s56, s59
s_mul_i32 s55, s3, 2304
v_bfe_u32 v25, v1, 3, 2
v_mul_u32_u24 v25, 3104, v25
v_bfe_u32 v2, v1, 2, 1
v_lshl_add_u32 v25, v2, 7, v25
v_bfe_u32 v2, v1, 5, 1
v_lshl_add_u32 v25, v2, 8, v25
v_and_b32 v2, 3, v1
v_lshl_add_u32 v25, v2, 3, v25
s_lshl_b32 s62, s49, 6
s_add_u32 s62, s62, 67584
v_add_u32 v25, s62, v25
s_lshl_b32 s62, s8, 1
s_add_u32 s62, s62, s3
s_lshr_b32 s63, s50, 2
s_cmp_lt_u32 s3, 2
s_cselect_b32 s62, s62, s63
s_lshl_b32 s62, s62, 13
s_cmp_eq_u32 s3, 3
s_cselect_b32 s62, 268435456, s62
v_lshl_add_u32 v26, v1, 4, s62
s_lshr_b32 s63, s20, 7
s_sub_u32 s63, 3, s63
s_and_b32 s63, s63, 7
s_and_b32 s62, s9, 8
s_add_u32 s63, s63, s62
s_lshl_b32 s62, s5, 2
s_add_u32 s62, s62, s3
s_mul_i32 s62, s62, 12288
s_lshl_b32 s64, s63, 7
s_add_u32 s62, s62, s64
s_xor_b32 s63, s63, s9
s_cmp_lt_u32 s63, 4
s_cselect_b32 s62, s62, 16777216
v_lshrrev_b32 v14, 3, v1
v_min_u32 v14, 5, v14
v_lshl_add_u32 v14, v14, 11, s62
s_mov_b32 s44, 983040
buffer_load_dword v27, v14, s[20:23], s44 offen
s_mov_b32 s44, 2555904
s_mul_i32 s59, s3, 2080
v_bfe_u32 v5, v1, 3, 1
v_lshrrev_b32 v2, 4, v1
v_lshl_add_u32 v5, v2, 3, v5
s_lshl_b32 s62, s3, 1
v_add_u32 v5, s62, v5
v_mul_u32_u24 v5, 2048, v5
v_and_b32 v2, 7, v1
v_lshl_add_u32 v5, v2, 4, v5
s_lshl_b32 s62, s7, 7
v_add_u32 v5, s62, v5
v_add_u32 v6, 64512, v5
s_lshl_b32 s62, s6, 10
s_add_u32 s62, s62, 30474240
s_lshl_b32 s64, s8, 10
s_add_u32 s64, s64, 30474240
s_lshr_b32 s67, s9, 1
s_and_b32 s67, s67, 3
s_lshl_b32 s67, s67, 7
s_add_u32 s64, s64, s67
s_lshr_b32 s65, s50, 3
s_lshl_b32 s65, s65, 10
s_add_u32 s65, s65, 30474240
s_lshr_b32 s67, s9, 1
s_and_b32 s67, s67, 3
s_lshl_b32 s67, s67, 7
s_add_u32 s65, s65, s67
v_lshl_add_u32 v252, v1, 7, s62
v_mov_b32 v253, s64
v_mov_b32 v255, 1
v_writelane_b32 v253, s65, 1
s_waitcnt vmcnt(1) lgkmcnt(0)
s_cmp_lg_u32 s3, 1
s_barrier
s_cbranch_scc1 .Lfirst53
s_mov_b64 exec, 15
buffer_atomic_add v255, v252, s[16:19], 0 offen
s_mov_b64 exec, 3
v_mov_b32 v254, 0
buffer_atomic_add v254, v253, s[16:19], 0 offen sc0
s_mov_b64 exec, -1
.Lfirst53:
TR 20,25,49664
TR 22,25,50176
TR 24,25,49696
TR 26,25,50208
TR 28,25,50688
TR 30,25,51200
TR 32,25,50720
TR 34,25,51232
TR 36,25,51712
TR 38,25,52224
TR 40,25,51744
TR 42,25,52256
v_lshrrev_b32 v2, 4, v1
v_lshlrev_b32 v2, 2, v2
v_and_b32 v13, 15, v1
v_sub_u32 v2, v13, v2
v_mov_b32 v13, 0xff61b1e6
v_subrev_u32 v54, 0, v2
v_cmp_gt_u32 vcc, 8, v54
s_nop 1
v_cndmask_b32 v50, v13, 0, vcc
v_cmp_gt_i32 vcc, -8, v54
s_nop 1
v_cndmask_b32 v46, v13, 0, vcc
v_subrev_u32 v54, 1, v2
v_cmp_gt_u32 vcc, 8, v54
s_nop 1
v_cndmask_b32 v51, v13, 0, vcc
v_cmp_gt_i32 vcc, -8, v54
s_nop 1
v_cndmask_b32 v47, v13, 0, vcc
v_subrev_u32 v54, 2, v2
v_cmp_gt_u32 vcc, 8, v54
s_nop 1
v_cndmask_b32 v52, v13, 0, vcc
v_cmp_gt_i32 vcc, -8, v54
s_nop 1
v_cndmask_b32 v48, v13, 0, vcc
v_subrev_u32 v54, 3, v2
v_cmp_gt_u32 vcc, 8, v54
s_nop 1
v_cndmask_b32 v53, v13, 0, vcc
v_cmp_gt_i32 vcc, -8, v54
s_nop 1
v_cndmask_b32 v49, v13, 0, vcc
s_cmp_lt_u32 s8, 2
s_cselect_b64 vcc, -1, 0
v_cndmask_b32 v54, v46, v13, vcc
v_cndmask_b32 v55, v47, v13, vcc
v_cndmask_b32 v56, v48, v13, vcc
v_cndmask_b32 v57, v49, v13, vcc
v_mov_b64 v[60:61], 0
v_mov_b64 v[62:63], 0
v_mov_b64 v[64:65], 0
v_mov_b64 v[66:67], 0
v_mov_b64 v[68:69], 0
v_mov_b64 v[70:71], 0
v_mov_b64 v[72:73], 0
v_mov_b64 v[74:75], 0
v_mov_b64 v[76:77], 0
v_mov_b64 v[78:79], 0
v_mov_b64 v[80:81], 0
v_mov_b64 v[82:83], 0
v_mov_b64 v[84:85], 0
v_mov_b64 v[86:87], 0
v_mov_b64 v[88:89], 0
v_mov_b64 v[90:91], 0
v_mov_b64 v[92:93], 0
v_mov_b64 v[94:95], 0
v_mov_b64 v[96:97], 0
v_mov_b64 v[98:99], 0
v_mov_b64 v[100:101], 0
v_mov_b64 v[102:103], 0
v_mov_b64 v[104:105], 0
v_mov_b64 v[106:107], 0
v_mov_b64 v[108:109], 0
v_mov_b64 v[110:111], 0
v_mov_b64 v[112:113], 0
v_mov_b64 v[114:115], 0
v_mov_b64 v[116:117], 0
v_mov_b64 v[118:119], 0
v_mov_b64 v[120:121], 0
v_mov_b64 v[122:123], 0
v_mov_b64 v[124:125], 0
v_mov_b64 v[126:127], 0
v_mov_b64 v[128:129], 0
v_mov_b64 v[130:131], 0
v_mov_b64 v[132:133], 0
v_mov_b64 v[134:135], 0
v_mov_b64 v[136:137], 0
v_mov_b64 v[138:139], 0
v_mov_b64 v[140:141], 0
v_mov_b64 v[142:143], 0
v_mov_b64 v[144:145], 0
v_mov_b64 v[146:147], 0
v_mov_b64 v[148:149], 0
v_mov_b64 v[150:151], 0
v_mov_b64 v[152:153], 0
v_mov_b64 v[154:155], 0
v_mov_b64 v[156:157], 0
v_mov_b64 v[158:159], 0
v_mov_b64 v[160:161], 0
v_mov_b64 v[162:163], 0
v_mov_b64 v[164:165], 0
v_mov_b64 v[166:167], 0
v_mov_b64 v[168:169], 0
v_mov_b64 v[170:171], 0
v_mov_b64 v[172:173], 0
v_mov_b64 v[174:175], 0
s_mov_b32 s75, 62914560
v_and_b32 v10, 15, v1
v_lshlrev_b32 v12, 2, v10
v_lshlrev_b32 v10, 4, v10
v_add_u32 v10, 152576, v10
v_lshrrev_b32 v11, 4, v1
v_lshlrev_b32 v11, 4, v11
s_lshl_b32 s62, s49, 7
s_add_u32 s62, s62, 158720
v_add_u32 v12, s62, v12
v_add_u32 v13, s62, v11
v_add_u32 v11, 156672, v11
s_lshl_b32 s62, s3, 11
s_add_u32 s62, s62, 143360
v_lshl_add_u32 v8, v1, 4, s62
v_xor_b32 v9, 2048, v8
v_mov_b32 v248, 0x3f803f80
v_mov_b32 v249, 0x3f803f80
v_mov_b32 v250, 0x3f803f80
v_mov_b32 v251, 0x3f803f80
v_and_b32 v7, 31, v1
v_lshrrev_b32 v2, 5, v1
v_lshl_add_u32 v7, v7, 1, v2
v_and_b32 v2, 0xc0, v0
v_add_u32 v7, v7, v2
v_lshlrev_b32 v17, 2, v7
v_add_u32 v17, 156672, v17
v_lshlrev_b32 v7, 4, v7
v_add_u32 v7, 152576, v7
s_lshl_b32 s74, s9, 1
s_add_u32 s74, s74, s49
s_lshl_b32 s74, s74, 17
s_add_u32 s74, s74, s85
s_lshl_b32 s63, s48, 12
s_add_u32 s74, s74, s63
s_add_u32 s74, s74, 37748736
s_mov_b32 s62, 0
v_lshl_add_u32 v4, v1, 4, s62
v_lshrrev_b32 v2, 3, v1
v_cmp_eq_u32 vcc, 3, v2
v_add_u32 v2, 67108480, v4
s_nop 0
v_cndmask_b32 v4, v4, v2, vcc
ds_read_b128 v[28:31], v13
ds_read_b128 v[32:35], v13 offset:64
ds_read_b128 v[36:39], v13 offset:256
ds_read_b128 v[40:43], v13 offset:320
ds_read_b32 v44, v12 offset:512
ds_read_b32 v45, v12 offset:576
s_waitcnt lgkmcnt(0)
s_cmp_lg_u32 s3, 1
s_cbranch_scc1 .Lnopoll52
s_mov_b64 exec, 3
s_mov_b32 s15, 0
.Lpoll51:
v_mov_b32 v255, 0
buffer_atomic_add v255, v253, s[16:19], 0 offen sc0
s_waitcnt vmcnt(1)
v_cmp_gt_u32 vcc, 16, v254
s_add_u32 s15, s15, 1
s_cbranch_vccz .Lnopoll52r
v_mov_b32 v254, 0
buffer_atomic_add v254, v253, s[16:19], 0 offen sc0
s_waitcnt vmcnt(1)
v_cmp_gt_u32 vcc, 16, v255
s_add_u32 s15, s15, 1
s_cbranch_vccz .Lnopoll52r
s_cmp_le_u32 s15, 100000
s_cbranch_scc1 .Lpoll51
s_branch .Lnopoll52r
.Lnopoll52:
s_mov_b64 exec, 0
s_cmp_eq_u32 s3, 2
s_cbranch_scc1 .Lpad12
s_cmp_eq_u32 s3, 3
s_cbranch_scc1 .Lpad13
s_branch .Lpad14
.Lnopoll52r:
s_mov_b64 exec, -1
s_barrier
s_cmp_eq_u32 s48, 1
s_cbranch_scc1 .Lqkv54
s_add_u32 m0, s55, 36864
s_nop 0
buffer_load_dwordx4 v21, s[16:19], s52 offen sc1 lds
buffer_load_dwordx4 v21, s[16:19], s52 offen offset:1024 sc1 lds
buffer_load_dword v22, s[16:19], s52 offen offset:2048 sc1 lds
s_add_u32 s52, s52, 131072
s_add_u32 m0, s55, 46080
s_nop 0
buffer_load_dwordx4 v21, s[16:19], s52 offen sc1 lds
buffer_load_dwordx4 v21, s[16:19], s52 offen offset:1024 sc1 lds
buffer_load_dword v22, s[16:19], s52 offen offset:2048 sc1 lds
s_add_u32 s52, s52, 131072
s_add_u32 m0, s55, 0
s_nop 0
buffer_load_dwordx4 v21, s[16:19], s52 offen sc1 lds
buffer_load_dwordx4 v21, s[16:19], s52 offen offset:1024 sc1 lds
buffer_load_dword v22, s[16:19], s52 offen offset:2048 sc1 lds
s_add_u32 s52, s52, 131072
s_add_u32 m0, s55, 9216
s_nop 0
buffer_load_dwordx4 v21, s[16:19], s52 offen sc1 lds
buffer_load_dwordx4 v21, s[16:19], s52 offen offset:1024 sc1 lds
buffer_load_dword v22, s[16:19], s52 offen offset:2048 sc1 lds
s_add_u32 s52, s52, 131072
s_add_u32 m0, s55, 18432
s_nop 0
buffer_load_dwordx4 v21, s[16:19], s52 offen sc1 lds
buffer_load_dwordx4 v21, s[16:19], s52 offen offset:1024 sc1 lds
buffer_load_dword v22, s[16:19], s52 offen offset:2048 sc1 lds
s_add_u32 s52, s52, 131072
s_waitcnt vmcnt(12)
s_barrier
RD 0,23,36864
RD 4,23,37888
RD 8,23,39168
RD 12,23,40192
RD 16,24,38912
s_waitcnt lgkmcnt(0)
s_mov_b32 s15, -4
.p2align 6
.Lk56:
s_waitcnt vmcnt(9) lgkmcnt(8)
s_barrier
MAA 60,20,0
RD 44,23,46080
s_add_u32 m0, s56, 104832
MAA 76,24,0
buffer_load_dwordx4 v18, s[20:23], s54 offen lds
MAA 80,24,4
RD 48,23,47104
v_add_f32 v164, v164, v168
MAA 64,20,4
RD 52,23,48384
MAA 68,20,8
buffer_load_dwordx4 v19, s[20:23], s54 offen offset:1024 lds
MAA 84,24,8
RD 56,23,49408
MAA 88,24,12
TR 64,25,62080
v_add_f32 v165, v165, v169
MAA 72,20,12
TR 66,25,62592
s_waitcnt lgkmcnt(6)
MAA 104,28,12
buffer_load_dwordx4 v20, s[20:23], s54 offen offset:2048 lds
MAA 120,32,12
TR 68,25,62112
s_add_u32 s54, s54, 196608
MAA 116,32,8
TR 70,25,62624
s_add_u32 m0, s55, 27648
MAA 100,28,8
buffer_load_dwordx4 v21, s[16:19], s52 offen sc1 lds
MAA 96,28,4
RD 60,24,48128
MAA 112,32,4
.Lpad12:
s_cbranch_execz .Lpad15
TR 72,25,63104
MAA 108,32,0
buffer_load_dwordx4 v21, s[16:19], s52 offen offset:1024 sc1 lds
MAA 92,28,0
TR 74,25,63616
v_add_f32 v166, v166, v170
MAA 156,28,16
TR 76,25,63136
MAA 160,32,16
TR 78,25,63648
MAA 124,0,36
buffer_load_dword v22, s[16:19], s52 offen offset:2048 sc1 lds
MAA 140,0,40
TR 80,25,64128
s_add_u32 s52, s52, 131072
MAA 144,4,40
TR 82,25,64640
v_add_f32 v167, v167, v171
MAA 128,4,36
buffer_load_dword v27, v14, s[20:23], s44 offen
MAA 132,8,36
TR 84,25,64160
s_add_u32 s44, s44, 1572864
MAA 148,8,40
TR 86,25,64672
MAA 152,12,40
MAA 136,12,36
s_waitcnt vmcnt(13) lgkmcnt(8)
s_barrier
MAA 60,64,44
ds_read_b128 a[0:3], v23
s_add_u32 m0, s56, 117248
MAA 76,68,44
buffer_load_dwordx4 v18, s[20:23], s54 offen lds
MAA 80,68,48
RD 4,23,1024
MAA 64,64,48
RD 8,23,2304
MAA 68,64,52
buffer_load_dwordx4 v19, s[20:23], s54 offen offset:1024 lds
MAA 84,68,52
RD 12,23,3328
MAA 88,68,56
ds_read_b64_tr_b16 a[20:21], v25
MAA 72,64,56
TR 22,25,512
s_waitcnt lgkmcnt(6)
MAA 104,72,56
buffer_load_dwordx4 v20, s[20:23], s54 offen offset:2048 lds
MAA 120,76,56
TR 24,25,32
s_add_u32 s54, s54, 196608
MAA 116,76,52
TR 26,25,544
s_add_u32 m0, s55, 36864
MAA 100,72,52
buffer_load_dwordx4 v21, s[16:19], s52 offen sc1 lds
MAA 96,72,48
RD 16,24,2048
MAA 112,76,48
TR 28,25,1024
MAA 108,76,44
buffer_load_dwordx4 v21, s[16:19], s52 offen offset:1024 sc1 lds
MAA 92,72,44
TR 30,25,1536
MAA 156,72,60
TR 32,25,1056
MAA 160,76,60
TR 34,25,1568
MAA 124,44,80
buffer_load_dword v22, s[16:19], s52 offen offset:2048 sc1 lds
MAA 140,44,84
TR 36,25,2048
s_add_u32 s52, s52, 131072
MAA 144,48,84
TR 38,25,2560
MAA 128,48,80
buffer_load_dwordx4 v[168:171], v26, s[16:19], s75 offen sc1
MAA 132,52,80
TR 40,25,2080
MAA 148,52,84
TR 42,25,2592
MAA 152,56,84
MAA 136,56,80
s_waitcnt vmcnt(17) lgkmcnt(8)
s_barrier
MAA 60,20,0
RD 44,23,9216
s_add_u32 m0, s56, 129664
MAA 76,24,0
buffer_load_dwordx4 v18, s[20:23], s54 offen lds
MAA 80,24,4
RD 48,23,10240
MAA 64,20,4
RD 52,23,11520
MAA 68,20,8
RD 56,23,12544
MAA 84,24,8
buffer_load_dwordx4 v19, s[20:23], s54 offen offset:1024 lds
MAA 88,24,12
TR 64,25,12416
MAA 72,20,12
TR 66,25,12928
s_waitcnt lgkmcnt(6)
MAA 104,28,12
TR 68,25,12448
MAA 120,32,12
buffer_load_dwordx4 v20, s[20:23], s54 offen offset:2048 lds
MAA 116,32,8
TR 70,25,12960
s_add_u32 s54, s54, 196608
MAA 100,28,8
RD 60,24,11264
MAA 96,28,4
s_add_u32 m0, s55, 46080
MAA 112,32,4
buffer_load_dwordx4 v21, s[16:19], s52 offen sc1 lds
MAA 108,32,0
TR 72,25,13440
MAA 92,28,0
TR 74,25,13952
MAA 156,28,16
TR 76,25,13472
MAA 160,32,16
buffer_load_dwordx4 v21, s[16:19], s52 offen offset:1024 sc1 lds
MAA 124,0,36
TR 78,25,13984
MAA 140,0,40
TR 80,25,14464
MAA 144,4,40
TR 82,25,14976
MAA 128,4,36
buffer_load_dword v22, s[16:19], s52 offen offset:2048 sc1 lds
MAA 132,8,36
TR 84,25,14496
s_add_u32 s52, s52, 131072
MAA 148,8,40
TR 86,25,15008
MAA 152,12,40
MAA 136,12,36
s_waitcnt vmcnt(20) lgkmcnt(8)
s_barrier
MAA 60,64,44
RD 0,23,18432
s_add_u32 m0, s56, 67584
MAA 76,68,44
buffer_load_dwordx4 v18, s[20:23], s54 offen lds
MAA 80,68,48
RD 4,23,19456
v_add_f32 v164, v164, v172
MAA 64,64,48
RD 8,23,20736
MAA 68,64,52
RD 12,23,21760
MAA 84,68,52
buffer_load_dwordx4 v19, s[20:23], s54 offen offset:1024 lds
MAA 88,68,56
TR 20,25,24832
MAA 72,64,56
TR 22,25,25344
s_waitcnt lgkmcnt(6)
MAA 104,72,56
TR 24,25,24864
v_add_f32 v165, v165, v173
MAA 120,76,56
buffer_load_dwordx4 v20, s[20:23], s54 offen offset:2048 lds
MAA 116,76,52
TR 26,25,25376
s_add_u32 s54, s54, 196608
MAA 100,72,52
RD 16,24,20480
MAA 96,72,48
s_add_u32 m0, s55, 0
MAA 112,76,48
buffer_load_dwordx4 v21, s[16:19], s52 offen sc1 lds
MAA 108,76,44
TR 28,25,25856
v_add_f32 v166, v166, v174
MAA 92,72,44
TR 30,25,26368
MAA 156,72,60
TR 32,25,25888
MAA 160,76,60
buffer_load_dwordx4 v21, s[16:19], s52 offen offset:1024 sc1 lds
MAA 124,44,80
TR 34,25,26400
MAA 140,44,84
TR 36,25,26880
v_add_f32 v167, v167, v175
MAA 144,48,84
TR 38,25,27392
MAA 128,48,80
buffer_load_dword v22, s[16:19], s52 offen offset:2048 sc1 lds
MAA 132,52,80
TR 40,25,26912
s_add_u32 s52, s52, 131072
MAA 148,52,84
TR 42,25,27424
MAA 152,56,84
MAA 136,56,80
s_waitcnt vmcnt(20) lgkmcnt(8)
s_barrier
MAA 60,20,0
RD 44,23,27648
s_add_u32 m0, s56, 80000
MAA 76,24,0
buffer_load_dwordx4 v18, s[20:23], s54 offen lds
MAA 80,24,4
RD 48,23,28672
MAA 64,20,4
RD 52,23,29952
MAA 68,20,8
buffer_load_dwordx4 v19, s[20:23], s54 offen offset:1024 lds
MAA 84,24,8
RD 56,23,30976
MAA 88,24,12
TR 64,25,37248
MAA 72,20,12
TR 66,25,37760
s_waitcnt lgkmcnt(6)
MAA 104,28,12
buffer_load_dwordx4 v20, s[20:23], s54 offen offset:2048 lds
MAA 120,32,12
TR 68,25,37280
s_add_u32 s54, s54, 196608
MAA 116,32,8
TR 70,25,37792
s_add_u32 m0, s55, 9216
MAA 100,28,8
buffer_load_dwordx4 v21, s[16:19], s52 offen sc1 lds
MAA 96,28,4
RD 60,24,29696
MAA 112,32,4
TR 72,25,38272
MAA 108,32,0
buffer_load_dwordx4 v21, s[16:19], s52 offen offset:1024 sc1 lds
MAA 92,28,0
TR 74,25,38784
MAA 156,28,16
TR 76,25,38304
MAA 160,32,16
TR 78,25,38816
MAA 124,0,36
buffer_load_dword v22, s[16:19], s52 offen offset:2048 sc1 lds
MAA 140,0,40
TR 80,25,39296
s_add_u32 s52, s52, 131072
MAA 144,4,40
TR 82,25,39808
MAA 128,4,36
buffer_load_dwordx4 v[172:175], v26, s[16:19], s75 offen offset:1024 sc1
MAA 132,8,36
TR 84,25,39328
s_add_u32 s75, s75, 2048
MAA 148,8,40
TR 86,25,39840
MAA 152,12,40
MAA 136,12,36
s_waitcnt vmcnt(20) lgkmcnt(8)
s_barrier
MAA 60,64,44
RD 0,23,36864
s_add_u32 m0, s56, 92416
MAA 76,68,44
buffer_load_dwordx4 v18, s[20:23], s54 offen lds
MAA 80,68,48
RD 4,23,37888
MAA 64,64,48
RD 8,23,39168
MAA 68,64,52
RD 12,23,40192
MAA 84,68,52
buffer_load_dwordx4 v19, s[20:23], s54 offen offset:1024 lds
MAA 88,68,56
TR 20,25,49664
MAA 72,64,56
TR 22,25,50176
s_waitcnt lgkmcnt(6)
MAA 104,72,56
TR 24,25,49696
MAA 120,76,56
buffer_load_dwordx4 v20, s[20:23], s54 offen offset:2048 lds
MAA 116,76,52
TR 26,25,50208
s_add_u32 s54, s54, 196608
MAA 100,72,52
RD 16,24,38912
MAA 96,72,48
s_add_u32 m0, s55, 18432
MAA 112,76,48
buffer_load_dwordx4 v21, s[16:19], s52 offen sc1 lds
MAA 108,76,44
TR 28,25,50688
MAA 92,72,44
TR 30,25,51200
MAA 156,72,60
TR 32,25,50720
MAA 160,76,60
buffer_load_dwordx4 v21, s[16:19], s52 offen offset:1024 sc1 lds
MAA 124,44,80
TR 34,25,51232
MAA 140,44,84
TR 36,25,51712
MAA 144,48,84
TR 38,25,52224
MAA 128,48,80
buffer_load_dword v22, s[16:19], s52 offen offset:2048 sc1 lds
MAA 132,52,80
TR 40,25,51744
s_add_u32 s52, s52, 131072
MAA 148,52,84
TR 42,25,52256
MAA 152,56,84
s_add_u32 s15, s15, 1
MAA 136,56,80
s_cbranch_scc0 .Lk56
s_waitcnt vmcnt(19) lgkmcnt(8)
s_barrier
MAA 60,20,0
RD 44,23,46080
s_add_u32 m0, s56, 104832
MAA 76,24,0
buffer_load_dwordx4 v18, s[20:23], s54 offen lds
MAA 80,24,4
RD 48,23,47104
v_add_f32 v164, v164, v168
MAA 64,20,4
RD 52,23,48384
v_add_f32 v165, v165, v169
MAA 68,20,8
RD 56,23,49408
v_add_f32 v166, v166, v170
MAA 84,24,8
buffer_load_dwordx4 v19, s[20:23], s54 offen offset:1024 lds
MAA 88,24,12
TR 64,25,62080
v_add_f32 v167, v167, v171
MAA 72,20,12
TR 66,25,62592
s_waitcnt lgkmcnt(6)
MAA 104,28,12
TR 68,25,62112
MAA 120,32,12
buffer_load_dwordx4 v20, s[20:23], s54 offen offset:2048 lds
MAA 116,32,8
TR 70,25,62624
s_add_u32 s54, s54, 196608
MAA 100,28,8
RD 60,24,48128
s_add_u32 m0, s55, 27648
MAA 96,28,4
TR 72,25,63104
MAA 112,32,4
buffer_load_dwordx4 v21, s[16:19], s52 offen sc1 lds
MAA 108,32,0
TR 74,25,63616
MAA 92,28,0
TR 76,25,63136
MAA 156,28,16
TR 78,25,63648
MAA 160,32,16
buffer_load_dwordx4 v21, s[16:19], s52 offen offset:1024 sc1 lds
MAA 124,0,36
TR 80,25,64128
MAA 140,0,40
TR 82,25,64640
MAA 144,4,40
TR 84,25,64160
MAA 128,4,36
buffer_load_dword v22, s[16:19], s52 offen offset:2048 sc1 lds
MAA 132,8,36
TR 86,25,64672
s_add_u32 s52, s52, 131072
MAA 148,8,40
MAA 152,12,40
MAA 136,12,36
s_waitcnt vmcnt(19) lgkmcnt(8)
s_barrier
MAA 60,64,44
ds_read_b128 a[0:3], v23
s_add_u32 m0, s56, 117248
MAA 76,68,44
buffer_load_dwordx4 v18, s[20:23], s54 offen lds
MAA 80,68,48
RD 4,23,1024
MAA 64,64,48
RD 8,23,2304
MAA 68,64,52
RD 12,23,3328
MAA 84,68,52
buffer_load_dwordx4 v19, s[20:23], s54 offen offset:1024 lds
MAA 88,68,56
ds_read_b64_tr_b16 a[20:21], v25
MAA 72,64,56
TR 22,25,512
s_waitcnt lgkmcnt(6)
MAA 104,72,56
TR 24,25,32
MAA 120,76,56
buffer_load_dwordx4 v20, s[20:23], s54 offen offset:2048 lds
MAA 116,76,52
TR 26,25,544
s_add_u32 s54, s54, 196608
MAA 100,72,52
RD 16,24,2048
MAA 96,72,48
s_add_u32 m0, s55, 36864
MAA 112,76,48
buffer_load_dwordx4 v21, s[16:19], s52 offen sc1 lds
MAA 108,76,44
TR 28,25,1024
MAA 92,72,44
TR 30,25,1536
MAA 156,72,60
TR 32,25,1056
MAA 160,76,60
buffer_load_dwordx4 v21, s[16:19], s52 offen offset:1024 sc1 lds
MAA 124,44,80
TR 34,25,1568
MAA 140,44,84
TR 36,25,2048
MAA 144,48,84
TR 38,25,2560
MAA 128,48,80
buffer_load_dword v22, s[16:19], s52 offen offset:2048 sc1 lds
MAA 132,52,80
TR 40,25,2080
s_add_u32 s52, s52, 131072
MAA 148,52,84
TR 42,25,2592
MAA 152,56,84
MAA 136,56,80
s_waitcnt vmcnt(19) lgkmcnt(8)
s_barrier
MAA 60,20,0
RD 44,23,9216
s_add_u32 m0, s56, 129664
MAA 76,24,0
buffer_load_dwordx4 v18, s[20:23], s54 offen lds
MAA 80,24,4
RD 48,23,10240
s_waitcnt vmcnt(19)
v_add_f32 v164, v164, v172
MAA 64,20,4
RD 52,23,11520
v_add_f32 v165, v165, v173
MAA 68,20,8
RD 56,23,12544
v_add_f32 v166, v166, v174
MAA 84,24,8
buffer_load_dwordx4 v19, s[20:23], s54 offen offset:1024 lds
MAA 88,24,12
TR 64,25,12416
v_add_f32 v167, v167, v175
MAA 72,20,12
TR 66,25,12928
s_waitcnt lgkmcnt(6)
MAA 104,28,12
TR 68,25,12448
MAA 120,32,12
buffer_load_dwordx4 v20, s[20:23], s54 offen offset:2048 lds
MAA 116,32,8
TR 70,25,12960
s_add_u32 s54, s54, 196608
MAA 100,28,8
RD 60,24,11264
s_add_u32 m0, s55, 46080
MAA 96,28,4
TR 72,25,13440
MAA 112,32,4
buffer_load_dwordx4 v21, s[16:19], s52 offen sc1 lds
MAA 108,32,0
TR 74,25,13952
MAA 92,28,0
TR 76,25,13472
MAA 156,28,16
TR 78,25,13984
MAA 160,32,16
buffer_load_dwordx4 v21, s[16:19], s52 offen offset:1024 sc1 lds
MAA 124,0,36
TR 80,25,14464
MAA 140,0,40
TR 82,25,14976
MAA 144,4,40
TR 84,25,14496
MAA 128,4,36
buffer_load_dword v22, s[16:19], s52 offen offset:2048 sc1 lds
MAA 132,8,36
TR 86,25,15008
s_add_u32 s52, s52, 131072
MAA 148,8,40
v_permlane32_swap_b32 v164, v166
MAA 152,12,40
v_permlane32_swap_b32 v165, v167
MAA 136,12,36
s_waitcnt vmcnt(18) lgkmcnt(8)
s_barrier
MAA 60,64,44
RD 0,23,18432
s_add_u32 m0, s59, 0
MAA 76,68,44
RD 4,23,19456
s_mov_b32 s58, 1048576
MAA 80,68,48
buffer_load_dwordx4 v5, s[24:27], s58 offen lds
MAA 64,64,48
RD 8,23,20736
v_add_f32 v164, v164, v166
MAA 68,64,52
RD 12,23,21760
v_add_f32 v165, v165, v167
MAA 84,68,52
TR 20,25,24832
v_mul_f32 v164, 0xba800000, v164
MAA 88,68,56
buffer_load_dwordx4 v6, s[24:27], s58 offen offset:1024 lds
MAA 72,64,56
TR 22,25,25344
s_add_u32 m0, s59, 58240
s_waitcnt lgkmcnt(6)
MAA 104,72,56
TR 24,25,24864
s_mov_b32 s58, 1966080
MAA 120,76,56
TR 26,25,25376
v_mul_f32 v165, 0x3a800000, v165
MAA 116,76,52
buffer_load_dwordx4 v5, s[24:27], s58 offen lds
MAA 100,72,52
RD 16,24,20480
v_fma_f32 v165, -v164, v164, v165
MAA 96,72,48
TR 28,25,25856
v_max_f32 v165, 0, v165
MAA 112,76,48
TR 30,25,26368
v_add_f32 v165, 0x3727c5ac, v165
.Lpad13:
s_cbranch_execz .Lpad16
MAA 108,76,44
buffer_load_dwordx4 v6, s[24:27], s58 offen offset:1024 lds
MAA 92,72,44
TR 32,25,25888
s_add_u32 m0, s59, 66560
MAA 156,72,60
TR 34,25,26400
s_mov_b32 s58, 0
MAA 160,76,60
TR 36,25,26880
MAA 124,44,80
buffer_load_dwordx4 v5, s[24:27], s58 offen lds
MAA 140,44,84
TR 38,25,27392
MAA 144,48,84
TR 40,25,26912
MAA 128,48,80
TR 42,25,27424
MAA 132,52,80
buffer_load_dwordx4 v6, s[24:27], s58 offen offset:1024 lds
MAA 148,52,84
v_rsq_f32 v166, v165
MAA 152,56,84
MAA 136,56,80
s_waitcnt vmcnt(18) lgkmcnt(8)
s_barrier
MAA 60,20,0
RD 44,23,27648
s_add_u32 m0, s59, 8320
MAA 76,24,0
RD 48,23,28672
s_mov_b32 s58, 1179648
MAA 80,24,4
buffer_load_dwordx4 v5, s[24:27], s58 offen lds
MAA 64,20,4
RD 52,23,29952
v_mov_b32 v165, v166
MAA 68,20,8
RD 56,23,30976
v_mul_f32 v166, 0x3e8293ee, v166
MAA 84,24,8
ds_write_b128 v7, v[164:167]
MAA 88,24,12
buffer_load_dwordx4 v6, s[24:27], s58 offen offset:1024 lds
MAA 72,20,12
TR 64,25,37248
s_add_u32 m0, s59, 74880
s_waitcnt lgkmcnt(6)
MAA 104,28,12
TR 66,25,37760
s_mov_b32 s58, 131072
MAA 120,32,12
TR 68,25,37280
MAA 116,32,8
buffer_load_dwordx4 v5, s[24:27], s58 offen lds
MAA 100,28,8
TR 70,25,37792
MAA 96,28,4
RD 60,24,29696
MAA 112,32,4
TR 72,25,38272
MAA 108,32,0
buffer_load_dwordx4 v6, s[24:27], s58 offen offset:1024 lds
MAA 92,28,0
TR 74,25,38784
s_add_u32 m0, s59, 83200
MAA 156,28,16
TR 76,25,38304
s_mov_b32 s58, 262144
MAA 160,32,16
TR 78,25,38816
MAA 124,0,36
buffer_load_dwordx4 v5, s[24:27], s58 offen lds
MAA 140,0,40
TR 80,25,39296
MAA 144,4,40
TR 82,25,39808
MAA 128,4,36
TR 84,25,39328
MAA 132,8,36
buffer_load_dwordx4 v6, s[24:27], s58 offen offset:1024 lds
MAA 148,8,40
TR 86,25,39840
MAA 152,12,40
MAA 136,12,36
s_waitcnt vmcnt(18) lgkmcnt(8)
s_barrier
MAA 60,64,44
ds_write_b32 v17, v164
s_add_u32 m0, s59, 16640
MAA 76,68,44
ds_write_b32 v17, v165 offset:1024
s_mov_b32 s58, 1310720
MAA 80,68,48
buffer_load_dwordx4 v5, s[24:27], s58 offen lds
MAA 64,64,48
RD 0,23,36864
MAA 68,64,52
RD 4,23,37888
MAA 84,68,52
RD 8,23,39168
MAA 88,68,56
RD 12,23,40192
MAA 72,64,56
TR 20,25,49664
s_waitcnt lgkmcnt(7)
MAA 104,72,56
buffer_load_dwordx4 v6, s[24:27], s58 offen offset:1024 lds
MAA 120,76,56
TR 22,25,50176
s_add_u32 m0, s59, 91520
MAA 116,76,52
TR 24,25,49696
s_mov_b32 s58, 393216
MAA 100,72,52
TR 26,25,50208
MAA 96,72,48
RD 16,24,38912
MAA 112,76,48
TR 28,25,50688
MAA 108,76,44
buffer_load_dwordx4 v5, s[24:27], s58 offen lds
MAA 92,72,44
TR 30,25,51200
MAA 156,72,60
TR 32,25,50720
MAA 160,76,60
TR 34,25,51232
MAA 124,44,80
TR 36,25,51712
MAA 140,44,84
TR 38,25,52224
MAA 144,48,84
buffer_load_dwordx4 v6, s[24:27], s58 offen offset:1024 lds
MAA 128,48,80
TR 40,25,51744
MAA 132,52,80
TR 42,25,52256
MAA 148,52,84
MAA 152,56,84
MAA 136,56,80
s_waitcnt vmcnt(16) lgkmcnt(8)
s_barrier
MAA 60,20,0
RD 44,23,46080
s_add_u32 m0, s59, 24960
MAA 76,24,0
RD 48,23,47104
s_mov_b32 s58, 1441792
MAA 80,24,4
buffer_load_dwordx4 v5, s[24:27], s58 offen lds
MAA 64,20,4
RD 52,23,48384
MAA 68,20,8
RD 56,23,49408
MAA 84,24,8
TR 64,25,62080
MAA 88,24,12
buffer_load_dwordx4 v6, s[24:27], s58 offen offset:1024 lds
MAA 72,20,12
TR 66,25,62592
s_add_u32 m0, s59, 99840
s_waitcnt lgkmcnt(6)
MAA 104,28,12
TR 68,25,62112
s_mov_b32 s58, 524288
MAA 120,32,12
TR 70,25,62624
MAA 116,32,8
buffer_load_dwordx4 v5, s[24:27], s58 offen lds
MAA 100,28,8
RD 60,24,48128
MAA 96,28,4
TR 72,25,63104
MAA 112,32,4
TR 74,25,63616
MAA 108,32,0
buffer_load_dwordx4 v6, s[24:27], s58 offen offset:1024 lds
MAA 92,28,0
TR 76,25,63136
s_add_u32 m0, s59, 108160
MAA 156,28,16
TR 78,25,63648
s_mov_b32 s58, 655360
MAA 160,32,16
TR 80,25,64128
MAA 124,0,36
buffer_load_dwordx4 v5, s[24:27], s58 offen lds
MAA 140,0,40
TR 82,25,64640
MAA 144,4,40
TR 84,25,64160
MAA 128,4,36
TR 86,25,64672
MAA 132,8,36
buffer_load_dwordx4 v6, s[24:27], s58 offen offset:1024 lds
MAA 148,8,40
MAA 152,12,40
MAA 136,12,36
s_waitcnt lgkmcnt(0)
s_barrier
MAA 156,72,60
ds_read_b128 v[232:235], v10 offset:768
s_add_u32 m0, s59, 33280
MAA 160,76,60
ds_read_b128 v[236:239], v10 offset:2816
s_mov_b32 s58, 1572864
MAA 104,72,56
ds_read_b128 v[228:231], v10 offset:512
MAA 120,76,56
ds_read_b128 v[224:227], v10 offset:256
MAA 136,56,80
ds_read_b128 v[220:223], v10
MAA 152,56,84
ds_read_b128 v[240:243], v11 offset:192
MAA 100,72,52
ds_read_b128 v[244:247], v11 offset:1216
MAA 116,76,52
buffer_load_dwordx4 v5, s[24:27], s58 offen lds
MAA 96,72,48
ds_read_b128 v[18:21], v11 offset:128
ds_read_b128 v[22:25], v11 offset:1152
s_waitcnt lgkmcnt(8)
v_pk_fma_f32 v[104:105], v[36:37], v[232:233], v[104:105] op_sel_hi:[1,0,1]
v_pk_mul_f32 v[104:105], v[104:105], v[232:233] op_sel:[0,1] op_sel_hi:[1,1]
v_pk_fma_f32 v[106:107], v[38:39], v[232:233], v[106:107] op_sel_hi:[1,0,1]
v_pk_mul_f32 v[106:107], v[106:107], v[232:233] op_sel:[0,1] op_sel_hi:[1,1]
v_pk_fma_f32 v[120:121], v[40:41], v[232:233], v[120:121] op_sel_hi:[1,0,1]
v_pk_mul_f32 v[120:121], v[120:121], v[232:233] op_sel:[0,1] op_sel_hi:[1,1]
v_pk_fma_f32 v[122:123], v[42:43], v[232:233], v[122:123] op_sel_hi:[1,0,1]
v_pk_mul_f32 v[122:123], v[122:123], v[232:233] op_sel:[0,1] op_sel_hi:[1,1]
s_waitcnt lgkmcnt(6)
v_pk_fma_f32 v[100:101], v[36:37], v[228:229], v[100:101] op_sel_hi:[1,0,1]
v_pk_mul_f32 v[100:101], v[100:101], v[228:229] op_sel:[0,1] op_sel_hi:[1,1]
v_pk_fma_f32 v[102:103], v[38:39], v[228:229], v[102:103] op_sel_hi:[1,0,1]
v_pk_mul_f32 v[102:103], v[102:103], v[228:229] op_sel:[0,1] op_sel_hi:[1,1]
v_pk_fma_f32 v[116:117], v[40:41], v[228:229], v[116:117] op_sel_hi:[1,0,1]
v_pk_mul_f32 v[116:117], v[116:117], v[228:229] op_sel:[0,1] op_sel_hi:[1,1]
s_waitcnt lgkmcnt(3)
v_pk_fma_f32 v[136:137], v[240:241], v[44:45], v[136:137] op_sel_hi:[1,0,1]
v_pk_fma_f32 v[138:139], v[242:243], v[44:45], v[138:139] op_sel_hi:[1,0,1]
v_pk_fma_f32 v[152:153], v[240:241], v[44:45], v[152:153] op_sel:[0,1,0] op_sel_hi:[1,1,1]
v_pk_fma_f32 v[154:155], v[242:243], v[44:45], v[154:155] op_sel:[0,1,0] op_sel_hi:[1,1,1]
s_waitcnt lgkmcnt(2)
v_pk_mul_f32 v[136:137], v[136:137], v[244:245]
v_pk_mul_f32 v[138:139], v[138:139], v[246:247]
v_pk_mul_f32 v[152:153], v[152:153], v[244:245]
v_pk_mul_f32 v[154:155], v[154:155], v[246:247]
v_pk_fma_f32 v[118:119], v[42:43], v[228:229], v[118:119] op_sel_hi:[1,0,1]
v_pk_mul_f32 v[118:119], v[118:119], v[228:229] op_sel:[0,1] op_sel_hi:[1,1]
v_pk_fma_f32 v[96:97], v[36:37], v[224:225], v[96:97] op_sel_hi:[1,0,1]
v_pk_mul_f32 v[96:97], v[96:97], v[224:225] op_sel:[0,1] op_sel_hi:[1,1]
v_pk_fma_f32 v[98:99], v[38:39], v[224:225], v[98:99] op_sel_hi:[1,0,1]
v_pk_mul_f32 v[98:99], v[98:99], v[224:225] op_sel:[0,1] op_sel_hi:[1,1]
v_pk_fma_f32 v[156:157], v[36:37], v[236:237], v[156:157] op_sel_hi:[1,0,1]
v_pk_mul_f32 v[156:157], v[156:157], v[236:237] op_sel:[0,1] op_sel_hi:[1,1]
v_pk_fma_f32 v[158:159], v[38:39], v[236:237], v[158:159] op_sel_hi:[1,0,1]
v_pk_mul_f32 v[158:159], v[158:159], v[236:237] op_sel:[0,1] op_sel_hi:[1,1]
v_pk_fma_f32 v[160:161], v[40:41], v[236:237], v[160:161] op_sel_hi:[1,0,1]
v_pk_mul_f32 v[160:161], v[160:161], v[236:237] op_sel:[0,1] op_sel_hi:[1,1]
v_pk_fma_f32 v[162:163], v[42:43], v[236:237], v[162:163] op_sel_hi:[1,0,1]
v_pk_mul_f32 v[162:163], v[162:163], v[236:237] op_sel:[0,1] op_sel_hi:[1,1]
v_cvt_pk_bf16_f32 v196, v104, v105
v_cvt_pk_bf16_f32 v197, v106, v107
MAA 112,76,48
buffer_load_dwordx4 v6, s[24:27], s58 offen offset:1024 lds
MAA 92,72,44
ds_read_b128 v[240:243], v11 offset:64
v_cvt_pk_bf16_f32 v198, v120, v121
MAA 108,76,44
ds_read_b128 v[244:247], v11 offset:1088
v_cvt_pk_bf16_f32 v199, v122, v123
MAA 72,64,56
ds_write_b128 v8, v[196:199]
v_cvt_pk_bf16_f32 v208, v136, v137
MAA 88,68,56
s_add_u32 m0, s59, 41600
v_cvt_pk_bf16_f32 v209, v138, v139
v_cvt_pk_bf16_f32 v218, v152, v153
v_cvt_pk_bf16_f32 v219, v154, v155
ds_write_b64 v8, v[208:209] offset:1024
v_pk_fma_f32 v[72:73], v[28:29], v[232:233], v[72:73] op_sel_hi:[1,0,1]
v_pk_fma_f32 v[74:75], v[30:31], v[232:233], v[74:75] op_sel_hi:[1,0,1]
s_nop 0
v_pk_fma_f32 v[88:89], v[32:33], v[232:233], v[88:89] op_sel_hi:[1,0,1]
v_pk_fma_f32 v[90:91], v[34:35], v[232:233], v[90:91] op_sel_hi:[1,0,1]
v_pk_fma_f32 v[112:113], v[40:41], v[224:225], v[112:113] op_sel_hi:[1,0,1]
v_pk_mul_f32 v[112:113], v[112:113], v[224:225] op_sel:[0,1] op_sel_hi:[1,1]
v_pk_fma_f32 v[114:115], v[42:43], v[224:225], v[114:115] op_sel_hi:[1,0,1]
v_pk_mul_f32 v[114:115], v[114:115], v[224:225] op_sel:[0,1] op_sel_hi:[1,1]
v_pk_fma_f32 v[92:93], v[36:37], v[220:221], v[92:93] op_sel_hi:[1,0,1]
v_pk_mul_f32 v[92:93], v[92:93], v[220:221] op_sel:[0,1] op_sel_hi:[1,1]
v_pk_fma_f32 v[94:95], v[38:39], v[220:221], v[94:95] op_sel_hi:[1,0,1]
v_pk_mul_f32 v[94:95], v[94:95], v[220:221] op_sel:[0,1] op_sel_hi:[1,1]
v_pk_fma_f32 v[108:109], v[40:41], v[220:221], v[108:109] op_sel_hi:[1,0,1]
v_pk_mul_f32 v[108:109], v[108:109], v[220:221] op_sel:[0,1] op_sel_hi:[1,1]
v_pk_fma_f32 v[110:111], v[42:43], v[220:221], v[110:111] op_sel_hi:[1,0,1]
v_pk_mul_f32 v[110:111], v[110:111], v[220:221] op_sel:[0,1] op_sel_hi:[1,1]
ds_write_b64 v8, v[218:219] offset:1032
s_nop 0
MAA 132,52,80
s_mov_b32 s58, 1703936
v_cvt_pk_bf16_f32 v192, v100, v101
v_cvt_pk_bf16_f32 v193, v102, v103
MAA 148,52,84
buffer_load_dwordx4 v5, s[24:27], s58 offen lds
MAA 68,64,52
v_cvt_pk_bf16_f32 v194, v116, v117
v_cvt_pk_bf16_f32 v195, v118, v119
MAA 84,68,52
v_cvt_pk_bf16_f32 v176, v72, v73
v_cvt_pk_bf16_f32 v177, v74, v75
MAA 128,48,80
v_cvt_pk_bf16_f32 v178, v88, v89
v_cvt_pk_bf16_f32 v179, v90, v91
v_cvt_pk_bf16_f32 v188, v96, v97
v_cvt_pk_bf16_f32 v189, v98, v99
v_cvt_pk_bf16_f32 v190, v112, v113
s_waitcnt lgkmcnt(6)
v_pk_fma_f32 v[132:133], v[18:19], v[44:45], v[132:133] op_sel_hi:[1,0,1]
s_waitcnt lgkmcnt(5)
v_pk_mul_f32 v[132:133], v[132:133], v[22:23]
v_pk_fma_f32 v[134:135], v[20:21], v[44:45], v[134:135] op_sel_hi:[1,0,1]
v_pk_mul_f32 v[134:135], v[134:135], v[24:25]
v_pk_fma_f32 v[148:149], v[18:19], v[44:45], v[148:149] op_sel:[0,1,0] op_sel_hi:[1,1,1]
v_pk_mul_f32 v[148:149], v[148:149], v[22:23]
v_pk_fma_f32 v[150:151], v[20:21], v[44:45], v[150:151] op_sel:[0,1,0] op_sel_hi:[1,1,1]
v_pk_mul_f32 v[150:151], v[150:151], v[24:25]
v_pk_fma_f32 v[68:69], v[28:29], v[228:229], v[68:69] op_sel_hi:[1,0,1]
v_pk_fma_f32 v[70:71], v[30:31], v[228:229], v[70:71] op_sel_hi:[1,0,1]
v_pk_fma_f32 v[84:85], v[32:33], v[228:229], v[84:85] op_sel_hi:[1,0,1]
v_pk_fma_f32 v[86:87], v[34:35], v[228:229], v[86:87] op_sel_hi:[1,0,1]
s_waitcnt lgkmcnt(4)
v_pk_fma_f32 v[128:129], v[240:241], v[44:45], v[128:129] op_sel_hi:[1,0,1]
s_waitcnt lgkmcnt(3)
v_pk_mul_f32 v[128:129], v[128:129], v[244:245]
v_pk_fma_f32 v[130:131], v[242:243], v[44:45], v[130:131] op_sel_hi:[1,0,1]
v_pk_mul_f32 v[130:131], v[130:131], v[246:247]
s_waitcnt lgkmcnt(0)
s_barrier
v_cvt_pk_bf16_f32 v206, v132, v133
MAA 144,48,84
ds_read_b64 v[200:201], v9 offset:1024
v_cvt_pk_bf16_f32 v207, v134, v135
MAA 64,64,48
ds_read_b64 v[210:211], v9 offset:1032
v_cvt_pk_bf16_f32 v216, v148, v149
MAA 80,68,48
buffer_load_dwordx4 v6, s[24:27], s58 offen offset:1024 lds
MAA 124,44,80
ds_read_b128 v[18:21], v11
s_add_u32 m0, s59, 49920
MAA 140,44,84
ds_read_b128 v[22:25], v11 offset:1024
s_mov_b32 s58, 1835008
MAA 60,64,44
v_cvt_pk_bf16_f32 v217, v150, v151
v_cvt_pk_bf16_f32 v191, v114, v115
MAA 76,68,44
buffer_load_dwordx4 v5, s[24:27], s58 offen lds
v_cvt_pk_bf16_f32 v172, v68, v69
v_cvt_pk_bf16_f32 v173, v70, v71
v_cvt_pk_bf16_f32 v174, v84, v85
v_pk_fma_f32 v[144:145], v[240:241], v[44:45], v[144:145] op_sel:[0,1,0] op_sel_hi:[1,1,1]
v_pk_mul_f32 v[144:145], v[144:145], v[244:245]
v_pk_fma_f32 v[146:147], v[242:243], v[44:45], v[146:147] op_sel:[0,1,0] op_sel_hi:[1,1,1]
v_pk_mul_f32 v[146:147], v[146:147], v[246:247]
v_pk_fma_f32 v[64:65], v[28:29], v[224:225], v[64:65] op_sel_hi:[1,0,1]
v_pk_fma_f32 v[66:67], v[30:31], v[224:225], v[66:67] op_sel_hi:[1,0,1]
v_pk_fma_f32 v[80:81], v[32:33], v[224:225], v[80:81] op_sel_hi:[1,0,1]
v_pk_fma_f32 v[82:83], v[34:35], v[224:225], v[82:83] op_sel_hi:[1,0,1]
v_pk_fma_f32 v[60:61], v[28:29], v[220:221], v[60:61] op_sel_hi:[1,0,1]
v_pk_fma_f32 v[62:63], v[30:31], v[220:221], v[62:63] op_sel_hi:[1,0,1]
v_pk_fma_f32 v[76:77], v[32:33], v[220:221], v[76:77] op_sel_hi:[1,0,1]
v_pk_fma_f32 v[78:79], v[34:35], v[220:221], v[78:79] op_sel_hi:[1,0,1]
v_cvt_pk_bf16_f32 v175, v86, v87
v_cvt_pk_bf16_f32 v204, v128, v129
v_mfma_f32_16x16x32_bf16 v[104:107], v[192:195], v[176:179], v[46:49]
buffer_load_dwordx4 v6, s[24:27], s58 offen offset:1024 lds
v_mfma_f32_16x16x32_bf16 v[120:123], v[196:199], v[176:179], v[50:53]
s_add_u32 m0, s59, 116480
s_mov_b32 s58, 786432
v_cvt_pk_bf16_f32 v205, v130, v131
v_mfma_f32_16x16x32_bf16 v[100:103], v[188:191], v[172:175], v[46:49]
s_nop 1
v_max3_f32 v88, v104, v105, v106
v_cvt_pk_bf16_f32 v214, v144, v145
v_mfma_f32_16x16x32_bf16 v[116:119], v[192:195], v[172:175], v[50:53]
v_max3_f32 v89, v107, v120, v121
v_max3_f32 v88, v88, v122, v123
v_max_f32 v90, v88, v89
buffer_load_dwordx4 v5, s[24:27], s58 offen lds
v_max_f32 v89, v88, v89
v_cvt_pk_bf16_f32 v215, v146, v147
v_max3_f32 v84, v100, v101, v102
v_permlane16_swap_b32 v90, v89
v_max3_f32 v85, v103, v116, v117
v_max_f32 v88, v90, v89
v_max_f32 v89, v90, v89
v_max3_f32 v84, v84, v118, v119
v_max_f32 v86, v84, v85
v_permlane32_swap_b32 v88, v89
v_max_f32 v85, v84, v85
buffer_load_dwordx4 v6, s[24:27], s58 offen offset:1024 lds
s_add_u32 m0, s59, 124800
s_mov_b32 s58, 917504
v_max_f32 v88, v88, v89
v_mul_f32 v88, v88, v234
v_pk_fma_f32 v[104:105], v[104:105], v[234:235], v[88:89] op_sel_hi:[1,0,0] neg_lo:[0,0,1] neg_hi:[0,0,1]
v_pk_fma_f32 v[106:107], v[106:107], v[234:235], v[88:89] op_sel_hi:[1,0,0] neg_lo:[0,0,1] neg_hi:[0,0,1]
v_pk_fma_f32 v[120:121], v[120:121], v[234:235], v[88:89] op_sel_hi:[1,0,0] neg_lo:[0,0,1] neg_hi:[0,0,1]
v_pk_fma_f32 v[122:123], v[122:123], v[234:235], v[88:89] op_sel_hi:[1,0,0] neg_lo:[0,0,1] neg_hi:[0,0,1]
v_exp_f32 v104, v104
v_exp_f32 v105, v105
v_exp_f32 v106, v106
v_exp_f32 v107, v107
v_exp_f32 v120, v120
v_exp_f32 v121, v121
v_exp_f32 v122, v122
v_exp_f32 v123, v123
v_cvt_pk_bf16_f32 v72, v104, v105
buffer_load_dwordx4 v5, s[24:27], s58 offen lds
v_cvt_pk_bf16_f32 v73, v106, v107
v_cvt_pk_bf16_f32 v74, v120, v121
v_cvt_pk_bf16_f32 v75, v122, v123
s_waitcnt lgkmcnt(1)
v_pk_fma_f32 v[124:125], v[18:19], v[44:45], v[124:125] op_sel_hi:[1,0,1]
s_waitcnt lgkmcnt(0)
v_pk_mul_f32 v[124:125], v[124:125], v[22:23]
v_pk_fma_f32 v[126:127], v[20:21], v[44:45], v[126:127] op_sel_hi:[1,0,1]
v_pk_mul_f32 v[126:127], v[126:127], v[24:25]
v_pk_fma_f32 v[140:141], v[18:19], v[44:45], v[140:141] op_sel:[0,1,0] op_sel_hi:[1,1,1]
v_pk_mul_f32 v[140:141], v[140:141], v[22:23]
v_pk_fma_f32 v[142:143], v[20:21], v[44:45], v[142:143] op_sel:[0,1,0] op_sel_hi:[1,1,1]
v_pk_mul_f32 v[142:143], v[142:143], v[24:25]
v_permlane16_swap_b32 v86, v85
s_nop 0
v_mfma_f32_16x16x32_bf16 v[88:91], v[248:251], v[72:75], 0
buffer_load_dwordx4 v6, s[24:27], s58 offen offset:1024 lds
v_mfma_f32_16x16x32_bf16 v[104:107], v[206:209], v[72:75], 0
v_max_f32 v84, v86, v85
v_max_f32 v85, v86, v85
v_mfma_f32_16x16x32_bf16 v[120:123], v[216:219], v[72:75], 0
s_nop 2
v_rcp_f32 v88, v88
v_permlane32_swap_b32 v84, v85
v_cvt_pk_bf16_f32 v184, v92, v93
v_pk_mul_f32 v[104:105], v[104:105], v[88:89] op_sel_hi:[1,0]
v_pk_mul_f32 v[106:107], v[106:107], v[88:89] op_sel_hi:[1,0]
v_pk_mul_f32 v[120:121], v[120:121], v[88:89] op_sel_hi:[1,0]
v_pk_mul_f32 v[122:123], v[122:123], v[88:89] op_sel_hi:[1,0]
v_cvt_pk_bf16_f32 v176, v104, v105
v_cvt_pk_bf16_f32 v177, v106, v107
v_cvt_pk_bf16_f32 v178, v120, v121
v_cvt_pk_bf16_f32 v179, v122, v123
buffer_store_dwordx4 v[176:179], v4, s[16:19], s74 offen offset:3072 sc1
v_max_f32 v84, v84, v85
v_mul_f32 v84, v84, v230
v_pk_fma_f32 v[100:101], v[100:101], v[230:231], v[84:85] op_sel_hi:[1,0,0] neg_lo:[0,0,1] neg_hi:[0,0,1]
v_pk_fma_f32 v[102:103], v[102:103], v[230:231], v[84:85] op_sel_hi:[1,0,0] neg_lo:[0,0,1] neg_hi:[0,0,1]
v_pk_fma_f32 v[116:117], v[116:117], v[230:231], v[84:85] op_sel_hi:[1,0,0] neg_lo:[0,0,1] neg_hi:[0,0,1]
v_pk_fma_f32 v[118:119], v[118:119], v[230:231], v[84:85] op_sel_hi:[1,0,0] neg_lo:[0,0,1] neg_hi:[0,0,1]
v_exp_f32 v100, v100
v_exp_f32 v101, v101
v_exp_f32 v102, v102
v_exp_f32 v103, v103
v_exp_f32 v116, v116
v_exp_f32 v117, v117
v_exp_f32 v118, v118
v_exp_f32 v119, v119
v_cvt_pk_bf16_f32 v68, v100, v101
v_cvt_pk_bf16_f32 v69, v102, v103
v_cvt_pk_bf16_f32 v70, v116, v117
v_cvt_pk_bf16_f32 v71, v118, v119
v_cvt_pk_bf16_f32 v185, v94, v95
v_cvt_pk_bf16_f32 v186, v108, v109
v_mfma_f32_16x16x32_bf16 v[84:87], v[248:251], v[68:71], 0
v_cvt_pk_bf16_f32 v187, v110, v111
v_cvt_pk_bf16_f32 v168, v64, v65
v_mfma_f32_16x16x32_bf16 v[100:103], v[204:207], v[68:71], 0
v_cvt_pk_bf16_f32 v169, v66, v67
v_cvt_pk_bf16_f32 v170, v80, v81
v_mfma_f32_16x16x32_bf16 v[116:119], v[214:217], v[68:71], 0
s_nop 1
v_rcp_f32 v84, v84
v_cvt_pk_bf16_f32 v171, v82, v83
v_cvt_pk_bf16_f32 v202, v124, v125
v_cvt_pk_bf16_f32 v203, v126, v127
v_pk_mul_f32 v[100:101], v[100:101], v[84:85] op_sel_hi:[1,0]
v_pk_mul_f32 v[102:103], v[102:103], v[84:85] op_sel_hi:[1,0]
v_pk_mul_f32 v[116:117], v[116:117], v[84:85] op_sel_hi:[1,0]
v_pk_mul_f32 v[118:119], v[118:119], v[84:85] op_sel_hi:[1,0]
v_cvt_pk_bf16_f32 v172, v100, v101
v_cvt_pk_bf16_f32 v173, v102, v103
v_mfma_f32_16x16x32_bf16 v[96:99], v[184:187], v[168:171], v[46:49]
v_cvt_pk_bf16_f32 v174, v116, v117
v_cvt_pk_bf16_f32 v175, v118, v119
v_mfma_f32_16x16x32_bf16 v[112:115], v[188:191], v[168:171], v[50:53]
buffer_store_dwordx4 v[172:175], v4, s[16:19], s74 offen offset:2048 sc1
v_cvt_pk_bf16_f32 v212, v140, v141
v_cvt_pk_bf16_f32 v213, v142, v143
s_nop 1
v_max3_f32 v80, v96, v97, v98
v_cvt_pk_bf16_f32 v180, v156, v157
v_cvt_pk_bf16_f32 v181, v158, v159
v_max3_f32 v81, v99, v112, v113
v_max3_f32 v80, v80, v114, v115
v_max_f32 v82, v80, v81
v_max_f32 v81, v80, v81
v_cvt_pk_bf16_f32 v182, v160, v161
v_cvt_pk_bf16_f32 v183, v162, v163
v_permlane16_swap_b32 v82, v81
v_cvt_pk_bf16_f32 v164, v60, v61
v_max_f32 v80, v82, v81
v_max_f32 v81, v82, v81
v_cvt_pk_bf16_f32 v165, v62, v63
v_cvt_pk_bf16_f32 v166, v76, v77
v_permlane32_swap_b32 v80, v81
v_cvt_pk_bf16_f32 v167, v78, v79
v_max_f32 v80, v80, v81
v_mul_f32 v80, v80, v226
v_mfma_f32_16x16x32_bf16 v[92:95], v[180:183], v[164:167], v[54:57]
v_mfma_f32_16x16x32_bf16 v[108:111], v[184:187], v[164:167], v[50:53]
s_nop 6
v_max3_f32 v76, v92, v93, v94
v_pk_fma_f32 v[96:97], v[96:97], v[226:227], v[80:81] op_sel_hi:[1,0,0] neg_lo:[0,0,1] neg_hi:[0,0,1]
v_pk_fma_f32 v[98:99], v[98:99], v[226:227], v[80:81] op_sel_hi:[1,0,0] neg_lo:[0,0,1] neg_hi:[0,0,1]
v_pk_fma_f32 v[112:113], v[112:113], v[226:227], v[80:81] op_sel_hi:[1,0,0] neg_lo:[0,0,1] neg_hi:[0,0,1]
v_pk_fma_f32 v[114:115], v[114:115], v[226:227], v[80:81] op_sel_hi:[1,0,0] neg_lo:[0,0,1] neg_hi:[0,0,1]
v_exp_f32 v96, v96
v_exp_f32 v97, v97
v_exp_f32 v98, v98
v_exp_f32 v99, v99
v_exp_f32 v112, v112
v_exp_f32 v113, v113
v_exp_f32 v114, v114
v_exp_f32 v115, v115
v_cvt_pk_bf16_f32 v64, v96, v97
v_cvt_pk_bf16_f32 v65, v98, v99
v_cvt_pk_bf16_f32 v66, v112, v113
v_cvt_pk_bf16_f32 v67, v114, v115
v_max3_f32 v77, v95, v108, v109
v_max3_f32 v76, v76, v110, v111
v_mfma_f32_16x16x32_bf16 v[80:83], v[248:251], v[64:67], 0
v_max_f32 v78, v76, v77
v_max_f32 v77, v76, v77
v_mfma_f32_16x16x32_bf16 v[96:99], v[202:205], v[64:67], 0
s_nop 0
v_permlane16_swap_b32 v78, v77
v_mfma_f32_16x16x32_bf16 v[112:115], v[212:215], v[64:67], 0
s_nop 1
v_rcp_f32 v80, v80
v_max_f32 v76, v78, v77
v_max_f32 v77, v78, v77
v_pk_mul_f32 v[96:97], v[96:97], v[80:81] op_sel_hi:[1,0]
v_pk_mul_f32 v[98:99], v[98:99], v[80:81] op_sel_hi:[1,0]
s_nop 0
v_pk_mul_f32 v[112:113], v[112:113], v[80:81] op_sel_hi:[1,0]
.Lpad14:
s_cbranch_execz .Lpad17
v_pk_mul_f32 v[114:115], v[114:115], v[80:81] op_sel_hi:[1,0]
v_cvt_pk_bf16_f32 v168, v96, v97
v_cvt_pk_bf16_f32 v169, v98, v99
v_cvt_pk_bf16_f32 v170, v112, v113
v_cvt_pk_bf16_f32 v171, v114, v115
buffer_store_dwordx4 v[168:171], v4, s[16:19], s74 offen offset:1024 sc1
v_permlane32_swap_b32 v76, v77
v_max_f32 v76, v76, v77
v_mul_f32 v76, v76, v222
v_pk_fma_f32 v[92:93], v[92:93], v[222:223], v[76:77] op_sel_hi:[1,0,0] neg_lo:[0,0,1] neg_hi:[0,0,1]
v_pk_fma_f32 v[94:95], v[94:95], v[222:223], v[76:77] op_sel_hi:[1,0,0] neg_lo:[0,0,1] neg_hi:[0,0,1]
v_pk_fma_f32 v[108:109], v[108:109], v[222:223], v[76:77] op_sel_hi:[1,0,0] neg_lo:[0,0,1] neg_hi:[0,0,1]
v_pk_fma_f32 v[110:111], v[110:111], v[222:223], v[76:77] op_sel_hi:[1,0,0] neg_lo:[0,0,1] neg_hi:[0,0,1]
v_exp_f32 v92, v92
v_exp_f32 v93, v93
v_exp_f32 v94, v94
v_exp_f32 v95, v95
v_exp_f32 v108, v108
v_exp_f32 v109, v109
v_exp_f32 v110, v110
v_exp_f32 v111, v111
v_cvt_pk_bf16_f32 v60, v92, v93
v_cvt_pk_bf16_f32 v61, v94, v95
v_cvt_pk_bf16_f32 v62, v108, v109
v_cvt_pk_bf16_f32 v63, v110, v111
s_nop 1
v_mfma_f32_16x16x32_bf16 v[76:79], v[248:251], v[60:63], 0
v_mfma_f32_16x16x32_bf16 v[92:95], v[200:203], v[60:63], 0
v_mfma_f32_16x16x32_bf16 v[108:111], v[210:213], v[60:63], 0
s_nop 5
v_rcp_f32 v76, v76
s_nop 0
v_pk_mul_f32 v[92:93], v[92:93], v[76:77] op_sel_hi:[1,0]
v_pk_mul_f32 v[94:95], v[94:95], v[76:77] op_sel_hi:[1,0]
v_pk_mul_f32 v[108:109], v[108:109], v[76:77] op_sel_hi:[1,0]
v_pk_mul_f32 v[110:111], v[110:111], v[76:77] op_sel_hi:[1,0]
v_cvt_pk_bf16_f32 v164, v92, v93
v_cvt_pk_bf16_f32 v165, v94, v95
v_cvt_pk_bf16_f32 v166, v108, v109
v_cvt_pk_bf16_f32 v167, v110, v111
buffer_store_dwordx4 v[164:167], v4, s[16:19], s74 offen sc1
s_nop 1
s_branch .Lqkve55
.Lpad15:
s_cbranch_execz .Lpad18
.Lsp49:
s_mov_b32 s15, 0
.Lsp49l:
v_mov_b32 v25, 0
buffer_atomic_add v25, v22, s[16:19], s73 offen sc0
s_add_u32 s15, s15, 1
s_cmp_gt_u32 s15, 100000
s_waitcnt vmcnt(0)
s_cbranch_scc1 .Lsp49b
v_cmp_gt_u32 vcc, v23, v25
s_nop 0
s_cbranch_vccnz .Lsp49l
s_branch .Lsp49b
.Lxs50:
s_mov_b32 s15, 0
.Lxs50l:
v_mov_b32 v15, 0
buffer_atomic_add v15, v12, s[16:19], s70 offen sc0
s_add_u32 s15, s15, 1
s_cmp_gt_u32 s15, 100000
s_waitcnt vmcnt(0)
s_cbranch_scc1 .Lxs50b
v_cmp_ne_u32 vcc, 0, v15
s_nop 0
s_cbranch_vccz .Lxs50l
s_branch .Lxs50b
.Lqkv54:
.Lpad16:
s_cbranch_execz .Lpad19
s_add_u32 m0, s55, 36864
s_nop 0
buffer_load_dwordx4 v21, s[16:19], s52 offen sc1 lds
buffer_load_dwordx4 v21, s[16:19], s52 offen offset:1024 sc1 lds
buffer_load_dword v22, s[16:19], s52 offen offset:2048 sc1 lds
s_add_u32 s52, s52, 131072
s_add_u32 m0, s55, 46080
s_nop 0
buffer_load_dwordx4 v21, s[16:19], s52 offen sc1 lds
buffer_load_dwordx4 v21, s[16:19], s52 offen offset:1024 sc1 lds
buffer_load_dword v22, s[16:19], s52 offen offset:2048 sc1 lds
s_add_u32 s52, s52, 131072
s_add_u32 m0, s55, 0
s_nop 0
buffer_load_dwordx4 v21, s[16:19], s52 offen sc1 lds
buffer_load_dwordx4 v21, s[16:19], s52 offen offset:1024 sc1 lds
buffer_load_dword v22, s[16:19], s52 offen offset:2048 sc1 lds
s_add_u32 s52, s52, 131072
s_add_u32 m0, s55, 9216
s_nop 0
buffer_load_dwordx4 v21, s[16:19], s52 offen sc1 lds
buffer_load_dwordx4 v21, s[16:19], s52 offen offset:1024 sc1 lds
buffer_load_dword v22, s[16:19], s52 offen offset:2048 sc1 lds
s_add_u32 s52, s52, 131072
s_add_u32 m0, s55, 18432
s_nop 0
buffer_load_dwordx4 v21, s[16:19], s52 offen sc1 lds
buffer_load_dwordx4 v21, s[16:19], s52 offen offset:1024 sc1 lds
buffer_load_dword v22, s[16:19], s52 offen offset:2048 sc1 lds
s_add_u32 s52, s52, 131072
s_waitcnt vmcnt(12)
s_barrier
RD 0,23,36864
RD 4,23,37888
RD 8,23,39168
RD 12,23,40192
RD 16,24,38912
s_waitcnt lgkmcnt(0)
s_mov_b32 s15, -4
.p2align 6
.Lk57:
s_waitcnt vmcnt(9) lgkmcnt(8)
s_barrier
MAA 60,20,0
RD 44,23,46080
v_add_f32 v164, v164, v168
MAA 76,24,0
RD 48,23,47104
s_add_u32 m0, s56, 104832
MAA 80,24,4
buffer_load_dwordx4 v18, s[20:23], s54 offen lds
MAA 64,20,4
RD 52,23,48384
MAA 68,20,8
RD 56,23,49408
MAA 84,24,8
buffer_load_dwordx4 v19, s[20:23], s54 offen offset:1024 lds
MAA 88,24,12
TR 64,25,62080
v_add_f32 v165, v165, v169
MAA 72,20,12
TR 66,25,62592
s_waitcnt lgkmcnt(6)
MAA 104,28,12
buffer_load_dwordx4 v20, s[20:23], s54 offen offset:2048 lds
MAA 120,32,12
TR 68,25,62112
s_add_u32 s54, s54, 196608
MAA 116,32,8
TR 70,25,62624
MAA 100,28,8
RD 60,24,48128
s_add_u32 m0, s55, 27648
MAA 96,28,4
buffer_load_dwordx4 v21, s[16:19], s52 offen sc1 lds
MAA 112,32,4
TR 72,25,63104
MAA 108,32,0
TR 74,25,63616
v_add_f32 v166, v166, v170
MAA 92,28,0
buffer_load_dwordx4 v21, s[16:19], s52 offen offset:1024 sc1 lds
MAA 124,0,36
TR 76,25,63136
MAA 140,0,40
TR 78,25,63648
MAA 144,4,40
TR 80,25,64128
v_add_f32 v167, v167, v171
MAA 128,4,36
buffer_load_dword v22, s[16:19], s52 offen offset:2048 sc1 lds
MAA 132,8,36
TR 82,25,64640
s_add_u32 s52, s52, 131072
MAA 148,8,40
TR 84,25,64160
MAA 152,12,40
buffer_load_dword v27, v14, s[20:23], s44 offen
MAA 136,12,36
TR 86,25,64672
s_add_u32 s44, s44, 1572864
MAA 156,16,36
MAA 160,16,40
s_waitcnt vmcnt(13) lgkmcnt(8)
s_barrier
MAA 60,64,44
ds_read_b128 a[0:3], v23
MAA 76,68,44
RD 4,23,1024
s_add_u32 m0, s56, 117248
MAA 80,68,48
buffer_load_dwordx4 v18, s[20:23], s54 offen lds
MAA 64,64,48
RD 8,23,2304
MAA 68,64,52
RD 12,23,3328
MAA 84,68,52
buffer_load_dwordx4 v19, s[20:23], s54 offen offset:1024 lds
MAA 88,68,56
ds_read_b64_tr_b16 a[20:21], v25
MAA 72,64,56
TR 22,25,512
s_waitcnt lgkmcnt(6)
MAA 104,72,56
buffer_load_dwordx4 v20, s[20:23], s54 offen offset:2048 lds
MAA 120,76,56
TR 24,25,32
s_add_u32 s54, s54, 196608
MAA 116,76,52
TR 26,25,544
MAA 100,72,52
RD 16,24,2048
s_add_u32 m0, s55, 36864
MAA 96,72,48
buffer_load_dwordx4 v21, s[16:19], s52 offen sc1 lds
MAA 112,76,48
TR 28,25,1024
MAA 108,76,44
TR 30,25,1536
MAA 92,72,44
buffer_load_dwordx4 v21, s[16:19], s52 offen offset:1024 sc1 lds
MAA 124,44,80
TR 32,25,1056
MAA 140,44,84
TR 34,25,1568
MAA 144,48,84
TR 36,25,2048
MAA 128,48,80
buffer_load_dword v22, s[16:19], s52 offen offset:2048 sc1 lds
MAA 132,52,80
TR 38,25,2560
s_add_u32 s52, s52, 131072
MAA 148,52,84
TR 40,25,2080
MAA 152,56,84
buffer_load_dwordx4 v[168:171], v26, s[16:19], s75 offen sc1
MAA 136,56,80
TR 42,25,2592
MAA 156,60,80
MAA 160,60,84
s_waitcnt vmcnt(17) lgkmcnt(8)
s_barrier
MAA 60,20,0
RD 44,23,9216
MAA 76,24,0
RD 48,23,10240
s_add_u32 m0, s56, 129664
MAA 80,24,4
buffer_load_dwordx4 v18, s[20:23], s54 offen lds
MAA 64,20,4
RD 52,23,11520
MAA 68,20,8
RD 56,23,12544
MAA 84,24,8
TR 64,25,12416
MAA 88,24,12
buffer_load_dwordx4 v19, s[20:23], s54 offen offset:1024 lds
MAA 72,20,12
TR 66,25,12928
s_waitcnt lgkmcnt(6)
MAA 104,28,12
TR 68,25,12448
MAA 120,32,12
TR 70,25,12960
MAA 116,32,8
buffer_load_dwordx4 v20, s[20:23], s54 offen offset:2048 lds
MAA 100,28,8
RD 60,24,11264
s_add_u32 s54, s54, 196608
MAA 96,28,4
MAA 112,32,4
TR 72,25,13440
s_add_u32 m0, s55, 46080
MAA 108,32,0
buffer_load_dwordx4 v21, s[16:19], s52 offen sc1 lds
MAA 92,28,0
TR 74,25,13952
MAA 124,0,36
TR 76,25,13472
MAA 140,0,40
TR 78,25,13984
MAA 144,4,40
buffer_load_dwordx4 v21, s[16:19], s52 offen offset:1024 sc1 lds
MAA 128,4,36
TR 80,25,14464
MAA 132,8,36
TR 82,25,14976
MAA 148,8,40
TR 84,25,14496
MAA 152,12,40
buffer_load_dword v22, s[16:19], s52 offen offset:2048 sc1 lds
MAA 136,12,36
TR 86,25,15008
s_add_u32 s52, s52, 131072
MAA 156,16,36
MAA 160,16,40
s_waitcnt vmcnt(20) lgkmcnt(8)
s_barrier
MAA 60,64,44
RD 0,23,18432
v_add_f32 v164, v164, v172
MAA 76,68,44
RD 4,23,19456
s_add_u32 m0, s56, 67584
MAA 80,68,48
buffer_load_dwordx4 v18, s[20:23], s54 offen lds
MAA 64,64,48
RD 8,23,20736
MAA 68,64,52
RD 12,23,21760
MAA 84,68,52
TR 20,25,24832
MAA 88,68,56
buffer_load_dwordx4 v19, s[20:23], s54 offen offset:1024 lds
MAA 72,64,56
TR 22,25,25344
s_waitcnt lgkmcnt(6)
MAA 104,72,56
TR 24,25,24864
v_add_f32 v165, v165, v173
MAA 120,76,56
TR 26,25,25376
MAA 116,76,52
buffer_load_dwordx4 v20, s[20:23], s54 offen offset:2048 lds
MAA 100,72,52
RD 16,24,20480
s_add_u32 s54, s54, 196608
MAA 96,72,48
MAA 112,76,48
TR 28,25,25856
s_add_u32 m0, s55, 0
MAA 108,76,44
buffer_load_dwordx4 v21, s[16:19], s52 offen sc1 lds
MAA 92,72,44
TR 30,25,26368
v_add_f32 v166, v166, v174
MAA 124,44,80
TR 32,25,25888
MAA 140,44,84
TR 34,25,26400
MAA 144,48,84
buffer_load_dwordx4 v21, s[16:19], s52 offen offset:1024 sc1 lds
MAA 128,48,80
TR 36,25,26880
MAA 132,52,80
TR 38,25,27392
v_add_f32 v167, v167, v175
MAA 148,52,84
TR 40,25,26912
MAA 152,56,84
buffer_load_dword v22, s[16:19], s52 offen offset:2048 sc1 lds
MAA 136,56,80
TR 42,25,27424
s_add_u32 s52, s52, 131072
MAA 156,60,80
MAA 160,60,84
s_waitcnt vmcnt(20) lgkmcnt(8)
s_barrier
MAA 60,20,0
RD 44,23,27648
MAA 76,24,0
RD 48,23,28672
s_add_u32 m0, s56, 80000
MAA 80,24,4
buffer_load_dwordx4 v18, s[20:23], s54 offen lds
MAA 64,20,4
RD 52,23,29952
MAA 68,20,8
RD 56,23,30976
MAA 84,24,8
buffer_load_dwordx4 v19, s[20:23], s54 offen offset:1024 lds
MAA 88,24,12
TR 64,25,37248
MAA 72,20,12
TR 66,25,37760
s_waitcnt lgkmcnt(6)
MAA 104,28,12
buffer_load_dwordx4 v20, s[20:23], s54 offen offset:2048 lds
MAA 120,32,12
TR 68,25,37280
s_add_u32 s54, s54, 196608
MAA 116,32,8
TR 70,25,37792
MAA 100,28,8
RD 60,24,29696
s_add_u32 m0, s55, 9216
MAA 96,28,4
buffer_load_dwordx4 v21, s[16:19], s52 offen sc1 lds
MAA 112,32,4
TR 72,25,38272
MAA 108,32,0
TR 74,25,38784
MAA 92,28,0
buffer_load_dwordx4 v21, s[16:19], s52 offen offset:1024 sc1 lds
MAA 124,0,36
TR 76,25,38304
MAA 140,0,40
TR 78,25,38816
MAA 144,4,40
TR 80,25,39296
MAA 128,4,36
buffer_load_dword v22, s[16:19], s52 offen offset:2048 sc1 lds
MAA 132,8,36
TR 82,25,39808
s_add_u32 s52, s52, 131072
MAA 148,8,40
TR 84,25,39328
MAA 152,12,40
buffer_load_dwordx4 v[172:175], v26, s[16:19], s75 offen offset:1024 sc1
MAA 136,12,36
TR 86,25,39840
s_add_u32 s75, s75, 2048
MAA 156,16,36
MAA 160,16,40
s_waitcnt vmcnt(20) lgkmcnt(8)
s_barrier
MAA 60,64,44
RD 0,23,36864
MAA 76,68,44
RD 4,23,37888
s_add_u32 m0, s56, 92416
MAA 80,68,48
buffer_load_dwordx4 v18, s[20:23], s54 offen lds
MAA 64,64,48
RD 8,23,39168
MAA 68,64,52
RD 12,23,40192
MAA 84,68,52
TR 20,25,49664
MAA 88,68,56
buffer_load_dwordx4 v19, s[20:23], s54 offen offset:1024 lds
MAA 72,64,56
TR 22,25,50176
s_waitcnt lgkmcnt(6)
MAA 104,72,56
TR 24,25,49696
MAA 120,76,56
TR 26,25,50208
MAA 116,76,52
buffer_load_dwordx4 v20, s[20:23], s54 offen offset:2048 lds
MAA 100,72,52
RD 16,24,38912
s_add_u32 s54, s54, 196608
MAA 96,72,48
MAA 112,76,48
TR 28,25,50688
s_add_u32 m0, s55, 18432
MAA 108,76,44
buffer_load_dwordx4 v21, s[16:19], s52 offen sc1 lds
MAA 92,72,44
TR 30,25,51200
MAA 124,44,80
TR 32,25,50720
MAA 140,44,84
TR 34,25,51232
MAA 144,48,84
buffer_load_dwordx4 v21, s[16:19], s52 offen offset:1024 sc1 lds
MAA 128,48,80
TR 36,25,51712
MAA 132,52,80
TR 38,25,52224
MAA 148,52,84
TR 40,25,51744
MAA 152,56,84
buffer_load_dword v22, s[16:19], s52 offen offset:2048 sc1 lds
MAA 136,56,80
TR 42,25,52256
s_add_u32 s52, s52, 131072
MAA 156,60,80
s_add_u32 s15, s15, 1
MAA 160,60,84
s_cbranch_scc0 .Lk57
s_waitcnt vmcnt(19) lgkmcnt(8)
s_barrier
MAA 60,20,0
RD 44,23,46080
v_add_f32 v164, v164, v168
MAA 76,24,0
RD 48,23,47104
s_add_u32 m0, s56, 104832
MAA 80,24,4
buffer_load_dwordx4 v18, s[20:23], s54 offen lds
MAA 64,20,4
RD 52,23,48384
v_add_f32 v165, v165, v169
MAA 68,20,8
RD 56,23,49408
v_add_f32 v166, v166, v170
MAA 84,24,8
TR 64,25,62080
v_add_f32 v167, v167, v171
MAA 88,24,12
buffer_load_dwordx4 v19, s[20:23], s54 offen offset:1024 lds
MAA 72,20,12
TR 66,25,62592
s_waitcnt lgkmcnt(6)
MAA 104,28,12
TR 68,25,62112
MAA 120,32,12
TR 70,25,62624
MAA 116,32,8
buffer_load_dwordx4 v20, s[20:23], s54 offen offset:2048 lds
MAA 100,28,8
RD 60,24,48128
s_add_u32 s54, s54, 196608
MAA 96,28,4
TR 72,25,63104
s_add_u32 m0, s55, 27648
MAA 112,32,4
TR 74,25,63616
MAA 108,32,0
buffer_load_dwordx4 v21, s[16:19], s52 offen sc1 lds
MAA 92,28,0
TR 76,25,63136
MAA 124,0,36
TR 78,25,63648
MAA 140,0,40
TR 80,25,64128
MAA 144,4,40
buffer_load_dwordx4 v21, s[16:19], s52 offen offset:1024 sc1 lds
MAA 128,4,36
TR 82,25,64640
MAA 132,8,36
TR 84,25,64160
MAA 148,8,40
TR 86,25,64672
MAA 152,12,40
buffer_load_dword v22, s[16:19], s52 offen offset:2048 sc1 lds
MAA 136,12,36
s_add_u32 s52, s52, 131072
MAA 156,16,36
MAA 160,16,40
s_waitcnt vmcnt(19) lgkmcnt(8)
s_barrier
MAA 60,64,44
ds_read_b128 a[0:3], v23
MAA 76,68,44
RD 4,23,1024
s_add_u32 m0, s56, 117248
MAA 80,68,48
buffer_load_dwordx4 v18, s[20:23], s54 offen lds
MAA 64,64,48
RD 8,23,2304
MAA 68,64,52
RD 12,23,3328
MAA 84,68,52
ds_read_b64_tr_b16 a[20:21], v25
MAA 88,68,56
buffer_load_dwordx4 v19, s[20:23], s54 offen offset:1024 lds
MAA 72,64,56
TR 22,25,512
s_waitcnt lgkmcnt(6)
MAA 104,72,56
TR 24,25,32
MAA 120,76,56
TR 26,25,544
MAA 116,76,52
buffer_load_dwordx4 v20, s[20:23], s54 offen offset:2048 lds
MAA 100,72,52
RD 16,24,2048
s_add_u32 s54, s54, 196608
MAA 96,72,48
MAA 112,76,48
TR 28,25,1024
s_add_u32 m0, s55, 36864
.Lpad17:
s_cbranch_execz .Lnopoll52r
MAA 108,76,44
buffer_load_dwordx4 v21, s[16:19], s52 offen sc1 lds
MAA 92,72,44
TR 30,25,1536
MAA 124,44,80
TR 32,25,1056
MAA 140,44,84
TR 34,25,1568
MAA 144,48,84
buffer_load_dwordx4 v21, s[16:19], s52 offen offset:1024 sc1 lds
MAA 128,48,80
TR 36,25,2048
MAA 132,52,80
TR 38,25,2560
MAA 148,52,84
TR 40,25,2080
MAA 152,56,84
buffer_load_dword v22, s[16:19], s52 offen offset:2048 sc1 lds
MAA 136,56,80
TR 42,25,2592
s_add_u32 s52, s52, 131072
MAA 156,60,80
MAA 160,60,84
s_waitcnt vmcnt(19) lgkmcnt(8)
s_barrier
MAA 60,20,0
RD 44,23,9216
s_waitcnt vmcnt(18)
v_add_f32 v164, v164, v172
MAA 76,24,0
RD 48,23,10240
s_add_u32 m0, s56, 129664
MAA 80,24,4
buffer_load_dwordx4 v18, s[20:23], s54 offen lds
MAA 64,20,4
RD 52,23,11520
v_add_f32 v165, v165, v173
MAA 68,20,8
RD 56,23,12544
v_add_f32 v166, v166, v174
MAA 84,24,8
TR 64,25,12416
v_add_f32 v167, v167, v175
MAA 88,24,12
buffer_load_dwordx4 v19, s[20:23], s54 offen offset:1024 lds
MAA 72,20,12
TR 66,25,12928
s_waitcnt lgkmcnt(6)
MAA 104,28,12
TR 68,25,12448
MAA 120,32,12
TR 70,25,12960
MAA 116,32,8
buffer_load_dwordx4 v20, s[20:23], s54 offen offset:2048 lds
MAA 100,28,8
RD 60,24,11264
s_add_u32 s54, s54, 196608
MAA 96,28,4
TR 72,25,13440
s_add_u32 m0, s55, 46080
MAA 112,32,4
TR 74,25,13952
MAA 108,32,0
buffer_load_dwordx4 v21, s[16:19], s52 offen sc1 lds
MAA 92,28,0
TR 76,25,13472
MAA 124,0,36
TR 78,25,13984
MAA 140,0,40
TR 80,25,14464
MAA 144,4,40
buffer_load_dwordx4 v21, s[16:19], s52 offen offset:1024 sc1 lds
MAA 128,4,36
TR 82,25,14976
MAA 132,8,36
TR 84,25,14496
MAA 148,8,40
TR 86,25,15008
MAA 152,12,40
buffer_load_dword v22, s[16:19], s52 offen offset:2048 sc1 lds
MAA 136,12,36
s_add_u32 s52, s52, 131072
v_permlane32_swap_b32 v164, v166
MAA 156,16,36
v_permlane32_swap_b32 v165, v167
MAA 160,16,40
s_waitcnt vmcnt(18) lgkmcnt(8)
s_barrier
MAA 60,64,44
RD 0,23,18432
v_add_f32 v164, v164, v166
MAA 76,68,44
RD 4,23,19456
s_add_u32 m0, s59, 0
MAA 80,68,48
RD 8,23,20736
s_mov_b32 s58, 1048576
MAA 64,64,48
buffer_load_dwordx4 v5, s[24:27], s58 offen lds
MAA 68,64,52
RD 12,23,21760
v_add_f32 v165, v165, v167
MAA 84,68,52
TR 20,25,24832
v_mul_f32 v164, 0xba800000, v164
MAA 88,68,56
TR 22,25,25344
v_mul_f32 v165, 0x3a800000, v165
MAA 72,64,56
buffer_load_dwordx4 v6, s[24:27], s58 offen offset:1024 lds
s_waitcnt lgkmcnt(6)
MAA 104,72,56
TR 24,25,24864
s_add_u32 m0, s59, 58240
MAA 120,76,56
TR 26,25,25376
s_mov_b32 s58, 1966080
MAA 116,76,52
RD 16,24,20480
v_fma_f32 v165, -v164, v164, v165
MAA 100,72,52
buffer_load_dwordx4 v5, s[24:27], s58 offen lds
MAA 96,72,48
TR 28,25,25856
v_max_f32 v165, 0, v165
MAA 112,76,48
TR 30,25,26368
v_add_f32 v165, 0x3727c5ac, v165
MAA 108,76,44
TR 32,25,25888
MAA 92,72,44
buffer_load_dwordx4 v6, s[24:27], s58 offen offset:1024 lds
MAA 124,44,80
TR 34,25,26400
s_add_u32 m0, s59, 66560
MAA 140,44,84
TR 36,25,26880
s_mov_b32 s58, 0
MAA 144,48,84
TR 38,25,27392
MAA 128,48,80
buffer_load_dwordx4 v5, s[24:27], s58 offen lds
MAA 132,52,80
TR 40,25,26912
MAA 148,52,84
TR 42,25,27424
MAA 152,56,84
v_rsq_f32 v166, v165
MAA 136,56,80
buffer_load_dwordx4 v6, s[24:27], s58 offen offset:1024 lds
MAA 156,60,80
MAA 160,60,84
s_waitcnt vmcnt(18) lgkmcnt(8)
s_barrier
MAA 60,20,0
RD 44,23,27648
v_mov_b32 v165, v166
MAA 76,24,0
RD 48,23,28672
s_add_u32 m0, s59, 8320
MAA 80,24,4
RD 52,23,29952
s_mov_b32 s58, 1179648
MAA 64,20,4
buffer_load_dwordx4 v5, s[24:27], s58 offen lds
MAA 68,20,8
RD 56,23,30976
v_mul_f32 v166, 0x3e8293ee, v166
MAA 84,24,8
ds_write_b128 v7, v[164:167]
MAA 88,24,12
TR 64,25,37248
MAA 72,20,12
buffer_load_dwordx4 v6, s[24:27], s58 offen offset:1024 lds
s_waitcnt lgkmcnt(6)
MAA 104,28,12
TR 66,25,37760
s_add_u32 m0, s59, 74880
MAA 120,32,12
TR 68,25,37280
s_mov_b32 s58, 131072
MAA 116,32,8
TR 70,25,37792
MAA 100,28,8
buffer_load_dwordx4 v5, s[24:27], s58 offen lds
MAA 96,28,4
RD 60,24,29696
MAA 112,32,4
TR 72,25,38272
MAA 108,32,0
TR 74,25,38784
MAA 92,28,0
buffer_load_dwordx4 v6, s[24:27], s58 offen offset:1024 lds
MAA 124,0,36
TR 76,25,38304
s_add_u32 m0, s59, 83200
MAA 140,0,40
TR 78,25,38816
s_mov_b32 s58, 262144
MAA 144,4,40
TR 80,25,39296
MAA 128,4,36
buffer_load_dwordx4 v5, s[24:27], s58 offen lds
MAA 132,8,36
TR 82,25,39808
MAA 148,8,40
TR 84,25,39328
MAA 152,12,40
TR 86,25,39840
MAA 136,12,36
buffer_load_dwordx4 v6, s[24:27], s58 offen offset:1024 lds
MAA 156,16,36
MAA 160,16,40
s_waitcnt vmcnt(18) lgkmcnt(8)
s_barrier
MAA 60,64,44
ds_write_b32 v17, v164
MAA 76,68,44
ds_write_b32 v17, v165 offset:1024
s_add_u32 m0, s59, 16640
MAA 80,68,48
RD 0,23,36864
s_mov_b32 s58, 1310720
MAA 64,64,48
buffer_load_dwordx4 v5, s[24:27], s58 offen lds
MAA 68,64,52
RD 4,23,37888
MAA 84,68,52
RD 8,23,39168
MAA 88,68,56
RD 12,23,40192
MAA 72,64,56
TR 20,25,49664
s_waitcnt lgkmcnt(7)
MAA 104,72,56
TR 22,25,50176
MAA 120,76,56
buffer_load_dwordx4 v6, s[24:27], s58 offen offset:1024 lds
MAA 116,76,52
TR 24,25,49696
s_add_u32 m0, s59, 91520
MAA 100,72,52
TR 26,25,50208
s_mov_b32 s58, 393216
MAA 96,72,48
RD 16,24,38912
MAA 112,76,48
TR 28,25,50688
MAA 108,76,44
TR 30,25,51200
MAA 92,72,44
buffer_load_dwordx4 v5, s[24:27], s58 offen lds
MAA 124,44,80
TR 32,25,50720
MAA 140,44,84
TR 34,25,51232
MAA 144,48,84
TR 36,25,51712
MAA 128,48,80
TR 38,25,52224
MAA 132,52,80
TR 40,25,51744
MAA 148,52,84
buffer_load_dwordx4 v6, s[24:27], s58 offen offset:1024 lds
MAA 152,56,84
TR 42,25,52256
MAA 136,56,80
MAA 156,60,80
MAA 160,60,84
s_waitcnt vmcnt(16) lgkmcnt(8)
s_barrier
MAA 60,20,0
RD 44,23,46080
MAA 76,24,0
RD 48,23,47104
s_add_u32 m0, s59, 24960
MAA 80,24,4
RD 52,23,48384
s_mov_b32 s58, 1441792
MAA 64,20,4
buffer_load_dwordx4 v5, s[24:27], s58 offen lds
MAA 68,20,8
RD 56,23,49408
MAA 84,24,8
TR 64,25,62080
MAA 88,24,12
TR 66,25,62592
MAA 72,20,12
buffer_load_dwordx4 v6, s[24:27], s58 offen offset:1024 lds
s_waitcnt lgkmcnt(6)
MAA 104,28,12
TR 68,25,62112
s_add_u32 m0, s59, 99840
MAA 120,32,12
TR 70,25,62624
s_mov_b32 s58, 524288
MAA 116,32,8
RD 60,24,48128
MAA 100,28,8
buffer_load_dwordx4 v5, s[24:27], s58 offen lds
MAA 96,28,4
TR 72,25,63104
MAA 112,32,4
TR 74,25,63616
MAA 108,32,0
TR 76,25,63136
MAA 92,28,0
buffer_load_dwordx4 v6, s[24:27], s58 offen offset:1024 lds
MAA 124,0,36
TR 78,25,63648
s_add_u32 m0, s59, 108160
MAA 140,0,40
TR 80,25,64128
s_mov_b32 s58, 655360
MAA 144,4,40
TR 82,25,64640
MAA 128,4,36
buffer_load_dwordx4 v5, s[24:27], s58 offen lds
MAA 132,8,36
TR 84,25,64160
MAA 148,8,40
TR 86,25,64672
MAA 152,12,40
MAA 136,12,36
buffer_load_dwordx4 v6, s[24:27], s58 offen offset:1024 lds
MAA 156,16,36
MAA 160,16,40
s_waitcnt lgkmcnt(0)
s_barrier
MAA 156,60,80
ds_read_b128 v[232:235], v10 offset:1792
s_add_u32 m0, s59, 33280
MAA 160,60,84
ds_read_b128 v[228:231], v10 offset:1536
s_mov_b32 s58, 1572864
MAA 104,72,56
ds_read_b128 v[224:227], v10 offset:1280
MAA 120,76,56
ds_read_b128 v[220:223], v10 offset:1024
MAA 136,56,80
ds_read_b128 v[240:243], v11 offset:704
MAA 152,56,84
ds_read_b128 v[244:247], v11 offset:1728
MAA 100,72,52
buffer_load_dwordx4 v5, s[24:27], s58 offen lds
MAA 116,76,52
ds_read_b128 v[18:21], v11 offset:448
MAA 96,72,48
ds_read_b128 v[22:25], v11 offset:1472
s_waitcnt lgkmcnt(7)
v_pk_fma_f32 v[104:105], v[36:37], v[232:233], v[104:105] op_sel_hi:[1,0,1]
v_pk_mul_f32 v[104:105], v[104:105], v[232:233] op_sel:[0,1] op_sel_hi:[1,1]
v_pk_fma_f32 v[106:107], v[38:39], v[232:233], v[106:107] op_sel_hi:[1,0,1]
v_pk_mul_f32 v[106:107], v[106:107], v[232:233] op_sel:[0,1] op_sel_hi:[1,1]
v_pk_fma_f32 v[120:121], v[40:41], v[232:233], v[120:121] op_sel_hi:[1,0,1]
v_pk_mul_f32 v[120:121], v[120:121], v[232:233] op_sel:[0,1] op_sel_hi:[1,1]
v_pk_fma_f32 v[122:123], v[42:43], v[232:233], v[122:123] op_sel_hi:[1,0,1]
v_pk_mul_f32 v[122:123], v[122:123], v[232:233] op_sel:[0,1] op_sel_hi:[1,1]
s_waitcnt lgkmcnt(6)
v_pk_fma_f32 v[100:101], v[36:37], v[228:229], v[100:101] op_sel_hi:[1,0,1]
v_pk_mul_f32 v[100:101], v[100:101], v[228:229] op_sel:[0,1] op_sel_hi:[1,1]
s_waitcnt lgkmcnt(3)
v_pk_fma_f32 v[156:157], v[240:241], v[44:45], v[156:157] op_sel_hi:[1,0,1]
v_pk_fma_f32 v[158:159], v[242:243], v[44:45], v[158:159] op_sel_hi:[1,0,1]
v_pk_fma_f32 v[160:161], v[240:241], v[44:45], v[160:161] op_sel:[0,1,0] op_sel_hi:[1,1,1]
v_pk_fma_f32 v[162:163], v[242:243], v[44:45], v[162:163] op_sel:[0,1,0] op_sel_hi:[1,1,1]
s_waitcnt lgkmcnt(2)
v_pk_mul_f32 v[156:157], v[156:157], v[244:245]
v_pk_mul_f32 v[158:159], v[158:159], v[246:247]
v_pk_mul_f32 v[160:161], v[160:161], v[244:245]
v_pk_mul_f32 v[162:163], v[162:163], v[246:247]
v_pk_fma_f32 v[102:103], v[38:39], v[228:229], v[102:103] op_sel_hi:[1,0,1]
v_pk_mul_f32 v[102:103], v[102:103], v[228:229] op_sel:[0,1] op_sel_hi:[1,1]
v_pk_fma_f32 v[116:117], v[40:41], v[228:229], v[116:117] op_sel_hi:[1,0,1]
v_pk_mul_f32 v[116:117], v[116:117], v[228:229] op_sel:[0,1] op_sel_hi:[1,1]
s_waitcnt lgkmcnt(1)
v_pk_fma_f32 v[136:137], v[18:19], v[44:45], v[136:137] op_sel_hi:[1,0,1]
v_pk_fma_f32 v[138:139], v[20:21], v[44:45], v[138:139] op_sel_hi:[1,0,1]
v_pk_fma_f32 v[152:153], v[18:19], v[44:45], v[152:153] op_sel:[0,1,0] op_sel_hi:[1,1,1]
v_pk_fma_f32 v[154:155], v[20:21], v[44:45], v[154:155] op_sel:[0,1,0] op_sel_hi:[1,1,1]
s_waitcnt lgkmcnt(0)
v_pk_mul_f32 v[136:137], v[136:137], v[22:23]
v_pk_mul_f32 v[138:139], v[138:139], v[24:25]
v_pk_mul_f32 v[152:153], v[152:153], v[22:23]
v_pk_mul_f32 v[154:155], v[154:155], v[24:25]
v_pk_fma_f32 v[118:119], v[42:43], v[228:229], v[118:119] op_sel_hi:[1,0,1]
v_pk_mul_f32 v[118:119], v[118:119], v[228:229] op_sel:[0,1] op_sel_hi:[1,1]
v_pk_fma_f32 v[96:97], v[36:37], v[224:225], v[96:97] op_sel_hi:[1,0,1]
v_pk_mul_f32 v[96:97], v[96:97], v[224:225] op_sel:[0,1] op_sel_hi:[1,1]
v_pk_fma_f32 v[98:99], v[38:39], v[224:225], v[98:99] op_sel_hi:[1,0,1]
v_pk_mul_f32 v[98:99], v[98:99], v[224:225] op_sel:[0,1] op_sel_hi:[1,1]
v_cvt_pk_bf16_f32 v236, v156, v157
v_cvt_pk_bf16_f32 v237, v158, v159
MAA 112,76,48
buffer_load_dwordx4 v6, s[24:27], s58 offen offset:1024 lds
MAA 92,72,44
ds_read_b128 v[240:243], v11 offset:384
v_cvt_pk_bf16_f32 v238, v160, v161
MAA 108,76,44
ds_read_b128 v[244:247], v11 offset:1408
v_cvt_pk_bf16_f32 v239, v162, v163
MAA 72,64,56
ds_write_b128 v8, v[236:239] offset:1024
s_add_u32 m0, s59, 41600
MAA 88,68,56
ds_read_b128 v[18:21], v11 offset:320
s_mov_b32 s58, 1703936
buffer_load_dwordx4 v5, s[24:27], s58 offen lds
s_nop 1
v_pk_fma_f32 v[72:73], v[28:29], v[232:233], v[72:73] op_sel_hi:[1,0,1]
v_pk_fma_f32 v[74:75], v[30:31], v[232:233], v[74:75] op_sel_hi:[1,0,1]
s_nop 0
v_pk_fma_f32 v[88:89], v[32:33], v[232:233], v[88:89] op_sel_hi:[1,0,1]
v_pk_fma_f32 v[90:91], v[34:35], v[232:233], v[90:91] op_sel_hi:[1,0,1]
v_pk_fma_f32 v[112:113], v[40:41], v[224:225], v[112:113] op_sel_hi:[1,0,1]
v_pk_mul_f32 v[112:113], v[112:113], v[224:225] op_sel:[0,1] op_sel_hi:[1,1]
v_pk_fma_f32 v[114:115], v[42:43], v[224:225], v[114:115] op_sel_hi:[1,0,1]
v_pk_mul_f32 v[114:115], v[114:115], v[224:225] op_sel:[0,1] op_sel_hi:[1,1]
v_pk_fma_f32 v[92:93], v[36:37], v[220:221], v[92:93] op_sel_hi:[1,0,1]
v_pk_mul_f32 v[92:93], v[92:93], v[220:221] op_sel:[0,1] op_sel_hi:[1,1]
v_pk_fma_f32 v[94:95], v[38:39], v[220:221], v[94:95] op_sel_hi:[1,0,1]
v_pk_mul_f32 v[94:95], v[94:95], v[220:221] op_sel:[0,1] op_sel_hi:[1,1]
v_pk_fma_f32 v[108:109], v[40:41], v[220:221], v[108:109] op_sel_hi:[1,0,1]
v_pk_mul_f32 v[108:109], v[108:109], v[220:221] op_sel:[0,1] op_sel_hi:[1,1]
v_pk_fma_f32 v[110:111], v[42:43], v[220:221], v[110:111] op_sel_hi:[1,0,1]
v_pk_mul_f32 v[110:111], v[110:111], v[220:221] op_sel:[0,1] op_sel_hi:[1,1]
v_cvt_pk_bf16_f32 v196, v104, v105
v_cvt_pk_bf16_f32 v197, v106, v107
MAA 132,52,80
buffer_load_dwordx4 v6, s[24:27], s58 offen offset:1024 lds
MAA 148,52,84
s_waitcnt lgkmcnt(1)
s_barrier
ds_read_b128 v[180:183], v9
MAA 68,64,52
ds_read_b64 v[200:201], v9 offset:1024
s_add_u32 m0, s59, 49920
MAA 84,68,52
ds_read_b64 v[210:211], v9 offset:1032
s_mov_b32 s58, 1835008
MAA 128,48,80
buffer_load_dwordx4 v5, s[24:27], s58 offen lds
v_cvt_pk_bf16_f32 v198, v120, v121
v_cvt_pk_bf16_f32 v199, v122, v123
v_cvt_pk_bf16_f32 v208, v136, v137
v_pk_fma_f32 v[132:133], v[240:241], v[44:45], v[132:133] op_sel_hi:[1,0,1]
v_pk_mul_f32 v[132:133], v[132:133], v[244:245]
v_pk_fma_f32 v[134:135], v[242:243], v[44:45], v[134:135] op_sel_hi:[1,0,1]
v_pk_mul_f32 v[134:135], v[134:135], v[246:247]
v_pk_fma_f32 v[148:149], v[240:241], v[44:45], v[148:149] op_sel:[0,1,0] op_sel_hi:[1,1,1]
v_pk_mul_f32 v[148:149], v[148:149], v[244:245]
v_pk_fma_f32 v[150:151], v[242:243], v[44:45], v[150:151] op_sel:[0,1,0] op_sel_hi:[1,1,1]
v_pk_mul_f32 v[150:151], v[150:151], v[246:247]
v_pk_fma_f32 v[68:69], v[28:29], v[228:229], v[68:69] op_sel_hi:[1,0,1]
v_pk_fma_f32 v[70:71], v[30:31], v[228:229], v[70:71] op_sel_hi:[1,0,1]
v_pk_fma_f32 v[84:85], v[32:33], v[228:229], v[84:85] op_sel_hi:[1,0,1]
v_pk_fma_f32 v[86:87], v[34:35], v[228:229], v[86:87] op_sel_hi:[1,0,1]
s_waitcnt lgkmcnt(3)
v_pk_fma_f32 v[128:129], v[18:19], v[44:45], v[128:129] op_sel_hi:[1,0,1]
v_pk_fma_f32 v[130:131], v[20:21], v[44:45], v[130:131] op_sel_hi:[1,0,1]
v_cvt_pk_bf16_f32 v209, v138, v139
v_cvt_pk_bf16_f32 v218, v152, v153
MAA 144,48,84
buffer_load_dwordx4 v6, s[24:27], s58 offen offset:1024 lds
MAA 64,64,48
ds_read_b128 v[22:25], v11 offset:1344
s_add_u32 m0, s59, 116480
MAA 80,68,48
ds_read_b128 v[240:243], v11 offset:256
s_mov_b32 s58, 786432
MAA 124,44,80
ds_read_b128 v[244:247], v11 offset:1280
v_cvt_pk_bf16_f32 v219, v154, v155
MAA 140,44,84
buffer_load_dwordx4 v5, s[24:27], s58 offen lds
MAA 60,64,44
v_cvt_pk_bf16_f32 v192, v100, v101
v_cvt_pk_bf16_f32 v193, v102, v103
MAA 76,68,44
v_cvt_pk_bf16_f32 v194, v116, v117
v_cvt_pk_bf16_f32 v195, v118, v119
v_cvt_pk_bf16_f32 v176, v72, v73
v_cvt_pk_bf16_f32 v177, v74, v75
v_cvt_pk_bf16_f32 v178, v88, v89
v_cvt_pk_bf16_f32 v179, v90, v91
v_pk_fma_f32 v[144:145], v[18:19], v[44:45], v[144:145] op_sel:[0,1,0] op_sel_hi:[1,1,1]
v_pk_fma_f32 v[146:147], v[20:21], v[44:45], v[146:147] op_sel:[0,1,0] op_sel_hi:[1,1,1]
v_pk_fma_f32 v[64:65], v[28:29], v[224:225], v[64:65] op_sel_hi:[1,0,1]
v_pk_fma_f32 v[66:67], v[30:31], v[224:225], v[66:67] op_sel_hi:[1,0,1]
v_pk_fma_f32 v[80:81], v[32:33], v[224:225], v[80:81] op_sel_hi:[1,0,1]
s_waitcnt lgkmcnt(2)
v_pk_mul_f32 v[128:129], v[128:129], v[22:23]
v_pk_mul_f32 v[130:131], v[130:131], v[24:25]
v_pk_mul_f32 v[144:145], v[144:145], v[22:23]
v_pk_mul_f32 v[146:147], v[146:147], v[24:25]
v_pk_fma_f32 v[82:83], v[34:35], v[224:225], v[82:83] op_sel_hi:[1,0,1]
s_waitcnt lgkmcnt(1)
v_pk_fma_f32 v[124:125], v[240:241], v[44:45], v[124:125] op_sel_hi:[1,0,1]
v_pk_fma_f32 v[126:127], v[242:243], v[44:45], v[126:127] op_sel_hi:[1,0,1]
v_pk_fma_f32 v[140:141], v[240:241], v[44:45], v[140:141] op_sel:[0,1,0] op_sel_hi:[1,1,1]
s_waitcnt lgkmcnt(0)
v_pk_mul_f32 v[124:125], v[124:125], v[244:245]
v_pk_mul_f32 v[126:127], v[126:127], v[246:247]
v_pk_mul_f32 v[140:141], v[140:141], v[244:245]
v_pk_fma_f32 v[142:143], v[242:243], v[44:45], v[142:143] op_sel:[0,1,0] op_sel_hi:[1,1,1]
v_pk_mul_f32 v[142:143], v[142:143], v[246:247]
v_pk_fma_f32 v[60:61], v[28:29], v[220:221], v[60:61] op_sel_hi:[1,0,1]
v_pk_fma_f32 v[62:63], v[30:31], v[220:221], v[62:63] op_sel_hi:[1,0,1]
v_pk_fma_f32 v[76:77], v[32:33], v[220:221], v[76:77] op_sel_hi:[1,0,1]
v_pk_fma_f32 v[78:79], v[34:35], v[220:221], v[78:79] op_sel_hi:[1,0,1]
v_cvt_pk_bf16_f32 v206, v132, v133
v_cvt_pk_bf16_f32 v207, v134, v135
v_mfma_f32_16x16x32_bf16 v[104:107], v[192:195], v[176:179], v[46:49]
buffer_load_dwordx4 v6, s[24:27], s58 offen offset:1024 lds
v_mfma_f32_16x16x32_bf16 v[120:123], v[196:199], v[176:179], v[50:53]
s_add_u32 m0, s59, 124800
s_mov_b32 s58, 917504
v_cvt_pk_bf16_f32 v216, v148, v149
v_cvt_pk_bf16_f32 v217, v150, v151
s_nop 1
v_max3_f32 v88, v104, v105, v106
v_cvt_pk_bf16_f32 v188, v96, v97
v_cvt_pk_bf16_f32 v189, v98, v99
v_cvt_pk_bf16_f32 v190, v112, v113
v_max3_f32 v89, v107, v120, v121
v_max3_f32 v88, v88, v122, v123
v_max_f32 v90, v88, v89
v_max_f32 v89, v88, v89
buffer_load_dwordx4 v5, s[24:27], s58 offen lds
s_nop 0
v_permlane16_swap_b32 v90, v89
v_cvt_pk_bf16_f32 v191, v114, v115
v_max_f32 v88, v90, v89
v_max_f32 v89, v90, v89
v_cvt_pk_bf16_f32 v172, v68, v69
v_cvt_pk_bf16_f32 v173, v70, v71
v_permlane32_swap_b32 v88, v89
v_cvt_pk_bf16_f32 v174, v84, v85
.Lpad18:
s_cbranch_execz .Lnopoll52r
v_max_f32 v88, v88, v89
v_mul_f32 v88, v88, v234
v_pk_fma_f32 v[104:105], v[104:105], v[234:235], v[88:89] op_sel_hi:[1,0,0] neg_lo:[0,0,1] neg_hi:[0,0,1]
buffer_load_dwordx4 v6, s[24:27], s58 offen offset:1024 lds
v_pk_fma_f32 v[106:107], v[106:107], v[234:235], v[88:89] op_sel_hi:[1,0,0] neg_lo:[0,0,1] neg_hi:[0,0,1]
v_pk_fma_f32 v[120:121], v[120:121], v[234:235], v[88:89] op_sel_hi:[1,0,0] neg_lo:[0,0,1] neg_hi:[0,0,1]
v_pk_fma_f32 v[122:123], v[122:123], v[234:235], v[88:89] op_sel_hi:[1,0,0] neg_lo:[0,0,1] neg_hi:[0,0,1]
v_exp_f32 v104, v104
v_exp_f32 v105, v105
v_exp_f32 v106, v106
v_exp_f32 v107, v107
v_exp_f32 v120, v120
v_exp_f32 v121, v121
v_exp_f32 v122, v122
v_exp_f32 v123, v123
v_cvt_pk_bf16_f32 v72, v104, v105
v_cvt_pk_bf16_f32 v73, v106, v107
v_cvt_pk_bf16_f32 v74, v120, v121
v_cvt_pk_bf16_f32 v75, v122, v123
v_cvt_pk_bf16_f32 v175, v86, v87
v_cvt_pk_bf16_f32 v204, v128, v129
v_mfma_f32_16x16x32_bf16 v[88:91], v[248:251], v[72:75], 0
v_cvt_pk_bf16_f32 v205, v130, v131
v_cvt_pk_bf16_f32 v214, v144, v145
v_mfma_f32_16x16x32_bf16 v[104:107], v[206:209], v[72:75], 0
v_cvt_pk_bf16_f32 v215, v146, v147
v_cvt_pk_bf16_f32 v184, v92, v93
v_mfma_f32_16x16x32_bf16 v[120:123], v[216:219], v[72:75], 0
s_nop 1
v_rcp_f32 v88, v88
v_mfma_f32_16x16x32_bf16 v[100:103], v[188:191], v[172:175], v[46:49]
v_cvt_pk_bf16_f32 v185, v94, v95
v_cvt_pk_bf16_f32 v186, v108, v109
v_mfma_f32_16x16x32_bf16 v[116:119], v[192:195], v[172:175], v[50:53]
v_cvt_pk_bf16_f32 v187, v110, v111
v_cvt_pk_bf16_f32 v168, v64, v65
v_cvt_pk_bf16_f32 v169, v66, v67
s_nop 1
v_max3_f32 v84, v100, v101, v102
v_cvt_pk_bf16_f32 v170, v80, v81
v_pk_mul_f32 v[104:105], v[104:105], v[88:89] op_sel_hi:[1,0]
v_pk_mul_f32 v[106:107], v[106:107], v[88:89] op_sel_hi:[1,0]
v_pk_mul_f32 v[120:121], v[120:121], v[88:89] op_sel_hi:[1,0]
v_pk_mul_f32 v[122:123], v[122:123], v[88:89] op_sel_hi:[1,0]
v_cvt_pk_bf16_f32 v176, v104, v105
v_cvt_pk_bf16_f32 v177, v106, v107
v_cvt_pk_bf16_f32 v178, v120, v121
v_cvt_pk_bf16_f32 v179, v122, v123
buffer_store_dwordx4 v[176:179], v4, s[16:19], s74 offen offset:3072 sc1
v_max3_f32 v85, v103, v116, v117
v_max3_f32 v84, v84, v118, v119
v_max_f32 v86, v84, v85
v_max_f32 v85, v84, v85
v_cvt_pk_bf16_f32 v171, v82, v83
v_cvt_pk_bf16_f32 v202, v124, v125
v_permlane16_swap_b32 v86, v85
v_mfma_f32_16x16x32_bf16 v[96:99], v[184:187], v[168:171], v[46:49]
v_max_f32 v84, v86, v85
v_max_f32 v85, v86, v85
v_mfma_f32_16x16x32_bf16 v[112:115], v[188:191], v[168:171], v[50:53]
s_nop 0
v_permlane32_swap_b32 v84, v85
v_cvt_pk_bf16_f32 v203, v126, v127
v_max_f32 v84, v84, v85
v_mul_f32 v84, v84, v230
v_pk_fma_f32 v[100:101], v[100:101], v[230:231], v[84:85] op_sel_hi:[1,0,0] neg_lo:[0,0,1] neg_hi:[0,0,1]
v_pk_fma_f32 v[102:103], v[102:103], v[230:231], v[84:85] op_sel_hi:[1,0,0] neg_lo:[0,0,1] neg_hi:[0,0,1]
v_pk_fma_f32 v[116:117], v[116:117], v[230:231], v[84:85] op_sel_hi:[1,0,0] neg_lo:[0,0,1] neg_hi:[0,0,1]
v_pk_fma_f32 v[118:119], v[118:119], v[230:231], v[84:85] op_sel_hi:[1,0,0] neg_lo:[0,0,1] neg_hi:[0,0,1]
v_exp_f32 v100, v100
v_exp_f32 v101, v101
v_exp_f32 v102, v102
v_exp_f32 v103, v103
v_exp_f32 v116, v116
v_exp_f32 v117, v117
v_exp_f32 v118, v118
v_exp_f32 v119, v119
v_cvt_pk_bf16_f32 v68, v100, v101
v_cvt_pk_bf16_f32 v69, v102, v103
v_cvt_pk_bf16_f32 v70, v116, v117
v_cvt_pk_bf16_f32 v71, v118, v119
v_cvt_pk_bf16_f32 v212, v140, v141
v_cvt_pk_bf16_f32 v213, v142, v143
v_mfma_f32_16x16x32_bf16 v[84:87], v[248:251], v[68:71], 0
v_max3_f32 v80, v96, v97, v98
v_max3_f32 v81, v99, v112, v113
v_mfma_f32_16x16x32_bf16 v[100:103], v[204:207], v[68:71], 0
v_max3_f32 v80, v80, v114, v115
v_max_f32 v82, v80, v81
v_mfma_f32_16x16x32_bf16 v[116:119], v[214:217], v[68:71], 0
s_nop 1
v_rcp_f32 v84, v84
v_max_f32 v81, v80, v81
v_cvt_pk_bf16_f32 v164, v60, v61
v_cvt_pk_bf16_f32 v165, v62, v63
v_pk_mul_f32 v[100:101], v[100:101], v[84:85] op_sel_hi:[1,0]
v_pk_mul_f32 v[102:103], v[102:103], v[84:85] op_sel_hi:[1,0]
v_pk_mul_f32 v[116:117], v[116:117], v[84:85] op_sel_hi:[1,0]
v_pk_mul_f32 v[118:119], v[118:119], v[84:85] op_sel_hi:[1,0]
v_cvt_pk_bf16_f32 v172, v100, v101
v_cvt_pk_bf16_f32 v173, v102, v103
v_cvt_pk_bf16_f32 v174, v116, v117
v_cvt_pk_bf16_f32 v175, v118, v119
buffer_store_dwordx4 v[172:175], v4, s[16:19], s74 offen offset:2048 sc1
v_permlane16_swap_b32 v82, v81
v_cvt_pk_bf16_f32 v166, v76, v77
v_max_f32 v80, v82, v81
v_max_f32 v81, v82, v81
v_cvt_pk_bf16_f32 v167, v78, v79
s_nop 0
v_permlane32_swap_b32 v80, v81
v_mfma_f32_16x16x32_bf16 v[92:95], v[180:183], v[164:167], v[46:49]
v_max_f32 v80, v80, v81
v_mul_f32 v80, v80, v226
v_mfma_f32_16x16x32_bf16 v[108:111], v[184:187], v[164:167], v[50:53]
s_nop 4
v_max3_f32 v76, v92, v93, v94
v_pk_fma_f32 v[96:97], v[96:97], v[226:227], v[80:81] op_sel_hi:[1,0,0] neg_lo:[0,0,1] neg_hi:[0,0,1]
v_pk_fma_f32 v[98:99], v[98:99], v[226:227], v[80:81] op_sel_hi:[1,0,0] neg_lo:[0,0,1] neg_hi:[0,0,1]
v_pk_fma_f32 v[112:113], v[112:113], v[226:227], v[80:81] op_sel_hi:[1,0,0] neg_lo:[0,0,1] neg_hi:[0,0,1]
v_pk_fma_f32 v[114:115], v[114:115], v[226:227], v[80:81] op_sel_hi:[1,0,0] neg_lo:[0,0,1] neg_hi:[0,0,1]
v_exp_f32 v96, v96
v_exp_f32 v97, v97
v_exp_f32 v98, v98
v_exp_f32 v99, v99
v_exp_f32 v112, v112
v_exp_f32 v113, v113
v_exp_f32 v114, v114
v_exp_f32 v115, v115
v_cvt_pk_bf16_f32 v64, v96, v97
v_cvt_pk_bf16_f32 v65, v98, v99
v_cvt_pk_bf16_f32 v66, v112, v113
v_cvt_pk_bf16_f32 v67, v114, v115
v_max3_f32 v77, v95, v108, v109
v_max3_f32 v76, v76, v110, v111
v_mfma_f32_16x16x32_bf16 v[80:83], v[248:251], v[64:67], 0
v_max_f32 v78, v76, v77
v_max_f32 v77, v76, v77
v_mfma_f32_16x16x32_bf16 v[96:99], v[202:205], v[64:67], 0
s_nop 0
v_permlane16_swap_b32 v78, v77
v_mfma_f32_16x16x32_bf16 v[112:115], v[212:215], v[64:67], 0
s_nop 1
v_rcp_f32 v80, v80
v_max_f32 v76, v78, v77
v_max_f32 v77, v78, v77
v_pk_mul_f32 v[96:97], v[96:97], v[80:81] op_sel_hi:[1,0]
v_pk_mul_f32 v[98:99], v[98:99], v[80:81] op_sel_hi:[1,0]
s_nop 0
v_pk_mul_f32 v[112:113], v[112:113], v[80:81] op_sel_hi:[1,0]
v_pk_mul_f32 v[114:115], v[114:115], v[80:81] op_sel_hi:[1,0]
v_cvt_pk_bf16_f32 v168, v96, v97
v_cvt_pk_bf16_f32 v169, v98, v99
v_cvt_pk_bf16_f32 v170, v112, v113
v_cvt_pk_bf16_f32 v171, v114, v115
buffer_store_dwordx4 v[168:171], v4, s[16:19], s74 offen offset:1024 sc1
v_permlane32_swap_b32 v76, v77
v_max_f32 v76, v76, v77
v_mul_f32 v76, v76, v222
v_pk_fma_f32 v[92:93], v[92:93], v[222:223], v[76:77] op_sel_hi:[1,0,0] neg_lo:[0,0,1] neg_hi:[0,0,1]
v_pk_fma_f32 v[94:95], v[94:95], v[222:223], v[76:77] op_sel_hi:[1,0,0] neg_lo:[0,0,1] neg_hi:[0,0,1]
v_pk_fma_f32 v[108:109], v[108:109], v[222:223], v[76:77] op_sel_hi:[1,0,0] neg_lo:[0,0,1] neg_hi:[0,0,1]
v_pk_fma_f32 v[110:111], v[110:111], v[222:223], v[76:77] op_sel_hi:[1,0,0] neg_lo:[0,0,1] neg_hi:[0,0,1]
v_exp_f32 v92, v92
v_exp_f32 v93, v93
v_exp_f32 v94, v94
v_exp_f32 v95, v95
v_exp_f32 v108, v108
v_exp_f32 v109, v109
v_exp_f32 v110, v110
v_exp_f32 v111, v111
v_cvt_pk_bf16_f32 v60, v92, v93
v_cvt_pk_bf16_f32 v61, v94, v95
v_cvt_pk_bf16_f32 v62, v108, v109
v_cvt_pk_bf16_f32 v63, v110, v111
s_nop 1
v_mfma_f32_16x16x32_bf16 v[76:79], v[248:251], v[60:63], 0
v_mfma_f32_16x16x32_bf16 v[92:95], v[200:203], v[60:63], 0
v_mfma_f32_16x16x32_bf16 v[108:111], v[210:213], v[60:63], 0
s_nop 5
v_rcp_f32 v76, v76
s_nop 0
v_pk_mul_f32 v[92:93], v[92:93], v[76:77] op_sel_hi:[1,0]
v_pk_mul_f32 v[94:95], v[94:95], v[76:77] op_sel_hi:[1,0]
v_pk_mul_f32 v[108:109], v[108:109], v[76:77] op_sel_hi:[1,0]
v_pk_mul_f32 v[110:111], v[110:111], v[76:77] op_sel_hi:[1,0]
v_cvt_pk_bf16_f32 v164, v92, v93
v_cvt_pk_bf16_f32 v165, v94, v95
v_cvt_pk_bf16_f32 v166, v108, v109
v_cvt_pk_bf16_f32 v167, v110, v111
buffer_store_dwordx4 v[164:167], v4, s[16:19], s74 offen sc1
s_nop 1
.Lqkve55:
.Lpad19:
s_cbranch_execz .Lnopoll52r
s_lshl_b32 s62, s3, 11
s_add_u32 s62, s62, s84
v_lshl_add_u32 v4, v1, 4, s62
v_lshrrev_b32 v2, 3, v1
v_cmp_eq_u32 vcc, 3, v2
v_add_u32 v2, 67108480, v4
s_nop 0
v_cndmask_b32 v4, v4, v2, vcc
v_bfe_u32 v5, v1, 3, 1
v_lshrrev_b32 v2, 4, v1
v_lshl_add_u32 v5, v2, 3, v5
s_lshl_b32 s62, s3, 1
v_add_u32 v5, s62, v5
v_mul_u32_u24 v5, 2048, v5
v_and_b32 v2, 7, v1
v_lshl_add_u32 v5, v2, 4, v5
s_lshl_b32 s62, s7, 7
v_add_u32 v5, s62, v5
v_add_u32 v6, 64512, v5
v_bfe_u32 v8, v1, 3, 2
v_mul_u32_u24 v8, 2080, v8
v_bfe_u32 v2, v1, 2, 1
v_lshl_add_u32 v8, v2, 7, v8
v_bfe_u32 v2, v1, 5, 1
v_lshl_add_u32 v8, v2, 8, v8
v_and_b32 v2, 3, v1
v_lshl_add_u32 v8, v2, 3, v8
s_mov_b32 s57, 66560
v_add_u32 v7, s57, v8
s_mov_b32 s52, 37748736
s_mov_b32 s53, 37879808
s_mov_b32 s54, 2097152
s_mul_i32 s56, s3, 2080
v_accvgpr_read_b32 v32, a224
v_accvgpr_read_b32 v33, a225
v_accvgpr_read_b32 v34, a226
v_accvgpr_read_b32 v35, a227
v_accvgpr_read_b32 v36, a228
v_accvgpr_read_b32 v37, a229
v_accvgpr_read_b32 v38, a230
v_accvgpr_read_b32 v39, a231
v_accvgpr_read_b32 v40, a232
v_accvgpr_read_b32 v41, a233
v_accvgpr_read_b32 v42, a234
v_accvgpr_read_b32 v43, a235
v_accvgpr_read_b32 v44, a236
v_accvgpr_read_b32 v45, a237
v_accvgpr_read_b32 v46, a238
v_accvgpr_read_b32 v47, a239
v_accvgpr_read_b32 v48, a240
v_accvgpr_read_b32 v49, a241
v_accvgpr_read_b32 v50, a242
v_accvgpr_read_b32 v51, a243
v_accvgpr_read_b32 v52, a244
v_accvgpr_read_b32 v53, a245
v_accvgpr_read_b32 v54, a246
v_accvgpr_read_b32 v55, a247
v_accvgpr_read_b32 v56, a248
v_accvgpr_read_b32 v57, a249
v_accvgpr_read_b32 v58, a250
v_accvgpr_read_b32 v59, a251
v_accvgpr_read_b32 v60, a252
v_accvgpr_read_b32 v61, a253
v_accvgpr_read_b32 v62, a254
v_accvgpr_read_b32 v63, a255
s_lshl_b32 s62, s49, 3
s_add_u32 s62, s62, s48
s_mul_i32 s62, s62, 28672
s_add_u32 s62, s62, s51
v_lshrrev_b32 v12, 4, v1
v_mul_u32_u24 v12, 57344, v12
v_and_b32 v2, 15, v1
v_lshl_add_u32 v12, v2, 4, v12
v_add_u32 v12, s62, v12
v_add_u32 v13, 6112, v12
v_add_u32 v14, 12224, v12
v_add_u32 v15, 18336, v12
s_mul_i32 s59, s3, 4224
s_mov_b32 s58, 0
s_lshl_b32 s62, s8, 10
s_add_u32 s62, s62, 30490624
s_lshl_b32 s64, s6, 10
s_add_u32 s64, s64, 30490624
s_lshr_b32 s67, s5, 2
s_and_b32 s67, s67, 3
s_lshl_b32 s67, s67, 7
s_add_u32 s64, s64, s67
v_lshl_add_u32 v252, v1, 7, s62
v_mov_b32 v253, s64
v_mov_b32 v255, 1
s_waitcnt vmcnt(0) lgkmcnt(0)
s_cmp_lg_u32 s3, 1
s_barrier
s_cbranch_scc1 .Lnopoll59
s_mov_b64 exec, 15
buffer_atomic_add v255, v252, s[16:19], 0 offen
s_mov_b64 exec, 1
v_mov_b32 v254, 0
buffer_atomic_add v254, v253, s[16:19], 0 offen sc0
s_sleep 5
s_mov_b32 s15, 0
.Lpoll58:
v_mov_b32 v255, 0
buffer_atomic_add v255, v253, s[16:19], 0 offen sc0
s_waitcnt vmcnt(1)
v_cmp_gt_u32 vcc, 16, v254
s_add_u32 s15, s15, 1
s_cbranch_vccz .Lnopoll59r
v_mov_b32 v254, 0
buffer_atomic_add v254, v253, s[16:19], 0 offen sc0
s_waitcnt vmcnt(1)
v_cmp_gt_u32 vcc, 16, v255
s_add_u32 s15, s15, 1
s_cbranch_vccz .Lnopoll59r
s_cmp_le_u32 s15, 100000
s_cbranch_scc1 .Lpoll58
s_branch .Lnopoll59r
.Lnopoll59:
s_mov_b64 exec, 0
s_cmp_eq_u32 s3, 2
s_cbranch_scc1 .Lpad20
s_cmp_eq_u32 s3, 3
s_cbranch_scc1 .Lpad21
s_branch .Lpad22
.Lnopoll59r:
s_mov_b64 exec, -1
s_barrier
buffer_load_dwordx4 v[64:67], v4, s[16:19], s52 offen sc1
buffer_load_dwordx4 v[68:71], v4, s[16:19], s52 offen offset:1024 sc1
s_add_u32 s52, s52, 262144
buffer_load_dwordx4 v[72:75], v4, s[16:19], s53 offen sc1
buffer_load_dwordx4 v[76:79], v4, s[16:19], s53 offen offset:1024 sc1
s_add_u32 s53, s53, 262144
buffer_load_dwordx4 v[80:83], v4, s[16:19], s52 offen sc1
buffer_load_dwordx4 v[84:87], v4, s[16:19], s52 offen offset:1024 sc1
s_add_u32 s52, s52, 262144
buffer_load_dwordx4 v[88:91], v4, s[16:19], s53 offen sc1
buffer_load_dwordx4 v[92:95], v4, s[16:19], s53 offen offset:1024 sc1
s_add_u32 s53, s53, 262144
buffer_load_dwordx4 v[96:99], v4, s[16:19], s52 offen sc1
buffer_load_dwordx4 v[100:103], v4, s[16:19], s52 offen offset:1024 sc1
s_add_u32 s52, s52, 262144
buffer_load_dwordx4 v[104:107], v4, s[16:19], s53 offen sc1
buffer_load_dwordx4 v[108:111], v4, s[16:19], s53 offen offset:1024 sc1
s_add_u32 s53, s53, 262144
ds_read_b64_tr_b16 a[0:1], v7
TR 2,7,512
TR 16,7,1024
TR 18,7,1536
TR 4,7,32
TR 6,7,544
TR 20,7,1056
TR 22,7,1568
TR 8,7,64
TR 10,7,576
TR 24,7,1088
TR 26,7,1600
TR 12,7,96
TR 14,7,608
TR 28,7,1120
TR 30,7,1632
s_waitcnt vmcnt(8) lgkmcnt(14)
MAV 32,0,64
TR 32,7,8320
TR 34,7,8832
s_waitcnt lgkmcnt(14)
MAV 32,16,72
buffer_load_dwordx4 v[112:115], v4, s[16:19], s52 offen sc1
MAV 48,16,76
TR 48,7,9344
TR 50,7,9856
MAV 48,0,68
TR 36,7,8352
s_waitcnt lgkmcnt(15)
MAV 52,4,68
buffer_load_dwordx4 v[116:119], v4, s[16:19], s52 offen offset:1024 sc1
s_waitcnt lgkmcnt(13)
MAV 52,20,76
TR 38,7,8864
s_add_u32 s52, s52, 262144
MAV 36,20,72
TR 52,7,9376
MAV 36,4,64
TR 54,7,9888
s_waitcnt lgkmcnt(14)
MAV 40,8,64
buffer_load_dwordx4 v[120:123], v4, s[16:19], s53 offen sc1
s_waitcnt lgkmcnt(12)
MAV 40,24,72
TR 40,7,8384
TR 42,7,8896
MAV 56,24,76
TR 56,7,9408
MAV 56,8,68
TR 58,7,9920
TR 44,7,8416
s_waitcnt lgkmcnt(15)
MAV 60,12,68
buffer_load_dwordx4 v[124:127], v4, s[16:19], s53 offen offset:1024 sc1
s_waitcnt lgkmcnt(13)
MAV 60,28,76
s_add_u32 s53, s53, 262144
MAV 44,28,72
TR 46,7,8928
TR 60,7,9440
MAV 44,12,64
TR 62,7,9952
s_waitcnt vmcnt(8) lgkmcnt(8)
MAV 32,32,80
TR 0,7,16640
TR 2,7,17152
MAV 32,48,88
buffer_load_dwordx4 v[64:67], v4, s[16:19], s52 offen sc1
MAV 48,48,92
TR 16,7,17664
TR 18,7,18176
MAV 48,32,84
TR 4,7,16672
MAV 52,36,84
buffer_load_dwordx4 v[68:71], v4, s[16:19], s52 offen offset:1024 sc1
MAV 52,52,92
TR 6,7,17184
s_add_u32 s52, s52, 262144
MAV 36,52,88
TR 20,7,17696
MAV 36,36,80
TR 22,7,18208
s_waitcnt lgkmcnt(8)
MAV 40,40,80
buffer_load_dwordx4 v[72:75], v4, s[16:19], s53 offen sc1
MAV 40,56,88
TR 8,7,16704
TR 10,7,17216
MAV 56,56,92
TR 24,7,17728
MAV 56,40,84
TR 26,7,18240
TR 12,7,16736
MAV 60,44,84
buffer_load_dwordx4 v[76:79], v4, s[16:19], s53 offen offset:1024 sc1
MAV 60,60,92
s_add_u32 s53, s53, 262144
MAV 44,60,88
TR 14,7,17248
TR 28,7,17760
MAV 44,44,80
TR 30,7,18272
s_waitcnt vmcnt(8) lgkmcnt(8)
MAV 32,0,96
TR 32,7,24960
TR 34,7,25472
MAV 32,16,104
buffer_load_dwordx4 v[80:83], v4, s[16:19], s52 offen sc1
MAV 48,16,108
TR 48,7,25984
TR 50,7,26496
MAV 48,0,100
TR 36,7,24992
MAV 52,4,100
buffer_load_dwordx4 v[84:87], v4, s[16:19], s52 offen offset:1024 sc1
MAV 52,20,108
TR 38,7,25504
s_add_u32 s52, s52, 262144
MAV 36,20,104
TR 52,7,26016
MAV 36,4,96
TR 54,7,26528
s_waitcnt lgkmcnt(8)
MAV 40,8,96
buffer_load_dwordx4 v[88:91], v4, s[16:19], s53 offen sc1
MAV 40,24,104
TR 40,7,25024
TR 42,7,25536
MAV 56,24,108
TR 56,7,26048
MAV 56,8,100
TR 58,7,26560
TR 44,7,25056
MAV 60,12,100
buffer_load_dwordx4 v[92:95], v4, s[16:19], s53 offen offset:1024 sc1
MAV 60,28,108
s_add_u32 s53, s53, 262144
MAV 44,28,104
TR 46,7,25568
TR 60,7,26080
MAV 44,12,96
TR 62,7,26592
s_waitcnt vmcnt(8) lgkmcnt(8)
MAV 32,32,112
TR 0,7,33280
TR 2,7,33792
MAV 32,48,120
buffer_load_dwordx4 v[96:99], v4, s[16:19], s52 offen sc1
MAV 48,48,124
TR 16,7,34304
TR 18,7,34816
MAV 48,32,116
TR 4,7,33312
MAV 52,36,116
buffer_load_dwordx4 v[100:103], v4, s[16:19], s52 offen offset:1024 sc1
MAV 52,52,124
TR 6,7,33824
s_add_u32 s52, s52, 262144
MAV 36,52,120
TR 20,7,34336
MAV 36,36,112
TR 22,7,34848
s_waitcnt lgkmcnt(8)
MAV 40,40,112
buffer_load_dwordx4 v[104:107], v4, s[16:19], s53 offen sc1
MAV 40,56,120
TR 8,7,33344
TR 10,7,33856
MAV 56,56,124
TR 24,7,34368
MAV 56,40,116
TR 26,7,34880
TR 12,7,33376
MAV 60,44,116
buffer_load_dwordx4 v[108:111], v4, s[16:19], s53 offen offset:1024 sc1
MAV 60,60,124
s_add_u32 s53, s53, 262144
MAV 44,60,120
TR 14,7,33888
TR 28,7,34400
MAV 44,44,112
TR 30,7,34912
s_waitcnt vmcnt(8) lgkmcnt(8)
MAV 32,0,64
TR 32,7,41600
TR 34,7,42112
MAV 32,16,72
buffer_load_dwordx4 v[112:115], v4, s[16:19], s52 offen sc1
MAV 48,16,76
TR 48,7,42624
TR 50,7,43136
MAV 48,0,68
TR 36,7,41632
MAV 52,4,68
buffer_load_dwordx4 v[116:119], v4, s[16:19], s52 offen offset:1024 sc1
MAV 52,20,76
TR 38,7,42144
s_add_u32 s52, s52, 262144
MAV 36,20,72
TR 52,7,42656
MAV 36,4,64
TR 54,7,43168
s_waitcnt lgkmcnt(8)
MAV 40,8,64
buffer_load_dwordx4 v[120:123], v4, s[16:19], s53 offen sc1
MAV 40,24,72
TR 40,7,41664
TR 42,7,42176
MAV 56,24,76
TR 56,7,42688
MAV 56,8,68
TR 58,7,43200
TR 44,7,41696
MAV 60,12,68
buffer_load_dwordx4 v[124:127], v4, s[16:19], s53 offen offset:1024 sc1
MAV 60,28,76
s_add_u32 s53, s53, 262144
MAV 44,28,72
TR 46,7,42208
TR 60,7,42720
MAV 44,12,64
TR 62,7,43232
s_waitcnt vmcnt(8) lgkmcnt(8)
MAV 32,32,80
TR 0,7,49920
TR 2,7,50432
MAV 32,48,88
buffer_load_dwordx4 v[64:67], v4, s[16:19], s52 offen sc1
MAV 48,48,92
TR 16,7,50944
TR 18,7,51456
MAV 48,32,84
TR 4,7,49952
MAV 52,36,84
buffer_load_dwordx4 v[68:71], v4, s[16:19], s52 offen offset:1024 sc1
MAV 52,52,92
TR 6,7,50464
s_add_u32 s52, s52, 262144
MAV 36,52,88
TR 20,7,50976
MAV 36,36,80
TR 22,7,51488
s_waitcnt lgkmcnt(8)
MAV 40,40,80
buffer_load_dwordx4 v[72:75], v4, s[16:19], s53 offen sc1
MAV 40,56,88
TR 8,7,49984
TR 10,7,50496
MAV 56,56,92
TR 24,7,51008
MAV 56,40,84
TR 26,7,51520
.Lpad20:
s_cbranch_execz .Lpad23
TR 12,7,50016
MAV 60,44,84
buffer_load_dwordx4 v[76:79], v4, s[16:19], s53 offen offset:1024 sc1
MAV 60,60,92
s_add_u32 s53, s53, 262144
MAV 44,60,88
TR 14,7,50528
TR 28,7,51040
MAV 44,44,80
TR 30,7,51552
s_waitcnt vmcnt(8) lgkmcnt(8)
MAV 32,0,96
TR 32,7,58240
TR 34,7,58752
MAV 32,16,104
buffer_load_dwordx4 v[80:83], v4, s[16:19], s52 offen sc1
MAV 48,16,108
TR 48,7,59264
TR 50,7,59776
MAV 48,0,100
TR 36,7,58272
MAV 52,4,100
buffer_load_dwordx4 v[84:87], v4, s[16:19], s52 offen offset:1024 sc1
MAV 52,20,108
TR 38,7,58784
s_add_u32 s52, s52, 262144
MAV 36,20,104
TR 52,7,59296
MAV 36,4,96
TR 54,7,59808
s_waitcnt lgkmcnt(8)
MAV 40,8,96
buffer_load_dwordx4 v[88:91], v4, s[16:19], s53 offen sc1
MAV 40,24,104
TR 40,7,58304
TR 42,7,58816
MAV 56,24,108
TR 56,7,59328
MAV 56,8,100
TR 58,7,59840
TR 44,7,58336
MAV 60,12,100
buffer_load_dwordx4 v[92:95], v4, s[16:19], s53 offen offset:1024 sc1
MAV 60,28,108
s_add_u32 s53, s53, 262144
MAV 44,28,104
TR 46,7,58848
TR 60,7,59360
MAV 44,12,96
TR 62,7,59872
s_xor_b32 s57, s57, 66560
v_add_u32 v7, s57, v8
s_waitcnt vmcnt(8) lgkmcnt(8)
MAV 32,32,112
ds_read_b64_tr_b16 a[0:1], v7
TR 2,7,512
MAV 32,48,120
buffer_load_dwordx4 v[96:99], v4, s[16:19], s52 offen sc1
MAV 48,48,124
TR 16,7,1024
TR 18,7,1536
MAV 48,32,116
TR 4,7,32
MAV 52,36,116
buffer_load_dwordx4 v[100:103], v4, s[16:19], s52 offen offset:1024 sc1
MAV 52,52,124
TR 6,7,544
s_add_u32 s52, s52, 262144
MAV 36,52,120
TR 20,7,1056
MAV 36,36,112
TR 22,7,1568
s_waitcnt lgkmcnt(8)
MAV 40,40,112
buffer_load_dwordx4 v[104:107], v4, s[16:19], s53 offen sc1
MAV 40,56,120
TR 8,7,64
TR 10,7,576
MAV 56,56,124
TR 24,7,1088
MAV 56,40,116
TR 26,7,1600
TR 12,7,96
MAV 60,44,116
buffer_load_dwordx4 v[108:111], v4, s[16:19], s53 offen offset:1024 sc1
MAV 60,60,124
s_add_u32 s53, s53, 262144
MAV 44,60,120
TR 14,7,608
TR 28,7,1120
MAV 44,44,112
TR 30,7,1632
s_waitcnt vmcnt(8) lgkmcnt(8)
MAV 32,0,64
TR 32,7,8320
TR 34,7,8832
MAV 32,16,72
buffer_load_dwordx4 v[112:115], v4, s[16:19], s52 offen sc1
MAV 48,16,76
TR 48,7,9344
TR 50,7,9856
MAV 48,0,68
TR 36,7,8352
MAV 52,4,68
buffer_load_dwordx4 v[116:119], v4, s[16:19], s52 offen offset:1024 sc1
MAV 52,20,76
TR 38,7,8864
s_add_u32 s52, s52, 262144
MAV 36,20,72
TR 52,7,9376
MAV 36,4,64
TR 54,7,9888
s_waitcnt lgkmcnt(8)
MAV 40,8,64
buffer_load_dwordx4 v[120:123], v4, s[16:19], s53 offen sc1
MAV 40,24,72
TR 40,7,8384
TR 42,7,8896
MAV 56,24,76
TR 56,7,9408
MAV 56,8,68
TR 58,7,9920
TR 44,7,8416
MAV 60,12,68
buffer_load_dwordx4 v[124:127], v4, s[16:19], s53 offen offset:1024 sc1
MAV 60,28,76
s_add_u32 s53, s53, 262144
MAV 44,28,72
TR 46,7,8928
TR 60,7,9440
MAV 44,12,64
TR 62,7,9952
s_waitcnt vmcnt(8) lgkmcnt(8)
MAV 32,32,80
TR 0,7,16640
TR 2,7,17152
MAV 32,48,88
buffer_load_dwordx4 v[64:67], v4, s[16:19], s52 offen sc1
MAV 48,48,92
TR 16,7,17664
TR 18,7,18176
MAV 48,32,84
TR 4,7,16672
MAV 52,36,84
buffer_load_dwordx4 v[68:71], v4, s[16:19], s52 offen offset:1024 sc1
MAV 52,52,92
TR 6,7,17184
s_add_u32 s52, s52, 262144
MAV 36,52,88
TR 20,7,17696
MAV 36,36,80
TR 22,7,18208
s_waitcnt lgkmcnt(8)
MAV 40,40,80
buffer_load_dwordx4 v[72:75], v4, s[16:19], s53 offen sc1
MAV 40,56,88
TR 8,7,16704
TR 10,7,17216
MAV 56,56,92
TR 24,7,17728
MAV 56,40,84
TR 26,7,18240
TR 12,7,16736
MAV 60,44,84
buffer_load_dwordx4 v[76:79], v4, s[16:19], s53 offen offset:1024 sc1
MAV 60,60,92
s_add_u32 s53, s53, 262144
MAV 44,60,88
TR 14,7,17248
TR 28,7,17760
MAV 44,44,80
TR 30,7,18272
s_waitcnt vmcnt(8) lgkmcnt(8)
MAV 32,0,96
TR 32,7,24960
TR 34,7,25472
MAV 32,16,104
buffer_load_dwordx4 v[80:83], v4, s[16:19], s52 offen sc1
MAV 48,16,108
TR 48,7,25984
TR 50,7,26496
MAV 48,0,100
TR 36,7,24992
MAV 52,4,100
buffer_load_dwordx4 v[84:87], v4, s[16:19], s52 offen offset:1024 sc1
MAV 52,20,108
TR 38,7,25504
s_add_u32 s52, s52, 262144
MAV 36,20,104
TR 52,7,26016
MAV 36,4,96
TR 54,7,26528
s_waitcnt lgkmcnt(8)
MAV 40,8,96
buffer_load_dwordx4 v[88:91], v4, s[16:19], s53 offen sc1
MAV 40,24,104
TR 40,7,25024
TR 42,7,25536
MAV 56,24,108
TR 56,7,26048
MAV 56,8,100
TR 58,7,26560
TR 44,7,25056
MAV 60,12,100
buffer_load_dwordx4 v[92:95], v4, s[16:19], s53 offen offset:1024 sc1
MAV 60,28,108
s_add_u32 s53, s53, 262144
MAV 44,28,104
TR 46,7,25568
TR 60,7,26080
MAV 44,12,96
TR 62,7,26592
s_waitcnt vmcnt(8) lgkmcnt(8)
MAV 32,32,112
TR 0,7,33280
TR 2,7,33792
MAV 32,48,120
buffer_load_dwordx4 v[96:99], v4, s[16:19], s52 offen sc1
MAV 48,48,124
TR 16,7,34304
TR 18,7,34816
MAV 48,32,116
TR 4,7,33312
MAV 52,36,116
buffer_load_dwordx4 v[100:103], v4, s[16:19], s52 offen offset:1024 sc1
MAV 52,52,124
TR 6,7,33824
s_add_u32 s52, s52, 262144
MAV 36,52,120
TR 20,7,34336
MAV 36,36,112
TR 22,7,34848
s_waitcnt lgkmcnt(8)
MAV 40,40,112
buffer_load_dwordx4 v[104:107], v4, s[16:19], s53 offen sc1
MAV 40,56,120
TR 8,7,33344
TR 10,7,33856
MAV 56,56,124
TR 24,7,34368
MAV 56,40,116
TR 26,7,34880
TR 12,7,33376
MAV 60,44,116
buffer_load_dwordx4 v[108:111], v4, s[16:19], s53 offen offset:1024 sc1
MAV 60,60,124
s_add_u32 s53, s53, 262144
MAV 44,60,120
TR 14,7,33888
TR 28,7,34400
MAV 44,44,112
TR 30,7,34912
s_waitcnt vmcnt(8) lgkmcnt(8)
MAV 32,0,64
TR 32,7,41600
TR 34,7,42112
MAV 32,16,72
buffer_load_dwordx4 v[112:115], v4, s[16:19], s52 offen sc1
MAV 48,16,76
TR 48,7,42624
TR 50,7,43136
MAV 48,0,68
TR 36,7,41632
MAV 52,4,68
buffer_load_dwordx4 v[116:119], v4, s[16:19], s52 offen offset:1024 sc1
MAV 52,20,76
TR 38,7,42144
s_add_u32 s52, s52, 262144
MAV 36,20,72
TR 52,7,42656
MAV 36,4,64
TR 54,7,43168
s_waitcnt lgkmcnt(8)
MAV 40,8,64
buffer_load_dwordx4 v[120:123], v4, s[16:19], s53 offen sc1
MAV 40,24,72
TR 40,7,41664
TR 42,7,42176
MAV 56,24,76
TR 56,7,42688
MAV 56,8,68
TR 58,7,43200
TR 44,7,41696
MAV 60,12,68
buffer_load_dwordx4 v[124:127], v4, s[16:19], s53 offen offset:1024 sc1
MAV 60,28,76
s_add_u32 s53, s53, 262144
MAV 44,28,72
TR 46,7,42208
TR 60,7,42720
MAV 44,12,64
TR 62,7,43232
s_barrier
s_waitcnt vmcnt(8) lgkmcnt(8)
MAV 32,32,80
TR 0,7,49920
s_add_u32 m0, s59, 84480
MAV 32,48,88
buffer_load_dwordx4 v12, s[32:35], s58 offen   lds
MAV 48,48,92
TR 2,7,50432
TR 16,7,50944
MAV 48,32,84
TR 18,7,51456
MAV 52,36,84
buffer_load_dwordx4 v13, s[32:35], s58 offen offset:1056   lds
MAV 52,52,92
TR 4,7,49952
TR 6,7,50464
MAV 36,52,88
TR 20,7,50976
MAV 36,36,80
TR 22,7,51488
s_waitcnt lgkmcnt(8)
MAV 40,40,80
buffer_load_dwordx4 v14, s[32:35], s58 offen offset:2112   lds
MAV 40,56,88
TR 8,7,49984
MAV 56,56,92
TR 10,7,50496
TR 24,7,51008
MAV 56,40,84
TR 26,7,51520
MAV 60,44,84
buffer_load_dwordx4 v15, s[32:35], s58 offen offset:3168   lds
MAV 60,60,92
TR 12,7,50016
TR 14,7,50528
MAV 44,60,88
TR 28,7,51040
MAV 44,44,80
TR 30,7,51552
s_waitcnt vmcnt(8) lgkmcnt(8)
MAV 32,0,96
TR 32,7,58240
s_add_u32 m0, s59, 101376
MAV 32,16,104
buffer_load_dwordx4 v12, s[80:83], s58 offen   lds
MAV 48,16,108
TR 34,7,58752
TR 48,7,59264
MAV 48,0,100
TR 50,7,59776
MAV 52,4,100
buffer_load_dwordx4 v13, s[80:83], s58 offen offset:1056   lds
MAV 52,20,108
TR 36,7,58272
TR 38,7,58784
MAV 36,20,104
TR 52,7,59296
MAV 36,4,96
TR 54,7,59808
s_waitcnt lgkmcnt(8)
MAV 40,8,96
buffer_load_dwordx4 v14, s[80:83], s58 offen offset:2112   lds
MAV 40,24,104
TR 40,7,58304
TR 42,7,58816
MAV 56,24,108
TR 56,7,59328
MAV 56,8,100
TR 58,7,59840
TR 44,7,58336
MAV 60,12,100
buffer_load_dwordx4 v15, s[80:83], s58 offen offset:3168   lds
MAV 60,28,108
s_add_u32 s58, s58, 458752
MAV 44,28,104
TR 46,7,58848
TR 60,7,59360
MAV 44,12,96
TR 62,7,59872
s_waitcnt vmcnt(11) lgkmcnt(14)
MAV 32,32,112
s_add_u32 m0, s59, 118272
s_lshl_b32 s64, s6, 14
s_lshl_b32 s65, s49, 13
s_waitcnt vmcnt(9) lgkmcnt(12)
MAV 32,48,120
buffer_load_dwordx4 v12, s[32:35], s58 offen   lds
s_waitcnt vmcnt(9)
MAV 48,48,124
s_add_u32 s64, s64, s65
s_lshl_b32 s65, s7, 9
s_add_u32 s64, s64, s65
MAV 48,32,116
s_lshl_b32 s65, s48, 8
s_add_u32 s64, s64, s65
s_add_u32 s64, s64, 63176704
s_waitcnt lgkmcnt(10)
MAV 52,36,116
s_lshl_b32 s62, s7, 18
v_and_b32 v152, 31, v1
v_lshlrev_b32 v152, 3, v152
s_waitcnt lgkmcnt(8)
MAV 52,52,124
buffer_load_dwordx4 v13, s[32:35], s58 offen offset:1056   lds
MAV 36,52,120
s_add_u32 s62, s62, 41943040
v_lshrrev_b32 v153, 5, v1
v_lshl_add_u32 v152, v153, 28, v152
MAV 36,36,112
s_add_u32 s63, s62, 131072
v_cvt_pk_bf16_f32 v128, v32, v33
v_cvt_pk_bf16_f32 v129, v34, v35
s_waitcnt lgkmcnt(6)
MAV 40,40,112
v_cvt_pk_bf16_f32 v136, v48, v49
v_cvt_pk_bf16_f32 v137, v50, v51
s_waitcnt lgkmcnt(4)
MAV 40,56,120
buffer_load_dwordx4 v14, s[32:35], s58 offen offset:2112   lds
MAV 56,56,124
v_cvt_pk_bf16_f32 v130, v36, v37
v_cvt_pk_bf16_f32 v131, v38, v39
MAV 56,40,116
s_nop 2
v_cvt_pk_bf16_f32 v132, v40, v41
v_cvt_pk_bf16_f32 v133, v42, v43
s_waitcnt lgkmcnt(2)
MAV 60,44,116
v_cvt_pk_bf16_f32 v138, v52, v53
v_cvt_pk_bf16_f32 v139, v54, v55
s_waitcnt lgkmcnt(0)
MAV 60,60,124
buffer_load_dwordx4 v15, s[32:35], s58 offen offset:3168   lds
MAV 44,60,120
v_cvt_pk_bf16_f32 v140, v56, v57
v_cvt_pk_bf16_f32 v141, v58, v59
MAV 44,44,112
s_nop 2
v_cvt_pk_bf16_f32 v142, v60, v61
v_cvt_pk_bf16_f32 v143, v62, v63
v_pk_mul_f32 v[146:147], v[32:33], v[32:33]
v_pk_mul_f32 v[150:151], v[48:49], v[48:49]
buffer_store_dwordx4 v[128:131], v4, s[16:19], s62 offen sc1
v_cvt_pk_bf16_f32 v134, v44, v45
v_cvt_pk_bf16_f32 v135, v46, v47
v_pk_fma_f32 v[146:147], v[34:35], v[34:35], v[146:147]
v_pk_add_f32 v[144:145], v[32:33], v[34:35]
v_pk_fma_f32 v[150:151], v[50:51], v[50:51], v[150:151]
v_pk_add_f32 v[148:149], v[48:49], v[50:51]
v_pk_fma_f32 v[146:147], v[36:37], v[36:37], v[146:147]
v_pk_add_f32 v[144:145], v[144:145], v[36:37]
v_pk_fma_f32 v[150:151], v[52:53], v[52:53], v[150:151]
v_pk_add_f32 v[148:149], v[148:149], v[52:53]
v_pk_fma_f32 v[146:147], v[38:39], v[38:39], v[146:147]
v_pk_add_f32 v[144:145], v[144:145], v[38:39]
v_pk_fma_f32 v[150:151], v[54:55], v[54:55], v[150:151]
buffer_store_dwordx4 v[132:135], v4, s[16:19], s63 offen sc1
v_pk_add_f32 v[148:149], v[148:149], v[54:55]
v_pk_fma_f32 v[146:147], v[40:41], v[40:41], v[146:147]
v_pk_add_f32 v[144:145], v[144:145], v[40:41]
v_pk_fma_f32 v[150:151], v[56:57], v[56:57], v[150:151]
v_pk_add_f32 v[148:149], v[148:149], v[56:57]
v_pk_fma_f32 v[146:147], v[42:43], v[42:43], v[146:147]
v_pk_add_f32 v[144:145], v[144:145], v[42:43]
v_pk_fma_f32 v[150:151], v[58:59], v[58:59], v[150:151]
v_pk_add_f32 v[148:149], v[148:149], v[58:59]
v_pk_fma_f32 v[146:147], v[44:45], v[44:45], v[146:147]
v_pk_add_f32 v[144:145], v[144:145], v[44:45]
v_pk_fma_f32 v[150:151], v[60:61], v[60:61], v[150:151]
v_pk_add_f32 v[148:149], v[148:149], v[60:61]
buffer_store_dwordx4 v[136:139], v4, s[16:19], s62 offen offset:1024 sc1
v_pk_fma_f32 v[146:147], v[46:47], v[46:47], v[146:147]
v_pk_add_f32 v[144:145], v[144:145], v[46:47]
v_pk_fma_f32 v[150:151], v[62:63], v[62:63], v[150:151]
v_pk_add_f32 v[148:149], v[148:149], v[62:63]
v_add_f32 v144, v144, v145
v_add_f32 v146, v146, v147
v_add_f32 v148, v148, v149
v_add_f32 v150, v150, v151
s_nop 0
v_permlane16_swap_b32 v144, v148
v_permlane16_swap_b32 v146, v150
v_add_f32 v144, v144, v148
buffer_store_dwordx4 v[140:143], v4, s[16:19], s63 offen offset:1024 sc1
v_add_f32 v146, v146, v150
s_nop 1
v_permlane32_swap_b32 v144, v146
v_add_f32 v144, v144, v146
s_nop 1
v_permlane32_swap_b32 v144, v145
buffer_store_dwordx2 v[144:145], v152, s[16:19], s64 offen sc1
s_nop 1
v_accvgpr_write_b32 a224, v32
v_accvgpr_write_b32 a225, v33
v_accvgpr_write_b32 a226, v34
v_accvgpr_write_b32 a227, v35
v_accvgpr_write_b32 a228, v36
v_accvgpr_write_b32 a229, v37
v_accvgpr_write_b32 a230, v38
v_accvgpr_write_b32 a231, v39
v_accvgpr_write_b32 a232, v40
v_accvgpr_write_b32 a233, v41
v_accvgpr_write_b32 a234, v42
v_accvgpr_write_b32 a235, v43
v_accvgpr_write_b32 a236, v44
v_accvgpr_write_b32 a237, v45
v_accvgpr_write_b32 a238, v46
v_accvgpr_write_b32 a239, v47
v_accvgpr_write_b32 a240, v48
v_accvgpr_write_b32 a241, v49
v_accvgpr_write_b32 a242, v50
v_accvgpr_write_b32 a243, v51
v_accvgpr_write_b32 a244, v52
v_accvgpr_write_b32 a245, v53
v_accvgpr_write_b32 a246, v54
v_accvgpr_write_b32 a247, v55
v_accvgpr_write_b32 a248, v56
v_accvgpr_write_b32 a249, v57
v_accvgpr_write_b32 a250, v58
v_accvgpr_write_b32 a251, v59
v_accvgpr_write_b32 a252, v60
v_accvgpr_write_b32 a253, v61
v_accvgpr_write_b32 a254, v62
v_accvgpr_write_b32 a255, v63
s_lshl_b32 s62, s10, 14
s_lshl_b32 s63, s3, 12
s_add_u32 s62, s62, s63
s_lshl_b32 s63, s12, 11
s_add_u32 s62, s62, s63
v_lshl_add_u32 v10, v1, 4, s62
v_lshrrev_b32 v2, 3, v1
v_cmp_eq_u32 vcc, 3, v2
v_add_u32 v2, 67108480, v10
s_nop 0
v_cndmask_b32 v10, v10, v2, vcc
v_xor_b32 v11, 2048, v10
v_bfe_u32 v16, v1, 2, 3
v_mul_u32_u24 v16, 1056, v16
v_bfe_u32 v2, v1, 5, 1
v_lshl_add_u32 v16, v2, 8, v16
v_and_b32 v2, 3, v1
v_lshl_add_u32 v16, v2, 3, v16
s_lshl_b32 s62, s12, 6
s_add_u32 s62, s62, 84480
s_xor_b32 s63, s12, 1
s_mul_i32 s63, s63, 192
s_add_u32 s63, s63, 84480
v_add_u32 v17, s63, v16
v_add_u32 v16, s62, v16
s_mov_b32 s52, 41943040
s_mov_b32 s53, 41943040
s_mov_b32 s54, s58
s_mov_b32 s55, s59
s_mul_i32 s59, s3, 2112
s_and_b32 s62, s7, 1
s_mul_i32 s62, s62, 3670016
.Lpad21:
s_cbranch_execz .Lpad24
s_lshr_b32 s63, s7, 1
s_lshl_b32 s63, s63, 8
s_add_u32 s62, s62, s63
s_lshl_b32 s63, s3, 12
s_add_u32 s62, s62, s63
v_lshrrev_b32 v5, 4, v1
v_lshlrev_b32 v5, 14, v5
v_and_b32 v2, 15, v1
v_lshl_add_u32 v5, v2, 4, v5
v_add_u32 v5, s62, v5
v_add_u32 v6, 992, v5
s_lshl_b32 s62, s10, 15
s_lshl_b32 s63, s3, 13
s_add_u32 s62, s62, s63
v_lshl_add_u32 v4, v1, 4, s62
s_lshl_b32 s62, s6, 10
s_add_u32 s62, s62, 30507008
s_lshl_b32 s64, s10, 1
s_lshl_b32 s64, s64, 10
s_add_u32 s64, s64, 30507008
s_lshr_b32 s67, s5, 2
s_and_b32 s67, s67, 3
s_lshl_b32 s67, s67, 7
s_add_u32 s64, s64, s67
s_add_u32 s65, s64, 1024
v_lshl_add_u32 v252, v1, 7, s62
v_mov_b32 v253, s64
v_mov_b32 v255, 1
v_writelane_b32 v253, s65, 1
s_waitcnt vmcnt(0) lgkmcnt(0)
s_cmp_lg_u32 s3, 1
s_barrier
s_cbranch_scc1 .Lnopoll62
s_mov_b64 exec, 15
buffer_atomic_add v255, v252, s[16:19], 0 offen
s_mov_b64 exec, 3
v_mov_b32 v254, 0
buffer_atomic_add v254, v253, s[16:19], 0 offen sc0
s_sleep 5
s_mov_b32 s15, 0
.Lpoll61:
v_mov_b32 v255, 0
buffer_atomic_add v255, v253, s[16:19], 0 offen sc0
s_waitcnt vmcnt(1)
v_cmp_gt_u32 vcc, 16, v254
s_add_u32 s15, s15, 1
s_cbranch_vccz .Lnopoll62r
v_mov_b32 v254, 0
buffer_atomic_add v254, v253, s[16:19], 0 offen sc0
s_waitcnt vmcnt(1)
v_cmp_gt_u32 vcc, 16, v255
s_add_u32 s15, s15, 1
s_cbranch_vccz .Lnopoll62r
s_cmp_le_u32 s15, 100000
s_cbranch_scc1 .Lpoll61
s_branch .Lnopoll62r
.Lnopoll62:
s_mov_b64 exec, 0
s_cmp_eq_u32 s3, 2
s_cbranch_scc1 .Lpad26
s_cmp_eq_u32 s3, 3
s_cbranch_scc1 .Lpad27
s_branch .Lpad28
.Lnopoll62r:
s_mov_b64 exec, -1
s_barrier
buffer_load_dwordx4 a[128:131], v10, s[16:19], s52 offen sc1
buffer_load_dwordx4 a[132:135], v10, s[16:19], s52 offen offset:1024 sc1
s_add_u32 s52, s52, 131072
buffer_load_dwordx4 a[144:147], v10, s[16:19], s52 offen sc1
buffer_load_dwordx4 a[148:151], v10, s[16:19], s52 offen offset:1024 sc1
s_add_u32 s52, s52, 131072
buffer_load_dwordx4 a[136:139], v11, s[16:19], s53 offen sc1
buffer_load_dwordx4 a[140:143], v11, s[16:19], s53 offen offset:1024 sc1
s_add_u32 s53, s53, 131072
buffer_load_dwordx4 a[152:155], v11, s[16:19], s53 offen sc1
buffer_load_dwordx4 a[156:159], v11, s[16:19], s53 offen offset:1024 sc1
s_add_u32 s53, s53, 131072
ds_read_b64_tr_b16 a[0:1], v16
TR 2,16,512
TR 4,16,8448
TR 6,16,8960
TR 8,16,32
TR 10,16,544
TR 12,16,8480
TR 14,16,8992
TR 16,16,64
TR 18,16,576
TR 20,16,8512
TR 22,16,9024
TR 24,16,96
TR 26,16,608
TR 28,16,8544
TR 30,16,9056
TR 32,16,128
TR 34,16,640
TR 36,16,8576
TR 38,16,9088
TR 40,16,160
TR 42,16,672
TR 44,16,8608
TR 46,16,9120
ds_read_b64_tr_b16 a[48:49], v17
TR 50,17,512
TR 52,17,8448
TR 54,17,8960
TR 56,17,32
TR 58,17,544
TR 60,17,8480
TR 62,17,8992
s_add_u32 m0, s55, 135168
s_nop 0
buffer_load_dwordx4 v12, s[80:83], s54 offen   lds
buffer_load_dwordx4 v13, s[80:83], s54 offen offset:1056   lds
buffer_load_dwordx4 v14, s[80:83], s54 offen offset:2112   lds
buffer_load_dwordx4 v15, s[80:83], s54 offen offset:3168   lds
s_add_u32 s54, s54, 458752
s_lshl_b32 s57, s3, 13
s_add_u32 s57, s57, 49920
v_lshl_add_u32 v2, v1, 4, s57
s_waitcnt lgkmcnt(0)
s_barrier
s_waitcnt vmcnt(11)
v_mfma_f32_16x16x32_bf16 v[32:35], a[0:3], a[128:131], 0
buffer_load_dwordx4 a[160:163], v10, s[16:19], s52 offen sc1
s_waitcnt vmcnt(10)
MAA 32,4,144
TR 64,16,16896
v_mfma_f32_16x16x32_bf16 v[36:39], a[0:3], a[132:135], 0
TR 66,16,17408
s_waitcnt vmcnt(9)
MAA 36,4,148
TR 68,16,25344
v_mfma_f32_16x16x32_bf16 v[52:55], a[8:11], a[132:135], 0
buffer_load_dwordx4 a[164:167], v10, s[16:19], s52 offen offset:1024 sc1
MAA 52,12,148
TR 70,16,25856
s_add_u32 s52, s52, 131072
v_mfma_f32_16x16x32_bf16 v[48:51], a[8:11], a[128:131], 0
TR 72,16,16928
MAA 48,12,144
TR 74,16,17440
v_mfma_f32_16x16x32_bf16 v[96:99], a[16:19], a[128:131], 0
buffer_load_dwordx4 a[176:179], v10, s[16:19], s52 offen sc1
MAA 96,20,144
TR 76,16,25376
v_mfma_f32_16x16x32_bf16 v[100:103], a[16:19], a[132:135], 0
TR 78,16,25888
MAA 100,20,148
TR 80,16,16960
v_mfma_f32_16x16x32_bf16 v[116:119], a[24:27], a[132:135], 0
buffer_load_dwordx4 a[180:183], v10, s[16:19], s52 offen offset:1024 sc1
MAA 116,28,148
TR 82,16,17472
s_add_u32 s52, s52, 131072
v_mfma_f32_16x16x32_bf16 v[112:115], a[24:27], a[128:131], 0
TR 84,16,25408
MAA 112,28,144
TR 86,16,25920
v_mfma_f32_16x16x32_bf16 v[160:163], a[32:35], a[128:131], 0
buffer_load_dwordx4 a[168:171], v11, s[16:19], s53 offen sc1
MAA 160,36,144
TR 88,16,16992
v_mfma_f32_16x16x32_bf16 v[164:167], a[32:35], a[132:135], 0
TR 90,16,17504
MAA 164,36,148
TR 92,16,25440
v_mfma_f32_16x16x32_bf16 v[180:183], a[40:43], a[132:135], 0
buffer_load_dwordx4 a[172:175], v11, s[16:19], s53 offen offset:1024 sc1
MAA 180,44,148
TR 94,16,25952
s_add_u32 s53, s53, 131072
v_mfma_f32_16x16x32_bf16 v[176:179], a[40:43], a[128:131], 0
TR 96,16,17024
MAA 176,44,144
TR 98,16,17536
v_mfma_f32_16x16x32_bf16 v[224:227], a[48:51], a[128:131], 0
buffer_load_dwordx4 a[184:187], v11, s[16:19], s53 offen sc1
MAA 224,52,144
TR 100,16,25472
v_mfma_f32_16x16x32_bf16 v[228:231], a[48:51], a[132:135], 0
TR 102,16,25984
MAA 228,52,148
TR 104,16,17056
v_mfma_f32_16x16x32_bf16 v[236:239], a[56:59], a[132:135], 0
buffer_load_dwordx4 a[188:191], v11, s[16:19], s53 offen offset:1024 sc1
MAA 236,60,148
TR 106,16,17568
s_add_u32 s53, s53, 131072
v_mfma_f32_16x16x32_bf16 v[232:235], a[56:59], a[128:131], 0
TR 108,16,25504
s_add_u32 m0, s55, 84480
MAA 232,60,144
TR 110,16,26016
s_waitcnt vmcnt(12)
v_mfma_f32_16x16x32_bf16 v[188:191], a[40:43], a[140:143], 0
buffer_load_dwordx4 v12, s[32:35], s54 offen   lds
MAA 188,44,156
TR 112,17,16896
v_mfma_f32_16x16x32_bf16 v[184:187], a[40:43], a[136:139], 0
TR 114,17,17408
MAA 184,44,152
TR 116,17,25344
v_mfma_f32_16x16x32_bf16 v[168:171], a[32:35], a[136:139], 0
buffer_load_dwordx4 v13, s[32:35], s54 offen offset:1056   lds
MAA 168,36,152
TR 118,17,25856
v_mfma_f32_16x16x32_bf16 v[172:175], a[32:35], a[140:143], 0
TR 120,17,16928
MAA 172,36,156
TR 122,17,17440
v_mfma_f32_16x16x32_bf16 v[124:127], a[24:27], a[140:143], 0
buffer_load_dwordx4 v14, s[32:35], s54 offen offset:2112   lds
MAA 124,28,156
TR 124,17,25376
v_mfma_f32_16x16x32_bf16 v[120:123], a[24:27], a[136:139], 0
TR 126,17,25888
MAA 120,28,152
v_mfma_f32_16x16x32_bf16 v[104:107], a[16:19], a[136:139], 0
buffer_load_dwordx4 v15, s[32:35], s54 offen offset:3168   lds
MAA 104,20,152
v_mfma_f32_16x16x32_bf16 v[108:111], a[16:19], a[140:143], 0
MAA 108,20,156
v_mfma_f32_16x16x32_bf16 v[60:63], a[8:11], a[140:143], 0
MAA 60,12,156
v_mfma_f32_16x16x32_bf16 v[56:59], a[8:11], a[136:139], 0
MAA 56,12,152
v_mfma_f32_16x16x32_bf16 v[40:43], a[0:3], a[136:139], 0
MAA 40,4,152
v_mfma_f32_16x16x32_bf16 v[44:47], a[0:3], a[140:143], 0
MAA 44,4,156
s_waitcnt lgkmcnt(0)
s_barrier
v_mfma_f32_16x16x32_bf16 v[64:67], a[64:67], a[128:131], 0
TR 0,16,33792
s_add_u32 m0, s55, 101376
MAA 64,68,144
buffer_load_dwordx4 v12, s[80:83], s54 offen   lds
v_mfma_f32_16x16x32_bf16 v[68:71], a[64:67], a[132:135], 0
TR 2,16,34304
s_mul_i32 s66, s13, 114688
MAA 68,68,148
TR 4,16,42240
s_mul_i32 s65, s10, 1818624
v_mfma_f32_16x16x32_bf16 v[84:87], a[72:75], a[132:135], 0
TR 6,16,42752
s_add_u32 s66, s66, s65
MAA 84,76,148
TR 8,16,33824
s_add_u32 s66, s66, 46137344
v_mfma_f32_16x16x32_bf16 v[80:83], a[72:75], a[128:131], 0
buffer_load_dwordx4 v13, s[80:83], s54 offen offset:1056   lds
MAA 80,76,144
TR 10,16,34336
s_add_u32 s65, s66, 49152
v_mfma_f32_16x16x32_bf16 v[128:131], a[80:83], a[128:131], 0
TR 12,16,42272
s_lshl_b32 s62, s12, 16
MAA 128,84,144
TR 14,16,42784
s_add_u32 s62, s62, s66
v_mfma_f32_16x16x32_bf16 v[132:135], a[80:83], a[132:135], 0
TR 16,16,33856
s_add_u32 s63, s62, 16384
MAA 132,84,148
buffer_load_dwordx4 v14, s[80:83], s54 offen offset:2112   lds
v_mfma_f32_16x16x32_bf16 v[148:151], a[88:91], a[132:135], 0
TR 18,16,34368
s_add_u32 s64, s62, 32768
MAA 148,92,148
TR 20,16,42304
s_lshl_b32 s72, s10, 1
v_mfma_f32_16x16x32_bf16 v[144:147], a[88:91], a[128:131], 0
TR 22,16,42816
s_lshr_b32 s74, s11, 4
MAA 144,92,144
TR 24,16,33888
s_add_u32 s72, s72, s74
v_mfma_f32_16x16x32_bf16 v[192:195], a[96:99], a[128:131], 0
buffer_load_dwordx4 v15, s[80:83], s54 offen offset:3168   lds
MAA 192,100,144
TR 26,16,34400
s_add_u32 s54, s54, 458752
v_mfma_f32_16x16x32_bf16 v[196:199], a[96:99], a[132:135], 0
TR 28,16,42336
s_add_u32 m0, s57, 0
MAA 196,100,148
TR 30,16,42848
s_mov_b32 s58, 63176704
v_mfma_f32_16x16x32_bf16 v[212:215], a[104:107], a[132:135], 0
TR 32,16,33920
s_lshl_b32 s72, s72, 10
MAA 212,108,148
buffer_load_dwordx4 v4, s[16:19], s58 offen sc1 lds
v_mfma_f32_16x16x32_bf16 v[208:211], a[104:107], a[128:131], 0
TR 34,16,34432
s_add_u32 s72, s72, 30523392
MAA 208,108,144
TR 36,16,42368
s_and_b32 s73, s6, 14
v_mfma_f32_16x16x32_bf16 v[240:243], a[112:115], a[128:131], 0
TR 38,16,42880
s_and_b32 s74, s7, 1
MAA 240,116,144
TR 40,16,33952
s_add_u32 s73, s73, s74
v_mfma_f32_16x16x32_bf16 v[244:247], a[112:115], a[132:135], 0
buffer_load_dwordx4 v4, s[16:19], s58 offen offset:1024 sc1 lds
MAA 244,116,148
TR 42,16,34464
s_lshl_b32 s73, s73, 10
v_mfma_f32_16x16x32_bf16 v[252:255], a[120:123], a[132:135], 0
TR 44,16,42400
s_add_u32 s73, s73, 30523392
MAA 252,124,148
TR 46,16,42912
s_lshr_b32 s67, s5, 2
v_mfma_f32_16x16x32_bf16 v[248:251], a[120:123], a[128:131], 0
TR 48,17,33792
s_and_b32 s67, s67, 3
MAA 248,124,144
buffer_load_dwordx4 a[128:131], v10, s[16:19], s52 offen sc1
v_mfma_f32_16x16x32_bf16 v[220:223], a[104:107], a[140:143], 0
TR 50,17,34304
s_lshl_b32 s67, s67, 7
MAA 220,108,156
TR 52,17,42240
s_add_u32 s73, s73, s67
v_mfma_f32_16x16x32_bf16 v[216:219], a[104:107], a[136:139], 0
TR 54,17,42752
MAA 216,108,152
TR 56,17,33824
v_mfma_f32_16x16x32_bf16 v[200:203], a[96:99], a[136:139], 0
buffer_load_dwordx4 a[132:135], v10, s[16:19], s52 offen offset:1024 sc1
MAA 200,100,152
TR 58,17,34336
s_add_u32 s52, s52, 131072
v_mfma_f32_16x16x32_bf16 v[204:207], a[96:99], a[140:143], 0
TR 60,17,42272
MAA 204,100,156
TR 62,17,42784
v_mfma_f32_16x16x32_bf16 v[156:159], a[88:91], a[140:143], 0
MAA 156,92,156
buffer_load_dwordx4 a[144:147], v10, s[16:19], s52 offen sc1
v_mfma_f32_16x16x32_bf16 v[152:155], a[88:91], a[136:139], 0
MAA 152,92,152
v_mfma_f32_16x16x32_bf16 v[136:139], a[80:83], a[136:139], 0
MAA 136,84,152
v_mfma_f32_16x16x32_bf16 v[140:143], a[80:83], a[140:143], 0
buffer_load_dwordx4 a[148:151], v10, s[16:19], s52 offen offset:1024 sc1
MAA 140,84,156
s_add_u32 s52, s52, 131072
v_mfma_f32_16x16x32_bf16 v[92:95], a[72:75], a[140:143], 0
MAA 92,76,156
v_mfma_f32_16x16x32_bf16 v[88:91], a[72:75], a[136:139], 0
MAA 88,76,152
v_mfma_f32_16x16x32_bf16 v[72:75], a[64:67], a[136:139], 0
MAA 72,68,152
v_mfma_f32_16x16x32_bf16 v[76:79], a[64:67], a[140:143], 0
MAA 76,68,156
s_waitcnt vmcnt(18) lgkmcnt(0)
s_barrier
MAA 32,0,160
buffer_load_dwordx4 a[136:139], v11, s[16:19], s53 offen sc1
MAA 32,4,176
TR 64,16,50688
s_and_b32 s74, s7, 1
MAA 36,4,180
TR 66,16,51200
s_mul_i32 s87, s74, 917504
MAA 36,0,164
TR 68,16,59136
s_lshr_b32 s75, s6, 1
MAA 52,8,164
TR 70,16,59648
s_mul_i32 s75, s75, 1818624
MAA 52,12,180
buffer_load_dwordx4 a[140:143], v11, s[16:19], s53 offen offset:1024 sc1
MAA 48,12,176
TR 72,16,50720
s_add_u32 s53, s53, 131072
MAA 48,8,160
TR 74,16,51232
s_add_u32 s87, s87, s75
MAA 96,16,160
TR 76,16,59168
s_add_u32 s87, s87, 46137344
MAA 96,20,176
TR 78,16,59680
s_and_b32 s74, s6, 3
MAA 100,20,180
buffer_load_dwordx4 a[152:155], v11, s[16:19], s53 offen sc1
MAA 100,16,164
TR 80,16,50752
s_xor_b32 s75, s74, 0
MAA 116,24,164
TR 82,16,51264
s_sub_u32 s75, s75, 0
MAA 116,28,180
TR 84,16,59200
s_mul_i32 s98, s75, 458752
MAA 112,28,176
TR 86,16,59712
s_mul_i32 s75, s75, 114688
MAA 112,24,160
buffer_load_dwordx4 a[156:159], v11, s[16:19], s53 offen offset:1024 sc1
MAA 160,32,160
TR 88,16,50784
s_add_u32 s53, s53, 131072
MAA 160,36,176
TR 90,16,51296
s_add_u32 m0, s55, 118272
MAA 164,36,180
TR 92,16,59232
s_add_u32 s76, s87, s75
MAA 164,32,164
TR 94,16,59744
s_xor_b32 s75, s74, 1
MAA 180,40,164
buffer_load_dwordx4 v12, s[32:35], s54 offen   lds
MAA 180,44,180
TR 96,16,50816
s_sub_u32 s75, s75, 1
MAA 176,44,176
TR 98,16,51328
s_mul_i32 s99, s75, 458752
MAA 176,40,160
TR 100,16,59264
s_mul_i32 s75, s75, 114688
MAA 224,48,160
TR 102,16,59776
s_add_u32 s77, s87, s75
MAA 224,52,176
buffer_load_dwordx4 v13, s[32:35], s54 offen offset:1056   lds
MAA 228,52,180
TR 104,16,50848
s_xor_b32 s75, s74, 2
MAA 228,48,164
TR 106,16,51360
s_sub_u32 s75, s75, 2
MAA 236,56,164
TR 108,16,59296
s_mul_i32 s100, s75, 458752
MAA 236,60,180
TR 110,16,59808
s_mul_i32 s75, s75, 114688
MAA 232,60,176
buffer_load_dwordx4 v14, s[32:35], s54 offen offset:2112   lds
MAA 232,56,160
TR 112,17,50688
s_add_u32 s78, s87, s75
s_waitcnt vmcnt(21)
MAA 188,40,172
TR 114,17,51200
s_xor_b32 s75, s74, 3
MAA 188,44,188
TR 116,17,59136
MAA 184,44,184
TR 118,17,59648
MAA 184,40,168
buffer_load_dwordx4 v15, s[32:35], s54 offen offset:3168   lds
MAA 168,32,168
TR 120,17,50720
s_add_u32 m0, s57, 2048
MAA 168,36,184
TR 122,17,51232
s_mov_b32 s58, 63178752
MAA 172,36,188
TR 124,17,59168
MAA 172,32,172
TR 126,17,59680
MAA 124,24,172
buffer_load_dwordx4 v4, s[16:19], s58 offen sc1 lds
MAA 124,28,188
MAA 120,28,184
MAA 120,24,168
MAA 104,16,168
MAA 104,20,184
buffer_load_dwordx4 v4, s[16:19], s58 offen offset:1024 sc1 lds
MAA 108,20,188
MAA 108,16,172
MAA 60,8,172
MAA 60,12,188
MAA 56,12,184
MAA 56,8,168
MAA 40,0,168
MAA 40,4,184
MAA 44,4,188
MAA 44,0,172
s_waitcnt vmcnt(20) lgkmcnt(0)
s_barrier
MAA 64,64,160
ds_read_b64_tr_b16 a[0:1], v16
s_add_u32 m0, s55, 135168
MAA 64,68,176
buffer_load_dwordx4 v12, s[80:83], s54 offen   lds
MAA 68,68,180
TR 2,16,512
s_sub_u32 s75, s75, 3
MAA 68,64,164
TR 4,16,8448
s_mul_i32 s101, s75, 458752
MAA 84,72,164
TR 6,16,8960
s_mul_i32 s75, s75, 114688
MAA 84,76,180
TR 8,16,32
s_add_u32 s79, s87, s75
MAA 80,76,176
buffer_load_dwordx4 v13, s[80:83], s54 offen offset:1056   lds
MAA 80,72,160
TR 10,16,544
s_and_b32 s87, s6, 3
MAA 128,80,160
TR 12,16,8480
s_mov_b32 s46, 0
MAA 128,84,176
TR 14,16,8992
s_lshl_b32 s74, s3, 10
MAA 132,84,180
TR 16,16,64
s_lshl_b32 s75, s12, 9
MAA 132,80,164
buffer_load_dwordx4 v14, s[80:83], s54 offen offset:2112   lds
MAA 148,88,164
TR 18,16,576
s_add_u32 s74, s74, s75
MAA 148,92,180
TR 20,16,8512
s_add_u32 s74, s74, 152576
MAA 144,92,176
TR 22,16,9024
v_and_b32 v18, 15, v1
MAA 144,88,160
TR 24,16,96
v_lshl_add_u32 v18, v18, 4, s74
MAA 192,96,160
buffer_load_dwordx4 v15, s[80:83], s54 offen offset:3168   lds
MAA 192,100,176
TR 26,16,608
s_add_u32 s54, s54, 458752
MAA 196,100,180
TR 28,16,8544
s_add_u32 m0, s57, 4096
MAA 196,96,164
TR 30,16,9056
s_mov_b32 s58, 63180800
MAA 212,104,164
TR 32,16,128
v_xor_b32 v19, 512, v18
MAA 212,108,180
buffer_load_dwordx4 v4, s[16:19], s58 offen sc1 lds
MAA 208,108,176
TR 34,16,640
s_lshl_b32 s74, s12, 7
MAA 208,104,160
TR 36,16,8576
s_add_u32 s74, s74, 161536
MAA 240,112,160
TR 38,16,9088
s_xor_b32 s75, s12, 1
MAA 240,116,176
TR 40,16,160
s_mul_i32 s75, s75, 384
MAA 244,116,180
buffer_load_dwordx4 v4, s[16:19], s58 offen offset:1024 sc1 lds
MAA 244,112,164
.Lpad22:
s_cbranch_execz .Lpad25
TR 42,16,672
s_add_u32 s75, s75, 161536
MAA 252,120,164
TR 44,16,8608
v_lshrrev_b32 v9, 4, v1
MAA 252,124,180
TR 46,16,9120
v_lshlrev_b32 v9, 4, v9
MAA 248,124,176
ds_read_b64_tr_b16 a[48:49], v17
v_add_u32 v8, s75, v9
MAA 248,120,160
buffer_load_dwordx4 a[160:163], v10, s[16:19], s52 offen sc1
MAA 220,104,172
TR 50,17,512
v_add_u32 v9, s74, v9
MAA 220,108,188
TR 52,17,8448
MAA 216,108,184
TR 54,17,8960
MAA 216,104,168
TR 56,17,32
MAA 200,96,168
buffer_load_dwordx4 a[164:167], v10, s[16:19], s52 offen offset:1024 sc1
MAA 200,100,184
TR 58,17,544
s_add_u32 s52, s52, 131072
MAA 204,100,188
TR 60,17,8480
MAA 204,96,172
TR 62,17,8992
MAA 156,88,172
MAA 156,92,188
buffer_load_dwordx4 a[176:179], v10, s[16:19], s52 offen sc1
MAA 152,92,184
MAA 152,88,168
MAA 136,80,168
MAA 136,84,184
MAA 140,84,188
buffer_load_dwordx4 a[180:183], v10, s[16:19], s52 offen offset:1024 sc1
MAA 140,80,172
s_add_u32 s52, s52, 131072
MAA 92,72,172
MAA 92,76,188
MAA 88,76,184
MAA 88,72,168
MAA 72,64,168
MAA 72,68,184
MAA 76,68,188
MAA 76,64,172
s_waitcnt vmcnt(20) lgkmcnt(0)
s_barrier
MAA 32,0,128
buffer_load_dwordx4 a[168:171], v11, s[16:19], s53 offen sc1
MAA 32,4,144
ds_read_b128 v[20:23], v2
MAA 36,4,148
ds_read_b128 v[28:31], v2 offset:1024
MAA 36,0,132
s_waitcnt vmcnt(11)
ds_read_b128 v[24:27], v2 offset:2048
MAA 52,8,132
TR 64,16,16896
MAA 52,12,148
buffer_load_dwordx4 a[172:175], v11, s[16:19], s53 offen offset:1024 sc1
MAA 48,12,144
TR 66,16,17408
s_add_u32 s53, s53, 131072
MAA 48,8,128
TR 68,16,25344
MAA 96,16,128
TR 70,16,25856
MAA 96,20,144
TR 72,16,16928
MAA 100,20,148
buffer_load_dwordx4 a[184:187], v11, s[16:19], s53 offen sc1
MAA 100,16,132
TR 74,16,17440
s_waitcnt lgkmcnt(7)
v_add_f32 v20, v20, v28
MAA 116,24,132
TR 76,16,25376
v_add_f32 v21, v21, v29
MAA 116,28,148
TR 78,16,25888
v_add_f32 v22, v22, v30
MAA 112,28,144
TR 80,16,16960
v_add_f32 v23, v23, v31
MAA 112,24,128
buffer_load_dwordx4 a[188:191], v11, s[16:19], s53 offen offset:1024 sc1
MAA 160,32,128
ds_read_b128 v[28:31], v2 offset:3072
s_add_u32 s53, s53, 131072
MAA 160,36,144
TR 82,16,17472
s_add_u32 m0, s55, 84480
MAA 164,36,148
TR 84,16,25408
s_waitcnt lgkmcnt(12)
v_add_f32 v20, v20, v24
MAA 164,32,132
TR 86,16,25920
v_add_f32 v21, v21, v25
MAA 180,40,132
buffer_load_dwordx4 v12, s[32:35], s54 offen   lds
MAA 180,44,148
TR 88,16,16992
v_add_f32 v22, v22, v26
MAA 176,44,144
TR 90,16,17504
v_add_f32 v23, v23, v27
MAA 176,40,128
TR 92,16,25440
MAA 224,48,128
TR 94,16,25952
MAA 224,52,144
buffer_load_dwordx4 v13, s[32:35], s54 offen offset:1056   lds
MAA 228,52,148
TR 96,16,17024
MAA 228,48,132
TR 98,16,17536
MAA 236,56,132
TR 100,16,25472
MAA 236,60,148
TR 102,16,25984
MAA 232,60,144
buffer_load_dwordx4 v14, s[32:35], s54 offen offset:2112   lds
MAA 232,56,128
TR 104,16,17056
MAA 188,40,140
TR 106,16,17568
MAA 188,44,156
TR 108,16,25504
MAA 184,44,152
TR 110,16,26016
MAA 184,40,136
buffer_load_dwordx4 v15, s[32:35], s54 offen offset:3168   lds
MAA 168,32,136
TR 112,17,16896
s_add_u32 m0, s57, 6144
MAA 168,36,152
TR 114,17,17408
s_mov_b32 s58, 63182848
MAA 172,36,156
TR 116,17,25344
MAA 172,32,140
TR 118,17,25856
MAA 124,24,140
buffer_load_dwordx4 v4, s[16:19], s58 offen sc1 lds
MAA 124,28,156
TR 120,17,16928
MAA 120,28,152
TR 122,17,17440
MAA 120,24,136
TR 124,17,25376
MAA 104,16,136
TR 126,17,25888
MAA 104,20,152
buffer_load_dwordx4 v4, s[16:19], s58 offen offset:1024 sc1 lds
MAA 108,20,156
MAA 108,16,140
MAA 60,8,140
MAA 60,12,156
MAA 56,12,152
MAA 56,8,136
MAA 40,0,136
MAA 40,4,152
MAA 44,4,156
MAA 44,0,140
s_waitcnt lgkmcnt(0)
s_barrier
MAA 64,64,128
s_waitcnt vmcnt(14)
ds_read_b128 v[24:27], v2 offset:4096
s_add_u32 m0, s55, 101376
MAA 64,68,144
buffer_load_dwordx4 v12, s[80:83], s54 offen   lds
MAA 68,68,148
TR 0,16,33792
v_add_f32 v20, v20, v28
MAA 68,64,132
TR 2,16,34304
v_add_f32 v21, v21, v29
MAA 84,72,132
TR 4,16,42240
v_add_f32 v22, v22, v30
MAA 84,76,148
TR 6,16,42752
v_add_f32 v23, v23, v31
MAA 80,76,144
ds_read_b128 v[28:31], v2 offset:5120
MAA 80,72,128
TR 8,16,33824
MAA 128,80,128
buffer_load_dwordx4 v13, s[80:83], s54 offen offset:1056   lds
MAA 128,84,144
TR 10,16,34336
s_waitcnt lgkmcnt(7)
v_add_f32 v20, v20, v24
MAA 132,84,148
TR 12,16,42272
v_add_f32 v21, v21, v25
MAA 132,80,132
TR 14,16,42784
v_add_f32 v22, v22, v26
MAA 148,88,132
TR 16,16,33856
v_add_f32 v23, v23, v27
MAA 148,92,148
TR 18,16,34368
MAA 144,92,144
TR 20,16,42304
MAA 144,88,128
buffer_load_dwordx4 v14, s[80:83], s54 offen offset:2112   lds
MAA 192,96,128
TR 22,16,42816
MAA 192,100,144
TR 24,16,33888
MAA 196,100,148
TR 26,16,34400
MAA 196,96,132
TR 28,16,42336
MAA 212,104,132
TR 30,16,42848
MAA 212,108,148
TR 32,16,33920
MAA 208,108,144
buffer_load_dwordx4 v15, s[80:83], s54 offen offset:3168   lds
MAA 208,104,128
TR 34,16,34432
s_add_u32 s54, s54, 458752
MAA 240,112,128
TR 36,16,42368
MAA 240,116,144
TR 38,16,42880
MAA 244,116,148
TR 40,16,33952
MAA 244,112,132
TR 42,16,34464
MAA 252,120,132
TR 44,16,42400
MAA 252,124,148
TR 46,16,42912
MAA 248,124,144
TR 48,17,33792
MAA 248,120,128
buffer_load_dwordx4 a[128:131], v10, s[16:19], s52 offen sc1
MAA 220,104,140
TR 50,17,34304
MAA 220,108,156
TR 52,17,42240
MAA 216,108,152
TR 54,17,42752
MAA 216,104,136
TR 56,17,33824
MAA 200,96,136
TR 58,17,34336
MAA 200,100,152
TR 60,17,42272
MAA 204,100,156
buffer_load_dwordx4 a[132:135], v10, s[16:19], s52 offen offset:1024 sc1
MAA 204,96,140
TR 62,17,42784
s_add_u32 s52, s52, 131072
MAA 156,88,140
MAA 156,92,156
MAA 152,92,152
MAA 152,88,136
MAA 136,80,136
MAA 136,84,152
buffer_load_dwordx4 a[144:147], v10, s[16:19], s52 offen sc1
MAA 140,84,156
MAA 140,80,140
MAA 92,72,140
MAA 92,76,156
MAA 88,76,152
MAA 88,72,136
MAA 72,64,136
buffer_load_dwordx4 a[148:151], v10, s[16:19], s52 offen offset:1024 sc1
MAA 72,68,152
s_add_u32 s52, s52, 131072
MAA 76,68,156
MAA 76,64,140
s_waitcnt vmcnt(18) lgkmcnt(0)
s_barrier
MAA 32,0,160
buffer_load_dwordx4 a[136:139], v11, s[16:19], s53 offen sc1
MAA 32,4,176
s_waitcnt vmcnt(9)
ds_read_b128 v[24:27], v2 offset:6144
v_add_f32 v20, v20, v28
MAA 36,4,180
TR 64,16,50688
v_add_f32 v21, v21, v29
MAA 36,0,164
TR 66,16,51200
v_add_f32 v22, v22, v30
MAA 52,8,164
TR 68,16,59136
v_add_f32 v23, v23, v31
MAA 52,12,180
ds_read_b128 v[28:31], v2 offset:7168
MAA 48,12,176
TR 70,16,59648
MAA 48,8,160
buffer_load_dwordx4 a[140:143], v11, s[16:19], s53 offen offset:1024 sc1
MAA 96,16,160
TR 72,16,50720
s_add_u32 s53, s53, 131072
MAA 96,20,176
TR 74,16,51232
s_waitcnt lgkmcnt(7)
v_add_f32 v20, v20, v24
MAA 100,20,180
TR 76,16,59168
v_add_f32 v21, v21, v25
MAA 100,16,164
TR 78,16,59680
v_add_f32 v22, v22, v26
MAA 116,24,164
TR 80,16,50752
v_add_f32 v23, v23, v27
MAA 116,28,180
TR 82,16,51264
s_waitcnt lgkmcnt(7)
v_add_f32 v20, v20, v28
MAA 112,28,176
buffer_load_dwordx4 a[152:155], v11, s[16:19], s53 offen sc1
MAA 112,24,160
TR 84,16,59200
v_add_f32 v21, v21, v29
MAA 160,32,160
TR 86,16,59712
v_add_f32 v22, v22, v30
MAA 160,36,176
TR 88,16,50784
v_add_f32 v23, v23, v31
MAA 164,36,180
TR 90,16,51296
MAA 164,32,164
TR 92,16,59232
MAA 180,40,164
TR 94,16,59744
MAA 180,44,180
buffer_load_dwordx4 a[156:159], v11, s[16:19], s53 offen offset:1024 sc1
MAA 176,44,176
TR 96,16,50816
s_add_u32 s53, s53, 131072
MAA 176,40,160
TR 98,16,51328
s_add_u32 m0, s55, 118272
MAA 224,48,160
TR 100,16,59264
MAA 224,52,176
TR 102,16,59776
MAA 228,52,180
TR 104,16,50848
MAA 228,48,164
TR 106,16,51360
MAA 236,56,164
buffer_load_dwordx4 v12, s[32:35], s54 offen   lds
MAA 236,60,180
TR 108,16,59296
MAA 232,60,176
TR 110,16,59808
MAA 232,56,160
TR 112,17,50688
MAA 188,40,172
TR 114,17,51200
MAA 188,44,188
TR 116,17,59136
MAA 184,44,184
TR 118,17,59648
MAA 184,40,168
buffer_load_dwordx4 v13, s[32:35], s54 offen offset:1056   lds
MAA 168,32,168
TR 120,17,50720
MAA 168,36,184
TR 122,17,51232
MAA 172,36,188
TR 124,17,59168
MAA 172,32,172
TR 126,17,59680
MAA 124,24,172
MAA 124,28,188
MAA 120,28,184
buffer_load_dwordx4 v14, s[32:35], s54 offen offset:2112   lds
MAA 120,24,168
MAA 104,16,168
MAA 104,20,184
MAA 108,20,188
MAA 108,16,172
MAA 60,8,172
MAA 60,12,188
buffer_load_dwordx4 v15, s[32:35], s54 offen offset:3168   lds
MAA 56,12,184
MAA 56,8,168
MAA 40,0,168
MAA 40,4,184
MAA 44,4,188
MAA 44,0,172
s_waitcnt lgkmcnt(0)
s_barrier
MAA 64,64,160
ds_read_b64_tr_b16 a[0:1], v16
s_add_u32 m0, s55, 135168
MAA 64,68,176
buffer_load_dwordx4 v12, s[80:83], s54 offen   lds
MAA 68,68,180
TR 2,16,512
v_permlane32_swap_b32 v20, v22
MAA 68,64,164
TR 4,16,8448
v_permlane32_swap_b32 v21, v23
MAA 84,72,164
TR 6,16,8960
v_add_f32 v20, v20, v22
MAA 84,76,180
TR 8,16,32
v_add_f32 v21, v21, v23
MAA 80,76,176
TR 10,16,544
v_mul_f32 v20, 0xba800000, v20
MAA 80,72,160
buffer_load_dwordx4 v13, s[80:83], s54 offen offset:1056   lds
MAA 128,80,160
TR 12,16,8480
v_mul_f32 v21, 0x3a800000, v21
MAA 128,84,176
TR 14,16,8992
v_fma_f32 v21, -v20, v20, v21
MAA 132,84,180
TR 16,16,64
v_max_f32 v21, 0, v21
MAA 132,80,164
TR 18,16,576
v_add_f32 v21, 0x3727c5ac, v21
MAA 148,88,164
TR 20,16,8512
v_rsq_f32 v22, v21
MAA 148,92,180
buffer_load_dwordx4 v14, s[80:83], s54 offen offset:2112   lds
MAA 144,92,176
TR 22,16,9024
v_and_b32 v24, 31, v1
MAA 144,88,160
TR 24,16,96
v_lshrrev_b32 v25, 5, v1
MAA 192,96,160
TR 26,16,608
v_lshl_add_u32 v24, v24, 1, v25
MAA 192,100,176
TR 28,16,8544
v_and_b32 v25, 0xc0, v0
MAA 196,100,180
TR 30,16,9056
v_add_u32 v24, v24, v25
MAA 196,96,164
TR 32,16,128
v_lshlrev_b32 v24, 4, v24
MAA 212,104,164
buffer_load_dwordx4 v15, s[80:83], s54 offen offset:3168   lds
MAA 212,108,180
TR 34,16,640
s_add_u32 s54, s54, 458752
MAA 208,108,176
TR 36,16,8576
v_add_u32 v24, 152576, v24
MAA 208,104,160
TR 38,16,9088
v_mul_f32 v22, 0xbfb8aa3b, v22
MAA 240,112,160
ds_write_b128 v24, v[20:23]
s_mov_b32 s58, s98
MAA 240,116,176
ds_read_b64 v[20:21], v18
s_mov_b32 s67, s59
MAA 244,116,180
ds_read_b64 v[22:23], v18 offset:256
MAA 244,112,164
ds_read_b64 v[24:25], v19
MAA 252,120,164
ds_read_b64 v[26:27], v19 offset:256
MAA 252,124,180
ds_read_b32 a192, v18 offset:8
MAA 248,124,176
ds_read_b32 a193, v18 offset:264
v_mov_b32 v18, v5
MAA 248,120,160
buffer_load_dwordx4 a[160:163], v10, s[16:19], s52 offen sc1
MAA 220,104,172
ds_read_b32 a194, v19 offset:8
MAA 220,108,188
ds_read_b32 a195, v19 offset:264
v_mov_b32 v19, v6
MAA 216,108,184
TR 40,16,160
MAA 216,104,168
TR 42,16,672
MAA 200,96,168
TR 44,16,8608
MAA 200,100,184
TR 46,16,9120
MAA 204,100,188
buffer_load_dwordx4 a[164:167], v10, s[16:19], s52 offen offset:1024 sc1
MAA 204,96,172
ds_read_b64_tr_b16 a[48:49], v17
s_add_u32 s52, s52, 131072
MAA 156,88,172
TR 50,17,512
MAA 156,92,188
TR 52,17,8448
MAA 152,92,184
TR 54,17,8960
MAA 152,88,168
TR 56,17,32
MAA 136,80,168
TR 58,17,544
MAA 136,84,184
buffer_load_dwordx4 a[176:179], v10, s[16:19], s52 offen sc1
MAA 140,84,188
TR 60,17,8480
MAA 140,80,172
TR 62,17,8992
MAA 92,72,172
MAA 92,76,188
MAA 88,76,184
MAA 88,72,168
MAA 72,64,168
buffer_load_dwordx4 a[180:183], v10, s[16:19], s52 offen offset:1024 sc1
MAA 72,68,184
s_add_u32 s52, s52, 131072
MAA 76,68,188
MAA 76,64,172
s_waitcnt vmcnt(16) lgkmcnt(0)
s_barrier
MAA 32,0,128
ds_read_b128 v[28:31], v9 offset:512
MAA 32,4,144
ds_read_b128 v[4:7], v9 offset:576
MAA 36,4,148
buffer_load_dwordx4 a[168:171], v11, s[16:19], s53 offen sc1
.Lpad23:
s_cbranch_execz .Lnopoll59r
MAA 36,0,132
TR 64,16,16896
MAA 52,8,132
TR 66,16,17408
MAA 52,12,148
TR 68,16,25344
MAA 48,12,144
TR 70,16,25856
MAA 48,8,128
TR 72,16,16928
MAA 96,16,128
buffer_load_dwordx4 a[172:175], v11, s[16:19], s53 offen offset:1024 sc1
MAA 96,20,144
TR 74,16,17440
s_add_u32 s53, s53, 131072
MAA 100,20,148
TR 76,16,25376
s_waitcnt lgkmcnt(8)
v_fmac_f32 v64, v28, v20
MAA 100,16,132
TR 78,16,25888
v_fmac_f32 v65, v29, v20
MAA 116,24,132
TR 80,16,16960
v_fmac_f32 v66, v30, v20
MAA 116,28,148
TR 82,16,17472
v_fmac_f32 v67, v31, v20
MAA 112,28,144
buffer_load_dwordx4 a[184:187], v11, s[16:19], s53 offen sc1
MAA 112,24,128
TR 84,16,25408
v_fmac_f32 v68, v28, v22
MAA 160,32,128
TR 86,16,25920
v_fmac_f32 v69, v29, v22
MAA 160,36,144
TR 88,16,16992
v_fmac_f32 v70, v30, v22
MAA 164,36,148
TR 90,16,17504
v_fmac_f32 v71, v31, v22
MAA 164,32,132
TR 92,16,25440
v_fmac_f32 v72, v28, v24
MAA 180,40,132
buffer_load_dwordx4 a[188:191], v11, s[16:19], s53 offen offset:1024 sc1
MAA 180,44,148
TR 94,16,25952
s_add_u32 s53, s53, 131072
MAA 176,44,144
TR 96,16,17024
s_add_u32 m0, s55, 84480
MAA 176,40,128
TR 98,16,17536
v_fmac_f32 v73, v29, v24
MAA 224,48,128
TR 100,16,25472
v_fmac_f32 v74, v30, v24
MAA 224,52,144
TR 102,16,25984
v_fmac_f32 v75, v31, v24
MAA 228,52,148
buffer_load_dwordx4 v12, s[32:35], s54 offen   lds
MAA 228,48,132
TR 104,16,17056
v_fmac_f32 v76, v28, v26
MAA 236,56,132
TR 106,16,17568
v_fmac_f32 v77, v29, v26
MAA 236,60,148
TR 108,16,25504
v_fmac_f32 v78, v30, v26
MAA 232,60,144
TR 110,16,26016
v_fmac_f32 v79, v31, v26
MAA 232,56,128
ds_read_b128 v[28:31], v9 offset:640
s_waitcnt lgkmcnt(15)
v_fmac_f32 v80, v4, v20
s_waitcnt vmcnt(17)
MAA 188,40,140
buffer_load_dwordx4 v13, s[32:35], s54 offen offset:1056   lds
MAA 188,44,156
TR 112,17,16896
v_fmac_f32 v81, v5, v20
MAA 184,44,152
TR 114,17,17408
v_fmac_f32 v82, v6, v20
MAA 184,40,136
TR 116,17,25344
v_fmac_f32 v83, v7, v20
MAA 168,32,136
TR 118,17,25856
v_fmac_f32 v84, v4, v22
MAA 168,36,152
TR 120,17,16928
v_fmac_f32 v85, v5, v22
MAA 172,36,156
buffer_load_dwordx4 v14, s[32:35], s54 offen offset:2112   lds
MAA 172,32,140
TR 122,17,17440
v_fmac_f32 v86, v6, v22
MAA 124,24,140
TR 124,17,25376
v_fmac_f32 v87, v7, v22
MAA 124,28,156
TR 126,17,25888
v_fmac_f32 v88, v4, v24
MAA 120,28,152
v_fmac_f32 v89, v5, v24
v_fmac_f32 v90, v6, v24
MAA 120,24,136
v_fmac_f32 v91, v7, v24
v_fmac_f32 v92, v4, v26
MAA 104,16,136
buffer_load_dwordx4 v15, s[32:35], s54 offen offset:3168   lds
MAA 104,20,152
s_mov_b32 m0, s67
v_fmac_f32 v93, v5, v26
v_fmac_f32 v94, v6, v26
MAA 108,20,156
v_fmac_f32 v95, v7, v26
s_waitcnt lgkmcnt(8)
v_fmac_f32 v128, v28, v20
MAA 108,16,140
ds_read_b128 v[4:7], v8 offset:512
v_fmac_f32 v129, v29, v20
MAA 60,8,140
v_fmac_f32 v130, v30, v20
v_fmac_f32 v131, v31, v20
MAA 60,12,156
v_fmac_f32 v132, v28, v22
v_fmac_f32 v133, v29, v22
MAA 56,12,152
buffer_load_dwordx4 v18, s[28:31], s58 offen lds
MAA 56,8,136
v_fmac_f32 v134, v30, v22
v_fmac_f32 v135, v31, v22
MAA 40,0,136
v_fmac_f32 v136, v28, v24
v_fmac_f32 v137, v29, v24
MAA 40,4,152
v_fmac_f32 v138, v30, v24
v_fmac_f32 v139, v31, v24
MAA 44,4,156
v_fmac_f32 v140, v28, v26
v_fmac_f32 v141, v29, v26
MAA 44,0,140
v_fmac_f32 v142, v30, v26
v_fmac_f32 v143, v31, v26
s_waitcnt lgkmcnt(0)
v_fmac_f32 v240, v4, v20
v_fmac_f32 v241, v5, v20
v_fmac_f32 v242, v6, v20
v_fmac_f32 v243, v7, v20
v_fmac_f32 v244, v4, v22
v_fmac_f32 v245, v5, v22
v_fmac_f32 v246, v6, v22
v_fmac_f32 v247, v7, v22
s_waitcnt vmcnt(17) lgkmcnt(0)
s_barrier
MAA 64,64,128
ds_read_b128 v[28:31], v9
s_add_u32 m0, s55, 101376
MAA 64,68,144
ds_read_b128 v[4:7], v9 offset:64
MAA 68,68,148
buffer_load_dwordx4 v12, s[80:83], s54 offen   lds
MAA 68,64,132
TR 0,16,33792
MAA 84,72,132
TR 2,16,34304
MAA 84,76,148
TR 4,16,42240
MAA 80,76,144
TR 6,16,42752
MAA 80,72,128
TR 8,16,33824
MAA 128,80,128
buffer_load_dwordx4 v13, s[80:83], s54 offen offset:1056   lds
MAA 128,84,144
TR 10,16,34336
s_waitcnt lgkmcnt(7)
v_fmac_f32 v32, v28, v20
MAA 132,84,148
TR 12,16,42272
v_fmac_f32 v33, v29, v20
MAA 132,80,132
TR 14,16,42784
v_fmac_f32 v34, v30, v20
MAA 148,88,132
TR 16,16,33856
v_fmac_f32 v35, v31, v20
MAA 148,92,148
TR 18,16,34368
v_fmac_f32 v36, v28, v22
MAA 144,92,144
buffer_load_dwordx4 v14, s[80:83], s54 offen offset:2112   lds
MAA 144,88,128
TR 20,16,42304
v_fmac_f32 v37, v29, v22
MAA 192,96,128
TR 22,16,42816
v_fmac_f32 v38, v30, v22
MAA 192,100,144
TR 24,16,33888
v_fmac_f32 v39, v31, v22
MAA 196,100,148
TR 26,16,34400
v_fmac_f32 v40, v28, v24
MAA 196,96,132
TR 28,16,42336
v_fmac_f32 v41, v29, v24
MAA 212,104,132
buffer_load_dwordx4 v15, s[80:83], s54 offen offset:3168   lds
MAA 212,108,148
TR 30,16,42848
s_add_u32 s54, s54, 458752
MAA 208,108,144
TR 32,16,33920
s_mov_b32 m0, s67
MAA 208,104,128
TR 34,16,34432
v_fmac_f32 v42, v30, v24
MAA 240,112,128
TR 36,16,42368
v_fmac_f32 v43, v31, v24
MAA 240,116,144
TR 38,16,42880
v_fmac_f32 v44, v28, v26
MAA 244,116,148
buffer_load_dwordx4 v19, s[28:31], s58 offen offset:1056 lds
MAA 244,112,132
TR 40,16,33952
s_add_u32 s67, s67, 8448
MAA 252,120,132
TR 42,16,34464
s_add_u32 s58, s58, 0x40000
MAA 252,124,148
TR 44,16,42400
v_fmac_f32 v45, v29, v26
MAA 248,124,144
TR 46,16,42912
v_fmac_f32 v46, v30, v26
MAA 248,120,128
TR 48,17,33792
v_fmac_f32 v47, v31, v26
MAA 220,104,140
ds_read_b128 v[28:31], v9 offset:128
s_waitcnt lgkmcnt(15)
v_fmac_f32 v48, v4, v20
MAA 220,108,156
buffer_load_dwordx4 a[128:131], v10, s[16:19], s52 offen sc1
MAA 216,108,152
TR 50,17,34304
v_fmac_f32 v49, v5, v20
MAA 216,104,136
TR 52,17,42240
v_fmac_f32 v50, v6, v20
MAA 200,96,136
TR 54,17,42752
v_fmac_f32 v51, v7, v20
MAA 200,100,152
TR 56,17,33824
v_fmac_f32 v52, v4, v22
MAA 204,100,156
TR 58,17,34336
v_fmac_f32 v53, v5, v22
MAA 204,96,140
buffer_load_dwordx4 a[132:135], v10, s[16:19], s52 offen offset:1024 sc1
MAA 156,88,140
TR 60,17,42272
s_add_u32 s52, s52, 131072
MAA 156,92,156
TR 62,17,42784
v_fmac_f32 v54, v6, v22
MAA 152,92,152
v_fmac_f32 v55, v7, v22
v_fmac_f32 v56, v4, v24
MAA 152,88,136
v_fmac_f32 v57, v5, v24
v_fmac_f32 v58, v6, v24
MAA 136,80,136
v_fmac_f32 v59, v7, v24
v_fmac_f32 v60, v4, v26
MAA 136,84,152
buffer_load_dwordx4 a[144:147], v10, s[16:19], s52 offen sc1
MAA 140,84,156
v_fmac_f32 v61, v5, v26
v_fmac_f32 v62, v6, v26
MAA 140,80,140
v_fmac_f32 v63, v7, v26
s_waitcnt lgkmcnt(7)
v_fmac_f32 v96, v28, v20
MAA 92,72,140
ds_read_b128 v[4:7], v8
v_fmac_f32 v97, v29, v20
MAA 92,76,156
v_fmac_f32 v98, v30, v20
v_fmac_f32 v99, v31, v20
MAA 88,76,152
v_fmac_f32 v100, v28, v22
v_fmac_f32 v101, v29, v22
MAA 88,72,136
buffer_load_dwordx4 a[148:151], v10, s[16:19], s52 offen offset:1024 sc1
MAA 72,64,136
s_add_u32 s52, s52, 131072
v_fmac_f32 v102, v30, v22
v_fmac_f32 v103, v31, v22
MAA 72,68,152
v_fmac_f32 v104, v28, v24
v_fmac_f32 v105, v29, v24
MAA 76,68,156
v_fmac_f32 v106, v30, v24
v_fmac_f32 v107, v31, v24
MAA 76,64,140
v_fmac_f32 v108, v28, v26
v_fmac_f32 v109, v29, v26
v_fmac_f32 v110, v30, v26
v_fmac_f32 v111, v31, v26
s_waitcnt lgkmcnt(0)
v_fmac_f32 v224, v4, v20
v_fmac_f32 v225, v5, v20
v_fmac_f32 v226, v6, v20
v_fmac_f32 v227, v7, v20
v_fmac_f32 v228, v4, v22
v_fmac_f32 v229, v5, v22
v_fmac_f32 v230, v6, v22
v_fmac_f32 v231, v7, v22
s_waitcnt vmcnt(18) lgkmcnt(0)
s_barrier
MAA 32,0,160
ds_read_b128 v[28:31], v9 offset:704
MAA 32,4,176
ds_read_b128 v[4:7], v9 offset:768
MAA 36,4,180
buffer_load_dwordx4 a[136:139], v11, s[16:19], s53 offen sc1
MAA 36,0,164
TR 64,16,50688
MAA 52,8,164
TR 66,16,51200
MAA 52,12,180
TR 68,16,59136
MAA 48,12,176
TR 70,16,59648
MAA 48,8,160
TR 72,16,50720
MAA 96,16,160
buffer_load_dwordx4 a[140:143], v11, s[16:19], s53 offen offset:1024 sc1
MAA 96,20,176
TR 74,16,51232
s_add_u32 s53, s53, 131072
MAA 100,20,180
TR 76,16,59168
s_waitcnt lgkmcnt(8)
v_fmac_f32 v144, v28, v20
MAA 100,16,164
TR 78,16,59680
v_fmac_f32 v145, v29, v20
MAA 116,24,164
TR 80,16,50752
v_fmac_f32 v146, v30, v20
MAA 116,28,180
TR 82,16,51264
v_fmac_f32 v147, v31, v20
MAA 112,28,176
buffer_load_dwordx4 a[152:155], v11, s[16:19], s53 offen sc1
MAA 112,24,160
TR 84,16,59200
v_fmac_f32 v148, v28, v22
MAA 160,32,160
TR 86,16,59712
v_fmac_f32 v149, v29, v22
MAA 160,36,176
TR 88,16,50784
v_fmac_f32 v150, v30, v22
MAA 164,36,180
TR 90,16,51296
v_fmac_f32 v151, v31, v22
MAA 164,32,164
TR 92,16,59232
v_fmac_f32 v152, v28, v24
MAA 180,40,164
buffer_load_dwordx4 a[156:159], v11, s[16:19], s53 offen offset:1024 sc1
MAA 180,44,180
TR 94,16,59744
s_add_u32 s53, s53, 131072
MAA 176,44,176
TR 96,16,50816
s_add_u32 m0, s55, 118272
MAA 176,40,160
TR 98,16,51328
v_fmac_f32 v153, v29, v24
MAA 224,48,160
TR 100,16,59264
v_fmac_f32 v154, v30, v24
MAA 224,52,176
TR 102,16,59776
v_fmac_f32 v155, v31, v24
MAA 228,52,180
buffer_load_dwordx4 v12, s[32:35], s54 offen   lds
MAA 228,48,164
TR 104,16,50848
v_fmac_f32 v156, v28, v26
MAA 236,56,164
TR 106,16,51360
v_fmac_f32 v157, v29, v26
MAA 236,60,180
TR 108,16,59296
v_fmac_f32 v158, v30, v26
MAA 232,60,176
TR 110,16,59808
v_fmac_f32 v159, v31, v26
MAA 232,56,160
ds_read_b128 v[28:31], v9 offset:832
s_waitcnt lgkmcnt(15)
v_fmac_f32 v192, v4, v20
s_waitcnt vmcnt(19)
MAA 188,40,172
buffer_load_dwordx4 v13, s[32:35], s54 offen offset:1056   lds
MAA 188,44,188
TR 112,17,50688
v_fmac_f32 v193, v5, v20
MAA 184,44,184
TR 114,17,51200
v_fmac_f32 v194, v6, v20
MAA 184,40,168
TR 116,17,59136
v_fmac_f32 v195, v7, v20
MAA 168,32,168
TR 118,17,59648
v_fmac_f32 v196, v4, v22
MAA 168,36,184
TR 120,17,50720
v_fmac_f32 v197, v5, v22
MAA 172,36,188
buffer_load_dwordx4 v14, s[32:35], s54 offen offset:2112   lds
MAA 172,32,172
TR 122,17,51232
v_fmac_f32 v198, v6, v22
MAA 124,24,172
TR 124,17,59168
v_fmac_f32 v199, v7, v22
MAA 124,28,188
TR 126,17,59680
v_fmac_f32 v200, v4, v24
MAA 120,28,184
v_fmac_f32 v201, v5, v24
v_fmac_f32 v202, v6, v24
MAA 120,24,168
v_fmac_f32 v203, v7, v24
v_fmac_f32 v204, v4, v26
MAA 104,16,168
buffer_load_dwordx4 v15, s[32:35], s54 offen offset:3168   lds
MAA 104,20,184
s_mov_b32 m0, s67
v_fmac_f32 v205, v5, v26
v_fmac_f32 v206, v6, v26
MAA 108,20,188
v_fmac_f32 v207, v7, v26
s_waitcnt lgkmcnt(8)
v_fmac_f32 v208, v28, v20
MAA 108,16,172
ds_read_b128 v[4:7], v8 offset:576
v_fmac_f32 v209, v29, v20
MAA 60,8,172
v_fmac_f32 v210, v30, v20
v_fmac_f32 v211, v31, v20
MAA 60,12,188
v_fmac_f32 v212, v28, v22
v_fmac_f32 v213, v29, v22
MAA 56,12,184
buffer_load_dwordx4 v18, s[28:31], s58 offen lds
MAA 56,8,168
v_fmac_f32 v214, v30, v22
v_fmac_f32 v215, v31, v22
MAA 40,0,168
v_fmac_f32 v216, v28, v24
v_fmac_f32 v217, v29, v24
MAA 40,4,184
v_fmac_f32 v218, v30, v24
v_fmac_f32 v219, v31, v24
MAA 44,4,188
v_fmac_f32 v220, v28, v26
v_fmac_f32 v221, v29, v26
MAA 44,0,172
v_fmac_f32 v222, v30, v26
v_fmac_f32 v223, v31, v26
s_waitcnt lgkmcnt(0)
v_fmac_f32 v248, v4, v20
v_fmac_f32 v249, v5, v20
v_fmac_f32 v250, v6, v20
v_fmac_f32 v251, v7, v20
v_fmac_f32 v252, v4, v22
v_fmac_f32 v253, v5, v22
v_fmac_f32 v254, v6, v22
v_fmac_f32 v255, v7, v22
s_waitcnt vmcnt(19) lgkmcnt(0)
s_barrier
MAA 64,64,160
ds_read_b128 v[28:31], v9 offset:192
s_add_u32 m0, s55, 135168
MAA 64,68,176
ds_read_b128 v[4:7], v9 offset:256
MAA 68,68,180
buffer_load_dwordx4 v12, s[80:83], s54 offen   lds
MAA 68,64,164
ds_read_b64_tr_b16 a[0:1], v16
MAA 84,72,164
TR 2,16,512
MAA 84,76,180
TR 4,16,8448
MAA 80,76,176
TR 6,16,8960
MAA 80,72,160
TR 8,16,32
MAA 128,80,160
buffer_load_dwordx4 v13, s[80:83], s54 offen offset:1056   lds
MAA 128,84,176
TR 10,16,544
s_waitcnt lgkmcnt(7)
v_fmac_f32 v112, v28, v20
MAA 132,84,180
TR 12,16,8480
v_fmac_f32 v113, v29, v20
MAA 132,80,164
TR 14,16,8992
v_fmac_f32 v114, v30, v20
MAA 148,88,164
TR 16,16,64
v_fmac_f32 v115, v31, v20
MAA 148,92,180
TR 18,16,576
v_fmac_f32 v116, v28, v22
MAA 144,92,176
buffer_load_dwordx4 v14, s[80:83], s54 offen offset:2112   lds
MAA 144,88,160
TR 20,16,8512
v_fmac_f32 v117, v29, v22
MAA 192,96,160
TR 22,16,9024
v_fmac_f32 v118, v30, v22
MAA 192,100,176
TR 24,16,96
v_fmac_f32 v119, v31, v22
MAA 196,100,180
TR 26,16,608
v_fmac_f32 v120, v28, v24
MAA 196,96,164
TR 28,16,8544
v_fmac_f32 v121, v29, v24
MAA 212,104,164
buffer_load_dwordx4 v15, s[80:83], s54 offen offset:3168   lds
MAA 212,108,180
TR 30,16,9056
s_add_u32 s54, s54, 458752
MAA 208,108,176
TR 32,16,128
s_mov_b32 m0, s67
MAA 208,104,160
TR 34,16,640
v_fmac_f32 v122, v30, v24
MAA 240,112,160
TR 36,16,8576
v_fmac_f32 v123, v31, v24
MAA 240,116,176
TR 38,16,9088
v_fmac_f32 v124, v28, v26
MAA 244,116,180
buffer_load_dwordx4 v19, s[28:31], s58 offen offset:1056 lds
MAA 244,112,164
TR 40,16,160
s_add_u32 s67, s67, 8448
MAA 252,120,164
TR 42,16,672
s_add_u32 s46, s46, 1
MAA 252,124,180
TR 44,16,8608
s_xor_b32 s58, s46, s87
MAA 248,124,176
TR 46,16,9120
s_mul_i32 s58, s58, 458752
MAA 248,120,160
ds_read_b64_tr_b16 a[48:49], v17
v_fmac_f32 v125, v29, v26
MAA 220,104,172
buffer_load_dwordx4 a[160:163], v10, s[16:19], s52 offen sc1
MAA 220,108,188
TR 50,17,512
v_fmac_f32 v126, v30, v26
MAA 216,108,184
TR 52,17,8448
v_fmac_f32 v127, v31, v26
MAA 216,104,168
ds_read_b128 v[28:31], v9 offset:320
s_waitcnt lgkmcnt(15)
v_fmac_f32 v160, v4, v20
MAA 200,96,168
TR 54,17,8960
v_fmac_f32 v161, v5, v20
MAA 200,100,184
TR 56,17,32
v_fmac_f32 v162, v6, v20
MAA 204,100,188
buffer_load_dwordx4 a[164:167], v10, s[16:19], s52 offen offset:1024 sc1
MAA 204,96,172
TR 58,17,544
s_add_u32 s52, s52, 131072
MAA 156,88,172
TR 60,17,8480
v_fmac_f32 v163, v7, v20
MAA 156,92,188
TR 62,17,8992
v_fmac_f32 v164, v4, v22
MAA 152,92,184
v_fmac_f32 v165, v5, v22
v_fmac_f32 v166, v6, v22
MAA 152,88,168
v_fmac_f32 v167, v7, v22
v_fmac_f32 v168, v4, v24
MAA 136,80,168
.Lpad24:
s_cbranch_execz .Lnopoll59r
buffer_load_dwordx4 a[176:179], v10, s[16:19], s52 offen sc1
MAA 136,84,184
v_fmac_f32 v169, v5, v24
v_fmac_f32 v170, v6, v24
MAA 140,84,188
v_fmac_f32 v171, v7, v24
v_fmac_f32 v172, v4, v26
MAA 140,80,172
v_fmac_f32 v173, v5, v26
v_fmac_f32 v174, v6, v26
MAA 92,72,172
v_fmac_f32 v175, v7, v26
s_waitcnt lgkmcnt(5)
v_fmac_f32 v176, v28, v20
MAA 92,76,188
ds_read_b128 v[4:7], v8 offset:64
v_fmac_f32 v177, v29, v20
MAA 88,76,184
buffer_load_dwordx4 a[180:183], v10, s[16:19], s52 offen offset:1024 sc1
MAA 88,72,168
s_add_u32 s52, s52, 131072
v_fmac_f32 v178, v30, v20
v_fmac_f32 v179, v31, v20
MAA 72,64,168
v_fmac_f32 v180, v28, v22
v_fmac_f32 v181, v29, v22
MAA 72,68,184
v_fmac_f32 v182, v30, v22
v_fmac_f32 v183, v31, v22
MAA 76,68,188
v_fmac_f32 v184, v28, v24
v_fmac_f32 v185, v29, v24
MAA 76,64,172
v_fmac_f32 v186, v30, v24
v_fmac_f32 v187, v31, v24
v_fmac_f32 v188, v28, v26
v_fmac_f32 v189, v29, v26
v_fmac_f32 v190, v30, v26
v_fmac_f32 v191, v31, v26
v_accvgpr_read_b32 v28, a192
s_waitcnt lgkmcnt(0)
v_fmac_f32 v232, v4, v20
v_fmac_f32 v233, v5, v20
v_fmac_f32 v234, v6, v20
v_fmac_f32 v235, v7, v20
v_fmac_f32 v236, v4, v22
v_fmac_f32 v237, v5, v22
v_fmac_f32 v238, v6, v22
v_fmac_f32 v239, v7, v22
v_accvgpr_read_b32 v29, a193
v_accvgpr_read_b32 v30, a194
v_accvgpr_read_b32 v31, a195
s_mov_b32 s15, -4
.p2align 6
.Lk64:
s_waitcnt vmcnt(18) lgkmcnt(0)
s_barrier
MAA 32,0,128
TR 64,16,16896
MAA 32,4,144
buffer_load_dwordx4 a[168:171], v11, s[16:19], s53 offen sc1
MAA 36,4,148
TR 66,16,17408
MAA 36,0,132
TR 68,16,25344
MAA 52,8,132
TR 70,16,25856
MAA 52,12,148
MAA 48,12,144
TR 72,16,16928
MAA 48,8,128
buffer_load_dwordx4 a[172:175], v11, s[16:19], s53 offen offset:1024 sc1
MAA 96,16,128
TR 74,16,17440
s_add_u32 s53, s53, 131072
MAA 96,20,144
TR 76,16,25376
MAA 100,20,148
MAA 100,16,132
TR 78,16,25888
MAA 116,24,132
TR 80,16,16960
MAA 116,28,148
buffer_load_dwordx4 a[184:187], v11, s[16:19], s53 offen sc1
MAA 112,28,144
TR 82,16,17472
MAA 112,24,128
MAA 160,32,128
TR 84,16,25408
MAA 160,36,144
TR 86,16,25920
MAA 164,36,148
TR 88,16,16992
MAA 164,32,132
buffer_load_dwordx4 a[188:191], v11, s[16:19], s53 offen offset:1024 sc1
MAA 180,40,132
s_add_u32 s53, s53, 131072
MAA 180,44,148
TR 90,16,17504
MAA 176,44,144
TR 92,16,25440
MAA 176,40,128
TR 94,16,25952
MAA 224,48,128
s_add_u32 m0, s55, 84480
MAA 224,52,144
buffer_load_dwordx4 v12, s[32:35], s54 offen   lds
MAA 228,52,148
TR 96,16,17024
MAA 228,48,132
TR 98,16,17536
MAA 236,56,132
TR 100,16,25472
MAA 236,60,148
TR 102,16,25984
MAA 232,60,144
MAA 232,56,128
TR 104,16,17056
s_waitcnt vmcnt(19)
MAA 188,40,140
buffer_load_dwordx4 v13, s[32:35], s54 offen offset:1056   lds
MAA 188,44,156
TR 106,16,17568
MAA 184,44,152
TR 108,16,25504
MAA 184,40,136
MAA 168,32,136
TR 110,16,26016
MAA 168,36,152
buffer_load_dwordx4 v14, s[32:35], s54 offen offset:2112   lds
MAA 172,36,156
TR 112,17,16896
MAA 172,32,140
TR 114,17,17408
MAA 124,24,140
MAA 124,28,156
TR 116,17,25344
MAA 120,28,152
TR 118,17,25856
MAA 120,24,136
buffer_load_dwordx4 v15, s[32:35], s54 offen offset:3168   lds
MAA 104,16,136
TR 120,17,16928
MAA 104,20,152
MAA 108,20,156
TR 122,17,17440
MAA 108,16,140
TR 124,17,25376
MAA 60,8,140
TR 126,17,25888
s_mov_b32 m0, s67
MAA 60,12,156
buffer_load_dwordx4 v18, s[28:31], s58 offen lds
MAA 56,12,152
MAA 56,8,136
MAA 40,0,136
MAA 40,4,152
MAA 44,4,156
MAA 44,0,140
s_waitcnt vmcnt(19) lgkmcnt(0)
s_barrier
MAA 64,64,128
TR 0,16,33792
s_add_u32 m0, s55, 101376
MAA 64,68,144
buffer_load_dwordx4 v12, s[80:83], s54 offen   lds
MAA 68,68,148
TR 2,16,34304
MAA 68,64,132
TR 4,16,42240
MAA 84,72,132
TR 6,16,42752
MAA 84,76,148
MAA 80,76,144
TR 8,16,33824
MAA 80,72,128
buffer_load_dwordx4 v13, s[80:83], s54 offen offset:1056   lds
MAA 128,80,128
TR 10,16,34336
MAA 128,84,144
TR 12,16,42272
MAA 132,84,148
TR 14,16,42784
MAA 132,80,132
MAA 148,88,132
TR 16,16,33856
MAA 148,92,148
buffer_load_dwordx4 v14, s[80:83], s54 offen offset:2112   lds
MAA 144,92,144
TR 18,16,34368
MAA 144,88,128
TR 20,16,42304
MAA 192,96,128
MAA 192,100,144
TR 22,16,42816
MAA 196,100,148
TR 24,16,33888
MAA 196,96,132
buffer_load_dwordx4 v15, s[80:83], s54 offen offset:3168   lds
MAA 212,104,132
TR 26,16,34400
s_add_u32 s54, s54, 458752
MAA 212,108,148
TR 28,16,42336
MAA 208,108,144
MAA 208,104,128
TR 30,16,42848
MAA 240,112,128
TR 32,16,33920
s_mov_b32 m0, s67
MAA 240,116,144
buffer_load_dwordx4 v19, s[28:31], s58 offen offset:1056 lds
MAA 244,116,148
s_add_u32 s67, s67, 8448
s_add_u32 s58, s58, 0x40000
MAA 244,112,132
TR 34,16,34432
MAA 252,120,132
MAA 252,124,148
TR 36,16,42368
MAA 248,124,144
TR 38,16,42880
MAA 248,120,128
buffer_load_dwordx4 a[128:131], v10, s[16:19], s52 offen sc1
MAA 220,104,140
TR 40,16,33952
MAA 220,108,156
TR 42,16,34464
MAA 216,108,152
MAA 216,104,136
TR 44,16,42400
MAA 200,96,136
TR 46,16,42912
MAA 200,100,152
buffer_load_dwordx4 a[132:135], v10, s[16:19], s52 offen offset:1024 sc1
MAA 204,100,156
TR 48,17,33792
s_add_u32 s52, s52, 131072
MAA 204,96,140
MAA 156,88,140
TR 50,17,34304
MAA 156,92,156
TR 52,17,42240
MAA 152,92,152
TR 54,17,42752
MAA 152,88,136
buffer_load_dwordx4 a[144:147], v10, s[16:19], s52 offen sc1
MAA 136,80,136
TR 56,17,33824
MAA 136,84,152
MAA 140,84,156
TR 58,17,34336
MAA 140,80,140
TR 60,17,42272
MAA 92,72,140
TR 62,17,42784
MAA 92,76,156
buffer_load_dwordx4 a[148:151], v10, s[16:19], s52 offen offset:1024 sc1
MAA 88,76,152
s_add_u32 s52, s52, 131072
MAA 88,72,136
MAA 72,64,136
MAA 72,68,152
MAA 76,68,156
MAA 76,64,140
s_waitcnt vmcnt(18) lgkmcnt(0)
s_barrier
MAA 32,0,160
TR 64,16,50688
MAA 32,4,176
buffer_load_dwordx4 a[136:139], v11, s[16:19], s53 offen sc1
MAA 36,4,180
TR 66,16,51200
MAA 36,0,164
TR 68,16,59136
MAA 52,8,164
TR 70,16,59648
MAA 52,12,180
MAA 48,12,176
TR 72,16,50720
MAA 48,8,160
buffer_load_dwordx4 a[140:143], v11, s[16:19], s53 offen offset:1024 sc1
MAA 96,16,160
TR 74,16,51232
s_add_u32 s53, s53, 131072
MAA 96,20,176
TR 76,16,59168
MAA 100,20,180
MAA 100,16,164
TR 78,16,59680
MAA 116,24,164
TR 80,16,50752
MAA 116,28,180
buffer_load_dwordx4 a[152:155], v11, s[16:19], s53 offen sc1
MAA 112,28,176
TR 82,16,51264
MAA 112,24,160
MAA 160,32,160
TR 84,16,59200
MAA 160,36,176
TR 86,16,59712
MAA 164,36,180
TR 88,16,50784
MAA 164,32,164
buffer_load_dwordx4 a[156:159], v11, s[16:19], s53 offen offset:1024 sc1
MAA 180,40,164
s_add_u32 s53, s53, 131072
MAA 180,44,180
TR 90,16,51296
MAA 176,44,176
TR 92,16,59232
MAA 176,40,160
TR 94,16,59744
MAA 224,48,160
s_add_u32 m0, s55, 118272
MAA 224,52,176
buffer_load_dwordx4 v12, s[32:35], s54 offen   lds
MAA 228,52,180
TR 96,16,50816
MAA 228,48,164
TR 98,16,51328
MAA 236,56,164
TR 100,16,59264
MAA 236,60,180
TR 102,16,59776
MAA 232,60,176
MAA 232,56,160
TR 104,16,50848
s_waitcnt vmcnt(19)
MAA 188,40,172
buffer_load_dwordx4 v13, s[32:35], s54 offen offset:1056   lds
MAA 188,44,188
TR 106,16,51360
MAA 184,44,184
TR 108,16,59296
MAA 184,40,168
MAA 168,32,168
TR 110,16,59808
MAA 168,36,184
buffer_load_dwordx4 v14, s[32:35], s54 offen offset:2112   lds
MAA 172,36,188
TR 112,17,50688
MAA 172,32,172
TR 114,17,51200
MAA 124,24,172
MAA 124,28,188
TR 116,17,59136
MAA 120,28,184
TR 118,17,59648
MAA 120,24,168
buffer_load_dwordx4 v15, s[32:35], s54 offen offset:3168   lds
MAA 104,16,168
TR 120,17,50720
MAA 104,20,184
MAA 108,20,188
TR 122,17,51232
MAA 108,16,172
TR 124,17,59168
MAA 60,8,172
TR 126,17,59680
s_mov_b32 m0, s67
MAA 60,12,188
buffer_load_dwordx4 v18, s[28:31], s58 offen lds
MAA 56,12,184
MAA 56,8,168
MAA 40,0,168
MAA 40,4,184
MAA 44,4,188
MAA 44,0,172
s_waitcnt vmcnt(19) lgkmcnt(0)
s_barrier
MAA 64,64,160
ds_read_b64_tr_b16 a[0:1], v16
s_add_u32 m0, s55, 135168
MAA 64,68,176
buffer_load_dwordx4 v12, s[80:83], s54 offen   lds
MAA 68,68,180
TR 2,16,512
MAA 68,64,164
TR 4,16,8448
MAA 84,72,164
TR 6,16,8960
MAA 84,76,180
MAA 80,76,176
TR 8,16,32
MAA 80,72,160
buffer_load_dwordx4 v13, s[80:83], s54 offen offset:1056   lds
MAA 128,80,160
TR 10,16,544
MAA 128,84,176
TR 12,16,8480
MAA 132,84,180
TR 14,16,8992
MAA 132,80,164
MAA 148,88,164
TR 16,16,64
MAA 148,92,180
buffer_load_dwordx4 v14, s[80:83], s54 offen offset:2112   lds
MAA 144,92,176
TR 18,16,576
MAA 144,88,160
TR 20,16,8512
MAA 192,96,160
MAA 192,100,176
TR 22,16,9024
MAA 196,100,180
TR 24,16,96
MAA 196,96,164
buffer_load_dwordx4 v15, s[80:83], s54 offen offset:3168   lds
MAA 212,104,164
TR 26,16,608
s_add_u32 s54, s54, 458752
MAA 212,108,180
TR 28,16,8544
MAA 208,108,176
MAA 208,104,160
TR 30,16,9056
MAA 240,112,160
TR 32,16,128
s_mov_b32 m0, s67
MAA 240,116,176
buffer_load_dwordx4 v19, s[28:31], s58 offen offset:1056 lds
MAA 244,116,180
s_add_u32 s67, s67, 8448
s_add_u32 s46, s46, 1
s_xor_b32 s58, s46, s87
s_mul_i32 s58, s58, 458752
MAA 244,112,164
TR 34,16,640
MAA 252,120,164
MAA 252,124,180
TR 36,16,8576
MAA 248,124,176
TR 38,16,9088
MAA 248,120,160
buffer_load_dwordx4 a[160:163], v10, s[16:19], s52 offen sc1
MAA 220,104,172
TR 40,16,160
MAA 220,108,188
TR 42,16,672
MAA 216,108,184
MAA 216,104,168
TR 44,16,8608
MAA 200,96,168
TR 46,16,9120
MAA 200,100,184
buffer_load_dwordx4 a[164:167], v10, s[16:19], s52 offen offset:1024 sc1
MAA 204,100,188
ds_read_b64_tr_b16 a[48:49], v17
s_add_u32 s52, s52, 131072
MAA 204,96,172
MAA 156,88,172
TR 50,17,512
MAA 156,92,188
TR 52,17,8448
MAA 152,92,184
TR 54,17,8960
MAA 152,88,168
buffer_load_dwordx4 a[176:179], v10, s[16:19], s52 offen sc1
MAA 136,80,168
TR 56,17,32
MAA 136,84,184
MAA 140,84,188
TR 58,17,544
MAA 140,80,172
TR 60,17,8480
MAA 92,72,172
TR 62,17,8992
MAA 92,76,188
buffer_load_dwordx4 a[180:183], v10, s[16:19], s52 offen offset:1024 sc1
MAA 88,76,184
s_add_u32 s52, s52, 131072
MAA 88,72,168
MAA 72,64,168
MAA 72,68,184
MAA 76,68,188
s_add_u32 s15, s15, 1
MAA 76,64,172
s_cbranch_scc0 .Lk64
s_waitcnt vmcnt(10) lgkmcnt(0)
s_barrier
MAA 32,0,128
buffer_load_dwordx4 a[168:171], v11, s[16:19], s53 offen sc1
MAA 32,4,144
TR 64,16,16896
s_add_u32 s58, s99, 2293760
MAA 48,12,144
TR 66,16,17408
s_lshl_b32 s74, s3, 11
MAA 48,8,128
TR 68,16,25344
s_add_u32 s74, s74, s84
MAA 36,0,132
buffer_load_dwordx4 a[172:175], v11, s[16:19], s53 offen offset:1024 sc1
MAA 36,4,148
TR 70,16,25856
s_add_u32 s53, s53, 131072
MAA 52,12,148
TR 72,16,16928
v_lshl_add_u32 v4, v1, 4, s74
MAA 52,8,132
TR 74,16,17440
v_lshrrev_b32 v2, 3, v1
MAA 40,0,136
buffer_load_dwordx4 a[184:187], v11, s[16:19], s53 offen sc1
MAA 40,4,152
TR 76,16,25376
v_cmp_eq_u32 vcc, 3, v2
MAA 56,12,152
TR 78,16,25888
v_add_u32 v2, 67108480, v4
MAA 56,8,136
TR 80,16,33792
v_cndmask_b32 v4, v4, v2, vcc
MAA 44,0,140
buffer_load_dwordx4 a[188:191], v11, s[16:19], s53 offen offset:1024 sc1
MAA 44,4,156
TR 82,16,34304
s_add_u32 s53, s53, 131072
MAA 60,12,156
TR 84,16,42240
s_and_b32 s74, s7, 1
MAA 60,8,140
TR 86,16,42752
s_add_u32 s54, s98, 65536
MAA 96,16,128
TR 88,16,33824
v_bfe_u32 v7, v1, 2, 3
MAA 96,20,144
TR 90,16,34336
v_mul_u32_u24 v7, 1056, v7
MAA 112,28,144
TR 92,16,42272
s_waitcnt vmcnt(9)
s_barrier
MAA 112,24,128
TR 94,16,42784
v_bfe_u32 v2, v1, 5, 1
MAA 100,16,132
TR 96,16,50688
v_lshl_add_u32 v7, v2, 8, v7
.Lpad25:
s_cbranch_execz .Lnopoll59r
MAA 100,20,148
TR 98,16,51200
v_and_b32 v2, 3, v1
MAA 116,28,148
TR 100,16,59136
v_lshl_add_u32 v7, v2, 3, v7
MAA 116,24,132
TR 102,16,59648
s_lshl_b32 s74, s74, 7
MAA 104,16,136
TR 104,16,50720
s_xor_b32 s75, s74, 128
MAA 104,20,152
TR 106,16,51232
v_add_u32 v6, s75, v7
MAA 120,28,152
TR 108,16,59168
v_add_u32 v7, s74, v7
MAA 120,24,136
TR 110,16,59680
s_mul_i32 s55, s3, 2112
MAA 108,16,140
TR 112,16,16960
s_mov_b32 s57, 67584
MAA 108,20,156
TR 114,16,17472
MAA 124,28,156
TR 116,16,25408
MAA 124,24,140
TR 118,16,25920
MAA 160,32,128
TR 120,16,16992
MAA 160,36,144
TR 122,16,17504
MAA 176,44,144
TR 124,16,25440
MAA 176,40,128
TR 126,16,25952
MAA 164,32,132
TR 192,16,33856
MAA 164,36,148
TR 194,16,34368
MAA 180,44,148
TR 196,16,42304
MAA 180,40,132
TR 198,16,42816
MAA 168,32,136
TR 200,16,33888
MAA 168,36,152
TR 202,16,34400
MAA 184,44,152
TR 204,16,42336
MAA 184,40,136
TR 206,16,42848
MAA 172,32,140
TR 208,16,50752
MAA 172,36,156
TR 210,16,51264
MAA 188,44,156
TR 212,16,59200
MAA 188,40,140
TR 214,16,59712
MAA 224,48,128
TR 216,16,50784
MAA 224,52,144
TR 218,16,51296
MAA 232,60,144
TR 220,16,59232
MAA 232,56,128
TR 222,16,59744
MAA 228,48,132
TR 0,16,17024
MAA 228,52,148
TR 2,16,17536
MAA 236,60,148
TR 4,16,25472
MAA 236,56,132
TR 6,16,25984
s_waitcnt lgkmcnt(15)
MAA 64,64,128
TR 8,16,17056
MAA 64,68,144
TR 10,16,17568
s_waitcnt vmcnt(7)
MAA 64,96,160
TR 12,16,25504
s_waitcnt vmcnt(5)
MAA 64,100,176
TR 14,16,26016
MAA 80,108,176
TR 16,16,33920
MAA 80,104,160
TR 18,16,34432
MAA 80,76,144
TR 20,16,42368
MAA 80,72,128
TR 22,16,42880
MAA 32,80,160
TR 24,16,33952
MAA 32,84,176
TR 26,16,34464
MAA 48,92,176
TR 28,16,42400
MAA 48,88,160
TR 30,16,42912
s_nop 2
v_pk_mul_f32 v[64:65], v[64:65], v[32:33]
v_pk_mul_f32 v[32:33], v[32:33], v[28:29] op_sel_hi:[1,0]
v_pk_mul_f32 v[66:67], v[66:67], v[34:35]
v_pk_mul_f32 v[34:35], v[34:35], v[28:29] op_sel_hi:[1,0]
v_pk_mul_f32 v[80:81], v[80:81], v[48:49]
v_pk_mul_f32 v[48:49], v[48:49], v[28:29] op_sel_hi:[1,0]
v_pk_mul_f32 v[82:83], v[82:83], v[50:51]
v_pk_mul_f32 v[50:51], v[50:51], v[28:29] op_sel_hi:[1,0]
v_exp_f32 v32, v32
s_nop 0
MAA 68,64,132
TR 32,16,50816
v_exp_f32 v33, v33
MAA 68,68,148
TR 34,16,51328
v_exp_f32 v34, v34
MAA 68,96,164
TR 36,16,59264
v_exp_f32 v35, v35
s_waitcnt vmcnt(4)
MAA 68,100,180
TR 38,16,59776
v_exp_f32 v48, v48
MAA 84,108,180
TR 40,16,50848
v_exp_f32 v49, v49
MAA 84,104,164
TR 42,16,51360
v_exp_f32 v50, v50
MAA 84,76,148
TR 44,16,59296
v_exp_f32 v51, v51
MAA 84,72,132
TR 46,16,59808
MAA 36,80,164
TR 48,17,16896
MAA 36,84,180
TR 50,17,17408
MAA 52,92,180
TR 52,17,25344
MAA 52,88,164
TR 54,17,25856
s_nop 2
v_pk_mul_f32 v[68:69], v[68:69], v[36:37]
v_pk_mul_f32 v[36:37], v[36:37], v[28:29] op_sel:[0,1] op_sel_hi:[1,1]
v_pk_mul_f32 v[70:71], v[70:71], v[38:39]
v_pk_mul_f32 v[38:39], v[38:39], v[28:29] op_sel:[0,1] op_sel_hi:[1,1]
v_pk_mul_f32 v[84:85], v[84:85], v[52:53]
v_pk_mul_f32 v[52:53], v[52:53], v[28:29] op_sel:[0,1] op_sel_hi:[1,1]
v_pk_mul_f32 v[86:87], v[86:87], v[54:55]
v_pk_mul_f32 v[54:55], v[54:55], v[28:29] op_sel:[0,1] op_sel_hi:[1,1]
v_pk_fma_f32 v[32:33], v[32:33], v[20:21], v[20:21] op_sel:[0,1,1] op_sel_hi:[1,1,1]
v_pk_fma_f32 v[34:35], v[34:35], v[20:21], v[20:21] op_sel:[0,1,1] op_sel_hi:[1,1,1]
v_pk_fma_f32 v[48:49], v[48:49], v[20:21], v[20:21] op_sel:[0,1,1] op_sel_hi:[1,1,1]
v_pk_fma_f32 v[50:51], v[50:51], v[20:21], v[20:21] op_sel:[0,1,1] op_sel_hi:[1,1,1]
v_rcp_f32 v32, v32
s_nop 0
MAA 72,64,136
TR 56,17,16928
v_rcp_f32 v33, v33
MAA 72,68,152
TR 58,17,17440
v_rcp_f32 v34, v34
s_waitcnt vmcnt(3)
MAA 72,96,168
TR 60,17,25376
v_rcp_f32 v35, v35
s_waitcnt vmcnt(1)
MAA 72,100,184
TR 62,17,25888
v_rcp_f32 v48, v48
MAA 88,108,184
v_rcp_f32 v49, v49
MAA 88,104,168
v_rcp_f32 v50, v50
MAA 88,76,152
v_rcp_f32 v51, v51
MAA 88,72,136
v_exp_f32 v36, v36
MAA 40,80,168
v_exp_f32 v37, v37
MAA 40,84,184
v_exp_f32 v38, v38
MAA 56,92,184
v_exp_f32 v39, v39
MAA 56,88,168
v_exp_f32 v52, v52
v_exp_f32 v53, v53
v_exp_f32 v54, v54
v_exp_f32 v55, v55
v_pk_mul_f32 v[64:65], v[64:65], v[32:33]
v_pk_mul_f32 v[66:67], v[66:67], v[34:35]
v_pk_mul_f32 v[80:81], v[80:81], v[48:49]
v_pk_mul_f32 v[82:83], v[82:83], v[50:51]
v_pk_mul_f32 v[72:73], v[72:73], v[40:41]
v_pk_mul_f32 v[40:41], v[40:41], v[30:31] op_sel_hi:[1,0]
v_pk_mul_f32 v[74:75], v[74:75], v[42:43]
v_pk_mul_f32 v[42:43], v[42:43], v[30:31] op_sel_hi:[1,0]
v_pk_mul_f32 v[88:89], v[88:89], v[56:57]
v_pk_mul_f32 v[56:57], v[56:57], v[30:31] op_sel_hi:[1,0]
v_pk_mul_f32 v[90:91], v[90:91], v[58:59]
v_pk_mul_f32 v[58:59], v[58:59], v[30:31] op_sel_hi:[1,0]
v_pk_fma_f32 v[36:37], v[36:37], v[22:23], v[22:23] op_sel:[0,1,1] op_sel_hi:[1,1,1]
v_pk_fma_f32 v[38:39], v[38:39], v[22:23], v[22:23] op_sel:[0,1,1] op_sel_hi:[1,1,1]
v_pk_fma_f32 v[52:53], v[52:53], v[22:23], v[22:23] op_sel:[0,1,1] op_sel_hi:[1,1,1]
v_pk_fma_f32 v[54:55], v[54:55], v[22:23], v[22:23] op_sel:[0,1,1] op_sel_hi:[1,1,1]
v_cvt_pk_bf16_f32 v32, v64, v65
v_cvt_pk_bf16_f32 v33, v66, v67
v_cvt_pk_bf16_f32 v34, v80, v81
v_cvt_pk_bf16_f32 v35, v82, v83
MAA 76,64,140
buffer_store_dwordx4 v[32:35], v10, s[16:19], s62 offen sc1
MAA 76,68,156
TR 64,17,33792
v_rcp_f32 v36, v36
MAA 76,96,172
TR 66,17,34304
v_rcp_f32 v37, v37
s_waitcnt vmcnt(1)
MAA 76,100,188
TR 68,17,42240
v_rcp_f32 v38, v38
MAA 92,108,188
TR 70,17,42752
v_rcp_f32 v39, v39
MAA 92,104,172
v_rcp_f32 v52, v52
MAA 92,76,156
TR 76,17,42272
v_rcp_f32 v53, v53
MAA 92,72,140
TR 72,17,33824
v_rcp_f32 v54, v54
MAA 44,80,172
TR 74,17,34336
v_rcp_f32 v55, v55
MAA 44,84,188
TR 78,17,42784
v_exp_f32 v40, v40
MAA 60,92,188
TR 80,17,50688
v_exp_f32 v41, v41
MAA 60,88,172
TR 82,17,51200
v_exp_f32 v42, v42
v_exp_f32 v43, v43
v_exp_f32 v56, v56
v_exp_f32 v57, v57
v_exp_f32 v58, v58
v_exp_f32 v59, v59
v_pk_mul_f32 v[68:69], v[68:69], v[36:37]
v_pk_mul_f32 v[70:71], v[70:71], v[38:39]
v_pk_mul_f32 v[84:85], v[84:85], v[52:53]
v_pk_mul_f32 v[86:87], v[86:87], v[54:55]
v_pk_mul_f32 v[76:77], v[76:77], v[44:45]
v_pk_mul_f32 v[44:45], v[44:45], v[30:31] op_sel:[0,1] op_sel_hi:[1,1]
v_pk_mul_f32 v[78:79], v[78:79], v[46:47]
v_pk_mul_f32 v[46:47], v[46:47], v[30:31] op_sel:[0,1] op_sel_hi:[1,1]
v_pk_mul_f32 v[92:93], v[92:93], v[60:61]
v_pk_mul_f32 v[60:61], v[60:61], v[30:31] op_sel:[0,1] op_sel_hi:[1,1]
v_pk_mul_f32 v[94:95], v[94:95], v[62:63]
v_pk_mul_f32 v[62:63], v[62:63], v[30:31] op_sel:[0,1] op_sel_hi:[1,1]
v_pk_fma_f32 v[40:41], v[40:41], v[24:25], v[24:25] op_sel:[0,1,1] op_sel_hi:[1,1,1]
v_pk_fma_f32 v[42:43], v[42:43], v[24:25], v[24:25] op_sel:[0,1,1] op_sel_hi:[1,1,1]
v_pk_fma_f32 v[56:57], v[56:57], v[24:25], v[24:25] op_sel:[0,1,1] op_sel_hi:[1,1,1]
v_pk_fma_f32 v[58:59], v[58:59], v[24:25], v[24:25] op_sel:[0,1,1] op_sel_hi:[1,1,1]
v_cvt_pk_bf16_f32 v36, v68, v69
v_cvt_pk_bf16_f32 v37, v70, v71
v_cvt_pk_bf16_f32 v38, v84, v85
v_cvt_pk_bf16_f32 v39, v86, v87
MAA 128,112,128
buffer_store_dwordx4 v[36:39], v10, s[16:19], s62 offen offset:1024 sc1
MAA 128,116,144
TR 84,17,59136
v_rcp_f32 v40, v40
s_waitcnt lgkmcnt(15)
MAA 128,208,160
TR 86,17,59648
v_rcp_f32 v41, v41
MAA 128,212,176
TR 88,17,50720
v_rcp_f32 v42, v42
MAA 144,220,176
TR 90,17,51232
v_rcp_f32 v43, v43
MAA 144,216,160
TR 92,17,59168
v_rcp_f32 v56, v56
MAA 144,124,144
TR 94,17,59680
v_rcp_f32 v57, v57
MAA 144,120,128
v_rcp_f32 v58, v58
MAA 96,192,160
v_rcp_f32 v59, v59
MAA 96,196,176
v_exp_f32 v44, v44
MAA 112,204,176
v_exp_f32 v45, v45
MAA 112,200,160
v_lshrrev_b32 v69, 2, v0
v_min_u32 v69, 1, v69
v_lshlrev_b32 v69, 28, v69
v_lshl_add_u32 v68, v0, 7, v69
v_xor_b32 v69, 64, v0
v_min_u32 v69, 1, v69
v_lshlrev_b32 v70, 4, v69
v_sub_u32 v70, 16, v70
v_lshlrev_b32 v69, 28, v69
v_mov_b32 v71, 1
s_waitcnt lgkmcnt(0)
s_barrier
v_mov_b32 v84, 0
v_mov_b32 v85, 0
v_mov_b32 v86, 0
v_exp_f32 v46, v46
v_exp_f32 v47, v47
v_exp_f32 v60, v60
v_exp_f32 v61, v61
v_exp_f32 v62, v62
v_exp_f32 v63, v63
v_pk_mul_f32 v[72:73], v[72:73], v[40:41]
v_pk_mul_f32 v[74:75], v[74:75], v[42:43]
v_pk_mul_f32 v[88:89], v[88:89], v[56:57]
v_pk_mul_f32 v[90:91], v[90:91], v[58:59]
v_pk_mul_f32 v[128:129], v[128:129], v[96:97]
v_pk_mul_f32 v[96:97], v[96:97], v[28:29] op_sel_hi:[1,0]
v_pk_mul_f32 v[130:131], v[130:131], v[98:99]
v_pk_mul_f32 v[98:99], v[98:99], v[28:29] op_sel_hi:[1,0]
v_pk_mul_f32 v[144:145], v[144:145], v[112:113]
v_pk_mul_f32 v[112:113], v[112:113], v[28:29] op_sel_hi:[1,0]
v_pk_mul_f32 v[146:147], v[146:147], v[114:115]
v_pk_mul_f32 v[114:115], v[114:115], v[28:29] op_sel_hi:[1,0]
v_pk_fma_f32 v[44:45], v[44:45], v[26:27], v[26:27] op_sel:[0,1,1] op_sel_hi:[1,1,1]
v_pk_fma_f32 v[46:47], v[46:47], v[26:27], v[26:27] op_sel:[0,1,1] op_sel_hi:[1,1,1]
v_pk_fma_f32 v[60:61], v[60:61], v[26:27], v[26:27] op_sel:[0,1,1] op_sel_hi:[1,1,1]
v_pk_fma_f32 v[62:63], v[62:63], v[26:27], v[26:27] op_sel:[0,1,1] op_sel_hi:[1,1,1]
v_cvt_pk_bf16_f32 v40, v72, v73
v_cvt_pk_bf16_f32 v41, v74, v75
v_cvt_pk_bf16_f32 v42, v88, v89
v_cvt_pk_bf16_f32 v43, v90, v91
MAA 132,112,132
buffer_store_dwordx4 v[40:43], v11, s[16:19], s62 offen sc1
MAA 132,116,148
s_add_u32 m0, s59, 84480
v_rcp_f32 v44, v44
MAA 132,208,164
v_rcp_f32 v45, v45
MAA 132,212,180
v_rcp_f32 v46, v46
MAA 148,220,180
buffer_load_dwordx4 v18, s[28:31], s58 offen lds
MAA 148,216,164
v_rcp_f32 v47, v47
MAA 148,124,148
v_rcp_f32 v60, v60
MAA 148,120,132
v_rcp_f32 v61, v61
MAA 100,192,164
buffer_load_dwordx4 v19, s[28:31], s58 offen offset:1056 lds
MAA 100,196,180
s_add_u32 m0, s59, 92928
s_add_u32 s58, s99, 2555904
v_rcp_f32 v62, v62
MAA 116,204,180
v_rcp_f32 v63, v63
MAA 116,200,164
v_exp_f32 v96, v96
v_exp_f32 v97, v97
v_exp_f32 v98, v98
v_exp_f32 v99, v99
v_exp_f32 v112, v112
v_exp_f32 v113, v113
v_exp_f32 v114, v114
v_exp_f32 v115, v115
v_pk_mul_f32 v[76:77], v[76:77], v[44:45]
v_pk_mul_f32 v[78:79], v[78:79], v[46:47]
v_pk_mul_f32 v[92:93], v[92:93], v[60:61]
v_pk_mul_f32 v[94:95], v[94:95], v[62:63]
v_pk_mul_f32 v[132:133], v[132:133], v[100:101]
v_pk_mul_f32 v[100:101], v[100:101], v[28:29] op_sel:[0,1] op_sel_hi:[1,1]
v_pk_mul_f32 v[134:135], v[134:135], v[102:103]
v_pk_mul_f32 v[102:103], v[102:103], v[28:29] op_sel:[0,1] op_sel_hi:[1,1]
v_pk_mul_f32 v[148:149], v[148:149], v[116:117]
v_pk_mul_f32 v[116:117], v[116:117], v[28:29] op_sel:[0,1] op_sel_hi:[1,1]
v_pk_mul_f32 v[150:151], v[150:151], v[118:119]
v_pk_mul_f32 v[118:119], v[118:119], v[28:29] op_sel:[0,1] op_sel_hi:[1,1]
v_pk_fma_f32 v[96:97], v[96:97], v[20:21], v[20:21] op_sel:[0,1,1] op_sel_hi:[1,1,1]
v_pk_fma_f32 v[98:99], v[98:99], v[20:21], v[20:21] op_sel:[0,1,1] op_sel_hi:[1,1,1]
v_pk_fma_f32 v[112:113], v[112:113], v[20:21], v[20:21] op_sel:[0,1,1] op_sel_hi:[1,1,1]
v_pk_fma_f32 v[114:115], v[114:115], v[20:21], v[20:21] op_sel:[0,1,1] op_sel_hi:[1,1,1]
v_cvt_pk_bf16_f32 v44, v76, v77
v_cvt_pk_bf16_f32 v45, v78, v79
v_cvt_pk_bf16_f32 v46, v92, v93
v_cvt_pk_bf16_f32 v47, v94, v95
MAA 136,112,136
buffer_store_dwordx4 v[44:47], v11, s[16:19], s62 offen offset:1024 sc1
MAA 136,116,152
v_rcp_f32 v96, v96
MAA 136,208,168
v_rcp_f32 v97, v97
MAA 136,212,184
v_rcp_f32 v98, v98
MAA 152,220,184
buffer_load_dwordx4 v18, s[28:31], s58 offen lds
MAA 152,216,168
v_rcp_f32 v99, v99
MAA 152,124,152
v_rcp_f32 v112, v112
MAA 152,120,136
v_rcp_f32 v113, v113
MAA 104,192,168
buffer_load_dwordx4 v19, s[28:31], s58 offen offset:1056 lds
MAA 104,196,184
s_add_u32 m0, s59, 101376
s_add_u32 s58, s100, 2752512
v_rcp_f32 v114, v114
MAA 120,204,184
v_rcp_f32 v115, v115
MAA 120,200,168
v_exp_f32 v100, v100
v_exp_f32 v101, v101
v_exp_f32 v102, v102
v_exp_f32 v103, v103
v_exp_f32 v116, v116
v_exp_f32 v117, v117
v_exp_f32 v118, v118
v_exp_f32 v119, v119
v_pk_mul_f32 v[128:129], v[128:129], v[96:97]
v_pk_mul_f32 v[130:131], v[130:131], v[98:99]
v_pk_mul_f32 v[144:145], v[144:145], v[112:113]
v_pk_mul_f32 v[146:147], v[146:147], v[114:115]
v_pk_mul_f32 v[136:137], v[136:137], v[104:105]
v_pk_mul_f32 v[104:105], v[104:105], v[30:31] op_sel_hi:[1,0]
v_pk_mul_f32 v[138:139], v[138:139], v[106:107]
v_pk_mul_f32 v[106:107], v[106:107], v[30:31] op_sel_hi:[1,0]
v_pk_mul_f32 v[152:153], v[152:153], v[120:121]
v_pk_mul_f32 v[120:121], v[120:121], v[30:31] op_sel_hi:[1,0]
v_pk_mul_f32 v[154:155], v[154:155], v[122:123]
v_pk_mul_f32 v[122:123], v[122:123], v[30:31] op_sel_hi:[1,0]
v_pk_fma_f32 v[100:101], v[100:101], v[22:23], v[22:23] op_sel:[0,1,1] op_sel_hi:[1,1,1]
v_pk_fma_f32 v[102:103], v[102:103], v[22:23], v[22:23] op_sel:[0,1,1] op_sel_hi:[1,1,1]
v_pk_fma_f32 v[116:117], v[116:117], v[22:23], v[22:23] op_sel:[0,1,1] op_sel_hi:[1,1,1]
v_pk_fma_f32 v[118:119], v[118:119], v[22:23], v[22:23] op_sel:[0,1,1] op_sel_hi:[1,1,1]
v_cvt_pk_bf16_f32 v96, v128, v129
v_cvt_pk_bf16_f32 v97, v130, v131
v_cvt_pk_bf16_f32 v98, v144, v145
v_cvt_pk_bf16_f32 v99, v146, v147
MAA 140,112,140
buffer_store_dwordx4 v[96:99], v10, s[16:19], s63 offen sc1
MAA 140,116,156
v_rcp_f32 v100, v100
MAA 140,208,172
v_rcp_f32 v101, v101
MAA 140,212,188
v_rcp_f32 v102, v102
MAA 156,220,188
buffer_load_dwordx4 v18, s[28:31], s58 offen lds
MAA 156,216,172
v_rcp_f32 v103, v103
MAA 156,124,156
v_rcp_f32 v116, v116
MAA 156,120,140
v_rcp_f32 v117, v117
MAA 108,192,172
buffer_load_dwordx4 v19, s[28:31], s58 offen offset:1056 lds
MAA 108,196,188
s_add_u32 m0, s59, 109824
s_add_u32 s58, s100, 3014656
v_rcp_f32 v118, v118
MAA 124,204,188
v_rcp_f32 v119, v119
MAA 124,200,172
v_exp_f32 v104, v104
v_exp_f32 v105, v105
v_exp_f32 v106, v106
v_exp_f32 v107, v107
v_exp_f32 v120, v120
v_exp_f32 v121, v121
v_exp_f32 v122, v122
v_exp_f32 v123, v123
v_pk_mul_f32 v[132:133], v[132:133], v[100:101]
v_pk_mul_f32 v[134:135], v[134:135], v[102:103]
v_pk_mul_f32 v[148:149], v[148:149], v[116:117]
v_pk_mul_f32 v[150:151], v[150:151], v[118:119]
v_pk_mul_f32 v[140:141], v[140:141], v[108:109]
v_pk_mul_f32 v[108:109], v[108:109], v[30:31] op_sel:[0,1] op_sel_hi:[1,1]
v_pk_mul_f32 v[142:143], v[142:143], v[110:111]
v_pk_mul_f32 v[110:111], v[110:111], v[30:31] op_sel:[0,1] op_sel_hi:[1,1]
v_pk_mul_f32 v[156:157], v[156:157], v[124:125]
v_pk_mul_f32 v[124:125], v[124:125], v[30:31] op_sel:[0,1] op_sel_hi:[1,1]
v_pk_mul_f32 v[158:159], v[158:159], v[126:127]
v_pk_mul_f32 v[126:127], v[126:127], v[30:31] op_sel:[0,1] op_sel_hi:[1,1]
v_pk_fma_f32 v[104:105], v[104:105], v[24:25], v[24:25] op_sel:[0,1,1] op_sel_hi:[1,1,1]
v_pk_fma_f32 v[106:107], v[106:107], v[24:25], v[24:25] op_sel:[0,1,1] op_sel_hi:[1,1,1]
v_pk_fma_f32 v[120:121], v[120:121], v[24:25], v[24:25] op_sel:[0,1,1] op_sel_hi:[1,1,1]
v_pk_fma_f32 v[122:123], v[122:123], v[24:25], v[24:25] op_sel:[0,1,1] op_sel_hi:[1,1,1]
v_cvt_pk_bf16_f32 v100, v132, v133
v_cvt_pk_bf16_f32 v101, v134, v135
v_cvt_pk_bf16_f32 v102, v148, v149
v_cvt_pk_bf16_f32 v103, v150, v151
MAA 192,0,128
buffer_store_dwordx4 v[100:103], v10, s[16:19], s63 offen offset:1024 sc1
MAA 192,4,144
v_rcp_f32 v104, v104
MAA 192,32,160
s_waitcnt vmcnt(6)
s_barrier
v_rcp_f32 v105, v105
MAA 192,36,176
v_rcp_f32 v106, v106
MAA 208,44,176
buffer_atomic_add v71, v68, s[16:19], s72 offen offset:512
MAA 208,40,160
v_rcp_f32 v107, v107
MAA 208,12,144
v_rcp_f32 v120, v120
MAA 208,8,128
v_rcp_f32 v121, v121
MAA 160,16,160
buffer_load_dwordx4 v18, s[28:31], s58 offen lds
MAA 160,20,176
v_rcp_f32 v122, v122
MAA 176,28,176
v_rcp_f32 v123, v123
MAA 176,24,160
v_exp_f32 v108, v108
v_exp_f32 v109, v109
v_exp_f32 v110, v110
v_exp_f32 v111, v111
v_exp_f32 v124, v124
v_exp_f32 v125, v125
v_exp_f32 v126, v126
v_exp_f32 v127, v127
v_pk_mul_f32 v[136:137], v[136:137], v[104:105]
v_pk_mul_f32 v[138:139], v[138:139], v[106:107]
v_pk_mul_f32 v[152:153], v[152:153], v[120:121]
v_pk_mul_f32 v[154:155], v[154:155], v[122:123]
v_pk_mul_f32 v[192:193], v[192:193], v[160:161]
v_pk_mul_f32 v[160:161], v[160:161], v[28:29] op_sel_hi:[1,0]
v_pk_mul_f32 v[194:195], v[194:195], v[162:163]
v_pk_mul_f32 v[162:163], v[162:163], v[28:29] op_sel_hi:[1,0]
v_pk_mul_f32 v[208:209], v[208:209], v[176:177]
v_pk_mul_f32 v[176:177], v[176:177], v[28:29] op_sel_hi:[1,0]
v_pk_mul_f32 v[210:211], v[210:211], v[178:179]
v_pk_mul_f32 v[178:179], v[178:179], v[28:29] op_sel_hi:[1,0]
v_pk_fma_f32 v[108:109], v[108:109], v[26:27], v[26:27] op_sel:[0,1,1] op_sel_hi:[1,1,1]
v_pk_fma_f32 v[110:111], v[110:111], v[26:27], v[26:27] op_sel:[0,1,1] op_sel_hi:[1,1,1]
v_pk_fma_f32 v[124:125], v[124:125], v[26:27], v[26:27] op_sel:[0,1,1] op_sel_hi:[1,1,1]
v_pk_fma_f32 v[126:127], v[126:127], v[26:27], v[26:27] op_sel:[0,1,1] op_sel_hi:[1,1,1]
v_cvt_pk_bf16_f32 v104, v136, v137
v_cvt_pk_bf16_f32 v105, v138, v139
v_cvt_pk_bf16_f32 v106, v152, v153
v_cvt_pk_bf16_f32 v107, v154, v155
MAA 196,0,132
buffer_store_dwordx4 v[104:107], v11, s[16:19], s63 offen sc1
MAA 196,4,148
v_rcp_f32 v108, v108
MAA 196,32,164
v_rcp_f32 v109, v109
MAA 196,36,180
v_rcp_f32 v110, v110
MAA 212,44,180
buffer_load_dwordx4 v19, s[28:31], s58 offen offset:1056 lds
MAA 212,40,164
s_add_u32 m0, s59, 118272
s_add_u32 s58, s101, 3211264
v_rcp_f32 v111, v111
MAA 212,12,148
v_rcp_f32 v124, v124
MAA 212,8,132
v_rcp_f32 v125, v125
MAA 164,16,164
buffer_load_dwordx4 v18, s[28:31], s58 offen lds
MAA 164,20,180
v_rcp_f32 v126, v126
MAA 180,28,180
v_rcp_f32 v127, v127
MAA 180,24,164
v_exp_f32 v160, v160
v_exp_f32 v161, v161
v_exp_f32 v162, v162
v_exp_f32 v163, v163
v_exp_f32 v176, v176
v_exp_f32 v177, v177
v_exp_f32 v178, v178
v_exp_f32 v179, v179
v_pk_mul_f32 v[140:141], v[140:141], v[108:109]
v_pk_mul_f32 v[142:143], v[142:143], v[110:111]
v_pk_mul_f32 v[156:157], v[156:157], v[124:125]
.Lpad26:
s_cbranch_execz .Lpad29
v_pk_mul_f32 v[158:159], v[158:159], v[126:127]
v_pk_mul_f32 v[196:197], v[196:197], v[164:165]
v_pk_mul_f32 v[164:165], v[164:165], v[28:29] op_sel:[0,1] op_sel_hi:[1,1]
v_pk_mul_f32 v[198:199], v[198:199], v[166:167]
v_pk_mul_f32 v[166:167], v[166:167], v[28:29] op_sel:[0,1] op_sel_hi:[1,1]
v_pk_mul_f32 v[212:213], v[212:213], v[180:181]
v_pk_mul_f32 v[180:181], v[180:181], v[28:29] op_sel:[0,1] op_sel_hi:[1,1]
v_pk_mul_f32 v[214:215], v[214:215], v[182:183]
v_pk_mul_f32 v[182:183], v[182:183], v[28:29] op_sel:[0,1] op_sel_hi:[1,1]
v_pk_fma_f32 v[160:161], v[160:161], v[20:21], v[20:21] op_sel:[0,1,1] op_sel_hi:[1,1,1]
v_pk_fma_f32 v[162:163], v[162:163], v[20:21], v[20:21] op_sel:[0,1,1] op_sel_hi:[1,1,1]
v_pk_fma_f32 v[176:177], v[176:177], v[20:21], v[20:21] op_sel:[0,1,1] op_sel_hi:[1,1,1]
v_pk_fma_f32 v[178:179], v[178:179], v[20:21], v[20:21] op_sel:[0,1,1] op_sel_hi:[1,1,1]
v_cvt_pk_bf16_f32 v108, v140, v141
v_cvt_pk_bf16_f32 v109, v142, v143
v_cvt_pk_bf16_f32 v110, v156, v157
v_cvt_pk_bf16_f32 v111, v158, v159
MAA 200,0,136
buffer_store_dwordx4 v[108:111], v11, s[16:19], s63 offen offset:1024 sc1
MAA 200,4,152
v_rcp_f32 v160, v160
MAA 200,32,168
v_rcp_f32 v161, v161
MAA 200,36,184
v_rcp_f32 v162, v162
MAA 216,44,184
buffer_load_dwordx4 v19, s[28:31], s58 offen offset:1056 lds
MAA 216,40,168
s_add_u32 m0, s59, 126720
s_add_u32 s58, s101, 3473408
v_rcp_f32 v163, v163
MAA 216,12,152
v_rcp_f32 v176, v176
MAA 216,8,136
v_rcp_f32 v177, v177
MAA 168,16,168
buffer_load_dwordx4 v18, s[28:31], s58 offen lds
MAA 168,20,184
v_rcp_f32 v178, v178
MAA 184,28,184
v_rcp_f32 v179, v179
MAA 184,24,168
v_exp_f32 v164, v164
v_exp_f32 v165, v165
v_exp_f32 v166, v166
v_exp_f32 v167, v167
v_exp_f32 v180, v180
v_exp_f32 v181, v181
v_exp_f32 v182, v182
v_exp_f32 v183, v183
v_pk_mul_f32 v[192:193], v[192:193], v[160:161]
v_pk_mul_f32 v[194:195], v[194:195], v[162:163]
v_pk_mul_f32 v[208:209], v[208:209], v[176:177]
v_pk_mul_f32 v[210:211], v[210:211], v[178:179]
v_pk_mul_f32 v[200:201], v[200:201], v[168:169]
v_pk_mul_f32 v[168:169], v[168:169], v[30:31] op_sel_hi:[1,0]
v_pk_mul_f32 v[202:203], v[202:203], v[170:171]
v_pk_mul_f32 v[170:171], v[170:171], v[30:31] op_sel_hi:[1,0]
v_pk_mul_f32 v[216:217], v[216:217], v[184:185]
v_pk_mul_f32 v[184:185], v[184:185], v[30:31] op_sel_hi:[1,0]
v_pk_mul_f32 v[218:219], v[218:219], v[186:187]
v_pk_mul_f32 v[186:187], v[186:187], v[30:31] op_sel_hi:[1,0]
v_pk_fma_f32 v[164:165], v[164:165], v[22:23], v[22:23] op_sel:[0,1,1] op_sel_hi:[1,1,1]
v_pk_fma_f32 v[166:167], v[166:167], v[22:23], v[22:23] op_sel:[0,1,1] op_sel_hi:[1,1,1]
v_pk_fma_f32 v[180:181], v[180:181], v[22:23], v[22:23] op_sel:[0,1,1] op_sel_hi:[1,1,1]
v_pk_fma_f32 v[182:183], v[182:183], v[22:23], v[22:23] op_sel:[0,1,1] op_sel_hi:[1,1,1]
v_cvt_pk_bf16_f32 v160, v192, v193
v_cvt_pk_bf16_f32 v161, v194, v195
v_cvt_pk_bf16_f32 v162, v208, v209
v_cvt_pk_bf16_f32 v163, v210, v211
MAA 204,0,140
buffer_store_dwordx4 v[160:163], v10, s[16:19], s64 offen sc1
MAA 204,4,156
v_rcp_f32 v164, v164
MAA 204,32,172
v_rcp_f32 v165, v165
MAA 204,36,188
v_rcp_f32 v166, v166
MAA 220,44,188
buffer_atomic_add v84, v69, s[16:19], s73 offen offset:512 sc0
MAA 220,40,172
v_rcp_f32 v167, v167
MAA 220,12,156
v_rcp_f32 v180, v180
MAA 220,8,140
v_rcp_f32 v181, v181
MAA 172,16,172
buffer_load_dwordx4 v19, s[28:31], s58 offen offset:1056 lds
MAA 172,20,188
v_rcp_f32 v182, v182
MAA 188,28,188
v_rcp_f32 v183, v183
MAA 188,24,172
v_exp_f32 v168, v168
v_exp_f32 v169, v169
v_exp_f32 v170, v170
v_exp_f32 v171, v171
v_exp_f32 v184, v184
v_exp_f32 v185, v185
v_exp_f32 v186, v186
v_exp_f32 v187, v187
v_pk_mul_f32 v[196:197], v[196:197], v[164:165]
v_pk_mul_f32 v[198:199], v[198:199], v[166:167]
v_pk_mul_f32 v[212:213], v[212:213], v[180:181]
v_pk_mul_f32 v[214:215], v[214:215], v[182:183]
v_pk_mul_f32 v[204:205], v[204:205], v[172:173]
v_pk_mul_f32 v[172:173], v[172:173], v[30:31] op_sel:[0,1] op_sel_hi:[1,1]
v_pk_mul_f32 v[206:207], v[206:207], v[174:175]
v_pk_mul_f32 v[174:175], v[174:175], v[30:31] op_sel:[0,1] op_sel_hi:[1,1]
v_pk_mul_f32 v[220:221], v[220:221], v[188:189]
v_pk_mul_f32 v[188:189], v[188:189], v[30:31] op_sel:[0,1] op_sel_hi:[1,1]
v_pk_mul_f32 v[222:223], v[222:223], v[190:191]
v_pk_mul_f32 v[190:191], v[190:191], v[30:31] op_sel:[0,1] op_sel_hi:[1,1]
v_pk_fma_f32 v[168:169], v[168:169], v[24:25], v[24:25] op_sel:[0,1,1] op_sel_hi:[1,1,1]
v_pk_fma_f32 v[170:171], v[170:171], v[24:25], v[24:25] op_sel:[0,1,1] op_sel_hi:[1,1,1]
v_pk_fma_f32 v[184:185], v[184:185], v[24:25], v[24:25] op_sel:[0,1,1] op_sel_hi:[1,1,1]
v_pk_fma_f32 v[186:187], v[186:187], v[24:25], v[24:25] op_sel:[0,1,1] op_sel_hi:[1,1,1]
v_cvt_pk_bf16_f32 v164, v196, v197
v_cvt_pk_bf16_f32 v165, v198, v199
v_cvt_pk_bf16_f32 v166, v212, v213
v_cvt_pk_bf16_f32 v167, v214, v215
MAA 240,48,128
buffer_store_dwordx4 v[164:167], v10, s[16:19], s64 offen offset:1024 sc1
MAA 240,52,144
v_rcp_f32 v168, v168
MAA 240,80,160
v_rcp_f32 v169, v169
MAA 240,84,176
v_rcp_f32 v170, v170
MAA 248,92,176
buffer_atomic_add v85, v69, s[16:19], s73 offen offset:512 sc0
MAA 248,88,160
v_rcp_f32 v171, v171
MAA 248,60,144
v_rcp_f32 v184, v184
MAA 248,56,128
v_rcp_f32 v185, v185
MAA 224,64,160
v_rcp_f32 v186, v186
MAA 224,68,176
v_rcp_f32 v187, v187
MAA 232,76,176
v_exp_f32 v172, v172
MAA 232,72,160
v_exp_f32 v173, v173
v_exp_f32 v174, v174
v_exp_f32 v175, v175
v_exp_f32 v188, v188
v_exp_f32 v189, v189
v_exp_f32 v190, v190
v_exp_f32 v191, v191
v_pk_mul_f32 v[200:201], v[200:201], v[168:169]
v_pk_mul_f32 v[202:203], v[202:203], v[170:171]
v_pk_mul_f32 v[216:217], v[216:217], v[184:185]
v_pk_mul_f32 v[218:219], v[218:219], v[186:187]
v_pk_mul_f32 v[240:241], v[240:241], v[224:225]
v_pk_mul_f32 v[224:225], v[224:225], v[28:29] op_sel_hi:[1,0]
v_pk_mul_f32 v[242:243], v[242:243], v[226:227]
v_pk_mul_f32 v[226:227], v[226:227], v[28:29] op_sel_hi:[1,0]
v_pk_mul_f32 v[248:249], v[248:249], v[232:233]
v_pk_mul_f32 v[232:233], v[232:233], v[28:29] op_sel_hi:[1,0]
v_pk_mul_f32 v[250:251], v[250:251], v[234:235]
v_pk_mul_f32 v[234:235], v[234:235], v[28:29] op_sel_hi:[1,0]
v_pk_fma_f32 v[172:173], v[172:173], v[26:27], v[26:27] op_sel:[0,1,1] op_sel_hi:[1,1,1]
v_pk_fma_f32 v[174:175], v[174:175], v[26:27], v[26:27] op_sel:[0,1,1] op_sel_hi:[1,1,1]
v_pk_fma_f32 v[188:189], v[188:189], v[26:27], v[26:27] op_sel:[0,1,1] op_sel_hi:[1,1,1]
v_pk_fma_f32 v[190:191], v[190:191], v[26:27], v[26:27] op_sel:[0,1,1] op_sel_hi:[1,1,1]
v_cvt_pk_bf16_f32 v168, v200, v201
v_cvt_pk_bf16_f32 v169, v202, v203
v_cvt_pk_bf16_f32 v170, v216, v217
v_cvt_pk_bf16_f32 v171, v218, v219
buffer_store_dwordx4 v[168:171], v11, s[16:19], s64 offen sc1
buffer_atomic_add v86, v69, s[16:19], s73 offen offset:512 sc0
s_waitcnt vmcnt(5)
v_cmp_gt_u32 vcc, v70, v84
s_nop 0
s_cbranch_vccz .Lok65
s_waitcnt vmcnt(2)
v_cmp_gt_u32 vcc, v70, v85
s_nop 0
s_cbranch_vccz .Lok65
s_waitcnt vmcnt(0)
v_cmp_gt_u32 vcc, v70, v86
s_nop 0
s_cbranch_vccz .Lok65
s_mov_b32 s15, 0
.Lok65l:
v_mov_b32 v84, 0
buffer_atomic_add v84, v69, s[16:19], s73 offen offset:512 sc0
s_add_u32 s15, s15, 1
s_cmp_gt_u32 s15, 100000
s_waitcnt vmcnt(0)
s_cbranch_scc1 .Lok65
v_cmp_gt_u32 vcc, v70, v84
s_nop 0
s_cbranch_vccnz .Lok65l
.Lok65:
s_waitcnt vmcnt(4)
s_barrier
MAA 244,48,132
ds_read_b64_tr_b16 a[0:1], v7
s_add_u32 s52, s76, 0
MAA 244,52,148
buffer_load_dwordx4 v[96:99], v4, s[16:19], s52 offen sc1
MAA 244,80,164
TR 2,7,512
v_rcp_f32 v172, v172
MAA 244,84,180
TR 4,7,32
v_rcp_f32 v173, v173
MAA 252,92,180
TR 6,7,544
v_rcp_f32 v174, v174
MAA 252,88,164
buffer_load_dwordx4 v[100:103], v4, s[16:19], s52 offen offset:1024 sc1
MAA 252,60,148
TR 8,7,64
s_add_u32 s52, s76, 65536
MAA 252,56,132
TR 10,7,576
v_rcp_f32 v175, v175
MAA 228,64,164
TR 12,7,96
v_rcp_f32 v188, v188
MAA 228,68,180
buffer_load_dwordx4 v[104:107], v4, s[16:19], s52 offen sc1
MAA 236,76,180
TR 14,7,608
v_rcp_f32 v189, v189
MAA 236,72,164
TR 16,7,8448
v_rcp_f32 v190, v190
v_rcp_f32 v191, v191
v_exp_f32 v224, v224
v_exp_f32 v225, v225
v_exp_f32 v226, v226
v_exp_f32 v227, v227
v_exp_f32 v232, v232
v_exp_f32 v233, v233
v_exp_f32 v234, v234
v_exp_f32 v235, v235
v_pk_mul_f32 v[204:205], v[204:205], v[172:173]
buffer_load_dwordx4 v[108:111], v4, s[16:19], s52 offen offset:1024 sc1
s_add_u32 s52, s77, 114688
v_pk_mul_f32 v[206:207], v[206:207], v[174:175]
v_pk_mul_f32 v[220:221], v[220:221], v[188:189]
v_pk_mul_f32 v[222:223], v[222:223], v[190:191]
v_pk_mul_f32 v[244:245], v[244:245], v[228:229]
v_pk_mul_f32 v[228:229], v[228:229], v[28:29] op_sel:[0,1] op_sel_hi:[1,1]
v_pk_mul_f32 v[246:247], v[246:247], v[230:231]
v_pk_mul_f32 v[230:231], v[230:231], v[28:29] op_sel:[0,1] op_sel_hi:[1,1]
v_pk_mul_f32 v[252:253], v[252:253], v[236:237]
v_pk_mul_f32 v[236:237], v[236:237], v[28:29] op_sel:[0,1] op_sel_hi:[1,1]
v_pk_mul_f32 v[254:255], v[254:255], v[238:239]
v_pk_mul_f32 v[238:239], v[238:239], v[28:29] op_sel:[0,1] op_sel_hi:[1,1]
v_pk_fma_f32 v[224:225], v[224:225], v[20:21], v[20:21] op_sel:[0,1,1] op_sel_hi:[1,1,1]
buffer_load_dwordx4 v[112:115], v4, s[16:19], s52 offen sc1
v_pk_fma_f32 v[226:227], v[226:227], v[20:21], v[20:21] op_sel:[0,1,1] op_sel_hi:[1,1,1]
v_pk_fma_f32 v[232:233], v[232:233], v[20:21], v[20:21] op_sel:[0,1,1] op_sel_hi:[1,1,1]
v_pk_fma_f32 v[234:235], v[234:235], v[20:21], v[20:21] op_sel:[0,1,1] op_sel_hi:[1,1,1]
v_cvt_pk_bf16_f32 v172, v204, v205
v_cvt_pk_bf16_f32 v173, v206, v207
v_cvt_pk_bf16_f32 v174, v220, v221
v_cvt_pk_bf16_f32 v175, v222, v223
TR 18,7,8960
TR 20,7,8480
TR 22,7,8992
buffer_store_dwordx4 v[172:175], v11, s[16:19], s64 offen offset:1024 sc1
TR 24,7,8512
TR 26,7,9024
TR 28,7,8544
TR 30,7,9056
v_rcp_f32 v224, v224
v_rcp_f32 v225, v225
v_rcp_f32 v226, v226
v_rcp_f32 v227, v227
v_rcp_f32 v232, v232
v_rcp_f32 v233, v233
v_rcp_f32 v234, v234
v_rcp_f32 v235, v235
v_exp_f32 v228, v228
v_exp_f32 v229, v229
v_exp_f32 v230, v230
v_exp_f32 v231, v231
v_exp_f32 v236, v236
v_exp_f32 v237, v237
v_exp_f32 v238, v238
v_exp_f32 v239, v239
v_pk_mul_f32 v[240:241], v[240:241], v[224:225]
buffer_load_dwordx4 v[116:119], v4, s[16:19], s52 offen offset:1024 sc1
s_add_u32 s52, s77, 180224
v_pk_mul_f32 v[242:243], v[242:243], v[226:227]
v_pk_mul_f32 v[248:249], v[248:249], v[232:233]
v_pk_mul_f32 v[250:251], v[250:251], v[234:235]
v_pk_fma_f32 v[228:229], v[228:229], v[22:23], v[22:23] op_sel:[0,1,1] op_sel_hi:[1,1,1]
v_pk_fma_f32 v[230:231], v[230:231], v[22:23], v[22:23] op_sel:[0,1,1] op_sel_hi:[1,1,1]
v_pk_fma_f32 v[236:237], v[236:237], v[22:23], v[22:23] op_sel:[0,1,1] op_sel_hi:[1,1,1]
v_pk_fma_f32 v[238:239], v[238:239], v[22:23], v[22:23] op_sel:[0,1,1] op_sel_hi:[1,1,1]
v_cvt_pk_bf16_f32 v224, v240, v241
v_cvt_pk_bf16_f32 v225, v242, v243
v_cvt_pk_bf16_f32 v226, v248, v249
v_cvt_pk_bf16_f32 v227, v250, v251
v_rcp_f32 v228, v228
v_rcp_f32 v229, v229
v_rcp_f32 v230, v230
v_rcp_f32 v231, v231
v_rcp_f32 v236, v236
v_rcp_f32 v237, v237
v_rcp_f32 v238, v238
v_rcp_f32 v239, v239
v_pk_mul_f32 v[244:245], v[244:245], v[228:229]
buffer_store_dwordx4 v[224:227], v10, s[16:19], s65 offen sc1
v_pk_mul_f32 v[246:247], v[246:247], v[230:231]
v_pk_mul_f32 v[252:253], v[252:253], v[236:237]
v_pk_mul_f32 v[254:255], v[254:255], v[238:239]
v_cvt_pk_bf16_f32 v228, v244, v245
v_cvt_pk_bf16_f32 v229, v246, v247
v_cvt_pk_bf16_f32 v230, v252, v253
v_cvt_pk_bf16_f32 v231, v254, v255
buffer_store_dwordx4 v[228:231], v10, s[16:19], s65 offen offset:1024 sc1
buffer_load_dwordx4 v[120:123], v4, s[16:19], s52 offen sc1
buffer_load_dwordx4 v[124:127], v4, s[16:19], s52 offen offset:1024 sc1
v_mov_b32 v21, v68
v_mov_b32 v22, v69
v_mov_b32 v23, v70
v_mov_b32 v24, v71
v_mov_b32 v25, 0
s_waitcnt vmcnt(7) lgkmcnt(0)
s_barrier
v_mfma_f32_16x16x32_bf16 v[32:35], a[0:3], v[96:99], 0
ds_read_b64_tr_b16 a[32:33], v6
s_add_u32 s52, s78, 229376
MAV 32,16,104
buffer_load_dwordx4 v[128:131], v4, s[16:19], s52 offen sc1
v_mfma_f32_16x16x32_bf16 v[48:51], a[0:3], v[100:103], 0
TR 34,6,512
TR 36,6,32
MAV 48,16,108
TR 38,6,544
v_mfma_f32_16x16x32_bf16 v[52:55], a[4:7], v[100:103], 0
buffer_load_dwordx4 v[132:135], v4, s[16:19], s52 offen offset:1024 sc1
MAV 52,20,108
TR 48,6,8448
TR 50,6,8960
v_mfma_f32_16x16x32_bf16 v[36:39], a[4:7], v[96:99], 0
TR 52,6,8480
MAV 36,20,104
TR 54,6,8992
s_add_u32 s52, s78, 294912
v_mfma_f32_16x16x32_bf16 v[40:43], a[8:11], v[96:99], 0
buffer_load_dwordx4 v[136:139], v4, s[16:19], s52 offen sc1
MAV 40,24,104
TR 40,6,64
v_mfma_f32_16x16x32_bf16 v[56:59], a[8:11], v[100:103], 0
TR 42,6,576
TR 44,6,96
MAV 56,24,108
TR 46,6,608
v_mfma_f32_16x16x32_bf16 v[60:63], a[12:15], v[100:103], 0
buffer_load_dwordx4 v[140:143], v4, s[16:19], s52 offen offset:1024 sc1
MAV 60,28,108
TR 56,6,8512
TR 58,6,9024
v_mfma_f32_16x16x32_bf16 v[44:47], a[12:15], v[96:99], 0
TR 60,6,8544
MAV 44,28,104
TR 62,6,9056
s_waitcnt lgkmcnt(8)
v_mfma_f32_16x16x32_bf16 v[64:67], a[32:35], v[96:99], 0
TR 0,7,16896
s_add_u32 s52, s79, 344064
MAV 64,48,104
buffer_load_dwordx4 v[144:147], v4, s[16:19], s52 offen sc1
v_mfma_f32_16x16x32_bf16 v[80:83], a[32:35], v[100:103], 0
TR 2,7,17408
TR 4,7,16928
MAV 80,48,108
TR 6,7,17440
v_mfma_f32_16x16x32_bf16 v[84:87], a[36:39], v[100:103], 0
buffer_load_dwordx4 v[148:151], v4, s[16:19], s52 offen offset:1024 sc1
MAV 84,52,108
TR 16,7,25344
TR 18,7,25856
v_mfma_f32_16x16x32_bf16 v[68:71], a[36:39], v[96:99], 0
TR 20,7,25376
MAV 68,52,104
TR 22,7,25888
s_add_u32 s52, s79, 409600
s_waitcnt lgkmcnt(8)
v_mfma_f32_16x16x32_bf16 v[72:75], a[40:43], v[96:99], 0
buffer_load_dwordx4 v[152:155], v4, s[16:19], s52 offen sc1
MAV 72,56,104
TR 8,7,16960
v_mfma_f32_16x16x32_bf16 v[88:91], a[40:43], v[100:103], 0
TR 10,7,17472
TR 12,7,16992
MAV 88,56,108
TR 14,7,17504
v_mfma_f32_16x16x32_bf16 v[92:95], a[44:47], v[100:103], 0
buffer_load_dwordx4 v[156:159], v4, s[16:19], s52 offen offset:1024 sc1
MAV 92,60,108
TR 24,7,25408
TR 26,7,25920
v_mfma_f32_16x16x32_bf16 v[76:79], a[44:47], v[96:99], 0
TR 28,7,25440
MAV 76,60,104
TR 30,7,25952
s_waitcnt vmcnt(8) lgkmcnt(8)
s_barrier
MAV 32,0,112
TR 32,6,16896
TR 34,6,17408
MAV 32,16,120
buffer_atomic_add v24, v21, s[16:19], s72 offen
MAV 48,16,124
TR 36,6,16928
TR 38,6,17440
MAV 48,0,116
TR 48,6,25344
s_add_u32 m0, s55, 0
MAV 52,4,116
buffer_load_dwordx4 v18, s[28:31], s54 offen lds
MAV 52,20,124
TR 50,6,25856
MAV 36,20,120
TR 52,6,25376
TR 54,6,25888
MAV 36,4,112
TR 40,6,16960
s_add_u32 s52, s76, 458752
s_waitcnt lgkmcnt(9)
MAV 40,8,112
buffer_load_dwordx4 v[96:99], v4, s[16:19], s52 offen sc1
MAV 40,24,120
TR 42,6,17472
TR 44,6,16992
MAV 56,24,124
buffer_load_dwordx4 v19, s[28:31], s54 offen offset:1056 lds
MAV 56,8,116
s_add_u32 s54, s98, 327680
MAV 60,12,116
TR 46,6,17504
TR 56,6,25408
MAV 60,28,124
buffer_load_dwordx4 v[100:103], v4, s[16:19], s52 offen offset:1024 sc1
MAV 44,28,120
TR 58,6,25920
TR 60,6,25440
MAV 44,12,112
TR 62,6,25952
s_waitcnt lgkmcnt(8)
MAV 64,32,112
TR 0,7,33792
s_add_u32 m0, s55, 8448
MAV 64,48,120
buffer_load_dwordx4 v18, s[28:31], s54 offen lds
MAV 80,48,124
TR 2,7,34304
TR 4,7,33824
MAV 80,32,116
TR 6,7,34336
s_add_u32 s52, s76, 524288
MAV 84,36,116
buffer_load_dwordx4 v[104:107], v4, s[16:19], s52 offen sc1
MAV 84,52,124
TR 16,7,42240
MAV 68,52,120
TR 18,7,42752
TR 20,7,42272
MAV 68,36,112
TR 22,7,42784
s_waitcnt lgkmcnt(8)
MAV 72,40,112
buffer_load_dwordx4 v19, s[28:31], s54 offen offset:1056 lds
MAV 72,56,120
s_add_u32 s54, s99, 524288
MAV 88,56,124
TR 8,7,33856
TR 10,7,34368
MAV 88,40,116
TR 12,7,33888
TR 14,7,34400
MAV 92,44,116
buffer_load_dwordx4 v[108:111], v4, s[16:19], s52 offen offset:1024 sc1
MAV 92,60,124
TR 24,7,42304
MAV 76,60,120
TR 26,7,42816
TR 28,7,42336
MAV 76,44,112
TR 30,7,42848
s_waitcnt vmcnt(13) lgkmcnt(8)
s_barrier
MAV 32,0,128
TR 32,6,33792
s_add_u32 m0, s55, 16896
MAV 32,16,136
buffer_load_dwordx4 v18, s[28:31], s54 offen lds
MAV 48,16,140
TR 34,6,34304
TR 36,6,33824
MAV 48,0,132
TR 38,6,34336
s_add_u32 s52, s77, 573440
MAV 52,4,132
buffer_load_dwordx4 v[112:115], v4, s[16:19], s52 offen sc1
MAV 52,20,140
TR 48,6,42240
MAV 36,20,136
TR 50,6,42752
TR 52,6,42272
MAV 36,4,128
TR 54,6,42784
s_waitcnt lgkmcnt(8)
MAV 40,8,128
buffer_load_dwordx4 v19, s[28:31], s54 offen offset:1056 lds
MAV 40,24,136
s_add_u32 s54, s99, 786432
MAV 56,24,140
TR 40,6,33856
TR 42,6,34368
MAV 56,8,132
TR 44,6,33888
TR 46,6,34400
MAV 60,12,132
buffer_load_dwordx4 v[116:119], v4, s[16:19], s52 offen offset:1024 sc1
MAV 60,28,140
TR 56,6,42304
MAV 44,28,136
TR 58,6,42816
TR 60,6,42336
MAV 44,12,128
TR 62,6,42848
s_waitcnt lgkmcnt(8)
MAV 64,32,128
TR 0,7,50688
s_add_u32 m0, s55, 25344
MAV 64,48,136
buffer_load_dwordx4 v18, s[28:31], s54 offen lds
MAV 80,48,140
TR 2,7,51200
TR 4,7,50720
MAV 80,32,132
TR 6,7,51232
s_add_u32 s52, s77, 638976
MAV 84,36,132
buffer_load_dwordx4 v[120:123], v4, s[16:19], s52 offen sc1
MAV 84,52,140
TR 16,7,59136
TR 18,7,59648
MAV 68,52,136
TR 20,7,59168
TR 22,7,59680
MAV 68,36,128
s_waitcnt lgkmcnt(8)
MAV 72,40,128
buffer_load_dwordx4 v19, s[28:31], s54 offen offset:1056 lds
MAV 72,56,136
TR 8,7,50752
s_add_u32 s54, s100, 983040
MAV 88,56,140
buffer_load_dwordx4 v[124:127], v4, s[16:19], s52 offen offset:1024 sc1
MAV 88,40,132
TR 10,7,51264
TR 12,7,50784
MAV 92,44,132
TR 14,7,51296
TR 24,7,59200
MAV 92,60,140
buffer_atomic_add v25, v22, s[16:19], s73 offen sc0
MAV 76,60,136
TR 26,7,59712
TR 28,7,59232
MAV 76,44,128
TR 30,7,59744
s_waitcnt vmcnt(18) lgkmcnt(8)
s_barrier
MAV 32,0,144
TR 32,6,50688
s_add_u32 m0, s55, 33792
.Lpad27:
s_cbranch_execz .Lpad30
MAV 32,16,152
buffer_load_dwordx4 v18, s[28:31], s54 offen lds
MAV 48,16,156
TR 34,6,51200
TR 36,6,50720
MAV 48,0,148
TR 38,6,51232
s_add_u32 s52, s78, 688128
MAV 52,4,148
buffer_load_dwordx4 v[128:131], v4, s[16:19], s52 offen sc1
MAV 52,20,156
TR 48,6,59136
MAV 36,20,152
TR 50,6,59648
TR 52,6,59168
MAV 36,4,144
TR 54,6,59680
s_waitcnt lgkmcnt(8)
MAV 40,8,144
buffer_load_dwordx4 v19, s[28:31], s54 offen offset:1056 lds
MAV 40,24,152
s_add_u32 s54, s100, 1245184
MAV 56,24,156
TR 40,6,50752
TR 42,6,51264
MAV 56,8,148
TR 44,6,50784
TR 46,6,51296
MAV 60,12,148
buffer_load_dwordx4 v[132:135], v4, s[16:19], s52 offen offset:1024 sc1
MAV 60,28,156
TR 56,6,59200
MAV 44,28,152
TR 58,6,59712
TR 60,6,59232
MAV 44,12,144
TR 62,6,59744
v_add_u32 v7, s57, v7
v_add_u32 v6, s57, v6
s_sub_u32 s57, 0, s57
s_waitcnt lgkmcnt(8)
MAV 64,32,144
ds_read_b64_tr_b16 a[0:1], v7
s_add_u32 m0, s55, 42240
MAV 64,48,152
buffer_load_dwordx4 v18, s[28:31], s54 offen lds
MAV 80,48,156
TR 2,7,512
TR 4,7,32
MAV 80,32,148
TR 6,7,544
s_add_u32 s52, s78, 753664
MAV 84,36,148
buffer_load_dwordx4 v[136:139], v4, s[16:19], s52 offen sc1
MAV 84,52,156
TR 16,7,8448
MAV 68,52,152
TR 18,7,8960
TR 20,7,8480
MAV 68,36,144
TR 22,7,8992
s_waitcnt lgkmcnt(8)
MAV 72,40,144
buffer_load_dwordx4 v19, s[28:31], s54 offen offset:1056 lds
MAV 72,56,152
s_add_u32 s54, s101, 1441792
MAV 88,56,156
TR 8,7,64
TR 10,7,576
MAV 88,40,148
TR 12,7,96
TR 14,7,608
MAV 92,44,148
buffer_load_dwordx4 v[140:143], v4, s[16:19], s52 offen offset:1024 sc1
MAV 92,60,156
TR 24,7,8512
MAV 76,60,152
TR 26,7,9024
TR 28,7,8544
MAV 76,44,144
TR 30,7,9056
s_waitcnt vmcnt(17) lgkmcnt(8)
s_barrier
MAV 32,0,96
ds_read_b64_tr_b16 a[32:33], v6
s_add_u32 m0, s55, 50688
MAV 32,16,104
buffer_load_dwordx4 v18, s[28:31], s54 offen lds
MAV 48,16,108
TR 34,6,512
TR 36,6,32
MAV 48,0,100
TR 38,6,544
s_add_u32 s52, s79, 802816
MAV 52,4,100
buffer_load_dwordx4 v[144:147], v4, s[16:19], s52 offen sc1
MAV 52,20,108
TR 48,6,8448
MAV 36,20,104
TR 50,6,8960
TR 52,6,8480
MAV 36,4,96
TR 54,6,8992
s_waitcnt lgkmcnt(8)
MAV 40,8,96
buffer_load_dwordx4 v19, s[28:31], s54 offen offset:1056 lds
MAV 40,24,104
s_add_u32 s54, s101, 1703936
MAV 56,24,108
TR 40,6,64
TR 42,6,576
MAV 56,8,100
TR 44,6,96
TR 46,6,608
MAV 60,12,100
buffer_load_dwordx4 v[148:151], v4, s[16:19], s52 offen offset:1024 sc1
MAV 60,28,108
TR 56,6,8512
MAV 44,28,104
TR 58,6,9024
TR 60,6,8544
MAV 44,12,96
TR 62,6,9056
s_waitcnt lgkmcnt(8)
MAV 64,32,96
TR 0,7,16896
s_add_u32 m0, s55, 59136
MAV 64,48,104
buffer_load_dwordx4 v18, s[28:31], s54 offen lds
MAV 80,48,108
TR 2,7,17408
TR 4,7,16928
MAV 80,32,100
TR 6,7,17440
s_add_u32 s52, s79, 868352
MAV 84,36,100
buffer_load_dwordx4 v[152:155], v4, s[16:19], s52 offen sc1
MAV 84,52,108
TR 16,7,25344
MAV 68,52,104
TR 18,7,25856
TR 20,7,25376
MAV 68,36,96
TR 22,7,25888
s_waitcnt lgkmcnt(8)
MAV 72,40,96
buffer_load_dwordx4 v19, s[28:31], s54 offen offset:1056 lds
MAV 72,56,104
s_add_u32 s54, s98, 1900544
MAV 88,56,108
TR 8,7,16960
TR 10,7,17472
MAV 88,40,100
TR 12,7,16992
TR 14,7,17504
MAV 92,44,100
buffer_load_dwordx4 v[156:159], v4, s[16:19], s52 offen offset:1024 sc1
MAV 92,60,108
TR 24,7,25408
MAV 76,60,104
TR 26,7,25920
TR 28,7,25440
MAV 76,44,96
TR 30,7,25952
s_waitcnt vmcnt(16)
v_cmp_gt_u32 vcc, v23, v25
s_nop 0
s_cbranch_vccnz .Lsp66
.Lsp66b:
s_waitcnt lgkmcnt(8)
s_barrier
MAV 32,0,112
TR 32,6,16896
s_add_u32 m0, s55, 67584
MAV 32,16,120
buffer_load_dwordx4 v18, s[28:31], s54 offen lds
MAV 48,16,124
TR 34,6,17408
TR 36,6,16928
MAV 48,0,116
TR 38,6,17440
s_add_u32 s52, s76, 16384
MAV 52,4,116
buffer_load_dwordx4 v[96:99], v4, s[16:19], s52 offen sc1
MAV 52,20,124
TR 48,6,25344
MAV 36,20,120
TR 50,6,25856
TR 52,6,25376
MAV 36,4,112
TR 54,6,25888
s_waitcnt lgkmcnt(8)
MAV 40,8,112
buffer_load_dwordx4 v19, s[28:31], s54 offen offset:1056 lds
MAV 40,24,120
s_add_u32 s54, s98, 2162688
MAV 56,24,124
TR 40,6,16960
TR 42,6,17472
MAV 56,8,116
TR 44,6,16992
TR 46,6,17504
MAV 60,12,116
buffer_load_dwordx4 v[100:103], v4, s[16:19], s52 offen offset:1024 sc1
MAV 60,28,124
TR 56,6,25408
MAV 44,28,120
TR 58,6,25920
TR 60,6,25440
MAV 44,12,112
TR 62,6,25952
s_waitcnt lgkmcnt(8)
MAV 64,32,112
TR 0,7,33792
s_add_u32 m0, s55, 76032
MAV 64,48,120
buffer_load_dwordx4 v18, s[28:31], s54 offen lds
MAV 80,48,124
TR 2,7,34304
TR 4,7,33824
MAV 80,32,116
TR 6,7,34336
s_add_u32 s52, s76, 81920
MAV 84,36,116
buffer_load_dwordx4 v[104:107], v4, s[16:19], s52 offen sc1
MAV 84,52,124
TR 16,7,42240
MAV 68,52,120
TR 18,7,42752
TR 20,7,42272
MAV 68,36,112
TR 22,7,42784
s_waitcnt lgkmcnt(8)
MAV 72,40,112
buffer_load_dwordx4 v19, s[28:31], s54 offen offset:1056 lds
MAV 72,56,120
s_add_u32 s54, s99, 2359296
MAV 88,56,124
TR 8,7,33856
TR 10,7,34368
MAV 88,40,116
TR 12,7,33888
TR 14,7,34400
MAV 92,44,116
buffer_load_dwordx4 v[108:111], v4, s[16:19], s52 offen offset:1024 sc1
MAV 92,60,124
TR 24,7,42304
MAV 76,60,120
TR 26,7,42816
TR 28,7,42336
MAV 76,44,112
TR 30,7,42848
s_waitcnt vmcnt(16) lgkmcnt(8)
s_barrier
MAV 32,0,128
TR 32,6,33792
s_add_u32 m0, s55, 84480
MAV 32,16,136
buffer_load_dwordx4 v18, s[28:31], s54 offen lds
MAV 48,16,140
TR 34,6,34304
TR 36,6,33824
MAV 48,0,132
TR 38,6,34336
s_add_u32 s52, s77, 131072
MAV 52,4,132
buffer_load_dwordx4 v[112:115], v4, s[16:19], s52 offen sc1
MAV 52,20,140
TR 48,6,42240
MAV 36,20,136
TR 50,6,42752
TR 52,6,42272
MAV 36,4,128
TR 54,6,42784
s_waitcnt lgkmcnt(8)
MAV 40,8,128
buffer_load_dwordx4 v19, s[28:31], s54 offen offset:1056 lds
MAV 40,24,136
s_add_u32 s54, s99, 2621440
MAV 56,24,140
TR 40,6,33856
TR 42,6,34368
MAV 56,8,132
TR 44,6,33888
TR 46,6,34400
MAV 60,12,132
buffer_load_dwordx4 v[116:119], v4, s[16:19], s52 offen offset:1024 sc1
MAV 60,28,140
TR 56,6,42304
MAV 44,28,136
TR 58,6,42816
TR 60,6,42336
MAV 44,12,128
TR 62,6,42848
s_waitcnt lgkmcnt(8)
MAV 64,32,128
TR 0,7,50688
s_add_u32 m0, s55, 92928
MAV 64,48,136
buffer_load_dwordx4 v18, s[28:31], s54 offen lds
MAV 80,48,140
TR 2,7,51200
TR 4,7,50720
MAV 80,32,132
TR 6,7,51232
s_add_u32 s52, s77, 196608
MAV 84,36,132
buffer_load_dwordx4 v[120:123], v4, s[16:19], s52 offen sc1
MAV 84,52,140
TR 16,7,59136
MAV 68,52,136
TR 18,7,59648
TR 20,7,59168
MAV 68,36,128
TR 22,7,59680
s_waitcnt lgkmcnt(8)
MAV 72,40,128
buffer_load_dwordx4 v19, s[28:31], s54 offen offset:1056 lds
MAV 72,56,136
s_add_u32 s54, s100, 2818048
MAV 88,56,140
TR 8,7,50752
TR 10,7,51264
MAV 88,40,132
TR 12,7,50784
TR 14,7,51296
MAV 92,44,132
buffer_load_dwordx4 v[124:127], v4, s[16:19], s52 offen offset:1024 sc1
MAV 92,60,140
TR 24,7,59200
MAV 76,60,136
TR 26,7,59712
TR 28,7,59232
MAV 76,44,128
TR 30,7,59744
s_waitcnt vmcnt(16) lgkmcnt(8)
s_barrier
MAV 32,0,144
TR 32,6,50688
s_add_u32 m0, s55, 101376
MAV 32,16,152
buffer_load_dwordx4 v18, s[28:31], s54 offen lds
MAV 48,16,156
TR 34,6,51200
TR 36,6,50720
MAV 48,0,148
TR 38,6,51232
s_add_u32 s52, s78, 245760
MAV 52,4,148
buffer_load_dwordx4 v[128:131], v4, s[16:19], s52 offen sc1
MAV 52,20,156
TR 48,6,59136
MAV 36,20,152
TR 50,6,59648
TR 52,6,59168
MAV 36,4,144
TR 54,6,59680
s_waitcnt lgkmcnt(8)
MAV 40,8,144
buffer_load_dwordx4 v19, s[28:31], s54 offen offset:1056 lds
MAV 40,24,152
s_add_u32 s54, s100, 3080192
MAV 56,24,156
TR 40,6,50752
TR 42,6,51264
MAV 56,8,148
TR 44,6,50784
TR 46,6,51296
MAV 60,12,148
buffer_load_dwordx4 v[132:135], v4, s[16:19], s52 offen offset:1024 sc1
MAV 60,28,156
TR 56,6,59200
MAV 44,28,152
TR 58,6,59712
TR 60,6,59232
MAV 44,12,144
TR 62,6,59744
v_add_u32 v7, s57, v7
v_add_u32 v6, s57, v6
s_sub_u32 s57, 0, s57
s_waitcnt lgkmcnt(8)
MAV 64,32,144
ds_read_b64_tr_b16 a[0:1], v7
s_add_u32 m0, s55, 109824
MAV 64,48,152
buffer_load_dwordx4 v18, s[28:31], s54 offen lds
MAV 80,48,156
TR 2,7,512
TR 4,7,32
MAV 80,32,148
TR 6,7,544
s_add_u32 s52, s78, 311296
MAV 84,36,148
buffer_load_dwordx4 v[136:139], v4, s[16:19], s52 offen sc1
MAV 84,52,156
TR 16,7,8448
MAV 68,52,152
TR 18,7,8960
TR 20,7,8480
MAV 68,36,144
TR 22,7,8992
s_waitcnt lgkmcnt(8)
MAV 72,40,144
buffer_load_dwordx4 v19, s[28:31], s54 offen offset:1056 lds
MAV 72,56,152
s_add_u32 s54, s101, 3276800
MAV 88,56,156
TR 8,7,64
TR 10,7,576
MAV 88,40,148
TR 12,7,96
TR 14,7,608
MAV 92,44,148
buffer_load_dwordx4 v[140:143], v4, s[16:19], s52 offen offset:1024 sc1
MAV 92,60,156
TR 24,7,8512
MAV 76,60,152
TR 26,7,9024
TR 28,7,8544
MAV 76,44,144
TR 30,7,9056
s_waitcnt vmcnt(16) lgkmcnt(8)
s_barrier
MAV 32,0,96
ds_read_b64_tr_b16 a[32:33], v6
s_add_u32 m0, s55, 118272
MAV 32,16,104
buffer_load_dwordx4 v18, s[28:31], s54 offen lds
MAV 48,16,108
TR 34,6,512
TR 36,6,32
MAV 48,0,100
TR 38,6,544
s_add_u32 s52, s79, 360448
MAV 52,4,100
buffer_load_dwordx4 v[144:147], v4, s[16:19], s52 offen sc1
MAV 52,20,108
TR 48,6,8448
MAV 36,20,104
TR 50,6,8960
TR 52,6,8480
MAV 36,4,96
TR 54,6,8992
s_waitcnt lgkmcnt(8)
MAV 40,8,96
buffer_load_dwordx4 v19, s[28:31], s54 offen offset:1056 lds
MAV 40,24,104
s_add_u32 s54, s101, 3538944
MAV 56,24,108
TR 40,6,64
TR 42,6,576
MAV 56,8,100
TR 44,6,96
TR 46,6,608
MAV 60,12,100
buffer_load_dwordx4 v[148:151], v4, s[16:19], s52 offen offset:1024 sc1
MAV 60,28,108
TR 56,6,8512
MAV 44,28,104
TR 58,6,9024
TR 60,6,8544
MAV 44,12,96
TR 62,6,9056
s_waitcnt lgkmcnt(8)
MAV 64,32,96
TR 0,7,16896
s_add_u32 m0, s55, 126720
MAV 64,48,104
buffer_load_dwordx4 v18, s[28:31], s54 offen lds
MAV 80,48,108
TR 2,7,17408
TR 4,7,16928
MAV 80,32,100
TR 6,7,17440
s_add_u32 s52, s79, 425984
MAV 84,36,100
buffer_load_dwordx4 v[152:155], v4, s[16:19], s52 offen sc1
MAV 84,52,108
TR 16,7,25344
MAV 68,52,104
TR 18,7,25856
TR 20,7,25376
MAV 68,36,96
TR 22,7,25888
s_waitcnt lgkmcnt(8)
MAV 72,40,96
buffer_load_dwordx4 v19, s[28:31], s54 offen offset:1056 lds
MAV 72,56,104
s_add_u32 s54, s98, 131072
MAV 88,56,108
TR 8,7,16960
TR 10,7,17472
MAV 88,40,100
TR 12,7,16992
TR 14,7,17504
MAV 92,44,100
buffer_load_dwordx4 v[156:159], v4, s[16:19], s52 offen offset:1024 sc1
MAV 92,60,108
TR 24,7,25408
MAV 76,60,104
TR 26,7,25920
TR 28,7,25440
MAV 76,44,96
TR 30,7,25952
s_waitcnt vmcnt(16) lgkmcnt(8)
s_barrier
MAV 32,0,112
TR 32,6,16896
s_add_u32 m0, s55, 0
MAV 32,16,120
buffer_load_dwordx4 v18, s[28:31], s54 offen lds
MAV 48,16,124
TR 34,6,17408
TR 36,6,16928
MAV 48,0,116
TR 38,6,17440
s_add_u32 s52, s76, 475136
MAV 52,4,116
buffer_load_dwordx4 v[96:99], v4, s[16:19], s52 offen sc1
MAV 52,20,124
TR 48,6,25344
MAV 36,20,120
TR 50,6,25856
TR 52,6,25376
MAV 36,4,112
TR 54,6,25888
s_waitcnt lgkmcnt(8)
MAV 40,8,112
buffer_load_dwordx4 v19, s[28:31], s54 offen offset:1056 lds
MAV 40,24,120
s_add_u32 s54, s98, 393216
MAV 56,24,124
TR 40,6,16960
.Lpad28:
s_cbranch_execz .Lpad31
TR 42,6,17472
MAV 56,8,116
TR 44,6,16992
TR 46,6,17504
MAV 60,12,116
buffer_load_dwordx4 v[100:103], v4, s[16:19], s52 offen offset:1024 sc1
MAV 60,28,124
TR 56,6,25408
MAV 44,28,120
TR 58,6,25920
TR 60,6,25440
MAV 44,12,112
TR 62,6,25952
s_waitcnt lgkmcnt(8)
MAV 64,32,112
TR 0,7,33792
s_add_u32 m0, s55, 8448
MAV 64,48,120
buffer_load_dwordx4 v18, s[28:31], s54 offen lds
MAV 80,48,124
TR 2,7,34304
TR 4,7,33824
MAV 80,32,116
TR 6,7,34336
s_add_u32 s52, s76, 540672
MAV 84,36,116
buffer_load_dwordx4 v[104:107], v4, s[16:19], s52 offen sc1
MAV 84,52,124
TR 16,7,42240
MAV 68,52,120
TR 18,7,42752
TR 20,7,42272
MAV 68,36,112
TR 22,7,42784
s_waitcnt lgkmcnt(8)
MAV 72,40,112
buffer_load_dwordx4 v19, s[28:31], s54 offen offset:1056 lds
MAV 72,56,120
s_add_u32 s54, s99, 589824
MAV 88,56,124
TR 8,7,33856
TR 10,7,34368
MAV 88,40,116
TR 12,7,33888
TR 14,7,34400
MAV 92,44,116
buffer_load_dwordx4 v[108:111], v4, s[16:19], s52 offen offset:1024 sc1
MAV 92,60,124
TR 24,7,42304
MAV 76,60,120
TR 26,7,42816
TR 28,7,42336
MAV 76,44,112
TR 30,7,42848
s_waitcnt vmcnt(16) lgkmcnt(8)
s_barrier
MAV 32,0,128
TR 32,6,33792
s_add_u32 m0, s55, 16896
MAV 32,16,136
buffer_load_dwordx4 v18, s[28:31], s54 offen lds
MAV 48,16,140
TR 34,6,34304
TR 36,6,33824
MAV 48,0,132
TR 38,6,34336
s_add_u32 s52, s77, 589824
MAV 52,4,132
buffer_load_dwordx4 v[112:115], v4, s[16:19], s52 offen sc1
MAV 52,20,140
TR 48,6,42240
MAV 36,20,136
TR 50,6,42752
TR 52,6,42272
MAV 36,4,128
TR 54,6,42784
s_waitcnt lgkmcnt(8)
MAV 40,8,128
buffer_load_dwordx4 v19, s[28:31], s54 offen offset:1056 lds
MAV 40,24,136
s_add_u32 s54, s99, 851968
MAV 56,24,140
TR 40,6,33856
TR 42,6,34368
MAV 56,8,132
TR 44,6,33888
TR 46,6,34400
MAV 60,12,132
buffer_load_dwordx4 v[116:119], v4, s[16:19], s52 offen offset:1024 sc1
MAV 60,28,140
TR 56,6,42304
MAV 44,28,136
TR 58,6,42816
TR 60,6,42336
MAV 44,12,128
TR 62,6,42848
s_waitcnt lgkmcnt(8)
MAV 64,32,128
TR 0,7,50688
s_add_u32 m0, s55, 25344
MAV 64,48,136
buffer_load_dwordx4 v18, s[28:31], s54 offen lds
MAV 80,48,140
TR 2,7,51200
TR 4,7,50720
MAV 80,32,132
TR 6,7,51232
s_add_u32 s52, s77, 655360
MAV 84,36,132
buffer_load_dwordx4 v[120:123], v4, s[16:19], s52 offen sc1
MAV 84,52,140
TR 16,7,59136
MAV 68,52,136
TR 18,7,59648
TR 20,7,59168
MAV 68,36,128
TR 22,7,59680
s_waitcnt lgkmcnt(8)
MAV 72,40,128
buffer_load_dwordx4 v19, s[28:31], s54 offen offset:1056 lds
MAV 72,56,136
s_add_u32 s54, s100, 1048576
MAV 88,56,140
TR 8,7,50752
TR 10,7,51264
MAV 88,40,132
TR 12,7,50784
TR 14,7,51296
MAV 92,44,132
buffer_load_dwordx4 v[124:127], v4, s[16:19], s52 offen offset:1024 sc1
MAV 92,60,140
TR 24,7,59200
MAV 76,60,136
TR 26,7,59712
TR 28,7,59232
MAV 76,44,128
TR 30,7,59744
s_waitcnt vmcnt(16) lgkmcnt(8)
s_barrier
MAV 32,0,144
TR 32,6,50688
s_add_u32 m0, s55, 33792
MAV 32,16,152
buffer_load_dwordx4 v18, s[28:31], s54 offen lds
MAV 48,16,156
TR 34,6,51200
TR 36,6,50720
MAV 48,0,148
TR 38,6,51232
s_add_u32 s52, s78, 704512
MAV 52,4,148
buffer_load_dwordx4 v[128:131], v4, s[16:19], s52 offen sc1
MAV 52,20,156
TR 48,6,59136
MAV 36,20,152
TR 50,6,59648
TR 52,6,59168
MAV 36,4,144
TR 54,6,59680
s_waitcnt lgkmcnt(8)
MAV 40,8,144
buffer_load_dwordx4 v19, s[28:31], s54 offen offset:1056 lds
MAV 40,24,152
s_add_u32 s54, s100, 1310720
MAV 56,24,156
TR 40,6,50752
TR 42,6,51264
MAV 56,8,148
TR 44,6,50784
TR 46,6,51296
MAV 60,12,148
buffer_load_dwordx4 v[132:135], v4, s[16:19], s52 offen offset:1024 sc1
MAV 60,28,156
TR 56,6,59200
MAV 44,28,152
TR 58,6,59712
TR 60,6,59232
MAV 44,12,144
TR 62,6,59744
v_add_u32 v7, s57, v7
v_add_u32 v6, s57, v6
s_sub_u32 s57, 0, s57
s_waitcnt lgkmcnt(8)
MAV 64,32,144
ds_read_b64_tr_b16 a[0:1], v7
s_add_u32 m0, s55, 42240
MAV 64,48,152
buffer_load_dwordx4 v18, s[28:31], s54 offen lds
MAV 80,48,156
TR 2,7,512
TR 4,7,32
MAV 80,32,148
TR 6,7,544
s_add_u32 s52, s78, 770048
MAV 84,36,148
buffer_load_dwordx4 v[136:139], v4, s[16:19], s52 offen sc1
MAV 84,52,156
TR 16,7,8448
MAV 68,52,152
TR 18,7,8960
TR 20,7,8480
MAV 68,36,144
TR 22,7,8992
s_waitcnt lgkmcnt(8)
MAV 72,40,144
buffer_load_dwordx4 v19, s[28:31], s54 offen offset:1056 lds
MAV 72,56,152
s_add_u32 s54, s101, 1507328
MAV 88,56,156
TR 8,7,64
TR 10,7,576
MAV 88,40,148
TR 12,7,96
TR 14,7,608
MAV 92,44,148
buffer_load_dwordx4 v[140:143], v4, s[16:19], s52 offen offset:1024 sc1
MAV 92,60,156
TR 24,7,8512
MAV 76,60,152
TR 26,7,9024
TR 28,7,8544
MAV 76,44,144
TR 30,7,9056
s_waitcnt vmcnt(16) lgkmcnt(8)
s_barrier
MAV 32,0,96
ds_read_b64_tr_b16 a[32:33], v6
s_add_u32 m0, s55, 50688
MAV 32,16,104
buffer_load_dwordx4 v18, s[28:31], s54 offen lds
MAV 48,16,108
TR 34,6,512
TR 36,6,32
MAV 48,0,100
TR 38,6,544
s_add_u32 s52, s79, 819200
MAV 52,4,100
buffer_load_dwordx4 v[144:147], v4, s[16:19], s52 offen sc1
MAV 52,20,108
TR 48,6,8448
MAV 36,20,104
TR 50,6,8960
TR 52,6,8480
MAV 36,4,96
TR 54,6,8992
s_waitcnt lgkmcnt(8)
MAV 40,8,96
buffer_load_dwordx4 v19, s[28:31], s54 offen offset:1056 lds
MAV 40,24,104
s_add_u32 s54, s101, 1769472
MAV 56,24,108
TR 40,6,64
TR 42,6,576
MAV 56,8,100
TR 44,6,96
TR 46,6,608
MAV 60,12,100
buffer_load_dwordx4 v[148:151], v4, s[16:19], s52 offen offset:1024 sc1
MAV 60,28,108
TR 56,6,8512
MAV 44,28,104
TR 58,6,9024
TR 60,6,8544
MAV 44,12,96
TR 62,6,9056
s_waitcnt lgkmcnt(8)
MAV 64,32,96
TR 0,7,16896
s_add_u32 m0, s55, 59136
MAV 64,48,104
buffer_load_dwordx4 v18, s[28:31], s54 offen lds
MAV 80,48,108
TR 2,7,17408
TR 4,7,16928
MAV 80,32,100
TR 6,7,17440
s_add_u32 s52, s79, 884736
MAV 84,36,100
buffer_load_dwordx4 v[152:155], v4, s[16:19], s52 offen sc1
MAV 84,52,108
TR 16,7,25344
MAV 68,52,104
TR 18,7,25856
TR 20,7,25376
MAV 68,36,96
TR 22,7,25888
s_waitcnt lgkmcnt(8)
MAV 72,40,96
buffer_load_dwordx4 v19, s[28:31], s54 offen offset:1056 lds
MAV 72,56,104
s_add_u32 s54, s98, 1966080
MAV 88,56,108
TR 8,7,16960
TR 10,7,17472
MAV 88,40,100
TR 12,7,16992
TR 14,7,17504
MAV 92,44,100
buffer_load_dwordx4 v[156:159], v4, s[16:19], s52 offen offset:1024 sc1
MAV 92,60,108
TR 24,7,25408
MAV 76,60,104
TR 26,7,25920
TR 28,7,25440
MAV 76,44,96
TR 30,7,25952
s_waitcnt vmcnt(16) lgkmcnt(8)
s_barrier
MAV 32,0,112
TR 32,6,16896
s_add_u32 m0, s55, 67584
MAV 32,16,120
buffer_load_dwordx4 v18, s[28:31], s54 offen lds
MAV 48,16,124
TR 34,6,17408
TR 36,6,16928
MAV 48,0,116
TR 38,6,17440
s_add_u32 s52, s76, 32768
MAV 52,4,116
buffer_load_dwordx4 v[96:99], v4, s[16:19], s52 offen sc1
MAV 52,20,124
TR 48,6,25344
MAV 36,20,120
TR 50,6,25856
TR 52,6,25376
MAV 36,4,112
TR 54,6,25888
s_waitcnt lgkmcnt(8)
MAV 40,8,112
buffer_load_dwordx4 v19, s[28:31], s54 offen offset:1056 lds
MAV 40,24,120
s_add_u32 s54, s98, 2228224
MAV 56,24,124
TR 40,6,16960
TR 42,6,17472
MAV 56,8,116
TR 44,6,16992
TR 46,6,17504
MAV 60,12,116
buffer_load_dwordx4 v[100:103], v4, s[16:19], s52 offen offset:1024 sc1
MAV 60,28,124
TR 56,6,25408
MAV 44,28,120
TR 58,6,25920
TR 60,6,25440
MAV 44,12,112
TR 62,6,25952
s_waitcnt lgkmcnt(8)
MAV 64,32,112
TR 0,7,33792
s_add_u32 m0, s55, 76032
MAV 64,48,120
buffer_load_dwordx4 v18, s[28:31], s54 offen lds
MAV 80,48,124
TR 2,7,34304
TR 4,7,33824
MAV 80,32,116
TR 6,7,34336
s_add_u32 s52, s76, 98304
MAV 84,36,116
buffer_load_dwordx4 v[104:107], v4, s[16:19], s52 offen sc1
MAV 84,52,124
TR 16,7,42240
MAV 68,52,120
TR 18,7,42752
TR 20,7,42272
MAV 68,36,112
TR 22,7,42784
s_waitcnt lgkmcnt(8)
MAV 72,40,112
buffer_load_dwordx4 v19, s[28:31], s54 offen offset:1056 lds
MAV 72,56,120
s_add_u32 s54, s99, 2424832
MAV 88,56,124
TR 8,7,33856
TR 10,7,34368
MAV 88,40,116
TR 12,7,33888
TR 14,7,34400
MAV 92,44,116
buffer_load_dwordx4 v[108:111], v4, s[16:19], s52 offen offset:1024 sc1
MAV 92,60,124
TR 24,7,42304
MAV 76,60,120
TR 26,7,42816
TR 28,7,42336
MAV 76,44,112
TR 30,7,42848
s_waitcnt vmcnt(16) lgkmcnt(8)
s_barrier
MAV 32,0,128
TR 32,6,33792
s_add_u32 m0, s55, 84480
MAV 32,16,136
buffer_load_dwordx4 v18, s[28:31], s54 offen lds
MAV 48,16,140
TR 34,6,34304
TR 36,6,33824
MAV 48,0,132
TR 38,6,34336
s_add_u32 s52, s77, 147456
MAV 52,4,132
buffer_load_dwordx4 v[112:115], v4, s[16:19], s52 offen sc1
MAV 52,20,140
TR 48,6,42240
MAV 36,20,136
TR 50,6,42752
TR 52,6,42272
MAV 36,4,128
TR 54,6,42784
s_waitcnt lgkmcnt(8)
MAV 40,8,128
buffer_load_dwordx4 v19, s[28:31], s54 offen offset:1056 lds
MAV 40,24,136
s_add_u32 s54, s99, 2686976
MAV 56,24,140
TR 40,6,33856
TR 42,6,34368
MAV 56,8,132
TR 44,6,33888
TR 46,6,34400
MAV 60,12,132
buffer_load_dwordx4 v[116:119], v4, s[16:19], s52 offen offset:1024 sc1
MAV 60,28,140
TR 56,6,42304
MAV 44,28,136
TR 58,6,42816
TR 60,6,42336
MAV 44,12,128
TR 62,6,42848
s_waitcnt lgkmcnt(8)
MAV 64,32,128
TR 0,7,50688
s_add_u32 m0, s55, 92928
MAV 64,48,136
buffer_load_dwordx4 v18, s[28:31], s54 offen lds
MAV 80,48,140
TR 2,7,51200
TR 4,7,50720
MAV 80,32,132
TR 6,7,51232
s_add_u32 s52, s77, 212992
MAV 84,36,132
buffer_load_dwordx4 v[120:123], v4, s[16:19], s52 offen sc1
MAV 84,52,140
TR 16,7,59136
MAV 68,52,136
TR 18,7,59648
TR 20,7,59168
MAV 68,36,128
TR 22,7,59680
s_waitcnt lgkmcnt(8)
MAV 72,40,128
buffer_load_dwordx4 v19, s[28:31], s54 offen offset:1056 lds
MAV 72,56,136
s_add_u32 s54, s100, 2883584
MAV 88,56,140
TR 8,7,50752
TR 10,7,51264
MAV 88,40,132
TR 12,7,50784
TR 14,7,51296
MAV 92,44,132
buffer_load_dwordx4 v[124:127], v4, s[16:19], s52 offen offset:1024 sc1
MAV 92,60,140
TR 24,7,59200
MAV 76,60,136
TR 26,7,59712
TR 28,7,59232
MAV 76,44,128
TR 30,7,59744
s_waitcnt vmcnt(16) lgkmcnt(8)
s_barrier
MAV 32,0,144
TR 32,6,50688
s_add_u32 m0, s55, 101376
MAV 32,16,152
buffer_load_dwordx4 v18, s[28:31], s54 offen lds
MAV 48,16,156
TR 34,6,51200
TR 36,6,50720
MAV 48,0,148
TR 38,6,51232
s_add_u32 s52, s78, 262144
MAV 52,4,148
buffer_load_dwordx4 v[128:131], v4, s[16:19], s52 offen sc1
MAV 52,20,156
TR 48,6,59136
MAV 36,20,152
TR 50,6,59648
TR 52,6,59168
MAV 36,4,144
TR 54,6,59680
s_waitcnt lgkmcnt(8)
MAV 40,8,144
buffer_load_dwordx4 v19, s[28:31], s54 offen offset:1056 lds
MAV 40,24,152
s_add_u32 s54, s100, 3145728
MAV 56,24,156
TR 40,6,50752
TR 42,6,51264
MAV 56,8,148
TR 44,6,50784
TR 46,6,51296
MAV 60,12,148
buffer_load_dwordx4 v[132:135], v4, s[16:19], s52 offen offset:1024 sc1
MAV 60,28,156
TR 56,6,59200
MAV 44,28,152
TR 58,6,59712
TR 60,6,59232
MAV 44,12,144
TR 62,6,59744
v_add_u32 v7, s57, v7
v_add_u32 v6, s57, v6
s_sub_u32 s57, 0, s57
s_waitcnt lgkmcnt(8)
MAV 64,32,144
ds_read_b64_tr_b16 a[0:1], v7
s_add_u32 m0, s55, 109824
MAV 64,48,152
buffer_load_dwordx4 v18, s[28:31], s54 offen lds
MAV 80,48,156
TR 2,7,512
TR 4,7,32
MAV 80,32,148
TR 6,7,544
s_add_u32 s52, s78, 327680
MAV 84,36,148
.Lpad29:
s_cbranch_execz .Lnopoll62r
buffer_load_dwordx4 v[136:139], v4, s[16:19], s52 offen sc1
MAV 84,52,156
TR 16,7,8448
MAV 68,52,152
TR 18,7,8960
TR 20,7,8480
MAV 68,36,144
TR 22,7,8992
s_waitcnt lgkmcnt(8)
MAV 72,40,144
buffer_load_dwordx4 v19, s[28:31], s54 offen offset:1056 lds
MAV 72,56,152
s_add_u32 s54, s101, 3342336
MAV 88,56,156
TR 8,7,64
TR 10,7,576
MAV 88,40,148
TR 12,7,96
TR 14,7,608
MAV 92,44,148
buffer_load_dwordx4 v[140:143], v4, s[16:19], s52 offen offset:1024 sc1
MAV 92,60,156
TR 24,7,8512
MAV 76,60,152
TR 26,7,9024
TR 28,7,8544
MAV 76,44,144
TR 30,7,9056
s_waitcnt vmcnt(16) lgkmcnt(8)
s_barrier
MAV 32,0,96
ds_read_b64_tr_b16 a[32:33], v6
s_add_u32 m0, s55, 118272
MAV 32,16,104
buffer_load_dwordx4 v18, s[28:31], s54 offen lds
MAV 48,16,108
TR 34,6,512
TR 36,6,32
MAV 48,0,100
TR 38,6,544
s_add_u32 s52, s79, 376832
MAV 52,4,100
buffer_load_dwordx4 v[144:147], v4, s[16:19], s52 offen sc1
MAV 52,20,108
TR 48,6,8448
MAV 36,20,104
TR 50,6,8960
TR 52,6,8480
MAV 36,4,96
TR 54,6,8992
s_waitcnt lgkmcnt(8)
MAV 40,8,96
buffer_load_dwordx4 v19, s[28:31], s54 offen offset:1056 lds
MAV 40,24,104
s_add_u32 s54, s101, 3604480
MAV 56,24,108
TR 40,6,64
TR 42,6,576
MAV 56,8,100
TR 44,6,96
TR 46,6,608
MAV 60,12,100
buffer_load_dwordx4 v[148:151], v4, s[16:19], s52 offen offset:1024 sc1
MAV 60,28,108
TR 56,6,8512
MAV 44,28,104
TR 58,6,9024
TR 60,6,8544
MAV 44,12,96
TR 62,6,9056
s_waitcnt lgkmcnt(8)
MAV 64,32,96
TR 0,7,16896
s_add_u32 m0, s55, 126720
MAV 64,48,104
buffer_load_dwordx4 v18, s[28:31], s54 offen lds
MAV 80,48,108
TR 2,7,17408
TR 4,7,16928
MAV 80,32,100
TR 6,7,17440
s_add_u32 s52, s79, 442368
MAV 84,36,100
buffer_load_dwordx4 v[152:155], v4, s[16:19], s52 offen sc1
MAV 84,52,108
TR 16,7,25344
MAV 68,52,104
TR 18,7,25856
TR 20,7,25376
MAV 68,36,96
TR 22,7,25888
s_waitcnt lgkmcnt(8)
MAV 72,40,96
buffer_load_dwordx4 v19, s[28:31], s54 offen offset:1056 lds
MAV 72,56,104
s_add_u32 s54, s98, 196608
MAV 88,56,108
TR 8,7,16960
TR 10,7,17472
MAV 88,40,100
TR 12,7,16992
TR 14,7,17504
MAV 92,44,100
buffer_load_dwordx4 v[156:159], v4, s[16:19], s52 offen offset:1024 sc1
MAV 92,60,108
TR 24,7,25408
MAV 76,60,104
TR 26,7,25920
TR 28,7,25440
MAV 76,44,96
TR 30,7,25952
s_waitcnt vmcnt(16) lgkmcnt(8)
s_barrier
MAV 32,0,112
TR 32,6,16896
s_add_u32 m0, s55, 0
MAV 32,16,120
buffer_load_dwordx4 v18, s[28:31], s54 offen lds
MAV 48,16,124
TR 34,6,17408
TR 36,6,16928
MAV 48,0,116
TR 38,6,17440
s_add_u32 s52, s76, 491520
MAV 52,4,116
buffer_load_dwordx4 v[96:99], v4, s[16:19], s52 offen sc1
MAV 52,20,124
TR 48,6,25344
MAV 36,20,120
TR 50,6,25856
TR 52,6,25376
MAV 36,4,112
TR 54,6,25888
s_waitcnt lgkmcnt(8)
MAV 40,8,112
buffer_load_dwordx4 v19, s[28:31], s54 offen offset:1056 lds
MAV 40,24,120
s_add_u32 s54, s99, 655360
MAV 56,24,124
TR 40,6,16960
TR 42,6,17472
MAV 56,8,116
TR 44,6,16992
TR 46,6,17504
MAV 60,12,116
buffer_load_dwordx4 v[100:103], v4, s[16:19], s52 offen offset:1024 sc1
MAV 60,28,124
TR 56,6,25408
MAV 44,28,120
TR 58,6,25920
TR 60,6,25440
MAV 44,12,112
TR 62,6,25952
s_waitcnt lgkmcnt(8)
MAV 64,32,112
TR 0,7,33792
s_add_u32 m0, s55, 8448
MAV 64,48,120
buffer_load_dwordx4 v18, s[28:31], s54 offen lds
MAV 80,48,124
TR 2,7,34304
TR 4,7,33824
MAV 80,32,116
TR 6,7,34336
s_add_u32 s52, s76, 557056
MAV 84,36,116
buffer_load_dwordx4 v[104:107], v4, s[16:19], s52 offen sc1
MAV 84,52,124
TR 16,7,42240
MAV 68,52,120
TR 18,7,42752
TR 20,7,42272
MAV 68,36,112
TR 22,7,42784
s_waitcnt lgkmcnt(8)
MAV 72,40,112
buffer_load_dwordx4 v19, s[28:31], s54 offen offset:1056 lds
MAV 72,56,120
s_add_u32 s54, s100, 1114112
MAV 88,56,124
TR 8,7,33856
TR 10,7,34368
MAV 88,40,116
TR 12,7,33888
TR 14,7,34400
MAV 92,44,116
buffer_load_dwordx4 v[108:111], v4, s[16:19], s52 offen offset:1024 sc1
MAV 92,60,124
TR 24,7,42304
MAV 76,60,120
TR 26,7,42816
TR 28,7,42336
MAV 76,44,112
TR 30,7,42848
s_waitcnt vmcnt(16) lgkmcnt(8)
s_barrier
MAV 32,0,128
TR 32,6,33792
s_add_u32 m0, s55, 16896
MAV 32,16,136
buffer_load_dwordx4 v18, s[28:31], s54 offen lds
MAV 48,16,140
TR 34,6,34304
TR 36,6,33824
MAV 48,0,132
TR 38,6,34336
s_add_u32 s52, s77, 606208
MAV 52,4,132
buffer_load_dwordx4 v[112:115], v4, s[16:19], s52 offen sc1
MAV 52,20,140
TR 48,6,42240
MAV 36,20,136
TR 50,6,42752
TR 52,6,42272
MAV 36,4,128
TR 54,6,42784
s_waitcnt lgkmcnt(8)
MAV 40,8,128
buffer_load_dwordx4 v19, s[28:31], s54 offen offset:1056 lds
MAV 40,24,136
s_add_u32 s54, s101, 1572864
MAV 56,24,140
TR 40,6,33856
TR 42,6,34368
MAV 56,8,132
TR 44,6,33888
TR 46,6,34400
MAV 60,12,132
buffer_load_dwordx4 v[116:119], v4, s[16:19], s52 offen offset:1024 sc1
MAV 60,28,140
TR 56,6,42304
MAV 44,28,136
TR 58,6,42816
TR 60,6,42336
MAV 44,12,128
TR 62,6,42848
s_waitcnt lgkmcnt(8)
MAV 64,32,128
TR 0,7,50688
s_add_u32 m0, s55, 25344
MAV 64,48,136
buffer_load_dwordx4 v18, s[28:31], s54 offen lds
MAV 80,48,140
TR 2,7,51200
TR 4,7,50720
MAV 80,32,132
TR 6,7,51232
s_add_u32 s52, s77, 671744
MAV 84,36,132
buffer_load_dwordx4 v[120:123], v4, s[16:19], s52 offen sc1
MAV 84,52,140
TR 16,7,59136
MAV 68,52,136
TR 18,7,59648
TR 20,7,59168
MAV 68,36,128
TR 22,7,59680
s_waitcnt lgkmcnt(8)
MAV 72,40,128
buffer_load_dwordx4 v19, s[28:31], s54 offen offset:1056 lds
MAV 72,56,136
s_add_u32 s54, s98, 2031616
MAV 88,56,140
TR 8,7,50752
TR 10,7,51264
MAV 88,40,132
TR 12,7,50784
TR 14,7,51296
MAV 92,44,132
buffer_load_dwordx4 v[124:127], v4, s[16:19], s52 offen offset:1024 sc1
MAV 92,60,140
TR 24,7,59200
MAV 76,60,136
TR 26,7,59712
TR 28,7,59232
MAV 76,44,128
TR 30,7,59744
s_waitcnt vmcnt(16) lgkmcnt(8)
s_barrier
MAV 32,0,144
TR 32,6,50688
s_add_u32 m0, s55, 33792
MAV 32,16,152
buffer_load_dwordx4 v18, s[28:31], s54 offen lds
MAV 48,16,156
TR 34,6,51200
TR 36,6,50720
MAV 48,0,148
TR 38,6,51232
s_add_u32 s52, s78, 720896
MAV 52,4,148
buffer_load_dwordx4 v[128:131], v4, s[16:19], s52 offen sc1
MAV 52,20,156
TR 48,6,59136
MAV 36,20,152
TR 50,6,59648
TR 52,6,59168
MAV 36,4,144
TR 54,6,59680
s_waitcnt lgkmcnt(8)
MAV 40,8,144
buffer_load_dwordx4 v19, s[28:31], s54 offen offset:1056 lds
MAV 40,24,152
s_add_u32 s54, s99, 2490368
MAV 56,24,156
TR 40,6,50752
TR 42,6,51264
MAV 56,8,148
TR 44,6,50784
TR 46,6,51296
MAV 60,12,148
buffer_load_dwordx4 v[132:135], v4, s[16:19], s52 offen offset:1024 sc1
MAV 60,28,156
TR 56,6,59200
MAV 44,28,152
TR 58,6,59712
TR 60,6,59232
MAV 44,12,144
TR 62,6,59744
v_add_u32 v7, s57, v7
v_add_u32 v6, s57, v6
s_sub_u32 s57, 0, s57
s_waitcnt lgkmcnt(8)
MAV 64,32,144
ds_read_b64_tr_b16 a[0:1], v6
s_add_u32 m0, s55, 42240
MAV 64,48,152
buffer_load_dwordx4 v18, s[28:31], s54 offen lds
MAV 80,48,156
TR 2,6,512
TR 4,6,32
MAV 80,32,148
TR 6,6,544
s_add_u32 s52, s78, 786432
MAV 84,36,148
buffer_load_dwordx4 v[136:139], v4, s[16:19], s52 offen sc1
MAV 84,52,156
TR 16,6,8448
MAV 68,52,152
TR 18,6,8960
TR 20,6,8480
MAV 68,36,144
TR 22,6,8992
s_waitcnt lgkmcnt(8)
MAV 72,40,144
buffer_load_dwordx4 v19, s[28:31], s54 offen offset:1056 lds
MAV 72,56,152
s_add_u32 s54, s100, 2949120
MAV 88,56,156
TR 8,6,64
TR 10,6,576
MAV 88,40,148
TR 12,6,96
TR 14,6,608
MAV 92,44,148
buffer_load_dwordx4 v[140:143], v4, s[16:19], s52 offen offset:1024 sc1
MAV 92,60,156
TR 24,6,8512
MAV 76,60,152
TR 26,6,9024
TR 28,6,8544
MAV 76,44,144
TR 30,6,9056
s_waitcnt vmcnt(16) lgkmcnt(8)
s_barrier
MAV 64,0,96
TR 32,6,16896
TR 34,6,17408
s_add_u32 m0, s55, 50688
MAV 64,16,104
TR 36,6,16928
buffer_load_dwordx4 v18, s[28:31], s54 offen lds
MAV 80,16,108
buffer_load_dwordx4 v19, s[28:31], s54 offen offset:1056 lds
MAV 80,0,100
TR 38,6,17440
s_add_u32 s54, s101, 3407872
s_add_u32 s52, s79, 835584
MAV 84,4,100
TR 48,6,25344
buffer_load_dwordx4 v[144:147], v4, s[16:19], s52 offen sc1
MAV 84,20,108
TR 50,6,25856
MAV 68,20,104
TR 52,6,25376
buffer_load_dwordx4 v[148:151], v4, s[16:19], s52 offen offset:1024 sc1
MAV 68,4,96
TR 54,6,25888
s_add_u32 m0, s55, 59136
s_waitcnt lgkmcnt(8)
MAV 72,8,96
buffer_load_dwordx4 v18, s[28:31], s54 offen lds
MAV 72,24,104
TR 40,6,16960
TR 42,6,17472
MAV 88,24,108
TR 44,6,16992
buffer_load_dwordx4 v19, s[28:31], s54 offen offset:1056 lds
MAV 88,8,100
TR 46,6,17504
s_add_u32 s52, s79, 901120
MAV 92,12,100
TR 56,6,25408
buffer_load_dwordx4 v[152:155], v4, s[16:19], s52 offen sc1
MAV 92,28,108
TR 58,6,25920
MAV 76,28,104
TR 60,6,25440
buffer_load_dwordx4 v[156:159], v4, s[16:19], s52 offen offset:1024 sc1
MAV 76,12,96
TR 62,6,25952
s_waitcnt vmcnt(16) lgkmcnt(8)
MAV 64,32,112
TR 0,6,33792
s_add_u32 s52, s76, 49152
s_lshl_b32 s70, s2, 10
MAV 64,48,120
buffer_load_dwordx4 v[160:163], v4, s[16:19], s52 offen sc1
s_lshl_b32 s62, s3, 7
MAV 80,48,124
TR 2,6,34304
TR 4,6,33824
MAV 80,32,116
TR 6,6,34336
s_add_u32 s70, s70, s62
s_add_u32 s70, s70, 31457792
MAV 84,36,116
buffer_load_dwordx4 v[164:167], v4, s[16:19], s52 offen offset:1024 sc1
s_xor_b32 s71, s70, 1024
MAV 84,52,124
TR 16,6,42240
TR 18,6,42752
MAV 68,52,120
TR 20,6,42272
v_min_u32 v12, 1, v1
v_lshlrev_b32 v12, 28, v12
MAV 68,36,112
TR 22,6,42784
s_add_u32 s52, s77, 163840
s_waitcnt lgkmcnt(8)
MAV 72,40,112
buffer_load_dwordx4 v[168:171], v4, s[16:19], s52 offen sc1
v_mov_b32 v13, 1
MAV 72,56,120
TR 8,6,33856
v_mov_b32 v15, 0
s_lshl_b32 s68, s7, 18
MAV 88,56,124
TR 10,6,34368
TR 12,6,33888
MAV 88,40,116
TR 14,6,34400
s_add_u32 s68, s68, 146800640
s_xor_b32 s69, s68, 262144
MAV 92,44,116
buffer_load_dwordx4 v[172:175], v4, s[16:19], s52 offen offset:1024 sc1
v_mov_b32 v11, v4
MAV 92,60,124
TR 24,6,42304
TR 26,6,42816
MAV 76,60,120
TR 28,6,42336
v_and_b32 v2, 1, v1
v_lshlrev_b32 v2, 4, v2
MAV 76,44,112
TR 30,6,42848
v_mov_b32 v224, 0x3f80
s_waitcnt vmcnt(12) lgkmcnt(8)
MAV 64,0,128
TR 32,6,50688
s_add_u32 s52, s78, 278528
v_lshlrev_b32 v2, v2, v224
MAV 64,16,136
buffer_load_dwordx4 v[176:179], v4, s[16:19], s52 offen sc1
v_bfe_u32 v224, v1, 2, 2
MAV 80,16,140
TR 34,6,51200
TR 36,6,50720
MAV 80,0,132
TR 38,6,51232
v_lshrrev_b32 v225, 4, v1
v_cmp_eq_u32 vcc, v224, v225
MAV 84,4,132
buffer_load_dwordx4 v[180:183], v4, s[16:19], s52 offen offset:1024 sc1
v_cndmask_b32 v2, 0, v2, vcc
MAV 84,20,140
TR 48,6,59136
TR 50,6,59648
MAV 68,20,136
TR 52,6,59168
v_and_b32 v224, 2, v1
v_cmp_eq_u32 vcc, 0, v224
MAV 68,4,128
TR 54,6,59680
s_add_u32 s52, s79, 393216
s_waitcnt lgkmcnt(8)
MAV 72,8,128
buffer_load_dwordx4 v[184:187], v4, s[16:19], s52 offen sc1
v_cndmask_b32 v226, 0, v2, vcc
MAV 72,24,136
TR 40,6,50752
v_cndmask_b32 v227, v2, 0, vcc
v_mov_b32 v224, 0
MAV 88,24,140
TR 42,6,51264
TR 44,6,50784
MAV 88,8,132
TR 46,6,51296
v_mov_b32 v225, 0
v_mov_b32 v228, 0
MAV 92,12,132
buffer_load_dwordx4 v[188:191], v4, s[16:19], s52 offen offset:1024 sc1
v_mov_b32 v229, 0
MAV 92,28,140
TR 56,6,59200
TR 58,6,59712
MAV 76,28,136
TR 60,6,59232
s_lshr_b32 s62, s6, 1
s_lshl_b32 s62, s62, 8
MAV 76,12,128
TR 62,6,59744
s_and_b32 s63, s6, 1
s_waitcnt vmcnt(8) lgkmcnt(8)
s_barrier
v_add_u32 v6, s57, v6
MAV 64,32,144
ds_read_b64_tr_b16 a[0:1], v6
s_add_u32 s52, s76, 507904
s_add_u32 s62, s62, s63
MAV 64,48,152
buffer_load_dwordx4 v[192:195], v4, s[16:19], s52 offen sc1
s_lshl_b32 s63, s3, 6
MAV 80,48,156
TR 2,6,512
TR 4,6,32
MAV 80,32,148
TR 6,6,544
s_add_u32 s62, s62, s63
s_lshl_b32 s62, s62, 11
MAV 84,36,148
buffer_load_dwordx4 v[196:199], v4, s[16:19], s52 offen offset:1024 sc1
s_lshl_b32 s63, s7, 7
MAV 84,52,156
.Lpad30:
s_cbranch_execz .Lnopoll62r
TR 16,6,8448
TR 18,6,8960
MAV 68,52,152
TR 20,6,8480
s_add_u32 s62, s62, s63
v_and_b32 v16, 15, v1
MAV 68,36,144
TR 22,6,8992
s_add_u32 s52, s77, 622592
s_waitcnt lgkmcnt(8)
MAV 72,40,144
buffer_load_dwordx4 v[200:203], v4, s[16:19], s52 offen sc1
v_lshlrev_b32 v16, 12, v16
MAV 72,56,152
TR 8,6,64
v_bfe_u32 v2, v1, 4, 1
v_lshl_add_u32 v16, v2, 5, v16
MAV 88,56,156
TR 10,6,576
TR 12,6,96
MAV 88,40,148
TR 14,6,608
v_bfe_u32 v2, v1, 5, 1
v_lshl_add_u32 v16, v2, 4, v16
MAV 92,44,148
buffer_load_dwordx4 v[204:207], v4, s[16:19], s52 offen offset:1024 sc1
v_add_u32 v16, s62, v16
MAV 92,60,156
TR 24,6,8512
TR 26,6,9024
MAV 76,60,152
TR 28,6,8544
v_add_u32 v17, 0x10000, v16
v_accvgpr_read_b32 v28, a224
MAV 76,44,144
TR 30,6,9056
v_add_f32 v32, v32, v28
s_waitcnt vmcnt(8) lgkmcnt(8)
MAV 64,0,160
TR 32,6,16896
s_add_u32 s52, s78, 737280
v_accvgpr_read_b32 v29, a225
MAV 64,16,168
buffer_load_dwordx4 v[208:211], v4, s[16:19], s52 offen sc1
v_add_f32 v33, v33, v29
MAV 80,16,172
TR 34,6,17408
TR 36,6,16928
MAV 80,0,164
TR 38,6,17440
v_accvgpr_read_b32 v28, a226
v_add_f32 v34, v34, v28
MAV 84,4,164
buffer_load_dwordx4 v[212:215], v4, s[16:19], s52 offen offset:1024 sc1
v_accvgpr_read_b32 v29, a227
MAV 84,20,172
TR 48,6,25344
TR 50,6,25856
MAV 68,20,168
TR 52,6,25376
v_add_f32 v35, v35, v29
v_accvgpr_read_b32 v28, a228
MAV 68,4,160
TR 54,6,25888
s_add_u32 s52, s79, 851968
s_waitcnt lgkmcnt(8)
MAV 72,8,160
buffer_load_dwordx4 v[216:219], v4, s[16:19], s52 offen sc1
v_add_f32 v36, v36, v28
MAV 72,24,168
TR 40,6,16960
v_accvgpr_read_b32 v29, a229
v_add_f32 v37, v37, v29
MAV 88,24,172
TR 42,6,17472
TR 44,6,16992
MAV 88,8,164
TR 46,6,17504
v_accvgpr_read_b32 v28, a230
v_add_f32 v38, v38, v28
MAV 92,12,164
buffer_load_dwordx4 v[220:223], v4, s[16:19], s52 offen offset:1024 sc1
v_accvgpr_read_b32 v29, a231
MAV 92,28,172
TR 56,6,25408
TR 58,6,25920
MAV 76,28,168
TR 60,6,25440
v_add_f32 v39, v39, v29
v_accvgpr_read_b32 v28, a232
MAV 76,12,160
TR 62,6,25952
v_add_f32 v40, v40, v28
s_waitcnt vmcnt(8) lgkmcnt(8)
MAV 64,32,176
TR 0,6,33792
v_accvgpr_read_b32 v29, a233
v_add_f32 v41, v41, v29
MAV 64,48,184
TR 2,6,34304
v_accvgpr_read_b32 v28, a234
MAV 80,48,188
TR 4,6,33824
v_add_f32 v42, v42, v28
MAV 80,32,180
TR 6,6,34336
v_accvgpr_read_b32 v29, a235
MAV 84,36,180
TR 16,6,42240
v_add_f32 v43, v43, v29
MAV 84,52,188
TR 18,6,42752
v_accvgpr_read_b32 v28, a236
MAV 68,52,184
TR 20,6,42272
v_add_f32 v44, v44, v28
MAV 68,36,176
TR 22,6,42784
s_waitcnt lgkmcnt(8)
MAV 72,40,176
TR 8,6,33856
v_accvgpr_read_b32 v29, a237
MAV 72,56,184
TR 10,6,34368
v_add_f32 v45, v45, v29
MAV 88,56,188
TR 12,6,33888
v_accvgpr_read_b32 v28, a238
MAV 88,40,180
TR 14,6,34400
v_add_f32 v46, v46, v28
MAV 92,44,180
TR 24,6,42304
v_accvgpr_read_b32 v29, a239
MAV 92,60,188
TR 26,6,42816
v_add_f32 v47, v47, v29
MAV 76,60,184
TR 28,6,42336
v_accvgpr_read_b32 v28, a240
MAV 76,44,176
TR 30,6,42848
v_add_f32 v48, v48, v28
s_waitcnt vmcnt(4) lgkmcnt(8)
MAV 64,0,192
TR 32,6,50688
v_accvgpr_read_b32 v29, a241
v_add_f32 v49, v49, v29
MAV 64,16,200
TR 34,6,51200
v_accvgpr_read_b32 v28, a242
MAV 80,16,204
TR 36,6,50720
v_add_f32 v50, v50, v28
MAV 80,0,196
TR 38,6,51232
v_accvgpr_read_b32 v29, a243
MAV 84,4,196
TR 48,6,59136
v_add_f32 v51, v51, v29
MAV 84,20,204
TR 50,6,59648
v_accvgpr_read_b32 v28, a244
MAV 68,20,200
TR 52,6,59168
v_add_f32 v52, v52, v28
MAV 68,4,192
TR 54,6,59680
s_waitcnt lgkmcnt(8)
MAV 72,8,192
TR 40,6,50752
v_accvgpr_read_b32 v29, a245
MAV 72,24,200
TR 42,6,51264
v_add_f32 v53, v53, v29
MAV 88,24,204
TR 44,6,50784
v_accvgpr_read_b32 v28, a246
MAV 88,8,196
TR 46,6,51296
v_add_f32 v54, v54, v28
MAV 92,12,196
TR 56,6,59200
v_accvgpr_read_b32 v29, a247
MAV 92,28,204
TR 58,6,59712
v_add_f32 v55, v55, v29
MAV 76,28,200
TR 60,6,59232
v_accvgpr_read_b32 v28, a248
MAV 76,12,192
TR 62,6,59744
v_add_f32 v56, v56, v28
s_waitcnt vmcnt(0) lgkmcnt(8)
MAV 64,32,208
ds_read_b64_tr_b16 a[0:1], v7
v_accvgpr_read_b32 v29, a249
MAV 64,48,216
TR 2,7,512
v_add_f32 v57, v57, v29
MAV 80,48,220
TR 4,7,32
v_accvgpr_read_b32 v28, a250
MAV 80,32,212
TR 6,7,544
v_add_f32 v58, v58, v28
MAV 84,36,212
TR 16,7,8448
v_accvgpr_read_b32 v29, a251
MAV 84,52,220
TR 18,7,8960
v_add_f32 v59, v59, v29
MAV 68,52,216
TR 20,7,8480
v_accvgpr_read_b32 v28, a252
MAV 68,36,208
TR 22,7,8992
s_waitcnt lgkmcnt(8)
MAV 72,40,208
TR 8,7,64
v_add_f32 v60, v60, v28
MAV 72,56,216
TR 10,7,576
v_accvgpr_read_b32 v29, a253
MAV 88,56,220
TR 12,7,96
v_add_f32 v61, v61, v29
MAV 88,40,212
TR 14,7,608
v_accvgpr_read_b32 v28, a254
MAV 92,44,212
TR 24,7,8512
v_add_f32 v62, v62, v28
MAV 92,60,220
TR 26,7,9024
v_accvgpr_read_b32 v29, a255
MAV 76,60,216
TR 28,7,8544
v_add_f32 v63, v63, v29
MAV 76,44,208
TR 30,7,9056
s_waitcnt lgkmcnt(8)
MAV 32,0,96
TR 32,7,16896
v_cvt_pk_bf16_f32 v232, v64, v65
v_cvt_pk_bf16_f32 v233, v66, v67
MAV 32,16,104
TR 34,7,17408
v_cvt_pk_bf16_f32 v234, v68, v69
MAV 48,16,108
TR 36,7,16928
v_cvt_pk_bf16_f32 v235, v70, v71
buffer_store_dwordx4 v[232:235], v11, s[16:19], s69 offen sc1
MAV 48,0,100
TR 38,7,17440
s_add_u32 s69, s69, 131072
MAV 52,4,100
TR 48,7,25344
v_cvt_pk_bf16_f32 v236, v72, v73
v_cvt_pk_bf16_f32 v237, v74, v75
MAV 52,20,108
TR 50,7,25856
v_cvt_pk_bf16_f32 v238, v76, v77
MAV 36,20,104
TR 52,7,25376
v_cvt_pk_bf16_f32 v239, v78, v79
buffer_store_dwordx4 v[236:239], v11, s[16:19], s69 offen sc1
MAV 36,4,96
TR 54,7,25888
s_add_u32 s69, s69, -130048
s_waitcnt lgkmcnt(8)
MAV 40,8,96
TR 40,7,16960
v_cvt_pk_bf16_f32 v240, v80, v81
MAV 40,24,104
TR 42,7,17472
v_cvt_pk_bf16_f32 v241, v82, v83
v_cvt_pk_bf16_f32 v242, v84, v85
MAV 56,24,108
TR 44,7,16992
v_cvt_pk_bf16_f32 v243, v86, v87
MAV 56,8,100
TR 46,7,17504
buffer_store_dwordx4 v[240:243], v11, s[16:19], s69 offen sc1
s_add_u32 s69, s69, 131072
MAV 60,12,100
TR 56,7,25408
v_cvt_pk_bf16_f32 v244, v88, v89
MAV 60,28,108
TR 58,7,25920
v_cvt_pk_bf16_f32 v245, v90, v91
v_cvt_pk_bf16_f32 v246, v92, v93
MAV 44,28,104
TR 60,7,25440
v_cvt_pk_bf16_f32 v247, v94, v95
MAV 44,12,96
TR 62,7,25952
buffer_store_dwordx4 v[244:247], v11, s[16:19], s69 offen sc1
s_waitcnt lgkmcnt(8)
MAV 32,32,112
TR 0,7,33792
MAV 32,48,120
TR 2,7,34304
MAV 48,48,124
TR 4,7,33824
MAV 48,32,116
TR 6,7,34336
MAV 52,36,116
TR 16,7,42240
MAV 52,52,124
TR 18,7,42752
MAV 36,52,120
TR 20,7,42272
MAV 36,36,112
TR 22,7,42784
s_waitcnt lgkmcnt(8)
MAV 40,40,112
TR 8,7,33856
MAV 40,56,120
TR 10,7,34368
MAV 56,56,124
TR 12,7,33888
MAV 56,40,116
TR 14,7,34400
MAV 60,44,116
TR 24,7,42304
MAV 60,60,124
TR 26,7,42816
MAV 44,60,120
TR 28,7,42336
MAV 44,44,112
TR 30,7,42848
s_waitcnt lgkmcnt(8)
MAV 32,0,128
TR 32,7,50688
MAV 32,16,136
TR 34,7,51200
MAV 48,16,140
TR 36,7,50720
MAV 48,0,132
TR 38,7,51232
MAV 52,4,132
TR 48,7,59136
MAV 52,20,140
TR 50,7,59648
MAV 36,20,136
TR 52,7,59168
MAV 36,4,128
TR 54,7,59680
s_waitcnt lgkmcnt(8)
MAV 40,8,128
TR 40,7,50752
MAV 40,24,136
TR 42,7,51264
MAV 56,24,140
TR 44,7,50784
MAV 56,8,132
TR 46,7,51296
MAV 60,12,132
TR 56,7,59200
MAV 60,28,140
TR 58,7,59712
MAV 44,28,136
TR 60,7,59232
MAV 44,12,128
TR 62,7,59744
v_add_u32 v7, s57, v7
s_waitcnt lgkmcnt(8)
MAV 32,32,144
ds_read_b64_tr_b16 a[0:1], v7
TR 2,7,512
MAV 32,48,152
s_waitcnt vmcnt(0)
buffer_atomic_add v13, v12, s[16:19], s71 offen
MAV 48,48,156
TR 4,7,32
MAV 48,32,148
TR 6,7,544
MAV 52,36,148
TR 16,7,8448
MAV 52,52,156
TR 18,7,8960
MAV 36,52,152
TR 20,7,8480
MAV 36,36,144
TR 22,7,8992
s_waitcnt lgkmcnt(8)
MAV 40,40,144
TR 8,7,64
MAV 40,56,152
TR 10,7,576
MAV 56,56,156
TR 12,7,96
MAV 56,40,148
TR 14,7,608
MAV 60,44,148
TR 24,7,8512
MAV 60,60,156
TR 26,7,9024
MAV 44,60,152
TR 28,7,8544
MAV 44,44,144
TR 30,7,9056
s_waitcnt lgkmcnt(8)
MAV 32,0,160
TR 32,7,16896
TR 34,7,17408
MAV 32,16,168
buffer_atomic_add v15, v12, s[16:19], s70 offen sc0
MAV 48,16,172
TR 36,7,16928
MAV 48,0,164
TR 38,7,17440
MAV 52,4,164
TR 48,7,25344
MAV 52,20,172
TR 50,7,25856
MAV 36,20,168
TR 52,7,25376
MAV 36,4,160
TR 54,7,25888
s_waitcnt lgkmcnt(8)
MAV 40,8,160
TR 40,7,16960
MAV 40,24,168
TR 42,7,17472
MAV 56,24,172
TR 44,7,16992
MAV 56,8,164
TR 46,7,17504
MAV 60,12,164
TR 56,7,25408
MAV 60,28,172
TR 58,7,25920
MAV 44,28,168
TR 60,7,25440
MAV 44,12,160
TR 62,7,25952
s_waitcnt lgkmcnt(8)
MAV 32,32,176
TR 0,7,33792
MAV 32,48,184
TR 2,7,34304
MAV 48,48,188
TR 4,7,33824
MAV 48,32,180
TR 6,7,34336
MAV 52,36,180
TR 16,7,42240
MAV 52,52,188
TR 18,7,42752
MAV 36,52,184
TR 20,7,42272
MAV 36,36,176
TR 22,7,42784
s_waitcnt lgkmcnt(8)
MAV 40,40,176
TR 8,7,33856
MAV 40,56,184
TR 10,7,34368
MAV 56,56,188
TR 12,7,33888
MAV 56,40,180
TR 14,7,34400
MAV 60,44,180
TR 24,7,42304
MAV 60,60,188
TR 26,7,42816
MAV 44,60,184
TR 28,7,42336
MAV 44,44,176
TR 30,7,42848
s_waitcnt vmcnt(0)
v_cmp_ne_u32 vcc, 0, v15
s_nop 0
s_cbranch_vccz .Lxs67
.Lxs67b:
s_waitcnt lgkmcnt(8)
MAV 32,0,192
TR 32,7,50688
TR 34,7,51200
MAV 32,16,200
buffer_load_dwordx4 v[232:235], v11, s[16:19], s68 offen sc1
MAV 48,16,204
TR 36,7,50720
s_add_u32 s68, s68, 131072
MAV 48,0,196
TR 38,7,51232
MAV 52,4,196
buffer_load_dwordx4 v[236:239], v11, s[16:19], s68 offen sc1
MAV 52,20,204
TR 48,7,59136
s_add_u32 s68, s68, -130048
MAV 36,20,200
TR 50,7,59648
TR 52,7,59168
MAV 36,4,192
TR 54,7,59680
s_waitcnt lgkmcnt(8)
MAV 40,8,192
buffer_load_dwordx4 v[240:243], v11, s[16:19], s68 offen sc1
MAV 40,24,200
s_add_u32 s68, s68, 131072
MAV 56,24,204
TR 40,7,50752
TR 42,7,51264
MAV 56,8,196
TR 44,7,50784
TR 46,7,51296
MAV 60,12,196
buffer_load_dwordx4 v[244:247], v11, s[16:19], s68 offen sc1
MAV 60,28,204
TR 56,7,59200
MAV 44,28,200
TR 58,7,59712
TR 60,7,59232
MAV 44,12,192
TR 62,7,59744
s_waitcnt lgkmcnt(8)
MAV 32,32,208
MAV 32,48,216
MAV 48,48,220
MAV 48,32,212
MAV 52,36,212
MAV 52,52,220
MAV 36,52,216
MAV 36,36,208
s_waitcnt lgkmcnt(0)
MAV 40,40,208
MAV 40,56,216
MAV 56,56,220
MAV 56,40,212
MAV 60,44,212
MAV 60,60,220
MAV 44,60,216
MAV 44,44,208
s_waitcnt vmcnt(3)
v_mfma_f32_16x16x32_bf16 v[32:35], v[226:229], v[232:235], v[32:35]
v_mfma_f32_16x16x32_bf16 v[36:39], v[224:227], v[232:235], v[36:39]
s_waitcnt vmcnt(2)
v_mfma_f32_16x16x32_bf16 v[40:43], v[226:229], v[236:239], v[40:43]
s_nop 4
v_cvt_pk_bf16_f32 v128, v32, v33
v_cvt_pk_bf16_f32 v129, v34, v35
v_mfma_f32_16x16x32_bf16 v[44:47], v[224:227], v[236:239], v[44:47]
v_cvt_pk_bf16_f32 v130, v36, v37
v_cvt_pk_bf16_f32 v131, v38, v39
s_waitcnt vmcnt(1)
.Lpad31:
s_cbranch_execz .Lnopoll62r
v_mfma_f32_16x16x32_bf16 v[48:51], v[226:229], v[240:243], v[48:51]
v_permlane16_swap_b32 v128, v130
v_mfma_f32_16x16x32_bf16 v[52:55], v[224:227], v[240:243], v[52:55]
v_permlane16_swap_b32 v129, v131
s_waitcnt vmcnt(0)
v_mfma_f32_16x16x32_bf16 v[56:59], v[226:229], v[244:247], v[56:59]
buffer_store_dwordx4 v[128:131], v16, s[36:39], 0 offen sc1
v_mfma_f32_16x16x32_bf16 v[60:63], v[224:227], v[244:247], v[60:63]
v_cvt_pk_bf16_f32 v132, v40, v41
v_cvt_pk_bf16_f32 v133, v42, v43
v_cvt_pk_bf16_f32 v134, v44, v45
v_cvt_pk_bf16_f32 v135, v46, v47
v_cvt_pk_bf16_f32 v136, v48, v49
v_permlane16_swap_b32 v132, v134
v_permlane16_swap_b32 v133, v135
v_cvt_pk_bf16_f32 v137, v50, v51
v_cvt_pk_bf16_f32 v138, v52, v53
buffer_store_dwordx4 v[132:135], v16, s[36:39], 0 offen offset:64 sc1
v_cvt_pk_bf16_f32 v139, v54, v55
v_permlane16_swap_b32 v136, v138
s_nop 0
v_permlane16_swap_b32 v137, v139
v_cvt_pk_bf16_f32 v140, v56, v57
v_cvt_pk_bf16_f32 v141, v58, v59
v_cvt_pk_bf16_f32 v142, v60, v61
v_cvt_pk_bf16_f32 v143, v62, v63
s_nop 0
v_permlane16_swap_b32 v140, v142
v_permlane16_swap_b32 v141, v143
buffer_store_dwordx4 v[136:139], v17, s[36:39], 0 offen sc1
buffer_store_dwordx4 v[140:143], v17, s[36:39], 0 offen offset:64 sc1
s_nop 1
.Lend:
s_endpgm
.Lsp66:
s_mov_b32 s15, 0
.Lsp66l:
v_mov_b32 v25, 0
buffer_atomic_add v25, v22, s[16:19], s73 offen sc0
s_add_u32 s15, s15, 1
s_cmp_gt_u32 s15, 100000
s_waitcnt vmcnt(0)
s_cbranch_scc1 .Lsp66b
v_cmp_gt_u32 vcc, v23, v25
s_nop 0
s_cbranch_vccnz .Lsp66l
s_branch .Lsp66b
.Lxs67:
s_mov_b32 s15, 0
.Lxs67l:
v_mov_b32 v15, 0
buffer_atomic_add v15, v12, s[16:19], s70 offen sc0
s_add_u32 s15, s15, 1
s_cmp_gt_u32 s15, 100000
s_waitcnt vmcnt(0)
s_cbranch_scc1 .Lxs67b
v_cmp_ne_u32 vcc, 0, v15
s_nop 0
s_cbranch_vccz .Lxs67l
s_branch .Lxs67b
.section .rodata,"a"
.p2align 6
.amdhsa_kernel interleave_layers__sliding_local_dilated__swiglu_ffn__prompt_kernel
  .amdhsa_next_free_vgpr 512
  .amdhsa_next_free_sgpr 102
  .amdhsa_accum_offset 256
  .amdhsa_group_segment_fixed_size 0
  .amdhsa_kernarg_size 80
  .amdhsa_user_sgpr_count 2
  .amdhsa_user_sgpr_kernarg_segment_ptr 1
  .amdhsa_system_sgpr_workgroup_id_x 1
  .amdhsa_float_denorm_mode_32 3
.end_amdhsa_kernel
```

```asm
; @launch grid=(256,1,1) block=(256,1,1) lds=162560
.amdgcn_target "amdgcn-amd-amdhsa--gfx950"
.macro MAA d,a,b
v_mfma_f32_16x16x32_bf16 v[\d:\d+3], a[\a:\a+3], a[\b:\b+3], v[\d:\d+3]
.endm
.macro MAV d,a,b
v_mfma_f32_16x16x32_bf16 v[\d:\d+3], a[\a:\a+3], v[\b:\b+3], v[\d:\d+3]
.endm
.macro TR d,v,o
ds_read_b64_tr_b16 a[\d:\d+1], v\v offset:\o
.endm
.macro RD d,v,o
ds_read_b128 a[\d:\d+3], v\v offset:\o
.endm
.text
.globl interleave_layers__sliding_local_dilated__swiglu_ffn__prompt_kernel
.p2align 8
.type interleave_layers__sliding_local_dilated__swiglu_ffn__prompt_kernel,@function
interleave_layers__sliding_local_dilated__swiglu_ffn__prompt_kernel:
s_load_dwordx4 s[68:71], s[0:1], 0
s_load_dwordx2 s[72:73], s[0:1], 16
s_load_dwordx8 s[76:83], s[0:1], 32
s_load_dwordx4 s[84:87], s[0:1], 64
s_cmp_lt_u32 s2, 256
s_cbranch_scc1 .Lgo
s_endpgm
.p2align 12
.Lgo:
v_lshrrev_b32 v2, 6, v0
v_and_b32 v1, 63, v0
v_readfirstlane_b32 s3, v2
s_and_b32 s4, s2, 7
s_lshr_b32 s5, s2, 3
s_lshr_b32 s8, s4, 2
s_lshl_b32 s8, s8, 3
s_and_b32 s62, s5, 7
s_add_u32 s8, s8, s62
s_and_b32 s9, s4, 3
s_lshl_b32 s9, s9, 2
s_lshr_b32 s62, s5, 3
s_add_u32 s9, s9, s62
s_and_b32 s48, s3, 1
s_lshr_b32 s49, s3, 1
s_lshl_b32 s50, s8, 3
s_sub_u32 s50, s50, 9
s_cmp_lt_u32 s8, 2
s_cselect_b32 s50, 7, s50
v_bfe_u32 v18, v1, 3, 1
v_bfe_u32 v2, v1, 5, 1
v_lshl_add_u32 v18, v2, 2, v18
v_and_b32 v2, 16, v1
v_add_u32 v18, v18, v2
s_lshl_b32 s62, s49, 2
s_add_u32 s62, s62, s48
s_lshl_b32 s62, s62, 1
v_add_u32 v18, s62, v18
v_mul_u32_u24 v18, 6144, v18
v_and_b32 v2, 7, v1
v_lshl_add_u32 v18, v2, 4, v18
s_lshl_b32 s62, s9, 7
v_add_u32 v18, s62, v18
v_add_u32 v19, 1024, v18
v_add_u32 v20, 2048, v18
s_mul_i32 s59, s3, 3104
s_mov_b32 s58, 0
s_lshr_b32 s62, s8, 1
s_lshl_b32 s62, s62, 8
s_and_b32 s67, s8, 1
s_add_u32 s62, s62, s67
s_lshl_b32 s62, s62, 11
s_lshl_b32 s63, s3, 17
s_add_u32 s62, s62, s63
v_lshrrev_b32 v2, 4, v1
v_xor_b32 v2, v2, v1
v_and_b32 v2, 7, v2
v_lshlrev_b32 v2, 4, v2
v_lshrrev_b32 v21, 3, v1
v_lshl_add_u32 v21, v21, 12, v2
v_add_u32 v21, s62, v21
v_xor_b32 v28, 64, v21
v_add_u32 v28, 31744, v28
s_lshr_b32 s63, s50, 3
s_lshr_b32 s62, s63, 1
s_lshl_b32 s62, s62, 8
s_and_b32 s67, s63, 1
s_add_u32 s62, s62, s67
s_lshl_b32 s62, s62, 11
s_lshl_b32 s63, s3, 14
s_add_u32 s62, s62, s63
s_add_u32 s62, s62, 456704
s_lshl_b32 s63, s3, 5
v_and_b32 v2, 31, v1
v_lshlrev_b32 v2, 2, v2
v_xor_b32 v2, s63, v2
v_lshrrev_b32 v22, 5, v1
v_lshl_add_u32 v22, v22, 12, v2
v_add_u32 v22, s62, v22
v_xor_b32 v29, 16, v22
v_add_u32 v29, -57344, v29
s_mov_b32 s52, 0
s_mov_b32 s53, 65536
s_mul_i32 s55, s3, 4608
s_mov_b32 s54, 0
s_mul_i32 s56, s3, 3104
s_waitcnt lgkmcnt(0)
s_mov_b32 s36, s68
s_mov_b32 s37, s69
s_mov_b32 s38, 4194304
s_mov_b32 s39, 0x20000
s_mov_b32 s20, s70
s_mov_b32 s21, s71
s_mov_b32 s22, 6291456
s_mov_b32 s23, 0x20000
s_lshr_b32 s6, s4, 1
s_lshl_b32 s6, s6, 2
s_and_b32 s62, s5, 3
s_add_u32 s6, s6, s62
s_and_b32 s7, s4, 1
s_lshr_b32 s62, s5, 2
s_lshl_b32 s62, s62, 1
s_add_u32 s7, s7, s62
s_lshr_b32 s62, s6, 1
s_lshl_b32 s62, s62, 8
s_and_b32 s63, s6, 1
s_add_u32 s62, s62, s63
s_lshl_b32 s63, s3, 6
s_add_u32 s62, s62, s63
s_lshl_b32 s62, s62, 11
s_lshl_b32 s63, s7, 7
s_add_u32 s62, s62, s63
v_and_b32 v228, 15, v1
v_lshlrev_b32 v228, 12, v228
v_bfe_u32 v2, v1, 4, 1
v_lshl_add_u32 v228, v2, 5, v228
v_bfe_u32 v2, v1, 5, 1
v_lshl_add_u32 v228, v2, 4, v228
v_add_u32 v228, s62, v228
v_add_u32 v229, 0x10000, v228
s_sub_u32 s64, s3, 1
s_max_i32 s64, s64, 0
s_lshl_b32 s64, s64, 11
s_lshl_b32 s66, s9, 7
s_add_u32 s66, s66, s64
s_cmp_eq_u32 s3, 1
s_cselect_b32 s66, 8388608, s66
s_mul_i32 s65, s8, 122880
s_add_u32 s65, s65, s66
v_lshrrev_b32 v9, 1, v1
v_min_u32 v9, 19, v9
v_mul_u32_u24 v9, 6144, v9
s_mov_b32 s16, s86
s_mov_b32 s17, s87
s_mov_b32 s18, 268435456
s_mov_b32 s19, 0x20000
s_xor_b32 s14, s3, 3
s_lshl_b32 s14, s14, 8
s_add_u32 s14, s14, s2
v_lshlrev_b32 v230, 4, v1
v_mov_b64 v[224:225], 0
v_mov_b64 v[226:227], 0
s_cmp_ge_u32 s14, 16
s_cbranch_scc1 .Lz3
s_lshl_b32 s62, s2, 13
s_add_u32 s62, s62, 30408704
s_add_u32 s63, s62, 4096
buffer_store_dwordx4 v[224:227], v230, s[16:19], s62 offen sc1
buffer_store_dwordx4 v[224:227], v230, s[16:19], s62 offen offset:1024 sc1
buffer_store_dwordx4 v[224:227], v230, s[16:19], s62 offen offset:2048 sc1
buffer_store_dwordx4 v[224:227], v230, s[16:19], s62 offen offset:3072 sc1
buffer_store_dwordx4 v[224:227], v230, s[16:19], s63 offen sc1
buffer_store_dwordx4 v[224:227], v230, s[16:19], s63 offen offset:1024 sc1
buffer_store_dwordx4 v[224:227], v230, s[16:19], s63 offen offset:2048 sc1
buffer_store_dwordx4 v[224:227], v230, s[16:19], s63 offen offset:3072 sc1
.Lz3:
buffer_load_dwordx4 v[164:167], v228, s[36:39], 0 offen
buffer_load_dwordx4 v[168:171], v228, s[36:39], 0 offen offset:64
buffer_load_dwordx4 v[172:175], v229, s[36:39], 0 offen
buffer_load_dwordx4 v[176:179], v229, s[36:39], 0 offen offset:64
buffer_load_dword v58, v9, s[20:23], s65 offen
s_mov_b32 s40, s84
s_mov_b32 s41, s85
s_mov_b32 s42, 256
s_mov_b32 s43, 0x20000
s_getpc_b64 s[62:63]
.Lpc:
s_lshl_b32 s64, s5, 12
v_lshrrev_b32 v59, 3, v0
v_lshl_add_u32 v59, v59, 7, s64
v_add_u32 v2, 0x20000, v59
v_min_u32 v2, .Lend-.Lpc, v2
v_min_u32 v59, .Lend-.Lpc, v59
global_load_dword v59, v59, s[62:63]
global_load_dword v58, v2, s[62:63]
s_mov_b32 s24, s72
s_mov_b32 s25, s73
s_mov_b32 s26, 2097152
s_mov_b32 s27, 0x20000
s_mov_b32 s28, s80
s_mov_b32 s29, s81
s_mov_b32 s30, 7340032
s_mov_b32 s31, 0x20000
s_mov_b32 s0, s82
s_mov_b32 s1, s83
s_mov_b32 s32, s76
s_mov_b32 s33, s77
s_mov_b32 s34, 7340032
s_mov_b32 s35, 0x20000
s_mov_b32 s80, s78
s_mov_b32 s81, s79
s_mov_b32 s82, 7340032
s_mov_b32 s83, 0x20000
s_lshr_b32 s10, s4, 2
s_lshl_b32 s10, s10, 2
s_and_b32 s62, s5, 3
s_add_u32 s10, s10, s62
s_and_b32 s11, s4, 3
s_lshl_b32 s11, s11, 3
s_lshr_b32 s62, s5, 2
s_add_u32 s11, s11, s62
s_and_b32 s12, s11, 1
s_lshr_b32 s13, s11, 1
s_mul_i32 s51, s13, 448
s_mul_i32 s62, s12, 192
s_add_u32 s51, s51, s62
s_lshl_b32 s62, s6, 3
s_lshr_b32 s84, s62, 4
s_lshl_b32 s84, s84, 14
s_and_b32 s62, s62, 15
s_lshl_b32 s62, s62, 10
s_add_u32 s84, s84, s62
s_lshl_b32 s62, s8, 3
s_lshr_b32 s85, s62, 4
s_lshl_b32 s85, s85, 14
s_and_b32 s62, s62, 15
s_lshl_b32 s62, s62, 10
s_add_u32 s85, s85, s62
s_lshl_b32 s62, s50, 0
s_lshr_b32 s86, s62, 4
s_lshl_b32 s86, s86, 14
s_and_b32 s62, s62, 15
s_lshl_b32 s62, s62, 10
s_add_u32 s86, s86, s62
s_mul_i32 s62, s8, 393216
s_add_u32 s62, s62, s66
v_mul_u32_u24 v14, 6144, v1
v_add_u32 v14, s62, v14
s_lshl_b32 s62, s8, 4
s_add_u32 s62, s62, s9
s_lshl_b32 s62, s62, 2
s_add_u32 s62, s62, s3
s_mul_i32 s62, s62, 6656
v_min_u32 v15, 51, v1
v_lshl_add_u32 v15, v15, 7, s62
s_sub_u32 s63, s8, 4
s_lshl_b32 s64, s8, 1
s_add_u32 s64, s64, 1
s_cmp_lt_u32 s8, 5
s_cselect_b64 vcc, -1, 0
s_cselect_b32 s46, s64, s63
v_cndmask_b32 v14, v14, v15, vcc
s_lshl_b32 s62, s2, 1
s_add_u32 s62, s62, s48
s_mul_i32 s62, s62, 5376
v_min_u32 v16, 41, v1
v_lshl_add_u32 v16, v16, 7, s62
s_cmp_lt_u32 s46, 6
s_cselect_b64 vcc, -1, 0
v_cndmask_b32 v15, v14, v16, vcc
v_cndmask_b32 v14, v16, v14, vcc
s_cmp_lt_u32 s3, 2
s_cselect_b32 s65, s32, s80
s_cselect_b32 s66, s33, s81
s_cselect_b32 s67, s34, s82
s_cmp_lt_u32 s8, 5
s_cselect_b32 s62, s24, s20
s_cselect_b32 s63, s25, s21
s_cselect_b32 s64, s26, s22
s_sub_u32 s47, s46, 6
s_cmp_lt_u32 s46, 6
s_cselect_b32 s47, s46, s47
s_cselect_b32 s76, s62, s65
s_cselect_b32 s98, s65, s62
s_cselect_b32 s77, s63, s66
s_cselect_b32 s99, s66, s63
s_cselect_b32 s78, s64, s67
s_cselect_b32 s100, s67, s64
s_mov_b32 s79, 0x20000
v_bfe_u32 v24, v1, 1, 3
v_lshrrev_b32 v2, 4, v1
v_xor_b32 v2, v2, v24
v_lshlrev_b32 v2, 4, v2
v_and_b32 v23, 15, v1
v_lshl_add_u32 v23, v23, 7, v2
s_mul_i32 s62, s48, 9216
v_add_u32 v23, s62, v23
v_xor_b32 v30, 64, v23
v_mul_u32_u24 v24, 2304, v24
v_add_u32 v24, v24, v2
v_and_b32 v2, 1, v1
v_lshl_add_u32 v24, v2, 7, v24
v_add_u32 v24, 2048, v24
v_xor_b32 v31, 64, v24
v_and_b32 v2, 15, v1
v_cmp_eq_u32 vcc, 0, v2
v_mov_b32 v2, 18432
s_nop 0
v_cndmask_b32 v24, v24, v2, vcc
v_cndmask_b32 v31, v31, v2, vcc
v_bfe_u32 v25, v1, 3, 2
v_mul_u32_u24 v25, 3104, v25
v_bfe_u32 v2, v1, 2, 1
v_lshl_add_u32 v25, v2, 7, v25
v_bfe_u32 v2, v1, 5, 1
v_lshl_add_u32 v25, v2, 8, v25
v_and_b32 v2, 3, v1
v_lshl_add_u32 v25, v2, 3, v25
s_lshl_b32 s62, s49, 6
s_add_u32 s62, s62, 73984
v_add_u32 v25, s62, v25
s_lshl_b32 s62, s8, 1
s_add_u32 s62, s62, s3
s_lshr_b32 s63, s50, 2
s_cmp_lt_u32 s3, 2
s_cselect_b32 s62, s62, s63
s_lshl_b32 s62, s62, 13
s_cmp_eq_u32 s3, 3
s_cselect_b32 s62, 268435456, s62
v_lshl_add_u32 v26, v1, 4, s62
s_mul_i32 s59, s3, 2080
v_bfe_u32 v5, v1, 3, 1
v_lshrrev_b32 v2, 4, v1
v_lshl_add_u32 v5, v2, 3, v5
s_lshl_b32 s62, s3, 1
v_add_u32 v5, s62, v5
v_mul_u32_u24 v5, 2048, v5
v_and_b32 v2, 7, v1
v_lshl_add_u32 v5, v2, 4, v5
s_lshl_b32 s62, s7, 7
v_add_u32 v5, s62, v5
v_add_u32 v6, 64512, v5
s_lshl_b32 s62, s6, 10
s_add_u32 s62, s62, 30408704
s_lshl_b32 s64, s8, 10
s_add_u32 s64, s64, 30408704
s_lshr_b32 s67, s9, 1
s_and_b32 s67, s67, 3
s_lshl_b32 s67, s67, 7
s_add_u32 s64, s64, s67
s_lshr_b32 s65, s50, 3
s_lshl_b32 s65, s65, 10
s_add_u32 s65, s65, 30408704
s_lshr_b32 s67, s9, 1
s_and_b32 s67, s67, 3
s_lshl_b32 s67, s67, 7
s_add_u32 s65, s65, s67
v_mov_b32 v2, 268435456
v_cmp_eq_u32 vcc, 65, v0
v_mov_b32 v33, s65
s_nop 0
v_cndmask_b32 v33, v2, v33, vcc
v_cndmask_b32 v36, 0, 16, vcc
v_cmp_eq_u32 vcc, 64, v0
v_mov_b32 v32, s64
s_nop 0
v_cndmask_b32 v33, v33, v32, vcc
v_lshl_add_u32 v32, v1, 7, s62
v_cndmask_b32 v34, v2, 0, vcc
v_cndmask_b32 v35, 0, 16, vcc
v_cndmask_b32 v36, v36, 16, vcc
v_lshrrev_b32 v37, 3, v0
v_cmp_eq_u32 vcc, 8, v37
s_nop 1
v_cndmask_b32 v32, v2, v32, vcc
v_mov_b32 v38, 1
v_lshrrev_b32 v2, 4, v1
v_lshlrev_b32 v2, 2, v2
v_and_b32 v13, 15, v1
v_sub_u32 v2, v13, v2
v_mov_b32 v13, 0xff61b1e6
v_subrev_u32 v54, 0, v2
v_cmp_gt_u32 vcc, 8, v54
s_nop 1
v_cndmask_b32 v50, v13, 0, vcc
v_cmp_gt_i32 vcc, -8, v54
s_nop 1
v_cndmask_b32 v46, v13, 0, vcc
v_subrev_u32 v54, 1, v2
v_cmp_gt_u32 vcc, 8, v54
s_nop 1
v_cndmask_b32 v51, v13, 0, vcc
v_cmp_gt_i32 vcc, -8, v54
s_nop 1
v_cndmask_b32 v47, v13, 0, vcc
v_subrev_u32 v54, 2, v2
v_cmp_gt_u32 vcc, 8, v54
s_nop 1
v_cndmask_b32 v52, v13, 0, vcc
v_cmp_gt_i32 vcc, -8, v54
s_nop 1
v_cndmask_b32 v48, v13, 0, vcc
v_subrev_u32 v54, 3, v2
v_cmp_gt_u32 vcc, 8, v54
s_nop 1
v_cndmask_b32 v53, v13, 0, vcc
v_cmp_gt_i32 vcc, -8, v54
s_nop 1
v_cndmask_b32 v49, v13, 0, vcc
s_cmp_lt_u32 s8, 2
s_cselect_b64 vcc, -1, 0
v_cndmask_b32 v54, v46, v13, vcc
v_cndmask_b32 v55, v47, v13, vcc
v_cndmask_b32 v56, v48, v13, vcc
v_cndmask_b32 v57, v49, v13, vcc
s_mov_b32 s75, 29360128
v_and_b32 v10, 15, v1
v_lshlrev_b32 v12, 2, v10
v_lshlrev_b32 v10, 4, v10
v_add_u32 v10, 152576, v10
v_lshrrev_b32 v11, 4, v1
v_lshlrev_b32 v11, 4, v11
s_lshl_b32 s62, s49, 7
s_add_u32 s62, s62, 158720
v_add_u32 v12, s62, v12
v_add_u32 v13, s62, v11
v_add_u32 v11, 156672, v11
s_lshl_b32 s62, s3, 11
s_add_u32 s62, s62, 143360
v_lshl_add_u32 v8, v1, 4, s62
v_xor_b32 v9, 2048, v8
v_mov_b32 v248, 0x3f803f80
v_mov_b32 v249, 0x3f803f80
v_mov_b32 v250, 0x3f803f80
v_mov_b32 v251, 0x3f803f80
s_mul_i32 s62, s3, 18496
s_add_u32 s62, s62, 18432
v_mov_b32 v2, s62
ds_write_b128 v2, v[248:251]
v_and_b32 v7, 31, v1
v_lshrrev_b32 v2, 5, v1
v_lshl_add_u32 v7, v7, 1, v2
v_and_b32 v2, 0xc0, v0
v_add_u32 v7, v7, v2
v_lshlrev_b32 v17, 2, v7
v_add_u32 v17, 156672, v17
v_lshlrev_b32 v7, 4, v7
v_add_u32 v7, 152576, v7
s_lshl_b32 s74, s9, 1
s_add_u32 s74, s74, s49
s_lshl_b32 s74, s74, 17
s_add_u32 s74, s74, s85
s_lshl_b32 s63, s48, 12
s_add_u32 s74, s74, s63
s_add_u32 s74, s74, 4194304
s_mov_b32 s62, 0
v_lshl_add_u32 v4, v1, 4, s62
v_lshrrev_b32 v2, 3, v1
v_cmp_eq_u32 vcc, 3, v2
v_add_u32 v2, 67108480, v4
s_nop 0
v_cndmask_b32 v4, v4, v2, vcc
s_add_u32 m0, s55, 0
s_nop 0
buffer_load_dwordx4 v21, s[36:39], s52 offen lds
buffer_load_dwordx4 v28, s[36:39], s52 offen offset:1024 lds
buffer_load_dword v22, s[36:39], s52 offen offset:2048 lds
s_add_u32 s52, s52, 128
s_add_u32 m0, s55, 2304
s_nop 0
buffer_load_dwordx4 v21, s[36:39], s53 offen lds
buffer_load_dwordx4 v28, s[36:39], s53 offen offset:1024 lds
buffer_load_dword v29, s[36:39], s53 offen offset:2048 lds
s_add_u32 s53, s53, 128
s_add_u32 m0, s56, 123648
s_nop 0
buffer_load_dwordx4 v18, s[20:23], s54 offen lds
buffer_load_dwordx4 v19, s[20:23], s54 offen offset:1024 lds
buffer_load_dwordx4 v20, s[20:23], s54 offen offset:2048 lds
s_add_u32 s54, s54, 196608
s_add_u32 m0, s56, 136064
s_nop 0
buffer_load_dwordx4 v18, s[20:23], s54 offen lds
buffer_load_dwordx4 v19, s[20:23], s54 offen offset:1024 lds
buffer_load_dwordx4 v20, s[20:23], s54 offen offset:2048 lds
s_add_u32 s54, s54, 196608
s_cmp_eq_u32 s48, 1
s_cbranch_scc1 .Lqkv1
s_cmp_lt_u32 s14, 16
s_cselect_b32 s62, 0, 4096
v_mov_b32 v231, 1
v_lshlrev_b32 v232, 8, v1
s_waitcnt vmcnt(18)
v_permlane16_swap_b32 v164, v166
v_permlane16_swap_b32 v165, v167
s_waitcnt vmcnt(17)
v_permlane16_swap_b32 v168, v170
v_permlane16_swap_b32 v169, v171
s_waitcnt vmcnt(16)
v_permlane16_swap_b32 v172, v174
v_permlane16_swap_b32 v173, v175
s_waitcnt vmcnt(15)
v_permlane16_swap_b32 v176, v178
v_permlane16_swap_b32 v177, v179
buffer_atomic_add v231, v232, s[40:43], s62 offen
v_lshlrev_b32 v192, 16, v164
v_and_b32 v193, 0xffff0000, v164
v_lshlrev_b32 v194, 16, v165
v_and_b32 v195, 0xffff0000, v165
v_lshlrev_b32 v196, 16, v166
v_and_b32 v197, 0xffff0000, v166
v_lshlrev_b32 v198, 16, v167
v_and_b32 v199, 0xffff0000, v167
v_lshlrev_b32 v200, 16, v168
v_and_b32 v201, 0xffff0000, v168
v_lshlrev_b32 v202, 16, v169
v_and_b32 v203, 0xffff0000, v169
v_lshlrev_b32 v204, 16, v170
v_and_b32 v205, 0xffff0000, v170
v_lshlrev_b32 v206, 16, v171
v_and_b32 v207, 0xffff0000, v171
v_lshlrev_b32 v208, 16, v172
v_and_b32 v209, 0xffff0000, v172
v_lshlrev_b32 v210, 16, v173
v_and_b32 v211, 0xffff0000, v173
v_lshlrev_b32 v212, 16, v174
v_and_b32 v213, 0xffff0000, v174
v_lshlrev_b32 v214, 16, v175
v_and_b32 v215, 0xffff0000, v175
v_lshlrev_b32 v216, 16, v176
v_and_b32 v217, 0xffff0000, v176
v_lshlrev_b32 v218, 16, v177
v_and_b32 v219, 0xffff0000, v177
v_lshlrev_b32 v220, 16, v178
v_and_b32 v221, 0xffff0000, v178
v_lshlrev_b32 v222, 16, v179
v_and_b32 v223, 0xffff0000, v179
s_lshl_b32 s64, s6, 14
s_lshl_b32 s65, s49, 13
s_add_u32 s64, s64, s65
s_lshl_b32 s65, s7, 9
s_add_u32 s64, s64, s65
s_lshl_b32 s65, s48, 8
s_add_u32 s64, s64, s65
s_add_u32 s64, s64, 29360128
v_and_b32 v188, 31, v1
v_lshlrev_b32 v188, 3, v188
v_lshrrev_b32 v189, 5, v1
v_lshl_add_u32 v188, v189, 28, v188
s_lshl_b32 s62, s7, 18
s_add_u32 s62, s62, 0
s_add_u32 s63, s62, 131072
v_pk_mul_f32 v[182:183], v[192:193], v[192:193]
v_pk_mul_f32 v[186:187], v[208:209], v[208:209]
v_pk_fma_f32 v[182:183], v[194:195], v[194:195], v[182:183]
v_pk_add_f32 v[180:181], v[192:193], v[194:195]
v_pk_fma_f32 v[186:187], v[210:211], v[210:211], v[186:187]
v_pk_add_f32 v[184:185], v[208:209], v[210:211]
v_pk_fma_f32 v[182:183], v[196:197], v[196:197], v[182:183]
v_pk_add_f32 v[180:181], v[180:181], v[196:197]
v_pk_fma_f32 v[186:187], v[212:213], v[212:213], v[186:187]
v_pk_add_f32 v[184:185], v[184:185], v[212:213]
v_pk_fma_f32 v[182:183], v[198:199], v[198:199], v[182:183]
v_pk_add_f32 v[180:181], v[180:181], v[198:199]
v_pk_fma_f32 v[186:187], v[214:215], v[214:215], v[186:187]
v_pk_add_f32 v[184:185], v[184:185], v[214:215]
v_pk_fma_f32 v[182:183], v[200:201], v[200:201], v[182:183]
v_pk_add_f32 v[180:181], v[180:181], v[200:201]
v_pk_fma_f32 v[186:187], v[216:217], v[216:217], v[186:187]
v_pk_add_f32 v[184:185], v[184:185], v[216:217]
v_pk_fma_f32 v[182:183], v[202:203], v[202:203], v[182:183]
v_pk_add_f32 v[180:181], v[180:181], v[202:203]
v_pk_fma_f32 v[186:187], v[218:219], v[218:219], v[186:187]
v_pk_add_f32 v[184:185], v[184:185], v[218:219]
v_pk_fma_f32 v[182:183], v[204:205], v[204:205], v[182:183]
v_pk_add_f32 v[180:181], v[180:181], v[204:205]
v_pk_fma_f32 v[186:187], v[220:221], v[220:221], v[186:187]
v_pk_add_f32 v[184:185], v[184:185], v[220:221]
v_pk_fma_f32 v[182:183], v[206:207], v[206:207], v[182:183]
v_pk_add_f32 v[180:181], v[180:181], v[206:207]
v_pk_fma_f32 v[186:187], v[222:223], v[222:223], v[186:187]
v_pk_add_f32 v[184:185], v[184:185], v[222:223]
v_add_f32 v180, v180, v181
v_add_f32 v182, v182, v183
v_add_f32 v184, v184, v185
v_add_f32 v186, v186, v187
s_nop 0
v_permlane16_swap_b32 v180, v184
v_permlane16_swap_b32 v182, v186
v_add_f32 v180, v180, v184
v_add_f32 v182, v182, v186
s_nop 1
v_permlane32_swap_b32 v180, v182
v_add_f32 v180, v180, v182
s_nop 1
v_permlane32_swap_b32 v180, v181
buffer_store_dwordx2 v[180:181], v188, s[16:19], s64 offen sc1
s_lshl_b32 s62, s2, 10
s_add_u32 s62, s62, 31457280
s_cmp_eq_u32 s3, 0
s_cselect_b32 s62, s62, 268435456
buffer_store_dwordx4 v[224:227], v230, s[16:19], s62 offen sc1
v_accvgpr_write_b32 a224, v192
v_accvgpr_write_b32 a225, v193
v_accvgpr_write_b32 a226, v194
v_accvgpr_write_b32 a227, v195
v_accvgpr_write_b32 a228, v196
v_accvgpr_write_b32 a229, v197
v_accvgpr_write_b32 a230, v198
v_accvgpr_write_b32 a231, v199
v_accvgpr_write_b32 a232, v200
v_accvgpr_write_b32 a233, v201
v_accvgpr_write_b32 a234, v202
v_accvgpr_write_b32 a235, v203
v_accvgpr_write_b32 a236, v204
v_accvgpr_write_b32 a237, v205
v_accvgpr_write_b32 a238, v206
v_accvgpr_write_b32 a239, v207
v_accvgpr_write_b32 a240, v208
v_accvgpr_write_b32 a241, v209
v_accvgpr_write_b32 a242, v210
v_accvgpr_write_b32 a243, v211
v_accvgpr_write_b32 a244, v212
v_accvgpr_write_b32 a245, v213
v_accvgpr_write_b32 a246, v214
v_accvgpr_write_b32 a247, v215
v_accvgpr_write_b32 a248, v216
v_accvgpr_write_b32 a249, v217
v_accvgpr_write_b32 a250, v218
v_accvgpr_write_b32 a251, v219
v_accvgpr_write_b32 a252, v220
v_accvgpr_write_b32 a253, v221
v_accvgpr_write_b32 a254, v222
v_accvgpr_write_b32 a255, v223
s_add_u32 m0, s55, 18496
s_nop 0
buffer_load_dwordx4 v21, s[36:39], s52 offen lds
buffer_load_dwordx4 v28, s[36:39], s52 offen offset:1024 lds
buffer_load_dword v22, s[36:39], s52 offen offset:2048 lds
s_add_u32 s52, s52, 128
s_add_u32 m0, s55, 20800
s_nop 0
buffer_load_dwordx4 v21, s[36:39], s53 offen lds
buffer_load_dwordx4 v28, s[36:39], s53 offen offset:1024 lds
buffer_load_dword v29, s[36:39], s53 offen offset:2048 lds
s_add_u32 s53, s53, 128
s_add_u32 m0, s56, 73984
s_nop 0
buffer_load_dwordx4 v18, s[20:23], s54 offen lds
buffer_load_dwordx4 v19, s[20:23], s54 offen offset:1024 lds
buffer_load_dwordx4 v20, s[20:23], s54 offen offset:2048 lds
s_add_u32 s54, s54, 196608
s_waitcnt vmcnt(15) lgkmcnt(0)
s_barrier
ds_read_b128 a[0:3], v23
RD 4,23,2304
RD 8,23,4608
RD 12,23,6912
TR 20,25,49664
TR 22,25,50176
TR 24,25,49696
TR 26,25,50208
ds_read_b128 a[16:19], v24
TR 28,25,50688
TR 30,25,51200
TR 32,25,50720
TR 34,25,51232
TR 36,25,51712
TR 38,25,52224
TR 40,25,51744
TR 42,25,52256
s_waitcnt vmcnt(12) lgkmcnt(8)
s_barrier
v_mfma_f32_16x16x32_bf16 v[60:63], a[20:23], a[0:3], 0
ds_read_b128 a[44:47], v30
s_add_u32 m0, s56, 86400
v_mfma_f32_16x16x32_bf16 v[76:79], a[24:27], a[0:3], 0
buffer_load_dwordx4 v18, s[20:23], s54 offen lds
v_mfma_f32_16x16x32_bf16 v[80:83], a[24:27], a[4:7], 0
s_sub_u32 s47, s47, 1
s_cbranch_scc1 .Lx4
.Lx4b:
v_mfma_f32_16x16x32_bf16 v[64:67], a[20:23], a[4:7], 0
buffer_load_dwordx4 v19, s[20:23], s54 offen offset:1024 lds
v_mfma_f32_16x16x32_bf16 v[68:71], a[20:23], a[8:11], 0
RD 48,30,2304
v_mfma_f32_16x16x32_bf16 v[84:87], a[24:27], a[8:11], 0
RD 52,30,4608
RD 56,30,6912
v_mfma_f32_16x16x32_bf16 v[88:91], a[24:27], a[12:15], 0
buffer_load_dwordx4 v20, s[20:23], s54 offen offset:2048 lds
v_mfma_f32_16x16x32_bf16 v[72:75], a[20:23], a[12:15], 0
s_add_u32 s54, s54, 196608
s_waitcnt lgkmcnt(4)
v_mfma_f32_16x16x32_bf16 v[244:247], a[20:23], a[16:19], 0
TR 64,25,62080
s_add_u32 m0, s55, 36992
v_mfma_f32_16x16x32_bf16 v[104:107], a[28:31], a[12:15], 0
buffer_load_dwordx4 v21, s[36:39], s52 offen lds
v_mfma_f32_16x16x32_bf16 v[120:123], a[32:35], a[12:15], 0
TR 66,25,62592
v_mfma_f32_16x16x32_bf16 v[116:119], a[32:35], a[8:11], 0
TR 68,25,62112
TR 70,25,62624
v_mfma_f32_16x16x32_bf16 v[100:103], a[28:31], a[8:11], 0
buffer_load_dwordx4 v28, s[36:39], s52 offen offset:1024 lds
v_mfma_f32_16x16x32_bf16 v[96:99], a[28:31], a[4:7], 0
ds_read_b128 a[60:63], v31
v_mfma_f32_16x16x32_bf16 v[112:115], a[32:35], a[4:7], 0
buffer_load_dword v22, s[36:39], s52 offen offset:2048 lds
v_mfma_f32_16x16x32_bf16 v[108:111], a[32:35], a[0:3], 0
TR 72,25,63104
s_add_u32 s52, s52, 128
v_mfma_f32_16x16x32_bf16 v[92:95], a[28:31], a[0:3], 0
s_add_u32 m0, s55, 39296
v_mfma_f32_16x16x32_bf16 v[156:159], a[28:31], a[16:19], 0
buffer_load_dwordx4 v21, s[36:39], s53 offen lds
v_mfma_f32_16x16x32_bf16 v[160:163], a[32:35], a[16:19], 0
TR 74,25,63616
TR 76,25,63136
v_mfma_f32_16x16x32_bf16 v[124:127], a[0:3], a[36:39], 0
TR 78,25,63648
v_mfma_f32_16x16x32_bf16 v[140:143], a[0:3], a[40:43], 0
buffer_load_dwordx4 v28, s[36:39], s53 offen offset:1024 lds
v_mfma_f32_16x16x32_bf16 v[144:147], a[4:7], a[40:43], 0
TR 80,25,64128
v_mfma_f32_16x16x32_bf16 v[128:131], a[4:7], a[36:39], 0
TR 82,25,64640
TR 84,25,64160
v_mfma_f32_16x16x32_bf16 v[132:135], a[8:11], a[36:39], 0
buffer_load_dword v29, s[36:39], s53 offen offset:2048 lds
v_mfma_f32_16x16x32_bf16 v[148:151], a[8:11], a[40:43], 0
s_add_u32 s53, s53, 128
v_mfma_f32_16x16x32_bf16 v[152:155], a[12:15], a[40:43], 0
TR 86,25,64672
v_mfma_f32_16x16x32_bf16 v[136:139], a[12:15], a[36:39], 0
s_waitcnt vmcnt(9) lgkmcnt(8)
s_barrier
MAA 60,64,44
RD 0,23,18496
s_add_u32 m0, s56, 98816
MAA 76,68,44
buffer_load_dwordx4 v18, s[20:23], s54 offen lds
MAA 80,68,48
RD 4,23,20800
MAA 64,64,48
buffer_load_dwordx4 v19, s[20:23], s54 offen offset:1024 lds
MAA 68,64,52
RD 8,23,23104
RD 12,23,25408
MAA 84,68,52
ds_read_b64_tr_b16 a[20:21], v25
MAA 88,68,56
buffer_load_dwordx4 v20, s[20:23], s54 offen offset:2048 lds
MAA 72,64,56
s_add_u32 s54, s54, 196608
s_waitcnt lgkmcnt(5)
MAA 244,64,60
TR 22,25,512
s_add_u32 m0, s56, 111232
MAA 104,72,56
buffer_load_dwordx4 v18, s[20:23], s54 offen lds
MAA 120,76,56
TR 24,25,32
MAA 116,76,52
TR 26,25,544
MAA 100,72,52
buffer_load_dwordx4 v19, s[20:23], s54 offen offset:1024 lds
MAA 96,72,48
RD 16,24,18496
TR 28,25,1024
MAA 112,76,48
buffer_load_dwordx4 v20, s[20:23], s54 offen offset:2048 lds
MAA 108,76,44
s_add_u32 s54, s54, 196608
MAA 92,72,44
TR 30,25,1536
s_add_u32 m0, s55, 55488
MAA 156,72,60
buffer_load_dwordx4 v21, s[36:39], s52 offen lds
MAA 160,76,60
TR 32,25,1056
MAA 124,44,80
TR 34,25,1568
MAA 140,44,84
buffer_load_dwordx4 v28, s[36:39], s52 offen offset:1024 lds
MAA 144,48,84
TR 36,25,2048
MAA 128,48,80
TR 38,25,2560
TR 40,25,2080
MAA 132,52,80
buffer_load_dword v22, s[36:39], s52 offen offset:2048 lds
MAA 148,52,84
s_add_u32 s52, s52, 128
MAA 152,56,84
TR 42,25,2592
MAA 136,56,80
s_waitcnt vmcnt(15) lgkmcnt(8)
s_barrier
MAA 60,20,0
RD 44,30,18496
s_add_u32 m0, s55, 57792
MAA 76,24,0
buffer_load_dwordx4 v21, s[36:39], s53 offen lds
MAA 80,24,4
s_sub_u32 s47, s47, 1
s_cbranch_scc1 .Lx5
.Lx5b:
MAA 64,20,4
buffer_load_dwordx4 v28, s[36:39], s53 offen offset:1024 lds
MAA 68,20,8
RD 48,30,20800
MAA 84,24,8
RD 52,30,23104
RD 56,30,25408
MAA 88,24,12
buffer_load_dword v29, s[36:39], s53 offen offset:2048 lds
MAA 72,20,12
s_add_u32 s53, s53, 128
s_waitcnt lgkmcnt(4)
MAA 244,20,16
TR 64,25,12416
s_add_u32 m0, s56, 123648
MAA 104,28,12
buffer_load_dwordx4 v18, s[20:23], s54 offen lds
MAA 120,32,12
TR 66,25,12928
MAA 116,32,8
TR 68,25,12448
TR 70,25,12960
MAA 100,28,8
buffer_load_dwordx4 v19, s[20:23], s54 offen offset:1024 lds
MAA 96,28,4
RD 60,31,18496
MAA 112,32,4
buffer_load_dwordx4 v20, s[20:23], s54 offen offset:2048 lds
MAA 108,32,0
TR 72,25,13440
s_add_u32 s54, s54, 196608
MAA 92,28,0
s_add_u32 m0, s56, 136064
MAA 156,28,16
buffer_load_dwordx4 v18, s[20:23], s54 offen lds
MAA 160,32,16
TR 74,25,13952
TR 76,25,13472
MAA 124,0,36
TR 78,25,13984
MAA 140,0,40
buffer_load_dwordx4 v19, s[20:23], s54 offen offset:1024 lds
MAA 144,4,40
TR 80,25,14464
MAA 128,4,36
TR 82,25,14976
TR 84,25,14496
MAA 132,8,36
buffer_load_dwordx4 v20, s[20:23], s54 offen offset:2048 lds
MAA 148,8,40
s_add_u32 s54, s54, 196608
MAA 152,12,40
TR 86,25,15008
MAA 136,12,36
s_waitcnt vmcnt(15) lgkmcnt(8)
s_barrier
MAA 60,64,44
RD 0,23,36992
s_add_u32 m0, s55, 0
MAA 76,68,44
buffer_load_dwordx4 v21, s[36:39], s52 offen lds
MAA 80,68,48
RD 4,23,39296
MAA 64,64,48
buffer_load_dwordx4 v28, s[36:39], s52 offen offset:1024 lds
MAA 68,64,52
RD 8,23,41600
RD 12,23,43904
MAA 84,68,52
TR 20,25,24832
MAA 88,68,56
buffer_load_dword v22, s[36:39], s52 offen offset:2048 lds
MAA 72,64,56
s_add_u32 s52, s52, 128
s_add_u32 m0, s55, 2304
s_waitcnt lgkmcnt(5)
MAA 244,64,60
buffer_load_dwordx4 v21, s[36:39], s53 offen lds
MAA 104,72,56
TR 22,25,25344
MAA 120,76,56
TR 24,25,24864
TR 26,25,25376
MAA 116,76,52
buffer_load_dwordx4 v28, s[36:39], s53 offen offset:1024 lds
MAA 100,72,52
RD 16,24,36992
MAA 96,72,48
buffer_load_dword v29, s[36:39], s53 offen offset:2048 lds
MAA 112,76,48
TR 28,25,25856
s_add_u32 s53, s53, 128
MAA 108,76,44
s_add_u32 m0, s56, 73984
MAA 92,72,44
buffer_load_dwordx4 v18, s[20:23], s54 offen lds
MAA 156,72,60
TR 30,25,26368
TR 32,25,25888
MAA 160,76,60
buffer_load_dwordx4 v19, s[20:23], s54 offen offset:1024 lds
MAA 124,44,80
TR 34,25,26400
MAA 140,44,84
TR 36,25,26880
MAA 144,48,84
buffer_load_dwordx4 v20, s[20:23], s54 offen offset:2048 lds
MAA 128,48,80
TR 38,25,27392
s_add_u32 s54, s54, 196608
MAA 132,52,80
buffer_load_dword v37, v34, s[40:43], 0 offen sc1
MAA 148,52,84
TR 40,25,26912
MAA 152,56,84
TR 42,25,27424
MAA 136,56,80
s_waitcnt vmcnt(22) lgkmcnt(8)
s_barrier
MAA 60,20,0
RD 44,30,36992
s_add_u32 m0, s56, 86400
MAA 76,24,0
buffer_load_dwordx4 v18, s[20:23], s54 offen lds
MAA 80,24,4
s_sub_u32 s47, s47, 1
s_cbranch_scc1 .Lx6
.Lx6b:
MAA 64,20,4
buffer_load_dwordx4 v19, s[20:23], s54 offen offset:1024 lds
MAA 68,20,8
RD 48,30,39296
MAA 84,24,8
RD 52,30,41600
RD 56,30,43904
MAA 88,24,12
buffer_load_dwordx4 v20, s[20:23], s54 offen offset:2048 lds
MAA 72,20,12
s_add_u32 s54, s54, 196608
s_waitcnt lgkmcnt(4)
MAA 244,20,16
TR 64,25,37248
s_add_u32 m0, s55, 18496
MAA 104,28,12
buffer_load_dwordx4 v21, s[36:39], s52 offen lds
MAA 120,32,12
TR 66,25,37760
MAA 116,32,8
TR 68,25,37280
TR 70,25,37792
MAA 100,28,8
buffer_load_dwordx4 v28, s[36:39], s52 offen offset:1024 lds
MAA 96,28,4
RD 60,31,36992
MAA 112,32,4
buffer_load_dword v22, s[36:39], s52 offen offset:2048 lds
MAA 108,32,0
TR 72,25,38272
s_add_u32 s52, s52, 128
MAA 92,28,0
s_add_u32 m0, s55, 20800
MAA 156,28,16
buffer_load_dwordx4 v21, s[36:39], s53 offen lds
MAA 160,32,16
TR 74,25,38784
TR 76,25,38304
MAA 124,0,36
TR 78,25,38816
MAA 140,0,40
buffer_load_dwordx4 v28, s[36:39], s53 offen offset:1024 lds
MAA 144,4,40
TR 80,25,39296
MAA 128,4,36
TR 82,25,39808
TR 84,25,39328
MAA 132,8,36
buffer_load_dword v29, s[36:39], s53 offen offset:2048 lds
MAA 148,8,40
s_add_u32 s53, s53, 128
MAA 152,12,40
TR 86,25,39840
MAA 136,12,36
s_waitcnt vmcnt(22) lgkmcnt(8)
s_barrier
MAA 60,64,44
RD 0,23,55488
s_add_u32 m0, s56, 98816
MAA 76,68,44
buffer_load_dwordx4 v18, s[20:23], s54 offen lds
MAA 80,68,48
RD 4,23,57792
MAA 64,64,48
RD 8,23,60096
MAA 68,64,52
RD 12,23,62400
MAA 84,68,52
buffer_load_dwordx4 v19, s[20:23], s54 offen offset:1024 lds
MAA 88,68,56
TR 20,25,49664
MAA 72,64,56
TR 22,25,50176
s_waitcnt lgkmcnt(6)
MAA 244,64,60
MAA 104,72,56
buffer_load_dwordx4 v20, s[20:23], s54 offen offset:2048 lds
MAA 120,76,56
TR 24,25,49696
s_add_u32 s54, s54, 196608
MAA 116,76,52
TR 26,25,50208
MAA 100,72,52
RD 16,24,55488
s_add_u32 m0, s55, 36992
MAA 96,72,48
buffer_load_dwordx4 v21, s[36:39], s52 offen lds
MAA 112,76,48
TR 28,25,50688
MAA 108,76,44
TR 30,25,51200
MAA 92,72,44
TR 32,25,50720
MAA 156,72,60
buffer_load_dwordx4 v28, s[36:39], s52 offen offset:1024 lds
MAA 160,76,60
MAA 124,44,80
TR 34,25,51232
MAA 140,44,84
TR 36,25,51712
MAA 144,48,84
buffer_load_dword v22, s[36:39], s52 offen offset:2048 lds
MAA 128,48,80
TR 38,25,52224
s_add_u32 s52, s52, 128
MAA 132,52,80
TR 40,25,51744
MAA 148,52,84
TR 42,25,52256
MAA 152,56,84
MAA 136,56,80
s_waitcnt vmcnt(25) lgkmcnt(8)
s_barrier
MAA 60,20,0
RD 44,30,55488
s_add_u32 m0, s56, 111232
MAA 76,24,0
buffer_load_dwordx4 v18, s[20:23], s54 offen lds
MAA 80,24,4
s_sub_u32 s47, s47, 1
s_cbranch_scc1 .Lx7
.Lx7b:
MAA 64,20,4
RD 48,30,57792
MAA 68,20,8
RD 52,30,60096
MAA 84,24,8
buffer_load_dwordx4 v19, s[20:23], s54 offen offset:1024 lds
MAA 88,24,12
RD 56,30,62400
MAA 72,20,12
TR 64,25,62080
s_waitcnt lgkmcnt(5)
MAA 244,20,16
TR 66,25,62592
MAA 104,28,12
buffer_load_dwordx4 v20, s[20:23], s54 offen offset:2048 lds
MAA 120,32,12
TR 68,25,62112
s_add_u32 s54, s54, 196608
MAA 116,32,8
TR 70,25,62624
MAA 100,28,8
RD 60,31,55488
s_add_u32 m0, s55, 39296
MAA 96,28,4
buffer_load_dwordx4 v21, s[36:39], s53 offen lds
MAA 112,32,4
MAA 108,32,0
TR 72,25,63104
MAA 92,28,0
TR 74,25,63616
MAA 156,28,16
buffer_load_dwordx4 v28, s[36:39], s53 offen offset:1024 lds
MAA 160,32,16
TR 76,25,63136
MAA 124,0,36
TR 78,25,63648
MAA 140,0,40
TR 80,25,64128
MAA 144,4,40
buffer_load_dword v29, s[36:39], s53 offen offset:2048 lds
MAA 128,4,36
TR 82,25,64640
s_add_u32 s53, s53, 128
MAA 132,8,36
TR 84,25,64160
MAA 148,8,40
TR 86,25,64672
MAA 152,12,40
MAA 136,12,36
s_waitcnt vmcnt(22) lgkmcnt(8)
s_barrier
s_waitcnt vmcnt(21)
v_cmp_gt_u32 vcc, v35, v37
s_nop 0
s_cbranch_vccnz .Lsp8
.Lsp8b:
v_mov_b32 v37, 0
MAA 60,64,44
ds_read_b128 a[0:3], v23
MAA 76,68,44
buffer_atomic_add v38, v32, s[16:19], 0 offen
MAA 80,68,48
RD 4,23,2304
MAA 64,64,48
RD 8,23,4608
s_add_u32 m0, s56, 123648
MAA 68,64,52
buffer_load_dwordx4 v18, s[20:23], s54 offen lds
MAA 84,68,52
RD 12,23,6912
MAA 88,68,56
ds_read_b64_tr_b16 a[20:21], v25
MAA 72,64,56
TR 22,25,512
s_waitcnt lgkmcnt(6)
MAA 244,64,60
buffer_load_dwordx4 v19, s[20:23], s54 offen offset:1024 lds
MAA 104,72,56
TR 24,25,32
MAA 120,76,56
TR 26,25,544
MAA 116,76,52
buffer_load_dwordx4 v20, s[20:23], s54 offen offset:2048 lds
MAA 100,72,52
ds_read_b128 a[16:19], v24
s_add_u32 s54, s54, 196608
MAA 96,72,48
MAA 112,76,48
TR 28,25,1024
s_add_u32 m0, s55, 55488
MAA 108,76,44
buffer_load_dwordx4 v21, s[36:39], s52 offen lds
MAA 92,72,44
TR 30,25,1536
MAA 156,72,60
TR 32,25,1056
MAA 160,76,60
buffer_load_dwordx4 v28, s[36:39], s52 offen offset:1024 lds
MAA 124,44,80
TR 34,25,1568
MAA 140,44,84
TR 36,25,2048
MAA 144,48,84
TR 38,25,2560
MAA 128,48,80
buffer_load_dword v22, s[36:39], s52 offen offset:2048 lds
MAA 132,52,80
TR 40,25,2080
s_add_u32 s52, s52, 128
MAA 148,52,84
TR 42,25,2592
MAA 152,56,84
MAA 136,56,80
s_waitcnt vmcnt(25) lgkmcnt(8)
s_barrier
MAA 60,20,0
ds_read_b128 a[44:47], v30
s_add_u32 m0, s56, 136064
MAA 76,24,0
buffer_load_dwordx4 v18, s[20:23], s54 offen lds
MAA 80,24,4
s_sub_u32 s47, s47, 1
s_cbranch_scc1 .Lx9
.Lx9b:
MAA 64,20,4
RD 48,30,2304
MAA 68,20,8
RD 52,30,4608
MAA 84,24,8
buffer_load_dwordx4 v19, s[20:23], s54 offen offset:1024 lds
MAA 88,24,12
RD 56,30,6912
MAA 72,20,12
TR 64,25,12416
s_waitcnt lgkmcnt(5)
MAA 244,20,16
TR 66,25,12928
MAA 104,28,12
buffer_load_dwordx4 v20, s[20:23], s54 offen offset:2048 lds
MAA 120,32,12
TR 68,25,12448
s_add_u32 s54, s54, 196608
MAA 116,32,8
TR 70,25,12960
MAA 100,28,8
ds_read_b128 a[60:63], v31
s_add_u32 m0, s55, 57792
MAA 96,28,4
buffer_load_dwordx4 v21, s[36:39], s53 offen lds
MAA 112,32,4
MAA 108,32,0
TR 72,25,13440
MAA 92,28,0
TR 74,25,13952
MAA 156,28,16
buffer_load_dwordx4 v28, s[36:39], s53 offen offset:1024 lds
MAA 160,32,16
TR 76,25,13472
MAA 124,0,36
TR 78,25,13984
MAA 140,0,40
TR 80,25,14464
MAA 144,4,40
buffer_load_dword v29, s[36:39], s53 offen offset:2048 lds
MAA 128,4,36
TR 82,25,14976
s_add_u32 s53, s53, 128
MAA 132,8,36
TR 84,25,14496
MAA 148,8,40
TR 86,25,15008
MAA 152,12,40
MAA 136,12,36
s_waitcnt vmcnt(22) lgkmcnt(8)
s_barrier
MAA 60,64,44
RD 0,23,18496
s_add_u32 m0, s56, 73984
MAA 76,68,44
buffer_load_dwordx4 v18, s[20:23], s54 offen lds
MAA 80,68,48
RD 4,23,20800
MAA 64,64,48
RD 8,23,23104
MAA 68,64,52
RD 12,23,25408
MAA 84,68,52
buffer_load_dwordx4 v19, s[20:23], s54 offen offset:1024 lds
MAA 88,68,56
TR 20,25,24832
MAA 72,64,56
TR 22,25,25344
s_waitcnt lgkmcnt(6)
MAA 244,64,60
MAA 104,72,56
buffer_load_dwordx4 v20, s[20:23], s54 offen offset:2048 lds
MAA 120,76,56
TR 24,25,24864
s_add_u32 s54, s54, 196608
MAA 116,76,52
TR 26,25,25376
MAA 100,72,52
RD 16,24,18496
s_add_u32 m0, s55, 0
MAA 96,72,48
buffer_load_dwordx4 v21, s[36:39], s52 offen lds
MAA 112,76,48
TR 28,25,25856
MAA 108,76,44
TR 30,25,26368
MAA 92,72,44
TR 32,25,25888
MAA 156,72,60
buffer_load_dwordx4 v28, s[36:39], s52 offen offset:1024 lds
MAA 160,76,60
MAA 124,44,80
TR 34,25,26400
MAA 140,44,84
TR 36,25,26880
MAA 144,48,84
buffer_load_dword v22, s[36:39], s52 offen offset:2048 lds
MAA 128,48,80
TR 38,25,27392
s_add_u32 s52, s52, 128
MAA 132,52,80
TR 40,25,26912
MAA 148,52,84
TR 42,25,27424
MAA 152,56,84
MAA 136,56,80
s_waitcnt vmcnt(22) lgkmcnt(8)
s_barrier
MAA 60,20,0
RD 44,30,18496
s_add_u32 m0, s56, 86400
MAA 76,24,0
buffer_load_dwordx4 v18, s[20:23], s54 offen lds
MAA 80,24,4
s_sub_u32 s47, s47, 1
s_cbranch_scc1 .Lx10
.Lx10b:
MAA 64,20,4
RD 48,30,20800
MAA 68,20,8
RD 52,30,23104
MAA 84,24,8
buffer_load_dwordx4 v19, s[20:23], s54 offen offset:1024 lds
MAA 88,24,12
RD 56,30,25408
MAA 72,20,12
TR 64,25,37248
s_waitcnt lgkmcnt(5)
MAA 244,20,16
TR 66,25,37760
MAA 104,28,12
buffer_load_dwordx4 v20, s[20:23], s54 offen offset:2048 lds
MAA 120,32,12
TR 68,25,37280
s_add_u32 s54, s54, 196608
MAA 116,32,8
TR 70,25,37792
MAA 100,28,8
RD 60,31,18496
s_add_u32 m0, s55, 2304
MAA 96,28,4
buffer_load_dwordx4 v21, s[36:39], s53 offen lds
MAA 112,32,4
MAA 108,32,0
TR 72,25,38272
MAA 92,28,0
TR 74,25,38784
MAA 156,28,16
buffer_load_dwordx4 v28, s[36:39], s53 offen offset:1024 lds
MAA 160,32,16
TR 76,25,38304
MAA 124,0,36
TR 78,25,38816
MAA 140,0,40
TR 80,25,39296
MAA 144,4,40
buffer_load_dword v29, s[36:39], s53 offen offset:2048 lds
MAA 128,4,36
TR 82,25,39808
s_add_u32 s53, s53, 128
MAA 132,8,36
TR 84,25,39328
MAA 148,8,40
TR 86,25,39840
MAA 152,12,40
MAA 136,12,36
s_waitcnt vmcnt(21) lgkmcnt(8)
s_barrier
MAA 60,64,44
RD 0,23,36992
s_add_u32 m0, s56, 98816
MAA 76,68,44
buffer_load_dwordx4 v18, s[20:23], s54 offen lds
MAA 80,68,48
RD 4,23,39296
MAA 64,64,48
RD 8,23,41600
MAA 68,64,52
RD 12,23,43904
MAA 84,68,52
buffer_load_dwordx4 v19, s[20:23], s54 offen offset:1024 lds
MAA 88,68,56
TR 20,25,49664
MAA 72,64,56
TR 22,25,50176
s_waitcnt lgkmcnt(6)
MAA 244,64,60
MAA 104,72,56
buffer_load_dwordx4 v20, s[20:23], s54 offen offset:2048 lds
MAA 120,76,56
TR 24,25,49696
s_add_u32 s54, s54, 196608
MAA 116,76,52
TR 26,25,50208
MAA 100,72,52
RD 16,24,36992
s_add_u32 m0, s55, 18496
MAA 96,72,48
buffer_load_dwordx4 v21, s[36:39], s52 offen lds
MAA 112,76,48
TR 28,25,50688
MAA 108,76,44
TR 30,25,51200
MAA 92,72,44
TR 32,25,50720
MAA 156,72,60
buffer_load_dwordx4 v28, s[36:39], s52 offen offset:1024 lds
MAA 160,76,60
MAA 124,44,80
TR 34,25,51232
MAA 140,44,84
TR 36,25,51712
MAA 144,48,84
buffer_load_dword v22, s[36:39], s52 offen offset:2048 lds
MAA 128,48,80
TR 38,25,52224
s_add_u32 s52, s52, 128
MAA 132,52,80
TR 40,25,51744
MAA 148,52,84
TR 42,25,52256
MAA 152,56,84
MAA 136,56,80
s_waitcnt vmcnt(21) lgkmcnt(8)
s_barrier
MAA 60,20,0
RD 44,30,36992
s_add_u32 m0, s56, 111232
MAA 76,24,0
buffer_load_dwordx4 v18, s[20:23], s54 offen lds
MAA 80,24,4
s_sub_u32 s47, s47, 1
s_cbranch_scc1 .Lx11
.Lx11b:
MAA 64,20,4
RD 48,30,39296
MAA 68,20,8
buffer_load_dwordx4 v19, s[20:23], s54 offen offset:1024 lds
MAA 84,24,8
RD 52,30,41600
MAA 88,24,12
RD 56,30,43904
MAA 72,20,12
TR 64,25,62080
s_waitcnt lgkmcnt(5)
MAA 244,20,16
buffer_load_dwordx4 v20, s[20:23], s54 offen offset:2048 lds
MAA 104,28,12
TR 66,25,62592
s_add_u32 s54, s54, 196608
MAA 120,32,12
TR 68,25,62112
s_add_u32 m0, s55, 20800
MAA 116,32,8
buffer_load_dwordx4 v21, s[36:39], s53 offen lds
MAA 100,28,8
TR 70,25,62624
MAA 96,28,4
RD 60,31,36992
MAA 112,32,4
TR 72,25,63104
MAA 108,32,0
buffer_load_dwordx4 v28, s[36:39], s53 offen offset:1024 lds
MAA 92,28,0
TR 74,25,63616
MAA 156,28,16
TR 76,25,63136
MAA 160,32,16
buffer_load_dword v29, s[36:39], s53 offen offset:2048 lds
MAA 124,0,36
TR 78,25,63648
s_add_u32 s53, s53, 128
MAA 140,0,40
TR 80,25,64128
MAA 144,4,40
TR 82,25,64640
MAA 128,4,36
buffer_atomic_add v37, v33, s[16:19], 0 offen sc0
MAA 132,8,36
TR 84,25,64160
MAA 148,8,40
TR 86,25,64672
MAA 152,12,40
MAA 136,12,36
s_waitcnt vmcnt(22) lgkmcnt(8)
s_barrier
MAA 60,64,44
RD 0,23,55488
s_add_u32 m0, s56, 123648
MAA 76,68,44
buffer_load_dwordx4 v18, s[20:23], s54 offen lds
MAA 80,68,48
RD 4,23,57792
MAA 64,64,48
RD 8,23,60096
MAA 68,64,52
RD 12,23,62400
MAA 84,68,52
buffer_load_dwordx4 v19, s[20:23], s54 offen offset:1024 lds
MAA 88,68,56
ds_read_b64_tr_b16 a[20:21], v25
MAA 72,64,56
TR 22,25,512
s_waitcnt lgkmcnt(6)
MAA 244,64,60
MAA 104,72,56
buffer_load_dwordx4 v20, s[20:23], s54 offen offset:2048 lds
MAA 120,76,56
TR 24,25,32
s_add_u32 s54, s54, 196608
MAA 116,76,52
TR 26,25,544
MAA 100,72,52
RD 16,24,55488
s_add_u32 m0, s55, 36992
MAA 96,72,48
buffer_load_dwordx4 v21, s[36:39], s52 offen lds
MAA 112,76,48
TR 28,25,1024
MAA 108,76,44
TR 30,25,1536
MAA 92,72,44
TR 32,25,1056
MAA 156,72,60
buffer_load_dwordx4 v28, s[36:39], s52 offen offset:1024 lds
MAA 160,76,60
MAA 124,44,80
TR 34,25,1568
MAA 140,44,84
TR 36,25,2048
MAA 144,48,84
buffer_load_dword v22, s[36:39], s52 offen offset:2048 lds
MAA 128,48,80
TR 38,25,2560
s_add_u32 s52, s52, 128
MAA 132,52,80
TR 40,25,2080
MAA 148,52,84
TR 42,25,2592
MAA 152,56,84
MAA 136,56,80
s_waitcnt vmcnt(22) lgkmcnt(8)
s_barrier
MAA 60,20,0
RD 44,30,55488
s_add_u32 m0, s56, 136064
MAA 76,24,0
buffer_load_dwordx4 v18, s[20:23], s54 offen lds
MAA 80,24,4
s_sub_u32 s47, s47, 1
s_cbranch_scc1 .Lx12
.Lx12b:
MAA 64,20,4
RD 48,30,57792
MAA 68,20,8
RD 52,30,60096
MAA 84,24,8
buffer_load_dwordx4 v19, s[20:23], s54 offen offset:1024 lds
MAA 88,24,12
RD 56,30,62400
MAA 72,20,12
TR 64,25,12416
s_waitcnt lgkmcnt(5)
MAA 244,20,16
TR 66,25,12928
MAA 104,28,12
buffer_load_dwordx4 v20, s[20:23], s54 offen offset:2048 lds
MAA 120,32,12
TR 68,25,12448
s_add_u32 s54, s54, 196608
MAA 116,32,8
TR 70,25,12960
MAA 100,28,8
RD 60,31,55488
s_add_u32 m0, s55, 39296
MAA 96,28,4
buffer_load_dwordx4 v21, s[36:39], s53 offen lds
MAA 112,32,4
MAA 108,32,0
TR 72,25,13440
MAA 92,28,0
TR 74,25,13952
MAA 156,28,16
buffer_load_dwordx4 v28, s[36:39], s53 offen offset:1024 lds
MAA 160,32,16
TR 76,25,13472
MAA 124,0,36
TR 78,25,13984
MAA 140,0,40
TR 80,25,14464
MAA 144,4,40
buffer_load_dword v29, s[36:39], s53 offen offset:2048 lds
MAA 128,4,36
TR 82,25,14976
s_add_u32 s53, s53, 128
MAA 132,8,36
TR 84,25,14496
MAA 148,8,40
TR 86,25,15008
MAA 152,12,40
MAA 136,12,36
s_waitcnt vmcnt(22) lgkmcnt(8)
s_barrier
MAA 60,64,44
ds_read_b128 a[0:3], v23
s_add_u32 m0, s56, 73984
MAA 76,68,44
buffer_load_dwordx4 v18, s[20:23], s54 offen lds
MAA 80,68,48
RD 4,23,2304
MAA 64,64,48
RD 8,23,4608
MAA 68,64,52
RD 12,23,6912
MAA 84,68,52
buffer_load_dwordx4 v19, s[20:23], s54 offen offset:1024 lds
MAA 88,68,56
TR 20,25,24832
MAA 72,64,56
TR 22,25,25344
s_waitcnt lgkmcnt(6)
MAA 244,64,60
MAA 104,72,56
buffer_load_dwordx4 v20, s[20:23], s54 offen offset:2048 lds
MAA 120,76,56
TR 24,25,24864
s_add_u32 s54, s54, 196608
MAA 116,76,52
TR 26,25,25376
MAA 100,72,52
ds_read_b128 a[16:19], v24
s_add_u32 m0, s55, 55488
MAA 96,72,48
buffer_load_dwordx4 v21, s[36:39], s52 offen lds
MAA 112,76,48
TR 28,25,25856
MAA 108,76,44
TR 30,25,26368
MAA 92,72,44
TR 32,25,25888
MAA 156,72,60
buffer_load_dwordx4 v28, s[36:39], s52 offen offset:1024 lds
MAA 160,76,60
MAA 124,44,80
TR 34,25,26400
MAA 140,44,84
TR 36,25,26880
MAA 144,48,84
buffer_load_dword v22, s[36:39], s52 offen offset:2048 lds
MAA 128,48,80
TR 38,25,27392
s_add_u32 s52, s52, 128
MAA 132,52,80
TR 40,25,26912
MAA 148,52,84
TR 42,25,27424
MAA 152,56,84
MAA 136,56,80
s_waitcnt vmcnt(22) lgkmcnt(8)
s_barrier
MAA 60,20,0
ds_read_b128 a[44:47], v30
s_add_u32 m0, s56, 86400
MAA 76,24,0
buffer_load_dwordx4 v18, s[20:23], s54 offen lds
MAA 80,24,4
s_sub_u32 s47, s47, 1
s_cbranch_scc1 .Lx13
.Lx13b:
MAA 64,20,4
RD 48,30,2304
MAA 68,20,8
RD 52,30,4608
MAA 84,24,8
buffer_load_dwordx4 v19, s[20:23], s54 offen offset:1024 lds
MAA 88,24,12
RD 56,30,6912
MAA 72,20,12
TR 64,25,37248
s_waitcnt lgkmcnt(5)
MAA 244,20,16
TR 66,25,37760
MAA 104,28,12
buffer_load_dwordx4 v20, s[20:23], s54 offen offset:2048 lds
MAA 120,32,12
TR 68,25,37280
s_add_u32 s54, s54, 196608
MAA 116,32,8
TR 70,25,37792
MAA 100,28,8
ds_read_b128 a[60:63], v31
s_add_u32 m0, s55, 57792
MAA 96,28,4
buffer_load_dwordx4 v21, s[36:39], s53 offen lds
MAA 112,32,4
MAA 108,32,0
TR 72,25,38272
MAA 92,28,0
TR 74,25,38784
MAA 156,28,16
buffer_load_dwordx4 v28, s[36:39], s53 offen offset:1024 lds
MAA 160,32,16
TR 76,25,38304
MAA 124,0,36
TR 78,25,38816
MAA 140,0,40
TR 80,25,39296
MAA 144,4,40
buffer_load_dword v29, s[36:39], s53 offen offset:2048 lds
MAA 128,4,36
TR 82,25,39808
s_add_u32 s53, s53, 128
MAA 132,8,36
TR 84,25,39328
MAA 148,8,40
TR 86,25,39840
MAA 152,12,40
MAA 136,12,36
s_waitcnt vmcnt(24)
v_cmp_gt_u32 vcc, v36, v37
s_nop 0
s_cbranch_vccnz .Lsp14
.Lsp14b:
s_waitcnt vmcnt(21) lgkmcnt(8)
s_barrier
MAA 60,64,44
RD 0,23,18496
s_add_u32 m0, s56, 98816
MAA 76,68,44
buffer_load_dwordx4 v18, s[20:23], s54 offen lds
MAA 80,68,48
RD 4,23,20800
MAA 64,64,48
RD 8,23,23104
MAA 68,64,52
buffer_load_dwordx4 v19, s[20:23], s54 offen offset:1024 lds
MAA 84,68,52
RD 12,23,25408
MAA 88,68,56
TR 20,25,49664
MAA 72,64,56
TR 22,25,50176
s_waitcnt lgkmcnt(6)
MAA 244,64,60
buffer_load_dwordx4 v20, s[20:23], s54 offen offset:2048 lds
MAA 104,72,56
TR 24,25,49696
s_add_u32 s54, s54, 196608
MAA 120,76,56
TR 26,25,50208
s_add_u32 m0, s55, 0
MAA 116,76,52
buffer_load_dwordx4 v21, s[36:39], s52 offen lds
MAA 100,72,52
RD 16,24,18496
MAA 96,72,48
MAA 112,76,48
TR 28,25,50688
MAA 108,76,44
buffer_load_dwordx4 v28, s[36:39], s52 offen offset:1024 lds
MAA 92,72,44
TR 30,25,51200
MAA 156,72,60
TR 32,25,50720
MAA 160,76,60
buffer_load_dword v22, s[36:39], s52 offen offset:2048 lds
MAA 124,44,80
TR 34,25,51232
s_add_u32 s52, s52, 128
MAA 140,44,84
TR 36,25,51712
MAA 144,48,84
TR 38,25,52224
MAA 128,48,80
buffer_load_dwordx4 v[164:167], v26, s[16:19], s75 offen sc1
MAA 132,52,80
TR 40,25,51744
MAA 148,52,84
TR 42,25,52256
MAA 152,56,84
MAA 136,56,80
s_waitcnt vmcnt(22) lgkmcnt(8)
s_barrier
MAA 60,20,0
RD 44,30,18496
s_add_u32 m0, s56, 111232
MAA 76,24,0
buffer_load_dwordx4 v18, s[20:23], s54 offen lds
MAA 80,24,4
s_sub_u32 s47, s47, 1
s_cbranch_scc1 .Lx15
.Lx15b:
MAA 64,20,4
RD 48,30,20800
MAA 68,20,8
buffer_load_dwordx4 v19, s[20:23], s54 offen offset:1024 lds
MAA 84,24,8
RD 52,30,23104
MAA 88,24,12
RD 56,30,25408
MAA 72,20,12
TR 64,25,62080
s_waitcnt lgkmcnt(5)
MAA 244,20,16
buffer_load_dwordx4 v20, s[20:23], s54 offen offset:2048 lds
MAA 104,28,12
TR 66,25,62592
s_add_u32 s54, s54, 196608
MAA 120,32,12
TR 68,25,62112
s_add_u32 m0, s55, 2304
MAA 116,32,8
buffer_load_dwordx4 v21, s[36:39], s53 offen lds
MAA 100,28,8
TR 70,25,62624
MAA 96,28,4
RD 60,31,18496
MAA 112,32,4
TR 72,25,63104
MAA 108,32,0
buffer_load_dwordx4 v28, s[36:39], s53 offen offset:1024 lds
MAA 92,28,0
TR 74,25,63616
MAA 156,28,16
TR 76,25,63136
MAA 160,32,16
buffer_load_dword v29, s[36:39], s53 offen offset:2048 lds
MAA 124,0,36
TR 78,25,63648
s_add_u32 s53, s53, 128
MAA 140,0,40
TR 80,25,64128
MAA 144,4,40
TR 82,25,64640
MAA 128,4,36
buffer_load_dwordx4 v[168:171], v26, s[16:19], s75 offen offset:1024 sc1
MAA 132,8,36
TR 84,25,64160
MAA 148,8,40
TR 86,25,64672
MAA 152,12,40
MAA 136,12,36
s_waitcnt vmcnt(23) lgkmcnt(8)
s_barrier
MAA 60,64,44
RD 0,23,36992
s_add_u32 m0, s56, 123648
MAA 76,68,44
buffer_load_dwordx4 v18, s[20:23], s54 offen lds
MAA 80,68,48
RD 4,23,39296
MAA 64,64,48
RD 8,23,41600
MAA 68,64,52
buffer_load_dwordx4 v19, s[20:23], s54 offen offset:1024 lds
MAA 84,68,52
RD 12,23,43904
MAA 88,68,56
ds_read_b64_tr_b16 a[20:21], v25
MAA 72,64,56
TR 22,25,512
s_waitcnt lgkmcnt(6)
MAA 244,64,60
buffer_load_dwordx4 v20, s[20:23], s54 offen offset:2048 lds
MAA 104,72,56
TR 24,25,32
s_add_u32 s54, s54, 196608
MAA 120,76,56
TR 26,25,544
s_add_u32 m0, s55, 18496
MAA 116,76,52
buffer_load_dwordx4 v21, s[36:39], s52 offen lds
MAA 100,72,52
RD 16,24,36992
MAA 96,72,48
MAA 112,76,48
TR 28,25,1024
MAA 108,76,44
buffer_load_dwordx4 v28, s[36:39], s52 offen offset:1024 lds
MAA 92,72,44
TR 30,25,1536
MAA 156,72,60
TR 32,25,1056
MAA 160,76,60
buffer_load_dword v22, s[36:39], s52 offen offset:2048 lds
MAA 124,44,80
TR 34,25,1568
s_add_u32 s52, s52, 128
MAA 140,44,84
TR 36,25,2048
MAA 144,48,84
TR 38,25,2560
MAA 128,48,80
buffer_load_dwordx4 v[172:175], v26, s[16:19], s75 offen offset:2048 sc1
MAA 132,52,80
TR 40,25,2080
MAA 148,52,84
TR 42,25,2592
MAA 152,56,84
MAA 136,56,80
s_waitcnt vmcnt(24) lgkmcnt(8)
s_barrier
MAA 60,20,0
RD 44,30,36992
s_add_u32 m0, s56, 136064
MAA 76,24,0
buffer_load_dwordx4 v18, s[20:23], s54 offen lds
MAA 80,24,4
s_sub_u32 s47, s47, 1
s_cbranch_scc1 .Lx16
.Lx16b:
MAA 64,20,4
RD 48,30,39296
MAA 68,20,8
buffer_load_dwordx4 v19, s[20:23], s54 offen offset:1024 lds
MAA 84,24,8
RD 52,30,41600
MAA 88,24,12
RD 56,30,43904
MAA 72,20,12
TR 64,25,12416
s_waitcnt lgkmcnt(5)
MAA 244,20,16
buffer_load_dwordx4 v20, s[20:23], s54 offen offset:2048 lds
MAA 104,28,12
TR 66,25,12928
s_add_u32 s54, s54, 196608
MAA 120,32,12
TR 68,25,12448
s_add_u32 m0, s55, 20800
MAA 116,32,8
buffer_load_dwordx4 v21, s[36:39], s53 offen lds
MAA 100,28,8
TR 70,25,12960
MAA 96,28,4
RD 60,31,36992
MAA 112,32,4
TR 72,25,13440
MAA 108,32,0
buffer_load_dwordx4 v28, s[36:39], s53 offen offset:1024 lds
MAA 92,28,0
TR 74,25,13952
MAA 156,28,16
TR 76,25,13472
MAA 160,32,16
buffer_load_dword v29, s[36:39], s53 offen offset:2048 lds
MAA 124,0,36
TR 78,25,13984
s_add_u32 s53, s53, 128
MAA 140,0,40
TR 80,25,14464
MAA 144,4,40
TR 82,25,14976
MAA 128,4,36
buffer_load_dwordx4 v[176:179], v26, s[16:19], s75 offen offset:3072 sc1
MAA 132,8,36
TR 84,25,14496
s_add_u32 s75, s75, 4096
MAA 148,8,40
TR 86,25,15008
MAA 152,12,40
MAA 136,12,36
s_waitcnt vmcnt(25) lgkmcnt(8)
s_barrier
MAA 60,64,44
RD 0,23,55488
s_add_u32 m0, s56, 73984
MAA 76,68,44
buffer_load_dwordx4 v18, s[20:23], s54 offen lds
MAA 80,68,48
RD 4,23,57792
MAA 64,64,48
RD 8,23,60096
MAA 68,64,52
buffer_load_dwordx4 v19, s[20:23], s54 offen offset:1024 lds
MAA 84,68,52
RD 12,23,62400
MAA 88,68,56
TR 20,25,24832
MAA 72,64,56
TR 22,25,25344
s_waitcnt lgkmcnt(6)
MAA 244,64,60
buffer_load_dwordx4 v20, s[20:23], s54 offen offset:2048 lds
MAA 104,72,56
TR 24,25,24864
s_add_u32 s54, s54, 196608
MAA 120,76,56
TR 26,25,25376
s_add_u32 m0, s55, 36992
MAA 116,76,52
buffer_load_dwordx4 v21, s[36:39], s52 offen lds
MAA 100,72,52
RD 16,24,55488
MAA 96,72,48
MAA 112,76,48
TR 28,25,25856
MAA 108,76,44
buffer_load_dwordx4 v28, s[36:39], s52 offen offset:1024 lds
MAA 92,72,44
TR 30,25,26368
MAA 156,72,60
TR 32,25,25888
MAA 160,76,60
buffer_load_dword v22, s[36:39], s52 offen offset:2048 lds
MAA 124,44,80
TR 34,25,26400
s_add_u32 s52, s52, 128
MAA 140,44,84
TR 36,25,26880
MAA 144,48,84
TR 38,25,27392
MAA 128,48,80
buffer_load_dwordx4 v[180:183], v26, s[16:19], s75 offen sc1
MAA 132,52,80
TR 40,25,26912
MAA 148,52,84
TR 42,25,27424
MAA 152,56,84
MAA 136,56,80
s_waitcnt vmcnt(25) lgkmcnt(8)
s_barrier
MAA 60,20,0
RD 44,30,55488
s_add_u32 m0, s56, 86400
MAA 76,24,0
buffer_load_dwordx4 v18, s[20:23], s54 offen lds
MAA 80,24,4
s_sub_u32 s47, s47, 1
s_cbranch_scc1 .Lx17
.Lx17b:
MAA 64,20,4
RD 48,30,57792
s_waitcnt vmcnt(22)
v_add_f32 v164, v164, v168
MAA 68,20,8
buffer_load_dwordx4 v19, s[20:23], s54 offen offset:1024 lds
MAA 84,24,8
RD 52,30,60096
MAA 88,24,12
RD 56,30,62400
MAA 72,20,12
TR 64,25,37248
s_waitcnt lgkmcnt(5)
MAA 244,20,16
buffer_load_dwordx4 v20, s[20:23], s54 offen offset:2048 lds
MAA 104,28,12
TR 66,25,37760
s_add_u32 s54, s54, 196608
MAA 120,32,12
TR 68,25,37280
s_add_u32 m0, s55, 39296
MAA 116,32,8
buffer_load_dwordx4 v21, s[36:39], s53 offen lds
MAA 100,28,8
TR 70,25,37792
v_add_f32 v165, v165, v169
MAA 96,28,4
RD 60,31,55488
MAA 112,32,4
TR 72,25,38272
MAA 108,32,0
buffer_load_dwordx4 v28, s[36:39], s53 offen offset:1024 lds
MAA 92,28,0
TR 74,25,38784
MAA 156,28,16
TR 76,25,38304
v_add_f32 v166, v166, v170
MAA 160,32,16
buffer_load_dword v29, s[36:39], s53 offen offset:2048 lds
MAA 124,0,36
TR 78,25,38816
s_add_u32 s53, s53, 128
MAA 140,0,40
TR 80,25,39296
MAA 144,4,40
TR 82,25,39808
MAA 128,4,36
buffer_load_dwordx4 v[184:187], v26, s[16:19], s75 offen offset:1024 sc1
MAA 132,8,36
TR 84,25,39328
v_add_f32 v167, v167, v171
MAA 148,8,40
TR 86,25,39840
MAA 152,12,40
MAA 136,12,36
s_waitcnt vmcnt(25) lgkmcnt(8)
s_barrier
MAA 60,64,44
ds_read_b128 a[0:3], v23
s_add_u32 m0, s56, 98816
MAA 76,68,44
buffer_load_dwordx4 v18, s[20:23], s54 offen lds
MAA 80,68,48
RD 4,23,2304
s_waitcnt vmcnt(22)
v_add_f32 v164, v164, v172
MAA 64,64,48
RD 8,23,4608
v_add_f32 v165, v165, v173
MAA 68,64,52
buffer_load_dwordx4 v19, s[20:23], s54 offen offset:1024 lds
MAA 84,68,52
RD 12,23,6912
v_add_f32 v166, v166, v174
MAA 88,68,56
TR 20,25,49664
v_add_f32 v167, v167, v175
MAA 72,64,56
buffer_load_dwordx4 v20, s[20:23], s54 offen offset:2048 lds
s_waitcnt lgkmcnt(5)
MAA 244,64,60
TR 22,25,50176
s_add_u32 s54, s54, 196608
MAA 104,72,56
TR 24,25,49696
s_add_u32 m0, s55, 55488
MAA 120,76,56
buffer_load_dwordx4 v21, s[36:39], s52 offen lds
MAA 116,76,52
TR 26,25,50208
MAA 100,72,52
ds_read_b128 a[16:19], v24
MAA 96,72,48
buffer_load_dwordx4 v28, s[36:39], s52 offen offset:1024 lds
MAA 112,76,48
TR 28,25,50688
MAA 108,76,44
TR 30,25,51200
MAA 92,72,44
buffer_load_dword v22, s[36:39], s52 offen offset:2048 lds
MAA 156,72,60
TR 32,25,50720
s_add_u32 s52, s52, 128
MAA 160,76,60
TR 34,25,51232
MAA 124,44,80
buffer_load_dwordx4 v[188:191], v26, s[16:19], s75 offen offset:2048 sc1
MAA 140,44,84
TR 36,25,51712
MAA 144,48,84
TR 38,25,52224
MAA 128,48,80
TR 40,25,51744
MAA 132,52,80
TR 42,25,52256
MAA 148,52,84
MAA 152,56,84
MAA 136,56,80
s_waitcnt vmcnt(25) lgkmcnt(8)
s_barrier
MAA 60,20,0
ds_read_b128 a[44:47], v30
s_add_u32 m0, s56, 111232
MAA 76,24,0
buffer_load_dwordx4 v18, s[20:23], s54 offen lds
MAA 80,24,4
RD 48,30,2304
s_waitcnt vmcnt(22)
v_add_f32 v164, v164, v176
MAA 64,20,4
RD 52,30,4608
v_add_f32 v165, v165, v177
MAA 68,20,8
buffer_load_dwordx4 v19, s[20:23], s54 offen offset:1024 lds
MAA 84,24,8
RD 56,30,6912
v_add_f32 v166, v166, v178
MAA 88,24,12
TR 64,25,62080
v_add_f32 v167, v167, v179
MAA 72,20,12
buffer_load_dwordx4 v20, s[20:23], s54 offen offset:2048 lds
s_waitcnt lgkmcnt(5)
MAA 244,20,16
TR 66,25,62592
s_add_u32 s54, s54, 196608
MAA 104,28,12
TR 68,25,62112
s_add_u32 m0, s55, 57792
MAA 120,32,12
buffer_load_dwordx4 v21, s[36:39], s53 offen lds
MAA 116,32,8
TR 70,25,62624
MAA 100,28,8
ds_read_b128 a[60:63], v31
MAA 96,28,4
buffer_load_dwordx4 v28, s[36:39], s53 offen offset:1024 lds
MAA 112,32,4
TR 72,25,63104
MAA 108,32,0
TR 74,25,63616
MAA 92,28,0
buffer_load_dword v29, s[36:39], s53 offen offset:2048 lds
MAA 156,28,16
TR 76,25,63136
s_add_u32 s53, s53, 128
MAA 160,32,16
TR 78,25,63648
MAA 124,0,36
buffer_load_dwordx4 v[192:195], v26, s[16:19], s75 offen offset:3072 sc1
MAA 140,0,40
TR 80,25,64128
MAA 144,4,40
TR 82,25,64640
MAA 128,4,36
TR 84,25,64160
MAA 132,8,36
TR 86,25,64672
MAA 148,8,40
MAA 152,12,40
MAA 136,12,36
s_waitcnt vmcnt(25) lgkmcnt(8)
s_barrier
MAA 60,64,44
RD 0,23,18496
s_add_u32 m0, s56, 123648
MAA 76,68,44
buffer_load_dwordx4 v18, s[20:23], s54 offen lds
MAA 80,68,48
RD 4,23,20800
s_waitcnt vmcnt(22)
v_add_f32 v164, v164, v180
MAA 64,64,48
RD 8,23,23104
v_add_f32 v165, v165, v181
MAA 68,64,52
RD 12,23,25408
v_add_f32 v166, v166, v182
MAA 84,68,52
ds_read_b64_tr_b16 a[20:21], v25
v_add_f32 v167, v167, v183
MAA 88,68,56
TR 22,25,512
MAA 72,64,56
TR 24,25,32
s_waitcnt lgkmcnt(7)
MAA 244,64,60
TR 26,25,544
MAA 104,72,56
buffer_load_dwordx4 v19, s[20:23], s54 offen offset:1024 lds
MAA 120,76,56
RD 16,24,18496
MAA 116,76,52
TR 28,25,1024
MAA 100,72,52
TR 30,25,1536
MAA 96,72,48
TR 32,25,1056
MAA 112,76,48
TR 34,25,1568
MAA 108,76,44
TR 36,25,2048
MAA 92,72,44
TR 38,25,2560
MAA 156,72,60
buffer_load_dwordx4 v20, s[20:23], s54 offen offset:2048 lds
MAA 160,76,60
TR 40,25,2080
s_add_u32 s54, s54, 196608
MAA 124,44,80
TR 42,25,2592
MAA 140,44,84
MAA 144,48,84
MAA 128,48,80
MAA 132,52,80
MAA 148,52,84
MAA 152,56,84
MAA 136,56,80
s_waitcnt vmcnt(21) lgkmcnt(8)
s_barrier
MAA 60,20,0
RD 44,30,18496
s_add_u32 m0, s56, 136064
MAA 76,24,0
buffer_load_dwordx4 v18, s[20:23], s54 offen lds
MAA 80,24,4
RD 48,30,20800
s_waitcnt vmcnt(18)
v_add_f32 v164, v164, v184
MAA 64,20,4
RD 52,30,23104
v_add_f32 v165, v165, v185
MAA 68,20,8
RD 56,30,25408
v_add_f32 v166, v166, v186
MAA 84,24,8
TR 64,25,12416
v_add_f32 v167, v167, v187
MAA 88,24,12
TR 66,25,12928
MAA 72,20,12
TR 68,25,12448
s_waitcnt lgkmcnt(7)
MAA 244,20,16
TR 70,25,12960
MAA 104,28,12
buffer_load_dwordx4 v19, s[20:23], s54 offen offset:1024 lds
MAA 120,32,12
RD 60,31,18496
MAA 116,32,8
TR 72,25,13440
MAA 100,28,8
TR 74,25,13952
MAA 96,28,4
TR 76,25,13472
MAA 112,32,4
TR 78,25,13984
MAA 108,32,0
TR 80,25,14464
MAA 92,28,0
TR 82,25,14976
MAA 156,28,16
buffer_load_dwordx4 v20, s[20:23], s54 offen offset:2048 lds
MAA 160,32,16
TR 84,25,14496
s_add_u32 s54, s54, 196608
MAA 124,0,36
TR 86,25,15008
MAA 140,0,40
MAA 144,4,40
MAA 128,4,36
MAA 132,8,36
MAA 148,8,40
MAA 152,12,40
MAA 136,12,36
s_waitcnt vmcnt(17) lgkmcnt(8)
s_barrier
MAA 60,64,44
RD 0,23,36992
s_add_u32 m0, s59, 0
MAA 76,68,44
RD 4,23,39296
s_mov_b32 s58, 1048576
MAA 80,68,48
buffer_load_dwordx4 v5, s[24:27], s58 offen lds
MAA 64,64,48
RD 8,23,41600
s_waitcnt vmcnt(14)
v_add_f32 v164, v164, v188
MAA 68,64,52
RD 12,23,43904
v_add_f32 v165, v165, v189
MAA 84,68,52
TR 20,25,24832
v_add_f32 v166, v166, v190
MAA 88,68,56
buffer_load_dwordx4 v6, s[24:27], s58 offen offset:1024 lds
MAA 72,64,56
TR 22,25,25344
s_add_u32 m0, s59, 8320
s_waitcnt lgkmcnt(6)
MAA 244,64,60
TR 24,25,24864
s_mov_b32 s58, 1179648
MAA 104,72,56
TR 26,25,25376
v_add_f32 v167, v167, v191
MAA 120,76,56
buffer_load_dwordx4 v5, s[24:27], s58 offen lds
MAA 116,76,52
RD 16,24,36992
MAA 100,72,52
TR 28,25,25856
MAA 96,72,48
TR 30,25,26368
MAA 112,76,48
buffer_load_dwordx4 v6, s[24:27], s58 offen offset:1024 lds
MAA 108,76,44
TR 32,25,25888
s_add_u32 m0, s59, 16640
MAA 92,72,44
TR 34,25,26400
s_mov_b32 s58, 1310720
MAA 156,72,60
TR 36,25,26880
MAA 160,76,60
buffer_load_dwordx4 v5, s[24:27], s58 offen lds
MAA 124,44,80
TR 38,25,27392
MAA 140,44,84
TR 40,25,26912
MAA 144,48,84
TR 42,25,27424
MAA 128,48,80
buffer_load_dwordx4 v6, s[24:27], s58 offen offset:1024 lds
MAA 132,52,80
MAA 148,52,84
MAA 152,56,84
MAA 136,56,80
s_waitcnt vmcnt(16) lgkmcnt(8)
s_barrier
MAA 60,20,0
RD 44,30,36992
s_add_u32 m0, s59, 24960
MAA 76,24,0
RD 48,30,39296
s_mov_b32 s58, 1441792
MAA 80,24,4
buffer_load_dwordx4 v5, s[24:27], s58 offen lds
MAA 64,20,4
RD 52,30,41600
s_waitcnt vmcnt(13)
v_add_f32 v164, v164, v192
MAA 68,20,8
RD 56,30,43904
v_add_f32 v165, v165, v193
MAA 84,24,8
TR 64,25,37248
v_add_f32 v166, v166, v194
MAA 88,24,12
buffer_load_dwordx4 v6, s[24:27], s58 offen offset:1024 lds
MAA 72,20,12
TR 66,25,37760
s_add_u32 m0, s59, 74880
s_waitcnt lgkmcnt(6)
MAA 244,20,16
TR 68,25,37280
s_mov_b32 s58, 131072
MAA 104,28,12
TR 70,25,37792
v_add_f32 v167, v167, v195
MAA 120,32,12
buffer_load_dwordx4 v5, s[24:27], s58 offen lds
MAA 116,32,8
RD 60,31,36992
MAA 100,28,8
TR 72,25,38272
MAA 96,28,4
TR 74,25,38784
MAA 112,32,4
buffer_load_dwordx4 v6, s[24:27], s58 offen offset:1024 lds
MAA 108,32,0
TR 76,25,38304
s_add_u32 m0, s59, 83200
MAA 92,28,0
TR 78,25,38816
s_mov_b32 s58, 262144
MAA 156,28,16
TR 80,25,39296
MAA 160,32,16
buffer_load_dwordx4 v5, s[24:27], s58 offen lds
MAA 124,0,36
TR 82,25,39808
MAA 140,0,40
TR 84,25,39328
MAA 144,4,40
TR 86,25,39840
MAA 128,4,36
buffer_load_dwordx4 v6, s[24:27], s58 offen offset:1024 lds
MAA 132,8,36
MAA 148,8,40
MAA 152,12,40
MAA 136,12,36
s_waitcnt vmcnt(15) lgkmcnt(8)
s_barrier
MAA 60,64,44
RD 0,23,55488
s_add_u32 m0, s59, 33280
MAA 76,68,44
RD 4,23,57792
s_mov_b32 s58, 1572864
MAA 80,68,48
buffer_load_dwordx4 v5, s[24:27], s58 offen lds
MAA 64,64,48
RD 8,23,60096
MAA 68,64,52
RD 12,23,62400
MAA 84,68,52
TR 20,25,49664
MAA 88,68,56
buffer_load_dwordx4 v6, s[24:27], s58 offen offset:1024 lds
MAA 72,64,56
TR 22,25,50176
s_add_u32 m0, s59, 41600
s_waitcnt lgkmcnt(6)
MAA 244,64,60
TR 24,25,49696
s_mov_b32 s58, 1703936
MAA 104,72,56
TR 26,25,50208
MAA 120,76,56
buffer_load_dwordx4 v5, s[24:27], s58 offen lds
MAA 116,76,52
RD 16,24,55488
MAA 100,72,52
TR 28,25,50688
MAA 96,72,48
TR 30,25,51200
MAA 112,76,48
buffer_load_dwordx4 v6, s[24:27], s58 offen offset:1024 lds
MAA 108,76,44
TR 32,25,50720
s_add_u32 m0, s59, 91520
MAA 92,72,44
TR 34,25,51232
s_mov_b32 s58, 393216
MAA 156,72,60
TR 36,25,51712
MAA 160,76,60
buffer_load_dwordx4 v5, s[24:27], s58 offen lds
MAA 124,44,80
TR 38,25,52224
MAA 140,44,84
TR 40,25,51744
MAA 144,48,84
TR 42,25,52256
MAA 128,48,80
buffer_load_dwordx4 v6, s[24:27], s58 offen offset:1024 lds
MAA 132,52,80
v_permlane32_swap_b32 v164, v166
MAA 148,52,84
v_permlane32_swap_b32 v165, v167
MAA 152,56,84
v_add_f32 v164, v164, v166
v_add_f32 v165, v165, v167
MAA 136,56,80
v_mul_f32 v164, 0xba800000, v164
v_mul_f32 v165, 0x3a800000, v165
v_fma_f32 v165, -v164, v164, v165
v_max_f32 v165, 0, v165
v_add_f32 v165, 0x3727c5ac, v165
s_waitcnt vmcnt(18) lgkmcnt(8)
s_barrier
MAA 60,20,0
ds_write_b32 v17, v164
s_add_u32 m0, s59, 99840
MAA 76,24,0
RD 44,30,55488
s_mov_b32 s58, 524288
MAA 80,24,4
buffer_load_dwordx4 v5, s[24:27], s58 offen lds
MAA 64,20,4
RD 48,30,57792
MAA 68,20,8
RD 52,30,60096
MAA 84,24,8
RD 56,30,62400
MAA 88,24,12
TR 64,25,62080
MAA 72,20,12
TR 66,25,62592
s_waitcnt lgkmcnt(7)
MAA 244,20,16
buffer_load_dwordx4 v6, s[24:27], s58 offen offset:1024 lds
MAA 104,28,12
TR 68,25,62112
s_add_u32 m0, s59, 108160
MAA 120,32,12
TR 70,25,62624
s_mov_b32 s58, 655360
MAA 116,32,8
RD 60,31,55488
MAA 100,28,8
TR 72,25,63104
MAA 96,28,4
TR 74,25,63616
MAA 112,32,4
buffer_load_dwordx4 v5, s[24:27], s58 offen lds
MAA 108,32,0
TR 76,25,63136
MAA 92,28,0
TR 78,25,63648
MAA 156,28,16
TR 80,25,64128
MAA 160,32,16
TR 82,25,64640
MAA 124,0,36
TR 84,25,64160
MAA 140,0,40
buffer_load_dwordx4 v6, s[24:27], s58 offen offset:1024 lds
MAA 144,4,40
TR 86,25,64672
MAA 128,4,36
v_rsq_f32 v166, v165
MAA 132,8,36
v_mov_b32 v165, v166
v_mul_f32 v166, 0x3e8293ee, v166
MAA 148,8,40
ds_write_b128 v7, v[164:167]
MAA 152,12,40
ds_write_b32 v17, v165 offset:1024
MAA 136,12,36
s_waitcnt lgkmcnt(0)
s_barrier
MAA 244,64,60
ds_read_b128 v[232:235], v10 offset:768
MAA 156,72,60
ds_read_b128 v[236:239], v10 offset:2816
MAA 160,76,60
ds_read_b128 v[228:231], v10 offset:512
MAA 104,72,56
ds_read_b128 v[224:227], v10 offset:256
MAA 120,76,56
ds_read_b128 v[220:223], v10
MAA 136,56,80
MAA 152,56,84
MAA 100,72,52
MAA 116,76,52
s_mov_b32 exec_lo, 0x10001
s_mov_b32 exec_hi, 0x10001
ds_write_b128 v13, v[244:247]
ds_write_b128 v13, v[156:159] offset:256
ds_write_b128 v13, v[160:163] offset:320
s_mov_b64 exec, -1
MAA 96,72,48
MAA 112,76,48
MAA 92,72,44
MAA 108,76,44
MAA 72,64,56
MAA 88,68,56
s_waitcnt lgkmcnt(0)
s_barrier
MAA 132,52,80
ds_read_b128 v[28:31], v13
s_add_u32 m0, s59, 49920
MAA 148,52,84
ds_read_b128 v[32:35], v13 offset:64
s_mov_b32 s58, 1835008
MAA 68,64,52
ds_read_b128 v[36:39], v13 offset:256
MAA 84,68,52
ds_read_b128 v[40:43], v13 offset:320
MAA 128,48,80
ds_read_b32 v44, v12 offset:512
MAA 144,48,84
ds_read_b32 v45, v12 offset:576
MAA 64,64,48
ds_read_b128 v[240:243], v11 offset:192
MAA 80,68,48
ds_read_b128 v[244:247], v11 offset:1216
MAA 124,44,80
buffer_load_dwordx4 v5, s[24:27], s58 offen lds
ds_read_b128 v[18:21], v11 offset:128
s_waitcnt lgkmcnt(8)
v_pk_fma_f32 v[72:73], v[28:29], v[232:233], v[72:73] op_sel_hi:[1,0,1]
v_pk_fma_f32 v[74:75], v[30:31], v[232:233], v[74:75] op_sel_hi:[1,0,1]
s_waitcnt lgkmcnt(6)
v_pk_fma_f32 v[104:105], v[36:37], v[232:233], v[104:105] op_sel_hi:[1,0,1]
v_pk_mul_f32 v[104:105], v[104:105], v[232:233] op_sel:[0,1] op_sel_hi:[1,1]
v_pk_fma_f32 v[106:107], v[38:39], v[232:233], v[106:107] op_sel_hi:[1,0,1]
v_pk_mul_f32 v[106:107], v[106:107], v[232:233] op_sel:[0,1] op_sel_hi:[1,1]
s_waitcnt lgkmcnt(5)
v_pk_fma_f32 v[120:121], v[40:41], v[232:233], v[120:121] op_sel_hi:[1,0,1]
v_pk_mul_f32 v[120:121], v[120:121], v[232:233] op_sel:[0,1] op_sel_hi:[1,1]
v_pk_fma_f32 v[122:123], v[42:43], v[232:233], v[122:123] op_sel_hi:[1,0,1]
v_pk_mul_f32 v[122:123], v[122:123], v[232:233] op_sel:[0,1] op_sel_hi:[1,1]
v_pk_fma_f32 v[100:101], v[36:37], v[228:229], v[100:101] op_sel_hi:[1,0,1]
v_pk_mul_f32 v[100:101], v[100:101], v[228:229] op_sel:[0,1] op_sel_hi:[1,1]
v_pk_fma_f32 v[102:103], v[38:39], v[228:229], v[102:103] op_sel_hi:[1,0,1]
v_pk_mul_f32 v[102:103], v[102:103], v[228:229] op_sel:[0,1] op_sel_hi:[1,1]
v_pk_fma_f32 v[116:117], v[40:41], v[228:229], v[116:117] op_sel_hi:[1,0,1]
v_pk_mul_f32 v[116:117], v[116:117], v[228:229] op_sel:[0,1] op_sel_hi:[1,1]
v_pk_fma_f32 v[118:119], v[42:43], v[228:229], v[118:119] op_sel_hi:[1,0,1]
v_pk_mul_f32 v[118:119], v[118:119], v[228:229] op_sel:[0,1] op_sel_hi:[1,1]
s_waitcnt lgkmcnt(2)
v_pk_fma_f32 v[136:137], v[240:241], v[44:45], v[136:137] op_sel_hi:[1,0,1]
v_pk_fma_f32 v[138:139], v[242:243], v[44:45], v[138:139] op_sel_hi:[1,0,1]
v_pk_fma_f32 v[152:153], v[240:241], v[44:45], v[152:153] op_sel:[0,1,0] op_sel_hi:[1,1,1]
v_pk_fma_f32 v[154:155], v[242:243], v[44:45], v[154:155] op_sel:[0,1,0] op_sel_hi:[1,1,1]
s_waitcnt lgkmcnt(1)
v_pk_mul_f32 v[136:137], v[136:137], v[244:245]
v_pk_mul_f32 v[138:139], v[138:139], v[246:247]
v_pk_mul_f32 v[152:153], v[152:153], v[244:245]
v_pk_mul_f32 v[154:155], v[154:155], v[246:247]
v_pk_fma_f32 v[88:89], v[32:33], v[232:233], v[88:89] op_sel_hi:[1,0,1]
v_pk_fma_f32 v[90:91], v[34:35], v[232:233], v[90:91] op_sel_hi:[1,0,1]
v_pk_fma_f32 v[96:97], v[36:37], v[224:225], v[96:97] op_sel_hi:[1,0,1]
s_waitcnt lgkmcnt(0)
v_pk_fma_f32 v[132:133], v[18:19], v[44:45], v[132:133] op_sel_hi:[1,0,1]
v_pk_fma_f32 v[134:135], v[20:21], v[44:45], v[134:135] op_sel_hi:[1,0,1]
v_pk_fma_f32 v[148:149], v[18:19], v[44:45], v[148:149] op_sel:[0,1,0] op_sel_hi:[1,1,1]
v_pk_fma_f32 v[150:151], v[20:21], v[44:45], v[150:151] op_sel:[0,1,0] op_sel_hi:[1,1,1]
v_pk_mul_f32 v[96:97], v[96:97], v[224:225] op_sel:[0,1] op_sel_hi:[1,1]
v_pk_fma_f32 v[98:99], v[38:39], v[224:225], v[98:99] op_sel_hi:[1,0,1]
v_pk_mul_f32 v[98:99], v[98:99], v[224:225] op_sel:[0,1] op_sel_hi:[1,1]
v_pk_fma_f32 v[112:113], v[40:41], v[224:225], v[112:113] op_sel_hi:[1,0,1]
v_pk_mul_f32 v[112:113], v[112:113], v[224:225] op_sel:[0,1] op_sel_hi:[1,1]
v_pk_fma_f32 v[114:115], v[42:43], v[224:225], v[114:115] op_sel_hi:[1,0,1]
v_pk_mul_f32 v[114:115], v[114:115], v[224:225] op_sel:[0,1] op_sel_hi:[1,1]
v_pk_fma_f32 v[68:69], v[28:29], v[228:229], v[68:69] op_sel_hi:[1,0,1]
v_pk_fma_f32 v[70:71], v[30:31], v[228:229], v[70:71] op_sel_hi:[1,0,1]
v_pk_fma_f32 v[84:85], v[32:33], v[228:229], v[84:85] op_sel_hi:[1,0,1]
v_pk_fma_f32 v[86:87], v[34:35], v[228:229], v[86:87] op_sel_hi:[1,0,1]
v_pk_fma_f32 v[92:93], v[36:37], v[220:221], v[92:93] op_sel_hi:[1,0,1]
v_pk_mul_f32 v[92:93], v[92:93], v[220:221] op_sel:[0,1] op_sel_hi:[1,1]
v_pk_fma_f32 v[94:95], v[38:39], v[220:221], v[94:95] op_sel_hi:[1,0,1]
v_pk_mul_f32 v[94:95], v[94:95], v[220:221] op_sel:[0,1] op_sel_hi:[1,1]
v_pk_fma_f32 v[108:109], v[40:41], v[220:221], v[108:109] op_sel_hi:[1,0,1]
v_pk_mul_f32 v[108:109], v[108:109], v[220:221] op_sel:[0,1] op_sel_hi:[1,1]
v_pk_fma_f32 v[110:111], v[42:43], v[220:221], v[110:111] op_sel_hi:[1,0,1]
v_pk_mul_f32 v[110:111], v[110:111], v[220:221] op_sel:[0,1] op_sel_hi:[1,1]
v_pk_fma_f32 v[64:65], v[28:29], v[224:225], v[64:65] op_sel_hi:[1,0,1]
v_pk_fma_f32 v[66:67], v[30:31], v[224:225], v[66:67] op_sel_hi:[1,0,1]
v_pk_fma_f32 v[80:81], v[32:33], v[224:225], v[80:81] op_sel_hi:[1,0,1]
v_pk_fma_f32 v[82:83], v[34:35], v[224:225], v[82:83] op_sel_hi:[1,0,1]
v_pk_fma_f32 v[156:157], v[36:37], v[236:237], v[156:157] op_sel_hi:[1,0,1]
v_pk_mul_f32 v[156:157], v[156:157], v[236:237] op_sel:[0,1] op_sel_hi:[1,1]
v_pk_fma_f32 v[158:159], v[38:39], v[236:237], v[158:159] op_sel_hi:[1,0,1]
v_pk_mul_f32 v[158:159], v[158:159], v[236:237] op_sel:[0,1] op_sel_hi:[1,1]
v_pk_fma_f32 v[160:161], v[40:41], v[236:237], v[160:161] op_sel_hi:[1,0,1]
v_pk_mul_f32 v[160:161], v[160:161], v[236:237] op_sel:[0,1] op_sel_hi:[1,1]
v_pk_fma_f32 v[162:163], v[42:43], v[236:237], v[162:163] op_sel_hi:[1,0,1]
v_pk_mul_f32 v[162:163], v[162:163], v[236:237] op_sel:[0,1] op_sel_hi:[1,1]
v_cvt_pk_bf16_f32 v196, v104, v105
v_cvt_pk_bf16_f32 v197, v106, v107
MAA 140,44,84
buffer_load_dwordx4 v6, s[24:27], s58 offen offset:1024 lds
MAA 60,64,44
ds_read_b128 v[22:25], v11 offset:1152
v_cvt_pk_bf16_f32 v198, v120, v121
MAA 76,68,44
ds_read_b128 v[240:243], v11 offset:64
v_cvt_pk_bf16_f32 v199, v122, v123
v_cvt_pk_bf16_f32 v208, v136, v137
v_cvt_pk_bf16_f32 v209, v138, v139
v_cvt_pk_bf16_f32 v218, v152, v153
v_cvt_pk_bf16_f32 v219, v154, v155
ds_write_b128 v8, v[196:199]
ds_write_b64 v8, v[208:209] offset:1024
ds_write_b64 v8, v[218:219] offset:1032
s_add_u32 m0, s59, 58240
s_mov_b32 s58, 1966080
buffer_load_dwordx4 v5, s[24:27], s58 offen lds
v_cvt_pk_bf16_f32 v192, v100, v101
v_cvt_pk_bf16_f32 v193, v102, v103
v_cvt_pk_bf16_f32 v194, v116, v117
v_cvt_pk_bf16_f32 v195, v118, v119
v_cvt_pk_bf16_f32 v176, v72, v73
v_cvt_pk_bf16_f32 v177, v74, v75
v_cvt_pk_bf16_f32 v178, v88, v89
v_cvt_pk_bf16_f32 v179, v90, v91
v_pk_fma_f32 v[60:61], v[28:29], v[220:221], v[60:61] op_sel_hi:[1,0,1]
v_pk_fma_f32 v[62:63], v[30:31], v[220:221], v[62:63] op_sel_hi:[1,0,1]
s_waitcnt lgkmcnt(4)
v_pk_mul_f32 v[132:133], v[132:133], v[22:23]
v_pk_mul_f32 v[134:135], v[134:135], v[24:25]
v_pk_mul_f32 v[148:149], v[148:149], v[22:23]
v_pk_mul_f32 v[150:151], v[150:151], v[24:25]
s_waitcnt lgkmcnt(3)
v_pk_fma_f32 v[128:129], v[240:241], v[44:45], v[128:129] op_sel_hi:[1,0,1]
v_pk_fma_f32 v[130:131], v[242:243], v[44:45], v[130:131] op_sel_hi:[1,0,1]
v_pk_fma_f32 v[144:145], v[240:241], v[44:45], v[144:145] op_sel:[0,1,0] op_sel_hi:[1,1,1]
v_pk_fma_f32 v[146:147], v[242:243], v[44:45], v[146:147] op_sel:[0,1,0] op_sel_hi:[1,1,1]
v_pk_fma_f32 v[76:77], v[32:33], v[220:221], v[76:77] op_sel_hi:[1,0,1]
v_pk_fma_f32 v[78:79], v[34:35], v[220:221], v[78:79] op_sel_hi:[1,0,1]
v_cvt_pk_bf16_f32 v206, v132, v133
v_cvt_pk_bf16_f32 v207, v134, v135
v_mfma_f32_16x16x32_bf16 v[104:107], v[192:195], v[176:179], v[46:49]
buffer_load_dwordx4 v6, s[24:27], s58 offen offset:1024 lds
v_mfma_f32_16x16x32_bf16 v[120:123], v[196:199], v[176:179], v[50:53]
s_waitcnt lgkmcnt(0)
s_barrier
ds_read_b64 v[200:201], v9 offset:1024
ds_read_b64 v[210:211], v9 offset:1032
s_add_u32 m0, s59, 66560
s_mov_b32 s58, 0
v_cvt_pk_bf16_f32 v216, v148, v149
v_cvt_pk_bf16_f32 v217, v150, v151
v_max3_f32 v88, v104, v105, v106
v_max3_f32 v89, v107, v120, v121
v_max3_f32 v88, v88, v122, v123
buffer_load_dwordx4 v5, s[24:27], s58 offen lds
v_max_f32 v90, v88, v89
v_max_f32 v89, v88, v89
v_cvt_pk_bf16_f32 v188, v96, v97
v_cvt_pk_bf16_f32 v189, v98, v99
v_permlane16_swap_b32 v90, v89
v_cvt_pk_bf16_f32 v190, v112, v113
v_max_f32 v88, v90, v89
v_max_f32 v89, v90, v89
v_cvt_pk_bf16_f32 v191, v114, v115
v_cvt_pk_bf16_f32 v172, v68, v69
v_permlane32_swap_b32 v88, v89
v_cvt_pk_bf16_f32 v173, v70, v71
buffer_load_dwordx4 v6, s[24:27], s58 offen offset:1024 lds
s_add_u32 m0, s59, 116480
s_mov_b32 s58, 786432
v_max_f32 v88, v88, v89
v_mul_f32 v88, v88, v234
v_pk_fma_f32 v[104:105], v[104:105], v[234:235], v[88:89] op_sel_hi:[1,0,0] neg_lo:[0,0,1] neg_hi:[0,0,1]
v_pk_fma_f32 v[106:107], v[106:107], v[234:235], v[88:89] op_sel_hi:[1,0,0] neg_lo:[0,0,1] neg_hi:[0,0,1]
v_pk_fma_f32 v[120:121], v[120:121], v[234:235], v[88:89] op_sel_hi:[1,0,0] neg_lo:[0,0,1] neg_hi:[0,0,1]
v_pk_fma_f32 v[122:123], v[122:123], v[234:235], v[88:89] op_sel_hi:[1,0,0] neg_lo:[0,0,1] neg_hi:[0,0,1]
v_exp_f32 v104, v104
v_exp_f32 v105, v105
v_exp_f32 v106, v106
v_exp_f32 v107, v107
v_exp_f32 v120, v120
v_exp_f32 v121, v121
v_exp_f32 v122, v122
v_exp_f32 v123, v123
v_cvt_pk_bf16_f32 v72, v104, v105
buffer_load_dwordx4 v5, s[24:27], s58 offen lds
v_cvt_pk_bf16_f32 v73, v106, v107
v_cvt_pk_bf16_f32 v74, v120, v121
v_cvt_pk_bf16_f32 v75, v122, v123
v_cvt_pk_bf16_f32 v174, v84, v85
v_cvt_pk_bf16_f32 v175, v86, v87
v_mfma_f32_16x16x32_bf16 v[88:91], v[248:251], v[72:75], 0
ds_read_b128 v[244:247], v11 offset:1088
v_cvt_pk_bf16_f32 v184, v92, v93
v_mfma_f32_16x16x32_bf16 v[104:107], v[206:209], v[72:75], 0
ds_read_b128 v[18:21], v11
v_cvt_pk_bf16_f32 v185, v94, v95
v_mfma_f32_16x16x32_bf16 v[120:123], v[216:219], v[72:75], 0
buffer_load_dwordx4 v6, s[24:27], s58 offen offset:1024 lds
v_mfma_f32_16x16x32_bf16 v[100:103], v[188:191], v[172:175], v[46:49]
ds_read_b128 v[22:25], v11 offset:1024
s_add_u32 m0, s59, 124800
v_mfma_f32_16x16x32_bf16 v[116:119], v[192:195], v[172:175], v[50:53]
s_mov_b32 s58, 917504
v_rcp_f32 v88, v88
v_cvt_pk_bf16_f32 v186, v108, v109
s_nop 1
v_max3_f32 v84, v100, v101, v102
v_cvt_pk_bf16_f32 v187, v110, v111
v_pk_mul_f32 v[104:105], v[104:105], v[88:89] op_sel_hi:[1,0]
v_pk_mul_f32 v[106:107], v[106:107], v[88:89] op_sel_hi:[1,0]
buffer_load_dwordx4 v5, s[24:27], s58 offen lds
v_pk_mul_f32 v[120:121], v[120:121], v[88:89] op_sel_hi:[1,0]
v_pk_mul_f32 v[122:123], v[122:123], v[88:89] op_sel_hi:[1,0]
v_cvt_pk_bf16_f32 v176, v104, v105
v_cvt_pk_bf16_f32 v177, v106, v107
v_cvt_pk_bf16_f32 v178, v120, v121
v_cvt_pk_bf16_f32 v179, v122, v123
s_waitcnt lgkmcnt(2)
v_pk_mul_f32 v[128:129], v[128:129], v[244:245]
v_cvt_pk_bf16_f32 v204, v128, v129
v_pk_mul_f32 v[130:131], v[130:131], v[246:247]
v_cvt_pk_bf16_f32 v205, v130, v131
v_pk_mul_f32 v[144:145], v[144:145], v[244:245]
v_cvt_pk_bf16_f32 v214, v144, v145
v_pk_mul_f32 v[146:147], v[146:147], v[246:247]
buffer_load_dwordx4 v6, s[24:27], s58 offen offset:1024 lds
v_cvt_pk_bf16_f32 v215, v146, v147
v_max3_f32 v85, v103, v116, v117
v_max3_f32 v84, v84, v118, v119
v_max_f32 v86, v84, v85
v_max_f32 v85, v84, v85
v_cvt_pk_bf16_f32 v168, v64, v65
v_cvt_pk_bf16_f32 v169, v66, v67
v_permlane16_swap_b32 v86, v85
v_cvt_pk_bf16_f32 v170, v80, v81
v_max_f32 v84, v86, v85
v_max_f32 v85, v86, v85
v_cvt_pk_bf16_f32 v171, v82, v83
s_waitcnt lgkmcnt(1)
v_pk_fma_f32 v[124:125], v[18:19], v[44:45], v[124:125] op_sel_hi:[1,0,1]
s_waitcnt lgkmcnt(0)
v_pk_mul_f32 v[124:125], v[124:125], v[22:23]
v_pk_fma_f32 v[126:127], v[20:21], v[44:45], v[126:127] op_sel_hi:[1,0,1]
v_pk_mul_f32 v[126:127], v[126:127], v[24:25]
v_pk_fma_f32 v[140:141], v[18:19], v[44:45], v[140:141] op_sel:[0,1,0] op_sel_hi:[1,1,1]
v_pk_mul_f32 v[140:141], v[140:141], v[22:23]
v_pk_fma_f32 v[142:143], v[20:21], v[44:45], v[142:143] op_sel:[0,1,0] op_sel_hi:[1,1,1]
v_pk_mul_f32 v[142:143], v[142:143], v[24:25]
v_permlane32_swap_b32 v84, v85
s_nop 0
v_mfma_f32_16x16x32_bf16 v[96:99], v[184:187], v[168:171], v[46:49]
buffer_store_dwordx4 v[176:179], v4, s[16:19], s74 offen offset:3072 sc1
v_mfma_f32_16x16x32_bf16 v[112:115], v[188:191], v[168:171], v[50:53]
v_max_f32 v84, v84, v85
v_mul_f32 v84, v84, v230
v_cvt_pk_bf16_f32 v202, v124, v125
v_cvt_pk_bf16_f32 v203, v126, v127
v_cvt_pk_bf16_f32 v212, v140, v141
v_pk_fma_f32 v[100:101], v[100:101], v[230:231], v[84:85] op_sel_hi:[1,0,0] neg_lo:[0,0,1] neg_hi:[0,0,1]
v_pk_fma_f32 v[102:103], v[102:103], v[230:231], v[84:85] op_sel_hi:[1,0,0] neg_lo:[0,0,1] neg_hi:[0,0,1]
v_pk_fma_f32 v[116:117], v[116:117], v[230:231], v[84:85] op_sel_hi:[1,0,0] neg_lo:[0,0,1] neg_hi:[0,0,1]
v_pk_fma_f32 v[118:119], v[118:119], v[230:231], v[84:85] op_sel_hi:[1,0,0] neg_lo:[0,0,1] neg_hi:[0,0,1]
v_exp_f32 v100, v100
v_exp_f32 v101, v101
v_exp_f32 v102, v102
v_exp_f32 v103, v103
v_exp_f32 v116, v116
v_exp_f32 v117, v117
v_exp_f32 v118, v118
v_exp_f32 v119, v119
v_cvt_pk_bf16_f32 v68, v100, v101
v_cvt_pk_bf16_f32 v69, v102, v103
v_cvt_pk_bf16_f32 v70, v116, v117
v_cvt_pk_bf16_f32 v71, v118, v119
v_cvt_pk_bf16_f32 v213, v142, v143
v_max3_f32 v80, v96, v97, v98
v_mfma_f32_16x16x32_bf16 v[84:87], v[248:251], v[68:71], 0
v_max3_f32 v81, v99, v112, v113
v_max3_f32 v80, v80, v114, v115
v_mfma_f32_16x16x32_bf16 v[100:103], v[204:207], v[68:71], 0
v_max_f32 v82, v80, v81
v_max_f32 v81, v80, v81
v_mfma_f32_16x16x32_bf16 v[116:119], v[214:217], v[68:71], 0
s_nop 1
v_rcp_f32 v84, v84
v_permlane16_swap_b32 v82, v81
v_cvt_pk_bf16_f32 v180, v156, v157
v_pk_mul_f32 v[100:101], v[100:101], v[84:85] op_sel_hi:[1,0]
v_pk_mul_f32 v[102:103], v[102:103], v[84:85] op_sel_hi:[1,0]
s_nop 0
v_pk_mul_f32 v[116:117], v[116:117], v[84:85] op_sel_hi:[1,0]
v_pk_mul_f32 v[118:119], v[118:119], v[84:85] op_sel_hi:[1,0]
v_cvt_pk_bf16_f32 v172, v100, v101
v_cvt_pk_bf16_f32 v173, v102, v103
v_cvt_pk_bf16_f32 v174, v116, v117
v_cvt_pk_bf16_f32 v175, v118, v119
buffer_store_dwordx4 v[172:175], v4, s[16:19], s74 offen offset:2048 sc1
v_max_f32 v80, v82, v81
v_max_f32 v81, v82, v81
v_cvt_pk_bf16_f32 v181, v158, v159
v_cvt_pk_bf16_f32 v182, v160, v161
v_permlane32_swap_b32 v80, v81
v_cvt_pk_bf16_f32 v183, v162, v163
v_max_f32 v80, v80, v81
v_mul_f32 v80, v80, v226
v_pk_fma_f32 v[96:97], v[96:97], v[226:227], v[80:81] op_sel_hi:[1,0,0] neg_lo:[0,0,1] neg_hi:[0,0,1]
v_pk_fma_f32 v[98:99], v[98:99], v[226:227], v[80:81] op_sel_hi:[1,0,0] neg_lo:[0,0,1] neg_hi:[0,0,1]
v_pk_fma_f32 v[112:113], v[112:113], v[226:227], v[80:81] op_sel_hi:[1,0,0] neg_lo:[0,0,1] neg_hi:[0,0,1]
v_pk_fma_f32 v[114:115], v[114:115], v[226:227], v[80:81] op_sel_hi:[1,0,0] neg_lo:[0,0,1] neg_hi:[0,0,1]
v_exp_f32 v96, v96
v_exp_f32 v97, v97
v_exp_f32 v98, v98
v_exp_f32 v99, v99
v_exp_f32 v112, v112
v_exp_f32 v113, v113
v_exp_f32 v114, v114
v_exp_f32 v115, v115
v_cvt_pk_bf16_f32 v64, v96, v97
v_cvt_pk_bf16_f32 v65, v98, v99
v_cvt_pk_bf16_f32 v66, v112, v113
v_cvt_pk_bf16_f32 v67, v114, v115
v_cvt_pk_bf16_f32 v164, v60, v61
v_cvt_pk_bf16_f32 v165, v62, v63
v_mfma_f32_16x16x32_bf16 v[80:83], v[248:251], v[64:67], 0
v_cvt_pk_bf16_f32 v166, v76, v77
v_cvt_pk_bf16_f32 v167, v78, v79
v_mfma_f32_16x16x32_bf16 v[96:99], v[202:205], v[64:67], 0
v_mfma_f32_16x16x32_bf16 v[112:115], v[212:215], v[64:67], 0
s_nop 3
v_rcp_f32 v80, v80
v_mfma_f32_16x16x32_bf16 v[92:95], v[180:183], v[164:167], v[54:57]
v_mfma_f32_16x16x32_bf16 v[108:111], v[184:187], v[164:167], v[50:53]
s_nop 6
v_max3_f32 v76, v92, v93, v94
v_pk_mul_f32 v[96:97], v[96:97], v[80:81] op_sel_hi:[1,0]
v_pk_mul_f32 v[98:99], v[98:99], v[80:81] op_sel_hi:[1,0]
v_pk_mul_f32 v[112:113], v[112:113], v[80:81] op_sel_hi:[1,0]
v_pk_mul_f32 v[114:115], v[114:115], v[80:81] op_sel_hi:[1,0]
v_cvt_pk_bf16_f32 v168, v96, v97
v_cvt_pk_bf16_f32 v169, v98, v99
v_cvt_pk_bf16_f32 v170, v112, v113
v_cvt_pk_bf16_f32 v171, v114, v115
buffer_store_dwordx4 v[168:171], v4, s[16:19], s74 offen offset:1024 sc1
v_max3_f32 v77, v95, v108, v109
v_max3_f32 v76, v76, v110, v111
v_max_f32 v78, v76, v77
v_max_f32 v77, v76, v77
s_nop 1
v_permlane16_swap_b32 v78, v77
v_max_f32 v76, v78, v77
v_max_f32 v77, v78, v77
s_nop 1
v_permlane32_swap_b32 v76, v77
v_max_f32 v76, v76, v77
v_mul_f32 v76, v76, v222
v_pk_fma_f32 v[92:93], v[92:93], v[222:223], v[76:77] op_sel_hi:[1,0,0] neg_lo:[0,0,1] neg_hi:[0,0,1]
v_pk_fma_f32 v[94:95], v[94:95], v[222:223], v[76:77] op_sel_hi:[1,0,0] neg_lo:[0,0,1] neg_hi:[0,0,1]
v_pk_fma_f32 v[108:109], v[108:109], v[222:223], v[76:77] op_sel_hi:[1,0,0] neg_lo:[0,0,1] neg_hi:[0,0,1]
v_pk_fma_f32 v[110:111], v[110:111], v[222:223], v[76:77] op_sel_hi:[1,0,0] neg_lo:[0,0,1] neg_hi:[0,0,1]
v_exp_f32 v92, v92
v_exp_f32 v93, v93
v_exp_f32 v94, v94
v_exp_f32 v95, v95
v_exp_f32 v108, v108
v_exp_f32 v109, v109
v_exp_f32 v110, v110
v_exp_f32 v111, v111
v_cvt_pk_bf16_f32 v60, v92, v93
v_cvt_pk_bf16_f32 v61, v94, v95
v_cvt_pk_bf16_f32 v62, v108, v109
v_cvt_pk_bf16_f32 v63, v110, v111
s_nop 1
v_mfma_f32_16x16x32_bf16 v[76:79], v[248:251], v[60:63], 0
v_mfma_f32_16x16x32_bf16 v[92:95], v[200:203], v[60:63], 0
v_mfma_f32_16x16x32_bf16 v[108:111], v[210:213], v[60:63], 0
s_nop 5
v_rcp_f32 v76, v76
s_nop 0
v_pk_mul_f32 v[92:93], v[92:93], v[76:77] op_sel_hi:[1,0]
v_pk_mul_f32 v[94:95], v[94:95], v[76:77] op_sel_hi:[1,0]
v_pk_mul_f32 v[108:109], v[108:109], v[76:77] op_sel_hi:[1,0]
v_pk_mul_f32 v[110:111], v[110:111], v[76:77] op_sel_hi:[1,0]
v_cvt_pk_bf16_f32 v164, v92, v93
v_cvt_pk_bf16_f32 v165, v94, v95
v_cvt_pk_bf16_f32 v166, v108, v109
v_cvt_pk_bf16_f32 v167, v110, v111
buffer_store_dwordx4 v[164:167], v4, s[16:19], s74 offen sc1
s_nop 1
s_branch .Lqkve2
.Lx4:
buffer_load_dword v27, v14, s[76:79], 0 offen
s_mov_b32 s76, s98
s_mov_b32 s77, s99
s_mov_b32 s78, s100
v_mov_b32 v14, v15
s_mov_b32 s47, 5
s_branch .Lx4b
.Lx5:
buffer_load_dword v27, v14, s[76:79], 0 offen
s_mov_b32 s76, s98
s_mov_b32 s77, s99
s_mov_b32 s78, s100
v_mov_b32 v14, v15
s_mov_b32 s47, 5
s_branch .Lx5b
.Lx6:
buffer_load_dword v27, v14, s[76:79], 0 offen
s_mov_b32 s76, s98
s_mov_b32 s77, s99
s_mov_b32 s78, s100
v_mov_b32 v14, v15
s_mov_b32 s47, 5
s_branch .Lx6b
.Lx7:
buffer_load_dword v27, v14, s[76:79], 0 offen
s_mov_b32 s76, s98
s_mov_b32 s77, s99
s_mov_b32 s78, s100
v_mov_b32 v14, v15
s_mov_b32 s47, 5
s_branch .Lx7b
.Lsp8:
s_mov_b32 s15, 0
.Lsp8l:
v_mov_b32 v37, 0
buffer_atomic_add v37, v34, s[40:43], 0 offen sc0
s_add_u32 s15, s15, 1
s_cmp_gt_u32 s15, 100000
s_waitcnt vmcnt(0)
s_cbranch_scc1 .Lsp8b
v_cmp_gt_u32 vcc, v35, v37
s_nop 0
s_cbranch_vccnz .Lsp8l
s_branch .Lsp8b
.Lx9:
buffer_load_dword v27, v14, s[76:79], 0 offen
s_mov_b32 s76, s98
s_mov_b32 s77, s99
s_mov_b32 s78, s100
v_mov_b32 v14, v15
s_mov_b32 s47, 5
s_branch .Lx9b
.Lx10:
buffer_load_dword v27, v14, s[76:79], 0 offen
s_mov_b32 s76, s98
s_mov_b32 s77, s99
s_mov_b32 s78, s100
v_mov_b32 v14, v15
s_mov_b32 s47, 5
s_branch .Lx10b
.Lx11:
buffer_load_dword v27, v14, s[76:79], 0 offen
s_mov_b32 s76, s98
s_mov_b32 s77, s99
s_mov_b32 s78, s100
v_mov_b32 v14, v15
s_mov_b32 s47, 5
s_branch .Lx11b
.Lx12:
buffer_load_dword v27, v14, s[76:79], 0 offen
s_mov_b32 s76, s98
s_mov_b32 s77, s99
s_mov_b32 s78, s100
v_mov_b32 v14, v15
s_mov_b32 s47, 5
s_branch .Lx12b
.Lx13:
buffer_load_dword v27, v14, s[76:79], 0 offen
s_mov_b32 s76, s98
s_mov_b32 s77, s99
s_mov_b32 s78, s100
v_mov_b32 v14, v15
s_mov_b32 s47, 5
s_branch .Lx13b
.Lsp14:
s_mov_b32 s15, 0
.Lsp14l:
v_mov_b32 v37, 0
buffer_atomic_add v37, v33, s[16:19], 0 offen sc0
s_add_u32 s15, s15, 1
s_cmp_gt_u32 s15, 100000
s_waitcnt vmcnt(0)
s_cbranch_scc1 .Lsp14b
v_cmp_gt_u32 vcc, v36, v37
s_nop 0
s_cbranch_vccnz .Lsp14l
s_branch .Lsp14b
.Lx15:
buffer_load_dword v27, v14, s[76:79], 0 offen
s_mov_b32 s76, s98
s_mov_b32 s77, s99
s_mov_b32 s78, s100
v_mov_b32 v14, v15
s_mov_b32 s47, 5
s_branch .Lx15b
.Lx16:
buffer_load_dword v27, v14, s[76:79], 0 offen
s_mov_b32 s76, s98
s_mov_b32 s77, s99
s_mov_b32 s78, s100
v_mov_b32 v14, v15
s_mov_b32 s47, 5
s_branch .Lx16b
.Lx17:
buffer_load_dword v27, v14, s[76:79], 0 offen
s_mov_b32 s76, s98
s_mov_b32 s77, s99
s_mov_b32 s78, s100
v_mov_b32 v14, v15
s_mov_b32 s47, 5
s_branch .Lx17b
.Lx19:
buffer_load_dword v27, v14, s[76:79], 0 offen
s_mov_b32 s76, s98
s_mov_b32 s77, s99
s_mov_b32 s78, s100
v_mov_b32 v14, v15
s_mov_b32 s47, 5
s_branch .Lx19b
.Lx20:
buffer_load_dword v27, v14, s[76:79], 0 offen
s_mov_b32 s76, s98
s_mov_b32 s77, s99
s_mov_b32 s78, s100
v_mov_b32 v14, v15
s_mov_b32 s47, 5
s_branch .Lx20b
.Lx21:
buffer_load_dword v27, v14, s[76:79], 0 offen
s_mov_b32 s76, s98
s_mov_b32 s77, s99
s_mov_b32 s78, s100
v_mov_b32 v14, v15
s_mov_b32 s47, 5
s_branch .Lx21b
.Lx22:
buffer_load_dword v27, v14, s[76:79], 0 offen
s_mov_b32 s76, s98
s_mov_b32 s77, s99
s_mov_b32 s78, s100
v_mov_b32 v14, v15
s_mov_b32 s47, 5
s_branch .Lx22b
.Lsp23:
s_mov_b32 s15, 0
.Lsp23l:
v_mov_b32 v37, 0
buffer_atomic_add v37, v34, s[40:43], 0 offen sc0
s_add_u32 s15, s15, 1
s_cmp_gt_u32 s15, 100000
s_waitcnt vmcnt(0)
s_cbranch_scc1 .Lsp23b
v_cmp_gt_u32 vcc, v35, v37
s_nop 0
s_cbranch_vccnz .Lsp23l
s_branch .Lsp23b
.Lx24:
buffer_load_dword v27, v14, s[76:79], 0 offen
s_mov_b32 s76, s98
s_mov_b32 s77, s99
s_mov_b32 s78, s100
v_mov_b32 v14, v15
s_mov_b32 s47, 5
s_branch .Lx24b
.Lx25:
buffer_load_dword v27, v14, s[76:79], 0 offen
s_mov_b32 s76, s98
s_mov_b32 s77, s99
s_mov_b32 s78, s100
v_mov_b32 v14, v15
s_mov_b32 s47, 5
s_branch .Lx25b
.Lx26:
buffer_load_dword v27, v14, s[76:79], 0 offen
s_mov_b32 s76, s98
s_mov_b32 s77, s99
s_mov_b32 s78, s100
v_mov_b32 v14, v15
s_mov_b32 s47, 5
s_branch .Lx26b
.Lx27:
buffer_load_dword v27, v14, s[76:79], 0 offen
s_mov_b32 s76, s98
s_mov_b32 s77, s99
s_mov_b32 s78, s100
v_mov_b32 v14, v15
s_mov_b32 s47, 5
s_branch .Lx27b
.Lx28:
buffer_load_dword v27, v14, s[76:79], 0 offen
s_mov_b32 s76, s98
s_mov_b32 s77, s99
s_mov_b32 s78, s100
v_mov_b32 v14, v15
s_mov_b32 s47, 5
s_branch .Lx28b
.Lsp29:
s_mov_b32 s15, 0
.Lsp29l:
v_mov_b32 v37, 0
buffer_atomic_add v37, v33, s[16:19], 0 offen sc0
s_add_u32 s15, s15, 1
s_cmp_gt_u32 s15, 100000
s_waitcnt vmcnt(0)
s_cbranch_scc1 .Lsp29b
v_cmp_gt_u32 vcc, v36, v37
s_nop 0
s_cbranch_vccnz .Lsp29l
s_branch .Lsp29b
.Lx30:
buffer_load_dword v27, v14, s[76:79], 0 offen
s_mov_b32 s76, s98
s_mov_b32 s77, s99
s_mov_b32 s78, s100
v_mov_b32 v14, v15
s_mov_b32 s47, 5
s_branch .Lx30b
.Lx31:
buffer_load_dword v27, v14, s[76:79], 0 offen
s_mov_b32 s76, s98
s_mov_b32 s77, s99
s_mov_b32 s78, s100
v_mov_b32 v14, v15
s_mov_b32 s47, 5
s_branch .Lx31b
.Lx32:
buffer_load_dword v27, v14, s[76:79], 0 offen
s_mov_b32 s76, s98
s_mov_b32 s77, s99
s_mov_b32 s78, s100
v_mov_b32 v14, v15
s_mov_b32 s47, 5
s_branch .Lx32b
.Lqkv1:
s_cmp_lt_u32 s14, 16
s_cselect_b32 s62, 0, 4096
v_mov_b32 v231, 1
v_lshlrev_b32 v232, 8, v1
s_waitcnt vmcnt(18)
v_permlane16_swap_b32 v164, v166
v_permlane16_swap_b32 v165, v167
s_waitcnt vmcnt(17)
v_permlane16_swap_b32 v168, v170
v_permlane16_swap_b32 v169, v171
s_waitcnt vmcnt(16)
v_permlane16_swap_b32 v172, v174
v_permlane16_swap_b32 v173, v175
s_waitcnt vmcnt(15)
v_permlane16_swap_b32 v176, v178
v_permlane16_swap_b32 v177, v179
buffer_atomic_add v231, v232, s[40:43], s62 offen
v_lshlrev_b32 v192, 16, v164
v_and_b32 v193, 0xffff0000, v164
v_lshlrev_b32 v194, 16, v165
v_and_b32 v195, 0xffff0000, v165
v_lshlrev_b32 v196, 16, v166
v_and_b32 v197, 0xffff0000, v166
v_lshlrev_b32 v198, 16, v167
v_and_b32 v199, 0xffff0000, v167
v_lshlrev_b32 v200, 16, v168
v_and_b32 v201, 0xffff0000, v168
v_lshlrev_b32 v202, 16, v169
v_and_b32 v203, 0xffff0000, v169
v_lshlrev_b32 v204, 16, v170
v_and_b32 v205, 0xffff0000, v170
v_lshlrev_b32 v206, 16, v171
v_and_b32 v207, 0xffff0000, v171
v_lshlrev_b32 v208, 16, v172
v_and_b32 v209, 0xffff0000, v172
v_lshlrev_b32 v210, 16, v173
v_and_b32 v211, 0xffff0000, v173
v_lshlrev_b32 v212, 16, v174
v_and_b32 v213, 0xffff0000, v174
v_lshlrev_b32 v214, 16, v175
v_and_b32 v215, 0xffff0000, v175
v_lshlrev_b32 v216, 16, v176
v_and_b32 v217, 0xffff0000, v176
v_lshlrev_b32 v218, 16, v177
v_and_b32 v219, 0xffff0000, v177
v_lshlrev_b32 v220, 16, v178
v_and_b32 v221, 0xffff0000, v178
v_lshlrev_b32 v222, 16, v179
v_and_b32 v223, 0xffff0000, v179
s_lshl_b32 s64, s6, 14
s_lshl_b32 s65, s49, 13
s_add_u32 s64, s64, s65
s_lshl_b32 s65, s7, 9
s_add_u32 s64, s64, s65
s_lshl_b32 s65, s48, 8
s_add_u32 s64, s64, s65
s_add_u32 s64, s64, 29360128
v_and_b32 v188, 31, v1
v_lshlrev_b32 v188, 3, v188
v_lshrrev_b32 v189, 5, v1
v_lshl_add_u32 v188, v189, 28, v188
s_lshl_b32 s62, s7, 18
s_add_u32 s62, s62, 0
s_add_u32 s63, s62, 131072
v_pk_mul_f32 v[182:183], v[192:193], v[192:193]
v_pk_mul_f32 v[186:187], v[208:209], v[208:209]
v_pk_fma_f32 v[182:183], v[194:195], v[194:195], v[182:183]
v_pk_add_f32 v[180:181], v[192:193], v[194:195]
v_pk_fma_f32 v[186:187], v[210:211], v[210:211], v[186:187]
v_pk_add_f32 v[184:185], v[208:209], v[210:211]
v_pk_fma_f32 v[182:183], v[196:197], v[196:197], v[182:183]
v_pk_add_f32 v[180:181], v[180:181], v[196:197]
v_pk_fma_f32 v[186:187], v[212:213], v[212:213], v[186:187]
v_pk_add_f32 v[184:185], v[184:185], v[212:213]
v_pk_fma_f32 v[182:183], v[198:199], v[198:199], v[182:183]
v_pk_add_f32 v[180:181], v[180:181], v[198:199]
v_pk_fma_f32 v[186:187], v[214:215], v[214:215], v[186:187]
v_pk_add_f32 v[184:185], v[184:185], v[214:215]
v_pk_fma_f32 v[182:183], v[200:201], v[200:201], v[182:183]
v_pk_add_f32 v[180:181], v[180:181], v[200:201]
v_pk_fma_f32 v[186:187], v[216:217], v[216:217], v[186:187]
v_pk_add_f32 v[184:185], v[184:185], v[216:217]
v_pk_fma_f32 v[182:183], v[202:203], v[202:203], v[182:183]
v_pk_add_f32 v[180:181], v[180:181], v[202:203]
v_pk_fma_f32 v[186:187], v[218:219], v[218:219], v[186:187]
v_pk_add_f32 v[184:185], v[184:185], v[218:219]
v_pk_fma_f32 v[182:183], v[204:205], v[204:205], v[182:183]
v_pk_add_f32 v[180:181], v[180:181], v[204:205]
v_pk_fma_f32 v[186:187], v[220:221], v[220:221], v[186:187]
v_pk_add_f32 v[184:185], v[184:185], v[220:221]
v_pk_fma_f32 v[182:183], v[206:207], v[206:207], v[182:183]
v_pk_add_f32 v[180:181], v[180:181], v[206:207]
v_pk_fma_f32 v[186:187], v[222:223], v[222:223], v[186:187]
v_pk_add_f32 v[184:185], v[184:185], v[222:223]
v_add_f32 v180, v180, v181
v_add_f32 v182, v182, v183
v_add_f32 v184, v184, v185
v_add_f32 v186, v186, v187
s_nop 0
v_permlane16_swap_b32 v180, v184
v_permlane16_swap_b32 v182, v186
v_add_f32 v180, v180, v184
v_add_f32 v182, v182, v186
s_nop 1
v_permlane32_swap_b32 v180, v182
v_add_f32 v180, v180, v182
s_nop 1
v_permlane32_swap_b32 v180, v181
buffer_store_dwordx2 v[180:181], v188, s[16:19], s64 offen sc1
s_lshl_b32 s62, s2, 10
s_add_u32 s62, s62, 31457280
s_cmp_eq_u32 s3, 0
s_cselect_b32 s62, s62, 268435456
buffer_store_dwordx4 v[224:227], v230, s[16:19], s62 offen sc1
v_accvgpr_write_b32 a224, v192
v_accvgpr_write_b32 a225, v193
v_accvgpr_write_b32 a226, v194
v_accvgpr_write_b32 a227, v195
v_accvgpr_write_b32 a228, v196
v_accvgpr_write_b32 a229, v197
v_accvgpr_write_b32 a230, v198
v_accvgpr_write_b32 a231, v199
v_accvgpr_write_b32 a232, v200
v_accvgpr_write_b32 a233, v201
v_accvgpr_write_b32 a234, v202
v_accvgpr_write_b32 a235, v203
v_accvgpr_write_b32 a236, v204
v_accvgpr_write_b32 a237, v205
v_accvgpr_write_b32 a238, v206
v_accvgpr_write_b32 a239, v207
v_accvgpr_write_b32 a240, v208
v_accvgpr_write_b32 a241, v209
v_accvgpr_write_b32 a242, v210
v_accvgpr_write_b32 a243, v211
v_accvgpr_write_b32 a244, v212
v_accvgpr_write_b32 a245, v213
v_accvgpr_write_b32 a246, v214
v_accvgpr_write_b32 a247, v215
v_accvgpr_write_b32 a248, v216
v_accvgpr_write_b32 a249, v217
v_accvgpr_write_b32 a250, v218
v_accvgpr_write_b32 a251, v219
v_accvgpr_write_b32 a252, v220
v_accvgpr_write_b32 a253, v221
v_accvgpr_write_b32 a254, v222
v_accvgpr_write_b32 a255, v223
s_add_u32 m0, s55, 18496
s_nop 0
buffer_load_dwordx4 v21, s[36:39], s52 offen lds
buffer_load_dwordx4 v28, s[36:39], s52 offen offset:1024 lds
buffer_load_dword v22, s[36:39], s52 offen offset:2048 lds
s_add_u32 s52, s52, 128
s_add_u32 m0, s55, 20800
s_nop 0
buffer_load_dwordx4 v21, s[36:39], s53 offen lds
buffer_load_dwordx4 v28, s[36:39], s53 offen offset:1024 lds
buffer_load_dword v29, s[36:39], s53 offen offset:2048 lds
s_add_u32 s53, s53, 128
s_add_u32 m0, s56, 73984
s_nop 0
buffer_load_dwordx4 v18, s[20:23], s54 offen lds
buffer_load_dwordx4 v19, s[20:23], s54 offen offset:1024 lds
buffer_load_dwordx4 v20, s[20:23], s54 offen offset:2048 lds
s_add_u32 s54, s54, 196608
s_waitcnt vmcnt(15) lgkmcnt(0)
s_barrier
ds_read_b128 a[0:3], v23
RD 4,23,2304
RD 8,23,4608
RD 12,23,6912
TR 20,25,49664
TR 22,25,50176
TR 24,25,49696
TR 26,25,50208
ds_read_b128 a[16:19], v24
TR 28,25,50688
TR 30,25,51200
TR 32,25,50720
TR 34,25,51232
TR 36,25,51712
TR 38,25,52224
TR 40,25,51744
TR 42,25,52256
s_waitcnt vmcnt(12) lgkmcnt(8)
s_barrier
v_mfma_f32_16x16x32_bf16 v[60:63], a[20:23], a[0:3], 0
ds_read_b128 a[44:47], v30
RD 48,30,2304
v_mfma_f32_16x16x32_bf16 v[76:79], a[24:27], a[0:3], 0
s_add_u32 m0, s56, 86400
v_mfma_f32_16x16x32_bf16 v[80:83], a[24:27], a[4:7], 0
buffer_load_dwordx4 v18, s[20:23], s54 offen lds
v_mfma_f32_16x16x32_bf16 v[64:67], a[20:23], a[4:7], 0
s_sub_u32 s47, s47, 1
s_cbranch_scc1 .Lx19
.Lx19b:
v_mfma_f32_16x16x32_bf16 v[68:71], a[20:23], a[8:11], 0
buffer_load_dwordx4 v19, s[20:23], s54 offen offset:1024 lds
v_mfma_f32_16x16x32_bf16 v[84:87], a[24:27], a[8:11], 0
RD 52,30,4608
RD 56,30,6912
v_mfma_f32_16x16x32_bf16 v[88:91], a[24:27], a[12:15], 0
TR 64,25,62080
v_mfma_f32_16x16x32_bf16 v[72:75], a[20:23], a[12:15], 0
TR 66,25,62592
s_waitcnt lgkmcnt(6)
v_mfma_f32_16x16x32_bf16 v[244:247], a[24:27], a[16:19], 0
buffer_load_dwordx4 v20, s[20:23], s54 offen offset:2048 lds
v_mfma_f32_16x16x32_bf16 v[104:107], a[28:31], a[12:15], 0
s_add_u32 s54, s54, 196608
s_add_u32 m0, s55, 36992
v_mfma_f32_16x16x32_bf16 v[120:123], a[32:35], a[12:15], 0
buffer_load_dwordx4 v21, s[36:39], s52 offen lds
v_mfma_f32_16x16x32_bf16 v[116:119], a[32:35], a[8:11], 0
TR 68,25,62112
TR 70,25,62624
v_mfma_f32_16x16x32_bf16 v[100:103], a[28:31], a[8:11], 0
ds_read_b128 a[60:63], v31
v_mfma_f32_16x16x32_bf16 v[96:99], a[28:31], a[4:7], 0
buffer_load_dwordx4 v28, s[36:39], s52 offen offset:1024 lds
v_mfma_f32_16x16x32_bf16 v[112:115], a[32:35], a[4:7], 0
TR 72,25,63104
v_mfma_f32_16x16x32_bf16 v[108:111], a[32:35], a[0:3], 0
buffer_load_dword v22, s[36:39], s52 offen offset:2048 lds
v_mfma_f32_16x16x32_bf16 v[92:95], a[28:31], a[0:3], 0
TR 74,25,63616
s_add_u32 s52, s52, 128
v_mfma_f32_16x16x32_bf16 v[124:127], a[0:3], a[36:39], 0
TR 76,25,63136
s_add_u32 m0, s55, 39296
v_mfma_f32_16x16x32_bf16 v[140:143], a[0:3], a[40:43], 0
buffer_load_dwordx4 v21, s[36:39], s53 offen lds
v_mfma_f32_16x16x32_bf16 v[144:147], a[4:7], a[40:43], 0
TR 78,25,63648
v_mfma_f32_16x16x32_bf16 v[128:131], a[4:7], a[36:39], 0
TR 80,25,64128
v_mfma_f32_16x16x32_bf16 v[132:135], a[8:11], a[36:39], 0
buffer_load_dwordx4 v28, s[36:39], s53 offen offset:1024 lds
v_mfma_f32_16x16x32_bf16 v[148:151], a[8:11], a[40:43], 0
TR 82,25,64640
TR 84,25,64160
v_mfma_f32_16x16x32_bf16 v[152:155], a[12:15], a[40:43], 0
TR 86,25,64672
v_mfma_f32_16x16x32_bf16 v[136:139], a[12:15], a[36:39], 0
buffer_load_dword v29, s[36:39], s53 offen offset:2048 lds
v_mfma_f32_16x16x32_bf16 v[156:159], a[16:19], a[36:39], 0
s_add_u32 s53, s53, 128
v_mfma_f32_16x16x32_bf16 v[160:163], a[16:19], a[40:43], 0
s_waitcnt vmcnt(9) lgkmcnt(8)
s_barrier
MAA 60,64,44
RD 0,23,18496
RD 4,23,20800
MAA 76,68,44
s_add_u32 m0, s56, 98816
MAA 80,68,48
buffer_load_dwordx4 v18, s[20:23], s54 offen lds
MAA 64,64,48
RD 8,23,23104
RD 12,23,25408
MAA 68,64,52
buffer_load_dwordx4 v19, s[20:23], s54 offen offset:1024 lds
MAA 84,68,52
ds_read_b64_tr_b16 a[20:21], v25
MAA 88,68,56
TR 22,25,512
MAA 72,64,56
TR 24,25,32
s_waitcnt lgkmcnt(7)
MAA 244,68,60
buffer_load_dwordx4 v20, s[20:23], s54 offen offset:2048 lds
MAA 104,72,56
s_add_u32 s54, s54, 196608
s_add_u32 m0, s56, 111232
MAA 120,76,56
buffer_load_dwordx4 v18, s[20:23], s54 offen lds
MAA 116,76,52
TR 26,25,544
MAA 100,72,52
RD 16,24,18496
TR 28,25,1024
MAA 96,72,48
buffer_load_dwordx4 v19, s[20:23], s54 offen offset:1024 lds
MAA 112,76,48
TR 30,25,1536
MAA 108,76,44
buffer_load_dwordx4 v20, s[20:23], s54 offen offset:2048 lds
MAA 92,72,44
s_add_u32 s54, s54, 196608
MAA 124,44,80
TR 32,25,1056
s_add_u32 m0, s55, 55488
MAA 140,44,84
buffer_load_dwordx4 v21, s[36:39], s52 offen lds
MAA 144,48,84
TR 34,25,1568
MAA 128,48,80
TR 36,25,2048
MAA 132,52,80
buffer_load_dwordx4 v28, s[36:39], s52 offen offset:1024 lds
MAA 148,52,84
TR 38,25,2560
TR 40,25,2080
MAA 152,56,84
TR 42,25,2592
MAA 136,56,80
buffer_load_dword v22, s[36:39], s52 offen offset:2048 lds
MAA 156,60,80
s_add_u32 s52, s52, 128
MAA 160,60,84
s_waitcnt vmcnt(15) lgkmcnt(8)
s_barrier
MAA 60,20,0
RD 44,30,18496
RD 48,30,20800
MAA 76,24,0
s_add_u32 m0, s55, 57792
MAA 80,24,4
buffer_load_dwordx4 v21, s[36:39], s53 offen lds
MAA 64,20,4
s_sub_u32 s47, s47, 1
s_cbranch_scc1 .Lx20
.Lx20b:
MAA 68,20,8
buffer_load_dwordx4 v28, s[36:39], s53 offen offset:1024 lds
MAA 84,24,8
RD 52,30,23104
RD 56,30,25408
MAA 88,24,12
TR 64,25,12416
MAA 72,20,12
TR 66,25,12928
s_waitcnt lgkmcnt(6)
MAA 244,24,16
buffer_load_dword v29, s[36:39], s53 offen offset:2048 lds
MAA 104,28,12
s_add_u32 s53, s53, 128
s_add_u32 m0, s56, 123648
MAA 120,32,12
buffer_load_dwordx4 v18, s[20:23], s54 offen lds
MAA 116,32,8
TR 68,25,12448
TR 70,25,12960
MAA 100,28,8
RD 60,31,18496
MAA 96,28,4
buffer_load_dwordx4 v19, s[20:23], s54 offen offset:1024 lds
MAA 112,32,4
TR 72,25,13440
MAA 108,32,0
buffer_load_dwordx4 v20, s[20:23], s54 offen offset:2048 lds
MAA 92,28,0
TR 74,25,13952
s_add_u32 s54, s54, 196608
MAA 124,0,36
TR 76,25,13472
s_add_u32 m0, s56, 136064
MAA 140,0,40
buffer_load_dwordx4 v18, s[20:23], s54 offen lds
MAA 144,4,40
TR 78,25,13984
MAA 128,4,36
TR 80,25,14464
MAA 132,8,36
buffer_load_dwordx4 v19, s[20:23], s54 offen offset:1024 lds
MAA 148,8,40
TR 82,25,14976
TR 84,25,14496
MAA 152,12,40
TR 86,25,15008
MAA 136,12,36
buffer_load_dwordx4 v20, s[20:23], s54 offen offset:2048 lds
MAA 156,16,36
s_add_u32 s54, s54, 196608
MAA 160,16,40
s_waitcnt vmcnt(15) lgkmcnt(8)
s_barrier
MAA 60,64,44
RD 0,23,36992
RD 4,23,39296
MAA 76,68,44
s_add_u32 m0, s55, 0
MAA 80,68,48
buffer_load_dwordx4 v21, s[36:39], s52 offen lds
MAA 64,64,48
RD 8,23,41600
RD 12,23,43904
MAA 68,64,52
buffer_load_dwordx4 v28, s[36:39], s52 offen offset:1024 lds
MAA 84,68,52
TR 20,25,24832
MAA 88,68,56
TR 22,25,25344
MAA 72,64,56
TR 24,25,24864
s_waitcnt lgkmcnt(7)
MAA 244,68,60
buffer_load_dword v22, s[36:39], s52 offen offset:2048 lds
MAA 104,72,56
TR 26,25,25376
s_add_u32 s52, s52, 128
s_add_u32 m0, s55, 2304
MAA 120,76,56
buffer_load_dwordx4 v21, s[36:39], s53 offen lds
MAA 116,76,52
RD 16,24,36992
MAA 100,72,52
buffer_load_dwordx4 v28, s[36:39], s53 offen offset:1024 lds
MAA 96,72,48
TR 28,25,25856
MAA 112,76,48
buffer_load_dword v29, s[36:39], s53 offen offset:2048 lds
MAA 108,76,44
TR 30,25,26368
s_add_u32 s53, s53, 128
MAA 92,72,44
TR 32,25,25888
s_add_u32 m0, s56, 73984
MAA 124,44,80
buffer_load_dwordx4 v18, s[20:23], s54 offen lds
MAA 140,44,84
TR 34,25,26400
MAA 144,48,84
buffer_load_dwordx4 v19, s[20:23], s54 offen offset:1024 lds
MAA 128,48,80
TR 36,25,26880
MAA 132,52,80
TR 38,25,27392
TR 40,25,26912
MAA 148,52,84
buffer_load_dwordx4 v20, s[20:23], s54 offen offset:2048 lds
MAA 152,56,84
s_add_u32 s54, s54, 196608
MAA 136,56,80
buffer_load_dword v37, v34, s[40:43], 0 offen sc1
MAA 156,60,80
TR 42,25,27424
MAA 160,60,84
s_waitcnt vmcnt(22) lgkmcnt(8)
s_barrier
MAA 60,20,0
RD 44,30,36992
RD 48,30,39296
MAA 76,24,0
s_add_u32 m0, s56, 86400
MAA 80,24,4
buffer_load_dwordx4 v18, s[20:23], s54 offen lds
MAA 64,20,4
s_sub_u32 s47, s47, 1
s_cbranch_scc1 .Lx21
.Lx21b:
MAA 68,20,8
buffer_load_dwordx4 v19, s[20:23], s54 offen offset:1024 lds
MAA 84,24,8
RD 52,30,41600
RD 56,30,43904
MAA 88,24,12
TR 64,25,37248
MAA 72,20,12
TR 66,25,37760
s_waitcnt lgkmcnt(6)
MAA 244,24,16
buffer_load_dwordx4 v20, s[20:23], s54 offen offset:2048 lds
MAA 104,28,12
s_add_u32 s54, s54, 196608
s_add_u32 m0, s55, 18496
MAA 120,32,12
buffer_load_dwordx4 v21, s[36:39], s52 offen lds
MAA 116,32,8
TR 68,25,37280
TR 70,25,37792
MAA 100,28,8
RD 60,31,36992
MAA 96,28,4
buffer_load_dwordx4 v28, s[36:39], s52 offen offset:1024 lds
MAA 112,32,4
TR 72,25,38272
MAA 108,32,0
buffer_load_dword v22, s[36:39], s52 offen offset:2048 lds
MAA 92,28,0
TR 74,25,38784
s_add_u32 s52, s52, 128
MAA 124,0,36
TR 76,25,38304
s_add_u32 m0, s55, 20800
MAA 140,0,40
buffer_load_dwordx4 v21, s[36:39], s53 offen lds
MAA 144,4,40
TR 78,25,38816
MAA 128,4,36
TR 80,25,39296
MAA 132,8,36
buffer_load_dwordx4 v28, s[36:39], s53 offen offset:1024 lds
MAA 148,8,40
TR 82,25,39808
TR 84,25,39328
MAA 152,12,40
TR 86,25,39840
MAA 136,12,36
buffer_load_dword v29, s[36:39], s53 offen offset:2048 lds
MAA 156,16,36
s_add_u32 s53, s53, 128
MAA 160,16,40
s_waitcnt vmcnt(22) lgkmcnt(8)
s_barrier
MAA 60,64,44
RD 0,23,55488
MAA 76,68,44
RD 4,23,57792
s_add_u32 m0, s56, 98816
MAA 80,68,48
buffer_load_dwordx4 v18, s[20:23], s54 offen lds
MAA 64,64,48
RD 8,23,60096
MAA 68,64,52
RD 12,23,62400
MAA 84,68,52
TR 20,25,49664
MAA 88,68,56
buffer_load_dwordx4 v19, s[20:23], s54 offen offset:1024 lds
MAA 72,64,56
TR 22,25,50176
s_waitcnt lgkmcnt(6)
MAA 244,68,60
MAA 104,72,56
TR 24,25,49696
MAA 120,76,56
buffer_load_dwordx4 v20, s[20:23], s54 offen offset:2048 lds
MAA 116,76,52
TR 26,25,50208
s_add_u32 s54, s54, 196608
MAA 100,72,52
RD 16,24,55488
MAA 96,72,48
TR 28,25,50688
s_add_u32 m0, s55, 36992
MAA 112,76,48
buffer_load_dwordx4 v21, s[36:39], s52 offen lds
MAA 108,76,44
TR 30,25,51200
MAA 92,72,44
TR 32,25,50720
MAA 124,44,80
MAA 140,44,84
buffer_load_dwordx4 v28, s[36:39], s52 offen offset:1024 lds
MAA 144,48,84
TR 34,25,51232
MAA 128,48,80
TR 36,25,51712
MAA 132,52,80
TR 38,25,52224
MAA 148,52,84
buffer_load_dword v22, s[36:39], s52 offen offset:2048 lds
MAA 152,56,84
TR 40,25,51744
s_add_u32 s52, s52, 128
MAA 136,56,80
TR 42,25,52256
MAA 156,60,80
MAA 160,60,84
s_waitcnt vmcnt(25) lgkmcnt(8)
s_barrier
MAA 60,20,0
RD 44,30,55488
MAA 76,24,0
RD 48,30,57792
s_add_u32 m0, s56, 111232
MAA 80,24,4
buffer_load_dwordx4 v18, s[20:23], s54 offen lds
MAA 64,20,4
s_sub_u32 s47, s47, 1
s_cbranch_scc1 .Lx22
.Lx22b:
MAA 68,20,8
RD 52,30,60096
MAA 84,24,8
RD 56,30,62400
MAA 88,24,12
buffer_load_dwordx4 v19, s[20:23], s54 offen offset:1024 lds
MAA 72,20,12
TR 64,25,62080
s_waitcnt lgkmcnt(5)
MAA 244,24,16
TR 66,25,62592
MAA 104,28,12
TR 68,25,62112
MAA 120,32,12
buffer_load_dwordx4 v20, s[20:23], s54 offen offset:2048 lds
MAA 116,32,8
TR 70,25,62624
s_add_u32 s54, s54, 196608
MAA 100,28,8
RD 60,31,55488
MAA 96,28,4
s_add_u32 m0, s55, 39296
MAA 112,32,4
buffer_load_dwordx4 v21, s[36:39], s53 offen lds
MAA 108,32,0
TR 72,25,63104
MAA 92,28,0
TR 74,25,63616
MAA 124,0,36
TR 76,25,63136
MAA 140,0,40
buffer_load_dwordx4 v28, s[36:39], s53 offen offset:1024 lds
MAA 144,4,40
TR 78,25,63648
MAA 128,4,36
TR 80,25,64128
MAA 132,8,36
TR 82,25,64640
MAA 148,8,40
buffer_load_dword v29, s[36:39], s53 offen offset:2048 lds
MAA 152,12,40
TR 84,25,64160
s_add_u32 s53, s53, 128
MAA 136,12,36
TR 86,25,64672
MAA 156,16,36
MAA 160,16,40
s_waitcnt vmcnt(22) lgkmcnt(8)
s_barrier
s_waitcnt vmcnt(21)
v_cmp_gt_u32 vcc, v35, v37
s_nop 0
s_cbranch_vccnz .Lsp23
.Lsp23b:
v_mov_b32 v37, 0
MAA 60,64,44
ds_read_b128 a[0:3], v23
MAA 76,68,44
RD 4,23,2304
MAA 80,68,48
buffer_atomic_add v38, v32, s[16:19], 0 offen
MAA 64,64,48
RD 8,23,4608
MAA 68,64,52
RD 12,23,6912
s_add_u32 m0, s56, 123648
MAA 84,68,52
buffer_load_dwordx4 v18, s[20:23], s54 offen lds
MAA 88,68,56
ds_read_b64_tr_b16 a[20:21], v25
MAA 72,64,56
TR 22,25,512
s_waitcnt lgkmcnt(6)
MAA 244,68,60
TR 24,25,32
MAA 104,72,56
buffer_load_dwordx4 v19, s[20:23], s54 offen offset:1024 lds
MAA 120,76,56
TR 26,25,544
MAA 116,76,52
ds_read_b128 a[16:19], v24
MAA 100,72,52
buffer_load_dwordx4 v20, s[20:23], s54 offen offset:2048 lds
MAA 96,72,48
s_add_u32 s54, s54, 196608
MAA 112,76,48
TR 28,25,1024
MAA 108,76,44
TR 30,25,1536
s_add_u32 m0, s55, 55488
MAA 92,72,44
buffer_load_dwordx4 v21, s[36:39], s52 offen lds
MAA 124,44,80
TR 32,25,1056
MAA 140,44,84
TR 34,25,1568
MAA 144,48,84
buffer_load_dwordx4 v28, s[36:39], s52 offen offset:1024 lds
MAA 128,48,80
TR 36,25,2048
MAA 132,52,80
TR 38,25,2560
MAA 148,52,84
TR 40,25,2080
MAA 152,56,84
buffer_load_dword v22, s[36:39], s52 offen offset:2048 lds
MAA 136,56,80
TR 42,25,2592
s_add_u32 s52, s52, 128
MAA 156,60,80
MAA 160,60,84
s_waitcnt vmcnt(25) lgkmcnt(8)
s_barrier
MAA 60,20,0
ds_read_b128 a[44:47], v30
MAA 76,24,0
RD 48,30,2304
s_add_u32 m0, s56, 136064
MAA 80,24,4
buffer_load_dwordx4 v18, s[20:23], s54 offen lds
MAA 64,20,4
s_sub_u32 s47, s47, 1
s_cbranch_scc1 .Lx24
.Lx24b:
MAA 68,20,8
RD 52,30,4608
MAA 84,24,8
RD 56,30,6912
MAA 88,24,12
buffer_load_dwordx4 v19, s[20:23], s54 offen offset:1024 lds
MAA 72,20,12
TR 64,25,12416
s_waitcnt lgkmcnt(5)
MAA 244,24,16
TR 66,25,12928
MAA 104,28,12
TR 68,25,12448
MAA 120,32,12
buffer_load_dwordx4 v20, s[20:23], s54 offen offset:2048 lds
MAA 116,32,8
TR 70,25,12960
s_add_u32 s54, s54, 196608
MAA 100,28,8
ds_read_b128 a[60:63], v31
MAA 96,28,4
s_add_u32 m0, s55, 57792
MAA 112,32,4
buffer_load_dwordx4 v21, s[36:39], s53 offen lds
MAA 108,32,0
TR 72,25,13440
MAA 92,28,0
TR 74,25,13952
MAA 124,0,36
TR 76,25,13472
MAA 140,0,40
buffer_load_dwordx4 v28, s[36:39], s53 offen offset:1024 lds
MAA 144,4,40
TR 78,25,13984
MAA 128,4,36
TR 80,25,14464
MAA 132,8,36
TR 82,25,14976
MAA 148,8,40
buffer_load_dword v29, s[36:39], s53 offen offset:2048 lds
MAA 152,12,40
TR 84,25,14496
s_add_u32 s53, s53, 128
MAA 136,12,36
TR 86,25,15008
MAA 156,16,36
MAA 160,16,40
s_waitcnt vmcnt(22) lgkmcnt(8)
s_barrier
MAA 60,64,44
RD 0,23,18496
MAA 76,68,44
RD 4,23,20800
s_add_u32 m0, s56, 73984
MAA 80,68,48
buffer_load_dwordx4 v18, s[20:23], s54 offen lds
MAA 64,64,48
RD 8,23,23104
MAA 68,64,52
RD 12,23,25408
MAA 84,68,52
TR 20,25,24832
MAA 88,68,56
buffer_load_dwordx4 v19, s[20:23], s54 offen offset:1024 lds
MAA 72,64,56
TR 22,25,25344
s_waitcnt lgkmcnt(6)
MAA 244,68,60
MAA 104,72,56
TR 24,25,24864
MAA 120,76,56
buffer_load_dwordx4 v20, s[20:23], s54 offen offset:2048 lds
MAA 116,76,52
TR 26,25,25376
s_add_u32 s54, s54, 196608
MAA 100,72,52
RD 16,24,18496
MAA 96,72,48
TR 28,25,25856
s_add_u32 m0, s55, 0
MAA 112,76,48
buffer_load_dwordx4 v21, s[36:39], s52 offen lds
MAA 108,76,44
TR 30,25,26368
MAA 92,72,44
TR 32,25,25888
MAA 124,44,80
MAA 140,44,84
buffer_load_dwordx4 v28, s[36:39], s52 offen offset:1024 lds
MAA 144,48,84
TR 34,25,26400
MAA 128,48,80
TR 36,25,26880
MAA 132,52,80
TR 38,25,27392
MAA 148,52,84
buffer_load_dword v22, s[36:39], s52 offen offset:2048 lds
MAA 152,56,84
TR 40,25,26912
s_add_u32 s52, s52, 128
MAA 136,56,80
TR 42,25,27424
MAA 156,60,80
MAA 160,60,84
s_waitcnt vmcnt(22) lgkmcnt(8)
s_barrier
MAA 60,20,0
RD 44,30,18496
MAA 76,24,0
RD 48,30,20800
s_add_u32 m0, s56, 86400
MAA 80,24,4
buffer_load_dwordx4 v18, s[20:23], s54 offen lds
MAA 64,20,4
s_sub_u32 s47, s47, 1
s_cbranch_scc1 .Lx25
.Lx25b:
MAA 68,20,8
RD 52,30,23104
MAA 84,24,8
RD 56,30,25408
MAA 88,24,12
buffer_load_dwordx4 v19, s[20:23], s54 offen offset:1024 lds
MAA 72,20,12
TR 64,25,37248
s_waitcnt lgkmcnt(5)
MAA 244,24,16
TR 66,25,37760
MAA 104,28,12
TR 68,25,37280
MAA 120,32,12
buffer_load_dwordx4 v20, s[20:23], s54 offen offset:2048 lds
MAA 116,32,8
TR 70,25,37792
s_add_u32 s54, s54, 196608
MAA 100,28,8
RD 60,31,18496
MAA 96,28,4
s_add_u32 m0, s55, 2304
MAA 112,32,4
buffer_load_dwordx4 v21, s[36:39], s53 offen lds
MAA 108,32,0
TR 72,25,38272
MAA 92,28,0
TR 74,25,38784
MAA 124,0,36
TR 76,25,38304
MAA 140,0,40
buffer_load_dwordx4 v28, s[36:39], s53 offen offset:1024 lds
MAA 144,4,40
TR 78,25,38816
MAA 128,4,36
TR 80,25,39296
MAA 132,8,36
TR 82,25,39808
MAA 148,8,40
buffer_load_dword v29, s[36:39], s53 offen offset:2048 lds
MAA 152,12,40
TR 84,25,39328
s_add_u32 s53, s53, 128
MAA 136,12,36
TR 86,25,39840
MAA 156,16,36
MAA 160,16,40
s_waitcnt vmcnt(21) lgkmcnt(8)
s_barrier
MAA 60,64,44
RD 0,23,36992
MAA 76,68,44
RD 4,23,39296
s_add_u32 m0, s56, 98816
MAA 80,68,48
buffer_load_dwordx4 v18, s[20:23], s54 offen lds
MAA 64,64,48
RD 8,23,41600
MAA 68,64,52
RD 12,23,43904
MAA 84,68,52
TR 20,25,49664
MAA 88,68,56
buffer_load_dwordx4 v19, s[20:23], s54 offen offset:1024 lds
MAA 72,64,56
TR 22,25,50176
s_waitcnt lgkmcnt(6)
MAA 244,68,60
MAA 104,72,56
TR 24,25,49696
MAA 120,76,56
buffer_load_dwordx4 v20, s[20:23], s54 offen offset:2048 lds
MAA 116,76,52
TR 26,25,50208
s_add_u32 s54, s54, 196608
MAA 100,72,52
RD 16,24,36992
MAA 96,72,48
TR 28,25,50688
s_add_u32 m0, s55, 18496
MAA 112,76,48
buffer_load_dwordx4 v21, s[36:39], s52 offen lds
MAA 108,76,44
TR 30,25,51200
MAA 92,72,44
TR 32,25,50720
MAA 124,44,80
MAA 140,44,84
buffer_load_dwordx4 v28, s[36:39], s52 offen offset:1024 lds
MAA 144,48,84
TR 34,25,51232
MAA 128,48,80
TR 36,25,51712
MAA 132,52,80
TR 38,25,52224
MAA 148,52,84
buffer_load_dword v22, s[36:39], s52 offen offset:2048 lds
MAA 152,56,84
TR 40,25,51744
s_add_u32 s52, s52, 128
MAA 136,56,80
TR 42,25,52256
MAA 156,60,80
MAA 160,60,84
s_waitcnt vmcnt(21) lgkmcnt(8)
s_barrier
MAA 60,20,0
RD 44,30,36992
MAA 76,24,0
RD 48,30,39296
s_add_u32 m0, s56, 111232
MAA 80,24,4
buffer_load_dwordx4 v18, s[20:23], s54 offen lds
MAA 64,20,4
s_sub_u32 s47, s47, 1
s_cbranch_scc1 .Lx26
.Lx26b:
MAA 68,20,8
RD 52,30,41600
MAA 84,24,8
buffer_load_dwordx4 v19, s[20:23], s54 offen offset:1024 lds
MAA 88,24,12
RD 56,30,43904
MAA 72,20,12
TR 64,25,62080
s_waitcnt lgkmcnt(5)
MAA 244,24,16
TR 66,25,62592
MAA 104,28,12
buffer_load_dwordx4 v20, s[20:23], s54 offen offset:2048 lds
MAA 120,32,12
TR 68,25,62112
s_add_u32 s54, s54, 196608
MAA 116,32,8
TR 70,25,62624
s_add_u32 m0, s55, 20800
MAA 100,28,8
buffer_load_dwordx4 v21, s[36:39], s53 offen lds
MAA 96,28,4
RD 60,31,36992
MAA 112,32,4
TR 72,25,63104
MAA 108,32,0
TR 74,25,63616
MAA 92,28,0
buffer_load_dwordx4 v28, s[36:39], s53 offen offset:1024 lds
MAA 124,0,36
TR 76,25,63136
MAA 140,0,40
TR 78,25,63648
MAA 144,4,40
buffer_load_dword v29, s[36:39], s53 offen offset:2048 lds
MAA 128,4,36
TR 80,25,64128
s_add_u32 s53, s53, 128
MAA 132,8,36
TR 82,25,64640
MAA 148,8,40
TR 84,25,64160
MAA 152,12,40
buffer_atomic_add v37, v33, s[16:19], 0 offen sc0
MAA 136,12,36
TR 86,25,64672
MAA 156,16,36
MAA 160,16,40
s_waitcnt vmcnt(22) lgkmcnt(8)
s_barrier
MAA 60,64,44
RD 0,23,55488
MAA 76,68,44
RD 4,23,57792
s_add_u32 m0, s56, 123648
MAA 80,68,48
buffer_load_dwordx4 v18, s[20:23], s54 offen lds
MAA 64,64,48
RD 8,23,60096
MAA 68,64,52
RD 12,23,62400
MAA 84,68,52
ds_read_b64_tr_b16 a[20:21], v25
MAA 88,68,56
buffer_load_dwordx4 v19, s[20:23], s54 offen offset:1024 lds
MAA 72,64,56
TR 22,25,512
s_waitcnt lgkmcnt(6)
MAA 244,68,60
MAA 104,72,56
TR 24,25,32
MAA 120,76,56
buffer_load_dwordx4 v20, s[20:23], s54 offen offset:2048 lds
MAA 116,76,52
TR 26,25,544
s_add_u32 s54, s54, 196608
MAA 100,72,52
RD 16,24,55488
MAA 96,72,48
TR 28,25,1024
s_add_u32 m0, s55, 36992
MAA 112,76,48
buffer_load_dwordx4 v21, s[36:39], s52 offen lds
MAA 108,76,44
TR 30,25,1536
MAA 92,72,44
TR 32,25,1056
MAA 124,44,80
MAA 140,44,84
buffer_load_dwordx4 v28, s[36:39], s52 offen offset:1024 lds
MAA 144,48,84
TR 34,25,1568
MAA 128,48,80
TR 36,25,2048
MAA 132,52,80
TR 38,25,2560
MAA 148,52,84
buffer_load_dword v22, s[36:39], s52 offen offset:2048 lds
MAA 152,56,84
TR 40,25,2080
s_add_u32 s52, s52, 128
MAA 136,56,80
TR 42,25,2592
MAA 156,60,80
MAA 160,60,84
s_waitcnt vmcnt(22) lgkmcnt(8)
s_barrier
MAA 60,20,0
RD 44,30,55488
MAA 76,24,0
RD 48,30,57792
s_add_u32 m0, s56, 136064
MAA 80,24,4
buffer_load_dwordx4 v18, s[20:23], s54 offen lds
MAA 64,20,4
s_sub_u32 s47, s47, 1
s_cbranch_scc1 .Lx27
.Lx27b:
MAA 68,20,8
RD 52,30,60096
MAA 84,24,8
RD 56,30,62400
MAA 88,24,12
buffer_load_dwordx4 v19, s[20:23], s54 offen offset:1024 lds
MAA 72,20,12
TR 64,25,12416
s_waitcnt lgkmcnt(5)
MAA 244,24,16
TR 66,25,12928
MAA 104,28,12
TR 68,25,12448
MAA 120,32,12
buffer_load_dwordx4 v20, s[20:23], s54 offen offset:2048 lds
MAA 116,32,8
TR 70,25,12960
s_add_u32 s54, s54, 196608
MAA 100,28,8
RD 60,31,55488
MAA 96,28,4
s_add_u32 m0, s55, 39296
MAA 112,32,4
buffer_load_dwordx4 v21, s[36:39], s53 offen lds
MAA 108,32,0
TR 72,25,13440
MAA 92,28,0
TR 74,25,13952
MAA 124,0,36
TR 76,25,13472
MAA 140,0,40
buffer_load_dwordx4 v28, s[36:39], s53 offen offset:1024 lds
MAA 144,4,40
TR 78,25,13984
MAA 128,4,36
TR 80,25,14464
MAA 132,8,36
TR 82,25,14976
MAA 148,8,40
buffer_load_dword v29, s[36:39], s53 offen offset:2048 lds
MAA 152,12,40
TR 84,25,14496
s_add_u32 s53, s53, 128
MAA 136,12,36
TR 86,25,15008
MAA 156,16,36
MAA 160,16,40
s_waitcnt vmcnt(22) lgkmcnt(8)
s_barrier
MAA 60,64,44
ds_read_b128 a[0:3], v23
MAA 76,68,44
RD 4,23,2304
s_add_u32 m0, s56, 73984
MAA 80,68,48
buffer_load_dwordx4 v18, s[20:23], s54 offen lds
MAA 64,64,48
RD 8,23,4608
MAA 68,64,52
RD 12,23,6912
MAA 84,68,52
TR 20,25,24832
MAA 88,68,56
buffer_load_dwordx4 v19, s[20:23], s54 offen offset:1024 lds
MAA 72,64,56
TR 22,25,25344
s_waitcnt lgkmcnt(6)
MAA 244,68,60
MAA 104,72,56
TR 24,25,24864
MAA 120,76,56
buffer_load_dwordx4 v20, s[20:23], s54 offen offset:2048 lds
MAA 116,76,52
TR 26,25,25376
s_add_u32 s54, s54, 196608
MAA 100,72,52
ds_read_b128 a[16:19], v24
MAA 96,72,48
TR 28,25,25856
s_add_u32 m0, s55, 55488
MAA 112,76,48
buffer_load_dwordx4 v21, s[36:39], s52 offen lds
MAA 108,76,44
TR 30,25,26368
MAA 92,72,44
TR 32,25,25888
MAA 124,44,80
MAA 140,44,84
buffer_load_dwordx4 v28, s[36:39], s52 offen offset:1024 lds
MAA 144,48,84
TR 34,25,26400
MAA 128,48,80
TR 36,25,26880
MAA 132,52,80
TR 38,25,27392
MAA 148,52,84
buffer_load_dword v22, s[36:39], s52 offen offset:2048 lds
MAA 152,56,84
TR 40,25,26912
s_add_u32 s52, s52, 128
MAA 136,56,80
TR 42,25,27424
MAA 156,60,80
MAA 160,60,84
s_waitcnt vmcnt(22) lgkmcnt(8)
s_barrier
MAA 60,20,0
ds_read_b128 a[44:47], v30
MAA 76,24,0
RD 48,30,2304
s_add_u32 m0, s56, 86400
MAA 80,24,4
buffer_load_dwordx4 v18, s[20:23], s54 offen lds
MAA 64,20,4
s_sub_u32 s47, s47, 1
s_cbranch_scc1 .Lx28
.Lx28b:
MAA 68,20,8
RD 52,30,4608
MAA 84,24,8
RD 56,30,6912
MAA 88,24,12
buffer_load_dwordx4 v19, s[20:23], s54 offen offset:1024 lds
MAA 72,20,12
TR 64,25,37248
s_waitcnt lgkmcnt(5)
MAA 244,24,16
TR 66,25,37760
MAA 104,28,12
TR 68,25,37280
MAA 120,32,12
buffer_load_dwordx4 v20, s[20:23], s54 offen offset:2048 lds
MAA 116,32,8
TR 70,25,37792
s_add_u32 s54, s54, 196608
MAA 100,28,8
ds_read_b128 a[60:63], v31
MAA 96,28,4
s_add_u32 m0, s55, 57792
MAA 112,32,4
buffer_load_dwordx4 v21, s[36:39], s53 offen lds
MAA 108,32,0
TR 72,25,38272
MAA 92,28,0
TR 74,25,38784
MAA 124,0,36
TR 76,25,38304
MAA 140,0,40
buffer_load_dwordx4 v28, s[36:39], s53 offen offset:1024 lds
MAA 144,4,40
TR 78,25,38816
MAA 128,4,36
TR 80,25,39296
MAA 132,8,36
TR 82,25,39808
MAA 148,8,40
buffer_load_dword v29, s[36:39], s53 offen offset:2048 lds
MAA 152,12,40
TR 84,25,39328
s_add_u32 s53, s53, 128
MAA 136,12,36
TR 86,25,39840
MAA 156,16,36
MAA 160,16,40
s_waitcnt vmcnt(24)
v_cmp_gt_u32 vcc, v36, v37
s_nop 0
s_cbranch_vccnz .Lsp29
.Lsp29b:
s_waitcnt vmcnt(21) lgkmcnt(8)
s_barrier
MAA 60,64,44
RD 0,23,18496
MAA 76,68,44
RD 4,23,20800
s_add_u32 m0, s56, 98816
MAA 80,68,48
buffer_load_dwordx4 v18, s[20:23], s54 offen lds
MAA 64,64,48
RD 8,23,23104
MAA 68,64,52
RD 12,23,25408
MAA 84,68,52
buffer_load_dwordx4 v19, s[20:23], s54 offen offset:1024 lds
MAA 88,68,56
TR 20,25,49664
MAA 72,64,56
TR 22,25,50176
s_waitcnt lgkmcnt(6)
MAA 244,68,60
TR 24,25,49696
MAA 104,72,56
buffer_load_dwordx4 v20, s[20:23], s54 offen offset:2048 lds
MAA 120,76,56
TR 26,25,50208
s_add_u32 s54, s54, 196608
MAA 116,76,52
RD 16,24,18496
s_add_u32 m0, s55, 0
MAA 100,72,52
buffer_load_dwordx4 v21, s[36:39], s52 offen lds
MAA 96,72,48
MAA 112,76,48
TR 28,25,50688
MAA 108,76,44
TR 30,25,51200
MAA 92,72,44
buffer_load_dwordx4 v28, s[36:39], s52 offen offset:1024 lds
MAA 124,44,80
TR 32,25,50720
MAA 140,44,84
TR 34,25,51232
MAA 144,48,84
buffer_load_dword v22, s[36:39], s52 offen offset:2048 lds
MAA 128,48,80
TR 36,25,51712
s_add_u32 s52, s52, 128
MAA 132,52,80
TR 38,25,52224
MAA 148,52,84
TR 40,25,51744
MAA 152,56,84
buffer_load_dwordx4 v[164:167], v26, s[16:19], s75 offen sc1
MAA 136,56,80
TR 42,25,52256
MAA 156,60,80
MAA 160,60,84
s_waitcnt vmcnt(22) lgkmcnt(8)
s_barrier
MAA 60,20,0
RD 44,30,18496
MAA 76,24,0
RD 48,30,20800
s_add_u32 m0, s56, 111232
MAA 80,24,4
buffer_load_dwordx4 v18, s[20:23], s54 offen lds
MAA 64,20,4
s_sub_u32 s47, s47, 1
s_cbranch_scc1 .Lx30
.Lx30b:
MAA 68,20,8
RD 52,30,23104
MAA 84,24,8
buffer_load_dwordx4 v19, s[20:23], s54 offen offset:1024 lds
MAA 88,24,12
RD 56,30,25408
MAA 72,20,12
TR 64,25,62080
s_waitcnt lgkmcnt(5)
MAA 244,24,16
TR 66,25,62592
MAA 104,28,12
buffer_load_dwordx4 v20, s[20:23], s54 offen offset:2048 lds
MAA 120,32,12
TR 68,25,62112
s_add_u32 s54, s54, 196608
MAA 116,32,8
TR 70,25,62624
s_add_u32 m0, s55, 2304
MAA 100,28,8
buffer_load_dwordx4 v21, s[36:39], s53 offen lds
MAA 96,28,4
RD 60,31,18496
MAA 112,32,4
TR 72,25,63104
MAA 108,32,0
TR 74,25,63616
MAA 92,28,0
buffer_load_dwordx4 v28, s[36:39], s53 offen offset:1024 lds
MAA 124,0,36
TR 76,25,63136
MAA 140,0,40
TR 78,25,63648
MAA 144,4,40
buffer_load_dword v29, s[36:39], s53 offen offset:2048 lds
MAA 128,4,36
TR 80,25,64128
s_add_u32 s53, s53, 128
MAA 132,8,36
TR 82,25,64640
MAA 148,8,40
TR 84,25,64160
MAA 152,12,40
buffer_load_dwordx4 v[168:171], v26, s[16:19], s75 offen offset:1024 sc1
MAA 136,12,36
TR 86,25,64672
MAA 156,16,36
MAA 160,16,40
s_waitcnt vmcnt(23) lgkmcnt(8)
s_barrier
MAA 60,64,44
RD 0,23,36992
MAA 76,68,44
RD 4,23,39296
s_add_u32 m0, s56, 123648
MAA 80,68,48
buffer_load_dwordx4 v18, s[20:23], s54 offen lds
MAA 64,64,48
RD 8,23,41600
MAA 68,64,52
RD 12,23,43904
MAA 84,68,52
buffer_load_dwordx4 v19, s[20:23], s54 offen offset:1024 lds
MAA 88,68,56
ds_read_b64_tr_b16 a[20:21], v25
MAA 72,64,56
TR 22,25,512
s_waitcnt lgkmcnt(6)
MAA 244,68,60
TR 24,25,32
MAA 104,72,56
buffer_load_dwordx4 v20, s[20:23], s54 offen offset:2048 lds
MAA 120,76,56
TR 26,25,544
s_add_u32 s54, s54, 196608
MAA 116,76,52
RD 16,24,36992
s_add_u32 m0, s55, 18496
MAA 100,72,52
buffer_load_dwordx4 v21, s[36:39], s52 offen lds
MAA 96,72,48
MAA 112,76,48
TR 28,25,1024
MAA 108,76,44
TR 30,25,1536
MAA 92,72,44
buffer_load_dwordx4 v28, s[36:39], s52 offen offset:1024 lds
MAA 124,44,80
TR 32,25,1056
MAA 140,44,84
TR 34,25,1568
MAA 144,48,84
buffer_load_dword v22, s[36:39], s52 offen offset:2048 lds
MAA 128,48,80
TR 36,25,2048
s_add_u32 s52, s52, 128
MAA 132,52,80
TR 38,25,2560
MAA 148,52,84
TR 40,25,2080
MAA 152,56,84
buffer_load_dwordx4 v[172:175], v26, s[16:19], s75 offen offset:2048 sc1
MAA 136,56,80
TR 42,25,2592
MAA 156,60,80
MAA 160,60,84
s_waitcnt vmcnt(24) lgkmcnt(8)
s_barrier
MAA 60,20,0
RD 44,30,36992
MAA 76,24,0
RD 48,30,39296
s_add_u32 m0, s56, 136064
MAA 80,24,4
buffer_load_dwordx4 v18, s[20:23], s54 offen lds
MAA 64,20,4
s_sub_u32 s47, s47, 1
s_cbranch_scc1 .Lx31
.Lx31b:
MAA 68,20,8
RD 52,30,41600
MAA 84,24,8
buffer_load_dwordx4 v19, s[20:23], s54 offen offset:1024 lds
MAA 88,24,12
RD 56,30,43904
MAA 72,20,12
TR 64,25,12416
s_waitcnt lgkmcnt(5)
MAA 244,24,16
TR 66,25,12928
MAA 104,28,12
buffer_load_dwordx4 v20, s[20:23], s54 offen offset:2048 lds
MAA 120,32,12
TR 68,25,12448
s_add_u32 s54, s54, 196608
MAA 116,32,8
TR 70,25,12960
s_add_u32 m0, s55, 20800
MAA 100,28,8
buffer_load_dwordx4 v21, s[36:39], s53 offen lds
MAA 96,28,4
RD 60,31,36992
MAA 112,32,4
TR 72,25,13440
MAA 108,32,0
TR 74,25,13952
MAA 92,28,0
buffer_load_dwordx4 v28, s[36:39], s53 offen offset:1024 lds
MAA 124,0,36
TR 76,25,13472
MAA 140,0,40
TR 78,25,13984
MAA 144,4,40
buffer_load_dword v29, s[36:39], s53 offen offset:2048 lds
MAA 128,4,36
TR 80,25,14464
s_add_u32 s53, s53, 128
MAA 132,8,36
TR 82,25,14976
MAA 148,8,40
TR 84,25,14496
MAA 152,12,40
buffer_load_dwordx4 v[176:179], v26, s[16:19], s75 offen offset:3072 sc1
MAA 136,12,36
TR 86,25,15008
s_add_u32 s75, s75, 4096
MAA 156,16,36
MAA 160,16,40
s_waitcnt vmcnt(25) lgkmcnt(8)
s_barrier
MAA 60,64,44
RD 0,23,55488
MAA 76,68,44
RD 4,23,57792
s_add_u32 m0, s56, 73984
MAA 80,68,48
buffer_load_dwordx4 v18, s[20:23], s54 offen lds
MAA 64,64,48
RD 8,23,60096
MAA 68,64,52
RD 12,23,62400
MAA 84,68,52
buffer_load_dwordx4 v19, s[20:23], s54 offen offset:1024 lds
MAA 88,68,56
TR 20,25,24832
MAA 72,64,56
TR 22,25,25344
s_waitcnt lgkmcnt(6)
MAA 244,68,60
TR 24,25,24864
MAA 104,72,56
buffer_load_dwordx4 v20, s[20:23], s54 offen offset:2048 lds
MAA 120,76,56
TR 26,25,25376
s_add_u32 s54, s54, 196608
MAA 116,76,52
RD 16,24,55488
s_add_u32 m0, s55, 36992
MAA 100,72,52
buffer_load_dwordx4 v21, s[36:39], s52 offen lds
MAA 96,72,48
MAA 112,76,48
TR 28,25,25856
MAA 108,76,44
TR 30,25,26368
MAA 92,72,44
buffer_load_dwordx4 v28, s[36:39], s52 offen offset:1024 lds
MAA 124,44,80
TR 32,25,25888
MAA 140,44,84
TR 34,25,26400
MAA 144,48,84
buffer_load_dword v22, s[36:39], s52 offen offset:2048 lds
MAA 128,48,80
TR 36,25,26880
s_add_u32 s52, s52, 128
MAA 132,52,80
TR 38,25,27392
MAA 148,52,84
TR 40,25,26912
MAA 152,56,84
buffer_load_dwordx4 v[180:183], v26, s[16:19], s75 offen sc1
MAA 136,56,80
TR 42,25,27424
MAA 156,60,80
MAA 160,60,84
s_waitcnt vmcnt(25) lgkmcnt(8)
s_barrier
MAA 60,20,0
RD 44,30,55488
s_waitcnt vmcnt(21)
v_add_f32 v164, v164, v168
MAA 76,24,0
RD 48,30,57792
s_add_u32 m0, s56, 86400
MAA 80,24,4
buffer_load_dwordx4 v18, s[20:23], s54 offen lds
MAA 64,20,4
s_sub_u32 s47, s47, 1
s_cbranch_scc1 .Lx32
.Lx32b:
MAA 68,20,8
RD 52,30,60096
MAA 84,24,8
buffer_load_dwordx4 v19, s[20:23], s54 offen offset:1024 lds
MAA 88,24,12
RD 56,30,62400
MAA 72,20,12
TR 64,25,37248
s_waitcnt lgkmcnt(5)
MAA 244,24,16
TR 66,25,37760
v_add_f32 v165, v165, v169
MAA 104,28,12
buffer_load_dwordx4 v20, s[20:23], s54 offen offset:2048 lds
MAA 120,32,12
TR 68,25,37280
s_add_u32 s54, s54, 196608
MAA 116,32,8
TR 70,25,37792
s_add_u32 m0, s55, 39296
MAA 100,28,8
buffer_load_dwordx4 v21, s[36:39], s53 offen lds
MAA 96,28,4
RD 60,31,55488
MAA 112,32,4
TR 72,25,38272
MAA 108,32,0
TR 74,25,38784
MAA 92,28,0
buffer_load_dwordx4 v28, s[36:39], s53 offen offset:1024 lds
MAA 124,0,36
TR 76,25,38304
v_add_f32 v166, v166, v170
MAA 140,0,40
TR 78,25,38816
MAA 144,4,40
buffer_load_dword v29, s[36:39], s53 offen offset:2048 lds
MAA 128,4,36
TR 80,25,39296
s_add_u32 s53, s53, 128
MAA 132,8,36
TR 82,25,39808
MAA 148,8,40
TR 84,25,39328
v_add_f32 v167, v167, v171
MAA 152,12,40
buffer_load_dwordx4 v[184:187], v26, s[16:19], s75 offen offset:1024 sc1
MAA 136,12,36
TR 86,25,39840
MAA 156,16,36
MAA 160,16,40
s_waitcnt vmcnt(25) lgkmcnt(8)
s_barrier
MAA 60,64,44
ds_read_b128 a[0:3], v23
s_waitcnt vmcnt(21)
v_add_f32 v164, v164, v172
MAA 76,68,44
RD 4,23,2304
s_add_u32 m0, s56, 98816
MAA 80,68,48
buffer_load_dwordx4 v18, s[20:23], s54 offen lds
MAA 64,64,48
RD 8,23,4608
v_add_f32 v165, v165, v173
MAA 68,64,52
RD 12,23,6912
v_add_f32 v166, v166, v174
MAA 84,68,52
buffer_load_dwordx4 v19, s[20:23], s54 offen offset:1024 lds
MAA 88,68,56
TR 20,25,49664
v_add_f32 v167, v167, v175
MAA 72,64,56
TR 22,25,50176
s_waitcnt lgkmcnt(6)
MAA 244,68,60
buffer_load_dwordx4 v20, s[20:23], s54 offen offset:2048 lds
MAA 104,72,56
TR 24,25,49696
s_add_u32 s54, s54, 196608
MAA 120,76,56
TR 26,25,50208
s_add_u32 m0, s55, 55488
MAA 116,76,52
buffer_load_dwordx4 v21, s[36:39], s52 offen lds
MAA 100,72,52
ds_read_b128 a[16:19], v24
MAA 96,72,48
TR 28,25,50688
MAA 112,76,48
buffer_load_dwordx4 v28, s[36:39], s52 offen offset:1024 lds
MAA 108,76,44
TR 30,25,51200
MAA 92,72,44
TR 32,25,50720
MAA 124,44,80
buffer_load_dword v22, s[36:39], s52 offen offset:2048 lds
MAA 140,44,84
TR 34,25,51232
s_add_u32 s52, s52, 128
MAA 144,48,84
TR 36,25,51712
MAA 128,48,80
buffer_load_dwordx4 v[188:191], v26, s[16:19], s75 offen offset:2048 sc1
MAA 132,52,80
TR 38,25,52224
MAA 148,52,84
TR 40,25,51744
MAA 152,56,84
TR 42,25,52256
MAA 136,56,80
MAA 156,60,80
MAA 160,60,84
s_waitcnt vmcnt(25) lgkmcnt(8)
s_barrier
MAA 60,20,0
ds_read_b128 a[44:47], v30
s_waitcnt vmcnt(21)
v_add_f32 v164, v164, v176
MAA 76,24,0
RD 48,30,2304
s_add_u32 m0, s56, 111232
MAA 80,24,4
buffer_load_dwordx4 v18, s[20:23], s54 offen lds
MAA 64,20,4
RD 52,30,4608
v_add_f32 v165, v165, v177
MAA 68,20,8
RD 56,30,6912
v_add_f32 v166, v166, v178
MAA 84,24,8
buffer_load_dwordx4 v19, s[20:23], s54 offen offset:1024 lds
MAA 88,24,12
TR 64,25,62080
v_add_f32 v167, v167, v179
MAA 72,20,12
TR 66,25,62592
s_waitcnt lgkmcnt(6)
MAA 244,24,16
buffer_load_dwordx4 v20, s[20:23], s54 offen offset:2048 lds
MAA 104,28,12
TR 68,25,62112
s_add_u32 s54, s54, 196608
MAA 120,32,12
TR 70,25,62624
s_add_u32 m0, s55, 57792
MAA 116,32,8
buffer_load_dwordx4 v21, s[36:39], s53 offen lds
MAA 100,28,8
ds_read_b128 a[60:63], v31
MAA 96,28,4
TR 72,25,63104
MAA 112,32,4
buffer_load_dwordx4 v28, s[36:39], s53 offen offset:1024 lds
MAA 108,32,0
TR 74,25,63616
MAA 92,28,0
TR 76,25,63136
MAA 124,0,36
buffer_load_dword v29, s[36:39], s53 offen offset:2048 lds
MAA 140,0,40
TR 78,25,63648
s_add_u32 s53, s53, 128
MAA 144,4,40
TR 80,25,64128
MAA 128,4,36
buffer_load_dwordx4 v[192:195], v26, s[16:19], s75 offen offset:3072 sc1
MAA 132,8,36
TR 82,25,64640
MAA 148,8,40
TR 84,25,64160
MAA 152,12,40
TR 86,25,64672
MAA 136,12,36
MAA 156,16,36
MAA 160,16,40
s_waitcnt vmcnt(25) lgkmcnt(8)
s_barrier
MAA 60,64,44
RD 0,23,18496
s_waitcnt vmcnt(21)
v_add_f32 v164, v164, v180
MAA 76,68,44
RD 4,23,20800
s_add_u32 m0, s56, 123648
MAA 80,68,48
buffer_load_dwordx4 v18, s[20:23], s54 offen lds
MAA 64,64,48
RD 8,23,23104
v_add_f32 v165, v165, v181
MAA 68,64,52
RD 12,23,25408
v_add_f32 v166, v166, v182
MAA 84,68,52
ds_read_b64_tr_b16 a[20:21], v25
v_add_f32 v167, v167, v183
MAA 88,68,56
TR 22,25,512
MAA 72,64,56
TR 24,25,32
s_waitcnt lgkmcnt(7)
MAA 244,68,60
TR 26,25,544
MAA 104,72,56
RD 16,24,18496
MAA 120,76,56
buffer_load_dwordx4 v19, s[20:23], s54 offen offset:1024 lds
MAA 116,76,52
TR 28,25,1024
MAA 100,72,52
TR 30,25,1536
MAA 96,72,48
TR 32,25,1056
MAA 112,76,48
TR 34,25,1568
MAA 108,76,44
TR 36,25,2048
MAA 92,72,44
TR 38,25,2560
MAA 124,44,80
TR 40,25,2080
MAA 140,44,84
buffer_load_dwordx4 v20, s[20:23], s54 offen offset:2048 lds
MAA 144,48,84
TR 42,25,2592
s_add_u32 s54, s54, 196608
MAA 128,48,80
MAA 132,52,80
MAA 148,52,84
MAA 152,56,84
MAA 136,56,80
MAA 156,60,80
MAA 160,60,84
s_waitcnt vmcnt(21) lgkmcnt(8)
s_barrier
MAA 60,20,0
RD 44,30,18496
s_waitcnt vmcnt(17)
v_add_f32 v164, v164, v184
MAA 76,24,0
RD 48,30,20800
s_add_u32 m0, s56, 136064
MAA 80,24,4
buffer_load_dwordx4 v18, s[20:23], s54 offen lds
MAA 64,20,4
RD 52,30,23104
v_add_f32 v165, v165, v185
MAA 68,20,8
RD 56,30,25408
v_add_f32 v166, v166, v186
MAA 84,24,8
TR 64,25,12416
v_add_f32 v167, v167, v187
MAA 88,24,12
TR 66,25,12928
MAA 72,20,12
TR 68,25,12448
s_waitcnt lgkmcnt(7)
MAA 244,24,16
TR 70,25,12960
MAA 104,28,12
RD 60,31,18496
MAA 120,32,12
buffer_load_dwordx4 v19, s[20:23], s54 offen offset:1024 lds
MAA 116,32,8
TR 72,25,13440
MAA 100,28,8
TR 74,25,13952
MAA 96,28,4
TR 76,25,13472
MAA 112,32,4
TR 78,25,13984
MAA 108,32,0
TR 80,25,14464
MAA 92,28,0
TR 82,25,14976
MAA 124,0,36
TR 84,25,14496
MAA 140,0,40
buffer_load_dwordx4 v20, s[20:23], s54 offen offset:2048 lds
MAA 144,4,40
TR 86,25,15008
s_add_u32 s54, s54, 196608
MAA 128,4,36
MAA 132,8,36
MAA 148,8,40
MAA 152,12,40
MAA 136,12,36
MAA 156,16,36
MAA 160,16,40
s_waitcnt vmcnt(17) lgkmcnt(8)
s_barrier
MAA 60,64,44
RD 0,23,36992
s_waitcnt vmcnt(13)
v_add_f32 v164, v164, v188
MAA 76,68,44
RD 4,23,39296
s_add_u32 m0, s59, 0
MAA 80,68,48
RD 8,23,41600
s_mov_b32 s58, 1048576
MAA 64,64,48
buffer_load_dwordx4 v5, s[24:27], s58 offen lds
MAA 68,64,52
RD 12,23,43904
v_add_f32 v165, v165, v189
MAA 84,68,52
TR 20,25,24832
v_add_f32 v166, v166, v190
MAA 88,68,56
TR 22,25,25344
v_add_f32 v167, v167, v191
MAA 72,64,56
buffer_load_dwordx4 v6, s[24:27], s58 offen offset:1024 lds
s_waitcnt lgkmcnt(6)
MAA 244,68,60
TR 24,25,24864
s_add_u32 m0, s59, 8320
MAA 104,72,56
TR 26,25,25376
s_mov_b32 s58, 1179648
MAA 120,76,56
RD 16,24,36992
MAA 116,76,52
buffer_load_dwordx4 v5, s[24:27], s58 offen lds
MAA 100,72,52
TR 28,25,25856
MAA 96,72,48
TR 30,25,26368
MAA 112,76,48
TR 32,25,25888
MAA 108,76,44
buffer_load_dwordx4 v6, s[24:27], s58 offen offset:1024 lds
MAA 92,72,44
TR 34,25,26400
s_add_u32 m0, s59, 16640
MAA 124,44,80
TR 36,25,26880
s_mov_b32 s58, 1310720
MAA 140,44,84
TR 38,25,27392
MAA 144,48,84
buffer_load_dwordx4 v5, s[24:27], s58 offen lds
MAA 128,48,80
TR 40,25,26912
MAA 132,52,80
TR 42,25,27424
MAA 148,52,84
MAA 152,56,84
buffer_load_dwordx4 v6, s[24:27], s58 offen offset:1024 lds
MAA 136,56,80
MAA 156,60,80
MAA 160,60,84
s_waitcnt vmcnt(16) lgkmcnt(8)
s_barrier
MAA 60,20,0
RD 44,30,36992
s_waitcnt vmcnt(12)
v_add_f32 v164, v164, v192
MAA 76,24,0
RD 48,30,39296
s_add_u32 m0, s59, 24960
MAA 80,24,4
RD 52,30,41600
s_mov_b32 s58, 1441792
MAA 64,20,4
buffer_load_dwordx4 v5, s[24:27], s58 offen lds
MAA 68,20,8
RD 56,30,43904
v_add_f32 v165, v165, v193
MAA 84,24,8
TR 64,25,37248
v_add_f32 v166, v166, v194
MAA 88,24,12
TR 66,25,37760
v_add_f32 v167, v167, v195
MAA 72,20,12
buffer_load_dwordx4 v6, s[24:27], s58 offen offset:1024 lds
s_waitcnt lgkmcnt(6)
MAA 244,24,16
TR 68,25,37280
s_add_u32 m0, s59, 74880
MAA 104,28,12
TR 70,25,37792
s_mov_b32 s58, 131072
MAA 120,32,12
RD 60,31,36992
MAA 116,32,8
buffer_load_dwordx4 v5, s[24:27], s58 offen lds
MAA 100,28,8
TR 72,25,38272
MAA 96,28,4
TR 74,25,38784
MAA 112,32,4
TR 76,25,38304
MAA 108,32,0
buffer_load_dwordx4 v6, s[24:27], s58 offen offset:1024 lds
MAA 92,28,0
TR 78,25,38816
s_add_u32 m0, s59, 83200
MAA 124,0,36
TR 80,25,39296
s_mov_b32 s58, 262144
MAA 140,0,40
TR 82,25,39808
MAA 144,4,40
buffer_load_dwordx4 v5, s[24:27], s58 offen lds
MAA 128,4,36
TR 84,25,39328
MAA 132,8,36
TR 86,25,39840
MAA 148,8,40
MAA 152,12,40
buffer_load_dwordx4 v6, s[24:27], s58 offen offset:1024 lds
MAA 136,12,36
MAA 156,16,36
MAA 160,16,40
s_waitcnt vmcnt(15) lgkmcnt(8)
s_barrier
MAA 60,64,44
RD 0,23,55488
MAA 76,68,44
RD 4,23,57792
s_add_u32 m0, s59, 33280
MAA 80,68,48
RD 8,23,60096
s_mov_b32 s58, 1572864
MAA 64,64,48
buffer_load_dwordx4 v5, s[24:27], s58 offen lds
MAA 68,64,52
RD 12,23,62400
MAA 84,68,52
TR 20,25,49664
MAA 88,68,56
TR 22,25,50176
MAA 72,64,56
buffer_load_dwordx4 v6, s[24:27], s58 offen offset:1024 lds
s_waitcnt lgkmcnt(6)
MAA 244,68,60
TR 24,25,49696
s_add_u32 m0, s59, 41600
MAA 104,72,56
TR 26,25,50208
s_mov_b32 s58, 1703936
MAA 120,76,56
RD 16,24,55488
MAA 116,76,52
buffer_load_dwordx4 v5, s[24:27], s58 offen lds
MAA 100,72,52
TR 28,25,50688
MAA 96,72,48
TR 30,25,51200
MAA 112,76,48
TR 32,25,50720
MAA 108,76,44
buffer_load_dwordx4 v6, s[24:27], s58 offen offset:1024 lds
MAA 92,72,44
TR 34,25,51232
s_add_u32 m0, s59, 91520
MAA 124,44,80
TR 36,25,51712
s_mov_b32 s58, 393216
MAA 140,44,84
TR 38,25,52224
MAA 144,48,84
buffer_load_dwordx4 v5, s[24:27], s58 offen lds
MAA 128,48,80
TR 40,25,51744
MAA 132,52,80
TR 42,25,52256
MAA 148,52,84
v_permlane32_swap_b32 v164, v166
MAA 152,56,84
buffer_load_dwordx4 v6, s[24:27], s58 offen offset:1024 lds
MAA 136,56,80
v_permlane32_swap_b32 v165, v167
MAA 156,60,80
v_add_f32 v164, v164, v166
v_add_f32 v165, v165, v167
MAA 160,60,84
v_mul_f32 v164, 0xba800000, v164
v_mul_f32 v165, 0x3a800000, v165
v_fma_f32 v165, -v164, v164, v165
v_max_f32 v165, 0, v165
v_add_f32 v165, 0x3727c5ac, v165
s_waitcnt vmcnt(18) lgkmcnt(8)
s_barrier
MAA 60,20,0
ds_write_b32 v17, v164
MAA 76,24,0
RD 44,30,55488
s_add_u32 m0, s59, 99840
MAA 80,24,4
RD 48,30,57792
s_mov_b32 s58, 524288
MAA 64,20,4
buffer_load_dwordx4 v5, s[24:27], s58 offen lds
MAA 68,20,8
RD 52,30,60096
MAA 84,24,8
RD 56,30,62400
MAA 88,24,12
TR 64,25,62080
MAA 72,20,12
TR 66,25,62592
s_waitcnt lgkmcnt(7)
MAA 244,24,16
TR 68,25,62112
MAA 104,28,12
buffer_load_dwordx4 v6, s[24:27], s58 offen offset:1024 lds
MAA 120,32,12
TR 70,25,62624
s_add_u32 m0, s59, 108160
MAA 116,32,8
RD 60,31,55488
s_mov_b32 s58, 655360
MAA 100,28,8
TR 72,25,63104
MAA 96,28,4
TR 74,25,63616
MAA 112,32,4
TR 76,25,63136
MAA 108,32,0
buffer_load_dwordx4 v5, s[24:27], s58 offen lds
MAA 92,28,0
TR 78,25,63648
MAA 124,0,36
TR 80,25,64128
MAA 140,0,40
TR 82,25,64640
MAA 144,4,40
TR 84,25,64160
MAA 128,4,36
TR 86,25,64672
MAA 132,8,36
buffer_load_dwordx4 v6, s[24:27], s58 offen offset:1024 lds
MAA 148,8,40
v_rsq_f32 v166, v165
MAA 152,12,40
v_mov_b32 v165, v166
v_mul_f32 v166, 0x3e8293ee, v166
MAA 136,12,36
ds_write_b128 v7, v[164:167]
MAA 156,16,36
ds_write_b32 v17, v165 offset:1024
MAA 160,16,40
s_waitcnt lgkmcnt(0)
s_barrier
MAA 244,68,60
ds_read_b128 v[232:235], v10 offset:1792
MAA 156,60,80
ds_read_b128 v[228:231], v10 offset:1536
MAA 160,60,84
ds_read_b128 v[224:227], v10 offset:1280
MAA 104,72,56
ds_read_b128 v[220:223], v10 offset:1024
MAA 120,76,56
MAA 136,56,80
MAA 152,56,84
MAA 100,72,52
MAA 116,76,52
s_mov_b32 exec_lo, 0x10001
s_mov_b32 exec_hi, 0x10001
ds_write_b128 v13, v[244:247] offset:64
s_mov_b64 exec, 0xffff
ds_write_b32 v12, v156 offset:512
ds_write_b32 v12, v160 offset:576
s_mov_b64 exec, -1
MAA 96,72,48
MAA 112,76,48
MAA 92,72,44
MAA 108,76,44
MAA 72,64,56
MAA 88,68,56
s_waitcnt lgkmcnt(0)
s_barrier
MAA 132,52,80
ds_read_b128 v[28:31], v13
s_add_u32 m0, s59, 49920
MAA 148,52,84
ds_read_b128 v[32:35], v13 offset:64
s_mov_b32 s58, 1835008
MAA 68,64,52
ds_read_b128 v[36:39], v13 offset:256
MAA 84,68,52
ds_read_b128 v[40:43], v13 offset:320
MAA 128,48,80
ds_read_b32 v44, v12 offset:512
MAA 144,48,84
ds_read_b32 v45, v12 offset:576
MAA 64,64,48
ds_read_b128 v[240:243], v11 offset:704
MAA 80,68,48
ds_read_b128 v[244:247], v11 offset:1728
MAA 124,44,80
buffer_load_dwordx4 v5, s[24:27], s58 offen lds
ds_read_b128 v[18:21], v11 offset:448
s_waitcnt lgkmcnt(8)
v_pk_fma_f32 v[72:73], v[28:29], v[232:233], v[72:73] op_sel_hi:[1,0,1]
v_pk_fma_f32 v[74:75], v[30:31], v[232:233], v[74:75] op_sel_hi:[1,0,1]
s_waitcnt lgkmcnt(6)
v_pk_fma_f32 v[104:105], v[36:37], v[232:233], v[104:105] op_sel_hi:[1,0,1]
v_pk_mul_f32 v[104:105], v[104:105], v[232:233] op_sel:[0,1] op_sel_hi:[1,1]
v_pk_fma_f32 v[106:107], v[38:39], v[232:233], v[106:107] op_sel_hi:[1,0,1]
v_pk_mul_f32 v[106:107], v[106:107], v[232:233] op_sel:[0,1] op_sel_hi:[1,1]
s_waitcnt lgkmcnt(5)
v_pk_fma_f32 v[120:121], v[40:41], v[232:233], v[120:121] op_sel_hi:[1,0,1]
v_pk_mul_f32 v[120:121], v[120:121], v[232:233] op_sel:[0,1] op_sel_hi:[1,1]
v_pk_fma_f32 v[122:123], v[42:43], v[232:233], v[122:123] op_sel_hi:[1,0,1]
v_pk_mul_f32 v[122:123], v[122:123], v[232:233] op_sel:[0,1] op_sel_hi:[1,1]
v_pk_fma_f32 v[100:101], v[36:37], v[228:229], v[100:101] op_sel_hi:[1,0,1]
v_pk_mul_f32 v[100:101], v[100:101], v[228:229] op_sel:[0,1] op_sel_hi:[1,1]
v_pk_fma_f32 v[102:103], v[38:39], v[228:229], v[102:103] op_sel_hi:[1,0,1]
v_pk_mul_f32 v[102:103], v[102:103], v[228:229] op_sel:[0,1] op_sel_hi:[1,1]
v_pk_fma_f32 v[116:117], v[40:41], v[228:229], v[116:117] op_sel_hi:[1,0,1]
v_pk_mul_f32 v[116:117], v[116:117], v[228:229] op_sel:[0,1] op_sel_hi:[1,1]
v_pk_fma_f32 v[118:119], v[42:43], v[228:229], v[118:119] op_sel_hi:[1,0,1]
v_pk_mul_f32 v[118:119], v[118:119], v[228:229] op_sel:[0,1] op_sel_hi:[1,1]
s_waitcnt lgkmcnt(2)
v_pk_fma_f32 v[156:157], v[240:241], v[44:45], v[156:157] op_sel_hi:[1,0,1]
v_pk_fma_f32 v[158:159], v[242:243], v[44:45], v[158:159] op_sel_hi:[1,0,1]
v_pk_fma_f32 v[160:161], v[240:241], v[44:45], v[160:161] op_sel:[0,1,0] op_sel_hi:[1,1,1]
v_pk_fma_f32 v[162:163], v[242:243], v[44:45], v[162:163] op_sel:[0,1,0] op_sel_hi:[1,1,1]
s_waitcnt lgkmcnt(1)
v_pk_mul_f32 v[156:157], v[156:157], v[244:245]
v_pk_mul_f32 v[158:159], v[158:159], v[246:247]
v_pk_mul_f32 v[160:161], v[160:161], v[244:245]
v_pk_mul_f32 v[162:163], v[162:163], v[246:247]
v_pk_fma_f32 v[88:89], v[32:33], v[232:233], v[88:89] op_sel_hi:[1,0,1]
v_pk_fma_f32 v[90:91], v[34:35], v[232:233], v[90:91] op_sel_hi:[1,0,1]
v_pk_fma_f32 v[96:97], v[36:37], v[224:225], v[96:97] op_sel_hi:[1,0,1]
s_waitcnt lgkmcnt(0)
v_pk_fma_f32 v[136:137], v[18:19], v[44:45], v[136:137] op_sel_hi:[1,0,1]
v_pk_fma_f32 v[138:139], v[20:21], v[44:45], v[138:139] op_sel_hi:[1,0,1]
v_pk_fma_f32 v[152:153], v[18:19], v[44:45], v[152:153] op_sel:[0,1,0] op_sel_hi:[1,1,1]
v_pk_fma_f32 v[154:155], v[20:21], v[44:45], v[154:155] op_sel:[0,1,0] op_sel_hi:[1,1,1]
v_pk_mul_f32 v[96:97], v[96:97], v[224:225] op_sel:[0,1] op_sel_hi:[1,1]
v_pk_fma_f32 v[98:99], v[38:39], v[224:225], v[98:99] op_sel_hi:[1,0,1]
v_pk_mul_f32 v[98:99], v[98:99], v[224:225] op_sel:[0,1] op_sel_hi:[1,1]
v_pk_fma_f32 v[112:113], v[40:41], v[224:225], v[112:113] op_sel_hi:[1,0,1]
v_pk_mul_f32 v[112:113], v[112:113], v[224:225] op_sel:[0,1] op_sel_hi:[1,1]
v_pk_fma_f32 v[114:115], v[42:43], v[224:225], v[114:115] op_sel_hi:[1,0,1]
v_pk_mul_f32 v[114:115], v[114:115], v[224:225] op_sel:[0,1] op_sel_hi:[1,1]
v_pk_fma_f32 v[68:69], v[28:29], v[228:229], v[68:69] op_sel_hi:[1,0,1]
v_pk_fma_f32 v[70:71], v[30:31], v[228:229], v[70:71] op_sel_hi:[1,0,1]
v_pk_fma_f32 v[84:85], v[32:33], v[228:229], v[84:85] op_sel_hi:[1,0,1]
v_pk_fma_f32 v[86:87], v[34:35], v[228:229], v[86:87] op_sel_hi:[1,0,1]
v_pk_fma_f32 v[92:93], v[36:37], v[220:221], v[92:93] op_sel_hi:[1,0,1]
v_pk_mul_f32 v[92:93], v[92:93], v[220:221] op_sel:[0,1] op_sel_hi:[1,1]
v_pk_fma_f32 v[94:95], v[38:39], v[220:221], v[94:95] op_sel_hi:[1,0,1]
v_pk_mul_f32 v[94:95], v[94:95], v[220:221] op_sel:[0,1] op_sel_hi:[1,1]
v_pk_fma_f32 v[108:109], v[40:41], v[220:221], v[108:109] op_sel_hi:[1,0,1]
v_pk_mul_f32 v[108:109], v[108:109], v[220:221] op_sel:[0,1] op_sel_hi:[1,1]
v_pk_fma_f32 v[110:111], v[42:43], v[220:221], v[110:111] op_sel_hi:[1,0,1]
v_pk_mul_f32 v[110:111], v[110:111], v[220:221] op_sel:[0,1] op_sel_hi:[1,1]
v_pk_fma_f32 v[64:65], v[28:29], v[224:225], v[64:65] op_sel_hi:[1,0,1]
v_pk_fma_f32 v[66:67], v[30:31], v[224:225], v[66:67] op_sel_hi:[1,0,1]
v_pk_fma_f32 v[80:81], v[32:33], v[224:225], v[80:81] op_sel_hi:[1,0,1]
v_pk_fma_f32 v[82:83], v[34:35], v[224:225], v[82:83] op_sel_hi:[1,0,1]
v_cvt_pk_bf16_f32 v236, v156, v157
v_cvt_pk_bf16_f32 v237, v158, v159
MAA 140,44,84
buffer_load_dwordx4 v6, s[24:27], s58 offen offset:1024 lds
MAA 60,64,44
ds_read_b128 v[22:25], v11 offset:1472
v_cvt_pk_bf16_f32 v238, v160, v161
MAA 76,68,44
ds_read_b128 v[240:243], v11 offset:384
v_cvt_pk_bf16_f32 v239, v162, v163
ds_write_b128 v8, v[236:239] offset:1024
s_add_u32 m0, s59, 58240
s_mov_b32 s58, 1966080
v_cvt_pk_bf16_f32 v196, v104, v105
buffer_load_dwordx4 v5, s[24:27], s58 offen lds
v_cvt_pk_bf16_f32 v197, v106, v107
v_cvt_pk_bf16_f32 v198, v120, v121
v_cvt_pk_bf16_f32 v199, v122, v123
v_cvt_pk_bf16_f32 v192, v100, v101
v_cvt_pk_bf16_f32 v193, v102, v103
v_cvt_pk_bf16_f32 v194, v116, v117
v_cvt_pk_bf16_f32 v195, v118, v119
v_cvt_pk_bf16_f32 v176, v72, v73
v_cvt_pk_bf16_f32 v177, v74, v75
v_cvt_pk_bf16_f32 v178, v88, v89
v_cvt_pk_bf16_f32 v179, v90, v91
v_pk_fma_f32 v[60:61], v[28:29], v[220:221], v[60:61] op_sel_hi:[1,0,1]
v_pk_fma_f32 v[62:63], v[30:31], v[220:221], v[62:63] op_sel_hi:[1,0,1]
v_pk_fma_f32 v[76:77], v[32:33], v[220:221], v[76:77] op_sel_hi:[1,0,1]
v_pk_fma_f32 v[78:79], v[34:35], v[220:221], v[78:79] op_sel_hi:[1,0,1]
ds_read_b128 v[244:247], v11 offset:1408
s_nop 0
v_mfma_f32_16x16x32_bf16 v[104:107], v[192:195], v[176:179], v[46:49]
buffer_load_dwordx4 v6, s[24:27], s58 offen offset:1024 lds
s_add_u32 m0, s59, 66560
s_mov_b32 s58, 0
v_cvt_pk_bf16_f32 v188, v96, v97
s_waitcnt lgkmcnt(3)
v_pk_mul_f32 v[136:137], v[136:137], v[22:23]
v_pk_mul_f32 v[138:139], v[138:139], v[24:25]
v_pk_mul_f32 v[152:153], v[152:153], v[22:23]
v_pk_mul_f32 v[154:155], v[154:155], v[24:25]
s_waitcnt lgkmcnt(2)
v_pk_fma_f32 v[132:133], v[240:241], v[44:45], v[132:133] op_sel_hi:[1,0,1]
v_pk_fma_f32 v[134:135], v[242:243], v[44:45], v[134:135] op_sel_hi:[1,0,1]
v_pk_fma_f32 v[148:149], v[240:241], v[44:45], v[148:149] op_sel:[0,1,0] op_sel_hi:[1,1,1]
v_pk_fma_f32 v[150:151], v[242:243], v[44:45], v[150:151] op_sel:[0,1,0] op_sel_hi:[1,1,1]
s_waitcnt lgkmcnt(1)
s_barrier
v_cvt_pk_bf16_f32 v208, v136, v137
v_mfma_f32_16x16x32_bf16 v[120:123], v[196:199], v[176:179], v[50:53]
ds_read_b128 v[180:183], v9
ds_read_b64 v[200:201], v9 offset:1024
ds_read_b64 v[210:211], v9 offset:1032
buffer_load_dwordx4 v5, s[24:27], s58 offen lds
v_cvt_pk_bf16_f32 v209, v138, v139
v_cvt_pk_bf16_f32 v218, v152, v153
v_cvt_pk_bf16_f32 v219, v154, v155
s_waitcnt lgkmcnt(3)
v_pk_mul_f32 v[132:133], v[132:133], v[244:245]
v_cvt_pk_bf16_f32 v206, v132, v133
v_pk_mul_f32 v[134:135], v[134:135], v[246:247]
v_cvt_pk_bf16_f32 v207, v134, v135
v_pk_mul_f32 v[148:149], v[148:149], v[244:245]
v_cvt_pk_bf16_f32 v216, v148, v149
v_pk_mul_f32 v[150:151], v[150:151], v[246:247]
v_cvt_pk_bf16_f32 v217, v150, v151
v_max3_f32 v88, v104, v105, v106
v_max3_f32 v89, v107, v120, v121
buffer_load_dwordx4 v6, s[24:27], s58 offen offset:1024 lds
s_add_u32 m0, s59, 116480
s_mov_b32 s58, 786432
v_max3_f32 v88, v88, v122, v123
v_max_f32 v90, v88, v89
v_max_f32 v89, v88, v89
v_cvt_pk_bf16_f32 v189, v98, v99
v_cvt_pk_bf16_f32 v190, v112, v113
v_permlane16_swap_b32 v90, v89
v_cvt_pk_bf16_f32 v191, v114, v115
v_max_f32 v88, v90, v89
v_max_f32 v89, v90, v89
v_cvt_pk_bf16_f32 v172, v68, v69
buffer_load_dwordx4 v5, s[24:27], s58 offen lds
v_permlane32_swap_b32 v88, v89
v_cvt_pk_bf16_f32 v173, v70, v71
v_max_f32 v88, v88, v89
v_mul_f32 v88, v88, v234
v_pk_fma_f32 v[104:105], v[104:105], v[234:235], v[88:89] op_sel_hi:[1,0,0] neg_lo:[0,0,1] neg_hi:[0,0,1]
v_pk_fma_f32 v[106:107], v[106:107], v[234:235], v[88:89] op_sel_hi:[1,0,0] neg_lo:[0,0,1] neg_hi:[0,0,1]
v_pk_fma_f32 v[120:121], v[120:121], v[234:235], v[88:89] op_sel_hi:[1,0,0] neg_lo:[0,0,1] neg_hi:[0,0,1]
v_pk_fma_f32 v[122:123], v[122:123], v[234:235], v[88:89] op_sel_hi:[1,0,0] neg_lo:[0,0,1] neg_hi:[0,0,1]
v_exp_f32 v104, v104
v_exp_f32 v105, v105
v_exp_f32 v106, v106
v_exp_f32 v107, v107
v_exp_f32 v120, v120
v_exp_f32 v121, v121
v_exp_f32 v122, v122
v_exp_f32 v123, v123
v_cvt_pk_bf16_f32 v72, v104, v105
buffer_load_dwordx4 v6, s[24:27], s58 offen offset:1024 lds
s_add_u32 m0, s59, 124800
s_mov_b32 s58, 917504
v_cvt_pk_bf16_f32 v73, v106, v107
v_cvt_pk_bf16_f32 v74, v120, v121
v_cvt_pk_bf16_f32 v75, v122, v123
v_cvt_pk_bf16_f32 v174, v84, v85
v_cvt_pk_bf16_f32 v175, v86, v87
v_mfma_f32_16x16x32_bf16 v[88:91], v[248:251], v[72:75], 0
ds_read_b128 v[18:21], v11 offset:320
v_cvt_pk_bf16_f32 v184, v92, v93
v_mfma_f32_16x16x32_bf16 v[104:107], v[206:209], v[72:75], 0
ds_read_b128 v[22:25], v11 offset:1344
v_cvt_pk_bf16_f32 v185, v94, v95
v_mfma_f32_16x16x32_bf16 v[120:123], v[216:219], v[72:75], 0
buffer_load_dwordx4 v5, s[24:27], s58 offen lds
v_mfma_f32_16x16x32_bf16 v[100:103], v[188:191], v[172:175], v[46:49]
ds_read_b128 v[240:243], v11 offset:256
v_rcp_f32 v88, v88
v_mfma_f32_16x16x32_bf16 v[116:119], v[192:195], v[172:175], v[50:53]
ds_read_b128 v[244:247], v11 offset:1280
v_cvt_pk_bf16_f32 v186, v108, v109
s_nop 2
v_max3_f32 v84, v100, v101, v102
v_cvt_pk_bf16_f32 v187, v110, v111
v_cvt_pk_bf16_f32 v168, v64, v65
v_pk_mul_f32 v[104:105], v[104:105], v[88:89] op_sel_hi:[1,0]
buffer_load_dwordx4 v6, s[24:27], s58 offen offset:1024 lds
v_pk_mul_f32 v[106:107], v[106:107], v[88:89] op_sel_hi:[1,0]
v_pk_mul_f32 v[120:121], v[120:121], v[88:89] op_sel_hi:[1,0]
v_pk_mul_f32 v[122:123], v[122:123], v[88:89] op_sel_hi:[1,0]
v_cvt_pk_bf16_f32 v176, v104, v105
v_cvt_pk_bf16_f32 v177, v106, v107
v_cvt_pk_bf16_f32 v178, v120, v121
v_cvt_pk_bf16_f32 v179, v122, v123
s_waitcnt lgkmcnt(3)
v_pk_fma_f32 v[128:129], v[18:19], v[44:45], v[128:129] op_sel_hi:[1,0,1]
v_pk_fma_f32 v[130:131], v[20:21], v[44:45], v[130:131] op_sel_hi:[1,0,1]
s_waitcnt lgkmcnt(2)
v_pk_mul_f32 v[128:129], v[128:129], v[22:23]
v_cvt_pk_bf16_f32 v204, v128, v129
v_pk_mul_f32 v[130:131], v[130:131], v[24:25]
v_cvt_pk_bf16_f32 v205, v130, v131
buffer_store_dwordx4 v[176:179], v4, s[16:19], s74 offen offset:3072 sc1
v_pk_fma_f32 v[144:145], v[18:19], v[44:45], v[144:145] op_sel:[0,1,0] op_sel_hi:[1,1,1]
v_pk_mul_f32 v[144:145], v[144:145], v[22:23]
v_cvt_pk_bf16_f32 v214, v144, v145
v_pk_fma_f32 v[146:147], v[20:21], v[44:45], v[146:147] op_sel:[0,1,0] op_sel_hi:[1,1,1]
v_pk_mul_f32 v[146:147], v[146:147], v[24:25]
v_cvt_pk_bf16_f32 v215, v146, v147
v_max3_f32 v85, v103, v116, v117
v_max3_f32 v84, v84, v118, v119
v_max_f32 v86, v84, v85
v_max_f32 v85, v84, v85
v_cvt_pk_bf16_f32 v169, v66, v67
v_cvt_pk_bf16_f32 v170, v80, v81
v_permlane16_swap_b32 v86, v85
v_cvt_pk_bf16_f32 v171, v82, v83
s_waitcnt lgkmcnt(1)
v_pk_fma_f32 v[124:125], v[240:241], v[44:45], v[124:125] op_sel_hi:[1,0,1]
s_waitcnt lgkmcnt(0)
v_pk_mul_f32 v[124:125], v[124:125], v[244:245]
v_pk_fma_f32 v[126:127], v[242:243], v[44:45], v[126:127] op_sel_hi:[1,0,1]
v_pk_mul_f32 v[126:127], v[126:127], v[246:247]
v_pk_fma_f32 v[140:141], v[240:241], v[44:45], v[140:141] op_sel:[0,1,0] op_sel_hi:[1,1,1]
v_pk_mul_f32 v[140:141], v[140:141], v[244:245]
v_pk_fma_f32 v[142:143], v[242:243], v[44:45], v[142:143] op_sel:[0,1,0] op_sel_hi:[1,1,1]
v_pk_mul_f32 v[142:143], v[142:143], v[246:247]
v_max_f32 v84, v86, v85
v_max_f32 v85, v86, v85
v_mfma_f32_16x16x32_bf16 v[96:99], v[184:187], v[168:171], v[46:49]
s_nop 0
v_permlane32_swap_b32 v84, v85
v_mfma_f32_16x16x32_bf16 v[112:115], v[188:191], v[168:171], v[50:53]
v_max_f32 v84, v84, v85
v_mul_f32 v84, v84, v230
v_cvt_pk_bf16_f32 v202, v124, v125
v_cvt_pk_bf16_f32 v203, v126, v127
v_cvt_pk_bf16_f32 v212, v140, v141
v_pk_fma_f32 v[100:101], v[100:101], v[230:231], v[84:85] op_sel_hi:[1,0,0] neg_lo:[0,0,1] neg_hi:[0,0,1]
v_pk_fma_f32 v[102:103], v[102:103], v[230:231], v[84:85] op_sel_hi:[1,0,0] neg_lo:[0,0,1] neg_hi:[0,0,1]
v_pk_fma_f32 v[116:117], v[116:117], v[230:231], v[84:85] op_sel_hi:[1,0,0] neg_lo:[0,0,1] neg_hi:[0,0,1]
v_pk_fma_f32 v[118:119], v[118:119], v[230:231], v[84:85] op_sel_hi:[1,0,0] neg_lo:[0,0,1] neg_hi:[0,0,1]
v_exp_f32 v100, v100
v_exp_f32 v101, v101
v_exp_f32 v102, v102
v_exp_f32 v103, v103
v_exp_f32 v116, v116
v_exp_f32 v117, v117
v_exp_f32 v118, v118
v_exp_f32 v119, v119
v_cvt_pk_bf16_f32 v68, v100, v101
v_cvt_pk_bf16_f32 v69, v102, v103
v_cvt_pk_bf16_f32 v70, v116, v117
v_cvt_pk_bf16_f32 v71, v118, v119
v_cvt_pk_bf16_f32 v213, v142, v143
v_max3_f32 v80, v96, v97, v98
v_mfma_f32_16x16x32_bf16 v[84:87], v[248:251], v[68:71], 0
v_max3_f32 v81, v99, v112, v113
v_max3_f32 v80, v80, v114, v115
v_mfma_f32_16x16x32_bf16 v[100:103], v[204:207], v[68:71], 0
v_max_f32 v82, v80, v81
v_max_f32 v81, v80, v81
v_mfma_f32_16x16x32_bf16 v[116:119], v[214:217], v[68:71], 0
s_nop 1
v_rcp_f32 v84, v84
v_permlane16_swap_b32 v82, v81
v_cvt_pk_bf16_f32 v164, v60, v61
v_pk_mul_f32 v[100:101], v[100:101], v[84:85] op_sel_hi:[1,0]
v_pk_mul_f32 v[102:103], v[102:103], v[84:85] op_sel_hi:[1,0]
s_nop 0
v_pk_mul_f32 v[116:117], v[116:117], v[84:85] op_sel_hi:[1,0]
v_pk_mul_f32 v[118:119], v[118:119], v[84:85] op_sel_hi:[1,0]
v_cvt_pk_bf16_f32 v172, v100, v101
v_cvt_pk_bf16_f32 v173, v102, v103
v_cvt_pk_bf16_f32 v174, v116, v117
v_cvt_pk_bf16_f32 v175, v118, v119
buffer_store_dwordx4 v[172:175], v4, s[16:19], s74 offen offset:2048 sc1
v_max_f32 v80, v82, v81
v_max_f32 v81, v82, v81
v_cvt_pk_bf16_f32 v165, v62, v63
v_cvt_pk_bf16_f32 v166, v76, v77
v_permlane32_swap_b32 v80, v81
v_cvt_pk_bf16_f32 v167, v78, v79
v_max_f32 v80, v80, v81
v_mul_f32 v80, v80, v226
v_mfma_f32_16x16x32_bf16 v[92:95], v[180:183], v[164:167], v[46:49]
v_mfma_f32_16x16x32_bf16 v[108:111], v[184:187], v[164:167], v[50:53]
s_nop 6
v_max3_f32 v76, v92, v93, v94
v_pk_fma_f32 v[96:97], v[96:97], v[226:227], v[80:81] op_sel_hi:[1,0,0] neg_lo:[0,0,1] neg_hi:[0,0,1]
v_pk_fma_f32 v[98:99], v[98:99], v[226:227], v[80:81] op_sel_hi:[1,0,0] neg_lo:[0,0,1] neg_hi:[0,0,1]
v_pk_fma_f32 v[112:113], v[112:113], v[226:227], v[80:81] op_sel_hi:[1,0,0] neg_lo:[0,0,1] neg_hi:[0,0,1]
v_pk_fma_f32 v[114:115], v[114:115], v[226:227], v[80:81] op_sel_hi:[1,0,0] neg_lo:[0,0,1] neg_hi:[0,0,1]
v_exp_f32 v96, v96
v_exp_f32 v97, v97
v_exp_f32 v98, v98
v_exp_f32 v99, v99
v_exp_f32 v112, v112
v_exp_f32 v113, v113
v_exp_f32 v114, v114
v_exp_f32 v115, v115
v_cvt_pk_bf16_f32 v64, v96, v97
v_cvt_pk_bf16_f32 v65, v98, v99
v_cvt_pk_bf16_f32 v66, v112, v113
v_cvt_pk_bf16_f32 v67, v114, v115
v_max3_f32 v77, v95, v108, v109
v_max3_f32 v76, v76, v110, v111
v_mfma_f32_16x16x32_bf16 v[80:83], v[248:251], v[64:67], 0
v_max_f32 v78, v76, v77
v_max_f32 v77, v76, v77
v_mfma_f32_16x16x32_bf16 v[96:99], v[202:205], v[64:67], 0
s_nop 0
v_permlane16_swap_b32 v78, v77
v_mfma_f32_16x16x32_bf16 v[112:115], v[212:215], v[64:67], 0
s_nop 1
v_rcp_f32 v80, v80
v_max_f32 v76, v78, v77
v_max_f32 v77, v78, v77
v_pk_mul_f32 v[96:97], v[96:97], v[80:81] op_sel_hi:[1,0]
v_pk_mul_f32 v[98:99], v[98:99], v[80:81] op_sel_hi:[1,0]
s_nop 0
v_pk_mul_f32 v[112:113], v[112:113], v[80:81] op_sel_hi:[1,0]
v_pk_mul_f32 v[114:115], v[114:115], v[80:81] op_sel_hi:[1,0]
v_cvt_pk_bf16_f32 v168, v96, v97
v_cvt_pk_bf16_f32 v169, v98, v99
v_cvt_pk_bf16_f32 v170, v112, v113
v_cvt_pk_bf16_f32 v171, v114, v115
buffer_store_dwordx4 v[168:171], v4, s[16:19], s74 offen offset:1024 sc1
v_permlane32_swap_b32 v76, v77
v_max_f32 v76, v76, v77
v_mul_f32 v76, v76, v222
v_pk_fma_f32 v[92:93], v[92:93], v[222:223], v[76:77] op_sel_hi:[1,0,0] neg_lo:[0,0,1] neg_hi:[0,0,1]
v_pk_fma_f32 v[94:95], v[94:95], v[222:223], v[76:77] op_sel_hi:[1,0,0] neg_lo:[0,0,1] neg_hi:[0,0,1]
v_pk_fma_f32 v[108:109], v[108:109], v[222:223], v[76:77] op_sel_hi:[1,0,0] neg_lo:[0,0,1] neg_hi:[0,0,1]
v_pk_fma_f32 v[110:111], v[110:111], v[222:223], v[76:77] op_sel_hi:[1,0,0] neg_lo:[0,0,1] neg_hi:[0,0,1]
v_exp_f32 v92, v92
v_exp_f32 v93, v93
v_exp_f32 v94, v94
v_exp_f32 v95, v95
v_exp_f32 v108, v108
v_exp_f32 v109, v109
v_exp_f32 v110, v110
v_exp_f32 v111, v111
v_cvt_pk_bf16_f32 v60, v92, v93
v_cvt_pk_bf16_f32 v61, v94, v95
v_cvt_pk_bf16_f32 v62, v108, v109
v_cvt_pk_bf16_f32 v63, v110, v111
s_nop 1
v_mfma_f32_16x16x32_bf16 v[76:79], v[248:251], v[60:63], 0
v_mfma_f32_16x16x32_bf16 v[92:95], v[200:203], v[60:63], 0
v_mfma_f32_16x16x32_bf16 v[108:111], v[210:213], v[60:63], 0
s_nop 5
v_rcp_f32 v76, v76
s_nop 0
v_pk_mul_f32 v[92:93], v[92:93], v[76:77] op_sel_hi:[1,0]
v_pk_mul_f32 v[94:95], v[94:95], v[76:77] op_sel_hi:[1,0]
v_pk_mul_f32 v[108:109], v[108:109], v[76:77] op_sel_hi:[1,0]
v_pk_mul_f32 v[110:111], v[110:111], v[76:77] op_sel_hi:[1,0]
v_cvt_pk_bf16_f32 v164, v92, v93
v_cvt_pk_bf16_f32 v165, v94, v95
v_cvt_pk_bf16_f32 v166, v108, v109
v_cvt_pk_bf16_f32 v167, v110, v111
buffer_store_dwordx4 v[164:167], v4, s[16:19], s74 offen sc1
s_nop 1
.Lqkve2:
s_lshl_b32 s62, s3, 11
s_add_u32 s62, s62, s84
v_lshl_add_u32 v4, v1, 4, s62
v_lshrrev_b32 v2, 3, v1
v_cmp_eq_u32 vcc, 3, v2
v_add_u32 v2, 67108480, v4
s_nop 0
v_cndmask_b32 v4, v4, v2, vcc
v_bfe_u32 v5, v1, 3, 1
v_lshrrev_b32 v2, 4, v1
v_lshl_add_u32 v5, v2, 3, v5
s_lshl_b32 s62, s3, 1
v_add_u32 v5, s62, v5
v_mul_u32_u24 v5, 2048, v5
v_and_b32 v2, 7, v1
v_lshl_add_u32 v5, v2, 4, v5
s_lshl_b32 s62, s7, 7
v_add_u32 v5, s62, v5
v_add_u32 v6, 64512, v5
v_bfe_u32 v8, v1, 3, 2
v_mul_u32_u24 v8, 2080, v8
v_bfe_u32 v2, v1, 2, 1
v_lshl_add_u32 v8, v2, 7, v8
v_bfe_u32 v2, v1, 5, 1
v_lshl_add_u32 v8, v2, 8, v8
v_and_b32 v2, 3, v1
v_lshl_add_u32 v8, v2, 3, v8
s_mov_b32 s57, 66560
v_add_u32 v7, s57, v8
s_mov_b32 s52, 4194304
s_mov_b32 s53, 4325376
s_mov_b32 s54, 2097152
s_mul_i32 s56, s3, 2080
v_accvgpr_read_b32 v32, a224
v_accvgpr_read_b32 v33, a225
v_accvgpr_read_b32 v34, a226
v_accvgpr_read_b32 v35, a227
v_accvgpr_read_b32 v36, a228
v_accvgpr_read_b32 v37, a229
v_accvgpr_read_b32 v38, a230
v_accvgpr_read_b32 v39, a231
v_accvgpr_read_b32 v40, a232
v_accvgpr_read_b32 v41, a233
v_accvgpr_read_b32 v42, a234
v_accvgpr_read_b32 v43, a235
v_accvgpr_read_b32 v44, a236
v_accvgpr_read_b32 v45, a237
v_accvgpr_read_b32 v46, a238
v_accvgpr_read_b32 v47, a239
v_accvgpr_read_b32 v48, a240
v_accvgpr_read_b32 v49, a241
v_accvgpr_read_b32 v50, a242
v_accvgpr_read_b32 v51, a243
v_accvgpr_read_b32 v52, a244
v_accvgpr_read_b32 v53, a245
v_accvgpr_read_b32 v54, a246
v_accvgpr_read_b32 v55, a247
v_accvgpr_read_b32 v56, a248
v_accvgpr_read_b32 v57, a249
v_accvgpr_read_b32 v58, a250
v_accvgpr_read_b32 v59, a251
v_accvgpr_read_b32 v60, a252
v_accvgpr_read_b32 v61, a253
v_accvgpr_read_b32 v62, a254
v_accvgpr_read_b32 v63, a255
s_lshl_b32 s62, s49, 3
s_add_u32 s62, s62, s48
s_mul_i32 s62, s62, 28672
s_add_u32 s62, s62, s51
v_lshrrev_b32 v12, 4, v1
v_mul_u32_u24 v12, 57344, v12
v_and_b32 v2, 15, v1
v_lshl_add_u32 v12, v2, 4, v12
v_add_u32 v12, s62, v12
v_add_u32 v13, 6112, v12
v_add_u32 v14, 12224, v12
v_add_u32 v15, 18336, v12
s_mul_i32 s59, s3, 4224
s_mov_b32 s58, 0
s_mov_b32 s36, s0
s_mov_b32 s37, s1
s_lshl_b32 s62, s8, 10
s_add_u32 s62, s62, 30425088
s_lshl_b32 s64, s6, 10
s_add_u32 s64, s64, 30425088
s_lshr_b32 s67, s5, 2
s_and_b32 s67, s67, 3
s_lshl_b32 s67, s67, 7
s_add_u32 s64, s64, s67
v_lshl_add_u32 v252, v1, 7, s62
v_mov_b32 v253, s64
v_mov_b32 v255, 1
s_waitcnt vmcnt(0) lgkmcnt(0)
s_cmp_lg_u32 s3, 1
s_barrier
s_cbranch_scc1 .Lnopoll34
s_mov_b64 exec, 15
buffer_atomic_add v255, v252, s[16:19], 0 offen
s_mov_b64 exec, 1
v_mov_b32 v254, 0
buffer_atomic_add v254, v253, s[16:19], 0 offen sc0
s_sleep 5
s_mov_b32 s15, 0
.Lpoll33:
v_mov_b32 v255, 0
buffer_atomic_add v255, v253, s[16:19], 0 offen sc0
s_waitcnt vmcnt(1)
v_cmp_gt_u32 vcc, 16, v254
s_add_u32 s15, s15, 1
s_cbranch_vccz .Lnopoll34r
v_mov_b32 v254, 0
buffer_atomic_add v254, v253, s[16:19], 0 offen sc0
s_waitcnt vmcnt(1)
v_cmp_gt_u32 vcc, 16, v255
s_add_u32 s15, s15, 1
s_cbranch_vccz .Lnopoll34r
s_cmp_le_u32 s15, 100000
s_cbranch_scc1 .Lpoll33
s_branch .Lnopoll34r
.Lnopoll34:
s_mov_b64 exec, 0
s_cmp_eq_u32 s3, 2
s_cbranch_scc1 .Lpad1
s_cmp_eq_u32 s3, 3
s_cbranch_scc1 .Lpad2
s_branch .Lpad3
.Lnopoll34r:
s_mov_b64 exec, -1
s_barrier
buffer_load_dwordx4 v[64:67], v4, s[16:19], s52 offen sc1
buffer_load_dwordx4 v[68:71], v4, s[16:19], s52 offen offset:1024 sc1
s_add_u32 s52, s52, 262144
buffer_load_dwordx4 v[72:75], v4, s[16:19], s53 offen sc1
buffer_load_dwordx4 v[76:79], v4, s[16:19], s53 offen offset:1024 sc1
s_add_u32 s53, s53, 262144
buffer_load_dwordx4 v[80:83], v4, s[16:19], s52 offen sc1
buffer_load_dwordx4 v[84:87], v4, s[16:19], s52 offen offset:1024 sc1
s_add_u32 s52, s52, 262144
buffer_load_dwordx4 v[88:91], v4, s[16:19], s53 offen sc1
buffer_load_dwordx4 v[92:95], v4, s[16:19], s53 offen offset:1024 sc1
s_add_u32 s53, s53, 262144
buffer_load_dwordx4 v[96:99], v4, s[16:19], s52 offen sc1
buffer_load_dwordx4 v[100:103], v4, s[16:19], s52 offen offset:1024 sc1
s_add_u32 s52, s52, 262144
buffer_load_dwordx4 v[104:107], v4, s[16:19], s53 offen sc1
buffer_load_dwordx4 v[108:111], v4, s[16:19], s53 offen offset:1024 sc1
s_add_u32 s53, s53, 262144
ds_read_b64_tr_b16 a[0:1], v7
TR 2,7,512
TR 16,7,1024
TR 18,7,1536
TR 4,7,32
TR 6,7,544
TR 20,7,1056
TR 22,7,1568
TR 8,7,64
TR 10,7,576
TR 24,7,1088
TR 26,7,1600
TR 12,7,96
TR 14,7,608
TR 28,7,1120
TR 30,7,1632
s_waitcnt vmcnt(8) lgkmcnt(14)
MAV 32,0,64
TR 32,7,8320
TR 34,7,8832
s_waitcnt lgkmcnt(14)
MAV 32,16,72
buffer_load_dwordx4 v[112:115], v4, s[16:19], s52 offen sc1
MAV 48,16,76
TR 48,7,9344
TR 50,7,9856
MAV 48,0,68
TR 36,7,8352
s_waitcnt lgkmcnt(15)
MAV 52,4,68
buffer_load_dwordx4 v[116:119], v4, s[16:19], s52 offen offset:1024 sc1
s_waitcnt lgkmcnt(13)
MAV 52,20,76
TR 38,7,8864
s_add_u32 s52, s52, 262144
MAV 36,20,72
TR 52,7,9376
MAV 36,4,64
TR 54,7,9888
s_waitcnt lgkmcnt(14)
MAV 40,8,64
buffer_load_dwordx4 v[120:123], v4, s[16:19], s53 offen sc1
s_waitcnt lgkmcnt(12)
MAV 40,24,72
TR 40,7,8384
TR 42,7,8896
MAV 56,24,76
TR 56,7,9408
MAV 56,8,68
TR 58,7,9920
TR 44,7,8416
s_waitcnt lgkmcnt(15)
MAV 60,12,68
buffer_load_dwordx4 v[124:127], v4, s[16:19], s53 offen offset:1024 sc1
s_waitcnt lgkmcnt(13)
MAV 60,28,76
s_add_u32 s53, s53, 262144
MAV 44,28,72
TR 46,7,8928
TR 60,7,9440
MAV 44,12,64
TR 62,7,9952
s_waitcnt vmcnt(8) lgkmcnt(8)
MAV 32,32,80
TR 0,7,16640
TR 2,7,17152
MAV 32,48,88
buffer_load_dwordx4 v[64:67], v4, s[16:19], s52 offen sc1
MAV 48,48,92
TR 16,7,17664
TR 18,7,18176
MAV 48,32,84
TR 4,7,16672
MAV 52,36,84
buffer_load_dwordx4 v[68:71], v4, s[16:19], s52 offen offset:1024 sc1
MAV 52,52,92
TR 6,7,17184
s_add_u32 s52, s52, 262144
MAV 36,52,88
TR 20,7,17696
MAV 36,36,80
TR 22,7,18208
s_waitcnt lgkmcnt(8)
MAV 40,40,80
buffer_load_dwordx4 v[72:75], v4, s[16:19], s53 offen sc1
MAV 40,56,88
TR 8,7,16704
TR 10,7,17216
MAV 56,56,92
TR 24,7,17728
MAV 56,40,84
TR 26,7,18240
TR 12,7,16736
MAV 60,44,84
buffer_load_dwordx4 v[76:79], v4, s[16:19], s53 offen offset:1024 sc1
MAV 60,60,92
s_add_u32 s53, s53, 262144
MAV 44,60,88
TR 14,7,17248
TR 28,7,17760
MAV 44,44,80
TR 30,7,18272
s_waitcnt vmcnt(8) lgkmcnt(8)
MAV 32,0,96
TR 32,7,24960
TR 34,7,25472
MAV 32,16,104
buffer_load_dwordx4 v[80:83], v4, s[16:19], s52 offen sc1
MAV 48,16,108
TR 48,7,25984
TR 50,7,26496
MAV 48,0,100
TR 36,7,24992
MAV 52,4,100
buffer_load_dwordx4 v[84:87], v4, s[16:19], s52 offen offset:1024 sc1
MAV 52,20,108
TR 38,7,25504
s_add_u32 s52, s52, 262144
MAV 36,20,104
TR 52,7,26016
MAV 36,4,96
TR 54,7,26528
s_waitcnt lgkmcnt(8)
MAV 40,8,96
buffer_load_dwordx4 v[88:91], v4, s[16:19], s53 offen sc1
MAV 40,24,104
TR 40,7,25024
TR 42,7,25536
MAV 56,24,108
TR 56,7,26048
MAV 56,8,100
TR 58,7,26560
TR 44,7,25056
MAV 60,12,100
buffer_load_dwordx4 v[92:95], v4, s[16:19], s53 offen offset:1024 sc1
MAV 60,28,108
s_add_u32 s53, s53, 262144
MAV 44,28,104
TR 46,7,25568
TR 60,7,26080
MAV 44,12,96
TR 62,7,26592
s_waitcnt vmcnt(8) lgkmcnt(8)
MAV 32,32,112
TR 0,7,33280
TR 2,7,33792
MAV 32,48,120
buffer_load_dwordx4 v[96:99], v4, s[16:19], s52 offen sc1
MAV 48,48,124
TR 16,7,34304
TR 18,7,34816
MAV 48,32,116
TR 4,7,33312
MAV 52,36,116
buffer_load_dwordx4 v[100:103], v4, s[16:19], s52 offen offset:1024 sc1
MAV 52,52,124
TR 6,7,33824
s_add_u32 s52, s52, 262144
MAV 36,52,120
TR 20,7,34336
MAV 36,36,112
TR 22,7,34848
s_waitcnt lgkmcnt(8)
MAV 40,40,112
buffer_load_dwordx4 v[104:107], v4, s[16:19], s53 offen sc1
MAV 40,56,120
TR 8,7,33344
TR 10,7,33856
MAV 56,56,124
TR 24,7,34368
MAV 56,40,116
TR 26,7,34880
TR 12,7,33376
MAV 60,44,116
buffer_load_dwordx4 v[108:111], v4, s[16:19], s53 offen offset:1024 sc1
MAV 60,60,124
s_add_u32 s53, s53, 262144
MAV 44,60,120
TR 14,7,33888
TR 28,7,34400
MAV 44,44,112
TR 30,7,34912
s_waitcnt vmcnt(8) lgkmcnt(8)
MAV 32,0,64
TR 32,7,41600
TR 34,7,42112
MAV 32,16,72
buffer_load_dwordx4 v[112:115], v4, s[16:19], s52 offen sc1
MAV 48,16,76
TR 48,7,42624
TR 50,7,43136
MAV 48,0,68
TR 36,7,41632
MAV 52,4,68
buffer_load_dwordx4 v[116:119], v4, s[16:19], s52 offen offset:1024 sc1
MAV 52,20,76
TR 38,7,42144
s_add_u32 s52, s52, 262144
MAV 36,20,72
TR 52,7,42656
MAV 36,4,64
TR 54,7,43168
s_waitcnt lgkmcnt(8)
MAV 40,8,64
buffer_load_dwordx4 v[120:123], v4, s[16:19], s53 offen sc1
MAV 40,24,72
TR 40,7,41664
TR 42,7,42176
MAV 56,24,76
TR 56,7,42688
MAV 56,8,68
TR 58,7,43200
TR 44,7,41696
MAV 60,12,68
buffer_load_dwordx4 v[124:127], v4, s[16:19], s53 offen offset:1024 sc1
MAV 60,28,76
s_add_u32 s53, s53, 262144
MAV 44,28,72
TR 46,7,42208
TR 60,7,42720
MAV 44,12,64
TR 62,7,43232
s_waitcnt vmcnt(8) lgkmcnt(8)
MAV 32,32,80
TR 0,7,49920
TR 2,7,50432
MAV 32,48,88
buffer_load_dwordx4 v[64:67], v4, s[16:19], s52 offen sc1
MAV 48,48,92
TR 16,7,50944
TR 18,7,51456
MAV 48,32,84
TR 4,7,49952
MAV 52,36,84
buffer_load_dwordx4 v[68:71], v4, s[16:19], s52 offen offset:1024 sc1
MAV 52,52,92
TR 6,7,50464
s_add_u32 s52, s52, 262144
MAV 36,52,88
TR 20,7,50976
MAV 36,36,80
TR 22,7,51488
s_waitcnt lgkmcnt(8)
MAV 40,40,80
buffer_load_dwordx4 v[72:75], v4, s[16:19], s53 offen sc1
MAV 40,56,88
TR 8,7,49984
TR 10,7,50496
MAV 56,56,92
TR 24,7,51008
MAV 56,40,84
TR 26,7,51520
TR 12,7,50016
MAV 60,44,84
buffer_load_dwordx4 v[76:79], v4, s[16:19], s53 offen offset:1024 sc1
MAV 60,60,92
s_add_u32 s53, s53, 262144
MAV 44,60,88
TR 14,7,50528
TR 28,7,51040
MAV 44,44,80
TR 30,7,51552
s_waitcnt vmcnt(8) lgkmcnt(8)
MAV 32,0,96
TR 32,7,58240
TR 34,7,58752
MAV 32,16,104
buffer_load_dwordx4 v[80:83], v4, s[16:19], s52 offen sc1
MAV 48,16,108
TR 48,7,59264
TR 50,7,59776
MAV 48,0,100
TR 36,7,58272
MAV 52,4,100
buffer_load_dwordx4 v[84:87], v4, s[16:19], s52 offen offset:1024 sc1
MAV 52,20,108
TR 38,7,58784
s_add_u32 s52, s52, 262144
MAV 36,20,104
TR 52,7,59296
MAV 36,4,96
TR 54,7,59808
s_waitcnt lgkmcnt(8)
MAV 40,8,96
buffer_load_dwordx4 v[88:91], v4, s[16:19], s53 offen sc1
MAV 40,24,104
TR 40,7,58304
TR 42,7,58816
MAV 56,24,108
TR 56,7,59328
MAV 56,8,100
TR 58,7,59840
TR 44,7,58336
MAV 60,12,100
buffer_load_dwordx4 v[92:95], v4, s[16:19], s53 offen offset:1024 sc1
MAV 60,28,108
s_add_u32 s53, s53, 262144
MAV 44,28,104
TR 46,7,58848
TR 60,7,59360
MAV 44,12,96
TR 62,7,59872
s_xor_b32 s57, s57, 66560
v_add_u32 v7, s57, v8
s_waitcnt vmcnt(8) lgkmcnt(8)
MAV 32,32,112
ds_read_b64_tr_b16 a[0:1], v7
TR 2,7,512
MAV 32,48,120
buffer_load_dwordx4 v[96:99], v4, s[16:19], s52 offen sc1
MAV 48,48,124
TR 16,7,1024
TR 18,7,1536
MAV 48,32,116
TR 4,7,32
MAV 52,36,116
buffer_load_dwordx4 v[100:103], v4, s[16:19], s52 offen offset:1024 sc1
MAV 52,52,124
TR 6,7,544
s_add_u32 s52, s52, 262144
MAV 36,52,120
TR 20,7,1056
MAV 36,36,112
TR 22,7,1568
s_waitcnt lgkmcnt(8)
MAV 40,40,112
buffer_load_dwordx4 v[104:107], v4, s[16:19], s53 offen sc1
MAV 40,56,120
TR 8,7,64
TR 10,7,576
MAV 56,56,124
TR 24,7,1088
MAV 56,40,116
TR 26,7,1600
TR 12,7,96
MAV 60,44,116
buffer_load_dwordx4 v[108:111], v4, s[16:19], s53 offen offset:1024 sc1
MAV 60,60,124
s_add_u32 s53, s53, 262144
MAV 44,60,120
TR 14,7,608
TR 28,7,1120
MAV 44,44,112
TR 30,7,1632
s_waitcnt vmcnt(8) lgkmcnt(8)
MAV 32,0,64
TR 32,7,8320
TR 34,7,8832
MAV 32,16,72
buffer_load_dwordx4 v[112:115], v4, s[16:19], s52 offen sc1
MAV 48,16,76
TR 48,7,9344
TR 50,7,9856
MAV 48,0,68
TR 36,7,8352
MAV 52,4,68
buffer_load_dwordx4 v[116:119], v4, s[16:19], s52 offen offset:1024 sc1
MAV 52,20,76
TR 38,7,8864
s_add_u32 s52, s52, 262144
MAV 36,20,72
TR 52,7,9376
MAV 36,4,64
TR 54,7,9888
s_waitcnt lgkmcnt(8)
MAV 40,8,64
buffer_load_dwordx4 v[120:123], v4, s[16:19], s53 offen sc1
MAV 40,24,72
TR 40,7,8384
TR 42,7,8896
MAV 56,24,76
TR 56,7,9408
MAV 56,8,68
TR 58,7,9920
TR 44,7,8416
MAV 60,12,68
buffer_load_dwordx4 v[124:127], v4, s[16:19], s53 offen offset:1024 sc1
MAV 60,28,76
s_add_u32 s53, s53, 262144
MAV 44,28,72
TR 46,7,8928
TR 60,7,9440
MAV 44,12,64
TR 62,7,9952
s_waitcnt vmcnt(8) lgkmcnt(8)
MAV 32,32,80
TR 0,7,16640
TR 2,7,17152
MAV 32,48,88
buffer_load_dwordx4 v[64:67], v4, s[16:19], s52 offen sc1
MAV 48,48,92
TR 16,7,17664
TR 18,7,18176
MAV 48,32,84
TR 4,7,16672
MAV 52,36,84
buffer_load_dwordx4 v[68:71], v4, s[16:19], s52 offen offset:1024 sc1
MAV 52,52,92
TR 6,7,17184
s_add_u32 s52, s52, 262144
MAV 36,52,88
TR 20,7,17696
MAV 36,36,80
TR 22,7,18208
s_waitcnt lgkmcnt(8)
MAV 40,40,80
buffer_load_dwordx4 v[72:75], v4, s[16:19], s53 offen sc1
MAV 40,56,88
TR 8,7,16704
TR 10,7,17216
MAV 56,56,92
TR 24,7,17728
MAV 56,40,84
TR 26,7,18240
TR 12,7,16736
MAV 60,44,84
buffer_load_dwordx4 v[76:79], v4, s[16:19], s53 offen offset:1024 sc1
MAV 60,60,92
s_add_u32 s53, s53, 262144
MAV 44,60,88
TR 14,7,17248
TR 28,7,17760
MAV 44,44,80
TR 30,7,18272
s_waitcnt vmcnt(8) lgkmcnt(8)
MAV 32,0,96
TR 32,7,24960
TR 34,7,25472
MAV 32,16,104
buffer_load_dwordx4 v[80:83], v4, s[16:19], s52 offen sc1
MAV 48,16,108
TR 48,7,25984
TR 50,7,26496
MAV 48,0,100
TR 36,7,24992
MAV 52,4,100
buffer_load_dwordx4 v[84:87], v4, s[16:19], s52 offen offset:1024 sc1
MAV 52,20,108
TR 38,7,25504
s_add_u32 s52, s52, 262144
MAV 36,20,104
TR 52,7,26016
MAV 36,4,96
TR 54,7,26528
s_waitcnt lgkmcnt(8)
MAV 40,8,96
buffer_load_dwordx4 v[88:91], v4, s[16:19], s53 offen sc1
MAV 40,24,104
TR 40,7,25024
TR 42,7,25536
MAV 56,24,108
TR 56,7,26048
MAV 56,8,100
TR 58,7,26560
TR 44,7,25056
MAV 60,12,100
buffer_load_dwordx4 v[92:95], v4, s[16:19], s53 offen offset:1024 sc1
MAV 60,28,108
s_add_u32 s53, s53, 262144
MAV 44,28,104
TR 46,7,25568
TR 60,7,26080
MAV 44,12,96
TR 62,7,26592
s_waitcnt vmcnt(8) lgkmcnt(8)
MAV 32,32,112
TR 0,7,33280
TR 2,7,33792
MAV 32,48,120
buffer_load_dwordx4 v[96:99], v4, s[16:19], s52 offen sc1
MAV 48,48,124
TR 16,7,34304
TR 18,7,34816
MAV 48,32,116
TR 4,7,33312
MAV 52,36,116
buffer_load_dwordx4 v[100:103], v4, s[16:19], s52 offen offset:1024 sc1
MAV 52,52,124
TR 6,7,33824
s_add_u32 s52, s52, 262144
MAV 36,52,120
TR 20,7,34336
MAV 36,36,112
.Lpad1:
s_cbranch_execz .Lpad4
TR 22,7,34848
s_waitcnt lgkmcnt(8)
MAV 40,40,112
buffer_load_dwordx4 v[104:107], v4, s[16:19], s53 offen sc1
MAV 40,56,120
TR 8,7,33344
TR 10,7,33856
MAV 56,56,124
TR 24,7,34368
MAV 56,40,116
TR 26,7,34880
TR 12,7,33376
MAV 60,44,116
buffer_load_dwordx4 v[108:111], v4, s[16:19], s53 offen offset:1024 sc1
MAV 60,60,124
s_add_u32 s53, s53, 262144
MAV 44,60,120
TR 14,7,33888
TR 28,7,34400
MAV 44,44,112
TR 30,7,34912
s_waitcnt vmcnt(8) lgkmcnt(8)
MAV 32,0,64
TR 32,7,41600
TR 34,7,42112
MAV 32,16,72
buffer_load_dwordx4 v[112:115], v4, s[16:19], s52 offen sc1
MAV 48,16,76
TR 48,7,42624
TR 50,7,43136
MAV 48,0,68
TR 36,7,41632
MAV 52,4,68
buffer_load_dwordx4 v[116:119], v4, s[16:19], s52 offen offset:1024 sc1
MAV 52,20,76
TR 38,7,42144
s_add_u32 s52, s52, 262144
MAV 36,20,72
TR 52,7,42656
MAV 36,4,64
TR 54,7,43168
s_waitcnt lgkmcnt(8)
MAV 40,8,64
buffer_load_dwordx4 v[120:123], v4, s[16:19], s53 offen sc1
MAV 40,24,72
TR 40,7,41664
TR 42,7,42176
MAV 56,24,76
TR 56,7,42688
MAV 56,8,68
TR 58,7,43200
TR 44,7,41696
MAV 60,12,68
buffer_load_dwordx4 v[124:127], v4, s[16:19], s53 offen offset:1024 sc1
MAV 60,28,76
s_add_u32 s53, s53, 262144
MAV 44,28,72
TR 46,7,42208
TR 60,7,42720
MAV 44,12,64
TR 62,7,43232
s_barrier
s_waitcnt vmcnt(8) lgkmcnt(8)
MAV 32,32,80
TR 0,7,49920
s_add_u32 m0, s59, 84480
MAV 32,48,88
buffer_load_dwordx4 v12, s[32:35], s58 offen   lds
MAV 48,48,92
TR 2,7,50432
TR 16,7,50944
MAV 48,32,84
TR 18,7,51456
MAV 52,36,84
buffer_load_dwordx4 v13, s[32:35], s58 offen offset:1056   lds
MAV 52,52,92
TR 4,7,49952
TR 6,7,50464
MAV 36,52,88
TR 20,7,50976
MAV 36,36,80
TR 22,7,51488
s_waitcnt lgkmcnt(8)
MAV 40,40,80
buffer_load_dwordx4 v14, s[32:35], s58 offen offset:2112   lds
MAV 40,56,88
TR 8,7,49984
MAV 56,56,92
TR 10,7,50496
TR 24,7,51008
MAV 56,40,84
TR 26,7,51520
MAV 60,44,84
buffer_load_dwordx4 v15, s[32:35], s58 offen offset:3168   lds
MAV 60,60,92
TR 12,7,50016
TR 14,7,50528
MAV 44,60,88
TR 28,7,51040
MAV 44,44,80
TR 30,7,51552
s_waitcnt vmcnt(8) lgkmcnt(8)
MAV 32,0,96
TR 32,7,58240
s_add_u32 m0, s59, 101376
MAV 32,16,104
buffer_load_dwordx4 v12, s[80:83], s58 offen   lds
MAV 48,16,108
TR 34,7,58752
TR 48,7,59264
MAV 48,0,100
TR 50,7,59776
MAV 52,4,100
buffer_load_dwordx4 v13, s[80:83], s58 offen offset:1056   lds
MAV 52,20,108
TR 36,7,58272
TR 38,7,58784
MAV 36,20,104
TR 52,7,59296
MAV 36,4,96
TR 54,7,59808
s_waitcnt lgkmcnt(8)
MAV 40,8,96
buffer_load_dwordx4 v14, s[80:83], s58 offen offset:2112   lds
MAV 40,24,104
TR 40,7,58304
TR 42,7,58816
MAV 56,24,108
TR 56,7,59328
MAV 56,8,100
TR 58,7,59840
TR 44,7,58336
MAV 60,12,100
buffer_load_dwordx4 v15, s[80:83], s58 offen offset:3168   lds
MAV 60,28,108
s_add_u32 s58, s58, 458752
MAV 44,28,104
TR 46,7,58848
TR 60,7,59360
MAV 44,12,96
TR 62,7,59872
s_waitcnt vmcnt(11) lgkmcnt(14)
MAV 32,32,112
s_add_u32 m0, s59, 118272
s_lshl_b32 s64, s6, 14
s_lshl_b32 s65, s49, 13
s_waitcnt vmcnt(9) lgkmcnt(12)
MAV 32,48,120
buffer_load_dwordx4 v12, s[32:35], s58 offen   lds
s_waitcnt vmcnt(9)
MAV 48,48,124
s_add_u32 s64, s64, s65
s_lshl_b32 s65, s7, 9
s_add_u32 s64, s64, s65
MAV 48,32,116
s_lshl_b32 s65, s48, 8
s_add_u32 s64, s64, s65
s_add_u32 s64, s64, 29622272
s_waitcnt lgkmcnt(10)
MAV 52,36,116
s_lshl_b32 s62, s7, 18
v_and_b32 v152, 31, v1
v_lshlrev_b32 v152, 3, v152
s_waitcnt lgkmcnt(8)
MAV 52,52,124
buffer_load_dwordx4 v13, s[32:35], s58 offen offset:1056   lds
MAV 36,52,120
s_add_u32 s62, s62, 8388608
v_lshrrev_b32 v153, 5, v1
v_lshl_add_u32 v152, v153, 28, v152
MAV 36,36,112
s_add_u32 s63, s62, 131072
v_cvt_pk_bf16_f32 v128, v32, v33
v_cvt_pk_bf16_f32 v129, v34, v35
s_waitcnt lgkmcnt(6)
MAV 40,40,112
v_cvt_pk_bf16_f32 v136, v48, v49
v_cvt_pk_bf16_f32 v137, v50, v51
s_waitcnt lgkmcnt(4)
MAV 40,56,120
buffer_load_dwordx4 v14, s[32:35], s58 offen offset:2112   lds
MAV 56,56,124
v_cvt_pk_bf16_f32 v130, v36, v37
v_cvt_pk_bf16_f32 v131, v38, v39
MAV 56,40,116
s_nop 2
v_cvt_pk_bf16_f32 v132, v40, v41
v_cvt_pk_bf16_f32 v133, v42, v43
s_waitcnt lgkmcnt(2)
MAV 60,44,116
v_cvt_pk_bf16_f32 v138, v52, v53
v_cvt_pk_bf16_f32 v139, v54, v55
s_waitcnt lgkmcnt(0)
MAV 60,60,124
buffer_load_dwordx4 v15, s[32:35], s58 offen offset:3168   lds
MAV 44,60,120
v_cvt_pk_bf16_f32 v140, v56, v57
v_cvt_pk_bf16_f32 v141, v58, v59
MAV 44,44,112
s_nop 2
v_cvt_pk_bf16_f32 v142, v60, v61
v_cvt_pk_bf16_f32 v143, v62, v63
v_pk_mul_f32 v[146:147], v[32:33], v[32:33]
v_pk_mul_f32 v[150:151], v[48:49], v[48:49]
buffer_store_dwordx4 v[128:131], v4, s[16:19], s62 offen sc1
v_cvt_pk_bf16_f32 v134, v44, v45
v_cvt_pk_bf16_f32 v135, v46, v47
v_pk_fma_f32 v[146:147], v[34:35], v[34:35], v[146:147]
v_pk_add_f32 v[144:145], v[32:33], v[34:35]
v_pk_fma_f32 v[150:151], v[50:51], v[50:51], v[150:151]
v_pk_add_f32 v[148:149], v[48:49], v[50:51]
v_pk_fma_f32 v[146:147], v[36:37], v[36:37], v[146:147]
v_pk_add_f32 v[144:145], v[144:145], v[36:37]
v_pk_fma_f32 v[150:151], v[52:53], v[52:53], v[150:151]
v_pk_add_f32 v[148:149], v[148:149], v[52:53]
v_pk_fma_f32 v[146:147], v[38:39], v[38:39], v[146:147]
v_pk_add_f32 v[144:145], v[144:145], v[38:39]
v_pk_fma_f32 v[150:151], v[54:55], v[54:55], v[150:151]
buffer_store_dwordx4 v[132:135], v4, s[16:19], s63 offen sc1
v_pk_add_f32 v[148:149], v[148:149], v[54:55]
v_pk_fma_f32 v[146:147], v[40:41], v[40:41], v[146:147]
v_pk_add_f32 v[144:145], v[144:145], v[40:41]
v_pk_fma_f32 v[150:151], v[56:57], v[56:57], v[150:151]
v_pk_add_f32 v[148:149], v[148:149], v[56:57]
v_pk_fma_f32 v[146:147], v[42:43], v[42:43], v[146:147]
v_pk_add_f32 v[144:145], v[144:145], v[42:43]
v_pk_fma_f32 v[150:151], v[58:59], v[58:59], v[150:151]
v_pk_add_f32 v[148:149], v[148:149], v[58:59]
v_pk_fma_f32 v[146:147], v[44:45], v[44:45], v[146:147]
v_pk_add_f32 v[144:145], v[144:145], v[44:45]
v_pk_fma_f32 v[150:151], v[60:61], v[60:61], v[150:151]
v_pk_add_f32 v[148:149], v[148:149], v[60:61]
buffer_store_dwordx4 v[136:139], v4, s[16:19], s62 offen offset:1024 sc1
v_pk_fma_f32 v[146:147], v[46:47], v[46:47], v[146:147]
v_pk_add_f32 v[144:145], v[144:145], v[46:47]
v_pk_fma_f32 v[150:151], v[62:63], v[62:63], v[150:151]
v_pk_add_f32 v[148:149], v[148:149], v[62:63]
v_add_f32 v144, v144, v145
v_add_f32 v146, v146, v147
v_add_f32 v148, v148, v149
v_add_f32 v150, v150, v151
s_nop 0
v_permlane16_swap_b32 v144, v148
v_permlane16_swap_b32 v146, v150
v_add_f32 v144, v144, v148
buffer_store_dwordx4 v[140:143], v4, s[16:19], s63 offen offset:1024 sc1
v_add_f32 v146, v146, v150
s_nop 1
v_permlane32_swap_b32 v144, v146
v_add_f32 v144, v144, v146
s_nop 1
v_permlane32_swap_b32 v144, v145
buffer_store_dwordx2 v[144:145], v152, s[16:19], s64 offen sc1
s_nop 1
v_accvgpr_write_b32 a224, v32
v_accvgpr_write_b32 a225, v33
v_accvgpr_write_b32 a226, v34
v_accvgpr_write_b32 a227, v35
v_accvgpr_write_b32 a228, v36
v_accvgpr_write_b32 a229, v37
v_accvgpr_write_b32 a230, v38
v_accvgpr_write_b32 a231, v39
v_accvgpr_write_b32 a232, v40
v_accvgpr_write_b32 a233, v41
v_accvgpr_write_b32 a234, v42
v_accvgpr_write_b32 a235, v43
v_accvgpr_write_b32 a236, v44
v_accvgpr_write_b32 a237, v45
v_accvgpr_write_b32 a238, v46
v_accvgpr_write_b32 a239, v47
v_accvgpr_write_b32 a240, v48
v_accvgpr_write_b32 a241, v49
v_accvgpr_write_b32 a242, v50
v_accvgpr_write_b32 a243, v51
v_accvgpr_write_b32 a244, v52
v_accvgpr_write_b32 a245, v53
v_accvgpr_write_b32 a246, v54
v_accvgpr_write_b32 a247, v55
v_accvgpr_write_b32 a248, v56
v_accvgpr_write_b32 a249, v57
v_accvgpr_write_b32 a250, v58
v_accvgpr_write_b32 a251, v59
v_accvgpr_write_b32 a252, v60
v_accvgpr_write_b32 a253, v61
v_accvgpr_write_b32 a254, v62
v_accvgpr_write_b32 a255, v63
s_lshl_b32 s62, s10, 14
s_lshl_b32 s63, s3, 12
s_add_u32 s62, s62, s63
s_lshl_b32 s63, s12, 11
s_add_u32 s62, s62, s63
v_lshl_add_u32 v10, v1, 4, s62
v_lshrrev_b32 v2, 3, v1
v_cmp_eq_u32 vcc, 3, v2
v_add_u32 v2, 67108480, v10
s_nop 0
v_cndmask_b32 v10, v10, v2, vcc
v_xor_b32 v11, 2048, v10
v_bfe_u32 v16, v1, 2, 3
v_mul_u32_u24 v16, 1056, v16
v_bfe_u32 v2, v1, 5, 1
v_lshl_add_u32 v16, v2, 8, v16
v_and_b32 v2, 3, v1
v_lshl_add_u32 v16, v2, 3, v16
s_lshl_b32 s62, s12, 6
s_add_u32 s62, s62, 84480
s_xor_b32 s63, s12, 1
s_mul_i32 s63, s63, 192
s_add_u32 s63, s63, 84480
v_add_u32 v17, s63, v16
v_add_u32 v16, s62, v16
s_mov_b32 s52, 8388608
s_mov_b32 s53, 8388608
s_mov_b32 s54, s58
s_mov_b32 s55, s59
s_mul_i32 s59, s3, 2112
s_and_b32 s62, s7, 1
s_mul_i32 s62, s62, 3670016
s_lshr_b32 s63, s7, 1
s_lshl_b32 s63, s63, 8
s_add_u32 s62, s62, s63
s_lshl_b32 s63, s3, 12
s_add_u32 s62, s62, s63
v_lshrrev_b32 v5, 4, v1
v_lshlrev_b32 v5, 14, v5
v_and_b32 v2, 15, v1
v_lshl_add_u32 v5, v2, 4, v5
v_add_u32 v5, s62, v5
v_add_u32 v6, 992, v5
s_lshl_b32 s62, s10, 15
s_lshl_b32 s63, s3, 13
s_add_u32 s62, s62, s63
v_lshl_add_u32 v4, v1, 4, s62
s_and_b32 s47, s5, 3
s_lshr_b32 s63, s5, 2
s_lshl_b32 s63, s63, 3
s_add_u32 s63, s63, s4
s_lshl_b32 s62, s63, 1
s_add_u32 s62, s62, s48
s_mul_i32 s62, s62, 1792
v_lshrrev_b32 v7, 2, v1
v_min_u32 v8, 13, v7
v_lshl_add_u32 v8, v8, 7, s62
s_lshl_b32 s62, s63, 2
s_add_u32 s62, s62, s3
s_mul_i32 s62, s62, 640
v_and_b32 v7, 7, v7
v_min_u32 v7, 4, v7
v_lshl_add_u32 v7, v7, 7, s62
v_lshrrev_b32 v2, 5, v1
v_mul_u32_u24 v2, 3670016, v2
v_add_u32 v7, v7, v2
s_mul_i32 s44, s47, 163840
s_add_u32 s45, s47, 12
s_mul_i32 s45, s45, 229376
v_and_b32 v2, 1, v1
v_lshlrev_b32 v2, 4, v2
v_mov_b32 v9, 0x3f80
v_lshlrev_b32 v2, v2, v9
v_bfe_u32 v9, v1, 1, 3
v_cmp_eq_u32 vcc, 0, v9
s_nop 1
v_cndmask_b32 v20, 0, v2, vcc
v_cmp_eq_u32 vcc, 1, v9
s_nop 1
v_cndmask_b32 v21, 0, v2, vcc
v_cmp_eq_u32 vcc, 2, v9
s_nop 1
v_cndmask_b32 v22, 0, v2, vcc
v_cmp_eq_u32 vcc, 3, v9
s_nop 1
v_cndmask_b32 v23, 0, v2, vcc
v_accvgpr_write_b32 a208, v20
v_accvgpr_write_b32 a209, v21
v_accvgpr_write_b32 a210, v22
v_accvgpr_write_b32 a211, v23
s_cmp_lt_u32 s3, 2
s_cselect_b32 s40, s32, s80
s_cselect_b32 s41, s33, s81
s_cselect_b32 s42, s34, s82
s_add_u32 s62, s55, 84480
v_lshl_add_u32 v9, v1, 4, s62
s_lshl_b32 s62, s6, 10
s_add_u32 s62, s62, 30441472
s_lshl_b32 s64, s10, 1
s_lshl_b32 s64, s64, 10
s_add_u32 s64, s64, 30441472
s_lshr_b32 s67, s5, 2
s_and_b32 s67, s67, 3
s_lshl_b32 s67, s67, 7
s_add_u32 s64, s64, s67
s_add_u32 s65, s64, 1024
v_lshl_add_u32 v252, v1, 7, s62
v_mov_b32 v253, s64
v_mov_b32 v255, 1
v_writelane_b32 v253, s65, 1
s_waitcnt vmcnt(0) lgkmcnt(0)
s_cmp_lg_u32 s3, 1
s_barrier
s_cbranch_scc1 .Lnopoll37
s_mov_b64 exec, 15
buffer_atomic_add v255, v252, s[16:19], 0 offen
s_mov_b64 exec, 3
v_mov_b32 v254, 0
buffer_atomic_add v254, v253, s[16:19], 0 offen sc0
s_sleep 5
s_mov_b32 s15, 0
.Lpoll36:
v_mov_b32 v255, 0
buffer_atomic_add v255, v253, s[16:19], 0 offen sc0
s_waitcnt vmcnt(1)
v_cmp_gt_u32 vcc, 16, v254
s_add_u32 s15, s15, 1
s_cbranch_vccz .Lnopoll37r
v_mov_b32 v254, 0
buffer_atomic_add v254, v253, s[16:19], 0 offen sc0
s_waitcnt vmcnt(1)
v_cmp_gt_u32 vcc, 16, v255
s_add_u32 s15, s15, 1
s_cbranch_vccz .Lnopoll37r
s_cmp_le_u32 s15, 100000
s_cbranch_scc1 .Lpoll36
s_branch .Lnopoll37r
.Lnopoll37:
s_mov_b64 exec, 0
s_cmp_eq_u32 s3, 2
s_cbranch_scc1 .Lpad6
s_cmp_eq_u32 s3, 3
s_cbranch_scc1 .Lpad7
s_branch .Lpad8
.Lnopoll37r:
s_mov_b64 exec, -1
s_barrier
buffer_load_dwordx4 a[128:131], v10, s[16:19], s52 offen sc1
buffer_load_dwordx4 a[132:135], v10, s[16:19], s52 offen offset:1024 sc1
s_add_u32 s52, s52, 131072
buffer_load_dwordx4 a[144:147], v10, s[16:19], s52 offen sc1
buffer_load_dwordx4 a[148:151], v10, s[16:19], s52 offen offset:1024 sc1
s_add_u32 s52, s52, 131072
buffer_load_dwordx4 a[136:139], v11, s[16:19], s53 offen sc1
buffer_load_dwordx4 a[140:143], v11, s[16:19], s53 offen offset:1024 sc1
s_add_u32 s53, s53, 131072
buffer_load_dwordx4 a[152:155], v11, s[16:19], s53 offen sc1
buffer_load_dwordx4 a[156:159], v11, s[16:19], s53 offen offset:1024 sc1
s_add_u32 s53, s53, 131072
ds_read_b64_tr_b16 a[0:1], v16
TR 2,16,512
TR 4,16,8448
TR 6,16,8960
TR 8,16,32
TR 10,16,544
TR 12,16,8480
TR 14,16,8992
TR 16,16,64
TR 18,16,576
TR 20,16,8512
TR 22,16,9024
TR 24,16,96
TR 26,16,608
TR 28,16,8544
TR 30,16,9056
TR 32,16,128
TR 34,16,640
TR 36,16,8576
TR 38,16,9088
TR 40,16,160
TR 42,16,672
TR 44,16,8608
TR 46,16,9120
ds_read_b64_tr_b16 a[48:49], v17
TR 50,17,512
TR 52,17,8448
TR 54,17,8960
TR 56,17,32
TR 58,17,544
TR 60,17,8480
TR 62,17,8992
ds_read_b128 a[192:195], v9
RD 196,9,1056
RD 200,9,2112
RD 204,9,3168
s_add_u32 m0, s55, 135168
s_nop 0
buffer_load_dwordx4 v12, s[80:83], s54 offen   lds
buffer_load_dwordx4 v13, s[80:83], s54 offen offset:1056   lds
buffer_load_dwordx4 v14, s[80:83], s54 offen offset:2112   lds
buffer_load_dwordx4 v15, s[80:83], s54 offen offset:3168   lds
s_add_u32 s54, s54, 458752
s_lshl_b32 s57, s3, 13
s_add_u32 s57, s57, 49920
v_lshl_add_u32 v2, v1, 4, s57
s_waitcnt lgkmcnt(0)
s_barrier
s_waitcnt vmcnt(11)
v_mfma_f32_16x16x32_bf16 v[32:35], a[0:3], a[128:131], 0
buffer_load_dwordx4 a[160:163], v10, s[16:19], s52 offen sc1
s_waitcnt vmcnt(10)
MAA 32,4,144
TR 64,16,16896
v_mfma_f32_16x16x32_bf16 a[212:215], a[208:211], a[192:195], 0
TR 66,16,17408
v_mfma_f32_16x16x32_bf16 a[212:215], a[208:211], a[196:199], a[212:215]
TR 68,16,25344
v_mfma_f32_16x16x32_bf16 a[212:215], a[208:211], a[200:203], a[212:215]
TR 70,16,25856
v_mfma_f32_16x16x32_bf16 a[212:215], a[208:211], a[204:207], a[212:215]
buffer_load_dwordx4 a[164:167], v10, s[16:19], s52 offen offset:1024 sc1
v_mfma_f32_16x16x32_bf16 v[36:39], a[0:3], a[132:135], 0
TR 72,16,16928
s_add_u32 s52, s52, 131072
s_waitcnt vmcnt(10)
MAA 36,4,148
TR 74,16,17440
v_mfma_f32_16x16x32_bf16 v[52:55], a[8:11], a[132:135], 0
TR 76,16,25376
MAA 52,12,148
TR 78,16,25888
v_mfma_f32_16x16x32_bf16 v[48:51], a[8:11], a[128:131], 0
buffer_load_dwordx4 a[176:179], v10, s[16:19], s52 offen sc1
MAA 48,12,144
TR 80,16,16960
v_mfma_f32_16x16x32_bf16 v[96:99], a[16:19], a[128:131], 0
TR 82,16,17472
MAA 96,20,144
TR 84,16,25408
v_mfma_f32_16x16x32_bf16 v[100:103], a[16:19], a[132:135], 0
TR 86,16,25920
MAA 100,20,148
buffer_load_dwordx4 a[180:183], v10, s[16:19], s52 offen offset:1024 sc1
v_mfma_f32_16x16x32_bf16 v[116:119], a[24:27], a[132:135], 0
TR 88,16,16992
s_add_u32 s52, s52, 131072
MAA 116,28,148
TR 90,16,17504
v_mfma_f32_16x16x32_bf16 v[112:115], a[24:27], a[128:131], 0
TR 92,16,25440
MAA 112,28,144
TR 94,16,25952
v_mfma_f32_16x16x32_bf16 v[160:163], a[32:35], a[128:131], 0
buffer_load_dwordx4 a[168:171], v11, s[16:19], s53 offen sc1
MAA 160,36,144
TR 96,16,17024
v_mfma_f32_16x16x32_bf16 v[164:167], a[32:35], a[132:135], 0
TR 98,16,17536
MAA 164,36,148
TR 100,16,25472
v_mfma_f32_16x16x32_bf16 v[180:183], a[40:43], a[132:135], 0
TR 102,16,25984
MAA 180,44,148
buffer_load_dwordx4 a[172:175], v11, s[16:19], s53 offen offset:1024 sc1
v_mfma_f32_16x16x32_bf16 v[176:179], a[40:43], a[128:131], 0
TR 104,16,17056
s_add_u32 s53, s53, 131072
MAA 176,44,144
TR 106,16,17568
v_mfma_f32_16x16x32_bf16 v[224:227], a[48:51], a[128:131], 0
TR 108,16,25504
MAA 224,52,144
TR 110,16,26016
v_mfma_f32_16x16x32_bf16 v[228:231], a[48:51], a[132:135], 0
buffer_load_dwordx4 a[184:187], v11, s[16:19], s53 offen sc1
MAA 228,52,148
TR 112,17,16896
v_mfma_f32_16x16x32_bf16 v[236:239], a[56:59], a[132:135], 0
TR 114,17,17408
MAA 236,60,148
TR 116,17,25344
v_mfma_f32_16x16x32_bf16 v[232:235], a[56:59], a[128:131], 0
TR 118,17,25856
MAA 232,60,144
buffer_load_dwordx4 a[188:191], v11, s[16:19], s53 offen offset:1024 sc1
s_waitcnt vmcnt(12)
v_mfma_f32_16x16x32_bf16 v[188:191], a[40:43], a[140:143], 0
TR 120,17,16928
s_add_u32 s53, s53, 131072
MAA 188,44,156
TR 122,17,17440
s_add_u32 m0, s55, 84480
v_mfma_f32_16x16x32_bf16 v[184:187], a[40:43], a[136:139], 0
TR 124,17,25376
MAA 184,44,152
TR 126,17,25888
v_mfma_f32_16x16x32_bf16 v[168:171], a[32:35], a[136:139], 0
buffer_load_dwordx4 v12, s[32:35], s54 offen   lds
MAA 168,36,152
RD 192,9,16896
v_mfma_f32_16x16x32_bf16 v[172:175], a[32:35], a[140:143], 0
RD 196,9,17952
MAA 172,36,156
RD 200,9,19008
v_mfma_f32_16x16x32_bf16 v[124:127], a[24:27], a[140:143], 0
RD 204,9,20064
.Lpad2:
s_cbranch_execz .Lpad5
MAA 124,28,156
buffer_load_dwordx4 v13, s[32:35], s54 offen offset:1056   lds
v_mfma_f32_16x16x32_bf16 v[120:123], a[24:27], a[136:139], 0
MAA 120,28,152
v_mfma_f32_16x16x32_bf16 v[104:107], a[16:19], a[136:139], 0
MAA 104,20,152
v_mfma_f32_16x16x32_bf16 v[108:111], a[16:19], a[140:143], 0
buffer_load_dwordx4 v14, s[32:35], s54 offen offset:2112   lds
MAA 108,20,156
v_mfma_f32_16x16x32_bf16 v[60:63], a[8:11], a[140:143], 0
MAA 60,12,156
v_mfma_f32_16x16x32_bf16 v[56:59], a[8:11], a[136:139], 0
MAA 56,12,152
buffer_load_dwordx4 v15, s[32:35], s54 offen offset:3168   lds
v_mfma_f32_16x16x32_bf16 v[40:43], a[0:3], a[136:139], 0
MAA 40,4,152
v_mfma_f32_16x16x32_bf16 v[44:47], a[0:3], a[140:143], 0
MAA 44,4,156
s_waitcnt lgkmcnt(0)
s_barrier
v_mfma_f32_16x16x32_bf16 v[64:67], a[64:67], a[128:131], 0
TR 0,16,33792
s_add_u32 m0, s55, 101376
MAA 64,68,144
buffer_load_dwordx4 v12, s[80:83], s54 offen   lds
v_mfma_f32_16x16x32_bf16 a[216:219], a[208:211], a[192:195], 0
TR 2,16,34304
s_mul_i32 s66, s13, 114688
v_mfma_f32_16x16x32_bf16 a[216:219], a[208:211], a[196:199], a[216:219]
TR 4,16,42240
s_mul_i32 s65, s10, 1818624
v_mfma_f32_16x16x32_bf16 a[216:219], a[208:211], a[200:203], a[216:219]
TR 6,16,42752
s_add_u32 s66, s66, s65
v_mfma_f32_16x16x32_bf16 a[216:219], a[208:211], a[204:207], a[216:219]
TR 8,16,33824
s_add_u32 s66, s66, 12582912
v_mfma_f32_16x16x32_bf16 v[68:71], a[64:67], a[132:135], 0
TR 10,16,34336
s_add_u32 s65, s66, 49152
MAA 68,68,148
buffer_load_dwordx4 v13, s[80:83], s54 offen offset:1056   lds
v_mfma_f32_16x16x32_bf16 v[84:87], a[72:75], a[132:135], 0
TR 12,16,42272
s_lshl_b32 s62, s12, 16
MAA 84,76,148
TR 14,16,42784
s_add_u32 s62, s62, s66
v_mfma_f32_16x16x32_bf16 v[80:83], a[72:75], a[128:131], 0
TR 16,16,33856
s_add_u32 s63, s62, 16384
MAA 80,76,144
TR 18,16,34368
s_add_u32 s64, s62, 32768
v_mfma_f32_16x16x32_bf16 v[128:131], a[80:83], a[128:131], 0
TR 20,16,42304
s_lshl_b32 s72, s10, 1
MAA 128,84,144
buffer_load_dwordx4 v14, s[80:83], s54 offen offset:2112   lds
v_mfma_f32_16x16x32_bf16 v[132:135], a[80:83], a[132:135], 0
TR 22,16,42816
s_lshr_b32 s74, s11, 4
MAA 132,84,148
TR 24,16,33888
s_add_u32 s72, s72, s74
v_mfma_f32_16x16x32_bf16 v[148:151], a[88:91], a[132:135], 0
TR 26,16,34400
s_lshl_b32 s72, s72, 10
MAA 148,92,148
TR 28,16,42336
s_add_u32 s72, s72, 30457856
v_mfma_f32_16x16x32_bf16 v[144:147], a[88:91], a[128:131], 0
TR 30,16,42848
s_and_b32 s73, s6, 14
MAA 144,92,144
buffer_load_dwordx4 v15, s[80:83], s54 offen offset:3168   lds
v_mfma_f32_16x16x32_bf16 v[192:195], a[96:99], a[128:131], 0
TR 32,16,33920
s_add_u32 s54, s54, 458752
MAA 192,100,144
TR 34,16,34432
s_add_u32 m0, s57, 0
v_mfma_f32_16x16x32_bf16 v[196:199], a[96:99], a[132:135], 0
TR 36,16,42368
s_mov_b32 s58, 29622272
MAA 196,100,148
TR 38,16,42880
s_and_b32 s74, s7, 1
v_mfma_f32_16x16x32_bf16 v[212:215], a[104:107], a[132:135], 0
TR 40,16,33952
s_add_u32 s73, s73, s74
MAA 212,108,148
buffer_load_dwordx4 v4, s[16:19], s58 offen sc1 lds
v_mfma_f32_16x16x32_bf16 v[208:211], a[104:107], a[128:131], 0
TR 42,16,34464
s_lshl_b32 s73, s73, 10
MAA 208,108,144
TR 44,16,42400
s_add_u32 s73, s73, 30457856
v_mfma_f32_16x16x32_bf16 v[240:243], a[112:115], a[128:131], 0
TR 46,16,42912
s_lshr_b32 s67, s5, 2
MAA 240,116,144
TR 48,17,33792
v_mfma_f32_16x16x32_bf16 v[244:247], a[112:115], a[132:135], 0
TR 50,17,34304
MAA 244,116,148
buffer_load_dwordx4 v4, s[16:19], s58 offen offset:1024 sc1 lds
v_mfma_f32_16x16x32_bf16 v[252:255], a[120:123], a[132:135], 0
TR 52,17,42240
MAA 252,124,148
TR 54,17,42752
v_mfma_f32_16x16x32_bf16 v[248:251], a[120:123], a[128:131], 0
TR 56,17,33824
MAA 248,124,144
TR 58,17,34336
v_mfma_f32_16x16x32_bf16 v[220:223], a[104:107], a[140:143], 0
TR 60,17,42272
MAA 220,108,156
buffer_load_dwordx4 a[128:131], v10, s[16:19], s52 offen sc1
v_mfma_f32_16x16x32_bf16 v[216:219], a[104:107], a[136:139], 0
TR 62,17,42784
MAA 216,108,152
RD 192,9,33792
v_mfma_f32_16x16x32_bf16 v[200:203], a[96:99], a[136:139], 0
RD 196,9,34848
MAA 200,100,152
RD 200,9,35904
v_mfma_f32_16x16x32_bf16 v[204:207], a[96:99], a[140:143], 0
RD 204,9,36960
MAA 204,100,156
buffer_load_dwordx4 a[132:135], v10, s[16:19], s52 offen offset:1024 sc1
v_mfma_f32_16x16x32_bf16 v[156:159], a[88:91], a[140:143], 0
s_add_u32 s52, s52, 131072
MAA 156,92,156
v_mfma_f32_16x16x32_bf16 v[152:155], a[88:91], a[136:139], 0
MAA 152,92,152
v_mfma_f32_16x16x32_bf16 v[136:139], a[80:83], a[136:139], 0
MAA 136,84,152
buffer_load_dwordx4 a[144:147], v10, s[16:19], s52 offen sc1
v_mfma_f32_16x16x32_bf16 v[140:143], a[80:83], a[140:143], 0
MAA 140,84,156
v_mfma_f32_16x16x32_bf16 v[92:95], a[72:75], a[140:143], 0
MAA 92,76,156
v_mfma_f32_16x16x32_bf16 v[88:91], a[72:75], a[136:139], 0
MAA 88,76,152
buffer_load_dwordx4 a[148:151], v10, s[16:19], s52 offen offset:1024 sc1
v_mfma_f32_16x16x32_bf16 v[72:75], a[64:67], a[136:139], 0
s_add_u32 s52, s52, 131072
MAA 72,68,152
v_mfma_f32_16x16x32_bf16 v[76:79], a[64:67], a[140:143], 0
MAA 76,68,156
s_waitcnt vmcnt(18) lgkmcnt(0)
s_barrier
MAA 32,0,160
buffer_load_dwordx4 a[136:139], v11, s[16:19], s53 offen sc1
MAA 32,4,176
TR 64,16,50688
s_and_b32 s67, s67, 3
v_mfma_f32_16x16x32_bf16 a[212:215], a[208:211], a[192:195], a[212:215]
TR 66,16,51200
s_lshl_b32 s67, s67, 7
v_mfma_f32_16x16x32_bf16 a[212:215], a[208:211], a[196:199], a[212:215]
TR 68,16,59136
s_add_u32 s73, s73, s67
v_mfma_f32_16x16x32_bf16 a[212:215], a[208:211], a[200:203], a[212:215]
TR 70,16,59648
s_and_b32 s74, s7, 1
v_mfma_f32_16x16x32_bf16 a[212:215], a[208:211], a[204:207], a[212:215]
TR 72,16,50720
s_mul_i32 s87, s74, 917504
MAA 36,4,180
buffer_load_dwordx4 a[140:143], v11, s[16:19], s53 offen offset:1024 sc1
MAA 36,0,164
TR 74,16,51232
s_add_u32 s53, s53, 131072
MAA 52,8,164
TR 76,16,59168
s_lshr_b32 s75, s6, 1
MAA 52,12,180
TR 78,16,59680
s_mul_i32 s75, s75, 1818624
MAA 48,12,176
TR 80,16,50752
s_add_u32 s87, s87, s75
MAA 48,8,160
TR 82,16,51264
s_add_u32 s87, s87, 12582912
MAA 96,16,160
buffer_load_dwordx4 a[152:155], v11, s[16:19], s53 offen sc1
MAA 96,20,176
TR 84,16,59200
s_and_b32 s74, s6, 3
MAA 100,20,180
TR 86,16,59712
s_xor_b32 s75, s74, 0
MAA 100,16,164
TR 88,16,50784
s_sub_u32 s75, s75, 0
MAA 116,24,164
TR 90,16,51296
s_mul_i32 s98, s75, 458752
MAA 116,28,180
TR 92,16,59232
s_mul_i32 s75, s75, 114688
MAA 112,28,176
buffer_load_dwordx4 a[156:159], v11, s[16:19], s53 offen offset:1024 sc1
MAA 112,24,160
TR 94,16,59744
s_add_u32 s53, s53, 131072
MAA 160,32,160
TR 96,16,50816
s_add_u32 m0, s55, 118272
MAA 160,36,176
TR 98,16,51328
s_add_u32 s76, s87, s75
MAA 164,36,180
TR 100,16,59264
s_xor_b32 s75, s74, 1
MAA 164,32,164
TR 102,16,59776
s_sub_u32 s75, s75, 1
MAA 180,40,164
buffer_load_dwordx4 v12, s[32:35], s54 offen   lds
MAA 180,44,180
TR 104,16,50848
s_mul_i32 s99, s75, 458752
MAA 176,44,176
TR 106,16,51360
s_mul_i32 s75, s75, 114688
MAA 176,40,160
TR 108,16,59296
s_add_u32 s77, s87, s75
MAA 224,48,160
TR 110,16,59808
MAA 224,52,176
TR 112,17,50688
MAA 228,52,180
buffer_load_dwordx4 v13, s[32:35], s54 offen offset:1056   lds
MAA 228,48,164
TR 114,17,51200
MAA 236,56,164
TR 116,17,59136
MAA 236,60,180
TR 118,17,59648
MAA 232,60,176
TR 120,17,50720
MAA 232,56,160
TR 122,17,51232
s_waitcnt vmcnt(20)
MAA 188,40,172
buffer_load_dwordx4 v14, s[32:35], s54 offen offset:2112   lds
MAA 188,44,188
TR 124,17,59168
MAA 184,44,184
TR 126,17,59680
MAA 184,40,168
RD 192,9,50688
MAA 168,32,168
RD 196,9,51744
MAA 168,36,184
RD 200,9,52800
MAA 172,36,188
buffer_load_dwordx4 v15, s[32:35], s54 offen offset:3168   lds
MAA 172,32,172
RD 204,9,53856
s_add_u32 m0, s57, 2048
MAA 124,24,172
s_mov_b32 s58, 29624320
MAA 124,28,188
MAA 120,28,184
MAA 120,24,168
MAA 104,16,168
buffer_load_dwordx4 v4, s[16:19], s58 offen sc1 lds
MAA 104,20,184
MAA 108,20,188
MAA 108,16,172
MAA 60,8,172
MAA 60,12,188
MAA 56,12,184
buffer_load_dwordx4 v4, s[16:19], s58 offen offset:1024 sc1 lds
MAA 56,8,168
MAA 40,0,168
MAA 40,4,184
MAA 44,4,188
MAA 44,0,172
s_waitcnt vmcnt(20) lgkmcnt(0)
s_barrier
MAA 64,64,160
ds_read_b64_tr_b16 a[0:1], v16
s_add_u32 m0, s55, 135168
MAA 64,68,176
buffer_load_dwordx4 v12, s[80:83], s54 offen   lds
v_mfma_f32_16x16x32_bf16 a[216:219], a[208:211], a[192:195], a[216:219]
TR 2,16,512
s_xor_b32 s75, s74, 2
v_mfma_f32_16x16x32_bf16 a[216:219], a[208:211], a[196:199], a[216:219]
TR 4,16,8448
s_sub_u32 s75, s75, 2
v_mfma_f32_16x16x32_bf16 a[216:219], a[208:211], a[200:203], a[216:219]
TR 6,16,8960
s_mul_i32 s100, s75, 458752
v_mfma_f32_16x16x32_bf16 a[216:219], a[208:211], a[204:207], a[216:219]
TR 8,16,32
s_mul_i32 s75, s75, 114688
MAA 68,68,180
TR 10,16,544
s_add_u32 s78, s87, s75
MAA 68,64,164
buffer_load_dwordx4 v13, s[80:83], s54 offen offset:1056   lds
MAA 84,72,164
TR 12,16,8480
s_xor_b32 s75, s74, 3
MAA 84,76,180
TR 14,16,8992
s_sub_u32 s75, s75, 3
MAA 80,76,176
TR 16,16,64
s_mul_i32 s101, s75, 458752
MAA 80,72,160
TR 18,16,576
s_mul_i32 s75, s75, 114688
MAA 128,80,160
TR 20,16,8512
s_add_u32 s79, s87, s75
MAA 128,84,176
buffer_load_dwordx4 v14, s[80:83], s54 offen offset:2112   lds
MAA 132,84,180
TR 22,16,9024
s_and_b32 s87, s6, 3
MAA 132,80,164
TR 24,16,96
s_mov_b32 s46, 0
MAA 148,88,164
TR 26,16,608
s_lshl_b32 s74, s3, 10
MAA 148,92,180
TR 28,16,8544
s_lshl_b32 s75, s12, 9
MAA 144,92,176
TR 30,16,9056
s_add_u32 s74, s74, s75
MAA 144,88,160
buffer_load_dwordx4 v15, s[80:83], s54 offen offset:3168   lds
MAA 192,96,160
TR 32,16,128
s_add_u32 s54, s54, 458752
MAA 192,100,176
TR 34,16,640
s_add_u32 m0, s57, 4096
MAA 196,100,180
TR 36,16,8576
s_mov_b32 s58, 29626368
MAA 196,96,164
TR 38,16,9088
s_add_u32 s74, s74, 152576
MAA 212,104,164
TR 40,16,160
v_and_b32 v18, 15, v1
MAA 212,108,180
buffer_load_dwordx4 v4, s[16:19], s58 offen sc1 lds
MAA 208,108,176
TR 42,16,672
v_lshl_add_u32 v18, v18, 4, s74
MAA 208,104,160
TR 44,16,8608
v_xor_b32 v19, 512, v18
MAA 240,112,160
TR 46,16,9120
MAA 240,116,176
ds_read_b64_tr_b16 a[48:49], v17
MAA 244,116,180
TR 50,17,512
MAA 244,112,164
buffer_load_dwordx4 v4, s[16:19], s58 offen offset:1024 sc1 lds
MAA 252,120,164
TR 52,17,8448
MAA 252,124,180
TR 54,17,8960
MAA 248,124,176
TR 56,17,32
MAA 248,120,160
TR 58,17,544
MAA 220,104,172
TR 60,17,8480
MAA 220,108,188
buffer_load_dwordx4 a[160:163], v10, s[16:19], s52 offen sc1
MAA 216,108,184
TR 62,17,8992
MAA 216,104,168
ds_read_b128 a[192:195], v9
MAA 200,96,168
RD 196,9,1056
MAA 200,100,184
RD 200,9,2112
MAA 204,100,188
RD 204,9,3168
MAA 204,96,172
buffer_load_dwordx4 a[164:167], v10, s[16:19], s52 offen offset:1024 sc1
MAA 156,88,172
s_add_u32 s52, s52, 131072
MAA 156,92,188
MAA 152,92,184
MAA 152,88,168
MAA 136,80,168
MAA 136,84,184
buffer_load_dwordx4 a[176:179], v10, s[16:19], s52 offen sc1
MAA 140,84,188
MAA 140,80,172
MAA 92,72,172
MAA 92,76,188
MAA 88,76,184
MAA 88,72,168
buffer_load_dwordx4 a[180:183], v10, s[16:19], s52 offen offset:1024 sc1
MAA 72,64,168
s_add_u32 s52, s52, 131072
MAA 72,68,184
MAA 76,68,188
MAA 76,64,172
s_waitcnt vmcnt(20) lgkmcnt(0)
s_barrier
MAA 32,0,128
buffer_load_dwordx4 a[168:171], v11, s[16:19], s53 offen sc1
MAA 32,4,144
ds_read_b128 v[20:23], v2
v_mfma_f32_16x16x32_bf16 a[212:215], a[208:211], a[192:195], a[212:215]
ds_read_b128 v[28:31], v2 offset:1024
v_mfma_f32_16x16x32_bf16 a[212:215], a[208:211], a[196:199], a[212:215]
s_waitcnt vmcnt(11)
ds_read_b128 v[24:27], v2 offset:2048
v_mfma_f32_16x16x32_bf16 a[212:215], a[208:211], a[200:203], a[212:215]
TR 64,16,16896
v_mfma_f32_16x16x32_bf16 a[212:215], a[208:211], a[204:207], a[212:215]
TR 66,16,17408
MAA 36,4,148
buffer_load_dwordx4 a[172:175], v11, s[16:19], s53 offen offset:1024 sc1
MAA 36,0,132
TR 68,16,25344
s_add_u32 s53, s53, 131072
MAA 52,8,132
TR 70,16,25856
MAA 52,12,148
TR 72,16,16928
MAA 48,12,144
TR 74,16,17440
s_waitcnt lgkmcnt(7)
v_add_f32 v20, v20, v28
MAA 48,8,128
TR 76,16,25376
v_add_f32 v21, v21, v29
MAA 96,16,128
buffer_load_dwordx4 a[184:187], v11, s[16:19], s53 offen sc1
MAA 96,20,144
TR 78,16,25888
v_add_f32 v22, v22, v30
MAA 100,20,148
TR 80,16,16960
v_add_f32 v23, v23, v31
MAA 100,16,132
ds_read_b128 v[28:31], v2 offset:3072
s_waitcnt lgkmcnt(10)
v_add_f32 v20, v20, v24
MAA 116,24,132
TR 82,16,17472
v_add_f32 v21, v21, v25
MAA 116,28,148
TR 84,16,25408
v_add_f32 v22, v22, v26
MAA 112,28,144
buffer_load_dwordx4 a[188:191], v11, s[16:19], s53 offen offset:1024 sc1
MAA 112,24,128
TR 86,16,25920
s_add_u32 s53, s53, 131072
MAA 160,32,128
TR 88,16,16992
s_add_u32 m0, s55, 84480
MAA 160,36,144
TR 90,16,17504
v_add_f32 v23, v23, v27
MAA 164,36,148
TR 92,16,25440
MAA 164,32,132
TR 94,16,25952
MAA 180,40,132
buffer_load_dwordx4 v12, s[32:35], s54 offen   lds
MAA 180,44,148
TR 96,16,17024
MAA 176,44,144
TR 98,16,17536
MAA 176,40,128
TR 100,16,25472
MAA 224,48,128
TR 102,16,25984
MAA 224,52,144
TR 104,16,17056
MAA 228,52,148
buffer_load_dwordx4 v13, s[32:35], s54 offen offset:1056   lds
MAA 228,48,132
TR 106,16,17568
MAA 236,56,132
TR 108,16,25504
MAA 236,60,148
TR 110,16,26016
MAA 232,60,144
TR 112,17,16896
MAA 232,56,128
TR 114,17,17408
MAA 188,40,140
buffer_load_dwordx4 v14, s[32:35], s54 offen offset:2112   lds
MAA 188,44,156
TR 116,17,25344
MAA 184,44,152
TR 118,17,25856
MAA 184,40,136
TR 120,17,16928
MAA 168,32,136
TR 122,17,17440
MAA 168,36,152
TR 124,17,25376
MAA 172,36,156
buffer_load_dwordx4 v15, s[32:35], s54 offen offset:3168   lds
MAA 172,32,140
TR 126,17,25888
s_add_u32 m0, s57, 6144
MAA 124,24,140
RD 192,9,16896
s_mov_b32 s58, 29628416
MAA 124,28,156
RD 196,9,17952
MAA 120,28,152
RD 200,9,19008
MAA 120,24,136
RD 204,9,20064
MAA 104,16,136
buffer_load_dwordx4 v4, s[16:19], s58 offen sc1 lds
MAA 104,20,152
MAA 108,20,156
MAA 108,16,140
MAA 60,8,140
MAA 60,12,156
.Lpad3:
s_cbranch_execz .Lnopoll34r
MAA 56,12,152
buffer_load_dwordx4 v4, s[16:19], s58 offen offset:1024 sc1 lds
MAA 56,8,136
MAA 40,0,136
MAA 40,4,152
MAA 44,4,156
s_sub_u32 s47, s47, 1
s_cbranch_scc1 .Lx39
.Lx39b:
MAA 44,0,140
s_waitcnt lgkmcnt(0)
s_barrier
MAA 64,64,128
s_waitcnt vmcnt(14)
ds_read_b128 v[24:27], v2 offset:4096
s_add_u32 m0, s55, 101376
MAA 64,68,144
buffer_load_dwordx4 v12, s[80:83], s54 offen   lds
v_mfma_f32_16x16x32_bf16 a[216:219], a[208:211], a[192:195], a[216:219]
TR 0,16,33792
v_add_f32 v20, v20, v28
v_mfma_f32_16x16x32_bf16 a[216:219], a[208:211], a[196:199], a[216:219]
TR 2,16,34304
v_add_f32 v21, v21, v29
v_mfma_f32_16x16x32_bf16 a[216:219], a[208:211], a[200:203], a[216:219]
TR 4,16,42240
v_add_f32 v22, v22, v30
v_mfma_f32_16x16x32_bf16 a[216:219], a[208:211], a[204:207], a[216:219]
TR 6,16,42752
v_add_f32 v23, v23, v31
MAA 68,68,148
ds_read_b128 v[28:31], v2 offset:5120
MAA 68,64,132
TR 8,16,33824
MAA 84,72,132
buffer_load_dwordx4 v13, s[80:83], s54 offen offset:1056   lds
MAA 84,76,148
TR 10,16,34336
s_waitcnt lgkmcnt(7)
v_add_f32 v20, v20, v24
MAA 80,76,144
TR 12,16,42272
v_add_f32 v21, v21, v25
MAA 80,72,128
TR 14,16,42784
v_add_f32 v22, v22, v26
MAA 128,80,128
TR 16,16,33856
v_add_f32 v23, v23, v27
MAA 128,84,144
TR 18,16,34368
MAA 132,84,148
TR 20,16,42304
MAA 132,80,132
buffer_load_dwordx4 v14, s[80:83], s54 offen offset:2112   lds
MAA 148,88,132
TR 22,16,42816
MAA 148,92,148
TR 24,16,33888
MAA 144,92,144
TR 26,16,34400
MAA 144,88,128
TR 28,16,42336
MAA 192,96,128
TR 30,16,42848
MAA 192,100,144
TR 32,16,33920
MAA 196,100,148
buffer_load_dwordx4 v15, s[80:83], s54 offen offset:3168   lds
MAA 196,96,132
TR 34,16,34432
s_add_u32 s54, s54, 458752
MAA 212,104,132
TR 36,16,42368
MAA 212,108,148
TR 38,16,42880
MAA 208,108,144
TR 40,16,33952
MAA 208,104,128
TR 42,16,34464
MAA 240,112,128
TR 44,16,42400
MAA 240,116,144
TR 46,16,42912
MAA 244,116,148
TR 48,17,33792
MAA 244,112,132
TR 50,17,34304
MAA 252,120,132
TR 52,17,42240
MAA 252,124,148
TR 54,17,42752
MAA 248,124,144
TR 56,17,33824
MAA 248,120,128
buffer_load_dwordx4 a[128:131], v10, s[16:19], s52 offen sc1
MAA 220,104,140
TR 58,17,34336
MAA 220,108,156
TR 60,17,42272
MAA 216,108,152
TR 62,17,42784
MAA 216,104,136
RD 192,9,33792
MAA 200,96,136
RD 196,9,34848
MAA 200,100,152
RD 200,9,35904
MAA 204,100,156
buffer_load_dwordx4 a[132:135], v10, s[16:19], s52 offen offset:1024 sc1
MAA 204,96,140
RD 204,9,36960
s_add_u32 s52, s52, 131072
MAA 156,88,140
MAA 156,92,156
MAA 152,92,152
MAA 152,88,136
MAA 136,80,136
MAA 136,84,152
buffer_load_dwordx4 a[144:147], v10, s[16:19], s52 offen sc1
MAA 140,84,156
MAA 140,80,140
MAA 92,72,140
MAA 92,76,156
MAA 88,76,152
MAA 88,72,136
MAA 72,64,136
buffer_load_dwordx4 a[148:151], v10, s[16:19], s52 offen offset:1024 sc1
MAA 72,68,152
s_add_u32 s52, s52, 131072
MAA 76,68,156
s_sub_u32 s47, s47, 1
s_cbranch_scc1 .Lx40
.Lx40b:
MAA 76,64,140
s_waitcnt vmcnt(18) lgkmcnt(0)
s_barrier
MAA 32,0,160
buffer_load_dwordx4 a[136:139], v11, s[16:19], s53 offen sc1
MAA 32,4,176
s_waitcnt vmcnt(9)
ds_read_b128 v[24:27], v2 offset:6144
v_add_f32 v20, v20, v28
v_mfma_f32_16x16x32_bf16 a[212:215], a[208:211], a[192:195], a[212:215]
TR 64,16,50688
v_add_f32 v21, v21, v29
v_mfma_f32_16x16x32_bf16 a[212:215], a[208:211], a[196:199], a[212:215]
TR 66,16,51200
v_add_f32 v22, v22, v30
v_mfma_f32_16x16x32_bf16 a[212:215], a[208:211], a[200:203], a[212:215]
TR 68,16,59136
v_add_f32 v23, v23, v31
v_mfma_f32_16x16x32_bf16 a[212:215], a[208:211], a[204:207], a[212:215]
ds_read_b128 v[28:31], v2 offset:7168
MAA 36,4,180
TR 70,16,59648
MAA 36,0,164
buffer_load_dwordx4 a[140:143], v11, s[16:19], s53 offen offset:1024 sc1
MAA 52,8,164
TR 72,16,50720
s_add_u32 s53, s53, 131072
MAA 52,12,180
TR 74,16,51232
s_waitcnt lgkmcnt(7)
v_add_f32 v20, v20, v24
MAA 48,12,176
TR 76,16,59168
v_add_f32 v21, v21, v25
MAA 48,8,160
TR 78,16,59680
v_add_f32 v22, v22, v26
MAA 96,16,160
TR 80,16,50752
v_add_f32 v23, v23, v27
MAA 96,20,176
TR 82,16,51264
s_waitcnt lgkmcnt(7)
v_add_f32 v20, v20, v28
MAA 100,20,180
buffer_load_dwordx4 a[152:155], v11, s[16:19], s53 offen sc1
MAA 100,16,164
TR 84,16,59200
v_add_f32 v21, v21, v29
MAA 116,24,164
TR 86,16,59712
v_add_f32 v22, v22, v30
MAA 116,28,180
TR 88,16,50784
v_add_f32 v23, v23, v31
MAA 112,28,176
TR 90,16,51296
MAA 112,24,160
TR 92,16,59232
MAA 160,32,160
TR 94,16,59744
MAA 160,36,176
buffer_load_dwordx4 a[156:159], v11, s[16:19], s53 offen offset:1024 sc1
MAA 164,36,180
TR 96,16,50816
s_add_u32 s53, s53, 131072
MAA 164,32,164
TR 98,16,51328
s_add_u32 m0, s55, 118272
MAA 180,40,164
TR 100,16,59264
MAA 180,44,180
TR 102,16,59776
MAA 176,44,176
TR 104,16,50848
MAA 176,40,160
TR 106,16,51360
MAA 224,48,160
buffer_load_dwordx4 v12, s[32:35], s54 offen   lds
MAA 224,52,176
TR 108,16,59296
MAA 228,52,180
TR 110,16,59808
MAA 228,48,164
TR 112,17,50688
MAA 236,56,164
TR 114,17,51200
MAA 236,60,180
TR 116,17,59136
MAA 232,60,176
TR 118,17,59648
MAA 232,56,160
buffer_load_dwordx4 v13, s[32:35], s54 offen offset:1056   lds
MAA 188,40,172
TR 120,17,50720
MAA 188,44,188
TR 122,17,51232
MAA 184,44,184
TR 124,17,59168
MAA 184,40,168
TR 126,17,59680
MAA 168,32,168
RD 192,9,50688
MAA 168,36,184
RD 196,9,51744
MAA 172,36,188
buffer_load_dwordx4 v14, s[32:35], s54 offen offset:2112   lds
MAA 172,32,172
RD 200,9,52800
MAA 124,24,172
RD 204,9,53856
MAA 124,28,188
MAA 120,28,184
MAA 120,24,168
MAA 104,16,168
MAA 104,20,184
buffer_load_dwordx4 v15, s[32:35], s54 offen offset:3168   lds
MAA 108,20,188
MAA 108,16,172
MAA 60,8,172
MAA 60,12,188
MAA 56,12,184
MAA 56,8,168
MAA 40,0,168
MAA 40,4,184
MAA 44,4,188
s_sub_u32 s47, s47, 1
s_cbranch_scc1 .Lx41
.Lx41b:
MAA 44,0,172
s_waitcnt lgkmcnt(0)
s_barrier
MAA 64,64,160
ds_read_b64_tr_b16 a[0:1], v16
s_add_u32 m0, s55, 135168
MAA 64,68,176
buffer_load_dwordx4 v12, s[80:83], s54 offen   lds
v_mfma_f32_16x16x32_bf16 a[216:219], a[208:211], a[192:195], a[216:219]
TR 2,16,512
v_permlane32_swap_b32 v20, v22
v_mfma_f32_16x16x32_bf16 a[216:219], a[208:211], a[196:199], a[216:219]
TR 4,16,8448
v_permlane32_swap_b32 v21, v23
v_mfma_f32_16x16x32_bf16 a[216:219], a[208:211], a[200:203], a[216:219]
TR 6,16,8960
v_add_f32 v20, v20, v22
v_mfma_f32_16x16x32_bf16 a[216:219], a[208:211], a[204:207], a[216:219]
TR 8,16,32
v_add_f32 v21, v21, v23
MAA 68,68,180
TR 10,16,544
v_mul_f32 v20, 0xba800000, v20
MAA 68,64,164
TR 12,16,8480
v_mul_f32 v21, 0x3a800000, v21
MAA 84,72,164
buffer_load_dwordx4 v13, s[80:83], s54 offen offset:1056   lds
MAA 84,76,180
TR 14,16,8992
v_fma_f32 v21, -v20, v20, v21
MAA 80,76,176
TR 16,16,64
v_max_f32 v21, 0, v21
MAA 80,72,160
TR 18,16,576
v_add_f32 v21, 0x3727c5ac, v21
MAA 128,80,160
TR 20,16,8512
v_rsq_f32 v22, v21
MAA 128,84,176
TR 22,16,9024
v_and_b32 v24, 31, v1
MAA 132,84,180
TR 24,16,96
v_lshrrev_b32 v25, 5, v1
MAA 132,80,164
buffer_load_dwordx4 v14, s[80:83], s54 offen offset:2112   lds
MAA 148,88,164
TR 26,16,608
v_lshl_add_u32 v24, v24, 1, v25
MAA 148,92,180
TR 28,16,8544
v_and_b32 v25, 0xc0, v0
MAA 144,92,176
TR 30,16,9056
v_add_u32 v24, v24, v25
MAA 144,88,160
TR 32,16,128
v_lshlrev_b32 v24, 4, v24
MAA 192,96,160
TR 34,16,640
v_add_u32 v24, 152576, v24
MAA 192,100,176
TR 36,16,8576
v_mul_f32 v22, 0xbfb8aa3b, v22
MAA 196,100,180
buffer_load_dwordx4 v15, s[80:83], s54 offen offset:3168   lds
MAA 196,96,164
ds_write_b128 v24, v[20:23]
s_add_u32 s54, s54, 458752
MAA 212,104,164
ds_read_b64 v[20:21], v18
s_mov_b32 s58, s98
MAA 212,108,180
ds_read_b64 v[22:23], v18 offset:256
s_mov_b32 s67, s59
MAA 208,108,176
ds_read_b64 v[24:25], v19
MAA 208,104,160
ds_read_b64 v[26:27], v19 offset:256
MAA 240,112,160
ds_read_b32 v28, v18 offset:8
MAA 240,116,176
ds_read_b32 v29, v18 offset:264
v_mov_b32 v18, v5
MAA 244,116,180
ds_read_b32 v30, v19 offset:8
MAA 244,112,164
ds_read_b32 v31, v19 offset:264
v_mov_b32 v19, v6
MAA 252,120,164
TR 38,16,9088
MAA 252,124,180
TR 40,16,160
MAA 248,124,176
TR 42,16,672
MAA 248,120,160
buffer_load_dwordx4 a[160:163], v10, s[16:19], s52 offen sc1
MAA 220,104,172
TR 44,16,8608
MAA 220,108,188
TR 46,16,9120
MAA 216,108,184
ds_read_b64_tr_b16 a[48:49], v17
MAA 216,104,168
TR 50,17,512
MAA 200,96,168
TR 52,17,8448
MAA 200,100,184
TR 54,17,8960
MAA 204,100,188
buffer_load_dwordx4 a[164:167], v10, s[16:19], s52 offen offset:1024 sc1
MAA 204,96,172
TR 56,17,32
s_add_u32 s52, s52, 131072
MAA 156,88,172
TR 58,17,544
MAA 156,92,188
TR 60,17,8480
MAA 152,92,184
TR 62,17,8992
MAA 152,88,168
ds_read_b128 a[192:195], v9
MAA 136,80,168
RD 196,9,1056
MAA 136,84,184
buffer_load_dwordx4 a[176:179], v10, s[16:19], s52 offen sc1
MAA 140,84,188
RD 200,9,2112
MAA 140,80,172
RD 204,9,3168
MAA 92,72,172
MAA 92,76,188
MAA 88,76,184
MAA 88,72,168
MAA 72,64,168
buffer_load_dwordx4 a[180:183], v10, s[16:19], s52 offen offset:1024 sc1
MAA 72,68,184
s_add_u32 s52, s52, 131072
MAA 76,68,188
s_sub_u32 s47, s47, 1
s_cbranch_scc1 .Lx42
.Lx42b:
MAA 76,64,172
s_mov_b32 s15, -5
.p2align 6
.Lk43:
s_waitcnt vmcnt(16) lgkmcnt(0)
s_barrier
MAA 32,0,128
TR 64,16,16896
MAA 32,4,144
buffer_load_dwordx4 a[168:171], v11, s[16:19], s53 offen sc1
v_mfma_f32_16x16x32_bf16 a[212:215], a[208:211], a[192:195], a[212:215]
s_sub_u32 s47, s47, 1
s_cbranch_scc1 .Lx44
.Lx44b:
v_mfma_f32_16x16x32_bf16 a[212:215], a[208:211], a[196:199], a[212:215]
TR 66,16,17408
v_mfma_f32_16x16x32_bf16 a[212:215], a[208:211], a[200:203], a[212:215]
TR 68,16,25344
v_mfma_f32_16x16x32_bf16 a[212:215], a[208:211], a[204:207], a[212:215]
TR 70,16,25856
MAA 36,4,148
MAA 36,0,132
buffer_load_dwordx4 a[172:175], v11, s[16:19], s53 offen offset:1024 sc1
MAA 52,8,132
TR 72,16,16928
s_add_u32 s53, s53, 131072
MAA 52,12,148
TR 74,16,17440
MAA 48,12,144
TR 76,16,25376
MAA 48,8,128
TR 78,16,25888
MAA 96,16,128
MAA 96,20,144
buffer_load_dwordx4 a[184:187], v11, s[16:19], s53 offen sc1
MAA 100,20,148
TR 80,16,16960
MAA 100,16,132
TR 82,16,17472
MAA 116,24,132
TR 84,16,25408
MAA 116,28,148
TR 86,16,25920
MAA 112,28,144
MAA 112,24,128
TR 88,16,16992
MAA 160,32,128
buffer_load_dwordx4 a[188:191], v11, s[16:19], s53 offen offset:1024 sc1
MAA 160,36,144
TR 90,16,17504
s_add_u32 s53, s53, 131072
MAA 164,36,148
TR 92,16,25440
MAA 164,32,132
TR 94,16,25952
MAA 180,40,132
MAA 180,44,148
TR 96,16,17024
s_add_u32 m0, s55, 84480
MAA 176,44,144
buffer_load_dwordx4 v12, s[32:35], s54 offen   lds
MAA 176,40,128
TR 98,16,17536
MAA 224,48,128
TR 100,16,25472
MAA 224,52,144
TR 102,16,25984
MAA 228,52,148
MAA 228,48,132
TR 104,16,17056
MAA 236,56,132
TR 106,16,17568
MAA 236,60,148
buffer_load_dwordx4 v13, s[32:35], s54 offen offset:1056   lds
MAA 232,60,144
TR 108,16,25504
MAA 232,56,128
TR 110,16,26016
s_waitcnt vmcnt(18)
MAA 188,40,140
MAA 188,44,156
TR 112,17,16896
MAA 184,44,152
TR 114,17,17408
MAA 184,40,136
buffer_load_dwordx4 v14, s[32:35], s54 offen offset:2112   lds
MAA 168,32,136
TR 116,17,25344
MAA 168,36,152
TR 118,17,25856
MAA 172,36,156
MAA 172,32,140
TR 120,17,16928
MAA 124,24,140
TR 122,17,17440
MAA 124,28,156
TR 124,17,25376
MAA 120,28,152
buffer_load_dwordx4 v15, s[32:35], s54 offen offset:3168   lds
MAA 120,24,136
TR 126,17,25888
MAA 104,16,136
MAA 104,20,152
RD 192,9,16896
MAA 108,20,156
RD 196,9,17952
MAA 108,16,140
RD 200,9,19008
s_mov_b32 m0, s67
MAA 60,8,140
buffer_load_dwordx4 v18, s[28:31], s58 offen lds
MAA 60,12,156
RD 204,9,20064
MAA 56,12,152
MAA 56,8,136
MAA 40,0,136
MAA 40,4,152
MAA 44,4,156
MAA 44,0,140
s_waitcnt vmcnt(17) lgkmcnt(0)
s_barrier
MAA 64,64,128
TR 0,16,33792
s_add_u32 m0, s55, 101376
MAA 64,68,144
buffer_load_dwordx4 v12, s[80:83], s54 offen   lds
v_mfma_f32_16x16x32_bf16 a[216:219], a[208:211], a[192:195], a[216:219]
s_sub_u32 s47, s47, 1
s_cbranch_scc1 .Lx45
.Lx45b:
v_mfma_f32_16x16x32_bf16 a[216:219], a[208:211], a[196:199], a[216:219]
TR 2,16,34304
v_mfma_f32_16x16x32_bf16 a[216:219], a[208:211], a[200:203], a[216:219]
TR 4,16,42240
v_mfma_f32_16x16x32_bf16 a[216:219], a[208:211], a[204:207], a[216:219]
TR 6,16,42752
MAA 68,68,148
TR 8,16,33824
MAA 68,64,132
.Lpad4:
s_cbranch_execz .Lnopoll34r
buffer_load_dwordx4 v13, s[80:83], s54 offen offset:1056   lds
MAA 84,72,132
MAA 84,76,148
TR 10,16,34336
MAA 80,76,144
TR 12,16,42272
MAA 80,72,128
TR 14,16,42784
MAA 128,80,128
TR 16,16,33856
MAA 128,84,144
buffer_load_dwordx4 v14, s[80:83], s54 offen offset:2112   lds
MAA 132,84,148
MAA 132,80,132
TR 18,16,34368
MAA 148,88,132
TR 20,16,42304
MAA 148,92,148
TR 22,16,42816
MAA 144,92,144
TR 24,16,33888
MAA 144,88,128
TR 26,16,34400
MAA 192,96,128
buffer_load_dwordx4 v15, s[80:83], s54 offen offset:3168   lds
MAA 192,100,144
s_add_u32 s54, s54, 458752
MAA 196,100,148
TR 28,16,42336
MAA 196,96,132
TR 30,16,42848
MAA 212,104,132
TR 32,16,33920
MAA 212,108,148
TR 34,16,34432
s_mov_b32 m0, s67
MAA 208,108,144
buffer_load_dwordx4 v19, s[28:31], s58 offen offset:1056 lds
MAA 208,104,128
s_add_u32 s67, s67, 8448
s_add_u32 s58, s58, 0x40000
MAA 240,112,128
MAA 240,116,144
TR 36,16,42368
MAA 244,116,148
TR 38,16,42880
MAA 244,112,132
TR 40,16,33952
MAA 252,120,132
TR 42,16,34464
MAA 252,124,148
TR 44,16,42400
MAA 248,124,144
MAA 248,120,128
buffer_load_dwordx4 a[128:131], v10, s[16:19], s52 offen sc1
MAA 220,104,140
TR 46,16,42912
MAA 220,108,156
TR 48,17,33792
MAA 216,108,152
TR 50,17,34304
MAA 216,104,136
buffer_load_dwordx4 a[132:135], v10, s[16:19], s52 offen offset:1024 sc1
MAA 200,96,136
TR 52,17,42240
s_add_u32 s52, s52, 131072
MAA 200,100,152
MAA 204,100,156
TR 54,17,42752
MAA 204,96,140
TR 56,17,33824
MAA 156,88,140
TR 58,17,34336
MAA 156,92,156
TR 60,17,42272
MAA 152,92,152
buffer_load_dwordx4 a[144:147], v10, s[16:19], s52 offen sc1
MAA 152,88,136
TR 62,17,42784
MAA 136,80,136
MAA 136,84,152
RD 192,9,33792
MAA 140,84,156
RD 196,9,34848
MAA 140,80,140
RD 200,9,35904
MAA 92,72,140
buffer_load_dwordx4 a[148:151], v10, s[16:19], s52 offen offset:1024 sc1
MAA 92,76,156
RD 204,9,36960
s_add_u32 s52, s52, 131072
MAA 88,76,152
MAA 88,72,136
MAA 72,64,136
MAA 72,68,152
MAA 76,68,156
MAA 76,64,140
s_waitcnt vmcnt(18) lgkmcnt(0)
s_barrier
MAA 32,0,160
TR 64,16,50688
MAA 32,4,176
buffer_load_dwordx4 a[136:139], v11, s[16:19], s53 offen sc1
v_mfma_f32_16x16x32_bf16 a[212:215], a[208:211], a[192:195], a[212:215]
s_sub_u32 s47, s47, 1
s_cbranch_scc1 .Lx46
.Lx46b:
v_mfma_f32_16x16x32_bf16 a[212:215], a[208:211], a[196:199], a[212:215]
TR 66,16,51200
v_mfma_f32_16x16x32_bf16 a[212:215], a[208:211], a[200:203], a[212:215]
TR 68,16,59136
v_mfma_f32_16x16x32_bf16 a[212:215], a[208:211], a[204:207], a[212:215]
TR 70,16,59648
MAA 36,4,180
MAA 36,0,164
buffer_load_dwordx4 a[140:143], v11, s[16:19], s53 offen offset:1024 sc1
MAA 52,8,164
TR 72,16,50720
s_add_u32 s53, s53, 131072
MAA 52,12,180
TR 74,16,51232
MAA 48,12,176
TR 76,16,59168
MAA 48,8,160
TR 78,16,59680
MAA 96,16,160
MAA 96,20,176
buffer_load_dwordx4 a[152:155], v11, s[16:19], s53 offen sc1
MAA 100,20,180
TR 80,16,50752
MAA 100,16,164
TR 82,16,51264
MAA 116,24,164
TR 84,16,59200
MAA 116,28,180
TR 86,16,59712
MAA 112,28,176
MAA 112,24,160
TR 88,16,50784
MAA 160,32,160
buffer_load_dwordx4 a[156:159], v11, s[16:19], s53 offen offset:1024 sc1
MAA 160,36,176
TR 90,16,51296
s_add_u32 s53, s53, 131072
MAA 164,36,180
TR 92,16,59232
MAA 164,32,164
TR 94,16,59744
MAA 180,40,164
MAA 180,44,180
TR 96,16,50816
s_add_u32 m0, s55, 118272
MAA 176,44,176
buffer_load_dwordx4 v12, s[32:35], s54 offen   lds
MAA 176,40,160
TR 98,16,51328
MAA 224,48,160
TR 100,16,59264
MAA 224,52,176
TR 102,16,59776
MAA 228,52,180
MAA 228,48,164
TR 104,16,50848
MAA 236,56,164
TR 106,16,51360
MAA 236,60,180
buffer_load_dwordx4 v13, s[32:35], s54 offen offset:1056   lds
MAA 232,60,176
TR 108,16,59296
MAA 232,56,160
TR 110,16,59808
s_waitcnt vmcnt(20)
MAA 188,40,172
MAA 188,44,188
TR 112,17,50688
MAA 184,44,184
TR 114,17,51200
MAA 184,40,168
buffer_load_dwordx4 v14, s[32:35], s54 offen offset:2112   lds
MAA 168,32,168
TR 116,17,59136
MAA 168,36,184
TR 118,17,59648
MAA 172,36,188
MAA 172,32,172
TR 120,17,50720
MAA 124,24,172
TR 122,17,51232
MAA 124,28,188
TR 124,17,59168
MAA 120,28,184
buffer_load_dwordx4 v15, s[32:35], s54 offen offset:3168   lds
MAA 120,24,168
TR 126,17,59680
MAA 104,16,168
MAA 104,20,184
RD 192,9,50688
MAA 108,20,188
RD 196,9,51744
MAA 108,16,172
RD 200,9,52800
s_mov_b32 m0, s67
MAA 60,8,172
buffer_load_dwordx4 v18, s[28:31], s58 offen lds
MAA 60,12,188
RD 204,9,53856
MAA 56,12,184
MAA 56,8,168
MAA 40,0,168
MAA 40,4,184
MAA 44,4,188
MAA 44,0,172
s_waitcnt vmcnt(19) lgkmcnt(0)
s_barrier
MAA 64,64,160
ds_read_b64_tr_b16 a[0:1], v16
s_add_u32 m0, s55, 135168
MAA 64,68,176
buffer_load_dwordx4 v12, s[80:83], s54 offen   lds
v_mfma_f32_16x16x32_bf16 a[216:219], a[208:211], a[192:195], a[216:219]
s_sub_u32 s47, s47, 1
s_cbranch_scc1 .Lx47
.Lx47b:
v_mfma_f32_16x16x32_bf16 a[216:219], a[208:211], a[196:199], a[216:219]
TR 2,16,512
v_mfma_f32_16x16x32_bf16 a[216:219], a[208:211], a[200:203], a[216:219]
TR 4,16,8448
v_mfma_f32_16x16x32_bf16 a[216:219], a[208:211], a[204:207], a[216:219]
TR 6,16,8960
MAA 68,68,180
TR 8,16,32
MAA 68,64,164
buffer_load_dwordx4 v13, s[80:83], s54 offen offset:1056   lds
MAA 84,72,164
MAA 84,76,180
TR 10,16,544
MAA 80,76,176
TR 12,16,8480
MAA 80,72,160
TR 14,16,8992
MAA 128,80,160
TR 16,16,64
MAA 128,84,176
buffer_load_dwordx4 v14, s[80:83], s54 offen offset:2112   lds
MAA 132,84,180
MAA 132,80,164
TR 18,16,576
MAA 148,88,164
TR 20,16,8512
MAA 148,92,180
TR 22,16,9024
MAA 144,92,176
TR 24,16,96
MAA 144,88,160
TR 26,16,608
MAA 192,96,160
buffer_load_dwordx4 v15, s[80:83], s54 offen offset:3168   lds
MAA 192,100,176
s_add_u32 s54, s54, 458752
MAA 196,100,180
TR 28,16,8544
MAA 196,96,164
TR 30,16,9056
MAA 212,104,164
TR 32,16,128
MAA 212,108,180
TR 34,16,640
s_mov_b32 m0, s67
MAA 208,108,176
buffer_load_dwordx4 v19, s[28:31], s58 offen offset:1056 lds
MAA 208,104,160
s_add_u32 s67, s67, 8448
s_add_u32 s46, s46, 1
s_xor_b32 s58, s46, s87
s_mul_i32 s58, s58, 458752
MAA 240,112,160
MAA 240,116,176
TR 36,16,8576
MAA 244,116,180
TR 38,16,9088
MAA 244,112,164
TR 40,16,160
MAA 252,120,164
TR 42,16,672
MAA 252,124,180
TR 44,16,8608
MAA 248,124,176
MAA 248,120,160
buffer_load_dwordx4 a[160:163], v10, s[16:19], s52 offen sc1
MAA 220,104,172
TR 46,16,9120
MAA 220,108,188
ds_read_b64_tr_b16 a[48:49], v17
MAA 216,108,184
TR 50,17,512
MAA 216,104,168
buffer_load_dwordx4 a[164:167], v10, s[16:19], s52 offen offset:1024 sc1
MAA 200,96,168
TR 52,17,8448
s_add_u32 s52, s52, 131072
MAA 200,100,184
MAA 204,100,188
TR 54,17,8960
MAA 204,96,172
TR 56,17,32
MAA 156,88,172
TR 58,17,544
MAA 156,92,188
TR 60,17,8480
MAA 152,92,184
buffer_load_dwordx4 a[176:179], v10, s[16:19], s52 offen sc1
MAA 152,88,168
TR 62,17,8992
MAA 136,80,168
MAA 136,84,184
ds_read_b128 a[192:195], v9
MAA 140,84,188
RD 196,9,1056
MAA 140,80,172
RD 200,9,2112
MAA 92,72,172
buffer_load_dwordx4 a[180:183], v10, s[16:19], s52 offen offset:1024 sc1
MAA 92,76,188
RD 204,9,3168
s_add_u32 s52, s52, 131072
MAA 88,76,184
MAA 88,72,168
MAA 72,64,168
MAA 72,68,184
MAA 76,68,188
s_add_u32 s15, s15, 1
MAA 76,64,172
s_cbranch_scc0 .Lk43
s_branch .Lj48
.Lx39:
buffer_load_dword a220, v8, s[40:43], s45 offen
buffer_load_dword a220, v7, s[28:31], s44 offen
s_add_u32 s44, s44, 655360
s_add_u32 s45, s45, 917504
s_mov_b32 s47, 3
s_branch .Lx39b
.Lx40:
buffer_load_dword a220, v8, s[40:43], s45 offen
buffer_load_dword a220, v7, s[28:31], s44 offen
s_add_u32 s44, s44, 655360
s_add_u32 s45, s45, 917504
s_mov_b32 s47, 3
s_branch .Lx40b
.Lx41:
buffer_load_dword a220, v8, s[40:43], s45 offen
buffer_load_dword a220, v7, s[28:31], s44 offen
s_add_u32 s44, s44, 655360
s_add_u32 s45, s45, 917504
s_mov_b32 s47, 3
s_branch .Lx41b
.Lx42:
buffer_load_dword a220, v8, s[40:43], s45 offen
buffer_load_dword a220, v7, s[28:31], s44 offen
s_add_u32 s44, s44, 655360
s_add_u32 s45, s45, 917504
s_mov_b32 s47, 3
s_branch .Lx42b
.Lx44:
buffer_load_dword a220, v8, s[40:43], s45 offen
buffer_load_dword a220, v7, s[28:31], s44 offen
s_add_u32 s44, s44, 655360
s_add_u32 s45, s45, 917504
s_mov_b32 s47, 3
s_branch .Lx44b
.Lx45:
buffer_load_dword a220, v8, s[40:43], s45 offen
buffer_load_dword a220, v7, s[28:31], s44 offen
s_add_u32 s44, s44, 655360
s_add_u32 s45, s45, 917504
s_mov_b32 s47, 3
s_branch .Lx45b
.Lx46:
buffer_load_dword a220, v8, s[40:43], s45 offen
buffer_load_dword a220, v7, s[28:31], s44 offen
s_add_u32 s44, s44, 655360
s_add_u32 s45, s45, 917504
s_mov_b32 s47, 3
s_branch .Lx46b
.Lx47:
buffer_load_dword a220, v8, s[40:43], s45 offen
buffer_load_dword a220, v7, s[28:31], s44 offen
s_add_u32 s44, s44, 655360
s_add_u32 s45, s45, 917504
s_mov_b32 s47, 3
s_branch .Lx47b
.Lj48:
s_waitcnt vmcnt(10) lgkmcnt(0)
s_barrier
v_mfma_f32_16x16x32_bf16 a[212:215], a[208:211], a[192:195], a[212:215]
RD 112,9,16896
s_lshl_b32 s74, s3, 10
v_mfma_f32_16x16x32_bf16 a[212:215], a[208:211], a[196:199], a[212:215]
RD 116,9,17952
s_add_u32 s74, s74, 152576
v_mfma_f32_16x16x32_bf16 a[212:215], a[208:211], a[200:203], a[212:215]
RD 120,9,19008
s_sub_u32 s75, 156672, s74
v_mfma_f32_16x16x32_bf16 a[212:215], a[208:211], a[204:207], a[212:215]
RD 124,9,20064
v_and_b32 v7, 15, v1
MAA 32,0,128
RD 192,9,33792
v_lshl_add_u32 v7, v7, 5, s74
MAA 32,4,144
RD 196,9,34848
v_bfe_u32 v2, v1, 4, 1
MAA 48,12,144
RD 200,9,35904
v_lshl_add_u32 v7, v2, 4, v7
MAA 48,8,128
RD 204,9,36960
v_bfe_u32 v2, v1, 5, 1
MAA 36,0,132
buffer_load_dwordx4 a[168:171], v11, s[16:19], s53 offen sc1
s_waitcnt lgkmcnt(7)
v_mfma_f32_16x16x32_bf16 a[216:219], a[208:211], a[112:115], a[216:219]
TR 64,16,16896
v_mul_u32_u24 v2, s75, v2
s_waitcnt lgkmcnt(7)
v_mfma_f32_16x16x32_bf16 a[216:219], a[208:211], a[116:119], a[216:219]
TR 66,16,17408
v_add_u32 v7, v7, v2
s_waitcnt lgkmcnt(7)
v_mfma_f32_16x16x32_bf16 a[216:219], a[208:211], a[120:123], a[216:219]
TR 68,16,25344
v_lshlrev_b32 v2, 4, v1
s_waitcnt lgkmcnt(7)
v_mfma_f32_16x16x32_bf16 a[216:219], a[208:211], a[124:127], a[216:219]
buffer_load_dwordx4 a[172:175], v11, s[16:19], s53 offen offset:1024 sc1
s_waitcnt lgkmcnt(6)
v_mfma_f32_16x16x32_bf16 a[212:215], a[208:211], a[192:195], a[212:215]
TR 70,16,25856
s_add_u32 s53, s53, 131072
s_waitcnt lgkmcnt(6)
v_mfma_f32_16x16x32_bf16 a[212:215], a[208:211], a[196:199], a[212:215]
TR 72,16,16928
v_add_u32 v2, 152576, v2
s_waitcnt lgkmcnt(6)
v_mfma_f32_16x16x32_bf16 a[212:215], a[208:211], a[200:203], a[212:215]
TR 74,16,17440
s_lshl_b32 s74, s12, 7
s_waitcnt lgkmcnt(6)
v_mfma_f32_16x16x32_bf16 a[212:215], a[208:211], a[204:207], a[212:215]
buffer_load_dwordx4 a[184:187], v11, s[16:19], s53 offen sc1
MAA 36,4,148
TR 76,16,25376
s_add_u32 s74, s74, 161536
MAA 52,12,148
s_nop 2
ds_write_b128 v7, a[212:215]
s_waitcnt vmcnt(8)
s_barrier
MAA 52,8,132
RD 112,9,50688
s_xor_b32 s75, s12, 1
MAA 40,0,136
RD 116,9,51744
s_mul_i32 s75, s75, 384
MAA 40,4,152
RD 120,9,52800
s_add_u32 s75, s75, 161536
MAA 56,12,152
RD 124,9,53856
v_lshrrev_b32 v9, 4, v1
MAA 56,8,136
buffer_load_dwordx4 a[188:191], v11, s[16:19], s53 offen offset:1024 sc1
MAA 44,0,140
TR 78,16,25888
s_add_u32 s53, s53, 131072
MAA 44,4,156
TR 80,16,33792
v_lshlrev_b32 v9, 4, v9
MAA 60,12,156
TR 82,16,34304
v_add_u32 v8, s75, v9
MAA 60,8,140
TR 84,16,42240
v_add_u32 v9, s74, v9
s_waitcnt lgkmcnt(7)
v_mfma_f32_16x16x32_bf16 a[216:219], a[208:211], a[112:115], a[216:219]
TR 86,16,42752
s_add_u32 s58, s99, 2293760
s_waitcnt lgkmcnt(7)
v_mfma_f32_16x16x32_bf16 a[216:219], a[208:211], a[116:119], a[216:219]
TR 88,16,33824
s_lshl_b32 s74, s3, 11
s_waitcnt lgkmcnt(7)
v_mfma_f32_16x16x32_bf16 a[216:219], a[208:211], a[120:123], a[216:219]
TR 90,16,34336
s_add_u32 s74, s74, s84
s_waitcnt lgkmcnt(7)
v_mfma_f32_16x16x32_bf16 a[216:219], a[208:211], a[124:127], a[216:219]
TR 92,16,42272
s_add_u32 s54, s98, 65536
MAA 96,16,128
TR 94,16,42784
s_mul_i32 s55, s3, 2112
MAA 96,20,144
s_nop 1
ds_write_b128 v7, a[216:219] offset:512
s_mov_b32 s57, 67584
MAA 112,28,144
TR 96,16,50688
MAA 112,24,128
TR 98,16,51200
MAA 100,16,132
TR 100,16,59136
MAA 100,20,148
TR 102,16,59648
MAA 116,28,148
TR 104,16,50720
MAA 116,24,132
TR 106,16,51232
MAA 104,16,136
TR 108,16,59168
MAA 104,20,152
s_waitcnt lgkmcnt(7)
s_barrier
ds_read_b128 v[12:15], v2
MAA 120,28,152
ds_read_b128 v[4:7], v2 offset:1024
MAA 120,24,136
TR 110,16,59680
MAA 108,16,140
TR 192,16,16960
MAA 108,20,156
TR 194,16,17472
MAA 124,28,156
TR 196,16,25408
MAA 124,24,140
TR 198,16,25920
MAA 160,32,128
TR 200,16,16992
MAA 160,36,144
TR 202,16,17504
MAA 176,44,144
TR 204,16,25440
s_waitcnt lgkmcnt(8)
v_add_f32 v12, v12, v4
MAA 176,40,128
TR 206,16,25952
v_add_f32 v13, v13, v5
MAA 164,32,132
TR 112,16,33856
v_add_f32 v14, v14, v6
MAA 164,36,148
TR 114,16,34368
v_add_f32 v15, v15, v7
MAA 180,44,148
ds_read_b128 v[4:7], v2 offset:2048
MAA 180,40,132
TR 116,16,42304
MAA 168,32,136
.Lpad5:
s_cbranch_execz .Lnopoll34r
TR 118,16,42816
MAA 168,36,152
TR 120,16,33888
MAA 184,44,152
TR 122,16,34400
MAA 184,40,136
TR 124,16,42336
MAA 172,32,140
TR 126,16,42848
MAA 172,36,156
TR 0,16,50752
MAA 188,44,156
TR 2,16,51264
s_waitcnt lgkmcnt(8)
v_add_f32 v12, v12, v4
MAA 188,40,140
TR 4,16,59200
v_add_f32 v13, v13, v5
MAA 224,48,128
TR 6,16,59712
v_add_f32 v14, v14, v6
MAA 224,52,144
TR 8,16,50784
v_add_f32 v15, v15, v7
MAA 232,60,144
ds_read_b128 v[4:7], v2 offset:3072
MAA 232,56,128
TR 10,16,51296
MAA 228,48,132
TR 12,16,59232
MAA 228,52,148
TR 14,16,59744
MAA 236,60,148
TR 16,16,17024
MAA 236,56,132
TR 18,16,17536
MAA 64,64,128
TR 20,16,25472
MAA 64,68,144
TR 22,16,25984
s_waitcnt vmcnt(7)
MAA 64,96,160
TR 24,16,17056
s_waitcnt lgkmcnt(8)
v_add_f32 v12, v12, v4
s_waitcnt vmcnt(5)
MAA 64,100,176
TR 26,16,17568
v_add_f32 v13, v13, v5
MAA 80,108,176
TR 28,16,25504
v_add_f32 v14, v14, v6
MAA 80,104,160
TR 30,16,26016
v_add_f32 v15, v15, v7
MAA 80,76,144
ds_write_b128 v2, v[12:15] offset:8960
v_lshrrev_b32 v2, 3, v1
MAA 80,72,128
ds_read_b128 v[12:15], v9
v_cmp_eq_u32 vcc, 3, v2
MAA 32,80,160
ds_read_b128 v[4:7], v9 offset:64
MAA 32,84,176
TR 32,16,33920
MAA 48,92,176
TR 34,16,34432
MAA 48,88,160
TR 36,16,42368
TR 38,16,42880
TR 40,16,33952
TR 42,16,34464
TR 44,16,42400
TR 46,16,42912
TR 48,16,50816
TR 50,16,51328
s_waitcnt lgkmcnt(11)
v_pk_fma_f32 v[32:33], v[12:13], v[20:21], v[32:33] op_sel_hi:[1,0,1]
v_pk_fma_f32 v[34:35], v[14:15], v[20:21], v[34:35] op_sel_hi:[1,0,1]
v_pk_fma_f32 v[36:37], v[12:13], v[22:23], v[36:37] op_sel_hi:[1,0,1]
v_pk_fma_f32 v[38:39], v[14:15], v[22:23], v[38:39] op_sel_hi:[1,0,1]
v_pk_fma_f32 v[40:41], v[12:13], v[24:25], v[40:41] op_sel_hi:[1,0,1]
v_pk_fma_f32 v[42:43], v[14:15], v[24:25], v[42:43] op_sel_hi:[1,0,1]
v_pk_fma_f32 v[44:45], v[12:13], v[26:27], v[44:45] op_sel_hi:[1,0,1]
v_pk_fma_f32 v[46:47], v[14:15], v[26:27], v[46:47] op_sel_hi:[1,0,1]
ds_read_b128 v[12:15], v9 offset:512
s_waitcnt lgkmcnt(11)
v_pk_fma_f32 v[48:49], v[4:5], v[20:21], v[48:49] op_sel_hi:[1,0,1]
v_pk_fma_f32 v[50:51], v[6:7], v[20:21], v[50:51] op_sel_hi:[1,0,1]
v_pk_fma_f32 v[52:53], v[4:5], v[22:23], v[52:53] op_sel_hi:[1,0,1]
v_pk_fma_f32 v[54:55], v[6:7], v[22:23], v[54:55] op_sel_hi:[1,0,1]
v_pk_fma_f32 v[56:57], v[4:5], v[24:25], v[56:57] op_sel_hi:[1,0,1]
v_pk_fma_f32 v[58:59], v[6:7], v[24:25], v[58:59] op_sel_hi:[1,0,1]
v_pk_fma_f32 v[60:61], v[4:5], v[26:27], v[60:61] op_sel_hi:[1,0,1]
v_pk_fma_f32 v[62:63], v[6:7], v[26:27], v[62:63] op_sel_hi:[1,0,1]
ds_read_b128 v[4:7], v9 offset:576
TR 52,16,59264
TR 54,16,59776
TR 56,16,50848
TR 58,16,51360
TR 60,16,59296
TR 62,16,59808
s_waitcnt lgkmcnt(7)
v_pk_fma_f32 v[64:65], v[12:13], v[20:21], v[64:65] op_sel_hi:[1,0,1]
v_pk_fma_f32 v[66:67], v[14:15], v[20:21], v[66:67] op_sel_hi:[1,0,1]
v_pk_fma_f32 v[68:69], v[12:13], v[22:23], v[68:69] op_sel_hi:[1,0,1]
v_pk_fma_f32 v[70:71], v[14:15], v[22:23], v[70:71] op_sel_hi:[1,0,1]
v_pk_fma_f32 v[72:73], v[12:13], v[24:25], v[72:73] op_sel_hi:[1,0,1]
v_pk_fma_f32 v[74:75], v[14:15], v[24:25], v[74:75] op_sel_hi:[1,0,1]
v_pk_fma_f32 v[76:77], v[12:13], v[26:27], v[76:77] op_sel_hi:[1,0,1]
v_pk_fma_f32 v[78:79], v[14:15], v[26:27], v[78:79] op_sel_hi:[1,0,1]
ds_read_b128 v[12:15], v9 offset:832
s_waitcnt lgkmcnt(7)
v_pk_fma_f32 v[80:81], v[4:5], v[20:21], v[80:81] op_sel_hi:[1,0,1]
v_pk_fma_f32 v[82:83], v[6:7], v[20:21], v[82:83] op_sel_hi:[1,0,1]
v_pk_fma_f32 v[84:85], v[4:5], v[22:23], v[84:85] op_sel_hi:[1,0,1]
v_pk_fma_f32 v[86:87], v[6:7], v[22:23], v[86:87] op_sel_hi:[1,0,1]
v_pk_fma_f32 v[88:89], v[4:5], v[24:25], v[88:89] op_sel_hi:[1,0,1]
v_pk_fma_f32 v[90:91], v[6:7], v[24:25], v[90:91] op_sel_hi:[1,0,1]
v_pk_fma_f32 v[92:93], v[4:5], v[26:27], v[92:93] op_sel_hi:[1,0,1]
v_pk_fma_f32 v[94:95], v[6:7], v[26:27], v[94:95] op_sel_hi:[1,0,1]
ds_read_b128 v[4:7], v9 offset:704
v_pk_mul_f32 v[64:65], v[64:65], v[32:33]
v_pk_mul_f32 v[32:33], v[32:33], v[28:29] op_sel_hi:[1,0]
v_pk_mul_f32 v[66:67], v[66:67], v[34:35]
v_pk_mul_f32 v[34:35], v[34:35], v[28:29] op_sel_hi:[1,0]
v_pk_mul_f32 v[80:81], v[80:81], v[48:49]
v_pk_mul_f32 v[48:49], v[48:49], v[28:29] op_sel_hi:[1,0]
v_pk_mul_f32 v[82:83], v[82:83], v[50:51]
v_pk_mul_f32 v[50:51], v[50:51], v[28:29] op_sel_hi:[1,0]
v_exp_f32 v32, v32
s_nop 0
MAA 68,64,132
v_exp_f32 v33, v33
MAA 68,68,148
v_exp_f32 v34, v34
MAA 68,96,164
v_exp_f32 v35, v35
s_waitcnt vmcnt(4)
MAA 68,100,180
v_exp_f32 v48, v48
MAA 84,108,180
v_exp_f32 v49, v49
MAA 84,104,164
v_exp_f32 v50, v50
MAA 84,76,148
v_exp_f32 v51, v51
MAA 84,72,132
MAA 36,80,164
MAA 36,84,180
MAA 52,92,180
MAA 52,88,164
s_nop 5
v_pk_mul_f32 v[68:69], v[68:69], v[36:37]
v_pk_mul_f32 v[36:37], v[36:37], v[28:29] op_sel:[0,1] op_sel_hi:[1,1]
v_pk_mul_f32 v[70:71], v[70:71], v[38:39]
v_pk_mul_f32 v[38:39], v[38:39], v[28:29] op_sel:[0,1] op_sel_hi:[1,1]
v_pk_mul_f32 v[84:85], v[84:85], v[52:53]
v_pk_mul_f32 v[52:53], v[52:53], v[28:29] op_sel:[0,1] op_sel_hi:[1,1]
v_pk_mul_f32 v[86:87], v[86:87], v[54:55]
v_pk_mul_f32 v[54:55], v[54:55], v[28:29] op_sel:[0,1] op_sel_hi:[1,1]
v_pk_fma_f32 v[32:33], v[32:33], v[20:21], v[20:21] op_sel:[0,1,1] op_sel_hi:[1,1,1]
v_pk_fma_f32 v[34:35], v[34:35], v[20:21], v[20:21] op_sel:[0,1,1] op_sel_hi:[1,1,1]
v_pk_fma_f32 v[48:49], v[48:49], v[20:21], v[20:21] op_sel:[0,1,1] op_sel_hi:[1,1,1]
v_pk_fma_f32 v[50:51], v[50:51], v[20:21], v[20:21] op_sel:[0,1,1] op_sel_hi:[1,1,1]
v_rcp_f32 v32, v32
s_nop 0
MAA 72,64,136
v_rcp_f32 v33, v33
MAA 72,68,152
v_rcp_f32 v34, v34
s_waitcnt vmcnt(3)
MAA 72,96,168
v_rcp_f32 v35, v35
s_waitcnt vmcnt(1)
MAA 72,100,184
v_rcp_f32 v48, v48
MAA 88,108,184
v_rcp_f32 v49, v49
MAA 88,104,168
v_rcp_f32 v50, v50
MAA 88,76,152
v_rcp_f32 v51, v51
MAA 88,72,136
v_exp_f32 v36, v36
MAA 40,80,168
v_exp_f32 v37, v37
MAA 40,84,184
v_exp_f32 v38, v38
MAA 56,92,184
v_exp_f32 v39, v39
MAA 56,88,168
v_exp_f32 v52, v52
v_exp_f32 v53, v53
v_exp_f32 v54, v54
v_exp_f32 v55, v55
v_pk_mul_f32 v[64:65], v[64:65], v[32:33]
v_pk_mul_f32 v[66:67], v[66:67], v[34:35]
v_pk_mul_f32 v[80:81], v[80:81], v[48:49]
v_pk_mul_f32 v[82:83], v[82:83], v[50:51]
ds_read_b128 v[48:51], v9 offset:128
v_pk_mul_f32 v[72:73], v[72:73], v[40:41]
v_pk_mul_f32 v[40:41], v[40:41], v[30:31] op_sel_hi:[1,0]
v_pk_mul_f32 v[74:75], v[74:75], v[42:43]
v_pk_mul_f32 v[42:43], v[42:43], v[30:31] op_sel_hi:[1,0]
v_pk_mul_f32 v[88:89], v[88:89], v[56:57]
v_pk_mul_f32 v[56:57], v[56:57], v[30:31] op_sel_hi:[1,0]
v_pk_mul_f32 v[90:91], v[90:91], v[58:59]
v_pk_mul_f32 v[58:59], v[58:59], v[30:31] op_sel_hi:[1,0]
v_pk_fma_f32 v[36:37], v[36:37], v[22:23], v[22:23] op_sel:[0,1,1] op_sel_hi:[1,1,1]
v_pk_fma_f32 v[38:39], v[38:39], v[22:23], v[22:23] op_sel:[0,1,1] op_sel_hi:[1,1,1]
v_pk_fma_f32 v[52:53], v[52:53], v[22:23], v[22:23] op_sel:[0,1,1] op_sel_hi:[1,1,1]
v_pk_fma_f32 v[54:55], v[54:55], v[22:23], v[22:23] op_sel:[0,1,1] op_sel_hi:[1,1,1]
v_cvt_pk_bf16_f32 v32, v64, v65
v_cvt_pk_bf16_f32 v33, v66, v67
ds_read_b128 v[64:67], v9 offset:192
v_cvt_pk_bf16_f32 v34, v80, v81
v_cvt_pk_bf16_f32 v35, v82, v83
MAA 76,64,140
buffer_store_dwordx4 v[32:35], v10, s[16:19], s62 offen sc1
MAA 76,68,156
ds_read_b128 v[80:83], v9 offset:640
v_rcp_f32 v36, v36
MAA 76,96,172
TR 64,17,16896
v_rcp_f32 v37, v37
s_waitcnt vmcnt(1)
MAA 76,100,188
TR 66,17,17408
v_rcp_f32 v38, v38
MAA 92,108,188
TR 68,17,25344
v_rcp_f32 v39, v39
MAA 92,104,172
TR 70,17,25856
v_rcp_f32 v52, v52
MAA 92,76,156
TR 76,17,25376
v_rcp_f32 v53, v53
MAA 92,72,140
TR 72,17,16928
v_rcp_f32 v54, v54
MAA 44,80,172
TR 74,17,17440
v_rcp_f32 v55, v55
MAA 44,84,188
TR 78,17,25888
v_exp_f32 v40, v40
MAA 60,92,188
TR 80,17,33792
v_exp_f32 v41, v41
MAA 60,88,172
TR 82,17,34304
v_exp_f32 v42, v42
v_exp_f32 v43, v43
v_exp_f32 v56, v56
v_exp_f32 v57, v57
v_exp_f32 v58, v58
v_exp_f32 v59, v59
v_pk_mul_f32 v[68:69], v[68:69], v[36:37]
v_pk_mul_f32 v[70:71], v[70:71], v[38:39]
v_pk_mul_f32 v[84:85], v[84:85], v[52:53]
v_pk_mul_f32 v[86:87], v[86:87], v[54:55]
ds_read_b128 v[52:55], v8 offset:576
v_pk_mul_f32 v[76:77], v[76:77], v[44:45]
v_pk_mul_f32 v[44:45], v[44:45], v[30:31] op_sel:[0,1] op_sel_hi:[1,1]
v_pk_mul_f32 v[78:79], v[78:79], v[46:47]
v_pk_mul_f32 v[46:47], v[46:47], v[30:31] op_sel:[0,1] op_sel_hi:[1,1]
v_pk_mul_f32 v[92:93], v[92:93], v[60:61]
v_pk_mul_f32 v[60:61], v[60:61], v[30:31] op_sel:[0,1] op_sel_hi:[1,1]
v_pk_mul_f32 v[94:95], v[94:95], v[62:63]
v_pk_mul_f32 v[62:63], v[62:63], v[30:31] op_sel:[0,1] op_sel_hi:[1,1]
v_pk_fma_f32 v[40:41], v[40:41], v[24:25], v[24:25] op_sel:[0,1,1] op_sel_hi:[1,1,1]
v_pk_fma_f32 v[42:43], v[42:43], v[24:25], v[24:25] op_sel:[0,1,1] op_sel_hi:[1,1,1]
v_pk_fma_f32 v[56:57], v[56:57], v[24:25], v[24:25] op_sel:[0,1,1] op_sel_hi:[1,1,1]
v_pk_fma_f32 v[58:59], v[58:59], v[24:25], v[24:25] op_sel:[0,1,1] op_sel_hi:[1,1,1]
v_cvt_pk_bf16_f32 v36, v68, v69
v_cvt_pk_bf16_f32 v37, v70, v71
v_cvt_pk_bf16_f32 v38, v84, v85
v_cvt_pk_bf16_f32 v39, v86, v87
MAA 128,192,128
buffer_store_dwordx4 v[36:39], v10, s[16:19], s62 offen offset:1024 sc1
MAA 128,196,144
TR 84,17,42240
v_rcp_f32 v40, v40
MAA 128,0,160
TR 86,17,42752
v_rcp_f32 v41, v41
MAA 128,4,176
TR 88,17,33824
v_rcp_f32 v42, v42
MAA 144,12,176
TR 90,17,34336
v_rcp_f32 v43, v43
MAA 144,8,160
TR 92,17,42272
v_rcp_f32 v56, v56
MAA 144,204,144
TR 94,17,42784
v_rcp_f32 v57, v57
MAA 144,200,128
TR 96,17,50688
v_rcp_f32 v58, v58
MAA 96,112,160
TR 98,17,51200
v_rcp_f32 v59, v59
MAA 96,116,176
TR 100,17,59136
v_exp_f32 v44, v44
MAA 112,124,176
TR 102,17,59648
v_exp_f32 v45, v45
MAA 112,120,160
TR 104,17,50720
v_lshrrev_b32 v69, 2, v0
v_min_u32 v69, 1, v69
v_lshlrev_b32 v69, 28, v69
v_lshl_add_u32 v68, v0, 7, v69
v_xor_b32 v69, 64, v0
v_min_u32 v69, 1, v69
v_lshlrev_b32 v70, 4, v69
v_sub_u32 v70, 16, v70
v_lshlrev_b32 v69, 28, v69
v_mov_b32 v71, 1
v_mov_b32 v84, 0
v_mov_b32 v85, 0
v_mov_b32 v86, 0
v_exp_f32 v46, v46
v_exp_f32 v47, v47
v_exp_f32 v60, v60
v_exp_f32 v61, v61
v_exp_f32 v62, v62
v_exp_f32 v63, v63
v_pk_mul_f32 v[72:73], v[72:73], v[40:41]
v_pk_mul_f32 v[74:75], v[74:75], v[42:43]
v_pk_mul_f32 v[88:89], v[88:89], v[56:57]
v_pk_mul_f32 v[90:91], v[90:91], v[58:59]
s_waitcnt lgkmcnt(15)
v_pk_fma_f32 v[96:97], v[48:49], v[20:21], v[96:97] op_sel_hi:[1,0,1]
v_pk_fma_f32 v[98:99], v[50:51], v[20:21], v[98:99] op_sel_hi:[1,0,1]
v_pk_fma_f32 v[112:113], v[64:65], v[20:21], v[112:113] op_sel_hi:[1,0,1]
v_pk_fma_f32 v[114:115], v[66:67], v[20:21], v[114:115] op_sel_hi:[1,0,1]
v_pk_fma_f32 v[128:129], v[80:81], v[20:21], v[128:129] op_sel_hi:[1,0,1]
v_pk_fma_f32 v[130:131], v[82:83], v[20:21], v[130:131] op_sel_hi:[1,0,1]
v_pk_fma_f32 v[144:145], v[4:5], v[20:21], v[144:145] op_sel_hi:[1,0,1]
v_pk_fma_f32 v[146:147], v[6:7], v[20:21], v[146:147] op_sel_hi:[1,0,1]
v_pk_mul_f32 v[128:129], v[128:129], v[96:97]
v_pk_mul_f32 v[96:97], v[96:97], v[28:29] op_sel_hi:[1,0]
v_pk_mul_f32 v[130:131], v[130:131], v[98:99]
v_pk_mul_f32 v[98:99], v[98:99], v[28:29] op_sel_hi:[1,0]
v_pk_mul_f32 v[144:145], v[144:145], v[112:113]
v_pk_mul_f32 v[112:113], v[112:113], v[28:29] op_sel_hi:[1,0]
v_pk_mul_f32 v[146:147], v[146:147], v[114:115]
v_pk_mul_f32 v[114:115], v[114:115], v[28:29] op_sel_hi:[1,0]
v_pk_fma_f32 v[44:45], v[44:45], v[26:27], v[26:27] op_sel:[0,1,1] op_sel_hi:[1,1,1]
v_pk_fma_f32 v[46:47], v[46:47], v[26:27], v[26:27] op_sel:[0,1,1] op_sel_hi:[1,1,1]
v_pk_fma_f32 v[60:61], v[60:61], v[26:27], v[26:27] op_sel:[0,1,1] op_sel_hi:[1,1,1]
v_pk_fma_f32 v[62:63], v[62:63], v[26:27], v[26:27] op_sel:[0,1,1] op_sel_hi:[1,1,1]
v_cvt_pk_bf16_f32 v40, v72, v73
v_cvt_pk_bf16_f32 v41, v74, v75
v_cvt_pk_bf16_f32 v42, v88, v89
v_cvt_pk_bf16_f32 v43, v90, v91
MAA 132,192,132
buffer_store_dwordx4 v[40:43], v11, s[16:19], s62 offen sc1
MAA 132,196,148
TR 106,17,51232
v_rcp_f32 v44, v44
MAA 132,0,164
TR 108,17,59168
v_rcp_f32 v45, v45
MAA 132,4,180
TR 110,17,59680
v_rcp_f32 v46, v46
MAA 148,12,180
v_rcp_f32 v47, v47
MAA 148,8,164
v_rcp_f32 v60, v60
MAA 148,204,148
v_rcp_f32 v61, v61
MAA 148,200,132
v_rcp_f32 v62, v62
MAA 100,112,164
v_rcp_f32 v63, v63
MAA 100,116,180
v_exp_f32 v96, v96
MAA 116,124,180
v_exp_f32 v97, v97
MAA 116,120,164
s_waitcnt lgkmcnt(0)
s_barrier
s_add_u32 m0, s59, 84480
v_exp_f32 v98, v98
v_exp_f32 v99, v99
v_exp_f32 v112, v112
v_exp_f32 v113, v113
v_exp_f32 v114, v114
v_exp_f32 v115, v115
v_pk_mul_f32 v[76:77], v[76:77], v[44:45]
v_pk_mul_f32 v[78:79], v[78:79], v[46:47]
v_pk_mul_f32 v[92:93], v[92:93], v[60:61]
v_pk_mul_f32 v[94:95], v[94:95], v[62:63]
v_pk_fma_f32 v[100:101], v[48:49], v[22:23], v[100:101] op_sel_hi:[1,0,1]
v_pk_fma_f32 v[102:103], v[50:51], v[22:23], v[102:103] op_sel_hi:[1,0,1]
v_pk_fma_f32 v[116:117], v[64:65], v[22:23], v[116:117] op_sel_hi:[1,0,1]
v_pk_fma_f32 v[118:119], v[66:67], v[22:23], v[118:119] op_sel_hi:[1,0,1]
v_pk_fma_f32 v[132:133], v[80:81], v[22:23], v[132:133] op_sel_hi:[1,0,1]
v_pk_fma_f32 v[134:135], v[82:83], v[22:23], v[134:135] op_sel_hi:[1,0,1]
v_pk_fma_f32 v[148:149], v[4:5], v[22:23], v[148:149] op_sel_hi:[1,0,1]
v_pk_fma_f32 v[150:151], v[6:7], v[22:23], v[150:151] op_sel_hi:[1,0,1]
v_pk_mul_f32 v[132:133], v[132:133], v[100:101]
v_pk_mul_f32 v[100:101], v[100:101], v[28:29] op_sel:[0,1] op_sel_hi:[1,1]
v_pk_mul_f32 v[134:135], v[134:135], v[102:103]
v_pk_mul_f32 v[102:103], v[102:103], v[28:29] op_sel:[0,1] op_sel_hi:[1,1]
v_pk_mul_f32 v[148:149], v[148:149], v[116:117]
v_pk_mul_f32 v[116:117], v[116:117], v[28:29] op_sel:[0,1] op_sel_hi:[1,1]
v_pk_mul_f32 v[150:151], v[150:151], v[118:119]
v_pk_mul_f32 v[118:119], v[118:119], v[28:29] op_sel:[0,1] op_sel_hi:[1,1]
v_pk_fma_f32 v[96:97], v[96:97], v[20:21], v[20:21] op_sel:[0,1,1] op_sel_hi:[1,1,1]
v_pk_fma_f32 v[98:99], v[98:99], v[20:21], v[20:21] op_sel:[0,1,1] op_sel_hi:[1,1,1]
v_pk_fma_f32 v[112:113], v[112:113], v[20:21], v[20:21] op_sel:[0,1,1] op_sel_hi:[1,1,1]
v_pk_fma_f32 v[114:115], v[114:115], v[20:21], v[20:21] op_sel:[0,1,1] op_sel_hi:[1,1,1]
v_cvt_pk_bf16_f32 v44, v76, v77
v_cvt_pk_bf16_f32 v45, v78, v79
v_cvt_pk_bf16_f32 v46, v92, v93
v_cvt_pk_bf16_f32 v47, v94, v95
MAA 136,192,136
buffer_store_dwordx4 v[44:47], v11, s[16:19], s62 offen offset:1024 sc1
MAA 136,196,152
v_rcp_f32 v96, v96
MAA 136,0,168
v_rcp_f32 v97, v97
MAA 136,4,184
v_rcp_f32 v98, v98
MAA 152,12,184
buffer_load_dwordx4 v18, s[28:31], s58 offen lds
MAA 152,8,168
v_rcp_f32 v99, v99
MAA 152,204,152
v_rcp_f32 v112, v112
MAA 152,200,136
v_rcp_f32 v113, v113
MAA 104,112,168
buffer_load_dwordx4 v19, s[28:31], s58 offen offset:1056 lds
MAA 104,116,184
s_add_u32 m0, s59, 92928
s_add_u32 s58, s99, 2555904
v_rcp_f32 v114, v114
MAA 120,124,184
v_rcp_f32 v115, v115
MAA 120,120,168
v_exp_f32 v100, v100
v_exp_f32 v101, v101
v_exp_f32 v102, v102
v_exp_f32 v103, v103
v_exp_f32 v116, v116
v_exp_f32 v117, v117
v_exp_f32 v118, v118
v_exp_f32 v119, v119
v_pk_mul_f32 v[128:129], v[128:129], v[96:97]
v_pk_mul_f32 v[130:131], v[130:131], v[98:99]
v_pk_mul_f32 v[144:145], v[144:145], v[112:113]
v_pk_mul_f32 v[146:147], v[146:147], v[114:115]
ds_read_b128 v[112:115], v9 offset:256
v_pk_fma_f32 v[104:105], v[48:49], v[24:25], v[104:105] op_sel_hi:[1,0,1]
v_pk_fma_f32 v[106:107], v[50:51], v[24:25], v[106:107] op_sel_hi:[1,0,1]
v_pk_fma_f32 v[120:121], v[64:65], v[24:25], v[120:121] op_sel_hi:[1,0,1]
v_pk_fma_f32 v[122:123], v[66:67], v[24:25], v[122:123] op_sel_hi:[1,0,1]
v_pk_fma_f32 v[136:137], v[80:81], v[24:25], v[136:137] op_sel_hi:[1,0,1]
v_pk_fma_f32 v[138:139], v[82:83], v[24:25], v[138:139] op_sel_hi:[1,0,1]
v_pk_fma_f32 v[152:153], v[4:5], v[24:25], v[152:153] op_sel_hi:[1,0,1]
v_pk_fma_f32 v[154:155], v[6:7], v[24:25], v[154:155] op_sel_hi:[1,0,1]
v_pk_mul_f32 v[136:137], v[136:137], v[104:105]
v_pk_mul_f32 v[104:105], v[104:105], v[30:31] op_sel_hi:[1,0]
v_pk_mul_f32 v[138:139], v[138:139], v[106:107]
v_pk_mul_f32 v[106:107], v[106:107], v[30:31] op_sel_hi:[1,0]
v_pk_mul_f32 v[152:153], v[152:153], v[120:121]
v_pk_mul_f32 v[120:121], v[120:121], v[30:31] op_sel_hi:[1,0]
v_pk_mul_f32 v[154:155], v[154:155], v[122:123]
v_pk_mul_f32 v[122:123], v[122:123], v[30:31] op_sel_hi:[1,0]
v_pk_fma_f32 v[100:101], v[100:101], v[22:23], v[22:23] op_sel:[0,1,1] op_sel_hi:[1,1,1]
v_pk_fma_f32 v[102:103], v[102:103], v[22:23], v[22:23] op_sel:[0,1,1] op_sel_hi:[1,1,1]
v_pk_fma_f32 v[116:117], v[116:117], v[22:23], v[22:23] op_sel:[0,1,1] op_sel_hi:[1,1,1]
v_pk_fma_f32 v[118:119], v[118:119], v[22:23], v[22:23] op_sel:[0,1,1] op_sel_hi:[1,1,1]
v_cvt_pk_bf16_f32 v96, v128, v129
v_cvt_pk_bf16_f32 v97, v130, v131
ds_read_b128 v[128:131], v9 offset:320
v_cvt_pk_bf16_f32 v98, v144, v145
v_cvt_pk_bf16_f32 v99, v146, v147
MAA 140,192,140
buffer_store_dwordx4 v[96:99], v10, s[16:19], s63 offen sc1
MAA 140,196,156
ds_read_b128 v[144:147], v9 offset:768
v_rcp_f32 v100, v100
MAA 140,0,172
v_rcp_f32 v101, v101
MAA 140,4,188
v_rcp_f32 v102, v102
MAA 156,12,188
buffer_load_dwordx4 v18, s[28:31], s58 offen lds
MAA 156,8,172
v_rcp_f32 v103, v103
MAA 156,204,156
v_rcp_f32 v116, v116
MAA 156,200,140
v_rcp_f32 v117, v117
MAA 108,112,172
buffer_load_dwordx4 v19, s[28:31], s58 offen offset:1056 lds
MAA 108,116,188
s_add_u32 m0, s59, 101376
s_add_u32 s58, s100, 2752512
v_rcp_f32 v118, v118
MAA 124,124,188
v_rcp_f32 v119, v119
MAA 124,120,172
v_exp_f32 v104, v104
v_exp_f32 v105, v105
v_exp_f32 v106, v106
v_exp_f32 v107, v107
v_exp_f32 v120, v120
v_exp_f32 v121, v121
v_exp_f32 v122, v122
v_exp_f32 v123, v123
v_pk_mul_f32 v[132:133], v[132:133], v[100:101]
v_pk_mul_f32 v[134:135], v[134:135], v[102:103]
v_pk_mul_f32 v[148:149], v[148:149], v[116:117]
v_pk_mul_f32 v[150:151], v[150:151], v[118:119]
v_pk_fma_f32 v[108:109], v[48:49], v[26:27], v[108:109] op_sel_hi:[1,0,1]
v_pk_fma_f32 v[110:111], v[50:51], v[26:27], v[110:111] op_sel_hi:[1,0,1]
v_pk_fma_f32 v[124:125], v[64:65], v[26:27], v[124:125] op_sel_hi:[1,0,1]
v_pk_fma_f32 v[126:127], v[66:67], v[26:27], v[126:127] op_sel_hi:[1,0,1]
v_pk_fma_f32 v[140:141], v[80:81], v[26:27], v[140:141] op_sel_hi:[1,0,1]
v_pk_fma_f32 v[142:143], v[82:83], v[26:27], v[142:143] op_sel_hi:[1,0,1]
v_pk_fma_f32 v[156:157], v[4:5], v[26:27], v[156:157] op_sel_hi:[1,0,1]
v_pk_fma_f32 v[158:159], v[6:7], v[26:27], v[158:159] op_sel_hi:[1,0,1]
v_pk_mul_f32 v[140:141], v[140:141], v[108:109]
v_pk_mul_f32 v[108:109], v[108:109], v[30:31] op_sel:[0,1] op_sel_hi:[1,1]
v_pk_mul_f32 v[142:143], v[142:143], v[110:111]
v_pk_mul_f32 v[110:111], v[110:111], v[30:31] op_sel:[0,1] op_sel_hi:[1,1]
v_pk_mul_f32 v[156:157], v[156:157], v[124:125]
s_waitcnt vmcnt(5)
s_barrier
buffer_atomic_add v71, v68, s[16:19], s72 offen offset:512
v_pk_mul_f32 v[124:125], v[124:125], v[30:31] op_sel:[0,1] op_sel_hi:[1,1]
v_pk_mul_f32 v[158:159], v[158:159], v[126:127]
v_pk_mul_f32 v[126:127], v[126:127], v[30:31] op_sel:[0,1] op_sel_hi:[1,1]
v_pk_fma_f32 v[104:105], v[104:105], v[24:25], v[24:25] op_sel:[0,1,1] op_sel_hi:[1,1,1]
v_pk_fma_f32 v[106:107], v[106:107], v[24:25], v[24:25] op_sel:[0,1,1] op_sel_hi:[1,1,1]
v_pk_fma_f32 v[120:121], v[120:121], v[24:25], v[24:25] op_sel:[0,1,1] op_sel_hi:[1,1,1]
v_pk_fma_f32 v[122:123], v[122:123], v[24:25], v[24:25] op_sel:[0,1,1] op_sel_hi:[1,1,1]
v_cvt_pk_bf16_f32 v100, v132, v133
v_cvt_pk_bf16_f32 v101, v134, v135
v_cvt_pk_bf16_f32 v102, v148, v149
v_cvt_pk_bf16_f32 v103, v150, v151
MAA 192,16,128
v_rcp_f32 v104, v104
MAA 192,20,144
buffer_store_dwordx4 v[100:103], v10, s[16:19], s63 offen offset:1024 sc1
MAA 192,48,160
v_rcp_f32 v105, v105
MAA 192,52,176
v_rcp_f32 v106, v106
MAA 208,60,176
v_rcp_f32 v107, v107
MAA 208,56,160
buffer_load_dwordx4 v18, s[28:31], s58 offen lds
MAA 208,28,144
v_rcp_f32 v120, v120
MAA 208,24,128
v_rcp_f32 v121, v121
MAA 160,32,160
v_rcp_f32 v122, v122
MAA 160,36,176
buffer_load_dwordx4 v19, s[28:31], s58 offen offset:1056 lds
MAA 176,44,176
s_add_u32 m0, s59, 109824
s_add_u32 s58, s100, 3014656
v_rcp_f32 v123, v123
MAA 176,40,160
v_exp_f32 v108, v108
v_exp_f32 v109, v109
v_exp_f32 v110, v110
v_exp_f32 v111, v111
v_exp_f32 v124, v124
v_exp_f32 v125, v125
v_exp_f32 v126, v126
v_exp_f32 v127, v127
v_pk_mul_f32 v[136:137], v[136:137], v[104:105]
v_pk_mul_f32 v[138:139], v[138:139], v[106:107]
v_pk_mul_f32 v[152:153], v[152:153], v[120:121]
v_pk_mul_f32 v[154:155], v[154:155], v[122:123]
s_waitcnt lgkmcnt(2)
v_pk_fma_f32 v[160:161], v[112:113], v[20:21], v[160:161] op_sel_hi:[1,0,1]
v_pk_fma_f32 v[162:163], v[114:115], v[20:21], v[162:163] op_sel_hi:[1,0,1]
.Lpad6:
s_cbranch_execz .Lpad9
s_waitcnt lgkmcnt(1)
v_pk_fma_f32 v[176:177], v[128:129], v[20:21], v[176:177] op_sel_hi:[1,0,1]
v_pk_fma_f32 v[178:179], v[130:131], v[20:21], v[178:179] op_sel_hi:[1,0,1]
s_waitcnt lgkmcnt(0)
v_pk_fma_f32 v[192:193], v[144:145], v[20:21], v[192:193] op_sel_hi:[1,0,1]
v_pk_fma_f32 v[194:195], v[146:147], v[20:21], v[194:195] op_sel_hi:[1,0,1]
v_pk_fma_f32 v[208:209], v[12:13], v[20:21], v[208:209] op_sel_hi:[1,0,1]
v_pk_fma_f32 v[210:211], v[14:15], v[20:21], v[210:211] op_sel_hi:[1,0,1]
v_pk_mul_f32 v[192:193], v[192:193], v[160:161]
v_pk_mul_f32 v[160:161], v[160:161], v[28:29] op_sel_hi:[1,0]
v_pk_mul_f32 v[194:195], v[194:195], v[162:163]
v_pk_mul_f32 v[162:163], v[162:163], v[28:29] op_sel_hi:[1,0]
v_pk_mul_f32 v[208:209], v[208:209], v[176:177]
v_pk_mul_f32 v[176:177], v[176:177], v[28:29] op_sel_hi:[1,0]
v_pk_mul_f32 v[210:211], v[210:211], v[178:179]
v_pk_mul_f32 v[178:179], v[178:179], v[28:29] op_sel_hi:[1,0]
v_pk_fma_f32 v[108:109], v[108:109], v[26:27], v[26:27] op_sel:[0,1,1] op_sel_hi:[1,1,1]
v_pk_fma_f32 v[110:111], v[110:111], v[26:27], v[26:27] op_sel:[0,1,1] op_sel_hi:[1,1,1]
v_pk_fma_f32 v[124:125], v[124:125], v[26:27], v[26:27] op_sel:[0,1,1] op_sel_hi:[1,1,1]
v_pk_fma_f32 v[126:127], v[126:127], v[26:27], v[26:27] op_sel:[0,1,1] op_sel_hi:[1,1,1]
v_cvt_pk_bf16_f32 v104, v136, v137
v_cvt_pk_bf16_f32 v105, v138, v139
v_cvt_pk_bf16_f32 v106, v152, v153
v_cvt_pk_bf16_f32 v107, v154, v155
MAA 196,16,132
buffer_store_dwordx4 v[104:107], v11, s[16:19], s63 offen sc1
MAA 196,20,148
v_rcp_f32 v108, v108
MAA 196,48,164
v_rcp_f32 v109, v109
MAA 196,52,180
v_rcp_f32 v110, v110
MAA 212,60,180
buffer_load_dwordx4 v18, s[28:31], s58 offen lds
MAA 212,56,164
v_rcp_f32 v111, v111
MAA 212,28,148
v_rcp_f32 v124, v124
MAA 212,24,132
v_rcp_f32 v125, v125
MAA 164,32,164
buffer_load_dwordx4 v19, s[28:31], s58 offen offset:1056 lds
MAA 164,36,180
s_add_u32 m0, s59, 118272
s_add_u32 s58, s101, 3211264
v_rcp_f32 v126, v126
MAA 180,44,180
v_rcp_f32 v127, v127
MAA 180,40,164
v_lshl_add_u32 v4, v1, 4, s74
v_add_u32 v2, 67108480, v4
v_cndmask_b32 v4, v4, v2, vcc
s_and_b32 s74, s7, 1
v_bfe_u32 v7, v1, 2, 3
v_mul_u32_u24 v7, 1056, v7
v_bfe_u32 v2, v1, 5, 1
v_lshl_add_u32 v7, v2, 8, v7
v_and_b32 v2, 3, v1
v_lshl_add_u32 v7, v2, 3, v7
s_lshl_b32 s74, s74, 7
s_xor_b32 s75, s74, 128
v_add_u32 v6, s75, v7
v_add_u32 v7, s74, v7
v_exp_f32 v160, v160
v_exp_f32 v161, v161
v_exp_f32 v162, v162
v_exp_f32 v163, v163
v_exp_f32 v176, v176
v_exp_f32 v177, v177
v_exp_f32 v178, v178
v_exp_f32 v179, v179
v_pk_mul_f32 v[140:141], v[140:141], v[108:109]
v_pk_mul_f32 v[142:143], v[142:143], v[110:111]
v_pk_mul_f32 v[156:157], v[156:157], v[124:125]
v_pk_mul_f32 v[158:159], v[158:159], v[126:127]
v_pk_fma_f32 v[164:165], v[112:113], v[22:23], v[164:165] op_sel_hi:[1,0,1]
v_pk_fma_f32 v[166:167], v[114:115], v[22:23], v[166:167] op_sel_hi:[1,0,1]
v_pk_fma_f32 v[180:181], v[128:129], v[22:23], v[180:181] op_sel_hi:[1,0,1]
v_pk_fma_f32 v[182:183], v[130:131], v[22:23], v[182:183] op_sel_hi:[1,0,1]
v_pk_fma_f32 v[196:197], v[144:145], v[22:23], v[196:197] op_sel_hi:[1,0,1]
v_pk_fma_f32 v[198:199], v[146:147], v[22:23], v[198:199] op_sel_hi:[1,0,1]
v_pk_fma_f32 v[212:213], v[12:13], v[22:23], v[212:213] op_sel_hi:[1,0,1]
v_pk_fma_f32 v[214:215], v[14:15], v[22:23], v[214:215] op_sel_hi:[1,0,1]
v_pk_mul_f32 v[196:197], v[196:197], v[164:165]
v_pk_mul_f32 v[164:165], v[164:165], v[28:29] op_sel:[0,1] op_sel_hi:[1,1]
v_pk_mul_f32 v[198:199], v[198:199], v[166:167]
v_pk_mul_f32 v[166:167], v[166:167], v[28:29] op_sel:[0,1] op_sel_hi:[1,1]
v_pk_mul_f32 v[212:213], v[212:213], v[180:181]
v_pk_mul_f32 v[180:181], v[180:181], v[28:29] op_sel:[0,1] op_sel_hi:[1,1]
v_pk_mul_f32 v[214:215], v[214:215], v[182:183]
v_pk_mul_f32 v[182:183], v[182:183], v[28:29] op_sel:[0,1] op_sel_hi:[1,1]
v_pk_fma_f32 v[160:161], v[160:161], v[20:21], v[20:21] op_sel:[0,1,1] op_sel_hi:[1,1,1]
v_pk_fma_f32 v[162:163], v[162:163], v[20:21], v[20:21] op_sel:[0,1,1] op_sel_hi:[1,1,1]
v_pk_fma_f32 v[176:177], v[176:177], v[20:21], v[20:21] op_sel:[0,1,1] op_sel_hi:[1,1,1]
v_pk_fma_f32 v[178:179], v[178:179], v[20:21], v[20:21] op_sel:[0,1,1] op_sel_hi:[1,1,1]
v_cvt_pk_bf16_f32 v108, v140, v141
v_cvt_pk_bf16_f32 v109, v142, v143
v_cvt_pk_bf16_f32 v110, v156, v157
v_cvt_pk_bf16_f32 v111, v158, v159
MAA 200,16,136
buffer_store_dwordx4 v[108:111], v11, s[16:19], s63 offen offset:1024 sc1
MAA 200,20,152
v_rcp_f32 v160, v160
MAA 200,48,168
v_rcp_f32 v161, v161
MAA 200,52,184
v_rcp_f32 v162, v162
MAA 216,60,184
buffer_load_dwordx4 v18, s[28:31], s58 offen lds
MAA 216,56,168
v_rcp_f32 v163, v163
MAA 216,28,152
v_rcp_f32 v176, v176
MAA 216,24,136
v_rcp_f32 v177, v177
MAA 168,32,168
buffer_load_dwordx4 v19, s[28:31], s58 offen offset:1056 lds
MAA 168,36,184
s_add_u32 m0, s59, 126720
s_add_u32 s58, s101, 3473408
v_rcp_f32 v178, v178
MAA 184,44,184
v_rcp_f32 v179, v179
MAA 184,40,168
v_exp_f32 v164, v164
v_exp_f32 v165, v165
v_exp_f32 v166, v166
v_exp_f32 v167, v167
v_exp_f32 v180, v180
v_exp_f32 v181, v181
v_exp_f32 v182, v182
v_exp_f32 v183, v183
v_pk_mul_f32 v[192:193], v[192:193], v[160:161]
v_pk_mul_f32 v[194:195], v[194:195], v[162:163]
v_pk_mul_f32 v[208:209], v[208:209], v[176:177]
v_pk_mul_f32 v[210:211], v[210:211], v[178:179]
ds_read_b128 v[176:179], v8
v_pk_fma_f32 v[168:169], v[112:113], v[24:25], v[168:169] op_sel_hi:[1,0,1]
v_pk_fma_f32 v[170:171], v[114:115], v[24:25], v[170:171] op_sel_hi:[1,0,1]
v_pk_fma_f32 v[184:185], v[128:129], v[24:25], v[184:185] op_sel_hi:[1,0,1]
v_pk_fma_f32 v[186:187], v[130:131], v[24:25], v[186:187] op_sel_hi:[1,0,1]
v_pk_fma_f32 v[200:201], v[144:145], v[24:25], v[200:201] op_sel_hi:[1,0,1]
v_pk_fma_f32 v[202:203], v[146:147], v[24:25], v[202:203] op_sel_hi:[1,0,1]
v_pk_fma_f32 v[216:217], v[12:13], v[24:25], v[216:217] op_sel_hi:[1,0,1]
v_pk_fma_f32 v[218:219], v[14:15], v[24:25], v[218:219] op_sel_hi:[1,0,1]
v_pk_mul_f32 v[200:201], v[200:201], v[168:169]
v_pk_mul_f32 v[168:169], v[168:169], v[30:31] op_sel_hi:[1,0]
v_pk_mul_f32 v[202:203], v[202:203], v[170:171]
v_pk_mul_f32 v[170:171], v[170:171], v[30:31] op_sel_hi:[1,0]
v_pk_mul_f32 v[216:217], v[216:217], v[184:185]
v_pk_mul_f32 v[184:185], v[184:185], v[30:31] op_sel_hi:[1,0]
v_pk_mul_f32 v[218:219], v[218:219], v[186:187]
v_pk_mul_f32 v[186:187], v[186:187], v[30:31] op_sel_hi:[1,0]
v_pk_fma_f32 v[164:165], v[164:165], v[22:23], v[22:23] op_sel:[0,1,1] op_sel_hi:[1,1,1]
v_pk_fma_f32 v[166:167], v[166:167], v[22:23], v[22:23] op_sel:[0,1,1] op_sel_hi:[1,1,1]
v_pk_fma_f32 v[180:181], v[180:181], v[22:23], v[22:23] op_sel:[0,1,1] op_sel_hi:[1,1,1]
v_pk_fma_f32 v[182:183], v[182:183], v[22:23], v[22:23] op_sel:[0,1,1] op_sel_hi:[1,1,1]
v_cvt_pk_bf16_f32 v160, v192, v193
v_cvt_pk_bf16_f32 v161, v194, v195
ds_read_b128 v[192:195], v8 offset:64
v_cvt_pk_bf16_f32 v162, v208, v209
v_cvt_pk_bf16_f32 v163, v210, v211
MAA 204,16,140
buffer_store_dwordx4 v[160:163], v10, s[16:19], s64 offen sc1
MAA 204,20,156
ds_read_b128 v[208:211], v8 offset:512
v_rcp_f32 v164, v164
MAA 204,48,172
v_rcp_f32 v165, v165
MAA 204,52,188
v_rcp_f32 v166, v166
MAA 220,60,188
buffer_atomic_add v84, v69, s[16:19], s73 offen offset:512 sc0
MAA 220,56,172
v_rcp_f32 v167, v167
MAA 220,28,156
v_rcp_f32 v180, v180
MAA 220,24,140
v_rcp_f32 v181, v181
MAA 172,32,172
buffer_load_dwordx4 v18, s[28:31], s58 offen lds
MAA 172,36,188
v_rcp_f32 v182, v182
MAA 188,44,188
v_rcp_f32 v183, v183
MAA 188,40,172
v_exp_f32 v168, v168
v_exp_f32 v169, v169
v_exp_f32 v170, v170
v_exp_f32 v171, v171
v_exp_f32 v184, v184
v_exp_f32 v185, v185
v_exp_f32 v186, v186
v_exp_f32 v187, v187
v_pk_mul_f32 v[196:197], v[196:197], v[164:165]
v_pk_mul_f32 v[198:199], v[198:199], v[166:167]
v_pk_mul_f32 v[212:213], v[212:213], v[180:181]
v_pk_mul_f32 v[214:215], v[214:215], v[182:183]
v_pk_fma_f32 v[172:173], v[112:113], v[26:27], v[172:173] op_sel_hi:[1,0,1]
v_pk_fma_f32 v[174:175], v[114:115], v[26:27], v[174:175] op_sel_hi:[1,0,1]
v_pk_fma_f32 v[188:189], v[128:129], v[26:27], v[188:189] op_sel_hi:[1,0,1]
v_pk_fma_f32 v[190:191], v[130:131], v[26:27], v[190:191] op_sel_hi:[1,0,1]
v_pk_fma_f32 v[204:205], v[144:145], v[26:27], v[204:205] op_sel_hi:[1,0,1]
v_pk_fma_f32 v[206:207], v[146:147], v[26:27], v[206:207] op_sel_hi:[1,0,1]
v_pk_fma_f32 v[220:221], v[12:13], v[26:27], v[220:221] op_sel_hi:[1,0,1]
v_pk_fma_f32 v[222:223], v[14:15], v[26:27], v[222:223] op_sel_hi:[1,0,1]
v_pk_mul_f32 v[204:205], v[204:205], v[172:173]
v_pk_mul_f32 v[172:173], v[172:173], v[30:31] op_sel:[0,1] op_sel_hi:[1,1]
v_pk_mul_f32 v[206:207], v[206:207], v[174:175]
v_pk_mul_f32 v[174:175], v[174:175], v[30:31] op_sel:[0,1] op_sel_hi:[1,1]
v_pk_mul_f32 v[220:221], v[220:221], v[188:189]
v_pk_mul_f32 v[188:189], v[188:189], v[30:31] op_sel:[0,1] op_sel_hi:[1,1]
v_pk_mul_f32 v[222:223], v[222:223], v[190:191]
v_pk_mul_f32 v[190:191], v[190:191], v[30:31] op_sel:[0,1] op_sel_hi:[1,1]
v_pk_fma_f32 v[168:169], v[168:169], v[24:25], v[24:25] op_sel:[0,1,1] op_sel_hi:[1,1,1]
v_pk_fma_f32 v[170:171], v[170:171], v[24:25], v[24:25] op_sel:[0,1,1] op_sel_hi:[1,1,1]
v_pk_fma_f32 v[184:185], v[184:185], v[24:25], v[24:25] op_sel:[0,1,1] op_sel_hi:[1,1,1]
v_pk_fma_f32 v[186:187], v[186:187], v[24:25], v[24:25] op_sel:[0,1,1] op_sel_hi:[1,1,1]
v_cvt_pk_bf16_f32 v164, v196, v197
v_cvt_pk_bf16_f32 v165, v198, v199
v_cvt_pk_bf16_f32 v166, v212, v213
v_cvt_pk_bf16_f32 v167, v214, v215
MAA 240,64,128
buffer_store_dwordx4 v[164:167], v10, s[16:19], s64 offen offset:1024 sc1
MAA 240,68,144
v_rcp_f32 v168, v168
MAA 240,96,160
v_rcp_f32 v169, v169
MAA 240,100,176
v_rcp_f32 v170, v170
MAA 248,108,176
buffer_atomic_add v85, v69, s[16:19], s73 offen offset:512 sc0
MAA 248,104,160
v_rcp_f32 v171, v171
MAA 248,76,144
v_rcp_f32 v184, v184
MAA 248,72,128
v_rcp_f32 v185, v185
MAA 224,80,160
buffer_load_dwordx4 v19, s[28:31], s58 offen offset:1056 lds
MAA 224,84,176
v_rcp_f32 v186, v186
MAA 232,92,176
v_rcp_f32 v187, v187
MAA 232,88,160
v_exp_f32 v172, v172
v_exp_f32 v173, v173
v_exp_f32 v174, v174
v_exp_f32 v175, v175
v_exp_f32 v188, v188
v_exp_f32 v189, v189
v_exp_f32 v190, v190
v_exp_f32 v191, v191
v_pk_mul_f32 v[200:201], v[200:201], v[168:169]
v_pk_mul_f32 v[202:203], v[202:203], v[170:171]
v_pk_mul_f32 v[216:217], v[216:217], v[184:185]
v_pk_mul_f32 v[218:219], v[218:219], v[186:187]
s_waitcnt lgkmcnt(2)
v_pk_fma_f32 v[224:225], v[176:177], v[20:21], v[224:225] op_sel_hi:[1,0,1]
v_pk_fma_f32 v[226:227], v[178:179], v[20:21], v[226:227] op_sel_hi:[1,0,1]
s_waitcnt lgkmcnt(1)
v_pk_fma_f32 v[232:233], v[192:193], v[20:21], v[232:233] op_sel_hi:[1,0,1]
v_pk_fma_f32 v[234:235], v[194:195], v[20:21], v[234:235] op_sel_hi:[1,0,1]
s_waitcnt lgkmcnt(0)
v_pk_fma_f32 v[240:241], v[208:209], v[20:21], v[240:241] op_sel_hi:[1,0,1]
v_pk_fma_f32 v[242:243], v[210:211], v[20:21], v[242:243] op_sel_hi:[1,0,1]
v_pk_fma_f32 v[248:249], v[52:53], v[20:21], v[248:249] op_sel_hi:[1,0,1]
v_pk_fma_f32 v[250:251], v[54:55], v[20:21], v[250:251] op_sel_hi:[1,0,1]
v_pk_mul_f32 v[240:241], v[240:241], v[224:225]
v_pk_mul_f32 v[224:225], v[224:225], v[28:29] op_sel_hi:[1,0]
v_pk_mul_f32 v[242:243], v[242:243], v[226:227]
v_pk_mul_f32 v[226:227], v[226:227], v[28:29] op_sel_hi:[1,0]
v_pk_mul_f32 v[248:249], v[248:249], v[232:233]
v_pk_mul_f32 v[232:233], v[232:233], v[28:29] op_sel_hi:[1,0]
v_pk_mul_f32 v[250:251], v[250:251], v[234:235]
v_pk_mul_f32 v[234:235], v[234:235], v[28:29] op_sel_hi:[1,0]
v_pk_fma_f32 v[172:173], v[172:173], v[26:27], v[26:27] op_sel:[0,1,1] op_sel_hi:[1,1,1]
v_pk_fma_f32 v[174:175], v[174:175], v[26:27], v[26:27] op_sel:[0,1,1] op_sel_hi:[1,1,1]
v_pk_fma_f32 v[188:189], v[188:189], v[26:27], v[26:27] op_sel:[0,1,1] op_sel_hi:[1,1,1]
v_pk_fma_f32 v[190:191], v[190:191], v[26:27], v[26:27] op_sel:[0,1,1] op_sel_hi:[1,1,1]
v_cvt_pk_bf16_f32 v168, v200, v201
v_cvt_pk_bf16_f32 v169, v202, v203
v_cvt_pk_bf16_f32 v170, v216, v217
v_cvt_pk_bf16_f32 v171, v218, v219
buffer_store_dwordx4 v[168:171], v11, s[16:19], s64 offen sc1
buffer_atomic_add v86, v69, s[16:19], s73 offen offset:512 sc0
s_waitcnt vmcnt(6)
v_cmp_gt_u32 vcc, v70, v84
s_nop 0
s_cbranch_vccz .Lok49
s_waitcnt vmcnt(3)
v_cmp_gt_u32 vcc, v70, v85
s_nop 0
s_cbranch_vccz .Lok49
s_waitcnt vmcnt(0)
v_cmp_gt_u32 vcc, v70, v86
s_nop 0
s_cbranch_vccz .Lok49
s_mov_b32 s15, 0
.Lok49l:
v_mov_b32 v84, 0
buffer_atomic_add v84, v69, s[16:19], s73 offen offset:512 sc0
s_add_u32 s15, s15, 1
s_cmp_gt_u32 s15, 100000
s_waitcnt vmcnt(0)
s_cbranch_scc1 .Lok49
v_cmp_gt_u32 vcc, v70, v84
s_nop 0
s_cbranch_vccnz .Lok49l
.Lok49:
s_waitcnt vmcnt(2)
s_barrier
MAA 244,64,132
ds_read_b64_tr_b16 a[0:1], v7
s_add_u32 s52, s76, 0
MAA 244,68,148
buffer_load_dwordx4 v[96:99], v4, s[16:19], s52 offen sc1
MAA 244,96,164
TR 2,7,512
v_rcp_f32 v172, v172
MAA 244,100,180
TR 4,7,32
v_rcp_f32 v173, v173
MAA 252,108,180
TR 6,7,544
v_rcp_f32 v174, v174
MAA 252,104,164
buffer_load_dwordx4 v[100:103], v4, s[16:19], s52 offen offset:1024 sc1
MAA 252,76,148
TR 8,7,64
s_add_u32 s52, s76, 65536
MAA 252,72,132
TR 10,7,576
v_rcp_f32 v175, v175
MAA 228,80,164
TR 12,7,96
v_rcp_f32 v188, v188
MAA 228,84,180
buffer_load_dwordx4 v[104:107], v4, s[16:19], s52 offen sc1
MAA 236,92,180
TR 14,7,608
v_rcp_f32 v189, v189
MAA 236,88,164
TR 16,7,8448
v_rcp_f32 v190, v190
v_rcp_f32 v191, v191
v_exp_f32 v224, v224
v_exp_f32 v225, v225
v_exp_f32 v226, v226
v_exp_f32 v227, v227
v_exp_f32 v232, v232
v_exp_f32 v233, v233
v_exp_f32 v234, v234
v_exp_f32 v235, v235
v_pk_mul_f32 v[204:205], v[204:205], v[172:173]
buffer_load_dwordx4 v[108:111], v4, s[16:19], s52 offen offset:1024 sc1
s_add_u32 s52, s77, 114688
v_pk_mul_f32 v[206:207], v[206:207], v[174:175]
v_pk_mul_f32 v[220:221], v[220:221], v[188:189]
v_pk_mul_f32 v[222:223], v[222:223], v[190:191]
v_pk_fma_f32 v[228:229], v[176:177], v[22:23], v[228:229] op_sel_hi:[1,0,1]
v_pk_fma_f32 v[230:231], v[178:179], v[22:23], v[230:231] op_sel_hi:[1,0,1]
v_pk_fma_f32 v[236:237], v[192:193], v[22:23], v[236:237] op_sel_hi:[1,0,1]
v_pk_fma_f32 v[238:239], v[194:195], v[22:23], v[238:239] op_sel_hi:[1,0,1]
v_pk_fma_f32 v[244:245], v[208:209], v[22:23], v[244:245] op_sel_hi:[1,0,1]
v_pk_fma_f32 v[246:247], v[210:211], v[22:23], v[246:247] op_sel_hi:[1,0,1]
v_pk_fma_f32 v[252:253], v[52:53], v[22:23], v[252:253] op_sel_hi:[1,0,1]
v_pk_fma_f32 v[254:255], v[54:55], v[22:23], v[254:255] op_sel_hi:[1,0,1]
v_pk_mul_f32 v[244:245], v[244:245], v[228:229]
buffer_load_dwordx4 v[112:115], v4, s[16:19], s52 offen sc1
v_pk_mul_f32 v[228:229], v[228:229], v[28:29] op_sel:[0,1] op_sel_hi:[1,1]
v_pk_mul_f32 v[246:247], v[246:247], v[230:231]
v_pk_mul_f32 v[230:231], v[230:231], v[28:29] op_sel:[0,1] op_sel_hi:[1,1]
v_pk_mul_f32 v[252:253], v[252:253], v[236:237]
v_pk_mul_f32 v[236:237], v[236:237], v[28:29] op_sel:[0,1] op_sel_hi:[1,1]
v_pk_mul_f32 v[254:255], v[254:255], v[238:239]
v_pk_mul_f32 v[238:239], v[238:239], v[28:29] op_sel:[0,1] op_sel_hi:[1,1]
v_pk_fma_f32 v[224:225], v[224:225], v[20:21], v[20:21] op_sel:[0,1,1] op_sel_hi:[1,1,1]
v_pk_fma_f32 v[226:227], v[226:227], v[20:21], v[20:21] op_sel:[0,1,1] op_sel_hi:[1,1,1]
v_pk_fma_f32 v[232:233], v[232:233], v[20:21], v[20:21] op_sel:[0,1,1] op_sel_hi:[1,1,1]
v_pk_fma_f32 v[234:235], v[234:235], v[20:21], v[20:21] op_sel:[0,1,1] op_sel_hi:[1,1,1]
v_cvt_pk_bf16_f32 v172, v204, v205
v_cvt_pk_bf16_f32 v173, v206, v207
buffer_load_dwordx4 v[116:119], v4, s[16:19], s52 offen offset:1024 sc1
s_add_u32 s52, s77, 180224
v_cvt_pk_bf16_f32 v174, v220, v221
v_cvt_pk_bf16_f32 v175, v222, v223
TR 18,7,8960
TR 20,7,8480
TR 22,7,8992
TR 24,7,8512
TR 26,7,9024
buffer_store_dwordx4 v[172:175], v11, s[16:19], s64 offen offset:1024 sc1
TR 28,7,8544
TR 30,7,9056
v_rcp_f32 v224, v224
v_rcp_f32 v225, v225
v_rcp_f32 v226, v226
v_rcp_f32 v227, v227
v_rcp_f32 v232, v232
v_rcp_f32 v233, v233
v_rcp_f32 v234, v234
v_rcp_f32 v235, v235
v_exp_f32 v228, v228
v_exp_f32 v229, v229
v_exp_f32 v230, v230
v_exp_f32 v231, v231
v_exp_f32 v236, v236
v_exp_f32 v237, v237
v_exp_f32 v238, v238
v_exp_f32 v239, v239
v_pk_mul_f32 v[240:241], v[240:241], v[224:225]
buffer_load_dwordx4 v[120:123], v4, s[16:19], s52 offen sc1
v_pk_mul_f32 v[242:243], v[242:243], v[226:227]
v_pk_mul_f32 v[248:249], v[248:249], v[232:233]
v_pk_mul_f32 v[250:251], v[250:251], v[234:235]
v_pk_fma_f32 v[228:229], v[228:229], v[22:23], v[22:23] op_sel:[0,1,1] op_sel_hi:[1,1,1]
v_pk_fma_f32 v[230:231], v[230:231], v[22:23], v[22:23] op_sel:[0,1,1] op_sel_hi:[1,1,1]
v_pk_fma_f32 v[236:237], v[236:237], v[22:23], v[22:23] op_sel:[0,1,1] op_sel_hi:[1,1,1]
v_pk_fma_f32 v[238:239], v[238:239], v[22:23], v[22:23] op_sel:[0,1,1] op_sel_hi:[1,1,1]
v_cvt_pk_bf16_f32 v224, v240, v241
v_cvt_pk_bf16_f32 v225, v242, v243
v_cvt_pk_bf16_f32 v226, v248, v249
v_cvt_pk_bf16_f32 v227, v250, v251
v_rcp_f32 v228, v228
v_rcp_f32 v229, v229
v_rcp_f32 v230, v230
v_rcp_f32 v231, v231
v_rcp_f32 v236, v236
v_rcp_f32 v237, v237
v_rcp_f32 v238, v238
v_rcp_f32 v239, v239
v_pk_mul_f32 v[244:245], v[244:245], v[228:229]
buffer_store_dwordx4 v[224:227], v10, s[16:19], s65 offen sc1
v_pk_mul_f32 v[246:247], v[246:247], v[230:231]
v_pk_mul_f32 v[252:253], v[252:253], v[236:237]
v_pk_mul_f32 v[254:255], v[254:255], v[238:239]
v_cvt_pk_bf16_f32 v228, v244, v245
v_cvt_pk_bf16_f32 v229, v246, v247
v_cvt_pk_bf16_f32 v230, v252, v253
v_cvt_pk_bf16_f32 v231, v254, v255
buffer_store_dwordx4 v[228:231], v10, s[16:19], s65 offen offset:1024 sc1
buffer_load_dwordx4 v[124:127], v4, s[16:19], s52 offen offset:1024 sc1
v_mov_b32 v21, v68
v_mov_b32 v22, v69
v_mov_b32 v23, v70
v_mov_b32 v24, v71
v_mov_b32 v25, 0
s_waitcnt vmcnt(7) lgkmcnt(0)
s_barrier
v_mfma_f32_16x16x32_bf16 v[32:35], a[0:3], v[96:99], 0
ds_read_b64_tr_b16 a[32:33], v6
s_add_u32 s52, s78, 229376
MAV 32,16,104
buffer_load_dwordx4 v[128:131], v4, s[16:19], s52 offen sc1
v_mfma_f32_16x16x32_bf16 v[48:51], a[0:3], v[100:103], 0
TR 34,6,512
TR 36,6,32
MAV 48,16,108
TR 38,6,544
v_mfma_f32_16x16x32_bf16 v[52:55], a[4:7], v[100:103], 0
buffer_load_dwordx4 v[132:135], v4, s[16:19], s52 offen offset:1024 sc1
MAV 52,20,108
TR 48,6,8448
TR 50,6,8960
v_mfma_f32_16x16x32_bf16 v[36:39], a[4:7], v[96:99], 0
TR 52,6,8480
MAV 36,20,104
TR 54,6,8992
s_add_u32 s52, s78, 294912
v_mfma_f32_16x16x32_bf16 v[40:43], a[8:11], v[96:99], 0
buffer_load_dwordx4 v[136:139], v4, s[16:19], s52 offen sc1
MAV 40,24,104
TR 40,6,64
v_mfma_f32_16x16x32_bf16 v[56:59], a[8:11], v[100:103], 0
TR 42,6,576
TR 44,6,96
MAV 56,24,108
TR 46,6,608
v_mfma_f32_16x16x32_bf16 v[60:63], a[12:15], v[100:103], 0
buffer_load_dwordx4 v[140:143], v4, s[16:19], s52 offen offset:1024 sc1
MAV 60,28,108
TR 56,6,8512
TR 58,6,9024
v_mfma_f32_16x16x32_bf16 v[44:47], a[12:15], v[96:99], 0
TR 60,6,8544
MAV 44,28,104
TR 62,6,9056
s_waitcnt lgkmcnt(8)
v_mfma_f32_16x16x32_bf16 v[64:67], a[32:35], v[96:99], 0
TR 0,7,16896
s_add_u32 s52, s79, 344064
MAV 64,48,104
buffer_load_dwordx4 v[144:147], v4, s[16:19], s52 offen sc1
v_mfma_f32_16x16x32_bf16 v[80:83], a[32:35], v[100:103], 0
TR 2,7,17408
TR 4,7,16928
MAV 80,48,108
TR 6,7,17440
v_mfma_f32_16x16x32_bf16 v[84:87], a[36:39], v[100:103], 0
buffer_load_dwordx4 v[148:151], v4, s[16:19], s52 offen offset:1024 sc1
MAV 84,52,108
TR 16,7,25344
TR 18,7,25856
v_mfma_f32_16x16x32_bf16 v[68:71], a[36:39], v[96:99], 0
TR 20,7,25376
MAV 68,52,104
TR 22,7,25888
s_add_u32 s52, s79, 409600
s_waitcnt lgkmcnt(8)
v_mfma_f32_16x16x32_bf16 v[72:75], a[40:43], v[96:99], 0
buffer_load_dwordx4 v[152:155], v4, s[16:19], s52 offen sc1
MAV 72,56,104
TR 8,7,16960
v_mfma_f32_16x16x32_bf16 v[88:91], a[40:43], v[100:103], 0
TR 10,7,17472
TR 12,7,16992
MAV 88,56,108
TR 14,7,17504
v_mfma_f32_16x16x32_bf16 v[92:95], a[44:47], v[100:103], 0
buffer_load_dwordx4 v[156:159], v4, s[16:19], s52 offen offset:1024 sc1
MAV 92,60,108
TR 24,7,25408
TR 26,7,25920
v_mfma_f32_16x16x32_bf16 v[76:79], a[44:47], v[96:99], 0
TR 28,7,25440
MAV 76,60,104
TR 30,7,25952
s_waitcnt vmcnt(8) lgkmcnt(8)
s_barrier
MAV 32,0,112
TR 32,6,16896
TR 34,6,17408
MAV 32,16,120
buffer_atomic_add v24, v21, s[16:19], s72 offen
MAV 48,16,124
TR 36,6,16928
TR 38,6,17440
MAV 48,0,116
TR 48,6,25344
s_add_u32 m0, s55, 0
MAV 52,4,116
buffer_load_dwordx4 v18, s[28:31], s54 offen lds
MAV 52,20,124
TR 50,6,25856
MAV 36,20,120
TR 52,6,25376
TR 54,6,25888
MAV 36,4,112
TR 40,6,16960
s_add_u32 s52, s76, 458752
s_waitcnt lgkmcnt(9)
MAV 40,8,112
buffer_load_dwordx4 v[96:99], v4, s[16:19], s52 offen sc1
MAV 40,24,120
TR 42,6,17472
TR 44,6,16992
MAV 56,24,124
buffer_load_dwordx4 v19, s[28:31], s54 offen offset:1056 lds
MAV 56,8,116
s_add_u32 s54, s98, 327680
MAV 60,12,116
TR 46,6,17504
TR 56,6,25408
MAV 60,28,124
buffer_load_dwordx4 v[100:103], v4, s[16:19], s52 offen offset:1024 sc1
MAV 44,28,120
TR 58,6,25920
TR 60,6,25440
MAV 44,12,112
TR 62,6,25952
s_waitcnt lgkmcnt(8)
MAV 64,32,112
TR 0,7,33792
s_add_u32 m0, s55, 8448
MAV 64,48,120
buffer_load_dwordx4 v18, s[28:31], s54 offen lds
MAV 80,48,124
TR 2,7,34304
TR 4,7,33824
MAV 80,32,116
TR 6,7,34336
s_add_u32 s52, s76, 524288
MAV 84,36,116
buffer_load_dwordx4 v[104:107], v4, s[16:19], s52 offen sc1
MAV 84,52,124
TR 16,7,42240
MAV 68,52,120
TR 18,7,42752
TR 20,7,42272
.Lpad7:
s_cbranch_execz .Lpad10
MAV 68,36,112
TR 22,7,42784
s_waitcnt lgkmcnt(8)
MAV 72,40,112
buffer_load_dwordx4 v19, s[28:31], s54 offen offset:1056 lds
MAV 72,56,120
s_add_u32 s54, s99, 524288
MAV 88,56,124
TR 8,7,33856
TR 10,7,34368
MAV 88,40,116
TR 12,7,33888
TR 14,7,34400
MAV 92,44,116
buffer_load_dwordx4 v[108:111], v4, s[16:19], s52 offen offset:1024 sc1
MAV 92,60,124
TR 24,7,42304
MAV 76,60,120
TR 26,7,42816
TR 28,7,42336
MAV 76,44,112
TR 30,7,42848
s_waitcnt vmcnt(13) lgkmcnt(8)
s_barrier
MAV 32,0,128
TR 32,6,33792
s_add_u32 m0, s55, 16896
MAV 32,16,136
buffer_load_dwordx4 v18, s[28:31], s54 offen lds
MAV 48,16,140
TR 34,6,34304
TR 36,6,33824
MAV 48,0,132
TR 38,6,34336
s_add_u32 s52, s77, 573440
MAV 52,4,132
buffer_load_dwordx4 v[112:115], v4, s[16:19], s52 offen sc1
MAV 52,20,140
TR 48,6,42240
MAV 36,20,136
TR 50,6,42752
TR 52,6,42272
MAV 36,4,128
TR 54,6,42784
s_waitcnt lgkmcnt(8)
MAV 40,8,128
buffer_load_dwordx4 v19, s[28:31], s54 offen offset:1056 lds
MAV 40,24,136
s_add_u32 s54, s99, 786432
MAV 56,24,140
TR 40,6,33856
TR 42,6,34368
MAV 56,8,132
TR 44,6,33888
TR 46,6,34400
MAV 60,12,132
buffer_load_dwordx4 v[116:119], v4, s[16:19], s52 offen offset:1024 sc1
MAV 60,28,140
TR 56,6,42304
MAV 44,28,136
TR 58,6,42816
TR 60,6,42336
MAV 44,12,128
TR 62,6,42848
s_waitcnt lgkmcnt(8)
MAV 64,32,128
TR 0,7,50688
s_add_u32 m0, s55, 25344
MAV 64,48,136
buffer_load_dwordx4 v18, s[28:31], s54 offen lds
MAV 80,48,140
TR 2,7,51200
TR 4,7,50720
MAV 80,32,132
TR 6,7,51232
s_add_u32 s52, s77, 638976
MAV 84,36,132
buffer_load_dwordx4 v[120:123], v4, s[16:19], s52 offen sc1
MAV 84,52,140
TR 16,7,59136
TR 18,7,59648
MAV 68,52,136
TR 20,7,59168
TR 22,7,59680
MAV 68,36,128
s_waitcnt lgkmcnt(8)
MAV 72,40,128
buffer_load_dwordx4 v19, s[28:31], s54 offen offset:1056 lds
MAV 72,56,136
TR 8,7,50752
s_add_u32 s54, s100, 983040
MAV 88,56,140
buffer_load_dwordx4 v[124:127], v4, s[16:19], s52 offen offset:1024 sc1
MAV 88,40,132
TR 10,7,51264
TR 12,7,50784
MAV 92,44,132
TR 14,7,51296
TR 24,7,59200
MAV 92,60,140
buffer_atomic_add v25, v22, s[16:19], s73 offen sc0
MAV 76,60,136
TR 26,7,59712
TR 28,7,59232
MAV 76,44,128
TR 30,7,59744
s_waitcnt vmcnt(18) lgkmcnt(8)
s_barrier
MAV 32,0,144
TR 32,6,50688
s_add_u32 m0, s55, 33792
MAV 32,16,152
buffer_load_dwordx4 v18, s[28:31], s54 offen lds
MAV 48,16,156
TR 34,6,51200
TR 36,6,50720
MAV 48,0,148
TR 38,6,51232
s_add_u32 s52, s78, 688128
MAV 52,4,148
buffer_load_dwordx4 v[128:131], v4, s[16:19], s52 offen sc1
MAV 52,20,156
TR 48,6,59136
MAV 36,20,152
TR 50,6,59648
TR 52,6,59168
MAV 36,4,144
TR 54,6,59680
s_waitcnt lgkmcnt(8)
MAV 40,8,144
buffer_load_dwordx4 v19, s[28:31], s54 offen offset:1056 lds
MAV 40,24,152
s_add_u32 s54, s100, 1245184
MAV 56,24,156
TR 40,6,50752
TR 42,6,51264
MAV 56,8,148
TR 44,6,50784
TR 46,6,51296
MAV 60,12,148
buffer_load_dwordx4 v[132:135], v4, s[16:19], s52 offen offset:1024 sc1
MAV 60,28,156
TR 56,6,59200
MAV 44,28,152
TR 58,6,59712
TR 60,6,59232
MAV 44,12,144
TR 62,6,59744
v_add_u32 v7, s57, v7
v_add_u32 v6, s57, v6
s_sub_u32 s57, 0, s57
s_waitcnt lgkmcnt(8)
MAV 64,32,144
ds_read_b64_tr_b16 a[0:1], v7
s_add_u32 m0, s55, 42240
MAV 64,48,152
buffer_load_dwordx4 v18, s[28:31], s54 offen lds
MAV 80,48,156
TR 2,7,512
TR 4,7,32
MAV 80,32,148
TR 6,7,544
s_add_u32 s52, s78, 753664
MAV 84,36,148
buffer_load_dwordx4 v[136:139], v4, s[16:19], s52 offen sc1
MAV 84,52,156
TR 16,7,8448
MAV 68,52,152
TR 18,7,8960
TR 20,7,8480
MAV 68,36,144
TR 22,7,8992
s_waitcnt lgkmcnt(8)
MAV 72,40,144
buffer_load_dwordx4 v19, s[28:31], s54 offen offset:1056 lds
MAV 72,56,152
s_add_u32 s54, s101, 1441792
MAV 88,56,156
TR 8,7,64
TR 10,7,576
MAV 88,40,148
TR 12,7,96
TR 14,7,608
MAV 92,44,148
buffer_load_dwordx4 v[140:143], v4, s[16:19], s52 offen offset:1024 sc1
MAV 92,60,156
TR 24,7,8512
MAV 76,60,152
TR 26,7,9024
TR 28,7,8544
MAV 76,44,144
TR 30,7,9056
s_waitcnt vmcnt(17) lgkmcnt(8)
s_barrier
MAV 32,0,96
ds_read_b64_tr_b16 a[32:33], v6
s_add_u32 m0, s55, 50688
MAV 32,16,104
buffer_load_dwordx4 v18, s[28:31], s54 offen lds
MAV 48,16,108
TR 34,6,512
TR 36,6,32
MAV 48,0,100
TR 38,6,544
s_add_u32 s52, s79, 802816
MAV 52,4,100
buffer_load_dwordx4 v[144:147], v4, s[16:19], s52 offen sc1
MAV 52,20,108
TR 48,6,8448
MAV 36,20,104
TR 50,6,8960
TR 52,6,8480
MAV 36,4,96
TR 54,6,8992
s_waitcnt lgkmcnt(8)
MAV 40,8,96
buffer_load_dwordx4 v19, s[28:31], s54 offen offset:1056 lds
MAV 40,24,104
s_add_u32 s54, s101, 1703936
MAV 56,24,108
TR 40,6,64
TR 42,6,576
MAV 56,8,100
TR 44,6,96
TR 46,6,608
MAV 60,12,100
buffer_load_dwordx4 v[148:151], v4, s[16:19], s52 offen offset:1024 sc1
MAV 60,28,108
TR 56,6,8512
MAV 44,28,104
TR 58,6,9024
TR 60,6,8544
MAV 44,12,96
TR 62,6,9056
s_waitcnt lgkmcnt(8)
MAV 64,32,96
TR 0,7,16896
s_add_u32 m0, s55, 59136
MAV 64,48,104
buffer_load_dwordx4 v18, s[28:31], s54 offen lds
MAV 80,48,108
TR 2,7,17408
TR 4,7,16928
MAV 80,32,100
TR 6,7,17440
s_add_u32 s52, s79, 868352
MAV 84,36,100
buffer_load_dwordx4 v[152:155], v4, s[16:19], s52 offen sc1
MAV 84,52,108
TR 16,7,25344
MAV 68,52,104
TR 18,7,25856
TR 20,7,25376
MAV 68,36,96
TR 22,7,25888
s_waitcnt lgkmcnt(8)
MAV 72,40,96
buffer_load_dwordx4 v19, s[28:31], s54 offen offset:1056 lds
MAV 72,56,104
s_add_u32 s54, s98, 1900544
MAV 88,56,108
TR 8,7,16960
TR 10,7,17472
MAV 88,40,100
TR 12,7,16992
TR 14,7,17504
MAV 92,44,100
buffer_load_dwordx4 v[156:159], v4, s[16:19], s52 offen offset:1024 sc1
MAV 92,60,108
TR 24,7,25408
MAV 76,60,104
TR 26,7,25920
TR 28,7,25440
MAV 76,44,96
TR 30,7,25952
s_waitcnt vmcnt(16)
v_cmp_gt_u32 vcc, v23, v25
s_nop 0
s_cbranch_vccnz .Lsp50
.Lsp50b:
s_waitcnt lgkmcnt(8)
s_barrier
MAV 32,0,112
TR 32,6,16896
s_add_u32 m0, s55, 67584
MAV 32,16,120
buffer_load_dwordx4 v18, s[28:31], s54 offen lds
MAV 48,16,124
TR 34,6,17408
TR 36,6,16928
MAV 48,0,116
TR 38,6,17440
s_add_u32 s52, s76, 16384
MAV 52,4,116
buffer_load_dwordx4 v[96:99], v4, s[16:19], s52 offen sc1
MAV 52,20,124
TR 48,6,25344
MAV 36,20,120
TR 50,6,25856
TR 52,6,25376
MAV 36,4,112
TR 54,6,25888
s_waitcnt lgkmcnt(8)
MAV 40,8,112
buffer_load_dwordx4 v19, s[28:31], s54 offen offset:1056 lds
MAV 40,24,120
s_add_u32 s54, s98, 2162688
MAV 56,24,124
TR 40,6,16960
TR 42,6,17472
MAV 56,8,116
TR 44,6,16992
TR 46,6,17504
MAV 60,12,116
buffer_load_dwordx4 v[100:103], v4, s[16:19], s52 offen offset:1024 sc1
MAV 60,28,124
TR 56,6,25408
MAV 44,28,120
TR 58,6,25920
TR 60,6,25440
MAV 44,12,112
TR 62,6,25952
s_waitcnt lgkmcnt(8)
MAV 64,32,112
TR 0,7,33792
s_add_u32 m0, s55, 76032
MAV 64,48,120
buffer_load_dwordx4 v18, s[28:31], s54 offen lds
MAV 80,48,124
TR 2,7,34304
TR 4,7,33824
MAV 80,32,116
TR 6,7,34336
s_add_u32 s52, s76, 81920
MAV 84,36,116
buffer_load_dwordx4 v[104:107], v4, s[16:19], s52 offen sc1
MAV 84,52,124
TR 16,7,42240
MAV 68,52,120
TR 18,7,42752
TR 20,7,42272
MAV 68,36,112
TR 22,7,42784
s_waitcnt lgkmcnt(8)
MAV 72,40,112
buffer_load_dwordx4 v19, s[28:31], s54 offen offset:1056 lds
MAV 72,56,120
s_add_u32 s54, s99, 2359296
MAV 88,56,124
TR 8,7,33856
TR 10,7,34368
MAV 88,40,116
TR 12,7,33888
TR 14,7,34400
MAV 92,44,116
buffer_load_dwordx4 v[108:111], v4, s[16:19], s52 offen offset:1024 sc1
MAV 92,60,124
TR 24,7,42304
MAV 76,60,120
TR 26,7,42816
TR 28,7,42336
MAV 76,44,112
TR 30,7,42848
s_waitcnt vmcnt(16) lgkmcnt(8)
s_barrier
MAV 32,0,128
TR 32,6,33792
s_add_u32 m0, s55, 84480
MAV 32,16,136
buffer_load_dwordx4 v18, s[28:31], s54 offen lds
MAV 48,16,140
TR 34,6,34304
TR 36,6,33824
MAV 48,0,132
TR 38,6,34336
s_add_u32 s52, s77, 131072
MAV 52,4,132
buffer_load_dwordx4 v[112:115], v4, s[16:19], s52 offen sc1
MAV 52,20,140
TR 48,6,42240
MAV 36,20,136
TR 50,6,42752
TR 52,6,42272
MAV 36,4,128
TR 54,6,42784
s_waitcnt lgkmcnt(8)
MAV 40,8,128
buffer_load_dwordx4 v19, s[28:31], s54 offen offset:1056 lds
MAV 40,24,136
s_add_u32 s54, s99, 2621440
MAV 56,24,140
TR 40,6,33856
TR 42,6,34368
MAV 56,8,132
TR 44,6,33888
TR 46,6,34400
MAV 60,12,132
buffer_load_dwordx4 v[116:119], v4, s[16:19], s52 offen offset:1024 sc1
MAV 60,28,140
TR 56,6,42304
MAV 44,28,136
TR 58,6,42816
TR 60,6,42336
MAV 44,12,128
TR 62,6,42848
s_waitcnt lgkmcnt(8)
MAV 64,32,128
TR 0,7,50688
s_add_u32 m0, s55, 92928
MAV 64,48,136
buffer_load_dwordx4 v18, s[28:31], s54 offen lds
MAV 80,48,140
TR 2,7,51200
TR 4,7,50720
MAV 80,32,132
TR 6,7,51232
s_add_u32 s52, s77, 196608
MAV 84,36,132
buffer_load_dwordx4 v[120:123], v4, s[16:19], s52 offen sc1
MAV 84,52,140
TR 16,7,59136
MAV 68,52,136
TR 18,7,59648
TR 20,7,59168
MAV 68,36,128
TR 22,7,59680
s_waitcnt lgkmcnt(8)
MAV 72,40,128
buffer_load_dwordx4 v19, s[28:31], s54 offen offset:1056 lds
MAV 72,56,136
s_add_u32 s54, s100, 2818048
MAV 88,56,140
TR 8,7,50752
TR 10,7,51264
MAV 88,40,132
TR 12,7,50784
TR 14,7,51296
MAV 92,44,132
buffer_load_dwordx4 v[124:127], v4, s[16:19], s52 offen offset:1024 sc1
MAV 92,60,140
TR 24,7,59200
MAV 76,60,136
TR 26,7,59712
TR 28,7,59232
MAV 76,44,128
TR 30,7,59744
s_waitcnt vmcnt(16) lgkmcnt(8)
s_barrier
MAV 32,0,144
TR 32,6,50688
s_add_u32 m0, s55, 101376
MAV 32,16,152
buffer_load_dwordx4 v18, s[28:31], s54 offen lds
MAV 48,16,156
TR 34,6,51200
TR 36,6,50720
MAV 48,0,148
TR 38,6,51232
s_add_u32 s52, s78, 245760
MAV 52,4,148
buffer_load_dwordx4 v[128:131], v4, s[16:19], s52 offen sc1
MAV 52,20,156
TR 48,6,59136
MAV 36,20,152
TR 50,6,59648
TR 52,6,59168
MAV 36,4,144
TR 54,6,59680
s_waitcnt lgkmcnt(8)
MAV 40,8,144
buffer_load_dwordx4 v19, s[28:31], s54 offen offset:1056 lds
MAV 40,24,152
s_add_u32 s54, s100, 3080192
MAV 56,24,156
TR 40,6,50752
TR 42,6,51264
MAV 56,8,148
TR 44,6,50784
TR 46,6,51296
MAV 60,12,148
buffer_load_dwordx4 v[132:135], v4, s[16:19], s52 offen offset:1024 sc1
MAV 60,28,156
TR 56,6,59200
MAV 44,28,152
TR 58,6,59712
TR 60,6,59232
MAV 44,12,144
TR 62,6,59744
v_add_u32 v7, s57, v7
v_add_u32 v6, s57, v6
s_sub_u32 s57, 0, s57
s_waitcnt lgkmcnt(8)
MAV 64,32,144
ds_read_b64_tr_b16 a[0:1], v7
s_add_u32 m0, s55, 109824
MAV 64,48,152
buffer_load_dwordx4 v18, s[28:31], s54 offen lds
MAV 80,48,156
TR 2,7,512
TR 4,7,32
MAV 80,32,148
TR 6,7,544
s_add_u32 s52, s78, 311296
MAV 84,36,148
buffer_load_dwordx4 v[136:139], v4, s[16:19], s52 offen sc1
MAV 84,52,156
TR 16,7,8448
MAV 68,52,152
TR 18,7,8960
TR 20,7,8480
MAV 68,36,144
TR 22,7,8992
s_waitcnt lgkmcnt(8)
MAV 72,40,144
buffer_load_dwordx4 v19, s[28:31], s54 offen offset:1056 lds
MAV 72,56,152
s_add_u32 s54, s101, 3276800
MAV 88,56,156
TR 8,7,64
TR 10,7,576
MAV 88,40,148
TR 12,7,96
TR 14,7,608
MAV 92,44,148
buffer_load_dwordx4 v[140:143], v4, s[16:19], s52 offen offset:1024 sc1
MAV 92,60,156
TR 24,7,8512
MAV 76,60,152
TR 26,7,9024
TR 28,7,8544
MAV 76,44,144
TR 30,7,9056
s_waitcnt vmcnt(16) lgkmcnt(8)
.Lpad8:
s_cbranch_execz .Lpad11
s_barrier
MAV 32,0,96
ds_read_b64_tr_b16 a[32:33], v6
s_add_u32 m0, s55, 118272
MAV 32,16,104
buffer_load_dwordx4 v18, s[28:31], s54 offen lds
MAV 48,16,108
TR 34,6,512
TR 36,6,32
MAV 48,0,100
TR 38,6,544
s_add_u32 s52, s79, 360448
MAV 52,4,100
buffer_load_dwordx4 v[144:147], v4, s[16:19], s52 offen sc1
MAV 52,20,108
TR 48,6,8448
MAV 36,20,104
TR 50,6,8960
TR 52,6,8480
MAV 36,4,96
TR 54,6,8992
s_waitcnt lgkmcnt(8)
MAV 40,8,96
buffer_load_dwordx4 v19, s[28:31], s54 offen offset:1056 lds
MAV 40,24,104
s_add_u32 s54, s101, 3538944
MAV 56,24,108
TR 40,6,64
TR 42,6,576
MAV 56,8,100
TR 44,6,96
TR 46,6,608
MAV 60,12,100
buffer_load_dwordx4 v[148:151], v4, s[16:19], s52 offen offset:1024 sc1
MAV 60,28,108
TR 56,6,8512
MAV 44,28,104
TR 58,6,9024
TR 60,6,8544
MAV 44,12,96
TR 62,6,9056
s_waitcnt lgkmcnt(8)
MAV 64,32,96
TR 0,7,16896
s_add_u32 m0, s55, 126720
MAV 64,48,104
buffer_load_dwordx4 v18, s[28:31], s54 offen lds
MAV 80,48,108
TR 2,7,17408
TR 4,7,16928
MAV 80,32,100
TR 6,7,17440
s_add_u32 s52, s79, 425984
MAV 84,36,100
buffer_load_dwordx4 v[152:155], v4, s[16:19], s52 offen sc1
MAV 84,52,108
TR 16,7,25344
MAV 68,52,104
TR 18,7,25856
TR 20,7,25376
MAV 68,36,96
TR 22,7,25888
s_waitcnt lgkmcnt(8)
MAV 72,40,96
buffer_load_dwordx4 v19, s[28:31], s54 offen offset:1056 lds
MAV 72,56,104
s_add_u32 s54, s98, 131072
MAV 88,56,108
TR 8,7,16960
TR 10,7,17472
MAV 88,40,100
TR 12,7,16992
TR 14,7,17504
MAV 92,44,100
buffer_load_dwordx4 v[156:159], v4, s[16:19], s52 offen offset:1024 sc1
MAV 92,60,108
TR 24,7,25408
MAV 76,60,104
TR 26,7,25920
TR 28,7,25440
MAV 76,44,96
TR 30,7,25952
s_waitcnt vmcnt(16) lgkmcnt(8)
s_barrier
MAV 32,0,112
TR 32,6,16896
s_add_u32 m0, s55, 0
MAV 32,16,120
buffer_load_dwordx4 v18, s[28:31], s54 offen lds
MAV 48,16,124
TR 34,6,17408
TR 36,6,16928
MAV 48,0,116
TR 38,6,17440
s_add_u32 s52, s76, 475136
MAV 52,4,116
buffer_load_dwordx4 v[96:99], v4, s[16:19], s52 offen sc1
MAV 52,20,124
TR 48,6,25344
MAV 36,20,120
TR 50,6,25856
TR 52,6,25376
MAV 36,4,112
TR 54,6,25888
s_waitcnt lgkmcnt(8)
MAV 40,8,112
buffer_load_dwordx4 v19, s[28:31], s54 offen offset:1056 lds
MAV 40,24,120
s_add_u32 s54, s98, 393216
MAV 56,24,124
TR 40,6,16960
TR 42,6,17472
MAV 56,8,116
TR 44,6,16992
TR 46,6,17504
MAV 60,12,116
buffer_load_dwordx4 v[100:103], v4, s[16:19], s52 offen offset:1024 sc1
MAV 60,28,124
TR 56,6,25408
MAV 44,28,120
TR 58,6,25920
TR 60,6,25440
MAV 44,12,112
TR 62,6,25952
s_waitcnt lgkmcnt(8)
MAV 64,32,112
TR 0,7,33792
s_add_u32 m0, s55, 8448
MAV 64,48,120
buffer_load_dwordx4 v18, s[28:31], s54 offen lds
MAV 80,48,124
TR 2,7,34304
TR 4,7,33824
MAV 80,32,116
TR 6,7,34336
s_add_u32 s52, s76, 540672
MAV 84,36,116
buffer_load_dwordx4 v[104:107], v4, s[16:19], s52 offen sc1
MAV 84,52,124
TR 16,7,42240
MAV 68,52,120
TR 18,7,42752
TR 20,7,42272
MAV 68,36,112
TR 22,7,42784
s_waitcnt lgkmcnt(8)
MAV 72,40,112
buffer_load_dwordx4 v19, s[28:31], s54 offen offset:1056 lds
MAV 72,56,120
s_add_u32 s54, s99, 589824
MAV 88,56,124
TR 8,7,33856
TR 10,7,34368
MAV 88,40,116
TR 12,7,33888
TR 14,7,34400
MAV 92,44,116
buffer_load_dwordx4 v[108:111], v4, s[16:19], s52 offen offset:1024 sc1
MAV 92,60,124
TR 24,7,42304
MAV 76,60,120
TR 26,7,42816
TR 28,7,42336
MAV 76,44,112
TR 30,7,42848
s_waitcnt vmcnt(16) lgkmcnt(8)
s_barrier
MAV 32,0,128
TR 32,6,33792
s_add_u32 m0, s55, 16896
MAV 32,16,136
buffer_load_dwordx4 v18, s[28:31], s54 offen lds
MAV 48,16,140
TR 34,6,34304
TR 36,6,33824
MAV 48,0,132
TR 38,6,34336
s_add_u32 s52, s77, 589824
MAV 52,4,132
buffer_load_dwordx4 v[112:115], v4, s[16:19], s52 offen sc1
MAV 52,20,140
TR 48,6,42240
MAV 36,20,136
TR 50,6,42752
TR 52,6,42272
MAV 36,4,128
TR 54,6,42784
s_waitcnt lgkmcnt(8)
MAV 40,8,128
buffer_load_dwordx4 v19, s[28:31], s54 offen offset:1056 lds
MAV 40,24,136
s_add_u32 s54, s99, 851968
MAV 56,24,140
TR 40,6,33856
TR 42,6,34368
MAV 56,8,132
TR 44,6,33888
TR 46,6,34400
MAV 60,12,132
buffer_load_dwordx4 v[116:119], v4, s[16:19], s52 offen offset:1024 sc1
MAV 60,28,140
TR 56,6,42304
MAV 44,28,136
TR 58,6,42816
TR 60,6,42336
MAV 44,12,128
TR 62,6,42848
s_waitcnt lgkmcnt(8)
MAV 64,32,128
TR 0,7,50688
s_add_u32 m0, s55, 25344
MAV 64,48,136
buffer_load_dwordx4 v18, s[28:31], s54 offen lds
MAV 80,48,140
TR 2,7,51200
TR 4,7,50720
MAV 80,32,132
TR 6,7,51232
s_add_u32 s52, s77, 655360
MAV 84,36,132
buffer_load_dwordx4 v[120:123], v4, s[16:19], s52 offen sc1
MAV 84,52,140
TR 16,7,59136
MAV 68,52,136
TR 18,7,59648
TR 20,7,59168
MAV 68,36,128
TR 22,7,59680
s_waitcnt lgkmcnt(8)
MAV 72,40,128
buffer_load_dwordx4 v19, s[28:31], s54 offen offset:1056 lds
MAV 72,56,136
s_add_u32 s54, s100, 1048576
MAV 88,56,140
TR 8,7,50752
TR 10,7,51264
MAV 88,40,132
TR 12,7,50784
TR 14,7,51296
MAV 92,44,132
buffer_load_dwordx4 v[124:127], v4, s[16:19], s52 offen offset:1024 sc1
MAV 92,60,140
TR 24,7,59200
MAV 76,60,136
TR 26,7,59712
TR 28,7,59232
MAV 76,44,128
TR 30,7,59744
s_waitcnt vmcnt(16) lgkmcnt(8)
s_barrier
MAV 32,0,144
TR 32,6,50688
s_add_u32 m0, s55, 33792
MAV 32,16,152
buffer_load_dwordx4 v18, s[28:31], s54 offen lds
MAV 48,16,156
TR 34,6,51200
TR 36,6,50720
MAV 48,0,148
TR 38,6,51232
s_add_u32 s52, s78, 704512
MAV 52,4,148
buffer_load_dwordx4 v[128:131], v4, s[16:19], s52 offen sc1
MAV 52,20,156
TR 48,6,59136
MAV 36,20,152
TR 50,6,59648
TR 52,6,59168
MAV 36,4,144
TR 54,6,59680
s_waitcnt lgkmcnt(8)
MAV 40,8,144
buffer_load_dwordx4 v19, s[28:31], s54 offen offset:1056 lds
MAV 40,24,152
s_add_u32 s54, s100, 1310720
MAV 56,24,156
TR 40,6,50752
TR 42,6,51264
MAV 56,8,148
TR 44,6,50784
TR 46,6,51296
MAV 60,12,148
buffer_load_dwordx4 v[132:135], v4, s[16:19], s52 offen offset:1024 sc1
MAV 60,28,156
TR 56,6,59200
MAV 44,28,152
TR 58,6,59712
TR 60,6,59232
MAV 44,12,144
TR 62,6,59744
v_add_u32 v7, s57, v7
v_add_u32 v6, s57, v6
s_sub_u32 s57, 0, s57
s_waitcnt lgkmcnt(8)
MAV 64,32,144
ds_read_b64_tr_b16 a[0:1], v7
s_add_u32 m0, s55, 42240
MAV 64,48,152
buffer_load_dwordx4 v18, s[28:31], s54 offen lds
MAV 80,48,156
TR 2,7,512
TR 4,7,32
MAV 80,32,148
TR 6,7,544
s_add_u32 s52, s78, 770048
MAV 84,36,148
buffer_load_dwordx4 v[136:139], v4, s[16:19], s52 offen sc1
MAV 84,52,156
TR 16,7,8448
MAV 68,52,152
TR 18,7,8960
TR 20,7,8480
MAV 68,36,144
TR 22,7,8992
s_waitcnt lgkmcnt(8)
MAV 72,40,144
buffer_load_dwordx4 v19, s[28:31], s54 offen offset:1056 lds
MAV 72,56,152
s_add_u32 s54, s101, 1507328
MAV 88,56,156
TR 8,7,64
TR 10,7,576
MAV 88,40,148
TR 12,7,96
TR 14,7,608
MAV 92,44,148
buffer_load_dwordx4 v[140:143], v4, s[16:19], s52 offen offset:1024 sc1
MAV 92,60,156
TR 24,7,8512
MAV 76,60,152
TR 26,7,9024
TR 28,7,8544
MAV 76,44,144
TR 30,7,9056
s_waitcnt vmcnt(16) lgkmcnt(8)
s_barrier
MAV 32,0,96
ds_read_b64_tr_b16 a[32:33], v6
s_add_u32 m0, s55, 50688
MAV 32,16,104
buffer_load_dwordx4 v18, s[28:31], s54 offen lds
MAV 48,16,108
TR 34,6,512
TR 36,6,32
MAV 48,0,100
TR 38,6,544
s_add_u32 s52, s79, 819200
MAV 52,4,100
buffer_load_dwordx4 v[144:147], v4, s[16:19], s52 offen sc1
MAV 52,20,108
TR 48,6,8448
MAV 36,20,104
TR 50,6,8960
TR 52,6,8480
MAV 36,4,96
TR 54,6,8992
s_waitcnt lgkmcnt(8)
MAV 40,8,96
buffer_load_dwordx4 v19, s[28:31], s54 offen offset:1056 lds
MAV 40,24,104
s_add_u32 s54, s101, 1769472
MAV 56,24,108
TR 40,6,64
TR 42,6,576
MAV 56,8,100
TR 44,6,96
TR 46,6,608
MAV 60,12,100
buffer_load_dwordx4 v[148:151], v4, s[16:19], s52 offen offset:1024 sc1
MAV 60,28,108
TR 56,6,8512
MAV 44,28,104
TR 58,6,9024
TR 60,6,8544
MAV 44,12,96
TR 62,6,9056
s_waitcnt lgkmcnt(8)
MAV 64,32,96
TR 0,7,16896
s_add_u32 m0, s55, 59136
MAV 64,48,104
buffer_load_dwordx4 v18, s[28:31], s54 offen lds
MAV 80,48,108
TR 2,7,17408
TR 4,7,16928
MAV 80,32,100
TR 6,7,17440
s_add_u32 s52, s79, 884736
MAV 84,36,100
buffer_load_dwordx4 v[152:155], v4, s[16:19], s52 offen sc1
MAV 84,52,108
TR 16,7,25344
MAV 68,52,104
TR 18,7,25856
TR 20,7,25376
MAV 68,36,96
TR 22,7,25888
s_waitcnt lgkmcnt(8)
MAV 72,40,96
buffer_load_dwordx4 v19, s[28:31], s54 offen offset:1056 lds
MAV 72,56,104
s_add_u32 s54, s98, 1966080
MAV 88,56,108
TR 8,7,16960
TR 10,7,17472
MAV 88,40,100
TR 12,7,16992
TR 14,7,17504
MAV 92,44,100
buffer_load_dwordx4 v[156:159], v4, s[16:19], s52 offen offset:1024 sc1
MAV 92,60,108
TR 24,7,25408
MAV 76,60,104
TR 26,7,25920
TR 28,7,25440
MAV 76,44,96
TR 30,7,25952
s_waitcnt vmcnt(16) lgkmcnt(8)
s_barrier
MAV 32,0,112
TR 32,6,16896
s_add_u32 m0, s55, 67584
MAV 32,16,120
buffer_load_dwordx4 v18, s[28:31], s54 offen lds
MAV 48,16,124
TR 34,6,17408
TR 36,6,16928
MAV 48,0,116
TR 38,6,17440
s_add_u32 s52, s76, 32768
MAV 52,4,116
buffer_load_dwordx4 v[96:99], v4, s[16:19], s52 offen sc1
MAV 52,20,124
TR 48,6,25344
MAV 36,20,120
TR 50,6,25856
TR 52,6,25376
MAV 36,4,112
TR 54,6,25888
s_waitcnt lgkmcnt(8)
MAV 40,8,112
buffer_load_dwordx4 v19, s[28:31], s54 offen offset:1056 lds
MAV 40,24,120
s_add_u32 s54, s98, 2228224
MAV 56,24,124
TR 40,6,16960
TR 42,6,17472
MAV 56,8,116
TR 44,6,16992
TR 46,6,17504
MAV 60,12,116
buffer_load_dwordx4 v[100:103], v4, s[16:19], s52 offen offset:1024 sc1
MAV 60,28,124
TR 56,6,25408
MAV 44,28,120
TR 58,6,25920
TR 60,6,25440
MAV 44,12,112
TR 62,6,25952
s_waitcnt lgkmcnt(8)
MAV 64,32,112
TR 0,7,33792
s_add_u32 m0, s55, 76032
MAV 64,48,120
buffer_load_dwordx4 v18, s[28:31], s54 offen lds
MAV 80,48,124
TR 2,7,34304
TR 4,7,33824
MAV 80,32,116
TR 6,7,34336
s_add_u32 s52, s76, 98304
MAV 84,36,116
buffer_load_dwordx4 v[104:107], v4, s[16:19], s52 offen sc1
MAV 84,52,124
TR 16,7,42240
MAV 68,52,120
TR 18,7,42752
TR 20,7,42272
MAV 68,36,112
TR 22,7,42784
s_waitcnt lgkmcnt(8)
MAV 72,40,112
buffer_load_dwordx4 v19, s[28:31], s54 offen offset:1056 lds
MAV 72,56,120
s_add_u32 s54, s99, 2424832
MAV 88,56,124
TR 8,7,33856
TR 10,7,34368
MAV 88,40,116
TR 12,7,33888
TR 14,7,34400
MAV 92,44,116
buffer_load_dwordx4 v[108:111], v4, s[16:19], s52 offen offset:1024 sc1
MAV 92,60,124
TR 24,7,42304
MAV 76,60,120
TR 26,7,42816
TR 28,7,42336
MAV 76,44,112
TR 30,7,42848
s_waitcnt vmcnt(16) lgkmcnt(8)
s_barrier
MAV 32,0,128
TR 32,6,33792
s_add_u32 m0, s55, 84480
MAV 32,16,136
buffer_load_dwordx4 v18, s[28:31], s54 offen lds
MAV 48,16,140
TR 34,6,34304
TR 36,6,33824
MAV 48,0,132
TR 38,6,34336
s_add_u32 s52, s77, 147456
MAV 52,4,132
buffer_load_dwordx4 v[112:115], v4, s[16:19], s52 offen sc1
MAV 52,20,140
TR 48,6,42240
MAV 36,20,136
TR 50,6,42752
TR 52,6,42272
MAV 36,4,128
TR 54,6,42784
s_waitcnt lgkmcnt(8)
MAV 40,8,128
buffer_load_dwordx4 v19, s[28:31], s54 offen offset:1056 lds
MAV 40,24,136
s_add_u32 s54, s99, 2686976
MAV 56,24,140
TR 40,6,33856
TR 42,6,34368
.Lpad9:
s_cbranch_execz .Lnopoll37r
MAV 56,8,132
TR 44,6,33888
TR 46,6,34400
MAV 60,12,132
buffer_load_dwordx4 v[116:119], v4, s[16:19], s52 offen offset:1024 sc1
MAV 60,28,140
TR 56,6,42304
MAV 44,28,136
TR 58,6,42816
TR 60,6,42336
MAV 44,12,128
TR 62,6,42848
s_waitcnt lgkmcnt(8)
MAV 64,32,128
TR 0,7,50688
s_add_u32 m0, s55, 92928
MAV 64,48,136
buffer_load_dwordx4 v18, s[28:31], s54 offen lds
MAV 80,48,140
TR 2,7,51200
TR 4,7,50720
MAV 80,32,132
TR 6,7,51232
s_add_u32 s52, s77, 212992
MAV 84,36,132
buffer_load_dwordx4 v[120:123], v4, s[16:19], s52 offen sc1
MAV 84,52,140
TR 16,7,59136
MAV 68,52,136
TR 18,7,59648
TR 20,7,59168
MAV 68,36,128
TR 22,7,59680
s_waitcnt lgkmcnt(8)
MAV 72,40,128
buffer_load_dwordx4 v19, s[28:31], s54 offen offset:1056 lds
MAV 72,56,136
s_add_u32 s54, s100, 2883584
MAV 88,56,140
TR 8,7,50752
TR 10,7,51264
MAV 88,40,132
TR 12,7,50784
TR 14,7,51296
MAV 92,44,132
buffer_load_dwordx4 v[124:127], v4, s[16:19], s52 offen offset:1024 sc1
MAV 92,60,140
TR 24,7,59200
MAV 76,60,136
TR 26,7,59712
TR 28,7,59232
MAV 76,44,128
TR 30,7,59744
s_waitcnt vmcnt(16) lgkmcnt(8)
s_barrier
MAV 32,0,144
TR 32,6,50688
s_add_u32 m0, s55, 101376
MAV 32,16,152
buffer_load_dwordx4 v18, s[28:31], s54 offen lds
MAV 48,16,156
TR 34,6,51200
TR 36,6,50720
MAV 48,0,148
TR 38,6,51232
s_add_u32 s52, s78, 262144
MAV 52,4,148
buffer_load_dwordx4 v[128:131], v4, s[16:19], s52 offen sc1
MAV 52,20,156
TR 48,6,59136
MAV 36,20,152
TR 50,6,59648
TR 52,6,59168
MAV 36,4,144
TR 54,6,59680
s_waitcnt lgkmcnt(8)
MAV 40,8,144
buffer_load_dwordx4 v19, s[28:31], s54 offen offset:1056 lds
MAV 40,24,152
s_add_u32 s54, s100, 3145728
MAV 56,24,156
TR 40,6,50752
TR 42,6,51264
MAV 56,8,148
TR 44,6,50784
TR 46,6,51296
MAV 60,12,148
buffer_load_dwordx4 v[132:135], v4, s[16:19], s52 offen offset:1024 sc1
MAV 60,28,156
TR 56,6,59200
MAV 44,28,152
TR 58,6,59712
TR 60,6,59232
MAV 44,12,144
TR 62,6,59744
v_add_u32 v7, s57, v7
v_add_u32 v6, s57, v6
s_sub_u32 s57, 0, s57
s_waitcnt lgkmcnt(8)
MAV 64,32,144
ds_read_b64_tr_b16 a[0:1], v7
s_add_u32 m0, s55, 109824
MAV 64,48,152
buffer_load_dwordx4 v18, s[28:31], s54 offen lds
MAV 80,48,156
TR 2,7,512
TR 4,7,32
MAV 80,32,148
TR 6,7,544
s_add_u32 s52, s78, 327680
MAV 84,36,148
buffer_load_dwordx4 v[136:139], v4, s[16:19], s52 offen sc1
MAV 84,52,156
TR 16,7,8448
MAV 68,52,152
TR 18,7,8960
TR 20,7,8480
MAV 68,36,144
TR 22,7,8992
s_waitcnt lgkmcnt(8)
MAV 72,40,144
buffer_load_dwordx4 v19, s[28:31], s54 offen offset:1056 lds
MAV 72,56,152
s_add_u32 s54, s101, 3342336
MAV 88,56,156
TR 8,7,64
TR 10,7,576
MAV 88,40,148
TR 12,7,96
TR 14,7,608
MAV 92,44,148
buffer_load_dwordx4 v[140:143], v4, s[16:19], s52 offen offset:1024 sc1
MAV 92,60,156
TR 24,7,8512
MAV 76,60,152
TR 26,7,9024
TR 28,7,8544
MAV 76,44,144
TR 30,7,9056
s_waitcnt vmcnt(16) lgkmcnt(8)
s_barrier
MAV 32,0,96
ds_read_b64_tr_b16 a[32:33], v6
s_add_u32 m0, s55, 118272
MAV 32,16,104
buffer_load_dwordx4 v18, s[28:31], s54 offen lds
MAV 48,16,108
TR 34,6,512
TR 36,6,32
MAV 48,0,100
TR 38,6,544
s_add_u32 s52, s79, 376832
MAV 52,4,100
buffer_load_dwordx4 v[144:147], v4, s[16:19], s52 offen sc1
MAV 52,20,108
TR 48,6,8448
MAV 36,20,104
TR 50,6,8960
TR 52,6,8480
MAV 36,4,96
TR 54,6,8992
s_waitcnt lgkmcnt(8)
MAV 40,8,96
buffer_load_dwordx4 v19, s[28:31], s54 offen offset:1056 lds
MAV 40,24,104
s_add_u32 s54, s101, 3604480
MAV 56,24,108
TR 40,6,64
TR 42,6,576
MAV 56,8,100
TR 44,6,96
TR 46,6,608
MAV 60,12,100
buffer_load_dwordx4 v[148:151], v4, s[16:19], s52 offen offset:1024 sc1
MAV 60,28,108
TR 56,6,8512
MAV 44,28,104
TR 58,6,9024
TR 60,6,8544
MAV 44,12,96
TR 62,6,9056
s_waitcnt lgkmcnt(8)
MAV 64,32,96
TR 0,7,16896
s_add_u32 m0, s55, 126720
MAV 64,48,104
buffer_load_dwordx4 v18, s[28:31], s54 offen lds
MAV 80,48,108
TR 2,7,17408
TR 4,7,16928
MAV 80,32,100
TR 6,7,17440
s_add_u32 s52, s79, 442368
MAV 84,36,100
buffer_load_dwordx4 v[152:155], v4, s[16:19], s52 offen sc1
MAV 84,52,108
TR 16,7,25344
MAV 68,52,104
TR 18,7,25856
TR 20,7,25376
MAV 68,36,96
TR 22,7,25888
s_waitcnt lgkmcnt(8)
MAV 72,40,96
buffer_load_dwordx4 v19, s[28:31], s54 offen offset:1056 lds
MAV 72,56,104
s_add_u32 s54, s98, 196608
MAV 88,56,108
TR 8,7,16960
TR 10,7,17472
MAV 88,40,100
TR 12,7,16992
TR 14,7,17504
MAV 92,44,100
buffer_load_dwordx4 v[156:159], v4, s[16:19], s52 offen offset:1024 sc1
MAV 92,60,108
TR 24,7,25408
MAV 76,60,104
TR 26,7,25920
TR 28,7,25440
MAV 76,44,96
TR 30,7,25952
s_waitcnt vmcnt(16) lgkmcnt(8)
s_barrier
MAV 32,0,112
TR 32,6,16896
s_add_u32 m0, s55, 0
MAV 32,16,120
buffer_load_dwordx4 v18, s[28:31], s54 offen lds
MAV 48,16,124
TR 34,6,17408
TR 36,6,16928
MAV 48,0,116
TR 38,6,17440
s_add_u32 s52, s76, 491520
MAV 52,4,116
buffer_load_dwordx4 v[96:99], v4, s[16:19], s52 offen sc1
MAV 52,20,124
TR 48,6,25344
MAV 36,20,120
TR 50,6,25856
TR 52,6,25376
MAV 36,4,112
TR 54,6,25888
s_waitcnt lgkmcnt(8)
MAV 40,8,112
buffer_load_dwordx4 v19, s[28:31], s54 offen offset:1056 lds
MAV 40,24,120
s_add_u32 s54, s99, 655360
MAV 56,24,124
TR 40,6,16960
TR 42,6,17472
MAV 56,8,116
TR 44,6,16992
TR 46,6,17504
MAV 60,12,116
buffer_load_dwordx4 v[100:103], v4, s[16:19], s52 offen offset:1024 sc1
MAV 60,28,124
TR 56,6,25408
MAV 44,28,120
TR 58,6,25920
TR 60,6,25440
MAV 44,12,112
TR 62,6,25952
s_waitcnt lgkmcnt(8)
MAV 64,32,112
TR 0,7,33792
s_add_u32 m0, s55, 8448
MAV 64,48,120
buffer_load_dwordx4 v18, s[28:31], s54 offen lds
MAV 80,48,124
TR 2,7,34304
TR 4,7,33824
MAV 80,32,116
TR 6,7,34336
s_add_u32 s52, s76, 557056
MAV 84,36,116
buffer_load_dwordx4 v[104:107], v4, s[16:19], s52 offen sc1
MAV 84,52,124
TR 16,7,42240
MAV 68,52,120
TR 18,7,42752
TR 20,7,42272
MAV 68,36,112
TR 22,7,42784
s_waitcnt lgkmcnt(8)
MAV 72,40,112
buffer_load_dwordx4 v19, s[28:31], s54 offen offset:1056 lds
MAV 72,56,120
s_add_u32 s54, s100, 1114112
MAV 88,56,124
TR 8,7,33856
TR 10,7,34368
MAV 88,40,116
TR 12,7,33888
TR 14,7,34400
MAV 92,44,116
buffer_load_dwordx4 v[108:111], v4, s[16:19], s52 offen offset:1024 sc1
MAV 92,60,124
TR 24,7,42304
MAV 76,60,120
TR 26,7,42816
TR 28,7,42336
MAV 76,44,112
TR 30,7,42848
s_waitcnt vmcnt(16) lgkmcnt(8)
s_barrier
MAV 32,0,128
TR 32,6,33792
s_add_u32 m0, s55, 16896
MAV 32,16,136
buffer_load_dwordx4 v18, s[28:31], s54 offen lds
MAV 48,16,140
TR 34,6,34304
TR 36,6,33824
MAV 48,0,132
TR 38,6,34336
s_add_u32 s52, s77, 606208
MAV 52,4,132
buffer_load_dwordx4 v[112:115], v4, s[16:19], s52 offen sc1
MAV 52,20,140
TR 48,6,42240
MAV 36,20,136
TR 50,6,42752
TR 52,6,42272
MAV 36,4,128
TR 54,6,42784
s_waitcnt lgkmcnt(8)
MAV 40,8,128
buffer_load_dwordx4 v19, s[28:31], s54 offen offset:1056 lds
MAV 40,24,136
s_add_u32 s54, s101, 1572864
MAV 56,24,140
TR 40,6,33856
TR 42,6,34368
MAV 56,8,132
TR 44,6,33888
TR 46,6,34400
MAV 60,12,132
buffer_load_dwordx4 v[116:119], v4, s[16:19], s52 offen offset:1024 sc1
MAV 60,28,140
TR 56,6,42304
MAV 44,28,136
TR 58,6,42816
TR 60,6,42336
MAV 44,12,128
TR 62,6,42848
s_waitcnt lgkmcnt(8)
MAV 64,32,128
TR 0,7,50688
s_add_u32 m0, s55, 25344
MAV 64,48,136
buffer_load_dwordx4 v18, s[28:31], s54 offen lds
MAV 80,48,140
TR 2,7,51200
TR 4,7,50720
MAV 80,32,132
TR 6,7,51232
s_add_u32 s52, s77, 671744
MAV 84,36,132
buffer_load_dwordx4 v[120:123], v4, s[16:19], s52 offen sc1
MAV 84,52,140
TR 16,7,59136
MAV 68,52,136
TR 18,7,59648
TR 20,7,59168
MAV 68,36,128
TR 22,7,59680
s_waitcnt lgkmcnt(8)
MAV 72,40,128
buffer_load_dwordx4 v19, s[28:31], s54 offen offset:1056 lds
MAV 72,56,136
s_add_u32 s54, s98, 2031616
MAV 88,56,140
TR 8,7,50752
TR 10,7,51264
MAV 88,40,132
TR 12,7,50784
TR 14,7,51296
MAV 92,44,132
buffer_load_dwordx4 v[124:127], v4, s[16:19], s52 offen offset:1024 sc1
MAV 92,60,140
TR 24,7,59200
MAV 76,60,136
TR 26,7,59712
TR 28,7,59232
MAV 76,44,128
TR 30,7,59744
s_waitcnt vmcnt(16) lgkmcnt(8)
s_barrier
MAV 32,0,144
TR 32,6,50688
s_add_u32 m0, s55, 33792
MAV 32,16,152
buffer_load_dwordx4 v18, s[28:31], s54 offen lds
MAV 48,16,156
TR 34,6,51200
TR 36,6,50720
MAV 48,0,148
TR 38,6,51232
s_add_u32 s52, s78, 720896
MAV 52,4,148
buffer_load_dwordx4 v[128:131], v4, s[16:19], s52 offen sc1
MAV 52,20,156
TR 48,6,59136
MAV 36,20,152
TR 50,6,59648
TR 52,6,59168
MAV 36,4,144
TR 54,6,59680
s_waitcnt lgkmcnt(8)
MAV 40,8,144
buffer_load_dwordx4 v19, s[28:31], s54 offen offset:1056 lds
MAV 40,24,152
s_add_u32 s54, s99, 2490368
MAV 56,24,156
TR 40,6,50752
TR 42,6,51264
MAV 56,8,148
TR 44,6,50784
TR 46,6,51296
MAV 60,12,148
buffer_load_dwordx4 v[132:135], v4, s[16:19], s52 offen offset:1024 sc1
MAV 60,28,156
TR 56,6,59200
MAV 44,28,152
TR 58,6,59712
TR 60,6,59232
MAV 44,12,144
TR 62,6,59744
v_add_u32 v7, s57, v7
v_add_u32 v6, s57, v6
s_sub_u32 s57, 0, s57
s_waitcnt lgkmcnt(8)
MAV 64,32,144
ds_read_b64_tr_b16 a[0:1], v6
s_add_u32 m0, s55, 42240
MAV 64,48,152
buffer_load_dwordx4 v18, s[28:31], s54 offen lds
MAV 80,48,156
TR 2,6,512
TR 4,6,32
MAV 80,32,148
TR 6,6,544
s_add_u32 s52, s78, 786432
MAV 84,36,148
buffer_load_dwordx4 v[136:139], v4, s[16:19], s52 offen sc1
MAV 84,52,156
TR 16,6,8448
MAV 68,52,152
TR 18,6,8960
TR 20,6,8480
MAV 68,36,144
TR 22,6,8992
s_waitcnt lgkmcnt(8)
MAV 72,40,144
buffer_load_dwordx4 v19, s[28:31], s54 offen offset:1056 lds
MAV 72,56,152
s_add_u32 s54, s100, 2949120
MAV 88,56,156
TR 8,6,64
TR 10,6,576
MAV 88,40,148
TR 12,6,96
TR 14,6,608
MAV 92,44,148
buffer_load_dwordx4 v[140:143], v4, s[16:19], s52 offen offset:1024 sc1
MAV 92,60,156
TR 24,6,8512
MAV 76,60,152
TR 26,6,9024
TR 28,6,8544
MAV 76,44,144
TR 30,6,9056
s_waitcnt vmcnt(16) lgkmcnt(8)
s_barrier
MAV 64,0,96
TR 32,6,16896
TR 34,6,17408
s_add_u32 m0, s55, 50688
MAV 64,16,104
TR 36,6,16928
buffer_load_dwordx4 v18, s[28:31], s54 offen lds
MAV 80,16,108
buffer_load_dwordx4 v19, s[28:31], s54 offen offset:1056 lds
MAV 80,0,100
TR 38,6,17440
s_add_u32 s54, s101, 3407872
s_add_u32 s52, s79, 835584
MAV 84,4,100
TR 48,6,25344
buffer_load_dwordx4 v[144:147], v4, s[16:19], s52 offen sc1
MAV 84,20,108
TR 50,6,25856
MAV 68,20,104
TR 52,6,25376
buffer_load_dwordx4 v[148:151], v4, s[16:19], s52 offen offset:1024 sc1
MAV 68,4,96
TR 54,6,25888
s_add_u32 m0, s55, 59136
s_waitcnt lgkmcnt(8)
MAV 72,8,96
buffer_load_dwordx4 v18, s[28:31], s54 offen lds
MAV 72,24,104
TR 40,6,16960
TR 42,6,17472
MAV 88,24,108
TR 44,6,16992
buffer_load_dwordx4 v19, s[28:31], s54 offen offset:1056 lds
MAV 88,8,100
TR 46,6,17504
s_add_u32 s52, s79, 901120
MAV 92,12,100
TR 56,6,25408
buffer_load_dwordx4 v[152:155], v4, s[16:19], s52 offen sc1
MAV 92,28,108
TR 58,6,25920
MAV 76,28,104
TR 60,6,25440
buffer_load_dwordx4 v[156:159], v4, s[16:19], s52 offen offset:1024 sc1
MAV 76,12,96
TR 62,6,25952
s_waitcnt vmcnt(16) lgkmcnt(8)
MAV 64,32,112
TR 0,6,33792
s_add_u32 s52, s76, 49152
s_lshl_b32 s70, s2, 10
MAV 64,48,120
buffer_load_dwordx4 v[160:163], v4, s[16:19], s52 offen sc1
s_lshl_b32 s62, s3, 7
MAV 80,48,124
.Lpad10:
s_cbranch_execz .Lnopoll37r
TR 2,6,34304
TR 4,6,33824
MAV 80,32,116
TR 6,6,34336
s_add_u32 s70, s70, s62
s_add_u32 s70, s70, 31457280
MAV 84,36,116
buffer_load_dwordx4 v[164:167], v4, s[16:19], s52 offen offset:1024 sc1
s_xor_b32 s71, s70, 1024
MAV 84,52,124
TR 16,6,42240
TR 18,6,42752
MAV 68,52,120
TR 20,6,42272
v_min_u32 v12, 1, v1
v_lshlrev_b32 v12, 28, v12
MAV 68,36,112
TR 22,6,42784
s_add_u32 s52, s77, 163840
s_waitcnt lgkmcnt(8)
MAV 72,40,112
buffer_load_dwordx4 v[168:171], v4, s[16:19], s52 offen sc1
v_mov_b32 v13, 1
MAV 72,56,120
TR 8,6,33856
v_mov_b32 v15, 0
s_lshl_b32 s68, s7, 18
MAV 88,56,124
TR 10,6,34368
TR 12,6,33888
MAV 88,40,116
TR 14,6,34400
s_add_u32 s68, s68, 33554432
s_xor_b32 s69, s68, 262144
MAV 92,44,116
buffer_load_dwordx4 v[172:175], v4, s[16:19], s52 offen offset:1024 sc1
v_mov_b32 v11, v4
MAV 92,60,124
TR 24,6,42304
TR 26,6,42816
MAV 76,60,120
TR 28,6,42336
v_and_b32 v2, 1, v1
v_lshlrev_b32 v2, 4, v2
MAV 76,44,112
TR 30,6,42848
v_mov_b32 v224, 0x3f80
s_waitcnt vmcnt(12) lgkmcnt(8)
MAV 64,0,128
TR 32,6,50688
s_add_u32 s52, s78, 278528
v_lshlrev_b32 v2, v2, v224
MAV 64,16,136
buffer_load_dwordx4 v[176:179], v4, s[16:19], s52 offen sc1
v_bfe_u32 v224, v1, 2, 2
MAV 80,16,140
TR 34,6,51200
TR 36,6,50720
MAV 80,0,132
TR 38,6,51232
v_lshrrev_b32 v225, 4, v1
v_cmp_eq_u32 vcc, v224, v225
MAV 84,4,132
buffer_load_dwordx4 v[180:183], v4, s[16:19], s52 offen offset:1024 sc1
v_cndmask_b32 v2, 0, v2, vcc
MAV 84,20,140
TR 48,6,59136
TR 50,6,59648
MAV 68,20,136
TR 52,6,59168
v_and_b32 v224, 2, v1
v_cmp_eq_u32 vcc, 0, v224
MAV 68,4,128
TR 54,6,59680
s_add_u32 s52, s79, 393216
s_waitcnt lgkmcnt(8)
MAV 72,8,128
buffer_load_dwordx4 v[184:187], v4, s[16:19], s52 offen sc1
v_cndmask_b32 v226, 0, v2, vcc
MAV 72,24,136
TR 40,6,50752
v_cndmask_b32 v227, v2, 0, vcc
v_mov_b32 v224, 0
MAV 88,24,140
TR 42,6,51264
TR 44,6,50784
MAV 88,8,132
TR 46,6,51296
v_mov_b32 v225, 0
v_mov_b32 v228, 0
MAV 92,12,132
buffer_load_dwordx4 v[188:191], v4, s[16:19], s52 offen offset:1024 sc1
v_mov_b32 v229, 0
MAV 92,28,140
TR 56,6,59200
TR 58,6,59712
MAV 76,28,136
TR 60,6,59232
v_bfe_u32 v18, v1, 3, 1
v_lshrrev_b32 v2, 4, v1
MAV 76,12,128
TR 62,6,59744
v_lshl_add_u32 v18, v2, 3, v18
s_waitcnt vmcnt(8) lgkmcnt(8)
s_barrier
v_add_u32 v6, s57, v6
MAV 64,32,144
ds_read_b64_tr_b16 a[0:1], v6
s_add_u32 s52, s76, 507904
s_lshl_b32 s62, s3, 1
MAV 64,48,152
buffer_load_dwordx4 v[192:195], v4, s[16:19], s52 offen sc1
v_add_u32 v18, s62, v18
MAV 80,48,156
TR 2,6,512
TR 4,6,32
MAV 80,32,148
TR 6,6,544
v_mul_u32_u24 v18, 6144, v18
v_and_b32 v2, 7, v1
MAV 84,36,148
buffer_load_dwordx4 v[196:199], v4, s[16:19], s52 offen offset:1024 sc1
v_lshl_add_u32 v18, v2, 4, v18
MAV 84,52,156
TR 16,6,8448
TR 18,6,8960
MAV 68,52,152
TR 20,6,8480
s_lshl_b32 s62, s9, 7
v_add_u32 v18, s62, v18
MAV 68,36,144
TR 22,6,8992
s_add_u32 s52, s77, 622592
s_waitcnt lgkmcnt(8)
MAV 72,40,144
buffer_load_dwordx4 v[200:203], v4, s[16:19], s52 offen sc1
v_add_u32 v19, 1024, v18
MAV 72,56,152
TR 8,6,64
v_add_u32 v20, 2048, v18
s_mul_i32 s59, s3, 3104
MAV 88,56,156
TR 10,6,576
TR 12,6,96
MAV 88,40,148
TR 14,6,608
s_mov_b32 s58, 0
v_accvgpr_read_b32 v28, a224
MAV 92,44,148
buffer_load_dwordx4 v[204:207], v4, s[16:19], s52 offen offset:1024 sc1
v_add_f32 v32, v32, v28
MAV 92,60,156
TR 24,6,8512
TR 26,6,9024
MAV 76,60,152
TR 28,6,8544
v_accvgpr_read_b32 v29, a225
v_add_f32 v33, v33, v29
MAV 76,44,144
TR 30,6,9056
v_accvgpr_read_b32 v28, a226
s_waitcnt vmcnt(8) lgkmcnt(8)
MAV 64,0,160
TR 32,6,16896
s_add_u32 s52, s78, 737280
v_add_f32 v34, v34, v28
MAV 64,16,168
buffer_load_dwordx4 v[208:211], v4, s[16:19], s52 offen sc1
v_accvgpr_read_b32 v29, a227
MAV 80,16,172
TR 34,6,17408
TR 36,6,16928
MAV 80,0,164
TR 38,6,17440
v_add_f32 v35, v35, v29
v_accvgpr_read_b32 v28, a228
MAV 84,4,164
buffer_load_dwordx4 v[212:215], v4, s[16:19], s52 offen offset:1024 sc1
v_add_f32 v36, v36, v28
MAV 84,20,172
TR 48,6,25344
TR 50,6,25856
MAV 68,20,168
TR 52,6,25376
v_accvgpr_read_b32 v29, a229
v_add_f32 v37, v37, v29
MAV 68,4,160
TR 54,6,25888
s_add_u32 s52, s79, 851968
s_waitcnt lgkmcnt(8)
MAV 72,8,160
buffer_load_dwordx4 v[216:219], v4, s[16:19], s52 offen sc1
v_accvgpr_read_b32 v28, a230
MAV 72,24,168
TR 40,6,16960
v_add_f32 v38, v38, v28
v_accvgpr_read_b32 v29, a231
MAV 88,24,172
TR 42,6,17472
TR 44,6,16992
MAV 88,8,164
TR 46,6,17504
v_add_f32 v39, v39, v29
v_accvgpr_read_b32 v28, a232
MAV 92,12,164
buffer_load_dwordx4 v[220:223], v4, s[16:19], s52 offen offset:1024 sc1
v_add_f32 v40, v40, v28
MAV 92,28,172
TR 56,6,25408
TR 58,6,25920
MAV 76,28,168
TR 60,6,25440
v_accvgpr_read_b32 v29, a233
v_add_f32 v41, v41, v29
MAV 76,12,160
TR 62,6,25952
v_accvgpr_read_b32 v28, a234
s_waitcnt vmcnt(8) lgkmcnt(8)
MAV 64,32,176
TR 0,6,33792
v_add_f32 v42, v42, v28
v_accvgpr_read_b32 v29, a235
MAV 64,48,184
TR 2,6,34304
v_add_f32 v43, v43, v29
MAV 80,48,188
TR 4,6,33824
v_accvgpr_read_b32 v28, a236
MAV 80,32,180
TR 6,6,34336
v_add_f32 v44, v44, v28
MAV 84,36,180
TR 16,6,42240
v_accvgpr_read_b32 v29, a237
MAV 84,52,188
TR 18,6,42752
v_add_f32 v45, v45, v29
MAV 68,52,184
TR 20,6,42272
v_accvgpr_read_b32 v28, a238
MAV 68,36,176
TR 22,6,42784
s_waitcnt lgkmcnt(8)
MAV 72,40,176
TR 8,6,33856
v_add_f32 v46, v46, v28
MAV 72,56,184
TR 10,6,34368
v_accvgpr_read_b32 v29, a239
MAV 88,56,188
TR 12,6,33888
v_add_f32 v47, v47, v29
MAV 88,40,180
TR 14,6,34400
v_accvgpr_read_b32 v28, a240
MAV 92,44,180
TR 24,6,42304
v_add_f32 v48, v48, v28
MAV 92,60,188
TR 26,6,42816
v_accvgpr_read_b32 v29, a241
MAV 76,60,184
TR 28,6,42336
v_add_f32 v49, v49, v29
MAV 76,44,176
TR 30,6,42848
v_accvgpr_read_b32 v28, a242
s_waitcnt vmcnt(4) lgkmcnt(8)
MAV 64,0,192
TR 32,6,50688
v_add_f32 v50, v50, v28
v_accvgpr_read_b32 v29, a243
MAV 64,16,200
TR 34,6,51200
v_add_f32 v51, v51, v29
MAV 80,16,204
TR 36,6,50720
v_accvgpr_read_b32 v28, a244
MAV 80,0,196
TR 38,6,51232
v_add_f32 v52, v52, v28
MAV 84,4,196
TR 48,6,59136
v_accvgpr_read_b32 v29, a245
MAV 84,20,204
TR 50,6,59648
v_add_f32 v53, v53, v29
MAV 68,20,200
TR 52,6,59168
v_accvgpr_read_b32 v28, a246
MAV 68,4,192
TR 54,6,59680
s_waitcnt lgkmcnt(8)
MAV 72,8,192
TR 40,6,50752
v_add_f32 v54, v54, v28
MAV 72,24,200
TR 42,6,51264
v_accvgpr_read_b32 v29, a247
MAV 88,24,204
TR 44,6,50784
v_add_f32 v55, v55, v29
MAV 88,8,196
TR 46,6,51296
v_accvgpr_read_b32 v28, a248
MAV 92,12,196
TR 56,6,59200
v_add_f32 v56, v56, v28
MAV 92,28,204
TR 58,6,59712
v_accvgpr_read_b32 v29, a249
MAV 76,28,200
TR 60,6,59232
v_add_f32 v57, v57, v29
MAV 76,12,192
TR 62,6,59744
v_accvgpr_read_b32 v28, a250
s_waitcnt vmcnt(0) lgkmcnt(8)
MAV 64,32,208
ds_read_b64_tr_b16 a[0:1], v7
v_add_f32 v58, v58, v28
MAV 64,48,216
TR 2,7,512
v_accvgpr_read_b32 v29, a251
MAV 80,48,220
TR 4,7,32
v_add_f32 v59, v59, v29
MAV 80,32,212
TR 6,7,544
MAV 84,36,212
TR 16,7,8448
v_accvgpr_read_b32 v28, a252
MAV 84,52,220
TR 18,7,8960
v_add_f32 v60, v60, v28
MAV 68,52,216
TR 20,7,8480
v_accvgpr_read_b32 v29, a253
MAV 68,36,208
TR 22,7,8992
s_waitcnt lgkmcnt(8)
MAV 72,40,208
TR 8,7,64
MAV 72,56,216
TR 10,7,576
v_add_f32 v61, v61, v29
MAV 88,56,220
TR 12,7,96
v_accvgpr_read_b32 v28, a254
MAV 88,40,212
TR 14,7,608
v_add_f32 v62, v62, v28
MAV 92,44,212
TR 24,7,8512
MAV 92,60,220
TR 26,7,9024
v_accvgpr_read_b32 v29, a255
MAV 76,60,216
TR 28,7,8544
v_add_f32 v63, v63, v29
MAV 76,44,208
TR 30,7,9056
s_waitcnt lgkmcnt(8)
MAV 32,0,96
TR 32,7,16896
v_cvt_pk_bf16_f32 v232, v64, v65
v_cvt_pk_bf16_f32 v233, v66, v67
MAV 32,16,104
TR 34,7,17408
v_cvt_pk_bf16_f32 v234, v68, v69
MAV 48,16,108
TR 36,7,16928
v_cvt_pk_bf16_f32 v235, v70, v71
buffer_store_dwordx4 v[232:235], v11, s[16:19], s69 offen sc1
MAV 48,0,100
TR 38,7,17440
s_add_u32 s69, s69, 131072
MAV 52,4,100
TR 48,7,25344
v_cvt_pk_bf16_f32 v236, v72, v73
v_cvt_pk_bf16_f32 v237, v74, v75
MAV 52,20,108
TR 50,7,25856
v_cvt_pk_bf16_f32 v238, v76, v77
MAV 36,20,104
TR 52,7,25376
v_cvt_pk_bf16_f32 v239, v78, v79
buffer_store_dwordx4 v[236:239], v11, s[16:19], s69 offen sc1
MAV 36,4,96
TR 54,7,25888
s_add_u32 s69, s69, -130048
s_waitcnt lgkmcnt(8)
MAV 40,8,96
TR 40,7,16960
v_cvt_pk_bf16_f32 v240, v80, v81
MAV 40,24,104
TR 42,7,17472
v_cvt_pk_bf16_f32 v241, v82, v83
v_cvt_pk_bf16_f32 v242, v84, v85
MAV 56,24,108
TR 44,7,16992
v_cvt_pk_bf16_f32 v243, v86, v87
MAV 56,8,100
TR 46,7,17504
buffer_store_dwordx4 v[240:243], v11, s[16:19], s69 offen sc1
s_add_u32 s69, s69, 131072
MAV 60,12,100
TR 56,7,25408
v_cvt_pk_bf16_f32 v244, v88, v89
MAV 60,28,108
TR 58,7,25920
v_cvt_pk_bf16_f32 v245, v90, v91
v_cvt_pk_bf16_f32 v246, v92, v93
MAV 44,28,104
TR 60,7,25440
v_cvt_pk_bf16_f32 v247, v94, v95
MAV 44,12,96
TR 62,7,25952
buffer_store_dwordx4 v[244:247], v11, s[16:19], s69 offen sc1
s_waitcnt lgkmcnt(8)
MAV 32,32,112
TR 0,7,33792
MAV 32,48,120
TR 2,7,34304
MAV 48,48,124
TR 4,7,33824
MAV 48,32,116
TR 6,7,34336
MAV 52,36,116
TR 16,7,42240
MAV 52,52,124
TR 18,7,42752
MAV 36,52,120
TR 20,7,42272
MAV 36,36,112
TR 22,7,42784
s_waitcnt lgkmcnt(8)
MAV 40,40,112
TR 8,7,33856
MAV 40,56,120
TR 10,7,34368
MAV 56,56,124
TR 12,7,33888
MAV 56,40,116
TR 14,7,34400
MAV 60,44,116
TR 24,7,42304
MAV 60,60,124
TR 26,7,42816
MAV 44,60,120
TR 28,7,42336
MAV 44,44,112
TR 30,7,42848
s_waitcnt lgkmcnt(8)
MAV 32,0,128
TR 32,7,50688
MAV 32,16,136
TR 34,7,51200
MAV 48,16,140
TR 36,7,50720
MAV 48,0,132
TR 38,7,51232
MAV 52,4,132
TR 48,7,59136
MAV 52,20,140
TR 50,7,59648
MAV 36,20,136
TR 52,7,59168
MAV 36,4,128
TR 54,7,59680
s_waitcnt lgkmcnt(8)
MAV 40,8,128
TR 40,7,50752
MAV 40,24,136
TR 42,7,51264
MAV 56,24,140
TR 44,7,50784
MAV 56,8,132
TR 46,7,51296
MAV 60,12,132
TR 56,7,59200
MAV 60,28,140
TR 58,7,59712
MAV 44,28,136
TR 60,7,59232
MAV 44,12,128
TR 62,7,59744
v_add_u32 v7, s57, v7
s_waitcnt lgkmcnt(8)
MAV 32,32,144
ds_read_b64_tr_b16 a[0:1], v7
TR 2,7,512
MAV 32,48,152
s_waitcnt vmcnt(0)
buffer_atomic_add v13, v12, s[16:19], s71 offen
MAV 48,48,156
TR 4,7,32
MAV 48,32,148
TR 6,7,544
MAV 52,36,148
TR 16,7,8448
MAV 52,52,156
TR 18,7,8960
MAV 36,52,152
TR 20,7,8480
MAV 36,36,144
TR 22,7,8992
s_waitcnt lgkmcnt(8)
MAV 40,40,144
TR 8,7,64
MAV 40,56,152
TR 10,7,576
MAV 56,56,156
TR 12,7,96
MAV 56,40,148
TR 14,7,608
MAV 60,44,148
TR 24,7,8512
MAV 60,60,156
TR 26,7,9024
MAV 44,60,152
TR 28,7,8544
MAV 44,44,144
TR 30,7,9056
s_waitcnt lgkmcnt(8)
s_barrier
MAV 32,0,160
TR 32,7,16896
TR 34,7,17408
MAV 32,16,168
buffer_atomic_add v15, v12, s[16:19], s70 offen sc0
MAV 48,16,172
TR 36,7,16928
TR 38,7,17440
MAV 48,0,164
TR 48,7,25344
s_add_u32 m0, s59, 117248
MAV 52,4,164
buffer_load_dwordx4 v18, s[20:23], s58 offen lds
MAV 52,20,172
TR 50,7,25856
TR 52,7,25376
MAV 36,20,168
TR 54,7,25888
MAV 36,4,160
TR 40,7,16960
s_waitcnt lgkmcnt(9)
MAV 40,8,160
buffer_load_dwordx4 v19, s[20:23], s58 offen offset:1024 lds
MAV 40,24,168
TR 42,7,17472
TR 44,7,16992
MAV 56,24,172
buffer_load_dwordx4 v20, s[20:23], s58 offen offset:2048 lds
MAV 56,8,164
.Lpad11:
s_cbranch_execz .Lnopoll37r
TR 46,7,17504
s_add_u32 s58, s58, 196608
MAV 60,12,164
TR 56,7,25408
s_add_u32 m0, s59, 129664
MAV 60,28,172
buffer_load_dwordx4 v18, s[20:23], s58 offen lds
MAV 44,28,168
TR 58,7,25920
TR 60,7,25440
MAV 44,12,160
TR 62,7,25952
s_waitcnt lgkmcnt(8)
MAV 32,32,176
TR 0,7,33792
TR 2,7,34304
MAV 32,48,184
buffer_load_dwordx4 v19, s[20:23], s58 offen offset:1024 lds
MAV 48,48,188
TR 4,7,33824
MAV 48,32,180
TR 6,7,34336
TR 16,7,42240
MAV 52,36,180
buffer_load_dwordx4 v20, s[20:23], s58 offen offset:2048 lds
MAV 52,52,188
TR 18,7,42752
s_add_u32 s58, s58, 196608
MAV 36,52,184
TR 20,7,42272
MAV 36,36,176
TR 22,7,42784
s_add_u32 m0, s59, 67584
s_waitcnt lgkmcnt(8)
MAV 40,40,176
buffer_load_dwordx4 v18, s[20:23], s58 offen lds
MAV 40,56,184
TR 8,7,33856
MAV 56,56,188
TR 10,7,34368
TR 12,7,33888
MAV 56,40,180
TR 14,7,34400
MAV 60,44,180
buffer_load_dwordx4 v19, s[20:23], s58 offen offset:1024 lds
MAV 60,60,188
TR 24,7,42304
TR 26,7,42816
MAV 44,60,184
TR 28,7,42336
MAV 44,44,176
TR 30,7,42848
s_waitcnt vmcnt(8)
v_cmp_ne_u32 vcc, 0, v15
s_nop 0
s_cbranch_vccz .Lxs51
.Lxs51b:
s_waitcnt lgkmcnt(8)
MAV 32,0,192
TR 32,7,50688
TR 34,7,51200
MAV 32,16,200
TR 36,7,50720
buffer_load_dwordx4 v[232:235], v11, s[16:19], s68 offen sc1
MAV 48,16,204
TR 38,7,51232
s_add_u32 s68, s68, 131072
MAV 48,0,196
TR 48,7,59136
buffer_load_dwordx4 v[236:239], v11, s[16:19], s68 offen sc1
MAV 52,4,196
TR 50,7,59648
s_add_u32 s68, s68, -130048
MAV 52,20,204
TR 52,7,59168
buffer_load_dwordx4 v[240:243], v11, s[16:19], s68 offen sc1
MAV 36,20,200
TR 54,7,59680
s_add_u32 s68, s68, 131072
MAV 36,4,192
buffer_load_dwordx4 v[244:247], v11, s[16:19], s68 offen sc1
s_waitcnt lgkmcnt(8)
MAV 40,8,192
TR 40,7,50752
buffer_load_dwordx4 v20, s[20:23], s58 offen offset:2048 lds
MAV 40,24,200
TR 42,7,51264
s_add_u32 s58, s58, 196608
s_add_u32 m0, s59, 80000
MAV 56,24,204
TR 44,7,50784
buffer_load_dwordx4 v18, s[20:23], s58 offen lds
MAV 56,8,196
TR 46,7,51296
MAV 60,12,196
TR 56,7,59200
buffer_load_dwordx4 v19, s[20:23], s58 offen offset:1024 lds
MAV 60,28,204
TR 58,7,59712
MAV 44,28,200
TR 60,7,59232
buffer_load_dwordx4 v20, s[20:23], s58 offen offset:2048 lds
MAV 44,12,192
TR 62,7,59744
s_add_u32 s58, s58, 196608
s_waitcnt lgkmcnt(8)
MAV 32,32,208
s_add_u32 m0, s59, 92416
MAV 32,48,216
buffer_load_dwordx4 v18, s[20:23], s58 offen lds
MAV 48,48,220
MAV 48,32,212
MAV 52,36,212
MAV 52,52,220
MAV 36,52,216
buffer_load_dwordx4 v19, s[20:23], s58 offen offset:1024 lds
MAV 36,36,208
s_waitcnt lgkmcnt(0)
MAV 40,40,208
MAV 40,56,216
MAV 56,56,220
MAV 56,40,212
buffer_load_dwordx4 v20, s[20:23], s58 offen offset:2048 lds
MAV 60,44,212
s_add_u32 s58, s58, 196608
MAV 60,60,220
MAV 44,60,216
MAV 44,44,208
s_waitcnt vmcnt(10)
v_mfma_f32_16x16x32_bf16 v[32:35], v[226:229], v[232:235], v[32:35]
s_lshl_b32 s64, s6, 14
s_lshl_b32 s65, s49, 13
s_add_u32 s64, s64, s65
v_mfma_f32_16x16x32_bf16 v[36:39], v[224:227], v[232:235], v[36:39]
s_lshl_b32 s65, s7, 9
s_add_u32 s64, s64, s65
s_lshl_b32 s65, s48, 8
s_waitcnt vmcnt(9)
v_mfma_f32_16x16x32_bf16 v[40:43], v[226:229], v[236:239], v[40:43]
s_add_u32 s64, s64, s65
s_add_u32 s64, s64, 62914560
v_and_b32 v152, 31, v1
v_mfma_f32_16x16x32_bf16 v[44:47], v[224:227], v[236:239], v[44:47]
s_lshl_b32 s62, s7, 18
v_lshlrev_b32 v152, 3, v152
v_lshrrev_b32 v153, 5, v1
s_waitcnt vmcnt(8)
v_mfma_f32_16x16x32_bf16 v[48:51], v[226:229], v[240:243], v[48:51]
s_add_u32 s62, s62, 33554432
v_lshl_add_u32 v152, v153, 28, v152
s_add_u32 s63, s62, 131072
v_mfma_f32_16x16x32_bf16 v[52:55], v[224:227], v[240:243], v[52:55]
v_cvt_pk_bf16_f32 v128, v32, v33
v_cvt_pk_bf16_f32 v129, v34, v35
s_waitcnt vmcnt(7)
v_mfma_f32_16x16x32_bf16 v[56:59], v[226:229], v[244:247], v[56:59]
v_cvt_pk_bf16_f32 v130, v36, v37
v_cvt_pk_bf16_f32 v131, v38, v39
v_mfma_f32_16x16x32_bf16 v[60:63], v[224:227], v[244:247], v[60:63]
buffer_store_dwordx4 v[128:131], v4, s[16:19], s62 offen sc1
v_cvt_pk_bf16_f32 v132, v40, v41
v_cvt_pk_bf16_f32 v133, v42, v43
v_cvt_pk_bf16_f32 v134, v44, v45
v_cvt_pk_bf16_f32 v135, v46, v47
v_cvt_pk_bf16_f32 v136, v48, v49
v_cvt_pk_bf16_f32 v137, v50, v51
v_cvt_pk_bf16_f32 v138, v52, v53
v_cvt_pk_bf16_f32 v139, v54, v55
v_cvt_pk_bf16_f32 v140, v56, v57
v_cvt_pk_bf16_f32 v141, v58, v59
v_cvt_pk_bf16_f32 v142, v60, v61
v_cvt_pk_bf16_f32 v143, v62, v63
v_pk_mul_f32 v[146:147], v[32:33], v[32:33]
buffer_store_dwordx4 v[132:135], v4, s[16:19], s63 offen sc1
v_pk_mul_f32 v[150:151], v[48:49], v[48:49]
v_pk_fma_f32 v[146:147], v[34:35], v[34:35], v[146:147]
v_pk_add_f32 v[144:145], v[32:33], v[34:35]
v_pk_fma_f32 v[150:151], v[50:51], v[50:51], v[150:151]
v_pk_add_f32 v[148:149], v[48:49], v[50:51]
v_pk_fma_f32 v[146:147], v[36:37], v[36:37], v[146:147]
v_pk_add_f32 v[144:145], v[144:145], v[36:37]
v_pk_fma_f32 v[150:151], v[52:53], v[52:53], v[150:151]
v_pk_add_f32 v[148:149], v[148:149], v[52:53]
v_pk_fma_f32 v[146:147], v[38:39], v[38:39], v[146:147]
v_pk_add_f32 v[144:145], v[144:145], v[38:39]
v_pk_fma_f32 v[150:151], v[54:55], v[54:55], v[150:151]
v_pk_add_f32 v[148:149], v[148:149], v[54:55]
buffer_store_dwordx4 v[136:139], v4, s[16:19], s62 offen offset:1024 sc1
v_pk_fma_f32 v[146:147], v[40:41], v[40:41], v[146:147]
v_pk_add_f32 v[144:145], v[144:145], v[40:41]
v_pk_fma_f32 v[150:151], v[56:57], v[56:57], v[150:151]
v_pk_add_f32 v[148:149], v[148:149], v[56:57]
v_pk_fma_f32 v[146:147], v[42:43], v[42:43], v[146:147]
v_pk_add_f32 v[144:145], v[144:145], v[42:43]
v_pk_fma_f32 v[150:151], v[58:59], v[58:59], v[150:151]
v_pk_add_f32 v[148:149], v[148:149], v[58:59]
v_pk_fma_f32 v[146:147], v[44:45], v[44:45], v[146:147]
v_pk_add_f32 v[144:145], v[144:145], v[44:45]
v_pk_fma_f32 v[150:151], v[60:61], v[60:61], v[150:151]
v_pk_add_f32 v[148:149], v[148:149], v[60:61]
v_pk_fma_f32 v[146:147], v[46:47], v[46:47], v[146:147]
buffer_store_dwordx4 v[140:143], v4, s[16:19], s63 offen offset:1024 sc1
v_pk_add_f32 v[144:145], v[144:145], v[46:47]
v_pk_fma_f32 v[150:151], v[62:63], v[62:63], v[150:151]
v_pk_add_f32 v[148:149], v[148:149], v[62:63]
v_add_f32 v144, v144, v145
v_add_f32 v146, v146, v147
v_add_f32 v148, v148, v149
v_add_f32 v150, v150, v151
s_nop 0
v_permlane16_swap_b32 v144, v148
v_permlane16_swap_b32 v146, v150
v_add_f32 v144, v144, v148
v_add_f32 v146, v146, v150
s_nop 1
v_permlane32_swap_b32 v144, v146
v_add_f32 v144, v144, v146
s_nop 1
v_permlane32_swap_b32 v144, v145
buffer_store_dwordx2 v[144:145], v152, s[16:19], s64 offen sc1
s_nop 1
v_accvgpr_write_b32 a224, v32
v_accvgpr_write_b32 a225, v33
v_accvgpr_write_b32 a226, v34
v_accvgpr_write_b32 a227, v35
v_accvgpr_write_b32 a228, v36
v_accvgpr_write_b32 a229, v37
v_accvgpr_write_b32 a230, v38
v_accvgpr_write_b32 a231, v39
v_accvgpr_write_b32 a232, v40
v_accvgpr_write_b32 a233, v41
v_accvgpr_write_b32 a234, v42
v_accvgpr_write_b32 a235, v43
v_accvgpr_write_b32 a236, v44
v_accvgpr_write_b32 a237, v45
v_accvgpr_write_b32 a238, v46
v_accvgpr_write_b32 a239, v47
v_accvgpr_write_b32 a240, v48
v_accvgpr_write_b32 a241, v49
v_accvgpr_write_b32 a242, v50
v_accvgpr_write_b32 a243, v51
v_accvgpr_write_b32 a244, v52
v_accvgpr_write_b32 a245, v53
v_accvgpr_write_b32 a246, v54
v_accvgpr_write_b32 a247, v55
v_accvgpr_write_b32 a248, v56
v_accvgpr_write_b32 a249, v57
v_accvgpr_write_b32 a250, v58
v_accvgpr_write_b32 a251, v59
v_accvgpr_write_b32 a252, v60
v_accvgpr_write_b32 a253, v61
v_accvgpr_write_b32 a254, v62
v_accvgpr_write_b32 a255, v63
s_lshl_b32 s62, s3, 11
s_add_u32 s62, s62, s85
v_lshl_add_u32 v21, v1, 4, s62
v_lshrrev_b32 v2, 3, v1
v_cmp_eq_u32 vcc, 3, v2
v_add_u32 v2, 67108480, v21
s_nop 0
v_cndmask_b32 v21, v21, v2, vcc
s_sub_u32 s62, s86, 2048
v_lshl_add_u32 v22, v0, 2, s62
v_lshrrev_b32 v2, 5, v0
v_cmp_eq_u32 vcc, 3, v2
v_add_u32 v2, 67108480, v22
s_nop 0
v_cndmask_b32 v22, v22, v2, vcc
s_mul_i32 s62, s48, 4608
v_lshl_add_u32 v23, v1, 4, s62
v_lshrrev_b32 v24, 4, v1
v_mul_u32_u24 v24, 2304, v24
v_and_b32 v2, 15, v1
v_lshl_add_u32 v24, v2, 4, v24
s_mov_b32 s52, 33554432
s_mov_b32 s54, s58
s_mov_b32 s56, s59
s_mul_i32 s55, s3, 2304
v_bfe_u32 v25, v1, 3, 2
v_mul_u32_u24 v25, 3104, v25
v_bfe_u32 v2, v1, 2, 1
v_lshl_add_u32 v25, v2, 7, v25
v_bfe_u32 v2, v1, 5, 1
v_lshl_add_u32 v25, v2, 8, v25
v_and_b32 v2, 3, v1
v_lshl_add_u32 v25, v2, 3, v25
s_lshl_b32 s62, s49, 6
s_add_u32 s62, s62, 67584
v_add_u32 v25, s62, v25
s_lshl_b32 s62, s8, 1
s_add_u32 s62, s62, s3
s_lshr_b32 s63, s50, 2
s_cmp_lt_u32 s3, 2
s_cselect_b32 s62, s62, s63
s_lshl_b32 s62, s62, 13
s_cmp_eq_u32 s3, 3
s_cselect_b32 s62, 268435456, s62
v_lshl_add_u32 v26, v1, 4, s62
s_lshr_b32 s63, s20, 7
s_sub_u32 s63, 3, s63
s_and_b32 s63, s63, 7
s_and_b32 s62, s9, 8
s_add_u32 s63, s63, s62
s_lshl_b32 s62, s5, 2
s_add_u32 s62, s62, s3
s_mul_i32 s62, s62, 12288
s_lshl_b32 s64, s63, 7
s_add_u32 s62, s62, s64
s_xor_b32 s63, s63, s9
s_cmp_lt_u32 s63, 4
s_cselect_b32 s62, s62, 16777216
v_lshrrev_b32 v14, 3, v1
v_min_u32 v14, 5, v14
v_lshl_add_u32 v14, v14, 11, s62
s_mov_b32 s44, 983040
buffer_load_dword v27, v14, s[20:23], s44 offen
s_mov_b32 s44, 2555904
s_mul_i32 s59, s3, 2080
v_bfe_u32 v5, v1, 3, 1
v_lshrrev_b32 v2, 4, v1
v_lshl_add_u32 v5, v2, 3, v5
s_lshl_b32 s62, s3, 1
v_add_u32 v5, s62, v5
v_mul_u32_u24 v5, 2048, v5
v_and_b32 v2, 7, v1
v_lshl_add_u32 v5, v2, 4, v5
s_lshl_b32 s62, s7, 7
v_add_u32 v5, s62, v5
v_add_u32 v6, 64512, v5
s_lshl_b32 s62, s6, 10
s_add_u32 s62, s62, 30474240
s_lshl_b32 s64, s8, 10
s_add_u32 s64, s64, 30474240
s_lshr_b32 s67, s9, 1
s_and_b32 s67, s67, 3
s_lshl_b32 s67, s67, 7
s_add_u32 s64, s64, s67
s_lshr_b32 s65, s50, 3
s_lshl_b32 s65, s65, 10
s_add_u32 s65, s65, 30474240
s_lshr_b32 s67, s9, 1
s_and_b32 s67, s67, 3
s_lshl_b32 s67, s67, 7
s_add_u32 s65, s65, s67
v_lshl_add_u32 v252, v1, 7, s62
v_mov_b32 v253, s64
v_mov_b32 v255, 1
v_writelane_b32 v253, s65, 1
s_waitcnt vmcnt(1) lgkmcnt(0)
s_cmp_lg_u32 s3, 1
s_barrier
s_cbranch_scc1 .Lfirst54
s_mov_b64 exec, 15
buffer_atomic_add v255, v252, s[16:19], 0 offen
s_mov_b64 exec, 3
v_mov_b32 v254, 0
buffer_atomic_add v254, v253, s[16:19], 0 offen sc0
s_mov_b64 exec, -1
.Lfirst54:
TR 20,25,49664
TR 22,25,50176
TR 24,25,49696
TR 26,25,50208
TR 28,25,50688
TR 30,25,51200
TR 32,25,50720
TR 34,25,51232
TR 36,25,51712
TR 38,25,52224
TR 40,25,51744
TR 42,25,52256
v_lshrrev_b32 v2, 4, v1
v_lshlrev_b32 v2, 2, v2
v_and_b32 v13, 15, v1
v_sub_u32 v2, v13, v2
v_mov_b32 v13, 0xff61b1e6
v_subrev_u32 v54, 0, v2
v_cmp_gt_u32 vcc, 8, v54
s_nop 1
v_cndmask_b32 v50, v13, 0, vcc
v_cmp_gt_i32 vcc, -8, v54
s_nop 1
v_cndmask_b32 v46, v13, 0, vcc
v_subrev_u32 v54, 1, v2
v_cmp_gt_u32 vcc, 8, v54
s_nop 1
v_cndmask_b32 v51, v13, 0, vcc
v_cmp_gt_i32 vcc, -8, v54
s_nop 1
v_cndmask_b32 v47, v13, 0, vcc
v_subrev_u32 v54, 2, v2
v_cmp_gt_u32 vcc, 8, v54
s_nop 1
v_cndmask_b32 v52, v13, 0, vcc
v_cmp_gt_i32 vcc, -8, v54
s_nop 1
v_cndmask_b32 v48, v13, 0, vcc
v_subrev_u32 v54, 3, v2
v_cmp_gt_u32 vcc, 8, v54
s_nop 1
v_cndmask_b32 v53, v13, 0, vcc
v_cmp_gt_i32 vcc, -8, v54
s_nop 1
v_cndmask_b32 v49, v13, 0, vcc
s_cmp_lt_u32 s8, 2
s_cselect_b64 vcc, -1, 0
v_cndmask_b32 v54, v46, v13, vcc
v_cndmask_b32 v55, v47, v13, vcc
v_cndmask_b32 v56, v48, v13, vcc
v_cndmask_b32 v57, v49, v13, vcc
v_mov_b64 v[60:61], 0
v_mov_b64 v[62:63], 0
v_mov_b64 v[64:65], 0
v_mov_b64 v[66:67], 0
v_mov_b64 v[68:69], 0
v_mov_b64 v[70:71], 0
v_mov_b64 v[72:73], 0
v_mov_b64 v[74:75], 0
v_mov_b64 v[76:77], 0
v_mov_b64 v[78:79], 0
v_mov_b64 v[80:81], 0
v_mov_b64 v[82:83], 0
v_mov_b64 v[84:85], 0
v_mov_b64 v[86:87], 0
v_mov_b64 v[88:89], 0
v_mov_b64 v[90:91], 0
v_mov_b64 v[92:93], 0
v_mov_b64 v[94:95], 0
v_mov_b64 v[96:97], 0
v_mov_b64 v[98:99], 0
v_mov_b64 v[100:101], 0
v_mov_b64 v[102:103], 0
v_mov_b64 v[104:105], 0
v_mov_b64 v[106:107], 0
v_mov_b64 v[108:109], 0
v_mov_b64 v[110:111], 0
v_mov_b64 v[112:113], 0
v_mov_b64 v[114:115], 0
v_mov_b64 v[116:117], 0
v_mov_b64 v[118:119], 0
v_mov_b64 v[120:121], 0
v_mov_b64 v[122:123], 0
v_mov_b64 v[124:125], 0
v_mov_b64 v[126:127], 0
v_mov_b64 v[128:129], 0
v_mov_b64 v[130:131], 0
v_mov_b64 v[132:133], 0
v_mov_b64 v[134:135], 0
v_mov_b64 v[136:137], 0
v_mov_b64 v[138:139], 0
v_mov_b64 v[140:141], 0
v_mov_b64 v[142:143], 0
v_mov_b64 v[144:145], 0
v_mov_b64 v[146:147], 0
v_mov_b64 v[148:149], 0
v_mov_b64 v[150:151], 0
v_mov_b64 v[152:153], 0
v_mov_b64 v[154:155], 0
v_mov_b64 v[156:157], 0
v_mov_b64 v[158:159], 0
v_mov_b64 v[160:161], 0
v_mov_b64 v[162:163], 0
v_mov_b64 v[164:165], 0
v_mov_b64 v[166:167], 0
v_mov_b64 v[168:169], 0
v_mov_b64 v[170:171], 0
v_mov_b64 v[172:173], 0
v_mov_b64 v[174:175], 0
s_mov_b32 s75, 62914560
v_and_b32 v10, 15, v1
v_lshlrev_b32 v12, 2, v10
v_lshlrev_b32 v10, 4, v10
v_add_u32 v10, 152576, v10
v_lshrrev_b32 v11, 4, v1
v_lshlrev_b32 v11, 4, v11
s_lshl_b32 s62, s49, 7
s_add_u32 s62, s62, 158720
v_add_u32 v12, s62, v12
v_add_u32 v13, s62, v11
v_add_u32 v11, 156672, v11
s_lshl_b32 s62, s3, 11
s_add_u32 s62, s62, 143360
v_lshl_add_u32 v8, v1, 4, s62
v_xor_b32 v9, 2048, v8
v_mov_b32 v248, 0x3f803f80
v_mov_b32 v249, 0x3f803f80
v_mov_b32 v250, 0x3f803f80
v_mov_b32 v251, 0x3f803f80
v_and_b32 v7, 31, v1
v_lshrrev_b32 v2, 5, v1
v_lshl_add_u32 v7, v7, 1, v2
v_and_b32 v2, 0xc0, v0
v_add_u32 v7, v7, v2
v_lshlrev_b32 v17, 2, v7
v_add_u32 v17, 156672, v17
v_lshlrev_b32 v7, 4, v7
v_add_u32 v7, 152576, v7
s_lshl_b32 s74, s9, 1
s_add_u32 s74, s74, s49
s_lshl_b32 s74, s74, 17
s_add_u32 s74, s74, s85
s_lshl_b32 s63, s48, 12
s_add_u32 s74, s74, s63
s_add_u32 s74, s74, 37748736
s_mov_b32 s62, 0
v_lshl_add_u32 v4, v1, 4, s62
v_lshrrev_b32 v2, 3, v1
v_cmp_eq_u32 vcc, 3, v2
v_add_u32 v2, 67108480, v4
s_nop 0
v_cndmask_b32 v4, v4, v2, vcc
ds_read_b128 v[28:31], v13
ds_read_b128 v[32:35], v13 offset:64
ds_read_b128 v[36:39], v13 offset:256
ds_read_b128 v[40:43], v13 offset:320
ds_read_b32 v44, v12 offset:512
ds_read_b32 v45, v12 offset:576
s_waitcnt lgkmcnt(0)
s_cmp_lg_u32 s3, 1
s_cbranch_scc1 .Lnopoll53
s_mov_b64 exec, 3
s_mov_b32 s15, 0
.Lpoll52:
v_mov_b32 v255, 0
buffer_atomic_add v255, v253, s[16:19], 0 offen sc0
s_waitcnt vmcnt(1)
v_cmp_gt_u32 vcc, 16, v254
s_add_u32 s15, s15, 1
s_cbranch_vccz .Lnopoll53r
v_mov_b32 v254, 0
buffer_atomic_add v254, v253, s[16:19], 0 offen sc0
s_waitcnt vmcnt(1)
v_cmp_gt_u32 vcc, 16, v255
s_add_u32 s15, s15, 1
s_cbranch_vccz .Lnopoll53r
s_cmp_le_u32 s15, 100000
s_cbranch_scc1 .Lpoll52
s_branch .Lnopoll53r
.Lnopoll53:
s_mov_b64 exec, 0
s_cmp_eq_u32 s3, 2
s_cbranch_scc1 .Lpad12
s_cmp_eq_u32 s3, 3
s_cbranch_scc1 .Lpad13
s_branch .Lpad14
.Lnopoll53r:
s_mov_b64 exec, -1
s_barrier
s_cmp_eq_u32 s48, 1
s_cbranch_scc1 .Lqkv55
s_add_u32 m0, s55, 36864
s_nop 0
buffer_load_dwordx4 v21, s[16:19], s52 offen sc1 lds
buffer_load_dwordx4 v21, s[16:19], s52 offen offset:1024 sc1 lds
buffer_load_dword v22, s[16:19], s52 offen offset:2048 sc1 lds
s_add_u32 s52, s52, 131072
s_add_u32 m0, s55, 46080
s_nop 0
buffer_load_dwordx4 v21, s[16:19], s52 offen sc1 lds
buffer_load_dwordx4 v21, s[16:19], s52 offen offset:1024 sc1 lds
buffer_load_dword v22, s[16:19], s52 offen offset:2048 sc1 lds
s_add_u32 s52, s52, 131072
s_add_u32 m0, s55, 0
s_nop 0
buffer_load_dwordx4 v21, s[16:19], s52 offen sc1 lds
buffer_load_dwordx4 v21, s[16:19], s52 offen offset:1024 sc1 lds
buffer_load_dword v22, s[16:19], s52 offen offset:2048 sc1 lds
s_add_u32 s52, s52, 131072
s_add_u32 m0, s55, 9216
s_nop 0
buffer_load_dwordx4 v21, s[16:19], s52 offen sc1 lds
buffer_load_dwordx4 v21, s[16:19], s52 offen offset:1024 sc1 lds
buffer_load_dword v22, s[16:19], s52 offen offset:2048 sc1 lds
s_add_u32 s52, s52, 131072
s_add_u32 m0, s55, 18432
s_nop 0
buffer_load_dwordx4 v21, s[16:19], s52 offen sc1 lds
buffer_load_dwordx4 v21, s[16:19], s52 offen offset:1024 sc1 lds
buffer_load_dword v22, s[16:19], s52 offen offset:2048 sc1 lds
s_add_u32 s52, s52, 131072
s_waitcnt vmcnt(12)
s_barrier
RD 0,23,36864
RD 4,23,37888
RD 8,23,39168
RD 12,23,40192
RD 16,24,38912
s_waitcnt lgkmcnt(0)
s_mov_b32 s15, -4
.p2align 6
.Lk57:
s_waitcnt vmcnt(9) lgkmcnt(8)
s_barrier
MAA 60,20,0
RD 44,23,46080
s_add_u32 m0, s56, 104832
MAA 76,24,0
buffer_load_dwordx4 v18, s[20:23], s54 offen lds
MAA 80,24,4
RD 48,23,47104
v_add_f32 v164, v164, v168
MAA 64,20,4
RD 52,23,48384
MAA 68,20,8
buffer_load_dwordx4 v19, s[20:23], s54 offen offset:1024 lds
MAA 84,24,8
RD 56,23,49408
MAA 88,24,12
TR 64,25,62080
v_add_f32 v165, v165, v169
MAA 72,20,12
TR 66,25,62592
s_waitcnt lgkmcnt(6)
MAA 104,28,12
buffer_load_dwordx4 v20, s[20:23], s54 offen offset:2048 lds
MAA 120,32,12
TR 68,25,62112
s_add_u32 s54, s54, 196608
MAA 116,32,8
TR 70,25,62624
s_add_u32 m0, s55, 27648
MAA 100,28,8
buffer_load_dwordx4 v21, s[16:19], s52 offen sc1 lds
MAA 96,28,4
RD 60,24,48128
MAA 112,32,4
TR 72,25,63104
MAA 108,32,0
buffer_load_dwordx4 v21, s[16:19], s52 offen offset:1024 sc1 lds
MAA 92,28,0
TR 74,25,63616
v_add_f32 v166, v166, v170
MAA 156,28,16
TR 76,25,63136
MAA 160,32,16
TR 78,25,63648
MAA 124,0,36
buffer_load_dword v22, s[16:19], s52 offen offset:2048 sc1 lds
MAA 140,0,40
TR 80,25,64128
s_add_u32 s52, s52, 131072
MAA 144,4,40
.Lpad12:
s_cbranch_execz .Lpad15
TR 82,25,64640
v_add_f32 v167, v167, v171
MAA 128,4,36
buffer_load_dword v27, v14, s[20:23], s44 offen
MAA 132,8,36
TR 84,25,64160
s_add_u32 s44, s44, 1572864
MAA 148,8,40
TR 86,25,64672
MAA 152,12,40
MAA 136,12,36
s_waitcnt vmcnt(13) lgkmcnt(8)
s_barrier
MAA 60,64,44
ds_read_b128 a[0:3], v23
s_add_u32 m0, s56, 117248
MAA 76,68,44
buffer_load_dwordx4 v18, s[20:23], s54 offen lds
MAA 80,68,48
RD 4,23,1024
MAA 64,64,48
RD 8,23,2304
MAA 68,64,52
buffer_load_dwordx4 v19, s[20:23], s54 offen offset:1024 lds
MAA 84,68,52
RD 12,23,3328
MAA 88,68,56
ds_read_b64_tr_b16 a[20:21], v25
MAA 72,64,56
TR 22,25,512
s_waitcnt lgkmcnt(6)
MAA 104,72,56
buffer_load_dwordx4 v20, s[20:23], s54 offen offset:2048 lds
MAA 120,76,56
TR 24,25,32
s_add_u32 s54, s54, 196608
MAA 116,76,52
TR 26,25,544
s_add_u32 m0, s55, 36864
MAA 100,72,52
buffer_load_dwordx4 v21, s[16:19], s52 offen sc1 lds
MAA 96,72,48
RD 16,24,2048
MAA 112,76,48
TR 28,25,1024
MAA 108,76,44
buffer_load_dwordx4 v21, s[16:19], s52 offen offset:1024 sc1 lds
MAA 92,72,44
TR 30,25,1536
MAA 156,72,60
TR 32,25,1056
MAA 160,76,60
TR 34,25,1568
MAA 124,44,80
buffer_load_dword v22, s[16:19], s52 offen offset:2048 sc1 lds
MAA 140,44,84
TR 36,25,2048
s_add_u32 s52, s52, 131072
MAA 144,48,84
TR 38,25,2560
MAA 128,48,80
buffer_load_dwordx4 v[168:171], v26, s[16:19], s75 offen sc1
MAA 132,52,80
TR 40,25,2080
MAA 148,52,84
TR 42,25,2592
MAA 152,56,84
MAA 136,56,80
s_waitcnt vmcnt(17) lgkmcnt(8)
s_barrier
MAA 60,20,0
RD 44,23,9216
s_add_u32 m0, s56, 129664
MAA 76,24,0
buffer_load_dwordx4 v18, s[20:23], s54 offen lds
MAA 80,24,4
RD 48,23,10240
MAA 64,20,4
RD 52,23,11520
MAA 68,20,8
RD 56,23,12544
MAA 84,24,8
buffer_load_dwordx4 v19, s[20:23], s54 offen offset:1024 lds
MAA 88,24,12
TR 64,25,12416
MAA 72,20,12
TR 66,25,12928
s_waitcnt lgkmcnt(6)
MAA 104,28,12
TR 68,25,12448
MAA 120,32,12
buffer_load_dwordx4 v20, s[20:23], s54 offen offset:2048 lds
MAA 116,32,8
TR 70,25,12960
s_add_u32 s54, s54, 196608
MAA 100,28,8
RD 60,24,11264
MAA 96,28,4
s_add_u32 m0, s55, 46080
MAA 112,32,4
buffer_load_dwordx4 v21, s[16:19], s52 offen sc1 lds
MAA 108,32,0
TR 72,25,13440
MAA 92,28,0
TR 74,25,13952
MAA 156,28,16
TR 76,25,13472
MAA 160,32,16
buffer_load_dwordx4 v21, s[16:19], s52 offen offset:1024 sc1 lds
MAA 124,0,36
TR 78,25,13984
MAA 140,0,40
TR 80,25,14464
MAA 144,4,40
TR 82,25,14976
MAA 128,4,36
buffer_load_dword v22, s[16:19], s52 offen offset:2048 sc1 lds
MAA 132,8,36
TR 84,25,14496
s_add_u32 s52, s52, 131072
MAA 148,8,40
TR 86,25,15008
MAA 152,12,40
MAA 136,12,36
s_waitcnt vmcnt(20) lgkmcnt(8)
s_barrier
MAA 60,64,44
RD 0,23,18432
s_add_u32 m0, s56, 67584
MAA 76,68,44
buffer_load_dwordx4 v18, s[20:23], s54 offen lds
MAA 80,68,48
RD 4,23,19456
v_add_f32 v164, v164, v172
MAA 64,64,48
RD 8,23,20736
MAA 68,64,52
RD 12,23,21760
MAA 84,68,52
buffer_load_dwordx4 v19, s[20:23], s54 offen offset:1024 lds
MAA 88,68,56
TR 20,25,24832
MAA 72,64,56
TR 22,25,25344
s_waitcnt lgkmcnt(6)
MAA 104,72,56
TR 24,25,24864
v_add_f32 v165, v165, v173
MAA 120,76,56
buffer_load_dwordx4 v20, s[20:23], s54 offen offset:2048 lds
MAA 116,76,52
TR 26,25,25376
s_add_u32 s54, s54, 196608
MAA 100,72,52
RD 16,24,20480
MAA 96,72,48
s_add_u32 m0, s55, 0
MAA 112,76,48
buffer_load_dwordx4 v21, s[16:19], s52 offen sc1 lds
MAA 108,76,44
TR 28,25,25856
v_add_f32 v166, v166, v174
MAA 92,72,44
TR 30,25,26368
MAA 156,72,60
TR 32,25,25888
MAA 160,76,60
buffer_load_dwordx4 v21, s[16:19], s52 offen offset:1024 sc1 lds
MAA 124,44,80
TR 34,25,26400
MAA 140,44,84
TR 36,25,26880
v_add_f32 v167, v167, v175
MAA 144,48,84
TR 38,25,27392
MAA 128,48,80
buffer_load_dword v22, s[16:19], s52 offen offset:2048 sc1 lds
MAA 132,52,80
TR 40,25,26912
s_add_u32 s52, s52, 131072
MAA 148,52,84
TR 42,25,27424
MAA 152,56,84
MAA 136,56,80
s_waitcnt vmcnt(20) lgkmcnt(8)
s_barrier
MAA 60,20,0
RD 44,23,27648
s_add_u32 m0, s56, 80000
MAA 76,24,0
buffer_load_dwordx4 v18, s[20:23], s54 offen lds
MAA 80,24,4
RD 48,23,28672
MAA 64,20,4
RD 52,23,29952
MAA 68,20,8
buffer_load_dwordx4 v19, s[20:23], s54 offen offset:1024 lds
MAA 84,24,8
RD 56,23,30976
MAA 88,24,12
TR 64,25,37248
MAA 72,20,12
TR 66,25,37760
s_waitcnt lgkmcnt(6)
MAA 104,28,12
buffer_load_dwordx4 v20, s[20:23], s54 offen offset:2048 lds
MAA 120,32,12
TR 68,25,37280
s_add_u32 s54, s54, 196608
MAA 116,32,8
TR 70,25,37792
s_add_u32 m0, s55, 9216
MAA 100,28,8
buffer_load_dwordx4 v21, s[16:19], s52 offen sc1 lds
MAA 96,28,4
RD 60,24,29696
MAA 112,32,4
TR 72,25,38272
MAA 108,32,0
buffer_load_dwordx4 v21, s[16:19], s52 offen offset:1024 sc1 lds
MAA 92,28,0
TR 74,25,38784
MAA 156,28,16
TR 76,25,38304
MAA 160,32,16
TR 78,25,38816
MAA 124,0,36
buffer_load_dword v22, s[16:19], s52 offen offset:2048 sc1 lds
MAA 140,0,40
TR 80,25,39296
s_add_u32 s52, s52, 131072
MAA 144,4,40
TR 82,25,39808
MAA 128,4,36
buffer_load_dwordx4 v[172:175], v26, s[16:19], s75 offen offset:1024 sc1
MAA 132,8,36
TR 84,25,39328
s_add_u32 s75, s75, 2048
MAA 148,8,40
TR 86,25,39840
MAA 152,12,40
MAA 136,12,36
s_waitcnt vmcnt(20) lgkmcnt(8)
s_barrier
MAA 60,64,44
RD 0,23,36864
s_add_u32 m0, s56, 92416
MAA 76,68,44
buffer_load_dwordx4 v18, s[20:23], s54 offen lds
MAA 80,68,48
RD 4,23,37888
MAA 64,64,48
RD 8,23,39168
MAA 68,64,52
RD 12,23,40192
MAA 84,68,52
buffer_load_dwordx4 v19, s[20:23], s54 offen offset:1024 lds
MAA 88,68,56
TR 20,25,49664
MAA 72,64,56
TR 22,25,50176
s_waitcnt lgkmcnt(6)
MAA 104,72,56
TR 24,25,49696
MAA 120,76,56
buffer_load_dwordx4 v20, s[20:23], s54 offen offset:2048 lds
MAA 116,76,52
TR 26,25,50208
s_add_u32 s54, s54, 196608
MAA 100,72,52
RD 16,24,38912
MAA 96,72,48
s_add_u32 m0, s55, 18432
MAA 112,76,48
buffer_load_dwordx4 v21, s[16:19], s52 offen sc1 lds
MAA 108,76,44
TR 28,25,50688
MAA 92,72,44
TR 30,25,51200
MAA 156,72,60
TR 32,25,50720
MAA 160,76,60
buffer_load_dwordx4 v21, s[16:19], s52 offen offset:1024 sc1 lds
MAA 124,44,80
TR 34,25,51232
MAA 140,44,84
TR 36,25,51712
MAA 144,48,84
TR 38,25,52224
MAA 128,48,80
buffer_load_dword v22, s[16:19], s52 offen offset:2048 sc1 lds
MAA 132,52,80
TR 40,25,51744
s_add_u32 s52, s52, 131072
MAA 148,52,84
TR 42,25,52256
MAA 152,56,84
s_add_u32 s15, s15, 1
MAA 136,56,80
s_cbranch_scc0 .Lk57
s_waitcnt vmcnt(19) lgkmcnt(8)
s_barrier
MAA 60,20,0
RD 44,23,46080
s_add_u32 m0, s56, 104832
MAA 76,24,0
buffer_load_dwordx4 v18, s[20:23], s54 offen lds
MAA 80,24,4
RD 48,23,47104
v_add_f32 v164, v164, v168
MAA 64,20,4
RD 52,23,48384
v_add_f32 v165, v165, v169
MAA 68,20,8
RD 56,23,49408
v_add_f32 v166, v166, v170
MAA 84,24,8
buffer_load_dwordx4 v19, s[20:23], s54 offen offset:1024 lds
MAA 88,24,12
TR 64,25,62080
v_add_f32 v167, v167, v171
MAA 72,20,12
TR 66,25,62592
s_waitcnt lgkmcnt(6)
MAA 104,28,12
TR 68,25,62112
MAA 120,32,12
buffer_load_dwordx4 v20, s[20:23], s54 offen offset:2048 lds
MAA 116,32,8
TR 70,25,62624
s_add_u32 s54, s54, 196608
MAA 100,28,8
RD 60,24,48128
s_add_u32 m0, s55, 27648
MAA 96,28,4
TR 72,25,63104
MAA 112,32,4
buffer_load_dwordx4 v21, s[16:19], s52 offen sc1 lds
MAA 108,32,0
TR 74,25,63616
MAA 92,28,0
TR 76,25,63136
MAA 156,28,16
TR 78,25,63648
MAA 160,32,16
buffer_load_dwordx4 v21, s[16:19], s52 offen offset:1024 sc1 lds
MAA 124,0,36
TR 80,25,64128
MAA 140,0,40
TR 82,25,64640
MAA 144,4,40
TR 84,25,64160
MAA 128,4,36
buffer_load_dword v22, s[16:19], s52 offen offset:2048 sc1 lds
MAA 132,8,36
TR 86,25,64672
s_add_u32 s52, s52, 131072
MAA 148,8,40
MAA 152,12,40
MAA 136,12,36
s_waitcnt vmcnt(19) lgkmcnt(8)
s_barrier
MAA 60,64,44
ds_read_b128 a[0:3], v23
s_add_u32 m0, s56, 117248
MAA 76,68,44
buffer_load_dwordx4 v18, s[20:23], s54 offen lds
MAA 80,68,48
RD 4,23,1024
MAA 64,64,48
RD 8,23,2304
MAA 68,64,52
RD 12,23,3328
MAA 84,68,52
buffer_load_dwordx4 v19, s[20:23], s54 offen offset:1024 lds
MAA 88,68,56
ds_read_b64_tr_b16 a[20:21], v25
MAA 72,64,56
TR 22,25,512
s_waitcnt lgkmcnt(6)
MAA 104,72,56
TR 24,25,32
MAA 120,76,56
buffer_load_dwordx4 v20, s[20:23], s54 offen offset:2048 lds
MAA 116,76,52
TR 26,25,544
s_add_u32 s54, s54, 196608
MAA 100,72,52
RD 16,24,2048
MAA 96,72,48
s_add_u32 m0, s55, 36864
MAA 112,76,48
buffer_load_dwordx4 v21, s[16:19], s52 offen sc1 lds
MAA 108,76,44
TR 28,25,1024
MAA 92,72,44
TR 30,25,1536
MAA 156,72,60
TR 32,25,1056
MAA 160,76,60
buffer_load_dwordx4 v21, s[16:19], s52 offen offset:1024 sc1 lds
MAA 124,44,80
TR 34,25,1568
MAA 140,44,84
TR 36,25,2048
MAA 144,48,84
TR 38,25,2560
MAA 128,48,80
buffer_load_dword v22, s[16:19], s52 offen offset:2048 sc1 lds
MAA 132,52,80
TR 40,25,2080
s_add_u32 s52, s52, 131072
MAA 148,52,84
TR 42,25,2592
MAA 152,56,84
MAA 136,56,80
s_waitcnt vmcnt(19) lgkmcnt(8)
s_barrier
MAA 60,20,0
RD 44,23,9216
s_add_u32 m0, s56, 129664
MAA 76,24,0
buffer_load_dwordx4 v18, s[20:23], s54 offen lds
MAA 80,24,4
RD 48,23,10240
s_waitcnt vmcnt(19)
v_add_f32 v164, v164, v172
MAA 64,20,4
RD 52,23,11520
v_add_f32 v165, v165, v173
MAA 68,20,8
RD 56,23,12544
v_add_f32 v166, v166, v174
MAA 84,24,8
buffer_load_dwordx4 v19, s[20:23], s54 offen offset:1024 lds
MAA 88,24,12
TR 64,25,12416
v_add_f32 v167, v167, v175
MAA 72,20,12
TR 66,25,12928
s_waitcnt lgkmcnt(6)
MAA 104,28,12
TR 68,25,12448
MAA 120,32,12
buffer_load_dwordx4 v20, s[20:23], s54 offen offset:2048 lds
MAA 116,32,8
TR 70,25,12960
s_add_u32 s54, s54, 196608
MAA 100,28,8
RD 60,24,11264
s_add_u32 m0, s55, 46080
MAA 96,28,4
TR 72,25,13440
MAA 112,32,4
buffer_load_dwordx4 v21, s[16:19], s52 offen sc1 lds
MAA 108,32,0
TR 74,25,13952
MAA 92,28,0
TR 76,25,13472
MAA 156,28,16
TR 78,25,13984
MAA 160,32,16
buffer_load_dwordx4 v21, s[16:19], s52 offen offset:1024 sc1 lds
MAA 124,0,36
TR 80,25,14464
MAA 140,0,40
TR 82,25,14976
MAA 144,4,40
TR 84,25,14496
MAA 128,4,36
buffer_load_dword v22, s[16:19], s52 offen offset:2048 sc1 lds
MAA 132,8,36
TR 86,25,15008
s_add_u32 s52, s52, 131072
MAA 148,8,40
v_permlane32_swap_b32 v164, v166
MAA 152,12,40
v_permlane32_swap_b32 v165, v167
MAA 136,12,36
s_waitcnt vmcnt(18) lgkmcnt(8)
s_barrier
MAA 60,64,44
RD 0,23,18432
s_add_u32 m0, s59, 0
MAA 76,68,44
RD 4,23,19456
s_mov_b32 s58, 1048576
MAA 80,68,48
buffer_load_dwordx4 v5, s[24:27], s58 offen lds
MAA 64,64,48
RD 8,23,20736
v_add_f32 v164, v164, v166
MAA 68,64,52
RD 12,23,21760
v_add_f32 v165, v165, v167
MAA 84,68,52
TR 20,25,24832
v_mul_f32 v164, 0xba800000, v164
MAA 88,68,56
buffer_load_dwordx4 v6, s[24:27], s58 offen offset:1024 lds
MAA 72,64,56
TR 22,25,25344
s_add_u32 m0, s59, 58240
s_waitcnt lgkmcnt(6)
MAA 104,72,56
TR 24,25,24864
s_mov_b32 s58, 1966080
MAA 120,76,56
TR 26,25,25376
v_mul_f32 v165, 0x3a800000, v165
MAA 116,76,52
buffer_load_dwordx4 v5, s[24:27], s58 offen lds
MAA 100,72,52
RD 16,24,20480
v_fma_f32 v165, -v164, v164, v165
MAA 96,72,48
TR 28,25,25856
v_max_f32 v165, 0, v165
MAA 112,76,48
TR 30,25,26368
v_add_f32 v165, 0x3727c5ac, v165
MAA 108,76,44
buffer_load_dwordx4 v6, s[24:27], s58 offen offset:1024 lds
MAA 92,72,44
TR 32,25,25888
s_add_u32 m0, s59, 66560
MAA 156,72,60
TR 34,25,26400
s_mov_b32 s58, 0
MAA 160,76,60
TR 36,25,26880
MAA 124,44,80
buffer_load_dwordx4 v5, s[24:27], s58 offen lds
MAA 140,44,84
TR 38,25,27392
MAA 144,48,84
TR 40,25,26912
.Lpad13:
s_cbranch_execz .Lpad16
MAA 128,48,80
TR 42,25,27424
MAA 132,52,80
buffer_load_dwordx4 v6, s[24:27], s58 offen offset:1024 lds
MAA 148,52,84
v_rsq_f32 v166, v165
MAA 152,56,84
MAA 136,56,80
s_waitcnt vmcnt(18) lgkmcnt(8)
s_barrier
MAA 60,20,0
RD 44,23,27648
s_add_u32 m0, s59, 8320
MAA 76,24,0
RD 48,23,28672
s_mov_b32 s58, 1179648
MAA 80,24,4
buffer_load_dwordx4 v5, s[24:27], s58 offen lds
MAA 64,20,4
RD 52,23,29952
v_mov_b32 v165, v166
MAA 68,20,8
RD 56,23,30976
v_mul_f32 v166, 0x3e8293ee, v166
MAA 84,24,8
ds_write_b128 v7, v[164:167]
MAA 88,24,12
buffer_load_dwordx4 v6, s[24:27], s58 offen offset:1024 lds
MAA 72,20,12
TR 64,25,37248
s_add_u32 m0, s59, 74880
s_waitcnt lgkmcnt(6)
MAA 104,28,12
TR 66,25,37760
s_mov_b32 s58, 131072
MAA 120,32,12
TR 68,25,37280
MAA 116,32,8
buffer_load_dwordx4 v5, s[24:27], s58 offen lds
MAA 100,28,8
TR 70,25,37792
MAA 96,28,4
RD 60,24,29696
MAA 112,32,4
TR 72,25,38272
MAA 108,32,0
buffer_load_dwordx4 v6, s[24:27], s58 offen offset:1024 lds
MAA 92,28,0
TR 74,25,38784
s_add_u32 m0, s59, 83200
MAA 156,28,16
TR 76,25,38304
s_mov_b32 s58, 262144
MAA 160,32,16
TR 78,25,38816
MAA 124,0,36
buffer_load_dwordx4 v5, s[24:27], s58 offen lds
MAA 140,0,40
TR 80,25,39296
MAA 144,4,40
TR 82,25,39808
MAA 128,4,36
TR 84,25,39328
MAA 132,8,36
buffer_load_dwordx4 v6, s[24:27], s58 offen offset:1024 lds
MAA 148,8,40
TR 86,25,39840
MAA 152,12,40
MAA 136,12,36
s_waitcnt vmcnt(18) lgkmcnt(8)
s_barrier
MAA 60,64,44
ds_write_b32 v17, v164
s_add_u32 m0, s59, 16640
MAA 76,68,44
ds_write_b32 v17, v165 offset:1024
s_mov_b32 s58, 1310720
MAA 80,68,48
buffer_load_dwordx4 v5, s[24:27], s58 offen lds
MAA 64,64,48
RD 0,23,36864
MAA 68,64,52
RD 4,23,37888
MAA 84,68,52
RD 8,23,39168
MAA 88,68,56
RD 12,23,40192
MAA 72,64,56
TR 20,25,49664
s_waitcnt lgkmcnt(7)
MAA 104,72,56
buffer_load_dwordx4 v6, s[24:27], s58 offen offset:1024 lds
MAA 120,76,56
TR 22,25,50176
s_add_u32 m0, s59, 91520
MAA 116,76,52
TR 24,25,49696
s_mov_b32 s58, 393216
MAA 100,72,52
TR 26,25,50208
MAA 96,72,48
RD 16,24,38912
MAA 112,76,48
TR 28,25,50688
MAA 108,76,44
buffer_load_dwordx4 v5, s[24:27], s58 offen lds
MAA 92,72,44
TR 30,25,51200
MAA 156,72,60
TR 32,25,50720
MAA 160,76,60
TR 34,25,51232
MAA 124,44,80
TR 36,25,51712
MAA 140,44,84
TR 38,25,52224
MAA 144,48,84
buffer_load_dwordx4 v6, s[24:27], s58 offen offset:1024 lds
MAA 128,48,80
TR 40,25,51744
MAA 132,52,80
TR 42,25,52256
MAA 148,52,84
MAA 152,56,84
MAA 136,56,80
s_waitcnt vmcnt(16) lgkmcnt(8)
s_barrier
MAA 60,20,0
RD 44,23,46080
s_add_u32 m0, s59, 24960
MAA 76,24,0
RD 48,23,47104
s_mov_b32 s58, 1441792
MAA 80,24,4
buffer_load_dwordx4 v5, s[24:27], s58 offen lds
MAA 64,20,4
RD 52,23,48384
MAA 68,20,8
RD 56,23,49408
MAA 84,24,8
TR 64,25,62080
MAA 88,24,12
buffer_load_dwordx4 v6, s[24:27], s58 offen offset:1024 lds
MAA 72,20,12
TR 66,25,62592
s_add_u32 m0, s59, 99840
s_waitcnt lgkmcnt(6)
MAA 104,28,12
TR 68,25,62112
s_mov_b32 s58, 524288
MAA 120,32,12
TR 70,25,62624
MAA 116,32,8
buffer_load_dwordx4 v5, s[24:27], s58 offen lds
MAA 100,28,8
RD 60,24,48128
MAA 96,28,4
TR 72,25,63104
MAA 112,32,4
TR 74,25,63616
MAA 108,32,0
buffer_load_dwordx4 v6, s[24:27], s58 offen offset:1024 lds
MAA 92,28,0
TR 76,25,63136
s_add_u32 m0, s59, 108160
MAA 156,28,16
TR 78,25,63648
s_mov_b32 s58, 655360
MAA 160,32,16
TR 80,25,64128
MAA 124,0,36
buffer_load_dwordx4 v5, s[24:27], s58 offen lds
MAA 140,0,40
TR 82,25,64640
MAA 144,4,40
TR 84,25,64160
MAA 128,4,36
TR 86,25,64672
MAA 132,8,36
buffer_load_dwordx4 v6, s[24:27], s58 offen offset:1024 lds
MAA 148,8,40
MAA 152,12,40
MAA 136,12,36
s_waitcnt lgkmcnt(0)
s_barrier
MAA 156,72,60
ds_read_b128 v[232:235], v10 offset:768
s_add_u32 m0, s59, 33280
MAA 160,76,60
ds_read_b128 v[236:239], v10 offset:2816
s_mov_b32 s58, 1572864
MAA 104,72,56
ds_read_b128 v[228:231], v10 offset:512
MAA 120,76,56
ds_read_b128 v[224:227], v10 offset:256
MAA 136,56,80
ds_read_b128 v[220:223], v10
MAA 152,56,84
ds_read_b128 v[240:243], v11 offset:192
MAA 100,72,52
ds_read_b128 v[244:247], v11 offset:1216
MAA 116,76,52
buffer_load_dwordx4 v5, s[24:27], s58 offen lds
MAA 96,72,48
ds_read_b128 v[18:21], v11 offset:128
ds_read_b128 v[22:25], v11 offset:1152
s_waitcnt lgkmcnt(8)
v_pk_fma_f32 v[104:105], v[36:37], v[232:233], v[104:105] op_sel_hi:[1,0,1]
v_pk_mul_f32 v[104:105], v[104:105], v[232:233] op_sel:[0,1] op_sel_hi:[1,1]
v_pk_fma_f32 v[106:107], v[38:39], v[232:233], v[106:107] op_sel_hi:[1,0,1]
v_pk_mul_f32 v[106:107], v[106:107], v[232:233] op_sel:[0,1] op_sel_hi:[1,1]
v_pk_fma_f32 v[120:121], v[40:41], v[232:233], v[120:121] op_sel_hi:[1,0,1]
v_pk_mul_f32 v[120:121], v[120:121], v[232:233] op_sel:[0,1] op_sel_hi:[1,1]
v_pk_fma_f32 v[122:123], v[42:43], v[232:233], v[122:123] op_sel_hi:[1,0,1]
v_pk_mul_f32 v[122:123], v[122:123], v[232:233] op_sel:[0,1] op_sel_hi:[1,1]
s_waitcnt lgkmcnt(6)
v_pk_fma_f32 v[100:101], v[36:37], v[228:229], v[100:101] op_sel_hi:[1,0,1]
v_pk_mul_f32 v[100:101], v[100:101], v[228:229] op_sel:[0,1] op_sel_hi:[1,1]
v_pk_fma_f32 v[102:103], v[38:39], v[228:229], v[102:103] op_sel_hi:[1,0,1]
v_pk_mul_f32 v[102:103], v[102:103], v[228:229] op_sel:[0,1] op_sel_hi:[1,1]
v_pk_fma_f32 v[116:117], v[40:41], v[228:229], v[116:117] op_sel_hi:[1,0,1]
v_pk_mul_f32 v[116:117], v[116:117], v[228:229] op_sel:[0,1] op_sel_hi:[1,1]
s_waitcnt lgkmcnt(3)
v_pk_fma_f32 v[136:137], v[240:241], v[44:45], v[136:137] op_sel_hi:[1,0,1]
v_pk_fma_f32 v[138:139], v[242:243], v[44:45], v[138:139] op_sel_hi:[1,0,1]
v_pk_fma_f32 v[152:153], v[240:241], v[44:45], v[152:153] op_sel:[0,1,0] op_sel_hi:[1,1,1]
v_pk_fma_f32 v[154:155], v[242:243], v[44:45], v[154:155] op_sel:[0,1,0] op_sel_hi:[1,1,1]
s_waitcnt lgkmcnt(2)
v_pk_mul_f32 v[136:137], v[136:137], v[244:245]
v_pk_mul_f32 v[138:139], v[138:139], v[246:247]
v_pk_mul_f32 v[152:153], v[152:153], v[244:245]
v_pk_mul_f32 v[154:155], v[154:155], v[246:247]
v_pk_fma_f32 v[118:119], v[42:43], v[228:229], v[118:119] op_sel_hi:[1,0,1]
v_pk_mul_f32 v[118:119], v[118:119], v[228:229] op_sel:[0,1] op_sel_hi:[1,1]
v_pk_fma_f32 v[96:97], v[36:37], v[224:225], v[96:97] op_sel_hi:[1,0,1]
v_pk_mul_f32 v[96:97], v[96:97], v[224:225] op_sel:[0,1] op_sel_hi:[1,1]
v_pk_fma_f32 v[98:99], v[38:39], v[224:225], v[98:99] op_sel_hi:[1,0,1]
v_pk_mul_f32 v[98:99], v[98:99], v[224:225] op_sel:[0,1] op_sel_hi:[1,1]
v_pk_fma_f32 v[156:157], v[36:37], v[236:237], v[156:157] op_sel_hi:[1,0,1]
v_pk_mul_f32 v[156:157], v[156:157], v[236:237] op_sel:[0,1] op_sel_hi:[1,1]
v_pk_fma_f32 v[158:159], v[38:39], v[236:237], v[158:159] op_sel_hi:[1,0,1]
v_pk_mul_f32 v[158:159], v[158:159], v[236:237] op_sel:[0,1] op_sel_hi:[1,1]
v_pk_fma_f32 v[160:161], v[40:41], v[236:237], v[160:161] op_sel_hi:[1,0,1]
v_pk_mul_f32 v[160:161], v[160:161], v[236:237] op_sel:[0,1] op_sel_hi:[1,1]
v_pk_fma_f32 v[162:163], v[42:43], v[236:237], v[162:163] op_sel_hi:[1,0,1]
v_pk_mul_f32 v[162:163], v[162:163], v[236:237] op_sel:[0,1] op_sel_hi:[1,1]
v_cvt_pk_bf16_f32 v196, v104, v105
v_cvt_pk_bf16_f32 v197, v106, v107
MAA 112,76,48
buffer_load_dwordx4 v6, s[24:27], s58 offen offset:1024 lds
MAA 92,72,44
ds_read_b128 v[240:243], v11 offset:64
v_cvt_pk_bf16_f32 v198, v120, v121
MAA 108,76,44
ds_read_b128 v[244:247], v11 offset:1088
v_cvt_pk_bf16_f32 v199, v122, v123
MAA 72,64,56
ds_write_b128 v8, v[196:199]
v_cvt_pk_bf16_f32 v208, v136, v137
MAA 88,68,56
s_add_u32 m0, s59, 41600
v_cvt_pk_bf16_f32 v209, v138, v139
v_cvt_pk_bf16_f32 v218, v152, v153
v_cvt_pk_bf16_f32 v219, v154, v155
ds_write_b64 v8, v[208:209] offset:1024
v_pk_fma_f32 v[72:73], v[28:29], v[232:233], v[72:73] op_sel_hi:[1,0,1]
v_pk_fma_f32 v[74:75], v[30:31], v[232:233], v[74:75] op_sel_hi:[1,0,1]
s_nop 0
v_pk_fma_f32 v[88:89], v[32:33], v[232:233], v[88:89] op_sel_hi:[1,0,1]
v_pk_fma_f32 v[90:91], v[34:35], v[232:233], v[90:91] op_sel_hi:[1,0,1]
v_pk_fma_f32 v[112:113], v[40:41], v[224:225], v[112:113] op_sel_hi:[1,0,1]
v_pk_mul_f32 v[112:113], v[112:113], v[224:225] op_sel:[0,1] op_sel_hi:[1,1]
v_pk_fma_f32 v[114:115], v[42:43], v[224:225], v[114:115] op_sel_hi:[1,0,1]
v_pk_mul_f32 v[114:115], v[114:115], v[224:225] op_sel:[0,1] op_sel_hi:[1,1]
v_pk_fma_f32 v[92:93], v[36:37], v[220:221], v[92:93] op_sel_hi:[1,0,1]
v_pk_mul_f32 v[92:93], v[92:93], v[220:221] op_sel:[0,1] op_sel_hi:[1,1]
v_pk_fma_f32 v[94:95], v[38:39], v[220:221], v[94:95] op_sel_hi:[1,0,1]
v_pk_mul_f32 v[94:95], v[94:95], v[220:221] op_sel:[0,1] op_sel_hi:[1,1]
v_pk_fma_f32 v[108:109], v[40:41], v[220:221], v[108:109] op_sel_hi:[1,0,1]
v_pk_mul_f32 v[108:109], v[108:109], v[220:221] op_sel:[0,1] op_sel_hi:[1,1]
v_pk_fma_f32 v[110:111], v[42:43], v[220:221], v[110:111] op_sel_hi:[1,0,1]
v_pk_mul_f32 v[110:111], v[110:111], v[220:221] op_sel:[0,1] op_sel_hi:[1,1]
ds_write_b64 v8, v[218:219] offset:1032
s_nop 0
MAA 132,52,80
s_mov_b32 s58, 1703936
v_cvt_pk_bf16_f32 v192, v100, v101
v_cvt_pk_bf16_f32 v193, v102, v103
MAA 148,52,84
buffer_load_dwordx4 v5, s[24:27], s58 offen lds
MAA 68,64,52
v_cvt_pk_bf16_f32 v194, v116, v117
v_cvt_pk_bf16_f32 v195, v118, v119
MAA 84,68,52
v_cvt_pk_bf16_f32 v176, v72, v73
v_cvt_pk_bf16_f32 v177, v74, v75
MAA 128,48,80
v_cvt_pk_bf16_f32 v178, v88, v89
v_cvt_pk_bf16_f32 v179, v90, v91
v_cvt_pk_bf16_f32 v188, v96, v97
v_cvt_pk_bf16_f32 v189, v98, v99
v_cvt_pk_bf16_f32 v190, v112, v113
s_waitcnt lgkmcnt(6)
v_pk_fma_f32 v[132:133], v[18:19], v[44:45], v[132:133] op_sel_hi:[1,0,1]
s_waitcnt lgkmcnt(5)
v_pk_mul_f32 v[132:133], v[132:133], v[22:23]
v_pk_fma_f32 v[134:135], v[20:21], v[44:45], v[134:135] op_sel_hi:[1,0,1]
v_pk_mul_f32 v[134:135], v[134:135], v[24:25]
v_pk_fma_f32 v[148:149], v[18:19], v[44:45], v[148:149] op_sel:[0,1,0] op_sel_hi:[1,1,1]
v_pk_mul_f32 v[148:149], v[148:149], v[22:23]
v_pk_fma_f32 v[150:151], v[20:21], v[44:45], v[150:151] op_sel:[0,1,0] op_sel_hi:[1,1,1]
v_pk_mul_f32 v[150:151], v[150:151], v[24:25]
v_pk_fma_f32 v[68:69], v[28:29], v[228:229], v[68:69] op_sel_hi:[1,0,1]
v_pk_fma_f32 v[70:71], v[30:31], v[228:229], v[70:71] op_sel_hi:[1,0,1]
v_pk_fma_f32 v[84:85], v[32:33], v[228:229], v[84:85] op_sel_hi:[1,0,1]
v_pk_fma_f32 v[86:87], v[34:35], v[228:229], v[86:87] op_sel_hi:[1,0,1]
s_waitcnt lgkmcnt(4)
v_pk_fma_f32 v[128:129], v[240:241], v[44:45], v[128:129] op_sel_hi:[1,0,1]
s_waitcnt lgkmcnt(3)
v_pk_mul_f32 v[128:129], v[128:129], v[244:245]
v_pk_fma_f32 v[130:131], v[242:243], v[44:45], v[130:131] op_sel_hi:[1,0,1]
v_pk_mul_f32 v[130:131], v[130:131], v[246:247]
s_waitcnt lgkmcnt(0)
s_barrier
v_cvt_pk_bf16_f32 v206, v132, v133
MAA 144,48,84
ds_read_b64 v[200:201], v9 offset:1024
v_cvt_pk_bf16_f32 v207, v134, v135
MAA 64,64,48
ds_read_b64 v[210:211], v9 offset:1032
v_cvt_pk_bf16_f32 v216, v148, v149
MAA 80,68,48
buffer_load_dwordx4 v6, s[24:27], s58 offen offset:1024 lds
MAA 124,44,80
ds_read_b128 v[18:21], v11
s_add_u32 m0, s59, 49920
MAA 140,44,84
ds_read_b128 v[22:25], v11 offset:1024
s_mov_b32 s58, 1835008
MAA 60,64,44
v_cvt_pk_bf16_f32 v217, v150, v151
v_cvt_pk_bf16_f32 v191, v114, v115
MAA 76,68,44
buffer_load_dwordx4 v5, s[24:27], s58 offen lds
v_cvt_pk_bf16_f32 v172, v68, v69
v_cvt_pk_bf16_f32 v173, v70, v71
v_cvt_pk_bf16_f32 v174, v84, v85
v_pk_fma_f32 v[144:145], v[240:241], v[44:45], v[144:145] op_sel:[0,1,0] op_sel_hi:[1,1,1]
v_pk_mul_f32 v[144:145], v[144:145], v[244:245]
v_pk_fma_f32 v[146:147], v[242:243], v[44:45], v[146:147] op_sel:[0,1,0] op_sel_hi:[1,1,1]
v_pk_mul_f32 v[146:147], v[146:147], v[246:247]
v_pk_fma_f32 v[64:65], v[28:29], v[224:225], v[64:65] op_sel_hi:[1,0,1]
v_pk_fma_f32 v[66:67], v[30:31], v[224:225], v[66:67] op_sel_hi:[1,0,1]
v_pk_fma_f32 v[80:81], v[32:33], v[224:225], v[80:81] op_sel_hi:[1,0,1]
v_pk_fma_f32 v[82:83], v[34:35], v[224:225], v[82:83] op_sel_hi:[1,0,1]
v_pk_fma_f32 v[60:61], v[28:29], v[220:221], v[60:61] op_sel_hi:[1,0,1]
v_pk_fma_f32 v[62:63], v[30:31], v[220:221], v[62:63] op_sel_hi:[1,0,1]
v_pk_fma_f32 v[76:77], v[32:33], v[220:221], v[76:77] op_sel_hi:[1,0,1]
v_pk_fma_f32 v[78:79], v[34:35], v[220:221], v[78:79] op_sel_hi:[1,0,1]
v_cvt_pk_bf16_f32 v175, v86, v87
v_cvt_pk_bf16_f32 v204, v128, v129
v_mfma_f32_16x16x32_bf16 v[104:107], v[192:195], v[176:179], v[46:49]
buffer_load_dwordx4 v6, s[24:27], s58 offen offset:1024 lds
v_mfma_f32_16x16x32_bf16 v[120:123], v[196:199], v[176:179], v[50:53]
s_add_u32 m0, s59, 116480
s_mov_b32 s58, 786432
v_cvt_pk_bf16_f32 v205, v130, v131
v_mfma_f32_16x16x32_bf16 v[100:103], v[188:191], v[172:175], v[46:49]
s_nop 1
v_max3_f32 v88, v104, v105, v106
v_cvt_pk_bf16_f32 v214, v144, v145
v_mfma_f32_16x16x32_bf16 v[116:119], v[192:195], v[172:175], v[50:53]
v_max3_f32 v89, v107, v120, v121
v_max3_f32 v88, v88, v122, v123
v_max_f32 v90, v88, v89
buffer_load_dwordx4 v5, s[24:27], s58 offen lds
v_max_f32 v89, v88, v89
v_cvt_pk_bf16_f32 v215, v146, v147
v_max3_f32 v84, v100, v101, v102
v_permlane16_swap_b32 v90, v89
v_max3_f32 v85, v103, v116, v117
v_max_f32 v88, v90, v89
v_max_f32 v89, v90, v89
v_max3_f32 v84, v84, v118, v119
v_max_f32 v86, v84, v85
v_permlane32_swap_b32 v88, v89
v_max_f32 v85, v84, v85
buffer_load_dwordx4 v6, s[24:27], s58 offen offset:1024 lds
s_add_u32 m0, s59, 124800
s_mov_b32 s58, 917504
v_max_f32 v88, v88, v89
v_mul_f32 v88, v88, v234
v_pk_fma_f32 v[104:105], v[104:105], v[234:235], v[88:89] op_sel_hi:[1,0,0] neg_lo:[0,0,1] neg_hi:[0,0,1]
v_pk_fma_f32 v[106:107], v[106:107], v[234:235], v[88:89] op_sel_hi:[1,0,0] neg_lo:[0,0,1] neg_hi:[0,0,1]
v_pk_fma_f32 v[120:121], v[120:121], v[234:235], v[88:89] op_sel_hi:[1,0,0] neg_lo:[0,0,1] neg_hi:[0,0,1]
v_pk_fma_f32 v[122:123], v[122:123], v[234:235], v[88:89] op_sel_hi:[1,0,0] neg_lo:[0,0,1] neg_hi:[0,0,1]
v_exp_f32 v104, v104
v_exp_f32 v105, v105
v_exp_f32 v106, v106
v_exp_f32 v107, v107
v_exp_f32 v120, v120
v_exp_f32 v121, v121
v_exp_f32 v122, v122
v_exp_f32 v123, v123
v_cvt_pk_bf16_f32 v72, v104, v105
buffer_load_dwordx4 v5, s[24:27], s58 offen lds
v_cvt_pk_bf16_f32 v73, v106, v107
v_cvt_pk_bf16_f32 v74, v120, v121
v_cvt_pk_bf16_f32 v75, v122, v123
s_waitcnt lgkmcnt(1)
v_pk_fma_f32 v[124:125], v[18:19], v[44:45], v[124:125] op_sel_hi:[1,0,1]
s_waitcnt lgkmcnt(0)
v_pk_mul_f32 v[124:125], v[124:125], v[22:23]
v_pk_fma_f32 v[126:127], v[20:21], v[44:45], v[126:127] op_sel_hi:[1,0,1]
v_pk_mul_f32 v[126:127], v[126:127], v[24:25]
v_pk_fma_f32 v[140:141], v[18:19], v[44:45], v[140:141] op_sel:[0,1,0] op_sel_hi:[1,1,1]
v_pk_mul_f32 v[140:141], v[140:141], v[22:23]
v_pk_fma_f32 v[142:143], v[20:21], v[44:45], v[142:143] op_sel:[0,1,0] op_sel_hi:[1,1,1]
v_pk_mul_f32 v[142:143], v[142:143], v[24:25]
v_permlane16_swap_b32 v86, v85
s_nop 0
v_mfma_f32_16x16x32_bf16 v[88:91], v[248:251], v[72:75], 0
buffer_load_dwordx4 v6, s[24:27], s58 offen offset:1024 lds
v_mfma_f32_16x16x32_bf16 v[104:107], v[206:209], v[72:75], 0
v_max_f32 v84, v86, v85
v_max_f32 v85, v86, v85
v_mfma_f32_16x16x32_bf16 v[120:123], v[216:219], v[72:75], 0
s_nop 2
v_rcp_f32 v88, v88
v_permlane32_swap_b32 v84, v85
v_cvt_pk_bf16_f32 v184, v92, v93
v_pk_mul_f32 v[104:105], v[104:105], v[88:89] op_sel_hi:[1,0]
v_pk_mul_f32 v[106:107], v[106:107], v[88:89] op_sel_hi:[1,0]
v_pk_mul_f32 v[120:121], v[120:121], v[88:89] op_sel_hi:[1,0]
v_pk_mul_f32 v[122:123], v[122:123], v[88:89] op_sel_hi:[1,0]
v_cvt_pk_bf16_f32 v176, v104, v105
v_cvt_pk_bf16_f32 v177, v106, v107
v_cvt_pk_bf16_f32 v178, v120, v121
v_cvt_pk_bf16_f32 v179, v122, v123
buffer_store_dwordx4 v[176:179], v4, s[16:19], s74 offen offset:3072 sc1
v_max_f32 v84, v84, v85
v_mul_f32 v84, v84, v230
v_pk_fma_f32 v[100:101], v[100:101], v[230:231], v[84:85] op_sel_hi:[1,0,0] neg_lo:[0,0,1] neg_hi:[0,0,1]
v_pk_fma_f32 v[102:103], v[102:103], v[230:231], v[84:85] op_sel_hi:[1,0,0] neg_lo:[0,0,1] neg_hi:[0,0,1]
v_pk_fma_f32 v[116:117], v[116:117], v[230:231], v[84:85] op_sel_hi:[1,0,0] neg_lo:[0,0,1] neg_hi:[0,0,1]
v_pk_fma_f32 v[118:119], v[118:119], v[230:231], v[84:85] op_sel_hi:[1,0,0] neg_lo:[0,0,1] neg_hi:[0,0,1]
v_exp_f32 v100, v100
v_exp_f32 v101, v101
v_exp_f32 v102, v102
v_exp_f32 v103, v103
v_exp_f32 v116, v116
v_exp_f32 v117, v117
v_exp_f32 v118, v118
v_exp_f32 v119, v119
v_cvt_pk_bf16_f32 v68, v100, v101
v_cvt_pk_bf16_f32 v69, v102, v103
v_cvt_pk_bf16_f32 v70, v116, v117
v_cvt_pk_bf16_f32 v71, v118, v119
v_cvt_pk_bf16_f32 v185, v94, v95
v_cvt_pk_bf16_f32 v186, v108, v109
v_mfma_f32_16x16x32_bf16 v[84:87], v[248:251], v[68:71], 0
v_cvt_pk_bf16_f32 v187, v110, v111
v_cvt_pk_bf16_f32 v168, v64, v65
v_mfma_f32_16x16x32_bf16 v[100:103], v[204:207], v[68:71], 0
v_cvt_pk_bf16_f32 v169, v66, v67
v_cvt_pk_bf16_f32 v170, v80, v81
v_mfma_f32_16x16x32_bf16 v[116:119], v[214:217], v[68:71], 0
s_nop 1
v_rcp_f32 v84, v84
v_cvt_pk_bf16_f32 v171, v82, v83
v_cvt_pk_bf16_f32 v202, v124, v125
v_cvt_pk_bf16_f32 v203, v126, v127
v_pk_mul_f32 v[100:101], v[100:101], v[84:85] op_sel_hi:[1,0]
v_pk_mul_f32 v[102:103], v[102:103], v[84:85] op_sel_hi:[1,0]
v_pk_mul_f32 v[116:117], v[116:117], v[84:85] op_sel_hi:[1,0]
v_pk_mul_f32 v[118:119], v[118:119], v[84:85] op_sel_hi:[1,0]
v_cvt_pk_bf16_f32 v172, v100, v101
v_cvt_pk_bf16_f32 v173, v102, v103
v_mfma_f32_16x16x32_bf16 v[96:99], v[184:187], v[168:171], v[46:49]
v_cvt_pk_bf16_f32 v174, v116, v117
v_cvt_pk_bf16_f32 v175, v118, v119
v_mfma_f32_16x16x32_bf16 v[112:115], v[188:191], v[168:171], v[50:53]
buffer_store_dwordx4 v[172:175], v4, s[16:19], s74 offen offset:2048 sc1
v_cvt_pk_bf16_f32 v212, v140, v141
v_cvt_pk_bf16_f32 v213, v142, v143
s_nop 1
v_max3_f32 v80, v96, v97, v98
v_cvt_pk_bf16_f32 v180, v156, v157
v_cvt_pk_bf16_f32 v181, v158, v159
v_max3_f32 v81, v99, v112, v113
v_max3_f32 v80, v80, v114, v115
v_max_f32 v82, v80, v81
v_max_f32 v81, v80, v81
v_cvt_pk_bf16_f32 v182, v160, v161
v_cvt_pk_bf16_f32 v183, v162, v163
v_permlane16_swap_b32 v82, v81
v_cvt_pk_bf16_f32 v164, v60, v61
v_max_f32 v80, v82, v81
v_max_f32 v81, v82, v81
v_cvt_pk_bf16_f32 v165, v62, v63
v_cvt_pk_bf16_f32 v166, v76, v77
v_permlane32_swap_b32 v80, v81
v_cvt_pk_bf16_f32 v167, v78, v79
v_max_f32 v80, v80, v81
v_mul_f32 v80, v80, v226
v_mfma_f32_16x16x32_bf16 v[92:95], v[180:183], v[164:167], v[54:57]
v_mfma_f32_16x16x32_bf16 v[108:111], v[184:187], v[164:167], v[50:53]
s_nop 6
v_max3_f32 v76, v92, v93, v94
v_pk_fma_f32 v[96:97], v[96:97], v[226:227], v[80:81] op_sel_hi:[1,0,0] neg_lo:[0,0,1] neg_hi:[0,0,1]
v_pk_fma_f32 v[98:99], v[98:99], v[226:227], v[80:81] op_sel_hi:[1,0,0] neg_lo:[0,0,1] neg_hi:[0,0,1]
v_pk_fma_f32 v[112:113], v[112:113], v[226:227], v[80:81] op_sel_hi:[1,0,0] neg_lo:[0,0,1] neg_hi:[0,0,1]
v_pk_fma_f32 v[114:115], v[114:115], v[226:227], v[80:81] op_sel_hi:[1,0,0] neg_lo:[0,0,1] neg_hi:[0,0,1]
v_exp_f32 v96, v96
v_exp_f32 v97, v97
v_exp_f32 v98, v98
v_exp_f32 v99, v99
v_exp_f32 v112, v112
v_exp_f32 v113, v113
v_exp_f32 v114, v114
v_exp_f32 v115, v115
v_cvt_pk_bf16_f32 v64, v96, v97
v_cvt_pk_bf16_f32 v65, v98, v99
v_cvt_pk_bf16_f32 v66, v112, v113
v_cvt_pk_bf16_f32 v67, v114, v115
v_max3_f32 v77, v95, v108, v109
v_max3_f32 v76, v76, v110, v111
v_mfma_f32_16x16x32_bf16 v[80:83], v[248:251], v[64:67], 0
v_max_f32 v78, v76, v77
v_max_f32 v77, v76, v77
v_mfma_f32_16x16x32_bf16 v[96:99], v[202:205], v[64:67], 0
s_nop 0
v_permlane16_swap_b32 v78, v77
v_mfma_f32_16x16x32_bf16 v[112:115], v[212:215], v[64:67], 0
s_nop 1
v_rcp_f32 v80, v80
v_max_f32 v76, v78, v77
v_max_f32 v77, v78, v77
v_pk_mul_f32 v[96:97], v[96:97], v[80:81] op_sel_hi:[1,0]
v_pk_mul_f32 v[98:99], v[98:99], v[80:81] op_sel_hi:[1,0]
s_nop 0
v_pk_mul_f32 v[112:113], v[112:113], v[80:81] op_sel_hi:[1,0]
v_pk_mul_f32 v[114:115], v[114:115], v[80:81] op_sel_hi:[1,0]
v_cvt_pk_bf16_f32 v168, v96, v97
v_cvt_pk_bf16_f32 v169, v98, v99
v_cvt_pk_bf16_f32 v170, v112, v113
v_cvt_pk_bf16_f32 v171, v114, v115
buffer_store_dwordx4 v[168:171], v4, s[16:19], s74 offen offset:1024 sc1
v_permlane32_swap_b32 v76, v77
v_max_f32 v76, v76, v77
v_mul_f32 v76, v76, v222
v_pk_fma_f32 v[92:93], v[92:93], v[222:223], v[76:77] op_sel_hi:[1,0,0] neg_lo:[0,0,1] neg_hi:[0,0,1]
v_pk_fma_f32 v[94:95], v[94:95], v[222:223], v[76:77] op_sel_hi:[1,0,0] neg_lo:[0,0,1] neg_hi:[0,0,1]
v_pk_fma_f32 v[108:109], v[108:109], v[222:223], v[76:77] op_sel_hi:[1,0,0] neg_lo:[0,0,1] neg_hi:[0,0,1]
v_pk_fma_f32 v[110:111], v[110:111], v[222:223], v[76:77] op_sel_hi:[1,0,0] neg_lo:[0,0,1] neg_hi:[0,0,1]
v_exp_f32 v92, v92
v_exp_f32 v93, v93
v_exp_f32 v94, v94
v_exp_f32 v95, v95
v_exp_f32 v108, v108
v_exp_f32 v109, v109
v_exp_f32 v110, v110
v_exp_f32 v111, v111
.Lpad14:
s_cbranch_execz .Lpad17
v_cvt_pk_bf16_f32 v60, v92, v93
v_cvt_pk_bf16_f32 v61, v94, v95
v_cvt_pk_bf16_f32 v62, v108, v109
v_cvt_pk_bf16_f32 v63, v110, v111
s_nop 1
v_mfma_f32_16x16x32_bf16 v[76:79], v[248:251], v[60:63], 0
v_mfma_f32_16x16x32_bf16 v[92:95], v[200:203], v[60:63], 0
v_mfma_f32_16x16x32_bf16 v[108:111], v[210:213], v[60:63], 0
s_nop 5
v_rcp_f32 v76, v76
s_nop 0
v_pk_mul_f32 v[92:93], v[92:93], v[76:77] op_sel_hi:[1,0]
v_pk_mul_f32 v[94:95], v[94:95], v[76:77] op_sel_hi:[1,0]
v_pk_mul_f32 v[108:109], v[108:109], v[76:77] op_sel_hi:[1,0]
v_pk_mul_f32 v[110:111], v[110:111], v[76:77] op_sel_hi:[1,0]
v_cvt_pk_bf16_f32 v164, v92, v93
v_cvt_pk_bf16_f32 v165, v94, v95
v_cvt_pk_bf16_f32 v166, v108, v109
v_cvt_pk_bf16_f32 v167, v110, v111
buffer_store_dwordx4 v[164:167], v4, s[16:19], s74 offen sc1
s_nop 1
s_branch .Lqkve56
.Lpad15:
s_cbranch_execz .Lpad18
.Lsp50:
s_mov_b32 s15, 0
.Lsp50l:
v_mov_b32 v25, 0
buffer_atomic_add v25, v22, s[16:19], s73 offen sc0
s_add_u32 s15, s15, 1
s_cmp_gt_u32 s15, 100000
s_waitcnt vmcnt(0)
s_cbranch_scc1 .Lsp50b
v_cmp_gt_u32 vcc, v23, v25
s_nop 0
s_cbranch_vccnz .Lsp50l
s_branch .Lsp50b
.Lxs51:
s_mov_b32 s15, 0
.Lxs51l:
v_mov_b32 v15, 0
buffer_atomic_add v15, v12, s[16:19], s70 offen sc0
s_add_u32 s15, s15, 1
s_cmp_gt_u32 s15, 100000
s_waitcnt vmcnt(0)
s_cbranch_scc1 .Lxs51b
v_cmp_ne_u32 vcc, 0, v15
s_nop 0
s_cbranch_vccz .Lxs51l
s_branch .Lxs51b
.Lqkv55:
.Lpad16:
s_cbranch_execz .Lpad19
s_add_u32 m0, s55, 36864
s_nop 0
buffer_load_dwordx4 v21, s[16:19], s52 offen sc1 lds
buffer_load_dwordx4 v21, s[16:19], s52 offen offset:1024 sc1 lds
buffer_load_dword v22, s[16:19], s52 offen offset:2048 sc1 lds
s_add_u32 s52, s52, 131072
s_add_u32 m0, s55, 46080
s_nop 0
buffer_load_dwordx4 v21, s[16:19], s52 offen sc1 lds
buffer_load_dwordx4 v21, s[16:19], s52 offen offset:1024 sc1 lds
buffer_load_dword v22, s[16:19], s52 offen offset:2048 sc1 lds
s_add_u32 s52, s52, 131072
s_add_u32 m0, s55, 0
s_nop 0
buffer_load_dwordx4 v21, s[16:19], s52 offen sc1 lds
buffer_load_dwordx4 v21, s[16:19], s52 offen offset:1024 sc1 lds
buffer_load_dword v22, s[16:19], s52 offen offset:2048 sc1 lds
s_add_u32 s52, s52, 131072
s_add_u32 m0, s55, 9216
s_nop 0
buffer_load_dwordx4 v21, s[16:19], s52 offen sc1 lds
buffer_load_dwordx4 v21, s[16:19], s52 offen offset:1024 sc1 lds
buffer_load_dword v22, s[16:19], s52 offen offset:2048 sc1 lds
s_add_u32 s52, s52, 131072
s_add_u32 m0, s55, 18432
s_nop 0
buffer_load_dwordx4 v21, s[16:19], s52 offen sc1 lds
buffer_load_dwordx4 v21, s[16:19], s52 offen offset:1024 sc1 lds
buffer_load_dword v22, s[16:19], s52 offen offset:2048 sc1 lds
s_add_u32 s52, s52, 131072
s_waitcnt vmcnt(12)
s_barrier
RD 0,23,36864
RD 4,23,37888
RD 8,23,39168
RD 12,23,40192
RD 16,24,38912
s_waitcnt lgkmcnt(0)
s_mov_b32 s15, -4
.p2align 6
.Lk58:
s_waitcnt vmcnt(9) lgkmcnt(8)
s_barrier
MAA 60,20,0
RD 44,23,46080
v_add_f32 v164, v164, v168
MAA 76,24,0
RD 48,23,47104
s_add_u32 m0, s56, 104832
MAA 80,24,4
buffer_load_dwordx4 v18, s[20:23], s54 offen lds
MAA 64,20,4
RD 52,23,48384
MAA 68,20,8
RD 56,23,49408
MAA 84,24,8
buffer_load_dwordx4 v19, s[20:23], s54 offen offset:1024 lds
MAA 88,24,12
TR 64,25,62080
v_add_f32 v165, v165, v169
MAA 72,20,12
TR 66,25,62592
s_waitcnt lgkmcnt(6)
MAA 104,28,12
buffer_load_dwordx4 v20, s[20:23], s54 offen offset:2048 lds
MAA 120,32,12
TR 68,25,62112
s_add_u32 s54, s54, 196608
MAA 116,32,8
TR 70,25,62624
MAA 100,28,8
RD 60,24,48128
s_add_u32 m0, s55, 27648
MAA 96,28,4
buffer_load_dwordx4 v21, s[16:19], s52 offen sc1 lds
MAA 112,32,4
TR 72,25,63104
MAA 108,32,0
TR 74,25,63616
v_add_f32 v166, v166, v170
MAA 92,28,0
buffer_load_dwordx4 v21, s[16:19], s52 offen offset:1024 sc1 lds
MAA 124,0,36
TR 76,25,63136
MAA 140,0,40
TR 78,25,63648
MAA 144,4,40
TR 80,25,64128
v_add_f32 v167, v167, v171
MAA 128,4,36
buffer_load_dword v22, s[16:19], s52 offen offset:2048 sc1 lds
MAA 132,8,36
TR 82,25,64640
s_add_u32 s52, s52, 131072
MAA 148,8,40
TR 84,25,64160
MAA 152,12,40
buffer_load_dword v27, v14, s[20:23], s44 offen
MAA 136,12,36
TR 86,25,64672
s_add_u32 s44, s44, 1572864
MAA 156,16,36
MAA 160,16,40
s_waitcnt vmcnt(13) lgkmcnt(8)
s_barrier
MAA 60,64,44
ds_read_b128 a[0:3], v23
MAA 76,68,44
RD 4,23,1024
s_add_u32 m0, s56, 117248
MAA 80,68,48
buffer_load_dwordx4 v18, s[20:23], s54 offen lds
MAA 64,64,48
RD 8,23,2304
MAA 68,64,52
RD 12,23,3328
MAA 84,68,52
buffer_load_dwordx4 v19, s[20:23], s54 offen offset:1024 lds
MAA 88,68,56
ds_read_b64_tr_b16 a[20:21], v25
MAA 72,64,56
TR 22,25,512
s_waitcnt lgkmcnt(6)
MAA 104,72,56
buffer_load_dwordx4 v20, s[20:23], s54 offen offset:2048 lds
MAA 120,76,56
TR 24,25,32
s_add_u32 s54, s54, 196608
MAA 116,76,52
TR 26,25,544
MAA 100,72,52
RD 16,24,2048
s_add_u32 m0, s55, 36864
MAA 96,72,48
buffer_load_dwordx4 v21, s[16:19], s52 offen sc1 lds
MAA 112,76,48
TR 28,25,1024
MAA 108,76,44
TR 30,25,1536
MAA 92,72,44
buffer_load_dwordx4 v21, s[16:19], s52 offen offset:1024 sc1 lds
MAA 124,44,80
TR 32,25,1056
MAA 140,44,84
TR 34,25,1568
MAA 144,48,84
TR 36,25,2048
MAA 128,48,80
buffer_load_dword v22, s[16:19], s52 offen offset:2048 sc1 lds
MAA 132,52,80
TR 38,25,2560
s_add_u32 s52, s52, 131072
MAA 148,52,84
TR 40,25,2080
MAA 152,56,84
buffer_load_dwordx4 v[168:171], v26, s[16:19], s75 offen sc1
MAA 136,56,80
TR 42,25,2592
MAA 156,60,80
MAA 160,60,84
s_waitcnt vmcnt(17) lgkmcnt(8)
s_barrier
MAA 60,20,0
RD 44,23,9216
MAA 76,24,0
RD 48,23,10240
s_add_u32 m0, s56, 129664
MAA 80,24,4
buffer_load_dwordx4 v18, s[20:23], s54 offen lds
MAA 64,20,4
RD 52,23,11520
MAA 68,20,8
RD 56,23,12544
MAA 84,24,8
TR 64,25,12416
MAA 88,24,12
buffer_load_dwordx4 v19, s[20:23], s54 offen offset:1024 lds
MAA 72,20,12
TR 66,25,12928
s_waitcnt lgkmcnt(6)
MAA 104,28,12
TR 68,25,12448
MAA 120,32,12
TR 70,25,12960
MAA 116,32,8
buffer_load_dwordx4 v20, s[20:23], s54 offen offset:2048 lds
MAA 100,28,8
RD 60,24,11264
s_add_u32 s54, s54, 196608
MAA 96,28,4
MAA 112,32,4
TR 72,25,13440
s_add_u32 m0, s55, 46080
MAA 108,32,0
buffer_load_dwordx4 v21, s[16:19], s52 offen sc1 lds
MAA 92,28,0
TR 74,25,13952
MAA 124,0,36
TR 76,25,13472
MAA 140,0,40
TR 78,25,13984
MAA 144,4,40
buffer_load_dwordx4 v21, s[16:19], s52 offen offset:1024 sc1 lds
MAA 128,4,36
TR 80,25,14464
MAA 132,8,36
TR 82,25,14976
MAA 148,8,40
TR 84,25,14496
MAA 152,12,40
buffer_load_dword v22, s[16:19], s52 offen offset:2048 sc1 lds
MAA 136,12,36
TR 86,25,15008
s_add_u32 s52, s52, 131072
MAA 156,16,36
MAA 160,16,40
s_waitcnt vmcnt(20) lgkmcnt(8)
s_barrier
MAA 60,64,44
RD 0,23,18432
v_add_f32 v164, v164, v172
MAA 76,68,44
RD 4,23,19456
s_add_u32 m0, s56, 67584
MAA 80,68,48
buffer_load_dwordx4 v18, s[20:23], s54 offen lds
MAA 64,64,48
RD 8,23,20736
MAA 68,64,52
RD 12,23,21760
MAA 84,68,52
TR 20,25,24832
MAA 88,68,56
buffer_load_dwordx4 v19, s[20:23], s54 offen offset:1024 lds
MAA 72,64,56
TR 22,25,25344
s_waitcnt lgkmcnt(6)
MAA 104,72,56
TR 24,25,24864
v_add_f32 v165, v165, v173
MAA 120,76,56
TR 26,25,25376
MAA 116,76,52
buffer_load_dwordx4 v20, s[20:23], s54 offen offset:2048 lds
MAA 100,72,52
RD 16,24,20480
s_add_u32 s54, s54, 196608
MAA 96,72,48
MAA 112,76,48
TR 28,25,25856
s_add_u32 m0, s55, 0
MAA 108,76,44
buffer_load_dwordx4 v21, s[16:19], s52 offen sc1 lds
MAA 92,72,44
TR 30,25,26368
v_add_f32 v166, v166, v174
MAA 124,44,80
TR 32,25,25888
MAA 140,44,84
TR 34,25,26400
MAA 144,48,84
buffer_load_dwordx4 v21, s[16:19], s52 offen offset:1024 sc1 lds
MAA 128,48,80
TR 36,25,26880
MAA 132,52,80
TR 38,25,27392
v_add_f32 v167, v167, v175
MAA 148,52,84
TR 40,25,26912
MAA 152,56,84
buffer_load_dword v22, s[16:19], s52 offen offset:2048 sc1 lds
MAA 136,56,80
TR 42,25,27424
s_add_u32 s52, s52, 131072
MAA 156,60,80
MAA 160,60,84
s_waitcnt vmcnt(20) lgkmcnt(8)
s_barrier
MAA 60,20,0
RD 44,23,27648
MAA 76,24,0
RD 48,23,28672
s_add_u32 m0, s56, 80000
MAA 80,24,4
buffer_load_dwordx4 v18, s[20:23], s54 offen lds
MAA 64,20,4
RD 52,23,29952
MAA 68,20,8
RD 56,23,30976
MAA 84,24,8
buffer_load_dwordx4 v19, s[20:23], s54 offen offset:1024 lds
MAA 88,24,12
TR 64,25,37248
MAA 72,20,12
TR 66,25,37760
s_waitcnt lgkmcnt(6)
MAA 104,28,12
buffer_load_dwordx4 v20, s[20:23], s54 offen offset:2048 lds
MAA 120,32,12
TR 68,25,37280
s_add_u32 s54, s54, 196608
MAA 116,32,8
TR 70,25,37792
MAA 100,28,8
RD 60,24,29696
s_add_u32 m0, s55, 9216
MAA 96,28,4
buffer_load_dwordx4 v21, s[16:19], s52 offen sc1 lds
MAA 112,32,4
TR 72,25,38272
MAA 108,32,0
TR 74,25,38784
MAA 92,28,0
buffer_load_dwordx4 v21, s[16:19], s52 offen offset:1024 sc1 lds
MAA 124,0,36
TR 76,25,38304
MAA 140,0,40
TR 78,25,38816
MAA 144,4,40
TR 80,25,39296
MAA 128,4,36
buffer_load_dword v22, s[16:19], s52 offen offset:2048 sc1 lds
MAA 132,8,36
TR 82,25,39808
s_add_u32 s52, s52, 131072
MAA 148,8,40
TR 84,25,39328
MAA 152,12,40
buffer_load_dwordx4 v[172:175], v26, s[16:19], s75 offen offset:1024 sc1
MAA 136,12,36
TR 86,25,39840
s_add_u32 s75, s75, 2048
MAA 156,16,36
MAA 160,16,40
s_waitcnt vmcnt(20) lgkmcnt(8)
s_barrier
MAA 60,64,44
RD 0,23,36864
MAA 76,68,44
RD 4,23,37888
s_add_u32 m0, s56, 92416
MAA 80,68,48
buffer_load_dwordx4 v18, s[20:23], s54 offen lds
MAA 64,64,48
RD 8,23,39168
MAA 68,64,52
RD 12,23,40192
MAA 84,68,52
TR 20,25,49664
MAA 88,68,56
buffer_load_dwordx4 v19, s[20:23], s54 offen offset:1024 lds
MAA 72,64,56
TR 22,25,50176
s_waitcnt lgkmcnt(6)
MAA 104,72,56
TR 24,25,49696
MAA 120,76,56
TR 26,25,50208
MAA 116,76,52
buffer_load_dwordx4 v20, s[20:23], s54 offen offset:2048 lds
MAA 100,72,52
RD 16,24,38912
s_add_u32 s54, s54, 196608
MAA 96,72,48
MAA 112,76,48
TR 28,25,50688
s_add_u32 m0, s55, 18432
MAA 108,76,44
buffer_load_dwordx4 v21, s[16:19], s52 offen sc1 lds
MAA 92,72,44
TR 30,25,51200
MAA 124,44,80
TR 32,25,50720
MAA 140,44,84
TR 34,25,51232
MAA 144,48,84
buffer_load_dwordx4 v21, s[16:19], s52 offen offset:1024 sc1 lds
MAA 128,48,80
TR 36,25,51712
MAA 132,52,80
TR 38,25,52224
MAA 148,52,84
TR 40,25,51744
MAA 152,56,84
buffer_load_dword v22, s[16:19], s52 offen offset:2048 sc1 lds
MAA 136,56,80
TR 42,25,52256
s_add_u32 s52, s52, 131072
MAA 156,60,80
s_add_u32 s15, s15, 1
MAA 160,60,84
s_cbranch_scc0 .Lk58
s_waitcnt vmcnt(19) lgkmcnt(8)
s_barrier
MAA 60,20,0
RD 44,23,46080
v_add_f32 v164, v164, v168
MAA 76,24,0
RD 48,23,47104
s_add_u32 m0, s56, 104832
MAA 80,24,4
buffer_load_dwordx4 v18, s[20:23], s54 offen lds
MAA 64,20,4
RD 52,23,48384
v_add_f32 v165, v165, v169
MAA 68,20,8
RD 56,23,49408
v_add_f32 v166, v166, v170
MAA 84,24,8
TR 64,25,62080
v_add_f32 v167, v167, v171
MAA 88,24,12
buffer_load_dwordx4 v19, s[20:23], s54 offen offset:1024 lds
MAA 72,20,12
TR 66,25,62592
s_waitcnt lgkmcnt(6)
MAA 104,28,12
TR 68,25,62112
MAA 120,32,12
TR 70,25,62624
MAA 116,32,8
buffer_load_dwordx4 v20, s[20:23], s54 offen offset:2048 lds
MAA 100,28,8
RD 60,24,48128
s_add_u32 s54, s54, 196608
MAA 96,28,4
TR 72,25,63104
s_add_u32 m0, s55, 27648
MAA 112,32,4
TR 74,25,63616
MAA 108,32,0
buffer_load_dwordx4 v21, s[16:19], s52 offen sc1 lds
MAA 92,28,0
TR 76,25,63136
MAA 124,0,36
TR 78,25,63648
MAA 140,0,40
TR 80,25,64128
MAA 144,4,40
buffer_load_dwordx4 v21, s[16:19], s52 offen offset:1024 sc1 lds
MAA 128,4,36
TR 82,25,64640
MAA 132,8,36
TR 84,25,64160
MAA 148,8,40
TR 86,25,64672
MAA 152,12,40
buffer_load_dword v22, s[16:19], s52 offen offset:2048 sc1 lds
MAA 136,12,36
s_add_u32 s52, s52, 131072
MAA 156,16,36
MAA 160,16,40
s_waitcnt vmcnt(19) lgkmcnt(8)
s_barrier
MAA 60,64,44
ds_read_b128 a[0:3], v23
MAA 76,68,44
RD 4,23,1024
s_add_u32 m0, s56, 117248
MAA 80,68,48
buffer_load_dwordx4 v18, s[20:23], s54 offen lds
MAA 64,64,48
RD 8,23,2304
MAA 68,64,52
RD 12,23,3328
MAA 84,68,52
ds_read_b64_tr_b16 a[20:21], v25
MAA 88,68,56
buffer_load_dwordx4 v19, s[20:23], s54 offen offset:1024 lds
MAA 72,64,56
TR 22,25,512
s_waitcnt lgkmcnt(6)
MAA 104,72,56
TR 24,25,32
MAA 120,76,56
TR 26,25,544
MAA 116,76,52
buffer_load_dwordx4 v20, s[20:23], s54 offen offset:2048 lds
MAA 100,72,52
RD 16,24,2048
s_add_u32 s54, s54, 196608
MAA 96,72,48
MAA 112,76,48
TR 28,25,1024
s_add_u32 m0, s55, 36864
MAA 108,76,44
buffer_load_dwordx4 v21, s[16:19], s52 offen sc1 lds
MAA 92,72,44
TR 30,25,1536
MAA 124,44,80
TR 32,25,1056
MAA 140,44,84
TR 34,25,1568
MAA 144,48,84
buffer_load_dwordx4 v21, s[16:19], s52 offen offset:1024 sc1 lds
MAA 128,48,80
TR 36,25,2048
MAA 132,52,80
TR 38,25,2560
MAA 148,52,84
TR 40,25,2080
.Lpad17:
s_cbranch_execz .Lnopoll53r
MAA 152,56,84
buffer_load_dword v22, s[16:19], s52 offen offset:2048 sc1 lds
MAA 136,56,80
TR 42,25,2592
s_add_u32 s52, s52, 131072
MAA 156,60,80
MAA 160,60,84
s_waitcnt vmcnt(19) lgkmcnt(8)
s_barrier
MAA 60,20,0
RD 44,23,9216
s_waitcnt vmcnt(18)
v_add_f32 v164, v164, v172
MAA 76,24,0
RD 48,23,10240
s_add_u32 m0, s56, 129664
MAA 80,24,4
buffer_load_dwordx4 v18, s[20:23], s54 offen lds
MAA 64,20,4
RD 52,23,11520
v_add_f32 v165, v165, v173
MAA 68,20,8
RD 56,23,12544
v_add_f32 v166, v166, v174
MAA 84,24,8
TR 64,25,12416
v_add_f32 v167, v167, v175
MAA 88,24,12
buffer_load_dwordx4 v19, s[20:23], s54 offen offset:1024 lds
MAA 72,20,12
TR 66,25,12928
s_waitcnt lgkmcnt(6)
MAA 104,28,12
TR 68,25,12448
MAA 120,32,12
TR 70,25,12960
MAA 116,32,8
buffer_load_dwordx4 v20, s[20:23], s54 offen offset:2048 lds
MAA 100,28,8
RD 60,24,11264
s_add_u32 s54, s54, 196608
MAA 96,28,4
TR 72,25,13440
s_add_u32 m0, s55, 46080
MAA 112,32,4
TR 74,25,13952
MAA 108,32,0
buffer_load_dwordx4 v21, s[16:19], s52 offen sc1 lds
MAA 92,28,0
TR 76,25,13472
MAA 124,0,36
TR 78,25,13984
MAA 140,0,40
TR 80,25,14464
MAA 144,4,40
buffer_load_dwordx4 v21, s[16:19], s52 offen offset:1024 sc1 lds
MAA 128,4,36
TR 82,25,14976
MAA 132,8,36
TR 84,25,14496
MAA 148,8,40
TR 86,25,15008
MAA 152,12,40
buffer_load_dword v22, s[16:19], s52 offen offset:2048 sc1 lds
MAA 136,12,36
s_add_u32 s52, s52, 131072
v_permlane32_swap_b32 v164, v166
MAA 156,16,36
v_permlane32_swap_b32 v165, v167
MAA 160,16,40
s_waitcnt vmcnt(18) lgkmcnt(8)
s_barrier
MAA 60,64,44
RD 0,23,18432
v_add_f32 v164, v164, v166
MAA 76,68,44
RD 4,23,19456
s_add_u32 m0, s59, 0
MAA 80,68,48
RD 8,23,20736
s_mov_b32 s58, 1048576
MAA 64,64,48
buffer_load_dwordx4 v5, s[24:27], s58 offen lds
MAA 68,64,52
RD 12,23,21760
v_add_f32 v165, v165, v167
MAA 84,68,52
TR 20,25,24832
v_mul_f32 v164, 0xba800000, v164
MAA 88,68,56
TR 22,25,25344
v_mul_f32 v165, 0x3a800000, v165
MAA 72,64,56
buffer_load_dwordx4 v6, s[24:27], s58 offen offset:1024 lds
s_waitcnt lgkmcnt(6)
MAA 104,72,56
TR 24,25,24864
s_add_u32 m0, s59, 58240
MAA 120,76,56
TR 26,25,25376
s_mov_b32 s58, 1966080
MAA 116,76,52
RD 16,24,20480
v_fma_f32 v165, -v164, v164, v165
MAA 100,72,52
buffer_load_dwordx4 v5, s[24:27], s58 offen lds
MAA 96,72,48
TR 28,25,25856
v_max_f32 v165, 0, v165
MAA 112,76,48
TR 30,25,26368
v_add_f32 v165, 0x3727c5ac, v165
MAA 108,76,44
TR 32,25,25888
MAA 92,72,44
buffer_load_dwordx4 v6, s[24:27], s58 offen offset:1024 lds
MAA 124,44,80
TR 34,25,26400
s_add_u32 m0, s59, 66560
MAA 140,44,84
TR 36,25,26880
s_mov_b32 s58, 0
MAA 144,48,84
TR 38,25,27392
MAA 128,48,80
buffer_load_dwordx4 v5, s[24:27], s58 offen lds
MAA 132,52,80
TR 40,25,26912
MAA 148,52,84
TR 42,25,27424
MAA 152,56,84
v_rsq_f32 v166, v165
MAA 136,56,80
buffer_load_dwordx4 v6, s[24:27], s58 offen offset:1024 lds
MAA 156,60,80
MAA 160,60,84
s_waitcnt vmcnt(18) lgkmcnt(8)
s_barrier
MAA 60,20,0
RD 44,23,27648
v_mov_b32 v165, v166
MAA 76,24,0
RD 48,23,28672
s_add_u32 m0, s59, 8320
MAA 80,24,4
RD 52,23,29952
s_mov_b32 s58, 1179648
MAA 64,20,4
buffer_load_dwordx4 v5, s[24:27], s58 offen lds
MAA 68,20,8
RD 56,23,30976
v_mul_f32 v166, 0x3e8293ee, v166
MAA 84,24,8
ds_write_b128 v7, v[164:167]
MAA 88,24,12
TR 64,25,37248
MAA 72,20,12
buffer_load_dwordx4 v6, s[24:27], s58 offen offset:1024 lds
s_waitcnt lgkmcnt(6)
MAA 104,28,12
TR 66,25,37760
s_add_u32 m0, s59, 74880
MAA 120,32,12
TR 68,25,37280
s_mov_b32 s58, 131072
MAA 116,32,8
TR 70,25,37792
MAA 100,28,8
buffer_load_dwordx4 v5, s[24:27], s58 offen lds
MAA 96,28,4
RD 60,24,29696
MAA 112,32,4
TR 72,25,38272
MAA 108,32,0
TR 74,25,38784
MAA 92,28,0
buffer_load_dwordx4 v6, s[24:27], s58 offen offset:1024 lds
MAA 124,0,36
TR 76,25,38304
s_add_u32 m0, s59, 83200
MAA 140,0,40
TR 78,25,38816
s_mov_b32 s58, 262144
MAA 144,4,40
TR 80,25,39296
MAA 128,4,36
buffer_load_dwordx4 v5, s[24:27], s58 offen lds
MAA 132,8,36
TR 82,25,39808
MAA 148,8,40
TR 84,25,39328
MAA 152,12,40
TR 86,25,39840
MAA 136,12,36
buffer_load_dwordx4 v6, s[24:27], s58 offen offset:1024 lds
MAA 156,16,36
MAA 160,16,40
s_waitcnt vmcnt(18) lgkmcnt(8)
s_barrier
MAA 60,64,44
ds_write_b32 v17, v164
MAA 76,68,44
ds_write_b32 v17, v165 offset:1024
s_add_u32 m0, s59, 16640
MAA 80,68,48
RD 0,23,36864
s_mov_b32 s58, 1310720
MAA 64,64,48
buffer_load_dwordx4 v5, s[24:27], s58 offen lds
MAA 68,64,52
RD 4,23,37888
MAA 84,68,52
RD 8,23,39168
MAA 88,68,56
RD 12,23,40192
MAA 72,64,56
TR 20,25,49664
s_waitcnt lgkmcnt(7)
MAA 104,72,56
TR 22,25,50176
MAA 120,76,56
buffer_load_dwordx4 v6, s[24:27], s58 offen offset:1024 lds
MAA 116,76,52
TR 24,25,49696
s_add_u32 m0, s59, 91520
MAA 100,72,52
TR 26,25,50208
s_mov_b32 s58, 393216
MAA 96,72,48
RD 16,24,38912
MAA 112,76,48
TR 28,25,50688
MAA 108,76,44
TR 30,25,51200
MAA 92,72,44
buffer_load_dwordx4 v5, s[24:27], s58 offen lds
MAA 124,44,80
TR 32,25,50720
MAA 140,44,84
TR 34,25,51232
MAA 144,48,84
TR 36,25,51712
MAA 128,48,80
TR 38,25,52224
MAA 132,52,80
TR 40,25,51744
MAA 148,52,84
buffer_load_dwordx4 v6, s[24:27], s58 offen offset:1024 lds
MAA 152,56,84
TR 42,25,52256
MAA 136,56,80
MAA 156,60,80
MAA 160,60,84
s_waitcnt vmcnt(16) lgkmcnt(8)
s_barrier
MAA 60,20,0
RD 44,23,46080
MAA 76,24,0
RD 48,23,47104
s_add_u32 m0, s59, 24960
MAA 80,24,4
RD 52,23,48384
s_mov_b32 s58, 1441792
MAA 64,20,4
buffer_load_dwordx4 v5, s[24:27], s58 offen lds
MAA 68,20,8
RD 56,23,49408
MAA 84,24,8
TR 64,25,62080
MAA 88,24,12
TR 66,25,62592
MAA 72,20,12
buffer_load_dwordx4 v6, s[24:27], s58 offen offset:1024 lds
s_waitcnt lgkmcnt(6)
MAA 104,28,12
TR 68,25,62112
s_add_u32 m0, s59, 99840
MAA 120,32,12
TR 70,25,62624
s_mov_b32 s58, 524288
MAA 116,32,8
RD 60,24,48128
MAA 100,28,8
buffer_load_dwordx4 v5, s[24:27], s58 offen lds
MAA 96,28,4
TR 72,25,63104
MAA 112,32,4
TR 74,25,63616
MAA 108,32,0
TR 76,25,63136
MAA 92,28,0
buffer_load_dwordx4 v6, s[24:27], s58 offen offset:1024 lds
MAA 124,0,36
TR 78,25,63648
s_add_u32 m0, s59, 108160
MAA 140,0,40
TR 80,25,64128
s_mov_b32 s58, 655360
MAA 144,4,40
TR 82,25,64640
MAA 128,4,36
buffer_load_dwordx4 v5, s[24:27], s58 offen lds
MAA 132,8,36
TR 84,25,64160
MAA 148,8,40
TR 86,25,64672
MAA 152,12,40
MAA 136,12,36
buffer_load_dwordx4 v6, s[24:27], s58 offen offset:1024 lds
MAA 156,16,36
MAA 160,16,40
s_waitcnt lgkmcnt(0)
s_barrier
MAA 156,60,80
ds_read_b128 v[232:235], v10 offset:1792
s_add_u32 m0, s59, 33280
MAA 160,60,84
ds_read_b128 v[228:231], v10 offset:1536
s_mov_b32 s58, 1572864
MAA 104,72,56
ds_read_b128 v[224:227], v10 offset:1280
MAA 120,76,56
ds_read_b128 v[220:223], v10 offset:1024
MAA 136,56,80
ds_read_b128 v[240:243], v11 offset:704
MAA 152,56,84
ds_read_b128 v[244:247], v11 offset:1728
MAA 100,72,52
buffer_load_dwordx4 v5, s[24:27], s58 offen lds
MAA 116,76,52
ds_read_b128 v[18:21], v11 offset:448
MAA 96,72,48
ds_read_b128 v[22:25], v11 offset:1472
s_waitcnt lgkmcnt(7)
v_pk_fma_f32 v[104:105], v[36:37], v[232:233], v[104:105] op_sel_hi:[1,0,1]
v_pk_mul_f32 v[104:105], v[104:105], v[232:233] op_sel:[0,1] op_sel_hi:[1,1]
v_pk_fma_f32 v[106:107], v[38:39], v[232:233], v[106:107] op_sel_hi:[1,0,1]
v_pk_mul_f32 v[106:107], v[106:107], v[232:233] op_sel:[0,1] op_sel_hi:[1,1]
v_pk_fma_f32 v[120:121], v[40:41], v[232:233], v[120:121] op_sel_hi:[1,0,1]
v_pk_mul_f32 v[120:121], v[120:121], v[232:233] op_sel:[0,1] op_sel_hi:[1,1]
v_pk_fma_f32 v[122:123], v[42:43], v[232:233], v[122:123] op_sel_hi:[1,0,1]
v_pk_mul_f32 v[122:123], v[122:123], v[232:233] op_sel:[0,1] op_sel_hi:[1,1]
s_waitcnt lgkmcnt(6)
v_pk_fma_f32 v[100:101], v[36:37], v[228:229], v[100:101] op_sel_hi:[1,0,1]
v_pk_mul_f32 v[100:101], v[100:101], v[228:229] op_sel:[0,1] op_sel_hi:[1,1]
s_waitcnt lgkmcnt(3)
v_pk_fma_f32 v[156:157], v[240:241], v[44:45], v[156:157] op_sel_hi:[1,0,1]
v_pk_fma_f32 v[158:159], v[242:243], v[44:45], v[158:159] op_sel_hi:[1,0,1]
v_pk_fma_f32 v[160:161], v[240:241], v[44:45], v[160:161] op_sel:[0,1,0] op_sel_hi:[1,1,1]
v_pk_fma_f32 v[162:163], v[242:243], v[44:45], v[162:163] op_sel:[0,1,0] op_sel_hi:[1,1,1]
s_waitcnt lgkmcnt(2)
v_pk_mul_f32 v[156:157], v[156:157], v[244:245]
v_pk_mul_f32 v[158:159], v[158:159], v[246:247]
v_pk_mul_f32 v[160:161], v[160:161], v[244:245]
v_pk_mul_f32 v[162:163], v[162:163], v[246:247]
v_pk_fma_f32 v[102:103], v[38:39], v[228:229], v[102:103] op_sel_hi:[1,0,1]
v_pk_mul_f32 v[102:103], v[102:103], v[228:229] op_sel:[0,1] op_sel_hi:[1,1]
v_pk_fma_f32 v[116:117], v[40:41], v[228:229], v[116:117] op_sel_hi:[1,0,1]
v_pk_mul_f32 v[116:117], v[116:117], v[228:229] op_sel:[0,1] op_sel_hi:[1,1]
s_waitcnt lgkmcnt(1)
v_pk_fma_f32 v[136:137], v[18:19], v[44:45], v[136:137] op_sel_hi:[1,0,1]
v_pk_fma_f32 v[138:139], v[20:21], v[44:45], v[138:139] op_sel_hi:[1,0,1]
v_pk_fma_f32 v[152:153], v[18:19], v[44:45], v[152:153] op_sel:[0,1,0] op_sel_hi:[1,1,1]
v_pk_fma_f32 v[154:155], v[20:21], v[44:45], v[154:155] op_sel:[0,1,0] op_sel_hi:[1,1,1]
s_waitcnt lgkmcnt(0)
v_pk_mul_f32 v[136:137], v[136:137], v[22:23]
v_pk_mul_f32 v[138:139], v[138:139], v[24:25]
v_pk_mul_f32 v[152:153], v[152:153], v[22:23]
v_pk_mul_f32 v[154:155], v[154:155], v[24:25]
v_pk_fma_f32 v[118:119], v[42:43], v[228:229], v[118:119] op_sel_hi:[1,0,1]
v_pk_mul_f32 v[118:119], v[118:119], v[228:229] op_sel:[0,1] op_sel_hi:[1,1]
v_pk_fma_f32 v[96:97], v[36:37], v[224:225], v[96:97] op_sel_hi:[1,0,1]
v_pk_mul_f32 v[96:97], v[96:97], v[224:225] op_sel:[0,1] op_sel_hi:[1,1]
v_pk_fma_f32 v[98:99], v[38:39], v[224:225], v[98:99] op_sel_hi:[1,0,1]
v_pk_mul_f32 v[98:99], v[98:99], v[224:225] op_sel:[0,1] op_sel_hi:[1,1]
v_cvt_pk_bf16_f32 v236, v156, v157
v_cvt_pk_bf16_f32 v237, v158, v159
MAA 112,76,48
buffer_load_dwordx4 v6, s[24:27], s58 offen offset:1024 lds
MAA 92,72,44
ds_read_b128 v[240:243], v11 offset:384
v_cvt_pk_bf16_f32 v238, v160, v161
MAA 108,76,44
ds_read_b128 v[244:247], v11 offset:1408
v_cvt_pk_bf16_f32 v239, v162, v163
MAA 72,64,56
ds_write_b128 v8, v[236:239] offset:1024
s_add_u32 m0, s59, 41600
MAA 88,68,56
ds_read_b128 v[18:21], v11 offset:320
s_mov_b32 s58, 1703936
buffer_load_dwordx4 v5, s[24:27], s58 offen lds
s_nop 1
v_pk_fma_f32 v[72:73], v[28:29], v[232:233], v[72:73] op_sel_hi:[1,0,1]
v_pk_fma_f32 v[74:75], v[30:31], v[232:233], v[74:75] op_sel_hi:[1,0,1]
s_nop 0
v_pk_fma_f32 v[88:89], v[32:33], v[232:233], v[88:89] op_sel_hi:[1,0,1]
v_pk_fma_f32 v[90:91], v[34:35], v[232:233], v[90:91] op_sel_hi:[1,0,1]
v_pk_fma_f32 v[112:113], v[40:41], v[224:225], v[112:113] op_sel_hi:[1,0,1]
v_pk_mul_f32 v[112:113], v[112:113], v[224:225] op_sel:[0,1] op_sel_hi:[1,1]
v_pk_fma_f32 v[114:115], v[42:43], v[224:225], v[114:115] op_sel_hi:[1,0,1]
v_pk_mul_f32 v[114:115], v[114:115], v[224:225] op_sel:[0,1] op_sel_hi:[1,1]
v_pk_fma_f32 v[92:93], v[36:37], v[220:221], v[92:93] op_sel_hi:[1,0,1]
v_pk_mul_f32 v[92:93], v[92:93], v[220:221] op_sel:[0,1] op_sel_hi:[1,1]
v_pk_fma_f32 v[94:95], v[38:39], v[220:221], v[94:95] op_sel_hi:[1,0,1]
v_pk_mul_f32 v[94:95], v[94:95], v[220:221] op_sel:[0,1] op_sel_hi:[1,1]
v_pk_fma_f32 v[108:109], v[40:41], v[220:221], v[108:109] op_sel_hi:[1,0,1]
v_pk_mul_f32 v[108:109], v[108:109], v[220:221] op_sel:[0,1] op_sel_hi:[1,1]
v_pk_fma_f32 v[110:111], v[42:43], v[220:221], v[110:111] op_sel_hi:[1,0,1]
v_pk_mul_f32 v[110:111], v[110:111], v[220:221] op_sel:[0,1] op_sel_hi:[1,1]
v_cvt_pk_bf16_f32 v196, v104, v105
v_cvt_pk_bf16_f32 v197, v106, v107
MAA 132,52,80
buffer_load_dwordx4 v6, s[24:27], s58 offen offset:1024 lds
MAA 148,52,84
s_waitcnt lgkmcnt(1)
s_barrier
ds_read_b128 v[180:183], v9
MAA 68,64,52
ds_read_b64 v[200:201], v9 offset:1024
s_add_u32 m0, s59, 49920
MAA 84,68,52
ds_read_b64 v[210:211], v9 offset:1032
s_mov_b32 s58, 1835008
MAA 128,48,80
buffer_load_dwordx4 v5, s[24:27], s58 offen lds
v_cvt_pk_bf16_f32 v198, v120, v121
v_cvt_pk_bf16_f32 v199, v122, v123
v_cvt_pk_bf16_f32 v208, v136, v137
v_pk_fma_f32 v[132:133], v[240:241], v[44:45], v[132:133] op_sel_hi:[1,0,1]
v_pk_mul_f32 v[132:133], v[132:133], v[244:245]
v_pk_fma_f32 v[134:135], v[242:243], v[44:45], v[134:135] op_sel_hi:[1,0,1]
v_pk_mul_f32 v[134:135], v[134:135], v[246:247]
v_pk_fma_f32 v[148:149], v[240:241], v[44:45], v[148:149] op_sel:[0,1,0] op_sel_hi:[1,1,1]
v_pk_mul_f32 v[148:149], v[148:149], v[244:245]
v_pk_fma_f32 v[150:151], v[242:243], v[44:45], v[150:151] op_sel:[0,1,0] op_sel_hi:[1,1,1]
v_pk_mul_f32 v[150:151], v[150:151], v[246:247]
v_pk_fma_f32 v[68:69], v[28:29], v[228:229], v[68:69] op_sel_hi:[1,0,1]
v_pk_fma_f32 v[70:71], v[30:31], v[228:229], v[70:71] op_sel_hi:[1,0,1]
v_pk_fma_f32 v[84:85], v[32:33], v[228:229], v[84:85] op_sel_hi:[1,0,1]
v_pk_fma_f32 v[86:87], v[34:35], v[228:229], v[86:87] op_sel_hi:[1,0,1]
s_waitcnt lgkmcnt(3)
v_pk_fma_f32 v[128:129], v[18:19], v[44:45], v[128:129] op_sel_hi:[1,0,1]
v_pk_fma_f32 v[130:131], v[20:21], v[44:45], v[130:131] op_sel_hi:[1,0,1]
v_cvt_pk_bf16_f32 v209, v138, v139
v_cvt_pk_bf16_f32 v218, v152, v153
MAA 144,48,84
buffer_load_dwordx4 v6, s[24:27], s58 offen offset:1024 lds
MAA 64,64,48
ds_read_b128 v[22:25], v11 offset:1344
s_add_u32 m0, s59, 116480
MAA 80,68,48
ds_read_b128 v[240:243], v11 offset:256
s_mov_b32 s58, 786432
MAA 124,44,80
ds_read_b128 v[244:247], v11 offset:1280
v_cvt_pk_bf16_f32 v219, v154, v155
MAA 140,44,84
buffer_load_dwordx4 v5, s[24:27], s58 offen lds
MAA 60,64,44
v_cvt_pk_bf16_f32 v192, v100, v101
v_cvt_pk_bf16_f32 v193, v102, v103
MAA 76,68,44
v_cvt_pk_bf16_f32 v194, v116, v117
v_cvt_pk_bf16_f32 v195, v118, v119
v_cvt_pk_bf16_f32 v176, v72, v73
v_cvt_pk_bf16_f32 v177, v74, v75
v_cvt_pk_bf16_f32 v178, v88, v89
v_cvt_pk_bf16_f32 v179, v90, v91
v_pk_fma_f32 v[144:145], v[18:19], v[44:45], v[144:145] op_sel:[0,1,0] op_sel_hi:[1,1,1]
v_pk_fma_f32 v[146:147], v[20:21], v[44:45], v[146:147] op_sel:[0,1,0] op_sel_hi:[1,1,1]
v_pk_fma_f32 v[64:65], v[28:29], v[224:225], v[64:65] op_sel_hi:[1,0,1]
v_pk_fma_f32 v[66:67], v[30:31], v[224:225], v[66:67] op_sel_hi:[1,0,1]
v_pk_fma_f32 v[80:81], v[32:33], v[224:225], v[80:81] op_sel_hi:[1,0,1]
s_waitcnt lgkmcnt(2)
v_pk_mul_f32 v[128:129], v[128:129], v[22:23]
v_pk_mul_f32 v[130:131], v[130:131], v[24:25]
v_pk_mul_f32 v[144:145], v[144:145], v[22:23]
v_pk_mul_f32 v[146:147], v[146:147], v[24:25]
v_pk_fma_f32 v[82:83], v[34:35], v[224:225], v[82:83] op_sel_hi:[1,0,1]
s_waitcnt lgkmcnt(1)
v_pk_fma_f32 v[124:125], v[240:241], v[44:45], v[124:125] op_sel_hi:[1,0,1]
v_pk_fma_f32 v[126:127], v[242:243], v[44:45], v[126:127] op_sel_hi:[1,0,1]
v_pk_fma_f32 v[140:141], v[240:241], v[44:45], v[140:141] op_sel:[0,1,0] op_sel_hi:[1,1,1]
s_waitcnt lgkmcnt(0)
v_pk_mul_f32 v[124:125], v[124:125], v[244:245]
v_pk_mul_f32 v[126:127], v[126:127], v[246:247]
v_pk_mul_f32 v[140:141], v[140:141], v[244:245]
v_pk_fma_f32 v[142:143], v[242:243], v[44:45], v[142:143] op_sel:[0,1,0] op_sel_hi:[1,1,1]
v_pk_mul_f32 v[142:143], v[142:143], v[246:247]
v_pk_fma_f32 v[60:61], v[28:29], v[220:221], v[60:61] op_sel_hi:[1,0,1]
v_pk_fma_f32 v[62:63], v[30:31], v[220:221], v[62:63] op_sel_hi:[1,0,1]
v_pk_fma_f32 v[76:77], v[32:33], v[220:221], v[76:77] op_sel_hi:[1,0,1]
v_pk_fma_f32 v[78:79], v[34:35], v[220:221], v[78:79] op_sel_hi:[1,0,1]
v_cvt_pk_bf16_f32 v206, v132, v133
v_cvt_pk_bf16_f32 v207, v134, v135
v_mfma_f32_16x16x32_bf16 v[104:107], v[192:195], v[176:179], v[46:49]
buffer_load_dwordx4 v6, s[24:27], s58 offen offset:1024 lds
v_mfma_f32_16x16x32_bf16 v[120:123], v[196:199], v[176:179], v[50:53]
s_add_u32 m0, s59, 124800
s_mov_b32 s58, 917504
v_cvt_pk_bf16_f32 v216, v148, v149
v_cvt_pk_bf16_f32 v217, v150, v151
s_nop 1
v_max3_f32 v88, v104, v105, v106
v_cvt_pk_bf16_f32 v188, v96, v97
v_cvt_pk_bf16_f32 v189, v98, v99
v_cvt_pk_bf16_f32 v190, v112, v113
v_max3_f32 v89, v107, v120, v121
v_max3_f32 v88, v88, v122, v123
v_max_f32 v90, v88, v89
v_max_f32 v89, v88, v89
buffer_load_dwordx4 v5, s[24:27], s58 offen lds
s_nop 0
v_permlane16_swap_b32 v90, v89
v_cvt_pk_bf16_f32 v191, v114, v115
v_max_f32 v88, v90, v89
v_max_f32 v89, v90, v89
v_cvt_pk_bf16_f32 v172, v68, v69
v_cvt_pk_bf16_f32 v173, v70, v71
v_permlane32_swap_b32 v88, v89
v_cvt_pk_bf16_f32 v174, v84, v85
v_max_f32 v88, v88, v89
v_mul_f32 v88, v88, v234
v_pk_fma_f32 v[104:105], v[104:105], v[234:235], v[88:89] op_sel_hi:[1,0,0] neg_lo:[0,0,1] neg_hi:[0,0,1]
buffer_load_dwordx4 v6, s[24:27], s58 offen offset:1024 lds
v_pk_fma_f32 v[106:107], v[106:107], v[234:235], v[88:89] op_sel_hi:[1,0,0] neg_lo:[0,0,1] neg_hi:[0,0,1]
v_pk_fma_f32 v[120:121], v[120:121], v[234:235], v[88:89] op_sel_hi:[1,0,0] neg_lo:[0,0,1] neg_hi:[0,0,1]
v_pk_fma_f32 v[122:123], v[122:123], v[234:235], v[88:89] op_sel_hi:[1,0,0] neg_lo:[0,0,1] neg_hi:[0,0,1]
v_exp_f32 v104, v104
v_exp_f32 v105, v105
v_exp_f32 v106, v106
v_exp_f32 v107, v107
v_exp_f32 v120, v120
v_exp_f32 v121, v121
v_exp_f32 v122, v122
v_exp_f32 v123, v123
v_cvt_pk_bf16_f32 v72, v104, v105
v_cvt_pk_bf16_f32 v73, v106, v107
v_cvt_pk_bf16_f32 v74, v120, v121
v_cvt_pk_bf16_f32 v75, v122, v123
v_cvt_pk_bf16_f32 v175, v86, v87
v_cvt_pk_bf16_f32 v204, v128, v129
.Lpad18:
s_cbranch_execz .Lnopoll53r
v_mfma_f32_16x16x32_bf16 v[88:91], v[248:251], v[72:75], 0
v_cvt_pk_bf16_f32 v205, v130, v131
v_cvt_pk_bf16_f32 v214, v144, v145
v_mfma_f32_16x16x32_bf16 v[104:107], v[206:209], v[72:75], 0
v_cvt_pk_bf16_f32 v215, v146, v147
v_cvt_pk_bf16_f32 v184, v92, v93
v_mfma_f32_16x16x32_bf16 v[120:123], v[216:219], v[72:75], 0
s_nop 1
v_rcp_f32 v88, v88
v_mfma_f32_16x16x32_bf16 v[100:103], v[188:191], v[172:175], v[46:49]
v_cvt_pk_bf16_f32 v185, v94, v95
v_cvt_pk_bf16_f32 v186, v108, v109
v_mfma_f32_16x16x32_bf16 v[116:119], v[192:195], v[172:175], v[50:53]
v_cvt_pk_bf16_f32 v187, v110, v111
v_cvt_pk_bf16_f32 v168, v64, v65
v_cvt_pk_bf16_f32 v169, v66, v67
s_nop 1
v_max3_f32 v84, v100, v101, v102
v_cvt_pk_bf16_f32 v170, v80, v81
v_pk_mul_f32 v[104:105], v[104:105], v[88:89] op_sel_hi:[1,0]
v_pk_mul_f32 v[106:107], v[106:107], v[88:89] op_sel_hi:[1,0]
v_pk_mul_f32 v[120:121], v[120:121], v[88:89] op_sel_hi:[1,0]
v_pk_mul_f32 v[122:123], v[122:123], v[88:89] op_sel_hi:[1,0]
v_cvt_pk_bf16_f32 v176, v104, v105
v_cvt_pk_bf16_f32 v177, v106, v107
v_cvt_pk_bf16_f32 v178, v120, v121
v_cvt_pk_bf16_f32 v179, v122, v123
buffer_store_dwordx4 v[176:179], v4, s[16:19], s74 offen offset:3072 sc1
v_max3_f32 v85, v103, v116, v117
v_max3_f32 v84, v84, v118, v119
v_max_f32 v86, v84, v85
v_max_f32 v85, v84, v85
v_cvt_pk_bf16_f32 v171, v82, v83
v_cvt_pk_bf16_f32 v202, v124, v125
v_permlane16_swap_b32 v86, v85
v_mfma_f32_16x16x32_bf16 v[96:99], v[184:187], v[168:171], v[46:49]
v_max_f32 v84, v86, v85
v_max_f32 v85, v86, v85
v_mfma_f32_16x16x32_bf16 v[112:115], v[188:191], v[168:171], v[50:53]
s_nop 0
v_permlane32_swap_b32 v84, v85
v_cvt_pk_bf16_f32 v203, v126, v127
v_max_f32 v84, v84, v85
v_mul_f32 v84, v84, v230
v_pk_fma_f32 v[100:101], v[100:101], v[230:231], v[84:85] op_sel_hi:[1,0,0] neg_lo:[0,0,1] neg_hi:[0,0,1]
v_pk_fma_f32 v[102:103], v[102:103], v[230:231], v[84:85] op_sel_hi:[1,0,0] neg_lo:[0,0,1] neg_hi:[0,0,1]
v_pk_fma_f32 v[116:117], v[116:117], v[230:231], v[84:85] op_sel_hi:[1,0,0] neg_lo:[0,0,1] neg_hi:[0,0,1]
v_pk_fma_f32 v[118:119], v[118:119], v[230:231], v[84:85] op_sel_hi:[1,0,0] neg_lo:[0,0,1] neg_hi:[0,0,1]
v_exp_f32 v100, v100
v_exp_f32 v101, v101
v_exp_f32 v102, v102
v_exp_f32 v103, v103
v_exp_f32 v116, v116
v_exp_f32 v117, v117
v_exp_f32 v118, v118
v_exp_f32 v119, v119
v_cvt_pk_bf16_f32 v68, v100, v101
v_cvt_pk_bf16_f32 v69, v102, v103
v_cvt_pk_bf16_f32 v70, v116, v117
v_cvt_pk_bf16_f32 v71, v118, v119
v_cvt_pk_bf16_f32 v212, v140, v141
v_cvt_pk_bf16_f32 v213, v142, v143
v_mfma_f32_16x16x32_bf16 v[84:87], v[248:251], v[68:71], 0
v_max3_f32 v80, v96, v97, v98
v_max3_f32 v81, v99, v112, v113
v_mfma_f32_16x16x32_bf16 v[100:103], v[204:207], v[68:71], 0
v_max3_f32 v80, v80, v114, v115
v_max_f32 v82, v80, v81
v_mfma_f32_16x16x32_bf16 v[116:119], v[214:217], v[68:71], 0
s_nop 1
v_rcp_f32 v84, v84
v_max_f32 v81, v80, v81
v_cvt_pk_bf16_f32 v164, v60, v61
v_cvt_pk_bf16_f32 v165, v62, v63
v_pk_mul_f32 v[100:101], v[100:101], v[84:85] op_sel_hi:[1,0]
v_pk_mul_f32 v[102:103], v[102:103], v[84:85] op_sel_hi:[1,0]
v_pk_mul_f32 v[116:117], v[116:117], v[84:85] op_sel_hi:[1,0]
v_pk_mul_f32 v[118:119], v[118:119], v[84:85] op_sel_hi:[1,0]
v_cvt_pk_bf16_f32 v172, v100, v101
v_cvt_pk_bf16_f32 v173, v102, v103
v_cvt_pk_bf16_f32 v174, v116, v117
v_cvt_pk_bf16_f32 v175, v118, v119
buffer_store_dwordx4 v[172:175], v4, s[16:19], s74 offen offset:2048 sc1
v_permlane16_swap_b32 v82, v81
v_cvt_pk_bf16_f32 v166, v76, v77
v_max_f32 v80, v82, v81
v_max_f32 v81, v82, v81
v_cvt_pk_bf16_f32 v167, v78, v79
s_nop 0
v_permlane32_swap_b32 v80, v81
v_mfma_f32_16x16x32_bf16 v[92:95], v[180:183], v[164:167], v[46:49]
v_max_f32 v80, v80, v81
v_mul_f32 v80, v80, v226
v_mfma_f32_16x16x32_bf16 v[108:111], v[184:187], v[164:167], v[50:53]
s_nop 4
v_max3_f32 v76, v92, v93, v94
v_pk_fma_f32 v[96:97], v[96:97], v[226:227], v[80:81] op_sel_hi:[1,0,0] neg_lo:[0,0,1] neg_hi:[0,0,1]
v_pk_fma_f32 v[98:99], v[98:99], v[226:227], v[80:81] op_sel_hi:[1,0,0] neg_lo:[0,0,1] neg_hi:[0,0,1]
v_pk_fma_f32 v[112:113], v[112:113], v[226:227], v[80:81] op_sel_hi:[1,0,0] neg_lo:[0,0,1] neg_hi:[0,0,1]
v_pk_fma_f32 v[114:115], v[114:115], v[226:227], v[80:81] op_sel_hi:[1,0,0] neg_lo:[0,0,1] neg_hi:[0,0,1]
v_exp_f32 v96, v96
v_exp_f32 v97, v97
v_exp_f32 v98, v98
v_exp_f32 v99, v99
v_exp_f32 v112, v112
v_exp_f32 v113, v113
v_exp_f32 v114, v114
v_exp_f32 v115, v115
v_cvt_pk_bf16_f32 v64, v96, v97
v_cvt_pk_bf16_f32 v65, v98, v99
v_cvt_pk_bf16_f32 v66, v112, v113
v_cvt_pk_bf16_f32 v67, v114, v115
v_max3_f32 v77, v95, v108, v109
v_max3_f32 v76, v76, v110, v111
v_mfma_f32_16x16x32_bf16 v[80:83], v[248:251], v[64:67], 0
v_max_f32 v78, v76, v77
v_max_f32 v77, v76, v77
v_mfma_f32_16x16x32_bf16 v[96:99], v[202:205], v[64:67], 0
s_nop 0
v_permlane16_swap_b32 v78, v77
v_mfma_f32_16x16x32_bf16 v[112:115], v[212:215], v[64:67], 0
s_nop 1
v_rcp_f32 v80, v80
v_max_f32 v76, v78, v77
v_max_f32 v77, v78, v77
v_pk_mul_f32 v[96:97], v[96:97], v[80:81] op_sel_hi:[1,0]
v_pk_mul_f32 v[98:99], v[98:99], v[80:81] op_sel_hi:[1,0]
s_nop 0
v_pk_mul_f32 v[112:113], v[112:113], v[80:81] op_sel_hi:[1,0]
v_pk_mul_f32 v[114:115], v[114:115], v[80:81] op_sel_hi:[1,0]
v_cvt_pk_bf16_f32 v168, v96, v97
v_cvt_pk_bf16_f32 v169, v98, v99
v_cvt_pk_bf16_f32 v170, v112, v113
v_cvt_pk_bf16_f32 v171, v114, v115
buffer_store_dwordx4 v[168:171], v4, s[16:19], s74 offen offset:1024 sc1
v_permlane32_swap_b32 v76, v77
v_max_f32 v76, v76, v77
v_mul_f32 v76, v76, v222
v_pk_fma_f32 v[92:93], v[92:93], v[222:223], v[76:77] op_sel_hi:[1,0,0] neg_lo:[0,0,1] neg_hi:[0,0,1]
v_pk_fma_f32 v[94:95], v[94:95], v[222:223], v[76:77] op_sel_hi:[1,0,0] neg_lo:[0,0,1] neg_hi:[0,0,1]
v_pk_fma_f32 v[108:109], v[108:109], v[222:223], v[76:77] op_sel_hi:[1,0,0] neg_lo:[0,0,1] neg_hi:[0,0,1]
v_pk_fma_f32 v[110:111], v[110:111], v[222:223], v[76:77] op_sel_hi:[1,0,0] neg_lo:[0,0,1] neg_hi:[0,0,1]
v_exp_f32 v92, v92
v_exp_f32 v93, v93
v_exp_f32 v94, v94
v_exp_f32 v95, v95
v_exp_f32 v108, v108
v_exp_f32 v109, v109
v_exp_f32 v110, v110
v_exp_f32 v111, v111
v_cvt_pk_bf16_f32 v60, v92, v93
v_cvt_pk_bf16_f32 v61, v94, v95
v_cvt_pk_bf16_f32 v62, v108, v109
v_cvt_pk_bf16_f32 v63, v110, v111
s_nop 1
v_mfma_f32_16x16x32_bf16 v[76:79], v[248:251], v[60:63], 0
v_mfma_f32_16x16x32_bf16 v[92:95], v[200:203], v[60:63], 0
v_mfma_f32_16x16x32_bf16 v[108:111], v[210:213], v[60:63], 0
s_nop 5
v_rcp_f32 v76, v76
s_nop 0
v_pk_mul_f32 v[92:93], v[92:93], v[76:77] op_sel_hi:[1,0]
v_pk_mul_f32 v[94:95], v[94:95], v[76:77] op_sel_hi:[1,0]
v_pk_mul_f32 v[108:109], v[108:109], v[76:77] op_sel_hi:[1,0]
v_pk_mul_f32 v[110:111], v[110:111], v[76:77] op_sel_hi:[1,0]
v_cvt_pk_bf16_f32 v164, v92, v93
v_cvt_pk_bf16_f32 v165, v94, v95
v_cvt_pk_bf16_f32 v166, v108, v109
v_cvt_pk_bf16_f32 v167, v110, v111
buffer_store_dwordx4 v[164:167], v4, s[16:19], s74 offen sc1
s_nop 1
.Lqkve56:
.Lpad19:
s_cbranch_execz .Lnopoll53r
s_lshl_b32 s62, s3, 11
s_add_u32 s62, s62, s84
v_lshl_add_u32 v4, v1, 4, s62
v_lshrrev_b32 v2, 3, v1
v_cmp_eq_u32 vcc, 3, v2
v_add_u32 v2, 67108480, v4
s_nop 0
v_cndmask_b32 v4, v4, v2, vcc
v_bfe_u32 v5, v1, 3, 1
v_lshrrev_b32 v2, 4, v1
v_lshl_add_u32 v5, v2, 3, v5
s_lshl_b32 s62, s3, 1
v_add_u32 v5, s62, v5
v_mul_u32_u24 v5, 2048, v5
v_and_b32 v2, 7, v1
v_lshl_add_u32 v5, v2, 4, v5
s_lshl_b32 s62, s7, 7
v_add_u32 v5, s62, v5
v_add_u32 v6, 64512, v5
v_bfe_u32 v8, v1, 3, 2
v_mul_u32_u24 v8, 2080, v8
v_bfe_u32 v2, v1, 2, 1
v_lshl_add_u32 v8, v2, 7, v8
v_bfe_u32 v2, v1, 5, 1
v_lshl_add_u32 v8, v2, 8, v8
v_and_b32 v2, 3, v1
v_lshl_add_u32 v8, v2, 3, v8
s_mov_b32 s57, 66560
v_add_u32 v7, s57, v8
s_mov_b32 s52, 37748736
s_mov_b32 s53, 37879808
s_mov_b32 s54, 2097152
s_mul_i32 s56, s3, 2080
v_accvgpr_read_b32 v32, a224
v_accvgpr_read_b32 v33, a225
v_accvgpr_read_b32 v34, a226
v_accvgpr_read_b32 v35, a227
v_accvgpr_read_b32 v36, a228
v_accvgpr_read_b32 v37, a229
v_accvgpr_read_b32 v38, a230
v_accvgpr_read_b32 v39, a231
v_accvgpr_read_b32 v40, a232
v_accvgpr_read_b32 v41, a233
v_accvgpr_read_b32 v42, a234
v_accvgpr_read_b32 v43, a235
v_accvgpr_read_b32 v44, a236
v_accvgpr_read_b32 v45, a237
v_accvgpr_read_b32 v46, a238
v_accvgpr_read_b32 v47, a239
v_accvgpr_read_b32 v48, a240
v_accvgpr_read_b32 v49, a241
v_accvgpr_read_b32 v50, a242
v_accvgpr_read_b32 v51, a243
v_accvgpr_read_b32 v52, a244
v_accvgpr_read_b32 v53, a245
v_accvgpr_read_b32 v54, a246
v_accvgpr_read_b32 v55, a247
v_accvgpr_read_b32 v56, a248
v_accvgpr_read_b32 v57, a249
v_accvgpr_read_b32 v58, a250
v_accvgpr_read_b32 v59, a251
v_accvgpr_read_b32 v60, a252
v_accvgpr_read_b32 v61, a253
v_accvgpr_read_b32 v62, a254
v_accvgpr_read_b32 v63, a255
s_lshl_b32 s62, s49, 3
s_add_u32 s62, s62, s48
s_mul_i32 s62, s62, 28672
s_add_u32 s62, s62, s51
v_lshrrev_b32 v12, 4, v1
v_mul_u32_u24 v12, 57344, v12
v_and_b32 v2, 15, v1
v_lshl_add_u32 v12, v2, 4, v12
v_add_u32 v12, s62, v12
v_add_u32 v13, 6112, v12
v_add_u32 v14, 12224, v12
v_add_u32 v15, 18336, v12
s_mul_i32 s59, s3, 4224
s_mov_b32 s58, 0
s_lshl_b32 s62, s8, 10
s_add_u32 s62, s62, 30490624
s_lshl_b32 s64, s6, 10
s_add_u32 s64, s64, 30490624
s_lshr_b32 s67, s5, 2
s_and_b32 s67, s67, 3
s_lshl_b32 s67, s67, 7
s_add_u32 s64, s64, s67
v_lshl_add_u32 v252, v1, 7, s62
v_mov_b32 v253, s64
v_mov_b32 v255, 1
s_waitcnt vmcnt(0) lgkmcnt(0)
s_cmp_lg_u32 s3, 1
s_barrier
s_cbranch_scc1 .Lnopoll60
s_mov_b64 exec, 15
buffer_atomic_add v255, v252, s[16:19], 0 offen
s_mov_b64 exec, 1
v_mov_b32 v254, 0
buffer_atomic_add v254, v253, s[16:19], 0 offen sc0
s_sleep 5
s_mov_b32 s15, 0
.Lpoll59:
v_mov_b32 v255, 0
buffer_atomic_add v255, v253, s[16:19], 0 offen sc0
s_waitcnt vmcnt(1)
v_cmp_gt_u32 vcc, 16, v254
s_add_u32 s15, s15, 1
s_cbranch_vccz .Lnopoll60r
v_mov_b32 v254, 0
buffer_atomic_add v254, v253, s[16:19], 0 offen sc0
s_waitcnt vmcnt(1)
v_cmp_gt_u32 vcc, 16, v255
s_add_u32 s15, s15, 1
s_cbranch_vccz .Lnopoll60r
s_cmp_le_u32 s15, 100000
s_cbranch_scc1 .Lpoll59
s_branch .Lnopoll60r
.Lnopoll60:
s_mov_b64 exec, 0
s_cmp_eq_u32 s3, 2
s_cbranch_scc1 .Lpad20
s_cmp_eq_u32 s3, 3
s_cbranch_scc1 .Lpad21
s_branch .Lpad22
.Lnopoll60r:
s_mov_b64 exec, -1
s_barrier
buffer_load_dwordx4 v[64:67], v4, s[16:19], s52 offen sc1
buffer_load_dwordx4 v[68:71], v4, s[16:19], s52 offen offset:1024 sc1
s_add_u32 s52, s52, 262144
buffer_load_dwordx4 v[72:75], v4, s[16:19], s53 offen sc1
buffer_load_dwordx4 v[76:79], v4, s[16:19], s53 offen offset:1024 sc1
s_add_u32 s53, s53, 262144
buffer_load_dwordx4 v[80:83], v4, s[16:19], s52 offen sc1
buffer_load_dwordx4 v[84:87], v4, s[16:19], s52 offen offset:1024 sc1
s_add_u32 s52, s52, 262144
buffer_load_dwordx4 v[88:91], v4, s[16:19], s53 offen sc1
buffer_load_dwordx4 v[92:95], v4, s[16:19], s53 offen offset:1024 sc1
s_add_u32 s53, s53, 262144
buffer_load_dwordx4 v[96:99], v4, s[16:19], s52 offen sc1
buffer_load_dwordx4 v[100:103], v4, s[16:19], s52 offen offset:1024 sc1
s_add_u32 s52, s52, 262144
buffer_load_dwordx4 v[104:107], v4, s[16:19], s53 offen sc1
buffer_load_dwordx4 v[108:111], v4, s[16:19], s53 offen offset:1024 sc1
s_add_u32 s53, s53, 262144
ds_read_b64_tr_b16 a[0:1], v7
TR 2,7,512
TR 16,7,1024
TR 18,7,1536
TR 4,7,32
TR 6,7,544
TR 20,7,1056
TR 22,7,1568
TR 8,7,64
TR 10,7,576
TR 24,7,1088
TR 26,7,1600
TR 12,7,96
TR 14,7,608
TR 28,7,1120
TR 30,7,1632
s_waitcnt vmcnt(8) lgkmcnt(14)
MAV 32,0,64
TR 32,7,8320
TR 34,7,8832
s_waitcnt lgkmcnt(14)
MAV 32,16,72
buffer_load_dwordx4 v[112:115], v4, s[16:19], s52 offen sc1
MAV 48,16,76
TR 48,7,9344
TR 50,7,9856
MAV 48,0,68
TR 36,7,8352
s_waitcnt lgkmcnt(15)
MAV 52,4,68
buffer_load_dwordx4 v[116:119], v4, s[16:19], s52 offen offset:1024 sc1
s_waitcnt lgkmcnt(13)
MAV 52,20,76
TR 38,7,8864
s_add_u32 s52, s52, 262144
MAV 36,20,72
TR 52,7,9376
MAV 36,4,64
TR 54,7,9888
s_waitcnt lgkmcnt(14)
MAV 40,8,64
buffer_load_dwordx4 v[120:123], v4, s[16:19], s53 offen sc1
s_waitcnt lgkmcnt(12)
MAV 40,24,72
TR 40,7,8384
TR 42,7,8896
MAV 56,24,76
TR 56,7,9408
MAV 56,8,68
TR 58,7,9920
TR 44,7,8416
s_waitcnt lgkmcnt(15)
MAV 60,12,68
buffer_load_dwordx4 v[124:127], v4, s[16:19], s53 offen offset:1024 sc1
s_waitcnt lgkmcnt(13)
MAV 60,28,76
s_add_u32 s53, s53, 262144
MAV 44,28,72
TR 46,7,8928
TR 60,7,9440
MAV 44,12,64
TR 62,7,9952
s_waitcnt vmcnt(8) lgkmcnt(8)
MAV 32,32,80
TR 0,7,16640
TR 2,7,17152
MAV 32,48,88
buffer_load_dwordx4 v[64:67], v4, s[16:19], s52 offen sc1
MAV 48,48,92
TR 16,7,17664
TR 18,7,18176
MAV 48,32,84
TR 4,7,16672
MAV 52,36,84
buffer_load_dwordx4 v[68:71], v4, s[16:19], s52 offen offset:1024 sc1
MAV 52,52,92
TR 6,7,17184
s_add_u32 s52, s52, 262144
MAV 36,52,88
TR 20,7,17696
MAV 36,36,80
TR 22,7,18208
s_waitcnt lgkmcnt(8)
MAV 40,40,80
buffer_load_dwordx4 v[72:75], v4, s[16:19], s53 offen sc1
MAV 40,56,88
TR 8,7,16704
TR 10,7,17216
MAV 56,56,92
TR 24,7,17728
MAV 56,40,84
TR 26,7,18240
TR 12,7,16736
MAV 60,44,84
buffer_load_dwordx4 v[76:79], v4, s[16:19], s53 offen offset:1024 sc1
MAV 60,60,92
s_add_u32 s53, s53, 262144
MAV 44,60,88
TR 14,7,17248
TR 28,7,17760
MAV 44,44,80
TR 30,7,18272
s_waitcnt vmcnt(8) lgkmcnt(8)
MAV 32,0,96
TR 32,7,24960
TR 34,7,25472
MAV 32,16,104
buffer_load_dwordx4 v[80:83], v4, s[16:19], s52 offen sc1
MAV 48,16,108
TR 48,7,25984
TR 50,7,26496
MAV 48,0,100
TR 36,7,24992
MAV 52,4,100
buffer_load_dwordx4 v[84:87], v4, s[16:19], s52 offen offset:1024 sc1
MAV 52,20,108
TR 38,7,25504
s_add_u32 s52, s52, 262144
MAV 36,20,104
TR 52,7,26016
MAV 36,4,96
TR 54,7,26528
s_waitcnt lgkmcnt(8)
MAV 40,8,96
buffer_load_dwordx4 v[88:91], v4, s[16:19], s53 offen sc1
MAV 40,24,104
TR 40,7,25024
TR 42,7,25536
MAV 56,24,108
TR 56,7,26048
MAV 56,8,100
TR 58,7,26560
TR 44,7,25056
MAV 60,12,100
buffer_load_dwordx4 v[92:95], v4, s[16:19], s53 offen offset:1024 sc1
MAV 60,28,108
s_add_u32 s53, s53, 262144
MAV 44,28,104
TR 46,7,25568
TR 60,7,26080
MAV 44,12,96
TR 62,7,26592
s_waitcnt vmcnt(8) lgkmcnt(8)
MAV 32,32,112
TR 0,7,33280
TR 2,7,33792
MAV 32,48,120
buffer_load_dwordx4 v[96:99], v4, s[16:19], s52 offen sc1
MAV 48,48,124
TR 16,7,34304
TR 18,7,34816
MAV 48,32,116
TR 4,7,33312
MAV 52,36,116
buffer_load_dwordx4 v[100:103], v4, s[16:19], s52 offen offset:1024 sc1
MAV 52,52,124
TR 6,7,33824
s_add_u32 s52, s52, 262144
MAV 36,52,120
TR 20,7,34336
MAV 36,36,112
TR 22,7,34848
s_waitcnt lgkmcnt(8)
MAV 40,40,112
buffer_load_dwordx4 v[104:107], v4, s[16:19], s53 offen sc1
MAV 40,56,120
TR 8,7,33344
TR 10,7,33856
MAV 56,56,124
TR 24,7,34368
MAV 56,40,116
TR 26,7,34880
TR 12,7,33376
MAV 60,44,116
buffer_load_dwordx4 v[108:111], v4, s[16:19], s53 offen offset:1024 sc1
MAV 60,60,124
s_add_u32 s53, s53, 262144
MAV 44,60,120
TR 14,7,33888
TR 28,7,34400
MAV 44,44,112
TR 30,7,34912
s_waitcnt vmcnt(8) lgkmcnt(8)
MAV 32,0,64
TR 32,7,41600
TR 34,7,42112
MAV 32,16,72
buffer_load_dwordx4 v[112:115], v4, s[16:19], s52 offen sc1
MAV 48,16,76
TR 48,7,42624
TR 50,7,43136
MAV 48,0,68
TR 36,7,41632
MAV 52,4,68
buffer_load_dwordx4 v[116:119], v4, s[16:19], s52 offen offset:1024 sc1
MAV 52,20,76
TR 38,7,42144
s_add_u32 s52, s52, 262144
MAV 36,20,72
TR 52,7,42656
MAV 36,4,64
TR 54,7,43168
s_waitcnt lgkmcnt(8)
MAV 40,8,64
buffer_load_dwordx4 v[120:123], v4, s[16:19], s53 offen sc1
MAV 40,24,72
TR 40,7,41664
TR 42,7,42176
MAV 56,24,76
TR 56,7,42688
MAV 56,8,68
TR 58,7,43200
TR 44,7,41696
MAV 60,12,68
buffer_load_dwordx4 v[124:127], v4, s[16:19], s53 offen offset:1024 sc1
MAV 60,28,76
s_add_u32 s53, s53, 262144
MAV 44,28,72
TR 46,7,42208
TR 60,7,42720
MAV 44,12,64
TR 62,7,43232
s_waitcnt vmcnt(8) lgkmcnt(8)
MAV 32,32,80
TR 0,7,49920
TR 2,7,50432
MAV 32,48,88
buffer_load_dwordx4 v[64:67], v4, s[16:19], s52 offen sc1
MAV 48,48,92
TR 16,7,50944
TR 18,7,51456
MAV 48,32,84
TR 4,7,49952
MAV 52,36,84
buffer_load_dwordx4 v[68:71], v4, s[16:19], s52 offen offset:1024 sc1
MAV 52,52,92
TR 6,7,50464
s_add_u32 s52, s52, 262144
MAV 36,52,88
TR 20,7,50976
MAV 36,36,80
TR 22,7,51488
s_waitcnt lgkmcnt(8)
MAV 40,40,80
buffer_load_dwordx4 v[72:75], v4, s[16:19], s53 offen sc1
MAV 40,56,88
TR 8,7,49984
TR 10,7,50496
MAV 56,56,92
TR 24,7,51008
MAV 56,40,84
TR 26,7,51520
TR 12,7,50016
MAV 60,44,84
buffer_load_dwordx4 v[76:79], v4, s[16:19], s53 offen offset:1024 sc1
MAV 60,60,92
s_add_u32 s53, s53, 262144
MAV 44,60,88
TR 14,7,50528
TR 28,7,51040
MAV 44,44,80
TR 30,7,51552
s_waitcnt vmcnt(8) lgkmcnt(8)
MAV 32,0,96
TR 32,7,58240
TR 34,7,58752
MAV 32,16,104
buffer_load_dwordx4 v[80:83], v4, s[16:19], s52 offen sc1
MAV 48,16,108
.Lpad20:
s_cbranch_execz .Lpad23
TR 48,7,59264
TR 50,7,59776
MAV 48,0,100
TR 36,7,58272
MAV 52,4,100
buffer_load_dwordx4 v[84:87], v4, s[16:19], s52 offen offset:1024 sc1
MAV 52,20,108
TR 38,7,58784
s_add_u32 s52, s52, 262144
MAV 36,20,104
TR 52,7,59296
MAV 36,4,96
TR 54,7,59808
s_waitcnt lgkmcnt(8)
MAV 40,8,96
buffer_load_dwordx4 v[88:91], v4, s[16:19], s53 offen sc1
MAV 40,24,104
TR 40,7,58304
TR 42,7,58816
MAV 56,24,108
TR 56,7,59328
MAV 56,8,100
TR 58,7,59840
TR 44,7,58336
MAV 60,12,100
buffer_load_dwordx4 v[92:95], v4, s[16:19], s53 offen offset:1024 sc1
MAV 60,28,108
s_add_u32 s53, s53, 262144
MAV 44,28,104
TR 46,7,58848
TR 60,7,59360
MAV 44,12,96
TR 62,7,59872
s_xor_b32 s57, s57, 66560
v_add_u32 v7, s57, v8
s_waitcnt vmcnt(8) lgkmcnt(8)
MAV 32,32,112
ds_read_b64_tr_b16 a[0:1], v7
TR 2,7,512
MAV 32,48,120
buffer_load_dwordx4 v[96:99], v4, s[16:19], s52 offen sc1
MAV 48,48,124
TR 16,7,1024
TR 18,7,1536
MAV 48,32,116
TR 4,7,32
MAV 52,36,116
buffer_load_dwordx4 v[100:103], v4, s[16:19], s52 offen offset:1024 sc1
MAV 52,52,124
TR 6,7,544
s_add_u32 s52, s52, 262144
MAV 36,52,120
TR 20,7,1056
MAV 36,36,112
TR 22,7,1568
s_waitcnt lgkmcnt(8)
MAV 40,40,112
buffer_load_dwordx4 v[104:107], v4, s[16:19], s53 offen sc1
MAV 40,56,120
TR 8,7,64
TR 10,7,576
MAV 56,56,124
TR 24,7,1088
MAV 56,40,116
TR 26,7,1600
TR 12,7,96
MAV 60,44,116
buffer_load_dwordx4 v[108:111], v4, s[16:19], s53 offen offset:1024 sc1
MAV 60,60,124
s_add_u32 s53, s53, 262144
MAV 44,60,120
TR 14,7,608
TR 28,7,1120
MAV 44,44,112
TR 30,7,1632
s_waitcnt vmcnt(8) lgkmcnt(8)
MAV 32,0,64
TR 32,7,8320
TR 34,7,8832
MAV 32,16,72
buffer_load_dwordx4 v[112:115], v4, s[16:19], s52 offen sc1
MAV 48,16,76
TR 48,7,9344
TR 50,7,9856
MAV 48,0,68
TR 36,7,8352
MAV 52,4,68
buffer_load_dwordx4 v[116:119], v4, s[16:19], s52 offen offset:1024 sc1
MAV 52,20,76
TR 38,7,8864
s_add_u32 s52, s52, 262144
MAV 36,20,72
TR 52,7,9376
MAV 36,4,64
TR 54,7,9888
s_waitcnt lgkmcnt(8)
MAV 40,8,64
buffer_load_dwordx4 v[120:123], v4, s[16:19], s53 offen sc1
MAV 40,24,72
TR 40,7,8384
TR 42,7,8896
MAV 56,24,76
TR 56,7,9408
MAV 56,8,68
TR 58,7,9920
TR 44,7,8416
MAV 60,12,68
buffer_load_dwordx4 v[124:127], v4, s[16:19], s53 offen offset:1024 sc1
MAV 60,28,76
s_add_u32 s53, s53, 262144
MAV 44,28,72
TR 46,7,8928
TR 60,7,9440
MAV 44,12,64
TR 62,7,9952
s_waitcnt vmcnt(8) lgkmcnt(8)
MAV 32,32,80
TR 0,7,16640
TR 2,7,17152
MAV 32,48,88
buffer_load_dwordx4 v[64:67], v4, s[16:19], s52 offen sc1
MAV 48,48,92
TR 16,7,17664
TR 18,7,18176
MAV 48,32,84
TR 4,7,16672
MAV 52,36,84
buffer_load_dwordx4 v[68:71], v4, s[16:19], s52 offen offset:1024 sc1
MAV 52,52,92
TR 6,7,17184
s_add_u32 s52, s52, 262144
MAV 36,52,88
TR 20,7,17696
MAV 36,36,80
TR 22,7,18208
s_waitcnt lgkmcnt(8)
MAV 40,40,80
buffer_load_dwordx4 v[72:75], v4, s[16:19], s53 offen sc1
MAV 40,56,88
TR 8,7,16704
TR 10,7,17216
MAV 56,56,92
TR 24,7,17728
MAV 56,40,84
TR 26,7,18240
TR 12,7,16736
MAV 60,44,84
buffer_load_dwordx4 v[76:79], v4, s[16:19], s53 offen offset:1024 sc1
MAV 60,60,92
s_add_u32 s53, s53, 262144
MAV 44,60,88
TR 14,7,17248
TR 28,7,17760
MAV 44,44,80
TR 30,7,18272
s_waitcnt vmcnt(8) lgkmcnt(8)
MAV 32,0,96
TR 32,7,24960
TR 34,7,25472
MAV 32,16,104
buffer_load_dwordx4 v[80:83], v4, s[16:19], s52 offen sc1
MAV 48,16,108
TR 48,7,25984
TR 50,7,26496
MAV 48,0,100
TR 36,7,24992
MAV 52,4,100
buffer_load_dwordx4 v[84:87], v4, s[16:19], s52 offen offset:1024 sc1
MAV 52,20,108
TR 38,7,25504
s_add_u32 s52, s52, 262144
MAV 36,20,104
TR 52,7,26016
MAV 36,4,96
TR 54,7,26528
s_waitcnt lgkmcnt(8)
MAV 40,8,96
buffer_load_dwordx4 v[88:91], v4, s[16:19], s53 offen sc1
MAV 40,24,104
TR 40,7,25024
TR 42,7,25536
MAV 56,24,108
TR 56,7,26048
MAV 56,8,100
TR 58,7,26560
TR 44,7,25056
MAV 60,12,100
buffer_load_dwordx4 v[92:95], v4, s[16:19], s53 offen offset:1024 sc1
MAV 60,28,108
s_add_u32 s53, s53, 262144
MAV 44,28,104
TR 46,7,25568
TR 60,7,26080
MAV 44,12,96
TR 62,7,26592
s_waitcnt vmcnt(8) lgkmcnt(8)
MAV 32,32,112
TR 0,7,33280
TR 2,7,33792
MAV 32,48,120
buffer_load_dwordx4 v[96:99], v4, s[16:19], s52 offen sc1
MAV 48,48,124
TR 16,7,34304
TR 18,7,34816
MAV 48,32,116
TR 4,7,33312
MAV 52,36,116
buffer_load_dwordx4 v[100:103], v4, s[16:19], s52 offen offset:1024 sc1
MAV 52,52,124
TR 6,7,33824
s_add_u32 s52, s52, 262144
MAV 36,52,120
TR 20,7,34336
MAV 36,36,112
TR 22,7,34848
s_waitcnt lgkmcnt(8)
MAV 40,40,112
buffer_load_dwordx4 v[104:107], v4, s[16:19], s53 offen sc1
MAV 40,56,120
TR 8,7,33344
TR 10,7,33856
MAV 56,56,124
TR 24,7,34368
MAV 56,40,116
TR 26,7,34880
TR 12,7,33376
MAV 60,44,116
buffer_load_dwordx4 v[108:111], v4, s[16:19], s53 offen offset:1024 sc1
MAV 60,60,124
s_add_u32 s53, s53, 262144
MAV 44,60,120
TR 14,7,33888
TR 28,7,34400
MAV 44,44,112
TR 30,7,34912
s_waitcnt vmcnt(8) lgkmcnt(8)
MAV 32,0,64
TR 32,7,41600
TR 34,7,42112
MAV 32,16,72
buffer_load_dwordx4 v[112:115], v4, s[16:19], s52 offen sc1
MAV 48,16,76
TR 48,7,42624
TR 50,7,43136
MAV 48,0,68
TR 36,7,41632
MAV 52,4,68
buffer_load_dwordx4 v[116:119], v4, s[16:19], s52 offen offset:1024 sc1
MAV 52,20,76
TR 38,7,42144
s_add_u32 s52, s52, 262144
MAV 36,20,72
TR 52,7,42656
MAV 36,4,64
TR 54,7,43168
s_waitcnt lgkmcnt(8)
MAV 40,8,64
buffer_load_dwordx4 v[120:123], v4, s[16:19], s53 offen sc1
MAV 40,24,72
TR 40,7,41664
TR 42,7,42176
MAV 56,24,76
TR 56,7,42688
MAV 56,8,68
TR 58,7,43200
TR 44,7,41696
MAV 60,12,68
buffer_load_dwordx4 v[124:127], v4, s[16:19], s53 offen offset:1024 sc1
MAV 60,28,76
s_add_u32 s53, s53, 262144
MAV 44,28,72
TR 46,7,42208
TR 60,7,42720
MAV 44,12,64
TR 62,7,43232
s_barrier
s_waitcnt vmcnt(8) lgkmcnt(8)
MAV 32,32,80
TR 0,7,49920
s_add_u32 m0, s59, 84480
MAV 32,48,88
buffer_load_dwordx4 v12, s[32:35], s58 offen   lds
MAV 48,48,92
TR 2,7,50432
TR 16,7,50944
MAV 48,32,84
TR 18,7,51456
MAV 52,36,84
buffer_load_dwordx4 v13, s[32:35], s58 offen offset:1056   lds
MAV 52,52,92
TR 4,7,49952
TR 6,7,50464
MAV 36,52,88
TR 20,7,50976
MAV 36,36,80
TR 22,7,51488
s_waitcnt lgkmcnt(8)
MAV 40,40,80
buffer_load_dwordx4 v14, s[32:35], s58 offen offset:2112   lds
MAV 40,56,88
TR 8,7,49984
MAV 56,56,92
TR 10,7,50496
TR 24,7,51008
MAV 56,40,84
TR 26,7,51520
MAV 60,44,84
buffer_load_dwordx4 v15, s[32:35], s58 offen offset:3168   lds
MAV 60,60,92
TR 12,7,50016
TR 14,7,50528
MAV 44,60,88
TR 28,7,51040
MAV 44,44,80
TR 30,7,51552
s_waitcnt vmcnt(8) lgkmcnt(8)
MAV 32,0,96
TR 32,7,58240
s_add_u32 m0, s59, 101376
MAV 32,16,104
buffer_load_dwordx4 v12, s[80:83], s58 offen   lds
MAV 48,16,108
TR 34,7,58752
TR 48,7,59264
MAV 48,0,100
TR 50,7,59776
MAV 52,4,100
buffer_load_dwordx4 v13, s[80:83], s58 offen offset:1056   lds
MAV 52,20,108
TR 36,7,58272
TR 38,7,58784
MAV 36,20,104
TR 52,7,59296
MAV 36,4,96
TR 54,7,59808
s_waitcnt lgkmcnt(8)
MAV 40,8,96
buffer_load_dwordx4 v14, s[80:83], s58 offen offset:2112   lds
MAV 40,24,104
TR 40,7,58304
TR 42,7,58816
MAV 56,24,108
TR 56,7,59328
MAV 56,8,100
TR 58,7,59840
TR 44,7,58336
MAV 60,12,100
buffer_load_dwordx4 v15, s[80:83], s58 offen offset:3168   lds
MAV 60,28,108
s_add_u32 s58, s58, 458752
MAV 44,28,104
TR 46,7,58848
TR 60,7,59360
MAV 44,12,96
TR 62,7,59872
s_waitcnt vmcnt(11) lgkmcnt(14)
MAV 32,32,112
s_add_u32 m0, s59, 118272
s_lshl_b32 s64, s6, 14
s_lshl_b32 s65, s49, 13
s_waitcnt vmcnt(9) lgkmcnt(12)
MAV 32,48,120
buffer_load_dwordx4 v12, s[32:35], s58 offen   lds
s_waitcnt vmcnt(9)
MAV 48,48,124
s_add_u32 s64, s64, s65
s_lshl_b32 s65, s7, 9
s_add_u32 s64, s64, s65
MAV 48,32,116
s_lshl_b32 s65, s48, 8
s_add_u32 s64, s64, s65
s_add_u32 s64, s64, 63176704
s_waitcnt lgkmcnt(10)
MAV 52,36,116
s_lshl_b32 s62, s7, 18
v_and_b32 v152, 31, v1
v_lshlrev_b32 v152, 3, v152
s_waitcnt lgkmcnt(8)
MAV 52,52,124
buffer_load_dwordx4 v13, s[32:35], s58 offen offset:1056   lds
MAV 36,52,120
s_add_u32 s62, s62, 41943040
v_lshrrev_b32 v153, 5, v1
v_lshl_add_u32 v152, v153, 28, v152
MAV 36,36,112
s_add_u32 s63, s62, 131072
v_cvt_pk_bf16_f32 v128, v32, v33
v_cvt_pk_bf16_f32 v129, v34, v35
s_waitcnt lgkmcnt(6)
MAV 40,40,112
v_cvt_pk_bf16_f32 v136, v48, v49
v_cvt_pk_bf16_f32 v137, v50, v51
s_waitcnt lgkmcnt(4)
MAV 40,56,120
buffer_load_dwordx4 v14, s[32:35], s58 offen offset:2112   lds
MAV 56,56,124
v_cvt_pk_bf16_f32 v130, v36, v37
v_cvt_pk_bf16_f32 v131, v38, v39
MAV 56,40,116
s_nop 2
v_cvt_pk_bf16_f32 v132, v40, v41
v_cvt_pk_bf16_f32 v133, v42, v43
s_waitcnt lgkmcnt(2)
MAV 60,44,116
v_cvt_pk_bf16_f32 v138, v52, v53
v_cvt_pk_bf16_f32 v139, v54, v55
s_waitcnt lgkmcnt(0)
MAV 60,60,124
buffer_load_dwordx4 v15, s[32:35], s58 offen offset:3168   lds
MAV 44,60,120
v_cvt_pk_bf16_f32 v140, v56, v57
v_cvt_pk_bf16_f32 v141, v58, v59
MAV 44,44,112
s_nop 2
v_cvt_pk_bf16_f32 v142, v60, v61
v_cvt_pk_bf16_f32 v143, v62, v63
v_pk_mul_f32 v[146:147], v[32:33], v[32:33]
v_pk_mul_f32 v[150:151], v[48:49], v[48:49]
buffer_store_dwordx4 v[128:131], v4, s[16:19], s62 offen sc1
v_cvt_pk_bf16_f32 v134, v44, v45
v_cvt_pk_bf16_f32 v135, v46, v47
v_pk_fma_f32 v[146:147], v[34:35], v[34:35], v[146:147]
v_pk_add_f32 v[144:145], v[32:33], v[34:35]
v_pk_fma_f32 v[150:151], v[50:51], v[50:51], v[150:151]
v_pk_add_f32 v[148:149], v[48:49], v[50:51]
v_pk_fma_f32 v[146:147], v[36:37], v[36:37], v[146:147]
v_pk_add_f32 v[144:145], v[144:145], v[36:37]
v_pk_fma_f32 v[150:151], v[52:53], v[52:53], v[150:151]
v_pk_add_f32 v[148:149], v[148:149], v[52:53]
v_pk_fma_f32 v[146:147], v[38:39], v[38:39], v[146:147]
v_pk_add_f32 v[144:145], v[144:145], v[38:39]
v_pk_fma_f32 v[150:151], v[54:55], v[54:55], v[150:151]
buffer_store_dwordx4 v[132:135], v4, s[16:19], s63 offen sc1
v_pk_add_f32 v[148:149], v[148:149], v[54:55]
v_pk_fma_f32 v[146:147], v[40:41], v[40:41], v[146:147]
v_pk_add_f32 v[144:145], v[144:145], v[40:41]
v_pk_fma_f32 v[150:151], v[56:57], v[56:57], v[150:151]
v_pk_add_f32 v[148:149], v[148:149], v[56:57]
v_pk_fma_f32 v[146:147], v[42:43], v[42:43], v[146:147]
v_pk_add_f32 v[144:145], v[144:145], v[42:43]
v_pk_fma_f32 v[150:151], v[58:59], v[58:59], v[150:151]
v_pk_add_f32 v[148:149], v[148:149], v[58:59]
v_pk_fma_f32 v[146:147], v[44:45], v[44:45], v[146:147]
v_pk_add_f32 v[144:145], v[144:145], v[44:45]
v_pk_fma_f32 v[150:151], v[60:61], v[60:61], v[150:151]
v_pk_add_f32 v[148:149], v[148:149], v[60:61]
buffer_store_dwordx4 v[136:139], v4, s[16:19], s62 offen offset:1024 sc1
v_pk_fma_f32 v[146:147], v[46:47], v[46:47], v[146:147]
v_pk_add_f32 v[144:145], v[144:145], v[46:47]
v_pk_fma_f32 v[150:151], v[62:63], v[62:63], v[150:151]
v_pk_add_f32 v[148:149], v[148:149], v[62:63]
v_add_f32 v144, v144, v145
v_add_f32 v146, v146, v147
v_add_f32 v148, v148, v149
v_add_f32 v150, v150, v151
s_nop 0
v_permlane16_swap_b32 v144, v148
v_permlane16_swap_b32 v146, v150
v_add_f32 v144, v144, v148
buffer_store_dwordx4 v[140:143], v4, s[16:19], s63 offen offset:1024 sc1
v_add_f32 v146, v146, v150
s_nop 1
v_permlane32_swap_b32 v144, v146
v_add_f32 v144, v144, v146
s_nop 1
v_permlane32_swap_b32 v144, v145
buffer_store_dwordx2 v[144:145], v152, s[16:19], s64 offen sc1
s_nop 1
v_accvgpr_write_b32 a224, v32
v_accvgpr_write_b32 a225, v33
v_accvgpr_write_b32 a226, v34
v_accvgpr_write_b32 a227, v35
v_accvgpr_write_b32 a228, v36
v_accvgpr_write_b32 a229, v37
v_accvgpr_write_b32 a230, v38
v_accvgpr_write_b32 a231, v39
v_accvgpr_write_b32 a232, v40
v_accvgpr_write_b32 a233, v41
v_accvgpr_write_b32 a234, v42
v_accvgpr_write_b32 a235, v43
v_accvgpr_write_b32 a236, v44
v_accvgpr_write_b32 a237, v45
v_accvgpr_write_b32 a238, v46
v_accvgpr_write_b32 a239, v47
v_accvgpr_write_b32 a240, v48
v_accvgpr_write_b32 a241, v49
v_accvgpr_write_b32 a242, v50
v_accvgpr_write_b32 a243, v51
v_accvgpr_write_b32 a244, v52
v_accvgpr_write_b32 a245, v53
v_accvgpr_write_b32 a246, v54
v_accvgpr_write_b32 a247, v55
v_accvgpr_write_b32 a248, v56
v_accvgpr_write_b32 a249, v57
v_accvgpr_write_b32 a250, v58
v_accvgpr_write_b32 a251, v59
v_accvgpr_write_b32 a252, v60
v_accvgpr_write_b32 a253, v61
v_accvgpr_write_b32 a254, v62
v_accvgpr_write_b32 a255, v63
s_lshl_b32 s62, s10, 14
s_lshl_b32 s63, s3, 12
s_add_u32 s62, s62, s63
s_lshl_b32 s63, s12, 11
s_add_u32 s62, s62, s63
v_lshl_add_u32 v10, v1, 4, s62
v_lshrrev_b32 v2, 3, v1
v_cmp_eq_u32 vcc, 3, v2
v_add_u32 v2, 67108480, v10
s_nop 0
v_cndmask_b32 v10, v10, v2, vcc
v_xor_b32 v11, 2048, v10
v_bfe_u32 v16, v1, 2, 3
v_mul_u32_u24 v16, 1056, v16
v_bfe_u32 v2, v1, 5, 1
v_lshl_add_u32 v16, v2, 8, v16
v_and_b32 v2, 3, v1
v_lshl_add_u32 v16, v2, 3, v16
s_lshl_b32 s62, s12, 6
s_add_u32 s62, s62, 84480
s_xor_b32 s63, s12, 1
s_mul_i32 s63, s63, 192
s_add_u32 s63, s63, 84480
v_add_u32 v17, s63, v16
v_add_u32 v16, s62, v16
s_mov_b32 s52, 41943040
s_mov_b32 s53, 41943040
s_mov_b32 s54, s58
s_mov_b32 s55, s59
s_mul_i32 s59, s3, 2112
s_and_b32 s62, s7, 1
s_mul_i32 s62, s62, 3670016
s_lshr_b32 s63, s7, 1
s_lshl_b32 s63, s63, 8
s_add_u32 s62, s62, s63
s_lshl_b32 s63, s3, 12
s_add_u32 s62, s62, s63
v_lshrrev_b32 v5, 4, v1
v_lshlrev_b32 v5, 14, v5
v_and_b32 v2, 15, v1
v_lshl_add_u32 v5, v2, 4, v5
v_add_u32 v5, s62, v5
v_add_u32 v6, 992, v5
s_lshl_b32 s62, s10, 15
s_lshl_b32 s63, s3, 13
s_add_u32 s62, s62, s63
v_lshl_add_u32 v4, v1, 4, s62
s_lshl_b32 s62, s6, 10
s_add_u32 s62, s62, 30507008
s_lshl_b32 s64, s10, 1
s_lshl_b32 s64, s64, 10
s_add_u32 s64, s64, 30507008
s_lshr_b32 s67, s5, 2
s_and_b32 s67, s67, 3
s_lshl_b32 s67, s67, 7
s_add_u32 s64, s64, s67
s_add_u32 s65, s64, 1024
.Lpad21:
s_cbranch_execz .Lpad24
v_lshl_add_u32 v252, v1, 7, s62
v_mov_b32 v253, s64
v_mov_b32 v255, 1
v_writelane_b32 v253, s65, 1
s_waitcnt vmcnt(0) lgkmcnt(0)
s_cmp_lg_u32 s3, 1
s_barrier
s_cbranch_scc1 .Lnopoll63
s_mov_b64 exec, 15
buffer_atomic_add v255, v252, s[16:19], 0 offen
s_mov_b64 exec, 3
v_mov_b32 v254, 0
buffer_atomic_add v254, v253, s[16:19], 0 offen sc0
s_sleep 5
s_mov_b32 s15, 0
.Lpoll62:
v_mov_b32 v255, 0
buffer_atomic_add v255, v253, s[16:19], 0 offen sc0
s_waitcnt vmcnt(1)
v_cmp_gt_u32 vcc, 16, v254
s_add_u32 s15, s15, 1
s_cbranch_vccz .Lnopoll63r
v_mov_b32 v254, 0
buffer_atomic_add v254, v253, s[16:19], 0 offen sc0
s_waitcnt vmcnt(1)
v_cmp_gt_u32 vcc, 16, v255
s_add_u32 s15, s15, 1
s_cbranch_vccz .Lnopoll63r
s_cmp_le_u32 s15, 100000
s_cbranch_scc1 .Lpoll62
s_branch .Lnopoll63r
.Lnopoll63:
s_mov_b64 exec, 0
s_cmp_eq_u32 s3, 2
s_cbranch_scc1 .Lpad26
s_cmp_eq_u32 s3, 3
s_cbranch_scc1 .Lpad27
s_branch .Lpad28
.Lnopoll63r:
s_mov_b64 exec, -1
s_barrier
buffer_load_dwordx4 a[128:131], v10, s[16:19], s52 offen sc1
buffer_load_dwordx4 a[132:135], v10, s[16:19], s52 offen offset:1024 sc1
s_add_u32 s52, s52, 131072
buffer_load_dwordx4 a[144:147], v10, s[16:19], s52 offen sc1
buffer_load_dwordx4 a[148:151], v10, s[16:19], s52 offen offset:1024 sc1
s_add_u32 s52, s52, 131072
buffer_load_dwordx4 a[136:139], v11, s[16:19], s53 offen sc1
buffer_load_dwordx4 a[140:143], v11, s[16:19], s53 offen offset:1024 sc1
s_add_u32 s53, s53, 131072
buffer_load_dwordx4 a[152:155], v11, s[16:19], s53 offen sc1
buffer_load_dwordx4 a[156:159], v11, s[16:19], s53 offen offset:1024 sc1
s_add_u32 s53, s53, 131072
ds_read_b64_tr_b16 a[0:1], v16
TR 2,16,512
TR 4,16,8448
TR 6,16,8960
TR 8,16,32
TR 10,16,544
TR 12,16,8480
TR 14,16,8992
TR 16,16,64
TR 18,16,576
TR 20,16,8512
TR 22,16,9024
TR 24,16,96
TR 26,16,608
TR 28,16,8544
TR 30,16,9056
TR 32,16,128
TR 34,16,640
TR 36,16,8576
TR 38,16,9088
TR 40,16,160
TR 42,16,672
TR 44,16,8608
TR 46,16,9120
ds_read_b64_tr_b16 a[48:49], v17
TR 50,17,512
TR 52,17,8448
TR 54,17,8960
TR 56,17,32
TR 58,17,544
TR 60,17,8480
TR 62,17,8992
s_add_u32 m0, s55, 135168
s_nop 0
buffer_load_dwordx4 v12, s[80:83], s54 offen   lds
buffer_load_dwordx4 v13, s[80:83], s54 offen offset:1056   lds
buffer_load_dwordx4 v14, s[80:83], s54 offen offset:2112   lds
buffer_load_dwordx4 v15, s[80:83], s54 offen offset:3168   lds
s_add_u32 s54, s54, 458752
s_lshl_b32 s57, s3, 13
s_add_u32 s57, s57, 49920
v_lshl_add_u32 v2, v1, 4, s57
s_waitcnt lgkmcnt(0)
s_barrier
s_waitcnt vmcnt(11)
v_mfma_f32_16x16x32_bf16 v[32:35], a[0:3], a[128:131], 0
buffer_load_dwordx4 a[160:163], v10, s[16:19], s52 offen sc1
s_waitcnt vmcnt(10)
MAA 32,4,144
TR 64,16,16896
v_mfma_f32_16x16x32_bf16 v[36:39], a[0:3], a[132:135], 0
TR 66,16,17408
s_waitcnt vmcnt(9)
MAA 36,4,148
TR 68,16,25344
v_mfma_f32_16x16x32_bf16 v[52:55], a[8:11], a[132:135], 0
buffer_load_dwordx4 a[164:167], v10, s[16:19], s52 offen offset:1024 sc1
MAA 52,12,148
TR 70,16,25856
s_add_u32 s52, s52, 131072
v_mfma_f32_16x16x32_bf16 v[48:51], a[8:11], a[128:131], 0
TR 72,16,16928
MAA 48,12,144
TR 74,16,17440
v_mfma_f32_16x16x32_bf16 v[96:99], a[16:19], a[128:131], 0
buffer_load_dwordx4 a[176:179], v10, s[16:19], s52 offen sc1
MAA 96,20,144
TR 76,16,25376
v_mfma_f32_16x16x32_bf16 v[100:103], a[16:19], a[132:135], 0
TR 78,16,25888
MAA 100,20,148
TR 80,16,16960
v_mfma_f32_16x16x32_bf16 v[116:119], a[24:27], a[132:135], 0
buffer_load_dwordx4 a[180:183], v10, s[16:19], s52 offen offset:1024 sc1
MAA 116,28,148
TR 82,16,17472
s_add_u32 s52, s52, 131072
v_mfma_f32_16x16x32_bf16 v[112:115], a[24:27], a[128:131], 0
TR 84,16,25408
MAA 112,28,144
TR 86,16,25920
v_mfma_f32_16x16x32_bf16 v[160:163], a[32:35], a[128:131], 0
buffer_load_dwordx4 a[168:171], v11, s[16:19], s53 offen sc1
MAA 160,36,144
TR 88,16,16992
v_mfma_f32_16x16x32_bf16 v[164:167], a[32:35], a[132:135], 0
TR 90,16,17504
MAA 164,36,148
TR 92,16,25440
v_mfma_f32_16x16x32_bf16 v[180:183], a[40:43], a[132:135], 0
buffer_load_dwordx4 a[172:175], v11, s[16:19], s53 offen offset:1024 sc1
MAA 180,44,148
TR 94,16,25952
s_add_u32 s53, s53, 131072
v_mfma_f32_16x16x32_bf16 v[176:179], a[40:43], a[128:131], 0
TR 96,16,17024
MAA 176,44,144
TR 98,16,17536
v_mfma_f32_16x16x32_bf16 v[224:227], a[48:51], a[128:131], 0
buffer_load_dwordx4 a[184:187], v11, s[16:19], s53 offen sc1
MAA 224,52,144
TR 100,16,25472
v_mfma_f32_16x16x32_bf16 v[228:231], a[48:51], a[132:135], 0
TR 102,16,25984
MAA 228,52,148
TR 104,16,17056
v_mfma_f32_16x16x32_bf16 v[236:239], a[56:59], a[132:135], 0
buffer_load_dwordx4 a[188:191], v11, s[16:19], s53 offen offset:1024 sc1
MAA 236,60,148
TR 106,16,17568
s_add_u32 s53, s53, 131072
v_mfma_f32_16x16x32_bf16 v[232:235], a[56:59], a[128:131], 0
TR 108,16,25504
s_add_u32 m0, s55, 84480
MAA 232,60,144
TR 110,16,26016
s_waitcnt vmcnt(12)
v_mfma_f32_16x16x32_bf16 v[188:191], a[40:43], a[140:143], 0
buffer_load_dwordx4 v12, s[32:35], s54 offen   lds
MAA 188,44,156
TR 112,17,16896
v_mfma_f32_16x16x32_bf16 v[184:187], a[40:43], a[136:139], 0
TR 114,17,17408
MAA 184,44,152
TR 116,17,25344
v_mfma_f32_16x16x32_bf16 v[168:171], a[32:35], a[136:139], 0
buffer_load_dwordx4 v13, s[32:35], s54 offen offset:1056   lds
MAA 168,36,152
TR 118,17,25856
v_mfma_f32_16x16x32_bf16 v[172:175], a[32:35], a[140:143], 0
TR 120,17,16928
MAA 172,36,156
TR 122,17,17440
v_mfma_f32_16x16x32_bf16 v[124:127], a[24:27], a[140:143], 0
buffer_load_dwordx4 v14, s[32:35], s54 offen offset:2112   lds
MAA 124,28,156
TR 124,17,25376
v_mfma_f32_16x16x32_bf16 v[120:123], a[24:27], a[136:139], 0
TR 126,17,25888
MAA 120,28,152
v_mfma_f32_16x16x32_bf16 v[104:107], a[16:19], a[136:139], 0
buffer_load_dwordx4 v15, s[32:35], s54 offen offset:3168   lds
MAA 104,20,152
v_mfma_f32_16x16x32_bf16 v[108:111], a[16:19], a[140:143], 0
MAA 108,20,156
v_mfma_f32_16x16x32_bf16 v[60:63], a[8:11], a[140:143], 0
MAA 60,12,156
v_mfma_f32_16x16x32_bf16 v[56:59], a[8:11], a[136:139], 0
MAA 56,12,152
v_mfma_f32_16x16x32_bf16 v[40:43], a[0:3], a[136:139], 0
MAA 40,4,152
v_mfma_f32_16x16x32_bf16 v[44:47], a[0:3], a[140:143], 0
MAA 44,4,156
s_waitcnt lgkmcnt(0)
s_barrier
v_mfma_f32_16x16x32_bf16 v[64:67], a[64:67], a[128:131], 0
TR 0,16,33792
s_add_u32 m0, s55, 101376
MAA 64,68,144
buffer_load_dwordx4 v12, s[80:83], s54 offen   lds
v_mfma_f32_16x16x32_bf16 v[68:71], a[64:67], a[132:135], 0
TR 2,16,34304
s_mul_i32 s66, s13, 114688
MAA 68,68,148
TR 4,16,42240
s_mul_i32 s65, s10, 1818624
v_mfma_f32_16x16x32_bf16 v[84:87], a[72:75], a[132:135], 0
TR 6,16,42752
s_add_u32 s66, s66, s65
MAA 84,76,148
TR 8,16,33824
s_add_u32 s66, s66, 46137344
v_mfma_f32_16x16x32_bf16 v[80:83], a[72:75], a[128:131], 0
buffer_load_dwordx4 v13, s[80:83], s54 offen offset:1056   lds
MAA 80,76,144
TR 10,16,34336
s_add_u32 s65, s66, 49152
v_mfma_f32_16x16x32_bf16 v[128:131], a[80:83], a[128:131], 0
TR 12,16,42272
s_lshl_b32 s62, s12, 16
MAA 128,84,144
TR 14,16,42784
s_add_u32 s62, s62, s66
v_mfma_f32_16x16x32_bf16 v[132:135], a[80:83], a[132:135], 0
TR 16,16,33856
s_add_u32 s63, s62, 16384
MAA 132,84,148
buffer_load_dwordx4 v14, s[80:83], s54 offen offset:2112   lds
v_mfma_f32_16x16x32_bf16 v[148:151], a[88:91], a[132:135], 0
TR 18,16,34368
s_add_u32 s64, s62, 32768
MAA 148,92,148
TR 20,16,42304
s_lshl_b32 s72, s10, 1
v_mfma_f32_16x16x32_bf16 v[144:147], a[88:91], a[128:131], 0
TR 22,16,42816
s_lshr_b32 s74, s11, 4
MAA 144,92,144
TR 24,16,33888
s_add_u32 s72, s72, s74
v_mfma_f32_16x16x32_bf16 v[192:195], a[96:99], a[128:131], 0
buffer_load_dwordx4 v15, s[80:83], s54 offen offset:3168   lds
MAA 192,100,144
TR 26,16,34400
s_add_u32 s54, s54, 458752
v_mfma_f32_16x16x32_bf16 v[196:199], a[96:99], a[132:135], 0
TR 28,16,42336
s_add_u32 m0, s57, 0
MAA 196,100,148
TR 30,16,42848
s_mov_b32 s58, 63176704
v_mfma_f32_16x16x32_bf16 v[212:215], a[104:107], a[132:135], 0
TR 32,16,33920
s_lshl_b32 s72, s72, 10
MAA 212,108,148
buffer_load_dwordx4 v4, s[16:19], s58 offen sc1 lds
v_mfma_f32_16x16x32_bf16 v[208:211], a[104:107], a[128:131], 0
TR 34,16,34432
s_add_u32 s72, s72, 30523392
MAA 208,108,144
TR 36,16,42368
s_and_b32 s73, s6, 14
v_mfma_f32_16x16x32_bf16 v[240:243], a[112:115], a[128:131], 0
TR 38,16,42880
s_and_b32 s74, s7, 1
MAA 240,116,144
TR 40,16,33952
s_add_u32 s73, s73, s74
v_mfma_f32_16x16x32_bf16 v[244:247], a[112:115], a[132:135], 0
buffer_load_dwordx4 v4, s[16:19], s58 offen offset:1024 sc1 lds
MAA 244,116,148
TR 42,16,34464
s_lshl_b32 s73, s73, 10
v_mfma_f32_16x16x32_bf16 v[252:255], a[120:123], a[132:135], 0
TR 44,16,42400
s_add_u32 s73, s73, 30523392
MAA 252,124,148
TR 46,16,42912
s_lshr_b32 s67, s5, 2
v_mfma_f32_16x16x32_bf16 v[248:251], a[120:123], a[128:131], 0
TR 48,17,33792
s_and_b32 s67, s67, 3
MAA 248,124,144
buffer_load_dwordx4 a[128:131], v10, s[16:19], s52 offen sc1
v_mfma_f32_16x16x32_bf16 v[220:223], a[104:107], a[140:143], 0
TR 50,17,34304
s_lshl_b32 s67, s67, 7
MAA 220,108,156
TR 52,17,42240
s_add_u32 s73, s73, s67
v_mfma_f32_16x16x32_bf16 v[216:219], a[104:107], a[136:139], 0
TR 54,17,42752
MAA 216,108,152
TR 56,17,33824
v_mfma_f32_16x16x32_bf16 v[200:203], a[96:99], a[136:139], 0
buffer_load_dwordx4 a[132:135], v10, s[16:19], s52 offen offset:1024 sc1
MAA 200,100,152
TR 58,17,34336
s_add_u32 s52, s52, 131072
v_mfma_f32_16x16x32_bf16 v[204:207], a[96:99], a[140:143], 0
TR 60,17,42272
MAA 204,100,156
TR 62,17,42784
v_mfma_f32_16x16x32_bf16 v[156:159], a[88:91], a[140:143], 0
MAA 156,92,156
buffer_load_dwordx4 a[144:147], v10, s[16:19], s52 offen sc1
v_mfma_f32_16x16x32_bf16 v[152:155], a[88:91], a[136:139], 0
MAA 152,92,152
v_mfma_f32_16x16x32_bf16 v[136:139], a[80:83], a[136:139], 0
MAA 136,84,152
v_mfma_f32_16x16x32_bf16 v[140:143], a[80:83], a[140:143], 0
buffer_load_dwordx4 a[148:151], v10, s[16:19], s52 offen offset:1024 sc1
MAA 140,84,156
s_add_u32 s52, s52, 131072
v_mfma_f32_16x16x32_bf16 v[92:95], a[72:75], a[140:143], 0
MAA 92,76,156
v_mfma_f32_16x16x32_bf16 v[88:91], a[72:75], a[136:139], 0
MAA 88,76,152
v_mfma_f32_16x16x32_bf16 v[72:75], a[64:67], a[136:139], 0
MAA 72,68,152
v_mfma_f32_16x16x32_bf16 v[76:79], a[64:67], a[140:143], 0
MAA 76,68,156
s_waitcnt vmcnt(18) lgkmcnt(0)
s_barrier
MAA 32,0,160
buffer_load_dwordx4 a[136:139], v11, s[16:19], s53 offen sc1
MAA 32,4,176
TR 64,16,50688
s_and_b32 s74, s7, 1
MAA 36,4,180
TR 66,16,51200
s_mul_i32 s87, s74, 917504
MAA 36,0,164
TR 68,16,59136
s_lshr_b32 s75, s6, 1
MAA 52,8,164
TR 70,16,59648
s_mul_i32 s75, s75, 1818624
MAA 52,12,180
buffer_load_dwordx4 a[140:143], v11, s[16:19], s53 offen offset:1024 sc1
MAA 48,12,176
TR 72,16,50720
s_add_u32 s53, s53, 131072
MAA 48,8,160
TR 74,16,51232
s_add_u32 s87, s87, s75
MAA 96,16,160
TR 76,16,59168
s_add_u32 s87, s87, 46137344
MAA 96,20,176
TR 78,16,59680
s_and_b32 s74, s6, 3
MAA 100,20,180
buffer_load_dwordx4 a[152:155], v11, s[16:19], s53 offen sc1
MAA 100,16,164
TR 80,16,50752
s_xor_b32 s75, s74, 0
MAA 116,24,164
TR 82,16,51264
s_sub_u32 s75, s75, 0
MAA 116,28,180
TR 84,16,59200
s_mul_i32 s98, s75, 458752
MAA 112,28,176
TR 86,16,59712
s_mul_i32 s75, s75, 114688
MAA 112,24,160
buffer_load_dwordx4 a[156:159], v11, s[16:19], s53 offen offset:1024 sc1
MAA 160,32,160
TR 88,16,50784
s_add_u32 s53, s53, 131072
MAA 160,36,176
TR 90,16,51296
s_add_u32 m0, s55, 118272
MAA 164,36,180
TR 92,16,59232
s_add_u32 s76, s87, s75
MAA 164,32,164
TR 94,16,59744
s_xor_b32 s75, s74, 1
MAA 180,40,164
buffer_load_dwordx4 v12, s[32:35], s54 offen   lds
MAA 180,44,180
TR 96,16,50816
s_sub_u32 s75, s75, 1
MAA 176,44,176
TR 98,16,51328
s_mul_i32 s99, s75, 458752
MAA 176,40,160
TR 100,16,59264
s_mul_i32 s75, s75, 114688
MAA 224,48,160
TR 102,16,59776
s_add_u32 s77, s87, s75
MAA 224,52,176
buffer_load_dwordx4 v13, s[32:35], s54 offen offset:1056   lds
MAA 228,52,180
TR 104,16,50848
s_xor_b32 s75, s74, 2
MAA 228,48,164
TR 106,16,51360
s_sub_u32 s75, s75, 2
MAA 236,56,164
TR 108,16,59296
s_mul_i32 s100, s75, 458752
MAA 236,60,180
TR 110,16,59808
s_mul_i32 s75, s75, 114688
MAA 232,60,176
buffer_load_dwordx4 v14, s[32:35], s54 offen offset:2112   lds
MAA 232,56,160
TR 112,17,50688
s_add_u32 s78, s87, s75
s_waitcnt vmcnt(21)
MAA 188,40,172
TR 114,17,51200
s_xor_b32 s75, s74, 3
MAA 188,44,188
TR 116,17,59136
MAA 184,44,184
TR 118,17,59648
MAA 184,40,168
buffer_load_dwordx4 v15, s[32:35], s54 offen offset:3168   lds
MAA 168,32,168
TR 120,17,50720
s_add_u32 m0, s57, 2048
MAA 168,36,184
TR 122,17,51232
s_mov_b32 s58, 63178752
MAA 172,36,188
TR 124,17,59168
MAA 172,32,172
TR 126,17,59680
MAA 124,24,172
buffer_load_dwordx4 v4, s[16:19], s58 offen sc1 lds
MAA 124,28,188
MAA 120,28,184
MAA 120,24,168
MAA 104,16,168
MAA 104,20,184
buffer_load_dwordx4 v4, s[16:19], s58 offen offset:1024 sc1 lds
MAA 108,20,188
MAA 108,16,172
MAA 60,8,172
MAA 60,12,188
MAA 56,12,184
MAA 56,8,168
MAA 40,0,168
MAA 40,4,184
MAA 44,4,188
MAA 44,0,172
s_waitcnt vmcnt(20) lgkmcnt(0)
s_barrier
MAA 64,64,160
ds_read_b64_tr_b16 a[0:1], v16
s_add_u32 m0, s55, 135168
MAA 64,68,176
buffer_load_dwordx4 v12, s[80:83], s54 offen   lds
MAA 68,68,180
TR 2,16,512
s_sub_u32 s75, s75, 3
MAA 68,64,164
TR 4,16,8448
s_mul_i32 s101, s75, 458752
MAA 84,72,164
TR 6,16,8960
s_mul_i32 s75, s75, 114688
MAA 84,76,180
TR 8,16,32
s_add_u32 s79, s87, s75
MAA 80,76,176
buffer_load_dwordx4 v13, s[80:83], s54 offen offset:1056   lds
MAA 80,72,160
TR 10,16,544
s_and_b32 s87, s6, 3
MAA 128,80,160
TR 12,16,8480
s_mov_b32 s46, 0
MAA 128,84,176
TR 14,16,8992
s_lshl_b32 s74, s3, 10
MAA 132,84,180
TR 16,16,64
s_lshl_b32 s75, s12, 9
MAA 132,80,164
buffer_load_dwordx4 v14, s[80:83], s54 offen offset:2112   lds
MAA 148,88,164
TR 18,16,576
s_add_u32 s74, s74, s75
MAA 148,92,180
TR 20,16,8512
s_add_u32 s74, s74, 152576
MAA 144,92,176
TR 22,16,9024
v_and_b32 v18, 15, v1
MAA 144,88,160
TR 24,16,96
v_lshl_add_u32 v18, v18, 4, s74
MAA 192,96,160
buffer_load_dwordx4 v15, s[80:83], s54 offen offset:3168   lds
MAA 192,100,176
TR 26,16,608
s_add_u32 s54, s54, 458752
MAA 196,100,180
TR 28,16,8544
s_add_u32 m0, s57, 4096
MAA 196,96,164
TR 30,16,9056
s_mov_b32 s58, 63180800
MAA 212,104,164
TR 32,16,128
v_xor_b32 v19, 512, v18
MAA 212,108,180
buffer_load_dwordx4 v4, s[16:19], s58 offen sc1 lds
MAA 208,108,176
TR 34,16,640
s_lshl_b32 s74, s12, 7
MAA 208,104,160
TR 36,16,8576
s_add_u32 s74, s74, 161536
MAA 240,112,160
TR 38,16,9088
s_xor_b32 s75, s12, 1
MAA 240,116,176
TR 40,16,160
s_mul_i32 s75, s75, 384
MAA 244,116,180
buffer_load_dwordx4 v4, s[16:19], s58 offen offset:1024 sc1 lds
MAA 244,112,164
TR 42,16,672
s_add_u32 s75, s75, 161536
MAA 252,120,164
TR 44,16,8608
v_lshrrev_b32 v9, 4, v1
MAA 252,124,180
TR 46,16,9120
v_lshlrev_b32 v9, 4, v9
MAA 248,124,176
ds_read_b64_tr_b16 a[48:49], v17
v_add_u32 v8, s75, v9
MAA 248,120,160
buffer_load_dwordx4 a[160:163], v10, s[16:19], s52 offen sc1
MAA 220,104,172
TR 50,17,512
v_add_u32 v9, s74, v9
MAA 220,108,188
TR 52,17,8448
.Lpad22:
s_cbranch_execz .Lpad25
MAA 216,108,184
TR 54,17,8960
MAA 216,104,168
TR 56,17,32
MAA 200,96,168
buffer_load_dwordx4 a[164:167], v10, s[16:19], s52 offen offset:1024 sc1
MAA 200,100,184
TR 58,17,544
s_add_u32 s52, s52, 131072
MAA 204,100,188
TR 60,17,8480
MAA 204,96,172
TR 62,17,8992
MAA 156,88,172
MAA 156,92,188
buffer_load_dwordx4 a[176:179], v10, s[16:19], s52 offen sc1
MAA 152,92,184
MAA 152,88,168
MAA 136,80,168
MAA 136,84,184
MAA 140,84,188
buffer_load_dwordx4 a[180:183], v10, s[16:19], s52 offen offset:1024 sc1
MAA 140,80,172
s_add_u32 s52, s52, 131072
MAA 92,72,172
MAA 92,76,188
MAA 88,76,184
MAA 88,72,168
MAA 72,64,168
MAA 72,68,184
MAA 76,68,188
MAA 76,64,172
s_waitcnt vmcnt(20) lgkmcnt(0)
s_barrier
MAA 32,0,128
buffer_load_dwordx4 a[168:171], v11, s[16:19], s53 offen sc1
MAA 32,4,144
ds_read_b128 v[20:23], v2
MAA 36,4,148
ds_read_b128 v[28:31], v2 offset:1024
MAA 36,0,132
s_waitcnt vmcnt(11)
ds_read_b128 v[24:27], v2 offset:2048
MAA 52,8,132
TR 64,16,16896
MAA 52,12,148
buffer_load_dwordx4 a[172:175], v11, s[16:19], s53 offen offset:1024 sc1
MAA 48,12,144
TR 66,16,17408
s_add_u32 s53, s53, 131072
MAA 48,8,128
TR 68,16,25344
MAA 96,16,128
TR 70,16,25856
MAA 96,20,144
TR 72,16,16928
MAA 100,20,148
buffer_load_dwordx4 a[184:187], v11, s[16:19], s53 offen sc1
MAA 100,16,132
TR 74,16,17440
s_waitcnt lgkmcnt(7)
v_add_f32 v20, v20, v28
MAA 116,24,132
TR 76,16,25376
v_add_f32 v21, v21, v29
MAA 116,28,148
TR 78,16,25888
v_add_f32 v22, v22, v30
MAA 112,28,144
TR 80,16,16960
v_add_f32 v23, v23, v31
MAA 112,24,128
buffer_load_dwordx4 a[188:191], v11, s[16:19], s53 offen offset:1024 sc1
MAA 160,32,128
ds_read_b128 v[28:31], v2 offset:3072
s_add_u32 s53, s53, 131072
MAA 160,36,144
TR 82,16,17472
s_add_u32 m0, s55, 84480
MAA 164,36,148
TR 84,16,25408
s_waitcnt lgkmcnt(12)
v_add_f32 v20, v20, v24
MAA 164,32,132
TR 86,16,25920
v_add_f32 v21, v21, v25
MAA 180,40,132
buffer_load_dwordx4 v12, s[32:35], s54 offen   lds
MAA 180,44,148
TR 88,16,16992
v_add_f32 v22, v22, v26
MAA 176,44,144
TR 90,16,17504
v_add_f32 v23, v23, v27
MAA 176,40,128
TR 92,16,25440
MAA 224,48,128
TR 94,16,25952
MAA 224,52,144
buffer_load_dwordx4 v13, s[32:35], s54 offen offset:1056   lds
MAA 228,52,148
TR 96,16,17024
MAA 228,48,132
TR 98,16,17536
MAA 236,56,132
TR 100,16,25472
MAA 236,60,148
TR 102,16,25984
MAA 232,60,144
buffer_load_dwordx4 v14, s[32:35], s54 offen offset:2112   lds
MAA 232,56,128
TR 104,16,17056
MAA 188,40,140
TR 106,16,17568
MAA 188,44,156
TR 108,16,25504
MAA 184,44,152
TR 110,16,26016
MAA 184,40,136
buffer_load_dwordx4 v15, s[32:35], s54 offen offset:3168   lds
MAA 168,32,136
TR 112,17,16896
s_add_u32 m0, s57, 6144
MAA 168,36,152
TR 114,17,17408
s_mov_b32 s58, 63182848
MAA 172,36,156
TR 116,17,25344
MAA 172,32,140
TR 118,17,25856
MAA 124,24,140
buffer_load_dwordx4 v4, s[16:19], s58 offen sc1 lds
MAA 124,28,156
TR 120,17,16928
MAA 120,28,152
TR 122,17,17440
MAA 120,24,136
TR 124,17,25376
MAA 104,16,136
TR 126,17,25888
MAA 104,20,152
buffer_load_dwordx4 v4, s[16:19], s58 offen offset:1024 sc1 lds
MAA 108,20,156
MAA 108,16,140
MAA 60,8,140
MAA 60,12,156
MAA 56,12,152
MAA 56,8,136
MAA 40,0,136
MAA 40,4,152
MAA 44,4,156
MAA 44,0,140
s_waitcnt lgkmcnt(0)
s_barrier
MAA 64,64,128
s_waitcnt vmcnt(14)
ds_read_b128 v[24:27], v2 offset:4096
s_add_u32 m0, s55, 101376
MAA 64,68,144
buffer_load_dwordx4 v12, s[80:83], s54 offen   lds
MAA 68,68,148
TR 0,16,33792
v_add_f32 v20, v20, v28
MAA 68,64,132
TR 2,16,34304
v_add_f32 v21, v21, v29
MAA 84,72,132
TR 4,16,42240
v_add_f32 v22, v22, v30
MAA 84,76,148
TR 6,16,42752
v_add_f32 v23, v23, v31
MAA 80,76,144
ds_read_b128 v[28:31], v2 offset:5120
MAA 80,72,128
TR 8,16,33824
MAA 128,80,128
buffer_load_dwordx4 v13, s[80:83], s54 offen offset:1056   lds
MAA 128,84,144
TR 10,16,34336
s_waitcnt lgkmcnt(7)
v_add_f32 v20, v20, v24
MAA 132,84,148
TR 12,16,42272
v_add_f32 v21, v21, v25
MAA 132,80,132
TR 14,16,42784
v_add_f32 v22, v22, v26
MAA 148,88,132
TR 16,16,33856
v_add_f32 v23, v23, v27
MAA 148,92,148
TR 18,16,34368
MAA 144,92,144
TR 20,16,42304
MAA 144,88,128
buffer_load_dwordx4 v14, s[80:83], s54 offen offset:2112   lds
MAA 192,96,128
TR 22,16,42816
MAA 192,100,144
TR 24,16,33888
MAA 196,100,148
TR 26,16,34400
MAA 196,96,132
TR 28,16,42336
MAA 212,104,132
TR 30,16,42848
MAA 212,108,148
TR 32,16,33920
MAA 208,108,144
buffer_load_dwordx4 v15, s[80:83], s54 offen offset:3168   lds
MAA 208,104,128
TR 34,16,34432
s_add_u32 s54, s54, 458752
MAA 240,112,128
TR 36,16,42368
MAA 240,116,144
TR 38,16,42880
MAA 244,116,148
TR 40,16,33952
MAA 244,112,132
TR 42,16,34464
MAA 252,120,132
TR 44,16,42400
MAA 252,124,148
TR 46,16,42912
MAA 248,124,144
TR 48,17,33792
MAA 248,120,128
buffer_load_dwordx4 a[128:131], v10, s[16:19], s52 offen sc1
MAA 220,104,140
TR 50,17,34304
MAA 220,108,156
TR 52,17,42240
MAA 216,108,152
TR 54,17,42752
MAA 216,104,136
TR 56,17,33824
MAA 200,96,136
TR 58,17,34336
MAA 200,100,152
TR 60,17,42272
MAA 204,100,156
buffer_load_dwordx4 a[132:135], v10, s[16:19], s52 offen offset:1024 sc1
MAA 204,96,140
TR 62,17,42784
s_add_u32 s52, s52, 131072
MAA 156,88,140
MAA 156,92,156
MAA 152,92,152
MAA 152,88,136
MAA 136,80,136
MAA 136,84,152
buffer_load_dwordx4 a[144:147], v10, s[16:19], s52 offen sc1
MAA 140,84,156
MAA 140,80,140
MAA 92,72,140
MAA 92,76,156
MAA 88,76,152
MAA 88,72,136
MAA 72,64,136
buffer_load_dwordx4 a[148:151], v10, s[16:19], s52 offen offset:1024 sc1
MAA 72,68,152
s_add_u32 s52, s52, 131072
MAA 76,68,156
MAA 76,64,140
s_waitcnt vmcnt(18) lgkmcnt(0)
s_barrier
MAA 32,0,160
buffer_load_dwordx4 a[136:139], v11, s[16:19], s53 offen sc1
MAA 32,4,176
s_waitcnt vmcnt(9)
ds_read_b128 v[24:27], v2 offset:6144
v_add_f32 v20, v20, v28
MAA 36,4,180
TR 64,16,50688
v_add_f32 v21, v21, v29
MAA 36,0,164
TR 66,16,51200
v_add_f32 v22, v22, v30
MAA 52,8,164
TR 68,16,59136
v_add_f32 v23, v23, v31
MAA 52,12,180
ds_read_b128 v[28:31], v2 offset:7168
MAA 48,12,176
TR 70,16,59648
MAA 48,8,160
buffer_load_dwordx4 a[140:143], v11, s[16:19], s53 offen offset:1024 sc1
MAA 96,16,160
TR 72,16,50720
s_add_u32 s53, s53, 131072
MAA 96,20,176
TR 74,16,51232
s_waitcnt lgkmcnt(7)
v_add_f32 v20, v20, v24
MAA 100,20,180
TR 76,16,59168
v_add_f32 v21, v21, v25
MAA 100,16,164
TR 78,16,59680
v_add_f32 v22, v22, v26
MAA 116,24,164
TR 80,16,50752
v_add_f32 v23, v23, v27
MAA 116,28,180
TR 82,16,51264
s_waitcnt lgkmcnt(7)
v_add_f32 v20, v20, v28
MAA 112,28,176
buffer_load_dwordx4 a[152:155], v11, s[16:19], s53 offen sc1
MAA 112,24,160
TR 84,16,59200
v_add_f32 v21, v21, v29
MAA 160,32,160
TR 86,16,59712
v_add_f32 v22, v22, v30
MAA 160,36,176
TR 88,16,50784
v_add_f32 v23, v23, v31
MAA 164,36,180
TR 90,16,51296
MAA 164,32,164
TR 92,16,59232
MAA 180,40,164
TR 94,16,59744
MAA 180,44,180
buffer_load_dwordx4 a[156:159], v11, s[16:19], s53 offen offset:1024 sc1
MAA 176,44,176
TR 96,16,50816
s_add_u32 s53, s53, 131072
MAA 176,40,160
TR 98,16,51328
s_add_u32 m0, s55, 118272
MAA 224,48,160
TR 100,16,59264
MAA 224,52,176
TR 102,16,59776
MAA 228,52,180
TR 104,16,50848
MAA 228,48,164
TR 106,16,51360
MAA 236,56,164
buffer_load_dwordx4 v12, s[32:35], s54 offen   lds
MAA 236,60,180
TR 108,16,59296
MAA 232,60,176
TR 110,16,59808
MAA 232,56,160
TR 112,17,50688
MAA 188,40,172
TR 114,17,51200
MAA 188,44,188
TR 116,17,59136
MAA 184,44,184
TR 118,17,59648
MAA 184,40,168
buffer_load_dwordx4 v13, s[32:35], s54 offen offset:1056   lds
MAA 168,32,168
TR 120,17,50720
MAA 168,36,184
TR 122,17,51232
MAA 172,36,188
TR 124,17,59168
MAA 172,32,172
TR 126,17,59680
MAA 124,24,172
MAA 124,28,188
MAA 120,28,184
buffer_load_dwordx4 v14, s[32:35], s54 offen offset:2112   lds
MAA 120,24,168
MAA 104,16,168
MAA 104,20,184
MAA 108,20,188
MAA 108,16,172
MAA 60,8,172
MAA 60,12,188
buffer_load_dwordx4 v15, s[32:35], s54 offen offset:3168   lds
MAA 56,12,184
MAA 56,8,168
MAA 40,0,168
MAA 40,4,184
MAA 44,4,188
MAA 44,0,172
s_waitcnt lgkmcnt(0)
s_barrier
MAA 64,64,160
ds_read_b64_tr_b16 a[0:1], v16
s_add_u32 m0, s55, 135168
MAA 64,68,176
buffer_load_dwordx4 v12, s[80:83], s54 offen   lds
MAA 68,68,180
TR 2,16,512
v_permlane32_swap_b32 v20, v22
MAA 68,64,164
TR 4,16,8448
v_permlane32_swap_b32 v21, v23
MAA 84,72,164
TR 6,16,8960
v_add_f32 v20, v20, v22
MAA 84,76,180
TR 8,16,32
v_add_f32 v21, v21, v23
MAA 80,76,176
TR 10,16,544
v_mul_f32 v20, 0xba800000, v20
MAA 80,72,160
buffer_load_dwordx4 v13, s[80:83], s54 offen offset:1056   lds
MAA 128,80,160
TR 12,16,8480
v_mul_f32 v21, 0x3a800000, v21
MAA 128,84,176
TR 14,16,8992
v_fma_f32 v21, -v20, v20, v21
MAA 132,84,180
TR 16,16,64
v_max_f32 v21, 0, v21
MAA 132,80,164
TR 18,16,576
v_add_f32 v21, 0x3727c5ac, v21
MAA 148,88,164
TR 20,16,8512
v_rsq_f32 v22, v21
MAA 148,92,180
buffer_load_dwordx4 v14, s[80:83], s54 offen offset:2112   lds
MAA 144,92,176
TR 22,16,9024
v_and_b32 v24, 31, v1
MAA 144,88,160
TR 24,16,96
v_lshrrev_b32 v25, 5, v1
MAA 192,96,160
TR 26,16,608
v_lshl_add_u32 v24, v24, 1, v25
MAA 192,100,176
TR 28,16,8544
v_and_b32 v25, 0xc0, v0
MAA 196,100,180
TR 30,16,9056
v_add_u32 v24, v24, v25
MAA 196,96,164
TR 32,16,128
v_lshlrev_b32 v24, 4, v24
MAA 212,104,164
buffer_load_dwordx4 v15, s[80:83], s54 offen offset:3168   lds
MAA 212,108,180
TR 34,16,640
s_add_u32 s54, s54, 458752
MAA 208,108,176
TR 36,16,8576
v_add_u32 v24, 152576, v24
MAA 208,104,160
TR 38,16,9088
v_mul_f32 v22, 0xbfb8aa3b, v22
MAA 240,112,160
ds_write_b128 v24, v[20:23]
s_mov_b32 s58, s98
MAA 240,116,176
ds_read_b64 v[20:21], v18
s_mov_b32 s67, s59
MAA 244,116,180
ds_read_b64 v[22:23], v18 offset:256
MAA 244,112,164
ds_read_b64 v[24:25], v19
MAA 252,120,164
ds_read_b64 v[26:27], v19 offset:256
MAA 252,124,180
ds_read_b32 a192, v18 offset:8
MAA 248,124,176
ds_read_b32 a193, v18 offset:264
v_mov_b32 v18, v5
MAA 248,120,160
buffer_load_dwordx4 a[160:163], v10, s[16:19], s52 offen sc1
MAA 220,104,172
ds_read_b32 a194, v19 offset:8
MAA 220,108,188
ds_read_b32 a195, v19 offset:264
v_mov_b32 v19, v6
MAA 216,108,184
TR 40,16,160
MAA 216,104,168
TR 42,16,672
MAA 200,96,168
TR 44,16,8608
MAA 200,100,184
TR 46,16,9120
MAA 204,100,188
buffer_load_dwordx4 a[164:167], v10, s[16:19], s52 offen offset:1024 sc1
MAA 204,96,172
ds_read_b64_tr_b16 a[48:49], v17
s_add_u32 s52, s52, 131072
MAA 156,88,172
TR 50,17,512
MAA 156,92,188
TR 52,17,8448
MAA 152,92,184
TR 54,17,8960
MAA 152,88,168
TR 56,17,32
MAA 136,80,168
TR 58,17,544
MAA 136,84,184
buffer_load_dwordx4 a[176:179], v10, s[16:19], s52 offen sc1
MAA 140,84,188
TR 60,17,8480
MAA 140,80,172
TR 62,17,8992
MAA 92,72,172
MAA 92,76,188
MAA 88,76,184
MAA 88,72,168
MAA 72,64,168
buffer_load_dwordx4 a[180:183], v10, s[16:19], s52 offen offset:1024 sc1
MAA 72,68,184
s_add_u32 s52, s52, 131072
MAA 76,68,188
MAA 76,64,172
s_waitcnt vmcnt(16) lgkmcnt(0)
s_barrier
MAA 32,0,128
ds_read_b128 v[28:31], v9 offset:512
MAA 32,4,144
ds_read_b128 v[4:7], v9 offset:576
MAA 36,4,148
buffer_load_dwordx4 a[168:171], v11, s[16:19], s53 offen sc1
MAA 36,0,132
TR 64,16,16896
MAA 52,8,132
TR 66,16,17408
MAA 52,12,148
TR 68,16,25344
MAA 48,12,144
TR 70,16,25856
MAA 48,8,128
TR 72,16,16928
MAA 96,16,128
buffer_load_dwordx4 a[172:175], v11, s[16:19], s53 offen offset:1024 sc1
MAA 96,20,144
TR 74,16,17440
s_add_u32 s53, s53, 131072
MAA 100,20,148
.Lpad23:
s_cbranch_execz .Lnopoll60r
TR 76,16,25376
s_waitcnt lgkmcnt(8)
v_fmac_f32 v64, v28, v20
MAA 100,16,132
TR 78,16,25888
v_fmac_f32 v65, v29, v20
MAA 116,24,132
TR 80,16,16960
v_fmac_f32 v66, v30, v20
MAA 116,28,148
TR 82,16,17472
v_fmac_f32 v67, v31, v20
MAA 112,28,144
buffer_load_dwordx4 a[184:187], v11, s[16:19], s53 offen sc1
MAA 112,24,128
TR 84,16,25408
v_fmac_f32 v68, v28, v22
MAA 160,32,128
TR 86,16,25920
v_fmac_f32 v69, v29, v22
MAA 160,36,144
TR 88,16,16992
v_fmac_f32 v70, v30, v22
MAA 164,36,148
TR 90,16,17504
v_fmac_f32 v71, v31, v22
MAA 164,32,132
TR 92,16,25440
v_fmac_f32 v72, v28, v24
MAA 180,40,132
buffer_load_dwordx4 a[188:191], v11, s[16:19], s53 offen offset:1024 sc1
MAA 180,44,148
TR 94,16,25952
s_add_u32 s53, s53, 131072
MAA 176,44,144
TR 96,16,17024
s_add_u32 m0, s55, 84480
MAA 176,40,128
TR 98,16,17536
v_fmac_f32 v73, v29, v24
MAA 224,48,128
TR 100,16,25472
v_fmac_f32 v74, v30, v24
MAA 224,52,144
TR 102,16,25984
v_fmac_f32 v75, v31, v24
MAA 228,52,148
buffer_load_dwordx4 v12, s[32:35], s54 offen   lds
MAA 228,48,132
TR 104,16,17056
v_fmac_f32 v76, v28, v26
MAA 236,56,132
TR 106,16,17568
v_fmac_f32 v77, v29, v26
MAA 236,60,148
TR 108,16,25504
v_fmac_f32 v78, v30, v26
MAA 232,60,144
TR 110,16,26016
v_fmac_f32 v79, v31, v26
MAA 232,56,128
ds_read_b128 v[28:31], v9 offset:640
s_waitcnt lgkmcnt(15)
v_fmac_f32 v80, v4, v20
s_waitcnt vmcnt(17)
MAA 188,40,140
buffer_load_dwordx4 v13, s[32:35], s54 offen offset:1056   lds
MAA 188,44,156
TR 112,17,16896
v_fmac_f32 v81, v5, v20
MAA 184,44,152
TR 114,17,17408
v_fmac_f32 v82, v6, v20
MAA 184,40,136
TR 116,17,25344
v_fmac_f32 v83, v7, v20
MAA 168,32,136
TR 118,17,25856
v_fmac_f32 v84, v4, v22
MAA 168,36,152
TR 120,17,16928
v_fmac_f32 v85, v5, v22
MAA 172,36,156
buffer_load_dwordx4 v14, s[32:35], s54 offen offset:2112   lds
MAA 172,32,140
TR 122,17,17440
v_fmac_f32 v86, v6, v22
MAA 124,24,140
TR 124,17,25376
v_fmac_f32 v87, v7, v22
MAA 124,28,156
TR 126,17,25888
v_fmac_f32 v88, v4, v24
MAA 120,28,152
v_fmac_f32 v89, v5, v24
v_fmac_f32 v90, v6, v24
MAA 120,24,136
v_fmac_f32 v91, v7, v24
v_fmac_f32 v92, v4, v26
MAA 104,16,136
buffer_load_dwordx4 v15, s[32:35], s54 offen offset:3168   lds
MAA 104,20,152
s_mov_b32 m0, s67
v_fmac_f32 v93, v5, v26
v_fmac_f32 v94, v6, v26
MAA 108,20,156
v_fmac_f32 v95, v7, v26
s_waitcnt lgkmcnt(8)
v_fmac_f32 v128, v28, v20
MAA 108,16,140
ds_read_b128 v[4:7], v8 offset:512
v_fmac_f32 v129, v29, v20
MAA 60,8,140
v_fmac_f32 v130, v30, v20
v_fmac_f32 v131, v31, v20
MAA 60,12,156
v_fmac_f32 v132, v28, v22
v_fmac_f32 v133, v29, v22
MAA 56,12,152
buffer_load_dwordx4 v18, s[28:31], s58 offen lds
MAA 56,8,136
v_fmac_f32 v134, v30, v22
v_fmac_f32 v135, v31, v22
MAA 40,0,136
v_fmac_f32 v136, v28, v24
v_fmac_f32 v137, v29, v24
MAA 40,4,152
v_fmac_f32 v138, v30, v24
v_fmac_f32 v139, v31, v24
MAA 44,4,156
v_fmac_f32 v140, v28, v26
v_fmac_f32 v141, v29, v26
MAA 44,0,140
v_fmac_f32 v142, v30, v26
v_fmac_f32 v143, v31, v26
s_waitcnt lgkmcnt(0)
v_fmac_f32 v240, v4, v20
v_fmac_f32 v241, v5, v20
v_fmac_f32 v242, v6, v20
v_fmac_f32 v243, v7, v20
v_fmac_f32 v244, v4, v22
v_fmac_f32 v245, v5, v22
v_fmac_f32 v246, v6, v22
v_fmac_f32 v247, v7, v22
s_waitcnt vmcnt(17) lgkmcnt(0)
s_barrier
MAA 64,64,128
ds_read_b128 v[28:31], v9
s_add_u32 m0, s55, 101376
MAA 64,68,144
ds_read_b128 v[4:7], v9 offset:64
MAA 68,68,148
buffer_load_dwordx4 v12, s[80:83], s54 offen   lds
MAA 68,64,132
TR 0,16,33792
MAA 84,72,132
TR 2,16,34304
MAA 84,76,148
TR 4,16,42240
MAA 80,76,144
TR 6,16,42752
MAA 80,72,128
TR 8,16,33824
MAA 128,80,128
buffer_load_dwordx4 v13, s[80:83], s54 offen offset:1056   lds
MAA 128,84,144
TR 10,16,34336
s_waitcnt lgkmcnt(7)
v_fmac_f32 v32, v28, v20
MAA 132,84,148
TR 12,16,42272
v_fmac_f32 v33, v29, v20
MAA 132,80,132
TR 14,16,42784
v_fmac_f32 v34, v30, v20
MAA 148,88,132
TR 16,16,33856
v_fmac_f32 v35, v31, v20
MAA 148,92,148
TR 18,16,34368
v_fmac_f32 v36, v28, v22
MAA 144,92,144
buffer_load_dwordx4 v14, s[80:83], s54 offen offset:2112   lds
MAA 144,88,128
TR 20,16,42304
v_fmac_f32 v37, v29, v22
MAA 192,96,128
TR 22,16,42816
v_fmac_f32 v38, v30, v22
MAA 192,100,144
TR 24,16,33888
v_fmac_f32 v39, v31, v22
MAA 196,100,148
TR 26,16,34400
v_fmac_f32 v40, v28, v24
MAA 196,96,132
TR 28,16,42336
v_fmac_f32 v41, v29, v24
MAA 212,104,132
buffer_load_dwordx4 v15, s[80:83], s54 offen offset:3168   lds
MAA 212,108,148
TR 30,16,42848
s_add_u32 s54, s54, 458752
MAA 208,108,144
TR 32,16,33920
s_mov_b32 m0, s67
MAA 208,104,128
TR 34,16,34432
v_fmac_f32 v42, v30, v24
MAA 240,112,128
TR 36,16,42368
v_fmac_f32 v43, v31, v24
MAA 240,116,144
TR 38,16,42880
v_fmac_f32 v44, v28, v26
MAA 244,116,148
buffer_load_dwordx4 v19, s[28:31], s58 offen offset:1056 lds
MAA 244,112,132
TR 40,16,33952
s_add_u32 s67, s67, 8448
MAA 252,120,132
TR 42,16,34464
s_add_u32 s58, s58, 0x40000
MAA 252,124,148
TR 44,16,42400
v_fmac_f32 v45, v29, v26
MAA 248,124,144
TR 46,16,42912
v_fmac_f32 v46, v30, v26
MAA 248,120,128
TR 48,17,33792
v_fmac_f32 v47, v31, v26
MAA 220,104,140
ds_read_b128 v[28:31], v9 offset:128
s_waitcnt lgkmcnt(15)
v_fmac_f32 v48, v4, v20
MAA 220,108,156
buffer_load_dwordx4 a[128:131], v10, s[16:19], s52 offen sc1
MAA 216,108,152
TR 50,17,34304
v_fmac_f32 v49, v5, v20
MAA 216,104,136
TR 52,17,42240
v_fmac_f32 v50, v6, v20
MAA 200,96,136
TR 54,17,42752
v_fmac_f32 v51, v7, v20
MAA 200,100,152
TR 56,17,33824
v_fmac_f32 v52, v4, v22
MAA 204,100,156
TR 58,17,34336
v_fmac_f32 v53, v5, v22
MAA 204,96,140
buffer_load_dwordx4 a[132:135], v10, s[16:19], s52 offen offset:1024 sc1
MAA 156,88,140
TR 60,17,42272
s_add_u32 s52, s52, 131072
MAA 156,92,156
TR 62,17,42784
v_fmac_f32 v54, v6, v22
MAA 152,92,152
v_fmac_f32 v55, v7, v22
v_fmac_f32 v56, v4, v24
MAA 152,88,136
v_fmac_f32 v57, v5, v24
v_fmac_f32 v58, v6, v24
MAA 136,80,136
v_fmac_f32 v59, v7, v24
v_fmac_f32 v60, v4, v26
MAA 136,84,152
buffer_load_dwordx4 a[144:147], v10, s[16:19], s52 offen sc1
MAA 140,84,156
v_fmac_f32 v61, v5, v26
v_fmac_f32 v62, v6, v26
MAA 140,80,140
v_fmac_f32 v63, v7, v26
s_waitcnt lgkmcnt(7)
v_fmac_f32 v96, v28, v20
MAA 92,72,140
ds_read_b128 v[4:7], v8
v_fmac_f32 v97, v29, v20
MAA 92,76,156
v_fmac_f32 v98, v30, v20
v_fmac_f32 v99, v31, v20
MAA 88,76,152
v_fmac_f32 v100, v28, v22
v_fmac_f32 v101, v29, v22
MAA 88,72,136
buffer_load_dwordx4 a[148:151], v10, s[16:19], s52 offen offset:1024 sc1
MAA 72,64,136
s_add_u32 s52, s52, 131072
v_fmac_f32 v102, v30, v22
v_fmac_f32 v103, v31, v22
MAA 72,68,152
v_fmac_f32 v104, v28, v24
v_fmac_f32 v105, v29, v24
MAA 76,68,156
v_fmac_f32 v106, v30, v24
v_fmac_f32 v107, v31, v24
MAA 76,64,140
v_fmac_f32 v108, v28, v26
v_fmac_f32 v109, v29, v26
v_fmac_f32 v110, v30, v26
v_fmac_f32 v111, v31, v26
s_waitcnt lgkmcnt(0)
v_fmac_f32 v224, v4, v20
v_fmac_f32 v225, v5, v20
v_fmac_f32 v226, v6, v20
v_fmac_f32 v227, v7, v20
v_fmac_f32 v228, v4, v22
v_fmac_f32 v229, v5, v22
v_fmac_f32 v230, v6, v22
v_fmac_f32 v231, v7, v22
s_waitcnt vmcnt(18) lgkmcnt(0)
s_barrier
MAA 32,0,160
ds_read_b128 v[28:31], v9 offset:704
MAA 32,4,176
ds_read_b128 v[4:7], v9 offset:768
MAA 36,4,180
buffer_load_dwordx4 a[136:139], v11, s[16:19], s53 offen sc1
MAA 36,0,164
TR 64,16,50688
MAA 52,8,164
TR 66,16,51200
MAA 52,12,180
TR 68,16,59136
MAA 48,12,176
TR 70,16,59648
MAA 48,8,160
TR 72,16,50720
MAA 96,16,160
buffer_load_dwordx4 a[140:143], v11, s[16:19], s53 offen offset:1024 sc1
MAA 96,20,176
TR 74,16,51232
s_add_u32 s53, s53, 131072
MAA 100,20,180
TR 76,16,59168
s_waitcnt lgkmcnt(8)
v_fmac_f32 v144, v28, v20
MAA 100,16,164
TR 78,16,59680
v_fmac_f32 v145, v29, v20
MAA 116,24,164
TR 80,16,50752
v_fmac_f32 v146, v30, v20
MAA 116,28,180
TR 82,16,51264
v_fmac_f32 v147, v31, v20
MAA 112,28,176
buffer_load_dwordx4 a[152:155], v11, s[16:19], s53 offen sc1
MAA 112,24,160
TR 84,16,59200
v_fmac_f32 v148, v28, v22
MAA 160,32,160
TR 86,16,59712
v_fmac_f32 v149, v29, v22
MAA 160,36,176
TR 88,16,50784
v_fmac_f32 v150, v30, v22
MAA 164,36,180
TR 90,16,51296
v_fmac_f32 v151, v31, v22
MAA 164,32,164
TR 92,16,59232
v_fmac_f32 v152, v28, v24
MAA 180,40,164
buffer_load_dwordx4 a[156:159], v11, s[16:19], s53 offen offset:1024 sc1
MAA 180,44,180
TR 94,16,59744
s_add_u32 s53, s53, 131072
MAA 176,44,176
TR 96,16,50816
s_add_u32 m0, s55, 118272
MAA 176,40,160
TR 98,16,51328
v_fmac_f32 v153, v29, v24
MAA 224,48,160
TR 100,16,59264
v_fmac_f32 v154, v30, v24
MAA 224,52,176
TR 102,16,59776
v_fmac_f32 v155, v31, v24
MAA 228,52,180
buffer_load_dwordx4 v12, s[32:35], s54 offen   lds
MAA 228,48,164
TR 104,16,50848
v_fmac_f32 v156, v28, v26
MAA 236,56,164
TR 106,16,51360
v_fmac_f32 v157, v29, v26
MAA 236,60,180
TR 108,16,59296
v_fmac_f32 v158, v30, v26
MAA 232,60,176
TR 110,16,59808
v_fmac_f32 v159, v31, v26
MAA 232,56,160
ds_read_b128 v[28:31], v9 offset:832
s_waitcnt lgkmcnt(15)
v_fmac_f32 v192, v4, v20
s_waitcnt vmcnt(19)
MAA 188,40,172
buffer_load_dwordx4 v13, s[32:35], s54 offen offset:1056   lds
MAA 188,44,188
TR 112,17,50688
v_fmac_f32 v193, v5, v20
MAA 184,44,184
TR 114,17,51200
v_fmac_f32 v194, v6, v20
MAA 184,40,168
TR 116,17,59136
v_fmac_f32 v195, v7, v20
MAA 168,32,168
TR 118,17,59648
v_fmac_f32 v196, v4, v22
MAA 168,36,184
TR 120,17,50720
v_fmac_f32 v197, v5, v22
MAA 172,36,188
buffer_load_dwordx4 v14, s[32:35], s54 offen offset:2112   lds
MAA 172,32,172
TR 122,17,51232
v_fmac_f32 v198, v6, v22
MAA 124,24,172
TR 124,17,59168
v_fmac_f32 v199, v7, v22
MAA 124,28,188
TR 126,17,59680
v_fmac_f32 v200, v4, v24
MAA 120,28,184
v_fmac_f32 v201, v5, v24
v_fmac_f32 v202, v6, v24
MAA 120,24,168
v_fmac_f32 v203, v7, v24
v_fmac_f32 v204, v4, v26
MAA 104,16,168
buffer_load_dwordx4 v15, s[32:35], s54 offen offset:3168   lds
MAA 104,20,184
s_mov_b32 m0, s67
v_fmac_f32 v205, v5, v26
v_fmac_f32 v206, v6, v26
MAA 108,20,188
v_fmac_f32 v207, v7, v26
s_waitcnt lgkmcnt(8)
v_fmac_f32 v208, v28, v20
MAA 108,16,172
ds_read_b128 v[4:7], v8 offset:576
v_fmac_f32 v209, v29, v20
MAA 60,8,172
v_fmac_f32 v210, v30, v20
v_fmac_f32 v211, v31, v20
MAA 60,12,188
v_fmac_f32 v212, v28, v22
v_fmac_f32 v213, v29, v22
MAA 56,12,184
buffer_load_dwordx4 v18, s[28:31], s58 offen lds
MAA 56,8,168
v_fmac_f32 v214, v30, v22
v_fmac_f32 v215, v31, v22
MAA 40,0,168
v_fmac_f32 v216, v28, v24
v_fmac_f32 v217, v29, v24
MAA 40,4,184
v_fmac_f32 v218, v30, v24
v_fmac_f32 v219, v31, v24
MAA 44,4,188
v_fmac_f32 v220, v28, v26
v_fmac_f32 v221, v29, v26
MAA 44,0,172
v_fmac_f32 v222, v30, v26
v_fmac_f32 v223, v31, v26
s_waitcnt lgkmcnt(0)
v_fmac_f32 v248, v4, v20
v_fmac_f32 v249, v5, v20
v_fmac_f32 v250, v6, v20
v_fmac_f32 v251, v7, v20
v_fmac_f32 v252, v4, v22
v_fmac_f32 v253, v5, v22
v_fmac_f32 v254, v6, v22
v_fmac_f32 v255, v7, v22
s_waitcnt vmcnt(19) lgkmcnt(0)
s_barrier
MAA 64,64,160
ds_read_b128 v[28:31], v9 offset:192
s_add_u32 m0, s55, 135168
MAA 64,68,176
ds_read_b128 v[4:7], v9 offset:256
MAA 68,68,180
buffer_load_dwordx4 v12, s[80:83], s54 offen   lds
MAA 68,64,164
ds_read_b64_tr_b16 a[0:1], v16
MAA 84,72,164
TR 2,16,512
MAA 84,76,180
TR 4,16,8448
MAA 80,76,176
TR 6,16,8960
MAA 80,72,160
TR 8,16,32
MAA 128,80,160
buffer_load_dwordx4 v13, s[80:83], s54 offen offset:1056   lds
MAA 128,84,176
TR 10,16,544
s_waitcnt lgkmcnt(7)
v_fmac_f32 v112, v28, v20
MAA 132,84,180
TR 12,16,8480
v_fmac_f32 v113, v29, v20
MAA 132,80,164
TR 14,16,8992
v_fmac_f32 v114, v30, v20
MAA 148,88,164
TR 16,16,64
v_fmac_f32 v115, v31, v20
MAA 148,92,180
TR 18,16,576
v_fmac_f32 v116, v28, v22
MAA 144,92,176
buffer_load_dwordx4 v14, s[80:83], s54 offen offset:2112   lds
MAA 144,88,160
TR 20,16,8512
v_fmac_f32 v117, v29, v22
MAA 192,96,160
TR 22,16,9024
v_fmac_f32 v118, v30, v22
MAA 192,100,176
TR 24,16,96
v_fmac_f32 v119, v31, v22
MAA 196,100,180
TR 26,16,608
v_fmac_f32 v120, v28, v24
MAA 196,96,164
TR 28,16,8544
v_fmac_f32 v121, v29, v24
MAA 212,104,164
buffer_load_dwordx4 v15, s[80:83], s54 offen offset:3168   lds
MAA 212,108,180
TR 30,16,9056
s_add_u32 s54, s54, 458752
MAA 208,108,176
TR 32,16,128
s_mov_b32 m0, s67
MAA 208,104,160
TR 34,16,640
v_fmac_f32 v122, v30, v24
MAA 240,112,160
TR 36,16,8576
v_fmac_f32 v123, v31, v24
MAA 240,116,176
TR 38,16,9088
v_fmac_f32 v124, v28, v26
MAA 244,116,180
buffer_load_dwordx4 v19, s[28:31], s58 offen offset:1056 lds
MAA 244,112,164
TR 40,16,160
s_add_u32 s67, s67, 8448
MAA 252,120,164
TR 42,16,672
s_add_u32 s46, s46, 1
MAA 252,124,180
TR 44,16,8608
s_xor_b32 s58, s46, s87
MAA 248,124,176
TR 46,16,9120
s_mul_i32 s58, s58, 458752
MAA 248,120,160
ds_read_b64_tr_b16 a[48:49], v17
v_fmac_f32 v125, v29, v26
MAA 220,104,172
buffer_load_dwordx4 a[160:163], v10, s[16:19], s52 offen sc1
MAA 220,108,188
TR 50,17,512
v_fmac_f32 v126, v30, v26
MAA 216,108,184
TR 52,17,8448
v_fmac_f32 v127, v31, v26
MAA 216,104,168
ds_read_b128 v[28:31], v9 offset:320
s_waitcnt lgkmcnt(15)
v_fmac_f32 v160, v4, v20
MAA 200,96,168
TR 54,17,8960
v_fmac_f32 v161, v5, v20
MAA 200,100,184
TR 56,17,32
v_fmac_f32 v162, v6, v20
MAA 204,100,188
buffer_load_dwordx4 a[164:167], v10, s[16:19], s52 offen offset:1024 sc1
MAA 204,96,172
TR 58,17,544
s_add_u32 s52, s52, 131072
MAA 156,88,172
TR 60,17,8480
v_fmac_f32 v163, v7, v20
MAA 156,92,188
TR 62,17,8992
v_fmac_f32 v164, v4, v22
MAA 152,92,184
v_fmac_f32 v165, v5, v22
v_fmac_f32 v166, v6, v22
MAA 152,88,168
v_fmac_f32 v167, v7, v22
v_fmac_f32 v168, v4, v24
MAA 136,80,168
buffer_load_dwordx4 a[176:179], v10, s[16:19], s52 offen sc1
MAA 136,84,184
v_fmac_f32 v169, v5, v24
v_fmac_f32 v170, v6, v24
MAA 140,84,188
v_fmac_f32 v171, v7, v24
v_fmac_f32 v172, v4, v26
MAA 140,80,172
v_fmac_f32 v173, v5, v26
v_fmac_f32 v174, v6, v26
MAA 92,72,172
v_fmac_f32 v175, v7, v26
s_waitcnt lgkmcnt(5)
v_fmac_f32 v176, v28, v20
MAA 92,76,188
ds_read_b128 v[4:7], v8 offset:64
v_fmac_f32 v177, v29, v20
MAA 88,76,184
buffer_load_dwordx4 a[180:183], v10, s[16:19], s52 offen offset:1024 sc1
MAA 88,72,168
s_add_u32 s52, s52, 131072
.Lpad24:
s_cbranch_execz .Lnopoll60r
v_fmac_f32 v178, v30, v20
v_fmac_f32 v179, v31, v20
MAA 72,64,168
v_fmac_f32 v180, v28, v22
v_fmac_f32 v181, v29, v22
MAA 72,68,184
v_fmac_f32 v182, v30, v22
v_fmac_f32 v183, v31, v22
MAA 76,68,188
v_fmac_f32 v184, v28, v24
v_fmac_f32 v185, v29, v24
MAA 76,64,172
v_fmac_f32 v186, v30, v24
v_fmac_f32 v187, v31, v24
v_fmac_f32 v188, v28, v26
v_fmac_f32 v189, v29, v26
v_fmac_f32 v190, v30, v26
v_fmac_f32 v191, v31, v26
v_accvgpr_read_b32 v28, a192
s_waitcnt lgkmcnt(0)
v_fmac_f32 v232, v4, v20
v_fmac_f32 v233, v5, v20
v_fmac_f32 v234, v6, v20
v_fmac_f32 v235, v7, v20
v_fmac_f32 v236, v4, v22
v_fmac_f32 v237, v5, v22
v_fmac_f32 v238, v6, v22
v_fmac_f32 v239, v7, v22
v_accvgpr_read_b32 v29, a193
v_accvgpr_read_b32 v30, a194
v_accvgpr_read_b32 v31, a195
s_mov_b32 s15, -4
.p2align 6
.Lk65:
s_waitcnt vmcnt(18) lgkmcnt(0)
s_barrier
MAA 32,0,128
TR 64,16,16896
MAA 32,4,144
buffer_load_dwordx4 a[168:171], v11, s[16:19], s53 offen sc1
MAA 36,4,148
TR 66,16,17408
MAA 36,0,132
TR 68,16,25344
MAA 52,8,132
TR 70,16,25856
MAA 52,12,148
MAA 48,12,144
TR 72,16,16928
MAA 48,8,128
buffer_load_dwordx4 a[172:175], v11, s[16:19], s53 offen offset:1024 sc1
MAA 96,16,128
TR 74,16,17440
s_add_u32 s53, s53, 131072
MAA 96,20,144
TR 76,16,25376
MAA 100,20,148
MAA 100,16,132
TR 78,16,25888
MAA 116,24,132
TR 80,16,16960
MAA 116,28,148
buffer_load_dwordx4 a[184:187], v11, s[16:19], s53 offen sc1
MAA 112,28,144
TR 82,16,17472
MAA 112,24,128
MAA 160,32,128
TR 84,16,25408
MAA 160,36,144
TR 86,16,25920
MAA 164,36,148
TR 88,16,16992
MAA 164,32,132
buffer_load_dwordx4 a[188:191], v11, s[16:19], s53 offen offset:1024 sc1
MAA 180,40,132
s_add_u32 s53, s53, 131072
MAA 180,44,148
TR 90,16,17504
MAA 176,44,144
TR 92,16,25440
MAA 176,40,128
TR 94,16,25952
MAA 224,48,128
s_add_u32 m0, s55, 84480
MAA 224,52,144
buffer_load_dwordx4 v12, s[32:35], s54 offen   lds
MAA 228,52,148
TR 96,16,17024
MAA 228,48,132
TR 98,16,17536
MAA 236,56,132
TR 100,16,25472
MAA 236,60,148
TR 102,16,25984
MAA 232,60,144
MAA 232,56,128
TR 104,16,17056
s_waitcnt vmcnt(19)
MAA 188,40,140
buffer_load_dwordx4 v13, s[32:35], s54 offen offset:1056   lds
MAA 188,44,156
TR 106,16,17568
MAA 184,44,152
TR 108,16,25504
MAA 184,40,136
MAA 168,32,136
TR 110,16,26016
MAA 168,36,152
buffer_load_dwordx4 v14, s[32:35], s54 offen offset:2112   lds
MAA 172,36,156
TR 112,17,16896
MAA 172,32,140
TR 114,17,17408
MAA 124,24,140
MAA 124,28,156
TR 116,17,25344
MAA 120,28,152
TR 118,17,25856
MAA 120,24,136
buffer_load_dwordx4 v15, s[32:35], s54 offen offset:3168   lds
MAA 104,16,136
TR 120,17,16928
MAA 104,20,152
MAA 108,20,156
TR 122,17,17440
MAA 108,16,140
TR 124,17,25376
MAA 60,8,140
TR 126,17,25888
s_mov_b32 m0, s67
MAA 60,12,156
buffer_load_dwordx4 v18, s[28:31], s58 offen lds
MAA 56,12,152
MAA 56,8,136
MAA 40,0,136
MAA 40,4,152
MAA 44,4,156
MAA 44,0,140
s_waitcnt vmcnt(19) lgkmcnt(0)
s_barrier
MAA 64,64,128
TR 0,16,33792
s_add_u32 m0, s55, 101376
MAA 64,68,144
buffer_load_dwordx4 v12, s[80:83], s54 offen   lds
MAA 68,68,148
TR 2,16,34304
MAA 68,64,132
TR 4,16,42240
MAA 84,72,132
TR 6,16,42752
MAA 84,76,148
MAA 80,76,144
TR 8,16,33824
MAA 80,72,128
buffer_load_dwordx4 v13, s[80:83], s54 offen offset:1056   lds
MAA 128,80,128
TR 10,16,34336
MAA 128,84,144
TR 12,16,42272
MAA 132,84,148
TR 14,16,42784
MAA 132,80,132
MAA 148,88,132
TR 16,16,33856
MAA 148,92,148
buffer_load_dwordx4 v14, s[80:83], s54 offen offset:2112   lds
MAA 144,92,144
TR 18,16,34368
MAA 144,88,128
TR 20,16,42304
MAA 192,96,128
MAA 192,100,144
TR 22,16,42816
MAA 196,100,148
TR 24,16,33888
MAA 196,96,132
buffer_load_dwordx4 v15, s[80:83], s54 offen offset:3168   lds
MAA 212,104,132
TR 26,16,34400
s_add_u32 s54, s54, 458752
MAA 212,108,148
TR 28,16,42336
MAA 208,108,144
MAA 208,104,128
TR 30,16,42848
MAA 240,112,128
TR 32,16,33920
s_mov_b32 m0, s67
MAA 240,116,144
buffer_load_dwordx4 v19, s[28:31], s58 offen offset:1056 lds
MAA 244,116,148
s_add_u32 s67, s67, 8448
s_add_u32 s58, s58, 0x40000
MAA 244,112,132
TR 34,16,34432
MAA 252,120,132
MAA 252,124,148
TR 36,16,42368
MAA 248,124,144
TR 38,16,42880
MAA 248,120,128
buffer_load_dwordx4 a[128:131], v10, s[16:19], s52 offen sc1
MAA 220,104,140
TR 40,16,33952
MAA 220,108,156
TR 42,16,34464
MAA 216,108,152
MAA 216,104,136
TR 44,16,42400
MAA 200,96,136
TR 46,16,42912
MAA 200,100,152
buffer_load_dwordx4 a[132:135], v10, s[16:19], s52 offen offset:1024 sc1
MAA 204,100,156
TR 48,17,33792
s_add_u32 s52, s52, 131072
MAA 204,96,140
MAA 156,88,140
TR 50,17,34304
MAA 156,92,156
TR 52,17,42240
MAA 152,92,152
TR 54,17,42752
MAA 152,88,136
buffer_load_dwordx4 a[144:147], v10, s[16:19], s52 offen sc1
MAA 136,80,136
TR 56,17,33824
MAA 136,84,152
MAA 140,84,156
TR 58,17,34336
MAA 140,80,140
TR 60,17,42272
MAA 92,72,140
TR 62,17,42784
MAA 92,76,156
buffer_load_dwordx4 a[148:151], v10, s[16:19], s52 offen offset:1024 sc1
MAA 88,76,152
s_add_u32 s52, s52, 131072
MAA 88,72,136
MAA 72,64,136
MAA 72,68,152
MAA 76,68,156
MAA 76,64,140
s_waitcnt vmcnt(18) lgkmcnt(0)
s_barrier
MAA 32,0,160
TR 64,16,50688
MAA 32,4,176
buffer_load_dwordx4 a[136:139], v11, s[16:19], s53 offen sc1
MAA 36,4,180
TR 66,16,51200
MAA 36,0,164
TR 68,16,59136
MAA 52,8,164
TR 70,16,59648
MAA 52,12,180
MAA 48,12,176
TR 72,16,50720
MAA 48,8,160
buffer_load_dwordx4 a[140:143], v11, s[16:19], s53 offen offset:1024 sc1
MAA 96,16,160
TR 74,16,51232
s_add_u32 s53, s53, 131072
MAA 96,20,176
TR 76,16,59168
MAA 100,20,180
MAA 100,16,164
TR 78,16,59680
MAA 116,24,164
TR 80,16,50752
MAA 116,28,180
buffer_load_dwordx4 a[152:155], v11, s[16:19], s53 offen sc1
MAA 112,28,176
TR 82,16,51264
MAA 112,24,160
MAA 160,32,160
TR 84,16,59200
MAA 160,36,176
TR 86,16,59712
MAA 164,36,180
TR 88,16,50784
MAA 164,32,164
buffer_load_dwordx4 a[156:159], v11, s[16:19], s53 offen offset:1024 sc1
MAA 180,40,164
s_add_u32 s53, s53, 131072
MAA 180,44,180
TR 90,16,51296
MAA 176,44,176
TR 92,16,59232
MAA 176,40,160
TR 94,16,59744
MAA 224,48,160
s_add_u32 m0, s55, 118272
MAA 224,52,176
buffer_load_dwordx4 v12, s[32:35], s54 offen   lds
MAA 228,52,180
TR 96,16,50816
MAA 228,48,164
TR 98,16,51328
MAA 236,56,164
TR 100,16,59264
MAA 236,60,180
TR 102,16,59776
MAA 232,60,176
MAA 232,56,160
TR 104,16,50848
s_waitcnt vmcnt(19)
MAA 188,40,172
buffer_load_dwordx4 v13, s[32:35], s54 offen offset:1056   lds
MAA 188,44,188
TR 106,16,51360
MAA 184,44,184
TR 108,16,59296
MAA 184,40,168
MAA 168,32,168
TR 110,16,59808
MAA 168,36,184
buffer_load_dwordx4 v14, s[32:35], s54 offen offset:2112   lds
MAA 172,36,188
TR 112,17,50688
MAA 172,32,172
TR 114,17,51200
MAA 124,24,172
MAA 124,28,188
TR 116,17,59136
MAA 120,28,184
TR 118,17,59648
MAA 120,24,168
buffer_load_dwordx4 v15, s[32:35], s54 offen offset:3168   lds
MAA 104,16,168
TR 120,17,50720
MAA 104,20,184
MAA 108,20,188
TR 122,17,51232
MAA 108,16,172
TR 124,17,59168
MAA 60,8,172
TR 126,17,59680
s_mov_b32 m0, s67
MAA 60,12,188
buffer_load_dwordx4 v18, s[28:31], s58 offen lds
MAA 56,12,184
MAA 56,8,168
MAA 40,0,168
MAA 40,4,184
MAA 44,4,188
MAA 44,0,172
s_waitcnt vmcnt(19) lgkmcnt(0)
s_barrier
MAA 64,64,160
ds_read_b64_tr_b16 a[0:1], v16
s_add_u32 m0, s55, 135168
MAA 64,68,176
buffer_load_dwordx4 v12, s[80:83], s54 offen   lds
MAA 68,68,180
TR 2,16,512
MAA 68,64,164
TR 4,16,8448
MAA 84,72,164
TR 6,16,8960
MAA 84,76,180
MAA 80,76,176
TR 8,16,32
MAA 80,72,160
buffer_load_dwordx4 v13, s[80:83], s54 offen offset:1056   lds
MAA 128,80,160
TR 10,16,544
MAA 128,84,176
TR 12,16,8480
MAA 132,84,180
TR 14,16,8992
MAA 132,80,164
MAA 148,88,164
TR 16,16,64
MAA 148,92,180
buffer_load_dwordx4 v14, s[80:83], s54 offen offset:2112   lds
MAA 144,92,176
TR 18,16,576
MAA 144,88,160
TR 20,16,8512
MAA 192,96,160
MAA 192,100,176
TR 22,16,9024
MAA 196,100,180
TR 24,16,96
MAA 196,96,164
buffer_load_dwordx4 v15, s[80:83], s54 offen offset:3168   lds
MAA 212,104,164
TR 26,16,608
s_add_u32 s54, s54, 458752
MAA 212,108,180
TR 28,16,8544
MAA 208,108,176
MAA 208,104,160
TR 30,16,9056
MAA 240,112,160
TR 32,16,128
s_mov_b32 m0, s67
MAA 240,116,176
buffer_load_dwordx4 v19, s[28:31], s58 offen offset:1056 lds
MAA 244,116,180
s_add_u32 s67, s67, 8448
s_add_u32 s46, s46, 1
s_xor_b32 s58, s46, s87
s_mul_i32 s58, s58, 458752
MAA 244,112,164
TR 34,16,640
MAA 252,120,164
MAA 252,124,180
TR 36,16,8576
MAA 248,124,176
TR 38,16,9088
MAA 248,120,160
buffer_load_dwordx4 a[160:163], v10, s[16:19], s52 offen sc1
MAA 220,104,172
TR 40,16,160
MAA 220,108,188
TR 42,16,672
MAA 216,108,184
MAA 216,104,168
TR 44,16,8608
MAA 200,96,168
TR 46,16,9120
MAA 200,100,184
buffer_load_dwordx4 a[164:167], v10, s[16:19], s52 offen offset:1024 sc1
MAA 204,100,188
ds_read_b64_tr_b16 a[48:49], v17
s_add_u32 s52, s52, 131072
MAA 204,96,172
MAA 156,88,172
TR 50,17,512
MAA 156,92,188
TR 52,17,8448
MAA 152,92,184
TR 54,17,8960
MAA 152,88,168
buffer_load_dwordx4 a[176:179], v10, s[16:19], s52 offen sc1
MAA 136,80,168
TR 56,17,32
MAA 136,84,184
MAA 140,84,188
TR 58,17,544
MAA 140,80,172
TR 60,17,8480
MAA 92,72,172
TR 62,17,8992
MAA 92,76,188
buffer_load_dwordx4 a[180:183], v10, s[16:19], s52 offen offset:1024 sc1
MAA 88,76,184
s_add_u32 s52, s52, 131072
MAA 88,72,168
MAA 72,64,168
MAA 72,68,184
MAA 76,68,188
s_add_u32 s15, s15, 1
MAA 76,64,172
s_cbranch_scc0 .Lk65
s_waitcnt vmcnt(10) lgkmcnt(0)
s_barrier
MAA 32,0,128
buffer_load_dwordx4 a[168:171], v11, s[16:19], s53 offen sc1
MAA 32,4,144
TR 64,16,16896
s_add_u32 s58, s99, 2293760
MAA 48,12,144
TR 66,16,17408
s_lshl_b32 s74, s3, 11
MAA 48,8,128
TR 68,16,25344
s_add_u32 s74, s74, s84
MAA 36,0,132
buffer_load_dwordx4 a[172:175], v11, s[16:19], s53 offen offset:1024 sc1
MAA 36,4,148
TR 70,16,25856
s_add_u32 s53, s53, 131072
MAA 52,12,148
TR 72,16,16928
v_lshl_add_u32 v4, v1, 4, s74
MAA 52,8,132
TR 74,16,17440
v_lshrrev_b32 v2, 3, v1
MAA 40,0,136
buffer_load_dwordx4 a[184:187], v11, s[16:19], s53 offen sc1
MAA 40,4,152
TR 76,16,25376
v_cmp_eq_u32 vcc, 3, v2
MAA 56,12,152
TR 78,16,25888
v_add_u32 v2, 67108480, v4
MAA 56,8,136
TR 80,16,33792
v_cndmask_b32 v4, v4, v2, vcc
MAA 44,0,140
buffer_load_dwordx4 a[188:191], v11, s[16:19], s53 offen offset:1024 sc1
MAA 44,4,156
TR 82,16,34304
s_add_u32 s53, s53, 131072
MAA 60,12,156
TR 84,16,42240
s_and_b32 s74, s7, 1
MAA 60,8,140
TR 86,16,42752
s_add_u32 s54, s98, 65536
MAA 96,16,128
TR 88,16,33824
v_bfe_u32 v7, v1, 2, 3
MAA 96,20,144
TR 90,16,34336
v_mul_u32_u24 v7, 1056, v7
MAA 112,28,144
TR 92,16,42272
s_waitcnt vmcnt(9)
s_barrier
MAA 112,24,128
TR 94,16,42784
v_bfe_u32 v2, v1, 5, 1
MAA 100,16,132
TR 96,16,50688
v_lshl_add_u32 v7, v2, 8, v7
MAA 100,20,148
TR 98,16,51200
v_and_b32 v2, 3, v1
MAA 116,28,148
TR 100,16,59136
v_lshl_add_u32 v7, v2, 3, v7
MAA 116,24,132
TR 102,16,59648
s_lshl_b32 s74, s74, 7
MAA 104,16,136
TR 104,16,50720
s_xor_b32 s75, s74, 128
MAA 104,20,152
TR 106,16,51232
v_add_u32 v6, s75, v7
MAA 120,28,152
TR 108,16,59168
v_add_u32 v7, s74, v7
.Lpad25:
s_cbranch_execz .Lnopoll60r
MAA 120,24,136
TR 110,16,59680
s_mul_i32 s55, s3, 2112
MAA 108,16,140
TR 112,16,16960
s_mov_b32 s57, 67584
MAA 108,20,156
TR 114,16,17472
MAA 124,28,156
TR 116,16,25408
MAA 124,24,140
TR 118,16,25920
MAA 160,32,128
TR 120,16,16992
MAA 160,36,144
TR 122,16,17504
MAA 176,44,144
TR 124,16,25440
MAA 176,40,128
TR 126,16,25952
MAA 164,32,132
TR 192,16,33856
MAA 164,36,148
TR 194,16,34368
MAA 180,44,148
TR 196,16,42304
MAA 180,40,132
TR 198,16,42816
MAA 168,32,136
TR 200,16,33888
MAA 168,36,152
TR 202,16,34400
MAA 184,44,152
TR 204,16,42336
MAA 184,40,136
TR 206,16,42848
MAA 172,32,140
TR 208,16,50752
MAA 172,36,156
TR 210,16,51264
MAA 188,44,156
TR 212,16,59200
MAA 188,40,140
TR 214,16,59712
MAA 224,48,128
TR 216,16,50784
MAA 224,52,144
TR 218,16,51296
MAA 232,60,144
TR 220,16,59232
MAA 232,56,128
TR 222,16,59744
MAA 228,48,132
TR 0,16,17024
MAA 228,52,148
TR 2,16,17536
MAA 236,60,148
TR 4,16,25472
MAA 236,56,132
TR 6,16,25984
s_waitcnt lgkmcnt(15)
MAA 64,64,128
TR 8,16,17056
MAA 64,68,144
TR 10,16,17568
s_waitcnt vmcnt(7)
MAA 64,96,160
TR 12,16,25504
s_waitcnt vmcnt(5)
MAA 64,100,176
TR 14,16,26016
MAA 80,108,176
TR 16,16,33920
MAA 80,104,160
TR 18,16,34432
MAA 80,76,144
TR 20,16,42368
MAA 80,72,128
TR 22,16,42880
MAA 32,80,160
TR 24,16,33952
MAA 32,84,176
TR 26,16,34464
MAA 48,92,176
TR 28,16,42400
MAA 48,88,160
TR 30,16,42912
s_nop 2
v_pk_mul_f32 v[64:65], v[64:65], v[32:33]
v_pk_mul_f32 v[32:33], v[32:33], v[28:29] op_sel_hi:[1,0]
v_pk_mul_f32 v[66:67], v[66:67], v[34:35]
v_pk_mul_f32 v[34:35], v[34:35], v[28:29] op_sel_hi:[1,0]
v_pk_mul_f32 v[80:81], v[80:81], v[48:49]
v_pk_mul_f32 v[48:49], v[48:49], v[28:29] op_sel_hi:[1,0]
v_pk_mul_f32 v[82:83], v[82:83], v[50:51]
v_pk_mul_f32 v[50:51], v[50:51], v[28:29] op_sel_hi:[1,0]
v_exp_f32 v32, v32
s_nop 0
MAA 68,64,132
TR 32,16,50816
v_exp_f32 v33, v33
MAA 68,68,148
TR 34,16,51328
v_exp_f32 v34, v34
MAA 68,96,164
TR 36,16,59264
v_exp_f32 v35, v35
s_waitcnt vmcnt(4)
MAA 68,100,180
TR 38,16,59776
v_exp_f32 v48, v48
MAA 84,108,180
TR 40,16,50848
v_exp_f32 v49, v49
MAA 84,104,164
TR 42,16,51360
v_exp_f32 v50, v50
MAA 84,76,148
TR 44,16,59296
v_exp_f32 v51, v51
MAA 84,72,132
TR 46,16,59808
MAA 36,80,164
TR 48,17,16896
MAA 36,84,180
TR 50,17,17408
MAA 52,92,180
TR 52,17,25344
MAA 52,88,164
TR 54,17,25856
s_nop 2
v_pk_mul_f32 v[68:69], v[68:69], v[36:37]
v_pk_mul_f32 v[36:37], v[36:37], v[28:29] op_sel:[0,1] op_sel_hi:[1,1]
v_pk_mul_f32 v[70:71], v[70:71], v[38:39]
v_pk_mul_f32 v[38:39], v[38:39], v[28:29] op_sel:[0,1] op_sel_hi:[1,1]
v_pk_mul_f32 v[84:85], v[84:85], v[52:53]
v_pk_mul_f32 v[52:53], v[52:53], v[28:29] op_sel:[0,1] op_sel_hi:[1,1]
v_pk_mul_f32 v[86:87], v[86:87], v[54:55]
v_pk_mul_f32 v[54:55], v[54:55], v[28:29] op_sel:[0,1] op_sel_hi:[1,1]
v_pk_fma_f32 v[32:33], v[32:33], v[20:21], v[20:21] op_sel:[0,1,1] op_sel_hi:[1,1,1]
v_pk_fma_f32 v[34:35], v[34:35], v[20:21], v[20:21] op_sel:[0,1,1] op_sel_hi:[1,1,1]
v_pk_fma_f32 v[48:49], v[48:49], v[20:21], v[20:21] op_sel:[0,1,1] op_sel_hi:[1,1,1]
v_pk_fma_f32 v[50:51], v[50:51], v[20:21], v[20:21] op_sel:[0,1,1] op_sel_hi:[1,1,1]
v_rcp_f32 v32, v32
s_nop 0
MAA 72,64,136
TR 56,17,16928
v_rcp_f32 v33, v33
MAA 72,68,152
TR 58,17,17440
v_rcp_f32 v34, v34
s_waitcnt vmcnt(3)
MAA 72,96,168
TR 60,17,25376
v_rcp_f32 v35, v35
s_waitcnt vmcnt(1)
MAA 72,100,184
TR 62,17,25888
v_rcp_f32 v48, v48
MAA 88,108,184
v_rcp_f32 v49, v49
MAA 88,104,168
v_rcp_f32 v50, v50
MAA 88,76,152
v_rcp_f32 v51, v51
MAA 88,72,136
v_exp_f32 v36, v36
MAA 40,80,168
v_exp_f32 v37, v37
MAA 40,84,184
v_exp_f32 v38, v38
MAA 56,92,184
v_exp_f32 v39, v39
MAA 56,88,168
v_exp_f32 v52, v52
v_exp_f32 v53, v53
v_exp_f32 v54, v54
v_exp_f32 v55, v55
v_pk_mul_f32 v[64:65], v[64:65], v[32:33]
v_pk_mul_f32 v[66:67], v[66:67], v[34:35]
v_pk_mul_f32 v[80:81], v[80:81], v[48:49]
v_pk_mul_f32 v[82:83], v[82:83], v[50:51]
v_pk_mul_f32 v[72:73], v[72:73], v[40:41]
v_pk_mul_f32 v[40:41], v[40:41], v[30:31] op_sel_hi:[1,0]
v_pk_mul_f32 v[74:75], v[74:75], v[42:43]
v_pk_mul_f32 v[42:43], v[42:43], v[30:31] op_sel_hi:[1,0]
v_pk_mul_f32 v[88:89], v[88:89], v[56:57]
v_pk_mul_f32 v[56:57], v[56:57], v[30:31] op_sel_hi:[1,0]
v_pk_mul_f32 v[90:91], v[90:91], v[58:59]
v_pk_mul_f32 v[58:59], v[58:59], v[30:31] op_sel_hi:[1,0]
v_pk_fma_f32 v[36:37], v[36:37], v[22:23], v[22:23] op_sel:[0,1,1] op_sel_hi:[1,1,1]
v_pk_fma_f32 v[38:39], v[38:39], v[22:23], v[22:23] op_sel:[0,1,1] op_sel_hi:[1,1,1]
v_pk_fma_f32 v[52:53], v[52:53], v[22:23], v[22:23] op_sel:[0,1,1] op_sel_hi:[1,1,1]
v_pk_fma_f32 v[54:55], v[54:55], v[22:23], v[22:23] op_sel:[0,1,1] op_sel_hi:[1,1,1]
v_cvt_pk_bf16_f32 v32, v64, v65
v_cvt_pk_bf16_f32 v33, v66, v67
v_cvt_pk_bf16_f32 v34, v80, v81
v_cvt_pk_bf16_f32 v35, v82, v83
MAA 76,64,140
buffer_store_dwordx4 v[32:35], v10, s[16:19], s62 offen sc1
MAA 76,68,156
TR 64,17,33792
v_rcp_f32 v36, v36
MAA 76,96,172
TR 66,17,34304
v_rcp_f32 v37, v37
s_waitcnt vmcnt(1)
MAA 76,100,188
TR 68,17,42240
v_rcp_f32 v38, v38
MAA 92,108,188
TR 70,17,42752
v_rcp_f32 v39, v39
MAA 92,104,172
v_rcp_f32 v52, v52
MAA 92,76,156
TR 76,17,42272
v_rcp_f32 v53, v53
MAA 92,72,140
TR 72,17,33824
v_rcp_f32 v54, v54
MAA 44,80,172
TR 74,17,34336
v_rcp_f32 v55, v55
MAA 44,84,188
TR 78,17,42784
v_exp_f32 v40, v40
MAA 60,92,188
TR 80,17,50688
v_exp_f32 v41, v41
MAA 60,88,172
TR 82,17,51200
v_exp_f32 v42, v42
v_exp_f32 v43, v43
v_exp_f32 v56, v56
v_exp_f32 v57, v57
v_exp_f32 v58, v58
v_exp_f32 v59, v59
v_pk_mul_f32 v[68:69], v[68:69], v[36:37]
v_pk_mul_f32 v[70:71], v[70:71], v[38:39]
v_pk_mul_f32 v[84:85], v[84:85], v[52:53]
v_pk_mul_f32 v[86:87], v[86:87], v[54:55]
v_pk_mul_f32 v[76:77], v[76:77], v[44:45]
v_pk_mul_f32 v[44:45], v[44:45], v[30:31] op_sel:[0,1] op_sel_hi:[1,1]
v_pk_mul_f32 v[78:79], v[78:79], v[46:47]
v_pk_mul_f32 v[46:47], v[46:47], v[30:31] op_sel:[0,1] op_sel_hi:[1,1]
v_pk_mul_f32 v[92:93], v[92:93], v[60:61]
v_pk_mul_f32 v[60:61], v[60:61], v[30:31] op_sel:[0,1] op_sel_hi:[1,1]
v_pk_mul_f32 v[94:95], v[94:95], v[62:63]
v_pk_mul_f32 v[62:63], v[62:63], v[30:31] op_sel:[0,1] op_sel_hi:[1,1]
v_pk_fma_f32 v[40:41], v[40:41], v[24:25], v[24:25] op_sel:[0,1,1] op_sel_hi:[1,1,1]
v_pk_fma_f32 v[42:43], v[42:43], v[24:25], v[24:25] op_sel:[0,1,1] op_sel_hi:[1,1,1]
v_pk_fma_f32 v[56:57], v[56:57], v[24:25], v[24:25] op_sel:[0,1,1] op_sel_hi:[1,1,1]
v_pk_fma_f32 v[58:59], v[58:59], v[24:25], v[24:25] op_sel:[0,1,1] op_sel_hi:[1,1,1]
v_cvt_pk_bf16_f32 v36, v68, v69
v_cvt_pk_bf16_f32 v37, v70, v71
v_cvt_pk_bf16_f32 v38, v84, v85
v_cvt_pk_bf16_f32 v39, v86, v87
MAA 128,112,128
buffer_store_dwordx4 v[36:39], v10, s[16:19], s62 offen offset:1024 sc1
MAA 128,116,144
TR 84,17,59136
v_rcp_f32 v40, v40
s_waitcnt lgkmcnt(15)
MAA 128,208,160
TR 86,17,59648
v_rcp_f32 v41, v41
MAA 128,212,176
TR 88,17,50720
v_rcp_f32 v42, v42
MAA 144,220,176
TR 90,17,51232
v_rcp_f32 v43, v43
MAA 144,216,160
TR 92,17,59168
v_rcp_f32 v56, v56
MAA 144,124,144
TR 94,17,59680
v_rcp_f32 v57, v57
MAA 144,120,128
v_rcp_f32 v58, v58
MAA 96,192,160
v_rcp_f32 v59, v59
MAA 96,196,176
v_exp_f32 v44, v44
MAA 112,204,176
v_exp_f32 v45, v45
MAA 112,200,160
v_lshrrev_b32 v69, 2, v0
v_min_u32 v69, 1, v69
v_lshlrev_b32 v69, 28, v69
v_lshl_add_u32 v68, v0, 7, v69
v_xor_b32 v69, 64, v0
v_min_u32 v69, 1, v69
v_lshlrev_b32 v70, 4, v69
v_sub_u32 v70, 16, v70
v_lshlrev_b32 v69, 28, v69
v_mov_b32 v71, 1
s_waitcnt lgkmcnt(0)
s_barrier
v_mov_b32 v84, 0
v_mov_b32 v85, 0
v_mov_b32 v86, 0
v_exp_f32 v46, v46
v_exp_f32 v47, v47
v_exp_f32 v60, v60
v_exp_f32 v61, v61
v_exp_f32 v62, v62
v_exp_f32 v63, v63
v_pk_mul_f32 v[72:73], v[72:73], v[40:41]
v_pk_mul_f32 v[74:75], v[74:75], v[42:43]
v_pk_mul_f32 v[88:89], v[88:89], v[56:57]
v_pk_mul_f32 v[90:91], v[90:91], v[58:59]
v_pk_mul_f32 v[128:129], v[128:129], v[96:97]
v_pk_mul_f32 v[96:97], v[96:97], v[28:29] op_sel_hi:[1,0]
v_pk_mul_f32 v[130:131], v[130:131], v[98:99]
v_pk_mul_f32 v[98:99], v[98:99], v[28:29] op_sel_hi:[1,0]
v_pk_mul_f32 v[144:145], v[144:145], v[112:113]
v_pk_mul_f32 v[112:113], v[112:113], v[28:29] op_sel_hi:[1,0]
v_pk_mul_f32 v[146:147], v[146:147], v[114:115]
v_pk_mul_f32 v[114:115], v[114:115], v[28:29] op_sel_hi:[1,0]
v_pk_fma_f32 v[44:45], v[44:45], v[26:27], v[26:27] op_sel:[0,1,1] op_sel_hi:[1,1,1]
v_pk_fma_f32 v[46:47], v[46:47], v[26:27], v[26:27] op_sel:[0,1,1] op_sel_hi:[1,1,1]
v_pk_fma_f32 v[60:61], v[60:61], v[26:27], v[26:27] op_sel:[0,1,1] op_sel_hi:[1,1,1]
v_pk_fma_f32 v[62:63], v[62:63], v[26:27], v[26:27] op_sel:[0,1,1] op_sel_hi:[1,1,1]
v_cvt_pk_bf16_f32 v40, v72, v73
v_cvt_pk_bf16_f32 v41, v74, v75
v_cvt_pk_bf16_f32 v42, v88, v89
v_cvt_pk_bf16_f32 v43, v90, v91
MAA 132,112,132
buffer_store_dwordx4 v[40:43], v11, s[16:19], s62 offen sc1
MAA 132,116,148
s_add_u32 m0, s59, 84480
v_rcp_f32 v44, v44
MAA 132,208,164
v_rcp_f32 v45, v45
MAA 132,212,180
v_rcp_f32 v46, v46
MAA 148,220,180
buffer_load_dwordx4 v18, s[28:31], s58 offen lds
MAA 148,216,164
v_rcp_f32 v47, v47
MAA 148,124,148
v_rcp_f32 v60, v60
MAA 148,120,132
v_rcp_f32 v61, v61
MAA 100,192,164
buffer_load_dwordx4 v19, s[28:31], s58 offen offset:1056 lds
MAA 100,196,180
s_add_u32 m0, s59, 92928
s_add_u32 s58, s99, 2555904
v_rcp_f32 v62, v62
MAA 116,204,180
v_rcp_f32 v63, v63
MAA 116,200,164
v_exp_f32 v96, v96
v_exp_f32 v97, v97
v_exp_f32 v98, v98
v_exp_f32 v99, v99
v_exp_f32 v112, v112
v_exp_f32 v113, v113
v_exp_f32 v114, v114
v_exp_f32 v115, v115
v_pk_mul_f32 v[76:77], v[76:77], v[44:45]
v_pk_mul_f32 v[78:79], v[78:79], v[46:47]
v_pk_mul_f32 v[92:93], v[92:93], v[60:61]
v_pk_mul_f32 v[94:95], v[94:95], v[62:63]
v_pk_mul_f32 v[132:133], v[132:133], v[100:101]
v_pk_mul_f32 v[100:101], v[100:101], v[28:29] op_sel:[0,1] op_sel_hi:[1,1]
v_pk_mul_f32 v[134:135], v[134:135], v[102:103]
v_pk_mul_f32 v[102:103], v[102:103], v[28:29] op_sel:[0,1] op_sel_hi:[1,1]
v_pk_mul_f32 v[148:149], v[148:149], v[116:117]
v_pk_mul_f32 v[116:117], v[116:117], v[28:29] op_sel:[0,1] op_sel_hi:[1,1]
v_pk_mul_f32 v[150:151], v[150:151], v[118:119]
v_pk_mul_f32 v[118:119], v[118:119], v[28:29] op_sel:[0,1] op_sel_hi:[1,1]
v_pk_fma_f32 v[96:97], v[96:97], v[20:21], v[20:21] op_sel:[0,1,1] op_sel_hi:[1,1,1]
v_pk_fma_f32 v[98:99], v[98:99], v[20:21], v[20:21] op_sel:[0,1,1] op_sel_hi:[1,1,1]
v_pk_fma_f32 v[112:113], v[112:113], v[20:21], v[20:21] op_sel:[0,1,1] op_sel_hi:[1,1,1]
v_pk_fma_f32 v[114:115], v[114:115], v[20:21], v[20:21] op_sel:[0,1,1] op_sel_hi:[1,1,1]
v_cvt_pk_bf16_f32 v44, v76, v77
v_cvt_pk_bf16_f32 v45, v78, v79
v_cvt_pk_bf16_f32 v46, v92, v93
v_cvt_pk_bf16_f32 v47, v94, v95
MAA 136,112,136
buffer_store_dwordx4 v[44:47], v11, s[16:19], s62 offen offset:1024 sc1
MAA 136,116,152
v_rcp_f32 v96, v96
MAA 136,208,168
v_rcp_f32 v97, v97
MAA 136,212,184
v_rcp_f32 v98, v98
MAA 152,220,184
buffer_load_dwordx4 v18, s[28:31], s58 offen lds
MAA 152,216,168
v_rcp_f32 v99, v99
MAA 152,124,152
v_rcp_f32 v112, v112
MAA 152,120,136
v_rcp_f32 v113, v113
MAA 104,192,168
buffer_load_dwordx4 v19, s[28:31], s58 offen offset:1056 lds
MAA 104,196,184
s_add_u32 m0, s59, 101376
s_add_u32 s58, s100, 2752512
v_rcp_f32 v114, v114
MAA 120,204,184
v_rcp_f32 v115, v115
MAA 120,200,168
v_exp_f32 v100, v100
v_exp_f32 v101, v101
v_exp_f32 v102, v102
v_exp_f32 v103, v103
v_exp_f32 v116, v116
v_exp_f32 v117, v117
v_exp_f32 v118, v118
v_exp_f32 v119, v119
v_pk_mul_f32 v[128:129], v[128:129], v[96:97]
v_pk_mul_f32 v[130:131], v[130:131], v[98:99]
v_pk_mul_f32 v[144:145], v[144:145], v[112:113]
v_pk_mul_f32 v[146:147], v[146:147], v[114:115]
v_pk_mul_f32 v[136:137], v[136:137], v[104:105]
v_pk_mul_f32 v[104:105], v[104:105], v[30:31] op_sel_hi:[1,0]
v_pk_mul_f32 v[138:139], v[138:139], v[106:107]
v_pk_mul_f32 v[106:107], v[106:107], v[30:31] op_sel_hi:[1,0]
v_pk_mul_f32 v[152:153], v[152:153], v[120:121]
v_pk_mul_f32 v[120:121], v[120:121], v[30:31] op_sel_hi:[1,0]
v_pk_mul_f32 v[154:155], v[154:155], v[122:123]
v_pk_mul_f32 v[122:123], v[122:123], v[30:31] op_sel_hi:[1,0]
v_pk_fma_f32 v[100:101], v[100:101], v[22:23], v[22:23] op_sel:[0,1,1] op_sel_hi:[1,1,1]
v_pk_fma_f32 v[102:103], v[102:103], v[22:23], v[22:23] op_sel:[0,1,1] op_sel_hi:[1,1,1]
v_pk_fma_f32 v[116:117], v[116:117], v[22:23], v[22:23] op_sel:[0,1,1] op_sel_hi:[1,1,1]
v_pk_fma_f32 v[118:119], v[118:119], v[22:23], v[22:23] op_sel:[0,1,1] op_sel_hi:[1,1,1]
v_cvt_pk_bf16_f32 v96, v128, v129
v_cvt_pk_bf16_f32 v97, v130, v131
v_cvt_pk_bf16_f32 v98, v144, v145
v_cvt_pk_bf16_f32 v99, v146, v147
MAA 140,112,140
buffer_store_dwordx4 v[96:99], v10, s[16:19], s63 offen sc1
MAA 140,116,156
v_rcp_f32 v100, v100
MAA 140,208,172
v_rcp_f32 v101, v101
MAA 140,212,188
v_rcp_f32 v102, v102
MAA 156,220,188
buffer_load_dwordx4 v18, s[28:31], s58 offen lds
MAA 156,216,172
v_rcp_f32 v103, v103
MAA 156,124,156
v_rcp_f32 v116, v116
MAA 156,120,140
v_rcp_f32 v117, v117
MAA 108,192,172
buffer_load_dwordx4 v19, s[28:31], s58 offen offset:1056 lds
MAA 108,196,188
s_add_u32 m0, s59, 109824
s_add_u32 s58, s100, 3014656
v_rcp_f32 v118, v118
MAA 124,204,188
v_rcp_f32 v119, v119
MAA 124,200,172
v_exp_f32 v104, v104
v_exp_f32 v105, v105
v_exp_f32 v106, v106
v_exp_f32 v107, v107
v_exp_f32 v120, v120
v_exp_f32 v121, v121
v_exp_f32 v122, v122
v_exp_f32 v123, v123
v_pk_mul_f32 v[132:133], v[132:133], v[100:101]
v_pk_mul_f32 v[134:135], v[134:135], v[102:103]
v_pk_mul_f32 v[148:149], v[148:149], v[116:117]
v_pk_mul_f32 v[150:151], v[150:151], v[118:119]
v_pk_mul_f32 v[140:141], v[140:141], v[108:109]
v_pk_mul_f32 v[108:109], v[108:109], v[30:31] op_sel:[0,1] op_sel_hi:[1,1]
v_pk_mul_f32 v[142:143], v[142:143], v[110:111]
v_pk_mul_f32 v[110:111], v[110:111], v[30:31] op_sel:[0,1] op_sel_hi:[1,1]
v_pk_mul_f32 v[156:157], v[156:157], v[124:125]
v_pk_mul_f32 v[124:125], v[124:125], v[30:31] op_sel:[0,1] op_sel_hi:[1,1]
v_pk_mul_f32 v[158:159], v[158:159], v[126:127]
v_pk_mul_f32 v[126:127], v[126:127], v[30:31] op_sel:[0,1] op_sel_hi:[1,1]
v_pk_fma_f32 v[104:105], v[104:105], v[24:25], v[24:25] op_sel:[0,1,1] op_sel_hi:[1,1,1]
v_pk_fma_f32 v[106:107], v[106:107], v[24:25], v[24:25] op_sel:[0,1,1] op_sel_hi:[1,1,1]
v_pk_fma_f32 v[120:121], v[120:121], v[24:25], v[24:25] op_sel:[0,1,1] op_sel_hi:[1,1,1]
v_pk_fma_f32 v[122:123], v[122:123], v[24:25], v[24:25] op_sel:[0,1,1] op_sel_hi:[1,1,1]
v_cvt_pk_bf16_f32 v100, v132, v133
v_cvt_pk_bf16_f32 v101, v134, v135
v_cvt_pk_bf16_f32 v102, v148, v149
v_cvt_pk_bf16_f32 v103, v150, v151
MAA 192,0,128
buffer_store_dwordx4 v[100:103], v10, s[16:19], s63 offen offset:1024 sc1
MAA 192,4,144
v_rcp_f32 v104, v104
MAA 192,32,160
s_waitcnt vmcnt(6)
s_barrier
v_rcp_f32 v105, v105
MAA 192,36,176
v_rcp_f32 v106, v106
MAA 208,44,176
buffer_atomic_add v71, v68, s[16:19], s72 offen offset:512
MAA 208,40,160
v_rcp_f32 v107, v107
MAA 208,12,144
v_rcp_f32 v120, v120
MAA 208,8,128
v_rcp_f32 v121, v121
MAA 160,16,160
buffer_load_dwordx4 v18, s[28:31], s58 offen lds
MAA 160,20,176
v_rcp_f32 v122, v122
MAA 176,28,176
v_rcp_f32 v123, v123
MAA 176,24,160
v_exp_f32 v108, v108
v_exp_f32 v109, v109
v_exp_f32 v110, v110
v_exp_f32 v111, v111
v_exp_f32 v124, v124
v_exp_f32 v125, v125
v_exp_f32 v126, v126
v_exp_f32 v127, v127
v_pk_mul_f32 v[136:137], v[136:137], v[104:105]
v_pk_mul_f32 v[138:139], v[138:139], v[106:107]
v_pk_mul_f32 v[152:153], v[152:153], v[120:121]
v_pk_mul_f32 v[154:155], v[154:155], v[122:123]
v_pk_mul_f32 v[192:193], v[192:193], v[160:161]
v_pk_mul_f32 v[160:161], v[160:161], v[28:29] op_sel_hi:[1,0]
v_pk_mul_f32 v[194:195], v[194:195], v[162:163]
v_pk_mul_f32 v[162:163], v[162:163], v[28:29] op_sel_hi:[1,0]
v_pk_mul_f32 v[208:209], v[208:209], v[176:177]
v_pk_mul_f32 v[176:177], v[176:177], v[28:29] op_sel_hi:[1,0]
v_pk_mul_f32 v[210:211], v[210:211], v[178:179]
v_pk_mul_f32 v[178:179], v[178:179], v[28:29] op_sel_hi:[1,0]
v_pk_fma_f32 v[108:109], v[108:109], v[26:27], v[26:27] op_sel:[0,1,1] op_sel_hi:[1,1,1]
v_pk_fma_f32 v[110:111], v[110:111], v[26:27], v[26:27] op_sel:[0,1,1] op_sel_hi:[1,1,1]
v_pk_fma_f32 v[124:125], v[124:125], v[26:27], v[26:27] op_sel:[0,1,1] op_sel_hi:[1,1,1]
v_pk_fma_f32 v[126:127], v[126:127], v[26:27], v[26:27] op_sel:[0,1,1] op_sel_hi:[1,1,1]
v_cvt_pk_bf16_f32 v104, v136, v137
v_cvt_pk_bf16_f32 v105, v138, v139
v_cvt_pk_bf16_f32 v106, v152, v153
v_cvt_pk_bf16_f32 v107, v154, v155
MAA 196,0,132
buffer_store_dwordx4 v[104:107], v11, s[16:19], s63 offen sc1
MAA 196,4,148
v_rcp_f32 v108, v108
MAA 196,32,164
v_rcp_f32 v109, v109
MAA 196,36,180
v_rcp_f32 v110, v110
MAA 212,44,180
buffer_load_dwordx4 v19, s[28:31], s58 offen offset:1056 lds
MAA 212,40,164
s_add_u32 m0, s59, 118272
s_add_u32 s58, s101, 3211264
v_rcp_f32 v111, v111
MAA 212,12,148
v_rcp_f32 v124, v124
MAA 212,8,132
v_rcp_f32 v125, v125
MAA 164,16,164
buffer_load_dwordx4 v18, s[28:31], s58 offen lds
MAA 164,20,180
v_rcp_f32 v126, v126
MAA 180,28,180
v_rcp_f32 v127, v127
MAA 180,24,164
v_exp_f32 v160, v160
v_exp_f32 v161, v161
v_exp_f32 v162, v162
v_exp_f32 v163, v163
v_exp_f32 v176, v176
v_exp_f32 v177, v177
v_exp_f32 v178, v178
v_exp_f32 v179, v179
v_pk_mul_f32 v[140:141], v[140:141], v[108:109]
v_pk_mul_f32 v[142:143], v[142:143], v[110:111]
v_pk_mul_f32 v[156:157], v[156:157], v[124:125]
v_pk_mul_f32 v[158:159], v[158:159], v[126:127]
v_pk_mul_f32 v[196:197], v[196:197], v[164:165]
v_pk_mul_f32 v[164:165], v[164:165], v[28:29] op_sel:[0,1] op_sel_hi:[1,1]
v_pk_mul_f32 v[198:199], v[198:199], v[166:167]
v_pk_mul_f32 v[166:167], v[166:167], v[28:29] op_sel:[0,1] op_sel_hi:[1,1]
v_pk_mul_f32 v[212:213], v[212:213], v[180:181]
v_pk_mul_f32 v[180:181], v[180:181], v[28:29] op_sel:[0,1] op_sel_hi:[1,1]
v_pk_mul_f32 v[214:215], v[214:215], v[182:183]
v_pk_mul_f32 v[182:183], v[182:183], v[28:29] op_sel:[0,1] op_sel_hi:[1,1]
v_pk_fma_f32 v[160:161], v[160:161], v[20:21], v[20:21] op_sel:[0,1,1] op_sel_hi:[1,1,1]
v_pk_fma_f32 v[162:163], v[162:163], v[20:21], v[20:21] op_sel:[0,1,1] op_sel_hi:[1,1,1]
v_pk_fma_f32 v[176:177], v[176:177], v[20:21], v[20:21] op_sel:[0,1,1] op_sel_hi:[1,1,1]
v_pk_fma_f32 v[178:179], v[178:179], v[20:21], v[20:21] op_sel:[0,1,1] op_sel_hi:[1,1,1]
v_cvt_pk_bf16_f32 v108, v140, v141
v_cvt_pk_bf16_f32 v109, v142, v143
v_cvt_pk_bf16_f32 v110, v156, v157
.Lpad26:
s_cbranch_execz .Lpad29
v_cvt_pk_bf16_f32 v111, v158, v159
MAA 200,0,136
buffer_store_dwordx4 v[108:111], v11, s[16:19], s63 offen offset:1024 sc1
MAA 200,4,152
v_rcp_f32 v160, v160
MAA 200,32,168
v_rcp_f32 v161, v161
MAA 200,36,184
v_rcp_f32 v162, v162
MAA 216,44,184
buffer_load_dwordx4 v19, s[28:31], s58 offen offset:1056 lds
MAA 216,40,168
s_add_u32 m0, s59, 126720
s_add_u32 s58, s101, 3473408
v_rcp_f32 v163, v163
MAA 216,12,152
v_rcp_f32 v176, v176
MAA 216,8,136
v_rcp_f32 v177, v177
MAA 168,16,168
buffer_load_dwordx4 v18, s[28:31], s58 offen lds
MAA 168,20,184
v_rcp_f32 v178, v178
MAA 184,28,184
v_rcp_f32 v179, v179
MAA 184,24,168
v_exp_f32 v164, v164
v_exp_f32 v165, v165
v_exp_f32 v166, v166
v_exp_f32 v167, v167
v_exp_f32 v180, v180
v_exp_f32 v181, v181
v_exp_f32 v182, v182
v_exp_f32 v183, v183
v_pk_mul_f32 v[192:193], v[192:193], v[160:161]
v_pk_mul_f32 v[194:195], v[194:195], v[162:163]
v_pk_mul_f32 v[208:209], v[208:209], v[176:177]
v_pk_mul_f32 v[210:211], v[210:211], v[178:179]
v_pk_mul_f32 v[200:201], v[200:201], v[168:169]
v_pk_mul_f32 v[168:169], v[168:169], v[30:31] op_sel_hi:[1,0]
v_pk_mul_f32 v[202:203], v[202:203], v[170:171]
v_pk_mul_f32 v[170:171], v[170:171], v[30:31] op_sel_hi:[1,0]
v_pk_mul_f32 v[216:217], v[216:217], v[184:185]
v_pk_mul_f32 v[184:185], v[184:185], v[30:31] op_sel_hi:[1,0]
v_pk_mul_f32 v[218:219], v[218:219], v[186:187]
v_pk_mul_f32 v[186:187], v[186:187], v[30:31] op_sel_hi:[1,0]
v_pk_fma_f32 v[164:165], v[164:165], v[22:23], v[22:23] op_sel:[0,1,1] op_sel_hi:[1,1,1]
v_pk_fma_f32 v[166:167], v[166:167], v[22:23], v[22:23] op_sel:[0,1,1] op_sel_hi:[1,1,1]
v_pk_fma_f32 v[180:181], v[180:181], v[22:23], v[22:23] op_sel:[0,1,1] op_sel_hi:[1,1,1]
v_pk_fma_f32 v[182:183], v[182:183], v[22:23], v[22:23] op_sel:[0,1,1] op_sel_hi:[1,1,1]
v_cvt_pk_bf16_f32 v160, v192, v193
v_cvt_pk_bf16_f32 v161, v194, v195
v_cvt_pk_bf16_f32 v162, v208, v209
v_cvt_pk_bf16_f32 v163, v210, v211
MAA 204,0,140
buffer_store_dwordx4 v[160:163], v10, s[16:19], s64 offen sc1
MAA 204,4,156
v_rcp_f32 v164, v164
MAA 204,32,172
v_rcp_f32 v165, v165
MAA 204,36,188
v_rcp_f32 v166, v166
MAA 220,44,188
buffer_atomic_add v84, v69, s[16:19], s73 offen offset:512 sc0
MAA 220,40,172
v_rcp_f32 v167, v167
MAA 220,12,156
v_rcp_f32 v180, v180
MAA 220,8,140
v_rcp_f32 v181, v181
MAA 172,16,172
buffer_load_dwordx4 v19, s[28:31], s58 offen offset:1056 lds
MAA 172,20,188
v_rcp_f32 v182, v182
MAA 188,28,188
v_rcp_f32 v183, v183
MAA 188,24,172
v_exp_f32 v168, v168
v_exp_f32 v169, v169
v_exp_f32 v170, v170
v_exp_f32 v171, v171
v_exp_f32 v184, v184
v_exp_f32 v185, v185
v_exp_f32 v186, v186
v_exp_f32 v187, v187
v_pk_mul_f32 v[196:197], v[196:197], v[164:165]
v_pk_mul_f32 v[198:199], v[198:199], v[166:167]
v_pk_mul_f32 v[212:213], v[212:213], v[180:181]
v_pk_mul_f32 v[214:215], v[214:215], v[182:183]
v_pk_mul_f32 v[204:205], v[204:205], v[172:173]
v_pk_mul_f32 v[172:173], v[172:173], v[30:31] op_sel:[0,1] op_sel_hi:[1,1]
v_pk_mul_f32 v[206:207], v[206:207], v[174:175]
v_pk_mul_f32 v[174:175], v[174:175], v[30:31] op_sel:[0,1] op_sel_hi:[1,1]
v_pk_mul_f32 v[220:221], v[220:221], v[188:189]
v_pk_mul_f32 v[188:189], v[188:189], v[30:31] op_sel:[0,1] op_sel_hi:[1,1]
v_pk_mul_f32 v[222:223], v[222:223], v[190:191]
v_pk_mul_f32 v[190:191], v[190:191], v[30:31] op_sel:[0,1] op_sel_hi:[1,1]
v_pk_fma_f32 v[168:169], v[168:169], v[24:25], v[24:25] op_sel:[0,1,1] op_sel_hi:[1,1,1]
v_pk_fma_f32 v[170:171], v[170:171], v[24:25], v[24:25] op_sel:[0,1,1] op_sel_hi:[1,1,1]
v_pk_fma_f32 v[184:185], v[184:185], v[24:25], v[24:25] op_sel:[0,1,1] op_sel_hi:[1,1,1]
v_pk_fma_f32 v[186:187], v[186:187], v[24:25], v[24:25] op_sel:[0,1,1] op_sel_hi:[1,1,1]
v_cvt_pk_bf16_f32 v164, v196, v197
v_cvt_pk_bf16_f32 v165, v198, v199
v_cvt_pk_bf16_f32 v166, v212, v213
v_cvt_pk_bf16_f32 v167, v214, v215
MAA 240,48,128
buffer_store_dwordx4 v[164:167], v10, s[16:19], s64 offen offset:1024 sc1
MAA 240,52,144
v_rcp_f32 v168, v168
MAA 240,80,160
v_rcp_f32 v169, v169
MAA 240,84,176
v_rcp_f32 v170, v170
MAA 248,92,176
buffer_atomic_add v85, v69, s[16:19], s73 offen offset:512 sc0
MAA 248,88,160
v_rcp_f32 v171, v171
MAA 248,60,144
v_rcp_f32 v184, v184
MAA 248,56,128
v_rcp_f32 v185, v185
MAA 224,64,160
v_rcp_f32 v186, v186
MAA 224,68,176
v_rcp_f32 v187, v187
MAA 232,76,176
v_exp_f32 v172, v172
MAA 232,72,160
v_exp_f32 v173, v173
v_exp_f32 v174, v174
v_exp_f32 v175, v175
v_exp_f32 v188, v188
v_exp_f32 v189, v189
v_exp_f32 v190, v190
v_exp_f32 v191, v191
v_pk_mul_f32 v[200:201], v[200:201], v[168:169]
v_pk_mul_f32 v[202:203], v[202:203], v[170:171]
v_pk_mul_f32 v[216:217], v[216:217], v[184:185]
v_pk_mul_f32 v[218:219], v[218:219], v[186:187]
v_pk_mul_f32 v[240:241], v[240:241], v[224:225]
v_pk_mul_f32 v[224:225], v[224:225], v[28:29] op_sel_hi:[1,0]
v_pk_mul_f32 v[242:243], v[242:243], v[226:227]
v_pk_mul_f32 v[226:227], v[226:227], v[28:29] op_sel_hi:[1,0]
v_pk_mul_f32 v[248:249], v[248:249], v[232:233]
v_pk_mul_f32 v[232:233], v[232:233], v[28:29] op_sel_hi:[1,0]
v_pk_mul_f32 v[250:251], v[250:251], v[234:235]
v_pk_mul_f32 v[234:235], v[234:235], v[28:29] op_sel_hi:[1,0]
v_pk_fma_f32 v[172:173], v[172:173], v[26:27], v[26:27] op_sel:[0,1,1] op_sel_hi:[1,1,1]
v_pk_fma_f32 v[174:175], v[174:175], v[26:27], v[26:27] op_sel:[0,1,1] op_sel_hi:[1,1,1]
v_pk_fma_f32 v[188:189], v[188:189], v[26:27], v[26:27] op_sel:[0,1,1] op_sel_hi:[1,1,1]
v_pk_fma_f32 v[190:191], v[190:191], v[26:27], v[26:27] op_sel:[0,1,1] op_sel_hi:[1,1,1]
v_cvt_pk_bf16_f32 v168, v200, v201
v_cvt_pk_bf16_f32 v169, v202, v203
v_cvt_pk_bf16_f32 v170, v216, v217
v_cvt_pk_bf16_f32 v171, v218, v219
buffer_store_dwordx4 v[168:171], v11, s[16:19], s64 offen sc1
buffer_atomic_add v86, v69, s[16:19], s73 offen offset:512 sc0
s_waitcnt vmcnt(5)
v_cmp_gt_u32 vcc, v70, v84
s_nop 0
s_cbranch_vccz .Lok66
s_waitcnt vmcnt(2)
v_cmp_gt_u32 vcc, v70, v85
s_nop 0
s_cbranch_vccz .Lok66
s_waitcnt vmcnt(0)
v_cmp_gt_u32 vcc, v70, v86
s_nop 0
s_cbranch_vccz .Lok66
s_mov_b32 s15, 0
.Lok66l:
v_mov_b32 v84, 0
buffer_atomic_add v84, v69, s[16:19], s73 offen offset:512 sc0
s_add_u32 s15, s15, 1
s_cmp_gt_u32 s15, 100000
s_waitcnt vmcnt(0)
s_cbranch_scc1 .Lok66
v_cmp_gt_u32 vcc, v70, v84
s_nop 0
s_cbranch_vccnz .Lok66l
.Lok66:
s_waitcnt vmcnt(4)
s_barrier
MAA 244,48,132
ds_read_b64_tr_b16 a[0:1], v7
s_add_u32 s52, s76, 0
MAA 244,52,148
buffer_load_dwordx4 v[96:99], v4, s[16:19], s52 offen sc1
MAA 244,80,164
TR 2,7,512
v_rcp_f32 v172, v172
MAA 244,84,180
TR 4,7,32
v_rcp_f32 v173, v173
MAA 252,92,180
TR 6,7,544
v_rcp_f32 v174, v174
MAA 252,88,164
buffer_load_dwordx4 v[100:103], v4, s[16:19], s52 offen offset:1024 sc1
MAA 252,60,148
TR 8,7,64
s_add_u32 s52, s76, 65536
MAA 252,56,132
TR 10,7,576
v_rcp_f32 v175, v175
MAA 228,64,164
TR 12,7,96
v_rcp_f32 v188, v188
MAA 228,68,180
buffer_load_dwordx4 v[104:107], v4, s[16:19], s52 offen sc1
MAA 236,76,180
TR 14,7,608
v_rcp_f32 v189, v189
MAA 236,72,164
TR 16,7,8448
v_rcp_f32 v190, v190
v_rcp_f32 v191, v191
v_exp_f32 v224, v224
v_exp_f32 v225, v225
v_exp_f32 v226, v226
v_exp_f32 v227, v227
v_exp_f32 v232, v232
v_exp_f32 v233, v233
v_exp_f32 v234, v234
v_exp_f32 v235, v235
v_pk_mul_f32 v[204:205], v[204:205], v[172:173]
buffer_load_dwordx4 v[108:111], v4, s[16:19], s52 offen offset:1024 sc1
s_add_u32 s52, s77, 114688
v_pk_mul_f32 v[206:207], v[206:207], v[174:175]
v_pk_mul_f32 v[220:221], v[220:221], v[188:189]
v_pk_mul_f32 v[222:223], v[222:223], v[190:191]
v_pk_mul_f32 v[244:245], v[244:245], v[228:229]
v_pk_mul_f32 v[228:229], v[228:229], v[28:29] op_sel:[0,1] op_sel_hi:[1,1]
v_pk_mul_f32 v[246:247], v[246:247], v[230:231]
v_pk_mul_f32 v[230:231], v[230:231], v[28:29] op_sel:[0,1] op_sel_hi:[1,1]
v_pk_mul_f32 v[252:253], v[252:253], v[236:237]
v_pk_mul_f32 v[236:237], v[236:237], v[28:29] op_sel:[0,1] op_sel_hi:[1,1]
v_pk_mul_f32 v[254:255], v[254:255], v[238:239]
v_pk_mul_f32 v[238:239], v[238:239], v[28:29] op_sel:[0,1] op_sel_hi:[1,1]
v_pk_fma_f32 v[224:225], v[224:225], v[20:21], v[20:21] op_sel:[0,1,1] op_sel_hi:[1,1,1]
buffer_load_dwordx4 v[112:115], v4, s[16:19], s52 offen sc1
v_pk_fma_f32 v[226:227], v[226:227], v[20:21], v[20:21] op_sel:[0,1,1] op_sel_hi:[1,1,1]
v_pk_fma_f32 v[232:233], v[232:233], v[20:21], v[20:21] op_sel:[0,1,1] op_sel_hi:[1,1,1]
v_pk_fma_f32 v[234:235], v[234:235], v[20:21], v[20:21] op_sel:[0,1,1] op_sel_hi:[1,1,1]
v_cvt_pk_bf16_f32 v172, v204, v205
v_cvt_pk_bf16_f32 v173, v206, v207
v_cvt_pk_bf16_f32 v174, v220, v221
v_cvt_pk_bf16_f32 v175, v222, v223
TR 18,7,8960
TR 20,7,8480
TR 22,7,8992
buffer_store_dwordx4 v[172:175], v11, s[16:19], s64 offen offset:1024 sc1
TR 24,7,8512
TR 26,7,9024
TR 28,7,8544
TR 30,7,9056
v_rcp_f32 v224, v224
v_rcp_f32 v225, v225
v_rcp_f32 v226, v226
v_rcp_f32 v227, v227
v_rcp_f32 v232, v232
v_rcp_f32 v233, v233
v_rcp_f32 v234, v234
v_rcp_f32 v235, v235
v_exp_f32 v228, v228
v_exp_f32 v229, v229
v_exp_f32 v230, v230
v_exp_f32 v231, v231
v_exp_f32 v236, v236
v_exp_f32 v237, v237
v_exp_f32 v238, v238
v_exp_f32 v239, v239
v_pk_mul_f32 v[240:241], v[240:241], v[224:225]
buffer_load_dwordx4 v[116:119], v4, s[16:19], s52 offen offset:1024 sc1
s_add_u32 s52, s77, 180224
v_pk_mul_f32 v[242:243], v[242:243], v[226:227]
v_pk_mul_f32 v[248:249], v[248:249], v[232:233]
v_pk_mul_f32 v[250:251], v[250:251], v[234:235]
v_pk_fma_f32 v[228:229], v[228:229], v[22:23], v[22:23] op_sel:[0,1,1] op_sel_hi:[1,1,1]
v_pk_fma_f32 v[230:231], v[230:231], v[22:23], v[22:23] op_sel:[0,1,1] op_sel_hi:[1,1,1]
v_pk_fma_f32 v[236:237], v[236:237], v[22:23], v[22:23] op_sel:[0,1,1] op_sel_hi:[1,1,1]
v_pk_fma_f32 v[238:239], v[238:239], v[22:23], v[22:23] op_sel:[0,1,1] op_sel_hi:[1,1,1]
v_cvt_pk_bf16_f32 v224, v240, v241
v_cvt_pk_bf16_f32 v225, v242, v243
v_cvt_pk_bf16_f32 v226, v248, v249
v_cvt_pk_bf16_f32 v227, v250, v251
v_rcp_f32 v228, v228
v_rcp_f32 v229, v229
v_rcp_f32 v230, v230
v_rcp_f32 v231, v231
v_rcp_f32 v236, v236
v_rcp_f32 v237, v237
v_rcp_f32 v238, v238
v_rcp_f32 v239, v239
v_pk_mul_f32 v[244:245], v[244:245], v[228:229]
buffer_store_dwordx4 v[224:227], v10, s[16:19], s65 offen sc1
v_pk_mul_f32 v[246:247], v[246:247], v[230:231]
v_pk_mul_f32 v[252:253], v[252:253], v[236:237]
v_pk_mul_f32 v[254:255], v[254:255], v[238:239]
v_cvt_pk_bf16_f32 v228, v244, v245
v_cvt_pk_bf16_f32 v229, v246, v247
v_cvt_pk_bf16_f32 v230, v252, v253
v_cvt_pk_bf16_f32 v231, v254, v255
buffer_store_dwordx4 v[228:231], v10, s[16:19], s65 offen offset:1024 sc1
buffer_load_dwordx4 v[120:123], v4, s[16:19], s52 offen sc1
buffer_load_dwordx4 v[124:127], v4, s[16:19], s52 offen offset:1024 sc1
v_mov_b32 v21, v68
v_mov_b32 v22, v69
v_mov_b32 v23, v70
v_mov_b32 v24, v71
v_mov_b32 v25, 0
s_waitcnt vmcnt(7) lgkmcnt(0)
s_barrier
v_mfma_f32_16x16x32_bf16 v[32:35], a[0:3], v[96:99], 0
ds_read_b64_tr_b16 a[32:33], v6
s_add_u32 s52, s78, 229376
MAV 32,16,104
buffer_load_dwordx4 v[128:131], v4, s[16:19], s52 offen sc1
v_mfma_f32_16x16x32_bf16 v[48:51], a[0:3], v[100:103], 0
TR 34,6,512
TR 36,6,32
MAV 48,16,108
TR 38,6,544
v_mfma_f32_16x16x32_bf16 v[52:55], a[4:7], v[100:103], 0
buffer_load_dwordx4 v[132:135], v4, s[16:19], s52 offen offset:1024 sc1
MAV 52,20,108
TR 48,6,8448
TR 50,6,8960
v_mfma_f32_16x16x32_bf16 v[36:39], a[4:7], v[96:99], 0
TR 52,6,8480
MAV 36,20,104
TR 54,6,8992
s_add_u32 s52, s78, 294912
v_mfma_f32_16x16x32_bf16 v[40:43], a[8:11], v[96:99], 0
buffer_load_dwordx4 v[136:139], v4, s[16:19], s52 offen sc1
MAV 40,24,104
TR 40,6,64
v_mfma_f32_16x16x32_bf16 v[56:59], a[8:11], v[100:103], 0
TR 42,6,576
TR 44,6,96
MAV 56,24,108
TR 46,6,608
v_mfma_f32_16x16x32_bf16 v[60:63], a[12:15], v[100:103], 0
buffer_load_dwordx4 v[140:143], v4, s[16:19], s52 offen offset:1024 sc1
MAV 60,28,108
TR 56,6,8512
TR 58,6,9024
v_mfma_f32_16x16x32_bf16 v[44:47], a[12:15], v[96:99], 0
TR 60,6,8544
MAV 44,28,104
TR 62,6,9056
s_waitcnt lgkmcnt(8)
v_mfma_f32_16x16x32_bf16 v[64:67], a[32:35], v[96:99], 0
TR 0,7,16896
s_add_u32 s52, s79, 344064
MAV 64,48,104
buffer_load_dwordx4 v[144:147], v4, s[16:19], s52 offen sc1
v_mfma_f32_16x16x32_bf16 v[80:83], a[32:35], v[100:103], 0
TR 2,7,17408
TR 4,7,16928
MAV 80,48,108
TR 6,7,17440
v_mfma_f32_16x16x32_bf16 v[84:87], a[36:39], v[100:103], 0
buffer_load_dwordx4 v[148:151], v4, s[16:19], s52 offen offset:1024 sc1
MAV 84,52,108
TR 16,7,25344
TR 18,7,25856
v_mfma_f32_16x16x32_bf16 v[68:71], a[36:39], v[96:99], 0
TR 20,7,25376
MAV 68,52,104
TR 22,7,25888
s_add_u32 s52, s79, 409600
s_waitcnt lgkmcnt(8)
v_mfma_f32_16x16x32_bf16 v[72:75], a[40:43], v[96:99], 0
buffer_load_dwordx4 v[152:155], v4, s[16:19], s52 offen sc1
MAV 72,56,104
TR 8,7,16960
v_mfma_f32_16x16x32_bf16 v[88:91], a[40:43], v[100:103], 0
TR 10,7,17472
TR 12,7,16992
MAV 88,56,108
TR 14,7,17504
v_mfma_f32_16x16x32_bf16 v[92:95], a[44:47], v[100:103], 0
buffer_load_dwordx4 v[156:159], v4, s[16:19], s52 offen offset:1024 sc1
MAV 92,60,108
TR 24,7,25408
TR 26,7,25920
v_mfma_f32_16x16x32_bf16 v[76:79], a[44:47], v[96:99], 0
TR 28,7,25440
MAV 76,60,104
TR 30,7,25952
s_waitcnt vmcnt(8) lgkmcnt(8)
s_barrier
MAV 32,0,112
TR 32,6,16896
TR 34,6,17408
MAV 32,16,120
buffer_atomic_add v24, v21, s[16:19], s72 offen
MAV 48,16,124
TR 36,6,16928
TR 38,6,17440
MAV 48,0,116
TR 48,6,25344
s_add_u32 m0, s55, 0
MAV 52,4,116
buffer_load_dwordx4 v18, s[28:31], s54 offen lds
MAV 52,20,124
TR 50,6,25856
MAV 36,20,120
TR 52,6,25376
TR 54,6,25888
MAV 36,4,112
TR 40,6,16960
s_add_u32 s52, s76, 458752
s_waitcnt lgkmcnt(9)
MAV 40,8,112
buffer_load_dwordx4 v[96:99], v4, s[16:19], s52 offen sc1
MAV 40,24,120
TR 42,6,17472
TR 44,6,16992
MAV 56,24,124
buffer_load_dwordx4 v19, s[28:31], s54 offen offset:1056 lds
MAV 56,8,116
s_add_u32 s54, s98, 327680
MAV 60,12,116
TR 46,6,17504
TR 56,6,25408
MAV 60,28,124
buffer_load_dwordx4 v[100:103], v4, s[16:19], s52 offen offset:1024 sc1
MAV 44,28,120
TR 58,6,25920
TR 60,6,25440
MAV 44,12,112
TR 62,6,25952
s_waitcnt lgkmcnt(8)
MAV 64,32,112
TR 0,7,33792
s_add_u32 m0, s55, 8448
MAV 64,48,120
buffer_load_dwordx4 v18, s[28:31], s54 offen lds
MAV 80,48,124
TR 2,7,34304
TR 4,7,33824
MAV 80,32,116
TR 6,7,34336
s_add_u32 s52, s76, 524288
MAV 84,36,116
buffer_load_dwordx4 v[104:107], v4, s[16:19], s52 offen sc1
MAV 84,52,124
TR 16,7,42240
MAV 68,52,120
TR 18,7,42752
TR 20,7,42272
MAV 68,36,112
TR 22,7,42784
s_waitcnt lgkmcnt(8)
MAV 72,40,112
buffer_load_dwordx4 v19, s[28:31], s54 offen offset:1056 lds
MAV 72,56,120
s_add_u32 s54, s99, 524288
MAV 88,56,124
TR 8,7,33856
TR 10,7,34368
MAV 88,40,116
TR 12,7,33888
TR 14,7,34400
MAV 92,44,116
buffer_load_dwordx4 v[108:111], v4, s[16:19], s52 offen offset:1024 sc1
MAV 92,60,124
TR 24,7,42304
MAV 76,60,120
TR 26,7,42816
TR 28,7,42336
MAV 76,44,112
TR 30,7,42848
s_waitcnt vmcnt(13) lgkmcnt(8)
s_barrier
MAV 32,0,128
TR 32,6,33792
s_add_u32 m0, s55, 16896
MAV 32,16,136
buffer_load_dwordx4 v18, s[28:31], s54 offen lds
MAV 48,16,140
TR 34,6,34304
TR 36,6,33824
MAV 48,0,132
TR 38,6,34336
s_add_u32 s52, s77, 573440
MAV 52,4,132
buffer_load_dwordx4 v[112:115], v4, s[16:19], s52 offen sc1
MAV 52,20,140
TR 48,6,42240
MAV 36,20,136
TR 50,6,42752
TR 52,6,42272
MAV 36,4,128
TR 54,6,42784
s_waitcnt lgkmcnt(8)
MAV 40,8,128
buffer_load_dwordx4 v19, s[28:31], s54 offen offset:1056 lds
MAV 40,24,136
s_add_u32 s54, s99, 786432
MAV 56,24,140
TR 40,6,33856
TR 42,6,34368
MAV 56,8,132
TR 44,6,33888
TR 46,6,34400
MAV 60,12,132
buffer_load_dwordx4 v[116:119], v4, s[16:19], s52 offen offset:1024 sc1
MAV 60,28,140
TR 56,6,42304
MAV 44,28,136
TR 58,6,42816
TR 60,6,42336
MAV 44,12,128
TR 62,6,42848
s_waitcnt lgkmcnt(8)
MAV 64,32,128
TR 0,7,50688
s_add_u32 m0, s55, 25344
MAV 64,48,136
buffer_load_dwordx4 v18, s[28:31], s54 offen lds
MAV 80,48,140
TR 2,7,51200
TR 4,7,50720
MAV 80,32,132
TR 6,7,51232
s_add_u32 s52, s77, 638976
MAV 84,36,132
buffer_load_dwordx4 v[120:123], v4, s[16:19], s52 offen sc1
MAV 84,52,140
TR 16,7,59136
TR 18,7,59648
MAV 68,52,136
TR 20,7,59168
TR 22,7,59680
MAV 68,36,128
s_waitcnt lgkmcnt(8)
MAV 72,40,128
buffer_load_dwordx4 v19, s[28:31], s54 offen offset:1056 lds
MAV 72,56,136
TR 8,7,50752
s_add_u32 s54, s100, 983040
MAV 88,56,140
buffer_load_dwordx4 v[124:127], v4, s[16:19], s52 offen offset:1024 sc1
MAV 88,40,132
TR 10,7,51264
TR 12,7,50784
MAV 92,44,132
TR 14,7,51296
TR 24,7,59200
MAV 92,60,140
buffer_atomic_add v25, v22, s[16:19], s73 offen sc0
MAV 76,60,136
TR 26,7,59712
TR 28,7,59232
MAV 76,44,128
TR 30,7,59744
s_waitcnt vmcnt(18) lgkmcnt(8)
s_barrier
MAV 32,0,144
TR 32,6,50688
s_add_u32 m0, s55, 33792
MAV 32,16,152
buffer_load_dwordx4 v18, s[28:31], s54 offen lds
MAV 48,16,156
TR 34,6,51200
TR 36,6,50720
MAV 48,0,148
TR 38,6,51232
s_add_u32 s52, s78, 688128
MAV 52,4,148
buffer_load_dwordx4 v[128:131], v4, s[16:19], s52 offen sc1
MAV 52,20,156
TR 48,6,59136
MAV 36,20,152
TR 50,6,59648
TR 52,6,59168
MAV 36,4,144
.Lpad27:
s_cbranch_execz .Lpad30
TR 54,6,59680
s_waitcnt lgkmcnt(8)
MAV 40,8,144
buffer_load_dwordx4 v19, s[28:31], s54 offen offset:1056 lds
MAV 40,24,152
s_add_u32 s54, s100, 1245184
MAV 56,24,156
TR 40,6,50752
TR 42,6,51264
MAV 56,8,148
TR 44,6,50784
TR 46,6,51296
MAV 60,12,148
buffer_load_dwordx4 v[132:135], v4, s[16:19], s52 offen offset:1024 sc1
MAV 60,28,156
TR 56,6,59200
MAV 44,28,152
TR 58,6,59712
TR 60,6,59232
MAV 44,12,144
TR 62,6,59744
v_add_u32 v7, s57, v7
v_add_u32 v6, s57, v6
s_sub_u32 s57, 0, s57
s_waitcnt lgkmcnt(8)
MAV 64,32,144
ds_read_b64_tr_b16 a[0:1], v7
s_add_u32 m0, s55, 42240
MAV 64,48,152
buffer_load_dwordx4 v18, s[28:31], s54 offen lds
MAV 80,48,156
TR 2,7,512
TR 4,7,32
MAV 80,32,148
TR 6,7,544
s_add_u32 s52, s78, 753664
MAV 84,36,148
buffer_load_dwordx4 v[136:139], v4, s[16:19], s52 offen sc1
MAV 84,52,156
TR 16,7,8448
MAV 68,52,152
TR 18,7,8960
TR 20,7,8480
MAV 68,36,144
TR 22,7,8992
s_waitcnt lgkmcnt(8)
MAV 72,40,144
buffer_load_dwordx4 v19, s[28:31], s54 offen offset:1056 lds
MAV 72,56,152
s_add_u32 s54, s101, 1441792
MAV 88,56,156
TR 8,7,64
TR 10,7,576
MAV 88,40,148
TR 12,7,96
TR 14,7,608
MAV 92,44,148
buffer_load_dwordx4 v[140:143], v4, s[16:19], s52 offen offset:1024 sc1
MAV 92,60,156
TR 24,7,8512
MAV 76,60,152
TR 26,7,9024
TR 28,7,8544
MAV 76,44,144
TR 30,7,9056
s_waitcnt vmcnt(17) lgkmcnt(8)
s_barrier
MAV 32,0,96
ds_read_b64_tr_b16 a[32:33], v6
s_add_u32 m0, s55, 50688
MAV 32,16,104
buffer_load_dwordx4 v18, s[28:31], s54 offen lds
MAV 48,16,108
TR 34,6,512
TR 36,6,32
MAV 48,0,100
TR 38,6,544
s_add_u32 s52, s79, 802816
MAV 52,4,100
buffer_load_dwordx4 v[144:147], v4, s[16:19], s52 offen sc1
MAV 52,20,108
TR 48,6,8448
MAV 36,20,104
TR 50,6,8960
TR 52,6,8480
MAV 36,4,96
TR 54,6,8992
s_waitcnt lgkmcnt(8)
MAV 40,8,96
buffer_load_dwordx4 v19, s[28:31], s54 offen offset:1056 lds
MAV 40,24,104
s_add_u32 s54, s101, 1703936
MAV 56,24,108
TR 40,6,64
TR 42,6,576
MAV 56,8,100
TR 44,6,96
TR 46,6,608
MAV 60,12,100
buffer_load_dwordx4 v[148:151], v4, s[16:19], s52 offen offset:1024 sc1
MAV 60,28,108
TR 56,6,8512
MAV 44,28,104
TR 58,6,9024
TR 60,6,8544
MAV 44,12,96
TR 62,6,9056
s_waitcnt lgkmcnt(8)
MAV 64,32,96
TR 0,7,16896
s_add_u32 m0, s55, 59136
MAV 64,48,104
buffer_load_dwordx4 v18, s[28:31], s54 offen lds
MAV 80,48,108
TR 2,7,17408
TR 4,7,16928
MAV 80,32,100
TR 6,7,17440
s_add_u32 s52, s79, 868352
MAV 84,36,100
buffer_load_dwordx4 v[152:155], v4, s[16:19], s52 offen sc1
MAV 84,52,108
TR 16,7,25344
MAV 68,52,104
TR 18,7,25856
TR 20,7,25376
MAV 68,36,96
TR 22,7,25888
s_waitcnt lgkmcnt(8)
MAV 72,40,96
buffer_load_dwordx4 v19, s[28:31], s54 offen offset:1056 lds
MAV 72,56,104
s_add_u32 s54, s98, 1900544
MAV 88,56,108
TR 8,7,16960
TR 10,7,17472
MAV 88,40,100
TR 12,7,16992
TR 14,7,17504
MAV 92,44,100
buffer_load_dwordx4 v[156:159], v4, s[16:19], s52 offen offset:1024 sc1
MAV 92,60,108
TR 24,7,25408
MAV 76,60,104
TR 26,7,25920
TR 28,7,25440
MAV 76,44,96
TR 30,7,25952
s_waitcnt vmcnt(16)
v_cmp_gt_u32 vcc, v23, v25
s_nop 0
s_cbranch_vccnz .Lsp67
.Lsp67b:
s_waitcnt lgkmcnt(8)
s_barrier
MAV 32,0,112
TR 32,6,16896
s_add_u32 m0, s55, 67584
MAV 32,16,120
buffer_load_dwordx4 v18, s[28:31], s54 offen lds
MAV 48,16,124
TR 34,6,17408
TR 36,6,16928
MAV 48,0,116
TR 38,6,17440
s_add_u32 s52, s76, 16384
MAV 52,4,116
buffer_load_dwordx4 v[96:99], v4, s[16:19], s52 offen sc1
MAV 52,20,124
TR 48,6,25344
MAV 36,20,120
TR 50,6,25856
TR 52,6,25376
MAV 36,4,112
TR 54,6,25888
s_waitcnt lgkmcnt(8)
MAV 40,8,112
buffer_load_dwordx4 v19, s[28:31], s54 offen offset:1056 lds
MAV 40,24,120
s_add_u32 s54, s98, 2162688
MAV 56,24,124
TR 40,6,16960
TR 42,6,17472
MAV 56,8,116
TR 44,6,16992
TR 46,6,17504
MAV 60,12,116
buffer_load_dwordx4 v[100:103], v4, s[16:19], s52 offen offset:1024 sc1
MAV 60,28,124
TR 56,6,25408
MAV 44,28,120
TR 58,6,25920
TR 60,6,25440
MAV 44,12,112
TR 62,6,25952
s_waitcnt lgkmcnt(8)
MAV 64,32,112
TR 0,7,33792
s_add_u32 m0, s55, 76032
MAV 64,48,120
buffer_load_dwordx4 v18, s[28:31], s54 offen lds
MAV 80,48,124
TR 2,7,34304
TR 4,7,33824
MAV 80,32,116
TR 6,7,34336
s_add_u32 s52, s76, 81920
MAV 84,36,116
buffer_load_dwordx4 v[104:107], v4, s[16:19], s52 offen sc1
MAV 84,52,124
TR 16,7,42240
MAV 68,52,120
TR 18,7,42752
TR 20,7,42272
MAV 68,36,112
TR 22,7,42784
s_waitcnt lgkmcnt(8)
MAV 72,40,112
buffer_load_dwordx4 v19, s[28:31], s54 offen offset:1056 lds
MAV 72,56,120
s_add_u32 s54, s99, 2359296
MAV 88,56,124
TR 8,7,33856
TR 10,7,34368
MAV 88,40,116
TR 12,7,33888
TR 14,7,34400
MAV 92,44,116
buffer_load_dwordx4 v[108:111], v4, s[16:19], s52 offen offset:1024 sc1
MAV 92,60,124
TR 24,7,42304
MAV 76,60,120
TR 26,7,42816
TR 28,7,42336
MAV 76,44,112
TR 30,7,42848
s_waitcnt vmcnt(16) lgkmcnt(8)
s_barrier
MAV 32,0,128
TR 32,6,33792
s_add_u32 m0, s55, 84480
MAV 32,16,136
buffer_load_dwordx4 v18, s[28:31], s54 offen lds
MAV 48,16,140
TR 34,6,34304
TR 36,6,33824
MAV 48,0,132
TR 38,6,34336
s_add_u32 s52, s77, 131072
MAV 52,4,132
buffer_load_dwordx4 v[112:115], v4, s[16:19], s52 offen sc1
MAV 52,20,140
TR 48,6,42240
MAV 36,20,136
TR 50,6,42752
TR 52,6,42272
MAV 36,4,128
TR 54,6,42784
s_waitcnt lgkmcnt(8)
MAV 40,8,128
buffer_load_dwordx4 v19, s[28:31], s54 offen offset:1056 lds
MAV 40,24,136
s_add_u32 s54, s99, 2621440
MAV 56,24,140
TR 40,6,33856
TR 42,6,34368
MAV 56,8,132
TR 44,6,33888
TR 46,6,34400
MAV 60,12,132
buffer_load_dwordx4 v[116:119], v4, s[16:19], s52 offen offset:1024 sc1
MAV 60,28,140
TR 56,6,42304
MAV 44,28,136
TR 58,6,42816
TR 60,6,42336
MAV 44,12,128
TR 62,6,42848
s_waitcnt lgkmcnt(8)
MAV 64,32,128
TR 0,7,50688
s_add_u32 m0, s55, 92928
MAV 64,48,136
buffer_load_dwordx4 v18, s[28:31], s54 offen lds
MAV 80,48,140
TR 2,7,51200
TR 4,7,50720
MAV 80,32,132
TR 6,7,51232
s_add_u32 s52, s77, 196608
MAV 84,36,132
buffer_load_dwordx4 v[120:123], v4, s[16:19], s52 offen sc1
MAV 84,52,140
TR 16,7,59136
MAV 68,52,136
TR 18,7,59648
TR 20,7,59168
MAV 68,36,128
TR 22,7,59680
s_waitcnt lgkmcnt(8)
MAV 72,40,128
buffer_load_dwordx4 v19, s[28:31], s54 offen offset:1056 lds
MAV 72,56,136
s_add_u32 s54, s100, 2818048
MAV 88,56,140
TR 8,7,50752
TR 10,7,51264
MAV 88,40,132
TR 12,7,50784
TR 14,7,51296
MAV 92,44,132
buffer_load_dwordx4 v[124:127], v4, s[16:19], s52 offen offset:1024 sc1
MAV 92,60,140
TR 24,7,59200
MAV 76,60,136
TR 26,7,59712
TR 28,7,59232
MAV 76,44,128
TR 30,7,59744
s_waitcnt vmcnt(16) lgkmcnt(8)
s_barrier
MAV 32,0,144
TR 32,6,50688
s_add_u32 m0, s55, 101376
MAV 32,16,152
buffer_load_dwordx4 v18, s[28:31], s54 offen lds
MAV 48,16,156
TR 34,6,51200
TR 36,6,50720
MAV 48,0,148
TR 38,6,51232
s_add_u32 s52, s78, 245760
MAV 52,4,148
buffer_load_dwordx4 v[128:131], v4, s[16:19], s52 offen sc1
MAV 52,20,156
TR 48,6,59136
MAV 36,20,152
TR 50,6,59648
TR 52,6,59168
MAV 36,4,144
TR 54,6,59680
s_waitcnt lgkmcnt(8)
MAV 40,8,144
buffer_load_dwordx4 v19, s[28:31], s54 offen offset:1056 lds
MAV 40,24,152
s_add_u32 s54, s100, 3080192
MAV 56,24,156
TR 40,6,50752
TR 42,6,51264
MAV 56,8,148
TR 44,6,50784
TR 46,6,51296
MAV 60,12,148
buffer_load_dwordx4 v[132:135], v4, s[16:19], s52 offen offset:1024 sc1
MAV 60,28,156
TR 56,6,59200
MAV 44,28,152
TR 58,6,59712
TR 60,6,59232
MAV 44,12,144
TR 62,6,59744
v_add_u32 v7, s57, v7
v_add_u32 v6, s57, v6
s_sub_u32 s57, 0, s57
s_waitcnt lgkmcnt(8)
MAV 64,32,144
ds_read_b64_tr_b16 a[0:1], v7
s_add_u32 m0, s55, 109824
MAV 64,48,152
buffer_load_dwordx4 v18, s[28:31], s54 offen lds
MAV 80,48,156
TR 2,7,512
TR 4,7,32
MAV 80,32,148
TR 6,7,544
s_add_u32 s52, s78, 311296
MAV 84,36,148
buffer_load_dwordx4 v[136:139], v4, s[16:19], s52 offen sc1
MAV 84,52,156
TR 16,7,8448
MAV 68,52,152
TR 18,7,8960
TR 20,7,8480
MAV 68,36,144
TR 22,7,8992
s_waitcnt lgkmcnt(8)
MAV 72,40,144
buffer_load_dwordx4 v19, s[28:31], s54 offen offset:1056 lds
MAV 72,56,152
s_add_u32 s54, s101, 3276800
MAV 88,56,156
TR 8,7,64
TR 10,7,576
MAV 88,40,148
TR 12,7,96
TR 14,7,608
MAV 92,44,148
buffer_load_dwordx4 v[140:143], v4, s[16:19], s52 offen offset:1024 sc1
MAV 92,60,156
TR 24,7,8512
MAV 76,60,152
TR 26,7,9024
TR 28,7,8544
MAV 76,44,144
TR 30,7,9056
s_waitcnt vmcnt(16) lgkmcnt(8)
s_barrier
MAV 32,0,96
ds_read_b64_tr_b16 a[32:33], v6
s_add_u32 m0, s55, 118272
MAV 32,16,104
buffer_load_dwordx4 v18, s[28:31], s54 offen lds
MAV 48,16,108
TR 34,6,512
TR 36,6,32
MAV 48,0,100
TR 38,6,544
s_add_u32 s52, s79, 360448
MAV 52,4,100
buffer_load_dwordx4 v[144:147], v4, s[16:19], s52 offen sc1
MAV 52,20,108
TR 48,6,8448
MAV 36,20,104
TR 50,6,8960
TR 52,6,8480
MAV 36,4,96
TR 54,6,8992
s_waitcnt lgkmcnt(8)
MAV 40,8,96
buffer_load_dwordx4 v19, s[28:31], s54 offen offset:1056 lds
MAV 40,24,104
s_add_u32 s54, s101, 3538944
MAV 56,24,108
TR 40,6,64
TR 42,6,576
MAV 56,8,100
TR 44,6,96
TR 46,6,608
MAV 60,12,100
buffer_load_dwordx4 v[148:151], v4, s[16:19], s52 offen offset:1024 sc1
MAV 60,28,108
TR 56,6,8512
MAV 44,28,104
TR 58,6,9024
TR 60,6,8544
MAV 44,12,96
TR 62,6,9056
s_waitcnt lgkmcnt(8)
MAV 64,32,96
TR 0,7,16896
s_add_u32 m0, s55, 126720
MAV 64,48,104
buffer_load_dwordx4 v18, s[28:31], s54 offen lds
MAV 80,48,108
TR 2,7,17408
TR 4,7,16928
MAV 80,32,100
TR 6,7,17440
s_add_u32 s52, s79, 425984
MAV 84,36,100
buffer_load_dwordx4 v[152:155], v4, s[16:19], s52 offen sc1
MAV 84,52,108
TR 16,7,25344
MAV 68,52,104
TR 18,7,25856
TR 20,7,25376
MAV 68,36,96
TR 22,7,25888
s_waitcnt lgkmcnt(8)
MAV 72,40,96
buffer_load_dwordx4 v19, s[28:31], s54 offen offset:1056 lds
MAV 72,56,104
s_add_u32 s54, s98, 131072
MAV 88,56,108
TR 8,7,16960
TR 10,7,17472
MAV 88,40,100
TR 12,7,16992
TR 14,7,17504
MAV 92,44,100
buffer_load_dwordx4 v[156:159], v4, s[16:19], s52 offen offset:1024 sc1
MAV 92,60,108
TR 24,7,25408
MAV 76,60,104
TR 26,7,25920
TR 28,7,25440
MAV 76,44,96
TR 30,7,25952
s_waitcnt vmcnt(16) lgkmcnt(8)
s_barrier
MAV 32,0,112
TR 32,6,16896
s_add_u32 m0, s55, 0
MAV 32,16,120
buffer_load_dwordx4 v18, s[28:31], s54 offen lds
MAV 48,16,124
TR 34,6,17408
TR 36,6,16928
MAV 48,0,116
TR 38,6,17440
s_add_u32 s52, s76, 475136
MAV 52,4,116
buffer_load_dwordx4 v[96:99], v4, s[16:19], s52 offen sc1
MAV 52,20,124
TR 48,6,25344
MAV 36,20,120
TR 50,6,25856
TR 52,6,25376
MAV 36,4,112
TR 54,6,25888
s_waitcnt lgkmcnt(8)
MAV 40,8,112
buffer_load_dwordx4 v19, s[28:31], s54 offen offset:1056 lds
MAV 40,24,120
s_add_u32 s54, s98, 393216
MAV 56,24,124
TR 40,6,16960
TR 42,6,17472
MAV 56,8,116
TR 44,6,16992
TR 46,6,17504
MAV 60,12,116
buffer_load_dwordx4 v[100:103], v4, s[16:19], s52 offen offset:1024 sc1
MAV 60,28,124
TR 56,6,25408
MAV 44,28,120
TR 58,6,25920
TR 60,6,25440
MAV 44,12,112
TR 62,6,25952
s_waitcnt lgkmcnt(8)
MAV 64,32,112
TR 0,7,33792
s_add_u32 m0, s55, 8448
.Lpad28:
s_cbranch_execz .Lpad31
MAV 64,48,120
buffer_load_dwordx4 v18, s[28:31], s54 offen lds
MAV 80,48,124
TR 2,7,34304
TR 4,7,33824
MAV 80,32,116
TR 6,7,34336
s_add_u32 s52, s76, 540672
MAV 84,36,116
buffer_load_dwordx4 v[104:107], v4, s[16:19], s52 offen sc1
MAV 84,52,124
TR 16,7,42240
MAV 68,52,120
TR 18,7,42752
TR 20,7,42272
MAV 68,36,112
TR 22,7,42784
s_waitcnt lgkmcnt(8)
MAV 72,40,112
buffer_load_dwordx4 v19, s[28:31], s54 offen offset:1056 lds
MAV 72,56,120
s_add_u32 s54, s99, 589824
MAV 88,56,124
TR 8,7,33856
TR 10,7,34368
MAV 88,40,116
TR 12,7,33888
TR 14,7,34400
MAV 92,44,116
buffer_load_dwordx4 v[108:111], v4, s[16:19], s52 offen offset:1024 sc1
MAV 92,60,124
TR 24,7,42304
MAV 76,60,120
TR 26,7,42816
TR 28,7,42336
MAV 76,44,112
TR 30,7,42848
s_waitcnt vmcnt(16) lgkmcnt(8)
s_barrier
MAV 32,0,128
TR 32,6,33792
s_add_u32 m0, s55, 16896
MAV 32,16,136
buffer_load_dwordx4 v18, s[28:31], s54 offen lds
MAV 48,16,140
TR 34,6,34304
TR 36,6,33824
MAV 48,0,132
TR 38,6,34336
s_add_u32 s52, s77, 589824
MAV 52,4,132
buffer_load_dwordx4 v[112:115], v4, s[16:19], s52 offen sc1
MAV 52,20,140
TR 48,6,42240
MAV 36,20,136
TR 50,6,42752
TR 52,6,42272
MAV 36,4,128
TR 54,6,42784
s_waitcnt lgkmcnt(8)
MAV 40,8,128
buffer_load_dwordx4 v19, s[28:31], s54 offen offset:1056 lds
MAV 40,24,136
s_add_u32 s54, s99, 851968
MAV 56,24,140
TR 40,6,33856
TR 42,6,34368
MAV 56,8,132
TR 44,6,33888
TR 46,6,34400
MAV 60,12,132
buffer_load_dwordx4 v[116:119], v4, s[16:19], s52 offen offset:1024 sc1
MAV 60,28,140
TR 56,6,42304
MAV 44,28,136
TR 58,6,42816
TR 60,6,42336
MAV 44,12,128
TR 62,6,42848
s_waitcnt lgkmcnt(8)
MAV 64,32,128
TR 0,7,50688
s_add_u32 m0, s55, 25344
MAV 64,48,136
buffer_load_dwordx4 v18, s[28:31], s54 offen lds
MAV 80,48,140
TR 2,7,51200
TR 4,7,50720
MAV 80,32,132
TR 6,7,51232
s_add_u32 s52, s77, 655360
MAV 84,36,132
buffer_load_dwordx4 v[120:123], v4, s[16:19], s52 offen sc1
MAV 84,52,140
TR 16,7,59136
MAV 68,52,136
TR 18,7,59648
TR 20,7,59168
MAV 68,36,128
TR 22,7,59680
s_waitcnt lgkmcnt(8)
MAV 72,40,128
buffer_load_dwordx4 v19, s[28:31], s54 offen offset:1056 lds
MAV 72,56,136
s_add_u32 s54, s100, 1048576
MAV 88,56,140
TR 8,7,50752
TR 10,7,51264
MAV 88,40,132
TR 12,7,50784
TR 14,7,51296
MAV 92,44,132
buffer_load_dwordx4 v[124:127], v4, s[16:19], s52 offen offset:1024 sc1
MAV 92,60,140
TR 24,7,59200
MAV 76,60,136
TR 26,7,59712
TR 28,7,59232
MAV 76,44,128
TR 30,7,59744
s_waitcnt vmcnt(16) lgkmcnt(8)
s_barrier
MAV 32,0,144
TR 32,6,50688
s_add_u32 m0, s55, 33792
MAV 32,16,152
buffer_load_dwordx4 v18, s[28:31], s54 offen lds
MAV 48,16,156
TR 34,6,51200
TR 36,6,50720
MAV 48,0,148
TR 38,6,51232
s_add_u32 s52, s78, 704512
MAV 52,4,148
buffer_load_dwordx4 v[128:131], v4, s[16:19], s52 offen sc1
MAV 52,20,156
TR 48,6,59136
MAV 36,20,152
TR 50,6,59648
TR 52,6,59168
MAV 36,4,144
TR 54,6,59680
s_waitcnt lgkmcnt(8)
MAV 40,8,144
buffer_load_dwordx4 v19, s[28:31], s54 offen offset:1056 lds
MAV 40,24,152
s_add_u32 s54, s100, 1310720
MAV 56,24,156
TR 40,6,50752
TR 42,6,51264
MAV 56,8,148
TR 44,6,50784
TR 46,6,51296
MAV 60,12,148
buffer_load_dwordx4 v[132:135], v4, s[16:19], s52 offen offset:1024 sc1
MAV 60,28,156
TR 56,6,59200
MAV 44,28,152
TR 58,6,59712
TR 60,6,59232
MAV 44,12,144
TR 62,6,59744
v_add_u32 v7, s57, v7
v_add_u32 v6, s57, v6
s_sub_u32 s57, 0, s57
s_waitcnt lgkmcnt(8)
MAV 64,32,144
ds_read_b64_tr_b16 a[0:1], v7
s_add_u32 m0, s55, 42240
MAV 64,48,152
buffer_load_dwordx4 v18, s[28:31], s54 offen lds
MAV 80,48,156
TR 2,7,512
TR 4,7,32
MAV 80,32,148
TR 6,7,544
s_add_u32 s52, s78, 770048
MAV 84,36,148
buffer_load_dwordx4 v[136:139], v4, s[16:19], s52 offen sc1
MAV 84,52,156
TR 16,7,8448
MAV 68,52,152
TR 18,7,8960
TR 20,7,8480
MAV 68,36,144
TR 22,7,8992
s_waitcnt lgkmcnt(8)
MAV 72,40,144
buffer_load_dwordx4 v19, s[28:31], s54 offen offset:1056 lds
MAV 72,56,152
s_add_u32 s54, s101, 1507328
MAV 88,56,156
TR 8,7,64
TR 10,7,576
MAV 88,40,148
TR 12,7,96
TR 14,7,608
MAV 92,44,148
buffer_load_dwordx4 v[140:143], v4, s[16:19], s52 offen offset:1024 sc1
MAV 92,60,156
TR 24,7,8512
MAV 76,60,152
TR 26,7,9024
TR 28,7,8544
MAV 76,44,144
TR 30,7,9056
s_waitcnt vmcnt(16) lgkmcnt(8)
s_barrier
MAV 32,0,96
ds_read_b64_tr_b16 a[32:33], v6
s_add_u32 m0, s55, 50688
MAV 32,16,104
buffer_load_dwordx4 v18, s[28:31], s54 offen lds
MAV 48,16,108
TR 34,6,512
TR 36,6,32
MAV 48,0,100
TR 38,6,544
s_add_u32 s52, s79, 819200
MAV 52,4,100
buffer_load_dwordx4 v[144:147], v4, s[16:19], s52 offen sc1
MAV 52,20,108
TR 48,6,8448
MAV 36,20,104
TR 50,6,8960
TR 52,6,8480
MAV 36,4,96
TR 54,6,8992
s_waitcnt lgkmcnt(8)
MAV 40,8,96
buffer_load_dwordx4 v19, s[28:31], s54 offen offset:1056 lds
MAV 40,24,104
s_add_u32 s54, s101, 1769472
MAV 56,24,108
TR 40,6,64
TR 42,6,576
MAV 56,8,100
TR 44,6,96
TR 46,6,608
MAV 60,12,100
buffer_load_dwordx4 v[148:151], v4, s[16:19], s52 offen offset:1024 sc1
MAV 60,28,108
TR 56,6,8512
MAV 44,28,104
TR 58,6,9024
TR 60,6,8544
MAV 44,12,96
TR 62,6,9056
s_waitcnt lgkmcnt(8)
MAV 64,32,96
TR 0,7,16896
s_add_u32 m0, s55, 59136
MAV 64,48,104
buffer_load_dwordx4 v18, s[28:31], s54 offen lds
MAV 80,48,108
TR 2,7,17408
TR 4,7,16928
MAV 80,32,100
TR 6,7,17440
s_add_u32 s52, s79, 884736
MAV 84,36,100
buffer_load_dwordx4 v[152:155], v4, s[16:19], s52 offen sc1
MAV 84,52,108
TR 16,7,25344
MAV 68,52,104
TR 18,7,25856
TR 20,7,25376
MAV 68,36,96
TR 22,7,25888
s_waitcnt lgkmcnt(8)
MAV 72,40,96
buffer_load_dwordx4 v19, s[28:31], s54 offen offset:1056 lds
MAV 72,56,104
s_add_u32 s54, s98, 1966080
MAV 88,56,108
TR 8,7,16960
TR 10,7,17472
MAV 88,40,100
TR 12,7,16992
TR 14,7,17504
MAV 92,44,100
buffer_load_dwordx4 v[156:159], v4, s[16:19], s52 offen offset:1024 sc1
MAV 92,60,108
TR 24,7,25408
MAV 76,60,104
TR 26,7,25920
TR 28,7,25440
MAV 76,44,96
TR 30,7,25952
s_waitcnt vmcnt(16) lgkmcnt(8)
s_barrier
MAV 32,0,112
TR 32,6,16896
s_add_u32 m0, s55, 67584
MAV 32,16,120
buffer_load_dwordx4 v18, s[28:31], s54 offen lds
MAV 48,16,124
TR 34,6,17408
TR 36,6,16928
MAV 48,0,116
TR 38,6,17440
s_add_u32 s52, s76, 32768
MAV 52,4,116
buffer_load_dwordx4 v[96:99], v4, s[16:19], s52 offen sc1
MAV 52,20,124
TR 48,6,25344
MAV 36,20,120
TR 50,6,25856
TR 52,6,25376
MAV 36,4,112
TR 54,6,25888
s_waitcnt lgkmcnt(8)
MAV 40,8,112
buffer_load_dwordx4 v19, s[28:31], s54 offen offset:1056 lds
MAV 40,24,120
s_add_u32 s54, s98, 2228224
MAV 56,24,124
TR 40,6,16960
TR 42,6,17472
MAV 56,8,116
TR 44,6,16992
TR 46,6,17504
MAV 60,12,116
buffer_load_dwordx4 v[100:103], v4, s[16:19], s52 offen offset:1024 sc1
MAV 60,28,124
TR 56,6,25408
MAV 44,28,120
TR 58,6,25920
TR 60,6,25440
MAV 44,12,112
TR 62,6,25952
s_waitcnt lgkmcnt(8)
MAV 64,32,112
TR 0,7,33792
s_add_u32 m0, s55, 76032
MAV 64,48,120
buffer_load_dwordx4 v18, s[28:31], s54 offen lds
MAV 80,48,124
TR 2,7,34304
TR 4,7,33824
MAV 80,32,116
TR 6,7,34336
s_add_u32 s52, s76, 98304
MAV 84,36,116
buffer_load_dwordx4 v[104:107], v4, s[16:19], s52 offen sc1
MAV 84,52,124
TR 16,7,42240
MAV 68,52,120
TR 18,7,42752
TR 20,7,42272
MAV 68,36,112
TR 22,7,42784
s_waitcnt lgkmcnt(8)
MAV 72,40,112
buffer_load_dwordx4 v19, s[28:31], s54 offen offset:1056 lds
MAV 72,56,120
s_add_u32 s54, s99, 2424832
MAV 88,56,124
TR 8,7,33856
TR 10,7,34368
MAV 88,40,116
TR 12,7,33888
TR 14,7,34400
MAV 92,44,116
buffer_load_dwordx4 v[108:111], v4, s[16:19], s52 offen offset:1024 sc1
MAV 92,60,124
TR 24,7,42304
MAV 76,60,120
TR 26,7,42816
TR 28,7,42336
MAV 76,44,112
TR 30,7,42848
s_waitcnt vmcnt(16) lgkmcnt(8)
s_barrier
MAV 32,0,128
TR 32,6,33792
s_add_u32 m0, s55, 84480
MAV 32,16,136
buffer_load_dwordx4 v18, s[28:31], s54 offen lds
MAV 48,16,140
TR 34,6,34304
TR 36,6,33824
MAV 48,0,132
TR 38,6,34336
s_add_u32 s52, s77, 147456
MAV 52,4,132
buffer_load_dwordx4 v[112:115], v4, s[16:19], s52 offen sc1
MAV 52,20,140
TR 48,6,42240
MAV 36,20,136
TR 50,6,42752
TR 52,6,42272
MAV 36,4,128
TR 54,6,42784
s_waitcnt lgkmcnt(8)
MAV 40,8,128
buffer_load_dwordx4 v19, s[28:31], s54 offen offset:1056 lds
MAV 40,24,136
s_add_u32 s54, s99, 2686976
MAV 56,24,140
TR 40,6,33856
TR 42,6,34368
MAV 56,8,132
TR 44,6,33888
TR 46,6,34400
MAV 60,12,132
buffer_load_dwordx4 v[116:119], v4, s[16:19], s52 offen offset:1024 sc1
MAV 60,28,140
TR 56,6,42304
MAV 44,28,136
TR 58,6,42816
TR 60,6,42336
MAV 44,12,128
TR 62,6,42848
s_waitcnt lgkmcnt(8)
MAV 64,32,128
TR 0,7,50688
s_add_u32 m0, s55, 92928
MAV 64,48,136
buffer_load_dwordx4 v18, s[28:31], s54 offen lds
MAV 80,48,140
TR 2,7,51200
TR 4,7,50720
MAV 80,32,132
TR 6,7,51232
s_add_u32 s52, s77, 212992
MAV 84,36,132
buffer_load_dwordx4 v[120:123], v4, s[16:19], s52 offen sc1
MAV 84,52,140
TR 16,7,59136
MAV 68,52,136
TR 18,7,59648
TR 20,7,59168
MAV 68,36,128
TR 22,7,59680
s_waitcnt lgkmcnt(8)
MAV 72,40,128
buffer_load_dwordx4 v19, s[28:31], s54 offen offset:1056 lds
MAV 72,56,136
s_add_u32 s54, s100, 2883584
MAV 88,56,140
TR 8,7,50752
TR 10,7,51264
MAV 88,40,132
TR 12,7,50784
TR 14,7,51296
MAV 92,44,132
buffer_load_dwordx4 v[124:127], v4, s[16:19], s52 offen offset:1024 sc1
MAV 92,60,140
TR 24,7,59200
MAV 76,60,136
TR 26,7,59712
TR 28,7,59232
MAV 76,44,128
TR 30,7,59744
s_waitcnt vmcnt(16) lgkmcnt(8)
s_barrier
MAV 32,0,144
TR 32,6,50688
s_add_u32 m0, s55, 101376
MAV 32,16,152
buffer_load_dwordx4 v18, s[28:31], s54 offen lds
MAV 48,16,156
TR 34,6,51200
TR 36,6,50720
MAV 48,0,148
TR 38,6,51232
s_add_u32 s52, s78, 262144
MAV 52,4,148
buffer_load_dwordx4 v[128:131], v4, s[16:19], s52 offen sc1
MAV 52,20,156
TR 48,6,59136
MAV 36,20,152
TR 50,6,59648
TR 52,6,59168
MAV 36,4,144
TR 54,6,59680
s_waitcnt lgkmcnt(8)
MAV 40,8,144
buffer_load_dwordx4 v19, s[28:31], s54 offen offset:1056 lds
MAV 40,24,152
s_add_u32 s54, s100, 3145728
MAV 56,24,156
TR 40,6,50752
TR 42,6,51264
MAV 56,8,148
TR 44,6,50784
TR 46,6,51296
MAV 60,12,148
buffer_load_dwordx4 v[132:135], v4, s[16:19], s52 offen offset:1024 sc1
MAV 60,28,156
TR 56,6,59200
MAV 44,28,152
TR 58,6,59712
TR 60,6,59232
MAV 44,12,144
TR 62,6,59744
v_add_u32 v7, s57, v7
v_add_u32 v6, s57, v6
s_sub_u32 s57, 0, s57
s_waitcnt lgkmcnt(8)
MAV 64,32,144
ds_read_b64_tr_b16 a[0:1], v7
s_add_u32 m0, s55, 109824
MAV 64,48,152
buffer_load_dwordx4 v18, s[28:31], s54 offen lds
MAV 80,48,156
TR 2,7,512
TR 4,7,32
MAV 80,32,148
TR 6,7,544
s_add_u32 s52, s78, 327680
MAV 84,36,148
buffer_load_dwordx4 v[136:139], v4, s[16:19], s52 offen sc1
MAV 84,52,156
TR 16,7,8448
MAV 68,52,152
TR 18,7,8960
TR 20,7,8480
MAV 68,36,144
TR 22,7,8992
s_waitcnt lgkmcnt(8)
MAV 72,40,144
buffer_load_dwordx4 v19, s[28:31], s54 offen offset:1056 lds
MAV 72,56,152
s_add_u32 s54, s101, 3342336
MAV 88,56,156
TR 8,7,64
TR 10,7,576
MAV 88,40,148
.Lpad29:
s_cbranch_execz .Lnopoll63r
TR 12,7,96
TR 14,7,608
MAV 92,44,148
buffer_load_dwordx4 v[140:143], v4, s[16:19], s52 offen offset:1024 sc1
MAV 92,60,156
TR 24,7,8512
MAV 76,60,152
TR 26,7,9024
TR 28,7,8544
MAV 76,44,144
TR 30,7,9056
s_waitcnt vmcnt(16) lgkmcnt(8)
s_barrier
MAV 32,0,96
ds_read_b64_tr_b16 a[32:33], v6
s_add_u32 m0, s55, 118272
MAV 32,16,104
buffer_load_dwordx4 v18, s[28:31], s54 offen lds
MAV 48,16,108
TR 34,6,512
TR 36,6,32
MAV 48,0,100
TR 38,6,544
s_add_u32 s52, s79, 376832
MAV 52,4,100
buffer_load_dwordx4 v[144:147], v4, s[16:19], s52 offen sc1
MAV 52,20,108
TR 48,6,8448
MAV 36,20,104
TR 50,6,8960
TR 52,6,8480
MAV 36,4,96
TR 54,6,8992
s_waitcnt lgkmcnt(8)
MAV 40,8,96
buffer_load_dwordx4 v19, s[28:31], s54 offen offset:1056 lds
MAV 40,24,104
s_add_u32 s54, s101, 3604480
MAV 56,24,108
TR 40,6,64
TR 42,6,576
MAV 56,8,100
TR 44,6,96
TR 46,6,608
MAV 60,12,100
buffer_load_dwordx4 v[148:151], v4, s[16:19], s52 offen offset:1024 sc1
MAV 60,28,108
TR 56,6,8512
MAV 44,28,104
TR 58,6,9024
TR 60,6,8544
MAV 44,12,96
TR 62,6,9056
s_waitcnt lgkmcnt(8)
MAV 64,32,96
TR 0,7,16896
s_add_u32 m0, s55, 126720
MAV 64,48,104
buffer_load_dwordx4 v18, s[28:31], s54 offen lds
MAV 80,48,108
TR 2,7,17408
TR 4,7,16928
MAV 80,32,100
TR 6,7,17440
s_add_u32 s52, s79, 442368
MAV 84,36,100
buffer_load_dwordx4 v[152:155], v4, s[16:19], s52 offen sc1
MAV 84,52,108
TR 16,7,25344
MAV 68,52,104
TR 18,7,25856
TR 20,7,25376
MAV 68,36,96
TR 22,7,25888
s_waitcnt lgkmcnt(8)
MAV 72,40,96
buffer_load_dwordx4 v19, s[28:31], s54 offen offset:1056 lds
MAV 72,56,104
s_add_u32 s54, s98, 196608
MAV 88,56,108
TR 8,7,16960
TR 10,7,17472
MAV 88,40,100
TR 12,7,16992
TR 14,7,17504
MAV 92,44,100
buffer_load_dwordx4 v[156:159], v4, s[16:19], s52 offen offset:1024 sc1
MAV 92,60,108
TR 24,7,25408
MAV 76,60,104
TR 26,7,25920
TR 28,7,25440
MAV 76,44,96
TR 30,7,25952
s_waitcnt vmcnt(16) lgkmcnt(8)
s_barrier
MAV 32,0,112
TR 32,6,16896
s_add_u32 m0, s55, 0
MAV 32,16,120
buffer_load_dwordx4 v18, s[28:31], s54 offen lds
MAV 48,16,124
TR 34,6,17408
TR 36,6,16928
MAV 48,0,116
TR 38,6,17440
s_add_u32 s52, s76, 491520
MAV 52,4,116
buffer_load_dwordx4 v[96:99], v4, s[16:19], s52 offen sc1
MAV 52,20,124
TR 48,6,25344
MAV 36,20,120
TR 50,6,25856
TR 52,6,25376
MAV 36,4,112
TR 54,6,25888
s_waitcnt lgkmcnt(8)
MAV 40,8,112
buffer_load_dwordx4 v19, s[28:31], s54 offen offset:1056 lds
MAV 40,24,120
s_add_u32 s54, s99, 655360
MAV 56,24,124
TR 40,6,16960
TR 42,6,17472
MAV 56,8,116
TR 44,6,16992
TR 46,6,17504
MAV 60,12,116
buffer_load_dwordx4 v[100:103], v4, s[16:19], s52 offen offset:1024 sc1
MAV 60,28,124
TR 56,6,25408
MAV 44,28,120
TR 58,6,25920
TR 60,6,25440
MAV 44,12,112
TR 62,6,25952
s_waitcnt lgkmcnt(8)
MAV 64,32,112
TR 0,7,33792
s_add_u32 m0, s55, 8448
MAV 64,48,120
buffer_load_dwordx4 v18, s[28:31], s54 offen lds
MAV 80,48,124
TR 2,7,34304
TR 4,7,33824
MAV 80,32,116
TR 6,7,34336
s_add_u32 s52, s76, 557056
MAV 84,36,116
buffer_load_dwordx4 v[104:107], v4, s[16:19], s52 offen sc1
MAV 84,52,124
TR 16,7,42240
MAV 68,52,120
TR 18,7,42752
TR 20,7,42272
MAV 68,36,112
TR 22,7,42784
s_waitcnt lgkmcnt(8)
MAV 72,40,112
buffer_load_dwordx4 v19, s[28:31], s54 offen offset:1056 lds
MAV 72,56,120
s_add_u32 s54, s100, 1114112
MAV 88,56,124
TR 8,7,33856
TR 10,7,34368
MAV 88,40,116
TR 12,7,33888
TR 14,7,34400
MAV 92,44,116
buffer_load_dwordx4 v[108:111], v4, s[16:19], s52 offen offset:1024 sc1
MAV 92,60,124
TR 24,7,42304
MAV 76,60,120
TR 26,7,42816
TR 28,7,42336
MAV 76,44,112
TR 30,7,42848
s_waitcnt vmcnt(16) lgkmcnt(8)
s_barrier
MAV 32,0,128
TR 32,6,33792
s_add_u32 m0, s55, 16896
MAV 32,16,136
buffer_load_dwordx4 v18, s[28:31], s54 offen lds
MAV 48,16,140
TR 34,6,34304
TR 36,6,33824
MAV 48,0,132
TR 38,6,34336
s_add_u32 s52, s77, 606208
MAV 52,4,132
buffer_load_dwordx4 v[112:115], v4, s[16:19], s52 offen sc1
MAV 52,20,140
TR 48,6,42240
MAV 36,20,136
TR 50,6,42752
TR 52,6,42272
MAV 36,4,128
TR 54,6,42784
s_waitcnt lgkmcnt(8)
MAV 40,8,128
buffer_load_dwordx4 v19, s[28:31], s54 offen offset:1056 lds
MAV 40,24,136
s_add_u32 s54, s101, 1572864
MAV 56,24,140
TR 40,6,33856
TR 42,6,34368
MAV 56,8,132
TR 44,6,33888
TR 46,6,34400
MAV 60,12,132
buffer_load_dwordx4 v[116:119], v4, s[16:19], s52 offen offset:1024 sc1
MAV 60,28,140
TR 56,6,42304
MAV 44,28,136
TR 58,6,42816
TR 60,6,42336
MAV 44,12,128
TR 62,6,42848
s_waitcnt lgkmcnt(8)
MAV 64,32,128
TR 0,7,50688
s_add_u32 m0, s55, 25344
MAV 64,48,136
buffer_load_dwordx4 v18, s[28:31], s54 offen lds
MAV 80,48,140
TR 2,7,51200
TR 4,7,50720
MAV 80,32,132
TR 6,7,51232
s_add_u32 s52, s77, 671744
MAV 84,36,132
buffer_load_dwordx4 v[120:123], v4, s[16:19], s52 offen sc1
MAV 84,52,140
TR 16,7,59136
MAV 68,52,136
TR 18,7,59648
TR 20,7,59168
MAV 68,36,128
TR 22,7,59680
s_waitcnt lgkmcnt(8)
MAV 72,40,128
buffer_load_dwordx4 v19, s[28:31], s54 offen offset:1056 lds
MAV 72,56,136
s_add_u32 s54, s98, 2031616
MAV 88,56,140
TR 8,7,50752
TR 10,7,51264
MAV 88,40,132
TR 12,7,50784
TR 14,7,51296
MAV 92,44,132
buffer_load_dwordx4 v[124:127], v4, s[16:19], s52 offen offset:1024 sc1
MAV 92,60,140
TR 24,7,59200
MAV 76,60,136
TR 26,7,59712
TR 28,7,59232
MAV 76,44,128
TR 30,7,59744
s_waitcnt vmcnt(16) lgkmcnt(8)
s_barrier
MAV 32,0,144
TR 32,6,50688
s_add_u32 m0, s55, 33792
MAV 32,16,152
buffer_load_dwordx4 v18, s[28:31], s54 offen lds
MAV 48,16,156
TR 34,6,51200
TR 36,6,50720
MAV 48,0,148
TR 38,6,51232
s_add_u32 s52, s78, 720896
MAV 52,4,148
buffer_load_dwordx4 v[128:131], v4, s[16:19], s52 offen sc1
MAV 52,20,156
TR 48,6,59136
MAV 36,20,152
TR 50,6,59648
TR 52,6,59168
MAV 36,4,144
TR 54,6,59680
s_waitcnt lgkmcnt(8)
MAV 40,8,144
buffer_load_dwordx4 v19, s[28:31], s54 offen offset:1056 lds
MAV 40,24,152
s_add_u32 s54, s99, 2490368
MAV 56,24,156
TR 40,6,50752
TR 42,6,51264
MAV 56,8,148
TR 44,6,50784
TR 46,6,51296
MAV 60,12,148
buffer_load_dwordx4 v[132:135], v4, s[16:19], s52 offen offset:1024 sc1
MAV 60,28,156
TR 56,6,59200
MAV 44,28,152
TR 58,6,59712
TR 60,6,59232
MAV 44,12,144
TR 62,6,59744
v_add_u32 v7, s57, v7
v_add_u32 v6, s57, v6
s_sub_u32 s57, 0, s57
s_waitcnt lgkmcnt(8)
MAV 64,32,144
ds_read_b64_tr_b16 a[0:1], v6
s_add_u32 m0, s55, 42240
MAV 64,48,152
buffer_load_dwordx4 v18, s[28:31], s54 offen lds
MAV 80,48,156
TR 2,6,512
TR 4,6,32
MAV 80,32,148
TR 6,6,544
s_add_u32 s52, s78, 786432
MAV 84,36,148
buffer_load_dwordx4 v[136:139], v4, s[16:19], s52 offen sc1
MAV 84,52,156
TR 16,6,8448
MAV 68,52,152
TR 18,6,8960
TR 20,6,8480
MAV 68,36,144
TR 22,6,8992
s_waitcnt lgkmcnt(8)
MAV 72,40,144
buffer_load_dwordx4 v19, s[28:31], s54 offen offset:1056 lds
MAV 72,56,152
s_add_u32 s54, s100, 2949120
MAV 88,56,156
TR 8,6,64
TR 10,6,576
MAV 88,40,148
TR 12,6,96
TR 14,6,608
MAV 92,44,148
buffer_load_dwordx4 v[140:143], v4, s[16:19], s52 offen offset:1024 sc1
MAV 92,60,156
TR 24,6,8512
MAV 76,60,152
TR 26,6,9024
TR 28,6,8544
MAV 76,44,144
TR 30,6,9056
s_waitcnt vmcnt(16) lgkmcnt(8)
s_barrier
MAV 64,0,96
TR 32,6,16896
TR 34,6,17408
s_add_u32 m0, s55, 50688
MAV 64,16,104
TR 36,6,16928
buffer_load_dwordx4 v18, s[28:31], s54 offen lds
MAV 80,16,108
buffer_load_dwordx4 v19, s[28:31], s54 offen offset:1056 lds
MAV 80,0,100
TR 38,6,17440
s_add_u32 s54, s101, 3407872
s_add_u32 s52, s79, 835584
MAV 84,4,100
TR 48,6,25344
buffer_load_dwordx4 v[144:147], v4, s[16:19], s52 offen sc1
MAV 84,20,108
TR 50,6,25856
MAV 68,20,104
TR 52,6,25376
buffer_load_dwordx4 v[148:151], v4, s[16:19], s52 offen offset:1024 sc1
MAV 68,4,96
TR 54,6,25888
s_add_u32 m0, s55, 59136
s_waitcnt lgkmcnt(8)
MAV 72,8,96
buffer_load_dwordx4 v18, s[28:31], s54 offen lds
MAV 72,24,104
TR 40,6,16960
TR 42,6,17472
MAV 88,24,108
TR 44,6,16992
buffer_load_dwordx4 v19, s[28:31], s54 offen offset:1056 lds
MAV 88,8,100
TR 46,6,17504
s_add_u32 s52, s79, 901120
MAV 92,12,100
TR 56,6,25408
buffer_load_dwordx4 v[152:155], v4, s[16:19], s52 offen sc1
MAV 92,28,108
TR 58,6,25920
MAV 76,28,104
TR 60,6,25440
buffer_load_dwordx4 v[156:159], v4, s[16:19], s52 offen offset:1024 sc1
MAV 76,12,96
TR 62,6,25952
s_waitcnt vmcnt(16) lgkmcnt(8)
MAV 64,32,112
TR 0,6,33792
s_add_u32 s52, s76, 49152
s_lshl_b32 s70, s2, 10
MAV 64,48,120
buffer_load_dwordx4 v[160:163], v4, s[16:19], s52 offen sc1
s_lshl_b32 s62, s3, 7
MAV 80,48,124
TR 2,6,34304
TR 4,6,33824
MAV 80,32,116
TR 6,6,34336
s_add_u32 s70, s70, s62
s_add_u32 s70, s70, 31457792
MAV 84,36,116
buffer_load_dwordx4 v[164:167], v4, s[16:19], s52 offen offset:1024 sc1
s_xor_b32 s71, s70, 1024
MAV 84,52,124
TR 16,6,42240
TR 18,6,42752
MAV 68,52,120
TR 20,6,42272
v_min_u32 v12, 1, v1
v_lshlrev_b32 v12, 28, v12
MAV 68,36,112
TR 22,6,42784
s_add_u32 s52, s77, 163840
s_waitcnt lgkmcnt(8)
MAV 72,40,112
buffer_load_dwordx4 v[168:171], v4, s[16:19], s52 offen sc1
v_mov_b32 v13, 1
MAV 72,56,120
TR 8,6,33856
v_mov_b32 v15, 0
s_lshl_b32 s68, s7, 18
MAV 88,56,124
TR 10,6,34368
TR 12,6,33888
MAV 88,40,116
TR 14,6,34400
s_add_u32 s68, s68, 146800640
s_xor_b32 s69, s68, 262144
MAV 92,44,116
buffer_load_dwordx4 v[172:175], v4, s[16:19], s52 offen offset:1024 sc1
v_mov_b32 v11, v4
MAV 92,60,124
TR 24,6,42304
TR 26,6,42816
MAV 76,60,120
TR 28,6,42336
v_and_b32 v2, 1, v1
v_lshlrev_b32 v2, 4, v2
MAV 76,44,112
TR 30,6,42848
v_mov_b32 v224, 0x3f80
s_waitcnt vmcnt(12) lgkmcnt(8)
MAV 64,0,128
TR 32,6,50688
s_add_u32 s52, s78, 278528
v_lshlrev_b32 v2, v2, v224
MAV 64,16,136
buffer_load_dwordx4 v[176:179], v4, s[16:19], s52 offen sc1
v_bfe_u32 v224, v1, 2, 2
MAV 80,16,140
TR 34,6,51200
TR 36,6,50720
MAV 80,0,132
TR 38,6,51232
v_lshrrev_b32 v225, 4, v1
v_cmp_eq_u32 vcc, v224, v225
MAV 84,4,132
buffer_load_dwordx4 v[180:183], v4, s[16:19], s52 offen offset:1024 sc1
v_cndmask_b32 v2, 0, v2, vcc
MAV 84,20,140
TR 48,6,59136
TR 50,6,59648
MAV 68,20,136
TR 52,6,59168
v_and_b32 v224, 2, v1
v_cmp_eq_u32 vcc, 0, v224
MAV 68,4,128
TR 54,6,59680
s_add_u32 s52, s79, 393216
s_waitcnt lgkmcnt(8)
MAV 72,8,128
buffer_load_dwordx4 v[184:187], v4, s[16:19], s52 offen sc1
v_cndmask_b32 v226, 0, v2, vcc
MAV 72,24,136
TR 40,6,50752
v_cndmask_b32 v227, v2, 0, vcc
v_mov_b32 v224, 0
MAV 88,24,140
TR 42,6,51264
TR 44,6,50784
MAV 88,8,132
TR 46,6,51296
v_mov_b32 v225, 0
v_mov_b32 v228, 0
MAV 92,12,132
buffer_load_dwordx4 v[188:191], v4, s[16:19], s52 offen offset:1024 sc1
v_mov_b32 v229, 0
MAV 92,28,140
TR 56,6,59200
TR 58,6,59712
MAV 76,28,136
TR 60,6,59232
s_lshr_b32 s62, s6, 1
s_lshl_b32 s62, s62, 8
MAV 76,12,128
TR 62,6,59744
s_and_b32 s63, s6, 1
s_waitcnt vmcnt(8) lgkmcnt(8)
s_barrier
v_add_u32 v6, s57, v6
MAV 64,32,144
ds_read_b64_tr_b16 a[0:1], v6
s_add_u32 s52, s76, 507904
s_add_u32 s62, s62, s63
MAV 64,48,152
buffer_load_dwordx4 v[192:195], v4, s[16:19], s52 offen sc1
s_lshl_b32 s63, s3, 6
MAV 80,48,156
TR 2,6,512
TR 4,6,32
MAV 80,32,148
TR 6,6,544
s_add_u32 s62, s62, s63
s_lshl_b32 s62, s62, 11
MAV 84,36,148
buffer_load_dwordx4 v[196:199], v4, s[16:19], s52 offen offset:1024 sc1
s_lshl_b32 s63, s7, 7
MAV 84,52,156
TR 16,6,8448
TR 18,6,8960
MAV 68,52,152
TR 20,6,8480
s_add_u32 s62, s62, s63
v_and_b32 v16, 15, v1
MAV 68,36,144
TR 22,6,8992
s_add_u32 s52, s77, 622592
s_waitcnt lgkmcnt(8)
MAV 72,40,144
buffer_load_dwordx4 v[200:203], v4, s[16:19], s52 offen sc1
v_lshlrev_b32 v16, 12, v16
MAV 72,56,152
TR 8,6,64
v_bfe_u32 v2, v1, 4, 1
v_lshl_add_u32 v16, v2, 5, v16
MAV 88,56,156
.Lpad30:
s_cbranch_execz .Lnopoll63r
TR 10,6,576
TR 12,6,96
MAV 88,40,148
TR 14,6,608
v_bfe_u32 v2, v1, 5, 1
v_lshl_add_u32 v16, v2, 4, v16
MAV 92,44,148
buffer_load_dwordx4 v[204:207], v4, s[16:19], s52 offen offset:1024 sc1
v_add_u32 v16, s62, v16
MAV 92,60,156
TR 24,6,8512
TR 26,6,9024
MAV 76,60,152
TR 28,6,8544
v_add_u32 v17, 0x10000, v16
v_accvgpr_read_b32 v28, a224
MAV 76,44,144
TR 30,6,9056
v_add_f32 v32, v32, v28
s_waitcnt vmcnt(8) lgkmcnt(8)
MAV 64,0,160
TR 32,6,16896
s_add_u32 s52, s78, 737280
v_accvgpr_read_b32 v29, a225
MAV 64,16,168
buffer_load_dwordx4 v[208:211], v4, s[16:19], s52 offen sc1
v_add_f32 v33, v33, v29
MAV 80,16,172
TR 34,6,17408
TR 36,6,16928
MAV 80,0,164
TR 38,6,17440
v_accvgpr_read_b32 v28, a226
v_add_f32 v34, v34, v28
MAV 84,4,164
buffer_load_dwordx4 v[212:215], v4, s[16:19], s52 offen offset:1024 sc1
v_accvgpr_read_b32 v29, a227
MAV 84,20,172
TR 48,6,25344
TR 50,6,25856
MAV 68,20,168
TR 52,6,25376
v_add_f32 v35, v35, v29
v_accvgpr_read_b32 v28, a228
MAV 68,4,160
TR 54,6,25888
s_add_u32 s52, s79, 851968
s_waitcnt lgkmcnt(8)
MAV 72,8,160
buffer_load_dwordx4 v[216:219], v4, s[16:19], s52 offen sc1
v_add_f32 v36, v36, v28
MAV 72,24,168
TR 40,6,16960
v_accvgpr_read_b32 v29, a229
v_add_f32 v37, v37, v29
MAV 88,24,172
TR 42,6,17472
TR 44,6,16992
MAV 88,8,164
TR 46,6,17504
v_accvgpr_read_b32 v28, a230
v_add_f32 v38, v38, v28
MAV 92,12,164
buffer_load_dwordx4 v[220:223], v4, s[16:19], s52 offen offset:1024 sc1
v_accvgpr_read_b32 v29, a231
MAV 92,28,172
TR 56,6,25408
TR 58,6,25920
MAV 76,28,168
TR 60,6,25440
v_add_f32 v39, v39, v29
v_accvgpr_read_b32 v28, a232
MAV 76,12,160
TR 62,6,25952
v_add_f32 v40, v40, v28
s_waitcnt vmcnt(8) lgkmcnt(8)
MAV 64,32,176
TR 0,6,33792
v_accvgpr_read_b32 v29, a233
v_add_f32 v41, v41, v29
MAV 64,48,184
TR 2,6,34304
v_accvgpr_read_b32 v28, a234
MAV 80,48,188
TR 4,6,33824
v_add_f32 v42, v42, v28
MAV 80,32,180
TR 6,6,34336
v_accvgpr_read_b32 v29, a235
MAV 84,36,180
TR 16,6,42240
v_add_f32 v43, v43, v29
MAV 84,52,188
TR 18,6,42752
v_accvgpr_read_b32 v28, a236
MAV 68,52,184
TR 20,6,42272
v_add_f32 v44, v44, v28
MAV 68,36,176
TR 22,6,42784
s_waitcnt lgkmcnt(8)
MAV 72,40,176
TR 8,6,33856
v_accvgpr_read_b32 v29, a237
MAV 72,56,184
TR 10,6,34368
v_add_f32 v45, v45, v29
MAV 88,56,188
TR 12,6,33888
v_accvgpr_read_b32 v28, a238
MAV 88,40,180
TR 14,6,34400
v_add_f32 v46, v46, v28
MAV 92,44,180
TR 24,6,42304
v_accvgpr_read_b32 v29, a239
MAV 92,60,188
TR 26,6,42816
v_add_f32 v47, v47, v29
MAV 76,60,184
TR 28,6,42336
v_accvgpr_read_b32 v28, a240
MAV 76,44,176
TR 30,6,42848
v_add_f32 v48, v48, v28
s_waitcnt vmcnt(4) lgkmcnt(8)
MAV 64,0,192
TR 32,6,50688
v_accvgpr_read_b32 v29, a241
v_add_f32 v49, v49, v29
MAV 64,16,200
TR 34,6,51200
v_accvgpr_read_b32 v28, a242
MAV 80,16,204
TR 36,6,50720
v_add_f32 v50, v50, v28
MAV 80,0,196
TR 38,6,51232
v_accvgpr_read_b32 v29, a243
MAV 84,4,196
TR 48,6,59136
v_add_f32 v51, v51, v29
MAV 84,20,204
TR 50,6,59648
v_accvgpr_read_b32 v28, a244
MAV 68,20,200
TR 52,6,59168
v_add_f32 v52, v52, v28
MAV 68,4,192
TR 54,6,59680
s_waitcnt lgkmcnt(8)
MAV 72,8,192
TR 40,6,50752
v_accvgpr_read_b32 v29, a245
MAV 72,24,200
TR 42,6,51264
v_add_f32 v53, v53, v29
MAV 88,24,204
TR 44,6,50784
v_accvgpr_read_b32 v28, a246
MAV 88,8,196
TR 46,6,51296
v_add_f32 v54, v54, v28
MAV 92,12,196
TR 56,6,59200
v_accvgpr_read_b32 v29, a247
MAV 92,28,204
TR 58,6,59712
v_add_f32 v55, v55, v29
MAV 76,28,200
TR 60,6,59232
v_accvgpr_read_b32 v28, a248
MAV 76,12,192
TR 62,6,59744
v_add_f32 v56, v56, v28
s_waitcnt vmcnt(0) lgkmcnt(8)
MAV 64,32,208
ds_read_b64_tr_b16 a[0:1], v7
v_accvgpr_read_b32 v29, a249
MAV 64,48,216
TR 2,7,512
v_add_f32 v57, v57, v29
MAV 80,48,220
TR 4,7,32
v_accvgpr_read_b32 v28, a250
MAV 80,32,212
TR 6,7,544
v_add_f32 v58, v58, v28
MAV 84,36,212
TR 16,7,8448
v_accvgpr_read_b32 v29, a251
MAV 84,52,220
TR 18,7,8960
v_add_f32 v59, v59, v29
MAV 68,52,216
TR 20,7,8480
v_accvgpr_read_b32 v28, a252
MAV 68,36,208
TR 22,7,8992
s_waitcnt lgkmcnt(8)
MAV 72,40,208
TR 8,7,64
v_add_f32 v60, v60, v28
MAV 72,56,216
TR 10,7,576
v_accvgpr_read_b32 v29, a253
MAV 88,56,220
TR 12,7,96
v_add_f32 v61, v61, v29
MAV 88,40,212
TR 14,7,608
v_accvgpr_read_b32 v28, a254
MAV 92,44,212
TR 24,7,8512
v_add_f32 v62, v62, v28
MAV 92,60,220
TR 26,7,9024
v_accvgpr_read_b32 v29, a255
MAV 76,60,216
TR 28,7,8544
v_add_f32 v63, v63, v29
MAV 76,44,208
TR 30,7,9056
s_waitcnt lgkmcnt(8)
MAV 32,0,96
TR 32,7,16896
v_cvt_pk_bf16_f32 v232, v64, v65
v_cvt_pk_bf16_f32 v233, v66, v67
MAV 32,16,104
TR 34,7,17408
v_cvt_pk_bf16_f32 v234, v68, v69
MAV 48,16,108
TR 36,7,16928
v_cvt_pk_bf16_f32 v235, v70, v71
buffer_store_dwordx4 v[232:235], v11, s[16:19], s69 offen sc1
MAV 48,0,100
TR 38,7,17440
s_add_u32 s69, s69, 131072
MAV 52,4,100
TR 48,7,25344
v_cvt_pk_bf16_f32 v236, v72, v73
v_cvt_pk_bf16_f32 v237, v74, v75
MAV 52,20,108
TR 50,7,25856
v_cvt_pk_bf16_f32 v238, v76, v77
MAV 36,20,104
TR 52,7,25376
v_cvt_pk_bf16_f32 v239, v78, v79
buffer_store_dwordx4 v[236:239], v11, s[16:19], s69 offen sc1
MAV 36,4,96
TR 54,7,25888
s_add_u32 s69, s69, -130048
s_waitcnt lgkmcnt(8)
MAV 40,8,96
TR 40,7,16960
v_cvt_pk_bf16_f32 v240, v80, v81
MAV 40,24,104
TR 42,7,17472
v_cvt_pk_bf16_f32 v241, v82, v83
v_cvt_pk_bf16_f32 v242, v84, v85
MAV 56,24,108
TR 44,7,16992
v_cvt_pk_bf16_f32 v243, v86, v87
MAV 56,8,100
TR 46,7,17504
buffer_store_dwordx4 v[240:243], v11, s[16:19], s69 offen sc1
s_add_u32 s69, s69, 131072
MAV 60,12,100
TR 56,7,25408
v_cvt_pk_bf16_f32 v244, v88, v89
MAV 60,28,108
TR 58,7,25920
v_cvt_pk_bf16_f32 v245, v90, v91
v_cvt_pk_bf16_f32 v246, v92, v93
MAV 44,28,104
TR 60,7,25440
v_cvt_pk_bf16_f32 v247, v94, v95
MAV 44,12,96
TR 62,7,25952
buffer_store_dwordx4 v[244:247], v11, s[16:19], s69 offen sc1
s_waitcnt lgkmcnt(8)
MAV 32,32,112
TR 0,7,33792
MAV 32,48,120
TR 2,7,34304
MAV 48,48,124
TR 4,7,33824
MAV 48,32,116
TR 6,7,34336
MAV 52,36,116
TR 16,7,42240
MAV 52,52,124
TR 18,7,42752
MAV 36,52,120
TR 20,7,42272
MAV 36,36,112
TR 22,7,42784
s_waitcnt lgkmcnt(8)
MAV 40,40,112
TR 8,7,33856
MAV 40,56,120
TR 10,7,34368
MAV 56,56,124
TR 12,7,33888
MAV 56,40,116
TR 14,7,34400
MAV 60,44,116
TR 24,7,42304
MAV 60,60,124
TR 26,7,42816
MAV 44,60,120
TR 28,7,42336
MAV 44,44,112
TR 30,7,42848
s_waitcnt lgkmcnt(8)
MAV 32,0,128
TR 32,7,50688
MAV 32,16,136
TR 34,7,51200
MAV 48,16,140
TR 36,7,50720
MAV 48,0,132
TR 38,7,51232
MAV 52,4,132
TR 48,7,59136
MAV 52,20,140
TR 50,7,59648
MAV 36,20,136
TR 52,7,59168
MAV 36,4,128
TR 54,7,59680
s_waitcnt lgkmcnt(8)
MAV 40,8,128
TR 40,7,50752
MAV 40,24,136
TR 42,7,51264
MAV 56,24,140
TR 44,7,50784
MAV 56,8,132
TR 46,7,51296
MAV 60,12,132
TR 56,7,59200
MAV 60,28,140
TR 58,7,59712
MAV 44,28,136
TR 60,7,59232
MAV 44,12,128
TR 62,7,59744
v_add_u32 v7, s57, v7
s_waitcnt lgkmcnt(8)
MAV 32,32,144
ds_read_b64_tr_b16 a[0:1], v7
TR 2,7,512
MAV 32,48,152
s_waitcnt vmcnt(0)
buffer_atomic_add v13, v12, s[16:19], s71 offen
MAV 48,48,156
TR 4,7,32
MAV 48,32,148
TR 6,7,544
MAV 52,36,148
TR 16,7,8448
MAV 52,52,156
TR 18,7,8960
MAV 36,52,152
TR 20,7,8480
MAV 36,36,144
TR 22,7,8992
s_waitcnt lgkmcnt(8)
MAV 40,40,144
TR 8,7,64
MAV 40,56,152
TR 10,7,576
MAV 56,56,156
TR 12,7,96
MAV 56,40,148
TR 14,7,608
MAV 60,44,148
TR 24,7,8512
MAV 60,60,156
TR 26,7,9024
MAV 44,60,152
TR 28,7,8544
MAV 44,44,144
TR 30,7,9056
s_waitcnt lgkmcnt(8)
MAV 32,0,160
TR 32,7,16896
TR 34,7,17408
MAV 32,16,168
buffer_atomic_add v15, v12, s[16:19], s70 offen sc0
MAV 48,16,172
TR 36,7,16928
MAV 48,0,164
TR 38,7,17440
MAV 52,4,164
TR 48,7,25344
MAV 52,20,172
TR 50,7,25856
MAV 36,20,168
TR 52,7,25376
MAV 36,4,160
TR 54,7,25888
s_waitcnt lgkmcnt(8)
MAV 40,8,160
TR 40,7,16960
MAV 40,24,168
TR 42,7,17472
MAV 56,24,172
TR 44,7,16992
MAV 56,8,164
TR 46,7,17504
MAV 60,12,164
TR 56,7,25408
MAV 60,28,172
TR 58,7,25920
MAV 44,28,168
TR 60,7,25440
MAV 44,12,160
TR 62,7,25952
s_waitcnt lgkmcnt(8)
MAV 32,32,176
TR 0,7,33792
MAV 32,48,184
TR 2,7,34304
MAV 48,48,188
TR 4,7,33824
MAV 48,32,180
TR 6,7,34336
MAV 52,36,180
TR 16,7,42240
MAV 52,52,188
TR 18,7,42752
MAV 36,52,184
TR 20,7,42272
MAV 36,36,176
TR 22,7,42784
s_waitcnt lgkmcnt(8)
MAV 40,40,176
TR 8,7,33856
MAV 40,56,184
TR 10,7,34368
MAV 56,56,188
TR 12,7,33888
MAV 56,40,180
TR 14,7,34400
MAV 60,44,180
TR 24,7,42304
MAV 60,60,188
TR 26,7,42816
MAV 44,60,184
TR 28,7,42336
MAV 44,44,176
TR 30,7,42848
s_waitcnt vmcnt(0)
v_cmp_ne_u32 vcc, 0, v15
s_nop 0
s_cbranch_vccz .Lxs68
.Lxs68b:
s_waitcnt lgkmcnt(8)
MAV 32,0,192
TR 32,7,50688
TR 34,7,51200
MAV 32,16,200
buffer_load_dwordx4 v[232:235], v11, s[16:19], s68 offen sc1
MAV 48,16,204
TR 36,7,50720
s_add_u32 s68, s68, 131072
MAV 48,0,196
TR 38,7,51232
MAV 52,4,196
buffer_load_dwordx4 v[236:239], v11, s[16:19], s68 offen sc1
MAV 52,20,204
TR 48,7,59136
s_add_u32 s68, s68, -130048
MAV 36,20,200
TR 50,7,59648
TR 52,7,59168
MAV 36,4,192
TR 54,7,59680
s_waitcnt lgkmcnt(8)
MAV 40,8,192
buffer_load_dwordx4 v[240:243], v11, s[16:19], s68 offen sc1
MAV 40,24,200
s_add_u32 s68, s68, 131072
MAV 56,24,204
TR 40,7,50752
TR 42,7,51264
MAV 56,8,196
TR 44,7,50784
TR 46,7,51296
MAV 60,12,196
buffer_load_dwordx4 v[244:247], v11, s[16:19], s68 offen sc1
MAV 60,28,204
TR 56,7,59200
MAV 44,28,200
TR 58,7,59712
TR 60,7,59232
MAV 44,12,192
TR 62,7,59744
s_waitcnt lgkmcnt(8)
MAV 32,32,208
MAV 32,48,216
MAV 48,48,220
MAV 48,32,212
MAV 52,36,212
MAV 52,52,220
MAV 36,52,216
MAV 36,36,208
s_waitcnt lgkmcnt(0)
MAV 40,40,208
MAV 40,56,216
MAV 56,56,220
MAV 56,40,212
MAV 60,44,212
MAV 60,60,220
MAV 44,60,216
MAV 44,44,208
s_waitcnt vmcnt(3)
v_mfma_f32_16x16x32_bf16 v[32:35], v[226:229], v[232:235], v[32:35]
v_mfma_f32_16x16x32_bf16 v[36:39], v[224:227], v[232:235], v[36:39]
s_waitcnt vmcnt(2)
v_mfma_f32_16x16x32_bf16 v[40:43], v[226:229], v[236:239], v[40:43]
s_nop 4
v_cvt_pk_bf16_f32 v128, v32, v33
v_cvt_pk_bf16_f32 v129, v34, v35
v_mfma_f32_16x16x32_bf16 v[44:47], v[224:227], v[236:239], v[44:47]
v_cvt_pk_bf16_f32 v130, v36, v37
v_cvt_pk_bf16_f32 v131, v38, v39
s_waitcnt vmcnt(1)
v_mfma_f32_16x16x32_bf16 v[48:51], v[226:229], v[240:243], v[48:51]
v_permlane16_swap_b32 v128, v130
v_mfma_f32_16x16x32_bf16 v[52:55], v[224:227], v[240:243], v[52:55]
v_permlane16_swap_b32 v129, v131
s_waitcnt vmcnt(0)
v_mfma_f32_16x16x32_bf16 v[56:59], v[226:229], v[244:247], v[56:59]
buffer_store_dwordx4 v[128:131], v16, s[36:39], 0 offen sc1
v_mfma_f32_16x16x32_bf16 v[60:63], v[224:227], v[244:247], v[60:63]
v_cvt_pk_bf16_f32 v132, v40, v41
v_cvt_pk_bf16_f32 v133, v42, v43
v_cvt_pk_bf16_f32 v134, v44, v45
v_cvt_pk_bf16_f32 v135, v46, v47
v_cvt_pk_bf16_f32 v136, v48, v49
v_permlane16_swap_b32 v132, v134
v_permlane16_swap_b32 v133, v135
v_cvt_pk_bf16_f32 v137, v50, v51
v_cvt_pk_bf16_f32 v138, v52, v53
buffer_store_dwordx4 v[132:135], v16, s[36:39], 0 offen offset:64 sc1
v_cvt_pk_bf16_f32 v139, v54, v55
.Lpad31:
s_cbranch_execz .Lnopoll63r
v_permlane16_swap_b32 v136, v138
s_nop 0
v_permlane16_swap_b32 v137, v139
v_cvt_pk_bf16_f32 v140, v56, v57
v_cvt_pk_bf16_f32 v141, v58, v59
v_cvt_pk_bf16_f32 v142, v60, v61
v_cvt_pk_bf16_f32 v143, v62, v63
s_nop 0
v_permlane16_swap_b32 v140, v142
v_permlane16_swap_b32 v141, v143
buffer_store_dwordx4 v[136:139], v17, s[36:39], 0 offen sc1
buffer_store_dwordx4 v[140:143], v17, s[36:39], 0 offen offset:64 sc1
s_nop 1
.Lend:
s_endpgm
.Lsp67:
s_mov_b32 s15, 0
.Lsp67l:
v_mov_b32 v25, 0
buffer_atomic_add v25, v22, s[16:19], s73 offen sc0
s_add_u32 s15, s15, 1
s_cmp_gt_u32 s15, 100000
s_waitcnt vmcnt(0)
s_cbranch_scc1 .Lsp67b
v_cmp_gt_u32 vcc, v23, v25
s_nop 0
s_cbranch_vccnz .Lsp67l
s_branch .Lsp67b
.Lxs68:
s_mov_b32 s15, 0
.Lxs68l:
v_mov_b32 v15, 0
buffer_atomic_add v15, v12, s[16:19], s70 offen sc0
s_add_u32 s15, s15, 1
s_cmp_gt_u32 s15, 100000
s_waitcnt vmcnt(0)
s_cbranch_scc1 .Lxs68b
v_cmp_ne_u32 vcc, 0, v15
s_nop 0
s_cbranch_vccz .Lxs68l
s_branch .Lxs68b
.section .rodata,"a"
.p2align 6
.amdhsa_kernel interleave_layers__sliding_local_dilated__swiglu_ffn__prompt_kernel
  .amdhsa_next_free_vgpr 512
  .amdhsa_next_free_sgpr 102
  .amdhsa_accum_offset 256
  .amdhsa_group_segment_fixed_size 0
  .amdhsa_kernarg_size 80
  .amdhsa_user_sgpr_count 2
  .amdhsa_user_sgpr_kernarg_segment_ptr 1
  .amdhsa_system_sgpr_workgroup_id_x 1
  .amdhsa_float_denorm_mode_32 3
.end_amdhsa_kernel
```

```asm
; @launch grid=(256,1,1) block=(256,1,1) lds=162560
.amdgcn_target "amdgcn-amd-amdhsa--gfx950"
.macro MAA d,a,b
v_mfma_f32_16x16x32_bf16 v[\d:\d+3], a[\a:\a+3], a[\b:\b+3], v[\d:\d+3]
.endm
.macro MAV d,a,b
v_mfma_f32_16x16x32_bf16 v[\d:\d+3], a[\a:\a+3], v[\b:\b+3], v[\d:\d+3]
.endm
.macro TR d,v,o
ds_read_b64_tr_b16 a[\d:\d+1], v\v offset:\o
.endm
.macro RD d,v,o
ds_read_b128 a[\d:\d+3], v\v offset:\o
.endm
.text
.globl interleave_layers__sliding_local_dilated__swiglu_ffn__prompt_kernel
.p2align 8
.type interleave_layers__sliding_local_dilated__swiglu_ffn__prompt_kernel,@function
interleave_layers__sliding_local_dilated__swiglu_ffn__prompt_kernel:
s_load_dwordx4 s[68:71], s[0:1], 0
s_load_dwordx2 s[72:73], s[0:1], 16
s_load_dwordx8 s[76:83], s[0:1], 32
s_load_dwordx4 s[84:87], s[0:1], 64
s_cmp_lt_u32 s2, 256
s_cbranch_scc1 .Lgo
s_endpgm
.p2align 12
.Lgo:
v_lshrrev_b32 v2, 6, v0
v_and_b32 v1, 63, v0
v_readfirstlane_b32 s3, v2
s_and_b32 s4, s2, 7
s_lshr_b32 s5, s2, 3
s_lshr_b32 s8, s4, 2
s_lshl_b32 s8, s8, 3
s_and_b32 s62, s5, 7
s_add_u32 s8, s8, s62
s_and_b32 s9, s4, 3
s_lshl_b32 s9, s9, 2
s_lshr_b32 s62, s5, 3
s_add_u32 s9, s9, s62
s_and_b32 s48, s3, 1
s_lshr_b32 s49, s3, 1
s_lshl_b32 s50, s8, 3
s_sub_u32 s50, s50, 9
s_cmp_lt_u32 s8, 2
s_cselect_b32 s50, 7, s50
v_bfe_u32 v18, v1, 3, 1
v_bfe_u32 v2, v1, 5, 1
v_lshl_add_u32 v18, v2, 2, v18
v_and_b32 v2, 16, v1
v_add_u32 v18, v18, v2
s_lshl_b32 s62, s49, 2
s_add_u32 s62, s62, s48
s_lshl_b32 s62, s62, 1
v_add_u32 v18, s62, v18
v_mul_u32_u24 v18, 6144, v18
v_and_b32 v2, 7, v1
v_lshl_add_u32 v18, v2, 4, v18
s_lshl_b32 s62, s9, 7
v_add_u32 v18, s62, v18
v_add_u32 v19, 1024, v18
v_add_u32 v20, 2048, v18
s_mul_i32 s59, s3, 3104
s_mov_b32 s58, 0
s_lshr_b32 s62, s8, 1
s_lshl_b32 s62, s62, 8
s_and_b32 s67, s8, 1
s_add_u32 s62, s62, s67
s_lshl_b32 s62, s62, 11
s_lshl_b32 s63, s3, 17
s_add_u32 s62, s62, s63
v_lshrrev_b32 v2, 4, v1
v_xor_b32 v2, v2, v1
v_and_b32 v2, 7, v2
v_lshlrev_b32 v2, 4, v2
v_lshrrev_b32 v21, 3, v1
v_lshl_add_u32 v21, v21, 12, v2
v_add_u32 v21, s62, v21
v_xor_b32 v28, 64, v21
v_add_u32 v28, 31744, v28
s_lshr_b32 s63, s50, 3
s_lshr_b32 s62, s63, 1
s_lshl_b32 s62, s62, 8
s_and_b32 s67, s63, 1
s_add_u32 s62, s62, s67
s_lshl_b32 s62, s62, 11
s_lshl_b32 s63, s3, 14
s_add_u32 s62, s62, s63
s_add_u32 s62, s62, 456704
s_lshl_b32 s63, s3, 5
v_and_b32 v2, 31, v1
v_lshlrev_b32 v2, 2, v2
v_xor_b32 v2, s63, v2
v_lshrrev_b32 v22, 5, v1
v_lshl_add_u32 v22, v22, 12, v2
v_add_u32 v22, s62, v22
v_xor_b32 v29, 16, v22
v_add_u32 v29, -57344, v29
s_mov_b32 s52, 0
s_mov_b32 s53, 65536
s_mul_i32 s55, s3, 4608
s_mov_b32 s54, 0
s_mul_i32 s56, s3, 3104
s_waitcnt lgkmcnt(0)
s_mov_b32 s36, s68
s_mov_b32 s37, s69
s_mov_b32 s38, 4194304
s_mov_b32 s39, 0x20000
s_mov_b32 s20, s70
s_mov_b32 s21, s71
s_mov_b32 s22, 6291456
s_mov_b32 s23, 0x20000
s_lshr_b32 s6, s4, 1
s_lshl_b32 s6, s6, 2
s_and_b32 s62, s5, 3
s_add_u32 s6, s6, s62
s_and_b32 s7, s4, 1
s_lshr_b32 s62, s5, 2
s_lshl_b32 s62, s62, 1
s_add_u32 s7, s7, s62
s_lshr_b32 s62, s6, 1
s_lshl_b32 s62, s62, 8
s_and_b32 s63, s6, 1
s_add_u32 s62, s62, s63
s_lshl_b32 s63, s3, 6
s_add_u32 s62, s62, s63
s_lshl_b32 s62, s62, 11
s_lshl_b32 s63, s7, 7
s_add_u32 s62, s62, s63
v_and_b32 v228, 15, v1
v_lshlrev_b32 v228, 12, v228
v_bfe_u32 v2, v1, 4, 1
v_lshl_add_u32 v228, v2, 5, v228
v_bfe_u32 v2, v1, 5, 1
v_lshl_add_u32 v228, v2, 4, v228
v_add_u32 v228, s62, v228
v_add_u32 v229, 0x10000, v228
s_sub_u32 s64, s3, 1
s_max_i32 s64, s64, 0
s_lshl_b32 s64, s64, 11
s_lshl_b32 s66, s9, 7
s_add_u32 s66, s66, s64
s_cmp_eq_u32 s3, 1
s_cselect_b32 s66, 8388608, s66
s_mul_i32 s65, s8, 122880
s_add_u32 s65, s65, s66
v_lshrrev_b32 v9, 1, v1
v_min_u32 v9, 19, v9
v_mul_u32_u24 v9, 6144, v9
s_mov_b32 s16, s86
s_mov_b32 s17, s87
s_mov_b32 s18, 268435456
s_mov_b32 s19, 0x20000
s_xor_b32 s14, s3, 3
s_lshl_b32 s14, s14, 8
s_add_u32 s14, s14, s2
v_lshlrev_b32 v230, 4, v1
v_mov_b64 v[224:225], 0
v_mov_b64 v[226:227], 0
s_cmp_ge_u32 s14, 16
s_cbranch_scc1 .Lz3
s_lshl_b32 s62, s2, 13
s_add_u32 s62, s62, 30408704
s_add_u32 s63, s62, 4096
buffer_store_dwordx4 v[224:227], v230, s[16:19], s62 offen sc1
buffer_store_dwordx4 v[224:227], v230, s[16:19], s62 offen offset:1024 sc1
buffer_store_dwordx4 v[224:227], v230, s[16:19], s62 offen offset:2048 sc1
buffer_store_dwordx4 v[224:227], v230, s[16:19], s62 offen offset:3072 sc1
buffer_store_dwordx4 v[224:227], v230, s[16:19], s63 offen sc1
buffer_store_dwordx4 v[224:227], v230, s[16:19], s63 offen offset:1024 sc1
buffer_store_dwordx4 v[224:227], v230, s[16:19], s63 offen offset:2048 sc1
buffer_store_dwordx4 v[224:227], v230, s[16:19], s63 offen offset:3072 sc1
.Lz3:
buffer_load_dwordx4 v[164:167], v228, s[36:39], 0 offen
buffer_load_dwordx4 v[168:171], v228, s[36:39], 0 offen offset:64
buffer_load_dwordx4 v[172:175], v229, s[36:39], 0 offen
buffer_load_dwordx4 v[176:179], v229, s[36:39], 0 offen offset:64
buffer_load_dword v58, v9, s[20:23], s65 offen
s_mov_b32 s40, s84
s_mov_b32 s41, s85
s_mov_b32 s42, 256
s_mov_b32 s43, 0x20000
s_getpc_b64 s[62:63]
.Lpc:
s_lshl_b32 s64, s5, 12
v_lshrrev_b32 v59, 3, v0
v_lshl_add_u32 v59, v59, 7, s64
v_add_u32 v2, 0x20000, v59
v_min_u32 v2, .Lend-.Lpc, v2
v_min_u32 v59, .Lend-.Lpc, v59
global_load_dword v59, v59, s[62:63]
global_load_dword v58, v2, s[62:63]
s_mov_b32 s24, s72
s_mov_b32 s25, s73
s_mov_b32 s26, 2097152
s_mov_b32 s27, 0x20000
s_mov_b32 s28, s80
s_mov_b32 s29, s81
s_mov_b32 s30, 7340032
s_mov_b32 s31, 0x20000
s_mov_b32 s0, s82
s_mov_b32 s1, s83
s_mov_b32 s32, s76
s_mov_b32 s33, s77
s_mov_b32 s34, 7340032
s_mov_b32 s35, 0x20000
s_mov_b32 s80, s78
s_mov_b32 s81, s79
s_mov_b32 s82, 7340032
s_mov_b32 s83, 0x20000
s_lshr_b32 s10, s4, 2
s_lshl_b32 s10, s10, 2
s_and_b32 s62, s5, 3
s_add_u32 s10, s10, s62
s_and_b32 s11, s4, 3
s_lshl_b32 s11, s11, 3
s_lshr_b32 s62, s5, 2
s_add_u32 s11, s11, s62
s_and_b32 s12, s11, 1
s_lshr_b32 s13, s11, 1
s_mul_i32 s51, s13, 448
s_mul_i32 s62, s12, 192
s_add_u32 s51, s51, s62
s_lshl_b32 s62, s6, 3
s_lshr_b32 s84, s62, 4
s_lshl_b32 s84, s84, 14
s_and_b32 s62, s62, 15
s_lshl_b32 s62, s62, 10
s_add_u32 s84, s84, s62
s_lshl_b32 s62, s8, 3
s_lshr_b32 s85, s62, 4
s_lshl_b32 s85, s85, 14
s_and_b32 s62, s62, 15
s_lshl_b32 s62, s62, 10
s_add_u32 s85, s85, s62
s_lshl_b32 s62, s50, 0
s_lshr_b32 s86, s62, 4
s_lshl_b32 s86, s86, 14
s_and_b32 s62, s62, 15
s_lshl_b32 s62, s62, 10
s_add_u32 s86, s86, s62
s_mul_i32 s62, s8, 393216
s_add_u32 s62, s62, s66
v_mul_u32_u24 v14, 6144, v1
v_add_u32 v14, s62, v14
s_lshl_b32 s62, s8, 4
s_add_u32 s62, s62, s9
s_lshl_b32 s62, s62, 2
s_add_u32 s62, s62, s3
s_mul_i32 s62, s62, 6656
v_min_u32 v15, 51, v1
v_lshl_add_u32 v15, v15, 7, s62
s_sub_u32 s63, s8, 4
s_lshl_b32 s64, s8, 1
s_add_u32 s64, s64, 1
s_cmp_lt_u32 s8, 5
s_cselect_b64 vcc, -1, 0
s_cselect_b32 s46, s64, s63
v_cndmask_b32 v14, v14, v15, vcc
s_lshl_b32 s62, s2, 1
s_add_u32 s62, s62, s48
s_mul_i32 s62, s62, 5376
v_min_u32 v16, 41, v1
v_lshl_add_u32 v16, v16, 7, s62
s_cmp_lt_u32 s46, 6
s_cselect_b64 vcc, -1, 0
v_cndmask_b32 v15, v14, v16, vcc
v_cndmask_b32 v14, v16, v14, vcc
s_cmp_lt_u32 s3, 2
s_cselect_b32 s65, s32, s80
s_cselect_b32 s66, s33, s81
s_cselect_b32 s67, s34, s82
s_cmp_lt_u32 s8, 5
s_cselect_b32 s62, s24, s20
s_cselect_b32 s63, s25, s21
s_cselect_b32 s64, s26, s22
s_sub_u32 s47, s46, 6
s_cmp_lt_u32 s46, 6
s_cselect_b32 s47, s46, s47
s_cselect_b32 s76, s62, s65
s_cselect_b32 s98, s65, s62
s_cselect_b32 s77, s63, s66
s_cselect_b32 s99, s66, s63
s_cselect_b32 s78, s64, s67
s_cselect_b32 s100, s67, s64
s_mov_b32 s79, 0x20000
v_bfe_u32 v24, v1, 1, 3
v_lshrrev_b32 v2, 4, v1
v_xor_b32 v2, v2, v24
v_lshlrev_b32 v2, 4, v2
v_and_b32 v23, 15, v1
v_lshl_add_u32 v23, v23, 7, v2
s_mul_i32 s62, s48, 9216
v_add_u32 v23, s62, v23
v_xor_b32 v30, 64, v23
v_mul_u32_u24 v24, 2304, v24
v_add_u32 v24, v24, v2
v_and_b32 v2, 1, v1
v_lshl_add_u32 v24, v2, 7, v24
v_add_u32 v24, 2048, v24
v_xor_b32 v31, 64, v24
v_and_b32 v2, 15, v1
v_cmp_eq_u32 vcc, 0, v2
v_mov_b32 v2, 18432
s_nop 0
v_cndmask_b32 v24, v24, v2, vcc
v_cndmask_b32 v31, v31, v2, vcc
v_bfe_u32 v25, v1, 3, 2
v_mul_u32_u24 v25, 3104, v25
v_bfe_u32 v2, v1, 2, 1
v_lshl_add_u32 v25, v2, 7, v25
v_bfe_u32 v2, v1, 5, 1
v_lshl_add_u32 v25, v2, 8, v25
v_and_b32 v2, 3, v1
v_lshl_add_u32 v25, v2, 3, v25
s_lshl_b32 s62, s49, 6
s_add_u32 s62, s62, 73984
v_add_u32 v25, s62, v25
s_lshl_b32 s62, s8, 1
s_add_u32 s62, s62, s3
s_lshr_b32 s63, s50, 2
s_cmp_lt_u32 s3, 2
s_cselect_b32 s62, s62, s63
s_lshl_b32 s62, s62, 13
s_cmp_eq_u32 s3, 3
s_cselect_b32 s62, 268435456, s62
v_lshl_add_u32 v26, v1, 4, s62
s_mul_i32 s59, s3, 2080
s_and_b32 s87, s6, 3
s_lshl_b32 s87, s87, 17
v_bfe_u32 v5, v1, 3, 1
v_lshrrev_b32 v2, 4, v1
v_lshl_add_u32 v5, v2, 3, v5
s_lshl_b32 s62, s3, 1
v_add_u32 v5, s62, v5
v_mul_u32_u24 v5, 2048, v5
v_and_b32 v2, 7, v1
v_lshl_add_u32 v5, v2, 4, v5
s_lshl_b32 s62, s7, 7
v_add_u32 v5, s62, v5
v_add_u32 v6, 64512, v5
s_lshl_b32 s62, s6, 10
s_add_u32 s62, s62, 30408704
s_lshl_b32 s64, s8, 10
s_add_u32 s64, s64, 30408704
s_lshr_b32 s67, s9, 1
s_and_b32 s67, s67, 3
s_lshl_b32 s67, s67, 7
s_add_u32 s64, s64, s67
s_lshr_b32 s65, s50, 3
s_lshl_b32 s65, s65, 10
s_add_u32 s65, s65, 30408704
s_lshr_b32 s67, s9, 1
s_and_b32 s67, s67, 3
s_lshl_b32 s67, s67, 7
s_add_u32 s65, s65, s67
v_mov_b32 v2, 268435456
v_cmp_eq_u32 vcc, 65, v0
v_mov_b32 v33, s65
s_nop 0
v_cndmask_b32 v33, v2, v33, vcc
v_cndmask_b32 v36, 0, 16, vcc
v_cmp_eq_u32 vcc, 64, v0
v_mov_b32 v32, s64
s_nop 0
v_cndmask_b32 v33, v33, v32, vcc
v_lshl_add_u32 v32, v1, 7, s62
v_cndmask_b32 v34, v2, 0, vcc
v_cndmask_b32 v35, 0, 16, vcc
v_cndmask_b32 v36, v36, 16, vcc
v_lshrrev_b32 v37, 3, v0
v_cmp_eq_u32 vcc, 8, v37
s_nop 1
v_cndmask_b32 v32, v2, v32, vcc
v_mov_b32 v38, 1
v_lshrrev_b32 v2, 4, v1
v_lshlrev_b32 v2, 2, v2
v_and_b32 v13, 15, v1
v_sub_u32 v2, v13, v2
v_mov_b32 v13, 0xff61b1e6
v_subrev_u32 v54, 0, v2
v_cmp_gt_u32 vcc, 8, v54
s_nop 1
v_cndmask_b32 v50, v13, 0, vcc
v_cmp_gt_i32 vcc, -8, v54
s_nop 1
v_cndmask_b32 v46, v13, 0, vcc
v_subrev_u32 v54, 1, v2
v_cmp_gt_u32 vcc, 8, v54
s_nop 1
v_cndmask_b32 v51, v13, 0, vcc
v_cmp_gt_i32 vcc, -8, v54
s_nop 1
v_cndmask_b32 v47, v13, 0, vcc
v_subrev_u32 v54, 2, v2
v_cmp_gt_u32 vcc, 8, v54
s_nop 1
v_cndmask_b32 v52, v13, 0, vcc
v_cmp_gt_i32 vcc, -8, v54
s_nop 1
v_cndmask_b32 v48, v13, 0, vcc
v_subrev_u32 v54, 3, v2
v_cmp_gt_u32 vcc, 8, v54
s_nop 1
v_cndmask_b32 v53, v13, 0, vcc
v_cmp_gt_i32 vcc, -8, v54
s_nop 1
v_cndmask_b32 v49, v13, 0, vcc
s_cmp_lt_u32 s8, 2
s_cselect_b64 vcc, -1, 0
v_cndmask_b32 v54, v46, v13, vcc
v_cndmask_b32 v55, v47, v13, vcc
v_cndmask_b32 v56, v48, v13, vcc
v_cndmask_b32 v57, v49, v13, vcc
s_mov_b32 s75, 29360128
v_and_b32 v10, 15, v1
v_lshlrev_b32 v12, 2, v10
v_lshlrev_b32 v10, 4, v10
v_add_u32 v10, 152576, v10
v_lshrrev_b32 v11, 4, v1
v_lshlrev_b32 v11, 4, v11
s_lshl_b32 s62, s49, 7
s_add_u32 s62, s62, 158720
v_add_u32 v12, s62, v12
v_add_u32 v13, s62, v11
v_add_u32 v11, 156672, v11
s_lshl_b32 s62, s3, 11
s_add_u32 s62, s62, 143360
v_lshl_add_u32 v8, v1, 4, s62
v_xor_b32 v9, 2048, v8
v_mov_b32 v248, 0x3f803f80
v_mov_b32 v249, 0x3f803f80
v_mov_b32 v250, 0x3f803f80
v_mov_b32 v251, 0x3f803f80
s_mul_i32 s62, s3, 18496
s_add_u32 s62, s62, 18432
v_mov_b32 v2, s62
ds_write_b128 v2, v[248:251]
v_and_b32 v7, 31, v1
v_lshrrev_b32 v2, 5, v1
v_lshl_add_u32 v7, v7, 1, v2
v_and_b32 v2, 0xc0, v0
v_add_u32 v7, v7, v2
v_lshlrev_b32 v17, 2, v7
v_add_u32 v17, 156672, v17
v_lshlrev_b32 v7, 4, v7
v_add_u32 v7, 152576, v7
s_lshl_b32 s74, s9, 1
s_add_u32 s74, s74, s49
s_lshl_b32 s74, s74, 17
s_add_u32 s74, s74, s85
s_lshl_b32 s63, s48, 12
s_add_u32 s74, s74, s63
s_add_u32 s74, s74, 4194304
s_mov_b32 s62, 0
v_lshl_add_u32 v4, v1, 4, s62
v_lshrrev_b32 v2, 3, v1
v_cmp_eq_u32 vcc, 3, v2
v_add_u32 v2, 67108480, v4
s_nop 0
v_cndmask_b32 v4, v4, v2, vcc
s_add_u32 m0, s55, 0
s_nop 0
buffer_load_dwordx4 v21, s[36:39], s52 offen lds
buffer_load_dwordx4 v28, s[36:39], s52 offen offset:1024 lds
buffer_load_dword v22, s[36:39], s52 offen offset:2048 lds
s_add_u32 s52, s52, 128
s_add_u32 m0, s55, 2304
s_nop 0
buffer_load_dwordx4 v21, s[36:39], s53 offen lds
buffer_load_dwordx4 v28, s[36:39], s53 offen offset:1024 lds
buffer_load_dword v29, s[36:39], s53 offen offset:2048 lds
s_add_u32 s53, s53, 128
s_add_u32 m0, s56, 123648
s_nop 0
buffer_load_dwordx4 v18, s[20:23], s54 offen lds
buffer_load_dwordx4 v19, s[20:23], s54 offen offset:1024 lds
buffer_load_dwordx4 v20, s[20:23], s54 offen offset:2048 lds
s_add_u32 s54, s54, 196608
s_add_u32 m0, s56, 136064
s_nop 0
buffer_load_dwordx4 v18, s[20:23], s54 offen lds
buffer_load_dwordx4 v19, s[20:23], s54 offen offset:1024 lds
buffer_load_dwordx4 v20, s[20:23], s54 offen offset:2048 lds
s_add_u32 s54, s54, 196608
s_cmp_eq_u32 s48, 1
s_cbranch_scc1 .Lqkv1
s_cmp_lt_u32 s14, 16
s_cselect_b32 s62, 0, 4096
v_mov_b32 v231, 1
v_lshlrev_b32 v232, 8, v1
s_waitcnt vmcnt(18)
v_permlane16_swap_b32 v164, v166
v_permlane16_swap_b32 v165, v167
s_waitcnt vmcnt(17)
v_permlane16_swap_b32 v168, v170
v_permlane16_swap_b32 v169, v171
s_waitcnt vmcnt(16)
v_permlane16_swap_b32 v172, v174
v_permlane16_swap_b32 v173, v175
s_waitcnt vmcnt(15)
v_permlane16_swap_b32 v176, v178
v_permlane16_swap_b32 v177, v179
buffer_atomic_add v231, v232, s[40:43], s62 offen
v_lshlrev_b32 v192, 16, v164
v_and_b32 v193, 0xffff0000, v164
v_lshlrev_b32 v194, 16, v165
v_and_b32 v195, 0xffff0000, v165
v_lshlrev_b32 v196, 16, v166
v_and_b32 v197, 0xffff0000, v166
v_lshlrev_b32 v198, 16, v167
v_and_b32 v199, 0xffff0000, v167
v_lshlrev_b32 v200, 16, v168
v_and_b32 v201, 0xffff0000, v168
v_lshlrev_b32 v202, 16, v169
v_and_b32 v203, 0xffff0000, v169
v_lshlrev_b32 v204, 16, v170
v_and_b32 v205, 0xffff0000, v170
v_lshlrev_b32 v206, 16, v171
v_and_b32 v207, 0xffff0000, v171
v_lshlrev_b32 v208, 16, v172
v_and_b32 v209, 0xffff0000, v172
v_lshlrev_b32 v210, 16, v173
v_and_b32 v211, 0xffff0000, v173
v_lshlrev_b32 v212, 16, v174
v_and_b32 v213, 0xffff0000, v174
v_lshlrev_b32 v214, 16, v175
v_and_b32 v215, 0xffff0000, v175
v_lshlrev_b32 v216, 16, v176
v_and_b32 v217, 0xffff0000, v176
v_lshlrev_b32 v218, 16, v177
v_and_b32 v219, 0xffff0000, v177
v_lshlrev_b32 v220, 16, v178
v_and_b32 v221, 0xffff0000, v178
v_lshlrev_b32 v222, 16, v179
v_and_b32 v223, 0xffff0000, v179
s_lshl_b32 s64, s6, 14
s_lshl_b32 s65, s49, 13
s_add_u32 s64, s64, s65
s_lshl_b32 s65, s7, 9
s_add_u32 s64, s64, s65
s_lshl_b32 s65, s48, 8
s_add_u32 s64, s64, s65
s_add_u32 s64, s64, 29360128
v_and_b32 v188, 31, v1
v_lshlrev_b32 v188, 3, v188
v_lshrrev_b32 v189, 5, v1
v_lshl_add_u32 v188, v189, 28, v188
s_lshl_b32 s62, s7, 18
s_add_u32 s62, s62, 0
s_add_u32 s63, s62, 131072
v_pk_mul_f32 v[182:183], v[192:193], v[192:193]
v_pk_mul_f32 v[186:187], v[208:209], v[208:209]
v_pk_fma_f32 v[182:183], v[194:195], v[194:195], v[182:183]
v_pk_add_f32 v[180:181], v[192:193], v[194:195]
v_pk_fma_f32 v[186:187], v[210:211], v[210:211], v[186:187]
v_pk_add_f32 v[184:185], v[208:209], v[210:211]
v_pk_fma_f32 v[182:183], v[196:197], v[196:197], v[182:183]
v_pk_add_f32 v[180:181], v[180:181], v[196:197]
v_pk_fma_f32 v[186:187], v[212:213], v[212:213], v[186:187]
v_pk_add_f32 v[184:185], v[184:185], v[212:213]
v_pk_fma_f32 v[182:183], v[198:199], v[198:199], v[182:183]
v_pk_add_f32 v[180:181], v[180:181], v[198:199]
v_pk_fma_f32 v[186:187], v[214:215], v[214:215], v[186:187]
v_pk_add_f32 v[184:185], v[184:185], v[214:215]
v_pk_fma_f32 v[182:183], v[200:201], v[200:201], v[182:183]
v_pk_add_f32 v[180:181], v[180:181], v[200:201]
v_pk_fma_f32 v[186:187], v[216:217], v[216:217], v[186:187]
v_pk_add_f32 v[184:185], v[184:185], v[216:217]
v_pk_fma_f32 v[182:183], v[202:203], v[202:203], v[182:183]
v_pk_add_f32 v[180:181], v[180:181], v[202:203]
v_pk_fma_f32 v[186:187], v[218:219], v[218:219], v[186:187]
v_pk_add_f32 v[184:185], v[184:185], v[218:219]
v_pk_fma_f32 v[182:183], v[204:205], v[204:205], v[182:183]
v_pk_add_f32 v[180:181], v[180:181], v[204:205]
v_pk_fma_f32 v[186:187], v[220:221], v[220:221], v[186:187]
v_pk_add_f32 v[184:185], v[184:185], v[220:221]
v_pk_fma_f32 v[182:183], v[206:207], v[206:207], v[182:183]
v_pk_add_f32 v[180:181], v[180:181], v[206:207]
v_pk_fma_f32 v[186:187], v[222:223], v[222:223], v[186:187]
v_pk_add_f32 v[184:185], v[184:185], v[222:223]
v_add_f32 v180, v180, v181
v_add_f32 v182, v182, v183
v_add_f32 v184, v184, v185
v_add_f32 v186, v186, v187
s_nop 0
v_permlane16_swap_b32 v180, v184
v_permlane16_swap_b32 v182, v186
v_add_f32 v180, v180, v184
v_add_f32 v182, v182, v186
s_nop 1
v_permlane32_swap_b32 v180, v182
v_add_f32 v180, v180, v182
s_nop 1
v_permlane32_swap_b32 v180, v181
buffer_store_dwordx2 v[180:181], v188, s[16:19], s64 offen sc1
s_lshl_b32 s62, s2, 10
s_add_u32 s62, s62, 31457280
s_cmp_eq_u32 s3, 0
s_cselect_b32 s62, s62, 268435456
buffer_store_dwordx4 v[224:227], v230, s[16:19], s62 offen sc1
v_accvgpr_write_b32 a224, v192
v_accvgpr_write_b32 a225, v193
v_accvgpr_write_b32 a226, v194
v_accvgpr_write_b32 a227, v195
v_accvgpr_write_b32 a228, v196
v_accvgpr_write_b32 a229, v197
v_accvgpr_write_b32 a230, v198
v_accvgpr_write_b32 a231, v199
v_accvgpr_write_b32 a232, v200
v_accvgpr_write_b32 a233, v201
v_accvgpr_write_b32 a234, v202
v_accvgpr_write_b32 a235, v203
v_accvgpr_write_b32 a236, v204
v_accvgpr_write_b32 a237, v205
v_accvgpr_write_b32 a238, v206
v_accvgpr_write_b32 a239, v207
v_accvgpr_write_b32 a240, v208
v_accvgpr_write_b32 a241, v209
v_accvgpr_write_b32 a242, v210
v_accvgpr_write_b32 a243, v211
v_accvgpr_write_b32 a244, v212
v_accvgpr_write_b32 a245, v213
v_accvgpr_write_b32 a246, v214
v_accvgpr_write_b32 a247, v215
v_accvgpr_write_b32 a248, v216
v_accvgpr_write_b32 a249, v217
v_accvgpr_write_b32 a250, v218
v_accvgpr_write_b32 a251, v219
v_accvgpr_write_b32 a252, v220
v_accvgpr_write_b32 a253, v221
v_accvgpr_write_b32 a254, v222
v_accvgpr_write_b32 a255, v223
s_add_u32 m0, s55, 18496
s_nop 0
buffer_load_dwordx4 v21, s[36:39], s52 offen lds
buffer_load_dwordx4 v28, s[36:39], s52 offen offset:1024 lds
buffer_load_dword v22, s[36:39], s52 offen offset:2048 lds
s_add_u32 s52, s52, 128
s_add_u32 m0, s55, 20800
s_nop 0
buffer_load_dwordx4 v21, s[36:39], s53 offen lds
buffer_load_dwordx4 v28, s[36:39], s53 offen offset:1024 lds
buffer_load_dword v29, s[36:39], s53 offen offset:2048 lds
s_add_u32 s53, s53, 128
s_add_u32 m0, s56, 73984
s_nop 0
buffer_load_dwordx4 v18, s[20:23], s54 offen lds
buffer_load_dwordx4 v19, s[20:23], s54 offen offset:1024 lds
buffer_load_dwordx4 v20, s[20:23], s54 offen offset:2048 lds
s_add_u32 s54, s54, 196608
s_waitcnt vmcnt(12) lgkmcnt(0)
s_barrier
ds_read_b128 a[0:3], v23
RD 4,23,2304
RD 8,23,4608
RD 12,23,6912
ds_read_b128 a[16:19], v24
ds_read_b128 a[20:23], v30
RD 24,30,2304
RD 28,30,4608
RD 32,30,6912
ds_read_b128 a[36:39], v31
TR 80,25,49664
TR 82,25,50176
TR 84,25,62080
TR 86,25,62592
TR 88,25,50688
TR 90,25,51200
TR 92,25,63104
TR 94,25,63616
TR 96,25,51712
TR 98,25,52224
TR 100,25,64128
TR 102,25,64640
s_waitcnt vmcnt(3) lgkmcnt(0)
s_barrier
v_mfma_f32_16x16x32_bf16 v[60:63], a[80:83], a[0:3], 0
TR 104,25,49696
s_add_u32 m0, s56, 86400
MAA 60,84,20
buffer_load_dwordx4 v18, s[20:23], s54 offen lds
v_mfma_f32_16x16x32_bf16 v[64:67], a[80:83], a[4:7], 0
s_sub_u32 s47, s47, 1
s_cbranch_scc1 .Lx4
.Lx4b:
MAA 64,84,24
buffer_load_dwordx4 v19, s[20:23], s54 offen offset:1024 lds
v_mfma_f32_16x16x32_bf16 v[68:71], a[80:83], a[8:11], 0
TR 106,25,50208
MAA 68,84,28
TR 108,25,62112
TR 110,25,62624
v_mfma_f32_16x16x32_bf16 v[72:75], a[80:83], a[12:15], 0
TR 112,25,50720
MAA 72,84,32
TR 114,25,51232
v_mfma_f32_16x16x32_bf16 v[244:247], a[80:83], a[16:19], 0
TR 116,25,63136
MAA 244,84,36
buffer_load_dwordx4 v20, s[20:23], s54 offen offset:2048 lds
v_mfma_f32_16x16x32_bf16 v[156:159], a[88:91], a[16:19], 0
s_add_u32 s54, s54, 196608
s_add_u32 m0, s55, 36992
MAA 156,92,36
buffer_load_dwordx4 v21, s[36:39], s52 offen lds
v_mfma_f32_16x16x32_bf16 v[104:107], a[88:91], a[12:15], 0
TR 118,25,63648
MAA 104,92,32
buffer_load_dwordx4 v28, s[36:39], s52 offen offset:1024 lds
v_mfma_f32_16x16x32_bf16 v[100:103], a[88:91], a[8:11], 0
TR 120,25,51744
MAA 100,92,28
buffer_load_dword v22, s[36:39], s52 offen offset:2048 lds
v_mfma_f32_16x16x32_bf16 v[96:99], a[88:91], a[4:7], 0
s_add_u32 s52, s52, 128
MAA 96,92,24
TR 122,25,52256
TR 124,25,64160
v_mfma_f32_16x16x32_bf16 v[92:95], a[88:91], a[0:3], 0
TR 126,25,64672
s_add_u32 m0, s55, 39296
MAA 92,92,20
buffer_load_dwordx4 v21, s[36:39], s53 offen lds
v_mfma_f32_16x16x32_bf16 v[124:127], a[0:3], a[96:99], 0
RD 40,23,18496
MAA 124,20,100
buffer_load_dwordx4 v28, s[36:39], s53 offen offset:1024 lds
v_mfma_f32_16x16x32_bf16 v[128:131], a[4:7], a[96:99], 0
RD 44,23,20800
MAA 128,24,100
RD 48,23,23104
RD 52,23,25408
v_mfma_f32_16x16x32_bf16 v[132:135], a[8:11], a[96:99], 0
RD 56,24,18496
MAA 132,28,100
buffer_load_dword v29, s[36:39], s53 offen offset:2048 lds
v_mfma_f32_16x16x32_bf16 v[136:139], a[12:15], a[96:99], 0
s_add_u32 s53, s53, 128
MAA 136,32,100
s_waitcnt vmcnt(6) lgkmcnt(5)
s_barrier
v_mfma_f32_16x16x32_bf16 v[76:79], a[104:107], a[0:3], 0
RD 60,30,18496
s_add_u32 m0, s56, 98816
MAA 76,108,20
buffer_load_dwordx4 v18, s[20:23], s54 offen lds
v_mfma_f32_16x16x32_bf16 v[80:83], a[104:107], a[4:7], 0
RD 64,30,20800
MAA 80,108,24
buffer_load_dwordx4 v19, s[20:23], s54 offen offset:1024 lds
v_mfma_f32_16x16x32_bf16 v[84:87], a[104:107], a[8:11], 0
RD 68,30,23104
MAA 84,108,28
RD 72,30,25408
RD 76,31,18496
v_mfma_f32_16x16x32_bf16 v[88:91], a[104:107], a[12:15], 0
ds_read_b64_tr_b16 a[80:81], v25
MAA 88,108,32
buffer_load_dwordx4 v20, s[20:23], s54 offen offset:2048 lds
v_mfma_f32_16x16x32_bf16 v[160:163], a[112:115], a[16:19], 0
s_add_u32 s54, s54, 196608
s_add_u32 m0, s56, 111232
MAA 160,116,36
buffer_load_dwordx4 v18, s[20:23], s54 offen lds
v_mfma_f32_16x16x32_bf16 v[120:123], a[112:115], a[12:15], 0
TR 82,25,512
MAA 120,116,32
buffer_load_dwordx4 v19, s[20:23], s54 offen offset:1024 lds
v_mfma_f32_16x16x32_bf16 v[116:119], a[112:115], a[8:11], 0
TR 84,25,12416
MAA 116,116,28
TR 86,25,12928
TR 88,25,1024
v_mfma_f32_16x16x32_bf16 v[112:115], a[112:115], a[4:7], 0
TR 90,25,1536
MAA 112,116,24
buffer_load_dwordx4 v20, s[20:23], s54 offen offset:2048 lds
v_mfma_f32_16x16x32_bf16 v[108:111], a[112:115], a[0:3], 0
s_add_u32 s54, s54, 196608
s_add_u32 m0, s55, 55488
MAA 108,116,20
buffer_load_dwordx4 v21, s[36:39], s52 offen lds
v_mfma_f32_16x16x32_bf16 v[140:143], a[0:3], a[120:123], 0
TR 92,25,13440
MAA 140,20,124
buffer_load_dwordx4 v28, s[36:39], s52 offen offset:1024 lds
v_mfma_f32_16x16x32_bf16 v[144:147], a[4:7], a[120:123], 0
TR 94,25,13952
MAA 144,24,124
TR 96,25,2048
TR 98,25,2560
v_mfma_f32_16x16x32_bf16 v[148:151], a[8:11], a[120:123], 0
TR 100,25,14464
MAA 148,28,124
buffer_load_dword v22, s[36:39], s52 offen offset:2048 lds
v_mfma_f32_16x16x32_bf16 v[152:155], a[12:15], a[120:123], 0
TR 102,25,14976
s_add_u32 s52, s52, 128
MAA 152,32,124
s_waitcnt vmcnt(9) lgkmcnt(8)
s_barrier
MAA 60,80,40
TR 104,25,32
s_add_u32 m0, s55, 57792
MAA 60,84,60
buffer_load_dwordx4 v21, s[36:39], s53 offen lds
MAA 64,84,64
s_sub_u32 s47, s47, 1
s_cbranch_scc1 .Lx5
.Lx5b:
MAA 64,80,44
buffer_load_dwordx4 v28, s[36:39], s53 offen offset:1024 lds
MAA 68,80,48
TR 106,25,544
MAA 68,84,68
TR 108,25,12448
TR 110,25,12960
MAA 72,84,72
TR 112,25,1056
MAA 72,80,52
TR 114,25,1568
s_waitcnt lgkmcnt(6)
MAA 244,80,56
TR 116,25,13472
MAA 244,84,76
buffer_load_dword v29, s[36:39], s53 offen offset:2048 lds
MAA 156,92,76
s_add_u32 s53, s53, 128
s_add_u32 m0, s56, 123648
MAA 156,88,56
buffer_load_dwordx4 v18, s[20:23], s54 offen lds
MAA 104,88,52
TR 118,25,13984
MAA 104,92,72
buffer_load_dwordx4 v19, s[20:23], s54 offen offset:1024 lds
MAA 100,92,68
TR 120,25,2080
MAA 100,88,48
buffer_load_dwordx4 v20, s[20:23], s54 offen offset:2048 lds
MAA 96,88,44
s_add_u32 s54, s54, 196608
MAA 96,92,64
TR 122,25,2592
TR 124,25,14496
MAA 92,92,60
TR 126,25,15008
s_add_u32 m0, s56, 136064
MAA 92,88,40
buffer_load_dwordx4 v18, s[20:23], s54 offen lds
MAA 124,40,96
RD 0,23,36992
MAA 124,60,100
buffer_load_dwordx4 v19, s[20:23], s54 offen offset:1024 lds
MAA 128,64,100
RD 4,23,39296
MAA 128,44,96
RD 8,23,41600
RD 12,23,43904
MAA 132,48,96
RD 16,24,36992
MAA 132,68,100
buffer_load_dwordx4 v20, s[20:23], s54 offen offset:2048 lds
MAA 136,72,100
s_add_u32 s54, s54, 196608
MAA 136,52,96
s_waitcnt vmcnt(12) lgkmcnt(5)
s_barrier
MAA 76,104,40
RD 20,30,36992
s_add_u32 m0, s55, 0
MAA 76,108,60
buffer_load_dwordx4 v21, s[36:39], s52 offen lds
MAA 80,108,64
RD 24,30,39296
MAA 80,104,44
buffer_load_dwordx4 v28, s[36:39], s52 offen offset:1024 lds
MAA 84,104,48
RD 28,30,41600
MAA 84,108,68
buffer_load_dword v22, s[36:39], s52 offen offset:2048 lds
MAA 88,108,72
RD 32,30,43904
s_add_u32 s52, s52, 128
MAA 88,104,52
RD 36,31,36992
TR 80,25,24832
TR 82,25,25344
MAA 160,112,56
TR 84,25,37248
s_add_u32 m0, s55, 2304
MAA 160,116,76
buffer_load_dwordx4 v21, s[36:39], s53 offen lds
MAA 120,116,72
TR 86,25,37760
MAA 120,112,52
buffer_load_dwordx4 v28, s[36:39], s53 offen offset:1024 lds
MAA 116,112,48
TR 88,25,25856
MAA 116,116,68
buffer_load_dword v29, s[36:39], s53 offen offset:2048 lds
MAA 112,116,64
s_add_u32 s53, s53, 128
s_add_u32 m0, s56, 73984
MAA 112,112,44
buffer_load_dwordx4 v18, s[20:23], s54 offen lds
MAA 108,112,40
TR 90,25,26368
MAA 108,116,60
buffer_load_dwordx4 v19, s[20:23], s54 offen offset:1024 lds
MAA 140,60,124
TR 92,25,38272
MAA 140,40,120
TR 94,25,38784
TR 96,25,26880
TR 98,25,27392
MAA 144,44,120
TR 100,25,39296
MAA 144,64,124
buffer_load_dwordx4 v20, s[20:23], s54 offen offset:2048 lds
MAA 148,68,124
TR 102,25,39808
s_add_u32 s54, s54, 196608
MAA 148,48,120
buffer_load_dword v37, v34, s[40:43], 0 offen sc1
MAA 152,52,120
MAA 152,72,124
s_waitcnt vmcnt(16) lgkmcnt(8)
s_barrier
MAA 60,80,0
TR 104,25,24864
s_add_u32 m0, s56, 86400
MAA 60,84,20
buffer_load_dwordx4 v18, s[20:23], s54 offen lds
MAA 64,84,24
s_sub_u32 s47, s47, 1
s_cbranch_scc1 .Lx6
.Lx6b:
MAA 64,80,4
buffer_load_dwordx4 v19, s[20:23], s54 offen offset:1024 lds
MAA 68,80,8
TR 106,25,25376
MAA 68,84,28
TR 108,25,37280
TR 110,25,37792
MAA 72,84,32
TR 112,25,25888
MAA 72,80,12
TR 114,25,26400
s_waitcnt lgkmcnt(6)
MAA 244,80,16
TR 116,25,38304
MAA 244,84,36
buffer_load_dwordx4 v20, s[20:23], s54 offen offset:2048 lds
MAA 156,92,36
s_add_u32 s54, s54, 196608
s_add_u32 m0, s55, 18496
MAA 156,88,16
buffer_load_dwordx4 v21, s[36:39], s52 offen lds
MAA 104,88,12
TR 118,25,38816
MAA 104,92,32
buffer_load_dwordx4 v28, s[36:39], s52 offen offset:1024 lds
MAA 100,92,28
TR 120,25,26912
MAA 100,88,8
buffer_load_dword v22, s[36:39], s52 offen offset:2048 lds
MAA 96,88,4
s_add_u32 s52, s52, 128
MAA 96,92,24
TR 122,25,27424
TR 124,25,39328
MAA 92,92,20
TR 126,25,39840
s_add_u32 m0, s55, 20800
MAA 92,88,0
buffer_load_dwordx4 v21, s[36:39], s53 offen lds
MAA 124,0,96
RD 40,23,55488
MAA 124,20,100
buffer_load_dwordx4 v28, s[36:39], s53 offen offset:1024 lds
MAA 128,24,100
RD 44,23,57792
MAA 128,4,96
RD 48,23,60096
RD 52,23,62400
MAA 132,8,96
RD 56,24,55488
MAA 132,28,100
buffer_load_dword v29, s[36:39], s53 offen offset:2048 lds
MAA 136,32,100
s_add_u32 s53, s53, 128
MAA 136,12,96
s_waitcnt vmcnt(19) lgkmcnt(5)
s_barrier
MAA 76,104,0
RD 60,30,55488
s_add_u32 m0, s56, 98816
MAA 76,108,20
buffer_load_dwordx4 v18, s[20:23], s54 offen lds
MAA 80,108,24
RD 64,30,57792
MAA 80,104,4
buffer_load_dwordx4 v19, s[20:23], s54 offen offset:1024 lds
MAA 84,104,8
RD 68,30,60096
MAA 84,108,28
RD 72,30,62400
RD 76,31,55488
MAA 88,108,32
TR 80,25,49664
MAA 88,104,12
buffer_load_dwordx4 v20, s[20:23], s54 offen offset:2048 lds
MAA 160,112,16
s_add_u32 s54, s54, 196608
s_add_u32 m0, s55, 36992
MAA 160,116,36
buffer_load_dwordx4 v21, s[36:39], s52 offen lds
MAA 120,116,32
TR 82,25,50176
MAA 120,112,12
buffer_load_dwordx4 v28, s[36:39], s52 offen offset:1024 lds
MAA 116,112,8
TR 84,25,62080
MAA 116,116,28
TR 86,25,62592
TR 88,25,50688
MAA 112,116,24
TR 90,25,51200
MAA 112,112,4
buffer_load_dword v22, s[36:39], s52 offen offset:2048 lds
MAA 108,112,0
s_add_u32 s52, s52, 128
s_add_u32 m0, s55, 39296
MAA 108,116,20
buffer_load_dwordx4 v21, s[36:39], s53 offen lds
MAA 140,20,124
TR 92,25,63104
MAA 140,0,120
buffer_load_dwordx4 v28, s[36:39], s53 offen offset:1024 lds
MAA 144,4,120
TR 94,25,63616
MAA 144,24,124
TR 96,25,51712
TR 98,25,52224
MAA 148,28,124
TR 100,25,64128
MAA 148,8,120
buffer_load_dword v29, s[36:39], s53 offen offset:2048 lds
MAA 152,12,120
TR 102,25,64640
s_add_u32 s53, s53, 128
MAA 152,32,124
s_waitcnt vmcnt(22) lgkmcnt(8)
s_barrier
MAA 60,80,40
TR 104,25,49696
s_add_u32 m0, s56, 111232
MAA 60,84,60
buffer_load_dwordx4 v18, s[20:23], s54 offen lds
MAA 64,84,64
s_sub_u32 s47, s47, 1
s_cbranch_scc1 .Lx7
.Lx7b:
MAA 64,80,44
TR 106,25,50208
MAA 68,80,48
TR 108,25,62112
MAA 68,84,68
buffer_load_dwordx4 v19, s[20:23], s54 offen offset:1024 lds
MAA 72,84,72
TR 110,25,62624
MAA 72,80,52
TR 112,25,50720
s_waitcnt lgkmcnt(5)
MAA 244,80,56
TR 114,25,51232
MAA 244,84,76
buffer_load_dwordx4 v20, s[20:23], s54 offen offset:2048 lds
MAA 156,92,76
s_add_u32 s54, s54, 196608
MAA 156,88,56
TR 116,25,63136
MAA 104,88,52
TR 118,25,63648
MAA 104,92,72
TR 120,25,51744
MAA 100,92,68
TR 122,25,52256
s_add_u32 m0, s55, 55488
MAA 100,88,48
buffer_load_dwordx4 v21, s[36:39], s52 offen lds
MAA 96,88,44
TR 124,25,64160
MAA 96,92,64
TR 126,25,64672
MAA 92,92,60
MAA 92,88,40
buffer_load_dwordx4 v28, s[36:39], s52 offen offset:1024 lds
MAA 124,40,96
ds_read_b128 a[0:3], v23
MAA 124,60,100
RD 4,23,2304
MAA 128,64,100
RD 8,23,4608
MAA 128,44,96
buffer_load_dword v22, s[36:39], s52 offen offset:2048 lds
MAA 132,48,96
RD 12,23,6912
s_add_u32 s52, s52, 128
MAA 132,68,100
ds_read_b128 a[16:19], v24
MAA 136,72,100
MAA 136,52,96
s_waitcnt vmcnt(21) lgkmcnt(5)
s_barrier
v_cmp_gt_u32 vcc, v35, v37
s_nop 0
s_cbranch_vccnz .Lsp8
.Lsp8b:
v_mov_b32 v37, 0
MAA 76,104,40
ds_read_b128 a[20:23], v30
MAA 76,108,60
buffer_atomic_add v38, v32, s[16:19], 0 offen
MAA 80,108,64
RD 24,30,2304
MAA 80,104,44
RD 28,30,4608
MAA 84,104,48
RD 32,30,6912
s_add_u32 m0, s56, 123648
MAA 84,108,68
buffer_load_dwordx4 v18, s[20:23], s54 offen lds
MAA 88,108,72
ds_read_b128 a[36:39], v31
MAA 88,104,52
buffer_load_dwordx4 v19, s[20:23], s54 offen offset:1024 lds
MAA 160,112,56
ds_read_b64_tr_b16 a[80:81], v25
MAA 160,116,76
TR 82,25,512
MAA 120,116,72
TR 84,25,12416
MAA 120,112,52
buffer_load_dwordx4 v20, s[20:23], s54 offen offset:2048 lds
MAA 116,112,48
TR 86,25,12928
s_add_u32 s54, s54, 196608
MAA 116,116,68
TR 88,25,1024
MAA 112,116,64
TR 90,25,1536
s_add_u32 m0, s55, 57792
MAA 112,112,44
buffer_load_dwordx4 v21, s[36:39], s53 offen lds
MAA 108,112,40
TR 92,25,13440
MAA 108,116,60
TR 94,25,13952
MAA 140,60,124
TR 96,25,2048
MAA 140,40,120
buffer_load_dwordx4 v28, s[36:39], s53 offen offset:1024 lds
MAA 144,44,120
TR 98,25,2560
MAA 144,64,124
buffer_load_dword v29, s[36:39], s53 offen offset:2048 lds
MAA 148,68,124
TR 100,25,14464
s_add_u32 s53, s53, 128
MAA 148,48,120
TR 102,25,14976
MAA 152,52,120
MAA 152,72,124
s_waitcnt vmcnt(22) lgkmcnt(8)
s_barrier
MAA 60,80,0
TR 104,25,32
s_add_u32 m0, s56, 136064
MAA 60,84,20
buffer_load_dwordx4 v18, s[20:23], s54 offen lds
MAA 64,84,24
s_sub_u32 s47, s47, 1
s_cbranch_scc1 .Lx9
.Lx9b:
MAA 64,80,4
TR 106,25,544
MAA 68,80,8
TR 108,25,12448
MAA 68,84,28
buffer_load_dwordx4 v19, s[20:23], s54 offen offset:1024 lds
MAA 72,84,32
TR 110,25,12960
MAA 72,80,12
TR 112,25,1056
s_waitcnt lgkmcnt(5)
MAA 244,80,16
TR 114,25,1568
MAA 244,84,36
buffer_load_dwordx4 v20, s[20:23], s54 offen offset:2048 lds
MAA 156,92,36
s_add_u32 s54, s54, 196608
MAA 156,88,16
TR 116,25,13472
MAA 104,88,12
TR 118,25,13984
MAA 104,92,32
TR 120,25,2080
MAA 100,92,28
TR 122,25,2592
s_add_u32 m0, s55, 0
MAA 100,88,8
buffer_load_dwordx4 v21, s[36:39], s52 offen lds
MAA 96,88,4
TR 124,25,14496
MAA 96,92,24
TR 126,25,15008
MAA 92,92,20
MAA 92,88,0
buffer_load_dwordx4 v28, s[36:39], s52 offen offset:1024 lds
MAA 124,0,96
RD 40,23,18496
MAA 124,20,100
RD 44,23,20800
MAA 128,24,100
RD 48,23,23104
MAA 128,4,96
buffer_load_dword v22, s[36:39], s52 offen offset:2048 lds
MAA 132,8,96
RD 52,23,25408
s_add_u32 s52, s52, 128
MAA 132,28,100
RD 56,24,18496
MAA 136,32,100
MAA 136,12,96
s_waitcnt vmcnt(16) lgkmcnt(5)
s_barrier
MAA 76,104,0
RD 60,30,18496
s_add_u32 m0, s56, 73984
MAA 76,108,20
buffer_load_dwordx4 v18, s[20:23], s54 offen lds
MAA 80,108,24
RD 64,30,20800
MAA 80,104,4
RD 68,30,23104
MAA 84,104,8
RD 72,30,25408
MAA 84,108,28
buffer_load_dwordx4 v19, s[20:23], s54 offen offset:1024 lds
MAA 88,108,32
RD 76,31,18496
MAA 88,104,12
TR 80,25,24832
MAA 160,112,16
TR 82,25,25344
MAA 160,116,36
buffer_load_dwordx4 v20, s[20:23], s54 offen offset:2048 lds
MAA 120,116,32
TR 84,25,37248
s_add_u32 s54, s54, 196608
MAA 120,112,12
TR 86,25,37760
MAA 116,112,8
s_add_u32 m0, s55, 2304
MAA 116,116,28
buffer_load_dwordx4 v21, s[36:39], s53 offen lds
MAA 112,116,24
TR 88,25,25856
MAA 112,112,4
TR 90,25,26368
MAA 108,112,0
TR 92,25,38272
MAA 108,116,20
buffer_load_dwordx4 v28, s[36:39], s53 offen offset:1024 lds
MAA 140,20,124
TR 94,25,38784
MAA 140,0,120
TR 96,25,26880
MAA 144,4,120
TR 98,25,27392
MAA 144,24,124
buffer_load_dword v29, s[36:39], s53 offen offset:2048 lds
MAA 148,28,124
TR 100,25,39296
s_add_u32 s53, s53, 128
MAA 148,8,120
TR 102,25,39808
MAA 152,12,120
MAA 152,32,124
s_waitcnt lgkmcnt(8)
s_barrier
MAA 60,80,40
TR 104,25,24864
s_add_u32 m0, s56, 86400
MAA 60,84,60
buffer_load_dwordx4 v18, s[20:23], s54 offen lds
MAA 64,84,64
s_sub_u32 s47, s47, 1
s_cbranch_scc1 .Lx10
.Lx10b:
MAA 64,80,44
TR 106,25,25376
MAA 68,80,48
TR 108,25,37280
MAA 68,84,68
buffer_load_dwordx4 v19, s[20:23], s54 offen offset:1024 lds
MAA 72,84,72
TR 110,25,37792
MAA 72,80,52
TR 112,25,25888
s_waitcnt lgkmcnt(5)
MAA 244,80,56
TR 114,25,26400
MAA 244,84,76
buffer_load_dwordx4 v20, s[20:23], s54 offen offset:2048 lds
MAA 156,92,76
s_add_u32 s54, s54, 196608
MAA 156,88,56
TR 116,25,38304
MAA 104,88,52
TR 118,25,38816
MAA 104,92,72
TR 120,25,26912
MAA 100,92,68
TR 122,25,27424
s_add_u32 m0, s55, 18496
MAA 100,88,48
buffer_load_dwordx4 v21, s[36:39], s52 offen lds
MAA 96,88,44
TR 124,25,39328
MAA 96,92,64
TR 126,25,39840
MAA 92,92,60
MAA 92,88,40
buffer_load_dwordx4 v28, s[36:39], s52 offen offset:1024 lds
MAA 124,40,96
RD 0,23,36992
MAA 124,60,100
RD 4,23,39296
MAA 128,64,100
RD 8,23,41600
MAA 128,44,96
buffer_load_dword v22, s[36:39], s52 offen offset:2048 lds
MAA 132,48,96
RD 12,23,43904
s_add_u32 s52, s52, 128
MAA 132,68,100
RD 16,24,36992
MAA 136,72,100
MAA 136,52,96
s_waitcnt vmcnt(15) lgkmcnt(5)
s_barrier
MAA 76,104,40
RD 20,30,36992
s_add_u32 m0, s56, 98816
MAA 76,108,60
buffer_load_dwordx4 v18, s[20:23], s54 offen lds
MAA 80,108,64
RD 24,30,39296
MAA 80,104,44
RD 28,30,41600
MAA 84,104,48
RD 32,30,43904
MAA 84,108,68
buffer_load_dwordx4 v19, s[20:23], s54 offen offset:1024 lds
MAA 88,108,72
RD 36,31,36992
MAA 88,104,52
buffer_load_dwordx4 v20, s[20:23], s54 offen offset:2048 lds
MAA 160,112,56
TR 80,25,49664
s_add_u32 s54, s54, 196608
MAA 160,116,76
TR 82,25,50176
MAA 120,116,72
TR 84,25,62080
s_add_u32 m0, s55, 20800
MAA 120,112,52
buffer_load_dwordx4 v21, s[36:39], s53 offen lds
MAA 116,112,48
TR 86,25,62592
MAA 116,116,68
TR 88,25,50688
MAA 112,116,64
TR 90,25,51200
MAA 112,112,44
buffer_load_dwordx4 v28, s[36:39], s53 offen offset:1024 lds
MAA 108,112,40
TR 92,25,63104
MAA 108,116,60
TR 94,25,63616
MAA 140,60,124
TR 96,25,51712
MAA 140,40,120
buffer_load_dword v29, s[36:39], s53 offen offset:2048 lds
MAA 144,44,120
TR 98,25,52224
s_add_u32 s53, s53, 128
MAA 144,64,124
buffer_atomic_add v37, v33, s[16:19], 0 offen sc0
MAA 148,68,124
TR 100,25,64128
MAA 148,48,120
TR 102,25,64640
MAA 152,52,120
MAA 152,72,124
s_waitcnt lgkmcnt(8)
s_barrier
MAA 60,80,0
TR 104,25,49696
s_add_u32 m0, s56, 111232
MAA 60,84,20
buffer_load_dwordx4 v18, s[20:23], s54 offen lds
MAA 64,84,24
s_sub_u32 s47, s47, 1
s_cbranch_scc1 .Lx11
.Lx11b:
MAA 64,80,4
TR 106,25,50208
MAA 68,80,8
TR 108,25,62112
MAA 68,84,28
buffer_load_dwordx4 v19, s[20:23], s54 offen offset:1024 lds
MAA 72,84,32
TR 110,25,62624
MAA 72,80,12
TR 112,25,50720
s_waitcnt lgkmcnt(5)
MAA 244,80,16
TR 114,25,51232
MAA 244,84,36
buffer_load_dwordx4 v20, s[20:23], s54 offen offset:2048 lds
MAA 156,92,36
s_add_u32 s54, s54, 196608
MAA 156,88,16
TR 116,25,63136
MAA 104,88,12
TR 118,25,63648
MAA 104,92,32
TR 120,25,51744
MAA 100,92,28
TR 122,25,52256
s_add_u32 m0, s55, 36992
MAA 100,88,8
buffer_load_dwordx4 v21, s[36:39], s52 offen lds
MAA 96,88,4
TR 124,25,64160
MAA 96,92,24
TR 126,25,64672
MAA 92,92,20
MAA 92,88,0
buffer_load_dwordx4 v28, s[36:39], s52 offen offset:1024 lds
MAA 124,0,96
RD 40,23,55488
MAA 124,20,100
RD 44,23,57792
MAA 128,24,100
RD 48,23,60096
MAA 128,4,96
buffer_load_dword v22, s[36:39], s52 offen offset:2048 lds
MAA 132,8,96
RD 52,23,62400
s_add_u32 s52, s52, 128
MAA 132,28,100
RD 56,24,55488
MAA 136,32,100
MAA 136,12,96
s_waitcnt vmcnt(16) lgkmcnt(5)
s_barrier
MAA 76,104,0
RD 60,30,55488
s_add_u32 m0, s56, 123648
MAA 76,108,20
buffer_load_dwordx4 v18, s[20:23], s54 offen lds
MAA 80,108,24
RD 64,30,57792
MAA 80,104,4
RD 68,30,60096
MAA 84,104,8
RD 72,30,62400
MAA 84,108,28
buffer_load_dwordx4 v19, s[20:23], s54 offen offset:1024 lds
MAA 88,108,32
RD 76,31,55488
MAA 88,104,12
ds_read_b64_tr_b16 a[80:81], v25
MAA 160,112,16
TR 82,25,512
MAA 160,116,36
buffer_load_dwordx4 v20, s[20:23], s54 offen offset:2048 lds
MAA 120,116,32
TR 84,25,12416
s_add_u32 s54, s54, 196608
MAA 120,112,12
TR 86,25,12928
MAA 116,112,8
s_add_u32 m0, s55, 39296
MAA 116,116,28
buffer_load_dwordx4 v21, s[36:39], s53 offen lds
MAA 112,116,24
TR 88,25,1024
MAA 112,112,4
TR 90,25,1536
MAA 108,112,0
TR 92,25,13440
MAA 108,116,20
buffer_load_dwordx4 v28, s[36:39], s53 offen offset:1024 lds
MAA 140,20,124
TR 94,25,13952
MAA 140,0,120
TR 96,25,2048
MAA 144,4,120
TR 98,25,2560
MAA 144,24,124
buffer_load_dword v29, s[36:39], s53 offen offset:2048 lds
MAA 148,28,124
TR 100,25,14464
s_add_u32 s53, s53, 128
MAA 148,8,120
TR 102,25,14976
MAA 152,12,120
MAA 152,32,124
s_waitcnt lgkmcnt(8)
s_barrier
MAA 60,80,40
TR 104,25,32
s_add_u32 m0, s56, 136064
MAA 60,84,60
buffer_load_dwordx4 v18, s[20:23], s54 offen lds
MAA 64,84,64
s_sub_u32 s47, s47, 1
s_cbranch_scc1 .Lx12
.Lx12b:
MAA 64,80,44
TR 106,25,544
MAA 68,80,48
TR 108,25,12448
MAA 68,84,68
buffer_load_dwordx4 v19, s[20:23], s54 offen offset:1024 lds
MAA 72,84,72
TR 110,25,12960
MAA 72,80,52
TR 112,25,1056
s_waitcnt lgkmcnt(5)
MAA 244,80,56
TR 114,25,1568
MAA 244,84,76
buffer_load_dwordx4 v20, s[20:23], s54 offen offset:2048 lds
MAA 156,92,76
s_add_u32 s54, s54, 196608
MAA 156,88,56
TR 116,25,13472
MAA 104,88,52
TR 118,25,13984
MAA 104,92,72
TR 120,25,2080
MAA 100,92,68
TR 122,25,2592
s_add_u32 m0, s55, 55488
MAA 100,88,48
buffer_load_dwordx4 v21, s[36:39], s52 offen lds
MAA 96,88,44
TR 124,25,14496
MAA 96,92,64
TR 126,25,15008
MAA 92,92,60
MAA 92,88,40
buffer_load_dwordx4 v28, s[36:39], s52 offen offset:1024 lds
MAA 124,40,96
ds_read_b128 a[0:3], v23
MAA 124,60,100
RD 4,23,2304
MAA 128,64,100
RD 8,23,4608
MAA 128,44,96
buffer_load_dword v22, s[36:39], s52 offen offset:2048 lds
MAA 132,48,96
RD 12,23,6912
s_add_u32 s52, s52, 128
MAA 132,68,100
ds_read_b128 a[16:19], v24
MAA 136,72,100
MAA 136,52,96
s_waitcnt vmcnt(18)
v_cmp_gt_u32 vcc, v36, v37
s_nop 0
s_cbranch_vccnz .Lsp13
.Lsp13b:
s_waitcnt vmcnt(15) lgkmcnt(5)
s_barrier
MAA 76,104,40
ds_read_b128 a[20:23], v30
s_add_u32 m0, s56, 73984
MAA 76,108,60
buffer_load_dwordx4 v18, s[20:23], s54 offen lds
MAA 80,108,64
RD 24,30,2304
MAA 80,104,44
RD 28,30,4608
MAA 84,104,48
RD 32,30,6912
MAA 84,108,68
buffer_load_dwordx4 v19, s[20:23], s54 offen offset:1024 lds
MAA 88,108,72
ds_read_b128 a[36:39], v31
MAA 88,104,52
buffer_load_dwordx4 v20, s[20:23], s54 offen offset:2048 lds
MAA 160,112,56
TR 80,25,24832
s_add_u32 s54, s54, 196608
MAA 160,116,76
TR 82,25,25344
MAA 120,116,72
TR 84,25,37248
s_add_u32 m0, s55, 57792
MAA 120,112,52
buffer_load_dwordx4 v21, s[36:39], s53 offen lds
MAA 116,112,48
TR 86,25,37760
MAA 116,116,68
TR 88,25,25856
MAA 112,116,64
TR 90,25,26368
MAA 112,112,44
buffer_load_dwordx4 v28, s[36:39], s53 offen offset:1024 lds
MAA 108,112,40
TR 92,25,38272
MAA 108,116,60
TR 94,25,38784
MAA 140,60,124
TR 96,25,26880
MAA 140,40,120
buffer_load_dword v29, s[36:39], s53 offen offset:2048 lds
MAA 144,44,120
TR 98,25,27392
s_add_u32 s53, s53, 128
MAA 144,64,124
buffer_load_dwordx4 v[164:167], v26, s[16:19], s75 offen sc1
MAA 148,68,124
TR 100,25,39296
MAA 148,48,120
TR 102,25,39808
MAA 152,52,120
MAA 152,72,124
s_waitcnt lgkmcnt(8)
s_barrier
MAA 60,80,0
TR 104,25,24864
s_add_u32 m0, s56, 86400
MAA 60,84,20
buffer_load_dwordx4 v18, s[20:23], s54 offen lds
MAA 64,84,24
s_sub_u32 s47, s47, 1
s_cbranch_scc1 .Lx14
.Lx14b:
MAA 64,80,4
TR 106,25,25376
MAA 68,80,8
TR 108,25,37280
MAA 68,84,28
buffer_load_dwordx4 v19, s[20:23], s54 offen offset:1024 lds
MAA 72,84,32
TR 110,25,37792
MAA 72,80,12
TR 112,25,25888
s_waitcnt lgkmcnt(5)
MAA 244,80,16
TR 114,25,26400
MAA 244,84,36
buffer_load_dwordx4 v20, s[20:23], s54 offen offset:2048 lds
MAA 156,92,36
TR 116,25,38304
s_add_u32 s54, s54, 196608
MAA 156,88,16
TR 118,25,38816
MAA 104,88,12
TR 120,25,26912
s_add_u32 m0, s55, 0
MAA 104,92,32
buffer_load_dwordx4 v21, s[36:39], s52 offen lds
MAA 100,92,28
MAA 100,88,8
buffer_load_dwordx4 v28, s[36:39], s52 offen offset:1024 lds
MAA 96,88,4
TR 122,25,27424
MAA 96,92,24
TR 124,25,39328
MAA 92,92,20
TR 126,25,39840
MAA 92,88,0
buffer_load_dword v22, s[36:39], s52 offen offset:2048 lds
MAA 124,0,96
RD 40,23,18496
s_add_u32 s52, s52, 128
MAA 124,20,100
RD 44,23,20800
MAA 128,24,100
RD 48,23,23104
MAA 128,4,96
buffer_load_dwordx4 v[168:171], v26, s[16:19], s75 offen offset:1024 sc1
MAA 132,8,96
RD 52,23,25408
MAA 132,28,100
RD 56,24,18496
MAA 136,32,100
MAA 136,12,96
s_waitcnt vmcnt(17) lgkmcnt(5)
s_barrier
MAA 76,104,0
RD 60,30,18496
s_add_u32 m0, s56, 98816
MAA 76,108,20
buffer_load_dwordx4 v18, s[20:23], s54 offen lds
MAA 80,108,24
RD 64,30,20800
MAA 80,104,4
RD 68,30,23104
MAA 84,104,8
RD 72,30,25408
MAA 84,108,28
buffer_load_dwordx4 v19, s[20:23], s54 offen offset:1024 lds
MAA 88,108,32
RD 76,31,18496
MAA 88,104,12
buffer_load_dwordx4 v20, s[20:23], s54 offen offset:2048 lds
MAA 160,112,16
TR 80,25,49664
s_add_u32 s54, s54, 196608
MAA 160,116,36
TR 82,25,50176
MAA 120,116,32
TR 84,25,62080
s_add_u32 m0, s55, 2304
MAA 120,112,12
buffer_load_dwordx4 v21, s[36:39], s53 offen lds
MAA 116,112,8
TR 86,25,62592
MAA 116,116,28
TR 88,25,50688
MAA 112,116,24
TR 90,25,51200
MAA 112,112,4
buffer_load_dwordx4 v28, s[36:39], s53 offen offset:1024 lds
MAA 108,112,0
TR 92,25,63104
MAA 108,116,20
TR 94,25,63616
MAA 140,20,124
TR 96,25,51712
MAA 140,0,120
buffer_load_dword v29, s[36:39], s53 offen offset:2048 lds
MAA 144,4,120
TR 98,25,52224
s_add_u32 s53, s53, 128
MAA 144,24,124
buffer_load_dwordx4 v[172:175], v26, s[16:19], s75 offen offset:2048 sc1
MAA 148,28,124
TR 100,25,64128
MAA 148,8,120
TR 102,25,64640
MAA 152,12,120
MAA 152,32,124
s_waitcnt lgkmcnt(8)
s_barrier
MAA 60,80,40
TR 104,25,49696
s_add_u32 m0, s56, 111232
MAA 60,84,60
buffer_load_dwordx4 v18, s[20:23], s54 offen lds
MAA 64,84,64
s_sub_u32 s47, s47, 1
s_cbranch_scc1 .Lx15
.Lx15b:
MAA 64,80,44
TR 106,25,50208
MAA 68,80,48
TR 108,25,62112
MAA 68,84,68
buffer_load_dwordx4 v19, s[20:23], s54 offen offset:1024 lds
MAA 72,84,72
TR 110,25,62624
MAA 72,80,52
TR 112,25,50720
s_waitcnt lgkmcnt(5)
MAA 244,80,56
TR 114,25,51232
MAA 244,84,76
buffer_load_dwordx4 v20, s[20:23], s54 offen offset:2048 lds
MAA 156,92,76
TR 116,25,63136
s_add_u32 s54, s54, 196608
MAA 156,88,56
TR 118,25,63648
MAA 104,88,52
TR 120,25,51744
s_add_u32 m0, s55, 18496
MAA 104,92,72
buffer_load_dwordx4 v21, s[36:39], s52 offen lds
MAA 100,92,68
MAA 100,88,48
buffer_load_dwordx4 v28, s[36:39], s52 offen offset:1024 lds
MAA 96,88,44
TR 122,25,52256
MAA 96,92,64
TR 124,25,64160
MAA 92,92,60
TR 126,25,64672
MAA 92,88,40
buffer_load_dword v22, s[36:39], s52 offen offset:2048 lds
MAA 124,40,96
RD 0,23,36992
s_add_u32 s52, s52, 128
MAA 124,60,100
RD 4,23,39296
MAA 128,64,100
RD 8,23,41600
MAA 128,44,96
buffer_load_dwordx4 v[176:179], v26, s[16:19], s75 offen offset:3072 sc1
MAA 132,48,96
RD 12,23,43904
s_add_u32 s75, s75, 4096
MAA 132,68,100
RD 16,24,36992
MAA 136,72,100
MAA 136,52,96
s_waitcnt vmcnt(18) lgkmcnt(5)
s_barrier
MAA 76,104,40
RD 20,30,36992
s_add_u32 m0, s56, 123648
MAA 76,108,60
buffer_load_dwordx4 v18, s[20:23], s54 offen lds
MAA 80,108,64
RD 24,30,39296
s_waitcnt vmcnt(15)
v_add_f32 v164, v164, v168
MAA 80,104,44
RD 28,30,41600
MAA 84,104,48
RD 32,30,43904
MAA 84,108,68
buffer_load_dwordx4 v19, s[20:23], s54 offen offset:1024 lds
MAA 88,108,72
RD 36,31,36992
v_add_f32 v165, v165, v169
MAA 88,104,52
buffer_load_dwordx4 v20, s[20:23], s54 offen offset:2048 lds
MAA 160,112,56
ds_read_b64_tr_b16 a[80:81], v25
s_add_u32 s54, s54, 196608
MAA 160,116,76
TR 82,25,512
MAA 120,116,72
TR 84,25,12416
s_add_u32 m0, s55, 20800
MAA 120,112,52
buffer_load_dwordx4 v21, s[36:39], s53 offen lds
MAA 116,112,48
TR 86,25,12928
MAA 116,116,68
TR 88,25,1024
MAA 112,116,64
TR 90,25,1536
v_add_f32 v166, v166, v170
MAA 112,112,44
buffer_load_dwordx4 v28, s[36:39], s53 offen offset:1024 lds
MAA 108,112,40
TR 92,25,13440
MAA 108,116,60
TR 94,25,13952
MAA 140,60,124
TR 96,25,2048
MAA 140,40,120
buffer_load_dword v29, s[36:39], s53 offen offset:2048 lds
MAA 144,44,120
TR 98,25,2560
s_add_u32 s53, s53, 128
MAA 144,64,124
buffer_load_dwordx4 v[180:183], v26, s[16:19], s75 offen sc1
MAA 148,68,124
TR 100,25,14464
v_add_f32 v167, v167, v171
MAA 148,48,120
TR 102,25,14976
MAA 152,52,120
MAA 152,72,124
s_waitcnt lgkmcnt(8)
s_barrier
MAA 60,80,0
TR 104,25,32
s_add_u32 m0, s56, 136064
MAA 60,84,20
buffer_load_dwordx4 v18, s[20:23], s54 offen lds
MAA 64,84,24
s_sub_u32 s47, s47, 1
s_cbranch_scc1 .Lx16
.Lx16b:
MAA 64,80,4
TR 106,25,544
s_waitcnt vmcnt(15)
v_add_f32 v164, v164, v172
MAA 68,80,8
TR 108,25,12448
MAA 68,84,28
buffer_load_dwordx4 v19, s[20:23], s54 offen offset:1024 lds
MAA 72,84,32
TR 110,25,12960
MAA 72,80,12
TR 112,25,1056
s_waitcnt lgkmcnt(5)
MAA 244,80,16
TR 114,25,1568
MAA 244,84,36
buffer_load_dwordx4 v20, s[20:23], s54 offen offset:2048 lds
MAA 156,92,36
TR 116,25,13472
s_add_u32 s54, s54, 196608
MAA 156,88,16
TR 118,25,13984
v_add_f32 v165, v165, v173
MAA 104,88,12
TR 120,25,2080
s_add_u32 m0, s55, 36992
MAA 104,92,32
buffer_load_dwordx4 v21, s[36:39], s52 offen lds
MAA 100,92,28
MAA 100,88,8
buffer_load_dwordx4 v28, s[36:39], s52 offen offset:1024 lds
MAA 96,88,4
TR 122,25,2592
MAA 96,92,24
TR 124,25,14496
v_add_f32 v166, v166, v174
MAA 92,92,20
TR 126,25,15008
MAA 92,88,0
buffer_load_dword v22, s[36:39], s52 offen offset:2048 lds
MAA 124,0,96
RD 40,23,55488
s_add_u32 s52, s52, 128
MAA 124,20,100
RD 44,23,57792
MAA 128,24,100
RD 48,23,60096
MAA 128,4,96
buffer_load_dwordx4 v[184:187], v26, s[16:19], s75 offen offset:1024 sc1
MAA 132,8,96
RD 52,23,62400
v_add_f32 v167, v167, v175
MAA 132,28,100
RD 56,24,55488
MAA 136,32,100
MAA 136,12,96
s_waitcnt vmcnt(18) lgkmcnt(5)
s_barrier
MAA 76,104,0
RD 60,30,55488
s_add_u32 m0, s56, 73984
MAA 76,108,20
buffer_load_dwordx4 v18, s[20:23], s54 offen lds
MAA 80,108,24
RD 64,30,57792
s_waitcnt vmcnt(15)
v_add_f32 v164, v164, v176
MAA 80,104,4
RD 68,30,60096
v_add_f32 v165, v165, v177
MAA 84,104,8
buffer_load_dwordx4 v19, s[20:23], s54 offen offset:1024 lds
MAA 84,108,28
RD 72,30,62400
v_add_f32 v166, v166, v178
MAA 88,108,32
RD 76,31,55488
v_add_f32 v167, v167, v179
MAA 88,104,12
buffer_load_dwordx4 v20, s[20:23], s54 offen offset:2048 lds
MAA 160,112,16
TR 80,25,24832
s_add_u32 s54, s54, 196608
MAA 160,116,36
TR 82,25,25344
s_add_u32 m0, s55, 39296
MAA 120,116,32
buffer_load_dwordx4 v21, s[36:39], s53 offen lds
MAA 120,112,12
TR 84,25,37248
MAA 116,112,8
TR 86,25,37760
MAA 116,116,28
buffer_load_dwordx4 v28, s[36:39], s53 offen offset:1024 lds
MAA 112,116,24
TR 88,25,25856
MAA 112,112,4
TR 90,25,26368
MAA 108,112,0
buffer_load_dword v29, s[36:39], s53 offen offset:2048 lds
MAA 108,116,20
TR 92,25,38272
s_add_u32 s53, s53, 128
MAA 140,20,124
TR 94,25,38784
MAA 140,0,120
buffer_load_dwordx4 v[188:191], v26, s[16:19], s75 offen offset:2048 sc1
MAA 144,4,120
TR 96,25,26880
MAA 144,24,124
TR 98,25,27392
MAA 148,28,124
TR 100,25,39296
MAA 148,8,120
TR 102,25,39808
MAA 152,12,120
MAA 152,32,124
s_waitcnt lgkmcnt(8)
s_barrier
MAA 60,80,40
TR 104,25,24864
s_add_u32 m0, s56, 86400
MAA 60,84,60
buffer_load_dwordx4 v18, s[20:23], s54 offen lds
MAA 64,84,64
s_sub_u32 s47, s47, 1
s_cbranch_scc1 .Lx17
.Lx17b:
MAA 64,80,44
TR 106,25,25376
s_waitcnt vmcnt(15)
v_add_f32 v164, v164, v180
MAA 68,80,48
TR 108,25,37280
MAA 68,84,68
buffer_load_dwordx4 v19, s[20:23], s54 offen offset:1024 lds
MAA 72,84,72
TR 110,25,37792
MAA 72,80,52
TR 112,25,25888
s_waitcnt lgkmcnt(5)
MAA 244,80,56
TR 114,25,26400
MAA 244,84,76
buffer_load_dwordx4 v20, s[20:23], s54 offen offset:2048 lds
MAA 156,92,76
TR 116,25,38304
s_add_u32 s54, s54, 196608
MAA 156,88,56
TR 118,25,38816
v_add_f32 v165, v165, v181
MAA 104,88,52
TR 120,25,26912
s_add_u32 m0, s55, 55488
MAA 104,92,72
buffer_load_dwordx4 v21, s[36:39], s52 offen lds
MAA 100,92,68
MAA 100,88,48
buffer_load_dwordx4 v28, s[36:39], s52 offen offset:1024 lds
MAA 96,88,44
TR 122,25,27424
MAA 96,92,64
TR 124,25,39328
v_add_f32 v166, v166, v182
MAA 92,92,60
TR 126,25,39840
MAA 92,88,40
buffer_load_dword v22, s[36:39], s52 offen offset:2048 lds
MAA 124,40,96
ds_read_b128 a[0:3], v23
s_add_u32 s52, s52, 128
MAA 124,60,100
RD 4,23,2304
MAA 128,64,100
RD 8,23,4608
MAA 128,44,96
buffer_load_dwordx4 v[192:195], v26, s[16:19], s75 offen offset:3072 sc1
MAA 132,48,96
RD 12,23,6912
v_add_f32 v167, v167, v183
MAA 132,68,100
ds_read_b128 a[16:19], v24
MAA 136,72,100
MAA 136,52,96
s_waitcnt vmcnt(18) lgkmcnt(5)
s_barrier
MAA 76,104,40
ds_read_b128 a[20:23], v30
s_add_u32 m0, s56, 98816
MAA 76,108,60
buffer_load_dwordx4 v18, s[20:23], s54 offen lds
MAA 80,108,64
RD 24,30,2304
s_waitcnt vmcnt(15)
v_add_f32 v164, v164, v184
MAA 80,104,44
RD 28,30,4608
v_add_f32 v165, v165, v185
MAA 84,104,48
RD 32,30,6912
v_add_f32 v166, v166, v186
MAA 84,108,68
buffer_load_dwordx4 v19, s[20:23], s54 offen offset:1024 lds
MAA 88,108,72
ds_read_b128 a[36:39], v31
v_add_f32 v167, v167, v187
MAA 88,104,52
TR 80,25,49664
MAA 160,112,56
TR 82,25,50176
MAA 160,116,76
buffer_load_dwordx4 v20, s[20:23], s54 offen offset:2048 lds
MAA 120,116,72
TR 84,25,62080
s_add_u32 s54, s54, 196608
MAA 120,112,52
TR 86,25,62592
s_add_u32 m0, s55, 57792
MAA 116,112,48
TR 88,25,50688
MAA 116,116,68
buffer_load_dwordx4 v21, s[36:39], s53 offen lds
MAA 112,116,64
TR 90,25,51200
MAA 112,112,44
TR 92,25,63104
MAA 108,112,40
TR 94,25,63616
MAA 108,116,60
buffer_load_dwordx4 v28, s[36:39], s53 offen offset:1024 lds
MAA 140,60,124
TR 96,25,51712
MAA 140,40,120
TR 98,25,52224
MAA 144,44,120
TR 100,25,64128
MAA 144,64,124
buffer_load_dword v29, s[36:39], s53 offen offset:2048 lds
MAA 148,68,124
TR 102,25,64640
s_add_u32 s53, s53, 128
MAA 148,48,120
MAA 152,52,120
MAA 152,72,124
s_waitcnt lgkmcnt(8)
s_barrier
MAA 60,80,0
TR 104,25,49696
s_add_u32 m0, s56, 111232
MAA 60,84,20
buffer_load_dwordx4 v18, s[20:23], s54 offen lds
MAA 64,84,24
TR 106,25,50208
s_waitcnt vmcnt(14)
v_add_f32 v164, v164, v188
MAA 64,80,4
TR 108,25,62112
v_add_f32 v165, v165, v189
MAA 68,80,8
buffer_load_dwordx4 v19, s[20:23], s54 offen offset:1024 lds
MAA 68,84,28
TR 110,25,62624
v_add_f32 v166, v166, v190
MAA 72,84,32
TR 112,25,50720
v_add_f32 v167, v167, v191
MAA 72,80,12
buffer_load_dwordx4 v20, s[20:23], s54 offen offset:2048 lds
s_waitcnt lgkmcnt(5)
MAA 244,80,16
TR 114,25,51232
s_add_u32 s54, s54, 196608
MAA 244,84,36
TR 116,25,63136
s_add_u32 m0, s59, 0
MAA 156,92,36
TR 118,25,63648
s_xor_b32 s58, s87, 1048576
MAA 156,88,16
buffer_load_dwordx4 v5, s[24:27], s58 offen lds
MAA 104,88,12
TR 120,25,51744
MAA 104,92,32
TR 122,25,52256
MAA 100,92,28
buffer_load_dwordx4 v6, s[24:27], s58 offen offset:1024 lds
MAA 100,88,8
TR 124,25,64160
s_add_u32 m0, s59, 8320
MAA 96,88,4
TR 126,25,64672
s_xor_b32 s58, s87, 1179648
MAA 96,92,24
buffer_load_dwordx4 v5, s[24:27], s58 offen lds
MAA 92,92,20
RD 40,23,18496
MAA 92,88,0
RD 44,23,20800
MAA 124,0,96
buffer_load_dwordx4 v6, s[24:27], s58 offen offset:1024 lds
MAA 124,20,100
RD 48,23,23104
MAA 128,24,100
RD 52,23,25408
MAA 128,4,96
RD 56,24,18496
MAA 132,8,96
MAA 132,28,100
MAA 136,32,100
MAA 136,12,96
s_waitcnt vmcnt(17) lgkmcnt(5)
s_barrier
MAA 76,104,0
RD 60,30,18496
s_add_u32 m0, s56, 123648
MAA 76,108,20
buffer_load_dwordx4 v18, s[20:23], s54 offen lds
MAA 80,108,24
RD 64,30,20800
s_waitcnt vmcnt(14)
v_add_f32 v164, v164, v192
MAA 80,104,4
RD 68,30,23104
v_add_f32 v165, v165, v193
MAA 84,104,8
RD 72,30,25408
v_add_f32 v166, v166, v194
MAA 84,108,28
RD 76,31,18496
v_add_f32 v167, v167, v195
MAA 88,108,32
ds_read_b64_tr_b16 a[80:81], v25
MAA 88,104,12
TR 82,25,512
MAA 160,112,16
TR 84,25,12416
MAA 160,116,36
buffer_load_dwordx4 v19, s[20:23], s54 offen offset:1024 lds
MAA 120,116,32
TR 86,25,12928
MAA 120,112,12
TR 88,25,1024
MAA 116,112,8
TR 90,25,1536
MAA 116,116,28
TR 92,25,13440
MAA 112,116,24
TR 94,25,13952
MAA 112,112,4
TR 96,25,2048
MAA 108,112,0
TR 98,25,2560
MAA 108,116,20
buffer_load_dwordx4 v20, s[20:23], s54 offen offset:2048 lds
MAA 140,20,124
TR 100,25,14464
s_add_u32 s54, s54, 196608
MAA 140,0,120
TR 102,25,14976
MAA 144,4,120
MAA 144,24,124
MAA 148,28,124
MAA 148,8,120
MAA 152,12,120
MAA 152,32,124
s_waitcnt lgkmcnt(8)
s_barrier
MAA 60,80,40
TR 104,25,32
s_add_u32 m0, s56, 136064
MAA 60,84,60
buffer_load_dwordx4 v18, s[20:23], s54 offen lds
MAA 64,84,64
TR 106,25,544
MAA 64,80,44
TR 108,25,12448
MAA 68,80,48
buffer_load_dwordx4 v19, s[20:23], s54 offen offset:1024 lds
MAA 68,84,68
TR 110,25,12960
MAA 72,84,72
TR 112,25,1056
MAA 72,80,52
buffer_load_dwordx4 v20, s[20:23], s54 offen offset:2048 lds
s_waitcnt lgkmcnt(5)
MAA 244,80,56
TR 114,25,1568
s_add_u32 s54, s54, 196608
MAA 244,84,76
TR 116,25,13472
s_add_u32 m0, s59, 16640
MAA 156,92,76
TR 118,25,13984
s_xor_b32 s58, s87, 1310720
MAA 156,88,56
buffer_load_dwordx4 v5, s[24:27], s58 offen lds
MAA 104,88,52
TR 120,25,2080
MAA 104,92,72
TR 122,25,2592
MAA 100,92,68
buffer_load_dwordx4 v6, s[24:27], s58 offen offset:1024 lds
MAA 100,88,48
TR 124,25,14496
s_add_u32 m0, s59, 24960
MAA 96,88,44
TR 126,25,15008
s_xor_b32 s58, s87, 1441792
MAA 96,92,64
buffer_load_dwordx4 v5, s[24:27], s58 offen lds
MAA 92,92,60
RD 0,23,36992
MAA 92,88,40
RD 4,23,39296
MAA 124,40,96
buffer_load_dwordx4 v6, s[24:27], s58 offen offset:1024 lds
MAA 124,60,100
RD 8,23,41600
MAA 128,64,100
RD 12,23,43904
MAA 128,44,96
RD 16,24,36992
MAA 132,48,96
v_permlane32_swap_b32 v164, v166
MAA 132,68,100
v_permlane32_swap_b32 v165, v167
MAA 136,72,100
v_add_f32 v164, v164, v166
v_add_f32 v165, v165, v167
MAA 136,52,96
v_mul_f32 v164, 0xba800000, v164
v_mul_f32 v165, 0x3a800000, v165
v_fma_f32 v165, -v164, v164, v165
v_max_f32 v165, 0, v165
v_add_f32 v165, 0x3727c5ac, v165
v_rsq_f32 v166, v165
s_nop 0
v_mov_b32 v165, v166
v_mul_f32 v166, 0x3e8293ee, v166
s_waitcnt vmcnt(14) lgkmcnt(5)
s_barrier
MAA 76,104,40
ds_write_b128 v7, v[164:167]
s_add_u32 m0, s59, 74880
MAA 76,108,60
ds_write_b32 v17, v164
s_xor_b32 s58, s87, 131072
MAA 80,108,64
ds_write_b32 v17, v165 offset:1024
MAA 80,104,44
buffer_load_dwordx4 v5, s[24:27], s58 offen lds
MAA 84,104,48
RD 20,30,36992
MAA 84,108,68
RD 24,30,39296
MAA 88,108,72
RD 28,30,41600
MAA 88,104,52
RD 32,30,43904
MAA 160,112,56
RD 36,31,36992
MAA 160,116,76
buffer_load_dwordx4 v6, s[24:27], s58 offen offset:1024 lds
MAA 120,116,72
TR 80,25,24832
s_add_u32 m0, s59, 83200
MAA 120,112,52
TR 82,25,25344
s_xor_b32 s58, s87, 262144
MAA 116,112,48
TR 84,25,37248
MAA 116,116,68
TR 86,25,37760
MAA 112,116,64
TR 88,25,25856
MAA 112,112,44
buffer_load_dwordx4 v5, s[24:27], s58 offen lds
MAA 108,112,40
TR 90,25,26368
MAA 108,116,60
TR 92,25,38272
MAA 140,60,124
TR 94,25,38784
MAA 140,40,120
TR 96,25,26880
MAA 144,44,120
TR 98,25,27392
MAA 144,64,124
buffer_load_dwordx4 v6, s[24:27], s58 offen offset:1024 lds
MAA 148,68,124
TR 100,25,39296
MAA 148,48,120
TR 102,25,39808
MAA 152,52,120
MAA 152,72,124
s_waitcnt vmcnt(8) lgkmcnt(0)
s_barrier
MAA 156,88,16
TR 112,25,25888
s_add_u32 m0, s59, 33280
MAA 156,92,36
TR 114,25,26400
s_xor_b32 s58, s87, 1572864
MAA 104,92,32
buffer_load_dwordx4 v5, s[24:27], s58 offen lds
MAA 104,88,12
TR 116,25,38304
MAA 100,88,8
TR 118,25,38816
MAA 100,92,28
TR 120,25,26912
MAA 96,92,24
buffer_load_dwordx4 v6, s[24:27], s58 offen offset:1024 lds
MAA 96,88,4
TR 122,25,27424
s_add_u32 m0, s59, 41600
MAA 92,88,0
TR 124,25,39328
s_xor_b32 s58, s87, 1703936
MAA 92,92,20
TR 126,25,39840
MAA 136,32,100
buffer_load_dwordx4 v5, s[24:27], s58 offen lds
MAA 136,12,96
TR 104,25,24864
MAA 244,80,16
TR 106,25,25376
MAA 244,84,36
TR 108,25,37280
MAA 72,84,32
buffer_load_dwordx4 v6, s[24:27], s58 offen offset:1024 lds
MAA 72,80,12
TR 110,25,37792
s_xor_b32 s58, s87, 393216
MAA 68,80,8
RD 40,23,55488
MAA 68,84,28
RD 44,23,57792
MAA 64,84,24
RD 48,23,60096
MAA 64,80,4
RD 52,23,62400
MAA 60,80,0
RD 56,24,55488
MAA 60,84,20
RD 60,30,55488
s_waitcnt lgkmcnt(15)
MAA 160,112,16
RD 64,30,57792
s_waitcnt lgkmcnt(15)
MAA 160,116,36
s_waitcnt lgkmcnt(7)
s_barrier
RD 68,30,60096
MAA 120,116,32
RD 72,30,62400
s_add_u32 m0, s59, 91520
MAA 120,112,12
RD 76,31,55488
MAA 116,112,8
TR 144,25,50688
MAA 116,116,28
TR 146,25,51200
MAA 112,116,24
TR 148,25,63104
MAA 112,112,4
TR 150,25,63616
MAA 108,112,0
TR 152,25,50720
MAA 108,116,20
TR 154,25,51232
MAA 152,32,124
TR 156,25,63136
MAA 152,12,120
TR 158,25,63648
MAA 88,104,12
TR 160,25,51712
MAA 88,108,32
TR 162,25,52224
MAA 84,108,28
TR 164,25,64128
MAA 84,104,8
TR 166,25,64640
MAA 80,104,4
TR 168,25,51744
MAA 80,108,24
TR 170,25,52256
MAA 76,108,20
TR 172,25,64160
MAA 76,104,0
TR 174,25,64672
s_waitcnt lgkmcnt(14)
MAA 156,144,56
TR 128,25,49664
s_waitcnt lgkmcnt(13)
MAA 156,148,76
TR 130,25,50176
MAA 104,148,72
TR 132,25,62080
MAA 104,144,52
TR 134,25,62592
MAA 100,144,48
TR 136,25,49696
MAA 100,148,68
TR 138,25,50208
MAA 96,148,64
TR 140,25,62112
MAA 96,144,44
TR 142,25,62624
MAA 92,144,40
ds_read_b128 v[232:235], v10 offset:768
MAA 92,148,60
ds_read_b128 v[236:239], v10 offset:2816
s_waitcnt lgkmcnt(15)
MAA 160,156,76
ds_read_b128 v[228:231], v10 offset:512
MAA 160,152,56
ds_read_b128 v[224:227], v10 offset:256
MAA 120,152,52
ds_read_b128 v[220:223], v10
MAA 120,156,72
buffer_load_dwordx4 v5, s[24:27], s58 offen lds
MAA 116,156,68
MAA 116,152,48
s_waitcnt lgkmcnt(5)
s_barrier
MAA 112,152,44
MAA 112,156,64
buffer_load_dwordx4 v6, s[24:27], s58 offen offset:1024 lds
MAA 108,156,60
s_add_u32 m0, s59, 99840
s_xor_b32 s58, s87, 524288
MAA 108,152,40
MAA 136,52,160
MAA 136,72,164
buffer_load_dwordx4 v5, s[24:27], s58 offen lds
MAA 152,72,172
MAA 152,52,168
MAA 244,128,56
MAA 244,132,76
buffer_load_dwordx4 v6, s[24:27], s58 offen offset:1024 lds
MAA 72,132,72
s_add_u32 m0, s59, 108160
s_xor_b32 s58, s87, 655360
MAA 72,128,52
MAA 68,128,48
MAA 68,132,68
buffer_load_dwordx4 v5, s[24:27], s58 offen lds
buffer_load_dwordx4 v6, s[24:27], s58 offen offset:1024 lds
s_mov_b32 exec_lo, 0x10001
s_mov_b32 exec_hi, 0x10001
ds_write_b128 v13, v[244:247]
ds_write_b128 v13, v[156:159] offset:256
ds_write_b128 v13, v[160:163] offset:320
s_mov_b64 exec, -1
MAA 64,128,44
MAA 64,132,64
MAA 60,132,60
MAA 60,128,40
MAA 88,136,52
MAA 88,140,72
s_waitcnt lgkmcnt(0)
s_barrier
MAA 84,136,48
ds_read_b128 v[28:31], v13
s_add_u32 m0, s59, 49920
MAA 84,140,68
ds_read_b128 v[32:35], v13 offset:64
s_xor_b32 s58, s87, 1835008
MAA 80,140,64
ds_read_b128 v[36:39], v13 offset:256
MAA 80,136,44
ds_read_b128 v[40:43], v13 offset:320
MAA 76,136,40
ds_read_b32 v44, v12 offset:512
MAA 76,140,60
ds_read_b32 v45, v12 offset:576
ds_read_b128 v[240:243], v11 offset:192
ds_read_b128 v[244:247], v11 offset:1216
ds_read_b128 v[18:21], v11 offset:128
ds_read_b128 v[22:25], v11 offset:1152
buffer_load_dwordx4 v5, s[24:27], s58 offen lds
s_waitcnt lgkmcnt(9)
v_pk_fma_f32 v[72:73], v[28:29], v[232:233], v[72:73] op_sel_hi:[1,0,1]
v_cvt_pk_bf16_f32 v176, v72, v73
v_pk_fma_f32 v[74:75], v[30:31], v[232:233], v[74:75] op_sel_hi:[1,0,1]
v_cvt_pk_bf16_f32 v177, v74, v75
s_waitcnt lgkmcnt(8)
v_pk_fma_f32 v[88:89], v[32:33], v[232:233], v[88:89] op_sel_hi:[1,0,1]
v_cvt_pk_bf16_f32 v178, v88, v89
v_pk_fma_f32 v[90:91], v[34:35], v[232:233], v[90:91] op_sel_hi:[1,0,1]
s_waitcnt lgkmcnt(7)
v_pk_fma_f32 v[104:105], v[36:37], v[232:233], v[104:105] op_sel_hi:[1,0,1]
v_pk_mul_f32 v[104:105], v[104:105], v[232:233] op_sel:[0,1] op_sel_hi:[1,1]
v_cvt_pk_bf16_f32 v196, v104, v105
v_pk_fma_f32 v[106:107], v[38:39], v[232:233], v[106:107] op_sel_hi:[1,0,1]
v_pk_mul_f32 v[106:107], v[106:107], v[232:233] op_sel:[0,1] op_sel_hi:[1,1]
v_cvt_pk_bf16_f32 v197, v106, v107
s_waitcnt lgkmcnt(6)
v_pk_fma_f32 v[120:121], v[40:41], v[232:233], v[120:121] op_sel_hi:[1,0,1]
v_pk_mul_f32 v[120:121], v[120:121], v[232:233] op_sel:[0,1] op_sel_hi:[1,1]
v_cvt_pk_bf16_f32 v198, v120, v121
v_pk_fma_f32 v[122:123], v[42:43], v[232:233], v[122:123] op_sel_hi:[1,0,1]
v_pk_mul_f32 v[122:123], v[122:123], v[232:233] op_sel:[0,1] op_sel_hi:[1,1]
v_cvt_pk_bf16_f32 v199, v122, v123
ds_write_b128 v8, v[196:199]
s_waitcnt lgkmcnt(4)
v_pk_fma_f32 v[136:137], v[240:241], v[44:45], v[136:137] op_sel_hi:[1,0,1]
v_pk_fma_f32 v[138:139], v[242:243], v[44:45], v[138:139] op_sel_hi:[1,0,1]
s_waitcnt lgkmcnt(3)
v_pk_mul_f32 v[136:137], v[136:137], v[244:245]
v_cvt_pk_bf16_f32 v208, v136, v137
v_pk_mul_f32 v[138:139], v[138:139], v[246:247]
v_cvt_pk_bf16_f32 v209, v138, v139
v_pk_fma_f32 v[152:153], v[240:241], v[44:45], v[152:153] op_sel:[0,1,0] op_sel_hi:[1,1,1]
v_pk_mul_f32 v[152:153], v[152:153], v[244:245]
v_cvt_pk_bf16_f32 v218, v152, v153
v_pk_fma_f32 v[154:155], v[242:243], v[44:45], v[154:155] op_sel:[0,1,0] op_sel_hi:[1,1,1]
v_pk_mul_f32 v[154:155], v[154:155], v[246:247]
v_cvt_pk_bf16_f32 v219, v154, v155
ds_write_b64 v8, v[208:209] offset:1024
ds_write_b64 v8, v[218:219] offset:1032
v_pk_fma_f32 v[156:157], v[36:37], v[236:237], v[156:157] op_sel_hi:[1,0,1]
v_pk_mul_f32 v[156:157], v[156:157], v[236:237] op_sel:[0,1] op_sel_hi:[1,1]
v_cvt_pk_bf16_f32 v180, v156, v157
v_pk_fma_f32 v[158:159], v[38:39], v[236:237], v[158:159] op_sel_hi:[1,0,1]
v_pk_mul_f32 v[158:159], v[158:159], v[236:237] op_sel:[0,1] op_sel_hi:[1,1]
v_cvt_pk_bf16_f32 v181, v158, v159
v_pk_fma_f32 v[160:161], v[40:41], v[236:237], v[160:161] op_sel_hi:[1,0,1]
v_pk_mul_f32 v[160:161], v[160:161], v[236:237] op_sel:[0,1] op_sel_hi:[1,1]
v_cvt_pk_bf16_f32 v182, v160, v161
v_pk_fma_f32 v[162:163], v[42:43], v[236:237], v[162:163] op_sel_hi:[1,0,1]
v_pk_mul_f32 v[162:163], v[162:163], v[236:237] op_sel:[0,1] op_sel_hi:[1,1]
v_cvt_pk_bf16_f32 v183, v162, v163
v_pk_fma_f32 v[100:101], v[36:37], v[228:229], v[100:101] op_sel_hi:[1,0,1]
v_pk_mul_f32 v[100:101], v[100:101], v[228:229] op_sel:[0,1] op_sel_hi:[1,1]
v_cvt_pk_bf16_f32 v192, v100, v101
v_pk_fma_f32 v[102:103], v[38:39], v[228:229], v[102:103] op_sel_hi:[1,0,1]
v_pk_mul_f32 v[102:103], v[102:103], v[228:229] op_sel:[0,1] op_sel_hi:[1,1]
v_cvt_pk_bf16_f32 v193, v102, v103
v_pk_fma_f32 v[116:117], v[40:41], v[228:229], v[116:117] op_sel_hi:[1,0,1]
v_pk_mul_f32 v[116:117], v[116:117], v[228:229] op_sel:[0,1] op_sel_hi:[1,1]
v_cvt_pk_bf16_f32 v194, v116, v117
v_pk_fma_f32 v[118:119], v[42:43], v[228:229], v[118:119] op_sel_hi:[1,0,1]
v_pk_mul_f32 v[118:119], v[118:119], v[228:229] op_sel:[0,1] op_sel_hi:[1,1]
v_cvt_pk_bf16_f32 v195, v118, v119
v_pk_fma_f32 v[96:97], v[36:37], v[224:225], v[96:97] op_sel_hi:[1,0,1]
v_pk_mul_f32 v[96:97], v[96:97], v[224:225] op_sel:[0,1] op_sel_hi:[1,1]
v_cvt_pk_bf16_f32 v188, v96, v97
v_pk_fma_f32 v[98:99], v[38:39], v[224:225], v[98:99] op_sel_hi:[1,0,1]
v_pk_mul_f32 v[98:99], v[98:99], v[224:225] op_sel:[0,1] op_sel_hi:[1,1]
v_cvt_pk_bf16_f32 v189, v98, v99
s_waitcnt lgkmcnt(0)
s_barrier
ds_read_b64 v[200:201], v9 offset:1024
ds_read_b64 v[210:211], v9 offset:1032
v_pk_fma_f32 v[112:113], v[40:41], v[224:225], v[112:113] op_sel_hi:[1,0,1]
v_pk_mul_f32 v[112:113], v[112:113], v[224:225] op_sel:[0,1] op_sel_hi:[1,1]
v_cvt_pk_bf16_f32 v190, v112, v113
v_pk_fma_f32 v[114:115], v[42:43], v[224:225], v[114:115] op_sel_hi:[1,0,1]
v_pk_mul_f32 v[114:115], v[114:115], v[224:225] op_sel:[0,1] op_sel_hi:[1,1]
v_cvt_pk_bf16_f32 v191, v114, v115
v_pk_fma_f32 v[92:93], v[36:37], v[220:221], v[92:93] op_sel_hi:[1,0,1]
v_pk_mul_f32 v[92:93], v[92:93], v[220:221] op_sel:[0,1] op_sel_hi:[1,1]
v_cvt_pk_bf16_f32 v184, v92, v93
v_pk_fma_f32 v[94:95], v[38:39], v[220:221], v[94:95] op_sel_hi:[1,0,1]
v_pk_mul_f32 v[94:95], v[94:95], v[220:221] op_sel:[0,1] op_sel_hi:[1,1]
v_cvt_pk_bf16_f32 v185, v94, v95
v_pk_fma_f32 v[108:109], v[40:41], v[220:221], v[108:109] op_sel_hi:[1,0,1]
v_pk_mul_f32 v[108:109], v[108:109], v[220:221] op_sel:[0,1] op_sel_hi:[1,1]
v_cvt_pk_bf16_f32 v186, v108, v109
v_pk_fma_f32 v[110:111], v[42:43], v[220:221], v[110:111] op_sel_hi:[1,0,1]
v_pk_mul_f32 v[110:111], v[110:111], v[220:221] op_sel:[0,1] op_sel_hi:[1,1]
v_cvt_pk_bf16_f32 v187, v110, v111
v_cvt_pk_bf16_f32 v179, v90, v91
v_pk_fma_f32 v[68:69], v[28:29], v[228:229], v[68:69] op_sel_hi:[1,0,1]
v_cvt_pk_bf16_f32 v172, v68, v69
v_pk_fma_f32 v[70:71], v[30:31], v[228:229], v[70:71] op_sel_hi:[1,0,1]
v_cvt_pk_bf16_f32 v173, v70, v71
v_pk_fma_f32 v[84:85], v[32:33], v[228:229], v[84:85] op_sel_hi:[1,0,1]
v_cvt_pk_bf16_f32 v174, v84, v85
v_pk_fma_f32 v[86:87], v[34:35], v[228:229], v[86:87] op_sel_hi:[1,0,1]
v_cvt_pk_bf16_f32 v175, v86, v87
v_pk_fma_f32 v[64:65], v[28:29], v[224:225], v[64:65] op_sel_hi:[1,0,1]
v_cvt_pk_bf16_f32 v168, v64, v65
v_pk_fma_f32 v[66:67], v[30:31], v[224:225], v[66:67] op_sel_hi:[1,0,1]
v_cvt_pk_bf16_f32 v169, v66, v67
v_pk_fma_f32 v[80:81], v[32:33], v[224:225], v[80:81] op_sel_hi:[1,0,1]
v_cvt_pk_bf16_f32 v170, v80, v81
v_pk_fma_f32 v[82:83], v[34:35], v[224:225], v[82:83] op_sel_hi:[1,0,1]
v_cvt_pk_bf16_f32 v171, v82, v83
v_pk_fma_f32 v[60:61], v[28:29], v[220:221], v[60:61] op_sel_hi:[1,0,1]
v_cvt_pk_bf16_f32 v164, v60, v61
v_pk_fma_f32 v[62:63], v[30:31], v[220:221], v[62:63] op_sel_hi:[1,0,1]
v_cvt_pk_bf16_f32 v165, v62, v63
v_pk_fma_f32 v[76:77], v[32:33], v[220:221], v[76:77] op_sel_hi:[1,0,1]
v_cvt_pk_bf16_f32 v166, v76, v77
v_pk_fma_f32 v[78:79], v[34:35], v[220:221], v[78:79] op_sel_hi:[1,0,1]
v_cvt_pk_bf16_f32 v167, v78, v79
s_nop 0
v_mfma_f32_16x16x32_bf16 v[120:123], v[196:199], v[176:179], v[50:53]
buffer_load_dwordx4 v6, s[24:27], s58 offen offset:1024 lds
v_mfma_f32_16x16x32_bf16 v[104:107], v[192:195], v[176:179], v[46:49]
ds_read_b128 v[240:243], v11 offset:64
s_add_u32 m0, s59, 58240
v_mfma_f32_16x16x32_bf16 v[116:119], v[192:195], v[172:175], v[50:53]
ds_read_b128 v[244:247], v11 offset:1088
s_xor_b32 s58, s87, 1966080
v_mfma_f32_16x16x32_bf16 v[100:103], v[188:191], v[172:175], v[46:49]
ds_read_b128 v[28:31], v11
v_mfma_f32_16x16x32_bf16 v[112:115], v[188:191], v[168:171], v[50:53]
buffer_load_dwordx4 v5, s[24:27], s58 offen lds
v_mfma_f32_16x16x32_bf16 v[96:99], v[184:187], v[168:171], v[46:49]
ds_read_b128 v[32:35], v11 offset:1024
v_max3_f32 v88, v104, v105, v106
v_mfma_f32_16x16x32_bf16 v[108:111], v[184:187], v[164:167], v[50:53]
v_max3_f32 v89, v107, v120, v121
v_max3_f32 v88, v88, v122, v123
v_mfma_f32_16x16x32_bf16 v[92:95], v[180:183], v[164:167], v[54:57]
v_max_f32 v90, v88, v89
v_max_f32 v89, v88, v89
MAA 132,8,96
buffer_load_dwordx4 v6, s[24:27], s58 offen offset:1024 lds
MAA 132,28,100
s_add_u32 m0, s59, 66560
s_xor_b32 s58, s87, 0
v_permlane16_swap_b32 v90, v89
MAA 132,48,160
v_max_f32 v88, v90, v89
v_max_f32 v89, v90, v89
MAA 132,68,164
s_nop 0
v_permlane32_swap_b32 v88, v89
MAA 148,68,172
buffer_load_dwordx4 v5, s[24:27], s58 offen lds
MAA 148,48,168
v_max_f32 v88, v88, v89
v_mul_f32 v88, v88, v234
MAA 148,28,124
v_max3_f32 v84, v100, v101, v102
v_max3_f32 v85, v103, v116, v117
MAA 148,8,120
v_max3_f32 v84, v84, v118, v119
v_max_f32 v86, v84, v85
v_max_f32 v85, v84, v85
v_max3_f32 v80, v96, v97, v98
v_max3_f32 v81, v99, v112, v113
v_permlane16_swap_b32 v86, v85
v_max3_f32 v80, v80, v114, v115
v_max_f32 v84, v86, v85
v_max_f32 v85, v86, v85
v_max_f32 v82, v80, v81
v_max_f32 v81, v80, v81
v_permlane32_swap_b32 v84, v85
v_max3_f32 v76, v92, v93, v94
v_max_f32 v84, v84, v85
v_mul_f32 v84, v84, v230
v_permlane16_swap_b32 v82, v81
v_max3_f32 v77, v95, v108, v109
v_max_f32 v80, v82, v81
v_max_f32 v81, v82, v81
v_max3_f32 v76, v76, v110, v111
v_max_f32 v78, v76, v77
v_permlane32_swap_b32 v80, v81
v_max_f32 v77, v76, v77
v_max_f32 v80, v80, v81
v_mul_f32 v80, v80, v226
v_permlane16_swap_b32 v78, v77
v_pk_fma_f32 v[104:105], v[104:105], v[234:235], v[88:89] op_sel_hi:[1,0,0] neg_lo:[0,0,1] neg_hi:[0,0,1]
v_max_f32 v76, v78, v77
v_max_f32 v77, v78, v77
v_pk_fma_f32 v[106:107], v[106:107], v[234:235], v[88:89] op_sel_hi:[1,0,0] neg_lo:[0,0,1] neg_hi:[0,0,1]
v_pk_fma_f32 v[120:121], v[120:121], v[234:235], v[88:89] op_sel_hi:[1,0,0] neg_lo:[0,0,1] neg_hi:[0,0,1]
v_permlane32_swap_b32 v76, v77
v_pk_fma_f32 v[122:123], v[122:123], v[234:235], v[88:89] op_sel_hi:[1,0,0] neg_lo:[0,0,1] neg_hi:[0,0,1]
v_max_f32 v76, v76, v77
v_mul_f32 v76, v76, v222
v_pk_fma_f32 v[100:101], v[100:101], v[230:231], v[84:85] op_sel_hi:[1,0,0] neg_lo:[0,0,1] neg_hi:[0,0,1]
v_pk_fma_f32 v[102:103], v[102:103], v[230:231], v[84:85] op_sel_hi:[1,0,0] neg_lo:[0,0,1] neg_hi:[0,0,1]
v_pk_fma_f32 v[116:117], v[116:117], v[230:231], v[84:85] op_sel_hi:[1,0,0] neg_lo:[0,0,1] neg_hi:[0,0,1]
v_pk_fma_f32 v[118:119], v[118:119], v[230:231], v[84:85] op_sel_hi:[1,0,0] neg_lo:[0,0,1] neg_hi:[0,0,1]
v_pk_fma_f32 v[96:97], v[96:97], v[226:227], v[80:81] op_sel_hi:[1,0,0] neg_lo:[0,0,1] neg_hi:[0,0,1]
v_pk_fma_f32 v[98:99], v[98:99], v[226:227], v[80:81] op_sel_hi:[1,0,0] neg_lo:[0,0,1] neg_hi:[0,0,1]
v_pk_fma_f32 v[112:113], v[112:113], v[226:227], v[80:81] op_sel_hi:[1,0,0] neg_lo:[0,0,1] neg_hi:[0,0,1]
v_pk_fma_f32 v[114:115], v[114:115], v[226:227], v[80:81] op_sel_hi:[1,0,0] neg_lo:[0,0,1] neg_hi:[0,0,1]
v_pk_fma_f32 v[92:93], v[92:93], v[222:223], v[76:77] op_sel_hi:[1,0,0] neg_lo:[0,0,1] neg_hi:[0,0,1]
v_pk_fma_f32 v[94:95], v[94:95], v[222:223], v[76:77] op_sel_hi:[1,0,0] neg_lo:[0,0,1] neg_hi:[0,0,1]
v_pk_fma_f32 v[108:109], v[108:109], v[222:223], v[76:77] op_sel_hi:[1,0,0] neg_lo:[0,0,1] neg_hi:[0,0,1]
v_pk_fma_f32 v[110:111], v[110:111], v[222:223], v[76:77] op_sel_hi:[1,0,0] neg_lo:[0,0,1] neg_hi:[0,0,1]
v_pk_fma_f32 v[132:133], v[18:19], v[44:45], v[132:133] op_sel_hi:[1,0,1]
v_pk_mul_f32 v[132:133], v[132:133], v[22:23]
v_pk_fma_f32 v[134:135], v[20:21], v[44:45], v[134:135] op_sel_hi:[1,0,1]
v_pk_mul_f32 v[134:135], v[134:135], v[24:25]
v_pk_fma_f32 v[148:149], v[18:19], v[44:45], v[148:149] op_sel:[0,1,0] op_sel_hi:[1,1,1]
v_pk_mul_f32 v[148:149], v[148:149], v[22:23]
v_pk_fma_f32 v[150:151], v[20:21], v[44:45], v[150:151] op_sel:[0,1,0] op_sel_hi:[1,1,1]
v_pk_mul_f32 v[150:151], v[150:151], v[24:25]
v_exp_f32 v104, v104
s_nop 0
MAA 128,4,96
buffer_load_dwordx4 v6, s[24:27], s58 offen offset:1024 lds
MAA 128,24,100
s_add_u32 m0, s59, 116480
s_xor_b32 s58, s87, 786432
v_exp_f32 v105, v105
MAA 128,44,160
v_exp_f32 v106, v106
MAA 128,64,164
v_exp_f32 v107, v107
MAA 144,64,172
buffer_load_dwordx4 v5, s[24:27], s58 offen lds
MAA 144,44,168
v_exp_f32 v120, v120
MAA 144,24,124
v_exp_f32 v121, v121
MAA 144,4,120
v_exp_f32 v122, v122
MAA 124,0,96
buffer_load_dwordx4 v6, s[24:27], s58 offen offset:1024 lds
MAA 124,20,100
s_add_u32 m0, s59, 124800
s_xor_b32 s58, s87, 917504
v_exp_f32 v123, v123
MAA 124,40,160
v_exp_f32 v100, v100
MAA 124,60,164
v_exp_f32 v101, v101
MAA 140,60,172
buffer_load_dwordx4 v5, s[24:27], s58 offen lds
MAA 140,40,168
v_exp_f32 v102, v102
MAA 140,20,124
v_exp_f32 v103, v103
MAA 140,0,120
v_cvt_pk_bf16_f32 v72, v104, v105
v_cvt_pk_bf16_f32 v73, v106, v107
v_cvt_pk_bf16_f32 v74, v120, v121
v_cvt_pk_bf16_f32 v75, v122, v123
v_exp_f32 v116, v116
v_exp_f32 v117, v117
v_exp_f32 v118, v118
v_exp_f32 v119, v119
v_cvt_pk_bf16_f32 v68, v100, v101
v_cvt_pk_bf16_f32 v69, v102, v103
v_cvt_pk_bf16_f32 v70, v116, v117
v_cvt_pk_bf16_f32 v71, v118, v119
v_exp_f32 v96, v96
v_exp_f32 v97, v97
v_exp_f32 v98, v98
v_exp_f32 v99, v99
v_exp_f32 v112, v112
v_exp_f32 v113, v113
v_exp_f32 v114, v114
v_exp_f32 v115, v115
v_cvt_pk_bf16_f32 v64, v96, v97
v_cvt_pk_bf16_f32 v65, v98, v99
v_cvt_pk_bf16_f32 v66, v112, v113
v_cvt_pk_bf16_f32 v67, v114, v115
v_cvt_pk_bf16_f32 v206, v132, v133
v_cvt_pk_bf16_f32 v207, v134, v135
v_cvt_pk_bf16_f32 v216, v148, v149
v_cvt_pk_bf16_f32 v217, v150, v151
s_waitcnt lgkmcnt(3)
v_pk_fma_f32 v[128:129], v[240:241], v[44:45], v[128:129] op_sel_hi:[1,0,1]
s_waitcnt lgkmcnt(2)
v_pk_mul_f32 v[128:129], v[128:129], v[244:245]
v_cvt_pk_bf16_f32 v204, v128, v129
v_pk_fma_f32 v[130:131], v[242:243], v[44:45], v[130:131] op_sel_hi:[1,0,1]
v_pk_mul_f32 v[130:131], v[130:131], v[246:247]
v_cvt_pk_bf16_f32 v205, v130, v131
v_pk_fma_f32 v[144:145], v[240:241], v[44:45], v[144:145] op_sel:[0,1,0] op_sel_hi:[1,1,1]
v_pk_mul_f32 v[144:145], v[144:145], v[244:245]
v_cvt_pk_bf16_f32 v214, v144, v145
v_pk_fma_f32 v[146:147], v[242:243], v[44:45], v[146:147] op_sel:[0,1,0] op_sel_hi:[1,1,1]
v_pk_mul_f32 v[146:147], v[146:147], v[246:247]
v_cvt_pk_bf16_f32 v215, v146, v147
s_waitcnt lgkmcnt(1)
v_pk_fma_f32 v[124:125], v[28:29], v[44:45], v[124:125] op_sel_hi:[1,0,1]
s_waitcnt lgkmcnt(0)
v_pk_mul_f32 v[124:125], v[124:125], v[32:33]
v_cvt_pk_bf16_f32 v202, v124, v125
v_pk_fma_f32 v[126:127], v[30:31], v[44:45], v[126:127] op_sel_hi:[1,0,1]
v_pk_mul_f32 v[126:127], v[126:127], v[34:35]
v_cvt_pk_bf16_f32 v203, v126, v127
v_pk_fma_f32 v[140:141], v[28:29], v[44:45], v[140:141] op_sel:[0,1,0] op_sel_hi:[1,1,1]
v_pk_mul_f32 v[140:141], v[140:141], v[32:33]
v_cvt_pk_bf16_f32 v212, v140, v141
v_pk_fma_f32 v[142:143], v[30:31], v[44:45], v[142:143] op_sel:[0,1,0] op_sel_hi:[1,1,1]
v_pk_mul_f32 v[142:143], v[142:143], v[34:35]
v_cvt_pk_bf16_f32 v213, v142, v143
s_nop 0
v_mfma_f32_16x16x32_bf16 v[88:91], v[248:251], v[72:75], 0
buffer_load_dwordx4 v6, s[24:27], s58 offen offset:1024 lds
v_mfma_f32_16x16x32_bf16 v[104:107], v[206:209], v[72:75], 0
v_exp_f32 v92, v92
v_mfma_f32_16x16x32_bf16 v[120:123], v[216:219], v[72:75], 0
v_exp_f32 v93, v93
v_mfma_f32_16x16x32_bf16 v[84:87], v[248:251], v[68:71], 0
v_exp_f32 v94, v94
v_mfma_f32_16x16x32_bf16 v[100:103], v[204:207], v[68:71], 0
v_exp_f32 v95, v95
v_mfma_f32_16x16x32_bf16 v[116:119], v[214:217], v[68:71], 0
v_exp_f32 v108, v108
v_mfma_f32_16x16x32_bf16 v[80:83], v[248:251], v[64:67], 0
v_exp_f32 v109, v109
v_mfma_f32_16x16x32_bf16 v[96:99], v[202:205], v[64:67], 0
v_exp_f32 v110, v110
v_mfma_f32_16x16x32_bf16 v[112:115], v[212:215], v[64:67], 0
v_exp_f32 v111, v111
v_cvt_pk_bf16_f32 v60, v92, v93
v_cvt_pk_bf16_f32 v61, v94, v95
v_cvt_pk_bf16_f32 v62, v108, v109
v_cvt_pk_bf16_f32 v63, v110, v111
v_rcp_f32 v88, v88
v_rcp_f32 v84, v84
v_mfma_f32_16x16x32_bf16 v[76:79], v[248:251], v[60:63], 0
v_rcp_f32 v80, v80
v_mfma_f32_16x16x32_bf16 v[92:95], v[200:203], v[60:63], 0
v_mfma_f32_16x16x32_bf16 v[108:111], v[210:213], v[60:63], 0
s_nop 4
v_rcp_f32 v76, v76
v_pk_mul_f32 v[104:105], v[104:105], v[88:89] op_sel_hi:[1,0]
v_pk_mul_f32 v[106:107], v[106:107], v[88:89] op_sel_hi:[1,0]
v_pk_mul_f32 v[120:121], v[120:121], v[88:89] op_sel_hi:[1,0]
v_pk_mul_f32 v[122:123], v[122:123], v[88:89] op_sel_hi:[1,0]
v_cvt_pk_bf16_f32 v176, v104, v105
v_cvt_pk_bf16_f32 v177, v106, v107
v_cvt_pk_bf16_f32 v178, v120, v121
v_cvt_pk_bf16_f32 v179, v122, v123
buffer_store_dwordx4 v[176:179], v4, s[16:19], s74 offen offset:3072 sc1
v_pk_mul_f32 v[100:101], v[100:101], v[84:85] op_sel_hi:[1,0]
v_pk_mul_f32 v[102:103], v[102:103], v[84:85] op_sel_hi:[1,0]
v_pk_mul_f32 v[116:117], v[116:117], v[84:85] op_sel_hi:[1,0]
v_pk_mul_f32 v[118:119], v[118:119], v[84:85] op_sel_hi:[1,0]
v_cvt_pk_bf16_f32 v172, v100, v101
v_cvt_pk_bf16_f32 v173, v102, v103
v_cvt_pk_bf16_f32 v174, v116, v117
v_cvt_pk_bf16_f32 v175, v118, v119
buffer_store_dwordx4 v[172:175], v4, s[16:19], s74 offen offset:2048 sc1
v_pk_mul_f32 v[96:97], v[96:97], v[80:81] op_sel_hi:[1,0]
v_pk_mul_f32 v[98:99], v[98:99], v[80:81] op_sel_hi:[1,0]
v_pk_mul_f32 v[112:113], v[112:113], v[80:81] op_sel_hi:[1,0]
v_pk_mul_f32 v[114:115], v[114:115], v[80:81] op_sel_hi:[1,0]
v_cvt_pk_bf16_f32 v168, v96, v97
v_cvt_pk_bf16_f32 v169, v98, v99
v_cvt_pk_bf16_f32 v170, v112, v113
v_cvt_pk_bf16_f32 v171, v114, v115
buffer_store_dwordx4 v[168:171], v4, s[16:19], s74 offen offset:1024 sc1
v_pk_mul_f32 v[92:93], v[92:93], v[76:77] op_sel_hi:[1,0]
v_pk_mul_f32 v[94:95], v[94:95], v[76:77] op_sel_hi:[1,0]
v_pk_mul_f32 v[108:109], v[108:109], v[76:77] op_sel_hi:[1,0]
v_pk_mul_f32 v[110:111], v[110:111], v[76:77] op_sel_hi:[1,0]
v_cvt_pk_bf16_f32 v164, v92, v93
v_cvt_pk_bf16_f32 v165, v94, v95
v_cvt_pk_bf16_f32 v166, v108, v109
v_cvt_pk_bf16_f32 v167, v110, v111
buffer_store_dwordx4 v[164:167], v4, s[16:19], s74 offen sc1
s_nop 1
s_branch .Lqkve2
.Lx4:
buffer_load_dword v27, v14, s[76:79], 0 offen
s_mov_b32 s76, s98
s_mov_b32 s77, s99
s_mov_b32 s78, s100
v_mov_b32 v14, v15
s_mov_b32 s47, 5
s_branch .Lx4b
.Lx5:
buffer_load_dword v27, v14, s[76:79], 0 offen
s_mov_b32 s76, s98
s_mov_b32 s77, s99
s_mov_b32 s78, s100
v_mov_b32 v14, v15
s_mov_b32 s47, 5
s_branch .Lx5b
.Lx6:
buffer_load_dword v27, v14, s[76:79], 0 offen
s_mov_b32 s76, s98
s_mov_b32 s77, s99
s_mov_b32 s78, s100
v_mov_b32 v14, v15
s_mov_b32 s47, 5
s_branch .Lx6b
.Lx7:
buffer_load_dword v27, v14, s[76:79], 0 offen
s_mov_b32 s76, s98
s_mov_b32 s77, s99
s_mov_b32 s78, s100
v_mov_b32 v14, v15
s_mov_b32 s47, 5
s_branch .Lx7b
.Lsp8:
s_mov_b32 s15, 0
.Lsp8l:
v_mov_b32 v37, 0
buffer_atomic_add v37, v34, s[40:43], 0 offen sc0
s_add_u32 s15, s15, 1
s_cmp_gt_u32 s15, 100000
s_waitcnt vmcnt(0)
s_cbranch_scc1 .Lsp8b
v_cmp_gt_u32 vcc, v35, v37
s_nop 0
s_cbranch_vccnz .Lsp8l
s_branch .Lsp8b
.Lx9:
buffer_load_dword v27, v14, s[76:79], 0 offen
s_mov_b32 s76, s98
s_mov_b32 s77, s99
s_mov_b32 s78, s100
v_mov_b32 v14, v15
s_mov_b32 s47, 5
s_branch .Lx9b
.Lx10:
buffer_load_dword v27, v14, s[76:79], 0 offen
s_mov_b32 s76, s98
s_mov_b32 s77, s99
s_mov_b32 s78, s100
v_mov_b32 v14, v15
s_mov_b32 s47, 5
s_branch .Lx10b
.Lx11:
buffer_load_dword v27, v14, s[76:79], 0 offen
s_mov_b32 s76, s98
s_mov_b32 s77, s99
s_mov_b32 s78, s100
v_mov_b32 v14, v15
s_mov_b32 s47, 5
s_branch .Lx11b
.Lx12:
buffer_load_dword v27, v14, s[76:79], 0 offen
s_mov_b32 s76, s98
s_mov_b32 s77, s99
s_mov_b32 s78, s100
v_mov_b32 v14, v15
s_mov_b32 s47, 5
s_branch .Lx12b
.Lsp13:
s_mov_b32 s15, 0
.Lsp13l:
v_mov_b32 v37, 0
buffer_atomic_add v37, v33, s[16:19], 0 offen sc0
s_add_u32 s15, s15, 1
s_cmp_gt_u32 s15, 100000
s_waitcnt vmcnt(0)
s_cbranch_scc1 .Lsp13b
v_cmp_gt_u32 vcc, v36, v37
s_nop 0
s_cbranch_vccnz .Lsp13l
s_branch .Lsp13b
.Lx14:
buffer_load_dword v27, v14, s[76:79], 0 offen
s_mov_b32 s76, s98
s_mov_b32 s77, s99
s_mov_b32 s78, s100
v_mov_b32 v14, v15
s_mov_b32 s47, 5
s_branch .Lx14b
.Lx15:
buffer_load_dword v27, v14, s[76:79], 0 offen
s_mov_b32 s76, s98
s_mov_b32 s77, s99
s_mov_b32 s78, s100
v_mov_b32 v14, v15
s_mov_b32 s47, 5
s_branch .Lx15b
.Lx16:
buffer_load_dword v27, v14, s[76:79], 0 offen
s_mov_b32 s76, s98
s_mov_b32 s77, s99
s_mov_b32 s78, s100
v_mov_b32 v14, v15
s_mov_b32 s47, 5
s_branch .Lx16b
.Lx17:
buffer_load_dword v27, v14, s[76:79], 0 offen
s_mov_b32 s76, s98
s_mov_b32 s77, s99
s_mov_b32 s78, s100
v_mov_b32 v14, v15
s_mov_b32 s47, 5
s_branch .Lx17b
.Lx19:
buffer_load_dword v27, v14, s[76:79], 0 offen
s_mov_b32 s76, s98
s_mov_b32 s77, s99
s_mov_b32 s78, s100
v_mov_b32 v14, v15
s_mov_b32 s47, 5
s_branch .Lx19b
.Lx20:
buffer_load_dword v27, v14, s[76:79], 0 offen
s_mov_b32 s76, s98
s_mov_b32 s77, s99
s_mov_b32 s78, s100
v_mov_b32 v14, v15
s_mov_b32 s47, 5
s_branch .Lx20b
.Lx21:
buffer_load_dword v27, v14, s[76:79], 0 offen
s_mov_b32 s76, s98
s_mov_b32 s77, s99
s_mov_b32 s78, s100
v_mov_b32 v14, v15
s_mov_b32 s47, 5
s_branch .Lx21b
.Lx22:
buffer_load_dword v27, v14, s[76:79], 0 offen
s_mov_b32 s76, s98
s_mov_b32 s77, s99
s_mov_b32 s78, s100
v_mov_b32 v14, v15
s_mov_b32 s47, 5
s_branch .Lx22b
.Lsp23:
s_mov_b32 s15, 0
.Lsp23l:
v_mov_b32 v37, 0
buffer_atomic_add v37, v34, s[40:43], 0 offen sc0
s_add_u32 s15, s15, 1
s_cmp_gt_u32 s15, 100000
s_waitcnt vmcnt(0)
s_cbranch_scc1 .Lsp23b
v_cmp_gt_u32 vcc, v35, v37
s_nop 0
s_cbranch_vccnz .Lsp23l
s_branch .Lsp23b
.Lx24:
buffer_load_dword v27, v14, s[76:79], 0 offen
s_mov_b32 s76, s98
s_mov_b32 s77, s99
s_mov_b32 s78, s100
v_mov_b32 v14, v15
s_mov_b32 s47, 5
s_branch .Lx24b
.Lx25:
buffer_load_dword v27, v14, s[76:79], 0 offen
s_mov_b32 s76, s98
s_mov_b32 s77, s99
s_mov_b32 s78, s100
v_mov_b32 v14, v15
s_mov_b32 s47, 5
s_branch .Lx25b
.Lx26:
buffer_load_dword v27, v14, s[76:79], 0 offen
s_mov_b32 s76, s98
s_mov_b32 s77, s99
s_mov_b32 s78, s100
v_mov_b32 v14, v15
s_mov_b32 s47, 5
s_branch .Lx26b
.Lx27:
buffer_load_dword v27, v14, s[76:79], 0 offen
s_mov_b32 s76, s98
s_mov_b32 s77, s99
s_mov_b32 s78, s100
v_mov_b32 v14, v15
s_mov_b32 s47, 5
s_branch .Lx27b
.Lsp28:
s_mov_b32 s15, 0
.Lsp28l:
v_mov_b32 v37, 0
buffer_atomic_add v37, v33, s[16:19], 0 offen sc0
s_add_u32 s15, s15, 1
s_cmp_gt_u32 s15, 100000
s_waitcnt vmcnt(0)
s_cbranch_scc1 .Lsp28b
v_cmp_gt_u32 vcc, v36, v37
s_nop 0
s_cbranch_vccnz .Lsp28l
s_branch .Lsp28b
.Lx29:
buffer_load_dword v27, v14, s[76:79], 0 offen
s_mov_b32 s76, s98
s_mov_b32 s77, s99
s_mov_b32 s78, s100
v_mov_b32 v14, v15
s_mov_b32 s47, 5
s_branch .Lx29b
.Lx30:
buffer_load_dword v27, v14, s[76:79], 0 offen
s_mov_b32 s76, s98
s_mov_b32 s77, s99
s_mov_b32 s78, s100
v_mov_b32 v14, v15
s_mov_b32 s47, 5
s_branch .Lx30b
.Lx31:
buffer_load_dword v27, v14, s[76:79], 0 offen
s_mov_b32 s76, s98
s_mov_b32 s77, s99
s_mov_b32 s78, s100
v_mov_b32 v14, v15
s_mov_b32 s47, 5
s_branch .Lx31b
.Lx32:
buffer_load_dword v27, v14, s[76:79], 0 offen
s_mov_b32 s76, s98
s_mov_b32 s77, s99
s_mov_b32 s78, s100
v_mov_b32 v14, v15
s_mov_b32 s47, 5
s_branch .Lx32b
.Lqkv1:
s_cmp_lt_u32 s14, 16
s_cselect_b32 s62, 0, 4096
v_mov_b32 v231, 1
v_lshlrev_b32 v232, 8, v1
s_waitcnt vmcnt(18)
v_permlane16_swap_b32 v164, v166
v_permlane16_swap_b32 v165, v167
s_waitcnt vmcnt(17)
v_permlane16_swap_b32 v168, v170
v_permlane16_swap_b32 v169, v171
s_waitcnt vmcnt(16)
v_permlane16_swap_b32 v172, v174
v_permlane16_swap_b32 v173, v175
s_waitcnt vmcnt(15)
v_permlane16_swap_b32 v176, v178
v_permlane16_swap_b32 v177, v179
buffer_atomic_add v231, v232, s[40:43], s62 offen
v_lshlrev_b32 v192, 16, v164
v_and_b32 v193, 0xffff0000, v164
v_lshlrev_b32 v194, 16, v165
v_and_b32 v195, 0xffff0000, v165
v_lshlrev_b32 v196, 16, v166
v_and_b32 v197, 0xffff0000, v166
v_lshlrev_b32 v198, 16, v167
v_and_b32 v199, 0xffff0000, v167
v_lshlrev_b32 v200, 16, v168
v_and_b32 v201, 0xffff0000, v168
v_lshlrev_b32 v202, 16, v169
v_and_b32 v203, 0xffff0000, v169
v_lshlrev_b32 v204, 16, v170
v_and_b32 v205, 0xffff0000, v170
v_lshlrev_b32 v206, 16, v171
v_and_b32 v207, 0xffff0000, v171
v_lshlrev_b32 v208, 16, v172
v_and_b32 v209, 0xffff0000, v172
v_lshlrev_b32 v210, 16, v173
v_and_b32 v211, 0xffff0000, v173
v_lshlrev_b32 v212, 16, v174
v_and_b32 v213, 0xffff0000, v174
v_lshlrev_b32 v214, 16, v175
v_and_b32 v215, 0xffff0000, v175
v_lshlrev_b32 v216, 16, v176
v_and_b32 v217, 0xffff0000, v176
v_lshlrev_b32 v218, 16, v177
v_and_b32 v219, 0xffff0000, v177
v_lshlrev_b32 v220, 16, v178
v_and_b32 v221, 0xffff0000, v178
v_lshlrev_b32 v222, 16, v179
v_and_b32 v223, 0xffff0000, v179
s_lshl_b32 s64, s6, 14
s_lshl_b32 s65, s49, 13
s_add_u32 s64, s64, s65
s_lshl_b32 s65, s7, 9
s_add_u32 s64, s64, s65
s_lshl_b32 s65, s48, 8
s_add_u32 s64, s64, s65
s_add_u32 s64, s64, 29360128
v_and_b32 v188, 31, v1
v_lshlrev_b32 v188, 3, v188
v_lshrrev_b32 v189, 5, v1
v_lshl_add_u32 v188, v189, 28, v188
s_lshl_b32 s62, s7, 18
s_add_u32 s62, s62, 0
s_add_u32 s63, s62, 131072
v_pk_mul_f32 v[182:183], v[192:193], v[192:193]
v_pk_mul_f32 v[186:187], v[208:209], v[208:209]
v_pk_fma_f32 v[182:183], v[194:195], v[194:195], v[182:183]
v_pk_add_f32 v[180:181], v[192:193], v[194:195]
v_pk_fma_f32 v[186:187], v[210:211], v[210:211], v[186:187]
v_pk_add_f32 v[184:185], v[208:209], v[210:211]
v_pk_fma_f32 v[182:183], v[196:197], v[196:197], v[182:183]
v_pk_add_f32 v[180:181], v[180:181], v[196:197]
v_pk_fma_f32 v[186:187], v[212:213], v[212:213], v[186:187]
v_pk_add_f32 v[184:185], v[184:185], v[212:213]
v_pk_fma_f32 v[182:183], v[198:199], v[198:199], v[182:183]
v_pk_add_f32 v[180:181], v[180:181], v[198:199]
v_pk_fma_f32 v[186:187], v[214:215], v[214:215], v[186:187]
v_pk_add_f32 v[184:185], v[184:185], v[214:215]
v_pk_fma_f32 v[182:183], v[200:201], v[200:201], v[182:183]
v_pk_add_f32 v[180:181], v[180:181], v[200:201]
v_pk_fma_f32 v[186:187], v[216:217], v[216:217], v[186:187]
v_pk_add_f32 v[184:185], v[184:185], v[216:217]
v_pk_fma_f32 v[182:183], v[202:203], v[202:203], v[182:183]
v_pk_add_f32 v[180:181], v[180:181], v[202:203]
v_pk_fma_f32 v[186:187], v[218:219], v[218:219], v[186:187]
v_pk_add_f32 v[184:185], v[184:185], v[218:219]
v_pk_fma_f32 v[182:183], v[204:205], v[204:205], v[182:183]
v_pk_add_f32 v[180:181], v[180:181], v[204:205]
v_pk_fma_f32 v[186:187], v[220:221], v[220:221], v[186:187]
v_pk_add_f32 v[184:185], v[184:185], v[220:221]
v_pk_fma_f32 v[182:183], v[206:207], v[206:207], v[182:183]
v_pk_add_f32 v[180:181], v[180:181], v[206:207]
v_pk_fma_f32 v[186:187], v[222:223], v[222:223], v[186:187]
v_pk_add_f32 v[184:185], v[184:185], v[222:223]
v_add_f32 v180, v180, v181
v_add_f32 v182, v182, v183
v_add_f32 v184, v184, v185
v_add_f32 v186, v186, v187
s_nop 0
v_permlane16_swap_b32 v180, v184
v_permlane16_swap_b32 v182, v186
v_add_f32 v180, v180, v184
v_add_f32 v182, v182, v186
s_nop 1
v_permlane32_swap_b32 v180, v182
v_add_f32 v180, v180, v182
s_nop 1
v_permlane32_swap_b32 v180, v181
buffer_store_dwordx2 v[180:181], v188, s[16:19], s64 offen sc1
s_lshl_b32 s62, s2, 10
s_add_u32 s62, s62, 31457280
s_cmp_eq_u32 s3, 0
s_cselect_b32 s62, s62, 268435456
buffer_store_dwordx4 v[224:227], v230, s[16:19], s62 offen sc1
v_accvgpr_write_b32 a224, v192
v_accvgpr_write_b32 a225, v193
v_accvgpr_write_b32 a226, v194
v_accvgpr_write_b32 a227, v195
v_accvgpr_write_b32 a228, v196
v_accvgpr_write_b32 a229, v197
v_accvgpr_write_b32 a230, v198
v_accvgpr_write_b32 a231, v199
v_accvgpr_write_b32 a232, v200
v_accvgpr_write_b32 a233, v201
v_accvgpr_write_b32 a234, v202
v_accvgpr_write_b32 a235, v203
v_accvgpr_write_b32 a236, v204
v_accvgpr_write_b32 a237, v205
v_accvgpr_write_b32 a238, v206
v_accvgpr_write_b32 a239, v207
v_accvgpr_write_b32 a240, v208
v_accvgpr_write_b32 a241, v209
v_accvgpr_write_b32 a242, v210
v_accvgpr_write_b32 a243, v211
v_accvgpr_write_b32 a244, v212
v_accvgpr_write_b32 a245, v213
v_accvgpr_write_b32 a246, v214
v_accvgpr_write_b32 a247, v215
v_accvgpr_write_b32 a248, v216
v_accvgpr_write_b32 a249, v217
v_accvgpr_write_b32 a250, v218
v_accvgpr_write_b32 a251, v219
v_accvgpr_write_b32 a252, v220
v_accvgpr_write_b32 a253, v221
v_accvgpr_write_b32 a254, v222
v_accvgpr_write_b32 a255, v223
s_add_u32 m0, s55, 18496
s_nop 0
buffer_load_dwordx4 v21, s[36:39], s52 offen lds
buffer_load_dwordx4 v28, s[36:39], s52 offen offset:1024 lds
buffer_load_dword v22, s[36:39], s52 offen offset:2048 lds
s_add_u32 s52, s52, 128
s_add_u32 m0, s55, 20800
s_nop 0
buffer_load_dwordx4 v21, s[36:39], s53 offen lds
buffer_load_dwordx4 v28, s[36:39], s53 offen offset:1024 lds
buffer_load_dword v29, s[36:39], s53 offen offset:2048 lds
s_add_u32 s53, s53, 128
s_add_u32 m0, s56, 73984
s_nop 0
buffer_load_dwordx4 v18, s[20:23], s54 offen lds
buffer_load_dwordx4 v19, s[20:23], s54 offen offset:1024 lds
buffer_load_dwordx4 v20, s[20:23], s54 offen offset:2048 lds
s_add_u32 s54, s54, 196608
s_waitcnt vmcnt(12) lgkmcnt(0)
s_barrier
ds_read_b128 a[0:3], v23
RD 4,23,2304
RD 8,23,4608
RD 12,23,6912
ds_read_b128 a[16:19], v24
ds_read_b128 a[20:23], v30
RD 24,30,2304
RD 28,30,4608
RD 32,30,6912
ds_read_b128 a[36:39], v31
TR 80,25,49664
TR 82,25,50176
TR 84,25,62080
TR 86,25,62592
TR 88,25,50688
TR 90,25,51200
TR 92,25,63104
TR 94,25,63616
TR 96,25,51712
TR 98,25,52224
TR 100,25,64128
TR 102,25,64640
s_waitcnt vmcnt(3) lgkmcnt(0)
s_barrier
v_mfma_f32_16x16x32_bf16 v[60:63], a[80:83], a[0:3], 0
TR 104,25,49696
s_add_u32 m0, s56, 86400
MAA 60,84,20
buffer_load_dwordx4 v18, s[20:23], s54 offen lds
v_mfma_f32_16x16x32_bf16 v[64:67], a[80:83], a[4:7], 0
s_sub_u32 s47, s47, 1
s_cbranch_scc1 .Lx19
.Lx19b:
MAA 64,84,24
buffer_load_dwordx4 v19, s[20:23], s54 offen offset:1024 lds
v_mfma_f32_16x16x32_bf16 v[68:71], a[80:83], a[8:11], 0
TR 106,25,50208
MAA 68,84,28
TR 108,25,62112
TR 110,25,62624
TR 112,25,50720
v_mfma_f32_16x16x32_bf16 v[72:75], a[80:83], a[12:15], 0
TR 114,25,51232
MAA 72,84,32
TR 116,25,63136
TR 118,25,63648
v_mfma_f32_16x16x32_bf16 v[104:107], a[88:91], a[12:15], 0
TR 120,25,51744
MAA 104,92,32
buffer_load_dwordx4 v20, s[20:23], s54 offen offset:2048 lds
v_mfma_f32_16x16x32_bf16 v[100:103], a[88:91], a[8:11], 0
s_add_u32 s54, s54, 196608
s_add_u32 m0, s55, 36992
MAA 100,92,28
buffer_load_dwordx4 v21, s[36:39], s52 offen lds
v_mfma_f32_16x16x32_bf16 v[96:99], a[88:91], a[4:7], 0
TR 122,25,52256
MAA 96,92,24
buffer_load_dwordx4 v28, s[36:39], s52 offen offset:1024 lds
v_mfma_f32_16x16x32_bf16 v[92:95], a[88:91], a[0:3], 0
TR 124,25,64160
MAA 92,92,20
buffer_load_dword v22, s[36:39], s52 offen offset:2048 lds
v_mfma_f32_16x16x32_bf16 v[124:127], a[0:3], a[96:99], 0
s_add_u32 s52, s52, 128
s_add_u32 m0, s55, 39296
MAA 124,20,100
buffer_load_dwordx4 v21, s[36:39], s53 offen lds
v_mfma_f32_16x16x32_bf16 v[128:131], a[4:7], a[96:99], 0
TR 126,25,64672
MAA 128,24,100
buffer_load_dwordx4 v28, s[36:39], s53 offen offset:1024 lds
v_mfma_f32_16x16x32_bf16 v[132:135], a[8:11], a[96:99], 0
RD 40,23,18496
MAA 132,28,100
RD 44,23,20800
RD 48,23,23104
RD 52,23,25408
v_mfma_f32_16x16x32_bf16 v[136:139], a[12:15], a[96:99], 0
RD 56,24,18496
MAA 136,32,100
buffer_load_dword v29, s[36:39], s53 offen offset:2048 lds
v_mfma_f32_16x16x32_bf16 v[156:159], a[16:19], a[96:99], 0
s_add_u32 s53, s53, 128
MAA 156,36,100
s_waitcnt vmcnt(6) lgkmcnt(5)
s_barrier
v_mfma_f32_16x16x32_bf16 v[76:79], a[104:107], a[0:3], 0
RD 60,30,18496
s_add_u32 m0, s56, 98816
MAA 76,108,20
buffer_load_dwordx4 v18, s[20:23], s54 offen lds
v_mfma_f32_16x16x32_bf16 v[80:83], a[104:107], a[4:7], 0
RD 64,30,20800
MAA 80,108,24
buffer_load_dwordx4 v19, s[20:23], s54 offen offset:1024 lds
v_mfma_f32_16x16x32_bf16 v[84:87], a[104:107], a[8:11], 0
RD 68,30,23104
MAA 84,108,28
RD 72,30,25408
v_mfma_f32_16x16x32_bf16 v[88:91], a[104:107], a[12:15], 0
RD 76,31,18496
MAA 88,108,32
buffer_load_dwordx4 v20, s[20:23], s54 offen offset:2048 lds
v_mfma_f32_16x16x32_bf16 v[244:247], a[104:107], a[16:19], 0
s_add_u32 s54, s54, 196608
s_add_u32 m0, s56, 111232
MAA 244,108,36
buffer_load_dwordx4 v18, s[20:23], s54 offen lds
v_mfma_f32_16x16x32_bf16 v[120:123], a[112:115], a[12:15], 0
ds_read_b64_tr_b16 a[80:81], v25
MAA 120,116,32
TR 82,25,512
v_mfma_f32_16x16x32_bf16 v[116:119], a[112:115], a[8:11], 0
TR 84,25,12416
MAA 116,116,28
buffer_load_dwordx4 v19, s[20:23], s54 offen offset:1024 lds
v_mfma_f32_16x16x32_bf16 v[112:115], a[112:115], a[4:7], 0
TR 86,25,12928
MAA 112,116,24
buffer_load_dwordx4 v20, s[20:23], s54 offen offset:2048 lds
v_mfma_f32_16x16x32_bf16 v[108:111], a[112:115], a[0:3], 0
TR 88,25,1024
s_add_u32 s54, s54, 196608
MAA 108,116,20
TR 90,25,1536
v_mfma_f32_16x16x32_bf16 v[140:143], a[0:3], a[120:123], 0
TR 92,25,13440
s_add_u32 m0, s55, 55488
MAA 140,20,124
buffer_load_dwordx4 v21, s[36:39], s52 offen lds
v_mfma_f32_16x16x32_bf16 v[144:147], a[4:7], a[120:123], 0
TR 94,25,13952
MAA 144,24,124
buffer_load_dwordx4 v28, s[36:39], s52 offen offset:1024 lds
v_mfma_f32_16x16x32_bf16 v[148:151], a[8:11], a[120:123], 0
TR 96,25,2048
MAA 148,28,124
TR 98,25,2560
v_mfma_f32_16x16x32_bf16 v[152:155], a[12:15], a[120:123], 0
TR 100,25,14464
MAA 152,32,124
buffer_load_dword v22, s[36:39], s52 offen offset:2048 lds
v_mfma_f32_16x16x32_bf16 v[160:163], a[16:19], a[120:123], 0
TR 102,25,14976
s_add_u32 s52, s52, 128
MAA 160,36,124
s_waitcnt vmcnt(9) lgkmcnt(8)
s_barrier
MAA 60,80,40
TR 104,25,32
s_add_u32 m0, s55, 57792
MAA 60,84,60
buffer_load_dwordx4 v21, s[36:39], s53 offen lds
MAA 64,84,64
s_sub_u32 s47, s47, 1
s_cbranch_scc1 .Lx20
.Lx20b:
MAA 64,80,44
buffer_load_dwordx4 v28, s[36:39], s53 offen offset:1024 lds
MAA 68,80,48
TR 106,25,544
MAA 68,84,68
TR 108,25,12448
TR 110,25,12960
TR 112,25,1056
MAA 72,84,72
TR 114,25,1568
MAA 72,80,52
TR 116,25,13472
TR 118,25,13984
s_waitcnt lgkmcnt(8)
MAA 104,88,52
TR 120,25,2080
MAA 104,92,72
buffer_load_dword v29, s[36:39], s53 offen offset:2048 lds
MAA 100,92,68
s_add_u32 s53, s53, 128
s_add_u32 m0, s56, 123648
MAA 100,88,48
buffer_load_dwordx4 v18, s[20:23], s54 offen lds
MAA 96,88,44
TR 122,25,2592
MAA 96,92,64
buffer_load_dwordx4 v19, s[20:23], s54 offen offset:1024 lds
MAA 92,92,60
TR 124,25,14496
MAA 92,88,40
buffer_load_dwordx4 v20, s[20:23], s54 offen offset:2048 lds
MAA 124,40,96
s_add_u32 s54, s54, 196608
s_add_u32 m0, s56, 136064
MAA 124,60,100
buffer_load_dwordx4 v18, s[20:23], s54 offen lds
MAA 128,64,100
TR 126,25,15008
MAA 128,44,96
buffer_load_dwordx4 v19, s[20:23], s54 offen offset:1024 lds
MAA 132,48,96
RD 0,23,36992
MAA 132,68,100
RD 4,23,39296
RD 8,23,41600
RD 12,23,43904
MAA 136,72,100
RD 16,24,36992
MAA 136,52,96
buffer_load_dwordx4 v20, s[20:23], s54 offen offset:2048 lds
MAA 156,56,96
s_add_u32 s54, s54, 196608
MAA 156,76,100
s_waitcnt vmcnt(12) lgkmcnt(5)
s_barrier
MAA 76,104,40
RD 20,30,36992
s_add_u32 m0, s55, 0
MAA 76,108,60
buffer_load_dwordx4 v21, s[36:39], s52 offen lds
MAA 80,108,64
RD 24,30,39296
MAA 80,104,44
buffer_load_dwordx4 v28, s[36:39], s52 offen offset:1024 lds
MAA 84,104,48
RD 28,30,41600
MAA 84,108,68
RD 32,30,43904
RD 36,31,36992
MAA 88,108,72
TR 80,25,24832
MAA 88,104,52
buffer_load_dword v22, s[36:39], s52 offen offset:2048 lds
MAA 244,104,56
s_add_u32 s52, s52, 128
s_add_u32 m0, s55, 2304
MAA 244,108,76
buffer_load_dwordx4 v21, s[36:39], s53 offen lds
MAA 120,116,72
TR 82,25,25344
MAA 120,112,52
buffer_load_dwordx4 v28, s[36:39], s53 offen offset:1024 lds
MAA 116,112,48
TR 84,25,37248
MAA 116,116,68
TR 86,25,37760
TR 88,25,25856
MAA 112,116,64
TR 90,25,26368
MAA 112,112,44
buffer_load_dword v29, s[36:39], s53 offen offset:2048 lds
MAA 108,112,40
s_add_u32 s53, s53, 128
s_add_u32 m0, s56, 73984
MAA 108,116,60
buffer_load_dwordx4 v18, s[20:23], s54 offen lds
MAA 140,60,124
TR 92,25,38272
MAA 140,40,120
buffer_load_dwordx4 v19, s[20:23], s54 offen offset:1024 lds
MAA 144,44,120
TR 94,25,38784
MAA 144,64,124
buffer_load_dwordx4 v20, s[20:23], s54 offen offset:2048 lds
MAA 148,68,124
TR 96,25,26880
s_add_u32 s54, s54, 196608
MAA 148,48,120
TR 98,25,27392
TR 100,25,39296
MAA 152,52,120
TR 102,25,39808
MAA 152,72,124
buffer_load_dword v37, v34, s[40:43], 0 offen sc1
MAA 160,76,124
MAA 160,56,120
s_waitcnt vmcnt(16) lgkmcnt(8)
s_barrier
MAA 60,80,0
TR 104,25,24864
s_add_u32 m0, s56, 86400
MAA 60,84,20
buffer_load_dwordx4 v18, s[20:23], s54 offen lds
MAA 64,84,24
s_sub_u32 s47, s47, 1
s_cbranch_scc1 .Lx21
.Lx21b:
MAA 64,80,4
buffer_load_dwordx4 v19, s[20:23], s54 offen offset:1024 lds
MAA 68,80,8
TR 106,25,25376
MAA 68,84,28
TR 108,25,37280
TR 110,25,37792
TR 112,25,25888
MAA 72,84,32
TR 114,25,26400
MAA 72,80,12
TR 116,25,38304
TR 118,25,38816
s_waitcnt lgkmcnt(8)
MAA 104,88,12
TR 120,25,26912
MAA 104,92,32
buffer_load_dwordx4 v20, s[20:23], s54 offen offset:2048 lds
MAA 100,92,28
s_add_u32 s54, s54, 196608
s_add_u32 m0, s55, 18496
MAA 100,88,8
buffer_load_dwordx4 v21, s[36:39], s52 offen lds
MAA 96,88,4
TR 122,25,27424
MAA 96,92,24
buffer_load_dwordx4 v28, s[36:39], s52 offen offset:1024 lds
MAA 92,92,20
TR 124,25,39328
MAA 92,88,0
buffer_load_dword v22, s[36:39], s52 offen offset:2048 lds
MAA 124,0,96
s_add_u32 s52, s52, 128
s_add_u32 m0, s55, 20800
MAA 124,20,100
buffer_load_dwordx4 v21, s[36:39], s53 offen lds
MAA 128,24,100
TR 126,25,39840
MAA 128,4,96
buffer_load_dwordx4 v28, s[36:39], s53 offen offset:1024 lds
MAA 132,8,96
RD 40,23,55488
MAA 132,28,100
RD 44,23,57792
RD 48,23,60096
RD 52,23,62400
MAA 136,32,100
RD 56,24,55488
MAA 136,12,96
buffer_load_dword v29, s[36:39], s53 offen offset:2048 lds
MAA 156,16,96
s_add_u32 s53, s53, 128
MAA 156,36,100
s_waitcnt vmcnt(19) lgkmcnt(5)
s_barrier
MAA 76,104,0
RD 60,30,55488
s_add_u32 m0, s56, 98816
MAA 76,108,20
buffer_load_dwordx4 v18, s[20:23], s54 offen lds
MAA 80,108,24
RD 64,30,57792
MAA 80,104,4
buffer_load_dwordx4 v19, s[20:23], s54 offen offset:1024 lds
MAA 84,104,8
RD 68,30,60096
MAA 84,108,28
RD 72,30,62400
MAA 88,108,32
RD 76,31,55488
MAA 88,104,12
buffer_load_dwordx4 v20, s[20:23], s54 offen offset:2048 lds
MAA 244,104,16
s_add_u32 s54, s54, 196608
s_add_u32 m0, s55, 36992
MAA 244,108,36
buffer_load_dwordx4 v21, s[36:39], s52 offen lds
MAA 120,116,32
TR 80,25,49664
MAA 120,112,12
TR 82,25,50176
MAA 116,112,8
TR 84,25,62080
MAA 116,116,28
buffer_load_dwordx4 v28, s[36:39], s52 offen offset:1024 lds
MAA 112,116,24
TR 86,25,62592
MAA 112,112,4
buffer_load_dword v22, s[36:39], s52 offen offset:2048 lds
MAA 108,112,0
TR 88,25,50688
s_add_u32 s52, s52, 128
MAA 108,116,20
TR 90,25,51200
MAA 140,20,124
TR 92,25,63104
s_add_u32 m0, s55, 39296
MAA 140,0,120
buffer_load_dwordx4 v21, s[36:39], s53 offen lds
MAA 144,4,120
TR 94,25,63616
MAA 144,24,124
buffer_load_dwordx4 v28, s[36:39], s53 offen offset:1024 lds
MAA 148,28,124
TR 96,25,51712
MAA 148,8,120
TR 98,25,52224
MAA 152,12,120
TR 100,25,64128
MAA 152,32,124
buffer_load_dword v29, s[36:39], s53 offen offset:2048 lds
MAA 160,36,124
TR 102,25,64640
s_add_u32 s53, s53, 128
MAA 160,16,120
s_waitcnt vmcnt(22) lgkmcnt(8)
s_barrier
MAA 60,80,40
TR 104,25,49696
MAA 60,84,60
TR 106,25,50208
MAA 64,84,64
TR 108,25,62112
s_add_u32 m0, s56, 111232
MAA 64,80,44
buffer_load_dwordx4 v18, s[20:23], s54 offen lds
MAA 68,80,48
s_sub_u32 s47, s47, 1
s_cbranch_scc1 .Lx22
.Lx22b:
MAA 68,84,68
TR 110,25,62624
MAA 72,84,72
TR 112,25,50720
MAA 72,80,52
TR 114,25,51232
s_waitcnt lgkmcnt(6)
MAA 104,88,52
TR 116,25,63136
MAA 104,92,72
buffer_load_dwordx4 v19, s[20:23], s54 offen offset:1024 lds
MAA 100,92,68
TR 118,25,63648
MAA 100,88,48
buffer_load_dwordx4 v20, s[20:23], s54 offen offset:2048 lds
MAA 96,88,44
TR 120,25,51744
s_add_u32 s54, s54, 196608
MAA 96,92,64
TR 122,25,52256
MAA 92,92,60
TR 124,25,64160
s_add_u32 m0, s55, 55488
MAA 92,88,40
buffer_load_dwordx4 v21, s[36:39], s52 offen lds
MAA 124,40,96
TR 126,25,64672
MAA 124,60,100
ds_read_b128 a[0:3], v23
MAA 128,64,100
RD 4,23,2304
MAA 128,44,96
buffer_load_dwordx4 v28, s[36:39], s52 offen offset:1024 lds
MAA 132,48,96
RD 8,23,4608
MAA 132,68,100
RD 12,23,6912
MAA 136,72,100
ds_read_b128 a[16:19], v24
MAA 136,52,96
buffer_load_dword v22, s[36:39], s52 offen offset:2048 lds
MAA 156,56,96
s_add_u32 s52, s52, 128
MAA 156,76,100
s_waitcnt vmcnt(21) lgkmcnt(5)
s_barrier
v_cmp_gt_u32 vcc, v35, v37
s_nop 0
s_cbranch_vccnz .Lsp23
.Lsp23b:
v_mov_b32 v37, 0
MAA 76,104,40
ds_read_b128 a[20:23], v30
MAA 76,108,60
buffer_atomic_add v38, v32, s[16:19], 0 offen
MAA 80,108,64
RD 24,30,2304
MAA 80,104,44
RD 28,30,4608
MAA 84,104,48
RD 32,30,6912
s_add_u32 m0, s56, 123648
MAA 84,108,68
buffer_load_dwordx4 v18, s[20:23], s54 offen lds
MAA 88,108,72
ds_read_b128 a[36:39], v31
MAA 88,104,52
ds_read_b64_tr_b16 a[80:81], v25
MAA 244,104,56
TR 82,25,512
MAA 244,108,76
buffer_load_dwordx4 v19, s[20:23], s54 offen offset:1024 lds
MAA 120,116,72
TR 84,25,12416
MAA 120,112,52
TR 86,25,12928
MAA 116,112,48
MAA 116,116,68
buffer_load_dwordx4 v20, s[20:23], s54 offen offset:2048 lds
MAA 112,116,64
s_add_u32 s54, s54, 196608
s_add_u32 m0, s55, 57792
MAA 112,112,44
buffer_load_dwordx4 v21, s[36:39], s53 offen lds
MAA 108,112,40
TR 88,25,1024
MAA 108,116,60
TR 90,25,1536
MAA 140,60,124
TR 92,25,13440
MAA 140,40,120
buffer_load_dwordx4 v28, s[36:39], s53 offen offset:1024 lds
MAA 144,44,120
TR 94,25,13952
MAA 144,64,124
TR 96,25,2048
MAA 148,68,124
TR 98,25,2560
MAA 148,48,120
buffer_load_dword v29, s[36:39], s53 offen offset:2048 lds
MAA 152,52,120
TR 100,25,14464
s_add_u32 s53, s53, 128
MAA 152,72,124
TR 102,25,14976
MAA 160,76,124
MAA 160,56,120
s_waitcnt vmcnt(22) lgkmcnt(8)
s_barrier
MAA 60,80,0
TR 104,25,32
MAA 60,84,20
TR 106,25,544
MAA 64,84,24
TR 108,25,12448
s_add_u32 m0, s56, 136064
MAA 64,80,4
buffer_load_dwordx4 v18, s[20:23], s54 offen lds
MAA 68,80,8
s_sub_u32 s47, s47, 1
s_cbranch_scc1 .Lx24
.Lx24b:
MAA 68,84,28
TR 110,25,12960
MAA 72,84,32
TR 112,25,1056
MAA 72,80,12
TR 114,25,1568
s_waitcnt lgkmcnt(6)
MAA 104,88,12
TR 116,25,13472
MAA 104,92,32
buffer_load_dwordx4 v19, s[20:23], s54 offen offset:1024 lds
MAA 100,92,28
TR 118,25,13984
MAA 100,88,8
buffer_load_dwordx4 v20, s[20:23], s54 offen offset:2048 lds
MAA 96,88,4
TR 120,25,2080
s_add_u32 s54, s54, 196608
MAA 96,92,24
TR 122,25,2592
MAA 92,92,20
TR 124,25,14496
s_add_u32 m0, s55, 0
MAA 92,88,0
buffer_load_dwordx4 v21, s[36:39], s52 offen lds
MAA 124,0,96
TR 126,25,15008
MAA 124,20,100
RD 40,23,18496
MAA 128,24,100
RD 44,23,20800
MAA 128,4,96
buffer_load_dwordx4 v28, s[36:39], s52 offen offset:1024 lds
MAA 132,8,96
RD 48,23,23104
MAA 132,28,100
RD 52,23,25408
MAA 136,32,100
RD 56,24,18496
MAA 136,12,96
buffer_load_dword v22, s[36:39], s52 offen offset:2048 lds
MAA 156,16,96
s_add_u32 s52, s52, 128
MAA 156,36,100
s_waitcnt vmcnt(16) lgkmcnt(5)
s_barrier
MAA 76,104,0
RD 60,30,18496
MAA 76,108,20
RD 64,30,20800
MAA 80,108,24
RD 68,30,23104
s_add_u32 m0, s56, 73984
MAA 80,104,4
buffer_load_dwordx4 v18, s[20:23], s54 offen lds
MAA 84,104,8
RD 72,30,25408
MAA 84,108,28
RD 76,31,18496
MAA 88,108,32
MAA 88,104,12
buffer_load_dwordx4 v19, s[20:23], s54 offen offset:1024 lds
MAA 244,104,16
TR 80,25,24832
MAA 244,108,36
TR 82,25,25344
MAA 120,116,32
TR 84,25,37248
MAA 120,112,12
buffer_load_dwordx4 v20, s[20:23], s54 offen offset:2048 lds
MAA 116,112,8
TR 86,25,37760
s_add_u32 s54, s54, 196608
MAA 116,116,28
MAA 112,116,24
TR 88,25,25856
MAA 112,112,4
TR 90,25,26368
MAA 108,112,0
TR 92,25,38272
s_add_u32 m0, s55, 2304
MAA 108,116,20
buffer_load_dwordx4 v21, s[36:39], s53 offen lds
MAA 140,20,124
TR 94,25,38784
MAA 140,0,120
MAA 144,4,120
TR 96,25,26880
MAA 144,24,124
buffer_load_dwordx4 v28, s[36:39], s53 offen offset:1024 lds
MAA 148,28,124
TR 98,25,27392
MAA 148,8,120
TR 100,25,39296
MAA 152,12,120
TR 102,25,39808
MAA 152,32,124
buffer_load_dword v29, s[36:39], s53 offen offset:2048 lds
MAA 160,36,124
s_add_u32 s53, s53, 128
MAA 160,16,120
s_waitcnt lgkmcnt(8)
s_barrier
MAA 60,80,40
TR 104,25,24864
MAA 60,84,60
TR 106,25,25376
MAA 64,84,64
TR 108,25,37280
s_add_u32 m0, s56, 86400
MAA 64,80,44
buffer_load_dwordx4 v18, s[20:23], s54 offen lds
MAA 68,80,48
s_sub_u32 s47, s47, 1
s_cbranch_scc1 .Lx25
.Lx25b:
MAA 68,84,68
TR 110,25,37792
MAA 72,84,72
TR 112,25,25888
MAA 72,80,52
TR 114,25,26400
s_waitcnt lgkmcnt(6)
MAA 104,88,52
TR 116,25,38304
MAA 104,92,72
buffer_load_dwordx4 v19, s[20:23], s54 offen offset:1024 lds
MAA 100,92,68
TR 118,25,38816
MAA 100,88,48
buffer_load_dwordx4 v20, s[20:23], s54 offen offset:2048 lds
MAA 96,88,44
TR 120,25,26912
s_add_u32 s54, s54, 196608
MAA 96,92,64
TR 122,25,27424
MAA 92,92,60
TR 124,25,39328
s_add_u32 m0, s55, 18496
MAA 92,88,40
buffer_load_dwordx4 v21, s[36:39], s52 offen lds
MAA 124,40,96
TR 126,25,39840
MAA 124,60,100
RD 0,23,36992
MAA 128,64,100
RD 4,23,39296
MAA 128,44,96
buffer_load_dwordx4 v28, s[36:39], s52 offen offset:1024 lds
MAA 132,48,96
RD 8,23,41600
MAA 132,68,100
RD 12,23,43904
MAA 136,72,100
RD 16,24,36992
MAA 136,52,96
buffer_load_dword v22, s[36:39], s52 offen offset:2048 lds
MAA 156,56,96
s_add_u32 s52, s52, 128
MAA 156,76,100
s_waitcnt vmcnt(15) lgkmcnt(5)
s_barrier
MAA 76,104,40
RD 20,30,36992
s_add_u32 m0, s56, 98816
MAA 76,108,60
buffer_load_dwordx4 v18, s[20:23], s54 offen lds
MAA 80,108,64
RD 24,30,39296
MAA 80,104,44
RD 28,30,41600
MAA 84,104,48
RD 32,30,43904
MAA 84,108,68
buffer_load_dwordx4 v19, s[20:23], s54 offen offset:1024 lds
MAA 88,108,72
RD 36,31,36992
MAA 88,104,52
TR 80,25,49664
MAA 244,104,56
MAA 244,108,76
buffer_load_dwordx4 v20, s[20:23], s54 offen offset:2048 lds
MAA 120,116,72
TR 82,25,50176
s_add_u32 s54, s54, 196608
MAA 120,112,52
TR 84,25,62080
MAA 116,112,48
TR 86,25,62592
s_add_u32 m0, s55, 20800
MAA 116,116,68
buffer_load_dwordx4 v21, s[36:39], s53 offen lds
MAA 112,116,64
TR 88,25,50688
MAA 112,112,44
buffer_load_dwordx4 v28, s[36:39], s53 offen offset:1024 lds
MAA 108,112,40
TR 90,25,51200
MAA 108,116,60
TR 92,25,63104
MAA 140,60,124
MAA 140,40,120
buffer_load_dword v29, s[36:39], s53 offen offset:2048 lds
MAA 144,44,120
TR 94,25,63616
s_add_u32 s53, s53, 128
MAA 144,64,124
TR 96,25,51712
MAA 148,68,124
TR 98,25,52224
MAA 148,48,120
buffer_atomic_add v37, v33, s[16:19], 0 offen sc0
MAA 152,52,120
TR 100,25,64128
MAA 152,72,124
TR 102,25,64640
MAA 160,76,124
MAA 160,56,120
s_waitcnt lgkmcnt(8)
s_barrier
MAA 60,80,0
TR 104,25,49696
MAA 60,84,20
TR 106,25,50208
MAA 64,84,24
TR 108,25,62112
s_add_u32 m0, s56, 111232
MAA 64,80,4
buffer_load_dwordx4 v18, s[20:23], s54 offen lds
MAA 68,80,8
s_sub_u32 s47, s47, 1
s_cbranch_scc1 .Lx26
.Lx26b:
MAA 68,84,28
TR 110,25,62624
MAA 72,84,32
TR 112,25,50720
MAA 72,80,12
TR 114,25,51232
s_waitcnt lgkmcnt(6)
MAA 104,88,12
TR 116,25,63136
MAA 104,92,32
buffer_load_dwordx4 v19, s[20:23], s54 offen offset:1024 lds
MAA 100,92,28
TR 118,25,63648
MAA 100,88,8
buffer_load_dwordx4 v20, s[20:23], s54 offen offset:2048 lds
MAA 96,88,4
TR 120,25,51744
s_add_u32 s54, s54, 196608
MAA 96,92,24
TR 122,25,52256
MAA 92,92,20
TR 124,25,64160
s_add_u32 m0, s55, 36992
MAA 92,88,0
buffer_load_dwordx4 v21, s[36:39], s52 offen lds
MAA 124,0,96
TR 126,25,64672
MAA 124,20,100
RD 40,23,55488
MAA 128,24,100
RD 44,23,57792
MAA 128,4,96
buffer_load_dwordx4 v28, s[36:39], s52 offen offset:1024 lds
MAA 132,8,96
RD 48,23,60096
MAA 132,28,100
RD 52,23,62400
MAA 136,32,100
RD 56,24,55488
MAA 136,12,96
buffer_load_dword v22, s[36:39], s52 offen offset:2048 lds
MAA 156,16,96
s_add_u32 s52, s52, 128
MAA 156,36,100
s_waitcnt vmcnt(16) lgkmcnt(5)
s_barrier
MAA 76,104,0
RD 60,30,55488
MAA 76,108,20
RD 64,30,57792
MAA 80,108,24
RD 68,30,60096
s_add_u32 m0, s56, 123648
MAA 80,104,4
buffer_load_dwordx4 v18, s[20:23], s54 offen lds
MAA 84,104,8
RD 72,30,62400
MAA 84,108,28
RD 76,31,55488
MAA 88,108,32
MAA 88,104,12
buffer_load_dwordx4 v19, s[20:23], s54 offen offset:1024 lds
MAA 244,104,16
ds_read_b64_tr_b16 a[80:81], v25
MAA 244,108,36
TR 82,25,512
MAA 120,116,32
TR 84,25,12416
MAA 120,112,12
buffer_load_dwordx4 v20, s[20:23], s54 offen offset:2048 lds
MAA 116,112,8
TR 86,25,12928
s_add_u32 s54, s54, 196608
MAA 116,116,28
MAA 112,116,24
TR 88,25,1024
MAA 112,112,4
TR 90,25,1536
MAA 108,112,0
TR 92,25,13440
s_add_u32 m0, s55, 39296
MAA 108,116,20
buffer_load_dwordx4 v21, s[36:39], s53 offen lds
MAA 140,20,124
TR 94,25,13952
MAA 140,0,120
MAA 144,4,120
TR 96,25,2048
MAA 144,24,124
buffer_load_dwordx4 v28, s[36:39], s53 offen offset:1024 lds
MAA 148,28,124
TR 98,25,2560
MAA 148,8,120
TR 100,25,14464
MAA 152,12,120
TR 102,25,14976
MAA 152,32,124
buffer_load_dword v29, s[36:39], s53 offen offset:2048 lds
MAA 160,36,124
s_add_u32 s53, s53, 128
MAA 160,16,120
s_waitcnt lgkmcnt(8)
s_barrier
MAA 60,80,40
TR 104,25,32
MAA 60,84,60
TR 106,25,544
MAA 64,84,64
TR 108,25,12448
s_add_u32 m0, s56, 136064
MAA 64,80,44
buffer_load_dwordx4 v18, s[20:23], s54 offen lds
MAA 68,80,48
s_sub_u32 s47, s47, 1
s_cbranch_scc1 .Lx27
.Lx27b:
MAA 68,84,68
TR 110,25,12960
MAA 72,84,72
TR 112,25,1056
MAA 72,80,52
TR 114,25,1568
s_waitcnt lgkmcnt(6)
MAA 104,88,52
TR 116,25,13472
MAA 104,92,72
buffer_load_dwordx4 v19, s[20:23], s54 offen offset:1024 lds
MAA 100,92,68
TR 118,25,13984
MAA 100,88,48
buffer_load_dwordx4 v20, s[20:23], s54 offen offset:2048 lds
MAA 96,88,44
TR 120,25,2080
s_add_u32 s54, s54, 196608
MAA 96,92,64
TR 122,25,2592
MAA 92,92,60
TR 124,25,14496
s_add_u32 m0, s55, 55488
MAA 92,88,40
buffer_load_dwordx4 v21, s[36:39], s52 offen lds
MAA 124,40,96
TR 126,25,15008
MAA 124,60,100
ds_read_b128 a[0:3], v23
MAA 128,64,100
RD 4,23,2304
MAA 128,44,96
buffer_load_dwordx4 v28, s[36:39], s52 offen offset:1024 lds
MAA 132,48,96
RD 8,23,4608
MAA 132,68,100
RD 12,23,6912
MAA 136,72,100
ds_read_b128 a[16:19], v24
MAA 136,52,96
buffer_load_dword v22, s[36:39], s52 offen offset:2048 lds
MAA 156,56,96
s_add_u32 s52, s52, 128
MAA 156,76,100
s_waitcnt vmcnt(18)
v_cmp_gt_u32 vcc, v36, v37
s_nop 0
s_cbranch_vccnz .Lsp28
.Lsp28b:
s_waitcnt vmcnt(15) lgkmcnt(5)
s_barrier
MAA 76,104,40
ds_read_b128 a[20:23], v30
s_add_u32 m0, s56, 73984
MAA 76,108,60
buffer_load_dwordx4 v18, s[20:23], s54 offen lds
MAA 80,108,64
RD 24,30,2304
MAA 80,104,44
RD 28,30,4608
MAA 84,104,48
RD 32,30,6912
MAA 84,108,68
buffer_load_dwordx4 v19, s[20:23], s54 offen offset:1024 lds
MAA 88,108,72
ds_read_b128 a[36:39], v31
MAA 88,104,52
TR 80,25,24832
MAA 244,104,56
MAA 244,108,76
buffer_load_dwordx4 v20, s[20:23], s54 offen offset:2048 lds
MAA 120,116,72
TR 82,25,25344
s_add_u32 s54, s54, 196608
MAA 120,112,52
TR 84,25,37248
MAA 116,112,48
TR 86,25,37760
s_add_u32 m0, s55, 57792
MAA 116,116,68
buffer_load_dwordx4 v21, s[36:39], s53 offen lds
MAA 112,116,64
TR 88,25,25856
MAA 112,112,44
buffer_load_dwordx4 v28, s[36:39], s53 offen offset:1024 lds
MAA 108,112,40
TR 90,25,26368
MAA 108,116,60
TR 92,25,38272
MAA 140,60,124
MAA 140,40,120
buffer_load_dword v29, s[36:39], s53 offen offset:2048 lds
MAA 144,44,120
TR 94,25,38784
s_add_u32 s53, s53, 128
MAA 144,64,124
TR 96,25,26880
MAA 148,68,124
TR 98,25,27392
MAA 148,48,120
buffer_load_dwordx4 v[164:167], v26, s[16:19], s75 offen sc1
MAA 152,52,120
TR 100,25,39296
MAA 152,72,124
TR 102,25,39808
MAA 160,76,124
MAA 160,56,120
s_waitcnt lgkmcnt(8)
s_barrier
MAA 60,80,0
TR 104,25,24864
s_add_u32 m0, s56, 86400
MAA 60,84,20
buffer_load_dwordx4 v18, s[20:23], s54 offen lds
MAA 64,84,24
s_sub_u32 s47, s47, 1
s_cbranch_scc1 .Lx29
.Lx29b:
MAA 64,80,4
TR 106,25,25376
TR 108,25,37280
MAA 68,80,8
TR 110,25,37792
MAA 68,84,28
buffer_load_dwordx4 v19, s[20:23], s54 offen offset:1024 lds
MAA 72,84,32
TR 112,25,25888
MAA 72,80,12
TR 114,25,26400
s_waitcnt lgkmcnt(6)
MAA 104,88,12
MAA 104,92,32
buffer_load_dwordx4 v20, s[20:23], s54 offen offset:2048 lds
MAA 100,92,28
s_add_u32 s54, s54, 196608
s_add_u32 m0, s55, 0
MAA 100,88,8
buffer_load_dwordx4 v21, s[36:39], s52 offen lds
MAA 96,88,4
TR 116,25,38304
MAA 96,92,24
TR 118,25,38816
TR 120,25,26912
MAA 92,92,20
TR 122,25,27424
MAA 92,88,0
buffer_load_dwordx4 v28, s[36:39], s52 offen offset:1024 lds
MAA 124,0,96
TR 124,25,39328
MAA 124,20,100
TR 126,25,39840
MAA 128,24,100
RD 40,23,18496
MAA 128,4,96
buffer_load_dword v22, s[36:39], s52 offen offset:2048 lds
MAA 132,8,96
RD 44,23,20800
s_add_u32 s52, s52, 128
MAA 132,28,100
buffer_load_dwordx4 v[168:171], v26, s[16:19], s75 offen offset:1024 sc1
MAA 136,32,100
RD 48,23,23104
MAA 136,12,96
RD 52,23,25408
RD 56,24,18496
MAA 156,16,96
MAA 156,36,100
s_waitcnt vmcnt(17) lgkmcnt(5)
s_barrier
MAA 76,104,0
RD 60,30,18496
s_add_u32 m0, s56, 98816
MAA 76,108,20
buffer_load_dwordx4 v18, s[20:23], s54 offen lds
MAA 80,108,24
RD 64,30,20800
MAA 80,104,4
RD 68,30,23104
MAA 84,104,8
RD 72,30,25408
MAA 84,108,28
buffer_load_dwordx4 v19, s[20:23], s54 offen offset:1024 lds
MAA 88,108,32
RD 76,31,18496
MAA 88,104,12
TR 80,25,49664
MAA 244,104,16
MAA 244,108,36
buffer_load_dwordx4 v20, s[20:23], s54 offen offset:2048 lds
MAA 120,116,32
TR 82,25,50176
s_add_u32 s54, s54, 196608
MAA 120,112,12
TR 84,25,62080
MAA 116,112,8
TR 86,25,62592
s_add_u32 m0, s55, 2304
MAA 116,116,28
buffer_load_dwordx4 v21, s[36:39], s53 offen lds
MAA 112,116,24
TR 88,25,50688
MAA 112,112,4
buffer_load_dwordx4 v28, s[36:39], s53 offen offset:1024 lds
MAA 108,112,0
TR 90,25,51200
MAA 108,116,20
TR 92,25,63104
MAA 140,20,124
MAA 140,0,120
buffer_load_dword v29, s[36:39], s53 offen offset:2048 lds
MAA 144,4,120
TR 94,25,63616
s_add_u32 s53, s53, 128
MAA 144,24,124
TR 96,25,51712
MAA 148,28,124
TR 98,25,52224
MAA 148,8,120
buffer_load_dwordx4 v[172:175], v26, s[16:19], s75 offen offset:2048 sc1
MAA 152,12,120
TR 100,25,64128
MAA 152,32,124
TR 102,25,64640
MAA 160,36,124
MAA 160,16,120
s_waitcnt lgkmcnt(8)
s_barrier
MAA 60,80,40
TR 104,25,49696
s_add_u32 m0, s56, 111232
MAA 60,84,60
buffer_load_dwordx4 v18, s[20:23], s54 offen lds
MAA 64,84,64
s_sub_u32 s47, s47, 1
s_cbranch_scc1 .Lx30
.Lx30b:
MAA 64,80,44
TR 106,25,50208
TR 108,25,62112
MAA 68,80,48
TR 110,25,62624
MAA 68,84,68
buffer_load_dwordx4 v19, s[20:23], s54 offen offset:1024 lds
MAA 72,84,72
TR 112,25,50720
MAA 72,80,52
TR 114,25,51232
s_waitcnt lgkmcnt(6)
MAA 104,88,52
MAA 104,92,72
buffer_load_dwordx4 v20, s[20:23], s54 offen offset:2048 lds
MAA 100,92,68
s_add_u32 s54, s54, 196608
s_add_u32 m0, s55, 18496
MAA 100,88,48
buffer_load_dwordx4 v21, s[36:39], s52 offen lds
MAA 96,88,44
TR 116,25,63136
MAA 96,92,64
TR 118,25,63648
TR 120,25,51744
MAA 92,92,60
TR 122,25,52256
MAA 92,88,40
buffer_load_dwordx4 v28, s[36:39], s52 offen offset:1024 lds
MAA 124,40,96
TR 124,25,64160
MAA 124,60,100
TR 126,25,64672
MAA 128,64,100
RD 0,23,36992
MAA 128,44,96
buffer_load_dword v22, s[36:39], s52 offen offset:2048 lds
MAA 132,48,96
RD 4,23,39296
s_add_u32 s52, s52, 128
MAA 132,68,100
buffer_load_dwordx4 v[176:179], v26, s[16:19], s75 offen offset:3072 sc1
MAA 136,72,100
RD 8,23,41600
s_add_u32 s75, s75, 4096
MAA 136,52,96
RD 12,23,43904
RD 16,24,36992
MAA 156,56,96
MAA 156,76,100
s_waitcnt vmcnt(18) lgkmcnt(5)
s_barrier
MAA 76,104,40
RD 20,30,36992
s_add_u32 m0, s56, 123648
MAA 76,108,60
buffer_load_dwordx4 v18, s[20:23], s54 offen lds
MAA 80,108,64
RD 24,30,39296
s_waitcnt vmcnt(15)
v_add_f32 v164, v164, v168
MAA 80,104,44
RD 28,30,41600
MAA 84,104,48
RD 32,30,43904
MAA 84,108,68
buffer_load_dwordx4 v19, s[20:23], s54 offen offset:1024 lds
MAA 88,108,72
RD 36,31,36992
MAA 88,104,52
ds_read_b64_tr_b16 a[80:81], v25
v_add_f32 v165, v165, v169
MAA 244,104,56
MAA 244,108,76
buffer_load_dwordx4 v20, s[20:23], s54 offen offset:2048 lds
MAA 120,116,72
TR 82,25,512
s_add_u32 s54, s54, 196608
MAA 120,112,52
TR 84,25,12416
MAA 116,112,48
TR 86,25,12928
s_add_u32 m0, s55, 20800
MAA 116,116,68
buffer_load_dwordx4 v21, s[36:39], s53 offen lds
MAA 112,116,64
TR 88,25,1024
MAA 112,112,44
buffer_load_dwordx4 v28, s[36:39], s53 offen offset:1024 lds
MAA 108,112,40
TR 90,25,1536
v_add_f32 v166, v166, v170
MAA 108,116,60
TR 92,25,13440
MAA 140,60,124
MAA 140,40,120
buffer_load_dword v29, s[36:39], s53 offen offset:2048 lds
MAA 144,44,120
TR 94,25,13952
s_add_u32 s53, s53, 128
MAA 144,64,124
TR 96,25,2048
MAA 148,68,124
TR 98,25,2560
v_add_f32 v167, v167, v171
MAA 148,48,120
buffer_load_dwordx4 v[180:183], v26, s[16:19], s75 offen sc1
MAA 152,52,120
TR 100,25,14464
MAA 152,72,124
TR 102,25,14976
MAA 160,76,124
MAA 160,56,120
s_waitcnt lgkmcnt(8)
s_barrier
MAA 60,80,0
TR 104,25,32
s_add_u32 m0, s56, 136064
MAA 60,84,20
buffer_load_dwordx4 v18, s[20:23], s54 offen lds
MAA 64,84,24
s_sub_u32 s47, s47, 1
s_cbranch_scc1 .Lx31
.Lx31b:
MAA 64,80,4
TR 106,25,544
TR 108,25,12448
MAA 68,80,8
TR 110,25,12960
s_waitcnt vmcnt(15)
v_add_f32 v164, v164, v172
MAA 68,84,28
buffer_load_dwordx4 v19, s[20:23], s54 offen offset:1024 lds
MAA 72,84,32
TR 112,25,1056
MAA 72,80,12
TR 114,25,1568
s_waitcnt lgkmcnt(6)
MAA 104,88,12
v_add_f32 v165, v165, v173
MAA 104,92,32
buffer_load_dwordx4 v20, s[20:23], s54 offen offset:2048 lds
MAA 100,92,28
s_add_u32 s54, s54, 196608
s_add_u32 m0, s55, 36992
MAA 100,88,8
buffer_load_dwordx4 v21, s[36:39], s52 offen lds
MAA 96,88,4
TR 116,25,13472
MAA 96,92,24
TR 118,25,13984
TR 120,25,2080
MAA 92,92,20
TR 122,25,2592
v_add_f32 v166, v166, v174
MAA 92,88,0
buffer_load_dwordx4 v28, s[36:39], s52 offen offset:1024 lds
MAA 124,0,96
TR 124,25,14496
MAA 124,20,100
TR 126,25,15008
MAA 128,24,100
RD 40,23,55488
v_add_f32 v167, v167, v175
MAA 128,4,96
buffer_load_dword v22, s[36:39], s52 offen offset:2048 lds
MAA 132,8,96
RD 44,23,57792
s_add_u32 s52, s52, 128
MAA 132,28,100
buffer_load_dwordx4 v[184:187], v26, s[16:19], s75 offen offset:1024 sc1
MAA 136,32,100
RD 48,23,60096
MAA 136,12,96
RD 52,23,62400
RD 56,24,55488
MAA 156,16,96
MAA 156,36,100
s_waitcnt vmcnt(18) lgkmcnt(5)
s_barrier
MAA 76,104,0
RD 60,30,55488
s_waitcnt vmcnt(14)
v_add_f32 v164, v164, v176
MAA 76,108,20
RD 64,30,57792
s_add_u32 m0, s56, 73984
MAA 80,108,24
buffer_load_dwordx4 v18, s[20:23], s54 offen lds
MAA 80,104,4
RD 68,30,60096
v_add_f32 v165, v165, v177
MAA 84,104,8
RD 72,30,62400
v_add_f32 v166, v166, v178
MAA 84,108,28
buffer_load_dwordx4 v19, s[20:23], s54 offen offset:1024 lds
MAA 88,108,32
RD 76,31,55488
v_add_f32 v167, v167, v179
MAA 88,104,12
TR 80,25,24832
MAA 244,104,16
buffer_load_dwordx4 v20, s[20:23], s54 offen offset:2048 lds
MAA 244,108,36
TR 82,25,25344
s_add_u32 s54, s54, 196608
MAA 120,116,32
TR 84,25,37248
s_add_u32 m0, s55, 39296
MAA 120,112,12
buffer_load_dwordx4 v21, s[36:39], s53 offen lds
MAA 116,112,8
TR 86,25,37760
MAA 116,116,28
TR 88,25,25856
MAA 112,116,24
buffer_load_dwordx4 v28, s[36:39], s53 offen offset:1024 lds
MAA 112,112,4
TR 90,25,26368
MAA 108,112,0
TR 92,25,38272
MAA 108,116,20
buffer_load_dword v29, s[36:39], s53 offen offset:2048 lds
MAA 140,20,124
TR 94,25,38784
s_add_u32 s53, s53, 128
MAA 140,0,120
TR 96,25,26880
MAA 144,4,120
buffer_load_dwordx4 v[188:191], v26, s[16:19], s75 offen offset:2048 sc1
MAA 144,24,124
TR 98,25,27392
MAA 148,28,124
TR 100,25,39296
MAA 148,8,120
TR 102,25,39808
MAA 152,12,120
MAA 152,32,124
MAA 160,36,124
MAA 160,16,120
s_waitcnt lgkmcnt(8)
s_barrier
MAA 60,80,40
TR 104,25,24864
s_add_u32 m0, s56, 86400
MAA 60,84,60
buffer_load_dwordx4 v18, s[20:23], s54 offen lds
MAA 64,84,64
s_sub_u32 s47, s47, 1
s_cbranch_scc1 .Lx32
.Lx32b:
MAA 64,80,44
TR 106,25,25376
TR 108,25,37280
MAA 68,80,48
TR 110,25,37792
s_waitcnt vmcnt(15)
v_add_f32 v164, v164, v180
MAA 68,84,68
buffer_load_dwordx4 v19, s[20:23], s54 offen offset:1024 lds
MAA 72,84,72
TR 112,25,25888
MAA 72,80,52
TR 114,25,26400
s_waitcnt lgkmcnt(6)
MAA 104,88,52
v_add_f32 v165, v165, v181
MAA 104,92,72
buffer_load_dwordx4 v20, s[20:23], s54 offen offset:2048 lds
MAA 100,92,68
s_add_u32 s54, s54, 196608
s_add_u32 m0, s55, 55488
MAA 100,88,48
buffer_load_dwordx4 v21, s[36:39], s52 offen lds
MAA 96,88,44
TR 116,25,38304
MAA 96,92,64
TR 118,25,38816
TR 120,25,26912
MAA 92,92,60
TR 122,25,27424
v_add_f32 v166, v166, v182
MAA 92,88,40
buffer_load_dwordx4 v28, s[36:39], s52 offen offset:1024 lds
MAA 124,40,96
TR 124,25,39328
MAA 124,60,100
TR 126,25,39840
MAA 128,64,100
ds_read_b128 a[0:3], v23
v_add_f32 v167, v167, v183
MAA 128,44,96
buffer_load_dword v22, s[36:39], s52 offen offset:2048 lds
MAA 132,48,96
RD 4,23,2304
s_add_u32 s52, s52, 128
MAA 132,68,100
buffer_load_dwordx4 v[192:195], v26, s[16:19], s75 offen offset:3072 sc1
MAA 136,72,100
RD 8,23,4608
MAA 136,52,96
RD 12,23,6912
ds_read_b128 a[16:19], v24
MAA 156,56,96
MAA 156,76,100
s_waitcnt vmcnt(18) lgkmcnt(5)
s_barrier
MAA 76,104,40
ds_read_b128 a[20:23], v30
s_waitcnt vmcnt(14)
v_add_f32 v164, v164, v184
MAA 76,108,60
RD 24,30,2304
s_add_u32 m0, s56, 98816
MAA 80,108,64
buffer_load_dwordx4 v18, s[20:23], s54 offen lds
MAA 80,104,44
RD 28,30,4608
v_add_f32 v165, v165, v185
MAA 84,104,48
RD 32,30,6912
v_add_f32 v166, v166, v186
MAA 84,108,68
ds_read_b128 a[36:39], v31
v_add_f32 v167, v167, v187
MAA 88,108,72
buffer_load_dwordx4 v19, s[20:23], s54 offen offset:1024 lds
MAA 88,104,52
TR 80,25,49664
MAA 244,104,56
TR 82,25,50176
MAA 244,108,76
TR 84,25,62080
MAA 120,116,72
buffer_load_dwordx4 v20, s[20:23], s54 offen offset:2048 lds
MAA 120,112,52
TR 86,25,62592
s_add_u32 s54, s54, 196608
MAA 116,112,48
TR 88,25,50688
s_add_u32 m0, s55, 57792
MAA 116,116,68
TR 90,25,51200
MAA 112,116,64
buffer_load_dwordx4 v21, s[36:39], s53 offen lds
MAA 112,112,44
TR 92,25,63104
MAA 108,112,40
TR 94,25,63616
MAA 108,116,60
TR 96,25,51712
MAA 140,60,124
buffer_load_dwordx4 v28, s[36:39], s53 offen offset:1024 lds
MAA 140,40,120
TR 98,25,52224
MAA 144,44,120
TR 100,25,64128
MAA 144,64,124
TR 102,25,64640
MAA 148,68,124
buffer_load_dword v29, s[36:39], s53 offen offset:2048 lds
MAA 148,48,120
s_add_u32 s53, s53, 128
MAA 152,52,120
MAA 152,72,124
MAA 160,76,124
MAA 160,56,120
s_waitcnt lgkmcnt(8)
s_barrier
MAA 60,80,0
TR 104,25,49696
s_waitcnt vmcnt(13)
v_add_f32 v164, v164, v188
MAA 60,84,20
TR 106,25,50208
s_add_u32 m0, s56, 111232
MAA 64,84,24
buffer_load_dwordx4 v18, s[20:23], s54 offen lds
MAA 64,80,4
TR 108,25,62112
v_add_f32 v165, v165, v189
MAA 68,80,8
TR 110,25,62624
v_add_f32 v166, v166, v190
MAA 68,84,28
buffer_load_dwordx4 v19, s[20:23], s54 offen offset:1024 lds
MAA 72,84,32
TR 112,25,50720
v_add_f32 v167, v167, v191
MAA 72,80,12
TR 114,25,51232
s_waitcnt lgkmcnt(6)
MAA 104,88,12
buffer_load_dwordx4 v20, s[20:23], s54 offen offset:2048 lds
MAA 104,92,32
TR 116,25,63136
s_add_u32 s54, s54, 196608
MAA 100,92,28
TR 118,25,63648
s_add_u32 m0, s59, 0
MAA 100,88,8
TR 120,25,51744
s_xor_b32 s58, s87, 1048576
MAA 96,88,4
buffer_load_dwordx4 v5, s[24:27], s58 offen lds
MAA 96,92,24
TR 122,25,52256
MAA 92,92,20
TR 124,25,64160
MAA 92,88,0
buffer_load_dwordx4 v6, s[24:27], s58 offen offset:1024 lds
MAA 124,0,96
TR 126,25,64672
s_add_u32 m0, s59, 8320
MAA 124,20,100
RD 40,23,18496
s_xor_b32 s58, s87, 1179648
MAA 128,24,100
buffer_load_dwordx4 v5, s[24:27], s58 offen lds
MAA 128,4,96
RD 44,23,20800
MAA 132,8,96
RD 48,23,23104
MAA 132,28,100
buffer_load_dwordx4 v6, s[24:27], s58 offen offset:1024 lds
MAA 136,32,100
RD 52,23,25408
MAA 136,12,96
RD 56,24,18496
MAA 156,16,96
MAA 156,36,100
s_waitcnt vmcnt(17) lgkmcnt(5)
s_barrier
MAA 76,104,0
RD 60,30,18496
s_waitcnt vmcnt(13)
v_add_f32 v164, v164, v192
MAA 76,108,20
RD 64,30,20800
s_add_u32 m0, s56, 123648
MAA 80,108,24
buffer_load_dwordx4 v18, s[20:23], s54 offen lds
MAA 80,104,4
RD 68,30,23104
v_add_f32 v165, v165, v193
MAA 84,104,8
RD 72,30,25408
v_add_f32 v166, v166, v194
MAA 84,108,28
RD 76,31,18496
v_add_f32 v167, v167, v195
MAA 88,108,32
ds_read_b64_tr_b16 a[80:81], v25
MAA 88,104,12
TR 82,25,512
MAA 244,104,16
TR 84,25,12416
MAA 244,108,36
TR 86,25,12928
MAA 120,116,32
buffer_load_dwordx4 v19, s[20:23], s54 offen offset:1024 lds
MAA 120,112,12
TR 88,25,1024
MAA 116,112,8
TR 90,25,1536
MAA 116,116,28
TR 92,25,13440
MAA 112,116,24
TR 94,25,13952
MAA 112,112,4
TR 96,25,2048
MAA 108,112,0
TR 98,25,2560
MAA 108,116,20
TR 100,25,14464
MAA 140,20,124
buffer_load_dwordx4 v20, s[20:23], s54 offen offset:2048 lds
MAA 140,0,120
TR 102,25,14976
s_add_u32 s54, s54, 196608
MAA 144,4,120
MAA 144,24,124
MAA 148,28,124
MAA 148,8,120
MAA 152,12,120
MAA 152,32,124
MAA 160,36,124
MAA 160,16,120
s_waitcnt lgkmcnt(8)
s_barrier
MAA 60,80,40
TR 104,25,32
MAA 60,84,60
TR 106,25,544
s_add_u32 m0, s56, 136064
MAA 64,84,64
buffer_load_dwordx4 v18, s[20:23], s54 offen lds
MAA 64,80,44
TR 108,25,12448
MAA 68,80,48
TR 110,25,12960
MAA 68,84,68
buffer_load_dwordx4 v19, s[20:23], s54 offen offset:1024 lds
MAA 72,84,72
TR 112,25,1056
MAA 72,80,52
TR 114,25,1568
s_waitcnt lgkmcnt(6)
MAA 104,88,52
buffer_load_dwordx4 v20, s[20:23], s54 offen offset:2048 lds
MAA 104,92,72
TR 116,25,13472
s_add_u32 s54, s54, 196608
MAA 100,92,68
TR 118,25,13984
s_add_u32 m0, s59, 16640
MAA 100,88,48
TR 120,25,2080
s_xor_b32 s58, s87, 1310720
MAA 96,88,44
buffer_load_dwordx4 v5, s[24:27], s58 offen lds
MAA 96,92,64
TR 122,25,2592
MAA 92,92,60
TR 124,25,14496
MAA 92,88,40
buffer_load_dwordx4 v6, s[24:27], s58 offen offset:1024 lds
MAA 124,40,96
TR 126,25,15008
s_add_u32 m0, s59, 24960
MAA 124,60,100
RD 0,23,36992
s_xor_b32 s58, s87, 1441792
MAA 128,64,100
buffer_load_dwordx4 v5, s[24:27], s58 offen lds
MAA 128,44,96
RD 4,23,39296
MAA 132,48,96
RD 8,23,41600
MAA 132,68,100
buffer_load_dwordx4 v6, s[24:27], s58 offen offset:1024 lds
MAA 136,72,100
RD 12,23,43904
MAA 136,52,96
RD 16,24,36992
MAA 156,56,96
v_permlane32_swap_b32 v164, v166
MAA 156,76,100
v_permlane32_swap_b32 v165, v167
v_add_f32 v164, v164, v166
v_add_f32 v165, v165, v167
v_mul_f32 v164, 0xba800000, v164
v_mul_f32 v165, 0x3a800000, v165
v_fma_f32 v165, -v164, v164, v165
v_max_f32 v165, 0, v165
v_add_f32 v165, 0x3727c5ac, v165
v_rsq_f32 v166, v165
s_nop 0
v_mov_b32 v165, v166
v_mul_f32 v166, 0x3e8293ee, v166
s_waitcnt vmcnt(14) lgkmcnt(5)
s_barrier
MAA 76,104,40
ds_write_b128 v7, v[164:167]
MAA 76,108,60
ds_write_b32 v17, v164
s_add_u32 m0, s59, 74880
MAA 80,108,64
ds_write_b32 v17, v165 offset:1024
s_xor_b32 s58, s87, 131072
MAA 80,104,44
buffer_load_dwordx4 v5, s[24:27], s58 offen lds
MAA 84,104,48
RD 20,30,36992
MAA 84,108,68
RD 24,30,39296
MAA 88,108,72
RD 28,30,41600
MAA 88,104,52
RD 32,30,43904
MAA 244,104,56
RD 36,31,36992
MAA 244,108,76
buffer_load_dwordx4 v6, s[24:27], s58 offen offset:1024 lds
MAA 120,116,72
TR 80,25,24832
s_add_u32 m0, s59, 83200
MAA 120,112,52
TR 82,25,25344
s_xor_b32 s58, s87, 262144
MAA 116,112,48
TR 84,25,37248
MAA 116,116,68
TR 86,25,37760
MAA 112,116,64
TR 88,25,25856
MAA 112,112,44
buffer_load_dwordx4 v5, s[24:27], s58 offen lds
MAA 108,112,40
TR 90,25,26368
MAA 108,116,60
TR 92,25,38272
MAA 140,60,124
TR 94,25,38784
MAA 140,40,120
TR 96,25,26880
MAA 144,44,120
TR 98,25,27392
MAA 144,64,124
buffer_load_dwordx4 v6, s[24:27], s58 offen offset:1024 lds
MAA 148,68,124
TR 100,25,39296
MAA 148,48,120
TR 102,25,39808
MAA 152,52,120
MAA 152,72,124
MAA 160,76,124
MAA 160,56,120
s_waitcnt vmcnt(8) lgkmcnt(0)
s_barrier
MAA 104,88,12
TR 112,25,25888
s_add_u32 m0, s59, 33280
MAA 104,92,32
TR 114,25,26400
s_xor_b32 s58, s87, 1572864
MAA 100,92,28
buffer_load_dwordx4 v5, s[24:27], s58 offen lds
MAA 100,88,8
TR 116,25,38304
MAA 96,88,4
TR 118,25,38816
MAA 96,92,24
TR 120,25,26912
MAA 92,92,20
buffer_load_dwordx4 v6, s[24:27], s58 offen offset:1024 lds
MAA 92,88,0
TR 122,25,27424
s_add_u32 m0, s59, 41600
MAA 156,16,96
TR 124,25,39328
s_xor_b32 s58, s87, 1703936
MAA 156,36,100
TR 126,25,39840
MAA 72,84,32
buffer_load_dwordx4 v5, s[24:27], s58 offen lds
MAA 72,80,12
TR 104,25,24864
MAA 68,80,8
TR 106,25,25376
MAA 68,84,28
TR 108,25,37280
MAA 64,84,24
buffer_load_dwordx4 v6, s[24:27], s58 offen offset:1024 lds
MAA 64,80,4
TR 110,25,37792
s_xor_b32 s58, s87, 393216
MAA 60,80,0
RD 40,23,55488
MAA 60,84,20
RD 44,23,57792
s_waitcnt lgkmcnt(12)
MAA 120,112,12
RD 48,23,60096
s_waitcnt lgkmcnt(11)
MAA 120,116,32
RD 52,23,62400
MAA 116,116,28
RD 56,24,55488
MAA 116,112,8
RD 60,30,55488
MAA 112,112,4
RD 64,30,57792
MAA 112,116,24
s_waitcnt lgkmcnt(7)
s_barrier
RD 68,30,60096
MAA 108,116,20
RD 72,30,62400
s_add_u32 m0, s59, 91520
MAA 108,112,0
RD 76,31,55488
MAA 160,16,120
TR 144,25,50688
MAA 160,36,124
TR 146,25,51200
MAA 244,108,36
TR 148,25,63104
MAA 244,104,16
TR 150,25,63616
MAA 88,104,12
TR 152,25,50720
MAA 88,108,32
TR 154,25,51232
MAA 84,108,28
TR 156,25,63136
MAA 84,104,8
TR 158,25,63648
MAA 80,104,4
TR 160,25,51712
MAA 80,108,24
TR 162,25,52224
MAA 76,108,20
TR 164,25,64128
MAA 76,104,0
TR 166,25,64640
s_waitcnt lgkmcnt(10)
MAA 104,144,52
TR 168,25,51744
s_waitcnt lgkmcnt(9)
MAA 104,148,72
TR 170,25,52256
MAA 100,148,68
TR 172,25,64160
MAA 100,144,48
TR 174,25,64672
MAA 96,144,44
TR 136,25,49696
MAA 96,148,64
TR 138,25,50208
MAA 92,148,60
TR 140,25,62112
MAA 92,144,40
TR 142,25,62624
s_waitcnt lgkmcnt(14)
MAA 120,152,52
TR 128,25,49664
s_waitcnt lgkmcnt(13)
MAA 120,156,72
TR 130,25,50176
MAA 116,156,68
TR 132,25,62080
MAA 116,152,48
TR 134,25,62592
MAA 112,152,44
ds_read_b128 v[232:235], v10 offset:1792
MAA 112,156,64
ds_read_b128 v[228:231], v10 offset:1536
MAA 108,156,60
ds_read_b128 v[224:227], v10 offset:1280
MAA 108,152,40
ds_read_b128 v[220:223], v10 offset:1024
s_waitcnt lgkmcnt(15)
MAA 156,56,160
buffer_load_dwordx4 v5, s[24:27], s58 offen lds
MAA 156,76,164
s_waitcnt lgkmcnt(12)
MAA 160,76,172
MAA 160,56,168
s_waitcnt lgkmcnt(4)
s_barrier
MAA 244,136,56
buffer_load_dwordx4 v6, s[24:27], s58 offen offset:1024 lds
MAA 244,140,76
s_add_u32 m0, s59, 99840
s_xor_b32 s58, s87, 524288
MAA 88,140,72
MAA 88,136,52
MAA 84,136,48
buffer_load_dwordx4 v5, s[24:27], s58 offen lds
MAA 84,140,68
buffer_load_dwordx4 v6, s[24:27], s58 offen offset:1024 lds
s_add_u32 m0, s59, 108160
s_xor_b32 s58, s87, 655360
buffer_load_dwordx4 v5, s[24:27], s58 offen lds
buffer_load_dwordx4 v6, s[24:27], s58 offen offset:1024 lds
s_mov_b32 exec_lo, 0x10001
s_mov_b32 exec_hi, 0x10001
ds_write_b128 v13, v[244:247] offset:64
s_mov_b64 exec, 0xffff
ds_write_b32 v12, v156 offset:512
ds_write_b32 v12, v160 offset:576
s_mov_b64 exec, -1
MAA 80,136,44
MAA 80,140,64
MAA 76,140,60
MAA 76,136,40
MAA 72,128,52
MAA 72,132,72
s_waitcnt lgkmcnt(0)
s_barrier
MAA 68,128,48
ds_read_b128 v[28:31], v13
s_add_u32 m0, s59, 49920
MAA 68,132,68
ds_read_b128 v[32:35], v13 offset:64
s_xor_b32 s58, s87, 1835008
MAA 64,132,64
ds_read_b128 v[36:39], v13 offset:256
MAA 64,128,44
ds_read_b128 v[40:43], v13 offset:320
MAA 60,128,40
ds_read_b32 v44, v12 offset:512
MAA 60,132,60
ds_read_b32 v45, v12 offset:576
ds_read_b128 v[240:243], v11 offset:704
ds_read_b128 v[244:247], v11 offset:1728
ds_read_b128 v[18:21], v11 offset:448
ds_read_b128 v[22:25], v11 offset:1472
buffer_load_dwordx4 v5, s[24:27], s58 offen lds
s_waitcnt lgkmcnt(9)
v_pk_fma_f32 v[72:73], v[28:29], v[232:233], v[72:73] op_sel_hi:[1,0,1]
v_cvt_pk_bf16_f32 v176, v72, v73
v_pk_fma_f32 v[74:75], v[30:31], v[232:233], v[74:75] op_sel_hi:[1,0,1]
v_cvt_pk_bf16_f32 v177, v74, v75
s_waitcnt lgkmcnt(8)
v_pk_fma_f32 v[88:89], v[32:33], v[232:233], v[88:89] op_sel_hi:[1,0,1]
v_cvt_pk_bf16_f32 v178, v88, v89
v_pk_fma_f32 v[90:91], v[34:35], v[232:233], v[90:91] op_sel_hi:[1,0,1]
s_waitcnt lgkmcnt(7)
v_pk_fma_f32 v[104:105], v[36:37], v[232:233], v[104:105] op_sel_hi:[1,0,1]
v_pk_mul_f32 v[104:105], v[104:105], v[232:233] op_sel:[0,1] op_sel_hi:[1,1]
v_cvt_pk_bf16_f32 v196, v104, v105
v_pk_fma_f32 v[106:107], v[38:39], v[232:233], v[106:107] op_sel_hi:[1,0,1]
v_pk_mul_f32 v[106:107], v[106:107], v[232:233] op_sel:[0,1] op_sel_hi:[1,1]
v_cvt_pk_bf16_f32 v197, v106, v107
s_waitcnt lgkmcnt(6)
v_pk_fma_f32 v[120:121], v[40:41], v[232:233], v[120:121] op_sel_hi:[1,0,1]
v_pk_mul_f32 v[120:121], v[120:121], v[232:233] op_sel:[0,1] op_sel_hi:[1,1]
v_cvt_pk_bf16_f32 v198, v120, v121
v_pk_fma_f32 v[122:123], v[42:43], v[232:233], v[122:123] op_sel_hi:[1,0,1]
v_pk_mul_f32 v[122:123], v[122:123], v[232:233] op_sel:[0,1] op_sel_hi:[1,1]
v_cvt_pk_bf16_f32 v199, v122, v123
v_pk_fma_f32 v[100:101], v[36:37], v[228:229], v[100:101] op_sel_hi:[1,0,1]
v_pk_mul_f32 v[100:101], v[100:101], v[228:229] op_sel:[0,1] op_sel_hi:[1,1]
s_waitcnt lgkmcnt(3)
v_pk_fma_f32 v[156:157], v[240:241], v[44:45], v[156:157] op_sel_hi:[1,0,1]
v_pk_fma_f32 v[158:159], v[242:243], v[44:45], v[158:159] op_sel_hi:[1,0,1]
s_waitcnt lgkmcnt(2)
v_pk_mul_f32 v[156:157], v[156:157], v[244:245]
v_cvt_pk_bf16_f32 v236, v156, v157
v_pk_mul_f32 v[158:159], v[158:159], v[246:247]
v_cvt_pk_bf16_f32 v237, v158, v159
v_pk_fma_f32 v[160:161], v[240:241], v[44:45], v[160:161] op_sel:[0,1,0] op_sel_hi:[1,1,1]
v_pk_mul_f32 v[160:161], v[160:161], v[244:245]
v_cvt_pk_bf16_f32 v238, v160, v161
v_pk_fma_f32 v[162:163], v[242:243], v[44:45], v[162:163] op_sel:[0,1,0] op_sel_hi:[1,1,1]
v_pk_mul_f32 v[162:163], v[162:163], v[246:247]
v_cvt_pk_bf16_f32 v239, v162, v163
ds_write_b128 v8, v[236:239] offset:1024
v_cvt_pk_bf16_f32 v192, v100, v101
v_pk_fma_f32 v[102:103], v[38:39], v[228:229], v[102:103] op_sel_hi:[1,0,1]
v_pk_mul_f32 v[102:103], v[102:103], v[228:229] op_sel:[0,1] op_sel_hi:[1,1]
v_cvt_pk_bf16_f32 v193, v102, v103
v_pk_fma_f32 v[116:117], v[40:41], v[228:229], v[116:117] op_sel_hi:[1,0,1]
v_pk_mul_f32 v[116:117], v[116:117], v[228:229] op_sel:[0,1] op_sel_hi:[1,1]
v_cvt_pk_bf16_f32 v194, v116, v117
v_pk_fma_f32 v[118:119], v[42:43], v[228:229], v[118:119] op_sel_hi:[1,0,1]
v_pk_mul_f32 v[118:119], v[118:119], v[228:229] op_sel:[0,1] op_sel_hi:[1,1]
v_cvt_pk_bf16_f32 v195, v118, v119
v_pk_fma_f32 v[96:97], v[36:37], v[224:225], v[96:97] op_sel_hi:[1,0,1]
v_pk_mul_f32 v[96:97], v[96:97], v[224:225] op_sel:[0,1] op_sel_hi:[1,1]
v_cvt_pk_bf16_f32 v188, v96, v97
v_pk_fma_f32 v[98:99], v[38:39], v[224:225], v[98:99] op_sel_hi:[1,0,1]
v_pk_mul_f32 v[98:99], v[98:99], v[224:225] op_sel:[0,1] op_sel_hi:[1,1]
v_cvt_pk_bf16_f32 v189, v98, v99
v_pk_fma_f32 v[112:113], v[40:41], v[224:225], v[112:113] op_sel_hi:[1,0,1]
v_pk_mul_f32 v[112:113], v[112:113], v[224:225] op_sel:[0,1] op_sel_hi:[1,1]
v_cvt_pk_bf16_f32 v190, v112, v113
v_pk_fma_f32 v[114:115], v[42:43], v[224:225], v[114:115] op_sel_hi:[1,0,1]
v_pk_mul_f32 v[114:115], v[114:115], v[224:225] op_sel:[0,1] op_sel_hi:[1,1]
v_cvt_pk_bf16_f32 v191, v114, v115
v_pk_fma_f32 v[92:93], v[36:37], v[220:221], v[92:93] op_sel_hi:[1,0,1]
v_pk_mul_f32 v[92:93], v[92:93], v[220:221] op_sel:[0,1] op_sel_hi:[1,1]
v_cvt_pk_bf16_f32 v184, v92, v93
v_pk_fma_f32 v[94:95], v[38:39], v[220:221], v[94:95] op_sel_hi:[1,0,1]
v_pk_mul_f32 v[94:95], v[94:95], v[220:221] op_sel:[0,1] op_sel_hi:[1,1]
v_cvt_pk_bf16_f32 v185, v94, v95
v_pk_fma_f32 v[108:109], v[40:41], v[220:221], v[108:109] op_sel_hi:[1,0,1]
v_pk_mul_f32 v[108:109], v[108:109], v[220:221] op_sel:[0,1] op_sel_hi:[1,1]
s_waitcnt lgkmcnt(0)
s_barrier
ds_read_b128 v[180:183], v9
ds_read_b64 v[200:201], v9 offset:1024
ds_read_b64 v[210:211], v9 offset:1032
v_cvt_pk_bf16_f32 v186, v108, v109
v_pk_fma_f32 v[110:111], v[42:43], v[220:221], v[110:111] op_sel_hi:[1,0,1]
v_pk_mul_f32 v[110:111], v[110:111], v[220:221] op_sel:[0,1] op_sel_hi:[1,1]
v_cvt_pk_bf16_f32 v187, v110, v111
v_cvt_pk_bf16_f32 v179, v90, v91
v_pk_fma_f32 v[68:69], v[28:29], v[228:229], v[68:69] op_sel_hi:[1,0,1]
v_cvt_pk_bf16_f32 v172, v68, v69
v_pk_fma_f32 v[70:71], v[30:31], v[228:229], v[70:71] op_sel_hi:[1,0,1]
v_cvt_pk_bf16_f32 v173, v70, v71
v_pk_fma_f32 v[84:85], v[32:33], v[228:229], v[84:85] op_sel_hi:[1,0,1]
v_cvt_pk_bf16_f32 v174, v84, v85
v_pk_fma_f32 v[86:87], v[34:35], v[228:229], v[86:87] op_sel_hi:[1,0,1]
v_cvt_pk_bf16_f32 v175, v86, v87
v_pk_fma_f32 v[64:65], v[28:29], v[224:225], v[64:65] op_sel_hi:[1,0,1]
v_cvt_pk_bf16_f32 v168, v64, v65
v_pk_fma_f32 v[66:67], v[30:31], v[224:225], v[66:67] op_sel_hi:[1,0,1]
v_cvt_pk_bf16_f32 v169, v66, v67
v_pk_fma_f32 v[80:81], v[32:33], v[224:225], v[80:81] op_sel_hi:[1,0,1]
v_cvt_pk_bf16_f32 v170, v80, v81
v_pk_fma_f32 v[82:83], v[34:35], v[224:225], v[82:83] op_sel_hi:[1,0,1]
v_cvt_pk_bf16_f32 v171, v82, v83
v_pk_fma_f32 v[60:61], v[28:29], v[220:221], v[60:61] op_sel_hi:[1,0,1]
v_cvt_pk_bf16_f32 v164, v60, v61
v_pk_fma_f32 v[62:63], v[30:31], v[220:221], v[62:63] op_sel_hi:[1,0,1]
v_cvt_pk_bf16_f32 v165, v62, v63
v_pk_fma_f32 v[76:77], v[32:33], v[220:221], v[76:77] op_sel_hi:[1,0,1]
v_cvt_pk_bf16_f32 v166, v76, v77
v_pk_fma_f32 v[78:79], v[34:35], v[220:221], v[78:79] op_sel_hi:[1,0,1]
v_cvt_pk_bf16_f32 v167, v78, v79
s_nop 0
v_mfma_f32_16x16x32_bf16 v[120:123], v[196:199], v[176:179], v[50:53]
buffer_load_dwordx4 v6, s[24:27], s58 offen offset:1024 lds
v_mfma_f32_16x16x32_bf16 v[104:107], v[192:195], v[176:179], v[46:49]
ds_read_b128 v[240:243], v11 offset:384
s_add_u32 m0, s59, 58240
v_mfma_f32_16x16x32_bf16 v[116:119], v[192:195], v[172:175], v[50:53]
ds_read_b128 v[244:247], v11 offset:1408
s_xor_b32 s58, s87, 1966080
v_mfma_f32_16x16x32_bf16 v[100:103], v[188:191], v[172:175], v[46:49]
ds_read_b128 v[28:31], v11 offset:320
v_mfma_f32_16x16x32_bf16 v[112:115], v[188:191], v[168:171], v[50:53]
buffer_load_dwordx4 v5, s[24:27], s58 offen lds
v_mfma_f32_16x16x32_bf16 v[96:99], v[184:187], v[168:171], v[46:49]
ds_read_b128 v[32:35], v11 offset:1344
v_max3_f32 v88, v104, v105, v106
v_mfma_f32_16x16x32_bf16 v[108:111], v[184:187], v[164:167], v[50:53]
ds_read_b128 v[36:39], v11 offset:256
v_max3_f32 v89, v107, v120, v121
s_waitcnt lgkmcnt(7)
v_mfma_f32_16x16x32_bf16 v[92:95], v[180:183], v[164:167], v[46:49]
ds_read_b128 v[40:43], v11 offset:1280
v_max3_f32 v88, v88, v122, v123
MAA 136,12,96
buffer_load_dwordx4 v6, s[24:27], s58 offen offset:1024 lds
MAA 136,32,100
s_add_u32 m0, s59, 66560
s_xor_b32 s58, s87, 0
v_max_f32 v90, v88, v89
MAA 136,52,160
v_max_f32 v89, v88, v89
v_max3_f32 v84, v100, v101, v102
MAA 136,72,164
v_permlane16_swap_b32 v90, v89
MAA 152,72,172
buffer_load_dwordx4 v5, s[24:27], s58 offen lds
MAA 152,52,168
v_max_f32 v88, v90, v89
v_max_f32 v89, v90, v89
MAA 152,32,124
s_nop 0
v_permlane32_swap_b32 v88, v89
MAA 152,12,120
v_max_f32 v88, v88, v89
v_mul_f32 v88, v88, v234
v_max3_f32 v85, v103, v116, v117
v_max3_f32 v84, v84, v118, v119
v_max_f32 v86, v84, v85
v_max_f32 v85, v84, v85
v_max3_f32 v80, v96, v97, v98
v_max3_f32 v81, v99, v112, v113
v_permlane16_swap_b32 v86, v85
v_max3_f32 v80, v80, v114, v115
v_max_f32 v84, v86, v85
v_max_f32 v85, v86, v85
v_max_f32 v82, v80, v81
v_max_f32 v81, v80, v81
v_permlane32_swap_b32 v84, v85
v_max3_f32 v76, v92, v93, v94
v_max_f32 v84, v84, v85
v_mul_f32 v84, v84, v230
v_permlane16_swap_b32 v82, v81
v_max3_f32 v77, v95, v108, v109
v_max_f32 v80, v82, v81
v_max_f32 v81, v82, v81
v_max3_f32 v76, v76, v110, v111
v_max_f32 v78, v76, v77
v_permlane32_swap_b32 v80, v81
v_max_f32 v77, v76, v77
v_max_f32 v80, v80, v81
v_mul_f32 v80, v80, v226
v_permlane16_swap_b32 v78, v77
v_pk_fma_f32 v[104:105], v[104:105], v[234:235], v[88:89] op_sel_hi:[1,0,0] neg_lo:[0,0,1] neg_hi:[0,0,1]
v_max_f32 v76, v78, v77
v_max_f32 v77, v78, v77
v_pk_fma_f32 v[106:107], v[106:107], v[234:235], v[88:89] op_sel_hi:[1,0,0] neg_lo:[0,0,1] neg_hi:[0,0,1]
v_pk_fma_f32 v[120:121], v[120:121], v[234:235], v[88:89] op_sel_hi:[1,0,0] neg_lo:[0,0,1] neg_hi:[0,0,1]
v_permlane32_swap_b32 v76, v77
v_pk_fma_f32 v[122:123], v[122:123], v[234:235], v[88:89] op_sel_hi:[1,0,0] neg_lo:[0,0,1] neg_hi:[0,0,1]
v_max_f32 v76, v76, v77
v_mul_f32 v76, v76, v222
v_pk_fma_f32 v[100:101], v[100:101], v[230:231], v[84:85] op_sel_hi:[1,0,0] neg_lo:[0,0,1] neg_hi:[0,0,1]
v_pk_fma_f32 v[102:103], v[102:103], v[230:231], v[84:85] op_sel_hi:[1,0,0] neg_lo:[0,0,1] neg_hi:[0,0,1]
v_pk_fma_f32 v[116:117], v[116:117], v[230:231], v[84:85] op_sel_hi:[1,0,0] neg_lo:[0,0,1] neg_hi:[0,0,1]
v_pk_fma_f32 v[118:119], v[118:119], v[230:231], v[84:85] op_sel_hi:[1,0,0] neg_lo:[0,0,1] neg_hi:[0,0,1]
v_pk_fma_f32 v[96:97], v[96:97], v[226:227], v[80:81] op_sel_hi:[1,0,0] neg_lo:[0,0,1] neg_hi:[0,0,1]
v_pk_fma_f32 v[98:99], v[98:99], v[226:227], v[80:81] op_sel_hi:[1,0,0] neg_lo:[0,0,1] neg_hi:[0,0,1]
v_pk_fma_f32 v[112:113], v[112:113], v[226:227], v[80:81] op_sel_hi:[1,0,0] neg_lo:[0,0,1] neg_hi:[0,0,1]
v_pk_fma_f32 v[114:115], v[114:115], v[226:227], v[80:81] op_sel_hi:[1,0,0] neg_lo:[0,0,1] neg_hi:[0,0,1]
v_pk_fma_f32 v[92:93], v[92:93], v[222:223], v[76:77] op_sel_hi:[1,0,0] neg_lo:[0,0,1] neg_hi:[0,0,1]
v_pk_fma_f32 v[94:95], v[94:95], v[222:223], v[76:77] op_sel_hi:[1,0,0] neg_lo:[0,0,1] neg_hi:[0,0,1]
v_pk_fma_f32 v[108:109], v[108:109], v[222:223], v[76:77] op_sel_hi:[1,0,0] neg_lo:[0,0,1] neg_hi:[0,0,1]
v_pk_fma_f32 v[110:111], v[110:111], v[222:223], v[76:77] op_sel_hi:[1,0,0] neg_lo:[0,0,1] neg_hi:[0,0,1]
v_pk_fma_f32 v[136:137], v[18:19], v[44:45], v[136:137] op_sel_hi:[1,0,1]
v_pk_mul_f32 v[136:137], v[136:137], v[22:23]
v_pk_fma_f32 v[138:139], v[20:21], v[44:45], v[138:139] op_sel_hi:[1,0,1]
v_pk_mul_f32 v[138:139], v[138:139], v[24:25]
v_pk_fma_f32 v[152:153], v[18:19], v[44:45], v[152:153] op_sel:[0,1,0] op_sel_hi:[1,1,1]
v_pk_mul_f32 v[152:153], v[152:153], v[22:23]
v_pk_fma_f32 v[154:155], v[20:21], v[44:45], v[154:155] op_sel:[0,1,0] op_sel_hi:[1,1,1]
v_pk_mul_f32 v[154:155], v[154:155], v[24:25]
v_exp_f32 v104, v104
s_nop 0
MAA 132,8,96
buffer_load_dwordx4 v6, s[24:27], s58 offen offset:1024 lds
MAA 132,28,100
s_add_u32 m0, s59, 116480
s_xor_b32 s58, s87, 786432
v_exp_f32 v105, v105
MAA 132,48,160
v_exp_f32 v106, v106
MAA 132,68,164
v_exp_f32 v107, v107
MAA 148,68,172
buffer_load_dwordx4 v5, s[24:27], s58 offen lds
MAA 148,48,168
v_exp_f32 v120, v120
MAA 148,28,124
v_exp_f32 v121, v121
MAA 148,8,120
v_exp_f32 v122, v122
MAA 128,4,96
buffer_load_dwordx4 v6, s[24:27], s58 offen offset:1024 lds
MAA 128,24,100
s_add_u32 m0, s59, 124800
s_xor_b32 s58, s87, 917504
v_exp_f32 v123, v123
MAA 128,44,160
v_exp_f32 v100, v100
MAA 128,64,164
v_exp_f32 v101, v101
MAA 144,64,172
buffer_load_dwordx4 v5, s[24:27], s58 offen lds
MAA 144,44,168
v_exp_f32 v102, v102
MAA 144,24,124
v_exp_f32 v103, v103
MAA 144,4,120
v_exp_f32 v116, v116
MAA 124,0,96
buffer_load_dwordx4 v6, s[24:27], s58 offen offset:1024 lds
MAA 124,20,100
v_exp_f32 v117, v117
MAA 124,40,160
v_exp_f32 v118, v118
MAA 124,60,164
v_exp_f32 v119, v119
MAA 140,60,172
v_exp_f32 v96, v96
MAA 140,40,168
v_exp_f32 v97, v97
MAA 140,20,124
v_exp_f32 v98, v98
MAA 140,0,120
v_cvt_pk_bf16_f32 v72, v104, v105
v_cvt_pk_bf16_f32 v73, v106, v107
v_cvt_pk_bf16_f32 v74, v120, v121
v_cvt_pk_bf16_f32 v75, v122, v123
v_cvt_pk_bf16_f32 v68, v100, v101
v_cvt_pk_bf16_f32 v69, v102, v103
v_cvt_pk_bf16_f32 v70, v116, v117
v_cvt_pk_bf16_f32 v71, v118, v119
v_exp_f32 v99, v99
v_exp_f32 v112, v112
v_exp_f32 v113, v113
v_exp_f32 v114, v114
v_exp_f32 v115, v115
v_cvt_pk_bf16_f32 v64, v96, v97
v_cvt_pk_bf16_f32 v65, v98, v99
v_cvt_pk_bf16_f32 v66, v112, v113
v_cvt_pk_bf16_f32 v67, v114, v115
v_cvt_pk_bf16_f32 v208, v136, v137
v_cvt_pk_bf16_f32 v209, v138, v139
v_cvt_pk_bf16_f32 v218, v152, v153
v_cvt_pk_bf16_f32 v219, v154, v155
s_waitcnt lgkmcnt(5)
v_pk_fma_f32 v[132:133], v[240:241], v[44:45], v[132:133] op_sel_hi:[1,0,1]
s_waitcnt lgkmcnt(4)
v_pk_mul_f32 v[132:133], v[132:133], v[244:245]
v_cvt_pk_bf16_f32 v206, v132, v133
v_pk_fma_f32 v[134:135], v[242:243], v[44:45], v[134:135] op_sel_hi:[1,0,1]
v_pk_mul_f32 v[134:135], v[134:135], v[246:247]
v_cvt_pk_bf16_f32 v207, v134, v135
v_pk_fma_f32 v[148:149], v[240:241], v[44:45], v[148:149] op_sel:[0,1,0] op_sel_hi:[1,1,1]
v_pk_mul_f32 v[148:149], v[148:149], v[244:245]
v_cvt_pk_bf16_f32 v216, v148, v149
v_pk_fma_f32 v[150:151], v[242:243], v[44:45], v[150:151] op_sel:[0,1,0] op_sel_hi:[1,1,1]
v_pk_mul_f32 v[150:151], v[150:151], v[246:247]
v_cvt_pk_bf16_f32 v217, v150, v151
s_waitcnt lgkmcnt(3)
v_pk_fma_f32 v[128:129], v[28:29], v[44:45], v[128:129] op_sel_hi:[1,0,1]
s_waitcnt lgkmcnt(2)
v_pk_mul_f32 v[128:129], v[128:129], v[32:33]
v_cvt_pk_bf16_f32 v204, v128, v129
v_pk_fma_f32 v[130:131], v[30:31], v[44:45], v[130:131] op_sel_hi:[1,0,1]
v_pk_mul_f32 v[130:131], v[130:131], v[34:35]
v_cvt_pk_bf16_f32 v205, v130, v131
v_pk_fma_f32 v[144:145], v[28:29], v[44:45], v[144:145] op_sel:[0,1,0] op_sel_hi:[1,1,1]
v_pk_mul_f32 v[144:145], v[144:145], v[32:33]
v_cvt_pk_bf16_f32 v214, v144, v145
v_pk_fma_f32 v[146:147], v[30:31], v[44:45], v[146:147] op_sel:[0,1,0] op_sel_hi:[1,1,1]
v_pk_mul_f32 v[146:147], v[146:147], v[34:35]
v_cvt_pk_bf16_f32 v215, v146, v147
s_waitcnt lgkmcnt(1)
v_pk_fma_f32 v[124:125], v[36:37], v[44:45], v[124:125] op_sel_hi:[1,0,1]
s_waitcnt lgkmcnt(0)
v_pk_mul_f32 v[124:125], v[124:125], v[40:41]
v_cvt_pk_bf16_f32 v202, v124, v125
v_pk_fma_f32 v[126:127], v[38:39], v[44:45], v[126:127] op_sel_hi:[1,0,1]
v_pk_mul_f32 v[126:127], v[126:127], v[42:43]
v_cvt_pk_bf16_f32 v203, v126, v127
v_pk_fma_f32 v[140:141], v[36:37], v[44:45], v[140:141] op_sel:[0,1,0] op_sel_hi:[1,1,1]
v_pk_mul_f32 v[140:141], v[140:141], v[40:41]
v_cvt_pk_bf16_f32 v212, v140, v141
v_pk_fma_f32 v[142:143], v[38:39], v[44:45], v[142:143] op_sel:[0,1,0] op_sel_hi:[1,1,1]
v_pk_mul_f32 v[142:143], v[142:143], v[42:43]
v_cvt_pk_bf16_f32 v213, v142, v143
s_nop 0
v_mfma_f32_16x16x32_bf16 v[88:91], v[248:251], v[72:75], 0
v_exp_f32 v92, v92
v_mfma_f32_16x16x32_bf16 v[104:107], v[206:209], v[72:75], 0
v_exp_f32 v93, v93
v_mfma_f32_16x16x32_bf16 v[120:123], v[216:219], v[72:75], 0
v_exp_f32 v94, v94
v_mfma_f32_16x16x32_bf16 v[84:87], v[248:251], v[68:71], 0
v_exp_f32 v95, v95
v_mfma_f32_16x16x32_bf16 v[100:103], v[204:207], v[68:71], 0
v_exp_f32 v108, v108
v_mfma_f32_16x16x32_bf16 v[116:119], v[214:217], v[68:71], 0
v_exp_f32 v109, v109
v_mfma_f32_16x16x32_bf16 v[80:83], v[248:251], v[64:67], 0
v_exp_f32 v110, v110
v_mfma_f32_16x16x32_bf16 v[96:99], v[202:205], v[64:67], 0
v_exp_f32 v111, v111
v_mfma_f32_16x16x32_bf16 v[112:115], v[212:215], v[64:67], 0
v_cvt_pk_bf16_f32 v60, v92, v93
v_cvt_pk_bf16_f32 v61, v94, v95
v_cvt_pk_bf16_f32 v62, v108, v109
v_cvt_pk_bf16_f32 v63, v110, v111
v_rcp_f32 v88, v88
v_rcp_f32 v84, v84
v_mfma_f32_16x16x32_bf16 v[76:79], v[248:251], v[60:63], 0
v_rcp_f32 v80, v80
v_mfma_f32_16x16x32_bf16 v[92:95], v[200:203], v[60:63], 0
v_mfma_f32_16x16x32_bf16 v[108:111], v[210:213], v[60:63], 0
s_nop 4
v_rcp_f32 v76, v76
v_pk_mul_f32 v[104:105], v[104:105], v[88:89] op_sel_hi:[1,0]
v_pk_mul_f32 v[106:107], v[106:107], v[88:89] op_sel_hi:[1,0]
v_pk_mul_f32 v[120:121], v[120:121], v[88:89] op_sel_hi:[1,0]
v_pk_mul_f32 v[122:123], v[122:123], v[88:89] op_sel_hi:[1,0]
v_cvt_pk_bf16_f32 v176, v104, v105
v_cvt_pk_bf16_f32 v177, v106, v107
v_cvt_pk_bf16_f32 v178, v120, v121
v_cvt_pk_bf16_f32 v179, v122, v123
buffer_store_dwordx4 v[176:179], v4, s[16:19], s74 offen offset:3072 sc1
v_pk_mul_f32 v[100:101], v[100:101], v[84:85] op_sel_hi:[1,0]
v_pk_mul_f32 v[102:103], v[102:103], v[84:85] op_sel_hi:[1,0]
v_pk_mul_f32 v[116:117], v[116:117], v[84:85] op_sel_hi:[1,0]
v_pk_mul_f32 v[118:119], v[118:119], v[84:85] op_sel_hi:[1,0]
v_cvt_pk_bf16_f32 v172, v100, v101
v_cvt_pk_bf16_f32 v173, v102, v103
v_cvt_pk_bf16_f32 v174, v116, v117
v_cvt_pk_bf16_f32 v175, v118, v119
buffer_store_dwordx4 v[172:175], v4, s[16:19], s74 offen offset:2048 sc1
v_pk_mul_f32 v[96:97], v[96:97], v[80:81] op_sel_hi:[1,0]
v_pk_mul_f32 v[98:99], v[98:99], v[80:81] op_sel_hi:[1,0]
v_pk_mul_f32 v[112:113], v[112:113], v[80:81] op_sel_hi:[1,0]
v_pk_mul_f32 v[114:115], v[114:115], v[80:81] op_sel_hi:[1,0]
v_cvt_pk_bf16_f32 v168, v96, v97
v_cvt_pk_bf16_f32 v169, v98, v99
v_cvt_pk_bf16_f32 v170, v112, v113
v_cvt_pk_bf16_f32 v171, v114, v115
buffer_store_dwordx4 v[168:171], v4, s[16:19], s74 offen offset:1024 sc1
v_pk_mul_f32 v[92:93], v[92:93], v[76:77] op_sel_hi:[1,0]
v_pk_mul_f32 v[94:95], v[94:95], v[76:77] op_sel_hi:[1,0]
v_pk_mul_f32 v[108:109], v[108:109], v[76:77] op_sel_hi:[1,0]
v_pk_mul_f32 v[110:111], v[110:111], v[76:77] op_sel_hi:[1,0]
v_cvt_pk_bf16_f32 v164, v92, v93
v_cvt_pk_bf16_f32 v165, v94, v95
v_cvt_pk_bf16_f32 v166, v108, v109
v_cvt_pk_bf16_f32 v167, v110, v111
buffer_store_dwordx4 v[164:167], v4, s[16:19], s74 offen sc1
s_nop 1
.Lqkve2:
s_lshl_b32 s62, s3, 11
s_add_u32 s62, s62, s84
v_lshl_add_u32 v4, v1, 4, s62
v_lshrrev_b32 v2, 3, v1
v_cmp_eq_u32 vcc, 3, v2
v_add_u32 v2, 67108480, v4
s_nop 0
v_cndmask_b32 v4, v4, v2, vcc
v_bfe_u32 v5, v1, 3, 1
v_lshrrev_b32 v2, 4, v1
v_lshl_add_u32 v5, v2, 3, v5
s_lshl_b32 s62, s3, 1
v_add_u32 v5, s62, v5
v_mul_u32_u24 v5, 2048, v5
v_and_b32 v2, 7, v1
v_lshl_add_u32 v5, v2, 4, v5
s_lshl_b32 s62, s7, 7
v_add_u32 v5, s62, v5
v_add_u32 v6, 64512, v5
v_bfe_u32 v8, v1, 3, 2
v_mul_u32_u24 v8, 2080, v8
v_bfe_u32 v2, v1, 2, 1
v_lshl_add_u32 v8, v2, 7, v8
v_bfe_u32 v2, v1, 5, 1
v_lshl_add_u32 v8, v2, 8, v8
v_and_b32 v2, 3, v1
v_lshl_add_u32 v8, v2, 3, v8
s_mov_b32 s57, 66560
v_add_u32 v7, s57, v8
s_lshr_b32 s54, s87, 17
s_lshl_b32 s54, s54, 18
s_add_u32 s54, s54, 4194304
s_mov_b32 s52, s54
s_add_u32 s53, s54, 131072
v_accvgpr_read_b32 v32, a224
v_accvgpr_read_b32 v33, a225
v_accvgpr_read_b32 v34, a226
v_accvgpr_read_b32 v35, a227
v_accvgpr_read_b32 v36, a228
v_accvgpr_read_b32 v37, a229
v_accvgpr_read_b32 v38, a230
v_accvgpr_read_b32 v39, a231
v_accvgpr_read_b32 v40, a232
v_accvgpr_read_b32 v41, a233
v_accvgpr_read_b32 v42, a234
v_accvgpr_read_b32 v43, a235
v_accvgpr_read_b32 v44, a236
v_accvgpr_read_b32 v45, a237
v_accvgpr_read_b32 v46, a238
v_accvgpr_read_b32 v47, a239
v_accvgpr_read_b32 v48, a240
v_accvgpr_read_b32 v49, a241
v_accvgpr_read_b32 v50, a242
v_accvgpr_read_b32 v51, a243
v_accvgpr_read_b32 v52, a244
v_accvgpr_read_b32 v53, a245
v_accvgpr_read_b32 v54, a246
v_accvgpr_read_b32 v55, a247
v_accvgpr_read_b32 v56, a248
v_accvgpr_read_b32 v57, a249
v_accvgpr_read_b32 v58, a250
v_accvgpr_read_b32 v59, a251
v_accvgpr_read_b32 v60, a252
v_accvgpr_read_b32 v61, a253
v_accvgpr_read_b32 v62, a254
v_accvgpr_read_b32 v63, a255
s_lshl_b32 s62, s49, 3
s_add_u32 s62, s62, s48
s_mul_i32 s62, s62, 28672
s_add_u32 s62, s62, s51
v_lshrrev_b32 v12, 4, v1
v_mul_u32_u24 v12, 57344, v12
v_and_b32 v2, 15, v1
v_lshl_add_u32 v12, v2, 4, v12
v_add_u32 v12, s62, v12
v_add_u32 v13, 6112, v12
v_add_u32 v14, 12224, v12
v_add_u32 v15, 18336, v12
s_mul_i32 s59, s3, 4224
s_mov_b32 s58, 0
s_mov_b32 s36, s0
s_mov_b32 s37, s1
s_lshl_b32 s62, s8, 10
s_add_u32 s62, s62, 30425088
s_lshl_b32 s64, s6, 10
s_add_u32 s64, s64, 30425088
s_lshr_b32 s67, s5, 2
s_and_b32 s67, s67, 3
s_lshl_b32 s67, s67, 7
s_add_u32 s64, s64, s67
v_lshl_add_u32 v252, v1, 7, s62
v_mov_b32 v253, s64
v_mov_b32 v255, 1
s_waitcnt vmcnt(0) lgkmcnt(0)
s_cmp_lg_u32 s3, 1
s_barrier
s_cbranch_scc1 .Lnopoll34
s_mov_b64 exec, 15
buffer_atomic_add v255, v252, s[16:19], 0 offen
s_mov_b64 exec, 1
v_mov_b32 v254, 0
buffer_atomic_add v254, v253, s[16:19], 0 offen sc0
s_sleep 5
s_mov_b32 s15, 0
.Lpoll33:
v_mov_b32 v255, 0
buffer_atomic_add v255, v253, s[16:19], 0 offen sc0
s_waitcnt vmcnt(1)
v_cmp_gt_u32 vcc, 16, v254
s_add_u32 s15, s15, 1
s_cbranch_vccz .Lnopoll34r
v_mov_b32 v254, 0
buffer_atomic_add v254, v253, s[16:19], 0 offen sc0
s_waitcnt vmcnt(1)
v_cmp_gt_u32 vcc, 16, v255
s_add_u32 s15, s15, 1
s_cbranch_vccz .Lnopoll34r
s_cmp_le_u32 s15, 100000
s_cbranch_scc1 .Lpoll33
s_branch .Lnopoll34r
.Lnopoll34:
s_mov_b64 exec, 0
s_cmp_eq_u32 s3, 2
s_cbranch_scc1 .Lpad1
s_cmp_eq_u32 s3, 3
s_cbranch_scc1 .Lpad2
s_branch .Lpad3
.Lnopoll34r:
s_mov_b64 exec, -1
s_barrier
buffer_load_dwordx4 v[64:67], v4, s[16:19], s52 offen sc1
buffer_load_dwordx4 v[68:71], v4, s[16:19], s52 offen offset:1024 sc1
s_xor_b32 s52, s54, 262144
buffer_load_dwordx4 v[72:75], v4, s[16:19], s53 offen sc1
buffer_load_dwordx4 v[76:79], v4, s[16:19], s53 offen offset:1024 sc1
s_xor_b32 s53, s54, 393216
buffer_load_dwordx4 v[80:83], v4, s[16:19], s52 offen sc1
buffer_load_dwordx4 v[84:87], v4, s[16:19], s52 offen offset:1024 sc1
s_xor_b32 s52, s54, 524288
buffer_load_dwordx4 v[88:91], v4, s[16:19], s53 offen sc1
buffer_load_dwordx4 v[92:95], v4, s[16:19], s53 offen offset:1024 sc1
s_xor_b32 s53, s54, 655360
buffer_load_dwordx4 v[96:99], v4, s[16:19], s52 offen sc1
buffer_load_dwordx4 v[100:103], v4, s[16:19], s52 offen offset:1024 sc1
s_xor_b32 s52, s54, 786432
buffer_load_dwordx4 v[104:107], v4, s[16:19], s53 offen sc1
buffer_load_dwordx4 v[108:111], v4, s[16:19], s53 offen offset:1024 sc1
s_xor_b32 s53, s54, 917504
ds_read_b64_tr_b16 a[0:1], v7
TR 2,7,512
TR 16,7,1024
TR 18,7,1536
TR 4,7,32
TR 6,7,544
TR 20,7,1056
TR 22,7,1568
TR 8,7,64
TR 10,7,576
TR 24,7,1088
TR 26,7,1600
TR 12,7,96
TR 14,7,608
TR 28,7,1120
TR 30,7,1632
s_waitcnt vmcnt(8) lgkmcnt(14)
MAV 32,0,64
TR 32,7,8320
s_waitcnt lgkmcnt(13)
MAV 32,16,72
buffer_load_dwordx4 v[112:115], v4, s[16:19], s52 offen sc1
MAV 48,16,76
TR 34,7,8832
MAV 48,0,68
TR 48,7,9344
TR 50,7,9856
s_waitcnt lgkmcnt(14)
MAV 52,4,68
TR 36,7,8352
s_waitcnt lgkmcnt(13)
MAV 52,20,76
buffer_load_dwordx4 v[116:119], v4, s[16:19], s52 offen offset:1024 sc1
MAV 36,20,72
TR 38,7,8864
s_xor_b32 s52, s54, 1048576
MAV 36,4,64
TR 52,7,9376
TR 54,7,9888
s_waitcnt lgkmcnt(14)
MAV 40,8,64
TR 40,7,8384
s_waitcnt lgkmcnt(13)
MAV 40,24,72
buffer_load_dwordx4 v[120:123], v4, s[16:19], s53 offen sc1
MAV 56,24,76
TR 42,7,8896
MAV 56,8,68
TR 56,7,9408
TR 58,7,9920
s_waitcnt lgkmcnt(14)
MAV 60,12,68
TR 44,7,8416
s_waitcnt lgkmcnt(13)
MAV 60,28,76
buffer_load_dwordx4 v[124:127], v4, s[16:19], s53 offen offset:1024 sc1
MAV 44,28,72
TR 46,7,8928
s_xor_b32 s53, s54, 1179648
MAV 44,12,64
TR 60,7,9440
TR 62,7,9952
s_waitcnt vmcnt(8) lgkmcnt(8)
MAV 32,32,80
TR 0,7,16640
MAV 32,48,88
buffer_load_dwordx4 v[64:67], v4, s[16:19], s52 offen sc1
MAV 48,48,92
TR 2,7,17152
MAV 48,32,84
TR 16,7,17664
TR 18,7,18176
MAV 52,36,84
TR 4,7,16672
MAV 52,52,92
buffer_load_dwordx4 v[68:71], v4, s[16:19], s52 offen offset:1024 sc1
MAV 36,52,88
TR 6,7,17184
s_xor_b32 s52, s54, 1310720
MAV 36,36,80
TR 20,7,17696
TR 22,7,18208
s_waitcnt lgkmcnt(8)
MAV 40,40,80
TR 8,7,16704
MAV 40,56,88
buffer_load_dwordx4 v[72:75], v4, s[16:19], s53 offen sc1
MAV 56,56,92
TR 10,7,17216
MAV 56,40,84
TR 24,7,17728
TR 26,7,18240
MAV 60,44,84
TR 12,7,16736
MAV 60,60,92
buffer_load_dwordx4 v[76:79], v4, s[16:19], s53 offen offset:1024 sc1
MAV 44,60,88
TR 14,7,17248
s_xor_b32 s53, s54, 1441792
MAV 44,44,80
TR 28,7,17760
TR 30,7,18272
s_waitcnt vmcnt(8) lgkmcnt(8)
MAV 32,0,96
TR 32,7,24960
MAV 32,16,104
buffer_load_dwordx4 v[80:83], v4, s[16:19], s52 offen sc1
MAV 48,16,108
TR 34,7,25472
MAV 48,0,100
TR 48,7,25984
TR 50,7,26496
MAV 52,4,100
TR 36,7,24992
MAV 52,20,108
buffer_load_dwordx4 v[84:87], v4, s[16:19], s52 offen offset:1024 sc1
MAV 36,20,104
TR 38,7,25504
s_xor_b32 s52, s54, 1572864
MAV 36,4,96
TR 52,7,26016
TR 54,7,26528
s_waitcnt lgkmcnt(8)
MAV 40,8,96
TR 40,7,25024
MAV 40,24,104
buffer_load_dwordx4 v[88:91], v4, s[16:19], s53 offen sc1
MAV 56,24,108
TR 42,7,25536
MAV 56,8,100
TR 56,7,26048
TR 58,7,26560
MAV 60,12,100
TR 44,7,25056
MAV 60,28,108
buffer_load_dwordx4 v[92:95], v4, s[16:19], s53 offen offset:1024 sc1
MAV 44,28,104
TR 46,7,25568
s_xor_b32 s53, s54, 1703936
MAV 44,12,96
TR 60,7,26080
TR 62,7,26592
s_waitcnt vmcnt(8) lgkmcnt(8)
MAV 32,32,112
TR 0,7,33280
MAV 32,48,120
buffer_load_dwordx4 v[96:99], v4, s[16:19], s52 offen sc1
MAV 48,48,124
TR 2,7,33792
MAV 48,32,116
TR 16,7,34304
TR 18,7,34816
MAV 52,36,116
TR 4,7,33312
MAV 52,52,124
buffer_load_dwordx4 v[100:103], v4, s[16:19], s52 offen offset:1024 sc1
MAV 36,52,120
TR 6,7,33824
s_xor_b32 s52, s54, 1835008
MAV 36,36,112
TR 20,7,34336
TR 22,7,34848
s_waitcnt lgkmcnt(8)
MAV 40,40,112
TR 8,7,33344
MAV 40,56,120
buffer_load_dwordx4 v[104:107], v4, s[16:19], s53 offen sc1
MAV 56,56,124
TR 10,7,33856
MAV 56,40,116
TR 24,7,34368
TR 26,7,34880
MAV 60,44,116
TR 12,7,33376
MAV 60,60,124
buffer_load_dwordx4 v[108:111], v4, s[16:19], s53 offen offset:1024 sc1
MAV 44,60,120
TR 14,7,33888
s_xor_b32 s53, s54, 1966080
MAV 44,44,112
TR 28,7,34400
TR 30,7,34912
s_waitcnt vmcnt(8) lgkmcnt(8)
MAV 32,0,64
TR 32,7,41600
MAV 32,16,72
buffer_load_dwordx4 v[112:115], v4, s[16:19], s52 offen sc1
MAV 48,16,76
TR 34,7,42112
MAV 48,0,68
TR 48,7,42624
TR 50,7,43136
MAV 52,4,68
TR 36,7,41632
MAV 52,20,76
buffer_load_dwordx4 v[116:119], v4, s[16:19], s52 offen offset:1024 sc1
MAV 36,20,72
TR 38,7,42144
s_xor_b32 s52, s54, 2097152
MAV 36,4,64
TR 52,7,42656
TR 54,7,43168
s_waitcnt lgkmcnt(8)
MAV 40,8,64
TR 40,7,41664
MAV 40,24,72
buffer_load_dwordx4 v[120:123], v4, s[16:19], s53 offen sc1
MAV 56,24,76
TR 42,7,42176
MAV 56,8,68
TR 56,7,42688
TR 58,7,43200
MAV 60,12,68
TR 44,7,41696
MAV 60,28,76
buffer_load_dwordx4 v[124:127], v4, s[16:19], s53 offen offset:1024 sc1
MAV 44,28,72
TR 46,7,42208
s_xor_b32 s53, s54, 2228224
MAV 44,12,64
TR 60,7,42720
TR 62,7,43232
s_waitcnt vmcnt(8) lgkmcnt(8)
MAV 32,32,80
TR 0,7,49920
MAV 32,48,88
buffer_load_dwordx4 v[64:67], v4, s[16:19], s52 offen sc1
MAV 48,48,92
TR 2,7,50432
MAV 48,32,84
TR 16,7,50944
TR 18,7,51456
MAV 52,36,84
TR 4,7,49952
MAV 52,52,92
buffer_load_dwordx4 v[68:71], v4, s[16:19], s52 offen offset:1024 sc1
MAV 36,52,88
TR 6,7,50464
s_xor_b32 s52, s54, 2359296
MAV 36,36,80
TR 20,7,50976
TR 22,7,51488
s_waitcnt lgkmcnt(8)
MAV 40,40,80
TR 8,7,49984
MAV 40,56,88
buffer_load_dwordx4 v[72:75], v4, s[16:19], s53 offen sc1
MAV 56,56,92
TR 10,7,50496
MAV 56,40,84
TR 24,7,51008
TR 26,7,51520
MAV 60,44,84
TR 12,7,50016
MAV 60,60,92
buffer_load_dwordx4 v[76:79], v4, s[16:19], s53 offen offset:1024 sc1
MAV 44,60,88
TR 14,7,50528
s_xor_b32 s53, s54, 2490368
MAV 44,44,80
TR 28,7,51040
TR 30,7,51552
s_waitcnt vmcnt(8) lgkmcnt(8)
MAV 32,0,96
TR 32,7,58240
MAV 32,16,104
buffer_load_dwordx4 v[80:83], v4, s[16:19], s52 offen sc1
MAV 48,16,108
TR 34,7,58752
MAV 48,0,100
TR 48,7,59264
TR 50,7,59776
MAV 52,4,100
TR 36,7,58272
MAV 52,20,108
buffer_load_dwordx4 v[84:87], v4, s[16:19], s52 offen offset:1024 sc1
MAV 36,20,104
TR 38,7,58784
s_xor_b32 s52, s54, 2621440
MAV 36,4,96
TR 52,7,59296
TR 54,7,59808
s_waitcnt lgkmcnt(8)
MAV 40,8,96
TR 40,7,58304
MAV 40,24,104
buffer_load_dwordx4 v[88:91], v4, s[16:19], s53 offen sc1
MAV 56,24,108
TR 42,7,58816
MAV 56,8,100
TR 56,7,59328
TR 58,7,59840
MAV 60,12,100
TR 44,7,58336
MAV 60,28,108
buffer_load_dwordx4 v[92:95], v4, s[16:19], s53 offen offset:1024 sc1
MAV 44,28,104
TR 46,7,58848
s_xor_b32 s53, s54, 2752512
MAV 44,12,96
TR 60,7,59360
TR 62,7,59872
s_xor_b32 s57, s57, 66560
v_add_u32 v7, s57, v8
s_waitcnt vmcnt(8) lgkmcnt(8)
MAV 32,32,112
ds_read_b64_tr_b16 a[0:1], v7
MAV 32,48,120
buffer_load_dwordx4 v[96:99], v4, s[16:19], s52 offen sc1
MAV 48,48,124
TR 2,7,512
MAV 48,32,116
TR 16,7,1024
TR 18,7,1536
MAV 52,36,116
TR 4,7,32
MAV 52,52,124
buffer_load_dwordx4 v[100:103], v4, s[16:19], s52 offen offset:1024 sc1
MAV 36,52,120
TR 6,7,544
s_xor_b32 s52, s54, 2883584
MAV 36,36,112
TR 20,7,1056
TR 22,7,1568
s_waitcnt lgkmcnt(8)
MAV 40,40,112
TR 8,7,64
MAV 40,56,120
buffer_load_dwordx4 v[104:107], v4, s[16:19], s53 offen sc1
MAV 56,56,124
TR 10,7,576
MAV 56,40,116
TR 24,7,1088
TR 26,7,1600
MAV 60,44,116
TR 12,7,96
MAV 60,60,124
buffer_load_dwordx4 v[108:111], v4, s[16:19], s53 offen offset:1024 sc1
MAV 44,60,120
TR 14,7,608
s_xor_b32 s53, s54, 3014656
MAV 44,44,112
TR 28,7,1120
TR 30,7,1632
s_waitcnt vmcnt(8) lgkmcnt(8)
MAV 32,0,64
TR 32,7,8320
MAV 32,16,72
buffer_load_dwordx4 v[112:115], v4, s[16:19], s52 offen sc1
MAV 48,16,76
TR 34,7,8832
MAV 48,0,68
TR 48,7,9344
TR 50,7,9856
MAV 52,4,68
TR 36,7,8352
MAV 52,20,76
buffer_load_dwordx4 v[116:119], v4, s[16:19], s52 offen offset:1024 sc1
MAV 36,20,72
TR 38,7,8864
s_xor_b32 s52, s54, 3145728
MAV 36,4,64
TR 52,7,9376
TR 54,7,9888
s_waitcnt lgkmcnt(8)
MAV 40,8,64
TR 40,7,8384
MAV 40,24,72
buffer_load_dwordx4 v[120:123], v4, s[16:19], s53 offen sc1
MAV 56,24,76
TR 42,7,8896
MAV 56,8,68
TR 56,7,9408
TR 58,7,9920
MAV 60,12,68
TR 44,7,8416
MAV 60,28,76
buffer_load_dwordx4 v[124:127], v4, s[16:19], s53 offen offset:1024 sc1
MAV 44,28,72
TR 46,7,8928
s_xor_b32 s53, s54, 3276800
MAV 44,12,64
TR 60,7,9440
TR 62,7,9952
s_waitcnt vmcnt(8) lgkmcnt(8)
MAV 32,32,80
TR 0,7,16640
MAV 32,48,88
buffer_load_dwordx4 v[64:67], v4, s[16:19], s52 offen sc1
MAV 48,48,92
TR 2,7,17152
MAV 48,32,84
TR 16,7,17664
TR 18,7,18176
MAV 52,36,84
TR 4,7,16672
MAV 52,52,92
buffer_load_dwordx4 v[68:71], v4, s[16:19], s52 offen offset:1024 sc1
MAV 36,52,88
TR 6,7,17184
s_xor_b32 s52, s54, 3407872
MAV 36,36,80
TR 20,7,17696
TR 22,7,18208
s_waitcnt lgkmcnt(8)
MAV 40,40,80
TR 8,7,16704
MAV 40,56,88
buffer_load_dwordx4 v[72:75], v4, s[16:19], s53 offen sc1
MAV 56,56,92
TR 10,7,17216
MAV 56,40,84
TR 24,7,17728
TR 26,7,18240
MAV 60,44,84
TR 12,7,16736
MAV 60,60,92
buffer_load_dwordx4 v[76:79], v4, s[16:19], s53 offen offset:1024 sc1
MAV 44,60,88
TR 14,7,17248
s_xor_b32 s53, s54, 3538944
MAV 44,44,80
TR 28,7,17760
TR 30,7,18272
s_waitcnt vmcnt(8) lgkmcnt(8)
MAV 32,0,96
TR 32,7,24960
MAV 32,16,104
buffer_load_dwordx4 v[80:83], v4, s[16:19], s52 offen sc1
MAV 48,16,108
TR 34,7,25472
MAV 48,0,100
TR 48,7,25984
TR 50,7,26496
MAV 52,4,100
TR 36,7,24992
MAV 52,20,108
buffer_load_dwordx4 v[84:87], v4, s[16:19], s52 offen offset:1024 sc1
MAV 36,20,104
TR 38,7,25504
s_xor_b32 s52, s54, 3670016
MAV 36,4,96
TR 52,7,26016
TR 54,7,26528
s_waitcnt lgkmcnt(8)
MAV 40,8,96
TR 40,7,25024
MAV 40,24,104
buffer_load_dwordx4 v[88:91], v4, s[16:19], s53 offen sc1
MAV 56,24,108
TR 42,7,25536
MAV 56,8,100
TR 56,7,26048
TR 58,7,26560
MAV 60,12,100
TR 44,7,25056
MAV 60,28,108
buffer_load_dwordx4 v[92:95], v4, s[16:19], s53 offen offset:1024 sc1
MAV 44,28,104
TR 46,7,25568
s_xor_b32 s53, s54, 3801088
MAV 44,12,96
TR 60,7,26080
TR 62,7,26592
s_waitcnt vmcnt(8) lgkmcnt(8)
MAV 32,32,112
TR 0,7,33280
MAV 32,48,120
buffer_load_dwordx4 v[96:99], v4, s[16:19], s52 offen sc1
MAV 48,48,124
TR 2,7,33792
MAV 48,32,116
TR 16,7,34304
TR 18,7,34816
MAV 52,36,116
TR 4,7,33312
MAV 52,52,124
buffer_load_dwordx4 v[100:103], v4, s[16:19], s52 offen offset:1024 sc1
MAV 36,52,120
TR 6,7,33824
s_xor_b32 s52, s54, 3932160
MAV 36,36,112
TR 20,7,34336
TR 22,7,34848
s_waitcnt lgkmcnt(8)
MAV 40,40,112
TR 8,7,33344
MAV 40,56,120
buffer_load_dwordx4 v[104:107], v4, s[16:19], s53 offen sc1
MAV 56,56,124
TR 10,7,33856
MAV 56,40,116
TR 24,7,34368
TR 26,7,34880
MAV 60,44,116
TR 12,7,33376
MAV 60,60,124
buffer_load_dwordx4 v[108:111], v4, s[16:19], s53 offen offset:1024 sc1
MAV 44,60,120
TR 14,7,33888
s_xor_b32 s53, s54, 4063232
MAV 44,44,112
TR 28,7,34400
TR 30,7,34912
.Lpad1:
s_cbranch_execz .Lpad4
s_waitcnt vmcnt(8) lgkmcnt(8)
MAV 32,0,64
TR 32,7,41600
MAV 32,16,72
buffer_load_dwordx4 v[112:115], v4, s[16:19], s52 offen sc1
MAV 48,16,76
TR 34,7,42112
MAV 48,0,68
TR 48,7,42624
TR 50,7,43136
MAV 52,4,68
TR 36,7,41632
MAV 52,20,76
buffer_load_dwordx4 v[116:119], v4, s[16:19], s52 offen offset:1024 sc1
MAV 36,20,72
TR 38,7,42144
MAV 36,4,64
TR 52,7,42656
TR 54,7,43168
s_waitcnt lgkmcnt(8)
MAV 40,8,64
TR 40,7,41664
MAV 40,24,72
buffer_load_dwordx4 v[120:123], v4, s[16:19], s53 offen sc1
MAV 56,24,76
TR 42,7,42176
MAV 56,8,68
TR 56,7,42688
TR 58,7,43200
MAV 60,12,68
TR 44,7,41696
MAV 60,28,76
buffer_load_dwordx4 v[124:127], v4, s[16:19], s53 offen offset:1024 sc1
MAV 44,28,72
TR 46,7,42208
MAV 44,12,64
TR 60,7,42720
TR 62,7,43232
s_barrier
s_waitcnt vmcnt(8) lgkmcnt(8)
MAV 32,32,80
TR 0,7,49920
s_add_u32 m0, s59, 84480
MAV 32,48,88
buffer_load_dwordx4 v12, s[32:35], s58 offen   lds
MAV 48,48,92
TR 2,7,50432
MAV 48,32,84
TR 16,7,50944
TR 18,7,51456
MAV 52,36,84
TR 4,7,49952
MAV 52,52,92
buffer_load_dwordx4 v13, s[32:35], s58 offen offset:1056   lds
MAV 36,52,88
TR 6,7,50464
MAV 36,36,80
TR 20,7,50976
TR 22,7,51488
s_waitcnt lgkmcnt(8)
MAV 40,40,80
TR 8,7,49984
MAV 40,56,88
buffer_load_dwordx4 v14, s[32:35], s58 offen offset:2112   lds
MAV 56,56,92
TR 10,7,50496
MAV 56,40,84
TR 24,7,51008
TR 26,7,51520
MAV 60,44,84
TR 12,7,50016
MAV 60,60,92
buffer_load_dwordx4 v15, s[32:35], s58 offen offset:3168   lds
MAV 44,60,88
TR 14,7,50528
MAV 44,44,80
TR 28,7,51040
TR 30,7,51552
s_waitcnt vmcnt(8) lgkmcnt(8)
MAV 32,0,96
TR 32,7,58240
s_add_u32 m0, s59, 101376
MAV 32,16,104
buffer_load_dwordx4 v12, s[80:83], s58 offen   lds
MAV 48,16,108
TR 34,7,58752
MAV 48,0,100
TR 48,7,59264
TR 50,7,59776
MAV 52,4,100
TR 36,7,58272
MAV 52,20,108
buffer_load_dwordx4 v13, s[80:83], s58 offen offset:1056   lds
MAV 36,20,104
TR 38,7,58784
MAV 36,4,96
TR 52,7,59296
TR 54,7,59808
s_waitcnt lgkmcnt(8)
MAV 40,8,96
TR 40,7,58304
MAV 40,24,104
buffer_load_dwordx4 v14, s[80:83], s58 offen offset:2112   lds
MAV 56,24,108
TR 42,7,58816
MAV 56,8,100
TR 56,7,59328
TR 58,7,59840
MAV 60,12,100
TR 44,7,58336
MAV 60,28,108
buffer_load_dwordx4 v15, s[80:83], s58 offen offset:3168   lds
MAV 44,28,104
TR 46,7,58848
s_add_u32 s58, s58, 458752
MAV 44,12,96
TR 60,7,59360
TR 62,7,59872
s_waitcnt vmcnt(11) lgkmcnt(14)
MAV 32,32,112
s_add_u32 m0, s59, 118272
s_lshl_b32 s64, s6, 14
s_lshl_b32 s65, s49, 13
s_waitcnt vmcnt(9) lgkmcnt(12)
MAV 32,48,120
buffer_load_dwordx4 v12, s[32:35], s58 offen   lds
s_waitcnt vmcnt(9)
MAV 48,48,124
s_add_u32 s64, s64, s65
s_lshl_b32 s65, s7, 9
s_add_u32 s64, s64, s65
MAV 48,32,116
s_lshl_b32 s65, s48, 8
s_add_u32 s64, s64, s65
s_add_u32 s64, s64, 29622272
s_waitcnt lgkmcnt(10)
MAV 52,36,116
s_lshl_b32 s62, s7, 18
v_and_b32 v152, 31, v1
v_lshlrev_b32 v152, 3, v152
s_waitcnt lgkmcnt(8)
MAV 52,52,124
buffer_load_dwordx4 v13, s[32:35], s58 offen offset:1056   lds
MAV 36,52,120
s_add_u32 s62, s62, 8388608
v_lshrrev_b32 v153, 5, v1
v_lshl_add_u32 v152, v153, 28, v152
MAV 36,36,112
s_add_u32 s63, s62, 131072
v_cvt_pk_bf16_f32 v128, v32, v33
v_cvt_pk_bf16_f32 v129, v34, v35
s_waitcnt lgkmcnt(6)
MAV 40,40,112
v_cvt_pk_bf16_f32 v136, v48, v49
v_cvt_pk_bf16_f32 v137, v50, v51
s_waitcnt lgkmcnt(4)
MAV 40,56,120
buffer_load_dwordx4 v14, s[32:35], s58 offen offset:2112   lds
MAV 56,56,124
v_cvt_pk_bf16_f32 v130, v36, v37
v_cvt_pk_bf16_f32 v131, v38, v39
MAV 56,40,116
v_cvt_pk_bf16_f32 v138, v52, v53
v_cvt_pk_bf16_f32 v139, v54, v55
s_waitcnt lgkmcnt(2)
MAV 60,44,116
v_cvt_pk_bf16_f32 v132, v40, v41
v_cvt_pk_bf16_f32 v133, v42, v43
s_waitcnt lgkmcnt(0)
MAV 60,60,124
buffer_load_dwordx4 v15, s[32:35], s58 offen offset:3168   lds
MAV 44,60,120
v_cvt_pk_bf16_f32 v140, v56, v57
v_cvt_pk_bf16_f32 v141, v58, v59
MAV 44,44,112
s_nop 2
v_cvt_pk_bf16_f32 v142, v60, v61
v_cvt_pk_bf16_f32 v143, v62, v63
v_pk_mul_f32 v[146:147], v[32:33], v[32:33]
buffer_store_dwordx4 v[128:131], v4, s[16:19], s62 offen sc1
v_pk_mul_f32 v[150:151], v[48:49], v[48:49]
v_pk_fma_f32 v[146:147], v[34:35], v[34:35], v[146:147]
v_pk_add_f32 v[144:145], v[32:33], v[34:35]
v_pk_fma_f32 v[150:151], v[50:51], v[50:51], v[150:151]
v_cvt_pk_bf16_f32 v134, v44, v45
v_cvt_pk_bf16_f32 v135, v46, v47
v_pk_add_f32 v[148:149], v[48:49], v[50:51]
v_pk_fma_f32 v[146:147], v[36:37], v[36:37], v[146:147]
v_pk_add_f32 v[144:145], v[144:145], v[36:37]
v_pk_fma_f32 v[150:151], v[52:53], v[52:53], v[150:151]
v_pk_add_f32 v[148:149], v[148:149], v[52:53]
v_pk_fma_f32 v[146:147], v[38:39], v[38:39], v[146:147]
v_pk_add_f32 v[144:145], v[144:145], v[38:39]
buffer_store_dwordx4 v[132:135], v4, s[16:19], s63 offen sc1
v_pk_fma_f32 v[150:151], v[54:55], v[54:55], v[150:151]
v_pk_add_f32 v[148:149], v[148:149], v[54:55]
v_pk_fma_f32 v[146:147], v[40:41], v[40:41], v[146:147]
v_pk_add_f32 v[144:145], v[144:145], v[40:41]
v_pk_fma_f32 v[150:151], v[56:57], v[56:57], v[150:151]
v_pk_add_f32 v[148:149], v[148:149], v[56:57]
v_pk_fma_f32 v[146:147], v[42:43], v[42:43], v[146:147]
v_pk_add_f32 v[144:145], v[144:145], v[42:43]
v_pk_fma_f32 v[150:151], v[58:59], v[58:59], v[150:151]
v_pk_add_f32 v[148:149], v[148:149], v[58:59]
v_pk_fma_f32 v[146:147], v[44:45], v[44:45], v[146:147]
v_pk_add_f32 v[144:145], v[144:145], v[44:45]
v_pk_fma_f32 v[150:151], v[60:61], v[60:61], v[150:151]
buffer_store_dwordx4 v[136:139], v4, s[16:19], s62 offen offset:1024 sc1
v_pk_add_f32 v[148:149], v[148:149], v[60:61]
v_pk_fma_f32 v[146:147], v[46:47], v[46:47], v[146:147]
v_pk_add_f32 v[144:145], v[144:145], v[46:47]
v_pk_fma_f32 v[150:151], v[62:63], v[62:63], v[150:151]
v_pk_add_f32 v[148:149], v[148:149], v[62:63]
v_add_f32 v144, v144, v145
v_add_f32 v146, v146, v147
v_add_f32 v148, v148, v149
v_add_f32 v150, v150, v151
s_nop 0
v_permlane16_swap_b32 v144, v148
buffer_store_dwordx4 v[140:143], v4, s[16:19], s63 offen offset:1024 sc1
v_permlane16_swap_b32 v146, v150
v_add_f32 v144, v144, v148
v_add_f32 v146, v146, v150
s_nop 1
v_permlane32_swap_b32 v144, v146
v_add_f32 v144, v144, v146
s_nop 1
v_permlane32_swap_b32 v144, v145
buffer_store_dwordx2 v[144:145], v152, s[16:19], s64 offen sc1
s_nop 1
v_accvgpr_write_b32 a224, v32
v_accvgpr_write_b32 a225, v33
v_accvgpr_write_b32 a226, v34
v_accvgpr_write_b32 a227, v35
v_accvgpr_write_b32 a228, v36
v_accvgpr_write_b32 a229, v37
v_accvgpr_write_b32 a230, v38
v_accvgpr_write_b32 a231, v39
v_accvgpr_write_b32 a232, v40
v_accvgpr_write_b32 a233, v41
v_accvgpr_write_b32 a234, v42
v_accvgpr_write_b32 a235, v43
v_accvgpr_write_b32 a236, v44
v_accvgpr_write_b32 a237, v45
v_accvgpr_write_b32 a238, v46
v_accvgpr_write_b32 a239, v47
v_accvgpr_write_b32 a240, v48
v_accvgpr_write_b32 a241, v49
v_accvgpr_write_b32 a242, v50
v_accvgpr_write_b32 a243, v51
v_accvgpr_write_b32 a244, v52
v_accvgpr_write_b32 a245, v53
v_accvgpr_write_b32 a246, v54
v_accvgpr_write_b32 a247, v55
v_accvgpr_write_b32 a248, v56
v_accvgpr_write_b32 a249, v57
v_accvgpr_write_b32 a250, v58
v_accvgpr_write_b32 a251, v59
v_accvgpr_write_b32 a252, v60
v_accvgpr_write_b32 a253, v61
v_accvgpr_write_b32 a254, v62
v_accvgpr_write_b32 a255, v63
s_lshl_b32 s62, s10, 14
s_lshl_b32 s63, s3, 12
s_add_u32 s62, s62, s63
s_lshl_b32 s63, s12, 11
s_add_u32 s62, s62, s63
v_lshl_add_u32 v10, v1, 4, s62
v_lshrrev_b32 v2, 3, v1
v_cmp_eq_u32 vcc, 3, v2
v_add_u32 v2, 67108480, v10
s_nop 0
v_cndmask_b32 v10, v10, v2, vcc
v_xor_b32 v11, 2048, v10
v_bfe_u32 v16, v1, 2, 3
v_mul_u32_u24 v16, 1056, v16
v_bfe_u32 v2, v1, 5, 1
v_lshl_add_u32 v16, v2, 8, v16
v_and_b32 v2, 3, v1
v_lshl_add_u32 v16, v2, 3, v16
s_lshl_b32 s62, s12, 6
s_add_u32 s62, s62, 84480
s_xor_b32 s63, s12, 1
s_mul_i32 s63, s63, 192
s_add_u32 s63, s63, 84480
v_add_u32 v17, s63, v16
v_add_u32 v16, s62, v16
s_mov_b32 s52, 8388608
s_mov_b32 s53, 8388608
s_mov_b32 s54, s58
s_mov_b32 s55, s59
s_mul_i32 s59, s3, 2112
s_and_b32 s62, s7, 1
s_mul_i32 s62, s62, 3670016
s_lshr_b32 s63, s7, 1
s_lshl_b32 s63, s63, 8
s_add_u32 s62, s62, s63
s_lshl_b32 s63, s3, 12
s_add_u32 s62, s62, s63
v_lshrrev_b32 v5, 4, v1
v_lshlrev_b32 v5, 14, v5
v_and_b32 v2, 15, v1
v_lshl_add_u32 v5, v2, 4, v5
v_add_u32 v5, s62, v5
v_add_u32 v6, 992, v5
s_lshl_b32 s62, s10, 15
s_lshl_b32 s63, s3, 13
s_add_u32 s62, s62, s63
v_lshl_add_u32 v4, v1, 4, s62
s_and_b32 s47, s5, 3
s_lshr_b32 s63, s5, 2
s_lshl_b32 s63, s63, 3
s_add_u32 s63, s63, s4
s_lshl_b32 s62, s63, 1
s_add_u32 s62, s62, s48
s_mul_i32 s62, s62, 1792
v_lshrrev_b32 v7, 2, v1
v_min_u32 v8, 13, v7
v_lshl_add_u32 v8, v8, 7, s62
s_lshl_b32 s62, s63, 2
s_add_u32 s62, s62, s3
s_mul_i32 s62, s62, 640
v_and_b32 v7, 7, v7
v_min_u32 v7, 4, v7
v_lshl_add_u32 v7, v7, 7, s62
v_lshrrev_b32 v2, 5, v1
v_mul_u32_u24 v2, 3670016, v2
v_add_u32 v7, v7, v2
s_mul_i32 s44, s47, 163840
s_add_u32 s45, s47, 12
s_mul_i32 s45, s45, 229376
v_and_b32 v6, 3, v1
v_cmp_eq_u32 vcc, 3, v6
v_mov_b32 v2, 0x3f80
v_mov_b32 v20, 1.0
v_cndmask_b32 v2, v2, v20, vcc
v_cndmask_b32 v6, v6, 0, vcc
v_or_b32 v6, 12, v6
v_mul_u32_u24 v6, 0x1111, v6
v_lshl_or_b32 v6, v6, 16, v6
v_bfe_u32 v22, v1, 2, 2
v_cmp_eq_u32 vcc, 0, v22
s_nop 1
v_cndmask_b32 v20, 0, v2, vcc
v_cmp_eq_u32 vcc, 1, v22
s_nop 1
v_cndmask_b32 v21, 0, v2, vcc
v_accvgpr_write_b32 a208, v20
v_accvgpr_write_b32 a209, v21
v_accvgpr_write_b32 a210, v20
v_accvgpr_write_b32 a211, v21
v_accvgpr_write_b32 a212, 0
v_accvgpr_write_b32 a213, 0
v_accvgpr_write_b32 a214, 0
v_accvgpr_write_b32 a215, 0
v_accvgpr_write_b32 a216, 0
v_accvgpr_write_b32 a217, 0
v_accvgpr_write_b32 a218, 0
v_accvgpr_write_b32 a219, 0
s_cmp_lt_u32 s3, 2
s_cselect_b32 s40, s32, s80
s_cselect_b32 s41, s33, s81
s_cselect_b32 s42, s34, s82
s_add_u32 s62, s55, 84480
v_lshl_add_u32 v9, v1, 4, s62
s_lshl_b32 s62, s6, 10
s_add_u32 s62, s62, 30441472
s_lshl_b32 s64, s10, 1
s_lshl_b32 s64, s64, 10
s_add_u32 s64, s64, 30441472
s_lshr_b32 s67, s5, 2
s_and_b32 s67, s67, 3
s_lshl_b32 s67, s67, 7
s_add_u32 s64, s64, s67
s_add_u32 s65, s64, 1024
v_lshl_add_u32 v252, v1, 7, s62
v_mov_b32 v253, s64
v_mov_b32 v255, 1
v_writelane_b32 v253, s65, 1
s_waitcnt vmcnt(0) lgkmcnt(0)
s_cmp_lg_u32 s3, 1
s_barrier
s_cbranch_scc1 .Lnopoll37
s_mov_b64 exec, 15
buffer_atomic_add v255, v252, s[16:19], 0 offen
s_mov_b64 exec, 3
v_mov_b32 v254, 0
buffer_atomic_add v254, v253, s[16:19], 0 offen sc0
s_sleep 5
s_mov_b32 s15, 0
.Lpoll36:
v_mov_b32 v255, 0
buffer_atomic_add v255, v253, s[16:19], 0 offen sc0
s_waitcnt vmcnt(1)
v_cmp_gt_u32 vcc, 16, v254
s_add_u32 s15, s15, 1
s_cbranch_vccz .Lnopoll37r
v_mov_b32 v254, 0
buffer_atomic_add v254, v253, s[16:19], 0 offen sc0
s_waitcnt vmcnt(1)
v_cmp_gt_u32 vcc, 16, v255
s_add_u32 s15, s15, 1
s_cbranch_vccz .Lnopoll37r
s_cmp_le_u32 s15, 100000
s_cbranch_scc1 .Lpoll36
s_branch .Lnopoll37r
.Lnopoll37:
s_mov_b64 exec, 0
s_cmp_eq_u32 s3, 2
s_cbranch_scc1 .Lpad6
s_cmp_eq_u32 s3, 3
s_cbranch_scc1 .Lpad7
s_branch .Lpad8
.Lnopoll37r:
s_mov_b64 exec, -1
s_barrier
buffer_load_dwordx4 a[128:131], v10, s[16:19], s52 offen sc1
buffer_load_dwordx4 a[132:135], v10, s[16:19], s52 offen offset:1024 sc1
s_add_u32 s52, s52, 131072
buffer_load_dwordx4 a[144:147], v10, s[16:19], s52 offen sc1
buffer_load_dwordx4 a[148:151], v10, s[16:19], s52 offen offset:1024 sc1
s_add_u32 s52, s52, 131072
buffer_load_dwordx4 a[136:139], v11, s[16:19], s53 offen sc1
buffer_load_dwordx4 a[140:143], v11, s[16:19], s53 offen offset:1024 sc1
s_add_u32 s53, s53, 131072
buffer_load_dwordx4 a[152:155], v11, s[16:19], s53 offen sc1
buffer_load_dwordx4 a[156:159], v11, s[16:19], s53 offen offset:1024 sc1
s_add_u32 s53, s53, 131072
ds_read_b64_tr_b16 a[0:1], v16
TR 2,16,512
TR 4,16,8448
TR 6,16,8960
TR 8,16,32
TR 10,16,544
TR 12,16,8480
TR 14,16,8992
TR 16,16,64
TR 18,16,576
TR 20,16,8512
TR 22,16,9024
TR 24,16,96
TR 26,16,608
TR 28,16,8544
TR 30,16,9056
TR 32,16,128
TR 34,16,640
TR 36,16,8576
TR 38,16,9088
TR 40,16,160
TR 42,16,672
TR 44,16,8608
TR 46,16,9120
ds_read_b64_tr_b16 a[48:49], v17
TR 50,17,512
TR 52,17,8448
TR 54,17,8960
TR 56,17,32
TR 58,17,544
TR 60,17,8480
TR 62,17,8992
ds_read_b128 a[192:195], v9
RD 196,9,1056
RD 200,9,2112
RD 204,9,3168
s_add_u32 m0, s55, 135168
s_nop 0
buffer_load_dwordx4 v12, s[80:83], s54 offen   lds
buffer_load_dwordx4 v13, s[80:83], s54 offen offset:1056   lds
buffer_load_dwordx4 v14, s[80:83], s54 offen offset:2112   lds
buffer_load_dwordx4 v15, s[80:83], s54 offen offset:3168   lds
s_add_u32 s54, s54, 458752
s_lshl_b32 s57, s3, 13
s_add_u32 s57, s57, 49920
v_lshl_add_u32 v2, v1, 4, s57
s_waitcnt lgkmcnt(0)
s_barrier
s_waitcnt vmcnt(11)
v_mfma_f32_16x16x32_bf16 v[32:35], a[0:3], a[128:131], 0
buffer_load_dwordx4 a[160:163], v10, s[16:19], s52 offen sc1
s_waitcnt vmcnt(10)
MAA 32,4,144
TR 64,16,16896
v_smfmac_f32_16x16x64_bf16 a[212:215], a[208:211], a[192:199], v6
TR 66,16,17408
v_smfmac_f32_16x16x64_bf16 a[212:215], a[208:211], a[200:207], v6
TR 68,16,25344
v_mfma_f32_16x16x32_bf16 v[36:39], a[0:3], a[132:135], 0
TR 70,16,25856
s_waitcnt vmcnt(9)
MAA 36,4,148
buffer_load_dwordx4 a[164:167], v10, s[16:19], s52 offen offset:1024 sc1
v_mfma_f32_16x16x32_bf16 v[52:55], a[8:11], a[132:135], 0
TR 72,16,16928
s_add_u32 s52, s52, 131072
MAA 52,12,148
TR 74,16,17440
v_mfma_f32_16x16x32_bf16 v[48:51], a[8:11], a[128:131], 0
TR 76,16,25376
MAA 48,12,144
TR 78,16,25888
v_mfma_f32_16x16x32_bf16 v[96:99], a[16:19], a[128:131], 0
buffer_load_dwordx4 a[176:179], v10, s[16:19], s52 offen sc1
MAA 96,20,144
TR 80,16,16960
v_mfma_f32_16x16x32_bf16 v[100:103], a[16:19], a[132:135], 0
TR 82,16,17472
MAA 100,20,148
TR 84,16,25408
v_mfma_f32_16x16x32_bf16 v[116:119], a[24:27], a[132:135], 0
TR 86,16,25920
MAA 116,28,148
buffer_load_dwordx4 a[180:183], v10, s[16:19], s52 offen offset:1024 sc1
v_mfma_f32_16x16x32_bf16 v[112:115], a[24:27], a[128:131], 0
TR 88,16,16992
s_add_u32 s52, s52, 131072
MAA 112,28,144
TR 90,16,17504
v_mfma_f32_16x16x32_bf16 v[160:163], a[32:35], a[128:131], 0
TR 92,16,25440
MAA 160,36,144
TR 94,16,25952
v_mfma_f32_16x16x32_bf16 v[164:167], a[32:35], a[132:135], 0
buffer_load_dwordx4 a[168:171], v11, s[16:19], s53 offen sc1
MAA 164,36,148
TR 96,16,17024
v_mfma_f32_16x16x32_bf16 v[180:183], a[40:43], a[132:135], 0
TR 98,16,17536
MAA 180,44,148
TR 100,16,25472
v_mfma_f32_16x16x32_bf16 v[176:179], a[40:43], a[128:131], 0
TR 102,16,25984
MAA 176,44,144
buffer_load_dwordx4 a[172:175], v11, s[16:19], s53 offen offset:1024 sc1
v_mfma_f32_16x16x32_bf16 v[224:227], a[48:51], a[128:131], 0
TR 104,16,17056
s_add_u32 s53, s53, 131072
MAA 224,52,144
TR 106,16,17568
v_mfma_f32_16x16x32_bf16 v[228:231], a[48:51], a[132:135], 0
TR 108,16,25504
MAA 228,52,148
TR 110,16,26016
v_mfma_f32_16x16x32_bf16 v[236:239], a[56:59], a[132:135], 0
buffer_load_dwordx4 a[184:187], v11, s[16:19], s53 offen sc1
MAA 236,60,148
TR 112,17,16896
v_mfma_f32_16x16x32_bf16 v[232:235], a[56:59], a[128:131], 0
TR 114,17,17408
MAA 232,60,144
TR 116,17,25344
s_waitcnt vmcnt(11)
v_mfma_f32_16x16x32_bf16 v[188:191], a[40:43], a[140:143], 0
TR 118,17,25856
MAA 188,44,156
buffer_load_dwordx4 a[188:191], v11, s[16:19], s53 offen offset:1024 sc1
v_mfma_f32_16x16x32_bf16 v[184:187], a[40:43], a[136:139], 0
TR 120,17,16928
s_add_u32 s53, s53, 131072
MAA 184,44,152
TR 122,17,17440
s_add_u32 m0, s55, 84480
v_mfma_f32_16x16x32_bf16 v[168:171], a[32:35], a[136:139], 0
TR 124,17,25376
MAA 168,36,152
TR 126,17,25888
v_mfma_f32_16x16x32_bf16 v[172:175], a[32:35], a[140:143], 0
buffer_load_dwordx4 v12, s[32:35], s54 offen   lds
MAA 172,36,156
RD 192,9,16896
v_mfma_f32_16x16x32_bf16 v[124:127], a[24:27], a[140:143], 0
RD 196,9,17952
MAA 124,28,156
RD 200,9,19008
v_mfma_f32_16x16x32_bf16 v[120:123], a[24:27], a[136:139], 0
RD 204,9,20064
MAA 120,28,152
buffer_load_dwordx4 v13, s[32:35], s54 offen offset:1056   lds
v_mfma_f32_16x16x32_bf16 v[104:107], a[16:19], a[136:139], 0
MAA 104,20,152
v_mfma_f32_16x16x32_bf16 v[108:111], a[16:19], a[140:143], 0
MAA 108,20,156
v_mfma_f32_16x16x32_bf16 v[60:63], a[8:11], a[140:143], 0
buffer_load_dwordx4 v14, s[32:35], s54 offen offset:2112   lds
MAA 60,12,156
v_mfma_f32_16x16x32_bf16 v[56:59], a[8:11], a[136:139], 0
MAA 56,12,152
v_mfma_f32_16x16x32_bf16 v[40:43], a[0:3], a[136:139], 0
MAA 40,4,152
.Lpad2:
s_cbranch_execz .Lpad5
buffer_load_dwordx4 v15, s[32:35], s54 offen offset:3168   lds
v_mfma_f32_16x16x32_bf16 v[44:47], a[0:3], a[140:143], 0
MAA 44,4,156
s_waitcnt lgkmcnt(0)
s_barrier
v_mfma_f32_16x16x32_bf16 v[64:67], a[64:67], a[128:131], 0
TR 0,16,33792
s_add_u32 m0, s55, 101376
MAA 64,68,144
buffer_load_dwordx4 v12, s[80:83], s54 offen   lds
v_smfmac_f32_16x16x64_bf16 a[216:219], a[208:211], a[192:199], v6
TR 2,16,34304
s_mul_i32 s66, s13, 114688
v_smfmac_f32_16x16x64_bf16 a[216:219], a[208:211], a[200:207], v6
TR 4,16,42240
s_mul_i32 s65, s10, 1818624
v_mfma_f32_16x16x32_bf16 v[68:71], a[64:67], a[132:135], 0
TR 6,16,42752
s_add_u32 s66, s66, s65
MAA 68,68,148
TR 8,16,33824
s_add_u32 s66, s66, 12582912
v_mfma_f32_16x16x32_bf16 v[84:87], a[72:75], a[132:135], 0
buffer_load_dwordx4 v13, s[80:83], s54 offen offset:1056   lds
MAA 84,76,148
TR 10,16,34336
s_add_u32 s65, s66, 49152
v_mfma_f32_16x16x32_bf16 v[80:83], a[72:75], a[128:131], 0
TR 12,16,42272
s_lshl_b32 s62, s12, 16
MAA 80,76,144
TR 14,16,42784
s_add_u32 s62, s62, s66
v_mfma_f32_16x16x32_bf16 v[128:131], a[80:83], a[128:131], 0
TR 16,16,33856
s_add_u32 s63, s62, 16384
MAA 128,84,144
buffer_load_dwordx4 v14, s[80:83], s54 offen offset:2112   lds
v_mfma_f32_16x16x32_bf16 v[132:135], a[80:83], a[132:135], 0
TR 18,16,34368
s_add_u32 s64, s62, 32768
MAA 132,84,148
TR 20,16,42304
s_lshl_b32 s72, s10, 1
v_mfma_f32_16x16x32_bf16 v[148:151], a[88:91], a[132:135], 0
TR 22,16,42816
s_lshr_b32 s74, s11, 4
MAA 148,92,148
TR 24,16,33888
s_add_u32 s72, s72, s74
v_mfma_f32_16x16x32_bf16 v[144:147], a[88:91], a[128:131], 0
buffer_load_dwordx4 v15, s[80:83], s54 offen offset:3168   lds
MAA 144,92,144
TR 26,16,34400
s_add_u32 s54, s54, 458752
v_mfma_f32_16x16x32_bf16 v[192:195], a[96:99], a[128:131], 0
TR 28,16,42336
s_add_u32 m0, s57, 0
MAA 192,100,144
TR 30,16,42848
s_mov_b32 s58, 29622272
v_mfma_f32_16x16x32_bf16 v[196:199], a[96:99], a[132:135], 0
TR 32,16,33920
s_lshl_b32 s72, s72, 10
MAA 196,100,148
buffer_load_dwordx4 v4, s[16:19], s58 offen sc1 lds
v_mfma_f32_16x16x32_bf16 v[212:215], a[104:107], a[132:135], 0
TR 34,16,34432
s_add_u32 s72, s72, 30457856
MAA 212,108,148
TR 36,16,42368
s_and_b32 s73, s6, 14
v_mfma_f32_16x16x32_bf16 v[208:211], a[104:107], a[128:131], 0
TR 38,16,42880
s_and_b32 s74, s7, 1
MAA 208,108,144
TR 40,16,33952
s_add_u32 s73, s73, s74
v_mfma_f32_16x16x32_bf16 v[240:243], a[112:115], a[128:131], 0
buffer_load_dwordx4 v4, s[16:19], s58 offen offset:1024 sc1 lds
MAA 240,116,144
TR 42,16,34464
s_lshl_b32 s73, s73, 10
v_mfma_f32_16x16x32_bf16 v[244:247], a[112:115], a[132:135], 0
TR 44,16,42400
s_add_u32 s73, s73, 30457856
MAA 244,116,148
TR 46,16,42912
s_lshr_b32 s67, s5, 2
v_mfma_f32_16x16x32_bf16 v[252:255], a[120:123], a[132:135], 0
TR 48,17,33792
MAA 252,124,148
TR 50,17,34304
v_mfma_f32_16x16x32_bf16 v[248:251], a[120:123], a[128:131], 0
buffer_load_dwordx4 a[128:131], v10, s[16:19], s52 offen sc1
MAA 248,124,144
TR 52,17,42240
v_mfma_f32_16x16x32_bf16 v[220:223], a[104:107], a[140:143], 0
TR 54,17,42752
MAA 220,108,156
TR 56,17,33824
v_mfma_f32_16x16x32_bf16 v[216:219], a[104:107], a[136:139], 0
TR 58,17,34336
MAA 216,108,152
buffer_load_dwordx4 a[132:135], v10, s[16:19], s52 offen offset:1024 sc1
v_mfma_f32_16x16x32_bf16 v[200:203], a[96:99], a[136:139], 0
TR 60,17,42272
s_add_u32 s52, s52, 131072
MAA 200,100,152
TR 62,17,42784
v_mfma_f32_16x16x32_bf16 v[204:207], a[96:99], a[140:143], 0
RD 192,9,33792
MAA 204,100,156
RD 196,9,34848
v_mfma_f32_16x16x32_bf16 v[156:159], a[88:91], a[140:143], 0
buffer_load_dwordx4 a[144:147], v10, s[16:19], s52 offen sc1
MAA 156,92,156
RD 200,9,35904
v_mfma_f32_16x16x32_bf16 v[152:155], a[88:91], a[136:139], 0
RD 204,9,36960
MAA 152,92,152
v_mfma_f32_16x16x32_bf16 v[136:139], a[80:83], a[136:139], 0
MAA 136,84,152
buffer_load_dwordx4 a[148:151], v10, s[16:19], s52 offen offset:1024 sc1
v_mfma_f32_16x16x32_bf16 v[140:143], a[80:83], a[140:143], 0
s_add_u32 s52, s52, 131072
MAA 140,84,156
v_mfma_f32_16x16x32_bf16 v[92:95], a[72:75], a[140:143], 0
MAA 92,76,156
v_mfma_f32_16x16x32_bf16 v[88:91], a[72:75], a[136:139], 0
MAA 88,76,152
v_mfma_f32_16x16x32_bf16 v[72:75], a[64:67], a[136:139], 0
MAA 72,68,152
v_mfma_f32_16x16x32_bf16 v[76:79], a[64:67], a[140:143], 0
MAA 76,68,156
s_waitcnt vmcnt(18) lgkmcnt(0)
s_barrier
MAA 32,0,160
buffer_load_dwordx4 a[136:139], v11, s[16:19], s53 offen sc1
MAA 32,4,176
TR 64,16,50688
s_and_b32 s67, s67, 3
v_smfmac_f32_16x16x64_bf16 a[212:215], a[208:211], a[192:199], v6
TR 66,16,51200
s_lshl_b32 s67, s67, 7
v_smfmac_f32_16x16x64_bf16 a[212:215], a[208:211], a[200:207], v6
TR 68,16,59136
s_add_u32 s73, s73, s67
MAA 36,4,180
TR 70,16,59648
s_and_b32 s74, s7, 1
MAA 36,0,164
buffer_load_dwordx4 a[140:143], v11, s[16:19], s53 offen offset:1024 sc1
MAA 52,8,164
TR 72,16,50720
s_add_u32 s53, s53, 131072
MAA 52,12,180
TR 74,16,51232
s_mul_i32 s87, s74, 917504
MAA 48,12,176
TR 76,16,59168
s_lshr_b32 s75, s6, 1
MAA 48,8,160
TR 78,16,59680
s_mul_i32 s75, s75, 1818624
MAA 96,16,160
buffer_load_dwordx4 a[152:155], v11, s[16:19], s53 offen sc1
MAA 96,20,176
TR 80,16,50752
s_add_u32 s87, s87, s75
MAA 100,20,180
TR 82,16,51264
s_add_u32 s87, s87, 12582912
MAA 100,16,164
TR 84,16,59200
s_and_b32 s74, s6, 3
MAA 116,24,164
TR 86,16,59712
s_xor_b32 s75, s74, 0
MAA 116,28,180
buffer_load_dwordx4 a[156:159], v11, s[16:19], s53 offen offset:1024 sc1
MAA 112,28,176
TR 88,16,50784
s_add_u32 s53, s53, 131072
MAA 112,24,160
TR 90,16,51296
s_add_u32 m0, s55, 118272
MAA 160,32,160
TR 92,16,59232
s_sub_u32 s75, s75, 0
MAA 160,36,176
TR 94,16,59744
s_mul_i32 s98, s75, 458752
MAA 164,36,180
buffer_load_dwordx4 v12, s[32:35], s54 offen   lds
MAA 164,32,164
TR 96,16,50816
s_mul_i32 s75, s75, 114688
MAA 180,40,164
TR 98,16,51328
s_add_u32 s76, s87, s75
MAA 180,44,180
TR 100,16,59264
s_xor_b32 s75, s74, 1
MAA 176,44,176
TR 102,16,59776
s_sub_u32 s75, s75, 1
MAA 176,40,160
buffer_load_dwordx4 v13, s[32:35], s54 offen offset:1056   lds
MAA 224,48,160
TR 104,16,50848
s_mul_i32 s99, s75, 458752
MAA 224,52,176
TR 106,16,51360
s_mul_i32 s75, s75, 114688
MAA 228,52,180
TR 108,16,59296
s_add_u32 s77, s87, s75
MAA 228,48,164
TR 110,16,59808
MAA 236,56,164
buffer_load_dwordx4 v14, s[32:35], s54 offen offset:2112   lds
MAA 236,60,180
TR 112,17,50688
MAA 232,60,176
TR 114,17,51200
MAA 232,56,160
TR 116,17,59136
s_waitcnt vmcnt(21)
MAA 188,40,172
TR 118,17,59648
MAA 188,44,188
buffer_load_dwordx4 v15, s[32:35], s54 offen offset:3168   lds
MAA 184,44,184
TR 120,17,50720
s_add_u32 m0, s57, 2048
MAA 184,40,168
TR 122,17,51232
s_mov_b32 s58, 29624320
MAA 168,32,168
TR 124,17,59168
MAA 168,36,184
TR 126,17,59680
MAA 172,36,188
buffer_load_dwordx4 v4, s[16:19], s58 offen sc1 lds
MAA 172,32,172
RD 192,9,50688
MAA 124,24,172
RD 196,9,51744
MAA 124,28,188
RD 200,9,52800
MAA 120,28,184
RD 204,9,53856
MAA 120,24,168
buffer_load_dwordx4 v4, s[16:19], s58 offen offset:1024 sc1 lds
MAA 104,16,168
MAA 104,20,184
MAA 108,20,188
MAA 108,16,172
MAA 60,8,172
MAA 60,12,188
MAA 56,12,184
MAA 56,8,168
MAA 40,0,168
MAA 40,4,184
MAA 44,4,188
MAA 44,0,172
s_waitcnt vmcnt(20) lgkmcnt(0)
s_barrier
MAA 64,64,160
ds_read_b64_tr_b16 a[0:1], v16
s_add_u32 m0, s55, 135168
MAA 64,68,176
buffer_load_dwordx4 v12, s[80:83], s54 offen   lds
v_smfmac_f32_16x16x64_bf16 a[216:219], a[208:211], a[192:199], v6
TR 2,16,512
s_xor_b32 s75, s74, 2
v_smfmac_f32_16x16x64_bf16 a[216:219], a[208:211], a[200:207], v6
TR 4,16,8448
s_sub_u32 s75, s75, 2
MAA 68,68,180
TR 6,16,8960
s_mul_i32 s100, s75, 458752
MAA 68,64,164
TR 8,16,32
s_mul_i32 s75, s75, 114688
MAA 84,72,164
buffer_load_dwordx4 v13, s[80:83], s54 offen offset:1056   lds
MAA 84,76,180
TR 10,16,544
s_add_u32 s78, s87, s75
MAA 80,76,176
TR 12,16,8480
s_xor_b32 s75, s74, 3
MAA 80,72,160
TR 14,16,8992
s_sub_u32 s75, s75, 3
MAA 128,80,160
TR 16,16,64
s_mul_i32 s101, s75, 458752
MAA 128,84,176
buffer_load_dwordx4 v14, s[80:83], s54 offen offset:2112   lds
MAA 132,84,180
TR 18,16,576
s_mul_i32 s75, s75, 114688
MAA 132,80,164
TR 20,16,8512
s_add_u32 s79, s87, s75
MAA 148,88,164
TR 22,16,9024
s_and_b32 s87, s6, 3
MAA 148,92,180
TR 24,16,96
s_mov_b32 s46, 0
MAA 144,92,176
buffer_load_dwordx4 v15, s[80:83], s54 offen offset:3168   lds
MAA 144,88,160
TR 26,16,608
s_add_u32 s54, s54, 458752
MAA 192,96,160
TR 28,16,8544
s_add_u32 m0, s57, 4096
MAA 192,100,176
TR 30,16,9056
s_mov_b32 s58, 29626368
MAA 196,100,180
TR 32,16,128
s_lshl_b32 s74, s3, 10
MAA 196,96,164
buffer_load_dwordx4 v4, s[16:19], s58 offen sc1 lds
MAA 212,104,164
TR 34,16,640
s_lshl_b32 s75, s12, 9
MAA 212,108,180
TR 36,16,8576
s_add_u32 s74, s74, s75
MAA 208,108,176
TR 38,16,9088
s_add_u32 s74, s74, 152576
MAA 208,104,160
TR 40,16,160
v_and_b32 v18, 15, v1
MAA 240,112,160
buffer_load_dwordx4 v4, s[16:19], s58 offen offset:1024 sc1 lds
MAA 240,116,176
TR 42,16,672
v_lshl_add_u32 v18, v18, 4, s74
MAA 244,116,180
TR 44,16,8608
v_xor_b32 v19, 512, v18
MAA 244,112,164
TR 46,16,9120
MAA 252,120,164
ds_read_b64_tr_b16 a[48:49], v17
MAA 252,124,180
TR 50,17,512
MAA 248,124,176
TR 52,17,8448
MAA 248,120,160
buffer_load_dwordx4 a[160:163], v10, s[16:19], s52 offen sc1
MAA 220,104,172
TR 54,17,8960
MAA 220,108,188
TR 56,17,32
MAA 216,108,184
TR 58,17,544
MAA 216,104,168
TR 60,17,8480
MAA 200,96,168
buffer_load_dwordx4 a[164:167], v10, s[16:19], s52 offen offset:1024 sc1
MAA 200,100,184
TR 62,17,8992
s_add_u32 s52, s52, 131072
MAA 204,100,188
ds_read_b128 a[192:195], v9
MAA 204,96,172
RD 196,9,1056
MAA 156,88,172
RD 200,9,2112
MAA 156,92,188
buffer_load_dwordx4 a[176:179], v10, s[16:19], s52 offen sc1
MAA 152,92,184
RD 204,9,3168
MAA 152,88,168
MAA 136,80,168
MAA 136,84,184
MAA 140,84,188
buffer_load_dwordx4 a[180:183], v10, s[16:19], s52 offen offset:1024 sc1
MAA 140,80,172
s_add_u32 s52, s52, 131072
MAA 92,72,172
MAA 92,76,188
MAA 88,76,184
MAA 88,72,168
MAA 72,64,168
MAA 72,68,184
MAA 76,68,188
MAA 76,64,172
s_waitcnt vmcnt(20) lgkmcnt(0)
s_barrier
MAA 32,0,128
buffer_load_dwordx4 a[168:171], v11, s[16:19], s53 offen sc1
MAA 32,4,144
ds_read_b128 v[20:23], v2
v_smfmac_f32_16x16x64_bf16 a[212:215], a[208:211], a[192:199], v6
ds_read_b128 v[28:31], v2 offset:1024
v_smfmac_f32_16x16x64_bf16 a[212:215], a[208:211], a[200:207], v6
s_waitcnt vmcnt(11)
ds_read_b128 v[24:27], v2 offset:2048
MAA 36,4,148
TR 64,16,16896
MAA 36,0,132
buffer_load_dwordx4 a[172:175], v11, s[16:19], s53 offen offset:1024 sc1
MAA 52,8,132
TR 66,16,17408
s_add_u32 s53, s53, 131072
MAA 52,12,148
TR 68,16,25344
MAA 48,12,144
TR 70,16,25856
MAA 48,8,128
TR 72,16,16928
MAA 96,16,128
buffer_load_dwordx4 a[184:187], v11, s[16:19], s53 offen sc1
MAA 96,20,144
TR 74,16,17440
s_waitcnt lgkmcnt(7)
v_add_f32 v20, v20, v28
MAA 100,20,148
TR 76,16,25376
v_add_f32 v21, v21, v29
MAA 100,16,132
TR 78,16,25888
v_add_f32 v22, v22, v30
MAA 116,24,132
TR 80,16,16960
v_add_f32 v23, v23, v31
MAA 116,28,148
buffer_load_dwordx4 a[188:191], v11, s[16:19], s53 offen offset:1024 sc1
MAA 112,28,144
ds_read_b128 v[28:31], v2 offset:3072
s_add_u32 s53, s53, 131072
MAA 112,24,128
TR 82,16,17472
s_add_u32 m0, s55, 84480
MAA 160,32,128
TR 84,16,25408
s_waitcnt lgkmcnt(12)
v_add_f32 v20, v20, v24
MAA 160,36,144
TR 86,16,25920
v_add_f32 v21, v21, v25
MAA 164,36,148
buffer_load_dwordx4 v12, s[32:35], s54 offen   lds
MAA 164,32,132
TR 88,16,16992
v_add_f32 v22, v22, v26
MAA 180,40,132
TR 90,16,17504
v_add_f32 v23, v23, v27
MAA 180,44,148
TR 92,16,25440
MAA 176,44,144
TR 94,16,25952
MAA 176,40,128
buffer_load_dwordx4 v13, s[32:35], s54 offen offset:1056   lds
MAA 224,48,128
TR 96,16,17024
MAA 224,52,144
TR 98,16,17536
MAA 228,52,148
TR 100,16,25472
MAA 228,48,132
TR 102,16,25984
MAA 236,56,132
buffer_load_dwordx4 v14, s[32:35], s54 offen offset:2112   lds
MAA 236,60,148
TR 104,16,17056
MAA 232,60,144
TR 106,16,17568
MAA 232,56,128
TR 108,16,25504
MAA 188,40,140
TR 110,16,26016
MAA 188,44,156
buffer_load_dwordx4 v15, s[32:35], s54 offen offset:3168   lds
MAA 184,44,152
TR 112,17,16896
s_add_u32 m0, s57, 6144
MAA 184,40,136
TR 114,17,17408
s_mov_b32 s58, 29628416
MAA 168,32,136
TR 116,17,25344
MAA 168,36,152
TR 118,17,25856
MAA 172,36,156
buffer_load_dwordx4 v4, s[16:19], s58 offen sc1 lds
MAA 172,32,140
TR 120,17,16928
MAA 124,24,140
TR 122,17,17440
MAA 124,28,156
TR 124,17,25376
MAA 120,28,152
TR 126,17,25888
MAA 120,24,136
buffer_load_dwordx4 v4, s[16:19], s58 offen offset:1024 sc1 lds
MAA 104,16,136
RD 192,9,16896
MAA 104,20,152
RD 196,9,17952
MAA 108,20,156
RD 200,9,19008
MAA 108,16,140
RD 204,9,20064
MAA 60,8,140
MAA 60,12,156
MAA 56,12,152
MAA 56,8,136
MAA 40,0,136
MAA 40,4,152
MAA 44,4,156
s_sub_u32 s47, s47, 1
s_cbranch_scc1 .Lx39
.Lx39b:
MAA 44,0,140
s_waitcnt lgkmcnt(0)
s_barrier
MAA 64,64,128
s_waitcnt vmcnt(14)
ds_read_b128 v[24:27], v2 offset:4096
s_add_u32 m0, s55, 101376
MAA 64,68,144
buffer_load_dwordx4 v12, s[80:83], s54 offen   lds
v_smfmac_f32_16x16x64_bf16 a[216:219], a[208:211], a[192:199], v6
TR 0,16,33792
v_add_f32 v20, v20, v28
v_smfmac_f32_16x16x64_bf16 a[216:219], a[208:211], a[200:207], v6
TR 2,16,34304
v_add_f32 v21, v21, v29
MAA 68,68,148
TR 4,16,42240
v_add_f32 v22, v22, v30
MAA 68,64,132
TR 6,16,42752
.Lpad3:
s_cbranch_execz .Lnopoll34r
v_add_f32 v23, v23, v31
MAA 84,72,132
ds_read_b128 v[28:31], v2 offset:5120
MAA 84,76,148
TR 8,16,33824
MAA 80,76,144
buffer_load_dwordx4 v13, s[80:83], s54 offen offset:1056   lds
MAA 80,72,128
TR 10,16,34336
s_waitcnt lgkmcnt(7)
v_add_f32 v20, v20, v24
MAA 128,80,128
TR 12,16,42272
v_add_f32 v21, v21, v25
MAA 128,84,144
TR 14,16,42784
v_add_f32 v22, v22, v26
MAA 132,84,148
TR 16,16,33856
v_add_f32 v23, v23, v27
MAA 132,80,132
TR 18,16,34368
MAA 148,88,132
TR 20,16,42304
MAA 148,92,148
buffer_load_dwordx4 v14, s[80:83], s54 offen offset:2112   lds
MAA 144,92,144
TR 22,16,42816
MAA 144,88,128
TR 24,16,33888
MAA 192,96,128
TR 26,16,34400
MAA 192,100,144
TR 28,16,42336
MAA 196,100,148
TR 30,16,42848
MAA 196,96,132
TR 32,16,33920
MAA 212,104,132
buffer_load_dwordx4 v15, s[80:83], s54 offen offset:3168   lds
MAA 212,108,148
TR 34,16,34432
s_add_u32 s54, s54, 458752
MAA 208,108,144
TR 36,16,42368
MAA 208,104,128
TR 38,16,42880
MAA 240,112,128
TR 40,16,33952
MAA 240,116,144
TR 42,16,34464
MAA 244,116,148
TR 44,16,42400
MAA 244,112,132
TR 46,16,42912
MAA 252,120,132
TR 48,17,33792
MAA 252,124,148
TR 50,17,34304
MAA 248,124,144
TR 52,17,42240
MAA 248,120,128
buffer_load_dwordx4 a[128:131], v10, s[16:19], s52 offen sc1
MAA 220,104,140
TR 54,17,42752
MAA 220,108,156
TR 56,17,33824
MAA 216,108,152
TR 58,17,34336
MAA 216,104,136
TR 60,17,42272
MAA 200,96,136
TR 62,17,42784
MAA 200,100,152
RD 192,9,33792
MAA 204,100,156
buffer_load_dwordx4 a[132:135], v10, s[16:19], s52 offen offset:1024 sc1
MAA 204,96,140
RD 196,9,34848
s_add_u32 s52, s52, 131072
MAA 156,88,140
RD 200,9,35904
MAA 156,92,156
RD 204,9,36960
MAA 152,92,152
MAA 152,88,136
MAA 136,80,136
MAA 136,84,152
buffer_load_dwordx4 a[144:147], v10, s[16:19], s52 offen sc1
MAA 140,84,156
MAA 140,80,140
MAA 92,72,140
MAA 92,76,156
MAA 88,76,152
MAA 88,72,136
MAA 72,64,136
buffer_load_dwordx4 a[148:151], v10, s[16:19], s52 offen offset:1024 sc1
MAA 72,68,152
s_add_u32 s52, s52, 131072
MAA 76,68,156
s_sub_u32 s47, s47, 1
s_cbranch_scc1 .Lx40
.Lx40b:
MAA 76,64,140
s_waitcnt vmcnt(18) lgkmcnt(0)
s_barrier
MAA 32,0,160
buffer_load_dwordx4 a[136:139], v11, s[16:19], s53 offen sc1
MAA 32,4,176
s_waitcnt vmcnt(9)
ds_read_b128 v[24:27], v2 offset:6144
v_add_f32 v20, v20, v28
v_smfmac_f32_16x16x64_bf16 a[212:215], a[208:211], a[192:199], v6
TR 64,16,50688
v_add_f32 v21, v21, v29
v_smfmac_f32_16x16x64_bf16 a[212:215], a[208:211], a[200:207], v6
TR 66,16,51200
v_add_f32 v22, v22, v30
MAA 36,4,180
TR 68,16,59136
v_add_f32 v23, v23, v31
MAA 36,0,164
ds_read_b128 v[28:31], v2 offset:7168
MAA 52,8,164
TR 70,16,59648
MAA 52,12,180
buffer_load_dwordx4 a[140:143], v11, s[16:19], s53 offen offset:1024 sc1
MAA 48,12,176
TR 72,16,50720
s_add_u32 s53, s53, 131072
MAA 48,8,160
TR 74,16,51232
s_waitcnt lgkmcnt(7)
v_add_f32 v20, v20, v24
MAA 96,16,160
TR 76,16,59168
v_add_f32 v21, v21, v25
MAA 96,20,176
TR 78,16,59680
v_add_f32 v22, v22, v26
MAA 100,20,180
TR 80,16,50752
v_add_f32 v23, v23, v27
MAA 100,16,164
TR 82,16,51264
s_waitcnt lgkmcnt(7)
v_add_f32 v20, v20, v28
MAA 116,24,164
buffer_load_dwordx4 a[152:155], v11, s[16:19], s53 offen sc1
MAA 116,28,180
TR 84,16,59200
v_add_f32 v21, v21, v29
MAA 112,28,176
TR 86,16,59712
v_add_f32 v22, v22, v30
MAA 112,24,160
TR 88,16,50784
v_add_f32 v23, v23, v31
MAA 160,32,160
TR 90,16,51296
MAA 160,36,176
TR 92,16,59232
MAA 164,36,180
TR 94,16,59744
MAA 164,32,164
buffer_load_dwordx4 a[156:159], v11, s[16:19], s53 offen offset:1024 sc1
MAA 180,40,164
TR 96,16,50816
s_add_u32 s53, s53, 131072
MAA 180,44,180
TR 98,16,51328
s_add_u32 m0, s55, 118272
MAA 176,44,176
TR 100,16,59264
MAA 176,40,160
TR 102,16,59776
MAA 224,48,160
TR 104,16,50848
MAA 224,52,176
TR 106,16,51360
MAA 228,52,180
buffer_load_dwordx4 v12, s[32:35], s54 offen   lds
MAA 228,48,164
TR 108,16,59296
MAA 236,56,164
TR 110,16,59808
MAA 236,60,180
TR 112,17,50688
MAA 232,60,176
TR 114,17,51200
MAA 232,56,160
TR 116,17,59136
MAA 188,40,172
TR 118,17,59648
MAA 188,44,188
buffer_load_dwordx4 v13, s[32:35], s54 offen offset:1056   lds
MAA 184,44,184
TR 120,17,50720
MAA 184,40,168
TR 122,17,51232
MAA 168,32,168
TR 124,17,59168
MAA 168,36,184
TR 126,17,59680
MAA 172,36,188
RD 192,9,50688
MAA 172,32,172
RD 196,9,51744
MAA 124,24,172
buffer_load_dwordx4 v14, s[32:35], s54 offen offset:2112   lds
MAA 124,28,188
RD 200,9,52800
MAA 120,28,184
RD 204,9,53856
MAA 120,24,168
MAA 104,16,168
MAA 104,20,184
MAA 108,20,188
MAA 108,16,172
buffer_load_dwordx4 v15, s[32:35], s54 offen offset:3168   lds
MAA 60,8,172
MAA 60,12,188
MAA 56,12,184
MAA 56,8,168
MAA 40,0,168
MAA 40,4,184
MAA 44,4,188
s_sub_u32 s47, s47, 1
s_cbranch_scc1 .Lx41
.Lx41b:
MAA 44,0,172
s_waitcnt lgkmcnt(0)
s_barrier
MAA 64,64,160
ds_read_b64_tr_b16 a[0:1], v16
s_add_u32 m0, s55, 135168
MAA 64,68,176
buffer_load_dwordx4 v12, s[80:83], s54 offen   lds
v_smfmac_f32_16x16x64_bf16 a[216:219], a[208:211], a[192:199], v6
TR 2,16,512
v_permlane32_swap_b32 v20, v22
v_smfmac_f32_16x16x64_bf16 a[216:219], a[208:211], a[200:207], v6
TR 4,16,8448
v_permlane32_swap_b32 v21, v23
MAA 68,68,180
TR 6,16,8960
v_add_f32 v20, v20, v22
MAA 68,64,164
TR 8,16,32
v_add_f32 v21, v21, v23
MAA 84,72,164
TR 10,16,544
v_mul_f32 v20, 0xba800000, v20
MAA 84,76,180
buffer_load_dwordx4 v13, s[80:83], s54 offen offset:1056   lds
MAA 80,76,176
TR 12,16,8480
v_mul_f32 v21, 0x3a800000, v21
MAA 80,72,160
TR 14,16,8992
v_fma_f32 v21, -v20, v20, v21
MAA 128,80,160
TR 16,16,64
v_max_f32 v21, 0, v21
MAA 128,84,176
TR 18,16,576
v_add_f32 v21, 0x3727c5ac, v21
MAA 132,84,180
TR 20,16,8512
v_rsq_f32 v22, v21
MAA 132,80,164
TR 22,16,9024
v_and_b32 v24, 31, v1
MAA 148,88,164
buffer_load_dwordx4 v14, s[80:83], s54 offen offset:2112   lds
MAA 148,92,180
TR 24,16,96
v_lshrrev_b32 v25, 5, v1
MAA 144,92,176
TR 26,16,608
v_lshl_add_u32 v24, v24, 1, v25
MAA 144,88,160
TR 28,16,8544
v_and_b32 v25, 0xc0, v0
MAA 192,96,160
TR 30,16,9056
v_add_u32 v24, v24, v25
MAA 192,100,176
TR 32,16,128
v_lshlrev_b32 v24, 4, v24
MAA 196,100,180
TR 34,16,640
v_add_u32 v24, 152576, v24
MAA 196,96,164
buffer_load_dwordx4 v15, s[80:83], s54 offen offset:3168   lds
MAA 212,104,164
TR 36,16,8576
s_add_u32 s54, s54, 458752
MAA 212,108,180
TR 38,16,9088
v_mul_f32 v22, 0xbfb8aa3b, v22
MAA 208,108,176
ds_write_b128 v24, v[20:23]
s_mov_b32 s58, s98
MAA 208,104,160
ds_read_b64 v[20:21], v18
s_mov_b32 s67, s59
MAA 240,112,160
ds_read_b64 v[22:23], v18 offset:256
MAA 240,116,176
ds_read_b64 v[24:25], v19
MAA 244,116,180
ds_read_b64 v[26:27], v19 offset:256
MAA 244,112,164
ds_read_b32 v28, v18 offset:8
MAA 252,120,164
ds_read_b32 v29, v18 offset:264
v_mov_b32 v18, v5
MAA 252,124,180
ds_read_b32 v30, v19 offset:8
MAA 248,124,176
ds_read_b32 v31, v19 offset:264
v_add_u32 v19, 992, v5
MAA 248,120,160
buffer_load_dwordx4 a[160:163], v10, s[16:19], s52 offen sc1
MAA 220,104,172
TR 40,16,160
MAA 220,108,188
TR 42,16,672
MAA 216,108,184
TR 44,16,8608
MAA 216,104,168
TR 46,16,9120
MAA 200,96,168
ds_read_b64_tr_b16 a[48:49], v17
MAA 200,100,184
TR 50,17,512
MAA 204,100,188
buffer_load_dwordx4 a[164:167], v10, s[16:19], s52 offen offset:1024 sc1
MAA 204,96,172
TR 52,17,8448
s_add_u32 s52, s52, 131072
MAA 156,88,172
TR 54,17,8960
MAA 156,92,188
TR 56,17,32
MAA 152,92,184
TR 58,17,544
MAA 152,88,168
TR 60,17,8480
MAA 136,80,168
TR 62,17,8992
MAA 136,84,184
buffer_load_dwordx4 a[176:179], v10, s[16:19], s52 offen sc1
MAA 140,84,188
ds_read_b128 a[192:195], v9
MAA 140,80,172
RD 196,9,1056
MAA 92,72,172
RD 200,9,2112
MAA 92,76,188
RD 204,9,3168
MAA 88,76,184
MAA 88,72,168
MAA 72,64,168
buffer_load_dwordx4 a[180:183], v10, s[16:19], s52 offen offset:1024 sc1
MAA 72,68,184
s_add_u32 s52, s52, 131072
MAA 76,68,188
s_sub_u32 s47, s47, 1
s_cbranch_scc1 .Lx42
.Lx42b:
MAA 76,64,172
s_mov_b32 s15, -5
.p2align 6
.Lk43:
s_waitcnt vmcnt(16) lgkmcnt(0)
s_barrier
MAA 32,0,128
TR 64,16,16896
MAA 32,4,144
buffer_load_dwordx4 a[168:171], v11, s[16:19], s53 offen sc1
v_smfmac_f32_16x16x64_bf16 a[212:215], a[208:211], a[192:199], v6
s_sub_u32 s47, s47, 1
s_cbranch_scc1 .Lx44
.Lx44b:
v_smfmac_f32_16x16x64_bf16 a[212:215], a[208:211], a[200:207], v6
TR 66,16,17408
MAA 36,4,148
TR 68,16,25344
MAA 36,0,132
TR 70,16,25856
MAA 52,8,132
TR 72,16,16928
MAA 52,12,148
buffer_load_dwordx4 a[172:175], v11, s[16:19], s53 offen offset:1024 sc1
MAA 48,12,144
TR 74,16,17440
s_add_u32 s53, s53, 131072
MAA 48,8,128
MAA 96,16,128
TR 76,16,25376
MAA 96,20,144
TR 78,16,25888
MAA 100,20,148
TR 80,16,16960
MAA 100,16,132
buffer_load_dwordx4 a[184:187], v11, s[16:19], s53 offen sc1
MAA 116,24,132
TR 82,16,17472
MAA 116,28,148
TR 84,16,25408
MAA 112,28,144
MAA 112,24,128
TR 86,16,25920
MAA 160,32,128
TR 88,16,16992
MAA 160,36,144
buffer_load_dwordx4 a[188:191], v11, s[16:19], s53 offen offset:1024 sc1
MAA 164,36,148
TR 90,16,17504
s_add_u32 s53, s53, 131072
MAA 164,32,132
TR 92,16,25440
MAA 180,40,132
TR 94,16,25952
MAA 180,44,148
MAA 176,44,144
TR 96,16,17024
s_add_u32 m0, s55, 84480
MAA 176,40,128
buffer_load_dwordx4 v12, s[32:35], s54 offen   lds
MAA 224,48,128
TR 98,16,17536
MAA 224,52,144
TR 100,16,25472
MAA 228,52,148
TR 102,16,25984
MAA 228,48,132
TR 104,16,17056
MAA 236,56,132
MAA 236,60,148
TR 106,16,17568
MAA 232,60,144
TR 108,16,25504
MAA 232,56,128
TR 110,16,26016
s_waitcnt vmcnt(17)
MAA 188,40,140
TR 112,17,16896
MAA 188,44,156
buffer_load_dwordx4 v13, s[32:35], s54 offen offset:1056   lds
MAA 184,44,152
TR 114,17,17408
MAA 184,40,136
MAA 168,32,136
TR 116,17,25344
MAA 168,36,152
buffer_load_dwordx4 v14, s[32:35], s54 offen offset:2112   lds
MAA 172,36,156
TR 118,17,25856
MAA 172,32,140
TR 120,17,16928
MAA 124,24,140
TR 122,17,17440
MAA 124,28,156
TR 124,17,25376
MAA 120,28,152
MAA 120,24,136
buffer_load_dwordx4 v15, s[32:35], s54 offen offset:3168   lds
MAA 104,16,136
TR 126,17,25888
MAA 104,20,152
RD 192,9,16896
MAA 108,20,156
RD 196,9,17952
MAA 108,16,140
RD 200,9,19008
MAA 60,8,140
RD 204,9,20064
s_mov_b32 m0, s67
MAA 60,12,156
buffer_load_dwordx4 v18, s[28:31], s58 offen lds
MAA 56,12,152
MAA 56,8,136
MAA 40,0,136
MAA 40,4,152
MAA 44,4,156
MAA 44,0,140
s_waitcnt vmcnt(17) lgkmcnt(0)
s_barrier
MAA 64,64,128
TR 0,16,33792
s_add_u32 m0, s55, 101376
MAA 64,68,144
buffer_load_dwordx4 v12, s[80:83], s54 offen   lds
v_smfmac_f32_16x16x64_bf16 a[216:219], a[208:211], a[192:199], v6
s_sub_u32 s47, s47, 1
s_cbranch_scc1 .Lx45
.Lx45b:
v_smfmac_f32_16x16x64_bf16 a[216:219], a[208:211], a[200:207], v6
TR 2,16,34304
MAA 68,68,148
TR 4,16,42240
MAA 68,64,132
TR 6,16,42752
MAA 84,72,132
TR 8,16,33824
MAA 84,76,148
buffer_load_dwordx4 v13, s[80:83], s54 offen offset:1056   lds
MAA 80,76,144
TR 10,16,34336
MAA 80,72,128
MAA 128,80,128
TR 12,16,42272
MAA 128,84,144
TR 14,16,42784
MAA 132,84,148
TR 16,16,33856
MAA 132,80,132
buffer_load_dwordx4 v14, s[80:83], s54 offen offset:2112   lds
MAA 148,88,132
TR 18,16,34368
MAA 148,92,148
TR 20,16,42304
MAA 144,92,144
TR 22,16,42816
MAA 144,88,128
MAA 192,96,128
TR 24,16,33888
MAA 192,100,144
buffer_load_dwordx4 v15, s[80:83], s54 offen offset:3168   lds
MAA 196,100,148
TR 26,16,34400
s_add_u32 s54, s54, 458752
MAA 196,96,132
TR 28,16,42336
MAA 212,104,132
TR 30,16,42848
MAA 212,108,148
TR 32,16,33920
MAA 208,108,144
TR 34,16,34432
.Lpad4:
s_cbranch_execz .Lnopoll34r
s_mov_b32 m0, s67
MAA 208,104,128
buffer_load_dwordx4 v19, s[28:31], s58 offen offset:1056 lds
MAA 240,112,128
s_add_u32 s67, s67, 8448
s_add_u32 s58, s58, 0x40000
MAA 240,116,144
MAA 244,116,148
TR 36,16,42368
MAA 244,112,132
TR 38,16,42880
MAA 252,120,132
TR 40,16,33952
MAA 252,124,148
TR 42,16,34464
MAA 248,124,144
TR 44,16,42400
MAA 248,120,128
buffer_load_dwordx4 a[128:131], v10, s[16:19], s52 offen sc1
MAA 220,104,140
TR 46,16,42912
MAA 220,108,156
MAA 216,108,152
TR 48,17,33792
MAA 216,104,136
TR 50,17,34304
MAA 200,96,136
TR 52,17,42240
MAA 200,100,152
buffer_load_dwordx4 a[132:135], v10, s[16:19], s52 offen offset:1024 sc1
MAA 204,100,156
TR 54,17,42752
s_add_u32 s52, s52, 131072
MAA 204,96,140
TR 56,17,33824
MAA 156,88,140
TR 58,17,34336
MAA 156,92,156
MAA 152,92,152
TR 60,17,42272
MAA 152,88,136
buffer_load_dwordx4 a[144:147], v10, s[16:19], s52 offen sc1
MAA 136,80,136
TR 62,17,42784
MAA 136,84,152
RD 192,9,33792
MAA 140,84,156
RD 196,9,34848
MAA 140,80,140
RD 200,9,35904
MAA 92,72,140
RD 204,9,36960
MAA 92,76,156
buffer_load_dwordx4 a[148:151], v10, s[16:19], s52 offen offset:1024 sc1
MAA 88,76,152
s_add_u32 s52, s52, 131072
MAA 88,72,136
MAA 72,64,136
MAA 72,68,152
MAA 76,68,156
MAA 76,64,140
s_waitcnt vmcnt(18) lgkmcnt(0)
s_barrier
MAA 32,0,160
TR 64,16,50688
MAA 32,4,176
buffer_load_dwordx4 a[136:139], v11, s[16:19], s53 offen sc1
v_smfmac_f32_16x16x64_bf16 a[212:215], a[208:211], a[192:199], v6
s_sub_u32 s47, s47, 1
s_cbranch_scc1 .Lx46
.Lx46b:
v_smfmac_f32_16x16x64_bf16 a[212:215], a[208:211], a[200:207], v6
TR 66,16,51200
MAA 36,4,180
TR 68,16,59136
MAA 36,0,164
TR 70,16,59648
MAA 52,8,164
TR 72,16,50720
MAA 52,12,180
buffer_load_dwordx4 a[140:143], v11, s[16:19], s53 offen offset:1024 sc1
MAA 48,12,176
TR 74,16,51232
s_add_u32 s53, s53, 131072
MAA 48,8,160
MAA 96,16,160
TR 76,16,59168
MAA 96,20,176
TR 78,16,59680
MAA 100,20,180
TR 80,16,50752
MAA 100,16,164
buffer_load_dwordx4 a[152:155], v11, s[16:19], s53 offen sc1
MAA 116,24,164
TR 82,16,51264
MAA 116,28,180
TR 84,16,59200
MAA 112,28,176
MAA 112,24,160
TR 86,16,59712
MAA 160,32,160
TR 88,16,50784
MAA 160,36,176
buffer_load_dwordx4 a[156:159], v11, s[16:19], s53 offen offset:1024 sc1
MAA 164,36,180
TR 90,16,51296
s_add_u32 s53, s53, 131072
MAA 164,32,164
TR 92,16,59232
MAA 180,40,164
TR 94,16,59744
MAA 180,44,180
MAA 176,44,176
TR 96,16,50816
s_add_u32 m0, s55, 118272
MAA 176,40,160
buffer_load_dwordx4 v12, s[32:35], s54 offen   lds
MAA 224,48,160
TR 98,16,51328
MAA 224,52,176
TR 100,16,59264
MAA 228,52,180
TR 102,16,59776
MAA 228,48,164
TR 104,16,50848
MAA 236,56,164
MAA 236,60,180
TR 106,16,51360
MAA 232,60,176
TR 108,16,59296
MAA 232,56,160
TR 110,16,59808
s_waitcnt vmcnt(19)
MAA 188,40,172
TR 112,17,50688
MAA 188,44,188
buffer_load_dwordx4 v13, s[32:35], s54 offen offset:1056   lds
MAA 184,44,184
TR 114,17,51200
MAA 184,40,168
MAA 168,32,168
TR 116,17,59136
MAA 168,36,184
buffer_load_dwordx4 v14, s[32:35], s54 offen offset:2112   lds
MAA 172,36,188
TR 118,17,59648
MAA 172,32,172
TR 120,17,50720
MAA 124,24,172
TR 122,17,51232
MAA 124,28,188
TR 124,17,59168
MAA 120,28,184
MAA 120,24,168
buffer_load_dwordx4 v15, s[32:35], s54 offen offset:3168   lds
MAA 104,16,168
TR 126,17,59680
MAA 104,20,184
RD 192,9,50688
MAA 108,20,188
RD 196,9,51744
MAA 108,16,172
RD 200,9,52800
MAA 60,8,172
RD 204,9,53856
s_mov_b32 m0, s67
MAA 60,12,188
buffer_load_dwordx4 v18, s[28:31], s58 offen lds
MAA 56,12,184
MAA 56,8,168
MAA 40,0,168
MAA 40,4,184
MAA 44,4,188
MAA 44,0,172
s_waitcnt vmcnt(19) lgkmcnt(0)
s_barrier
MAA 64,64,160
ds_read_b64_tr_b16 a[0:1], v16
s_add_u32 m0, s55, 135168
MAA 64,68,176
buffer_load_dwordx4 v12, s[80:83], s54 offen   lds
v_smfmac_f32_16x16x64_bf16 a[216:219], a[208:211], a[192:199], v6
s_sub_u32 s47, s47, 1
s_cbranch_scc1 .Lx47
.Lx47b:
v_smfmac_f32_16x16x64_bf16 a[216:219], a[208:211], a[200:207], v6
TR 2,16,512
MAA 68,68,180
TR 4,16,8448
MAA 68,64,164
TR 6,16,8960
MAA 84,72,164
TR 8,16,32
MAA 84,76,180
buffer_load_dwordx4 v13, s[80:83], s54 offen offset:1056   lds
MAA 80,76,176
TR 10,16,544
MAA 80,72,160
MAA 128,80,160
TR 12,16,8480
MAA 128,84,176
TR 14,16,8992
MAA 132,84,180
TR 16,16,64
MAA 132,80,164
buffer_load_dwordx4 v14, s[80:83], s54 offen offset:2112   lds
MAA 148,88,164
TR 18,16,576
MAA 148,92,180
TR 20,16,8512
MAA 144,92,176
TR 22,16,9024
MAA 144,88,160
MAA 192,96,160
TR 24,16,96
MAA 192,100,176
buffer_load_dwordx4 v15, s[80:83], s54 offen offset:3168   lds
MAA 196,100,180
TR 26,16,608
s_add_u32 s54, s54, 458752
MAA 196,96,164
TR 28,16,8544
MAA 212,104,164
TR 30,16,9056
MAA 212,108,180
TR 32,16,128
MAA 208,108,176
TR 34,16,640
s_mov_b32 m0, s67
MAA 208,104,160
buffer_load_dwordx4 v19, s[28:31], s58 offen offset:1056 lds
MAA 240,112,160
s_add_u32 s67, s67, 8448
s_add_u32 s46, s46, 1
s_xor_b32 s58, s46, s87
s_mul_i32 s58, s58, 458752
MAA 240,116,176
MAA 244,116,180
TR 36,16,8576
MAA 244,112,164
TR 38,16,9088
MAA 252,120,164
TR 40,16,160
MAA 252,124,180
TR 42,16,672
MAA 248,124,176
TR 44,16,8608
MAA 248,120,160
buffer_load_dwordx4 a[160:163], v10, s[16:19], s52 offen sc1
MAA 220,104,172
TR 46,16,9120
MAA 220,108,188
MAA 216,108,184
ds_read_b64_tr_b16 a[48:49], v17
MAA 216,104,168
TR 50,17,512
MAA 200,96,168
TR 52,17,8448
MAA 200,100,184
buffer_load_dwordx4 a[164:167], v10, s[16:19], s52 offen offset:1024 sc1
MAA 204,100,188
TR 54,17,8960
s_add_u32 s52, s52, 131072
MAA 204,96,172
TR 56,17,32
MAA 156,88,172
TR 58,17,544
MAA 156,92,188
MAA 152,92,184
TR 60,17,8480
MAA 152,88,168
buffer_load_dwordx4 a[176:179], v10, s[16:19], s52 offen sc1
MAA 136,80,168
TR 62,17,8992
MAA 136,84,184
ds_read_b128 a[192:195], v9
MAA 140,84,188
RD 196,9,1056
MAA 140,80,172
RD 200,9,2112
MAA 92,72,172
RD 204,9,3168
MAA 92,76,188
buffer_load_dwordx4 a[180:183], v10, s[16:19], s52 offen offset:1024 sc1
MAA 88,76,184
s_add_u32 s52, s52, 131072
MAA 88,72,168
MAA 72,64,168
MAA 72,68,184
MAA 76,68,188
s_add_u32 s15, s15, 1
MAA 76,64,172
s_cbranch_scc0 .Lk43
s_branch .Lj48
.Lx39:
buffer_load_dword a220, v8, s[40:43], s45 offen
buffer_load_dword a220, v7, s[28:31], s44 offen
s_add_u32 s44, s44, 655360
s_add_u32 s45, s45, 917504
s_mov_b32 s47, 3
s_branch .Lx39b
.Lx40:
buffer_load_dword a220, v8, s[40:43], s45 offen
buffer_load_dword a220, v7, s[28:31], s44 offen
s_add_u32 s44, s44, 655360
s_add_u32 s45, s45, 917504
s_mov_b32 s47, 3
s_branch .Lx40b
.Lx41:
buffer_load_dword a220, v8, s[40:43], s45 offen
buffer_load_dword a220, v7, s[28:31], s44 offen
s_add_u32 s44, s44, 655360
s_add_u32 s45, s45, 917504
s_mov_b32 s47, 3
s_branch .Lx41b
.Lx42:
buffer_load_dword a220, v8, s[40:43], s45 offen
buffer_load_dword a220, v7, s[28:31], s44 offen
s_add_u32 s44, s44, 655360
s_add_u32 s45, s45, 917504
s_mov_b32 s47, 3
s_branch .Lx42b
.Lx44:
buffer_load_dword a220, v8, s[40:43], s45 offen
buffer_load_dword a220, v7, s[28:31], s44 offen
s_add_u32 s44, s44, 655360
s_add_u32 s45, s45, 917504
s_mov_b32 s47, 3
s_branch .Lx44b
.Lx45:
buffer_load_dword a220, v8, s[40:43], s45 offen
buffer_load_dword a220, v7, s[28:31], s44 offen
s_add_u32 s44, s44, 655360
s_add_u32 s45, s45, 917504
s_mov_b32 s47, 3
s_branch .Lx45b
.Lx46:
buffer_load_dword a220, v8, s[40:43], s45 offen
buffer_load_dword a220, v7, s[28:31], s44 offen
s_add_u32 s44, s44, 655360
s_add_u32 s45, s45, 917504
s_mov_b32 s47, 3
s_branch .Lx46b
.Lx47:
buffer_load_dword a220, v8, s[40:43], s45 offen
buffer_load_dword a220, v7, s[28:31], s44 offen
s_add_u32 s44, s44, 655360
s_add_u32 s45, s45, 917504
s_mov_b32 s47, 3
s_branch .Lx47b
.Lj48:
s_waitcnt vmcnt(10) lgkmcnt(0)
s_barrier
v_smfmac_f32_16x16x64_bf16 a[212:215], a[208:211], a[192:199], v6
RD 112,9,16896
s_lshl_b32 s74, s3, 10
v_smfmac_f32_16x16x64_bf16 a[212:215], a[208:211], a[200:207], v6
RD 116,9,17952
s_add_u32 s74, s74, 152576
MAA 32,0,128
RD 120,9,19008
s_sub_u32 s75, 156672, s74
MAA 32,4,144
RD 124,9,20064
v_and_b32 v7, 15, v1
MAA 48,12,144
RD 192,9,33792
v_lshl_add_u32 v7, v7, 5, s74
MAA 48,8,128
RD 196,9,34848
v_bfe_u32 v2, v1, 4, 1
MAA 36,0,132
RD 200,9,35904
v_lshl_add_u32 v7, v2, 4, v7
MAA 36,4,148
RD 204,9,36960
v_bfe_u32 v2, v1, 5, 1
MAA 52,12,148
buffer_load_dwordx4 a[168:171], v11, s[16:19], s53 offen sc1
MAA 52,8,132
TR 64,16,16896
v_mul_u32_u24 v2, s75, v2
s_waitcnt lgkmcnt(7)
v_smfmac_f32_16x16x64_bf16 a[216:219], a[208:211], a[112:119], v6
TR 66,16,17408
v_add_u32 v7, v7, v2
MAA 40,0,136
TR 68,16,25344
v_lshlrev_b32 v2, 4, v1
s_waitcnt lgkmcnt(7)
v_smfmac_f32_16x16x64_bf16 a[216:219], a[208:211], a[120:127], v6
buffer_load_dwordx4 a[172:175], v11, s[16:19], s53 offen offset:1024 sc1
MAA 40,4,152
TR 70,16,25856
s_add_u32 s53, s53, 131072
s_waitcnt lgkmcnt(6)
v_smfmac_f32_16x16x64_bf16 a[212:215], a[208:211], a[192:199], v6
TR 72,16,16928
v_add_u32 v2, 152576, v2
MAA 56,12,152
TR 74,16,17440
s_lshl_b32 s74, s12, 7
s_waitcnt lgkmcnt(6)
v_smfmac_f32_16x16x64_bf16 a[212:215], a[208:211], a[200:207], v6
buffer_load_dwordx4 a[184:187], v11, s[16:19], s53 offen sc1
MAA 56,8,136
TR 76,16,25376
s_add_u32 s74, s74, 161536
MAA 44,0,140
TR 78,16,25888
s_waitcnt vmcnt(8)
s_barrier
MAA 44,4,156
RD 112,9,50688
s_xor_b32 s75, s12, 1
MAA 60,12,156
RD 116,9,51744
s_mul_i32 s75, s75, 384
MAA 60,8,140
RD 120,9,52800
s_add_u32 s75, s75, 161536
MAA 96,16,128
RD 124,9,53856
v_lshrrev_b32 v9, 4, v1
MAA 96,20,144
ds_write_b128 v7, a[212:215]
v_lshlrev_b32 v9, 4, v9
MAA 112,28,144
buffer_load_dwordx4 a[188:191], v11, s[16:19], s53 offen offset:1024 sc1
MAA 112,24,128
TR 80,16,33792
s_add_u32 s53, s53, 131072
MAA 100,16,132
TR 82,16,34304
v_add_u32 v8, s75, v9
MAA 100,20,148
TR 84,16,42240
v_add_u32 v9, s74, v9
MAA 116,28,148
TR 86,16,42752
s_add_u32 s58, s99, 2293760
s_waitcnt lgkmcnt(7)
v_smfmac_f32_16x16x64_bf16 a[216:219], a[208:211], a[112:119], v6
TR 88,16,33824
s_lshl_b32 s74, s3, 11
MAA 116,24,132
TR 90,16,34336
s_add_u32 s74, s74, s84
s_waitcnt lgkmcnt(7)
v_smfmac_f32_16x16x64_bf16 a[216:219], a[208:211], a[120:127], v6
TR 92,16,42272
s_add_u32 s54, s98, 65536
MAA 104,16,136
TR 94,16,42784
s_mul_i32 s55, s3, 2112
MAA 104,20,152
TR 96,16,50688
s_mov_b32 s57, 67584
MAA 120,28,152
ds_write_b128 v7, a[216:219] offset:512
MAA 120,24,136
TR 98,16,51200
MAA 108,16,140
TR 100,16,59136
MAA 108,20,156
TR 102,16,59648
MAA 124,28,156
TR 104,16,50720
MAA 124,24,140
TR 106,16,51232
MAA 160,32,128
TR 108,16,59168
MAA 160,36,144
TR 110,16,59680
MAA 176,44,144
s_waitcnt lgkmcnt(7)
s_barrier
ds_read_b128 v[12:15], v2
MAA 176,40,128
ds_read_b128 v[4:7], v2 offset:1024
MAA 164,32,132
TR 192,16,16960
MAA 164,36,148
TR 194,16,17472
MAA 180,44,148
TR 196,16,25408
MAA 180,40,132
TR 198,16,25920
MAA 168,32,136
TR 200,16,16992
MAA 168,36,152
TR 202,16,17504
MAA 184,44,152
TR 204,16,25440
MAA 184,40,136
TR 206,16,25952
s_waitcnt lgkmcnt(8)
v_add_f32 v12, v12, v4
MAA 172,32,140
TR 112,16,33856
v_add_f32 v13, v13, v5
MAA 172,36,156
TR 114,16,34368
v_add_f32 v14, v14, v6
MAA 188,44,156
TR 116,16,42304
v_add_f32 v15, v15, v7
MAA 188,40,140
ds_read_b128 v[4:7], v2 offset:2048
MAA 224,48,128
TR 118,16,42816
MAA 224,52,144
TR 120,16,33888
MAA 232,60,144
TR 122,16,34400
MAA 232,56,128
TR 124,16,42336
MAA 228,48,132
TR 126,16,42848
MAA 228,52,148
TR 0,16,50752
MAA 236,60,148
TR 2,16,51264
MAA 236,56,132
TR 4,16,59200
s_waitcnt lgkmcnt(8)
v_add_f32 v12, v12, v4
MAA 64,64,128
TR 6,16,59712
v_add_f32 v13, v13, v5
MAA 64,68,144
TR 8,16,50784
v_add_f32 v14, v14, v6
s_waitcnt vmcnt(7)
MAA 64,96,160
TR 10,16,51296
v_add_f32 v15, v15, v7
s_waitcnt vmcnt(5)
MAA 64,100,176
ds_read_b128 v[4:7], v2 offset:3072
MAA 80,108,176
TR 12,16,59232
MAA 80,104,160
TR 14,16,59744
MAA 80,76,144
TR 16,16,17024
MAA 80,72,128
TR 18,16,17536
MAA 32,80,160
TR 20,16,25472
MAA 32,84,176
TR 22,16,25984
MAA 48,92,176
TR 24,16,17056
MAA 48,88,160
TR 26,16,17568
s_waitcnt lgkmcnt(8)
v_add_f32 v12, v12, v4
v_add_f32 v13, v13, v5
.Lpad5:
s_cbranch_execz .Lnopoll34r
v_add_f32 v14, v14, v6
v_add_f32 v15, v15, v7
ds_write_b128 v2, v[12:15] offset:8960
ds_read_b128 v[12:15], v9
ds_read_b128 v[4:7], v9 offset:64
v_lshrrev_b32 v2, 3, v1
v_cmp_eq_u32 vcc, 3, v2
TR 28,16,25504
TR 30,16,26016
TR 32,16,33920
TR 34,16,34432
TR 36,16,42368
TR 38,16,42880
TR 40,16,33952
TR 42,16,34464
TR 44,16,42400
TR 46,16,42912
TR 48,16,50816
TR 50,16,51328
TR 52,16,59264
s_waitcnt lgkmcnt(14)
v_pk_fma_f32 v[32:33], v[12:13], v[20:21], v[32:33] op_sel_hi:[1,0,1]
v_pk_fma_f32 v[34:35], v[14:15], v[20:21], v[34:35] op_sel_hi:[1,0,1]
v_pk_fma_f32 v[36:37], v[12:13], v[22:23], v[36:37] op_sel_hi:[1,0,1]
v_pk_fma_f32 v[38:39], v[14:15], v[22:23], v[38:39] op_sel_hi:[1,0,1]
v_pk_fma_f32 v[40:41], v[12:13], v[24:25], v[40:41] op_sel_hi:[1,0,1]
v_pk_fma_f32 v[42:43], v[14:15], v[24:25], v[42:43] op_sel_hi:[1,0,1]
v_pk_fma_f32 v[44:45], v[12:13], v[26:27], v[44:45] op_sel_hi:[1,0,1]
v_pk_fma_f32 v[46:47], v[14:15], v[26:27], v[46:47] op_sel_hi:[1,0,1]
ds_read_b128 v[12:15], v9 offset:512
s_waitcnt lgkmcnt(14)
v_pk_fma_f32 v[48:49], v[4:5], v[20:21], v[48:49] op_sel_hi:[1,0,1]
v_pk_fma_f32 v[50:51], v[6:7], v[20:21], v[50:51] op_sel_hi:[1,0,1]
v_pk_fma_f32 v[52:53], v[4:5], v[22:23], v[52:53] op_sel_hi:[1,0,1]
v_pk_fma_f32 v[54:55], v[6:7], v[22:23], v[54:55] op_sel_hi:[1,0,1]
v_pk_fma_f32 v[56:57], v[4:5], v[24:25], v[56:57] op_sel_hi:[1,0,1]
v_pk_fma_f32 v[58:59], v[6:7], v[24:25], v[58:59] op_sel_hi:[1,0,1]
v_pk_fma_f32 v[60:61], v[4:5], v[26:27], v[60:61] op_sel_hi:[1,0,1]
v_pk_fma_f32 v[62:63], v[6:7], v[26:27], v[62:63] op_sel_hi:[1,0,1]
ds_read_b128 v[4:7], v9 offset:576
TR 54,16,59776
TR 56,16,50848
TR 58,16,51360
TR 60,16,59296
TR 62,16,59808
s_waitcnt lgkmcnt(6)
v_pk_fma_f32 v[64:65], v[12:13], v[20:21], v[64:65] op_sel_hi:[1,0,1]
v_pk_fma_f32 v[66:67], v[14:15], v[20:21], v[66:67] op_sel_hi:[1,0,1]
v_pk_fma_f32 v[68:69], v[12:13], v[22:23], v[68:69] op_sel_hi:[1,0,1]
v_pk_fma_f32 v[70:71], v[14:15], v[22:23], v[70:71] op_sel_hi:[1,0,1]
v_pk_fma_f32 v[72:73], v[12:13], v[24:25], v[72:73] op_sel_hi:[1,0,1]
v_pk_fma_f32 v[74:75], v[14:15], v[24:25], v[74:75] op_sel_hi:[1,0,1]
v_pk_fma_f32 v[76:77], v[12:13], v[26:27], v[76:77] op_sel_hi:[1,0,1]
v_pk_fma_f32 v[78:79], v[14:15], v[26:27], v[78:79] op_sel_hi:[1,0,1]
ds_read_b128 v[12:15], v9 offset:832
s_waitcnt lgkmcnt(6)
v_pk_fma_f32 v[80:81], v[4:5], v[20:21], v[80:81] op_sel_hi:[1,0,1]
v_pk_fma_f32 v[82:83], v[6:7], v[20:21], v[82:83] op_sel_hi:[1,0,1]
v_pk_fma_f32 v[84:85], v[4:5], v[22:23], v[84:85] op_sel_hi:[1,0,1]
v_pk_fma_f32 v[86:87], v[6:7], v[22:23], v[86:87] op_sel_hi:[1,0,1]
v_pk_fma_f32 v[88:89], v[4:5], v[24:25], v[88:89] op_sel_hi:[1,0,1]
v_pk_fma_f32 v[90:91], v[6:7], v[24:25], v[90:91] op_sel_hi:[1,0,1]
v_pk_fma_f32 v[92:93], v[4:5], v[26:27], v[92:93] op_sel_hi:[1,0,1]
v_pk_fma_f32 v[94:95], v[6:7], v[26:27], v[94:95] op_sel_hi:[1,0,1]
ds_read_b128 v[4:7], v9 offset:704
v_pk_mul_f32 v[64:65], v[64:65], v[32:33]
v_pk_mul_f32 v[32:33], v[32:33], v[28:29] op_sel_hi:[1,0]
v_pk_mul_f32 v[66:67], v[66:67], v[34:35]
v_pk_mul_f32 v[34:35], v[34:35], v[28:29] op_sel_hi:[1,0]
v_pk_mul_f32 v[80:81], v[80:81], v[48:49]
v_pk_mul_f32 v[48:49], v[48:49], v[28:29] op_sel_hi:[1,0]
v_pk_mul_f32 v[82:83], v[82:83], v[50:51]
v_pk_mul_f32 v[50:51], v[50:51], v[28:29] op_sel_hi:[1,0]
v_exp_f32 v32, v32
v_exp_f32 v33, v33
MAA 68,64,132
v_exp_f32 v34, v34
MAA 68,68,148
v_exp_f32 v35, v35
MAA 68,96,164
v_exp_f32 v48, v48
s_waitcnt vmcnt(4)
MAA 68,100,180
v_exp_f32 v49, v49
MAA 84,108,180
v_exp_f32 v50, v50
MAA 84,104,164
v_exp_f32 v51, v51
MAA 84,76,148
MAA 84,72,132
MAA 36,80,164
MAA 36,84,180
MAA 52,92,180
MAA 52,88,164
s_nop 5
v_pk_mul_f32 v[68:69], v[68:69], v[36:37]
v_pk_fma_f32 v[32:33], v[32:33], v[20:21], v[20:21] op_sel:[0,1,1] op_sel_hi:[1,1,1]
v_pk_fma_f32 v[34:35], v[34:35], v[20:21], v[20:21] op_sel:[0,1,1] op_sel_hi:[1,1,1]
v_pk_fma_f32 v[48:49], v[48:49], v[20:21], v[20:21] op_sel:[0,1,1] op_sel_hi:[1,1,1]
v_pk_fma_f32 v[50:51], v[50:51], v[20:21], v[20:21] op_sel:[0,1,1] op_sel_hi:[1,1,1]
v_rcp_f32 v32, v32
v_pk_mul_f32 v[36:37], v[36:37], v[28:29] op_sel:[0,1] op_sel_hi:[1,1]
v_pk_mul_f32 v[70:71], v[70:71], v[38:39]
v_pk_mul_f32 v[38:39], v[38:39], v[28:29] op_sel:[0,1] op_sel_hi:[1,1]
v_pk_mul_f32 v[84:85], v[84:85], v[52:53]
v_pk_mul_f32 v[52:53], v[52:53], v[28:29] op_sel:[0,1] op_sel_hi:[1,1]
v_pk_mul_f32 v[86:87], v[86:87], v[54:55]
v_pk_mul_f32 v[54:55], v[54:55], v[28:29] op_sel:[0,1] op_sel_hi:[1,1]
v_rcp_f32 v33, v33
v_rcp_f32 v34, v34
MAA 72,64,136
v_rcp_f32 v35, v35
MAA 72,68,152
v_rcp_f32 v48, v48
s_waitcnt vmcnt(3)
MAA 72,96,168
v_rcp_f32 v49, v49
s_waitcnt vmcnt(1)
MAA 72,100,184
v_rcp_f32 v50, v50
MAA 88,108,184
v_rcp_f32 v51, v51
MAA 88,104,168
v_exp_f32 v36, v36
MAA 88,76,152
v_exp_f32 v37, v37
MAA 88,72,136
v_exp_f32 v38, v38
MAA 40,80,168
v_exp_f32 v39, v39
MAA 40,84,184
v_exp_f32 v52, v52
MAA 56,92,184
v_exp_f32 v53, v53
MAA 56,88,168
v_exp_f32 v54, v54
v_exp_f32 v55, v55
v_pk_mul_f32 v[64:65], v[64:65], v[32:33]
v_pk_mul_f32 v[66:67], v[66:67], v[34:35]
v_pk_mul_f32 v[80:81], v[80:81], v[48:49]
v_pk_mul_f32 v[82:83], v[82:83], v[50:51]
ds_read_b128 v[48:51], v9 offset:128
v_pk_mul_f32 v[72:73], v[72:73], v[40:41]
v_pk_mul_f32 v[40:41], v[40:41], v[30:31] op_sel_hi:[1,0]
v_pk_mul_f32 v[74:75], v[74:75], v[42:43]
v_pk_mul_f32 v[42:43], v[42:43], v[30:31] op_sel_hi:[1,0]
v_pk_mul_f32 v[88:89], v[88:89], v[56:57]
v_pk_mul_f32 v[56:57], v[56:57], v[30:31] op_sel_hi:[1,0]
v_pk_mul_f32 v[90:91], v[90:91], v[58:59]
v_pk_mul_f32 v[58:59], v[58:59], v[30:31] op_sel_hi:[1,0]
v_pk_fma_f32 v[36:37], v[36:37], v[22:23], v[22:23] op_sel:[0,1,1] op_sel_hi:[1,1,1]
v_pk_fma_f32 v[38:39], v[38:39], v[22:23], v[22:23] op_sel:[0,1,1] op_sel_hi:[1,1,1]
v_pk_fma_f32 v[52:53], v[52:53], v[22:23], v[22:23] op_sel:[0,1,1] op_sel_hi:[1,1,1]
v_pk_fma_f32 v[54:55], v[54:55], v[22:23], v[22:23] op_sel:[0,1,1] op_sel_hi:[1,1,1]
v_cvt_pk_bf16_f32 v32, v64, v65
v_cvt_pk_bf16_f32 v33, v66, v67
ds_read_b128 v[64:67], v9 offset:192
v_cvt_pk_bf16_f32 v34, v80, v81
v_cvt_pk_bf16_f32 v35, v82, v83
MAA 76,64,140
buffer_store_dwordx4 v[32:35], v10, s[16:19], s62 offen sc1
MAA 76,68,156
ds_read_b128 v[80:83], v9 offset:640
v_rcp_f32 v36, v36
MAA 76,96,172
TR 64,17,16896
v_rcp_f32 v37, v37
s_waitcnt vmcnt(1)
MAA 76,100,188
TR 66,17,17408
v_rcp_f32 v38, v38
MAA 92,108,188
TR 68,17,25344
v_rcp_f32 v39, v39
MAA 92,104,172
TR 70,17,25856
v_rcp_f32 v52, v52
MAA 92,76,156
TR 76,17,25376
v_rcp_f32 v53, v53
MAA 92,72,140
TR 72,17,16928
v_rcp_f32 v54, v54
MAA 44,80,172
TR 74,17,17440
v_rcp_f32 v55, v55
MAA 44,84,188
TR 78,17,25888
v_exp_f32 v40, v40
MAA 60,92,188
TR 80,17,33792
v_exp_f32 v41, v41
MAA 60,88,172
TR 82,17,34304
v_exp_f32 v42, v42
v_exp_f32 v43, v43
v_exp_f32 v56, v56
v_exp_f32 v57, v57
v_exp_f32 v58, v58
v_exp_f32 v59, v59
v_pk_mul_f32 v[68:69], v[68:69], v[36:37]
v_pk_mul_f32 v[70:71], v[70:71], v[38:39]
v_pk_mul_f32 v[84:85], v[84:85], v[52:53]
v_pk_mul_f32 v[86:87], v[86:87], v[54:55]
ds_read_b128 v[52:55], v8 offset:576
v_pk_mul_f32 v[76:77], v[76:77], v[44:45]
v_pk_mul_f32 v[44:45], v[44:45], v[30:31] op_sel:[0,1] op_sel_hi:[1,1]
v_pk_mul_f32 v[78:79], v[78:79], v[46:47]
v_pk_mul_f32 v[46:47], v[46:47], v[30:31] op_sel:[0,1] op_sel_hi:[1,1]
v_pk_mul_f32 v[92:93], v[92:93], v[60:61]
v_pk_mul_f32 v[60:61], v[60:61], v[30:31] op_sel:[0,1] op_sel_hi:[1,1]
v_pk_mul_f32 v[94:95], v[94:95], v[62:63]
v_pk_mul_f32 v[62:63], v[62:63], v[30:31] op_sel:[0,1] op_sel_hi:[1,1]
v_pk_fma_f32 v[40:41], v[40:41], v[24:25], v[24:25] op_sel:[0,1,1] op_sel_hi:[1,1,1]
v_pk_fma_f32 v[42:43], v[42:43], v[24:25], v[24:25] op_sel:[0,1,1] op_sel_hi:[1,1,1]
v_pk_fma_f32 v[56:57], v[56:57], v[24:25], v[24:25] op_sel:[0,1,1] op_sel_hi:[1,1,1]
v_pk_fma_f32 v[58:59], v[58:59], v[24:25], v[24:25] op_sel:[0,1,1] op_sel_hi:[1,1,1]
v_cvt_pk_bf16_f32 v36, v68, v69
v_cvt_pk_bf16_f32 v37, v70, v71
v_cvt_pk_bf16_f32 v38, v84, v85
v_cvt_pk_bf16_f32 v39, v86, v87
MAA 128,192,128
buffer_store_dwordx4 v[36:39], v10, s[16:19], s62 offen offset:1024 sc1
MAA 128,196,144
TR 84,17,42240
v_rcp_f32 v40, v40
MAA 128,0,160
TR 86,17,42752
v_rcp_f32 v41, v41
MAA 128,4,176
TR 88,17,33824
v_rcp_f32 v42, v42
MAA 144,12,176
TR 90,17,34336
v_rcp_f32 v43, v43
MAA 144,8,160
TR 92,17,42272
v_rcp_f32 v56, v56
MAA 144,204,144
TR 94,17,42784
v_rcp_f32 v57, v57
MAA 144,200,128
TR 96,17,50688
v_rcp_f32 v58, v58
MAA 96,112,160
TR 98,17,51200
v_rcp_f32 v59, v59
MAA 96,116,176
TR 100,17,59136
v_exp_f32 v44, v44
MAA 112,124,176
TR 102,17,59648
v_exp_f32 v45, v45
MAA 112,120,160
TR 104,17,50720
v_lshrrev_b32 v69, 2, v0
v_min_u32 v69, 1, v69
v_lshlrev_b32 v69, 28, v69
v_lshl_add_u32 v68, v0, 7, v69
v_xor_b32 v69, 64, v0
v_min_u32 v69, 1, v69
v_lshlrev_b32 v70, 4, v69
v_sub_u32 v70, 16, v70
v_lshlrev_b32 v69, 28, v69
v_mov_b32 v71, 1
v_mov_b32 v84, 0
v_mov_b32 v85, 0
v_mov_b32 v86, 0
v_exp_f32 v46, v46
v_exp_f32 v47, v47
v_exp_f32 v60, v60
v_exp_f32 v61, v61
v_exp_f32 v62, v62
v_exp_f32 v63, v63
v_pk_mul_f32 v[72:73], v[72:73], v[40:41]
v_pk_mul_f32 v[74:75], v[74:75], v[42:43]
v_pk_mul_f32 v[88:89], v[88:89], v[56:57]
v_pk_mul_f32 v[90:91], v[90:91], v[58:59]
s_waitcnt lgkmcnt(15)
v_pk_fma_f32 v[96:97], v[48:49], v[20:21], v[96:97] op_sel_hi:[1,0,1]
v_pk_fma_f32 v[98:99], v[50:51], v[20:21], v[98:99] op_sel_hi:[1,0,1]
v_pk_fma_f32 v[112:113], v[64:65], v[20:21], v[112:113] op_sel_hi:[1,0,1]
v_pk_fma_f32 v[114:115], v[66:67], v[20:21], v[114:115] op_sel_hi:[1,0,1]
v_pk_fma_f32 v[128:129], v[80:81], v[20:21], v[128:129] op_sel_hi:[1,0,1]
v_pk_fma_f32 v[130:131], v[82:83], v[20:21], v[130:131] op_sel_hi:[1,0,1]
v_pk_fma_f32 v[144:145], v[4:5], v[20:21], v[144:145] op_sel_hi:[1,0,1]
v_pk_fma_f32 v[146:147], v[6:7], v[20:21], v[146:147] op_sel_hi:[1,0,1]
v_pk_mul_f32 v[128:129], v[128:129], v[96:97]
v_pk_mul_f32 v[96:97], v[96:97], v[28:29] op_sel_hi:[1,0]
v_pk_mul_f32 v[130:131], v[130:131], v[98:99]
v_pk_mul_f32 v[98:99], v[98:99], v[28:29] op_sel_hi:[1,0]
v_pk_mul_f32 v[144:145], v[144:145], v[112:113]
v_pk_mul_f32 v[112:113], v[112:113], v[28:29] op_sel_hi:[1,0]
v_pk_mul_f32 v[146:147], v[146:147], v[114:115]
v_pk_mul_f32 v[114:115], v[114:115], v[28:29] op_sel_hi:[1,0]
v_pk_fma_f32 v[44:45], v[44:45], v[26:27], v[26:27] op_sel:[0,1,1] op_sel_hi:[1,1,1]
v_pk_fma_f32 v[46:47], v[46:47], v[26:27], v[26:27] op_sel:[0,1,1] op_sel_hi:[1,1,1]
v_pk_fma_f32 v[60:61], v[60:61], v[26:27], v[26:27] op_sel:[0,1,1] op_sel_hi:[1,1,1]
v_pk_fma_f32 v[62:63], v[62:63], v[26:27], v[26:27] op_sel:[0,1,1] op_sel_hi:[1,1,1]
v_cvt_pk_bf16_f32 v40, v72, v73
v_cvt_pk_bf16_f32 v41, v74, v75
v_cvt_pk_bf16_f32 v42, v88, v89
v_cvt_pk_bf16_f32 v43, v90, v91
MAA 132,192,132
buffer_store_dwordx4 v[40:43], v11, s[16:19], s62 offen sc1
MAA 132,196,148
TR 106,17,51232
v_rcp_f32 v44, v44
MAA 132,0,164
TR 108,17,59168
v_rcp_f32 v45, v45
MAA 132,4,180
TR 110,17,59680
v_rcp_f32 v46, v46
MAA 148,12,180
v_rcp_f32 v47, v47
MAA 148,8,164
v_rcp_f32 v60, v60
MAA 148,204,148
v_rcp_f32 v61, v61
MAA 148,200,132
v_rcp_f32 v62, v62
MAA 100,112,164
v_rcp_f32 v63, v63
MAA 100,116,180
v_exp_f32 v96, v96
MAA 116,124,180
v_exp_f32 v97, v97
MAA 116,120,164
s_waitcnt lgkmcnt(0)
s_barrier
s_add_u32 m0, s59, 84480
v_exp_f32 v98, v98
v_exp_f32 v99, v99
v_exp_f32 v112, v112
v_exp_f32 v113, v113
v_exp_f32 v114, v114
v_exp_f32 v115, v115
v_pk_mul_f32 v[76:77], v[76:77], v[44:45]
v_pk_mul_f32 v[78:79], v[78:79], v[46:47]
v_pk_mul_f32 v[92:93], v[92:93], v[60:61]
v_pk_mul_f32 v[94:95], v[94:95], v[62:63]
v_pk_fma_f32 v[100:101], v[48:49], v[22:23], v[100:101] op_sel_hi:[1,0,1]
v_pk_fma_f32 v[102:103], v[50:51], v[22:23], v[102:103] op_sel_hi:[1,0,1]
v_pk_fma_f32 v[116:117], v[64:65], v[22:23], v[116:117] op_sel_hi:[1,0,1]
v_pk_fma_f32 v[118:119], v[66:67], v[22:23], v[118:119] op_sel_hi:[1,0,1]
v_pk_fma_f32 v[132:133], v[80:81], v[22:23], v[132:133] op_sel_hi:[1,0,1]
v_pk_fma_f32 v[134:135], v[82:83], v[22:23], v[134:135] op_sel_hi:[1,0,1]
v_pk_fma_f32 v[148:149], v[4:5], v[22:23], v[148:149] op_sel_hi:[1,0,1]
v_pk_fma_f32 v[150:151], v[6:7], v[22:23], v[150:151] op_sel_hi:[1,0,1]
v_pk_mul_f32 v[132:133], v[132:133], v[100:101]
v_pk_mul_f32 v[100:101], v[100:101], v[28:29] op_sel:[0,1] op_sel_hi:[1,1]
v_pk_mul_f32 v[134:135], v[134:135], v[102:103]
v_pk_mul_f32 v[102:103], v[102:103], v[28:29] op_sel:[0,1] op_sel_hi:[1,1]
v_pk_mul_f32 v[148:149], v[148:149], v[116:117]
v_pk_mul_f32 v[116:117], v[116:117], v[28:29] op_sel:[0,1] op_sel_hi:[1,1]
v_pk_mul_f32 v[150:151], v[150:151], v[118:119]
v_pk_mul_f32 v[118:119], v[118:119], v[28:29] op_sel:[0,1] op_sel_hi:[1,1]
v_pk_fma_f32 v[96:97], v[96:97], v[20:21], v[20:21] op_sel:[0,1,1] op_sel_hi:[1,1,1]
v_pk_fma_f32 v[98:99], v[98:99], v[20:21], v[20:21] op_sel:[0,1,1] op_sel_hi:[1,1,1]
v_pk_fma_f32 v[112:113], v[112:113], v[20:21], v[20:21] op_sel:[0,1,1] op_sel_hi:[1,1,1]
v_pk_fma_f32 v[114:115], v[114:115], v[20:21], v[20:21] op_sel:[0,1,1] op_sel_hi:[1,1,1]
v_cvt_pk_bf16_f32 v44, v76, v77
v_cvt_pk_bf16_f32 v45, v78, v79
v_cvt_pk_bf16_f32 v46, v92, v93
v_cvt_pk_bf16_f32 v47, v94, v95
MAA 136,192,136
buffer_store_dwordx4 v[44:47], v11, s[16:19], s62 offen offset:1024 sc1
MAA 136,196,152
v_rcp_f32 v96, v96
MAA 136,0,168
v_rcp_f32 v97, v97
MAA 136,4,184
v_rcp_f32 v98, v98
MAA 152,12,184
buffer_load_dwordx4 v18, s[28:31], s58 offen lds
MAA 152,8,168
v_rcp_f32 v99, v99
MAA 152,204,152
v_rcp_f32 v112, v112
MAA 152,200,136
v_rcp_f32 v113, v113
MAA 104,112,168
buffer_load_dwordx4 v19, s[28:31], s58 offen offset:1056 lds
MAA 104,116,184
s_add_u32 m0, s59, 92928
s_add_u32 s58, s99, 2555904
v_rcp_f32 v114, v114
MAA 120,124,184
v_rcp_f32 v115, v115
MAA 120,120,168
v_exp_f32 v100, v100
v_exp_f32 v101, v101
v_exp_f32 v102, v102
v_exp_f32 v103, v103
v_exp_f32 v116, v116
v_exp_f32 v117, v117
v_exp_f32 v118, v118
v_exp_f32 v119, v119
v_pk_mul_f32 v[128:129], v[128:129], v[96:97]
v_pk_mul_f32 v[130:131], v[130:131], v[98:99]
v_pk_mul_f32 v[144:145], v[144:145], v[112:113]
v_pk_mul_f32 v[146:147], v[146:147], v[114:115]
ds_read_b128 v[112:115], v9 offset:256
v_pk_fma_f32 v[104:105], v[48:49], v[24:25], v[104:105] op_sel_hi:[1,0,1]
v_pk_fma_f32 v[106:107], v[50:51], v[24:25], v[106:107] op_sel_hi:[1,0,1]
v_pk_fma_f32 v[120:121], v[64:65], v[24:25], v[120:121] op_sel_hi:[1,0,1]
v_pk_fma_f32 v[122:123], v[66:67], v[24:25], v[122:123] op_sel_hi:[1,0,1]
v_pk_fma_f32 v[136:137], v[80:81], v[24:25], v[136:137] op_sel_hi:[1,0,1]
v_pk_fma_f32 v[138:139], v[82:83], v[24:25], v[138:139] op_sel_hi:[1,0,1]
v_pk_fma_f32 v[152:153], v[4:5], v[24:25], v[152:153] op_sel_hi:[1,0,1]
v_pk_fma_f32 v[154:155], v[6:7], v[24:25], v[154:155] op_sel_hi:[1,0,1]
v_pk_mul_f32 v[136:137], v[136:137], v[104:105]
v_pk_mul_f32 v[104:105], v[104:105], v[30:31] op_sel_hi:[1,0]
v_pk_mul_f32 v[138:139], v[138:139], v[106:107]
v_pk_mul_f32 v[106:107], v[106:107], v[30:31] op_sel_hi:[1,0]
v_pk_mul_f32 v[152:153], v[152:153], v[120:121]
v_pk_mul_f32 v[120:121], v[120:121], v[30:31] op_sel_hi:[1,0]
v_pk_mul_f32 v[154:155], v[154:155], v[122:123]
v_pk_mul_f32 v[122:123], v[122:123], v[30:31] op_sel_hi:[1,0]
v_pk_fma_f32 v[100:101], v[100:101], v[22:23], v[22:23] op_sel:[0,1,1] op_sel_hi:[1,1,1]
v_pk_fma_f32 v[102:103], v[102:103], v[22:23], v[22:23] op_sel:[0,1,1] op_sel_hi:[1,1,1]
v_pk_fma_f32 v[116:117], v[116:117], v[22:23], v[22:23] op_sel:[0,1,1] op_sel_hi:[1,1,1]
v_pk_fma_f32 v[118:119], v[118:119], v[22:23], v[22:23] op_sel:[0,1,1] op_sel_hi:[1,1,1]
v_cvt_pk_bf16_f32 v96, v128, v129
v_cvt_pk_bf16_f32 v97, v130, v131
ds_read_b128 v[128:131], v9 offset:320
v_cvt_pk_bf16_f32 v98, v144, v145
v_cvt_pk_bf16_f32 v99, v146, v147
MAA 140,192,140
buffer_store_dwordx4 v[96:99], v10, s[16:19], s63 offen sc1
MAA 140,196,156
ds_read_b128 v[144:147], v9 offset:768
v_rcp_f32 v100, v100
MAA 140,0,172
v_rcp_f32 v101, v101
MAA 140,4,188
v_rcp_f32 v102, v102
MAA 156,12,188
buffer_load_dwordx4 v18, s[28:31], s58 offen lds
MAA 156,8,172
v_rcp_f32 v103, v103
MAA 156,204,156
v_rcp_f32 v116, v116
MAA 156,200,140
v_rcp_f32 v117, v117
MAA 108,112,172
buffer_load_dwordx4 v19, s[28:31], s58 offen offset:1056 lds
MAA 108,116,188
s_add_u32 m0, s59, 101376
s_add_u32 s58, s100, 2752512
v_rcp_f32 v118, v118
MAA 124,124,188
v_rcp_f32 v119, v119
MAA 124,120,172
v_exp_f32 v104, v104
v_exp_f32 v105, v105
v_exp_f32 v106, v106
v_exp_f32 v107, v107
v_exp_f32 v120, v120
v_exp_f32 v121, v121
v_exp_f32 v122, v122
v_exp_f32 v123, v123
v_pk_mul_f32 v[132:133], v[132:133], v[100:101]
v_pk_mul_f32 v[134:135], v[134:135], v[102:103]
v_pk_mul_f32 v[148:149], v[148:149], v[116:117]
v_pk_mul_f32 v[150:151], v[150:151], v[118:119]
v_pk_fma_f32 v[108:109], v[48:49], v[26:27], v[108:109] op_sel_hi:[1,0,1]
v_pk_fma_f32 v[110:111], v[50:51], v[26:27], v[110:111] op_sel_hi:[1,0,1]
v_pk_fma_f32 v[124:125], v[64:65], v[26:27], v[124:125] op_sel_hi:[1,0,1]
v_pk_fma_f32 v[126:127], v[66:67], v[26:27], v[126:127] op_sel_hi:[1,0,1]
v_pk_fma_f32 v[140:141], v[80:81], v[26:27], v[140:141] op_sel_hi:[1,0,1]
v_pk_fma_f32 v[142:143], v[82:83], v[26:27], v[142:143] op_sel_hi:[1,0,1]
v_pk_fma_f32 v[156:157], v[4:5], v[26:27], v[156:157] op_sel_hi:[1,0,1]
v_pk_fma_f32 v[158:159], v[6:7], v[26:27], v[158:159] op_sel_hi:[1,0,1]
v_pk_mul_f32 v[140:141], v[140:141], v[108:109]
v_pk_mul_f32 v[108:109], v[108:109], v[30:31] op_sel:[0,1] op_sel_hi:[1,1]
v_pk_mul_f32 v[142:143], v[142:143], v[110:111]
v_pk_mul_f32 v[110:111], v[110:111], v[30:31] op_sel:[0,1] op_sel_hi:[1,1]
v_pk_mul_f32 v[156:157], v[156:157], v[124:125]
s_waitcnt vmcnt(5)
s_barrier
buffer_atomic_add v71, v68, s[16:19], s72 offen offset:512
v_pk_mul_f32 v[124:125], v[124:125], v[30:31] op_sel:[0,1] op_sel_hi:[1,1]
v_pk_mul_f32 v[158:159], v[158:159], v[126:127]
v_pk_mul_f32 v[126:127], v[126:127], v[30:31] op_sel:[0,1] op_sel_hi:[1,1]
v_pk_fma_f32 v[104:105], v[104:105], v[24:25], v[24:25] op_sel:[0,1,1] op_sel_hi:[1,1,1]
v_pk_fma_f32 v[106:107], v[106:107], v[24:25], v[24:25] op_sel:[0,1,1] op_sel_hi:[1,1,1]
v_pk_fma_f32 v[120:121], v[120:121], v[24:25], v[24:25] op_sel:[0,1,1] op_sel_hi:[1,1,1]
v_pk_fma_f32 v[122:123], v[122:123], v[24:25], v[24:25] op_sel:[0,1,1] op_sel_hi:[1,1,1]
v_cvt_pk_bf16_f32 v100, v132, v133
v_cvt_pk_bf16_f32 v101, v134, v135
v_cvt_pk_bf16_f32 v102, v148, v149
v_cvt_pk_bf16_f32 v103, v150, v151
MAA 192,16,128
v_rcp_f32 v104, v104
MAA 192,20,144
buffer_store_dwordx4 v[100:103], v10, s[16:19], s63 offen offset:1024 sc1
MAA 192,48,160
v_rcp_f32 v105, v105
MAA 192,52,176
v_rcp_f32 v106, v106
MAA 208,60,176
v_rcp_f32 v107, v107
MAA 208,56,160
buffer_load_dwordx4 v18, s[28:31], s58 offen lds
MAA 208,28,144
v_rcp_f32 v120, v120
MAA 208,24,128
v_rcp_f32 v121, v121
MAA 160,32,160
v_rcp_f32 v122, v122
MAA 160,36,176
buffer_load_dwordx4 v19, s[28:31], s58 offen offset:1056 lds
MAA 176,44,176
s_add_u32 m0, s59, 109824
s_add_u32 s58, s100, 3014656
v_rcp_f32 v123, v123
MAA 176,40,160
v_exp_f32 v108, v108
v_exp_f32 v109, v109
v_exp_f32 v110, v110
v_exp_f32 v111, v111
v_exp_f32 v124, v124
v_exp_f32 v125, v125
v_exp_f32 v126, v126
v_exp_f32 v127, v127
v_pk_mul_f32 v[136:137], v[136:137], v[104:105]
v_pk_mul_f32 v[138:139], v[138:139], v[106:107]
v_pk_mul_f32 v[152:153], v[152:153], v[120:121]
v_pk_mul_f32 v[154:155], v[154:155], v[122:123]
s_waitcnt lgkmcnt(2)
v_pk_fma_f32 v[160:161], v[112:113], v[20:21], v[160:161] op_sel_hi:[1,0,1]
v_pk_fma_f32 v[162:163], v[114:115], v[20:21], v[162:163] op_sel_hi:[1,0,1]
s_waitcnt lgkmcnt(1)
v_pk_fma_f32 v[176:177], v[128:129], v[20:21], v[176:177] op_sel_hi:[1,0,1]
v_pk_fma_f32 v[178:179], v[130:131], v[20:21], v[178:179] op_sel_hi:[1,0,1]
s_waitcnt lgkmcnt(0)
v_pk_fma_f32 v[192:193], v[144:145], v[20:21], v[192:193] op_sel_hi:[1,0,1]
v_pk_fma_f32 v[194:195], v[146:147], v[20:21], v[194:195] op_sel_hi:[1,0,1]
v_pk_fma_f32 v[208:209], v[12:13], v[20:21], v[208:209] op_sel_hi:[1,0,1]
v_pk_fma_f32 v[210:211], v[14:15], v[20:21], v[210:211] op_sel_hi:[1,0,1]
v_pk_mul_f32 v[192:193], v[192:193], v[160:161]
v_pk_mul_f32 v[160:161], v[160:161], v[28:29] op_sel_hi:[1,0]
v_pk_mul_f32 v[194:195], v[194:195], v[162:163]
v_pk_mul_f32 v[162:163], v[162:163], v[28:29] op_sel_hi:[1,0]
v_pk_mul_f32 v[208:209], v[208:209], v[176:177]
v_pk_mul_f32 v[176:177], v[176:177], v[28:29] op_sel_hi:[1,0]
v_pk_mul_f32 v[210:211], v[210:211], v[178:179]
v_pk_mul_f32 v[178:179], v[178:179], v[28:29] op_sel_hi:[1,0]
v_pk_fma_f32 v[108:109], v[108:109], v[26:27], v[26:27] op_sel:[0,1,1] op_sel_hi:[1,1,1]
v_pk_fma_f32 v[110:111], v[110:111], v[26:27], v[26:27] op_sel:[0,1,1] op_sel_hi:[1,1,1]
v_pk_fma_f32 v[124:125], v[124:125], v[26:27], v[26:27] op_sel:[0,1,1] op_sel_hi:[1,1,1]
v_pk_fma_f32 v[126:127], v[126:127], v[26:27], v[26:27] op_sel:[0,1,1] op_sel_hi:[1,1,1]
v_cvt_pk_bf16_f32 v104, v136, v137
v_cvt_pk_bf16_f32 v105, v138, v139
v_cvt_pk_bf16_f32 v106, v152, v153
v_cvt_pk_bf16_f32 v107, v154, v155
MAA 196,16,132
buffer_store_dwordx4 v[104:107], v11, s[16:19], s63 offen sc1
MAA 196,20,148
v_rcp_f32 v108, v108
MAA 196,48,164
v_rcp_f32 v109, v109
MAA 196,52,180
v_rcp_f32 v110, v110
MAA 212,60,180
buffer_load_dwordx4 v18, s[28:31], s58 offen lds
MAA 212,56,164
v_rcp_f32 v111, v111
MAA 212,28,148
v_rcp_f32 v124, v124
MAA 212,24,132
v_rcp_f32 v125, v125
MAA 164,32,164
buffer_load_dwordx4 v19, s[28:31], s58 offen offset:1056 lds
MAA 164,36,180
s_add_u32 m0, s59, 118272
s_add_u32 s58, s101, 3211264
v_rcp_f32 v126, v126
MAA 180,44,180
v_rcp_f32 v127, v127
MAA 180,40,164
v_lshl_add_u32 v4, v1, 4, s74
v_add_u32 v2, 67108480, v4
v_cndmask_b32 v4, v4, v2, vcc
s_and_b32 s74, s7, 1
v_bfe_u32 v7, v1, 2, 3
v_mul_u32_u24 v7, 1056, v7
v_bfe_u32 v2, v1, 5, 1
v_lshl_add_u32 v7, v2, 8, v7
v_and_b32 v2, 3, v1
v_lshl_add_u32 v7, v2, 3, v7
s_lshl_b32 s74, s74, 7
.Lpad6:
s_cbranch_execz .Lpad9
s_xor_b32 s75, s74, 128
v_add_u32 v6, s75, v7
v_add_u32 v7, s74, v7
v_exp_f32 v160, v160
v_exp_f32 v161, v161
v_exp_f32 v162, v162
v_exp_f32 v163, v163
v_exp_f32 v176, v176
v_exp_f32 v177, v177
v_exp_f32 v178, v178
v_exp_f32 v179, v179
v_pk_mul_f32 v[140:141], v[140:141], v[108:109]
v_pk_mul_f32 v[142:143], v[142:143], v[110:111]
v_pk_mul_f32 v[156:157], v[156:157], v[124:125]
v_pk_mul_f32 v[158:159], v[158:159], v[126:127]
v_pk_fma_f32 v[164:165], v[112:113], v[22:23], v[164:165] op_sel_hi:[1,0,1]
v_pk_fma_f32 v[166:167], v[114:115], v[22:23], v[166:167] op_sel_hi:[1,0,1]
v_pk_fma_f32 v[180:181], v[128:129], v[22:23], v[180:181] op_sel_hi:[1,0,1]
v_pk_fma_f32 v[182:183], v[130:131], v[22:23], v[182:183] op_sel_hi:[1,0,1]
v_pk_fma_f32 v[196:197], v[144:145], v[22:23], v[196:197] op_sel_hi:[1,0,1]
v_pk_fma_f32 v[198:199], v[146:147], v[22:23], v[198:199] op_sel_hi:[1,0,1]
v_pk_fma_f32 v[212:213], v[12:13], v[22:23], v[212:213] op_sel_hi:[1,0,1]
v_pk_fma_f32 v[214:215], v[14:15], v[22:23], v[214:215] op_sel_hi:[1,0,1]
v_pk_mul_f32 v[196:197], v[196:197], v[164:165]
v_pk_mul_f32 v[164:165], v[164:165], v[28:29] op_sel:[0,1] op_sel_hi:[1,1]
v_pk_mul_f32 v[198:199], v[198:199], v[166:167]
v_pk_mul_f32 v[166:167], v[166:167], v[28:29] op_sel:[0,1] op_sel_hi:[1,1]
v_pk_mul_f32 v[212:213], v[212:213], v[180:181]
v_pk_mul_f32 v[180:181], v[180:181], v[28:29] op_sel:[0,1] op_sel_hi:[1,1]
v_pk_mul_f32 v[214:215], v[214:215], v[182:183]
v_pk_mul_f32 v[182:183], v[182:183], v[28:29] op_sel:[0,1] op_sel_hi:[1,1]
v_pk_fma_f32 v[160:161], v[160:161], v[20:21], v[20:21] op_sel:[0,1,1] op_sel_hi:[1,1,1]
v_pk_fma_f32 v[162:163], v[162:163], v[20:21], v[20:21] op_sel:[0,1,1] op_sel_hi:[1,1,1]
v_pk_fma_f32 v[176:177], v[176:177], v[20:21], v[20:21] op_sel:[0,1,1] op_sel_hi:[1,1,1]
v_pk_fma_f32 v[178:179], v[178:179], v[20:21], v[20:21] op_sel:[0,1,1] op_sel_hi:[1,1,1]
v_cvt_pk_bf16_f32 v108, v140, v141
v_cvt_pk_bf16_f32 v109, v142, v143
v_cvt_pk_bf16_f32 v110, v156, v157
v_cvt_pk_bf16_f32 v111, v158, v159
MAA 200,16,136
buffer_store_dwordx4 v[108:111], v11, s[16:19], s63 offen offset:1024 sc1
MAA 200,20,152
v_rcp_f32 v160, v160
MAA 200,48,168
v_rcp_f32 v161, v161
MAA 200,52,184
v_rcp_f32 v162, v162
MAA 216,60,184
buffer_load_dwordx4 v18, s[28:31], s58 offen lds
MAA 216,56,168
v_rcp_f32 v163, v163
MAA 216,28,152
v_rcp_f32 v176, v176
MAA 216,24,136
v_rcp_f32 v177, v177
MAA 168,32,168
buffer_load_dwordx4 v19, s[28:31], s58 offen offset:1056 lds
MAA 168,36,184
s_add_u32 m0, s59, 126720
s_add_u32 s58, s101, 3473408
v_rcp_f32 v178, v178
MAA 184,44,184
v_rcp_f32 v179, v179
MAA 184,40,168
v_exp_f32 v164, v164
v_exp_f32 v165, v165
v_exp_f32 v166, v166
v_exp_f32 v167, v167
v_exp_f32 v180, v180
v_exp_f32 v181, v181
v_exp_f32 v182, v182
v_exp_f32 v183, v183
v_pk_mul_f32 v[192:193], v[192:193], v[160:161]
v_pk_mul_f32 v[194:195], v[194:195], v[162:163]
v_pk_mul_f32 v[208:209], v[208:209], v[176:177]
v_pk_mul_f32 v[210:211], v[210:211], v[178:179]
ds_read_b128 v[176:179], v8
v_pk_fma_f32 v[168:169], v[112:113], v[24:25], v[168:169] op_sel_hi:[1,0,1]
v_pk_fma_f32 v[170:171], v[114:115], v[24:25], v[170:171] op_sel_hi:[1,0,1]
v_pk_fma_f32 v[184:185], v[128:129], v[24:25], v[184:185] op_sel_hi:[1,0,1]
v_pk_fma_f32 v[186:187], v[130:131], v[24:25], v[186:187] op_sel_hi:[1,0,1]
v_pk_fma_f32 v[200:201], v[144:145], v[24:25], v[200:201] op_sel_hi:[1,0,1]
v_pk_fma_f32 v[202:203], v[146:147], v[24:25], v[202:203] op_sel_hi:[1,0,1]
v_pk_fma_f32 v[216:217], v[12:13], v[24:25], v[216:217] op_sel_hi:[1,0,1]
v_pk_fma_f32 v[218:219], v[14:15], v[24:25], v[218:219] op_sel_hi:[1,0,1]
v_pk_mul_f32 v[200:201], v[200:201], v[168:169]
v_pk_mul_f32 v[168:169], v[168:169], v[30:31] op_sel_hi:[1,0]
v_pk_mul_f32 v[202:203], v[202:203], v[170:171]
v_pk_mul_f32 v[170:171], v[170:171], v[30:31] op_sel_hi:[1,0]
v_pk_mul_f32 v[216:217], v[216:217], v[184:185]
v_pk_mul_f32 v[184:185], v[184:185], v[30:31] op_sel_hi:[1,0]
v_pk_mul_f32 v[218:219], v[218:219], v[186:187]
v_pk_mul_f32 v[186:187], v[186:187], v[30:31] op_sel_hi:[1,0]
v_pk_fma_f32 v[164:165], v[164:165], v[22:23], v[22:23] op_sel:[0,1,1] op_sel_hi:[1,1,1]
v_pk_fma_f32 v[166:167], v[166:167], v[22:23], v[22:23] op_sel:[0,1,1] op_sel_hi:[1,1,1]
v_pk_fma_f32 v[180:181], v[180:181], v[22:23], v[22:23] op_sel:[0,1,1] op_sel_hi:[1,1,1]
v_pk_fma_f32 v[182:183], v[182:183], v[22:23], v[22:23] op_sel:[0,1,1] op_sel_hi:[1,1,1]
v_cvt_pk_bf16_f32 v160, v192, v193
v_cvt_pk_bf16_f32 v161, v194, v195
ds_read_b128 v[192:195], v8 offset:64
v_cvt_pk_bf16_f32 v162, v208, v209
v_cvt_pk_bf16_f32 v163, v210, v211
MAA 204,16,140
buffer_store_dwordx4 v[160:163], v10, s[16:19], s64 offen sc1
MAA 204,20,156
ds_read_b128 v[208:211], v8 offset:512
v_rcp_f32 v164, v164
MAA 204,48,172
v_rcp_f32 v165, v165
MAA 204,52,188
v_rcp_f32 v166, v166
MAA 220,60,188
buffer_atomic_add v84, v69, s[16:19], s73 offen offset:512 sc0
MAA 220,56,172
v_rcp_f32 v167, v167
MAA 220,28,156
v_rcp_f32 v180, v180
MAA 220,24,140
v_rcp_f32 v181, v181
MAA 172,32,172
buffer_load_dwordx4 v18, s[28:31], s58 offen lds
MAA 172,36,188
v_rcp_f32 v182, v182
MAA 188,44,188
v_rcp_f32 v183, v183
MAA 188,40,172
v_exp_f32 v168, v168
v_exp_f32 v169, v169
v_exp_f32 v170, v170
v_exp_f32 v171, v171
v_exp_f32 v184, v184
v_exp_f32 v185, v185
v_exp_f32 v186, v186
v_exp_f32 v187, v187
v_pk_mul_f32 v[196:197], v[196:197], v[164:165]
v_pk_mul_f32 v[198:199], v[198:199], v[166:167]
v_pk_mul_f32 v[212:213], v[212:213], v[180:181]
v_pk_mul_f32 v[214:215], v[214:215], v[182:183]
v_pk_fma_f32 v[172:173], v[112:113], v[26:27], v[172:173] op_sel_hi:[1,0,1]
v_pk_fma_f32 v[174:175], v[114:115], v[26:27], v[174:175] op_sel_hi:[1,0,1]
v_pk_fma_f32 v[188:189], v[128:129], v[26:27], v[188:189] op_sel_hi:[1,0,1]
v_pk_fma_f32 v[190:191], v[130:131], v[26:27], v[190:191] op_sel_hi:[1,0,1]
v_pk_fma_f32 v[204:205], v[144:145], v[26:27], v[204:205] op_sel_hi:[1,0,1]
v_pk_fma_f32 v[206:207], v[146:147], v[26:27], v[206:207] op_sel_hi:[1,0,1]
v_pk_fma_f32 v[220:221], v[12:13], v[26:27], v[220:221] op_sel_hi:[1,0,1]
v_pk_fma_f32 v[222:223], v[14:15], v[26:27], v[222:223] op_sel_hi:[1,0,1]
v_pk_mul_f32 v[204:205], v[204:205], v[172:173]
v_pk_mul_f32 v[172:173], v[172:173], v[30:31] op_sel:[0,1] op_sel_hi:[1,1]
v_pk_mul_f32 v[206:207], v[206:207], v[174:175]
v_pk_mul_f32 v[174:175], v[174:175], v[30:31] op_sel:[0,1] op_sel_hi:[1,1]
v_pk_mul_f32 v[220:221], v[220:221], v[188:189]
v_pk_mul_f32 v[188:189], v[188:189], v[30:31] op_sel:[0,1] op_sel_hi:[1,1]
v_pk_mul_f32 v[222:223], v[222:223], v[190:191]
v_pk_mul_f32 v[190:191], v[190:191], v[30:31] op_sel:[0,1] op_sel_hi:[1,1]
v_pk_fma_f32 v[168:169], v[168:169], v[24:25], v[24:25] op_sel:[0,1,1] op_sel_hi:[1,1,1]
v_pk_fma_f32 v[170:171], v[170:171], v[24:25], v[24:25] op_sel:[0,1,1] op_sel_hi:[1,1,1]
v_pk_fma_f32 v[184:185], v[184:185], v[24:25], v[24:25] op_sel:[0,1,1] op_sel_hi:[1,1,1]
v_pk_fma_f32 v[186:187], v[186:187], v[24:25], v[24:25] op_sel:[0,1,1] op_sel_hi:[1,1,1]
v_cvt_pk_bf16_f32 v164, v196, v197
v_cvt_pk_bf16_f32 v165, v198, v199
v_cvt_pk_bf16_f32 v166, v212, v213
v_cvt_pk_bf16_f32 v167, v214, v215
MAA 240,64,128
buffer_store_dwordx4 v[164:167], v10, s[16:19], s64 offen offset:1024 sc1
MAA 240,68,144
v_rcp_f32 v168, v168
MAA 240,96,160
v_rcp_f32 v169, v169
MAA 240,100,176
v_rcp_f32 v170, v170
MAA 248,108,176
buffer_atomic_add v85, v69, s[16:19], s73 offen offset:512 sc0
MAA 248,104,160
v_rcp_f32 v171, v171
MAA 248,76,144
v_rcp_f32 v184, v184
MAA 248,72,128
v_rcp_f32 v185, v185
MAA 224,80,160
buffer_load_dwordx4 v19, s[28:31], s58 offen offset:1056 lds
MAA 224,84,176
v_rcp_f32 v186, v186
MAA 232,92,176
v_rcp_f32 v187, v187
MAA 232,88,160
v_exp_f32 v172, v172
v_exp_f32 v173, v173
v_exp_f32 v174, v174
v_exp_f32 v175, v175
v_exp_f32 v188, v188
v_exp_f32 v189, v189
v_exp_f32 v190, v190
v_exp_f32 v191, v191
v_pk_mul_f32 v[200:201], v[200:201], v[168:169]
v_pk_mul_f32 v[202:203], v[202:203], v[170:171]
v_pk_mul_f32 v[216:217], v[216:217], v[184:185]
v_pk_mul_f32 v[218:219], v[218:219], v[186:187]
s_waitcnt lgkmcnt(2)
v_pk_fma_f32 v[224:225], v[176:177], v[20:21], v[224:225] op_sel_hi:[1,0,1]
v_pk_fma_f32 v[226:227], v[178:179], v[20:21], v[226:227] op_sel_hi:[1,0,1]
s_waitcnt lgkmcnt(1)
v_pk_fma_f32 v[232:233], v[192:193], v[20:21], v[232:233] op_sel_hi:[1,0,1]
v_pk_fma_f32 v[234:235], v[194:195], v[20:21], v[234:235] op_sel_hi:[1,0,1]
s_waitcnt lgkmcnt(0)
v_pk_fma_f32 v[240:241], v[208:209], v[20:21], v[240:241] op_sel_hi:[1,0,1]
v_pk_fma_f32 v[242:243], v[210:211], v[20:21], v[242:243] op_sel_hi:[1,0,1]
v_pk_fma_f32 v[248:249], v[52:53], v[20:21], v[248:249] op_sel_hi:[1,0,1]
v_pk_fma_f32 v[250:251], v[54:55], v[20:21], v[250:251] op_sel_hi:[1,0,1]
v_pk_mul_f32 v[240:241], v[240:241], v[224:225]
v_pk_mul_f32 v[224:225], v[224:225], v[28:29] op_sel_hi:[1,0]
v_pk_mul_f32 v[242:243], v[242:243], v[226:227]
v_pk_mul_f32 v[226:227], v[226:227], v[28:29] op_sel_hi:[1,0]
v_pk_mul_f32 v[248:249], v[248:249], v[232:233]
v_pk_mul_f32 v[232:233], v[232:233], v[28:29] op_sel_hi:[1,0]
v_pk_mul_f32 v[250:251], v[250:251], v[234:235]
v_pk_mul_f32 v[234:235], v[234:235], v[28:29] op_sel_hi:[1,0]
v_pk_fma_f32 v[172:173], v[172:173], v[26:27], v[26:27] op_sel:[0,1,1] op_sel_hi:[1,1,1]
v_pk_fma_f32 v[174:175], v[174:175], v[26:27], v[26:27] op_sel:[0,1,1] op_sel_hi:[1,1,1]
v_pk_fma_f32 v[188:189], v[188:189], v[26:27], v[26:27] op_sel:[0,1,1] op_sel_hi:[1,1,1]
v_pk_fma_f32 v[190:191], v[190:191], v[26:27], v[26:27] op_sel:[0,1,1] op_sel_hi:[1,1,1]
v_cvt_pk_bf16_f32 v168, v200, v201
v_cvt_pk_bf16_f32 v169, v202, v203
v_cvt_pk_bf16_f32 v170, v216, v217
v_cvt_pk_bf16_f32 v171, v218, v219
buffer_store_dwordx4 v[168:171], v11, s[16:19], s64 offen sc1
buffer_atomic_add v86, v69, s[16:19], s73 offen offset:512 sc0
s_waitcnt vmcnt(6)
v_cmp_gt_u32 vcc, v70, v84
s_nop 0
s_cbranch_vccz .Lok49
s_waitcnt vmcnt(3)
v_cmp_gt_u32 vcc, v70, v85
s_nop 0
s_cbranch_vccz .Lok49
s_waitcnt vmcnt(0)
v_cmp_gt_u32 vcc, v70, v86
s_nop 0
s_cbranch_vccz .Lok49
s_mov_b32 s15, 0
.Lok49l:
v_mov_b32 v84, 0
buffer_atomic_add v84, v69, s[16:19], s73 offen offset:512 sc0
s_add_u32 s15, s15, 1
s_cmp_gt_u32 s15, 100000
s_waitcnt vmcnt(0)
s_cbranch_scc1 .Lok49
v_cmp_gt_u32 vcc, v70, v84
s_nop 0
s_cbranch_vccnz .Lok49l
.Lok49:
s_waitcnt vmcnt(2)
s_barrier
MAA 244,64,132
ds_read_b64_tr_b16 a[0:1], v7
s_add_u32 s52, s76, 0
MAA 244,68,148
buffer_load_dwordx4 v[96:99], v4, s[16:19], s52 offen sc1
MAA 244,96,164
TR 2,7,512
v_rcp_f32 v172, v172
MAA 244,100,180
TR 4,7,32
v_rcp_f32 v173, v173
MAA 252,108,180
TR 6,7,544
v_rcp_f32 v174, v174
MAA 252,104,164
buffer_load_dwordx4 v[100:103], v4, s[16:19], s52 offen offset:1024 sc1
MAA 252,76,148
TR 8,7,64
s_add_u32 s52, s76, 65536
MAA 252,72,132
TR 10,7,576
v_rcp_f32 v175, v175
MAA 228,80,164
TR 12,7,96
v_rcp_f32 v188, v188
MAA 228,84,180
buffer_load_dwordx4 v[104:107], v4, s[16:19], s52 offen sc1
MAA 236,92,180
TR 14,7,608
v_rcp_f32 v189, v189
MAA 236,88,164
TR 16,7,8448
v_rcp_f32 v190, v190
v_rcp_f32 v191, v191
v_exp_f32 v224, v224
v_exp_f32 v225, v225
v_exp_f32 v226, v226
v_exp_f32 v227, v227
v_exp_f32 v232, v232
v_exp_f32 v233, v233
v_exp_f32 v234, v234
v_exp_f32 v235, v235
v_pk_mul_f32 v[204:205], v[204:205], v[172:173]
buffer_load_dwordx4 v[108:111], v4, s[16:19], s52 offen offset:1024 sc1
s_add_u32 s52, s77, 114688
v_pk_mul_f32 v[206:207], v[206:207], v[174:175]
v_pk_mul_f32 v[220:221], v[220:221], v[188:189]
v_pk_mul_f32 v[222:223], v[222:223], v[190:191]
v_pk_fma_f32 v[228:229], v[176:177], v[22:23], v[228:229] op_sel_hi:[1,0,1]
v_pk_fma_f32 v[230:231], v[178:179], v[22:23], v[230:231] op_sel_hi:[1,0,1]
v_pk_fma_f32 v[236:237], v[192:193], v[22:23], v[236:237] op_sel_hi:[1,0,1]
v_pk_fma_f32 v[238:239], v[194:195], v[22:23], v[238:239] op_sel_hi:[1,0,1]
v_pk_fma_f32 v[244:245], v[208:209], v[22:23], v[244:245] op_sel_hi:[1,0,1]
v_pk_fma_f32 v[246:247], v[210:211], v[22:23], v[246:247] op_sel_hi:[1,0,1]
v_pk_fma_f32 v[252:253], v[52:53], v[22:23], v[252:253] op_sel_hi:[1,0,1]
v_pk_fma_f32 v[254:255], v[54:55], v[22:23], v[254:255] op_sel_hi:[1,0,1]
v_pk_mul_f32 v[244:245], v[244:245], v[228:229]
buffer_load_dwordx4 v[112:115], v4, s[16:19], s52 offen sc1
v_pk_mul_f32 v[228:229], v[228:229], v[28:29] op_sel:[0,1] op_sel_hi:[1,1]
v_pk_mul_f32 v[246:247], v[246:247], v[230:231]
v_pk_mul_f32 v[230:231], v[230:231], v[28:29] op_sel:[0,1] op_sel_hi:[1,1]
v_pk_mul_f32 v[252:253], v[252:253], v[236:237]
v_pk_mul_f32 v[236:237], v[236:237], v[28:29] op_sel:[0,1] op_sel_hi:[1,1]
v_pk_mul_f32 v[254:255], v[254:255], v[238:239]
v_pk_mul_f32 v[238:239], v[238:239], v[28:29] op_sel:[0,1] op_sel_hi:[1,1]
v_pk_fma_f32 v[224:225], v[224:225], v[20:21], v[20:21] op_sel:[0,1,1] op_sel_hi:[1,1,1]
v_pk_fma_f32 v[226:227], v[226:227], v[20:21], v[20:21] op_sel:[0,1,1] op_sel_hi:[1,1,1]
v_pk_fma_f32 v[232:233], v[232:233], v[20:21], v[20:21] op_sel:[0,1,1] op_sel_hi:[1,1,1]
v_pk_fma_f32 v[234:235], v[234:235], v[20:21], v[20:21] op_sel:[0,1,1] op_sel_hi:[1,1,1]
v_cvt_pk_bf16_f32 v172, v204, v205
v_cvt_pk_bf16_f32 v173, v206, v207
buffer_load_dwordx4 v[116:119], v4, s[16:19], s52 offen offset:1024 sc1
s_add_u32 s52, s77, 180224
v_cvt_pk_bf16_f32 v174, v220, v221
v_cvt_pk_bf16_f32 v175, v222, v223
TR 18,7,8960
TR 20,7,8480
TR 22,7,8992
TR 24,7,8512
TR 26,7,9024
buffer_store_dwordx4 v[172:175], v11, s[16:19], s64 offen offset:1024 sc1
TR 28,7,8544
TR 30,7,9056
v_rcp_f32 v224, v224
v_rcp_f32 v225, v225
v_rcp_f32 v226, v226
v_rcp_f32 v227, v227
v_rcp_f32 v232, v232
v_rcp_f32 v233, v233
v_rcp_f32 v234, v234
v_rcp_f32 v235, v235
v_exp_f32 v228, v228
v_exp_f32 v229, v229
v_exp_f32 v230, v230
v_exp_f32 v231, v231
v_exp_f32 v236, v236
v_exp_f32 v237, v237
v_exp_f32 v238, v238
v_exp_f32 v239, v239
v_pk_mul_f32 v[240:241], v[240:241], v[224:225]
buffer_load_dwordx4 v[120:123], v4, s[16:19], s52 offen sc1
v_pk_mul_f32 v[242:243], v[242:243], v[226:227]
v_pk_mul_f32 v[248:249], v[248:249], v[232:233]
v_pk_mul_f32 v[250:251], v[250:251], v[234:235]
v_pk_fma_f32 v[228:229], v[228:229], v[22:23], v[22:23] op_sel:[0,1,1] op_sel_hi:[1,1,1]
v_pk_fma_f32 v[230:231], v[230:231], v[22:23], v[22:23] op_sel:[0,1,1] op_sel_hi:[1,1,1]
v_pk_fma_f32 v[236:237], v[236:237], v[22:23], v[22:23] op_sel:[0,1,1] op_sel_hi:[1,1,1]
v_pk_fma_f32 v[238:239], v[238:239], v[22:23], v[22:23] op_sel:[0,1,1] op_sel_hi:[1,1,1]
v_cvt_pk_bf16_f32 v224, v240, v241
v_cvt_pk_bf16_f32 v225, v242, v243
v_cvt_pk_bf16_f32 v226, v248, v249
v_cvt_pk_bf16_f32 v227, v250, v251
v_rcp_f32 v228, v228
v_rcp_f32 v229, v229
v_rcp_f32 v230, v230
v_rcp_f32 v231, v231
v_rcp_f32 v236, v236
v_rcp_f32 v237, v237
v_rcp_f32 v238, v238
v_rcp_f32 v239, v239
v_pk_mul_f32 v[244:245], v[244:245], v[228:229]
buffer_store_dwordx4 v[224:227], v10, s[16:19], s65 offen sc1
v_pk_mul_f32 v[246:247], v[246:247], v[230:231]
v_pk_mul_f32 v[252:253], v[252:253], v[236:237]
v_pk_mul_f32 v[254:255], v[254:255], v[238:239]
v_cvt_pk_bf16_f32 v228, v244, v245
v_cvt_pk_bf16_f32 v229, v246, v247
v_cvt_pk_bf16_f32 v230, v252, v253
v_cvt_pk_bf16_f32 v231, v254, v255
buffer_store_dwordx4 v[228:231], v10, s[16:19], s65 offen offset:1024 sc1
buffer_load_dwordx4 v[124:127], v4, s[16:19], s52 offen offset:1024 sc1
v_mov_b32 v21, v68
v_mov_b32 v22, v69
v_mov_b32 v23, v70
v_mov_b32 v24, v71
v_mov_b32 v25, 0
s_waitcnt vmcnt(7) lgkmcnt(0)
s_barrier
v_mfma_f32_16x16x32_bf16 v[32:35], a[0:3], v[96:99], 0
ds_read_b64_tr_b16 a[32:33], v6
s_add_u32 s52, s78, 229376
MAV 32,16,104
buffer_load_dwordx4 v[128:131], v4, s[16:19], s52 offen sc1
v_mfma_f32_16x16x32_bf16 v[48:51], a[0:3], v[100:103], 0
TR 34,6,512
MAV 48,16,108
TR 36,6,32
TR 38,6,544
v_mfma_f32_16x16x32_bf16 v[52:55], a[4:7], v[100:103], 0
TR 48,6,8448
MAV 52,20,108
buffer_load_dwordx4 v[132:135], v4, s[16:19], s52 offen offset:1024 sc1
v_mfma_f32_16x16x32_bf16 v[36:39], a[4:7], v[96:99], 0
TR 50,6,8960
MAV 36,20,104
TR 52,6,8480
TR 54,6,8992
v_mfma_f32_16x16x32_bf16 v[40:43], a[8:11], v[96:99], 0
TR 40,6,64
s_add_u32 s52, s78, 294912
MAV 40,24,104
buffer_load_dwordx4 v[136:139], v4, s[16:19], s52 offen sc1
v_mfma_f32_16x16x32_bf16 v[56:59], a[8:11], v[100:103], 0
TR 42,6,576
MAV 56,24,108
TR 44,6,96
TR 46,6,608
v_mfma_f32_16x16x32_bf16 v[60:63], a[12:15], v[100:103], 0
TR 56,6,8512
MAV 60,28,108
buffer_load_dwordx4 v[140:143], v4, s[16:19], s52 offen offset:1024 sc1
v_mfma_f32_16x16x32_bf16 v[44:47], a[12:15], v[96:99], 0
TR 58,6,9024
MAV 44,28,104
TR 60,6,8544
TR 62,6,9056
s_waitcnt lgkmcnt(8)
v_mfma_f32_16x16x32_bf16 v[64:67], a[32:35], v[96:99], 0
TR 0,7,16896
s_add_u32 s52, s79, 344064
MAV 64,48,104
buffer_load_dwordx4 v[144:147], v4, s[16:19], s52 offen sc1
v_mfma_f32_16x16x32_bf16 v[80:83], a[32:35], v[100:103], 0
TR 2,7,17408
MAV 80,48,108
TR 4,7,16928
TR 6,7,17440
v_mfma_f32_16x16x32_bf16 v[84:87], a[36:39], v[100:103], 0
TR 16,7,25344
MAV 84,52,108
buffer_load_dwordx4 v[148:151], v4, s[16:19], s52 offen offset:1024 sc1
v_mfma_f32_16x16x32_bf16 v[68:71], a[36:39], v[96:99], 0
TR 18,7,25856
MAV 68,52,104
TR 20,7,25376
TR 22,7,25888
s_waitcnt lgkmcnt(8)
v_mfma_f32_16x16x32_bf16 v[72:75], a[40:43], v[96:99], 0
TR 8,7,16960
s_add_u32 s52, s79, 409600
MAV 72,56,104
buffer_load_dwordx4 v[152:155], v4, s[16:19], s52 offen sc1
v_mfma_f32_16x16x32_bf16 v[88:91], a[40:43], v[100:103], 0
TR 10,7,17472
MAV 88,56,108
TR 12,7,16992
TR 14,7,17504
v_mfma_f32_16x16x32_bf16 v[92:95], a[44:47], v[100:103], 0
TR 24,7,25408
MAV 92,60,108
buffer_load_dwordx4 v[156:159], v4, s[16:19], s52 offen offset:1024 sc1
v_mfma_f32_16x16x32_bf16 v[76:79], a[44:47], v[96:99], 0
TR 26,7,25920
MAV 76,60,104
TR 28,7,25440
TR 30,7,25952
s_waitcnt vmcnt(8) lgkmcnt(8)
s_barrier
MAV 32,0,112
TR 32,6,16896
MAV 32,16,120
buffer_atomic_add v24, v21, s[16:19], s72 offen
MAV 48,16,124
TR 34,6,17408
MAV 48,0,116
TR 36,6,16928
TR 38,6,17440
TR 48,6,25344
MAV 52,4,116
TR 50,6,25856
s_add_u32 m0, s55, 0
MAV 52,20,124
buffer_load_dwordx4 v18, s[28:31], s54 offen lds
MAV 36,20,120
TR 52,6,25376
MAV 36,4,112
TR 54,6,25888
TR 40,6,16960
s_waitcnt lgkmcnt(9)
MAV 40,8,112
TR 42,6,17472
s_add_u32 s52, s76, 458752
MAV 40,24,120
buffer_load_dwordx4 v[96:99], v4, s[16:19], s52 offen sc1
MAV 56,24,124
TR 44,6,16992
MAV 56,8,116
buffer_load_dwordx4 v19, s[28:31], s54 offen offset:1056 lds
MAV 60,12,116
TR 46,6,17504
s_add_u32 s54, s98, 327680
MAV 60,28,124
buffer_load_dwordx4 v[100:103], v4, s[16:19], s52 offen offset:1024 sc1
MAV 44,28,120
TR 56,6,25408
MAV 44,12,112
TR 58,6,25920
TR 60,6,25440
TR 62,6,25952
s_waitcnt lgkmcnt(8)
MAV 64,32,112
TR 0,7,33792
s_add_u32 m0, s55, 8448
MAV 64,48,120
buffer_load_dwordx4 v18, s[28:31], s54 offen lds
MAV 80,48,124
TR 2,7,34304
MAV 80,32,116
TR 4,7,33824
TR 6,7,34336
MAV 84,36,116
TR 16,7,42240
s_add_u32 s52, s76, 524288
MAV 84,52,124
buffer_load_dwordx4 v[104:107], v4, s[16:19], s52 offen sc1
MAV 68,52,120
TR 18,7,42752
MAV 68,36,112
TR 20,7,42272
TR 22,7,42784
s_waitcnt lgkmcnt(8)
MAV 72,40,112
TR 8,7,33856
MAV 72,56,120
buffer_load_dwordx4 v19, s[28:31], s54 offen offset:1056 lds
MAV 88,56,124
TR 10,7,34368
s_add_u32 s54, s99, 524288
MAV 88,40,116
TR 12,7,33888
TR 14,7,34400
MAV 92,44,116
TR 24,7,42304
MAV 92,60,124
buffer_load_dwordx4 v[108:111], v4, s[16:19], s52 offen offset:1024 sc1
MAV 76,60,120
TR 26,7,42816
MAV 76,44,112
TR 28,7,42336
TR 30,7,42848
s_waitcnt vmcnt(13) lgkmcnt(8)
s_barrier
MAV 32,0,128
TR 32,6,33792
s_add_u32 m0, s55, 16896
MAV 32,16,136
buffer_load_dwordx4 v18, s[28:31], s54 offen lds
MAV 48,16,140
TR 34,6,34304
MAV 48,0,132
TR 36,6,33824
TR 38,6,34336
MAV 52,4,132
TR 48,6,42240
s_add_u32 s52, s77, 573440
MAV 52,20,140
buffer_load_dwordx4 v[112:115], v4, s[16:19], s52 offen sc1
MAV 36,20,136
TR 50,6,42752
MAV 36,4,128
TR 52,6,42272
TR 54,6,42784
s_waitcnt lgkmcnt(8)
MAV 40,8,128
TR 40,6,33856
MAV 40,24,136
buffer_load_dwordx4 v19, s[28:31], s54 offen offset:1056 lds
MAV 56,24,140
TR 42,6,34368
s_add_u32 s54, s99, 786432
MAV 56,8,132
TR 44,6,33888
TR 46,6,34400
.Lpad7:
s_cbranch_execz .Lpad10
MAV 60,12,132
TR 56,6,42304
MAV 60,28,140
buffer_load_dwordx4 v[116:119], v4, s[16:19], s52 offen offset:1024 sc1
MAV 44,28,136
TR 58,6,42816
MAV 44,12,128
TR 60,6,42336
TR 62,6,42848
s_waitcnt lgkmcnt(8)
MAV 64,32,128
TR 0,7,50688
s_add_u32 m0, s55, 25344
MAV 64,48,136
buffer_load_dwordx4 v18, s[28:31], s54 offen lds
MAV 80,48,140
TR 2,7,51200
MAV 80,32,132
TR 4,7,50720
TR 6,7,51232
TR 16,7,59136
MAV 84,36,132
TR 18,7,59648
s_add_u32 s52, s77, 638976
MAV 84,52,140
buffer_load_dwordx4 v[120:123], v4, s[16:19], s52 offen sc1
MAV 68,52,136
TR 20,7,59168
MAV 68,36,128
TR 22,7,59680
TR 8,7,50752
s_waitcnt lgkmcnt(9)
MAV 72,40,128
TR 10,7,51264
MAV 72,56,136
buffer_load_dwordx4 v19, s[28:31], s54 offen offset:1056 lds
MAV 88,56,140
TR 12,7,50784
s_add_u32 s54, s100, 983040
MAV 88,40,132
buffer_load_dwordx4 v[124:127], v4, s[16:19], s52 offen offset:1024 sc1
MAV 92,44,132
TR 14,7,51296
MAV 92,60,140
buffer_atomic_add v25, v22, s[16:19], s73 offen sc0
MAV 76,60,136
TR 24,7,59200
MAV 76,44,128
TR 26,7,59712
TR 28,7,59232
TR 30,7,59744
s_waitcnt vmcnt(18) lgkmcnt(8)
s_barrier
MAV 32,0,144
TR 32,6,50688
s_add_u32 m0, s55, 33792
MAV 32,16,152
buffer_load_dwordx4 v18, s[28:31], s54 offen lds
MAV 48,16,156
TR 34,6,51200
MAV 48,0,148
TR 36,6,50720
TR 38,6,51232
MAV 52,4,148
TR 48,6,59136
s_add_u32 s52, s78, 688128
MAV 52,20,156
buffer_load_dwordx4 v[128:131], v4, s[16:19], s52 offen sc1
MAV 36,20,152
TR 50,6,59648
MAV 36,4,144
TR 52,6,59168
TR 54,6,59680
s_waitcnt lgkmcnt(8)
MAV 40,8,144
TR 40,6,50752
MAV 40,24,152
buffer_load_dwordx4 v19, s[28:31], s54 offen offset:1056 lds
MAV 56,24,156
TR 42,6,51264
s_add_u32 s54, s100, 1245184
MAV 56,8,148
TR 44,6,50784
TR 46,6,51296
MAV 60,12,148
TR 56,6,59200
MAV 60,28,156
buffer_load_dwordx4 v[132:135], v4, s[16:19], s52 offen offset:1024 sc1
MAV 44,28,152
TR 58,6,59712
MAV 44,12,144
TR 60,6,59232
TR 62,6,59744
v_add_u32 v7, s57, v7
v_add_u32 v6, s57, v6
s_sub_u32 s57, 0, s57
s_waitcnt lgkmcnt(8)
MAV 64,32,144
ds_read_b64_tr_b16 a[0:1], v7
s_add_u32 m0, s55, 42240
MAV 64,48,152
buffer_load_dwordx4 v18, s[28:31], s54 offen lds
MAV 80,48,156
TR 2,7,512
MAV 80,32,148
TR 4,7,32
TR 6,7,544
MAV 84,36,148
TR 16,7,8448
s_add_u32 s52, s78, 753664
MAV 84,52,156
buffer_load_dwordx4 v[136:139], v4, s[16:19], s52 offen sc1
MAV 68,52,152
TR 18,7,8960
MAV 68,36,144
TR 20,7,8480
TR 22,7,8992
s_waitcnt lgkmcnt(8)
MAV 72,40,144
TR 8,7,64
MAV 72,56,152
buffer_load_dwordx4 v19, s[28:31], s54 offen offset:1056 lds
MAV 88,56,156
TR 10,7,576
s_add_u32 s54, s101, 1441792
MAV 88,40,148
TR 12,7,96
TR 14,7,608
MAV 92,44,148
TR 24,7,8512
MAV 92,60,156
buffer_load_dwordx4 v[140:143], v4, s[16:19], s52 offen offset:1024 sc1
MAV 76,60,152
TR 26,7,9024
MAV 76,44,144
TR 28,7,8544
TR 30,7,9056
s_waitcnt vmcnt(17) lgkmcnt(8)
s_barrier
MAV 32,0,96
ds_read_b64_tr_b16 a[32:33], v6
s_add_u32 m0, s55, 50688
MAV 32,16,104
buffer_load_dwordx4 v18, s[28:31], s54 offen lds
MAV 48,16,108
TR 34,6,512
MAV 48,0,100
TR 36,6,32
TR 38,6,544
MAV 52,4,100
TR 48,6,8448
s_add_u32 s52, s79, 802816
MAV 52,20,108
buffer_load_dwordx4 v[144:147], v4, s[16:19], s52 offen sc1
MAV 36,20,104
TR 50,6,8960
MAV 36,4,96
TR 52,6,8480
TR 54,6,8992
s_waitcnt lgkmcnt(8)
MAV 40,8,96
TR 40,6,64
MAV 40,24,104
buffer_load_dwordx4 v19, s[28:31], s54 offen offset:1056 lds
MAV 56,24,108
TR 42,6,576
s_add_u32 s54, s101, 1703936
MAV 56,8,100
TR 44,6,96
TR 46,6,608
MAV 60,12,100
TR 56,6,8512
MAV 60,28,108
buffer_load_dwordx4 v[148:151], v4, s[16:19], s52 offen offset:1024 sc1
MAV 44,28,104
TR 58,6,9024
MAV 44,12,96
TR 60,6,8544
TR 62,6,9056
s_waitcnt lgkmcnt(8)
MAV 64,32,96
TR 0,7,16896
s_add_u32 m0, s55, 59136
MAV 64,48,104
buffer_load_dwordx4 v18, s[28:31], s54 offen lds
MAV 80,48,108
TR 2,7,17408
MAV 80,32,100
TR 4,7,16928
TR 6,7,17440
MAV 84,36,100
TR 16,7,25344
s_add_u32 s52, s79, 868352
MAV 84,52,108
buffer_load_dwordx4 v[152:155], v4, s[16:19], s52 offen sc1
MAV 68,52,104
TR 18,7,25856
MAV 68,36,96
TR 20,7,25376
TR 22,7,25888
s_waitcnt lgkmcnt(8)
MAV 72,40,96
TR 8,7,16960
MAV 72,56,104
buffer_load_dwordx4 v19, s[28:31], s54 offen offset:1056 lds
MAV 88,56,108
TR 10,7,17472
s_add_u32 s54, s98, 1900544
MAV 88,40,100
TR 12,7,16992
TR 14,7,17504
MAV 92,44,100
TR 24,7,25408
MAV 92,60,108
buffer_load_dwordx4 v[156:159], v4, s[16:19], s52 offen offset:1024 sc1
MAV 76,60,104
TR 26,7,25920
MAV 76,44,96
TR 28,7,25440
TR 30,7,25952
s_waitcnt vmcnt(16)
v_cmp_gt_u32 vcc, v23, v25
s_nop 0
s_cbranch_vccnz .Lsp50
.Lsp50b:
s_waitcnt lgkmcnt(8)
s_barrier
MAV 32,0,112
TR 32,6,16896
s_add_u32 m0, s55, 67584
MAV 32,16,120
buffer_load_dwordx4 v18, s[28:31], s54 offen lds
MAV 48,16,124
TR 34,6,17408
MAV 48,0,116
TR 36,6,16928
TR 38,6,17440
MAV 52,4,116
TR 48,6,25344
s_add_u32 s52, s76, 16384
MAV 52,20,124
buffer_load_dwordx4 v[96:99], v4, s[16:19], s52 offen sc1
MAV 36,20,120
TR 50,6,25856
MAV 36,4,112
TR 52,6,25376
TR 54,6,25888
s_waitcnt lgkmcnt(8)
MAV 40,8,112
TR 40,6,16960
MAV 40,24,120
buffer_load_dwordx4 v19, s[28:31], s54 offen offset:1056 lds
MAV 56,24,124
TR 42,6,17472
s_add_u32 s54, s98, 2162688
MAV 56,8,116
TR 44,6,16992
TR 46,6,17504
MAV 60,12,116
TR 56,6,25408
MAV 60,28,124
buffer_load_dwordx4 v[100:103], v4, s[16:19], s52 offen offset:1024 sc1
MAV 44,28,120
TR 58,6,25920
MAV 44,12,112
TR 60,6,25440
TR 62,6,25952
s_waitcnt lgkmcnt(8)
MAV 64,32,112
TR 0,7,33792
s_add_u32 m0, s55, 76032
MAV 64,48,120
buffer_load_dwordx4 v18, s[28:31], s54 offen lds
MAV 80,48,124
TR 2,7,34304
MAV 80,32,116
TR 4,7,33824
TR 6,7,34336
MAV 84,36,116
TR 16,7,42240
s_add_u32 s52, s76, 81920
MAV 84,52,124
buffer_load_dwordx4 v[104:107], v4, s[16:19], s52 offen sc1
MAV 68,52,120
TR 18,7,42752
MAV 68,36,112
TR 20,7,42272
TR 22,7,42784
s_waitcnt lgkmcnt(8)
MAV 72,40,112
TR 8,7,33856
MAV 72,56,120
buffer_load_dwordx4 v19, s[28:31], s54 offen offset:1056 lds
MAV 88,56,124
TR 10,7,34368
s_add_u32 s54, s99, 2359296
MAV 88,40,116
TR 12,7,33888
TR 14,7,34400
MAV 92,44,116
TR 24,7,42304
MAV 92,60,124
buffer_load_dwordx4 v[108:111], v4, s[16:19], s52 offen offset:1024 sc1
MAV 76,60,120
TR 26,7,42816
MAV 76,44,112
TR 28,7,42336
TR 30,7,42848
s_waitcnt vmcnt(16) lgkmcnt(8)
s_barrier
MAV 32,0,128
TR 32,6,33792
s_add_u32 m0, s55, 84480
MAV 32,16,136
buffer_load_dwordx4 v18, s[28:31], s54 offen lds
MAV 48,16,140
TR 34,6,34304
MAV 48,0,132
TR 36,6,33824
TR 38,6,34336
MAV 52,4,132
TR 48,6,42240
s_add_u32 s52, s77, 131072
MAV 52,20,140
buffer_load_dwordx4 v[112:115], v4, s[16:19], s52 offen sc1
MAV 36,20,136
TR 50,6,42752
MAV 36,4,128
TR 52,6,42272
TR 54,6,42784
s_waitcnt lgkmcnt(8)
MAV 40,8,128
TR 40,6,33856
MAV 40,24,136
buffer_load_dwordx4 v19, s[28:31], s54 offen offset:1056 lds
MAV 56,24,140
TR 42,6,34368
s_add_u32 s54, s99, 2621440
MAV 56,8,132
TR 44,6,33888
TR 46,6,34400
MAV 60,12,132
TR 56,6,42304
MAV 60,28,140
buffer_load_dwordx4 v[116:119], v4, s[16:19], s52 offen offset:1024 sc1
MAV 44,28,136
TR 58,6,42816
MAV 44,12,128
TR 60,6,42336
TR 62,6,42848
s_waitcnt lgkmcnt(8)
MAV 64,32,128
TR 0,7,50688
s_add_u32 m0, s55, 92928
MAV 64,48,136
buffer_load_dwordx4 v18, s[28:31], s54 offen lds
MAV 80,48,140
TR 2,7,51200
MAV 80,32,132
TR 4,7,50720
TR 6,7,51232
MAV 84,36,132
TR 16,7,59136
s_add_u32 s52, s77, 196608
MAV 84,52,140
buffer_load_dwordx4 v[120:123], v4, s[16:19], s52 offen sc1
MAV 68,52,136
TR 18,7,59648
MAV 68,36,128
TR 20,7,59168
TR 22,7,59680
s_waitcnt lgkmcnt(8)
MAV 72,40,128
TR 8,7,50752
MAV 72,56,136
buffer_load_dwordx4 v19, s[28:31], s54 offen offset:1056 lds
MAV 88,56,140
TR 10,7,51264
s_add_u32 s54, s100, 2818048
MAV 88,40,132
TR 12,7,50784
TR 14,7,51296
MAV 92,44,132
TR 24,7,59200
MAV 92,60,140
buffer_load_dwordx4 v[124:127], v4, s[16:19], s52 offen offset:1024 sc1
MAV 76,60,136
TR 26,7,59712
MAV 76,44,128
TR 28,7,59232
TR 30,7,59744
s_waitcnt vmcnt(16) lgkmcnt(8)
s_barrier
MAV 32,0,144
TR 32,6,50688
s_add_u32 m0, s55, 101376
MAV 32,16,152
buffer_load_dwordx4 v18, s[28:31], s54 offen lds
MAV 48,16,156
TR 34,6,51200
MAV 48,0,148
TR 36,6,50720
TR 38,6,51232
MAV 52,4,148
TR 48,6,59136
s_add_u32 s52, s78, 245760
MAV 52,20,156
buffer_load_dwordx4 v[128:131], v4, s[16:19], s52 offen sc1
MAV 36,20,152
TR 50,6,59648
MAV 36,4,144
TR 52,6,59168
TR 54,6,59680
s_waitcnt lgkmcnt(8)
MAV 40,8,144
TR 40,6,50752
MAV 40,24,152
buffer_load_dwordx4 v19, s[28:31], s54 offen offset:1056 lds
MAV 56,24,156
TR 42,6,51264
s_add_u32 s54, s100, 3080192
MAV 56,8,148
TR 44,6,50784
TR 46,6,51296
MAV 60,12,148
TR 56,6,59200
MAV 60,28,156
buffer_load_dwordx4 v[132:135], v4, s[16:19], s52 offen offset:1024 sc1
MAV 44,28,152
TR 58,6,59712
MAV 44,12,144
TR 60,6,59232
TR 62,6,59744
v_add_u32 v7, s57, v7
v_add_u32 v6, s57, v6
s_sub_u32 s57, 0, s57
s_waitcnt lgkmcnt(8)
MAV 64,32,144
ds_read_b64_tr_b16 a[0:1], v7
s_add_u32 m0, s55, 109824
MAV 64,48,152
buffer_load_dwordx4 v18, s[28:31], s54 offen lds
MAV 80,48,156
TR 2,7,512
MAV 80,32,148
TR 4,7,32
TR 6,7,544
MAV 84,36,148
TR 16,7,8448
s_add_u32 s52, s78, 311296
MAV 84,52,156
buffer_load_dwordx4 v[136:139], v4, s[16:19], s52 offen sc1
MAV 68,52,152
TR 18,7,8960
MAV 68,36,144
TR 20,7,8480
TR 22,7,8992
s_waitcnt lgkmcnt(8)
MAV 72,40,144
TR 8,7,64
MAV 72,56,152
buffer_load_dwordx4 v19, s[28:31], s54 offen offset:1056 lds
MAV 88,56,156
TR 10,7,576
s_add_u32 s54, s101, 3276800
MAV 88,40,148
TR 12,7,96
TR 14,7,608
MAV 92,44,148
TR 24,7,8512
MAV 92,60,156
buffer_load_dwordx4 v[140:143], v4, s[16:19], s52 offen offset:1024 sc1
MAV 76,60,152
TR 26,7,9024
MAV 76,44,144
TR 28,7,8544
TR 30,7,9056
s_waitcnt vmcnt(16) lgkmcnt(8)
s_barrier
MAV 32,0,96
ds_read_b64_tr_b16 a[32:33], v6
s_add_u32 m0, s55, 118272
MAV 32,16,104
buffer_load_dwordx4 v18, s[28:31], s54 offen lds
MAV 48,16,108
TR 34,6,512
MAV 48,0,100
TR 36,6,32
TR 38,6,544
MAV 52,4,100
TR 48,6,8448
s_add_u32 s52, s79, 360448
MAV 52,20,108
buffer_load_dwordx4 v[144:147], v4, s[16:19], s52 offen sc1
MAV 36,20,104
TR 50,6,8960
MAV 36,4,96
TR 52,6,8480
TR 54,6,8992
s_waitcnt lgkmcnt(8)
MAV 40,8,96
TR 40,6,64
MAV 40,24,104
buffer_load_dwordx4 v19, s[28:31], s54 offen offset:1056 lds
MAV 56,24,108
TR 42,6,576
s_add_u32 s54, s101, 3538944
MAV 56,8,100
TR 44,6,96
TR 46,6,608
MAV 60,12,100
TR 56,6,8512
MAV 60,28,108
buffer_load_dwordx4 v[148:151], v4, s[16:19], s52 offen offset:1024 sc1
MAV 44,28,104
TR 58,6,9024
MAV 44,12,96
TR 60,6,8544
TR 62,6,9056
s_waitcnt lgkmcnt(8)
MAV 64,32,96
TR 0,7,16896
s_add_u32 m0, s55, 126720
MAV 64,48,104
buffer_load_dwordx4 v18, s[28:31], s54 offen lds
MAV 80,48,108
TR 2,7,17408
MAV 80,32,100
TR 4,7,16928
TR 6,7,17440
MAV 84,36,100
TR 16,7,25344
s_add_u32 s52, s79, 425984
.Lpad8:
s_cbranch_execz .Lpad11
MAV 84,52,108
buffer_load_dwordx4 v[152:155], v4, s[16:19], s52 offen sc1
MAV 68,52,104
TR 18,7,25856
MAV 68,36,96
TR 20,7,25376
TR 22,7,25888
s_waitcnt lgkmcnt(8)
MAV 72,40,96
TR 8,7,16960
MAV 72,56,104
buffer_load_dwordx4 v19, s[28:31], s54 offen offset:1056 lds
MAV 88,56,108
TR 10,7,17472
s_add_u32 s54, s98, 131072
MAV 88,40,100
TR 12,7,16992
TR 14,7,17504
MAV 92,44,100
TR 24,7,25408
MAV 92,60,108
buffer_load_dwordx4 v[156:159], v4, s[16:19], s52 offen offset:1024 sc1
MAV 76,60,104
TR 26,7,25920
MAV 76,44,96
TR 28,7,25440
TR 30,7,25952
s_waitcnt vmcnt(16) lgkmcnt(8)
s_barrier
MAV 32,0,112
TR 32,6,16896
s_add_u32 m0, s55, 0
MAV 32,16,120
buffer_load_dwordx4 v18, s[28:31], s54 offen lds
MAV 48,16,124
TR 34,6,17408
MAV 48,0,116
TR 36,6,16928
TR 38,6,17440
MAV 52,4,116
TR 48,6,25344
s_add_u32 s52, s76, 475136
MAV 52,20,124
buffer_load_dwordx4 v[96:99], v4, s[16:19], s52 offen sc1
MAV 36,20,120
TR 50,6,25856
MAV 36,4,112
TR 52,6,25376
TR 54,6,25888
s_waitcnt lgkmcnt(8)
MAV 40,8,112
TR 40,6,16960
MAV 40,24,120
buffer_load_dwordx4 v19, s[28:31], s54 offen offset:1056 lds
MAV 56,24,124
TR 42,6,17472
s_add_u32 s54, s98, 393216
MAV 56,8,116
TR 44,6,16992
TR 46,6,17504
MAV 60,12,116
TR 56,6,25408
MAV 60,28,124
buffer_load_dwordx4 v[100:103], v4, s[16:19], s52 offen offset:1024 sc1
MAV 44,28,120
TR 58,6,25920
MAV 44,12,112
TR 60,6,25440
TR 62,6,25952
s_waitcnt lgkmcnt(8)
MAV 64,32,112
TR 0,7,33792
s_add_u32 m0, s55, 8448
MAV 64,48,120
buffer_load_dwordx4 v18, s[28:31], s54 offen lds
MAV 80,48,124
TR 2,7,34304
MAV 80,32,116
TR 4,7,33824
TR 6,7,34336
MAV 84,36,116
TR 16,7,42240
s_add_u32 s52, s76, 540672
MAV 84,52,124
buffer_load_dwordx4 v[104:107], v4, s[16:19], s52 offen sc1
MAV 68,52,120
TR 18,7,42752
MAV 68,36,112
TR 20,7,42272
TR 22,7,42784
s_waitcnt lgkmcnt(8)
MAV 72,40,112
TR 8,7,33856
MAV 72,56,120
buffer_load_dwordx4 v19, s[28:31], s54 offen offset:1056 lds
MAV 88,56,124
TR 10,7,34368
s_add_u32 s54, s99, 589824
MAV 88,40,116
TR 12,7,33888
TR 14,7,34400
MAV 92,44,116
TR 24,7,42304
MAV 92,60,124
buffer_load_dwordx4 v[108:111], v4, s[16:19], s52 offen offset:1024 sc1
MAV 76,60,120
TR 26,7,42816
MAV 76,44,112
TR 28,7,42336
TR 30,7,42848
s_waitcnt vmcnt(16) lgkmcnt(8)
s_barrier
MAV 32,0,128
TR 32,6,33792
s_add_u32 m0, s55, 16896
MAV 32,16,136
buffer_load_dwordx4 v18, s[28:31], s54 offen lds
MAV 48,16,140
TR 34,6,34304
MAV 48,0,132
TR 36,6,33824
TR 38,6,34336
MAV 52,4,132
TR 48,6,42240
s_add_u32 s52, s77, 589824
MAV 52,20,140
buffer_load_dwordx4 v[112:115], v4, s[16:19], s52 offen sc1
MAV 36,20,136
TR 50,6,42752
MAV 36,4,128
TR 52,6,42272
TR 54,6,42784
s_waitcnt lgkmcnt(8)
MAV 40,8,128
TR 40,6,33856
MAV 40,24,136
buffer_load_dwordx4 v19, s[28:31], s54 offen offset:1056 lds
MAV 56,24,140
TR 42,6,34368
s_add_u32 s54, s99, 851968
MAV 56,8,132
TR 44,6,33888
TR 46,6,34400
MAV 60,12,132
TR 56,6,42304
MAV 60,28,140
buffer_load_dwordx4 v[116:119], v4, s[16:19], s52 offen offset:1024 sc1
MAV 44,28,136
TR 58,6,42816
MAV 44,12,128
TR 60,6,42336
TR 62,6,42848
s_waitcnt lgkmcnt(8)
MAV 64,32,128
TR 0,7,50688
s_add_u32 m0, s55, 25344
MAV 64,48,136
buffer_load_dwordx4 v18, s[28:31], s54 offen lds
MAV 80,48,140
TR 2,7,51200
MAV 80,32,132
TR 4,7,50720
TR 6,7,51232
MAV 84,36,132
TR 16,7,59136
s_add_u32 s52, s77, 655360
MAV 84,52,140
buffer_load_dwordx4 v[120:123], v4, s[16:19], s52 offen sc1
MAV 68,52,136
TR 18,7,59648
MAV 68,36,128
TR 20,7,59168
TR 22,7,59680
s_waitcnt lgkmcnt(8)
MAV 72,40,128
TR 8,7,50752
MAV 72,56,136
buffer_load_dwordx4 v19, s[28:31], s54 offen offset:1056 lds
MAV 88,56,140
TR 10,7,51264
s_add_u32 s54, s100, 1048576
MAV 88,40,132
TR 12,7,50784
TR 14,7,51296
MAV 92,44,132
TR 24,7,59200
MAV 92,60,140
buffer_load_dwordx4 v[124:127], v4, s[16:19], s52 offen offset:1024 sc1
MAV 76,60,136
TR 26,7,59712
MAV 76,44,128
TR 28,7,59232
TR 30,7,59744
s_waitcnt vmcnt(16) lgkmcnt(8)
s_barrier
MAV 32,0,144
TR 32,6,50688
s_add_u32 m0, s55, 33792
MAV 32,16,152
buffer_load_dwordx4 v18, s[28:31], s54 offen lds
MAV 48,16,156
TR 34,6,51200
MAV 48,0,148
TR 36,6,50720
TR 38,6,51232
MAV 52,4,148
TR 48,6,59136
s_add_u32 s52, s78, 704512
MAV 52,20,156
buffer_load_dwordx4 v[128:131], v4, s[16:19], s52 offen sc1
MAV 36,20,152
TR 50,6,59648
MAV 36,4,144
TR 52,6,59168
TR 54,6,59680
s_waitcnt lgkmcnt(8)
MAV 40,8,144
TR 40,6,50752
MAV 40,24,152
buffer_load_dwordx4 v19, s[28:31], s54 offen offset:1056 lds
MAV 56,24,156
TR 42,6,51264
s_add_u32 s54, s100, 1310720
MAV 56,8,148
TR 44,6,50784
TR 46,6,51296
MAV 60,12,148
TR 56,6,59200
MAV 60,28,156
buffer_load_dwordx4 v[132:135], v4, s[16:19], s52 offen offset:1024 sc1
MAV 44,28,152
TR 58,6,59712
MAV 44,12,144
TR 60,6,59232
TR 62,6,59744
v_add_u32 v7, s57, v7
v_add_u32 v6, s57, v6
s_sub_u32 s57, 0, s57
s_waitcnt lgkmcnt(8)
MAV 64,32,144
ds_read_b64_tr_b16 a[0:1], v7
s_add_u32 m0, s55, 42240
MAV 64,48,152
buffer_load_dwordx4 v18, s[28:31], s54 offen lds
MAV 80,48,156
TR 2,7,512
MAV 80,32,148
TR 4,7,32
TR 6,7,544
MAV 84,36,148
TR 16,7,8448
s_add_u32 s52, s78, 770048
MAV 84,52,156
buffer_load_dwordx4 v[136:139], v4, s[16:19], s52 offen sc1
MAV 68,52,152
TR 18,7,8960
MAV 68,36,144
TR 20,7,8480
TR 22,7,8992
s_waitcnt lgkmcnt(8)
MAV 72,40,144
TR 8,7,64
MAV 72,56,152
buffer_load_dwordx4 v19, s[28:31], s54 offen offset:1056 lds
MAV 88,56,156
TR 10,7,576
s_add_u32 s54, s101, 1507328
MAV 88,40,148
TR 12,7,96
TR 14,7,608
MAV 92,44,148
TR 24,7,8512
MAV 92,60,156
buffer_load_dwordx4 v[140:143], v4, s[16:19], s52 offen offset:1024 sc1
MAV 76,60,152
TR 26,7,9024
MAV 76,44,144
TR 28,7,8544
TR 30,7,9056
s_waitcnt vmcnt(16) lgkmcnt(8)
s_barrier
MAV 32,0,96
ds_read_b64_tr_b16 a[32:33], v6
s_add_u32 m0, s55, 50688
MAV 32,16,104
buffer_load_dwordx4 v18, s[28:31], s54 offen lds
MAV 48,16,108
TR 34,6,512
MAV 48,0,100
TR 36,6,32
TR 38,6,544
MAV 52,4,100
TR 48,6,8448
s_add_u32 s52, s79, 819200
MAV 52,20,108
buffer_load_dwordx4 v[144:147], v4, s[16:19], s52 offen sc1
MAV 36,20,104
TR 50,6,8960
MAV 36,4,96
TR 52,6,8480
TR 54,6,8992
s_waitcnt lgkmcnt(8)
MAV 40,8,96
TR 40,6,64
MAV 40,24,104
buffer_load_dwordx4 v19, s[28:31], s54 offen offset:1056 lds
MAV 56,24,108
TR 42,6,576
s_add_u32 s54, s101, 1769472
MAV 56,8,100
TR 44,6,96
TR 46,6,608
MAV 60,12,100
TR 56,6,8512
MAV 60,28,108
buffer_load_dwordx4 v[148:151], v4, s[16:19], s52 offen offset:1024 sc1
MAV 44,28,104
TR 58,6,9024
MAV 44,12,96
TR 60,6,8544
TR 62,6,9056
s_waitcnt lgkmcnt(8)
MAV 64,32,96
TR 0,7,16896
s_add_u32 m0, s55, 59136
MAV 64,48,104
buffer_load_dwordx4 v18, s[28:31], s54 offen lds
MAV 80,48,108
TR 2,7,17408
MAV 80,32,100
TR 4,7,16928
TR 6,7,17440
MAV 84,36,100
TR 16,7,25344
s_add_u32 s52, s79, 884736
MAV 84,52,108
buffer_load_dwordx4 v[152:155], v4, s[16:19], s52 offen sc1
MAV 68,52,104
TR 18,7,25856
MAV 68,36,96
TR 20,7,25376
TR 22,7,25888
s_waitcnt lgkmcnt(8)
MAV 72,40,96
TR 8,7,16960
MAV 72,56,104
buffer_load_dwordx4 v19, s[28:31], s54 offen offset:1056 lds
MAV 88,56,108
TR 10,7,17472
s_add_u32 s54, s98, 1966080
MAV 88,40,100
TR 12,7,16992
TR 14,7,17504
MAV 92,44,100
TR 24,7,25408
MAV 92,60,108
buffer_load_dwordx4 v[156:159], v4, s[16:19], s52 offen offset:1024 sc1
MAV 76,60,104
TR 26,7,25920
MAV 76,44,96
TR 28,7,25440
TR 30,7,25952
s_waitcnt vmcnt(16) lgkmcnt(8)
s_barrier
MAV 32,0,112
TR 32,6,16896
s_add_u32 m0, s55, 67584
MAV 32,16,120
buffer_load_dwordx4 v18, s[28:31], s54 offen lds
MAV 48,16,124
TR 34,6,17408
MAV 48,0,116
TR 36,6,16928
TR 38,6,17440
MAV 52,4,116
TR 48,6,25344
s_add_u32 s52, s76, 32768
MAV 52,20,124
buffer_load_dwordx4 v[96:99], v4, s[16:19], s52 offen sc1
MAV 36,20,120
TR 50,6,25856
MAV 36,4,112
TR 52,6,25376
TR 54,6,25888
s_waitcnt lgkmcnt(8)
MAV 40,8,112
TR 40,6,16960
MAV 40,24,120
buffer_load_dwordx4 v19, s[28:31], s54 offen offset:1056 lds
MAV 56,24,124
TR 42,6,17472
s_add_u32 s54, s98, 2228224
MAV 56,8,116
TR 44,6,16992
TR 46,6,17504
MAV 60,12,116
TR 56,6,25408
MAV 60,28,124
buffer_load_dwordx4 v[100:103], v4, s[16:19], s52 offen offset:1024 sc1
MAV 44,28,120
TR 58,6,25920
MAV 44,12,112
TR 60,6,25440
TR 62,6,25952
s_waitcnt lgkmcnt(8)
MAV 64,32,112
TR 0,7,33792
s_add_u32 m0, s55, 76032
MAV 64,48,120
buffer_load_dwordx4 v18, s[28:31], s54 offen lds
MAV 80,48,124
TR 2,7,34304
MAV 80,32,116
TR 4,7,33824
TR 6,7,34336
MAV 84,36,116
TR 16,7,42240
s_add_u32 s52, s76, 98304
MAV 84,52,124
buffer_load_dwordx4 v[104:107], v4, s[16:19], s52 offen sc1
MAV 68,52,120
TR 18,7,42752
MAV 68,36,112
TR 20,7,42272
TR 22,7,42784
s_waitcnt lgkmcnt(8)
MAV 72,40,112
TR 8,7,33856
MAV 72,56,120
buffer_load_dwordx4 v19, s[28:31], s54 offen offset:1056 lds
MAV 88,56,124
TR 10,7,34368
s_add_u32 s54, s99, 2424832
MAV 88,40,116
TR 12,7,33888
TR 14,7,34400
MAV 92,44,116
TR 24,7,42304
MAV 92,60,124
buffer_load_dwordx4 v[108:111], v4, s[16:19], s52 offen offset:1024 sc1
MAV 76,60,120
TR 26,7,42816
MAV 76,44,112
TR 28,7,42336
TR 30,7,42848
s_waitcnt vmcnt(16) lgkmcnt(8)
s_barrier
MAV 32,0,128
TR 32,6,33792
s_add_u32 m0, s55, 84480
MAV 32,16,136
buffer_load_dwordx4 v18, s[28:31], s54 offen lds
MAV 48,16,140
TR 34,6,34304
MAV 48,0,132
TR 36,6,33824
TR 38,6,34336
MAV 52,4,132
TR 48,6,42240
s_add_u32 s52, s77, 147456
MAV 52,20,140
buffer_load_dwordx4 v[112:115], v4, s[16:19], s52 offen sc1
MAV 36,20,136
TR 50,6,42752
MAV 36,4,128
TR 52,6,42272
TR 54,6,42784
s_waitcnt lgkmcnt(8)
MAV 40,8,128
TR 40,6,33856
MAV 40,24,136
buffer_load_dwordx4 v19, s[28:31], s54 offen offset:1056 lds
MAV 56,24,140
TR 42,6,34368
s_add_u32 s54, s99, 2686976
MAV 56,8,132
TR 44,6,33888
TR 46,6,34400
MAV 60,12,132
TR 56,6,42304
MAV 60,28,140
buffer_load_dwordx4 v[116:119], v4, s[16:19], s52 offen offset:1024 sc1
MAV 44,28,136
TR 58,6,42816
MAV 44,12,128
TR 60,6,42336
TR 62,6,42848
s_waitcnt lgkmcnt(8)
MAV 64,32,128
TR 0,7,50688
s_add_u32 m0, s55, 92928
MAV 64,48,136
buffer_load_dwordx4 v18, s[28:31], s54 offen lds
MAV 80,48,140
TR 2,7,51200
MAV 80,32,132
TR 4,7,50720
TR 6,7,51232
MAV 84,36,132
TR 16,7,59136
s_add_u32 s52, s77, 212992
MAV 84,52,140
buffer_load_dwordx4 v[120:123], v4, s[16:19], s52 offen sc1
MAV 68,52,136
TR 18,7,59648
MAV 68,36,128
TR 20,7,59168
TR 22,7,59680
s_waitcnt lgkmcnt(8)
MAV 72,40,128
TR 8,7,50752
MAV 72,56,136
buffer_load_dwordx4 v19, s[28:31], s54 offen offset:1056 lds
MAV 88,56,140
TR 10,7,51264
s_add_u32 s54, s100, 2883584
MAV 88,40,132
TR 12,7,50784
TR 14,7,51296
MAV 92,44,132
TR 24,7,59200
MAV 92,60,140
buffer_load_dwordx4 v[124:127], v4, s[16:19], s52 offen offset:1024 sc1
MAV 76,60,136
TR 26,7,59712
MAV 76,44,128
TR 28,7,59232
TR 30,7,59744
s_waitcnt vmcnt(16) lgkmcnt(8)
.Lpad9:
s_cbranch_execz .Lnopoll37r
s_barrier
MAV 32,0,144
TR 32,6,50688
s_add_u32 m0, s55, 101376
MAV 32,16,152
buffer_load_dwordx4 v18, s[28:31], s54 offen lds
MAV 48,16,156
TR 34,6,51200
MAV 48,0,148
TR 36,6,50720
TR 38,6,51232
MAV 52,4,148
TR 48,6,59136
s_add_u32 s52, s78, 262144
MAV 52,20,156
buffer_load_dwordx4 v[128:131], v4, s[16:19], s52 offen sc1
MAV 36,20,152
TR 50,6,59648
MAV 36,4,144
TR 52,6,59168
TR 54,6,59680
s_waitcnt lgkmcnt(8)
MAV 40,8,144
TR 40,6,50752
MAV 40,24,152
buffer_load_dwordx4 v19, s[28:31], s54 offen offset:1056 lds
MAV 56,24,156
TR 42,6,51264
s_add_u32 s54, s100, 3145728
MAV 56,8,148
TR 44,6,50784
TR 46,6,51296
MAV 60,12,148
TR 56,6,59200
MAV 60,28,156
buffer_load_dwordx4 v[132:135], v4, s[16:19], s52 offen offset:1024 sc1
MAV 44,28,152
TR 58,6,59712
MAV 44,12,144
TR 60,6,59232
TR 62,6,59744
v_add_u32 v7, s57, v7
v_add_u32 v6, s57, v6
s_sub_u32 s57, 0, s57
s_waitcnt lgkmcnt(8)
MAV 64,32,144
ds_read_b64_tr_b16 a[0:1], v7
s_add_u32 m0, s55, 109824
MAV 64,48,152
buffer_load_dwordx4 v18, s[28:31], s54 offen lds
MAV 80,48,156
TR 2,7,512
MAV 80,32,148
TR 4,7,32
TR 6,7,544
MAV 84,36,148
TR 16,7,8448
s_add_u32 s52, s78, 327680
MAV 84,52,156
buffer_load_dwordx4 v[136:139], v4, s[16:19], s52 offen sc1
MAV 68,52,152
TR 18,7,8960
MAV 68,36,144
TR 20,7,8480
TR 22,7,8992
s_waitcnt lgkmcnt(8)
MAV 72,40,144
TR 8,7,64
MAV 72,56,152
buffer_load_dwordx4 v19, s[28:31], s54 offen offset:1056 lds
MAV 88,56,156
TR 10,7,576
s_add_u32 s54, s101, 3342336
MAV 88,40,148
TR 12,7,96
TR 14,7,608
MAV 92,44,148
TR 24,7,8512
MAV 92,60,156
buffer_load_dwordx4 v[140:143], v4, s[16:19], s52 offen offset:1024 sc1
MAV 76,60,152
TR 26,7,9024
MAV 76,44,144
TR 28,7,8544
TR 30,7,9056
s_waitcnt vmcnt(16) lgkmcnt(8)
s_barrier
MAV 32,0,96
ds_read_b64_tr_b16 a[32:33], v6
s_add_u32 m0, s55, 118272
MAV 32,16,104
buffer_load_dwordx4 v18, s[28:31], s54 offen lds
MAV 48,16,108
TR 34,6,512
MAV 48,0,100
TR 36,6,32
TR 38,6,544
MAV 52,4,100
TR 48,6,8448
s_add_u32 s52, s79, 376832
MAV 52,20,108
buffer_load_dwordx4 v[144:147], v4, s[16:19], s52 offen sc1
MAV 36,20,104
TR 50,6,8960
MAV 36,4,96
TR 52,6,8480
TR 54,6,8992
s_waitcnt lgkmcnt(8)
MAV 40,8,96
TR 40,6,64
MAV 40,24,104
buffer_load_dwordx4 v19, s[28:31], s54 offen offset:1056 lds
MAV 56,24,108
TR 42,6,576
s_add_u32 s54, s101, 3604480
MAV 56,8,100
TR 44,6,96
TR 46,6,608
MAV 60,12,100
TR 56,6,8512
MAV 60,28,108
buffer_load_dwordx4 v[148:151], v4, s[16:19], s52 offen offset:1024 sc1
MAV 44,28,104
TR 58,6,9024
MAV 44,12,96
TR 60,6,8544
TR 62,6,9056
s_waitcnt lgkmcnt(8)
MAV 64,32,96
TR 0,7,16896
s_add_u32 m0, s55, 126720
MAV 64,48,104
buffer_load_dwordx4 v18, s[28:31], s54 offen lds
MAV 80,48,108
TR 2,7,17408
MAV 80,32,100
TR 4,7,16928
TR 6,7,17440
MAV 84,36,100
TR 16,7,25344
s_add_u32 s52, s79, 442368
MAV 84,52,108
buffer_load_dwordx4 v[152:155], v4, s[16:19], s52 offen sc1
MAV 68,52,104
TR 18,7,25856
MAV 68,36,96
TR 20,7,25376
TR 22,7,25888
s_waitcnt lgkmcnt(8)
MAV 72,40,96
TR 8,7,16960
MAV 72,56,104
buffer_load_dwordx4 v19, s[28:31], s54 offen offset:1056 lds
MAV 88,56,108
TR 10,7,17472
s_add_u32 s54, s98, 196608
MAV 88,40,100
TR 12,7,16992
TR 14,7,17504
MAV 92,44,100
TR 24,7,25408
MAV 92,60,108
buffer_load_dwordx4 v[156:159], v4, s[16:19], s52 offen offset:1024 sc1
MAV 76,60,104
TR 26,7,25920
MAV 76,44,96
TR 28,7,25440
TR 30,7,25952
s_waitcnt vmcnt(16) lgkmcnt(8)
s_barrier
MAV 32,0,112
TR 32,6,16896
s_add_u32 m0, s55, 0
MAV 32,16,120
buffer_load_dwordx4 v18, s[28:31], s54 offen lds
MAV 48,16,124
TR 34,6,17408
MAV 48,0,116
TR 36,6,16928
TR 38,6,17440
MAV 52,4,116
TR 48,6,25344
s_add_u32 s52, s76, 491520
MAV 52,20,124
buffer_load_dwordx4 v[96:99], v4, s[16:19], s52 offen sc1
MAV 36,20,120
TR 50,6,25856
MAV 36,4,112
TR 52,6,25376
TR 54,6,25888
s_waitcnt lgkmcnt(8)
MAV 40,8,112
TR 40,6,16960
MAV 40,24,120
buffer_load_dwordx4 v19, s[28:31], s54 offen offset:1056 lds
MAV 56,24,124
TR 42,6,17472
s_add_u32 s54, s99, 655360
MAV 56,8,116
TR 44,6,16992
TR 46,6,17504
MAV 60,12,116
TR 56,6,25408
MAV 60,28,124
buffer_load_dwordx4 v[100:103], v4, s[16:19], s52 offen offset:1024 sc1
MAV 44,28,120
TR 58,6,25920
MAV 44,12,112
TR 60,6,25440
TR 62,6,25952
s_waitcnt lgkmcnt(8)
MAV 64,32,112
TR 0,7,33792
s_add_u32 m0, s55, 8448
MAV 64,48,120
buffer_load_dwordx4 v18, s[28:31], s54 offen lds
MAV 80,48,124
TR 2,7,34304
MAV 80,32,116
TR 4,7,33824
TR 6,7,34336
MAV 84,36,116
TR 16,7,42240
s_add_u32 s52, s76, 557056
MAV 84,52,124
buffer_load_dwordx4 v[104:107], v4, s[16:19], s52 offen sc1
MAV 68,52,120
TR 18,7,42752
MAV 68,36,112
TR 20,7,42272
TR 22,7,42784
s_waitcnt lgkmcnt(8)
MAV 72,40,112
TR 8,7,33856
MAV 72,56,120
buffer_load_dwordx4 v19, s[28:31], s54 offen offset:1056 lds
MAV 88,56,124
TR 10,7,34368
s_add_u32 s54, s100, 1114112
MAV 88,40,116
TR 12,7,33888
TR 14,7,34400
MAV 92,44,116
TR 24,7,42304
MAV 92,60,124
buffer_load_dwordx4 v[108:111], v4, s[16:19], s52 offen offset:1024 sc1
MAV 76,60,120
TR 26,7,42816
MAV 76,44,112
TR 28,7,42336
TR 30,7,42848
s_waitcnt vmcnt(16) lgkmcnt(8)
s_barrier
MAV 32,0,128
TR 32,6,33792
s_add_u32 m0, s55, 16896
MAV 32,16,136
buffer_load_dwordx4 v18, s[28:31], s54 offen lds
MAV 48,16,140
TR 34,6,34304
MAV 48,0,132
TR 36,6,33824
TR 38,6,34336
MAV 52,4,132
TR 48,6,42240
s_add_u32 s52, s77, 606208
MAV 52,20,140
buffer_load_dwordx4 v[112:115], v4, s[16:19], s52 offen sc1
MAV 36,20,136
TR 50,6,42752
MAV 36,4,128
TR 52,6,42272
TR 54,6,42784
s_waitcnt lgkmcnt(8)
MAV 40,8,128
TR 40,6,33856
MAV 40,24,136
buffer_load_dwordx4 v19, s[28:31], s54 offen offset:1056 lds
MAV 56,24,140
TR 42,6,34368
s_add_u32 s54, s101, 1572864
MAV 56,8,132
TR 44,6,33888
TR 46,6,34400
MAV 60,12,132
TR 56,6,42304
MAV 60,28,140
buffer_load_dwordx4 v[116:119], v4, s[16:19], s52 offen offset:1024 sc1
MAV 44,28,136
TR 58,6,42816
MAV 44,12,128
TR 60,6,42336
TR 62,6,42848
s_waitcnt lgkmcnt(8)
MAV 64,32,128
TR 0,7,50688
s_add_u32 m0, s55, 25344
MAV 64,48,136
buffer_load_dwordx4 v18, s[28:31], s54 offen lds
MAV 80,48,140
TR 2,7,51200
MAV 80,32,132
TR 4,7,50720
TR 6,7,51232
MAV 84,36,132
TR 16,7,59136
s_add_u32 s52, s77, 671744
MAV 84,52,140
buffer_load_dwordx4 v[120:123], v4, s[16:19], s52 offen sc1
MAV 68,52,136
TR 18,7,59648
MAV 68,36,128
TR 20,7,59168
TR 22,7,59680
s_waitcnt lgkmcnt(8)
MAV 72,40,128
TR 8,7,50752
MAV 72,56,136
buffer_load_dwordx4 v19, s[28:31], s54 offen offset:1056 lds
MAV 88,56,140
TR 10,7,51264
s_add_u32 s54, s98, 2031616
MAV 88,40,132
TR 12,7,50784
TR 14,7,51296
MAV 92,44,132
TR 24,7,59200
MAV 92,60,140
buffer_load_dwordx4 v[124:127], v4, s[16:19], s52 offen offset:1024 sc1
MAV 76,60,136
TR 26,7,59712
MAV 76,44,128
TR 28,7,59232
TR 30,7,59744
s_waitcnt vmcnt(16) lgkmcnt(8)
s_barrier
MAV 32,0,144
TR 32,6,50688
s_add_u32 m0, s55, 33792
MAV 32,16,152
buffer_load_dwordx4 v18, s[28:31], s54 offen lds
MAV 48,16,156
TR 34,6,51200
MAV 48,0,148
TR 36,6,50720
TR 38,6,51232
MAV 52,4,148
TR 48,6,59136
s_add_u32 s52, s78, 720896
MAV 52,20,156
buffer_load_dwordx4 v[128:131], v4, s[16:19], s52 offen sc1
MAV 36,20,152
TR 50,6,59648
MAV 36,4,144
TR 52,6,59168
TR 54,6,59680
s_waitcnt lgkmcnt(8)
MAV 40,8,144
TR 40,6,50752
MAV 40,24,152
buffer_load_dwordx4 v19, s[28:31], s54 offen offset:1056 lds
MAV 56,24,156
TR 42,6,51264
s_add_u32 s54, s99, 2490368
MAV 56,8,148
TR 44,6,50784
TR 46,6,51296
MAV 60,12,148
TR 56,6,59200
MAV 60,28,156
buffer_load_dwordx4 v[132:135], v4, s[16:19], s52 offen offset:1024 sc1
MAV 44,28,152
TR 58,6,59712
MAV 44,12,144
TR 60,6,59232
TR 62,6,59744
v_add_u32 v7, s57, v7
v_add_u32 v6, s57, v6
s_sub_u32 s57, 0, s57
s_waitcnt lgkmcnt(8)
MAV 64,32,144
ds_read_b64_tr_b16 a[0:1], v6
s_add_u32 m0, s55, 42240
MAV 64,48,152
buffer_load_dwordx4 v18, s[28:31], s54 offen lds
MAV 80,48,156
TR 2,6,512
MAV 80,32,148
TR 4,6,32
TR 6,6,544
MAV 84,36,148
TR 16,6,8448
s_add_u32 s52, s78, 786432
MAV 84,52,156
buffer_load_dwordx4 v[136:139], v4, s[16:19], s52 offen sc1
MAV 68,52,152
TR 18,6,8960
MAV 68,36,144
TR 20,6,8480
TR 22,6,8992
s_waitcnt lgkmcnt(8)
MAV 72,40,144
TR 8,6,64
MAV 72,56,152
buffer_load_dwordx4 v19, s[28:31], s54 offen offset:1056 lds
MAV 88,56,156
TR 10,6,576
s_add_u32 s54, s100, 2949120
MAV 88,40,148
TR 12,6,96
TR 14,6,608
MAV 92,44,148
TR 24,6,8512
MAV 92,60,156
buffer_load_dwordx4 v[140:143], v4, s[16:19], s52 offen offset:1024 sc1
MAV 76,60,152
TR 26,6,9024
MAV 76,44,144
TR 28,6,8544
TR 30,6,9056
s_waitcnt vmcnt(16) lgkmcnt(8)
s_barrier
MAV 64,0,96
TR 32,6,16896
TR 34,6,17408
s_add_u32 m0, s55, 50688
MAV 64,16,104
TR 36,6,16928
buffer_load_dwordx4 v18, s[28:31], s54 offen lds
MAV 80,16,108
TR 38,6,17440
MAV 80,0,100
TR 48,6,25344
buffer_load_dwordx4 v19, s[28:31], s54 offen offset:1056 lds
MAV 84,4,100
TR 50,6,25856
s_add_u32 s54, s101, 3407872
s_add_u32 s52, s79, 835584
MAV 84,20,108
buffer_load_dwordx4 v[144:147], v4, s[16:19], s52 offen sc1
MAV 68,20,104
TR 52,6,25376
TR 54,6,25888
MAV 68,4,96
TR 40,6,16960
s_waitcnt lgkmcnt(9)
MAV 72,8,96
TR 42,6,17472
MAV 72,24,104
TR 44,6,16992
buffer_load_dwordx4 v[148:151], v4, s[16:19], s52 offen offset:1024 sc1
MAV 88,24,108
TR 46,6,17504
s_add_u32 m0, s55, 59136
MAV 88,8,100
TR 56,6,25408
buffer_load_dwordx4 v18, s[28:31], s54 offen lds
MAV 92,12,100
TR 58,6,25920
MAV 92,28,108
TR 60,6,25440
buffer_load_dwordx4 v19, s[28:31], s54 offen offset:1056 lds
MAV 76,28,104
TR 62,6,25952
s_add_u32 s52, s79, 901120
MAV 76,12,96
buffer_load_dwordx4 v[152:155], v4, s[16:19], s52 offen sc1
buffer_load_dwordx4 v[156:159], v4, s[16:19], s52 offen offset:1024 sc1
s_waitcnt vmcnt(16) lgkmcnt(8)
MAV 64,32,112
TR 0,6,33792
s_add_u32 s52, s76, 49152
s_lshl_b32 s70, s2, 10
MAV 64,48,120
buffer_load_dwordx4 v[160:163], v4, s[16:19], s52 offen sc1
s_lshl_b32 s62, s3, 7
MAV 80,48,124
TR 2,6,34304
s_add_u32 s70, s70, s62
s_add_u32 s70, s70, 31457280
MAV 80,32,116
TR 4,6,33824
TR 6,6,34336
MAV 84,36,116
TR 16,6,42240
s_xor_b32 s71, s70, 1024
v_min_u32 v12, 1, v1
MAV 84,52,124
buffer_load_dwordx4 v[164:167], v4, s[16:19], s52 offen offset:1024 sc1
v_lshlrev_b32 v12, 28, v12
MAV 68,52,120
TR 18,6,42752
v_mov_b32 v13, 1
MAV 68,36,112
TR 20,6,42272
TR 22,6,42784
s_waitcnt lgkmcnt(8)
MAV 72,40,112
TR 8,6,33856
s_add_u32 s52, s77, 163840
v_mov_b32 v15, 0
MAV 72,56,120
buffer_load_dwordx4 v[168:171], v4, s[16:19], s52 offen sc1
s_lshl_b32 s68, s7, 18
MAV 88,56,124
TR 10,6,34368
s_add_u32 s68, s68, 33554432
s_xor_b32 s69, s68, 262144
MAV 88,40,116
TR 12,6,33888
TR 14,6,34400
MAV 92,44,116
TR 24,6,42304
v_mov_b32 v11, v4
v_and_b32 v2, 1, v1
MAV 92,60,124
buffer_load_dwordx4 v[172:175], v4, s[16:19], s52 offen offset:1024 sc1
v_lshlrev_b32 v2, 4, v2
MAV 76,60,120
TR 26,6,42816
v_mov_b32 v224, 0x3f80
MAV 76,44,112
TR 28,6,42336
TR 30,6,42848
s_waitcnt vmcnt(12) lgkmcnt(8)
MAV 64,0,128
TR 32,6,50688
s_add_u32 s52, s78, 278528
v_lshlrev_b32 v2, v2, v224
MAV 64,16,136
buffer_load_dwordx4 v[176:179], v4, s[16:19], s52 offen sc1
v_bfe_u32 v224, v1, 2, 2
MAV 80,16,140
TR 34,6,51200
v_lshrrev_b32 v225, 4, v1
v_cmp_eq_u32 vcc, v224, v225
MAV 80,0,132
.Lpad10:
s_cbranch_execz .Lnopoll37r
TR 36,6,50720
TR 38,6,51232
MAV 84,4,132
TR 48,6,59136
v_cndmask_b32 v2, 0, v2, vcc
v_and_b32 v224, 2, v1
MAV 84,20,140
buffer_load_dwordx4 v[180:183], v4, s[16:19], s52 offen offset:1024 sc1
v_cmp_eq_u32 vcc, 0, v224
MAV 68,20,136
TR 50,6,59648
v_cndmask_b32 v226, 0, v2, vcc
MAV 68,4,128
TR 52,6,59168
TR 54,6,59680
s_waitcnt lgkmcnt(8)
MAV 72,8,128
TR 40,6,50752
s_add_u32 s52, s79, 393216
v_cndmask_b32 v227, v2, 0, vcc
MAV 72,24,136
buffer_load_dwordx4 v[184:187], v4, s[16:19], s52 offen sc1
v_mov_b32 v224, 0
MAV 88,24,140
TR 42,6,51264
v_mov_b32 v225, 0
v_mov_b32 v228, 0
MAV 88,8,132
TR 44,6,50784
TR 46,6,51296
MAV 92,12,132
TR 56,6,59200
v_mov_b32 v229, 0
v_bfe_u32 v18, v1, 3, 1
MAV 92,28,140
buffer_load_dwordx4 v[188:191], v4, s[16:19], s52 offen offset:1024 sc1
v_lshrrev_b32 v2, 4, v1
MAV 76,28,136
TR 58,6,59712
v_lshl_add_u32 v18, v2, 3, v18
MAV 76,12,128
TR 60,6,59232
TR 62,6,59744
s_waitcnt vmcnt(8) lgkmcnt(8)
s_barrier
v_add_u32 v6, s57, v6
MAV 64,32,144
ds_read_b64_tr_b16 a[0:1], v6
s_add_u32 s52, s76, 507904
s_lshl_b32 s62, s3, 1
MAV 64,48,152
buffer_load_dwordx4 v[192:195], v4, s[16:19], s52 offen sc1
v_add_u32 v18, s62, v18
MAV 80,48,156
TR 2,6,512
v_mul_u32_u24 v18, 6144, v18
v_and_b32 v2, 7, v1
MAV 80,32,148
TR 4,6,32
TR 6,6,544
MAV 84,36,148
TR 16,6,8448
v_lshl_add_u32 v18, v2, 4, v18
s_lshl_b32 s62, s9, 7
MAV 84,52,156
buffer_load_dwordx4 v[196:199], v4, s[16:19], s52 offen offset:1024 sc1
v_add_u32 v18, s62, v18
MAV 68,52,152
TR 18,6,8960
v_add_u32 v19, 1024, v18
MAV 68,36,144
TR 20,6,8480
TR 22,6,8992
s_waitcnt lgkmcnt(8)
MAV 72,40,144
TR 8,6,64
s_add_u32 s52, s77, 622592
v_add_u32 v20, 2048, v18
MAV 72,56,152
buffer_load_dwordx4 v[200:203], v4, s[16:19], s52 offen sc1
s_mul_i32 s59, s3, 3104
MAV 88,56,156
TR 10,6,576
s_mov_b32 s58, 0
v_accvgpr_read_b32 v28, a224
MAV 88,40,148
TR 12,6,96
TR 14,6,608
MAV 92,44,148
TR 24,6,8512
v_add_f32 v32, v32, v28
v_accvgpr_read_b32 v29, a225
MAV 92,60,156
buffer_load_dwordx4 v[204:207], v4, s[16:19], s52 offen offset:1024 sc1
v_add_f32 v33, v33, v29
MAV 76,60,152
TR 26,6,9024
v_accvgpr_read_b32 v28, a226
MAV 76,44,144
TR 28,6,8544
TR 30,6,9056
s_waitcnt vmcnt(8) lgkmcnt(8)
MAV 64,0,160
TR 32,6,16896
s_add_u32 s52, s78, 737280
v_add_f32 v34, v34, v28
MAV 64,16,168
buffer_load_dwordx4 v[208:211], v4, s[16:19], s52 offen sc1
v_accvgpr_read_b32 v29, a227
MAV 80,16,172
TR 34,6,17408
v_add_f32 v35, v35, v29
v_accvgpr_read_b32 v28, a228
MAV 80,0,164
TR 36,6,16928
TR 38,6,17440
MAV 84,4,164
TR 48,6,25344
v_add_f32 v36, v36, v28
v_accvgpr_read_b32 v29, a229
MAV 84,20,172
buffer_load_dwordx4 v[212:215], v4, s[16:19], s52 offen offset:1024 sc1
v_add_f32 v37, v37, v29
MAV 68,20,168
TR 50,6,25856
v_accvgpr_read_b32 v28, a230
MAV 68,4,160
TR 52,6,25376
TR 54,6,25888
s_waitcnt lgkmcnt(8)
MAV 72,8,160
TR 40,6,16960
s_add_u32 s52, s79, 851968
v_add_f32 v38, v38, v28
MAV 72,24,168
buffer_load_dwordx4 v[216:219], v4, s[16:19], s52 offen sc1
v_accvgpr_read_b32 v29, a231
MAV 88,24,172
TR 42,6,17472
v_add_f32 v39, v39, v29
v_accvgpr_read_b32 v28, a232
MAV 88,8,164
TR 44,6,16992
TR 46,6,17504
MAV 92,12,164
TR 56,6,25408
v_add_f32 v40, v40, v28
v_accvgpr_read_b32 v29, a233
MAV 92,28,172
buffer_load_dwordx4 v[220:223], v4, s[16:19], s52 offen offset:1024 sc1
v_add_f32 v41, v41, v29
MAV 76,28,168
TR 58,6,25920
v_accvgpr_read_b32 v28, a234
MAV 76,12,160
TR 60,6,25440
TR 62,6,25952
s_waitcnt vmcnt(8) lgkmcnt(8)
MAV 64,32,176
TR 0,6,33792
v_add_f32 v42, v42, v28
MAV 64,48,184
TR 2,6,34304
v_accvgpr_read_b32 v29, a235
v_add_f32 v43, v43, v29
MAV 80,48,188
TR 4,6,33824
MAV 80,32,180
TR 6,6,34336
v_accvgpr_read_b32 v28, a236
v_add_f32 v44, v44, v28
MAV 84,36,180
TR 16,6,42240
MAV 84,52,188
TR 18,6,42752
v_accvgpr_read_b32 v29, a237
v_add_f32 v45, v45, v29
MAV 68,52,184
TR 20,6,42272
MAV 68,36,176
TR 22,6,42784
v_accvgpr_read_b32 v28, a238
s_waitcnt lgkmcnt(8)
MAV 72,40,176
TR 8,6,33856
v_add_f32 v46, v46, v28
MAV 72,56,184
TR 10,6,34368
v_accvgpr_read_b32 v29, a239
MAV 88,56,188
TR 12,6,33888
v_add_f32 v47, v47, v29
MAV 88,40,180
TR 14,6,34400
v_accvgpr_read_b32 v28, a240
MAV 92,44,180
TR 24,6,42304
v_add_f32 v48, v48, v28
MAV 92,60,188
TR 26,6,42816
v_accvgpr_read_b32 v29, a241
MAV 76,60,184
TR 28,6,42336
v_add_f32 v49, v49, v29
MAV 76,44,176
TR 30,6,42848
v_accvgpr_read_b32 v28, a242
s_waitcnt vmcnt(4) lgkmcnt(8)
MAV 64,0,192
TR 32,6,50688
v_add_f32 v50, v50, v28
MAV 64,16,200
TR 34,6,51200
v_accvgpr_read_b32 v29, a243
v_add_f32 v51, v51, v29
MAV 80,16,204
TR 36,6,50720
MAV 80,0,196
TR 38,6,51232
v_accvgpr_read_b32 v28, a244
v_add_f32 v52, v52, v28
MAV 84,4,196
TR 48,6,59136
MAV 84,20,204
TR 50,6,59648
v_accvgpr_read_b32 v29, a245
v_add_f32 v53, v53, v29
MAV 68,20,200
TR 52,6,59168
MAV 68,4,192
TR 54,6,59680
v_accvgpr_read_b32 v28, a246
s_waitcnt lgkmcnt(8)
MAV 72,8,192
TR 40,6,50752
v_add_f32 v54, v54, v28
MAV 72,24,200
TR 42,6,51264
v_accvgpr_read_b32 v29, a247
MAV 88,24,204
TR 44,6,50784
v_add_f32 v55, v55, v29
MAV 88,8,196
TR 46,6,51296
v_accvgpr_read_b32 v28, a248
MAV 92,12,196
TR 56,6,59200
v_add_f32 v56, v56, v28
MAV 92,28,204
TR 58,6,59712
v_accvgpr_read_b32 v29, a249
MAV 76,28,200
TR 60,6,59232
v_add_f32 v57, v57, v29
MAV 76,12,192
TR 62,6,59744
v_accvgpr_read_b32 v28, a250
s_waitcnt vmcnt(0) lgkmcnt(8)
MAV 64,32,208
ds_read_b64_tr_b16 a[0:1], v7
v_add_f32 v58, v58, v28
MAV 64,48,216
TR 2,7,512
v_accvgpr_read_b32 v29, a251
MAV 80,48,220
TR 4,7,32
v_add_f32 v59, v59, v29
MAV 80,32,212
TR 6,7,544
MAV 84,36,212
TR 16,7,8448
v_accvgpr_read_b32 v28, a252
MAV 84,52,220
TR 18,7,8960
v_add_f32 v60, v60, v28
MAV 68,52,216
TR 20,7,8480
v_accvgpr_read_b32 v29, a253
MAV 68,36,208
TR 22,7,8992
s_waitcnt lgkmcnt(8)
MAV 72,40,208
TR 8,7,64
MAV 72,56,216
TR 10,7,576
v_add_f32 v61, v61, v29
MAV 88,56,220
TR 12,7,96
v_accvgpr_read_b32 v28, a254
MAV 88,40,212
TR 14,7,608
v_add_f32 v62, v62, v28
MAV 92,44,212
TR 24,7,8512
MAV 92,60,220
TR 26,7,9024
v_accvgpr_read_b32 v29, a255
MAV 76,60,216
TR 28,7,8544
v_add_f32 v63, v63, v29
MAV 76,44,208
TR 30,7,9056
s_waitcnt lgkmcnt(8)
MAV 32,0,96
TR 32,7,16896
v_cvt_pk_bf16_f32 v232, v64, v65
MAV 32,16,104
TR 34,7,17408
v_cvt_pk_bf16_f32 v233, v66, v67
v_cvt_pk_bf16_f32 v234, v68, v69
MAV 48,16,108
TR 36,7,16928
v_cvt_pk_bf16_f32 v235, v70, v71
MAV 48,0,100
TR 38,7,17440
buffer_store_dwordx4 v[232:235], v11, s[16:19], s69 offen sc1
s_add_u32 s69, s69, 131072
MAV 52,4,100
TR 48,7,25344
v_cvt_pk_bf16_f32 v236, v72, v73
MAV 52,20,108
TR 50,7,25856
v_cvt_pk_bf16_f32 v237, v74, v75
v_cvt_pk_bf16_f32 v238, v76, v77
MAV 36,20,104
TR 52,7,25376
v_cvt_pk_bf16_f32 v239, v78, v79
MAV 36,4,96
TR 54,7,25888
buffer_store_dwordx4 v[236:239], v11, s[16:19], s69 offen sc1
s_waitcnt lgkmcnt(8)
MAV 40,8,96
TR 40,7,16960
s_add_u32 s69, s69, -130048
MAV 40,24,104
TR 42,7,17472
v_cvt_pk_bf16_f32 v240, v80, v81
v_cvt_pk_bf16_f32 v241, v82, v83
MAV 56,24,108
TR 44,7,16992
v_cvt_pk_bf16_f32 v242, v84, v85
MAV 56,8,100
TR 46,7,17504
v_cvt_pk_bf16_f32 v243, v86, v87
buffer_store_dwordx4 v[240:243], v11, s[16:19], s69 offen sc1
MAV 60,12,100
TR 56,7,25408
s_add_u32 s69, s69, 131072
MAV 60,28,108
TR 58,7,25920
v_cvt_pk_bf16_f32 v244, v88, v89
v_cvt_pk_bf16_f32 v245, v90, v91
MAV 44,28,104
TR 60,7,25440
v_cvt_pk_bf16_f32 v246, v92, v93
MAV 44,12,96
TR 62,7,25952
v_cvt_pk_bf16_f32 v247, v94, v95
buffer_store_dwordx4 v[244:247], v11, s[16:19], s69 offen sc1
s_waitcnt lgkmcnt(8)
MAV 32,32,112
TR 0,7,33792
MAV 32,48,120
TR 2,7,34304
MAV 48,48,124
TR 4,7,33824
MAV 48,32,116
TR 6,7,34336
MAV 52,36,116
TR 16,7,42240
MAV 52,52,124
TR 18,7,42752
MAV 36,52,120
TR 20,7,42272
MAV 36,36,112
TR 22,7,42784
s_waitcnt lgkmcnt(8)
MAV 40,40,112
TR 8,7,33856
MAV 40,56,120
TR 10,7,34368
MAV 56,56,124
TR 12,7,33888
MAV 56,40,116
TR 14,7,34400
MAV 60,44,116
TR 24,7,42304
MAV 60,60,124
TR 26,7,42816
MAV 44,60,120
TR 28,7,42336
MAV 44,44,112
TR 30,7,42848
s_waitcnt lgkmcnt(8)
MAV 32,0,128
TR 32,7,50688
MAV 32,16,136
TR 34,7,51200
MAV 48,16,140
TR 36,7,50720
MAV 48,0,132
TR 38,7,51232
MAV 52,4,132
TR 48,7,59136
MAV 52,20,140
TR 50,7,59648
MAV 36,20,136
TR 52,7,59168
MAV 36,4,128
TR 54,7,59680
s_waitcnt lgkmcnt(8)
MAV 40,8,128
TR 40,7,50752
MAV 40,24,136
TR 42,7,51264
MAV 56,24,140
TR 44,7,50784
MAV 56,8,132
TR 46,7,51296
MAV 60,12,132
TR 56,7,59200
MAV 60,28,140
TR 58,7,59712
MAV 44,28,136
TR 60,7,59232
MAV 44,12,128
TR 62,7,59744
v_add_u32 v7, s57, v7
s_waitcnt lgkmcnt(8)
MAV 32,32,144
ds_read_b64_tr_b16 a[0:1], v7
MAV 32,48,152
s_waitcnt vmcnt(0)
buffer_atomic_add v13, v12, s[16:19], s71 offen
MAV 48,48,156
TR 2,7,512
MAV 48,32,148
TR 4,7,32
TR 6,7,544
MAV 52,36,148
MAV 52,52,156
TR 16,7,8448
TR 18,7,8960
MAV 36,52,152
TR 20,7,8480
MAV 36,36,144
s_waitcnt lgkmcnt(7)
MAV 40,40,144
TR 22,7,8992
MAV 40,56,152
TR 8,7,64
TR 10,7,576
MAV 56,56,156
MAV 56,40,148
TR 12,7,96
TR 14,7,608
MAV 60,44,148
TR 24,7,8512
MAV 60,60,156
TR 26,7,9024
MAV 44,60,152
TR 28,7,8544
MAV 44,44,144
TR 30,7,9056
s_waitcnt lgkmcnt(8)
s_barrier
MAV 32,0,160
TR 32,7,16896
TR 34,7,17408
MAV 32,16,168
buffer_atomic_add v15, v12, s[16:19], s70 offen sc0
MAV 48,16,172
TR 36,7,16928
TR 38,7,17440
MAV 48,0,164
TR 48,7,25344
MAV 52,4,164
TR 50,7,25856
s_add_u32 m0, s59, 117248
MAV 52,20,172
TR 52,7,25376
buffer_load_dwordx4 v18, s[20:23], s58 offen lds
MAV 36,20,168
TR 54,7,25888
MAV 36,4,160
TR 40,7,16960
s_waitcnt lgkmcnt(9)
MAV 40,8,160
TR 42,7,17472
MAV 40,24,168
TR 44,7,16992
buffer_load_dwordx4 v19, s[20:23], s58 offen offset:1024 lds
MAV 56,24,172
TR 46,7,17504
MAV 56,8,164
TR 56,7,25408
buffer_load_dwordx4 v20, s[20:23], s58 offen offset:2048 lds
MAV 60,12,164
s_add_u32 s58, s58, 196608
s_add_u32 m0, s59, 129664
MAV 60,28,172
TR 58,7,25920
buffer_load_dwordx4 v18, s[20:23], s58 offen lds
MAV 44,28,168
TR 60,7,25440
MAV 44,12,160
TR 62,7,25952
s_waitcnt lgkmcnt(8)
MAV 32,32,176
TR 0,7,33792
MAV 32,48,184
buffer_load_dwordx4 v19, s[20:23], s58 offen offset:1024 lds
MAV 48,48,188
TR 2,7,34304
MAV 48,32,180
TR 4,7,33824
TR 6,7,34336
MAV 52,36,180
TR 16,7,42240
MAV 52,52,188
buffer_load_dwordx4 v20, s[20:23], s58 offen offset:2048 lds
MAV 36,52,184
TR 18,7,42752
s_add_u32 s58, s58, 196608
MAV 36,36,176
TR 20,7,42272
TR 22,7,42784
s_waitcnt lgkmcnt(8)
MAV 40,40,176
TR 8,7,33856
s_add_u32 m0, s59, 67584
MAV 40,56,184
buffer_load_dwordx4 v18, s[20:23], s58 offen lds
MAV 56,56,188
TR 10,7,34368
MAV 56,40,180
TR 12,7,33888
TR 14,7,34400
MAV 60,44,180
TR 24,7,42304
MAV 60,60,188
buffer_load_dwordx4 v19, s[20:23], s58 offen offset:1024 lds
MAV 44,60,184
TR 26,7,42816
MAV 44,44,176
TR 28,7,42336
TR 30,7,42848
s_waitcnt vmcnt(8)
v_cmp_ne_u32 vcc, 0, v15
s_nop 0
s_cbranch_vccz .Lxs51
.Lxs51b:
.Lpad11:
s_cbranch_execz .Lnopoll37r
s_waitcnt lgkmcnt(8)
MAV 32,0,192
TR 32,7,50688
TR 34,7,51200
MAV 32,16,200
TR 36,7,50720
buffer_load_dwordx4 v[232:235], v11, s[16:19], s68 offen sc1
MAV 48,16,204
TR 38,7,51232
s_add_u32 s68, s68, 131072
MAV 48,0,196
TR 48,7,59136
buffer_load_dwordx4 v[236:239], v11, s[16:19], s68 offen sc1
MAV 52,4,196
TR 50,7,59648
s_add_u32 s68, s68, -130048
MAV 52,20,204
TR 52,7,59168
buffer_load_dwordx4 v[240:243], v11, s[16:19], s68 offen sc1
MAV 36,20,200
TR 54,7,59680
s_add_u32 s68, s68, 131072
MAV 36,4,192
TR 40,7,50752
s_waitcnt lgkmcnt(9)
MAV 40,8,192
TR 42,7,51264
TR 44,7,50784
MAV 40,24,200
buffer_load_dwordx4 v[244:247], v11, s[16:19], s68 offen sc1
MAV 56,24,204
TR 46,7,51296
TR 56,7,59200
MAV 56,8,196
TR 58,7,59712
buffer_load_dwordx4 v20, s[20:23], s58 offen offset:2048 lds
MAV 60,12,196
s_add_u32 s58, s58, 196608
s_add_u32 m0, s59, 80000
MAV 60,28,204
TR 60,7,59232
buffer_load_dwordx4 v18, s[20:23], s58 offen lds
MAV 44,28,200
TR 62,7,59744
MAV 44,12,192
buffer_load_dwordx4 v19, s[20:23], s58 offen offset:1024 lds
buffer_load_dwordx4 v20, s[20:23], s58 offen offset:2048 lds
s_add_u32 s58, s58, 196608
s_waitcnt lgkmcnt(8)
MAV 32,32,208
s_add_u32 m0, s59, 92416
MAV 32,48,216
buffer_load_dwordx4 v18, s[20:23], s58 offen lds
MAV 48,48,220
MAV 48,32,212
MAV 52,36,212
MAV 52,52,220
MAV 36,52,216
MAV 36,36,208
s_waitcnt lgkmcnt(0)
MAV 40,40,208
MAV 40,56,216
buffer_load_dwordx4 v19, s[20:23], s58 offen offset:1024 lds
MAV 56,56,220
MAV 56,40,212
buffer_load_dwordx4 v20, s[20:23], s58 offen offset:2048 lds
MAV 60,44,212
s_add_u32 s58, s58, 196608
MAV 60,60,220
MAV 44,60,216
MAV 44,44,208
s_waitcnt vmcnt(10)
v_mfma_f32_16x16x32_bf16 v[32:35], v[226:229], v[232:235], v[32:35]
s_lshl_b32 s64, s6, 14
s_lshl_b32 s65, s49, 13
s_add_u32 s64, s64, s65
v_mfma_f32_16x16x32_bf16 v[36:39], v[224:227], v[232:235], v[36:39]
s_lshl_b32 s65, s7, 9
s_add_u32 s64, s64, s65
s_lshl_b32 s65, s48, 8
s_waitcnt vmcnt(9)
v_mfma_f32_16x16x32_bf16 v[40:43], v[226:229], v[236:239], v[40:43]
s_add_u32 s64, s64, s65
s_add_u32 s64, s64, 62914560
v_and_b32 v152, 31, v1
v_mfma_f32_16x16x32_bf16 v[44:47], v[224:227], v[236:239], v[44:47]
s_lshl_b32 s62, s7, 18
v_lshlrev_b32 v152, 3, v152
v_lshrrev_b32 v153, 5, v1
s_waitcnt vmcnt(8)
v_mfma_f32_16x16x32_bf16 v[48:51], v[226:229], v[240:243], v[48:51]
s_add_u32 s62, s62, 33554432
v_lshl_add_u32 v152, v153, 28, v152
s_add_u32 s63, s62, 131072
v_mfma_f32_16x16x32_bf16 v[52:55], v[224:227], v[240:243], v[52:55]
v_cvt_pk_bf16_f32 v128, v32, v33
v_cvt_pk_bf16_f32 v129, v34, v35
s_waitcnt vmcnt(7)
v_mfma_f32_16x16x32_bf16 v[56:59], v[226:229], v[244:247], v[56:59]
v_cvt_pk_bf16_f32 v130, v36, v37
v_cvt_pk_bf16_f32 v131, v38, v39
v_mfma_f32_16x16x32_bf16 v[60:63], v[224:227], v[244:247], v[60:63]
buffer_store_dwordx4 v[128:131], v4, s[16:19], s62 offen sc1
v_cvt_pk_bf16_f32 v132, v40, v41
v_cvt_pk_bf16_f32 v133, v42, v43
v_cvt_pk_bf16_f32 v134, v44, v45
v_cvt_pk_bf16_f32 v135, v46, v47
v_cvt_pk_bf16_f32 v136, v48, v49
v_cvt_pk_bf16_f32 v137, v50, v51
v_cvt_pk_bf16_f32 v138, v52, v53
v_cvt_pk_bf16_f32 v139, v54, v55
v_cvt_pk_bf16_f32 v140, v56, v57
v_cvt_pk_bf16_f32 v141, v58, v59
v_cvt_pk_bf16_f32 v142, v60, v61
v_cvt_pk_bf16_f32 v143, v62, v63
v_pk_mul_f32 v[146:147], v[32:33], v[32:33]
buffer_store_dwordx4 v[132:135], v4, s[16:19], s63 offen sc1
v_pk_mul_f32 v[150:151], v[48:49], v[48:49]
v_pk_fma_f32 v[146:147], v[34:35], v[34:35], v[146:147]
v_pk_add_f32 v[144:145], v[32:33], v[34:35]
v_pk_fma_f32 v[150:151], v[50:51], v[50:51], v[150:151]
v_pk_add_f32 v[148:149], v[48:49], v[50:51]
v_pk_fma_f32 v[146:147], v[36:37], v[36:37], v[146:147]
v_pk_add_f32 v[144:145], v[144:145], v[36:37]
v_pk_fma_f32 v[150:151], v[52:53], v[52:53], v[150:151]
v_pk_add_f32 v[148:149], v[148:149], v[52:53]
v_pk_fma_f32 v[146:147], v[38:39], v[38:39], v[146:147]
v_pk_add_f32 v[144:145], v[144:145], v[38:39]
v_pk_fma_f32 v[150:151], v[54:55], v[54:55], v[150:151]
v_pk_add_f32 v[148:149], v[148:149], v[54:55]
buffer_store_dwordx4 v[136:139], v4, s[16:19], s62 offen offset:1024 sc1
v_pk_fma_f32 v[146:147], v[40:41], v[40:41], v[146:147]
v_pk_add_f32 v[144:145], v[144:145], v[40:41]
v_pk_fma_f32 v[150:151], v[56:57], v[56:57], v[150:151]
v_pk_add_f32 v[148:149], v[148:149], v[56:57]
v_pk_fma_f32 v[146:147], v[42:43], v[42:43], v[146:147]
v_pk_add_f32 v[144:145], v[144:145], v[42:43]
v_pk_fma_f32 v[150:151], v[58:59], v[58:59], v[150:151]
v_pk_add_f32 v[148:149], v[148:149], v[58:59]
v_pk_fma_f32 v[146:147], v[44:45], v[44:45], v[146:147]
v_pk_add_f32 v[144:145], v[144:145], v[44:45]
v_pk_fma_f32 v[150:151], v[60:61], v[60:61], v[150:151]
v_pk_add_f32 v[148:149], v[148:149], v[60:61]
v_pk_fma_f32 v[146:147], v[46:47], v[46:47], v[146:147]
buffer_store_dwordx4 v[140:143], v4, s[16:19], s63 offen offset:1024 sc1
v_pk_add_f32 v[144:145], v[144:145], v[46:47]
v_pk_fma_f32 v[150:151], v[62:63], v[62:63], v[150:151]
v_pk_add_f32 v[148:149], v[148:149], v[62:63]
v_add_f32 v144, v144, v145
v_add_f32 v146, v146, v147
v_add_f32 v148, v148, v149
v_add_f32 v150, v150, v151
s_nop 0
v_permlane16_swap_b32 v144, v148
v_permlane16_swap_b32 v146, v150
v_add_f32 v144, v144, v148
v_add_f32 v146, v146, v150
s_nop 1
v_permlane32_swap_b32 v144, v146
v_add_f32 v144, v144, v146
s_nop 1
v_permlane32_swap_b32 v144, v145
buffer_store_dwordx2 v[144:145], v152, s[16:19], s64 offen sc1
s_nop 1
v_accvgpr_write_b32 a224, v32
v_accvgpr_write_b32 a225, v33
v_accvgpr_write_b32 a226, v34
v_accvgpr_write_b32 a227, v35
v_accvgpr_write_b32 a228, v36
v_accvgpr_write_b32 a229, v37
v_accvgpr_write_b32 a230, v38
v_accvgpr_write_b32 a231, v39
v_accvgpr_write_b32 a232, v40
v_accvgpr_write_b32 a233, v41
v_accvgpr_write_b32 a234, v42
v_accvgpr_write_b32 a235, v43
v_accvgpr_write_b32 a236, v44
v_accvgpr_write_b32 a237, v45
v_accvgpr_write_b32 a238, v46
v_accvgpr_write_b32 a239, v47
v_accvgpr_write_b32 a240, v48
v_accvgpr_write_b32 a241, v49
v_accvgpr_write_b32 a242, v50
v_accvgpr_write_b32 a243, v51
v_accvgpr_write_b32 a244, v52
v_accvgpr_write_b32 a245, v53
v_accvgpr_write_b32 a246, v54
v_accvgpr_write_b32 a247, v55
v_accvgpr_write_b32 a248, v56
v_accvgpr_write_b32 a249, v57
v_accvgpr_write_b32 a250, v58
v_accvgpr_write_b32 a251, v59
v_accvgpr_write_b32 a252, v60
v_accvgpr_write_b32 a253, v61
v_accvgpr_write_b32 a254, v62
v_accvgpr_write_b32 a255, v63
s_lshl_b32 s62, s3, 11
s_add_u32 s62, s62, s85
v_lshl_add_u32 v21, v1, 4, s62
v_lshrrev_b32 v2, 3, v1
v_cmp_eq_u32 vcc, 3, v2
v_add_u32 v2, 67108480, v21
s_nop 0
v_cndmask_b32 v21, v21, v2, vcc
s_sub_u32 s62, s86, 2048
v_lshl_add_u32 v22, v0, 2, s62
v_lshrrev_b32 v2, 5, v0
v_cmp_eq_u32 vcc, 3, v2
v_add_u32 v2, 67108480, v22
s_nop 0
v_cndmask_b32 v22, v22, v2, vcc
s_mul_i32 s62, s48, 4608
v_lshl_add_u32 v23, v1, 4, s62
v_lshrrev_b32 v24, 4, v1
v_mul_u32_u24 v24, 2304, v24
v_and_b32 v2, 15, v1
v_lshl_add_u32 v24, v2, 4, v24
s_mov_b32 s52, 33554432
s_mov_b32 s54, s58
s_mov_b32 s56, s59
s_mul_i32 s55, s3, 2304
v_bfe_u32 v25, v1, 3, 2
v_mul_u32_u24 v25, 3104, v25
v_bfe_u32 v2, v1, 2, 1
v_lshl_add_u32 v25, v2, 7, v25
v_bfe_u32 v2, v1, 5, 1
v_lshl_add_u32 v25, v2, 8, v25
v_and_b32 v2, 3, v1
v_lshl_add_u32 v25, v2, 3, v25
s_lshl_b32 s62, s49, 6
s_add_u32 s62, s62, 67584
v_add_u32 v25, s62, v25
s_lshl_b32 s62, s8, 1
s_add_u32 s62, s62, s3
s_lshr_b32 s63, s50, 2
s_cmp_lt_u32 s3, 2
s_cselect_b32 s62, s62, s63
s_lshl_b32 s62, s62, 13
s_cmp_eq_u32 s3, 3
s_cselect_b32 s62, 268435456, s62
v_lshl_add_u32 v26, v1, 4, s62
s_lshr_b32 s63, s20, 7
s_sub_u32 s63, 3, s63
s_and_b32 s63, s63, 7
s_and_b32 s62, s9, 8
s_add_u32 s63, s63, s62
s_lshl_b32 s62, s5, 2
s_add_u32 s62, s62, s3
s_mul_i32 s62, s62, 12288
s_lshl_b32 s64, s63, 7
s_add_u32 s62, s62, s64
s_xor_b32 s63, s63, s9
s_cmp_lt_u32 s63, 4
s_cselect_b32 s62, s62, 16777216
v_lshrrev_b32 v14, 3, v1
v_min_u32 v14, 5, v14
v_lshl_add_u32 v14, v14, 11, s62
s_mov_b32 s44, 983040
buffer_load_dword v27, v14, s[20:23], s44 offen
s_mov_b32 s44, 2555904
s_mul_i32 s59, s3, 2080
s_and_b32 s87, s6, 3
s_lshl_b32 s87, s87, 17
v_bfe_u32 v5, v1, 3, 1
v_lshrrev_b32 v2, 4, v1
v_lshl_add_u32 v5, v2, 3, v5
s_lshl_b32 s62, s3, 1
v_add_u32 v5, s62, v5
v_mul_u32_u24 v5, 2048, v5
v_and_b32 v2, 7, v1
v_lshl_add_u32 v5, v2, 4, v5
s_lshl_b32 s62, s7, 7
v_add_u32 v5, s62, v5
v_add_u32 v6, 64512, v5
s_lshl_b32 s62, s6, 10
s_add_u32 s62, s62, 30474240
s_lshl_b32 s64, s8, 10
s_add_u32 s64, s64, 30474240
s_lshr_b32 s67, s9, 1
s_and_b32 s67, s67, 3
s_lshl_b32 s67, s67, 7
s_add_u32 s64, s64, s67
s_lshr_b32 s65, s50, 3
s_lshl_b32 s65, s65, 10
s_add_u32 s65, s65, 30474240
s_lshr_b32 s67, s9, 1
s_and_b32 s67, s67, 3
s_lshl_b32 s67, s67, 7
s_add_u32 s65, s65, s67
v_lshl_add_u32 v252, v1, 7, s62
v_mov_b32 v253, s64
v_mov_b32 v255, 1
v_writelane_b32 v253, s65, 1
s_waitcnt vmcnt(1) lgkmcnt(0)
s_cmp_lg_u32 s3, 1
s_barrier
s_cbranch_scc1 .Lfirst54
s_mov_b64 exec, 15
buffer_atomic_add v255, v252, s[16:19], 0 offen
s_mov_b64 exec, 3
v_mov_b32 v254, 0
buffer_atomic_add v254, v253, s[16:19], 0 offen sc0
s_mov_b64 exec, -1
.Lfirst54:
TR 80,25,49664
TR 82,25,50176
TR 84,25,62080
TR 86,25,62592
TR 88,25,50688
TR 90,25,51200
TR 92,25,63104
TR 94,25,63616
TR 96,25,51712
TR 98,25,52224
TR 100,25,64128
TR 102,25,64640
v_lshrrev_b32 v2, 4, v1
v_lshlrev_b32 v2, 2, v2
v_and_b32 v13, 15, v1
v_sub_u32 v2, v13, v2
v_mov_b32 v13, 0xff61b1e6
v_subrev_u32 v54, 0, v2
v_cmp_gt_u32 vcc, 8, v54
s_nop 1
v_cndmask_b32 v50, v13, 0, vcc
v_cmp_gt_i32 vcc, -8, v54
s_nop 1
v_cndmask_b32 v46, v13, 0, vcc
v_subrev_u32 v54, 1, v2
v_cmp_gt_u32 vcc, 8, v54
s_nop 1
v_cndmask_b32 v51, v13, 0, vcc
v_cmp_gt_i32 vcc, -8, v54
s_nop 1
v_cndmask_b32 v47, v13, 0, vcc
v_subrev_u32 v54, 2, v2
v_cmp_gt_u32 vcc, 8, v54
s_nop 1
v_cndmask_b32 v52, v13, 0, vcc
v_cmp_gt_i32 vcc, -8, v54
s_nop 1
v_cndmask_b32 v48, v13, 0, vcc
v_subrev_u32 v54, 3, v2
v_cmp_gt_u32 vcc, 8, v54
s_nop 1
v_cndmask_b32 v53, v13, 0, vcc
v_cmp_gt_i32 vcc, -8, v54
s_nop 1
v_cndmask_b32 v49, v13, 0, vcc
s_cmp_lt_u32 s8, 2
s_cselect_b64 vcc, -1, 0
v_cndmask_b32 v54, v46, v13, vcc
v_cndmask_b32 v55, v47, v13, vcc
v_cndmask_b32 v56, v48, v13, vcc
v_cndmask_b32 v57, v49, v13, vcc
v_mov_b64 v[60:61], 0
v_mov_b64 v[62:63], 0
v_mov_b64 v[64:65], 0
v_mov_b64 v[66:67], 0
v_mov_b64 v[68:69], 0
v_mov_b64 v[70:71], 0
v_mov_b64 v[72:73], 0
v_mov_b64 v[74:75], 0
v_mov_b64 v[76:77], 0
v_mov_b64 v[78:79], 0
v_mov_b64 v[80:81], 0
v_mov_b64 v[82:83], 0
v_mov_b64 v[84:85], 0
v_mov_b64 v[86:87], 0
v_mov_b64 v[88:89], 0
v_mov_b64 v[90:91], 0
v_mov_b64 v[92:93], 0
v_mov_b64 v[94:95], 0
v_mov_b64 v[96:97], 0
v_mov_b64 v[98:99], 0
v_mov_b64 v[100:101], 0
v_mov_b64 v[102:103], 0
v_mov_b64 v[104:105], 0
v_mov_b64 v[106:107], 0
v_mov_b64 v[108:109], 0
v_mov_b64 v[110:111], 0
v_mov_b64 v[112:113], 0
v_mov_b64 v[114:115], 0
v_mov_b64 v[116:117], 0
v_mov_b64 v[118:119], 0
v_mov_b64 v[120:121], 0
v_mov_b64 v[122:123], 0
v_mov_b64 v[124:125], 0
v_mov_b64 v[126:127], 0
v_mov_b64 v[128:129], 0
v_mov_b64 v[130:131], 0
v_mov_b64 v[132:133], 0
v_mov_b64 v[134:135], 0
v_mov_b64 v[136:137], 0
v_mov_b64 v[138:139], 0
v_mov_b64 v[140:141], 0
v_mov_b64 v[142:143], 0
v_mov_b64 v[144:145], 0
v_mov_b64 v[146:147], 0
v_mov_b64 v[148:149], 0
v_mov_b64 v[150:151], 0
v_mov_b64 v[152:153], 0
v_mov_b64 v[154:155], 0
v_mov_b64 v[156:157], 0
v_mov_b64 v[158:159], 0
v_mov_b64 v[160:161], 0
v_mov_b64 v[162:163], 0
v_mov_b64 v[164:165], 0
v_mov_b64 v[166:167], 0
v_mov_b64 v[168:169], 0
v_mov_b64 v[170:171], 0
v_mov_b64 v[172:173], 0
v_mov_b64 v[174:175], 0
s_mov_b32 s75, 62914560
v_and_b32 v10, 15, v1
v_lshlrev_b32 v12, 2, v10
v_lshlrev_b32 v10, 4, v10
v_add_u32 v10, 152576, v10
v_lshrrev_b32 v11, 4, v1
v_lshlrev_b32 v11, 4, v11
s_lshl_b32 s62, s49, 7
s_add_u32 s62, s62, 158720
v_add_u32 v12, s62, v12
v_add_u32 v13, s62, v11
v_add_u32 v11, 156672, v11
s_lshl_b32 s62, s3, 11
s_add_u32 s62, s62, 143360
v_lshl_add_u32 v8, v1, 4, s62
v_xor_b32 v9, 2048, v8
v_mov_b32 v248, 0x3f803f80
v_mov_b32 v249, 0x3f803f80
v_mov_b32 v250, 0x3f803f80
v_mov_b32 v251, 0x3f803f80
v_and_b32 v7, 31, v1
v_lshrrev_b32 v2, 5, v1
v_lshl_add_u32 v7, v7, 1, v2
v_and_b32 v2, 0xc0, v0
v_add_u32 v7, v7, v2
v_lshlrev_b32 v17, 2, v7
v_add_u32 v17, 156672, v17
v_lshlrev_b32 v7, 4, v7
v_add_u32 v7, 152576, v7
s_lshl_b32 s74, s9, 1
s_add_u32 s74, s74, s49
s_lshl_b32 s74, s74, 17
s_add_u32 s74, s74, s85
s_lshl_b32 s63, s48, 12
s_add_u32 s74, s74, s63
s_add_u32 s74, s74, 37748736
s_mov_b32 s62, 0
v_lshl_add_u32 v4, v1, 4, s62
v_lshrrev_b32 v2, 3, v1
v_cmp_eq_u32 vcc, 3, v2
v_add_u32 v2, 67108480, v4
s_nop 0
v_cndmask_b32 v4, v4, v2, vcc
ds_read_b128 v[28:31], v13
ds_read_b128 v[32:35], v13 offset:64
ds_read_b128 v[36:39], v13 offset:256
ds_read_b128 v[40:43], v13 offset:320
ds_read_b32 v44, v12 offset:512
ds_read_b32 v45, v12 offset:576
s_waitcnt lgkmcnt(0)
s_cmp_lg_u32 s3, 1
s_cbranch_scc1 .Lnopoll53
s_mov_b64 exec, 3
s_mov_b32 s15, 0
.Lpoll52:
v_mov_b32 v255, 0
buffer_atomic_add v255, v253, s[16:19], 0 offen sc0
s_waitcnt vmcnt(1)
v_cmp_gt_u32 vcc, 16, v254
s_add_u32 s15, s15, 1
s_cbranch_vccz .Lnopoll53r
v_mov_b32 v254, 0
buffer_atomic_add v254, v253, s[16:19], 0 offen sc0
s_waitcnt vmcnt(1)
v_cmp_gt_u32 vcc, 16, v255
s_add_u32 s15, s15, 1
s_cbranch_vccz .Lnopoll53r
s_cmp_le_u32 s15, 100000
s_cbranch_scc1 .Lpoll52
s_branch .Lnopoll53r
.Lnopoll53:
s_mov_b64 exec, 0
s_cmp_eq_u32 s3, 2
s_cbranch_scc1 .Lpad12
s_cmp_eq_u32 s3, 3
s_cbranch_scc1 .Lpad13
s_branch .Lpad14
.Lnopoll53r:
s_mov_b64 exec, -1
s_barrier
s_cmp_eq_u32 s48, 1
s_cbranch_scc1 .Lqkv55
s_add_u32 m0, s55, 36864
s_nop 0
buffer_load_dwordx4 v21, s[16:19], s52 offen sc1 lds
buffer_load_dwordx4 v21, s[16:19], s52 offen offset:1024 sc1 lds
buffer_load_dword v22, s[16:19], s52 offen offset:2048 sc1 lds
s_add_u32 s52, s52, 131072
s_add_u32 m0, s55, 46080
s_nop 0
buffer_load_dwordx4 v21, s[16:19], s52 offen sc1 lds
buffer_load_dwordx4 v21, s[16:19], s52 offen offset:1024 sc1 lds
buffer_load_dword v22, s[16:19], s52 offen offset:2048 sc1 lds
s_add_u32 s52, s52, 131072
s_add_u32 m0, s55, 0
s_nop 0
buffer_load_dwordx4 v21, s[16:19], s52 offen sc1 lds
buffer_load_dwordx4 v21, s[16:19], s52 offen offset:1024 sc1 lds
buffer_load_dword v22, s[16:19], s52 offen offset:2048 sc1 lds
s_add_u32 s52, s52, 131072
s_add_u32 m0, s55, 9216
s_nop 0
buffer_load_dwordx4 v21, s[16:19], s52 offen sc1 lds
buffer_load_dwordx4 v21, s[16:19], s52 offen offset:1024 sc1 lds
buffer_load_dword v22, s[16:19], s52 offen offset:2048 sc1 lds
s_add_u32 s52, s52, 131072
s_add_u32 m0, s55, 18432
s_nop 0
buffer_load_dwordx4 v21, s[16:19], s52 offen sc1 lds
buffer_load_dwordx4 v21, s[16:19], s52 offen offset:1024 sc1 lds
buffer_load_dword v22, s[16:19], s52 offen offset:2048 sc1 lds
s_add_u32 s52, s52, 131072
s_add_u32 m0, s55, 27648
s_nop 0
buffer_load_dwordx4 v21, s[16:19], s52 offen sc1 lds
buffer_load_dwordx4 v21, s[16:19], s52 offen offset:1024 sc1 lds
buffer_load_dword v22, s[16:19], s52 offen offset:2048 sc1 lds
s_add_u32 s52, s52, 131072
s_waitcnt vmcnt(12)
s_barrier
RD 0,23,36864
RD 4,23,37888
RD 8,23,39168
RD 12,23,40192
RD 16,24,38912
RD 20,23,46080
RD 24,23,47104
RD 28,23,48384
RD 32,23,49408
RD 36,24,48128
s_waitcnt lgkmcnt(0)
s_mov_b32 s15, -2
.p2align 6
.Lk57:
s_waitcnt vmcnt(9) lgkmcnt(8)
s_barrier
MAA 60,80,0
TR 104,25,49696
s_add_u32 m0, s56, 104832
MAA 60,84,20
buffer_load_dwordx4 v18, s[20:23], s54 offen lds
MAA 64,84,24
TR 106,25,50208
v_add_f32 v164, v164, v168
MAA 64,80,4
TR 108,25,62112
MAA 68,80,8
TR 110,25,62624
MAA 68,84,28
buffer_load_dwordx4 v19, s[20:23], s54 offen offset:1024 lds
MAA 72,84,32
TR 112,25,50720
v_add_f32 v165, v165, v169
MAA 72,80,12
TR 114,25,51232
s_waitcnt lgkmcnt(6)
MAA 156,88,16
TR 116,25,63136
MAA 156,92,36
buffer_load_dwordx4 v20, s[20:23], s54 offen offset:2048 lds
MAA 104,92,32
s_add_u32 s54, s54, 196608
s_add_u32 m0, s55, 36864
MAA 104,88,12
buffer_load_dwordx4 v21, s[16:19], s52 offen sc1 lds
MAA 100,88,8
TR 118,25,63648
MAA 100,92,28
TR 120,25,51744
v_add_f32 v166, v166, v170
MAA 96,92,24
TR 122,25,52256
MAA 96,88,4
buffer_load_dwordx4 v21, s[16:19], s52 offen offset:1024 sc1 lds
MAA 92,88,0
TR 124,25,64160
MAA 92,92,20
TR 126,25,64672
v_add_f32 v167, v167, v171
MAA 124,20,100
ds_read_b128 a[40:43], v23
MAA 124,0,96
buffer_load_dword v22, s[16:19], s52 offen offset:2048 sc1 lds
MAA 128,4,96
RD 44,23,1024
s_add_u32 s52, s52, 131072
MAA 128,24,100
buffer_load_dword v27, v14, s[20:23], s44 offen
MAA 132,28,100
RD 48,23,2304
s_add_u32 s44, s44, 1572864
MAA 132,8,96
RD 52,23,3328
MAA 136,12,96
RD 56,24,2048
MAA 136,32,100
s_waitcnt vmcnt(13) lgkmcnt(5)
s_barrier
MAA 76,104,0
RD 60,23,9216
s_add_u32 m0, s56, 117248
MAA 76,108,20
buffer_load_dwordx4 v18, s[20:23], s54 offen lds
MAA 80,108,24
RD 64,23,10240
MAA 80,104,4
RD 68,23,11520
MAA 84,104,8
RD 72,23,12544
MAA 84,108,28
buffer_load_dwordx4 v19, s[20:23], s54 offen offset:1024 lds
MAA 88,108,32
RD 76,24,11264
MAA 88,104,12
buffer_load_dwordx4 v20, s[20:23], s54 offen offset:2048 lds
MAA 160,112,16
ds_read_b64_tr_b16 a[80:81], v25
s_add_u32 s54, s54, 196608
MAA 160,116,36
TR 82,25,512
MAA 120,116,32
TR 84,25,12416
s_add_u32 m0, s55, 46080
MAA 120,112,12
buffer_load_dwordx4 v21, s[16:19], s52 offen sc1 lds
MAA 116,112,8
TR 86,25,12928
MAA 116,116,28
TR 88,25,1024
MAA 112,116,24
TR 90,25,1536
MAA 112,112,4
buffer_load_dwordx4 v21, s[16:19], s52 offen offset:1024 sc1 lds
MAA 108,112,0
TR 92,25,13440
.Lpad12:
s_cbranch_execz .Lpad15
MAA 108,116,20
TR 94,25,13952
MAA 140,20,124
TR 96,25,2048
MAA 140,0,120
buffer_load_dword v22, s[16:19], s52 offen offset:2048 sc1 lds
MAA 144,4,120
TR 98,25,2560
s_add_u32 s52, s52, 131072
MAA 144,24,124
buffer_load_dwordx4 v[168:171], v26, s[16:19], s75 offen sc1
MAA 148,28,124
TR 100,25,14464
MAA 148,8,120
TR 102,25,14976
MAA 152,12,120
MAA 152,32,124
s_waitcnt vmcnt(17) lgkmcnt(8)
s_barrier
MAA 60,80,40
TR 104,25,32
s_add_u32 m0, s56, 129664
MAA 60,84,60
buffer_load_dwordx4 v18, s[20:23], s54 offen lds
MAA 64,84,64
TR 106,25,544
v_add_f32 v164, v164, v172
MAA 64,80,44
TR 108,25,12448
MAA 68,80,48
TR 110,25,12960
MAA 68,84,68
buffer_load_dwordx4 v19, s[20:23], s54 offen offset:1024 lds
MAA 72,84,72
TR 112,25,1056
MAA 72,80,52
TR 114,25,1568
s_waitcnt lgkmcnt(6)
MAA 156,88,56
TR 116,25,13472
v_add_f32 v165, v165, v173
MAA 156,92,76
buffer_load_dwordx4 v20, s[20:23], s54 offen offset:2048 lds
MAA 104,92,72
TR 118,25,13984
s_add_u32 s54, s54, 196608
MAA 104,88,52
TR 120,25,2080
MAA 100,88,48
s_add_u32 m0, s55, 0
MAA 100,92,68
buffer_load_dwordx4 v21, s[16:19], s52 offen sc1 lds
MAA 96,92,64
TR 122,25,2592
v_add_f32 v166, v166, v174
MAA 96,88,44
TR 124,25,14496
MAA 92,88,40
TR 126,25,15008
MAA 92,92,60
buffer_load_dwordx4 v21, s[16:19], s52 offen offset:1024 sc1 lds
MAA 124,60,100
RD 0,23,18432
MAA 124,40,96
RD 4,23,19456
v_add_f32 v167, v167, v175
MAA 128,44,96
RD 8,23,20736
MAA 128,64,100
buffer_load_dword v22, s[16:19], s52 offen offset:2048 sc1 lds
MAA 132,68,100
RD 12,23,21760
s_add_u32 s52, s52, 131072
MAA 132,48,96
RD 16,24,20480
MAA 136,52,96
MAA 136,72,100
s_waitcnt vmcnt(17) lgkmcnt(5)
s_barrier
MAA 76,104,40
RD 20,23,27648
s_add_u32 m0, s56, 67584
MAA 76,108,60
buffer_load_dwordx4 v18, s[20:23], s54 offen lds
MAA 80,108,64
RD 24,23,28672
MAA 80,104,44
RD 28,23,29952
MAA 84,104,48
RD 32,23,30976
MAA 84,108,68
buffer_load_dwordx4 v19, s[20:23], s54 offen offset:1024 lds
MAA 88,108,72
RD 36,24,29696
MAA 88,104,52
buffer_load_dwordx4 v20, s[20:23], s54 offen offset:2048 lds
MAA 160,112,56
TR 80,25,24832
s_add_u32 s54, s54, 196608
MAA 160,116,76
TR 82,25,25344
MAA 120,116,72
TR 84,25,37248
s_add_u32 m0, s55, 9216
MAA 120,112,52
buffer_load_dwordx4 v21, s[16:19], s52 offen sc1 lds
MAA 116,112,48
TR 86,25,37760
MAA 116,116,68
TR 88,25,25856
MAA 112,116,64
TR 90,25,26368
MAA 112,112,44
buffer_load_dwordx4 v21, s[16:19], s52 offen offset:1024 sc1 lds
MAA 108,112,40
TR 92,25,38272
MAA 108,116,60
TR 94,25,38784
MAA 140,60,124
TR 96,25,26880
MAA 140,40,120
buffer_load_dword v22, s[16:19], s52 offen offset:2048 sc1 lds
MAA 144,44,120
TR 98,25,27392
s_add_u32 s52, s52, 131072
MAA 144,64,124
buffer_load_dwordx4 v[172:175], v26, s[16:19], s75 offen offset:1024 sc1
MAA 148,68,124
TR 100,25,39296
s_add_u32 s75, s75, 2048
MAA 148,48,120
TR 102,25,39808
MAA 152,52,120
MAA 152,72,124
s_waitcnt vmcnt(21) lgkmcnt(8)
s_barrier
MAA 60,80,0
TR 104,25,24864
s_add_u32 m0, s56, 80000
MAA 60,84,20
buffer_load_dwordx4 v18, s[20:23], s54 offen lds
MAA 64,84,24
TR 106,25,25376
MAA 64,80,4
TR 108,25,37280
MAA 68,80,8
TR 110,25,37792
MAA 68,84,28
buffer_load_dwordx4 v19, s[20:23], s54 offen offset:1024 lds
MAA 72,84,32
TR 112,25,25888
MAA 72,80,12
TR 114,25,26400
s_waitcnt lgkmcnt(6)
MAA 156,88,16
TR 116,25,38304
MAA 156,92,36
buffer_load_dwordx4 v20, s[20:23], s54 offen offset:2048 lds
MAA 104,92,32
TR 118,25,38816
s_add_u32 s54, s54, 196608
MAA 104,88,12
TR 120,25,26912
MAA 100,88,8
s_add_u32 m0, s55, 18432
MAA 100,92,28
buffer_load_dwordx4 v21, s[16:19], s52 offen sc1 lds
MAA 96,92,24
TR 122,25,27424
MAA 96,88,4
TR 124,25,39328
MAA 92,88,0
TR 126,25,39840
MAA 92,92,20
buffer_load_dwordx4 v21, s[16:19], s52 offen offset:1024 sc1 lds
MAA 124,20,100
RD 40,23,36864
MAA 124,0,96
RD 44,23,37888
MAA 128,4,96
RD 48,23,39168
MAA 128,24,100
buffer_load_dword v22, s[16:19], s52 offen offset:2048 sc1 lds
MAA 132,28,100
RD 52,23,40192
s_add_u32 s52, s52, 131072
MAA 132,8,96
RD 56,24,38912
MAA 136,12,96
MAA 136,32,100
s_waitcnt vmcnt(16) lgkmcnt(5)
s_barrier
MAA 76,104,0
RD 60,23,46080
s_add_u32 m0, s56, 92416
MAA 76,108,20
buffer_load_dwordx4 v18, s[20:23], s54 offen lds
MAA 80,108,24
RD 64,23,47104
MAA 80,104,4
RD 68,23,48384
MAA 84,104,8
RD 72,23,49408
MAA 84,108,28
buffer_load_dwordx4 v19, s[20:23], s54 offen offset:1024 lds
MAA 88,108,32
RD 76,24,48128
MAA 88,104,12
TR 80,25,49664
MAA 160,112,16
TR 82,25,50176
MAA 160,116,36
buffer_load_dwordx4 v20, s[20:23], s54 offen offset:2048 lds
MAA 120,116,32
TR 84,25,62080
s_add_u32 s54, s54, 196608
MAA 120,112,12
TR 86,25,62592
MAA 116,112,8
s_add_u32 m0, s55, 27648
MAA 116,116,28
buffer_load_dwordx4 v21, s[16:19], s52 offen sc1 lds
MAA 112,116,24
TR 88,25,50688
MAA 112,112,4
TR 90,25,51200
MAA 108,112,0
TR 92,25,63104
MAA 108,116,20
buffer_load_dwordx4 v21, s[16:19], s52 offen offset:1024 sc1 lds
MAA 140,20,124
TR 94,25,63616
MAA 140,0,120
TR 96,25,51712
MAA 144,4,120
TR 98,25,52224
MAA 144,24,124
buffer_load_dword v22, s[16:19], s52 offen offset:2048 sc1 lds
MAA 148,28,124
TR 100,25,64128
s_add_u32 s52, s52, 131072
MAA 148,8,120
TR 102,25,64640
MAA 152,12,120
MAA 152,32,124
s_waitcnt vmcnt(19) lgkmcnt(8)
s_barrier
MAA 60,80,40
TR 104,25,49696
s_add_u32 m0, s56, 104832
MAA 60,84,60
buffer_load_dwordx4 v18, s[20:23], s54 offen lds
MAA 64,84,64
TR 106,25,50208
v_add_f32 v164, v164, v168
MAA 64,80,44
TR 108,25,62112
MAA 68,80,48
TR 110,25,62624
MAA 68,84,68
buffer_load_dwordx4 v19, s[20:23], s54 offen offset:1024 lds
MAA 72,84,72
TR 112,25,50720
v_add_f32 v165, v165, v169
MAA 72,80,52
TR 114,25,51232
s_waitcnt lgkmcnt(6)
MAA 156,88,56
TR 116,25,63136
MAA 156,92,76
buffer_load_dwordx4 v20, s[20:23], s54 offen offset:2048 lds
MAA 104,92,72
s_add_u32 s54, s54, 196608
s_add_u32 m0, s55, 36864
MAA 104,88,52
buffer_load_dwordx4 v21, s[16:19], s52 offen sc1 lds
MAA 100,88,48
TR 118,25,63648
MAA 100,92,68
TR 120,25,51744
v_add_f32 v166, v166, v170
MAA 96,92,64
TR 122,25,52256
MAA 96,88,44
buffer_load_dwordx4 v21, s[16:19], s52 offen offset:1024 sc1 lds
MAA 92,88,40
TR 124,25,64160
MAA 92,92,60
TR 126,25,64672
v_add_f32 v167, v167, v171
MAA 124,60,100
ds_read_b128 a[0:3], v23
MAA 124,40,96
buffer_load_dword v22, s[16:19], s52 offen offset:2048 sc1 lds
MAA 128,44,96
RD 4,23,1024
s_add_u32 s52, s52, 131072
MAA 128,64,100
buffer_load_dword v27, v14, s[20:23], s44 offen
MAA 132,68,100
RD 8,23,2304
s_add_u32 s44, s44, 1572864
MAA 132,48,96
RD 12,23,3328
MAA 136,52,96
RD 16,24,2048
MAA 136,72,100
s_waitcnt vmcnt(16) lgkmcnt(5)
s_barrier
MAA 76,104,40
RD 20,23,9216
s_add_u32 m0, s56, 117248
MAA 76,108,60
buffer_load_dwordx4 v18, s[20:23], s54 offen lds
MAA 80,108,64
RD 24,23,10240
MAA 80,104,44
RD 28,23,11520
MAA 84,104,48
RD 32,23,12544
MAA 84,108,68
buffer_load_dwordx4 v19, s[20:23], s54 offen offset:1024 lds
MAA 88,108,72
RD 36,24,11264
MAA 88,104,52
buffer_load_dwordx4 v20, s[20:23], s54 offen offset:2048 lds
MAA 160,112,56
ds_read_b64_tr_b16 a[80:81], v25
s_add_u32 s54, s54, 196608
MAA 160,116,76
TR 82,25,512
MAA 120,116,72
TR 84,25,12416
s_add_u32 m0, s55, 46080
MAA 120,112,52
buffer_load_dwordx4 v21, s[16:19], s52 offen sc1 lds
MAA 116,112,48
TR 86,25,12928
MAA 116,116,68
TR 88,25,1024
MAA 112,116,64
TR 90,25,1536
MAA 112,112,44
buffer_load_dwordx4 v21, s[16:19], s52 offen offset:1024 sc1 lds
MAA 108,112,40
TR 92,25,13440
MAA 108,116,60
TR 94,25,13952
MAA 140,60,124
TR 96,25,2048
MAA 140,40,120
buffer_load_dword v22, s[16:19], s52 offen offset:2048 sc1 lds
MAA 144,44,120
TR 98,25,2560
s_add_u32 s52, s52, 131072
MAA 144,64,124
buffer_load_dwordx4 v[168:171], v26, s[16:19], s75 offen sc1
MAA 148,68,124
TR 100,25,14464
MAA 148,48,120
TR 102,25,14976
MAA 152,52,120
MAA 152,72,124
s_waitcnt vmcnt(20) lgkmcnt(8)
s_barrier
MAA 60,80,0
TR 104,25,32
s_add_u32 m0, s56, 129664
MAA 60,84,20
buffer_load_dwordx4 v18, s[20:23], s54 offen lds
MAA 64,84,24
TR 106,25,544
v_add_f32 v164, v164, v172
MAA 64,80,4
TR 108,25,12448
MAA 68,80,8
TR 110,25,12960
MAA 68,84,28
buffer_load_dwordx4 v19, s[20:23], s54 offen offset:1024 lds
MAA 72,84,32
TR 112,25,1056
MAA 72,80,12
TR 114,25,1568
s_waitcnt lgkmcnt(6)
MAA 156,88,16
TR 116,25,13472
v_add_f32 v165, v165, v173
MAA 156,92,36
buffer_load_dwordx4 v20, s[20:23], s54 offen offset:2048 lds
MAA 104,92,32
TR 118,25,13984
s_add_u32 s54, s54, 196608
MAA 104,88,12
TR 120,25,2080
MAA 100,88,8
s_add_u32 m0, s55, 0
MAA 100,92,28
buffer_load_dwordx4 v21, s[16:19], s52 offen sc1 lds
MAA 96,92,24
TR 122,25,2592
v_add_f32 v166, v166, v174
MAA 96,88,4
TR 124,25,14496
MAA 92,88,0
TR 126,25,15008
MAA 92,92,20
buffer_load_dwordx4 v21, s[16:19], s52 offen offset:1024 sc1 lds
MAA 124,20,100
RD 40,23,18432
MAA 124,0,96
RD 44,23,19456
v_add_f32 v167, v167, v175
MAA 128,4,96
RD 48,23,20736
MAA 128,24,100
buffer_load_dword v22, s[16:19], s52 offen offset:2048 sc1 lds
MAA 132,28,100
RD 52,23,21760
s_add_u32 s52, s52, 131072
MAA 132,8,96
RD 56,24,20480
MAA 136,12,96
MAA 136,32,100
s_waitcnt vmcnt(17) lgkmcnt(5)
s_barrier
MAA 76,104,0
RD 60,23,27648
s_add_u32 m0, s56, 67584
MAA 76,108,20
buffer_load_dwordx4 v18, s[20:23], s54 offen lds
MAA 80,108,24
RD 64,23,28672
MAA 80,104,4
RD 68,23,29952
MAA 84,104,8
RD 72,23,30976
MAA 84,108,28
buffer_load_dwordx4 v19, s[20:23], s54 offen offset:1024 lds
MAA 88,108,32
RD 76,24,29696
MAA 88,104,12
buffer_load_dwordx4 v20, s[20:23], s54 offen offset:2048 lds
MAA 160,112,16
TR 80,25,24832
s_add_u32 s54, s54, 196608
MAA 160,116,36
TR 82,25,25344
MAA 120,116,32
TR 84,25,37248
s_add_u32 m0, s55, 9216
MAA 120,112,12
buffer_load_dwordx4 v21, s[16:19], s52 offen sc1 lds
MAA 116,112,8
TR 86,25,37760
MAA 116,116,28
TR 88,25,25856
MAA 112,116,24
TR 90,25,26368
MAA 112,112,4
buffer_load_dwordx4 v21, s[16:19], s52 offen offset:1024 sc1 lds
MAA 108,112,0
TR 92,25,38272
MAA 108,116,20
TR 94,25,38784
MAA 140,20,124
TR 96,25,26880
MAA 140,0,120
buffer_load_dword v22, s[16:19], s52 offen offset:2048 sc1 lds
MAA 144,4,120
TR 98,25,27392
s_add_u32 s52, s52, 131072
MAA 144,24,124
buffer_load_dwordx4 v[172:175], v26, s[16:19], s75 offen offset:1024 sc1
MAA 148,28,124
TR 100,25,39296
s_add_u32 s75, s75, 2048
MAA 148,8,120
TR 102,25,39808
MAA 152,12,120
MAA 152,32,124
s_waitcnt vmcnt(21) lgkmcnt(8)
s_barrier
MAA 60,80,40
TR 104,25,24864
s_add_u32 m0, s56, 80000
MAA 60,84,60
buffer_load_dwordx4 v18, s[20:23], s54 offen lds
MAA 64,84,64
TR 106,25,25376
MAA 64,80,44
TR 108,25,37280
MAA 68,80,48
TR 110,25,37792
MAA 68,84,68
buffer_load_dwordx4 v19, s[20:23], s54 offen offset:1024 lds
MAA 72,84,72
TR 112,25,25888
MAA 72,80,52
TR 114,25,26400
s_waitcnt lgkmcnt(6)
MAA 156,88,56
TR 116,25,38304
MAA 156,92,76
buffer_load_dwordx4 v20, s[20:23], s54 offen offset:2048 lds
MAA 104,92,72
TR 118,25,38816
s_add_u32 s54, s54, 196608
MAA 104,88,52
TR 120,25,26912
MAA 100,88,48
s_add_u32 m0, s55, 18432
MAA 100,92,68
buffer_load_dwordx4 v21, s[16:19], s52 offen sc1 lds
MAA 96,92,64
TR 122,25,27424
MAA 96,88,44
TR 124,25,39328
MAA 92,88,40
TR 126,25,39840
MAA 92,92,60
buffer_load_dwordx4 v21, s[16:19], s52 offen offset:1024 sc1 lds
MAA 124,60,100
RD 0,23,36864
MAA 124,40,96
RD 4,23,37888
MAA 128,44,96
RD 8,23,39168
MAA 128,64,100
buffer_load_dword v22, s[16:19], s52 offen offset:2048 sc1 lds
MAA 132,68,100
.Lpad13:
s_cbranch_execz .Lpad16
RD 12,23,40192
s_add_u32 s52, s52, 131072
MAA 132,48,96
RD 16,24,38912
MAA 136,52,96
MAA 136,72,100
s_waitcnt vmcnt(16) lgkmcnt(5)
s_barrier
MAA 76,104,40
RD 20,23,46080
s_add_u32 m0, s56, 92416
MAA 76,108,60
buffer_load_dwordx4 v18, s[20:23], s54 offen lds
MAA 80,108,64
RD 24,23,47104
MAA 80,104,44
RD 28,23,48384
MAA 84,104,48
RD 32,23,49408
MAA 84,108,68
buffer_load_dwordx4 v19, s[20:23], s54 offen offset:1024 lds
MAA 88,108,72
RD 36,24,48128
MAA 88,104,52
TR 80,25,49664
MAA 160,112,56
TR 82,25,50176
MAA 160,116,76
buffer_load_dwordx4 v20, s[20:23], s54 offen offset:2048 lds
MAA 120,116,72
TR 84,25,62080
s_add_u32 s54, s54, 196608
MAA 120,112,52
TR 86,25,62592
MAA 116,112,48
s_add_u32 m0, s55, 27648
MAA 116,116,68
buffer_load_dwordx4 v21, s[16:19], s52 offen sc1 lds
MAA 112,116,64
TR 88,25,50688
MAA 112,112,44
TR 90,25,51200
MAA 108,112,40
TR 92,25,63104
MAA 108,116,60
buffer_load_dwordx4 v21, s[16:19], s52 offen offset:1024 sc1 lds
MAA 140,60,124
TR 94,25,63616
MAA 140,40,120
TR 96,25,51712
MAA 144,44,120
TR 98,25,52224
MAA 144,64,124
buffer_load_dword v22, s[16:19], s52 offen offset:2048 sc1 lds
MAA 148,68,124
TR 100,25,64128
s_add_u32 s52, s52, 131072
MAA 148,48,120
TR 102,25,64640
MAA 152,52,120
s_add_u32 s15, s15, 1
MAA 152,72,124
s_cbranch_scc0 .Lk57
s_waitcnt vmcnt(19) lgkmcnt(8)
s_barrier
MAA 60,80,0
TR 104,25,49696
s_add_u32 m0, s56, 104832
MAA 60,84,20
buffer_load_dwordx4 v18, s[20:23], s54 offen lds
MAA 64,84,24
TR 106,25,50208
v_add_f32 v164, v164, v168
MAA 64,80,4
TR 108,25,62112
v_add_f32 v165, v165, v169
MAA 68,80,8
TR 110,25,62624
v_add_f32 v166, v166, v170
MAA 68,84,28
buffer_load_dwordx4 v19, s[20:23], s54 offen offset:1024 lds
MAA 72,84,32
TR 112,25,50720
v_add_f32 v167, v167, v171
MAA 72,80,12
TR 114,25,51232
s_waitcnt lgkmcnt(6)
MAA 156,88,16
TR 116,25,63136
MAA 156,92,36
buffer_load_dwordx4 v20, s[20:23], s54 offen offset:2048 lds
MAA 104,92,32
TR 118,25,63648
s_add_u32 s54, s54, 196608
MAA 104,88,12
TR 120,25,51744
s_add_u32 m0, s55, 36864
MAA 100,88,8
TR 122,25,52256
MAA 100,92,28
buffer_load_dwordx4 v21, s[16:19], s52 offen sc1 lds
MAA 96,92,24
TR 124,25,64160
MAA 96,88,4
TR 126,25,64672
MAA 92,88,0
ds_read_b128 a[40:43], v23
MAA 92,92,20
buffer_load_dwordx4 v21, s[16:19], s52 offen offset:1024 sc1 lds
MAA 124,20,100
RD 44,23,1024
MAA 124,0,96
RD 48,23,2304
MAA 128,4,96
RD 52,23,3328
MAA 128,24,100
buffer_load_dword v22, s[16:19], s52 offen offset:2048 sc1 lds
MAA 132,28,100
RD 56,24,2048
s_add_u32 s52, s52, 131072
MAA 132,8,96
MAA 136,12,96
MAA 136,32,100
s_waitcnt vmcnt(15) lgkmcnt(5)
s_barrier
MAA 76,104,0
RD 60,23,9216
s_add_u32 m0, s56, 117248
MAA 76,108,20
buffer_load_dwordx4 v18, s[20:23], s54 offen lds
MAA 80,108,24
RD 64,23,10240
v_add_f32 v164, v164, v172
MAA 80,104,4
RD 68,23,11520
v_add_f32 v165, v165, v173
MAA 84,104,8
RD 72,23,12544
v_add_f32 v166, v166, v174
MAA 84,108,28
buffer_load_dwordx4 v19, s[20:23], s54 offen offset:1024 lds
MAA 88,108,32
RD 76,24,11264
v_add_f32 v167, v167, v175
MAA 88,104,12
ds_read_b64_tr_b16 a[80:81], v25
MAA 160,112,16
TR 82,25,512
MAA 160,116,36
buffer_load_dwordx4 v20, s[20:23], s54 offen offset:2048 lds
MAA 120,116,32
TR 84,25,12416
s_add_u32 s54, s54, 196608
MAA 120,112,12
TR 86,25,12928
s_add_u32 m0, s55, 46080
MAA 116,112,8
TR 88,25,1024
MAA 116,116,28
buffer_load_dwordx4 v21, s[16:19], s52 offen sc1 lds
MAA 112,116,24
TR 90,25,1536
MAA 112,112,4
TR 92,25,13440
MAA 108,112,0
TR 94,25,13952
MAA 108,116,20
buffer_load_dwordx4 v21, s[16:19], s52 offen offset:1024 sc1 lds
MAA 140,20,124
TR 96,25,2048
MAA 140,0,120
TR 98,25,2560
MAA 144,4,120
TR 100,25,14464
MAA 144,24,124
buffer_load_dword v22, s[16:19], s52 offen offset:2048 sc1 lds
MAA 148,28,124
TR 102,25,14976
s_add_u32 s52, s52, 131072
MAA 148,8,120
v_permlane32_swap_b32 v164, v166
MAA 152,12,120
v_permlane32_swap_b32 v165, v167
MAA 152,32,124
s_waitcnt vmcnt(18) lgkmcnt(8)
s_barrier
MAA 60,80,40
TR 104,25,32
s_add_u32 m0, s56, 129664
MAA 60,84,60
buffer_load_dwordx4 v18, s[20:23], s54 offen lds
MAA 64,84,64
TR 106,25,544
v_add_f32 v164, v164, v166
MAA 64,80,44
TR 108,25,12448
v_add_f32 v165, v165, v167
MAA 68,80,48
buffer_load_dwordx4 v19, s[20:23], s54 offen offset:1024 lds
MAA 68,84,68
TR 110,25,12960
v_mul_f32 v164, 0xba800000, v164
MAA 72,84,72
TR 112,25,1056
v_mul_f32 v165, 0x3a800000, v165
MAA 72,80,52
buffer_load_dwordx4 v20, s[20:23], s54 offen offset:2048 lds
s_waitcnt lgkmcnt(5)
MAA 156,88,56
TR 114,25,1568
s_add_u32 s54, s54, 196608
MAA 156,92,76
TR 116,25,13472
s_add_u32 m0, s59, 58240
MAA 104,92,72
TR 118,25,13984
s_xor_b32 s58, s87, 1966080
MAA 104,88,52
buffer_load_dwordx4 v5, s[24:27], s58 offen lds
MAA 100,88,48
TR 120,25,2080
v_fma_f32 v165, -v164, v164, v165
MAA 100,92,68
TR 122,25,2592
v_max_f32 v165, 0, v165
MAA 96,92,64
buffer_load_dwordx4 v6, s[24:27], s58 offen offset:1024 lds
MAA 96,88,44
TR 124,25,14496
s_add_u32 m0, s59, 0
MAA 92,88,40
TR 126,25,15008
s_xor_b32 s58, s87, 1048576
MAA 92,92,60
buffer_load_dwordx4 v5, s[24:27], s58 offen lds
MAA 124,60,100
RD 0,23,18432
v_add_f32 v165, 0x3727c5ac, v165
MAA 124,40,96
RD 4,23,19456
MAA 128,44,96
buffer_load_dwordx4 v6, s[24:27], s58 offen offset:1024 lds
MAA 128,64,100
RD 8,23,20736
MAA 132,68,100
RD 12,23,21760
MAA 132,48,96
RD 16,24,20480
MAA 136,52,96
v_rsq_f32 v166, v165
MAA 136,72,100
v_mov_b32 v165, v166
v_mul_f32 v166, 0x3e8293ee, v166
ds_write_b128 v7, v[164:167]
s_waitcnt vmcnt(16) lgkmcnt(6)
s_barrier
MAA 76,104,40
ds_write_b32 v17, v164
s_add_u32 m0, s59, 8320
MAA 76,108,60
ds_write_b32 v17, v165 offset:1024
s_xor_b32 s58, s87, 1179648
MAA 80,108,64
buffer_load_dwordx4 v5, s[24:27], s58 offen lds
MAA 80,104,44
RD 20,23,27648
MAA 84,104,48
RD 24,23,28672
MAA 84,108,68
RD 28,23,29952
MAA 88,108,72
buffer_load_dwordx4 v6, s[24:27], s58 offen offset:1024 lds
MAA 88,104,52
RD 32,23,30976
s_add_u32 m0, s59, 66560
MAA 160,112,56
RD 36,24,29696
s_xor_b32 s58, s87, 0
MAA 160,116,76
TR 80,25,24832
MAA 120,116,72
buffer_load_dwordx4 v5, s[24:27], s58 offen lds
MAA 120,112,52
TR 82,25,25344
MAA 116,112,48
TR 84,25,37248
MAA 116,116,68
TR 86,25,37760
MAA 112,116,64
buffer_load_dwordx4 v6, s[24:27], s58 offen offset:1024 lds
MAA 112,112,44
TR 88,25,25856
s_add_u32 m0, s59, 74880
MAA 108,112,40
TR 90,25,26368
s_xor_b32 s58, s87, 131072
MAA 108,116,60
TR 92,25,38272
MAA 140,60,124
buffer_load_dwordx4 v5, s[24:27], s58 offen lds
MAA 140,40,120
TR 94,25,38784
MAA 144,44,120
TR 96,25,26880
MAA 144,64,124
TR 98,25,27392
MAA 148,68,124
buffer_load_dwordx4 v6, s[24:27], s58 offen offset:1024 lds
MAA 148,48,120
TR 100,25,39296
MAA 152,52,120
TR 102,25,39808
MAA 152,72,124
s_waitcnt vmcnt(10) lgkmcnt(0)
s_barrier
MAA 156,88,16
TR 112,25,25888
s_add_u32 m0, s59, 83200
MAA 156,92,36
TR 114,25,26400
s_xor_b32 s58, s87, 262144
MAA 104,92,32
buffer_load_dwordx4 v5, s[24:27], s58 offen lds
MAA 104,88,12
TR 116,25,38304
MAA 100,88,8
TR 118,25,38816
MAA 100,92,28
TR 120,25,26912
MAA 96,92,24
buffer_load_dwordx4 v6, s[24:27], s58 offen offset:1024 lds
MAA 96,88,4
TR 122,25,27424
s_add_u32 m0, s59, 16640
MAA 92,88,0
TR 124,25,39328
s_xor_b32 s58, s87, 1310720
MAA 92,92,20
TR 126,25,39840
MAA 136,32,100
buffer_load_dwordx4 v5, s[24:27], s58 offen lds
MAA 136,12,96
TR 104,25,24864
MAA 72,80,12
TR 106,25,25376
MAA 72,84,32
TR 108,25,37280
MAA 68,84,28
buffer_load_dwordx4 v6, s[24:27], s58 offen offset:1024 lds
MAA 68,80,8
TR 110,25,37792
s_add_u32 m0, s59, 24960
MAA 64,80,4
RD 40,23,36864
s_xor_b32 s58, s87, 1441792
MAA 64,84,24
RD 44,23,37888
MAA 60,84,20
buffer_load_dwordx4 v5, s[24:27], s58 offen lds
MAA 60,80,0
RD 48,23,39168
s_waitcnt lgkmcnt(13)
MAA 160,112,16
RD 52,23,40192
s_waitcnt lgkmcnt(12)
MAA 160,116,36
RD 56,24,38912
MAA 120,116,32
buffer_load_dwordx4 v6, s[24:27], s58 offen offset:1024 lds
MAA 120,112,12
s_waitcnt lgkmcnt(5)
s_barrier
RD 60,23,46080
MAA 116,112,8
RD 64,23,47104
s_add_u32 m0, s59, 91520
MAA 116,116,28
RD 68,23,48384
s_xor_b32 s58, s87, 393216
MAA 112,116,24
RD 72,23,49408
MAA 112,112,4
RD 76,24,48128
MAA 108,112,0
TR 144,25,50688
MAA 108,116,20
TR 146,25,51200
MAA 152,32,124
TR 148,25,63104
MAA 152,12,120
TR 150,25,63616
MAA 88,104,12
TR 152,25,50720
MAA 88,108,32
TR 154,25,51232
MAA 84,108,28
TR 156,25,63136
MAA 84,104,8
TR 158,25,63648
MAA 80,104,4
TR 160,25,51712
MAA 80,108,24
TR 162,25,52224
MAA 76,108,20
TR 164,25,64128
MAA 76,104,0
TR 166,25,64640
s_waitcnt lgkmcnt(10)
MAA 156,144,56
TR 168,25,51744
s_waitcnt lgkmcnt(9)
MAA 156,148,76
TR 170,25,52256
MAA 104,148,72
TR 172,25,64160
MAA 104,144,52
TR 174,25,64672
MAA 100,144,48
TR 128,25,49664
MAA 100,148,68
TR 130,25,50176
MAA 96,148,64
TR 132,25,62080
MAA 96,144,44
TR 134,25,62592
MAA 92,144,40
TR 136,25,49696
MAA 92,148,60
TR 138,25,50208
s_waitcnt lgkmcnt(14)
MAA 160,156,76
TR 140,25,62112
MAA 160,152,56
TR 142,25,62624
MAA 120,152,52
ds_read_b128 v[232:235], v10 offset:768
MAA 120,156,72
ds_read_b128 v[236:239], v10 offset:2816
MAA 116,156,68
ds_read_b128 v[228:231], v10 offset:512
MAA 116,152,48
ds_read_b128 v[224:227], v10 offset:256
MAA 112,152,44
ds_read_b128 v[220:223], v10
MAA 112,156,64
buffer_load_dwordx4 v5, s[24:27], s58 offen lds
MAA 108,156,60
ds_read_b128 v[240:243], v11 offset:192
MAA 108,152,40
s_waitcnt lgkmcnt(6)
s_barrier
ds_read_b128 v[244:247], v11 offset:1216
MAA 136,52,160
ds_read_b128 v[18:21], v11 offset:128
MAA 136,72,164
buffer_load_dwordx4 v6, s[24:27], s58 offen offset:1024 lds
MAA 152,72,172
ds_read_b128 v[22:25], v11 offset:1152
s_add_u32 m0, s59, 99840
MAA 152,52,168
s_xor_b32 s58, s87, 524288
MAA 72,128,52
MAA 72,132,72
buffer_load_dwordx4 v5, s[24:27], s58 offen lds
MAA 68,132,68
MAA 68,128,48
MAA 64,128,44
MAA 64,132,64
buffer_load_dwordx4 v6, s[24:27], s58 offen offset:1024 lds
MAA 60,132,60
s_add_u32 m0, s59, 108160
s_xor_b32 s58, s87, 655360
MAA 60,128,40
MAA 88,136,52
MAA 88,140,72
buffer_load_dwordx4 v5, s[24:27], s58 offen lds
MAA 84,140,68
MAA 84,136,48
MAA 80,136,44
MAA 80,140,64
buffer_load_dwordx4 v6, s[24:27], s58 offen offset:1024 lds
MAA 76,140,60
s_add_u32 m0, s59, 33280
s_xor_b32 s58, s87, 1572864
MAA 76,136,40
s_waitcnt lgkmcnt(8)
v_pk_fma_f32 v[104:105], v[36:37], v[232:233], v[104:105] op_sel_hi:[1,0,1]
v_pk_mul_f32 v[104:105], v[104:105], v[232:233] op_sel:[0,1] op_sel_hi:[1,1]
v_cvt_pk_bf16_f32 v196, v104, v105
v_pk_fma_f32 v[106:107], v[38:39], v[232:233], v[106:107] op_sel_hi:[1,0,1]
v_pk_mul_f32 v[106:107], v[106:107], v[232:233] op_sel:[0,1] op_sel_hi:[1,1]
v_cvt_pk_bf16_f32 v197, v106, v107
v_pk_fma_f32 v[120:121], v[40:41], v[232:233], v[120:121] op_sel_hi:[1,0,1]
v_pk_mul_f32 v[120:121], v[120:121], v[232:233] op_sel:[0,1] op_sel_hi:[1,1]
v_cvt_pk_bf16_f32 v198, v120, v121
v_pk_fma_f32 v[122:123], v[42:43], v[232:233], v[122:123] op_sel_hi:[1,0,1]
v_pk_mul_f32 v[122:123], v[122:123], v[232:233] op_sel:[0,1] op_sel_hi:[1,1]
v_cvt_pk_bf16_f32 v199, v122, v123
s_waitcnt lgkmcnt(3)
v_pk_fma_f32 v[136:137], v[240:241], v[44:45], v[136:137] op_sel_hi:[1,0,1]
s_waitcnt lgkmcnt(2)
v_pk_mul_f32 v[136:137], v[136:137], v[244:245]
v_cvt_pk_bf16_f32 v208, v136, v137
v_pk_fma_f32 v[138:139], v[242:243], v[44:45], v[138:139] op_sel_hi:[1,0,1]
v_pk_mul_f32 v[138:139], v[138:139], v[246:247]
v_cvt_pk_bf16_f32 v209, v138, v139
v_pk_fma_f32 v[152:153], v[240:241], v[44:45], v[152:153] op_sel:[0,1,0] op_sel_hi:[1,1,1]
v_pk_mul_f32 v[152:153], v[152:153], v[244:245]
v_cvt_pk_bf16_f32 v218, v152, v153
v_pk_fma_f32 v[154:155], v[242:243], v[44:45], v[154:155] op_sel:[0,1,0] op_sel_hi:[1,1,1]
v_pk_mul_f32 v[154:155], v[154:155], v[246:247]
v_cvt_pk_bf16_f32 v219, v154, v155
ds_write_b128 v8, v[196:199]
ds_write_b64 v8, v[208:209] offset:1024
ds_write_b64 v8, v[218:219] offset:1032
v_pk_fma_f32 v[156:157], v[36:37], v[236:237], v[156:157] op_sel_hi:[1,0,1]
v_pk_mul_f32 v[156:157], v[156:157], v[236:237] op_sel:[0,1] op_sel_hi:[1,1]
v_cvt_pk_bf16_f32 v180, v156, v157
v_pk_fma_f32 v[158:159], v[38:39], v[236:237], v[158:159] op_sel_hi:[1,0,1]
v_pk_mul_f32 v[158:159], v[158:159], v[236:237] op_sel:[0,1] op_sel_hi:[1,1]
v_cvt_pk_bf16_f32 v181, v158, v159
v_pk_fma_f32 v[160:161], v[40:41], v[236:237], v[160:161] op_sel_hi:[1,0,1]
v_pk_mul_f32 v[160:161], v[160:161], v[236:237] op_sel:[0,1] op_sel_hi:[1,1]
v_cvt_pk_bf16_f32 v182, v160, v161
v_pk_fma_f32 v[162:163], v[42:43], v[236:237], v[162:163] op_sel_hi:[1,0,1]
v_pk_mul_f32 v[162:163], v[162:163], v[236:237] op_sel:[0,1] op_sel_hi:[1,1]
v_cvt_pk_bf16_f32 v183, v162, v163
v_pk_fma_f32 v[100:101], v[36:37], v[228:229], v[100:101] op_sel_hi:[1,0,1]
v_pk_mul_f32 v[100:101], v[100:101], v[228:229] op_sel:[0,1] op_sel_hi:[1,1]
v_cvt_pk_bf16_f32 v192, v100, v101
v_pk_fma_f32 v[102:103], v[38:39], v[228:229], v[102:103] op_sel_hi:[1,0,1]
v_pk_mul_f32 v[102:103], v[102:103], v[228:229] op_sel:[0,1] op_sel_hi:[1,1]
v_cvt_pk_bf16_f32 v193, v102, v103
v_pk_fma_f32 v[116:117], v[40:41], v[228:229], v[116:117] op_sel_hi:[1,0,1]
.Lpad14:
s_cbranch_execz .Lpad17
v_pk_mul_f32 v[116:117], v[116:117], v[228:229] op_sel:[0,1] op_sel_hi:[1,1]
v_cvt_pk_bf16_f32 v194, v116, v117
v_pk_fma_f32 v[118:119], v[42:43], v[228:229], v[118:119] op_sel_hi:[1,0,1]
v_pk_mul_f32 v[118:119], v[118:119], v[228:229] op_sel:[0,1] op_sel_hi:[1,1]
v_cvt_pk_bf16_f32 v195, v118, v119
v_pk_fma_f32 v[96:97], v[36:37], v[224:225], v[96:97] op_sel_hi:[1,0,1]
v_pk_mul_f32 v[96:97], v[96:97], v[224:225] op_sel:[0,1] op_sel_hi:[1,1]
v_cvt_pk_bf16_f32 v188, v96, v97
v_pk_fma_f32 v[98:99], v[38:39], v[224:225], v[98:99] op_sel_hi:[1,0,1]
v_pk_mul_f32 v[98:99], v[98:99], v[224:225] op_sel:[0,1] op_sel_hi:[1,1]
v_cvt_pk_bf16_f32 v189, v98, v99
s_waitcnt lgkmcnt(0)
s_barrier
ds_read_b64 v[200:201], v9 offset:1024
ds_read_b64 v[210:211], v9 offset:1032
v_pk_fma_f32 v[112:113], v[40:41], v[224:225], v[112:113] op_sel_hi:[1,0,1]
v_pk_mul_f32 v[112:113], v[112:113], v[224:225] op_sel:[0,1] op_sel_hi:[1,1]
v_cvt_pk_bf16_f32 v190, v112, v113
v_pk_fma_f32 v[114:115], v[42:43], v[224:225], v[114:115] op_sel_hi:[1,0,1]
v_pk_mul_f32 v[114:115], v[114:115], v[224:225] op_sel:[0,1] op_sel_hi:[1,1]
v_cvt_pk_bf16_f32 v191, v114, v115
v_pk_fma_f32 v[92:93], v[36:37], v[220:221], v[92:93] op_sel_hi:[1,0,1]
v_pk_mul_f32 v[92:93], v[92:93], v[220:221] op_sel:[0,1] op_sel_hi:[1,1]
v_cvt_pk_bf16_f32 v184, v92, v93
v_pk_fma_f32 v[94:95], v[38:39], v[220:221], v[94:95] op_sel_hi:[1,0,1]
v_pk_mul_f32 v[94:95], v[94:95], v[220:221] op_sel:[0,1] op_sel_hi:[1,1]
v_cvt_pk_bf16_f32 v185, v94, v95
v_pk_fma_f32 v[108:109], v[40:41], v[220:221], v[108:109] op_sel_hi:[1,0,1]
v_pk_mul_f32 v[108:109], v[108:109], v[220:221] op_sel:[0,1] op_sel_hi:[1,1]
v_cvt_pk_bf16_f32 v186, v108, v109
v_pk_fma_f32 v[110:111], v[42:43], v[220:221], v[110:111] op_sel_hi:[1,0,1]
v_pk_mul_f32 v[110:111], v[110:111], v[220:221] op_sel:[0,1] op_sel_hi:[1,1]
v_cvt_pk_bf16_f32 v187, v110, v111
v_pk_fma_f32 v[72:73], v[28:29], v[232:233], v[72:73] op_sel_hi:[1,0,1]
v_cvt_pk_bf16_f32 v176, v72, v73
v_pk_fma_f32 v[74:75], v[30:31], v[232:233], v[74:75] op_sel_hi:[1,0,1]
v_cvt_pk_bf16_f32 v177, v74, v75
v_pk_fma_f32 v[88:89], v[32:33], v[232:233], v[88:89] op_sel_hi:[1,0,1]
v_cvt_pk_bf16_f32 v178, v88, v89
v_pk_fma_f32 v[90:91], v[34:35], v[232:233], v[90:91] op_sel_hi:[1,0,1]
v_cvt_pk_bf16_f32 v179, v90, v91
v_pk_fma_f32 v[68:69], v[28:29], v[228:229], v[68:69] op_sel_hi:[1,0,1]
v_cvt_pk_bf16_f32 v172, v68, v69
v_pk_fma_f32 v[70:71], v[30:31], v[228:229], v[70:71] op_sel_hi:[1,0,1]
v_cvt_pk_bf16_f32 v173, v70, v71
v_pk_fma_f32 v[84:85], v[32:33], v[228:229], v[84:85] op_sel_hi:[1,0,1]
v_cvt_pk_bf16_f32 v174, v84, v85
v_pk_fma_f32 v[86:87], v[34:35], v[228:229], v[86:87] op_sel_hi:[1,0,1]
v_cvt_pk_bf16_f32 v175, v86, v87
v_pk_fma_f32 v[64:65], v[28:29], v[224:225], v[64:65] op_sel_hi:[1,0,1]
v_cvt_pk_bf16_f32 v168, v64, v65
v_pk_fma_f32 v[66:67], v[30:31], v[224:225], v[66:67] op_sel_hi:[1,0,1]
v_cvt_pk_bf16_f32 v169, v66, v67
v_pk_fma_f32 v[80:81], v[32:33], v[224:225], v[80:81] op_sel_hi:[1,0,1]
v_cvt_pk_bf16_f32 v170, v80, v81
v_pk_fma_f32 v[82:83], v[34:35], v[224:225], v[82:83] op_sel_hi:[1,0,1]
v_cvt_pk_bf16_f32 v171, v82, v83
v_pk_fma_f32 v[60:61], v[28:29], v[220:221], v[60:61] op_sel_hi:[1,0,1]
v_cvt_pk_bf16_f32 v164, v60, v61
v_pk_fma_f32 v[62:63], v[30:31], v[220:221], v[62:63] op_sel_hi:[1,0,1]
v_cvt_pk_bf16_f32 v165, v62, v63
v_pk_fma_f32 v[76:77], v[32:33], v[220:221], v[76:77] op_sel_hi:[1,0,1]
v_cvt_pk_bf16_f32 v166, v76, v77
v_pk_fma_f32 v[78:79], v[34:35], v[220:221], v[78:79] op_sel_hi:[1,0,1]
v_cvt_pk_bf16_f32 v167, v78, v79
s_nop 0
v_mfma_f32_16x16x32_bf16 v[120:123], v[196:199], v[176:179], v[50:53]
buffer_load_dwordx4 v5, s[24:27], s58 offen lds
v_mfma_f32_16x16x32_bf16 v[104:107], v[192:195], v[176:179], v[46:49]
ds_read_b128 v[240:243], v11 offset:64
v_mfma_f32_16x16x32_bf16 v[116:119], v[192:195], v[172:175], v[50:53]
ds_read_b128 v[244:247], v11 offset:1088
v_mfma_f32_16x16x32_bf16 v[100:103], v[188:191], v[172:175], v[46:49]
ds_read_b128 v[28:31], v11
v_mfma_f32_16x16x32_bf16 v[112:115], v[188:191], v[168:171], v[50:53]
buffer_load_dwordx4 v6, s[24:27], s58 offen offset:1024 lds
v_mfma_f32_16x16x32_bf16 v[96:99], v[184:187], v[168:171], v[46:49]
ds_read_b128 v[32:35], v11 offset:1024
s_add_u32 m0, s59, 41600
v_mfma_f32_16x16x32_bf16 v[108:111], v[184:187], v[164:167], v[50:53]
s_xor_b32 s58, s87, 1703936
v_max3_f32 v88, v104, v105, v106
v_max3_f32 v89, v107, v120, v121
v_mfma_f32_16x16x32_bf16 v[92:95], v[180:183], v[164:167], v[54:57]
v_max3_f32 v88, v88, v122, v123
v_max_f32 v90, v88, v89
MAA 132,8,96
buffer_load_dwordx4 v5, s[24:27], s58 offen lds
MAA 132,28,100
v_max_f32 v89, v88, v89
v_max3_f32 v84, v100, v101, v102
MAA 132,48,160
v_permlane16_swap_b32 v90, v89
MAA 132,68,164
v_max_f32 v88, v90, v89
v_max_f32 v89, v90, v89
MAA 148,68,172
buffer_load_dwordx4 v6, s[24:27], s58 offen offset:1024 lds
MAA 148,48,168
s_add_u32 m0, s59, 49920
s_xor_b32 s58, s87, 1835008
v_permlane32_swap_b32 v88, v89
MAA 148,28,124
v_max_f32 v88, v88, v89
v_mul_f32 v88, v88, v234
MAA 148,8,120
v_max3_f32 v85, v103, v116, v117
v_max3_f32 v84, v84, v118, v119
v_max_f32 v86, v84, v85
v_max_f32 v85, v84, v85
v_max3_f32 v80, v96, v97, v98
v_max3_f32 v81, v99, v112, v113
v_permlane16_swap_b32 v86, v85
v_max3_f32 v80, v80, v114, v115
v_max_f32 v84, v86, v85
v_max_f32 v85, v86, v85
v_max_f32 v82, v80, v81
v_max_f32 v81, v80, v81
v_permlane32_swap_b32 v84, v85
v_max3_f32 v76, v92, v93, v94
v_max_f32 v84, v84, v85
v_mul_f32 v84, v84, v230
v_permlane16_swap_b32 v82, v81
v_max3_f32 v77, v95, v108, v109
v_max_f32 v80, v82, v81
v_max_f32 v81, v82, v81
v_max3_f32 v76, v76, v110, v111
v_max_f32 v78, v76, v77
v_permlane32_swap_b32 v80, v81
v_max_f32 v77, v76, v77
v_max_f32 v80, v80, v81
v_mul_f32 v80, v80, v226
v_permlane16_swap_b32 v78, v77
v_pk_fma_f32 v[104:105], v[104:105], v[234:235], v[88:89] op_sel_hi:[1,0,0] neg_lo:[0,0,1] neg_hi:[0,0,1]
v_max_f32 v76, v78, v77
v_max_f32 v77, v78, v77
v_pk_fma_f32 v[106:107], v[106:107], v[234:235], v[88:89] op_sel_hi:[1,0,0] neg_lo:[0,0,1] neg_hi:[0,0,1]
v_pk_fma_f32 v[120:121], v[120:121], v[234:235], v[88:89] op_sel_hi:[1,0,0] neg_lo:[0,0,1] neg_hi:[0,0,1]
v_permlane32_swap_b32 v76, v77
v_pk_fma_f32 v[122:123], v[122:123], v[234:235], v[88:89] op_sel_hi:[1,0,0] neg_lo:[0,0,1] neg_hi:[0,0,1]
v_max_f32 v76, v76, v77
v_mul_f32 v76, v76, v222
v_pk_fma_f32 v[100:101], v[100:101], v[230:231], v[84:85] op_sel_hi:[1,0,0] neg_lo:[0,0,1] neg_hi:[0,0,1]
v_pk_fma_f32 v[102:103], v[102:103], v[230:231], v[84:85] op_sel_hi:[1,0,0] neg_lo:[0,0,1] neg_hi:[0,0,1]
v_pk_fma_f32 v[116:117], v[116:117], v[230:231], v[84:85] op_sel_hi:[1,0,0] neg_lo:[0,0,1] neg_hi:[0,0,1]
v_pk_fma_f32 v[118:119], v[118:119], v[230:231], v[84:85] op_sel_hi:[1,0,0] neg_lo:[0,0,1] neg_hi:[0,0,1]
v_pk_fma_f32 v[96:97], v[96:97], v[226:227], v[80:81] op_sel_hi:[1,0,0] neg_lo:[0,0,1] neg_hi:[0,0,1]
v_pk_fma_f32 v[98:99], v[98:99], v[226:227], v[80:81] op_sel_hi:[1,0,0] neg_lo:[0,0,1] neg_hi:[0,0,1]
v_pk_fma_f32 v[112:113], v[112:113], v[226:227], v[80:81] op_sel_hi:[1,0,0] neg_lo:[0,0,1] neg_hi:[0,0,1]
v_pk_fma_f32 v[114:115], v[114:115], v[226:227], v[80:81] op_sel_hi:[1,0,0] neg_lo:[0,0,1] neg_hi:[0,0,1]
v_pk_fma_f32 v[92:93], v[92:93], v[222:223], v[76:77] op_sel_hi:[1,0,0] neg_lo:[0,0,1] neg_hi:[0,0,1]
v_pk_fma_f32 v[94:95], v[94:95], v[222:223], v[76:77] op_sel_hi:[1,0,0] neg_lo:[0,0,1] neg_hi:[0,0,1]
v_pk_fma_f32 v[108:109], v[108:109], v[222:223], v[76:77] op_sel_hi:[1,0,0] neg_lo:[0,0,1] neg_hi:[0,0,1]
v_pk_fma_f32 v[110:111], v[110:111], v[222:223], v[76:77] op_sel_hi:[1,0,0] neg_lo:[0,0,1] neg_hi:[0,0,1]
v_pk_fma_f32 v[132:133], v[18:19], v[44:45], v[132:133] op_sel_hi:[1,0,1]
v_pk_mul_f32 v[132:133], v[132:133], v[22:23]
v_pk_fma_f32 v[134:135], v[20:21], v[44:45], v[134:135] op_sel_hi:[1,0,1]
v_pk_mul_f32 v[134:135], v[134:135], v[24:25]
v_pk_fma_f32 v[148:149], v[18:19], v[44:45], v[148:149] op_sel:[0,1,0] op_sel_hi:[1,1,1]
v_pk_mul_f32 v[148:149], v[148:149], v[22:23]
v_pk_fma_f32 v[150:151], v[20:21], v[44:45], v[150:151] op_sel:[0,1,0] op_sel_hi:[1,1,1]
v_pk_mul_f32 v[150:151], v[150:151], v[24:25]
v_exp_f32 v104, v104
s_nop 0
MAA 128,4,96
buffer_load_dwordx4 v5, s[24:27], s58 offen lds
MAA 128,24,100
v_exp_f32 v105, v105
MAA 128,44,160
v_exp_f32 v106, v106
MAA 128,64,164
v_exp_f32 v107, v107
MAA 144,64,172
buffer_load_dwordx4 v6, s[24:27], s58 offen offset:1024 lds
MAA 144,44,168
s_add_u32 m0, s59, 116480
s_xor_b32 s58, s87, 786432
v_exp_f32 v120, v120
MAA 144,24,124
v_exp_f32 v121, v121
MAA 144,4,120
v_exp_f32 v122, v122
MAA 124,0,96
buffer_load_dwordx4 v5, s[24:27], s58 offen lds
MAA 124,20,100
v_exp_f32 v123, v123
MAA 124,40,160
v_exp_f32 v100, v100
MAA 124,60,164
v_exp_f32 v101, v101
MAA 140,60,172
buffer_load_dwordx4 v6, s[24:27], s58 offen offset:1024 lds
MAA 140,40,168
s_add_u32 m0, s59, 124800
s_xor_b32 s58, s87, 917504
v_exp_f32 v102, v102
MAA 140,20,124
v_exp_f32 v103, v103
MAA 140,0,120
v_cvt_pk_bf16_f32 v72, v104, v105
v_cvt_pk_bf16_f32 v73, v106, v107
v_cvt_pk_bf16_f32 v74, v120, v121
v_cvt_pk_bf16_f32 v75, v122, v123
v_exp_f32 v116, v116
v_exp_f32 v117, v117
v_exp_f32 v118, v118
v_exp_f32 v119, v119
v_cvt_pk_bf16_f32 v68, v100, v101
v_cvt_pk_bf16_f32 v69, v102, v103
v_cvt_pk_bf16_f32 v70, v116, v117
v_cvt_pk_bf16_f32 v71, v118, v119
v_exp_f32 v96, v96
v_exp_f32 v97, v97
v_exp_f32 v98, v98
v_exp_f32 v99, v99
v_exp_f32 v112, v112
v_exp_f32 v113, v113
v_exp_f32 v114, v114
v_exp_f32 v115, v115
v_cvt_pk_bf16_f32 v64, v96, v97
v_cvt_pk_bf16_f32 v65, v98, v99
v_cvt_pk_bf16_f32 v66, v112, v113
v_cvt_pk_bf16_f32 v67, v114, v115
v_cvt_pk_bf16_f32 v206, v132, v133
v_cvt_pk_bf16_f32 v207, v134, v135
v_cvt_pk_bf16_f32 v216, v148, v149
v_cvt_pk_bf16_f32 v217, v150, v151
s_waitcnt lgkmcnt(3)
v_pk_fma_f32 v[128:129], v[240:241], v[44:45], v[128:129] op_sel_hi:[1,0,1]
s_waitcnt lgkmcnt(2)
v_pk_mul_f32 v[128:129], v[128:129], v[244:245]
v_cvt_pk_bf16_f32 v204, v128, v129
v_pk_fma_f32 v[130:131], v[242:243], v[44:45], v[130:131] op_sel_hi:[1,0,1]
v_pk_mul_f32 v[130:131], v[130:131], v[246:247]
v_cvt_pk_bf16_f32 v205, v130, v131
v_pk_fma_f32 v[144:145], v[240:241], v[44:45], v[144:145] op_sel:[0,1,0] op_sel_hi:[1,1,1]
v_pk_mul_f32 v[144:145], v[144:145], v[244:245]
v_cvt_pk_bf16_f32 v214, v144, v145
v_pk_fma_f32 v[146:147], v[242:243], v[44:45], v[146:147] op_sel:[0,1,0] op_sel_hi:[1,1,1]
v_pk_mul_f32 v[146:147], v[146:147], v[246:247]
v_cvt_pk_bf16_f32 v215, v146, v147
s_waitcnt lgkmcnt(1)
v_pk_fma_f32 v[124:125], v[28:29], v[44:45], v[124:125] op_sel_hi:[1,0,1]
s_waitcnt lgkmcnt(0)
v_pk_mul_f32 v[124:125], v[124:125], v[32:33]
v_cvt_pk_bf16_f32 v202, v124, v125
v_pk_fma_f32 v[126:127], v[30:31], v[44:45], v[126:127] op_sel_hi:[1,0,1]
v_pk_mul_f32 v[126:127], v[126:127], v[34:35]
v_cvt_pk_bf16_f32 v203, v126, v127
v_pk_fma_f32 v[140:141], v[28:29], v[44:45], v[140:141] op_sel:[0,1,0] op_sel_hi:[1,1,1]
v_pk_mul_f32 v[140:141], v[140:141], v[32:33]
v_cvt_pk_bf16_f32 v212, v140, v141
v_pk_fma_f32 v[142:143], v[30:31], v[44:45], v[142:143] op_sel:[0,1,0] op_sel_hi:[1,1,1]
v_pk_mul_f32 v[142:143], v[142:143], v[34:35]
v_cvt_pk_bf16_f32 v213, v142, v143
s_nop 0
v_mfma_f32_16x16x32_bf16 v[88:91], v[248:251], v[72:75], 0
buffer_load_dwordx4 v5, s[24:27], s58 offen lds
v_mfma_f32_16x16x32_bf16 v[104:107], v[206:209], v[72:75], 0
v_exp_f32 v92, v92
v_mfma_f32_16x16x32_bf16 v[120:123], v[216:219], v[72:75], 0
v_exp_f32 v93, v93
v_mfma_f32_16x16x32_bf16 v[84:87], v[248:251], v[68:71], 0
v_exp_f32 v94, v94
v_mfma_f32_16x16x32_bf16 v[100:103], v[204:207], v[68:71], 0
buffer_load_dwordx4 v6, s[24:27], s58 offen offset:1024 lds
v_mfma_f32_16x16x32_bf16 v[116:119], v[214:217], v[68:71], 0
v_exp_f32 v95, v95
v_mfma_f32_16x16x32_bf16 v[80:83], v[248:251], v[64:67], 0
v_exp_f32 v108, v108
v_mfma_f32_16x16x32_bf16 v[96:99], v[202:205], v[64:67], 0
v_exp_f32 v109, v109
v_mfma_f32_16x16x32_bf16 v[112:115], v[212:215], v[64:67], 0
v_exp_f32 v110, v110
v_cvt_pk_bf16_f32 v60, v92, v93
v_cvt_pk_bf16_f32 v61, v94, v95
v_cvt_pk_bf16_f32 v62, v108, v109
v_rcp_f32 v88, v88
v_rcp_f32 v84, v84
v_rcp_f32 v80, v80
v_pk_mul_f32 v[104:105], v[104:105], v[88:89] op_sel_hi:[1,0]
v_pk_mul_f32 v[106:107], v[106:107], v[88:89] op_sel_hi:[1,0]
v_pk_mul_f32 v[120:121], v[120:121], v[88:89] op_sel_hi:[1,0]
v_pk_mul_f32 v[122:123], v[122:123], v[88:89] op_sel_hi:[1,0]
v_cvt_pk_bf16_f32 v176, v104, v105
v_cvt_pk_bf16_f32 v177, v106, v107
v_cvt_pk_bf16_f32 v178, v120, v121
v_cvt_pk_bf16_f32 v179, v122, v123
buffer_store_dwordx4 v[176:179], v4, s[16:19], s74 offen offset:3072 sc1
v_pk_mul_f32 v[100:101], v[100:101], v[84:85] op_sel_hi:[1,0]
v_pk_mul_f32 v[102:103], v[102:103], v[84:85] op_sel_hi:[1,0]
v_pk_mul_f32 v[116:117], v[116:117], v[84:85] op_sel_hi:[1,0]
v_pk_mul_f32 v[118:119], v[118:119], v[84:85] op_sel_hi:[1,0]
v_cvt_pk_bf16_f32 v172, v100, v101
v_cvt_pk_bf16_f32 v173, v102, v103
v_cvt_pk_bf16_f32 v174, v116, v117
v_cvt_pk_bf16_f32 v175, v118, v119
buffer_store_dwordx4 v[172:175], v4, s[16:19], s74 offen offset:2048 sc1
v_pk_mul_f32 v[96:97], v[96:97], v[80:81] op_sel_hi:[1,0]
v_pk_mul_f32 v[98:99], v[98:99], v[80:81] op_sel_hi:[1,0]
v_pk_mul_f32 v[112:113], v[112:113], v[80:81] op_sel_hi:[1,0]
v_pk_mul_f32 v[114:115], v[114:115], v[80:81] op_sel_hi:[1,0]
v_cvt_pk_bf16_f32 v168, v96, v97
v_cvt_pk_bf16_f32 v169, v98, v99
v_cvt_pk_bf16_f32 v170, v112, v113
v_cvt_pk_bf16_f32 v171, v114, v115
buffer_store_dwordx4 v[168:171], v4, s[16:19], s74 offen offset:1024 sc1
v_exp_f32 v111, v111
s_nop 0
v_cvt_pk_bf16_f32 v63, v110, v111
s_nop 1
v_mfma_f32_16x16x32_bf16 v[76:79], v[248:251], v[60:63], 0
v_mfma_f32_16x16x32_bf16 v[92:95], v[200:203], v[60:63], 0
v_mfma_f32_16x16x32_bf16 v[108:111], v[210:213], v[60:63], 0
s_nop 5
v_rcp_f32 v76, v76
s_nop 0
v_pk_mul_f32 v[92:93], v[92:93], v[76:77] op_sel_hi:[1,0]
v_cvt_pk_bf16_f32 v164, v92, v93
v_pk_mul_f32 v[94:95], v[94:95], v[76:77] op_sel_hi:[1,0]
v_cvt_pk_bf16_f32 v165, v94, v95
v_pk_mul_f32 v[108:109], v[108:109], v[76:77] op_sel_hi:[1,0]
v_cvt_pk_bf16_f32 v166, v108, v109
v_pk_mul_f32 v[110:111], v[110:111], v[76:77] op_sel_hi:[1,0]
v_cvt_pk_bf16_f32 v167, v110, v111
buffer_store_dwordx4 v[164:167], v4, s[16:19], s74 offen sc1
s_nop 1
s_branch .Lqkve56
.Lpad15:
s_cbranch_execz .Lpad18
.Lsp50:
s_mov_b32 s15, 0
.Lsp50l:
v_mov_b32 v25, 0
buffer_atomic_add v25, v22, s[16:19], s73 offen sc0
s_add_u32 s15, s15, 1
s_cmp_gt_u32 s15, 100000
s_waitcnt vmcnt(0)
s_cbranch_scc1 .Lsp50b
v_cmp_gt_u32 vcc, v23, v25
s_nop 0
s_cbranch_vccnz .Lsp50l
s_branch .Lsp50b
.Lxs51:
s_mov_b32 s15, 0
.Lxs51l:
v_mov_b32 v15, 0
buffer_atomic_add v15, v12, s[16:19], s70 offen sc0
s_add_u32 s15, s15, 1
s_cmp_gt_u32 s15, 100000
s_waitcnt vmcnt(0)
s_cbranch_scc1 .Lxs51b
v_cmp_ne_u32 vcc, 0, v15
s_nop 0
s_cbranch_vccz .Lxs51l
s_branch .Lxs51b
.Lqkv55:
.Lpad16:
s_cbranch_execz .Lpad19
s_add_u32 m0, s55, 36864
s_nop 0
buffer_load_dwordx4 v21, s[16:19], s52 offen sc1 lds
buffer_load_dwordx4 v21, s[16:19], s52 offen offset:1024 sc1 lds
buffer_load_dword v22, s[16:19], s52 offen offset:2048 sc1 lds
s_add_u32 s52, s52, 131072
s_add_u32 m0, s55, 46080
s_nop 0
buffer_load_dwordx4 v21, s[16:19], s52 offen sc1 lds
buffer_load_dwordx4 v21, s[16:19], s52 offen offset:1024 sc1 lds
buffer_load_dword v22, s[16:19], s52 offen offset:2048 sc1 lds
s_add_u32 s52, s52, 131072
s_add_u32 m0, s55, 0
s_nop 0
buffer_load_dwordx4 v21, s[16:19], s52 offen sc1 lds
buffer_load_dwordx4 v21, s[16:19], s52 offen offset:1024 sc1 lds
buffer_load_dword v22, s[16:19], s52 offen offset:2048 sc1 lds
s_add_u32 s52, s52, 131072
s_add_u32 m0, s55, 9216
s_nop 0
buffer_load_dwordx4 v21, s[16:19], s52 offen sc1 lds
buffer_load_dwordx4 v21, s[16:19], s52 offen offset:1024 sc1 lds
buffer_load_dword v22, s[16:19], s52 offen offset:2048 sc1 lds
s_add_u32 s52, s52, 131072
s_add_u32 m0, s55, 18432
s_nop 0
buffer_load_dwordx4 v21, s[16:19], s52 offen sc1 lds
buffer_load_dwordx4 v21, s[16:19], s52 offen offset:1024 sc1 lds
buffer_load_dword v22, s[16:19], s52 offen offset:2048 sc1 lds
s_add_u32 s52, s52, 131072
s_add_u32 m0, s55, 27648
s_nop 0
buffer_load_dwordx4 v21, s[16:19], s52 offen sc1 lds
buffer_load_dwordx4 v21, s[16:19], s52 offen offset:1024 sc1 lds
buffer_load_dword v22, s[16:19], s52 offen offset:2048 sc1 lds
s_add_u32 s52, s52, 131072
s_waitcnt vmcnt(12)
s_barrier
RD 0,23,36864
RD 4,23,37888
RD 8,23,39168
RD 12,23,40192
RD 16,24,38912
RD 20,23,46080
RD 24,23,47104
RD 28,23,48384
RD 32,23,49408
RD 36,24,48128
s_waitcnt lgkmcnt(0)
s_mov_b32 s15, -2
.p2align 6
.Lk58:
s_waitcnt vmcnt(9) lgkmcnt(8)
s_barrier
MAA 60,80,0
TR 104,25,49696
s_add_u32 m0, s56, 104832
MAA 60,84,20
buffer_load_dwordx4 v18, s[20:23], s54 offen lds
MAA 64,84,24
TR 106,25,50208
v_add_f32 v164, v164, v168
MAA 64,80,4
TR 108,25,62112
MAA 68,80,8
TR 110,25,62624
MAA 68,84,28
buffer_load_dwordx4 v19, s[20:23], s54 offen offset:1024 lds
MAA 72,84,32
TR 112,25,50720
v_add_f32 v165, v165, v169
MAA 72,80,12
TR 114,25,51232
s_waitcnt lgkmcnt(6)
MAA 104,88,12
TR 116,25,63136
MAA 104,92,32
buffer_load_dwordx4 v20, s[20:23], s54 offen offset:2048 lds
MAA 100,92,28
s_add_u32 s54, s54, 196608
s_add_u32 m0, s55, 36864
MAA 100,88,8
buffer_load_dwordx4 v21, s[16:19], s52 offen sc1 lds
MAA 96,88,4
TR 118,25,63648
MAA 96,92,24
TR 120,25,51744
v_add_f32 v166, v166, v170
MAA 92,92,20
TR 122,25,52256
MAA 92,88,0
buffer_load_dwordx4 v21, s[16:19], s52 offen offset:1024 sc1 lds
MAA 124,0,96
TR 124,25,64160
MAA 124,20,100
TR 126,25,64672
v_add_f32 v167, v167, v171
MAA 128,24,100
ds_read_b128 a[40:43], v23
MAA 128,4,96
buffer_load_dword v22, s[16:19], s52 offen offset:2048 sc1 lds
MAA 132,8,96
RD 44,23,1024
s_add_u32 s52, s52, 131072
MAA 132,28,100
buffer_load_dword v27, v14, s[20:23], s44 offen
MAA 136,32,100
RD 48,23,2304
s_add_u32 s44, s44, 1572864
MAA 136,12,96
RD 52,23,3328
MAA 156,16,96
RD 56,24,2048
MAA 156,36,100
s_waitcnt vmcnt(13) lgkmcnt(5)
s_barrier
MAA 76,104,0
RD 60,23,9216
s_add_u32 m0, s56, 117248
MAA 76,108,20
buffer_load_dwordx4 v18, s[20:23], s54 offen lds
MAA 80,108,24
RD 64,23,10240
MAA 80,104,4
RD 68,23,11520
MAA 84,104,8
RD 72,23,12544
MAA 84,108,28
buffer_load_dwordx4 v19, s[20:23], s54 offen offset:1024 lds
MAA 88,108,32
RD 76,24,11264
MAA 88,104,12
buffer_load_dwordx4 v20, s[20:23], s54 offen offset:2048 lds
MAA 120,112,12
ds_read_b64_tr_b16 a[80:81], v25
s_add_u32 s54, s54, 196608
MAA 120,116,32
TR 82,25,512
MAA 116,116,28
TR 84,25,12416
s_add_u32 m0, s55, 46080
MAA 116,112,8
buffer_load_dwordx4 v21, s[16:19], s52 offen sc1 lds
MAA 112,112,4
TR 86,25,12928
MAA 112,116,24
TR 88,25,1024
MAA 108,116,20
TR 90,25,1536
MAA 108,112,0
buffer_load_dwordx4 v21, s[16:19], s52 offen offset:1024 sc1 lds
MAA 140,0,120
TR 92,25,13440
MAA 140,20,124
TR 94,25,13952
MAA 144,24,124
TR 96,25,2048
MAA 144,4,120
buffer_load_dword v22, s[16:19], s52 offen offset:2048 sc1 lds
MAA 148,8,120
TR 98,25,2560
s_add_u32 s52, s52, 131072
MAA 148,28,124
buffer_load_dwordx4 v[168:171], v26, s[16:19], s75 offen sc1
MAA 152,32,124
TR 100,25,14464
MAA 152,12,120
TR 102,25,14976
MAA 160,16,120
MAA 160,36,124
s_waitcnt vmcnt(17) lgkmcnt(8)
s_barrier
MAA 60,80,40
TR 104,25,32
v_add_f32 v164, v164, v172
MAA 60,84,60
TR 106,25,544
MAA 64,84,64
TR 108,25,12448
s_add_u32 m0, s56, 129664
MAA 64,80,44
buffer_load_dwordx4 v18, s[20:23], s54 offen lds
MAA 68,80,48
TR 110,25,12960
MAA 68,84,68
TR 112,25,1056
MAA 72,84,72
TR 114,25,1568
v_add_f32 v165, v165, v173
MAA 72,80,52
TR 116,25,13472
s_waitcnt lgkmcnt(7)
MAA 104,88,52
TR 118,25,13984
MAA 104,92,72
buffer_load_dwordx4 v19, s[20:23], s54 offen offset:1024 lds
MAA 100,92,68
TR 120,25,2080
MAA 100,88,48
buffer_load_dwordx4 v20, s[20:23], s54 offen offset:2048 lds
MAA 96,88,44
s_add_u32 s54, s54, 196608
MAA 96,92,64
TR 122,25,2592
v_add_f32 v166, v166, v174
MAA 92,92,60
TR 124,25,14496
s_add_u32 m0, s55, 0
MAA 92,88,40
buffer_load_dwordx4 v21, s[16:19], s52 offen sc1 lds
MAA 124,40,96
TR 126,25,15008
MAA 124,60,100
RD 0,23,18432
MAA 128,64,100
RD 4,23,19456
MAA 128,44,96
buffer_load_dwordx4 v21, s[16:19], s52 offen offset:1024 sc1 lds
MAA 132,48,96
RD 8,23,20736
.Lpad17:
s_cbranch_execz .Lpad20
v_add_f32 v167, v167, v175
MAA 132,68,100
RD 12,23,21760
MAA 136,72,100
RD 16,24,20480
MAA 136,52,96
buffer_load_dword v22, s[16:19], s52 offen offset:2048 sc1 lds
MAA 156,56,96
s_add_u32 s52, s52, 131072
MAA 156,76,100
s_waitcnt vmcnt(17) lgkmcnt(5)
s_barrier
MAA 76,104,40
RD 20,23,27648
s_add_u32 m0, s56, 67584
MAA 76,108,60
buffer_load_dwordx4 v18, s[20:23], s54 offen lds
MAA 80,108,64
RD 24,23,28672
MAA 80,104,44
RD 28,23,29952
MAA 84,104,48
RD 32,23,30976
MAA 84,108,68
buffer_load_dwordx4 v19, s[20:23], s54 offen offset:1024 lds
MAA 88,108,72
RD 36,24,29696
MAA 88,104,52
buffer_load_dwordx4 v20, s[20:23], s54 offen offset:2048 lds
MAA 120,112,52
TR 80,25,24832
s_add_u32 s54, s54, 196608
MAA 120,116,72
TR 82,25,25344
MAA 116,116,68
TR 84,25,37248
s_add_u32 m0, s55, 9216
MAA 116,112,48
buffer_load_dwordx4 v21, s[16:19], s52 offen sc1 lds
MAA 112,112,44
TR 86,25,37760
MAA 112,116,64
TR 88,25,25856
MAA 108,116,60
TR 90,25,26368
MAA 108,112,40
buffer_load_dwordx4 v21, s[16:19], s52 offen offset:1024 sc1 lds
MAA 140,40,120
TR 92,25,38272
MAA 140,60,124
TR 94,25,38784
MAA 144,64,124
TR 96,25,26880
MAA 144,44,120
buffer_load_dword v22, s[16:19], s52 offen offset:2048 sc1 lds
MAA 148,48,120
TR 98,25,27392
s_add_u32 s52, s52, 131072
MAA 148,68,124
buffer_load_dwordx4 v[172:175], v26, s[16:19], s75 offen offset:1024 sc1
MAA 152,72,124
TR 100,25,39296
s_add_u32 s75, s75, 2048
MAA 152,52,120
TR 102,25,39808
MAA 160,56,120
MAA 160,76,124
s_waitcnt vmcnt(21) lgkmcnt(8)
s_barrier
MAA 60,80,0
TR 104,25,24864
MAA 60,84,20
TR 106,25,25376
MAA 64,84,24
TR 108,25,37280
s_add_u32 m0, s56, 80000
MAA 64,80,4
buffer_load_dwordx4 v18, s[20:23], s54 offen lds
MAA 68,80,8
TR 110,25,37792
MAA 68,84,28
TR 112,25,25888
MAA 72,84,32
TR 114,25,26400
MAA 72,80,12
TR 116,25,38304
s_waitcnt lgkmcnt(7)
MAA 104,88,12
TR 118,25,38816
MAA 104,92,32
buffer_load_dwordx4 v19, s[20:23], s54 offen offset:1024 lds
MAA 100,92,28
TR 120,25,26912
MAA 100,88,8
buffer_load_dwordx4 v20, s[20:23], s54 offen offset:2048 lds
MAA 96,88,4
s_add_u32 s54, s54, 196608
MAA 96,92,24
TR 122,25,27424
MAA 92,92,20
TR 124,25,39328
s_add_u32 m0, s55, 18432
MAA 92,88,0
buffer_load_dwordx4 v21, s[16:19], s52 offen sc1 lds
MAA 124,0,96
TR 126,25,39840
MAA 124,20,100
RD 40,23,36864
MAA 128,24,100
RD 44,23,37888
MAA 128,4,96
buffer_load_dwordx4 v21, s[16:19], s52 offen offset:1024 sc1 lds
MAA 132,8,96
RD 48,23,39168
MAA 132,28,100
RD 52,23,40192
MAA 136,32,100
RD 56,24,38912
MAA 136,12,96
buffer_load_dword v22, s[16:19], s52 offen offset:2048 sc1 lds
MAA 156,16,96
s_add_u32 s52, s52, 131072
MAA 156,36,100
s_waitcnt vmcnt(16) lgkmcnt(5)
s_barrier
MAA 76,104,0
RD 60,23,46080
MAA 76,108,20
RD 64,23,47104
MAA 80,108,24
RD 68,23,48384
s_add_u32 m0, s56, 92416
MAA 80,104,4
buffer_load_dwordx4 v18, s[20:23], s54 offen lds
MAA 84,104,8
RD 72,23,49408
MAA 84,108,28
RD 76,24,48128
MAA 88,108,32
TR 80,25,49664
MAA 88,104,12
buffer_load_dwordx4 v19, s[20:23], s54 offen offset:1024 lds
MAA 120,112,12
TR 82,25,50176
MAA 120,116,32
TR 84,25,62080
MAA 116,116,28
TR 86,25,62592
MAA 116,112,8
buffer_load_dwordx4 v20, s[20:23], s54 offen offset:2048 lds
MAA 112,112,4
s_add_u32 s54, s54, 196608
MAA 112,116,24
TR 88,25,50688
MAA 108,116,20
TR 90,25,51200
s_add_u32 m0, s55, 27648
MAA 108,112,0
buffer_load_dwordx4 v21, s[16:19], s52 offen sc1 lds
MAA 140,0,120
TR 92,25,63104
MAA 140,20,124
TR 94,25,63616
MAA 144,24,124
TR 96,25,51712
MAA 144,4,120
buffer_load_dwordx4 v21, s[16:19], s52 offen offset:1024 sc1 lds
MAA 148,8,120
TR 98,25,52224
MAA 148,28,124
TR 100,25,64128
MAA 152,32,124
TR 102,25,64640
MAA 152,12,120
buffer_load_dword v22, s[16:19], s52 offen offset:2048 sc1 lds
MAA 160,16,120
s_add_u32 s52, s52, 131072
MAA 160,36,124
s_waitcnt vmcnt(19) lgkmcnt(8)
s_barrier
MAA 60,80,40
TR 104,25,49696
s_add_u32 m0, s56, 104832
MAA 60,84,60
buffer_load_dwordx4 v18, s[20:23], s54 offen lds
MAA 64,84,64
TR 106,25,50208
v_add_f32 v164, v164, v168
MAA 64,80,44
TR 108,25,62112
MAA 68,80,48
TR 110,25,62624
MAA 68,84,68
buffer_load_dwordx4 v19, s[20:23], s54 offen offset:1024 lds
MAA 72,84,72
TR 112,25,50720
v_add_f32 v165, v165, v169
MAA 72,80,52
TR 114,25,51232
s_waitcnt lgkmcnt(6)
MAA 104,88,52
TR 116,25,63136
MAA 104,92,72
buffer_load_dwordx4 v20, s[20:23], s54 offen offset:2048 lds
MAA 100,92,68
s_add_u32 s54, s54, 196608
s_add_u32 m0, s55, 36864
MAA 100,88,48
buffer_load_dwordx4 v21, s[16:19], s52 offen sc1 lds
MAA 96,88,44
TR 118,25,63648
MAA 96,92,64
TR 120,25,51744
v_add_f32 v166, v166, v170
MAA 92,92,60
TR 122,25,52256
MAA 92,88,40
buffer_load_dwordx4 v21, s[16:19], s52 offen offset:1024 sc1 lds
MAA 124,40,96
TR 124,25,64160
MAA 124,60,100
TR 126,25,64672
v_add_f32 v167, v167, v171
MAA 128,64,100
ds_read_b128 a[0:3], v23
MAA 128,44,96
buffer_load_dword v22, s[16:19], s52 offen offset:2048 sc1 lds
MAA 132,48,96
RD 4,23,1024
s_add_u32 s52, s52, 131072
MAA 132,68,100
buffer_load_dword v27, v14, s[20:23], s44 offen
MAA 136,72,100
RD 8,23,2304
s_add_u32 s44, s44, 1572864
MAA 136,52,96
RD 12,23,3328
MAA 156,56,96
RD 16,24,2048
MAA 156,76,100
s_waitcnt vmcnt(16) lgkmcnt(5)
s_barrier
MAA 76,104,40
RD 20,23,9216
s_add_u32 m0, s56, 117248
MAA 76,108,60
buffer_load_dwordx4 v18, s[20:23], s54 offen lds
MAA 80,108,64
RD 24,23,10240
MAA 80,104,44
RD 28,23,11520
MAA 84,104,48
RD 32,23,12544
MAA 84,108,68
buffer_load_dwordx4 v19, s[20:23], s54 offen offset:1024 lds
MAA 88,108,72
RD 36,24,11264
MAA 88,104,52
buffer_load_dwordx4 v20, s[20:23], s54 offen offset:2048 lds
MAA 120,112,52
ds_read_b64_tr_b16 a[80:81], v25
s_add_u32 s54, s54, 196608
MAA 120,116,72
TR 82,25,512
MAA 116,116,68
TR 84,25,12416
s_add_u32 m0, s55, 46080
MAA 116,112,48
buffer_load_dwordx4 v21, s[16:19], s52 offen sc1 lds
MAA 112,112,44
TR 86,25,12928
MAA 112,116,64
TR 88,25,1024
MAA 108,116,60
TR 90,25,1536
MAA 108,112,40
buffer_load_dwordx4 v21, s[16:19], s52 offen offset:1024 sc1 lds
MAA 140,40,120
TR 92,25,13440
MAA 140,60,124
TR 94,25,13952
MAA 144,64,124
TR 96,25,2048
MAA 144,44,120
buffer_load_dword v22, s[16:19], s52 offen offset:2048 sc1 lds
MAA 148,48,120
TR 98,25,2560
s_add_u32 s52, s52, 131072
MAA 148,68,124
buffer_load_dwordx4 v[168:171], v26, s[16:19], s75 offen sc1
MAA 152,72,124
TR 100,25,14464
MAA 152,52,120
TR 102,25,14976
MAA 160,56,120
MAA 160,76,124
s_waitcnt vmcnt(20) lgkmcnt(8)
s_barrier
MAA 60,80,0
TR 104,25,32
v_add_f32 v164, v164, v172
MAA 60,84,20
TR 106,25,544
MAA 64,84,24
TR 108,25,12448
s_add_u32 m0, s56, 129664
MAA 64,80,4
buffer_load_dwordx4 v18, s[20:23], s54 offen lds
MAA 68,80,8
TR 110,25,12960
MAA 68,84,28
TR 112,25,1056
MAA 72,84,32
TR 114,25,1568
v_add_f32 v165, v165, v173
MAA 72,80,12
TR 116,25,13472
s_waitcnt lgkmcnt(7)
MAA 104,88,12
TR 118,25,13984
MAA 104,92,32
buffer_load_dwordx4 v19, s[20:23], s54 offen offset:1024 lds
MAA 100,92,28
TR 120,25,2080
MAA 100,88,8
buffer_load_dwordx4 v20, s[20:23], s54 offen offset:2048 lds
MAA 96,88,4
s_add_u32 s54, s54, 196608
MAA 96,92,24
TR 122,25,2592
v_add_f32 v166, v166, v174
MAA 92,92,20
TR 124,25,14496
s_add_u32 m0, s55, 0
MAA 92,88,0
buffer_load_dwordx4 v21, s[16:19], s52 offen sc1 lds
MAA 124,0,96
TR 126,25,15008
MAA 124,20,100
RD 40,23,18432
MAA 128,24,100
RD 44,23,19456
MAA 128,4,96
buffer_load_dwordx4 v21, s[16:19], s52 offen offset:1024 sc1 lds
MAA 132,8,96
RD 48,23,20736
v_add_f32 v167, v167, v175
MAA 132,28,100
RD 52,23,21760
MAA 136,32,100
RD 56,24,20480
MAA 136,12,96
buffer_load_dword v22, s[16:19], s52 offen offset:2048 sc1 lds
MAA 156,16,96
s_add_u32 s52, s52, 131072
MAA 156,36,100
s_waitcnt vmcnt(17) lgkmcnt(5)
s_barrier
MAA 76,104,0
RD 60,23,27648
s_add_u32 m0, s56, 67584
MAA 76,108,20
buffer_load_dwordx4 v18, s[20:23], s54 offen lds
MAA 80,108,24
RD 64,23,28672
MAA 80,104,4
RD 68,23,29952
MAA 84,104,8
RD 72,23,30976
MAA 84,108,28
buffer_load_dwordx4 v19, s[20:23], s54 offen offset:1024 lds
MAA 88,108,32
RD 76,24,29696
MAA 88,104,12
buffer_load_dwordx4 v20, s[20:23], s54 offen offset:2048 lds
MAA 120,112,12
TR 80,25,24832
s_add_u32 s54, s54, 196608
MAA 120,116,32
TR 82,25,25344
MAA 116,116,28
TR 84,25,37248
s_add_u32 m0, s55, 9216
MAA 116,112,8
buffer_load_dwordx4 v21, s[16:19], s52 offen sc1 lds
MAA 112,112,4
TR 86,25,37760
MAA 112,116,24
TR 88,25,25856
MAA 108,116,20
TR 90,25,26368
MAA 108,112,0
buffer_load_dwordx4 v21, s[16:19], s52 offen offset:1024 sc1 lds
MAA 140,0,120
TR 92,25,38272
MAA 140,20,124
TR 94,25,38784
MAA 144,24,124
TR 96,25,26880
MAA 144,4,120
buffer_load_dword v22, s[16:19], s52 offen offset:2048 sc1 lds
MAA 148,8,120
TR 98,25,27392
s_add_u32 s52, s52, 131072
MAA 148,28,124
buffer_load_dwordx4 v[172:175], v26, s[16:19], s75 offen offset:1024 sc1
MAA 152,32,124
TR 100,25,39296
s_add_u32 s75, s75, 2048
MAA 152,12,120
TR 102,25,39808
MAA 160,16,120
MAA 160,36,124
s_waitcnt vmcnt(21) lgkmcnt(8)
s_barrier
MAA 60,80,40
TR 104,25,24864
MAA 60,84,60
TR 106,25,25376
MAA 64,84,64
TR 108,25,37280
s_add_u32 m0, s56, 80000
MAA 64,80,44
buffer_load_dwordx4 v18, s[20:23], s54 offen lds
MAA 68,80,48
TR 110,25,37792
MAA 68,84,68
TR 112,25,25888
MAA 72,84,72
TR 114,25,26400
MAA 72,80,52
TR 116,25,38304
s_waitcnt lgkmcnt(7)
MAA 104,88,52
TR 118,25,38816
MAA 104,92,72
buffer_load_dwordx4 v19, s[20:23], s54 offen offset:1024 lds
MAA 100,92,68
TR 120,25,26912
MAA 100,88,48
buffer_load_dwordx4 v20, s[20:23], s54 offen offset:2048 lds
MAA 96,88,44
s_add_u32 s54, s54, 196608
MAA 96,92,64
TR 122,25,27424
MAA 92,92,60
TR 124,25,39328
s_add_u32 m0, s55, 18432
MAA 92,88,40
buffer_load_dwordx4 v21, s[16:19], s52 offen sc1 lds
MAA 124,40,96
TR 126,25,39840
MAA 124,60,100
RD 0,23,36864
MAA 128,64,100
RD 4,23,37888
MAA 128,44,96
buffer_load_dwordx4 v21, s[16:19], s52 offen offset:1024 sc1 lds
MAA 132,48,96
RD 8,23,39168
MAA 132,68,100
RD 12,23,40192
MAA 136,72,100
RD 16,24,38912
MAA 136,52,96
buffer_load_dword v22, s[16:19], s52 offen offset:2048 sc1 lds
MAA 156,56,96
s_add_u32 s52, s52, 131072
MAA 156,76,100
s_waitcnt vmcnt(16) lgkmcnt(5)
s_barrier
MAA 76,104,40
RD 20,23,46080
MAA 76,108,60
RD 24,23,47104
MAA 80,108,64
RD 28,23,48384
s_add_u32 m0, s56, 92416
MAA 80,104,44
buffer_load_dwordx4 v18, s[20:23], s54 offen lds
MAA 84,104,48
RD 32,23,49408
MAA 84,108,68
RD 36,24,48128
MAA 88,108,72
TR 80,25,49664
MAA 88,104,52
buffer_load_dwordx4 v19, s[20:23], s54 offen offset:1024 lds
MAA 120,112,52
TR 82,25,50176
MAA 120,116,72
TR 84,25,62080
MAA 116,116,68
TR 86,25,62592
MAA 116,112,48
buffer_load_dwordx4 v20, s[20:23], s54 offen offset:2048 lds
MAA 112,112,44
s_add_u32 s54, s54, 196608
MAA 112,116,64
TR 88,25,50688
MAA 108,116,60
TR 90,25,51200
s_add_u32 m0, s55, 27648
MAA 108,112,40
buffer_load_dwordx4 v21, s[16:19], s52 offen sc1 lds
MAA 140,40,120
TR 92,25,63104
MAA 140,60,124
TR 94,25,63616
MAA 144,64,124
TR 96,25,51712
MAA 144,44,120
buffer_load_dwordx4 v21, s[16:19], s52 offen offset:1024 sc1 lds
MAA 148,48,120
TR 98,25,52224
MAA 148,68,124
TR 100,25,64128
MAA 152,72,124
TR 102,25,64640
MAA 152,52,120
buffer_load_dword v22, s[16:19], s52 offen offset:2048 sc1 lds
MAA 160,56,120
s_add_u32 s52, s52, 131072
s_add_u32 s15, s15, 1
MAA 160,76,124
s_cbranch_scc0 .Lk58
s_waitcnt vmcnt(19) lgkmcnt(8)
s_barrier
MAA 60,80,0
TR 104,25,49696
.Lpad18:
s_cbranch_execz .Lnopoll53r
v_add_f32 v164, v164, v168
MAA 60,84,20
TR 106,25,50208
s_add_u32 m0, s56, 104832
MAA 64,84,24
buffer_load_dwordx4 v18, s[20:23], s54 offen lds
MAA 64,80,4
TR 108,25,62112
v_add_f32 v165, v165, v169
MAA 68,80,8
TR 110,25,62624
v_add_f32 v166, v166, v170
MAA 68,84,28
TR 112,25,50720
v_add_f32 v167, v167, v171
MAA 72,84,32
buffer_load_dwordx4 v19, s[20:23], s54 offen offset:1024 lds
MAA 72,80,12
TR 114,25,51232
s_waitcnt lgkmcnt(6)
MAA 104,88,12
TR 116,25,63136
MAA 104,92,32
TR 118,25,63648
MAA 100,92,28
buffer_load_dwordx4 v20, s[20:23], s54 offen offset:2048 lds
MAA 100,88,8
TR 120,25,51744
s_add_u32 s54, s54, 196608
MAA 96,88,4
TR 122,25,52256
s_add_u32 m0, s55, 36864
MAA 96,92,24
TR 124,25,64160
MAA 92,92,20
buffer_load_dwordx4 v21, s[16:19], s52 offen sc1 lds
MAA 92,88,0
TR 126,25,64672
MAA 124,0,96
ds_read_b128 a[40:43], v23
MAA 124,20,100
RD 44,23,1024
MAA 128,24,100
buffer_load_dwordx4 v21, s[16:19], s52 offen offset:1024 sc1 lds
MAA 128,4,96
RD 48,23,2304
MAA 132,8,96
RD 52,23,3328
MAA 132,28,100
RD 56,24,2048
MAA 136,32,100
buffer_load_dword v22, s[16:19], s52 offen offset:2048 sc1 lds
MAA 136,12,96
s_add_u32 s52, s52, 131072
MAA 156,16,96
MAA 156,36,100
s_waitcnt vmcnt(15) lgkmcnt(5)
s_barrier
MAA 76,104,0
RD 60,23,9216
v_add_f32 v164, v164, v172
MAA 76,108,20
RD 64,23,10240
s_add_u32 m0, s56, 117248
MAA 80,108,24
buffer_load_dwordx4 v18, s[20:23], s54 offen lds
MAA 80,104,4
RD 68,23,11520
v_add_f32 v165, v165, v173
MAA 84,104,8
RD 72,23,12544
v_add_f32 v166, v166, v174
MAA 84,108,28
RD 76,24,11264
v_add_f32 v167, v167, v175
MAA 88,108,32
buffer_load_dwordx4 v19, s[20:23], s54 offen offset:1024 lds
MAA 88,104,12
ds_read_b64_tr_b16 a[80:81], v25
MAA 120,112,12
TR 82,25,512
MAA 120,116,32
TR 84,25,12416
MAA 116,116,28
buffer_load_dwordx4 v20, s[20:23], s54 offen offset:2048 lds
MAA 116,112,8
TR 86,25,12928
s_add_u32 s54, s54, 196608
MAA 112,112,4
TR 88,25,1024
s_add_u32 m0, s55, 46080
MAA 112,116,24
TR 90,25,1536
MAA 108,116,20
buffer_load_dwordx4 v21, s[16:19], s52 offen sc1 lds
MAA 108,112,0
TR 92,25,13440
MAA 140,0,120
TR 94,25,13952
MAA 140,20,124
TR 96,25,2048
MAA 144,24,124
buffer_load_dwordx4 v21, s[16:19], s52 offen offset:1024 sc1 lds
MAA 144,4,120
TR 98,25,2560
MAA 148,8,120
TR 100,25,14464
MAA 148,28,124
TR 102,25,14976
MAA 152,32,124
buffer_load_dword v22, s[16:19], s52 offen offset:2048 sc1 lds
MAA 152,12,120
s_add_u32 s52, s52, 131072
v_permlane32_swap_b32 v164, v166
MAA 160,16,120
v_permlane32_swap_b32 v165, v167
MAA 160,36,124
s_waitcnt vmcnt(18) lgkmcnt(8)
s_barrier
MAA 60,80,40
TR 104,25,32
v_add_f32 v164, v164, v166
MAA 60,84,60
TR 106,25,544
s_add_u32 m0, s56, 129664
MAA 64,84,64
buffer_load_dwordx4 v18, s[20:23], s54 offen lds
MAA 64,80,44
TR 108,25,12448
v_add_f32 v165, v165, v167
MAA 68,80,48
TR 110,25,12960
v_mul_f32 v164, 0xba800000, v164
MAA 68,84,68
buffer_load_dwordx4 v19, s[20:23], s54 offen offset:1024 lds
MAA 72,84,72
TR 112,25,1056
v_mul_f32 v165, 0x3a800000, v165
MAA 72,80,52
TR 114,25,1568
v_fma_f32 v165, -v164, v164, v165
s_waitcnt lgkmcnt(6)
MAA 104,88,52
buffer_load_dwordx4 v20, s[20:23], s54 offen offset:2048 lds
MAA 104,92,72
TR 116,25,13472
s_add_u32 s54, s54, 196608
MAA 100,92,68
TR 118,25,13984
s_add_u32 m0, s59, 58240
MAA 100,88,48
TR 120,25,2080
s_xor_b32 s58, s87, 1966080
MAA 96,88,44
buffer_load_dwordx4 v5, s[24:27], s58 offen lds
MAA 96,92,64
TR 122,25,2592
v_max_f32 v165, 0, v165
MAA 92,92,60
TR 124,25,14496
v_add_f32 v165, 0x3727c5ac, v165
MAA 92,88,40
buffer_load_dwordx4 v6, s[24:27], s58 offen offset:1024 lds
MAA 124,40,96
TR 126,25,15008
s_add_u32 m0, s59, 0
MAA 124,60,100
RD 0,23,18432
s_xor_b32 s58, s87, 1048576
MAA 128,64,100
buffer_load_dwordx4 v5, s[24:27], s58 offen lds
MAA 128,44,96
RD 4,23,19456
MAA 132,48,96
RD 8,23,20736
MAA 132,68,100
buffer_load_dwordx4 v6, s[24:27], s58 offen offset:1024 lds
MAA 136,72,100
RD 12,23,21760
MAA 136,52,96
RD 16,24,20480
MAA 156,56,96
v_rsq_f32 v166, v165
MAA 156,76,100
v_mov_b32 v165, v166
v_mul_f32 v166, 0x3e8293ee, v166
ds_write_b128 v7, v[164:167]
s_waitcnt vmcnt(16) lgkmcnt(6)
s_barrier
MAA 76,104,40
ds_write_b32 v17, v164
MAA 76,108,60
ds_write_b32 v17, v165 offset:1024
s_add_u32 m0, s59, 8320
MAA 80,108,64
RD 20,23,27648
s_xor_b32 s58, s87, 1179648
MAA 80,104,44
buffer_load_dwordx4 v5, s[24:27], s58 offen lds
MAA 84,104,48
RD 24,23,28672
MAA 84,108,68
RD 28,23,29952
MAA 88,108,72
RD 32,23,30976
MAA 88,104,52
buffer_load_dwordx4 v6, s[24:27], s58 offen offset:1024 lds
MAA 120,112,52
RD 36,24,29696
s_add_u32 m0, s59, 66560
MAA 120,116,72
TR 80,25,24832
s_xor_b32 s58, s87, 0
MAA 116,116,68
TR 82,25,25344
MAA 116,112,48
buffer_load_dwordx4 v5, s[24:27], s58 offen lds
MAA 112,112,44
TR 84,25,37248
MAA 112,116,64
TR 86,25,37760
MAA 108,116,60
TR 88,25,25856
MAA 108,112,40
buffer_load_dwordx4 v6, s[24:27], s58 offen offset:1024 lds
MAA 140,40,120
TR 90,25,26368
s_add_u32 m0, s59, 74880
MAA 140,60,124
TR 92,25,38272
s_xor_b32 s58, s87, 131072
MAA 144,64,124
TR 94,25,38784
MAA 144,44,120
buffer_load_dwordx4 v5, s[24:27], s58 offen lds
MAA 148,48,120
TR 96,25,26880
MAA 148,68,124
TR 98,25,27392
MAA 152,72,124
TR 100,25,39296
MAA 152,52,120
buffer_load_dwordx4 v6, s[24:27], s58 offen offset:1024 lds
MAA 160,56,120
TR 102,25,39808
MAA 160,76,124
s_waitcnt vmcnt(10) lgkmcnt(0)
s_barrier
MAA 104,88,12
TR 112,25,25888
s_add_u32 m0, s59, 83200
MAA 104,92,32
TR 114,25,26400
s_xor_b32 s58, s87, 262144
MAA 100,92,28
buffer_load_dwordx4 v5, s[24:27], s58 offen lds
MAA 100,88,8
TR 116,25,38304
MAA 96,88,4
TR 118,25,38816
MAA 96,92,24
TR 120,25,26912
MAA 92,92,20
buffer_load_dwordx4 v6, s[24:27], s58 offen offset:1024 lds
MAA 92,88,0
TR 122,25,27424
s_add_u32 m0, s59, 16640
MAA 156,16,96
TR 124,25,39328
s_xor_b32 s58, s87, 1310720
MAA 156,36,100
TR 126,25,39840
MAA 72,84,32
buffer_load_dwordx4 v5, s[24:27], s58 offen lds
MAA 72,80,12
TR 104,25,24864
MAA 68,80,8
TR 106,25,25376
MAA 68,84,28
TR 108,25,37280
MAA 64,84,24
buffer_load_dwordx4 v6, s[24:27], s58 offen offset:1024 lds
MAA 64,80,4
TR 110,25,37792
s_add_u32 m0, s59, 24960
MAA 60,80,0
RD 40,23,36864
s_xor_b32 s58, s87, 1441792
MAA 60,84,20
RD 44,23,37888
s_waitcnt lgkmcnt(12)
MAA 120,112,12
buffer_load_dwordx4 v5, s[24:27], s58 offen lds
s_waitcnt lgkmcnt(10)
MAA 120,116,32
RD 48,23,39168
MAA 116,116,28
RD 52,23,40192
MAA 116,112,8
RD 56,24,38912
MAA 112,112,4
buffer_load_dwordx4 v6, s[24:27], s58 offen offset:1024 lds
MAA 112,116,24
s_waitcnt lgkmcnt(5)
s_barrier
RD 60,23,46080
MAA 108,116,20
RD 64,23,47104
s_add_u32 m0, s59, 91520
MAA 108,112,0
RD 68,23,48384
s_xor_b32 s58, s87, 393216
MAA 160,16,120
RD 72,23,49408
MAA 160,36,124
RD 76,24,48128
MAA 88,108,32
TR 144,25,50688
MAA 88,104,12
TR 146,25,51200
MAA 84,104,8
TR 148,25,63104
MAA 84,108,28
TR 150,25,63616
MAA 80,108,24
TR 152,25,50720
MAA 80,104,4
TR 154,25,51232
MAA 76,104,0
TR 156,25,63136
MAA 76,108,20
TR 158,25,63648
TR 160,25,51712
TR 162,25,52224
TR 164,25,64128
s_waitcnt lgkmcnt(9)
MAA 104,144,52
TR 166,25,64640
TR 168,25,51744
TR 170,25,52256
s_waitcnt lgkmcnt(10)
MAA 104,148,72
TR 172,25,64160
MAA 100,148,68
TR 174,25,64672
MAA 100,144,48
TR 136,25,49696
MAA 96,144,44
TR 138,25,50208
MAA 96,148,64
TR 140,25,62112
MAA 92,148,60
TR 142,25,62624
MAA 92,144,40
TR 128,25,49664
s_waitcnt lgkmcnt(15)
MAA 120,152,52
TR 130,25,50176
s_waitcnt lgkmcnt(14)
MAA 120,156,72
TR 132,25,62080
MAA 116,156,68
TR 134,25,62592
MAA 116,152,48
ds_read_b128 v[232:235], v10 offset:1792
MAA 112,152,44
ds_read_b128 v[228:231], v10 offset:1536
MAA 112,156,64
ds_read_b128 v[224:227], v10 offset:1280
MAA 108,156,60
ds_read_b128 v[220:223], v10 offset:1024
MAA 108,152,40
buffer_load_dwordx4 v5, s[24:27], s58 offen lds
s_waitcnt lgkmcnt(15)
MAA 156,56,160
ds_read_b128 v[240:243], v11 offset:704
MAA 156,76,164
ds_read_b128 v[244:247], v11 offset:1728
s_waitcnt lgkmcnt(14)
MAA 160,76,172
s_waitcnt lgkmcnt(6)
s_barrier
ds_read_b128 v[18:21], v11 offset:448
MAA 160,56,168
buffer_load_dwordx4 v6, s[24:27], s58 offen offset:1024 lds
MAA 88,136,52
ds_read_b128 v[22:25], v11 offset:1472
s_add_u32 m0, s59, 99840
MAA 88,140,72
s_xor_b32 s58, s87, 524288
MAA 84,140,68
MAA 84,136,48
buffer_load_dwordx4 v5, s[24:27], s58 offen lds
MAA 80,136,44
MAA 80,140,64
MAA 76,140,60
MAA 76,136,40
buffer_load_dwordx4 v6, s[24:27], s58 offen offset:1024 lds
MAA 72,128,52
s_add_u32 m0, s59, 108160
s_xor_b32 s58, s87, 655360
MAA 72,132,72
MAA 68,132,68
MAA 68,128,48
buffer_load_dwordx4 v5, s[24:27], s58 offen lds
MAA 64,128,44
MAA 64,132,64
MAA 60,132,60
MAA 60,128,40
buffer_load_dwordx4 v6, s[24:27], s58 offen offset:1024 lds
s_waitcnt lgkmcnt(3)
v_pk_fma_f32 v[156:157], v[240:241], v[44:45], v[156:157] op_sel_hi:[1,0,1]
s_waitcnt lgkmcnt(2)
v_pk_mul_f32 v[156:157], v[156:157], v[244:245]
v_cvt_pk_bf16_f32 v236, v156, v157
v_pk_fma_f32 v[158:159], v[242:243], v[44:45], v[158:159] op_sel_hi:[1,0,1]
v_pk_mul_f32 v[158:159], v[158:159], v[246:247]
v_cvt_pk_bf16_f32 v237, v158, v159
v_pk_fma_f32 v[160:161], v[240:241], v[44:45], v[160:161] op_sel:[0,1,0] op_sel_hi:[1,1,1]
v_pk_mul_f32 v[160:161], v[160:161], v[244:245]
v_cvt_pk_bf16_f32 v238, v160, v161
v_pk_fma_f32 v[162:163], v[242:243], v[44:45], v[162:163] op_sel:[0,1,0] op_sel_hi:[1,1,1]
v_pk_mul_f32 v[162:163], v[162:163], v[246:247]
v_cvt_pk_bf16_f32 v239, v162, v163
ds_write_b128 v8, v[236:239] offset:1024
v_pk_fma_f32 v[104:105], v[36:37], v[232:233], v[104:105] op_sel_hi:[1,0,1]
v_pk_mul_f32 v[104:105], v[104:105], v[232:233] op_sel:[0,1] op_sel_hi:[1,1]
v_cvt_pk_bf16_f32 v196, v104, v105
v_pk_fma_f32 v[106:107], v[38:39], v[232:233], v[106:107] op_sel_hi:[1,0,1]
v_pk_mul_f32 v[106:107], v[106:107], v[232:233] op_sel:[0,1] op_sel_hi:[1,1]
v_cvt_pk_bf16_f32 v197, v106, v107
v_pk_fma_f32 v[120:121], v[40:41], v[232:233], v[120:121] op_sel_hi:[1,0,1]
v_pk_mul_f32 v[120:121], v[120:121], v[232:233] op_sel:[0,1] op_sel_hi:[1,1]
v_cvt_pk_bf16_f32 v198, v120, v121
v_pk_fma_f32 v[122:123], v[42:43], v[232:233], v[122:123] op_sel_hi:[1,0,1]
v_pk_mul_f32 v[122:123], v[122:123], v[232:233] op_sel:[0,1] op_sel_hi:[1,1]
v_cvt_pk_bf16_f32 v199, v122, v123
v_pk_fma_f32 v[100:101], v[36:37], v[228:229], v[100:101] op_sel_hi:[1,0,1]
v_pk_mul_f32 v[100:101], v[100:101], v[228:229] op_sel:[0,1] op_sel_hi:[1,1]
v_cvt_pk_bf16_f32 v192, v100, v101
v_pk_fma_f32 v[102:103], v[38:39], v[228:229], v[102:103] op_sel_hi:[1,0,1]
v_pk_mul_f32 v[102:103], v[102:103], v[228:229] op_sel:[0,1] op_sel_hi:[1,1]
v_cvt_pk_bf16_f32 v193, v102, v103
v_pk_fma_f32 v[116:117], v[40:41], v[228:229], v[116:117] op_sel_hi:[1,0,1]
v_pk_mul_f32 v[116:117], v[116:117], v[228:229] op_sel:[0,1] op_sel_hi:[1,1]
v_cvt_pk_bf16_f32 v194, v116, v117
v_pk_fma_f32 v[118:119], v[42:43], v[228:229], v[118:119] op_sel_hi:[1,0,1]
v_pk_mul_f32 v[118:119], v[118:119], v[228:229] op_sel:[0,1] op_sel_hi:[1,1]
v_cvt_pk_bf16_f32 v195, v118, v119
v_pk_fma_f32 v[96:97], v[36:37], v[224:225], v[96:97] op_sel_hi:[1,0,1]
v_pk_mul_f32 v[96:97], v[96:97], v[224:225] op_sel:[0,1] op_sel_hi:[1,1]
v_cvt_pk_bf16_f32 v188, v96, v97
v_pk_fma_f32 v[98:99], v[38:39], v[224:225], v[98:99] op_sel_hi:[1,0,1]
v_pk_mul_f32 v[98:99], v[98:99], v[224:225] op_sel:[0,1] op_sel_hi:[1,1]
v_cvt_pk_bf16_f32 v189, v98, v99
s_waitcnt lgkmcnt(0)
s_barrier
ds_read_b128 v[180:183], v9
ds_read_b64 v[200:201], v9 offset:1024
ds_read_b64 v[210:211], v9 offset:1032
v_pk_fma_f32 v[112:113], v[40:41], v[224:225], v[112:113] op_sel_hi:[1,0,1]
v_pk_mul_f32 v[112:113], v[112:113], v[224:225] op_sel:[0,1] op_sel_hi:[1,1]
v_cvt_pk_bf16_f32 v190, v112, v113
v_pk_fma_f32 v[114:115], v[42:43], v[224:225], v[114:115] op_sel_hi:[1,0,1]
v_pk_mul_f32 v[114:115], v[114:115], v[224:225] op_sel:[0,1] op_sel_hi:[1,1]
v_cvt_pk_bf16_f32 v191, v114, v115
v_pk_fma_f32 v[92:93], v[36:37], v[220:221], v[92:93] op_sel_hi:[1,0,1]
v_pk_mul_f32 v[92:93], v[92:93], v[220:221] op_sel:[0,1] op_sel_hi:[1,1]
v_cvt_pk_bf16_f32 v184, v92, v93
v_pk_fma_f32 v[94:95], v[38:39], v[220:221], v[94:95] op_sel_hi:[1,0,1]
v_pk_mul_f32 v[94:95], v[94:95], v[220:221] op_sel:[0,1] op_sel_hi:[1,1]
v_cvt_pk_bf16_f32 v185, v94, v95
v_pk_fma_f32 v[108:109], v[40:41], v[220:221], v[108:109] op_sel_hi:[1,0,1]
v_pk_mul_f32 v[108:109], v[108:109], v[220:221] op_sel:[0,1] op_sel_hi:[1,1]
v_cvt_pk_bf16_f32 v186, v108, v109
v_pk_fma_f32 v[110:111], v[42:43], v[220:221], v[110:111] op_sel_hi:[1,0,1]
v_pk_mul_f32 v[110:111], v[110:111], v[220:221] op_sel:[0,1] op_sel_hi:[1,1]
v_cvt_pk_bf16_f32 v187, v110, v111
v_pk_fma_f32 v[72:73], v[28:29], v[232:233], v[72:73] op_sel_hi:[1,0,1]
v_cvt_pk_bf16_f32 v176, v72, v73
v_pk_fma_f32 v[74:75], v[30:31], v[232:233], v[74:75] op_sel_hi:[1,0,1]
v_cvt_pk_bf16_f32 v177, v74, v75
v_pk_fma_f32 v[88:89], v[32:33], v[232:233], v[88:89] op_sel_hi:[1,0,1]
v_cvt_pk_bf16_f32 v178, v88, v89
v_pk_fma_f32 v[90:91], v[34:35], v[232:233], v[90:91] op_sel_hi:[1,0,1]
v_cvt_pk_bf16_f32 v179, v90, v91
v_pk_fma_f32 v[68:69], v[28:29], v[228:229], v[68:69] op_sel_hi:[1,0,1]
v_cvt_pk_bf16_f32 v172, v68, v69
v_pk_fma_f32 v[70:71], v[30:31], v[228:229], v[70:71] op_sel_hi:[1,0,1]
v_cvt_pk_bf16_f32 v173, v70, v71
v_pk_fma_f32 v[84:85], v[32:33], v[228:229], v[84:85] op_sel_hi:[1,0,1]
v_cvt_pk_bf16_f32 v174, v84, v85
v_pk_fma_f32 v[86:87], v[34:35], v[228:229], v[86:87] op_sel_hi:[1,0,1]
v_cvt_pk_bf16_f32 v175, v86, v87
v_pk_fma_f32 v[64:65], v[28:29], v[224:225], v[64:65] op_sel_hi:[1,0,1]
v_cvt_pk_bf16_f32 v168, v64, v65
v_pk_fma_f32 v[66:67], v[30:31], v[224:225], v[66:67] op_sel_hi:[1,0,1]
v_cvt_pk_bf16_f32 v169, v66, v67
v_pk_fma_f32 v[80:81], v[32:33], v[224:225], v[80:81] op_sel_hi:[1,0,1]
v_cvt_pk_bf16_f32 v170, v80, v81
v_pk_fma_f32 v[82:83], v[34:35], v[224:225], v[82:83] op_sel_hi:[1,0,1]
v_cvt_pk_bf16_f32 v171, v82, v83
v_pk_fma_f32 v[60:61], v[28:29], v[220:221], v[60:61] op_sel_hi:[1,0,1]
v_cvt_pk_bf16_f32 v164, v60, v61
v_pk_fma_f32 v[62:63], v[30:31], v[220:221], v[62:63] op_sel_hi:[1,0,1]
v_cvt_pk_bf16_f32 v165, v62, v63
v_pk_fma_f32 v[76:77], v[32:33], v[220:221], v[76:77] op_sel_hi:[1,0,1]
v_cvt_pk_bf16_f32 v166, v76, v77
v_pk_fma_f32 v[78:79], v[34:35], v[220:221], v[78:79] op_sel_hi:[1,0,1]
v_cvt_pk_bf16_f32 v167, v78, v79
s_nop 0
v_mfma_f32_16x16x32_bf16 v[120:123], v[196:199], v[176:179], v[50:53]
ds_read_b128 v[240:243], v11 offset:384
s_add_u32 m0, s59, 33280
v_mfma_f32_16x16x32_bf16 v[104:107], v[192:195], v[176:179], v[46:49]
ds_read_b128 v[244:247], v11 offset:1408
s_xor_b32 s58, s87, 1572864
v_mfma_f32_16x16x32_bf16 v[116:119], v[192:195], v[172:175], v[50:53]
buffer_load_dwordx4 v5, s[24:27], s58 offen lds
v_mfma_f32_16x16x32_bf16 v[100:103], v[188:191], v[172:175], v[46:49]
ds_read_b128 v[28:31], v11 offset:320
v_mfma_f32_16x16x32_bf16 v[112:115], v[188:191], v[168:171], v[50:53]
ds_read_b128 v[32:35], v11 offset:1344
v_max3_f32 v88, v104, v105, v106
v_mfma_f32_16x16x32_bf16 v[96:99], v[184:187], v[168:171], v[46:49]
ds_read_b128 v[36:39], v11 offset:256
v_max3_f32 v89, v107, v120, v121
v_mfma_f32_16x16x32_bf16 v[108:111], v[184:187], v[164:167], v[50:53]
buffer_load_dwordx4 v6, s[24:27], s58 offen offset:1024 lds
s_waitcnt lgkmcnt(7)
v_mfma_f32_16x16x32_bf16 v[92:95], v[180:183], v[164:167], v[46:49]
ds_read_b128 v[40:43], v11 offset:1280
s_add_u32 m0, s59, 41600
MAA 136,12,96
.Lpad19:
s_cbranch_execz .Lnopoll53r
s_xor_b32 s58, s87, 1703936
v_max3_f32 v88, v88, v122, v123
v_max_f32 v90, v88, v89
MAA 136,32,100
v_max_f32 v89, v88, v89
v_max3_f32 v84, v100, v101, v102
MAA 136,52,160
buffer_load_dwordx4 v5, s[24:27], s58 offen lds
MAA 136,72,164
v_permlane16_swap_b32 v90, v89
MAA 152,72,172
v_max_f32 v88, v90, v89
v_max_f32 v89, v90, v89
MAA 152,52,168
s_nop 0
v_permlane32_swap_b32 v88, v89
MAA 152,32,124
buffer_load_dwordx4 v6, s[24:27], s58 offen offset:1024 lds
MAA 152,12,120
s_add_u32 m0, s59, 49920
s_xor_b32 s58, s87, 1835008
v_max_f32 v88, v88, v89
v_mul_f32 v88, v88, v234
v_max3_f32 v85, v103, v116, v117
v_max3_f32 v84, v84, v118, v119
v_max_f32 v86, v84, v85
v_max_f32 v85, v84, v85
v_max3_f32 v80, v96, v97, v98
v_max3_f32 v81, v99, v112, v113
v_permlane16_swap_b32 v86, v85
v_max3_f32 v80, v80, v114, v115
v_max_f32 v84, v86, v85
v_max_f32 v85, v86, v85
v_max_f32 v82, v80, v81
v_max_f32 v81, v80, v81
v_permlane32_swap_b32 v84, v85
v_max3_f32 v76, v92, v93, v94
v_max_f32 v84, v84, v85
v_mul_f32 v84, v84, v230
v_permlane16_swap_b32 v82, v81
v_max3_f32 v77, v95, v108, v109
v_max_f32 v80, v82, v81
v_max_f32 v81, v82, v81
v_max3_f32 v76, v76, v110, v111
v_max_f32 v78, v76, v77
v_permlane32_swap_b32 v80, v81
v_max_f32 v77, v76, v77
v_max_f32 v80, v80, v81
v_mul_f32 v80, v80, v226
v_permlane16_swap_b32 v78, v77
v_pk_fma_f32 v[104:105], v[104:105], v[234:235], v[88:89] op_sel_hi:[1,0,0] neg_lo:[0,0,1] neg_hi:[0,0,1]
v_max_f32 v76, v78, v77
v_max_f32 v77, v78, v77
v_pk_fma_f32 v[106:107], v[106:107], v[234:235], v[88:89] op_sel_hi:[1,0,0] neg_lo:[0,0,1] neg_hi:[0,0,1]
v_pk_fma_f32 v[120:121], v[120:121], v[234:235], v[88:89] op_sel_hi:[1,0,0] neg_lo:[0,0,1] neg_hi:[0,0,1]
v_permlane32_swap_b32 v76, v77
v_pk_fma_f32 v[122:123], v[122:123], v[234:235], v[88:89] op_sel_hi:[1,0,0] neg_lo:[0,0,1] neg_hi:[0,0,1]
v_max_f32 v76, v76, v77
v_mul_f32 v76, v76, v222
v_pk_fma_f32 v[100:101], v[100:101], v[230:231], v[84:85] op_sel_hi:[1,0,0] neg_lo:[0,0,1] neg_hi:[0,0,1]
v_pk_fma_f32 v[102:103], v[102:103], v[230:231], v[84:85] op_sel_hi:[1,0,0] neg_lo:[0,0,1] neg_hi:[0,0,1]
v_pk_fma_f32 v[116:117], v[116:117], v[230:231], v[84:85] op_sel_hi:[1,0,0] neg_lo:[0,0,1] neg_hi:[0,0,1]
v_pk_fma_f32 v[118:119], v[118:119], v[230:231], v[84:85] op_sel_hi:[1,0,0] neg_lo:[0,0,1] neg_hi:[0,0,1]
v_pk_fma_f32 v[96:97], v[96:97], v[226:227], v[80:81] op_sel_hi:[1,0,0] neg_lo:[0,0,1] neg_hi:[0,0,1]
v_pk_fma_f32 v[98:99], v[98:99], v[226:227], v[80:81] op_sel_hi:[1,0,0] neg_lo:[0,0,1] neg_hi:[0,0,1]
v_pk_fma_f32 v[112:113], v[112:113], v[226:227], v[80:81] op_sel_hi:[1,0,0] neg_lo:[0,0,1] neg_hi:[0,0,1]
v_pk_fma_f32 v[114:115], v[114:115], v[226:227], v[80:81] op_sel_hi:[1,0,0] neg_lo:[0,0,1] neg_hi:[0,0,1]
v_pk_fma_f32 v[92:93], v[92:93], v[222:223], v[76:77] op_sel_hi:[1,0,0] neg_lo:[0,0,1] neg_hi:[0,0,1]
v_pk_fma_f32 v[94:95], v[94:95], v[222:223], v[76:77] op_sel_hi:[1,0,0] neg_lo:[0,0,1] neg_hi:[0,0,1]
v_pk_fma_f32 v[108:109], v[108:109], v[222:223], v[76:77] op_sel_hi:[1,0,0] neg_lo:[0,0,1] neg_hi:[0,0,1]
v_pk_fma_f32 v[110:111], v[110:111], v[222:223], v[76:77] op_sel_hi:[1,0,0] neg_lo:[0,0,1] neg_hi:[0,0,1]
v_pk_fma_f32 v[136:137], v[18:19], v[44:45], v[136:137] op_sel_hi:[1,0,1]
v_pk_mul_f32 v[136:137], v[136:137], v[22:23]
v_pk_fma_f32 v[138:139], v[20:21], v[44:45], v[138:139] op_sel_hi:[1,0,1]
v_pk_mul_f32 v[138:139], v[138:139], v[24:25]
v_pk_fma_f32 v[152:153], v[18:19], v[44:45], v[152:153] op_sel:[0,1,0] op_sel_hi:[1,1,1]
v_pk_mul_f32 v[152:153], v[152:153], v[22:23]
v_pk_fma_f32 v[154:155], v[20:21], v[44:45], v[154:155] op_sel:[0,1,0] op_sel_hi:[1,1,1]
v_pk_mul_f32 v[154:155], v[154:155], v[24:25]
v_exp_f32 v104, v104
s_nop 0
MAA 132,8,96
buffer_load_dwordx4 v5, s[24:27], s58 offen lds
MAA 132,28,100
v_exp_f32 v105, v105
MAA 132,48,160
v_exp_f32 v106, v106
MAA 132,68,164
v_exp_f32 v107, v107
MAA 148,68,172
buffer_load_dwordx4 v6, s[24:27], s58 offen offset:1024 lds
MAA 148,48,168
s_add_u32 m0, s59, 116480
s_xor_b32 s58, s87, 786432
v_exp_f32 v120, v120
MAA 148,28,124
v_exp_f32 v121, v121
MAA 148,8,120
v_exp_f32 v122, v122
MAA 128,4,96
buffer_load_dwordx4 v5, s[24:27], s58 offen lds
MAA 128,24,100
v_exp_f32 v123, v123
MAA 128,44,160
v_exp_f32 v100, v100
MAA 128,64,164
v_exp_f32 v101, v101
MAA 144,64,172
buffer_load_dwordx4 v6, s[24:27], s58 offen offset:1024 lds
MAA 144,44,168
s_add_u32 m0, s59, 124800
s_xor_b32 s58, s87, 917504
v_exp_f32 v102, v102
MAA 144,24,124
v_exp_f32 v103, v103
MAA 144,4,120
v_exp_f32 v116, v116
MAA 124,0,96
buffer_load_dwordx4 v5, s[24:27], s58 offen lds
MAA 124,20,100
v_exp_f32 v117, v117
MAA 124,40,160
v_exp_f32 v118, v118
MAA 124,60,164
v_exp_f32 v119, v119
MAA 140,60,172
buffer_load_dwordx4 v6, s[24:27], s58 offen offset:1024 lds
MAA 140,40,168
v_exp_f32 v96, v96
MAA 140,20,124
v_exp_f32 v97, v97
MAA 140,0,120
v_cvt_pk_bf16_f32 v72, v104, v105
v_cvt_pk_bf16_f32 v73, v106, v107
v_cvt_pk_bf16_f32 v74, v120, v121
v_cvt_pk_bf16_f32 v75, v122, v123
v_cvt_pk_bf16_f32 v68, v100, v101
v_cvt_pk_bf16_f32 v69, v102, v103
v_cvt_pk_bf16_f32 v70, v116, v117
v_cvt_pk_bf16_f32 v71, v118, v119
v_exp_f32 v98, v98
v_exp_f32 v99, v99
v_exp_f32 v112, v112
v_exp_f32 v113, v113
v_exp_f32 v114, v114
v_exp_f32 v115, v115
v_cvt_pk_bf16_f32 v64, v96, v97
v_cvt_pk_bf16_f32 v65, v98, v99
v_cvt_pk_bf16_f32 v66, v112, v113
v_cvt_pk_bf16_f32 v67, v114, v115
v_cvt_pk_bf16_f32 v208, v136, v137
v_cvt_pk_bf16_f32 v209, v138, v139
v_cvt_pk_bf16_f32 v218, v152, v153
v_cvt_pk_bf16_f32 v219, v154, v155
s_waitcnt lgkmcnt(5)
v_pk_fma_f32 v[132:133], v[240:241], v[44:45], v[132:133] op_sel_hi:[1,0,1]
s_waitcnt lgkmcnt(4)
v_pk_mul_f32 v[132:133], v[132:133], v[244:245]
v_cvt_pk_bf16_f32 v206, v132, v133
v_pk_fma_f32 v[134:135], v[242:243], v[44:45], v[134:135] op_sel_hi:[1,0,1]
v_pk_mul_f32 v[134:135], v[134:135], v[246:247]
v_cvt_pk_bf16_f32 v207, v134, v135
v_pk_fma_f32 v[148:149], v[240:241], v[44:45], v[148:149] op_sel:[0,1,0] op_sel_hi:[1,1,1]
v_pk_mul_f32 v[148:149], v[148:149], v[244:245]
v_cvt_pk_bf16_f32 v216, v148, v149
v_pk_fma_f32 v[150:151], v[242:243], v[44:45], v[150:151] op_sel:[0,1,0] op_sel_hi:[1,1,1]
v_pk_mul_f32 v[150:151], v[150:151], v[246:247]
v_cvt_pk_bf16_f32 v217, v150, v151
s_waitcnt lgkmcnt(3)
v_pk_fma_f32 v[128:129], v[28:29], v[44:45], v[128:129] op_sel_hi:[1,0,1]
s_waitcnt lgkmcnt(2)
v_pk_mul_f32 v[128:129], v[128:129], v[32:33]
v_cvt_pk_bf16_f32 v204, v128, v129
v_pk_fma_f32 v[130:131], v[30:31], v[44:45], v[130:131] op_sel_hi:[1,0,1]
v_pk_mul_f32 v[130:131], v[130:131], v[34:35]
v_cvt_pk_bf16_f32 v205, v130, v131
v_pk_fma_f32 v[144:145], v[28:29], v[44:45], v[144:145] op_sel:[0,1,0] op_sel_hi:[1,1,1]
v_pk_mul_f32 v[144:145], v[144:145], v[32:33]
v_cvt_pk_bf16_f32 v214, v144, v145
v_pk_fma_f32 v[146:147], v[30:31], v[44:45], v[146:147] op_sel:[0,1,0] op_sel_hi:[1,1,1]
v_pk_mul_f32 v[146:147], v[146:147], v[34:35]
v_cvt_pk_bf16_f32 v215, v146, v147
s_waitcnt lgkmcnt(1)
v_pk_fma_f32 v[124:125], v[36:37], v[44:45], v[124:125] op_sel_hi:[1,0,1]
s_waitcnt lgkmcnt(0)
v_pk_mul_f32 v[124:125], v[124:125], v[40:41]
v_cvt_pk_bf16_f32 v202, v124, v125
v_pk_fma_f32 v[126:127], v[38:39], v[44:45], v[126:127] op_sel_hi:[1,0,1]
v_pk_mul_f32 v[126:127], v[126:127], v[42:43]
v_cvt_pk_bf16_f32 v203, v126, v127
v_pk_fma_f32 v[140:141], v[36:37], v[44:45], v[140:141] op_sel:[0,1,0] op_sel_hi:[1,1,1]
v_pk_mul_f32 v[140:141], v[140:141], v[40:41]
v_cvt_pk_bf16_f32 v212, v140, v141
v_pk_fma_f32 v[142:143], v[38:39], v[44:45], v[142:143] op_sel:[0,1,0] op_sel_hi:[1,1,1]
v_pk_mul_f32 v[142:143], v[142:143], v[42:43]
v_cvt_pk_bf16_f32 v213, v142, v143
s_nop 0
v_mfma_f32_16x16x32_bf16 v[88:91], v[248:251], v[72:75], 0
v_exp_f32 v92, v92
v_mfma_f32_16x16x32_bf16 v[104:107], v[206:209], v[72:75], 0
v_exp_f32 v93, v93
v_mfma_f32_16x16x32_bf16 v[120:123], v[216:219], v[72:75], 0
v_exp_f32 v94, v94
v_mfma_f32_16x16x32_bf16 v[84:87], v[248:251], v[68:71], 0
v_exp_f32 v95, v95
v_mfma_f32_16x16x32_bf16 v[100:103], v[204:207], v[68:71], 0
v_exp_f32 v108, v108
v_mfma_f32_16x16x32_bf16 v[116:119], v[214:217], v[68:71], 0
v_exp_f32 v109, v109
v_mfma_f32_16x16x32_bf16 v[80:83], v[248:251], v[64:67], 0
v_exp_f32 v110, v110
v_mfma_f32_16x16x32_bf16 v[96:99], v[202:205], v[64:67], 0
v_exp_f32 v111, v111
v_mfma_f32_16x16x32_bf16 v[112:115], v[212:215], v[64:67], 0
v_cvt_pk_bf16_f32 v60, v92, v93
v_cvt_pk_bf16_f32 v61, v94, v95
v_cvt_pk_bf16_f32 v62, v108, v109
v_cvt_pk_bf16_f32 v63, v110, v111
v_rcp_f32 v88, v88
v_rcp_f32 v84, v84
v_mfma_f32_16x16x32_bf16 v[76:79], v[248:251], v[60:63], 0
v_rcp_f32 v80, v80
v_mfma_f32_16x16x32_bf16 v[92:95], v[200:203], v[60:63], 0
v_mfma_f32_16x16x32_bf16 v[108:111], v[210:213], v[60:63], 0
s_nop 4
v_rcp_f32 v76, v76
v_pk_mul_f32 v[104:105], v[104:105], v[88:89] op_sel_hi:[1,0]
v_pk_mul_f32 v[106:107], v[106:107], v[88:89] op_sel_hi:[1,0]
v_pk_mul_f32 v[120:121], v[120:121], v[88:89] op_sel_hi:[1,0]
v_pk_mul_f32 v[122:123], v[122:123], v[88:89] op_sel_hi:[1,0]
v_cvt_pk_bf16_f32 v176, v104, v105
v_cvt_pk_bf16_f32 v177, v106, v107
v_cvt_pk_bf16_f32 v178, v120, v121
v_cvt_pk_bf16_f32 v179, v122, v123
buffer_store_dwordx4 v[176:179], v4, s[16:19], s74 offen offset:3072 sc1
v_pk_mul_f32 v[100:101], v[100:101], v[84:85] op_sel_hi:[1,0]
v_pk_mul_f32 v[102:103], v[102:103], v[84:85] op_sel_hi:[1,0]
v_pk_mul_f32 v[116:117], v[116:117], v[84:85] op_sel_hi:[1,0]
v_pk_mul_f32 v[118:119], v[118:119], v[84:85] op_sel_hi:[1,0]
v_cvt_pk_bf16_f32 v172, v100, v101
v_cvt_pk_bf16_f32 v173, v102, v103
v_cvt_pk_bf16_f32 v174, v116, v117
v_cvt_pk_bf16_f32 v175, v118, v119
buffer_store_dwordx4 v[172:175], v4, s[16:19], s74 offen offset:2048 sc1
v_pk_mul_f32 v[96:97], v[96:97], v[80:81] op_sel_hi:[1,0]
v_pk_mul_f32 v[98:99], v[98:99], v[80:81] op_sel_hi:[1,0]
v_pk_mul_f32 v[112:113], v[112:113], v[80:81] op_sel_hi:[1,0]
v_pk_mul_f32 v[114:115], v[114:115], v[80:81] op_sel_hi:[1,0]
v_cvt_pk_bf16_f32 v168, v96, v97
v_cvt_pk_bf16_f32 v169, v98, v99
v_cvt_pk_bf16_f32 v170, v112, v113
v_cvt_pk_bf16_f32 v171, v114, v115
buffer_store_dwordx4 v[168:171], v4, s[16:19], s74 offen offset:1024 sc1
v_pk_mul_f32 v[92:93], v[92:93], v[76:77] op_sel_hi:[1,0]
v_pk_mul_f32 v[94:95], v[94:95], v[76:77] op_sel_hi:[1,0]
v_pk_mul_f32 v[108:109], v[108:109], v[76:77] op_sel_hi:[1,0]
v_pk_mul_f32 v[110:111], v[110:111], v[76:77] op_sel_hi:[1,0]
v_cvt_pk_bf16_f32 v164, v92, v93
v_cvt_pk_bf16_f32 v165, v94, v95
v_cvt_pk_bf16_f32 v166, v108, v109
v_cvt_pk_bf16_f32 v167, v110, v111
buffer_store_dwordx4 v[164:167], v4, s[16:19], s74 offen sc1
s_nop 1
.Lqkve56:
.Lpad20:
s_cbranch_execz .Lnopoll53r
s_lshl_b32 s62, s3, 11
s_add_u32 s62, s62, s84
v_lshl_add_u32 v4, v1, 4, s62
v_lshrrev_b32 v2, 3, v1
v_cmp_eq_u32 vcc, 3, v2
v_add_u32 v2, 67108480, v4
s_nop 0
v_cndmask_b32 v4, v4, v2, vcc
v_bfe_u32 v5, v1, 3, 1
v_lshrrev_b32 v2, 4, v1
v_lshl_add_u32 v5, v2, 3, v5
s_lshl_b32 s62, s3, 1
v_add_u32 v5, s62, v5
v_mul_u32_u24 v5, 2048, v5
v_and_b32 v2, 7, v1
v_lshl_add_u32 v5, v2, 4, v5
s_lshl_b32 s62, s7, 7
v_add_u32 v5, s62, v5
v_add_u32 v6, 64512, v5
v_bfe_u32 v8, v1, 3, 2
v_mul_u32_u24 v8, 2080, v8
v_bfe_u32 v2, v1, 2, 1
v_lshl_add_u32 v8, v2, 7, v8
v_bfe_u32 v2, v1, 5, 1
v_lshl_add_u32 v8, v2, 8, v8
v_and_b32 v2, 3, v1
v_lshl_add_u32 v8, v2, 3, v8
s_mov_b32 s57, 66560
v_add_u32 v7, s57, v8
s_lshr_b32 s54, s87, 17
s_lshl_b32 s54, s54, 18
s_add_u32 s54, s54, 37748736
s_mov_b32 s52, s54
s_add_u32 s53, s54, 131072
v_accvgpr_read_b32 v32, a224
v_accvgpr_read_b32 v33, a225
v_accvgpr_read_b32 v34, a226
v_accvgpr_read_b32 v35, a227
v_accvgpr_read_b32 v36, a228
v_accvgpr_read_b32 v37, a229
v_accvgpr_read_b32 v38, a230
v_accvgpr_read_b32 v39, a231
v_accvgpr_read_b32 v40, a232
v_accvgpr_read_b32 v41, a233
v_accvgpr_read_b32 v42, a234
v_accvgpr_read_b32 v43, a235
v_accvgpr_read_b32 v44, a236
v_accvgpr_read_b32 v45, a237
v_accvgpr_read_b32 v46, a238
v_accvgpr_read_b32 v47, a239
v_accvgpr_read_b32 v48, a240
v_accvgpr_read_b32 v49, a241
v_accvgpr_read_b32 v50, a242
v_accvgpr_read_b32 v51, a243
v_accvgpr_read_b32 v52, a244
v_accvgpr_read_b32 v53, a245
v_accvgpr_read_b32 v54, a246
v_accvgpr_read_b32 v55, a247
v_accvgpr_read_b32 v56, a248
v_accvgpr_read_b32 v57, a249
v_accvgpr_read_b32 v58, a250
v_accvgpr_read_b32 v59, a251
v_accvgpr_read_b32 v60, a252
v_accvgpr_read_b32 v61, a253
v_accvgpr_read_b32 v62, a254
v_accvgpr_read_b32 v63, a255
s_lshl_b32 s62, s49, 3
s_add_u32 s62, s62, s48
s_mul_i32 s62, s62, 28672
s_add_u32 s62, s62, s51
v_lshrrev_b32 v12, 4, v1
v_mul_u32_u24 v12, 57344, v12
v_and_b32 v2, 15, v1
v_lshl_add_u32 v12, v2, 4, v12
v_add_u32 v12, s62, v12
v_add_u32 v13, 6112, v12
v_add_u32 v14, 12224, v12
v_add_u32 v15, 18336, v12
s_mul_i32 s59, s3, 4224
s_mov_b32 s58, 0
s_lshl_b32 s62, s8, 10
s_add_u32 s62, s62, 30490624
s_lshl_b32 s64, s6, 10
s_add_u32 s64, s64, 30490624
s_lshr_b32 s67, s5, 2
s_and_b32 s67, s67, 3
s_lshl_b32 s67, s67, 7
s_add_u32 s64, s64, s67
v_lshl_add_u32 v252, v1, 7, s62
v_mov_b32 v253, s64
v_mov_b32 v255, 1
s_waitcnt vmcnt(0) lgkmcnt(0)
s_cmp_lg_u32 s3, 1
s_barrier
s_cbranch_scc1 .Lnopoll60
s_mov_b64 exec, 15
buffer_atomic_add v255, v252, s[16:19], 0 offen
s_mov_b64 exec, 1
v_mov_b32 v254, 0
buffer_atomic_add v254, v253, s[16:19], 0 offen sc0
s_sleep 5
s_mov_b32 s15, 0
.Lpoll59:
v_mov_b32 v255, 0
buffer_atomic_add v255, v253, s[16:19], 0 offen sc0
s_waitcnt vmcnt(1)
v_cmp_gt_u32 vcc, 16, v254
s_add_u32 s15, s15, 1
s_cbranch_vccz .Lnopoll60r
v_mov_b32 v254, 0
buffer_atomic_add v254, v253, s[16:19], 0 offen sc0
s_waitcnt vmcnt(1)
v_cmp_gt_u32 vcc, 16, v255
s_add_u32 s15, s15, 1
s_cbranch_vccz .Lnopoll60r
s_cmp_le_u32 s15, 100000
s_cbranch_scc1 .Lpoll59
s_branch .Lnopoll60r
.Lnopoll60:
s_mov_b64 exec, 0
s_cmp_eq_u32 s3, 2
s_cbranch_scc1 .Lpad21
s_cmp_eq_u32 s3, 3
s_cbranch_scc1 .Lpad22
s_branch .Lpad23
.Lnopoll60r:
s_mov_b64 exec, -1
s_barrier
buffer_load_dwordx4 v[64:67], v4, s[16:19], s52 offen sc1
buffer_load_dwordx4 v[68:71], v4, s[16:19], s52 offen offset:1024 sc1
s_xor_b32 s52, s54, 262144
buffer_load_dwordx4 v[72:75], v4, s[16:19], s53 offen sc1
buffer_load_dwordx4 v[76:79], v4, s[16:19], s53 offen offset:1024 sc1
s_xor_b32 s53, s54, 393216
buffer_load_dwordx4 v[80:83], v4, s[16:19], s52 offen sc1
buffer_load_dwordx4 v[84:87], v4, s[16:19], s52 offen offset:1024 sc1
s_xor_b32 s52, s54, 524288
buffer_load_dwordx4 v[88:91], v4, s[16:19], s53 offen sc1
buffer_load_dwordx4 v[92:95], v4, s[16:19], s53 offen offset:1024 sc1
s_xor_b32 s53, s54, 655360
buffer_load_dwordx4 v[96:99], v4, s[16:19], s52 offen sc1
buffer_load_dwordx4 v[100:103], v4, s[16:19], s52 offen offset:1024 sc1
s_xor_b32 s52, s54, 786432
buffer_load_dwordx4 v[104:107], v4, s[16:19], s53 offen sc1
buffer_load_dwordx4 v[108:111], v4, s[16:19], s53 offen offset:1024 sc1
s_xor_b32 s53, s54, 917504
ds_read_b64_tr_b16 a[0:1], v7
TR 2,7,512
TR 16,7,1024
TR 18,7,1536
TR 4,7,32
TR 6,7,544
TR 20,7,1056
TR 22,7,1568
TR 8,7,64
TR 10,7,576
TR 24,7,1088
TR 26,7,1600
TR 12,7,96
TR 14,7,608
TR 28,7,1120
TR 30,7,1632
s_waitcnt vmcnt(8) lgkmcnt(14)
MAV 32,0,64
TR 32,7,8320
s_waitcnt lgkmcnt(13)
MAV 32,16,72
buffer_load_dwordx4 v[112:115], v4, s[16:19], s52 offen sc1
MAV 48,16,76
TR 34,7,8832
MAV 48,0,68
TR 48,7,9344
TR 50,7,9856
s_waitcnt lgkmcnt(14)
MAV 52,4,68
TR 36,7,8352
s_waitcnt lgkmcnt(13)
MAV 52,20,76
buffer_load_dwordx4 v[116:119], v4, s[16:19], s52 offen offset:1024 sc1
MAV 36,20,72
TR 38,7,8864
s_xor_b32 s52, s54, 1048576
MAV 36,4,64
TR 52,7,9376
TR 54,7,9888
s_waitcnt lgkmcnt(14)
MAV 40,8,64
TR 40,7,8384
s_waitcnt lgkmcnt(13)
MAV 40,24,72
buffer_load_dwordx4 v[120:123], v4, s[16:19], s53 offen sc1
MAV 56,24,76
TR 42,7,8896
MAV 56,8,68
TR 56,7,9408
TR 58,7,9920
s_waitcnt lgkmcnt(14)
MAV 60,12,68
TR 44,7,8416
s_waitcnt lgkmcnt(13)
MAV 60,28,76
buffer_load_dwordx4 v[124:127], v4, s[16:19], s53 offen offset:1024 sc1
MAV 44,28,72
TR 46,7,8928
s_xor_b32 s53, s54, 1179648
MAV 44,12,64
TR 60,7,9440
TR 62,7,9952
s_waitcnt vmcnt(8) lgkmcnt(8)
MAV 32,32,80
TR 0,7,16640
MAV 32,48,88
buffer_load_dwordx4 v[64:67], v4, s[16:19], s52 offen sc1
MAV 48,48,92
TR 2,7,17152
MAV 48,32,84
TR 16,7,17664
TR 18,7,18176
MAV 52,36,84
TR 4,7,16672
MAV 52,52,92
buffer_load_dwordx4 v[68:71], v4, s[16:19], s52 offen offset:1024 sc1
MAV 36,52,88
TR 6,7,17184
s_xor_b32 s52, s54, 1310720
MAV 36,36,80
TR 20,7,17696
TR 22,7,18208
s_waitcnt lgkmcnt(8)
MAV 40,40,80
TR 8,7,16704
MAV 40,56,88
buffer_load_dwordx4 v[72:75], v4, s[16:19], s53 offen sc1
MAV 56,56,92
TR 10,7,17216
MAV 56,40,84
TR 24,7,17728
TR 26,7,18240
MAV 60,44,84
TR 12,7,16736
MAV 60,60,92
buffer_load_dwordx4 v[76:79], v4, s[16:19], s53 offen offset:1024 sc1
MAV 44,60,88
TR 14,7,17248
s_xor_b32 s53, s54, 1441792
MAV 44,44,80
TR 28,7,17760
TR 30,7,18272
s_waitcnt vmcnt(8) lgkmcnt(8)
MAV 32,0,96
TR 32,7,24960
MAV 32,16,104
buffer_load_dwordx4 v[80:83], v4, s[16:19], s52 offen sc1
MAV 48,16,108
TR 34,7,25472
MAV 48,0,100
TR 48,7,25984
TR 50,7,26496
MAV 52,4,100
TR 36,7,24992
MAV 52,20,108
buffer_load_dwordx4 v[84:87], v4, s[16:19], s52 offen offset:1024 sc1
MAV 36,20,104
TR 38,7,25504
s_xor_b32 s52, s54, 1572864
MAV 36,4,96
TR 52,7,26016
TR 54,7,26528
s_waitcnt lgkmcnt(8)
MAV 40,8,96
TR 40,7,25024
MAV 40,24,104
buffer_load_dwordx4 v[88:91], v4, s[16:19], s53 offen sc1
MAV 56,24,108
TR 42,7,25536
MAV 56,8,100
TR 56,7,26048
TR 58,7,26560
MAV 60,12,100
TR 44,7,25056
MAV 60,28,108
buffer_load_dwordx4 v[92:95], v4, s[16:19], s53 offen offset:1024 sc1
MAV 44,28,104
TR 46,7,25568
s_xor_b32 s53, s54, 1703936
MAV 44,12,96
TR 60,7,26080
TR 62,7,26592
s_waitcnt vmcnt(8) lgkmcnt(8)
MAV 32,32,112
TR 0,7,33280
MAV 32,48,120
buffer_load_dwordx4 v[96:99], v4, s[16:19], s52 offen sc1
MAV 48,48,124
TR 2,7,33792
MAV 48,32,116
TR 16,7,34304
TR 18,7,34816
MAV 52,36,116
TR 4,7,33312
MAV 52,52,124
buffer_load_dwordx4 v[100:103], v4, s[16:19], s52 offen offset:1024 sc1
MAV 36,52,120
TR 6,7,33824
s_xor_b32 s52, s54, 1835008
MAV 36,36,112
TR 20,7,34336
TR 22,7,34848
s_waitcnt lgkmcnt(8)
MAV 40,40,112
TR 8,7,33344
MAV 40,56,120
buffer_load_dwordx4 v[104:107], v4, s[16:19], s53 offen sc1
MAV 56,56,124
TR 10,7,33856
MAV 56,40,116
TR 24,7,34368
TR 26,7,34880
MAV 60,44,116
TR 12,7,33376
MAV 60,60,124
buffer_load_dwordx4 v[108:111], v4, s[16:19], s53 offen offset:1024 sc1
MAV 44,60,120
TR 14,7,33888
s_xor_b32 s53, s54, 1966080
MAV 44,44,112
TR 28,7,34400
TR 30,7,34912
.Lpad21:
s_cbranch_execz .Lpad24
s_waitcnt vmcnt(8) lgkmcnt(8)
MAV 32,0,64
TR 32,7,41600
MAV 32,16,72
buffer_load_dwordx4 v[112:115], v4, s[16:19], s52 offen sc1
MAV 48,16,76
TR 34,7,42112
MAV 48,0,68
TR 48,7,42624
TR 50,7,43136
MAV 52,4,68
TR 36,7,41632
MAV 52,20,76
buffer_load_dwordx4 v[116:119], v4, s[16:19], s52 offen offset:1024 sc1
MAV 36,20,72
TR 38,7,42144
s_xor_b32 s52, s54, 2097152
MAV 36,4,64
TR 52,7,42656
TR 54,7,43168
s_waitcnt lgkmcnt(8)
MAV 40,8,64
TR 40,7,41664
MAV 40,24,72
buffer_load_dwordx4 v[120:123], v4, s[16:19], s53 offen sc1
MAV 56,24,76
TR 42,7,42176
MAV 56,8,68
TR 56,7,42688
TR 58,7,43200
MAV 60,12,68
TR 44,7,41696
MAV 60,28,76
buffer_load_dwordx4 v[124:127], v4, s[16:19], s53 offen offset:1024 sc1
MAV 44,28,72
TR 46,7,42208
s_xor_b32 s53, s54, 2228224
MAV 44,12,64
TR 60,7,42720
TR 62,7,43232
s_waitcnt vmcnt(8) lgkmcnt(8)
MAV 32,32,80
TR 0,7,49920
MAV 32,48,88
buffer_load_dwordx4 v[64:67], v4, s[16:19], s52 offen sc1
MAV 48,48,92
TR 2,7,50432
MAV 48,32,84
TR 16,7,50944
TR 18,7,51456
MAV 52,36,84
TR 4,7,49952
MAV 52,52,92
buffer_load_dwordx4 v[68:71], v4, s[16:19], s52 offen offset:1024 sc1
MAV 36,52,88
TR 6,7,50464
s_xor_b32 s52, s54, 2359296
MAV 36,36,80
TR 20,7,50976
TR 22,7,51488
s_waitcnt lgkmcnt(8)
MAV 40,40,80
TR 8,7,49984
MAV 40,56,88
buffer_load_dwordx4 v[72:75], v4, s[16:19], s53 offen sc1
MAV 56,56,92
TR 10,7,50496
MAV 56,40,84
TR 24,7,51008
TR 26,7,51520
MAV 60,44,84
TR 12,7,50016
MAV 60,60,92
buffer_load_dwordx4 v[76:79], v4, s[16:19], s53 offen offset:1024 sc1
MAV 44,60,88
TR 14,7,50528
s_xor_b32 s53, s54, 2490368
MAV 44,44,80
TR 28,7,51040
TR 30,7,51552
s_waitcnt vmcnt(8) lgkmcnt(8)
MAV 32,0,96
TR 32,7,58240
MAV 32,16,104
buffer_load_dwordx4 v[80:83], v4, s[16:19], s52 offen sc1
MAV 48,16,108
TR 34,7,58752
MAV 48,0,100
TR 48,7,59264
TR 50,7,59776
MAV 52,4,100
TR 36,7,58272
MAV 52,20,108
buffer_load_dwordx4 v[84:87], v4, s[16:19], s52 offen offset:1024 sc1
MAV 36,20,104
TR 38,7,58784
s_xor_b32 s52, s54, 2621440
MAV 36,4,96
TR 52,7,59296
TR 54,7,59808
s_waitcnt lgkmcnt(8)
MAV 40,8,96
TR 40,7,58304
MAV 40,24,104
buffer_load_dwordx4 v[88:91], v4, s[16:19], s53 offen sc1
MAV 56,24,108
TR 42,7,58816
MAV 56,8,100
TR 56,7,59328
TR 58,7,59840
MAV 60,12,100
TR 44,7,58336
MAV 60,28,108
buffer_load_dwordx4 v[92:95], v4, s[16:19], s53 offen offset:1024 sc1
MAV 44,28,104
TR 46,7,58848
s_xor_b32 s53, s54, 2752512
MAV 44,12,96
TR 60,7,59360
TR 62,7,59872
s_xor_b32 s57, s57, 66560
v_add_u32 v7, s57, v8
s_waitcnt vmcnt(8) lgkmcnt(8)
MAV 32,32,112
ds_read_b64_tr_b16 a[0:1], v7
MAV 32,48,120
buffer_load_dwordx4 v[96:99], v4, s[16:19], s52 offen sc1
MAV 48,48,124
TR 2,7,512
MAV 48,32,116
TR 16,7,1024
TR 18,7,1536
MAV 52,36,116
TR 4,7,32
MAV 52,52,124
buffer_load_dwordx4 v[100:103], v4, s[16:19], s52 offen offset:1024 sc1
MAV 36,52,120
TR 6,7,544
s_xor_b32 s52, s54, 2883584
MAV 36,36,112
TR 20,7,1056
TR 22,7,1568
s_waitcnt lgkmcnt(8)
MAV 40,40,112
TR 8,7,64
MAV 40,56,120
buffer_load_dwordx4 v[104:107], v4, s[16:19], s53 offen sc1
MAV 56,56,124
TR 10,7,576
MAV 56,40,116
TR 24,7,1088
TR 26,7,1600
MAV 60,44,116
TR 12,7,96
MAV 60,60,124
buffer_load_dwordx4 v[108:111], v4, s[16:19], s53 offen offset:1024 sc1
MAV 44,60,120
TR 14,7,608
s_xor_b32 s53, s54, 3014656
MAV 44,44,112
TR 28,7,1120
TR 30,7,1632
s_waitcnt vmcnt(8) lgkmcnt(8)
MAV 32,0,64
TR 32,7,8320
MAV 32,16,72
buffer_load_dwordx4 v[112:115], v4, s[16:19], s52 offen sc1
MAV 48,16,76
TR 34,7,8832
MAV 48,0,68
TR 48,7,9344
TR 50,7,9856
MAV 52,4,68
TR 36,7,8352
MAV 52,20,76
buffer_load_dwordx4 v[116:119], v4, s[16:19], s52 offen offset:1024 sc1
MAV 36,20,72
TR 38,7,8864
s_xor_b32 s52, s54, 3145728
MAV 36,4,64
TR 52,7,9376
TR 54,7,9888
s_waitcnt lgkmcnt(8)
MAV 40,8,64
TR 40,7,8384
MAV 40,24,72
buffer_load_dwordx4 v[120:123], v4, s[16:19], s53 offen sc1
MAV 56,24,76
TR 42,7,8896
MAV 56,8,68
TR 56,7,9408
TR 58,7,9920
MAV 60,12,68
TR 44,7,8416
MAV 60,28,76
buffer_load_dwordx4 v[124:127], v4, s[16:19], s53 offen offset:1024 sc1
MAV 44,28,72
TR 46,7,8928
s_xor_b32 s53, s54, 3276800
MAV 44,12,64
TR 60,7,9440
TR 62,7,9952
s_waitcnt vmcnt(8) lgkmcnt(8)
MAV 32,32,80
TR 0,7,16640
MAV 32,48,88
buffer_load_dwordx4 v[64:67], v4, s[16:19], s52 offen sc1
MAV 48,48,92
TR 2,7,17152
MAV 48,32,84
TR 16,7,17664
TR 18,7,18176
MAV 52,36,84
TR 4,7,16672
MAV 52,52,92
buffer_load_dwordx4 v[68:71], v4, s[16:19], s52 offen offset:1024 sc1
MAV 36,52,88
TR 6,7,17184
s_xor_b32 s52, s54, 3407872
MAV 36,36,80
TR 20,7,17696
TR 22,7,18208
s_waitcnt lgkmcnt(8)
MAV 40,40,80
TR 8,7,16704
MAV 40,56,88
buffer_load_dwordx4 v[72:75], v4, s[16:19], s53 offen sc1
MAV 56,56,92
TR 10,7,17216
MAV 56,40,84
TR 24,7,17728
TR 26,7,18240
MAV 60,44,84
TR 12,7,16736
MAV 60,60,92
buffer_load_dwordx4 v[76:79], v4, s[16:19], s53 offen offset:1024 sc1
MAV 44,60,88
TR 14,7,17248
s_xor_b32 s53, s54, 3538944
MAV 44,44,80
TR 28,7,17760
TR 30,7,18272
s_waitcnt vmcnt(8) lgkmcnt(8)
MAV 32,0,96
TR 32,7,24960
MAV 32,16,104
buffer_load_dwordx4 v[80:83], v4, s[16:19], s52 offen sc1
MAV 48,16,108
TR 34,7,25472
MAV 48,0,100
TR 48,7,25984
TR 50,7,26496
MAV 52,4,100
TR 36,7,24992
MAV 52,20,108
buffer_load_dwordx4 v[84:87], v4, s[16:19], s52 offen offset:1024 sc1
MAV 36,20,104
TR 38,7,25504
s_xor_b32 s52, s54, 3670016
MAV 36,4,96
TR 52,7,26016
TR 54,7,26528
s_waitcnt lgkmcnt(8)
MAV 40,8,96
TR 40,7,25024
MAV 40,24,104
buffer_load_dwordx4 v[88:91], v4, s[16:19], s53 offen sc1
MAV 56,24,108
TR 42,7,25536
MAV 56,8,100
TR 56,7,26048
TR 58,7,26560
MAV 60,12,100
TR 44,7,25056
MAV 60,28,108
buffer_load_dwordx4 v[92:95], v4, s[16:19], s53 offen offset:1024 sc1
MAV 44,28,104
TR 46,7,25568
s_xor_b32 s53, s54, 3801088
MAV 44,12,96
TR 60,7,26080
TR 62,7,26592
s_waitcnt vmcnt(8) lgkmcnt(8)
MAV 32,32,112
TR 0,7,33280
MAV 32,48,120
buffer_load_dwordx4 v[96:99], v4, s[16:19], s52 offen sc1
MAV 48,48,124
TR 2,7,33792
MAV 48,32,116
TR 16,7,34304
TR 18,7,34816
MAV 52,36,116
TR 4,7,33312
MAV 52,52,124
buffer_load_dwordx4 v[100:103], v4, s[16:19], s52 offen offset:1024 sc1
MAV 36,52,120
TR 6,7,33824
s_xor_b32 s52, s54, 3932160
MAV 36,36,112
TR 20,7,34336
TR 22,7,34848
s_waitcnt lgkmcnt(8)
MAV 40,40,112
TR 8,7,33344
MAV 40,56,120
buffer_load_dwordx4 v[104:107], v4, s[16:19], s53 offen sc1
MAV 56,56,124
TR 10,7,33856
MAV 56,40,116
TR 24,7,34368
TR 26,7,34880
MAV 60,44,116
TR 12,7,33376
MAV 60,60,124
buffer_load_dwordx4 v[108:111], v4, s[16:19], s53 offen offset:1024 sc1
MAV 44,60,120
TR 14,7,33888
s_xor_b32 s53, s54, 4063232
MAV 44,44,112
TR 28,7,34400
TR 30,7,34912
s_waitcnt vmcnt(8) lgkmcnt(8)
MAV 32,0,64
TR 32,7,41600
MAV 32,16,72
buffer_load_dwordx4 v[112:115], v4, s[16:19], s52 offen sc1
MAV 48,16,76
TR 34,7,42112
MAV 48,0,68
TR 48,7,42624
TR 50,7,43136
MAV 52,4,68
TR 36,7,41632
MAV 52,20,76
buffer_load_dwordx4 v[116:119], v4, s[16:19], s52 offen offset:1024 sc1
MAV 36,20,72
TR 38,7,42144
MAV 36,4,64
TR 52,7,42656
TR 54,7,43168
s_waitcnt lgkmcnt(8)
MAV 40,8,64
TR 40,7,41664
MAV 40,24,72
buffer_load_dwordx4 v[120:123], v4, s[16:19], s53 offen sc1
MAV 56,24,76
TR 42,7,42176
MAV 56,8,68
TR 56,7,42688
TR 58,7,43200
MAV 60,12,68
TR 44,7,41696
MAV 60,28,76
buffer_load_dwordx4 v[124:127], v4, s[16:19], s53 offen offset:1024 sc1
MAV 44,28,72
TR 46,7,42208
MAV 44,12,64
TR 60,7,42720
TR 62,7,43232
s_barrier
s_waitcnt vmcnt(8) lgkmcnt(8)
MAV 32,32,80
TR 0,7,49920
s_add_u32 m0, s59, 84480
MAV 32,48,88
buffer_load_dwordx4 v12, s[32:35], s58 offen   lds
MAV 48,48,92
TR 2,7,50432
MAV 48,32,84
TR 16,7,50944
TR 18,7,51456
MAV 52,36,84
TR 4,7,49952
MAV 52,52,92
buffer_load_dwordx4 v13, s[32:35], s58 offen offset:1056   lds
MAV 36,52,88
TR 6,7,50464
MAV 36,36,80
TR 20,7,50976
TR 22,7,51488
s_waitcnt lgkmcnt(8)
MAV 40,40,80
TR 8,7,49984
MAV 40,56,88
buffer_load_dwordx4 v14, s[32:35], s58 offen offset:2112   lds
MAV 56,56,92
TR 10,7,50496
MAV 56,40,84
TR 24,7,51008
TR 26,7,51520
MAV 60,44,84
TR 12,7,50016
MAV 60,60,92
buffer_load_dwordx4 v15, s[32:35], s58 offen offset:3168   lds
MAV 44,60,88
TR 14,7,50528
MAV 44,44,80
TR 28,7,51040
TR 30,7,51552
s_waitcnt vmcnt(8) lgkmcnt(8)
MAV 32,0,96
TR 32,7,58240
s_add_u32 m0, s59, 101376
MAV 32,16,104
buffer_load_dwordx4 v12, s[80:83], s58 offen   lds
MAV 48,16,108
TR 34,7,58752
MAV 48,0,100
TR 48,7,59264
TR 50,7,59776
MAV 52,4,100
TR 36,7,58272
MAV 52,20,108
buffer_load_dwordx4 v13, s[80:83], s58 offen offset:1056   lds
MAV 36,20,104
TR 38,7,58784
MAV 36,4,96
TR 52,7,59296
TR 54,7,59808
s_waitcnt lgkmcnt(8)
MAV 40,8,96
TR 40,7,58304
MAV 40,24,104
buffer_load_dwordx4 v14, s[80:83], s58 offen offset:2112   lds
MAV 56,24,108
TR 42,7,58816
MAV 56,8,100
TR 56,7,59328
TR 58,7,59840
MAV 60,12,100
TR 44,7,58336
MAV 60,28,108
buffer_load_dwordx4 v15, s[80:83], s58 offen offset:3168   lds
MAV 44,28,104
TR 46,7,58848
s_add_u32 s58, s58, 458752
MAV 44,12,96
TR 60,7,59360
TR 62,7,59872
s_waitcnt vmcnt(11) lgkmcnt(14)
MAV 32,32,112
s_add_u32 m0, s59, 118272
s_lshl_b32 s64, s6, 14
s_lshl_b32 s65, s49, 13
s_waitcnt vmcnt(9) lgkmcnt(12)
MAV 32,48,120
buffer_load_dwordx4 v12, s[32:35], s58 offen   lds
s_waitcnt vmcnt(9)
MAV 48,48,124
s_add_u32 s64, s64, s65
s_lshl_b32 s65, s7, 9
s_add_u32 s64, s64, s65
MAV 48,32,116
s_lshl_b32 s65, s48, 8
s_add_u32 s64, s64, s65
s_add_u32 s64, s64, 63176704
s_waitcnt lgkmcnt(10)
MAV 52,36,116
s_lshl_b32 s62, s7, 18
v_and_b32 v152, 31, v1
v_lshlrev_b32 v152, 3, v152
s_waitcnt lgkmcnt(8)
MAV 52,52,124
buffer_load_dwordx4 v13, s[32:35], s58 offen offset:1056   lds
MAV 36,52,120
s_add_u32 s62, s62, 41943040
v_lshrrev_b32 v153, 5, v1
v_lshl_add_u32 v152, v153, 28, v152
MAV 36,36,112
s_add_u32 s63, s62, 131072
v_cvt_pk_bf16_f32 v128, v32, v33
v_cvt_pk_bf16_f32 v129, v34, v35
s_waitcnt lgkmcnt(6)
MAV 40,40,112
v_cvt_pk_bf16_f32 v136, v48, v49
v_cvt_pk_bf16_f32 v137, v50, v51
s_waitcnt lgkmcnt(4)
MAV 40,56,120
buffer_load_dwordx4 v14, s[32:35], s58 offen offset:2112   lds
MAV 56,56,124
v_cvt_pk_bf16_f32 v130, v36, v37
v_cvt_pk_bf16_f32 v131, v38, v39
MAV 56,40,116
v_cvt_pk_bf16_f32 v138, v52, v53
v_cvt_pk_bf16_f32 v139, v54, v55
s_waitcnt lgkmcnt(2)
MAV 60,44,116
v_cvt_pk_bf16_f32 v132, v40, v41
v_cvt_pk_bf16_f32 v133, v42, v43
s_waitcnt lgkmcnt(0)
MAV 60,60,124
buffer_load_dwordx4 v15, s[32:35], s58 offen offset:3168   lds
MAV 44,60,120
v_cvt_pk_bf16_f32 v140, v56, v57
v_cvt_pk_bf16_f32 v141, v58, v59
MAV 44,44,112
s_nop 2
v_cvt_pk_bf16_f32 v142, v60, v61
v_cvt_pk_bf16_f32 v143, v62, v63
v_pk_mul_f32 v[146:147], v[32:33], v[32:33]
buffer_store_dwordx4 v[128:131], v4, s[16:19], s62 offen sc1
v_pk_mul_f32 v[150:151], v[48:49], v[48:49]
v_pk_fma_f32 v[146:147], v[34:35], v[34:35], v[146:147]
v_pk_add_f32 v[144:145], v[32:33], v[34:35]
v_pk_fma_f32 v[150:151], v[50:51], v[50:51], v[150:151]
v_cvt_pk_bf16_f32 v134, v44, v45
v_cvt_pk_bf16_f32 v135, v46, v47
v_pk_add_f32 v[148:149], v[48:49], v[50:51]
v_pk_fma_f32 v[146:147], v[36:37], v[36:37], v[146:147]
v_pk_add_f32 v[144:145], v[144:145], v[36:37]
v_pk_fma_f32 v[150:151], v[52:53], v[52:53], v[150:151]
v_pk_add_f32 v[148:149], v[148:149], v[52:53]
v_pk_fma_f32 v[146:147], v[38:39], v[38:39], v[146:147]
v_pk_add_f32 v[144:145], v[144:145], v[38:39]
buffer_store_dwordx4 v[132:135], v4, s[16:19], s63 offen sc1
v_pk_fma_f32 v[150:151], v[54:55], v[54:55], v[150:151]
v_pk_add_f32 v[148:149], v[148:149], v[54:55]
v_pk_fma_f32 v[146:147], v[40:41], v[40:41], v[146:147]
v_pk_add_f32 v[144:145], v[144:145], v[40:41]
v_pk_fma_f32 v[150:151], v[56:57], v[56:57], v[150:151]
v_pk_add_f32 v[148:149], v[148:149], v[56:57]
v_pk_fma_f32 v[146:147], v[42:43], v[42:43], v[146:147]
v_pk_add_f32 v[144:145], v[144:145], v[42:43]
v_pk_fma_f32 v[150:151], v[58:59], v[58:59], v[150:151]
v_pk_add_f32 v[148:149], v[148:149], v[58:59]
v_pk_fma_f32 v[146:147], v[44:45], v[44:45], v[146:147]
v_pk_add_f32 v[144:145], v[144:145], v[44:45]
v_pk_fma_f32 v[150:151], v[60:61], v[60:61], v[150:151]
buffer_store_dwordx4 v[136:139], v4, s[16:19], s62 offen offset:1024 sc1
v_pk_add_f32 v[148:149], v[148:149], v[60:61]
v_pk_fma_f32 v[146:147], v[46:47], v[46:47], v[146:147]
v_pk_add_f32 v[144:145], v[144:145], v[46:47]
v_pk_fma_f32 v[150:151], v[62:63], v[62:63], v[150:151]
.Lpad22:
s_cbranch_execz .Lpad25
v_pk_add_f32 v[148:149], v[148:149], v[62:63]
v_add_f32 v144, v144, v145
v_add_f32 v146, v146, v147
v_add_f32 v148, v148, v149
v_add_f32 v150, v150, v151
s_nop 0
v_permlane16_swap_b32 v144, v148
buffer_store_dwordx4 v[140:143], v4, s[16:19], s63 offen offset:1024 sc1
v_permlane16_swap_b32 v146, v150
v_add_f32 v144, v144, v148
v_add_f32 v146, v146, v150
s_nop 1
v_permlane32_swap_b32 v144, v146
v_add_f32 v144, v144, v146
s_nop 1
v_permlane32_swap_b32 v144, v145
buffer_store_dwordx2 v[144:145], v152, s[16:19], s64 offen sc1
s_nop 1
v_accvgpr_write_b32 a224, v32
v_accvgpr_write_b32 a225, v33
v_accvgpr_write_b32 a226, v34
v_accvgpr_write_b32 a227, v35
v_accvgpr_write_b32 a228, v36
v_accvgpr_write_b32 a229, v37
v_accvgpr_write_b32 a230, v38
v_accvgpr_write_b32 a231, v39
v_accvgpr_write_b32 a232, v40
v_accvgpr_write_b32 a233, v41
v_accvgpr_write_b32 a234, v42
v_accvgpr_write_b32 a235, v43
v_accvgpr_write_b32 a236, v44
v_accvgpr_write_b32 a237, v45
v_accvgpr_write_b32 a238, v46
v_accvgpr_write_b32 a239, v47
v_accvgpr_write_b32 a240, v48
v_accvgpr_write_b32 a241, v49
v_accvgpr_write_b32 a242, v50
v_accvgpr_write_b32 a243, v51
v_accvgpr_write_b32 a244, v52
v_accvgpr_write_b32 a245, v53
v_accvgpr_write_b32 a246, v54
v_accvgpr_write_b32 a247, v55
v_accvgpr_write_b32 a248, v56
v_accvgpr_write_b32 a249, v57
v_accvgpr_write_b32 a250, v58
v_accvgpr_write_b32 a251, v59
v_accvgpr_write_b32 a252, v60
v_accvgpr_write_b32 a253, v61
v_accvgpr_write_b32 a254, v62
v_accvgpr_write_b32 a255, v63
s_lshl_b32 s62, s10, 14
s_lshl_b32 s63, s3, 12
s_add_u32 s62, s62, s63
s_lshl_b32 s63, s12, 11
s_add_u32 s62, s62, s63
v_lshl_add_u32 v10, v1, 4, s62
v_lshrrev_b32 v2, 3, v1
v_cmp_eq_u32 vcc, 3, v2
v_add_u32 v2, 67108480, v10
s_nop 0
v_cndmask_b32 v10, v10, v2, vcc
v_xor_b32 v11, 2048, v10
v_bfe_u32 v16, v1, 2, 3
v_mul_u32_u24 v16, 1056, v16
v_bfe_u32 v2, v1, 5, 1
v_lshl_add_u32 v16, v2, 8, v16
v_and_b32 v2, 3, v1
v_lshl_add_u32 v16, v2, 3, v16
s_lshl_b32 s62, s12, 6
s_add_u32 s62, s62, 84480
s_xor_b32 s63, s12, 1
s_mul_i32 s63, s63, 192
s_add_u32 s63, s63, 84480
v_add_u32 v17, s63, v16
v_add_u32 v16, s62, v16
s_mov_b32 s52, 41943040
s_mov_b32 s53, 41943040
s_mov_b32 s54, s58
s_mov_b32 s55, s59
s_mul_i32 s59, s3, 2112
s_and_b32 s62, s7, 1
s_mul_i32 s62, s62, 3670016
s_lshr_b32 s63, s7, 1
s_lshl_b32 s63, s63, 8
s_add_u32 s62, s62, s63
s_lshl_b32 s63, s3, 12
s_add_u32 s62, s62, s63
v_lshrrev_b32 v5, 4, v1
v_lshlrev_b32 v5, 14, v5
v_and_b32 v2, 15, v1
v_lshl_add_u32 v5, v2, 4, v5
v_add_u32 v5, s62, v5
v_add_u32 v6, 992, v5
s_lshl_b32 s62, s10, 15
s_lshl_b32 s63, s3, 13
s_add_u32 s62, s62, s63
v_lshl_add_u32 v4, v1, 4, s62
s_lshl_b32 s62, s6, 10
s_add_u32 s62, s62, 30507008
s_lshl_b32 s64, s10, 1
s_lshl_b32 s64, s64, 10
s_add_u32 s64, s64, 30507008
s_lshr_b32 s67, s5, 2
s_and_b32 s67, s67, 3
s_lshl_b32 s67, s67, 7
s_add_u32 s64, s64, s67
s_add_u32 s65, s64, 1024
v_lshl_add_u32 v252, v1, 7, s62
v_mov_b32 v253, s64
v_mov_b32 v255, 1
v_writelane_b32 v253, s65, 1
s_waitcnt vmcnt(0) lgkmcnt(0)
s_cmp_lg_u32 s3, 1
s_barrier
s_cbranch_scc1 .Lnopoll63
s_mov_b64 exec, 15
buffer_atomic_add v255, v252, s[16:19], 0 offen
s_mov_b64 exec, 3
v_mov_b32 v254, 0
buffer_atomic_add v254, v253, s[16:19], 0 offen sc0
s_sleep 5
s_mov_b32 s15, 0
.Lpoll62:
v_mov_b32 v255, 0
buffer_atomic_add v255, v253, s[16:19], 0 offen sc0
s_waitcnt vmcnt(1)
v_cmp_gt_u32 vcc, 16, v254
s_add_u32 s15, s15, 1
s_cbranch_vccz .Lnopoll63r
v_mov_b32 v254, 0
buffer_atomic_add v254, v253, s[16:19], 0 offen sc0
s_waitcnt vmcnt(1)
v_cmp_gt_u32 vcc, 16, v255
s_add_u32 s15, s15, 1
s_cbranch_vccz .Lnopoll63r
s_cmp_le_u32 s15, 100000
s_cbranch_scc1 .Lpoll62
s_branch .Lnopoll63r
.Lnopoll63:
s_mov_b64 exec, 0
s_cmp_eq_u32 s3, 2
s_cbranch_scc1 .Lpad27
s_cmp_eq_u32 s3, 3
s_cbranch_scc1 .Lpad28
s_branch .Lpad29
.Lnopoll63r:
s_mov_b64 exec, -1
s_barrier
buffer_load_dwordx4 a[128:131], v10, s[16:19], s52 offen sc1
buffer_load_dwordx4 a[132:135], v10, s[16:19], s52 offen offset:1024 sc1
s_add_u32 s52, s52, 131072
buffer_load_dwordx4 a[144:147], v10, s[16:19], s52 offen sc1
buffer_load_dwordx4 a[148:151], v10, s[16:19], s52 offen offset:1024 sc1
s_add_u32 s52, s52, 131072
buffer_load_dwordx4 a[136:139], v11, s[16:19], s53 offen sc1
buffer_load_dwordx4 a[140:143], v11, s[16:19], s53 offen offset:1024 sc1
s_add_u32 s53, s53, 131072
buffer_load_dwordx4 a[152:155], v11, s[16:19], s53 offen sc1
buffer_load_dwordx4 a[156:159], v11, s[16:19], s53 offen offset:1024 sc1
s_add_u32 s53, s53, 131072
ds_read_b64_tr_b16 a[0:1], v16
TR 2,16,512
TR 4,16,8448
TR 6,16,8960
TR 8,16,32
TR 10,16,544
TR 12,16,8480
TR 14,16,8992
TR 16,16,64
TR 18,16,576
TR 20,16,8512
TR 22,16,9024
TR 24,16,96
TR 26,16,608
TR 28,16,8544
TR 30,16,9056
TR 32,16,128
TR 34,16,640
TR 36,16,8576
TR 38,16,9088
TR 40,16,160
TR 42,16,672
TR 44,16,8608
TR 46,16,9120
ds_read_b64_tr_b16 a[48:49], v17
TR 50,17,512
TR 52,17,8448
TR 54,17,8960
TR 56,17,32
TR 58,17,544
TR 60,17,8480
TR 62,17,8992
s_add_u32 m0, s55, 135168
s_nop 0
buffer_load_dwordx4 v12, s[80:83], s54 offen   lds
buffer_load_dwordx4 v13, s[80:83], s54 offen offset:1056   lds
buffer_load_dwordx4 v14, s[80:83], s54 offen offset:2112   lds
buffer_load_dwordx4 v15, s[80:83], s54 offen offset:3168   lds
s_add_u32 s54, s54, 458752
s_lshl_b32 s57, s3, 13
s_add_u32 s57, s57, 49920
v_lshl_add_u32 v2, v1, 4, s57
s_waitcnt lgkmcnt(0)
s_barrier
s_waitcnt vmcnt(11)
v_mfma_f32_16x16x32_bf16 v[32:35], a[0:3], a[128:131], 0
buffer_load_dwordx4 a[160:163], v10, s[16:19], s52 offen sc1
s_waitcnt vmcnt(10)
MAA 32,4,144
TR 64,16,16896
v_mfma_f32_16x16x32_bf16 v[36:39], a[0:3], a[132:135], 0
TR 66,16,17408
s_waitcnt vmcnt(9)
MAA 36,4,148
TR 68,16,25344
v_mfma_f32_16x16x32_bf16 v[52:55], a[8:11], a[132:135], 0
buffer_load_dwordx4 a[164:167], v10, s[16:19], s52 offen offset:1024 sc1
MAA 52,12,148
TR 70,16,25856
s_add_u32 s52, s52, 131072
v_mfma_f32_16x16x32_bf16 v[48:51], a[8:11], a[128:131], 0
TR 72,16,16928
MAA 48,12,144
TR 74,16,17440
v_mfma_f32_16x16x32_bf16 v[96:99], a[16:19], a[128:131], 0
buffer_load_dwordx4 a[176:179], v10, s[16:19], s52 offen sc1
MAA 96,20,144
TR 76,16,25376
v_mfma_f32_16x16x32_bf16 v[100:103], a[16:19], a[132:135], 0
TR 78,16,25888
MAA 100,20,148
TR 80,16,16960
v_mfma_f32_16x16x32_bf16 v[116:119], a[24:27], a[132:135], 0
buffer_load_dwordx4 a[180:183], v10, s[16:19], s52 offen offset:1024 sc1
MAA 116,28,148
TR 82,16,17472
s_add_u32 s52, s52, 131072
v_mfma_f32_16x16x32_bf16 v[112:115], a[24:27], a[128:131], 0
TR 84,16,25408
MAA 112,28,144
TR 86,16,25920
v_mfma_f32_16x16x32_bf16 v[160:163], a[32:35], a[128:131], 0
buffer_load_dwordx4 a[168:171], v11, s[16:19], s53 offen sc1
MAA 160,36,144
TR 88,16,16992
v_mfma_f32_16x16x32_bf16 v[164:167], a[32:35], a[132:135], 0
TR 90,16,17504
MAA 164,36,148
TR 92,16,25440
v_mfma_f32_16x16x32_bf16 v[180:183], a[40:43], a[132:135], 0
buffer_load_dwordx4 a[172:175], v11, s[16:19], s53 offen offset:1024 sc1
MAA 180,44,148
TR 94,16,25952
s_add_u32 s53, s53, 131072
v_mfma_f32_16x16x32_bf16 v[176:179], a[40:43], a[128:131], 0
TR 96,16,17024
MAA 176,44,144
TR 98,16,17536
v_mfma_f32_16x16x32_bf16 v[224:227], a[48:51], a[128:131], 0
buffer_load_dwordx4 a[184:187], v11, s[16:19], s53 offen sc1
MAA 224,52,144
TR 100,16,25472
v_mfma_f32_16x16x32_bf16 v[228:231], a[48:51], a[132:135], 0
TR 102,16,25984
MAA 228,52,148
TR 104,16,17056
v_mfma_f32_16x16x32_bf16 v[236:239], a[56:59], a[132:135], 0
buffer_load_dwordx4 a[188:191], v11, s[16:19], s53 offen offset:1024 sc1
MAA 236,60,148
TR 106,16,17568
s_add_u32 s53, s53, 131072
v_mfma_f32_16x16x32_bf16 v[232:235], a[56:59], a[128:131], 0
TR 108,16,25504
s_add_u32 m0, s55, 84480
MAA 232,60,144
TR 110,16,26016
s_waitcnt vmcnt(12)
v_mfma_f32_16x16x32_bf16 v[188:191], a[40:43], a[140:143], 0
buffer_load_dwordx4 v12, s[32:35], s54 offen   lds
MAA 188,44,156
TR 112,17,16896
v_mfma_f32_16x16x32_bf16 v[184:187], a[40:43], a[136:139], 0
TR 114,17,17408
MAA 184,44,152
TR 116,17,25344
v_mfma_f32_16x16x32_bf16 v[168:171], a[32:35], a[136:139], 0
buffer_load_dwordx4 v13, s[32:35], s54 offen offset:1056   lds
MAA 168,36,152
TR 118,17,25856
v_mfma_f32_16x16x32_bf16 v[172:175], a[32:35], a[140:143], 0
TR 120,17,16928
MAA 172,36,156
TR 122,17,17440
v_mfma_f32_16x16x32_bf16 v[124:127], a[24:27], a[140:143], 0
buffer_load_dwordx4 v14, s[32:35], s54 offen offset:2112   lds
MAA 124,28,156
TR 124,17,25376
v_mfma_f32_16x16x32_bf16 v[120:123], a[24:27], a[136:139], 0
TR 126,17,25888
MAA 120,28,152
v_mfma_f32_16x16x32_bf16 v[104:107], a[16:19], a[136:139], 0
buffer_load_dwordx4 v15, s[32:35], s54 offen offset:3168   lds
MAA 104,20,152
v_mfma_f32_16x16x32_bf16 v[108:111], a[16:19], a[140:143], 0
MAA 108,20,156
v_mfma_f32_16x16x32_bf16 v[60:63], a[8:11], a[140:143], 0
MAA 60,12,156
v_mfma_f32_16x16x32_bf16 v[56:59], a[8:11], a[136:139], 0
MAA 56,12,152
v_mfma_f32_16x16x32_bf16 v[40:43], a[0:3], a[136:139], 0
MAA 40,4,152
v_mfma_f32_16x16x32_bf16 v[44:47], a[0:3], a[140:143], 0
MAA 44,4,156
s_waitcnt lgkmcnt(0)
s_barrier
v_mfma_f32_16x16x32_bf16 v[64:67], a[64:67], a[128:131], 0
TR 0,16,33792
s_add_u32 m0, s55, 101376
MAA 64,68,144
buffer_load_dwordx4 v12, s[80:83], s54 offen   lds
v_mfma_f32_16x16x32_bf16 v[68:71], a[64:67], a[132:135], 0
TR 2,16,34304
s_mul_i32 s66, s13, 114688
MAA 68,68,148
TR 4,16,42240
s_mul_i32 s65, s10, 1818624
v_mfma_f32_16x16x32_bf16 v[84:87], a[72:75], a[132:135], 0
TR 6,16,42752
s_add_u32 s66, s66, s65
MAA 84,76,148
TR 8,16,33824
s_add_u32 s66, s66, 46137344
v_mfma_f32_16x16x32_bf16 v[80:83], a[72:75], a[128:131], 0
buffer_load_dwordx4 v13, s[80:83], s54 offen offset:1056   lds
MAA 80,76,144
TR 10,16,34336
s_add_u32 s65, s66, 49152
v_mfma_f32_16x16x32_bf16 v[128:131], a[80:83], a[128:131], 0
TR 12,16,42272
s_lshl_b32 s62, s12, 16
MAA 128,84,144
TR 14,16,42784
s_add_u32 s62, s62, s66
v_mfma_f32_16x16x32_bf16 v[132:135], a[80:83], a[132:135], 0
TR 16,16,33856
s_add_u32 s63, s62, 16384
MAA 132,84,148
buffer_load_dwordx4 v14, s[80:83], s54 offen offset:2112   lds
v_mfma_f32_16x16x32_bf16 v[148:151], a[88:91], a[132:135], 0
TR 18,16,34368
s_add_u32 s64, s62, 32768
MAA 148,92,148
TR 20,16,42304
s_lshl_b32 s72, s10, 1
v_mfma_f32_16x16x32_bf16 v[144:147], a[88:91], a[128:131], 0
TR 22,16,42816
s_lshr_b32 s74, s11, 4
MAA 144,92,144
TR 24,16,33888
s_add_u32 s72, s72, s74
v_mfma_f32_16x16x32_bf16 v[192:195], a[96:99], a[128:131], 0
buffer_load_dwordx4 v15, s[80:83], s54 offen offset:3168   lds
MAA 192,100,144
TR 26,16,34400
s_add_u32 s54, s54, 458752
v_mfma_f32_16x16x32_bf16 v[196:199], a[96:99], a[132:135], 0
TR 28,16,42336
s_add_u32 m0, s57, 0
MAA 196,100,148
TR 30,16,42848
s_mov_b32 s58, 63176704
v_mfma_f32_16x16x32_bf16 v[212:215], a[104:107], a[132:135], 0
TR 32,16,33920
s_lshl_b32 s72, s72, 10
MAA 212,108,148
buffer_load_dwordx4 v4, s[16:19], s58 offen sc1 lds
v_mfma_f32_16x16x32_bf16 v[208:211], a[104:107], a[128:131], 0
TR 34,16,34432
s_add_u32 s72, s72, 30523392
MAA 208,108,144
TR 36,16,42368
s_and_b32 s73, s6, 14
v_mfma_f32_16x16x32_bf16 v[240:243], a[112:115], a[128:131], 0
TR 38,16,42880
s_and_b32 s74, s7, 1
MAA 240,116,144
TR 40,16,33952
s_add_u32 s73, s73, s74
v_mfma_f32_16x16x32_bf16 v[244:247], a[112:115], a[132:135], 0
buffer_load_dwordx4 v4, s[16:19], s58 offen offset:1024 sc1 lds
MAA 244,116,148
TR 42,16,34464
s_lshl_b32 s73, s73, 10
v_mfma_f32_16x16x32_bf16 v[252:255], a[120:123], a[132:135], 0
TR 44,16,42400
s_add_u32 s73, s73, 30523392
MAA 252,124,148
TR 46,16,42912
s_lshr_b32 s67, s5, 2
v_mfma_f32_16x16x32_bf16 v[248:251], a[120:123], a[128:131], 0
TR 48,17,33792
s_and_b32 s67, s67, 3
MAA 248,124,144
buffer_load_dwordx4 a[128:131], v10, s[16:19], s52 offen sc1
v_mfma_f32_16x16x32_bf16 v[220:223], a[104:107], a[140:143], 0
TR 50,17,34304
s_lshl_b32 s67, s67, 7
MAA 220,108,156
TR 52,17,42240
s_add_u32 s73, s73, s67
v_mfma_f32_16x16x32_bf16 v[216:219], a[104:107], a[136:139], 0
TR 54,17,42752
MAA 216,108,152
TR 56,17,33824
v_mfma_f32_16x16x32_bf16 v[200:203], a[96:99], a[136:139], 0
buffer_load_dwordx4 a[132:135], v10, s[16:19], s52 offen offset:1024 sc1
MAA 200,100,152
TR 58,17,34336
s_add_u32 s52, s52, 131072
v_mfma_f32_16x16x32_bf16 v[204:207], a[96:99], a[140:143], 0
TR 60,17,42272
MAA 204,100,156
TR 62,17,42784
v_mfma_f32_16x16x32_bf16 v[156:159], a[88:91], a[140:143], 0
MAA 156,92,156
buffer_load_dwordx4 a[144:147], v10, s[16:19], s52 offen sc1
v_mfma_f32_16x16x32_bf16 v[152:155], a[88:91], a[136:139], 0
MAA 152,92,152
v_mfma_f32_16x16x32_bf16 v[136:139], a[80:83], a[136:139], 0
MAA 136,84,152
v_mfma_f32_16x16x32_bf16 v[140:143], a[80:83], a[140:143], 0
buffer_load_dwordx4 a[148:151], v10, s[16:19], s52 offen offset:1024 sc1
MAA 140,84,156
s_add_u32 s52, s52, 131072
v_mfma_f32_16x16x32_bf16 v[92:95], a[72:75], a[140:143], 0
MAA 92,76,156
v_mfma_f32_16x16x32_bf16 v[88:91], a[72:75], a[136:139], 0
MAA 88,76,152
v_mfma_f32_16x16x32_bf16 v[72:75], a[64:67], a[136:139], 0
MAA 72,68,152
v_mfma_f32_16x16x32_bf16 v[76:79], a[64:67], a[140:143], 0
MAA 76,68,156
s_waitcnt vmcnt(18) lgkmcnt(0)
s_barrier
MAA 32,0,160
buffer_load_dwordx4 a[136:139], v11, s[16:19], s53 offen sc1
MAA 32,4,176
TR 64,16,50688
s_and_b32 s74, s7, 1
MAA 36,4,180
TR 66,16,51200
s_mul_i32 s87, s74, 917504
MAA 36,0,164
TR 68,16,59136
s_lshr_b32 s75, s6, 1
MAA 52,8,164
TR 70,16,59648
s_mul_i32 s75, s75, 1818624
MAA 52,12,180
buffer_load_dwordx4 a[140:143], v11, s[16:19], s53 offen offset:1024 sc1
MAA 48,12,176
TR 72,16,50720
s_add_u32 s53, s53, 131072
MAA 48,8,160
TR 74,16,51232
s_add_u32 s87, s87, s75
MAA 96,16,160
TR 76,16,59168
s_add_u32 s87, s87, 46137344
MAA 96,20,176
TR 78,16,59680
s_and_b32 s74, s6, 3
MAA 100,20,180
buffer_load_dwordx4 a[152:155], v11, s[16:19], s53 offen sc1
MAA 100,16,164
TR 80,16,50752
s_xor_b32 s75, s74, 0
MAA 116,24,164
TR 82,16,51264
s_sub_u32 s75, s75, 0
MAA 116,28,180
TR 84,16,59200
s_mul_i32 s98, s75, 458752
MAA 112,28,176
TR 86,16,59712
s_mul_i32 s75, s75, 114688
MAA 112,24,160
buffer_load_dwordx4 a[156:159], v11, s[16:19], s53 offen offset:1024 sc1
MAA 160,32,160
TR 88,16,50784
s_add_u32 s53, s53, 131072
MAA 160,36,176
TR 90,16,51296
s_add_u32 m0, s55, 118272
MAA 164,36,180
TR 92,16,59232
s_add_u32 s76, s87, s75
MAA 164,32,164
TR 94,16,59744
s_xor_b32 s75, s74, 1
MAA 180,40,164
buffer_load_dwordx4 v12, s[32:35], s54 offen   lds
MAA 180,44,180
TR 96,16,50816
s_sub_u32 s75, s75, 1
MAA 176,44,176
TR 98,16,51328
s_mul_i32 s99, s75, 458752
MAA 176,40,160
TR 100,16,59264
s_mul_i32 s75, s75, 114688
MAA 224,48,160
TR 102,16,59776
s_add_u32 s77, s87, s75
MAA 224,52,176
buffer_load_dwordx4 v13, s[32:35], s54 offen offset:1056   lds
MAA 228,52,180
TR 104,16,50848
s_xor_b32 s75, s74, 2
MAA 228,48,164
TR 106,16,51360
s_sub_u32 s75, s75, 2
MAA 236,56,164
TR 108,16,59296
s_mul_i32 s100, s75, 458752
MAA 236,60,180
TR 110,16,59808
s_mul_i32 s75, s75, 114688
MAA 232,60,176
buffer_load_dwordx4 v14, s[32:35], s54 offen offset:2112   lds
MAA 232,56,160
TR 112,17,50688
s_add_u32 s78, s87, s75
s_waitcnt vmcnt(21)
MAA 188,40,172
TR 114,17,51200
s_xor_b32 s75, s74, 3
MAA 188,44,188
TR 116,17,59136
MAA 184,44,184
TR 118,17,59648
MAA 184,40,168
buffer_load_dwordx4 v15, s[32:35], s54 offen offset:3168   lds
MAA 168,32,168
TR 120,17,50720
s_add_u32 m0, s57, 2048
MAA 168,36,184
TR 122,17,51232
s_mov_b32 s58, 63178752
MAA 172,36,188
TR 124,17,59168
MAA 172,32,172
TR 126,17,59680
MAA 124,24,172
buffer_load_dwordx4 v4, s[16:19], s58 offen sc1 lds
MAA 124,28,188
MAA 120,28,184
MAA 120,24,168
MAA 104,16,168
MAA 104,20,184
buffer_load_dwordx4 v4, s[16:19], s58 offen offset:1024 sc1 lds
MAA 108,20,188
MAA 108,16,172
MAA 60,8,172
MAA 60,12,188
MAA 56,12,184
MAA 56,8,168
MAA 40,0,168
MAA 40,4,184
MAA 44,4,188
MAA 44,0,172
s_waitcnt vmcnt(20) lgkmcnt(0)
s_barrier
MAA 64,64,160
ds_read_b64_tr_b16 a[0:1], v16
s_add_u32 m0, s55, 135168
MAA 64,68,176
buffer_load_dwordx4 v12, s[80:83], s54 offen   lds
.Lpad23:
s_cbranch_execz .Lpad26
MAA 68,68,180
TR 2,16,512
s_sub_u32 s75, s75, 3
MAA 68,64,164
TR 4,16,8448
s_mul_i32 s101, s75, 458752
MAA 84,72,164
TR 6,16,8960
s_mul_i32 s75, s75, 114688
MAA 84,76,180
TR 8,16,32
s_add_u32 s79, s87, s75
MAA 80,76,176
buffer_load_dwordx4 v13, s[80:83], s54 offen offset:1056   lds
MAA 80,72,160
TR 10,16,544
s_and_b32 s87, s6, 3
MAA 128,80,160
TR 12,16,8480
s_mov_b32 s46, 0
MAA 128,84,176
TR 14,16,8992
s_lshl_b32 s74, s3, 10
MAA 132,84,180
TR 16,16,64
s_lshl_b32 s75, s12, 9
MAA 132,80,164
buffer_load_dwordx4 v14, s[80:83], s54 offen offset:2112   lds
MAA 148,88,164
TR 18,16,576
s_add_u32 s74, s74, s75
MAA 148,92,180
TR 20,16,8512
s_add_u32 s74, s74, 152576
MAA 144,92,176
TR 22,16,9024
v_and_b32 v18, 15, v1
MAA 144,88,160
TR 24,16,96
v_lshl_add_u32 v18, v18, 4, s74
MAA 192,96,160
buffer_load_dwordx4 v15, s[80:83], s54 offen offset:3168   lds
MAA 192,100,176
TR 26,16,608
s_add_u32 s54, s54, 458752
MAA 196,100,180
TR 28,16,8544
s_add_u32 m0, s57, 4096
MAA 196,96,164
TR 30,16,9056
s_mov_b32 s58, 63180800
MAA 212,104,164
TR 32,16,128
v_xor_b32 v19, 512, v18
MAA 212,108,180
buffer_load_dwordx4 v4, s[16:19], s58 offen sc1 lds
MAA 208,108,176
TR 34,16,640
s_lshl_b32 s74, s12, 7
MAA 208,104,160
TR 36,16,8576
s_add_u32 s74, s74, 161536
MAA 240,112,160
TR 38,16,9088
s_xor_b32 s75, s12, 1
MAA 240,116,176
TR 40,16,160
s_mul_i32 s75, s75, 384
MAA 244,116,180
buffer_load_dwordx4 v4, s[16:19], s58 offen offset:1024 sc1 lds
MAA 244,112,164
TR 42,16,672
s_add_u32 s75, s75, 161536
MAA 252,120,164
TR 44,16,8608
v_lshrrev_b32 v9, 4, v1
MAA 252,124,180
TR 46,16,9120
v_lshlrev_b32 v9, 4, v9
MAA 248,124,176
ds_read_b64_tr_b16 a[48:49], v17
v_add_u32 v8, s75, v9
MAA 248,120,160
buffer_load_dwordx4 a[160:163], v10, s[16:19], s52 offen sc1
MAA 220,104,172
TR 50,17,512
v_add_u32 v9, s74, v9
MAA 220,108,188
TR 52,17,8448
MAA 216,108,184
TR 54,17,8960
MAA 216,104,168
TR 56,17,32
MAA 200,96,168
buffer_load_dwordx4 a[164:167], v10, s[16:19], s52 offen offset:1024 sc1
MAA 200,100,184
TR 58,17,544
s_add_u32 s52, s52, 131072
MAA 204,100,188
TR 60,17,8480
MAA 204,96,172
TR 62,17,8992
MAA 156,88,172
MAA 156,92,188
buffer_load_dwordx4 a[176:179], v10, s[16:19], s52 offen sc1
MAA 152,92,184
MAA 152,88,168
MAA 136,80,168
MAA 136,84,184
MAA 140,84,188
buffer_load_dwordx4 a[180:183], v10, s[16:19], s52 offen offset:1024 sc1
MAA 140,80,172
s_add_u32 s52, s52, 131072
MAA 92,72,172
MAA 92,76,188
MAA 88,76,184
MAA 88,72,168
MAA 72,64,168
MAA 72,68,184
MAA 76,68,188
MAA 76,64,172
s_waitcnt vmcnt(20) lgkmcnt(0)
s_barrier
MAA 32,0,128
buffer_load_dwordx4 a[168:171], v11, s[16:19], s53 offen sc1
MAA 32,4,144
ds_read_b128 v[20:23], v2
MAA 36,4,148
ds_read_b128 v[28:31], v2 offset:1024
MAA 36,0,132
s_waitcnt vmcnt(11)
ds_read_b128 v[24:27], v2 offset:2048
MAA 52,8,132
TR 64,16,16896
MAA 52,12,148
buffer_load_dwordx4 a[172:175], v11, s[16:19], s53 offen offset:1024 sc1
MAA 48,12,144
TR 66,16,17408
s_add_u32 s53, s53, 131072
MAA 48,8,128
TR 68,16,25344
MAA 96,16,128
TR 70,16,25856
MAA 96,20,144
TR 72,16,16928
MAA 100,20,148
buffer_load_dwordx4 a[184:187], v11, s[16:19], s53 offen sc1
MAA 100,16,132
TR 74,16,17440
s_waitcnt lgkmcnt(7)
v_add_f32 v20, v20, v28
MAA 116,24,132
TR 76,16,25376
v_add_f32 v21, v21, v29
MAA 116,28,148
TR 78,16,25888
v_add_f32 v22, v22, v30
MAA 112,28,144
TR 80,16,16960
v_add_f32 v23, v23, v31
MAA 112,24,128
buffer_load_dwordx4 a[188:191], v11, s[16:19], s53 offen offset:1024 sc1
MAA 160,32,128
ds_read_b128 v[28:31], v2 offset:3072
s_add_u32 s53, s53, 131072
MAA 160,36,144
TR 82,16,17472
s_add_u32 m0, s55, 84480
MAA 164,36,148
TR 84,16,25408
s_waitcnt lgkmcnt(12)
v_add_f32 v20, v20, v24
MAA 164,32,132
TR 86,16,25920
v_add_f32 v21, v21, v25
MAA 180,40,132
buffer_load_dwordx4 v12, s[32:35], s54 offen   lds
MAA 180,44,148
TR 88,16,16992
v_add_f32 v22, v22, v26
MAA 176,44,144
TR 90,16,17504
v_add_f32 v23, v23, v27
MAA 176,40,128
TR 92,16,25440
MAA 224,48,128
TR 94,16,25952
MAA 224,52,144
buffer_load_dwordx4 v13, s[32:35], s54 offen offset:1056   lds
MAA 228,52,148
TR 96,16,17024
MAA 228,48,132
TR 98,16,17536
MAA 236,56,132
TR 100,16,25472
MAA 236,60,148
TR 102,16,25984
MAA 232,60,144
buffer_load_dwordx4 v14, s[32:35], s54 offen offset:2112   lds
MAA 232,56,128
TR 104,16,17056
MAA 188,40,140
TR 106,16,17568
MAA 188,44,156
TR 108,16,25504
MAA 184,44,152
TR 110,16,26016
MAA 184,40,136
buffer_load_dwordx4 v15, s[32:35], s54 offen offset:3168   lds
MAA 168,32,136
TR 112,17,16896
s_add_u32 m0, s57, 6144
MAA 168,36,152
TR 114,17,17408
s_mov_b32 s58, 63182848
MAA 172,36,156
TR 116,17,25344
MAA 172,32,140
TR 118,17,25856
MAA 124,24,140
buffer_load_dwordx4 v4, s[16:19], s58 offen sc1 lds
MAA 124,28,156
TR 120,17,16928
MAA 120,28,152
TR 122,17,17440
MAA 120,24,136
TR 124,17,25376
MAA 104,16,136
TR 126,17,25888
MAA 104,20,152
buffer_load_dwordx4 v4, s[16:19], s58 offen offset:1024 sc1 lds
MAA 108,20,156
MAA 108,16,140
MAA 60,8,140
MAA 60,12,156
MAA 56,12,152
MAA 56,8,136
MAA 40,0,136
MAA 40,4,152
MAA 44,4,156
MAA 44,0,140
s_waitcnt lgkmcnt(0)
s_barrier
MAA 64,64,128
s_waitcnt vmcnt(14)
ds_read_b128 v[24:27], v2 offset:4096
s_add_u32 m0, s55, 101376
MAA 64,68,144
buffer_load_dwordx4 v12, s[80:83], s54 offen   lds
MAA 68,68,148
TR 0,16,33792
v_add_f32 v20, v20, v28
MAA 68,64,132
TR 2,16,34304
v_add_f32 v21, v21, v29
MAA 84,72,132
TR 4,16,42240
v_add_f32 v22, v22, v30
MAA 84,76,148
TR 6,16,42752
v_add_f32 v23, v23, v31
MAA 80,76,144
ds_read_b128 v[28:31], v2 offset:5120
MAA 80,72,128
TR 8,16,33824
MAA 128,80,128
buffer_load_dwordx4 v13, s[80:83], s54 offen offset:1056   lds
MAA 128,84,144
TR 10,16,34336
s_waitcnt lgkmcnt(7)
v_add_f32 v20, v20, v24
MAA 132,84,148
TR 12,16,42272
v_add_f32 v21, v21, v25
MAA 132,80,132
TR 14,16,42784
v_add_f32 v22, v22, v26
MAA 148,88,132
TR 16,16,33856
v_add_f32 v23, v23, v27
MAA 148,92,148
TR 18,16,34368
MAA 144,92,144
TR 20,16,42304
MAA 144,88,128
buffer_load_dwordx4 v14, s[80:83], s54 offen offset:2112   lds
MAA 192,96,128
TR 22,16,42816
MAA 192,100,144
TR 24,16,33888
MAA 196,100,148
TR 26,16,34400
MAA 196,96,132
TR 28,16,42336
MAA 212,104,132
TR 30,16,42848
MAA 212,108,148
TR 32,16,33920
MAA 208,108,144
buffer_load_dwordx4 v15, s[80:83], s54 offen offset:3168   lds
MAA 208,104,128
TR 34,16,34432
s_add_u32 s54, s54, 458752
MAA 240,112,128
TR 36,16,42368
MAA 240,116,144
TR 38,16,42880
MAA 244,116,148
TR 40,16,33952
MAA 244,112,132
TR 42,16,34464
MAA 252,120,132
TR 44,16,42400
MAA 252,124,148
TR 46,16,42912
MAA 248,124,144
TR 48,17,33792
MAA 248,120,128
buffer_load_dwordx4 a[128:131], v10, s[16:19], s52 offen sc1
MAA 220,104,140
TR 50,17,34304
MAA 220,108,156
TR 52,17,42240
MAA 216,108,152
TR 54,17,42752
MAA 216,104,136
TR 56,17,33824
MAA 200,96,136
TR 58,17,34336
MAA 200,100,152
TR 60,17,42272
MAA 204,100,156
buffer_load_dwordx4 a[132:135], v10, s[16:19], s52 offen offset:1024 sc1
MAA 204,96,140
TR 62,17,42784
s_add_u32 s52, s52, 131072
MAA 156,88,140
MAA 156,92,156
MAA 152,92,152
MAA 152,88,136
MAA 136,80,136
MAA 136,84,152
buffer_load_dwordx4 a[144:147], v10, s[16:19], s52 offen sc1
MAA 140,84,156
MAA 140,80,140
MAA 92,72,140
MAA 92,76,156
MAA 88,76,152
MAA 88,72,136
MAA 72,64,136
buffer_load_dwordx4 a[148:151], v10, s[16:19], s52 offen offset:1024 sc1
MAA 72,68,152
s_add_u32 s52, s52, 131072
MAA 76,68,156
MAA 76,64,140
s_waitcnt vmcnt(18) lgkmcnt(0)
s_barrier
MAA 32,0,160
buffer_load_dwordx4 a[136:139], v11, s[16:19], s53 offen sc1
MAA 32,4,176
s_waitcnt vmcnt(9)
ds_read_b128 v[24:27], v2 offset:6144
v_add_f32 v20, v20, v28
MAA 36,4,180
TR 64,16,50688
v_add_f32 v21, v21, v29
MAA 36,0,164
TR 66,16,51200
v_add_f32 v22, v22, v30
MAA 52,8,164
TR 68,16,59136
v_add_f32 v23, v23, v31
MAA 52,12,180
ds_read_b128 v[28:31], v2 offset:7168
MAA 48,12,176
TR 70,16,59648
MAA 48,8,160
buffer_load_dwordx4 a[140:143], v11, s[16:19], s53 offen offset:1024 sc1
MAA 96,16,160
TR 72,16,50720
s_add_u32 s53, s53, 131072
MAA 96,20,176
TR 74,16,51232
s_waitcnt lgkmcnt(7)
v_add_f32 v20, v20, v24
MAA 100,20,180
TR 76,16,59168
v_add_f32 v21, v21, v25
MAA 100,16,164
TR 78,16,59680
v_add_f32 v22, v22, v26
MAA 116,24,164
TR 80,16,50752
v_add_f32 v23, v23, v27
MAA 116,28,180
TR 82,16,51264
s_waitcnt lgkmcnt(7)
v_add_f32 v20, v20, v28
MAA 112,28,176
buffer_load_dwordx4 a[152:155], v11, s[16:19], s53 offen sc1
MAA 112,24,160
TR 84,16,59200
v_add_f32 v21, v21, v29
MAA 160,32,160
TR 86,16,59712
v_add_f32 v22, v22, v30
MAA 160,36,176
TR 88,16,50784
v_add_f32 v23, v23, v31
MAA 164,36,180
TR 90,16,51296
MAA 164,32,164
TR 92,16,59232
MAA 180,40,164
TR 94,16,59744
MAA 180,44,180
buffer_load_dwordx4 a[156:159], v11, s[16:19], s53 offen offset:1024 sc1
MAA 176,44,176
TR 96,16,50816
s_add_u32 s53, s53, 131072
MAA 176,40,160
TR 98,16,51328
s_add_u32 m0, s55, 118272
MAA 224,48,160
TR 100,16,59264
MAA 224,52,176
TR 102,16,59776
MAA 228,52,180
TR 104,16,50848
MAA 228,48,164
TR 106,16,51360
MAA 236,56,164
buffer_load_dwordx4 v12, s[32:35], s54 offen   lds
MAA 236,60,180
TR 108,16,59296
MAA 232,60,176
TR 110,16,59808
MAA 232,56,160
TR 112,17,50688
MAA 188,40,172
TR 114,17,51200
MAA 188,44,188
TR 116,17,59136
MAA 184,44,184
TR 118,17,59648
MAA 184,40,168
buffer_load_dwordx4 v13, s[32:35], s54 offen offset:1056   lds
MAA 168,32,168
TR 120,17,50720
MAA 168,36,184
TR 122,17,51232
MAA 172,36,188
TR 124,17,59168
MAA 172,32,172
TR 126,17,59680
MAA 124,24,172
MAA 124,28,188
MAA 120,28,184
buffer_load_dwordx4 v14, s[32:35], s54 offen offset:2112   lds
MAA 120,24,168
MAA 104,16,168
MAA 104,20,184
MAA 108,20,188
MAA 108,16,172
MAA 60,8,172
MAA 60,12,188
buffer_load_dwordx4 v15, s[32:35], s54 offen offset:3168   lds
MAA 56,12,184
MAA 56,8,168
MAA 40,0,168
MAA 40,4,184
MAA 44,4,188
MAA 44,0,172
s_waitcnt lgkmcnt(0)
s_barrier
MAA 64,64,160
ds_read_b64_tr_b16 a[0:1], v16
s_add_u32 m0, s55, 135168
MAA 64,68,176
buffer_load_dwordx4 v12, s[80:83], s54 offen   lds
MAA 68,68,180
TR 2,16,512
v_permlane32_swap_b32 v20, v22
MAA 68,64,164
TR 4,16,8448
v_permlane32_swap_b32 v21, v23
MAA 84,72,164
TR 6,16,8960
v_add_f32 v20, v20, v22
MAA 84,76,180
TR 8,16,32
v_add_f32 v21, v21, v23
MAA 80,76,176
TR 10,16,544
v_mul_f32 v20, 0xba800000, v20
MAA 80,72,160
buffer_load_dwordx4 v13, s[80:83], s54 offen offset:1056   lds
MAA 128,80,160
TR 12,16,8480
v_mul_f32 v21, 0x3a800000, v21
MAA 128,84,176
TR 14,16,8992
v_fma_f32 v21, -v20, v20, v21
MAA 132,84,180
TR 16,16,64
v_max_f32 v21, 0, v21
MAA 132,80,164
TR 18,16,576
v_add_f32 v21, 0x3727c5ac, v21
MAA 148,88,164
TR 20,16,8512
v_rsq_f32 v22, v21
MAA 148,92,180
buffer_load_dwordx4 v14, s[80:83], s54 offen offset:2112   lds
MAA 144,92,176
TR 22,16,9024
v_and_b32 v24, 31, v1
MAA 144,88,160
TR 24,16,96
v_lshrrev_b32 v25, 5, v1
MAA 192,96,160
TR 26,16,608
v_lshl_add_u32 v24, v24, 1, v25
MAA 192,100,176
TR 28,16,8544
v_and_b32 v25, 0xc0, v0
MAA 196,100,180
TR 30,16,9056
v_add_u32 v24, v24, v25
MAA 196,96,164
TR 32,16,128
v_lshlrev_b32 v24, 4, v24
MAA 212,104,164
buffer_load_dwordx4 v15, s[80:83], s54 offen offset:3168   lds
MAA 212,108,180
TR 34,16,640
s_add_u32 s54, s54, 458752
MAA 208,108,176
TR 36,16,8576
v_add_u32 v24, 152576, v24
MAA 208,104,160
TR 38,16,9088
v_mul_f32 v22, 0xbfb8aa3b, v22
MAA 240,112,160
ds_write_b128 v24, v[20:23]
.Lpad24:
s_cbranch_execz .Lnopoll60r
s_mov_b32 s58, s98
MAA 240,116,176
ds_read_b64 v[20:21], v18
s_mov_b32 s67, s59
MAA 244,116,180
ds_read_b64 v[22:23], v18 offset:256
MAA 244,112,164
ds_read_b64 v[24:25], v19
MAA 252,120,164
ds_read_b64 v[26:27], v19 offset:256
MAA 252,124,180
ds_read_b32 a192, v18 offset:8
MAA 248,124,176
ds_read_b32 a193, v18 offset:264
v_mov_b32 v18, v5
MAA 248,120,160
buffer_load_dwordx4 a[160:163], v10, s[16:19], s52 offen sc1
MAA 220,104,172
ds_read_b32 a194, v19 offset:8
MAA 220,108,188
ds_read_b32 a195, v19 offset:264
v_add_u32 v19, 992, v5
MAA 216,108,184
TR 40,16,160
MAA 216,104,168
TR 42,16,672
MAA 200,96,168
TR 44,16,8608
MAA 200,100,184
TR 46,16,9120
MAA 204,100,188
buffer_load_dwordx4 a[164:167], v10, s[16:19], s52 offen offset:1024 sc1
MAA 204,96,172
ds_read_b64_tr_b16 a[48:49], v17
s_add_u32 s52, s52, 131072
MAA 156,88,172
TR 50,17,512
MAA 156,92,188
TR 52,17,8448
MAA 152,92,184
TR 54,17,8960
MAA 152,88,168
TR 56,17,32
MAA 136,80,168
TR 58,17,544
MAA 136,84,184
buffer_load_dwordx4 a[176:179], v10, s[16:19], s52 offen sc1
MAA 140,84,188
TR 60,17,8480
MAA 140,80,172
TR 62,17,8992
MAA 92,72,172
MAA 92,76,188
MAA 88,76,184
MAA 88,72,168
MAA 72,64,168
buffer_load_dwordx4 a[180:183], v10, s[16:19], s52 offen offset:1024 sc1
MAA 72,68,184
s_add_u32 s52, s52, 131072
MAA 76,68,188
MAA 76,64,172
s_waitcnt vmcnt(16) lgkmcnt(0)
s_barrier
MAA 32,0,128
ds_read_b128 v[28:31], v9 offset:512
MAA 32,4,144
ds_read_b128 v[4:7], v9 offset:576
MAA 36,4,148
buffer_load_dwordx4 a[168:171], v11, s[16:19], s53 offen sc1
MAA 36,0,132
TR 64,16,16896
MAA 52,8,132
TR 66,16,17408
MAA 52,12,148
TR 68,16,25344
MAA 48,12,144
TR 70,16,25856
MAA 48,8,128
TR 72,16,16928
MAA 96,16,128
buffer_load_dwordx4 a[172:175], v11, s[16:19], s53 offen offset:1024 sc1
MAA 96,20,144
TR 74,16,17440
s_add_u32 s53, s53, 131072
MAA 100,20,148
TR 76,16,25376
s_waitcnt lgkmcnt(8)
v_fmac_f32 v64, v28, v20
MAA 100,16,132
TR 78,16,25888
v_fmac_f32 v65, v29, v20
MAA 116,24,132
TR 80,16,16960
v_fmac_f32 v66, v30, v20
MAA 116,28,148
TR 82,16,17472
v_fmac_f32 v67, v31, v20
MAA 112,28,144
buffer_load_dwordx4 a[184:187], v11, s[16:19], s53 offen sc1
MAA 112,24,128
TR 84,16,25408
v_fmac_f32 v68, v28, v22
MAA 160,32,128
TR 86,16,25920
v_fmac_f32 v69, v29, v22
MAA 160,36,144
TR 88,16,16992
v_fmac_f32 v70, v30, v22
MAA 164,36,148
TR 90,16,17504
v_fmac_f32 v71, v31, v22
MAA 164,32,132
TR 92,16,25440
v_fmac_f32 v72, v28, v24
MAA 180,40,132
buffer_load_dwordx4 a[188:191], v11, s[16:19], s53 offen offset:1024 sc1
MAA 180,44,148
TR 94,16,25952
s_add_u32 s53, s53, 131072
MAA 176,44,144
TR 96,16,17024
s_add_u32 m0, s55, 84480
MAA 176,40,128
TR 98,16,17536
v_fmac_f32 v73, v29, v24
MAA 224,48,128
TR 100,16,25472
v_fmac_f32 v74, v30, v24
MAA 224,52,144
TR 102,16,25984
v_fmac_f32 v75, v31, v24
MAA 228,52,148
buffer_load_dwordx4 v12, s[32:35], s54 offen   lds
MAA 228,48,132
TR 104,16,17056
v_fmac_f32 v76, v28, v26
MAA 236,56,132
TR 106,16,17568
v_fmac_f32 v77, v29, v26
MAA 236,60,148
TR 108,16,25504
v_fmac_f32 v78, v30, v26
MAA 232,60,144
TR 110,16,26016
v_fmac_f32 v79, v31, v26
MAA 232,56,128
ds_read_b128 v[28:31], v9 offset:640
s_waitcnt lgkmcnt(15)
v_fmac_f32 v80, v4, v20
s_waitcnt vmcnt(17)
MAA 188,40,140
buffer_load_dwordx4 v13, s[32:35], s54 offen offset:1056   lds
MAA 188,44,156
TR 112,17,16896
v_fmac_f32 v81, v5, v20
MAA 184,44,152
TR 114,17,17408
v_fmac_f32 v82, v6, v20
MAA 184,40,136
TR 116,17,25344
v_fmac_f32 v83, v7, v20
MAA 168,32,136
TR 118,17,25856
v_fmac_f32 v84, v4, v22
MAA 168,36,152
TR 120,17,16928
v_fmac_f32 v85, v5, v22
MAA 172,36,156
buffer_load_dwordx4 v14, s[32:35], s54 offen offset:2112   lds
MAA 172,32,140
TR 122,17,17440
v_fmac_f32 v86, v6, v22
MAA 124,24,140
TR 124,17,25376
v_fmac_f32 v87, v7, v22
MAA 124,28,156
TR 126,17,25888
v_fmac_f32 v88, v4, v24
MAA 120,28,152
v_fmac_f32 v89, v5, v24
v_fmac_f32 v90, v6, v24
MAA 120,24,136
v_fmac_f32 v91, v7, v24
v_fmac_f32 v92, v4, v26
MAA 104,16,136
buffer_load_dwordx4 v15, s[32:35], s54 offen offset:3168   lds
MAA 104,20,152
s_mov_b32 m0, s67
v_fmac_f32 v93, v5, v26
v_fmac_f32 v94, v6, v26
MAA 108,20,156
v_fmac_f32 v95, v7, v26
s_waitcnt lgkmcnt(8)
v_fmac_f32 v128, v28, v20
MAA 108,16,140
ds_read_b128 v[4:7], v8 offset:512
v_fmac_f32 v129, v29, v20
MAA 60,8,140
v_fmac_f32 v130, v30, v20
v_fmac_f32 v131, v31, v20
MAA 60,12,156
v_fmac_f32 v132, v28, v22
v_fmac_f32 v133, v29, v22
MAA 56,12,152
buffer_load_dwordx4 v18, s[28:31], s58 offen lds
MAA 56,8,136
v_fmac_f32 v134, v30, v22
v_fmac_f32 v135, v31, v22
MAA 40,0,136
v_fmac_f32 v136, v28, v24
v_fmac_f32 v137, v29, v24
MAA 40,4,152
v_fmac_f32 v138, v30, v24
v_fmac_f32 v139, v31, v24
MAA 44,4,156
v_fmac_f32 v140, v28, v26
v_fmac_f32 v141, v29, v26
MAA 44,0,140
v_fmac_f32 v142, v30, v26
v_fmac_f32 v143, v31, v26
s_waitcnt lgkmcnt(0)
v_fmac_f32 v240, v4, v20
v_fmac_f32 v241, v5, v20
v_fmac_f32 v242, v6, v20
v_fmac_f32 v243, v7, v20
v_fmac_f32 v244, v4, v22
v_fmac_f32 v245, v5, v22
v_fmac_f32 v246, v6, v22
v_fmac_f32 v247, v7, v22
s_waitcnt vmcnt(17) lgkmcnt(0)
s_barrier
MAA 64,64,128
ds_read_b128 v[28:31], v9
s_add_u32 m0, s55, 101376
MAA 64,68,144
ds_read_b128 v[4:7], v9 offset:64
MAA 68,68,148
buffer_load_dwordx4 v12, s[80:83], s54 offen   lds
MAA 68,64,132
TR 0,16,33792
MAA 84,72,132
TR 2,16,34304
MAA 84,76,148
TR 4,16,42240
MAA 80,76,144
TR 6,16,42752
MAA 80,72,128
TR 8,16,33824
MAA 128,80,128
buffer_load_dwordx4 v13, s[80:83], s54 offen offset:1056   lds
MAA 128,84,144
TR 10,16,34336
s_waitcnt lgkmcnt(7)
v_fmac_f32 v32, v28, v20
MAA 132,84,148
TR 12,16,42272
v_fmac_f32 v33, v29, v20
MAA 132,80,132
TR 14,16,42784
v_fmac_f32 v34, v30, v20
MAA 148,88,132
TR 16,16,33856
v_fmac_f32 v35, v31, v20
MAA 148,92,148
TR 18,16,34368
v_fmac_f32 v36, v28, v22
MAA 144,92,144
buffer_load_dwordx4 v14, s[80:83], s54 offen offset:2112   lds
MAA 144,88,128
TR 20,16,42304
v_fmac_f32 v37, v29, v22
MAA 192,96,128
TR 22,16,42816
v_fmac_f32 v38, v30, v22
MAA 192,100,144
TR 24,16,33888
v_fmac_f32 v39, v31, v22
MAA 196,100,148
TR 26,16,34400
v_fmac_f32 v40, v28, v24
MAA 196,96,132
TR 28,16,42336
v_fmac_f32 v41, v29, v24
MAA 212,104,132
buffer_load_dwordx4 v15, s[80:83], s54 offen offset:3168   lds
MAA 212,108,148
TR 30,16,42848
s_add_u32 s54, s54, 458752
MAA 208,108,144
TR 32,16,33920
s_mov_b32 m0, s67
MAA 208,104,128
TR 34,16,34432
v_fmac_f32 v42, v30, v24
MAA 240,112,128
TR 36,16,42368
v_fmac_f32 v43, v31, v24
MAA 240,116,144
TR 38,16,42880
v_fmac_f32 v44, v28, v26
MAA 244,116,148
buffer_load_dwordx4 v19, s[28:31], s58 offen offset:1056 lds
MAA 244,112,132
TR 40,16,33952
s_add_u32 s67, s67, 8448
MAA 252,120,132
TR 42,16,34464
s_add_u32 s58, s58, 0x40000
MAA 252,124,148
TR 44,16,42400
v_fmac_f32 v45, v29, v26
MAA 248,124,144
TR 46,16,42912
v_fmac_f32 v46, v30, v26
MAA 248,120,128
TR 48,17,33792
v_fmac_f32 v47, v31, v26
MAA 220,104,140
ds_read_b128 v[28:31], v9 offset:128
s_waitcnt lgkmcnt(15)
v_fmac_f32 v48, v4, v20
MAA 220,108,156
buffer_load_dwordx4 a[128:131], v10, s[16:19], s52 offen sc1
MAA 216,108,152
TR 50,17,34304
v_fmac_f32 v49, v5, v20
MAA 216,104,136
TR 52,17,42240
v_fmac_f32 v50, v6, v20
MAA 200,96,136
TR 54,17,42752
v_fmac_f32 v51, v7, v20
MAA 200,100,152
TR 56,17,33824
v_fmac_f32 v52, v4, v22
MAA 204,100,156
TR 58,17,34336
v_fmac_f32 v53, v5, v22
MAA 204,96,140
buffer_load_dwordx4 a[132:135], v10, s[16:19], s52 offen offset:1024 sc1
MAA 156,88,140
TR 60,17,42272
s_add_u32 s52, s52, 131072
MAA 156,92,156
TR 62,17,42784
v_fmac_f32 v54, v6, v22
MAA 152,92,152
v_fmac_f32 v55, v7, v22
v_fmac_f32 v56, v4, v24
MAA 152,88,136
v_fmac_f32 v57, v5, v24
v_fmac_f32 v58, v6, v24
MAA 136,80,136
v_fmac_f32 v59, v7, v24
v_fmac_f32 v60, v4, v26
MAA 136,84,152
buffer_load_dwordx4 a[144:147], v10, s[16:19], s52 offen sc1
MAA 140,84,156
v_fmac_f32 v61, v5, v26
v_fmac_f32 v62, v6, v26
MAA 140,80,140
v_fmac_f32 v63, v7, v26
s_waitcnt lgkmcnt(7)
v_fmac_f32 v96, v28, v20
MAA 92,72,140
ds_read_b128 v[4:7], v8
v_fmac_f32 v97, v29, v20
MAA 92,76,156
v_fmac_f32 v98, v30, v20
v_fmac_f32 v99, v31, v20
MAA 88,76,152
v_fmac_f32 v100, v28, v22
v_fmac_f32 v101, v29, v22
MAA 88,72,136
buffer_load_dwordx4 a[148:151], v10, s[16:19], s52 offen offset:1024 sc1
MAA 72,64,136
s_add_u32 s52, s52, 131072
v_fmac_f32 v102, v30, v22
v_fmac_f32 v103, v31, v22
MAA 72,68,152
v_fmac_f32 v104, v28, v24
v_fmac_f32 v105, v29, v24
MAA 76,68,156
v_fmac_f32 v106, v30, v24
v_fmac_f32 v107, v31, v24
MAA 76,64,140
v_fmac_f32 v108, v28, v26
v_fmac_f32 v109, v29, v26
v_fmac_f32 v110, v30, v26
v_fmac_f32 v111, v31, v26
s_waitcnt lgkmcnt(0)
v_fmac_f32 v224, v4, v20
v_fmac_f32 v225, v5, v20
v_fmac_f32 v226, v6, v20
v_fmac_f32 v227, v7, v20
v_fmac_f32 v228, v4, v22
v_fmac_f32 v229, v5, v22
v_fmac_f32 v230, v6, v22
v_fmac_f32 v231, v7, v22
s_waitcnt vmcnt(18) lgkmcnt(0)
s_barrier
MAA 32,0,160
ds_read_b128 v[28:31], v9 offset:704
MAA 32,4,176
ds_read_b128 v[4:7], v9 offset:768
MAA 36,4,180
buffer_load_dwordx4 a[136:139], v11, s[16:19], s53 offen sc1
MAA 36,0,164
TR 64,16,50688
MAA 52,8,164
TR 66,16,51200
MAA 52,12,180
TR 68,16,59136
MAA 48,12,176
TR 70,16,59648
MAA 48,8,160
TR 72,16,50720
MAA 96,16,160
buffer_load_dwordx4 a[140:143], v11, s[16:19], s53 offen offset:1024 sc1
MAA 96,20,176
TR 74,16,51232
s_add_u32 s53, s53, 131072
MAA 100,20,180
TR 76,16,59168
s_waitcnt lgkmcnt(8)
v_fmac_f32 v144, v28, v20
MAA 100,16,164
TR 78,16,59680
v_fmac_f32 v145, v29, v20
MAA 116,24,164
TR 80,16,50752
v_fmac_f32 v146, v30, v20
MAA 116,28,180
TR 82,16,51264
v_fmac_f32 v147, v31, v20
MAA 112,28,176
buffer_load_dwordx4 a[152:155], v11, s[16:19], s53 offen sc1
MAA 112,24,160
TR 84,16,59200
v_fmac_f32 v148, v28, v22
MAA 160,32,160
TR 86,16,59712
v_fmac_f32 v149, v29, v22
MAA 160,36,176
TR 88,16,50784
v_fmac_f32 v150, v30, v22
MAA 164,36,180
TR 90,16,51296
v_fmac_f32 v151, v31, v22
MAA 164,32,164
TR 92,16,59232
v_fmac_f32 v152, v28, v24
MAA 180,40,164
buffer_load_dwordx4 a[156:159], v11, s[16:19], s53 offen offset:1024 sc1
MAA 180,44,180
TR 94,16,59744
s_add_u32 s53, s53, 131072
MAA 176,44,176
TR 96,16,50816
s_add_u32 m0, s55, 118272
MAA 176,40,160
TR 98,16,51328
v_fmac_f32 v153, v29, v24
MAA 224,48,160
TR 100,16,59264
v_fmac_f32 v154, v30, v24
MAA 224,52,176
TR 102,16,59776
v_fmac_f32 v155, v31, v24
MAA 228,52,180
buffer_load_dwordx4 v12, s[32:35], s54 offen   lds
MAA 228,48,164
TR 104,16,50848
v_fmac_f32 v156, v28, v26
MAA 236,56,164
TR 106,16,51360
v_fmac_f32 v157, v29, v26
MAA 236,60,180
TR 108,16,59296
v_fmac_f32 v158, v30, v26
MAA 232,60,176
TR 110,16,59808
v_fmac_f32 v159, v31, v26
MAA 232,56,160
ds_read_b128 v[28:31], v9 offset:832
s_waitcnt lgkmcnt(15)
v_fmac_f32 v192, v4, v20
s_waitcnt vmcnt(19)
MAA 188,40,172
buffer_load_dwordx4 v13, s[32:35], s54 offen offset:1056   lds
MAA 188,44,188
TR 112,17,50688
v_fmac_f32 v193, v5, v20
MAA 184,44,184
TR 114,17,51200
v_fmac_f32 v194, v6, v20
MAA 184,40,168
TR 116,17,59136
v_fmac_f32 v195, v7, v20
MAA 168,32,168
TR 118,17,59648
v_fmac_f32 v196, v4, v22
MAA 168,36,184
TR 120,17,50720
v_fmac_f32 v197, v5, v22
MAA 172,36,188
buffer_load_dwordx4 v14, s[32:35], s54 offen offset:2112   lds
MAA 172,32,172
TR 122,17,51232
v_fmac_f32 v198, v6, v22
MAA 124,24,172
TR 124,17,59168
v_fmac_f32 v199, v7, v22
MAA 124,28,188
TR 126,17,59680
v_fmac_f32 v200, v4, v24
MAA 120,28,184
v_fmac_f32 v201, v5, v24
v_fmac_f32 v202, v6, v24
MAA 120,24,168
v_fmac_f32 v203, v7, v24
v_fmac_f32 v204, v4, v26
MAA 104,16,168
buffer_load_dwordx4 v15, s[32:35], s54 offen offset:3168   lds
MAA 104,20,184
s_mov_b32 m0, s67
v_fmac_f32 v205, v5, v26
v_fmac_f32 v206, v6, v26
MAA 108,20,188
v_fmac_f32 v207, v7, v26
s_waitcnt lgkmcnt(8)
v_fmac_f32 v208, v28, v20
MAA 108,16,172
ds_read_b128 v[4:7], v8 offset:576
v_fmac_f32 v209, v29, v20
MAA 60,8,172
v_fmac_f32 v210, v30, v20
v_fmac_f32 v211, v31, v20
MAA 60,12,188
v_fmac_f32 v212, v28, v22
v_fmac_f32 v213, v29, v22
MAA 56,12,184
buffer_load_dwordx4 v18, s[28:31], s58 offen lds
MAA 56,8,168
v_fmac_f32 v214, v30, v22
v_fmac_f32 v215, v31, v22
MAA 40,0,168
v_fmac_f32 v216, v28, v24
v_fmac_f32 v217, v29, v24
MAA 40,4,184
v_fmac_f32 v218, v30, v24
v_fmac_f32 v219, v31, v24
MAA 44,4,188
v_fmac_f32 v220, v28, v26
v_fmac_f32 v221, v29, v26
MAA 44,0,172
v_fmac_f32 v222, v30, v26
v_fmac_f32 v223, v31, v26
s_waitcnt lgkmcnt(0)
v_fmac_f32 v248, v4, v20
v_fmac_f32 v249, v5, v20
v_fmac_f32 v250, v6, v20
v_fmac_f32 v251, v7, v20
v_fmac_f32 v252, v4, v22
v_fmac_f32 v253, v5, v22
v_fmac_f32 v254, v6, v22
v_fmac_f32 v255, v7, v22
s_waitcnt vmcnt(19) lgkmcnt(0)
s_barrier
MAA 64,64,160
ds_read_b128 v[28:31], v9 offset:192
s_add_u32 m0, s55, 135168
MAA 64,68,176
ds_read_b128 v[4:7], v9 offset:256
MAA 68,68,180
buffer_load_dwordx4 v12, s[80:83], s54 offen   lds
MAA 68,64,164
ds_read_b64_tr_b16 a[0:1], v16
MAA 84,72,164
TR 2,16,512
MAA 84,76,180
TR 4,16,8448
MAA 80,76,176
TR 6,16,8960
MAA 80,72,160
TR 8,16,32
MAA 128,80,160
buffer_load_dwordx4 v13, s[80:83], s54 offen offset:1056   lds
MAA 128,84,176
TR 10,16,544
s_waitcnt lgkmcnt(7)
v_fmac_f32 v112, v28, v20
MAA 132,84,180
TR 12,16,8480
v_fmac_f32 v113, v29, v20
MAA 132,80,164
TR 14,16,8992
v_fmac_f32 v114, v30, v20
MAA 148,88,164
TR 16,16,64
v_fmac_f32 v115, v31, v20
MAA 148,92,180
TR 18,16,576
v_fmac_f32 v116, v28, v22
MAA 144,92,176
buffer_load_dwordx4 v14, s[80:83], s54 offen offset:2112   lds
MAA 144,88,160
TR 20,16,8512
v_fmac_f32 v117, v29, v22
MAA 192,96,160
TR 22,16,9024
v_fmac_f32 v118, v30, v22
MAA 192,100,176
TR 24,16,96
.Lpad25:
s_cbranch_execz .Lnopoll60r
v_fmac_f32 v119, v31, v22
MAA 196,100,180
TR 26,16,608
v_fmac_f32 v120, v28, v24
MAA 196,96,164
TR 28,16,8544
v_fmac_f32 v121, v29, v24
MAA 212,104,164
buffer_load_dwordx4 v15, s[80:83], s54 offen offset:3168   lds
MAA 212,108,180
TR 30,16,9056
s_add_u32 s54, s54, 458752
MAA 208,108,176
TR 32,16,128
s_mov_b32 m0, s67
MAA 208,104,160
TR 34,16,640
v_fmac_f32 v122, v30, v24
MAA 240,112,160
TR 36,16,8576
v_fmac_f32 v123, v31, v24
MAA 240,116,176
TR 38,16,9088
v_fmac_f32 v124, v28, v26
MAA 244,116,180
buffer_load_dwordx4 v19, s[28:31], s58 offen offset:1056 lds
MAA 244,112,164
TR 40,16,160
s_add_u32 s67, s67, 8448
MAA 252,120,164
TR 42,16,672
s_add_u32 s46, s46, 1
MAA 252,124,180
TR 44,16,8608
s_xor_b32 s58, s46, s87
MAA 248,124,176
TR 46,16,9120
s_mul_i32 s58, s58, 458752
MAA 248,120,160
ds_read_b64_tr_b16 a[48:49], v17
v_fmac_f32 v125, v29, v26
MAA 220,104,172
buffer_load_dwordx4 a[160:163], v10, s[16:19], s52 offen sc1
MAA 220,108,188
TR 50,17,512
v_fmac_f32 v126, v30, v26
MAA 216,108,184
TR 52,17,8448
v_fmac_f32 v127, v31, v26
MAA 216,104,168
ds_read_b128 v[28:31], v9 offset:320
s_waitcnt lgkmcnt(15)
v_fmac_f32 v160, v4, v20
MAA 200,96,168
TR 54,17,8960
v_fmac_f32 v161, v5, v20
MAA 200,100,184
TR 56,17,32
v_fmac_f32 v162, v6, v20
MAA 204,100,188
buffer_load_dwordx4 a[164:167], v10, s[16:19], s52 offen offset:1024 sc1
MAA 204,96,172
TR 58,17,544
s_add_u32 s52, s52, 131072
MAA 156,88,172
TR 60,17,8480
v_fmac_f32 v163, v7, v20
MAA 156,92,188
TR 62,17,8992
v_fmac_f32 v164, v4, v22
MAA 152,92,184
v_fmac_f32 v165, v5, v22
v_fmac_f32 v166, v6, v22
MAA 152,88,168
v_fmac_f32 v167, v7, v22
v_fmac_f32 v168, v4, v24
MAA 136,80,168
buffer_load_dwordx4 a[176:179], v10, s[16:19], s52 offen sc1
MAA 136,84,184
v_fmac_f32 v169, v5, v24
v_fmac_f32 v170, v6, v24
MAA 140,84,188
v_fmac_f32 v171, v7, v24
v_fmac_f32 v172, v4, v26
MAA 140,80,172
v_fmac_f32 v173, v5, v26
v_fmac_f32 v174, v6, v26
MAA 92,72,172
v_fmac_f32 v175, v7, v26
s_waitcnt lgkmcnt(5)
v_fmac_f32 v176, v28, v20
MAA 92,76,188
ds_read_b128 v[4:7], v8 offset:64
v_fmac_f32 v177, v29, v20
MAA 88,76,184
buffer_load_dwordx4 a[180:183], v10, s[16:19], s52 offen offset:1024 sc1
MAA 88,72,168
s_add_u32 s52, s52, 131072
v_fmac_f32 v178, v30, v20
v_fmac_f32 v179, v31, v20
MAA 72,64,168
v_fmac_f32 v180, v28, v22
v_fmac_f32 v181, v29, v22
MAA 72,68,184
v_fmac_f32 v182, v30, v22
v_fmac_f32 v183, v31, v22
MAA 76,68,188
v_fmac_f32 v184, v28, v24
v_fmac_f32 v185, v29, v24
MAA 76,64,172
v_fmac_f32 v186, v30, v24
v_fmac_f32 v187, v31, v24
v_fmac_f32 v188, v28, v26
v_fmac_f32 v189, v29, v26
v_fmac_f32 v190, v30, v26
v_fmac_f32 v191, v31, v26
v_accvgpr_read_b32 v28, a192
s_waitcnt lgkmcnt(0)
v_fmac_f32 v232, v4, v20
v_fmac_f32 v233, v5, v20
v_fmac_f32 v234, v6, v20
v_fmac_f32 v235, v7, v20
v_fmac_f32 v236, v4, v22
v_fmac_f32 v237, v5, v22
v_fmac_f32 v238, v6, v22
v_fmac_f32 v239, v7, v22
v_accvgpr_read_b32 v29, a193
v_accvgpr_read_b32 v30, a194
v_accvgpr_read_b32 v31, a195
s_mov_b32 s15, -4
.p2align 6
.Lk65:
s_waitcnt vmcnt(18) lgkmcnt(0)
s_barrier
MAA 32,0,128
TR 64,16,16896
MAA 32,4,144
buffer_load_dwordx4 a[168:171], v11, s[16:19], s53 offen sc1
MAA 36,4,148
TR 66,16,17408
MAA 36,0,132
TR 68,16,25344
MAA 52,8,132
TR 70,16,25856
MAA 52,12,148
MAA 48,12,144
TR 72,16,16928
MAA 48,8,128
buffer_load_dwordx4 a[172:175], v11, s[16:19], s53 offen offset:1024 sc1
MAA 96,16,128
TR 74,16,17440
s_add_u32 s53, s53, 131072
MAA 96,20,144
TR 76,16,25376
MAA 100,20,148
MAA 100,16,132
TR 78,16,25888
MAA 116,24,132
TR 80,16,16960
MAA 116,28,148
buffer_load_dwordx4 a[184:187], v11, s[16:19], s53 offen sc1
MAA 112,28,144
TR 82,16,17472
MAA 112,24,128
MAA 160,32,128
TR 84,16,25408
MAA 160,36,144
TR 86,16,25920
MAA 164,36,148
TR 88,16,16992
MAA 164,32,132
buffer_load_dwordx4 a[188:191], v11, s[16:19], s53 offen offset:1024 sc1
MAA 180,40,132
s_add_u32 s53, s53, 131072
MAA 180,44,148
TR 90,16,17504
MAA 176,44,144
TR 92,16,25440
MAA 176,40,128
TR 94,16,25952
MAA 224,48,128
s_add_u32 m0, s55, 84480
MAA 224,52,144
buffer_load_dwordx4 v12, s[32:35], s54 offen   lds
MAA 228,52,148
TR 96,16,17024
MAA 228,48,132
TR 98,16,17536
MAA 236,56,132
TR 100,16,25472
MAA 236,60,148
TR 102,16,25984
MAA 232,60,144
MAA 232,56,128
TR 104,16,17056
s_waitcnt vmcnt(19)
MAA 188,40,140
TR 106,16,17568
MAA 188,44,156
buffer_load_dwordx4 v13, s[32:35], s54 offen offset:1056   lds
MAA 184,44,152
TR 108,16,25504
MAA 184,40,136
MAA 168,32,136
TR 110,16,26016
MAA 168,36,152
buffer_load_dwordx4 v14, s[32:35], s54 offen offset:2112   lds
MAA 172,36,156
TR 112,17,16896
MAA 172,32,140
TR 114,17,17408
MAA 124,24,140
MAA 124,28,156
TR 116,17,25344
MAA 120,28,152
TR 118,17,25856
MAA 120,24,136
buffer_load_dwordx4 v15, s[32:35], s54 offen offset:3168   lds
MAA 104,16,136
TR 120,17,16928
MAA 104,20,152
MAA 108,20,156
TR 122,17,17440
MAA 108,16,140
TR 124,17,25376
MAA 60,8,140
TR 126,17,25888
s_mov_b32 m0, s67
MAA 60,12,156
buffer_load_dwordx4 v18, s[28:31], s58 offen lds
MAA 56,12,152
MAA 56,8,136
MAA 40,0,136
MAA 40,4,152
MAA 44,4,156
MAA 44,0,140
s_waitcnt vmcnt(19) lgkmcnt(0)
s_barrier
MAA 64,64,128
TR 0,16,33792
s_add_u32 m0, s55, 101376
MAA 64,68,144
buffer_load_dwordx4 v12, s[80:83], s54 offen   lds
MAA 68,68,148
TR 2,16,34304
MAA 68,64,132
TR 4,16,42240
MAA 84,72,132
TR 6,16,42752
MAA 84,76,148
MAA 80,76,144
TR 8,16,33824
MAA 80,72,128
buffer_load_dwordx4 v13, s[80:83], s54 offen offset:1056   lds
MAA 128,80,128
TR 10,16,34336
MAA 128,84,144
TR 12,16,42272
MAA 132,84,148
TR 14,16,42784
MAA 132,80,132
MAA 148,88,132
TR 16,16,33856
MAA 148,92,148
buffer_load_dwordx4 v14, s[80:83], s54 offen offset:2112   lds
MAA 144,92,144
TR 18,16,34368
MAA 144,88,128
TR 20,16,42304
MAA 192,96,128
MAA 192,100,144
TR 22,16,42816
MAA 196,100,148
TR 24,16,33888
MAA 196,96,132
buffer_load_dwordx4 v15, s[80:83], s54 offen offset:3168   lds
MAA 212,104,132
TR 26,16,34400
s_add_u32 s54, s54, 458752
MAA 212,108,148
TR 28,16,42336
MAA 208,108,144
MAA 208,104,128
TR 30,16,42848
MAA 240,112,128
TR 32,16,33920
s_mov_b32 m0, s67
MAA 240,116,144
buffer_load_dwordx4 v19, s[28:31], s58 offen offset:1056 lds
MAA 244,116,148
s_add_u32 s67, s67, 8448
s_add_u32 s58, s58, 0x40000
MAA 244,112,132
TR 34,16,34432
MAA 252,120,132
MAA 252,124,148
TR 36,16,42368
MAA 248,124,144
TR 38,16,42880
MAA 248,120,128
buffer_load_dwordx4 a[128:131], v10, s[16:19], s52 offen sc1
MAA 220,104,140
TR 40,16,33952
MAA 220,108,156
TR 42,16,34464
MAA 216,108,152
MAA 216,104,136
TR 44,16,42400
MAA 200,96,136
TR 46,16,42912
MAA 200,100,152
buffer_load_dwordx4 a[132:135], v10, s[16:19], s52 offen offset:1024 sc1
MAA 204,100,156
TR 48,17,33792
s_add_u32 s52, s52, 131072
MAA 204,96,140
MAA 156,88,140
TR 50,17,34304
MAA 156,92,156
TR 52,17,42240
MAA 152,92,152
TR 54,17,42752
MAA 152,88,136
buffer_load_dwordx4 a[144:147], v10, s[16:19], s52 offen sc1
MAA 136,80,136
TR 56,17,33824
MAA 136,84,152
MAA 140,84,156
TR 58,17,34336
MAA 140,80,140
TR 60,17,42272
MAA 92,72,140
TR 62,17,42784
MAA 92,76,156
buffer_load_dwordx4 a[148:151], v10, s[16:19], s52 offen offset:1024 sc1
MAA 88,76,152
s_add_u32 s52, s52, 131072
MAA 88,72,136
MAA 72,64,136
MAA 72,68,152
MAA 76,68,156
MAA 76,64,140
s_waitcnt vmcnt(18) lgkmcnt(0)
s_barrier
MAA 32,0,160
TR 64,16,50688
MAA 32,4,176
buffer_load_dwordx4 a[136:139], v11, s[16:19], s53 offen sc1
MAA 36,4,180
TR 66,16,51200
MAA 36,0,164
TR 68,16,59136
MAA 52,8,164
TR 70,16,59648
MAA 52,12,180
MAA 48,12,176
TR 72,16,50720
MAA 48,8,160
buffer_load_dwordx4 a[140:143], v11, s[16:19], s53 offen offset:1024 sc1
MAA 96,16,160
TR 74,16,51232
s_add_u32 s53, s53, 131072
MAA 96,20,176
TR 76,16,59168
MAA 100,20,180
MAA 100,16,164
TR 78,16,59680
MAA 116,24,164
TR 80,16,50752
MAA 116,28,180
buffer_load_dwordx4 a[152:155], v11, s[16:19], s53 offen sc1
MAA 112,28,176
TR 82,16,51264
MAA 112,24,160
MAA 160,32,160
TR 84,16,59200
MAA 160,36,176
TR 86,16,59712
MAA 164,36,180
TR 88,16,50784
MAA 164,32,164
buffer_load_dwordx4 a[156:159], v11, s[16:19], s53 offen offset:1024 sc1
MAA 180,40,164
s_add_u32 s53, s53, 131072
MAA 180,44,180
TR 90,16,51296
MAA 176,44,176
TR 92,16,59232
MAA 176,40,160
TR 94,16,59744
MAA 224,48,160
s_add_u32 m0, s55, 118272
MAA 224,52,176
buffer_load_dwordx4 v12, s[32:35], s54 offen   lds
MAA 228,52,180
TR 96,16,50816
MAA 228,48,164
TR 98,16,51328
MAA 236,56,164
TR 100,16,59264
MAA 236,60,180
TR 102,16,59776
MAA 232,60,176
MAA 232,56,160
TR 104,16,50848
s_waitcnt vmcnt(19)
MAA 188,40,172
TR 106,16,51360
MAA 188,44,188
buffer_load_dwordx4 v13, s[32:35], s54 offen offset:1056   lds
MAA 184,44,184
TR 108,16,59296
MAA 184,40,168
MAA 168,32,168
TR 110,16,59808
MAA 168,36,184
buffer_load_dwordx4 v14, s[32:35], s54 offen offset:2112   lds
MAA 172,36,188
TR 112,17,50688
MAA 172,32,172
TR 114,17,51200
MAA 124,24,172
MAA 124,28,188
TR 116,17,59136
MAA 120,28,184
TR 118,17,59648
MAA 120,24,168
buffer_load_dwordx4 v15, s[32:35], s54 offen offset:3168   lds
MAA 104,16,168
TR 120,17,50720
MAA 104,20,184
MAA 108,20,188
TR 122,17,51232
MAA 108,16,172
TR 124,17,59168
MAA 60,8,172
TR 126,17,59680
s_mov_b32 m0, s67
MAA 60,12,188
buffer_load_dwordx4 v18, s[28:31], s58 offen lds
MAA 56,12,184
MAA 56,8,168
MAA 40,0,168
MAA 40,4,184
MAA 44,4,188
MAA 44,0,172
s_waitcnt vmcnt(19) lgkmcnt(0)
s_barrier
MAA 64,64,160
ds_read_b64_tr_b16 a[0:1], v16
s_add_u32 m0, s55, 135168
MAA 64,68,176
buffer_load_dwordx4 v12, s[80:83], s54 offen   lds
MAA 68,68,180
TR 2,16,512
MAA 68,64,164
TR 4,16,8448
MAA 84,72,164
TR 6,16,8960
MAA 84,76,180
MAA 80,76,176
TR 8,16,32
MAA 80,72,160
buffer_load_dwordx4 v13, s[80:83], s54 offen offset:1056   lds
MAA 128,80,160
TR 10,16,544
MAA 128,84,176
TR 12,16,8480
MAA 132,84,180
TR 14,16,8992
MAA 132,80,164
MAA 148,88,164
TR 16,16,64
MAA 148,92,180
buffer_load_dwordx4 v14, s[80:83], s54 offen offset:2112   lds
MAA 144,92,176
TR 18,16,576
MAA 144,88,160
TR 20,16,8512
MAA 192,96,160
MAA 192,100,176
TR 22,16,9024
MAA 196,100,180
TR 24,16,96
MAA 196,96,164
buffer_load_dwordx4 v15, s[80:83], s54 offen offset:3168   lds
MAA 212,104,164
TR 26,16,608
s_add_u32 s54, s54, 458752
MAA 212,108,180
TR 28,16,8544
MAA 208,108,176
MAA 208,104,160
TR 30,16,9056
MAA 240,112,160
TR 32,16,128
s_mov_b32 m0, s67
MAA 240,116,176
buffer_load_dwordx4 v19, s[28:31], s58 offen offset:1056 lds
MAA 244,116,180
s_add_u32 s67, s67, 8448
s_add_u32 s46, s46, 1
s_xor_b32 s58, s46, s87
s_mul_i32 s58, s58, 458752
MAA 244,112,164
TR 34,16,640
MAA 252,120,164
MAA 252,124,180
TR 36,16,8576
MAA 248,124,176
TR 38,16,9088
MAA 248,120,160
buffer_load_dwordx4 a[160:163], v10, s[16:19], s52 offen sc1
MAA 220,104,172
TR 40,16,160
MAA 220,108,188
TR 42,16,672
MAA 216,108,184
MAA 216,104,168
TR 44,16,8608
MAA 200,96,168
TR 46,16,9120
MAA 200,100,184
buffer_load_dwordx4 a[164:167], v10, s[16:19], s52 offen offset:1024 sc1
MAA 204,100,188
ds_read_b64_tr_b16 a[48:49], v17
s_add_u32 s52, s52, 131072
MAA 204,96,172
MAA 156,88,172
TR 50,17,512
MAA 156,92,188
TR 52,17,8448
MAA 152,92,184
TR 54,17,8960
MAA 152,88,168
buffer_load_dwordx4 a[176:179], v10, s[16:19], s52 offen sc1
MAA 136,80,168
TR 56,17,32
MAA 136,84,184
MAA 140,84,188
TR 58,17,544
MAA 140,80,172
TR 60,17,8480
MAA 92,72,172
TR 62,17,8992
MAA 92,76,188
buffer_load_dwordx4 a[180:183], v10, s[16:19], s52 offen offset:1024 sc1
MAA 88,76,184
.Lpad26:
s_cbranch_execz .Lnopoll60r
s_add_u32 s52, s52, 131072
MAA 88,72,168
MAA 72,64,168
MAA 72,68,184
MAA 76,68,188
s_add_u32 s15, s15, 1
MAA 76,64,172
s_cbranch_scc0 .Lk65
s_waitcnt vmcnt(10) lgkmcnt(0)
s_barrier
MAA 32,0,128
buffer_load_dwordx4 a[168:171], v11, s[16:19], s53 offen sc1
MAA 32,4,144
TR 64,16,16896
s_add_u32 s58, s99, 2293760
MAA 48,12,144
TR 66,16,17408
s_lshl_b32 s74, s3, 11
MAA 48,8,128
TR 68,16,25344
s_add_u32 s74, s74, s84
MAA 36,0,132
buffer_load_dwordx4 a[172:175], v11, s[16:19], s53 offen offset:1024 sc1
MAA 36,4,148
TR 70,16,25856
s_add_u32 s53, s53, 131072
MAA 52,12,148
TR 72,16,16928
v_lshl_add_u32 v4, v1, 4, s74
MAA 52,8,132
TR 74,16,17440
v_lshrrev_b32 v2, 3, v1
MAA 40,0,136
buffer_load_dwordx4 a[184:187], v11, s[16:19], s53 offen sc1
MAA 40,4,152
TR 76,16,25376
v_cmp_eq_u32 vcc, 3, v2
MAA 56,12,152
TR 78,16,25888
v_add_u32 v2, 67108480, v4
MAA 56,8,136
TR 80,16,33792
v_cndmask_b32 v4, v4, v2, vcc
MAA 44,0,140
buffer_load_dwordx4 a[188:191], v11, s[16:19], s53 offen offset:1024 sc1
MAA 44,4,156
TR 82,16,34304
s_add_u32 s53, s53, 131072
MAA 60,12,156
TR 84,16,42240
s_and_b32 s74, s7, 1
MAA 60,8,140
TR 86,16,42752
s_add_u32 s54, s98, 65536
MAA 96,16,128
TR 88,16,33824
v_bfe_u32 v7, v1, 2, 3
MAA 96,20,144
TR 90,16,34336
v_mul_u32_u24 v7, 1056, v7
MAA 112,28,144
TR 92,16,42272
s_waitcnt vmcnt(9)
s_barrier
MAA 112,24,128
TR 94,16,42784
v_bfe_u32 v2, v1, 5, 1
MAA 100,16,132
TR 96,16,50688
v_lshl_add_u32 v7, v2, 8, v7
MAA 100,20,148
TR 98,16,51200
v_and_b32 v2, 3, v1
MAA 116,28,148
TR 100,16,59136
v_lshl_add_u32 v7, v2, 3, v7
MAA 116,24,132
TR 102,16,59648
s_lshl_b32 s74, s74, 7
MAA 104,16,136
TR 104,16,50720
s_xor_b32 s75, s74, 128
MAA 104,20,152
TR 106,16,51232
v_add_u32 v6, s75, v7
MAA 120,28,152
TR 108,16,59168
v_add_u32 v7, s74, v7
MAA 120,24,136
TR 110,16,59680
s_mul_i32 s55, s3, 2112
MAA 108,16,140
TR 112,16,16960
s_mov_b32 s57, 67584
MAA 108,20,156
TR 114,16,17472
MAA 124,28,156
TR 116,16,25408
MAA 124,24,140
TR 118,16,25920
MAA 160,32,128
TR 120,16,16992
MAA 160,36,144
TR 122,16,17504
MAA 176,44,144
TR 124,16,25440
MAA 176,40,128
TR 126,16,25952
MAA 164,32,132
TR 192,16,33856
MAA 164,36,148
TR 194,16,34368
MAA 180,44,148
TR 196,16,42304
MAA 180,40,132
TR 198,16,42816
MAA 168,32,136
TR 200,16,33888
MAA 168,36,152
TR 202,16,34400
MAA 184,44,152
TR 204,16,42336
MAA 184,40,136
TR 206,16,42848
MAA 172,32,140
TR 208,16,50752
MAA 172,36,156
TR 210,16,51264
MAA 188,44,156
TR 212,16,59200
MAA 188,40,140
TR 214,16,59712
MAA 224,48,128
TR 216,16,50784
MAA 224,52,144
TR 218,16,51296
MAA 232,60,144
TR 220,16,59232
MAA 232,56,128
TR 222,16,59744
MAA 228,48,132
TR 0,16,17024
MAA 228,52,148
TR 2,16,17536
MAA 236,60,148
TR 4,16,25472
MAA 236,56,132
TR 6,16,25984
s_waitcnt lgkmcnt(15)
MAA 64,64,128
TR 8,16,17056
MAA 64,68,144
TR 10,16,17568
s_waitcnt vmcnt(7)
MAA 64,96,160
TR 12,16,25504
s_waitcnt vmcnt(5)
MAA 64,100,176
TR 14,16,26016
MAA 80,108,176
TR 16,16,33920
MAA 80,104,160
TR 18,16,34432
MAA 80,76,144
TR 20,16,42368
MAA 80,72,128
TR 22,16,42880
MAA 32,80,160
TR 24,16,33952
MAA 32,84,176
TR 26,16,34464
MAA 48,92,176
TR 28,16,42400
MAA 48,88,160
TR 30,16,42912
s_nop 2
v_pk_mul_f32 v[64:65], v[64:65], v[32:33]
TR 32,16,50816
TR 34,16,51328
v_pk_mul_f32 v[32:33], v[32:33], v[28:29] op_sel_hi:[1,0]
v_pk_mul_f32 v[66:67], v[66:67], v[34:35]
v_pk_mul_f32 v[34:35], v[34:35], v[28:29] op_sel_hi:[1,0]
v_exp_f32 v32, v32
v_pk_mul_f32 v[80:81], v[80:81], v[48:49]
v_pk_mul_f32 v[48:49], v[48:49], v[28:29] op_sel_hi:[1,0]
v_pk_mul_f32 v[82:83], v[82:83], v[50:51]
v_pk_mul_f32 v[50:51], v[50:51], v[28:29] op_sel_hi:[1,0]
v_exp_f32 v33, v33
v_exp_f32 v34, v34
MAA 68,64,132
TR 36,16,59264
v_exp_f32 v35, v35
MAA 68,68,148
TR 38,16,59776
v_exp_f32 v48, v48
MAA 68,96,164
TR 40,16,50848
v_exp_f32 v49, v49
s_waitcnt vmcnt(4)
MAA 68,100,180
TR 42,16,51360
v_exp_f32 v50, v50
MAA 84,108,180
TR 44,16,59296
v_exp_f32 v51, v51
MAA 84,104,164
TR 46,16,59808
MAA 84,76,148
TR 48,17,16896
MAA 84,72,132
TR 50,17,17408
MAA 36,80,164
TR 52,17,25344
MAA 36,84,180
TR 54,17,25856
MAA 52,92,180
TR 56,17,16928
MAA 52,88,164
TR 58,17,17440
s_nop 2
v_pk_mul_f32 v[68:69], v[68:69], v[36:37]
v_pk_fma_f32 v[32:33], v[32:33], v[20:21], v[20:21] op_sel:[0,1,1] op_sel_hi:[1,1,1]
v_pk_fma_f32 v[34:35], v[34:35], v[20:21], v[20:21] op_sel:[0,1,1] op_sel_hi:[1,1,1]
v_pk_mul_f32 v[36:37], v[36:37], v[28:29] op_sel:[0,1] op_sel_hi:[1,1]
v_pk_mul_f32 v[70:71], v[70:71], v[38:39]
v_pk_mul_f32 v[38:39], v[38:39], v[28:29] op_sel:[0,1] op_sel_hi:[1,1]
v_pk_fma_f32 v[48:49], v[48:49], v[20:21], v[20:21] op_sel:[0,1,1] op_sel_hi:[1,1,1]
v_pk_mul_f32 v[84:85], v[84:85], v[52:53]
v_pk_mul_f32 v[52:53], v[52:53], v[28:29] op_sel:[0,1] op_sel_hi:[1,1]
v_pk_mul_f32 v[86:87], v[86:87], v[54:55]
v_pk_mul_f32 v[54:55], v[54:55], v[28:29] op_sel:[0,1] op_sel_hi:[1,1]
v_pk_fma_f32 v[50:51], v[50:51], v[20:21], v[20:21] op_sel:[0,1,1] op_sel_hi:[1,1,1]
v_rcp_f32 v32, v32
v_rcp_f32 v33, v33
MAA 72,64,136
TR 60,17,25376
v_rcp_f32 v34, v34
MAA 72,68,152
TR 62,17,25888
v_rcp_f32 v35, v35
s_waitcnt vmcnt(3)
MAA 72,96,168
v_rcp_f32 v48, v48
s_waitcnt vmcnt(1)
MAA 72,100,184
v_rcp_f32 v49, v49
MAA 88,108,184
v_rcp_f32 v50, v50
MAA 88,104,168
v_rcp_f32 v51, v51
MAA 88,76,152
v_exp_f32 v36, v36
MAA 88,72,136
v_exp_f32 v37, v37
MAA 40,80,168
v_exp_f32 v38, v38
MAA 40,84,184
v_exp_f32 v39, v39
MAA 56,92,184
v_exp_f32 v52, v52
MAA 56,88,168
v_exp_f32 v53, v53
v_exp_f32 v54, v54
v_exp_f32 v55, v55
v_pk_mul_f32 v[64:65], v[64:65], v[32:33]
v_pk_mul_f32 v[66:67], v[66:67], v[34:35]
v_pk_mul_f32 v[80:81], v[80:81], v[48:49]
v_pk_mul_f32 v[82:83], v[82:83], v[50:51]
v_pk_mul_f32 v[72:73], v[72:73], v[40:41]
v_pk_mul_f32 v[40:41], v[40:41], v[30:31] op_sel_hi:[1,0]
v_pk_mul_f32 v[74:75], v[74:75], v[42:43]
v_pk_mul_f32 v[42:43], v[42:43], v[30:31] op_sel_hi:[1,0]
v_pk_mul_f32 v[88:89], v[88:89], v[56:57]
v_pk_mul_f32 v[56:57], v[56:57], v[30:31] op_sel_hi:[1,0]
v_pk_mul_f32 v[90:91], v[90:91], v[58:59]
v_pk_mul_f32 v[58:59], v[58:59], v[30:31] op_sel_hi:[1,0]
v_pk_fma_f32 v[36:37], v[36:37], v[22:23], v[22:23] op_sel:[0,1,1] op_sel_hi:[1,1,1]
v_pk_fma_f32 v[38:39], v[38:39], v[22:23], v[22:23] op_sel:[0,1,1] op_sel_hi:[1,1,1]
v_pk_fma_f32 v[52:53], v[52:53], v[22:23], v[22:23] op_sel:[0,1,1] op_sel_hi:[1,1,1]
v_pk_fma_f32 v[54:55], v[54:55], v[22:23], v[22:23] op_sel:[0,1,1] op_sel_hi:[1,1,1]
v_cvt_pk_bf16_f32 v32, v64, v65
v_cvt_pk_bf16_f32 v33, v66, v67
v_cvt_pk_bf16_f32 v34, v80, v81
v_cvt_pk_bf16_f32 v35, v82, v83
MAA 76,64,140
buffer_store_dwordx4 v[32:35], v10, s[16:19], s62 offen sc1
MAA 76,68,156
TR 64,17,33792
v_rcp_f32 v36, v36
MAA 76,96,172
TR 66,17,34304
v_rcp_f32 v37, v37
s_waitcnt vmcnt(1)
MAA 76,100,188
TR 68,17,42240
v_rcp_f32 v38, v38
MAA 92,108,188
TR 70,17,42752
v_rcp_f32 v39, v39
MAA 92,104,172
v_rcp_f32 v52, v52
MAA 92,76,156
TR 76,17,42272
v_rcp_f32 v53, v53
MAA 92,72,140
TR 72,17,33824
v_rcp_f32 v54, v54
MAA 44,80,172
TR 74,17,34336
v_rcp_f32 v55, v55
MAA 44,84,188
TR 78,17,42784
v_exp_f32 v40, v40
MAA 60,92,188
TR 80,17,50688
v_exp_f32 v41, v41
MAA 60,88,172
TR 82,17,51200
v_exp_f32 v42, v42
v_exp_f32 v43, v43
v_exp_f32 v56, v56
v_exp_f32 v57, v57
v_exp_f32 v58, v58
v_exp_f32 v59, v59
v_pk_mul_f32 v[68:69], v[68:69], v[36:37]
v_pk_mul_f32 v[70:71], v[70:71], v[38:39]
v_pk_mul_f32 v[84:85], v[84:85], v[52:53]
v_pk_mul_f32 v[86:87], v[86:87], v[54:55]
v_pk_mul_f32 v[76:77], v[76:77], v[44:45]
v_pk_mul_f32 v[44:45], v[44:45], v[30:31] op_sel:[0,1] op_sel_hi:[1,1]
v_pk_mul_f32 v[78:79], v[78:79], v[46:47]
v_pk_mul_f32 v[46:47], v[46:47], v[30:31] op_sel:[0,1] op_sel_hi:[1,1]
v_pk_mul_f32 v[92:93], v[92:93], v[60:61]
v_pk_mul_f32 v[60:61], v[60:61], v[30:31] op_sel:[0,1] op_sel_hi:[1,1]
v_pk_mul_f32 v[94:95], v[94:95], v[62:63]
v_pk_mul_f32 v[62:63], v[62:63], v[30:31] op_sel:[0,1] op_sel_hi:[1,1]
v_pk_fma_f32 v[40:41], v[40:41], v[24:25], v[24:25] op_sel:[0,1,1] op_sel_hi:[1,1,1]
v_pk_fma_f32 v[42:43], v[42:43], v[24:25], v[24:25] op_sel:[0,1,1] op_sel_hi:[1,1,1]
v_pk_fma_f32 v[56:57], v[56:57], v[24:25], v[24:25] op_sel:[0,1,1] op_sel_hi:[1,1,1]
v_pk_fma_f32 v[58:59], v[58:59], v[24:25], v[24:25] op_sel:[0,1,1] op_sel_hi:[1,1,1]
v_cvt_pk_bf16_f32 v36, v68, v69
v_cvt_pk_bf16_f32 v37, v70, v71
v_cvt_pk_bf16_f32 v38, v84, v85
v_cvt_pk_bf16_f32 v39, v86, v87
MAA 128,112,128
buffer_store_dwordx4 v[36:39], v10, s[16:19], s62 offen offset:1024 sc1
MAA 128,116,144
TR 84,17,59136
v_rcp_f32 v40, v40
s_waitcnt lgkmcnt(15)
MAA 128,208,160
TR 86,17,59648
v_rcp_f32 v41, v41
MAA 128,212,176
TR 88,17,50720
v_rcp_f32 v42, v42
MAA 144,220,176
TR 90,17,51232
v_rcp_f32 v43, v43
MAA 144,216,160
TR 92,17,59168
v_rcp_f32 v56, v56
MAA 144,124,144
TR 94,17,59680
v_rcp_f32 v57, v57
MAA 144,120,128
v_rcp_f32 v58, v58
MAA 96,192,160
v_rcp_f32 v59, v59
MAA 96,196,176
v_exp_f32 v44, v44
MAA 112,204,176
v_exp_f32 v45, v45
MAA 112,200,160
v_lshrrev_b32 v69, 2, v0
v_min_u32 v69, 1, v69
v_lshlrev_b32 v69, 28, v69
v_lshl_add_u32 v68, v0, 7, v69
v_xor_b32 v69, 64, v0
v_min_u32 v69, 1, v69
v_lshlrev_b32 v70, 4, v69
v_sub_u32 v70, 16, v70
v_lshlrev_b32 v69, 28, v69
v_mov_b32 v71, 1
s_waitcnt lgkmcnt(0)
s_barrier
v_mov_b32 v84, 0
v_mov_b32 v85, 0
v_mov_b32 v86, 0
v_exp_f32 v46, v46
v_exp_f32 v47, v47
v_exp_f32 v60, v60
v_exp_f32 v61, v61
v_exp_f32 v62, v62
v_exp_f32 v63, v63
v_pk_mul_f32 v[72:73], v[72:73], v[40:41]
v_pk_mul_f32 v[74:75], v[74:75], v[42:43]
v_pk_mul_f32 v[88:89], v[88:89], v[56:57]
v_pk_mul_f32 v[90:91], v[90:91], v[58:59]
v_pk_mul_f32 v[128:129], v[128:129], v[96:97]
v_pk_mul_f32 v[96:97], v[96:97], v[28:29] op_sel_hi:[1,0]
v_pk_mul_f32 v[130:131], v[130:131], v[98:99]
v_pk_mul_f32 v[98:99], v[98:99], v[28:29] op_sel_hi:[1,0]
v_pk_mul_f32 v[144:145], v[144:145], v[112:113]
v_pk_mul_f32 v[112:113], v[112:113], v[28:29] op_sel_hi:[1,0]
v_pk_mul_f32 v[146:147], v[146:147], v[114:115]
v_pk_mul_f32 v[114:115], v[114:115], v[28:29] op_sel_hi:[1,0]
v_pk_fma_f32 v[44:45], v[44:45], v[26:27], v[26:27] op_sel:[0,1,1] op_sel_hi:[1,1,1]
v_pk_fma_f32 v[46:47], v[46:47], v[26:27], v[26:27] op_sel:[0,1,1] op_sel_hi:[1,1,1]
v_pk_fma_f32 v[60:61], v[60:61], v[26:27], v[26:27] op_sel:[0,1,1] op_sel_hi:[1,1,1]
v_pk_fma_f32 v[62:63], v[62:63], v[26:27], v[26:27] op_sel:[0,1,1] op_sel_hi:[1,1,1]
v_cvt_pk_bf16_f32 v40, v72, v73
v_cvt_pk_bf16_f32 v41, v74, v75
v_cvt_pk_bf16_f32 v42, v88, v89
v_cvt_pk_bf16_f32 v43, v90, v91
MAA 132,112,132
buffer_store_dwordx4 v[40:43], v11, s[16:19], s62 offen sc1
MAA 132,116,148
s_add_u32 m0, s59, 84480
v_rcp_f32 v44, v44
MAA 132,208,164
v_rcp_f32 v45, v45
MAA 132,212,180
v_rcp_f32 v46, v46
MAA 148,220,180
buffer_load_dwordx4 v18, s[28:31], s58 offen lds
MAA 148,216,164
v_rcp_f32 v47, v47
MAA 148,124,148
v_rcp_f32 v60, v60
MAA 148,120,132
v_rcp_f32 v61, v61
MAA 100,192,164
buffer_load_dwordx4 v19, s[28:31], s58 offen offset:1056 lds
MAA 100,196,180
s_add_u32 m0, s59, 92928
s_add_u32 s58, s99, 2555904
v_rcp_f32 v62, v62
MAA 116,204,180
v_rcp_f32 v63, v63
MAA 116,200,164
v_exp_f32 v96, v96
v_exp_f32 v97, v97
v_exp_f32 v98, v98
v_exp_f32 v99, v99
v_exp_f32 v112, v112
v_exp_f32 v113, v113
v_exp_f32 v114, v114
v_exp_f32 v115, v115
v_pk_mul_f32 v[76:77], v[76:77], v[44:45]
v_pk_mul_f32 v[78:79], v[78:79], v[46:47]
v_pk_mul_f32 v[92:93], v[92:93], v[60:61]
v_pk_mul_f32 v[94:95], v[94:95], v[62:63]
v_pk_mul_f32 v[132:133], v[132:133], v[100:101]
v_pk_mul_f32 v[100:101], v[100:101], v[28:29] op_sel:[0,1] op_sel_hi:[1,1]
v_pk_mul_f32 v[134:135], v[134:135], v[102:103]
v_pk_mul_f32 v[102:103], v[102:103], v[28:29] op_sel:[0,1] op_sel_hi:[1,1]
v_pk_mul_f32 v[148:149], v[148:149], v[116:117]
v_pk_mul_f32 v[116:117], v[116:117], v[28:29] op_sel:[0,1] op_sel_hi:[1,1]
v_pk_mul_f32 v[150:151], v[150:151], v[118:119]
v_pk_mul_f32 v[118:119], v[118:119], v[28:29] op_sel:[0,1] op_sel_hi:[1,1]
v_pk_fma_f32 v[96:97], v[96:97], v[20:21], v[20:21] op_sel:[0,1,1] op_sel_hi:[1,1,1]
v_pk_fma_f32 v[98:99], v[98:99], v[20:21], v[20:21] op_sel:[0,1,1] op_sel_hi:[1,1,1]
v_pk_fma_f32 v[112:113], v[112:113], v[20:21], v[20:21] op_sel:[0,1,1] op_sel_hi:[1,1,1]
v_pk_fma_f32 v[114:115], v[114:115], v[20:21], v[20:21] op_sel:[0,1,1] op_sel_hi:[1,1,1]
v_cvt_pk_bf16_f32 v44, v76, v77
v_cvt_pk_bf16_f32 v45, v78, v79
v_cvt_pk_bf16_f32 v46, v92, v93
v_cvt_pk_bf16_f32 v47, v94, v95
MAA 136,112,136
buffer_store_dwordx4 v[44:47], v11, s[16:19], s62 offen offset:1024 sc1
MAA 136,116,152
v_rcp_f32 v96, v96
MAA 136,208,168
v_rcp_f32 v97, v97
MAA 136,212,184
v_rcp_f32 v98, v98
MAA 152,220,184
buffer_load_dwordx4 v18, s[28:31], s58 offen lds
MAA 152,216,168
v_rcp_f32 v99, v99
MAA 152,124,152
v_rcp_f32 v112, v112
MAA 152,120,136
v_rcp_f32 v113, v113
MAA 104,192,168
buffer_load_dwordx4 v19, s[28:31], s58 offen offset:1056 lds
MAA 104,196,184
s_add_u32 m0, s59, 101376
s_add_u32 s58, s100, 2752512
v_rcp_f32 v114, v114
MAA 120,204,184
v_rcp_f32 v115, v115
MAA 120,200,168
v_exp_f32 v100, v100
v_exp_f32 v101, v101
v_exp_f32 v102, v102
v_exp_f32 v103, v103
v_exp_f32 v116, v116
v_exp_f32 v117, v117
v_exp_f32 v118, v118
v_exp_f32 v119, v119
v_pk_mul_f32 v[128:129], v[128:129], v[96:97]
v_pk_mul_f32 v[130:131], v[130:131], v[98:99]
v_pk_mul_f32 v[144:145], v[144:145], v[112:113]
v_pk_mul_f32 v[146:147], v[146:147], v[114:115]
v_pk_mul_f32 v[136:137], v[136:137], v[104:105]
v_pk_mul_f32 v[104:105], v[104:105], v[30:31] op_sel_hi:[1,0]
v_pk_mul_f32 v[138:139], v[138:139], v[106:107]
v_pk_mul_f32 v[106:107], v[106:107], v[30:31] op_sel_hi:[1,0]
v_pk_mul_f32 v[152:153], v[152:153], v[120:121]
v_pk_mul_f32 v[120:121], v[120:121], v[30:31] op_sel_hi:[1,0]
v_pk_mul_f32 v[154:155], v[154:155], v[122:123]
v_pk_mul_f32 v[122:123], v[122:123], v[30:31] op_sel_hi:[1,0]
v_pk_fma_f32 v[100:101], v[100:101], v[22:23], v[22:23] op_sel:[0,1,1] op_sel_hi:[1,1,1]
v_pk_fma_f32 v[102:103], v[102:103], v[22:23], v[22:23] op_sel:[0,1,1] op_sel_hi:[1,1,1]
v_pk_fma_f32 v[116:117], v[116:117], v[22:23], v[22:23] op_sel:[0,1,1] op_sel_hi:[1,1,1]
v_pk_fma_f32 v[118:119], v[118:119], v[22:23], v[22:23] op_sel:[0,1,1] op_sel_hi:[1,1,1]
v_cvt_pk_bf16_f32 v96, v128, v129
v_cvt_pk_bf16_f32 v97, v130, v131
v_cvt_pk_bf16_f32 v98, v144, v145
v_cvt_pk_bf16_f32 v99, v146, v147
MAA 140,112,140
buffer_store_dwordx4 v[96:99], v10, s[16:19], s63 offen sc1
MAA 140,116,156
v_rcp_f32 v100, v100
MAA 140,208,172
v_rcp_f32 v101, v101
MAA 140,212,188
v_rcp_f32 v102, v102
MAA 156,220,188
buffer_load_dwordx4 v18, s[28:31], s58 offen lds
MAA 156,216,172
v_rcp_f32 v103, v103
MAA 156,124,156
v_rcp_f32 v116, v116
MAA 156,120,140
v_rcp_f32 v117, v117
MAA 108,192,172
buffer_load_dwordx4 v19, s[28:31], s58 offen offset:1056 lds
MAA 108,196,188
s_add_u32 m0, s59, 109824
s_add_u32 s58, s100, 3014656
v_rcp_f32 v118, v118
MAA 124,204,188
v_rcp_f32 v119, v119
MAA 124,200,172
v_exp_f32 v104, v104
v_exp_f32 v105, v105
v_exp_f32 v106, v106
v_exp_f32 v107, v107
v_exp_f32 v120, v120
v_exp_f32 v121, v121
v_exp_f32 v122, v122
v_exp_f32 v123, v123
v_pk_mul_f32 v[132:133], v[132:133], v[100:101]
v_pk_mul_f32 v[134:135], v[134:135], v[102:103]
v_pk_mul_f32 v[148:149], v[148:149], v[116:117]
v_pk_mul_f32 v[150:151], v[150:151], v[118:119]
v_pk_mul_f32 v[140:141], v[140:141], v[108:109]
v_pk_mul_f32 v[108:109], v[108:109], v[30:31] op_sel:[0,1] op_sel_hi:[1,1]
v_pk_mul_f32 v[142:143], v[142:143], v[110:111]
v_pk_mul_f32 v[110:111], v[110:111], v[30:31] op_sel:[0,1] op_sel_hi:[1,1]
v_pk_mul_f32 v[156:157], v[156:157], v[124:125]
v_pk_mul_f32 v[124:125], v[124:125], v[30:31] op_sel:[0,1] op_sel_hi:[1,1]
v_pk_mul_f32 v[158:159], v[158:159], v[126:127]
v_pk_mul_f32 v[126:127], v[126:127], v[30:31] op_sel:[0,1] op_sel_hi:[1,1]
v_pk_fma_f32 v[104:105], v[104:105], v[24:25], v[24:25] op_sel:[0,1,1] op_sel_hi:[1,1,1]
v_pk_fma_f32 v[106:107], v[106:107], v[24:25], v[24:25] op_sel:[0,1,1] op_sel_hi:[1,1,1]
v_pk_fma_f32 v[120:121], v[120:121], v[24:25], v[24:25] op_sel:[0,1,1] op_sel_hi:[1,1,1]
v_pk_fma_f32 v[122:123], v[122:123], v[24:25], v[24:25] op_sel:[0,1,1] op_sel_hi:[1,1,1]
v_cvt_pk_bf16_f32 v100, v132, v133
v_cvt_pk_bf16_f32 v101, v134, v135
v_cvt_pk_bf16_f32 v102, v148, v149
v_cvt_pk_bf16_f32 v103, v150, v151
MAA 192,0,128
buffer_store_dwordx4 v[100:103], v10, s[16:19], s63 offen offset:1024 sc1
MAA 192,4,144
v_rcp_f32 v104, v104
MAA 192,32,160
s_waitcnt vmcnt(6)
s_barrier
v_rcp_f32 v105, v105
MAA 192,36,176
v_rcp_f32 v106, v106
MAA 208,44,176
.Lpad27:
s_cbranch_execz .Lpad30
buffer_atomic_add v71, v68, s[16:19], s72 offen offset:512
MAA 208,40,160
v_rcp_f32 v107, v107
MAA 208,12,144
v_rcp_f32 v120, v120
MAA 208,8,128
v_rcp_f32 v121, v121
MAA 160,16,160
buffer_load_dwordx4 v18, s[28:31], s58 offen lds
MAA 160,20,176
v_rcp_f32 v122, v122
MAA 176,28,176
v_rcp_f32 v123, v123
MAA 176,24,160
v_exp_f32 v108, v108
v_exp_f32 v109, v109
v_exp_f32 v110, v110
v_exp_f32 v111, v111
v_exp_f32 v124, v124
v_exp_f32 v125, v125
v_exp_f32 v126, v126
v_exp_f32 v127, v127
v_pk_mul_f32 v[136:137], v[136:137], v[104:105]
v_pk_mul_f32 v[138:139], v[138:139], v[106:107]
v_pk_mul_f32 v[152:153], v[152:153], v[120:121]
v_pk_mul_f32 v[154:155], v[154:155], v[122:123]
v_pk_mul_f32 v[192:193], v[192:193], v[160:161]
v_pk_mul_f32 v[160:161], v[160:161], v[28:29] op_sel_hi:[1,0]
v_pk_mul_f32 v[194:195], v[194:195], v[162:163]
v_pk_mul_f32 v[162:163], v[162:163], v[28:29] op_sel_hi:[1,0]
v_pk_mul_f32 v[208:209], v[208:209], v[176:177]
v_pk_mul_f32 v[176:177], v[176:177], v[28:29] op_sel_hi:[1,0]
v_pk_mul_f32 v[210:211], v[210:211], v[178:179]
v_pk_mul_f32 v[178:179], v[178:179], v[28:29] op_sel_hi:[1,0]
v_pk_fma_f32 v[108:109], v[108:109], v[26:27], v[26:27] op_sel:[0,1,1] op_sel_hi:[1,1,1]
v_pk_fma_f32 v[110:111], v[110:111], v[26:27], v[26:27] op_sel:[0,1,1] op_sel_hi:[1,1,1]
v_pk_fma_f32 v[124:125], v[124:125], v[26:27], v[26:27] op_sel:[0,1,1] op_sel_hi:[1,1,1]
v_pk_fma_f32 v[126:127], v[126:127], v[26:27], v[26:27] op_sel:[0,1,1] op_sel_hi:[1,1,1]
v_cvt_pk_bf16_f32 v104, v136, v137
v_cvt_pk_bf16_f32 v105, v138, v139
v_cvt_pk_bf16_f32 v106, v152, v153
v_cvt_pk_bf16_f32 v107, v154, v155
MAA 196,0,132
buffer_store_dwordx4 v[104:107], v11, s[16:19], s63 offen sc1
MAA 196,4,148
v_rcp_f32 v108, v108
MAA 196,32,164
v_rcp_f32 v109, v109
MAA 196,36,180
v_rcp_f32 v110, v110
MAA 212,44,180
buffer_load_dwordx4 v19, s[28:31], s58 offen offset:1056 lds
MAA 212,40,164
s_add_u32 m0, s59, 118272
s_add_u32 s58, s101, 3211264
v_rcp_f32 v111, v111
MAA 212,12,148
v_rcp_f32 v124, v124
MAA 212,8,132
v_rcp_f32 v125, v125
MAA 164,16,164
buffer_load_dwordx4 v18, s[28:31], s58 offen lds
MAA 164,20,180
v_rcp_f32 v126, v126
MAA 180,28,180
v_rcp_f32 v127, v127
MAA 180,24,164
v_exp_f32 v160, v160
v_exp_f32 v161, v161
v_exp_f32 v162, v162
v_exp_f32 v163, v163
v_exp_f32 v176, v176
v_exp_f32 v177, v177
v_exp_f32 v178, v178
v_exp_f32 v179, v179
v_pk_mul_f32 v[140:141], v[140:141], v[108:109]
v_pk_mul_f32 v[142:143], v[142:143], v[110:111]
v_pk_mul_f32 v[156:157], v[156:157], v[124:125]
v_pk_mul_f32 v[158:159], v[158:159], v[126:127]
v_pk_mul_f32 v[196:197], v[196:197], v[164:165]
v_pk_mul_f32 v[164:165], v[164:165], v[28:29] op_sel:[0,1] op_sel_hi:[1,1]
v_pk_mul_f32 v[198:199], v[198:199], v[166:167]
v_pk_mul_f32 v[166:167], v[166:167], v[28:29] op_sel:[0,1] op_sel_hi:[1,1]
v_pk_mul_f32 v[212:213], v[212:213], v[180:181]
v_pk_mul_f32 v[180:181], v[180:181], v[28:29] op_sel:[0,1] op_sel_hi:[1,1]
v_pk_mul_f32 v[214:215], v[214:215], v[182:183]
v_pk_mul_f32 v[182:183], v[182:183], v[28:29] op_sel:[0,1] op_sel_hi:[1,1]
v_pk_fma_f32 v[160:161], v[160:161], v[20:21], v[20:21] op_sel:[0,1,1] op_sel_hi:[1,1,1]
v_pk_fma_f32 v[162:163], v[162:163], v[20:21], v[20:21] op_sel:[0,1,1] op_sel_hi:[1,1,1]
v_pk_fma_f32 v[176:177], v[176:177], v[20:21], v[20:21] op_sel:[0,1,1] op_sel_hi:[1,1,1]
v_pk_fma_f32 v[178:179], v[178:179], v[20:21], v[20:21] op_sel:[0,1,1] op_sel_hi:[1,1,1]
v_cvt_pk_bf16_f32 v108, v140, v141
v_cvt_pk_bf16_f32 v109, v142, v143
v_cvt_pk_bf16_f32 v110, v156, v157
v_cvt_pk_bf16_f32 v111, v158, v159
MAA 200,0,136
buffer_store_dwordx4 v[108:111], v11, s[16:19], s63 offen offset:1024 sc1
MAA 200,4,152
v_rcp_f32 v160, v160
MAA 200,32,168
v_rcp_f32 v161, v161
MAA 200,36,184
v_rcp_f32 v162, v162
MAA 216,44,184
buffer_load_dwordx4 v19, s[28:31], s58 offen offset:1056 lds
MAA 216,40,168
s_add_u32 m0, s59, 126720
s_add_u32 s58, s101, 3473408
v_rcp_f32 v163, v163
MAA 216,12,152
v_rcp_f32 v176, v176
MAA 216,8,136
v_rcp_f32 v177, v177
MAA 168,16,168
buffer_load_dwordx4 v18, s[28:31], s58 offen lds
MAA 168,20,184
v_rcp_f32 v178, v178
MAA 184,28,184
v_rcp_f32 v179, v179
MAA 184,24,168
v_exp_f32 v164, v164
v_exp_f32 v165, v165
v_exp_f32 v166, v166
v_exp_f32 v167, v167
v_exp_f32 v180, v180
v_exp_f32 v181, v181
v_exp_f32 v182, v182
v_exp_f32 v183, v183
v_pk_mul_f32 v[192:193], v[192:193], v[160:161]
v_pk_mul_f32 v[194:195], v[194:195], v[162:163]
v_pk_mul_f32 v[208:209], v[208:209], v[176:177]
v_pk_mul_f32 v[210:211], v[210:211], v[178:179]
v_pk_mul_f32 v[200:201], v[200:201], v[168:169]
v_pk_mul_f32 v[168:169], v[168:169], v[30:31] op_sel_hi:[1,0]
v_pk_mul_f32 v[202:203], v[202:203], v[170:171]
v_pk_mul_f32 v[170:171], v[170:171], v[30:31] op_sel_hi:[1,0]
v_pk_mul_f32 v[216:217], v[216:217], v[184:185]
v_pk_mul_f32 v[184:185], v[184:185], v[30:31] op_sel_hi:[1,0]
v_pk_mul_f32 v[218:219], v[218:219], v[186:187]
v_pk_mul_f32 v[186:187], v[186:187], v[30:31] op_sel_hi:[1,0]
v_pk_fma_f32 v[164:165], v[164:165], v[22:23], v[22:23] op_sel:[0,1,1] op_sel_hi:[1,1,1]
v_pk_fma_f32 v[166:167], v[166:167], v[22:23], v[22:23] op_sel:[0,1,1] op_sel_hi:[1,1,1]
v_pk_fma_f32 v[180:181], v[180:181], v[22:23], v[22:23] op_sel:[0,1,1] op_sel_hi:[1,1,1]
v_pk_fma_f32 v[182:183], v[182:183], v[22:23], v[22:23] op_sel:[0,1,1] op_sel_hi:[1,1,1]
v_cvt_pk_bf16_f32 v160, v192, v193
v_cvt_pk_bf16_f32 v161, v194, v195
v_cvt_pk_bf16_f32 v162, v208, v209
v_cvt_pk_bf16_f32 v163, v210, v211
MAA 204,0,140
buffer_store_dwordx4 v[160:163], v10, s[16:19], s64 offen sc1
MAA 204,4,156
v_rcp_f32 v164, v164
MAA 204,32,172
v_rcp_f32 v165, v165
MAA 204,36,188
v_rcp_f32 v166, v166
MAA 220,44,188
buffer_atomic_add v84, v69, s[16:19], s73 offen offset:512 sc0
MAA 220,40,172
v_rcp_f32 v167, v167
MAA 220,12,156
v_rcp_f32 v180, v180
MAA 220,8,140
v_rcp_f32 v181, v181
MAA 172,16,172
buffer_load_dwordx4 v19, s[28:31], s58 offen offset:1056 lds
MAA 172,20,188
v_rcp_f32 v182, v182
MAA 188,28,188
v_rcp_f32 v183, v183
MAA 188,24,172
v_exp_f32 v168, v168
v_exp_f32 v169, v169
v_exp_f32 v170, v170
v_exp_f32 v171, v171
v_exp_f32 v184, v184
v_exp_f32 v185, v185
v_exp_f32 v186, v186
v_exp_f32 v187, v187
v_pk_mul_f32 v[196:197], v[196:197], v[164:165]
v_pk_mul_f32 v[198:199], v[198:199], v[166:167]
v_pk_mul_f32 v[212:213], v[212:213], v[180:181]
v_pk_mul_f32 v[214:215], v[214:215], v[182:183]
v_pk_mul_f32 v[204:205], v[204:205], v[172:173]
v_pk_mul_f32 v[172:173], v[172:173], v[30:31] op_sel:[0,1] op_sel_hi:[1,1]
v_pk_mul_f32 v[206:207], v[206:207], v[174:175]
v_pk_mul_f32 v[174:175], v[174:175], v[30:31] op_sel:[0,1] op_sel_hi:[1,1]
v_pk_mul_f32 v[220:221], v[220:221], v[188:189]
v_pk_mul_f32 v[188:189], v[188:189], v[30:31] op_sel:[0,1] op_sel_hi:[1,1]
v_pk_mul_f32 v[222:223], v[222:223], v[190:191]
v_pk_mul_f32 v[190:191], v[190:191], v[30:31] op_sel:[0,1] op_sel_hi:[1,1]
v_pk_fma_f32 v[168:169], v[168:169], v[24:25], v[24:25] op_sel:[0,1,1] op_sel_hi:[1,1,1]
v_pk_fma_f32 v[170:171], v[170:171], v[24:25], v[24:25] op_sel:[0,1,1] op_sel_hi:[1,1,1]
v_pk_fma_f32 v[184:185], v[184:185], v[24:25], v[24:25] op_sel:[0,1,1] op_sel_hi:[1,1,1]
v_pk_fma_f32 v[186:187], v[186:187], v[24:25], v[24:25] op_sel:[0,1,1] op_sel_hi:[1,1,1]
v_cvt_pk_bf16_f32 v164, v196, v197
v_cvt_pk_bf16_f32 v165, v198, v199
v_cvt_pk_bf16_f32 v166, v212, v213
v_cvt_pk_bf16_f32 v167, v214, v215
MAA 240,48,128
buffer_store_dwordx4 v[164:167], v10, s[16:19], s64 offen offset:1024 sc1
MAA 240,52,144
v_rcp_f32 v168, v168
MAA 240,80,160
v_rcp_f32 v169, v169
MAA 240,84,176
v_rcp_f32 v170, v170
MAA 248,92,176
buffer_atomic_add v85, v69, s[16:19], s73 offen offset:512 sc0
MAA 248,88,160
v_rcp_f32 v171, v171
MAA 248,60,144
v_rcp_f32 v184, v184
MAA 248,56,128
v_rcp_f32 v185, v185
MAA 224,64,160
v_rcp_f32 v186, v186
MAA 224,68,176
v_rcp_f32 v187, v187
MAA 232,76,176
v_exp_f32 v172, v172
MAA 232,72,160
v_exp_f32 v173, v173
v_exp_f32 v174, v174
v_exp_f32 v175, v175
v_exp_f32 v188, v188
v_exp_f32 v189, v189
v_exp_f32 v190, v190
v_exp_f32 v191, v191
v_pk_mul_f32 v[200:201], v[200:201], v[168:169]
v_pk_mul_f32 v[202:203], v[202:203], v[170:171]
v_pk_mul_f32 v[216:217], v[216:217], v[184:185]
v_pk_mul_f32 v[218:219], v[218:219], v[186:187]
v_pk_mul_f32 v[240:241], v[240:241], v[224:225]
v_pk_mul_f32 v[224:225], v[224:225], v[28:29] op_sel_hi:[1,0]
v_pk_mul_f32 v[242:243], v[242:243], v[226:227]
v_pk_mul_f32 v[226:227], v[226:227], v[28:29] op_sel_hi:[1,0]
v_pk_mul_f32 v[248:249], v[248:249], v[232:233]
v_pk_mul_f32 v[232:233], v[232:233], v[28:29] op_sel_hi:[1,0]
v_pk_mul_f32 v[250:251], v[250:251], v[234:235]
v_pk_mul_f32 v[234:235], v[234:235], v[28:29] op_sel_hi:[1,0]
v_pk_fma_f32 v[172:173], v[172:173], v[26:27], v[26:27] op_sel:[0,1,1] op_sel_hi:[1,1,1]
v_pk_fma_f32 v[174:175], v[174:175], v[26:27], v[26:27] op_sel:[0,1,1] op_sel_hi:[1,1,1]
v_pk_fma_f32 v[188:189], v[188:189], v[26:27], v[26:27] op_sel:[0,1,1] op_sel_hi:[1,1,1]
v_pk_fma_f32 v[190:191], v[190:191], v[26:27], v[26:27] op_sel:[0,1,1] op_sel_hi:[1,1,1]
v_cvt_pk_bf16_f32 v168, v200, v201
v_cvt_pk_bf16_f32 v169, v202, v203
v_cvt_pk_bf16_f32 v170, v216, v217
v_cvt_pk_bf16_f32 v171, v218, v219
buffer_store_dwordx4 v[168:171], v11, s[16:19], s64 offen sc1
buffer_atomic_add v86, v69, s[16:19], s73 offen offset:512 sc0
s_waitcnt vmcnt(5)
v_cmp_gt_u32 vcc, v70, v84
s_nop 0
s_cbranch_vccz .Lok66
s_waitcnt vmcnt(2)
v_cmp_gt_u32 vcc, v70, v85
s_nop 0
s_cbranch_vccz .Lok66
s_waitcnt vmcnt(0)
v_cmp_gt_u32 vcc, v70, v86
s_nop 0
s_cbranch_vccz .Lok66
s_mov_b32 s15, 0
.Lok66l:
v_mov_b32 v84, 0
buffer_atomic_add v84, v69, s[16:19], s73 offen offset:512 sc0
s_add_u32 s15, s15, 1
s_cmp_gt_u32 s15, 100000
s_waitcnt vmcnt(0)
s_cbranch_scc1 .Lok66
v_cmp_gt_u32 vcc, v70, v84
s_nop 0
s_cbranch_vccnz .Lok66l
.Lok66:
s_waitcnt vmcnt(4)
s_barrier
MAA 244,48,132
ds_read_b64_tr_b16 a[0:1], v7
s_add_u32 s52, s76, 0
MAA 244,52,148
buffer_load_dwordx4 v[96:99], v4, s[16:19], s52 offen sc1
MAA 244,80,164
TR 2,7,512
v_rcp_f32 v172, v172
MAA 244,84,180
TR 4,7,32
v_rcp_f32 v173, v173
MAA 252,92,180
TR 6,7,544
v_rcp_f32 v174, v174
MAA 252,88,164
buffer_load_dwordx4 v[100:103], v4, s[16:19], s52 offen offset:1024 sc1
MAA 252,60,148
TR 8,7,64
s_add_u32 s52, s76, 65536
MAA 252,56,132
TR 10,7,576
v_rcp_f32 v175, v175
MAA 228,64,164
TR 12,7,96
v_rcp_f32 v188, v188
MAA 228,68,180
buffer_load_dwordx4 v[104:107], v4, s[16:19], s52 offen sc1
MAA 236,76,180
TR 14,7,608
v_rcp_f32 v189, v189
MAA 236,72,164
TR 16,7,8448
v_rcp_f32 v190, v190
v_rcp_f32 v191, v191
v_exp_f32 v224, v224
v_exp_f32 v225, v225
v_exp_f32 v226, v226
v_exp_f32 v227, v227
v_exp_f32 v232, v232
v_exp_f32 v233, v233
v_exp_f32 v234, v234
v_exp_f32 v235, v235
v_pk_mul_f32 v[204:205], v[204:205], v[172:173]
buffer_load_dwordx4 v[108:111], v4, s[16:19], s52 offen offset:1024 sc1
s_add_u32 s52, s77, 114688
v_pk_mul_f32 v[206:207], v[206:207], v[174:175]
v_pk_mul_f32 v[220:221], v[220:221], v[188:189]
v_pk_mul_f32 v[222:223], v[222:223], v[190:191]
v_pk_mul_f32 v[244:245], v[244:245], v[228:229]
v_pk_mul_f32 v[228:229], v[228:229], v[28:29] op_sel:[0,1] op_sel_hi:[1,1]
v_pk_mul_f32 v[246:247], v[246:247], v[230:231]
v_pk_mul_f32 v[230:231], v[230:231], v[28:29] op_sel:[0,1] op_sel_hi:[1,1]
v_pk_mul_f32 v[252:253], v[252:253], v[236:237]
v_pk_mul_f32 v[236:237], v[236:237], v[28:29] op_sel:[0,1] op_sel_hi:[1,1]
v_pk_mul_f32 v[254:255], v[254:255], v[238:239]
v_pk_mul_f32 v[238:239], v[238:239], v[28:29] op_sel:[0,1] op_sel_hi:[1,1]
v_pk_fma_f32 v[224:225], v[224:225], v[20:21], v[20:21] op_sel:[0,1,1] op_sel_hi:[1,1,1]
buffer_load_dwordx4 v[112:115], v4, s[16:19], s52 offen sc1
v_pk_fma_f32 v[226:227], v[226:227], v[20:21], v[20:21] op_sel:[0,1,1] op_sel_hi:[1,1,1]
v_pk_fma_f32 v[232:233], v[232:233], v[20:21], v[20:21] op_sel:[0,1,1] op_sel_hi:[1,1,1]
v_pk_fma_f32 v[234:235], v[234:235], v[20:21], v[20:21] op_sel:[0,1,1] op_sel_hi:[1,1,1]
v_cvt_pk_bf16_f32 v172, v204, v205
v_cvt_pk_bf16_f32 v173, v206, v207
v_cvt_pk_bf16_f32 v174, v220, v221
v_cvt_pk_bf16_f32 v175, v222, v223
TR 18,7,8960
TR 20,7,8480
TR 22,7,8992
buffer_store_dwordx4 v[172:175], v11, s[16:19], s64 offen offset:1024 sc1
TR 24,7,8512
TR 26,7,9024
TR 28,7,8544
TR 30,7,9056
v_rcp_f32 v224, v224
v_rcp_f32 v225, v225
v_rcp_f32 v226, v226
v_rcp_f32 v227, v227
v_rcp_f32 v232, v232
v_rcp_f32 v233, v233
v_rcp_f32 v234, v234
v_rcp_f32 v235, v235
v_exp_f32 v228, v228
v_exp_f32 v229, v229
v_exp_f32 v230, v230
v_exp_f32 v231, v231
v_exp_f32 v236, v236
v_exp_f32 v237, v237
v_exp_f32 v238, v238
v_exp_f32 v239, v239
v_pk_mul_f32 v[240:241], v[240:241], v[224:225]
buffer_load_dwordx4 v[116:119], v4, s[16:19], s52 offen offset:1024 sc1
s_add_u32 s52, s77, 180224
v_pk_mul_f32 v[242:243], v[242:243], v[226:227]
v_pk_mul_f32 v[248:249], v[248:249], v[232:233]
v_pk_mul_f32 v[250:251], v[250:251], v[234:235]
v_pk_fma_f32 v[228:229], v[228:229], v[22:23], v[22:23] op_sel:[0,1,1] op_sel_hi:[1,1,1]
v_pk_fma_f32 v[230:231], v[230:231], v[22:23], v[22:23] op_sel:[0,1,1] op_sel_hi:[1,1,1]
v_pk_fma_f32 v[236:237], v[236:237], v[22:23], v[22:23] op_sel:[0,1,1] op_sel_hi:[1,1,1]
v_pk_fma_f32 v[238:239], v[238:239], v[22:23], v[22:23] op_sel:[0,1,1] op_sel_hi:[1,1,1]
v_cvt_pk_bf16_f32 v224, v240, v241
v_cvt_pk_bf16_f32 v225, v242, v243
v_cvt_pk_bf16_f32 v226, v248, v249
v_cvt_pk_bf16_f32 v227, v250, v251
v_rcp_f32 v228, v228
v_rcp_f32 v229, v229
v_rcp_f32 v230, v230
v_rcp_f32 v231, v231
v_rcp_f32 v236, v236
v_rcp_f32 v237, v237
v_rcp_f32 v238, v238
v_rcp_f32 v239, v239
v_pk_mul_f32 v[244:245], v[244:245], v[228:229]
buffer_store_dwordx4 v[224:227], v10, s[16:19], s65 offen sc1
v_pk_mul_f32 v[246:247], v[246:247], v[230:231]
v_pk_mul_f32 v[252:253], v[252:253], v[236:237]
v_pk_mul_f32 v[254:255], v[254:255], v[238:239]
v_cvt_pk_bf16_f32 v228, v244, v245
v_cvt_pk_bf16_f32 v229, v246, v247
v_cvt_pk_bf16_f32 v230, v252, v253
v_cvt_pk_bf16_f32 v231, v254, v255
buffer_store_dwordx4 v[228:231], v10, s[16:19], s65 offen offset:1024 sc1
buffer_load_dwordx4 v[120:123], v4, s[16:19], s52 offen sc1
buffer_load_dwordx4 v[124:127], v4, s[16:19], s52 offen offset:1024 sc1
v_mov_b32 v21, v68
v_mov_b32 v22, v69
v_mov_b32 v23, v70
v_mov_b32 v24, v71
v_mov_b32 v25, 0
s_waitcnt vmcnt(7) lgkmcnt(0)
s_barrier
v_mfma_f32_16x16x32_bf16 v[32:35], a[0:3], v[96:99], 0
ds_read_b64_tr_b16 a[32:33], v6
s_add_u32 s52, s78, 229376
MAV 32,16,104
buffer_load_dwordx4 v[128:131], v4, s[16:19], s52 offen sc1
v_mfma_f32_16x16x32_bf16 v[48:51], a[0:3], v[100:103], 0
TR 34,6,512
MAV 48,16,108
TR 36,6,32
TR 38,6,544
v_mfma_f32_16x16x32_bf16 v[52:55], a[4:7], v[100:103], 0
TR 48,6,8448
MAV 52,20,108
buffer_load_dwordx4 v[132:135], v4, s[16:19], s52 offen offset:1024 sc1
v_mfma_f32_16x16x32_bf16 v[36:39], a[4:7], v[96:99], 0
TR 50,6,8960
MAV 36,20,104
TR 52,6,8480
TR 54,6,8992
v_mfma_f32_16x16x32_bf16 v[40:43], a[8:11], v[96:99], 0
TR 40,6,64
s_add_u32 s52, s78, 294912
MAV 40,24,104
buffer_load_dwordx4 v[136:139], v4, s[16:19], s52 offen sc1
v_mfma_f32_16x16x32_bf16 v[56:59], a[8:11], v[100:103], 0
TR 42,6,576
MAV 56,24,108
TR 44,6,96
TR 46,6,608
v_mfma_f32_16x16x32_bf16 v[60:63], a[12:15], v[100:103], 0
TR 56,6,8512
MAV 60,28,108
buffer_load_dwordx4 v[140:143], v4, s[16:19], s52 offen offset:1024 sc1
v_mfma_f32_16x16x32_bf16 v[44:47], a[12:15], v[96:99], 0
TR 58,6,9024
MAV 44,28,104
TR 60,6,8544
TR 62,6,9056
s_waitcnt lgkmcnt(8)
v_mfma_f32_16x16x32_bf16 v[64:67], a[32:35], v[96:99], 0
TR 0,7,16896
s_add_u32 s52, s79, 344064
MAV 64,48,104
buffer_load_dwordx4 v[144:147], v4, s[16:19], s52 offen sc1
v_mfma_f32_16x16x32_bf16 v[80:83], a[32:35], v[100:103], 0
TR 2,7,17408
MAV 80,48,108
TR 4,7,16928
TR 6,7,17440
v_mfma_f32_16x16x32_bf16 v[84:87], a[36:39], v[100:103], 0
TR 16,7,25344
MAV 84,52,108
buffer_load_dwordx4 v[148:151], v4, s[16:19], s52 offen offset:1024 sc1
v_mfma_f32_16x16x32_bf16 v[68:71], a[36:39], v[96:99], 0
TR 18,7,25856
MAV 68,52,104
TR 20,7,25376
TR 22,7,25888
s_waitcnt lgkmcnt(8)
v_mfma_f32_16x16x32_bf16 v[72:75], a[40:43], v[96:99], 0
TR 8,7,16960
s_add_u32 s52, s79, 409600
MAV 72,56,104
buffer_load_dwordx4 v[152:155], v4, s[16:19], s52 offen sc1
v_mfma_f32_16x16x32_bf16 v[88:91], a[40:43], v[100:103], 0
TR 10,7,17472
MAV 88,56,108
TR 12,7,16992
TR 14,7,17504
v_mfma_f32_16x16x32_bf16 v[92:95], a[44:47], v[100:103], 0
TR 24,7,25408
MAV 92,60,108
buffer_load_dwordx4 v[156:159], v4, s[16:19], s52 offen offset:1024 sc1
v_mfma_f32_16x16x32_bf16 v[76:79], a[44:47], v[96:99], 0
TR 26,7,25920
MAV 76,60,104
TR 28,7,25440
TR 30,7,25952
s_waitcnt vmcnt(8) lgkmcnt(8)
s_barrier
MAV 32,0,112
TR 32,6,16896
MAV 32,16,120
buffer_atomic_add v24, v21, s[16:19], s72 offen
MAV 48,16,124
TR 34,6,17408
MAV 48,0,116
TR 36,6,16928
TR 38,6,17440
TR 48,6,25344
MAV 52,4,116
TR 50,6,25856
s_add_u32 m0, s55, 0
MAV 52,20,124
buffer_load_dwordx4 v18, s[28:31], s54 offen lds
MAV 36,20,120
TR 52,6,25376
MAV 36,4,112
TR 54,6,25888
TR 40,6,16960
s_waitcnt lgkmcnt(9)
MAV 40,8,112
TR 42,6,17472
s_add_u32 s52, s76, 458752
MAV 40,24,120
buffer_load_dwordx4 v[96:99], v4, s[16:19], s52 offen sc1
MAV 56,24,124
TR 44,6,16992
MAV 56,8,116
buffer_load_dwordx4 v19, s[28:31], s54 offen offset:1056 lds
MAV 60,12,116
TR 46,6,17504
s_add_u32 s54, s98, 327680
MAV 60,28,124
buffer_load_dwordx4 v[100:103], v4, s[16:19], s52 offen offset:1024 sc1
MAV 44,28,120
TR 56,6,25408
MAV 44,12,112
TR 58,6,25920
TR 60,6,25440
TR 62,6,25952
s_waitcnt lgkmcnt(8)
MAV 64,32,112
TR 0,7,33792
s_add_u32 m0, s55, 8448
MAV 64,48,120
buffer_load_dwordx4 v18, s[28:31], s54 offen lds
MAV 80,48,124
TR 2,7,34304
MAV 80,32,116
TR 4,7,33824
TR 6,7,34336
MAV 84,36,116
TR 16,7,42240
s_add_u32 s52, s76, 524288
MAV 84,52,124
buffer_load_dwordx4 v[104:107], v4, s[16:19], s52 offen sc1
MAV 68,52,120
TR 18,7,42752
MAV 68,36,112
TR 20,7,42272
TR 22,7,42784
s_waitcnt lgkmcnt(8)
MAV 72,40,112
TR 8,7,33856
MAV 72,56,120
buffer_load_dwordx4 v19, s[28:31], s54 offen offset:1056 lds
MAV 88,56,124
TR 10,7,34368
s_add_u32 s54, s99, 524288
MAV 88,40,116
TR 12,7,33888
TR 14,7,34400
MAV 92,44,116
TR 24,7,42304
MAV 92,60,124
buffer_load_dwordx4 v[108:111], v4, s[16:19], s52 offen offset:1024 sc1
MAV 76,60,120
TR 26,7,42816
MAV 76,44,112
TR 28,7,42336
TR 30,7,42848
s_waitcnt vmcnt(13) lgkmcnt(8)
s_barrier
MAV 32,0,128
TR 32,6,33792
s_add_u32 m0, s55, 16896
MAV 32,16,136
buffer_load_dwordx4 v18, s[28:31], s54 offen lds
MAV 48,16,140
TR 34,6,34304
MAV 48,0,132
TR 36,6,33824
TR 38,6,34336
MAV 52,4,132
TR 48,6,42240
s_add_u32 s52, s77, 573440
MAV 52,20,140
buffer_load_dwordx4 v[112:115], v4, s[16:19], s52 offen sc1
MAV 36,20,136
TR 50,6,42752
MAV 36,4,128
TR 52,6,42272
TR 54,6,42784
s_waitcnt lgkmcnt(8)
MAV 40,8,128
.Lpad28:
s_cbranch_execz .Lpad31
TR 40,6,33856
MAV 40,24,136
buffer_load_dwordx4 v19, s[28:31], s54 offen offset:1056 lds
MAV 56,24,140
TR 42,6,34368
s_add_u32 s54, s99, 786432
MAV 56,8,132
TR 44,6,33888
TR 46,6,34400
MAV 60,12,132
TR 56,6,42304
MAV 60,28,140
buffer_load_dwordx4 v[116:119], v4, s[16:19], s52 offen offset:1024 sc1
MAV 44,28,136
TR 58,6,42816
MAV 44,12,128
TR 60,6,42336
TR 62,6,42848
s_waitcnt lgkmcnt(8)
MAV 64,32,128
TR 0,7,50688
s_add_u32 m0, s55, 25344
MAV 64,48,136
buffer_load_dwordx4 v18, s[28:31], s54 offen lds
MAV 80,48,140
TR 2,7,51200
MAV 80,32,132
TR 4,7,50720
TR 6,7,51232
TR 16,7,59136
MAV 84,36,132
TR 18,7,59648
s_add_u32 s52, s77, 638976
MAV 84,52,140
buffer_load_dwordx4 v[120:123], v4, s[16:19], s52 offen sc1
MAV 68,52,136
TR 20,7,59168
MAV 68,36,128
TR 22,7,59680
TR 8,7,50752
s_waitcnt lgkmcnt(9)
MAV 72,40,128
TR 10,7,51264
MAV 72,56,136
buffer_load_dwordx4 v19, s[28:31], s54 offen offset:1056 lds
MAV 88,56,140
TR 12,7,50784
s_add_u32 s54, s100, 983040
MAV 88,40,132
buffer_load_dwordx4 v[124:127], v4, s[16:19], s52 offen offset:1024 sc1
MAV 92,44,132
TR 14,7,51296
MAV 92,60,140
buffer_atomic_add v25, v22, s[16:19], s73 offen sc0
MAV 76,60,136
TR 24,7,59200
MAV 76,44,128
TR 26,7,59712
TR 28,7,59232
TR 30,7,59744
s_waitcnt vmcnt(18) lgkmcnt(8)
s_barrier
MAV 32,0,144
TR 32,6,50688
s_add_u32 m0, s55, 33792
MAV 32,16,152
buffer_load_dwordx4 v18, s[28:31], s54 offen lds
MAV 48,16,156
TR 34,6,51200
MAV 48,0,148
TR 36,6,50720
TR 38,6,51232
MAV 52,4,148
TR 48,6,59136
s_add_u32 s52, s78, 688128
MAV 52,20,156
buffer_load_dwordx4 v[128:131], v4, s[16:19], s52 offen sc1
MAV 36,20,152
TR 50,6,59648
MAV 36,4,144
TR 52,6,59168
TR 54,6,59680
s_waitcnt lgkmcnt(8)
MAV 40,8,144
TR 40,6,50752
MAV 40,24,152
buffer_load_dwordx4 v19, s[28:31], s54 offen offset:1056 lds
MAV 56,24,156
TR 42,6,51264
s_add_u32 s54, s100, 1245184
MAV 56,8,148
TR 44,6,50784
TR 46,6,51296
MAV 60,12,148
TR 56,6,59200
MAV 60,28,156
buffer_load_dwordx4 v[132:135], v4, s[16:19], s52 offen offset:1024 sc1
MAV 44,28,152
TR 58,6,59712
MAV 44,12,144
TR 60,6,59232
TR 62,6,59744
v_add_u32 v7, s57, v7
v_add_u32 v6, s57, v6
s_sub_u32 s57, 0, s57
s_waitcnt lgkmcnt(8)
MAV 64,32,144
ds_read_b64_tr_b16 a[0:1], v7
s_add_u32 m0, s55, 42240
MAV 64,48,152
buffer_load_dwordx4 v18, s[28:31], s54 offen lds
MAV 80,48,156
TR 2,7,512
MAV 80,32,148
TR 4,7,32
TR 6,7,544
MAV 84,36,148
TR 16,7,8448
s_add_u32 s52, s78, 753664
MAV 84,52,156
buffer_load_dwordx4 v[136:139], v4, s[16:19], s52 offen sc1
MAV 68,52,152
TR 18,7,8960
MAV 68,36,144
TR 20,7,8480
TR 22,7,8992
s_waitcnt lgkmcnt(8)
MAV 72,40,144
TR 8,7,64
MAV 72,56,152
buffer_load_dwordx4 v19, s[28:31], s54 offen offset:1056 lds
MAV 88,56,156
TR 10,7,576
s_add_u32 s54, s101, 1441792
MAV 88,40,148
TR 12,7,96
TR 14,7,608
MAV 92,44,148
TR 24,7,8512
MAV 92,60,156
buffer_load_dwordx4 v[140:143], v4, s[16:19], s52 offen offset:1024 sc1
MAV 76,60,152
TR 26,7,9024
MAV 76,44,144
TR 28,7,8544
TR 30,7,9056
s_waitcnt vmcnt(17) lgkmcnt(8)
s_barrier
MAV 32,0,96
ds_read_b64_tr_b16 a[32:33], v6
s_add_u32 m0, s55, 50688
MAV 32,16,104
buffer_load_dwordx4 v18, s[28:31], s54 offen lds
MAV 48,16,108
TR 34,6,512
MAV 48,0,100
TR 36,6,32
TR 38,6,544
MAV 52,4,100
TR 48,6,8448
s_add_u32 s52, s79, 802816
MAV 52,20,108
buffer_load_dwordx4 v[144:147], v4, s[16:19], s52 offen sc1
MAV 36,20,104
TR 50,6,8960
MAV 36,4,96
TR 52,6,8480
TR 54,6,8992
s_waitcnt lgkmcnt(8)
MAV 40,8,96
TR 40,6,64
MAV 40,24,104
buffer_load_dwordx4 v19, s[28:31], s54 offen offset:1056 lds
MAV 56,24,108
TR 42,6,576
s_add_u32 s54, s101, 1703936
MAV 56,8,100
TR 44,6,96
TR 46,6,608
MAV 60,12,100
TR 56,6,8512
MAV 60,28,108
buffer_load_dwordx4 v[148:151], v4, s[16:19], s52 offen offset:1024 sc1
MAV 44,28,104
TR 58,6,9024
MAV 44,12,96
TR 60,6,8544
TR 62,6,9056
s_waitcnt lgkmcnt(8)
MAV 64,32,96
TR 0,7,16896
s_add_u32 m0, s55, 59136
MAV 64,48,104
buffer_load_dwordx4 v18, s[28:31], s54 offen lds
MAV 80,48,108
TR 2,7,17408
MAV 80,32,100
TR 4,7,16928
TR 6,7,17440
MAV 84,36,100
TR 16,7,25344
s_add_u32 s52, s79, 868352
MAV 84,52,108
buffer_load_dwordx4 v[152:155], v4, s[16:19], s52 offen sc1
MAV 68,52,104
TR 18,7,25856
MAV 68,36,96
TR 20,7,25376
TR 22,7,25888
s_waitcnt lgkmcnt(8)
MAV 72,40,96
TR 8,7,16960
MAV 72,56,104
buffer_load_dwordx4 v19, s[28:31], s54 offen offset:1056 lds
MAV 88,56,108
TR 10,7,17472
s_add_u32 s54, s98, 1900544
MAV 88,40,100
TR 12,7,16992
TR 14,7,17504
MAV 92,44,100
TR 24,7,25408
MAV 92,60,108
buffer_load_dwordx4 v[156:159], v4, s[16:19], s52 offen offset:1024 sc1
MAV 76,60,104
TR 26,7,25920
MAV 76,44,96
TR 28,7,25440
TR 30,7,25952
s_waitcnt vmcnt(16)
v_cmp_gt_u32 vcc, v23, v25
s_nop 0
s_cbranch_vccnz .Lsp67
.Lsp67b:
s_waitcnt lgkmcnt(8)
s_barrier
MAV 32,0,112
TR 32,6,16896
s_add_u32 m0, s55, 67584
MAV 32,16,120
buffer_load_dwordx4 v18, s[28:31], s54 offen lds
MAV 48,16,124
TR 34,6,17408
MAV 48,0,116
TR 36,6,16928
TR 38,6,17440
MAV 52,4,116
TR 48,6,25344
s_add_u32 s52, s76, 16384
MAV 52,20,124
buffer_load_dwordx4 v[96:99], v4, s[16:19], s52 offen sc1
MAV 36,20,120
TR 50,6,25856
MAV 36,4,112
TR 52,6,25376
TR 54,6,25888
s_waitcnt lgkmcnt(8)
MAV 40,8,112
TR 40,6,16960
MAV 40,24,120
buffer_load_dwordx4 v19, s[28:31], s54 offen offset:1056 lds
MAV 56,24,124
TR 42,6,17472
s_add_u32 s54, s98, 2162688
MAV 56,8,116
TR 44,6,16992
TR 46,6,17504
MAV 60,12,116
TR 56,6,25408
MAV 60,28,124
buffer_load_dwordx4 v[100:103], v4, s[16:19], s52 offen offset:1024 sc1
MAV 44,28,120
TR 58,6,25920
MAV 44,12,112
TR 60,6,25440
TR 62,6,25952
s_waitcnt lgkmcnt(8)
MAV 64,32,112
TR 0,7,33792
s_add_u32 m0, s55, 76032
MAV 64,48,120
buffer_load_dwordx4 v18, s[28:31], s54 offen lds
MAV 80,48,124
TR 2,7,34304
MAV 80,32,116
TR 4,7,33824
TR 6,7,34336
MAV 84,36,116
TR 16,7,42240
s_add_u32 s52, s76, 81920
MAV 84,52,124
buffer_load_dwordx4 v[104:107], v4, s[16:19], s52 offen sc1
MAV 68,52,120
TR 18,7,42752
MAV 68,36,112
TR 20,7,42272
TR 22,7,42784
s_waitcnt lgkmcnt(8)
MAV 72,40,112
TR 8,7,33856
MAV 72,56,120
buffer_load_dwordx4 v19, s[28:31], s54 offen offset:1056 lds
MAV 88,56,124
TR 10,7,34368
s_add_u32 s54, s99, 2359296
MAV 88,40,116
TR 12,7,33888
TR 14,7,34400
MAV 92,44,116
TR 24,7,42304
MAV 92,60,124
buffer_load_dwordx4 v[108:111], v4, s[16:19], s52 offen offset:1024 sc1
MAV 76,60,120
TR 26,7,42816
MAV 76,44,112
TR 28,7,42336
TR 30,7,42848
s_waitcnt vmcnt(16) lgkmcnt(8)
s_barrier
MAV 32,0,128
TR 32,6,33792
s_add_u32 m0, s55, 84480
MAV 32,16,136
buffer_load_dwordx4 v18, s[28:31], s54 offen lds
MAV 48,16,140
TR 34,6,34304
MAV 48,0,132
TR 36,6,33824
TR 38,6,34336
MAV 52,4,132
TR 48,6,42240
s_add_u32 s52, s77, 131072
MAV 52,20,140
buffer_load_dwordx4 v[112:115], v4, s[16:19], s52 offen sc1
MAV 36,20,136
TR 50,6,42752
MAV 36,4,128
TR 52,6,42272
TR 54,6,42784
s_waitcnt lgkmcnt(8)
MAV 40,8,128
TR 40,6,33856
MAV 40,24,136
buffer_load_dwordx4 v19, s[28:31], s54 offen offset:1056 lds
MAV 56,24,140
TR 42,6,34368
s_add_u32 s54, s99, 2621440
MAV 56,8,132
TR 44,6,33888
TR 46,6,34400
MAV 60,12,132
TR 56,6,42304
MAV 60,28,140
buffer_load_dwordx4 v[116:119], v4, s[16:19], s52 offen offset:1024 sc1
MAV 44,28,136
TR 58,6,42816
MAV 44,12,128
TR 60,6,42336
TR 62,6,42848
s_waitcnt lgkmcnt(8)
MAV 64,32,128
TR 0,7,50688
s_add_u32 m0, s55, 92928
MAV 64,48,136
buffer_load_dwordx4 v18, s[28:31], s54 offen lds
MAV 80,48,140
TR 2,7,51200
MAV 80,32,132
TR 4,7,50720
TR 6,7,51232
MAV 84,36,132
TR 16,7,59136
s_add_u32 s52, s77, 196608
MAV 84,52,140
buffer_load_dwordx4 v[120:123], v4, s[16:19], s52 offen sc1
MAV 68,52,136
TR 18,7,59648
MAV 68,36,128
TR 20,7,59168
TR 22,7,59680
s_waitcnt lgkmcnt(8)
MAV 72,40,128
TR 8,7,50752
MAV 72,56,136
buffer_load_dwordx4 v19, s[28:31], s54 offen offset:1056 lds
MAV 88,56,140
TR 10,7,51264
s_add_u32 s54, s100, 2818048
MAV 88,40,132
TR 12,7,50784
TR 14,7,51296
MAV 92,44,132
TR 24,7,59200
MAV 92,60,140
buffer_load_dwordx4 v[124:127], v4, s[16:19], s52 offen offset:1024 sc1
MAV 76,60,136
TR 26,7,59712
MAV 76,44,128
TR 28,7,59232
TR 30,7,59744
s_waitcnt vmcnt(16) lgkmcnt(8)
s_barrier
MAV 32,0,144
TR 32,6,50688
s_add_u32 m0, s55, 101376
MAV 32,16,152
buffer_load_dwordx4 v18, s[28:31], s54 offen lds
MAV 48,16,156
TR 34,6,51200
MAV 48,0,148
TR 36,6,50720
TR 38,6,51232
MAV 52,4,148
TR 48,6,59136
s_add_u32 s52, s78, 245760
MAV 52,20,156
buffer_load_dwordx4 v[128:131], v4, s[16:19], s52 offen sc1
MAV 36,20,152
TR 50,6,59648
MAV 36,4,144
TR 52,6,59168
TR 54,6,59680
s_waitcnt lgkmcnt(8)
MAV 40,8,144
TR 40,6,50752
MAV 40,24,152
buffer_load_dwordx4 v19, s[28:31], s54 offen offset:1056 lds
MAV 56,24,156
TR 42,6,51264
s_add_u32 s54, s100, 3080192
MAV 56,8,148
TR 44,6,50784
TR 46,6,51296
MAV 60,12,148
TR 56,6,59200
MAV 60,28,156
buffer_load_dwordx4 v[132:135], v4, s[16:19], s52 offen offset:1024 sc1
MAV 44,28,152
TR 58,6,59712
MAV 44,12,144
TR 60,6,59232
TR 62,6,59744
v_add_u32 v7, s57, v7
v_add_u32 v6, s57, v6
s_sub_u32 s57, 0, s57
s_waitcnt lgkmcnt(8)
MAV 64,32,144
ds_read_b64_tr_b16 a[0:1], v7
s_add_u32 m0, s55, 109824
MAV 64,48,152
buffer_load_dwordx4 v18, s[28:31], s54 offen lds
MAV 80,48,156
TR 2,7,512
MAV 80,32,148
TR 4,7,32
TR 6,7,544
MAV 84,36,148
TR 16,7,8448
s_add_u32 s52, s78, 311296
MAV 84,52,156
buffer_load_dwordx4 v[136:139], v4, s[16:19], s52 offen sc1
MAV 68,52,152
TR 18,7,8960
MAV 68,36,144
TR 20,7,8480
TR 22,7,8992
s_waitcnt lgkmcnt(8)
MAV 72,40,144
TR 8,7,64
MAV 72,56,152
buffer_load_dwordx4 v19, s[28:31], s54 offen offset:1056 lds
MAV 88,56,156
TR 10,7,576
s_add_u32 s54, s101, 3276800
MAV 88,40,148
TR 12,7,96
TR 14,7,608
MAV 92,44,148
TR 24,7,8512
MAV 92,60,156
buffer_load_dwordx4 v[140:143], v4, s[16:19], s52 offen offset:1024 sc1
MAV 76,60,152
TR 26,7,9024
MAV 76,44,144
TR 28,7,8544
TR 30,7,9056
s_waitcnt vmcnt(16) lgkmcnt(8)
s_barrier
MAV 32,0,96
ds_read_b64_tr_b16 a[32:33], v6
s_add_u32 m0, s55, 118272
MAV 32,16,104
buffer_load_dwordx4 v18, s[28:31], s54 offen lds
MAV 48,16,108
TR 34,6,512
MAV 48,0,100
TR 36,6,32
TR 38,6,544
MAV 52,4,100
TR 48,6,8448
s_add_u32 s52, s79, 360448
MAV 52,20,108
buffer_load_dwordx4 v[144:147], v4, s[16:19], s52 offen sc1
MAV 36,20,104
TR 50,6,8960
MAV 36,4,96
TR 52,6,8480
TR 54,6,8992
s_waitcnt lgkmcnt(8)
MAV 40,8,96
TR 40,6,64
MAV 40,24,104
buffer_load_dwordx4 v19, s[28:31], s54 offen offset:1056 lds
MAV 56,24,108
TR 42,6,576
s_add_u32 s54, s101, 3538944
MAV 56,8,100
TR 44,6,96
TR 46,6,608
MAV 60,12,100
TR 56,6,8512
MAV 60,28,108
buffer_load_dwordx4 v[148:151], v4, s[16:19], s52 offen offset:1024 sc1
MAV 44,28,104
TR 58,6,9024
MAV 44,12,96
TR 60,6,8544
TR 62,6,9056
s_waitcnt lgkmcnt(8)
MAV 64,32,96
TR 0,7,16896
s_add_u32 m0, s55, 126720
MAV 64,48,104
.Lpad29:
s_cbranch_execz .Lpad32
buffer_load_dwordx4 v18, s[28:31], s54 offen lds
MAV 80,48,108
TR 2,7,17408
MAV 80,32,100
TR 4,7,16928
TR 6,7,17440
MAV 84,36,100
TR 16,7,25344
s_add_u32 s52, s79, 425984
MAV 84,52,108
buffer_load_dwordx4 v[152:155], v4, s[16:19], s52 offen sc1
MAV 68,52,104
TR 18,7,25856
MAV 68,36,96
TR 20,7,25376
TR 22,7,25888
s_waitcnt lgkmcnt(8)
MAV 72,40,96
TR 8,7,16960
MAV 72,56,104
buffer_load_dwordx4 v19, s[28:31], s54 offen offset:1056 lds
MAV 88,56,108
TR 10,7,17472
s_add_u32 s54, s98, 131072
MAV 88,40,100
TR 12,7,16992
TR 14,7,17504
MAV 92,44,100
TR 24,7,25408
MAV 92,60,108
buffer_load_dwordx4 v[156:159], v4, s[16:19], s52 offen offset:1024 sc1
MAV 76,60,104
TR 26,7,25920
MAV 76,44,96
TR 28,7,25440
TR 30,7,25952
s_waitcnt vmcnt(16) lgkmcnt(8)
s_barrier
MAV 32,0,112
TR 32,6,16896
s_add_u32 m0, s55, 0
MAV 32,16,120
buffer_load_dwordx4 v18, s[28:31], s54 offen lds
MAV 48,16,124
TR 34,6,17408
MAV 48,0,116
TR 36,6,16928
TR 38,6,17440
MAV 52,4,116
TR 48,6,25344
s_add_u32 s52, s76, 475136
MAV 52,20,124
buffer_load_dwordx4 v[96:99], v4, s[16:19], s52 offen sc1
MAV 36,20,120
TR 50,6,25856
MAV 36,4,112
TR 52,6,25376
TR 54,6,25888
s_waitcnt lgkmcnt(8)
MAV 40,8,112
TR 40,6,16960
MAV 40,24,120
buffer_load_dwordx4 v19, s[28:31], s54 offen offset:1056 lds
MAV 56,24,124
TR 42,6,17472
s_add_u32 s54, s98, 393216
MAV 56,8,116
TR 44,6,16992
TR 46,6,17504
MAV 60,12,116
TR 56,6,25408
MAV 60,28,124
buffer_load_dwordx4 v[100:103], v4, s[16:19], s52 offen offset:1024 sc1
MAV 44,28,120
TR 58,6,25920
MAV 44,12,112
TR 60,6,25440
TR 62,6,25952
s_waitcnt lgkmcnt(8)
MAV 64,32,112
TR 0,7,33792
s_add_u32 m0, s55, 8448
MAV 64,48,120
buffer_load_dwordx4 v18, s[28:31], s54 offen lds
MAV 80,48,124
TR 2,7,34304
MAV 80,32,116
TR 4,7,33824
TR 6,7,34336
MAV 84,36,116
TR 16,7,42240
s_add_u32 s52, s76, 540672
MAV 84,52,124
buffer_load_dwordx4 v[104:107], v4, s[16:19], s52 offen sc1
MAV 68,52,120
TR 18,7,42752
MAV 68,36,112
TR 20,7,42272
TR 22,7,42784
s_waitcnt lgkmcnt(8)
MAV 72,40,112
TR 8,7,33856
MAV 72,56,120
buffer_load_dwordx4 v19, s[28:31], s54 offen offset:1056 lds
MAV 88,56,124
TR 10,7,34368
s_add_u32 s54, s99, 589824
MAV 88,40,116
TR 12,7,33888
TR 14,7,34400
MAV 92,44,116
TR 24,7,42304
MAV 92,60,124
buffer_load_dwordx4 v[108:111], v4, s[16:19], s52 offen offset:1024 sc1
MAV 76,60,120
TR 26,7,42816
MAV 76,44,112
TR 28,7,42336
TR 30,7,42848
s_waitcnt vmcnt(16) lgkmcnt(8)
s_barrier
MAV 32,0,128
TR 32,6,33792
s_add_u32 m0, s55, 16896
MAV 32,16,136
buffer_load_dwordx4 v18, s[28:31], s54 offen lds
MAV 48,16,140
TR 34,6,34304
MAV 48,0,132
TR 36,6,33824
TR 38,6,34336
MAV 52,4,132
TR 48,6,42240
s_add_u32 s52, s77, 589824
MAV 52,20,140
buffer_load_dwordx4 v[112:115], v4, s[16:19], s52 offen sc1
MAV 36,20,136
TR 50,6,42752
MAV 36,4,128
TR 52,6,42272
TR 54,6,42784
s_waitcnt lgkmcnt(8)
MAV 40,8,128
TR 40,6,33856
MAV 40,24,136
buffer_load_dwordx4 v19, s[28:31], s54 offen offset:1056 lds
MAV 56,24,140
TR 42,6,34368
s_add_u32 s54, s99, 851968
MAV 56,8,132
TR 44,6,33888
TR 46,6,34400
MAV 60,12,132
TR 56,6,42304
MAV 60,28,140
buffer_load_dwordx4 v[116:119], v4, s[16:19], s52 offen offset:1024 sc1
MAV 44,28,136
TR 58,6,42816
MAV 44,12,128
TR 60,6,42336
TR 62,6,42848
s_waitcnt lgkmcnt(8)
MAV 64,32,128
TR 0,7,50688
s_add_u32 m0, s55, 25344
MAV 64,48,136
buffer_load_dwordx4 v18, s[28:31], s54 offen lds
MAV 80,48,140
TR 2,7,51200
MAV 80,32,132
TR 4,7,50720
TR 6,7,51232
MAV 84,36,132
TR 16,7,59136
s_add_u32 s52, s77, 655360
MAV 84,52,140
buffer_load_dwordx4 v[120:123], v4, s[16:19], s52 offen sc1
MAV 68,52,136
TR 18,7,59648
MAV 68,36,128
TR 20,7,59168
TR 22,7,59680
s_waitcnt lgkmcnt(8)
MAV 72,40,128
TR 8,7,50752
MAV 72,56,136
buffer_load_dwordx4 v19, s[28:31], s54 offen offset:1056 lds
MAV 88,56,140
TR 10,7,51264
s_add_u32 s54, s100, 1048576
MAV 88,40,132
TR 12,7,50784
TR 14,7,51296
MAV 92,44,132
TR 24,7,59200
MAV 92,60,140
buffer_load_dwordx4 v[124:127], v4, s[16:19], s52 offen offset:1024 sc1
MAV 76,60,136
TR 26,7,59712
MAV 76,44,128
TR 28,7,59232
TR 30,7,59744
s_waitcnt vmcnt(16) lgkmcnt(8)
s_barrier
MAV 32,0,144
TR 32,6,50688
s_add_u32 m0, s55, 33792
MAV 32,16,152
buffer_load_dwordx4 v18, s[28:31], s54 offen lds
MAV 48,16,156
TR 34,6,51200
MAV 48,0,148
TR 36,6,50720
TR 38,6,51232
MAV 52,4,148
TR 48,6,59136
s_add_u32 s52, s78, 704512
MAV 52,20,156
buffer_load_dwordx4 v[128:131], v4, s[16:19], s52 offen sc1
MAV 36,20,152
TR 50,6,59648
MAV 36,4,144
TR 52,6,59168
TR 54,6,59680
s_waitcnt lgkmcnt(8)
MAV 40,8,144
TR 40,6,50752
MAV 40,24,152
buffer_load_dwordx4 v19, s[28:31], s54 offen offset:1056 lds
MAV 56,24,156
TR 42,6,51264
s_add_u32 s54, s100, 1310720
MAV 56,8,148
TR 44,6,50784
TR 46,6,51296
MAV 60,12,148
TR 56,6,59200
MAV 60,28,156
buffer_load_dwordx4 v[132:135], v4, s[16:19], s52 offen offset:1024 sc1
MAV 44,28,152
TR 58,6,59712
MAV 44,12,144
TR 60,6,59232
TR 62,6,59744
v_add_u32 v7, s57, v7
v_add_u32 v6, s57, v6
s_sub_u32 s57, 0, s57
s_waitcnt lgkmcnt(8)
MAV 64,32,144
ds_read_b64_tr_b16 a[0:1], v7
s_add_u32 m0, s55, 42240
MAV 64,48,152
buffer_load_dwordx4 v18, s[28:31], s54 offen lds
MAV 80,48,156
TR 2,7,512
MAV 80,32,148
TR 4,7,32
TR 6,7,544
MAV 84,36,148
TR 16,7,8448
s_add_u32 s52, s78, 770048
MAV 84,52,156
buffer_load_dwordx4 v[136:139], v4, s[16:19], s52 offen sc1
MAV 68,52,152
TR 18,7,8960
MAV 68,36,144
TR 20,7,8480
TR 22,7,8992
s_waitcnt lgkmcnt(8)
MAV 72,40,144
TR 8,7,64
MAV 72,56,152
buffer_load_dwordx4 v19, s[28:31], s54 offen offset:1056 lds
MAV 88,56,156
TR 10,7,576
s_add_u32 s54, s101, 1507328
MAV 88,40,148
TR 12,7,96
TR 14,7,608
MAV 92,44,148
TR 24,7,8512
MAV 92,60,156
buffer_load_dwordx4 v[140:143], v4, s[16:19], s52 offen offset:1024 sc1
MAV 76,60,152
TR 26,7,9024
MAV 76,44,144
TR 28,7,8544
TR 30,7,9056
s_waitcnt vmcnt(16) lgkmcnt(8)
s_barrier
MAV 32,0,96
ds_read_b64_tr_b16 a[32:33], v6
s_add_u32 m0, s55, 50688
MAV 32,16,104
buffer_load_dwordx4 v18, s[28:31], s54 offen lds
MAV 48,16,108
TR 34,6,512
MAV 48,0,100
TR 36,6,32
TR 38,6,544
MAV 52,4,100
TR 48,6,8448
s_add_u32 s52, s79, 819200
MAV 52,20,108
buffer_load_dwordx4 v[144:147], v4, s[16:19], s52 offen sc1
MAV 36,20,104
TR 50,6,8960
MAV 36,4,96
TR 52,6,8480
TR 54,6,8992
s_waitcnt lgkmcnt(8)
MAV 40,8,96
TR 40,6,64
MAV 40,24,104
buffer_load_dwordx4 v19, s[28:31], s54 offen offset:1056 lds
MAV 56,24,108
TR 42,6,576
s_add_u32 s54, s101, 1769472
MAV 56,8,100
TR 44,6,96
TR 46,6,608
MAV 60,12,100
TR 56,6,8512
MAV 60,28,108
buffer_load_dwordx4 v[148:151], v4, s[16:19], s52 offen offset:1024 sc1
MAV 44,28,104
TR 58,6,9024
MAV 44,12,96
TR 60,6,8544
TR 62,6,9056
s_waitcnt lgkmcnt(8)
MAV 64,32,96
TR 0,7,16896
s_add_u32 m0, s55, 59136
MAV 64,48,104
buffer_load_dwordx4 v18, s[28:31], s54 offen lds
MAV 80,48,108
TR 2,7,17408
MAV 80,32,100
TR 4,7,16928
TR 6,7,17440
MAV 84,36,100
TR 16,7,25344
s_add_u32 s52, s79, 884736
MAV 84,52,108
buffer_load_dwordx4 v[152:155], v4, s[16:19], s52 offen sc1
MAV 68,52,104
TR 18,7,25856
MAV 68,36,96
TR 20,7,25376
TR 22,7,25888
s_waitcnt lgkmcnt(8)
MAV 72,40,96
TR 8,7,16960
MAV 72,56,104
buffer_load_dwordx4 v19, s[28:31], s54 offen offset:1056 lds
MAV 88,56,108
TR 10,7,17472
s_add_u32 s54, s98, 1966080
MAV 88,40,100
TR 12,7,16992
TR 14,7,17504
MAV 92,44,100
TR 24,7,25408
MAV 92,60,108
buffer_load_dwordx4 v[156:159], v4, s[16:19], s52 offen offset:1024 sc1
MAV 76,60,104
TR 26,7,25920
MAV 76,44,96
TR 28,7,25440
TR 30,7,25952
s_waitcnt vmcnt(16) lgkmcnt(8)
s_barrier
MAV 32,0,112
TR 32,6,16896
s_add_u32 m0, s55, 67584
MAV 32,16,120
buffer_load_dwordx4 v18, s[28:31], s54 offen lds
MAV 48,16,124
TR 34,6,17408
MAV 48,0,116
TR 36,6,16928
TR 38,6,17440
MAV 52,4,116
TR 48,6,25344
s_add_u32 s52, s76, 32768
MAV 52,20,124
buffer_load_dwordx4 v[96:99], v4, s[16:19], s52 offen sc1
MAV 36,20,120
TR 50,6,25856
MAV 36,4,112
TR 52,6,25376
TR 54,6,25888
s_waitcnt lgkmcnt(8)
MAV 40,8,112
TR 40,6,16960
MAV 40,24,120
buffer_load_dwordx4 v19, s[28:31], s54 offen offset:1056 lds
MAV 56,24,124
TR 42,6,17472
s_add_u32 s54, s98, 2228224
MAV 56,8,116
TR 44,6,16992
TR 46,6,17504
MAV 60,12,116
TR 56,6,25408
MAV 60,28,124
buffer_load_dwordx4 v[100:103], v4, s[16:19], s52 offen offset:1024 sc1
MAV 44,28,120
TR 58,6,25920
MAV 44,12,112
TR 60,6,25440
TR 62,6,25952
s_waitcnt lgkmcnt(8)
MAV 64,32,112
TR 0,7,33792
s_add_u32 m0, s55, 76032
MAV 64,48,120
buffer_load_dwordx4 v18, s[28:31], s54 offen lds
MAV 80,48,124
TR 2,7,34304
MAV 80,32,116
TR 4,7,33824
TR 6,7,34336
MAV 84,36,116
TR 16,7,42240
s_add_u32 s52, s76, 98304
MAV 84,52,124
buffer_load_dwordx4 v[104:107], v4, s[16:19], s52 offen sc1
MAV 68,52,120
TR 18,7,42752
MAV 68,36,112
TR 20,7,42272
TR 22,7,42784
s_waitcnt lgkmcnt(8)
MAV 72,40,112
TR 8,7,33856
MAV 72,56,120
buffer_load_dwordx4 v19, s[28:31], s54 offen offset:1056 lds
MAV 88,56,124
TR 10,7,34368
s_add_u32 s54, s99, 2424832
MAV 88,40,116
TR 12,7,33888
TR 14,7,34400
MAV 92,44,116
TR 24,7,42304
MAV 92,60,124
buffer_load_dwordx4 v[108:111], v4, s[16:19], s52 offen offset:1024 sc1
MAV 76,60,120
TR 26,7,42816
MAV 76,44,112
TR 28,7,42336
TR 30,7,42848
s_waitcnt vmcnt(16) lgkmcnt(8)
s_barrier
MAV 32,0,128
TR 32,6,33792
s_add_u32 m0, s55, 84480
MAV 32,16,136
buffer_load_dwordx4 v18, s[28:31], s54 offen lds
MAV 48,16,140
TR 34,6,34304
MAV 48,0,132
TR 36,6,33824
TR 38,6,34336
MAV 52,4,132
TR 48,6,42240
s_add_u32 s52, s77, 147456
MAV 52,20,140
buffer_load_dwordx4 v[112:115], v4, s[16:19], s52 offen sc1
MAV 36,20,136
TR 50,6,42752
MAV 36,4,128
TR 52,6,42272
TR 54,6,42784
s_waitcnt lgkmcnt(8)
MAV 40,8,128
TR 40,6,33856
MAV 40,24,136
buffer_load_dwordx4 v19, s[28:31], s54 offen offset:1056 lds
MAV 56,24,140
TR 42,6,34368
s_add_u32 s54, s99, 2686976
MAV 56,8,132
TR 44,6,33888
TR 46,6,34400
MAV 60,12,132
TR 56,6,42304
MAV 60,28,140
buffer_load_dwordx4 v[116:119], v4, s[16:19], s52 offen offset:1024 sc1
MAV 44,28,136
TR 58,6,42816
MAV 44,12,128
TR 60,6,42336
TR 62,6,42848
s_waitcnt lgkmcnt(8)
MAV 64,32,128
TR 0,7,50688
s_add_u32 m0, s55, 92928
MAV 64,48,136
buffer_load_dwordx4 v18, s[28:31], s54 offen lds
MAV 80,48,140
TR 2,7,51200
MAV 80,32,132
TR 4,7,50720
TR 6,7,51232
MAV 84,36,132
TR 16,7,59136
s_add_u32 s52, s77, 212992
MAV 84,52,140
buffer_load_dwordx4 v[120:123], v4, s[16:19], s52 offen sc1
MAV 68,52,136
TR 18,7,59648
MAV 68,36,128
TR 20,7,59168
TR 22,7,59680
s_waitcnt lgkmcnt(8)
MAV 72,40,128
TR 8,7,50752
MAV 72,56,136
buffer_load_dwordx4 v19, s[28:31], s54 offen offset:1056 lds
MAV 88,56,140
TR 10,7,51264
s_add_u32 s54, s100, 2883584
MAV 88,40,132
TR 12,7,50784
TR 14,7,51296
MAV 92,44,132
.Lpad30:
s_cbranch_execz .Lnopoll63r
TR 24,7,59200
MAV 92,60,140
buffer_load_dwordx4 v[124:127], v4, s[16:19], s52 offen offset:1024 sc1
MAV 76,60,136
TR 26,7,59712
MAV 76,44,128
TR 28,7,59232
TR 30,7,59744
s_waitcnt vmcnt(16) lgkmcnt(8)
s_barrier
MAV 32,0,144
TR 32,6,50688
s_add_u32 m0, s55, 101376
MAV 32,16,152
buffer_load_dwordx4 v18, s[28:31], s54 offen lds
MAV 48,16,156
TR 34,6,51200
MAV 48,0,148
TR 36,6,50720
TR 38,6,51232
MAV 52,4,148
TR 48,6,59136
s_add_u32 s52, s78, 262144
MAV 52,20,156
buffer_load_dwordx4 v[128:131], v4, s[16:19], s52 offen sc1
MAV 36,20,152
TR 50,6,59648
MAV 36,4,144
TR 52,6,59168
TR 54,6,59680
s_waitcnt lgkmcnt(8)
MAV 40,8,144
TR 40,6,50752
MAV 40,24,152
buffer_load_dwordx4 v19, s[28:31], s54 offen offset:1056 lds
MAV 56,24,156
TR 42,6,51264
s_add_u32 s54, s100, 3145728
MAV 56,8,148
TR 44,6,50784
TR 46,6,51296
MAV 60,12,148
TR 56,6,59200
MAV 60,28,156
buffer_load_dwordx4 v[132:135], v4, s[16:19], s52 offen offset:1024 sc1
MAV 44,28,152
TR 58,6,59712
MAV 44,12,144
TR 60,6,59232
TR 62,6,59744
v_add_u32 v7, s57, v7
v_add_u32 v6, s57, v6
s_sub_u32 s57, 0, s57
s_waitcnt lgkmcnt(8)
MAV 64,32,144
ds_read_b64_tr_b16 a[0:1], v7
s_add_u32 m0, s55, 109824
MAV 64,48,152
buffer_load_dwordx4 v18, s[28:31], s54 offen lds
MAV 80,48,156
TR 2,7,512
MAV 80,32,148
TR 4,7,32
TR 6,7,544
MAV 84,36,148
TR 16,7,8448
s_add_u32 s52, s78, 327680
MAV 84,52,156
buffer_load_dwordx4 v[136:139], v4, s[16:19], s52 offen sc1
MAV 68,52,152
TR 18,7,8960
MAV 68,36,144
TR 20,7,8480
TR 22,7,8992
s_waitcnt lgkmcnt(8)
MAV 72,40,144
TR 8,7,64
MAV 72,56,152
buffer_load_dwordx4 v19, s[28:31], s54 offen offset:1056 lds
MAV 88,56,156
TR 10,7,576
s_add_u32 s54, s101, 3342336
MAV 88,40,148
TR 12,7,96
TR 14,7,608
MAV 92,44,148
TR 24,7,8512
MAV 92,60,156
buffer_load_dwordx4 v[140:143], v4, s[16:19], s52 offen offset:1024 sc1
MAV 76,60,152
TR 26,7,9024
MAV 76,44,144
TR 28,7,8544
TR 30,7,9056
s_waitcnt vmcnt(16) lgkmcnt(8)
s_barrier
MAV 32,0,96
ds_read_b64_tr_b16 a[32:33], v6
s_add_u32 m0, s55, 118272
MAV 32,16,104
buffer_load_dwordx4 v18, s[28:31], s54 offen lds
MAV 48,16,108
TR 34,6,512
MAV 48,0,100
TR 36,6,32
TR 38,6,544
MAV 52,4,100
TR 48,6,8448
s_add_u32 s52, s79, 376832
MAV 52,20,108
buffer_load_dwordx4 v[144:147], v4, s[16:19], s52 offen sc1
MAV 36,20,104
TR 50,6,8960
MAV 36,4,96
TR 52,6,8480
TR 54,6,8992
s_waitcnt lgkmcnt(8)
MAV 40,8,96
TR 40,6,64
MAV 40,24,104
buffer_load_dwordx4 v19, s[28:31], s54 offen offset:1056 lds
MAV 56,24,108
TR 42,6,576
s_add_u32 s54, s101, 3604480
MAV 56,8,100
TR 44,6,96
TR 46,6,608
MAV 60,12,100
TR 56,6,8512
MAV 60,28,108
buffer_load_dwordx4 v[148:151], v4, s[16:19], s52 offen offset:1024 sc1
MAV 44,28,104
TR 58,6,9024
MAV 44,12,96
TR 60,6,8544
TR 62,6,9056
s_waitcnt lgkmcnt(8)
MAV 64,32,96
TR 0,7,16896
s_add_u32 m0, s55, 126720
MAV 64,48,104
buffer_load_dwordx4 v18, s[28:31], s54 offen lds
MAV 80,48,108
TR 2,7,17408
MAV 80,32,100
TR 4,7,16928
TR 6,7,17440
MAV 84,36,100
TR 16,7,25344
s_add_u32 s52, s79, 442368
MAV 84,52,108
buffer_load_dwordx4 v[152:155], v4, s[16:19], s52 offen sc1
MAV 68,52,104
TR 18,7,25856
MAV 68,36,96
TR 20,7,25376
TR 22,7,25888
s_waitcnt lgkmcnt(8)
MAV 72,40,96
TR 8,7,16960
MAV 72,56,104
buffer_load_dwordx4 v19, s[28:31], s54 offen offset:1056 lds
MAV 88,56,108
TR 10,7,17472
s_add_u32 s54, s98, 196608
MAV 88,40,100
TR 12,7,16992
TR 14,7,17504
MAV 92,44,100
TR 24,7,25408
MAV 92,60,108
buffer_load_dwordx4 v[156:159], v4, s[16:19], s52 offen offset:1024 sc1
MAV 76,60,104
TR 26,7,25920
MAV 76,44,96
TR 28,7,25440
TR 30,7,25952
s_waitcnt vmcnt(16) lgkmcnt(8)
s_barrier
MAV 32,0,112
TR 32,6,16896
s_add_u32 m0, s55, 0
MAV 32,16,120
buffer_load_dwordx4 v18, s[28:31], s54 offen lds
MAV 48,16,124
TR 34,6,17408
MAV 48,0,116
TR 36,6,16928
TR 38,6,17440
MAV 52,4,116
TR 48,6,25344
s_add_u32 s52, s76, 491520
MAV 52,20,124
buffer_load_dwordx4 v[96:99], v4, s[16:19], s52 offen sc1
MAV 36,20,120
TR 50,6,25856
MAV 36,4,112
TR 52,6,25376
TR 54,6,25888
s_waitcnt lgkmcnt(8)
MAV 40,8,112
TR 40,6,16960
MAV 40,24,120
buffer_load_dwordx4 v19, s[28:31], s54 offen offset:1056 lds
MAV 56,24,124
TR 42,6,17472
s_add_u32 s54, s99, 655360
MAV 56,8,116
TR 44,6,16992
TR 46,6,17504
MAV 60,12,116
TR 56,6,25408
MAV 60,28,124
buffer_load_dwordx4 v[100:103], v4, s[16:19], s52 offen offset:1024 sc1
MAV 44,28,120
TR 58,6,25920
MAV 44,12,112
TR 60,6,25440
TR 62,6,25952
s_waitcnt lgkmcnt(8)
MAV 64,32,112
TR 0,7,33792
s_add_u32 m0, s55, 8448
MAV 64,48,120
buffer_load_dwordx4 v18, s[28:31], s54 offen lds
MAV 80,48,124
TR 2,7,34304
MAV 80,32,116
TR 4,7,33824
TR 6,7,34336
MAV 84,36,116
TR 16,7,42240
s_add_u32 s52, s76, 557056
MAV 84,52,124
buffer_load_dwordx4 v[104:107], v4, s[16:19], s52 offen sc1
MAV 68,52,120
TR 18,7,42752
MAV 68,36,112
TR 20,7,42272
TR 22,7,42784
s_waitcnt lgkmcnt(8)
MAV 72,40,112
TR 8,7,33856
MAV 72,56,120
buffer_load_dwordx4 v19, s[28:31], s54 offen offset:1056 lds
MAV 88,56,124
TR 10,7,34368
s_add_u32 s54, s100, 1114112
MAV 88,40,116
TR 12,7,33888
TR 14,7,34400
MAV 92,44,116
TR 24,7,42304
MAV 92,60,124
buffer_load_dwordx4 v[108:111], v4, s[16:19], s52 offen offset:1024 sc1
MAV 76,60,120
TR 26,7,42816
MAV 76,44,112
TR 28,7,42336
TR 30,7,42848
s_waitcnt vmcnt(16) lgkmcnt(8)
s_barrier
MAV 32,0,128
TR 32,6,33792
s_add_u32 m0, s55, 16896
MAV 32,16,136
buffer_load_dwordx4 v18, s[28:31], s54 offen lds
MAV 48,16,140
TR 34,6,34304
MAV 48,0,132
TR 36,6,33824
TR 38,6,34336
MAV 52,4,132
TR 48,6,42240
s_add_u32 s52, s77, 606208
MAV 52,20,140
buffer_load_dwordx4 v[112:115], v4, s[16:19], s52 offen sc1
MAV 36,20,136
TR 50,6,42752
MAV 36,4,128
TR 52,6,42272
TR 54,6,42784
s_waitcnt lgkmcnt(8)
MAV 40,8,128
TR 40,6,33856
MAV 40,24,136
buffer_load_dwordx4 v19, s[28:31], s54 offen offset:1056 lds
MAV 56,24,140
TR 42,6,34368
s_add_u32 s54, s101, 1572864
MAV 56,8,132
TR 44,6,33888
TR 46,6,34400
MAV 60,12,132
TR 56,6,42304
MAV 60,28,140
buffer_load_dwordx4 v[116:119], v4, s[16:19], s52 offen offset:1024 sc1
MAV 44,28,136
TR 58,6,42816
MAV 44,12,128
TR 60,6,42336
TR 62,6,42848
s_waitcnt lgkmcnt(8)
MAV 64,32,128
TR 0,7,50688
s_add_u32 m0, s55, 25344
MAV 64,48,136
buffer_load_dwordx4 v18, s[28:31], s54 offen lds
MAV 80,48,140
TR 2,7,51200
MAV 80,32,132
TR 4,7,50720
TR 6,7,51232
MAV 84,36,132
TR 16,7,59136
s_add_u32 s52, s77, 671744
MAV 84,52,140
buffer_load_dwordx4 v[120:123], v4, s[16:19], s52 offen sc1
MAV 68,52,136
TR 18,7,59648
MAV 68,36,128
TR 20,7,59168
TR 22,7,59680
s_waitcnt lgkmcnt(8)
MAV 72,40,128
TR 8,7,50752
MAV 72,56,136
buffer_load_dwordx4 v19, s[28:31], s54 offen offset:1056 lds
MAV 88,56,140
TR 10,7,51264
s_add_u32 s54, s98, 2031616
MAV 88,40,132
TR 12,7,50784
TR 14,7,51296
MAV 92,44,132
TR 24,7,59200
MAV 92,60,140
buffer_load_dwordx4 v[124:127], v4, s[16:19], s52 offen offset:1024 sc1
MAV 76,60,136
TR 26,7,59712
MAV 76,44,128
TR 28,7,59232
TR 30,7,59744
s_waitcnt vmcnt(16) lgkmcnt(8)
s_barrier
MAV 32,0,144
TR 32,6,50688
s_add_u32 m0, s55, 33792
MAV 32,16,152
buffer_load_dwordx4 v18, s[28:31], s54 offen lds
MAV 48,16,156
TR 34,6,51200
MAV 48,0,148
TR 36,6,50720
TR 38,6,51232
MAV 52,4,148
TR 48,6,59136
s_add_u32 s52, s78, 720896
MAV 52,20,156
buffer_load_dwordx4 v[128:131], v4, s[16:19], s52 offen sc1
MAV 36,20,152
TR 50,6,59648
MAV 36,4,144
TR 52,6,59168
TR 54,6,59680
s_waitcnt lgkmcnt(8)
MAV 40,8,144
TR 40,6,50752
MAV 40,24,152
buffer_load_dwordx4 v19, s[28:31], s54 offen offset:1056 lds
MAV 56,24,156
TR 42,6,51264
s_add_u32 s54, s99, 2490368
MAV 56,8,148
TR 44,6,50784
TR 46,6,51296
MAV 60,12,148
TR 56,6,59200
MAV 60,28,156
buffer_load_dwordx4 v[132:135], v4, s[16:19], s52 offen offset:1024 sc1
MAV 44,28,152
TR 58,6,59712
MAV 44,12,144
TR 60,6,59232
TR 62,6,59744
v_add_u32 v7, s57, v7
v_add_u32 v6, s57, v6
s_sub_u32 s57, 0, s57
s_waitcnt lgkmcnt(8)
MAV 64,32,144
ds_read_b64_tr_b16 a[0:1], v6
s_add_u32 m0, s55, 42240
MAV 64,48,152
buffer_load_dwordx4 v18, s[28:31], s54 offen lds
MAV 80,48,156
TR 2,6,512
MAV 80,32,148
TR 4,6,32
TR 6,6,544
MAV 84,36,148
TR 16,6,8448
s_add_u32 s52, s78, 786432
MAV 84,52,156
buffer_load_dwordx4 v[136:139], v4, s[16:19], s52 offen sc1
MAV 68,52,152
TR 18,6,8960
MAV 68,36,144
TR 20,6,8480
TR 22,6,8992
s_waitcnt lgkmcnt(8)
MAV 72,40,144
TR 8,6,64
MAV 72,56,152
buffer_load_dwordx4 v19, s[28:31], s54 offen offset:1056 lds
MAV 88,56,156
TR 10,6,576
s_add_u32 s54, s100, 2949120
MAV 88,40,148
TR 12,6,96
TR 14,6,608
MAV 92,44,148
TR 24,6,8512
MAV 92,60,156
buffer_load_dwordx4 v[140:143], v4, s[16:19], s52 offen offset:1024 sc1
MAV 76,60,152
TR 26,6,9024
MAV 76,44,144
TR 28,6,8544
TR 30,6,9056
s_waitcnt vmcnt(16) lgkmcnt(8)
s_barrier
MAV 64,0,96
TR 32,6,16896
TR 34,6,17408
s_add_u32 m0, s55, 50688
MAV 64,16,104
TR 36,6,16928
buffer_load_dwordx4 v18, s[28:31], s54 offen lds
MAV 80,16,108
TR 38,6,17440
MAV 80,0,100
TR 48,6,25344
buffer_load_dwordx4 v19, s[28:31], s54 offen offset:1056 lds
MAV 84,4,100
TR 50,6,25856
s_add_u32 s54, s101, 3407872
s_add_u32 s52, s79, 835584
MAV 84,20,108
buffer_load_dwordx4 v[144:147], v4, s[16:19], s52 offen sc1
MAV 68,20,104
TR 52,6,25376
TR 54,6,25888
MAV 68,4,96
TR 40,6,16960
s_waitcnt lgkmcnt(9)
MAV 72,8,96
TR 42,6,17472
MAV 72,24,104
TR 44,6,16992
buffer_load_dwordx4 v[148:151], v4, s[16:19], s52 offen offset:1024 sc1
MAV 88,24,108
TR 46,6,17504
s_add_u32 m0, s55, 59136
MAV 88,8,100
TR 56,6,25408
buffer_load_dwordx4 v18, s[28:31], s54 offen lds
MAV 92,12,100
TR 58,6,25920
MAV 92,28,108
TR 60,6,25440
buffer_load_dwordx4 v19, s[28:31], s54 offen offset:1056 lds
MAV 76,28,104
TR 62,6,25952
s_add_u32 s52, s79, 901120
MAV 76,12,96
buffer_load_dwordx4 v[152:155], v4, s[16:19], s52 offen sc1
buffer_load_dwordx4 v[156:159], v4, s[16:19], s52 offen offset:1024 sc1
s_waitcnt vmcnt(16) lgkmcnt(8)
MAV 64,32,112
TR 0,6,33792
s_add_u32 s52, s76, 49152
s_lshl_b32 s70, s2, 10
MAV 64,48,120
buffer_load_dwordx4 v[160:163], v4, s[16:19], s52 offen sc1
s_lshl_b32 s62, s3, 7
MAV 80,48,124
TR 2,6,34304
s_add_u32 s70, s70, s62
s_add_u32 s70, s70, 31457792
MAV 80,32,116
TR 4,6,33824
TR 6,6,34336
MAV 84,36,116
TR 16,6,42240
s_xor_b32 s71, s70, 1024
v_min_u32 v12, 1, v1
MAV 84,52,124
buffer_load_dwordx4 v[164:167], v4, s[16:19], s52 offen offset:1024 sc1
v_lshlrev_b32 v12, 28, v12
MAV 68,52,120
TR 18,6,42752
v_mov_b32 v13, 1
MAV 68,36,112
TR 20,6,42272
TR 22,6,42784
s_waitcnt lgkmcnt(8)
MAV 72,40,112
TR 8,6,33856
s_add_u32 s52, s77, 163840
v_mov_b32 v15, 0
MAV 72,56,120
buffer_load_dwordx4 v[168:171], v4, s[16:19], s52 offen sc1
s_lshl_b32 s68, s7, 18
MAV 88,56,124
TR 10,6,34368
s_add_u32 s68, s68, 146800640
s_xor_b32 s69, s68, 262144
MAV 88,40,116
TR 12,6,33888
TR 14,6,34400
MAV 92,44,116
TR 24,6,42304
v_mov_b32 v11, v4
v_and_b32 v2, 1, v1
MAV 92,60,124
buffer_load_dwordx4 v[172:175], v4, s[16:19], s52 offen offset:1024 sc1
v_lshlrev_b32 v2, 4, v2
MAV 76,60,120
TR 26,6,42816
v_mov_b32 v224, 0x3f80
MAV 76,44,112
TR 28,6,42336
TR 30,6,42848
s_waitcnt vmcnt(12) lgkmcnt(8)
MAV 64,0,128
TR 32,6,50688
.Lpad31:
s_cbranch_execz .Lnopoll63r
s_add_u32 s52, s78, 278528
v_lshlrev_b32 v2, v2, v224
MAV 64,16,136
buffer_load_dwordx4 v[176:179], v4, s[16:19], s52 offen sc1
v_bfe_u32 v224, v1, 2, 2
MAV 80,16,140
TR 34,6,51200
v_lshrrev_b32 v225, 4, v1
v_cmp_eq_u32 vcc, v224, v225
MAV 80,0,132
TR 36,6,50720
TR 38,6,51232
MAV 84,4,132
TR 48,6,59136
v_cndmask_b32 v2, 0, v2, vcc
v_and_b32 v224, 2, v1
MAV 84,20,140
buffer_load_dwordx4 v[180:183], v4, s[16:19], s52 offen offset:1024 sc1
v_cmp_eq_u32 vcc, 0, v224
MAV 68,20,136
TR 50,6,59648
v_cndmask_b32 v226, 0, v2, vcc
MAV 68,4,128
TR 52,6,59168
TR 54,6,59680
s_waitcnt lgkmcnt(8)
MAV 72,8,128
TR 40,6,50752
s_add_u32 s52, s79, 393216
v_cndmask_b32 v227, v2, 0, vcc
MAV 72,24,136
buffer_load_dwordx4 v[184:187], v4, s[16:19], s52 offen sc1
v_mov_b32 v224, 0
MAV 88,24,140
TR 42,6,51264
v_mov_b32 v225, 0
v_mov_b32 v228, 0
MAV 88,8,132
TR 44,6,50784
TR 46,6,51296
MAV 92,12,132
TR 56,6,59200
v_mov_b32 v229, 0
s_lshr_b32 s62, s6, 1
MAV 92,28,140
buffer_load_dwordx4 v[188:191], v4, s[16:19], s52 offen offset:1024 sc1
s_lshl_b32 s62, s62, 8
MAV 76,28,136
TR 58,6,59712
s_and_b32 s63, s6, 1
MAV 76,12,128
TR 60,6,59232
TR 62,6,59744
s_waitcnt vmcnt(8) lgkmcnt(8)
s_barrier
v_add_u32 v6, s57, v6
MAV 64,32,144
ds_read_b64_tr_b16 a[0:1], v6
s_add_u32 s52, s76, 507904
s_add_u32 s62, s62, s63
MAV 64,48,152
buffer_load_dwordx4 v[192:195], v4, s[16:19], s52 offen sc1
s_lshl_b32 s63, s3, 6
MAV 80,48,156
TR 2,6,512
s_add_u32 s62, s62, s63
s_lshl_b32 s62, s62, 11
MAV 80,32,148
TR 4,6,32
TR 6,6,544
MAV 84,36,148
TR 16,6,8448
s_lshl_b32 s63, s7, 7
s_add_u32 s62, s62, s63
MAV 84,52,156
buffer_load_dwordx4 v[196:199], v4, s[16:19], s52 offen offset:1024 sc1
v_and_b32 v16, 15, v1
MAV 68,52,152
TR 18,6,8960
v_lshlrev_b32 v16, 12, v16
MAV 68,36,144
TR 20,6,8480
TR 22,6,8992
s_waitcnt lgkmcnt(8)
MAV 72,40,144
TR 8,6,64
s_add_u32 s52, s77, 622592
v_bfe_u32 v2, v1, 4, 1
MAV 72,56,152
buffer_load_dwordx4 v[200:203], v4, s[16:19], s52 offen sc1
v_lshl_add_u32 v16, v2, 5, v16
MAV 88,56,156
TR 10,6,576
v_bfe_u32 v2, v1, 5, 1
v_lshl_add_u32 v16, v2, 4, v16
MAV 88,40,148
TR 12,6,96
TR 14,6,608
MAV 92,44,148
TR 24,6,8512
v_add_u32 v16, s62, v16
v_add_u32 v17, 0x10000, v16
MAV 92,60,156
buffer_load_dwordx4 v[204:207], v4, s[16:19], s52 offen offset:1024 sc1
v_accvgpr_read_b32 v28, a224
MAV 76,60,152
TR 26,6,9024
v_add_f32 v32, v32, v28
MAV 76,44,144
TR 28,6,8544
TR 30,6,9056
s_waitcnt vmcnt(8) lgkmcnt(8)
MAV 64,0,160
TR 32,6,16896
s_add_u32 s52, s78, 737280
v_accvgpr_read_b32 v29, a225
MAV 64,16,168
buffer_load_dwordx4 v[208:211], v4, s[16:19], s52 offen sc1
v_add_f32 v33, v33, v29
MAV 80,16,172
TR 34,6,17408
v_accvgpr_read_b32 v28, a226
v_add_f32 v34, v34, v28
MAV 80,0,164
TR 36,6,16928
TR 38,6,17440
MAV 84,4,164
TR 48,6,25344
v_accvgpr_read_b32 v29, a227
v_add_f32 v35, v35, v29
MAV 84,20,172
buffer_load_dwordx4 v[212:215], v4, s[16:19], s52 offen offset:1024 sc1
v_accvgpr_read_b32 v28, a228
MAV 68,20,168
TR 50,6,25856
v_add_f32 v36, v36, v28
MAV 68,4,160
TR 52,6,25376
TR 54,6,25888
s_waitcnt lgkmcnt(8)
MAV 72,8,160
TR 40,6,16960
s_add_u32 s52, s79, 851968
v_accvgpr_read_b32 v29, a229
MAV 72,24,168
buffer_load_dwordx4 v[216:219], v4, s[16:19], s52 offen sc1
v_add_f32 v37, v37, v29
MAV 88,24,172
TR 42,6,17472
v_accvgpr_read_b32 v28, a230
v_add_f32 v38, v38, v28
MAV 88,8,164
TR 44,6,16992
TR 46,6,17504
MAV 92,12,164
TR 56,6,25408
v_accvgpr_read_b32 v29, a231
v_add_f32 v39, v39, v29
MAV 92,28,172
buffer_load_dwordx4 v[220:223], v4, s[16:19], s52 offen offset:1024 sc1
v_accvgpr_read_b32 v28, a232
MAV 76,28,168
TR 58,6,25920
v_add_f32 v40, v40, v28
MAV 76,12,160
TR 60,6,25440
TR 62,6,25952
s_waitcnt vmcnt(8) lgkmcnt(8)
MAV 64,32,176
TR 0,6,33792
v_accvgpr_read_b32 v29, a233
MAV 64,48,184
TR 2,6,34304
v_add_f32 v41, v41, v29
v_accvgpr_read_b32 v28, a234
MAV 80,48,188
TR 4,6,33824
MAV 80,32,180
TR 6,6,34336
v_add_f32 v42, v42, v28
v_accvgpr_read_b32 v29, a235
MAV 84,36,180
TR 16,6,42240
MAV 84,52,188
TR 18,6,42752
v_add_f32 v43, v43, v29
v_accvgpr_read_b32 v28, a236
MAV 68,52,184
TR 20,6,42272
MAV 68,36,176
TR 22,6,42784
v_add_f32 v44, v44, v28
s_waitcnt lgkmcnt(8)
MAV 72,40,176
TR 8,6,33856
v_accvgpr_read_b32 v29, a237
MAV 72,56,184
TR 10,6,34368
v_add_f32 v45, v45, v29
MAV 88,56,188
TR 12,6,33888
v_accvgpr_read_b32 v28, a238
MAV 88,40,180
TR 14,6,34400
v_add_f32 v46, v46, v28
MAV 92,44,180
TR 24,6,42304
v_accvgpr_read_b32 v29, a239
MAV 92,60,188
TR 26,6,42816
v_add_f32 v47, v47, v29
MAV 76,60,184
TR 28,6,42336
v_accvgpr_read_b32 v28, a240
MAV 76,44,176
TR 30,6,42848
v_add_f32 v48, v48, v28
s_waitcnt vmcnt(4) lgkmcnt(8)
MAV 64,0,192
TR 32,6,50688
v_accvgpr_read_b32 v29, a241
MAV 64,16,200
TR 34,6,51200
v_add_f32 v49, v49, v29
v_accvgpr_read_b32 v28, a242
MAV 80,16,204
TR 36,6,50720
MAV 80,0,196
TR 38,6,51232
v_add_f32 v50, v50, v28
v_accvgpr_read_b32 v29, a243
MAV 84,4,196
TR 48,6,59136
MAV 84,20,204
TR 50,6,59648
v_add_f32 v51, v51, v29
v_accvgpr_read_b32 v28, a244
MAV 68,20,200
TR 52,6,59168
MAV 68,4,192
TR 54,6,59680
v_add_f32 v52, v52, v28
s_waitcnt lgkmcnt(8)
MAV 72,8,192
TR 40,6,50752
v_accvgpr_read_b32 v29, a245
MAV 72,24,200
TR 42,6,51264
v_add_f32 v53, v53, v29
MAV 88,24,204
TR 44,6,50784
v_accvgpr_read_b32 v28, a246
MAV 88,8,196
TR 46,6,51296
v_add_f32 v54, v54, v28
MAV 92,12,196
TR 56,6,59200
v_accvgpr_read_b32 v29, a247
MAV 92,28,204
TR 58,6,59712
v_add_f32 v55, v55, v29
MAV 76,28,200
TR 60,6,59232
v_accvgpr_read_b32 v28, a248
MAV 76,12,192
TR 62,6,59744
v_add_f32 v56, v56, v28
s_waitcnt vmcnt(0) lgkmcnt(8)
MAV 64,32,208
ds_read_b64_tr_b16 a[0:1], v7
v_accvgpr_read_b32 v29, a249
MAV 64,48,216
TR 2,7,512
v_add_f32 v57, v57, v29
MAV 80,48,220
TR 4,7,32
v_accvgpr_read_b32 v28, a250
MAV 80,32,212
TR 6,7,544
v_add_f32 v58, v58, v28
MAV 84,36,212
TR 16,7,8448
v_accvgpr_read_b32 v29, a251
MAV 84,52,220
TR 18,7,8960
v_add_f32 v59, v59, v29
MAV 68,52,216
TR 20,7,8480
v_accvgpr_read_b32 v28, a252
MAV 68,36,208
TR 22,7,8992
s_waitcnt lgkmcnt(8)
MAV 72,40,208
TR 8,7,64
v_add_f32 v60, v60, v28
MAV 72,56,216
TR 10,7,576
v_accvgpr_read_b32 v29, a253
MAV 88,56,220
TR 12,7,96
v_add_f32 v61, v61, v29
MAV 88,40,212
TR 14,7,608
v_accvgpr_read_b32 v28, a254
MAV 92,44,212
TR 24,7,8512
v_add_f32 v62, v62, v28
MAV 92,60,220
TR 26,7,9024
v_accvgpr_read_b32 v29, a255
MAV 76,60,216
TR 28,7,8544
v_add_f32 v63, v63, v29
MAV 76,44,208
TR 30,7,9056
s_waitcnt lgkmcnt(8)
MAV 32,0,96
TR 32,7,16896
v_cvt_pk_bf16_f32 v232, v64, v65
MAV 32,16,104
TR 34,7,17408
v_cvt_pk_bf16_f32 v233, v66, v67
v_cvt_pk_bf16_f32 v234, v68, v69
MAV 48,16,108
TR 36,7,16928
v_cvt_pk_bf16_f32 v235, v70, v71
MAV 48,0,100
TR 38,7,17440
buffer_store_dwordx4 v[232:235], v11, s[16:19], s69 offen sc1
s_add_u32 s69, s69, 131072
MAV 52,4,100
TR 48,7,25344
v_cvt_pk_bf16_f32 v236, v72, v73
MAV 52,20,108
TR 50,7,25856
v_cvt_pk_bf16_f32 v237, v74, v75
v_cvt_pk_bf16_f32 v238, v76, v77
MAV 36,20,104
TR 52,7,25376
v_cvt_pk_bf16_f32 v239, v78, v79
MAV 36,4,96
TR 54,7,25888
buffer_store_dwordx4 v[236:239], v11, s[16:19], s69 offen sc1
s_waitcnt lgkmcnt(8)
MAV 40,8,96
TR 40,7,16960
s_add_u32 s69, s69, -130048
MAV 40,24,104
TR 42,7,17472
v_cvt_pk_bf16_f32 v240, v80, v81
v_cvt_pk_bf16_f32 v241, v82, v83
MAV 56,24,108
TR 44,7,16992
v_cvt_pk_bf16_f32 v242, v84, v85
MAV 56,8,100
TR 46,7,17504
v_cvt_pk_bf16_f32 v243, v86, v87
buffer_store_dwordx4 v[240:243], v11, s[16:19], s69 offen sc1
MAV 60,12,100
TR 56,7,25408
s_add_u32 s69, s69, 131072
MAV 60,28,108
TR 58,7,25920
v_cvt_pk_bf16_f32 v244, v88, v89
v_cvt_pk_bf16_f32 v245, v90, v91
MAV 44,28,104
TR 60,7,25440
v_cvt_pk_bf16_f32 v246, v92, v93
MAV 44,12,96
TR 62,7,25952
v_cvt_pk_bf16_f32 v247, v94, v95
buffer_store_dwordx4 v[244:247], v11, s[16:19], s69 offen sc1
s_waitcnt lgkmcnt(8)
MAV 32,32,112
TR 0,7,33792
MAV 32,48,120
TR 2,7,34304
MAV 48,48,124
TR 4,7,33824
MAV 48,32,116
TR 6,7,34336
MAV 52,36,116
TR 16,7,42240
MAV 52,52,124
TR 18,7,42752
MAV 36,52,120
TR 20,7,42272
MAV 36,36,112
TR 22,7,42784
s_waitcnt lgkmcnt(8)
MAV 40,40,112
TR 8,7,33856
MAV 40,56,120
TR 10,7,34368
MAV 56,56,124
TR 12,7,33888
MAV 56,40,116
TR 14,7,34400
MAV 60,44,116
TR 24,7,42304
MAV 60,60,124
TR 26,7,42816
MAV 44,60,120
TR 28,7,42336
MAV 44,44,112
TR 30,7,42848
s_waitcnt lgkmcnt(8)
MAV 32,0,128
TR 32,7,50688
MAV 32,16,136
TR 34,7,51200
MAV 48,16,140
TR 36,7,50720
MAV 48,0,132
TR 38,7,51232
MAV 52,4,132
TR 48,7,59136
MAV 52,20,140
TR 50,7,59648
MAV 36,20,136
TR 52,7,59168
MAV 36,4,128
TR 54,7,59680
s_waitcnt lgkmcnt(8)
MAV 40,8,128
TR 40,7,50752
MAV 40,24,136
TR 42,7,51264
MAV 56,24,140
TR 44,7,50784
MAV 56,8,132
TR 46,7,51296
MAV 60,12,132
TR 56,7,59200
MAV 60,28,140
TR 58,7,59712
MAV 44,28,136
TR 60,7,59232
MAV 44,12,128
TR 62,7,59744
v_add_u32 v7, s57, v7
s_waitcnt lgkmcnt(8)
MAV 32,32,144
ds_read_b64_tr_b16 a[0:1], v7
MAV 32,48,152
s_waitcnt vmcnt(0)
buffer_atomic_add v13, v12, s[16:19], s71 offen
MAV 48,48,156
TR 2,7,512
MAV 48,32,148
TR 4,7,32
TR 6,7,544
MAV 52,36,148
MAV 52,52,156
TR 16,7,8448
TR 18,7,8960
MAV 36,52,152
TR 20,7,8480
MAV 36,36,144
s_waitcnt lgkmcnt(7)
MAV 40,40,144
TR 22,7,8992
MAV 40,56,152
TR 8,7,64
TR 10,7,576
MAV 56,56,156
MAV 56,40,148
TR 12,7,96
TR 14,7,608
MAV 60,44,148
TR 24,7,8512
MAV 60,60,156
TR 26,7,9024
MAV 44,60,152
TR 28,7,8544
MAV 44,44,144
TR 30,7,9056
s_waitcnt lgkmcnt(8)
MAV 32,0,160
TR 32,7,16896
MAV 32,16,168
buffer_atomic_add v15, v12, s[16:19], s70 offen sc0
MAV 48,16,172
TR 34,7,17408
MAV 48,0,164
TR 36,7,16928
TR 38,7,17440
MAV 52,4,164
MAV 52,20,172
TR 48,7,25344
TR 50,7,25856
MAV 36,20,168
TR 52,7,25376
MAV 36,4,160
s_waitcnt lgkmcnt(7)
MAV 40,8,160
TR 54,7,25888
MAV 40,24,168
TR 40,7,16960
TR 42,7,17472
MAV 56,24,172
MAV 56,8,164
TR 44,7,16992
TR 46,7,17504
MAV 60,12,164
TR 56,7,25408
MAV 60,28,172
TR 58,7,25920
MAV 44,28,168
TR 60,7,25440
MAV 44,12,160
TR 62,7,25952
s_waitcnt lgkmcnt(8)
MAV 32,32,176
TR 0,7,33792
MAV 32,48,184
TR 2,7,34304
MAV 48,48,188
TR 4,7,33824
MAV 48,32,180
TR 6,7,34336
MAV 52,36,180
TR 16,7,42240
MAV 52,52,188
TR 18,7,42752
MAV 36,52,184
TR 20,7,42272
MAV 36,36,176
TR 22,7,42784
s_waitcnt lgkmcnt(8)
MAV 40,40,176
TR 8,7,33856
MAV 40,56,184
TR 10,7,34368
MAV 56,56,188
TR 12,7,33888
MAV 56,40,180
TR 14,7,34400
MAV 60,44,180
TR 24,7,42304
MAV 60,60,188
TR 26,7,42816
MAV 44,60,184
TR 28,7,42336
MAV 44,44,176
TR 30,7,42848
s_waitcnt vmcnt(0)
v_cmp_ne_u32 vcc, 0, v15
s_nop 0
s_cbranch_vccz .Lxs68
.Lxs68b:
s_waitcnt lgkmcnt(8)
MAV 32,0,192
TR 32,7,50688
MAV 32,16,200
buffer_load_dwordx4 v[232:235], v11, s[16:19], s68 offen sc1
.Lpad32:
s_cbranch_execz .Lnopoll63r
MAV 48,16,204
TR 34,7,51200
s_add_u32 s68, s68, 131072
MAV 48,0,196
TR 36,7,50720
TR 38,7,51232
MAV 52,4,196
TR 48,7,59136
MAV 52,20,204
buffer_load_dwordx4 v[236:239], v11, s[16:19], s68 offen sc1
MAV 36,20,200
TR 50,7,59648
s_add_u32 s68, s68, -130048
MAV 36,4,192
TR 52,7,59168
TR 54,7,59680
s_waitcnt lgkmcnt(8)
MAV 40,8,192
TR 40,7,50752
MAV 40,24,200
buffer_load_dwordx4 v[240:243], v11, s[16:19], s68 offen sc1
MAV 56,24,204
TR 42,7,51264
s_add_u32 s68, s68, 131072
MAV 56,8,196
TR 44,7,50784
TR 46,7,51296
MAV 60,12,196
TR 56,7,59200
MAV 60,28,204
buffer_load_dwordx4 v[244:247], v11, s[16:19], s68 offen sc1
MAV 44,28,200
TR 58,7,59712
MAV 44,12,192
TR 60,7,59232
TR 62,7,59744
s_waitcnt lgkmcnt(8)
MAV 32,32,208
MAV 32,48,216
MAV 48,48,220
MAV 48,32,212
MAV 52,36,212
MAV 52,52,220
MAV 36,52,216
MAV 36,36,208
s_waitcnt lgkmcnt(0)
MAV 40,40,208
MAV 40,56,216
MAV 56,56,220
MAV 56,40,212
MAV 60,44,212
MAV 60,60,220
MAV 44,60,216
MAV 44,44,208
s_waitcnt vmcnt(3)
v_mfma_f32_16x16x32_bf16 v[32:35], v[226:229], v[232:235], v[32:35]
v_mfma_f32_16x16x32_bf16 v[36:39], v[224:227], v[232:235], v[36:39]
s_waitcnt vmcnt(2)
v_mfma_f32_16x16x32_bf16 v[40:43], v[226:229], v[236:239], v[40:43]
v_mfma_f32_16x16x32_bf16 v[44:47], v[224:227], v[236:239], v[44:47]
s_waitcnt vmcnt(1)
v_mfma_f32_16x16x32_bf16 v[48:51], v[226:229], v[240:243], v[48:51]
v_mfma_f32_16x16x32_bf16 v[52:55], v[224:227], v[240:243], v[52:55]
s_waitcnt vmcnt(0)
v_mfma_f32_16x16x32_bf16 v[56:59], v[226:229], v[244:247], v[56:59]
v_cvt_pk_bf16_f32 v128, v32, v33
v_mfma_f32_16x16x32_bf16 v[60:63], v[224:227], v[244:247], v[60:63]
v_cvt_pk_bf16_f32 v129, v34, v35
v_cvt_pk_bf16_f32 v130, v36, v37
v_cvt_pk_bf16_f32 v131, v38, v39
v_cvt_pk_bf16_f32 v132, v40, v41
v_permlane16_swap_b32 v128, v130
v_permlane16_swap_b32 v129, v131
v_cvt_pk_bf16_f32 v133, v42, v43
buffer_store_dwordx4 v[128:131], v16, s[36:39], 0 offen sc1
v_cvt_pk_bf16_f32 v134, v44, v45
v_cvt_pk_bf16_f32 v135, v46, v47
v_cvt_pk_bf16_f32 v136, v48, v49
v_permlane16_swap_b32 v132, v134
v_permlane16_swap_b32 v133, v135
v_cvt_pk_bf16_f32 v137, v50, v51
v_cvt_pk_bf16_f32 v138, v52, v53
v_cvt_pk_bf16_f32 v139, v54, v55
v_cvt_pk_bf16_f32 v140, v56, v57
v_permlane16_swap_b32 v136, v138
v_permlane16_swap_b32 v137, v139
v_cvt_pk_bf16_f32 v141, v58, v59
buffer_store_dwordx4 v[132:135], v16, s[36:39], 0 offen offset:64 sc1
v_cvt_pk_bf16_f32 v142, v60, v61
v_cvt_pk_bf16_f32 v143, v62, v63
s_nop 0
v_permlane16_swap_b32 v140, v142
v_permlane16_swap_b32 v141, v143
buffer_store_dwordx4 v[136:139], v17, s[36:39], 0 offen sc1
buffer_store_dwordx4 v[140:143], v17, s[36:39], 0 offen offset:64 sc1
s_nop 1
.Lend:
s_endpgm
.Lsp67:
s_mov_b32 s15, 0
.Lsp67l:
v_mov_b32 v25, 0
buffer_atomic_add v25, v22, s[16:19], s73 offen sc0
s_add_u32 s15, s15, 1
s_cmp_gt_u32 s15, 100000
s_waitcnt vmcnt(0)
s_cbranch_scc1 .Lsp67b
v_cmp_gt_u32 vcc, v23, v25
s_nop 0
s_cbranch_vccnz .Lsp67l
s_branch .Lsp67b
.Lxs68:
s_mov_b32 s15, 0
.Lxs68l:
v_mov_b32 v15, 0
buffer_atomic_add v15, v12, s[16:19], s70 offen sc0
s_add_u32 s15, s15, 1
s_cmp_gt_u32 s15, 100000
s_waitcnt vmcnt(0)
s_cbranch_scc1 .Lxs68b
v_cmp_ne_u32 vcc, 0, v15
s_nop 0
s_cbranch_vccz .Lxs68l
s_branch .Lxs68b
.section .rodata,"a"
.p2align 6
.amdhsa_kernel interleave_layers__sliding_local_dilated__swiglu_ffn__prompt_kernel
  .amdhsa_next_free_vgpr 512
  .amdhsa_next_free_sgpr 102
  .amdhsa_accum_offset 256
  .amdhsa_group_segment_fixed_size 0
  .amdhsa_kernarg_size 80
  .amdhsa_user_sgpr_count 2
  .amdhsa_user_sgpr_kernarg_segment_ptr 1
  .amdhsa_system_sgpr_workgroup_id_x 1
  .amdhsa_float_denorm_mode_32 3
.end_amdhsa_kernel
```

```asm
; @launch grid=(256,1,1) block=(256,1,1) lds=162560
.amdgcn_target "amdgcn-amd-amdhsa--gfx950"
.macro MAA d,a,b
v_mfma_f32_16x16x32_bf16 v[\d:\d+3], a[\a:\a+3], a[\b:\b+3], v[\d:\d+3]
.endm
.macro MAV d,a,b
v_mfma_f32_16x16x32_bf16 v[\d:\d+3], a[\a:\a+3], v[\b:\b+3], v[\d:\d+3]
.endm
.macro TR d,v,o
ds_read_b64_tr_b16 a[\d:\d+1], v\v offset:\o
.endm
.macro RD d,v,o
ds_read_b128 a[\d:\d+3], v\v offset:\o
.endm
.text
.globl interleave_layers__sliding_local_dilated__swiglu_ffn__prompt_kernel
.p2align 8
.type interleave_layers__sliding_local_dilated__swiglu_ffn__prompt_kernel,@function
interleave_layers__sliding_local_dilated__swiglu_ffn__prompt_kernel:
s_load_dwordx4 s[68:71], s[0:1], 0
s_load_dwordx2 s[72:73], s[0:1], 16
s_load_dwordx8 s[76:83], s[0:1], 32
s_load_dwordx4 s[84:87], s[0:1], 64
s_cmp_lt_u32 s2, 256
s_cbranch_scc1 .Lgo
s_endpgm
.p2align 12
.Lgo:
v_lshrrev_b32 v2, 6, v0
v_and_b32 v1, 63, v0
v_readfirstlane_b32 s3, v2
s_and_b32 s4, s2, 7
s_lshr_b32 s5, s2, 3
s_lshr_b32 s8, s4, 2
s_lshl_b32 s8, s8, 3
s_and_b32 s62, s5, 7
s_add_u32 s8, s8, s62
s_and_b32 s9, s4, 3
s_lshl_b32 s9, s9, 2
s_lshr_b32 s62, s5, 3
s_add_u32 s9, s9, s62
s_and_b32 s48, s3, 1
s_lshr_b32 s49, s3, 1
s_lshl_b32 s50, s8, 3
s_sub_u32 s50, s50, 9
s_cmp_lt_u32 s8, 2
s_cselect_b32 s50, 7, s50
v_bfe_u32 v18, v1, 3, 1
v_bfe_u32 v2, v1, 5, 1
v_lshl_add_u32 v18, v2, 2, v18
v_and_b32 v2, 16, v1
v_add_u32 v18, v18, v2
s_lshl_b32 s62, s49, 2
s_add_u32 s62, s62, s48
s_lshl_b32 s62, s62, 1
v_add_u32 v18, s62, v18
v_mul_u32_u24 v18, 6144, v18
v_and_b32 v2, 7, v1
v_lshl_add_u32 v18, v2, 4, v18
s_lshl_b32 s62, s9, 7
v_add_u32 v18, s62, v18
v_add_u32 v19, 1024, v18
v_add_u32 v20, 2048, v18
s_mul_i32 s59, s3, 3104
s_mov_b32 s58, 0
s_lshr_b32 s62, s8, 1
s_lshl_b32 s62, s62, 8
s_and_b32 s67, s8, 1
s_add_u32 s62, s62, s67
s_lshl_b32 s62, s62, 11
s_lshl_b32 s63, s3, 17
s_add_u32 s62, s62, s63
v_lshrrev_b32 v2, 4, v1
v_xor_b32 v2, v2, v1
v_and_b32 v2, 7, v2
v_lshlrev_b32 v2, 4, v2
v_lshrrev_b32 v21, 3, v1
v_lshl_add_u32 v21, v21, 12, v2
v_add_u32 v21, s62, v21
v_xor_b32 v28, 64, v21
v_add_u32 v28, 31744, v28
s_lshr_b32 s63, s50, 3
s_lshr_b32 s62, s63, 1
s_lshl_b32 s62, s62, 8
s_and_b32 s67, s63, 1
s_add_u32 s62, s62, s67
s_lshl_b32 s62, s62, 11
s_lshl_b32 s63, s3, 14
s_add_u32 s62, s62, s63
s_add_u32 s62, s62, 456704
s_lshl_b32 s63, s3, 5
v_and_b32 v2, 31, v1
v_lshlrev_b32 v2, 2, v2
v_xor_b32 v2, s63, v2
v_lshrrev_b32 v22, 5, v1
v_lshl_add_u32 v22, v22, 12, v2
v_add_u32 v22, s62, v22
v_xor_b32 v29, 16, v22
v_add_u32 v29, -57344, v29
s_mov_b32 s52, 0
s_mov_b32 s53, 65536
s_mul_i32 s55, s3, 4608
s_mov_b32 s54, 0
s_mul_i32 s56, s3, 3104
s_waitcnt lgkmcnt(0)
s_mov_b32 s36, s68
s_mov_b32 s37, s69
s_mov_b32 s38, 4194304
s_mov_b32 s39, 0x20000
s_mov_b32 s20, s70
s_mov_b32 s21, s71
s_mov_b32 s22, 6291456
s_mov_b32 s23, 0x20000
s_lshr_b32 s6, s4, 1
s_lshl_b32 s6, s6, 2
s_and_b32 s62, s5, 3
s_add_u32 s6, s6, s62
s_and_b32 s7, s4, 1
s_lshr_b32 s62, s5, 2
s_lshl_b32 s62, s62, 1
s_add_u32 s7, s7, s62
s_lshr_b32 s62, s6, 1
s_lshl_b32 s62, s62, 8
s_and_b32 s63, s6, 1
s_add_u32 s62, s62, s63
s_lshl_b32 s63, s3, 6
s_add_u32 s62, s62, s63
s_lshl_b32 s62, s62, 11
s_lshl_b32 s63, s7, 7
s_add_u32 s62, s62, s63
v_and_b32 v228, 15, v1
v_lshlrev_b32 v228, 12, v228
v_bfe_u32 v2, v1, 4, 1
v_lshl_add_u32 v228, v2, 5, v228
v_bfe_u32 v2, v1, 5, 1
v_lshl_add_u32 v228, v2, 4, v228
v_add_u32 v228, s62, v228
v_add_u32 v229, 0x10000, v228
s_sub_u32 s64, s3, 1
s_max_i32 s64, s64, 0
s_lshl_b32 s64, s64, 11
s_lshl_b32 s66, s9, 7
s_add_u32 s66, s66, s64
s_cmp_eq_u32 s3, 1
s_cselect_b32 s66, 8388608, s66
s_mul_i32 s65, s8, 122880
s_add_u32 s65, s65, s66
v_lshrrev_b32 v9, 1, v1
v_min_u32 v9, 19, v9
v_mul_u32_u24 v9, 6144, v9
s_mov_b32 s16, s86
s_mov_b32 s17, s87
s_mov_b32 s18, 268435456
s_mov_b32 s19, 0x20000
s_xor_b32 s14, s3, 3
s_lshl_b32 s14, s14, 8
s_add_u32 s14, s14, s2
v_lshlrev_b32 v230, 4, v1
v_mov_b64 v[224:225], 0
v_mov_b64 v[226:227], 0
s_cmp_ge_u32 s14, 16
s_cbranch_scc1 .Lz3
s_lshl_b32 s62, s2, 13
s_add_u32 s62, s62, 30408704
s_add_u32 s63, s62, 4096
buffer_store_dwordx4 v[224:227], v230, s[16:19], s62 offen sc1
buffer_store_dwordx4 v[224:227], v230, s[16:19], s62 offen offset:1024 sc1
buffer_store_dwordx4 v[224:227], v230, s[16:19], s62 offen offset:2048 sc1
buffer_store_dwordx4 v[224:227], v230, s[16:19], s62 offen offset:3072 sc1
buffer_store_dwordx4 v[224:227], v230, s[16:19], s63 offen sc1
buffer_store_dwordx4 v[224:227], v230, s[16:19], s63 offen offset:1024 sc1
buffer_store_dwordx4 v[224:227], v230, s[16:19], s63 offen offset:2048 sc1
buffer_store_dwordx4 v[224:227], v230, s[16:19], s63 offen offset:3072 sc1
.Lz3:
buffer_load_dwordx4 v[164:167], v228, s[36:39], 0 offen
buffer_load_dwordx4 v[168:171], v228, s[36:39], 0 offen offset:64
buffer_load_dwordx4 v[172:175], v229, s[36:39], 0 offen
buffer_load_dwordx4 v[176:179], v229, s[36:39], 0 offen offset:64
buffer_load_dword v58, v9, s[20:23], s65 offen
s_mov_b32 s40, s84
s_mov_b32 s41, s85
s_mov_b32 s42, 256
s_mov_b32 s43, 0x20000
s_getpc_b64 s[62:63]
.Lpc:
s_lshl_b32 s64, s5, 12
v_lshrrev_b32 v59, 3, v0
v_lshl_add_u32 v59, v59, 7, s64
v_add_u32 v2, 0x20000, v59
v_min_u32 v2, .Lend-.Lpc, v2
v_min_u32 v59, .Lend-.Lpc, v59
global_load_dword v59, v59, s[62:63]
global_load_dword v58, v2, s[62:63]
s_mov_b32 s24, s72
s_mov_b32 s25, s73
s_mov_b32 s26, 2097152
s_mov_b32 s27, 0x20000
s_mov_b32 s28, s80
s_mov_b32 s29, s81
s_mov_b32 s30, 7340032
s_mov_b32 s31, 0x20000
s_mov_b32 s0, s82
s_mov_b32 s1, s83
s_mov_b32 s32, s76
s_mov_b32 s33, s77
s_mov_b32 s34, 7340032
s_mov_b32 s35, 0x20000
s_mov_b32 s80, s78
s_mov_b32 s81, s79
s_mov_b32 s82, 7340032
s_mov_b32 s83, 0x20000
s_lshr_b32 s10, s4, 2
s_lshl_b32 s10, s10, 2
s_and_b32 s62, s5, 3
s_add_u32 s10, s10, s62
s_and_b32 s11, s4, 3
s_lshl_b32 s11, s11, 3
s_lshr_b32 s62, s5, 2
s_add_u32 s11, s11, s62
s_and_b32 s12, s11, 1
s_lshr_b32 s13, s11, 1
s_mul_i32 s51, s13, 448
s_mul_i32 s62, s12, 192
s_add_u32 s51, s51, s62
s_lshl_b32 s62, s6, 3
s_lshr_b32 s84, s62, 4
s_lshl_b32 s84, s84, 14
s_and_b32 s62, s62, 15
s_lshl_b32 s62, s62, 10
s_add_u32 s84, s84, s62
s_lshl_b32 s62, s8, 3
s_lshr_b32 s85, s62, 4
s_lshl_b32 s85, s85, 14
s_and_b32 s62, s62, 15
s_lshl_b32 s62, s62, 10
s_add_u32 s85, s85, s62
s_lshl_b32 s62, s50, 0
s_lshr_b32 s86, s62, 4
s_lshl_b32 s86, s86, 14
s_and_b32 s62, s62, 15
s_lshl_b32 s62, s62, 10
s_add_u32 s86, s86, s62
s_mul_i32 s62, s8, 393216
s_add_u32 s62, s62, s66
v_mul_u32_u24 v14, 6144, v1
v_add_u32 v14, s62, v14
s_lshl_b32 s62, s8, 4
s_add_u32 s62, s62, s9
s_lshl_b32 s62, s62, 2
s_add_u32 s62, s62, s3
s_mul_i32 s62, s62, 6656
v_min_u32 v15, 51, v1
v_lshl_add_u32 v15, v15, 7, s62
s_sub_u32 s63, s8, 4
s_lshl_b32 s64, s8, 1
s_add_u32 s64, s64, 1
s_cmp_lt_u32 s8, 5
s_cselect_b64 vcc, -1, 0
s_cselect_b32 s46, s64, s63
v_cndmask_b32 v14, v14, v15, vcc
s_lshl_b32 s62, s2, 1
s_add_u32 s62, s62, s48
s_mul_i32 s62, s62, 5376
v_min_u32 v16, 41, v1
v_lshl_add_u32 v16, v16, 7, s62
s_cmp_lt_u32 s46, 6
s_cselect_b64 vcc, -1, 0
v_cndmask_b32 v15, v14, v16, vcc
v_cndmask_b32 v14, v16, v14, vcc
s_cmp_lt_u32 s3, 2
s_cselect_b32 s65, s32, s80
s_cselect_b32 s66, s33, s81
s_cselect_b32 s67, s34, s82
s_cmp_lt_u32 s8, 5
s_cselect_b32 s62, s24, s20
s_cselect_b32 s63, s25, s21
s_cselect_b32 s64, s26, s22
s_sub_u32 s47, s46, 6
s_cmp_lt_u32 s46, 6
s_cselect_b32 s47, s46, s47
s_cselect_b32 s76, s62, s65
s_cselect_b32 s98, s65, s62
s_cselect_b32 s77, s63, s66
s_cselect_b32 s99, s66, s63
s_cselect_b32 s78, s64, s67
s_cselect_b32 s100, s67, s64
s_mov_b32 s79, 0x20000
v_bfe_u32 v24, v1, 1, 3
v_lshrrev_b32 v2, 4, v1
v_xor_b32 v2, v2, v24
v_lshlrev_b32 v2, 4, v2
v_and_b32 v23, 15, v1
v_lshl_add_u32 v23, v23, 7, v2
s_mul_i32 s62, s48, 9216
v_add_u32 v23, s62, v23
v_xor_b32 v30, 64, v23
v_mul_u32_u24 v24, 2304, v24
v_add_u32 v24, v24, v2
v_and_b32 v2, 1, v1
v_lshl_add_u32 v24, v2, 7, v24
v_add_u32 v24, 2048, v24
v_xor_b32 v31, 64, v24
v_and_b32 v2, 15, v1
v_cmp_eq_u32 vcc, 0, v2
v_mov_b32 v2, 18432
s_nop 0
v_cndmask_b32 v24, v24, v2, vcc
v_cndmask_b32 v31, v31, v2, vcc
v_bfe_u32 v25, v1, 3, 2
v_mul_u32_u24 v25, 3104, v25
v_bfe_u32 v2, v1, 2, 1
v_lshl_add_u32 v25, v2, 7, v25
v_bfe_u32 v2, v1, 5, 1
v_lshl_add_u32 v25, v2, 8, v25
v_and_b32 v2, 3, v1
v_lshl_add_u32 v25, v2, 3, v25
s_lshl_b32 s62, s49, 6
s_add_u32 s62, s62, 73984
v_add_u32 v25, s62, v25
s_lshl_b32 s62, s8, 1
s_add_u32 s62, s62, s3
s_lshr_b32 s63, s50, 2
s_cmp_lt_u32 s3, 2
s_cselect_b32 s62, s62, s63
s_lshl_b32 s62, s62, 13
s_cmp_eq_u32 s3, 3
s_cselect_b32 s62, 268435456, s62
v_lshl_add_u32 v26, v1, 4, s62
s_mul_i32 s59, s3, 2080
s_and_b32 s87, s6, 3
s_lshl_b32 s87, s87, 17
v_bfe_u32 v5, v1, 3, 1
v_lshrrev_b32 v2, 4, v1
v_lshl_add_u32 v5, v2, 3, v5
s_lshl_b32 s62, s3, 1
v_add_u32 v5, s62, v5
v_mul_u32_u24 v5, 2048, v5
v_and_b32 v2, 7, v1
v_lshl_add_u32 v5, v2, 4, v5
s_lshl_b32 s62, s7, 7
v_add_u32 v5, s62, v5
v_add_u32 v6, 64512, v5
s_lshl_b32 s62, s6, 10
s_add_u32 s62, s62, 30408704
s_lshl_b32 s64, s8, 10
s_add_u32 s64, s64, 30408704
s_lshr_b32 s67, s9, 1
s_and_b32 s67, s67, 3
s_lshl_b32 s67, s67, 7
s_add_u32 s64, s64, s67
s_lshr_b32 s65, s50, 3
s_lshl_b32 s65, s65, 10
s_add_u32 s65, s65, 30408704
s_lshr_b32 s67, s9, 1
s_and_b32 s67, s67, 3
s_lshl_b32 s67, s67, 7
s_add_u32 s65, s65, s67
v_mov_b32 v2, 268435456
v_cmp_eq_u32 vcc, 65, v0
v_mov_b32 v33, s65
s_nop 0
v_cndmask_b32 v33, v2, v33, vcc
v_cndmask_b32 v36, 0, 16, vcc
v_cmp_eq_u32 vcc, 64, v0
v_mov_b32 v32, s64
s_nop 0
v_cndmask_b32 v33, v33, v32, vcc
v_lshl_add_u32 v32, v1, 7, s62
v_cndmask_b32 v34, v2, 0, vcc
v_cndmask_b32 v35, 0, 16, vcc
v_cndmask_b32 v36, v36, 16, vcc
v_lshrrev_b32 v37, 3, v0
v_cmp_eq_u32 vcc, 8, v37
s_nop 1
v_cndmask_b32 v32, v2, v32, vcc
v_mov_b32 v38, 1
v_lshrrev_b32 v2, 4, v1
v_lshlrev_b32 v2, 2, v2
v_and_b32 v13, 15, v1
v_sub_u32 v2, v13, v2
v_mov_b32 v13, 0xff61b1e6
v_subrev_u32 v54, 0, v2
v_cmp_gt_u32 vcc, 8, v54
s_nop 1
v_cndmask_b32 v50, v13, 0, vcc
v_cmp_gt_i32 vcc, -8, v54
s_nop 1
v_cndmask_b32 v46, v13, 0, vcc
v_subrev_u32 v54, 1, v2
v_cmp_gt_u32 vcc, 8, v54
s_nop 1
v_cndmask_b32 v51, v13, 0, vcc
v_cmp_gt_i32 vcc, -8, v54
s_nop 1
v_cndmask_b32 v47, v13, 0, vcc
v_subrev_u32 v54, 2, v2
v_cmp_gt_u32 vcc, 8, v54
s_nop 1
v_cndmask_b32 v52, v13, 0, vcc
v_cmp_gt_i32 vcc, -8, v54
s_nop 1
v_cndmask_b32 v48, v13, 0, vcc
v_subrev_u32 v54, 3, v2
v_cmp_gt_u32 vcc, 8, v54
s_nop 1
v_cndmask_b32 v53, v13, 0, vcc
v_cmp_gt_i32 vcc, -8, v54
s_nop 1
v_cndmask_b32 v49, v13, 0, vcc
s_cmp_lt_u32 s8, 2
s_cselect_b64 vcc, -1, 0
v_cndmask_b32 v54, v46, v13, vcc
v_cndmask_b32 v55, v47, v13, vcc
v_cndmask_b32 v56, v48, v13, vcc
v_cndmask_b32 v57, v49, v13, vcc
s_mov_b32 s75, 29360128
v_and_b32 v10, 15, v1
v_lshlrev_b32 v12, 2, v10
v_lshlrev_b32 v10, 4, v10
v_add_u32 v10, 152576, v10
v_lshrrev_b32 v11, 4, v1
v_lshlrev_b32 v11, 4, v11
s_lshl_b32 s62, s49, 7
s_add_u32 s62, s62, 158720
v_add_u32 v12, s62, v12
v_add_u32 v13, s62, v11
v_add_u32 v11, 156672, v11
s_lshl_b32 s62, s3, 11
s_add_u32 s62, s62, 143360
v_lshl_add_u32 v8, v1, 4, s62
v_xor_b32 v9, 2048, v8
v_mov_b32 v248, 0x3f803f80
v_mov_b32 v249, 0x3f803f80
v_mov_b32 v250, 0x3f803f80
v_mov_b32 v251, 0x3f803f80
s_mul_i32 s62, s3, 18496
s_add_u32 s62, s62, 18432
v_mov_b32 v2, s62
ds_write_b128 v2, v[248:251]
v_and_b32 v7, 31, v1
v_lshrrev_b32 v2, 5, v1
v_lshl_add_u32 v7, v7, 1, v2
v_and_b32 v2, 0xc0, v0
v_add_u32 v7, v7, v2
v_lshlrev_b32 v17, 2, v7
v_add_u32 v17, 156672, v17
v_lshlrev_b32 v7, 4, v7
v_add_u32 v7, 152576, v7
s_lshl_b32 s74, s9, 1
s_add_u32 s74, s74, s49
s_lshl_b32 s74, s74, 17
s_add_u32 s74, s74, s85
s_lshl_b32 s63, s48, 12
s_add_u32 s74, s74, s63
s_add_u32 s74, s74, 4194304
s_mov_b32 s62, 0
v_lshl_add_u32 v4, v1, 4, s62
v_lshrrev_b32 v2, 3, v1
v_cmp_eq_u32 vcc, 3, v2
v_add_u32 v2, 67108480, v4
s_nop 0
v_cndmask_b32 v4, v4, v2, vcc
s_add_u32 m0, s55, 0
s_nop 0
buffer_load_dwordx4 v21, s[36:39], s52 offen lds
buffer_load_dwordx4 v28, s[36:39], s52 offen offset:1024 lds
buffer_load_dword v22, s[36:39], s52 offen offset:2048 lds
s_add_u32 s52, s52, 128
s_add_u32 m0, s55, 2304
s_nop 0
buffer_load_dwordx4 v21, s[36:39], s53 offen lds
buffer_load_dwordx4 v28, s[36:39], s53 offen offset:1024 lds
buffer_load_dword v29, s[36:39], s53 offen offset:2048 lds
s_add_u32 s53, s53, 128
s_add_u32 m0, s56, 123648
s_nop 0
buffer_load_dwordx4 v18, s[20:23], s54 offen lds
buffer_load_dwordx4 v19, s[20:23], s54 offen offset:1024 lds
buffer_load_dwordx4 v20, s[20:23], s54 offen offset:2048 lds
s_add_u32 s54, s54, 196608
s_add_u32 m0, s56, 136064
s_nop 0
buffer_load_dwordx4 v18, s[20:23], s54 offen lds
buffer_load_dwordx4 v19, s[20:23], s54 offen offset:1024 lds
buffer_load_dwordx4 v20, s[20:23], s54 offen offset:2048 lds
s_add_u32 s54, s54, 196608
s_cmp_eq_u32 s48, 1
s_cbranch_scc1 .Lqkv1
s_cmp_lt_u32 s14, 16
s_cselect_b32 s62, 0, 4096
v_mov_b32 v231, 1
v_lshlrev_b32 v232, 8, v1
s_waitcnt vmcnt(18)
v_permlane16_swap_b32 v164, v166
v_permlane16_swap_b32 v165, v167
s_waitcnt vmcnt(17)
v_permlane16_swap_b32 v168, v170
v_permlane16_swap_b32 v169, v171
s_waitcnt vmcnt(16)
v_permlane16_swap_b32 v172, v174
v_permlane16_swap_b32 v173, v175
s_waitcnt vmcnt(15)
v_permlane16_swap_b32 v176, v178
v_permlane16_swap_b32 v177, v179
buffer_atomic_add v231, v232, s[40:43], s62 offen
v_lshlrev_b32 v192, 16, v164
v_and_b32 v193, 0xffff0000, v164
v_lshlrev_b32 v194, 16, v165
v_and_b32 v195, 0xffff0000, v165
v_lshlrev_b32 v196, 16, v166
v_and_b32 v197, 0xffff0000, v166
v_lshlrev_b32 v198, 16, v167
v_and_b32 v199, 0xffff0000, v167
v_lshlrev_b32 v200, 16, v168
v_and_b32 v201, 0xffff0000, v168
v_lshlrev_b32 v202, 16, v169
v_and_b32 v203, 0xffff0000, v169
v_lshlrev_b32 v204, 16, v170
v_and_b32 v205, 0xffff0000, v170
v_lshlrev_b32 v206, 16, v171
v_and_b32 v207, 0xffff0000, v171
v_lshlrev_b32 v208, 16, v172
v_and_b32 v209, 0xffff0000, v172
v_lshlrev_b32 v210, 16, v173
v_and_b32 v211, 0xffff0000, v173
v_lshlrev_b32 v212, 16, v174
v_and_b32 v213, 0xffff0000, v174
v_lshlrev_b32 v214, 16, v175
v_and_b32 v215, 0xffff0000, v175
v_lshlrev_b32 v216, 16, v176
v_and_b32 v217, 0xffff0000, v176
v_lshlrev_b32 v218, 16, v177
v_and_b32 v219, 0xffff0000, v177
v_lshlrev_b32 v220, 16, v178
v_and_b32 v221, 0xffff0000, v178
v_lshlrev_b32 v222, 16, v179
v_and_b32 v223, 0xffff0000, v179
s_lshl_b32 s64, s6, 14
s_lshl_b32 s65, s49, 13
s_add_u32 s64, s64, s65
s_lshl_b32 s65, s7, 9
s_add_u32 s64, s64, s65
s_lshl_b32 s65, s48, 8
s_add_u32 s64, s64, s65
s_add_u32 s64, s64, 29360128
v_and_b32 v188, 31, v1
v_lshlrev_b32 v188, 3, v188
v_lshrrev_b32 v189, 5, v1
v_lshl_add_u32 v188, v189, 28, v188
s_lshl_b32 s62, s7, 18
s_add_u32 s62, s62, 0
s_add_u32 s63, s62, 131072
v_pk_mul_f32 v[182:183], v[192:193], v[192:193]
v_pk_mul_f32 v[186:187], v[208:209], v[208:209]
v_pk_fma_f32 v[182:183], v[194:195], v[194:195], v[182:183]
v_pk_add_f32 v[180:181], v[192:193], v[194:195]
v_pk_fma_f32 v[186:187], v[210:211], v[210:211], v[186:187]
v_pk_add_f32 v[184:185], v[208:209], v[210:211]
v_pk_fma_f32 v[182:183], v[196:197], v[196:197], v[182:183]
v_pk_add_f32 v[180:181], v[180:181], v[196:197]
v_pk_fma_f32 v[186:187], v[212:213], v[212:213], v[186:187]
v_pk_add_f32 v[184:185], v[184:185], v[212:213]
v_pk_fma_f32 v[182:183], v[198:199], v[198:199], v[182:183]
v_pk_add_f32 v[180:181], v[180:181], v[198:199]
v_pk_fma_f32 v[186:187], v[214:215], v[214:215], v[186:187]
v_pk_add_f32 v[184:185], v[184:185], v[214:215]
v_pk_fma_f32 v[182:183], v[200:201], v[200:201], v[182:183]
v_pk_add_f32 v[180:181], v[180:181], v[200:201]
v_pk_fma_f32 v[186:187], v[216:217], v[216:217], v[186:187]
v_pk_add_f32 v[184:185], v[184:185], v[216:217]
v_pk_fma_f32 v[182:183], v[202:203], v[202:203], v[182:183]
v_pk_add_f32 v[180:181], v[180:181], v[202:203]
v_pk_fma_f32 v[186:187], v[218:219], v[218:219], v[186:187]
v_pk_add_f32 v[184:185], v[184:185], v[218:219]
v_pk_fma_f32 v[182:183], v[204:205], v[204:205], v[182:183]
v_pk_add_f32 v[180:181], v[180:181], v[204:205]
v_pk_fma_f32 v[186:187], v[220:221], v[220:221], v[186:187]
v_pk_add_f32 v[184:185], v[184:185], v[220:221]
v_pk_fma_f32 v[182:183], v[206:207], v[206:207], v[182:183]
v_pk_add_f32 v[180:181], v[180:181], v[206:207]
v_pk_fma_f32 v[186:187], v[222:223], v[222:223], v[186:187]
v_pk_add_f32 v[184:185], v[184:185], v[222:223]
v_add_f32 v180, v180, v181
v_add_f32 v182, v182, v183
v_add_f32 v184, v184, v185
v_add_f32 v186, v186, v187
s_nop 0
v_permlane16_swap_b32 v180, v184
v_permlane16_swap_b32 v182, v186
v_add_f32 v180, v180, v184
v_add_f32 v182, v182, v186
s_nop 1
v_permlane32_swap_b32 v180, v182
v_add_f32 v180, v180, v182
s_nop 1
v_permlane32_swap_b32 v180, v181
buffer_store_dwordx2 v[180:181], v188, s[16:19], s64 offen sc1
s_lshl_b32 s62, s2, 10
s_add_u32 s62, s62, 31457280
s_cmp_eq_u32 s3, 0
s_cselect_b32 s62, s62, 268435456
buffer_store_dwordx4 v[224:227], v230, s[16:19], s62 offen sc1
v_accvgpr_write_b32 a224, v192
v_accvgpr_write_b32 a225, v193
v_accvgpr_write_b32 a226, v194
v_accvgpr_write_b32 a227, v195
v_accvgpr_write_b32 a228, v196
v_accvgpr_write_b32 a229, v197
v_accvgpr_write_b32 a230, v198
v_accvgpr_write_b32 a231, v199
v_accvgpr_write_b32 a232, v200
v_accvgpr_write_b32 a233, v201
v_accvgpr_write_b32 a234, v202
v_accvgpr_write_b32 a235, v203
v_accvgpr_write_b32 a236, v204
v_accvgpr_write_b32 a237, v205
v_accvgpr_write_b32 a238, v206
v_accvgpr_write_b32 a239, v207
v_accvgpr_write_b32 a240, v208
v_accvgpr_write_b32 a241, v209
v_accvgpr_write_b32 a242, v210
v_accvgpr_write_b32 a243, v211
v_accvgpr_write_b32 a244, v212
v_accvgpr_write_b32 a245, v213
v_accvgpr_write_b32 a246, v214
v_accvgpr_write_b32 a247, v215
v_accvgpr_write_b32 a248, v216
v_accvgpr_write_b32 a249, v217
v_accvgpr_write_b32 a250, v218
v_accvgpr_write_b32 a251, v219
v_accvgpr_write_b32 a252, v220
v_accvgpr_write_b32 a253, v221
v_accvgpr_write_b32 a254, v222
v_accvgpr_write_b32 a255, v223
s_add_u32 m0, s55, 18496
s_nop 0
buffer_load_dwordx4 v21, s[36:39], s52 offen lds
buffer_load_dwordx4 v28, s[36:39], s52 offen offset:1024 lds
buffer_load_dword v22, s[36:39], s52 offen offset:2048 lds
s_add_u32 s52, s52, 128
s_add_u32 m0, s55, 20800
s_nop 0
buffer_load_dwordx4 v21, s[36:39], s53 offen lds
buffer_load_dwordx4 v28, s[36:39], s53 offen offset:1024 lds
buffer_load_dword v29, s[36:39], s53 offen offset:2048 lds
s_add_u32 s53, s53, 128
s_add_u32 m0, s56, 73984
s_nop 0
buffer_load_dwordx4 v18, s[20:23], s54 offen lds
buffer_load_dwordx4 v19, s[20:23], s54 offen offset:1024 lds
buffer_load_dwordx4 v20, s[20:23], s54 offen offset:2048 lds
s_add_u32 s54, s54, 196608
s_waitcnt vmcnt(12) lgkmcnt(0)
s_barrier
ds_read_b128 a[0:3], v23
RD 4,23,2304
RD 8,23,4608
RD 12,23,6912
ds_read_b128 a[16:19], v24
ds_read_b128 a[20:23], v30
RD 24,30,2304
RD 28,30,4608
RD 32,30,6912
ds_read_b128 a[36:39], v31
TR 80,25,49664
TR 82,25,50176
TR 84,25,62080
TR 86,25,62592
TR 88,25,50688
TR 90,25,51200
TR 92,25,63104
TR 94,25,63616
TR 96,25,51712
TR 98,25,52224
TR 100,25,64128
TR 102,25,64640
s_waitcnt vmcnt(3) lgkmcnt(0)
s_barrier
v_mfma_f32_16x16x32_bf16 v[60:63], a[80:83], a[0:3], 0
TR 104,25,49696
s_add_u32 m0, s56, 86400
MAA 60,84,20
buffer_load_dwordx4 v18, s[20:23], s54 offen lds
v_mfma_f32_16x16x32_bf16 v[64:67], a[80:83], a[4:7], 0
s_sub_u32 s47, s47, 1
s_cbranch_scc1 .Lx4
.Lx4b:
MAA 64,84,24
buffer_load_dwordx4 v19, s[20:23], s54 offen offset:1024 lds
v_mfma_f32_16x16x32_bf16 v[68:71], a[80:83], a[8:11], 0
TR 106,25,50208
MAA 68,84,28
TR 108,25,62112
TR 110,25,62624
v_mfma_f32_16x16x32_bf16 v[72:75], a[80:83], a[12:15], 0
TR 112,25,50720
MAA 72,84,32
TR 114,25,51232
v_mfma_f32_16x16x32_bf16 v[244:247], a[80:83], a[16:19], 0
TR 116,25,63136
MAA 244,84,36
buffer_load_dwordx4 v20, s[20:23], s54 offen offset:2048 lds
v_mfma_f32_16x16x32_bf16 v[156:159], a[88:91], a[16:19], 0
s_add_u32 s54, s54, 196608
s_add_u32 m0, s55, 36992
MAA 156,92,36
buffer_load_dwordx4 v21, s[36:39], s52 offen lds
v_mfma_f32_16x16x32_bf16 v[104:107], a[88:91], a[12:15], 0
TR 118,25,63648
MAA 104,92,32
buffer_load_dwordx4 v28, s[36:39], s52 offen offset:1024 lds
v_mfma_f32_16x16x32_bf16 v[100:103], a[88:91], a[8:11], 0
TR 120,25,51744
MAA 100,92,28
buffer_load_dword v22, s[36:39], s52 offen offset:2048 lds
v_mfma_f32_16x16x32_bf16 v[96:99], a[88:91], a[4:7], 0
s_add_u32 s52, s52, 128
MAA 96,92,24
TR 122,25,52256
TR 124,25,64160
v_mfma_f32_16x16x32_bf16 v[92:95], a[88:91], a[0:3], 0
TR 126,25,64672
s_add_u32 m0, s55, 39296
MAA 92,92,20
buffer_load_dwordx4 v21, s[36:39], s53 offen lds
v_mfma_f32_16x16x32_bf16 v[124:127], a[0:3], a[96:99], 0
RD 40,23,18496
MAA 124,20,100
buffer_load_dwordx4 v28, s[36:39], s53 offen offset:1024 lds
v_mfma_f32_16x16x32_bf16 v[128:131], a[4:7], a[96:99], 0
RD 44,23,20800
MAA 128,24,100
RD 48,23,23104
RD 52,23,25408
v_mfma_f32_16x16x32_bf16 v[132:135], a[8:11], a[96:99], 0
RD 56,24,18496
MAA 132,28,100
buffer_load_dword v29, s[36:39], s53 offen offset:2048 lds
v_mfma_f32_16x16x32_bf16 v[136:139], a[12:15], a[96:99], 0
s_add_u32 s53, s53, 128
MAA 136,32,100
s_waitcnt vmcnt(6) lgkmcnt(5)
s_barrier
v_mfma_f32_16x16x32_bf16 v[76:79], a[104:107], a[0:3], 0
RD 60,30,18496
s_add_u32 m0, s56, 98816
MAA 76,108,20
buffer_load_dwordx4 v18, s[20:23], s54 offen lds
v_mfma_f32_16x16x32_bf16 v[80:83], a[104:107], a[4:7], 0
RD 64,30,20800
MAA 80,108,24
buffer_load_dwordx4 v19, s[20:23], s54 offen offset:1024 lds
v_mfma_f32_16x16x32_bf16 v[84:87], a[104:107], a[8:11], 0
RD 68,30,23104
MAA 84,108,28
RD 72,30,25408
RD 76,31,18496
v_mfma_f32_16x16x32_bf16 v[88:91], a[104:107], a[12:15], 0
ds_read_b64_tr_b16 a[80:81], v25
MAA 88,108,32
buffer_load_dwordx4 v20, s[20:23], s54 offen offset:2048 lds
v_mfma_f32_16x16x32_bf16 v[160:163], a[112:115], a[16:19], 0
s_add_u32 s54, s54, 196608
s_add_u32 m0, s56, 111232
MAA 160,116,36
buffer_load_dwordx4 v18, s[20:23], s54 offen lds
v_mfma_f32_16x16x32_bf16 v[120:123], a[112:115], a[12:15], 0
TR 82,25,512
MAA 120,116,32
buffer_load_dwordx4 v19, s[20:23], s54 offen offset:1024 lds
v_mfma_f32_16x16x32_bf16 v[116:119], a[112:115], a[8:11], 0
TR 84,25,12416
MAA 116,116,28
TR 86,25,12928
TR 88,25,1024
v_mfma_f32_16x16x32_bf16 v[112:115], a[112:115], a[4:7], 0
TR 90,25,1536
MAA 112,116,24
buffer_load_dwordx4 v20, s[20:23], s54 offen offset:2048 lds
v_mfma_f32_16x16x32_bf16 v[108:111], a[112:115], a[0:3], 0
s_add_u32 s54, s54, 196608
s_add_u32 m0, s55, 55488
MAA 108,116,20
buffer_load_dwordx4 v21, s[36:39], s52 offen lds
v_mfma_f32_16x16x32_bf16 v[140:143], a[0:3], a[120:123], 0
TR 92,25,13440
MAA 140,20,124
buffer_load_dwordx4 v28, s[36:39], s52 offen offset:1024 lds
v_mfma_f32_16x16x32_bf16 v[144:147], a[4:7], a[120:123], 0
TR 94,25,13952
MAA 144,24,124
TR 96,25,2048
TR 98,25,2560
v_mfma_f32_16x16x32_bf16 v[148:151], a[8:11], a[120:123], 0
TR 100,25,14464
MAA 148,28,124
buffer_load_dword v22, s[36:39], s52 offen offset:2048 lds
v_mfma_f32_16x16x32_bf16 v[152:155], a[12:15], a[120:123], 0
TR 102,25,14976
s_add_u32 s52, s52, 128
MAA 152,32,124
s_waitcnt vmcnt(9) lgkmcnt(8)
s_barrier
MAA 60,80,40
TR 104,25,32
s_add_u32 m0, s55, 57792
MAA 60,84,60
buffer_load_dwordx4 v21, s[36:39], s53 offen lds
MAA 64,84,64
s_sub_u32 s47, s47, 1
s_cbranch_scc1 .Lx5
.Lx5b:
MAA 64,80,44
buffer_load_dwordx4 v28, s[36:39], s53 offen offset:1024 lds
MAA 68,80,48
TR 106,25,544
MAA 68,84,68
TR 108,25,12448
TR 110,25,12960
MAA 72,84,72
TR 112,25,1056
MAA 72,80,52
TR 114,25,1568
s_waitcnt lgkmcnt(6)
MAA 244,80,56
TR 116,25,13472
MAA 244,84,76
buffer_load_dword v29, s[36:39], s53 offen offset:2048 lds
MAA 156,92,76
s_add_u32 s53, s53, 128
s_add_u32 m0, s56, 123648
MAA 156,88,56
buffer_load_dwordx4 v18, s[20:23], s54 offen lds
MAA 104,88,52
TR 118,25,13984
MAA 104,92,72
buffer_load_dwordx4 v19, s[20:23], s54 offen offset:1024 lds
MAA 100,92,68
TR 120,25,2080
MAA 100,88,48
buffer_load_dwordx4 v20, s[20:23], s54 offen offset:2048 lds
MAA 96,88,44
s_add_u32 s54, s54, 196608
MAA 96,92,64
TR 122,25,2592
TR 124,25,14496
MAA 92,92,60
TR 126,25,15008
s_add_u32 m0, s56, 136064
MAA 92,88,40
buffer_load_dwordx4 v18, s[20:23], s54 offen lds
MAA 124,40,96
RD 0,23,36992
MAA 124,60,100
buffer_load_dwordx4 v19, s[20:23], s54 offen offset:1024 lds
MAA 128,64,100
RD 4,23,39296
MAA 128,44,96
RD 8,23,41600
RD 12,23,43904
MAA 132,48,96
RD 16,24,36992
MAA 132,68,100
buffer_load_dwordx4 v20, s[20:23], s54 offen offset:2048 lds
MAA 136,72,100
s_add_u32 s54, s54, 196608
MAA 136,52,96
s_waitcnt vmcnt(12) lgkmcnt(5)
s_barrier
MAA 76,104,40
RD 20,30,36992
s_add_u32 m0, s55, 0
MAA 76,108,60
buffer_load_dwordx4 v21, s[36:39], s52 offen lds
MAA 80,108,64
RD 24,30,39296
MAA 80,104,44
buffer_load_dwordx4 v28, s[36:39], s52 offen offset:1024 lds
MAA 84,104,48
RD 28,30,41600
MAA 84,108,68
buffer_load_dword v22, s[36:39], s52 offen offset:2048 lds
MAA 88,108,72
RD 32,30,43904
s_add_u32 s52, s52, 128
MAA 88,104,52
RD 36,31,36992
TR 80,25,24832
TR 82,25,25344
MAA 160,112,56
TR 84,25,37248
s_add_u32 m0, s55, 2304
MAA 160,116,76
buffer_load_dwordx4 v21, s[36:39], s53 offen lds
MAA 120,116,72
TR 86,25,37760
MAA 120,112,52
buffer_load_dwordx4 v28, s[36:39], s53 offen offset:1024 lds
MAA 116,112,48
TR 88,25,25856
MAA 116,116,68
buffer_load_dword v29, s[36:39], s53 offen offset:2048 lds
MAA 112,116,64
s_add_u32 s53, s53, 128
s_add_u32 m0, s56, 73984
MAA 112,112,44
buffer_load_dwordx4 v18, s[20:23], s54 offen lds
MAA 108,112,40
TR 90,25,26368
MAA 108,116,60
buffer_load_dwordx4 v19, s[20:23], s54 offen offset:1024 lds
MAA 140,60,124
TR 92,25,38272
MAA 140,40,120
TR 94,25,38784
TR 96,25,26880
TR 98,25,27392
MAA 144,44,120
TR 100,25,39296
MAA 144,64,124
buffer_load_dwordx4 v20, s[20:23], s54 offen offset:2048 lds
MAA 148,68,124
TR 102,25,39808
s_add_u32 s54, s54, 196608
MAA 148,48,120
buffer_load_dword v37, v34, s[40:43], 0 offen sc1
MAA 152,52,120
MAA 152,72,124
s_waitcnt vmcnt(16) lgkmcnt(8)
s_barrier
MAA 60,80,0
TR 104,25,24864
s_add_u32 m0, s56, 86400
MAA 60,84,20
buffer_load_dwordx4 v18, s[20:23], s54 offen lds
MAA 64,84,24
s_sub_u32 s47, s47, 1
s_cbranch_scc1 .Lx6
.Lx6b:
MAA 64,80,4
buffer_load_dwordx4 v19, s[20:23], s54 offen offset:1024 lds
MAA 68,80,8
TR 106,25,25376
MAA 68,84,28
TR 108,25,37280
TR 110,25,37792
MAA 72,84,32
TR 112,25,25888
MAA 72,80,12
TR 114,25,26400
s_waitcnt lgkmcnt(6)
MAA 244,80,16
TR 116,25,38304
MAA 244,84,36
buffer_load_dwordx4 v20, s[20:23], s54 offen offset:2048 lds
MAA 156,92,36
s_add_u32 s54, s54, 196608
s_add_u32 m0, s55, 18496
MAA 156,88,16
buffer_load_dwordx4 v21, s[36:39], s52 offen lds
MAA 104,88,12
TR 118,25,38816
MAA 104,92,32
buffer_load_dwordx4 v28, s[36:39], s52 offen offset:1024 lds
MAA 100,92,28
TR 120,25,26912
MAA 100,88,8
buffer_load_dword v22, s[36:39], s52 offen offset:2048 lds
MAA 96,88,4
s_add_u32 s52, s52, 128
MAA 96,92,24
TR 122,25,27424
TR 124,25,39328
MAA 92,92,20
TR 126,25,39840
s_add_u32 m0, s55, 20800
MAA 92,88,0
buffer_load_dwordx4 v21, s[36:39], s53 offen lds
MAA 124,0,96
RD 40,23,55488
MAA 124,20,100
buffer_load_dwordx4 v28, s[36:39], s53 offen offset:1024 lds
MAA 128,24,100
RD 44,23,57792
MAA 128,4,96
RD 48,23,60096
RD 52,23,62400
MAA 132,8,96
RD 56,24,55488
MAA 132,28,100
buffer_load_dword v29, s[36:39], s53 offen offset:2048 lds
MAA 136,32,100
s_add_u32 s53, s53, 128
MAA 136,12,96
s_waitcnt vmcnt(19) lgkmcnt(5)
s_barrier
MAA 76,104,0
RD 60,30,55488
s_add_u32 m0, s56, 98816
MAA 76,108,20
buffer_load_dwordx4 v18, s[20:23], s54 offen lds
MAA 80,108,24
RD 64,30,57792
MAA 80,104,4
buffer_load_dwordx4 v19, s[20:23], s54 offen offset:1024 lds
MAA 84,104,8
RD 68,30,60096
MAA 84,108,28
RD 72,30,62400
RD 76,31,55488
MAA 88,108,32
TR 80,25,49664
MAA 88,104,12
buffer_load_dwordx4 v20, s[20:23], s54 offen offset:2048 lds
MAA 160,112,16
s_add_u32 s54, s54, 196608
s_add_u32 m0, s55, 36992
MAA 160,116,36
buffer_load_dwordx4 v21, s[36:39], s52 offen lds
MAA 120,116,32
TR 82,25,50176
MAA 120,112,12
buffer_load_dwordx4 v28, s[36:39], s52 offen offset:1024 lds
MAA 116,112,8
TR 84,25,62080
MAA 116,116,28
TR 86,25,62592
TR 88,25,50688
MAA 112,116,24
TR 90,25,51200
MAA 112,112,4
buffer_load_dword v22, s[36:39], s52 offen offset:2048 lds
MAA 108,112,0
s_add_u32 s52, s52, 128
s_add_u32 m0, s55, 39296
MAA 108,116,20
buffer_load_dwordx4 v21, s[36:39], s53 offen lds
MAA 140,20,124
TR 92,25,63104
MAA 140,0,120
buffer_load_dwordx4 v28, s[36:39], s53 offen offset:1024 lds
MAA 144,4,120
TR 94,25,63616
MAA 144,24,124
TR 96,25,51712
TR 98,25,52224
MAA 148,28,124
TR 100,25,64128
MAA 148,8,120
buffer_load_dword v29, s[36:39], s53 offen offset:2048 lds
MAA 152,12,120
TR 102,25,64640
s_add_u32 s53, s53, 128
MAA 152,32,124
s_waitcnt vmcnt(22) lgkmcnt(8)
s_barrier
MAA 60,80,40
TR 104,25,49696
s_add_u32 m0, s56, 111232
MAA 60,84,60
buffer_load_dwordx4 v18, s[20:23], s54 offen lds
MAA 64,84,64
s_sub_u32 s47, s47, 1
s_cbranch_scc1 .Lx7
.Lx7b:
MAA 64,80,44
TR 106,25,50208
MAA 68,80,48
TR 108,25,62112
MAA 68,84,68
buffer_load_dwordx4 v19, s[20:23], s54 offen offset:1024 lds
MAA 72,84,72
TR 110,25,62624
MAA 72,80,52
TR 112,25,50720
s_waitcnt lgkmcnt(5)
MAA 244,80,56
TR 114,25,51232
MAA 244,84,76
buffer_load_dwordx4 v20, s[20:23], s54 offen offset:2048 lds
MAA 156,92,76
s_add_u32 s54, s54, 196608
MAA 156,88,56
TR 116,25,63136
MAA 104,88,52
TR 118,25,63648
MAA 104,92,72
TR 120,25,51744
MAA 100,92,68
TR 122,25,52256
s_add_u32 m0, s55, 55488
MAA 100,88,48
buffer_load_dwordx4 v21, s[36:39], s52 offen lds
MAA 96,88,44
TR 124,25,64160
MAA 96,92,64
TR 126,25,64672
MAA 92,92,60
MAA 92,88,40
buffer_load_dwordx4 v28, s[36:39], s52 offen offset:1024 lds
MAA 124,40,96
ds_read_b128 a[0:3], v23
MAA 124,60,100
RD 4,23,2304
MAA 128,64,100
RD 8,23,4608
MAA 128,44,96
buffer_load_dword v22, s[36:39], s52 offen offset:2048 lds
MAA 132,48,96
RD 12,23,6912
s_add_u32 s52, s52, 128
MAA 132,68,100
ds_read_b128 a[16:19], v24
MAA 136,72,100
MAA 136,52,96
s_waitcnt vmcnt(21) lgkmcnt(5)
s_barrier
v_cmp_gt_u32 vcc, v35, v37
s_nop 0
s_cbranch_vccnz .Lsp8
.Lsp8b:
v_mov_b32 v37, 0
MAA 76,104,40
ds_read_b128 a[20:23], v30
MAA 76,108,60
buffer_atomic_add v38, v32, s[16:19], 0 offen
MAA 80,108,64
RD 24,30,2304
MAA 80,104,44
RD 28,30,4608
MAA 84,104,48
RD 32,30,6912
s_add_u32 m0, s56, 123648
MAA 84,108,68
buffer_load_dwordx4 v18, s[20:23], s54 offen lds
MAA 88,108,72
ds_read_b128 a[36:39], v31
MAA 88,104,52
buffer_load_dwordx4 v19, s[20:23], s54 offen offset:1024 lds
MAA 160,112,56
ds_read_b64_tr_b16 a[80:81], v25
MAA 160,116,76
TR 82,25,512
MAA 120,116,72
TR 84,25,12416
MAA 120,112,52
buffer_load_dwordx4 v20, s[20:23], s54 offen offset:2048 lds
MAA 116,112,48
TR 86,25,12928
s_add_u32 s54, s54, 196608
MAA 116,116,68
TR 88,25,1024
MAA 112,116,64
TR 90,25,1536
s_add_u32 m0, s55, 57792
MAA 112,112,44
buffer_load_dwordx4 v21, s[36:39], s53 offen lds
MAA 108,112,40
TR 92,25,13440
MAA 108,116,60
TR 94,25,13952
MAA 140,60,124
TR 96,25,2048
MAA 140,40,120
buffer_load_dwordx4 v28, s[36:39], s53 offen offset:1024 lds
MAA 144,44,120
TR 98,25,2560
MAA 144,64,124
buffer_load_dword v29, s[36:39], s53 offen offset:2048 lds
MAA 148,68,124
TR 100,25,14464
s_add_u32 s53, s53, 128
MAA 148,48,120
TR 102,25,14976
MAA 152,52,120
MAA 152,72,124
s_waitcnt vmcnt(22) lgkmcnt(8)
s_barrier
MAA 60,80,0
TR 104,25,32
s_add_u32 m0, s56, 136064
MAA 60,84,20
buffer_load_dwordx4 v18, s[20:23], s54 offen lds
MAA 64,84,24
s_sub_u32 s47, s47, 1
s_cbranch_scc1 .Lx9
.Lx9b:
MAA 64,80,4
TR 106,25,544
MAA 68,80,8
TR 108,25,12448
MAA 68,84,28
buffer_load_dwordx4 v19, s[20:23], s54 offen offset:1024 lds
MAA 72,84,32
TR 110,25,12960
MAA 72,80,12
TR 112,25,1056
s_waitcnt lgkmcnt(5)
MAA 244,80,16
TR 114,25,1568
MAA 244,84,36
buffer_load_dwordx4 v20, s[20:23], s54 offen offset:2048 lds
MAA 156,92,36
s_add_u32 s54, s54, 196608
MAA 156,88,16
TR 116,25,13472
MAA 104,88,12
TR 118,25,13984
MAA 104,92,32
TR 120,25,2080
MAA 100,92,28
TR 122,25,2592
s_add_u32 m0, s55, 0
MAA 100,88,8
buffer_load_dwordx4 v21, s[36:39], s52 offen lds
MAA 96,88,4
TR 124,25,14496
MAA 96,92,24
TR 126,25,15008
MAA 92,92,20
MAA 92,88,0
buffer_load_dwordx4 v28, s[36:39], s52 offen offset:1024 lds
MAA 124,0,96
RD 40,23,18496
MAA 124,20,100
RD 44,23,20800
MAA 128,24,100
RD 48,23,23104
MAA 128,4,96
buffer_load_dword v22, s[36:39], s52 offen offset:2048 lds
MAA 132,8,96
RD 52,23,25408
s_add_u32 s52, s52, 128
MAA 132,28,100
RD 56,24,18496
MAA 136,32,100
MAA 136,12,96
s_waitcnt vmcnt(16) lgkmcnt(5)
s_barrier
MAA 76,104,0
RD 60,30,18496
s_add_u32 m0, s56, 73984
MAA 76,108,20
buffer_load_dwordx4 v18, s[20:23], s54 offen lds
MAA 80,108,24
RD 64,30,20800
MAA 80,104,4
RD 68,30,23104
MAA 84,104,8
RD 72,30,25408
MAA 84,108,28
buffer_load_dwordx4 v19, s[20:23], s54 offen offset:1024 lds
MAA 88,108,32
RD 76,31,18496
MAA 88,104,12
TR 80,25,24832
MAA 160,112,16
TR 82,25,25344
MAA 160,116,36
buffer_load_dwordx4 v20, s[20:23], s54 offen offset:2048 lds
MAA 120,116,32
TR 84,25,37248
s_add_u32 s54, s54, 196608
MAA 120,112,12
TR 86,25,37760
MAA 116,112,8
s_add_u32 m0, s55, 2304
MAA 116,116,28
buffer_load_dwordx4 v21, s[36:39], s53 offen lds
MAA 112,116,24
TR 88,25,25856
MAA 112,112,4
TR 90,25,26368
MAA 108,112,0
TR 92,25,38272
MAA 108,116,20
buffer_load_dwordx4 v28, s[36:39], s53 offen offset:1024 lds
MAA 140,20,124
TR 94,25,38784
MAA 140,0,120
TR 96,25,26880
MAA 144,4,120
TR 98,25,27392
MAA 144,24,124
buffer_load_dword v29, s[36:39], s53 offen offset:2048 lds
MAA 148,28,124
TR 100,25,39296
s_add_u32 s53, s53, 128
MAA 148,8,120
TR 102,25,39808
MAA 152,12,120
MAA 152,32,124
s_waitcnt lgkmcnt(8)
s_barrier
MAA 60,80,40
TR 104,25,24864
s_add_u32 m0, s56, 86400
MAA 60,84,60
buffer_load_dwordx4 v18, s[20:23], s54 offen lds
MAA 64,84,64
s_sub_u32 s47, s47, 1
s_cbranch_scc1 .Lx10
.Lx10b:
MAA 64,80,44
TR 106,25,25376
MAA 68,80,48
TR 108,25,37280
MAA 68,84,68
buffer_load_dwordx4 v19, s[20:23], s54 offen offset:1024 lds
MAA 72,84,72
TR 110,25,37792
MAA 72,80,52
TR 112,25,25888
s_waitcnt lgkmcnt(5)
MAA 244,80,56
TR 114,25,26400
MAA 244,84,76
buffer_load_dwordx4 v20, s[20:23], s54 offen offset:2048 lds
MAA 156,92,76
s_add_u32 s54, s54, 196608
MAA 156,88,56
TR 116,25,38304
MAA 104,88,52
TR 118,25,38816
MAA 104,92,72
TR 120,25,26912
MAA 100,92,68
TR 122,25,27424
s_add_u32 m0, s55, 18496
MAA 100,88,48
buffer_load_dwordx4 v21, s[36:39], s52 offen lds
MAA 96,88,44
TR 124,25,39328
MAA 96,92,64
TR 126,25,39840
MAA 92,92,60
MAA 92,88,40
buffer_load_dwordx4 v28, s[36:39], s52 offen offset:1024 lds
MAA 124,40,96
RD 0,23,36992
MAA 124,60,100
RD 4,23,39296
MAA 128,64,100
RD 8,23,41600
MAA 128,44,96
buffer_load_dword v22, s[36:39], s52 offen offset:2048 lds
MAA 132,48,96
RD 12,23,43904
s_add_u32 s52, s52, 128
MAA 132,68,100
RD 16,24,36992
MAA 136,72,100
MAA 136,52,96
s_waitcnt vmcnt(15) lgkmcnt(5)
s_barrier
MAA 76,104,40
RD 20,30,36992
s_add_u32 m0, s56, 98816
MAA 76,108,60
buffer_load_dwordx4 v18, s[20:23], s54 offen lds
MAA 80,108,64
RD 24,30,39296
MAA 80,104,44
RD 28,30,41600
MAA 84,104,48
RD 32,30,43904
MAA 84,108,68
buffer_load_dwordx4 v19, s[20:23], s54 offen offset:1024 lds
MAA 88,108,72
RD 36,31,36992
MAA 88,104,52
buffer_load_dwordx4 v20, s[20:23], s54 offen offset:2048 lds
MAA 160,112,56
TR 80,25,49664
s_add_u32 s54, s54, 196608
MAA 160,116,76
TR 82,25,50176
MAA 120,116,72
TR 84,25,62080
s_add_u32 m0, s55, 20800
MAA 120,112,52
buffer_load_dwordx4 v21, s[36:39], s53 offen lds
MAA 116,112,48
TR 86,25,62592
MAA 116,116,68
TR 88,25,50688
MAA 112,116,64
TR 90,25,51200
MAA 112,112,44
buffer_load_dwordx4 v28, s[36:39], s53 offen offset:1024 lds
MAA 108,112,40
TR 92,25,63104
MAA 108,116,60
TR 94,25,63616
MAA 140,60,124
TR 96,25,51712
MAA 140,40,120
buffer_load_dword v29, s[36:39], s53 offen offset:2048 lds
MAA 144,44,120
TR 98,25,52224
s_add_u32 s53, s53, 128
MAA 144,64,124
buffer_atomic_add v37, v33, s[16:19], 0 offen sc0
MAA 148,68,124
TR 100,25,64128
MAA 148,48,120
TR 102,25,64640
MAA 152,52,120
MAA 152,72,124
s_waitcnt lgkmcnt(8)
s_barrier
MAA 60,80,0
TR 104,25,49696
s_add_u32 m0, s56, 111232
MAA 60,84,20
buffer_load_dwordx4 v18, s[20:23], s54 offen lds
MAA 64,84,24
s_sub_u32 s47, s47, 1
s_cbranch_scc1 .Lx11
.Lx11b:
MAA 64,80,4
TR 106,25,50208
MAA 68,80,8
TR 108,25,62112
MAA 68,84,28
buffer_load_dwordx4 v19, s[20:23], s54 offen offset:1024 lds
MAA 72,84,32
TR 110,25,62624
MAA 72,80,12
TR 112,25,50720
s_waitcnt lgkmcnt(5)
MAA 244,80,16
TR 114,25,51232
MAA 244,84,36
buffer_load_dwordx4 v20, s[20:23], s54 offen offset:2048 lds
MAA 156,92,36
s_add_u32 s54, s54, 196608
MAA 156,88,16
TR 116,25,63136
MAA 104,88,12
TR 118,25,63648
MAA 104,92,32
TR 120,25,51744
MAA 100,92,28
TR 122,25,52256
s_add_u32 m0, s55, 36992
MAA 100,88,8
buffer_load_dwordx4 v21, s[36:39], s52 offen lds
MAA 96,88,4
TR 124,25,64160
MAA 96,92,24
TR 126,25,64672
MAA 92,92,20
MAA 92,88,0
buffer_load_dwordx4 v28, s[36:39], s52 offen offset:1024 lds
MAA 124,0,96
RD 40,23,55488
MAA 124,20,100
RD 44,23,57792
MAA 128,24,100
RD 48,23,60096
MAA 128,4,96
buffer_load_dword v22, s[36:39], s52 offen offset:2048 lds
MAA 132,8,96
RD 52,23,62400
s_add_u32 s52, s52, 128
MAA 132,28,100
RD 56,24,55488
MAA 136,32,100
MAA 136,12,96
s_waitcnt vmcnt(16) lgkmcnt(5)
s_barrier
MAA 76,104,0
RD 60,30,55488
s_add_u32 m0, s56, 123648
MAA 76,108,20
buffer_load_dwordx4 v18, s[20:23], s54 offen lds
MAA 80,108,24
RD 64,30,57792
MAA 80,104,4
RD 68,30,60096
MAA 84,104,8
RD 72,30,62400
MAA 84,108,28
buffer_load_dwordx4 v19, s[20:23], s54 offen offset:1024 lds
MAA 88,108,32
RD 76,31,55488
MAA 88,104,12
ds_read_b64_tr_b16 a[80:81], v25
MAA 160,112,16
TR 82,25,512
MAA 160,116,36
buffer_load_dwordx4 v20, s[20:23], s54 offen offset:2048 lds
MAA 120,116,32
TR 84,25,12416
s_add_u32 s54, s54, 196608
MAA 120,112,12
TR 86,25,12928
MAA 116,112,8
s_add_u32 m0, s55, 39296
MAA 116,116,28
buffer_load_dwordx4 v21, s[36:39], s53 offen lds
MAA 112,116,24
TR 88,25,1024
MAA 112,112,4
TR 90,25,1536
MAA 108,112,0
TR 92,25,13440
MAA 108,116,20
buffer_load_dwordx4 v28, s[36:39], s53 offen offset:1024 lds
MAA 140,20,124
TR 94,25,13952
MAA 140,0,120
TR 96,25,2048
MAA 144,4,120
TR 98,25,2560
MAA 144,24,124
buffer_load_dword v29, s[36:39], s53 offen offset:2048 lds
MAA 148,28,124
TR 100,25,14464
s_add_u32 s53, s53, 128
MAA 148,8,120
TR 102,25,14976
MAA 152,12,120
MAA 152,32,124
s_waitcnt lgkmcnt(8)
s_barrier
MAA 60,80,40
TR 104,25,32
s_add_u32 m0, s56, 136064
MAA 60,84,60
buffer_load_dwordx4 v18, s[20:23], s54 offen lds
MAA 64,84,64
s_sub_u32 s47, s47, 1
s_cbranch_scc1 .Lx12
.Lx12b:
MAA 64,80,44
TR 106,25,544
MAA 68,80,48
TR 108,25,12448
MAA 68,84,68
buffer_load_dwordx4 v19, s[20:23], s54 offen offset:1024 lds
MAA 72,84,72
TR 110,25,12960
MAA 72,80,52
TR 112,25,1056
s_waitcnt lgkmcnt(5)
MAA 244,80,56
TR 114,25,1568
MAA 244,84,76
buffer_load_dwordx4 v20, s[20:23], s54 offen offset:2048 lds
MAA 156,92,76
s_add_u32 s54, s54, 196608
MAA 156,88,56
TR 116,25,13472
MAA 104,88,52
TR 118,25,13984
MAA 104,92,72
TR 120,25,2080
MAA 100,92,68
TR 122,25,2592
s_add_u32 m0, s55, 55488
MAA 100,88,48
buffer_load_dwordx4 v21, s[36:39], s52 offen lds
MAA 96,88,44
TR 124,25,14496
MAA 96,92,64
TR 126,25,15008
MAA 92,92,60
MAA 92,88,40
buffer_load_dwordx4 v28, s[36:39], s52 offen offset:1024 lds
MAA 124,40,96
ds_read_b128 a[0:3], v23
MAA 124,60,100
RD 4,23,2304
MAA 128,64,100
RD 8,23,4608
MAA 128,44,96
buffer_load_dword v22, s[36:39], s52 offen offset:2048 lds
MAA 132,48,96
RD 12,23,6912
s_add_u32 s52, s52, 128
MAA 132,68,100
ds_read_b128 a[16:19], v24
MAA 136,72,100
MAA 136,52,96
s_waitcnt vmcnt(18)
v_cmp_gt_u32 vcc, v36, v37
s_nop 0
s_cbranch_vccnz .Lsp13
.Lsp13b:
s_waitcnt vmcnt(15) lgkmcnt(5)
s_barrier
MAA 76,104,40
ds_read_b128 a[20:23], v30
s_add_u32 m0, s56, 73984
MAA 76,108,60
buffer_load_dwordx4 v18, s[20:23], s54 offen lds
MAA 80,108,64
RD 24,30,2304
MAA 80,104,44
RD 28,30,4608
MAA 84,104,48
RD 32,30,6912
MAA 84,108,68
buffer_load_dwordx4 v19, s[20:23], s54 offen offset:1024 lds
MAA 88,108,72
ds_read_b128 a[36:39], v31
MAA 88,104,52
buffer_load_dwordx4 v20, s[20:23], s54 offen offset:2048 lds
MAA 160,112,56
TR 80,25,24832
s_add_u32 s54, s54, 196608
MAA 160,116,76
TR 82,25,25344
MAA 120,116,72
TR 84,25,37248
s_add_u32 m0, s55, 57792
MAA 120,112,52
buffer_load_dwordx4 v21, s[36:39], s53 offen lds
MAA 116,112,48
TR 86,25,37760
MAA 116,116,68
TR 88,25,25856
MAA 112,116,64
TR 90,25,26368
MAA 112,112,44
buffer_load_dwordx4 v28, s[36:39], s53 offen offset:1024 lds
MAA 108,112,40
TR 92,25,38272
MAA 108,116,60
TR 94,25,38784
MAA 140,60,124
TR 96,25,26880
MAA 140,40,120
buffer_load_dword v29, s[36:39], s53 offen offset:2048 lds
MAA 144,44,120
TR 98,25,27392
s_add_u32 s53, s53, 128
MAA 144,64,124
buffer_load_dwordx4 v[164:167], v26, s[16:19], s75 offen sc1
MAA 148,68,124
TR 100,25,39296
MAA 148,48,120
TR 102,25,39808
MAA 152,52,120
MAA 152,72,124
s_waitcnt lgkmcnt(8)
s_barrier
MAA 60,80,0
TR 104,25,24864
s_add_u32 m0, s56, 86400
MAA 60,84,20
buffer_load_dwordx4 v18, s[20:23], s54 offen lds
MAA 64,84,24
s_sub_u32 s47, s47, 1
s_cbranch_scc1 .Lx14
.Lx14b:
MAA 64,80,4
TR 106,25,25376
MAA 68,80,8
TR 108,25,37280
MAA 68,84,28
buffer_load_dwordx4 v19, s[20:23], s54 offen offset:1024 lds
MAA 72,84,32
TR 110,25,37792
MAA 72,80,12
TR 112,25,25888
s_waitcnt lgkmcnt(5)
MAA 244,80,16
TR 114,25,26400
MAA 244,84,36
buffer_load_dwordx4 v20, s[20:23], s54 offen offset:2048 lds
MAA 156,92,36
TR 116,25,38304
s_add_u32 s54, s54, 196608
MAA 156,88,16
TR 118,25,38816
MAA 104,88,12
TR 120,25,26912
s_add_u32 m0, s55, 0
MAA 104,92,32
buffer_load_dwordx4 v21, s[36:39], s52 offen lds
MAA 100,92,28
MAA 100,88,8
buffer_load_dwordx4 v28, s[36:39], s52 offen offset:1024 lds
MAA 96,88,4
TR 122,25,27424
MAA 96,92,24
TR 124,25,39328
MAA 92,92,20
TR 126,25,39840
MAA 92,88,0
buffer_load_dword v22, s[36:39], s52 offen offset:2048 lds
MAA 124,0,96
RD 40,23,18496
s_add_u32 s52, s52, 128
MAA 124,20,100
RD 44,23,20800
MAA 128,24,100
RD 48,23,23104
MAA 128,4,96
buffer_load_dwordx4 v[168:171], v26, s[16:19], s75 offen offset:1024 sc1
MAA 132,8,96
RD 52,23,25408
MAA 132,28,100
RD 56,24,18496
MAA 136,32,100
MAA 136,12,96
s_waitcnt vmcnt(17) lgkmcnt(5)
s_barrier
MAA 76,104,0
RD 60,30,18496
s_add_u32 m0, s56, 98816
MAA 76,108,20
buffer_load_dwordx4 v18, s[20:23], s54 offen lds
MAA 80,108,24
RD 64,30,20800
MAA 80,104,4
RD 68,30,23104
MAA 84,104,8
RD 72,30,25408
MAA 84,108,28
buffer_load_dwordx4 v19, s[20:23], s54 offen offset:1024 lds
MAA 88,108,32
RD 76,31,18496
MAA 88,104,12
buffer_load_dwordx4 v20, s[20:23], s54 offen offset:2048 lds
MAA 160,112,16
TR 80,25,49664
s_add_u32 s54, s54, 196608
MAA 160,116,36
TR 82,25,50176
MAA 120,116,32
TR 84,25,62080
s_add_u32 m0, s55, 2304
MAA 120,112,12
buffer_load_dwordx4 v21, s[36:39], s53 offen lds
MAA 116,112,8
TR 86,25,62592
MAA 116,116,28
TR 88,25,50688
MAA 112,116,24
TR 90,25,51200
MAA 112,112,4
buffer_load_dwordx4 v28, s[36:39], s53 offen offset:1024 lds
MAA 108,112,0
TR 92,25,63104
MAA 108,116,20
TR 94,25,63616
MAA 140,20,124
TR 96,25,51712
MAA 140,0,120
buffer_load_dword v29, s[36:39], s53 offen offset:2048 lds
MAA 144,4,120
TR 98,25,52224
s_add_u32 s53, s53, 128
MAA 144,24,124
buffer_load_dwordx4 v[172:175], v26, s[16:19], s75 offen offset:2048 sc1
MAA 148,28,124
TR 100,25,64128
MAA 148,8,120
TR 102,25,64640
MAA 152,12,120
MAA 152,32,124
s_waitcnt lgkmcnt(8)
s_barrier
MAA 60,80,40
TR 104,25,49696
s_add_u32 m0, s56, 111232
MAA 60,84,60
buffer_load_dwordx4 v18, s[20:23], s54 offen lds
MAA 64,84,64
s_sub_u32 s47, s47, 1
s_cbranch_scc1 .Lx15
.Lx15b:
MAA 64,80,44
TR 106,25,50208
MAA 68,80,48
TR 108,25,62112
MAA 68,84,68
buffer_load_dwordx4 v19, s[20:23], s54 offen offset:1024 lds
MAA 72,84,72
TR 110,25,62624
MAA 72,80,52
TR 112,25,50720
s_waitcnt lgkmcnt(5)
MAA 244,80,56
TR 114,25,51232
MAA 244,84,76
buffer_load_dwordx4 v20, s[20:23], s54 offen offset:2048 lds
MAA 156,92,76
TR 116,25,63136
s_add_u32 s54, s54, 196608
MAA 156,88,56
TR 118,25,63648
MAA 104,88,52
TR 120,25,51744
s_add_u32 m0, s55, 18496
MAA 104,92,72
buffer_load_dwordx4 v21, s[36:39], s52 offen lds
MAA 100,92,68
MAA 100,88,48
buffer_load_dwordx4 v28, s[36:39], s52 offen offset:1024 lds
MAA 96,88,44
TR 122,25,52256
MAA 96,92,64
TR 124,25,64160
MAA 92,92,60
TR 126,25,64672
MAA 92,88,40
buffer_load_dword v22, s[36:39], s52 offen offset:2048 lds
MAA 124,40,96
RD 0,23,36992
s_add_u32 s52, s52, 128
MAA 124,60,100
RD 4,23,39296
MAA 128,64,100
RD 8,23,41600
MAA 128,44,96
buffer_load_dwordx4 v[176:179], v26, s[16:19], s75 offen offset:3072 sc1
MAA 132,48,96
RD 12,23,43904
s_add_u32 s75, s75, 4096
MAA 132,68,100
RD 16,24,36992
MAA 136,72,100
MAA 136,52,96
s_waitcnt vmcnt(18) lgkmcnt(5)
s_barrier
MAA 76,104,40
RD 20,30,36992
s_add_u32 m0, s56, 123648
MAA 76,108,60
buffer_load_dwordx4 v18, s[20:23], s54 offen lds
MAA 80,108,64
RD 24,30,39296
s_waitcnt vmcnt(15)
v_add_f32 v164, v164, v168
MAA 80,104,44
RD 28,30,41600
MAA 84,104,48
RD 32,30,43904
MAA 84,108,68
buffer_load_dwordx4 v19, s[20:23], s54 offen offset:1024 lds
MAA 88,108,72
RD 36,31,36992
v_add_f32 v165, v165, v169
MAA 88,104,52
buffer_load_dwordx4 v20, s[20:23], s54 offen offset:2048 lds
MAA 160,112,56
ds_read_b64_tr_b16 a[80:81], v25
s_add_u32 s54, s54, 196608
MAA 160,116,76
TR 82,25,512
MAA 120,116,72
TR 84,25,12416
s_add_u32 m0, s55, 20800
MAA 120,112,52
buffer_load_dwordx4 v21, s[36:39], s53 offen lds
MAA 116,112,48
TR 86,25,12928
MAA 116,116,68
TR 88,25,1024
MAA 112,116,64
TR 90,25,1536
v_add_f32 v166, v166, v170
MAA 112,112,44
buffer_load_dwordx4 v28, s[36:39], s53 offen offset:1024 lds
MAA 108,112,40
TR 92,25,13440
MAA 108,116,60
TR 94,25,13952
MAA 140,60,124
TR 96,25,2048
MAA 140,40,120
buffer_load_dword v29, s[36:39], s53 offen offset:2048 lds
MAA 144,44,120
TR 98,25,2560
s_add_u32 s53, s53, 128
MAA 144,64,124
buffer_load_dwordx4 v[180:183], v26, s[16:19], s75 offen sc1
MAA 148,68,124
TR 100,25,14464
v_add_f32 v167, v167, v171
MAA 148,48,120
TR 102,25,14976
MAA 152,52,120
MAA 152,72,124
s_waitcnt lgkmcnt(8)
s_barrier
MAA 60,80,0
TR 104,25,32
s_add_u32 m0, s56, 136064
MAA 60,84,20
buffer_load_dwordx4 v18, s[20:23], s54 offen lds
MAA 64,84,24
s_sub_u32 s47, s47, 1
s_cbranch_scc1 .Lx16
.Lx16b:
MAA 64,80,4
TR 106,25,544
s_waitcnt vmcnt(15)
v_add_f32 v164, v164, v172
MAA 68,80,8
TR 108,25,12448
MAA 68,84,28
buffer_load_dwordx4 v19, s[20:23], s54 offen offset:1024 lds
MAA 72,84,32
TR 110,25,12960
MAA 72,80,12
TR 112,25,1056
s_waitcnt lgkmcnt(5)
MAA 244,80,16
TR 114,25,1568
MAA 244,84,36
buffer_load_dwordx4 v20, s[20:23], s54 offen offset:2048 lds
MAA 156,92,36
TR 116,25,13472
s_add_u32 s54, s54, 196608
MAA 156,88,16
TR 118,25,13984
v_add_f32 v165, v165, v173
MAA 104,88,12
TR 120,25,2080
s_add_u32 m0, s55, 36992
MAA 104,92,32
buffer_load_dwordx4 v21, s[36:39], s52 offen lds
MAA 100,92,28
MAA 100,88,8
buffer_load_dwordx4 v28, s[36:39], s52 offen offset:1024 lds
MAA 96,88,4
TR 122,25,2592
MAA 96,92,24
TR 124,25,14496
v_add_f32 v166, v166, v174
MAA 92,92,20
TR 126,25,15008
MAA 92,88,0
buffer_load_dword v22, s[36:39], s52 offen offset:2048 lds
MAA 124,0,96
RD 40,23,55488
s_add_u32 s52, s52, 128
MAA 124,20,100
RD 44,23,57792
MAA 128,24,100
RD 48,23,60096
MAA 128,4,96
buffer_load_dwordx4 v[184:187], v26, s[16:19], s75 offen offset:1024 sc1
MAA 132,8,96
RD 52,23,62400
v_add_f32 v167, v167, v175
MAA 132,28,100
RD 56,24,55488
MAA 136,32,100
MAA 136,12,96
s_waitcnt vmcnt(18) lgkmcnt(5)
s_barrier
MAA 76,104,0
RD 60,30,55488
s_add_u32 m0, s56, 73984
MAA 76,108,20
buffer_load_dwordx4 v18, s[20:23], s54 offen lds
MAA 80,108,24
RD 64,30,57792
s_waitcnt vmcnt(15)
v_add_f32 v164, v164, v176
MAA 80,104,4
RD 68,30,60096
v_add_f32 v165, v165, v177
MAA 84,104,8
buffer_load_dwordx4 v19, s[20:23], s54 offen offset:1024 lds
MAA 84,108,28
RD 72,30,62400
v_add_f32 v166, v166, v178
MAA 88,108,32
RD 76,31,55488
v_add_f32 v167, v167, v179
MAA 88,104,12
buffer_load_dwordx4 v20, s[20:23], s54 offen offset:2048 lds
MAA 160,112,16
TR 80,25,24832
s_add_u32 s54, s54, 196608
MAA 160,116,36
TR 82,25,25344
s_add_u32 m0, s55, 39296
MAA 120,116,32
buffer_load_dwordx4 v21, s[36:39], s53 offen lds
MAA 120,112,12
TR 84,25,37248
MAA 116,112,8
TR 86,25,37760
MAA 116,116,28
buffer_load_dwordx4 v28, s[36:39], s53 offen offset:1024 lds
MAA 112,116,24
TR 88,25,25856
MAA 112,112,4
TR 90,25,26368
MAA 108,112,0
buffer_load_dword v29, s[36:39], s53 offen offset:2048 lds
MAA 108,116,20
TR 92,25,38272
s_add_u32 s53, s53, 128
MAA 140,20,124
TR 94,25,38784
MAA 140,0,120
buffer_load_dwordx4 v[188:191], v26, s[16:19], s75 offen offset:2048 sc1
MAA 144,4,120
TR 96,25,26880
MAA 144,24,124
TR 98,25,27392
MAA 148,28,124
TR 100,25,39296
MAA 148,8,120
TR 102,25,39808
MAA 152,12,120
MAA 152,32,124
s_waitcnt lgkmcnt(8)
s_barrier
MAA 60,80,40
TR 104,25,24864
s_add_u32 m0, s56, 86400
MAA 60,84,60
buffer_load_dwordx4 v18, s[20:23], s54 offen lds
MAA 64,84,64
s_sub_u32 s47, s47, 1
s_cbranch_scc1 .Lx17
.Lx17b:
MAA 64,80,44
TR 106,25,25376
s_waitcnt vmcnt(15)
v_add_f32 v164, v164, v180
MAA 68,80,48
TR 108,25,37280
MAA 68,84,68
buffer_load_dwordx4 v19, s[20:23], s54 offen offset:1024 lds
MAA 72,84,72
TR 110,25,37792
MAA 72,80,52
TR 112,25,25888
s_waitcnt lgkmcnt(5)
MAA 244,80,56
TR 114,25,26400
MAA 244,84,76
buffer_load_dwordx4 v20, s[20:23], s54 offen offset:2048 lds
MAA 156,92,76
TR 116,25,38304
s_add_u32 s54, s54, 196608
MAA 156,88,56
TR 118,25,38816
v_add_f32 v165, v165, v181
MAA 104,88,52
TR 120,25,26912
s_add_u32 m0, s55, 55488
MAA 104,92,72
buffer_load_dwordx4 v21, s[36:39], s52 offen lds
MAA 100,92,68
MAA 100,88,48
buffer_load_dwordx4 v28, s[36:39], s52 offen offset:1024 lds
MAA 96,88,44
TR 122,25,27424
MAA 96,92,64
TR 124,25,39328
v_add_f32 v166, v166, v182
MAA 92,92,60
TR 126,25,39840
MAA 92,88,40
buffer_load_dword v22, s[36:39], s52 offen offset:2048 lds
MAA 124,40,96
ds_read_b128 a[0:3], v23
s_add_u32 s52, s52, 128
MAA 124,60,100
RD 4,23,2304
MAA 128,64,100
RD 8,23,4608
MAA 128,44,96
buffer_load_dwordx4 v[192:195], v26, s[16:19], s75 offen offset:3072 sc1
MAA 132,48,96
RD 12,23,6912
v_add_f32 v167, v167, v183
MAA 132,68,100
ds_read_b128 a[16:19], v24
MAA 136,72,100
MAA 136,52,96
s_waitcnt vmcnt(18) lgkmcnt(5)
s_barrier
MAA 76,104,40
ds_read_b128 a[20:23], v30
s_add_u32 m0, s56, 98816
MAA 76,108,60
buffer_load_dwordx4 v18, s[20:23], s54 offen lds
MAA 80,108,64
RD 24,30,2304
s_waitcnt vmcnt(15)
v_add_f32 v164, v164, v184
MAA 80,104,44
RD 28,30,4608
v_add_f32 v165, v165, v185
MAA 84,104,48
RD 32,30,6912
v_add_f32 v166, v166, v186
MAA 84,108,68
buffer_load_dwordx4 v19, s[20:23], s54 offen offset:1024 lds
MAA 88,108,72
ds_read_b128 a[36:39], v31
v_add_f32 v167, v167, v187
MAA 88,104,52
TR 80,25,49664
MAA 160,112,56
TR 82,25,50176
MAA 160,116,76
buffer_load_dwordx4 v20, s[20:23], s54 offen offset:2048 lds
MAA 120,116,72
TR 84,25,62080
s_add_u32 s54, s54, 196608
MAA 120,112,52
TR 86,25,62592
s_add_u32 m0, s55, 57792
MAA 116,112,48
TR 88,25,50688
MAA 116,116,68
buffer_load_dwordx4 v21, s[36:39], s53 offen lds
MAA 112,116,64
TR 90,25,51200
MAA 112,112,44
TR 92,25,63104
MAA 108,112,40
TR 94,25,63616
MAA 108,116,60
buffer_load_dwordx4 v28, s[36:39], s53 offen offset:1024 lds
MAA 140,60,124
TR 96,25,51712
MAA 140,40,120
TR 98,25,52224
MAA 144,44,120
TR 100,25,64128
MAA 144,64,124
buffer_load_dword v29, s[36:39], s53 offen offset:2048 lds
MAA 148,68,124
TR 102,25,64640
s_add_u32 s53, s53, 128
MAA 148,48,120
MAA 152,52,120
MAA 152,72,124
s_waitcnt lgkmcnt(8)
s_barrier
MAA 60,80,0
TR 104,25,49696
s_add_u32 m0, s56, 111232
MAA 60,84,20
buffer_load_dwordx4 v18, s[20:23], s54 offen lds
MAA 64,84,24
TR 106,25,50208
s_waitcnt vmcnt(14)
v_add_f32 v164, v164, v188
MAA 64,80,4
TR 108,25,62112
v_add_f32 v165, v165, v189
MAA 68,80,8
buffer_load_dwordx4 v19, s[20:23], s54 offen offset:1024 lds
MAA 68,84,28
TR 110,25,62624
v_add_f32 v166, v166, v190
MAA 72,84,32
TR 112,25,50720
v_add_f32 v167, v167, v191
MAA 72,80,12
buffer_load_dwordx4 v20, s[20:23], s54 offen offset:2048 lds
s_waitcnt lgkmcnt(5)
MAA 244,80,16
TR 114,25,51232
s_add_u32 s54, s54, 196608
MAA 244,84,36
TR 116,25,63136
s_add_u32 m0, s59, 0
MAA 156,92,36
TR 118,25,63648
s_xor_b32 s58, s87, 1048576
MAA 156,88,16
buffer_load_dwordx4 v5, s[24:27], s58 offen lds
MAA 104,88,12
TR 120,25,51744
MAA 104,92,32
TR 122,25,52256
MAA 100,92,28
buffer_load_dwordx4 v6, s[24:27], s58 offen offset:1024 lds
MAA 100,88,8
TR 124,25,64160
s_add_u32 m0, s59, 8320
MAA 96,88,4
TR 126,25,64672
s_xor_b32 s58, s87, 1179648
MAA 96,92,24
buffer_load_dwordx4 v5, s[24:27], s58 offen lds
MAA 92,92,20
RD 40,23,18496
MAA 92,88,0
RD 44,23,20800
MAA 124,0,96
buffer_load_dwordx4 v6, s[24:27], s58 offen offset:1024 lds
MAA 124,20,100
RD 48,23,23104
MAA 128,24,100
RD 52,23,25408
MAA 128,4,96
RD 56,24,18496
MAA 132,8,96
MAA 132,28,100
MAA 136,32,100
MAA 136,12,96
s_waitcnt vmcnt(17) lgkmcnt(5)
s_barrier
MAA 76,104,0
RD 60,30,18496
s_add_u32 m0, s56, 123648
MAA 76,108,20
buffer_load_dwordx4 v18, s[20:23], s54 offen lds
MAA 80,108,24
RD 64,30,20800
s_waitcnt vmcnt(14)
v_add_f32 v164, v164, v192
MAA 80,104,4
RD 68,30,23104
v_add_f32 v165, v165, v193
MAA 84,104,8
RD 72,30,25408
v_add_f32 v166, v166, v194
MAA 84,108,28
RD 76,31,18496
v_add_f32 v167, v167, v195
MAA 88,108,32
ds_read_b64_tr_b16 a[80:81], v25
MAA 88,104,12
TR 82,25,512
MAA 160,112,16
TR 84,25,12416
MAA 160,116,36
buffer_load_dwordx4 v19, s[20:23], s54 offen offset:1024 lds
MAA 120,116,32
TR 86,25,12928
MAA 120,112,12
TR 88,25,1024
MAA 116,112,8
TR 90,25,1536
MAA 116,116,28
TR 92,25,13440
MAA 112,116,24
TR 94,25,13952
MAA 112,112,4
TR 96,25,2048
MAA 108,112,0
TR 98,25,2560
MAA 108,116,20
buffer_load_dwordx4 v20, s[20:23], s54 offen offset:2048 lds
MAA 140,20,124
TR 100,25,14464
s_add_u32 s54, s54, 196608
MAA 140,0,120
TR 102,25,14976
MAA 144,4,120
MAA 144,24,124
MAA 148,28,124
MAA 148,8,120
MAA 152,12,120
MAA 152,32,124
s_waitcnt lgkmcnt(8)
s_barrier
MAA 60,80,40
TR 104,25,32
s_add_u32 m0, s56, 136064
MAA 60,84,60
buffer_load_dwordx4 v18, s[20:23], s54 offen lds
MAA 64,84,64
TR 106,25,544
MAA 64,80,44
TR 108,25,12448
MAA 68,80,48
buffer_load_dwordx4 v19, s[20:23], s54 offen offset:1024 lds
MAA 68,84,68
TR 110,25,12960
MAA 72,84,72
TR 112,25,1056
MAA 72,80,52
buffer_load_dwordx4 v20, s[20:23], s54 offen offset:2048 lds
s_waitcnt lgkmcnt(5)
MAA 244,80,56
TR 114,25,1568
s_add_u32 s54, s54, 196608
MAA 244,84,76
TR 116,25,13472
s_add_u32 m0, s59, 16640
MAA 156,92,76
TR 118,25,13984
s_xor_b32 s58, s87, 1310720
MAA 156,88,56
buffer_load_dwordx4 v5, s[24:27], s58 offen lds
MAA 104,88,52
TR 120,25,2080
MAA 104,92,72
TR 122,25,2592
MAA 100,92,68
buffer_load_dwordx4 v6, s[24:27], s58 offen offset:1024 lds
MAA 100,88,48
TR 124,25,14496
s_add_u32 m0, s59, 24960
MAA 96,88,44
TR 126,25,15008
s_xor_b32 s58, s87, 1441792
MAA 96,92,64
buffer_load_dwordx4 v5, s[24:27], s58 offen lds
MAA 92,92,60
RD 0,23,36992
MAA 92,88,40
RD 4,23,39296
MAA 124,40,96
buffer_load_dwordx4 v6, s[24:27], s58 offen offset:1024 lds
MAA 124,60,100
RD 8,23,41600
MAA 128,64,100
RD 12,23,43904
MAA 128,44,96
RD 16,24,36992
MAA 132,48,96
v_permlane32_swap_b32 v164, v166
MAA 132,68,100
v_permlane32_swap_b32 v165, v167
MAA 136,72,100
v_add_f32 v164, v164, v166
v_add_f32 v165, v165, v167
MAA 136,52,96
v_mul_f32 v164, 0xba800000, v164
v_mul_f32 v165, 0x3a800000, v165
v_fma_f32 v165, -v164, v164, v165
v_max_f32 v165, 0, v165
v_add_f32 v165, 0x3727c5ac, v165
v_rsq_f32 v166, v165
s_nop 0
v_mov_b32 v165, v166
v_mul_f32 v166, 0x3e8293ee, v166
s_waitcnt vmcnt(14) lgkmcnt(5)
s_barrier
MAA 76,104,40
ds_write_b128 v7, v[164:167]
s_add_u32 m0, s59, 74880
MAA 76,108,60
ds_write_b32 v17, v164
s_xor_b32 s58, s87, 131072
MAA 80,108,64
ds_write_b32 v17, v165 offset:1024
MAA 80,104,44
buffer_load_dwordx4 v5, s[24:27], s58 offen lds
MAA 84,104,48
RD 20,30,36992
MAA 84,108,68
RD 24,30,39296
MAA 88,108,72
RD 28,30,41600
MAA 88,104,52
RD 32,30,43904
MAA 160,112,56
RD 36,31,36992
MAA 160,116,76
buffer_load_dwordx4 v6, s[24:27], s58 offen offset:1024 lds
MAA 120,116,72
TR 80,25,24832
s_add_u32 m0, s59, 83200
MAA 120,112,52
TR 82,25,25344
s_xor_b32 s58, s87, 262144
MAA 116,112,48
TR 84,25,37248
MAA 116,116,68
TR 86,25,37760
MAA 112,116,64
TR 88,25,25856
MAA 112,112,44
buffer_load_dwordx4 v5, s[24:27], s58 offen lds
MAA 108,112,40
TR 90,25,26368
MAA 108,116,60
TR 92,25,38272
MAA 140,60,124
TR 94,25,38784
MAA 140,40,120
TR 96,25,26880
MAA 144,44,120
TR 98,25,27392
MAA 144,64,124
buffer_load_dwordx4 v6, s[24:27], s58 offen offset:1024 lds
MAA 148,68,124
TR 100,25,39296
MAA 148,48,120
TR 102,25,39808
MAA 152,52,120
MAA 152,72,124
s_waitcnt vmcnt(8) lgkmcnt(0)
s_barrier
MAA 156,88,16
TR 112,25,25888
s_add_u32 m0, s59, 33280
MAA 156,92,36
TR 114,25,26400
s_xor_b32 s58, s87, 1572864
MAA 104,92,32
buffer_load_dwordx4 v5, s[24:27], s58 offen lds
MAA 104,88,12
TR 116,25,38304
MAA 100,88,8
TR 118,25,38816
MAA 100,92,28
TR 120,25,26912
MAA 96,92,24
buffer_load_dwordx4 v6, s[24:27], s58 offen offset:1024 lds
MAA 96,88,4
TR 122,25,27424
s_add_u32 m0, s59, 41600
MAA 92,88,0
TR 124,25,39328
s_xor_b32 s58, s87, 1703936
MAA 92,92,20
TR 126,25,39840
MAA 136,32,100
buffer_load_dwordx4 v5, s[24:27], s58 offen lds
MAA 136,12,96
TR 104,25,24864
MAA 244,80,16
TR 106,25,25376
MAA 244,84,36
TR 108,25,37280
MAA 72,84,32
buffer_load_dwordx4 v6, s[24:27], s58 offen offset:1024 lds
MAA 72,80,12
TR 110,25,37792
s_xor_b32 s58, s87, 393216
MAA 68,80,8
RD 40,23,55488
MAA 68,84,28
RD 44,23,57792
MAA 64,84,24
RD 48,23,60096
MAA 64,80,4
RD 52,23,62400
MAA 60,80,0
RD 56,24,55488
MAA 60,84,20
RD 60,30,55488
s_waitcnt lgkmcnt(15)
MAA 160,112,16
RD 64,30,57792
s_waitcnt lgkmcnt(15)
MAA 160,116,36
s_waitcnt lgkmcnt(7)
s_barrier
RD 68,30,60096
MAA 120,116,32
RD 72,30,62400
s_add_u32 m0, s59, 91520
MAA 120,112,12
RD 76,31,55488
MAA 116,112,8
TR 144,25,50688
MAA 116,116,28
TR 146,25,51200
MAA 112,116,24
TR 148,25,63104
MAA 112,112,4
TR 150,25,63616
MAA 108,112,0
TR 152,25,50720
MAA 108,116,20
TR 154,25,51232
MAA 152,32,124
TR 156,25,63136
MAA 152,12,120
TR 158,25,63648
MAA 88,104,12
TR 160,25,51712
MAA 88,108,32
TR 162,25,52224
MAA 84,108,28
TR 164,25,64128
MAA 84,104,8
TR 166,25,64640
MAA 80,104,4
TR 168,25,51744
MAA 80,108,24
TR 170,25,52256
MAA 76,108,20
TR 172,25,64160
MAA 76,104,0
TR 174,25,64672
s_waitcnt lgkmcnt(14)
MAA 156,144,56
TR 128,25,49664
s_waitcnt lgkmcnt(13)
MAA 156,148,76
TR 130,25,50176
MAA 104,148,72
TR 132,25,62080
MAA 104,144,52
TR 134,25,62592
MAA 100,144,48
TR 136,25,49696
MAA 100,148,68
TR 138,25,50208
MAA 96,148,64
TR 140,25,62112
MAA 96,144,44
TR 142,25,62624
MAA 92,144,40
ds_read_b128 v[232:235], v10 offset:768
MAA 92,148,60
ds_read_b128 v[236:239], v10 offset:2816
s_waitcnt lgkmcnt(15)
MAA 160,156,76
ds_read_b128 v[228:231], v10 offset:512
MAA 160,152,56
ds_read_b128 v[224:227], v10 offset:256
MAA 120,152,52
ds_read_b128 v[220:223], v10
MAA 120,156,72
buffer_load_dwordx4 v5, s[24:27], s58 offen lds
MAA 116,156,68
MAA 116,152,48
s_waitcnt lgkmcnt(5)
s_barrier
MAA 112,152,44
MAA 112,156,64
buffer_load_dwordx4 v6, s[24:27], s58 offen offset:1024 lds
MAA 108,156,60
s_add_u32 m0, s59, 99840
s_xor_b32 s58, s87, 524288
MAA 108,152,40
MAA 136,52,160
MAA 136,72,164
buffer_load_dwordx4 v5, s[24:27], s58 offen lds
MAA 152,72,172
MAA 152,52,168
MAA 244,128,56
MAA 244,132,76
buffer_load_dwordx4 v6, s[24:27], s58 offen offset:1024 lds
MAA 72,132,72
s_add_u32 m0, s59, 108160
s_xor_b32 s58, s87, 655360
MAA 72,128,52
MAA 68,128,48
MAA 68,132,68
buffer_load_dwordx4 v5, s[24:27], s58 offen lds
buffer_load_dwordx4 v6, s[24:27], s58 offen offset:1024 lds
s_mov_b32 exec_lo, 0x10001
s_mov_b32 exec_hi, 0x10001
ds_write_b128 v13, v[244:247]
ds_write_b128 v13, v[156:159] offset:256
ds_write_b128 v13, v[160:163] offset:320
s_mov_b64 exec, -1
MAA 64,128,44
MAA 64,132,64
MAA 60,132,60
MAA 60,128,40
MAA 88,136,52
MAA 88,140,72
s_waitcnt lgkmcnt(0)
s_barrier
MAA 84,136,48
ds_read_b128 v[28:31], v13
s_add_u32 m0, s59, 49920
MAA 84,140,68
ds_read_b128 v[32:35], v13 offset:64
s_xor_b32 s58, s87, 1835008
MAA 80,140,64
ds_read_b128 v[36:39], v13 offset:256
MAA 80,136,44
ds_read_b128 v[40:43], v13 offset:320
MAA 76,136,40
ds_read_b32 v44, v12 offset:512
MAA 76,140,60
ds_read_b32 v45, v12 offset:576
ds_read_b128 v[240:243], v11 offset:192
ds_read_b128 v[244:247], v11 offset:1216
ds_read_b128 v[18:21], v11 offset:128
ds_read_b128 v[22:25], v11 offset:1152
buffer_load_dwordx4 v5, s[24:27], s58 offen lds
s_waitcnt lgkmcnt(9)
v_pk_fma_f32 v[72:73], v[28:29], v[232:233], v[72:73] op_sel_hi:[1,0,1]
v_cvt_pk_bf16_f32 v176, v72, v73
v_pk_fma_f32 v[74:75], v[30:31], v[232:233], v[74:75] op_sel_hi:[1,0,1]
v_cvt_pk_bf16_f32 v177, v74, v75
s_waitcnt lgkmcnt(8)
v_pk_fma_f32 v[88:89], v[32:33], v[232:233], v[88:89] op_sel_hi:[1,0,1]
v_cvt_pk_bf16_f32 v178, v88, v89
v_pk_fma_f32 v[90:91], v[34:35], v[232:233], v[90:91] op_sel_hi:[1,0,1]
s_waitcnt lgkmcnt(7)
v_pk_fma_f32 v[104:105], v[36:37], v[232:233], v[104:105] op_sel_hi:[1,0,1]
v_pk_mul_f32 v[104:105], v[104:105], v[232:233] op_sel:[0,1] op_sel_hi:[1,1]
v_cvt_pk_bf16_f32 v196, v104, v105
v_pk_fma_f32 v[106:107], v[38:39], v[232:233], v[106:107] op_sel_hi:[1,0,1]
v_pk_mul_f32 v[106:107], v[106:107], v[232:233] op_sel:[0,1] op_sel_hi:[1,1]
v_cvt_pk_bf16_f32 v197, v106, v107
s_waitcnt lgkmcnt(6)
v_pk_fma_f32 v[120:121], v[40:41], v[232:233], v[120:121] op_sel_hi:[1,0,1]
v_pk_mul_f32 v[120:121], v[120:121], v[232:233] op_sel:[0,1] op_sel_hi:[1,1]
v_cvt_pk_bf16_f32 v198, v120, v121
v_pk_fma_f32 v[122:123], v[42:43], v[232:233], v[122:123] op_sel_hi:[1,0,1]
v_pk_mul_f32 v[122:123], v[122:123], v[232:233] op_sel:[0,1] op_sel_hi:[1,1]
v_cvt_pk_bf16_f32 v199, v122, v123
ds_write_b128 v8, v[196:199]
s_waitcnt lgkmcnt(4)
v_pk_fma_f32 v[136:137], v[240:241], v[44:45], v[136:137] op_sel_hi:[1,0,1]
v_pk_fma_f32 v[138:139], v[242:243], v[44:45], v[138:139] op_sel_hi:[1,0,1]
s_waitcnt lgkmcnt(3)
v_pk_mul_f32 v[136:137], v[136:137], v[244:245]
v_cvt_pk_bf16_f32 v208, v136, v137
v_pk_mul_f32 v[138:139], v[138:139], v[246:247]
v_cvt_pk_bf16_f32 v209, v138, v139
v_pk_fma_f32 v[152:153], v[240:241], v[44:45], v[152:153] op_sel:[0,1,0] op_sel_hi:[1,1,1]
v_pk_mul_f32 v[152:153], v[152:153], v[244:245]
v_cvt_pk_bf16_f32 v218, v152, v153
v_pk_fma_f32 v[154:155], v[242:243], v[44:45], v[154:155] op_sel:[0,1,0] op_sel_hi:[1,1,1]
v_pk_mul_f32 v[154:155], v[154:155], v[246:247]
v_cvt_pk_bf16_f32 v219, v154, v155
ds_write_b64 v8, v[208:209] offset:1024
ds_write_b64 v8, v[218:219] offset:1032
v_pk_fma_f32 v[156:157], v[36:37], v[236:237], v[156:157] op_sel_hi:[1,0,1]
v_pk_mul_f32 v[156:157], v[156:157], v[236:237] op_sel:[0,1] op_sel_hi:[1,1]
v_cvt_pk_bf16_f32 v180, v156, v157
v_pk_fma_f32 v[158:159], v[38:39], v[236:237], v[158:159] op_sel_hi:[1,0,1]
v_pk_mul_f32 v[158:159], v[158:159], v[236:237] op_sel:[0,1] op_sel_hi:[1,1]
v_cvt_pk_bf16_f32 v181, v158, v159
v_pk_fma_f32 v[160:161], v[40:41], v[236:237], v[160:161] op_sel_hi:[1,0,1]
v_pk_mul_f32 v[160:161], v[160:161], v[236:237] op_sel:[0,1] op_sel_hi:[1,1]
v_cvt_pk_bf16_f32 v182, v160, v161
v_pk_fma_f32 v[162:163], v[42:43], v[236:237], v[162:163] op_sel_hi:[1,0,1]
v_pk_mul_f32 v[162:163], v[162:163], v[236:237] op_sel:[0,1] op_sel_hi:[1,1]
v_cvt_pk_bf16_f32 v183, v162, v163
v_pk_fma_f32 v[100:101], v[36:37], v[228:229], v[100:101] op_sel_hi:[1,0,1]
v_pk_mul_f32 v[100:101], v[100:101], v[228:229] op_sel:[0,1] op_sel_hi:[1,1]
v_cvt_pk_bf16_f32 v192, v100, v101
v_pk_fma_f32 v[102:103], v[38:39], v[228:229], v[102:103] op_sel_hi:[1,0,1]
v_pk_mul_f32 v[102:103], v[102:103], v[228:229] op_sel:[0,1] op_sel_hi:[1,1]
v_cvt_pk_bf16_f32 v193, v102, v103
v_pk_fma_f32 v[116:117], v[40:41], v[228:229], v[116:117] op_sel_hi:[1,0,1]
v_pk_mul_f32 v[116:117], v[116:117], v[228:229] op_sel:[0,1] op_sel_hi:[1,1]
v_cvt_pk_bf16_f32 v194, v116, v117
v_pk_fma_f32 v[118:119], v[42:43], v[228:229], v[118:119] op_sel_hi:[1,0,1]
v_pk_mul_f32 v[118:119], v[118:119], v[228:229] op_sel:[0,1] op_sel_hi:[1,1]
s_waitcnt lgkmcnt(0)
s_barrier
v_cvt_pk_bf16_f32 v195, v118, v119
v_pk_fma_f32 v[96:97], v[36:37], v[224:225], v[96:97] op_sel_hi:[1,0,1]
v_pk_mul_f32 v[96:97], v[96:97], v[224:225] op_sel:[0,1] op_sel_hi:[1,1]
v_cvt_pk_bf16_f32 v188, v96, v97
v_pk_fma_f32 v[98:99], v[38:39], v[224:225], v[98:99] op_sel_hi:[1,0,1]
v_pk_mul_f32 v[98:99], v[98:99], v[224:225] op_sel:[0,1] op_sel_hi:[1,1]
v_cvt_pk_bf16_f32 v189, v98, v99
v_pk_fma_f32 v[112:113], v[40:41], v[224:225], v[112:113] op_sel_hi:[1,0,1]
v_pk_mul_f32 v[112:113], v[112:113], v[224:225] op_sel:[0,1] op_sel_hi:[1,1]
v_cvt_pk_bf16_f32 v190, v112, v113
v_pk_fma_f32 v[114:115], v[42:43], v[224:225], v[114:115] op_sel_hi:[1,0,1]
v_pk_mul_f32 v[114:115], v[114:115], v[224:225] op_sel:[0,1] op_sel_hi:[1,1]
v_cvt_pk_bf16_f32 v191, v114, v115
v_pk_fma_f32 v[92:93], v[36:37], v[220:221], v[92:93] op_sel_hi:[1,0,1]
v_pk_mul_f32 v[92:93], v[92:93], v[220:221] op_sel:[0,1] op_sel_hi:[1,1]
v_cvt_pk_bf16_f32 v184, v92, v93
v_pk_fma_f32 v[94:95], v[38:39], v[220:221], v[94:95] op_sel_hi:[1,0,1]
v_pk_mul_f32 v[94:95], v[94:95], v[220:221] op_sel:[0,1] op_sel_hi:[1,1]
v_cvt_pk_bf16_f32 v185, v94, v95
v_pk_fma_f32 v[108:109], v[40:41], v[220:221], v[108:109] op_sel_hi:[1,0,1]
v_pk_mul_f32 v[108:109], v[108:109], v[220:221] op_sel:[0,1] op_sel_hi:[1,1]
v_cvt_pk_bf16_f32 v186, v108, v109
v_pk_fma_f32 v[110:111], v[42:43], v[220:221], v[110:111] op_sel_hi:[1,0,1]
v_pk_mul_f32 v[110:111], v[110:111], v[220:221] op_sel:[0,1] op_sel_hi:[1,1]
v_cvt_pk_bf16_f32 v187, v110, v111
v_cvt_pk_bf16_f32 v179, v90, v91
v_pk_fma_f32 v[68:69], v[28:29], v[228:229], v[68:69] op_sel_hi:[1,0,1]
v_cvt_pk_bf16_f32 v172, v68, v69
v_pk_fma_f32 v[70:71], v[30:31], v[228:229], v[70:71] op_sel_hi:[1,0,1]
v_cvt_pk_bf16_f32 v173, v70, v71
v_pk_fma_f32 v[84:85], v[32:33], v[228:229], v[84:85] op_sel_hi:[1,0,1]
v_cvt_pk_bf16_f32 v174, v84, v85
v_pk_fma_f32 v[86:87], v[34:35], v[228:229], v[86:87] op_sel_hi:[1,0,1]
v_cvt_pk_bf16_f32 v175, v86, v87
v_pk_fma_f32 v[64:65], v[28:29], v[224:225], v[64:65] op_sel_hi:[1,0,1]
v_cvt_pk_bf16_f32 v168, v64, v65
v_pk_fma_f32 v[66:67], v[30:31], v[224:225], v[66:67] op_sel_hi:[1,0,1]
v_cvt_pk_bf16_f32 v169, v66, v67
v_pk_fma_f32 v[80:81], v[32:33], v[224:225], v[80:81] op_sel_hi:[1,0,1]
v_cvt_pk_bf16_f32 v170, v80, v81
v_pk_fma_f32 v[82:83], v[34:35], v[224:225], v[82:83] op_sel_hi:[1,0,1]
v_cvt_pk_bf16_f32 v171, v82, v83
v_pk_fma_f32 v[60:61], v[28:29], v[220:221], v[60:61] op_sel_hi:[1,0,1]
v_cvt_pk_bf16_f32 v164, v60, v61
v_pk_fma_f32 v[62:63], v[30:31], v[220:221], v[62:63] op_sel_hi:[1,0,1]
v_cvt_pk_bf16_f32 v165, v62, v63
v_pk_fma_f32 v[76:77], v[32:33], v[220:221], v[76:77] op_sel_hi:[1,0,1]
v_cvt_pk_bf16_f32 v166, v76, v77
v_pk_fma_f32 v[78:79], v[34:35], v[220:221], v[78:79] op_sel_hi:[1,0,1]
v_cvt_pk_bf16_f32 v167, v78, v79
s_nop 0
v_mfma_f32_16x16x32_bf16 v[120:123], v[196:199], v[176:179], v[50:53]
buffer_load_dwordx4 v6, s[24:27], s58 offen offset:1024 lds
v_mfma_f32_16x16x32_bf16 v[104:107], v[192:195], v[176:179], v[46:49]
ds_read_b64 v[200:201], v9 offset:1024
s_add_u32 m0, s59, 58240
v_mfma_f32_16x16x32_bf16 v[116:119], v[192:195], v[172:175], v[50:53]
ds_read_b64 v[210:211], v9 offset:1032
s_xor_b32 s58, s87, 1966080
v_mfma_f32_16x16x32_bf16 v[100:103], v[188:191], v[172:175], v[46:49]
ds_read_b128 v[240:243], v11 offset:64
v_mfma_f32_16x16x32_bf16 v[112:115], v[188:191], v[168:171], v[50:53]
buffer_load_dwordx4 v5, s[24:27], s58 offen lds
v_mfma_f32_16x16x32_bf16 v[96:99], v[184:187], v[168:171], v[46:49]
ds_read_b128 v[244:247], v11 offset:1088
v_max3_f32 v88, v104, v105, v106
v_mfma_f32_16x16x32_bf16 v[108:111], v[184:187], v[164:167], v[50:53]
ds_read_b128 v[28:31], v11
v_max3_f32 v89, v107, v120, v121
v_mfma_f32_16x16x32_bf16 v[92:95], v[180:183], v[164:167], v[54:57]
ds_read_b128 v[32:35], v11 offset:1024
v_max3_f32 v88, v88, v122, v123
MAA 132,8,96
buffer_load_dwordx4 v6, s[24:27], s58 offen offset:1024 lds
MAA 132,28,100
s_add_u32 m0, s59, 66560
s_xor_b32 s58, s87, 0
v_max_f32 v90, v88, v89
MAA 132,48,160
v_max_f32 v89, v88, v89
v_max3_f32 v84, v100, v101, v102
MAA 132,68,164
v_permlane16_swap_b32 v90, v89
MAA 148,68,172
buffer_load_dwordx4 v5, s[24:27], s58 offen lds
MAA 148,48,168
v_max_f32 v88, v90, v89
v_max_f32 v89, v90, v89
MAA 148,28,124
s_nop 0
v_permlane32_swap_b32 v88, v89
MAA 148,8,120
v_max_f32 v88, v88, v89
v_mul_f32 v88, v88, v234
v_max3_f32 v85, v103, v116, v117
v_max3_f32 v84, v84, v118, v119
v_max_f32 v86, v84, v85
v_max_f32 v85, v84, v85
v_max3_f32 v80, v96, v97, v98
v_max3_f32 v81, v99, v112, v113
v_permlane16_swap_b32 v86, v85
v_max3_f32 v80, v80, v114, v115
v_max_f32 v84, v86, v85
v_max_f32 v85, v86, v85
v_max_f32 v82, v80, v81
v_max_f32 v81, v80, v81
v_permlane32_swap_b32 v84, v85
v_max3_f32 v76, v92, v93, v94
v_max_f32 v84, v84, v85
v_mul_f32 v84, v84, v230
v_permlane16_swap_b32 v82, v81
v_max3_f32 v77, v95, v108, v109
v_max_f32 v80, v82, v81
v_max_f32 v81, v82, v81
v_max3_f32 v76, v76, v110, v111
v_max_f32 v78, v76, v77
v_permlane32_swap_b32 v80, v81
v_max_f32 v77, v76, v77
v_max_f32 v80, v80, v81
v_mul_f32 v80, v80, v226
v_permlane16_swap_b32 v78, v77
v_pk_fma_f32 v[104:105], v[104:105], v[234:235], v[88:89] op_sel_hi:[1,0,0] neg_lo:[0,0,1] neg_hi:[0,0,1]
v_max_f32 v76, v78, v77
v_max_f32 v77, v78, v77
v_pk_fma_f32 v[106:107], v[106:107], v[234:235], v[88:89] op_sel_hi:[1,0,0] neg_lo:[0,0,1] neg_hi:[0,0,1]
v_pk_fma_f32 v[120:121], v[120:121], v[234:235], v[88:89] op_sel_hi:[1,0,0] neg_lo:[0,0,1] neg_hi:[0,0,1]
v_permlane32_swap_b32 v76, v77
v_pk_fma_f32 v[122:123], v[122:123], v[234:235], v[88:89] op_sel_hi:[1,0,0] neg_lo:[0,0,1] neg_hi:[0,0,1]
v_max_f32 v76, v76, v77
v_mul_f32 v76, v76, v222
v_pk_fma_f32 v[100:101], v[100:101], v[230:231], v[84:85] op_sel_hi:[1,0,0] neg_lo:[0,0,1] neg_hi:[0,0,1]
v_pk_fma_f32 v[102:103], v[102:103], v[230:231], v[84:85] op_sel_hi:[1,0,0] neg_lo:[0,0,1] neg_hi:[0,0,1]
v_pk_fma_f32 v[116:117], v[116:117], v[230:231], v[84:85] op_sel_hi:[1,0,0] neg_lo:[0,0,1] neg_hi:[0,0,1]
v_pk_fma_f32 v[118:119], v[118:119], v[230:231], v[84:85] op_sel_hi:[1,0,0] neg_lo:[0,0,1] neg_hi:[0,0,1]
v_pk_fma_f32 v[96:97], v[96:97], v[226:227], v[80:81] op_sel_hi:[1,0,0] neg_lo:[0,0,1] neg_hi:[0,0,1]
v_pk_fma_f32 v[98:99], v[98:99], v[226:227], v[80:81] op_sel_hi:[1,0,0] neg_lo:[0,0,1] neg_hi:[0,0,1]
v_pk_fma_f32 v[112:113], v[112:113], v[226:227], v[80:81] op_sel_hi:[1,0,0] neg_lo:[0,0,1] neg_hi:[0,0,1]
v_pk_fma_f32 v[114:115], v[114:115], v[226:227], v[80:81] op_sel_hi:[1,0,0] neg_lo:[0,0,1] neg_hi:[0,0,1]
v_pk_fma_f32 v[92:93], v[92:93], v[222:223], v[76:77] op_sel_hi:[1,0,0] neg_lo:[0,0,1] neg_hi:[0,0,1]
v_pk_fma_f32 v[94:95], v[94:95], v[222:223], v[76:77] op_sel_hi:[1,0,0] neg_lo:[0,0,1] neg_hi:[0,0,1]
v_pk_fma_f32 v[108:109], v[108:109], v[222:223], v[76:77] op_sel_hi:[1,0,0] neg_lo:[0,0,1] neg_hi:[0,0,1]
v_pk_fma_f32 v[110:111], v[110:111], v[222:223], v[76:77] op_sel_hi:[1,0,0] neg_lo:[0,0,1] neg_hi:[0,0,1]
v_pk_fma_f32 v[132:133], v[18:19], v[44:45], v[132:133] op_sel_hi:[1,0,1]
v_pk_mul_f32 v[132:133], v[132:133], v[22:23]
v_pk_fma_f32 v[134:135], v[20:21], v[44:45], v[134:135] op_sel_hi:[1,0,1]
v_pk_mul_f32 v[134:135], v[134:135], v[24:25]
v_pk_fma_f32 v[148:149], v[18:19], v[44:45], v[148:149] op_sel:[0,1,0] op_sel_hi:[1,1,1]
v_pk_mul_f32 v[148:149], v[148:149], v[22:23]
v_pk_fma_f32 v[150:151], v[20:21], v[44:45], v[150:151] op_sel:[0,1,0] op_sel_hi:[1,1,1]
v_pk_mul_f32 v[150:151], v[150:151], v[24:25]
v_exp_f32 v104, v104
s_nop 0
MAA 128,4,96
buffer_load_dwordx4 v6, s[24:27], s58 offen offset:1024 lds
MAA 128,24,100
s_add_u32 m0, s59, 116480
s_xor_b32 s58, s87, 786432
v_exp_f32 v105, v105
MAA 128,44,160
v_exp_f32 v106, v106
MAA 128,64,164
v_exp_f32 v107, v107
MAA 144,64,172
buffer_load_dwordx4 v5, s[24:27], s58 offen lds
MAA 144,44,168
v_exp_f32 v120, v120
MAA 144,24,124
v_exp_f32 v121, v121
MAA 144,4,120
v_exp_f32 v122, v122
MAA 124,0,96
buffer_load_dwordx4 v6, s[24:27], s58 offen offset:1024 lds
MAA 124,20,100
s_add_u32 m0, s59, 124800
s_xor_b32 s58, s87, 917504
v_exp_f32 v123, v123
MAA 124,40,160
v_exp_f32 v100, v100
MAA 124,60,164
v_exp_f32 v101, v101
MAA 140,60,172
buffer_load_dwordx4 v5, s[24:27], s58 offen lds
MAA 140,40,168
v_exp_f32 v102, v102
MAA 140,20,124
v_exp_f32 v103, v103
MAA 140,0,120
v_cvt_pk_bf16_f32 v72, v104, v105
v_cvt_pk_bf16_f32 v73, v106, v107
v_cvt_pk_bf16_f32 v74, v120, v121
v_cvt_pk_bf16_f32 v75, v122, v123
v_exp_f32 v116, v116
v_exp_f32 v117, v117
v_exp_f32 v118, v118
v_exp_f32 v119, v119
v_cvt_pk_bf16_f32 v68, v100, v101
v_cvt_pk_bf16_f32 v69, v102, v103
v_cvt_pk_bf16_f32 v70, v116, v117
v_cvt_pk_bf16_f32 v71, v118, v119
v_exp_f32 v96, v96
v_exp_f32 v97, v97
v_exp_f32 v98, v98
v_exp_f32 v99, v99
v_exp_f32 v112, v112
v_exp_f32 v113, v113
v_exp_f32 v114, v114
v_exp_f32 v115, v115
v_cvt_pk_bf16_f32 v64, v96, v97
v_cvt_pk_bf16_f32 v65, v98, v99
v_cvt_pk_bf16_f32 v66, v112, v113
v_cvt_pk_bf16_f32 v67, v114, v115
v_cvt_pk_bf16_f32 v206, v132, v133
v_cvt_pk_bf16_f32 v207, v134, v135
v_cvt_pk_bf16_f32 v216, v148, v149
v_cvt_pk_bf16_f32 v217, v150, v151
s_waitcnt lgkmcnt(3)
v_pk_fma_f32 v[128:129], v[240:241], v[44:45], v[128:129] op_sel_hi:[1,0,1]
s_waitcnt lgkmcnt(2)
v_pk_mul_f32 v[128:129], v[128:129], v[244:245]
v_cvt_pk_bf16_f32 v204, v128, v129
v_pk_fma_f32 v[130:131], v[242:243], v[44:45], v[130:131] op_sel_hi:[1,0,1]
v_pk_mul_f32 v[130:131], v[130:131], v[246:247]
v_cvt_pk_bf16_f32 v205, v130, v131
v_pk_fma_f32 v[144:145], v[240:241], v[44:45], v[144:145] op_sel:[0,1,0] op_sel_hi:[1,1,1]
v_pk_mul_f32 v[144:145], v[144:145], v[244:245]
v_cvt_pk_bf16_f32 v214, v144, v145
v_pk_fma_f32 v[146:147], v[242:243], v[44:45], v[146:147] op_sel:[0,1,0] op_sel_hi:[1,1,1]
v_pk_mul_f32 v[146:147], v[146:147], v[246:247]
v_cvt_pk_bf16_f32 v215, v146, v147
s_waitcnt lgkmcnt(1)
v_pk_fma_f32 v[124:125], v[28:29], v[44:45], v[124:125] op_sel_hi:[1,0,1]
s_waitcnt lgkmcnt(0)
v_pk_mul_f32 v[124:125], v[124:125], v[32:33]
v_cvt_pk_bf16_f32 v202, v124, v125
v_pk_fma_f32 v[126:127], v[30:31], v[44:45], v[126:127] op_sel_hi:[1,0,1]
v_pk_mul_f32 v[126:127], v[126:127], v[34:35]
v_cvt_pk_bf16_f32 v203, v126, v127
v_pk_fma_f32 v[140:141], v[28:29], v[44:45], v[140:141] op_sel:[0,1,0] op_sel_hi:[1,1,1]
v_pk_mul_f32 v[140:141], v[140:141], v[32:33]
v_cvt_pk_bf16_f32 v212, v140, v141
v_pk_fma_f32 v[142:143], v[30:31], v[44:45], v[142:143] op_sel:[0,1,0] op_sel_hi:[1,1,1]
v_pk_mul_f32 v[142:143], v[142:143], v[34:35]
v_cvt_pk_bf16_f32 v213, v142, v143
s_nop 0
v_mfma_f32_16x16x32_bf16 v[88:91], v[248:251], v[72:75], 0
buffer_load_dwordx4 v6, s[24:27], s58 offen offset:1024 lds
v_mfma_f32_16x16x32_bf16 v[104:107], v[206:209], v[72:75], 0
v_exp_f32 v92, v92
v_mfma_f32_16x16x32_bf16 v[120:123], v[216:219], v[72:75], 0
v_exp_f32 v93, v93
v_mfma_f32_16x16x32_bf16 v[84:87], v[248:251], v[68:71], 0
v_exp_f32 v94, v94
v_mfma_f32_16x16x32_bf16 v[100:103], v[204:207], v[68:71], 0
v_exp_f32 v95, v95
v_mfma_f32_16x16x32_bf16 v[116:119], v[214:217], v[68:71], 0
v_exp_f32 v108, v108
v_mfma_f32_16x16x32_bf16 v[80:83], v[248:251], v[64:67], 0
v_exp_f32 v109, v109
v_mfma_f32_16x16x32_bf16 v[96:99], v[202:205], v[64:67], 0
v_exp_f32 v110, v110
v_mfma_f32_16x16x32_bf16 v[112:115], v[212:215], v[64:67], 0
v_exp_f32 v111, v111
v_cvt_pk_bf16_f32 v60, v92, v93
v_cvt_pk_bf16_f32 v61, v94, v95
v_cvt_pk_bf16_f32 v62, v108, v109
v_cvt_pk_bf16_f32 v63, v110, v111
v_rcp_f32 v88, v88
v_rcp_f32 v84, v84
v_mfma_f32_16x16x32_bf16 v[76:79], v[248:251], v[60:63], 0
v_rcp_f32 v80, v80
v_mfma_f32_16x16x32_bf16 v[92:95], v[200:203], v[60:63], 0
v_mfma_f32_16x16x32_bf16 v[108:111], v[210:213], v[60:63], 0
s_nop 4
v_rcp_f32 v76, v76
v_pk_mul_f32 v[104:105], v[104:105], v[88:89] op_sel_hi:[1,0]
v_pk_mul_f32 v[106:107], v[106:107], v[88:89] op_sel_hi:[1,0]
v_pk_mul_f32 v[120:121], v[120:121], v[88:89] op_sel_hi:[1,0]
v_pk_mul_f32 v[122:123], v[122:123], v[88:89] op_sel_hi:[1,0]
v_cvt_pk_bf16_f32 v176, v104, v105
v_cvt_pk_bf16_f32 v177, v106, v107
v_cvt_pk_bf16_f32 v178, v120, v121
v_cvt_pk_bf16_f32 v179, v122, v123
buffer_store_dwordx4 v[176:179], v4, s[16:19], s74 offen offset:3072 sc1
v_pk_mul_f32 v[100:101], v[100:101], v[84:85] op_sel_hi:[1,0]
v_pk_mul_f32 v[102:103], v[102:103], v[84:85] op_sel_hi:[1,0]
v_pk_mul_f32 v[116:117], v[116:117], v[84:85] op_sel_hi:[1,0]
v_pk_mul_f32 v[118:119], v[118:119], v[84:85] op_sel_hi:[1,0]
v_cvt_pk_bf16_f32 v172, v100, v101
v_cvt_pk_bf16_f32 v173, v102, v103
v_cvt_pk_bf16_f32 v174, v116, v117
v_cvt_pk_bf16_f32 v175, v118, v119
buffer_store_dwordx4 v[172:175], v4, s[16:19], s74 offen offset:2048 sc1
v_pk_mul_f32 v[96:97], v[96:97], v[80:81] op_sel_hi:[1,0]
v_pk_mul_f32 v[98:99], v[98:99], v[80:81] op_sel_hi:[1,0]
v_pk_mul_f32 v[112:113], v[112:113], v[80:81] op_sel_hi:[1,0]
v_pk_mul_f32 v[114:115], v[114:115], v[80:81] op_sel_hi:[1,0]
v_cvt_pk_bf16_f32 v168, v96, v97
v_cvt_pk_bf16_f32 v169, v98, v99
v_cvt_pk_bf16_f32 v170, v112, v113
v_cvt_pk_bf16_f32 v171, v114, v115
buffer_store_dwordx4 v[168:171], v4, s[16:19], s74 offen offset:1024 sc1
v_pk_mul_f32 v[92:93], v[92:93], v[76:77] op_sel_hi:[1,0]
v_pk_mul_f32 v[94:95], v[94:95], v[76:77] op_sel_hi:[1,0]
v_pk_mul_f32 v[108:109], v[108:109], v[76:77] op_sel_hi:[1,0]
v_pk_mul_f32 v[110:111], v[110:111], v[76:77] op_sel_hi:[1,0]
v_cvt_pk_bf16_f32 v164, v92, v93
v_cvt_pk_bf16_f32 v165, v94, v95
v_cvt_pk_bf16_f32 v166, v108, v109
v_cvt_pk_bf16_f32 v167, v110, v111
buffer_store_dwordx4 v[164:167], v4, s[16:19], s74 offen sc1
s_nop 1
s_branch .Lqkve2
.Lx4:
buffer_load_dword v27, v14, s[76:79], 0 offen
s_mov_b32 s76, s98
s_mov_b32 s77, s99
s_mov_b32 s78, s100
v_mov_b32 v14, v15
s_mov_b32 s47, 5
s_branch .Lx4b
.Lx5:
buffer_load_dword v27, v14, s[76:79], 0 offen
s_mov_b32 s76, s98
s_mov_b32 s77, s99
s_mov_b32 s78, s100
v_mov_b32 v14, v15
s_mov_b32 s47, 5
s_branch .Lx5b
.Lx6:
buffer_load_dword v27, v14, s[76:79], 0 offen
s_mov_b32 s76, s98
s_mov_b32 s77, s99
s_mov_b32 s78, s100
v_mov_b32 v14, v15
s_mov_b32 s47, 5
s_branch .Lx6b
.Lx7:
buffer_load_dword v27, v14, s[76:79], 0 offen
s_mov_b32 s76, s98
s_mov_b32 s77, s99
s_mov_b32 s78, s100
v_mov_b32 v14, v15
s_mov_b32 s47, 5
s_branch .Lx7b
.Lsp8:
s_mov_b32 s15, 0
.Lsp8l:
v_mov_b32 v37, 0
buffer_atomic_add v37, v34, s[40:43], 0 offen sc0
s_add_u32 s15, s15, 1
s_cmp_gt_u32 s15, 100000
s_waitcnt vmcnt(0)
s_cbranch_scc1 .Lsp8b
v_cmp_gt_u32 vcc, v35, v37
s_nop 0
s_cbranch_vccnz .Lsp8l
s_branch .Lsp8b
.Lx9:
buffer_load_dword v27, v14, s[76:79], 0 offen
s_mov_b32 s76, s98
s_mov_b32 s77, s99
s_mov_b32 s78, s100
v_mov_b32 v14, v15
s_mov_b32 s47, 5
s_branch .Lx9b
.Lx10:
buffer_load_dword v27, v14, s[76:79], 0 offen
s_mov_b32 s76, s98
s_mov_b32 s77, s99
s_mov_b32 s78, s100
v_mov_b32 v14, v15
s_mov_b32 s47, 5
s_branch .Lx10b
.Lx11:
buffer_load_dword v27, v14, s[76:79], 0 offen
s_mov_b32 s76, s98
s_mov_b32 s77, s99
s_mov_b32 s78, s100
v_mov_b32 v14, v15
s_mov_b32 s47, 5
s_branch .Lx11b
.Lx12:
buffer_load_dword v27, v14, s[76:79], 0 offen
s_mov_b32 s76, s98
s_mov_b32 s77, s99
s_mov_b32 s78, s100
v_mov_b32 v14, v15
s_mov_b32 s47, 5
s_branch .Lx12b
.Lsp13:
s_mov_b32 s15, 0
.Lsp13l:
v_mov_b32 v37, 0
buffer_atomic_add v37, v33, s[16:19], 0 offen sc0
s_add_u32 s15, s15, 1
s_cmp_gt_u32 s15, 100000
s_waitcnt vmcnt(0)
s_cbranch_scc1 .Lsp13b
v_cmp_gt_u32 vcc, v36, v37
s_nop 0
s_cbranch_vccnz .Lsp13l
s_branch .Lsp13b
.Lx14:
buffer_load_dword v27, v14, s[76:79], 0 offen
s_mov_b32 s76, s98
s_mov_b32 s77, s99
s_mov_b32 s78, s100
v_mov_b32 v14, v15
s_mov_b32 s47, 5
s_branch .Lx14b
.Lx15:
buffer_load_dword v27, v14, s[76:79], 0 offen
s_mov_b32 s76, s98
s_mov_b32 s77, s99
s_mov_b32 s78, s100
v_mov_b32 v14, v15
s_mov_b32 s47, 5
s_branch .Lx15b
.Lx16:
buffer_load_dword v27, v14, s[76:79], 0 offen
s_mov_b32 s76, s98
s_mov_b32 s77, s99
s_mov_b32 s78, s100
v_mov_b32 v14, v15
s_mov_b32 s47, 5
s_branch .Lx16b
.Lx17:
buffer_load_dword v27, v14, s[76:79], 0 offen
s_mov_b32 s76, s98
s_mov_b32 s77, s99
s_mov_b32 s78, s100
v_mov_b32 v14, v15
s_mov_b32 s47, 5
s_branch .Lx17b
.Lx19:
buffer_load_dword v27, v14, s[76:79], 0 offen
s_mov_b32 s76, s98
s_mov_b32 s77, s99
s_mov_b32 s78, s100
v_mov_b32 v14, v15
s_mov_b32 s47, 5
s_branch .Lx19b
.Lx20:
buffer_load_dword v27, v14, s[76:79], 0 offen
s_mov_b32 s76, s98
s_mov_b32 s77, s99
s_mov_b32 s78, s100
v_mov_b32 v14, v15
s_mov_b32 s47, 5
s_branch .Lx20b
.Lx21:
buffer_load_dword v27, v14, s[76:79], 0 offen
s_mov_b32 s76, s98
s_mov_b32 s77, s99
s_mov_b32 s78, s100
v_mov_b32 v14, v15
s_mov_b32 s47, 5
s_branch .Lx21b
.Lx22:
buffer_load_dword v27, v14, s[76:79], 0 offen
s_mov_b32 s76, s98
s_mov_b32 s77, s99
s_mov_b32 s78, s100
v_mov_b32 v14, v15
s_mov_b32 s47, 5
s_branch .Lx22b
.Lsp23:
s_mov_b32 s15, 0
.Lsp23l:
v_mov_b32 v37, 0
buffer_atomic_add v37, v34, s[40:43], 0 offen sc0
s_add_u32 s15, s15, 1
s_cmp_gt_u32 s15, 100000
s_waitcnt vmcnt(0)
s_cbranch_scc1 .Lsp23b
v_cmp_gt_u32 vcc, v35, v37
s_nop 0
s_cbranch_vccnz .Lsp23l
s_branch .Lsp23b
.Lx24:
buffer_load_dword v27, v14, s[76:79], 0 offen
s_mov_b32 s76, s98
s_mov_b32 s77, s99
s_mov_b32 s78, s100
v_mov_b32 v14, v15
s_mov_b32 s47, 5
s_branch .Lx24b
.Lx25:
buffer_load_dword v27, v14, s[76:79], 0 offen
s_mov_b32 s76, s98
s_mov_b32 s77, s99
s_mov_b32 s78, s100
v_mov_b32 v14, v15
s_mov_b32 s47, 5
s_branch .Lx25b
.Lx26:
buffer_load_dword v27, v14, s[76:79], 0 offen
s_mov_b32 s76, s98
s_mov_b32 s77, s99
s_mov_b32 s78, s100
v_mov_b32 v14, v15
s_mov_b32 s47, 5
s_branch .Lx26b
.Lx27:
buffer_load_dword v27, v14, s[76:79], 0 offen
s_mov_b32 s76, s98
s_mov_b32 s77, s99
s_mov_b32 s78, s100
v_mov_b32 v14, v15
s_mov_b32 s47, 5
s_branch .Lx27b
.Lsp28:
s_mov_b32 s15, 0
.Lsp28l:
v_mov_b32 v37, 0
buffer_atomic_add v37, v33, s[16:19], 0 offen sc0
s_add_u32 s15, s15, 1
s_cmp_gt_u32 s15, 100000
s_waitcnt vmcnt(0)
s_cbranch_scc1 .Lsp28b
v_cmp_gt_u32 vcc, v36, v37
s_nop 0
s_cbranch_vccnz .Lsp28l
s_branch .Lsp28b
.Lx29:
buffer_load_dword v27, v14, s[76:79], 0 offen
s_mov_b32 s76, s98
s_mov_b32 s77, s99
s_mov_b32 s78, s100
v_mov_b32 v14, v15
s_mov_b32 s47, 5
s_branch .Lx29b
.Lx30:
buffer_load_dword v27, v14, s[76:79], 0 offen
s_mov_b32 s76, s98
s_mov_b32 s77, s99
s_mov_b32 s78, s100
v_mov_b32 v14, v15
s_mov_b32 s47, 5
s_branch .Lx30b
.Lx31:
buffer_load_dword v27, v14, s[76:79], 0 offen
s_mov_b32 s76, s98
s_mov_b32 s77, s99
s_mov_b32 s78, s100
v_mov_b32 v14, v15
s_mov_b32 s47, 5
s_branch .Lx31b
.Lx32:
buffer_load_dword v27, v14, s[76:79], 0 offen
s_mov_b32 s76, s98
s_mov_b32 s77, s99
s_mov_b32 s78, s100
v_mov_b32 v14, v15
s_mov_b32 s47, 5
s_branch .Lx32b
.Lqkv1:
s_cmp_lt_u32 s14, 16
s_cselect_b32 s62, 0, 4096
v_mov_b32 v231, 1
v_lshlrev_b32 v232, 8, v1
s_waitcnt vmcnt(18)
v_permlane16_swap_b32 v164, v166
v_permlane16_swap_b32 v165, v167
s_waitcnt vmcnt(17)
v_permlane16_swap_b32 v168, v170
v_permlane16_swap_b32 v169, v171
s_waitcnt vmcnt(16)
v_permlane16_swap_b32 v172, v174
v_permlane16_swap_b32 v173, v175
s_waitcnt vmcnt(15)
v_permlane16_swap_b32 v176, v178
v_permlane16_swap_b32 v177, v179
buffer_atomic_add v231, v232, s[40:43], s62 offen
v_lshlrev_b32 v192, 16, v164
v_and_b32 v193, 0xffff0000, v164
v_lshlrev_b32 v194, 16, v165
v_and_b32 v195, 0xffff0000, v165
v_lshlrev_b32 v196, 16, v166
v_and_b32 v197, 0xffff0000, v166
v_lshlrev_b32 v198, 16, v167
v_and_b32 v199, 0xffff0000, v167
v_lshlrev_b32 v200, 16, v168
v_and_b32 v201, 0xffff0000, v168
v_lshlrev_b32 v202, 16, v169
v_and_b32 v203, 0xffff0000, v169
v_lshlrev_b32 v204, 16, v170
v_and_b32 v205, 0xffff0000, v170
v_lshlrev_b32 v206, 16, v171
v_and_b32 v207, 0xffff0000, v171
v_lshlrev_b32 v208, 16, v172
v_and_b32 v209, 0xffff0000, v172
v_lshlrev_b32 v210, 16, v173
v_and_b32 v211, 0xffff0000, v173
v_lshlrev_b32 v212, 16, v174
v_and_b32 v213, 0xffff0000, v174
v_lshlrev_b32 v214, 16, v175
v_and_b32 v215, 0xffff0000, v175
v_lshlrev_b32 v216, 16, v176
v_and_b32 v217, 0xffff0000, v176
v_lshlrev_b32 v218, 16, v177
v_and_b32 v219, 0xffff0000, v177
v_lshlrev_b32 v220, 16, v178
v_and_b32 v221, 0xffff0000, v178
v_lshlrev_b32 v222, 16, v179
v_and_b32 v223, 0xffff0000, v179
s_lshl_b32 s64, s6, 14
s_lshl_b32 s65, s49, 13
s_add_u32 s64, s64, s65
s_lshl_b32 s65, s7, 9
s_add_u32 s64, s64, s65
s_lshl_b32 s65, s48, 8
s_add_u32 s64, s64, s65
s_add_u32 s64, s64, 29360128
v_and_b32 v188, 31, v1
v_lshlrev_b32 v188, 3, v188
v_lshrrev_b32 v189, 5, v1
v_lshl_add_u32 v188, v189, 28, v188
s_lshl_b32 s62, s7, 18
s_add_u32 s62, s62, 0
s_add_u32 s63, s62, 131072
v_pk_mul_f32 v[182:183], v[192:193], v[192:193]
v_pk_mul_f32 v[186:187], v[208:209], v[208:209]
v_pk_fma_f32 v[182:183], v[194:195], v[194:195], v[182:183]
v_pk_add_f32 v[180:181], v[192:193], v[194:195]
v_pk_fma_f32 v[186:187], v[210:211], v[210:211], v[186:187]
v_pk_add_f32 v[184:185], v[208:209], v[210:211]
v_pk_fma_f32 v[182:183], v[196:197], v[196:197], v[182:183]
v_pk_add_f32 v[180:181], v[180:181], v[196:197]
v_pk_fma_f32 v[186:187], v[212:213], v[212:213], v[186:187]
v_pk_add_f32 v[184:185], v[184:185], v[212:213]
v_pk_fma_f32 v[182:183], v[198:199], v[198:199], v[182:183]
v_pk_add_f32 v[180:181], v[180:181], v[198:199]
v_pk_fma_f32 v[186:187], v[214:215], v[214:215], v[186:187]
v_pk_add_f32 v[184:185], v[184:185], v[214:215]
v_pk_fma_f32 v[182:183], v[200:201], v[200:201], v[182:183]
v_pk_add_f32 v[180:181], v[180:181], v[200:201]
v_pk_fma_f32 v[186:187], v[216:217], v[216:217], v[186:187]
v_pk_add_f32 v[184:185], v[184:185], v[216:217]
v_pk_fma_f32 v[182:183], v[202:203], v[202:203], v[182:183]
v_pk_add_f32 v[180:181], v[180:181], v[202:203]
v_pk_fma_f32 v[186:187], v[218:219], v[218:219], v[186:187]
v_pk_add_f32 v[184:185], v[184:185], v[218:219]
v_pk_fma_f32 v[182:183], v[204:205], v[204:205], v[182:183]
v_pk_add_f32 v[180:181], v[180:181], v[204:205]
v_pk_fma_f32 v[186:187], v[220:221], v[220:221], v[186:187]
v_pk_add_f32 v[184:185], v[184:185], v[220:221]
v_pk_fma_f32 v[182:183], v[206:207], v[206:207], v[182:183]
v_pk_add_f32 v[180:181], v[180:181], v[206:207]
v_pk_fma_f32 v[186:187], v[222:223], v[222:223], v[186:187]
v_pk_add_f32 v[184:185], v[184:185], v[222:223]
v_add_f32 v180, v180, v181
v_add_f32 v182, v182, v183
v_add_f32 v184, v184, v185
v_add_f32 v186, v186, v187
s_nop 0
v_permlane16_swap_b32 v180, v184
v_permlane16_swap_b32 v182, v186
v_add_f32 v180, v180, v184
v_add_f32 v182, v182, v186
s_nop 1
v_permlane32_swap_b32 v180, v182
v_add_f32 v180, v180, v182
s_nop 1
v_permlane32_swap_b32 v180, v181
buffer_store_dwordx2 v[180:181], v188, s[16:19], s64 offen sc1
s_lshl_b32 s62, s2, 10
s_add_u32 s62, s62, 31457280
s_cmp_eq_u32 s3, 0
s_cselect_b32 s62, s62, 268435456
buffer_store_dwordx4 v[224:227], v230, s[16:19], s62 offen sc1
v_accvgpr_write_b32 a224, v192
v_accvgpr_write_b32 a225, v193
v_accvgpr_write_b32 a226, v194
v_accvgpr_write_b32 a227, v195
v_accvgpr_write_b32 a228, v196
v_accvgpr_write_b32 a229, v197
v_accvgpr_write_b32 a230, v198
v_accvgpr_write_b32 a231, v199
v_accvgpr_write_b32 a232, v200
v_accvgpr_write_b32 a233, v201
v_accvgpr_write_b32 a234, v202
v_accvgpr_write_b32 a235, v203
v_accvgpr_write_b32 a236, v204
v_accvgpr_write_b32 a237, v205
v_accvgpr_write_b32 a238, v206
v_accvgpr_write_b32 a239, v207
v_accvgpr_write_b32 a240, v208
v_accvgpr_write_b32 a241, v209
v_accvgpr_write_b32 a242, v210
v_accvgpr_write_b32 a243, v211
v_accvgpr_write_b32 a244, v212
v_accvgpr_write_b32 a245, v213
v_accvgpr_write_b32 a246, v214
v_accvgpr_write_b32 a247, v215
v_accvgpr_write_b32 a248, v216
v_accvgpr_write_b32 a249, v217
v_accvgpr_write_b32 a250, v218
v_accvgpr_write_b32 a251, v219
v_accvgpr_write_b32 a252, v220
v_accvgpr_write_b32 a253, v221
v_accvgpr_write_b32 a254, v222
v_accvgpr_write_b32 a255, v223
s_add_u32 m0, s55, 18496
s_nop 0
buffer_load_dwordx4 v21, s[36:39], s52 offen lds
buffer_load_dwordx4 v28, s[36:39], s52 offen offset:1024 lds
buffer_load_dword v22, s[36:39], s52 offen offset:2048 lds
s_add_u32 s52, s52, 128
s_add_u32 m0, s55, 20800
s_nop 0
buffer_load_dwordx4 v21, s[36:39], s53 offen lds
buffer_load_dwordx4 v28, s[36:39], s53 offen offset:1024 lds
buffer_load_dword v29, s[36:39], s53 offen offset:2048 lds
s_add_u32 s53, s53, 128
s_add_u32 m0, s56, 73984
s_nop 0
buffer_load_dwordx4 v18, s[20:23], s54 offen lds
buffer_load_dwordx4 v19, s[20:23], s54 offen offset:1024 lds
buffer_load_dwordx4 v20, s[20:23], s54 offen offset:2048 lds
s_add_u32 s54, s54, 196608
s_waitcnt vmcnt(12) lgkmcnt(0)
s_barrier
ds_read_b128 a[0:3], v23
RD 4,23,2304
RD 8,23,4608
RD 12,23,6912
ds_read_b128 a[16:19], v24
ds_read_b128 a[20:23], v30
RD 24,30,2304
RD 28,30,4608
RD 32,30,6912
ds_read_b128 a[36:39], v31
TR 80,25,49664
TR 82,25,50176
TR 84,25,62080
TR 86,25,62592
TR 88,25,50688
TR 90,25,51200
TR 92,25,63104
TR 94,25,63616
TR 96,25,51712
TR 98,25,52224
TR 100,25,64128
TR 102,25,64640
s_waitcnt vmcnt(3) lgkmcnt(0)
s_barrier
v_mfma_f32_16x16x32_bf16 v[60:63], a[80:83], a[0:3], 0
TR 104,25,49696
s_add_u32 m0, s56, 86400
MAA 60,84,20
buffer_load_dwordx4 v18, s[20:23], s54 offen lds
v_mfma_f32_16x16x32_bf16 v[64:67], a[80:83], a[4:7], 0
s_sub_u32 s47, s47, 1
s_cbranch_scc1 .Lx19
.Lx19b:
MAA 64,84,24
buffer_load_dwordx4 v19, s[20:23], s54 offen offset:1024 lds
v_mfma_f32_16x16x32_bf16 v[68:71], a[80:83], a[8:11], 0
TR 106,25,50208
MAA 68,84,28
TR 108,25,62112
TR 110,25,62624
TR 112,25,50720
v_mfma_f32_16x16x32_bf16 v[72:75], a[80:83], a[12:15], 0
TR 114,25,51232
MAA 72,84,32
TR 116,25,63136
TR 118,25,63648
v_mfma_f32_16x16x32_bf16 v[104:107], a[88:91], a[12:15], 0
TR 120,25,51744
MAA 104,92,32
buffer_load_dwordx4 v20, s[20:23], s54 offen offset:2048 lds
v_mfma_f32_16x16x32_bf16 v[100:103], a[88:91], a[8:11], 0
s_add_u32 s54, s54, 196608
s_add_u32 m0, s55, 36992
MAA 100,92,28
buffer_load_dwordx4 v21, s[36:39], s52 offen lds
v_mfma_f32_16x16x32_bf16 v[96:99], a[88:91], a[4:7], 0
TR 122,25,52256
MAA 96,92,24
buffer_load_dwordx4 v28, s[36:39], s52 offen offset:1024 lds
v_mfma_f32_16x16x32_bf16 v[92:95], a[88:91], a[0:3], 0
TR 124,25,64160
MAA 92,92,20
buffer_load_dword v22, s[36:39], s52 offen offset:2048 lds
v_mfma_f32_16x16x32_bf16 v[124:127], a[0:3], a[96:99], 0
s_add_u32 s52, s52, 128
s_add_u32 m0, s55, 39296
MAA 124,20,100
buffer_load_dwordx4 v21, s[36:39], s53 offen lds
v_mfma_f32_16x16x32_bf16 v[128:131], a[4:7], a[96:99], 0
TR 126,25,64672
MAA 128,24,100
buffer_load_dwordx4 v28, s[36:39], s53 offen offset:1024 lds
v_mfma_f32_16x16x32_bf16 v[132:135], a[8:11], a[96:99], 0
RD 40,23,18496
MAA 132,28,100
RD 44,23,20800
RD 48,23,23104
RD 52,23,25408
v_mfma_f32_16x16x32_bf16 v[136:139], a[12:15], a[96:99], 0
RD 56,24,18496
MAA 136,32,100
buffer_load_dword v29, s[36:39], s53 offen offset:2048 lds
v_mfma_f32_16x16x32_bf16 v[156:159], a[16:19], a[96:99], 0
s_add_u32 s53, s53, 128
MAA 156,36,100
s_waitcnt vmcnt(6) lgkmcnt(5)
s_barrier
v_mfma_f32_16x16x32_bf16 v[76:79], a[104:107], a[0:3], 0
RD 60,30,18496
s_add_u32 m0, s56, 98816
MAA 76,108,20
buffer_load_dwordx4 v18, s[20:23], s54 offen lds
v_mfma_f32_16x16x32_bf16 v[80:83], a[104:107], a[4:7], 0
RD 64,30,20800
MAA 80,108,24
buffer_load_dwordx4 v19, s[20:23], s54 offen offset:1024 lds
v_mfma_f32_16x16x32_bf16 v[84:87], a[104:107], a[8:11], 0
RD 68,30,23104
MAA 84,108,28
RD 72,30,25408
v_mfma_f32_16x16x32_bf16 v[88:91], a[104:107], a[12:15], 0
RD 76,31,18496
MAA 88,108,32
buffer_load_dwordx4 v20, s[20:23], s54 offen offset:2048 lds
v_mfma_f32_16x16x32_bf16 v[244:247], a[104:107], a[16:19], 0
s_add_u32 s54, s54, 196608
s_add_u32 m0, s56, 111232
MAA 244,108,36
buffer_load_dwordx4 v18, s[20:23], s54 offen lds
v_mfma_f32_16x16x32_bf16 v[120:123], a[112:115], a[12:15], 0
ds_read_b64_tr_b16 a[80:81], v25
MAA 120,116,32
TR 82,25,512
v_mfma_f32_16x16x32_bf16 v[116:119], a[112:115], a[8:11], 0
TR 84,25,12416
MAA 116,116,28
buffer_load_dwordx4 v19, s[20:23], s54 offen offset:1024 lds
v_mfma_f32_16x16x32_bf16 v[112:115], a[112:115], a[4:7], 0
TR 86,25,12928
MAA 112,116,24
buffer_load_dwordx4 v20, s[20:23], s54 offen offset:2048 lds
v_mfma_f32_16x16x32_bf16 v[108:111], a[112:115], a[0:3], 0
TR 88,25,1024
s_add_u32 s54, s54, 196608
MAA 108,116,20
TR 90,25,1536
v_mfma_f32_16x16x32_bf16 v[140:143], a[0:3], a[120:123], 0
TR 92,25,13440
s_add_u32 m0, s55, 55488
MAA 140,20,124
buffer_load_dwordx4 v21, s[36:39], s52 offen lds
v_mfma_f32_16x16x32_bf16 v[144:147], a[4:7], a[120:123], 0
TR 94,25,13952
MAA 144,24,124
buffer_load_dwordx4 v28, s[36:39], s52 offen offset:1024 lds
v_mfma_f32_16x16x32_bf16 v[148:151], a[8:11], a[120:123], 0
TR 96,25,2048
MAA 148,28,124
TR 98,25,2560
v_mfma_f32_16x16x32_bf16 v[152:155], a[12:15], a[120:123], 0
TR 100,25,14464
MAA 152,32,124
buffer_load_dword v22, s[36:39], s52 offen offset:2048 lds
v_mfma_f32_16x16x32_bf16 v[160:163], a[16:19], a[120:123], 0
TR 102,25,14976
s_add_u32 s52, s52, 128
MAA 160,36,124
s_waitcnt vmcnt(9) lgkmcnt(8)
s_barrier
MAA 60,80,40
TR 104,25,32
s_add_u32 m0, s55, 57792
MAA 60,84,60
buffer_load_dwordx4 v21, s[36:39], s53 offen lds
MAA 64,84,64
s_sub_u32 s47, s47, 1
s_cbranch_scc1 .Lx20
.Lx20b:
MAA 64,80,44
buffer_load_dwordx4 v28, s[36:39], s53 offen offset:1024 lds
MAA 68,80,48
TR 106,25,544
MAA 68,84,68
TR 108,25,12448
TR 110,25,12960
TR 112,25,1056
MAA 72,84,72
TR 114,25,1568
MAA 72,80,52
TR 116,25,13472
TR 118,25,13984
s_waitcnt lgkmcnt(8)
MAA 104,88,52
TR 120,25,2080
MAA 104,92,72
buffer_load_dword v29, s[36:39], s53 offen offset:2048 lds
MAA 100,92,68
s_add_u32 s53, s53, 128
s_add_u32 m0, s56, 123648
MAA 100,88,48
buffer_load_dwordx4 v18, s[20:23], s54 offen lds
MAA 96,88,44
TR 122,25,2592
MAA 96,92,64
buffer_load_dwordx4 v19, s[20:23], s54 offen offset:1024 lds
MAA 92,92,60
TR 124,25,14496
MAA 92,88,40
buffer_load_dwordx4 v20, s[20:23], s54 offen offset:2048 lds
MAA 124,40,96
s_add_u32 s54, s54, 196608
s_add_u32 m0, s56, 136064
MAA 124,60,100
buffer_load_dwordx4 v18, s[20:23], s54 offen lds
MAA 128,64,100
TR 126,25,15008
MAA 128,44,96
buffer_load_dwordx4 v19, s[20:23], s54 offen offset:1024 lds
MAA 132,48,96
RD 0,23,36992
MAA 132,68,100
RD 4,23,39296
RD 8,23,41600
RD 12,23,43904
MAA 136,72,100
RD 16,24,36992
MAA 136,52,96
buffer_load_dwordx4 v20, s[20:23], s54 offen offset:2048 lds
MAA 156,56,96
s_add_u32 s54, s54, 196608
MAA 156,76,100
s_waitcnt vmcnt(12) lgkmcnt(5)
s_barrier
MAA 76,104,40
RD 20,30,36992
s_add_u32 m0, s55, 0
MAA 76,108,60
buffer_load_dwordx4 v21, s[36:39], s52 offen lds
MAA 80,108,64
RD 24,30,39296
MAA 80,104,44
buffer_load_dwordx4 v28, s[36:39], s52 offen offset:1024 lds
MAA 84,104,48
RD 28,30,41600
MAA 84,108,68
RD 32,30,43904
RD 36,31,36992
MAA 88,108,72
TR 80,25,24832
MAA 88,104,52
buffer_load_dword v22, s[36:39], s52 offen offset:2048 lds
MAA 244,104,56
s_add_u32 s52, s52, 128
s_add_u32 m0, s55, 2304
MAA 244,108,76
buffer_load_dwordx4 v21, s[36:39], s53 offen lds
MAA 120,116,72
TR 82,25,25344
MAA 120,112,52
buffer_load_dwordx4 v28, s[36:39], s53 offen offset:1024 lds
MAA 116,112,48
TR 84,25,37248
MAA 116,116,68
TR 86,25,37760
TR 88,25,25856
MAA 112,116,64
TR 90,25,26368
MAA 112,112,44
buffer_load_dword v29, s[36:39], s53 offen offset:2048 lds
MAA 108,112,40
s_add_u32 s53, s53, 128
s_add_u32 m0, s56, 73984
MAA 108,116,60
buffer_load_dwordx4 v18, s[20:23], s54 offen lds
MAA 140,60,124
TR 92,25,38272
MAA 140,40,120
buffer_load_dwordx4 v19, s[20:23], s54 offen offset:1024 lds
MAA 144,44,120
TR 94,25,38784
MAA 144,64,124
buffer_load_dwordx4 v20, s[20:23], s54 offen offset:2048 lds
MAA 148,68,124
TR 96,25,26880
s_add_u32 s54, s54, 196608
MAA 148,48,120
TR 98,25,27392
TR 100,25,39296
MAA 152,52,120
TR 102,25,39808
MAA 152,72,124
buffer_load_dword v37, v34, s[40:43], 0 offen sc1
MAA 160,76,124
MAA 160,56,120
s_waitcnt vmcnt(16) lgkmcnt(8)
s_barrier
MAA 60,80,0
TR 104,25,24864
s_add_u32 m0, s56, 86400
MAA 60,84,20
buffer_load_dwordx4 v18, s[20:23], s54 offen lds
MAA 64,84,24
s_sub_u32 s47, s47, 1
s_cbranch_scc1 .Lx21
.Lx21b:
MAA 64,80,4
buffer_load_dwordx4 v19, s[20:23], s54 offen offset:1024 lds
MAA 68,80,8
TR 106,25,25376
MAA 68,84,28
TR 108,25,37280
TR 110,25,37792
TR 112,25,25888
MAA 72,84,32
TR 114,25,26400
MAA 72,80,12
TR 116,25,38304
TR 118,25,38816
s_waitcnt lgkmcnt(8)
MAA 104,88,12
TR 120,25,26912
MAA 104,92,32
buffer_load_dwordx4 v20, s[20:23], s54 offen offset:2048 lds
MAA 100,92,28
s_add_u32 s54, s54, 196608
s_add_u32 m0, s55, 18496
MAA 100,88,8
buffer_load_dwordx4 v21, s[36:39], s52 offen lds
MAA 96,88,4
TR 122,25,27424
MAA 96,92,24
buffer_load_dwordx4 v28, s[36:39], s52 offen offset:1024 lds
MAA 92,92,20
TR 124,25,39328
MAA 92,88,0
buffer_load_dword v22, s[36:39], s52 offen offset:2048 lds
MAA 124,0,96
s_add_u32 s52, s52, 128
s_add_u32 m0, s55, 20800
MAA 124,20,100
buffer_load_dwordx4 v21, s[36:39], s53 offen lds
MAA 128,24,100
TR 126,25,39840
MAA 128,4,96
buffer_load_dwordx4 v28, s[36:39], s53 offen offset:1024 lds
MAA 132,8,96
RD 40,23,55488
MAA 132,28,100
RD 44,23,57792
RD 48,23,60096
RD 52,23,62400
MAA 136,32,100
RD 56,24,55488
MAA 136,12,96
buffer_load_dword v29, s[36:39], s53 offen offset:2048 lds
MAA 156,16,96
s_add_u32 s53, s53, 128
MAA 156,36,100
s_waitcnt vmcnt(19) lgkmcnt(5)
s_barrier
MAA 76,104,0
RD 60,30,55488
s_add_u32 m0, s56, 98816
MAA 76,108,20
buffer_load_dwordx4 v18, s[20:23], s54 offen lds
MAA 80,108,24
RD 64,30,57792
MAA 80,104,4
buffer_load_dwordx4 v19, s[20:23], s54 offen offset:1024 lds
MAA 84,104,8
RD 68,30,60096
MAA 84,108,28
RD 72,30,62400
MAA 88,108,32
RD 76,31,55488
MAA 88,104,12
buffer_load_dwordx4 v20, s[20:23], s54 offen offset:2048 lds
MAA 244,104,16
s_add_u32 s54, s54, 196608
s_add_u32 m0, s55, 36992
MAA 244,108,36
buffer_load_dwordx4 v21, s[36:39], s52 offen lds
MAA 120,116,32
TR 80,25,49664
MAA 120,112,12
TR 82,25,50176
MAA 116,112,8
TR 84,25,62080
MAA 116,116,28
buffer_load_dwordx4 v28, s[36:39], s52 offen offset:1024 lds
MAA 112,116,24
TR 86,25,62592
MAA 112,112,4
buffer_load_dword v22, s[36:39], s52 offen offset:2048 lds
MAA 108,112,0
TR 88,25,50688
s_add_u32 s52, s52, 128
MAA 108,116,20
TR 90,25,51200
MAA 140,20,124
TR 92,25,63104
s_add_u32 m0, s55, 39296
MAA 140,0,120
buffer_load_dwordx4 v21, s[36:39], s53 offen lds
MAA 144,4,120
TR 94,25,63616
MAA 144,24,124
buffer_load_dwordx4 v28, s[36:39], s53 offen offset:1024 lds
MAA 148,28,124
TR 96,25,51712
MAA 148,8,120
TR 98,25,52224
MAA 152,12,120
TR 100,25,64128
MAA 152,32,124
buffer_load_dword v29, s[36:39], s53 offen offset:2048 lds
MAA 160,36,124
TR 102,25,64640
s_add_u32 s53, s53, 128
MAA 160,16,120
s_waitcnt vmcnt(22) lgkmcnt(8)
s_barrier
MAA 60,80,40
TR 104,25,49696
MAA 60,84,60
TR 106,25,50208
MAA 64,84,64
TR 108,25,62112
s_add_u32 m0, s56, 111232
MAA 64,80,44
buffer_load_dwordx4 v18, s[20:23], s54 offen lds
MAA 68,80,48
s_sub_u32 s47, s47, 1
s_cbranch_scc1 .Lx22
.Lx22b:
MAA 68,84,68
TR 110,25,62624
MAA 72,84,72
TR 112,25,50720
MAA 72,80,52
TR 114,25,51232
s_waitcnt lgkmcnt(6)
MAA 104,88,52
TR 116,25,63136
MAA 104,92,72
buffer_load_dwordx4 v19, s[20:23], s54 offen offset:1024 lds
MAA 100,92,68
TR 118,25,63648
MAA 100,88,48
buffer_load_dwordx4 v20, s[20:23], s54 offen offset:2048 lds
MAA 96,88,44
TR 120,25,51744
s_add_u32 s54, s54, 196608
MAA 96,92,64
TR 122,25,52256
MAA 92,92,60
TR 124,25,64160
s_add_u32 m0, s55, 55488
MAA 92,88,40
buffer_load_dwordx4 v21, s[36:39], s52 offen lds
MAA 124,40,96
TR 126,25,64672
MAA 124,60,100
ds_read_b128 a[0:3], v23
MAA 128,64,100
RD 4,23,2304
MAA 128,44,96
buffer_load_dwordx4 v28, s[36:39], s52 offen offset:1024 lds
MAA 132,48,96
RD 8,23,4608
MAA 132,68,100
RD 12,23,6912
MAA 136,72,100
ds_read_b128 a[16:19], v24
MAA 136,52,96
buffer_load_dword v22, s[36:39], s52 offen offset:2048 lds
MAA 156,56,96
s_add_u32 s52, s52, 128
MAA 156,76,100
s_waitcnt vmcnt(21) lgkmcnt(5)
s_barrier
v_cmp_gt_u32 vcc, v35, v37
s_nop 0
s_cbranch_vccnz .Lsp23
.Lsp23b:
v_mov_b32 v37, 0
MAA 76,104,40
ds_read_b128 a[20:23], v30
MAA 76,108,60
buffer_atomic_add v38, v32, s[16:19], 0 offen
MAA 80,108,64
RD 24,30,2304
MAA 80,104,44
RD 28,30,4608
MAA 84,104,48
RD 32,30,6912
s_add_u32 m0, s56, 123648
MAA 84,108,68
buffer_load_dwordx4 v18, s[20:23], s54 offen lds
MAA 88,108,72
ds_read_b128 a[36:39], v31
MAA 88,104,52
ds_read_b64_tr_b16 a[80:81], v25
MAA 244,104,56
TR 82,25,512
MAA 244,108,76
buffer_load_dwordx4 v19, s[20:23], s54 offen offset:1024 lds
MAA 120,116,72
TR 84,25,12416
MAA 120,112,52
TR 86,25,12928
MAA 116,112,48
MAA 116,116,68
buffer_load_dwordx4 v20, s[20:23], s54 offen offset:2048 lds
MAA 112,116,64
s_add_u32 s54, s54, 196608
s_add_u32 m0, s55, 57792
MAA 112,112,44
buffer_load_dwordx4 v21, s[36:39], s53 offen lds
MAA 108,112,40
TR 88,25,1024
MAA 108,116,60
TR 90,25,1536
MAA 140,60,124
TR 92,25,13440
MAA 140,40,120
buffer_load_dwordx4 v28, s[36:39], s53 offen offset:1024 lds
MAA 144,44,120
TR 94,25,13952
MAA 144,64,124
TR 96,25,2048
MAA 148,68,124
TR 98,25,2560
MAA 148,48,120
buffer_load_dword v29, s[36:39], s53 offen offset:2048 lds
MAA 152,52,120
TR 100,25,14464
s_add_u32 s53, s53, 128
MAA 152,72,124
TR 102,25,14976
MAA 160,76,124
MAA 160,56,120
s_waitcnt vmcnt(22) lgkmcnt(8)
s_barrier
MAA 60,80,0
TR 104,25,32
MAA 60,84,20
TR 106,25,544
MAA 64,84,24
TR 108,25,12448
s_add_u32 m0, s56, 136064
MAA 64,80,4
buffer_load_dwordx4 v18, s[20:23], s54 offen lds
MAA 68,80,8
s_sub_u32 s47, s47, 1
s_cbranch_scc1 .Lx24
.Lx24b:
MAA 68,84,28
TR 110,25,12960
MAA 72,84,32
TR 112,25,1056
MAA 72,80,12
TR 114,25,1568
s_waitcnt lgkmcnt(6)
MAA 104,88,12
TR 116,25,13472
MAA 104,92,32
buffer_load_dwordx4 v19, s[20:23], s54 offen offset:1024 lds
MAA 100,92,28
TR 118,25,13984
MAA 100,88,8
buffer_load_dwordx4 v20, s[20:23], s54 offen offset:2048 lds
MAA 96,88,4
TR 120,25,2080
s_add_u32 s54, s54, 196608
MAA 96,92,24
TR 122,25,2592
MAA 92,92,20
TR 124,25,14496
s_add_u32 m0, s55, 0
MAA 92,88,0
buffer_load_dwordx4 v21, s[36:39], s52 offen lds
MAA 124,0,96
TR 126,25,15008
MAA 124,20,100
RD 40,23,18496
MAA 128,24,100
RD 44,23,20800
MAA 128,4,96
buffer_load_dwordx4 v28, s[36:39], s52 offen offset:1024 lds
MAA 132,8,96
RD 48,23,23104
MAA 132,28,100
RD 52,23,25408
MAA 136,32,100
RD 56,24,18496
MAA 136,12,96
buffer_load_dword v22, s[36:39], s52 offen offset:2048 lds
MAA 156,16,96
s_add_u32 s52, s52, 128
MAA 156,36,100
s_waitcnt vmcnt(16) lgkmcnt(5)
s_barrier
MAA 76,104,0
RD 60,30,18496
MAA 76,108,20
RD 64,30,20800
MAA 80,108,24
RD 68,30,23104
s_add_u32 m0, s56, 73984
MAA 80,104,4
buffer_load_dwordx4 v18, s[20:23], s54 offen lds
MAA 84,104,8
RD 72,30,25408
MAA 84,108,28
RD 76,31,18496
MAA 88,108,32
MAA 88,104,12
buffer_load_dwordx4 v19, s[20:23], s54 offen offset:1024 lds
MAA 244,104,16
TR 80,25,24832
MAA 244,108,36
TR 82,25,25344
MAA 120,116,32
TR 84,25,37248
MAA 120,112,12
buffer_load_dwordx4 v20, s[20:23], s54 offen offset:2048 lds
MAA 116,112,8
TR 86,25,37760
s_add_u32 s54, s54, 196608
MAA 116,116,28
MAA 112,116,24
TR 88,25,25856
MAA 112,112,4
TR 90,25,26368
MAA 108,112,0
TR 92,25,38272
s_add_u32 m0, s55, 2304
MAA 108,116,20
buffer_load_dwordx4 v21, s[36:39], s53 offen lds
MAA 140,20,124
TR 94,25,38784
MAA 140,0,120
MAA 144,4,120
TR 96,25,26880
MAA 144,24,124
buffer_load_dwordx4 v28, s[36:39], s53 offen offset:1024 lds
MAA 148,28,124
TR 98,25,27392
MAA 148,8,120
TR 100,25,39296
MAA 152,12,120
TR 102,25,39808
MAA 152,32,124
buffer_load_dword v29, s[36:39], s53 offen offset:2048 lds
MAA 160,36,124
s_add_u32 s53, s53, 128
MAA 160,16,120
s_waitcnt lgkmcnt(8)
s_barrier
MAA 60,80,40
TR 104,25,24864
MAA 60,84,60
TR 106,25,25376
MAA 64,84,64
TR 108,25,37280
s_add_u32 m0, s56, 86400
MAA 64,80,44
buffer_load_dwordx4 v18, s[20:23], s54 offen lds
MAA 68,80,48
s_sub_u32 s47, s47, 1
s_cbranch_scc1 .Lx25
.Lx25b:
MAA 68,84,68
TR 110,25,37792
MAA 72,84,72
TR 112,25,25888
MAA 72,80,52
TR 114,25,26400
s_waitcnt lgkmcnt(6)
MAA 104,88,52
TR 116,25,38304
MAA 104,92,72
buffer_load_dwordx4 v19, s[20:23], s54 offen offset:1024 lds
MAA 100,92,68
TR 118,25,38816
MAA 100,88,48
buffer_load_dwordx4 v20, s[20:23], s54 offen offset:2048 lds
MAA 96,88,44
TR 120,25,26912
s_add_u32 s54, s54, 196608
MAA 96,92,64
TR 122,25,27424
MAA 92,92,60
TR 124,25,39328
s_add_u32 m0, s55, 18496
MAA 92,88,40
buffer_load_dwordx4 v21, s[36:39], s52 offen lds
MAA 124,40,96
TR 126,25,39840
MAA 124,60,100
RD 0,23,36992
MAA 128,64,100
RD 4,23,39296
MAA 128,44,96
buffer_load_dwordx4 v28, s[36:39], s52 offen offset:1024 lds
MAA 132,48,96
RD 8,23,41600
MAA 132,68,100
RD 12,23,43904
MAA 136,72,100
RD 16,24,36992
MAA 136,52,96
buffer_load_dword v22, s[36:39], s52 offen offset:2048 lds
MAA 156,56,96
s_add_u32 s52, s52, 128
MAA 156,76,100
s_waitcnt vmcnt(15) lgkmcnt(5)
s_barrier
MAA 76,104,40
RD 20,30,36992
s_add_u32 m0, s56, 98816
MAA 76,108,60
buffer_load_dwordx4 v18, s[20:23], s54 offen lds
MAA 80,108,64
RD 24,30,39296
MAA 80,104,44
RD 28,30,41600
MAA 84,104,48
RD 32,30,43904
MAA 84,108,68
buffer_load_dwordx4 v19, s[20:23], s54 offen offset:1024 lds
MAA 88,108,72
RD 36,31,36992
MAA 88,104,52
TR 80,25,49664
MAA 244,104,56
MAA 244,108,76
buffer_load_dwordx4 v20, s[20:23], s54 offen offset:2048 lds
MAA 120,116,72
TR 82,25,50176
s_add_u32 s54, s54, 196608
MAA 120,112,52
TR 84,25,62080
MAA 116,112,48
TR 86,25,62592
s_add_u32 m0, s55, 20800
MAA 116,116,68
buffer_load_dwordx4 v21, s[36:39], s53 offen lds
MAA 112,116,64
TR 88,25,50688
MAA 112,112,44
buffer_load_dwordx4 v28, s[36:39], s53 offen offset:1024 lds
MAA 108,112,40
TR 90,25,51200
MAA 108,116,60
TR 92,25,63104
MAA 140,60,124
MAA 140,40,120
buffer_load_dword v29, s[36:39], s53 offen offset:2048 lds
MAA 144,44,120
TR 94,25,63616
s_add_u32 s53, s53, 128
MAA 144,64,124
TR 96,25,51712
MAA 148,68,124
TR 98,25,52224
MAA 148,48,120
buffer_atomic_add v37, v33, s[16:19], 0 offen sc0
MAA 152,52,120
TR 100,25,64128
MAA 152,72,124
TR 102,25,64640
MAA 160,76,124
MAA 160,56,120
s_waitcnt lgkmcnt(8)
s_barrier
MAA 60,80,0
TR 104,25,49696
MAA 60,84,20
TR 106,25,50208
MAA 64,84,24
TR 108,25,62112
s_add_u32 m0, s56, 111232
MAA 64,80,4
buffer_load_dwordx4 v18, s[20:23], s54 offen lds
MAA 68,80,8
s_sub_u32 s47, s47, 1
s_cbranch_scc1 .Lx26
.Lx26b:
MAA 68,84,28
TR 110,25,62624
MAA 72,84,32
TR 112,25,50720
MAA 72,80,12
TR 114,25,51232
s_waitcnt lgkmcnt(6)
MAA 104,88,12
TR 116,25,63136
MAA 104,92,32
buffer_load_dwordx4 v19, s[20:23], s54 offen offset:1024 lds
MAA 100,92,28
TR 118,25,63648
MAA 100,88,8
buffer_load_dwordx4 v20, s[20:23], s54 offen offset:2048 lds
MAA 96,88,4
TR 120,25,51744
s_add_u32 s54, s54, 196608
MAA 96,92,24
TR 122,25,52256
MAA 92,92,20
TR 124,25,64160
s_add_u32 m0, s55, 36992
MAA 92,88,0
buffer_load_dwordx4 v21, s[36:39], s52 offen lds
MAA 124,0,96
TR 126,25,64672
MAA 124,20,100
RD 40,23,55488
MAA 128,24,100
RD 44,23,57792
MAA 128,4,96
buffer_load_dwordx4 v28, s[36:39], s52 offen offset:1024 lds
MAA 132,8,96
RD 48,23,60096
MAA 132,28,100
RD 52,23,62400
MAA 136,32,100
RD 56,24,55488
MAA 136,12,96
buffer_load_dword v22, s[36:39], s52 offen offset:2048 lds
MAA 156,16,96
s_add_u32 s52, s52, 128
MAA 156,36,100
s_waitcnt vmcnt(16) lgkmcnt(5)
s_barrier
MAA 76,104,0
RD 60,30,55488
MAA 76,108,20
RD 64,30,57792
MAA 80,108,24
RD 68,30,60096
s_add_u32 m0, s56, 123648
MAA 80,104,4
buffer_load_dwordx4 v18, s[20:23], s54 offen lds
MAA 84,104,8
RD 72,30,62400
MAA 84,108,28
RD 76,31,55488
MAA 88,108,32
MAA 88,104,12
buffer_load_dwordx4 v19, s[20:23], s54 offen offset:1024 lds
MAA 244,104,16
ds_read_b64_tr_b16 a[80:81], v25
MAA 244,108,36
TR 82,25,512
MAA 120,116,32
TR 84,25,12416
MAA 120,112,12
buffer_load_dwordx4 v20, s[20:23], s54 offen offset:2048 lds
MAA 116,112,8
TR 86,25,12928
s_add_u32 s54, s54, 196608
MAA 116,116,28
MAA 112,116,24
TR 88,25,1024
MAA 112,112,4
TR 90,25,1536
MAA 108,112,0
TR 92,25,13440
s_add_u32 m0, s55, 39296
MAA 108,116,20
buffer_load_dwordx4 v21, s[36:39], s53 offen lds
MAA 140,20,124
TR 94,25,13952
MAA 140,0,120
MAA 144,4,120
TR 96,25,2048
MAA 144,24,124
buffer_load_dwordx4 v28, s[36:39], s53 offen offset:1024 lds
MAA 148,28,124
TR 98,25,2560
MAA 148,8,120
TR 100,25,14464
MAA 152,12,120
TR 102,25,14976
MAA 152,32,124
buffer_load_dword v29, s[36:39], s53 offen offset:2048 lds
MAA 160,36,124
s_add_u32 s53, s53, 128
MAA 160,16,120
s_waitcnt lgkmcnt(8)
s_barrier
MAA 60,80,40
TR 104,25,32
MAA 60,84,60
TR 106,25,544
MAA 64,84,64
TR 108,25,12448
s_add_u32 m0, s56, 136064
MAA 64,80,44
buffer_load_dwordx4 v18, s[20:23], s54 offen lds
MAA 68,80,48
s_sub_u32 s47, s47, 1
s_cbranch_scc1 .Lx27
.Lx27b:
MAA 68,84,68
TR 110,25,12960
MAA 72,84,72
TR 112,25,1056
MAA 72,80,52
TR 114,25,1568
s_waitcnt lgkmcnt(6)
MAA 104,88,52
TR 116,25,13472
MAA 104,92,72
buffer_load_dwordx4 v19, s[20:23], s54 offen offset:1024 lds
MAA 100,92,68
TR 118,25,13984
MAA 100,88,48
buffer_load_dwordx4 v20, s[20:23], s54 offen offset:2048 lds
MAA 96,88,44
TR 120,25,2080
s_add_u32 s54, s54, 196608
MAA 96,92,64
TR 122,25,2592
MAA 92,92,60
TR 124,25,14496
s_add_u32 m0, s55, 55488
MAA 92,88,40
buffer_load_dwordx4 v21, s[36:39], s52 offen lds
MAA 124,40,96
TR 126,25,15008
MAA 124,60,100
ds_read_b128 a[0:3], v23
MAA 128,64,100
RD 4,23,2304
MAA 128,44,96
buffer_load_dwordx4 v28, s[36:39], s52 offen offset:1024 lds
MAA 132,48,96
RD 8,23,4608
MAA 132,68,100
RD 12,23,6912
MAA 136,72,100
ds_read_b128 a[16:19], v24
MAA 136,52,96
buffer_load_dword v22, s[36:39], s52 offen offset:2048 lds
MAA 156,56,96
s_add_u32 s52, s52, 128
MAA 156,76,100
s_waitcnt vmcnt(18)
v_cmp_gt_u32 vcc, v36, v37
s_nop 0
s_cbranch_vccnz .Lsp28
.Lsp28b:
s_waitcnt vmcnt(15) lgkmcnt(5)
s_barrier
MAA 76,104,40
ds_read_b128 a[20:23], v30
s_add_u32 m0, s56, 73984
MAA 76,108,60
buffer_load_dwordx4 v18, s[20:23], s54 offen lds
MAA 80,108,64
RD 24,30,2304
MAA 80,104,44
RD 28,30,4608
MAA 84,104,48
RD 32,30,6912
MAA 84,108,68
buffer_load_dwordx4 v19, s[20:23], s54 offen offset:1024 lds
MAA 88,108,72
ds_read_b128 a[36:39], v31
MAA 88,104,52
TR 80,25,24832
MAA 244,104,56
MAA 244,108,76
buffer_load_dwordx4 v20, s[20:23], s54 offen offset:2048 lds
MAA 120,116,72
TR 82,25,25344
s_add_u32 s54, s54, 196608
MAA 120,112,52
TR 84,25,37248
MAA 116,112,48
TR 86,25,37760
s_add_u32 m0, s55, 57792
MAA 116,116,68
buffer_load_dwordx4 v21, s[36:39], s53 offen lds
MAA 112,116,64
TR 88,25,25856
MAA 112,112,44
buffer_load_dwordx4 v28, s[36:39], s53 offen offset:1024 lds
MAA 108,112,40
TR 90,25,26368
MAA 108,116,60
TR 92,25,38272
MAA 140,60,124
MAA 140,40,120
buffer_load_dword v29, s[36:39], s53 offen offset:2048 lds
MAA 144,44,120
TR 94,25,38784
s_add_u32 s53, s53, 128
MAA 144,64,124
TR 96,25,26880
MAA 148,68,124
TR 98,25,27392
MAA 148,48,120
buffer_load_dwordx4 v[164:167], v26, s[16:19], s75 offen sc1
MAA 152,52,120
TR 100,25,39296
MAA 152,72,124
TR 102,25,39808
MAA 160,76,124
MAA 160,56,120
s_waitcnt lgkmcnt(8)
s_barrier
MAA 60,80,0
TR 104,25,24864
s_add_u32 m0, s56, 86400
MAA 60,84,20
buffer_load_dwordx4 v18, s[20:23], s54 offen lds
MAA 64,84,24
s_sub_u32 s47, s47, 1
s_cbranch_scc1 .Lx29
.Lx29b:
MAA 64,80,4
TR 106,25,25376
TR 108,25,37280
MAA 68,80,8
TR 110,25,37792
MAA 68,84,28
buffer_load_dwordx4 v19, s[20:23], s54 offen offset:1024 lds
MAA 72,84,32
TR 112,25,25888
MAA 72,80,12
TR 114,25,26400
s_waitcnt lgkmcnt(6)
MAA 104,88,12
MAA 104,92,32
buffer_load_dwordx4 v20, s[20:23], s54 offen offset:2048 lds
MAA 100,92,28
s_add_u32 s54, s54, 196608
s_add_u32 m0, s55, 0
MAA 100,88,8
buffer_load_dwordx4 v21, s[36:39], s52 offen lds
MAA 96,88,4
TR 116,25,38304
MAA 96,92,24
TR 118,25,38816
TR 120,25,26912
MAA 92,92,20
TR 122,25,27424
MAA 92,88,0
buffer_load_dwordx4 v28, s[36:39], s52 offen offset:1024 lds
MAA 124,0,96
TR 124,25,39328
MAA 124,20,100
TR 126,25,39840
MAA 128,24,100
RD 40,23,18496
MAA 128,4,96
buffer_load_dword v22, s[36:39], s52 offen offset:2048 lds
MAA 132,8,96
RD 44,23,20800
s_add_u32 s52, s52, 128
MAA 132,28,100
buffer_load_dwordx4 v[168:171], v26, s[16:19], s75 offen offset:1024 sc1
MAA 136,32,100
RD 48,23,23104
MAA 136,12,96
RD 52,23,25408
RD 56,24,18496
MAA 156,16,96
MAA 156,36,100
s_waitcnt vmcnt(17) lgkmcnt(5)
s_barrier
MAA 76,104,0
RD 60,30,18496
s_add_u32 m0, s56, 98816
MAA 76,108,20
buffer_load_dwordx4 v18, s[20:23], s54 offen lds
MAA 80,108,24
RD 64,30,20800
MAA 80,104,4
RD 68,30,23104
MAA 84,104,8
RD 72,30,25408
MAA 84,108,28
buffer_load_dwordx4 v19, s[20:23], s54 offen offset:1024 lds
MAA 88,108,32
RD 76,31,18496
MAA 88,104,12
TR 80,25,49664
MAA 244,104,16
MAA 244,108,36
buffer_load_dwordx4 v20, s[20:23], s54 offen offset:2048 lds
MAA 120,116,32
TR 82,25,50176
s_add_u32 s54, s54, 196608
MAA 120,112,12
TR 84,25,62080
MAA 116,112,8
TR 86,25,62592
s_add_u32 m0, s55, 2304
MAA 116,116,28
buffer_load_dwordx4 v21, s[36:39], s53 offen lds
MAA 112,116,24
TR 88,25,50688
MAA 112,112,4
buffer_load_dwordx4 v28, s[36:39], s53 offen offset:1024 lds
MAA 108,112,0
TR 90,25,51200
MAA 108,116,20
TR 92,25,63104
MAA 140,20,124
MAA 140,0,120
buffer_load_dword v29, s[36:39], s53 offen offset:2048 lds
MAA 144,4,120
TR 94,25,63616
s_add_u32 s53, s53, 128
MAA 144,24,124
TR 96,25,51712
MAA 148,28,124
TR 98,25,52224
MAA 148,8,120
buffer_load_dwordx4 v[172:175], v26, s[16:19], s75 offen offset:2048 sc1
MAA 152,12,120
TR 100,25,64128
MAA 152,32,124
TR 102,25,64640
MAA 160,36,124
MAA 160,16,120
s_waitcnt lgkmcnt(8)
s_barrier
MAA 60,80,40
TR 104,25,49696
s_add_u32 m0, s56, 111232
MAA 60,84,60
buffer_load_dwordx4 v18, s[20:23], s54 offen lds
MAA 64,84,64
s_sub_u32 s47, s47, 1
s_cbranch_scc1 .Lx30
.Lx30b:
MAA 64,80,44
TR 106,25,50208
TR 108,25,62112
MAA 68,80,48
TR 110,25,62624
MAA 68,84,68
buffer_load_dwordx4 v19, s[20:23], s54 offen offset:1024 lds
MAA 72,84,72
TR 112,25,50720
MAA 72,80,52
TR 114,25,51232
s_waitcnt lgkmcnt(6)
MAA 104,88,52
MAA 104,92,72
buffer_load_dwordx4 v20, s[20:23], s54 offen offset:2048 lds
MAA 100,92,68
s_add_u32 s54, s54, 196608
s_add_u32 m0, s55, 18496
MAA 100,88,48
buffer_load_dwordx4 v21, s[36:39], s52 offen lds
MAA 96,88,44
TR 116,25,63136
MAA 96,92,64
TR 118,25,63648
TR 120,25,51744
MAA 92,92,60
TR 122,25,52256
MAA 92,88,40
buffer_load_dwordx4 v28, s[36:39], s52 offen offset:1024 lds
MAA 124,40,96
TR 124,25,64160
MAA 124,60,100
TR 126,25,64672
MAA 128,64,100
RD 0,23,36992
MAA 128,44,96
buffer_load_dword v22, s[36:39], s52 offen offset:2048 lds
MAA 132,48,96
RD 4,23,39296
s_add_u32 s52, s52, 128
MAA 132,68,100
buffer_load_dwordx4 v[176:179], v26, s[16:19], s75 offen offset:3072 sc1
MAA 136,72,100
RD 8,23,41600
s_add_u32 s75, s75, 4096
MAA 136,52,96
RD 12,23,43904
RD 16,24,36992
MAA 156,56,96
MAA 156,76,100
s_waitcnt vmcnt(18) lgkmcnt(5)
s_barrier
MAA 76,104,40
RD 20,30,36992
s_add_u32 m0, s56, 123648
MAA 76,108,60
buffer_load_dwordx4 v18, s[20:23], s54 offen lds
MAA 80,108,64
RD 24,30,39296
s_waitcnt vmcnt(15)
v_add_f32 v164, v164, v168
MAA 80,104,44
RD 28,30,41600
MAA 84,104,48
RD 32,30,43904
MAA 84,108,68
buffer_load_dwordx4 v19, s[20:23], s54 offen offset:1024 lds
MAA 88,108,72
RD 36,31,36992
MAA 88,104,52
ds_read_b64_tr_b16 a[80:81], v25
v_add_f32 v165, v165, v169
MAA 244,104,56
MAA 244,108,76
buffer_load_dwordx4 v20, s[20:23], s54 offen offset:2048 lds
MAA 120,116,72
TR 82,25,512
s_add_u32 s54, s54, 196608
MAA 120,112,52
TR 84,25,12416
MAA 116,112,48
TR 86,25,12928
s_add_u32 m0, s55, 20800
MAA 116,116,68
buffer_load_dwordx4 v21, s[36:39], s53 offen lds
MAA 112,116,64
TR 88,25,1024
MAA 112,112,44
buffer_load_dwordx4 v28, s[36:39], s53 offen offset:1024 lds
MAA 108,112,40
TR 90,25,1536
v_add_f32 v166, v166, v170
MAA 108,116,60
TR 92,25,13440
MAA 140,60,124
MAA 140,40,120
buffer_load_dword v29, s[36:39], s53 offen offset:2048 lds
MAA 144,44,120
TR 94,25,13952
s_add_u32 s53, s53, 128
MAA 144,64,124
TR 96,25,2048
MAA 148,68,124
TR 98,25,2560
v_add_f32 v167, v167, v171
MAA 148,48,120
buffer_load_dwordx4 v[180:183], v26, s[16:19], s75 offen sc1
MAA 152,52,120
TR 100,25,14464
MAA 152,72,124
TR 102,25,14976
MAA 160,76,124
MAA 160,56,120
s_waitcnt lgkmcnt(8)
s_barrier
MAA 60,80,0
TR 104,25,32
s_add_u32 m0, s56, 136064
MAA 60,84,20
buffer_load_dwordx4 v18, s[20:23], s54 offen lds
MAA 64,84,24
s_sub_u32 s47, s47, 1
s_cbranch_scc1 .Lx31
.Lx31b:
MAA 64,80,4
TR 106,25,544
TR 108,25,12448
MAA 68,80,8
TR 110,25,12960
s_waitcnt vmcnt(15)
v_add_f32 v164, v164, v172
MAA 68,84,28
buffer_load_dwordx4 v19, s[20:23], s54 offen offset:1024 lds
MAA 72,84,32
TR 112,25,1056
MAA 72,80,12
TR 114,25,1568
s_waitcnt lgkmcnt(6)
MAA 104,88,12
v_add_f32 v165, v165, v173
MAA 104,92,32
buffer_load_dwordx4 v20, s[20:23], s54 offen offset:2048 lds
MAA 100,92,28
s_add_u32 s54, s54, 196608
s_add_u32 m0, s55, 36992
MAA 100,88,8
buffer_load_dwordx4 v21, s[36:39], s52 offen lds
MAA 96,88,4
TR 116,25,13472
MAA 96,92,24
TR 118,25,13984
TR 120,25,2080
MAA 92,92,20
TR 122,25,2592
v_add_f32 v166, v166, v174
MAA 92,88,0
buffer_load_dwordx4 v28, s[36:39], s52 offen offset:1024 lds
MAA 124,0,96
TR 124,25,14496
MAA 124,20,100
TR 126,25,15008
MAA 128,24,100
RD 40,23,55488
v_add_f32 v167, v167, v175
MAA 128,4,96
buffer_load_dword v22, s[36:39], s52 offen offset:2048 lds
MAA 132,8,96
RD 44,23,57792
s_add_u32 s52, s52, 128
MAA 132,28,100
buffer_load_dwordx4 v[184:187], v26, s[16:19], s75 offen offset:1024 sc1
MAA 136,32,100
RD 48,23,60096
MAA 136,12,96
RD 52,23,62400
RD 56,24,55488
MAA 156,16,96
MAA 156,36,100
s_waitcnt vmcnt(18) lgkmcnt(5)
s_barrier
MAA 76,104,0
RD 60,30,55488
s_waitcnt vmcnt(14)
v_add_f32 v164, v164, v176
MAA 76,108,20
RD 64,30,57792
s_add_u32 m0, s56, 73984
MAA 80,108,24
buffer_load_dwordx4 v18, s[20:23], s54 offen lds
MAA 80,104,4
RD 68,30,60096
v_add_f32 v165, v165, v177
MAA 84,104,8
RD 72,30,62400
v_add_f32 v166, v166, v178
MAA 84,108,28
buffer_load_dwordx4 v19, s[20:23], s54 offen offset:1024 lds
MAA 88,108,32
RD 76,31,55488
v_add_f32 v167, v167, v179
MAA 88,104,12
TR 80,25,24832
MAA 244,104,16
buffer_load_dwordx4 v20, s[20:23], s54 offen offset:2048 lds
MAA 244,108,36
TR 82,25,25344
s_add_u32 s54, s54, 196608
MAA 120,116,32
TR 84,25,37248
s_add_u32 m0, s55, 39296
MAA 120,112,12
buffer_load_dwordx4 v21, s[36:39], s53 offen lds
MAA 116,112,8
TR 86,25,37760
MAA 116,116,28
TR 88,25,25856
MAA 112,116,24
buffer_load_dwordx4 v28, s[36:39], s53 offen offset:1024 lds
MAA 112,112,4
TR 90,25,26368
MAA 108,112,0
TR 92,25,38272
MAA 108,116,20
buffer_load_dword v29, s[36:39], s53 offen offset:2048 lds
MAA 140,20,124
TR 94,25,38784
s_add_u32 s53, s53, 128
MAA 140,0,120
TR 96,25,26880
MAA 144,4,120
buffer_load_dwordx4 v[188:191], v26, s[16:19], s75 offen offset:2048 sc1
MAA 144,24,124
TR 98,25,27392
MAA 148,28,124
TR 100,25,39296
MAA 148,8,120
TR 102,25,39808
MAA 152,12,120
MAA 152,32,124
MAA 160,36,124
MAA 160,16,120
s_waitcnt lgkmcnt(8)
s_barrier
MAA 60,80,40
TR 104,25,24864
s_add_u32 m0, s56, 86400
MAA 60,84,60
buffer_load_dwordx4 v18, s[20:23], s54 offen lds
MAA 64,84,64
s_sub_u32 s47, s47, 1
s_cbranch_scc1 .Lx32
.Lx32b:
MAA 64,80,44
TR 106,25,25376
TR 108,25,37280
MAA 68,80,48
TR 110,25,37792
s_waitcnt vmcnt(15)
v_add_f32 v164, v164, v180
MAA 68,84,68
buffer_load_dwordx4 v19, s[20:23], s54 offen offset:1024 lds
MAA 72,84,72
TR 112,25,25888
MAA 72,80,52
TR 114,25,26400
s_waitcnt lgkmcnt(6)
MAA 104,88,52
v_add_f32 v165, v165, v181
MAA 104,92,72
buffer_load_dwordx4 v20, s[20:23], s54 offen offset:2048 lds
MAA 100,92,68
s_add_u32 s54, s54, 196608
s_add_u32 m0, s55, 55488
MAA 100,88,48
buffer_load_dwordx4 v21, s[36:39], s52 offen lds
MAA 96,88,44
TR 116,25,38304
MAA 96,92,64
TR 118,25,38816
TR 120,25,26912
MAA 92,92,60
TR 122,25,27424
v_add_f32 v166, v166, v182
MAA 92,88,40
buffer_load_dwordx4 v28, s[36:39], s52 offen offset:1024 lds
MAA 124,40,96
TR 124,25,39328
MAA 124,60,100
TR 126,25,39840
MAA 128,64,100
ds_read_b128 a[0:3], v23
v_add_f32 v167, v167, v183
MAA 128,44,96
buffer_load_dword v22, s[36:39], s52 offen offset:2048 lds
MAA 132,48,96
RD 4,23,2304
s_add_u32 s52, s52, 128
MAA 132,68,100
buffer_load_dwordx4 v[192:195], v26, s[16:19], s75 offen offset:3072 sc1
MAA 136,72,100
RD 8,23,4608
MAA 136,52,96
RD 12,23,6912
ds_read_b128 a[16:19], v24
MAA 156,56,96
MAA 156,76,100
s_waitcnt vmcnt(18) lgkmcnt(5)
s_barrier
MAA 76,104,40
ds_read_b128 a[20:23], v30
s_waitcnt vmcnt(14)
v_add_f32 v164, v164, v184
MAA 76,108,60
RD 24,30,2304
s_add_u32 m0, s56, 98816
MAA 80,108,64
buffer_load_dwordx4 v18, s[20:23], s54 offen lds
MAA 80,104,44
RD 28,30,4608
v_add_f32 v165, v165, v185
MAA 84,104,48
RD 32,30,6912
v_add_f32 v166, v166, v186
MAA 84,108,68
ds_read_b128 a[36:39], v31
v_add_f32 v167, v167, v187
MAA 88,108,72
buffer_load_dwordx4 v19, s[20:23], s54 offen offset:1024 lds
MAA 88,104,52
TR 80,25,49664
MAA 244,104,56
TR 82,25,50176
MAA 244,108,76
TR 84,25,62080
MAA 120,116,72
buffer_load_dwordx4 v20, s[20:23], s54 offen offset:2048 lds
MAA 120,112,52
TR 86,25,62592
s_add_u32 s54, s54, 196608
MAA 116,112,48
TR 88,25,50688
s_add_u32 m0, s55, 57792
MAA 116,116,68
TR 90,25,51200
MAA 112,116,64
buffer_load_dwordx4 v21, s[36:39], s53 offen lds
MAA 112,112,44
TR 92,25,63104
MAA 108,112,40
TR 94,25,63616
MAA 108,116,60
TR 96,25,51712
MAA 140,60,124
buffer_load_dwordx4 v28, s[36:39], s53 offen offset:1024 lds
MAA 140,40,120
TR 98,25,52224
MAA 144,44,120
TR 100,25,64128
MAA 144,64,124
TR 102,25,64640
MAA 148,68,124
buffer_load_dword v29, s[36:39], s53 offen offset:2048 lds
MAA 148,48,120
s_add_u32 s53, s53, 128
MAA 152,52,120
MAA 152,72,124
MAA 160,76,124
MAA 160,56,120
s_waitcnt lgkmcnt(8)
s_barrier
MAA 60,80,0
TR 104,25,49696
s_waitcnt vmcnt(13)
v_add_f32 v164, v164, v188
MAA 60,84,20
TR 106,25,50208
s_add_u32 m0, s56, 111232
MAA 64,84,24
buffer_load_dwordx4 v18, s[20:23], s54 offen lds
MAA 64,80,4
TR 108,25,62112
v_add_f32 v165, v165, v189
MAA 68,80,8
TR 110,25,62624
v_add_f32 v166, v166, v190
MAA 68,84,28
buffer_load_dwordx4 v19, s[20:23], s54 offen offset:1024 lds
MAA 72,84,32
TR 112,25,50720
v_add_f32 v167, v167, v191
MAA 72,80,12
TR 114,25,51232
s_waitcnt lgkmcnt(6)
MAA 104,88,12
buffer_load_dwordx4 v20, s[20:23], s54 offen offset:2048 lds
MAA 104,92,32
TR 116,25,63136
s_add_u32 s54, s54, 196608
MAA 100,92,28
TR 118,25,63648
s_add_u32 m0, s59, 0
MAA 100,88,8
TR 120,25,51744
s_xor_b32 s58, s87, 1048576
MAA 96,88,4
buffer_load_dwordx4 v5, s[24:27], s58 offen lds
MAA 96,92,24
TR 122,25,52256
MAA 92,92,20
TR 124,25,64160
MAA 92,88,0
buffer_load_dwordx4 v6, s[24:27], s58 offen offset:1024 lds
MAA 124,0,96
TR 126,25,64672
s_add_u32 m0, s59, 8320
MAA 124,20,100
RD 40,23,18496
s_xor_b32 s58, s87, 1179648
MAA 128,24,100
buffer_load_dwordx4 v5, s[24:27], s58 offen lds
MAA 128,4,96
RD 44,23,20800
MAA 132,8,96
RD 48,23,23104
MAA 132,28,100
buffer_load_dwordx4 v6, s[24:27], s58 offen offset:1024 lds
MAA 136,32,100
RD 52,23,25408
MAA 136,12,96
RD 56,24,18496
MAA 156,16,96
MAA 156,36,100
s_waitcnt vmcnt(17) lgkmcnt(5)
s_barrier
MAA 76,104,0
RD 60,30,18496
s_waitcnt vmcnt(13)
v_add_f32 v164, v164, v192
MAA 76,108,20
RD 64,30,20800
s_add_u32 m0, s56, 123648
MAA 80,108,24
buffer_load_dwordx4 v18, s[20:23], s54 offen lds
MAA 80,104,4
RD 68,30,23104
v_add_f32 v165, v165, v193
MAA 84,104,8
RD 72,30,25408
v_add_f32 v166, v166, v194
MAA 84,108,28
RD 76,31,18496
v_add_f32 v167, v167, v195
MAA 88,108,32
ds_read_b64_tr_b16 a[80:81], v25
MAA 88,104,12
TR 82,25,512
MAA 244,104,16
TR 84,25,12416
MAA 244,108,36
TR 86,25,12928
MAA 120,116,32
buffer_load_dwordx4 v19, s[20:23], s54 offen offset:1024 lds
MAA 120,112,12
TR 88,25,1024
MAA 116,112,8
TR 90,25,1536
MAA 116,116,28
TR 92,25,13440
MAA 112,116,24
TR 94,25,13952
MAA 112,112,4
TR 96,25,2048
MAA 108,112,0
TR 98,25,2560
MAA 108,116,20
TR 100,25,14464
MAA 140,20,124
buffer_load_dwordx4 v20, s[20:23], s54 offen offset:2048 lds
MAA 140,0,120
TR 102,25,14976
s_add_u32 s54, s54, 196608
MAA 144,4,120
MAA 144,24,124
MAA 148,28,124
MAA 148,8,120
MAA 152,12,120
MAA 152,32,124
MAA 160,36,124
MAA 160,16,120
s_waitcnt lgkmcnt(8)
s_barrier
MAA 60,80,40
TR 104,25,32
MAA 60,84,60
TR 106,25,544
s_add_u32 m0, s56, 136064
MAA 64,84,64
buffer_load_dwordx4 v18, s[20:23], s54 offen lds
MAA 64,80,44
TR 108,25,12448
MAA 68,80,48
TR 110,25,12960
MAA 68,84,68
buffer_load_dwordx4 v19, s[20:23], s54 offen offset:1024 lds
MAA 72,84,72
TR 112,25,1056
MAA 72,80,52
TR 114,25,1568
s_waitcnt lgkmcnt(6)
MAA 104,88,52
buffer_load_dwordx4 v20, s[20:23], s54 offen offset:2048 lds
MAA 104,92,72
TR 116,25,13472
s_add_u32 s54, s54, 196608
MAA 100,92,68
TR 118,25,13984
s_add_u32 m0, s59, 16640
MAA 100,88,48
TR 120,25,2080
s_xor_b32 s58, s87, 1310720
MAA 96,88,44
buffer_load_dwordx4 v5, s[24:27], s58 offen lds
MAA 96,92,64
TR 122,25,2592
MAA 92,92,60
TR 124,25,14496
MAA 92,88,40
buffer_load_dwordx4 v6, s[24:27], s58 offen offset:1024 lds
MAA 124,40,96
TR 126,25,15008
s_add_u32 m0, s59, 24960
MAA 124,60,100
RD 0,23,36992
s_xor_b32 s58, s87, 1441792
MAA 128,64,100
buffer_load_dwordx4 v5, s[24:27], s58 offen lds
MAA 128,44,96
RD 4,23,39296
MAA 132,48,96
RD 8,23,41600
MAA 132,68,100
buffer_load_dwordx4 v6, s[24:27], s58 offen offset:1024 lds
MAA 136,72,100
RD 12,23,43904
MAA 136,52,96
RD 16,24,36992
MAA 156,56,96
v_permlane32_swap_b32 v164, v166
MAA 156,76,100
v_permlane32_swap_b32 v165, v167
v_add_f32 v164, v164, v166
v_add_f32 v165, v165, v167
v_mul_f32 v164, 0xba800000, v164
v_mul_f32 v165, 0x3a800000, v165
v_fma_f32 v165, -v164, v164, v165
v_max_f32 v165, 0, v165
v_add_f32 v165, 0x3727c5ac, v165
v_rsq_f32 v166, v165
s_nop 0
v_mov_b32 v165, v166
v_mul_f32 v166, 0x3e8293ee, v166
s_waitcnt vmcnt(14) lgkmcnt(5)
s_barrier
MAA 76,104,40
ds_write_b128 v7, v[164:167]
MAA 76,108,60
ds_write_b32 v17, v164
s_add_u32 m0, s59, 74880
MAA 80,108,64
ds_write_b32 v17, v165 offset:1024
s_xor_b32 s58, s87, 131072
MAA 80,104,44
buffer_load_dwordx4 v5, s[24:27], s58 offen lds
MAA 84,104,48
RD 20,30,36992
MAA 84,108,68
RD 24,30,39296
MAA 88,108,72
RD 28,30,41600
MAA 88,104,52
RD 32,30,43904
MAA 244,104,56
RD 36,31,36992
MAA 244,108,76
buffer_load_dwordx4 v6, s[24:27], s58 offen offset:1024 lds
MAA 120,116,72
TR 80,25,24832
s_add_u32 m0, s59, 83200
MAA 120,112,52
TR 82,25,25344
s_xor_b32 s58, s87, 262144
MAA 116,112,48
TR 84,25,37248
MAA 116,116,68
TR 86,25,37760
MAA 112,116,64
TR 88,25,25856
MAA 112,112,44
buffer_load_dwordx4 v5, s[24:27], s58 offen lds
MAA 108,112,40
TR 90,25,26368
MAA 108,116,60
TR 92,25,38272
MAA 140,60,124
TR 94,25,38784
MAA 140,40,120
TR 96,25,26880
MAA 144,44,120
TR 98,25,27392
MAA 144,64,124
buffer_load_dwordx4 v6, s[24:27], s58 offen offset:1024 lds
MAA 148,68,124
TR 100,25,39296
MAA 148,48,120
TR 102,25,39808
MAA 152,52,120
MAA 152,72,124
MAA 160,76,124
MAA 160,56,120
s_waitcnt vmcnt(8) lgkmcnt(0)
s_barrier
MAA 104,88,12
TR 112,25,25888
s_add_u32 m0, s59, 33280
MAA 104,92,32
TR 114,25,26400
s_xor_b32 s58, s87, 1572864
MAA 100,92,28
buffer_load_dwordx4 v5, s[24:27], s58 offen lds
MAA 100,88,8
TR 116,25,38304
MAA 96,88,4
TR 118,25,38816
MAA 96,92,24
TR 120,25,26912
MAA 92,92,20
buffer_load_dwordx4 v6, s[24:27], s58 offen offset:1024 lds
MAA 92,88,0
TR 122,25,27424
s_add_u32 m0, s59, 41600
MAA 156,16,96
TR 124,25,39328
s_xor_b32 s58, s87, 1703936
MAA 156,36,100
TR 126,25,39840
MAA 72,84,32
buffer_load_dwordx4 v5, s[24:27], s58 offen lds
MAA 72,80,12
TR 104,25,24864
MAA 68,80,8
TR 106,25,25376
MAA 68,84,28
TR 108,25,37280
MAA 64,84,24
buffer_load_dwordx4 v6, s[24:27], s58 offen offset:1024 lds
MAA 64,80,4
TR 110,25,37792
s_xor_b32 s58, s87, 393216
MAA 60,80,0
RD 40,23,55488
MAA 60,84,20
RD 44,23,57792
s_waitcnt lgkmcnt(12)
MAA 120,112,12
RD 48,23,60096
s_waitcnt lgkmcnt(11)
MAA 120,116,32
RD 52,23,62400
MAA 116,116,28
RD 56,24,55488
MAA 116,112,8
RD 60,30,55488
MAA 112,112,4
RD 64,30,57792
MAA 112,116,24
s_waitcnt lgkmcnt(7)
s_barrier
RD 68,30,60096
MAA 108,116,20
RD 72,30,62400
s_add_u32 m0, s59, 91520
MAA 108,112,0
RD 76,31,55488
MAA 160,16,120
TR 144,25,50688
MAA 160,36,124
TR 146,25,51200
MAA 244,108,36
TR 148,25,63104
MAA 244,104,16
TR 150,25,63616
MAA 88,104,12
TR 152,25,50720
MAA 88,108,32
TR 154,25,51232
MAA 84,108,28
TR 156,25,63136
MAA 84,104,8
TR 158,25,63648
MAA 80,104,4
TR 160,25,51712
MAA 80,108,24
TR 162,25,52224
MAA 76,108,20
TR 164,25,64128
MAA 76,104,0
TR 166,25,64640
s_waitcnt lgkmcnt(10)
MAA 104,144,52
TR 168,25,51744
s_waitcnt lgkmcnt(9)
MAA 104,148,72
TR 170,25,52256
MAA 100,148,68
TR 172,25,64160
MAA 100,144,48
TR 174,25,64672
MAA 96,144,44
TR 136,25,49696
MAA 96,148,64
TR 138,25,50208
MAA 92,148,60
TR 140,25,62112
MAA 92,144,40
TR 142,25,62624
s_waitcnt lgkmcnt(14)
MAA 120,152,52
TR 128,25,49664
s_waitcnt lgkmcnt(13)
MAA 120,156,72
TR 130,25,50176
MAA 116,156,68
TR 132,25,62080
MAA 116,152,48
TR 134,25,62592
MAA 112,152,44
ds_read_b128 v[232:235], v10 offset:1792
MAA 112,156,64
ds_read_b128 v[228:231], v10 offset:1536
MAA 108,156,60
ds_read_b128 v[224:227], v10 offset:1280
MAA 108,152,40
ds_read_b128 v[220:223], v10 offset:1024
s_waitcnt lgkmcnt(15)
MAA 156,56,160
buffer_load_dwordx4 v5, s[24:27], s58 offen lds
MAA 156,76,164
s_waitcnt lgkmcnt(12)
MAA 160,76,172
MAA 160,56,168
s_waitcnt lgkmcnt(4)
s_barrier
MAA 244,136,56
buffer_load_dwordx4 v6, s[24:27], s58 offen offset:1024 lds
MAA 244,140,76
s_add_u32 m0, s59, 99840
s_xor_b32 s58, s87, 524288
MAA 88,140,72
MAA 88,136,52
MAA 84,136,48
buffer_load_dwordx4 v5, s[24:27], s58 offen lds
MAA 84,140,68
buffer_load_dwordx4 v6, s[24:27], s58 offen offset:1024 lds
s_add_u32 m0, s59, 108160
s_xor_b32 s58, s87, 655360
buffer_load_dwordx4 v5, s[24:27], s58 offen lds
buffer_load_dwordx4 v6, s[24:27], s58 offen offset:1024 lds
s_mov_b32 exec_lo, 0x10001
s_mov_b32 exec_hi, 0x10001
ds_write_b128 v13, v[244:247] offset:64
s_mov_b64 exec, 0xffff
ds_write_b32 v12, v156 offset:512
ds_write_b32 v12, v160 offset:576
s_mov_b64 exec, -1
MAA 80,136,44
MAA 80,140,64
MAA 76,140,60
MAA 76,136,40
MAA 72,128,52
MAA 72,132,72
s_waitcnt lgkmcnt(0)
s_barrier
MAA 68,128,48
ds_read_b128 v[28:31], v13
s_add_u32 m0, s59, 49920
MAA 68,132,68
ds_read_b128 v[32:35], v13 offset:64
s_xor_b32 s58, s87, 1835008
MAA 64,132,64
ds_read_b128 v[36:39], v13 offset:256
MAA 64,128,44
ds_read_b128 v[40:43], v13 offset:320
MAA 60,128,40
ds_read_b32 v44, v12 offset:512
MAA 60,132,60
ds_read_b32 v45, v12 offset:576
ds_read_b128 v[240:243], v11 offset:704
ds_read_b128 v[244:247], v11 offset:1728
ds_read_b128 v[18:21], v11 offset:448
ds_read_b128 v[22:25], v11 offset:1472
buffer_load_dwordx4 v5, s[24:27], s58 offen lds
s_waitcnt lgkmcnt(9)
v_pk_fma_f32 v[72:73], v[28:29], v[232:233], v[72:73] op_sel_hi:[1,0,1]
v_cvt_pk_bf16_f32 v176, v72, v73
v_pk_fma_f32 v[74:75], v[30:31], v[232:233], v[74:75] op_sel_hi:[1,0,1]
v_cvt_pk_bf16_f32 v177, v74, v75
s_waitcnt lgkmcnt(8)
v_pk_fma_f32 v[88:89], v[32:33], v[232:233], v[88:89] op_sel_hi:[1,0,1]
v_cvt_pk_bf16_f32 v178, v88, v89
v_pk_fma_f32 v[90:91], v[34:35], v[232:233], v[90:91] op_sel_hi:[1,0,1]
s_waitcnt lgkmcnt(7)
v_pk_fma_f32 v[104:105], v[36:37], v[232:233], v[104:105] op_sel_hi:[1,0,1]
v_pk_mul_f32 v[104:105], v[104:105], v[232:233] op_sel:[0,1] op_sel_hi:[1,1]
v_cvt_pk_bf16_f32 v196, v104, v105
v_pk_fma_f32 v[106:107], v[38:39], v[232:233], v[106:107] op_sel_hi:[1,0,1]
v_pk_mul_f32 v[106:107], v[106:107], v[232:233] op_sel:[0,1] op_sel_hi:[1,1]
v_cvt_pk_bf16_f32 v197, v106, v107
s_waitcnt lgkmcnt(6)
v_pk_fma_f32 v[120:121], v[40:41], v[232:233], v[120:121] op_sel_hi:[1,0,1]
v_pk_mul_f32 v[120:121], v[120:121], v[232:233] op_sel:[0,1] op_sel_hi:[1,1]
v_cvt_pk_bf16_f32 v198, v120, v121
v_pk_fma_f32 v[122:123], v[42:43], v[232:233], v[122:123] op_sel_hi:[1,0,1]
v_pk_mul_f32 v[122:123], v[122:123], v[232:233] op_sel:[0,1] op_sel_hi:[1,1]
v_cvt_pk_bf16_f32 v199, v122, v123
v_pk_fma_f32 v[100:101], v[36:37], v[228:229], v[100:101] op_sel_hi:[1,0,1]
v_pk_mul_f32 v[100:101], v[100:101], v[228:229] op_sel:[0,1] op_sel_hi:[1,1]
s_waitcnt lgkmcnt(3)
v_pk_fma_f32 v[156:157], v[240:241], v[44:45], v[156:157] op_sel_hi:[1,0,1]
v_pk_fma_f32 v[158:159], v[242:243], v[44:45], v[158:159] op_sel_hi:[1,0,1]
s_waitcnt lgkmcnt(2)
v_pk_mul_f32 v[156:157], v[156:157], v[244:245]
v_cvt_pk_bf16_f32 v236, v156, v157
v_pk_mul_f32 v[158:159], v[158:159], v[246:247]
v_cvt_pk_bf16_f32 v237, v158, v159
v_pk_fma_f32 v[160:161], v[240:241], v[44:45], v[160:161] op_sel:[0,1,0] op_sel_hi:[1,1,1]
v_pk_mul_f32 v[160:161], v[160:161], v[244:245]
v_cvt_pk_bf16_f32 v238, v160, v161
v_pk_fma_f32 v[162:163], v[242:243], v[44:45], v[162:163] op_sel:[0,1,0] op_sel_hi:[1,1,1]
v_pk_mul_f32 v[162:163], v[162:163], v[246:247]
v_cvt_pk_bf16_f32 v239, v162, v163
ds_write_b128 v8, v[236:239] offset:1024
v_cvt_pk_bf16_f32 v192, v100, v101
v_pk_fma_f32 v[102:103], v[38:39], v[228:229], v[102:103] op_sel_hi:[1,0,1]
v_pk_mul_f32 v[102:103], v[102:103], v[228:229] op_sel:[0,1] op_sel_hi:[1,1]
v_cvt_pk_bf16_f32 v193, v102, v103
v_pk_fma_f32 v[116:117], v[40:41], v[228:229], v[116:117] op_sel_hi:[1,0,1]
v_pk_mul_f32 v[116:117], v[116:117], v[228:229] op_sel:[0,1] op_sel_hi:[1,1]
v_cvt_pk_bf16_f32 v194, v116, v117
v_pk_fma_f32 v[118:119], v[42:43], v[228:229], v[118:119] op_sel_hi:[1,0,1]
v_pk_mul_f32 v[118:119], v[118:119], v[228:229] op_sel:[0,1] op_sel_hi:[1,1]
v_cvt_pk_bf16_f32 v195, v118, v119
v_pk_fma_f32 v[96:97], v[36:37], v[224:225], v[96:97] op_sel_hi:[1,0,1]
v_pk_mul_f32 v[96:97], v[96:97], v[224:225] op_sel:[0,1] op_sel_hi:[1,1]
v_cvt_pk_bf16_f32 v188, v96, v97
v_pk_fma_f32 v[98:99], v[38:39], v[224:225], v[98:99] op_sel_hi:[1,0,1]
v_pk_mul_f32 v[98:99], v[98:99], v[224:225] op_sel:[0,1] op_sel_hi:[1,1]
v_cvt_pk_bf16_f32 v189, v98, v99
v_pk_fma_f32 v[112:113], v[40:41], v[224:225], v[112:113] op_sel_hi:[1,0,1]
v_pk_mul_f32 v[112:113], v[112:113], v[224:225] op_sel:[0,1] op_sel_hi:[1,1]
v_cvt_pk_bf16_f32 v190, v112, v113
v_pk_fma_f32 v[114:115], v[42:43], v[224:225], v[114:115] op_sel_hi:[1,0,1]
v_pk_mul_f32 v[114:115], v[114:115], v[224:225] op_sel:[0,1] op_sel_hi:[1,1]
v_cvt_pk_bf16_f32 v191, v114, v115
v_pk_fma_f32 v[92:93], v[36:37], v[220:221], v[92:93] op_sel_hi:[1,0,1]
v_pk_mul_f32 v[92:93], v[92:93], v[220:221] op_sel:[0,1] op_sel_hi:[1,1]
v_cvt_pk_bf16_f32 v184, v92, v93
v_pk_fma_f32 v[94:95], v[38:39], v[220:221], v[94:95] op_sel_hi:[1,0,1]
v_pk_mul_f32 v[94:95], v[94:95], v[220:221] op_sel:[0,1] op_sel_hi:[1,1]
v_cvt_pk_bf16_f32 v185, v94, v95
v_pk_fma_f32 v[108:109], v[40:41], v[220:221], v[108:109] op_sel_hi:[1,0,1]
v_pk_mul_f32 v[108:109], v[108:109], v[220:221] op_sel:[0,1] op_sel_hi:[1,1]
v_cvt_pk_bf16_f32 v186, v108, v109
v_pk_fma_f32 v[110:111], v[42:43], v[220:221], v[110:111] op_sel_hi:[1,0,1]
v_pk_mul_f32 v[110:111], v[110:111], v[220:221] op_sel:[0,1] op_sel_hi:[1,1]
v_cvt_pk_bf16_f32 v187, v110, v111
v_cvt_pk_bf16_f32 v179, v90, v91
v_pk_fma_f32 v[68:69], v[28:29], v[228:229], v[68:69] op_sel_hi:[1,0,1]
v_cvt_pk_bf16_f32 v172, v68, v69
v_pk_fma_f32 v[70:71], v[30:31], v[228:229], v[70:71] op_sel_hi:[1,0,1]
v_cvt_pk_bf16_f32 v173, v70, v71
v_pk_fma_f32 v[84:85], v[32:33], v[228:229], v[84:85] op_sel_hi:[1,0,1]
v_cvt_pk_bf16_f32 v174, v84, v85
v_pk_fma_f32 v[86:87], v[34:35], v[228:229], v[86:87] op_sel_hi:[1,0,1]
v_cvt_pk_bf16_f32 v175, v86, v87
v_pk_fma_f32 v[64:65], v[28:29], v[224:225], v[64:65] op_sel_hi:[1,0,1]
v_cvt_pk_bf16_f32 v168, v64, v65
v_pk_fma_f32 v[66:67], v[30:31], v[224:225], v[66:67] op_sel_hi:[1,0,1]
v_cvt_pk_bf16_f32 v169, v66, v67
v_pk_fma_f32 v[80:81], v[32:33], v[224:225], v[80:81] op_sel_hi:[1,0,1]
v_cvt_pk_bf16_f32 v170, v80, v81
v_pk_fma_f32 v[82:83], v[34:35], v[224:225], v[82:83] op_sel_hi:[1,0,1]
v_cvt_pk_bf16_f32 v171, v82, v83
v_pk_fma_f32 v[60:61], v[28:29], v[220:221], v[60:61] op_sel_hi:[1,0,1]
v_cvt_pk_bf16_f32 v164, v60, v61
v_pk_fma_f32 v[62:63], v[30:31], v[220:221], v[62:63] op_sel_hi:[1,0,1]
v_cvt_pk_bf16_f32 v165, v62, v63
v_pk_fma_f32 v[76:77], v[32:33], v[220:221], v[76:77] op_sel_hi:[1,0,1]
v_cvt_pk_bf16_f32 v166, v76, v77
v_pk_fma_f32 v[78:79], v[34:35], v[220:221], v[78:79] op_sel_hi:[1,0,1]
s_waitcnt lgkmcnt(0)
s_barrier
v_cvt_pk_bf16_f32 v167, v78, v79
v_mfma_f32_16x16x32_bf16 v[120:123], v[196:199], v[176:179], v[50:53]
ds_read_b128 v[180:183], v9
v_mfma_f32_16x16x32_bf16 v[104:107], v[192:195], v[176:179], v[46:49]
buffer_load_dwordx4 v6, s[24:27], s58 offen offset:1024 lds
v_mfma_f32_16x16x32_bf16 v[116:119], v[192:195], v[172:175], v[50:53]
ds_read_b64 v[200:201], v9 offset:1024
s_add_u32 m0, s59, 58240
v_mfma_f32_16x16x32_bf16 v[100:103], v[188:191], v[172:175], v[46:49]
ds_read_b64 v[210:211], v9 offset:1032
s_xor_b32 s58, s87, 1966080
v_mfma_f32_16x16x32_bf16 v[112:115], v[188:191], v[168:171], v[50:53]
ds_read_b128 v[240:243], v11 offset:384
v_max3_f32 v88, v104, v105, v106
v_mfma_f32_16x16x32_bf16 v[96:99], v[184:187], v[168:171], v[46:49]
buffer_load_dwordx4 v5, s[24:27], s58 offen lds
v_mfma_f32_16x16x32_bf16 v[108:111], v[184:187], v[164:167], v[50:53]
ds_read_b128 v[244:247], v11 offset:1408
v_max3_f32 v89, v107, v120, v121
v_max3_f32 v88, v88, v122, v123
v_max_f32 v90, v88, v89
v_max_f32 v89, v88, v89
v_max3_f32 v84, v100, v101, v102
v_max3_f32 v85, v103, v116, v117
s_waitcnt lgkmcnt(4)
v_mfma_f32_16x16x32_bf16 v[92:95], v[180:183], v[164:167], v[46:49]
ds_read_b128 v[28:31], v11 offset:320
v_permlane16_swap_b32 v90, v89
MAA 136,12,96
buffer_load_dwordx4 v6, s[24:27], s58 offen offset:1024 lds
MAA 136,32,100
ds_read_b128 v[32:35], v11 offset:1344
s_add_u32 m0, s59, 66560
MAA 136,52,160
ds_read_b128 v[36:39], v11 offset:256
s_xor_b32 s58, s87, 0
MAA 136,72,164
ds_read_b128 v[40:43], v11 offset:1280
v_max_f32 v88, v90, v89
MAA 152,72,172
buffer_load_dwordx4 v5, s[24:27], s58 offen lds
MAA 152,52,168
v_max_f32 v89, v90, v89
v_max3_f32 v84, v84, v118, v119
MAA 152,32,124
v_permlane32_swap_b32 v88, v89
MAA 152,12,120
v_max_f32 v88, v88, v89
v_mul_f32 v88, v88, v234
v_max_f32 v86, v84, v85
v_max_f32 v85, v84, v85
v_max3_f32 v80, v96, v97, v98
v_max3_f32 v81, v99, v112, v113
v_permlane16_swap_b32 v86, v85
v_max3_f32 v80, v80, v114, v115
v_max_f32 v84, v86, v85
v_max_f32 v85, v86, v85
v_max_f32 v82, v80, v81
v_max_f32 v81, v80, v81
v_permlane32_swap_b32 v84, v85
v_max3_f32 v76, v92, v93, v94
v_max_f32 v84, v84, v85
v_mul_f32 v84, v84, v230
v_permlane16_swap_b32 v82, v81
v_max3_f32 v77, v95, v108, v109
v_max_f32 v80, v82, v81
v_max_f32 v81, v82, v81
v_max3_f32 v76, v76, v110, v111
v_max_f32 v78, v76, v77
v_permlane32_swap_b32 v80, v81
v_max_f32 v77, v76, v77
v_max_f32 v80, v80, v81
v_mul_f32 v80, v80, v226
v_permlane16_swap_b32 v78, v77
v_pk_fma_f32 v[104:105], v[104:105], v[234:235], v[88:89] op_sel_hi:[1,0,0] neg_lo:[0,0,1] neg_hi:[0,0,1]
v_max_f32 v76, v78, v77
v_max_f32 v77, v78, v77
v_pk_fma_f32 v[106:107], v[106:107], v[234:235], v[88:89] op_sel_hi:[1,0,0] neg_lo:[0,0,1] neg_hi:[0,0,1]
v_pk_fma_f32 v[120:121], v[120:121], v[234:235], v[88:89] op_sel_hi:[1,0,0] neg_lo:[0,0,1] neg_hi:[0,0,1]
v_permlane32_swap_b32 v76, v77
v_pk_fma_f32 v[122:123], v[122:123], v[234:235], v[88:89] op_sel_hi:[1,0,0] neg_lo:[0,0,1] neg_hi:[0,0,1]
v_max_f32 v76, v76, v77
v_mul_f32 v76, v76, v222
v_pk_fma_f32 v[100:101], v[100:101], v[230:231], v[84:85] op_sel_hi:[1,0,0] neg_lo:[0,0,1] neg_hi:[0,0,1]
v_pk_fma_f32 v[102:103], v[102:103], v[230:231], v[84:85] op_sel_hi:[1,0,0] neg_lo:[0,0,1] neg_hi:[0,0,1]
v_pk_fma_f32 v[116:117], v[116:117], v[230:231], v[84:85] op_sel_hi:[1,0,0] neg_lo:[0,0,1] neg_hi:[0,0,1]
v_pk_fma_f32 v[118:119], v[118:119], v[230:231], v[84:85] op_sel_hi:[1,0,0] neg_lo:[0,0,1] neg_hi:[0,0,1]
v_pk_fma_f32 v[96:97], v[96:97], v[226:227], v[80:81] op_sel_hi:[1,0,0] neg_lo:[0,0,1] neg_hi:[0,0,1]
v_pk_fma_f32 v[98:99], v[98:99], v[226:227], v[80:81] op_sel_hi:[1,0,0] neg_lo:[0,0,1] neg_hi:[0,0,1]
v_pk_fma_f32 v[112:113], v[112:113], v[226:227], v[80:81] op_sel_hi:[1,0,0] neg_lo:[0,0,1] neg_hi:[0,0,1]
v_pk_fma_f32 v[114:115], v[114:115], v[226:227], v[80:81] op_sel_hi:[1,0,0] neg_lo:[0,0,1] neg_hi:[0,0,1]
v_pk_fma_f32 v[92:93], v[92:93], v[222:223], v[76:77] op_sel_hi:[1,0,0] neg_lo:[0,0,1] neg_hi:[0,0,1]
v_pk_fma_f32 v[94:95], v[94:95], v[222:223], v[76:77] op_sel_hi:[1,0,0] neg_lo:[0,0,1] neg_hi:[0,0,1]
v_pk_fma_f32 v[108:109], v[108:109], v[222:223], v[76:77] op_sel_hi:[1,0,0] neg_lo:[0,0,1] neg_hi:[0,0,1]
v_pk_fma_f32 v[110:111], v[110:111], v[222:223], v[76:77] op_sel_hi:[1,0,0] neg_lo:[0,0,1] neg_hi:[0,0,1]
v_pk_fma_f32 v[136:137], v[18:19], v[44:45], v[136:137] op_sel_hi:[1,0,1]
v_pk_mul_f32 v[136:137], v[136:137], v[22:23]
v_pk_fma_f32 v[138:139], v[20:21], v[44:45], v[138:139] op_sel_hi:[1,0,1]
v_pk_mul_f32 v[138:139], v[138:139], v[24:25]
v_pk_fma_f32 v[152:153], v[18:19], v[44:45], v[152:153] op_sel:[0,1,0] op_sel_hi:[1,1,1]
v_pk_mul_f32 v[152:153], v[152:153], v[22:23]
v_pk_fma_f32 v[154:155], v[20:21], v[44:45], v[154:155] op_sel:[0,1,0] op_sel_hi:[1,1,1]
v_pk_mul_f32 v[154:155], v[154:155], v[24:25]
v_exp_f32 v104, v104
s_nop 0
MAA 132,8,96
buffer_load_dwordx4 v6, s[24:27], s58 offen offset:1024 lds
MAA 132,28,100
s_add_u32 m0, s59, 116480
s_xor_b32 s58, s87, 786432
v_exp_f32 v105, v105
MAA 132,48,160
v_exp_f32 v106, v106
MAA 132,68,164
v_exp_f32 v107, v107
MAA 148,68,172
buffer_load_dwordx4 v5, s[24:27], s58 offen lds
MAA 148,48,168
v_exp_f32 v120, v120
MAA 148,28,124
v_exp_f32 v121, v121
MAA 148,8,120
v_exp_f32 v122, v122
MAA 128,4,96
buffer_load_dwordx4 v6, s[24:27], s58 offen offset:1024 lds
MAA 128,24,100
s_add_u32 m0, s59, 124800
s_xor_b32 s58, s87, 917504
v_exp_f32 v123, v123
MAA 128,44,160
v_exp_f32 v100, v100
MAA 128,64,164
v_exp_f32 v101, v101
MAA 144,64,172
buffer_load_dwordx4 v5, s[24:27], s58 offen lds
MAA 144,44,168
v_exp_f32 v102, v102
MAA 144,24,124
v_exp_f32 v103, v103
MAA 144,4,120
v_exp_f32 v116, v116
MAA 124,0,96
buffer_load_dwordx4 v6, s[24:27], s58 offen offset:1024 lds
MAA 124,20,100
v_exp_f32 v117, v117
MAA 124,40,160
v_exp_f32 v118, v118
MAA 124,60,164
v_exp_f32 v119, v119
MAA 140,60,172
v_exp_f32 v96, v96
MAA 140,40,168
v_exp_f32 v97, v97
MAA 140,20,124
v_exp_f32 v98, v98
MAA 140,0,120
v_cvt_pk_bf16_f32 v72, v104, v105
v_cvt_pk_bf16_f32 v73, v106, v107
v_cvt_pk_bf16_f32 v74, v120, v121
v_cvt_pk_bf16_f32 v75, v122, v123
v_cvt_pk_bf16_f32 v68, v100, v101
v_cvt_pk_bf16_f32 v69, v102, v103
v_cvt_pk_bf16_f32 v70, v116, v117
v_cvt_pk_bf16_f32 v71, v118, v119
v_exp_f32 v99, v99
v_exp_f32 v112, v112
v_exp_f32 v113, v113
v_exp_f32 v114, v114
v_exp_f32 v115, v115
v_cvt_pk_bf16_f32 v64, v96, v97
v_cvt_pk_bf16_f32 v65, v98, v99
v_cvt_pk_bf16_f32 v66, v112, v113
v_cvt_pk_bf16_f32 v67, v114, v115
v_cvt_pk_bf16_f32 v208, v136, v137
v_cvt_pk_bf16_f32 v209, v138, v139
v_cvt_pk_bf16_f32 v218, v152, v153
v_cvt_pk_bf16_f32 v219, v154, v155
s_waitcnt lgkmcnt(5)
v_pk_fma_f32 v[132:133], v[240:241], v[44:45], v[132:133] op_sel_hi:[1,0,1]
s_waitcnt lgkmcnt(4)
v_pk_mul_f32 v[132:133], v[132:133], v[244:245]
v_cvt_pk_bf16_f32 v206, v132, v133
v_pk_fma_f32 v[134:135], v[242:243], v[44:45], v[134:135] op_sel_hi:[1,0,1]
v_pk_mul_f32 v[134:135], v[134:135], v[246:247]
v_cvt_pk_bf16_f32 v207, v134, v135
v_pk_fma_f32 v[148:149], v[240:241], v[44:45], v[148:149] op_sel:[0,1,0] op_sel_hi:[1,1,1]
v_pk_mul_f32 v[148:149], v[148:149], v[244:245]
v_cvt_pk_bf16_f32 v216, v148, v149
v_pk_fma_f32 v[150:151], v[242:243], v[44:45], v[150:151] op_sel:[0,1,0] op_sel_hi:[1,1,1]
v_pk_mul_f32 v[150:151], v[150:151], v[246:247]
v_cvt_pk_bf16_f32 v217, v150, v151
s_waitcnt lgkmcnt(3)
v_pk_fma_f32 v[128:129], v[28:29], v[44:45], v[128:129] op_sel_hi:[1,0,1]
s_waitcnt lgkmcnt(2)
v_pk_mul_f32 v[128:129], v[128:129], v[32:33]
v_cvt_pk_bf16_f32 v204, v128, v129
v_pk_fma_f32 v[130:131], v[30:31], v[44:45], v[130:131] op_sel_hi:[1,0,1]
v_pk_mul_f32 v[130:131], v[130:131], v[34:35]
v_cvt_pk_bf16_f32 v205, v130, v131
v_pk_fma_f32 v[144:145], v[28:29], v[44:45], v[144:145] op_sel:[0,1,0] op_sel_hi:[1,1,1]
v_pk_mul_f32 v[144:145], v[144:145], v[32:33]
v_cvt_pk_bf16_f32 v214, v144, v145
v_pk_fma_f32 v[146:147], v[30:31], v[44:45], v[146:147] op_sel:[0,1,0] op_sel_hi:[1,1,1]
v_pk_mul_f32 v[146:147], v[146:147], v[34:35]
v_cvt_pk_bf16_f32 v215, v146, v147
s_waitcnt lgkmcnt(1)
v_pk_fma_f32 v[124:125], v[36:37], v[44:45], v[124:125] op_sel_hi:[1,0,1]
s_waitcnt lgkmcnt(0)
v_pk_mul_f32 v[124:125], v[124:125], v[40:41]
v_cvt_pk_bf16_f32 v202, v124, v125
v_pk_fma_f32 v[126:127], v[38:39], v[44:45], v[126:127] op_sel_hi:[1,0,1]
v_pk_mul_f32 v[126:127], v[126:127], v[42:43]
v_cvt_pk_bf16_f32 v203, v126, v127
v_pk_fma_f32 v[140:141], v[36:37], v[44:45], v[140:141] op_sel:[0,1,0] op_sel_hi:[1,1,1]
v_pk_mul_f32 v[140:141], v[140:141], v[40:41]
v_cvt_pk_bf16_f32 v212, v140, v141
v_pk_fma_f32 v[142:143], v[38:39], v[44:45], v[142:143] op_sel:[0,1,0] op_sel_hi:[1,1,1]
v_pk_mul_f32 v[142:143], v[142:143], v[42:43]
v_cvt_pk_bf16_f32 v213, v142, v143
s_nop 0
v_mfma_f32_16x16x32_bf16 v[88:91], v[248:251], v[72:75], 0
v_exp_f32 v92, v92
v_mfma_f32_16x16x32_bf16 v[104:107], v[206:209], v[72:75], 0
v_exp_f32 v93, v93
v_mfma_f32_16x16x32_bf16 v[120:123], v[216:219], v[72:75], 0
v_exp_f32 v94, v94
v_mfma_f32_16x16x32_bf16 v[84:87], v[248:251], v[68:71], 0
v_exp_f32 v95, v95
v_mfma_f32_16x16x32_bf16 v[100:103], v[204:207], v[68:71], 0
v_exp_f32 v108, v108
v_mfma_f32_16x16x32_bf16 v[116:119], v[214:217], v[68:71], 0
v_exp_f32 v109, v109
v_mfma_f32_16x16x32_bf16 v[80:83], v[248:251], v[64:67], 0
v_exp_f32 v110, v110
v_mfma_f32_16x16x32_bf16 v[96:99], v[202:205], v[64:67], 0
v_exp_f32 v111, v111
v_mfma_f32_16x16x32_bf16 v[112:115], v[212:215], v[64:67], 0
v_cvt_pk_bf16_f32 v60, v92, v93
v_cvt_pk_bf16_f32 v61, v94, v95
v_cvt_pk_bf16_f32 v62, v108, v109
v_cvt_pk_bf16_f32 v63, v110, v111
v_rcp_f32 v88, v88
v_rcp_f32 v84, v84
v_mfma_f32_16x16x32_bf16 v[76:79], v[248:251], v[60:63], 0
v_rcp_f32 v80, v80
v_mfma_f32_16x16x32_bf16 v[92:95], v[200:203], v[60:63], 0
v_mfma_f32_16x16x32_bf16 v[108:111], v[210:213], v[60:63], 0
s_nop 4
v_rcp_f32 v76, v76
v_pk_mul_f32 v[104:105], v[104:105], v[88:89] op_sel_hi:[1,0]
v_pk_mul_f32 v[106:107], v[106:107], v[88:89] op_sel_hi:[1,0]
v_pk_mul_f32 v[120:121], v[120:121], v[88:89] op_sel_hi:[1,0]
v_pk_mul_f32 v[122:123], v[122:123], v[88:89] op_sel_hi:[1,0]
v_cvt_pk_bf16_f32 v176, v104, v105
v_cvt_pk_bf16_f32 v177, v106, v107
v_cvt_pk_bf16_f32 v178, v120, v121
v_cvt_pk_bf16_f32 v179, v122, v123
buffer_store_dwordx4 v[176:179], v4, s[16:19], s74 offen offset:3072 sc1
v_pk_mul_f32 v[100:101], v[100:101], v[84:85] op_sel_hi:[1,0]
v_pk_mul_f32 v[102:103], v[102:103], v[84:85] op_sel_hi:[1,0]
v_pk_mul_f32 v[116:117], v[116:117], v[84:85] op_sel_hi:[1,0]
v_pk_mul_f32 v[118:119], v[118:119], v[84:85] op_sel_hi:[1,0]
v_cvt_pk_bf16_f32 v172, v100, v101
v_cvt_pk_bf16_f32 v173, v102, v103
v_cvt_pk_bf16_f32 v174, v116, v117
v_cvt_pk_bf16_f32 v175, v118, v119
buffer_store_dwordx4 v[172:175], v4, s[16:19], s74 offen offset:2048 sc1
v_pk_mul_f32 v[96:97], v[96:97], v[80:81] op_sel_hi:[1,0]
v_pk_mul_f32 v[98:99], v[98:99], v[80:81] op_sel_hi:[1,0]
v_pk_mul_f32 v[112:113], v[112:113], v[80:81] op_sel_hi:[1,0]
v_pk_mul_f32 v[114:115], v[114:115], v[80:81] op_sel_hi:[1,0]
v_cvt_pk_bf16_f32 v168, v96, v97
v_cvt_pk_bf16_f32 v169, v98, v99
v_cvt_pk_bf16_f32 v170, v112, v113
v_cvt_pk_bf16_f32 v171, v114, v115
buffer_store_dwordx4 v[168:171], v4, s[16:19], s74 offen offset:1024 sc1
v_pk_mul_f32 v[92:93], v[92:93], v[76:77] op_sel_hi:[1,0]
v_pk_mul_f32 v[94:95], v[94:95], v[76:77] op_sel_hi:[1,0]
v_pk_mul_f32 v[108:109], v[108:109], v[76:77] op_sel_hi:[1,0]
v_pk_mul_f32 v[110:111], v[110:111], v[76:77] op_sel_hi:[1,0]
v_cvt_pk_bf16_f32 v164, v92, v93
v_cvt_pk_bf16_f32 v165, v94, v95
v_cvt_pk_bf16_f32 v166, v108, v109
v_cvt_pk_bf16_f32 v167, v110, v111
buffer_store_dwordx4 v[164:167], v4, s[16:19], s74 offen sc1
s_nop 1
.Lqkve2:
s_lshl_b32 s62, s3, 11
s_add_u32 s62, s62, s84
v_lshl_add_u32 v4, v1, 4, s62
v_lshrrev_b32 v2, 3, v1
v_cmp_eq_u32 vcc, 3, v2
v_add_u32 v2, 67108480, v4
s_nop 0
v_cndmask_b32 v4, v4, v2, vcc
v_bfe_u32 v5, v1, 3, 1
v_lshrrev_b32 v2, 4, v1
v_lshl_add_u32 v5, v2, 3, v5
s_lshl_b32 s62, s3, 1
v_add_u32 v5, s62, v5
v_mul_u32_u24 v5, 2048, v5
v_and_b32 v2, 7, v1
v_lshl_add_u32 v5, v2, 4, v5
s_lshl_b32 s62, s7, 7
v_add_u32 v5, s62, v5
v_add_u32 v6, 64512, v5
v_bfe_u32 v8, v1, 3, 2
v_mul_u32_u24 v8, 2080, v8
v_bfe_u32 v2, v1, 2, 1
v_lshl_add_u32 v8, v2, 7, v8
v_bfe_u32 v2, v1, 5, 1
v_lshl_add_u32 v8, v2, 8, v8
v_and_b32 v2, 3, v1
v_lshl_add_u32 v8, v2, 3, v8
s_mov_b32 s57, 66560
v_add_u32 v7, s57, v8
s_lshr_b32 s54, s87, 17
s_lshl_b32 s54, s54, 18
s_add_u32 s54, s54, 4194304
s_mov_b32 s52, s54
s_add_u32 s53, s54, 131072
v_accvgpr_read_b32 v32, a224
v_accvgpr_read_b32 v33, a225
v_accvgpr_read_b32 v34, a226
v_accvgpr_read_b32 v35, a227
v_accvgpr_read_b32 v36, a228
v_accvgpr_read_b32 v37, a229
v_accvgpr_read_b32 v38, a230
v_accvgpr_read_b32 v39, a231
v_accvgpr_read_b32 v40, a232
v_accvgpr_read_b32 v41, a233
v_accvgpr_read_b32 v42, a234
v_accvgpr_read_b32 v43, a235
v_accvgpr_read_b32 v44, a236
v_accvgpr_read_b32 v45, a237
v_accvgpr_read_b32 v46, a238
v_accvgpr_read_b32 v47, a239
v_accvgpr_read_b32 v48, a240
v_accvgpr_read_b32 v49, a241
v_accvgpr_read_b32 v50, a242
v_accvgpr_read_b32 v51, a243
v_accvgpr_read_b32 v52, a244
v_accvgpr_read_b32 v53, a245
v_accvgpr_read_b32 v54, a246
v_accvgpr_read_b32 v55, a247
v_accvgpr_read_b32 v56, a248
v_accvgpr_read_b32 v57, a249
v_accvgpr_read_b32 v58, a250
v_accvgpr_read_b32 v59, a251
v_accvgpr_read_b32 v60, a252
v_accvgpr_read_b32 v61, a253
v_accvgpr_read_b32 v62, a254
v_accvgpr_read_b32 v63, a255
s_lshl_b32 s62, s49, 3
s_add_u32 s62, s62, s48
s_mul_i32 s62, s62, 28672
s_add_u32 s62, s62, s51
v_lshrrev_b32 v12, 4, v1
v_mul_u32_u24 v12, 57344, v12
v_and_b32 v2, 15, v1
v_lshl_add_u32 v12, v2, 4, v12
v_add_u32 v12, s62, v12
v_add_u32 v13, 6112, v12
v_add_u32 v14, 12224, v12
v_add_u32 v15, 18336, v12
s_mul_i32 s59, s3, 4224
s_mov_b32 s58, 0
s_mov_b32 s36, s0
s_mov_b32 s37, s1
s_lshl_b32 s62, s8, 10
s_add_u32 s62, s62, 30425088
s_lshl_b32 s64, s6, 10
s_add_u32 s64, s64, 30425088
s_lshr_b32 s67, s5, 2
s_and_b32 s67, s67, 3
s_lshl_b32 s67, s67, 7
s_add_u32 s64, s64, s67
v_lshl_add_u32 v252, v1, 7, s62
v_mov_b32 v253, s64
v_mov_b32 v255, 1
s_waitcnt vmcnt(0) lgkmcnt(0)
s_cmp_lg_u32 s3, 1
s_barrier
s_cbranch_scc1 .Lnopoll34
s_mov_b64 exec, 15
buffer_atomic_add v255, v252, s[16:19], 0 offen
s_mov_b64 exec, 1
v_mov_b32 v254, 0
buffer_atomic_add v254, v253, s[16:19], 0 offen sc0
s_sleep 5
s_mov_b32 s15, 0
.Lpoll33:
v_mov_b32 v255, 0
buffer_atomic_add v255, v253, s[16:19], 0 offen sc0
s_waitcnt vmcnt(1)
v_cmp_gt_u32 vcc, 16, v254
s_add_u32 s15, s15, 1
s_cbranch_vccz .Lnopoll34r
v_mov_b32 v254, 0
buffer_atomic_add v254, v253, s[16:19], 0 offen sc0
s_waitcnt vmcnt(1)
v_cmp_gt_u32 vcc, 16, v255
s_add_u32 s15, s15, 1
s_cbranch_vccz .Lnopoll34r
s_cmp_le_u32 s15, 100000
s_cbranch_scc1 .Lpoll33
s_branch .Lnopoll34r
.Lnopoll34:
s_mov_b64 exec, 0
s_cmp_eq_u32 s3, 2
s_cbranch_scc1 .Lpad1
s_cmp_eq_u32 s3, 3
s_cbranch_scc1 .Lpad2
s_branch .Lpad3
.Lnopoll34r:
s_mov_b64 exec, -1
s_barrier
buffer_load_dwordx4 v[64:67], v4, s[16:19], s52 offen sc1
buffer_load_dwordx4 v[68:71], v4, s[16:19], s52 offen offset:1024 sc1
s_xor_b32 s52, s54, 262144
buffer_load_dwordx4 v[72:75], v4, s[16:19], s53 offen sc1
buffer_load_dwordx4 v[76:79], v4, s[16:19], s53 offen offset:1024 sc1
s_xor_b32 s53, s54, 393216
buffer_load_dwordx4 v[80:83], v4, s[16:19], s52 offen sc1
buffer_load_dwordx4 v[84:87], v4, s[16:19], s52 offen offset:1024 sc1
s_xor_b32 s52, s54, 524288
buffer_load_dwordx4 v[88:91], v4, s[16:19], s53 offen sc1
buffer_load_dwordx4 v[92:95], v4, s[16:19], s53 offen offset:1024 sc1
s_xor_b32 s53, s54, 655360
buffer_load_dwordx4 v[96:99], v4, s[16:19], s52 offen sc1
buffer_load_dwordx4 v[100:103], v4, s[16:19], s52 offen offset:1024 sc1
s_xor_b32 s52, s54, 786432
buffer_load_dwordx4 v[104:107], v4, s[16:19], s53 offen sc1
buffer_load_dwordx4 v[108:111], v4, s[16:19], s53 offen offset:1024 sc1
s_xor_b32 s53, s54, 917504
ds_read_b64_tr_b16 a[0:1], v7
TR 2,7,512
TR 16,7,1024
TR 18,7,1536
TR 4,7,32
TR 6,7,544
TR 20,7,1056
TR 22,7,1568
TR 8,7,64
TR 10,7,576
TR 24,7,1088
TR 26,7,1600
TR 12,7,96
TR 14,7,608
TR 28,7,1120
TR 30,7,1632
s_waitcnt vmcnt(8) lgkmcnt(14)
MAV 32,0,64
TR 32,7,8320
s_waitcnt lgkmcnt(13)
MAV 32,16,72
buffer_load_dwordx4 v[112:115], v4, s[16:19], s52 offen sc1
MAV 48,16,76
TR 34,7,8832
MAV 48,0,68
TR 48,7,9344
TR 50,7,9856
s_waitcnt lgkmcnt(14)
MAV 52,4,68
TR 36,7,8352
s_waitcnt lgkmcnt(13)
MAV 52,20,76
buffer_load_dwordx4 v[116:119], v4, s[16:19], s52 offen offset:1024 sc1
MAV 36,20,72
TR 38,7,8864
s_xor_b32 s52, s54, 1048576
MAV 36,4,64
TR 52,7,9376
TR 54,7,9888
s_waitcnt lgkmcnt(14)
MAV 40,8,64
TR 40,7,8384
s_waitcnt lgkmcnt(13)
MAV 40,24,72
buffer_load_dwordx4 v[120:123], v4, s[16:19], s53 offen sc1
MAV 56,24,76
TR 42,7,8896
MAV 56,8,68
TR 56,7,9408
TR 58,7,9920
s_waitcnt lgkmcnt(14)
MAV 60,12,68
TR 44,7,8416
s_waitcnt lgkmcnt(13)
MAV 60,28,76
buffer_load_dwordx4 v[124:127], v4, s[16:19], s53 offen offset:1024 sc1
MAV 44,28,72
TR 46,7,8928
s_xor_b32 s53, s54, 1179648
MAV 44,12,64
TR 60,7,9440
TR 62,7,9952
s_waitcnt vmcnt(8) lgkmcnt(8)
MAV 32,32,80
TR 0,7,16640
MAV 32,48,88
buffer_load_dwordx4 v[64:67], v4, s[16:19], s52 offen sc1
MAV 48,48,92
TR 2,7,17152
MAV 48,32,84
TR 16,7,17664
TR 18,7,18176
MAV 52,36,84
TR 4,7,16672
MAV 52,52,92
buffer_load_dwordx4 v[68:71], v4, s[16:19], s52 offen offset:1024 sc1
MAV 36,52,88
TR 6,7,17184
s_xor_b32 s52, s54, 1310720
MAV 36,36,80
TR 20,7,17696
TR 22,7,18208
s_waitcnt lgkmcnt(8)
MAV 40,40,80
TR 8,7,16704
MAV 40,56,88
buffer_load_dwordx4 v[72:75], v4, s[16:19], s53 offen sc1
MAV 56,56,92
TR 10,7,17216
MAV 56,40,84
TR 24,7,17728
TR 26,7,18240
MAV 60,44,84
TR 12,7,16736
MAV 60,60,92
buffer_load_dwordx4 v[76:79], v4, s[16:19], s53 offen offset:1024 sc1
MAV 44,60,88
TR 14,7,17248
s_xor_b32 s53, s54, 1441792
MAV 44,44,80
TR 28,7,17760
TR 30,7,18272
s_waitcnt vmcnt(8) lgkmcnt(8)
MAV 32,0,96
TR 32,7,24960
MAV 32,16,104
buffer_load_dwordx4 v[80:83], v4, s[16:19], s52 offen sc1
MAV 48,16,108
TR 34,7,25472
MAV 48,0,100
TR 48,7,25984
TR 50,7,26496
MAV 52,4,100
TR 36,7,24992
MAV 52,20,108
buffer_load_dwordx4 v[84:87], v4, s[16:19], s52 offen offset:1024 sc1
MAV 36,20,104
TR 38,7,25504
s_xor_b32 s52, s54, 1572864
MAV 36,4,96
TR 52,7,26016
TR 54,7,26528
s_waitcnt lgkmcnt(8)
MAV 40,8,96
TR 40,7,25024
MAV 40,24,104
buffer_load_dwordx4 v[88:91], v4, s[16:19], s53 offen sc1
MAV 56,24,108
TR 42,7,25536
MAV 56,8,100
TR 56,7,26048
TR 58,7,26560
MAV 60,12,100
TR 44,7,25056
MAV 60,28,108
buffer_load_dwordx4 v[92:95], v4, s[16:19], s53 offen offset:1024 sc1
MAV 44,28,104
TR 46,7,25568
s_xor_b32 s53, s54, 1703936
MAV 44,12,96
TR 60,7,26080
TR 62,7,26592
s_waitcnt vmcnt(8) lgkmcnt(8)
MAV 32,32,112
TR 0,7,33280
MAV 32,48,120
buffer_load_dwordx4 v[96:99], v4, s[16:19], s52 offen sc1
MAV 48,48,124
TR 2,7,33792
MAV 48,32,116
TR 16,7,34304
TR 18,7,34816
MAV 52,36,116
TR 4,7,33312
MAV 52,52,124
buffer_load_dwordx4 v[100:103], v4, s[16:19], s52 offen offset:1024 sc1
MAV 36,52,120
TR 6,7,33824
s_xor_b32 s52, s54, 1835008
MAV 36,36,112
TR 20,7,34336
TR 22,7,34848
s_waitcnt lgkmcnt(8)
MAV 40,40,112
TR 8,7,33344
MAV 40,56,120
buffer_load_dwordx4 v[104:107], v4, s[16:19], s53 offen sc1
MAV 56,56,124
TR 10,7,33856
MAV 56,40,116
TR 24,7,34368
TR 26,7,34880
MAV 60,44,116
TR 12,7,33376
MAV 60,60,124
buffer_load_dwordx4 v[108:111], v4, s[16:19], s53 offen offset:1024 sc1
MAV 44,60,120
TR 14,7,33888
s_xor_b32 s53, s54, 1966080
MAV 44,44,112
TR 28,7,34400
TR 30,7,34912
s_waitcnt vmcnt(8) lgkmcnt(8)
MAV 32,0,64
TR 32,7,41600
MAV 32,16,72
buffer_load_dwordx4 v[112:115], v4, s[16:19], s52 offen sc1
MAV 48,16,76
TR 34,7,42112
MAV 48,0,68
TR 48,7,42624
TR 50,7,43136
MAV 52,4,68
TR 36,7,41632
MAV 52,20,76
buffer_load_dwordx4 v[116:119], v4, s[16:19], s52 offen offset:1024 sc1
MAV 36,20,72
TR 38,7,42144
s_xor_b32 s52, s54, 2097152
MAV 36,4,64
TR 52,7,42656
TR 54,7,43168
s_waitcnt lgkmcnt(8)
MAV 40,8,64
TR 40,7,41664
MAV 40,24,72
buffer_load_dwordx4 v[120:123], v4, s[16:19], s53 offen sc1
MAV 56,24,76
TR 42,7,42176
MAV 56,8,68
TR 56,7,42688
TR 58,7,43200
MAV 60,12,68
TR 44,7,41696
MAV 60,28,76
buffer_load_dwordx4 v[124:127], v4, s[16:19], s53 offen offset:1024 sc1
MAV 44,28,72
TR 46,7,42208
s_xor_b32 s53, s54, 2228224
MAV 44,12,64
TR 60,7,42720
TR 62,7,43232
s_waitcnt vmcnt(8) lgkmcnt(8)
MAV 32,32,80
TR 0,7,49920
MAV 32,48,88
buffer_load_dwordx4 v[64:67], v4, s[16:19], s52 offen sc1
MAV 48,48,92
TR 2,7,50432
MAV 48,32,84
TR 16,7,50944
TR 18,7,51456
MAV 52,36,84
TR 4,7,49952
MAV 52,52,92
buffer_load_dwordx4 v[68:71], v4, s[16:19], s52 offen offset:1024 sc1
MAV 36,52,88
TR 6,7,50464
s_xor_b32 s52, s54, 2359296
MAV 36,36,80
TR 20,7,50976
TR 22,7,51488
s_waitcnt lgkmcnt(8)
MAV 40,40,80
TR 8,7,49984
MAV 40,56,88
buffer_load_dwordx4 v[72:75], v4, s[16:19], s53 offen sc1
MAV 56,56,92
TR 10,7,50496
MAV 56,40,84
TR 24,7,51008
TR 26,7,51520
MAV 60,44,84
TR 12,7,50016
MAV 60,60,92
buffer_load_dwordx4 v[76:79], v4, s[16:19], s53 offen offset:1024 sc1
MAV 44,60,88
TR 14,7,50528
s_xor_b32 s53, s54, 2490368
MAV 44,44,80
TR 28,7,51040
TR 30,7,51552
s_waitcnt vmcnt(8) lgkmcnt(8)
MAV 32,0,96
TR 32,7,58240
MAV 32,16,104
buffer_load_dwordx4 v[80:83], v4, s[16:19], s52 offen sc1
MAV 48,16,108
TR 34,7,58752
MAV 48,0,100
TR 48,7,59264
TR 50,7,59776
MAV 52,4,100
TR 36,7,58272
MAV 52,20,108
buffer_load_dwordx4 v[84:87], v4, s[16:19], s52 offen offset:1024 sc1
MAV 36,20,104
TR 38,7,58784
s_xor_b32 s52, s54, 2621440
MAV 36,4,96
TR 52,7,59296
TR 54,7,59808
s_waitcnt lgkmcnt(8)
MAV 40,8,96
TR 40,7,58304
MAV 40,24,104
buffer_load_dwordx4 v[88:91], v4, s[16:19], s53 offen sc1
MAV 56,24,108
TR 42,7,58816
MAV 56,8,100
TR 56,7,59328
TR 58,7,59840
MAV 60,12,100
TR 44,7,58336
MAV 60,28,108
buffer_load_dwordx4 v[92:95], v4, s[16:19], s53 offen offset:1024 sc1
MAV 44,28,104
TR 46,7,58848
s_xor_b32 s53, s54, 2752512
MAV 44,12,96
TR 60,7,59360
TR 62,7,59872
s_xor_b32 s57, s57, 66560
v_add_u32 v7, s57, v8
s_waitcnt vmcnt(8) lgkmcnt(8)
MAV 32,32,112
ds_read_b64_tr_b16 a[0:1], v7
MAV 32,48,120
buffer_load_dwordx4 v[96:99], v4, s[16:19], s52 offen sc1
MAV 48,48,124
TR 2,7,512
MAV 48,32,116
TR 16,7,1024
TR 18,7,1536
MAV 52,36,116
TR 4,7,32
MAV 52,52,124
buffer_load_dwordx4 v[100:103], v4, s[16:19], s52 offen offset:1024 sc1
MAV 36,52,120
TR 6,7,544
s_xor_b32 s52, s54, 2883584
MAV 36,36,112
TR 20,7,1056
TR 22,7,1568
s_waitcnt lgkmcnt(8)
MAV 40,40,112
TR 8,7,64
MAV 40,56,120
buffer_load_dwordx4 v[104:107], v4, s[16:19], s53 offen sc1
MAV 56,56,124
TR 10,7,576
MAV 56,40,116
TR 24,7,1088
TR 26,7,1600
MAV 60,44,116
TR 12,7,96
MAV 60,60,124
buffer_load_dwordx4 v[108:111], v4, s[16:19], s53 offen offset:1024 sc1
MAV 44,60,120
TR 14,7,608
s_xor_b32 s53, s54, 3014656
MAV 44,44,112
TR 28,7,1120
TR 30,7,1632
s_waitcnt vmcnt(8) lgkmcnt(8)
MAV 32,0,64
TR 32,7,8320
MAV 32,16,72
buffer_load_dwordx4 v[112:115], v4, s[16:19], s52 offen sc1
MAV 48,16,76
TR 34,7,8832
MAV 48,0,68
TR 48,7,9344
TR 50,7,9856
MAV 52,4,68
TR 36,7,8352
MAV 52,20,76
buffer_load_dwordx4 v[116:119], v4, s[16:19], s52 offen offset:1024 sc1
MAV 36,20,72
TR 38,7,8864
s_xor_b32 s52, s54, 3145728
MAV 36,4,64
TR 52,7,9376
TR 54,7,9888
s_waitcnt lgkmcnt(8)
MAV 40,8,64
TR 40,7,8384
MAV 40,24,72
buffer_load_dwordx4 v[120:123], v4, s[16:19], s53 offen sc1
MAV 56,24,76
TR 42,7,8896
MAV 56,8,68
TR 56,7,9408
TR 58,7,9920
MAV 60,12,68
TR 44,7,8416
MAV 60,28,76
buffer_load_dwordx4 v[124:127], v4, s[16:19], s53 offen offset:1024 sc1
MAV 44,28,72
TR 46,7,8928
s_xor_b32 s53, s54, 3276800
MAV 44,12,64
TR 60,7,9440
TR 62,7,9952
s_waitcnt vmcnt(8) lgkmcnt(8)
MAV 32,32,80
TR 0,7,16640
MAV 32,48,88
buffer_load_dwordx4 v[64:67], v4, s[16:19], s52 offen sc1
MAV 48,48,92
TR 2,7,17152
MAV 48,32,84
TR 16,7,17664
TR 18,7,18176
MAV 52,36,84
TR 4,7,16672
MAV 52,52,92
buffer_load_dwordx4 v[68:71], v4, s[16:19], s52 offen offset:1024 sc1
MAV 36,52,88
TR 6,7,17184
s_xor_b32 s52, s54, 3407872
MAV 36,36,80
TR 20,7,17696
TR 22,7,18208
s_waitcnt lgkmcnt(8)
MAV 40,40,80
TR 8,7,16704
MAV 40,56,88
buffer_load_dwordx4 v[72:75], v4, s[16:19], s53 offen sc1
MAV 56,56,92
TR 10,7,17216
MAV 56,40,84
TR 24,7,17728
TR 26,7,18240
MAV 60,44,84
TR 12,7,16736
MAV 60,60,92
buffer_load_dwordx4 v[76:79], v4, s[16:19], s53 offen offset:1024 sc1
MAV 44,60,88
TR 14,7,17248
s_xor_b32 s53, s54, 3538944
MAV 44,44,80
TR 28,7,17760
TR 30,7,18272
s_waitcnt vmcnt(8) lgkmcnt(8)
MAV 32,0,96
TR 32,7,24960
MAV 32,16,104
buffer_load_dwordx4 v[80:83], v4, s[16:19], s52 offen sc1
MAV 48,16,108
TR 34,7,25472
MAV 48,0,100
TR 48,7,25984
TR 50,7,26496
MAV 52,4,100
TR 36,7,24992
MAV 52,20,108
buffer_load_dwordx4 v[84:87], v4, s[16:19], s52 offen offset:1024 sc1
MAV 36,20,104
TR 38,7,25504
s_xor_b32 s52, s54, 3670016
MAV 36,4,96
TR 52,7,26016
TR 54,7,26528
s_waitcnt lgkmcnt(8)
MAV 40,8,96
TR 40,7,25024
MAV 40,24,104
buffer_load_dwordx4 v[88:91], v4, s[16:19], s53 offen sc1
MAV 56,24,108
TR 42,7,25536
MAV 56,8,100
TR 56,7,26048
TR 58,7,26560
MAV 60,12,100
TR 44,7,25056
MAV 60,28,108
buffer_load_dwordx4 v[92:95], v4, s[16:19], s53 offen offset:1024 sc1
MAV 44,28,104
TR 46,7,25568
s_xor_b32 s53, s54, 3801088
MAV 44,12,96
TR 60,7,26080
TR 62,7,26592
s_waitcnt vmcnt(8) lgkmcnt(8)
MAV 32,32,112
TR 0,7,33280
MAV 32,48,120
buffer_load_dwordx4 v[96:99], v4, s[16:19], s52 offen sc1
MAV 48,48,124
TR 2,7,33792
MAV 48,32,116
TR 16,7,34304
TR 18,7,34816
MAV 52,36,116
TR 4,7,33312
MAV 52,52,124
buffer_load_dwordx4 v[100:103], v4, s[16:19], s52 offen offset:1024 sc1
MAV 36,52,120
TR 6,7,33824
s_xor_b32 s52, s54, 3932160
MAV 36,36,112
TR 20,7,34336
TR 22,7,34848
s_waitcnt lgkmcnt(8)
MAV 40,40,112
TR 8,7,33344
MAV 40,56,120
buffer_load_dwordx4 v[104:107], v4, s[16:19], s53 offen sc1
MAV 56,56,124
TR 10,7,33856
MAV 56,40,116
TR 24,7,34368
TR 26,7,34880
MAV 60,44,116
TR 12,7,33376
MAV 60,60,124
buffer_load_dwordx4 v[108:111], v4, s[16:19], s53 offen offset:1024 sc1
MAV 44,60,120
TR 14,7,33888
s_xor_b32 s53, s54, 4063232
MAV 44,44,112
TR 28,7,34400
TR 30,7,34912
s_waitcnt vmcnt(8) lgkmcnt(8)
.Lpad1:
s_cbranch_execz .Lpad4
MAV 32,0,64
TR 32,7,41600
MAV 32,16,72
buffer_load_dwordx4 v[112:115], v4, s[16:19], s52 offen sc1
MAV 48,16,76
TR 34,7,42112
MAV 48,0,68
TR 48,7,42624
TR 50,7,43136
MAV 52,4,68
TR 36,7,41632
MAV 52,20,76
buffer_load_dwordx4 v[116:119], v4, s[16:19], s52 offen offset:1024 sc1
MAV 36,20,72
TR 38,7,42144
MAV 36,4,64
TR 52,7,42656
TR 54,7,43168
s_waitcnt lgkmcnt(8)
MAV 40,8,64
TR 40,7,41664
MAV 40,24,72
buffer_load_dwordx4 v[120:123], v4, s[16:19], s53 offen sc1
MAV 56,24,76
TR 42,7,42176
MAV 56,8,68
TR 56,7,42688
TR 58,7,43200
MAV 60,12,68
TR 44,7,41696
MAV 60,28,76
buffer_load_dwordx4 v[124:127], v4, s[16:19], s53 offen offset:1024 sc1
MAV 44,28,72
TR 46,7,42208
MAV 44,12,64
TR 60,7,42720
TR 62,7,43232
s_barrier
s_waitcnt vmcnt(8) lgkmcnt(8)
MAV 32,32,80
TR 0,7,49920
s_add_u32 m0, s59, 84480
MAV 32,48,88
buffer_load_dwordx4 v12, s[32:35], s58 offen   lds
MAV 48,48,92
TR 2,7,50432
MAV 48,32,84
TR 16,7,50944
TR 18,7,51456
MAV 52,36,84
TR 4,7,49952
MAV 52,52,92
buffer_load_dwordx4 v13, s[32:35], s58 offen offset:1056   lds
MAV 36,52,88
TR 6,7,50464
MAV 36,36,80
TR 20,7,50976
TR 22,7,51488
s_waitcnt lgkmcnt(8)
MAV 40,40,80
TR 8,7,49984
MAV 40,56,88
buffer_load_dwordx4 v14, s[32:35], s58 offen offset:2112   lds
MAV 56,56,92
TR 10,7,50496
MAV 56,40,84
TR 24,7,51008
TR 26,7,51520
MAV 60,44,84
TR 12,7,50016
MAV 60,60,92
buffer_load_dwordx4 v15, s[32:35], s58 offen offset:3168   lds
MAV 44,60,88
TR 14,7,50528
MAV 44,44,80
TR 28,7,51040
TR 30,7,51552
s_waitcnt vmcnt(8) lgkmcnt(8)
MAV 32,0,96
TR 32,7,58240
s_add_u32 m0, s59, 101376
MAV 32,16,104
buffer_load_dwordx4 v12, s[80:83], s58 offen   lds
MAV 48,16,108
TR 34,7,58752
MAV 48,0,100
TR 48,7,59264
TR 50,7,59776
MAV 52,4,100
TR 36,7,58272
MAV 52,20,108
buffer_load_dwordx4 v13, s[80:83], s58 offen offset:1056   lds
MAV 36,20,104
TR 38,7,58784
MAV 36,4,96
TR 52,7,59296
TR 54,7,59808
s_waitcnt lgkmcnt(8)
MAV 40,8,96
TR 40,7,58304
MAV 40,24,104
buffer_load_dwordx4 v14, s[80:83], s58 offen offset:2112   lds
MAV 56,24,108
TR 42,7,58816
MAV 56,8,100
TR 56,7,59328
TR 58,7,59840
MAV 60,12,100
TR 44,7,58336
MAV 60,28,108
buffer_load_dwordx4 v15, s[80:83], s58 offen offset:3168   lds
MAV 44,28,104
TR 46,7,58848
s_add_u32 s58, s58, 458752
MAV 44,12,96
TR 60,7,59360
TR 62,7,59872
s_waitcnt vmcnt(11) lgkmcnt(14)
MAV 32,32,112
s_add_u32 m0, s59, 118272
s_lshl_b32 s64, s6, 14
s_lshl_b32 s65, s49, 13
s_waitcnt vmcnt(9) lgkmcnt(12)
MAV 32,48,120
buffer_load_dwordx4 v12, s[32:35], s58 offen   lds
s_waitcnt vmcnt(9)
MAV 48,48,124
s_add_u32 s64, s64, s65
s_lshl_b32 s65, s7, 9
s_add_u32 s64, s64, s65
MAV 48,32,116
s_lshl_b32 s65, s48, 8
s_add_u32 s64, s64, s65
s_add_u32 s64, s64, 29622272
s_waitcnt lgkmcnt(10)
MAV 52,36,116
s_lshl_b32 s62, s7, 18
v_and_b32 v152, 31, v1
v_lshlrev_b32 v152, 3, v152
s_waitcnt lgkmcnt(8)
MAV 52,52,124
buffer_load_dwordx4 v13, s[32:35], s58 offen offset:1056   lds
MAV 36,52,120
s_add_u32 s62, s62, 8388608
v_lshrrev_b32 v153, 5, v1
v_lshl_add_u32 v152, v153, 28, v152
MAV 36,36,112
s_add_u32 s63, s62, 131072
v_cvt_pk_bf16_f32 v128, v32, v33
v_cvt_pk_bf16_f32 v129, v34, v35
s_waitcnt lgkmcnt(6)
MAV 40,40,112
v_cvt_pk_bf16_f32 v136, v48, v49
v_cvt_pk_bf16_f32 v137, v50, v51
s_waitcnt lgkmcnt(4)
MAV 40,56,120
buffer_load_dwordx4 v14, s[32:35], s58 offen offset:2112   lds
MAV 56,56,124
v_cvt_pk_bf16_f32 v130, v36, v37
v_cvt_pk_bf16_f32 v131, v38, v39
MAV 56,40,116
v_cvt_pk_bf16_f32 v138, v52, v53
v_cvt_pk_bf16_f32 v139, v54, v55
s_waitcnt lgkmcnt(2)
MAV 60,44,116
v_cvt_pk_bf16_f32 v132, v40, v41
v_cvt_pk_bf16_f32 v133, v42, v43
s_waitcnt lgkmcnt(0)
MAV 60,60,124
buffer_load_dwordx4 v15, s[32:35], s58 offen offset:3168   lds
MAV 44,60,120
v_cvt_pk_bf16_f32 v140, v56, v57
v_cvt_pk_bf16_f32 v141, v58, v59
MAV 44,44,112
s_nop 2
v_cvt_pk_bf16_f32 v142, v60, v61
v_cvt_pk_bf16_f32 v143, v62, v63
v_pk_mul_f32 v[146:147], v[32:33], v[32:33]
buffer_store_dwordx4 v[128:131], v4, s[16:19], s62 offen sc1
v_pk_mul_f32 v[150:151], v[48:49], v[48:49]
v_pk_fma_f32 v[146:147], v[34:35], v[34:35], v[146:147]
v_pk_add_f32 v[144:145], v[32:33], v[34:35]
v_pk_fma_f32 v[150:151], v[50:51], v[50:51], v[150:151]
v_cvt_pk_bf16_f32 v134, v44, v45
v_cvt_pk_bf16_f32 v135, v46, v47
v_pk_add_f32 v[148:149], v[48:49], v[50:51]
v_pk_fma_f32 v[146:147], v[36:37], v[36:37], v[146:147]
v_pk_add_f32 v[144:145], v[144:145], v[36:37]
v_pk_fma_f32 v[150:151], v[52:53], v[52:53], v[150:151]
v_pk_add_f32 v[148:149], v[148:149], v[52:53]
v_pk_fma_f32 v[146:147], v[38:39], v[38:39], v[146:147]
v_pk_add_f32 v[144:145], v[144:145], v[38:39]
buffer_store_dwordx4 v[132:135], v4, s[16:19], s63 offen sc1
v_pk_fma_f32 v[150:151], v[54:55], v[54:55], v[150:151]
v_pk_add_f32 v[148:149], v[148:149], v[54:55]
v_pk_fma_f32 v[146:147], v[40:41], v[40:41], v[146:147]
v_pk_add_f32 v[144:145], v[144:145], v[40:41]
v_pk_fma_f32 v[150:151], v[56:57], v[56:57], v[150:151]
v_pk_add_f32 v[148:149], v[148:149], v[56:57]
v_pk_fma_f32 v[146:147], v[42:43], v[42:43], v[146:147]
v_pk_add_f32 v[144:145], v[144:145], v[42:43]
v_pk_fma_f32 v[150:151], v[58:59], v[58:59], v[150:151]
v_pk_add_f32 v[148:149], v[148:149], v[58:59]
v_pk_fma_f32 v[146:147], v[44:45], v[44:45], v[146:147]
v_pk_add_f32 v[144:145], v[144:145], v[44:45]
v_pk_fma_f32 v[150:151], v[60:61], v[60:61], v[150:151]
buffer_store_dwordx4 v[136:139], v4, s[16:19], s62 offen offset:1024 sc1
v_pk_add_f32 v[148:149], v[148:149], v[60:61]
v_pk_fma_f32 v[146:147], v[46:47], v[46:47], v[146:147]
v_pk_add_f32 v[144:145], v[144:145], v[46:47]
v_pk_fma_f32 v[150:151], v[62:63], v[62:63], v[150:151]
v_pk_add_f32 v[148:149], v[148:149], v[62:63]
v_add_f32 v144, v144, v145
v_add_f32 v146, v146, v147
v_add_f32 v148, v148, v149
v_add_f32 v150, v150, v151
s_nop 0
v_permlane16_swap_b32 v144, v148
buffer_store_dwordx4 v[140:143], v4, s[16:19], s63 offen offset:1024 sc1
v_permlane16_swap_b32 v146, v150
v_add_f32 v144, v144, v148
v_add_f32 v146, v146, v150
s_nop 1
v_permlane32_swap_b32 v144, v146
v_add_f32 v144, v144, v146
s_nop 1
v_permlane32_swap_b32 v144, v145
buffer_store_dwordx2 v[144:145], v152, s[16:19], s64 offen sc1
s_nop 1
v_accvgpr_write_b32 a224, v32
v_accvgpr_write_b32 a225, v33
v_accvgpr_write_b32 a226, v34
v_accvgpr_write_b32 a227, v35
v_accvgpr_write_b32 a228, v36
v_accvgpr_write_b32 a229, v37
v_accvgpr_write_b32 a230, v38
v_accvgpr_write_b32 a231, v39
v_accvgpr_write_b32 a232, v40
v_accvgpr_write_b32 a233, v41
v_accvgpr_write_b32 a234, v42
v_accvgpr_write_b32 a235, v43
v_accvgpr_write_b32 a236, v44
v_accvgpr_write_b32 a237, v45
v_accvgpr_write_b32 a238, v46
v_accvgpr_write_b32 a239, v47
v_accvgpr_write_b32 a240, v48
v_accvgpr_write_b32 a241, v49
v_accvgpr_write_b32 a242, v50
v_accvgpr_write_b32 a243, v51
v_accvgpr_write_b32 a244, v52
v_accvgpr_write_b32 a245, v53
v_accvgpr_write_b32 a246, v54
v_accvgpr_write_b32 a247, v55
v_accvgpr_write_b32 a248, v56
v_accvgpr_write_b32 a249, v57
v_accvgpr_write_b32 a250, v58
v_accvgpr_write_b32 a251, v59
v_accvgpr_write_b32 a252, v60
v_accvgpr_write_b32 a253, v61
v_accvgpr_write_b32 a254, v62
v_accvgpr_write_b32 a255, v63
s_lshl_b32 s62, s10, 14
s_lshl_b32 s63, s3, 12
s_add_u32 s62, s62, s63
s_lshl_b32 s63, s12, 11
s_add_u32 s62, s62, s63
v_lshl_add_u32 v10, v1, 4, s62
v_lshrrev_b32 v2, 3, v1
v_cmp_eq_u32 vcc, 3, v2
v_add_u32 v2, 67108480, v10
s_nop 0
v_cndmask_b32 v10, v10, v2, vcc
v_xor_b32 v11, 2048, v10
v_bfe_u32 v16, v1, 2, 3
v_mul_u32_u24 v16, 1056, v16
v_bfe_u32 v2, v1, 5, 1
v_lshl_add_u32 v16, v2, 8, v16
v_and_b32 v2, 3, v1
v_lshl_add_u32 v16, v2, 3, v16
s_lshl_b32 s62, s12, 6
s_add_u32 s62, s62, 84480
s_xor_b32 s63, s12, 1
s_mul_i32 s63, s63, 192
s_add_u32 s63, s63, 84480
v_add_u32 v17, s63, v16
v_add_u32 v16, s62, v16
s_mov_b32 s52, 8388608
s_mov_b32 s53, 8388608
s_mov_b32 s54, s58
s_mov_b32 s55, s59
s_mul_i32 s59, s3, 2112
s_and_b32 s62, s7, 1
s_mul_i32 s62, s62, 3670016
s_lshr_b32 s63, s7, 1
s_lshl_b32 s63, s63, 8
s_add_u32 s62, s62, s63
s_lshl_b32 s63, s3, 12
s_add_u32 s62, s62, s63
v_lshrrev_b32 v5, 4, v1
v_lshlrev_b32 v5, 14, v5
v_and_b32 v2, 15, v1
v_lshl_add_u32 v5, v2, 4, v5
v_add_u32 v5, s62, v5
v_add_u32 v6, 992, v5
s_lshl_b32 s62, s10, 15
s_lshl_b32 s63, s3, 13
s_add_u32 s62, s62, s63
v_lshl_add_u32 v4, v1, 4, s62
s_and_b32 s47, s5, 3
s_lshr_b32 s63, s5, 2
s_lshl_b32 s63, s63, 3
s_add_u32 s63, s63, s4
s_lshl_b32 s62, s63, 1
s_add_u32 s62, s62, s48
s_mul_i32 s62, s62, 1792
v_lshrrev_b32 v7, 2, v1
v_min_u32 v8, 13, v7
v_lshl_add_u32 v8, v8, 7, s62
s_lshl_b32 s62, s63, 2
s_add_u32 s62, s62, s3
s_mul_i32 s62, s62, 640
v_and_b32 v7, 7, v7
v_min_u32 v7, 4, v7
v_lshl_add_u32 v7, v7, 7, s62
v_lshrrev_b32 v2, 5, v1
v_mul_u32_u24 v2, 3670016, v2
v_add_u32 v7, v7, v2
s_mul_i32 s44, s47, 163840
s_add_u32 s45, s47, 12
s_mul_i32 s45, s45, 229376
v_and_b32 v6, 3, v1
v_cmp_eq_u32 vcc, 3, v6
v_mov_b32 v2, 0x3f80
v_mov_b32 v20, 1.0
v_cndmask_b32 v2, v2, v20, vcc
v_cndmask_b32 v6, v6, 0, vcc
v_or_b32 v6, 12, v6
v_mul_u32_u24 v6, 0x1111, v6
v_lshl_or_b32 v6, v6, 16, v6
v_bfe_u32 v22, v1, 2, 2
v_cmp_eq_u32 vcc, 0, v22
s_nop 1
v_cndmask_b32 v20, 0, v2, vcc
v_cmp_eq_u32 vcc, 1, v22
s_nop 1
v_cndmask_b32 v21, 0, v2, vcc
v_accvgpr_write_b32 a208, v20
v_accvgpr_write_b32 a209, v21
v_accvgpr_write_b32 a210, v20
v_accvgpr_write_b32 a211, v21
v_accvgpr_write_b32 a212, 0
v_accvgpr_write_b32 a213, 0
v_accvgpr_write_b32 a214, 0
v_accvgpr_write_b32 a215, 0
v_accvgpr_write_b32 a216, 0
v_accvgpr_write_b32 a217, 0
v_accvgpr_write_b32 a218, 0
v_accvgpr_write_b32 a219, 0
s_cmp_lt_u32 s3, 2
s_cselect_b32 s40, s32, s80
s_cselect_b32 s41, s33, s81
s_cselect_b32 s42, s34, s82
s_add_u32 s62, s55, 84480
v_lshl_add_u32 v9, v1, 4, s62
s_lshl_b32 s62, s6, 10
s_add_u32 s62, s62, 30441472
s_lshl_b32 s64, s10, 1
s_lshl_b32 s64, s64, 10
s_add_u32 s64, s64, 30441472
s_lshr_b32 s67, s5, 2
s_and_b32 s67, s67, 3
s_lshl_b32 s67, s67, 7
s_add_u32 s64, s64, s67
s_add_u32 s65, s64, 1024
v_lshl_add_u32 v252, v1, 7, s62
v_mov_b32 v253, s64
v_mov_b32 v255, 1
v_writelane_b32 v253, s65, 1
s_waitcnt vmcnt(0) lgkmcnt(0)
s_cmp_lg_u32 s3, 1
s_barrier
s_cbranch_scc1 .Lnopoll37
s_mov_b64 exec, 15
buffer_atomic_add v255, v252, s[16:19], 0 offen
s_mov_b64 exec, 3
v_mov_b32 v254, 0
buffer_atomic_add v254, v253, s[16:19], 0 offen sc0
s_sleep 5
s_mov_b32 s15, 0
.Lpoll36:
v_mov_b32 v255, 0
buffer_atomic_add v255, v253, s[16:19], 0 offen sc0
s_waitcnt vmcnt(1)
v_cmp_gt_u32 vcc, 16, v254
s_add_u32 s15, s15, 1
s_cbranch_vccz .Lnopoll37r
v_mov_b32 v254, 0
buffer_atomic_add v254, v253, s[16:19], 0 offen sc0
s_waitcnt vmcnt(1)
v_cmp_gt_u32 vcc, 16, v255
s_add_u32 s15, s15, 1
s_cbranch_vccz .Lnopoll37r
s_cmp_le_u32 s15, 100000
s_cbranch_scc1 .Lpoll36
s_branch .Lnopoll37r
.Lnopoll37:
s_mov_b64 exec, 0
s_cmp_eq_u32 s3, 2
s_cbranch_scc1 .Lpad6
s_cmp_eq_u32 s3, 3
s_cbranch_scc1 .Lpad7
s_branch .Lpad8
.Lnopoll37r:
s_mov_b64 exec, -1
s_barrier
buffer_load_dwordx4 a[128:131], v10, s[16:19], s52 offen sc1
buffer_load_dwordx4 a[132:135], v10, s[16:19], s52 offen offset:1024 sc1
s_add_u32 s52, s52, 131072
buffer_load_dwordx4 a[144:147], v10, s[16:19], s52 offen sc1
buffer_load_dwordx4 a[148:151], v10, s[16:19], s52 offen offset:1024 sc1
s_add_u32 s52, s52, 131072
buffer_load_dwordx4 a[136:139], v11, s[16:19], s53 offen sc1
buffer_load_dwordx4 a[140:143], v11, s[16:19], s53 offen offset:1024 sc1
s_add_u32 s53, s53, 131072
buffer_load_dwordx4 a[152:155], v11, s[16:19], s53 offen sc1
buffer_load_dwordx4 a[156:159], v11, s[16:19], s53 offen offset:1024 sc1
s_add_u32 s53, s53, 131072
ds_read_b64_tr_b16 a[0:1], v16
TR 2,16,512
TR 4,16,8448
TR 6,16,8960
TR 8,16,32
TR 10,16,544
TR 12,16,8480
TR 14,16,8992
TR 16,16,64
TR 18,16,576
TR 20,16,8512
TR 22,16,9024
TR 24,16,96
TR 26,16,608
TR 28,16,8544
TR 30,16,9056
TR 32,16,128
TR 34,16,640
TR 36,16,8576
TR 38,16,9088
TR 40,16,160
TR 42,16,672
TR 44,16,8608
TR 46,16,9120
ds_read_b64_tr_b16 a[48:49], v17
TR 50,17,512
TR 52,17,8448
TR 54,17,8960
TR 56,17,32
TR 58,17,544
TR 60,17,8480
TR 62,17,8992
ds_read_b128 a[192:195], v9
RD 196,9,1056
RD 200,9,2112
RD 204,9,3168
s_add_u32 m0, s55, 135168
s_nop 0
buffer_load_dwordx4 v12, s[80:83], s54 offen   lds
buffer_load_dwordx4 v13, s[80:83], s54 offen offset:1056   lds
buffer_load_dwordx4 v14, s[80:83], s54 offen offset:2112   lds
buffer_load_dwordx4 v15, s[80:83], s54 offen offset:3168   lds
s_add_u32 s54, s54, 458752
s_lshl_b32 s57, s3, 13
s_add_u32 s57, s57, 49920
v_lshl_add_u32 v2, v1, 4, s57
s_waitcnt lgkmcnt(0)
s_barrier
s_waitcnt vmcnt(11)
v_mfma_f32_16x16x32_bf16 v[32:35], a[0:3], a[128:131], 0
buffer_load_dwordx4 a[160:163], v10, s[16:19], s52 offen sc1
s_waitcnt vmcnt(10)
MAA 32,4,144
TR 64,16,16896
v_smfmac_f32_16x16x64_bf16 a[212:215], a[208:211], a[192:199], v6
TR 66,16,17408
v_smfmac_f32_16x16x64_bf16 a[212:215], a[208:211], a[200:207], v6
TR 68,16,25344
v_mfma_f32_16x16x32_bf16 v[36:39], a[0:3], a[132:135], 0
TR 70,16,25856
s_waitcnt vmcnt(9)
MAA 36,4,148
buffer_load_dwordx4 a[164:167], v10, s[16:19], s52 offen offset:1024 sc1
v_mfma_f32_16x16x32_bf16 v[52:55], a[8:11], a[132:135], 0
TR 72,16,16928
s_add_u32 s52, s52, 131072
MAA 52,12,148
TR 74,16,17440
v_mfma_f32_16x16x32_bf16 v[48:51], a[8:11], a[128:131], 0
TR 76,16,25376
MAA 48,12,144
TR 78,16,25888
v_mfma_f32_16x16x32_bf16 v[96:99], a[16:19], a[128:131], 0
buffer_load_dwordx4 a[176:179], v10, s[16:19], s52 offen sc1
MAA 96,20,144
TR 80,16,16960
v_mfma_f32_16x16x32_bf16 v[100:103], a[16:19], a[132:135], 0
TR 82,16,17472
MAA 100,20,148
TR 84,16,25408
v_mfma_f32_16x16x32_bf16 v[116:119], a[24:27], a[132:135], 0
TR 86,16,25920
MAA 116,28,148
buffer_load_dwordx4 a[180:183], v10, s[16:19], s52 offen offset:1024 sc1
v_mfma_f32_16x16x32_bf16 v[112:115], a[24:27], a[128:131], 0
TR 88,16,16992
s_add_u32 s52, s52, 131072
MAA 112,28,144
TR 90,16,17504
v_mfma_f32_16x16x32_bf16 v[160:163], a[32:35], a[128:131], 0
TR 92,16,25440
MAA 160,36,144
TR 94,16,25952
v_mfma_f32_16x16x32_bf16 v[164:167], a[32:35], a[132:135], 0
buffer_load_dwordx4 a[168:171], v11, s[16:19], s53 offen sc1
MAA 164,36,148
TR 96,16,17024
v_mfma_f32_16x16x32_bf16 v[180:183], a[40:43], a[132:135], 0
TR 98,16,17536
MAA 180,44,148
TR 100,16,25472
v_mfma_f32_16x16x32_bf16 v[176:179], a[40:43], a[128:131], 0
TR 102,16,25984
MAA 176,44,144
buffer_load_dwordx4 a[172:175], v11, s[16:19], s53 offen offset:1024 sc1
v_mfma_f32_16x16x32_bf16 v[224:227], a[48:51], a[128:131], 0
TR 104,16,17056
s_add_u32 s53, s53, 131072
MAA 224,52,144
TR 106,16,17568
v_mfma_f32_16x16x32_bf16 v[228:231], a[48:51], a[132:135], 0
TR 108,16,25504
MAA 228,52,148
TR 110,16,26016
v_mfma_f32_16x16x32_bf16 v[236:239], a[56:59], a[132:135], 0
buffer_load_dwordx4 a[184:187], v11, s[16:19], s53 offen sc1
MAA 236,60,148
TR 112,17,16896
v_mfma_f32_16x16x32_bf16 v[232:235], a[56:59], a[128:131], 0
TR 114,17,17408
MAA 232,60,144
TR 116,17,25344
s_waitcnt vmcnt(11)
v_mfma_f32_16x16x32_bf16 v[188:191], a[40:43], a[140:143], 0
TR 118,17,25856
MAA 188,44,156
buffer_load_dwordx4 a[188:191], v11, s[16:19], s53 offen offset:1024 sc1
v_mfma_f32_16x16x32_bf16 v[184:187], a[40:43], a[136:139], 0
TR 120,17,16928
s_add_u32 s53, s53, 131072
MAA 184,44,152
TR 122,17,17440
s_add_u32 m0, s55, 84480
v_mfma_f32_16x16x32_bf16 v[168:171], a[32:35], a[136:139], 0
TR 124,17,25376
MAA 168,36,152
TR 126,17,25888
v_mfma_f32_16x16x32_bf16 v[172:175], a[32:35], a[140:143], 0
buffer_load_dwordx4 v12, s[32:35], s54 offen   lds
MAA 172,36,156
RD 192,9,16896
v_mfma_f32_16x16x32_bf16 v[124:127], a[24:27], a[140:143], 0
RD 196,9,17952
MAA 124,28,156
RD 200,9,19008
v_mfma_f32_16x16x32_bf16 v[120:123], a[24:27], a[136:139], 0
RD 204,9,20064
MAA 120,28,152
buffer_load_dwordx4 v13, s[32:35], s54 offen offset:1056   lds
v_mfma_f32_16x16x32_bf16 v[104:107], a[16:19], a[136:139], 0
MAA 104,20,152
v_mfma_f32_16x16x32_bf16 v[108:111], a[16:19], a[140:143], 0
MAA 108,20,156
v_mfma_f32_16x16x32_bf16 v[60:63], a[8:11], a[140:143], 0
buffer_load_dwordx4 v14, s[32:35], s54 offen offset:2112   lds
MAA 60,12,156
v_mfma_f32_16x16x32_bf16 v[56:59], a[8:11], a[136:139], 0
MAA 56,12,152
v_mfma_f32_16x16x32_bf16 v[40:43], a[0:3], a[136:139], 0
MAA 40,4,152
buffer_load_dwordx4 v15, s[32:35], s54 offen offset:3168   lds
.Lpad2:
s_cbranch_execz .Lpad5
v_mfma_f32_16x16x32_bf16 v[44:47], a[0:3], a[140:143], 0
MAA 44,4,156
s_waitcnt lgkmcnt(0)
s_barrier
v_mfma_f32_16x16x32_bf16 v[64:67], a[64:67], a[128:131], 0
TR 0,16,33792
s_add_u32 m0, s55, 101376
MAA 64,68,144
buffer_load_dwordx4 v12, s[80:83], s54 offen   lds
v_smfmac_f32_16x16x64_bf16 a[216:219], a[208:211], a[192:199], v6
TR 2,16,34304
s_mul_i32 s66, s13, 114688
v_smfmac_f32_16x16x64_bf16 a[216:219], a[208:211], a[200:207], v6
TR 4,16,42240
s_mul_i32 s65, s10, 1818624
v_mfma_f32_16x16x32_bf16 v[68:71], a[64:67], a[132:135], 0
TR 6,16,42752
s_add_u32 s66, s66, s65
MAA 68,68,148
TR 8,16,33824
s_add_u32 s66, s66, 12582912
v_mfma_f32_16x16x32_bf16 v[84:87], a[72:75], a[132:135], 0
buffer_load_dwordx4 v13, s[80:83], s54 offen offset:1056   lds
MAA 84,76,148
TR 10,16,34336
s_add_u32 s65, s66, 49152
v_mfma_f32_16x16x32_bf16 v[80:83], a[72:75], a[128:131], 0
TR 12,16,42272
s_lshl_b32 s62, s12, 16
MAA 80,76,144
TR 14,16,42784
s_add_u32 s62, s62, s66
v_mfma_f32_16x16x32_bf16 v[128:131], a[80:83], a[128:131], 0
TR 16,16,33856
s_add_u32 s63, s62, 16384
MAA 128,84,144
buffer_load_dwordx4 v14, s[80:83], s54 offen offset:2112   lds
v_mfma_f32_16x16x32_bf16 v[132:135], a[80:83], a[132:135], 0
TR 18,16,34368
s_add_u32 s64, s62, 32768
MAA 132,84,148
TR 20,16,42304
s_lshl_b32 s72, s10, 1
v_mfma_f32_16x16x32_bf16 v[148:151], a[88:91], a[132:135], 0
TR 22,16,42816
s_lshr_b32 s74, s11, 4
MAA 148,92,148
TR 24,16,33888
s_add_u32 s72, s72, s74
v_mfma_f32_16x16x32_bf16 v[144:147], a[88:91], a[128:131], 0
buffer_load_dwordx4 v15, s[80:83], s54 offen offset:3168   lds
MAA 144,92,144
TR 26,16,34400
s_add_u32 s54, s54, 458752
v_mfma_f32_16x16x32_bf16 v[192:195], a[96:99], a[128:131], 0
TR 28,16,42336
s_add_u32 m0, s57, 0
MAA 192,100,144
TR 30,16,42848
s_mov_b32 s58, 29622272
v_mfma_f32_16x16x32_bf16 v[196:199], a[96:99], a[132:135], 0
TR 32,16,33920
s_lshl_b32 s72, s72, 10
MAA 196,100,148
buffer_load_dwordx4 v4, s[16:19], s58 offen sc1 lds
v_mfma_f32_16x16x32_bf16 v[212:215], a[104:107], a[132:135], 0
TR 34,16,34432
s_add_u32 s72, s72, 30457856
MAA 212,108,148
TR 36,16,42368
s_and_b32 s73, s6, 14
v_mfma_f32_16x16x32_bf16 v[208:211], a[104:107], a[128:131], 0
TR 38,16,42880
s_and_b32 s74, s7, 1
MAA 208,108,144
TR 40,16,33952
s_add_u32 s73, s73, s74
v_mfma_f32_16x16x32_bf16 v[240:243], a[112:115], a[128:131], 0
buffer_load_dwordx4 v4, s[16:19], s58 offen offset:1024 sc1 lds
MAA 240,116,144
TR 42,16,34464
s_lshl_b32 s73, s73, 10
v_mfma_f32_16x16x32_bf16 v[244:247], a[112:115], a[132:135], 0
TR 44,16,42400
s_add_u32 s73, s73, 30457856
MAA 244,116,148
TR 46,16,42912
s_lshr_b32 s67, s5, 2
v_mfma_f32_16x16x32_bf16 v[252:255], a[120:123], a[132:135], 0
TR 48,17,33792
MAA 252,124,148
TR 50,17,34304
v_mfma_f32_16x16x32_bf16 v[248:251], a[120:123], a[128:131], 0
buffer_load_dwordx4 a[128:131], v10, s[16:19], s52 offen sc1
MAA 248,124,144
TR 52,17,42240
v_mfma_f32_16x16x32_bf16 v[220:223], a[104:107], a[140:143], 0
TR 54,17,42752
MAA 220,108,156
TR 56,17,33824
v_mfma_f32_16x16x32_bf16 v[216:219], a[104:107], a[136:139], 0
TR 58,17,34336
MAA 216,108,152
buffer_load_dwordx4 a[132:135], v10, s[16:19], s52 offen offset:1024 sc1
v_mfma_f32_16x16x32_bf16 v[200:203], a[96:99], a[136:139], 0
TR 60,17,42272
s_add_u32 s52, s52, 131072
MAA 200,100,152
TR 62,17,42784
v_mfma_f32_16x16x32_bf16 v[204:207], a[96:99], a[140:143], 0
RD 192,9,33792
MAA 204,100,156
RD 196,9,34848
v_mfma_f32_16x16x32_bf16 v[156:159], a[88:91], a[140:143], 0
buffer_load_dwordx4 a[144:147], v10, s[16:19], s52 offen sc1
MAA 156,92,156
RD 200,9,35904
v_mfma_f32_16x16x32_bf16 v[152:155], a[88:91], a[136:139], 0
RD 204,9,36960
MAA 152,92,152
v_mfma_f32_16x16x32_bf16 v[136:139], a[80:83], a[136:139], 0
MAA 136,84,152
buffer_load_dwordx4 a[148:151], v10, s[16:19], s52 offen offset:1024 sc1
v_mfma_f32_16x16x32_bf16 v[140:143], a[80:83], a[140:143], 0
s_add_u32 s52, s52, 131072
MAA 140,84,156
v_mfma_f32_16x16x32_bf16 v[92:95], a[72:75], a[140:143], 0
MAA 92,76,156
v_mfma_f32_16x16x32_bf16 v[88:91], a[72:75], a[136:139], 0
MAA 88,76,152
v_mfma_f32_16x16x32_bf16 v[72:75], a[64:67], a[136:139], 0
MAA 72,68,152
v_mfma_f32_16x16x32_bf16 v[76:79], a[64:67], a[140:143], 0
MAA 76,68,156
s_waitcnt vmcnt(18) lgkmcnt(0)
s_barrier
MAA 32,0,160
buffer_load_dwordx4 a[136:139], v11, s[16:19], s53 offen sc1
MAA 32,4,176
TR 64,16,50688
s_and_b32 s67, s67, 3
v_smfmac_f32_16x16x64_bf16 a[212:215], a[208:211], a[192:199], v6
TR 66,16,51200
s_lshl_b32 s67, s67, 7
v_smfmac_f32_16x16x64_bf16 a[212:215], a[208:211], a[200:207], v6
TR 68,16,59136
s_add_u32 s73, s73, s67
MAA 36,4,180
TR 70,16,59648
s_and_b32 s74, s7, 1
MAA 36,0,164
buffer_load_dwordx4 a[140:143], v11, s[16:19], s53 offen offset:1024 sc1
MAA 52,8,164
TR 72,16,50720
s_add_u32 s53, s53, 131072
MAA 52,12,180
TR 74,16,51232
s_mul_i32 s87, s74, 917504
MAA 48,12,176
TR 76,16,59168
s_lshr_b32 s75, s6, 1
MAA 48,8,160
TR 78,16,59680
s_mul_i32 s75, s75, 1818624
MAA 96,16,160
buffer_load_dwordx4 a[152:155], v11, s[16:19], s53 offen sc1
MAA 96,20,176
TR 80,16,50752
s_add_u32 s87, s87, s75
MAA 100,20,180
TR 82,16,51264
s_add_u32 s87, s87, 12582912
MAA 100,16,164
TR 84,16,59200
s_and_b32 s74, s6, 3
MAA 116,24,164
TR 86,16,59712
s_xor_b32 s75, s74, 0
MAA 116,28,180
buffer_load_dwordx4 a[156:159], v11, s[16:19], s53 offen offset:1024 sc1
MAA 112,28,176
TR 88,16,50784
s_add_u32 s53, s53, 131072
MAA 112,24,160
TR 90,16,51296
s_add_u32 m0, s55, 118272
MAA 160,32,160
TR 92,16,59232
s_sub_u32 s75, s75, 0
MAA 160,36,176
TR 94,16,59744
s_mul_i32 s98, s75, 458752
MAA 164,36,180
buffer_load_dwordx4 v12, s[32:35], s54 offen   lds
MAA 164,32,164
TR 96,16,50816
s_mul_i32 s75, s75, 114688
MAA 180,40,164
TR 98,16,51328
s_add_u32 s76, s87, s75
MAA 180,44,180
TR 100,16,59264
s_xor_b32 s75, s74, 1
MAA 176,44,176
TR 102,16,59776
s_sub_u32 s75, s75, 1
MAA 176,40,160
buffer_load_dwordx4 v13, s[32:35], s54 offen offset:1056   lds
MAA 224,48,160
TR 104,16,50848
s_mul_i32 s99, s75, 458752
MAA 224,52,176
TR 106,16,51360
s_mul_i32 s75, s75, 114688
MAA 228,52,180
TR 108,16,59296
s_add_u32 s77, s87, s75
MAA 228,48,164
TR 110,16,59808
MAA 236,56,164
buffer_load_dwordx4 v14, s[32:35], s54 offen offset:2112   lds
MAA 236,60,180
TR 112,17,50688
MAA 232,60,176
TR 114,17,51200
MAA 232,56,160
TR 116,17,59136
s_waitcnt vmcnt(21)
MAA 188,40,172
TR 118,17,59648
MAA 188,44,188
buffer_load_dwordx4 v15, s[32:35], s54 offen offset:3168   lds
MAA 184,44,184
TR 120,17,50720
s_add_u32 m0, s57, 2048
MAA 184,40,168
TR 122,17,51232
s_mov_b32 s58, 29624320
MAA 168,32,168
TR 124,17,59168
MAA 168,36,184
TR 126,17,59680
MAA 172,36,188
buffer_load_dwordx4 v4, s[16:19], s58 offen sc1 lds
MAA 172,32,172
RD 192,9,50688
MAA 124,24,172
RD 196,9,51744
MAA 124,28,188
RD 200,9,52800
MAA 120,28,184
RD 204,9,53856
MAA 120,24,168
buffer_load_dwordx4 v4, s[16:19], s58 offen offset:1024 sc1 lds
MAA 104,16,168
MAA 104,20,184
MAA 108,20,188
MAA 108,16,172
MAA 60,8,172
MAA 60,12,188
MAA 56,12,184
MAA 56,8,168
MAA 40,0,168
MAA 40,4,184
MAA 44,4,188
MAA 44,0,172
s_waitcnt vmcnt(20) lgkmcnt(0)
s_barrier
MAA 64,64,160
ds_read_b64_tr_b16 a[0:1], v16
s_add_u32 m0, s55, 135168
MAA 64,68,176
buffer_load_dwordx4 v12, s[80:83], s54 offen   lds
v_smfmac_f32_16x16x64_bf16 a[216:219], a[208:211], a[192:199], v6
TR 2,16,512
s_xor_b32 s75, s74, 2
v_smfmac_f32_16x16x64_bf16 a[216:219], a[208:211], a[200:207], v6
TR 4,16,8448
s_sub_u32 s75, s75, 2
MAA 68,68,180
TR 6,16,8960
s_mul_i32 s100, s75, 458752
MAA 68,64,164
TR 8,16,32
s_mul_i32 s75, s75, 114688
MAA 84,72,164
buffer_load_dwordx4 v13, s[80:83], s54 offen offset:1056   lds
MAA 84,76,180
TR 10,16,544
s_add_u32 s78, s87, s75
MAA 80,76,176
TR 12,16,8480
s_xor_b32 s75, s74, 3
MAA 80,72,160
TR 14,16,8992
s_sub_u32 s75, s75, 3
MAA 128,80,160
TR 16,16,64
s_mul_i32 s101, s75, 458752
MAA 128,84,176
buffer_load_dwordx4 v14, s[80:83], s54 offen offset:2112   lds
MAA 132,84,180
TR 18,16,576
s_mul_i32 s75, s75, 114688
MAA 132,80,164
TR 20,16,8512
s_add_u32 s79, s87, s75
MAA 148,88,164
TR 22,16,9024
s_and_b32 s87, s6, 3
MAA 148,92,180
TR 24,16,96
s_mov_b32 s46, 0
MAA 144,92,176
buffer_load_dwordx4 v15, s[80:83], s54 offen offset:3168   lds
MAA 144,88,160
TR 26,16,608
s_add_u32 s54, s54, 458752
MAA 192,96,160
TR 28,16,8544
s_add_u32 m0, s57, 4096
MAA 192,100,176
TR 30,16,9056
s_mov_b32 s58, 29626368
MAA 196,100,180
TR 32,16,128
s_lshl_b32 s74, s3, 10
MAA 196,96,164
buffer_load_dwordx4 v4, s[16:19], s58 offen sc1 lds
MAA 212,104,164
TR 34,16,640
s_lshl_b32 s75, s12, 9
MAA 212,108,180
TR 36,16,8576
s_add_u32 s74, s74, s75
MAA 208,108,176
TR 38,16,9088
s_add_u32 s74, s74, 152576
MAA 208,104,160
TR 40,16,160
v_and_b32 v18, 15, v1
MAA 240,112,160
buffer_load_dwordx4 v4, s[16:19], s58 offen offset:1024 sc1 lds
MAA 240,116,176
TR 42,16,672
v_lshl_add_u32 v18, v18, 4, s74
MAA 244,116,180
TR 44,16,8608
v_xor_b32 v19, 512, v18
MAA 244,112,164
TR 46,16,9120
MAA 252,120,164
ds_read_b64_tr_b16 a[48:49], v17
MAA 252,124,180
TR 50,17,512
MAA 248,124,176
TR 52,17,8448
MAA 248,120,160
buffer_load_dwordx4 a[160:163], v10, s[16:19], s52 offen sc1
MAA 220,104,172
TR 54,17,8960
MAA 220,108,188
TR 56,17,32
MAA 216,108,184
TR 58,17,544
MAA 216,104,168
TR 60,17,8480
MAA 200,96,168
buffer_load_dwordx4 a[164:167], v10, s[16:19], s52 offen offset:1024 sc1
MAA 200,100,184
TR 62,17,8992
s_add_u32 s52, s52, 131072
MAA 204,100,188
ds_read_b128 a[192:195], v9
MAA 204,96,172
RD 196,9,1056
MAA 156,88,172
RD 200,9,2112
MAA 156,92,188
buffer_load_dwordx4 a[176:179], v10, s[16:19], s52 offen sc1
MAA 152,92,184
RD 204,9,3168
MAA 152,88,168
MAA 136,80,168
MAA 136,84,184
MAA 140,84,188
buffer_load_dwordx4 a[180:183], v10, s[16:19], s52 offen offset:1024 sc1
MAA 140,80,172
s_add_u32 s52, s52, 131072
MAA 92,72,172
MAA 92,76,188
MAA 88,76,184
MAA 88,72,168
MAA 72,64,168
MAA 72,68,184
MAA 76,68,188
MAA 76,64,172
s_waitcnt vmcnt(20) lgkmcnt(0)
s_barrier
MAA 32,0,128
buffer_load_dwordx4 a[168:171], v11, s[16:19], s53 offen sc1
MAA 32,4,144
ds_read_b128 v[20:23], v2
v_smfmac_f32_16x16x64_bf16 a[212:215], a[208:211], a[192:199], v6
ds_read_b128 v[28:31], v2 offset:1024
v_smfmac_f32_16x16x64_bf16 a[212:215], a[208:211], a[200:207], v6
s_waitcnt vmcnt(11)
ds_read_b128 v[24:27], v2 offset:2048
MAA 36,4,148
TR 64,16,16896
MAA 36,0,132
buffer_load_dwordx4 a[172:175], v11, s[16:19], s53 offen offset:1024 sc1
MAA 52,8,132
TR 66,16,17408
s_add_u32 s53, s53, 131072
MAA 52,12,148
TR 68,16,25344
MAA 48,12,144
TR 70,16,25856
MAA 48,8,128
TR 72,16,16928
MAA 96,16,128
buffer_load_dwordx4 a[184:187], v11, s[16:19], s53 offen sc1
MAA 96,20,144
TR 74,16,17440
s_waitcnt lgkmcnt(7)
v_add_f32 v20, v20, v28
MAA 100,20,148
TR 76,16,25376
v_add_f32 v21, v21, v29
MAA 100,16,132
TR 78,16,25888
v_add_f32 v22, v22, v30
MAA 116,24,132
TR 80,16,16960
v_add_f32 v23, v23, v31
MAA 116,28,148
buffer_load_dwordx4 a[188:191], v11, s[16:19], s53 offen offset:1024 sc1
MAA 112,28,144
ds_read_b128 v[28:31], v2 offset:3072
s_add_u32 s53, s53, 131072
MAA 112,24,128
TR 82,16,17472
s_add_u32 m0, s55, 84480
MAA 160,32,128
TR 84,16,25408
s_waitcnt lgkmcnt(12)
v_add_f32 v20, v20, v24
MAA 160,36,144
TR 86,16,25920
v_add_f32 v21, v21, v25
MAA 164,36,148
buffer_load_dwordx4 v12, s[32:35], s54 offen   lds
MAA 164,32,132
TR 88,16,16992
v_add_f32 v22, v22, v26
MAA 180,40,132
TR 90,16,17504
v_add_f32 v23, v23, v27
MAA 180,44,148
TR 92,16,25440
MAA 176,44,144
TR 94,16,25952
MAA 176,40,128
buffer_load_dwordx4 v13, s[32:35], s54 offen offset:1056   lds
MAA 224,48,128
TR 96,16,17024
MAA 224,52,144
TR 98,16,17536
MAA 228,52,148
TR 100,16,25472
MAA 228,48,132
TR 102,16,25984
MAA 236,56,132
buffer_load_dwordx4 v14, s[32:35], s54 offen offset:2112   lds
MAA 236,60,148
TR 104,16,17056
MAA 232,60,144
TR 106,16,17568
MAA 232,56,128
TR 108,16,25504
MAA 188,40,140
TR 110,16,26016
MAA 188,44,156
buffer_load_dwordx4 v15, s[32:35], s54 offen offset:3168   lds
MAA 184,44,152
TR 112,17,16896
s_add_u32 m0, s57, 6144
MAA 184,40,136
TR 114,17,17408
s_mov_b32 s58, 29628416
MAA 168,32,136
TR 116,17,25344
MAA 168,36,152
TR 118,17,25856
MAA 172,36,156
buffer_load_dwordx4 v4, s[16:19], s58 offen sc1 lds
MAA 172,32,140
TR 120,17,16928
MAA 124,24,140
TR 122,17,17440
MAA 124,28,156
TR 124,17,25376
MAA 120,28,152
TR 126,17,25888
MAA 120,24,136
buffer_load_dwordx4 v4, s[16:19], s58 offen offset:1024 sc1 lds
MAA 104,16,136
RD 192,9,16896
MAA 104,20,152
RD 196,9,17952
MAA 108,20,156
RD 200,9,19008
MAA 108,16,140
RD 204,9,20064
MAA 60,8,140
MAA 60,12,156
MAA 56,12,152
MAA 56,8,136
MAA 40,0,136
MAA 40,4,152
MAA 44,4,156
s_sub_u32 s47, s47, 1
s_cbranch_scc1 .Lx39
.Lx39b:
MAA 44,0,140
s_waitcnt lgkmcnt(0)
s_barrier
MAA 64,64,128
s_waitcnt vmcnt(14)
ds_read_b128 v[24:27], v2 offset:4096
s_add_u32 m0, s55, 101376
MAA 64,68,144
buffer_load_dwordx4 v12, s[80:83], s54 offen   lds
v_smfmac_f32_16x16x64_bf16 a[216:219], a[208:211], a[192:199], v6
TR 0,16,33792
v_add_f32 v20, v20, v28
v_smfmac_f32_16x16x64_bf16 a[216:219], a[208:211], a[200:207], v6
TR 2,16,34304
v_add_f32 v21, v21, v29
MAA 68,68,148
TR 4,16,42240
v_add_f32 v22, v22, v30
MAA 68,64,132
TR 6,16,42752
v_add_f32 v23, v23, v31
.Lpad3:
s_cbranch_execz .Lnopoll34r
MAA 84,72,132
ds_read_b128 v[28:31], v2 offset:5120
MAA 84,76,148
TR 8,16,33824
MAA 80,76,144
buffer_load_dwordx4 v13, s[80:83], s54 offen offset:1056   lds
MAA 80,72,128
TR 10,16,34336
s_waitcnt lgkmcnt(7)
v_add_f32 v20, v20, v24
MAA 128,80,128
TR 12,16,42272
v_add_f32 v21, v21, v25
MAA 128,84,144
TR 14,16,42784
v_add_f32 v22, v22, v26
MAA 132,84,148
TR 16,16,33856
v_add_f32 v23, v23, v27
MAA 132,80,132
TR 18,16,34368
MAA 148,88,132
TR 20,16,42304
MAA 148,92,148
buffer_load_dwordx4 v14, s[80:83], s54 offen offset:2112   lds
MAA 144,92,144
TR 22,16,42816
MAA 144,88,128
TR 24,16,33888
MAA 192,96,128
TR 26,16,34400
MAA 192,100,144
TR 28,16,42336
MAA 196,100,148
TR 30,16,42848
MAA 196,96,132
TR 32,16,33920
MAA 212,104,132
buffer_load_dwordx4 v15, s[80:83], s54 offen offset:3168   lds
MAA 212,108,148
TR 34,16,34432
s_add_u32 s54, s54, 458752
MAA 208,108,144
TR 36,16,42368
MAA 208,104,128
TR 38,16,42880
MAA 240,112,128
TR 40,16,33952
MAA 240,116,144
TR 42,16,34464
MAA 244,116,148
TR 44,16,42400
MAA 244,112,132
TR 46,16,42912
MAA 252,120,132
TR 48,17,33792
MAA 252,124,148
TR 50,17,34304
MAA 248,124,144
TR 52,17,42240
MAA 248,120,128
buffer_load_dwordx4 a[128:131], v10, s[16:19], s52 offen sc1
MAA 220,104,140
TR 54,17,42752
MAA 220,108,156
TR 56,17,33824
MAA 216,108,152
TR 58,17,34336
MAA 216,104,136
TR 60,17,42272
MAA 200,96,136
TR 62,17,42784
MAA 200,100,152
RD 192,9,33792
MAA 204,100,156
buffer_load_dwordx4 a[132:135], v10, s[16:19], s52 offen offset:1024 sc1
MAA 204,96,140
RD 196,9,34848
s_add_u32 s52, s52, 131072
MAA 156,88,140
RD 200,9,35904
MAA 156,92,156
RD 204,9,36960
MAA 152,92,152
MAA 152,88,136
MAA 136,80,136
MAA 136,84,152
buffer_load_dwordx4 a[144:147], v10, s[16:19], s52 offen sc1
MAA 140,84,156
MAA 140,80,140
MAA 92,72,140
MAA 92,76,156
MAA 88,76,152
MAA 88,72,136
MAA 72,64,136
buffer_load_dwordx4 a[148:151], v10, s[16:19], s52 offen offset:1024 sc1
MAA 72,68,152
s_add_u32 s52, s52, 131072
MAA 76,68,156
s_sub_u32 s47, s47, 1
s_cbranch_scc1 .Lx40
.Lx40b:
MAA 76,64,140
s_waitcnt vmcnt(18) lgkmcnt(0)
s_barrier
MAA 32,0,160
buffer_load_dwordx4 a[136:139], v11, s[16:19], s53 offen sc1
MAA 32,4,176
s_waitcnt vmcnt(9)
ds_read_b128 v[24:27], v2 offset:6144
v_add_f32 v20, v20, v28
v_smfmac_f32_16x16x64_bf16 a[212:215], a[208:211], a[192:199], v6
TR 64,16,50688
v_add_f32 v21, v21, v29
v_smfmac_f32_16x16x64_bf16 a[212:215], a[208:211], a[200:207], v6
TR 66,16,51200
v_add_f32 v22, v22, v30
MAA 36,4,180
TR 68,16,59136
v_add_f32 v23, v23, v31
MAA 36,0,164
ds_read_b128 v[28:31], v2 offset:7168
MAA 52,8,164
TR 70,16,59648
MAA 52,12,180
buffer_load_dwordx4 a[140:143], v11, s[16:19], s53 offen offset:1024 sc1
MAA 48,12,176
TR 72,16,50720
s_add_u32 s53, s53, 131072
MAA 48,8,160
TR 74,16,51232
s_waitcnt lgkmcnt(7)
v_add_f32 v20, v20, v24
MAA 96,16,160
TR 76,16,59168
v_add_f32 v21, v21, v25
MAA 96,20,176
TR 78,16,59680
v_add_f32 v22, v22, v26
MAA 100,20,180
TR 80,16,50752
v_add_f32 v23, v23, v27
MAA 100,16,164
TR 82,16,51264
s_waitcnt lgkmcnt(7)
v_add_f32 v20, v20, v28
MAA 116,24,164
buffer_load_dwordx4 a[152:155], v11, s[16:19], s53 offen sc1
MAA 116,28,180
TR 84,16,59200
v_add_f32 v21, v21, v29
MAA 112,28,176
TR 86,16,59712
v_add_f32 v22, v22, v30
MAA 112,24,160
TR 88,16,50784
v_add_f32 v23, v23, v31
MAA 160,32,160
TR 90,16,51296
MAA 160,36,176
TR 92,16,59232
MAA 164,36,180
TR 94,16,59744
MAA 164,32,164
buffer_load_dwordx4 a[156:159], v11, s[16:19], s53 offen offset:1024 sc1
MAA 180,40,164
TR 96,16,50816
s_add_u32 s53, s53, 131072
MAA 180,44,180
TR 98,16,51328
s_add_u32 m0, s55, 118272
MAA 176,44,176
TR 100,16,59264
MAA 176,40,160
TR 102,16,59776
MAA 224,48,160
TR 104,16,50848
MAA 224,52,176
TR 106,16,51360
MAA 228,52,180
buffer_load_dwordx4 v12, s[32:35], s54 offen   lds
MAA 228,48,164
TR 108,16,59296
MAA 236,56,164
TR 110,16,59808
MAA 236,60,180
TR 112,17,50688
MAA 232,60,176
TR 114,17,51200
MAA 232,56,160
TR 116,17,59136
MAA 188,40,172
TR 118,17,59648
MAA 188,44,188
buffer_load_dwordx4 v13, s[32:35], s54 offen offset:1056   lds
MAA 184,44,184
TR 120,17,50720
MAA 184,40,168
TR 122,17,51232
MAA 168,32,168
TR 124,17,59168
MAA 168,36,184
TR 126,17,59680
MAA 172,36,188
RD 192,9,50688
MAA 172,32,172
RD 196,9,51744
MAA 124,24,172
buffer_load_dwordx4 v14, s[32:35], s54 offen offset:2112   lds
MAA 124,28,188
RD 200,9,52800
MAA 120,28,184
RD 204,9,53856
MAA 120,24,168
MAA 104,16,168
MAA 104,20,184
MAA 108,20,188
MAA 108,16,172
buffer_load_dwordx4 v15, s[32:35], s54 offen offset:3168   lds
MAA 60,8,172
MAA 60,12,188
MAA 56,12,184
MAA 56,8,168
MAA 40,0,168
MAA 40,4,184
MAA 44,4,188
s_sub_u32 s47, s47, 1
s_cbranch_scc1 .Lx41
.Lx41b:
MAA 44,0,172
s_waitcnt lgkmcnt(0)
s_barrier
MAA 64,64,160
ds_read_b64_tr_b16 a[0:1], v16
s_add_u32 m0, s55, 135168
MAA 64,68,176
buffer_load_dwordx4 v12, s[80:83], s54 offen   lds
v_smfmac_f32_16x16x64_bf16 a[216:219], a[208:211], a[192:199], v6
TR 2,16,512
v_permlane32_swap_b32 v20, v22
v_smfmac_f32_16x16x64_bf16 a[216:219], a[208:211], a[200:207], v6
TR 4,16,8448
v_permlane32_swap_b32 v21, v23
MAA 68,68,180
TR 6,16,8960
v_add_f32 v20, v20, v22
MAA 68,64,164
TR 8,16,32
v_add_f32 v21, v21, v23
MAA 84,72,164
TR 10,16,544
v_mul_f32 v20, 0xba800000, v20
MAA 84,76,180
buffer_load_dwordx4 v13, s[80:83], s54 offen offset:1056   lds
MAA 80,76,176
TR 12,16,8480
v_mul_f32 v21, 0x3a800000, v21
MAA 80,72,160
TR 14,16,8992
v_fma_f32 v21, -v20, v20, v21
MAA 128,80,160
TR 16,16,64
v_max_f32 v21, 0, v21
MAA 128,84,176
TR 18,16,576
v_add_f32 v21, 0x3727c5ac, v21
MAA 132,84,180
TR 20,16,8512
v_rsq_f32 v22, v21
MAA 132,80,164
TR 22,16,9024
v_and_b32 v24, 31, v1
MAA 148,88,164
buffer_load_dwordx4 v14, s[80:83], s54 offen offset:2112   lds
MAA 148,92,180
TR 24,16,96
v_lshrrev_b32 v25, 5, v1
MAA 144,92,176
TR 26,16,608
v_lshl_add_u32 v24, v24, 1, v25
MAA 144,88,160
TR 28,16,8544
v_and_b32 v25, 0xc0, v0
MAA 192,96,160
TR 30,16,9056
v_add_u32 v24, v24, v25
MAA 192,100,176
TR 32,16,128
v_lshlrev_b32 v24, 4, v24
MAA 196,100,180
TR 34,16,640
v_add_u32 v24, 152576, v24
MAA 196,96,164
buffer_load_dwordx4 v15, s[80:83], s54 offen offset:3168   lds
MAA 212,104,164
TR 36,16,8576
s_add_u32 s54, s54, 458752
MAA 212,108,180
TR 38,16,9088
v_mul_f32 v22, 0xbfb8aa3b, v22
MAA 208,108,176
ds_write_b128 v24, v[20:23]
s_mov_b32 s58, s98
MAA 208,104,160
ds_read_b64 v[20:21], v18
s_mov_b32 s67, s59
MAA 240,112,160
ds_read_b64 v[22:23], v18 offset:256
MAA 240,116,176
ds_read_b64 v[24:25], v19
MAA 244,116,180
ds_read_b64 v[26:27], v19 offset:256
MAA 244,112,164
ds_read_b32 v28, v18 offset:8
MAA 252,120,164
ds_read_b32 v29, v18 offset:264
v_mov_b32 v18, v5
MAA 252,124,180
ds_read_b32 v30, v19 offset:8
MAA 248,124,176
ds_read_b32 v31, v19 offset:264
v_add_u32 v19, 992, v5
MAA 248,120,160
buffer_load_dwordx4 a[160:163], v10, s[16:19], s52 offen sc1
MAA 220,104,172
TR 40,16,160
MAA 220,108,188
TR 42,16,672
MAA 216,108,184
TR 44,16,8608
MAA 216,104,168
TR 46,16,9120
MAA 200,96,168
ds_read_b64_tr_b16 a[48:49], v17
MAA 200,100,184
TR 50,17,512
MAA 204,100,188
buffer_load_dwordx4 a[164:167], v10, s[16:19], s52 offen offset:1024 sc1
MAA 204,96,172
TR 52,17,8448
s_add_u32 s52, s52, 131072
MAA 156,88,172
TR 54,17,8960
MAA 156,92,188
TR 56,17,32
MAA 152,92,184
TR 58,17,544
MAA 152,88,168
TR 60,17,8480
MAA 136,80,168
TR 62,17,8992
MAA 136,84,184
buffer_load_dwordx4 a[176:179], v10, s[16:19], s52 offen sc1
MAA 140,84,188
ds_read_b128 a[192:195], v9
MAA 140,80,172
RD 196,9,1056
MAA 92,72,172
RD 200,9,2112
MAA 92,76,188
RD 204,9,3168
MAA 88,76,184
MAA 88,72,168
MAA 72,64,168
buffer_load_dwordx4 a[180:183], v10, s[16:19], s52 offen offset:1024 sc1
MAA 72,68,184
s_add_u32 s52, s52, 131072
MAA 76,68,188
s_sub_u32 s47, s47, 1
s_cbranch_scc1 .Lx42
.Lx42b:
MAA 76,64,172
s_mov_b32 s15, -5
.p2align 6
.Lk43:
s_waitcnt vmcnt(16) lgkmcnt(0)
s_barrier
MAA 32,0,128
TR 64,16,16896
MAA 32,4,144
buffer_load_dwordx4 a[168:171], v11, s[16:19], s53 offen sc1
v_smfmac_f32_16x16x64_bf16 a[212:215], a[208:211], a[192:199], v6
s_sub_u32 s47, s47, 1
s_cbranch_scc1 .Lx44
.Lx44b:
v_smfmac_f32_16x16x64_bf16 a[212:215], a[208:211], a[200:207], v6
TR 66,16,17408
MAA 36,4,148
TR 68,16,25344
MAA 36,0,132
TR 70,16,25856
MAA 52,8,132
TR 72,16,16928
MAA 52,12,148
buffer_load_dwordx4 a[172:175], v11, s[16:19], s53 offen offset:1024 sc1
MAA 48,12,144
TR 74,16,17440
s_add_u32 s53, s53, 131072
MAA 48,8,128
MAA 96,16,128
TR 76,16,25376
MAA 96,20,144
TR 78,16,25888
MAA 100,20,148
TR 80,16,16960
MAA 100,16,132
buffer_load_dwordx4 a[184:187], v11, s[16:19], s53 offen sc1
MAA 116,24,132
TR 82,16,17472
MAA 116,28,148
TR 84,16,25408
MAA 112,28,144
MAA 112,24,128
TR 86,16,25920
MAA 160,32,128
TR 88,16,16992
MAA 160,36,144
buffer_load_dwordx4 a[188:191], v11, s[16:19], s53 offen offset:1024 sc1
MAA 164,36,148
TR 90,16,17504
s_add_u32 s53, s53, 131072
MAA 164,32,132
TR 92,16,25440
MAA 180,40,132
TR 94,16,25952
MAA 180,44,148
MAA 176,44,144
TR 96,16,17024
s_add_u32 m0, s55, 84480
MAA 176,40,128
buffer_load_dwordx4 v12, s[32:35], s54 offen   lds
MAA 224,48,128
TR 98,16,17536
MAA 224,52,144
TR 100,16,25472
MAA 228,52,148
TR 102,16,25984
MAA 228,48,132
TR 104,16,17056
MAA 236,56,132
MAA 236,60,148
TR 106,16,17568
MAA 232,60,144
TR 108,16,25504
MAA 232,56,128
TR 110,16,26016
s_waitcnt vmcnt(17)
MAA 188,40,140
TR 112,17,16896
MAA 188,44,156
buffer_load_dwordx4 v13, s[32:35], s54 offen offset:1056   lds
MAA 184,44,152
TR 114,17,17408
MAA 184,40,136
MAA 168,32,136
TR 116,17,25344
MAA 168,36,152
buffer_load_dwordx4 v14, s[32:35], s54 offen offset:2112   lds
MAA 172,36,156
TR 118,17,25856
MAA 172,32,140
TR 120,17,16928
MAA 124,24,140
TR 122,17,17440
MAA 124,28,156
TR 124,17,25376
MAA 120,28,152
MAA 120,24,136
buffer_load_dwordx4 v15, s[32:35], s54 offen offset:3168   lds
MAA 104,16,136
TR 126,17,25888
MAA 104,20,152
RD 192,9,16896
MAA 108,20,156
RD 196,9,17952
MAA 108,16,140
RD 200,9,19008
MAA 60,8,140
RD 204,9,20064
s_mov_b32 m0, s67
MAA 60,12,156
buffer_load_dwordx4 v18, s[28:31], s58 offen lds
MAA 56,12,152
MAA 56,8,136
MAA 40,0,136
MAA 40,4,152
MAA 44,4,156
MAA 44,0,140
s_waitcnt vmcnt(17) lgkmcnt(0)
s_barrier
MAA 64,64,128
TR 0,16,33792
s_add_u32 m0, s55, 101376
MAA 64,68,144
buffer_load_dwordx4 v12, s[80:83], s54 offen   lds
v_smfmac_f32_16x16x64_bf16 a[216:219], a[208:211], a[192:199], v6
s_sub_u32 s47, s47, 1
s_cbranch_scc1 .Lx45
.Lx45b:
v_smfmac_f32_16x16x64_bf16 a[216:219], a[208:211], a[200:207], v6
TR 2,16,34304
MAA 68,68,148
TR 4,16,42240
MAA 68,64,132
TR 6,16,42752
MAA 84,72,132
TR 8,16,33824
MAA 84,76,148
buffer_load_dwordx4 v13, s[80:83], s54 offen offset:1056   lds
MAA 80,76,144
TR 10,16,34336
MAA 80,72,128
MAA 128,80,128
TR 12,16,42272
MAA 128,84,144
TR 14,16,42784
MAA 132,84,148
TR 16,16,33856
MAA 132,80,132
buffer_load_dwordx4 v14, s[80:83], s54 offen offset:2112   lds
MAA 148,88,132
TR 18,16,34368
MAA 148,92,148
TR 20,16,42304
MAA 144,92,144
TR 22,16,42816
MAA 144,88,128
MAA 192,96,128
TR 24,16,33888
MAA 192,100,144
buffer_load_dwordx4 v15, s[80:83], s54 offen offset:3168   lds
MAA 196,100,148
TR 26,16,34400
s_add_u32 s54, s54, 458752
MAA 196,96,132
TR 28,16,42336
MAA 212,104,132
TR 30,16,42848
MAA 212,108,148
TR 32,16,33920
MAA 208,108,144
TR 34,16,34432
.Lpad4:
s_cbranch_execz .Lnopoll34r
s_mov_b32 m0, s67
MAA 208,104,128
buffer_load_dwordx4 v19, s[28:31], s58 offen offset:1056 lds
MAA 240,112,128
s_add_u32 s67, s67, 8448
s_add_u32 s58, s58, 0x40000
MAA 240,116,144
MAA 244,116,148
TR 36,16,42368
MAA 244,112,132
TR 38,16,42880
MAA 252,120,132
TR 40,16,33952
MAA 252,124,148
TR 42,16,34464
MAA 248,124,144
TR 44,16,42400
MAA 248,120,128
buffer_load_dwordx4 a[128:131], v10, s[16:19], s52 offen sc1
MAA 220,104,140
TR 46,16,42912
MAA 220,108,156
MAA 216,108,152
TR 48,17,33792
MAA 216,104,136
TR 50,17,34304
MAA 200,96,136
TR 52,17,42240
MAA 200,100,152
buffer_load_dwordx4 a[132:135], v10, s[16:19], s52 offen offset:1024 sc1
MAA 204,100,156
TR 54,17,42752
s_add_u32 s52, s52, 131072
MAA 204,96,140
TR 56,17,33824
MAA 156,88,140
TR 58,17,34336
MAA 156,92,156
MAA 152,92,152
TR 60,17,42272
MAA 152,88,136
buffer_load_dwordx4 a[144:147], v10, s[16:19], s52 offen sc1
MAA 136,80,136
TR 62,17,42784
MAA 136,84,152
RD 192,9,33792
MAA 140,84,156
RD 196,9,34848
MAA 140,80,140
RD 200,9,35904
MAA 92,72,140
RD 204,9,36960
MAA 92,76,156
buffer_load_dwordx4 a[148:151], v10, s[16:19], s52 offen offset:1024 sc1
MAA 88,76,152
s_add_u32 s52, s52, 131072
MAA 88,72,136
MAA 72,64,136
MAA 72,68,152
MAA 76,68,156
MAA 76,64,140
s_waitcnt vmcnt(18) lgkmcnt(0)
s_barrier
MAA 32,0,160
TR 64,16,50688
MAA 32,4,176
buffer_load_dwordx4 a[136:139], v11, s[16:19], s53 offen sc1
v_smfmac_f32_16x16x64_bf16 a[212:215], a[208:211], a[192:199], v6
s_sub_u32 s47, s47, 1
s_cbranch_scc1 .Lx46
.Lx46b:
v_smfmac_f32_16x16x64_bf16 a[212:215], a[208:211], a[200:207], v6
TR 66,16,51200
MAA 36,4,180
TR 68,16,59136
MAA 36,0,164
TR 70,16,59648
MAA 52,8,164
TR 72,16,50720
MAA 52,12,180
buffer_load_dwordx4 a[140:143], v11, s[16:19], s53 offen offset:1024 sc1
MAA 48,12,176
TR 74,16,51232
s_add_u32 s53, s53, 131072
MAA 48,8,160
MAA 96,16,160
TR 76,16,59168
MAA 96,20,176
TR 78,16,59680
MAA 100,20,180
TR 80,16,50752
MAA 100,16,164
buffer_load_dwordx4 a[152:155], v11, s[16:19], s53 offen sc1
MAA 116,24,164
TR 82,16,51264
MAA 116,28,180
TR 84,16,59200
MAA 112,28,176
MAA 112,24,160
TR 86,16,59712
MAA 160,32,160
TR 88,16,50784
MAA 160,36,176
buffer_load_dwordx4 a[156:159], v11, s[16:19], s53 offen offset:1024 sc1
MAA 164,36,180
TR 90,16,51296
s_add_u32 s53, s53, 131072
MAA 164,32,164
TR 92,16,59232
MAA 180,40,164
TR 94,16,59744
MAA 180,44,180
MAA 176,44,176
TR 96,16,50816
s_add_u32 m0, s55, 118272
MAA 176,40,160
buffer_load_dwordx4 v12, s[32:35], s54 offen   lds
MAA 224,48,160
TR 98,16,51328
MAA 224,52,176
TR 100,16,59264
MAA 228,52,180
TR 102,16,59776
MAA 228,48,164
TR 104,16,50848
MAA 236,56,164
MAA 236,60,180
TR 106,16,51360
MAA 232,60,176
TR 108,16,59296
MAA 232,56,160
TR 110,16,59808
s_waitcnt vmcnt(19)
MAA 188,40,172
TR 112,17,50688
MAA 188,44,188
buffer_load_dwordx4 v13, s[32:35], s54 offen offset:1056   lds
MAA 184,44,184
TR 114,17,51200
MAA 184,40,168
MAA 168,32,168
TR 116,17,59136
MAA 168,36,184
buffer_load_dwordx4 v14, s[32:35], s54 offen offset:2112   lds
MAA 172,36,188
TR 118,17,59648
MAA 172,32,172
TR 120,17,50720
MAA 124,24,172
TR 122,17,51232
MAA 124,28,188
TR 124,17,59168
MAA 120,28,184
MAA 120,24,168
buffer_load_dwordx4 v15, s[32:35], s54 offen offset:3168   lds
MAA 104,16,168
TR 126,17,59680
MAA 104,20,184
RD 192,9,50688
MAA 108,20,188
RD 196,9,51744
MAA 108,16,172
RD 200,9,52800
MAA 60,8,172
RD 204,9,53856
s_mov_b32 m0, s67
MAA 60,12,188
buffer_load_dwordx4 v18, s[28:31], s58 offen lds
MAA 56,12,184
MAA 56,8,168
MAA 40,0,168
MAA 40,4,184
MAA 44,4,188
MAA 44,0,172
s_waitcnt vmcnt(19) lgkmcnt(0)
s_barrier
MAA 64,64,160
ds_read_b64_tr_b16 a[0:1], v16
s_add_u32 m0, s55, 135168
MAA 64,68,176
buffer_load_dwordx4 v12, s[80:83], s54 offen   lds
v_smfmac_f32_16x16x64_bf16 a[216:219], a[208:211], a[192:199], v6
s_sub_u32 s47, s47, 1
s_cbranch_scc1 .Lx47
.Lx47b:
v_smfmac_f32_16x16x64_bf16 a[216:219], a[208:211], a[200:207], v6
TR 2,16,512
MAA 68,68,180
TR 4,16,8448
MAA 68,64,164
TR 6,16,8960
MAA 84,72,164
TR 8,16,32
MAA 84,76,180
buffer_load_dwordx4 v13, s[80:83], s54 offen offset:1056   lds
MAA 80,76,176
TR 10,16,544
MAA 80,72,160
MAA 128,80,160
TR 12,16,8480
MAA 128,84,176
TR 14,16,8992
MAA 132,84,180
TR 16,16,64
MAA 132,80,164
buffer_load_dwordx4 v14, s[80:83], s54 offen offset:2112   lds
MAA 148,88,164
TR 18,16,576
MAA 148,92,180
TR 20,16,8512
MAA 144,92,176
TR 22,16,9024
MAA 144,88,160
MAA 192,96,160
TR 24,16,96
MAA 192,100,176
buffer_load_dwordx4 v15, s[80:83], s54 offen offset:3168   lds
MAA 196,100,180
TR 26,16,608
s_add_u32 s54, s54, 458752
MAA 196,96,164
TR 28,16,8544
MAA 212,104,164
TR 30,16,9056
MAA 212,108,180
TR 32,16,128
MAA 208,108,176
TR 34,16,640
s_mov_b32 m0, s67
MAA 208,104,160
buffer_load_dwordx4 v19, s[28:31], s58 offen offset:1056 lds
MAA 240,112,160
s_add_u32 s67, s67, 8448
s_add_u32 s46, s46, 1
s_xor_b32 s58, s46, s87
s_mul_i32 s58, s58, 458752
MAA 240,116,176
MAA 244,116,180
TR 36,16,8576
MAA 244,112,164
TR 38,16,9088
MAA 252,120,164
TR 40,16,160
MAA 252,124,180
TR 42,16,672
MAA 248,124,176
TR 44,16,8608
MAA 248,120,160
buffer_load_dwordx4 a[160:163], v10, s[16:19], s52 offen sc1
MAA 220,104,172
TR 46,16,9120
MAA 220,108,188
MAA 216,108,184
ds_read_b64_tr_b16 a[48:49], v17
MAA 216,104,168
TR 50,17,512
MAA 200,96,168
TR 52,17,8448
MAA 200,100,184
buffer_load_dwordx4 a[164:167], v10, s[16:19], s52 offen offset:1024 sc1
MAA 204,100,188
TR 54,17,8960
s_add_u32 s52, s52, 131072
MAA 204,96,172
TR 56,17,32
MAA 156,88,172
TR 58,17,544
MAA 156,92,188
MAA 152,92,184
TR 60,17,8480
MAA 152,88,168
buffer_load_dwordx4 a[176:179], v10, s[16:19], s52 offen sc1
MAA 136,80,168
TR 62,17,8992
MAA 136,84,184
ds_read_b128 a[192:195], v9
MAA 140,84,188
RD 196,9,1056
MAA 140,80,172
RD 200,9,2112
MAA 92,72,172
RD 204,9,3168
MAA 92,76,188
buffer_load_dwordx4 a[180:183], v10, s[16:19], s52 offen offset:1024 sc1
MAA 88,76,184
s_add_u32 s52, s52, 131072
MAA 88,72,168
MAA 72,64,168
MAA 72,68,184
MAA 76,68,188
s_add_u32 s15, s15, 1
MAA 76,64,172
s_cbranch_scc0 .Lk43
s_branch .Lj48
.Lx39:
buffer_load_dword a220, v8, s[40:43], s45 offen
buffer_load_dword a220, v7, s[28:31], s44 offen
s_add_u32 s44, s44, 655360
s_add_u32 s45, s45, 917504
s_mov_b32 s47, 3
s_branch .Lx39b
.Lx40:
buffer_load_dword a220, v8, s[40:43], s45 offen
buffer_load_dword a220, v7, s[28:31], s44 offen
s_add_u32 s44, s44, 655360
s_add_u32 s45, s45, 917504
s_mov_b32 s47, 3
s_branch .Lx40b
.Lx41:
buffer_load_dword a220, v8, s[40:43], s45 offen
buffer_load_dword a220, v7, s[28:31], s44 offen
s_add_u32 s44, s44, 655360
s_add_u32 s45, s45, 917504
s_mov_b32 s47, 3
s_branch .Lx41b
.Lx42:
buffer_load_dword a220, v8, s[40:43], s45 offen
buffer_load_dword a220, v7, s[28:31], s44 offen
s_add_u32 s44, s44, 655360
s_add_u32 s45, s45, 917504
s_mov_b32 s47, 3
s_branch .Lx42b
.Lx44:
buffer_load_dword a220, v8, s[40:43], s45 offen
buffer_load_dword a220, v7, s[28:31], s44 offen
s_add_u32 s44, s44, 655360
s_add_u32 s45, s45, 917504
s_mov_b32 s47, 3
s_branch .Lx44b
.Lx45:
buffer_load_dword a220, v8, s[40:43], s45 offen
buffer_load_dword a220, v7, s[28:31], s44 offen
s_add_u32 s44, s44, 655360
s_add_u32 s45, s45, 917504
s_mov_b32 s47, 3
s_branch .Lx45b
.Lx46:
buffer_load_dword a220, v8, s[40:43], s45 offen
buffer_load_dword a220, v7, s[28:31], s44 offen
s_add_u32 s44, s44, 655360
s_add_u32 s45, s45, 917504
s_mov_b32 s47, 3
s_branch .Lx46b
.Lx47:
buffer_load_dword a220, v8, s[40:43], s45 offen
buffer_load_dword a220, v7, s[28:31], s44 offen
s_add_u32 s44, s44, 655360
s_add_u32 s45, s45, 917504
s_mov_b32 s47, 3
s_branch .Lx47b
.Lj48:
s_waitcnt vmcnt(10) lgkmcnt(0)
s_barrier
v_smfmac_f32_16x16x64_bf16 a[212:215], a[208:211], a[192:199], v6
RD 112,9,16896
s_lshl_b32 s74, s3, 10
v_smfmac_f32_16x16x64_bf16 a[212:215], a[208:211], a[200:207], v6
RD 116,9,17952
s_add_u32 s74, s74, 152576
MAA 32,0,128
RD 120,9,19008
s_sub_u32 s75, 156672, s74
MAA 32,4,144
RD 124,9,20064
v_and_b32 v7, 15, v1
MAA 48,12,144
RD 192,9,33792
v_lshl_add_u32 v7, v7, 5, s74
MAA 48,8,128
RD 196,9,34848
v_bfe_u32 v2, v1, 4, 1
MAA 36,0,132
RD 200,9,35904
v_lshl_add_u32 v7, v2, 4, v7
MAA 36,4,148
RD 204,9,36960
v_bfe_u32 v2, v1, 5, 1
MAA 52,12,148
buffer_load_dwordx4 a[168:171], v11, s[16:19], s53 offen sc1
MAA 52,8,132
TR 64,16,16896
v_mul_u32_u24 v2, s75, v2
s_waitcnt lgkmcnt(7)
v_smfmac_f32_16x16x64_bf16 a[216:219], a[208:211], a[112:119], v6
TR 66,16,17408
v_add_u32 v7, v7, v2
MAA 40,0,136
TR 68,16,25344
v_lshlrev_b32 v2, 4, v1
s_waitcnt lgkmcnt(7)
v_smfmac_f32_16x16x64_bf16 a[216:219], a[208:211], a[120:127], v6
buffer_load_dwordx4 a[172:175], v11, s[16:19], s53 offen offset:1024 sc1
MAA 40,4,152
TR 70,16,25856
s_add_u32 s53, s53, 131072
s_waitcnt lgkmcnt(6)
v_smfmac_f32_16x16x64_bf16 a[212:215], a[208:211], a[192:199], v6
TR 72,16,16928
v_add_u32 v2, 152576, v2
MAA 56,12,152
TR 74,16,17440
s_lshl_b32 s74, s12, 7
s_waitcnt lgkmcnt(6)
v_smfmac_f32_16x16x64_bf16 a[212:215], a[208:211], a[200:207], v6
buffer_load_dwordx4 a[184:187], v11, s[16:19], s53 offen sc1
MAA 56,8,136
TR 76,16,25376
s_add_u32 s74, s74, 161536
MAA 44,0,140
TR 78,16,25888
s_waitcnt vmcnt(8)
s_barrier
MAA 44,4,156
RD 112,9,50688
s_xor_b32 s75, s12, 1
MAA 60,12,156
RD 116,9,51744
s_mul_i32 s75, s75, 384
MAA 60,8,140
RD 120,9,52800
s_add_u32 s75, s75, 161536
MAA 96,16,128
RD 124,9,53856
v_lshrrev_b32 v9, 4, v1
MAA 96,20,144
ds_write_b128 v7, a[212:215]
v_lshlrev_b32 v9, 4, v9
MAA 112,28,144
buffer_load_dwordx4 a[188:191], v11, s[16:19], s53 offen offset:1024 sc1
MAA 112,24,128
TR 80,16,33792
s_add_u32 s53, s53, 131072
MAA 100,16,132
TR 82,16,34304
v_add_u32 v8, s75, v9
MAA 100,20,148
TR 84,16,42240
v_add_u32 v9, s74, v9
MAA 116,28,148
TR 86,16,42752
s_add_u32 s58, s99, 2293760
s_waitcnt lgkmcnt(7)
v_smfmac_f32_16x16x64_bf16 a[216:219], a[208:211], a[112:119], v6
TR 88,16,33824
s_lshl_b32 s74, s3, 11
MAA 116,24,132
TR 90,16,34336
s_add_u32 s74, s74, s84
s_waitcnt lgkmcnt(7)
v_smfmac_f32_16x16x64_bf16 a[216:219], a[208:211], a[120:127], v6
TR 92,16,42272
s_add_u32 s54, s98, 65536
MAA 104,16,136
TR 94,16,42784
s_mul_i32 s55, s3, 2112
MAA 104,20,152
TR 96,16,50688
s_mov_b32 s57, 67584
MAA 120,28,152
ds_write_b128 v7, a[216:219] offset:512
MAA 120,24,136
TR 98,16,51200
MAA 108,16,140
TR 100,16,59136
MAA 108,20,156
TR 102,16,59648
MAA 124,28,156
TR 104,16,50720
MAA 124,24,140
TR 106,16,51232
MAA 160,32,128
TR 108,16,59168
MAA 160,36,144
TR 110,16,59680
MAA 176,44,144
s_waitcnt lgkmcnt(7)
s_barrier
ds_read_b128 v[12:15], v2
MAA 176,40,128
ds_read_b128 v[4:7], v2 offset:1024
MAA 164,32,132
TR 192,16,16960
MAA 164,36,148
TR 194,16,17472
MAA 180,44,148
TR 196,16,25408
MAA 180,40,132
TR 198,16,25920
MAA 168,32,136
TR 200,16,16992
MAA 168,36,152
TR 202,16,17504
MAA 184,44,152
TR 204,16,25440
MAA 184,40,136
TR 206,16,25952
s_waitcnt lgkmcnt(8)
v_add_f32 v12, v12, v4
MAA 172,32,140
TR 112,16,33856
v_add_f32 v13, v13, v5
MAA 172,36,156
TR 114,16,34368
v_add_f32 v14, v14, v6
MAA 188,44,156
TR 116,16,42304
v_add_f32 v15, v15, v7
MAA 188,40,140
ds_read_b128 v[4:7], v2 offset:2048
MAA 224,48,128
TR 118,16,42816
MAA 224,52,144
TR 120,16,33888
MAA 232,60,144
TR 122,16,34400
MAA 232,56,128
TR 124,16,42336
MAA 228,48,132
TR 126,16,42848
MAA 228,52,148
TR 0,16,50752
MAA 236,60,148
TR 2,16,51264
MAA 236,56,132
TR 4,16,59200
s_waitcnt lgkmcnt(8)
v_add_f32 v12, v12, v4
MAA 64,64,128
TR 6,16,59712
v_add_f32 v13, v13, v5
MAA 64,68,144
TR 8,16,50784
v_add_f32 v14, v14, v6
s_waitcnt vmcnt(7)
MAA 64,96,160
TR 10,16,51296
v_add_f32 v15, v15, v7
s_waitcnt vmcnt(5)
MAA 64,100,176
ds_read_b128 v[4:7], v2 offset:3072
MAA 80,108,176
TR 12,16,59232
MAA 80,104,160
TR 14,16,59744
MAA 80,76,144
TR 16,16,17024
MAA 80,72,128
TR 18,16,17536
MAA 32,80,160
TR 20,16,25472
MAA 32,84,176
TR 22,16,25984
MAA 48,92,176
TR 24,16,17056
MAA 48,88,160
TR 26,16,17568
s_waitcnt lgkmcnt(8)
v_add_f32 v12, v12, v4
v_add_f32 v13, v13, v5
.Lpad5:
s_cbranch_execz .Lnopoll34r
v_add_f32 v14, v14, v6
v_add_f32 v15, v15, v7
ds_write_b128 v2, v[12:15] offset:8960
ds_read_b128 v[12:15], v9
ds_read_b128 v[4:7], v9 offset:64
v_lshrrev_b32 v2, 3, v1
v_cmp_eq_u32 vcc, 3, v2
TR 28,16,25504
TR 30,16,26016
TR 32,16,33920
TR 34,16,34432
TR 36,16,42368
TR 38,16,42880
TR 40,16,33952
TR 42,16,34464
TR 44,16,42400
TR 46,16,42912
TR 48,16,50816
TR 50,16,51328
TR 52,16,59264
s_waitcnt lgkmcnt(14)
v_pk_fma_f32 v[32:33], v[12:13], v[20:21], v[32:33] op_sel_hi:[1,0,1]
v_pk_fma_f32 v[34:35], v[14:15], v[20:21], v[34:35] op_sel_hi:[1,0,1]
v_pk_fma_f32 v[36:37], v[12:13], v[22:23], v[36:37] op_sel_hi:[1,0,1]
v_pk_fma_f32 v[38:39], v[14:15], v[22:23], v[38:39] op_sel_hi:[1,0,1]
v_pk_fma_f32 v[40:41], v[12:13], v[24:25], v[40:41] op_sel_hi:[1,0,1]
v_pk_fma_f32 v[42:43], v[14:15], v[24:25], v[42:43] op_sel_hi:[1,0,1]
v_pk_fma_f32 v[44:45], v[12:13], v[26:27], v[44:45] op_sel_hi:[1,0,1]
v_pk_fma_f32 v[46:47], v[14:15], v[26:27], v[46:47] op_sel_hi:[1,0,1]
ds_read_b128 v[12:15], v9 offset:512
s_waitcnt lgkmcnt(14)
v_pk_fma_f32 v[48:49], v[4:5], v[20:21], v[48:49] op_sel_hi:[1,0,1]
v_pk_fma_f32 v[50:51], v[6:7], v[20:21], v[50:51] op_sel_hi:[1,0,1]
v_pk_fma_f32 v[52:53], v[4:5], v[22:23], v[52:53] op_sel_hi:[1,0,1]
v_pk_fma_f32 v[54:55], v[6:7], v[22:23], v[54:55] op_sel_hi:[1,0,1]
v_pk_fma_f32 v[56:57], v[4:5], v[24:25], v[56:57] op_sel_hi:[1,0,1]
v_pk_fma_f32 v[58:59], v[6:7], v[24:25], v[58:59] op_sel_hi:[1,0,1]
v_pk_fma_f32 v[60:61], v[4:5], v[26:27], v[60:61] op_sel_hi:[1,0,1]
v_pk_fma_f32 v[62:63], v[6:7], v[26:27], v[62:63] op_sel_hi:[1,0,1]
ds_read_b128 v[4:7], v9 offset:576
TR 54,16,59776
TR 56,16,50848
TR 58,16,51360
TR 60,16,59296
TR 62,16,59808
s_waitcnt lgkmcnt(6)
v_pk_fma_f32 v[64:65], v[12:13], v[20:21], v[64:65] op_sel_hi:[1,0,1]
v_pk_fma_f32 v[66:67], v[14:15], v[20:21], v[66:67] op_sel_hi:[1,0,1]
v_pk_fma_f32 v[68:69], v[12:13], v[22:23], v[68:69] op_sel_hi:[1,0,1]
v_pk_fma_f32 v[70:71], v[14:15], v[22:23], v[70:71] op_sel_hi:[1,0,1]
v_pk_fma_f32 v[72:73], v[12:13], v[24:25], v[72:73] op_sel_hi:[1,0,1]
v_pk_fma_f32 v[74:75], v[14:15], v[24:25], v[74:75] op_sel_hi:[1,0,1]
v_pk_fma_f32 v[76:77], v[12:13], v[26:27], v[76:77] op_sel_hi:[1,0,1]
v_pk_fma_f32 v[78:79], v[14:15], v[26:27], v[78:79] op_sel_hi:[1,0,1]
ds_read_b128 v[12:15], v9 offset:832
s_waitcnt lgkmcnt(6)
v_pk_fma_f32 v[80:81], v[4:5], v[20:21], v[80:81] op_sel_hi:[1,0,1]
v_pk_fma_f32 v[82:83], v[6:7], v[20:21], v[82:83] op_sel_hi:[1,0,1]
v_pk_fma_f32 v[84:85], v[4:5], v[22:23], v[84:85] op_sel_hi:[1,0,1]
v_pk_fma_f32 v[86:87], v[6:7], v[22:23], v[86:87] op_sel_hi:[1,0,1]
v_pk_fma_f32 v[88:89], v[4:5], v[24:25], v[88:89] op_sel_hi:[1,0,1]
v_pk_fma_f32 v[90:91], v[6:7], v[24:25], v[90:91] op_sel_hi:[1,0,1]
v_pk_fma_f32 v[92:93], v[4:5], v[26:27], v[92:93] op_sel_hi:[1,0,1]
v_pk_fma_f32 v[94:95], v[6:7], v[26:27], v[94:95] op_sel_hi:[1,0,1]
ds_read_b128 v[4:7], v9 offset:704
v_pk_mul_f32 v[64:65], v[64:65], v[32:33]
v_pk_mul_f32 v[32:33], v[32:33], v[28:29] op_sel_hi:[1,0]
v_pk_mul_f32 v[66:67], v[66:67], v[34:35]
v_pk_mul_f32 v[34:35], v[34:35], v[28:29] op_sel_hi:[1,0]
v_pk_mul_f32 v[80:81], v[80:81], v[48:49]
v_pk_mul_f32 v[48:49], v[48:49], v[28:29] op_sel_hi:[1,0]
v_pk_mul_f32 v[82:83], v[82:83], v[50:51]
v_pk_mul_f32 v[50:51], v[50:51], v[28:29] op_sel_hi:[1,0]
v_exp_f32 v32, v32
v_exp_f32 v33, v33
MAA 68,64,132
v_exp_f32 v34, v34
MAA 68,68,148
v_exp_f32 v35, v35
MAA 68,96,164
v_exp_f32 v48, v48
s_waitcnt vmcnt(4)
MAA 68,100,180
v_exp_f32 v49, v49
MAA 84,108,180
v_exp_f32 v50, v50
MAA 84,104,164
v_exp_f32 v51, v51
MAA 84,76,148
MAA 84,72,132
MAA 36,80,164
MAA 36,84,180
MAA 52,92,180
MAA 52,88,164
s_nop 5
v_pk_mul_f32 v[68:69], v[68:69], v[36:37]
v_pk_fma_f32 v[32:33], v[32:33], v[20:21], v[20:21] op_sel:[0,1,1] op_sel_hi:[1,1,1]
v_pk_fma_f32 v[34:35], v[34:35], v[20:21], v[20:21] op_sel:[0,1,1] op_sel_hi:[1,1,1]
v_pk_fma_f32 v[48:49], v[48:49], v[20:21], v[20:21] op_sel:[0,1,1] op_sel_hi:[1,1,1]
v_pk_fma_f32 v[50:51], v[50:51], v[20:21], v[20:21] op_sel:[0,1,1] op_sel_hi:[1,1,1]
v_rcp_f32 v32, v32
v_pk_mul_f32 v[36:37], v[36:37], v[28:29] op_sel:[0,1] op_sel_hi:[1,1]
v_pk_mul_f32 v[70:71], v[70:71], v[38:39]
v_pk_mul_f32 v[38:39], v[38:39], v[28:29] op_sel:[0,1] op_sel_hi:[1,1]
v_pk_mul_f32 v[84:85], v[84:85], v[52:53]
v_pk_mul_f32 v[52:53], v[52:53], v[28:29] op_sel:[0,1] op_sel_hi:[1,1]
v_pk_mul_f32 v[86:87], v[86:87], v[54:55]
v_pk_mul_f32 v[54:55], v[54:55], v[28:29] op_sel:[0,1] op_sel_hi:[1,1]
v_rcp_f32 v33, v33
v_rcp_f32 v34, v34
MAA 72,64,136
v_rcp_f32 v35, v35
MAA 72,68,152
v_rcp_f32 v48, v48
s_waitcnt vmcnt(3)
MAA 72,96,168
v_rcp_f32 v49, v49
s_waitcnt vmcnt(1)
MAA 72,100,184
v_rcp_f32 v50, v50
MAA 88,108,184
v_rcp_f32 v51, v51
MAA 88,104,168
v_exp_f32 v36, v36
MAA 88,76,152
v_exp_f32 v37, v37
MAA 88,72,136
v_exp_f32 v38, v38
MAA 40,80,168
v_exp_f32 v39, v39
MAA 40,84,184
v_exp_f32 v52, v52
MAA 56,92,184
v_exp_f32 v53, v53
MAA 56,88,168
v_exp_f32 v54, v54
v_exp_f32 v55, v55
v_pk_mul_f32 v[64:65], v[64:65], v[32:33]
v_pk_mul_f32 v[66:67], v[66:67], v[34:35]
v_pk_mul_f32 v[80:81], v[80:81], v[48:49]
v_pk_mul_f32 v[82:83], v[82:83], v[50:51]
ds_read_b128 v[48:51], v9 offset:128
v_pk_mul_f32 v[72:73], v[72:73], v[40:41]
v_pk_mul_f32 v[40:41], v[40:41], v[30:31] op_sel_hi:[1,0]
v_pk_mul_f32 v[74:75], v[74:75], v[42:43]
v_pk_mul_f32 v[42:43], v[42:43], v[30:31] op_sel_hi:[1,0]
v_pk_mul_f32 v[88:89], v[88:89], v[56:57]
v_pk_mul_f32 v[56:57], v[56:57], v[30:31] op_sel_hi:[1,0]
v_pk_mul_f32 v[90:91], v[90:91], v[58:59]
v_pk_mul_f32 v[58:59], v[58:59], v[30:31] op_sel_hi:[1,0]
v_pk_fma_f32 v[36:37], v[36:37], v[22:23], v[22:23] op_sel:[0,1,1] op_sel_hi:[1,1,1]
v_pk_fma_f32 v[38:39], v[38:39], v[22:23], v[22:23] op_sel:[0,1,1] op_sel_hi:[1,1,1]
v_pk_fma_f32 v[52:53], v[52:53], v[22:23], v[22:23] op_sel:[0,1,1] op_sel_hi:[1,1,1]
v_pk_fma_f32 v[54:55], v[54:55], v[22:23], v[22:23] op_sel:[0,1,1] op_sel_hi:[1,1,1]
v_cvt_pk_bf16_f32 v32, v64, v65
v_cvt_pk_bf16_f32 v33, v66, v67
ds_read_b128 v[64:67], v9 offset:192
v_cvt_pk_bf16_f32 v34, v80, v81
v_cvt_pk_bf16_f32 v35, v82, v83
MAA 76,64,140
buffer_store_dwordx4 v[32:35], v10, s[16:19], s62 offen sc1
MAA 76,68,156
ds_read_b128 v[80:83], v9 offset:640
v_rcp_f32 v36, v36
MAA 76,96,172
TR 64,17,16896
v_rcp_f32 v37, v37
s_waitcnt vmcnt(1)
MAA 76,100,188
TR 66,17,17408
v_rcp_f32 v38, v38
MAA 92,108,188
TR 68,17,25344
v_rcp_f32 v39, v39
MAA 92,104,172
TR 70,17,25856
v_rcp_f32 v52, v52
MAA 92,76,156
TR 76,17,25376
v_rcp_f32 v53, v53
MAA 92,72,140
TR 72,17,16928
v_rcp_f32 v54, v54
MAA 44,80,172
TR 74,17,17440
v_rcp_f32 v55, v55
MAA 44,84,188
TR 78,17,25888
v_exp_f32 v40, v40
MAA 60,92,188
TR 80,17,33792
v_exp_f32 v41, v41
MAA 60,88,172
TR 82,17,34304
v_exp_f32 v42, v42
v_exp_f32 v43, v43
v_exp_f32 v56, v56
v_exp_f32 v57, v57
v_exp_f32 v58, v58
v_exp_f32 v59, v59
v_pk_mul_f32 v[68:69], v[68:69], v[36:37]
v_pk_mul_f32 v[70:71], v[70:71], v[38:39]
v_pk_mul_f32 v[84:85], v[84:85], v[52:53]
v_pk_mul_f32 v[86:87], v[86:87], v[54:55]
ds_read_b128 v[52:55], v8 offset:576
v_pk_mul_f32 v[76:77], v[76:77], v[44:45]
v_pk_mul_f32 v[44:45], v[44:45], v[30:31] op_sel:[0,1] op_sel_hi:[1,1]
v_pk_mul_f32 v[78:79], v[78:79], v[46:47]
v_pk_mul_f32 v[46:47], v[46:47], v[30:31] op_sel:[0,1] op_sel_hi:[1,1]
v_pk_mul_f32 v[92:93], v[92:93], v[60:61]
v_pk_mul_f32 v[60:61], v[60:61], v[30:31] op_sel:[0,1] op_sel_hi:[1,1]
v_pk_mul_f32 v[94:95], v[94:95], v[62:63]
v_pk_mul_f32 v[62:63], v[62:63], v[30:31] op_sel:[0,1] op_sel_hi:[1,1]
v_pk_fma_f32 v[40:41], v[40:41], v[24:25], v[24:25] op_sel:[0,1,1] op_sel_hi:[1,1,1]
v_pk_fma_f32 v[42:43], v[42:43], v[24:25], v[24:25] op_sel:[0,1,1] op_sel_hi:[1,1,1]
v_pk_fma_f32 v[56:57], v[56:57], v[24:25], v[24:25] op_sel:[0,1,1] op_sel_hi:[1,1,1]
v_pk_fma_f32 v[58:59], v[58:59], v[24:25], v[24:25] op_sel:[0,1,1] op_sel_hi:[1,1,1]
v_cvt_pk_bf16_f32 v36, v68, v69
v_cvt_pk_bf16_f32 v37, v70, v71
v_cvt_pk_bf16_f32 v38, v84, v85
v_cvt_pk_bf16_f32 v39, v86, v87
MAA 128,192,128
buffer_store_dwordx4 v[36:39], v10, s[16:19], s62 offen offset:1024 sc1
MAA 128,196,144
TR 84,17,42240
v_rcp_f32 v40, v40
MAA 128,0,160
TR 86,17,42752
v_rcp_f32 v41, v41
MAA 128,4,176
TR 88,17,33824
v_rcp_f32 v42, v42
MAA 144,12,176
TR 90,17,34336
v_rcp_f32 v43, v43
MAA 144,8,160
TR 92,17,42272
v_rcp_f32 v56, v56
MAA 144,204,144
TR 94,17,42784
v_rcp_f32 v57, v57
MAA 144,200,128
TR 96,17,50688
v_rcp_f32 v58, v58
MAA 96,112,160
TR 98,17,51200
v_rcp_f32 v59, v59
MAA 96,116,176
TR 100,17,59136
v_exp_f32 v44, v44
MAA 112,124,176
TR 102,17,59648
v_exp_f32 v45, v45
MAA 112,120,160
TR 104,17,50720
v_lshrrev_b32 v69, 2, v0
v_min_u32 v69, 1, v69
v_lshlrev_b32 v69, 28, v69
v_lshl_add_u32 v68, v0, 7, v69
v_xor_b32 v69, 64, v0
v_min_u32 v69, 1, v69
v_lshlrev_b32 v70, 4, v69
v_sub_u32 v70, 16, v70
v_lshlrev_b32 v69, 28, v69
v_mov_b32 v71, 1
v_mov_b32 v84, 0
v_mov_b32 v85, 0
v_mov_b32 v86, 0
v_exp_f32 v46, v46
v_exp_f32 v47, v47
v_exp_f32 v60, v60
v_exp_f32 v61, v61
v_exp_f32 v62, v62
v_exp_f32 v63, v63
v_pk_mul_f32 v[72:73], v[72:73], v[40:41]
v_pk_mul_f32 v[74:75], v[74:75], v[42:43]
v_pk_mul_f32 v[88:89], v[88:89], v[56:57]
v_pk_mul_f32 v[90:91], v[90:91], v[58:59]
s_waitcnt lgkmcnt(15)
v_pk_fma_f32 v[96:97], v[48:49], v[20:21], v[96:97] op_sel_hi:[1,0,1]
v_pk_fma_f32 v[98:99], v[50:51], v[20:21], v[98:99] op_sel_hi:[1,0,1]
v_pk_fma_f32 v[112:113], v[64:65], v[20:21], v[112:113] op_sel_hi:[1,0,1]
v_pk_fma_f32 v[114:115], v[66:67], v[20:21], v[114:115] op_sel_hi:[1,0,1]
v_pk_fma_f32 v[128:129], v[80:81], v[20:21], v[128:129] op_sel_hi:[1,0,1]
v_pk_fma_f32 v[130:131], v[82:83], v[20:21], v[130:131] op_sel_hi:[1,0,1]
v_pk_fma_f32 v[144:145], v[4:5], v[20:21], v[144:145] op_sel_hi:[1,0,1]
v_pk_fma_f32 v[146:147], v[6:7], v[20:21], v[146:147] op_sel_hi:[1,0,1]
v_pk_mul_f32 v[128:129], v[128:129], v[96:97]
v_pk_mul_f32 v[96:97], v[96:97], v[28:29] op_sel_hi:[1,0]
v_pk_mul_f32 v[130:131], v[130:131], v[98:99]
v_pk_mul_f32 v[98:99], v[98:99], v[28:29] op_sel_hi:[1,0]
v_pk_mul_f32 v[144:145], v[144:145], v[112:113]
v_pk_mul_f32 v[112:113], v[112:113], v[28:29] op_sel_hi:[1,0]
v_pk_mul_f32 v[146:147], v[146:147], v[114:115]
v_pk_mul_f32 v[114:115], v[114:115], v[28:29] op_sel_hi:[1,0]
v_pk_fma_f32 v[44:45], v[44:45], v[26:27], v[26:27] op_sel:[0,1,1] op_sel_hi:[1,1,1]
v_pk_fma_f32 v[46:47], v[46:47], v[26:27], v[26:27] op_sel:[0,1,1] op_sel_hi:[1,1,1]
v_pk_fma_f32 v[60:61], v[60:61], v[26:27], v[26:27] op_sel:[0,1,1] op_sel_hi:[1,1,1]
v_pk_fma_f32 v[62:63], v[62:63], v[26:27], v[26:27] op_sel:[0,1,1] op_sel_hi:[1,1,1]
v_cvt_pk_bf16_f32 v40, v72, v73
v_cvt_pk_bf16_f32 v41, v74, v75
v_cvt_pk_bf16_f32 v42, v88, v89
v_cvt_pk_bf16_f32 v43, v90, v91
MAA 132,192,132
buffer_store_dwordx4 v[40:43], v11, s[16:19], s62 offen sc1
MAA 132,196,148
TR 106,17,51232
v_rcp_f32 v44, v44
MAA 132,0,164
TR 108,17,59168
v_rcp_f32 v45, v45
MAA 132,4,180
TR 110,17,59680
v_rcp_f32 v46, v46
MAA 148,12,180
v_rcp_f32 v47, v47
MAA 148,8,164
v_rcp_f32 v60, v60
MAA 148,204,148
v_rcp_f32 v61, v61
MAA 148,200,132
v_rcp_f32 v62, v62
MAA 100,112,164
v_rcp_f32 v63, v63
MAA 100,116,180
v_exp_f32 v96, v96
MAA 116,124,180
v_exp_f32 v97, v97
MAA 116,120,164
s_waitcnt lgkmcnt(0)
s_barrier
s_add_u32 m0, s59, 84480
v_exp_f32 v98, v98
v_exp_f32 v99, v99
v_exp_f32 v112, v112
v_exp_f32 v113, v113
v_exp_f32 v114, v114
v_exp_f32 v115, v115
v_pk_mul_f32 v[76:77], v[76:77], v[44:45]
v_pk_mul_f32 v[78:79], v[78:79], v[46:47]
v_pk_mul_f32 v[92:93], v[92:93], v[60:61]
v_pk_mul_f32 v[94:95], v[94:95], v[62:63]
v_pk_fma_f32 v[100:101], v[48:49], v[22:23], v[100:101] op_sel_hi:[1,0,1]
v_pk_fma_f32 v[102:103], v[50:51], v[22:23], v[102:103] op_sel_hi:[1,0,1]
v_pk_fma_f32 v[116:117], v[64:65], v[22:23], v[116:117] op_sel_hi:[1,0,1]
v_pk_fma_f32 v[118:119], v[66:67], v[22:23], v[118:119] op_sel_hi:[1,0,1]
v_pk_fma_f32 v[132:133], v[80:81], v[22:23], v[132:133] op_sel_hi:[1,0,1]
v_pk_fma_f32 v[134:135], v[82:83], v[22:23], v[134:135] op_sel_hi:[1,0,1]
v_pk_fma_f32 v[148:149], v[4:5], v[22:23], v[148:149] op_sel_hi:[1,0,1]
v_pk_fma_f32 v[150:151], v[6:7], v[22:23], v[150:151] op_sel_hi:[1,0,1]
v_pk_mul_f32 v[132:133], v[132:133], v[100:101]
v_pk_mul_f32 v[100:101], v[100:101], v[28:29] op_sel:[0,1] op_sel_hi:[1,1]
v_pk_mul_f32 v[134:135], v[134:135], v[102:103]
v_pk_mul_f32 v[102:103], v[102:103], v[28:29] op_sel:[0,1] op_sel_hi:[1,1]
v_pk_mul_f32 v[148:149], v[148:149], v[116:117]
v_pk_mul_f32 v[116:117], v[116:117], v[28:29] op_sel:[0,1] op_sel_hi:[1,1]
v_pk_mul_f32 v[150:151], v[150:151], v[118:119]
v_pk_mul_f32 v[118:119], v[118:119], v[28:29] op_sel:[0,1] op_sel_hi:[1,1]
v_pk_fma_f32 v[96:97], v[96:97], v[20:21], v[20:21] op_sel:[0,1,1] op_sel_hi:[1,1,1]
v_pk_fma_f32 v[98:99], v[98:99], v[20:21], v[20:21] op_sel:[0,1,1] op_sel_hi:[1,1,1]
v_pk_fma_f32 v[112:113], v[112:113], v[20:21], v[20:21] op_sel:[0,1,1] op_sel_hi:[1,1,1]
v_pk_fma_f32 v[114:115], v[114:115], v[20:21], v[20:21] op_sel:[0,1,1] op_sel_hi:[1,1,1]
v_cvt_pk_bf16_f32 v44, v76, v77
v_cvt_pk_bf16_f32 v45, v78, v79
v_cvt_pk_bf16_f32 v46, v92, v93
v_cvt_pk_bf16_f32 v47, v94, v95
MAA 136,192,136
buffer_store_dwordx4 v[44:47], v11, s[16:19], s62 offen offset:1024 sc1
MAA 136,196,152
v_rcp_f32 v96, v96
MAA 136,0,168
v_rcp_f32 v97, v97
MAA 136,4,184
v_rcp_f32 v98, v98
MAA 152,12,184
buffer_load_dwordx4 v18, s[28:31], s58 offen lds
MAA 152,8,168
v_rcp_f32 v99, v99
MAA 152,204,152
v_rcp_f32 v112, v112
MAA 152,200,136
v_rcp_f32 v113, v113
MAA 104,112,168
buffer_load_dwordx4 v19, s[28:31], s58 offen offset:1056 lds
MAA 104,116,184
s_add_u32 m0, s59, 92928
s_add_u32 s58, s99, 2555904
v_rcp_f32 v114, v114
MAA 120,124,184
v_rcp_f32 v115, v115
MAA 120,120,168
v_exp_f32 v100, v100
v_exp_f32 v101, v101
v_exp_f32 v102, v102
v_exp_f32 v103, v103
v_exp_f32 v116, v116
v_exp_f32 v117, v117
v_exp_f32 v118, v118
v_exp_f32 v119, v119
v_pk_mul_f32 v[128:129], v[128:129], v[96:97]
v_pk_mul_f32 v[130:131], v[130:131], v[98:99]
v_pk_mul_f32 v[144:145], v[144:145], v[112:113]
v_pk_mul_f32 v[146:147], v[146:147], v[114:115]
ds_read_b128 v[112:115], v9 offset:256
v_pk_fma_f32 v[104:105], v[48:49], v[24:25], v[104:105] op_sel_hi:[1,0,1]
v_pk_fma_f32 v[106:107], v[50:51], v[24:25], v[106:107] op_sel_hi:[1,0,1]
v_pk_fma_f32 v[120:121], v[64:65], v[24:25], v[120:121] op_sel_hi:[1,0,1]
v_pk_fma_f32 v[122:123], v[66:67], v[24:25], v[122:123] op_sel_hi:[1,0,1]
v_pk_fma_f32 v[136:137], v[80:81], v[24:25], v[136:137] op_sel_hi:[1,0,1]
v_pk_fma_f32 v[138:139], v[82:83], v[24:25], v[138:139] op_sel_hi:[1,0,1]
v_pk_fma_f32 v[152:153], v[4:5], v[24:25], v[152:153] op_sel_hi:[1,0,1]
v_pk_fma_f32 v[154:155], v[6:7], v[24:25], v[154:155] op_sel_hi:[1,0,1]
v_pk_mul_f32 v[136:137], v[136:137], v[104:105]
v_pk_mul_f32 v[104:105], v[104:105], v[30:31] op_sel_hi:[1,0]
v_pk_mul_f32 v[138:139], v[138:139], v[106:107]
v_pk_mul_f32 v[106:107], v[106:107], v[30:31] op_sel_hi:[1,0]
v_pk_mul_f32 v[152:153], v[152:153], v[120:121]
v_pk_mul_f32 v[120:121], v[120:121], v[30:31] op_sel_hi:[1,0]
v_pk_mul_f32 v[154:155], v[154:155], v[122:123]
v_pk_mul_f32 v[122:123], v[122:123], v[30:31] op_sel_hi:[1,0]
v_pk_fma_f32 v[100:101], v[100:101], v[22:23], v[22:23] op_sel:[0,1,1] op_sel_hi:[1,1,1]
v_pk_fma_f32 v[102:103], v[102:103], v[22:23], v[22:23] op_sel:[0,1,1] op_sel_hi:[1,1,1]
v_pk_fma_f32 v[116:117], v[116:117], v[22:23], v[22:23] op_sel:[0,1,1] op_sel_hi:[1,1,1]
v_pk_fma_f32 v[118:119], v[118:119], v[22:23], v[22:23] op_sel:[0,1,1] op_sel_hi:[1,1,1]
v_cvt_pk_bf16_f32 v96, v128, v129
v_cvt_pk_bf16_f32 v97, v130, v131
ds_read_b128 v[128:131], v9 offset:320
v_cvt_pk_bf16_f32 v98, v144, v145
v_cvt_pk_bf16_f32 v99, v146, v147
MAA 140,192,140
buffer_store_dwordx4 v[96:99], v10, s[16:19], s63 offen sc1
MAA 140,196,156
ds_read_b128 v[144:147], v9 offset:768
v_rcp_f32 v100, v100
MAA 140,0,172
v_rcp_f32 v101, v101
MAA 140,4,188
v_rcp_f32 v102, v102
MAA 156,12,188
buffer_load_dwordx4 v18, s[28:31], s58 offen lds
MAA 156,8,172
v_rcp_f32 v103, v103
MAA 156,204,156
v_rcp_f32 v116, v116
MAA 156,200,140
v_rcp_f32 v117, v117
MAA 108,112,172
buffer_load_dwordx4 v19, s[28:31], s58 offen offset:1056 lds
MAA 108,116,188
s_add_u32 m0, s59, 101376
s_add_u32 s58, s100, 2752512
v_rcp_f32 v118, v118
MAA 124,124,188
v_rcp_f32 v119, v119
MAA 124,120,172
v_exp_f32 v104, v104
v_exp_f32 v105, v105
v_exp_f32 v106, v106
v_exp_f32 v107, v107
v_exp_f32 v120, v120
v_exp_f32 v121, v121
v_exp_f32 v122, v122
v_exp_f32 v123, v123
v_pk_mul_f32 v[132:133], v[132:133], v[100:101]
v_pk_mul_f32 v[134:135], v[134:135], v[102:103]
v_pk_mul_f32 v[148:149], v[148:149], v[116:117]
v_pk_mul_f32 v[150:151], v[150:151], v[118:119]
v_pk_fma_f32 v[108:109], v[48:49], v[26:27], v[108:109] op_sel_hi:[1,0,1]
v_pk_fma_f32 v[110:111], v[50:51], v[26:27], v[110:111] op_sel_hi:[1,0,1]
v_pk_fma_f32 v[124:125], v[64:65], v[26:27], v[124:125] op_sel_hi:[1,0,1]
v_pk_fma_f32 v[126:127], v[66:67], v[26:27], v[126:127] op_sel_hi:[1,0,1]
v_pk_fma_f32 v[140:141], v[80:81], v[26:27], v[140:141] op_sel_hi:[1,0,1]
v_pk_fma_f32 v[142:143], v[82:83], v[26:27], v[142:143] op_sel_hi:[1,0,1]
v_pk_fma_f32 v[156:157], v[4:5], v[26:27], v[156:157] op_sel_hi:[1,0,1]
v_pk_fma_f32 v[158:159], v[6:7], v[26:27], v[158:159] op_sel_hi:[1,0,1]
v_pk_mul_f32 v[140:141], v[140:141], v[108:109]
v_pk_mul_f32 v[108:109], v[108:109], v[30:31] op_sel:[0,1] op_sel_hi:[1,1]
v_pk_mul_f32 v[142:143], v[142:143], v[110:111]
v_pk_mul_f32 v[110:111], v[110:111], v[30:31] op_sel:[0,1] op_sel_hi:[1,1]
v_pk_mul_f32 v[156:157], v[156:157], v[124:125]
s_waitcnt vmcnt(5)
s_barrier
buffer_atomic_add v71, v68, s[16:19], s72 offen offset:512
v_pk_mul_f32 v[124:125], v[124:125], v[30:31] op_sel:[0,1] op_sel_hi:[1,1]
v_pk_mul_f32 v[158:159], v[158:159], v[126:127]
v_pk_mul_f32 v[126:127], v[126:127], v[30:31] op_sel:[0,1] op_sel_hi:[1,1]
v_pk_fma_f32 v[104:105], v[104:105], v[24:25], v[24:25] op_sel:[0,1,1] op_sel_hi:[1,1,1]
v_pk_fma_f32 v[106:107], v[106:107], v[24:25], v[24:25] op_sel:[0,1,1] op_sel_hi:[1,1,1]
v_pk_fma_f32 v[120:121], v[120:121], v[24:25], v[24:25] op_sel:[0,1,1] op_sel_hi:[1,1,1]
v_pk_fma_f32 v[122:123], v[122:123], v[24:25], v[24:25] op_sel:[0,1,1] op_sel_hi:[1,1,1]
v_cvt_pk_bf16_f32 v100, v132, v133
v_cvt_pk_bf16_f32 v101, v134, v135
v_cvt_pk_bf16_f32 v102, v148, v149
v_cvt_pk_bf16_f32 v103, v150, v151
MAA 192,16,128
v_rcp_f32 v104, v104
MAA 192,20,144
buffer_store_dwordx4 v[100:103], v10, s[16:19], s63 offen offset:1024 sc1
MAA 192,48,160
v_rcp_f32 v105, v105
MAA 192,52,176
v_rcp_f32 v106, v106
MAA 208,60,176
v_rcp_f32 v107, v107
MAA 208,56,160
buffer_load_dwordx4 v18, s[28:31], s58 offen lds
MAA 208,28,144
v_rcp_f32 v120, v120
MAA 208,24,128
v_rcp_f32 v121, v121
MAA 160,32,160
v_rcp_f32 v122, v122
MAA 160,36,176
buffer_load_dwordx4 v19, s[28:31], s58 offen offset:1056 lds
MAA 176,44,176
s_add_u32 m0, s59, 109824
s_add_u32 s58, s100, 3014656
v_rcp_f32 v123, v123
MAA 176,40,160
v_exp_f32 v108, v108
v_exp_f32 v109, v109
v_exp_f32 v110, v110
v_exp_f32 v111, v111
v_exp_f32 v124, v124
v_exp_f32 v125, v125
v_exp_f32 v126, v126
v_exp_f32 v127, v127
v_pk_mul_f32 v[136:137], v[136:137], v[104:105]
v_pk_mul_f32 v[138:139], v[138:139], v[106:107]
v_pk_mul_f32 v[152:153], v[152:153], v[120:121]
v_pk_mul_f32 v[154:155], v[154:155], v[122:123]
s_waitcnt lgkmcnt(2)
v_pk_fma_f32 v[160:161], v[112:113], v[20:21], v[160:161] op_sel_hi:[1,0,1]
v_pk_fma_f32 v[162:163], v[114:115], v[20:21], v[162:163] op_sel_hi:[1,0,1]
s_waitcnt lgkmcnt(1)
v_pk_fma_f32 v[176:177], v[128:129], v[20:21], v[176:177] op_sel_hi:[1,0,1]
v_pk_fma_f32 v[178:179], v[130:131], v[20:21], v[178:179] op_sel_hi:[1,0,1]
s_waitcnt lgkmcnt(0)
v_pk_fma_f32 v[192:193], v[144:145], v[20:21], v[192:193] op_sel_hi:[1,0,1]
v_pk_fma_f32 v[194:195], v[146:147], v[20:21], v[194:195] op_sel_hi:[1,0,1]
v_pk_fma_f32 v[208:209], v[12:13], v[20:21], v[208:209] op_sel_hi:[1,0,1]
v_pk_fma_f32 v[210:211], v[14:15], v[20:21], v[210:211] op_sel_hi:[1,0,1]
v_pk_mul_f32 v[192:193], v[192:193], v[160:161]
v_pk_mul_f32 v[160:161], v[160:161], v[28:29] op_sel_hi:[1,0]
v_pk_mul_f32 v[194:195], v[194:195], v[162:163]
v_pk_mul_f32 v[162:163], v[162:163], v[28:29] op_sel_hi:[1,0]
v_pk_mul_f32 v[208:209], v[208:209], v[176:177]
v_pk_mul_f32 v[176:177], v[176:177], v[28:29] op_sel_hi:[1,0]
v_pk_mul_f32 v[210:211], v[210:211], v[178:179]
v_pk_mul_f32 v[178:179], v[178:179], v[28:29] op_sel_hi:[1,0]
v_pk_fma_f32 v[108:109], v[108:109], v[26:27], v[26:27] op_sel:[0,1,1] op_sel_hi:[1,1,1]
v_pk_fma_f32 v[110:111], v[110:111], v[26:27], v[26:27] op_sel:[0,1,1] op_sel_hi:[1,1,1]
v_pk_fma_f32 v[124:125], v[124:125], v[26:27], v[26:27] op_sel:[0,1,1] op_sel_hi:[1,1,1]
v_pk_fma_f32 v[126:127], v[126:127], v[26:27], v[26:27] op_sel:[0,1,1] op_sel_hi:[1,1,1]
v_cvt_pk_bf16_f32 v104, v136, v137
v_cvt_pk_bf16_f32 v105, v138, v139
v_cvt_pk_bf16_f32 v106, v152, v153
v_cvt_pk_bf16_f32 v107, v154, v155
MAA 196,16,132
buffer_store_dwordx4 v[104:107], v11, s[16:19], s63 offen sc1
MAA 196,20,148
v_rcp_f32 v108, v108
MAA 196,48,164
v_rcp_f32 v109, v109
MAA 196,52,180
v_rcp_f32 v110, v110
MAA 212,60,180
buffer_load_dwordx4 v18, s[28:31], s58 offen lds
MAA 212,56,164
v_rcp_f32 v111, v111
MAA 212,28,148
v_rcp_f32 v124, v124
MAA 212,24,132
v_rcp_f32 v125, v125
MAA 164,32,164
buffer_load_dwordx4 v19, s[28:31], s58 offen offset:1056 lds
MAA 164,36,180
s_add_u32 m0, s59, 118272
s_add_u32 s58, s101, 3211264
v_rcp_f32 v126, v126
MAA 180,44,180
v_rcp_f32 v127, v127
MAA 180,40,164
v_lshl_add_u32 v4, v1, 4, s74
v_add_u32 v2, 67108480, v4
v_cndmask_b32 v4, v4, v2, vcc
s_and_b32 s74, s7, 1
v_bfe_u32 v7, v1, 2, 3
v_mul_u32_u24 v7, 1056, v7
v_bfe_u32 v2, v1, 5, 1
v_lshl_add_u32 v7, v2, 8, v7
v_and_b32 v2, 3, v1
v_lshl_add_u32 v7, v2, 3, v7
s_lshl_b32 s74, s74, 7
.Lpad6:
s_cbranch_execz .Lpad9
s_xor_b32 s75, s74, 128
v_add_u32 v6, s75, v7
v_add_u32 v7, s74, v7
v_exp_f32 v160, v160
v_exp_f32 v161, v161
v_exp_f32 v162, v162
v_exp_f32 v163, v163
v_exp_f32 v176, v176
v_exp_f32 v177, v177
v_exp_f32 v178, v178
v_exp_f32 v179, v179
v_pk_mul_f32 v[140:141], v[140:141], v[108:109]
v_pk_mul_f32 v[142:143], v[142:143], v[110:111]
v_pk_mul_f32 v[156:157], v[156:157], v[124:125]
v_pk_mul_f32 v[158:159], v[158:159], v[126:127]
v_pk_fma_f32 v[164:165], v[112:113], v[22:23], v[164:165] op_sel_hi:[1,0,1]
v_pk_fma_f32 v[166:167], v[114:115], v[22:23], v[166:167] op_sel_hi:[1,0,1]
v_pk_fma_f32 v[180:181], v[128:129], v[22:23], v[180:181] op_sel_hi:[1,0,1]
v_pk_fma_f32 v[182:183], v[130:131], v[22:23], v[182:183] op_sel_hi:[1,0,1]
v_pk_fma_f32 v[196:197], v[144:145], v[22:23], v[196:197] op_sel_hi:[1,0,1]
v_pk_fma_f32 v[198:199], v[146:147], v[22:23], v[198:199] op_sel_hi:[1,0,1]
v_pk_fma_f32 v[212:213], v[12:13], v[22:23], v[212:213] op_sel_hi:[1,0,1]
v_pk_fma_f32 v[214:215], v[14:15], v[22:23], v[214:215] op_sel_hi:[1,0,1]
v_pk_mul_f32 v[196:197], v[196:197], v[164:165]
v_pk_mul_f32 v[164:165], v[164:165], v[28:29] op_sel:[0,1] op_sel_hi:[1,1]
v_pk_mul_f32 v[198:199], v[198:199], v[166:167]
v_pk_mul_f32 v[166:167], v[166:167], v[28:29] op_sel:[0,1] op_sel_hi:[1,1]
v_pk_mul_f32 v[212:213], v[212:213], v[180:181]
v_pk_mul_f32 v[180:181], v[180:181], v[28:29] op_sel:[0,1] op_sel_hi:[1,1]
v_pk_mul_f32 v[214:215], v[214:215], v[182:183]
v_pk_mul_f32 v[182:183], v[182:183], v[28:29] op_sel:[0,1] op_sel_hi:[1,1]
v_pk_fma_f32 v[160:161], v[160:161], v[20:21], v[20:21] op_sel:[0,1,1] op_sel_hi:[1,1,1]
v_pk_fma_f32 v[162:163], v[162:163], v[20:21], v[20:21] op_sel:[0,1,1] op_sel_hi:[1,1,1]
v_pk_fma_f32 v[176:177], v[176:177], v[20:21], v[20:21] op_sel:[0,1,1] op_sel_hi:[1,1,1]
v_pk_fma_f32 v[178:179], v[178:179], v[20:21], v[20:21] op_sel:[0,1,1] op_sel_hi:[1,1,1]
v_cvt_pk_bf16_f32 v108, v140, v141
v_cvt_pk_bf16_f32 v109, v142, v143
v_cvt_pk_bf16_f32 v110, v156, v157
v_cvt_pk_bf16_f32 v111, v158, v159
MAA 200,16,136
buffer_store_dwordx4 v[108:111], v11, s[16:19], s63 offen offset:1024 sc1
MAA 200,20,152
v_rcp_f32 v160, v160
MAA 200,48,168
v_rcp_f32 v161, v161
MAA 200,52,184
v_rcp_f32 v162, v162
MAA 216,60,184
buffer_load_dwordx4 v18, s[28:31], s58 offen lds
MAA 216,56,168
v_rcp_f32 v163, v163
MAA 216,28,152
v_rcp_f32 v176, v176
MAA 216,24,136
v_rcp_f32 v177, v177
MAA 168,32,168
buffer_load_dwordx4 v19, s[28:31], s58 offen offset:1056 lds
MAA 168,36,184
s_add_u32 m0, s59, 126720
s_add_u32 s58, s101, 3473408
v_rcp_f32 v178, v178
MAA 184,44,184
v_rcp_f32 v179, v179
MAA 184,40,168
v_exp_f32 v164, v164
v_exp_f32 v165, v165
v_exp_f32 v166, v166
v_exp_f32 v167, v167
v_exp_f32 v180, v180
v_exp_f32 v181, v181
v_exp_f32 v182, v182
v_exp_f32 v183, v183
v_pk_mul_f32 v[192:193], v[192:193], v[160:161]
v_pk_mul_f32 v[194:195], v[194:195], v[162:163]
v_pk_mul_f32 v[208:209], v[208:209], v[176:177]
v_pk_mul_f32 v[210:211], v[210:211], v[178:179]
ds_read_b128 v[176:179], v8
v_pk_fma_f32 v[168:169], v[112:113], v[24:25], v[168:169] op_sel_hi:[1,0,1]
v_pk_fma_f32 v[170:171], v[114:115], v[24:25], v[170:171] op_sel_hi:[1,0,1]
v_pk_fma_f32 v[184:185], v[128:129], v[24:25], v[184:185] op_sel_hi:[1,0,1]
v_pk_fma_f32 v[186:187], v[130:131], v[24:25], v[186:187] op_sel_hi:[1,0,1]
v_pk_fma_f32 v[200:201], v[144:145], v[24:25], v[200:201] op_sel_hi:[1,0,1]
v_pk_fma_f32 v[202:203], v[146:147], v[24:25], v[202:203] op_sel_hi:[1,0,1]
v_pk_fma_f32 v[216:217], v[12:13], v[24:25], v[216:217] op_sel_hi:[1,0,1]
v_pk_fma_f32 v[218:219], v[14:15], v[24:25], v[218:219] op_sel_hi:[1,0,1]
v_pk_mul_f32 v[200:201], v[200:201], v[168:169]
v_pk_mul_f32 v[168:169], v[168:169], v[30:31] op_sel_hi:[1,0]
v_pk_mul_f32 v[202:203], v[202:203], v[170:171]
v_pk_mul_f32 v[170:171], v[170:171], v[30:31] op_sel_hi:[1,0]
v_pk_mul_f32 v[216:217], v[216:217], v[184:185]
v_pk_mul_f32 v[184:185], v[184:185], v[30:31] op_sel_hi:[1,0]
v_pk_mul_f32 v[218:219], v[218:219], v[186:187]
v_pk_mul_f32 v[186:187], v[186:187], v[30:31] op_sel_hi:[1,0]
v_pk_fma_f32 v[164:165], v[164:165], v[22:23], v[22:23] op_sel:[0,1,1] op_sel_hi:[1,1,1]
v_pk_fma_f32 v[166:167], v[166:167], v[22:23], v[22:23] op_sel:[0,1,1] op_sel_hi:[1,1,1]
v_pk_fma_f32 v[180:181], v[180:181], v[22:23], v[22:23] op_sel:[0,1,1] op_sel_hi:[1,1,1]
v_pk_fma_f32 v[182:183], v[182:183], v[22:23], v[22:23] op_sel:[0,1,1] op_sel_hi:[1,1,1]
v_cvt_pk_bf16_f32 v160, v192, v193
v_cvt_pk_bf16_f32 v161, v194, v195
ds_read_b128 v[192:195], v8 offset:64
v_cvt_pk_bf16_f32 v162, v208, v209
v_cvt_pk_bf16_f32 v163, v210, v211
MAA 204,16,140
buffer_store_dwordx4 v[160:163], v10, s[16:19], s64 offen sc1
MAA 204,20,156
ds_read_b128 v[208:211], v8 offset:512
v_rcp_f32 v164, v164
MAA 204,48,172
v_rcp_f32 v165, v165
MAA 204,52,188
v_rcp_f32 v166, v166
MAA 220,60,188
buffer_atomic_add v84, v69, s[16:19], s73 offen offset:512 sc0
MAA 220,56,172
v_rcp_f32 v167, v167
MAA 220,28,156
v_rcp_f32 v180, v180
MAA 220,24,140
v_rcp_f32 v181, v181
MAA 172,32,172
buffer_load_dwordx4 v18, s[28:31], s58 offen lds
MAA 172,36,188
v_rcp_f32 v182, v182
MAA 188,44,188
v_rcp_f32 v183, v183
MAA 188,40,172
v_exp_f32 v168, v168
v_exp_f32 v169, v169
v_exp_f32 v170, v170
v_exp_f32 v171, v171
v_exp_f32 v184, v184
v_exp_f32 v185, v185
v_exp_f32 v186, v186
v_exp_f32 v187, v187
v_pk_mul_f32 v[196:197], v[196:197], v[164:165]
v_pk_mul_f32 v[198:199], v[198:199], v[166:167]
v_pk_mul_f32 v[212:213], v[212:213], v[180:181]
v_pk_mul_f32 v[214:215], v[214:215], v[182:183]
v_pk_fma_f32 v[172:173], v[112:113], v[26:27], v[172:173] op_sel_hi:[1,0,1]
v_pk_fma_f32 v[174:175], v[114:115], v[26:27], v[174:175] op_sel_hi:[1,0,1]
v_pk_fma_f32 v[188:189], v[128:129], v[26:27], v[188:189] op_sel_hi:[1,0,1]
v_pk_fma_f32 v[190:191], v[130:131], v[26:27], v[190:191] op_sel_hi:[1,0,1]
v_pk_fma_f32 v[204:205], v[144:145], v[26:27], v[204:205] op_sel_hi:[1,0,1]
v_pk_fma_f32 v[206:207], v[146:147], v[26:27], v[206:207] op_sel_hi:[1,0,1]
v_pk_fma_f32 v[220:221], v[12:13], v[26:27], v[220:221] op_sel_hi:[1,0,1]
v_pk_fma_f32 v[222:223], v[14:15], v[26:27], v[222:223] op_sel_hi:[1,0,1]
v_pk_mul_f32 v[204:205], v[204:205], v[172:173]
v_pk_mul_f32 v[172:173], v[172:173], v[30:31] op_sel:[0,1] op_sel_hi:[1,1]
v_pk_mul_f32 v[206:207], v[206:207], v[174:175]
v_pk_mul_f32 v[174:175], v[174:175], v[30:31] op_sel:[0,1] op_sel_hi:[1,1]
v_pk_mul_f32 v[220:221], v[220:221], v[188:189]
v_pk_mul_f32 v[188:189], v[188:189], v[30:31] op_sel:[0,1] op_sel_hi:[1,1]
v_pk_mul_f32 v[222:223], v[222:223], v[190:191]
v_pk_mul_f32 v[190:191], v[190:191], v[30:31] op_sel:[0,1] op_sel_hi:[1,1]
v_pk_fma_f32 v[168:169], v[168:169], v[24:25], v[24:25] op_sel:[0,1,1] op_sel_hi:[1,1,1]
v_pk_fma_f32 v[170:171], v[170:171], v[24:25], v[24:25] op_sel:[0,1,1] op_sel_hi:[1,1,1]
v_pk_fma_f32 v[184:185], v[184:185], v[24:25], v[24:25] op_sel:[0,1,1] op_sel_hi:[1,1,1]
v_pk_fma_f32 v[186:187], v[186:187], v[24:25], v[24:25] op_sel:[0,1,1] op_sel_hi:[1,1,1]
v_cvt_pk_bf16_f32 v164, v196, v197
v_cvt_pk_bf16_f32 v165, v198, v199
v_cvt_pk_bf16_f32 v166, v212, v213
v_cvt_pk_bf16_f32 v167, v214, v215
MAA 240,64,128
buffer_store_dwordx4 v[164:167], v10, s[16:19], s64 offen offset:1024 sc1
MAA 240,68,144
v_rcp_f32 v168, v168
MAA 240,96,160
v_rcp_f32 v169, v169
MAA 240,100,176
v_rcp_f32 v170, v170
MAA 248,108,176
buffer_atomic_add v85, v69, s[16:19], s73 offen offset:512 sc0
MAA 248,104,160
v_rcp_f32 v171, v171
MAA 248,76,144
v_rcp_f32 v184, v184
MAA 248,72,128
v_rcp_f32 v185, v185
MAA 224,80,160
buffer_load_dwordx4 v19, s[28:31], s58 offen offset:1056 lds
MAA 224,84,176
v_rcp_f32 v186, v186
MAA 232,92,176
v_rcp_f32 v187, v187
MAA 232,88,160
v_exp_f32 v172, v172
v_exp_f32 v173, v173
v_exp_f32 v174, v174
v_exp_f32 v175, v175
v_exp_f32 v188, v188
v_exp_f32 v189, v189
v_exp_f32 v190, v190
v_exp_f32 v191, v191
v_pk_mul_f32 v[200:201], v[200:201], v[168:169]
v_pk_mul_f32 v[202:203], v[202:203], v[170:171]
v_pk_mul_f32 v[216:217], v[216:217], v[184:185]
v_pk_mul_f32 v[218:219], v[218:219], v[186:187]
s_waitcnt lgkmcnt(2)
v_pk_fma_f32 v[224:225], v[176:177], v[20:21], v[224:225] op_sel_hi:[1,0,1]
v_pk_fma_f32 v[226:227], v[178:179], v[20:21], v[226:227] op_sel_hi:[1,0,1]
s_waitcnt lgkmcnt(1)
v_pk_fma_f32 v[232:233], v[192:193], v[20:21], v[232:233] op_sel_hi:[1,0,1]
v_pk_fma_f32 v[234:235], v[194:195], v[20:21], v[234:235] op_sel_hi:[1,0,1]
s_waitcnt lgkmcnt(0)
v_pk_fma_f32 v[240:241], v[208:209], v[20:21], v[240:241] op_sel_hi:[1,0,1]
v_pk_fma_f32 v[242:243], v[210:211], v[20:21], v[242:243] op_sel_hi:[1,0,1]
v_pk_fma_f32 v[248:249], v[52:53], v[20:21], v[248:249] op_sel_hi:[1,0,1]
v_pk_fma_f32 v[250:251], v[54:55], v[20:21], v[250:251] op_sel_hi:[1,0,1]
v_pk_mul_f32 v[240:241], v[240:241], v[224:225]
v_pk_mul_f32 v[224:225], v[224:225], v[28:29] op_sel_hi:[1,0]
v_pk_mul_f32 v[242:243], v[242:243], v[226:227]
v_pk_mul_f32 v[226:227], v[226:227], v[28:29] op_sel_hi:[1,0]
v_pk_mul_f32 v[248:249], v[248:249], v[232:233]
v_pk_mul_f32 v[232:233], v[232:233], v[28:29] op_sel_hi:[1,0]
v_pk_mul_f32 v[250:251], v[250:251], v[234:235]
v_pk_mul_f32 v[234:235], v[234:235], v[28:29] op_sel_hi:[1,0]
v_pk_fma_f32 v[172:173], v[172:173], v[26:27], v[26:27] op_sel:[0,1,1] op_sel_hi:[1,1,1]
v_pk_fma_f32 v[174:175], v[174:175], v[26:27], v[26:27] op_sel:[0,1,1] op_sel_hi:[1,1,1]
v_pk_fma_f32 v[188:189], v[188:189], v[26:27], v[26:27] op_sel:[0,1,1] op_sel_hi:[1,1,1]
v_pk_fma_f32 v[190:191], v[190:191], v[26:27], v[26:27] op_sel:[0,1,1] op_sel_hi:[1,1,1]
v_cvt_pk_bf16_f32 v168, v200, v201
v_cvt_pk_bf16_f32 v169, v202, v203
v_cvt_pk_bf16_f32 v170, v216, v217
v_cvt_pk_bf16_f32 v171, v218, v219
buffer_store_dwordx4 v[168:171], v11, s[16:19], s64 offen sc1
buffer_atomic_add v86, v69, s[16:19], s73 offen offset:512 sc0
s_waitcnt vmcnt(6)
v_cmp_gt_u32 vcc, v70, v84
s_nop 0
s_cbranch_vccz .Lok49
s_waitcnt vmcnt(3)
v_cmp_gt_u32 vcc, v70, v85
s_nop 0
s_cbranch_vccz .Lok49
s_waitcnt vmcnt(0)
v_cmp_gt_u32 vcc, v70, v86
s_nop 0
s_cbranch_vccz .Lok49
s_mov_b32 s15, 0
.Lok49l:
v_mov_b32 v84, 0
buffer_atomic_add v84, v69, s[16:19], s73 offen offset:512 sc0
s_add_u32 s15, s15, 1
s_cmp_gt_u32 s15, 100000
s_waitcnt vmcnt(0)
s_cbranch_scc1 .Lok49
v_cmp_gt_u32 vcc, v70, v84
s_nop 0
s_cbranch_vccnz .Lok49l
.Lok49:
s_waitcnt vmcnt(2)
s_barrier
MAA 244,64,132
ds_read_b64_tr_b16 a[0:1], v7
s_add_u32 s52, s76, 0
MAA 244,68,148
buffer_load_dwordx4 v[96:99], v4, s[16:19], s52 offen sc1
MAA 244,96,164
TR 2,7,512
v_rcp_f32 v172, v172
MAA 244,100,180
TR 4,7,32
v_rcp_f32 v173, v173
MAA 252,108,180
TR 6,7,544
v_rcp_f32 v174, v174
MAA 252,104,164
buffer_load_dwordx4 v[100:103], v4, s[16:19], s52 offen offset:1024 sc1
MAA 252,76,148
TR 8,7,64
s_add_u32 s52, s76, 65536
MAA 252,72,132
TR 10,7,576
v_rcp_f32 v175, v175
MAA 228,80,164
TR 12,7,96
v_rcp_f32 v188, v188
MAA 228,84,180
buffer_load_dwordx4 v[104:107], v4, s[16:19], s52 offen sc1
MAA 236,92,180
TR 14,7,608
v_rcp_f32 v189, v189
MAA 236,88,164
TR 16,7,8448
v_rcp_f32 v190, v190
v_rcp_f32 v191, v191
v_exp_f32 v224, v224
v_exp_f32 v225, v225
v_exp_f32 v226, v226
v_exp_f32 v227, v227
v_exp_f32 v232, v232
v_exp_f32 v233, v233
v_exp_f32 v234, v234
v_exp_f32 v235, v235
v_pk_mul_f32 v[204:205], v[204:205], v[172:173]
buffer_load_dwordx4 v[108:111], v4, s[16:19], s52 offen offset:1024 sc1
s_add_u32 s52, s77, 114688
v_pk_mul_f32 v[206:207], v[206:207], v[174:175]
v_pk_mul_f32 v[220:221], v[220:221], v[188:189]
v_pk_mul_f32 v[222:223], v[222:223], v[190:191]
v_pk_fma_f32 v[228:229], v[176:177], v[22:23], v[228:229] op_sel_hi:[1,0,1]
v_pk_fma_f32 v[230:231], v[178:179], v[22:23], v[230:231] op_sel_hi:[1,0,1]
v_pk_fma_f32 v[236:237], v[192:193], v[22:23], v[236:237] op_sel_hi:[1,0,1]
v_pk_fma_f32 v[238:239], v[194:195], v[22:23], v[238:239] op_sel_hi:[1,0,1]
v_pk_fma_f32 v[244:245], v[208:209], v[22:23], v[244:245] op_sel_hi:[1,0,1]
v_pk_fma_f32 v[246:247], v[210:211], v[22:23], v[246:247] op_sel_hi:[1,0,1]
v_pk_fma_f32 v[252:253], v[52:53], v[22:23], v[252:253] op_sel_hi:[1,0,1]
v_pk_fma_f32 v[254:255], v[54:55], v[22:23], v[254:255] op_sel_hi:[1,0,1]
v_pk_mul_f32 v[244:245], v[244:245], v[228:229]
buffer_load_dwordx4 v[112:115], v4, s[16:19], s52 offen sc1
v_pk_mul_f32 v[228:229], v[228:229], v[28:29] op_sel:[0,1] op_sel_hi:[1,1]
v_pk_mul_f32 v[246:247], v[246:247], v[230:231]
v_pk_mul_f32 v[230:231], v[230:231], v[28:29] op_sel:[0,1] op_sel_hi:[1,1]
v_pk_mul_f32 v[252:253], v[252:253], v[236:237]
v_pk_mul_f32 v[236:237], v[236:237], v[28:29] op_sel:[0,1] op_sel_hi:[1,1]
v_pk_mul_f32 v[254:255], v[254:255], v[238:239]
v_pk_mul_f32 v[238:239], v[238:239], v[28:29] op_sel:[0,1] op_sel_hi:[1,1]
v_pk_fma_f32 v[224:225], v[224:225], v[20:21], v[20:21] op_sel:[0,1,1] op_sel_hi:[1,1,1]
v_pk_fma_f32 v[226:227], v[226:227], v[20:21], v[20:21] op_sel:[0,1,1] op_sel_hi:[1,1,1]
v_pk_fma_f32 v[232:233], v[232:233], v[20:21], v[20:21] op_sel:[0,1,1] op_sel_hi:[1,1,1]
v_pk_fma_f32 v[234:235], v[234:235], v[20:21], v[20:21] op_sel:[0,1,1] op_sel_hi:[1,1,1]
v_cvt_pk_bf16_f32 v172, v204, v205
v_cvt_pk_bf16_f32 v173, v206, v207
buffer_load_dwordx4 v[116:119], v4, s[16:19], s52 offen offset:1024 sc1
s_add_u32 s52, s77, 180224
v_cvt_pk_bf16_f32 v174, v220, v221
v_cvt_pk_bf16_f32 v175, v222, v223
TR 18,7,8960
TR 20,7,8480
TR 22,7,8992
TR 24,7,8512
TR 26,7,9024
buffer_store_dwordx4 v[172:175], v11, s[16:19], s64 offen offset:1024 sc1
TR 28,7,8544
TR 30,7,9056
v_rcp_f32 v224, v224
v_rcp_f32 v225, v225
v_rcp_f32 v226, v226
v_rcp_f32 v227, v227
v_rcp_f32 v232, v232
v_rcp_f32 v233, v233
v_rcp_f32 v234, v234
v_rcp_f32 v235, v235
v_exp_f32 v228, v228
v_exp_f32 v229, v229
v_exp_f32 v230, v230
v_exp_f32 v231, v231
v_exp_f32 v236, v236
v_exp_f32 v237, v237
v_exp_f32 v238, v238
v_exp_f32 v239, v239
v_pk_mul_f32 v[240:241], v[240:241], v[224:225]
buffer_load_dwordx4 v[120:123], v4, s[16:19], s52 offen sc1
v_pk_mul_f32 v[242:243], v[242:243], v[226:227]
v_pk_mul_f32 v[248:249], v[248:249], v[232:233]
v_pk_mul_f32 v[250:251], v[250:251], v[234:235]
v_pk_fma_f32 v[228:229], v[228:229], v[22:23], v[22:23] op_sel:[0,1,1] op_sel_hi:[1,1,1]
v_pk_fma_f32 v[230:231], v[230:231], v[22:23], v[22:23] op_sel:[0,1,1] op_sel_hi:[1,1,1]
v_pk_fma_f32 v[236:237], v[236:237], v[22:23], v[22:23] op_sel:[0,1,1] op_sel_hi:[1,1,1]
v_pk_fma_f32 v[238:239], v[238:239], v[22:23], v[22:23] op_sel:[0,1,1] op_sel_hi:[1,1,1]
v_cvt_pk_bf16_f32 v224, v240, v241
v_cvt_pk_bf16_f32 v225, v242, v243
v_cvt_pk_bf16_f32 v226, v248, v249
v_cvt_pk_bf16_f32 v227, v250, v251
v_rcp_f32 v228, v228
v_rcp_f32 v229, v229
v_rcp_f32 v230, v230
v_rcp_f32 v231, v231
v_rcp_f32 v236, v236
v_rcp_f32 v237, v237
v_rcp_f32 v238, v238
v_rcp_f32 v239, v239
v_pk_mul_f32 v[244:245], v[244:245], v[228:229]
buffer_store_dwordx4 v[224:227], v10, s[16:19], s65 offen sc1
v_pk_mul_f32 v[246:247], v[246:247], v[230:231]
v_pk_mul_f32 v[252:253], v[252:253], v[236:237]
v_pk_mul_f32 v[254:255], v[254:255], v[238:239]
v_cvt_pk_bf16_f32 v228, v244, v245
v_cvt_pk_bf16_f32 v229, v246, v247
v_cvt_pk_bf16_f32 v230, v252, v253
v_cvt_pk_bf16_f32 v231, v254, v255
buffer_store_dwordx4 v[228:231], v10, s[16:19], s65 offen offset:1024 sc1
buffer_load_dwordx4 v[124:127], v4, s[16:19], s52 offen offset:1024 sc1
v_mov_b32 v21, v68
v_mov_b32 v22, v69
v_mov_b32 v23, v70
v_mov_b32 v24, v71
v_mov_b32 v25, 0
s_waitcnt vmcnt(7) lgkmcnt(0)
s_barrier
v_mfma_f32_16x16x32_bf16 v[32:35], a[0:3], v[96:99], 0
ds_read_b64_tr_b16 a[32:33], v6
s_add_u32 s52, s78, 229376
MAV 32,16,104
buffer_load_dwordx4 v[128:131], v4, s[16:19], s52 offen sc1
v_mfma_f32_16x16x32_bf16 v[48:51], a[0:3], v[100:103], 0
TR 34,6,512
MAV 48,16,108
TR 36,6,32
TR 38,6,544
v_mfma_f32_16x16x32_bf16 v[52:55], a[4:7], v[100:103], 0
TR 48,6,8448
MAV 52,20,108
buffer_load_dwordx4 v[132:135], v4, s[16:19], s52 offen offset:1024 sc1
v_mfma_f32_16x16x32_bf16 v[36:39], a[4:7], v[96:99], 0
TR 50,6,8960
MAV 36,20,104
TR 52,6,8480
TR 54,6,8992
v_mfma_f32_16x16x32_bf16 v[40:43], a[8:11], v[96:99], 0
TR 40,6,64
s_add_u32 s52, s78, 294912
MAV 40,24,104
buffer_load_dwordx4 v[136:139], v4, s[16:19], s52 offen sc1
v_mfma_f32_16x16x32_bf16 v[56:59], a[8:11], v[100:103], 0
TR 42,6,576
MAV 56,24,108
TR 44,6,96
TR 46,6,608
v_mfma_f32_16x16x32_bf16 v[60:63], a[12:15], v[100:103], 0
TR 56,6,8512
MAV 60,28,108
buffer_load_dwordx4 v[140:143], v4, s[16:19], s52 offen offset:1024 sc1
v_mfma_f32_16x16x32_bf16 v[44:47], a[12:15], v[96:99], 0
TR 58,6,9024
MAV 44,28,104
TR 60,6,8544
TR 62,6,9056
s_waitcnt lgkmcnt(8)
v_mfma_f32_16x16x32_bf16 v[64:67], a[32:35], v[96:99], 0
TR 0,7,16896
s_add_u32 s52, s79, 344064
MAV 64,48,104
buffer_load_dwordx4 v[144:147], v4, s[16:19], s52 offen sc1
v_mfma_f32_16x16x32_bf16 v[80:83], a[32:35], v[100:103], 0
TR 2,7,17408
MAV 80,48,108
TR 4,7,16928
TR 6,7,17440
v_mfma_f32_16x16x32_bf16 v[84:87], a[36:39], v[100:103], 0
TR 16,7,25344
MAV 84,52,108
buffer_load_dwordx4 v[148:151], v4, s[16:19], s52 offen offset:1024 sc1
v_mfma_f32_16x16x32_bf16 v[68:71], a[36:39], v[96:99], 0
TR 18,7,25856
MAV 68,52,104
TR 20,7,25376
TR 22,7,25888
s_waitcnt lgkmcnt(8)
v_mfma_f32_16x16x32_bf16 v[72:75], a[40:43], v[96:99], 0
TR 8,7,16960
s_add_u32 s52, s79, 409600
MAV 72,56,104
buffer_load_dwordx4 v[152:155], v4, s[16:19], s52 offen sc1
v_mfma_f32_16x16x32_bf16 v[88:91], a[40:43], v[100:103], 0
TR 10,7,17472
MAV 88,56,108
TR 12,7,16992
TR 14,7,17504
v_mfma_f32_16x16x32_bf16 v[92:95], a[44:47], v[100:103], 0
TR 24,7,25408
MAV 92,60,108
buffer_load_dwordx4 v[156:159], v4, s[16:19], s52 offen offset:1024 sc1
v_mfma_f32_16x16x32_bf16 v[76:79], a[44:47], v[96:99], 0
TR 26,7,25920
MAV 76,60,104
TR 28,7,25440
TR 30,7,25952
s_waitcnt vmcnt(8) lgkmcnt(8)
s_barrier
MAV 32,0,112
TR 32,6,16896
MAV 32,16,120
buffer_atomic_add v24, v21, s[16:19], s72 offen
MAV 48,16,124
TR 34,6,17408
MAV 48,0,116
TR 36,6,16928
TR 38,6,17440
TR 48,6,25344
MAV 52,4,116
TR 50,6,25856
s_add_u32 m0, s55, 0
MAV 52,20,124
buffer_load_dwordx4 v18, s[28:31], s54 offen lds
MAV 36,20,120
TR 52,6,25376
MAV 36,4,112
TR 54,6,25888
TR 40,6,16960
s_waitcnt lgkmcnt(9)
MAV 40,8,112
TR 42,6,17472
s_add_u32 s52, s76, 458752
MAV 40,24,120
buffer_load_dwordx4 v[96:99], v4, s[16:19], s52 offen sc1
MAV 56,24,124
TR 44,6,16992
MAV 56,8,116
buffer_load_dwordx4 v19, s[28:31], s54 offen offset:1056 lds
MAV 60,12,116
TR 46,6,17504
s_add_u32 s54, s98, 327680
MAV 60,28,124
buffer_load_dwordx4 v[100:103], v4, s[16:19], s52 offen offset:1024 sc1
MAV 44,28,120
TR 56,6,25408
MAV 44,12,112
TR 58,6,25920
TR 60,6,25440
TR 62,6,25952
s_waitcnt lgkmcnt(8)
MAV 64,32,112
TR 0,7,33792
s_add_u32 m0, s55, 8448
MAV 64,48,120
buffer_load_dwordx4 v18, s[28:31], s54 offen lds
MAV 80,48,124
TR 2,7,34304
MAV 80,32,116
TR 4,7,33824
TR 6,7,34336
MAV 84,36,116
TR 16,7,42240
s_add_u32 s52, s76, 524288
MAV 84,52,124
buffer_load_dwordx4 v[104:107], v4, s[16:19], s52 offen sc1
MAV 68,52,120
TR 18,7,42752
MAV 68,36,112
TR 20,7,42272
TR 22,7,42784
s_waitcnt lgkmcnt(8)
MAV 72,40,112
TR 8,7,33856
MAV 72,56,120
buffer_load_dwordx4 v19, s[28:31], s54 offen offset:1056 lds
MAV 88,56,124
TR 10,7,34368
s_add_u32 s54, s99, 524288
MAV 88,40,116
TR 12,7,33888
TR 14,7,34400
MAV 92,44,116
TR 24,7,42304
MAV 92,60,124
buffer_load_dwordx4 v[108:111], v4, s[16:19], s52 offen offset:1024 sc1
MAV 76,60,120
TR 26,7,42816
MAV 76,44,112
TR 28,7,42336
TR 30,7,42848
s_waitcnt vmcnt(13) lgkmcnt(8)
s_barrier
MAV 32,0,128
TR 32,6,33792
s_add_u32 m0, s55, 16896
MAV 32,16,136
buffer_load_dwordx4 v18, s[28:31], s54 offen lds
MAV 48,16,140
TR 34,6,34304
MAV 48,0,132
TR 36,6,33824
TR 38,6,34336
MAV 52,4,132
TR 48,6,42240
s_add_u32 s52, s77, 573440
MAV 52,20,140
buffer_load_dwordx4 v[112:115], v4, s[16:19], s52 offen sc1
MAV 36,20,136
TR 50,6,42752
MAV 36,4,128
TR 52,6,42272
TR 54,6,42784
s_waitcnt lgkmcnt(8)
MAV 40,8,128
TR 40,6,33856
MAV 40,24,136
buffer_load_dwordx4 v19, s[28:31], s54 offen offset:1056 lds
MAV 56,24,140
TR 42,6,34368
s_add_u32 s54, s99, 786432
MAV 56,8,132
TR 44,6,33888
TR 46,6,34400
.Lpad7:
s_cbranch_execz .Lpad10
MAV 60,12,132
TR 56,6,42304
MAV 60,28,140
buffer_load_dwordx4 v[116:119], v4, s[16:19], s52 offen offset:1024 sc1
MAV 44,28,136
TR 58,6,42816
MAV 44,12,128
TR 60,6,42336
TR 62,6,42848
s_waitcnt lgkmcnt(8)
MAV 64,32,128
TR 0,7,50688
s_add_u32 m0, s55, 25344
MAV 64,48,136
buffer_load_dwordx4 v18, s[28:31], s54 offen lds
MAV 80,48,140
TR 2,7,51200
MAV 80,32,132
TR 4,7,50720
TR 6,7,51232
TR 16,7,59136
MAV 84,36,132
TR 18,7,59648
s_add_u32 s52, s77, 638976
MAV 84,52,140
buffer_load_dwordx4 v[120:123], v4, s[16:19], s52 offen sc1
MAV 68,52,136
TR 20,7,59168
MAV 68,36,128
TR 22,7,59680
TR 8,7,50752
s_waitcnt lgkmcnt(9)
MAV 72,40,128
TR 10,7,51264
MAV 72,56,136
buffer_load_dwordx4 v19, s[28:31], s54 offen offset:1056 lds
MAV 88,56,140
TR 12,7,50784
s_add_u32 s54, s100, 983040
MAV 88,40,132
buffer_load_dwordx4 v[124:127], v4, s[16:19], s52 offen offset:1024 sc1
MAV 92,44,132
TR 14,7,51296
MAV 92,60,140
buffer_atomic_add v25, v22, s[16:19], s73 offen sc0
MAV 76,60,136
TR 24,7,59200
MAV 76,44,128
TR 26,7,59712
TR 28,7,59232
TR 30,7,59744
s_waitcnt vmcnt(18) lgkmcnt(8)
s_barrier
MAV 32,0,144
TR 32,6,50688
s_add_u32 m0, s55, 33792
MAV 32,16,152
buffer_load_dwordx4 v18, s[28:31], s54 offen lds
MAV 48,16,156
TR 34,6,51200
MAV 48,0,148
TR 36,6,50720
TR 38,6,51232
MAV 52,4,148
TR 48,6,59136
s_add_u32 s52, s78, 688128
MAV 52,20,156
buffer_load_dwordx4 v[128:131], v4, s[16:19], s52 offen sc1
MAV 36,20,152
TR 50,6,59648
MAV 36,4,144
TR 52,6,59168
TR 54,6,59680
s_waitcnt lgkmcnt(8)
MAV 40,8,144
TR 40,6,50752
MAV 40,24,152
buffer_load_dwordx4 v19, s[28:31], s54 offen offset:1056 lds
MAV 56,24,156
TR 42,6,51264
s_add_u32 s54, s100, 1245184
MAV 56,8,148
TR 44,6,50784
TR 46,6,51296
MAV 60,12,148
TR 56,6,59200
MAV 60,28,156
buffer_load_dwordx4 v[132:135], v4, s[16:19], s52 offen offset:1024 sc1
MAV 44,28,152
TR 58,6,59712
MAV 44,12,144
TR 60,6,59232
TR 62,6,59744
v_add_u32 v7, s57, v7
v_add_u32 v6, s57, v6
s_sub_u32 s57, 0, s57
s_waitcnt lgkmcnt(8)
MAV 64,32,144
ds_read_b64_tr_b16 a[0:1], v7
s_add_u32 m0, s55, 42240
MAV 64,48,152
buffer_load_dwordx4 v18, s[28:31], s54 offen lds
MAV 80,48,156
TR 2,7,512
MAV 80,32,148
TR 4,7,32
TR 6,7,544
MAV 84,36,148
TR 16,7,8448
s_add_u32 s52, s78, 753664
MAV 84,52,156
buffer_load_dwordx4 v[136:139], v4, s[16:19], s52 offen sc1
MAV 68,52,152
TR 18,7,8960
MAV 68,36,144
TR 20,7,8480
TR 22,7,8992
s_waitcnt lgkmcnt(8)
MAV 72,40,144
TR 8,7,64
MAV 72,56,152
buffer_load_dwordx4 v19, s[28:31], s54 offen offset:1056 lds
MAV 88,56,156
TR 10,7,576
s_add_u32 s54, s101, 1441792
MAV 88,40,148
TR 12,7,96
TR 14,7,608
MAV 92,44,148
TR 24,7,8512
MAV 92,60,156
buffer_load_dwordx4 v[140:143], v4, s[16:19], s52 offen offset:1024 sc1
MAV 76,60,152
TR 26,7,9024
MAV 76,44,144
TR 28,7,8544
TR 30,7,9056
s_waitcnt vmcnt(17) lgkmcnt(8)
s_barrier
MAV 32,0,96
ds_read_b64_tr_b16 a[32:33], v6
s_add_u32 m0, s55, 50688
MAV 32,16,104
buffer_load_dwordx4 v18, s[28:31], s54 offen lds
MAV 48,16,108
TR 34,6,512
MAV 48,0,100
TR 36,6,32
TR 38,6,544
MAV 52,4,100
TR 48,6,8448
s_add_u32 s52, s79, 802816
MAV 52,20,108
buffer_load_dwordx4 v[144:147], v4, s[16:19], s52 offen sc1
MAV 36,20,104
TR 50,6,8960
MAV 36,4,96
TR 52,6,8480
TR 54,6,8992
s_waitcnt lgkmcnt(8)
MAV 40,8,96
TR 40,6,64
MAV 40,24,104
buffer_load_dwordx4 v19, s[28:31], s54 offen offset:1056 lds
MAV 56,24,108
TR 42,6,576
s_add_u32 s54, s101, 1703936
MAV 56,8,100
TR 44,6,96
TR 46,6,608
MAV 60,12,100
TR 56,6,8512
MAV 60,28,108
buffer_load_dwordx4 v[148:151], v4, s[16:19], s52 offen offset:1024 sc1
MAV 44,28,104
TR 58,6,9024
MAV 44,12,96
TR 60,6,8544
TR 62,6,9056
s_waitcnt lgkmcnt(8)
MAV 64,32,96
TR 0,7,16896
s_add_u32 m0, s55, 59136
MAV 64,48,104
buffer_load_dwordx4 v18, s[28:31], s54 offen lds
MAV 80,48,108
TR 2,7,17408
MAV 80,32,100
TR 4,7,16928
TR 6,7,17440
MAV 84,36,100
TR 16,7,25344
s_add_u32 s52, s79, 868352
MAV 84,52,108
buffer_load_dwordx4 v[152:155], v4, s[16:19], s52 offen sc1
MAV 68,52,104
TR 18,7,25856
MAV 68,36,96
TR 20,7,25376
TR 22,7,25888
s_waitcnt lgkmcnt(8)
MAV 72,40,96
TR 8,7,16960
MAV 72,56,104
buffer_load_dwordx4 v19, s[28:31], s54 offen offset:1056 lds
MAV 88,56,108
TR 10,7,17472
s_add_u32 s54, s98, 1900544
MAV 88,40,100
TR 12,7,16992
TR 14,7,17504
MAV 92,44,100
TR 24,7,25408
MAV 92,60,108
buffer_load_dwordx4 v[156:159], v4, s[16:19], s52 offen offset:1024 sc1
MAV 76,60,104
TR 26,7,25920
MAV 76,44,96
TR 28,7,25440
TR 30,7,25952
s_waitcnt vmcnt(16)
v_cmp_gt_u32 vcc, v23, v25
s_nop 0
s_cbranch_vccnz .Lsp50
.Lsp50b:
s_waitcnt lgkmcnt(8)
s_barrier
MAV 32,0,112
TR 32,6,16896
s_add_u32 m0, s55, 67584
MAV 32,16,120
buffer_load_dwordx4 v18, s[28:31], s54 offen lds
MAV 48,16,124
TR 34,6,17408
MAV 48,0,116
TR 36,6,16928
TR 38,6,17440
MAV 52,4,116
TR 48,6,25344
s_add_u32 s52, s76, 16384
MAV 52,20,124
buffer_load_dwordx4 v[96:99], v4, s[16:19], s52 offen sc1
MAV 36,20,120
TR 50,6,25856
MAV 36,4,112
TR 52,6,25376
TR 54,6,25888
s_waitcnt lgkmcnt(8)
MAV 40,8,112
TR 40,6,16960
MAV 40,24,120
buffer_load_dwordx4 v19, s[28:31], s54 offen offset:1056 lds
MAV 56,24,124
TR 42,6,17472
s_add_u32 s54, s98, 2162688
MAV 56,8,116
TR 44,6,16992
TR 46,6,17504
MAV 60,12,116
TR 56,6,25408
MAV 60,28,124
buffer_load_dwordx4 v[100:103], v4, s[16:19], s52 offen offset:1024 sc1
MAV 44,28,120
TR 58,6,25920
MAV 44,12,112
TR 60,6,25440
TR 62,6,25952
s_waitcnt lgkmcnt(8)
MAV 64,32,112
TR 0,7,33792
s_add_u32 m0, s55, 76032
MAV 64,48,120
buffer_load_dwordx4 v18, s[28:31], s54 offen lds
MAV 80,48,124
TR 2,7,34304
MAV 80,32,116
TR 4,7,33824
TR 6,7,34336
MAV 84,36,116
TR 16,7,42240
s_add_u32 s52, s76, 81920
MAV 84,52,124
buffer_load_dwordx4 v[104:107], v4, s[16:19], s52 offen sc1
MAV 68,52,120
TR 18,7,42752
MAV 68,36,112
TR 20,7,42272
TR 22,7,42784
s_waitcnt lgkmcnt(8)
MAV 72,40,112
TR 8,7,33856
MAV 72,56,120
buffer_load_dwordx4 v19, s[28:31], s54 offen offset:1056 lds
MAV 88,56,124
TR 10,7,34368
s_add_u32 s54, s99, 2359296
MAV 88,40,116
TR 12,7,33888
TR 14,7,34400
MAV 92,44,116
TR 24,7,42304
MAV 92,60,124
buffer_load_dwordx4 v[108:111], v4, s[16:19], s52 offen offset:1024 sc1
MAV 76,60,120
TR 26,7,42816
MAV 76,44,112
TR 28,7,42336
TR 30,7,42848
s_waitcnt vmcnt(16) lgkmcnt(8)
s_barrier
MAV 32,0,128
TR 32,6,33792
s_add_u32 m0, s55, 84480
MAV 32,16,136
buffer_load_dwordx4 v18, s[28:31], s54 offen lds
MAV 48,16,140
TR 34,6,34304
MAV 48,0,132
TR 36,6,33824
TR 38,6,34336
MAV 52,4,132
TR 48,6,42240
s_add_u32 s52, s77, 131072
MAV 52,20,140
buffer_load_dwordx4 v[112:115], v4, s[16:19], s52 offen sc1
MAV 36,20,136
TR 50,6,42752
MAV 36,4,128
TR 52,6,42272
TR 54,6,42784
s_waitcnt lgkmcnt(8)
MAV 40,8,128
TR 40,6,33856
MAV 40,24,136
buffer_load_dwordx4 v19, s[28:31], s54 offen offset:1056 lds
MAV 56,24,140
TR 42,6,34368
s_add_u32 s54, s99, 2621440
MAV 56,8,132
TR 44,6,33888
TR 46,6,34400
MAV 60,12,132
TR 56,6,42304
MAV 60,28,140
buffer_load_dwordx4 v[116:119], v4, s[16:19], s52 offen offset:1024 sc1
MAV 44,28,136
TR 58,6,42816
MAV 44,12,128
TR 60,6,42336
TR 62,6,42848
s_waitcnt lgkmcnt(8)
MAV 64,32,128
TR 0,7,50688
s_add_u32 m0, s55, 92928
MAV 64,48,136
buffer_load_dwordx4 v18, s[28:31], s54 offen lds
MAV 80,48,140
TR 2,7,51200
MAV 80,32,132
TR 4,7,50720
TR 6,7,51232
MAV 84,36,132
TR 16,7,59136
s_add_u32 s52, s77, 196608
MAV 84,52,140
buffer_load_dwordx4 v[120:123], v4, s[16:19], s52 offen sc1
MAV 68,52,136
TR 18,7,59648
MAV 68,36,128
TR 20,7,59168
TR 22,7,59680
s_waitcnt lgkmcnt(8)
MAV 72,40,128
TR 8,7,50752
MAV 72,56,136
buffer_load_dwordx4 v19, s[28:31], s54 offen offset:1056 lds
MAV 88,56,140
TR 10,7,51264
s_add_u32 s54, s100, 2818048
MAV 88,40,132
TR 12,7,50784
TR 14,7,51296
MAV 92,44,132
TR 24,7,59200
MAV 92,60,140
buffer_load_dwordx4 v[124:127], v4, s[16:19], s52 offen offset:1024 sc1
MAV 76,60,136
TR 26,7,59712
MAV 76,44,128
TR 28,7,59232
TR 30,7,59744
s_waitcnt vmcnt(16) lgkmcnt(8)
s_barrier
MAV 32,0,144
TR 32,6,50688
s_add_u32 m0, s55, 101376
MAV 32,16,152
buffer_load_dwordx4 v18, s[28:31], s54 offen lds
MAV 48,16,156
TR 34,6,51200
MAV 48,0,148
TR 36,6,50720
TR 38,6,51232
MAV 52,4,148
TR 48,6,59136
s_add_u32 s52, s78, 245760
MAV 52,20,156
buffer_load_dwordx4 v[128:131], v4, s[16:19], s52 offen sc1
MAV 36,20,152
TR 50,6,59648
MAV 36,4,144
TR 52,6,59168
TR 54,6,59680
s_waitcnt lgkmcnt(8)
MAV 40,8,144
TR 40,6,50752
MAV 40,24,152
buffer_load_dwordx4 v19, s[28:31], s54 offen offset:1056 lds
MAV 56,24,156
TR 42,6,51264
s_add_u32 s54, s100, 3080192
MAV 56,8,148
TR 44,6,50784
TR 46,6,51296
MAV 60,12,148
TR 56,6,59200
MAV 60,28,156
buffer_load_dwordx4 v[132:135], v4, s[16:19], s52 offen offset:1024 sc1
MAV 44,28,152
TR 58,6,59712
MAV 44,12,144
TR 60,6,59232
TR 62,6,59744
v_add_u32 v7, s57, v7
v_add_u32 v6, s57, v6
s_sub_u32 s57, 0, s57
s_waitcnt lgkmcnt(8)
MAV 64,32,144
ds_read_b64_tr_b16 a[0:1], v7
s_add_u32 m0, s55, 109824
MAV 64,48,152
buffer_load_dwordx4 v18, s[28:31], s54 offen lds
MAV 80,48,156
TR 2,7,512
MAV 80,32,148
TR 4,7,32
TR 6,7,544
MAV 84,36,148
TR 16,7,8448
s_add_u32 s52, s78, 311296
MAV 84,52,156
buffer_load_dwordx4 v[136:139], v4, s[16:19], s52 offen sc1
MAV 68,52,152
TR 18,7,8960
MAV 68,36,144
TR 20,7,8480
TR 22,7,8992
s_waitcnt lgkmcnt(8)
MAV 72,40,144
TR 8,7,64
MAV 72,56,152
buffer_load_dwordx4 v19, s[28:31], s54 offen offset:1056 lds
MAV 88,56,156
TR 10,7,576
s_add_u32 s54, s101, 3276800
MAV 88,40,148
TR 12,7,96
TR 14,7,608
MAV 92,44,148
TR 24,7,8512
MAV 92,60,156
buffer_load_dwordx4 v[140:143], v4, s[16:19], s52 offen offset:1024 sc1
MAV 76,60,152
TR 26,7,9024
MAV 76,44,144
TR 28,7,8544
TR 30,7,9056
s_waitcnt vmcnt(16) lgkmcnt(8)
s_barrier
MAV 32,0,96
ds_read_b64_tr_b16 a[32:33], v6
s_add_u32 m0, s55, 118272
MAV 32,16,104
buffer_load_dwordx4 v18, s[28:31], s54 offen lds
MAV 48,16,108
TR 34,6,512
MAV 48,0,100
TR 36,6,32
TR 38,6,544
MAV 52,4,100
TR 48,6,8448
s_add_u32 s52, s79, 360448
MAV 52,20,108
buffer_load_dwordx4 v[144:147], v4, s[16:19], s52 offen sc1
MAV 36,20,104
TR 50,6,8960
MAV 36,4,96
TR 52,6,8480
TR 54,6,8992
s_waitcnt lgkmcnt(8)
MAV 40,8,96
TR 40,6,64
MAV 40,24,104
buffer_load_dwordx4 v19, s[28:31], s54 offen offset:1056 lds
MAV 56,24,108
TR 42,6,576
s_add_u32 s54, s101, 3538944
MAV 56,8,100
TR 44,6,96
TR 46,6,608
MAV 60,12,100
TR 56,6,8512
MAV 60,28,108
buffer_load_dwordx4 v[148:151], v4, s[16:19], s52 offen offset:1024 sc1
MAV 44,28,104
TR 58,6,9024
MAV 44,12,96
TR 60,6,8544
TR 62,6,9056
s_waitcnt lgkmcnt(8)
MAV 64,32,96
TR 0,7,16896
s_add_u32 m0, s55, 126720
MAV 64,48,104
buffer_load_dwordx4 v18, s[28:31], s54 offen lds
MAV 80,48,108
TR 2,7,17408
MAV 80,32,100
TR 4,7,16928
TR 6,7,17440
MAV 84,36,100
TR 16,7,25344
s_add_u32 s52, s79, 425984
.Lpad8:
s_cbranch_execz .Lpad11
MAV 84,52,108
buffer_load_dwordx4 v[152:155], v4, s[16:19], s52 offen sc1
MAV 68,52,104
TR 18,7,25856
MAV 68,36,96
TR 20,7,25376
TR 22,7,25888
s_waitcnt lgkmcnt(8)
MAV 72,40,96
TR 8,7,16960
MAV 72,56,104
buffer_load_dwordx4 v19, s[28:31], s54 offen offset:1056 lds
MAV 88,56,108
TR 10,7,17472
s_add_u32 s54, s98, 131072
MAV 88,40,100
TR 12,7,16992
TR 14,7,17504
MAV 92,44,100
TR 24,7,25408
MAV 92,60,108
buffer_load_dwordx4 v[156:159], v4, s[16:19], s52 offen offset:1024 sc1
MAV 76,60,104
TR 26,7,25920
MAV 76,44,96
TR 28,7,25440
TR 30,7,25952
s_waitcnt vmcnt(16) lgkmcnt(8)
s_barrier
MAV 32,0,112
TR 32,6,16896
s_add_u32 m0, s55, 0
MAV 32,16,120
buffer_load_dwordx4 v18, s[28:31], s54 offen lds
MAV 48,16,124
TR 34,6,17408
MAV 48,0,116
TR 36,6,16928
TR 38,6,17440
MAV 52,4,116
TR 48,6,25344
s_add_u32 s52, s76, 475136
MAV 52,20,124
buffer_load_dwordx4 v[96:99], v4, s[16:19], s52 offen sc1
MAV 36,20,120
TR 50,6,25856
MAV 36,4,112
TR 52,6,25376
TR 54,6,25888
s_waitcnt lgkmcnt(8)
MAV 40,8,112
TR 40,6,16960
MAV 40,24,120
buffer_load_dwordx4 v19, s[28:31], s54 offen offset:1056 lds
MAV 56,24,124
TR 42,6,17472
s_add_u32 s54, s98, 393216
MAV 56,8,116
TR 44,6,16992
TR 46,6,17504
MAV 60,12,116
TR 56,6,25408
MAV 60,28,124
buffer_load_dwordx4 v[100:103], v4, s[16:19], s52 offen offset:1024 sc1
MAV 44,28,120
TR 58,6,25920
MAV 44,12,112
TR 60,6,25440
TR 62,6,25952
s_waitcnt lgkmcnt(8)
MAV 64,32,112
TR 0,7,33792
s_add_u32 m0, s55, 8448
MAV 64,48,120
buffer_load_dwordx4 v18, s[28:31], s54 offen lds
MAV 80,48,124
TR 2,7,34304
MAV 80,32,116
TR 4,7,33824
TR 6,7,34336
MAV 84,36,116
TR 16,7,42240
s_add_u32 s52, s76, 540672
MAV 84,52,124
buffer_load_dwordx4 v[104:107], v4, s[16:19], s52 offen sc1
MAV 68,52,120
TR 18,7,42752
MAV 68,36,112
TR 20,7,42272
TR 22,7,42784
s_waitcnt lgkmcnt(8)
MAV 72,40,112
TR 8,7,33856
MAV 72,56,120
buffer_load_dwordx4 v19, s[28:31], s54 offen offset:1056 lds
MAV 88,56,124
TR 10,7,34368
s_add_u32 s54, s99, 589824
MAV 88,40,116
TR 12,7,33888
TR 14,7,34400
MAV 92,44,116
TR 24,7,42304
MAV 92,60,124
buffer_load_dwordx4 v[108:111], v4, s[16:19], s52 offen offset:1024 sc1
MAV 76,60,120
TR 26,7,42816
MAV 76,44,112
TR 28,7,42336
TR 30,7,42848
s_waitcnt vmcnt(16) lgkmcnt(8)
s_barrier
MAV 32,0,128
TR 32,6,33792
s_add_u32 m0, s55, 16896
MAV 32,16,136
buffer_load_dwordx4 v18, s[28:31], s54 offen lds
MAV 48,16,140
TR 34,6,34304
MAV 48,0,132
TR 36,6,33824
TR 38,6,34336
MAV 52,4,132
TR 48,6,42240
s_add_u32 s52, s77, 589824
MAV 52,20,140
buffer_load_dwordx4 v[112:115], v4, s[16:19], s52 offen sc1
MAV 36,20,136
TR 50,6,42752
MAV 36,4,128
TR 52,6,42272
TR 54,6,42784
s_waitcnt lgkmcnt(8)
MAV 40,8,128
TR 40,6,33856
MAV 40,24,136
buffer_load_dwordx4 v19, s[28:31], s54 offen offset:1056 lds
MAV 56,24,140
TR 42,6,34368
s_add_u32 s54, s99, 851968
MAV 56,8,132
TR 44,6,33888
TR 46,6,34400
MAV 60,12,132
TR 56,6,42304
MAV 60,28,140
buffer_load_dwordx4 v[116:119], v4, s[16:19], s52 offen offset:1024 sc1
MAV 44,28,136
TR 58,6,42816
MAV 44,12,128
TR 60,6,42336
TR 62,6,42848
s_waitcnt lgkmcnt(8)
MAV 64,32,128
TR 0,7,50688
s_add_u32 m0, s55, 25344
MAV 64,48,136
buffer_load_dwordx4 v18, s[28:31], s54 offen lds
MAV 80,48,140
TR 2,7,51200
MAV 80,32,132
TR 4,7,50720
TR 6,7,51232
MAV 84,36,132
TR 16,7,59136
s_add_u32 s52, s77, 655360
MAV 84,52,140
buffer_load_dwordx4 v[120:123], v4, s[16:19], s52 offen sc1
MAV 68,52,136
TR 18,7,59648
MAV 68,36,128
TR 20,7,59168
TR 22,7,59680
s_waitcnt lgkmcnt(8)
MAV 72,40,128
TR 8,7,50752
MAV 72,56,136
buffer_load_dwordx4 v19, s[28:31], s54 offen offset:1056 lds
MAV 88,56,140
TR 10,7,51264
s_add_u32 s54, s100, 1048576
MAV 88,40,132
TR 12,7,50784
TR 14,7,51296
MAV 92,44,132
TR 24,7,59200
MAV 92,60,140
buffer_load_dwordx4 v[124:127], v4, s[16:19], s52 offen offset:1024 sc1
MAV 76,60,136
TR 26,7,59712
MAV 76,44,128
TR 28,7,59232
TR 30,7,59744
s_waitcnt vmcnt(16) lgkmcnt(8)
s_barrier
MAV 32,0,144
TR 32,6,50688
s_add_u32 m0, s55, 33792
MAV 32,16,152
buffer_load_dwordx4 v18, s[28:31], s54 offen lds
MAV 48,16,156
TR 34,6,51200
MAV 48,0,148
TR 36,6,50720
TR 38,6,51232
MAV 52,4,148
TR 48,6,59136
s_add_u32 s52, s78, 704512
MAV 52,20,156
buffer_load_dwordx4 v[128:131], v4, s[16:19], s52 offen sc1
MAV 36,20,152
TR 50,6,59648
MAV 36,4,144
TR 52,6,59168
TR 54,6,59680
s_waitcnt lgkmcnt(8)
MAV 40,8,144
TR 40,6,50752
MAV 40,24,152
buffer_load_dwordx4 v19, s[28:31], s54 offen offset:1056 lds
MAV 56,24,156
TR 42,6,51264
s_add_u32 s54, s100, 1310720
MAV 56,8,148
TR 44,6,50784
TR 46,6,51296
MAV 60,12,148
TR 56,6,59200
MAV 60,28,156
buffer_load_dwordx4 v[132:135], v4, s[16:19], s52 offen offset:1024 sc1
MAV 44,28,152
TR 58,6,59712
MAV 44,12,144
TR 60,6,59232
TR 62,6,59744
v_add_u32 v7, s57, v7
v_add_u32 v6, s57, v6
s_sub_u32 s57, 0, s57
s_waitcnt lgkmcnt(8)
MAV 64,32,144
ds_read_b64_tr_b16 a[0:1], v7
s_add_u32 m0, s55, 42240
MAV 64,48,152
buffer_load_dwordx4 v18, s[28:31], s54 offen lds
MAV 80,48,156
TR 2,7,512
MAV 80,32,148
TR 4,7,32
TR 6,7,544
MAV 84,36,148
TR 16,7,8448
s_add_u32 s52, s78, 770048
MAV 84,52,156
buffer_load_dwordx4 v[136:139], v4, s[16:19], s52 offen sc1
MAV 68,52,152
TR 18,7,8960
MAV 68,36,144
TR 20,7,8480
TR 22,7,8992
s_waitcnt lgkmcnt(8)
MAV 72,40,144
TR 8,7,64
MAV 72,56,152
buffer_load_dwordx4 v19, s[28:31], s54 offen offset:1056 lds
MAV 88,56,156
TR 10,7,576
s_add_u32 s54, s101, 1507328
MAV 88,40,148
TR 12,7,96
TR 14,7,608
MAV 92,44,148
TR 24,7,8512
MAV 92,60,156
buffer_load_dwordx4 v[140:143], v4, s[16:19], s52 offen offset:1024 sc1
MAV 76,60,152
TR 26,7,9024
MAV 76,44,144
TR 28,7,8544
TR 30,7,9056
s_waitcnt vmcnt(16) lgkmcnt(8)
s_barrier
MAV 32,0,96
ds_read_b64_tr_b16 a[32:33], v6
s_add_u32 m0, s55, 50688
MAV 32,16,104
buffer_load_dwordx4 v18, s[28:31], s54 offen lds
MAV 48,16,108
TR 34,6,512
MAV 48,0,100
TR 36,6,32
TR 38,6,544
MAV 52,4,100
TR 48,6,8448
s_add_u32 s52, s79, 819200
MAV 52,20,108
buffer_load_dwordx4 v[144:147], v4, s[16:19], s52 offen sc1
MAV 36,20,104
TR 50,6,8960
MAV 36,4,96
TR 52,6,8480
TR 54,6,8992
s_waitcnt lgkmcnt(8)
MAV 40,8,96
TR 40,6,64
MAV 40,24,104
buffer_load_dwordx4 v19, s[28:31], s54 offen offset:1056 lds
MAV 56,24,108
TR 42,6,576
s_add_u32 s54, s101, 1769472
MAV 56,8,100
TR 44,6,96
TR 46,6,608
MAV 60,12,100
TR 56,6,8512
MAV 60,28,108
buffer_load_dwordx4 v[148:151], v4, s[16:19], s52 offen offset:1024 sc1
MAV 44,28,104
TR 58,6,9024
MAV 44,12,96
TR 60,6,8544
TR 62,6,9056
s_waitcnt lgkmcnt(8)
MAV 64,32,96
TR 0,7,16896
s_add_u32 m0, s55, 59136
MAV 64,48,104
buffer_load_dwordx4 v18, s[28:31], s54 offen lds
MAV 80,48,108
TR 2,7,17408
MAV 80,32,100
TR 4,7,16928
TR 6,7,17440
MAV 84,36,100
TR 16,7,25344
s_add_u32 s52, s79, 884736
MAV 84,52,108
buffer_load_dwordx4 v[152:155], v4, s[16:19], s52 offen sc1
MAV 68,52,104
TR 18,7,25856
MAV 68,36,96
TR 20,7,25376
TR 22,7,25888
s_waitcnt lgkmcnt(8)
MAV 72,40,96
TR 8,7,16960
MAV 72,56,104
buffer_load_dwordx4 v19, s[28:31], s54 offen offset:1056 lds
MAV 88,56,108
TR 10,7,17472
s_add_u32 s54, s98, 1966080
MAV 88,40,100
TR 12,7,16992
TR 14,7,17504
MAV 92,44,100
TR 24,7,25408
MAV 92,60,108
buffer_load_dwordx4 v[156:159], v4, s[16:19], s52 offen offset:1024 sc1
MAV 76,60,104
TR 26,7,25920
MAV 76,44,96
TR 28,7,25440
TR 30,7,25952
s_waitcnt vmcnt(16) lgkmcnt(8)
s_barrier
MAV 32,0,112
TR 32,6,16896
s_add_u32 m0, s55, 67584
MAV 32,16,120
buffer_load_dwordx4 v18, s[28:31], s54 offen lds
MAV 48,16,124
TR 34,6,17408
MAV 48,0,116
TR 36,6,16928
TR 38,6,17440
MAV 52,4,116
TR 48,6,25344
s_add_u32 s52, s76, 32768
MAV 52,20,124
buffer_load_dwordx4 v[96:99], v4, s[16:19], s52 offen sc1
MAV 36,20,120
TR 50,6,25856
MAV 36,4,112
TR 52,6,25376
TR 54,6,25888
s_waitcnt lgkmcnt(8)
MAV 40,8,112
TR 40,6,16960
MAV 40,24,120
buffer_load_dwordx4 v19, s[28:31], s54 offen offset:1056 lds
MAV 56,24,124
TR 42,6,17472
s_add_u32 s54, s98, 2228224
MAV 56,8,116
TR 44,6,16992
TR 46,6,17504
MAV 60,12,116
TR 56,6,25408
MAV 60,28,124
buffer_load_dwordx4 v[100:103], v4, s[16:19], s52 offen offset:1024 sc1
MAV 44,28,120
TR 58,6,25920
MAV 44,12,112
TR 60,6,25440
TR 62,6,25952
s_waitcnt lgkmcnt(8)
MAV 64,32,112
TR 0,7,33792
s_add_u32 m0, s55, 76032
MAV 64,48,120
buffer_load_dwordx4 v18, s[28:31], s54 offen lds
MAV 80,48,124
TR 2,7,34304
MAV 80,32,116
TR 4,7,33824
TR 6,7,34336
MAV 84,36,116
TR 16,7,42240
s_add_u32 s52, s76, 98304
MAV 84,52,124
buffer_load_dwordx4 v[104:107], v4, s[16:19], s52 offen sc1
MAV 68,52,120
TR 18,7,42752
MAV 68,36,112
TR 20,7,42272
TR 22,7,42784
s_waitcnt lgkmcnt(8)
MAV 72,40,112
TR 8,7,33856
MAV 72,56,120
buffer_load_dwordx4 v19, s[28:31], s54 offen offset:1056 lds
MAV 88,56,124
TR 10,7,34368
s_add_u32 s54, s99, 2424832
MAV 88,40,116
TR 12,7,33888
TR 14,7,34400
MAV 92,44,116
TR 24,7,42304
MAV 92,60,124
buffer_load_dwordx4 v[108:111], v4, s[16:19], s52 offen offset:1024 sc1
MAV 76,60,120
TR 26,7,42816
MAV 76,44,112
TR 28,7,42336
TR 30,7,42848
s_waitcnt vmcnt(16) lgkmcnt(8)
s_barrier
MAV 32,0,128
TR 32,6,33792
s_add_u32 m0, s55, 84480
MAV 32,16,136
buffer_load_dwordx4 v18, s[28:31], s54 offen lds
MAV 48,16,140
TR 34,6,34304
MAV 48,0,132
TR 36,6,33824
TR 38,6,34336
MAV 52,4,132
TR 48,6,42240
s_add_u32 s52, s77, 147456
MAV 52,20,140
buffer_load_dwordx4 v[112:115], v4, s[16:19], s52 offen sc1
MAV 36,20,136
TR 50,6,42752
MAV 36,4,128
TR 52,6,42272
TR 54,6,42784
s_waitcnt lgkmcnt(8)
MAV 40,8,128
TR 40,6,33856
MAV 40,24,136
buffer_load_dwordx4 v19, s[28:31], s54 offen offset:1056 lds
MAV 56,24,140
TR 42,6,34368
s_add_u32 s54, s99, 2686976
MAV 56,8,132
TR 44,6,33888
TR 46,6,34400
MAV 60,12,132
TR 56,6,42304
MAV 60,28,140
buffer_load_dwordx4 v[116:119], v4, s[16:19], s52 offen offset:1024 sc1
MAV 44,28,136
TR 58,6,42816
MAV 44,12,128
TR 60,6,42336
TR 62,6,42848
s_waitcnt lgkmcnt(8)
MAV 64,32,128
TR 0,7,50688
s_add_u32 m0, s55, 92928
MAV 64,48,136
buffer_load_dwordx4 v18, s[28:31], s54 offen lds
MAV 80,48,140
TR 2,7,51200
MAV 80,32,132
TR 4,7,50720
TR 6,7,51232
MAV 84,36,132
TR 16,7,59136
s_add_u32 s52, s77, 212992
MAV 84,52,140
buffer_load_dwordx4 v[120:123], v4, s[16:19], s52 offen sc1
MAV 68,52,136
TR 18,7,59648
MAV 68,36,128
TR 20,7,59168
TR 22,7,59680
s_waitcnt lgkmcnt(8)
MAV 72,40,128
TR 8,7,50752
MAV 72,56,136
buffer_load_dwordx4 v19, s[28:31], s54 offen offset:1056 lds
MAV 88,56,140
TR 10,7,51264
s_add_u32 s54, s100, 2883584
MAV 88,40,132
TR 12,7,50784
TR 14,7,51296
MAV 92,44,132
TR 24,7,59200
MAV 92,60,140
buffer_load_dwordx4 v[124:127], v4, s[16:19], s52 offen offset:1024 sc1
MAV 76,60,136
TR 26,7,59712
MAV 76,44,128
TR 28,7,59232
TR 30,7,59744
s_waitcnt vmcnt(16) lgkmcnt(8)
.Lpad9:
s_cbranch_execz .Lnopoll37r
s_barrier
MAV 32,0,144
TR 32,6,50688
s_add_u32 m0, s55, 101376
MAV 32,16,152
buffer_load_dwordx4 v18, s[28:31], s54 offen lds
MAV 48,16,156
TR 34,6,51200
MAV 48,0,148
TR 36,6,50720
TR 38,6,51232
MAV 52,4,148
TR 48,6,59136
s_add_u32 s52, s78, 262144
MAV 52,20,156
buffer_load_dwordx4 v[128:131], v4, s[16:19], s52 offen sc1
MAV 36,20,152
TR 50,6,59648
MAV 36,4,144
TR 52,6,59168
TR 54,6,59680
s_waitcnt lgkmcnt(8)
MAV 40,8,144
TR 40,6,50752
MAV 40,24,152
buffer_load_dwordx4 v19, s[28:31], s54 offen offset:1056 lds
MAV 56,24,156
TR 42,6,51264
s_add_u32 s54, s100, 3145728
MAV 56,8,148
TR 44,6,50784
TR 46,6,51296
MAV 60,12,148
TR 56,6,59200
MAV 60,28,156
buffer_load_dwordx4 v[132:135], v4, s[16:19], s52 offen offset:1024 sc1
MAV 44,28,152
TR 58,6,59712
MAV 44,12,144
TR 60,6,59232
TR 62,6,59744
v_add_u32 v7, s57, v7
v_add_u32 v6, s57, v6
s_sub_u32 s57, 0, s57
s_waitcnt lgkmcnt(8)
MAV 64,32,144
ds_read_b64_tr_b16 a[0:1], v7
s_add_u32 m0, s55, 109824
MAV 64,48,152
buffer_load_dwordx4 v18, s[28:31], s54 offen lds
MAV 80,48,156
TR 2,7,512
MAV 80,32,148
TR 4,7,32
TR 6,7,544
MAV 84,36,148
TR 16,7,8448
s_add_u32 s52, s78, 327680
MAV 84,52,156
buffer_load_dwordx4 v[136:139], v4, s[16:19], s52 offen sc1
MAV 68,52,152
TR 18,7,8960
MAV 68,36,144
TR 20,7,8480
TR 22,7,8992
s_waitcnt lgkmcnt(8)
MAV 72,40,144
TR 8,7,64
MAV 72,56,152
buffer_load_dwordx4 v19, s[28:31], s54 offen offset:1056 lds
MAV 88,56,156
TR 10,7,576
s_add_u32 s54, s101, 3342336
MAV 88,40,148
TR 12,7,96
TR 14,7,608
MAV 92,44,148
TR 24,7,8512
MAV 92,60,156
buffer_load_dwordx4 v[140:143], v4, s[16:19], s52 offen offset:1024 sc1
MAV 76,60,152
TR 26,7,9024
MAV 76,44,144
TR 28,7,8544
TR 30,7,9056
s_waitcnt vmcnt(16) lgkmcnt(8)
s_barrier
MAV 32,0,96
ds_read_b64_tr_b16 a[32:33], v6
s_add_u32 m0, s55, 118272
MAV 32,16,104
buffer_load_dwordx4 v18, s[28:31], s54 offen lds
MAV 48,16,108
TR 34,6,512
MAV 48,0,100
TR 36,6,32
TR 38,6,544
MAV 52,4,100
TR 48,6,8448
s_add_u32 s52, s79, 376832
MAV 52,20,108
buffer_load_dwordx4 v[144:147], v4, s[16:19], s52 offen sc1
MAV 36,20,104
TR 50,6,8960
MAV 36,4,96
TR 52,6,8480
TR 54,6,8992
s_waitcnt lgkmcnt(8)
MAV 40,8,96
TR 40,6,64
MAV 40,24,104
buffer_load_dwordx4 v19, s[28:31], s54 offen offset:1056 lds
MAV 56,24,108
TR 42,6,576
s_add_u32 s54, s101, 3604480
MAV 56,8,100
TR 44,6,96
TR 46,6,608
MAV 60,12,100
TR 56,6,8512
MAV 60,28,108
buffer_load_dwordx4 v[148:151], v4, s[16:19], s52 offen offset:1024 sc1
MAV 44,28,104
TR 58,6,9024
MAV 44,12,96
TR 60,6,8544
TR 62,6,9056
s_waitcnt lgkmcnt(8)
MAV 64,32,96
TR 0,7,16896
s_add_u32 m0, s55, 126720
MAV 64,48,104
buffer_load_dwordx4 v18, s[28:31], s54 offen lds
MAV 80,48,108
TR 2,7,17408
MAV 80,32,100
TR 4,7,16928
TR 6,7,17440
MAV 84,36,100
TR 16,7,25344
s_add_u32 s52, s79, 442368
MAV 84,52,108
buffer_load_dwordx4 v[152:155], v4, s[16:19], s52 offen sc1
MAV 68,52,104
TR 18,7,25856
MAV 68,36,96
TR 20,7,25376
TR 22,7,25888
s_waitcnt lgkmcnt(8)
MAV 72,40,96
TR 8,7,16960
MAV 72,56,104
buffer_load_dwordx4 v19, s[28:31], s54 offen offset:1056 lds
MAV 88,56,108
TR 10,7,17472
s_add_u32 s54, s98, 196608
MAV 88,40,100
TR 12,7,16992
TR 14,7,17504
MAV 92,44,100
TR 24,7,25408
MAV 92,60,108
buffer_load_dwordx4 v[156:159], v4, s[16:19], s52 offen offset:1024 sc1
MAV 76,60,104
TR 26,7,25920
MAV 76,44,96
TR 28,7,25440
TR 30,7,25952
s_waitcnt vmcnt(16) lgkmcnt(8)
s_barrier
MAV 32,0,112
TR 32,6,16896
s_add_u32 m0, s55, 0
MAV 32,16,120
buffer_load_dwordx4 v18, s[28:31], s54 offen lds
MAV 48,16,124
TR 34,6,17408
MAV 48,0,116
TR 36,6,16928
TR 38,6,17440
MAV 52,4,116
TR 48,6,25344
s_add_u32 s52, s76, 491520
MAV 52,20,124
buffer_load_dwordx4 v[96:99], v4, s[16:19], s52 offen sc1
MAV 36,20,120
TR 50,6,25856
MAV 36,4,112
TR 52,6,25376
TR 54,6,25888
s_waitcnt lgkmcnt(8)
MAV 40,8,112
TR 40,6,16960
MAV 40,24,120
buffer_load_dwordx4 v19, s[28:31], s54 offen offset:1056 lds
MAV 56,24,124
TR 42,6,17472
s_add_u32 s54, s99, 655360
MAV 56,8,116
TR 44,6,16992
TR 46,6,17504
MAV 60,12,116
TR 56,6,25408
MAV 60,28,124
buffer_load_dwordx4 v[100:103], v4, s[16:19], s52 offen offset:1024 sc1
MAV 44,28,120
TR 58,6,25920
MAV 44,12,112
TR 60,6,25440
TR 62,6,25952
s_waitcnt lgkmcnt(8)
MAV 64,32,112
TR 0,7,33792
s_add_u32 m0, s55, 8448
MAV 64,48,120
buffer_load_dwordx4 v18, s[28:31], s54 offen lds
MAV 80,48,124
TR 2,7,34304
MAV 80,32,116
TR 4,7,33824
TR 6,7,34336
MAV 84,36,116
TR 16,7,42240
s_add_u32 s52, s76, 557056
MAV 84,52,124
buffer_load_dwordx4 v[104:107], v4, s[16:19], s52 offen sc1
MAV 68,52,120
TR 18,7,42752
MAV 68,36,112
TR 20,7,42272
TR 22,7,42784
s_waitcnt lgkmcnt(8)
MAV 72,40,112
TR 8,7,33856
MAV 72,56,120
buffer_load_dwordx4 v19, s[28:31], s54 offen offset:1056 lds
MAV 88,56,124
TR 10,7,34368
s_add_u32 s54, s100, 1114112
MAV 88,40,116
TR 12,7,33888
TR 14,7,34400
MAV 92,44,116
TR 24,7,42304
MAV 92,60,124
buffer_load_dwordx4 v[108:111], v4, s[16:19], s52 offen offset:1024 sc1
MAV 76,60,120
TR 26,7,42816
MAV 76,44,112
TR 28,7,42336
TR 30,7,42848
s_waitcnt vmcnt(16) lgkmcnt(8)
s_barrier
MAV 32,0,128
TR 32,6,33792
s_add_u32 m0, s55, 16896
MAV 32,16,136
buffer_load_dwordx4 v18, s[28:31], s54 offen lds
MAV 48,16,140
TR 34,6,34304
MAV 48,0,132
TR 36,6,33824
TR 38,6,34336
MAV 52,4,132
TR 48,6,42240
s_add_u32 s52, s77, 606208
MAV 52,20,140
buffer_load_dwordx4 v[112:115], v4, s[16:19], s52 offen sc1
MAV 36,20,136
TR 50,6,42752
MAV 36,4,128
TR 52,6,42272
TR 54,6,42784
s_waitcnt lgkmcnt(8)
MAV 40,8,128
TR 40,6,33856
MAV 40,24,136
buffer_load_dwordx4 v19, s[28:31], s54 offen offset:1056 lds
MAV 56,24,140
TR 42,6,34368
s_add_u32 s54, s101, 1572864
MAV 56,8,132
TR 44,6,33888
TR 46,6,34400
MAV 60,12,132
TR 56,6,42304
MAV 60,28,140
buffer_load_dwordx4 v[116:119], v4, s[16:19], s52 offen offset:1024 sc1
MAV 44,28,136
TR 58,6,42816
MAV 44,12,128
TR 60,6,42336
TR 62,6,42848
s_waitcnt lgkmcnt(8)
MAV 64,32,128
TR 0,7,50688
s_add_u32 m0, s55, 25344
MAV 64,48,136
buffer_load_dwordx4 v18, s[28:31], s54 offen lds
MAV 80,48,140
TR 2,7,51200
MAV 80,32,132
TR 4,7,50720
TR 6,7,51232
MAV 84,36,132
TR 16,7,59136
s_add_u32 s52, s77, 671744
MAV 84,52,140
buffer_load_dwordx4 v[120:123], v4, s[16:19], s52 offen sc1
MAV 68,52,136
TR 18,7,59648
MAV 68,36,128
TR 20,7,59168
TR 22,7,59680
s_waitcnt lgkmcnt(8)
MAV 72,40,128
TR 8,7,50752
MAV 72,56,136
buffer_load_dwordx4 v19, s[28:31], s54 offen offset:1056 lds
MAV 88,56,140
TR 10,7,51264
s_add_u32 s54, s98, 2031616
MAV 88,40,132
TR 12,7,50784
TR 14,7,51296
MAV 92,44,132
TR 24,7,59200
MAV 92,60,140
buffer_load_dwordx4 v[124:127], v4, s[16:19], s52 offen offset:1024 sc1
MAV 76,60,136
TR 26,7,59712
MAV 76,44,128
TR 28,7,59232
TR 30,7,59744
s_waitcnt vmcnt(16) lgkmcnt(8)
s_barrier
MAV 32,0,144
TR 32,6,50688
s_add_u32 m0, s55, 33792
MAV 32,16,152
buffer_load_dwordx4 v18, s[28:31], s54 offen lds
MAV 48,16,156
TR 34,6,51200
MAV 48,0,148
TR 36,6,50720
TR 38,6,51232
MAV 52,4,148
TR 48,6,59136
s_add_u32 s52, s78, 720896
MAV 52,20,156
buffer_load_dwordx4 v[128:131], v4, s[16:19], s52 offen sc1
MAV 36,20,152
TR 50,6,59648
MAV 36,4,144
TR 52,6,59168
TR 54,6,59680
s_waitcnt lgkmcnt(8)
MAV 40,8,144
TR 40,6,50752
MAV 40,24,152
buffer_load_dwordx4 v19, s[28:31], s54 offen offset:1056 lds
MAV 56,24,156
TR 42,6,51264
s_add_u32 s54, s99, 2490368
MAV 56,8,148
TR 44,6,50784
TR 46,6,51296
MAV 60,12,148
TR 56,6,59200
MAV 60,28,156
buffer_load_dwordx4 v[132:135], v4, s[16:19], s52 offen offset:1024 sc1
MAV 44,28,152
TR 58,6,59712
MAV 44,12,144
TR 60,6,59232
TR 62,6,59744
v_add_u32 v7, s57, v7
v_add_u32 v6, s57, v6
s_sub_u32 s57, 0, s57
s_waitcnt lgkmcnt(8)
MAV 64,32,144
ds_read_b64_tr_b16 a[0:1], v6
s_add_u32 m0, s55, 42240
MAV 64,48,152
buffer_load_dwordx4 v18, s[28:31], s54 offen lds
MAV 80,48,156
TR 2,6,512
MAV 80,32,148
TR 4,6,32
TR 6,6,544
MAV 84,36,148
TR 16,6,8448
s_add_u32 s52, s78, 786432
MAV 84,52,156
buffer_load_dwordx4 v[136:139], v4, s[16:19], s52 offen sc1
MAV 68,52,152
TR 18,6,8960
MAV 68,36,144
TR 20,6,8480
TR 22,6,8992
s_waitcnt lgkmcnt(8)
MAV 72,40,144
TR 8,6,64
MAV 72,56,152
buffer_load_dwordx4 v19, s[28:31], s54 offen offset:1056 lds
MAV 88,56,156
TR 10,6,576
s_add_u32 s54, s100, 2949120
MAV 88,40,148
TR 12,6,96
TR 14,6,608
MAV 92,44,148
TR 24,6,8512
MAV 92,60,156
buffer_load_dwordx4 v[140:143], v4, s[16:19], s52 offen offset:1024 sc1
MAV 76,60,152
TR 26,6,9024
MAV 76,44,144
TR 28,6,8544
TR 30,6,9056
s_waitcnt vmcnt(16) lgkmcnt(8)
s_barrier
MAV 64,0,96
TR 32,6,16896
TR 34,6,17408
s_add_u32 m0, s55, 50688
MAV 64,16,104
TR 36,6,16928
buffer_load_dwordx4 v18, s[28:31], s54 offen lds
MAV 80,16,108
TR 38,6,17440
MAV 80,0,100
TR 48,6,25344
buffer_load_dwordx4 v19, s[28:31], s54 offen offset:1056 lds
MAV 84,4,100
TR 50,6,25856
s_add_u32 s54, s101, 3407872
s_add_u32 s52, s79, 835584
MAV 84,20,108
buffer_load_dwordx4 v[144:147], v4, s[16:19], s52 offen sc1
MAV 68,20,104
TR 52,6,25376
TR 54,6,25888
MAV 68,4,96
TR 40,6,16960
s_waitcnt lgkmcnt(9)
MAV 72,8,96
TR 42,6,17472
MAV 72,24,104
TR 44,6,16992
buffer_load_dwordx4 v[148:151], v4, s[16:19], s52 offen offset:1024 sc1
MAV 88,24,108
TR 46,6,17504
s_add_u32 m0, s55, 59136
MAV 88,8,100
TR 56,6,25408
buffer_load_dwordx4 v18, s[28:31], s54 offen lds
MAV 92,12,100
TR 58,6,25920
MAV 92,28,108
TR 60,6,25440
buffer_load_dwordx4 v19, s[28:31], s54 offen offset:1056 lds
MAV 76,28,104
TR 62,6,25952
s_add_u32 s52, s79, 901120
MAV 76,12,96
buffer_load_dwordx4 v[152:155], v4, s[16:19], s52 offen sc1
buffer_load_dwordx4 v[156:159], v4, s[16:19], s52 offen offset:1024 sc1
s_waitcnt vmcnt(16) lgkmcnt(8)
MAV 64,32,112
TR 0,6,33792
s_add_u32 s52, s76, 49152
s_lshl_b32 s70, s2, 10
MAV 64,48,120
buffer_load_dwordx4 v[160:163], v4, s[16:19], s52 offen sc1
s_lshl_b32 s62, s3, 7
MAV 80,48,124
TR 2,6,34304
s_add_u32 s70, s70, s62
s_add_u32 s70, s70, 31457280
MAV 80,32,116
TR 4,6,33824
TR 6,6,34336
MAV 84,36,116
TR 16,6,42240
s_xor_b32 s71, s70, 1024
v_min_u32 v12, 1, v1
MAV 84,52,124
buffer_load_dwordx4 v[164:167], v4, s[16:19], s52 offen offset:1024 sc1
v_lshlrev_b32 v12, 28, v12
MAV 68,52,120
TR 18,6,42752
v_mov_b32 v13, 1
MAV 68,36,112
TR 20,6,42272
TR 22,6,42784
s_waitcnt lgkmcnt(8)
MAV 72,40,112
TR 8,6,33856
s_add_u32 s52, s77, 163840
v_mov_b32 v15, 0
MAV 72,56,120
buffer_load_dwordx4 v[168:171], v4, s[16:19], s52 offen sc1
s_lshl_b32 s68, s7, 18
MAV 88,56,124
TR 10,6,34368
s_add_u32 s68, s68, 33554432
s_xor_b32 s69, s68, 262144
MAV 88,40,116
TR 12,6,33888
TR 14,6,34400
MAV 92,44,116
TR 24,6,42304
v_mov_b32 v11, v4
v_and_b32 v2, 1, v1
MAV 92,60,124
buffer_load_dwordx4 v[172:175], v4, s[16:19], s52 offen offset:1024 sc1
v_lshlrev_b32 v2, 4, v2
MAV 76,60,120
TR 26,6,42816
v_mov_b32 v224, 0x3f80
MAV 76,44,112
TR 28,6,42336
TR 30,6,42848
s_waitcnt vmcnt(12) lgkmcnt(8)
MAV 64,0,128
TR 32,6,50688
s_add_u32 s52, s78, 278528
v_lshlrev_b32 v2, v2, v224
MAV 64,16,136
buffer_load_dwordx4 v[176:179], v4, s[16:19], s52 offen sc1
v_bfe_u32 v224, v1, 2, 2
MAV 80,16,140
TR 34,6,51200
v_lshrrev_b32 v225, 4, v1
v_cmp_eq_u32 vcc, v224, v225
MAV 80,0,132
.Lpad10:
s_cbranch_execz .Lnopoll37r
TR 36,6,50720
TR 38,6,51232
MAV 84,4,132
TR 48,6,59136
v_cndmask_b32 v2, 0, v2, vcc
v_and_b32 v224, 2, v1
MAV 84,20,140
buffer_load_dwordx4 v[180:183], v4, s[16:19], s52 offen offset:1024 sc1
v_cmp_eq_u32 vcc, 0, v224
MAV 68,20,136
TR 50,6,59648
v_cndmask_b32 v226, 0, v2, vcc
MAV 68,4,128
TR 52,6,59168
TR 54,6,59680
s_waitcnt lgkmcnt(8)
MAV 72,8,128
TR 40,6,50752
s_add_u32 s52, s79, 393216
v_cndmask_b32 v227, v2, 0, vcc
MAV 72,24,136
buffer_load_dwordx4 v[184:187], v4, s[16:19], s52 offen sc1
v_mov_b32 v224, 0
MAV 88,24,140
TR 42,6,51264
v_mov_b32 v225, 0
v_mov_b32 v228, 0
MAV 88,8,132
TR 44,6,50784
TR 46,6,51296
MAV 92,12,132
TR 56,6,59200
v_mov_b32 v229, 0
v_bfe_u32 v18, v1, 3, 1
MAV 92,28,140
buffer_load_dwordx4 v[188:191], v4, s[16:19], s52 offen offset:1024 sc1
v_lshrrev_b32 v2, 4, v1
MAV 76,28,136
TR 58,6,59712
v_lshl_add_u32 v18, v2, 3, v18
MAV 76,12,128
TR 60,6,59232
TR 62,6,59744
s_waitcnt vmcnt(8) lgkmcnt(8)
s_barrier
v_add_u32 v6, s57, v6
MAV 64,32,144
ds_read_b64_tr_b16 a[0:1], v6
s_add_u32 s52, s76, 507904
s_lshl_b32 s62, s3, 1
MAV 64,48,152
buffer_load_dwordx4 v[192:195], v4, s[16:19], s52 offen sc1
v_add_u32 v18, s62, v18
MAV 80,48,156
TR 2,6,512
v_mul_u32_u24 v18, 6144, v18
v_and_b32 v2, 7, v1
MAV 80,32,148
TR 4,6,32
TR 6,6,544
MAV 84,36,148
TR 16,6,8448
v_lshl_add_u32 v18, v2, 4, v18
s_lshl_b32 s62, s9, 7
MAV 84,52,156
buffer_load_dwordx4 v[196:199], v4, s[16:19], s52 offen offset:1024 sc1
v_add_u32 v18, s62, v18
MAV 68,52,152
TR 18,6,8960
v_add_u32 v19, 1024, v18
MAV 68,36,144
TR 20,6,8480
TR 22,6,8992
s_waitcnt lgkmcnt(8)
MAV 72,40,144
TR 8,6,64
s_add_u32 s52, s77, 622592
v_add_u32 v20, 2048, v18
MAV 72,56,152
buffer_load_dwordx4 v[200:203], v4, s[16:19], s52 offen sc1
s_mul_i32 s59, s3, 3104
MAV 88,56,156
TR 10,6,576
s_mov_b32 s58, 0
v_accvgpr_read_b32 v28, a224
MAV 88,40,148
TR 12,6,96
TR 14,6,608
MAV 92,44,148
TR 24,6,8512
v_add_f32 v32, v32, v28
v_accvgpr_read_b32 v29, a225
MAV 92,60,156
buffer_load_dwordx4 v[204:207], v4, s[16:19], s52 offen offset:1024 sc1
v_add_f32 v33, v33, v29
MAV 76,60,152
TR 26,6,9024
v_accvgpr_read_b32 v28, a226
MAV 76,44,144
TR 28,6,8544
TR 30,6,9056
s_waitcnt vmcnt(8) lgkmcnt(8)
MAV 64,0,160
TR 32,6,16896
s_add_u32 s52, s78, 737280
v_add_f32 v34, v34, v28
MAV 64,16,168
buffer_load_dwordx4 v[208:211], v4, s[16:19], s52 offen sc1
v_accvgpr_read_b32 v29, a227
MAV 80,16,172
TR 34,6,17408
v_add_f32 v35, v35, v29
v_accvgpr_read_b32 v28, a228
MAV 80,0,164
TR 36,6,16928
TR 38,6,17440
MAV 84,4,164
TR 48,6,25344
v_add_f32 v36, v36, v28
v_accvgpr_read_b32 v29, a229
MAV 84,20,172
buffer_load_dwordx4 v[212:215], v4, s[16:19], s52 offen offset:1024 sc1
v_add_f32 v37, v37, v29
MAV 68,20,168
TR 50,6,25856
v_accvgpr_read_b32 v28, a230
MAV 68,4,160
TR 52,6,25376
TR 54,6,25888
s_waitcnt lgkmcnt(8)
MAV 72,8,160
TR 40,6,16960
s_add_u32 s52, s79, 851968
v_add_f32 v38, v38, v28
MAV 72,24,168
buffer_load_dwordx4 v[216:219], v4, s[16:19], s52 offen sc1
v_accvgpr_read_b32 v29, a231
MAV 88,24,172
TR 42,6,17472
v_add_f32 v39, v39, v29
v_accvgpr_read_b32 v28, a232
MAV 88,8,164
TR 44,6,16992
TR 46,6,17504
MAV 92,12,164
TR 56,6,25408
v_add_f32 v40, v40, v28
v_accvgpr_read_b32 v29, a233
MAV 92,28,172
buffer_load_dwordx4 v[220:223], v4, s[16:19], s52 offen offset:1024 sc1
v_add_f32 v41, v41, v29
MAV 76,28,168
TR 58,6,25920
v_accvgpr_read_b32 v28, a234
MAV 76,12,160
TR 60,6,25440
TR 62,6,25952
s_waitcnt vmcnt(8) lgkmcnt(8)
MAV 64,32,176
TR 0,6,33792
v_add_f32 v42, v42, v28
MAV 64,48,184
TR 2,6,34304
v_accvgpr_read_b32 v29, a235
v_add_f32 v43, v43, v29
MAV 80,48,188
TR 4,6,33824
MAV 80,32,180
TR 6,6,34336
v_accvgpr_read_b32 v28, a236
v_add_f32 v44, v44, v28
MAV 84,36,180
TR 16,6,42240
MAV 84,52,188
TR 18,6,42752
v_accvgpr_read_b32 v29, a237
v_add_f32 v45, v45, v29
MAV 68,52,184
TR 20,6,42272
MAV 68,36,176
TR 22,6,42784
v_accvgpr_read_b32 v28, a238
s_waitcnt lgkmcnt(8)
MAV 72,40,176
TR 8,6,33856
v_add_f32 v46, v46, v28
MAV 72,56,184
TR 10,6,34368
v_accvgpr_read_b32 v29, a239
MAV 88,56,188
TR 12,6,33888
v_add_f32 v47, v47, v29
MAV 88,40,180
TR 14,6,34400
v_accvgpr_read_b32 v28, a240
MAV 92,44,180
TR 24,6,42304
v_add_f32 v48, v48, v28
MAV 92,60,188
TR 26,6,42816
v_accvgpr_read_b32 v29, a241
MAV 76,60,184
TR 28,6,42336
v_add_f32 v49, v49, v29
MAV 76,44,176
TR 30,6,42848
v_accvgpr_read_b32 v28, a242
s_waitcnt vmcnt(4) lgkmcnt(8)
MAV 64,0,192
TR 32,6,50688
v_add_f32 v50, v50, v28
MAV 64,16,200
TR 34,6,51200
v_accvgpr_read_b32 v29, a243
v_add_f32 v51, v51, v29
MAV 80,16,204
TR 36,6,50720
MAV 80,0,196
TR 38,6,51232
v_accvgpr_read_b32 v28, a244
v_add_f32 v52, v52, v28
MAV 84,4,196
TR 48,6,59136
MAV 84,20,204
TR 50,6,59648
v_accvgpr_read_b32 v29, a245
v_add_f32 v53, v53, v29
MAV 68,20,200
TR 52,6,59168
MAV 68,4,192
TR 54,6,59680
v_accvgpr_read_b32 v28, a246
s_waitcnt lgkmcnt(8)
MAV 72,8,192
TR 40,6,50752
v_add_f32 v54, v54, v28
MAV 72,24,200
TR 42,6,51264
v_accvgpr_read_b32 v29, a247
MAV 88,24,204
TR 44,6,50784
v_add_f32 v55, v55, v29
MAV 88,8,196
TR 46,6,51296
v_accvgpr_read_b32 v28, a248
MAV 92,12,196
TR 56,6,59200
v_add_f32 v56, v56, v28
MAV 92,28,204
TR 58,6,59712
v_accvgpr_read_b32 v29, a249
MAV 76,28,200
TR 60,6,59232
v_add_f32 v57, v57, v29
MAV 76,12,192
TR 62,6,59744
v_accvgpr_read_b32 v28, a250
s_waitcnt vmcnt(0) lgkmcnt(8)
MAV 64,32,208
ds_read_b64_tr_b16 a[0:1], v7
v_add_f32 v58, v58, v28
MAV 64,48,216
TR 2,7,512
v_accvgpr_read_b32 v29, a251
MAV 80,48,220
TR 4,7,32
v_add_f32 v59, v59, v29
MAV 80,32,212
TR 6,7,544
MAV 84,36,212
TR 16,7,8448
v_accvgpr_read_b32 v28, a252
MAV 84,52,220
TR 18,7,8960
v_add_f32 v60, v60, v28
MAV 68,52,216
TR 20,7,8480
v_accvgpr_read_b32 v29, a253
MAV 68,36,208
TR 22,7,8992
s_waitcnt lgkmcnt(8)
MAV 72,40,208
TR 8,7,64
MAV 72,56,216
TR 10,7,576
v_add_f32 v61, v61, v29
MAV 88,56,220
TR 12,7,96
v_accvgpr_read_b32 v28, a254
MAV 88,40,212
TR 14,7,608
v_add_f32 v62, v62, v28
MAV 92,44,212
TR 24,7,8512
MAV 92,60,220
TR 26,7,9024
v_accvgpr_read_b32 v29, a255
MAV 76,60,216
TR 28,7,8544
v_add_f32 v63, v63, v29
MAV 76,44,208
TR 30,7,9056
s_waitcnt lgkmcnt(8)
MAV 32,0,96
TR 32,7,16896
v_cvt_pk_bf16_f32 v232, v64, v65
MAV 32,16,104
TR 34,7,17408
v_cvt_pk_bf16_f32 v233, v66, v67
v_cvt_pk_bf16_f32 v234, v68, v69
MAV 48,16,108
TR 36,7,16928
v_cvt_pk_bf16_f32 v235, v70, v71
MAV 48,0,100
TR 38,7,17440
buffer_store_dwordx4 v[232:235], v11, s[16:19], s69 offen sc1
s_add_u32 s69, s69, 131072
MAV 52,4,100
TR 48,7,25344
v_cvt_pk_bf16_f32 v236, v72, v73
MAV 52,20,108
TR 50,7,25856
v_cvt_pk_bf16_f32 v237, v74, v75
v_cvt_pk_bf16_f32 v238, v76, v77
MAV 36,20,104
TR 52,7,25376
v_cvt_pk_bf16_f32 v239, v78, v79
MAV 36,4,96
TR 54,7,25888
buffer_store_dwordx4 v[236:239], v11, s[16:19], s69 offen sc1
s_waitcnt lgkmcnt(8)
MAV 40,8,96
TR 40,7,16960
s_add_u32 s69, s69, -130048
MAV 40,24,104
TR 42,7,17472
v_cvt_pk_bf16_f32 v240, v80, v81
v_cvt_pk_bf16_f32 v241, v82, v83
MAV 56,24,108
TR 44,7,16992
v_cvt_pk_bf16_f32 v242, v84, v85
MAV 56,8,100
TR 46,7,17504
v_cvt_pk_bf16_f32 v243, v86, v87
buffer_store_dwordx4 v[240:243], v11, s[16:19], s69 offen sc1
MAV 60,12,100
TR 56,7,25408
s_add_u32 s69, s69, 131072
MAV 60,28,108
TR 58,7,25920
v_cvt_pk_bf16_f32 v244, v88, v89
v_cvt_pk_bf16_f32 v245, v90, v91
MAV 44,28,104
TR 60,7,25440
v_cvt_pk_bf16_f32 v246, v92, v93
MAV 44,12,96
TR 62,7,25952
v_cvt_pk_bf16_f32 v247, v94, v95
buffer_store_dwordx4 v[244:247], v11, s[16:19], s69 offen sc1
s_waitcnt lgkmcnt(8)
MAV 32,32,112
TR 0,7,33792
MAV 32,48,120
TR 2,7,34304
MAV 48,48,124
TR 4,7,33824
MAV 48,32,116
TR 6,7,34336
MAV 52,36,116
TR 16,7,42240
MAV 52,52,124
TR 18,7,42752
MAV 36,52,120
TR 20,7,42272
MAV 36,36,112
TR 22,7,42784
s_waitcnt lgkmcnt(8)
MAV 40,40,112
TR 8,7,33856
MAV 40,56,120
TR 10,7,34368
MAV 56,56,124
TR 12,7,33888
MAV 56,40,116
TR 14,7,34400
MAV 60,44,116
TR 24,7,42304
MAV 60,60,124
TR 26,7,42816
MAV 44,60,120
TR 28,7,42336
MAV 44,44,112
TR 30,7,42848
s_waitcnt lgkmcnt(8)
MAV 32,0,128
TR 32,7,50688
MAV 32,16,136
TR 34,7,51200
MAV 48,16,140
TR 36,7,50720
MAV 48,0,132
TR 38,7,51232
MAV 52,4,132
TR 48,7,59136
MAV 52,20,140
TR 50,7,59648
MAV 36,20,136
TR 52,7,59168
MAV 36,4,128
TR 54,7,59680
s_waitcnt lgkmcnt(8)
MAV 40,8,128
TR 40,7,50752
MAV 40,24,136
TR 42,7,51264
MAV 56,24,140
TR 44,7,50784
MAV 56,8,132
TR 46,7,51296
MAV 60,12,132
TR 56,7,59200
MAV 60,28,140
TR 58,7,59712
MAV 44,28,136
TR 60,7,59232
MAV 44,12,128
TR 62,7,59744
v_add_u32 v7, s57, v7
s_waitcnt lgkmcnt(8)
MAV 32,32,144
ds_read_b64_tr_b16 a[0:1], v7
MAV 32,48,152
s_waitcnt vmcnt(0)
buffer_atomic_add v13, v12, s[16:19], s71 offen
MAV 48,48,156
TR 2,7,512
MAV 48,32,148
TR 4,7,32
TR 6,7,544
MAV 52,36,148
MAV 52,52,156
TR 16,7,8448
TR 18,7,8960
MAV 36,52,152
TR 20,7,8480
MAV 36,36,144
s_waitcnt lgkmcnt(7)
MAV 40,40,144
TR 22,7,8992
MAV 40,56,152
TR 8,7,64
TR 10,7,576
MAV 56,56,156
MAV 56,40,148
TR 12,7,96
TR 14,7,608
MAV 60,44,148
TR 24,7,8512
MAV 60,60,156
TR 26,7,9024
MAV 44,60,152
TR 28,7,8544
MAV 44,44,144
TR 30,7,9056
s_waitcnt lgkmcnt(8)
s_barrier
MAV 32,0,160
TR 32,7,16896
TR 34,7,17408
MAV 32,16,168
buffer_atomic_add v15, v12, s[16:19], s70 offen sc0
MAV 48,16,172
TR 36,7,16928
TR 38,7,17440
MAV 48,0,164
TR 48,7,25344
MAV 52,4,164
TR 50,7,25856
s_add_u32 m0, s59, 117248
MAV 52,20,172
TR 52,7,25376
buffer_load_dwordx4 v18, s[20:23], s58 offen lds
MAV 36,20,168
TR 54,7,25888
MAV 36,4,160
TR 40,7,16960
s_waitcnt lgkmcnt(9)
MAV 40,8,160
TR 42,7,17472
MAV 40,24,168
TR 44,7,16992
buffer_load_dwordx4 v19, s[20:23], s58 offen offset:1024 lds
MAV 56,24,172
TR 46,7,17504
MAV 56,8,164
TR 56,7,25408
buffer_load_dwordx4 v20, s[20:23], s58 offen offset:2048 lds
MAV 60,12,164
s_add_u32 s58, s58, 196608
s_add_u32 m0, s59, 129664
MAV 60,28,172
TR 58,7,25920
buffer_load_dwordx4 v18, s[20:23], s58 offen lds
MAV 44,28,168
TR 60,7,25440
MAV 44,12,160
TR 62,7,25952
s_waitcnt lgkmcnt(8)
MAV 32,32,176
TR 0,7,33792
MAV 32,48,184
buffer_load_dwordx4 v19, s[20:23], s58 offen offset:1024 lds
MAV 48,48,188
TR 2,7,34304
MAV 48,32,180
TR 4,7,33824
TR 6,7,34336
MAV 52,36,180
TR 16,7,42240
MAV 52,52,188
buffer_load_dwordx4 v20, s[20:23], s58 offen offset:2048 lds
MAV 36,52,184
TR 18,7,42752
s_add_u32 s58, s58, 196608
MAV 36,36,176
TR 20,7,42272
TR 22,7,42784
s_waitcnt lgkmcnt(8)
MAV 40,40,176
TR 8,7,33856
s_add_u32 m0, s59, 67584
MAV 40,56,184
buffer_load_dwordx4 v18, s[20:23], s58 offen lds
MAV 56,56,188
TR 10,7,34368
MAV 56,40,180
TR 12,7,33888
TR 14,7,34400
MAV 60,44,180
TR 24,7,42304
MAV 60,60,188
buffer_load_dwordx4 v19, s[20:23], s58 offen offset:1024 lds
MAV 44,60,184
TR 26,7,42816
MAV 44,44,176
TR 28,7,42336
TR 30,7,42848
s_waitcnt vmcnt(8)
v_cmp_ne_u32 vcc, 0, v15
s_nop 0
s_cbranch_vccz .Lxs51
.Lxs51b:
.Lpad11:
s_cbranch_execz .Lnopoll37r
s_waitcnt lgkmcnt(8)
MAV 32,0,192
TR 32,7,50688
TR 34,7,51200
MAV 32,16,200
TR 36,7,50720
buffer_load_dwordx4 v[232:235], v11, s[16:19], s68 offen sc1
MAV 48,16,204
TR 38,7,51232
s_add_u32 s68, s68, 131072
MAV 48,0,196
TR 48,7,59136
buffer_load_dwordx4 v[236:239], v11, s[16:19], s68 offen sc1
MAV 52,4,196
TR 50,7,59648
s_add_u32 s68, s68, -130048
MAV 52,20,204
TR 52,7,59168
buffer_load_dwordx4 v[240:243], v11, s[16:19], s68 offen sc1
MAV 36,20,200
TR 54,7,59680
s_add_u32 s68, s68, 131072
MAV 36,4,192
TR 40,7,50752
s_waitcnt lgkmcnt(9)
MAV 40,8,192
TR 42,7,51264
TR 44,7,50784
MAV 40,24,200
buffer_load_dwordx4 v[244:247], v11, s[16:19], s68 offen sc1
MAV 56,24,204
TR 46,7,51296
TR 56,7,59200
MAV 56,8,196
TR 58,7,59712
buffer_load_dwordx4 v20, s[20:23], s58 offen offset:2048 lds
MAV 60,12,196
s_add_u32 s58, s58, 196608
s_add_u32 m0, s59, 80000
MAV 60,28,204
TR 60,7,59232
buffer_load_dwordx4 v18, s[20:23], s58 offen lds
MAV 44,28,200
TR 62,7,59744
MAV 44,12,192
buffer_load_dwordx4 v19, s[20:23], s58 offen offset:1024 lds
buffer_load_dwordx4 v20, s[20:23], s58 offen offset:2048 lds
s_add_u32 s58, s58, 196608
s_waitcnt lgkmcnt(8)
MAV 32,32,208
s_add_u32 m0, s59, 92416
MAV 32,48,216
buffer_load_dwordx4 v18, s[20:23], s58 offen lds
MAV 48,48,220
MAV 48,32,212
MAV 52,36,212
MAV 52,52,220
MAV 36,52,216
MAV 36,36,208
s_waitcnt lgkmcnt(0)
MAV 40,40,208
MAV 40,56,216
buffer_load_dwordx4 v19, s[20:23], s58 offen offset:1024 lds
MAV 56,56,220
MAV 56,40,212
buffer_load_dwordx4 v20, s[20:23], s58 offen offset:2048 lds
MAV 60,44,212
s_add_u32 s58, s58, 196608
MAV 60,60,220
MAV 44,60,216
MAV 44,44,208
s_waitcnt vmcnt(10)
v_mfma_f32_16x16x32_bf16 v[32:35], v[226:229], v[232:235], v[32:35]
s_lshl_b32 s64, s6, 14
s_lshl_b32 s65, s49, 13
s_add_u32 s64, s64, s65
v_mfma_f32_16x16x32_bf16 v[36:39], v[224:227], v[232:235], v[36:39]
s_lshl_b32 s65, s7, 9
s_add_u32 s64, s64, s65
s_lshl_b32 s65, s48, 8
s_waitcnt vmcnt(9)
v_mfma_f32_16x16x32_bf16 v[40:43], v[226:229], v[236:239], v[40:43]
s_add_u32 s64, s64, s65
s_add_u32 s64, s64, 62914560
v_and_b32 v152, 31, v1
v_mfma_f32_16x16x32_bf16 v[44:47], v[224:227], v[236:239], v[44:47]
s_lshl_b32 s62, s7, 18
v_lshlrev_b32 v152, 3, v152
v_lshrrev_b32 v153, 5, v1
s_waitcnt vmcnt(8)
v_mfma_f32_16x16x32_bf16 v[48:51], v[226:229], v[240:243], v[48:51]
s_add_u32 s62, s62, 33554432
v_lshl_add_u32 v152, v153, 28, v152
s_add_u32 s63, s62, 131072
v_mfma_f32_16x16x32_bf16 v[52:55], v[224:227], v[240:243], v[52:55]
v_cvt_pk_bf16_f32 v128, v32, v33
v_cvt_pk_bf16_f32 v129, v34, v35
s_waitcnt vmcnt(7)
v_mfma_f32_16x16x32_bf16 v[56:59], v[226:229], v[244:247], v[56:59]
v_cvt_pk_bf16_f32 v130, v36, v37
v_cvt_pk_bf16_f32 v131, v38, v39
v_mfma_f32_16x16x32_bf16 v[60:63], v[224:227], v[244:247], v[60:63]
buffer_store_dwordx4 v[128:131], v4, s[16:19], s62 offen sc1
v_cvt_pk_bf16_f32 v132, v40, v41
v_cvt_pk_bf16_f32 v133, v42, v43
v_cvt_pk_bf16_f32 v134, v44, v45
v_cvt_pk_bf16_f32 v135, v46, v47
v_cvt_pk_bf16_f32 v136, v48, v49
v_cvt_pk_bf16_f32 v137, v50, v51
v_cvt_pk_bf16_f32 v138, v52, v53
v_cvt_pk_bf16_f32 v139, v54, v55
v_cvt_pk_bf16_f32 v140, v56, v57
v_cvt_pk_bf16_f32 v141, v58, v59
v_cvt_pk_bf16_f32 v142, v60, v61
v_cvt_pk_bf16_f32 v143, v62, v63
v_pk_mul_f32 v[146:147], v[32:33], v[32:33]
buffer_store_dwordx4 v[132:135], v4, s[16:19], s63 offen sc1
v_pk_mul_f32 v[150:151], v[48:49], v[48:49]
v_pk_fma_f32 v[146:147], v[34:35], v[34:35], v[146:147]
v_pk_add_f32 v[144:145], v[32:33], v[34:35]
v_pk_fma_f32 v[150:151], v[50:51], v[50:51], v[150:151]
v_pk_add_f32 v[148:149], v[48:49], v[50:51]
v_pk_fma_f32 v[146:147], v[36:37], v[36:37], v[146:147]
v_pk_add_f32 v[144:145], v[144:145], v[36:37]
v_pk_fma_f32 v[150:151], v[52:53], v[52:53], v[150:151]
v_pk_add_f32 v[148:149], v[148:149], v[52:53]
v_pk_fma_f32 v[146:147], v[38:39], v[38:39], v[146:147]
v_pk_add_f32 v[144:145], v[144:145], v[38:39]
v_pk_fma_f32 v[150:151], v[54:55], v[54:55], v[150:151]
v_pk_add_f32 v[148:149], v[148:149], v[54:55]
buffer_store_dwordx4 v[136:139], v4, s[16:19], s62 offen offset:1024 sc1
v_pk_fma_f32 v[146:147], v[40:41], v[40:41], v[146:147]
v_pk_add_f32 v[144:145], v[144:145], v[40:41]
v_pk_fma_f32 v[150:151], v[56:57], v[56:57], v[150:151]
v_pk_add_f32 v[148:149], v[148:149], v[56:57]
v_pk_fma_f32 v[146:147], v[42:43], v[42:43], v[146:147]
v_pk_add_f32 v[144:145], v[144:145], v[42:43]
v_pk_fma_f32 v[150:151], v[58:59], v[58:59], v[150:151]
v_pk_add_f32 v[148:149], v[148:149], v[58:59]
v_pk_fma_f32 v[146:147], v[44:45], v[44:45], v[146:147]
v_pk_add_f32 v[144:145], v[144:145], v[44:45]
v_pk_fma_f32 v[150:151], v[60:61], v[60:61], v[150:151]
v_pk_add_f32 v[148:149], v[148:149], v[60:61]
v_pk_fma_f32 v[146:147], v[46:47], v[46:47], v[146:147]
buffer_store_dwordx4 v[140:143], v4, s[16:19], s63 offen offset:1024 sc1
v_pk_add_f32 v[144:145], v[144:145], v[46:47]
v_pk_fma_f32 v[150:151], v[62:63], v[62:63], v[150:151]
v_pk_add_f32 v[148:149], v[148:149], v[62:63]
v_add_f32 v144, v144, v145
v_add_f32 v146, v146, v147
v_add_f32 v148, v148, v149
v_add_f32 v150, v150, v151
s_nop 0
v_permlane16_swap_b32 v144, v148
v_permlane16_swap_b32 v146, v150
v_add_f32 v144, v144, v148
v_add_f32 v146, v146, v150
s_nop 1
v_permlane32_swap_b32 v144, v146
v_add_f32 v144, v144, v146
s_nop 1
v_permlane32_swap_b32 v144, v145
buffer_store_dwordx2 v[144:145], v152, s[16:19], s64 offen sc1
s_nop 1
v_accvgpr_write_b32 a224, v32
v_accvgpr_write_b32 a225, v33
v_accvgpr_write_b32 a226, v34
v_accvgpr_write_b32 a227, v35
v_accvgpr_write_b32 a228, v36
v_accvgpr_write_b32 a229, v37
v_accvgpr_write_b32 a230, v38
v_accvgpr_write_b32 a231, v39
v_accvgpr_write_b32 a232, v40
v_accvgpr_write_b32 a233, v41
v_accvgpr_write_b32 a234, v42
v_accvgpr_write_b32 a235, v43
v_accvgpr_write_b32 a236, v44
v_accvgpr_write_b32 a237, v45
v_accvgpr_write_b32 a238, v46
v_accvgpr_write_b32 a239, v47
v_accvgpr_write_b32 a240, v48
v_accvgpr_write_b32 a241, v49
v_accvgpr_write_b32 a242, v50
v_accvgpr_write_b32 a243, v51
v_accvgpr_write_b32 a244, v52
v_accvgpr_write_b32 a245, v53
v_accvgpr_write_b32 a246, v54
v_accvgpr_write_b32 a247, v55
v_accvgpr_write_b32 a248, v56
v_accvgpr_write_b32 a249, v57
v_accvgpr_write_b32 a250, v58
v_accvgpr_write_b32 a251, v59
v_accvgpr_write_b32 a252, v60
v_accvgpr_write_b32 a253, v61
v_accvgpr_write_b32 a254, v62
v_accvgpr_write_b32 a255, v63
s_lshl_b32 s62, s3, 11
s_add_u32 s62, s62, s85
v_lshl_add_u32 v21, v1, 4, s62
v_lshrrev_b32 v2, 3, v1
v_cmp_eq_u32 vcc, 3, v2
v_add_u32 v2, 67108480, v21
s_nop 0
v_cndmask_b32 v21, v21, v2, vcc
s_sub_u32 s62, s86, 2048
v_lshl_add_u32 v22, v0, 2, s62
v_lshrrev_b32 v2, 5, v0
v_cmp_eq_u32 vcc, 3, v2
v_add_u32 v2, 67108480, v22
s_nop 0
v_cndmask_b32 v22, v22, v2, vcc
s_mul_i32 s62, s48, 4608
v_lshl_add_u32 v23, v1, 4, s62
v_lshrrev_b32 v24, 4, v1
v_mul_u32_u24 v24, 2304, v24
v_and_b32 v2, 15, v1
v_lshl_add_u32 v24, v2, 4, v24
s_mov_b32 s52, 33554432
s_mov_b32 s54, s58
s_mov_b32 s56, s59
s_mul_i32 s55, s3, 2304
v_bfe_u32 v25, v1, 3, 2
v_mul_u32_u24 v25, 3104, v25
v_bfe_u32 v2, v1, 2, 1
v_lshl_add_u32 v25, v2, 7, v25
v_bfe_u32 v2, v1, 5, 1
v_lshl_add_u32 v25, v2, 8, v25
v_and_b32 v2, 3, v1
v_lshl_add_u32 v25, v2, 3, v25
s_lshl_b32 s62, s49, 6
s_add_u32 s62, s62, 67584
v_add_u32 v25, s62, v25
s_lshl_b32 s62, s8, 1
s_add_u32 s62, s62, s3
s_lshr_b32 s63, s50, 2
s_cmp_lt_u32 s3, 2
s_cselect_b32 s62, s62, s63
s_lshl_b32 s62, s62, 13
s_cmp_eq_u32 s3, 3
s_cselect_b32 s62, 268435456, s62
v_lshl_add_u32 v26, v1, 4, s62
s_lshr_b32 s63, s20, 7
s_sub_u32 s63, 3, s63
s_and_b32 s63, s63, 7
s_and_b32 s62, s9, 8
s_add_u32 s63, s63, s62
s_lshl_b32 s62, s5, 2
s_add_u32 s62, s62, s3
s_mul_i32 s62, s62, 12288
s_lshl_b32 s64, s63, 7
s_add_u32 s62, s62, s64
s_xor_b32 s63, s63, s9
s_cmp_lt_u32 s63, 4
s_cselect_b32 s62, s62, 16777216
v_lshrrev_b32 v14, 3, v1
v_min_u32 v14, 5, v14
v_lshl_add_u32 v14, v14, 11, s62
s_mov_b32 s44, 983040
buffer_load_dword v27, v14, s[20:23], s44 offen
s_mov_b32 s44, 2555904
s_mul_i32 s59, s3, 2080
s_and_b32 s87, s6, 3
s_lshl_b32 s87, s87, 17
v_bfe_u32 v5, v1, 3, 1
v_lshrrev_b32 v2, 4, v1
v_lshl_add_u32 v5, v2, 3, v5
s_lshl_b32 s62, s3, 1
v_add_u32 v5, s62, v5
v_mul_u32_u24 v5, 2048, v5
v_and_b32 v2, 7, v1
v_lshl_add_u32 v5, v2, 4, v5
s_lshl_b32 s62, s7, 7
v_add_u32 v5, s62, v5
v_add_u32 v6, 64512, v5
s_lshl_b32 s62, s6, 10
s_add_u32 s62, s62, 30474240
s_lshl_b32 s64, s8, 10
s_add_u32 s64, s64, 30474240
s_lshr_b32 s67, s9, 1
s_and_b32 s67, s67, 3
s_lshl_b32 s67, s67, 7
s_add_u32 s64, s64, s67
s_lshr_b32 s65, s50, 3
s_lshl_b32 s65, s65, 10
s_add_u32 s65, s65, 30474240
s_lshr_b32 s67, s9, 1
s_and_b32 s67, s67, 3
s_lshl_b32 s67, s67, 7
s_add_u32 s65, s65, s67
v_lshl_add_u32 v252, v1, 7, s62
v_mov_b32 v253, s64
v_mov_b32 v255, 1
v_writelane_b32 v253, s65, 1
s_waitcnt vmcnt(1) lgkmcnt(0)
s_cmp_lg_u32 s3, 1
s_barrier
s_cbranch_scc1 .Lfirst54
s_mov_b64 exec, 15
buffer_atomic_add v255, v252, s[16:19], 0 offen
s_mov_b64 exec, 3
v_mov_b32 v254, 0
buffer_atomic_add v254, v253, s[16:19], 0 offen sc0
s_mov_b64 exec, -1
.Lfirst54:
TR 80,25,49664
TR 82,25,50176
TR 84,25,62080
TR 86,25,62592
TR 88,25,50688
TR 90,25,51200
TR 92,25,63104
TR 94,25,63616
TR 96,25,51712
TR 98,25,52224
TR 100,25,64128
TR 102,25,64640
v_lshrrev_b32 v2, 4, v1
v_lshlrev_b32 v2, 2, v2
v_and_b32 v13, 15, v1
v_sub_u32 v2, v13, v2
v_mov_b32 v13, 0xff61b1e6
v_subrev_u32 v54, 0, v2
v_cmp_gt_u32 vcc, 8, v54
s_nop 1
v_cndmask_b32 v50, v13, 0, vcc
v_cmp_gt_i32 vcc, -8, v54
s_nop 1
v_cndmask_b32 v46, v13, 0, vcc
v_subrev_u32 v54, 1, v2
v_cmp_gt_u32 vcc, 8, v54
s_nop 1
v_cndmask_b32 v51, v13, 0, vcc
v_cmp_gt_i32 vcc, -8, v54
s_nop 1
v_cndmask_b32 v47, v13, 0, vcc
v_subrev_u32 v54, 2, v2
v_cmp_gt_u32 vcc, 8, v54
s_nop 1
v_cndmask_b32 v52, v13, 0, vcc
v_cmp_gt_i32 vcc, -8, v54
s_nop 1
v_cndmask_b32 v48, v13, 0, vcc
v_subrev_u32 v54, 3, v2
v_cmp_gt_u32 vcc, 8, v54
s_nop 1
v_cndmask_b32 v53, v13, 0, vcc
v_cmp_gt_i32 vcc, -8, v54
s_nop 1
v_cndmask_b32 v49, v13, 0, vcc
s_cmp_lt_u32 s8, 2
s_cselect_b64 vcc, -1, 0
v_cndmask_b32 v54, v46, v13, vcc
v_cndmask_b32 v55, v47, v13, vcc
v_cndmask_b32 v56, v48, v13, vcc
v_cndmask_b32 v57, v49, v13, vcc
v_mov_b64 v[60:61], 0
v_mov_b64 v[62:63], 0
v_mov_b64 v[64:65], 0
v_mov_b64 v[66:67], 0
v_mov_b64 v[68:69], 0
v_mov_b64 v[70:71], 0
v_mov_b64 v[72:73], 0
v_mov_b64 v[74:75], 0
v_mov_b64 v[76:77], 0
v_mov_b64 v[78:79], 0
v_mov_b64 v[80:81], 0
v_mov_b64 v[82:83], 0
v_mov_b64 v[84:85], 0
v_mov_b64 v[86:87], 0
v_mov_b64 v[88:89], 0
v_mov_b64 v[90:91], 0
v_mov_b64 v[92:93], 0
v_mov_b64 v[94:95], 0
v_mov_b64 v[96:97], 0
v_mov_b64 v[98:99], 0
v_mov_b64 v[100:101], 0
v_mov_b64 v[102:103], 0
v_mov_b64 v[104:105], 0
v_mov_b64 v[106:107], 0
v_mov_b64 v[108:109], 0
v_mov_b64 v[110:111], 0
v_mov_b64 v[112:113], 0
v_mov_b64 v[114:115], 0
v_mov_b64 v[116:117], 0
v_mov_b64 v[118:119], 0
v_mov_b64 v[120:121], 0
v_mov_b64 v[122:123], 0
v_mov_b64 v[124:125], 0
v_mov_b64 v[126:127], 0
v_mov_b64 v[128:129], 0
v_mov_b64 v[130:131], 0
v_mov_b64 v[132:133], 0
v_mov_b64 v[134:135], 0
v_mov_b64 v[136:137], 0
v_mov_b64 v[138:139], 0
v_mov_b64 v[140:141], 0
v_mov_b64 v[142:143], 0
v_mov_b64 v[144:145], 0
v_mov_b64 v[146:147], 0
v_mov_b64 v[148:149], 0
v_mov_b64 v[150:151], 0
v_mov_b64 v[152:153], 0
v_mov_b64 v[154:155], 0
v_mov_b64 v[156:157], 0
v_mov_b64 v[158:159], 0
v_mov_b64 v[160:161], 0
v_mov_b64 v[162:163], 0
v_mov_b64 v[164:165], 0
v_mov_b64 v[166:167], 0
v_mov_b64 v[168:169], 0
v_mov_b64 v[170:171], 0
v_mov_b64 v[172:173], 0
v_mov_b64 v[174:175], 0
s_mov_b32 s75, 62914560
v_and_b32 v10, 15, v1
v_lshlrev_b32 v12, 2, v10
v_lshlrev_b32 v10, 4, v10
v_add_u32 v10, 152576, v10
v_lshrrev_b32 v11, 4, v1
v_lshlrev_b32 v11, 4, v11
s_lshl_b32 s62, s49, 7
s_add_u32 s62, s62, 158720
v_add_u32 v12, s62, v12
v_add_u32 v13, s62, v11
v_add_u32 v11, 156672, v11
s_lshl_b32 s62, s3, 11
s_add_u32 s62, s62, 143360
v_lshl_add_u32 v8, v1, 4, s62
v_xor_b32 v9, 2048, v8
v_mov_b32 v248, 0x3f803f80
v_mov_b32 v249, 0x3f803f80
v_mov_b32 v250, 0x3f803f80
v_mov_b32 v251, 0x3f803f80
v_and_b32 v7, 31, v1
v_lshrrev_b32 v2, 5, v1
v_lshl_add_u32 v7, v7, 1, v2
v_and_b32 v2, 0xc0, v0
v_add_u32 v7, v7, v2
v_lshlrev_b32 v17, 2, v7
v_add_u32 v17, 156672, v17
v_lshlrev_b32 v7, 4, v7
v_add_u32 v7, 152576, v7
s_lshl_b32 s74, s9, 1
s_add_u32 s74, s74, s49
s_lshl_b32 s74, s74, 17
s_add_u32 s74, s74, s85
s_lshl_b32 s63, s48, 12
s_add_u32 s74, s74, s63
s_add_u32 s74, s74, 37748736
s_mov_b32 s62, 0
v_lshl_add_u32 v4, v1, 4, s62
v_lshrrev_b32 v2, 3, v1
v_cmp_eq_u32 vcc, 3, v2
v_add_u32 v2, 67108480, v4
s_nop 0
v_cndmask_b32 v4, v4, v2, vcc
ds_read_b128 v[28:31], v13
ds_read_b128 v[32:35], v13 offset:64
ds_read_b128 v[36:39], v13 offset:256
ds_read_b128 v[40:43], v13 offset:320
ds_read_b32 v44, v12 offset:512
ds_read_b32 v45, v12 offset:576
s_waitcnt lgkmcnt(0)
s_cmp_lg_u32 s3, 1
s_cbranch_scc1 .Lnopoll53
s_mov_b64 exec, 3
s_mov_b32 s15, 0
.Lpoll52:
v_mov_b32 v255, 0
buffer_atomic_add v255, v253, s[16:19], 0 offen sc0
s_waitcnt vmcnt(1)
v_cmp_gt_u32 vcc, 16, v254
s_add_u32 s15, s15, 1
s_cbranch_vccz .Lnopoll53r
v_mov_b32 v254, 0
buffer_atomic_add v254, v253, s[16:19], 0 offen sc0
s_waitcnt vmcnt(1)
v_cmp_gt_u32 vcc, 16, v255
s_add_u32 s15, s15, 1
s_cbranch_vccz .Lnopoll53r
s_cmp_le_u32 s15, 100000
s_cbranch_scc1 .Lpoll52
s_branch .Lnopoll53r
.Lnopoll53:
s_mov_b64 exec, 0
s_cmp_eq_u32 s3, 2
s_cbranch_scc1 .Lpad12
s_cmp_eq_u32 s3, 3
s_cbranch_scc1 .Lpad13
s_branch .Lpad14
.Lnopoll53r:
s_mov_b64 exec, -1
s_barrier
s_cmp_eq_u32 s48, 1
s_cbranch_scc1 .Lqkv55
s_add_u32 m0, s55, 36864
s_nop 0
buffer_load_dwordx4 v21, s[16:19], s52 offen sc1 lds
buffer_load_dwordx4 v21, s[16:19], s52 offen offset:1024 sc1 lds
buffer_load_dword v22, s[16:19], s52 offen offset:2048 sc1 lds
s_add_u32 s52, s52, 131072
s_add_u32 m0, s55, 46080
s_nop 0
buffer_load_dwordx4 v21, s[16:19], s52 offen sc1 lds
buffer_load_dwordx4 v21, s[16:19], s52 offen offset:1024 sc1 lds
buffer_load_dword v22, s[16:19], s52 offen offset:2048 sc1 lds
s_add_u32 s52, s52, 131072
s_add_u32 m0, s55, 0
s_nop 0
buffer_load_dwordx4 v21, s[16:19], s52 offen sc1 lds
buffer_load_dwordx4 v21, s[16:19], s52 offen offset:1024 sc1 lds
buffer_load_dword v22, s[16:19], s52 offen offset:2048 sc1 lds
s_add_u32 s52, s52, 131072
s_add_u32 m0, s55, 9216
s_nop 0
buffer_load_dwordx4 v21, s[16:19], s52 offen sc1 lds
buffer_load_dwordx4 v21, s[16:19], s52 offen offset:1024 sc1 lds
buffer_load_dword v22, s[16:19], s52 offen offset:2048 sc1 lds
s_add_u32 s52, s52, 131072
s_add_u32 m0, s55, 18432
s_nop 0
buffer_load_dwordx4 v21, s[16:19], s52 offen sc1 lds
buffer_load_dwordx4 v21, s[16:19], s52 offen offset:1024 sc1 lds
buffer_load_dword v22, s[16:19], s52 offen offset:2048 sc1 lds
s_add_u32 s52, s52, 131072
s_add_u32 m0, s55, 27648
s_nop 0
buffer_load_dwordx4 v21, s[16:19], s52 offen sc1 lds
buffer_load_dwordx4 v21, s[16:19], s52 offen offset:1024 sc1 lds
buffer_load_dword v22, s[16:19], s52 offen offset:2048 sc1 lds
s_add_u32 s52, s52, 131072
s_waitcnt vmcnt(12)
s_barrier
RD 0,23,36864
RD 4,23,37888
RD 8,23,39168
RD 12,23,40192
RD 16,24,38912
RD 20,23,46080
RD 24,23,47104
RD 28,23,48384
RD 32,23,49408
RD 36,24,48128
s_waitcnt lgkmcnt(0)
s_mov_b32 s15, -2
.p2align 6
.Lk57:
s_waitcnt vmcnt(9) lgkmcnt(8)
s_barrier
MAA 60,80,0
TR 104,25,49696
s_add_u32 m0, s56, 104832
MAA 60,84,20
buffer_load_dwordx4 v18, s[20:23], s54 offen lds
MAA 64,84,24
TR 106,25,50208
v_add_f32 v164, v164, v168
MAA 64,80,4
TR 108,25,62112
MAA 68,80,8
TR 110,25,62624
MAA 68,84,28
buffer_load_dwordx4 v19, s[20:23], s54 offen offset:1024 lds
MAA 72,84,32
TR 112,25,50720
v_add_f32 v165, v165, v169
MAA 72,80,12
TR 114,25,51232
s_waitcnt lgkmcnt(6)
MAA 156,88,16
TR 116,25,63136
MAA 156,92,36
buffer_load_dwordx4 v20, s[20:23], s54 offen offset:2048 lds
MAA 104,92,32
s_add_u32 s54, s54, 196608
s_add_u32 m0, s55, 36864
MAA 104,88,12
buffer_load_dwordx4 v21, s[16:19], s52 offen sc1 lds
MAA 100,88,8
TR 118,25,63648
MAA 100,92,28
TR 120,25,51744
v_add_f32 v166, v166, v170
MAA 96,92,24
TR 122,25,52256
MAA 96,88,4
buffer_load_dwordx4 v21, s[16:19], s52 offen offset:1024 sc1 lds
MAA 92,88,0
TR 124,25,64160
MAA 92,92,20
TR 126,25,64672
v_add_f32 v167, v167, v171
MAA 124,20,100
ds_read_b128 a[40:43], v23
MAA 124,0,96
buffer_load_dword v22, s[16:19], s52 offen offset:2048 sc1 lds
MAA 128,4,96
RD 44,23,1024
s_add_u32 s52, s52, 131072
MAA 128,24,100
buffer_load_dword v27, v14, s[20:23], s44 offen
MAA 132,28,100
RD 48,23,2304
s_add_u32 s44, s44, 1572864
MAA 132,8,96
RD 52,23,3328
MAA 136,12,96
RD 56,24,2048
MAA 136,32,100
s_waitcnt vmcnt(13) lgkmcnt(5)
s_barrier
MAA 76,104,0
RD 60,23,9216
s_add_u32 m0, s56, 117248
MAA 76,108,20
buffer_load_dwordx4 v18, s[20:23], s54 offen lds
MAA 80,108,24
RD 64,23,10240
MAA 80,104,4
RD 68,23,11520
MAA 84,104,8
RD 72,23,12544
MAA 84,108,28
buffer_load_dwordx4 v19, s[20:23], s54 offen offset:1024 lds
MAA 88,108,32
RD 76,24,11264
MAA 88,104,12
buffer_load_dwordx4 v20, s[20:23], s54 offen offset:2048 lds
MAA 160,112,16
ds_read_b64_tr_b16 a[80:81], v25
s_add_u32 s54, s54, 196608
MAA 160,116,36
TR 82,25,512
MAA 120,116,32
TR 84,25,12416
s_add_u32 m0, s55, 46080
MAA 120,112,12
buffer_load_dwordx4 v21, s[16:19], s52 offen sc1 lds
MAA 116,112,8
TR 86,25,12928
MAA 116,116,28
TR 88,25,1024
MAA 112,116,24
TR 90,25,1536
MAA 112,112,4
buffer_load_dwordx4 v21, s[16:19], s52 offen offset:1024 sc1 lds
MAA 108,112,0
TR 92,25,13440
.Lpad12:
s_cbranch_execz .Lpad15
MAA 108,116,20
TR 94,25,13952
MAA 140,20,124
TR 96,25,2048
MAA 140,0,120
buffer_load_dword v22, s[16:19], s52 offen offset:2048 sc1 lds
MAA 144,4,120
TR 98,25,2560
s_add_u32 s52, s52, 131072
MAA 144,24,124
buffer_load_dwordx4 v[168:171], v26, s[16:19], s75 offen sc1
MAA 148,28,124
TR 100,25,14464
MAA 148,8,120
TR 102,25,14976
MAA 152,12,120
MAA 152,32,124
s_waitcnt vmcnt(17) lgkmcnt(8)
s_barrier
MAA 60,80,40
TR 104,25,32
s_add_u32 m0, s56, 129664
MAA 60,84,60
buffer_load_dwordx4 v18, s[20:23], s54 offen lds
MAA 64,84,64
TR 106,25,544
v_add_f32 v164, v164, v172
MAA 64,80,44
TR 108,25,12448
MAA 68,80,48
TR 110,25,12960
MAA 68,84,68
buffer_load_dwordx4 v19, s[20:23], s54 offen offset:1024 lds
MAA 72,84,72
TR 112,25,1056
MAA 72,80,52
TR 114,25,1568
s_waitcnt lgkmcnt(6)
MAA 156,88,56
TR 116,25,13472
v_add_f32 v165, v165, v173
MAA 156,92,76
buffer_load_dwordx4 v20, s[20:23], s54 offen offset:2048 lds
MAA 104,92,72
TR 118,25,13984
s_add_u32 s54, s54, 196608
MAA 104,88,52
TR 120,25,2080
MAA 100,88,48
s_add_u32 m0, s55, 0
MAA 100,92,68
buffer_load_dwordx4 v21, s[16:19], s52 offen sc1 lds
MAA 96,92,64
TR 122,25,2592
v_add_f32 v166, v166, v174
MAA 96,88,44
TR 124,25,14496
MAA 92,88,40
TR 126,25,15008
MAA 92,92,60
buffer_load_dwordx4 v21, s[16:19], s52 offen offset:1024 sc1 lds
MAA 124,60,100
RD 0,23,18432
MAA 124,40,96
RD 4,23,19456
v_add_f32 v167, v167, v175
MAA 128,44,96
RD 8,23,20736
MAA 128,64,100
buffer_load_dword v22, s[16:19], s52 offen offset:2048 sc1 lds
MAA 132,68,100
RD 12,23,21760
s_add_u32 s52, s52, 131072
MAA 132,48,96
RD 16,24,20480
MAA 136,52,96
MAA 136,72,100
s_waitcnt vmcnt(17) lgkmcnt(5)
s_barrier
MAA 76,104,40
RD 20,23,27648
s_add_u32 m0, s56, 67584
MAA 76,108,60
buffer_load_dwordx4 v18, s[20:23], s54 offen lds
MAA 80,108,64
RD 24,23,28672
MAA 80,104,44
RD 28,23,29952
MAA 84,104,48
RD 32,23,30976
MAA 84,108,68
buffer_load_dwordx4 v19, s[20:23], s54 offen offset:1024 lds
MAA 88,108,72
RD 36,24,29696
MAA 88,104,52
buffer_load_dwordx4 v20, s[20:23], s54 offen offset:2048 lds
MAA 160,112,56
TR 80,25,24832
s_add_u32 s54, s54, 196608
MAA 160,116,76
TR 82,25,25344
MAA 120,116,72
TR 84,25,37248
s_add_u32 m0, s55, 9216
MAA 120,112,52
buffer_load_dwordx4 v21, s[16:19], s52 offen sc1 lds
MAA 116,112,48
TR 86,25,37760
MAA 116,116,68
TR 88,25,25856
MAA 112,116,64
TR 90,25,26368
MAA 112,112,44
buffer_load_dwordx4 v21, s[16:19], s52 offen offset:1024 sc1 lds
MAA 108,112,40
TR 92,25,38272
MAA 108,116,60
TR 94,25,38784
MAA 140,60,124
TR 96,25,26880
MAA 140,40,120
buffer_load_dword v22, s[16:19], s52 offen offset:2048 sc1 lds
MAA 144,44,120
TR 98,25,27392
s_add_u32 s52, s52, 131072
MAA 144,64,124
buffer_load_dwordx4 v[172:175], v26, s[16:19], s75 offen offset:1024 sc1
MAA 148,68,124
TR 100,25,39296
s_add_u32 s75, s75, 2048
MAA 148,48,120
TR 102,25,39808
MAA 152,52,120
MAA 152,72,124
s_waitcnt vmcnt(21) lgkmcnt(8)
s_barrier
MAA 60,80,0
TR 104,25,24864
s_add_u32 m0, s56, 80000
MAA 60,84,20
buffer_load_dwordx4 v18, s[20:23], s54 offen lds
MAA 64,84,24
TR 106,25,25376
MAA 64,80,4
TR 108,25,37280
MAA 68,80,8
TR 110,25,37792
MAA 68,84,28
buffer_load_dwordx4 v19, s[20:23], s54 offen offset:1024 lds
MAA 72,84,32
TR 112,25,25888
MAA 72,80,12
TR 114,25,26400
s_waitcnt lgkmcnt(6)
MAA 156,88,16
TR 116,25,38304
MAA 156,92,36
buffer_load_dwordx4 v20, s[20:23], s54 offen offset:2048 lds
MAA 104,92,32
TR 118,25,38816
s_add_u32 s54, s54, 196608
MAA 104,88,12
TR 120,25,26912
MAA 100,88,8
s_add_u32 m0, s55, 18432
MAA 100,92,28
buffer_load_dwordx4 v21, s[16:19], s52 offen sc1 lds
MAA 96,92,24
TR 122,25,27424
MAA 96,88,4
TR 124,25,39328
MAA 92,88,0
TR 126,25,39840
MAA 92,92,20
buffer_load_dwordx4 v21, s[16:19], s52 offen offset:1024 sc1 lds
MAA 124,20,100
RD 40,23,36864
MAA 124,0,96
RD 44,23,37888
MAA 128,4,96
RD 48,23,39168
MAA 128,24,100
buffer_load_dword v22, s[16:19], s52 offen offset:2048 sc1 lds
MAA 132,28,100
RD 52,23,40192
s_add_u32 s52, s52, 131072
MAA 132,8,96
RD 56,24,38912
MAA 136,12,96
MAA 136,32,100
s_waitcnt vmcnt(16) lgkmcnt(5)
s_barrier
MAA 76,104,0
RD 60,23,46080
s_add_u32 m0, s56, 92416
MAA 76,108,20
buffer_load_dwordx4 v18, s[20:23], s54 offen lds
MAA 80,108,24
RD 64,23,47104
MAA 80,104,4
RD 68,23,48384
MAA 84,104,8
RD 72,23,49408
MAA 84,108,28
buffer_load_dwordx4 v19, s[20:23], s54 offen offset:1024 lds
MAA 88,108,32
RD 76,24,48128
MAA 88,104,12
TR 80,25,49664
MAA 160,112,16
TR 82,25,50176
MAA 160,116,36
buffer_load_dwordx4 v20, s[20:23], s54 offen offset:2048 lds
MAA 120,116,32
TR 84,25,62080
s_add_u32 s54, s54, 196608
MAA 120,112,12
TR 86,25,62592
MAA 116,112,8
s_add_u32 m0, s55, 27648
MAA 116,116,28
buffer_load_dwordx4 v21, s[16:19], s52 offen sc1 lds
MAA 112,116,24
TR 88,25,50688
MAA 112,112,4
TR 90,25,51200
MAA 108,112,0
TR 92,25,63104
MAA 108,116,20
buffer_load_dwordx4 v21, s[16:19], s52 offen offset:1024 sc1 lds
MAA 140,20,124
TR 94,25,63616
MAA 140,0,120
TR 96,25,51712
MAA 144,4,120
TR 98,25,52224
MAA 144,24,124
buffer_load_dword v22, s[16:19], s52 offen offset:2048 sc1 lds
MAA 148,28,124
TR 100,25,64128
s_add_u32 s52, s52, 131072
MAA 148,8,120
TR 102,25,64640
MAA 152,12,120
MAA 152,32,124
s_waitcnt vmcnt(19) lgkmcnt(8)
s_barrier
MAA 60,80,40
TR 104,25,49696
s_add_u32 m0, s56, 104832
MAA 60,84,60
buffer_load_dwordx4 v18, s[20:23], s54 offen lds
MAA 64,84,64
TR 106,25,50208
v_add_f32 v164, v164, v168
MAA 64,80,44
TR 108,25,62112
MAA 68,80,48
TR 110,25,62624
MAA 68,84,68
buffer_load_dwordx4 v19, s[20:23], s54 offen offset:1024 lds
MAA 72,84,72
TR 112,25,50720
v_add_f32 v165, v165, v169
MAA 72,80,52
TR 114,25,51232
s_waitcnt lgkmcnt(6)
MAA 156,88,56
TR 116,25,63136
MAA 156,92,76
buffer_load_dwordx4 v20, s[20:23], s54 offen offset:2048 lds
MAA 104,92,72
s_add_u32 s54, s54, 196608
s_add_u32 m0, s55, 36864
MAA 104,88,52
buffer_load_dwordx4 v21, s[16:19], s52 offen sc1 lds
MAA 100,88,48
TR 118,25,63648
MAA 100,92,68
TR 120,25,51744
v_add_f32 v166, v166, v170
MAA 96,92,64
TR 122,25,52256
MAA 96,88,44
buffer_load_dwordx4 v21, s[16:19], s52 offen offset:1024 sc1 lds
MAA 92,88,40
TR 124,25,64160
MAA 92,92,60
TR 126,25,64672
v_add_f32 v167, v167, v171
MAA 124,60,100
ds_read_b128 a[0:3], v23
MAA 124,40,96
buffer_load_dword v22, s[16:19], s52 offen offset:2048 sc1 lds
MAA 128,44,96
RD 4,23,1024
s_add_u32 s52, s52, 131072
MAA 128,64,100
buffer_load_dword v27, v14, s[20:23], s44 offen
MAA 132,68,100
RD 8,23,2304
s_add_u32 s44, s44, 1572864
MAA 132,48,96
RD 12,23,3328
MAA 136,52,96
RD 16,24,2048
MAA 136,72,100
s_waitcnt vmcnt(16) lgkmcnt(5)
s_barrier
MAA 76,104,40
RD 20,23,9216
s_add_u32 m0, s56, 117248
MAA 76,108,60
buffer_load_dwordx4 v18, s[20:23], s54 offen lds
MAA 80,108,64
RD 24,23,10240
MAA 80,104,44
RD 28,23,11520
MAA 84,104,48
RD 32,23,12544
MAA 84,108,68
buffer_load_dwordx4 v19, s[20:23], s54 offen offset:1024 lds
MAA 88,108,72
RD 36,24,11264
MAA 88,104,52
buffer_load_dwordx4 v20, s[20:23], s54 offen offset:2048 lds
MAA 160,112,56
ds_read_b64_tr_b16 a[80:81], v25
s_add_u32 s54, s54, 196608
MAA 160,116,76
TR 82,25,512
MAA 120,116,72
TR 84,25,12416
s_add_u32 m0, s55, 46080
MAA 120,112,52
buffer_load_dwordx4 v21, s[16:19], s52 offen sc1 lds
MAA 116,112,48
TR 86,25,12928
MAA 116,116,68
TR 88,25,1024
MAA 112,116,64
TR 90,25,1536
MAA 112,112,44
buffer_load_dwordx4 v21, s[16:19], s52 offen offset:1024 sc1 lds
MAA 108,112,40
TR 92,25,13440
MAA 108,116,60
TR 94,25,13952
MAA 140,60,124
TR 96,25,2048
MAA 140,40,120
buffer_load_dword v22, s[16:19], s52 offen offset:2048 sc1 lds
MAA 144,44,120
TR 98,25,2560
s_add_u32 s52, s52, 131072
MAA 144,64,124
buffer_load_dwordx4 v[168:171], v26, s[16:19], s75 offen sc1
MAA 148,68,124
TR 100,25,14464
MAA 148,48,120
TR 102,25,14976
MAA 152,52,120
MAA 152,72,124
s_waitcnt vmcnt(20) lgkmcnt(8)
s_barrier
MAA 60,80,0
TR 104,25,32
s_add_u32 m0, s56, 129664
MAA 60,84,20
buffer_load_dwordx4 v18, s[20:23], s54 offen lds
MAA 64,84,24
TR 106,25,544
v_add_f32 v164, v164, v172
MAA 64,80,4
TR 108,25,12448
MAA 68,80,8
TR 110,25,12960
MAA 68,84,28
buffer_load_dwordx4 v19, s[20:23], s54 offen offset:1024 lds
MAA 72,84,32
TR 112,25,1056
MAA 72,80,12
TR 114,25,1568
s_waitcnt lgkmcnt(6)
MAA 156,88,16
TR 116,25,13472
v_add_f32 v165, v165, v173
MAA 156,92,36
buffer_load_dwordx4 v20, s[20:23], s54 offen offset:2048 lds
MAA 104,92,32
TR 118,25,13984
s_add_u32 s54, s54, 196608
MAA 104,88,12
TR 120,25,2080
MAA 100,88,8
s_add_u32 m0, s55, 0
MAA 100,92,28
buffer_load_dwordx4 v21, s[16:19], s52 offen sc1 lds
MAA 96,92,24
TR 122,25,2592
v_add_f32 v166, v166, v174
MAA 96,88,4
TR 124,25,14496
MAA 92,88,0
TR 126,25,15008
MAA 92,92,20
buffer_load_dwordx4 v21, s[16:19], s52 offen offset:1024 sc1 lds
MAA 124,20,100
RD 40,23,18432
MAA 124,0,96
RD 44,23,19456
v_add_f32 v167, v167, v175
MAA 128,4,96
RD 48,23,20736
MAA 128,24,100
buffer_load_dword v22, s[16:19], s52 offen offset:2048 sc1 lds
MAA 132,28,100
RD 52,23,21760
s_add_u32 s52, s52, 131072
MAA 132,8,96
RD 56,24,20480
MAA 136,12,96
MAA 136,32,100
s_waitcnt vmcnt(17) lgkmcnt(5)
s_barrier
MAA 76,104,0
RD 60,23,27648
s_add_u32 m0, s56, 67584
MAA 76,108,20
buffer_load_dwordx4 v18, s[20:23], s54 offen lds
MAA 80,108,24
RD 64,23,28672
MAA 80,104,4
RD 68,23,29952
MAA 84,104,8
RD 72,23,30976
MAA 84,108,28
buffer_load_dwordx4 v19, s[20:23], s54 offen offset:1024 lds
MAA 88,108,32
RD 76,24,29696
MAA 88,104,12
buffer_load_dwordx4 v20, s[20:23], s54 offen offset:2048 lds
MAA 160,112,16
TR 80,25,24832
s_add_u32 s54, s54, 196608
MAA 160,116,36
TR 82,25,25344
MAA 120,116,32
TR 84,25,37248
s_add_u32 m0, s55, 9216
MAA 120,112,12
buffer_load_dwordx4 v21, s[16:19], s52 offen sc1 lds
MAA 116,112,8
TR 86,25,37760
MAA 116,116,28
TR 88,25,25856
MAA 112,116,24
TR 90,25,26368
MAA 112,112,4
buffer_load_dwordx4 v21, s[16:19], s52 offen offset:1024 sc1 lds
MAA 108,112,0
TR 92,25,38272
MAA 108,116,20
TR 94,25,38784
MAA 140,20,124
TR 96,25,26880
MAA 140,0,120
buffer_load_dword v22, s[16:19], s52 offen offset:2048 sc1 lds
MAA 144,4,120
TR 98,25,27392
s_add_u32 s52, s52, 131072
MAA 144,24,124
buffer_load_dwordx4 v[172:175], v26, s[16:19], s75 offen offset:1024 sc1
MAA 148,28,124
TR 100,25,39296
s_add_u32 s75, s75, 2048
MAA 148,8,120
TR 102,25,39808
MAA 152,12,120
MAA 152,32,124
s_waitcnt vmcnt(21) lgkmcnt(8)
s_barrier
MAA 60,80,40
TR 104,25,24864
s_add_u32 m0, s56, 80000
MAA 60,84,60
buffer_load_dwordx4 v18, s[20:23], s54 offen lds
MAA 64,84,64
TR 106,25,25376
MAA 64,80,44
TR 108,25,37280
MAA 68,80,48
TR 110,25,37792
MAA 68,84,68
buffer_load_dwordx4 v19, s[20:23], s54 offen offset:1024 lds
MAA 72,84,72
TR 112,25,25888
MAA 72,80,52
TR 114,25,26400
s_waitcnt lgkmcnt(6)
MAA 156,88,56
TR 116,25,38304
MAA 156,92,76
buffer_load_dwordx4 v20, s[20:23], s54 offen offset:2048 lds
MAA 104,92,72
TR 118,25,38816
s_add_u32 s54, s54, 196608
MAA 104,88,52
TR 120,25,26912
MAA 100,88,48
s_add_u32 m0, s55, 18432
MAA 100,92,68
buffer_load_dwordx4 v21, s[16:19], s52 offen sc1 lds
MAA 96,92,64
TR 122,25,27424
MAA 96,88,44
TR 124,25,39328
MAA 92,88,40
TR 126,25,39840
MAA 92,92,60
buffer_load_dwordx4 v21, s[16:19], s52 offen offset:1024 sc1 lds
MAA 124,60,100
RD 0,23,36864
MAA 124,40,96
RD 4,23,37888
MAA 128,44,96
RD 8,23,39168
MAA 128,64,100
buffer_load_dword v22, s[16:19], s52 offen offset:2048 sc1 lds
MAA 132,68,100
.Lpad13:
s_cbranch_execz .Lpad16
RD 12,23,40192
s_add_u32 s52, s52, 131072
MAA 132,48,96
RD 16,24,38912
MAA 136,52,96
MAA 136,72,100
s_waitcnt vmcnt(16) lgkmcnt(5)
s_barrier
MAA 76,104,40
RD 20,23,46080
s_add_u32 m0, s56, 92416
MAA 76,108,60
buffer_load_dwordx4 v18, s[20:23], s54 offen lds
MAA 80,108,64
RD 24,23,47104
MAA 80,104,44
RD 28,23,48384
MAA 84,104,48
RD 32,23,49408
MAA 84,108,68
buffer_load_dwordx4 v19, s[20:23], s54 offen offset:1024 lds
MAA 88,108,72
RD 36,24,48128
MAA 88,104,52
TR 80,25,49664
MAA 160,112,56
TR 82,25,50176
MAA 160,116,76
buffer_load_dwordx4 v20, s[20:23], s54 offen offset:2048 lds
MAA 120,116,72
TR 84,25,62080
s_add_u32 s54, s54, 196608
MAA 120,112,52
TR 86,25,62592
MAA 116,112,48
s_add_u32 m0, s55, 27648
MAA 116,116,68
buffer_load_dwordx4 v21, s[16:19], s52 offen sc1 lds
MAA 112,116,64
TR 88,25,50688
MAA 112,112,44
TR 90,25,51200
MAA 108,112,40
TR 92,25,63104
MAA 108,116,60
buffer_load_dwordx4 v21, s[16:19], s52 offen offset:1024 sc1 lds
MAA 140,60,124
TR 94,25,63616
MAA 140,40,120
TR 96,25,51712
MAA 144,44,120
TR 98,25,52224
MAA 144,64,124
buffer_load_dword v22, s[16:19], s52 offen offset:2048 sc1 lds
MAA 148,68,124
TR 100,25,64128
s_add_u32 s52, s52, 131072
MAA 148,48,120
TR 102,25,64640
MAA 152,52,120
s_add_u32 s15, s15, 1
MAA 152,72,124
s_cbranch_scc0 .Lk57
s_waitcnt vmcnt(19) lgkmcnt(8)
s_barrier
MAA 60,80,0
TR 104,25,49696
s_add_u32 m0, s56, 104832
MAA 60,84,20
buffer_load_dwordx4 v18, s[20:23], s54 offen lds
MAA 64,84,24
TR 106,25,50208
v_add_f32 v164, v164, v168
MAA 64,80,4
TR 108,25,62112
v_add_f32 v165, v165, v169
MAA 68,80,8
TR 110,25,62624
v_add_f32 v166, v166, v170
MAA 68,84,28
buffer_load_dwordx4 v19, s[20:23], s54 offen offset:1024 lds
MAA 72,84,32
TR 112,25,50720
v_add_f32 v167, v167, v171
MAA 72,80,12
TR 114,25,51232
s_waitcnt lgkmcnt(6)
MAA 156,88,16
TR 116,25,63136
MAA 156,92,36
buffer_load_dwordx4 v20, s[20:23], s54 offen offset:2048 lds
MAA 104,92,32
TR 118,25,63648
s_add_u32 s54, s54, 196608
MAA 104,88,12
TR 120,25,51744
s_add_u32 m0, s55, 36864
MAA 100,88,8
TR 122,25,52256
MAA 100,92,28
buffer_load_dwordx4 v21, s[16:19], s52 offen sc1 lds
MAA 96,92,24
TR 124,25,64160
MAA 96,88,4
TR 126,25,64672
MAA 92,88,0
ds_read_b128 a[40:43], v23
MAA 92,92,20
buffer_load_dwordx4 v21, s[16:19], s52 offen offset:1024 sc1 lds
MAA 124,20,100
RD 44,23,1024
MAA 124,0,96
RD 48,23,2304
MAA 128,4,96
RD 52,23,3328
MAA 128,24,100
buffer_load_dword v22, s[16:19], s52 offen offset:2048 sc1 lds
MAA 132,28,100
RD 56,24,2048
s_add_u32 s52, s52, 131072
MAA 132,8,96
MAA 136,12,96
MAA 136,32,100
s_waitcnt vmcnt(15) lgkmcnt(5)
s_barrier
MAA 76,104,0
RD 60,23,9216
s_add_u32 m0, s56, 117248
MAA 76,108,20
buffer_load_dwordx4 v18, s[20:23], s54 offen lds
MAA 80,108,24
RD 64,23,10240
v_add_f32 v164, v164, v172
MAA 80,104,4
RD 68,23,11520
v_add_f32 v165, v165, v173
MAA 84,104,8
RD 72,23,12544
v_add_f32 v166, v166, v174
MAA 84,108,28
buffer_load_dwordx4 v19, s[20:23], s54 offen offset:1024 lds
MAA 88,108,32
RD 76,24,11264
v_add_f32 v167, v167, v175
MAA 88,104,12
ds_read_b64_tr_b16 a[80:81], v25
MAA 160,112,16
TR 82,25,512
MAA 160,116,36
buffer_load_dwordx4 v20, s[20:23], s54 offen offset:2048 lds
MAA 120,116,32
TR 84,25,12416
s_add_u32 s54, s54, 196608
MAA 120,112,12
TR 86,25,12928
s_add_u32 m0, s55, 46080
MAA 116,112,8
TR 88,25,1024
MAA 116,116,28
buffer_load_dwordx4 v21, s[16:19], s52 offen sc1 lds
MAA 112,116,24
TR 90,25,1536
MAA 112,112,4
TR 92,25,13440
MAA 108,112,0
TR 94,25,13952
MAA 108,116,20
buffer_load_dwordx4 v21, s[16:19], s52 offen offset:1024 sc1 lds
MAA 140,20,124
TR 96,25,2048
MAA 140,0,120
TR 98,25,2560
MAA 144,4,120
TR 100,25,14464
MAA 144,24,124
buffer_load_dword v22, s[16:19], s52 offen offset:2048 sc1 lds
MAA 148,28,124
TR 102,25,14976
s_add_u32 s52, s52, 131072
MAA 148,8,120
v_permlane32_swap_b32 v164, v166
MAA 152,12,120
v_permlane32_swap_b32 v165, v167
MAA 152,32,124
s_waitcnt vmcnt(18) lgkmcnt(8)
s_barrier
MAA 60,80,40
TR 104,25,32
s_add_u32 m0, s56, 129664
MAA 60,84,60
buffer_load_dwordx4 v18, s[20:23], s54 offen lds
MAA 64,84,64
TR 106,25,544
v_add_f32 v164, v164, v166
MAA 64,80,44
TR 108,25,12448
v_add_f32 v165, v165, v167
MAA 68,80,48
buffer_load_dwordx4 v19, s[20:23], s54 offen offset:1024 lds
MAA 68,84,68
TR 110,25,12960
v_mul_f32 v164, 0xba800000, v164
MAA 72,84,72
TR 112,25,1056
v_mul_f32 v165, 0x3a800000, v165
MAA 72,80,52
buffer_load_dwordx4 v20, s[20:23], s54 offen offset:2048 lds
s_waitcnt lgkmcnt(5)
MAA 156,88,56
TR 114,25,1568
s_add_u32 s54, s54, 196608
MAA 156,92,76
TR 116,25,13472
s_add_u32 m0, s59, 58240
MAA 104,92,72
TR 118,25,13984
s_xor_b32 s58, s87, 1966080
MAA 104,88,52
buffer_load_dwordx4 v5, s[24:27], s58 offen lds
MAA 100,88,48
TR 120,25,2080
v_fma_f32 v165, -v164, v164, v165
MAA 100,92,68
TR 122,25,2592
v_max_f32 v165, 0, v165
MAA 96,92,64
buffer_load_dwordx4 v6, s[24:27], s58 offen offset:1024 lds
MAA 96,88,44
TR 124,25,14496
s_add_u32 m0, s59, 0
MAA 92,88,40
TR 126,25,15008
s_xor_b32 s58, s87, 1048576
MAA 92,92,60
buffer_load_dwordx4 v5, s[24:27], s58 offen lds
MAA 124,60,100
RD 0,23,18432
v_add_f32 v165, 0x3727c5ac, v165
MAA 124,40,96
RD 4,23,19456
MAA 128,44,96
buffer_load_dwordx4 v6, s[24:27], s58 offen offset:1024 lds
MAA 128,64,100
RD 8,23,20736
MAA 132,68,100
RD 12,23,21760
MAA 132,48,96
RD 16,24,20480
MAA 136,52,96
v_rsq_f32 v166, v165
MAA 136,72,100
v_mov_b32 v165, v166
v_mul_f32 v166, 0x3e8293ee, v166
ds_write_b128 v7, v[164:167]
s_waitcnt vmcnt(16) lgkmcnt(6)
s_barrier
MAA 76,104,40
ds_write_b32 v17, v164
s_add_u32 m0, s59, 8320
MAA 76,108,60
ds_write_b32 v17, v165 offset:1024
s_xor_b32 s58, s87, 1179648
MAA 80,108,64
buffer_load_dwordx4 v5, s[24:27], s58 offen lds
MAA 80,104,44
RD 20,23,27648
MAA 84,104,48
RD 24,23,28672
MAA 84,108,68
RD 28,23,29952
MAA 88,108,72
buffer_load_dwordx4 v6, s[24:27], s58 offen offset:1024 lds
MAA 88,104,52
RD 32,23,30976
s_add_u32 m0, s59, 66560
MAA 160,112,56
RD 36,24,29696
s_xor_b32 s58, s87, 0
MAA 160,116,76
TR 80,25,24832
MAA 120,116,72
buffer_load_dwordx4 v5, s[24:27], s58 offen lds
MAA 120,112,52
TR 82,25,25344
MAA 116,112,48
TR 84,25,37248
MAA 116,116,68
TR 86,25,37760
MAA 112,116,64
buffer_load_dwordx4 v6, s[24:27], s58 offen offset:1024 lds
MAA 112,112,44
TR 88,25,25856
s_add_u32 m0, s59, 74880
MAA 108,112,40
TR 90,25,26368
s_xor_b32 s58, s87, 131072
MAA 108,116,60
TR 92,25,38272
MAA 140,60,124
buffer_load_dwordx4 v5, s[24:27], s58 offen lds
MAA 140,40,120
TR 94,25,38784
MAA 144,44,120
TR 96,25,26880
MAA 144,64,124
TR 98,25,27392
MAA 148,68,124
buffer_load_dwordx4 v6, s[24:27], s58 offen offset:1024 lds
MAA 148,48,120
TR 100,25,39296
MAA 152,52,120
TR 102,25,39808
MAA 152,72,124
s_waitcnt vmcnt(10) lgkmcnt(0)
s_barrier
MAA 156,88,16
TR 112,25,25888
s_add_u32 m0, s59, 83200
MAA 156,92,36
TR 114,25,26400
s_xor_b32 s58, s87, 262144
MAA 104,92,32
buffer_load_dwordx4 v5, s[24:27], s58 offen lds
MAA 104,88,12
TR 116,25,38304
MAA 100,88,8
TR 118,25,38816
MAA 100,92,28
TR 120,25,26912
MAA 96,92,24
buffer_load_dwordx4 v6, s[24:27], s58 offen offset:1024 lds
MAA 96,88,4
TR 122,25,27424
s_add_u32 m0, s59, 16640
MAA 92,88,0
TR 124,25,39328
s_xor_b32 s58, s87, 1310720
MAA 92,92,20
TR 126,25,39840
MAA 136,32,100
buffer_load_dwordx4 v5, s[24:27], s58 offen lds
MAA 136,12,96
TR 104,25,24864
MAA 72,80,12
TR 106,25,25376
MAA 72,84,32
TR 108,25,37280
MAA 68,84,28
buffer_load_dwordx4 v6, s[24:27], s58 offen offset:1024 lds
MAA 68,80,8
TR 110,25,37792
s_add_u32 m0, s59, 24960
MAA 64,80,4
RD 40,23,36864
s_xor_b32 s58, s87, 1441792
MAA 64,84,24
RD 44,23,37888
MAA 60,84,20
buffer_load_dwordx4 v5, s[24:27], s58 offen lds
MAA 60,80,0
RD 48,23,39168
s_waitcnt lgkmcnt(13)
MAA 160,112,16
RD 52,23,40192
s_waitcnt lgkmcnt(12)
MAA 160,116,36
RD 56,24,38912
MAA 120,116,32
buffer_load_dwordx4 v6, s[24:27], s58 offen offset:1024 lds
MAA 120,112,12
s_waitcnt lgkmcnt(5)
s_barrier
RD 60,23,46080
MAA 116,112,8
RD 64,23,47104
s_add_u32 m0, s59, 91520
MAA 116,116,28
RD 68,23,48384
s_xor_b32 s58, s87, 393216
MAA 112,116,24
RD 72,23,49408
MAA 112,112,4
RD 76,24,48128
MAA 108,112,0
TR 144,25,50688
MAA 108,116,20
TR 146,25,51200
MAA 152,32,124
TR 148,25,63104
MAA 152,12,120
TR 150,25,63616
MAA 88,104,12
TR 152,25,50720
MAA 88,108,32
TR 154,25,51232
MAA 84,108,28
TR 156,25,63136
MAA 84,104,8
TR 158,25,63648
MAA 80,104,4
TR 160,25,51712
MAA 80,108,24
TR 162,25,52224
MAA 76,108,20
TR 164,25,64128
MAA 76,104,0
TR 166,25,64640
s_waitcnt lgkmcnt(10)
MAA 156,144,56
TR 168,25,51744
s_waitcnt lgkmcnt(9)
MAA 156,148,76
TR 170,25,52256
MAA 104,148,72
TR 172,25,64160
MAA 104,144,52
TR 174,25,64672
MAA 100,144,48
TR 128,25,49664
MAA 100,148,68
TR 130,25,50176
MAA 96,148,64
TR 132,25,62080
MAA 96,144,44
TR 134,25,62592
MAA 92,144,40
TR 136,25,49696
MAA 92,148,60
TR 138,25,50208
s_waitcnt lgkmcnt(14)
MAA 160,156,76
TR 140,25,62112
MAA 160,152,56
TR 142,25,62624
MAA 120,152,52
ds_read_b128 v[232:235], v10 offset:768
MAA 120,156,72
ds_read_b128 v[236:239], v10 offset:2816
MAA 116,156,68
ds_read_b128 v[228:231], v10 offset:512
MAA 116,152,48
ds_read_b128 v[224:227], v10 offset:256
MAA 112,152,44
ds_read_b128 v[220:223], v10
MAA 112,156,64
buffer_load_dwordx4 v5, s[24:27], s58 offen lds
MAA 108,156,60
ds_read_b128 v[240:243], v11 offset:192
MAA 108,152,40
s_waitcnt lgkmcnt(6)
s_barrier
ds_read_b128 v[244:247], v11 offset:1216
MAA 136,52,160
ds_read_b128 v[18:21], v11 offset:128
MAA 136,72,164
buffer_load_dwordx4 v6, s[24:27], s58 offen offset:1024 lds
MAA 152,72,172
ds_read_b128 v[22:25], v11 offset:1152
s_add_u32 m0, s59, 99840
MAA 152,52,168
s_xor_b32 s58, s87, 524288
MAA 72,128,52
MAA 72,132,72
buffer_load_dwordx4 v5, s[24:27], s58 offen lds
MAA 68,132,68
MAA 68,128,48
MAA 64,128,44
MAA 64,132,64
buffer_load_dwordx4 v6, s[24:27], s58 offen offset:1024 lds
MAA 60,132,60
s_add_u32 m0, s59, 108160
s_xor_b32 s58, s87, 655360
MAA 60,128,40
MAA 88,136,52
MAA 88,140,72
buffer_load_dwordx4 v5, s[24:27], s58 offen lds
MAA 84,140,68
MAA 84,136,48
MAA 80,136,44
MAA 80,140,64
buffer_load_dwordx4 v6, s[24:27], s58 offen offset:1024 lds
MAA 76,140,60
s_add_u32 m0, s59, 33280
s_xor_b32 s58, s87, 1572864
MAA 76,136,40
s_waitcnt lgkmcnt(8)
v_pk_fma_f32 v[104:105], v[36:37], v[232:233], v[104:105] op_sel_hi:[1,0,1]
v_pk_mul_f32 v[104:105], v[104:105], v[232:233] op_sel:[0,1] op_sel_hi:[1,1]
v_cvt_pk_bf16_f32 v196, v104, v105
v_pk_fma_f32 v[106:107], v[38:39], v[232:233], v[106:107] op_sel_hi:[1,0,1]
v_pk_mul_f32 v[106:107], v[106:107], v[232:233] op_sel:[0,1] op_sel_hi:[1,1]
v_cvt_pk_bf16_f32 v197, v106, v107
v_pk_fma_f32 v[120:121], v[40:41], v[232:233], v[120:121] op_sel_hi:[1,0,1]
v_pk_mul_f32 v[120:121], v[120:121], v[232:233] op_sel:[0,1] op_sel_hi:[1,1]
v_cvt_pk_bf16_f32 v198, v120, v121
v_pk_fma_f32 v[122:123], v[42:43], v[232:233], v[122:123] op_sel_hi:[1,0,1]
v_pk_mul_f32 v[122:123], v[122:123], v[232:233] op_sel:[0,1] op_sel_hi:[1,1]
v_cvt_pk_bf16_f32 v199, v122, v123
s_waitcnt lgkmcnt(3)
v_pk_fma_f32 v[136:137], v[240:241], v[44:45], v[136:137] op_sel_hi:[1,0,1]
s_waitcnt lgkmcnt(2)
v_pk_mul_f32 v[136:137], v[136:137], v[244:245]
v_cvt_pk_bf16_f32 v208, v136, v137
v_pk_fma_f32 v[138:139], v[242:243], v[44:45], v[138:139] op_sel_hi:[1,0,1]
v_pk_mul_f32 v[138:139], v[138:139], v[246:247]
v_cvt_pk_bf16_f32 v209, v138, v139
v_pk_fma_f32 v[152:153], v[240:241], v[44:45], v[152:153] op_sel:[0,1,0] op_sel_hi:[1,1,1]
v_pk_mul_f32 v[152:153], v[152:153], v[244:245]
v_cvt_pk_bf16_f32 v218, v152, v153
v_pk_fma_f32 v[154:155], v[242:243], v[44:45], v[154:155] op_sel:[0,1,0] op_sel_hi:[1,1,1]
v_pk_mul_f32 v[154:155], v[154:155], v[246:247]
v_cvt_pk_bf16_f32 v219, v154, v155
ds_write_b128 v8, v[196:199]
ds_write_b64 v8, v[208:209] offset:1024
ds_write_b64 v8, v[218:219] offset:1032
v_pk_fma_f32 v[156:157], v[36:37], v[236:237], v[156:157] op_sel_hi:[1,0,1]
v_pk_mul_f32 v[156:157], v[156:157], v[236:237] op_sel:[0,1] op_sel_hi:[1,1]
v_cvt_pk_bf16_f32 v180, v156, v157
v_pk_fma_f32 v[158:159], v[38:39], v[236:237], v[158:159] op_sel_hi:[1,0,1]
v_pk_mul_f32 v[158:159], v[158:159], v[236:237] op_sel:[0,1] op_sel_hi:[1,1]
v_cvt_pk_bf16_f32 v181, v158, v159
v_pk_fma_f32 v[160:161], v[40:41], v[236:237], v[160:161] op_sel_hi:[1,0,1]
v_pk_mul_f32 v[160:161], v[160:161], v[236:237] op_sel:[0,1] op_sel_hi:[1,1]
v_cvt_pk_bf16_f32 v182, v160, v161
v_pk_fma_f32 v[162:163], v[42:43], v[236:237], v[162:163] op_sel_hi:[1,0,1]
v_pk_mul_f32 v[162:163], v[162:163], v[236:237] op_sel:[0,1] op_sel_hi:[1,1]
v_cvt_pk_bf16_f32 v183, v162, v163
v_pk_fma_f32 v[100:101], v[36:37], v[228:229], v[100:101] op_sel_hi:[1,0,1]
v_pk_mul_f32 v[100:101], v[100:101], v[228:229] op_sel:[0,1] op_sel_hi:[1,1]
v_cvt_pk_bf16_f32 v192, v100, v101
v_pk_fma_f32 v[102:103], v[38:39], v[228:229], v[102:103] op_sel_hi:[1,0,1]
v_pk_mul_f32 v[102:103], v[102:103], v[228:229] op_sel:[0,1] op_sel_hi:[1,1]
v_cvt_pk_bf16_f32 v193, v102, v103
v_pk_fma_f32 v[116:117], v[40:41], v[228:229], v[116:117] op_sel_hi:[1,0,1]
.Lpad14:
s_cbranch_execz .Lpad17
v_pk_mul_f32 v[116:117], v[116:117], v[228:229] op_sel:[0,1] op_sel_hi:[1,1]
v_cvt_pk_bf16_f32 v194, v116, v117
v_pk_fma_f32 v[118:119], v[42:43], v[228:229], v[118:119] op_sel_hi:[1,0,1]
v_pk_mul_f32 v[118:119], v[118:119], v[228:229] op_sel:[0,1] op_sel_hi:[1,1]
s_waitcnt lgkmcnt(0)
s_barrier
v_cvt_pk_bf16_f32 v195, v118, v119
v_pk_fma_f32 v[96:97], v[36:37], v[224:225], v[96:97] op_sel_hi:[1,0,1]
v_pk_mul_f32 v[96:97], v[96:97], v[224:225] op_sel:[0,1] op_sel_hi:[1,1]
v_cvt_pk_bf16_f32 v188, v96, v97
v_pk_fma_f32 v[98:99], v[38:39], v[224:225], v[98:99] op_sel_hi:[1,0,1]
v_pk_mul_f32 v[98:99], v[98:99], v[224:225] op_sel:[0,1] op_sel_hi:[1,1]
v_cvt_pk_bf16_f32 v189, v98, v99
v_pk_fma_f32 v[112:113], v[40:41], v[224:225], v[112:113] op_sel_hi:[1,0,1]
v_pk_mul_f32 v[112:113], v[112:113], v[224:225] op_sel:[0,1] op_sel_hi:[1,1]
v_cvt_pk_bf16_f32 v190, v112, v113
v_pk_fma_f32 v[114:115], v[42:43], v[224:225], v[114:115] op_sel_hi:[1,0,1]
v_pk_mul_f32 v[114:115], v[114:115], v[224:225] op_sel:[0,1] op_sel_hi:[1,1]
v_cvt_pk_bf16_f32 v191, v114, v115
v_pk_fma_f32 v[92:93], v[36:37], v[220:221], v[92:93] op_sel_hi:[1,0,1]
v_pk_mul_f32 v[92:93], v[92:93], v[220:221] op_sel:[0,1] op_sel_hi:[1,1]
v_cvt_pk_bf16_f32 v184, v92, v93
v_pk_fma_f32 v[94:95], v[38:39], v[220:221], v[94:95] op_sel_hi:[1,0,1]
v_pk_mul_f32 v[94:95], v[94:95], v[220:221] op_sel:[0,1] op_sel_hi:[1,1]
v_cvt_pk_bf16_f32 v185, v94, v95
v_pk_fma_f32 v[108:109], v[40:41], v[220:221], v[108:109] op_sel_hi:[1,0,1]
v_pk_mul_f32 v[108:109], v[108:109], v[220:221] op_sel:[0,1] op_sel_hi:[1,1]
v_cvt_pk_bf16_f32 v186, v108, v109
v_pk_fma_f32 v[110:111], v[42:43], v[220:221], v[110:111] op_sel_hi:[1,0,1]
v_pk_mul_f32 v[110:111], v[110:111], v[220:221] op_sel:[0,1] op_sel_hi:[1,1]
v_cvt_pk_bf16_f32 v187, v110, v111
v_pk_fma_f32 v[72:73], v[28:29], v[232:233], v[72:73] op_sel_hi:[1,0,1]
v_cvt_pk_bf16_f32 v176, v72, v73
v_pk_fma_f32 v[74:75], v[30:31], v[232:233], v[74:75] op_sel_hi:[1,0,1]
v_cvt_pk_bf16_f32 v177, v74, v75
v_pk_fma_f32 v[88:89], v[32:33], v[232:233], v[88:89] op_sel_hi:[1,0,1]
v_cvt_pk_bf16_f32 v178, v88, v89
v_pk_fma_f32 v[90:91], v[34:35], v[232:233], v[90:91] op_sel_hi:[1,0,1]
v_cvt_pk_bf16_f32 v179, v90, v91
v_pk_fma_f32 v[68:69], v[28:29], v[228:229], v[68:69] op_sel_hi:[1,0,1]
v_cvt_pk_bf16_f32 v172, v68, v69
v_pk_fma_f32 v[70:71], v[30:31], v[228:229], v[70:71] op_sel_hi:[1,0,1]
v_cvt_pk_bf16_f32 v173, v70, v71
v_pk_fma_f32 v[84:85], v[32:33], v[228:229], v[84:85] op_sel_hi:[1,0,1]
v_cvt_pk_bf16_f32 v174, v84, v85
v_pk_fma_f32 v[86:87], v[34:35], v[228:229], v[86:87] op_sel_hi:[1,0,1]
v_cvt_pk_bf16_f32 v175, v86, v87
v_pk_fma_f32 v[64:65], v[28:29], v[224:225], v[64:65] op_sel_hi:[1,0,1]
v_cvt_pk_bf16_f32 v168, v64, v65
v_pk_fma_f32 v[66:67], v[30:31], v[224:225], v[66:67] op_sel_hi:[1,0,1]
v_cvt_pk_bf16_f32 v169, v66, v67
v_pk_fma_f32 v[80:81], v[32:33], v[224:225], v[80:81] op_sel_hi:[1,0,1]
v_cvt_pk_bf16_f32 v170, v80, v81
v_pk_fma_f32 v[82:83], v[34:35], v[224:225], v[82:83] op_sel_hi:[1,0,1]
v_cvt_pk_bf16_f32 v171, v82, v83
v_pk_fma_f32 v[60:61], v[28:29], v[220:221], v[60:61] op_sel_hi:[1,0,1]
v_cvt_pk_bf16_f32 v164, v60, v61
v_pk_fma_f32 v[62:63], v[30:31], v[220:221], v[62:63] op_sel_hi:[1,0,1]
v_cvt_pk_bf16_f32 v165, v62, v63
v_pk_fma_f32 v[76:77], v[32:33], v[220:221], v[76:77] op_sel_hi:[1,0,1]
v_cvt_pk_bf16_f32 v166, v76, v77
v_pk_fma_f32 v[78:79], v[34:35], v[220:221], v[78:79] op_sel_hi:[1,0,1]
v_cvt_pk_bf16_f32 v167, v78, v79
s_nop 0
v_mfma_f32_16x16x32_bf16 v[120:123], v[196:199], v[176:179], v[50:53]
buffer_load_dwordx4 v5, s[24:27], s58 offen lds
v_mfma_f32_16x16x32_bf16 v[104:107], v[192:195], v[176:179], v[46:49]
ds_read_b64 v[200:201], v9 offset:1024
v_mfma_f32_16x16x32_bf16 v[116:119], v[192:195], v[172:175], v[50:53]
ds_read_b64 v[210:211], v9 offset:1032
v_mfma_f32_16x16x32_bf16 v[100:103], v[188:191], v[172:175], v[46:49]
ds_read_b128 v[240:243], v11 offset:64
v_mfma_f32_16x16x32_bf16 v[112:115], v[188:191], v[168:171], v[50:53]
buffer_load_dwordx4 v6, s[24:27], s58 offen offset:1024 lds
v_mfma_f32_16x16x32_bf16 v[96:99], v[184:187], v[168:171], v[46:49]
ds_read_b128 v[244:247], v11 offset:1088
s_add_u32 m0, s59, 41600
v_mfma_f32_16x16x32_bf16 v[108:111], v[184:187], v[164:167], v[50:53]
ds_read_b128 v[28:31], v11
s_xor_b32 s58, s87, 1703936
v_mfma_f32_16x16x32_bf16 v[92:95], v[180:183], v[164:167], v[54:57]
ds_read_b128 v[32:35], v11 offset:1024
v_max3_f32 v88, v104, v105, v106
MAA 132,8,96
buffer_load_dwordx4 v5, s[24:27], s58 offen lds
MAA 132,28,100
v_max3_f32 v89, v107, v120, v121
v_max3_f32 v88, v88, v122, v123
MAA 132,48,160
v_max_f32 v90, v88, v89
v_max_f32 v89, v88, v89
MAA 132,68,164
s_nop 0
v_permlane16_swap_b32 v90, v89
MAA 148,68,172
buffer_load_dwordx4 v6, s[24:27], s58 offen offset:1024 lds
MAA 148,48,168
s_add_u32 m0, s59, 49920
s_xor_b32 s58, s87, 1835008
v_max_f32 v88, v90, v89
MAA 148,28,124
v_max_f32 v89, v90, v89
v_max3_f32 v84, v100, v101, v102
MAA 148,8,120
v_permlane32_swap_b32 v88, v89
v_max3_f32 v85, v103, v116, v117
v_max_f32 v88, v88, v89
v_mul_f32 v88, v88, v234
v_max3_f32 v84, v84, v118, v119
v_max_f32 v86, v84, v85
v_max_f32 v85, v84, v85
v_max3_f32 v80, v96, v97, v98
v_max3_f32 v81, v99, v112, v113
v_permlane16_swap_b32 v86, v85
v_max3_f32 v80, v80, v114, v115
v_max_f32 v84, v86, v85
v_max_f32 v85, v86, v85
v_max_f32 v82, v80, v81
v_max_f32 v81, v80, v81
v_permlane32_swap_b32 v84, v85
v_max3_f32 v76, v92, v93, v94
v_max_f32 v84, v84, v85
v_mul_f32 v84, v84, v230
v_permlane16_swap_b32 v82, v81
v_max3_f32 v77, v95, v108, v109
v_max_f32 v80, v82, v81
v_max_f32 v81, v82, v81
v_max3_f32 v76, v76, v110, v111
v_max_f32 v78, v76, v77
v_permlane32_swap_b32 v80, v81
v_max_f32 v77, v76, v77
v_max_f32 v80, v80, v81
v_mul_f32 v80, v80, v226
v_permlane16_swap_b32 v78, v77
v_pk_fma_f32 v[104:105], v[104:105], v[234:235], v[88:89] op_sel_hi:[1,0,0] neg_lo:[0,0,1] neg_hi:[0,0,1]
v_max_f32 v76, v78, v77
v_max_f32 v77, v78, v77
v_pk_fma_f32 v[106:107], v[106:107], v[234:235], v[88:89] op_sel_hi:[1,0,0] neg_lo:[0,0,1] neg_hi:[0,0,1]
v_pk_fma_f32 v[120:121], v[120:121], v[234:235], v[88:89] op_sel_hi:[1,0,0] neg_lo:[0,0,1] neg_hi:[0,0,1]
v_permlane32_swap_b32 v76, v77
v_pk_fma_f32 v[122:123], v[122:123], v[234:235], v[88:89] op_sel_hi:[1,0,0] neg_lo:[0,0,1] neg_hi:[0,0,1]
v_max_f32 v76, v76, v77
v_mul_f32 v76, v76, v222
v_pk_fma_f32 v[100:101], v[100:101], v[230:231], v[84:85] op_sel_hi:[1,0,0] neg_lo:[0,0,1] neg_hi:[0,0,1]
v_pk_fma_f32 v[102:103], v[102:103], v[230:231], v[84:85] op_sel_hi:[1,0,0] neg_lo:[0,0,1] neg_hi:[0,0,1]
v_pk_fma_f32 v[116:117], v[116:117], v[230:231], v[84:85] op_sel_hi:[1,0,0] neg_lo:[0,0,1] neg_hi:[0,0,1]
v_pk_fma_f32 v[118:119], v[118:119], v[230:231], v[84:85] op_sel_hi:[1,0,0] neg_lo:[0,0,1] neg_hi:[0,0,1]
v_pk_fma_f32 v[96:97], v[96:97], v[226:227], v[80:81] op_sel_hi:[1,0,0] neg_lo:[0,0,1] neg_hi:[0,0,1]
v_pk_fma_f32 v[98:99], v[98:99], v[226:227], v[80:81] op_sel_hi:[1,0,0] neg_lo:[0,0,1] neg_hi:[0,0,1]
v_pk_fma_f32 v[112:113], v[112:113], v[226:227], v[80:81] op_sel_hi:[1,0,0] neg_lo:[0,0,1] neg_hi:[0,0,1]
v_pk_fma_f32 v[114:115], v[114:115], v[226:227], v[80:81] op_sel_hi:[1,0,0] neg_lo:[0,0,1] neg_hi:[0,0,1]
v_pk_fma_f32 v[92:93], v[92:93], v[222:223], v[76:77] op_sel_hi:[1,0,0] neg_lo:[0,0,1] neg_hi:[0,0,1]
v_pk_fma_f32 v[94:95], v[94:95], v[222:223], v[76:77] op_sel_hi:[1,0,0] neg_lo:[0,0,1] neg_hi:[0,0,1]
v_pk_fma_f32 v[108:109], v[108:109], v[222:223], v[76:77] op_sel_hi:[1,0,0] neg_lo:[0,0,1] neg_hi:[0,0,1]
v_pk_fma_f32 v[110:111], v[110:111], v[222:223], v[76:77] op_sel_hi:[1,0,0] neg_lo:[0,0,1] neg_hi:[0,0,1]
v_pk_fma_f32 v[132:133], v[18:19], v[44:45], v[132:133] op_sel_hi:[1,0,1]
v_pk_mul_f32 v[132:133], v[132:133], v[22:23]
v_pk_fma_f32 v[134:135], v[20:21], v[44:45], v[134:135] op_sel_hi:[1,0,1]
v_pk_mul_f32 v[134:135], v[134:135], v[24:25]
v_pk_fma_f32 v[148:149], v[18:19], v[44:45], v[148:149] op_sel:[0,1,0] op_sel_hi:[1,1,1]
v_pk_mul_f32 v[148:149], v[148:149], v[22:23]
v_pk_fma_f32 v[150:151], v[20:21], v[44:45], v[150:151] op_sel:[0,1,0] op_sel_hi:[1,1,1]
v_pk_mul_f32 v[150:151], v[150:151], v[24:25]
v_exp_f32 v104, v104
s_nop 0
MAA 128,4,96
buffer_load_dwordx4 v5, s[24:27], s58 offen lds
MAA 128,24,100
v_exp_f32 v105, v105
MAA 128,44,160
v_exp_f32 v106, v106
MAA 128,64,164
v_exp_f32 v107, v107
MAA 144,64,172
buffer_load_dwordx4 v6, s[24:27], s58 offen offset:1024 lds
MAA 144,44,168
s_add_u32 m0, s59, 116480
s_xor_b32 s58, s87, 786432
v_exp_f32 v120, v120
MAA 144,24,124
v_exp_f32 v121, v121
MAA 144,4,120
v_exp_f32 v122, v122
MAA 124,0,96
buffer_load_dwordx4 v5, s[24:27], s58 offen lds
MAA 124,20,100
v_exp_f32 v123, v123
MAA 124,40,160
v_exp_f32 v100, v100
MAA 124,60,164
v_exp_f32 v101, v101
MAA 140,60,172
buffer_load_dwordx4 v6, s[24:27], s58 offen offset:1024 lds
MAA 140,40,168
s_add_u32 m0, s59, 124800
s_xor_b32 s58, s87, 917504
v_exp_f32 v102, v102
MAA 140,20,124
v_exp_f32 v103, v103
MAA 140,0,120
v_cvt_pk_bf16_f32 v72, v104, v105
v_cvt_pk_bf16_f32 v73, v106, v107
v_cvt_pk_bf16_f32 v74, v120, v121
v_cvt_pk_bf16_f32 v75, v122, v123
v_exp_f32 v116, v116
v_exp_f32 v117, v117
v_exp_f32 v118, v118
v_exp_f32 v119, v119
v_cvt_pk_bf16_f32 v68, v100, v101
v_cvt_pk_bf16_f32 v69, v102, v103
v_cvt_pk_bf16_f32 v70, v116, v117
v_cvt_pk_bf16_f32 v71, v118, v119
v_exp_f32 v96, v96
v_exp_f32 v97, v97
v_exp_f32 v98, v98
v_exp_f32 v99, v99
v_exp_f32 v112, v112
v_exp_f32 v113, v113
v_exp_f32 v114, v114
v_exp_f32 v115, v115
v_cvt_pk_bf16_f32 v64, v96, v97
v_cvt_pk_bf16_f32 v65, v98, v99
v_cvt_pk_bf16_f32 v66, v112, v113
v_cvt_pk_bf16_f32 v67, v114, v115
v_cvt_pk_bf16_f32 v206, v132, v133
v_cvt_pk_bf16_f32 v207, v134, v135
v_cvt_pk_bf16_f32 v216, v148, v149
v_cvt_pk_bf16_f32 v217, v150, v151
s_waitcnt lgkmcnt(3)
v_pk_fma_f32 v[128:129], v[240:241], v[44:45], v[128:129] op_sel_hi:[1,0,1]
s_waitcnt lgkmcnt(2)
v_pk_mul_f32 v[128:129], v[128:129], v[244:245]
v_cvt_pk_bf16_f32 v204, v128, v129
v_pk_fma_f32 v[130:131], v[242:243], v[44:45], v[130:131] op_sel_hi:[1,0,1]
v_pk_mul_f32 v[130:131], v[130:131], v[246:247]
v_cvt_pk_bf16_f32 v205, v130, v131
v_pk_fma_f32 v[144:145], v[240:241], v[44:45], v[144:145] op_sel:[0,1,0] op_sel_hi:[1,1,1]
v_pk_mul_f32 v[144:145], v[144:145], v[244:245]
v_cvt_pk_bf16_f32 v214, v144, v145
v_pk_fma_f32 v[146:147], v[242:243], v[44:45], v[146:147] op_sel:[0,1,0] op_sel_hi:[1,1,1]
v_pk_mul_f32 v[146:147], v[146:147], v[246:247]
v_cvt_pk_bf16_f32 v215, v146, v147
s_waitcnt lgkmcnt(1)
v_pk_fma_f32 v[124:125], v[28:29], v[44:45], v[124:125] op_sel_hi:[1,0,1]
s_waitcnt lgkmcnt(0)
v_pk_mul_f32 v[124:125], v[124:125], v[32:33]
v_cvt_pk_bf16_f32 v202, v124, v125
v_pk_fma_f32 v[126:127], v[30:31], v[44:45], v[126:127] op_sel_hi:[1,0,1]
v_pk_mul_f32 v[126:127], v[126:127], v[34:35]
v_cvt_pk_bf16_f32 v203, v126, v127
v_pk_fma_f32 v[140:141], v[28:29], v[44:45], v[140:141] op_sel:[0,1,0] op_sel_hi:[1,1,1]
v_pk_mul_f32 v[140:141], v[140:141], v[32:33]
v_cvt_pk_bf16_f32 v212, v140, v141
v_pk_fma_f32 v[142:143], v[30:31], v[44:45], v[142:143] op_sel:[0,1,0] op_sel_hi:[1,1,1]
v_pk_mul_f32 v[142:143], v[142:143], v[34:35]
v_cvt_pk_bf16_f32 v213, v142, v143
s_nop 0
v_mfma_f32_16x16x32_bf16 v[88:91], v[248:251], v[72:75], 0
buffer_load_dwordx4 v5, s[24:27], s58 offen lds
v_mfma_f32_16x16x32_bf16 v[104:107], v[206:209], v[72:75], 0
v_exp_f32 v92, v92
v_mfma_f32_16x16x32_bf16 v[120:123], v[216:219], v[72:75], 0
v_exp_f32 v93, v93
v_mfma_f32_16x16x32_bf16 v[84:87], v[248:251], v[68:71], 0
v_exp_f32 v94, v94
v_mfma_f32_16x16x32_bf16 v[100:103], v[204:207], v[68:71], 0
buffer_load_dwordx4 v6, s[24:27], s58 offen offset:1024 lds
v_mfma_f32_16x16x32_bf16 v[116:119], v[214:217], v[68:71], 0
v_exp_f32 v95, v95
v_mfma_f32_16x16x32_bf16 v[80:83], v[248:251], v[64:67], 0
v_exp_f32 v108, v108
v_mfma_f32_16x16x32_bf16 v[96:99], v[202:205], v[64:67], 0
v_exp_f32 v109, v109
v_mfma_f32_16x16x32_bf16 v[112:115], v[212:215], v[64:67], 0
v_exp_f32 v110, v110
v_cvt_pk_bf16_f32 v60, v92, v93
v_cvt_pk_bf16_f32 v61, v94, v95
v_cvt_pk_bf16_f32 v62, v108, v109
v_rcp_f32 v88, v88
v_rcp_f32 v84, v84
v_rcp_f32 v80, v80
v_pk_mul_f32 v[104:105], v[104:105], v[88:89] op_sel_hi:[1,0]
v_pk_mul_f32 v[106:107], v[106:107], v[88:89] op_sel_hi:[1,0]
v_pk_mul_f32 v[120:121], v[120:121], v[88:89] op_sel_hi:[1,0]
v_pk_mul_f32 v[122:123], v[122:123], v[88:89] op_sel_hi:[1,0]
v_cvt_pk_bf16_f32 v176, v104, v105
v_cvt_pk_bf16_f32 v177, v106, v107
v_cvt_pk_bf16_f32 v178, v120, v121
v_cvt_pk_bf16_f32 v179, v122, v123
buffer_store_dwordx4 v[176:179], v4, s[16:19], s74 offen offset:3072 sc1
v_pk_mul_f32 v[100:101], v[100:101], v[84:85] op_sel_hi:[1,0]
v_pk_mul_f32 v[102:103], v[102:103], v[84:85] op_sel_hi:[1,0]
v_pk_mul_f32 v[116:117], v[116:117], v[84:85] op_sel_hi:[1,0]
v_pk_mul_f32 v[118:119], v[118:119], v[84:85] op_sel_hi:[1,0]
v_cvt_pk_bf16_f32 v172, v100, v101
v_cvt_pk_bf16_f32 v173, v102, v103
v_cvt_pk_bf16_f32 v174, v116, v117
v_cvt_pk_bf16_f32 v175, v118, v119
buffer_store_dwordx4 v[172:175], v4, s[16:19], s74 offen offset:2048 sc1
v_pk_mul_f32 v[96:97], v[96:97], v[80:81] op_sel_hi:[1,0]
v_pk_mul_f32 v[98:99], v[98:99], v[80:81] op_sel_hi:[1,0]
v_pk_mul_f32 v[112:113], v[112:113], v[80:81] op_sel_hi:[1,0]
v_pk_mul_f32 v[114:115], v[114:115], v[80:81] op_sel_hi:[1,0]
v_cvt_pk_bf16_f32 v168, v96, v97
v_cvt_pk_bf16_f32 v169, v98, v99
v_cvt_pk_bf16_f32 v170, v112, v113
v_cvt_pk_bf16_f32 v171, v114, v115
buffer_store_dwordx4 v[168:171], v4, s[16:19], s74 offen offset:1024 sc1
v_exp_f32 v111, v111
s_nop 0
v_cvt_pk_bf16_f32 v63, v110, v111
s_nop 1
v_mfma_f32_16x16x32_bf16 v[76:79], v[248:251], v[60:63], 0
v_mfma_f32_16x16x32_bf16 v[92:95], v[200:203], v[60:63], 0
v_mfma_f32_16x16x32_bf16 v[108:111], v[210:213], v[60:63], 0
s_nop 5
v_rcp_f32 v76, v76
s_nop 0
v_pk_mul_f32 v[92:93], v[92:93], v[76:77] op_sel_hi:[1,0]
v_cvt_pk_bf16_f32 v164, v92, v93
v_pk_mul_f32 v[94:95], v[94:95], v[76:77] op_sel_hi:[1,0]
v_cvt_pk_bf16_f32 v165, v94, v95
v_pk_mul_f32 v[108:109], v[108:109], v[76:77] op_sel_hi:[1,0]
v_cvt_pk_bf16_f32 v166, v108, v109
v_pk_mul_f32 v[110:111], v[110:111], v[76:77] op_sel_hi:[1,0]
v_cvt_pk_bf16_f32 v167, v110, v111
buffer_store_dwordx4 v[164:167], v4, s[16:19], s74 offen sc1
s_nop 1
s_branch .Lqkve56
.Lpad15:
s_cbranch_execz .Lpad18
.Lsp50:
s_mov_b32 s15, 0
.Lsp50l:
v_mov_b32 v25, 0
buffer_atomic_add v25, v22, s[16:19], s73 offen sc0
s_add_u32 s15, s15, 1
s_cmp_gt_u32 s15, 100000
s_waitcnt vmcnt(0)
s_cbranch_scc1 .Lsp50b
v_cmp_gt_u32 vcc, v23, v25
s_nop 0
s_cbranch_vccnz .Lsp50l
s_branch .Lsp50b
.Lxs51:
s_mov_b32 s15, 0
.Lxs51l:
v_mov_b32 v15, 0
buffer_atomic_add v15, v12, s[16:19], s70 offen sc0
s_add_u32 s15, s15, 1
s_cmp_gt_u32 s15, 100000
s_waitcnt vmcnt(0)
s_cbranch_scc1 .Lxs51b
v_cmp_ne_u32 vcc, 0, v15
s_nop 0
s_cbranch_vccz .Lxs51l
s_branch .Lxs51b
.Lqkv55:
.Lpad16:
s_cbranch_execz .Lpad19
s_add_u32 m0, s55, 36864
s_nop 0
buffer_load_dwordx4 v21, s[16:19], s52 offen sc1 lds
buffer_load_dwordx4 v21, s[16:19], s52 offen offset:1024 sc1 lds
buffer_load_dword v22, s[16:19], s52 offen offset:2048 sc1 lds
s_add_u32 s52, s52, 131072
s_add_u32 m0, s55, 46080
s_nop 0
buffer_load_dwordx4 v21, s[16:19], s52 offen sc1 lds
buffer_load_dwordx4 v21, s[16:19], s52 offen offset:1024 sc1 lds
buffer_load_dword v22, s[16:19], s52 offen offset:2048 sc1 lds
s_add_u32 s52, s52, 131072
s_add_u32 m0, s55, 0
s_nop 0
buffer_load_dwordx4 v21, s[16:19], s52 offen sc1 lds
buffer_load_dwordx4 v21, s[16:19], s52 offen offset:1024 sc1 lds
buffer_load_dword v22, s[16:19], s52 offen offset:2048 sc1 lds
s_add_u32 s52, s52, 131072
s_add_u32 m0, s55, 9216
s_nop 0
buffer_load_dwordx4 v21, s[16:19], s52 offen sc1 lds
buffer_load_dwordx4 v21, s[16:19], s52 offen offset:1024 sc1 lds
buffer_load_dword v22, s[16:19], s52 offen offset:2048 sc1 lds
s_add_u32 s52, s52, 131072
s_add_u32 m0, s55, 18432
s_nop 0
buffer_load_dwordx4 v21, s[16:19], s52 offen sc1 lds
buffer_load_dwordx4 v21, s[16:19], s52 offen offset:1024 sc1 lds
buffer_load_dword v22, s[16:19], s52 offen offset:2048 sc1 lds
s_add_u32 s52, s52, 131072
s_add_u32 m0, s55, 27648
s_nop 0
buffer_load_dwordx4 v21, s[16:19], s52 offen sc1 lds
buffer_load_dwordx4 v21, s[16:19], s52 offen offset:1024 sc1 lds
buffer_load_dword v22, s[16:19], s52 offen offset:2048 sc1 lds
s_add_u32 s52, s52, 131072
s_waitcnt vmcnt(12)
s_barrier
RD 0,23,36864
RD 4,23,37888
RD 8,23,39168
RD 12,23,40192
RD 16,24,38912
RD 20,23,46080
RD 24,23,47104
RD 28,23,48384
RD 32,23,49408
RD 36,24,48128
s_waitcnt lgkmcnt(0)
s_mov_b32 s15, -2
.p2align 6
.Lk58:
s_waitcnt vmcnt(9) lgkmcnt(8)
s_barrier
MAA 60,80,0
TR 104,25,49696
s_add_u32 m0, s56, 104832
MAA 60,84,20
buffer_load_dwordx4 v18, s[20:23], s54 offen lds
MAA 64,84,24
TR 106,25,50208
v_add_f32 v164, v164, v168
MAA 64,80,4
TR 108,25,62112
MAA 68,80,8
TR 110,25,62624
MAA 68,84,28
buffer_load_dwordx4 v19, s[20:23], s54 offen offset:1024 lds
MAA 72,84,32
TR 112,25,50720
v_add_f32 v165, v165, v169
MAA 72,80,12
TR 114,25,51232
s_waitcnt lgkmcnt(6)
MAA 104,88,12
TR 116,25,63136
MAA 104,92,32
buffer_load_dwordx4 v20, s[20:23], s54 offen offset:2048 lds
MAA 100,92,28
s_add_u32 s54, s54, 196608
s_add_u32 m0, s55, 36864
MAA 100,88,8
buffer_load_dwordx4 v21, s[16:19], s52 offen sc1 lds
MAA 96,88,4
TR 118,25,63648
MAA 96,92,24
TR 120,25,51744
v_add_f32 v166, v166, v170
MAA 92,92,20
TR 122,25,52256
MAA 92,88,0
buffer_load_dwordx4 v21, s[16:19], s52 offen offset:1024 sc1 lds
MAA 124,0,96
TR 124,25,64160
MAA 124,20,100
TR 126,25,64672
v_add_f32 v167, v167, v171
MAA 128,24,100
ds_read_b128 a[40:43], v23
MAA 128,4,96
buffer_load_dword v22, s[16:19], s52 offen offset:2048 sc1 lds
MAA 132,8,96
RD 44,23,1024
s_add_u32 s52, s52, 131072
MAA 132,28,100
buffer_load_dword v27, v14, s[20:23], s44 offen
MAA 136,32,100
RD 48,23,2304
s_add_u32 s44, s44, 1572864
MAA 136,12,96
RD 52,23,3328
MAA 156,16,96
RD 56,24,2048
MAA 156,36,100
s_waitcnt vmcnt(13) lgkmcnt(5)
s_barrier
MAA 76,104,0
RD 60,23,9216
s_add_u32 m0, s56, 117248
MAA 76,108,20
buffer_load_dwordx4 v18, s[20:23], s54 offen lds
MAA 80,108,24
RD 64,23,10240
MAA 80,104,4
RD 68,23,11520
MAA 84,104,8
RD 72,23,12544
MAA 84,108,28
buffer_load_dwordx4 v19, s[20:23], s54 offen offset:1024 lds
MAA 88,108,32
RD 76,24,11264
MAA 88,104,12
buffer_load_dwordx4 v20, s[20:23], s54 offen offset:2048 lds
MAA 120,112,12
ds_read_b64_tr_b16 a[80:81], v25
s_add_u32 s54, s54, 196608
MAA 120,116,32
TR 82,25,512
MAA 116,116,28
TR 84,25,12416
s_add_u32 m0, s55, 46080
MAA 116,112,8
buffer_load_dwordx4 v21, s[16:19], s52 offen sc1 lds
MAA 112,112,4
TR 86,25,12928
MAA 112,116,24
TR 88,25,1024
MAA 108,116,20
TR 90,25,1536
MAA 108,112,0
buffer_load_dwordx4 v21, s[16:19], s52 offen offset:1024 sc1 lds
MAA 140,0,120
TR 92,25,13440
MAA 140,20,124
TR 94,25,13952
MAA 144,24,124
TR 96,25,2048
MAA 144,4,120
buffer_load_dword v22, s[16:19], s52 offen offset:2048 sc1 lds
MAA 148,8,120
TR 98,25,2560
s_add_u32 s52, s52, 131072
MAA 148,28,124
buffer_load_dwordx4 v[168:171], v26, s[16:19], s75 offen sc1
MAA 152,32,124
TR 100,25,14464
MAA 152,12,120
TR 102,25,14976
MAA 160,16,120
MAA 160,36,124
s_waitcnt vmcnt(17) lgkmcnt(8)
s_barrier
MAA 60,80,40
TR 104,25,32
v_add_f32 v164, v164, v172
MAA 60,84,60
TR 106,25,544
MAA 64,84,64
TR 108,25,12448
s_add_u32 m0, s56, 129664
MAA 64,80,44
buffer_load_dwordx4 v18, s[20:23], s54 offen lds
MAA 68,80,48
TR 110,25,12960
MAA 68,84,68
TR 112,25,1056
MAA 72,84,72
TR 114,25,1568
v_add_f32 v165, v165, v173
MAA 72,80,52
TR 116,25,13472
s_waitcnt lgkmcnt(7)
MAA 104,88,52
TR 118,25,13984
MAA 104,92,72
buffer_load_dwordx4 v19, s[20:23], s54 offen offset:1024 lds
MAA 100,92,68
TR 120,25,2080
MAA 100,88,48
buffer_load_dwordx4 v20, s[20:23], s54 offen offset:2048 lds
MAA 96,88,44
s_add_u32 s54, s54, 196608
MAA 96,92,64
TR 122,25,2592
v_add_f32 v166, v166, v174
MAA 92,92,60
TR 124,25,14496
s_add_u32 m0, s55, 0
MAA 92,88,40
buffer_load_dwordx4 v21, s[16:19], s52 offen sc1 lds
MAA 124,40,96
TR 126,25,15008
MAA 124,60,100
RD 0,23,18432
MAA 128,64,100
RD 4,23,19456
MAA 128,44,96
buffer_load_dwordx4 v21, s[16:19], s52 offen offset:1024 sc1 lds
MAA 132,48,96
RD 8,23,20736
.Lpad17:
s_cbranch_execz .Lpad20
v_add_f32 v167, v167, v175
MAA 132,68,100
RD 12,23,21760
MAA 136,72,100
RD 16,24,20480
MAA 136,52,96
buffer_load_dword v22, s[16:19], s52 offen offset:2048 sc1 lds
MAA 156,56,96
s_add_u32 s52, s52, 131072
MAA 156,76,100
s_waitcnt vmcnt(17) lgkmcnt(5)
s_barrier
MAA 76,104,40
RD 20,23,27648
s_add_u32 m0, s56, 67584
MAA 76,108,60
buffer_load_dwordx4 v18, s[20:23], s54 offen lds
MAA 80,108,64
RD 24,23,28672
MAA 80,104,44
RD 28,23,29952
MAA 84,104,48
RD 32,23,30976
MAA 84,108,68
buffer_load_dwordx4 v19, s[20:23], s54 offen offset:1024 lds
MAA 88,108,72
RD 36,24,29696
MAA 88,104,52
buffer_load_dwordx4 v20, s[20:23], s54 offen offset:2048 lds
MAA 120,112,52
TR 80,25,24832
s_add_u32 s54, s54, 196608
MAA 120,116,72
TR 82,25,25344
MAA 116,116,68
TR 84,25,37248
s_add_u32 m0, s55, 9216
MAA 116,112,48
buffer_load_dwordx4 v21, s[16:19], s52 offen sc1 lds
MAA 112,112,44
TR 86,25,37760
MAA 112,116,64
TR 88,25,25856
MAA 108,116,60
TR 90,25,26368
MAA 108,112,40
buffer_load_dwordx4 v21, s[16:19], s52 offen offset:1024 sc1 lds
MAA 140,40,120
TR 92,25,38272
MAA 140,60,124
TR 94,25,38784
MAA 144,64,124
TR 96,25,26880
MAA 144,44,120
buffer_load_dword v22, s[16:19], s52 offen offset:2048 sc1 lds
MAA 148,48,120
TR 98,25,27392
s_add_u32 s52, s52, 131072
MAA 148,68,124
buffer_load_dwordx4 v[172:175], v26, s[16:19], s75 offen offset:1024 sc1
MAA 152,72,124
TR 100,25,39296
s_add_u32 s75, s75, 2048
MAA 152,52,120
TR 102,25,39808
MAA 160,56,120
MAA 160,76,124
s_waitcnt vmcnt(21) lgkmcnt(8)
s_barrier
MAA 60,80,0
TR 104,25,24864
MAA 60,84,20
TR 106,25,25376
MAA 64,84,24
TR 108,25,37280
s_add_u32 m0, s56, 80000
MAA 64,80,4
buffer_load_dwordx4 v18, s[20:23], s54 offen lds
MAA 68,80,8
TR 110,25,37792
MAA 68,84,28
TR 112,25,25888
MAA 72,84,32
TR 114,25,26400
MAA 72,80,12
TR 116,25,38304
s_waitcnt lgkmcnt(7)
MAA 104,88,12
TR 118,25,38816
MAA 104,92,32
buffer_load_dwordx4 v19, s[20:23], s54 offen offset:1024 lds
MAA 100,92,28
TR 120,25,26912
MAA 100,88,8
buffer_load_dwordx4 v20, s[20:23], s54 offen offset:2048 lds
MAA 96,88,4
s_add_u32 s54, s54, 196608
MAA 96,92,24
TR 122,25,27424
MAA 92,92,20
TR 124,25,39328
s_add_u32 m0, s55, 18432
MAA 92,88,0
buffer_load_dwordx4 v21, s[16:19], s52 offen sc1 lds
MAA 124,0,96
TR 126,25,39840
MAA 124,20,100
RD 40,23,36864
MAA 128,24,100
RD 44,23,37888
MAA 128,4,96
buffer_load_dwordx4 v21, s[16:19], s52 offen offset:1024 sc1 lds
MAA 132,8,96
RD 48,23,39168
MAA 132,28,100
RD 52,23,40192
MAA 136,32,100
RD 56,24,38912
MAA 136,12,96
buffer_load_dword v22, s[16:19], s52 offen offset:2048 sc1 lds
MAA 156,16,96
s_add_u32 s52, s52, 131072
MAA 156,36,100
s_waitcnt vmcnt(16) lgkmcnt(5)
s_barrier
MAA 76,104,0
RD 60,23,46080
MAA 76,108,20
RD 64,23,47104
MAA 80,108,24
RD 68,23,48384
s_add_u32 m0, s56, 92416
MAA 80,104,4
buffer_load_dwordx4 v18, s[20:23], s54 offen lds
MAA 84,104,8
RD 72,23,49408
MAA 84,108,28
RD 76,24,48128
MAA 88,108,32
TR 80,25,49664
MAA 88,104,12
buffer_load_dwordx4 v19, s[20:23], s54 offen offset:1024 lds
MAA 120,112,12
TR 82,25,50176
MAA 120,116,32
TR 84,25,62080
MAA 116,116,28
TR 86,25,62592
MAA 116,112,8
buffer_load_dwordx4 v20, s[20:23], s54 offen offset:2048 lds
MAA 112,112,4
s_add_u32 s54, s54, 196608
MAA 112,116,24
TR 88,25,50688
MAA 108,116,20
TR 90,25,51200
s_add_u32 m0, s55, 27648
MAA 108,112,0
buffer_load_dwordx4 v21, s[16:19], s52 offen sc1 lds
MAA 140,0,120
TR 92,25,63104
MAA 140,20,124
TR 94,25,63616
MAA 144,24,124
TR 96,25,51712
MAA 144,4,120
buffer_load_dwordx4 v21, s[16:19], s52 offen offset:1024 sc1 lds
MAA 148,8,120
TR 98,25,52224
MAA 148,28,124
TR 100,25,64128
MAA 152,32,124
TR 102,25,64640
MAA 152,12,120
buffer_load_dword v22, s[16:19], s52 offen offset:2048 sc1 lds
MAA 160,16,120
s_add_u32 s52, s52, 131072
MAA 160,36,124
s_waitcnt vmcnt(19) lgkmcnt(8)
s_barrier
MAA 60,80,40
TR 104,25,49696
s_add_u32 m0, s56, 104832
MAA 60,84,60
buffer_load_dwordx4 v18, s[20:23], s54 offen lds
MAA 64,84,64
TR 106,25,50208
v_add_f32 v164, v164, v168
MAA 64,80,44
TR 108,25,62112
MAA 68,80,48
TR 110,25,62624
MAA 68,84,68
buffer_load_dwordx4 v19, s[20:23], s54 offen offset:1024 lds
MAA 72,84,72
TR 112,25,50720
v_add_f32 v165, v165, v169
MAA 72,80,52
TR 114,25,51232
s_waitcnt lgkmcnt(6)
MAA 104,88,52
TR 116,25,63136
MAA 104,92,72
buffer_load_dwordx4 v20, s[20:23], s54 offen offset:2048 lds
MAA 100,92,68
s_add_u32 s54, s54, 196608
s_add_u32 m0, s55, 36864
MAA 100,88,48
buffer_load_dwordx4 v21, s[16:19], s52 offen sc1 lds
MAA 96,88,44
TR 118,25,63648
MAA 96,92,64
TR 120,25,51744
v_add_f32 v166, v166, v170
MAA 92,92,60
TR 122,25,52256
MAA 92,88,40
buffer_load_dwordx4 v21, s[16:19], s52 offen offset:1024 sc1 lds
MAA 124,40,96
TR 124,25,64160
MAA 124,60,100
TR 126,25,64672
v_add_f32 v167, v167, v171
MAA 128,64,100
ds_read_b128 a[0:3], v23
MAA 128,44,96
buffer_load_dword v22, s[16:19], s52 offen offset:2048 sc1 lds
MAA 132,48,96
RD 4,23,1024
s_add_u32 s52, s52, 131072
MAA 132,68,100
buffer_load_dword v27, v14, s[20:23], s44 offen
MAA 136,72,100
RD 8,23,2304
s_add_u32 s44, s44, 1572864
MAA 136,52,96
RD 12,23,3328
MAA 156,56,96
RD 16,24,2048
MAA 156,76,100
s_waitcnt vmcnt(16) lgkmcnt(5)
s_barrier
MAA 76,104,40
RD 20,23,9216
s_add_u32 m0, s56, 117248
MAA 76,108,60
buffer_load_dwordx4 v18, s[20:23], s54 offen lds
MAA 80,108,64
RD 24,23,10240
MAA 80,104,44
RD 28,23,11520
MAA 84,104,48
RD 32,23,12544
MAA 84,108,68
buffer_load_dwordx4 v19, s[20:23], s54 offen offset:1024 lds
MAA 88,108,72
RD 36,24,11264
MAA 88,104,52
buffer_load_dwordx4 v20, s[20:23], s54 offen offset:2048 lds
MAA 120,112,52
ds_read_b64_tr_b16 a[80:81], v25
s_add_u32 s54, s54, 196608
MAA 120,116,72
TR 82,25,512
MAA 116,116,68
TR 84,25,12416
s_add_u32 m0, s55, 46080
MAA 116,112,48
buffer_load_dwordx4 v21, s[16:19], s52 offen sc1 lds
MAA 112,112,44
TR 86,25,12928
MAA 112,116,64
TR 88,25,1024
MAA 108,116,60
TR 90,25,1536
MAA 108,112,40
buffer_load_dwordx4 v21, s[16:19], s52 offen offset:1024 sc1 lds
MAA 140,40,120
TR 92,25,13440
MAA 140,60,124
TR 94,25,13952
MAA 144,64,124
TR 96,25,2048
MAA 144,44,120
buffer_load_dword v22, s[16:19], s52 offen offset:2048 sc1 lds
MAA 148,48,120
TR 98,25,2560
s_add_u32 s52, s52, 131072
MAA 148,68,124
buffer_load_dwordx4 v[168:171], v26, s[16:19], s75 offen sc1
MAA 152,72,124
TR 100,25,14464
MAA 152,52,120
TR 102,25,14976
MAA 160,56,120
MAA 160,76,124
s_waitcnt vmcnt(20) lgkmcnt(8)
s_barrier
MAA 60,80,0
TR 104,25,32
v_add_f32 v164, v164, v172
MAA 60,84,20
TR 106,25,544
MAA 64,84,24
TR 108,25,12448
s_add_u32 m0, s56, 129664
MAA 64,80,4
buffer_load_dwordx4 v18, s[20:23], s54 offen lds
MAA 68,80,8
TR 110,25,12960
MAA 68,84,28
TR 112,25,1056
MAA 72,84,32
TR 114,25,1568
v_add_f32 v165, v165, v173
MAA 72,80,12
TR 116,25,13472
s_waitcnt lgkmcnt(7)
MAA 104,88,12
TR 118,25,13984
MAA 104,92,32
buffer_load_dwordx4 v19, s[20:23], s54 offen offset:1024 lds
MAA 100,92,28
TR 120,25,2080
MAA 100,88,8
buffer_load_dwordx4 v20, s[20:23], s54 offen offset:2048 lds
MAA 96,88,4
s_add_u32 s54, s54, 196608
MAA 96,92,24
TR 122,25,2592
v_add_f32 v166, v166, v174
MAA 92,92,20
TR 124,25,14496
s_add_u32 m0, s55, 0
MAA 92,88,0
buffer_load_dwordx4 v21, s[16:19], s52 offen sc1 lds
MAA 124,0,96
TR 126,25,15008
MAA 124,20,100
RD 40,23,18432
MAA 128,24,100
RD 44,23,19456
MAA 128,4,96
buffer_load_dwordx4 v21, s[16:19], s52 offen offset:1024 sc1 lds
MAA 132,8,96
RD 48,23,20736
v_add_f32 v167, v167, v175
MAA 132,28,100
RD 52,23,21760
MAA 136,32,100
RD 56,24,20480
MAA 136,12,96
buffer_load_dword v22, s[16:19], s52 offen offset:2048 sc1 lds
MAA 156,16,96
s_add_u32 s52, s52, 131072
MAA 156,36,100
s_waitcnt vmcnt(17) lgkmcnt(5)
s_barrier
MAA 76,104,0
RD 60,23,27648
s_add_u32 m0, s56, 67584
MAA 76,108,20
buffer_load_dwordx4 v18, s[20:23], s54 offen lds
MAA 80,108,24
RD 64,23,28672
MAA 80,104,4
RD 68,23,29952
MAA 84,104,8
RD 72,23,30976
MAA 84,108,28
buffer_load_dwordx4 v19, s[20:23], s54 offen offset:1024 lds
MAA 88,108,32
RD 76,24,29696
MAA 88,104,12
buffer_load_dwordx4 v20, s[20:23], s54 offen offset:2048 lds
MAA 120,112,12
TR 80,25,24832
s_add_u32 s54, s54, 196608
MAA 120,116,32
TR 82,25,25344
MAA 116,116,28
TR 84,25,37248
s_add_u32 m0, s55, 9216
MAA 116,112,8
buffer_load_dwordx4 v21, s[16:19], s52 offen sc1 lds
MAA 112,112,4
TR 86,25,37760
MAA 112,116,24
TR 88,25,25856
MAA 108,116,20
TR 90,25,26368
MAA 108,112,0
buffer_load_dwordx4 v21, s[16:19], s52 offen offset:1024 sc1 lds
MAA 140,0,120
TR 92,25,38272
MAA 140,20,124
TR 94,25,38784
MAA 144,24,124
TR 96,25,26880
MAA 144,4,120
buffer_load_dword v22, s[16:19], s52 offen offset:2048 sc1 lds
MAA 148,8,120
TR 98,25,27392
s_add_u32 s52, s52, 131072
MAA 148,28,124
buffer_load_dwordx4 v[172:175], v26, s[16:19], s75 offen offset:1024 sc1
MAA 152,32,124
TR 100,25,39296
s_add_u32 s75, s75, 2048
MAA 152,12,120
TR 102,25,39808
MAA 160,16,120
MAA 160,36,124
s_waitcnt vmcnt(21) lgkmcnt(8)
s_barrier
MAA 60,80,40
TR 104,25,24864
MAA 60,84,60
TR 106,25,25376
MAA 64,84,64
TR 108,25,37280
s_add_u32 m0, s56, 80000
MAA 64,80,44
buffer_load_dwordx4 v18, s[20:23], s54 offen lds
MAA 68,80,48
TR 110,25,37792
MAA 68,84,68
TR 112,25,25888
MAA 72,84,72
TR 114,25,26400
MAA 72,80,52
TR 116,25,38304
s_waitcnt lgkmcnt(7)
MAA 104,88,52
TR 118,25,38816
MAA 104,92,72
buffer_load_dwordx4 v19, s[20:23], s54 offen offset:1024 lds
MAA 100,92,68
TR 120,25,26912
MAA 100,88,48
buffer_load_dwordx4 v20, s[20:23], s54 offen offset:2048 lds
MAA 96,88,44
s_add_u32 s54, s54, 196608
MAA 96,92,64
TR 122,25,27424
MAA 92,92,60
TR 124,25,39328
s_add_u32 m0, s55, 18432
MAA 92,88,40
buffer_load_dwordx4 v21, s[16:19], s52 offen sc1 lds
MAA 124,40,96
TR 126,25,39840
MAA 124,60,100
RD 0,23,36864
MAA 128,64,100
RD 4,23,37888
MAA 128,44,96
buffer_load_dwordx4 v21, s[16:19], s52 offen offset:1024 sc1 lds
MAA 132,48,96
RD 8,23,39168
MAA 132,68,100
RD 12,23,40192
MAA 136,72,100
RD 16,24,38912
MAA 136,52,96
buffer_load_dword v22, s[16:19], s52 offen offset:2048 sc1 lds
MAA 156,56,96
s_add_u32 s52, s52, 131072
MAA 156,76,100
s_waitcnt vmcnt(16) lgkmcnt(5)
s_barrier
MAA 76,104,40
RD 20,23,46080
MAA 76,108,60
RD 24,23,47104
MAA 80,108,64
RD 28,23,48384
s_add_u32 m0, s56, 92416
MAA 80,104,44
buffer_load_dwordx4 v18, s[20:23], s54 offen lds
MAA 84,104,48
RD 32,23,49408
MAA 84,108,68
RD 36,24,48128
MAA 88,108,72
TR 80,25,49664
MAA 88,104,52
buffer_load_dwordx4 v19, s[20:23], s54 offen offset:1024 lds
MAA 120,112,52
TR 82,25,50176
MAA 120,116,72
TR 84,25,62080
MAA 116,116,68
TR 86,25,62592
MAA 116,112,48
buffer_load_dwordx4 v20, s[20:23], s54 offen offset:2048 lds
MAA 112,112,44
s_add_u32 s54, s54, 196608
MAA 112,116,64
TR 88,25,50688
MAA 108,116,60
TR 90,25,51200
s_add_u32 m0, s55, 27648
MAA 108,112,40
buffer_load_dwordx4 v21, s[16:19], s52 offen sc1 lds
MAA 140,40,120
TR 92,25,63104
MAA 140,60,124
TR 94,25,63616
MAA 144,64,124
TR 96,25,51712
MAA 144,44,120
buffer_load_dwordx4 v21, s[16:19], s52 offen offset:1024 sc1 lds
MAA 148,48,120
TR 98,25,52224
MAA 148,68,124
TR 100,25,64128
MAA 152,72,124
TR 102,25,64640
MAA 152,52,120
buffer_load_dword v22, s[16:19], s52 offen offset:2048 sc1 lds
MAA 160,56,120
s_add_u32 s52, s52, 131072
s_add_u32 s15, s15, 1
MAA 160,76,124
s_cbranch_scc0 .Lk58
s_waitcnt vmcnt(19) lgkmcnt(8)
s_barrier
MAA 60,80,0
TR 104,25,49696
.Lpad18:
s_cbranch_execz .Lnopoll53r
v_add_f32 v164, v164, v168
MAA 60,84,20
TR 106,25,50208
s_add_u32 m0, s56, 104832
MAA 64,84,24
buffer_load_dwordx4 v18, s[20:23], s54 offen lds
MAA 64,80,4
TR 108,25,62112
v_add_f32 v165, v165, v169
MAA 68,80,8
TR 110,25,62624
v_add_f32 v166, v166, v170
MAA 68,84,28
TR 112,25,50720
v_add_f32 v167, v167, v171
MAA 72,84,32
buffer_load_dwordx4 v19, s[20:23], s54 offen offset:1024 lds
MAA 72,80,12
TR 114,25,51232
s_waitcnt lgkmcnt(6)
MAA 104,88,12
TR 116,25,63136
MAA 104,92,32
TR 118,25,63648
MAA 100,92,28
buffer_load_dwordx4 v20, s[20:23], s54 offen offset:2048 lds
MAA 100,88,8
TR 120,25,51744
s_add_u32 s54, s54, 196608
MAA 96,88,4
TR 122,25,52256
s_add_u32 m0, s55, 36864
MAA 96,92,24
TR 124,25,64160
MAA 92,92,20
buffer_load_dwordx4 v21, s[16:19], s52 offen sc1 lds
MAA 92,88,0
TR 126,25,64672
MAA 124,0,96
ds_read_b128 a[40:43], v23
MAA 124,20,100
RD 44,23,1024
MAA 128,24,100
buffer_load_dwordx4 v21, s[16:19], s52 offen offset:1024 sc1 lds
MAA 128,4,96
RD 48,23,2304
MAA 132,8,96
RD 52,23,3328
MAA 132,28,100
RD 56,24,2048
MAA 136,32,100
buffer_load_dword v22, s[16:19], s52 offen offset:2048 sc1 lds
MAA 136,12,96
s_add_u32 s52, s52, 131072
MAA 156,16,96
MAA 156,36,100
s_waitcnt vmcnt(15) lgkmcnt(5)
s_barrier
MAA 76,104,0
RD 60,23,9216
v_add_f32 v164, v164, v172
MAA 76,108,20
RD 64,23,10240
s_add_u32 m0, s56, 117248
MAA 80,108,24
buffer_load_dwordx4 v18, s[20:23], s54 offen lds
MAA 80,104,4
RD 68,23,11520
v_add_f32 v165, v165, v173
MAA 84,104,8
RD 72,23,12544
v_add_f32 v166, v166, v174
MAA 84,108,28
RD 76,24,11264
v_add_f32 v167, v167, v175
MAA 88,108,32
buffer_load_dwordx4 v19, s[20:23], s54 offen offset:1024 lds
MAA 88,104,12
ds_read_b64_tr_b16 a[80:81], v25
MAA 120,112,12
TR 82,25,512
MAA 120,116,32
TR 84,25,12416
MAA 116,116,28
buffer_load_dwordx4 v20, s[20:23], s54 offen offset:2048 lds
MAA 116,112,8
TR 86,25,12928
s_add_u32 s54, s54, 196608
MAA 112,112,4
TR 88,25,1024
s_add_u32 m0, s55, 46080
MAA 112,116,24
TR 90,25,1536
MAA 108,116,20
buffer_load_dwordx4 v21, s[16:19], s52 offen sc1 lds
MAA 108,112,0
TR 92,25,13440
MAA 140,0,120
TR 94,25,13952
MAA 140,20,124
TR 96,25,2048
MAA 144,24,124
buffer_load_dwordx4 v21, s[16:19], s52 offen offset:1024 sc1 lds
MAA 144,4,120
TR 98,25,2560
MAA 148,8,120
TR 100,25,14464
MAA 148,28,124
TR 102,25,14976
MAA 152,32,124
buffer_load_dword v22, s[16:19], s52 offen offset:2048 sc1 lds
MAA 152,12,120
s_add_u32 s52, s52, 131072
v_permlane32_swap_b32 v164, v166
MAA 160,16,120
v_permlane32_swap_b32 v165, v167
MAA 160,36,124
s_waitcnt vmcnt(18) lgkmcnt(8)
s_barrier
MAA 60,80,40
TR 104,25,32
v_add_f32 v164, v164, v166
MAA 60,84,60
TR 106,25,544
s_add_u32 m0, s56, 129664
MAA 64,84,64
buffer_load_dwordx4 v18, s[20:23], s54 offen lds
MAA 64,80,44
TR 108,25,12448
v_add_f32 v165, v165, v167
MAA 68,80,48
TR 110,25,12960
v_mul_f32 v164, 0xba800000, v164
MAA 68,84,68
buffer_load_dwordx4 v19, s[20:23], s54 offen offset:1024 lds
MAA 72,84,72
TR 112,25,1056
v_mul_f32 v165, 0x3a800000, v165
MAA 72,80,52
TR 114,25,1568
v_fma_f32 v165, -v164, v164, v165
s_waitcnt lgkmcnt(6)
MAA 104,88,52
buffer_load_dwordx4 v20, s[20:23], s54 offen offset:2048 lds
MAA 104,92,72
TR 116,25,13472
s_add_u32 s54, s54, 196608
MAA 100,92,68
TR 118,25,13984
s_add_u32 m0, s59, 58240
MAA 100,88,48
TR 120,25,2080
s_xor_b32 s58, s87, 1966080
MAA 96,88,44
buffer_load_dwordx4 v5, s[24:27], s58 offen lds
MAA 96,92,64
TR 122,25,2592
v_max_f32 v165, 0, v165
MAA 92,92,60
TR 124,25,14496
v_add_f32 v165, 0x3727c5ac, v165
MAA 92,88,40
buffer_load_dwordx4 v6, s[24:27], s58 offen offset:1024 lds
MAA 124,40,96
TR 126,25,15008
s_add_u32 m0, s59, 0
MAA 124,60,100
RD 0,23,18432
s_xor_b32 s58, s87, 1048576
MAA 128,64,100
buffer_load_dwordx4 v5, s[24:27], s58 offen lds
MAA 128,44,96
RD 4,23,19456
MAA 132,48,96
RD 8,23,20736
MAA 132,68,100
buffer_load_dwordx4 v6, s[24:27], s58 offen offset:1024 lds
MAA 136,72,100
RD 12,23,21760
MAA 136,52,96
RD 16,24,20480
MAA 156,56,96
v_rsq_f32 v166, v165
MAA 156,76,100
v_mov_b32 v165, v166
v_mul_f32 v166, 0x3e8293ee, v166
ds_write_b128 v7, v[164:167]
s_waitcnt vmcnt(16) lgkmcnt(6)
s_barrier
MAA 76,104,40
ds_write_b32 v17, v164
MAA 76,108,60
ds_write_b32 v17, v165 offset:1024
s_add_u32 m0, s59, 8320
MAA 80,108,64
RD 20,23,27648
s_xor_b32 s58, s87, 1179648
MAA 80,104,44
buffer_load_dwordx4 v5, s[24:27], s58 offen lds
MAA 84,104,48
RD 24,23,28672
MAA 84,108,68
RD 28,23,29952
MAA 88,108,72
RD 32,23,30976
MAA 88,104,52
buffer_load_dwordx4 v6, s[24:27], s58 offen offset:1024 lds
MAA 120,112,52
RD 36,24,29696
s_add_u32 m0, s59, 66560
MAA 120,116,72
TR 80,25,24832
s_xor_b32 s58, s87, 0
MAA 116,116,68
TR 82,25,25344
MAA 116,112,48
buffer_load_dwordx4 v5, s[24:27], s58 offen lds
MAA 112,112,44
TR 84,25,37248
MAA 112,116,64
TR 86,25,37760
MAA 108,116,60
TR 88,25,25856
MAA 108,112,40
buffer_load_dwordx4 v6, s[24:27], s58 offen offset:1024 lds
MAA 140,40,120
TR 90,25,26368
s_add_u32 m0, s59, 74880
MAA 140,60,124
TR 92,25,38272
s_xor_b32 s58, s87, 131072
MAA 144,64,124
TR 94,25,38784
MAA 144,44,120
buffer_load_dwordx4 v5, s[24:27], s58 offen lds
MAA 148,48,120
TR 96,25,26880
MAA 148,68,124
TR 98,25,27392
MAA 152,72,124
TR 100,25,39296
MAA 152,52,120
buffer_load_dwordx4 v6, s[24:27], s58 offen offset:1024 lds
MAA 160,56,120
TR 102,25,39808
MAA 160,76,124
s_waitcnt vmcnt(10) lgkmcnt(0)
s_barrier
MAA 104,88,12
TR 112,25,25888
s_add_u32 m0, s59, 83200
MAA 104,92,32
TR 114,25,26400
s_xor_b32 s58, s87, 262144
MAA 100,92,28
buffer_load_dwordx4 v5, s[24:27], s58 offen lds
MAA 100,88,8
TR 116,25,38304
MAA 96,88,4
TR 118,25,38816
MAA 96,92,24
TR 120,25,26912
MAA 92,92,20
buffer_load_dwordx4 v6, s[24:27], s58 offen offset:1024 lds
MAA 92,88,0
TR 122,25,27424
s_add_u32 m0, s59, 16640
MAA 156,16,96
TR 124,25,39328
s_xor_b32 s58, s87, 1310720
MAA 156,36,100
TR 126,25,39840
MAA 72,84,32
buffer_load_dwordx4 v5, s[24:27], s58 offen lds
MAA 72,80,12
TR 104,25,24864
MAA 68,80,8
TR 106,25,25376
MAA 68,84,28
TR 108,25,37280
MAA 64,84,24
buffer_load_dwordx4 v6, s[24:27], s58 offen offset:1024 lds
MAA 64,80,4
TR 110,25,37792
s_add_u32 m0, s59, 24960
MAA 60,80,0
RD 40,23,36864
s_xor_b32 s58, s87, 1441792
MAA 60,84,20
RD 44,23,37888
s_waitcnt lgkmcnt(12)
MAA 120,112,12
buffer_load_dwordx4 v5, s[24:27], s58 offen lds
s_waitcnt lgkmcnt(10)
MAA 120,116,32
RD 48,23,39168
MAA 116,116,28
RD 52,23,40192
MAA 116,112,8
RD 56,24,38912
MAA 112,112,4
buffer_load_dwordx4 v6, s[24:27], s58 offen offset:1024 lds
MAA 112,116,24
s_waitcnt lgkmcnt(5)
s_barrier
RD 60,23,46080
MAA 108,116,20
RD 64,23,47104
s_add_u32 m0, s59, 91520
MAA 108,112,0
RD 68,23,48384
s_xor_b32 s58, s87, 393216
MAA 160,16,120
RD 72,23,49408
MAA 160,36,124
RD 76,24,48128
MAA 88,108,32
TR 144,25,50688
MAA 88,104,12
TR 146,25,51200
MAA 84,104,8
TR 148,25,63104
MAA 84,108,28
TR 150,25,63616
MAA 80,108,24
TR 152,25,50720
MAA 80,104,4
TR 154,25,51232
MAA 76,104,0
TR 156,25,63136
MAA 76,108,20
TR 158,25,63648
TR 160,25,51712
TR 162,25,52224
TR 164,25,64128
s_waitcnt lgkmcnt(9)
MAA 104,144,52
TR 166,25,64640
TR 168,25,51744
TR 170,25,52256
s_waitcnt lgkmcnt(10)
MAA 104,148,72
TR 172,25,64160
MAA 100,148,68
TR 174,25,64672
MAA 100,144,48
TR 136,25,49696
MAA 96,144,44
TR 138,25,50208
MAA 96,148,64
TR 140,25,62112
MAA 92,148,60
TR 142,25,62624
MAA 92,144,40
TR 128,25,49664
s_waitcnt lgkmcnt(15)
MAA 120,152,52
TR 130,25,50176
s_waitcnt lgkmcnt(14)
MAA 120,156,72
TR 132,25,62080
MAA 116,156,68
TR 134,25,62592
MAA 116,152,48
ds_read_b128 v[232:235], v10 offset:1792
MAA 112,152,44
ds_read_b128 v[228:231], v10 offset:1536
MAA 112,156,64
ds_read_b128 v[224:227], v10 offset:1280
MAA 108,156,60
ds_read_b128 v[220:223], v10 offset:1024
MAA 108,152,40
buffer_load_dwordx4 v5, s[24:27], s58 offen lds
s_waitcnt lgkmcnt(15)
MAA 156,56,160
ds_read_b128 v[240:243], v11 offset:704
MAA 156,76,164
ds_read_b128 v[244:247], v11 offset:1728
s_waitcnt lgkmcnt(14)
MAA 160,76,172
s_waitcnt lgkmcnt(6)
s_barrier
ds_read_b128 v[18:21], v11 offset:448
MAA 160,56,168
buffer_load_dwordx4 v6, s[24:27], s58 offen offset:1024 lds
MAA 88,136,52
ds_read_b128 v[22:25], v11 offset:1472
s_add_u32 m0, s59, 99840
MAA 88,140,72
s_xor_b32 s58, s87, 524288
MAA 84,140,68
MAA 84,136,48
buffer_load_dwordx4 v5, s[24:27], s58 offen lds
MAA 80,136,44
MAA 80,140,64
MAA 76,140,60
MAA 76,136,40
buffer_load_dwordx4 v6, s[24:27], s58 offen offset:1024 lds
MAA 72,128,52
s_add_u32 m0, s59, 108160
s_xor_b32 s58, s87, 655360
MAA 72,132,72
MAA 68,132,68
MAA 68,128,48
buffer_load_dwordx4 v5, s[24:27], s58 offen lds
MAA 64,128,44
MAA 64,132,64
MAA 60,132,60
MAA 60,128,40
buffer_load_dwordx4 v6, s[24:27], s58 offen offset:1024 lds
s_waitcnt lgkmcnt(3)
v_pk_fma_f32 v[156:157], v[240:241], v[44:45], v[156:157] op_sel_hi:[1,0,1]
s_waitcnt lgkmcnt(2)
v_pk_mul_f32 v[156:157], v[156:157], v[244:245]
v_cvt_pk_bf16_f32 v236, v156, v157
v_pk_fma_f32 v[158:159], v[242:243], v[44:45], v[158:159] op_sel_hi:[1,0,1]
v_pk_mul_f32 v[158:159], v[158:159], v[246:247]
v_cvt_pk_bf16_f32 v237, v158, v159
v_pk_fma_f32 v[160:161], v[240:241], v[44:45], v[160:161] op_sel:[0,1,0] op_sel_hi:[1,1,1]
v_pk_mul_f32 v[160:161], v[160:161], v[244:245]
v_cvt_pk_bf16_f32 v238, v160, v161
v_pk_fma_f32 v[162:163], v[242:243], v[44:45], v[162:163] op_sel:[0,1,0] op_sel_hi:[1,1,1]
v_pk_mul_f32 v[162:163], v[162:163], v[246:247]
v_cvt_pk_bf16_f32 v239, v162, v163
ds_write_b128 v8, v[236:239] offset:1024
v_pk_fma_f32 v[104:105], v[36:37], v[232:233], v[104:105] op_sel_hi:[1,0,1]
v_pk_mul_f32 v[104:105], v[104:105], v[232:233] op_sel:[0,1] op_sel_hi:[1,1]
v_cvt_pk_bf16_f32 v196, v104, v105
v_pk_fma_f32 v[106:107], v[38:39], v[232:233], v[106:107] op_sel_hi:[1,0,1]
v_pk_mul_f32 v[106:107], v[106:107], v[232:233] op_sel:[0,1] op_sel_hi:[1,1]
v_cvt_pk_bf16_f32 v197, v106, v107
v_pk_fma_f32 v[120:121], v[40:41], v[232:233], v[120:121] op_sel_hi:[1,0,1]
v_pk_mul_f32 v[120:121], v[120:121], v[232:233] op_sel:[0,1] op_sel_hi:[1,1]
v_cvt_pk_bf16_f32 v198, v120, v121
v_pk_fma_f32 v[122:123], v[42:43], v[232:233], v[122:123] op_sel_hi:[1,0,1]
v_pk_mul_f32 v[122:123], v[122:123], v[232:233] op_sel:[0,1] op_sel_hi:[1,1]
v_cvt_pk_bf16_f32 v199, v122, v123
v_pk_fma_f32 v[100:101], v[36:37], v[228:229], v[100:101] op_sel_hi:[1,0,1]
v_pk_mul_f32 v[100:101], v[100:101], v[228:229] op_sel:[0,1] op_sel_hi:[1,1]
v_cvt_pk_bf16_f32 v192, v100, v101
v_pk_fma_f32 v[102:103], v[38:39], v[228:229], v[102:103] op_sel_hi:[1,0,1]
v_pk_mul_f32 v[102:103], v[102:103], v[228:229] op_sel:[0,1] op_sel_hi:[1,1]
v_cvt_pk_bf16_f32 v193, v102, v103
v_pk_fma_f32 v[116:117], v[40:41], v[228:229], v[116:117] op_sel_hi:[1,0,1]
v_pk_mul_f32 v[116:117], v[116:117], v[228:229] op_sel:[0,1] op_sel_hi:[1,1]
v_cvt_pk_bf16_f32 v194, v116, v117
v_pk_fma_f32 v[118:119], v[42:43], v[228:229], v[118:119] op_sel_hi:[1,0,1]
v_pk_mul_f32 v[118:119], v[118:119], v[228:229] op_sel:[0,1] op_sel_hi:[1,1]
v_cvt_pk_bf16_f32 v195, v118, v119
v_pk_fma_f32 v[96:97], v[36:37], v[224:225], v[96:97] op_sel_hi:[1,0,1]
v_pk_mul_f32 v[96:97], v[96:97], v[224:225] op_sel:[0,1] op_sel_hi:[1,1]
v_cvt_pk_bf16_f32 v188, v96, v97
v_pk_fma_f32 v[98:99], v[38:39], v[224:225], v[98:99] op_sel_hi:[1,0,1]
v_pk_mul_f32 v[98:99], v[98:99], v[224:225] op_sel:[0,1] op_sel_hi:[1,1]
v_cvt_pk_bf16_f32 v189, v98, v99
v_pk_fma_f32 v[112:113], v[40:41], v[224:225], v[112:113] op_sel_hi:[1,0,1]
v_pk_mul_f32 v[112:113], v[112:113], v[224:225] op_sel:[0,1] op_sel_hi:[1,1]
v_cvt_pk_bf16_f32 v190, v112, v113
v_pk_fma_f32 v[114:115], v[42:43], v[224:225], v[114:115] op_sel_hi:[1,0,1]
v_pk_mul_f32 v[114:115], v[114:115], v[224:225] op_sel:[0,1] op_sel_hi:[1,1]
v_cvt_pk_bf16_f32 v191, v114, v115
v_pk_fma_f32 v[92:93], v[36:37], v[220:221], v[92:93] op_sel_hi:[1,0,1]
v_pk_mul_f32 v[92:93], v[92:93], v[220:221] op_sel:[0,1] op_sel_hi:[1,1]
v_cvt_pk_bf16_f32 v184, v92, v93
v_pk_fma_f32 v[94:95], v[38:39], v[220:221], v[94:95] op_sel_hi:[1,0,1]
v_pk_mul_f32 v[94:95], v[94:95], v[220:221] op_sel:[0,1] op_sel_hi:[1,1]
v_cvt_pk_bf16_f32 v185, v94, v95
v_pk_fma_f32 v[108:109], v[40:41], v[220:221], v[108:109] op_sel_hi:[1,0,1]
v_pk_mul_f32 v[108:109], v[108:109], v[220:221] op_sel:[0,1] op_sel_hi:[1,1]
v_cvt_pk_bf16_f32 v186, v108, v109
v_pk_fma_f32 v[110:111], v[42:43], v[220:221], v[110:111] op_sel_hi:[1,0,1]
v_pk_mul_f32 v[110:111], v[110:111], v[220:221] op_sel:[0,1] op_sel_hi:[1,1]
v_cvt_pk_bf16_f32 v187, v110, v111
v_pk_fma_f32 v[72:73], v[28:29], v[232:233], v[72:73] op_sel_hi:[1,0,1]
v_cvt_pk_bf16_f32 v176, v72, v73
v_pk_fma_f32 v[74:75], v[30:31], v[232:233], v[74:75] op_sel_hi:[1,0,1]
v_cvt_pk_bf16_f32 v177, v74, v75
v_pk_fma_f32 v[88:89], v[32:33], v[232:233], v[88:89] op_sel_hi:[1,0,1]
v_cvt_pk_bf16_f32 v178, v88, v89
v_pk_fma_f32 v[90:91], v[34:35], v[232:233], v[90:91] op_sel_hi:[1,0,1]
v_cvt_pk_bf16_f32 v179, v90, v91
v_pk_fma_f32 v[68:69], v[28:29], v[228:229], v[68:69] op_sel_hi:[1,0,1]
v_cvt_pk_bf16_f32 v172, v68, v69
v_pk_fma_f32 v[70:71], v[30:31], v[228:229], v[70:71] op_sel_hi:[1,0,1]
v_cvt_pk_bf16_f32 v173, v70, v71
v_pk_fma_f32 v[84:85], v[32:33], v[228:229], v[84:85] op_sel_hi:[1,0,1]
v_cvt_pk_bf16_f32 v174, v84, v85
v_pk_fma_f32 v[86:87], v[34:35], v[228:229], v[86:87] op_sel_hi:[1,0,1]
v_cvt_pk_bf16_f32 v175, v86, v87
v_pk_fma_f32 v[64:65], v[28:29], v[224:225], v[64:65] op_sel_hi:[1,0,1]
v_cvt_pk_bf16_f32 v168, v64, v65
v_pk_fma_f32 v[66:67], v[30:31], v[224:225], v[66:67] op_sel_hi:[1,0,1]
v_cvt_pk_bf16_f32 v169, v66, v67
v_pk_fma_f32 v[80:81], v[32:33], v[224:225], v[80:81] op_sel_hi:[1,0,1]
v_cvt_pk_bf16_f32 v170, v80, v81
v_pk_fma_f32 v[82:83], v[34:35], v[224:225], v[82:83] op_sel_hi:[1,0,1]
v_cvt_pk_bf16_f32 v171, v82, v83
v_pk_fma_f32 v[60:61], v[28:29], v[220:221], v[60:61] op_sel_hi:[1,0,1]
v_cvt_pk_bf16_f32 v164, v60, v61
v_pk_fma_f32 v[62:63], v[30:31], v[220:221], v[62:63] op_sel_hi:[1,0,1]
v_cvt_pk_bf16_f32 v165, v62, v63
v_pk_fma_f32 v[76:77], v[32:33], v[220:221], v[76:77] op_sel_hi:[1,0,1]
v_cvt_pk_bf16_f32 v166, v76, v77
v_pk_fma_f32 v[78:79], v[34:35], v[220:221], v[78:79] op_sel_hi:[1,0,1]
s_waitcnt lgkmcnt(0)
s_barrier
v_cvt_pk_bf16_f32 v167, v78, v79
v_mfma_f32_16x16x32_bf16 v[120:123], v[196:199], v[176:179], v[50:53]
ds_read_b128 v[180:183], v9
s_add_u32 m0, s59, 33280
v_mfma_f32_16x16x32_bf16 v[104:107], v[192:195], v[176:179], v[46:49]
ds_read_b64 v[200:201], v9 offset:1024
s_xor_b32 s58, s87, 1572864
v_mfma_f32_16x16x32_bf16 v[116:119], v[192:195], v[172:175], v[50:53]
buffer_load_dwordx4 v5, s[24:27], s58 offen lds
v_mfma_f32_16x16x32_bf16 v[100:103], v[188:191], v[172:175], v[46:49]
ds_read_b64 v[210:211], v9 offset:1032
v_mfma_f32_16x16x32_bf16 v[112:115], v[188:191], v[168:171], v[50:53]
ds_read_b128 v[240:243], v11 offset:384
v_max3_f32 v88, v104, v105, v106
v_mfma_f32_16x16x32_bf16 v[96:99], v[184:187], v[168:171], v[46:49]
ds_read_b128 v[244:247], v11 offset:1408
v_max3_f32 v89, v107, v120, v121
v_mfma_f32_16x16x32_bf16 v[108:111], v[184:187], v[164:167], v[50:53]
buffer_load_dwordx4 v6, s[24:27], s58 offen offset:1024 lds
v_max3_f32 v88, v88, v122, v123
v_max_f32 v90, v88, v89
v_max_f32 v89, v88, v89
v_max3_f32 v84, v100, v101, v102
v_max3_f32 v85, v103, v116, v117
s_waitcnt lgkmcnt(4)
v_mfma_f32_16x16x32_bf16 v[92:95], v[180:183], v[164:167], v[46:49]
ds_read_b128 v[28:31], v11 offset:320
s_add_u32 m0, s59, 41600
.Lpad19:
s_cbranch_execz .Lnopoll53r
MAA 136,12,96
ds_read_b128 v[32:35], v11 offset:1344
s_xor_b32 s58, s87, 1703936
MAA 136,32,100
buffer_load_dwordx4 v5, s[24:27], s58 offen lds
MAA 136,52,160
ds_read_b128 v[36:39], v11 offset:256
v_permlane16_swap_b32 v90, v89
MAA 136,72,164
ds_read_b128 v[40:43], v11 offset:1280
v_max_f32 v88, v90, v89
MAA 152,72,172
v_max_f32 v89, v90, v89
v_max3_f32 v84, v84, v118, v119
MAA 152,52,168
buffer_load_dwordx4 v6, s[24:27], s58 offen offset:1024 lds
MAA 152,32,124
s_add_u32 m0, s59, 49920
s_xor_b32 s58, s87, 1835008
v_permlane32_swap_b32 v88, v89
MAA 152,12,120
v_max_f32 v88, v88, v89
v_mul_f32 v88, v88, v234
v_max_f32 v86, v84, v85
v_max_f32 v85, v84, v85
v_max3_f32 v80, v96, v97, v98
v_max3_f32 v81, v99, v112, v113
v_permlane16_swap_b32 v86, v85
v_max3_f32 v80, v80, v114, v115
v_max_f32 v84, v86, v85
v_max_f32 v85, v86, v85
v_max_f32 v82, v80, v81
v_max_f32 v81, v80, v81
v_permlane32_swap_b32 v84, v85
v_max3_f32 v76, v92, v93, v94
v_max_f32 v84, v84, v85
v_mul_f32 v84, v84, v230
v_permlane16_swap_b32 v82, v81
v_max3_f32 v77, v95, v108, v109
v_max_f32 v80, v82, v81
v_max_f32 v81, v82, v81
v_max3_f32 v76, v76, v110, v111
v_max_f32 v78, v76, v77
v_permlane32_swap_b32 v80, v81
v_max_f32 v77, v76, v77
v_max_f32 v80, v80, v81
v_mul_f32 v80, v80, v226
v_permlane16_swap_b32 v78, v77
v_pk_fma_f32 v[104:105], v[104:105], v[234:235], v[88:89] op_sel_hi:[1,0,0] neg_lo:[0,0,1] neg_hi:[0,0,1]
v_max_f32 v76, v78, v77
v_max_f32 v77, v78, v77
v_pk_fma_f32 v[106:107], v[106:107], v[234:235], v[88:89] op_sel_hi:[1,0,0] neg_lo:[0,0,1] neg_hi:[0,0,1]
v_pk_fma_f32 v[120:121], v[120:121], v[234:235], v[88:89] op_sel_hi:[1,0,0] neg_lo:[0,0,1] neg_hi:[0,0,1]
v_permlane32_swap_b32 v76, v77
v_pk_fma_f32 v[122:123], v[122:123], v[234:235], v[88:89] op_sel_hi:[1,0,0] neg_lo:[0,0,1] neg_hi:[0,0,1]
v_max_f32 v76, v76, v77
v_mul_f32 v76, v76, v222
v_pk_fma_f32 v[100:101], v[100:101], v[230:231], v[84:85] op_sel_hi:[1,0,0] neg_lo:[0,0,1] neg_hi:[0,0,1]
v_pk_fma_f32 v[102:103], v[102:103], v[230:231], v[84:85] op_sel_hi:[1,0,0] neg_lo:[0,0,1] neg_hi:[0,0,1]
v_pk_fma_f32 v[116:117], v[116:117], v[230:231], v[84:85] op_sel_hi:[1,0,0] neg_lo:[0,0,1] neg_hi:[0,0,1]
v_pk_fma_f32 v[118:119], v[118:119], v[230:231], v[84:85] op_sel_hi:[1,0,0] neg_lo:[0,0,1] neg_hi:[0,0,1]
v_pk_fma_f32 v[96:97], v[96:97], v[226:227], v[80:81] op_sel_hi:[1,0,0] neg_lo:[0,0,1] neg_hi:[0,0,1]
v_pk_fma_f32 v[98:99], v[98:99], v[226:227], v[80:81] op_sel_hi:[1,0,0] neg_lo:[0,0,1] neg_hi:[0,0,1]
v_pk_fma_f32 v[112:113], v[112:113], v[226:227], v[80:81] op_sel_hi:[1,0,0] neg_lo:[0,0,1] neg_hi:[0,0,1]
v_pk_fma_f32 v[114:115], v[114:115], v[226:227], v[80:81] op_sel_hi:[1,0,0] neg_lo:[0,0,1] neg_hi:[0,0,1]
v_pk_fma_f32 v[92:93], v[92:93], v[222:223], v[76:77] op_sel_hi:[1,0,0] neg_lo:[0,0,1] neg_hi:[0,0,1]
v_pk_fma_f32 v[94:95], v[94:95], v[222:223], v[76:77] op_sel_hi:[1,0,0] neg_lo:[0,0,1] neg_hi:[0,0,1]
v_pk_fma_f32 v[108:109], v[108:109], v[222:223], v[76:77] op_sel_hi:[1,0,0] neg_lo:[0,0,1] neg_hi:[0,0,1]
v_pk_fma_f32 v[110:111], v[110:111], v[222:223], v[76:77] op_sel_hi:[1,0,0] neg_lo:[0,0,1] neg_hi:[0,0,1]
v_pk_fma_f32 v[136:137], v[18:19], v[44:45], v[136:137] op_sel_hi:[1,0,1]
v_pk_mul_f32 v[136:137], v[136:137], v[22:23]
v_pk_fma_f32 v[138:139], v[20:21], v[44:45], v[138:139] op_sel_hi:[1,0,1]
v_pk_mul_f32 v[138:139], v[138:139], v[24:25]
v_pk_fma_f32 v[152:153], v[18:19], v[44:45], v[152:153] op_sel:[0,1,0] op_sel_hi:[1,1,1]
v_pk_mul_f32 v[152:153], v[152:153], v[22:23]
v_pk_fma_f32 v[154:155], v[20:21], v[44:45], v[154:155] op_sel:[0,1,0] op_sel_hi:[1,1,1]
v_pk_mul_f32 v[154:155], v[154:155], v[24:25]
v_exp_f32 v104, v104
s_nop 0
MAA 132,8,96
buffer_load_dwordx4 v5, s[24:27], s58 offen lds
MAA 132,28,100
v_exp_f32 v105, v105
MAA 132,48,160
v_exp_f32 v106, v106
MAA 132,68,164
v_exp_f32 v107, v107
MAA 148,68,172
buffer_load_dwordx4 v6, s[24:27], s58 offen offset:1024 lds
MAA 148,48,168
s_add_u32 m0, s59, 116480
s_xor_b32 s58, s87, 786432
v_exp_f32 v120, v120
MAA 148,28,124
v_exp_f32 v121, v121
MAA 148,8,120
v_exp_f32 v122, v122
MAA 128,4,96
buffer_load_dwordx4 v5, s[24:27], s58 offen lds
MAA 128,24,100
v_exp_f32 v123, v123
MAA 128,44,160
v_exp_f32 v100, v100
MAA 128,64,164
v_exp_f32 v101, v101
MAA 144,64,172
buffer_load_dwordx4 v6, s[24:27], s58 offen offset:1024 lds
MAA 144,44,168
s_add_u32 m0, s59, 124800
s_xor_b32 s58, s87, 917504
v_exp_f32 v102, v102
MAA 144,24,124
v_exp_f32 v103, v103
MAA 144,4,120
v_exp_f32 v116, v116
MAA 124,0,96
buffer_load_dwordx4 v5, s[24:27], s58 offen lds
MAA 124,20,100
v_exp_f32 v117, v117
MAA 124,40,160
v_exp_f32 v118, v118
MAA 124,60,164
v_exp_f32 v119, v119
MAA 140,60,172
buffer_load_dwordx4 v6, s[24:27], s58 offen offset:1024 lds
MAA 140,40,168
v_exp_f32 v96, v96
MAA 140,20,124
v_exp_f32 v97, v97
MAA 140,0,120
v_cvt_pk_bf16_f32 v72, v104, v105
v_cvt_pk_bf16_f32 v73, v106, v107
v_cvt_pk_bf16_f32 v74, v120, v121
v_cvt_pk_bf16_f32 v75, v122, v123
v_cvt_pk_bf16_f32 v68, v100, v101
v_cvt_pk_bf16_f32 v69, v102, v103
v_cvt_pk_bf16_f32 v70, v116, v117
v_cvt_pk_bf16_f32 v71, v118, v119
v_exp_f32 v98, v98
v_exp_f32 v99, v99
v_exp_f32 v112, v112
v_exp_f32 v113, v113
v_exp_f32 v114, v114
v_exp_f32 v115, v115
v_cvt_pk_bf16_f32 v64, v96, v97
v_cvt_pk_bf16_f32 v65, v98, v99
v_cvt_pk_bf16_f32 v66, v112, v113
v_cvt_pk_bf16_f32 v67, v114, v115
v_cvt_pk_bf16_f32 v208, v136, v137
v_cvt_pk_bf16_f32 v209, v138, v139
v_cvt_pk_bf16_f32 v218, v152, v153
v_cvt_pk_bf16_f32 v219, v154, v155
s_waitcnt lgkmcnt(5)
v_pk_fma_f32 v[132:133], v[240:241], v[44:45], v[132:133] op_sel_hi:[1,0,1]
s_waitcnt lgkmcnt(4)
v_pk_mul_f32 v[132:133], v[132:133], v[244:245]
v_cvt_pk_bf16_f32 v206, v132, v133
v_pk_fma_f32 v[134:135], v[242:243], v[44:45], v[134:135] op_sel_hi:[1,0,1]
v_pk_mul_f32 v[134:135], v[134:135], v[246:247]
v_cvt_pk_bf16_f32 v207, v134, v135
v_pk_fma_f32 v[148:149], v[240:241], v[44:45], v[148:149] op_sel:[0,1,0] op_sel_hi:[1,1,1]
v_pk_mul_f32 v[148:149], v[148:149], v[244:245]
v_cvt_pk_bf16_f32 v216, v148, v149
v_pk_fma_f32 v[150:151], v[242:243], v[44:45], v[150:151] op_sel:[0,1,0] op_sel_hi:[1,1,1]
v_pk_mul_f32 v[150:151], v[150:151], v[246:247]
v_cvt_pk_bf16_f32 v217, v150, v151
s_waitcnt lgkmcnt(3)
v_pk_fma_f32 v[128:129], v[28:29], v[44:45], v[128:129] op_sel_hi:[1,0,1]
s_waitcnt lgkmcnt(2)
v_pk_mul_f32 v[128:129], v[128:129], v[32:33]
v_cvt_pk_bf16_f32 v204, v128, v129
v_pk_fma_f32 v[130:131], v[30:31], v[44:45], v[130:131] op_sel_hi:[1,0,1]
v_pk_mul_f32 v[130:131], v[130:131], v[34:35]
v_cvt_pk_bf16_f32 v205, v130, v131
v_pk_fma_f32 v[144:145], v[28:29], v[44:45], v[144:145] op_sel:[0,1,0] op_sel_hi:[1,1,1]
v_pk_mul_f32 v[144:145], v[144:145], v[32:33]
v_cvt_pk_bf16_f32 v214, v144, v145
v_pk_fma_f32 v[146:147], v[30:31], v[44:45], v[146:147] op_sel:[0,1,0] op_sel_hi:[1,1,1]
v_pk_mul_f32 v[146:147], v[146:147], v[34:35]
v_cvt_pk_bf16_f32 v215, v146, v147
s_waitcnt lgkmcnt(1)
v_pk_fma_f32 v[124:125], v[36:37], v[44:45], v[124:125] op_sel_hi:[1,0,1]
s_waitcnt lgkmcnt(0)
v_pk_mul_f32 v[124:125], v[124:125], v[40:41]
v_cvt_pk_bf16_f32 v202, v124, v125
v_pk_fma_f32 v[126:127], v[38:39], v[44:45], v[126:127] op_sel_hi:[1,0,1]
v_pk_mul_f32 v[126:127], v[126:127], v[42:43]
v_cvt_pk_bf16_f32 v203, v126, v127
v_pk_fma_f32 v[140:141], v[36:37], v[44:45], v[140:141] op_sel:[0,1,0] op_sel_hi:[1,1,1]
v_pk_mul_f32 v[140:141], v[140:141], v[40:41]
v_cvt_pk_bf16_f32 v212, v140, v141
v_pk_fma_f32 v[142:143], v[38:39], v[44:45], v[142:143] op_sel:[0,1,0] op_sel_hi:[1,1,1]
v_pk_mul_f32 v[142:143], v[142:143], v[42:43]
v_cvt_pk_bf16_f32 v213, v142, v143
s_nop 0
v_mfma_f32_16x16x32_bf16 v[88:91], v[248:251], v[72:75], 0
v_exp_f32 v92, v92
v_mfma_f32_16x16x32_bf16 v[104:107], v[206:209], v[72:75], 0
v_exp_f32 v93, v93
v_mfma_f32_16x16x32_bf16 v[120:123], v[216:219], v[72:75], 0
v_exp_f32 v94, v94
v_mfma_f32_16x16x32_bf16 v[84:87], v[248:251], v[68:71], 0
v_exp_f32 v95, v95
v_mfma_f32_16x16x32_bf16 v[100:103], v[204:207], v[68:71], 0
v_exp_f32 v108, v108
v_mfma_f32_16x16x32_bf16 v[116:119], v[214:217], v[68:71], 0
v_exp_f32 v109, v109
v_mfma_f32_16x16x32_bf16 v[80:83], v[248:251], v[64:67], 0
v_exp_f32 v110, v110
v_mfma_f32_16x16x32_bf16 v[96:99], v[202:205], v[64:67], 0
v_exp_f32 v111, v111
v_mfma_f32_16x16x32_bf16 v[112:115], v[212:215], v[64:67], 0
v_cvt_pk_bf16_f32 v60, v92, v93
v_cvt_pk_bf16_f32 v61, v94, v95
v_cvt_pk_bf16_f32 v62, v108, v109
v_cvt_pk_bf16_f32 v63, v110, v111
v_rcp_f32 v88, v88
v_rcp_f32 v84, v84
v_mfma_f32_16x16x32_bf16 v[76:79], v[248:251], v[60:63], 0
v_rcp_f32 v80, v80
v_mfma_f32_16x16x32_bf16 v[92:95], v[200:203], v[60:63], 0
v_mfma_f32_16x16x32_bf16 v[108:111], v[210:213], v[60:63], 0
s_nop 4
v_rcp_f32 v76, v76
v_pk_mul_f32 v[104:105], v[104:105], v[88:89] op_sel_hi:[1,0]
v_pk_mul_f32 v[106:107], v[106:107], v[88:89] op_sel_hi:[1,0]
v_pk_mul_f32 v[120:121], v[120:121], v[88:89] op_sel_hi:[1,0]
v_pk_mul_f32 v[122:123], v[122:123], v[88:89] op_sel_hi:[1,0]
v_cvt_pk_bf16_f32 v176, v104, v105
v_cvt_pk_bf16_f32 v177, v106, v107
v_cvt_pk_bf16_f32 v178, v120, v121
v_cvt_pk_bf16_f32 v179, v122, v123
buffer_store_dwordx4 v[176:179], v4, s[16:19], s74 offen offset:3072 sc1
v_pk_mul_f32 v[100:101], v[100:101], v[84:85] op_sel_hi:[1,0]
v_pk_mul_f32 v[102:103], v[102:103], v[84:85] op_sel_hi:[1,0]
v_pk_mul_f32 v[116:117], v[116:117], v[84:85] op_sel_hi:[1,0]
v_pk_mul_f32 v[118:119], v[118:119], v[84:85] op_sel_hi:[1,0]
v_cvt_pk_bf16_f32 v172, v100, v101
v_cvt_pk_bf16_f32 v173, v102, v103
v_cvt_pk_bf16_f32 v174, v116, v117
v_cvt_pk_bf16_f32 v175, v118, v119
buffer_store_dwordx4 v[172:175], v4, s[16:19], s74 offen offset:2048 sc1
v_pk_mul_f32 v[96:97], v[96:97], v[80:81] op_sel_hi:[1,0]
v_pk_mul_f32 v[98:99], v[98:99], v[80:81] op_sel_hi:[1,0]
v_pk_mul_f32 v[112:113], v[112:113], v[80:81] op_sel_hi:[1,0]
v_pk_mul_f32 v[114:115], v[114:115], v[80:81] op_sel_hi:[1,0]
v_cvt_pk_bf16_f32 v168, v96, v97
v_cvt_pk_bf16_f32 v169, v98, v99
v_cvt_pk_bf16_f32 v170, v112, v113
v_cvt_pk_bf16_f32 v171, v114, v115
buffer_store_dwordx4 v[168:171], v4, s[16:19], s74 offen offset:1024 sc1
v_pk_mul_f32 v[92:93], v[92:93], v[76:77] op_sel_hi:[1,0]
v_pk_mul_f32 v[94:95], v[94:95], v[76:77] op_sel_hi:[1,0]
v_pk_mul_f32 v[108:109], v[108:109], v[76:77] op_sel_hi:[1,0]
v_pk_mul_f32 v[110:111], v[110:111], v[76:77] op_sel_hi:[1,0]
v_cvt_pk_bf16_f32 v164, v92, v93
v_cvt_pk_bf16_f32 v165, v94, v95
v_cvt_pk_bf16_f32 v166, v108, v109
v_cvt_pk_bf16_f32 v167, v110, v111
buffer_store_dwordx4 v[164:167], v4, s[16:19], s74 offen sc1
s_nop 1
.Lqkve56:
.Lpad20:
s_cbranch_execz .Lnopoll53r
s_lshl_b32 s62, s3, 11
s_add_u32 s62, s62, s84
v_lshl_add_u32 v4, v1, 4, s62
v_lshrrev_b32 v2, 3, v1
v_cmp_eq_u32 vcc, 3, v2
v_add_u32 v2, 67108480, v4
s_nop 0
v_cndmask_b32 v4, v4, v2, vcc
v_bfe_u32 v5, v1, 3, 1
v_lshrrev_b32 v2, 4, v1
v_lshl_add_u32 v5, v2, 3, v5
s_lshl_b32 s62, s3, 1
v_add_u32 v5, s62, v5
v_mul_u32_u24 v5, 2048, v5
v_and_b32 v2, 7, v1
v_lshl_add_u32 v5, v2, 4, v5
s_lshl_b32 s62, s7, 7
v_add_u32 v5, s62, v5
v_add_u32 v6, 64512, v5
v_bfe_u32 v8, v1, 3, 2
v_mul_u32_u24 v8, 2080, v8
v_bfe_u32 v2, v1, 2, 1
v_lshl_add_u32 v8, v2, 7, v8
v_bfe_u32 v2, v1, 5, 1
v_lshl_add_u32 v8, v2, 8, v8
v_and_b32 v2, 3, v1
v_lshl_add_u32 v8, v2, 3, v8
s_mov_b32 s57, 66560
v_add_u32 v7, s57, v8
s_lshr_b32 s54, s87, 17
s_lshl_b32 s54, s54, 18
s_add_u32 s54, s54, 37748736
s_mov_b32 s52, s54
s_add_u32 s53, s54, 131072
v_accvgpr_read_b32 v32, a224
v_accvgpr_read_b32 v33, a225
v_accvgpr_read_b32 v34, a226
v_accvgpr_read_b32 v35, a227
v_accvgpr_read_b32 v36, a228
v_accvgpr_read_b32 v37, a229
v_accvgpr_read_b32 v38, a230
v_accvgpr_read_b32 v39, a231
v_accvgpr_read_b32 v40, a232
v_accvgpr_read_b32 v41, a233
v_accvgpr_read_b32 v42, a234
v_accvgpr_read_b32 v43, a235
v_accvgpr_read_b32 v44, a236
v_accvgpr_read_b32 v45, a237
v_accvgpr_read_b32 v46, a238
v_accvgpr_read_b32 v47, a239
v_accvgpr_read_b32 v48, a240
v_accvgpr_read_b32 v49, a241
v_accvgpr_read_b32 v50, a242
v_accvgpr_read_b32 v51, a243
v_accvgpr_read_b32 v52, a244
v_accvgpr_read_b32 v53, a245
v_accvgpr_read_b32 v54, a246
v_accvgpr_read_b32 v55, a247
v_accvgpr_read_b32 v56, a248
v_accvgpr_read_b32 v57, a249
v_accvgpr_read_b32 v58, a250
v_accvgpr_read_b32 v59, a251
v_accvgpr_read_b32 v60, a252
v_accvgpr_read_b32 v61, a253
v_accvgpr_read_b32 v62, a254
v_accvgpr_read_b32 v63, a255
s_lshl_b32 s62, s49, 3
s_add_u32 s62, s62, s48
s_mul_i32 s62, s62, 28672
s_add_u32 s62, s62, s51
v_lshrrev_b32 v12, 4, v1
v_mul_u32_u24 v12, 57344, v12
v_and_b32 v2, 15, v1
v_lshl_add_u32 v12, v2, 4, v12
v_add_u32 v12, s62, v12
v_add_u32 v13, 6112, v12
v_add_u32 v14, 12224, v12
v_add_u32 v15, 18336, v12
s_mul_i32 s59, s3, 4224
s_mov_b32 s58, 0
s_lshl_b32 s62, s8, 10
s_add_u32 s62, s62, 30490624
s_lshl_b32 s64, s6, 10
s_add_u32 s64, s64, 30490624
s_lshr_b32 s67, s5, 2
s_and_b32 s67, s67, 3
s_lshl_b32 s67, s67, 7
s_add_u32 s64, s64, s67
v_lshl_add_u32 v252, v1, 7, s62
v_mov_b32 v253, s64
v_mov_b32 v255, 1
s_waitcnt vmcnt(0) lgkmcnt(0)
s_cmp_lg_u32 s3, 1
s_barrier
s_cbranch_scc1 .Lnopoll60
s_mov_b64 exec, 15
buffer_atomic_add v255, v252, s[16:19], 0 offen
s_mov_b64 exec, 1
v_mov_b32 v254, 0
buffer_atomic_add v254, v253, s[16:19], 0 offen sc0
s_sleep 5
s_mov_b32 s15, 0
.Lpoll59:
v_mov_b32 v255, 0
buffer_atomic_add v255, v253, s[16:19], 0 offen sc0
s_waitcnt vmcnt(1)
v_cmp_gt_u32 vcc, 16, v254
s_add_u32 s15, s15, 1
s_cbranch_vccz .Lnopoll60r
v_mov_b32 v254, 0
buffer_atomic_add v254, v253, s[16:19], 0 offen sc0
s_waitcnt vmcnt(1)
v_cmp_gt_u32 vcc, 16, v255
s_add_u32 s15, s15, 1
s_cbranch_vccz .Lnopoll60r
s_cmp_le_u32 s15, 100000
s_cbranch_scc1 .Lpoll59
s_branch .Lnopoll60r
.Lnopoll60:
s_mov_b64 exec, 0
s_cmp_eq_u32 s3, 2
s_cbranch_scc1 .Lpad21
s_cmp_eq_u32 s3, 3
s_cbranch_scc1 .Lpad22
s_branch .Lpad23
.Lnopoll60r:
s_mov_b64 exec, -1
s_barrier
buffer_load_dwordx4 v[64:67], v4, s[16:19], s52 offen sc1
buffer_load_dwordx4 v[68:71], v4, s[16:19], s52 offen offset:1024 sc1
s_xor_b32 s52, s54, 262144
buffer_load_dwordx4 v[72:75], v4, s[16:19], s53 offen sc1
buffer_load_dwordx4 v[76:79], v4, s[16:19], s53 offen offset:1024 sc1
s_xor_b32 s53, s54, 393216
buffer_load_dwordx4 v[80:83], v4, s[16:19], s52 offen sc1
buffer_load_dwordx4 v[84:87], v4, s[16:19], s52 offen offset:1024 sc1
s_xor_b32 s52, s54, 524288
buffer_load_dwordx4 v[88:91], v4, s[16:19], s53 offen sc1
buffer_load_dwordx4 v[92:95], v4, s[16:19], s53 offen offset:1024 sc1
s_xor_b32 s53, s54, 655360
buffer_load_dwordx4 v[96:99], v4, s[16:19], s52 offen sc1
buffer_load_dwordx4 v[100:103], v4, s[16:19], s52 offen offset:1024 sc1
s_xor_b32 s52, s54, 786432
buffer_load_dwordx4 v[104:107], v4, s[16:19], s53 offen sc1
buffer_load_dwordx4 v[108:111], v4, s[16:19], s53 offen offset:1024 sc1
s_xor_b32 s53, s54, 917504
ds_read_b64_tr_b16 a[0:1], v7
TR 2,7,512
TR 16,7,1024
TR 18,7,1536
TR 4,7,32
TR 6,7,544
TR 20,7,1056
TR 22,7,1568
TR 8,7,64
TR 10,7,576
TR 24,7,1088
TR 26,7,1600
TR 12,7,96
TR 14,7,608
TR 28,7,1120
TR 30,7,1632
s_waitcnt vmcnt(8) lgkmcnt(14)
MAV 32,0,64
TR 32,7,8320
s_waitcnt lgkmcnt(13)
MAV 32,16,72
buffer_load_dwordx4 v[112:115], v4, s[16:19], s52 offen sc1
MAV 48,16,76
TR 34,7,8832
MAV 48,0,68
TR 48,7,9344
TR 50,7,9856
s_waitcnt lgkmcnt(14)
MAV 52,4,68
TR 36,7,8352
s_waitcnt lgkmcnt(13)
MAV 52,20,76
buffer_load_dwordx4 v[116:119], v4, s[16:19], s52 offen offset:1024 sc1
MAV 36,20,72
TR 38,7,8864
s_xor_b32 s52, s54, 1048576
MAV 36,4,64
TR 52,7,9376
TR 54,7,9888
s_waitcnt lgkmcnt(14)
MAV 40,8,64
TR 40,7,8384
s_waitcnt lgkmcnt(13)
MAV 40,24,72
buffer_load_dwordx4 v[120:123], v4, s[16:19], s53 offen sc1
MAV 56,24,76
TR 42,7,8896
MAV 56,8,68
TR 56,7,9408
TR 58,7,9920
s_waitcnt lgkmcnt(14)
MAV 60,12,68
TR 44,7,8416
s_waitcnt lgkmcnt(13)
MAV 60,28,76
buffer_load_dwordx4 v[124:127], v4, s[16:19], s53 offen offset:1024 sc1
MAV 44,28,72
TR 46,7,8928
s_xor_b32 s53, s54, 1179648
MAV 44,12,64
TR 60,7,9440
TR 62,7,9952
s_waitcnt vmcnt(8) lgkmcnt(8)
MAV 32,32,80
TR 0,7,16640
MAV 32,48,88
buffer_load_dwordx4 v[64:67], v4, s[16:19], s52 offen sc1
MAV 48,48,92
TR 2,7,17152
MAV 48,32,84
TR 16,7,17664
TR 18,7,18176
MAV 52,36,84
TR 4,7,16672
MAV 52,52,92
buffer_load_dwordx4 v[68:71], v4, s[16:19], s52 offen offset:1024 sc1
MAV 36,52,88
TR 6,7,17184
s_xor_b32 s52, s54, 1310720
MAV 36,36,80
TR 20,7,17696
TR 22,7,18208
s_waitcnt lgkmcnt(8)
MAV 40,40,80
TR 8,7,16704
MAV 40,56,88
buffer_load_dwordx4 v[72:75], v4, s[16:19], s53 offen sc1
MAV 56,56,92
TR 10,7,17216
MAV 56,40,84
TR 24,7,17728
TR 26,7,18240
MAV 60,44,84
TR 12,7,16736
MAV 60,60,92
buffer_load_dwordx4 v[76:79], v4, s[16:19], s53 offen offset:1024 sc1
MAV 44,60,88
TR 14,7,17248
s_xor_b32 s53, s54, 1441792
MAV 44,44,80
TR 28,7,17760
TR 30,7,18272
s_waitcnt vmcnt(8) lgkmcnt(8)
MAV 32,0,96
TR 32,7,24960
MAV 32,16,104
buffer_load_dwordx4 v[80:83], v4, s[16:19], s52 offen sc1
MAV 48,16,108
TR 34,7,25472
MAV 48,0,100
TR 48,7,25984
TR 50,7,26496
MAV 52,4,100
TR 36,7,24992
MAV 52,20,108
buffer_load_dwordx4 v[84:87], v4, s[16:19], s52 offen offset:1024 sc1
MAV 36,20,104
TR 38,7,25504
s_xor_b32 s52, s54, 1572864
MAV 36,4,96
TR 52,7,26016
TR 54,7,26528
s_waitcnt lgkmcnt(8)
MAV 40,8,96
TR 40,7,25024
MAV 40,24,104
buffer_load_dwordx4 v[88:91], v4, s[16:19], s53 offen sc1
MAV 56,24,108
TR 42,7,25536
MAV 56,8,100
TR 56,7,26048
TR 58,7,26560
MAV 60,12,100
TR 44,7,25056
MAV 60,28,108
buffer_load_dwordx4 v[92:95], v4, s[16:19], s53 offen offset:1024 sc1
MAV 44,28,104
TR 46,7,25568
s_xor_b32 s53, s54, 1703936
MAV 44,12,96
TR 60,7,26080
TR 62,7,26592
s_waitcnt vmcnt(8) lgkmcnt(8)
MAV 32,32,112
TR 0,7,33280
MAV 32,48,120
buffer_load_dwordx4 v[96:99], v4, s[16:19], s52 offen sc1
MAV 48,48,124
TR 2,7,33792
MAV 48,32,116
TR 16,7,34304
TR 18,7,34816
MAV 52,36,116
TR 4,7,33312
MAV 52,52,124
buffer_load_dwordx4 v[100:103], v4, s[16:19], s52 offen offset:1024 sc1
MAV 36,52,120
TR 6,7,33824
s_xor_b32 s52, s54, 1835008
MAV 36,36,112
TR 20,7,34336
TR 22,7,34848
s_waitcnt lgkmcnt(8)
MAV 40,40,112
TR 8,7,33344
MAV 40,56,120
buffer_load_dwordx4 v[104:107], v4, s[16:19], s53 offen sc1
MAV 56,56,124
TR 10,7,33856
MAV 56,40,116
TR 24,7,34368
TR 26,7,34880
MAV 60,44,116
TR 12,7,33376
MAV 60,60,124
buffer_load_dwordx4 v[108:111], v4, s[16:19], s53 offen offset:1024 sc1
MAV 44,60,120
TR 14,7,33888
s_xor_b32 s53, s54, 1966080
MAV 44,44,112
TR 28,7,34400
TR 30,7,34912
s_waitcnt vmcnt(8) lgkmcnt(8)
.Lpad21:
s_cbranch_execz .Lpad24
MAV 32,0,64
TR 32,7,41600
MAV 32,16,72
buffer_load_dwordx4 v[112:115], v4, s[16:19], s52 offen sc1
MAV 48,16,76
TR 34,7,42112
MAV 48,0,68
TR 48,7,42624
TR 50,7,43136
MAV 52,4,68
TR 36,7,41632
MAV 52,20,76
buffer_load_dwordx4 v[116:119], v4, s[16:19], s52 offen offset:1024 sc1
MAV 36,20,72
TR 38,7,42144
s_xor_b32 s52, s54, 2097152
MAV 36,4,64
TR 52,7,42656
TR 54,7,43168
s_waitcnt lgkmcnt(8)
MAV 40,8,64
TR 40,7,41664
MAV 40,24,72
buffer_load_dwordx4 v[120:123], v4, s[16:19], s53 offen sc1
MAV 56,24,76
TR 42,7,42176
MAV 56,8,68
TR 56,7,42688
TR 58,7,43200
MAV 60,12,68
TR 44,7,41696
MAV 60,28,76
buffer_load_dwordx4 v[124:127], v4, s[16:19], s53 offen offset:1024 sc1
MAV 44,28,72
TR 46,7,42208
s_xor_b32 s53, s54, 2228224
MAV 44,12,64
TR 60,7,42720
TR 62,7,43232
s_waitcnt vmcnt(8) lgkmcnt(8)
MAV 32,32,80
TR 0,7,49920
MAV 32,48,88
buffer_load_dwordx4 v[64:67], v4, s[16:19], s52 offen sc1
MAV 48,48,92
TR 2,7,50432
MAV 48,32,84
TR 16,7,50944
TR 18,7,51456
MAV 52,36,84
TR 4,7,49952
MAV 52,52,92
buffer_load_dwordx4 v[68:71], v4, s[16:19], s52 offen offset:1024 sc1
MAV 36,52,88
TR 6,7,50464
s_xor_b32 s52, s54, 2359296
MAV 36,36,80
TR 20,7,50976
TR 22,7,51488
s_waitcnt lgkmcnt(8)
MAV 40,40,80
TR 8,7,49984
MAV 40,56,88
buffer_load_dwordx4 v[72:75], v4, s[16:19], s53 offen sc1
MAV 56,56,92
TR 10,7,50496
MAV 56,40,84
TR 24,7,51008
TR 26,7,51520
MAV 60,44,84
TR 12,7,50016
MAV 60,60,92
buffer_load_dwordx4 v[76:79], v4, s[16:19], s53 offen offset:1024 sc1
MAV 44,60,88
TR 14,7,50528
s_xor_b32 s53, s54, 2490368
MAV 44,44,80
TR 28,7,51040
TR 30,7,51552
s_waitcnt vmcnt(8) lgkmcnt(8)
MAV 32,0,96
TR 32,7,58240
MAV 32,16,104
buffer_load_dwordx4 v[80:83], v4, s[16:19], s52 offen sc1
MAV 48,16,108
TR 34,7,58752
MAV 48,0,100
TR 48,7,59264
TR 50,7,59776
MAV 52,4,100
TR 36,7,58272
MAV 52,20,108
buffer_load_dwordx4 v[84:87], v4, s[16:19], s52 offen offset:1024 sc1
MAV 36,20,104
TR 38,7,58784
s_xor_b32 s52, s54, 2621440
MAV 36,4,96
TR 52,7,59296
TR 54,7,59808
s_waitcnt lgkmcnt(8)
MAV 40,8,96
TR 40,7,58304
MAV 40,24,104
buffer_load_dwordx4 v[88:91], v4, s[16:19], s53 offen sc1
MAV 56,24,108
TR 42,7,58816
MAV 56,8,100
TR 56,7,59328
TR 58,7,59840
MAV 60,12,100
TR 44,7,58336
MAV 60,28,108
buffer_load_dwordx4 v[92:95], v4, s[16:19], s53 offen offset:1024 sc1
MAV 44,28,104
TR 46,7,58848
s_xor_b32 s53, s54, 2752512
MAV 44,12,96
TR 60,7,59360
TR 62,7,59872
s_xor_b32 s57, s57, 66560
v_add_u32 v7, s57, v8
s_waitcnt vmcnt(8) lgkmcnt(8)
MAV 32,32,112
ds_read_b64_tr_b16 a[0:1], v7
MAV 32,48,120
buffer_load_dwordx4 v[96:99], v4, s[16:19], s52 offen sc1
MAV 48,48,124
TR 2,7,512
MAV 48,32,116
TR 16,7,1024
TR 18,7,1536
MAV 52,36,116
TR 4,7,32
MAV 52,52,124
buffer_load_dwordx4 v[100:103], v4, s[16:19], s52 offen offset:1024 sc1
MAV 36,52,120
TR 6,7,544
s_xor_b32 s52, s54, 2883584
MAV 36,36,112
TR 20,7,1056
TR 22,7,1568
s_waitcnt lgkmcnt(8)
MAV 40,40,112
TR 8,7,64
MAV 40,56,120
buffer_load_dwordx4 v[104:107], v4, s[16:19], s53 offen sc1
MAV 56,56,124
TR 10,7,576
MAV 56,40,116
TR 24,7,1088
TR 26,7,1600
MAV 60,44,116
TR 12,7,96
MAV 60,60,124
buffer_load_dwordx4 v[108:111], v4, s[16:19], s53 offen offset:1024 sc1
MAV 44,60,120
TR 14,7,608
s_xor_b32 s53, s54, 3014656
MAV 44,44,112
TR 28,7,1120
TR 30,7,1632
s_waitcnt vmcnt(8) lgkmcnt(8)
MAV 32,0,64
TR 32,7,8320
MAV 32,16,72
buffer_load_dwordx4 v[112:115], v4, s[16:19], s52 offen sc1
MAV 48,16,76
TR 34,7,8832
MAV 48,0,68
TR 48,7,9344
TR 50,7,9856
MAV 52,4,68
TR 36,7,8352
MAV 52,20,76
buffer_load_dwordx4 v[116:119], v4, s[16:19], s52 offen offset:1024 sc1
MAV 36,20,72
TR 38,7,8864
s_xor_b32 s52, s54, 3145728
MAV 36,4,64
TR 52,7,9376
TR 54,7,9888
s_waitcnt lgkmcnt(8)
MAV 40,8,64
TR 40,7,8384
MAV 40,24,72
buffer_load_dwordx4 v[120:123], v4, s[16:19], s53 offen sc1
MAV 56,24,76
TR 42,7,8896
MAV 56,8,68
TR 56,7,9408
TR 58,7,9920
MAV 60,12,68
TR 44,7,8416
MAV 60,28,76
buffer_load_dwordx4 v[124:127], v4, s[16:19], s53 offen offset:1024 sc1
MAV 44,28,72
TR 46,7,8928
s_xor_b32 s53, s54, 3276800
MAV 44,12,64
TR 60,7,9440
TR 62,7,9952
s_waitcnt vmcnt(8) lgkmcnt(8)
MAV 32,32,80
TR 0,7,16640
MAV 32,48,88
buffer_load_dwordx4 v[64:67], v4, s[16:19], s52 offen sc1
MAV 48,48,92
TR 2,7,17152
MAV 48,32,84
TR 16,7,17664
TR 18,7,18176
MAV 52,36,84
TR 4,7,16672
MAV 52,52,92
buffer_load_dwordx4 v[68:71], v4, s[16:19], s52 offen offset:1024 sc1
MAV 36,52,88
TR 6,7,17184
s_xor_b32 s52, s54, 3407872
MAV 36,36,80
TR 20,7,17696
TR 22,7,18208
s_waitcnt lgkmcnt(8)
MAV 40,40,80
TR 8,7,16704
MAV 40,56,88
buffer_load_dwordx4 v[72:75], v4, s[16:19], s53 offen sc1
MAV 56,56,92
TR 10,7,17216
MAV 56,40,84
TR 24,7,17728
TR 26,7,18240
MAV 60,44,84
TR 12,7,16736
MAV 60,60,92
buffer_load_dwordx4 v[76:79], v4, s[16:19], s53 offen offset:1024 sc1
MAV 44,60,88
TR 14,7,17248
s_xor_b32 s53, s54, 3538944
MAV 44,44,80
TR 28,7,17760
TR 30,7,18272
s_waitcnt vmcnt(8) lgkmcnt(8)
MAV 32,0,96
TR 32,7,24960
MAV 32,16,104
buffer_load_dwordx4 v[80:83], v4, s[16:19], s52 offen sc1
MAV 48,16,108
TR 34,7,25472
MAV 48,0,100
TR 48,7,25984
TR 50,7,26496
MAV 52,4,100
TR 36,7,24992
MAV 52,20,108
buffer_load_dwordx4 v[84:87], v4, s[16:19], s52 offen offset:1024 sc1
MAV 36,20,104
TR 38,7,25504
s_xor_b32 s52, s54, 3670016
MAV 36,4,96
TR 52,7,26016
TR 54,7,26528
s_waitcnt lgkmcnt(8)
MAV 40,8,96
TR 40,7,25024
MAV 40,24,104
buffer_load_dwordx4 v[88:91], v4, s[16:19], s53 offen sc1
MAV 56,24,108
TR 42,7,25536
MAV 56,8,100
TR 56,7,26048
TR 58,7,26560
MAV 60,12,100
TR 44,7,25056
MAV 60,28,108
buffer_load_dwordx4 v[92:95], v4, s[16:19], s53 offen offset:1024 sc1
MAV 44,28,104
TR 46,7,25568
s_xor_b32 s53, s54, 3801088
MAV 44,12,96
TR 60,7,26080
TR 62,7,26592
s_waitcnt vmcnt(8) lgkmcnt(8)
MAV 32,32,112
TR 0,7,33280
MAV 32,48,120
buffer_load_dwordx4 v[96:99], v4, s[16:19], s52 offen sc1
MAV 48,48,124
TR 2,7,33792
MAV 48,32,116
TR 16,7,34304
TR 18,7,34816
MAV 52,36,116
TR 4,7,33312
MAV 52,52,124
buffer_load_dwordx4 v[100:103], v4, s[16:19], s52 offen offset:1024 sc1
MAV 36,52,120
TR 6,7,33824
s_xor_b32 s52, s54, 3932160
MAV 36,36,112
TR 20,7,34336
TR 22,7,34848
s_waitcnt lgkmcnt(8)
MAV 40,40,112
TR 8,7,33344
MAV 40,56,120
buffer_load_dwordx4 v[104:107], v4, s[16:19], s53 offen sc1
MAV 56,56,124
TR 10,7,33856
MAV 56,40,116
TR 24,7,34368
TR 26,7,34880
MAV 60,44,116
TR 12,7,33376
MAV 60,60,124
buffer_load_dwordx4 v[108:111], v4, s[16:19], s53 offen offset:1024 sc1
MAV 44,60,120
TR 14,7,33888
s_xor_b32 s53, s54, 4063232
MAV 44,44,112
TR 28,7,34400
TR 30,7,34912
s_waitcnt vmcnt(8) lgkmcnt(8)
MAV 32,0,64
TR 32,7,41600
MAV 32,16,72
buffer_load_dwordx4 v[112:115], v4, s[16:19], s52 offen sc1
MAV 48,16,76
TR 34,7,42112
MAV 48,0,68
TR 48,7,42624
TR 50,7,43136
MAV 52,4,68
TR 36,7,41632
MAV 52,20,76
buffer_load_dwordx4 v[116:119], v4, s[16:19], s52 offen offset:1024 sc1
MAV 36,20,72
TR 38,7,42144
MAV 36,4,64
TR 52,7,42656
TR 54,7,43168
s_waitcnt lgkmcnt(8)
MAV 40,8,64
TR 40,7,41664
MAV 40,24,72
buffer_load_dwordx4 v[120:123], v4, s[16:19], s53 offen sc1
MAV 56,24,76
TR 42,7,42176
MAV 56,8,68
TR 56,7,42688
TR 58,7,43200
MAV 60,12,68
TR 44,7,41696
MAV 60,28,76
buffer_load_dwordx4 v[124:127], v4, s[16:19], s53 offen offset:1024 sc1
MAV 44,28,72
TR 46,7,42208
MAV 44,12,64
TR 60,7,42720
TR 62,7,43232
s_barrier
s_waitcnt vmcnt(8) lgkmcnt(8)
MAV 32,32,80
TR 0,7,49920
s_add_u32 m0, s59, 84480
MAV 32,48,88
buffer_load_dwordx4 v12, s[32:35], s58 offen   lds
MAV 48,48,92
TR 2,7,50432
MAV 48,32,84
TR 16,7,50944
TR 18,7,51456
MAV 52,36,84
TR 4,7,49952
MAV 52,52,92
buffer_load_dwordx4 v13, s[32:35], s58 offen offset:1056   lds
MAV 36,52,88
TR 6,7,50464
MAV 36,36,80
TR 20,7,50976
TR 22,7,51488
s_waitcnt lgkmcnt(8)
MAV 40,40,80
TR 8,7,49984
MAV 40,56,88
buffer_load_dwordx4 v14, s[32:35], s58 offen offset:2112   lds
MAV 56,56,92
TR 10,7,50496
MAV 56,40,84
TR 24,7,51008
TR 26,7,51520
MAV 60,44,84
TR 12,7,50016
MAV 60,60,92
buffer_load_dwordx4 v15, s[32:35], s58 offen offset:3168   lds
MAV 44,60,88
TR 14,7,50528
MAV 44,44,80
TR 28,7,51040
TR 30,7,51552
s_waitcnt vmcnt(8) lgkmcnt(8)
MAV 32,0,96
TR 32,7,58240
s_add_u32 m0, s59, 101376
MAV 32,16,104
buffer_load_dwordx4 v12, s[80:83], s58 offen   lds
MAV 48,16,108
TR 34,7,58752
MAV 48,0,100
TR 48,7,59264
TR 50,7,59776
MAV 52,4,100
TR 36,7,58272
MAV 52,20,108
buffer_load_dwordx4 v13, s[80:83], s58 offen offset:1056   lds
MAV 36,20,104
TR 38,7,58784
MAV 36,4,96
TR 52,7,59296
TR 54,7,59808
s_waitcnt lgkmcnt(8)
MAV 40,8,96
TR 40,7,58304
MAV 40,24,104
buffer_load_dwordx4 v14, s[80:83], s58 offen offset:2112   lds
MAV 56,24,108
TR 42,7,58816
MAV 56,8,100
TR 56,7,59328
TR 58,7,59840
MAV 60,12,100
TR 44,7,58336
MAV 60,28,108
buffer_load_dwordx4 v15, s[80:83], s58 offen offset:3168   lds
MAV 44,28,104
TR 46,7,58848
s_add_u32 s58, s58, 458752
MAV 44,12,96
TR 60,7,59360
TR 62,7,59872
s_waitcnt vmcnt(11) lgkmcnt(14)
MAV 32,32,112
s_add_u32 m0, s59, 118272
s_lshl_b32 s64, s6, 14
s_lshl_b32 s65, s49, 13
s_waitcnt vmcnt(9) lgkmcnt(12)
MAV 32,48,120
buffer_load_dwordx4 v12, s[32:35], s58 offen   lds
s_waitcnt vmcnt(9)
MAV 48,48,124
s_add_u32 s64, s64, s65
s_lshl_b32 s65, s7, 9
s_add_u32 s64, s64, s65
MAV 48,32,116
s_lshl_b32 s65, s48, 8
s_add_u32 s64, s64, s65
s_add_u32 s64, s64, 63176704
s_waitcnt lgkmcnt(10)
MAV 52,36,116
s_lshl_b32 s62, s7, 18
v_and_b32 v152, 31, v1
v_lshlrev_b32 v152, 3, v152
s_waitcnt lgkmcnt(8)
MAV 52,52,124
buffer_load_dwordx4 v13, s[32:35], s58 offen offset:1056   lds
MAV 36,52,120
s_add_u32 s62, s62, 41943040
v_lshrrev_b32 v153, 5, v1
v_lshl_add_u32 v152, v153, 28, v152
MAV 36,36,112
s_add_u32 s63, s62, 131072
v_cvt_pk_bf16_f32 v128, v32, v33
v_cvt_pk_bf16_f32 v129, v34, v35
s_waitcnt lgkmcnt(6)
MAV 40,40,112
v_cvt_pk_bf16_f32 v136, v48, v49
v_cvt_pk_bf16_f32 v137, v50, v51
s_waitcnt lgkmcnt(4)
MAV 40,56,120
buffer_load_dwordx4 v14, s[32:35], s58 offen offset:2112   lds
MAV 56,56,124
v_cvt_pk_bf16_f32 v130, v36, v37
v_cvt_pk_bf16_f32 v131, v38, v39
MAV 56,40,116
v_cvt_pk_bf16_f32 v138, v52, v53
v_cvt_pk_bf16_f32 v139, v54, v55
s_waitcnt lgkmcnt(2)
MAV 60,44,116
v_cvt_pk_bf16_f32 v132, v40, v41
v_cvt_pk_bf16_f32 v133, v42, v43
s_waitcnt lgkmcnt(0)
MAV 60,60,124
buffer_load_dwordx4 v15, s[32:35], s58 offen offset:3168   lds
MAV 44,60,120
v_cvt_pk_bf16_f32 v140, v56, v57
v_cvt_pk_bf16_f32 v141, v58, v59
MAV 44,44,112
s_nop 2
v_cvt_pk_bf16_f32 v142, v60, v61
v_cvt_pk_bf16_f32 v143, v62, v63
v_pk_mul_f32 v[146:147], v[32:33], v[32:33]
buffer_store_dwordx4 v[128:131], v4, s[16:19], s62 offen sc1
v_pk_mul_f32 v[150:151], v[48:49], v[48:49]
v_pk_fma_f32 v[146:147], v[34:35], v[34:35], v[146:147]
v_pk_add_f32 v[144:145], v[32:33], v[34:35]
v_pk_fma_f32 v[150:151], v[50:51], v[50:51], v[150:151]
v_cvt_pk_bf16_f32 v134, v44, v45
v_cvt_pk_bf16_f32 v135, v46, v47
v_pk_add_f32 v[148:149], v[48:49], v[50:51]
v_pk_fma_f32 v[146:147], v[36:37], v[36:37], v[146:147]
v_pk_add_f32 v[144:145], v[144:145], v[36:37]
v_pk_fma_f32 v[150:151], v[52:53], v[52:53], v[150:151]
v_pk_add_f32 v[148:149], v[148:149], v[52:53]
v_pk_fma_f32 v[146:147], v[38:39], v[38:39], v[146:147]
v_pk_add_f32 v[144:145], v[144:145], v[38:39]
buffer_store_dwordx4 v[132:135], v4, s[16:19], s63 offen sc1
v_pk_fma_f32 v[150:151], v[54:55], v[54:55], v[150:151]
v_pk_add_f32 v[148:149], v[148:149], v[54:55]
v_pk_fma_f32 v[146:147], v[40:41], v[40:41], v[146:147]
v_pk_add_f32 v[144:145], v[144:145], v[40:41]
v_pk_fma_f32 v[150:151], v[56:57], v[56:57], v[150:151]
v_pk_add_f32 v[148:149], v[148:149], v[56:57]
v_pk_fma_f32 v[146:147], v[42:43], v[42:43], v[146:147]
v_pk_add_f32 v[144:145], v[144:145], v[42:43]
v_pk_fma_f32 v[150:151], v[58:59], v[58:59], v[150:151]
v_pk_add_f32 v[148:149], v[148:149], v[58:59]
v_pk_fma_f32 v[146:147], v[44:45], v[44:45], v[146:147]
v_pk_add_f32 v[144:145], v[144:145], v[44:45]
v_pk_fma_f32 v[150:151], v[60:61], v[60:61], v[150:151]
buffer_store_dwordx4 v[136:139], v4, s[16:19], s62 offen offset:1024 sc1
v_pk_add_f32 v[148:149], v[148:149], v[60:61]
v_pk_fma_f32 v[146:147], v[46:47], v[46:47], v[146:147]
v_pk_add_f32 v[144:145], v[144:145], v[46:47]
v_pk_fma_f32 v[150:151], v[62:63], v[62:63], v[150:151]
v_pk_add_f32 v[148:149], v[148:149], v[62:63]
.Lpad22:
s_cbranch_execz .Lpad25
v_add_f32 v144, v144, v145
v_add_f32 v146, v146, v147
v_add_f32 v148, v148, v149
v_add_f32 v150, v150, v151
s_nop 0
v_permlane16_swap_b32 v144, v148
buffer_store_dwordx4 v[140:143], v4, s[16:19], s63 offen offset:1024 sc1
v_permlane16_swap_b32 v146, v150
v_add_f32 v144, v144, v148
v_add_f32 v146, v146, v150
s_nop 1
v_permlane32_swap_b32 v144, v146
v_add_f32 v144, v144, v146
s_nop 1
v_permlane32_swap_b32 v144, v145
buffer_store_dwordx2 v[144:145], v152, s[16:19], s64 offen sc1
s_nop 1
v_accvgpr_write_b32 a224, v32
v_accvgpr_write_b32 a225, v33
v_accvgpr_write_b32 a226, v34
v_accvgpr_write_b32 a227, v35
v_accvgpr_write_b32 a228, v36
v_accvgpr_write_b32 a229, v37
v_accvgpr_write_b32 a230, v38
v_accvgpr_write_b32 a231, v39
v_accvgpr_write_b32 a232, v40
v_accvgpr_write_b32 a233, v41
v_accvgpr_write_b32 a234, v42
v_accvgpr_write_b32 a235, v43
v_accvgpr_write_b32 a236, v44
v_accvgpr_write_b32 a237, v45
v_accvgpr_write_b32 a238, v46
v_accvgpr_write_b32 a239, v47
v_accvgpr_write_b32 a240, v48
v_accvgpr_write_b32 a241, v49
v_accvgpr_write_b32 a242, v50
v_accvgpr_write_b32 a243, v51
v_accvgpr_write_b32 a244, v52
v_accvgpr_write_b32 a245, v53
v_accvgpr_write_b32 a246, v54
v_accvgpr_write_b32 a247, v55
v_accvgpr_write_b32 a248, v56
v_accvgpr_write_b32 a249, v57
v_accvgpr_write_b32 a250, v58
v_accvgpr_write_b32 a251, v59
v_accvgpr_write_b32 a252, v60
v_accvgpr_write_b32 a253, v61
v_accvgpr_write_b32 a254, v62
v_accvgpr_write_b32 a255, v63
s_lshl_b32 s62, s10, 14
s_lshl_b32 s63, s3, 12
s_add_u32 s62, s62, s63
s_lshl_b32 s63, s12, 11
s_add_u32 s62, s62, s63
v_lshl_add_u32 v10, v1, 4, s62
v_lshrrev_b32 v2, 3, v1
v_cmp_eq_u32 vcc, 3, v2
v_add_u32 v2, 67108480, v10
s_nop 0
v_cndmask_b32 v10, v10, v2, vcc
v_xor_b32 v11, 2048, v10
v_bfe_u32 v16, v1, 2, 3
v_mul_u32_u24 v16, 1056, v16
v_bfe_u32 v2, v1, 5, 1
v_lshl_add_u32 v16, v2, 8, v16
v_and_b32 v2, 3, v1
v_lshl_add_u32 v16, v2, 3, v16
s_lshl_b32 s62, s12, 6
s_add_u32 s62, s62, 84480
s_xor_b32 s63, s12, 1
s_mul_i32 s63, s63, 192
s_add_u32 s63, s63, 84480
v_add_u32 v17, s63, v16
v_add_u32 v16, s62, v16
s_mov_b32 s52, 41943040
s_mov_b32 s53, 41943040
s_mov_b32 s54, s58
s_mov_b32 s55, s59
s_mul_i32 s59, s3, 2112
s_and_b32 s62, s7, 1
s_mul_i32 s62, s62, 3670016
s_lshr_b32 s63, s7, 1
s_lshl_b32 s63, s63, 8
s_add_u32 s62, s62, s63
s_lshl_b32 s63, s3, 12
s_add_u32 s62, s62, s63
v_lshrrev_b32 v5, 4, v1
v_lshlrev_b32 v5, 14, v5
v_and_b32 v2, 15, v1
v_lshl_add_u32 v5, v2, 4, v5
v_add_u32 v5, s62, v5
v_add_u32 v6, 992, v5
s_lshl_b32 s62, s10, 15
s_lshl_b32 s63, s3, 13
s_add_u32 s62, s62, s63
v_lshl_add_u32 v4, v1, 4, s62
s_lshl_b32 s62, s6, 10
s_add_u32 s62, s62, 30507008
s_lshl_b32 s64, s10, 1
s_lshl_b32 s64, s64, 10
s_add_u32 s64, s64, 30507008
s_lshr_b32 s67, s5, 2
s_and_b32 s67, s67, 3
s_lshl_b32 s67, s67, 7
s_add_u32 s64, s64, s67
s_add_u32 s65, s64, 1024
v_lshl_add_u32 v252, v1, 7, s62
v_mov_b32 v253, s64
v_mov_b32 v255, 1
v_writelane_b32 v253, s65, 1
s_waitcnt vmcnt(0) lgkmcnt(0)
s_cmp_lg_u32 s3, 1
s_barrier
s_cbranch_scc1 .Lnopoll63
s_mov_b64 exec, 15
buffer_atomic_add v255, v252, s[16:19], 0 offen
s_mov_b64 exec, 3
v_mov_b32 v254, 0
buffer_atomic_add v254, v253, s[16:19], 0 offen sc0
s_sleep 5
s_mov_b32 s15, 0
.Lpoll62:
v_mov_b32 v255, 0
buffer_atomic_add v255, v253, s[16:19], 0 offen sc0
s_waitcnt vmcnt(1)
v_cmp_gt_u32 vcc, 16, v254
s_add_u32 s15, s15, 1
s_cbranch_vccz .Lnopoll63r
v_mov_b32 v254, 0
buffer_atomic_add v254, v253, s[16:19], 0 offen sc0
s_waitcnt vmcnt(1)
v_cmp_gt_u32 vcc, 16, v255
s_add_u32 s15, s15, 1
s_cbranch_vccz .Lnopoll63r
s_cmp_le_u32 s15, 100000
s_cbranch_scc1 .Lpoll62
s_branch .Lnopoll63r
.Lnopoll63:
s_mov_b64 exec, 0
s_cmp_eq_u32 s3, 2
s_cbranch_scc1 .Lpad27
s_cmp_eq_u32 s3, 3
s_cbranch_scc1 .Lpad28
s_branch .Lpad29
.Lnopoll63r:
s_mov_b64 exec, -1
s_barrier
buffer_load_dwordx4 a[128:131], v10, s[16:19], s52 offen sc1
buffer_load_dwordx4 a[132:135], v10, s[16:19], s52 offen offset:1024 sc1
s_add_u32 s52, s52, 131072
buffer_load_dwordx4 a[144:147], v10, s[16:19], s52 offen sc1
buffer_load_dwordx4 a[148:151], v10, s[16:19], s52 offen offset:1024 sc1
s_add_u32 s52, s52, 131072
buffer_load_dwordx4 a[136:139], v11, s[16:19], s53 offen sc1
buffer_load_dwordx4 a[140:143], v11, s[16:19], s53 offen offset:1024 sc1
s_add_u32 s53, s53, 131072
buffer_load_dwordx4 a[152:155], v11, s[16:19], s53 offen sc1
buffer_load_dwordx4 a[156:159], v11, s[16:19], s53 offen offset:1024 sc1
s_add_u32 s53, s53, 131072
ds_read_b64_tr_b16 a[0:1], v16
TR 2,16,512
TR 4,16,8448
TR 6,16,8960
TR 8,16,32
TR 10,16,544
TR 12,16,8480
TR 14,16,8992
TR 16,16,64
TR 18,16,576
TR 20,16,8512
TR 22,16,9024
TR 24,16,96
TR 26,16,608
TR 28,16,8544
TR 30,16,9056
TR 32,16,128
TR 34,16,640
TR 36,16,8576
TR 38,16,9088
TR 40,16,160
TR 42,16,672
TR 44,16,8608
TR 46,16,9120
ds_read_b64_tr_b16 a[48:49], v17
TR 50,17,512
TR 52,17,8448
TR 54,17,8960
TR 56,17,32
TR 58,17,544
TR 60,17,8480
TR 62,17,8992
s_add_u32 m0, s55, 135168
s_nop 0
buffer_load_dwordx4 v12, s[80:83], s54 offen   lds
buffer_load_dwordx4 v13, s[80:83], s54 offen offset:1056   lds
buffer_load_dwordx4 v14, s[80:83], s54 offen offset:2112   lds
buffer_load_dwordx4 v15, s[80:83], s54 offen offset:3168   lds
s_add_u32 s54, s54, 458752
s_lshl_b32 s57, s3, 13
s_add_u32 s57, s57, 49920
v_lshl_add_u32 v2, v1, 4, s57
s_waitcnt lgkmcnt(0)
s_barrier
s_waitcnt vmcnt(11)
v_mfma_f32_16x16x32_bf16 v[32:35], a[0:3], a[128:131], 0
buffer_load_dwordx4 a[160:163], v10, s[16:19], s52 offen sc1
s_waitcnt vmcnt(10)
MAA 32,4,144
TR 64,16,16896
v_mfma_f32_16x16x32_bf16 v[36:39], a[0:3], a[132:135], 0
TR 66,16,17408
s_waitcnt vmcnt(9)
MAA 36,4,148
TR 68,16,25344
v_mfma_f32_16x16x32_bf16 v[52:55], a[8:11], a[132:135], 0
buffer_load_dwordx4 a[164:167], v10, s[16:19], s52 offen offset:1024 sc1
MAA 52,12,148
TR 70,16,25856
s_add_u32 s52, s52, 131072
v_mfma_f32_16x16x32_bf16 v[48:51], a[8:11], a[128:131], 0
TR 72,16,16928
MAA 48,12,144
TR 74,16,17440
v_mfma_f32_16x16x32_bf16 v[96:99], a[16:19], a[128:131], 0
buffer_load_dwordx4 a[176:179], v10, s[16:19], s52 offen sc1
MAA 96,20,144
TR 76,16,25376
v_mfma_f32_16x16x32_bf16 v[100:103], a[16:19], a[132:135], 0
TR 78,16,25888
MAA 100,20,148
TR 80,16,16960
v_mfma_f32_16x16x32_bf16 v[116:119], a[24:27], a[132:135], 0
buffer_load_dwordx4 a[180:183], v10, s[16:19], s52 offen offset:1024 sc1
MAA 116,28,148
TR 82,16,17472
s_add_u32 s52, s52, 131072
v_mfma_f32_16x16x32_bf16 v[112:115], a[24:27], a[128:131], 0
TR 84,16,25408
MAA 112,28,144
TR 86,16,25920
v_mfma_f32_16x16x32_bf16 v[160:163], a[32:35], a[128:131], 0
buffer_load_dwordx4 a[168:171], v11, s[16:19], s53 offen sc1
MAA 160,36,144
TR 88,16,16992
v_mfma_f32_16x16x32_bf16 v[164:167], a[32:35], a[132:135], 0
TR 90,16,17504
MAA 164,36,148
TR 92,16,25440
v_mfma_f32_16x16x32_bf16 v[180:183], a[40:43], a[132:135], 0
buffer_load_dwordx4 a[172:175], v11, s[16:19], s53 offen offset:1024 sc1
MAA 180,44,148
TR 94,16,25952
s_add_u32 s53, s53, 131072
v_mfma_f32_16x16x32_bf16 v[176:179], a[40:43], a[128:131], 0
TR 96,16,17024
MAA 176,44,144
TR 98,16,17536
v_mfma_f32_16x16x32_bf16 v[224:227], a[48:51], a[128:131], 0
buffer_load_dwordx4 a[184:187], v11, s[16:19], s53 offen sc1
MAA 224,52,144
TR 100,16,25472
v_mfma_f32_16x16x32_bf16 v[228:231], a[48:51], a[132:135], 0
TR 102,16,25984
MAA 228,52,148
TR 104,16,17056
v_mfma_f32_16x16x32_bf16 v[236:239], a[56:59], a[132:135], 0
buffer_load_dwordx4 a[188:191], v11, s[16:19], s53 offen offset:1024 sc1
MAA 236,60,148
TR 106,16,17568
s_add_u32 s53, s53, 131072
v_mfma_f32_16x16x32_bf16 v[232:235], a[56:59], a[128:131], 0
TR 108,16,25504
s_add_u32 m0, s55, 84480
MAA 232,60,144
TR 110,16,26016
s_waitcnt vmcnt(12)
v_mfma_f32_16x16x32_bf16 v[188:191], a[40:43], a[140:143], 0
buffer_load_dwordx4 v12, s[32:35], s54 offen   lds
MAA 188,44,156
TR 112,17,16896
v_mfma_f32_16x16x32_bf16 v[184:187], a[40:43], a[136:139], 0
TR 114,17,17408
MAA 184,44,152
TR 116,17,25344
v_mfma_f32_16x16x32_bf16 v[168:171], a[32:35], a[136:139], 0
buffer_load_dwordx4 v13, s[32:35], s54 offen offset:1056   lds
MAA 168,36,152
TR 118,17,25856
v_mfma_f32_16x16x32_bf16 v[172:175], a[32:35], a[140:143], 0
TR 120,17,16928
MAA 172,36,156
TR 122,17,17440
v_mfma_f32_16x16x32_bf16 v[124:127], a[24:27], a[140:143], 0
buffer_load_dwordx4 v14, s[32:35], s54 offen offset:2112   lds
MAA 124,28,156
TR 124,17,25376
v_mfma_f32_16x16x32_bf16 v[120:123], a[24:27], a[136:139], 0
TR 126,17,25888
MAA 120,28,152
v_mfma_f32_16x16x32_bf16 v[104:107], a[16:19], a[136:139], 0
buffer_load_dwordx4 v15, s[32:35], s54 offen offset:3168   lds
MAA 104,20,152
v_mfma_f32_16x16x32_bf16 v[108:111], a[16:19], a[140:143], 0
MAA 108,20,156
v_mfma_f32_16x16x32_bf16 v[60:63], a[8:11], a[140:143], 0
MAA 60,12,156
v_mfma_f32_16x16x32_bf16 v[56:59], a[8:11], a[136:139], 0
MAA 56,12,152
v_mfma_f32_16x16x32_bf16 v[40:43], a[0:3], a[136:139], 0
MAA 40,4,152
v_mfma_f32_16x16x32_bf16 v[44:47], a[0:3], a[140:143], 0
MAA 44,4,156
s_waitcnt lgkmcnt(0)
s_barrier
v_mfma_f32_16x16x32_bf16 v[64:67], a[64:67], a[128:131], 0
TR 0,16,33792
s_add_u32 m0, s55, 101376
MAA 64,68,144
buffer_load_dwordx4 v12, s[80:83], s54 offen   lds
v_mfma_f32_16x16x32_bf16 v[68:71], a[64:67], a[132:135], 0
TR 2,16,34304
s_mul_i32 s66, s13, 114688
MAA 68,68,148
TR 4,16,42240
s_mul_i32 s65, s10, 1818624
v_mfma_f32_16x16x32_bf16 v[84:87], a[72:75], a[132:135], 0
TR 6,16,42752
s_add_u32 s66, s66, s65
MAA 84,76,148
TR 8,16,33824
s_add_u32 s66, s66, 46137344
v_mfma_f32_16x16x32_bf16 v[80:83], a[72:75], a[128:131], 0
buffer_load_dwordx4 v13, s[80:83], s54 offen offset:1056   lds
MAA 80,76,144
TR 10,16,34336
s_add_u32 s65, s66, 49152
v_mfma_f32_16x16x32_bf16 v[128:131], a[80:83], a[128:131], 0
TR 12,16,42272
s_lshl_b32 s62, s12, 16
MAA 128,84,144
TR 14,16,42784
s_add_u32 s62, s62, s66
v_mfma_f32_16x16x32_bf16 v[132:135], a[80:83], a[132:135], 0
TR 16,16,33856
s_add_u32 s63, s62, 16384
MAA 132,84,148
buffer_load_dwordx4 v14, s[80:83], s54 offen offset:2112   lds
v_mfma_f32_16x16x32_bf16 v[148:151], a[88:91], a[132:135], 0
TR 18,16,34368
s_add_u32 s64, s62, 32768
MAA 148,92,148
TR 20,16,42304
s_lshl_b32 s72, s10, 1
v_mfma_f32_16x16x32_bf16 v[144:147], a[88:91], a[128:131], 0
TR 22,16,42816
s_lshr_b32 s74, s11, 4
MAA 144,92,144
TR 24,16,33888
s_add_u32 s72, s72, s74
v_mfma_f32_16x16x32_bf16 v[192:195], a[96:99], a[128:131], 0
buffer_load_dwordx4 v15, s[80:83], s54 offen offset:3168   lds
MAA 192,100,144
TR 26,16,34400
s_add_u32 s54, s54, 458752
v_mfma_f32_16x16x32_bf16 v[196:199], a[96:99], a[132:135], 0
TR 28,16,42336
s_add_u32 m0, s57, 0
MAA 196,100,148
TR 30,16,42848
s_mov_b32 s58, 63176704
v_mfma_f32_16x16x32_bf16 v[212:215], a[104:107], a[132:135], 0
TR 32,16,33920
s_lshl_b32 s72, s72, 10
MAA 212,108,148
buffer_load_dwordx4 v4, s[16:19], s58 offen sc1 lds
v_mfma_f32_16x16x32_bf16 v[208:211], a[104:107], a[128:131], 0
TR 34,16,34432
s_add_u32 s72, s72, 30523392
MAA 208,108,144
TR 36,16,42368
s_and_b32 s73, s6, 14
v_mfma_f32_16x16x32_bf16 v[240:243], a[112:115], a[128:131], 0
TR 38,16,42880
s_and_b32 s74, s7, 1
MAA 240,116,144
TR 40,16,33952
s_add_u32 s73, s73, s74
v_mfma_f32_16x16x32_bf16 v[244:247], a[112:115], a[132:135], 0
buffer_load_dwordx4 v4, s[16:19], s58 offen offset:1024 sc1 lds
MAA 244,116,148
TR 42,16,34464
s_lshl_b32 s73, s73, 10
v_mfma_f32_16x16x32_bf16 v[252:255], a[120:123], a[132:135], 0
TR 44,16,42400
s_add_u32 s73, s73, 30523392
MAA 252,124,148
TR 46,16,42912
s_lshr_b32 s67, s5, 2
v_mfma_f32_16x16x32_bf16 v[248:251], a[120:123], a[128:131], 0
TR 48,17,33792
s_and_b32 s67, s67, 3
MAA 248,124,144
buffer_load_dwordx4 a[128:131], v10, s[16:19], s52 offen sc1
v_mfma_f32_16x16x32_bf16 v[220:223], a[104:107], a[140:143], 0
TR 50,17,34304
s_lshl_b32 s67, s67, 7
MAA 220,108,156
TR 52,17,42240
s_add_u32 s73, s73, s67
v_mfma_f32_16x16x32_bf16 v[216:219], a[104:107], a[136:139], 0
TR 54,17,42752
MAA 216,108,152
TR 56,17,33824
v_mfma_f32_16x16x32_bf16 v[200:203], a[96:99], a[136:139], 0
buffer_load_dwordx4 a[132:135], v10, s[16:19], s52 offen offset:1024 sc1
MAA 200,100,152
TR 58,17,34336
s_add_u32 s52, s52, 131072
v_mfma_f32_16x16x32_bf16 v[204:207], a[96:99], a[140:143], 0
TR 60,17,42272
MAA 204,100,156
TR 62,17,42784
v_mfma_f32_16x16x32_bf16 v[156:159], a[88:91], a[140:143], 0
MAA 156,92,156
buffer_load_dwordx4 a[144:147], v10, s[16:19], s52 offen sc1
v_mfma_f32_16x16x32_bf16 v[152:155], a[88:91], a[136:139], 0
MAA 152,92,152
v_mfma_f32_16x16x32_bf16 v[136:139], a[80:83], a[136:139], 0
MAA 136,84,152
v_mfma_f32_16x16x32_bf16 v[140:143], a[80:83], a[140:143], 0
buffer_load_dwordx4 a[148:151], v10, s[16:19], s52 offen offset:1024 sc1
MAA 140,84,156
s_add_u32 s52, s52, 131072
v_mfma_f32_16x16x32_bf16 v[92:95], a[72:75], a[140:143], 0
MAA 92,76,156
v_mfma_f32_16x16x32_bf16 v[88:91], a[72:75], a[136:139], 0
MAA 88,76,152
v_mfma_f32_16x16x32_bf16 v[72:75], a[64:67], a[136:139], 0
MAA 72,68,152
v_mfma_f32_16x16x32_bf16 v[76:79], a[64:67], a[140:143], 0
MAA 76,68,156
s_waitcnt vmcnt(18) lgkmcnt(0)
s_barrier
MAA 32,0,160
buffer_load_dwordx4 a[136:139], v11, s[16:19], s53 offen sc1
MAA 32,4,176
TR 64,16,50688
s_and_b32 s74, s7, 1
MAA 36,4,180
TR 66,16,51200
s_mul_i32 s87, s74, 917504
MAA 36,0,164
TR 68,16,59136
s_lshr_b32 s75, s6, 1
MAA 52,8,164
TR 70,16,59648
s_mul_i32 s75, s75, 1818624
MAA 52,12,180
buffer_load_dwordx4 a[140:143], v11, s[16:19], s53 offen offset:1024 sc1
MAA 48,12,176
TR 72,16,50720
s_add_u32 s53, s53, 131072
MAA 48,8,160
TR 74,16,51232
s_add_u32 s87, s87, s75
MAA 96,16,160
TR 76,16,59168
s_add_u32 s87, s87, 46137344
MAA 96,20,176
TR 78,16,59680
s_and_b32 s74, s6, 3
MAA 100,20,180
buffer_load_dwordx4 a[152:155], v11, s[16:19], s53 offen sc1
MAA 100,16,164
TR 80,16,50752
s_xor_b32 s75, s74, 0
MAA 116,24,164
TR 82,16,51264
s_sub_u32 s75, s75, 0
MAA 116,28,180
TR 84,16,59200
s_mul_i32 s98, s75, 458752
MAA 112,28,176
TR 86,16,59712
s_mul_i32 s75, s75, 114688
MAA 112,24,160
buffer_load_dwordx4 a[156:159], v11, s[16:19], s53 offen offset:1024 sc1
MAA 160,32,160
TR 88,16,50784
s_add_u32 s53, s53, 131072
MAA 160,36,176
TR 90,16,51296
s_add_u32 m0, s55, 118272
MAA 164,36,180
TR 92,16,59232
s_add_u32 s76, s87, s75
MAA 164,32,164
TR 94,16,59744
s_xor_b32 s75, s74, 1
MAA 180,40,164
buffer_load_dwordx4 v12, s[32:35], s54 offen   lds
MAA 180,44,180
TR 96,16,50816
s_sub_u32 s75, s75, 1
MAA 176,44,176
TR 98,16,51328
s_mul_i32 s99, s75, 458752
MAA 176,40,160
TR 100,16,59264
s_mul_i32 s75, s75, 114688
MAA 224,48,160
TR 102,16,59776
s_add_u32 s77, s87, s75
MAA 224,52,176
buffer_load_dwordx4 v13, s[32:35], s54 offen offset:1056   lds
MAA 228,52,180
TR 104,16,50848
s_xor_b32 s75, s74, 2
MAA 228,48,164
TR 106,16,51360
s_sub_u32 s75, s75, 2
MAA 236,56,164
TR 108,16,59296
s_mul_i32 s100, s75, 458752
MAA 236,60,180
TR 110,16,59808
s_mul_i32 s75, s75, 114688
MAA 232,60,176
buffer_load_dwordx4 v14, s[32:35], s54 offen offset:2112   lds
MAA 232,56,160
TR 112,17,50688
s_add_u32 s78, s87, s75
s_waitcnt vmcnt(21)
MAA 188,40,172
TR 114,17,51200
s_xor_b32 s75, s74, 3
MAA 188,44,188
TR 116,17,59136
MAA 184,44,184
TR 118,17,59648
MAA 184,40,168
buffer_load_dwordx4 v15, s[32:35], s54 offen offset:3168   lds
MAA 168,32,168
TR 120,17,50720
s_add_u32 m0, s57, 2048
MAA 168,36,184
TR 122,17,51232
s_mov_b32 s58, 63178752
MAA 172,36,188
TR 124,17,59168
MAA 172,32,172
TR 126,17,59680
MAA 124,24,172
buffer_load_dwordx4 v4, s[16:19], s58 offen sc1 lds
MAA 124,28,188
MAA 120,28,184
MAA 120,24,168
MAA 104,16,168
MAA 104,20,184
buffer_load_dwordx4 v4, s[16:19], s58 offen offset:1024 sc1 lds
MAA 108,20,188
MAA 108,16,172
MAA 60,8,172
MAA 60,12,188
MAA 56,12,184
MAA 56,8,168
MAA 40,0,168
MAA 40,4,184
MAA 44,4,188
MAA 44,0,172
s_waitcnt vmcnt(20) lgkmcnt(0)
s_barrier
MAA 64,64,160
ds_read_b64_tr_b16 a[0:1], v16
s_add_u32 m0, s55, 135168
MAA 64,68,176
buffer_load_dwordx4 v12, s[80:83], s54 offen   lds
MAA 68,68,180
.Lpad23:
s_cbranch_execz .Lpad26
TR 2,16,512
s_sub_u32 s75, s75, 3
MAA 68,64,164
TR 4,16,8448
s_mul_i32 s101, s75, 458752
MAA 84,72,164
TR 6,16,8960
s_mul_i32 s75, s75, 114688
MAA 84,76,180
TR 8,16,32
s_add_u32 s79, s87, s75
MAA 80,76,176
buffer_load_dwordx4 v13, s[80:83], s54 offen offset:1056   lds
MAA 80,72,160
TR 10,16,544
s_and_b32 s87, s6, 3
MAA 128,80,160
TR 12,16,8480
s_mov_b32 s46, 0
MAA 128,84,176
TR 14,16,8992
s_lshl_b32 s74, s3, 10
MAA 132,84,180
TR 16,16,64
s_lshl_b32 s75, s12, 9
MAA 132,80,164
buffer_load_dwordx4 v14, s[80:83], s54 offen offset:2112   lds
MAA 148,88,164
TR 18,16,576
s_add_u32 s74, s74, s75
MAA 148,92,180
TR 20,16,8512
s_add_u32 s74, s74, 152576
MAA 144,92,176
TR 22,16,9024
v_and_b32 v18, 15, v1
MAA 144,88,160
TR 24,16,96
v_lshl_add_u32 v18, v18, 4, s74
MAA 192,96,160
buffer_load_dwordx4 v15, s[80:83], s54 offen offset:3168   lds
MAA 192,100,176
TR 26,16,608
s_add_u32 s54, s54, 458752
MAA 196,100,180
TR 28,16,8544
s_add_u32 m0, s57, 4096
MAA 196,96,164
TR 30,16,9056
s_mov_b32 s58, 63180800
MAA 212,104,164
TR 32,16,128
v_xor_b32 v19, 512, v18
MAA 212,108,180
buffer_load_dwordx4 v4, s[16:19], s58 offen sc1 lds
MAA 208,108,176
TR 34,16,640
s_lshl_b32 s74, s12, 7
MAA 208,104,160
TR 36,16,8576
s_add_u32 s74, s74, 161536
MAA 240,112,160
TR 38,16,9088
s_xor_b32 s75, s12, 1
MAA 240,116,176
TR 40,16,160
s_mul_i32 s75, s75, 384
MAA 244,116,180
buffer_load_dwordx4 v4, s[16:19], s58 offen offset:1024 sc1 lds
MAA 244,112,164
TR 42,16,672
s_add_u32 s75, s75, 161536
MAA 252,120,164
TR 44,16,8608
v_lshrrev_b32 v9, 4, v1
MAA 252,124,180
TR 46,16,9120
v_lshlrev_b32 v9, 4, v9
MAA 248,124,176
ds_read_b64_tr_b16 a[48:49], v17
v_add_u32 v8, s75, v9
MAA 248,120,160
buffer_load_dwordx4 a[160:163], v10, s[16:19], s52 offen sc1
MAA 220,104,172
TR 50,17,512
v_add_u32 v9, s74, v9
MAA 220,108,188
TR 52,17,8448
MAA 216,108,184
TR 54,17,8960
MAA 216,104,168
TR 56,17,32
MAA 200,96,168
buffer_load_dwordx4 a[164:167], v10, s[16:19], s52 offen offset:1024 sc1
MAA 200,100,184
TR 58,17,544
s_add_u32 s52, s52, 131072
MAA 204,100,188
TR 60,17,8480
MAA 204,96,172
TR 62,17,8992
MAA 156,88,172
MAA 156,92,188
buffer_load_dwordx4 a[176:179], v10, s[16:19], s52 offen sc1
MAA 152,92,184
MAA 152,88,168
MAA 136,80,168
MAA 136,84,184
MAA 140,84,188
buffer_load_dwordx4 a[180:183], v10, s[16:19], s52 offen offset:1024 sc1
MAA 140,80,172
s_add_u32 s52, s52, 131072
MAA 92,72,172
MAA 92,76,188
MAA 88,76,184
MAA 88,72,168
MAA 72,64,168
MAA 72,68,184
MAA 76,68,188
MAA 76,64,172
s_waitcnt vmcnt(20) lgkmcnt(0)
s_barrier
MAA 32,0,128
buffer_load_dwordx4 a[168:171], v11, s[16:19], s53 offen sc1
MAA 32,4,144
ds_read_b128 v[20:23], v2
MAA 36,4,148
ds_read_b128 v[28:31], v2 offset:1024
MAA 36,0,132
s_waitcnt vmcnt(11)
ds_read_b128 v[24:27], v2 offset:2048
MAA 52,8,132
TR 64,16,16896
MAA 52,12,148
buffer_load_dwordx4 a[172:175], v11, s[16:19], s53 offen offset:1024 sc1
MAA 48,12,144
TR 66,16,17408
s_add_u32 s53, s53, 131072
MAA 48,8,128
TR 68,16,25344
MAA 96,16,128
TR 70,16,25856
MAA 96,20,144
TR 72,16,16928
MAA 100,20,148
buffer_load_dwordx4 a[184:187], v11, s[16:19], s53 offen sc1
MAA 100,16,132
TR 74,16,17440
s_waitcnt lgkmcnt(7)
v_add_f32 v20, v20, v28
MAA 116,24,132
TR 76,16,25376
v_add_f32 v21, v21, v29
MAA 116,28,148
TR 78,16,25888
v_add_f32 v22, v22, v30
MAA 112,28,144
TR 80,16,16960
v_add_f32 v23, v23, v31
MAA 112,24,128
buffer_load_dwordx4 a[188:191], v11, s[16:19], s53 offen offset:1024 sc1
MAA 160,32,128
ds_read_b128 v[28:31], v2 offset:3072
s_add_u32 s53, s53, 131072
MAA 160,36,144
TR 82,16,17472
s_add_u32 m0, s55, 84480
MAA 164,36,148
TR 84,16,25408
s_waitcnt lgkmcnt(12)
v_add_f32 v20, v20, v24
MAA 164,32,132
TR 86,16,25920
v_add_f32 v21, v21, v25
MAA 180,40,132
buffer_load_dwordx4 v12, s[32:35], s54 offen   lds
MAA 180,44,148
TR 88,16,16992
v_add_f32 v22, v22, v26
MAA 176,44,144
TR 90,16,17504
v_add_f32 v23, v23, v27
MAA 176,40,128
TR 92,16,25440
MAA 224,48,128
TR 94,16,25952
MAA 224,52,144
buffer_load_dwordx4 v13, s[32:35], s54 offen offset:1056   lds
MAA 228,52,148
TR 96,16,17024
MAA 228,48,132
TR 98,16,17536
MAA 236,56,132
TR 100,16,25472
MAA 236,60,148
TR 102,16,25984
MAA 232,60,144
buffer_load_dwordx4 v14, s[32:35], s54 offen offset:2112   lds
MAA 232,56,128
TR 104,16,17056
MAA 188,40,140
TR 106,16,17568
MAA 188,44,156
TR 108,16,25504
MAA 184,44,152
TR 110,16,26016
MAA 184,40,136
buffer_load_dwordx4 v15, s[32:35], s54 offen offset:3168   lds
MAA 168,32,136
TR 112,17,16896
s_add_u32 m0, s57, 6144
MAA 168,36,152
TR 114,17,17408
s_mov_b32 s58, 63182848
MAA 172,36,156
TR 116,17,25344
MAA 172,32,140
TR 118,17,25856
MAA 124,24,140
buffer_load_dwordx4 v4, s[16:19], s58 offen sc1 lds
MAA 124,28,156
TR 120,17,16928
MAA 120,28,152
TR 122,17,17440
MAA 120,24,136
TR 124,17,25376
MAA 104,16,136
TR 126,17,25888
MAA 104,20,152
buffer_load_dwordx4 v4, s[16:19], s58 offen offset:1024 sc1 lds
MAA 108,20,156
MAA 108,16,140
MAA 60,8,140
MAA 60,12,156
MAA 56,12,152
MAA 56,8,136
MAA 40,0,136
MAA 40,4,152
MAA 44,4,156
MAA 44,0,140
s_waitcnt lgkmcnt(0)
s_barrier
MAA 64,64,128
s_waitcnt vmcnt(14)
ds_read_b128 v[24:27], v2 offset:4096
s_add_u32 m0, s55, 101376
MAA 64,68,144
buffer_load_dwordx4 v12, s[80:83], s54 offen   lds
MAA 68,68,148
TR 0,16,33792
v_add_f32 v20, v20, v28
MAA 68,64,132
TR 2,16,34304
v_add_f32 v21, v21, v29
MAA 84,72,132
TR 4,16,42240
v_add_f32 v22, v22, v30
MAA 84,76,148
TR 6,16,42752
v_add_f32 v23, v23, v31
MAA 80,76,144
ds_read_b128 v[28:31], v2 offset:5120
MAA 80,72,128
TR 8,16,33824
MAA 128,80,128
buffer_load_dwordx4 v13, s[80:83], s54 offen offset:1056   lds
MAA 128,84,144
TR 10,16,34336
s_waitcnt lgkmcnt(7)
v_add_f32 v20, v20, v24
MAA 132,84,148
TR 12,16,42272
v_add_f32 v21, v21, v25
MAA 132,80,132
TR 14,16,42784
v_add_f32 v22, v22, v26
MAA 148,88,132
TR 16,16,33856
v_add_f32 v23, v23, v27
MAA 148,92,148
TR 18,16,34368
MAA 144,92,144
TR 20,16,42304
MAA 144,88,128
buffer_load_dwordx4 v14, s[80:83], s54 offen offset:2112   lds
MAA 192,96,128
TR 22,16,42816
MAA 192,100,144
TR 24,16,33888
MAA 196,100,148
TR 26,16,34400
MAA 196,96,132
TR 28,16,42336
MAA 212,104,132
TR 30,16,42848
MAA 212,108,148
TR 32,16,33920
MAA 208,108,144
buffer_load_dwordx4 v15, s[80:83], s54 offen offset:3168   lds
MAA 208,104,128
TR 34,16,34432
s_add_u32 s54, s54, 458752
MAA 240,112,128
TR 36,16,42368
MAA 240,116,144
TR 38,16,42880
MAA 244,116,148
TR 40,16,33952
MAA 244,112,132
TR 42,16,34464
MAA 252,120,132
TR 44,16,42400
MAA 252,124,148
TR 46,16,42912
MAA 248,124,144
TR 48,17,33792
MAA 248,120,128
buffer_load_dwordx4 a[128:131], v10, s[16:19], s52 offen sc1
MAA 220,104,140
TR 50,17,34304
MAA 220,108,156
TR 52,17,42240
MAA 216,108,152
TR 54,17,42752
MAA 216,104,136
TR 56,17,33824
MAA 200,96,136
TR 58,17,34336
MAA 200,100,152
TR 60,17,42272
MAA 204,100,156
buffer_load_dwordx4 a[132:135], v10, s[16:19], s52 offen offset:1024 sc1
MAA 204,96,140
TR 62,17,42784
s_add_u32 s52, s52, 131072
MAA 156,88,140
MAA 156,92,156
MAA 152,92,152
MAA 152,88,136
MAA 136,80,136
MAA 136,84,152
buffer_load_dwordx4 a[144:147], v10, s[16:19], s52 offen sc1
MAA 140,84,156
MAA 140,80,140
MAA 92,72,140
MAA 92,76,156
MAA 88,76,152
MAA 88,72,136
MAA 72,64,136
buffer_load_dwordx4 a[148:151], v10, s[16:19], s52 offen offset:1024 sc1
MAA 72,68,152
s_add_u32 s52, s52, 131072
MAA 76,68,156
MAA 76,64,140
s_waitcnt vmcnt(18) lgkmcnt(0)
s_barrier
MAA 32,0,160
buffer_load_dwordx4 a[136:139], v11, s[16:19], s53 offen sc1
MAA 32,4,176
s_waitcnt vmcnt(9)
ds_read_b128 v[24:27], v2 offset:6144
v_add_f32 v20, v20, v28
MAA 36,4,180
TR 64,16,50688
v_add_f32 v21, v21, v29
MAA 36,0,164
TR 66,16,51200
v_add_f32 v22, v22, v30
MAA 52,8,164
TR 68,16,59136
v_add_f32 v23, v23, v31
MAA 52,12,180
ds_read_b128 v[28:31], v2 offset:7168
MAA 48,12,176
TR 70,16,59648
MAA 48,8,160
buffer_load_dwordx4 a[140:143], v11, s[16:19], s53 offen offset:1024 sc1
MAA 96,16,160
TR 72,16,50720
s_add_u32 s53, s53, 131072
MAA 96,20,176
TR 74,16,51232
s_waitcnt lgkmcnt(7)
v_add_f32 v20, v20, v24
MAA 100,20,180
TR 76,16,59168
v_add_f32 v21, v21, v25
MAA 100,16,164
TR 78,16,59680
v_add_f32 v22, v22, v26
MAA 116,24,164
TR 80,16,50752
v_add_f32 v23, v23, v27
MAA 116,28,180
TR 82,16,51264
s_waitcnt lgkmcnt(7)
v_add_f32 v20, v20, v28
MAA 112,28,176
buffer_load_dwordx4 a[152:155], v11, s[16:19], s53 offen sc1
MAA 112,24,160
TR 84,16,59200
v_add_f32 v21, v21, v29
MAA 160,32,160
TR 86,16,59712
v_add_f32 v22, v22, v30
MAA 160,36,176
TR 88,16,50784
v_add_f32 v23, v23, v31
MAA 164,36,180
TR 90,16,51296
MAA 164,32,164
TR 92,16,59232
MAA 180,40,164
TR 94,16,59744
MAA 180,44,180
buffer_load_dwordx4 a[156:159], v11, s[16:19], s53 offen offset:1024 sc1
MAA 176,44,176
TR 96,16,50816
s_add_u32 s53, s53, 131072
MAA 176,40,160
TR 98,16,51328
s_add_u32 m0, s55, 118272
MAA 224,48,160
TR 100,16,59264
MAA 224,52,176
TR 102,16,59776
MAA 228,52,180
TR 104,16,50848
MAA 228,48,164
TR 106,16,51360
MAA 236,56,164
buffer_load_dwordx4 v12, s[32:35], s54 offen   lds
MAA 236,60,180
TR 108,16,59296
MAA 232,60,176
TR 110,16,59808
MAA 232,56,160
TR 112,17,50688
MAA 188,40,172
TR 114,17,51200
MAA 188,44,188
TR 116,17,59136
MAA 184,44,184
TR 118,17,59648
MAA 184,40,168
buffer_load_dwordx4 v13, s[32:35], s54 offen offset:1056   lds
MAA 168,32,168
TR 120,17,50720
MAA 168,36,184
TR 122,17,51232
MAA 172,36,188
TR 124,17,59168
MAA 172,32,172
TR 126,17,59680
MAA 124,24,172
MAA 124,28,188
MAA 120,28,184
buffer_load_dwordx4 v14, s[32:35], s54 offen offset:2112   lds
MAA 120,24,168
MAA 104,16,168
MAA 104,20,184
MAA 108,20,188
MAA 108,16,172
MAA 60,8,172
MAA 60,12,188
buffer_load_dwordx4 v15, s[32:35], s54 offen offset:3168   lds
MAA 56,12,184
MAA 56,8,168
MAA 40,0,168
MAA 40,4,184
MAA 44,4,188
MAA 44,0,172
s_waitcnt lgkmcnt(0)
s_barrier
MAA 64,64,160
ds_read_b64_tr_b16 a[0:1], v16
s_add_u32 m0, s55, 135168
MAA 64,68,176
buffer_load_dwordx4 v12, s[80:83], s54 offen   lds
MAA 68,68,180
TR 2,16,512
v_permlane32_swap_b32 v20, v22
MAA 68,64,164
TR 4,16,8448
v_permlane32_swap_b32 v21, v23
MAA 84,72,164
TR 6,16,8960
v_add_f32 v20, v20, v22
MAA 84,76,180
TR 8,16,32
v_add_f32 v21, v21, v23
MAA 80,76,176
TR 10,16,544
v_mul_f32 v20, 0xba800000, v20
MAA 80,72,160
buffer_load_dwordx4 v13, s[80:83], s54 offen offset:1056   lds
MAA 128,80,160
TR 12,16,8480
v_mul_f32 v21, 0x3a800000, v21
MAA 128,84,176
TR 14,16,8992
v_fma_f32 v21, -v20, v20, v21
MAA 132,84,180
TR 16,16,64
v_max_f32 v21, 0, v21
MAA 132,80,164
TR 18,16,576
v_add_f32 v21, 0x3727c5ac, v21
MAA 148,88,164
TR 20,16,8512
v_rsq_f32 v22, v21
MAA 148,92,180
buffer_load_dwordx4 v14, s[80:83], s54 offen offset:2112   lds
MAA 144,92,176
TR 22,16,9024
v_and_b32 v24, 31, v1
MAA 144,88,160
TR 24,16,96
v_lshrrev_b32 v25, 5, v1
MAA 192,96,160
TR 26,16,608
v_lshl_add_u32 v24, v24, 1, v25
MAA 192,100,176
TR 28,16,8544
v_and_b32 v25, 0xc0, v0
MAA 196,100,180
TR 30,16,9056
v_add_u32 v24, v24, v25
MAA 196,96,164
TR 32,16,128
v_lshlrev_b32 v24, 4, v24
MAA 212,104,164
buffer_load_dwordx4 v15, s[80:83], s54 offen offset:3168   lds
MAA 212,108,180
TR 34,16,640
s_add_u32 s54, s54, 458752
MAA 208,108,176
TR 36,16,8576
v_add_u32 v24, 152576, v24
MAA 208,104,160
TR 38,16,9088
v_mul_f32 v22, 0xbfb8aa3b, v22
MAA 240,112,160
ds_write_b128 v24, v[20:23]
s_mov_b32 s58, s98
MAA 240,116,176
.Lpad24:
s_cbranch_execz .Lnopoll60r
ds_read_b64 v[20:21], v18
s_mov_b32 s67, s59
MAA 244,116,180
ds_read_b64 v[22:23], v18 offset:256
MAA 244,112,164
ds_read_b64 v[24:25], v19
MAA 252,120,164
ds_read_b64 v[26:27], v19 offset:256
MAA 252,124,180
ds_read_b32 a192, v18 offset:8
MAA 248,124,176
ds_read_b32 a193, v18 offset:264
v_mov_b32 v18, v5
MAA 248,120,160
buffer_load_dwordx4 a[160:163], v10, s[16:19], s52 offen sc1
MAA 220,104,172
ds_read_b32 a194, v19 offset:8
MAA 220,108,188
ds_read_b32 a195, v19 offset:264
v_add_u32 v19, 992, v5
MAA 216,108,184
TR 40,16,160
MAA 216,104,168
TR 42,16,672
MAA 200,96,168
TR 44,16,8608
MAA 200,100,184
TR 46,16,9120
MAA 204,100,188
buffer_load_dwordx4 a[164:167], v10, s[16:19], s52 offen offset:1024 sc1
MAA 204,96,172
ds_read_b64_tr_b16 a[48:49], v17
s_add_u32 s52, s52, 131072
MAA 156,88,172
TR 50,17,512
MAA 156,92,188
TR 52,17,8448
MAA 152,92,184
TR 54,17,8960
MAA 152,88,168
TR 56,17,32
MAA 136,80,168
TR 58,17,544
MAA 136,84,184
buffer_load_dwordx4 a[176:179], v10, s[16:19], s52 offen sc1
MAA 140,84,188
TR 60,17,8480
MAA 140,80,172
TR 62,17,8992
MAA 92,72,172
MAA 92,76,188
MAA 88,76,184
MAA 88,72,168
MAA 72,64,168
buffer_load_dwordx4 a[180:183], v10, s[16:19], s52 offen offset:1024 sc1
MAA 72,68,184
s_add_u32 s52, s52, 131072
MAA 76,68,188
MAA 76,64,172
s_waitcnt vmcnt(16) lgkmcnt(0)
s_barrier
MAA 32,0,128
ds_read_b128 v[28:31], v9 offset:512
MAA 32,4,144
ds_read_b128 v[4:7], v9 offset:576
MAA 36,4,148
buffer_load_dwordx4 a[168:171], v11, s[16:19], s53 offen sc1
MAA 36,0,132
TR 64,16,16896
MAA 52,8,132
TR 66,16,17408
MAA 52,12,148
TR 68,16,25344
MAA 48,12,144
TR 70,16,25856
MAA 48,8,128
TR 72,16,16928
MAA 96,16,128
buffer_load_dwordx4 a[172:175], v11, s[16:19], s53 offen offset:1024 sc1
MAA 96,20,144
TR 74,16,17440
s_add_u32 s53, s53, 131072
MAA 100,20,148
TR 76,16,25376
s_waitcnt lgkmcnt(8)
v_fmac_f32 v64, v28, v20
MAA 100,16,132
TR 78,16,25888
v_fmac_f32 v65, v29, v20
MAA 116,24,132
TR 80,16,16960
v_fmac_f32 v66, v30, v20
MAA 116,28,148
TR 82,16,17472
v_fmac_f32 v67, v31, v20
MAA 112,28,144
buffer_load_dwordx4 a[184:187], v11, s[16:19], s53 offen sc1
MAA 112,24,128
TR 84,16,25408
v_fmac_f32 v68, v28, v22
MAA 160,32,128
TR 86,16,25920
v_fmac_f32 v69, v29, v22
MAA 160,36,144
TR 88,16,16992
v_fmac_f32 v70, v30, v22
MAA 164,36,148
TR 90,16,17504
v_fmac_f32 v71, v31, v22
MAA 164,32,132
TR 92,16,25440
v_fmac_f32 v72, v28, v24
MAA 180,40,132
buffer_load_dwordx4 a[188:191], v11, s[16:19], s53 offen offset:1024 sc1
MAA 180,44,148
TR 94,16,25952
s_add_u32 s53, s53, 131072
MAA 176,44,144
TR 96,16,17024
s_add_u32 m0, s55, 84480
MAA 176,40,128
TR 98,16,17536
v_fmac_f32 v73, v29, v24
MAA 224,48,128
TR 100,16,25472
v_fmac_f32 v74, v30, v24
MAA 224,52,144
TR 102,16,25984
v_fmac_f32 v75, v31, v24
MAA 228,52,148
buffer_load_dwordx4 v12, s[32:35], s54 offen   lds
MAA 228,48,132
TR 104,16,17056
v_fmac_f32 v76, v28, v26
MAA 236,56,132
TR 106,16,17568
v_fmac_f32 v77, v29, v26
MAA 236,60,148
TR 108,16,25504
v_fmac_f32 v78, v30, v26
MAA 232,60,144
TR 110,16,26016
v_fmac_f32 v79, v31, v26
MAA 232,56,128
ds_read_b128 v[28:31], v9 offset:640
s_waitcnt lgkmcnt(15)
v_fmac_f32 v80, v4, v20
s_waitcnt vmcnt(17)
MAA 188,40,140
buffer_load_dwordx4 v13, s[32:35], s54 offen offset:1056   lds
MAA 188,44,156
TR 112,17,16896
v_fmac_f32 v81, v5, v20
MAA 184,44,152
TR 114,17,17408
v_fmac_f32 v82, v6, v20
MAA 184,40,136
TR 116,17,25344
v_fmac_f32 v83, v7, v20
MAA 168,32,136
TR 118,17,25856
v_fmac_f32 v84, v4, v22
MAA 168,36,152
TR 120,17,16928
v_fmac_f32 v85, v5, v22
MAA 172,36,156
buffer_load_dwordx4 v14, s[32:35], s54 offen offset:2112   lds
MAA 172,32,140
TR 122,17,17440
v_fmac_f32 v86, v6, v22
MAA 124,24,140
TR 124,17,25376
v_fmac_f32 v87, v7, v22
MAA 124,28,156
TR 126,17,25888
v_fmac_f32 v88, v4, v24
MAA 120,28,152
v_fmac_f32 v89, v5, v24
v_fmac_f32 v90, v6, v24
MAA 120,24,136
v_fmac_f32 v91, v7, v24
v_fmac_f32 v92, v4, v26
MAA 104,16,136
buffer_load_dwordx4 v15, s[32:35], s54 offen offset:3168   lds
MAA 104,20,152
s_mov_b32 m0, s67
v_fmac_f32 v93, v5, v26
v_fmac_f32 v94, v6, v26
MAA 108,20,156
v_fmac_f32 v95, v7, v26
s_waitcnt lgkmcnt(8)
v_fmac_f32 v128, v28, v20
MAA 108,16,140
ds_read_b128 v[4:7], v8 offset:512
v_fmac_f32 v129, v29, v20
MAA 60,8,140
v_fmac_f32 v130, v30, v20
v_fmac_f32 v131, v31, v20
MAA 60,12,156
v_fmac_f32 v132, v28, v22
v_fmac_f32 v133, v29, v22
MAA 56,12,152
buffer_load_dwordx4 v18, s[28:31], s58 offen lds
MAA 56,8,136
v_fmac_f32 v134, v30, v22
v_fmac_f32 v135, v31, v22
MAA 40,0,136
v_fmac_f32 v136, v28, v24
v_fmac_f32 v137, v29, v24
MAA 40,4,152
v_fmac_f32 v138, v30, v24
v_fmac_f32 v139, v31, v24
MAA 44,4,156
v_fmac_f32 v140, v28, v26
v_fmac_f32 v141, v29, v26
MAA 44,0,140
v_fmac_f32 v142, v30, v26
v_fmac_f32 v143, v31, v26
s_waitcnt lgkmcnt(0)
v_fmac_f32 v240, v4, v20
v_fmac_f32 v241, v5, v20
v_fmac_f32 v242, v6, v20
v_fmac_f32 v243, v7, v20
v_fmac_f32 v244, v4, v22
v_fmac_f32 v245, v5, v22
v_fmac_f32 v246, v6, v22
v_fmac_f32 v247, v7, v22
s_waitcnt vmcnt(17) lgkmcnt(0)
s_barrier
MAA 64,64,128
ds_read_b128 v[28:31], v9
s_add_u32 m0, s55, 101376
MAA 64,68,144
ds_read_b128 v[4:7], v9 offset:64
MAA 68,68,148
buffer_load_dwordx4 v12, s[80:83], s54 offen   lds
MAA 68,64,132
TR 0,16,33792
MAA 84,72,132
TR 2,16,34304
MAA 84,76,148
TR 4,16,42240
MAA 80,76,144
TR 6,16,42752
MAA 80,72,128
TR 8,16,33824
MAA 128,80,128
buffer_load_dwordx4 v13, s[80:83], s54 offen offset:1056   lds
MAA 128,84,144
TR 10,16,34336
s_waitcnt lgkmcnt(7)
v_fmac_f32 v32, v28, v20
MAA 132,84,148
TR 12,16,42272
v_fmac_f32 v33, v29, v20
MAA 132,80,132
TR 14,16,42784
v_fmac_f32 v34, v30, v20
MAA 148,88,132
TR 16,16,33856
v_fmac_f32 v35, v31, v20
MAA 148,92,148
TR 18,16,34368
v_fmac_f32 v36, v28, v22
MAA 144,92,144
buffer_load_dwordx4 v14, s[80:83], s54 offen offset:2112   lds
MAA 144,88,128
TR 20,16,42304
v_fmac_f32 v37, v29, v22
MAA 192,96,128
TR 22,16,42816
v_fmac_f32 v38, v30, v22
MAA 192,100,144
TR 24,16,33888
v_fmac_f32 v39, v31, v22
MAA 196,100,148
TR 26,16,34400
v_fmac_f32 v40, v28, v24
MAA 196,96,132
TR 28,16,42336
v_fmac_f32 v41, v29, v24
MAA 212,104,132
buffer_load_dwordx4 v15, s[80:83], s54 offen offset:3168   lds
MAA 212,108,148
TR 30,16,42848
s_add_u32 s54, s54, 458752
MAA 208,108,144
TR 32,16,33920
s_mov_b32 m0, s67
MAA 208,104,128
TR 34,16,34432
v_fmac_f32 v42, v30, v24
MAA 240,112,128
TR 36,16,42368
v_fmac_f32 v43, v31, v24
MAA 240,116,144
TR 38,16,42880
v_fmac_f32 v44, v28, v26
MAA 244,116,148
buffer_load_dwordx4 v19, s[28:31], s58 offen offset:1056 lds
MAA 244,112,132
TR 40,16,33952
s_add_u32 s67, s67, 8448
MAA 252,120,132
TR 42,16,34464
s_add_u32 s58, s58, 0x40000
MAA 252,124,148
TR 44,16,42400
v_fmac_f32 v45, v29, v26
MAA 248,124,144
TR 46,16,42912
v_fmac_f32 v46, v30, v26
MAA 248,120,128
TR 48,17,33792
v_fmac_f32 v47, v31, v26
MAA 220,104,140
ds_read_b128 v[28:31], v9 offset:128
s_waitcnt lgkmcnt(15)
v_fmac_f32 v48, v4, v20
MAA 220,108,156
buffer_load_dwordx4 a[128:131], v10, s[16:19], s52 offen sc1
MAA 216,108,152
TR 50,17,34304
v_fmac_f32 v49, v5, v20
MAA 216,104,136
TR 52,17,42240
v_fmac_f32 v50, v6, v20
MAA 200,96,136
TR 54,17,42752
v_fmac_f32 v51, v7, v20
MAA 200,100,152
TR 56,17,33824
v_fmac_f32 v52, v4, v22
MAA 204,100,156
TR 58,17,34336
v_fmac_f32 v53, v5, v22
MAA 204,96,140
buffer_load_dwordx4 a[132:135], v10, s[16:19], s52 offen offset:1024 sc1
MAA 156,88,140
TR 60,17,42272
s_add_u32 s52, s52, 131072
MAA 156,92,156
TR 62,17,42784
v_fmac_f32 v54, v6, v22
MAA 152,92,152
v_fmac_f32 v55, v7, v22
v_fmac_f32 v56, v4, v24
MAA 152,88,136
v_fmac_f32 v57, v5, v24
v_fmac_f32 v58, v6, v24
MAA 136,80,136
v_fmac_f32 v59, v7, v24
v_fmac_f32 v60, v4, v26
MAA 136,84,152
buffer_load_dwordx4 a[144:147], v10, s[16:19], s52 offen sc1
MAA 140,84,156
v_fmac_f32 v61, v5, v26
v_fmac_f32 v62, v6, v26
MAA 140,80,140
v_fmac_f32 v63, v7, v26
s_waitcnt lgkmcnt(7)
v_fmac_f32 v96, v28, v20
MAA 92,72,140
ds_read_b128 v[4:7], v8
v_fmac_f32 v97, v29, v20
MAA 92,76,156
v_fmac_f32 v98, v30, v20
v_fmac_f32 v99, v31, v20
MAA 88,76,152
v_fmac_f32 v100, v28, v22
v_fmac_f32 v101, v29, v22
MAA 88,72,136
buffer_load_dwordx4 a[148:151], v10, s[16:19], s52 offen offset:1024 sc1
MAA 72,64,136
s_add_u32 s52, s52, 131072
v_fmac_f32 v102, v30, v22
v_fmac_f32 v103, v31, v22
MAA 72,68,152
v_fmac_f32 v104, v28, v24
v_fmac_f32 v105, v29, v24
MAA 76,68,156
v_fmac_f32 v106, v30, v24
v_fmac_f32 v107, v31, v24
MAA 76,64,140
v_fmac_f32 v108, v28, v26
v_fmac_f32 v109, v29, v26
v_fmac_f32 v110, v30, v26
v_fmac_f32 v111, v31, v26
s_waitcnt lgkmcnt(0)
v_fmac_f32 v224, v4, v20
v_fmac_f32 v225, v5, v20
v_fmac_f32 v226, v6, v20
v_fmac_f32 v227, v7, v20
v_fmac_f32 v228, v4, v22
v_fmac_f32 v229, v5, v22
v_fmac_f32 v230, v6, v22
v_fmac_f32 v231, v7, v22
s_waitcnt vmcnt(18) lgkmcnt(0)
s_barrier
MAA 32,0,160
ds_read_b128 v[28:31], v9 offset:704
MAA 32,4,176
ds_read_b128 v[4:7], v9 offset:768
MAA 36,4,180
buffer_load_dwordx4 a[136:139], v11, s[16:19], s53 offen sc1
MAA 36,0,164
TR 64,16,50688
MAA 52,8,164
TR 66,16,51200
MAA 52,12,180
TR 68,16,59136
MAA 48,12,176
TR 70,16,59648
MAA 48,8,160
TR 72,16,50720
MAA 96,16,160
buffer_load_dwordx4 a[140:143], v11, s[16:19], s53 offen offset:1024 sc1
MAA 96,20,176
TR 74,16,51232
s_add_u32 s53, s53, 131072
MAA 100,20,180
TR 76,16,59168
s_waitcnt lgkmcnt(8)
v_fmac_f32 v144, v28, v20
MAA 100,16,164
TR 78,16,59680
v_fmac_f32 v145, v29, v20
MAA 116,24,164
TR 80,16,50752
v_fmac_f32 v146, v30, v20
MAA 116,28,180
TR 82,16,51264
v_fmac_f32 v147, v31, v20
MAA 112,28,176
buffer_load_dwordx4 a[152:155], v11, s[16:19], s53 offen sc1
MAA 112,24,160
TR 84,16,59200
v_fmac_f32 v148, v28, v22
MAA 160,32,160
TR 86,16,59712
v_fmac_f32 v149, v29, v22
MAA 160,36,176
TR 88,16,50784
v_fmac_f32 v150, v30, v22
MAA 164,36,180
TR 90,16,51296
v_fmac_f32 v151, v31, v22
MAA 164,32,164
TR 92,16,59232
v_fmac_f32 v152, v28, v24
MAA 180,40,164
buffer_load_dwordx4 a[156:159], v11, s[16:19], s53 offen offset:1024 sc1
MAA 180,44,180
TR 94,16,59744
s_add_u32 s53, s53, 131072
MAA 176,44,176
TR 96,16,50816
s_add_u32 m0, s55, 118272
MAA 176,40,160
TR 98,16,51328
v_fmac_f32 v153, v29, v24
MAA 224,48,160
TR 100,16,59264
v_fmac_f32 v154, v30, v24
MAA 224,52,176
TR 102,16,59776
v_fmac_f32 v155, v31, v24
MAA 228,52,180
buffer_load_dwordx4 v12, s[32:35], s54 offen   lds
MAA 228,48,164
TR 104,16,50848
v_fmac_f32 v156, v28, v26
MAA 236,56,164
TR 106,16,51360
v_fmac_f32 v157, v29, v26
MAA 236,60,180
TR 108,16,59296
v_fmac_f32 v158, v30, v26
MAA 232,60,176
TR 110,16,59808
v_fmac_f32 v159, v31, v26
MAA 232,56,160
ds_read_b128 v[28:31], v9 offset:832
s_waitcnt lgkmcnt(15)
v_fmac_f32 v192, v4, v20
s_waitcnt vmcnt(19)
MAA 188,40,172
buffer_load_dwordx4 v13, s[32:35], s54 offen offset:1056   lds
MAA 188,44,188
TR 112,17,50688
v_fmac_f32 v193, v5, v20
MAA 184,44,184
TR 114,17,51200
v_fmac_f32 v194, v6, v20
MAA 184,40,168
TR 116,17,59136
v_fmac_f32 v195, v7, v20
MAA 168,32,168
TR 118,17,59648
v_fmac_f32 v196, v4, v22
MAA 168,36,184
TR 120,17,50720
v_fmac_f32 v197, v5, v22
MAA 172,36,188
buffer_load_dwordx4 v14, s[32:35], s54 offen offset:2112   lds
MAA 172,32,172
TR 122,17,51232
v_fmac_f32 v198, v6, v22
MAA 124,24,172
TR 124,17,59168
v_fmac_f32 v199, v7, v22
MAA 124,28,188
TR 126,17,59680
v_fmac_f32 v200, v4, v24
MAA 120,28,184
v_fmac_f32 v201, v5, v24
v_fmac_f32 v202, v6, v24
MAA 120,24,168
v_fmac_f32 v203, v7, v24
v_fmac_f32 v204, v4, v26
MAA 104,16,168
buffer_load_dwordx4 v15, s[32:35], s54 offen offset:3168   lds
MAA 104,20,184
s_mov_b32 m0, s67
v_fmac_f32 v205, v5, v26
v_fmac_f32 v206, v6, v26
MAA 108,20,188
v_fmac_f32 v207, v7, v26
s_waitcnt lgkmcnt(8)
v_fmac_f32 v208, v28, v20
MAA 108,16,172
ds_read_b128 v[4:7], v8 offset:576
v_fmac_f32 v209, v29, v20
MAA 60,8,172
v_fmac_f32 v210, v30, v20
v_fmac_f32 v211, v31, v20
MAA 60,12,188
v_fmac_f32 v212, v28, v22
v_fmac_f32 v213, v29, v22
MAA 56,12,184
buffer_load_dwordx4 v18, s[28:31], s58 offen lds
MAA 56,8,168
v_fmac_f32 v214, v30, v22
v_fmac_f32 v215, v31, v22
MAA 40,0,168
v_fmac_f32 v216, v28, v24
v_fmac_f32 v217, v29, v24
MAA 40,4,184
v_fmac_f32 v218, v30, v24
v_fmac_f32 v219, v31, v24
MAA 44,4,188
v_fmac_f32 v220, v28, v26
v_fmac_f32 v221, v29, v26
MAA 44,0,172
v_fmac_f32 v222, v30, v26
v_fmac_f32 v223, v31, v26
s_waitcnt lgkmcnt(0)
v_fmac_f32 v248, v4, v20
v_fmac_f32 v249, v5, v20
v_fmac_f32 v250, v6, v20
v_fmac_f32 v251, v7, v20
v_fmac_f32 v252, v4, v22
v_fmac_f32 v253, v5, v22
v_fmac_f32 v254, v6, v22
v_fmac_f32 v255, v7, v22
s_waitcnt vmcnt(19) lgkmcnt(0)
s_barrier
MAA 64,64,160
ds_read_b128 v[28:31], v9 offset:192
s_add_u32 m0, s55, 135168
MAA 64,68,176
ds_read_b128 v[4:7], v9 offset:256
MAA 68,68,180
buffer_load_dwordx4 v12, s[80:83], s54 offen   lds
MAA 68,64,164
ds_read_b64_tr_b16 a[0:1], v16
MAA 84,72,164
TR 2,16,512
MAA 84,76,180
TR 4,16,8448
MAA 80,76,176
TR 6,16,8960
MAA 80,72,160
TR 8,16,32
MAA 128,80,160
buffer_load_dwordx4 v13, s[80:83], s54 offen offset:1056   lds
MAA 128,84,176
TR 10,16,544
s_waitcnt lgkmcnt(7)
v_fmac_f32 v112, v28, v20
MAA 132,84,180
TR 12,16,8480
v_fmac_f32 v113, v29, v20
MAA 132,80,164
TR 14,16,8992
v_fmac_f32 v114, v30, v20
MAA 148,88,164
TR 16,16,64
v_fmac_f32 v115, v31, v20
MAA 148,92,180
TR 18,16,576
v_fmac_f32 v116, v28, v22
MAA 144,92,176
buffer_load_dwordx4 v14, s[80:83], s54 offen offset:2112   lds
MAA 144,88,160
TR 20,16,8512
v_fmac_f32 v117, v29, v22
MAA 192,96,160
TR 22,16,9024
v_fmac_f32 v118, v30, v22
MAA 192,100,176
TR 24,16,96
v_fmac_f32 v119, v31, v22
.Lpad25:
s_cbranch_execz .Lnopoll60r
MAA 196,100,180
TR 26,16,608
v_fmac_f32 v120, v28, v24
MAA 196,96,164
TR 28,16,8544
v_fmac_f32 v121, v29, v24
MAA 212,104,164
buffer_load_dwordx4 v15, s[80:83], s54 offen offset:3168   lds
MAA 212,108,180
TR 30,16,9056
s_add_u32 s54, s54, 458752
MAA 208,108,176
TR 32,16,128
s_mov_b32 m0, s67
MAA 208,104,160
TR 34,16,640
v_fmac_f32 v122, v30, v24
MAA 240,112,160
TR 36,16,8576
v_fmac_f32 v123, v31, v24
MAA 240,116,176
TR 38,16,9088
v_fmac_f32 v124, v28, v26
MAA 244,116,180
buffer_load_dwordx4 v19, s[28:31], s58 offen offset:1056 lds
MAA 244,112,164
TR 40,16,160
s_add_u32 s67, s67, 8448
MAA 252,120,164
TR 42,16,672
s_add_u32 s46, s46, 1
MAA 252,124,180
TR 44,16,8608
s_xor_b32 s58, s46, s87
MAA 248,124,176
TR 46,16,9120
s_mul_i32 s58, s58, 458752
MAA 248,120,160
ds_read_b64_tr_b16 a[48:49], v17
v_fmac_f32 v125, v29, v26
MAA 220,104,172
buffer_load_dwordx4 a[160:163], v10, s[16:19], s52 offen sc1
MAA 220,108,188
TR 50,17,512
v_fmac_f32 v126, v30, v26
MAA 216,108,184
TR 52,17,8448
v_fmac_f32 v127, v31, v26
MAA 216,104,168
ds_read_b128 v[28:31], v9 offset:320
s_waitcnt lgkmcnt(15)
v_fmac_f32 v160, v4, v20
MAA 200,96,168
TR 54,17,8960
v_fmac_f32 v161, v5, v20
MAA 200,100,184
TR 56,17,32
v_fmac_f32 v162, v6, v20
MAA 204,100,188
buffer_load_dwordx4 a[164:167], v10, s[16:19], s52 offen offset:1024 sc1
MAA 204,96,172
TR 58,17,544
s_add_u32 s52, s52, 131072
MAA 156,88,172
TR 60,17,8480
v_fmac_f32 v163, v7, v20
MAA 156,92,188
TR 62,17,8992
v_fmac_f32 v164, v4, v22
MAA 152,92,184
v_fmac_f32 v165, v5, v22
v_fmac_f32 v166, v6, v22
MAA 152,88,168
v_fmac_f32 v167, v7, v22
v_fmac_f32 v168, v4, v24
MAA 136,80,168
buffer_load_dwordx4 a[176:179], v10, s[16:19], s52 offen sc1
MAA 136,84,184
v_fmac_f32 v169, v5, v24
v_fmac_f32 v170, v6, v24
MAA 140,84,188
v_fmac_f32 v171, v7, v24
v_fmac_f32 v172, v4, v26
MAA 140,80,172
v_fmac_f32 v173, v5, v26
v_fmac_f32 v174, v6, v26
MAA 92,72,172
v_fmac_f32 v175, v7, v26
s_waitcnt lgkmcnt(5)
v_fmac_f32 v176, v28, v20
MAA 92,76,188
ds_read_b128 v[4:7], v8 offset:64
v_fmac_f32 v177, v29, v20
MAA 88,76,184
buffer_load_dwordx4 a[180:183], v10, s[16:19], s52 offen offset:1024 sc1
MAA 88,72,168
s_add_u32 s52, s52, 131072
v_fmac_f32 v178, v30, v20
v_fmac_f32 v179, v31, v20
MAA 72,64,168
v_fmac_f32 v180, v28, v22
v_fmac_f32 v181, v29, v22
MAA 72,68,184
v_fmac_f32 v182, v30, v22
v_fmac_f32 v183, v31, v22
MAA 76,68,188
v_fmac_f32 v184, v28, v24
v_fmac_f32 v185, v29, v24
MAA 76,64,172
v_fmac_f32 v186, v30, v24
v_fmac_f32 v187, v31, v24
v_fmac_f32 v188, v28, v26
v_fmac_f32 v189, v29, v26
v_fmac_f32 v190, v30, v26
v_fmac_f32 v191, v31, v26
v_accvgpr_read_b32 v28, a192
s_waitcnt lgkmcnt(0)
v_fmac_f32 v232, v4, v20
v_fmac_f32 v233, v5, v20
v_fmac_f32 v234, v6, v20
v_fmac_f32 v235, v7, v20
v_fmac_f32 v236, v4, v22
v_fmac_f32 v237, v5, v22
v_fmac_f32 v238, v6, v22
v_fmac_f32 v239, v7, v22
v_accvgpr_read_b32 v29, a193
v_accvgpr_read_b32 v30, a194
v_accvgpr_read_b32 v31, a195
s_mov_b32 s15, -4
.p2align 6
.Lk65:
s_waitcnt vmcnt(18) lgkmcnt(0)
s_barrier
MAA 32,0,128
TR 64,16,16896
MAA 32,4,144
buffer_load_dwordx4 a[168:171], v11, s[16:19], s53 offen sc1
MAA 36,4,148
TR 66,16,17408
MAA 36,0,132
TR 68,16,25344
MAA 52,8,132
TR 70,16,25856
MAA 52,12,148
MAA 48,12,144
TR 72,16,16928
MAA 48,8,128
buffer_load_dwordx4 a[172:175], v11, s[16:19], s53 offen offset:1024 sc1
MAA 96,16,128
TR 74,16,17440
s_add_u32 s53, s53, 131072
MAA 96,20,144
TR 76,16,25376
MAA 100,20,148
MAA 100,16,132
TR 78,16,25888
MAA 116,24,132
TR 80,16,16960
MAA 116,28,148
buffer_load_dwordx4 a[184:187], v11, s[16:19], s53 offen sc1
MAA 112,28,144
TR 82,16,17472
MAA 112,24,128
MAA 160,32,128
TR 84,16,25408
MAA 160,36,144
TR 86,16,25920
MAA 164,36,148
TR 88,16,16992
MAA 164,32,132
buffer_load_dwordx4 a[188:191], v11, s[16:19], s53 offen offset:1024 sc1
MAA 180,40,132
s_add_u32 s53, s53, 131072
MAA 180,44,148
TR 90,16,17504
MAA 176,44,144
TR 92,16,25440
MAA 176,40,128
TR 94,16,25952
MAA 224,48,128
s_add_u32 m0, s55, 84480
MAA 224,52,144
buffer_load_dwordx4 v12, s[32:35], s54 offen   lds
MAA 228,52,148
TR 96,16,17024
MAA 228,48,132
TR 98,16,17536
MAA 236,56,132
TR 100,16,25472
MAA 236,60,148
TR 102,16,25984
MAA 232,60,144
MAA 232,56,128
TR 104,16,17056
s_waitcnt vmcnt(19)
MAA 188,40,140
TR 106,16,17568
MAA 188,44,156
buffer_load_dwordx4 v13, s[32:35], s54 offen offset:1056   lds
MAA 184,44,152
TR 108,16,25504
MAA 184,40,136
MAA 168,32,136
TR 110,16,26016
MAA 168,36,152
buffer_load_dwordx4 v14, s[32:35], s54 offen offset:2112   lds
MAA 172,36,156
TR 112,17,16896
MAA 172,32,140
TR 114,17,17408
MAA 124,24,140
MAA 124,28,156
TR 116,17,25344
MAA 120,28,152
TR 118,17,25856
MAA 120,24,136
buffer_load_dwordx4 v15, s[32:35], s54 offen offset:3168   lds
MAA 104,16,136
TR 120,17,16928
MAA 104,20,152
MAA 108,20,156
TR 122,17,17440
MAA 108,16,140
TR 124,17,25376
MAA 60,8,140
TR 126,17,25888
s_mov_b32 m0, s67
MAA 60,12,156
buffer_load_dwordx4 v18, s[28:31], s58 offen lds
MAA 56,12,152
MAA 56,8,136
MAA 40,0,136
MAA 40,4,152
MAA 44,4,156
MAA 44,0,140
s_waitcnt vmcnt(19) lgkmcnt(0)
s_barrier
MAA 64,64,128
TR 0,16,33792
s_add_u32 m0, s55, 101376
MAA 64,68,144
buffer_load_dwordx4 v12, s[80:83], s54 offen   lds
MAA 68,68,148
TR 2,16,34304
MAA 68,64,132
TR 4,16,42240
MAA 84,72,132
TR 6,16,42752
MAA 84,76,148
MAA 80,76,144
TR 8,16,33824
MAA 80,72,128
buffer_load_dwordx4 v13, s[80:83], s54 offen offset:1056   lds
MAA 128,80,128
TR 10,16,34336
MAA 128,84,144
TR 12,16,42272
MAA 132,84,148
TR 14,16,42784
MAA 132,80,132
MAA 148,88,132
TR 16,16,33856
MAA 148,92,148
buffer_load_dwordx4 v14, s[80:83], s54 offen offset:2112   lds
MAA 144,92,144
TR 18,16,34368
MAA 144,88,128
TR 20,16,42304
MAA 192,96,128
MAA 192,100,144
TR 22,16,42816
MAA 196,100,148
TR 24,16,33888
MAA 196,96,132
buffer_load_dwordx4 v15, s[80:83], s54 offen offset:3168   lds
MAA 212,104,132
TR 26,16,34400
s_add_u32 s54, s54, 458752
MAA 212,108,148
TR 28,16,42336
MAA 208,108,144
MAA 208,104,128
TR 30,16,42848
MAA 240,112,128
TR 32,16,33920
s_mov_b32 m0, s67
MAA 240,116,144
buffer_load_dwordx4 v19, s[28:31], s58 offen offset:1056 lds
MAA 244,116,148
s_add_u32 s67, s67, 8448
s_add_u32 s58, s58, 0x40000
MAA 244,112,132
TR 34,16,34432
MAA 252,120,132
MAA 252,124,148
TR 36,16,42368
MAA 248,124,144
TR 38,16,42880
MAA 248,120,128
buffer_load_dwordx4 a[128:131], v10, s[16:19], s52 offen sc1
MAA 220,104,140
TR 40,16,33952
MAA 220,108,156
TR 42,16,34464
MAA 216,108,152
MAA 216,104,136
TR 44,16,42400
MAA 200,96,136
TR 46,16,42912
MAA 200,100,152
buffer_load_dwordx4 a[132:135], v10, s[16:19], s52 offen offset:1024 sc1
MAA 204,100,156
TR 48,17,33792
s_add_u32 s52, s52, 131072
MAA 204,96,140
MAA 156,88,140
TR 50,17,34304
MAA 156,92,156
TR 52,17,42240
MAA 152,92,152
TR 54,17,42752
MAA 152,88,136
buffer_load_dwordx4 a[144:147], v10, s[16:19], s52 offen sc1
MAA 136,80,136
TR 56,17,33824
MAA 136,84,152
MAA 140,84,156
TR 58,17,34336
MAA 140,80,140
TR 60,17,42272
MAA 92,72,140
TR 62,17,42784
MAA 92,76,156
buffer_load_dwordx4 a[148:151], v10, s[16:19], s52 offen offset:1024 sc1
MAA 88,76,152
s_add_u32 s52, s52, 131072
MAA 88,72,136
MAA 72,64,136
MAA 72,68,152
MAA 76,68,156
MAA 76,64,140
s_waitcnt vmcnt(18) lgkmcnt(0)
s_barrier
MAA 32,0,160
TR 64,16,50688
MAA 32,4,176
buffer_load_dwordx4 a[136:139], v11, s[16:19], s53 offen sc1
MAA 36,4,180
TR 66,16,51200
MAA 36,0,164
TR 68,16,59136
MAA 52,8,164
TR 70,16,59648
MAA 52,12,180
MAA 48,12,176
TR 72,16,50720
MAA 48,8,160
buffer_load_dwordx4 a[140:143], v11, s[16:19], s53 offen offset:1024 sc1
MAA 96,16,160
TR 74,16,51232
s_add_u32 s53, s53, 131072
MAA 96,20,176
TR 76,16,59168
MAA 100,20,180
MAA 100,16,164
TR 78,16,59680
MAA 116,24,164
TR 80,16,50752
MAA 116,28,180
buffer_load_dwordx4 a[152:155], v11, s[16:19], s53 offen sc1
MAA 112,28,176
TR 82,16,51264
MAA 112,24,160
MAA 160,32,160
TR 84,16,59200
MAA 160,36,176
TR 86,16,59712
MAA 164,36,180
TR 88,16,50784
MAA 164,32,164
buffer_load_dwordx4 a[156:159], v11, s[16:19], s53 offen offset:1024 sc1
MAA 180,40,164
s_add_u32 s53, s53, 131072
MAA 180,44,180
TR 90,16,51296
MAA 176,44,176
TR 92,16,59232
MAA 176,40,160
TR 94,16,59744
MAA 224,48,160
s_add_u32 m0, s55, 118272
MAA 224,52,176
buffer_load_dwordx4 v12, s[32:35], s54 offen   lds
MAA 228,52,180
TR 96,16,50816
MAA 228,48,164
TR 98,16,51328
MAA 236,56,164
TR 100,16,59264
MAA 236,60,180
TR 102,16,59776
MAA 232,60,176
MAA 232,56,160
TR 104,16,50848
s_waitcnt vmcnt(19)
MAA 188,40,172
TR 106,16,51360
MAA 188,44,188
buffer_load_dwordx4 v13, s[32:35], s54 offen offset:1056   lds
MAA 184,44,184
TR 108,16,59296
MAA 184,40,168
MAA 168,32,168
TR 110,16,59808
MAA 168,36,184
buffer_load_dwordx4 v14, s[32:35], s54 offen offset:2112   lds
MAA 172,36,188
TR 112,17,50688
MAA 172,32,172
TR 114,17,51200
MAA 124,24,172
MAA 124,28,188
TR 116,17,59136
MAA 120,28,184
TR 118,17,59648
MAA 120,24,168
buffer_load_dwordx4 v15, s[32:35], s54 offen offset:3168   lds
MAA 104,16,168
TR 120,17,50720
MAA 104,20,184
MAA 108,20,188
TR 122,17,51232
MAA 108,16,172
TR 124,17,59168
MAA 60,8,172
TR 126,17,59680
s_mov_b32 m0, s67
MAA 60,12,188
buffer_load_dwordx4 v18, s[28:31], s58 offen lds
MAA 56,12,184
MAA 56,8,168
MAA 40,0,168
MAA 40,4,184
MAA 44,4,188
MAA 44,0,172
s_waitcnt vmcnt(19) lgkmcnt(0)
s_barrier
MAA 64,64,160
ds_read_b64_tr_b16 a[0:1], v16
s_add_u32 m0, s55, 135168
MAA 64,68,176
buffer_load_dwordx4 v12, s[80:83], s54 offen   lds
MAA 68,68,180
TR 2,16,512
MAA 68,64,164
TR 4,16,8448
MAA 84,72,164
TR 6,16,8960
MAA 84,76,180
MAA 80,76,176
TR 8,16,32
MAA 80,72,160
buffer_load_dwordx4 v13, s[80:83], s54 offen offset:1056   lds
MAA 128,80,160
TR 10,16,544
MAA 128,84,176
TR 12,16,8480
MAA 132,84,180
TR 14,16,8992
MAA 132,80,164
MAA 148,88,164
TR 16,16,64
MAA 148,92,180
buffer_load_dwordx4 v14, s[80:83], s54 offen offset:2112   lds
MAA 144,92,176
TR 18,16,576
MAA 144,88,160
TR 20,16,8512
MAA 192,96,160
MAA 192,100,176
TR 22,16,9024
MAA 196,100,180
TR 24,16,96
MAA 196,96,164
buffer_load_dwordx4 v15, s[80:83], s54 offen offset:3168   lds
MAA 212,104,164
TR 26,16,608
s_add_u32 s54, s54, 458752
MAA 212,108,180
TR 28,16,8544
MAA 208,108,176
MAA 208,104,160
TR 30,16,9056
MAA 240,112,160
TR 32,16,128
s_mov_b32 m0, s67
MAA 240,116,176
buffer_load_dwordx4 v19, s[28:31], s58 offen offset:1056 lds
MAA 244,116,180
s_add_u32 s67, s67, 8448
s_add_u32 s46, s46, 1
s_xor_b32 s58, s46, s87
s_mul_i32 s58, s58, 458752
MAA 244,112,164
TR 34,16,640
MAA 252,120,164
MAA 252,124,180
TR 36,16,8576
MAA 248,124,176
TR 38,16,9088
MAA 248,120,160
buffer_load_dwordx4 a[160:163], v10, s[16:19], s52 offen sc1
MAA 220,104,172
TR 40,16,160
MAA 220,108,188
TR 42,16,672
MAA 216,108,184
MAA 216,104,168
TR 44,16,8608
MAA 200,96,168
TR 46,16,9120
MAA 200,100,184
buffer_load_dwordx4 a[164:167], v10, s[16:19], s52 offen offset:1024 sc1
MAA 204,100,188
ds_read_b64_tr_b16 a[48:49], v17
s_add_u32 s52, s52, 131072
MAA 204,96,172
MAA 156,88,172
TR 50,17,512
MAA 156,92,188
TR 52,17,8448
MAA 152,92,184
TR 54,17,8960
MAA 152,88,168
buffer_load_dwordx4 a[176:179], v10, s[16:19], s52 offen sc1
MAA 136,80,168
TR 56,17,32
MAA 136,84,184
MAA 140,84,188
TR 58,17,544
MAA 140,80,172
TR 60,17,8480
MAA 92,72,172
TR 62,17,8992
MAA 92,76,188
buffer_load_dwordx4 a[180:183], v10, s[16:19], s52 offen offset:1024 sc1
MAA 88,76,184
.Lpad26:
s_cbranch_execz .Lnopoll60r
s_add_u32 s52, s52, 131072
MAA 88,72,168
MAA 72,64,168
MAA 72,68,184
MAA 76,68,188
s_add_u32 s15, s15, 1
MAA 76,64,172
s_cbranch_scc0 .Lk65
s_waitcnt vmcnt(10) lgkmcnt(0)
s_barrier
MAA 32,0,128
buffer_load_dwordx4 a[168:171], v11, s[16:19], s53 offen sc1
MAA 32,4,144
TR 64,16,16896
s_add_u32 s58, s99, 2293760
MAA 48,12,144
TR 66,16,17408
s_lshl_b32 s74, s3, 11
MAA 48,8,128
TR 68,16,25344
s_add_u32 s74, s74, s84
MAA 36,0,132
buffer_load_dwordx4 a[172:175], v11, s[16:19], s53 offen offset:1024 sc1
MAA 36,4,148
TR 70,16,25856
s_add_u32 s53, s53, 131072
MAA 52,12,148
TR 72,16,16928
v_lshl_add_u32 v4, v1, 4, s74
MAA 52,8,132
TR 74,16,17440
v_lshrrev_b32 v2, 3, v1
MAA 40,0,136
buffer_load_dwordx4 a[184:187], v11, s[16:19], s53 offen sc1
MAA 40,4,152
TR 76,16,25376
v_cmp_eq_u32 vcc, 3, v2
MAA 56,12,152
TR 78,16,25888
v_add_u32 v2, 67108480, v4
MAA 56,8,136
TR 80,16,33792
v_cndmask_b32 v4, v4, v2, vcc
MAA 44,0,140
buffer_load_dwordx4 a[188:191], v11, s[16:19], s53 offen offset:1024 sc1
MAA 44,4,156
TR 82,16,34304
s_add_u32 s53, s53, 131072
MAA 60,12,156
TR 84,16,42240
s_and_b32 s74, s7, 1
MAA 60,8,140
TR 86,16,42752
s_add_u32 s54, s98, 65536
MAA 96,16,128
TR 88,16,33824
v_bfe_u32 v7, v1, 2, 3
MAA 96,20,144
TR 90,16,34336
v_mul_u32_u24 v7, 1056, v7
MAA 112,28,144
TR 92,16,42272
s_waitcnt vmcnt(9)
s_barrier
MAA 112,24,128
TR 94,16,42784
v_bfe_u32 v2, v1, 5, 1
MAA 100,16,132
TR 96,16,50688
v_lshl_add_u32 v7, v2, 8, v7
MAA 100,20,148
TR 98,16,51200
v_and_b32 v2, 3, v1
MAA 116,28,148
TR 100,16,59136
v_lshl_add_u32 v7, v2, 3, v7
MAA 116,24,132
TR 102,16,59648
s_lshl_b32 s74, s74, 7
MAA 104,16,136
TR 104,16,50720
s_xor_b32 s75, s74, 128
MAA 104,20,152
TR 106,16,51232
v_add_u32 v6, s75, v7
MAA 120,28,152
TR 108,16,59168
v_add_u32 v7, s74, v7
MAA 120,24,136
TR 110,16,59680
s_mul_i32 s55, s3, 2112
MAA 108,16,140
TR 112,16,16960
s_mov_b32 s57, 67584
MAA 108,20,156
TR 114,16,17472
MAA 124,28,156
TR 116,16,25408
MAA 124,24,140
TR 118,16,25920
MAA 160,32,128
TR 120,16,16992
MAA 160,36,144
TR 122,16,17504
MAA 176,44,144
TR 124,16,25440
MAA 176,40,128
TR 126,16,25952
MAA 164,32,132
TR 192,16,33856
MAA 164,36,148
TR 194,16,34368
MAA 180,44,148
TR 196,16,42304
MAA 180,40,132
TR 198,16,42816
MAA 168,32,136
TR 200,16,33888
MAA 168,36,152
TR 202,16,34400
MAA 184,44,152
TR 204,16,42336
MAA 184,40,136
TR 206,16,42848
MAA 172,32,140
TR 208,16,50752
MAA 172,36,156
TR 210,16,51264
MAA 188,44,156
TR 212,16,59200
MAA 188,40,140
TR 214,16,59712
MAA 224,48,128
TR 216,16,50784
MAA 224,52,144
TR 218,16,51296
MAA 232,60,144
TR 220,16,59232
MAA 232,56,128
TR 222,16,59744
MAA 228,48,132
TR 0,16,17024
MAA 228,52,148
TR 2,16,17536
MAA 236,60,148
TR 4,16,25472
MAA 236,56,132
TR 6,16,25984
s_waitcnt lgkmcnt(15)
MAA 64,64,128
TR 8,16,17056
MAA 64,68,144
TR 10,16,17568
s_waitcnt vmcnt(7)
MAA 64,96,160
TR 12,16,25504
s_waitcnt vmcnt(5)
MAA 64,100,176
TR 14,16,26016
MAA 80,108,176
TR 16,16,33920
MAA 80,104,160
TR 18,16,34432
MAA 80,76,144
TR 20,16,42368
MAA 80,72,128
TR 22,16,42880
MAA 32,80,160
TR 24,16,33952
MAA 32,84,176
TR 26,16,34464
MAA 48,92,176
TR 28,16,42400
MAA 48,88,160
TR 30,16,42912
s_nop 2
v_pk_mul_f32 v[64:65], v[64:65], v[32:33]
TR 32,16,50816
TR 34,16,51328
v_pk_mul_f32 v[32:33], v[32:33], v[28:29] op_sel_hi:[1,0]
v_pk_mul_f32 v[66:67], v[66:67], v[34:35]
v_pk_mul_f32 v[34:35], v[34:35], v[28:29] op_sel_hi:[1,0]
v_exp_f32 v32, v32
v_pk_mul_f32 v[80:81], v[80:81], v[48:49]
v_pk_mul_f32 v[48:49], v[48:49], v[28:29] op_sel_hi:[1,0]
v_pk_mul_f32 v[82:83], v[82:83], v[50:51]
v_pk_mul_f32 v[50:51], v[50:51], v[28:29] op_sel_hi:[1,0]
v_exp_f32 v33, v33
v_exp_f32 v34, v34
MAA 68,64,132
TR 36,16,59264
v_exp_f32 v35, v35
MAA 68,68,148
TR 38,16,59776
v_exp_f32 v48, v48
MAA 68,96,164
TR 40,16,50848
v_exp_f32 v49, v49
s_waitcnt vmcnt(4)
MAA 68,100,180
TR 42,16,51360
v_exp_f32 v50, v50
MAA 84,108,180
TR 44,16,59296
v_exp_f32 v51, v51
MAA 84,104,164
TR 46,16,59808
MAA 84,76,148
TR 48,17,16896
MAA 84,72,132
TR 50,17,17408
MAA 36,80,164
TR 52,17,25344
MAA 36,84,180
TR 54,17,25856
MAA 52,92,180
TR 56,17,16928
MAA 52,88,164
TR 58,17,17440
s_nop 2
v_pk_mul_f32 v[68:69], v[68:69], v[36:37]
v_pk_fma_f32 v[32:33], v[32:33], v[20:21], v[20:21] op_sel:[0,1,1] op_sel_hi:[1,1,1]
v_pk_fma_f32 v[34:35], v[34:35], v[20:21], v[20:21] op_sel:[0,1,1] op_sel_hi:[1,1,1]
v_pk_mul_f32 v[36:37], v[36:37], v[28:29] op_sel:[0,1] op_sel_hi:[1,1]
v_pk_mul_f32 v[70:71], v[70:71], v[38:39]
v_pk_mul_f32 v[38:39], v[38:39], v[28:29] op_sel:[0,1] op_sel_hi:[1,1]
v_pk_fma_f32 v[48:49], v[48:49], v[20:21], v[20:21] op_sel:[0,1,1] op_sel_hi:[1,1,1]
v_pk_mul_f32 v[84:85], v[84:85], v[52:53]
v_pk_mul_f32 v[52:53], v[52:53], v[28:29] op_sel:[0,1] op_sel_hi:[1,1]
v_pk_mul_f32 v[86:87], v[86:87], v[54:55]
v_pk_mul_f32 v[54:55], v[54:55], v[28:29] op_sel:[0,1] op_sel_hi:[1,1]
v_pk_fma_f32 v[50:51], v[50:51], v[20:21], v[20:21] op_sel:[0,1,1] op_sel_hi:[1,1,1]
v_rcp_f32 v32, v32
v_rcp_f32 v33, v33
MAA 72,64,136
TR 60,17,25376
v_rcp_f32 v34, v34
MAA 72,68,152
TR 62,17,25888
v_rcp_f32 v35, v35
s_waitcnt vmcnt(3)
MAA 72,96,168
v_rcp_f32 v48, v48
s_waitcnt vmcnt(1)
MAA 72,100,184
v_rcp_f32 v49, v49
MAA 88,108,184
v_rcp_f32 v50, v50
MAA 88,104,168
v_rcp_f32 v51, v51
MAA 88,76,152
v_exp_f32 v36, v36
MAA 88,72,136
v_exp_f32 v37, v37
MAA 40,80,168
v_exp_f32 v38, v38
MAA 40,84,184
v_exp_f32 v39, v39
MAA 56,92,184
v_exp_f32 v52, v52
MAA 56,88,168
v_exp_f32 v53, v53
v_exp_f32 v54, v54
v_exp_f32 v55, v55
v_pk_mul_f32 v[64:65], v[64:65], v[32:33]
v_pk_mul_f32 v[66:67], v[66:67], v[34:35]
v_pk_mul_f32 v[80:81], v[80:81], v[48:49]
v_pk_mul_f32 v[82:83], v[82:83], v[50:51]
v_pk_mul_f32 v[72:73], v[72:73], v[40:41]
v_pk_mul_f32 v[40:41], v[40:41], v[30:31] op_sel_hi:[1,0]
v_pk_mul_f32 v[74:75], v[74:75], v[42:43]
v_pk_mul_f32 v[42:43], v[42:43], v[30:31] op_sel_hi:[1,0]
v_pk_mul_f32 v[88:89], v[88:89], v[56:57]
v_pk_mul_f32 v[56:57], v[56:57], v[30:31] op_sel_hi:[1,0]
v_pk_mul_f32 v[90:91], v[90:91], v[58:59]
v_pk_mul_f32 v[58:59], v[58:59], v[30:31] op_sel_hi:[1,0]
v_pk_fma_f32 v[36:37], v[36:37], v[22:23], v[22:23] op_sel:[0,1,1] op_sel_hi:[1,1,1]
v_pk_fma_f32 v[38:39], v[38:39], v[22:23], v[22:23] op_sel:[0,1,1] op_sel_hi:[1,1,1]
v_pk_fma_f32 v[52:53], v[52:53], v[22:23], v[22:23] op_sel:[0,1,1] op_sel_hi:[1,1,1]
v_pk_fma_f32 v[54:55], v[54:55], v[22:23], v[22:23] op_sel:[0,1,1] op_sel_hi:[1,1,1]
v_cvt_pk_bf16_f32 v32, v64, v65
v_cvt_pk_bf16_f32 v33, v66, v67
v_cvt_pk_bf16_f32 v34, v80, v81
v_cvt_pk_bf16_f32 v35, v82, v83
MAA 76,64,140
buffer_store_dwordx4 v[32:35], v10, s[16:19], s62 offen sc1
MAA 76,68,156
TR 64,17,33792
v_rcp_f32 v36, v36
MAA 76,96,172
TR 66,17,34304
v_rcp_f32 v37, v37
s_waitcnt vmcnt(1)
MAA 76,100,188
TR 68,17,42240
v_rcp_f32 v38, v38
MAA 92,108,188
TR 70,17,42752
v_rcp_f32 v39, v39
MAA 92,104,172
v_rcp_f32 v52, v52
MAA 92,76,156
TR 76,17,42272
v_rcp_f32 v53, v53
MAA 92,72,140
TR 72,17,33824
v_rcp_f32 v54, v54
MAA 44,80,172
TR 74,17,34336
v_rcp_f32 v55, v55
MAA 44,84,188
TR 78,17,42784
v_exp_f32 v40, v40
MAA 60,92,188
TR 80,17,50688
v_exp_f32 v41, v41
MAA 60,88,172
TR 82,17,51200
v_exp_f32 v42, v42
v_exp_f32 v43, v43
v_exp_f32 v56, v56
v_exp_f32 v57, v57
v_exp_f32 v58, v58
v_exp_f32 v59, v59
v_pk_mul_f32 v[68:69], v[68:69], v[36:37]
v_pk_mul_f32 v[70:71], v[70:71], v[38:39]
v_pk_mul_f32 v[84:85], v[84:85], v[52:53]
v_pk_mul_f32 v[86:87], v[86:87], v[54:55]
v_pk_mul_f32 v[76:77], v[76:77], v[44:45]
v_pk_mul_f32 v[44:45], v[44:45], v[30:31] op_sel:[0,1] op_sel_hi:[1,1]
v_pk_mul_f32 v[78:79], v[78:79], v[46:47]
v_pk_mul_f32 v[46:47], v[46:47], v[30:31] op_sel:[0,1] op_sel_hi:[1,1]
v_pk_mul_f32 v[92:93], v[92:93], v[60:61]
v_pk_mul_f32 v[60:61], v[60:61], v[30:31] op_sel:[0,1] op_sel_hi:[1,1]
v_pk_mul_f32 v[94:95], v[94:95], v[62:63]
v_pk_mul_f32 v[62:63], v[62:63], v[30:31] op_sel:[0,1] op_sel_hi:[1,1]
v_pk_fma_f32 v[40:41], v[40:41], v[24:25], v[24:25] op_sel:[0,1,1] op_sel_hi:[1,1,1]
v_pk_fma_f32 v[42:43], v[42:43], v[24:25], v[24:25] op_sel:[0,1,1] op_sel_hi:[1,1,1]
v_pk_fma_f32 v[56:57], v[56:57], v[24:25], v[24:25] op_sel:[0,1,1] op_sel_hi:[1,1,1]
v_pk_fma_f32 v[58:59], v[58:59], v[24:25], v[24:25] op_sel:[0,1,1] op_sel_hi:[1,1,1]
v_cvt_pk_bf16_f32 v36, v68, v69
v_cvt_pk_bf16_f32 v37, v70, v71
v_cvt_pk_bf16_f32 v38, v84, v85
v_cvt_pk_bf16_f32 v39, v86, v87
MAA 128,112,128
buffer_store_dwordx4 v[36:39], v10, s[16:19], s62 offen offset:1024 sc1
MAA 128,116,144
TR 84,17,59136
v_rcp_f32 v40, v40
s_waitcnt lgkmcnt(15)
MAA 128,208,160
TR 86,17,59648
v_rcp_f32 v41, v41
MAA 128,212,176
TR 88,17,50720
v_rcp_f32 v42, v42
MAA 144,220,176
TR 90,17,51232
v_rcp_f32 v43, v43
MAA 144,216,160
TR 92,17,59168
v_rcp_f32 v56, v56
MAA 144,124,144
TR 94,17,59680
v_rcp_f32 v57, v57
MAA 144,120,128
v_rcp_f32 v58, v58
MAA 96,192,160
v_rcp_f32 v59, v59
MAA 96,196,176
v_exp_f32 v44, v44
MAA 112,204,176
v_exp_f32 v45, v45
MAA 112,200,160
v_lshrrev_b32 v69, 2, v0
v_min_u32 v69, 1, v69
v_lshlrev_b32 v69, 28, v69
v_lshl_add_u32 v68, v0, 7, v69
v_xor_b32 v69, 64, v0
v_min_u32 v69, 1, v69
v_lshlrev_b32 v70, 4, v69
v_sub_u32 v70, 16, v70
v_lshlrev_b32 v69, 28, v69
v_mov_b32 v71, 1
s_waitcnt lgkmcnt(0)
s_barrier
v_mov_b32 v84, 0
v_mov_b32 v85, 0
v_mov_b32 v86, 0
v_exp_f32 v46, v46
v_exp_f32 v47, v47
v_exp_f32 v60, v60
v_exp_f32 v61, v61
v_exp_f32 v62, v62
v_exp_f32 v63, v63
v_pk_mul_f32 v[72:73], v[72:73], v[40:41]
v_pk_mul_f32 v[74:75], v[74:75], v[42:43]
v_pk_mul_f32 v[88:89], v[88:89], v[56:57]
v_pk_mul_f32 v[90:91], v[90:91], v[58:59]
v_pk_mul_f32 v[128:129], v[128:129], v[96:97]
v_pk_mul_f32 v[96:97], v[96:97], v[28:29] op_sel_hi:[1,0]
v_pk_mul_f32 v[130:131], v[130:131], v[98:99]
v_pk_mul_f32 v[98:99], v[98:99], v[28:29] op_sel_hi:[1,0]
v_pk_mul_f32 v[144:145], v[144:145], v[112:113]
v_pk_mul_f32 v[112:113], v[112:113], v[28:29] op_sel_hi:[1,0]
v_pk_mul_f32 v[146:147], v[146:147], v[114:115]
v_pk_mul_f32 v[114:115], v[114:115], v[28:29] op_sel_hi:[1,0]
v_pk_fma_f32 v[44:45], v[44:45], v[26:27], v[26:27] op_sel:[0,1,1] op_sel_hi:[1,1,1]
v_pk_fma_f32 v[46:47], v[46:47], v[26:27], v[26:27] op_sel:[0,1,1] op_sel_hi:[1,1,1]
v_pk_fma_f32 v[60:61], v[60:61], v[26:27], v[26:27] op_sel:[0,1,1] op_sel_hi:[1,1,1]
v_pk_fma_f32 v[62:63], v[62:63], v[26:27], v[26:27] op_sel:[0,1,1] op_sel_hi:[1,1,1]
v_cvt_pk_bf16_f32 v40, v72, v73
v_cvt_pk_bf16_f32 v41, v74, v75
v_cvt_pk_bf16_f32 v42, v88, v89
v_cvt_pk_bf16_f32 v43, v90, v91
MAA 132,112,132
buffer_store_dwordx4 v[40:43], v11, s[16:19], s62 offen sc1
MAA 132,116,148
s_add_u32 m0, s59, 84480
v_rcp_f32 v44, v44
MAA 132,208,164
v_rcp_f32 v45, v45
MAA 132,212,180
v_rcp_f32 v46, v46
MAA 148,220,180
buffer_load_dwordx4 v18, s[28:31], s58 offen lds
MAA 148,216,164
v_rcp_f32 v47, v47
MAA 148,124,148
v_rcp_f32 v60, v60
MAA 148,120,132
v_rcp_f32 v61, v61
MAA 100,192,164
buffer_load_dwordx4 v19, s[28:31], s58 offen offset:1056 lds
MAA 100,196,180
s_add_u32 m0, s59, 92928
s_add_u32 s58, s99, 2555904
v_rcp_f32 v62, v62
MAA 116,204,180
v_rcp_f32 v63, v63
MAA 116,200,164
v_exp_f32 v96, v96
v_exp_f32 v97, v97
v_exp_f32 v98, v98
v_exp_f32 v99, v99
v_exp_f32 v112, v112
v_exp_f32 v113, v113
v_exp_f32 v114, v114
v_exp_f32 v115, v115
v_pk_mul_f32 v[76:77], v[76:77], v[44:45]
v_pk_mul_f32 v[78:79], v[78:79], v[46:47]
v_pk_mul_f32 v[92:93], v[92:93], v[60:61]
v_pk_mul_f32 v[94:95], v[94:95], v[62:63]
v_pk_mul_f32 v[132:133], v[132:133], v[100:101]
v_pk_mul_f32 v[100:101], v[100:101], v[28:29] op_sel:[0,1] op_sel_hi:[1,1]
v_pk_mul_f32 v[134:135], v[134:135], v[102:103]
v_pk_mul_f32 v[102:103], v[102:103], v[28:29] op_sel:[0,1] op_sel_hi:[1,1]
v_pk_mul_f32 v[148:149], v[148:149], v[116:117]
v_pk_mul_f32 v[116:117], v[116:117], v[28:29] op_sel:[0,1] op_sel_hi:[1,1]
v_pk_mul_f32 v[150:151], v[150:151], v[118:119]
v_pk_mul_f32 v[118:119], v[118:119], v[28:29] op_sel:[0,1] op_sel_hi:[1,1]
v_pk_fma_f32 v[96:97], v[96:97], v[20:21], v[20:21] op_sel:[0,1,1] op_sel_hi:[1,1,1]
v_pk_fma_f32 v[98:99], v[98:99], v[20:21], v[20:21] op_sel:[0,1,1] op_sel_hi:[1,1,1]
v_pk_fma_f32 v[112:113], v[112:113], v[20:21], v[20:21] op_sel:[0,1,1] op_sel_hi:[1,1,1]
v_pk_fma_f32 v[114:115], v[114:115], v[20:21], v[20:21] op_sel:[0,1,1] op_sel_hi:[1,1,1]
v_cvt_pk_bf16_f32 v44, v76, v77
v_cvt_pk_bf16_f32 v45, v78, v79
v_cvt_pk_bf16_f32 v46, v92, v93
v_cvt_pk_bf16_f32 v47, v94, v95
MAA 136,112,136
buffer_store_dwordx4 v[44:47], v11, s[16:19], s62 offen offset:1024 sc1
MAA 136,116,152
v_rcp_f32 v96, v96
MAA 136,208,168
v_rcp_f32 v97, v97
MAA 136,212,184
v_rcp_f32 v98, v98
MAA 152,220,184
buffer_load_dwordx4 v18, s[28:31], s58 offen lds
MAA 152,216,168
v_rcp_f32 v99, v99
MAA 152,124,152
v_rcp_f32 v112, v112
MAA 152,120,136
v_rcp_f32 v113, v113
MAA 104,192,168
buffer_load_dwordx4 v19, s[28:31], s58 offen offset:1056 lds
MAA 104,196,184
s_add_u32 m0, s59, 101376
s_add_u32 s58, s100, 2752512
v_rcp_f32 v114, v114
MAA 120,204,184
v_rcp_f32 v115, v115
MAA 120,200,168
v_exp_f32 v100, v100
v_exp_f32 v101, v101
v_exp_f32 v102, v102
v_exp_f32 v103, v103
v_exp_f32 v116, v116
v_exp_f32 v117, v117
v_exp_f32 v118, v118
v_exp_f32 v119, v119
v_pk_mul_f32 v[128:129], v[128:129], v[96:97]
v_pk_mul_f32 v[130:131], v[130:131], v[98:99]
v_pk_mul_f32 v[144:145], v[144:145], v[112:113]
v_pk_mul_f32 v[146:147], v[146:147], v[114:115]
v_pk_mul_f32 v[136:137], v[136:137], v[104:105]
v_pk_mul_f32 v[104:105], v[104:105], v[30:31] op_sel_hi:[1,0]
v_pk_mul_f32 v[138:139], v[138:139], v[106:107]
v_pk_mul_f32 v[106:107], v[106:107], v[30:31] op_sel_hi:[1,0]
v_pk_mul_f32 v[152:153], v[152:153], v[120:121]
v_pk_mul_f32 v[120:121], v[120:121], v[30:31] op_sel_hi:[1,0]
v_pk_mul_f32 v[154:155], v[154:155], v[122:123]
v_pk_mul_f32 v[122:123], v[122:123], v[30:31] op_sel_hi:[1,0]
v_pk_fma_f32 v[100:101], v[100:101], v[22:23], v[22:23] op_sel:[0,1,1] op_sel_hi:[1,1,1]
v_pk_fma_f32 v[102:103], v[102:103], v[22:23], v[22:23] op_sel:[0,1,1] op_sel_hi:[1,1,1]
v_pk_fma_f32 v[116:117], v[116:117], v[22:23], v[22:23] op_sel:[0,1,1] op_sel_hi:[1,1,1]
v_pk_fma_f32 v[118:119], v[118:119], v[22:23], v[22:23] op_sel:[0,1,1] op_sel_hi:[1,1,1]
v_cvt_pk_bf16_f32 v96, v128, v129
v_cvt_pk_bf16_f32 v97, v130, v131
v_cvt_pk_bf16_f32 v98, v144, v145
v_cvt_pk_bf16_f32 v99, v146, v147
MAA 140,112,140
buffer_store_dwordx4 v[96:99], v10, s[16:19], s63 offen sc1
MAA 140,116,156
v_rcp_f32 v100, v100
MAA 140,208,172
v_rcp_f32 v101, v101
MAA 140,212,188
v_rcp_f32 v102, v102
MAA 156,220,188
buffer_load_dwordx4 v18, s[28:31], s58 offen lds
MAA 156,216,172
v_rcp_f32 v103, v103
MAA 156,124,156
v_rcp_f32 v116, v116
MAA 156,120,140
v_rcp_f32 v117, v117
MAA 108,192,172
buffer_load_dwordx4 v19, s[28:31], s58 offen offset:1056 lds
MAA 108,196,188
s_add_u32 m0, s59, 109824
s_add_u32 s58, s100, 3014656
v_rcp_f32 v118, v118
MAA 124,204,188
v_rcp_f32 v119, v119
MAA 124,200,172
v_exp_f32 v104, v104
v_exp_f32 v105, v105
v_exp_f32 v106, v106
v_exp_f32 v107, v107
v_exp_f32 v120, v120
v_exp_f32 v121, v121
v_exp_f32 v122, v122
v_exp_f32 v123, v123
v_pk_mul_f32 v[132:133], v[132:133], v[100:101]
v_pk_mul_f32 v[134:135], v[134:135], v[102:103]
v_pk_mul_f32 v[148:149], v[148:149], v[116:117]
v_pk_mul_f32 v[150:151], v[150:151], v[118:119]
v_pk_mul_f32 v[140:141], v[140:141], v[108:109]
v_pk_mul_f32 v[108:109], v[108:109], v[30:31] op_sel:[0,1] op_sel_hi:[1,1]
v_pk_mul_f32 v[142:143], v[142:143], v[110:111]
v_pk_mul_f32 v[110:111], v[110:111], v[30:31] op_sel:[0,1] op_sel_hi:[1,1]
v_pk_mul_f32 v[156:157], v[156:157], v[124:125]
v_pk_mul_f32 v[124:125], v[124:125], v[30:31] op_sel:[0,1] op_sel_hi:[1,1]
v_pk_mul_f32 v[158:159], v[158:159], v[126:127]
v_pk_mul_f32 v[126:127], v[126:127], v[30:31] op_sel:[0,1] op_sel_hi:[1,1]
v_pk_fma_f32 v[104:105], v[104:105], v[24:25], v[24:25] op_sel:[0,1,1] op_sel_hi:[1,1,1]
v_pk_fma_f32 v[106:107], v[106:107], v[24:25], v[24:25] op_sel:[0,1,1] op_sel_hi:[1,1,1]
v_pk_fma_f32 v[120:121], v[120:121], v[24:25], v[24:25] op_sel:[0,1,1] op_sel_hi:[1,1,1]
v_pk_fma_f32 v[122:123], v[122:123], v[24:25], v[24:25] op_sel:[0,1,1] op_sel_hi:[1,1,1]
v_cvt_pk_bf16_f32 v100, v132, v133
v_cvt_pk_bf16_f32 v101, v134, v135
v_cvt_pk_bf16_f32 v102, v148, v149
v_cvt_pk_bf16_f32 v103, v150, v151
MAA 192,0,128
buffer_store_dwordx4 v[100:103], v10, s[16:19], s63 offen offset:1024 sc1
MAA 192,4,144
v_rcp_f32 v104, v104
MAA 192,32,160
s_waitcnt vmcnt(6)
s_barrier
v_rcp_f32 v105, v105
MAA 192,36,176
v_rcp_f32 v106, v106
MAA 208,44,176
.Lpad27:
s_cbranch_execz .Lpad30
buffer_atomic_add v71, v68, s[16:19], s72 offen offset:512
MAA 208,40,160
v_rcp_f32 v107, v107
MAA 208,12,144
v_rcp_f32 v120, v120
MAA 208,8,128
v_rcp_f32 v121, v121
MAA 160,16,160
buffer_load_dwordx4 v18, s[28:31], s58 offen lds
MAA 160,20,176
v_rcp_f32 v122, v122
MAA 176,28,176
v_rcp_f32 v123, v123
MAA 176,24,160
v_exp_f32 v108, v108
v_exp_f32 v109, v109
v_exp_f32 v110, v110
v_exp_f32 v111, v111
v_exp_f32 v124, v124
v_exp_f32 v125, v125
v_exp_f32 v126, v126
v_exp_f32 v127, v127
v_pk_mul_f32 v[136:137], v[136:137], v[104:105]
v_pk_mul_f32 v[138:139], v[138:139], v[106:107]
v_pk_mul_f32 v[152:153], v[152:153], v[120:121]
v_pk_mul_f32 v[154:155], v[154:155], v[122:123]
v_pk_mul_f32 v[192:193], v[192:193], v[160:161]
v_pk_mul_f32 v[160:161], v[160:161], v[28:29] op_sel_hi:[1,0]
v_pk_mul_f32 v[194:195], v[194:195], v[162:163]
v_pk_mul_f32 v[162:163], v[162:163], v[28:29] op_sel_hi:[1,0]
v_pk_mul_f32 v[208:209], v[208:209], v[176:177]
v_pk_mul_f32 v[176:177], v[176:177], v[28:29] op_sel_hi:[1,0]
v_pk_mul_f32 v[210:211], v[210:211], v[178:179]
v_pk_mul_f32 v[178:179], v[178:179], v[28:29] op_sel_hi:[1,0]
v_pk_fma_f32 v[108:109], v[108:109], v[26:27], v[26:27] op_sel:[0,1,1] op_sel_hi:[1,1,1]
v_pk_fma_f32 v[110:111], v[110:111], v[26:27], v[26:27] op_sel:[0,1,1] op_sel_hi:[1,1,1]
v_pk_fma_f32 v[124:125], v[124:125], v[26:27], v[26:27] op_sel:[0,1,1] op_sel_hi:[1,1,1]
v_pk_fma_f32 v[126:127], v[126:127], v[26:27], v[26:27] op_sel:[0,1,1] op_sel_hi:[1,1,1]
v_cvt_pk_bf16_f32 v104, v136, v137
v_cvt_pk_bf16_f32 v105, v138, v139
v_cvt_pk_bf16_f32 v106, v152, v153
v_cvt_pk_bf16_f32 v107, v154, v155
MAA 196,0,132
buffer_store_dwordx4 v[104:107], v11, s[16:19], s63 offen sc1
MAA 196,4,148
v_rcp_f32 v108, v108
MAA 196,32,164
v_rcp_f32 v109, v109
MAA 196,36,180
v_rcp_f32 v110, v110
MAA 212,44,180
buffer_load_dwordx4 v19, s[28:31], s58 offen offset:1056 lds
MAA 212,40,164
s_add_u32 m0, s59, 118272
s_add_u32 s58, s101, 3211264
v_rcp_f32 v111, v111
MAA 212,12,148
v_rcp_f32 v124, v124
MAA 212,8,132
v_rcp_f32 v125, v125
MAA 164,16,164
buffer_load_dwordx4 v18, s[28:31], s58 offen lds
MAA 164,20,180
v_rcp_f32 v126, v126
MAA 180,28,180
v_rcp_f32 v127, v127
MAA 180,24,164
v_exp_f32 v160, v160
v_exp_f32 v161, v161
v_exp_f32 v162, v162
v_exp_f32 v163, v163
v_exp_f32 v176, v176
v_exp_f32 v177, v177
v_exp_f32 v178, v178
v_exp_f32 v179, v179
v_pk_mul_f32 v[140:141], v[140:141], v[108:109]
v_pk_mul_f32 v[142:143], v[142:143], v[110:111]
v_pk_mul_f32 v[156:157], v[156:157], v[124:125]
v_pk_mul_f32 v[158:159], v[158:159], v[126:127]
v_pk_mul_f32 v[196:197], v[196:197], v[164:165]
v_pk_mul_f32 v[164:165], v[164:165], v[28:29] op_sel:[0,1] op_sel_hi:[1,1]
v_pk_mul_f32 v[198:199], v[198:199], v[166:167]
v_pk_mul_f32 v[166:167], v[166:167], v[28:29] op_sel:[0,1] op_sel_hi:[1,1]
v_pk_mul_f32 v[212:213], v[212:213], v[180:181]
v_pk_mul_f32 v[180:181], v[180:181], v[28:29] op_sel:[0,1] op_sel_hi:[1,1]
v_pk_mul_f32 v[214:215], v[214:215], v[182:183]
v_pk_mul_f32 v[182:183], v[182:183], v[28:29] op_sel:[0,1] op_sel_hi:[1,1]
v_pk_fma_f32 v[160:161], v[160:161], v[20:21], v[20:21] op_sel:[0,1,1] op_sel_hi:[1,1,1]
v_pk_fma_f32 v[162:163], v[162:163], v[20:21], v[20:21] op_sel:[0,1,1] op_sel_hi:[1,1,1]
v_pk_fma_f32 v[176:177], v[176:177], v[20:21], v[20:21] op_sel:[0,1,1] op_sel_hi:[1,1,1]
v_pk_fma_f32 v[178:179], v[178:179], v[20:21], v[20:21] op_sel:[0,1,1] op_sel_hi:[1,1,1]
v_cvt_pk_bf16_f32 v108, v140, v141
v_cvt_pk_bf16_f32 v109, v142, v143
v_cvt_pk_bf16_f32 v110, v156, v157
v_cvt_pk_bf16_f32 v111, v158, v159
MAA 200,0,136
buffer_store_dwordx4 v[108:111], v11, s[16:19], s63 offen offset:1024 sc1
MAA 200,4,152
v_rcp_f32 v160, v160
MAA 200,32,168
v_rcp_f32 v161, v161
MAA 200,36,184
v_rcp_f32 v162, v162
MAA 216,44,184
buffer_load_dwordx4 v19, s[28:31], s58 offen offset:1056 lds
MAA 216,40,168
s_add_u32 m0, s59, 126720
s_add_u32 s58, s101, 3473408
v_rcp_f32 v163, v163
MAA 216,12,152
v_rcp_f32 v176, v176
MAA 216,8,136
v_rcp_f32 v177, v177
MAA 168,16,168
buffer_load_dwordx4 v18, s[28:31], s58 offen lds
MAA 168,20,184
v_rcp_f32 v178, v178
MAA 184,28,184
v_rcp_f32 v179, v179
MAA 184,24,168
v_exp_f32 v164, v164
v_exp_f32 v165, v165
v_exp_f32 v166, v166
v_exp_f32 v167, v167
v_exp_f32 v180, v180
v_exp_f32 v181, v181
v_exp_f32 v182, v182
v_exp_f32 v183, v183
v_pk_mul_f32 v[192:193], v[192:193], v[160:161]
v_pk_mul_f32 v[194:195], v[194:195], v[162:163]
v_pk_mul_f32 v[208:209], v[208:209], v[176:177]
v_pk_mul_f32 v[210:211], v[210:211], v[178:179]
v_pk_mul_f32 v[200:201], v[200:201], v[168:169]
v_pk_mul_f32 v[168:169], v[168:169], v[30:31] op_sel_hi:[1,0]
v_pk_mul_f32 v[202:203], v[202:203], v[170:171]
v_pk_mul_f32 v[170:171], v[170:171], v[30:31] op_sel_hi:[1,0]
v_pk_mul_f32 v[216:217], v[216:217], v[184:185]
v_pk_mul_f32 v[184:185], v[184:185], v[30:31] op_sel_hi:[1,0]
v_pk_mul_f32 v[218:219], v[218:219], v[186:187]
v_pk_mul_f32 v[186:187], v[186:187], v[30:31] op_sel_hi:[1,0]
v_pk_fma_f32 v[164:165], v[164:165], v[22:23], v[22:23] op_sel:[0,1,1] op_sel_hi:[1,1,1]
v_pk_fma_f32 v[166:167], v[166:167], v[22:23], v[22:23] op_sel:[0,1,1] op_sel_hi:[1,1,1]
v_pk_fma_f32 v[180:181], v[180:181], v[22:23], v[22:23] op_sel:[0,1,1] op_sel_hi:[1,1,1]
v_pk_fma_f32 v[182:183], v[182:183], v[22:23], v[22:23] op_sel:[0,1,1] op_sel_hi:[1,1,1]
v_cvt_pk_bf16_f32 v160, v192, v193
v_cvt_pk_bf16_f32 v161, v194, v195
v_cvt_pk_bf16_f32 v162, v208, v209
v_cvt_pk_bf16_f32 v163, v210, v211
MAA 204,0,140
buffer_store_dwordx4 v[160:163], v10, s[16:19], s64 offen sc1
MAA 204,4,156
v_rcp_f32 v164, v164
MAA 204,32,172
v_rcp_f32 v165, v165
MAA 204,36,188
v_rcp_f32 v166, v166
MAA 220,44,188
buffer_atomic_add v84, v69, s[16:19], s73 offen offset:512 sc0
MAA 220,40,172
v_rcp_f32 v167, v167
MAA 220,12,156
v_rcp_f32 v180, v180
MAA 220,8,140
v_rcp_f32 v181, v181
MAA 172,16,172
buffer_load_dwordx4 v19, s[28:31], s58 offen offset:1056 lds
MAA 172,20,188
v_rcp_f32 v182, v182
MAA 188,28,188
v_rcp_f32 v183, v183
MAA 188,24,172
v_exp_f32 v168, v168
v_exp_f32 v169, v169
v_exp_f32 v170, v170
v_exp_f32 v171, v171
v_exp_f32 v184, v184
v_exp_f32 v185, v185
v_exp_f32 v186, v186
v_exp_f32 v187, v187
v_pk_mul_f32 v[196:197], v[196:197], v[164:165]
v_pk_mul_f32 v[198:199], v[198:199], v[166:167]
v_pk_mul_f32 v[212:213], v[212:213], v[180:181]
v_pk_mul_f32 v[214:215], v[214:215], v[182:183]
v_pk_mul_f32 v[204:205], v[204:205], v[172:173]
v_pk_mul_f32 v[172:173], v[172:173], v[30:31] op_sel:[0,1] op_sel_hi:[1,1]
v_pk_mul_f32 v[206:207], v[206:207], v[174:175]
v_pk_mul_f32 v[174:175], v[174:175], v[30:31] op_sel:[0,1] op_sel_hi:[1,1]
v_pk_mul_f32 v[220:221], v[220:221], v[188:189]
v_pk_mul_f32 v[188:189], v[188:189], v[30:31] op_sel:[0,1] op_sel_hi:[1,1]
v_pk_mul_f32 v[222:223], v[222:223], v[190:191]
v_pk_mul_f32 v[190:191], v[190:191], v[30:31] op_sel:[0,1] op_sel_hi:[1,1]
v_pk_fma_f32 v[168:169], v[168:169], v[24:25], v[24:25] op_sel:[0,1,1] op_sel_hi:[1,1,1]
v_pk_fma_f32 v[170:171], v[170:171], v[24:25], v[24:25] op_sel:[0,1,1] op_sel_hi:[1,1,1]
v_pk_fma_f32 v[184:185], v[184:185], v[24:25], v[24:25] op_sel:[0,1,1] op_sel_hi:[1,1,1]
v_pk_fma_f32 v[186:187], v[186:187], v[24:25], v[24:25] op_sel:[0,1,1] op_sel_hi:[1,1,1]
v_cvt_pk_bf16_f32 v164, v196, v197
v_cvt_pk_bf16_f32 v165, v198, v199
v_cvt_pk_bf16_f32 v166, v212, v213
v_cvt_pk_bf16_f32 v167, v214, v215
MAA 240,48,128
buffer_store_dwordx4 v[164:167], v10, s[16:19], s64 offen offset:1024 sc1
MAA 240,52,144
v_rcp_f32 v168, v168
MAA 240,80,160
v_rcp_f32 v169, v169
MAA 240,84,176
v_rcp_f32 v170, v170
MAA 248,92,176
buffer_atomic_add v85, v69, s[16:19], s73 offen offset:512 sc0
MAA 248,88,160
v_rcp_f32 v171, v171
MAA 248,60,144
v_rcp_f32 v184, v184
MAA 248,56,128
v_rcp_f32 v185, v185
MAA 224,64,160
v_rcp_f32 v186, v186
MAA 224,68,176
v_rcp_f32 v187, v187
MAA 232,76,176
v_exp_f32 v172, v172
MAA 232,72,160
v_exp_f32 v173, v173
v_exp_f32 v174, v174
v_exp_f32 v175, v175
v_exp_f32 v188, v188
v_exp_f32 v189, v189
v_exp_f32 v190, v190
v_exp_f32 v191, v191
v_pk_mul_f32 v[200:201], v[200:201], v[168:169]
v_pk_mul_f32 v[202:203], v[202:203], v[170:171]
v_pk_mul_f32 v[216:217], v[216:217], v[184:185]
v_pk_mul_f32 v[218:219], v[218:219], v[186:187]
v_pk_mul_f32 v[240:241], v[240:241], v[224:225]
v_pk_mul_f32 v[224:225], v[224:225], v[28:29] op_sel_hi:[1,0]
v_pk_mul_f32 v[242:243], v[242:243], v[226:227]
v_pk_mul_f32 v[226:227], v[226:227], v[28:29] op_sel_hi:[1,0]
v_pk_mul_f32 v[248:249], v[248:249], v[232:233]
v_pk_mul_f32 v[232:233], v[232:233], v[28:29] op_sel_hi:[1,0]
v_pk_mul_f32 v[250:251], v[250:251], v[234:235]
v_pk_mul_f32 v[234:235], v[234:235], v[28:29] op_sel_hi:[1,0]
v_pk_fma_f32 v[172:173], v[172:173], v[26:27], v[26:27] op_sel:[0,1,1] op_sel_hi:[1,1,1]
v_pk_fma_f32 v[174:175], v[174:175], v[26:27], v[26:27] op_sel:[0,1,1] op_sel_hi:[1,1,1]
v_pk_fma_f32 v[188:189], v[188:189], v[26:27], v[26:27] op_sel:[0,1,1] op_sel_hi:[1,1,1]
v_pk_fma_f32 v[190:191], v[190:191], v[26:27], v[26:27] op_sel:[0,1,1] op_sel_hi:[1,1,1]
v_cvt_pk_bf16_f32 v168, v200, v201
v_cvt_pk_bf16_f32 v169, v202, v203
v_cvt_pk_bf16_f32 v170, v216, v217
v_cvt_pk_bf16_f32 v171, v218, v219
buffer_store_dwordx4 v[168:171], v11, s[16:19], s64 offen sc1
buffer_atomic_add v86, v69, s[16:19], s73 offen offset:512 sc0
s_waitcnt vmcnt(5)
v_cmp_gt_u32 vcc, v70, v84
s_nop 0
s_cbranch_vccz .Lok66
s_waitcnt vmcnt(2)
v_cmp_gt_u32 vcc, v70, v85
s_nop 0
s_cbranch_vccz .Lok66
s_waitcnt vmcnt(0)
v_cmp_gt_u32 vcc, v70, v86
s_nop 0
s_cbranch_vccz .Lok66
s_mov_b32 s15, 0
.Lok66l:
v_mov_b32 v84, 0
buffer_atomic_add v84, v69, s[16:19], s73 offen offset:512 sc0
s_add_u32 s15, s15, 1
s_cmp_gt_u32 s15, 100000
s_waitcnt vmcnt(0)
s_cbranch_scc1 .Lok66
v_cmp_gt_u32 vcc, v70, v84
s_nop 0
s_cbranch_vccnz .Lok66l
.Lok66:
s_waitcnt vmcnt(4)
s_barrier
MAA 244,48,132
ds_read_b64_tr_b16 a[0:1], v7
s_add_u32 s52, s76, 0
MAA 244,52,148
buffer_load_dwordx4 v[96:99], v4, s[16:19], s52 offen sc1
MAA 244,80,164
TR 2,7,512
v_rcp_f32 v172, v172
MAA 244,84,180
TR 4,7,32
v_rcp_f32 v173, v173
MAA 252,92,180
TR 6,7,544
v_rcp_f32 v174, v174
MAA 252,88,164
buffer_load_dwordx4 v[100:103], v4, s[16:19], s52 offen offset:1024 sc1
MAA 252,60,148
TR 8,7,64
s_add_u32 s52, s76, 65536
MAA 252,56,132
TR 10,7,576
v_rcp_f32 v175, v175
MAA 228,64,164
TR 12,7,96
v_rcp_f32 v188, v188
MAA 228,68,180
buffer_load_dwordx4 v[104:107], v4, s[16:19], s52 offen sc1
MAA 236,76,180
TR 14,7,608
v_rcp_f32 v189, v189
MAA 236,72,164
TR 16,7,8448
v_rcp_f32 v190, v190
v_rcp_f32 v191, v191
v_exp_f32 v224, v224
v_exp_f32 v225, v225
v_exp_f32 v226, v226
v_exp_f32 v227, v227
v_exp_f32 v232, v232
v_exp_f32 v233, v233
v_exp_f32 v234, v234
v_exp_f32 v235, v235
v_pk_mul_f32 v[204:205], v[204:205], v[172:173]
buffer_load_dwordx4 v[108:111], v4, s[16:19], s52 offen offset:1024 sc1
s_add_u32 s52, s77, 114688
v_pk_mul_f32 v[206:207], v[206:207], v[174:175]
v_pk_mul_f32 v[220:221], v[220:221], v[188:189]
v_pk_mul_f32 v[222:223], v[222:223], v[190:191]
v_pk_mul_f32 v[244:245], v[244:245], v[228:229]
v_pk_mul_f32 v[228:229], v[228:229], v[28:29] op_sel:[0,1] op_sel_hi:[1,1]
v_pk_mul_f32 v[246:247], v[246:247], v[230:231]
v_pk_mul_f32 v[230:231], v[230:231], v[28:29] op_sel:[0,1] op_sel_hi:[1,1]
v_pk_mul_f32 v[252:253], v[252:253], v[236:237]
v_pk_mul_f32 v[236:237], v[236:237], v[28:29] op_sel:[0,1] op_sel_hi:[1,1]
v_pk_mul_f32 v[254:255], v[254:255], v[238:239]
v_pk_mul_f32 v[238:239], v[238:239], v[28:29] op_sel:[0,1] op_sel_hi:[1,1]
v_pk_fma_f32 v[224:225], v[224:225], v[20:21], v[20:21] op_sel:[0,1,1] op_sel_hi:[1,1,1]
buffer_load_dwordx4 v[112:115], v4, s[16:19], s52 offen sc1
v_pk_fma_f32 v[226:227], v[226:227], v[20:21], v[20:21] op_sel:[0,1,1] op_sel_hi:[1,1,1]
v_pk_fma_f32 v[232:233], v[232:233], v[20:21], v[20:21] op_sel:[0,1,1] op_sel_hi:[1,1,1]
v_pk_fma_f32 v[234:235], v[234:235], v[20:21], v[20:21] op_sel:[0,1,1] op_sel_hi:[1,1,1]
v_cvt_pk_bf16_f32 v172, v204, v205
v_cvt_pk_bf16_f32 v173, v206, v207
v_cvt_pk_bf16_f32 v174, v220, v221
v_cvt_pk_bf16_f32 v175, v222, v223
TR 18,7,8960
TR 20,7,8480
TR 22,7,8992
buffer_store_dwordx4 v[172:175], v11, s[16:19], s64 offen offset:1024 sc1
TR 24,7,8512
TR 26,7,9024
TR 28,7,8544
TR 30,7,9056
v_rcp_f32 v224, v224
v_rcp_f32 v225, v225
v_rcp_f32 v226, v226
v_rcp_f32 v227, v227
v_rcp_f32 v232, v232
v_rcp_f32 v233, v233
v_rcp_f32 v234, v234
v_rcp_f32 v235, v235
v_exp_f32 v228, v228
v_exp_f32 v229, v229
v_exp_f32 v230, v230
v_exp_f32 v231, v231
v_exp_f32 v236, v236
v_exp_f32 v237, v237
v_exp_f32 v238, v238
v_exp_f32 v239, v239
v_pk_mul_f32 v[240:241], v[240:241], v[224:225]
buffer_load_dwordx4 v[116:119], v4, s[16:19], s52 offen offset:1024 sc1
s_add_u32 s52, s77, 180224
v_pk_mul_f32 v[242:243], v[242:243], v[226:227]
v_pk_mul_f32 v[248:249], v[248:249], v[232:233]
v_pk_mul_f32 v[250:251], v[250:251], v[234:235]
v_pk_fma_f32 v[228:229], v[228:229], v[22:23], v[22:23] op_sel:[0,1,1] op_sel_hi:[1,1,1]
v_pk_fma_f32 v[230:231], v[230:231], v[22:23], v[22:23] op_sel:[0,1,1] op_sel_hi:[1,1,1]
v_pk_fma_f32 v[236:237], v[236:237], v[22:23], v[22:23] op_sel:[0,1,1] op_sel_hi:[1,1,1]
v_pk_fma_f32 v[238:239], v[238:239], v[22:23], v[22:23] op_sel:[0,1,1] op_sel_hi:[1,1,1]
v_cvt_pk_bf16_f32 v224, v240, v241
v_cvt_pk_bf16_f32 v225, v242, v243
v_cvt_pk_bf16_f32 v226, v248, v249
v_cvt_pk_bf16_f32 v227, v250, v251
v_rcp_f32 v228, v228
v_rcp_f32 v229, v229
v_rcp_f32 v230, v230
v_rcp_f32 v231, v231
v_rcp_f32 v236, v236
v_rcp_f32 v237, v237
v_rcp_f32 v238, v238
v_rcp_f32 v239, v239
v_pk_mul_f32 v[244:245], v[244:245], v[228:229]
buffer_store_dwordx4 v[224:227], v10, s[16:19], s65 offen sc1
v_pk_mul_f32 v[246:247], v[246:247], v[230:231]
v_pk_mul_f32 v[252:253], v[252:253], v[236:237]
v_pk_mul_f32 v[254:255], v[254:255], v[238:239]
v_cvt_pk_bf16_f32 v228, v244, v245
v_cvt_pk_bf16_f32 v229, v246, v247
v_cvt_pk_bf16_f32 v230, v252, v253
v_cvt_pk_bf16_f32 v231, v254, v255
buffer_store_dwordx4 v[228:231], v10, s[16:19], s65 offen offset:1024 sc1
buffer_load_dwordx4 v[120:123], v4, s[16:19], s52 offen sc1
buffer_load_dwordx4 v[124:127], v4, s[16:19], s52 offen offset:1024 sc1
v_mov_b32 v21, v68
v_mov_b32 v22, v69
v_mov_b32 v23, v70
v_mov_b32 v24, v71
v_mov_b32 v25, 0
s_waitcnt vmcnt(7) lgkmcnt(0)
s_barrier
v_mfma_f32_16x16x32_bf16 v[32:35], a[0:3], v[96:99], 0
ds_read_b64_tr_b16 a[32:33], v6
s_add_u32 s52, s78, 229376
MAV 32,16,104
buffer_load_dwordx4 v[128:131], v4, s[16:19], s52 offen sc1
v_mfma_f32_16x16x32_bf16 v[48:51], a[0:3], v[100:103], 0
TR 34,6,512
MAV 48,16,108
TR 36,6,32
TR 38,6,544
v_mfma_f32_16x16x32_bf16 v[52:55], a[4:7], v[100:103], 0
TR 48,6,8448
MAV 52,20,108
buffer_load_dwordx4 v[132:135], v4, s[16:19], s52 offen offset:1024 sc1
v_mfma_f32_16x16x32_bf16 v[36:39], a[4:7], v[96:99], 0
TR 50,6,8960
MAV 36,20,104
TR 52,6,8480
TR 54,6,8992
v_mfma_f32_16x16x32_bf16 v[40:43], a[8:11], v[96:99], 0
TR 40,6,64
s_add_u32 s52, s78, 294912
MAV 40,24,104
buffer_load_dwordx4 v[136:139], v4, s[16:19], s52 offen sc1
v_mfma_f32_16x16x32_bf16 v[56:59], a[8:11], v[100:103], 0
TR 42,6,576
MAV 56,24,108
TR 44,6,96
TR 46,6,608
v_mfma_f32_16x16x32_bf16 v[60:63], a[12:15], v[100:103], 0
TR 56,6,8512
MAV 60,28,108
buffer_load_dwordx4 v[140:143], v4, s[16:19], s52 offen offset:1024 sc1
v_mfma_f32_16x16x32_bf16 v[44:47], a[12:15], v[96:99], 0
TR 58,6,9024
MAV 44,28,104
TR 60,6,8544
TR 62,6,9056
s_waitcnt lgkmcnt(8)
v_mfma_f32_16x16x32_bf16 v[64:67], a[32:35], v[96:99], 0
TR 0,7,16896
s_add_u32 s52, s79, 344064
MAV 64,48,104
buffer_load_dwordx4 v[144:147], v4, s[16:19], s52 offen sc1
v_mfma_f32_16x16x32_bf16 v[80:83], a[32:35], v[100:103], 0
TR 2,7,17408
MAV 80,48,108
TR 4,7,16928
TR 6,7,17440
v_mfma_f32_16x16x32_bf16 v[84:87], a[36:39], v[100:103], 0
TR 16,7,25344
MAV 84,52,108
buffer_load_dwordx4 v[148:151], v4, s[16:19], s52 offen offset:1024 sc1
v_mfma_f32_16x16x32_bf16 v[68:71], a[36:39], v[96:99], 0
TR 18,7,25856
MAV 68,52,104
TR 20,7,25376
TR 22,7,25888
s_waitcnt lgkmcnt(8)
v_mfma_f32_16x16x32_bf16 v[72:75], a[40:43], v[96:99], 0
TR 8,7,16960
s_add_u32 s52, s79, 409600
MAV 72,56,104
buffer_load_dwordx4 v[152:155], v4, s[16:19], s52 offen sc1
v_mfma_f32_16x16x32_bf16 v[88:91], a[40:43], v[100:103], 0
TR 10,7,17472
MAV 88,56,108
TR 12,7,16992
TR 14,7,17504
v_mfma_f32_16x16x32_bf16 v[92:95], a[44:47], v[100:103], 0
TR 24,7,25408
MAV 92,60,108
buffer_load_dwordx4 v[156:159], v4, s[16:19], s52 offen offset:1024 sc1
v_mfma_f32_16x16x32_bf16 v[76:79], a[44:47], v[96:99], 0
TR 26,7,25920
MAV 76,60,104
TR 28,7,25440
TR 30,7,25952
s_waitcnt vmcnt(8) lgkmcnt(8)
s_barrier
MAV 32,0,112
TR 32,6,16896
MAV 32,16,120
buffer_atomic_add v24, v21, s[16:19], s72 offen
MAV 48,16,124
TR 34,6,17408
MAV 48,0,116
TR 36,6,16928
TR 38,6,17440
TR 48,6,25344
MAV 52,4,116
TR 50,6,25856
s_add_u32 m0, s55, 0
MAV 52,20,124
buffer_load_dwordx4 v18, s[28:31], s54 offen lds
MAV 36,20,120
TR 52,6,25376
MAV 36,4,112
TR 54,6,25888
TR 40,6,16960
s_waitcnt lgkmcnt(9)
MAV 40,8,112
TR 42,6,17472
s_add_u32 s52, s76, 458752
MAV 40,24,120
buffer_load_dwordx4 v[96:99], v4, s[16:19], s52 offen sc1
MAV 56,24,124
TR 44,6,16992
MAV 56,8,116
buffer_load_dwordx4 v19, s[28:31], s54 offen offset:1056 lds
MAV 60,12,116
TR 46,6,17504
s_add_u32 s54, s98, 327680
MAV 60,28,124
buffer_load_dwordx4 v[100:103], v4, s[16:19], s52 offen offset:1024 sc1
MAV 44,28,120
TR 56,6,25408
MAV 44,12,112
TR 58,6,25920
TR 60,6,25440
TR 62,6,25952
s_waitcnt lgkmcnt(8)
MAV 64,32,112
TR 0,7,33792
s_add_u32 m0, s55, 8448
MAV 64,48,120
buffer_load_dwordx4 v18, s[28:31], s54 offen lds
MAV 80,48,124
TR 2,7,34304
MAV 80,32,116
TR 4,7,33824
TR 6,7,34336
MAV 84,36,116
TR 16,7,42240
s_add_u32 s52, s76, 524288
MAV 84,52,124
buffer_load_dwordx4 v[104:107], v4, s[16:19], s52 offen sc1
MAV 68,52,120
TR 18,7,42752
MAV 68,36,112
TR 20,7,42272
TR 22,7,42784
s_waitcnt lgkmcnt(8)
MAV 72,40,112
TR 8,7,33856
MAV 72,56,120
buffer_load_dwordx4 v19, s[28:31], s54 offen offset:1056 lds
MAV 88,56,124
TR 10,7,34368
s_add_u32 s54, s99, 524288
MAV 88,40,116
TR 12,7,33888
TR 14,7,34400
MAV 92,44,116
TR 24,7,42304
MAV 92,60,124
buffer_load_dwordx4 v[108:111], v4, s[16:19], s52 offen offset:1024 sc1
MAV 76,60,120
TR 26,7,42816
MAV 76,44,112
TR 28,7,42336
TR 30,7,42848
s_waitcnt vmcnt(13) lgkmcnt(8)
s_barrier
MAV 32,0,128
TR 32,6,33792
s_add_u32 m0, s55, 16896
MAV 32,16,136
buffer_load_dwordx4 v18, s[28:31], s54 offen lds
MAV 48,16,140
TR 34,6,34304
MAV 48,0,132
TR 36,6,33824
TR 38,6,34336
MAV 52,4,132
TR 48,6,42240
s_add_u32 s52, s77, 573440
MAV 52,20,140
buffer_load_dwordx4 v[112:115], v4, s[16:19], s52 offen sc1
MAV 36,20,136
TR 50,6,42752
MAV 36,4,128
TR 52,6,42272
TR 54,6,42784
s_waitcnt lgkmcnt(8)
MAV 40,8,128
.Lpad28:
s_cbranch_execz .Lpad31
TR 40,6,33856
MAV 40,24,136
buffer_load_dwordx4 v19, s[28:31], s54 offen offset:1056 lds
MAV 56,24,140
TR 42,6,34368
s_add_u32 s54, s99, 786432
MAV 56,8,132
TR 44,6,33888
TR 46,6,34400
MAV 60,12,132
TR 56,6,42304
MAV 60,28,140
buffer_load_dwordx4 v[116:119], v4, s[16:19], s52 offen offset:1024 sc1
MAV 44,28,136
TR 58,6,42816
MAV 44,12,128
TR 60,6,42336
TR 62,6,42848
s_waitcnt lgkmcnt(8)
MAV 64,32,128
TR 0,7,50688
s_add_u32 m0, s55, 25344
MAV 64,48,136
buffer_load_dwordx4 v18, s[28:31], s54 offen lds
MAV 80,48,140
TR 2,7,51200
MAV 80,32,132
TR 4,7,50720
TR 6,7,51232
TR 16,7,59136
MAV 84,36,132
TR 18,7,59648
s_add_u32 s52, s77, 638976
MAV 84,52,140
buffer_load_dwordx4 v[120:123], v4, s[16:19], s52 offen sc1
MAV 68,52,136
TR 20,7,59168
MAV 68,36,128
TR 22,7,59680
TR 8,7,50752
s_waitcnt lgkmcnt(9)
MAV 72,40,128
TR 10,7,51264
MAV 72,56,136
buffer_load_dwordx4 v19, s[28:31], s54 offen offset:1056 lds
MAV 88,56,140
TR 12,7,50784
s_add_u32 s54, s100, 983040
MAV 88,40,132
buffer_load_dwordx4 v[124:127], v4, s[16:19], s52 offen offset:1024 sc1
MAV 92,44,132
TR 14,7,51296
MAV 92,60,140
buffer_atomic_add v25, v22, s[16:19], s73 offen sc0
MAV 76,60,136
TR 24,7,59200
MAV 76,44,128
TR 26,7,59712
TR 28,7,59232
TR 30,7,59744
s_waitcnt vmcnt(18) lgkmcnt(8)
s_barrier
MAV 32,0,144
TR 32,6,50688
s_add_u32 m0, s55, 33792
MAV 32,16,152
buffer_load_dwordx4 v18, s[28:31], s54 offen lds
MAV 48,16,156
TR 34,6,51200
MAV 48,0,148
TR 36,6,50720
TR 38,6,51232
MAV 52,4,148
TR 48,6,59136
s_add_u32 s52, s78, 688128
MAV 52,20,156
buffer_load_dwordx4 v[128:131], v4, s[16:19], s52 offen sc1
MAV 36,20,152
TR 50,6,59648
MAV 36,4,144
TR 52,6,59168
TR 54,6,59680
s_waitcnt lgkmcnt(8)
MAV 40,8,144
TR 40,6,50752
MAV 40,24,152
buffer_load_dwordx4 v19, s[28:31], s54 offen offset:1056 lds
MAV 56,24,156
TR 42,6,51264
s_add_u32 s54, s100, 1245184
MAV 56,8,148
TR 44,6,50784
TR 46,6,51296
MAV 60,12,148
TR 56,6,59200
MAV 60,28,156
buffer_load_dwordx4 v[132:135], v4, s[16:19], s52 offen offset:1024 sc1
MAV 44,28,152
TR 58,6,59712
MAV 44,12,144
TR 60,6,59232
TR 62,6,59744
v_add_u32 v7, s57, v7
v_add_u32 v6, s57, v6
s_sub_u32 s57, 0, s57
s_waitcnt lgkmcnt(8)
MAV 64,32,144
ds_read_b64_tr_b16 a[0:1], v7
s_add_u32 m0, s55, 42240
MAV 64,48,152
buffer_load_dwordx4 v18, s[28:31], s54 offen lds
MAV 80,48,156
TR 2,7,512
MAV 80,32,148
TR 4,7,32
TR 6,7,544
MAV 84,36,148
TR 16,7,8448
s_add_u32 s52, s78, 753664
MAV 84,52,156
buffer_load_dwordx4 v[136:139], v4, s[16:19], s52 offen sc1
MAV 68,52,152
TR 18,7,8960
MAV 68,36,144
TR 20,7,8480
TR 22,7,8992
s_waitcnt lgkmcnt(8)
MAV 72,40,144
TR 8,7,64
MAV 72,56,152
buffer_load_dwordx4 v19, s[28:31], s54 offen offset:1056 lds
MAV 88,56,156
TR 10,7,576
s_add_u32 s54, s101, 1441792
MAV 88,40,148
TR 12,7,96
TR 14,7,608
MAV 92,44,148
TR 24,7,8512
MAV 92,60,156
buffer_load_dwordx4 v[140:143], v4, s[16:19], s52 offen offset:1024 sc1
MAV 76,60,152
TR 26,7,9024
MAV 76,44,144
TR 28,7,8544
TR 30,7,9056
s_waitcnt vmcnt(17) lgkmcnt(8)
s_barrier
MAV 32,0,96
ds_read_b64_tr_b16 a[32:33], v6
s_add_u32 m0, s55, 50688
MAV 32,16,104
buffer_load_dwordx4 v18, s[28:31], s54 offen lds
MAV 48,16,108
TR 34,6,512
MAV 48,0,100
TR 36,6,32
TR 38,6,544
MAV 52,4,100
TR 48,6,8448
s_add_u32 s52, s79, 802816
MAV 52,20,108
buffer_load_dwordx4 v[144:147], v4, s[16:19], s52 offen sc1
MAV 36,20,104
TR 50,6,8960
MAV 36,4,96
TR 52,6,8480
TR 54,6,8992
s_waitcnt lgkmcnt(8)
MAV 40,8,96
TR 40,6,64
MAV 40,24,104
buffer_load_dwordx4 v19, s[28:31], s54 offen offset:1056 lds
MAV 56,24,108
TR 42,6,576
s_add_u32 s54, s101, 1703936
MAV 56,8,100
TR 44,6,96
TR 46,6,608
MAV 60,12,100
TR 56,6,8512
MAV 60,28,108
buffer_load_dwordx4 v[148:151], v4, s[16:19], s52 offen offset:1024 sc1
MAV 44,28,104
TR 58,6,9024
MAV 44,12,96
TR 60,6,8544
TR 62,6,9056
s_waitcnt lgkmcnt(8)
MAV 64,32,96
TR 0,7,16896
s_add_u32 m0, s55, 59136
MAV 64,48,104
buffer_load_dwordx4 v18, s[28:31], s54 offen lds
MAV 80,48,108
TR 2,7,17408
MAV 80,32,100
TR 4,7,16928
TR 6,7,17440
MAV 84,36,100
TR 16,7,25344
s_add_u32 s52, s79, 868352
MAV 84,52,108
buffer_load_dwordx4 v[152:155], v4, s[16:19], s52 offen sc1
MAV 68,52,104
TR 18,7,25856
MAV 68,36,96
TR 20,7,25376
TR 22,7,25888
s_waitcnt lgkmcnt(8)
MAV 72,40,96
TR 8,7,16960
MAV 72,56,104
buffer_load_dwordx4 v19, s[28:31], s54 offen offset:1056 lds
MAV 88,56,108
TR 10,7,17472
s_add_u32 s54, s98, 1900544
MAV 88,40,100
TR 12,7,16992
TR 14,7,17504
MAV 92,44,100
TR 24,7,25408
MAV 92,60,108
buffer_load_dwordx4 v[156:159], v4, s[16:19], s52 offen offset:1024 sc1
MAV 76,60,104
TR 26,7,25920
MAV 76,44,96
TR 28,7,25440
TR 30,7,25952
s_waitcnt vmcnt(16)
v_cmp_gt_u32 vcc, v23, v25
s_nop 0
s_cbranch_vccnz .Lsp67
.Lsp67b:
s_waitcnt lgkmcnt(8)
s_barrier
MAV 32,0,112
TR 32,6,16896
s_add_u32 m0, s55, 67584
MAV 32,16,120
buffer_load_dwordx4 v18, s[28:31], s54 offen lds
MAV 48,16,124
TR 34,6,17408
MAV 48,0,116
TR 36,6,16928
TR 38,6,17440
MAV 52,4,116
TR 48,6,25344
s_add_u32 s52, s76, 16384
MAV 52,20,124
buffer_load_dwordx4 v[96:99], v4, s[16:19], s52 offen sc1
MAV 36,20,120
TR 50,6,25856
MAV 36,4,112
TR 52,6,25376
TR 54,6,25888
s_waitcnt lgkmcnt(8)
MAV 40,8,112
TR 40,6,16960
MAV 40,24,120
buffer_load_dwordx4 v19, s[28:31], s54 offen offset:1056 lds
MAV 56,24,124
TR 42,6,17472
s_add_u32 s54, s98, 2162688
MAV 56,8,116
TR 44,6,16992
TR 46,6,17504
MAV 60,12,116
TR 56,6,25408
MAV 60,28,124
buffer_load_dwordx4 v[100:103], v4, s[16:19], s52 offen offset:1024 sc1
MAV 44,28,120
TR 58,6,25920
MAV 44,12,112
TR 60,6,25440
TR 62,6,25952
s_waitcnt lgkmcnt(8)
MAV 64,32,112
TR 0,7,33792
s_add_u32 m0, s55, 76032
MAV 64,48,120
buffer_load_dwordx4 v18, s[28:31], s54 offen lds
MAV 80,48,124
TR 2,7,34304
MAV 80,32,116
TR 4,7,33824
TR 6,7,34336
MAV 84,36,116
TR 16,7,42240
s_add_u32 s52, s76, 81920
MAV 84,52,124
buffer_load_dwordx4 v[104:107], v4, s[16:19], s52 offen sc1
MAV 68,52,120
TR 18,7,42752
MAV 68,36,112
TR 20,7,42272
TR 22,7,42784
s_waitcnt lgkmcnt(8)
MAV 72,40,112
TR 8,7,33856
MAV 72,56,120
buffer_load_dwordx4 v19, s[28:31], s54 offen offset:1056 lds
MAV 88,56,124
TR 10,7,34368
s_add_u32 s54, s99, 2359296
MAV 88,40,116
TR 12,7,33888
TR 14,7,34400
MAV 92,44,116
TR 24,7,42304
MAV 92,60,124
buffer_load_dwordx4 v[108:111], v4, s[16:19], s52 offen offset:1024 sc1
MAV 76,60,120
TR 26,7,42816
MAV 76,44,112
TR 28,7,42336
TR 30,7,42848
s_waitcnt vmcnt(16) lgkmcnt(8)
s_barrier
MAV 32,0,128
TR 32,6,33792
s_add_u32 m0, s55, 84480
MAV 32,16,136
buffer_load_dwordx4 v18, s[28:31], s54 offen lds
MAV 48,16,140
TR 34,6,34304
MAV 48,0,132
TR 36,6,33824
TR 38,6,34336
MAV 52,4,132
TR 48,6,42240
s_add_u32 s52, s77, 131072
MAV 52,20,140
buffer_load_dwordx4 v[112:115], v4, s[16:19], s52 offen sc1
MAV 36,20,136
TR 50,6,42752
MAV 36,4,128
TR 52,6,42272
TR 54,6,42784
s_waitcnt lgkmcnt(8)
MAV 40,8,128
TR 40,6,33856
MAV 40,24,136
buffer_load_dwordx4 v19, s[28:31], s54 offen offset:1056 lds
MAV 56,24,140
TR 42,6,34368
s_add_u32 s54, s99, 2621440
MAV 56,8,132
TR 44,6,33888
TR 46,6,34400
MAV 60,12,132
TR 56,6,42304
MAV 60,28,140
buffer_load_dwordx4 v[116:119], v4, s[16:19], s52 offen offset:1024 sc1
MAV 44,28,136
TR 58,6,42816
MAV 44,12,128
TR 60,6,42336
TR 62,6,42848
s_waitcnt lgkmcnt(8)
MAV 64,32,128
TR 0,7,50688
s_add_u32 m0, s55, 92928
MAV 64,48,136
buffer_load_dwordx4 v18, s[28:31], s54 offen lds
MAV 80,48,140
TR 2,7,51200
MAV 80,32,132
TR 4,7,50720
TR 6,7,51232
MAV 84,36,132
TR 16,7,59136
s_add_u32 s52, s77, 196608
MAV 84,52,140
buffer_load_dwordx4 v[120:123], v4, s[16:19], s52 offen sc1
MAV 68,52,136
TR 18,7,59648
MAV 68,36,128
TR 20,7,59168
TR 22,7,59680
s_waitcnt lgkmcnt(8)
MAV 72,40,128
TR 8,7,50752
MAV 72,56,136
buffer_load_dwordx4 v19, s[28:31], s54 offen offset:1056 lds
MAV 88,56,140
TR 10,7,51264
s_add_u32 s54, s100, 2818048
MAV 88,40,132
TR 12,7,50784
TR 14,7,51296
MAV 92,44,132
TR 24,7,59200
MAV 92,60,140
buffer_load_dwordx4 v[124:127], v4, s[16:19], s52 offen offset:1024 sc1
MAV 76,60,136
TR 26,7,59712
MAV 76,44,128
TR 28,7,59232
TR 30,7,59744
s_waitcnt vmcnt(16) lgkmcnt(8)
s_barrier
MAV 32,0,144
TR 32,6,50688
s_add_u32 m0, s55, 101376
MAV 32,16,152
buffer_load_dwordx4 v18, s[28:31], s54 offen lds
MAV 48,16,156
TR 34,6,51200
MAV 48,0,148
TR 36,6,50720
TR 38,6,51232
MAV 52,4,148
TR 48,6,59136
s_add_u32 s52, s78, 245760
MAV 52,20,156
buffer_load_dwordx4 v[128:131], v4, s[16:19], s52 offen sc1
MAV 36,20,152
TR 50,6,59648
MAV 36,4,144
TR 52,6,59168
TR 54,6,59680
s_waitcnt lgkmcnt(8)
MAV 40,8,144
TR 40,6,50752
MAV 40,24,152
buffer_load_dwordx4 v19, s[28:31], s54 offen offset:1056 lds
MAV 56,24,156
TR 42,6,51264
s_add_u32 s54, s100, 3080192
MAV 56,8,148
TR 44,6,50784
TR 46,6,51296
MAV 60,12,148
TR 56,6,59200
MAV 60,28,156
buffer_load_dwordx4 v[132:135], v4, s[16:19], s52 offen offset:1024 sc1
MAV 44,28,152
TR 58,6,59712
MAV 44,12,144
TR 60,6,59232
TR 62,6,59744
v_add_u32 v7, s57, v7
v_add_u32 v6, s57, v6
s_sub_u32 s57, 0, s57
s_waitcnt lgkmcnt(8)
MAV 64,32,144
ds_read_b64_tr_b16 a[0:1], v7
s_add_u32 m0, s55, 109824
MAV 64,48,152
buffer_load_dwordx4 v18, s[28:31], s54 offen lds
MAV 80,48,156
TR 2,7,512
MAV 80,32,148
TR 4,7,32
TR 6,7,544
MAV 84,36,148
TR 16,7,8448
s_add_u32 s52, s78, 311296
MAV 84,52,156
buffer_load_dwordx4 v[136:139], v4, s[16:19], s52 offen sc1
MAV 68,52,152
TR 18,7,8960
MAV 68,36,144
TR 20,7,8480
TR 22,7,8992
s_waitcnt lgkmcnt(8)
MAV 72,40,144
TR 8,7,64
MAV 72,56,152
buffer_load_dwordx4 v19, s[28:31], s54 offen offset:1056 lds
MAV 88,56,156
TR 10,7,576
s_add_u32 s54, s101, 3276800
MAV 88,40,148
TR 12,7,96
TR 14,7,608
MAV 92,44,148
TR 24,7,8512
MAV 92,60,156
buffer_load_dwordx4 v[140:143], v4, s[16:19], s52 offen offset:1024 sc1
MAV 76,60,152
TR 26,7,9024
MAV 76,44,144
TR 28,7,8544
TR 30,7,9056
s_waitcnt vmcnt(16) lgkmcnt(8)
s_barrier
MAV 32,0,96
ds_read_b64_tr_b16 a[32:33], v6
s_add_u32 m0, s55, 118272
MAV 32,16,104
buffer_load_dwordx4 v18, s[28:31], s54 offen lds
MAV 48,16,108
TR 34,6,512
MAV 48,0,100
TR 36,6,32
TR 38,6,544
MAV 52,4,100
TR 48,6,8448
s_add_u32 s52, s79, 360448
MAV 52,20,108
buffer_load_dwordx4 v[144:147], v4, s[16:19], s52 offen sc1
MAV 36,20,104
TR 50,6,8960
MAV 36,4,96
TR 52,6,8480
TR 54,6,8992
s_waitcnt lgkmcnt(8)
MAV 40,8,96
TR 40,6,64
MAV 40,24,104
buffer_load_dwordx4 v19, s[28:31], s54 offen offset:1056 lds
MAV 56,24,108
TR 42,6,576
s_add_u32 s54, s101, 3538944
MAV 56,8,100
TR 44,6,96
TR 46,6,608
MAV 60,12,100
TR 56,6,8512
MAV 60,28,108
buffer_load_dwordx4 v[148:151], v4, s[16:19], s52 offen offset:1024 sc1
MAV 44,28,104
TR 58,6,9024
MAV 44,12,96
TR 60,6,8544
TR 62,6,9056
s_waitcnt lgkmcnt(8)
MAV 64,32,96
TR 0,7,16896
s_add_u32 m0, s55, 126720
MAV 64,48,104
.Lpad29:
s_cbranch_execz .Lpad32
buffer_load_dwordx4 v18, s[28:31], s54 offen lds
MAV 80,48,108
TR 2,7,17408
MAV 80,32,100
TR 4,7,16928
TR 6,7,17440
MAV 84,36,100
TR 16,7,25344
s_add_u32 s52, s79, 425984
MAV 84,52,108
buffer_load_dwordx4 v[152:155], v4, s[16:19], s52 offen sc1
MAV 68,52,104
TR 18,7,25856
MAV 68,36,96
TR 20,7,25376
TR 22,7,25888
s_waitcnt lgkmcnt(8)
MAV 72,40,96
TR 8,7,16960
MAV 72,56,104
buffer_load_dwordx4 v19, s[28:31], s54 offen offset:1056 lds
MAV 88,56,108
TR 10,7,17472
s_add_u32 s54, s98, 131072
MAV 88,40,100
TR 12,7,16992
TR 14,7,17504
MAV 92,44,100
TR 24,7,25408
MAV 92,60,108
buffer_load_dwordx4 v[156:159], v4, s[16:19], s52 offen offset:1024 sc1
MAV 76,60,104
TR 26,7,25920
MAV 76,44,96
TR 28,7,25440
TR 30,7,25952
s_waitcnt vmcnt(16) lgkmcnt(8)
s_barrier
MAV 32,0,112
TR 32,6,16896
s_add_u32 m0, s55, 0
MAV 32,16,120
buffer_load_dwordx4 v18, s[28:31], s54 offen lds
MAV 48,16,124
TR 34,6,17408
MAV 48,0,116
TR 36,6,16928
TR 38,6,17440
MAV 52,4,116
TR 48,6,25344
s_add_u32 s52, s76, 475136
MAV 52,20,124
buffer_load_dwordx4 v[96:99], v4, s[16:19], s52 offen sc1
MAV 36,20,120
TR 50,6,25856
MAV 36,4,112
TR 52,6,25376
TR 54,6,25888
s_waitcnt lgkmcnt(8)
MAV 40,8,112
TR 40,6,16960
MAV 40,24,120
buffer_load_dwordx4 v19, s[28:31], s54 offen offset:1056 lds
MAV 56,24,124
TR 42,6,17472
s_add_u32 s54, s98, 393216
MAV 56,8,116
TR 44,6,16992
TR 46,6,17504
MAV 60,12,116
TR 56,6,25408
MAV 60,28,124
buffer_load_dwordx4 v[100:103], v4, s[16:19], s52 offen offset:1024 sc1
MAV 44,28,120
TR 58,6,25920
MAV 44,12,112
TR 60,6,25440
TR 62,6,25952
s_waitcnt lgkmcnt(8)
MAV 64,32,112
TR 0,7,33792
s_add_u32 m0, s55, 8448
MAV 64,48,120
buffer_load_dwordx4 v18, s[28:31], s54 offen lds
MAV 80,48,124
TR 2,7,34304
MAV 80,32,116
TR 4,7,33824
TR 6,7,34336
MAV 84,36,116
TR 16,7,42240
s_add_u32 s52, s76, 540672
MAV 84,52,124
buffer_load_dwordx4 v[104:107], v4, s[16:19], s52 offen sc1
MAV 68,52,120
TR 18,7,42752
MAV 68,36,112
TR 20,7,42272
TR 22,7,42784
s_waitcnt lgkmcnt(8)
MAV 72,40,112
TR 8,7,33856
MAV 72,56,120
buffer_load_dwordx4 v19, s[28:31], s54 offen offset:1056 lds
MAV 88,56,124
TR 10,7,34368
s_add_u32 s54, s99, 589824
MAV 88,40,116
TR 12,7,33888
TR 14,7,34400
MAV 92,44,116
TR 24,7,42304
MAV 92,60,124
buffer_load_dwordx4 v[108:111], v4, s[16:19], s52 offen offset:1024 sc1
MAV 76,60,120
TR 26,7,42816
MAV 76,44,112
TR 28,7,42336
TR 30,7,42848
s_waitcnt vmcnt(16) lgkmcnt(8)
s_barrier
MAV 32,0,128
TR 32,6,33792
s_add_u32 m0, s55, 16896
MAV 32,16,136
buffer_load_dwordx4 v18, s[28:31], s54 offen lds
MAV 48,16,140
TR 34,6,34304
MAV 48,0,132
TR 36,6,33824
TR 38,6,34336
MAV 52,4,132
TR 48,6,42240
s_add_u32 s52, s77, 589824
MAV 52,20,140
buffer_load_dwordx4 v[112:115], v4, s[16:19], s52 offen sc1
MAV 36,20,136
TR 50,6,42752
MAV 36,4,128
TR 52,6,42272
TR 54,6,42784
s_waitcnt lgkmcnt(8)
MAV 40,8,128
TR 40,6,33856
MAV 40,24,136
buffer_load_dwordx4 v19, s[28:31], s54 offen offset:1056 lds
MAV 56,24,140
TR 42,6,34368
s_add_u32 s54, s99, 851968
MAV 56,8,132
TR 44,6,33888
TR 46,6,34400
MAV 60,12,132
TR 56,6,42304
MAV 60,28,140
buffer_load_dwordx4 v[116:119], v4, s[16:19], s52 offen offset:1024 sc1
MAV 44,28,136
TR 58,6,42816
MAV 44,12,128
TR 60,6,42336
TR 62,6,42848
s_waitcnt lgkmcnt(8)
MAV 64,32,128
TR 0,7,50688
s_add_u32 m0, s55, 25344
MAV 64,48,136
buffer_load_dwordx4 v18, s[28:31], s54 offen lds
MAV 80,48,140
TR 2,7,51200
MAV 80,32,132
TR 4,7,50720
TR 6,7,51232
MAV 84,36,132
TR 16,7,59136
s_add_u32 s52, s77, 655360
MAV 84,52,140
buffer_load_dwordx4 v[120:123], v4, s[16:19], s52 offen sc1
MAV 68,52,136
TR 18,7,59648
MAV 68,36,128
TR 20,7,59168
TR 22,7,59680
s_waitcnt lgkmcnt(8)
MAV 72,40,128
TR 8,7,50752
MAV 72,56,136
buffer_load_dwordx4 v19, s[28:31], s54 offen offset:1056 lds
MAV 88,56,140
TR 10,7,51264
s_add_u32 s54, s100, 1048576
MAV 88,40,132
TR 12,7,50784
TR 14,7,51296
MAV 92,44,132
TR 24,7,59200
MAV 92,60,140
buffer_load_dwordx4 v[124:127], v4, s[16:19], s52 offen offset:1024 sc1
MAV 76,60,136
TR 26,7,59712
MAV 76,44,128
TR 28,7,59232
TR 30,7,59744
s_waitcnt vmcnt(16) lgkmcnt(8)
s_barrier
MAV 32,0,144
TR 32,6,50688
s_add_u32 m0, s55, 33792
MAV 32,16,152
buffer_load_dwordx4 v18, s[28:31], s54 offen lds
MAV 48,16,156
TR 34,6,51200
MAV 48,0,148
TR 36,6,50720
TR 38,6,51232
MAV 52,4,148
TR 48,6,59136
s_add_u32 s52, s78, 704512
MAV 52,20,156
buffer_load_dwordx4 v[128:131], v4, s[16:19], s52 offen sc1
MAV 36,20,152
TR 50,6,59648
MAV 36,4,144
TR 52,6,59168
TR 54,6,59680
s_waitcnt lgkmcnt(8)
MAV 40,8,144
TR 40,6,50752
MAV 40,24,152
buffer_load_dwordx4 v19, s[28:31], s54 offen offset:1056 lds
MAV 56,24,156
TR 42,6,51264
s_add_u32 s54, s100, 1310720
MAV 56,8,148
TR 44,6,50784
TR 46,6,51296
MAV 60,12,148
TR 56,6,59200
MAV 60,28,156
buffer_load_dwordx4 v[132:135], v4, s[16:19], s52 offen offset:1024 sc1
MAV 44,28,152
TR 58,6,59712
MAV 44,12,144
TR 60,6,59232
TR 62,6,59744
v_add_u32 v7, s57, v7
v_add_u32 v6, s57, v6
s_sub_u32 s57, 0, s57
s_waitcnt lgkmcnt(8)
MAV 64,32,144
ds_read_b64_tr_b16 a[0:1], v7
s_add_u32 m0, s55, 42240
MAV 64,48,152
buffer_load_dwordx4 v18, s[28:31], s54 offen lds
MAV 80,48,156
TR 2,7,512
MAV 80,32,148
TR 4,7,32
TR 6,7,544
MAV 84,36,148
TR 16,7,8448
s_add_u32 s52, s78, 770048
MAV 84,52,156
buffer_load_dwordx4 v[136:139], v4, s[16:19], s52 offen sc1
MAV 68,52,152
TR 18,7,8960
MAV 68,36,144
TR 20,7,8480
TR 22,7,8992
s_waitcnt lgkmcnt(8)
MAV 72,40,144
TR 8,7,64
MAV 72,56,152
buffer_load_dwordx4 v19, s[28:31], s54 offen offset:1056 lds
MAV 88,56,156
TR 10,7,576
s_add_u32 s54, s101, 1507328
MAV 88,40,148
TR 12,7,96
TR 14,7,608
MAV 92,44,148
TR 24,7,8512
MAV 92,60,156
buffer_load_dwordx4 v[140:143], v4, s[16:19], s52 offen offset:1024 sc1
MAV 76,60,152
TR 26,7,9024
MAV 76,44,144
TR 28,7,8544
TR 30,7,9056
s_waitcnt vmcnt(16) lgkmcnt(8)
s_barrier
MAV 32,0,96
ds_read_b64_tr_b16 a[32:33], v6
s_add_u32 m0, s55, 50688
MAV 32,16,104
buffer_load_dwordx4 v18, s[28:31], s54 offen lds
MAV 48,16,108
TR 34,6,512
MAV 48,0,100
TR 36,6,32
TR 38,6,544
MAV 52,4,100
TR 48,6,8448
s_add_u32 s52, s79, 819200
MAV 52,20,108
buffer_load_dwordx4 v[144:147], v4, s[16:19], s52 offen sc1
MAV 36,20,104
TR 50,6,8960
MAV 36,4,96
TR 52,6,8480
TR 54,6,8992
s_waitcnt lgkmcnt(8)
MAV 40,8,96
TR 40,6,64
MAV 40,24,104
buffer_load_dwordx4 v19, s[28:31], s54 offen offset:1056 lds
MAV 56,24,108
TR 42,6,576
s_add_u32 s54, s101, 1769472
MAV 56,8,100
TR 44,6,96
TR 46,6,608
MAV 60,12,100
TR 56,6,8512
MAV 60,28,108
buffer_load_dwordx4 v[148:151], v4, s[16:19], s52 offen offset:1024 sc1
MAV 44,28,104
TR 58,6,9024
MAV 44,12,96
TR 60,6,8544
TR 62,6,9056
s_waitcnt lgkmcnt(8)
MAV 64,32,96
TR 0,7,16896
s_add_u32 m0, s55, 59136
MAV 64,48,104
buffer_load_dwordx4 v18, s[28:31], s54 offen lds
MAV 80,48,108
TR 2,7,17408
MAV 80,32,100
TR 4,7,16928
TR 6,7,17440
MAV 84,36,100
TR 16,7,25344
s_add_u32 s52, s79, 884736
MAV 84,52,108
buffer_load_dwordx4 v[152:155], v4, s[16:19], s52 offen sc1
MAV 68,52,104
TR 18,7,25856
MAV 68,36,96
TR 20,7,25376
TR 22,7,25888
s_waitcnt lgkmcnt(8)
MAV 72,40,96
TR 8,7,16960
MAV 72,56,104
buffer_load_dwordx4 v19, s[28:31], s54 offen offset:1056 lds
MAV 88,56,108
TR 10,7,17472
s_add_u32 s54, s98, 1966080
MAV 88,40,100
TR 12,7,16992
TR 14,7,17504
MAV 92,44,100
TR 24,7,25408
MAV 92,60,108
buffer_load_dwordx4 v[156:159], v4, s[16:19], s52 offen offset:1024 sc1
MAV 76,60,104
TR 26,7,25920
MAV 76,44,96
TR 28,7,25440
TR 30,7,25952
s_waitcnt vmcnt(16) lgkmcnt(8)
s_barrier
MAV 32,0,112
TR 32,6,16896
s_add_u32 m0, s55, 67584
MAV 32,16,120
buffer_load_dwordx4 v18, s[28:31], s54 offen lds
MAV 48,16,124
TR 34,6,17408
MAV 48,0,116
TR 36,6,16928
TR 38,6,17440
MAV 52,4,116
TR 48,6,25344
s_add_u32 s52, s76, 32768
MAV 52,20,124
buffer_load_dwordx4 v[96:99], v4, s[16:19], s52 offen sc1
MAV 36,20,120
TR 50,6,25856
MAV 36,4,112
TR 52,6,25376
TR 54,6,25888
s_waitcnt lgkmcnt(8)
MAV 40,8,112
TR 40,6,16960
MAV 40,24,120
buffer_load_dwordx4 v19, s[28:31], s54 offen offset:1056 lds
MAV 56,24,124
TR 42,6,17472
s_add_u32 s54, s98, 2228224
MAV 56,8,116
TR 44,6,16992
TR 46,6,17504
MAV 60,12,116
TR 56,6,25408
MAV 60,28,124
buffer_load_dwordx4 v[100:103], v4, s[16:19], s52 offen offset:1024 sc1
MAV 44,28,120
TR 58,6,25920
MAV 44,12,112
TR 60,6,25440
TR 62,6,25952
s_waitcnt lgkmcnt(8)
MAV 64,32,112
TR 0,7,33792
s_add_u32 m0, s55, 76032
MAV 64,48,120
buffer_load_dwordx4 v18, s[28:31], s54 offen lds
MAV 80,48,124
TR 2,7,34304
MAV 80,32,116
TR 4,7,33824
TR 6,7,34336
MAV 84,36,116
TR 16,7,42240
s_add_u32 s52, s76, 98304
MAV 84,52,124
buffer_load_dwordx4 v[104:107], v4, s[16:19], s52 offen sc1
MAV 68,52,120
TR 18,7,42752
MAV 68,36,112
TR 20,7,42272
TR 22,7,42784
s_waitcnt lgkmcnt(8)
MAV 72,40,112
TR 8,7,33856
MAV 72,56,120
buffer_load_dwordx4 v19, s[28:31], s54 offen offset:1056 lds
MAV 88,56,124
TR 10,7,34368
s_add_u32 s54, s99, 2424832
MAV 88,40,116
TR 12,7,33888
TR 14,7,34400
MAV 92,44,116
TR 24,7,42304
MAV 92,60,124
buffer_load_dwordx4 v[108:111], v4, s[16:19], s52 offen offset:1024 sc1
MAV 76,60,120
TR 26,7,42816
MAV 76,44,112
TR 28,7,42336
TR 30,7,42848
s_waitcnt vmcnt(16) lgkmcnt(8)
s_barrier
MAV 32,0,128
TR 32,6,33792
s_add_u32 m0, s55, 84480
MAV 32,16,136
buffer_load_dwordx4 v18, s[28:31], s54 offen lds
MAV 48,16,140
TR 34,6,34304
MAV 48,0,132
TR 36,6,33824
TR 38,6,34336
MAV 52,4,132
TR 48,6,42240
s_add_u32 s52, s77, 147456
MAV 52,20,140
buffer_load_dwordx4 v[112:115], v4, s[16:19], s52 offen sc1
MAV 36,20,136
TR 50,6,42752
MAV 36,4,128
TR 52,6,42272
TR 54,6,42784
s_waitcnt lgkmcnt(8)
MAV 40,8,128
TR 40,6,33856
MAV 40,24,136
buffer_load_dwordx4 v19, s[28:31], s54 offen offset:1056 lds
MAV 56,24,140
TR 42,6,34368
s_add_u32 s54, s99, 2686976
MAV 56,8,132
TR 44,6,33888
TR 46,6,34400
MAV 60,12,132
TR 56,6,42304
MAV 60,28,140
buffer_load_dwordx4 v[116:119], v4, s[16:19], s52 offen offset:1024 sc1
MAV 44,28,136
TR 58,6,42816
MAV 44,12,128
TR 60,6,42336
TR 62,6,42848
s_waitcnt lgkmcnt(8)
MAV 64,32,128
TR 0,7,50688
s_add_u32 m0, s55, 92928
MAV 64,48,136
buffer_load_dwordx4 v18, s[28:31], s54 offen lds
MAV 80,48,140
TR 2,7,51200
MAV 80,32,132
TR 4,7,50720
TR 6,7,51232
MAV 84,36,132
TR 16,7,59136
s_add_u32 s52, s77, 212992
MAV 84,52,140
buffer_load_dwordx4 v[120:123], v4, s[16:19], s52 offen sc1
MAV 68,52,136
TR 18,7,59648
MAV 68,36,128
TR 20,7,59168
TR 22,7,59680
s_waitcnt lgkmcnt(8)
MAV 72,40,128
TR 8,7,50752
MAV 72,56,136
buffer_load_dwordx4 v19, s[28:31], s54 offen offset:1056 lds
MAV 88,56,140
TR 10,7,51264
s_add_u32 s54, s100, 2883584
MAV 88,40,132
TR 12,7,50784
TR 14,7,51296
MAV 92,44,132
.Lpad30:
s_cbranch_execz .Lnopoll63r
TR 24,7,59200
MAV 92,60,140
buffer_load_dwordx4 v[124:127], v4, s[16:19], s52 offen offset:1024 sc1
MAV 76,60,136
TR 26,7,59712
MAV 76,44,128
TR 28,7,59232
TR 30,7,59744
s_waitcnt vmcnt(16) lgkmcnt(8)
s_barrier
MAV 32,0,144
TR 32,6,50688
s_add_u32 m0, s55, 101376
MAV 32,16,152
buffer_load_dwordx4 v18, s[28:31], s54 offen lds
MAV 48,16,156
TR 34,6,51200
MAV 48,0,148
TR 36,6,50720
TR 38,6,51232
MAV 52,4,148
TR 48,6,59136
s_add_u32 s52, s78, 262144
MAV 52,20,156
buffer_load_dwordx4 v[128:131], v4, s[16:19], s52 offen sc1
MAV 36,20,152
TR 50,6,59648
MAV 36,4,144
TR 52,6,59168
TR 54,6,59680
s_waitcnt lgkmcnt(8)
MAV 40,8,144
TR 40,6,50752
MAV 40,24,152
buffer_load_dwordx4 v19, s[28:31], s54 offen offset:1056 lds
MAV 56,24,156
TR 42,6,51264
s_add_u32 s54, s100, 3145728
MAV 56,8,148
TR 44,6,50784
TR 46,6,51296
MAV 60,12,148
TR 56,6,59200
MAV 60,28,156
buffer_load_dwordx4 v[132:135], v4, s[16:19], s52 offen offset:1024 sc1
MAV 44,28,152
TR 58,6,59712
MAV 44,12,144
TR 60,6,59232
TR 62,6,59744
v_add_u32 v7, s57, v7
v_add_u32 v6, s57, v6
s_sub_u32 s57, 0, s57
s_waitcnt lgkmcnt(8)
MAV 64,32,144
ds_read_b64_tr_b16 a[0:1], v7
s_add_u32 m0, s55, 109824
MAV 64,48,152
buffer_load_dwordx4 v18, s[28:31], s54 offen lds
MAV 80,48,156
TR 2,7,512
MAV 80,32,148
TR 4,7,32
TR 6,7,544
MAV 84,36,148
TR 16,7,8448
s_add_u32 s52, s78, 327680
MAV 84,52,156
buffer_load_dwordx4 v[136:139], v4, s[16:19], s52 offen sc1
MAV 68,52,152
TR 18,7,8960
MAV 68,36,144
TR 20,7,8480
TR 22,7,8992
s_waitcnt lgkmcnt(8)
MAV 72,40,144
TR 8,7,64
MAV 72,56,152
buffer_load_dwordx4 v19, s[28:31], s54 offen offset:1056 lds
MAV 88,56,156
TR 10,7,576
s_add_u32 s54, s101, 3342336
MAV 88,40,148
TR 12,7,96
TR 14,7,608
MAV 92,44,148
TR 24,7,8512
MAV 92,60,156
buffer_load_dwordx4 v[140:143], v4, s[16:19], s52 offen offset:1024 sc1
MAV 76,60,152
TR 26,7,9024
MAV 76,44,144
TR 28,7,8544
TR 30,7,9056
s_waitcnt vmcnt(16) lgkmcnt(8)
s_barrier
MAV 32,0,96
ds_read_b64_tr_b16 a[32:33], v6
s_add_u32 m0, s55, 118272
MAV 32,16,104
buffer_load_dwordx4 v18, s[28:31], s54 offen lds
MAV 48,16,108
TR 34,6,512
MAV 48,0,100
TR 36,6,32
TR 38,6,544
MAV 52,4,100
TR 48,6,8448
s_add_u32 s52, s79, 376832
MAV 52,20,108
buffer_load_dwordx4 v[144:147], v4, s[16:19], s52 offen sc1
MAV 36,20,104
TR 50,6,8960
MAV 36,4,96
TR 52,6,8480
TR 54,6,8992
s_waitcnt lgkmcnt(8)
MAV 40,8,96
TR 40,6,64
MAV 40,24,104
buffer_load_dwordx4 v19, s[28:31], s54 offen offset:1056 lds
MAV 56,24,108
TR 42,6,576
s_add_u32 s54, s101, 3604480
MAV 56,8,100
TR 44,6,96
TR 46,6,608
MAV 60,12,100
TR 56,6,8512
MAV 60,28,108
buffer_load_dwordx4 v[148:151], v4, s[16:19], s52 offen offset:1024 sc1
MAV 44,28,104
TR 58,6,9024
MAV 44,12,96
TR 60,6,8544
TR 62,6,9056
s_waitcnt lgkmcnt(8)
MAV 64,32,96
TR 0,7,16896
s_add_u32 m0, s55, 126720
MAV 64,48,104
buffer_load_dwordx4 v18, s[28:31], s54 offen lds
MAV 80,48,108
TR 2,7,17408
MAV 80,32,100
TR 4,7,16928
TR 6,7,17440
MAV 84,36,100
TR 16,7,25344
s_add_u32 s52, s79, 442368
MAV 84,52,108
buffer_load_dwordx4 v[152:155], v4, s[16:19], s52 offen sc1
MAV 68,52,104
TR 18,7,25856
MAV 68,36,96
TR 20,7,25376
TR 22,7,25888
s_waitcnt lgkmcnt(8)
MAV 72,40,96
TR 8,7,16960
MAV 72,56,104
buffer_load_dwordx4 v19, s[28:31], s54 offen offset:1056 lds
MAV 88,56,108
TR 10,7,17472
s_add_u32 s54, s98, 196608
MAV 88,40,100
TR 12,7,16992
TR 14,7,17504
MAV 92,44,100
TR 24,7,25408
MAV 92,60,108
buffer_load_dwordx4 v[156:159], v4, s[16:19], s52 offen offset:1024 sc1
MAV 76,60,104
TR 26,7,25920
MAV 76,44,96
TR 28,7,25440
TR 30,7,25952
s_waitcnt vmcnt(16) lgkmcnt(8)
s_barrier
MAV 32,0,112
TR 32,6,16896
s_add_u32 m0, s55, 0
MAV 32,16,120
buffer_load_dwordx4 v18, s[28:31], s54 offen lds
MAV 48,16,124
TR 34,6,17408
MAV 48,0,116
TR 36,6,16928
TR 38,6,17440
MAV 52,4,116
TR 48,6,25344
s_add_u32 s52, s76, 491520
MAV 52,20,124
buffer_load_dwordx4 v[96:99], v4, s[16:19], s52 offen sc1
MAV 36,20,120
TR 50,6,25856
MAV 36,4,112
TR 52,6,25376
TR 54,6,25888
s_waitcnt lgkmcnt(8)
MAV 40,8,112
TR 40,6,16960
MAV 40,24,120
buffer_load_dwordx4 v19, s[28:31], s54 offen offset:1056 lds
MAV 56,24,124
TR 42,6,17472
s_add_u32 s54, s99, 655360
MAV 56,8,116
TR 44,6,16992
TR 46,6,17504
MAV 60,12,116
TR 56,6,25408
MAV 60,28,124
buffer_load_dwordx4 v[100:103], v4, s[16:19], s52 offen offset:1024 sc1
MAV 44,28,120
TR 58,6,25920
MAV 44,12,112
TR 60,6,25440
TR 62,6,25952
s_waitcnt lgkmcnt(8)
MAV 64,32,112
TR 0,7,33792
s_add_u32 m0, s55, 8448
MAV 64,48,120
buffer_load_dwordx4 v18, s[28:31], s54 offen lds
MAV 80,48,124
TR 2,7,34304
MAV 80,32,116
TR 4,7,33824
TR 6,7,34336
MAV 84,36,116
TR 16,7,42240
s_add_u32 s52, s76, 557056
MAV 84,52,124
buffer_load_dwordx4 v[104:107], v4, s[16:19], s52 offen sc1
MAV 68,52,120
TR 18,7,42752
MAV 68,36,112
TR 20,7,42272
TR 22,7,42784
s_waitcnt lgkmcnt(8)
MAV 72,40,112
TR 8,7,33856
MAV 72,56,120
buffer_load_dwordx4 v19, s[28:31], s54 offen offset:1056 lds
MAV 88,56,124
TR 10,7,34368
s_add_u32 s54, s100, 1114112
MAV 88,40,116
TR 12,7,33888
TR 14,7,34400
MAV 92,44,116
TR 24,7,42304
MAV 92,60,124
buffer_load_dwordx4 v[108:111], v4, s[16:19], s52 offen offset:1024 sc1
MAV 76,60,120
TR 26,7,42816
MAV 76,44,112
TR 28,7,42336
TR 30,7,42848
s_waitcnt vmcnt(16) lgkmcnt(8)
s_barrier
MAV 32,0,128
TR 32,6,33792
s_add_u32 m0, s55, 16896
MAV 32,16,136
buffer_load_dwordx4 v18, s[28:31], s54 offen lds
MAV 48,16,140
TR 34,6,34304
MAV 48,0,132
TR 36,6,33824
TR 38,6,34336
MAV 52,4,132
TR 48,6,42240
s_add_u32 s52, s77, 606208
MAV 52,20,140
buffer_load_dwordx4 v[112:115], v4, s[16:19], s52 offen sc1
MAV 36,20,136
TR 50,6,42752
MAV 36,4,128
TR 52,6,42272
TR 54,6,42784
s_waitcnt lgkmcnt(8)
MAV 40,8,128
TR 40,6,33856
MAV 40,24,136
buffer_load_dwordx4 v19, s[28:31], s54 offen offset:1056 lds
MAV 56,24,140
TR 42,6,34368
s_add_u32 s54, s101, 1572864
MAV 56,8,132
TR 44,6,33888
TR 46,6,34400
MAV 60,12,132
TR 56,6,42304
MAV 60,28,140
buffer_load_dwordx4 v[116:119], v4, s[16:19], s52 offen offset:1024 sc1
MAV 44,28,136
TR 58,6,42816
MAV 44,12,128
TR 60,6,42336
TR 62,6,42848
s_waitcnt lgkmcnt(8)
MAV 64,32,128
TR 0,7,50688
s_add_u32 m0, s55, 25344
MAV 64,48,136
buffer_load_dwordx4 v18, s[28:31], s54 offen lds
MAV 80,48,140
TR 2,7,51200
MAV 80,32,132
TR 4,7,50720
TR 6,7,51232
MAV 84,36,132
TR 16,7,59136
s_add_u32 s52, s77, 671744
MAV 84,52,140
buffer_load_dwordx4 v[120:123], v4, s[16:19], s52 offen sc1
MAV 68,52,136
TR 18,7,59648
MAV 68,36,128
TR 20,7,59168
TR 22,7,59680
s_waitcnt lgkmcnt(8)
MAV 72,40,128
TR 8,7,50752
MAV 72,56,136
buffer_load_dwordx4 v19, s[28:31], s54 offen offset:1056 lds
MAV 88,56,140
TR 10,7,51264
s_add_u32 s54, s98, 2031616
MAV 88,40,132
TR 12,7,50784
TR 14,7,51296
MAV 92,44,132
TR 24,7,59200
MAV 92,60,140
buffer_load_dwordx4 v[124:127], v4, s[16:19], s52 offen offset:1024 sc1
MAV 76,60,136
TR 26,7,59712
MAV 76,44,128
TR 28,7,59232
TR 30,7,59744
s_waitcnt vmcnt(16) lgkmcnt(8)
s_barrier
MAV 32,0,144
TR 32,6,50688
s_add_u32 m0, s55, 33792
MAV 32,16,152
buffer_load_dwordx4 v18, s[28:31], s54 offen lds
MAV 48,16,156
TR 34,6,51200
MAV 48,0,148
TR 36,6,50720
TR 38,6,51232
MAV 52,4,148
TR 48,6,59136
s_add_u32 s52, s78, 720896
MAV 52,20,156
buffer_load_dwordx4 v[128:131], v4, s[16:19], s52 offen sc1
MAV 36,20,152
TR 50,6,59648
MAV 36,4,144
TR 52,6,59168
TR 54,6,59680
s_waitcnt lgkmcnt(8)
MAV 40,8,144
TR 40,6,50752
MAV 40,24,152
buffer_load_dwordx4 v19, s[28:31], s54 offen offset:1056 lds
MAV 56,24,156
TR 42,6,51264
s_add_u32 s54, s99, 2490368
MAV 56,8,148
TR 44,6,50784
TR 46,6,51296
MAV 60,12,148
TR 56,6,59200
MAV 60,28,156
buffer_load_dwordx4 v[132:135], v4, s[16:19], s52 offen offset:1024 sc1
MAV 44,28,152
TR 58,6,59712
MAV 44,12,144
TR 60,6,59232
TR 62,6,59744
v_add_u32 v7, s57, v7
v_add_u32 v6, s57, v6
s_sub_u32 s57, 0, s57
s_waitcnt lgkmcnt(8)
MAV 64,32,144
ds_read_b64_tr_b16 a[0:1], v6
s_add_u32 m0, s55, 42240
MAV 64,48,152
buffer_load_dwordx4 v18, s[28:31], s54 offen lds
MAV 80,48,156
TR 2,6,512
MAV 80,32,148
TR 4,6,32
TR 6,6,544
MAV 84,36,148
TR 16,6,8448
s_add_u32 s52, s78, 786432
MAV 84,52,156
buffer_load_dwordx4 v[136:139], v4, s[16:19], s52 offen sc1
MAV 68,52,152
TR 18,6,8960
MAV 68,36,144
TR 20,6,8480
TR 22,6,8992
s_waitcnt lgkmcnt(8)
MAV 72,40,144
TR 8,6,64
MAV 72,56,152
buffer_load_dwordx4 v19, s[28:31], s54 offen offset:1056 lds
MAV 88,56,156
TR 10,6,576
s_add_u32 s54, s100, 2949120
MAV 88,40,148
TR 12,6,96
TR 14,6,608
MAV 92,44,148
TR 24,6,8512
MAV 92,60,156
buffer_load_dwordx4 v[140:143], v4, s[16:19], s52 offen offset:1024 sc1
MAV 76,60,152
TR 26,6,9024
MAV 76,44,144
TR 28,6,8544
TR 30,6,9056
s_waitcnt vmcnt(16) lgkmcnt(8)
s_barrier
MAV 64,0,96
TR 32,6,16896
TR 34,6,17408
s_add_u32 m0, s55, 50688
MAV 64,16,104
TR 36,6,16928
buffer_load_dwordx4 v18, s[28:31], s54 offen lds
MAV 80,16,108
TR 38,6,17440
MAV 80,0,100
TR 48,6,25344
buffer_load_dwordx4 v19, s[28:31], s54 offen offset:1056 lds
MAV 84,4,100
TR 50,6,25856
s_add_u32 s54, s101, 3407872
s_add_u32 s52, s79, 835584
MAV 84,20,108
buffer_load_dwordx4 v[144:147], v4, s[16:19], s52 offen sc1
MAV 68,20,104
TR 52,6,25376
TR 54,6,25888
MAV 68,4,96
TR 40,6,16960
s_waitcnt lgkmcnt(9)
MAV 72,8,96
TR 42,6,17472
MAV 72,24,104
TR 44,6,16992
buffer_load_dwordx4 v[148:151], v4, s[16:19], s52 offen offset:1024 sc1
MAV 88,24,108
TR 46,6,17504
s_add_u32 m0, s55, 59136
MAV 88,8,100
TR 56,6,25408
buffer_load_dwordx4 v18, s[28:31], s54 offen lds
MAV 92,12,100
TR 58,6,25920
MAV 92,28,108
TR 60,6,25440
buffer_load_dwordx4 v19, s[28:31], s54 offen offset:1056 lds
MAV 76,28,104
TR 62,6,25952
s_add_u32 s52, s79, 901120
MAV 76,12,96
buffer_load_dwordx4 v[152:155], v4, s[16:19], s52 offen sc1
buffer_load_dwordx4 v[156:159], v4, s[16:19], s52 offen offset:1024 sc1
s_waitcnt vmcnt(16) lgkmcnt(8)
MAV 64,32,112
TR 0,6,33792
s_add_u32 s52, s76, 49152
s_lshl_b32 s70, s2, 10
s_lshl_b32 s62, s3, 7
MAV 64,48,120
buffer_load_dwordx4 v[160:163], v4, s[16:19], s52 offen sc1
s_add_u32 s70, s70, s62
MAV 80,48,124
TR 2,6,34304
s_add_u32 s70, s70, 31457792
MAV 80,32,116
TR 4,6,33824
TR 6,6,34336
s_xor_b32 s71, s70, 1024
MAV 84,36,116
TR 16,6,42240
v_min_u32 v12, 1, v1
MAV 84,52,124
buffer_load_dwordx4 v[164:167], v4, s[16:19], s52 offen offset:1024 sc1
v_lshlrev_b32 v12, 28, v12
MAV 68,52,120
TR 18,6,42752
v_mov_b32 v13, 1
MAV 68,36,112
TR 20,6,42272
TR 22,6,42784
v_mov_b32 v15, 0
s_waitcnt lgkmcnt(8)
MAV 72,40,112
TR 8,6,33856
s_add_u32 s52, s77, 163840
s_lshl_b32 s68, s7, 18
MAV 72,56,120
buffer_load_dwordx4 v[168:171], v4, s[16:19], s52 offen sc1
s_add_u32 s68, s68, 146800640
MAV 88,56,124
TR 10,6,34368
s_xor_b32 s69, s68, 262144
MAV 88,40,116
TR 12,6,33888
TR 14,6,34400
v_mov_b32 v11, v4
MAV 92,44,116
TR 24,6,42304
v_and_b32 v2, 1, v1
MAV 92,60,124
buffer_load_dwordx4 v[172:175], v4, s[16:19], s52 offen offset:1024 sc1
v_lshlrev_b32 v2, 4, v2
MAV 76,60,120
TR 26,6,42816
v_mov_b32 v224, 0x3f80
v_lshlrev_b32 v2, v2, v224
MAV 76,44,112
TR 28,6,42336
TR 30,6,42848
s_waitcnt vmcnt(12) lgkmcnt(8)
MAV 64,0,128
.Lpad31:
s_cbranch_execz .Lnopoll63r
TR 32,6,50688
s_add_u32 s52, s78, 278528
v_bfe_u32 v224, v1, 2, 2
v_lshrrev_b32 v225, 4, v1
MAV 64,16,136
buffer_load_dwordx4 v[176:179], v4, s[16:19], s52 offen sc1
v_cmp_eq_u32 vcc, v224, v225
MAV 80,16,140
TR 34,6,51200
v_cndmask_b32 v2, 0, v2, vcc
MAV 80,0,132
TR 36,6,50720
TR 38,6,51232
v_and_b32 v224, 2, v1
MAV 84,4,132
TR 48,6,59136
v_cmp_eq_u32 vcc, 0, v224
MAV 84,20,140
buffer_load_dwordx4 v[180:183], v4, s[16:19], s52 offen offset:1024 sc1
v_cndmask_b32 v226, 0, v2, vcc
MAV 68,20,136
TR 50,6,59648
v_cndmask_b32 v227, v2, 0, vcc
MAV 68,4,128
TR 52,6,59168
TR 54,6,59680
v_mov_b32 v224, 0
s_waitcnt lgkmcnt(8)
MAV 72,8,128
TR 40,6,50752
s_add_u32 s52, s79, 393216
v_mov_b32 v225, 0
MAV 72,24,136
buffer_load_dwordx4 v[184:187], v4, s[16:19], s52 offen sc1
v_mov_b32 v228, 0
MAV 88,24,140
TR 42,6,51264
v_mov_b32 v229, 0
MAV 88,8,132
TR 44,6,50784
TR 46,6,51296
s_lshr_b32 s62, s6, 1
MAV 92,12,132
TR 56,6,59200
s_lshl_b32 s62, s62, 8
MAV 92,28,140
buffer_load_dwordx4 v[188:191], v4, s[16:19], s52 offen offset:1024 sc1
s_and_b32 s67, s6, 1
MAV 76,28,136
TR 58,6,59712
s_add_u32 s62, s62, s67
s_lshl_b32 s62, s62, 11
MAV 76,12,128
TR 60,6,59232
TR 62,6,59744
s_waitcnt vmcnt(8) lgkmcnt(8)
s_barrier
v_add_u32 v6, s57, v6
MAV 64,32,144
ds_read_b64_tr_b16 a[0:1], v6
s_add_u32 s52, s76, 507904
s_lshl_b32 s63, s3, 17
s_add_u32 s62, s62, s63
MAV 64,48,152
buffer_load_dwordx4 v[192:195], v4, s[16:19], s52 offen sc1
s_lshl_b32 s63, s7, 7
MAV 80,48,156
TR 2,6,512
s_add_u32 s62, s62, s63
MAV 80,32,148
TR 4,6,32
TR 6,6,544
s_mov_b32 s64, 0x8000
MAV 84,36,148
TR 16,6,8448
v_lshrrev_b32 v21, 3, v1
MAV 84,52,156
buffer_load_dwordx4 v[196:199], v4, s[16:19], s52 offen offset:1024 sc1
v_and_b32 v2, 7, v1
MAV 68,52,152
TR 18,6,8960
v_lshlrev_b32 v2, 4, v2
MAV 68,36,144
TR 20,6,8480
TR 22,6,8992
v_lshl_add_u32 v16, v21, 12, v2
s_waitcnt lgkmcnt(8)
MAV 72,40,144
TR 8,6,64
s_add_u32 s52, s77, 622592
v_add_u32 v16, s62, v16
MAV 72,56,152
buffer_load_dwordx4 v[200:203], v4, s[16:19], s52 offen sc1
v_add_u32 v17, 0x10000, v16
MAV 88,56,156
TR 10,6,576
s_mul_i32 s62, s3, 4608
MAV 88,40,148
TR 12,6,96
TR 14,6,608
s_add_u32 s62, s62, 135168
MAV 92,44,148
TR 24,6,8512
v_mul_u32_u24 v21, 144, v21
MAV 92,60,156
buffer_load_dwordx4 v[204:207], v4, s[16:19], s52 offen offset:1024 sc1
v_add3_u32 v21, v21, v2, s62
MAV 76,60,152
TR 26,6,9024
v_and_b32 v20, 15, v1
v_mul_u32_u24 v20, 144, v20
MAV 76,44,144
TR 28,6,8544
TR 30,6,9056
s_waitcnt vmcnt(8) lgkmcnt(8)
MAV 64,0,160
TR 32,6,16896
s_add_u32 s52, s78, 737280
v_lshrrev_b32 v2, 4, v1
v_lshlrev_b32 v2, 3, v2
MAV 64,16,168
buffer_load_dwordx4 v[208:211], v4, s[16:19], s52 offen sc1
v_add3_u32 v20, v20, v2, s62
MAV 80,16,172
TR 34,6,17408
v_accvgpr_read_b32 v28, a224
MAV 80,0,164
TR 36,6,16928
TR 38,6,17440
v_add_f32 v32, v32, v28
MAV 84,4,164
TR 48,6,25344
v_accvgpr_read_b32 v29, a225
MAV 84,20,172
buffer_load_dwordx4 v[212:215], v4, s[16:19], s52 offen offset:1024 sc1
v_add_f32 v33, v33, v29
MAV 68,20,168
TR 50,6,25856
v_accvgpr_read_b32 v28, a226
MAV 68,4,160
TR 52,6,25376
TR 54,6,25888
v_add_f32 v34, v34, v28
s_waitcnt lgkmcnt(8)
MAV 72,8,160
TR 40,6,16960
s_add_u32 s52, s79, 851968
v_accvgpr_read_b32 v29, a227
MAV 72,24,168
buffer_load_dwordx4 v[216:219], v4, s[16:19], s52 offen sc1
v_add_f32 v35, v35, v29
MAV 88,24,172
TR 42,6,17472
v_accvgpr_read_b32 v28, a228
MAV 88,8,164
TR 44,6,16992
TR 46,6,17504
v_add_f32 v36, v36, v28
MAV 92,12,164
TR 56,6,25408
v_accvgpr_read_b32 v29, a229
MAV 92,28,172
buffer_load_dwordx4 v[220:223], v4, s[16:19], s52 offen offset:1024 sc1
v_add_f32 v37, v37, v29
MAV 76,28,168
TR 58,6,25920
v_accvgpr_read_b32 v28, a230
v_add_f32 v38, v38, v28
MAV 76,12,160
TR 60,6,25440
TR 62,6,25952
s_waitcnt vmcnt(8) lgkmcnt(8)
MAV 64,32,176
TR 0,6,33792
v_accvgpr_read_b32 v29, a231
MAV 64,48,184
TR 2,6,34304
v_add_f32 v39, v39, v29
v_accvgpr_read_b32 v28, a232
MAV 80,48,188
TR 4,6,33824
MAV 80,32,180
TR 6,6,34336
v_add_f32 v40, v40, v28
v_accvgpr_read_b32 v29, a233
MAV 84,36,180
TR 16,6,42240
v_add_f32 v41, v41, v29
MAV 84,52,188
TR 18,6,42752
v_accvgpr_read_b32 v28, a234
MAV 68,52,184
TR 20,6,42272
v_add_f32 v42, v42, v28
MAV 68,36,176
TR 22,6,42784
v_accvgpr_read_b32 v29, a235
s_waitcnt lgkmcnt(8)
MAV 72,40,176
TR 8,6,33856
MAV 72,56,184
TR 10,6,34368
v_add_f32 v43, v43, v29
v_accvgpr_read_b32 v28, a236
MAV 88,56,188
TR 12,6,33888
v_add_f32 v44, v44, v28
MAV 88,40,180
TR 14,6,34400
v_accvgpr_read_b32 v29, a237
MAV 92,44,180
TR 24,6,42304
v_add_f32 v45, v45, v29
MAV 92,60,188
TR 26,6,42816
v_accvgpr_read_b32 v28, a238
MAV 76,60,184
TR 28,6,42336
v_add_f32 v46, v46, v28
MAV 76,44,176
TR 30,6,42848
v_accvgpr_read_b32 v29, a239
s_waitcnt vmcnt(4) lgkmcnt(8)
MAV 64,0,192
TR 32,6,50688
v_add_f32 v47, v47, v29
MAV 64,16,200
TR 34,6,51200
v_accvgpr_read_b32 v28, a240
v_add_f32 v48, v48, v28
MAV 80,16,204
TR 36,6,50720
MAV 80,0,196
TR 38,6,51232
v_accvgpr_read_b32 v29, a241
v_add_f32 v49, v49, v29
MAV 84,4,196
TR 48,6,59136
v_accvgpr_read_b32 v28, a242
MAV 84,20,204
TR 50,6,59648
v_add_f32 v50, v50, v28
MAV 68,20,200
TR 52,6,59168
v_accvgpr_read_b32 v29, a243
MAV 68,4,192
TR 54,6,59680
v_add_f32 v51, v51, v29
s_waitcnt lgkmcnt(8)
MAV 72,8,192
TR 40,6,50752
MAV 72,24,200
TR 42,6,51264
v_accvgpr_read_b32 v28, a244
v_add_f32 v52, v52, v28
MAV 88,24,204
TR 44,6,50784
v_accvgpr_read_b32 v29, a245
MAV 88,8,196
TR 46,6,51296
v_add_f32 v53, v53, v29
MAV 92,12,196
TR 56,6,59200
v_accvgpr_read_b32 v28, a246
MAV 92,28,204
TR 58,6,59712
v_add_f32 v54, v54, v28
MAV 76,28,200
TR 60,6,59232
v_accvgpr_read_b32 v29, a247
MAV 76,12,192
TR 62,6,59744
v_add_f32 v55, v55, v29
s_waitcnt vmcnt(0) lgkmcnt(8)
MAV 64,32,208
ds_read_b64_tr_b16 a[0:1], v7
v_accvgpr_read_b32 v28, a248
MAV 64,48,216
TR 2,7,512
v_add_f32 v56, v56, v28
v_accvgpr_read_b32 v29, a249
MAV 80,48,220
TR 4,7,32
MAV 80,32,212
TR 6,7,544
v_add_f32 v57, v57, v29
v_accvgpr_read_b32 v28, a250
MAV 84,36,212
TR 16,7,8448
MAV 84,52,220
TR 18,7,8960
v_add_f32 v58, v58, v28
v_accvgpr_read_b32 v29, a251
MAV 68,52,216
TR 20,7,8480
MAV 68,36,208
TR 22,7,8992
v_add_f32 v59, v59, v29
s_waitcnt lgkmcnt(8)
MAV 72,40,208
TR 8,7,64
v_accvgpr_read_b32 v28, a252
MAV 72,56,216
TR 10,7,576
v_add_f32 v60, v60, v28
MAV 88,56,220
TR 12,7,96
v_accvgpr_read_b32 v29, a253
MAV 88,40,212
TR 14,7,608
v_add_f32 v61, v61, v29
MAV 92,44,212
TR 24,7,8512
v_accvgpr_read_b32 v28, a254
MAV 92,60,220
TR 26,7,9024
v_add_f32 v62, v62, v28
MAV 76,60,216
TR 28,7,8544
v_accvgpr_read_b32 v29, a255
MAV 76,44,208
TR 30,7,9056
v_add_f32 v63, v63, v29
s_waitcnt lgkmcnt(8)
MAV 32,0,96
TR 32,7,16896
v_cvt_pk_bf16_f32 v232, v64, v65
MAV 32,16,104
TR 34,7,17408
v_cvt_pk_bf16_f32 v233, v66, v67
v_cvt_pk_bf16_f32 v234, v68, v69
MAV 48,16,108
TR 36,7,16928
v_cvt_pk_bf16_f32 v235, v70, v71
MAV 48,0,100
TR 38,7,17440
buffer_store_dwordx4 v[232:235], v11, s[16:19], s69 offen sc1
s_add_u32 s69, s69, 131072
MAV 52,4,100
TR 48,7,25344
v_cvt_pk_bf16_f32 v236, v72, v73
MAV 52,20,108
TR 50,7,25856
v_cvt_pk_bf16_f32 v237, v74, v75
v_cvt_pk_bf16_f32 v238, v76, v77
MAV 36,20,104
TR 52,7,25376
v_cvt_pk_bf16_f32 v239, v78, v79
MAV 36,4,96
TR 54,7,25888
buffer_store_dwordx4 v[236:239], v11, s[16:19], s69 offen sc1
s_waitcnt lgkmcnt(8)
MAV 40,8,96
TR 40,7,16960
s_add_u32 s69, s69, -130048
MAV 40,24,104
TR 42,7,17472
v_cvt_pk_bf16_f32 v240, v80, v81
v_cvt_pk_bf16_f32 v241, v82, v83
MAV 56,24,108
TR 44,7,16992
v_cvt_pk_bf16_f32 v242, v84, v85
MAV 56,8,100
TR 46,7,17504
v_cvt_pk_bf16_f32 v243, v86, v87
buffer_store_dwordx4 v[240:243], v11, s[16:19], s69 offen sc1
MAV 60,12,100
TR 56,7,25408
s_add_u32 s69, s69, 131072
MAV 60,28,108
TR 58,7,25920
v_cvt_pk_bf16_f32 v244, v88, v89
v_cvt_pk_bf16_f32 v245, v90, v91
MAV 44,28,104
TR 60,7,25440
v_cvt_pk_bf16_f32 v246, v92, v93
MAV 44,12,96
TR 62,7,25952
v_cvt_pk_bf16_f32 v247, v94, v95
buffer_store_dwordx4 v[244:247], v11, s[16:19], s69 offen sc1
s_waitcnt lgkmcnt(8)
MAV 32,32,112
TR 0,7,33792
MAV 32,48,120
TR 2,7,34304
MAV 48,48,124
TR 4,7,33824
MAV 48,32,116
TR 6,7,34336
MAV 52,36,116
TR 16,7,42240
MAV 52,52,124
TR 18,7,42752
MAV 36,52,120
TR 20,7,42272
MAV 36,36,112
TR 22,7,42784
s_waitcnt lgkmcnt(8)
MAV 40,40,112
TR 8,7,33856
MAV 40,56,120
TR 10,7,34368
MAV 56,56,124
TR 12,7,33888
MAV 56,40,116
TR 14,7,34400
MAV 60,44,116
TR 24,7,42304
MAV 60,60,124
TR 26,7,42816
MAV 44,60,120
TR 28,7,42336
MAV 44,44,112
TR 30,7,42848
s_waitcnt lgkmcnt(8)
MAV 32,0,128
TR 32,7,50688
MAV 32,16,136
TR 34,7,51200
MAV 48,16,140
TR 36,7,50720
MAV 48,0,132
TR 38,7,51232
MAV 52,4,132
TR 48,7,59136
MAV 52,20,140
TR 50,7,59648
MAV 36,20,136
TR 52,7,59168
MAV 36,4,128
TR 54,7,59680
s_waitcnt lgkmcnt(8)
MAV 40,8,128
TR 40,7,50752
MAV 40,24,136
TR 42,7,51264
MAV 56,24,140
TR 44,7,50784
MAV 56,8,132
TR 46,7,51296
MAV 60,12,132
TR 56,7,59200
MAV 60,28,140
TR 58,7,59712
MAV 44,28,136
TR 60,7,59232
MAV 44,12,128
TR 62,7,59744
v_add_u32 v7, s57, v7
s_waitcnt lgkmcnt(8)
MAV 32,32,144
ds_read_b64_tr_b16 a[0:1], v7
MAV 32,48,152
s_waitcnt vmcnt(0)
buffer_atomic_add v13, v12, s[16:19], s71 offen
MAV 48,48,156
TR 2,7,512
MAV 48,32,148
TR 4,7,32
TR 6,7,544
MAV 52,36,148
MAV 52,52,156
TR 16,7,8448
TR 18,7,8960
MAV 36,52,152
TR 20,7,8480
MAV 36,36,144
s_waitcnt lgkmcnt(7)
MAV 40,40,144
TR 22,7,8992
MAV 40,56,152
TR 8,7,64
TR 10,7,576
MAV 56,56,156
MAV 56,40,148
TR 12,7,96
TR 14,7,608
MAV 60,44,148
TR 24,7,8512
MAV 60,60,156
TR 26,7,9024
MAV 44,60,152
TR 28,7,8544
MAV 44,44,144
TR 30,7,9056
s_waitcnt lgkmcnt(8)
MAV 32,0,160
TR 32,7,16896
MAV 32,16,168
buffer_atomic_add v15, v12, s[16:19], s70 offen sc0
MAV 48,16,172
TR 34,7,17408
MAV 48,0,164
TR 36,7,16928
TR 38,7,17440
MAV 52,4,164
MAV 52,20,172
TR 48,7,25344
TR 50,7,25856
MAV 36,20,168
TR 52,7,25376
MAV 36,4,160
s_waitcnt lgkmcnt(7)
MAV 40,8,160
TR 54,7,25888
MAV 40,24,168
TR 40,7,16960
TR 42,7,17472
MAV 56,24,172
MAV 56,8,164
TR 44,7,16992
TR 46,7,17504
MAV 60,12,164
TR 56,7,25408
MAV 60,28,172
TR 58,7,25920
MAV 44,28,168
TR 60,7,25440
MAV 44,12,160
TR 62,7,25952
s_waitcnt lgkmcnt(8)
MAV 32,32,176
TR 0,7,33792
MAV 32,48,184
TR 2,7,34304
MAV 48,48,188
TR 4,7,33824
MAV 48,32,180
TR 6,7,34336
MAV 52,36,180
TR 16,7,42240
MAV 52,52,188
TR 18,7,42752
MAV 36,52,184
TR 20,7,42272
MAV 36,36,176
TR 22,7,42784
s_waitcnt lgkmcnt(8)
MAV 40,40,176
TR 8,7,33856
MAV 40,56,184
TR 10,7,34368
MAV 56,56,188
TR 12,7,33888
MAV 56,40,180
TR 14,7,34400
MAV 60,44,180
TR 24,7,42304
MAV 60,60,188
TR 26,7,42816
MAV 44,60,184
TR 28,7,42336
MAV 44,44,176
TR 30,7,42848
.Lpad32:
s_cbranch_execz .Lnopoll63r
s_waitcnt vmcnt(0)
v_cmp_ne_u32 vcc, 0, v15
s_nop 0
s_cbranch_vccz .Lxs68
.Lxs68b:
s_waitcnt lgkmcnt(8)
MAV 32,0,192
TR 32,7,50688
MAV 32,16,200
buffer_load_dwordx4 v[232:235], v11, s[16:19], s68 offen sc1
MAV 48,16,204
TR 34,7,51200
s_add_u32 s68, s68, 131072
MAV 48,0,196
TR 36,7,50720
TR 38,7,51232
MAV 52,4,196
TR 48,7,59136
MAV 52,20,204
buffer_load_dwordx4 v[236:239], v11, s[16:19], s68 offen sc1
MAV 36,20,200
TR 50,7,59648
s_add_u32 s68, s68, -130048
MAV 36,4,192
TR 52,7,59168
TR 54,7,59680
s_waitcnt lgkmcnt(8)
MAV 40,8,192
TR 40,7,50752
MAV 40,24,200
buffer_load_dwordx4 v[240:243], v11, s[16:19], s68 offen sc1
MAV 56,24,204
TR 42,7,51264
s_add_u32 s68, s68, 131072
MAV 56,8,196
TR 44,7,50784
TR 46,7,51296
MAV 60,12,196
TR 56,7,59200
MAV 60,28,204
buffer_load_dwordx4 v[244:247], v11, s[16:19], s68 offen sc1
MAV 44,28,200
TR 58,7,59712
MAV 44,12,192
TR 60,7,59232
TR 62,7,59744
s_waitcnt lgkmcnt(8)
MAV 32,32,208
MAV 32,48,216
MAV 48,48,220
MAV 48,32,212
MAV 52,36,212
MAV 52,52,220
MAV 36,52,216
MAV 36,36,208
s_waitcnt lgkmcnt(0)
MAV 40,40,208
MAV 40,56,216
MAV 56,56,220
MAV 56,40,212
MAV 60,44,212
MAV 60,60,220
MAV 44,60,216
MAV 44,44,208
s_waitcnt vmcnt(3)
v_mfma_f32_16x16x32_bf16 v[32:35], v[226:229], v[232:235], v[32:35]
v_mfma_f32_16x16x32_bf16 v[36:39], v[224:227], v[232:235], v[36:39]
s_waitcnt vmcnt(2)
v_mfma_f32_16x16x32_bf16 v[40:43], v[226:229], v[236:239], v[40:43]
v_mfma_f32_16x16x32_bf16 v[44:47], v[224:227], v[236:239], v[44:47]
s_waitcnt vmcnt(1)
v_mfma_f32_16x16x32_bf16 v[48:51], v[226:229], v[240:243], v[48:51]
v_mfma_f32_16x16x32_bf16 v[52:55], v[224:227], v[240:243], v[52:55]
s_waitcnt vmcnt(0)
v_mfma_f32_16x16x32_bf16 v[56:59], v[226:229], v[244:247], v[56:59]
v_cvt_pk_bf16_f32 v128, v32, v33
v_mfma_f32_16x16x32_bf16 v[60:63], v[224:227], v[244:247], v[60:63]
v_cvt_pk_bf16_f32 v129, v34, v35
ds_write_b64 v20, v[128:129]
v_cvt_pk_bf16_f32 v130, v36, v37
v_cvt_pk_bf16_f32 v131, v38, v39
ds_write_b64 v20, v[130:131] offset:32
v_cvt_pk_bf16_f32 v132, v40, v41
v_cvt_pk_bf16_f32 v133, v42, v43
ds_write_b64 v20, v[132:133] offset:64
v_cvt_pk_bf16_f32 v134, v44, v45
v_cvt_pk_bf16_f32 v135, v46, v47
ds_write_b64 v20, v[134:135] offset:96
ds_read_b128 v[144:147], v21
ds_read_b128 v[148:151], v21 offset:1152
v_cvt_pk_bf16_f32 v136, v48, v49
v_cvt_pk_bf16_f32 v137, v50, v51
ds_write_b64 v20, v[136:137] offset:2304
v_cvt_pk_bf16_f32 v138, v52, v53
v_cvt_pk_bf16_f32 v139, v54, v55
ds_write_b64 v20, v[138:139] offset:2336
v_cvt_pk_bf16_f32 v140, v56, v57
v_cvt_pk_bf16_f32 v141, v58, v59
ds_write_b64 v20, v[140:141] offset:2368
v_cvt_pk_bf16_f32 v142, v60, v61
v_cvt_pk_bf16_f32 v143, v62, v63
ds_write_b64 v20, v[142:143] offset:2400
ds_read_b128 v[152:155], v21 offset:2304
ds_read_b128 v[156:159], v21 offset:3456
s_waitcnt lgkmcnt(7)
buffer_store_dwordx4 v[144:147], v16, s[36:39], 0 offen sc1
s_waitcnt lgkmcnt(6)
buffer_store_dwordx4 v[148:151], v16, s[36:39], s64 offen sc1
s_waitcnt lgkmcnt(1)
buffer_store_dwordx4 v[152:155], v17, s[36:39], 0 offen sc1
s_waitcnt lgkmcnt(0)
buffer_store_dwordx4 v[156:159], v17, s[36:39], s64 offen sc1
s_nop 1
.Lend:
s_endpgm
.Lsp67:
s_mov_b32 s15, 0
.Lsp67l:
v_mov_b32 v25, 0
buffer_atomic_add v25, v22, s[16:19], s73 offen sc0
s_add_u32 s15, s15, 1
s_cmp_gt_u32 s15, 100000
s_waitcnt vmcnt(0)
s_cbranch_scc1 .Lsp67b
v_cmp_gt_u32 vcc, v23, v25
s_nop 0
s_cbranch_vccnz .Lsp67l
s_branch .Lsp67b
.Lxs68:
s_mov_b32 s15, 0
.Lxs68l:
v_mov_b32 v15, 0
buffer_atomic_add v15, v12, s[16:19], s70 offen sc0
s_add_u32 s15, s15, 1
s_cmp_gt_u32 s15, 100000
s_waitcnt vmcnt(0)
s_cbranch_scc1 .Lxs68b
v_cmp_ne_u32 vcc, 0, v15
s_nop 0
s_cbranch_vccz .Lxs68l
s_branch .Lxs68b
.section .rodata,"a"
.p2align 6
.amdhsa_kernel interleave_layers__sliding_local_dilated__swiglu_ffn__prompt_kernel
  .amdhsa_next_free_vgpr 512
  .amdhsa_next_free_sgpr 102
  .amdhsa_accum_offset 256
  .amdhsa_group_segment_fixed_size 0
  .amdhsa_kernarg_size 80
  .amdhsa_user_sgpr_count 2
  .amdhsa_user_sgpr_kernarg_segment_ptr 1
  .amdhsa_system_sgpr_workgroup_id_x 1
  .amdhsa_float_denorm_mode_32 3
.end_amdhsa_kernel
```

```asm
; @launch grid=(256,1,1) block=(256,1,1) lds=162560
.amdgcn_target "amdgcn-amd-amdhsa--gfx950"
.macro MAA d,a,b
v_mfma_f32_16x16x32_bf16 v[\d:\d+3], a[\a:\a+3], a[\b:\b+3], v[\d:\d+3]
.endm
.macro MAV d,a,b
v_mfma_f32_16x16x32_bf16 v[\d:\d+3], a[\a:\a+3], v[\b:\b+3], v[\d:\d+3]
.endm
.macro TR d,v,o
ds_read_b64_tr_b16 a[\d:\d+1], v\v offset:\o
.endm
.macro RD d,v,o
ds_read_b128 a[\d:\d+3], v\v offset:\o
.endm
.text
.globl interleave_layers__sliding_local_dilated__swiglu_ffn__prompt_kernel
.p2align 8
.type interleave_layers__sliding_local_dilated__swiglu_ffn__prompt_kernel,@function
interleave_layers__sliding_local_dilated__swiglu_ffn__prompt_kernel:
s_load_dwordx4 s[68:71], s[0:1], 0
s_load_dwordx2 s[72:73], s[0:1], 16
s_load_dwordx8 s[76:83], s[0:1], 32
s_load_dwordx4 s[84:87], s[0:1], 64
s_cmp_lt_u32 s2, 256
s_cbranch_scc1 .Lgo
s_endpgm
.p2align 12
.Lgo:
v_lshrrev_b32 v2, 6, v0
v_and_b32 v1, 63, v0
v_readfirstlane_b32 s3, v2
s_and_b32 s4, s2, 7
s_lshr_b32 s5, s2, 3
s_lshr_b32 s8, s4, 2
s_lshl_b32 s8, s8, 3
s_and_b32 s62, s5, 7
s_add_u32 s8, s8, s62
s_and_b32 s9, s4, 3
s_lshl_b32 s9, s9, 2
s_lshr_b32 s62, s5, 3
s_add_u32 s9, s9, s62
s_and_b32 s48, s3, 1
s_lshr_b32 s49, s3, 1
s_lshl_b32 s50, s8, 3
s_sub_u32 s50, s50, 9
s_cmp_lt_u32 s8, 2
s_cselect_b32 s50, 7, s50
v_bfe_u32 v18, v1, 3, 1
v_bfe_u32 v2, v1, 5, 1
v_lshl_add_u32 v18, v2, 2, v18
v_and_b32 v2, 16, v1
v_add_u32 v18, v18, v2
s_lshl_b32 s62, s49, 2
s_add_u32 s62, s62, s48
s_lshl_b32 s62, s62, 1
v_add_u32 v18, s62, v18
v_mul_u32_u24 v18, 6144, v18
v_and_b32 v2, 7, v1
v_lshl_add_u32 v18, v2, 4, v18
s_lshl_b32 s62, s9, 7
v_add_u32 v18, s62, v18
v_add_u32 v19, 1024, v18
v_add_u32 v20, 2048, v18
s_mul_i32 s59, s3, 3104
s_mov_b32 s58, 0
s_lshr_b32 s62, s8, 1
s_lshl_b32 s62, s62, 8
s_and_b32 s67, s8, 1
s_add_u32 s62, s62, s67
s_lshl_b32 s62, s62, 11
s_lshl_b32 s63, s3, 17
s_add_u32 s62, s62, s63
v_lshrrev_b32 v2, 4, v1
v_xor_b32 v2, v2, v1
v_and_b32 v2, 7, v2
v_lshlrev_b32 v2, 4, v2
v_lshrrev_b32 v21, 3, v1
v_lshl_add_u32 v21, v21, 12, v2
v_add_u32 v21, s62, v21
v_xor_b32 v28, 64, v21
v_add_u32 v28, 31744, v28
s_lshr_b32 s63, s50, 3
s_lshr_b32 s62, s63, 1
s_lshl_b32 s62, s62, 8
s_and_b32 s67, s63, 1
s_add_u32 s62, s62, s67
s_lshl_b32 s62, s62, 11
s_lshl_b32 s63, s3, 14
s_add_u32 s62, s62, s63
s_add_u32 s62, s62, 456704
s_lshl_b32 s63, s3, 5
v_and_b32 v2, 31, v1
v_lshlrev_b32 v2, 2, v2
v_xor_b32 v2, s63, v2
v_lshrrev_b32 v22, 5, v1
v_lshl_add_u32 v22, v22, 12, v2
v_add_u32 v22, s62, v22
v_xor_b32 v29, 16, v22
v_add_u32 v29, -57344, v29
s_mov_b32 s52, 0
s_mov_b32 s53, 65536
s_mul_i32 s55, s3, 4608
s_mov_b32 s54, 0
s_mul_i32 s56, s3, 3104
s_waitcnt lgkmcnt(0)
s_mov_b32 s36, s68
s_mov_b32 s37, s69
s_mov_b32 s38, 4194304
s_mov_b32 s39, 0x20000
s_mov_b32 s20, s70
s_mov_b32 s21, s71
s_mov_b32 s22, 6291456
s_mov_b32 s23, 0x20000
s_lshr_b32 s6, s4, 1
s_lshl_b32 s6, s6, 2
s_and_b32 s62, s5, 3
s_add_u32 s6, s6, s62
s_and_b32 s7, s4, 1
s_lshr_b32 s62, s5, 2
s_lshl_b32 s62, s62, 1
s_add_u32 s7, s7, s62
s_lshr_b32 s62, s6, 1
s_lshl_b32 s62, s62, 8
s_and_b32 s63, s6, 1
s_add_u32 s62, s62, s63
s_lshl_b32 s63, s3, 6
s_add_u32 s62, s62, s63
s_lshl_b32 s62, s62, 11
s_lshl_b32 s63, s7, 7
s_add_u32 s62, s62, s63
v_and_b32 v228, 15, v1
v_lshlrev_b32 v228, 12, v228
v_bfe_u32 v2, v1, 4, 1
v_lshl_add_u32 v228, v2, 5, v228
v_bfe_u32 v2, v1, 5, 1
v_lshl_add_u32 v228, v2, 4, v228
v_add_u32 v228, s62, v228
v_add_u32 v229, 0x10000, v228
s_sub_u32 s64, s3, 1
s_max_i32 s64, s64, 0
s_lshl_b32 s64, s64, 11
s_lshl_b32 s66, s9, 7
s_add_u32 s66, s66, s64
s_cmp_eq_u32 s3, 1
s_cselect_b32 s66, 8388608, s66
s_mul_i32 s65, s8, 122880
s_add_u32 s65, s65, s66
v_lshrrev_b32 v9, 1, v1
v_min_u32 v9, 19, v9
v_mul_u32_u24 v9, 6144, v9
s_mov_b32 s16, s86
s_mov_b32 s17, s87
s_mov_b32 s18, 268435456
s_mov_b32 s19, 0x20000
s_xor_b32 s14, s3, 3
s_lshl_b32 s14, s14, 8
s_add_u32 s14, s14, s2
v_lshlrev_b32 v230, 4, v1
v_mov_b64 v[224:225], 0
v_mov_b64 v[226:227], 0
s_cmp_ge_u32 s14, 16
s_cbranch_scc1 .Lz3
s_lshl_b32 s62, s2, 13
s_add_u32 s62, s62, 30408704
s_add_u32 s63, s62, 4096
buffer_store_dwordx4 v[224:227], v230, s[16:19], s62 offen sc1
buffer_store_dwordx4 v[224:227], v230, s[16:19], s62 offen offset:1024 sc1
buffer_store_dwordx4 v[224:227], v230, s[16:19], s62 offen offset:2048 sc1
buffer_store_dwordx4 v[224:227], v230, s[16:19], s62 offen offset:3072 sc1
buffer_store_dwordx4 v[224:227], v230, s[16:19], s63 offen sc1
buffer_store_dwordx4 v[224:227], v230, s[16:19], s63 offen offset:1024 sc1
buffer_store_dwordx4 v[224:227], v230, s[16:19], s63 offen offset:2048 sc1
buffer_store_dwordx4 v[224:227], v230, s[16:19], s63 offen offset:3072 sc1
.Lz3:
buffer_load_dwordx4 v[164:167], v228, s[36:39], 0 offen
buffer_load_dwordx4 v[168:171], v228, s[36:39], 0 offen offset:64
buffer_load_dwordx4 v[172:175], v229, s[36:39], 0 offen
buffer_load_dwordx4 v[176:179], v229, s[36:39], 0 offen offset:64
buffer_load_dword v58, v9, s[20:23], s65 offen
s_mov_b32 s40, s84
s_mov_b32 s41, s85
s_mov_b32 s42, 256
s_mov_b32 s43, 0x20000
s_getpc_b64 s[62:63]
.Lpc:
s_lshl_b32 s64, s5, 12
v_lshrrev_b32 v59, 3, v0
v_lshl_add_u32 v59, v59, 7, s64
v_add_u32 v2, 0x20000, v59
v_min_u32 v2, .Lend-.Lpc, v2
v_min_u32 v59, .Lend-.Lpc, v59
global_load_dword v59, v59, s[62:63]
global_load_dword v58, v2, s[62:63]
s_mov_b32 s24, s72
s_mov_b32 s25, s73
s_mov_b32 s26, 2097152
s_mov_b32 s27, 0x20000
s_mov_b32 s28, s80
s_mov_b32 s29, s81
s_mov_b32 s30, 7340032
s_mov_b32 s31, 0x20000
s_mov_b32 s0, s82
s_mov_b32 s1, s83
s_mov_b32 s32, s76
s_mov_b32 s33, s77
s_mov_b32 s34, 7340032
s_mov_b32 s35, 0x20000
s_mov_b32 s80, s78
s_mov_b32 s81, s79
s_mov_b32 s82, 7340032
s_mov_b32 s83, 0x20000
s_lshr_b32 s10, s4, 2
s_lshl_b32 s10, s10, 2
s_and_b32 s62, s5, 3
s_add_u32 s10, s10, s62
s_and_b32 s11, s4, 3
s_lshl_b32 s11, s11, 3
s_lshr_b32 s62, s5, 2
s_add_u32 s11, s11, s62
s_and_b32 s12, s11, 1
s_lshr_b32 s13, s11, 1
s_mul_i32 s51, s13, 448
s_mul_i32 s62, s12, 192
s_add_u32 s51, s51, s62
s_lshl_b32 s62, s6, 3
s_lshr_b32 s84, s62, 4
s_lshl_b32 s84, s84, 14
s_and_b32 s62, s62, 15
s_lshl_b32 s62, s62, 10
s_add_u32 s84, s84, s62
s_lshl_b32 s62, s8, 3
s_lshr_b32 s85, s62, 4
s_lshl_b32 s85, s85, 14
s_and_b32 s62, s62, 15
s_lshl_b32 s62, s62, 10
s_add_u32 s85, s85, s62
s_lshl_b32 s62, s50, 0
s_lshr_b32 s86, s62, 4
s_lshl_b32 s86, s86, 14
s_and_b32 s62, s62, 15
s_lshl_b32 s62, s62, 10
s_add_u32 s86, s86, s62
s_mul_i32 s62, s8, 393216
s_add_u32 s62, s62, s66
v_mul_u32_u24 v14, 6144, v1
v_add_u32 v14, s62, v14
s_lshl_b32 s62, s8, 4
s_add_u32 s62, s62, s9
s_lshl_b32 s62, s62, 2
s_add_u32 s62, s62, s3
s_mul_i32 s62, s62, 6656
v_min_u32 v15, 51, v1
v_lshl_add_u32 v15, v15, 7, s62
s_sub_u32 s63, s8, 4
s_lshl_b32 s64, s8, 1
s_add_u32 s64, s64, 1
s_cmp_lt_u32 s8, 5
s_cselect_b64 vcc, -1, 0
s_cselect_b32 s46, s64, s63
v_cndmask_b32 v14, v14, v15, vcc
s_lshl_b32 s62, s2, 1
s_add_u32 s62, s62, s48
s_mul_i32 s62, s62, 5376
v_min_u32 v16, 41, v1
v_lshl_add_u32 v16, v16, 7, s62
s_cmp_lt_u32 s46, 6
s_cselect_b64 vcc, -1, 0
v_cndmask_b32 v15, v14, v16, vcc
v_cndmask_b32 v14, v16, v14, vcc
s_cmp_lt_u32 s3, 2
s_cselect_b32 s65, s32, s80
s_cselect_b32 s66, s33, s81
s_cselect_b32 s67, s34, s82
s_cmp_lt_u32 s8, 5
s_cselect_b32 s62, s24, s20
s_cselect_b32 s63, s25, s21
s_cselect_b32 s64, s26, s22
s_sub_u32 s47, s46, 6
s_cmp_lt_u32 s46, 6
s_cselect_b32 s47, s46, s47
s_cselect_b32 s76, s62, s65
s_cselect_b32 s98, s65, s62
s_cselect_b32 s77, s63, s66
s_cselect_b32 s99, s66, s63
s_cselect_b32 s78, s64, s67
s_cselect_b32 s100, s67, s64
s_mov_b32 s79, 0x20000
v_bfe_u32 v24, v1, 1, 3
v_lshrrev_b32 v2, 4, v1
v_xor_b32 v2, v2, v24
v_lshlrev_b32 v2, 4, v2
v_and_b32 v23, 15, v1
v_lshl_add_u32 v23, v23, 7, v2
s_mul_i32 s62, s48, 9216
v_add_u32 v23, s62, v23
v_xor_b32 v30, 64, v23
v_mul_u32_u24 v24, 2304, v24
v_add_u32 v24, v24, v2
v_and_b32 v2, 1, v1
v_lshl_add_u32 v24, v2, 7, v24
v_add_u32 v24, 2048, v24
v_xor_b32 v31, 64, v24
v_and_b32 v2, 15, v1
v_cmp_eq_u32 vcc, 0, v2
v_mov_b32 v2, 18432
s_nop 0
v_cndmask_b32 v24, v24, v2, vcc
v_cndmask_b32 v31, v31, v2, vcc
v_bfe_u32 v25, v1, 3, 2
v_mul_u32_u24 v25, 3104, v25
v_bfe_u32 v2, v1, 2, 1
v_lshl_add_u32 v25, v2, 7, v25
v_bfe_u32 v2, v1, 5, 1
v_lshl_add_u32 v25, v2, 8, v25
v_and_b32 v2, 3, v1
v_lshl_add_u32 v25, v2, 3, v25
s_lshl_b32 s62, s49, 6
s_add_u32 s62, s62, 73984
v_add_u32 v25, s62, v25
s_lshl_b32 s62, s8, 1
s_add_u32 s62, s62, s3
s_lshr_b32 s63, s50, 2
s_cmp_lt_u32 s3, 2
s_cselect_b32 s62, s62, s63
s_lshl_b32 s62, s62, 13
s_cmp_eq_u32 s3, 3
s_cselect_b32 s62, 268435456, s62
v_lshl_add_u32 v26, v1, 4, s62
s_mul_i32 s59, s3, 2080
s_and_b32 s87, s6, 3
s_lshl_b32 s87, s87, 17
v_bfe_u32 v5, v1, 3, 1
v_lshrrev_b32 v2, 4, v1
v_lshl_add_u32 v5, v2, 3, v5
s_lshl_b32 s62, s3, 1
v_add_u32 v5, s62, v5
v_mul_u32_u24 v5, 2048, v5
v_and_b32 v2, 7, v1
v_lshl_add_u32 v5, v2, 4, v5
s_lshl_b32 s62, s7, 7
v_add_u32 v5, s62, v5
v_add_u32 v6, 64512, v5
s_lshl_b32 s62, s6, 10
s_add_u32 s62, s62, 30408704
s_lshl_b32 s64, s8, 10
s_add_u32 s64, s64, 30408704
s_lshr_b32 s67, s9, 1
s_and_b32 s67, s67, 3
s_lshl_b32 s67, s67, 7
s_add_u32 s64, s64, s67
s_lshr_b32 s65, s50, 3
s_lshl_b32 s65, s65, 10
s_add_u32 s65, s65, 30408704
s_lshr_b32 s67, s9, 1
s_and_b32 s67, s67, 3
s_lshl_b32 s67, s67, 7
s_add_u32 s65, s65, s67
v_mov_b32 v2, 268435456
v_cmp_eq_u32 vcc, 65, v0
v_mov_b32 v33, s65
s_nop 0
v_cndmask_b32 v33, v2, v33, vcc
v_cndmask_b32 v36, 0, 16, vcc
v_cmp_eq_u32 vcc, 64, v0
v_mov_b32 v32, s64
s_nop 0
v_cndmask_b32 v33, v33, v32, vcc
v_lshl_add_u32 v32, v1, 7, s62
v_cndmask_b32 v34, v2, 0, vcc
v_cndmask_b32 v35, 0, 16, vcc
v_cndmask_b32 v36, v36, 16, vcc
v_lshrrev_b32 v37, 3, v0
v_cmp_eq_u32 vcc, 8, v37
s_nop 1
v_cndmask_b32 v32, v2, v32, vcc
v_mov_b32 v38, 1
v_lshrrev_b32 v2, 4, v1
v_lshlrev_b32 v2, 2, v2
v_and_b32 v13, 15, v1
v_sub_u32 v2, v13, v2
v_mov_b32 v13, 0xff61b1e6
v_subrev_u32 v54, 0, v2
v_cmp_gt_u32 vcc, 8, v54
s_nop 1
v_cndmask_b32 v50, v13, 0, vcc
v_cmp_gt_i32 vcc, -8, v54
s_nop 1
v_cndmask_b32 v46, v13, 0, vcc
v_subrev_u32 v54, 1, v2
v_cmp_gt_u32 vcc, 8, v54
s_nop 1
v_cndmask_b32 v51, v13, 0, vcc
v_cmp_gt_i32 vcc, -8, v54
s_nop 1
v_cndmask_b32 v47, v13, 0, vcc
v_subrev_u32 v54, 2, v2
v_cmp_gt_u32 vcc, 8, v54
s_nop 1
v_cndmask_b32 v52, v13, 0, vcc
v_cmp_gt_i32 vcc, -8, v54
s_nop 1
v_cndmask_b32 v48, v13, 0, vcc
v_subrev_u32 v54, 3, v2
v_cmp_gt_u32 vcc, 8, v54
s_nop 1
v_cndmask_b32 v53, v13, 0, vcc
v_cmp_gt_i32 vcc, -8, v54
s_nop 1
v_cndmask_b32 v49, v13, 0, vcc
s_cmp_lt_u32 s8, 2
s_cselect_b64 vcc, -1, 0
v_cndmask_b32 v54, v46, v13, vcc
v_cndmask_b32 v55, v47, v13, vcc
v_cndmask_b32 v56, v48, v13, vcc
v_cndmask_b32 v57, v49, v13, vcc
s_mov_b32 s75, 29360128
v_and_b32 v10, 15, v1
v_lshlrev_b32 v12, 2, v10
v_lshlrev_b32 v10, 4, v10
v_add_u32 v10, 152576, v10
v_lshrrev_b32 v11, 4, v1
v_lshlrev_b32 v11, 4, v11
s_lshl_b32 s62, s49, 7
s_add_u32 s62, s62, 158720
v_add_u32 v12, s62, v12
v_add_u32 v13, s62, v11
v_add_u32 v11, 156672, v11
s_lshl_b32 s62, s3, 11
s_add_u32 s62, s62, 143360
v_lshl_add_u32 v8, v1, 4, s62
v_xor_b32 v9, 2048, v8
v_mov_b32 v248, 0x3f803f80
v_mov_b32 v249, 0x3f803f80
v_mov_b32 v250, 0x3f803f80
v_mov_b32 v251, 0x3f803f80
s_mul_i32 s62, s3, 18496
s_add_u32 s62, s62, 18432
v_mov_b32 v2, s62
ds_write_b128 v2, v[248:251]
v_and_b32 v7, 31, v1
v_lshrrev_b32 v2, 5, v1
v_lshl_add_u32 v7, v7, 1, v2
v_and_b32 v2, 0xc0, v0
v_add_u32 v7, v7, v2
v_lshlrev_b32 v17, 2, v7
v_add_u32 v17, 156672, v17
v_lshlrev_b32 v7, 4, v7
v_add_u32 v7, 152576, v7
s_lshl_b32 s74, s9, 1
s_add_u32 s74, s74, s49
s_lshl_b32 s74, s74, 17
s_add_u32 s74, s74, s85
s_lshl_b32 s63, s48, 12
s_add_u32 s74, s74, s63
s_add_u32 s74, s74, 4194304
s_mov_b32 s62, 0
v_lshl_add_u32 v4, v1, 4, s62
v_lshrrev_b32 v2, 3, v1
v_cmp_eq_u32 vcc, 3, v2
v_add_u32 v2, 67108480, v4
s_nop 0
v_cndmask_b32 v4, v4, v2, vcc
s_add_u32 m0, s55, 0
s_nop 0
buffer_load_dwordx4 v21, s[36:39], s52 offen lds
buffer_load_dwordx4 v28, s[36:39], s52 offen offset:1024 lds
buffer_load_dword v22, s[36:39], s52 offen offset:2048 lds
s_add_u32 s52, s52, 128
s_add_u32 m0, s55, 2304
s_nop 0
buffer_load_dwordx4 v21, s[36:39], s53 offen lds
buffer_load_dwordx4 v28, s[36:39], s53 offen offset:1024 lds
buffer_load_dword v29, s[36:39], s53 offen offset:2048 lds
s_add_u32 s53, s53, 128
s_add_u32 m0, s56, 123648
s_nop 0
buffer_load_dwordx4 v18, s[20:23], s54 offen lds
buffer_load_dwordx4 v19, s[20:23], s54 offen offset:1024 lds
buffer_load_dwordx4 v20, s[20:23], s54 offen offset:2048 lds
s_add_u32 s54, s54, 196608
s_add_u32 m0, s56, 136064
s_nop 0
buffer_load_dwordx4 v18, s[20:23], s54 offen lds
buffer_load_dwordx4 v19, s[20:23], s54 offen offset:1024 lds
buffer_load_dwordx4 v20, s[20:23], s54 offen offset:2048 lds
s_add_u32 s54, s54, 196608
s_cmp_eq_u32 s48, 1
s_cbranch_scc1 .Lqkv1
s_cmp_lt_u32 s14, 16
s_cselect_b32 s62, 0, 4096
v_mov_b32 v231, 1
v_lshlrev_b32 v232, 8, v1
s_waitcnt vmcnt(18)
v_permlane16_swap_b32 v164, v166
v_permlane16_swap_b32 v165, v167
s_waitcnt vmcnt(17)
v_permlane16_swap_b32 v168, v170
v_permlane16_swap_b32 v169, v171
s_waitcnt vmcnt(16)
v_permlane16_swap_b32 v172, v174
v_permlane16_swap_b32 v173, v175
s_waitcnt vmcnt(15)
v_permlane16_swap_b32 v176, v178
v_permlane16_swap_b32 v177, v179
buffer_atomic_add v231, v232, s[40:43], s62 offen
v_lshlrev_b32 v192, 16, v164
v_and_b32 v193, 0xffff0000, v164
v_lshlrev_b32 v194, 16, v165
v_and_b32 v195, 0xffff0000, v165
v_lshlrev_b32 v196, 16, v166
v_and_b32 v197, 0xffff0000, v166
v_lshlrev_b32 v198, 16, v167
v_and_b32 v199, 0xffff0000, v167
v_lshlrev_b32 v200, 16, v168
v_and_b32 v201, 0xffff0000, v168
v_lshlrev_b32 v202, 16, v169
v_and_b32 v203, 0xffff0000, v169
v_lshlrev_b32 v204, 16, v170
v_and_b32 v205, 0xffff0000, v170
v_lshlrev_b32 v206, 16, v171
v_and_b32 v207, 0xffff0000, v171
v_lshlrev_b32 v208, 16, v172
v_and_b32 v209, 0xffff0000, v172
v_lshlrev_b32 v210, 16, v173
v_and_b32 v211, 0xffff0000, v173
v_lshlrev_b32 v212, 16, v174
v_and_b32 v213, 0xffff0000, v174
v_lshlrev_b32 v214, 16, v175
v_and_b32 v215, 0xffff0000, v175
v_lshlrev_b32 v216, 16, v176
v_and_b32 v217, 0xffff0000, v176
v_lshlrev_b32 v218, 16, v177
v_and_b32 v219, 0xffff0000, v177
v_lshlrev_b32 v220, 16, v178
v_and_b32 v221, 0xffff0000, v178
v_lshlrev_b32 v222, 16, v179
v_and_b32 v223, 0xffff0000, v179
s_lshl_b32 s64, s6, 14
s_lshl_b32 s65, s49, 13
s_add_u32 s64, s64, s65
s_lshl_b32 s65, s7, 9
s_add_u32 s64, s64, s65
s_lshl_b32 s65, s48, 8
s_add_u32 s64, s64, s65
s_add_u32 s64, s64, 29360128
v_and_b32 v188, 31, v1
v_lshlrev_b32 v188, 3, v188
v_lshrrev_b32 v189, 5, v1
v_lshl_add_u32 v188, v189, 28, v188
s_lshl_b32 s62, s7, 18
s_add_u32 s62, s62, 0
s_add_u32 s63, s62, 131072
v_pk_mul_f32 v[182:183], v[192:193], v[192:193]
v_pk_mul_f32 v[186:187], v[208:209], v[208:209]
v_pk_fma_f32 v[182:183], v[194:195], v[194:195], v[182:183]
v_pk_add_f32 v[180:181], v[192:193], v[194:195]
v_pk_fma_f32 v[186:187], v[210:211], v[210:211], v[186:187]
v_pk_add_f32 v[184:185], v[208:209], v[210:211]
v_pk_fma_f32 v[182:183], v[196:197], v[196:197], v[182:183]
v_pk_add_f32 v[180:181], v[180:181], v[196:197]
v_pk_fma_f32 v[186:187], v[212:213], v[212:213], v[186:187]
v_pk_add_f32 v[184:185], v[184:185], v[212:213]
v_pk_fma_f32 v[182:183], v[198:199], v[198:199], v[182:183]
v_pk_add_f32 v[180:181], v[180:181], v[198:199]
v_pk_fma_f32 v[186:187], v[214:215], v[214:215], v[186:187]
v_pk_add_f32 v[184:185], v[184:185], v[214:215]
v_pk_fma_f32 v[182:183], v[200:201], v[200:201], v[182:183]
v_pk_add_f32 v[180:181], v[180:181], v[200:201]
v_pk_fma_f32 v[186:187], v[216:217], v[216:217], v[186:187]
v_pk_add_f32 v[184:185], v[184:185], v[216:217]
v_pk_fma_f32 v[182:183], v[202:203], v[202:203], v[182:183]
v_pk_add_f32 v[180:181], v[180:181], v[202:203]
v_pk_fma_f32 v[186:187], v[218:219], v[218:219], v[186:187]
v_pk_add_f32 v[184:185], v[184:185], v[218:219]
v_pk_fma_f32 v[182:183], v[204:205], v[204:205], v[182:183]
v_pk_add_f32 v[180:181], v[180:181], v[204:205]
v_pk_fma_f32 v[186:187], v[220:221], v[220:221], v[186:187]
v_pk_add_f32 v[184:185], v[184:185], v[220:221]
v_pk_fma_f32 v[182:183], v[206:207], v[206:207], v[182:183]
v_pk_add_f32 v[180:181], v[180:181], v[206:207]
v_pk_fma_f32 v[186:187], v[222:223], v[222:223], v[186:187]
v_pk_add_f32 v[184:185], v[184:185], v[222:223]
v_add_f32 v180, v180, v181
v_add_f32 v182, v182, v183
v_add_f32 v184, v184, v185
v_add_f32 v186, v186, v187
s_nop 0
v_permlane16_swap_b32 v180, v184
v_permlane16_swap_b32 v182, v186
v_add_f32 v180, v180, v184
v_add_f32 v182, v182, v186
s_nop 1
v_permlane32_swap_b32 v180, v182
v_add_f32 v180, v180, v182
s_nop 1
v_permlane32_swap_b32 v180, v181
buffer_store_dwordx2 v[180:181], v188, s[16:19], s64 offen sc1
s_lshl_b32 s62, s2, 10
s_add_u32 s62, s62, 31457280
s_cmp_eq_u32 s3, 0
s_cselect_b32 s62, s62, 268435456
buffer_store_dwordx4 v[224:227], v230, s[16:19], s62 offen sc1
v_accvgpr_write_b32 a224, v192
v_accvgpr_write_b32 a225, v193
v_accvgpr_write_b32 a226, v194
v_accvgpr_write_b32 a227, v195
v_accvgpr_write_b32 a228, v196
v_accvgpr_write_b32 a229, v197
v_accvgpr_write_b32 a230, v198
v_accvgpr_write_b32 a231, v199
v_accvgpr_write_b32 a232, v200
v_accvgpr_write_b32 a233, v201
v_accvgpr_write_b32 a234, v202
v_accvgpr_write_b32 a235, v203
v_accvgpr_write_b32 a236, v204
v_accvgpr_write_b32 a237, v205
v_accvgpr_write_b32 a238, v206
v_accvgpr_write_b32 a239, v207
v_accvgpr_write_b32 a240, v208
v_accvgpr_write_b32 a241, v209
v_accvgpr_write_b32 a242, v210
v_accvgpr_write_b32 a243, v211
v_accvgpr_write_b32 a244, v212
v_accvgpr_write_b32 a245, v213
v_accvgpr_write_b32 a246, v214
v_accvgpr_write_b32 a247, v215
v_accvgpr_write_b32 a248, v216
v_accvgpr_write_b32 a249, v217
v_accvgpr_write_b32 a250, v218
v_accvgpr_write_b32 a251, v219
v_accvgpr_write_b32 a252, v220
v_accvgpr_write_b32 a253, v221
v_accvgpr_write_b32 a254, v222
v_accvgpr_write_b32 a255, v223
s_add_u32 m0, s55, 18496
s_nop 0
buffer_load_dwordx4 v21, s[36:39], s52 offen lds
buffer_load_dwordx4 v28, s[36:39], s52 offen offset:1024 lds
buffer_load_dword v22, s[36:39], s52 offen offset:2048 lds
s_add_u32 s52, s52, 128
s_add_u32 m0, s55, 20800
s_nop 0
buffer_load_dwordx4 v21, s[36:39], s53 offen lds
buffer_load_dwordx4 v28, s[36:39], s53 offen offset:1024 lds
buffer_load_dword v29, s[36:39], s53 offen offset:2048 lds
s_add_u32 s53, s53, 128
s_add_u32 m0, s56, 73984
s_nop 0
buffer_load_dwordx4 v18, s[20:23], s54 offen lds
buffer_load_dwordx4 v19, s[20:23], s54 offen offset:1024 lds
buffer_load_dwordx4 v20, s[20:23], s54 offen offset:2048 lds
s_add_u32 s54, s54, 196608
s_waitcnt vmcnt(12) lgkmcnt(0)
s_barrier
ds_read_b128 a[0:3], v23
RD 4,23,2304
RD 8,23,4608
RD 12,23,6912
ds_read_b128 a[16:19], v24
ds_read_b128 a[20:23], v30
RD 24,30,2304
RD 28,30,4608
RD 32,30,6912
ds_read_b128 a[36:39], v31
TR 80,25,49664
TR 82,25,50176
TR 84,25,62080
TR 86,25,62592
TR 88,25,50688
TR 90,25,51200
TR 92,25,63104
TR 94,25,63616
TR 96,25,51712
TR 98,25,52224
TR 100,25,64128
TR 102,25,64640
s_waitcnt vmcnt(3) lgkmcnt(0)
s_barrier
v_mfma_f32_16x16x32_bf16 v[60:63], a[80:83], a[0:3], 0
TR 104,25,49696
s_add_u32 m0, s56, 86400
MAA 60,84,20
buffer_load_dwordx4 v18, s[20:23], s54 offen lds
v_mfma_f32_16x16x32_bf16 v[64:67], a[80:83], a[4:7], 0
s_sub_u32 s47, s47, 1
s_cbranch_scc1 .Lx4
.Lx4b:
MAA 64,84,24
buffer_load_dwordx4 v19, s[20:23], s54 offen offset:1024 lds
v_mfma_f32_16x16x32_bf16 v[68:71], a[80:83], a[8:11], 0
TR 106,25,50208
MAA 68,84,28
TR 108,25,62112
TR 110,25,62624
v_mfma_f32_16x16x32_bf16 v[72:75], a[80:83], a[12:15], 0
TR 112,25,50720
MAA 72,84,32
TR 114,25,51232
v_mfma_f32_16x16x32_bf16 v[244:247], a[80:83], a[16:19], 0
TR 116,25,63136
MAA 244,84,36
buffer_load_dwordx4 v20, s[20:23], s54 offen offset:2048 lds
v_mfma_f32_16x16x32_bf16 v[156:159], a[88:91], a[16:19], 0
s_add_u32 s54, s54, 196608
s_add_u32 m0, s55, 36992
MAA 156,92,36
buffer_load_dwordx4 v21, s[36:39], s52 offen lds
v_mfma_f32_16x16x32_bf16 v[104:107], a[88:91], a[12:15], 0
TR 118,25,63648
MAA 104,92,32
buffer_load_dwordx4 v28, s[36:39], s52 offen offset:1024 lds
v_mfma_f32_16x16x32_bf16 v[100:103], a[88:91], a[8:11], 0
TR 120,25,51744
MAA 100,92,28
buffer_load_dword v22, s[36:39], s52 offen offset:2048 lds
v_mfma_f32_16x16x32_bf16 v[96:99], a[88:91], a[4:7], 0
s_add_u32 s52, s52, 128
MAA 96,92,24
TR 122,25,52256
TR 124,25,64160
v_mfma_f32_16x16x32_bf16 v[92:95], a[88:91], a[0:3], 0
TR 126,25,64672
s_add_u32 m0, s55, 39296
MAA 92,92,20
buffer_load_dwordx4 v21, s[36:39], s53 offen lds
v_mfma_f32_16x16x32_bf16 v[124:127], a[0:3], a[96:99], 0
RD 40,23,18496
MAA 124,20,100
buffer_load_dwordx4 v28, s[36:39], s53 offen offset:1024 lds
v_mfma_f32_16x16x32_bf16 v[128:131], a[4:7], a[96:99], 0
RD 44,23,20800
MAA 128,24,100
RD 48,23,23104
RD 52,23,25408
v_mfma_f32_16x16x32_bf16 v[132:135], a[8:11], a[96:99], 0
RD 56,24,18496
MAA 132,28,100
buffer_load_dword v29, s[36:39], s53 offen offset:2048 lds
v_mfma_f32_16x16x32_bf16 v[136:139], a[12:15], a[96:99], 0
s_add_u32 s53, s53, 128
MAA 136,32,100
s_waitcnt vmcnt(6) lgkmcnt(5)
s_barrier
v_mfma_f32_16x16x32_bf16 v[76:79], a[104:107], a[0:3], 0
RD 60,30,18496
s_add_u32 m0, s56, 98816
MAA 76,108,20
buffer_load_dwordx4 v18, s[20:23], s54 offen lds
v_mfma_f32_16x16x32_bf16 v[80:83], a[104:107], a[4:7], 0
RD 64,30,20800
MAA 80,108,24
buffer_load_dwordx4 v19, s[20:23], s54 offen offset:1024 lds
v_mfma_f32_16x16x32_bf16 v[84:87], a[104:107], a[8:11], 0
RD 68,30,23104
MAA 84,108,28
RD 72,30,25408
RD 76,31,18496
v_mfma_f32_16x16x32_bf16 v[88:91], a[104:107], a[12:15], 0
ds_read_b64_tr_b16 a[80:81], v25
MAA 88,108,32
buffer_load_dwordx4 v20, s[20:23], s54 offen offset:2048 lds
v_mfma_f32_16x16x32_bf16 v[160:163], a[112:115], a[16:19], 0
s_add_u32 s54, s54, 196608
s_add_u32 m0, s56, 111232
MAA 160,116,36
buffer_load_dwordx4 v18, s[20:23], s54 offen lds
v_mfma_f32_16x16x32_bf16 v[120:123], a[112:115], a[12:15], 0
TR 82,25,512
MAA 120,116,32
buffer_load_dwordx4 v19, s[20:23], s54 offen offset:1024 lds
v_mfma_f32_16x16x32_bf16 v[116:119], a[112:115], a[8:11], 0
TR 84,25,12416
MAA 116,116,28
TR 86,25,12928
TR 88,25,1024
v_mfma_f32_16x16x32_bf16 v[112:115], a[112:115], a[4:7], 0
TR 90,25,1536
MAA 112,116,24
buffer_load_dwordx4 v20, s[20:23], s54 offen offset:2048 lds
v_mfma_f32_16x16x32_bf16 v[108:111], a[112:115], a[0:3], 0
s_add_u32 s54, s54, 196608
s_add_u32 m0, s55, 55488
MAA 108,116,20
buffer_load_dwordx4 v21, s[36:39], s52 offen lds
v_mfma_f32_16x16x32_bf16 v[140:143], a[0:3], a[120:123], 0
TR 92,25,13440
MAA 140,20,124
buffer_load_dwordx4 v28, s[36:39], s52 offen offset:1024 lds
v_mfma_f32_16x16x32_bf16 v[144:147], a[4:7], a[120:123], 0
TR 94,25,13952
MAA 144,24,124
TR 96,25,2048
TR 98,25,2560
v_mfma_f32_16x16x32_bf16 v[148:151], a[8:11], a[120:123], 0
TR 100,25,14464
MAA 148,28,124
buffer_load_dword v22, s[36:39], s52 offen offset:2048 lds
v_mfma_f32_16x16x32_bf16 v[152:155], a[12:15], a[120:123], 0
TR 102,25,14976
s_add_u32 s52, s52, 128
MAA 152,32,124
s_waitcnt vmcnt(9) lgkmcnt(8)
s_barrier
MAA 60,80,40
TR 104,25,32
s_add_u32 m0, s55, 57792
MAA 60,84,60
buffer_load_dwordx4 v21, s[36:39], s53 offen lds
MAA 64,84,64
s_sub_u32 s47, s47, 1
s_cbranch_scc1 .Lx5
.Lx5b:
MAA 64,80,44
buffer_load_dwordx4 v28, s[36:39], s53 offen offset:1024 lds
MAA 68,80,48
TR 106,25,544
MAA 68,84,68
TR 108,25,12448
TR 110,25,12960
MAA 72,84,72
TR 112,25,1056
MAA 72,80,52
TR 114,25,1568
s_waitcnt lgkmcnt(6)
MAA 244,80,56
TR 116,25,13472
MAA 244,84,76
buffer_load_dword v29, s[36:39], s53 offen offset:2048 lds
MAA 156,92,76
s_add_u32 s53, s53, 128
s_add_u32 m0, s56, 123648
MAA 156,88,56
buffer_load_dwordx4 v18, s[20:23], s54 offen lds
MAA 104,88,52
TR 118,25,13984
MAA 104,92,72
buffer_load_dwordx4 v19, s[20:23], s54 offen offset:1024 lds
MAA 100,92,68
TR 120,25,2080
MAA 100,88,48
buffer_load_dwordx4 v20, s[20:23], s54 offen offset:2048 lds
MAA 96,88,44
s_add_u32 s54, s54, 196608
MAA 96,92,64
TR 122,25,2592
TR 124,25,14496
MAA 92,92,60
TR 126,25,15008
s_add_u32 m0, s56, 136064
MAA 92,88,40
buffer_load_dwordx4 v18, s[20:23], s54 offen lds
MAA 124,40,96
RD 0,23,36992
MAA 124,60,100
buffer_load_dwordx4 v19, s[20:23], s54 offen offset:1024 lds
MAA 128,64,100
RD 4,23,39296
MAA 128,44,96
RD 8,23,41600
RD 12,23,43904
MAA 132,48,96
RD 16,24,36992
MAA 132,68,100
buffer_load_dwordx4 v20, s[20:23], s54 offen offset:2048 lds
MAA 136,72,100
s_add_u32 s54, s54, 196608
MAA 136,52,96
s_waitcnt vmcnt(12) lgkmcnt(5)
s_barrier
MAA 76,104,40
RD 20,30,36992
s_add_u32 m0, s55, 0
MAA 76,108,60
buffer_load_dwordx4 v21, s[36:39], s52 offen lds
MAA 80,108,64
RD 24,30,39296
MAA 80,104,44
buffer_load_dwordx4 v28, s[36:39], s52 offen offset:1024 lds
MAA 84,104,48
RD 28,30,41600
MAA 84,108,68
buffer_load_dword v22, s[36:39], s52 offen offset:2048 lds
MAA 88,108,72
RD 32,30,43904
s_add_u32 s52, s52, 128
MAA 88,104,52
RD 36,31,36992
TR 80,25,24832
TR 82,25,25344
MAA 160,112,56
TR 84,25,37248
s_add_u32 m0, s55, 2304
MAA 160,116,76
buffer_load_dwordx4 v21, s[36:39], s53 offen lds
MAA 120,116,72
TR 86,25,37760
MAA 120,112,52
buffer_load_dwordx4 v28, s[36:39], s53 offen offset:1024 lds
MAA 116,112,48
TR 88,25,25856
MAA 116,116,68
buffer_load_dword v29, s[36:39], s53 offen offset:2048 lds
MAA 112,116,64
s_add_u32 s53, s53, 128
s_add_u32 m0, s56, 73984
MAA 112,112,44
buffer_load_dwordx4 v18, s[20:23], s54 offen lds
MAA 108,112,40
TR 90,25,26368
MAA 108,116,60
buffer_load_dwordx4 v19, s[20:23], s54 offen offset:1024 lds
MAA 140,60,124
TR 92,25,38272
MAA 140,40,120
TR 94,25,38784
TR 96,25,26880
TR 98,25,27392
MAA 144,44,120
TR 100,25,39296
MAA 144,64,124
buffer_load_dwordx4 v20, s[20:23], s54 offen offset:2048 lds
MAA 148,68,124
TR 102,25,39808
s_add_u32 s54, s54, 196608
MAA 148,48,120
buffer_load_dword v37, v34, s[40:43], 0 offen sc1
MAA 152,52,120
MAA 152,72,124
s_waitcnt vmcnt(16) lgkmcnt(8)
s_barrier
MAA 60,80,0
TR 104,25,24864
s_add_u32 m0, s56, 86400
MAA 60,84,20
buffer_load_dwordx4 v18, s[20:23], s54 offen lds
MAA 64,84,24
s_sub_u32 s47, s47, 1
s_cbranch_scc1 .Lx6
.Lx6b:
MAA 64,80,4
buffer_load_dwordx4 v19, s[20:23], s54 offen offset:1024 lds
MAA 68,80,8
TR 106,25,25376
MAA 68,84,28
TR 108,25,37280
TR 110,25,37792
MAA 72,84,32
TR 112,25,25888
MAA 72,80,12
TR 114,25,26400
s_waitcnt lgkmcnt(6)
MAA 244,80,16
TR 116,25,38304
MAA 244,84,36
buffer_load_dwordx4 v20, s[20:23], s54 offen offset:2048 lds
MAA 156,92,36
s_add_u32 s54, s54, 196608
s_add_u32 m0, s55, 18496
MAA 156,88,16
buffer_load_dwordx4 v21, s[36:39], s52 offen lds
MAA 104,88,12
TR 118,25,38816
MAA 104,92,32
buffer_load_dwordx4 v28, s[36:39], s52 offen offset:1024 lds
MAA 100,92,28
TR 120,25,26912
MAA 100,88,8
buffer_load_dword v22, s[36:39], s52 offen offset:2048 lds
MAA 96,88,4
s_add_u32 s52, s52, 128
MAA 96,92,24
TR 122,25,27424
TR 124,25,39328
MAA 92,92,20
TR 126,25,39840
s_add_u32 m0, s55, 20800
MAA 92,88,0
buffer_load_dwordx4 v21, s[36:39], s53 offen lds
MAA 124,0,96
RD 40,23,55488
MAA 124,20,100
buffer_load_dwordx4 v28, s[36:39], s53 offen offset:1024 lds
MAA 128,24,100
RD 44,23,57792
MAA 128,4,96
RD 48,23,60096
RD 52,23,62400
MAA 132,8,96
RD 56,24,55488
MAA 132,28,100
buffer_load_dword v29, s[36:39], s53 offen offset:2048 lds
MAA 136,32,100
s_add_u32 s53, s53, 128
MAA 136,12,96
s_waitcnt vmcnt(19) lgkmcnt(5)
s_barrier
MAA 76,104,0
RD 60,30,55488
s_add_u32 m0, s56, 98816
MAA 76,108,20
buffer_load_dwordx4 v18, s[20:23], s54 offen lds
MAA 80,108,24
RD 64,30,57792
MAA 80,104,4
buffer_load_dwordx4 v19, s[20:23], s54 offen offset:1024 lds
MAA 84,104,8
RD 68,30,60096
MAA 84,108,28
RD 72,30,62400
RD 76,31,55488
MAA 88,108,32
TR 80,25,49664
MAA 88,104,12
buffer_load_dwordx4 v20, s[20:23], s54 offen offset:2048 lds
MAA 160,112,16
s_add_u32 s54, s54, 196608
s_add_u32 m0, s55, 36992
MAA 160,116,36
buffer_load_dwordx4 v21, s[36:39], s52 offen lds
MAA 120,116,32
TR 82,25,50176
MAA 120,112,12
buffer_load_dwordx4 v28, s[36:39], s52 offen offset:1024 lds
MAA 116,112,8
TR 84,25,62080
MAA 116,116,28
TR 86,25,62592
TR 88,25,50688
MAA 112,116,24
TR 90,25,51200
MAA 112,112,4
buffer_load_dword v22, s[36:39], s52 offen offset:2048 lds
MAA 108,112,0
s_add_u32 s52, s52, 128
s_add_u32 m0, s55, 39296
MAA 108,116,20
buffer_load_dwordx4 v21, s[36:39], s53 offen lds
MAA 140,20,124
TR 92,25,63104
MAA 140,0,120
buffer_load_dwordx4 v28, s[36:39], s53 offen offset:1024 lds
MAA 144,4,120
TR 94,25,63616
MAA 144,24,124
TR 96,25,51712
TR 98,25,52224
MAA 148,28,124
TR 100,25,64128
MAA 148,8,120
buffer_load_dword v29, s[36:39], s53 offen offset:2048 lds
MAA 152,12,120
TR 102,25,64640
s_add_u32 s53, s53, 128
MAA 152,32,124
s_waitcnt vmcnt(22) lgkmcnt(8)
s_barrier
MAA 60,80,40
TR 104,25,49696
s_add_u32 m0, s56, 111232
MAA 60,84,60
buffer_load_dwordx4 v18, s[20:23], s54 offen lds
MAA 64,84,64
s_sub_u32 s47, s47, 1
s_cbranch_scc1 .Lx7
.Lx7b:
MAA 64,80,44
TR 106,25,50208
MAA 68,80,48
TR 108,25,62112
MAA 68,84,68
buffer_load_dwordx4 v19, s[20:23], s54 offen offset:1024 lds
MAA 72,84,72
TR 110,25,62624
MAA 72,80,52
TR 112,25,50720
s_waitcnt lgkmcnt(5)
MAA 244,80,56
TR 114,25,51232
MAA 244,84,76
buffer_load_dwordx4 v20, s[20:23], s54 offen offset:2048 lds
MAA 156,92,76
s_add_u32 s54, s54, 196608
MAA 156,88,56
TR 116,25,63136
MAA 104,88,52
TR 118,25,63648
MAA 104,92,72
TR 120,25,51744
MAA 100,92,68
TR 122,25,52256
s_add_u32 m0, s55, 55488
MAA 100,88,48
buffer_load_dwordx4 v21, s[36:39], s52 offen lds
MAA 96,88,44
TR 124,25,64160
MAA 96,92,64
TR 126,25,64672
MAA 92,92,60
MAA 92,88,40
buffer_load_dwordx4 v28, s[36:39], s52 offen offset:1024 lds
MAA 124,40,96
ds_read_b128 a[0:3], v23
MAA 124,60,100
RD 4,23,2304
MAA 128,64,100
RD 8,23,4608
MAA 128,44,96
buffer_load_dword v22, s[36:39], s52 offen offset:2048 lds
MAA 132,48,96
RD 12,23,6912
s_add_u32 s52, s52, 128
MAA 132,68,100
ds_read_b128 a[16:19], v24
MAA 136,72,100
MAA 136,52,96
s_waitcnt vmcnt(21) lgkmcnt(5)
s_barrier
v_cmp_gt_u32 vcc, v35, v37
s_nop 0
s_cbranch_vccnz .Lsp8
.Lsp8b:
v_mov_b32 v37, 0
MAA 76,104,40
ds_read_b128 a[20:23], v30
MAA 76,108,60
buffer_atomic_add v38, v32, s[16:19], 0 offen
MAA 80,108,64
RD 24,30,2304
MAA 80,104,44
RD 28,30,4608
MAA 84,104,48
RD 32,30,6912
s_add_u32 m0, s56, 123648
MAA 84,108,68
buffer_load_dwordx4 v18, s[20:23], s54 offen lds
MAA 88,108,72
ds_read_b128 a[36:39], v31
MAA 88,104,52
buffer_load_dwordx4 v19, s[20:23], s54 offen offset:1024 lds
MAA 160,112,56
ds_read_b64_tr_b16 a[80:81], v25
MAA 160,116,76
TR 82,25,512
MAA 120,116,72
TR 84,25,12416
MAA 120,112,52
buffer_load_dwordx4 v20, s[20:23], s54 offen offset:2048 lds
MAA 116,112,48
TR 86,25,12928
s_add_u32 s54, s54, 196608
MAA 116,116,68
TR 88,25,1024
MAA 112,116,64
TR 90,25,1536
s_add_u32 m0, s55, 57792
MAA 112,112,44
buffer_load_dwordx4 v21, s[36:39], s53 offen lds
MAA 108,112,40
TR 92,25,13440
MAA 108,116,60
TR 94,25,13952
MAA 140,60,124
TR 96,25,2048
MAA 140,40,120
buffer_load_dwordx4 v28, s[36:39], s53 offen offset:1024 lds
MAA 144,44,120
TR 98,25,2560
MAA 144,64,124
buffer_load_dword v29, s[36:39], s53 offen offset:2048 lds
MAA 148,68,124
TR 100,25,14464
s_add_u32 s53, s53, 128
MAA 148,48,120
TR 102,25,14976
MAA 152,52,120
MAA 152,72,124
s_waitcnt vmcnt(22) lgkmcnt(8)
s_barrier
MAA 60,80,0
TR 104,25,32
s_add_u32 m0, s56, 136064
MAA 60,84,20
buffer_load_dwordx4 v18, s[20:23], s54 offen lds
MAA 64,84,24
s_sub_u32 s47, s47, 1
s_cbranch_scc1 .Lx9
.Lx9b:
MAA 64,80,4
TR 106,25,544
MAA 68,80,8
TR 108,25,12448
MAA 68,84,28
buffer_load_dwordx4 v19, s[20:23], s54 offen offset:1024 lds
MAA 72,84,32
TR 110,25,12960
MAA 72,80,12
TR 112,25,1056
s_waitcnt lgkmcnt(5)
MAA 244,80,16
TR 114,25,1568
MAA 244,84,36
buffer_load_dwordx4 v20, s[20:23], s54 offen offset:2048 lds
MAA 156,92,36
s_add_u32 s54, s54, 196608
MAA 156,88,16
TR 116,25,13472
MAA 104,88,12
TR 118,25,13984
MAA 104,92,32
TR 120,25,2080
MAA 100,92,28
TR 122,25,2592
s_add_u32 m0, s55, 0
MAA 100,88,8
buffer_load_dwordx4 v21, s[36:39], s52 offen lds
MAA 96,88,4
TR 124,25,14496
MAA 96,92,24
TR 126,25,15008
MAA 92,92,20
MAA 92,88,0
buffer_load_dwordx4 v28, s[36:39], s52 offen offset:1024 lds
MAA 124,0,96
RD 40,23,18496
MAA 124,20,100
RD 44,23,20800
MAA 128,24,100
RD 48,23,23104
MAA 128,4,96
buffer_load_dword v22, s[36:39], s52 offen offset:2048 lds
MAA 132,8,96
RD 52,23,25408
s_add_u32 s52, s52, 128
MAA 132,28,100
RD 56,24,18496
MAA 136,32,100
MAA 136,12,96
s_waitcnt vmcnt(16) lgkmcnt(5)
s_barrier
MAA 76,104,0
RD 60,30,18496
s_add_u32 m0, s56, 73984
MAA 76,108,20
buffer_load_dwordx4 v18, s[20:23], s54 offen lds
MAA 80,108,24
RD 64,30,20800
MAA 80,104,4
RD 68,30,23104
MAA 84,104,8
RD 72,30,25408
MAA 84,108,28
buffer_load_dwordx4 v19, s[20:23], s54 offen offset:1024 lds
MAA 88,108,32
RD 76,31,18496
MAA 88,104,12
TR 80,25,24832
MAA 160,112,16
TR 82,25,25344
MAA 160,116,36
buffer_load_dwordx4 v20, s[20:23], s54 offen offset:2048 lds
MAA 120,116,32
TR 84,25,37248
s_add_u32 s54, s54, 196608
MAA 120,112,12
TR 86,25,37760
MAA 116,112,8
s_add_u32 m0, s55, 2304
MAA 116,116,28
buffer_load_dwordx4 v21, s[36:39], s53 offen lds
MAA 112,116,24
TR 88,25,25856
MAA 112,112,4
TR 90,25,26368
MAA 108,112,0
TR 92,25,38272
MAA 108,116,20
buffer_load_dwordx4 v28, s[36:39], s53 offen offset:1024 lds
MAA 140,20,124
TR 94,25,38784
MAA 140,0,120
TR 96,25,26880
MAA 144,4,120
TR 98,25,27392
MAA 144,24,124
buffer_load_dword v29, s[36:39], s53 offen offset:2048 lds
MAA 148,28,124
TR 100,25,39296
s_add_u32 s53, s53, 128
MAA 148,8,120
TR 102,25,39808
MAA 152,12,120
MAA 152,32,124
s_waitcnt lgkmcnt(8)
s_barrier
MAA 60,80,40
TR 104,25,24864
s_add_u32 m0, s56, 86400
MAA 60,84,60
buffer_load_dwordx4 v18, s[20:23], s54 offen lds
MAA 64,84,64
s_sub_u32 s47, s47, 1
s_cbranch_scc1 .Lx10
.Lx10b:
MAA 64,80,44
TR 106,25,25376
MAA 68,80,48
TR 108,25,37280
MAA 68,84,68
buffer_load_dwordx4 v19, s[20:23], s54 offen offset:1024 lds
MAA 72,84,72
TR 110,25,37792
MAA 72,80,52
TR 112,25,25888
s_waitcnt lgkmcnt(5)
MAA 244,80,56
TR 114,25,26400
MAA 244,84,76
buffer_load_dwordx4 v20, s[20:23], s54 offen offset:2048 lds
MAA 156,92,76
s_add_u32 s54, s54, 196608
MAA 156,88,56
TR 116,25,38304
MAA 104,88,52
TR 118,25,38816
MAA 104,92,72
TR 120,25,26912
MAA 100,92,68
TR 122,25,27424
s_add_u32 m0, s55, 18496
MAA 100,88,48
buffer_load_dwordx4 v21, s[36:39], s52 offen lds
MAA 96,88,44
TR 124,25,39328
MAA 96,92,64
TR 126,25,39840
MAA 92,92,60
MAA 92,88,40
buffer_load_dwordx4 v28, s[36:39], s52 offen offset:1024 lds
MAA 124,40,96
RD 0,23,36992
MAA 124,60,100
RD 4,23,39296
MAA 128,64,100
RD 8,23,41600
MAA 128,44,96
buffer_load_dword v22, s[36:39], s52 offen offset:2048 lds
MAA 132,48,96
RD 12,23,43904
s_add_u32 s52, s52, 128
MAA 132,68,100
RD 16,24,36992
MAA 136,72,100
MAA 136,52,96
s_waitcnt vmcnt(15) lgkmcnt(5)
s_barrier
MAA 76,104,40
RD 20,30,36992
s_add_u32 m0, s56, 98816
MAA 76,108,60
buffer_load_dwordx4 v18, s[20:23], s54 offen lds
MAA 80,108,64
RD 24,30,39296
MAA 80,104,44
RD 28,30,41600
MAA 84,104,48
RD 32,30,43904
MAA 84,108,68
buffer_load_dwordx4 v19, s[20:23], s54 offen offset:1024 lds
MAA 88,108,72
RD 36,31,36992
MAA 88,104,52
buffer_load_dwordx4 v20, s[20:23], s54 offen offset:2048 lds
MAA 160,112,56
TR 80,25,49664
s_add_u32 s54, s54, 196608
MAA 160,116,76
TR 82,25,50176
MAA 120,116,72
TR 84,25,62080
s_add_u32 m0, s55, 20800
MAA 120,112,52
buffer_load_dwordx4 v21, s[36:39], s53 offen lds
MAA 116,112,48
TR 86,25,62592
MAA 116,116,68
TR 88,25,50688
MAA 112,116,64
TR 90,25,51200
MAA 112,112,44
buffer_load_dwordx4 v28, s[36:39], s53 offen offset:1024 lds
MAA 108,112,40
TR 92,25,63104
MAA 108,116,60
TR 94,25,63616
MAA 140,60,124
TR 96,25,51712
MAA 140,40,120
buffer_load_dword v29, s[36:39], s53 offen offset:2048 lds
MAA 144,44,120
TR 98,25,52224
s_add_u32 s53, s53, 128
MAA 144,64,124
buffer_atomic_add v37, v33, s[16:19], 0 offen sc0
MAA 148,68,124
TR 100,25,64128
MAA 148,48,120
TR 102,25,64640
MAA 152,52,120
MAA 152,72,124
s_waitcnt lgkmcnt(8)
s_barrier
MAA 60,80,0
TR 104,25,49696
s_add_u32 m0, s56, 111232
MAA 60,84,20
buffer_load_dwordx4 v18, s[20:23], s54 offen lds
MAA 64,84,24
s_sub_u32 s47, s47, 1
s_cbranch_scc1 .Lx11
.Lx11b:
MAA 64,80,4
TR 106,25,50208
MAA 68,80,8
TR 108,25,62112
MAA 68,84,28
buffer_load_dwordx4 v19, s[20:23], s54 offen offset:1024 lds
MAA 72,84,32
TR 110,25,62624
MAA 72,80,12
TR 112,25,50720
s_waitcnt lgkmcnt(5)
MAA 244,80,16
TR 114,25,51232
MAA 244,84,36
buffer_load_dwordx4 v20, s[20:23], s54 offen offset:2048 lds
MAA 156,92,36
s_add_u32 s54, s54, 196608
MAA 156,88,16
TR 116,25,63136
MAA 104,88,12
TR 118,25,63648
MAA 104,92,32
TR 120,25,51744
MAA 100,92,28
TR 122,25,52256
s_add_u32 m0, s55, 36992
MAA 100,88,8
buffer_load_dwordx4 v21, s[36:39], s52 offen lds
MAA 96,88,4
TR 124,25,64160
MAA 96,92,24
TR 126,25,64672
MAA 92,92,20
MAA 92,88,0
buffer_load_dwordx4 v28, s[36:39], s52 offen offset:1024 lds
MAA 124,0,96
RD 40,23,55488
MAA 124,20,100
RD 44,23,57792
MAA 128,24,100
RD 48,23,60096
MAA 128,4,96
buffer_load_dword v22, s[36:39], s52 offen offset:2048 lds
MAA 132,8,96
RD 52,23,62400
s_add_u32 s52, s52, 128
MAA 132,28,100
RD 56,24,55488
MAA 136,32,100
MAA 136,12,96
s_waitcnt vmcnt(16) lgkmcnt(5)
s_barrier
MAA 76,104,0
RD 60,30,55488
s_add_u32 m0, s56, 123648
MAA 76,108,20
buffer_load_dwordx4 v18, s[20:23], s54 offen lds
MAA 80,108,24
RD 64,30,57792
MAA 80,104,4
RD 68,30,60096
MAA 84,104,8
RD 72,30,62400
MAA 84,108,28
buffer_load_dwordx4 v19, s[20:23], s54 offen offset:1024 lds
MAA 88,108,32
RD 76,31,55488
MAA 88,104,12
ds_read_b64_tr_b16 a[80:81], v25
MAA 160,112,16
TR 82,25,512
MAA 160,116,36
buffer_load_dwordx4 v20, s[20:23], s54 offen offset:2048 lds
MAA 120,116,32
TR 84,25,12416
s_add_u32 s54, s54, 196608
MAA 120,112,12
TR 86,25,12928
MAA 116,112,8
s_add_u32 m0, s55, 39296
MAA 116,116,28
buffer_load_dwordx4 v21, s[36:39], s53 offen lds
MAA 112,116,24
TR 88,25,1024
MAA 112,112,4
TR 90,25,1536
MAA 108,112,0
TR 92,25,13440
MAA 108,116,20
buffer_load_dwordx4 v28, s[36:39], s53 offen offset:1024 lds
MAA 140,20,124
TR 94,25,13952
MAA 140,0,120
TR 96,25,2048
MAA 144,4,120
TR 98,25,2560
MAA 144,24,124
buffer_load_dword v29, s[36:39], s53 offen offset:2048 lds
MAA 148,28,124
TR 100,25,14464
s_add_u32 s53, s53, 128
MAA 148,8,120
TR 102,25,14976
MAA 152,12,120
MAA 152,32,124
s_waitcnt lgkmcnt(8)
s_barrier
MAA 60,80,40
TR 104,25,32
s_add_u32 m0, s56, 136064
MAA 60,84,60
buffer_load_dwordx4 v18, s[20:23], s54 offen lds
MAA 64,84,64
s_sub_u32 s47, s47, 1
s_cbranch_scc1 .Lx12
.Lx12b:
MAA 64,80,44
TR 106,25,544
MAA 68,80,48
TR 108,25,12448
MAA 68,84,68
buffer_load_dwordx4 v19, s[20:23], s54 offen offset:1024 lds
MAA 72,84,72
TR 110,25,12960
MAA 72,80,52
TR 112,25,1056
s_waitcnt lgkmcnt(5)
MAA 244,80,56
TR 114,25,1568
MAA 244,84,76
buffer_load_dwordx4 v20, s[20:23], s54 offen offset:2048 lds
MAA 156,92,76
s_add_u32 s54, s54, 196608
MAA 156,88,56
TR 116,25,13472
MAA 104,88,52
TR 118,25,13984
MAA 104,92,72
TR 120,25,2080
MAA 100,92,68
TR 122,25,2592
s_add_u32 m0, s55, 55488
MAA 100,88,48
buffer_load_dwordx4 v21, s[36:39], s52 offen lds
MAA 96,88,44
TR 124,25,14496
MAA 96,92,64
TR 126,25,15008
MAA 92,92,60
MAA 92,88,40
buffer_load_dwordx4 v28, s[36:39], s52 offen offset:1024 lds
MAA 124,40,96
ds_read_b128 a[0:3], v23
MAA 124,60,100
RD 4,23,2304
MAA 128,64,100
RD 8,23,4608
MAA 128,44,96
buffer_load_dword v22, s[36:39], s52 offen offset:2048 lds
MAA 132,48,96
RD 12,23,6912
s_add_u32 s52, s52, 128
MAA 132,68,100
ds_read_b128 a[16:19], v24
MAA 136,72,100
MAA 136,52,96
s_waitcnt vmcnt(18)
v_cmp_gt_u32 vcc, v36, v37
s_nop 0
s_cbranch_vccnz .Lsp13
.Lsp13b:
s_waitcnt vmcnt(15) lgkmcnt(5)
s_barrier
MAA 76,104,40
ds_read_b128 a[20:23], v30
s_add_u32 m0, s56, 73984
MAA 76,108,60
buffer_load_dwordx4 v18, s[20:23], s54 offen lds
MAA 80,108,64
RD 24,30,2304
MAA 80,104,44
RD 28,30,4608
MAA 84,104,48
RD 32,30,6912
MAA 84,108,68
buffer_load_dwordx4 v19, s[20:23], s54 offen offset:1024 lds
MAA 88,108,72
ds_read_b128 a[36:39], v31
MAA 88,104,52
buffer_load_dwordx4 v20, s[20:23], s54 offen offset:2048 lds
MAA 160,112,56
TR 80,25,24832
s_add_u32 s54, s54, 196608
MAA 160,116,76
TR 82,25,25344
MAA 120,116,72
TR 84,25,37248
s_add_u32 m0, s55, 57792
MAA 120,112,52
buffer_load_dwordx4 v21, s[36:39], s53 offen lds
MAA 116,112,48
TR 86,25,37760
MAA 116,116,68
TR 88,25,25856
MAA 112,116,64
TR 90,25,26368
MAA 112,112,44
buffer_load_dwordx4 v28, s[36:39], s53 offen offset:1024 lds
MAA 108,112,40
TR 92,25,38272
MAA 108,116,60
TR 94,25,38784
MAA 140,60,124
TR 96,25,26880
MAA 140,40,120
buffer_load_dword v29, s[36:39], s53 offen offset:2048 lds
MAA 144,44,120
TR 98,25,27392
s_add_u32 s53, s53, 128
MAA 144,64,124
buffer_load_dwordx4 v[164:167], v26, s[16:19], s75 offen sc1
MAA 148,68,124
TR 100,25,39296
MAA 148,48,120
TR 102,25,39808
MAA 152,52,120
MAA 152,72,124
s_waitcnt lgkmcnt(8)
s_barrier
MAA 60,80,0
TR 104,25,24864
s_add_u32 m0, s56, 86400
MAA 60,84,20
buffer_load_dwordx4 v18, s[20:23], s54 offen lds
MAA 64,84,24
s_sub_u32 s47, s47, 1
s_cbranch_scc1 .Lx14
.Lx14b:
MAA 64,80,4
TR 106,25,25376
MAA 68,80,8
TR 108,25,37280
MAA 68,84,28
buffer_load_dwordx4 v19, s[20:23], s54 offen offset:1024 lds
MAA 72,84,32
TR 110,25,37792
MAA 72,80,12
TR 112,25,25888
s_waitcnt lgkmcnt(5)
MAA 244,80,16
TR 114,25,26400
MAA 244,84,36
buffer_load_dwordx4 v20, s[20:23], s54 offen offset:2048 lds
MAA 156,92,36
TR 116,25,38304
s_add_u32 s54, s54, 196608
MAA 156,88,16
TR 118,25,38816
MAA 104,88,12
TR 120,25,26912
s_add_u32 m0, s55, 0
MAA 104,92,32
buffer_load_dwordx4 v21, s[36:39], s52 offen lds
MAA 100,92,28
MAA 100,88,8
buffer_load_dwordx4 v28, s[36:39], s52 offen offset:1024 lds
MAA 96,88,4
TR 122,25,27424
MAA 96,92,24
TR 124,25,39328
MAA 92,92,20
TR 126,25,39840
MAA 92,88,0
buffer_load_dword v22, s[36:39], s52 offen offset:2048 lds
MAA 124,0,96
RD 40,23,18496
s_add_u32 s52, s52, 128
MAA 124,20,100
RD 44,23,20800
MAA 128,24,100
RD 48,23,23104
MAA 128,4,96
buffer_load_dwordx4 v[168:171], v26, s[16:19], s75 offen offset:1024 sc1
MAA 132,8,96
RD 52,23,25408
MAA 132,28,100
RD 56,24,18496
MAA 136,32,100
MAA 136,12,96
s_waitcnt vmcnt(17) lgkmcnt(5)
s_barrier
MAA 76,104,0
RD 60,30,18496
s_add_u32 m0, s56, 98816
MAA 76,108,20
buffer_load_dwordx4 v18, s[20:23], s54 offen lds
MAA 80,108,24
RD 64,30,20800
MAA 80,104,4
RD 68,30,23104
MAA 84,104,8
RD 72,30,25408
MAA 84,108,28
buffer_load_dwordx4 v19, s[20:23], s54 offen offset:1024 lds
MAA 88,108,32
RD 76,31,18496
MAA 88,104,12
buffer_load_dwordx4 v20, s[20:23], s54 offen offset:2048 lds
MAA 160,112,16
TR 80,25,49664
s_add_u32 s54, s54, 196608
MAA 160,116,36
TR 82,25,50176
MAA 120,116,32
TR 84,25,62080
s_add_u32 m0, s55, 2304
MAA 120,112,12
buffer_load_dwordx4 v21, s[36:39], s53 offen lds
MAA 116,112,8
TR 86,25,62592
MAA 116,116,28
TR 88,25,50688
MAA 112,116,24
TR 90,25,51200
MAA 112,112,4
buffer_load_dwordx4 v28, s[36:39], s53 offen offset:1024 lds
MAA 108,112,0
TR 92,25,63104
MAA 108,116,20
TR 94,25,63616
MAA 140,20,124
TR 96,25,51712
MAA 140,0,120
buffer_load_dword v29, s[36:39], s53 offen offset:2048 lds
MAA 144,4,120
TR 98,25,52224
s_add_u32 s53, s53, 128
MAA 144,24,124
buffer_load_dwordx4 v[172:175], v26, s[16:19], s75 offen offset:2048 sc1
MAA 148,28,124
TR 100,25,64128
MAA 148,8,120
TR 102,25,64640
MAA 152,12,120
MAA 152,32,124
s_waitcnt lgkmcnt(8)
s_barrier
MAA 60,80,40
TR 104,25,49696
s_add_u32 m0, s56, 111232
MAA 60,84,60
buffer_load_dwordx4 v18, s[20:23], s54 offen lds
MAA 64,84,64
s_sub_u32 s47, s47, 1
s_cbranch_scc1 .Lx15
.Lx15b:
MAA 64,80,44
TR 106,25,50208
MAA 68,80,48
TR 108,25,62112
MAA 68,84,68
buffer_load_dwordx4 v19, s[20:23], s54 offen offset:1024 lds
MAA 72,84,72
TR 110,25,62624
MAA 72,80,52
TR 112,25,50720
s_waitcnt lgkmcnt(5)
MAA 244,80,56
TR 114,25,51232
MAA 244,84,76
buffer_load_dwordx4 v20, s[20:23], s54 offen offset:2048 lds
MAA 156,92,76
TR 116,25,63136
s_add_u32 s54, s54, 196608
MAA 156,88,56
TR 118,25,63648
MAA 104,88,52
TR 120,25,51744
s_add_u32 m0, s55, 18496
MAA 104,92,72
buffer_load_dwordx4 v21, s[36:39], s52 offen lds
MAA 100,92,68
MAA 100,88,48
buffer_load_dwordx4 v28, s[36:39], s52 offen offset:1024 lds
MAA 96,88,44
TR 122,25,52256
MAA 96,92,64
TR 124,25,64160
MAA 92,92,60
TR 126,25,64672
MAA 92,88,40
buffer_load_dword v22, s[36:39], s52 offen offset:2048 lds
MAA 124,40,96
RD 0,23,36992
s_add_u32 s52, s52, 128
MAA 124,60,100
RD 4,23,39296
MAA 128,64,100
RD 8,23,41600
MAA 128,44,96
buffer_load_dwordx4 v[176:179], v26, s[16:19], s75 offen offset:3072 sc1
MAA 132,48,96
RD 12,23,43904
s_add_u32 s75, s75, 4096
MAA 132,68,100
RD 16,24,36992
MAA 136,72,100
MAA 136,52,96
s_waitcnt vmcnt(18) lgkmcnt(5)
s_barrier
MAA 76,104,40
RD 20,30,36992
s_add_u32 m0, s56, 123648
MAA 76,108,60
buffer_load_dwordx4 v18, s[20:23], s54 offen lds
MAA 80,108,64
RD 24,30,39296
s_waitcnt vmcnt(15)
v_add_f32 v164, v164, v168
MAA 80,104,44
RD 28,30,41600
MAA 84,104,48
RD 32,30,43904
MAA 84,108,68
buffer_load_dwordx4 v19, s[20:23], s54 offen offset:1024 lds
MAA 88,108,72
RD 36,31,36992
v_add_f32 v165, v165, v169
MAA 88,104,52
buffer_load_dwordx4 v20, s[20:23], s54 offen offset:2048 lds
MAA 160,112,56
ds_read_b64_tr_b16 a[80:81], v25
s_add_u32 s54, s54, 196608
MAA 160,116,76
TR 82,25,512
MAA 120,116,72
TR 84,25,12416
s_add_u32 m0, s55, 20800
MAA 120,112,52
buffer_load_dwordx4 v21, s[36:39], s53 offen lds
MAA 116,112,48
TR 86,25,12928
MAA 116,116,68
TR 88,25,1024
MAA 112,116,64
TR 90,25,1536
v_add_f32 v166, v166, v170
MAA 112,112,44
buffer_load_dwordx4 v28, s[36:39], s53 offen offset:1024 lds
MAA 108,112,40
TR 92,25,13440
MAA 108,116,60
TR 94,25,13952
MAA 140,60,124
TR 96,25,2048
MAA 140,40,120
buffer_load_dword v29, s[36:39], s53 offen offset:2048 lds
MAA 144,44,120
TR 98,25,2560
s_add_u32 s53, s53, 128
MAA 144,64,124
buffer_load_dwordx4 v[180:183], v26, s[16:19], s75 offen sc1
MAA 148,68,124
TR 100,25,14464
v_add_f32 v167, v167, v171
MAA 148,48,120
TR 102,25,14976
MAA 152,52,120
MAA 152,72,124
s_waitcnt lgkmcnt(8)
s_barrier
MAA 60,80,0
TR 104,25,32
s_add_u32 m0, s56, 136064
MAA 60,84,20
buffer_load_dwordx4 v18, s[20:23], s54 offen lds
MAA 64,84,24
s_sub_u32 s47, s47, 1
s_cbranch_scc1 .Lx16
.Lx16b:
MAA 64,80,4
TR 106,25,544
s_waitcnt vmcnt(15)
v_add_f32 v164, v164, v172
MAA 68,80,8
TR 108,25,12448
MAA 68,84,28
buffer_load_dwordx4 v19, s[20:23], s54 offen offset:1024 lds
MAA 72,84,32
TR 110,25,12960
MAA 72,80,12
TR 112,25,1056
s_waitcnt lgkmcnt(5)
MAA 244,80,16
TR 114,25,1568
MAA 244,84,36
buffer_load_dwordx4 v20, s[20:23], s54 offen offset:2048 lds
MAA 156,92,36
TR 116,25,13472
s_add_u32 s54, s54, 196608
MAA 156,88,16
TR 118,25,13984
v_add_f32 v165, v165, v173
MAA 104,88,12
TR 120,25,2080
s_add_u32 m0, s55, 36992
MAA 104,92,32
buffer_load_dwordx4 v21, s[36:39], s52 offen lds
MAA 100,92,28
MAA 100,88,8
buffer_load_dwordx4 v28, s[36:39], s52 offen offset:1024 lds
MAA 96,88,4
TR 122,25,2592
MAA 96,92,24
TR 124,25,14496
v_add_f32 v166, v166, v174
MAA 92,92,20
TR 126,25,15008
MAA 92,88,0
buffer_load_dword v22, s[36:39], s52 offen offset:2048 lds
MAA 124,0,96
RD 40,23,55488
s_add_u32 s52, s52, 128
MAA 124,20,100
RD 44,23,57792
MAA 128,24,100
RD 48,23,60096
MAA 128,4,96
buffer_load_dwordx4 v[184:187], v26, s[16:19], s75 offen offset:1024 sc1
MAA 132,8,96
RD 52,23,62400
v_add_f32 v167, v167, v175
MAA 132,28,100
RD 56,24,55488
MAA 136,32,100
MAA 136,12,96
s_waitcnt vmcnt(18) lgkmcnt(5)
s_barrier
MAA 76,104,0
RD 60,30,55488
s_add_u32 m0, s56, 73984
MAA 76,108,20
buffer_load_dwordx4 v18, s[20:23], s54 offen lds
MAA 80,108,24
RD 64,30,57792
s_waitcnt vmcnt(15)
v_add_f32 v164, v164, v176
MAA 80,104,4
RD 68,30,60096
v_add_f32 v165, v165, v177
MAA 84,104,8
buffer_load_dwordx4 v19, s[20:23], s54 offen offset:1024 lds
MAA 84,108,28
RD 72,30,62400
v_add_f32 v166, v166, v178
MAA 88,108,32
RD 76,31,55488
v_add_f32 v167, v167, v179
MAA 88,104,12
buffer_load_dwordx4 v20, s[20:23], s54 offen offset:2048 lds
MAA 160,112,16
TR 80,25,24832
s_add_u32 s54, s54, 196608
MAA 160,116,36
TR 82,25,25344
s_add_u32 m0, s55, 39296
MAA 120,116,32
buffer_load_dwordx4 v21, s[36:39], s53 offen lds
MAA 120,112,12
TR 84,25,37248
MAA 116,112,8
TR 86,25,37760
MAA 116,116,28
buffer_load_dwordx4 v28, s[36:39], s53 offen offset:1024 lds
MAA 112,116,24
TR 88,25,25856
MAA 112,112,4
TR 90,25,26368
MAA 108,112,0
buffer_load_dword v29, s[36:39], s53 offen offset:2048 lds
MAA 108,116,20
TR 92,25,38272
s_add_u32 s53, s53, 128
MAA 140,20,124
TR 94,25,38784
MAA 140,0,120
buffer_load_dwordx4 v[188:191], v26, s[16:19], s75 offen offset:2048 sc1
MAA 144,4,120
TR 96,25,26880
MAA 144,24,124
TR 98,25,27392
MAA 148,28,124
TR 100,25,39296
MAA 148,8,120
TR 102,25,39808
MAA 152,12,120
MAA 152,32,124
s_waitcnt lgkmcnt(8)
s_barrier
MAA 60,80,40
TR 104,25,24864
s_add_u32 m0, s56, 86400
MAA 60,84,60
buffer_load_dwordx4 v18, s[20:23], s54 offen lds
MAA 64,84,64
s_sub_u32 s47, s47, 1
s_cbranch_scc1 .Lx17
.Lx17b:
MAA 64,80,44
TR 106,25,25376
s_waitcnt vmcnt(15)
v_add_f32 v164, v164, v180
MAA 68,80,48
TR 108,25,37280
MAA 68,84,68
buffer_load_dwordx4 v19, s[20:23], s54 offen offset:1024 lds
MAA 72,84,72
TR 110,25,37792
MAA 72,80,52
TR 112,25,25888
s_waitcnt lgkmcnt(5)
MAA 244,80,56
TR 114,25,26400
MAA 244,84,76
buffer_load_dwordx4 v20, s[20:23], s54 offen offset:2048 lds
MAA 156,92,76
TR 116,25,38304
s_add_u32 s54, s54, 196608
MAA 156,88,56
TR 118,25,38816
v_add_f32 v165, v165, v181
MAA 104,88,52
TR 120,25,26912
s_add_u32 m0, s55, 55488
MAA 104,92,72
buffer_load_dwordx4 v21, s[36:39], s52 offen lds
MAA 100,92,68
MAA 100,88,48
buffer_load_dwordx4 v28, s[36:39], s52 offen offset:1024 lds
MAA 96,88,44
TR 122,25,27424
MAA 96,92,64
TR 124,25,39328
v_add_f32 v166, v166, v182
MAA 92,92,60
TR 126,25,39840
MAA 92,88,40
buffer_load_dword v22, s[36:39], s52 offen offset:2048 lds
MAA 124,40,96
ds_read_b128 a[0:3], v23
s_add_u32 s52, s52, 128
MAA 124,60,100
RD 4,23,2304
MAA 128,64,100
RD 8,23,4608
MAA 128,44,96
buffer_load_dwordx4 v[192:195], v26, s[16:19], s75 offen offset:3072 sc1
MAA 132,48,96
RD 12,23,6912
v_add_f32 v167, v167, v183
MAA 132,68,100
ds_read_b128 a[16:19], v24
MAA 136,72,100
MAA 136,52,96
s_waitcnt vmcnt(18) lgkmcnt(5)
s_barrier
MAA 76,104,40
ds_read_b128 a[20:23], v30
s_add_u32 m0, s56, 98816
MAA 76,108,60
buffer_load_dwordx4 v18, s[20:23], s54 offen lds
MAA 80,108,64
RD 24,30,2304
s_waitcnt vmcnt(15)
v_add_f32 v164, v164, v184
MAA 80,104,44
RD 28,30,4608
v_add_f32 v165, v165, v185
MAA 84,104,48
RD 32,30,6912
v_add_f32 v166, v166, v186
MAA 84,108,68
buffer_load_dwordx4 v19, s[20:23], s54 offen offset:1024 lds
MAA 88,108,72
ds_read_b128 a[36:39], v31
v_add_f32 v167, v167, v187
MAA 88,104,52
TR 80,25,49664
MAA 160,112,56
TR 82,25,50176
MAA 160,116,76
buffer_load_dwordx4 v20, s[20:23], s54 offen offset:2048 lds
MAA 120,116,72
TR 84,25,62080
s_add_u32 s54, s54, 196608
MAA 120,112,52
TR 86,25,62592
s_add_u32 m0, s55, 57792
MAA 116,112,48
TR 88,25,50688
MAA 116,116,68
buffer_load_dwordx4 v21, s[36:39], s53 offen lds
MAA 112,116,64
TR 90,25,51200
MAA 112,112,44
TR 92,25,63104
MAA 108,112,40
TR 94,25,63616
MAA 108,116,60
buffer_load_dwordx4 v28, s[36:39], s53 offen offset:1024 lds
MAA 140,60,124
TR 96,25,51712
MAA 140,40,120
TR 98,25,52224
MAA 144,44,120
TR 100,25,64128
MAA 144,64,124
buffer_load_dword v29, s[36:39], s53 offen offset:2048 lds
MAA 148,68,124
TR 102,25,64640
s_add_u32 s53, s53, 128
MAA 148,48,120
MAA 152,52,120
MAA 152,72,124
s_waitcnt lgkmcnt(8)
s_barrier
MAA 60,80,0
TR 104,25,49696
s_add_u32 m0, s56, 111232
MAA 60,84,20
buffer_load_dwordx4 v18, s[20:23], s54 offen lds
MAA 64,84,24
TR 106,25,50208
s_waitcnt vmcnt(14)
v_add_f32 v164, v164, v188
MAA 64,80,4
TR 108,25,62112
v_add_f32 v165, v165, v189
MAA 68,80,8
buffer_load_dwordx4 v19, s[20:23], s54 offen offset:1024 lds
MAA 68,84,28
TR 110,25,62624
v_add_f32 v166, v166, v190
MAA 72,84,32
TR 112,25,50720
v_add_f32 v167, v167, v191
MAA 72,80,12
buffer_load_dwordx4 v20, s[20:23], s54 offen offset:2048 lds
s_waitcnt lgkmcnt(5)
MAA 244,80,16
TR 114,25,51232
s_add_u32 s54, s54, 196608
MAA 244,84,36
TR 116,25,63136
s_add_u32 m0, s59, 0
MAA 156,92,36
TR 118,25,63648
s_xor_b32 s58, s87, 1048576
MAA 156,88,16
buffer_load_dwordx4 v5, s[24:27], s58 offen lds
MAA 104,88,12
TR 120,25,51744
MAA 104,92,32
TR 122,25,52256
MAA 100,92,28
buffer_load_dwordx4 v6, s[24:27], s58 offen offset:1024 lds
MAA 100,88,8
TR 124,25,64160
s_add_u32 m0, s59, 8320
MAA 96,88,4
TR 126,25,64672
s_xor_b32 s58, s87, 1179648
MAA 96,92,24
buffer_load_dwordx4 v5, s[24:27], s58 offen lds
MAA 92,92,20
RD 40,23,18496
MAA 92,88,0
RD 44,23,20800
MAA 124,0,96
buffer_load_dwordx4 v6, s[24:27], s58 offen offset:1024 lds
MAA 124,20,100
RD 48,23,23104
MAA 128,24,100
RD 52,23,25408
MAA 128,4,96
RD 56,24,18496
MAA 132,8,96
MAA 132,28,100
MAA 136,32,100
MAA 136,12,96
s_waitcnt vmcnt(17) lgkmcnt(5)
s_barrier
MAA 76,104,0
RD 60,30,18496
s_add_u32 m0, s56, 123648
MAA 76,108,20
buffer_load_dwordx4 v18, s[20:23], s54 offen lds
MAA 80,108,24
RD 64,30,20800
s_waitcnt vmcnt(14)
v_add_f32 v164, v164, v192
MAA 80,104,4
RD 68,30,23104
v_add_f32 v165, v165, v193
MAA 84,104,8
RD 72,30,25408
v_add_f32 v166, v166, v194
MAA 84,108,28
RD 76,31,18496
v_add_f32 v167, v167, v195
MAA 88,108,32
ds_read_b64_tr_b16 a[80:81], v25
MAA 88,104,12
TR 82,25,512
MAA 160,112,16
TR 84,25,12416
MAA 160,116,36
buffer_load_dwordx4 v19, s[20:23], s54 offen offset:1024 lds
MAA 120,116,32
TR 86,25,12928
MAA 120,112,12
TR 88,25,1024
MAA 116,112,8
TR 90,25,1536
MAA 116,116,28
TR 92,25,13440
MAA 112,116,24
TR 94,25,13952
MAA 112,112,4
TR 96,25,2048
MAA 108,112,0
TR 98,25,2560
MAA 108,116,20
buffer_load_dwordx4 v20, s[20:23], s54 offen offset:2048 lds
MAA 140,20,124
TR 100,25,14464
s_add_u32 s54, s54, 196608
MAA 140,0,120
TR 102,25,14976
MAA 144,4,120
MAA 144,24,124
MAA 148,28,124
MAA 148,8,120
MAA 152,12,120
MAA 152,32,124
s_waitcnt lgkmcnt(8)
s_barrier
MAA 60,80,40
TR 104,25,32
s_add_u32 m0, s56, 136064
MAA 60,84,60
buffer_load_dwordx4 v18, s[20:23], s54 offen lds
MAA 64,84,64
TR 106,25,544
MAA 64,80,44
TR 108,25,12448
MAA 68,80,48
buffer_load_dwordx4 v19, s[20:23], s54 offen offset:1024 lds
MAA 68,84,68
TR 110,25,12960
MAA 72,84,72
TR 112,25,1056
MAA 72,80,52
buffer_load_dwordx4 v20, s[20:23], s54 offen offset:2048 lds
s_waitcnt lgkmcnt(5)
MAA 244,80,56
TR 114,25,1568
s_add_u32 s54, s54, 196608
MAA 244,84,76
TR 116,25,13472
s_add_u32 m0, s59, 16640
MAA 156,92,76
TR 118,25,13984
s_xor_b32 s58, s87, 1310720
MAA 156,88,56
buffer_load_dwordx4 v5, s[24:27], s58 offen lds
MAA 104,88,52
TR 120,25,2080
MAA 104,92,72
TR 122,25,2592
MAA 100,92,68
buffer_load_dwordx4 v6, s[24:27], s58 offen offset:1024 lds
MAA 100,88,48
TR 124,25,14496
s_add_u32 m0, s59, 24960
MAA 96,88,44
TR 126,25,15008
s_xor_b32 s58, s87, 1441792
MAA 96,92,64
buffer_load_dwordx4 v5, s[24:27], s58 offen lds
MAA 92,92,60
RD 0,23,36992
MAA 92,88,40
RD 4,23,39296
MAA 124,40,96
buffer_load_dwordx4 v6, s[24:27], s58 offen offset:1024 lds
MAA 124,60,100
RD 8,23,41600
MAA 128,64,100
RD 12,23,43904
MAA 128,44,96
RD 16,24,36992
MAA 132,48,96
v_permlane32_swap_b32 v164, v166
MAA 132,68,100
v_permlane32_swap_b32 v165, v167
MAA 136,72,100
v_add_f32 v164, v164, v166
v_add_f32 v165, v165, v167
MAA 136,52,96
v_mul_f32 v164, 0xba800000, v164
v_mul_f32 v165, 0x3a800000, v165
v_fma_f32 v165, -v164, v164, v165
v_max_f32 v165, 0, v165
v_add_f32 v165, 0x3727c5ac, v165
v_rsq_f32 v166, v165
s_nop 0
v_mov_b32 v165, v166
v_mul_f32 v166, 0x3e8293ee, v166
s_waitcnt vmcnt(14) lgkmcnt(5)
s_barrier
MAA 76,104,40
ds_write_b128 v7, v[164:167]
s_add_u32 m0, s59, 74880
MAA 76,108,60
ds_write_b32 v17, v164
s_xor_b32 s58, s87, 131072
MAA 80,108,64
ds_write_b32 v17, v165 offset:1024
MAA 80,104,44
buffer_load_dwordx4 v5, s[24:27], s58 offen lds
MAA 84,104,48
RD 20,30,36992
MAA 84,108,68
RD 24,30,39296
MAA 88,108,72
RD 28,30,41600
MAA 88,104,52
RD 32,30,43904
MAA 160,112,56
RD 36,31,36992
MAA 160,116,76
buffer_load_dwordx4 v6, s[24:27], s58 offen offset:1024 lds
MAA 120,116,72
TR 80,25,24832
s_add_u32 m0, s59, 83200
MAA 120,112,52
TR 82,25,25344
s_xor_b32 s58, s87, 262144
MAA 116,112,48
TR 84,25,37248
MAA 116,116,68
TR 86,25,37760
MAA 112,116,64
TR 88,25,25856
MAA 112,112,44
buffer_load_dwordx4 v5, s[24:27], s58 offen lds
MAA 108,112,40
TR 90,25,26368
MAA 108,116,60
TR 92,25,38272
MAA 140,60,124
TR 94,25,38784
MAA 140,40,120
TR 96,25,26880
MAA 144,44,120
TR 98,25,27392
MAA 144,64,124
buffer_load_dwordx4 v6, s[24:27], s58 offen offset:1024 lds
MAA 148,68,124
TR 100,25,39296
MAA 148,48,120
TR 102,25,39808
MAA 152,52,120
MAA 152,72,124
s_waitcnt vmcnt(8) lgkmcnt(0)
s_barrier
MAA 156,88,16
TR 112,25,25888
s_add_u32 m0, s59, 33280
MAA 156,92,36
TR 114,25,26400
s_xor_b32 s58, s87, 1572864
MAA 104,92,32
buffer_load_dwordx4 v5, s[24:27], s58 offen lds
MAA 104,88,12
TR 116,25,38304
MAA 100,88,8
TR 118,25,38816
MAA 100,92,28
TR 120,25,26912
MAA 96,92,24
buffer_load_dwordx4 v6, s[24:27], s58 offen offset:1024 lds
MAA 96,88,4
TR 122,25,27424
s_add_u32 m0, s59, 41600
MAA 92,88,0
TR 124,25,39328
s_xor_b32 s58, s87, 1703936
MAA 92,92,20
TR 126,25,39840
MAA 136,32,100
buffer_load_dwordx4 v5, s[24:27], s58 offen lds
MAA 136,12,96
TR 104,25,24864
MAA 244,80,16
TR 106,25,25376
MAA 244,84,36
TR 108,25,37280
MAA 72,84,32
buffer_load_dwordx4 v6, s[24:27], s58 offen offset:1024 lds
MAA 72,80,12
TR 110,25,37792
s_xor_b32 s58, s87, 393216
MAA 68,80,8
RD 40,23,55488
MAA 68,84,28
RD 44,23,57792
MAA 64,84,24
RD 48,23,60096
MAA 64,80,4
RD 52,23,62400
MAA 60,80,0
RD 56,24,55488
MAA 60,84,20
RD 60,30,55488
s_waitcnt lgkmcnt(15)
MAA 160,112,16
RD 64,30,57792
s_waitcnt lgkmcnt(15)
MAA 160,116,36
s_waitcnt lgkmcnt(7)
s_barrier
RD 68,30,60096
MAA 120,116,32
RD 72,30,62400
s_add_u32 m0, s59, 91520
MAA 120,112,12
RD 76,31,55488
MAA 116,112,8
TR 144,25,50688
MAA 116,116,28
TR 146,25,51200
MAA 112,116,24
TR 148,25,63104
MAA 112,112,4
TR 150,25,63616
MAA 108,112,0
TR 152,25,50720
MAA 108,116,20
TR 154,25,51232
MAA 152,32,124
TR 156,25,63136
MAA 152,12,120
TR 158,25,63648
MAA 88,104,12
TR 160,25,51712
MAA 88,108,32
TR 162,25,52224
MAA 84,108,28
TR 164,25,64128
MAA 84,104,8
TR 166,25,64640
MAA 80,104,4
TR 168,25,51744
MAA 80,108,24
TR 170,25,52256
MAA 76,108,20
TR 172,25,64160
MAA 76,104,0
TR 174,25,64672
s_waitcnt lgkmcnt(14)
MAA 156,144,56
TR 128,25,49664
s_waitcnt lgkmcnt(13)
MAA 156,148,76
TR 130,25,50176
MAA 104,148,72
TR 132,25,62080
MAA 104,144,52
TR 134,25,62592
MAA 100,144,48
TR 136,25,49696
MAA 100,148,68
TR 138,25,50208
MAA 96,148,64
TR 140,25,62112
MAA 96,144,44
TR 142,25,62624
MAA 92,144,40
ds_read_b128 v[232:235], v10 offset:768
MAA 92,148,60
ds_read_b128 v[236:239], v10 offset:2816
s_waitcnt lgkmcnt(15)
MAA 160,156,76
ds_read_b128 v[228:231], v10 offset:512
MAA 160,152,56
ds_read_b128 v[224:227], v10 offset:256
MAA 120,152,52
ds_read_b128 v[220:223], v10
MAA 120,156,72
buffer_load_dwordx4 v5, s[24:27], s58 offen lds
MAA 116,156,68
MAA 116,152,48
s_waitcnt lgkmcnt(5)
s_barrier
MAA 112,152,44
MAA 112,156,64
buffer_load_dwordx4 v6, s[24:27], s58 offen offset:1024 lds
MAA 108,156,60
s_add_u32 m0, s59, 99840
s_xor_b32 s58, s87, 524288
MAA 108,152,40
MAA 136,52,160
MAA 136,72,164
buffer_load_dwordx4 v5, s[24:27], s58 offen lds
MAA 152,72,172
MAA 152,52,168
MAA 244,128,56
MAA 244,132,76
buffer_load_dwordx4 v6, s[24:27], s58 offen offset:1024 lds
MAA 72,132,72
s_add_u32 m0, s59, 108160
s_xor_b32 s58, s87, 655360
MAA 72,128,52
MAA 68,128,48
MAA 68,132,68
buffer_load_dwordx4 v5, s[24:27], s58 offen lds
buffer_load_dwordx4 v6, s[24:27], s58 offen offset:1024 lds
s_mov_b32 exec_lo, 0x10001
s_mov_b32 exec_hi, 0x10001
ds_write_b128 v13, v[244:247]
ds_write_b128 v13, v[156:159] offset:256
ds_write_b128 v13, v[160:163] offset:320
s_mov_b64 exec, -1
MAA 64,128,44
MAA 64,132,64
MAA 60,132,60
MAA 60,128,40
MAA 88,136,52
MAA 88,140,72
s_waitcnt lgkmcnt(0)
s_barrier
MAA 84,136,48
ds_read_b128 v[28:31], v13
s_add_u32 m0, s59, 49920
MAA 84,140,68
ds_read_b128 v[32:35], v13 offset:64
s_xor_b32 s58, s87, 1835008
MAA 80,140,64
ds_read_b128 v[36:39], v13 offset:256
MAA 80,136,44
ds_read_b128 v[40:43], v13 offset:320
MAA 76,136,40
ds_read_b32 v44, v12 offset:512
MAA 76,140,60
ds_read_b32 v45, v12 offset:576
ds_read_b128 v[240:243], v11 offset:192
ds_read_b128 v[244:247], v11 offset:1216
ds_read_b128 v[18:21], v11 offset:128
ds_read_b128 v[22:25], v11 offset:1152
buffer_load_dwordx4 v5, s[24:27], s58 offen lds
s_waitcnt lgkmcnt(9)
v_pk_fma_f32 v[72:73], v[28:29], v[232:233], v[72:73] op_sel_hi:[1,0,1]
v_cvt_pk_bf16_f32 v176, v72, v73
v_pk_fma_f32 v[74:75], v[30:31], v[232:233], v[74:75] op_sel_hi:[1,0,1]
v_cvt_pk_bf16_f32 v177, v74, v75
s_waitcnt lgkmcnt(8)
v_pk_fma_f32 v[88:89], v[32:33], v[232:233], v[88:89] op_sel_hi:[1,0,1]
v_cvt_pk_bf16_f32 v178, v88, v89
v_pk_fma_f32 v[90:91], v[34:35], v[232:233], v[90:91] op_sel_hi:[1,0,1]
s_waitcnt lgkmcnt(7)
v_pk_fma_f32 v[104:105], v[36:37], v[232:233], v[104:105] op_sel_hi:[1,0,1]
v_pk_mul_f32 v[104:105], v[104:105], v[232:233] op_sel:[0,1] op_sel_hi:[1,1]
v_cvt_pk_bf16_f32 v196, v104, v105
v_pk_fma_f32 v[106:107], v[38:39], v[232:233], v[106:107] op_sel_hi:[1,0,1]
v_pk_mul_f32 v[106:107], v[106:107], v[232:233] op_sel:[0,1] op_sel_hi:[1,1]
v_cvt_pk_bf16_f32 v197, v106, v107
s_waitcnt lgkmcnt(6)
v_pk_fma_f32 v[120:121], v[40:41], v[232:233], v[120:121] op_sel_hi:[1,0,1]
v_pk_mul_f32 v[120:121], v[120:121], v[232:233] op_sel:[0,1] op_sel_hi:[1,1]
v_cvt_pk_bf16_f32 v198, v120, v121
v_pk_fma_f32 v[122:123], v[42:43], v[232:233], v[122:123] op_sel_hi:[1,0,1]
v_pk_mul_f32 v[122:123], v[122:123], v[232:233] op_sel:[0,1] op_sel_hi:[1,1]
v_cvt_pk_bf16_f32 v199, v122, v123
ds_write_b128 v8, v[196:199]
s_waitcnt lgkmcnt(4)
v_pk_fma_f32 v[136:137], v[240:241], v[44:45], v[136:137] op_sel_hi:[1,0,1]
v_pk_fma_f32 v[138:139], v[242:243], v[44:45], v[138:139] op_sel_hi:[1,0,1]
s_waitcnt lgkmcnt(3)
v_pk_mul_f32 v[136:137], v[136:137], v[244:245]
v_cvt_pk_bf16_f32 v208, v136, v137
v_pk_mul_f32 v[138:139], v[138:139], v[246:247]
v_cvt_pk_bf16_f32 v209, v138, v139
v_pk_fma_f32 v[152:153], v[240:241], v[44:45], v[152:153] op_sel:[0,1,0] op_sel_hi:[1,1,1]
v_pk_mul_f32 v[152:153], v[152:153], v[244:245]
v_cvt_pk_bf16_f32 v218, v152, v153
v_pk_fma_f32 v[154:155], v[242:243], v[44:45], v[154:155] op_sel:[0,1,0] op_sel_hi:[1,1,1]
v_pk_mul_f32 v[154:155], v[154:155], v[246:247]
v_cvt_pk_bf16_f32 v219, v154, v155
ds_write_b64 v8, v[208:209] offset:1024
ds_write_b64 v8, v[218:219] offset:1032
v_pk_fma_f32 v[156:157], v[36:37], v[236:237], v[156:157] op_sel_hi:[1,0,1]
v_pk_mul_f32 v[156:157], v[156:157], v[236:237] op_sel:[0,1] op_sel_hi:[1,1]
v_cvt_pk_bf16_f32 v180, v156, v157
v_pk_fma_f32 v[158:159], v[38:39], v[236:237], v[158:159] op_sel_hi:[1,0,1]
v_pk_mul_f32 v[158:159], v[158:159], v[236:237] op_sel:[0,1] op_sel_hi:[1,1]
v_cvt_pk_bf16_f32 v181, v158, v159
v_pk_fma_f32 v[160:161], v[40:41], v[236:237], v[160:161] op_sel_hi:[1,0,1]
v_pk_mul_f32 v[160:161], v[160:161], v[236:237] op_sel:[0,1] op_sel_hi:[1,1]
v_cvt_pk_bf16_f32 v182, v160, v161
v_pk_fma_f32 v[162:163], v[42:43], v[236:237], v[162:163] op_sel_hi:[1,0,1]
v_pk_mul_f32 v[162:163], v[162:163], v[236:237] op_sel:[0,1] op_sel_hi:[1,1]
v_cvt_pk_bf16_f32 v183, v162, v163
v_pk_fma_f32 v[100:101], v[36:37], v[228:229], v[100:101] op_sel_hi:[1,0,1]
v_pk_mul_f32 v[100:101], v[100:101], v[228:229] op_sel:[0,1] op_sel_hi:[1,1]
v_cvt_pk_bf16_f32 v192, v100, v101
v_pk_fma_f32 v[102:103], v[38:39], v[228:229], v[102:103] op_sel_hi:[1,0,1]
v_pk_mul_f32 v[102:103], v[102:103], v[228:229] op_sel:[0,1] op_sel_hi:[1,1]
v_cvt_pk_bf16_f32 v193, v102, v103
v_pk_fma_f32 v[116:117], v[40:41], v[228:229], v[116:117] op_sel_hi:[1,0,1]
v_pk_mul_f32 v[116:117], v[116:117], v[228:229] op_sel:[0,1] op_sel_hi:[1,1]
v_cvt_pk_bf16_f32 v194, v116, v117
v_pk_fma_f32 v[118:119], v[42:43], v[228:229], v[118:119] op_sel_hi:[1,0,1]
v_pk_mul_f32 v[118:119], v[118:119], v[228:229] op_sel:[0,1] op_sel_hi:[1,1]
s_waitcnt lgkmcnt(0)
s_barrier
v_cvt_pk_bf16_f32 v195, v118, v119
v_pk_fma_f32 v[96:97], v[36:37], v[224:225], v[96:97] op_sel_hi:[1,0,1]
v_pk_mul_f32 v[96:97], v[96:97], v[224:225] op_sel:[0,1] op_sel_hi:[1,1]
v_cvt_pk_bf16_f32 v188, v96, v97
v_pk_fma_f32 v[98:99], v[38:39], v[224:225], v[98:99] op_sel_hi:[1,0,1]
v_pk_mul_f32 v[98:99], v[98:99], v[224:225] op_sel:[0,1] op_sel_hi:[1,1]
v_cvt_pk_bf16_f32 v189, v98, v99
v_pk_fma_f32 v[112:113], v[40:41], v[224:225], v[112:113] op_sel_hi:[1,0,1]
v_pk_mul_f32 v[112:113], v[112:113], v[224:225] op_sel:[0,1] op_sel_hi:[1,1]
v_cvt_pk_bf16_f32 v190, v112, v113
v_pk_fma_f32 v[114:115], v[42:43], v[224:225], v[114:115] op_sel_hi:[1,0,1]
v_pk_mul_f32 v[114:115], v[114:115], v[224:225] op_sel:[0,1] op_sel_hi:[1,1]
v_cvt_pk_bf16_f32 v191, v114, v115
v_pk_fma_f32 v[92:93], v[36:37], v[220:221], v[92:93] op_sel_hi:[1,0,1]
v_pk_mul_f32 v[92:93], v[92:93], v[220:221] op_sel:[0,1] op_sel_hi:[1,1]
v_cvt_pk_bf16_f32 v184, v92, v93
v_pk_fma_f32 v[94:95], v[38:39], v[220:221], v[94:95] op_sel_hi:[1,0,1]
v_pk_mul_f32 v[94:95], v[94:95], v[220:221] op_sel:[0,1] op_sel_hi:[1,1]
v_cvt_pk_bf16_f32 v185, v94, v95
v_pk_fma_f32 v[108:109], v[40:41], v[220:221], v[108:109] op_sel_hi:[1,0,1]
v_pk_mul_f32 v[108:109], v[108:109], v[220:221] op_sel:[0,1] op_sel_hi:[1,1]
v_cvt_pk_bf16_f32 v186, v108, v109
v_pk_fma_f32 v[110:111], v[42:43], v[220:221], v[110:111] op_sel_hi:[1,0,1]
v_pk_mul_f32 v[110:111], v[110:111], v[220:221] op_sel:[0,1] op_sel_hi:[1,1]
v_cvt_pk_bf16_f32 v187, v110, v111
v_cvt_pk_bf16_f32 v179, v90, v91
v_pk_fma_f32 v[68:69], v[28:29], v[228:229], v[68:69] op_sel_hi:[1,0,1]
v_cvt_pk_bf16_f32 v172, v68, v69
v_pk_fma_f32 v[70:71], v[30:31], v[228:229], v[70:71] op_sel_hi:[1,0,1]
v_cvt_pk_bf16_f32 v173, v70, v71
v_pk_fma_f32 v[84:85], v[32:33], v[228:229], v[84:85] op_sel_hi:[1,0,1]
v_cvt_pk_bf16_f32 v174, v84, v85
v_pk_fma_f32 v[86:87], v[34:35], v[228:229], v[86:87] op_sel_hi:[1,0,1]
v_cvt_pk_bf16_f32 v175, v86, v87
v_pk_fma_f32 v[64:65], v[28:29], v[224:225], v[64:65] op_sel_hi:[1,0,1]
v_cvt_pk_bf16_f32 v168, v64, v65
v_pk_fma_f32 v[66:67], v[30:31], v[224:225], v[66:67] op_sel_hi:[1,0,1]
v_cvt_pk_bf16_f32 v169, v66, v67
v_pk_fma_f32 v[80:81], v[32:33], v[224:225], v[80:81] op_sel_hi:[1,0,1]
v_cvt_pk_bf16_f32 v170, v80, v81
v_pk_fma_f32 v[82:83], v[34:35], v[224:225], v[82:83] op_sel_hi:[1,0,1]
v_cvt_pk_bf16_f32 v171, v82, v83
v_pk_fma_f32 v[60:61], v[28:29], v[220:221], v[60:61] op_sel_hi:[1,0,1]
v_cvt_pk_bf16_f32 v164, v60, v61
v_pk_fma_f32 v[62:63], v[30:31], v[220:221], v[62:63] op_sel_hi:[1,0,1]
v_cvt_pk_bf16_f32 v165, v62, v63
v_pk_fma_f32 v[76:77], v[32:33], v[220:221], v[76:77] op_sel_hi:[1,0,1]
v_cvt_pk_bf16_f32 v166, v76, v77
v_pk_fma_f32 v[78:79], v[34:35], v[220:221], v[78:79] op_sel_hi:[1,0,1]
v_cvt_pk_bf16_f32 v167, v78, v79
s_nop 0
v_mfma_f32_16x16x32_bf16 v[120:123], v[196:199], v[176:179], v[50:53]
buffer_load_dwordx4 v6, s[24:27], s58 offen offset:1024 lds
v_mfma_f32_16x16x32_bf16 v[104:107], v[192:195], v[176:179], v[46:49]
ds_read_b64 v[200:201], v9 offset:1024
s_add_u32 m0, s59, 58240
v_mfma_f32_16x16x32_bf16 v[116:119], v[192:195], v[172:175], v[50:53]
ds_read_b64 v[210:211], v9 offset:1032
s_xor_b32 s58, s87, 1966080
v_mfma_f32_16x16x32_bf16 v[100:103], v[188:191], v[172:175], v[46:49]
ds_read_b128 v[240:243], v11 offset:64
v_mfma_f32_16x16x32_bf16 v[112:115], v[188:191], v[168:171], v[50:53]
buffer_load_dwordx4 v5, s[24:27], s58 offen lds
v_mfma_f32_16x16x32_bf16 v[96:99], v[184:187], v[168:171], v[46:49]
ds_read_b128 v[244:247], v11 offset:1088
v_max3_f32 v88, v104, v105, v106
v_mfma_f32_16x16x32_bf16 v[108:111], v[184:187], v[164:167], v[50:53]
ds_read_b128 v[28:31], v11
v_max3_f32 v89, v107, v120, v121
v_mfma_f32_16x16x32_bf16 v[92:95], v[180:183], v[164:167], v[54:57]
ds_read_b128 v[32:35], v11 offset:1024
v_max3_f32 v88, v88, v122, v123
MAA 132,8,96
buffer_load_dwordx4 v6, s[24:27], s58 offen offset:1024 lds
MAA 132,28,100
s_add_u32 m0, s59, 66560
s_xor_b32 s58, s87, 0
v_max_f32 v90, v88, v89
MAA 132,48,160
v_max_f32 v89, v88, v89
v_max3_f32 v84, v100, v101, v102
MAA 132,68,164
v_permlane16_swap_b32 v90, v89
MAA 148,68,172
buffer_load_dwordx4 v5, s[24:27], s58 offen lds
MAA 148,48,168
v_max_f32 v88, v90, v89
v_max_f32 v89, v90, v89
MAA 148,28,124
s_nop 0
v_permlane32_swap_b32 v88, v89
MAA 148,8,120
v_max_f32 v88, v88, v89
v_mul_f32 v88, v88, v234
v_max3_f32 v85, v103, v116, v117
v_max3_f32 v84, v84, v118, v119
v_max_f32 v86, v84, v85
v_max_f32 v85, v84, v85
v_max3_f32 v80, v96, v97, v98
v_max3_f32 v81, v99, v112, v113
v_permlane16_swap_b32 v86, v85
v_max3_f32 v80, v80, v114, v115
v_max_f32 v84, v86, v85
v_max_f32 v85, v86, v85
v_max_f32 v82, v80, v81
v_max_f32 v81, v80, v81
v_permlane32_swap_b32 v84, v85
v_max3_f32 v76, v92, v93, v94
v_max_f32 v84, v84, v85
v_mul_f32 v84, v84, v230
v_permlane16_swap_b32 v82, v81
v_max3_f32 v77, v95, v108, v109
v_max_f32 v80, v82, v81
v_max_f32 v81, v82, v81
v_max3_f32 v76, v76, v110, v111
v_max_f32 v78, v76, v77
v_permlane32_swap_b32 v80, v81
v_max_f32 v77, v76, v77
v_max_f32 v80, v80, v81
v_mul_f32 v80, v80, v226
v_permlane16_swap_b32 v78, v77
v_pk_fma_f32 v[104:105], v[104:105], v[234:235], v[88:89] op_sel_hi:[1,0,0] neg_lo:[0,0,1] neg_hi:[0,0,1]
v_max_f32 v76, v78, v77
v_max_f32 v77, v78, v77
v_pk_fma_f32 v[106:107], v[106:107], v[234:235], v[88:89] op_sel_hi:[1,0,0] neg_lo:[0,0,1] neg_hi:[0,0,1]
v_pk_fma_f32 v[120:121], v[120:121], v[234:235], v[88:89] op_sel_hi:[1,0,0] neg_lo:[0,0,1] neg_hi:[0,0,1]
v_permlane32_swap_b32 v76, v77
v_pk_fma_f32 v[122:123], v[122:123], v[234:235], v[88:89] op_sel_hi:[1,0,0] neg_lo:[0,0,1] neg_hi:[0,0,1]
v_max_f32 v76, v76, v77
v_mul_f32 v76, v76, v222
v_pk_fma_f32 v[100:101], v[100:101], v[230:231], v[84:85] op_sel_hi:[1,0,0] neg_lo:[0,0,1] neg_hi:[0,0,1]
v_pk_fma_f32 v[102:103], v[102:103], v[230:231], v[84:85] op_sel_hi:[1,0,0] neg_lo:[0,0,1] neg_hi:[0,0,1]
v_pk_fma_f32 v[116:117], v[116:117], v[230:231], v[84:85] op_sel_hi:[1,0,0] neg_lo:[0,0,1] neg_hi:[0,0,1]
v_pk_fma_f32 v[118:119], v[118:119], v[230:231], v[84:85] op_sel_hi:[1,0,0] neg_lo:[0,0,1] neg_hi:[0,0,1]
v_pk_fma_f32 v[96:97], v[96:97], v[226:227], v[80:81] op_sel_hi:[1,0,0] neg_lo:[0,0,1] neg_hi:[0,0,1]
v_pk_fma_f32 v[98:99], v[98:99], v[226:227], v[80:81] op_sel_hi:[1,0,0] neg_lo:[0,0,1] neg_hi:[0,0,1]
v_pk_fma_f32 v[112:113], v[112:113], v[226:227], v[80:81] op_sel_hi:[1,0,0] neg_lo:[0,0,1] neg_hi:[0,0,1]
v_pk_fma_f32 v[114:115], v[114:115], v[226:227], v[80:81] op_sel_hi:[1,0,0] neg_lo:[0,0,1] neg_hi:[0,0,1]
v_pk_fma_f32 v[92:93], v[92:93], v[222:223], v[76:77] op_sel_hi:[1,0,0] neg_lo:[0,0,1] neg_hi:[0,0,1]
v_pk_fma_f32 v[94:95], v[94:95], v[222:223], v[76:77] op_sel_hi:[1,0,0] neg_lo:[0,0,1] neg_hi:[0,0,1]
v_pk_fma_f32 v[108:109], v[108:109], v[222:223], v[76:77] op_sel_hi:[1,0,0] neg_lo:[0,0,1] neg_hi:[0,0,1]
v_pk_fma_f32 v[110:111], v[110:111], v[222:223], v[76:77] op_sel_hi:[1,0,0] neg_lo:[0,0,1] neg_hi:[0,0,1]
v_pk_fma_f32 v[132:133], v[18:19], v[44:45], v[132:133] op_sel_hi:[1,0,1]
v_pk_mul_f32 v[132:133], v[132:133], v[22:23]
v_pk_fma_f32 v[134:135], v[20:21], v[44:45], v[134:135] op_sel_hi:[1,0,1]
v_pk_mul_f32 v[134:135], v[134:135], v[24:25]
v_pk_fma_f32 v[148:149], v[18:19], v[44:45], v[148:149] op_sel:[0,1,0] op_sel_hi:[1,1,1]
v_pk_mul_f32 v[148:149], v[148:149], v[22:23]
v_pk_fma_f32 v[150:151], v[20:21], v[44:45], v[150:151] op_sel:[0,1,0] op_sel_hi:[1,1,1]
v_pk_mul_f32 v[150:151], v[150:151], v[24:25]
v_exp_f32 v104, v104
s_nop 0
MAA 128,4,96
buffer_load_dwordx4 v6, s[24:27], s58 offen offset:1024 lds
MAA 128,24,100
s_add_u32 m0, s59, 116480
s_xor_b32 s58, s87, 786432
v_exp_f32 v105, v105
MAA 128,44,160
v_exp_f32 v106, v106
MAA 128,64,164
v_exp_f32 v107, v107
MAA 144,64,172
buffer_load_dwordx4 v5, s[24:27], s58 offen lds
MAA 144,44,168
v_exp_f32 v120, v120
MAA 144,24,124
v_exp_f32 v121, v121
MAA 144,4,120
v_exp_f32 v122, v122
MAA 124,0,96
buffer_load_dwordx4 v6, s[24:27], s58 offen offset:1024 lds
MAA 124,20,100
s_add_u32 m0, s59, 124800
s_xor_b32 s58, s87, 917504
v_exp_f32 v123, v123
MAA 124,40,160
v_exp_f32 v100, v100
MAA 124,60,164
v_exp_f32 v101, v101
MAA 140,60,172
buffer_load_dwordx4 v5, s[24:27], s58 offen lds
MAA 140,40,168
v_exp_f32 v102, v102
MAA 140,20,124
v_exp_f32 v103, v103
MAA 140,0,120
v_cvt_pk_bf16_f32 v72, v104, v105
v_cvt_pk_bf16_f32 v73, v106, v107
v_cvt_pk_bf16_f32 v74, v120, v121
v_cvt_pk_bf16_f32 v75, v122, v123
v_exp_f32 v116, v116
v_exp_f32 v117, v117
v_exp_f32 v118, v118
v_exp_f32 v119, v119
v_cvt_pk_bf16_f32 v68, v100, v101
v_cvt_pk_bf16_f32 v69, v102, v103
v_cvt_pk_bf16_f32 v70, v116, v117
v_cvt_pk_bf16_f32 v71, v118, v119
v_exp_f32 v96, v96
v_exp_f32 v97, v97
v_exp_f32 v98, v98
v_exp_f32 v99, v99
v_exp_f32 v112, v112
v_exp_f32 v113, v113
v_exp_f32 v114, v114
v_exp_f32 v115, v115
v_cvt_pk_bf16_f32 v64, v96, v97
v_cvt_pk_bf16_f32 v65, v98, v99
v_cvt_pk_bf16_f32 v66, v112, v113
v_cvt_pk_bf16_f32 v67, v114, v115
v_cvt_pk_bf16_f32 v206, v132, v133
v_cvt_pk_bf16_f32 v207, v134, v135
v_cvt_pk_bf16_f32 v216, v148, v149
v_cvt_pk_bf16_f32 v217, v150, v151
s_waitcnt lgkmcnt(3)
v_pk_fma_f32 v[128:129], v[240:241], v[44:45], v[128:129] op_sel_hi:[1,0,1]
s_waitcnt lgkmcnt(2)
v_pk_mul_f32 v[128:129], v[128:129], v[244:245]
v_cvt_pk_bf16_f32 v204, v128, v129
v_pk_fma_f32 v[130:131], v[242:243], v[44:45], v[130:131] op_sel_hi:[1,0,1]
v_pk_mul_f32 v[130:131], v[130:131], v[246:247]
v_cvt_pk_bf16_f32 v205, v130, v131
v_pk_fma_f32 v[144:145], v[240:241], v[44:45], v[144:145] op_sel:[0,1,0] op_sel_hi:[1,1,1]
v_pk_mul_f32 v[144:145], v[144:145], v[244:245]
v_cvt_pk_bf16_f32 v214, v144, v145
v_pk_fma_f32 v[146:147], v[242:243], v[44:45], v[146:147] op_sel:[0,1,0] op_sel_hi:[1,1,1]
v_pk_mul_f32 v[146:147], v[146:147], v[246:247]
v_cvt_pk_bf16_f32 v215, v146, v147
s_waitcnt lgkmcnt(1)
v_pk_fma_f32 v[124:125], v[28:29], v[44:45], v[124:125] op_sel_hi:[1,0,1]
s_waitcnt lgkmcnt(0)
v_pk_mul_f32 v[124:125], v[124:125], v[32:33]
v_cvt_pk_bf16_f32 v202, v124, v125
v_pk_fma_f32 v[126:127], v[30:31], v[44:45], v[126:127] op_sel_hi:[1,0,1]
v_pk_mul_f32 v[126:127], v[126:127], v[34:35]
v_cvt_pk_bf16_f32 v203, v126, v127
v_pk_fma_f32 v[140:141], v[28:29], v[44:45], v[140:141] op_sel:[0,1,0] op_sel_hi:[1,1,1]
v_pk_mul_f32 v[140:141], v[140:141], v[32:33]
v_cvt_pk_bf16_f32 v212, v140, v141
v_pk_fma_f32 v[142:143], v[30:31], v[44:45], v[142:143] op_sel:[0,1,0] op_sel_hi:[1,1,1]
v_pk_mul_f32 v[142:143], v[142:143], v[34:35]
v_cvt_pk_bf16_f32 v213, v142, v143
s_nop 0
v_mfma_f32_16x16x32_bf16 v[88:91], v[248:251], v[72:75], 0
buffer_load_dwordx4 v6, s[24:27], s58 offen offset:1024 lds
v_mfma_f32_16x16x32_bf16 v[104:107], v[206:209], v[72:75], 0
v_exp_f32 v92, v92
v_mfma_f32_16x16x32_bf16 v[120:123], v[216:219], v[72:75], 0
v_exp_f32 v93, v93
v_mfma_f32_16x16x32_bf16 v[84:87], v[248:251], v[68:71], 0
v_exp_f32 v94, v94
v_mfma_f32_16x16x32_bf16 v[100:103], v[204:207], v[68:71], 0
v_exp_f32 v95, v95
v_mfma_f32_16x16x32_bf16 v[116:119], v[214:217], v[68:71], 0
v_exp_f32 v108, v108
v_mfma_f32_16x16x32_bf16 v[80:83], v[248:251], v[64:67], 0
v_exp_f32 v109, v109
v_mfma_f32_16x16x32_bf16 v[96:99], v[202:205], v[64:67], 0
v_exp_f32 v110, v110
v_mfma_f32_16x16x32_bf16 v[112:115], v[212:215], v[64:67], 0
v_exp_f32 v111, v111
v_cvt_pk_bf16_f32 v60, v92, v93
v_cvt_pk_bf16_f32 v61, v94, v95
v_cvt_pk_bf16_f32 v62, v108, v109
v_cvt_pk_bf16_f32 v63, v110, v111
v_rcp_f32 v88, v88
v_rcp_f32 v84, v84
v_mfma_f32_16x16x32_bf16 v[76:79], v[248:251], v[60:63], 0
v_rcp_f32 v80, v80
v_mfma_f32_16x16x32_bf16 v[92:95], v[200:203], v[60:63], 0
v_mfma_f32_16x16x32_bf16 v[108:111], v[210:213], v[60:63], 0
s_nop 4
v_rcp_f32 v76, v76
v_pk_mul_f32 v[104:105], v[104:105], v[88:89] op_sel_hi:[1,0]
v_pk_mul_f32 v[106:107], v[106:107], v[88:89] op_sel_hi:[1,0]
v_pk_mul_f32 v[120:121], v[120:121], v[88:89] op_sel_hi:[1,0]
v_pk_mul_f32 v[122:123], v[122:123], v[88:89] op_sel_hi:[1,0]
v_cvt_pk_bf16_f32 v176, v104, v105
v_cvt_pk_bf16_f32 v177, v106, v107
v_cvt_pk_bf16_f32 v178, v120, v121
v_cvt_pk_bf16_f32 v179, v122, v123
buffer_store_dwordx4 v[176:179], v4, s[16:19], s74 offen offset:3072 sc1
v_pk_mul_f32 v[100:101], v[100:101], v[84:85] op_sel_hi:[1,0]
v_pk_mul_f32 v[102:103], v[102:103], v[84:85] op_sel_hi:[1,0]
v_pk_mul_f32 v[116:117], v[116:117], v[84:85] op_sel_hi:[1,0]
v_pk_mul_f32 v[118:119], v[118:119], v[84:85] op_sel_hi:[1,0]
v_cvt_pk_bf16_f32 v172, v100, v101
v_cvt_pk_bf16_f32 v173, v102, v103
v_cvt_pk_bf16_f32 v174, v116, v117
v_cvt_pk_bf16_f32 v175, v118, v119
buffer_store_dwordx4 v[172:175], v4, s[16:19], s74 offen offset:2048 sc1
v_pk_mul_f32 v[96:97], v[96:97], v[80:81] op_sel_hi:[1,0]
v_pk_mul_f32 v[98:99], v[98:99], v[80:81] op_sel_hi:[1,0]
v_pk_mul_f32 v[112:113], v[112:113], v[80:81] op_sel_hi:[1,0]
v_pk_mul_f32 v[114:115], v[114:115], v[80:81] op_sel_hi:[1,0]
v_cvt_pk_bf16_f32 v168, v96, v97
v_cvt_pk_bf16_f32 v169, v98, v99
v_cvt_pk_bf16_f32 v170, v112, v113
v_cvt_pk_bf16_f32 v171, v114, v115
buffer_store_dwordx4 v[168:171], v4, s[16:19], s74 offen offset:1024 sc1
v_pk_mul_f32 v[92:93], v[92:93], v[76:77] op_sel_hi:[1,0]
v_pk_mul_f32 v[94:95], v[94:95], v[76:77] op_sel_hi:[1,0]
v_pk_mul_f32 v[108:109], v[108:109], v[76:77] op_sel_hi:[1,0]
v_pk_mul_f32 v[110:111], v[110:111], v[76:77] op_sel_hi:[1,0]
v_cvt_pk_bf16_f32 v164, v92, v93
v_cvt_pk_bf16_f32 v165, v94, v95
v_cvt_pk_bf16_f32 v166, v108, v109
v_cvt_pk_bf16_f32 v167, v110, v111
buffer_store_dwordx4 v[164:167], v4, s[16:19], s74 offen sc1
s_nop 1
s_branch .Lqkve2
.Lx4:
buffer_load_dword v27, v14, s[76:79], 0 offen
s_mov_b32 s76, s98
s_mov_b32 s77, s99
s_mov_b32 s78, s100
v_mov_b32 v14, v15
s_mov_b32 s47, 5
s_branch .Lx4b
.Lx5:
buffer_load_dword v27, v14, s[76:79], 0 offen
s_mov_b32 s76, s98
s_mov_b32 s77, s99
s_mov_b32 s78, s100
v_mov_b32 v14, v15
s_mov_b32 s47, 5
s_branch .Lx5b
.Lx6:
buffer_load_dword v27, v14, s[76:79], 0 offen
s_mov_b32 s76, s98
s_mov_b32 s77, s99
s_mov_b32 s78, s100
v_mov_b32 v14, v15
s_mov_b32 s47, 5
s_branch .Lx6b
.Lx7:
buffer_load_dword v27, v14, s[76:79], 0 offen
s_mov_b32 s76, s98
s_mov_b32 s77, s99
s_mov_b32 s78, s100
v_mov_b32 v14, v15
s_mov_b32 s47, 5
s_branch .Lx7b
.Lsp8:
s_mov_b32 s15, 0
.Lsp8l:
v_mov_b32 v37, 0
buffer_atomic_add v37, v34, s[40:43], 0 offen sc0
s_add_u32 s15, s15, 1
s_cmp_gt_u32 s15, 100000
s_waitcnt vmcnt(0)
s_cbranch_scc1 .Lsp8b
v_cmp_gt_u32 vcc, v35, v37
s_nop 0
s_cbranch_vccnz .Lsp8l
s_branch .Lsp8b
.Lx9:
buffer_load_dword v27, v14, s[76:79], 0 offen
s_mov_b32 s76, s98
s_mov_b32 s77, s99
s_mov_b32 s78, s100
v_mov_b32 v14, v15
s_mov_b32 s47, 5
s_branch .Lx9b
.Lx10:
buffer_load_dword v27, v14, s[76:79], 0 offen
s_mov_b32 s76, s98
s_mov_b32 s77, s99
s_mov_b32 s78, s100
v_mov_b32 v14, v15
s_mov_b32 s47, 5
s_branch .Lx10b
.Lx11:
buffer_load_dword v27, v14, s[76:79], 0 offen
s_mov_b32 s76, s98
s_mov_b32 s77, s99
s_mov_b32 s78, s100
v_mov_b32 v14, v15
s_mov_b32 s47, 5
s_branch .Lx11b
.Lx12:
buffer_load_dword v27, v14, s[76:79], 0 offen
s_mov_b32 s76, s98
s_mov_b32 s77, s99
s_mov_b32 s78, s100
v_mov_b32 v14, v15
s_mov_b32 s47, 5
s_branch .Lx12b
.Lsp13:
s_mov_b32 s15, 0
.Lsp13l:
v_mov_b32 v37, 0
buffer_atomic_add v37, v33, s[16:19], 0 offen sc0
s_add_u32 s15, s15, 1
s_cmp_gt_u32 s15, 100000
s_waitcnt vmcnt(0)
s_cbranch_scc1 .Lsp13b
v_cmp_gt_u32 vcc, v36, v37
s_nop 0
s_cbranch_vccnz .Lsp13l
s_branch .Lsp13b
.Lx14:
buffer_load_dword v27, v14, s[76:79], 0 offen
s_mov_b32 s76, s98
s_mov_b32 s77, s99
s_mov_b32 s78, s100
v_mov_b32 v14, v15
s_mov_b32 s47, 5
s_branch .Lx14b
.Lx15:
buffer_load_dword v27, v14, s[76:79], 0 offen
s_mov_b32 s76, s98
s_mov_b32 s77, s99
s_mov_b32 s78, s100
v_mov_b32 v14, v15
s_mov_b32 s47, 5
s_branch .Lx15b
.Lx16:
buffer_load_dword v27, v14, s[76:79], 0 offen
s_mov_b32 s76, s98
s_mov_b32 s77, s99
s_mov_b32 s78, s100
v_mov_b32 v14, v15
s_mov_b32 s47, 5
s_branch .Lx16b
.Lx17:
buffer_load_dword v27, v14, s[76:79], 0 offen
s_mov_b32 s76, s98
s_mov_b32 s77, s99
s_mov_b32 s78, s100
v_mov_b32 v14, v15
s_mov_b32 s47, 5
s_branch .Lx17b
.Lx19:
buffer_load_dword v27, v14, s[76:79], 0 offen
s_mov_b32 s76, s98
s_mov_b32 s77, s99
s_mov_b32 s78, s100
v_mov_b32 v14, v15
s_mov_b32 s47, 5
s_branch .Lx19b
.Lx20:
buffer_load_dword v27, v14, s[76:79], 0 offen
s_mov_b32 s76, s98
s_mov_b32 s77, s99
s_mov_b32 s78, s100
v_mov_b32 v14, v15
s_mov_b32 s47, 5
s_branch .Lx20b
.Lx21:
buffer_load_dword v27, v14, s[76:79], 0 offen
s_mov_b32 s76, s98
s_mov_b32 s77, s99
s_mov_b32 s78, s100
v_mov_b32 v14, v15
s_mov_b32 s47, 5
s_branch .Lx21b
.Lx22:
buffer_load_dword v27, v14, s[76:79], 0 offen
s_mov_b32 s76, s98
s_mov_b32 s77, s99
s_mov_b32 s78, s100
v_mov_b32 v14, v15
s_mov_b32 s47, 5
s_branch .Lx22b
.Lsp23:
s_mov_b32 s15, 0
.Lsp23l:
v_mov_b32 v37, 0
buffer_atomic_add v37, v34, s[40:43], 0 offen sc0
s_add_u32 s15, s15, 1
s_cmp_gt_u32 s15, 100000
s_waitcnt vmcnt(0)
s_cbranch_scc1 .Lsp23b
v_cmp_gt_u32 vcc, v35, v37
s_nop 0
s_cbranch_vccnz .Lsp23l
s_branch .Lsp23b
.Lx24:
buffer_load_dword v27, v14, s[76:79], 0 offen
s_mov_b32 s76, s98
s_mov_b32 s77, s99
s_mov_b32 s78, s100
v_mov_b32 v14, v15
s_mov_b32 s47, 5
s_branch .Lx24b
.Lx25:
buffer_load_dword v27, v14, s[76:79], 0 offen
s_mov_b32 s76, s98
s_mov_b32 s77, s99
s_mov_b32 s78, s100
v_mov_b32 v14, v15
s_mov_b32 s47, 5
s_branch .Lx25b
.Lx26:
buffer_load_dword v27, v14, s[76:79], 0 offen
s_mov_b32 s76, s98
s_mov_b32 s77, s99
s_mov_b32 s78, s100
v_mov_b32 v14, v15
s_mov_b32 s47, 5
s_branch .Lx26b
.Lx27:
buffer_load_dword v27, v14, s[76:79], 0 offen
s_mov_b32 s76, s98
s_mov_b32 s77, s99
s_mov_b32 s78, s100
v_mov_b32 v14, v15
s_mov_b32 s47, 5
s_branch .Lx27b
.Lsp28:
s_mov_b32 s15, 0
.Lsp28l:
v_mov_b32 v37, 0
buffer_atomic_add v37, v33, s[16:19], 0 offen sc0
s_add_u32 s15, s15, 1
s_cmp_gt_u32 s15, 100000
s_waitcnt vmcnt(0)
s_cbranch_scc1 .Lsp28b
v_cmp_gt_u32 vcc, v36, v37
s_nop 0
s_cbranch_vccnz .Lsp28l
s_branch .Lsp28b
.Lx29:
buffer_load_dword v27, v14, s[76:79], 0 offen
s_mov_b32 s76, s98
s_mov_b32 s77, s99
s_mov_b32 s78, s100
v_mov_b32 v14, v15
s_mov_b32 s47, 5
s_branch .Lx29b
.Lx30:
buffer_load_dword v27, v14, s[76:79], 0 offen
s_mov_b32 s76, s98
s_mov_b32 s77, s99
s_mov_b32 s78, s100
v_mov_b32 v14, v15
s_mov_b32 s47, 5
s_branch .Lx30b
.Lx31:
buffer_load_dword v27, v14, s[76:79], 0 offen
s_mov_b32 s76, s98
s_mov_b32 s77, s99
s_mov_b32 s78, s100
v_mov_b32 v14, v15
s_mov_b32 s47, 5
s_branch .Lx31b
.Lx32:
buffer_load_dword v27, v14, s[76:79], 0 offen
s_mov_b32 s76, s98
s_mov_b32 s77, s99
s_mov_b32 s78, s100
v_mov_b32 v14, v15
s_mov_b32 s47, 5
s_branch .Lx32b
.Lqkv1:
s_cmp_lt_u32 s14, 16
s_cselect_b32 s62, 0, 4096
v_mov_b32 v231, 1
v_lshlrev_b32 v232, 8, v1
s_waitcnt vmcnt(18)
v_permlane16_swap_b32 v164, v166
v_permlane16_swap_b32 v165, v167
s_waitcnt vmcnt(17)
v_permlane16_swap_b32 v168, v170
v_permlane16_swap_b32 v169, v171
s_waitcnt vmcnt(16)
v_permlane16_swap_b32 v172, v174
v_permlane16_swap_b32 v173, v175
s_waitcnt vmcnt(15)
v_permlane16_swap_b32 v176, v178
v_permlane16_swap_b32 v177, v179
buffer_atomic_add v231, v232, s[40:43], s62 offen
v_lshlrev_b32 v192, 16, v164
v_and_b32 v193, 0xffff0000, v164
v_lshlrev_b32 v194, 16, v165
v_and_b32 v195, 0xffff0000, v165
v_lshlrev_b32 v196, 16, v166
v_and_b32 v197, 0xffff0000, v166
v_lshlrev_b32 v198, 16, v167
v_and_b32 v199, 0xffff0000, v167
v_lshlrev_b32 v200, 16, v168
v_and_b32 v201, 0xffff0000, v168
v_lshlrev_b32 v202, 16, v169
v_and_b32 v203, 0xffff0000, v169
v_lshlrev_b32 v204, 16, v170
v_and_b32 v205, 0xffff0000, v170
v_lshlrev_b32 v206, 16, v171
v_and_b32 v207, 0xffff0000, v171
v_lshlrev_b32 v208, 16, v172
v_and_b32 v209, 0xffff0000, v172
v_lshlrev_b32 v210, 16, v173
v_and_b32 v211, 0xffff0000, v173
v_lshlrev_b32 v212, 16, v174
v_and_b32 v213, 0xffff0000, v174
v_lshlrev_b32 v214, 16, v175
v_and_b32 v215, 0xffff0000, v175
v_lshlrev_b32 v216, 16, v176
v_and_b32 v217, 0xffff0000, v176
v_lshlrev_b32 v218, 16, v177
v_and_b32 v219, 0xffff0000, v177
v_lshlrev_b32 v220, 16, v178
v_and_b32 v221, 0xffff0000, v178
v_lshlrev_b32 v222, 16, v179
v_and_b32 v223, 0xffff0000, v179
s_lshl_b32 s64, s6, 14
s_lshl_b32 s65, s49, 13
s_add_u32 s64, s64, s65
s_lshl_b32 s65, s7, 9
s_add_u32 s64, s64, s65
s_lshl_b32 s65, s48, 8
s_add_u32 s64, s64, s65
s_add_u32 s64, s64, 29360128
v_and_b32 v188, 31, v1
v_lshlrev_b32 v188, 3, v188
v_lshrrev_b32 v189, 5, v1
v_lshl_add_u32 v188, v189, 28, v188
s_lshl_b32 s62, s7, 18
s_add_u32 s62, s62, 0
s_add_u32 s63, s62, 131072
v_pk_mul_f32 v[182:183], v[192:193], v[192:193]
v_pk_mul_f32 v[186:187], v[208:209], v[208:209]
v_pk_fma_f32 v[182:183], v[194:195], v[194:195], v[182:183]
v_pk_add_f32 v[180:181], v[192:193], v[194:195]
v_pk_fma_f32 v[186:187], v[210:211], v[210:211], v[186:187]
v_pk_add_f32 v[184:185], v[208:209], v[210:211]
v_pk_fma_f32 v[182:183], v[196:197], v[196:197], v[182:183]
v_pk_add_f32 v[180:181], v[180:181], v[196:197]
v_pk_fma_f32 v[186:187], v[212:213], v[212:213], v[186:187]
v_pk_add_f32 v[184:185], v[184:185], v[212:213]
v_pk_fma_f32 v[182:183], v[198:199], v[198:199], v[182:183]
v_pk_add_f32 v[180:181], v[180:181], v[198:199]
v_pk_fma_f32 v[186:187], v[214:215], v[214:215], v[186:187]
v_pk_add_f32 v[184:185], v[184:185], v[214:215]
v_pk_fma_f32 v[182:183], v[200:201], v[200:201], v[182:183]
v_pk_add_f32 v[180:181], v[180:181], v[200:201]
v_pk_fma_f32 v[186:187], v[216:217], v[216:217], v[186:187]
v_pk_add_f32 v[184:185], v[184:185], v[216:217]
v_pk_fma_f32 v[182:183], v[202:203], v[202:203], v[182:183]
v_pk_add_f32 v[180:181], v[180:181], v[202:203]
v_pk_fma_f32 v[186:187], v[218:219], v[218:219], v[186:187]
v_pk_add_f32 v[184:185], v[184:185], v[218:219]
v_pk_fma_f32 v[182:183], v[204:205], v[204:205], v[182:183]
v_pk_add_f32 v[180:181], v[180:181], v[204:205]
v_pk_fma_f32 v[186:187], v[220:221], v[220:221], v[186:187]
v_pk_add_f32 v[184:185], v[184:185], v[220:221]
v_pk_fma_f32 v[182:183], v[206:207], v[206:207], v[182:183]
v_pk_add_f32 v[180:181], v[180:181], v[206:207]
v_pk_fma_f32 v[186:187], v[222:223], v[222:223], v[186:187]
v_pk_add_f32 v[184:185], v[184:185], v[222:223]
v_add_f32 v180, v180, v181
v_add_f32 v182, v182, v183
v_add_f32 v184, v184, v185
v_add_f32 v186, v186, v187
s_nop 0
v_permlane16_swap_b32 v180, v184
v_permlane16_swap_b32 v182, v186
v_add_f32 v180, v180, v184
v_add_f32 v182, v182, v186
s_nop 1
v_permlane32_swap_b32 v180, v182
v_add_f32 v180, v180, v182
s_nop 1
v_permlane32_swap_b32 v180, v181
buffer_store_dwordx2 v[180:181], v188, s[16:19], s64 offen sc1
s_lshl_b32 s62, s2, 10
s_add_u32 s62, s62, 31457280
s_cmp_eq_u32 s3, 0
s_cselect_b32 s62, s62, 268435456
buffer_store_dwordx4 v[224:227], v230, s[16:19], s62 offen sc1
v_accvgpr_write_b32 a224, v192
v_accvgpr_write_b32 a225, v193
v_accvgpr_write_b32 a226, v194
v_accvgpr_write_b32 a227, v195
v_accvgpr_write_b32 a228, v196
v_accvgpr_write_b32 a229, v197
v_accvgpr_write_b32 a230, v198
v_accvgpr_write_b32 a231, v199
v_accvgpr_write_b32 a232, v200
v_accvgpr_write_b32 a233, v201
v_accvgpr_write_b32 a234, v202
v_accvgpr_write_b32 a235, v203
v_accvgpr_write_b32 a236, v204
v_accvgpr_write_b32 a237, v205
v_accvgpr_write_b32 a238, v206
v_accvgpr_write_b32 a239, v207
v_accvgpr_write_b32 a240, v208
v_accvgpr_write_b32 a241, v209
v_accvgpr_write_b32 a242, v210
v_accvgpr_write_b32 a243, v211
v_accvgpr_write_b32 a244, v212
v_accvgpr_write_b32 a245, v213
v_accvgpr_write_b32 a246, v214
v_accvgpr_write_b32 a247, v215
v_accvgpr_write_b32 a248, v216
v_accvgpr_write_b32 a249, v217
v_accvgpr_write_b32 a250, v218
v_accvgpr_write_b32 a251, v219
v_accvgpr_write_b32 a252, v220
v_accvgpr_write_b32 a253, v221
v_accvgpr_write_b32 a254, v222
v_accvgpr_write_b32 a255, v223
s_add_u32 m0, s55, 18496
s_nop 0
buffer_load_dwordx4 v21, s[36:39], s52 offen lds
buffer_load_dwordx4 v28, s[36:39], s52 offen offset:1024 lds
buffer_load_dword v22, s[36:39], s52 offen offset:2048 lds
s_add_u32 s52, s52, 128
s_add_u32 m0, s55, 20800
s_nop 0
buffer_load_dwordx4 v21, s[36:39], s53 offen lds
buffer_load_dwordx4 v28, s[36:39], s53 offen offset:1024 lds
buffer_load_dword v29, s[36:39], s53 offen offset:2048 lds
s_add_u32 s53, s53, 128
s_add_u32 m0, s56, 73984
s_nop 0
buffer_load_dwordx4 v18, s[20:23], s54 offen lds
buffer_load_dwordx4 v19, s[20:23], s54 offen offset:1024 lds
buffer_load_dwordx4 v20, s[20:23], s54 offen offset:2048 lds
s_add_u32 s54, s54, 196608
s_waitcnt vmcnt(12) lgkmcnt(0)
s_barrier
ds_read_b128 a[0:3], v23
RD 4,23,2304
RD 8,23,4608
RD 12,23,6912
ds_read_b128 a[16:19], v24
ds_read_b128 a[20:23], v30
RD 24,30,2304
RD 28,30,4608
RD 32,30,6912
ds_read_b128 a[36:39], v31
TR 80,25,49664
TR 82,25,50176
TR 84,25,62080
TR 86,25,62592
TR 88,25,50688
TR 90,25,51200
TR 92,25,63104
TR 94,25,63616
TR 96,25,51712
TR 98,25,52224
TR 100,25,64128
TR 102,25,64640
s_waitcnt vmcnt(3) lgkmcnt(0)
s_barrier
v_mfma_f32_16x16x32_bf16 v[60:63], a[80:83], a[0:3], 0
TR 104,25,49696
s_add_u32 m0, s56, 86400
MAA 60,84,20
buffer_load_dwordx4 v18, s[20:23], s54 offen lds
v_mfma_f32_16x16x32_bf16 v[64:67], a[80:83], a[4:7], 0
s_sub_u32 s47, s47, 1
s_cbranch_scc1 .Lx19
.Lx19b:
MAA 64,84,24
buffer_load_dwordx4 v19, s[20:23], s54 offen offset:1024 lds
v_mfma_f32_16x16x32_bf16 v[68:71], a[80:83], a[8:11], 0
TR 106,25,50208
MAA 68,84,28
TR 108,25,62112
TR 110,25,62624
TR 112,25,50720
v_mfma_f32_16x16x32_bf16 v[72:75], a[80:83], a[12:15], 0
TR 114,25,51232
MAA 72,84,32
TR 116,25,63136
TR 118,25,63648
v_mfma_f32_16x16x32_bf16 v[104:107], a[88:91], a[12:15], 0
TR 120,25,51744
MAA 104,92,32
buffer_load_dwordx4 v20, s[20:23], s54 offen offset:2048 lds
v_mfma_f32_16x16x32_bf16 v[100:103], a[88:91], a[8:11], 0
s_add_u32 s54, s54, 196608
s_add_u32 m0, s55, 36992
MAA 100,92,28
buffer_load_dwordx4 v21, s[36:39], s52 offen lds
v_mfma_f32_16x16x32_bf16 v[96:99], a[88:91], a[4:7], 0
TR 122,25,52256
MAA 96,92,24
buffer_load_dwordx4 v28, s[36:39], s52 offen offset:1024 lds
v_mfma_f32_16x16x32_bf16 v[92:95], a[88:91], a[0:3], 0
TR 124,25,64160
MAA 92,92,20
buffer_load_dword v22, s[36:39], s52 offen offset:2048 lds
v_mfma_f32_16x16x32_bf16 v[124:127], a[0:3], a[96:99], 0
s_add_u32 s52, s52, 128
s_add_u32 m0, s55, 39296
MAA 124,20,100
buffer_load_dwordx4 v21, s[36:39], s53 offen lds
v_mfma_f32_16x16x32_bf16 v[128:131], a[4:7], a[96:99], 0
TR 126,25,64672
MAA 128,24,100
buffer_load_dwordx4 v28, s[36:39], s53 offen offset:1024 lds
v_mfma_f32_16x16x32_bf16 v[132:135], a[8:11], a[96:99], 0
RD 40,23,18496
MAA 132,28,100
RD 44,23,20800
RD 48,23,23104
RD 52,23,25408
v_mfma_f32_16x16x32_bf16 v[136:139], a[12:15], a[96:99], 0
RD 56,24,18496
MAA 136,32,100
buffer_load_dword v29, s[36:39], s53 offen offset:2048 lds
v_mfma_f32_16x16x32_bf16 v[156:159], a[16:19], a[96:99], 0
s_add_u32 s53, s53, 128
MAA 156,36,100
s_waitcnt vmcnt(6) lgkmcnt(5)
s_barrier
v_mfma_f32_16x16x32_bf16 v[76:79], a[104:107], a[0:3], 0
RD 60,30,18496
s_add_u32 m0, s56, 98816
MAA 76,108,20
buffer_load_dwordx4 v18, s[20:23], s54 offen lds
v_mfma_f32_16x16x32_bf16 v[80:83], a[104:107], a[4:7], 0
RD 64,30,20800
MAA 80,108,24
buffer_load_dwordx4 v19, s[20:23], s54 offen offset:1024 lds
v_mfma_f32_16x16x32_bf16 v[84:87], a[104:107], a[8:11], 0
RD 68,30,23104
MAA 84,108,28
RD 72,30,25408
v_mfma_f32_16x16x32_bf16 v[88:91], a[104:107], a[12:15], 0
RD 76,31,18496
MAA 88,108,32
buffer_load_dwordx4 v20, s[20:23], s54 offen offset:2048 lds
v_mfma_f32_16x16x32_bf16 v[244:247], a[104:107], a[16:19], 0
s_add_u32 s54, s54, 196608
s_add_u32 m0, s56, 111232
MAA 244,108,36
buffer_load_dwordx4 v18, s[20:23], s54 offen lds
v_mfma_f32_16x16x32_bf16 v[120:123], a[112:115], a[12:15], 0
ds_read_b64_tr_b16 a[80:81], v25
MAA 120,116,32
TR 82,25,512
v_mfma_f32_16x16x32_bf16 v[116:119], a[112:115], a[8:11], 0
TR 84,25,12416
MAA 116,116,28
buffer_load_dwordx4 v19, s[20:23], s54 offen offset:1024 lds
v_mfma_f32_16x16x32_bf16 v[112:115], a[112:115], a[4:7], 0
TR 86,25,12928
MAA 112,116,24
buffer_load_dwordx4 v20, s[20:23], s54 offen offset:2048 lds
v_mfma_f32_16x16x32_bf16 v[108:111], a[112:115], a[0:3], 0
TR 88,25,1024
s_add_u32 s54, s54, 196608
MAA 108,116,20
TR 90,25,1536
v_mfma_f32_16x16x32_bf16 v[140:143], a[0:3], a[120:123], 0
TR 92,25,13440
s_add_u32 m0, s55, 55488
MAA 140,20,124
buffer_load_dwordx4 v21, s[36:39], s52 offen lds
v_mfma_f32_16x16x32_bf16 v[144:147], a[4:7], a[120:123], 0
TR 94,25,13952
MAA 144,24,124
buffer_load_dwordx4 v28, s[36:39], s52 offen offset:1024 lds
v_mfma_f32_16x16x32_bf16 v[148:151], a[8:11], a[120:123], 0
TR 96,25,2048
MAA 148,28,124
TR 98,25,2560
v_mfma_f32_16x16x32_bf16 v[152:155], a[12:15], a[120:123], 0
TR 100,25,14464
MAA 152,32,124
buffer_load_dword v22, s[36:39], s52 offen offset:2048 lds
v_mfma_f32_16x16x32_bf16 v[160:163], a[16:19], a[120:123], 0
TR 102,25,14976
s_add_u32 s52, s52, 128
MAA 160,36,124
s_waitcnt vmcnt(9) lgkmcnt(8)
s_barrier
MAA 60,80,40
TR 104,25,32
s_add_u32 m0, s55, 57792
MAA 60,84,60
buffer_load_dwordx4 v21, s[36:39], s53 offen lds
MAA 64,84,64
s_sub_u32 s47, s47, 1
s_cbranch_scc1 .Lx20
.Lx20b:
MAA 64,80,44
buffer_load_dwordx4 v28, s[36:39], s53 offen offset:1024 lds
MAA 68,80,48
TR 106,25,544
MAA 68,84,68
TR 108,25,12448
TR 110,25,12960
TR 112,25,1056
MAA 72,84,72
TR 114,25,1568
MAA 72,80,52
TR 116,25,13472
TR 118,25,13984
s_waitcnt lgkmcnt(8)
MAA 104,88,52
TR 120,25,2080
MAA 104,92,72
buffer_load_dword v29, s[36:39], s53 offen offset:2048 lds
MAA 100,92,68
s_add_u32 s53, s53, 128
s_add_u32 m0, s56, 123648
MAA 100,88,48
buffer_load_dwordx4 v18, s[20:23], s54 offen lds
MAA 96,88,44
TR 122,25,2592
MAA 96,92,64
buffer_load_dwordx4 v19, s[20:23], s54 offen offset:1024 lds
MAA 92,92,60
TR 124,25,14496
MAA 92,88,40
buffer_load_dwordx4 v20, s[20:23], s54 offen offset:2048 lds
MAA 124,40,96
s_add_u32 s54, s54, 196608
s_add_u32 m0, s56, 136064
MAA 124,60,100
buffer_load_dwordx4 v18, s[20:23], s54 offen lds
MAA 128,64,100
TR 126,25,15008
MAA 128,44,96
buffer_load_dwordx4 v19, s[20:23], s54 offen offset:1024 lds
MAA 132,48,96
RD 0,23,36992
MAA 132,68,100
RD 4,23,39296
RD 8,23,41600
RD 12,23,43904
MAA 136,72,100
RD 16,24,36992
MAA 136,52,96
buffer_load_dwordx4 v20, s[20:23], s54 offen offset:2048 lds
MAA 156,56,96
s_add_u32 s54, s54, 196608
MAA 156,76,100
s_waitcnt vmcnt(12) lgkmcnt(5)
s_barrier
MAA 76,104,40
RD 20,30,36992
s_add_u32 m0, s55, 0
MAA 76,108,60
buffer_load_dwordx4 v21, s[36:39], s52 offen lds
MAA 80,108,64
RD 24,30,39296
MAA 80,104,44
buffer_load_dwordx4 v28, s[36:39], s52 offen offset:1024 lds
MAA 84,104,48
RD 28,30,41600
MAA 84,108,68
RD 32,30,43904
RD 36,31,36992
MAA 88,108,72
TR 80,25,24832
MAA 88,104,52
buffer_load_dword v22, s[36:39], s52 offen offset:2048 lds
MAA 244,104,56
s_add_u32 s52, s52, 128
s_add_u32 m0, s55, 2304
MAA 244,108,76
buffer_load_dwordx4 v21, s[36:39], s53 offen lds
MAA 120,116,72
TR 82,25,25344
MAA 120,112,52
buffer_load_dwordx4 v28, s[36:39], s53 offen offset:1024 lds
MAA 116,112,48
TR 84,25,37248
MAA 116,116,68
TR 86,25,37760
TR 88,25,25856
MAA 112,116,64
TR 90,25,26368
MAA 112,112,44
buffer_load_dword v29, s[36:39], s53 offen offset:2048 lds
MAA 108,112,40
s_add_u32 s53, s53, 128
s_add_u32 m0, s56, 73984
MAA 108,116,60
buffer_load_dwordx4 v18, s[20:23], s54 offen lds
MAA 140,60,124
TR 92,25,38272
MAA 140,40,120
buffer_load_dwordx4 v19, s[20:23], s54 offen offset:1024 lds
MAA 144,44,120
TR 94,25,38784
MAA 144,64,124
buffer_load_dwordx4 v20, s[20:23], s54 offen offset:2048 lds
MAA 148,68,124
TR 96,25,26880
s_add_u32 s54, s54, 196608
MAA 148,48,120
TR 98,25,27392
TR 100,25,39296
MAA 152,52,120
TR 102,25,39808
MAA 152,72,124
buffer_load_dword v37, v34, s[40:43], 0 offen sc1
MAA 160,76,124
MAA 160,56,120
s_waitcnt vmcnt(16) lgkmcnt(8)
s_barrier
MAA 60,80,0
TR 104,25,24864
s_add_u32 m0, s56, 86400
MAA 60,84,20
buffer_load_dwordx4 v18, s[20:23], s54 offen lds
MAA 64,84,24
s_sub_u32 s47, s47, 1
s_cbranch_scc1 .Lx21
.Lx21b:
MAA 64,80,4
buffer_load_dwordx4 v19, s[20:23], s54 offen offset:1024 lds
MAA 68,80,8
TR 106,25,25376
MAA 68,84,28
TR 108,25,37280
TR 110,25,37792
TR 112,25,25888
MAA 72,84,32
TR 114,25,26400
MAA 72,80,12
TR 116,25,38304
TR 118,25,38816
s_waitcnt lgkmcnt(8)
MAA 104,88,12
TR 120,25,26912
MAA 104,92,32
buffer_load_dwordx4 v20, s[20:23], s54 offen offset:2048 lds
MAA 100,92,28
s_add_u32 s54, s54, 196608
s_add_u32 m0, s55, 18496
MAA 100,88,8
buffer_load_dwordx4 v21, s[36:39], s52 offen lds
MAA 96,88,4
TR 122,25,27424
MAA 96,92,24
buffer_load_dwordx4 v28, s[36:39], s52 offen offset:1024 lds
MAA 92,92,20
TR 124,25,39328
MAA 92,88,0
buffer_load_dword v22, s[36:39], s52 offen offset:2048 lds
MAA 124,0,96
s_add_u32 s52, s52, 128
s_add_u32 m0, s55, 20800
MAA 124,20,100
buffer_load_dwordx4 v21, s[36:39], s53 offen lds
MAA 128,24,100
TR 126,25,39840
MAA 128,4,96
buffer_load_dwordx4 v28, s[36:39], s53 offen offset:1024 lds
MAA 132,8,96
RD 40,23,55488
MAA 132,28,100
RD 44,23,57792
RD 48,23,60096
RD 52,23,62400
MAA 136,32,100
RD 56,24,55488
MAA 136,12,96
buffer_load_dword v29, s[36:39], s53 offen offset:2048 lds
MAA 156,16,96
s_add_u32 s53, s53, 128
MAA 156,36,100
s_waitcnt vmcnt(19) lgkmcnt(5)
s_barrier
MAA 76,104,0
RD 60,30,55488
s_add_u32 m0, s56, 98816
MAA 76,108,20
buffer_load_dwordx4 v18, s[20:23], s54 offen lds
MAA 80,108,24
RD 64,30,57792
MAA 80,104,4
buffer_load_dwordx4 v19, s[20:23], s54 offen offset:1024 lds
MAA 84,104,8
RD 68,30,60096
MAA 84,108,28
RD 72,30,62400
MAA 88,108,32
RD 76,31,55488
MAA 88,104,12
buffer_load_dwordx4 v20, s[20:23], s54 offen offset:2048 lds
MAA 244,104,16
s_add_u32 s54, s54, 196608
s_add_u32 m0, s55, 36992
MAA 244,108,36
buffer_load_dwordx4 v21, s[36:39], s52 offen lds
MAA 120,116,32
TR 80,25,49664
MAA 120,112,12
TR 82,25,50176
MAA 116,112,8
TR 84,25,62080
MAA 116,116,28
buffer_load_dwordx4 v28, s[36:39], s52 offen offset:1024 lds
MAA 112,116,24
TR 86,25,62592
MAA 112,112,4
buffer_load_dword v22, s[36:39], s52 offen offset:2048 lds
MAA 108,112,0
TR 88,25,50688
s_add_u32 s52, s52, 128
MAA 108,116,20
TR 90,25,51200
MAA 140,20,124
TR 92,25,63104
s_add_u32 m0, s55, 39296
MAA 140,0,120
buffer_load_dwordx4 v21, s[36:39], s53 offen lds
MAA 144,4,120
TR 94,25,63616
MAA 144,24,124
buffer_load_dwordx4 v28, s[36:39], s53 offen offset:1024 lds
MAA 148,28,124
TR 96,25,51712
MAA 148,8,120
TR 98,25,52224
MAA 152,12,120
TR 100,25,64128
MAA 152,32,124
buffer_load_dword v29, s[36:39], s53 offen offset:2048 lds
MAA 160,36,124
TR 102,25,64640
s_add_u32 s53, s53, 128
MAA 160,16,120
s_waitcnt vmcnt(22) lgkmcnt(8)
s_barrier
MAA 60,80,40
TR 104,25,49696
MAA 60,84,60
TR 106,25,50208
MAA 64,84,64
TR 108,25,62112
s_add_u32 m0, s56, 111232
MAA 64,80,44
buffer_load_dwordx4 v18, s[20:23], s54 offen lds
MAA 68,80,48
s_sub_u32 s47, s47, 1
s_cbranch_scc1 .Lx22
.Lx22b:
MAA 68,84,68
TR 110,25,62624
MAA 72,84,72
TR 112,25,50720
MAA 72,80,52
TR 114,25,51232
s_waitcnt lgkmcnt(6)
MAA 104,88,52
TR 116,25,63136
MAA 104,92,72
buffer_load_dwordx4 v19, s[20:23], s54 offen offset:1024 lds
MAA 100,92,68
TR 118,25,63648
MAA 100,88,48
buffer_load_dwordx4 v20, s[20:23], s54 offen offset:2048 lds
MAA 96,88,44
TR 120,25,51744
s_add_u32 s54, s54, 196608
MAA 96,92,64
TR 122,25,52256
MAA 92,92,60
TR 124,25,64160
s_add_u32 m0, s55, 55488
MAA 92,88,40
buffer_load_dwordx4 v21, s[36:39], s52 offen lds
MAA 124,40,96
TR 126,25,64672
MAA 124,60,100
ds_read_b128 a[0:3], v23
MAA 128,64,100
RD 4,23,2304
MAA 128,44,96
buffer_load_dwordx4 v28, s[36:39], s52 offen offset:1024 lds
MAA 132,48,96
RD 8,23,4608
MAA 132,68,100
RD 12,23,6912
MAA 136,72,100
ds_read_b128 a[16:19], v24
MAA 136,52,96
buffer_load_dword v22, s[36:39], s52 offen offset:2048 lds
MAA 156,56,96
s_add_u32 s52, s52, 128
MAA 156,76,100
s_waitcnt vmcnt(21) lgkmcnt(5)
s_barrier
v_cmp_gt_u32 vcc, v35, v37
s_nop 0
s_cbranch_vccnz .Lsp23
.Lsp23b:
v_mov_b32 v37, 0
MAA 76,104,40
ds_read_b128 a[20:23], v30
MAA 76,108,60
buffer_atomic_add v38, v32, s[16:19], 0 offen
MAA 80,108,64
RD 24,30,2304
MAA 80,104,44
RD 28,30,4608
MAA 84,104,48
RD 32,30,6912
s_add_u32 m0, s56, 123648
MAA 84,108,68
buffer_load_dwordx4 v18, s[20:23], s54 offen lds
MAA 88,108,72
ds_read_b128 a[36:39], v31
MAA 88,104,52
ds_read_b64_tr_b16 a[80:81], v25
MAA 244,104,56
TR 82,25,512
MAA 244,108,76
buffer_load_dwordx4 v19, s[20:23], s54 offen offset:1024 lds
MAA 120,116,72
TR 84,25,12416
MAA 120,112,52
TR 86,25,12928
MAA 116,112,48
MAA 116,116,68
buffer_load_dwordx4 v20, s[20:23], s54 offen offset:2048 lds
MAA 112,116,64
s_add_u32 s54, s54, 196608
s_add_u32 m0, s55, 57792
MAA 112,112,44
buffer_load_dwordx4 v21, s[36:39], s53 offen lds
MAA 108,112,40
TR 88,25,1024
MAA 108,116,60
TR 90,25,1536
MAA 140,60,124
TR 92,25,13440
MAA 140,40,120
buffer_load_dwordx4 v28, s[36:39], s53 offen offset:1024 lds
MAA 144,44,120
TR 94,25,13952
MAA 144,64,124
TR 96,25,2048
MAA 148,68,124
TR 98,25,2560
MAA 148,48,120
buffer_load_dword v29, s[36:39], s53 offen offset:2048 lds
MAA 152,52,120
TR 100,25,14464
s_add_u32 s53, s53, 128
MAA 152,72,124
TR 102,25,14976
MAA 160,76,124
MAA 160,56,120
s_waitcnt vmcnt(22) lgkmcnt(8)
s_barrier
MAA 60,80,0
TR 104,25,32
MAA 60,84,20
TR 106,25,544
MAA 64,84,24
TR 108,25,12448
s_add_u32 m0, s56, 136064
MAA 64,80,4
buffer_load_dwordx4 v18, s[20:23], s54 offen lds
MAA 68,80,8
s_sub_u32 s47, s47, 1
s_cbranch_scc1 .Lx24
.Lx24b:
MAA 68,84,28
TR 110,25,12960
MAA 72,84,32
TR 112,25,1056
MAA 72,80,12
TR 114,25,1568
s_waitcnt lgkmcnt(6)
MAA 104,88,12
TR 116,25,13472
MAA 104,92,32
buffer_load_dwordx4 v19, s[20:23], s54 offen offset:1024 lds
MAA 100,92,28
TR 118,25,13984
MAA 100,88,8
buffer_load_dwordx4 v20, s[20:23], s54 offen offset:2048 lds
MAA 96,88,4
TR 120,25,2080
s_add_u32 s54, s54, 196608
MAA 96,92,24
TR 122,25,2592
MAA 92,92,20
TR 124,25,14496
s_add_u32 m0, s55, 0
MAA 92,88,0
buffer_load_dwordx4 v21, s[36:39], s52 offen lds
MAA 124,0,96
TR 126,25,15008
MAA 124,20,100
RD 40,23,18496
MAA 128,24,100
RD 44,23,20800
MAA 128,4,96
buffer_load_dwordx4 v28, s[36:39], s52 offen offset:1024 lds
MAA 132,8,96
RD 48,23,23104
MAA 132,28,100
RD 52,23,25408
MAA 136,32,100
RD 56,24,18496
MAA 136,12,96
buffer_load_dword v22, s[36:39], s52 offen offset:2048 lds
MAA 156,16,96
s_add_u32 s52, s52, 128
MAA 156,36,100
s_waitcnt vmcnt(16) lgkmcnt(5)
s_barrier
MAA 76,104,0
RD 60,30,18496
MAA 76,108,20
RD 64,30,20800
MAA 80,108,24
RD 68,30,23104
s_add_u32 m0, s56, 73984
MAA 80,104,4
buffer_load_dwordx4 v18, s[20:23], s54 offen lds
MAA 84,104,8
RD 72,30,25408
MAA 84,108,28
RD 76,31,18496
MAA 88,108,32
MAA 88,104,12
buffer_load_dwordx4 v19, s[20:23], s54 offen offset:1024 lds
MAA 244,104,16
TR 80,25,24832
MAA 244,108,36
TR 82,25,25344
MAA 120,116,32
TR 84,25,37248
MAA 120,112,12
buffer_load_dwordx4 v20, s[20:23], s54 offen offset:2048 lds
MAA 116,112,8
TR 86,25,37760
s_add_u32 s54, s54, 196608
MAA 116,116,28
MAA 112,116,24
TR 88,25,25856
MAA 112,112,4
TR 90,25,26368
MAA 108,112,0
TR 92,25,38272
s_add_u32 m0, s55, 2304
MAA 108,116,20
buffer_load_dwordx4 v21, s[36:39], s53 offen lds
MAA 140,20,124
TR 94,25,38784
MAA 140,0,120
MAA 144,4,120
TR 96,25,26880
MAA 144,24,124
buffer_load_dwordx4 v28, s[36:39], s53 offen offset:1024 lds
MAA 148,28,124
TR 98,25,27392
MAA 148,8,120
TR 100,25,39296
MAA 152,12,120
TR 102,25,39808
MAA 152,32,124
buffer_load_dword v29, s[36:39], s53 offen offset:2048 lds
MAA 160,36,124
s_add_u32 s53, s53, 128
MAA 160,16,120
s_waitcnt lgkmcnt(8)
s_barrier
MAA 60,80,40
TR 104,25,24864
MAA 60,84,60
TR 106,25,25376
MAA 64,84,64
TR 108,25,37280
s_add_u32 m0, s56, 86400
MAA 64,80,44
buffer_load_dwordx4 v18, s[20:23], s54 offen lds
MAA 68,80,48
s_sub_u32 s47, s47, 1
s_cbranch_scc1 .Lx25
.Lx25b:
MAA 68,84,68
TR 110,25,37792
MAA 72,84,72
TR 112,25,25888
MAA 72,80,52
TR 114,25,26400
s_waitcnt lgkmcnt(6)
MAA 104,88,52
TR 116,25,38304
MAA 104,92,72
buffer_load_dwordx4 v19, s[20:23], s54 offen offset:1024 lds
MAA 100,92,68
TR 118,25,38816
MAA 100,88,48
buffer_load_dwordx4 v20, s[20:23], s54 offen offset:2048 lds
MAA 96,88,44
TR 120,25,26912
s_add_u32 s54, s54, 196608
MAA 96,92,64
TR 122,25,27424
MAA 92,92,60
TR 124,25,39328
s_add_u32 m0, s55, 18496
MAA 92,88,40
buffer_load_dwordx4 v21, s[36:39], s52 offen lds
MAA 124,40,96
TR 126,25,39840
MAA 124,60,100
RD 0,23,36992
MAA 128,64,100
RD 4,23,39296
MAA 128,44,96
buffer_load_dwordx4 v28, s[36:39], s52 offen offset:1024 lds
MAA 132,48,96
RD 8,23,41600
MAA 132,68,100
RD 12,23,43904
MAA 136,72,100
RD 16,24,36992
MAA 136,52,96
buffer_load_dword v22, s[36:39], s52 offen offset:2048 lds
MAA 156,56,96
s_add_u32 s52, s52, 128
MAA 156,76,100
s_waitcnt vmcnt(15) lgkmcnt(5)
s_barrier
MAA 76,104,40
RD 20,30,36992
s_add_u32 m0, s56, 98816
MAA 76,108,60
buffer_load_dwordx4 v18, s[20:23], s54 offen lds
MAA 80,108,64
RD 24,30,39296
MAA 80,104,44
RD 28,30,41600
MAA 84,104,48
RD 32,30,43904
MAA 84,108,68
buffer_load_dwordx4 v19, s[20:23], s54 offen offset:1024 lds
MAA 88,108,72
RD 36,31,36992
MAA 88,104,52
TR 80,25,49664
MAA 244,104,56
MAA 244,108,76
buffer_load_dwordx4 v20, s[20:23], s54 offen offset:2048 lds
MAA 120,116,72
TR 82,25,50176
s_add_u32 s54, s54, 196608
MAA 120,112,52
TR 84,25,62080
MAA 116,112,48
TR 86,25,62592
s_add_u32 m0, s55, 20800
MAA 116,116,68
buffer_load_dwordx4 v21, s[36:39], s53 offen lds
MAA 112,116,64
TR 88,25,50688
MAA 112,112,44
buffer_load_dwordx4 v28, s[36:39], s53 offen offset:1024 lds
MAA 108,112,40
TR 90,25,51200
MAA 108,116,60
TR 92,25,63104
MAA 140,60,124
MAA 140,40,120
buffer_load_dword v29, s[36:39], s53 offen offset:2048 lds
MAA 144,44,120
TR 94,25,63616
s_add_u32 s53, s53, 128
MAA 144,64,124
TR 96,25,51712
MAA 148,68,124
TR 98,25,52224
MAA 148,48,120
buffer_atomic_add v37, v33, s[16:19], 0 offen sc0
MAA 152,52,120
TR 100,25,64128
MAA 152,72,124
TR 102,25,64640
MAA 160,76,124
MAA 160,56,120
s_waitcnt lgkmcnt(8)
s_barrier
MAA 60,80,0
TR 104,25,49696
MAA 60,84,20
TR 106,25,50208
MAA 64,84,24
TR 108,25,62112
s_add_u32 m0, s56, 111232
MAA 64,80,4
buffer_load_dwordx4 v18, s[20:23], s54 offen lds
MAA 68,80,8
s_sub_u32 s47, s47, 1
s_cbranch_scc1 .Lx26
.Lx26b:
MAA 68,84,28
TR 110,25,62624
MAA 72,84,32
TR 112,25,50720
MAA 72,80,12
TR 114,25,51232
s_waitcnt lgkmcnt(6)
MAA 104,88,12
TR 116,25,63136
MAA 104,92,32
buffer_load_dwordx4 v19, s[20:23], s54 offen offset:1024 lds
MAA 100,92,28
TR 118,25,63648
MAA 100,88,8
buffer_load_dwordx4 v20, s[20:23], s54 offen offset:2048 lds
MAA 96,88,4
TR 120,25,51744
s_add_u32 s54, s54, 196608
MAA 96,92,24
TR 122,25,52256
MAA 92,92,20
TR 124,25,64160
s_add_u32 m0, s55, 36992
MAA 92,88,0
buffer_load_dwordx4 v21, s[36:39], s52 offen lds
MAA 124,0,96
TR 126,25,64672
MAA 124,20,100
RD 40,23,55488
MAA 128,24,100
RD 44,23,57792
MAA 128,4,96
buffer_load_dwordx4 v28, s[36:39], s52 offen offset:1024 lds
MAA 132,8,96
RD 48,23,60096
MAA 132,28,100
RD 52,23,62400
MAA 136,32,100
RD 56,24,55488
MAA 136,12,96
buffer_load_dword v22, s[36:39], s52 offen offset:2048 lds
MAA 156,16,96
s_add_u32 s52, s52, 128
MAA 156,36,100
s_waitcnt vmcnt(16) lgkmcnt(5)
s_barrier
MAA 76,104,0
RD 60,30,55488
MAA 76,108,20
RD 64,30,57792
MAA 80,108,24
RD 68,30,60096
s_add_u32 m0, s56, 123648
MAA 80,104,4
buffer_load_dwordx4 v18, s[20:23], s54 offen lds
MAA 84,104,8
RD 72,30,62400
MAA 84,108,28
RD 76,31,55488
MAA 88,108,32
MAA 88,104,12
buffer_load_dwordx4 v19, s[20:23], s54 offen offset:1024 lds
MAA 244,104,16
ds_read_b64_tr_b16 a[80:81], v25
MAA 244,108,36
TR 82,25,512
MAA 120,116,32
TR 84,25,12416
MAA 120,112,12
buffer_load_dwordx4 v20, s[20:23], s54 offen offset:2048 lds
MAA 116,112,8
TR 86,25,12928
s_add_u32 s54, s54, 196608
MAA 116,116,28
MAA 112,116,24
TR 88,25,1024
MAA 112,112,4
TR 90,25,1536
MAA 108,112,0
TR 92,25,13440
s_add_u32 m0, s55, 39296
MAA 108,116,20
buffer_load_dwordx4 v21, s[36:39], s53 offen lds
MAA 140,20,124
TR 94,25,13952
MAA 140,0,120
MAA 144,4,120
TR 96,25,2048
MAA 144,24,124
buffer_load_dwordx4 v28, s[36:39], s53 offen offset:1024 lds
MAA 148,28,124
TR 98,25,2560
MAA 148,8,120
TR 100,25,14464
MAA 152,12,120
TR 102,25,14976
MAA 152,32,124
buffer_load_dword v29, s[36:39], s53 offen offset:2048 lds
MAA 160,36,124
s_add_u32 s53, s53, 128
MAA 160,16,120
s_waitcnt lgkmcnt(8)
s_barrier
MAA 60,80,40
TR 104,25,32
MAA 60,84,60
TR 106,25,544
MAA 64,84,64
TR 108,25,12448
s_add_u32 m0, s56, 136064
MAA 64,80,44
buffer_load_dwordx4 v18, s[20:23], s54 offen lds
MAA 68,80,48
s_sub_u32 s47, s47, 1
s_cbranch_scc1 .Lx27
.Lx27b:
MAA 68,84,68
TR 110,25,12960
MAA 72,84,72
TR 112,25,1056
MAA 72,80,52
TR 114,25,1568
s_waitcnt lgkmcnt(6)
MAA 104,88,52
TR 116,25,13472
MAA 104,92,72
buffer_load_dwordx4 v19, s[20:23], s54 offen offset:1024 lds
MAA 100,92,68
TR 118,25,13984
MAA 100,88,48
buffer_load_dwordx4 v20, s[20:23], s54 offen offset:2048 lds
MAA 96,88,44
TR 120,25,2080
s_add_u32 s54, s54, 196608
MAA 96,92,64
TR 122,25,2592
MAA 92,92,60
TR 124,25,14496
s_add_u32 m0, s55, 55488
MAA 92,88,40
buffer_load_dwordx4 v21, s[36:39], s52 offen lds
MAA 124,40,96
TR 126,25,15008
MAA 124,60,100
ds_read_b128 a[0:3], v23
MAA 128,64,100
RD 4,23,2304
MAA 128,44,96
buffer_load_dwordx4 v28, s[36:39], s52 offen offset:1024 lds
MAA 132,48,96
RD 8,23,4608
MAA 132,68,100
RD 12,23,6912
MAA 136,72,100
ds_read_b128 a[16:19], v24
MAA 136,52,96
buffer_load_dword v22, s[36:39], s52 offen offset:2048 lds
MAA 156,56,96
s_add_u32 s52, s52, 128
MAA 156,76,100
s_waitcnt vmcnt(18)
v_cmp_gt_u32 vcc, v36, v37
s_nop 0
s_cbranch_vccnz .Lsp28
.Lsp28b:
s_waitcnt vmcnt(15) lgkmcnt(5)
s_barrier
MAA 76,104,40
ds_read_b128 a[20:23], v30
s_add_u32 m0, s56, 73984
MAA 76,108,60
buffer_load_dwordx4 v18, s[20:23], s54 offen lds
MAA 80,108,64
RD 24,30,2304
MAA 80,104,44
RD 28,30,4608
MAA 84,104,48
RD 32,30,6912
MAA 84,108,68
buffer_load_dwordx4 v19, s[20:23], s54 offen offset:1024 lds
MAA 88,108,72
ds_read_b128 a[36:39], v31
MAA 88,104,52
TR 80,25,24832
MAA 244,104,56
MAA 244,108,76
buffer_load_dwordx4 v20, s[20:23], s54 offen offset:2048 lds
MAA 120,116,72
TR 82,25,25344
s_add_u32 s54, s54, 196608
MAA 120,112,52
TR 84,25,37248
MAA 116,112,48
TR 86,25,37760
s_add_u32 m0, s55, 57792
MAA 116,116,68
buffer_load_dwordx4 v21, s[36:39], s53 offen lds
MAA 112,116,64
TR 88,25,25856
MAA 112,112,44
buffer_load_dwordx4 v28, s[36:39], s53 offen offset:1024 lds
MAA 108,112,40
TR 90,25,26368
MAA 108,116,60
TR 92,25,38272
MAA 140,60,124
MAA 140,40,120
buffer_load_dword v29, s[36:39], s53 offen offset:2048 lds
MAA 144,44,120
TR 94,25,38784
s_add_u32 s53, s53, 128
MAA 144,64,124
TR 96,25,26880
MAA 148,68,124
TR 98,25,27392
MAA 148,48,120
buffer_load_dwordx4 v[164:167], v26, s[16:19], s75 offen sc1
MAA 152,52,120
TR 100,25,39296
MAA 152,72,124
TR 102,25,39808
MAA 160,76,124
MAA 160,56,120
s_waitcnt lgkmcnt(8)
s_barrier
MAA 60,80,0
TR 104,25,24864
s_add_u32 m0, s56, 86400
MAA 60,84,20
buffer_load_dwordx4 v18, s[20:23], s54 offen lds
MAA 64,84,24
s_sub_u32 s47, s47, 1
s_cbranch_scc1 .Lx29
.Lx29b:
MAA 64,80,4
TR 106,25,25376
TR 108,25,37280
MAA 68,80,8
TR 110,25,37792
MAA 68,84,28
buffer_load_dwordx4 v19, s[20:23], s54 offen offset:1024 lds
MAA 72,84,32
TR 112,25,25888
MAA 72,80,12
TR 114,25,26400
s_waitcnt lgkmcnt(6)
MAA 104,88,12
MAA 104,92,32
buffer_load_dwordx4 v20, s[20:23], s54 offen offset:2048 lds
MAA 100,92,28
s_add_u32 s54, s54, 196608
s_add_u32 m0, s55, 0
MAA 100,88,8
buffer_load_dwordx4 v21, s[36:39], s52 offen lds
MAA 96,88,4
TR 116,25,38304
MAA 96,92,24
TR 118,25,38816
TR 120,25,26912
MAA 92,92,20
TR 122,25,27424
MAA 92,88,0
buffer_load_dwordx4 v28, s[36:39], s52 offen offset:1024 lds
MAA 124,0,96
TR 124,25,39328
MAA 124,20,100
TR 126,25,39840
MAA 128,24,100
RD 40,23,18496
MAA 128,4,96
buffer_load_dword v22, s[36:39], s52 offen offset:2048 lds
MAA 132,8,96
RD 44,23,20800
s_add_u32 s52, s52, 128
MAA 132,28,100
buffer_load_dwordx4 v[168:171], v26, s[16:19], s75 offen offset:1024 sc1
MAA 136,32,100
RD 48,23,23104
MAA 136,12,96
RD 52,23,25408
RD 56,24,18496
MAA 156,16,96
MAA 156,36,100
s_waitcnt vmcnt(17) lgkmcnt(5)
s_barrier
MAA 76,104,0
RD 60,30,18496
s_add_u32 m0, s56, 98816
MAA 76,108,20
buffer_load_dwordx4 v18, s[20:23], s54 offen lds
MAA 80,108,24
RD 64,30,20800
MAA 80,104,4
RD 68,30,23104
MAA 84,104,8
RD 72,30,25408
MAA 84,108,28
buffer_load_dwordx4 v19, s[20:23], s54 offen offset:1024 lds
MAA 88,108,32
RD 76,31,18496
MAA 88,104,12
TR 80,25,49664
MAA 244,104,16
MAA 244,108,36
buffer_load_dwordx4 v20, s[20:23], s54 offen offset:2048 lds
MAA 120,116,32
TR 82,25,50176
s_add_u32 s54, s54, 196608
MAA 120,112,12
TR 84,25,62080
MAA 116,112,8
TR 86,25,62592
s_add_u32 m0, s55, 2304
MAA 116,116,28
buffer_load_dwordx4 v21, s[36:39], s53 offen lds
MAA 112,116,24
TR 88,25,50688
MAA 112,112,4
buffer_load_dwordx4 v28, s[36:39], s53 offen offset:1024 lds
MAA 108,112,0
TR 90,25,51200
MAA 108,116,20
TR 92,25,63104
MAA 140,20,124
MAA 140,0,120
buffer_load_dword v29, s[36:39], s53 offen offset:2048 lds
MAA 144,4,120
TR 94,25,63616
s_add_u32 s53, s53, 128
MAA 144,24,124
TR 96,25,51712
MAA 148,28,124
TR 98,25,52224
MAA 148,8,120
buffer_load_dwordx4 v[172:175], v26, s[16:19], s75 offen offset:2048 sc1
MAA 152,12,120
TR 100,25,64128
MAA 152,32,124
TR 102,25,64640
MAA 160,36,124
MAA 160,16,120
s_waitcnt lgkmcnt(8)
s_barrier
MAA 60,80,40
TR 104,25,49696
s_add_u32 m0, s56, 111232
MAA 60,84,60
buffer_load_dwordx4 v18, s[20:23], s54 offen lds
MAA 64,84,64
s_sub_u32 s47, s47, 1
s_cbranch_scc1 .Lx30
.Lx30b:
MAA 64,80,44
TR 106,25,50208
TR 108,25,62112
MAA 68,80,48
TR 110,25,62624
MAA 68,84,68
buffer_load_dwordx4 v19, s[20:23], s54 offen offset:1024 lds
MAA 72,84,72
TR 112,25,50720
MAA 72,80,52
TR 114,25,51232
s_waitcnt lgkmcnt(6)
MAA 104,88,52
MAA 104,92,72
buffer_load_dwordx4 v20, s[20:23], s54 offen offset:2048 lds
MAA 100,92,68
s_add_u32 s54, s54, 196608
s_add_u32 m0, s55, 18496
MAA 100,88,48
buffer_load_dwordx4 v21, s[36:39], s52 offen lds
MAA 96,88,44
TR 116,25,63136
MAA 96,92,64
TR 118,25,63648
TR 120,25,51744
MAA 92,92,60
TR 122,25,52256
MAA 92,88,40
buffer_load_dwordx4 v28, s[36:39], s52 offen offset:1024 lds
MAA 124,40,96
TR 124,25,64160
MAA 124,60,100
TR 126,25,64672
MAA 128,64,100
RD 0,23,36992
MAA 128,44,96
buffer_load_dword v22, s[36:39], s52 offen offset:2048 lds
MAA 132,48,96
RD 4,23,39296
s_add_u32 s52, s52, 128
MAA 132,68,100
buffer_load_dwordx4 v[176:179], v26, s[16:19], s75 offen offset:3072 sc1
MAA 136,72,100
RD 8,23,41600
s_add_u32 s75, s75, 4096
MAA 136,52,96
RD 12,23,43904
RD 16,24,36992
MAA 156,56,96
MAA 156,76,100
s_waitcnt vmcnt(18) lgkmcnt(5)
s_barrier
MAA 76,104,40
RD 20,30,36992
s_add_u32 m0, s56, 123648
MAA 76,108,60
buffer_load_dwordx4 v18, s[20:23], s54 offen lds
MAA 80,108,64
RD 24,30,39296
s_waitcnt vmcnt(15)
v_add_f32 v164, v164, v168
MAA 80,104,44
RD 28,30,41600
MAA 84,104,48
RD 32,30,43904
MAA 84,108,68
buffer_load_dwordx4 v19, s[20:23], s54 offen offset:1024 lds
MAA 88,108,72
RD 36,31,36992
MAA 88,104,52
ds_read_b64_tr_b16 a[80:81], v25
v_add_f32 v165, v165, v169
MAA 244,104,56
MAA 244,108,76
buffer_load_dwordx4 v20, s[20:23], s54 offen offset:2048 lds
MAA 120,116,72
TR 82,25,512
s_add_u32 s54, s54, 196608
MAA 120,112,52
TR 84,25,12416
MAA 116,112,48
TR 86,25,12928
s_add_u32 m0, s55, 20800
MAA 116,116,68
buffer_load_dwordx4 v21, s[36:39], s53 offen lds
MAA 112,116,64
TR 88,25,1024
MAA 112,112,44
buffer_load_dwordx4 v28, s[36:39], s53 offen offset:1024 lds
MAA 108,112,40
TR 90,25,1536
v_add_f32 v166, v166, v170
MAA 108,116,60
TR 92,25,13440
MAA 140,60,124
MAA 140,40,120
buffer_load_dword v29, s[36:39], s53 offen offset:2048 lds
MAA 144,44,120
TR 94,25,13952
s_add_u32 s53, s53, 128
MAA 144,64,124
TR 96,25,2048
MAA 148,68,124
TR 98,25,2560
v_add_f32 v167, v167, v171
MAA 148,48,120
buffer_load_dwordx4 v[180:183], v26, s[16:19], s75 offen sc1
MAA 152,52,120
TR 100,25,14464
MAA 152,72,124
TR 102,25,14976
MAA 160,76,124
MAA 160,56,120
s_waitcnt lgkmcnt(8)
s_barrier
MAA 60,80,0
TR 104,25,32
s_add_u32 m0, s56, 136064
MAA 60,84,20
buffer_load_dwordx4 v18, s[20:23], s54 offen lds
MAA 64,84,24
s_sub_u32 s47, s47, 1
s_cbranch_scc1 .Lx31
.Lx31b:
MAA 64,80,4
TR 106,25,544
TR 108,25,12448
MAA 68,80,8
TR 110,25,12960
s_waitcnt vmcnt(15)
v_add_f32 v164, v164, v172
MAA 68,84,28
buffer_load_dwordx4 v19, s[20:23], s54 offen offset:1024 lds
MAA 72,84,32
TR 112,25,1056
MAA 72,80,12
TR 114,25,1568
s_waitcnt lgkmcnt(6)
MAA 104,88,12
v_add_f32 v165, v165, v173
MAA 104,92,32
buffer_load_dwordx4 v20, s[20:23], s54 offen offset:2048 lds
MAA 100,92,28
s_add_u32 s54, s54, 196608
s_add_u32 m0, s55, 36992
MAA 100,88,8
buffer_load_dwordx4 v21, s[36:39], s52 offen lds
MAA 96,88,4
TR 116,25,13472
MAA 96,92,24
TR 118,25,13984
TR 120,25,2080
MAA 92,92,20
TR 122,25,2592
v_add_f32 v166, v166, v174
MAA 92,88,0
buffer_load_dwordx4 v28, s[36:39], s52 offen offset:1024 lds
MAA 124,0,96
TR 124,25,14496
MAA 124,20,100
TR 126,25,15008
MAA 128,24,100
RD 40,23,55488
v_add_f32 v167, v167, v175
MAA 128,4,96
buffer_load_dword v22, s[36:39], s52 offen offset:2048 lds
MAA 132,8,96
RD 44,23,57792
s_add_u32 s52, s52, 128
MAA 132,28,100
buffer_load_dwordx4 v[184:187], v26, s[16:19], s75 offen offset:1024 sc1
MAA 136,32,100
RD 48,23,60096
MAA 136,12,96
RD 52,23,62400
RD 56,24,55488
MAA 156,16,96
MAA 156,36,100
s_waitcnt vmcnt(18) lgkmcnt(5)
s_barrier
MAA 76,104,0
RD 60,30,55488
s_waitcnt vmcnt(14)
v_add_f32 v164, v164, v176
MAA 76,108,20
RD 64,30,57792
s_add_u32 m0, s56, 73984
MAA 80,108,24
buffer_load_dwordx4 v18, s[20:23], s54 offen lds
MAA 80,104,4
RD 68,30,60096
v_add_f32 v165, v165, v177
MAA 84,104,8
RD 72,30,62400
v_add_f32 v166, v166, v178
MAA 84,108,28
buffer_load_dwordx4 v19, s[20:23], s54 offen offset:1024 lds
MAA 88,108,32
RD 76,31,55488
v_add_f32 v167, v167, v179
MAA 88,104,12
TR 80,25,24832
MAA 244,104,16
buffer_load_dwordx4 v20, s[20:23], s54 offen offset:2048 lds
MAA 244,108,36
TR 82,25,25344
s_add_u32 s54, s54, 196608
MAA 120,116,32
TR 84,25,37248
s_add_u32 m0, s55, 39296
MAA 120,112,12
buffer_load_dwordx4 v21, s[36:39], s53 offen lds
MAA 116,112,8
TR 86,25,37760
MAA 116,116,28
TR 88,25,25856
MAA 112,116,24
buffer_load_dwordx4 v28, s[36:39], s53 offen offset:1024 lds
MAA 112,112,4
TR 90,25,26368
MAA 108,112,0
TR 92,25,38272
MAA 108,116,20
buffer_load_dword v29, s[36:39], s53 offen offset:2048 lds
MAA 140,20,124
TR 94,25,38784
s_add_u32 s53, s53, 128
MAA 140,0,120
TR 96,25,26880
MAA 144,4,120
buffer_load_dwordx4 v[188:191], v26, s[16:19], s75 offen offset:2048 sc1
MAA 144,24,124
TR 98,25,27392
MAA 148,28,124
TR 100,25,39296
MAA 148,8,120
TR 102,25,39808
MAA 152,12,120
MAA 152,32,124
MAA 160,36,124
MAA 160,16,120
s_waitcnt lgkmcnt(8)
s_barrier
MAA 60,80,40
TR 104,25,24864
s_add_u32 m0, s56, 86400
MAA 60,84,60
buffer_load_dwordx4 v18, s[20:23], s54 offen lds
MAA 64,84,64
s_sub_u32 s47, s47, 1
s_cbranch_scc1 .Lx32
.Lx32b:
MAA 64,80,44
TR 106,25,25376
TR 108,25,37280
MAA 68,80,48
TR 110,25,37792
s_waitcnt vmcnt(15)
v_add_f32 v164, v164, v180
MAA 68,84,68
buffer_load_dwordx4 v19, s[20:23], s54 offen offset:1024 lds
MAA 72,84,72
TR 112,25,25888
MAA 72,80,52
TR 114,25,26400
s_waitcnt lgkmcnt(6)
MAA 104,88,52
v_add_f32 v165, v165, v181
MAA 104,92,72
buffer_load_dwordx4 v20, s[20:23], s54 offen offset:2048 lds
MAA 100,92,68
s_add_u32 s54, s54, 196608
s_add_u32 m0, s55, 55488
MAA 100,88,48
buffer_load_dwordx4 v21, s[36:39], s52 offen lds
MAA 96,88,44
TR 116,25,38304
MAA 96,92,64
TR 118,25,38816
TR 120,25,26912
MAA 92,92,60
TR 122,25,27424
v_add_f32 v166, v166, v182
MAA 92,88,40
buffer_load_dwordx4 v28, s[36:39], s52 offen offset:1024 lds
MAA 124,40,96
TR 124,25,39328
MAA 124,60,100
TR 126,25,39840
MAA 128,64,100
ds_read_b128 a[0:3], v23
v_add_f32 v167, v167, v183
MAA 128,44,96
buffer_load_dword v22, s[36:39], s52 offen offset:2048 lds
MAA 132,48,96
RD 4,23,2304
s_add_u32 s52, s52, 128
MAA 132,68,100
buffer_load_dwordx4 v[192:195], v26, s[16:19], s75 offen offset:3072 sc1
MAA 136,72,100
RD 8,23,4608
MAA 136,52,96
RD 12,23,6912
ds_read_b128 a[16:19], v24
MAA 156,56,96
MAA 156,76,100
s_waitcnt vmcnt(18) lgkmcnt(5)
s_barrier
MAA 76,104,40
ds_read_b128 a[20:23], v30
s_waitcnt vmcnt(14)
v_add_f32 v164, v164, v184
MAA 76,108,60
RD 24,30,2304
s_add_u32 m0, s56, 98816
MAA 80,108,64
buffer_load_dwordx4 v18, s[20:23], s54 offen lds
MAA 80,104,44
RD 28,30,4608
v_add_f32 v165, v165, v185
MAA 84,104,48
RD 32,30,6912
v_add_f32 v166, v166, v186
MAA 84,108,68
ds_read_b128 a[36:39], v31
v_add_f32 v167, v167, v187
MAA 88,108,72
buffer_load_dwordx4 v19, s[20:23], s54 offen offset:1024 lds
MAA 88,104,52
TR 80,25,49664
MAA 244,104,56
TR 82,25,50176
MAA 244,108,76
TR 84,25,62080
MAA 120,116,72
buffer_load_dwordx4 v20, s[20:23], s54 offen offset:2048 lds
MAA 120,112,52
TR 86,25,62592
s_add_u32 s54, s54, 196608
MAA 116,112,48
TR 88,25,50688
s_add_u32 m0, s55, 57792
MAA 116,116,68
TR 90,25,51200
MAA 112,116,64
buffer_load_dwordx4 v21, s[36:39], s53 offen lds
MAA 112,112,44
TR 92,25,63104
MAA 108,112,40
TR 94,25,63616
MAA 108,116,60
TR 96,25,51712
MAA 140,60,124
buffer_load_dwordx4 v28, s[36:39], s53 offen offset:1024 lds
MAA 140,40,120
TR 98,25,52224
MAA 144,44,120
TR 100,25,64128
MAA 144,64,124
TR 102,25,64640
MAA 148,68,124
buffer_load_dword v29, s[36:39], s53 offen offset:2048 lds
MAA 148,48,120
s_add_u32 s53, s53, 128
MAA 152,52,120
MAA 152,72,124
MAA 160,76,124
MAA 160,56,120
s_waitcnt lgkmcnt(8)
s_barrier
MAA 60,80,0
TR 104,25,49696
s_waitcnt vmcnt(13)
v_add_f32 v164, v164, v188
MAA 60,84,20
TR 106,25,50208
s_add_u32 m0, s56, 111232
MAA 64,84,24
buffer_load_dwordx4 v18, s[20:23], s54 offen lds
MAA 64,80,4
TR 108,25,62112
v_add_f32 v165, v165, v189
MAA 68,80,8
TR 110,25,62624
v_add_f32 v166, v166, v190
MAA 68,84,28
buffer_load_dwordx4 v19, s[20:23], s54 offen offset:1024 lds
MAA 72,84,32
TR 112,25,50720
v_add_f32 v167, v167, v191
MAA 72,80,12
TR 114,25,51232
s_waitcnt lgkmcnt(6)
MAA 104,88,12
buffer_load_dwordx4 v20, s[20:23], s54 offen offset:2048 lds
MAA 104,92,32
TR 116,25,63136
s_add_u32 s54, s54, 196608
MAA 100,92,28
TR 118,25,63648
s_add_u32 m0, s59, 0
MAA 100,88,8
TR 120,25,51744
s_xor_b32 s58, s87, 1048576
MAA 96,88,4
buffer_load_dwordx4 v5, s[24:27], s58 offen lds
MAA 96,92,24
TR 122,25,52256
MAA 92,92,20
TR 124,25,64160
MAA 92,88,0
buffer_load_dwordx4 v6, s[24:27], s58 offen offset:1024 lds
MAA 124,0,96
TR 126,25,64672
s_add_u32 m0, s59, 8320
MAA 124,20,100
RD 40,23,18496
s_xor_b32 s58, s87, 1179648
MAA 128,24,100
buffer_load_dwordx4 v5, s[24:27], s58 offen lds
MAA 128,4,96
RD 44,23,20800
MAA 132,8,96
RD 48,23,23104
MAA 132,28,100
buffer_load_dwordx4 v6, s[24:27], s58 offen offset:1024 lds
MAA 136,32,100
RD 52,23,25408
MAA 136,12,96
RD 56,24,18496
MAA 156,16,96
MAA 156,36,100
s_waitcnt vmcnt(17) lgkmcnt(5)
s_barrier
MAA 76,104,0
RD 60,30,18496
s_waitcnt vmcnt(13)
v_add_f32 v164, v164, v192
MAA 76,108,20
RD 64,30,20800
s_add_u32 m0, s56, 123648
MAA 80,108,24
buffer_load_dwordx4 v18, s[20:23], s54 offen lds
MAA 80,104,4
RD 68,30,23104
v_add_f32 v165, v165, v193
MAA 84,104,8
RD 72,30,25408
v_add_f32 v166, v166, v194
MAA 84,108,28
RD 76,31,18496
v_add_f32 v167, v167, v195
MAA 88,108,32
ds_read_b64_tr_b16 a[80:81], v25
MAA 88,104,12
TR 82,25,512
MAA 244,104,16
TR 84,25,12416
MAA 244,108,36
TR 86,25,12928
MAA 120,116,32
buffer_load_dwordx4 v19, s[20:23], s54 offen offset:1024 lds
MAA 120,112,12
TR 88,25,1024
MAA 116,112,8
TR 90,25,1536
MAA 116,116,28
TR 92,25,13440
MAA 112,116,24
TR 94,25,13952
MAA 112,112,4
TR 96,25,2048
MAA 108,112,0
TR 98,25,2560
MAA 108,116,20
TR 100,25,14464
MAA 140,20,124
buffer_load_dwordx4 v20, s[20:23], s54 offen offset:2048 lds
MAA 140,0,120
TR 102,25,14976
s_add_u32 s54, s54, 196608
MAA 144,4,120
MAA 144,24,124
MAA 148,28,124
MAA 148,8,120
MAA 152,12,120
MAA 152,32,124
MAA 160,36,124
MAA 160,16,120
s_waitcnt lgkmcnt(8)
s_barrier
MAA 60,80,40
TR 104,25,32
MAA 60,84,60
TR 106,25,544
s_add_u32 m0, s56, 136064
MAA 64,84,64
buffer_load_dwordx4 v18, s[20:23], s54 offen lds
MAA 64,80,44
TR 108,25,12448
MAA 68,80,48
TR 110,25,12960
MAA 68,84,68
buffer_load_dwordx4 v19, s[20:23], s54 offen offset:1024 lds
MAA 72,84,72
TR 112,25,1056
MAA 72,80,52
TR 114,25,1568
s_waitcnt lgkmcnt(6)
MAA 104,88,52
buffer_load_dwordx4 v20, s[20:23], s54 offen offset:2048 lds
MAA 104,92,72
TR 116,25,13472
s_add_u32 s54, s54, 196608
MAA 100,92,68
TR 118,25,13984
s_add_u32 m0, s59, 16640
MAA 100,88,48
TR 120,25,2080
s_xor_b32 s58, s87, 1310720
MAA 96,88,44
buffer_load_dwordx4 v5, s[24:27], s58 offen lds
MAA 96,92,64
TR 122,25,2592
MAA 92,92,60
TR 124,25,14496
MAA 92,88,40
buffer_load_dwordx4 v6, s[24:27], s58 offen offset:1024 lds
MAA 124,40,96
TR 126,25,15008
s_add_u32 m0, s59, 24960
MAA 124,60,100
RD 0,23,36992
s_xor_b32 s58, s87, 1441792
MAA 128,64,100
buffer_load_dwordx4 v5, s[24:27], s58 offen lds
MAA 128,44,96
RD 4,23,39296
MAA 132,48,96
RD 8,23,41600
MAA 132,68,100
buffer_load_dwordx4 v6, s[24:27], s58 offen offset:1024 lds
MAA 136,72,100
RD 12,23,43904
MAA 136,52,96
RD 16,24,36992
MAA 156,56,96
v_permlane32_swap_b32 v164, v166
MAA 156,76,100
v_permlane32_swap_b32 v165, v167
v_add_f32 v164, v164, v166
v_add_f32 v165, v165, v167
v_mul_f32 v164, 0xba800000, v164
v_mul_f32 v165, 0x3a800000, v165
v_fma_f32 v165, -v164, v164, v165
v_max_f32 v165, 0, v165
v_add_f32 v165, 0x3727c5ac, v165
v_rsq_f32 v166, v165
s_nop 0
v_mov_b32 v165, v166
v_mul_f32 v166, 0x3e8293ee, v166
s_waitcnt vmcnt(14) lgkmcnt(5)
s_barrier
MAA 76,104,40
ds_write_b128 v7, v[164:167]
MAA 76,108,60
ds_write_b32 v17, v164
s_add_u32 m0, s59, 74880
MAA 80,108,64
ds_write_b32 v17, v165 offset:1024
s_xor_b32 s58, s87, 131072
MAA 80,104,44
buffer_load_dwordx4 v5, s[24:27], s58 offen lds
MAA 84,104,48
RD 20,30,36992
MAA 84,108,68
RD 24,30,39296
MAA 88,108,72
RD 28,30,41600
MAA 88,104,52
RD 32,30,43904
MAA 244,104,56
RD 36,31,36992
MAA 244,108,76
buffer_load_dwordx4 v6, s[24:27], s58 offen offset:1024 lds
MAA 120,116,72
TR 80,25,24832
s_add_u32 m0, s59, 83200
MAA 120,112,52
TR 82,25,25344
s_xor_b32 s58, s87, 262144
MAA 116,112,48
TR 84,25,37248
MAA 116,116,68
TR 86,25,37760
MAA 112,116,64
TR 88,25,25856
MAA 112,112,44
buffer_load_dwordx4 v5, s[24:27], s58 offen lds
MAA 108,112,40
TR 90,25,26368
MAA 108,116,60
TR 92,25,38272
MAA 140,60,124
TR 94,25,38784
MAA 140,40,120
TR 96,25,26880
MAA 144,44,120
TR 98,25,27392
MAA 144,64,124
buffer_load_dwordx4 v6, s[24:27], s58 offen offset:1024 lds
MAA 148,68,124
TR 100,25,39296
MAA 148,48,120
TR 102,25,39808
MAA 152,52,120
MAA 152,72,124
MAA 160,76,124
MAA 160,56,120
s_waitcnt vmcnt(8) lgkmcnt(0)
s_barrier
MAA 104,88,12
TR 112,25,25888
s_add_u32 m0, s59, 33280
MAA 104,92,32
TR 114,25,26400
s_xor_b32 s58, s87, 1572864
MAA 100,92,28
buffer_load_dwordx4 v5, s[24:27], s58 offen lds
MAA 100,88,8
TR 116,25,38304
MAA 96,88,4
TR 118,25,38816
MAA 96,92,24
TR 120,25,26912
MAA 92,92,20
buffer_load_dwordx4 v6, s[24:27], s58 offen offset:1024 lds
MAA 92,88,0
TR 122,25,27424
s_add_u32 m0, s59, 41600
MAA 156,16,96
TR 124,25,39328
s_xor_b32 s58, s87, 1703936
MAA 156,36,100
TR 126,25,39840
MAA 72,84,32
buffer_load_dwordx4 v5, s[24:27], s58 offen lds
MAA 72,80,12
TR 104,25,24864
MAA 68,80,8
TR 106,25,25376
MAA 68,84,28
TR 108,25,37280
MAA 64,84,24
buffer_load_dwordx4 v6, s[24:27], s58 offen offset:1024 lds
MAA 64,80,4
TR 110,25,37792
s_xor_b32 s58, s87, 393216
MAA 60,80,0
RD 40,23,55488
MAA 60,84,20
RD 44,23,57792
s_waitcnt lgkmcnt(12)
MAA 120,112,12
RD 48,23,60096
s_waitcnt lgkmcnt(11)
MAA 120,116,32
RD 52,23,62400
MAA 116,116,28
RD 56,24,55488
MAA 116,112,8
RD 60,30,55488
MAA 112,112,4
RD 64,30,57792
MAA 112,116,24
s_waitcnt lgkmcnt(7)
s_barrier
RD 68,30,60096
MAA 108,116,20
RD 72,30,62400
s_add_u32 m0, s59, 91520
MAA 108,112,0
RD 76,31,55488
MAA 160,16,120
TR 144,25,50688
MAA 160,36,124
TR 146,25,51200
MAA 244,108,36
TR 148,25,63104
MAA 244,104,16
TR 150,25,63616
MAA 88,104,12
TR 152,25,50720
MAA 88,108,32
TR 154,25,51232
MAA 84,108,28
TR 156,25,63136
MAA 84,104,8
TR 158,25,63648
MAA 80,104,4
TR 160,25,51712
MAA 80,108,24
TR 162,25,52224
MAA 76,108,20
TR 164,25,64128
MAA 76,104,0
TR 166,25,64640
s_waitcnt lgkmcnt(10)
MAA 104,144,52
TR 168,25,51744
s_waitcnt lgkmcnt(9)
MAA 104,148,72
TR 170,25,52256
MAA 100,148,68
TR 172,25,64160
MAA 100,144,48
TR 174,25,64672
MAA 96,144,44
TR 136,25,49696
MAA 96,148,64
TR 138,25,50208
MAA 92,148,60
TR 140,25,62112
MAA 92,144,40
TR 142,25,62624
s_waitcnt lgkmcnt(14)
MAA 120,152,52
TR 128,25,49664
s_waitcnt lgkmcnt(13)
MAA 120,156,72
TR 130,25,50176
MAA 116,156,68
TR 132,25,62080
MAA 116,152,48
TR 134,25,62592
MAA 112,152,44
ds_read_b128 v[232:235], v10 offset:1792
MAA 112,156,64
ds_read_b128 v[228:231], v10 offset:1536
MAA 108,156,60
ds_read_b128 v[224:227], v10 offset:1280
MAA 108,152,40
ds_read_b128 v[220:223], v10 offset:1024
s_waitcnt lgkmcnt(15)
MAA 156,56,160
buffer_load_dwordx4 v5, s[24:27], s58 offen lds
MAA 156,76,164
s_waitcnt lgkmcnt(12)
MAA 160,76,172
MAA 160,56,168
s_waitcnt lgkmcnt(4)
s_barrier
MAA 244,136,56
buffer_load_dwordx4 v6, s[24:27], s58 offen offset:1024 lds
MAA 244,140,76
s_add_u32 m0, s59, 99840
s_xor_b32 s58, s87, 524288
MAA 88,140,72
MAA 88,136,52
MAA 84,136,48
buffer_load_dwordx4 v5, s[24:27], s58 offen lds
MAA 84,140,68
buffer_load_dwordx4 v6, s[24:27], s58 offen offset:1024 lds
s_add_u32 m0, s59, 108160
s_xor_b32 s58, s87, 655360
buffer_load_dwordx4 v5, s[24:27], s58 offen lds
buffer_load_dwordx4 v6, s[24:27], s58 offen offset:1024 lds
s_mov_b32 exec_lo, 0x10001
s_mov_b32 exec_hi, 0x10001
ds_write_b128 v13, v[244:247] offset:64
s_mov_b64 exec, 0xffff
ds_write_b32 v12, v156 offset:512
ds_write_b32 v12, v160 offset:576
s_mov_b64 exec, -1
MAA 80,136,44
MAA 80,140,64
MAA 76,140,60
MAA 76,136,40
MAA 72,128,52
MAA 72,132,72
s_waitcnt lgkmcnt(0)
s_barrier
MAA 68,128,48
ds_read_b128 v[28:31], v13
s_add_u32 m0, s59, 49920
MAA 68,132,68
ds_read_b128 v[32:35], v13 offset:64
s_xor_b32 s58, s87, 1835008
MAA 64,132,64
ds_read_b128 v[36:39], v13 offset:256
MAA 64,128,44
ds_read_b128 v[40:43], v13 offset:320
MAA 60,128,40
ds_read_b32 v44, v12 offset:512
MAA 60,132,60
ds_read_b32 v45, v12 offset:576
ds_read_b128 v[240:243], v11 offset:704
ds_read_b128 v[244:247], v11 offset:1728
ds_read_b128 v[18:21], v11 offset:448
ds_read_b128 v[22:25], v11 offset:1472
buffer_load_dwordx4 v5, s[24:27], s58 offen lds
s_waitcnt lgkmcnt(9)
v_pk_fma_f32 v[72:73], v[28:29], v[232:233], v[72:73] op_sel_hi:[1,0,1]
v_cvt_pk_bf16_f32 v176, v72, v73
v_pk_fma_f32 v[74:75], v[30:31], v[232:233], v[74:75] op_sel_hi:[1,0,1]
v_cvt_pk_bf16_f32 v177, v74, v75
s_waitcnt lgkmcnt(8)
v_pk_fma_f32 v[88:89], v[32:33], v[232:233], v[88:89] op_sel_hi:[1,0,1]
v_cvt_pk_bf16_f32 v178, v88, v89
v_pk_fma_f32 v[90:91], v[34:35], v[232:233], v[90:91] op_sel_hi:[1,0,1]
s_waitcnt lgkmcnt(7)
v_pk_fma_f32 v[104:105], v[36:37], v[232:233], v[104:105] op_sel_hi:[1,0,1]
v_pk_mul_f32 v[104:105], v[104:105], v[232:233] op_sel:[0,1] op_sel_hi:[1,1]
v_cvt_pk_bf16_f32 v196, v104, v105
v_pk_fma_f32 v[106:107], v[38:39], v[232:233], v[106:107] op_sel_hi:[1,0,1]
v_pk_mul_f32 v[106:107], v[106:107], v[232:233] op_sel:[0,1] op_sel_hi:[1,1]
v_cvt_pk_bf16_f32 v197, v106, v107
s_waitcnt lgkmcnt(6)
v_pk_fma_f32 v[120:121], v[40:41], v[232:233], v[120:121] op_sel_hi:[1,0,1]
v_pk_mul_f32 v[120:121], v[120:121], v[232:233] op_sel:[0,1] op_sel_hi:[1,1]
v_cvt_pk_bf16_f32 v198, v120, v121
v_pk_fma_f32 v[122:123], v[42:43], v[232:233], v[122:123] op_sel_hi:[1,0,1]
v_pk_mul_f32 v[122:123], v[122:123], v[232:233] op_sel:[0,1] op_sel_hi:[1,1]
v_cvt_pk_bf16_f32 v199, v122, v123
v_pk_fma_f32 v[100:101], v[36:37], v[228:229], v[100:101] op_sel_hi:[1,0,1]
v_pk_mul_f32 v[100:101], v[100:101], v[228:229] op_sel:[0,1] op_sel_hi:[1,1]
s_waitcnt lgkmcnt(3)
v_pk_fma_f32 v[156:157], v[240:241], v[44:45], v[156:157] op_sel_hi:[1,0,1]
v_pk_fma_f32 v[158:159], v[242:243], v[44:45], v[158:159] op_sel_hi:[1,0,1]
s_waitcnt lgkmcnt(2)
v_pk_mul_f32 v[156:157], v[156:157], v[244:245]
v_cvt_pk_bf16_f32 v236, v156, v157
v_pk_mul_f32 v[158:159], v[158:159], v[246:247]
v_cvt_pk_bf16_f32 v237, v158, v159
v_pk_fma_f32 v[160:161], v[240:241], v[44:45], v[160:161] op_sel:[0,1,0] op_sel_hi:[1,1,1]
v_pk_mul_f32 v[160:161], v[160:161], v[244:245]
v_cvt_pk_bf16_f32 v238, v160, v161
v_pk_fma_f32 v[162:163], v[242:243], v[44:45], v[162:163] op_sel:[0,1,0] op_sel_hi:[1,1,1]
v_pk_mul_f32 v[162:163], v[162:163], v[246:247]
v_cvt_pk_bf16_f32 v239, v162, v163
ds_write_b128 v8, v[236:239] offset:1024
v_cvt_pk_bf16_f32 v192, v100, v101
v_pk_fma_f32 v[102:103], v[38:39], v[228:229], v[102:103] op_sel_hi:[1,0,1]
v_pk_mul_f32 v[102:103], v[102:103], v[228:229] op_sel:[0,1] op_sel_hi:[1,1]
v_cvt_pk_bf16_f32 v193, v102, v103
v_pk_fma_f32 v[116:117], v[40:41], v[228:229], v[116:117] op_sel_hi:[1,0,1]
v_pk_mul_f32 v[116:117], v[116:117], v[228:229] op_sel:[0,1] op_sel_hi:[1,1]
v_cvt_pk_bf16_f32 v194, v116, v117
v_pk_fma_f32 v[118:119], v[42:43], v[228:229], v[118:119] op_sel_hi:[1,0,1]
v_pk_mul_f32 v[118:119], v[118:119], v[228:229] op_sel:[0,1] op_sel_hi:[1,1]
v_cvt_pk_bf16_f32 v195, v118, v119
v_pk_fma_f32 v[96:97], v[36:37], v[224:225], v[96:97] op_sel_hi:[1,0,1]
v_pk_mul_f32 v[96:97], v[96:97], v[224:225] op_sel:[0,1] op_sel_hi:[1,1]
v_cvt_pk_bf16_f32 v188, v96, v97
v_pk_fma_f32 v[98:99], v[38:39], v[224:225], v[98:99] op_sel_hi:[1,0,1]
v_pk_mul_f32 v[98:99], v[98:99], v[224:225] op_sel:[0,1] op_sel_hi:[1,1]
v_cvt_pk_bf16_f32 v189, v98, v99
v_pk_fma_f32 v[112:113], v[40:41], v[224:225], v[112:113] op_sel_hi:[1,0,1]
v_pk_mul_f32 v[112:113], v[112:113], v[224:225] op_sel:[0,1] op_sel_hi:[1,1]
v_cvt_pk_bf16_f32 v190, v112, v113
v_pk_fma_f32 v[114:115], v[42:43], v[224:225], v[114:115] op_sel_hi:[1,0,1]
v_pk_mul_f32 v[114:115], v[114:115], v[224:225] op_sel:[0,1] op_sel_hi:[1,1]
v_cvt_pk_bf16_f32 v191, v114, v115
v_pk_fma_f32 v[92:93], v[36:37], v[220:221], v[92:93] op_sel_hi:[1,0,1]
v_pk_mul_f32 v[92:93], v[92:93], v[220:221] op_sel:[0,1] op_sel_hi:[1,1]
v_cvt_pk_bf16_f32 v184, v92, v93
v_pk_fma_f32 v[94:95], v[38:39], v[220:221], v[94:95] op_sel_hi:[1,0,1]
v_pk_mul_f32 v[94:95], v[94:95], v[220:221] op_sel:[0,1] op_sel_hi:[1,1]
v_cvt_pk_bf16_f32 v185, v94, v95
v_pk_fma_f32 v[108:109], v[40:41], v[220:221], v[108:109] op_sel_hi:[1,0,1]
v_pk_mul_f32 v[108:109], v[108:109], v[220:221] op_sel:[0,1] op_sel_hi:[1,1]
v_cvt_pk_bf16_f32 v186, v108, v109
v_pk_fma_f32 v[110:111], v[42:43], v[220:221], v[110:111] op_sel_hi:[1,0,1]
v_pk_mul_f32 v[110:111], v[110:111], v[220:221] op_sel:[0,1] op_sel_hi:[1,1]
v_cvt_pk_bf16_f32 v187, v110, v111
v_cvt_pk_bf16_f32 v179, v90, v91
v_pk_fma_f32 v[68:69], v[28:29], v[228:229], v[68:69] op_sel_hi:[1,0,1]
v_cvt_pk_bf16_f32 v172, v68, v69
v_pk_fma_f32 v[70:71], v[30:31], v[228:229], v[70:71] op_sel_hi:[1,0,1]
v_cvt_pk_bf16_f32 v173, v70, v71
v_pk_fma_f32 v[84:85], v[32:33], v[228:229], v[84:85] op_sel_hi:[1,0,1]
v_cvt_pk_bf16_f32 v174, v84, v85
v_pk_fma_f32 v[86:87], v[34:35], v[228:229], v[86:87] op_sel_hi:[1,0,1]
v_cvt_pk_bf16_f32 v175, v86, v87
v_pk_fma_f32 v[64:65], v[28:29], v[224:225], v[64:65] op_sel_hi:[1,0,1]
v_cvt_pk_bf16_f32 v168, v64, v65
v_pk_fma_f32 v[66:67], v[30:31], v[224:225], v[66:67] op_sel_hi:[1,0,1]
v_cvt_pk_bf16_f32 v169, v66, v67
v_pk_fma_f32 v[80:81], v[32:33], v[224:225], v[80:81] op_sel_hi:[1,0,1]
v_cvt_pk_bf16_f32 v170, v80, v81
v_pk_fma_f32 v[82:83], v[34:35], v[224:225], v[82:83] op_sel_hi:[1,0,1]
v_cvt_pk_bf16_f32 v171, v82, v83
v_pk_fma_f32 v[60:61], v[28:29], v[220:221], v[60:61] op_sel_hi:[1,0,1]
v_cvt_pk_bf16_f32 v164, v60, v61
v_pk_fma_f32 v[62:63], v[30:31], v[220:221], v[62:63] op_sel_hi:[1,0,1]
v_cvt_pk_bf16_f32 v165, v62, v63
v_pk_fma_f32 v[76:77], v[32:33], v[220:221], v[76:77] op_sel_hi:[1,0,1]
v_cvt_pk_bf16_f32 v166, v76, v77
v_pk_fma_f32 v[78:79], v[34:35], v[220:221], v[78:79] op_sel_hi:[1,0,1]
s_waitcnt lgkmcnt(0)
s_barrier
v_cvt_pk_bf16_f32 v167, v78, v79
v_mfma_f32_16x16x32_bf16 v[120:123], v[196:199], v[176:179], v[50:53]
ds_read_b128 v[180:183], v9
v_mfma_f32_16x16x32_bf16 v[104:107], v[192:195], v[176:179], v[46:49]
buffer_load_dwordx4 v6, s[24:27], s58 offen offset:1024 lds
v_mfma_f32_16x16x32_bf16 v[116:119], v[192:195], v[172:175], v[50:53]
ds_read_b64 v[200:201], v9 offset:1024
s_add_u32 m0, s59, 58240
v_mfma_f32_16x16x32_bf16 v[100:103], v[188:191], v[172:175], v[46:49]
ds_read_b64 v[210:211], v9 offset:1032
s_xor_b32 s58, s87, 1966080
v_mfma_f32_16x16x32_bf16 v[112:115], v[188:191], v[168:171], v[50:53]
ds_read_b128 v[240:243], v11 offset:384
v_max3_f32 v88, v104, v105, v106
v_mfma_f32_16x16x32_bf16 v[96:99], v[184:187], v[168:171], v[46:49]
buffer_load_dwordx4 v5, s[24:27], s58 offen lds
v_mfma_f32_16x16x32_bf16 v[108:111], v[184:187], v[164:167], v[50:53]
ds_read_b128 v[244:247], v11 offset:1408
v_max3_f32 v89, v107, v120, v121
v_max3_f32 v88, v88, v122, v123
v_max_f32 v90, v88, v89
v_max_f32 v89, v88, v89
v_max3_f32 v84, v100, v101, v102
v_max3_f32 v85, v103, v116, v117
s_waitcnt lgkmcnt(4)
v_mfma_f32_16x16x32_bf16 v[92:95], v[180:183], v[164:167], v[46:49]
ds_read_b128 v[28:31], v11 offset:320
v_permlane16_swap_b32 v90, v89
MAA 136,12,96
buffer_load_dwordx4 v6, s[24:27], s58 offen offset:1024 lds
MAA 136,32,100
ds_read_b128 v[32:35], v11 offset:1344
s_add_u32 m0, s59, 66560
MAA 136,52,160
ds_read_b128 v[36:39], v11 offset:256
s_xor_b32 s58, s87, 0
MAA 136,72,164
ds_read_b128 v[40:43], v11 offset:1280
v_max_f32 v88, v90, v89
MAA 152,72,172
buffer_load_dwordx4 v5, s[24:27], s58 offen lds
MAA 152,52,168
v_max_f32 v89, v90, v89
v_max3_f32 v84, v84, v118, v119
MAA 152,32,124
v_permlane32_swap_b32 v88, v89
MAA 152,12,120
v_max_f32 v88, v88, v89
v_mul_f32 v88, v88, v234
v_max_f32 v86, v84, v85
v_max_f32 v85, v84, v85
v_max3_f32 v80, v96, v97, v98
v_max3_f32 v81, v99, v112, v113
v_permlane16_swap_b32 v86, v85
v_max3_f32 v80, v80, v114, v115
v_max_f32 v84, v86, v85
v_max_f32 v85, v86, v85
v_max_f32 v82, v80, v81
v_max_f32 v81, v80, v81
v_permlane32_swap_b32 v84, v85
v_max3_f32 v76, v92, v93, v94
v_max_f32 v84, v84, v85
v_mul_f32 v84, v84, v230
v_permlane16_swap_b32 v82, v81
v_max3_f32 v77, v95, v108, v109
v_max_f32 v80, v82, v81
v_max_f32 v81, v82, v81
v_max3_f32 v76, v76, v110, v111
v_max_f32 v78, v76, v77
v_permlane32_swap_b32 v80, v81
v_max_f32 v77, v76, v77
v_max_f32 v80, v80, v81
v_mul_f32 v80, v80, v226
v_permlane16_swap_b32 v78, v77
v_pk_fma_f32 v[104:105], v[104:105], v[234:235], v[88:89] op_sel_hi:[1,0,0] neg_lo:[0,0,1] neg_hi:[0,0,1]
v_max_f32 v76, v78, v77
v_max_f32 v77, v78, v77
v_pk_fma_f32 v[106:107], v[106:107], v[234:235], v[88:89] op_sel_hi:[1,0,0] neg_lo:[0,0,1] neg_hi:[0,0,1]
v_pk_fma_f32 v[120:121], v[120:121], v[234:235], v[88:89] op_sel_hi:[1,0,0] neg_lo:[0,0,1] neg_hi:[0,0,1]
v_permlane32_swap_b32 v76, v77
v_pk_fma_f32 v[122:123], v[122:123], v[234:235], v[88:89] op_sel_hi:[1,0,0] neg_lo:[0,0,1] neg_hi:[0,0,1]
v_max_f32 v76, v76, v77
v_mul_f32 v76, v76, v222
v_pk_fma_f32 v[100:101], v[100:101], v[230:231], v[84:85] op_sel_hi:[1,0,0] neg_lo:[0,0,1] neg_hi:[0,0,1]
v_pk_fma_f32 v[102:103], v[102:103], v[230:231], v[84:85] op_sel_hi:[1,0,0] neg_lo:[0,0,1] neg_hi:[0,0,1]
v_pk_fma_f32 v[116:117], v[116:117], v[230:231], v[84:85] op_sel_hi:[1,0,0] neg_lo:[0,0,1] neg_hi:[0,0,1]
v_pk_fma_f32 v[118:119], v[118:119], v[230:231], v[84:85] op_sel_hi:[1,0,0] neg_lo:[0,0,1] neg_hi:[0,0,1]
v_pk_fma_f32 v[96:97], v[96:97], v[226:227], v[80:81] op_sel_hi:[1,0,0] neg_lo:[0,0,1] neg_hi:[0,0,1]
v_pk_fma_f32 v[98:99], v[98:99], v[226:227], v[80:81] op_sel_hi:[1,0,0] neg_lo:[0,0,1] neg_hi:[0,0,1]
v_pk_fma_f32 v[112:113], v[112:113], v[226:227], v[80:81] op_sel_hi:[1,0,0] neg_lo:[0,0,1] neg_hi:[0,0,1]
v_pk_fma_f32 v[114:115], v[114:115], v[226:227], v[80:81] op_sel_hi:[1,0,0] neg_lo:[0,0,1] neg_hi:[0,0,1]
v_pk_fma_f32 v[92:93], v[92:93], v[222:223], v[76:77] op_sel_hi:[1,0,0] neg_lo:[0,0,1] neg_hi:[0,0,1]
v_pk_fma_f32 v[94:95], v[94:95], v[222:223], v[76:77] op_sel_hi:[1,0,0] neg_lo:[0,0,1] neg_hi:[0,0,1]
v_pk_fma_f32 v[108:109], v[108:109], v[222:223], v[76:77] op_sel_hi:[1,0,0] neg_lo:[0,0,1] neg_hi:[0,0,1]
v_pk_fma_f32 v[110:111], v[110:111], v[222:223], v[76:77] op_sel_hi:[1,0,0] neg_lo:[0,0,1] neg_hi:[0,0,1]
v_pk_fma_f32 v[136:137], v[18:19], v[44:45], v[136:137] op_sel_hi:[1,0,1]
v_pk_mul_f32 v[136:137], v[136:137], v[22:23]
v_pk_fma_f32 v[138:139], v[20:21], v[44:45], v[138:139] op_sel_hi:[1,0,1]
v_pk_mul_f32 v[138:139], v[138:139], v[24:25]
v_pk_fma_f32 v[152:153], v[18:19], v[44:45], v[152:153] op_sel:[0,1,0] op_sel_hi:[1,1,1]
v_pk_mul_f32 v[152:153], v[152:153], v[22:23]
v_pk_fma_f32 v[154:155], v[20:21], v[44:45], v[154:155] op_sel:[0,1,0] op_sel_hi:[1,1,1]
v_pk_mul_f32 v[154:155], v[154:155], v[24:25]
v_exp_f32 v104, v104
s_nop 0
MAA 132,8,96
buffer_load_dwordx4 v6, s[24:27], s58 offen offset:1024 lds
MAA 132,28,100
s_add_u32 m0, s59, 116480
s_xor_b32 s58, s87, 786432
v_exp_f32 v105, v105
MAA 132,48,160
v_exp_f32 v106, v106
MAA 132,68,164
v_exp_f32 v107, v107
MAA 148,68,172
buffer_load_dwordx4 v5, s[24:27], s58 offen lds
MAA 148,48,168
v_exp_f32 v120, v120
MAA 148,28,124
v_exp_f32 v121, v121
MAA 148,8,120
v_exp_f32 v122, v122
MAA 128,4,96
buffer_load_dwordx4 v6, s[24:27], s58 offen offset:1024 lds
MAA 128,24,100
s_add_u32 m0, s59, 124800
s_xor_b32 s58, s87, 917504
v_exp_f32 v123, v123
MAA 128,44,160
v_exp_f32 v100, v100
MAA 128,64,164
v_exp_f32 v101, v101
MAA 144,64,172
buffer_load_dwordx4 v5, s[24:27], s58 offen lds
MAA 144,44,168
v_exp_f32 v102, v102
MAA 144,24,124
v_exp_f32 v103, v103
MAA 144,4,120
v_exp_f32 v116, v116
MAA 124,0,96
buffer_load_dwordx4 v6, s[24:27], s58 offen offset:1024 lds
MAA 124,20,100
v_exp_f32 v117, v117
MAA 124,40,160
v_exp_f32 v118, v118
MAA 124,60,164
v_exp_f32 v119, v119
MAA 140,60,172
v_exp_f32 v96, v96
MAA 140,40,168
v_exp_f32 v97, v97
MAA 140,20,124
v_exp_f32 v98, v98
MAA 140,0,120
v_cvt_pk_bf16_f32 v72, v104, v105
v_cvt_pk_bf16_f32 v73, v106, v107
v_cvt_pk_bf16_f32 v74, v120, v121
v_cvt_pk_bf16_f32 v75, v122, v123
v_cvt_pk_bf16_f32 v68, v100, v101
v_cvt_pk_bf16_f32 v69, v102, v103
v_cvt_pk_bf16_f32 v70, v116, v117
v_cvt_pk_bf16_f32 v71, v118, v119
v_exp_f32 v99, v99
v_exp_f32 v112, v112
v_exp_f32 v113, v113
v_exp_f32 v114, v114
v_exp_f32 v115, v115
v_cvt_pk_bf16_f32 v64, v96, v97
v_cvt_pk_bf16_f32 v65, v98, v99
v_cvt_pk_bf16_f32 v66, v112, v113
v_cvt_pk_bf16_f32 v67, v114, v115
v_cvt_pk_bf16_f32 v208, v136, v137
v_cvt_pk_bf16_f32 v209, v138, v139
v_cvt_pk_bf16_f32 v218, v152, v153
v_cvt_pk_bf16_f32 v219, v154, v155
s_waitcnt lgkmcnt(5)
v_pk_fma_f32 v[132:133], v[240:241], v[44:45], v[132:133] op_sel_hi:[1,0,1]
s_waitcnt lgkmcnt(4)
v_pk_mul_f32 v[132:133], v[132:133], v[244:245]
v_cvt_pk_bf16_f32 v206, v132, v133
v_pk_fma_f32 v[134:135], v[242:243], v[44:45], v[134:135] op_sel_hi:[1,0,1]
v_pk_mul_f32 v[134:135], v[134:135], v[246:247]
v_cvt_pk_bf16_f32 v207, v134, v135
v_pk_fma_f32 v[148:149], v[240:241], v[44:45], v[148:149] op_sel:[0,1,0] op_sel_hi:[1,1,1]
v_pk_mul_f32 v[148:149], v[148:149], v[244:245]
v_cvt_pk_bf16_f32 v216, v148, v149
v_pk_fma_f32 v[150:151], v[242:243], v[44:45], v[150:151] op_sel:[0,1,0] op_sel_hi:[1,1,1]
v_pk_mul_f32 v[150:151], v[150:151], v[246:247]
v_cvt_pk_bf16_f32 v217, v150, v151
s_waitcnt lgkmcnt(3)
v_pk_fma_f32 v[128:129], v[28:29], v[44:45], v[128:129] op_sel_hi:[1,0,1]
s_waitcnt lgkmcnt(2)
v_pk_mul_f32 v[128:129], v[128:129], v[32:33]
v_cvt_pk_bf16_f32 v204, v128, v129
v_pk_fma_f32 v[130:131], v[30:31], v[44:45], v[130:131] op_sel_hi:[1,0,1]
v_pk_mul_f32 v[130:131], v[130:131], v[34:35]
v_cvt_pk_bf16_f32 v205, v130, v131
v_pk_fma_f32 v[144:145], v[28:29], v[44:45], v[144:145] op_sel:[0,1,0] op_sel_hi:[1,1,1]
v_pk_mul_f32 v[144:145], v[144:145], v[32:33]
v_cvt_pk_bf16_f32 v214, v144, v145
v_pk_fma_f32 v[146:147], v[30:31], v[44:45], v[146:147] op_sel:[0,1,0] op_sel_hi:[1,1,1]
v_pk_mul_f32 v[146:147], v[146:147], v[34:35]
v_cvt_pk_bf16_f32 v215, v146, v147
s_waitcnt lgkmcnt(1)
v_pk_fma_f32 v[124:125], v[36:37], v[44:45], v[124:125] op_sel_hi:[1,0,1]
s_waitcnt lgkmcnt(0)
v_pk_mul_f32 v[124:125], v[124:125], v[40:41]
v_cvt_pk_bf16_f32 v202, v124, v125
v_pk_fma_f32 v[126:127], v[38:39], v[44:45], v[126:127] op_sel_hi:[1,0,1]
v_pk_mul_f32 v[126:127], v[126:127], v[42:43]
v_cvt_pk_bf16_f32 v203, v126, v127
v_pk_fma_f32 v[140:141], v[36:37], v[44:45], v[140:141] op_sel:[0,1,0] op_sel_hi:[1,1,1]
v_pk_mul_f32 v[140:141], v[140:141], v[40:41]
v_cvt_pk_bf16_f32 v212, v140, v141
v_pk_fma_f32 v[142:143], v[38:39], v[44:45], v[142:143] op_sel:[0,1,0] op_sel_hi:[1,1,1]
v_pk_mul_f32 v[142:143], v[142:143], v[42:43]
v_cvt_pk_bf16_f32 v213, v142, v143
s_nop 0
v_mfma_f32_16x16x32_bf16 v[88:91], v[248:251], v[72:75], 0
v_exp_f32 v92, v92
v_mfma_f32_16x16x32_bf16 v[104:107], v[206:209], v[72:75], 0
v_exp_f32 v93, v93
v_mfma_f32_16x16x32_bf16 v[120:123], v[216:219], v[72:75], 0
v_exp_f32 v94, v94
v_mfma_f32_16x16x32_bf16 v[84:87], v[248:251], v[68:71], 0
v_exp_f32 v95, v95
v_mfma_f32_16x16x32_bf16 v[100:103], v[204:207], v[68:71], 0
v_exp_f32 v108, v108
v_mfma_f32_16x16x32_bf16 v[116:119], v[214:217], v[68:71], 0
v_exp_f32 v109, v109
v_mfma_f32_16x16x32_bf16 v[80:83], v[248:251], v[64:67], 0
v_exp_f32 v110, v110
v_mfma_f32_16x16x32_bf16 v[96:99], v[202:205], v[64:67], 0
v_exp_f32 v111, v111
v_mfma_f32_16x16x32_bf16 v[112:115], v[212:215], v[64:67], 0
v_cvt_pk_bf16_f32 v60, v92, v93
v_cvt_pk_bf16_f32 v61, v94, v95
v_cvt_pk_bf16_f32 v62, v108, v109
v_cvt_pk_bf16_f32 v63, v110, v111
v_rcp_f32 v88, v88
v_rcp_f32 v84, v84
v_mfma_f32_16x16x32_bf16 v[76:79], v[248:251], v[60:63], 0
v_rcp_f32 v80, v80
v_mfma_f32_16x16x32_bf16 v[92:95], v[200:203], v[60:63], 0
v_mfma_f32_16x16x32_bf16 v[108:111], v[210:213], v[60:63], 0
s_nop 4
v_rcp_f32 v76, v76
v_pk_mul_f32 v[104:105], v[104:105], v[88:89] op_sel_hi:[1,0]
v_pk_mul_f32 v[106:107], v[106:107], v[88:89] op_sel_hi:[1,0]
v_pk_mul_f32 v[120:121], v[120:121], v[88:89] op_sel_hi:[1,0]
v_pk_mul_f32 v[122:123], v[122:123], v[88:89] op_sel_hi:[1,0]
v_cvt_pk_bf16_f32 v176, v104, v105
v_cvt_pk_bf16_f32 v177, v106, v107
v_cvt_pk_bf16_f32 v178, v120, v121
v_cvt_pk_bf16_f32 v179, v122, v123
buffer_store_dwordx4 v[176:179], v4, s[16:19], s74 offen offset:3072 sc1
v_pk_mul_f32 v[100:101], v[100:101], v[84:85] op_sel_hi:[1,0]
v_pk_mul_f32 v[102:103], v[102:103], v[84:85] op_sel_hi:[1,0]
v_pk_mul_f32 v[116:117], v[116:117], v[84:85] op_sel_hi:[1,0]
v_pk_mul_f32 v[118:119], v[118:119], v[84:85] op_sel_hi:[1,0]
v_cvt_pk_bf16_f32 v172, v100, v101
v_cvt_pk_bf16_f32 v173, v102, v103
v_cvt_pk_bf16_f32 v174, v116, v117
v_cvt_pk_bf16_f32 v175, v118, v119
buffer_store_dwordx4 v[172:175], v4, s[16:19], s74 offen offset:2048 sc1
v_pk_mul_f32 v[96:97], v[96:97], v[80:81] op_sel_hi:[1,0]
v_pk_mul_f32 v[98:99], v[98:99], v[80:81] op_sel_hi:[1,0]
v_pk_mul_f32 v[112:113], v[112:113], v[80:81] op_sel_hi:[1,0]
v_pk_mul_f32 v[114:115], v[114:115], v[80:81] op_sel_hi:[1,0]
v_cvt_pk_bf16_f32 v168, v96, v97
v_cvt_pk_bf16_f32 v169, v98, v99
v_cvt_pk_bf16_f32 v170, v112, v113
v_cvt_pk_bf16_f32 v171, v114, v115
buffer_store_dwordx4 v[168:171], v4, s[16:19], s74 offen offset:1024 sc1
v_pk_mul_f32 v[92:93], v[92:93], v[76:77] op_sel_hi:[1,0]
v_pk_mul_f32 v[94:95], v[94:95], v[76:77] op_sel_hi:[1,0]
v_pk_mul_f32 v[108:109], v[108:109], v[76:77] op_sel_hi:[1,0]
v_pk_mul_f32 v[110:111], v[110:111], v[76:77] op_sel_hi:[1,0]
v_cvt_pk_bf16_f32 v164, v92, v93
v_cvt_pk_bf16_f32 v165, v94, v95
v_cvt_pk_bf16_f32 v166, v108, v109
v_cvt_pk_bf16_f32 v167, v110, v111
buffer_store_dwordx4 v[164:167], v4, s[16:19], s74 offen sc1
s_nop 1
.Lqkve2:
s_lshl_b32 s62, s3, 11
s_add_u32 s62, s62, s84
v_lshl_add_u32 v4, v1, 4, s62
v_lshrrev_b32 v2, 3, v1
v_cmp_eq_u32 vcc, 3, v2
v_add_u32 v2, 67108480, v4
s_nop 0
v_cndmask_b32 v4, v4, v2, vcc
v_bfe_u32 v5, v1, 3, 1
v_lshrrev_b32 v2, 4, v1
v_lshl_add_u32 v5, v2, 3, v5
s_lshl_b32 s62, s3, 1
v_add_u32 v5, s62, v5
v_mul_u32_u24 v5, 2048, v5
v_and_b32 v2, 7, v1
v_lshl_add_u32 v5, v2, 4, v5
s_lshl_b32 s62, s7, 7
v_add_u32 v5, s62, v5
v_add_u32 v6, 64512, v5
v_bfe_u32 v8, v1, 3, 2
v_mul_u32_u24 v8, 2080, v8
v_bfe_u32 v2, v1, 2, 1
v_lshl_add_u32 v8, v2, 7, v8
v_bfe_u32 v2, v1, 5, 1
v_lshl_add_u32 v8, v2, 8, v8
v_and_b32 v2, 3, v1
v_lshl_add_u32 v8, v2, 3, v8
s_mov_b32 s57, 66560
v_add_u32 v7, s57, v8
s_lshr_b32 s54, s87, 17
s_lshl_b32 s54, s54, 18
s_add_u32 s54, s54, 4194304
s_mov_b32 s52, s54
s_add_u32 s53, s54, 131072
v_accvgpr_read_b32 v32, a224
v_accvgpr_read_b32 v33, a225
v_accvgpr_read_b32 v34, a226
v_accvgpr_read_b32 v35, a227
v_accvgpr_read_b32 v36, a228
v_accvgpr_read_b32 v37, a229
v_accvgpr_read_b32 v38, a230
v_accvgpr_read_b32 v39, a231
v_accvgpr_read_b32 v40, a232
v_accvgpr_read_b32 v41, a233
v_accvgpr_read_b32 v42, a234
v_accvgpr_read_b32 v43, a235
v_accvgpr_read_b32 v44, a236
v_accvgpr_read_b32 v45, a237
v_accvgpr_read_b32 v46, a238
v_accvgpr_read_b32 v47, a239
v_accvgpr_read_b32 v48, a240
v_accvgpr_read_b32 v49, a241
v_accvgpr_read_b32 v50, a242
v_accvgpr_read_b32 v51, a243
v_accvgpr_read_b32 v52, a244
v_accvgpr_read_b32 v53, a245
v_accvgpr_read_b32 v54, a246
v_accvgpr_read_b32 v55, a247
v_accvgpr_read_b32 v56, a248
v_accvgpr_read_b32 v57, a249
v_accvgpr_read_b32 v58, a250
v_accvgpr_read_b32 v59, a251
v_accvgpr_read_b32 v60, a252
v_accvgpr_read_b32 v61, a253
v_accvgpr_read_b32 v62, a254
v_accvgpr_read_b32 v63, a255
s_lshl_b32 s62, s49, 3
s_add_u32 s62, s62, s48
s_mul_i32 s62, s62, 28672
s_add_u32 s62, s62, s51
v_lshrrev_b32 v12, 4, v1
v_mul_u32_u24 v12, 57344, v12
v_and_b32 v2, 15, v1
v_lshl_add_u32 v12, v2, 4, v12
v_add_u32 v12, s62, v12
v_add_u32 v13, 6112, v12
v_add_u32 v14, 12224, v12
v_add_u32 v15, 18336, v12
s_mul_i32 s59, s3, 4224
s_mov_b32 s58, 0
s_mov_b32 s36, s0
s_mov_b32 s37, s1
s_lshl_b32 s62, s8, 10
s_add_u32 s62, s62, 30425088
s_lshl_b32 s64, s6, 10
s_add_u32 s64, s64, 30425088
s_lshr_b32 s67, s5, 2
s_and_b32 s67, s67, 3
s_lshl_b32 s67, s67, 7
s_add_u32 s64, s64, s67
v_lshl_add_u32 v252, v1, 7, s62
v_mov_b32 v253, s64
v_mov_b32 v255, 1
s_waitcnt vmcnt(0) lgkmcnt(0)
s_cmp_lg_u32 s3, 1
s_barrier
s_cbranch_scc1 .Lnopoll34
s_mov_b64 exec, 15
buffer_atomic_add v255, v252, s[16:19], 0 offen
s_mov_b64 exec, 1
v_mov_b32 v254, 0
buffer_atomic_add v254, v253, s[16:19], 0 offen sc0
s_sleep 5
s_mov_b32 s15, 0
.Lpoll33:
v_mov_b32 v255, 0
buffer_atomic_add v255, v253, s[16:19], 0 offen sc0
s_waitcnt vmcnt(1)
v_cmp_gt_u32 vcc, 16, v254
s_add_u32 s15, s15, 1
s_cbranch_vccz .Lnopoll34r
v_mov_b32 v254, 0
buffer_atomic_add v254, v253, s[16:19], 0 offen sc0
s_waitcnt vmcnt(1)
v_cmp_gt_u32 vcc, 16, v255
s_add_u32 s15, s15, 1
s_cbranch_vccz .Lnopoll34r
s_cmp_le_u32 s15, 100000
s_cbranch_scc1 .Lpoll33
s_branch .Lnopoll34r
.Lnopoll34:
s_mov_b64 exec, 0
s_cmp_eq_u32 s3, 2
s_cbranch_scc1 .Lpad1
s_cmp_eq_u32 s3, 3
s_cbranch_scc1 .Lpad2
s_branch .Lpad3
.Lnopoll34r:
s_mov_b64 exec, -1
s_barrier
buffer_load_dwordx4 v[64:67], v4, s[16:19], s52 offen sc1
buffer_load_dwordx4 v[68:71], v4, s[16:19], s52 offen offset:1024 sc1
s_xor_b32 s52, s54, 262144
buffer_load_dwordx4 v[72:75], v4, s[16:19], s53 offen sc1
buffer_load_dwordx4 v[76:79], v4, s[16:19], s53 offen offset:1024 sc1
s_xor_b32 s53, s54, 393216
buffer_load_dwordx4 v[80:83], v4, s[16:19], s52 offen sc1
buffer_load_dwordx4 v[84:87], v4, s[16:19], s52 offen offset:1024 sc1
s_xor_b32 s52, s54, 524288
buffer_load_dwordx4 v[88:91], v4, s[16:19], s53 offen sc1
buffer_load_dwordx4 v[92:95], v4, s[16:19], s53 offen offset:1024 sc1
s_xor_b32 s53, s54, 655360
buffer_load_dwordx4 v[96:99], v4, s[16:19], s52 offen sc1
buffer_load_dwordx4 v[100:103], v4, s[16:19], s52 offen offset:1024 sc1
s_xor_b32 s52, s54, 786432
buffer_load_dwordx4 v[104:107], v4, s[16:19], s53 offen sc1
buffer_load_dwordx4 v[108:111], v4, s[16:19], s53 offen offset:1024 sc1
s_xor_b32 s53, s54, 917504
ds_read_b64_tr_b16 a[0:1], v7
TR 2,7,512
TR 16,7,1024
TR 18,7,1536
TR 4,7,32
TR 6,7,544
TR 20,7,1056
TR 22,7,1568
TR 8,7,64
TR 10,7,576
TR 24,7,1088
TR 26,7,1600
TR 12,7,96
TR 14,7,608
TR 28,7,1120
TR 30,7,1632
s_waitcnt vmcnt(8) lgkmcnt(14)
MAV 32,0,64
TR 32,7,8320
s_waitcnt lgkmcnt(13)
MAV 32,16,72
buffer_load_dwordx4 v[112:115], v4, s[16:19], s52 offen sc1
MAV 48,16,76
TR 34,7,8832
MAV 48,0,68
TR 48,7,9344
TR 50,7,9856
s_waitcnt lgkmcnt(14)
MAV 52,4,68
TR 36,7,8352
s_waitcnt lgkmcnt(13)
MAV 52,20,76
buffer_load_dwordx4 v[116:119], v4, s[16:19], s52 offen offset:1024 sc1
MAV 36,20,72
TR 38,7,8864
s_xor_b32 s52, s54, 1048576
MAV 36,4,64
TR 52,7,9376
TR 54,7,9888
s_waitcnt lgkmcnt(14)
MAV 40,8,64
TR 40,7,8384
s_waitcnt lgkmcnt(13)
MAV 40,24,72
buffer_load_dwordx4 v[120:123], v4, s[16:19], s53 offen sc1
MAV 56,24,76
TR 42,7,8896
MAV 56,8,68
TR 56,7,9408
TR 58,7,9920
s_waitcnt lgkmcnt(14)
MAV 60,12,68
TR 44,7,8416
s_waitcnt lgkmcnt(13)
MAV 60,28,76
buffer_load_dwordx4 v[124:127], v4, s[16:19], s53 offen offset:1024 sc1
MAV 44,28,72
TR 46,7,8928
s_xor_b32 s53, s54, 1179648
MAV 44,12,64
TR 60,7,9440
TR 62,7,9952
s_waitcnt vmcnt(8) lgkmcnt(8)
MAV 32,32,80
TR 0,7,16640
MAV 32,48,88
buffer_load_dwordx4 v[64:67], v4, s[16:19], s52 offen sc1
MAV 48,48,92
TR 2,7,17152
MAV 48,32,84
TR 16,7,17664
TR 18,7,18176
MAV 52,36,84
TR 4,7,16672
MAV 52,52,92
buffer_load_dwordx4 v[68:71], v4, s[16:19], s52 offen offset:1024 sc1
MAV 36,52,88
TR 6,7,17184
s_xor_b32 s52, s54, 1310720
MAV 36,36,80
TR 20,7,17696
TR 22,7,18208
s_waitcnt lgkmcnt(8)
MAV 40,40,80
TR 8,7,16704
MAV 40,56,88
buffer_load_dwordx4 v[72:75], v4, s[16:19], s53 offen sc1
MAV 56,56,92
TR 10,7,17216
MAV 56,40,84
TR 24,7,17728
TR 26,7,18240
MAV 60,44,84
TR 12,7,16736
MAV 60,60,92
buffer_load_dwordx4 v[76:79], v4, s[16:19], s53 offen offset:1024 sc1
MAV 44,60,88
TR 14,7,17248
s_xor_b32 s53, s54, 1441792
MAV 44,44,80
TR 28,7,17760
TR 30,7,18272
s_waitcnt vmcnt(8) lgkmcnt(8)
MAV 32,0,96
TR 32,7,24960
MAV 32,16,104
buffer_load_dwordx4 v[80:83], v4, s[16:19], s52 offen sc1
MAV 48,16,108
TR 34,7,25472
MAV 48,0,100
TR 48,7,25984
TR 50,7,26496
MAV 52,4,100
TR 36,7,24992
MAV 52,20,108
buffer_load_dwordx4 v[84:87], v4, s[16:19], s52 offen offset:1024 sc1
MAV 36,20,104
TR 38,7,25504
s_xor_b32 s52, s54, 1572864
MAV 36,4,96
TR 52,7,26016
TR 54,7,26528
s_waitcnt lgkmcnt(8)
MAV 40,8,96
TR 40,7,25024
MAV 40,24,104
buffer_load_dwordx4 v[88:91], v4, s[16:19], s53 offen sc1
MAV 56,24,108
TR 42,7,25536
MAV 56,8,100
TR 56,7,26048
TR 58,7,26560
MAV 60,12,100
TR 44,7,25056
MAV 60,28,108
buffer_load_dwordx4 v[92:95], v4, s[16:19], s53 offen offset:1024 sc1
MAV 44,28,104
TR 46,7,25568
s_xor_b32 s53, s54, 1703936
MAV 44,12,96
TR 60,7,26080
TR 62,7,26592
s_waitcnt vmcnt(8) lgkmcnt(8)
MAV 32,32,112
TR 0,7,33280
MAV 32,48,120
buffer_load_dwordx4 v[96:99], v4, s[16:19], s52 offen sc1
MAV 48,48,124
TR 2,7,33792
MAV 48,32,116
TR 16,7,34304
TR 18,7,34816
MAV 52,36,116
TR 4,7,33312
MAV 52,52,124
buffer_load_dwordx4 v[100:103], v4, s[16:19], s52 offen offset:1024 sc1
MAV 36,52,120
TR 6,7,33824
s_xor_b32 s52, s54, 1835008
MAV 36,36,112
TR 20,7,34336
TR 22,7,34848
s_waitcnt lgkmcnt(8)
MAV 40,40,112
TR 8,7,33344
MAV 40,56,120
buffer_load_dwordx4 v[104:107], v4, s[16:19], s53 offen sc1
MAV 56,56,124
TR 10,7,33856
MAV 56,40,116
TR 24,7,34368
TR 26,7,34880
MAV 60,44,116
TR 12,7,33376
MAV 60,60,124
buffer_load_dwordx4 v[108:111], v4, s[16:19], s53 offen offset:1024 sc1
MAV 44,60,120
TR 14,7,33888
s_xor_b32 s53, s54, 1966080
MAV 44,44,112
TR 28,7,34400
TR 30,7,34912
s_waitcnt vmcnt(8) lgkmcnt(8)
MAV 32,0,64
TR 32,7,41600
MAV 32,16,72
buffer_load_dwordx4 v[112:115], v4, s[16:19], s52 offen sc1
MAV 48,16,76
TR 34,7,42112
MAV 48,0,68
TR 48,7,42624
TR 50,7,43136
MAV 52,4,68
TR 36,7,41632
MAV 52,20,76
buffer_load_dwordx4 v[116:119], v4, s[16:19], s52 offen offset:1024 sc1
MAV 36,20,72
TR 38,7,42144
s_xor_b32 s52, s54, 2097152
MAV 36,4,64
TR 52,7,42656
TR 54,7,43168
s_waitcnt lgkmcnt(8)
MAV 40,8,64
TR 40,7,41664
MAV 40,24,72
buffer_load_dwordx4 v[120:123], v4, s[16:19], s53 offen sc1
MAV 56,24,76
TR 42,7,42176
MAV 56,8,68
TR 56,7,42688
TR 58,7,43200
MAV 60,12,68
TR 44,7,41696
MAV 60,28,76
buffer_load_dwordx4 v[124:127], v4, s[16:19], s53 offen offset:1024 sc1
MAV 44,28,72
TR 46,7,42208
s_xor_b32 s53, s54, 2228224
MAV 44,12,64
TR 60,7,42720
TR 62,7,43232
s_waitcnt vmcnt(8) lgkmcnt(8)
MAV 32,32,80
TR 0,7,49920
MAV 32,48,88
buffer_load_dwordx4 v[64:67], v4, s[16:19], s52 offen sc1
MAV 48,48,92
TR 2,7,50432
MAV 48,32,84
TR 16,7,50944
TR 18,7,51456
MAV 52,36,84
TR 4,7,49952
MAV 52,52,92
buffer_load_dwordx4 v[68:71], v4, s[16:19], s52 offen offset:1024 sc1
MAV 36,52,88
TR 6,7,50464
s_xor_b32 s52, s54, 2359296
MAV 36,36,80
TR 20,7,50976
TR 22,7,51488
s_waitcnt lgkmcnt(8)
MAV 40,40,80
TR 8,7,49984
MAV 40,56,88
buffer_load_dwordx4 v[72:75], v4, s[16:19], s53 offen sc1
MAV 56,56,92
TR 10,7,50496
MAV 56,40,84
TR 24,7,51008
TR 26,7,51520
MAV 60,44,84
TR 12,7,50016
MAV 60,60,92
buffer_load_dwordx4 v[76:79], v4, s[16:19], s53 offen offset:1024 sc1
MAV 44,60,88
TR 14,7,50528
s_xor_b32 s53, s54, 2490368
MAV 44,44,80
TR 28,7,51040
TR 30,7,51552
s_waitcnt vmcnt(8) lgkmcnt(8)
MAV 32,0,96
TR 32,7,58240
MAV 32,16,104
buffer_load_dwordx4 v[80:83], v4, s[16:19], s52 offen sc1
MAV 48,16,108
TR 34,7,58752
MAV 48,0,100
TR 48,7,59264
TR 50,7,59776
MAV 52,4,100
TR 36,7,58272
MAV 52,20,108
buffer_load_dwordx4 v[84:87], v4, s[16:19], s52 offen offset:1024 sc1
MAV 36,20,104
TR 38,7,58784
s_xor_b32 s52, s54, 2621440
MAV 36,4,96
TR 52,7,59296
TR 54,7,59808
s_waitcnt lgkmcnt(8)
MAV 40,8,96
TR 40,7,58304
MAV 40,24,104
buffer_load_dwordx4 v[88:91], v4, s[16:19], s53 offen sc1
MAV 56,24,108
TR 42,7,58816
MAV 56,8,100
TR 56,7,59328
TR 58,7,59840
MAV 60,12,100
TR 44,7,58336
MAV 60,28,108
buffer_load_dwordx4 v[92:95], v4, s[16:19], s53 offen offset:1024 sc1
MAV 44,28,104
TR 46,7,58848
s_xor_b32 s53, s54, 2752512
MAV 44,12,96
TR 60,7,59360
TR 62,7,59872
s_xor_b32 s57, s57, 66560
v_add_u32 v7, s57, v8
s_waitcnt vmcnt(8) lgkmcnt(8)
MAV 32,32,112
ds_read_b64_tr_b16 a[0:1], v7
MAV 32,48,120
buffer_load_dwordx4 v[96:99], v4, s[16:19], s52 offen sc1
MAV 48,48,124
TR 2,7,512
MAV 48,32,116
TR 16,7,1024
TR 18,7,1536
MAV 52,36,116
TR 4,7,32
MAV 52,52,124
buffer_load_dwordx4 v[100:103], v4, s[16:19], s52 offen offset:1024 sc1
MAV 36,52,120
TR 6,7,544
s_xor_b32 s52, s54, 2883584
MAV 36,36,112
TR 20,7,1056
TR 22,7,1568
s_waitcnt lgkmcnt(8)
MAV 40,40,112
TR 8,7,64
MAV 40,56,120
buffer_load_dwordx4 v[104:107], v4, s[16:19], s53 offen sc1
MAV 56,56,124
TR 10,7,576
MAV 56,40,116
TR 24,7,1088
TR 26,7,1600
MAV 60,44,116
TR 12,7,96
MAV 60,60,124
buffer_load_dwordx4 v[108:111], v4, s[16:19], s53 offen offset:1024 sc1
MAV 44,60,120
TR 14,7,608
s_xor_b32 s53, s54, 3014656
MAV 44,44,112
TR 28,7,1120
TR 30,7,1632
s_waitcnt vmcnt(8) lgkmcnt(8)
MAV 32,0,64
TR 32,7,8320
MAV 32,16,72
buffer_load_dwordx4 v[112:115], v4, s[16:19], s52 offen sc1
MAV 48,16,76
TR 34,7,8832
MAV 48,0,68
TR 48,7,9344
TR 50,7,9856
MAV 52,4,68
TR 36,7,8352
MAV 52,20,76
buffer_load_dwordx4 v[116:119], v4, s[16:19], s52 offen offset:1024 sc1
MAV 36,20,72
TR 38,7,8864
s_xor_b32 s52, s54, 3145728
MAV 36,4,64
TR 52,7,9376
TR 54,7,9888
s_waitcnt lgkmcnt(8)
MAV 40,8,64
TR 40,7,8384
MAV 40,24,72
buffer_load_dwordx4 v[120:123], v4, s[16:19], s53 offen sc1
MAV 56,24,76
TR 42,7,8896
MAV 56,8,68
TR 56,7,9408
TR 58,7,9920
MAV 60,12,68
TR 44,7,8416
MAV 60,28,76
buffer_load_dwordx4 v[124:127], v4, s[16:19], s53 offen offset:1024 sc1
MAV 44,28,72
TR 46,7,8928
s_xor_b32 s53, s54, 3276800
MAV 44,12,64
TR 60,7,9440
TR 62,7,9952
s_waitcnt vmcnt(8) lgkmcnt(8)
MAV 32,32,80
TR 0,7,16640
MAV 32,48,88
buffer_load_dwordx4 v[64:67], v4, s[16:19], s52 offen sc1
MAV 48,48,92
TR 2,7,17152
MAV 48,32,84
TR 16,7,17664
TR 18,7,18176
MAV 52,36,84
TR 4,7,16672
MAV 52,52,92
buffer_load_dwordx4 v[68:71], v4, s[16:19], s52 offen offset:1024 sc1
MAV 36,52,88
TR 6,7,17184
s_xor_b32 s52, s54, 3407872
MAV 36,36,80
TR 20,7,17696
TR 22,7,18208
s_waitcnt lgkmcnt(8)
MAV 40,40,80
TR 8,7,16704
MAV 40,56,88
buffer_load_dwordx4 v[72:75], v4, s[16:19], s53 offen sc1
MAV 56,56,92
TR 10,7,17216
MAV 56,40,84
TR 24,7,17728
TR 26,7,18240
MAV 60,44,84
TR 12,7,16736
MAV 60,60,92
buffer_load_dwordx4 v[76:79], v4, s[16:19], s53 offen offset:1024 sc1
MAV 44,60,88
TR 14,7,17248
s_xor_b32 s53, s54, 3538944
MAV 44,44,80
TR 28,7,17760
TR 30,7,18272
s_waitcnt vmcnt(8) lgkmcnt(8)
MAV 32,0,96
TR 32,7,24960
MAV 32,16,104
buffer_load_dwordx4 v[80:83], v4, s[16:19], s52 offen sc1
MAV 48,16,108
TR 34,7,25472
MAV 48,0,100
TR 48,7,25984
TR 50,7,26496
MAV 52,4,100
TR 36,7,24992
MAV 52,20,108
buffer_load_dwordx4 v[84:87], v4, s[16:19], s52 offen offset:1024 sc1
MAV 36,20,104
TR 38,7,25504
s_xor_b32 s52, s54, 3670016
MAV 36,4,96
TR 52,7,26016
TR 54,7,26528
s_waitcnt lgkmcnt(8)
MAV 40,8,96
TR 40,7,25024
MAV 40,24,104
buffer_load_dwordx4 v[88:91], v4, s[16:19], s53 offen sc1
MAV 56,24,108
TR 42,7,25536
MAV 56,8,100
TR 56,7,26048
TR 58,7,26560
MAV 60,12,100
TR 44,7,25056
MAV 60,28,108
buffer_load_dwordx4 v[92:95], v4, s[16:19], s53 offen offset:1024 sc1
MAV 44,28,104
TR 46,7,25568
s_xor_b32 s53, s54, 3801088
MAV 44,12,96
TR 60,7,26080
TR 62,7,26592
s_waitcnt vmcnt(8) lgkmcnt(8)
MAV 32,32,112
TR 0,7,33280
MAV 32,48,120
buffer_load_dwordx4 v[96:99], v4, s[16:19], s52 offen sc1
MAV 48,48,124
TR 2,7,33792
MAV 48,32,116
TR 16,7,34304
TR 18,7,34816
MAV 52,36,116
TR 4,7,33312
MAV 52,52,124
buffer_load_dwordx4 v[100:103], v4, s[16:19], s52 offen offset:1024 sc1
MAV 36,52,120
TR 6,7,33824
s_xor_b32 s52, s54, 3932160
MAV 36,36,112
TR 20,7,34336
TR 22,7,34848
s_waitcnt lgkmcnt(8)
MAV 40,40,112
TR 8,7,33344
MAV 40,56,120
buffer_load_dwordx4 v[104:107], v4, s[16:19], s53 offen sc1
MAV 56,56,124
TR 10,7,33856
MAV 56,40,116
TR 24,7,34368
TR 26,7,34880
MAV 60,44,116
TR 12,7,33376
MAV 60,60,124
buffer_load_dwordx4 v[108:111], v4, s[16:19], s53 offen offset:1024 sc1
MAV 44,60,120
TR 14,7,33888
s_xor_b32 s53, s54, 4063232
MAV 44,44,112
TR 28,7,34400
TR 30,7,34912
s_waitcnt vmcnt(8) lgkmcnt(8)
.Lpad1:
s_cbranch_execz .Lpad4
MAV 32,0,64
TR 32,7,41600
MAV 32,16,72
buffer_load_dwordx4 v[112:115], v4, s[16:19], s52 offen sc1
MAV 48,16,76
TR 34,7,42112
MAV 48,0,68
TR 48,7,42624
TR 50,7,43136
MAV 52,4,68
TR 36,7,41632
MAV 52,20,76
buffer_load_dwordx4 v[116:119], v4, s[16:19], s52 offen offset:1024 sc1
MAV 36,20,72
TR 38,7,42144
MAV 36,4,64
TR 52,7,42656
TR 54,7,43168
s_waitcnt lgkmcnt(8)
MAV 40,8,64
TR 40,7,41664
MAV 40,24,72
buffer_load_dwordx4 v[120:123], v4, s[16:19], s53 offen sc1
MAV 56,24,76
TR 42,7,42176
MAV 56,8,68
TR 56,7,42688
TR 58,7,43200
MAV 60,12,68
TR 44,7,41696
MAV 60,28,76
buffer_load_dwordx4 v[124:127], v4, s[16:19], s53 offen offset:1024 sc1
MAV 44,28,72
TR 46,7,42208
MAV 44,12,64
TR 60,7,42720
TR 62,7,43232
s_barrier
s_waitcnt vmcnt(8) lgkmcnt(8)
MAV 32,32,80
TR 0,7,49920
s_add_u32 m0, s59, 84480
MAV 32,48,88
buffer_load_dwordx4 v12, s[32:35], s58 offen   lds
MAV 48,48,92
TR 2,7,50432
MAV 48,32,84
TR 16,7,50944
TR 18,7,51456
MAV 52,36,84
TR 4,7,49952
MAV 52,52,92
buffer_load_dwordx4 v13, s[32:35], s58 offen offset:1056   lds
MAV 36,52,88
TR 6,7,50464
MAV 36,36,80
TR 20,7,50976
TR 22,7,51488
s_waitcnt lgkmcnt(8)
MAV 40,40,80
TR 8,7,49984
MAV 40,56,88
buffer_load_dwordx4 v14, s[32:35], s58 offen offset:2112   lds
MAV 56,56,92
TR 10,7,50496
MAV 56,40,84
TR 24,7,51008
TR 26,7,51520
MAV 60,44,84
TR 12,7,50016
MAV 60,60,92
buffer_load_dwordx4 v15, s[32:35], s58 offen offset:3168   lds
MAV 44,60,88
TR 14,7,50528
MAV 44,44,80
TR 28,7,51040
TR 30,7,51552
s_waitcnt vmcnt(8) lgkmcnt(8)
MAV 32,0,96
TR 32,7,58240
s_add_u32 m0, s59, 101376
MAV 32,16,104
buffer_load_dwordx4 v12, s[80:83], s58 offen   lds
MAV 48,16,108
TR 34,7,58752
MAV 48,0,100
TR 48,7,59264
TR 50,7,59776
MAV 52,4,100
TR 36,7,58272
MAV 52,20,108
buffer_load_dwordx4 v13, s[80:83], s58 offen offset:1056   lds
MAV 36,20,104
TR 38,7,58784
MAV 36,4,96
TR 52,7,59296
TR 54,7,59808
s_waitcnt lgkmcnt(8)
MAV 40,8,96
TR 40,7,58304
MAV 40,24,104
buffer_load_dwordx4 v14, s[80:83], s58 offen offset:2112   lds
MAV 56,24,108
TR 42,7,58816
MAV 56,8,100
TR 56,7,59328
TR 58,7,59840
MAV 60,12,100
TR 44,7,58336
MAV 60,28,108
buffer_load_dwordx4 v15, s[80:83], s58 offen offset:3168   lds
MAV 44,28,104
TR 46,7,58848
s_add_u32 s58, s58, 458752
MAV 44,12,96
TR 60,7,59360
TR 62,7,59872
s_waitcnt vmcnt(11) lgkmcnt(14)
MAV 32,32,112
s_add_u32 m0, s59, 118272
s_lshl_b32 s64, s6, 14
s_lshl_b32 s65, s49, 13
s_waitcnt vmcnt(9) lgkmcnt(12)
MAV 32,48,120
buffer_load_dwordx4 v12, s[32:35], s58 offen   lds
s_waitcnt vmcnt(9)
MAV 48,48,124
s_add_u32 s64, s64, s65
s_lshl_b32 s65, s7, 9
s_add_u32 s64, s64, s65
MAV 48,32,116
s_lshl_b32 s65, s48, 8
s_add_u32 s64, s64, s65
s_add_u32 s64, s64, 29622272
s_waitcnt lgkmcnt(10)
MAV 52,36,116
s_lshl_b32 s62, s7, 18
v_and_b32 v152, 31, v1
v_lshlrev_b32 v152, 3, v152
s_waitcnt lgkmcnt(8)
MAV 52,52,124
buffer_load_dwordx4 v13, s[32:35], s58 offen offset:1056   lds
MAV 36,52,120
s_add_u32 s62, s62, 8388608
v_lshrrev_b32 v153, 5, v1
v_lshl_add_u32 v152, v153, 28, v152
MAV 36,36,112
s_add_u32 s63, s62, 131072
v_cvt_pk_bf16_f32 v128, v32, v33
v_cvt_pk_bf16_f32 v129, v34, v35
s_waitcnt lgkmcnt(6)
MAV 40,40,112
v_cvt_pk_bf16_f32 v136, v48, v49
v_cvt_pk_bf16_f32 v137, v50, v51
s_waitcnt lgkmcnt(4)
MAV 40,56,120
buffer_load_dwordx4 v14, s[32:35], s58 offen offset:2112   lds
MAV 56,56,124
v_cvt_pk_bf16_f32 v130, v36, v37
v_cvt_pk_bf16_f32 v131, v38, v39
MAV 56,40,116
v_cvt_pk_bf16_f32 v138, v52, v53
v_cvt_pk_bf16_f32 v139, v54, v55
s_waitcnt lgkmcnt(2)
MAV 60,44,116
v_cvt_pk_bf16_f32 v132, v40, v41
v_cvt_pk_bf16_f32 v133, v42, v43
s_waitcnt lgkmcnt(0)
MAV 60,60,124
buffer_load_dwordx4 v15, s[32:35], s58 offen offset:3168   lds
MAV 44,60,120
v_cvt_pk_bf16_f32 v140, v56, v57
v_cvt_pk_bf16_f32 v141, v58, v59
MAV 44,44,112
s_nop 2
v_cvt_pk_bf16_f32 v142, v60, v61
v_cvt_pk_bf16_f32 v143, v62, v63
v_pk_mul_f32 v[146:147], v[32:33], v[32:33]
buffer_store_dwordx4 v[128:131], v4, s[16:19], s62 offen sc1
v_pk_mul_f32 v[150:151], v[48:49], v[48:49]
v_pk_fma_f32 v[146:147], v[34:35], v[34:35], v[146:147]
v_pk_add_f32 v[144:145], v[32:33], v[34:35]
v_pk_fma_f32 v[150:151], v[50:51], v[50:51], v[150:151]
v_cvt_pk_bf16_f32 v134, v44, v45
v_cvt_pk_bf16_f32 v135, v46, v47
v_pk_add_f32 v[148:149], v[48:49], v[50:51]
v_pk_fma_f32 v[146:147], v[36:37], v[36:37], v[146:147]
v_pk_add_f32 v[144:145], v[144:145], v[36:37]
v_pk_fma_f32 v[150:151], v[52:53], v[52:53], v[150:151]
v_pk_add_f32 v[148:149], v[148:149], v[52:53]
v_pk_fma_f32 v[146:147], v[38:39], v[38:39], v[146:147]
v_pk_add_f32 v[144:145], v[144:145], v[38:39]
buffer_store_dwordx4 v[132:135], v4, s[16:19], s63 offen sc1
v_pk_fma_f32 v[150:151], v[54:55], v[54:55], v[150:151]
v_pk_add_f32 v[148:149], v[148:149], v[54:55]
v_pk_fma_f32 v[146:147], v[40:41], v[40:41], v[146:147]
v_pk_add_f32 v[144:145], v[144:145], v[40:41]
v_pk_fma_f32 v[150:151], v[56:57], v[56:57], v[150:151]
v_pk_add_f32 v[148:149], v[148:149], v[56:57]
v_pk_fma_f32 v[146:147], v[42:43], v[42:43], v[146:147]
v_pk_add_f32 v[144:145], v[144:145], v[42:43]
v_pk_fma_f32 v[150:151], v[58:59], v[58:59], v[150:151]
v_pk_add_f32 v[148:149], v[148:149], v[58:59]
v_pk_fma_f32 v[146:147], v[44:45], v[44:45], v[146:147]
v_pk_add_f32 v[144:145], v[144:145], v[44:45]
v_pk_fma_f32 v[150:151], v[60:61], v[60:61], v[150:151]
buffer_store_dwordx4 v[136:139], v4, s[16:19], s62 offen offset:1024 sc1
v_pk_add_f32 v[148:149], v[148:149], v[60:61]
v_pk_fma_f32 v[146:147], v[46:47], v[46:47], v[146:147]
v_pk_add_f32 v[144:145], v[144:145], v[46:47]
v_pk_fma_f32 v[150:151], v[62:63], v[62:63], v[150:151]
v_pk_add_f32 v[148:149], v[148:149], v[62:63]
v_add_f32 v144, v144, v145
v_add_f32 v146, v146, v147
v_add_f32 v148, v148, v149
v_add_f32 v150, v150, v151
s_nop 0
v_permlane16_swap_b32 v144, v148
buffer_store_dwordx4 v[140:143], v4, s[16:19], s63 offen offset:1024 sc1
v_permlane16_swap_b32 v146, v150
v_add_f32 v144, v144, v148
v_add_f32 v146, v146, v150
s_nop 1
v_permlane32_swap_b32 v144, v146
v_add_f32 v144, v144, v146
s_nop 1
v_permlane32_swap_b32 v144, v145
buffer_store_dwordx2 v[144:145], v152, s[16:19], s64 offen sc1
s_nop 1
v_accvgpr_write_b32 a224, v32
v_accvgpr_write_b32 a225, v33
v_accvgpr_write_b32 a226, v34
v_accvgpr_write_b32 a227, v35
v_accvgpr_write_b32 a228, v36
v_accvgpr_write_b32 a229, v37
v_accvgpr_write_b32 a230, v38
v_accvgpr_write_b32 a231, v39
v_accvgpr_write_b32 a232, v40
v_accvgpr_write_b32 a233, v41
v_accvgpr_write_b32 a234, v42
v_accvgpr_write_b32 a235, v43
v_accvgpr_write_b32 a236, v44
v_accvgpr_write_b32 a237, v45
v_accvgpr_write_b32 a238, v46
v_accvgpr_write_b32 a239, v47
v_accvgpr_write_b32 a240, v48
v_accvgpr_write_b32 a241, v49
v_accvgpr_write_b32 a242, v50
v_accvgpr_write_b32 a243, v51
v_accvgpr_write_b32 a244, v52
v_accvgpr_write_b32 a245, v53
v_accvgpr_write_b32 a246, v54
v_accvgpr_write_b32 a247, v55
v_accvgpr_write_b32 a248, v56
v_accvgpr_write_b32 a249, v57
v_accvgpr_write_b32 a250, v58
v_accvgpr_write_b32 a251, v59
v_accvgpr_write_b32 a252, v60
v_accvgpr_write_b32 a253, v61
v_accvgpr_write_b32 a254, v62
v_accvgpr_write_b32 a255, v63
s_lshl_b32 s62, s10, 14
s_lshl_b32 s63, s3, 12
s_add_u32 s62, s62, s63
s_lshl_b32 s63, s12, 11
s_add_u32 s62, s62, s63
v_lshl_add_u32 v10, v1, 4, s62
v_lshrrev_b32 v2, 3, v1
v_cmp_eq_u32 vcc, 3, v2
v_add_u32 v2, 67108480, v10
s_nop 0
v_cndmask_b32 v10, v10, v2, vcc
v_xor_b32 v11, 2048, v10
v_bfe_u32 v16, v1, 2, 3
v_mul_u32_u24 v16, 1056, v16
v_bfe_u32 v2, v1, 5, 1
v_lshl_add_u32 v16, v2, 8, v16
v_and_b32 v2, 3, v1
v_lshl_add_u32 v16, v2, 3, v16
s_lshl_b32 s62, s12, 6
s_add_u32 s62, s62, 84480
s_xor_b32 s63, s12, 1
s_mul_i32 s63, s63, 192
s_add_u32 s63, s63, 84480
v_add_u32 v17, s63, v16
v_add_u32 v16, s62, v16
s_mov_b32 s52, 8388608
s_mov_b32 s53, 8388608
s_mov_b32 s54, s58
s_mov_b32 s55, s59
s_mul_i32 s59, s3, 2112
s_and_b32 s62, s7, 1
s_mul_i32 s62, s62, 3670016
s_lshr_b32 s63, s7, 1
s_lshl_b32 s63, s63, 8
s_add_u32 s62, s62, s63
s_lshl_b32 s63, s3, 12
s_add_u32 s62, s62, s63
v_lshrrev_b32 v5, 4, v1
v_lshlrev_b32 v5, 14, v5
v_and_b32 v2, 15, v1
v_lshl_add_u32 v5, v2, 4, v5
v_add_u32 v5, s62, v5
v_add_u32 v6, 992, v5
s_lshl_b32 s62, s10, 15
s_lshl_b32 s63, s3, 13
s_add_u32 s62, s62, s63
v_lshl_add_u32 v4, v1, 4, s62
s_and_b32 s47, s5, 3
s_lshr_b32 s63, s5, 2
s_lshl_b32 s63, s63, 3
s_add_u32 s63, s63, s4
s_lshl_b32 s62, s63, 1
s_add_u32 s62, s62, s48
s_mul_i32 s62, s62, 1792
v_lshrrev_b32 v7, 2, v1
v_min_u32 v8, 13, v7
v_lshl_add_u32 v8, v8, 7, s62
s_lshl_b32 s62, s63, 2
s_add_u32 s62, s62, s3
s_mul_i32 s62, s62, 640
v_and_b32 v7, 7, v7
v_min_u32 v7, 4, v7
v_lshl_add_u32 v7, v7, 7, s62
v_lshrrev_b32 v2, 5, v1
v_mul_u32_u24 v2, 3670016, v2
v_add_u32 v7, v7, v2
s_mul_i32 s44, s47, 163840
s_add_u32 s45, s47, 12
s_mul_i32 s45, s45, 229376
v_and_b32 v6, 3, v1
v_cmp_eq_u32 vcc, 3, v6
v_mov_b32 v2, 0x3f80
v_mov_b32 v20, 1.0
v_cndmask_b32 v2, v2, v20, vcc
v_cndmask_b32 v6, v6, 0, vcc
v_or_b32 v6, 12, v6
v_mul_u32_u24 v6, 0x1111, v6
v_lshl_or_b32 v6, v6, 16, v6
v_bfe_u32 v22, v1, 2, 2
v_cmp_eq_u32 vcc, 0, v22
s_nop 1
v_cndmask_b32 v20, 0, v2, vcc
v_cmp_eq_u32 vcc, 1, v22
s_nop 1
v_cndmask_b32 v21, 0, v2, vcc
v_accvgpr_write_b32 a208, v20
v_accvgpr_write_b32 a209, v21
v_accvgpr_write_b32 a210, v20
v_accvgpr_write_b32 a211, v21
v_accvgpr_write_b32 a212, 0
v_accvgpr_write_b32 a213, 0
v_accvgpr_write_b32 a214, 0
v_accvgpr_write_b32 a215, 0
v_accvgpr_write_b32 a216, 0
v_accvgpr_write_b32 a217, 0
v_accvgpr_write_b32 a218, 0
v_accvgpr_write_b32 a219, 0
s_cmp_lt_u32 s3, 2
s_cselect_b32 s40, s32, s80
s_cselect_b32 s41, s33, s81
s_cselect_b32 s42, s34, s82
s_add_u32 s62, s55, 84480
v_lshl_add_u32 v9, v1, 4, s62
s_lshl_b32 s62, s6, 10
s_add_u32 s62, s62, 30441472
s_lshl_b32 s64, s10, 1
s_lshl_b32 s64, s64, 10
s_add_u32 s64, s64, 30441472
s_lshr_b32 s67, s5, 2
s_and_b32 s67, s67, 3
s_lshl_b32 s67, s67, 7
s_add_u32 s64, s64, s67
s_add_u32 s65, s64, 1024
v_lshl_add_u32 v252, v1, 7, s62
v_mov_b32 v253, s64
v_mov_b32 v255, 1
v_writelane_b32 v253, s65, 1
s_waitcnt vmcnt(0) lgkmcnt(0)
s_cmp_lg_u32 s3, 1
s_barrier
s_cbranch_scc1 .Lnopoll37
s_mov_b64 exec, 15
buffer_atomic_add v255, v252, s[16:19], 0 offen
s_mov_b64 exec, 3
v_mov_b32 v254, 0
buffer_atomic_add v254, v253, s[16:19], 0 offen sc0
s_sleep 5
s_mov_b32 s15, 0
.Lpoll36:
v_mov_b32 v255, 0
buffer_atomic_add v255, v253, s[16:19], 0 offen sc0
s_waitcnt vmcnt(1)
v_cmp_gt_u32 vcc, 16, v254
s_add_u32 s15, s15, 1
s_cbranch_vccz .Lnopoll37r
v_mov_b32 v254, 0
buffer_atomic_add v254, v253, s[16:19], 0 offen sc0
s_waitcnt vmcnt(1)
v_cmp_gt_u32 vcc, 16, v255
s_add_u32 s15, s15, 1
s_cbranch_vccz .Lnopoll37r
s_cmp_le_u32 s15, 100000
s_cbranch_scc1 .Lpoll36
s_branch .Lnopoll37r
.Lnopoll37:
s_mov_b64 exec, 0
s_cmp_eq_u32 s3, 2
s_cbranch_scc1 .Lpad6
s_cmp_eq_u32 s3, 3
s_cbranch_scc1 .Lpad7
s_branch .Lpad8
.Lnopoll37r:
s_mov_b64 exec, -1
s_barrier
buffer_load_dwordx4 a[128:131], v10, s[16:19], s52 offen sc1
buffer_load_dwordx4 a[132:135], v10, s[16:19], s52 offen offset:1024 sc1
s_add_u32 s52, s52, 131072
buffer_load_dwordx4 a[144:147], v10, s[16:19], s52 offen sc1
buffer_load_dwordx4 a[148:151], v10, s[16:19], s52 offen offset:1024 sc1
s_add_u32 s52, s52, 131072
buffer_load_dwordx4 a[136:139], v11, s[16:19], s53 offen sc1
buffer_load_dwordx4 a[140:143], v11, s[16:19], s53 offen offset:1024 sc1
s_add_u32 s53, s53, 131072
buffer_load_dwordx4 a[152:155], v11, s[16:19], s53 offen sc1
buffer_load_dwordx4 a[156:159], v11, s[16:19], s53 offen offset:1024 sc1
s_add_u32 s53, s53, 131072
ds_read_b64_tr_b16 a[0:1], v16
TR 2,16,512
TR 4,16,8448
TR 6,16,8960
TR 8,16,32
TR 10,16,544
TR 12,16,8480
TR 14,16,8992
TR 16,16,64
TR 18,16,576
TR 20,16,8512
TR 22,16,9024
TR 24,16,96
TR 26,16,608
TR 28,16,8544
TR 30,16,9056
TR 32,16,128
TR 34,16,640
TR 36,16,8576
TR 38,16,9088
TR 40,16,160
TR 42,16,672
TR 44,16,8608
TR 46,16,9120
ds_read_b64_tr_b16 a[48:49], v17
TR 50,17,512
TR 52,17,8448
TR 54,17,8960
TR 56,17,32
TR 58,17,544
TR 60,17,8480
TR 62,17,8992
ds_read_b128 a[192:195], v9
RD 196,9,1056
RD 200,9,2112
RD 204,9,3168
s_add_u32 m0, s55, 135168
s_nop 0
buffer_load_dwordx4 v12, s[80:83], s54 offen   lds
buffer_load_dwordx4 v13, s[80:83], s54 offen offset:1056   lds
buffer_load_dwordx4 v14, s[80:83], s54 offen offset:2112   lds
buffer_load_dwordx4 v15, s[80:83], s54 offen offset:3168   lds
s_add_u32 s54, s54, 458752
s_lshl_b32 s57, s3, 13
s_add_u32 s57, s57, 49920
v_lshl_add_u32 v2, v1, 4, s57
s_waitcnt lgkmcnt(0)
s_barrier
s_waitcnt vmcnt(11)
v_mfma_f32_16x16x32_bf16 v[32:35], a[0:3], a[128:131], 0
buffer_load_dwordx4 a[160:163], v10, s[16:19], s52 offen sc1
s_waitcnt vmcnt(10)
MAA 32,4,144
TR 64,16,16896
v_smfmac_f32_16x16x64_bf16 a[212:215], a[208:211], a[192:199], v6
TR 66,16,17408
v_smfmac_f32_16x16x64_bf16 a[212:215], a[208:211], a[200:207], v6
TR 68,16,25344
v_mfma_f32_16x16x32_bf16 v[36:39], a[0:3], a[132:135], 0
TR 70,16,25856
s_waitcnt vmcnt(9)
MAA 36,4,148
buffer_load_dwordx4 a[164:167], v10, s[16:19], s52 offen offset:1024 sc1
v_mfma_f32_16x16x32_bf16 v[52:55], a[8:11], a[132:135], 0
TR 72,16,16928
s_add_u32 s52, s52, 131072
MAA 52,12,148
TR 74,16,17440
v_mfma_f32_16x16x32_bf16 v[48:51], a[8:11], a[128:131], 0
TR 76,16,25376
MAA 48,12,144
TR 78,16,25888
v_mfma_f32_16x16x32_bf16 v[96:99], a[16:19], a[128:131], 0
buffer_load_dwordx4 a[176:179], v10, s[16:19], s52 offen sc1
MAA 96,20,144
TR 80,16,16960
v_mfma_f32_16x16x32_bf16 v[100:103], a[16:19], a[132:135], 0
TR 82,16,17472
MAA 100,20,148
TR 84,16,25408
v_mfma_f32_16x16x32_bf16 v[116:119], a[24:27], a[132:135], 0
TR 86,16,25920
MAA 116,28,148
buffer_load_dwordx4 a[180:183], v10, s[16:19], s52 offen offset:1024 sc1
v_mfma_f32_16x16x32_bf16 v[112:115], a[24:27], a[128:131], 0
TR 88,16,16992
s_add_u32 s52, s52, 131072
MAA 112,28,144
TR 90,16,17504
v_mfma_f32_16x16x32_bf16 v[160:163], a[32:35], a[128:131], 0
TR 92,16,25440
MAA 160,36,144
TR 94,16,25952
v_mfma_f32_16x16x32_bf16 v[164:167], a[32:35], a[132:135], 0
buffer_load_dwordx4 a[168:171], v11, s[16:19], s53 offen sc1
MAA 164,36,148
TR 96,16,17024
v_mfma_f32_16x16x32_bf16 v[180:183], a[40:43], a[132:135], 0
TR 98,16,17536
MAA 180,44,148
TR 100,16,25472
v_mfma_f32_16x16x32_bf16 v[176:179], a[40:43], a[128:131], 0
TR 102,16,25984
MAA 176,44,144
buffer_load_dwordx4 a[172:175], v11, s[16:19], s53 offen offset:1024 sc1
v_mfma_f32_16x16x32_bf16 v[224:227], a[48:51], a[128:131], 0
TR 104,16,17056
s_add_u32 s53, s53, 131072
MAA 224,52,144
TR 106,16,17568
v_mfma_f32_16x16x32_bf16 v[228:231], a[48:51], a[132:135], 0
TR 108,16,25504
MAA 228,52,148
TR 110,16,26016
v_mfma_f32_16x16x32_bf16 v[236:239], a[56:59], a[132:135], 0
buffer_load_dwordx4 a[184:187], v11, s[16:19], s53 offen sc1
MAA 236,60,148
TR 112,17,16896
v_mfma_f32_16x16x32_bf16 v[232:235], a[56:59], a[128:131], 0
TR 114,17,17408
MAA 232,60,144
TR 116,17,25344
s_waitcnt vmcnt(11)
v_mfma_f32_16x16x32_bf16 v[188:191], a[40:43], a[140:143], 0
TR 118,17,25856
MAA 188,44,156
buffer_load_dwordx4 a[188:191], v11, s[16:19], s53 offen offset:1024 sc1
v_mfma_f32_16x16x32_bf16 v[184:187], a[40:43], a[136:139], 0
TR 120,17,16928
s_add_u32 s53, s53, 131072
MAA 184,44,152
TR 122,17,17440
s_add_u32 m0, s55, 84480
v_mfma_f32_16x16x32_bf16 v[168:171], a[32:35], a[136:139], 0
TR 124,17,25376
MAA 168,36,152
TR 126,17,25888
v_mfma_f32_16x16x32_bf16 v[172:175], a[32:35], a[140:143], 0
buffer_load_dwordx4 v12, s[32:35], s54 offen   lds
MAA 172,36,156
RD 192,9,16896
v_mfma_f32_16x16x32_bf16 v[124:127], a[24:27], a[140:143], 0
RD 196,9,17952
MAA 124,28,156
RD 200,9,19008
v_mfma_f32_16x16x32_bf16 v[120:123], a[24:27], a[136:139], 0
RD 204,9,20064
MAA 120,28,152
buffer_load_dwordx4 v13, s[32:35], s54 offen offset:1056   lds
v_mfma_f32_16x16x32_bf16 v[104:107], a[16:19], a[136:139], 0
MAA 104,20,152
v_mfma_f32_16x16x32_bf16 v[108:111], a[16:19], a[140:143], 0
MAA 108,20,156
v_mfma_f32_16x16x32_bf16 v[60:63], a[8:11], a[140:143], 0
buffer_load_dwordx4 v14, s[32:35], s54 offen offset:2112   lds
MAA 60,12,156
v_mfma_f32_16x16x32_bf16 v[56:59], a[8:11], a[136:139], 0
MAA 56,12,152
v_mfma_f32_16x16x32_bf16 v[40:43], a[0:3], a[136:139], 0
MAA 40,4,152
buffer_load_dwordx4 v15, s[32:35], s54 offen offset:3168   lds
.Lpad2:
s_cbranch_execz .Lpad5
v_mfma_f32_16x16x32_bf16 v[44:47], a[0:3], a[140:143], 0
MAA 44,4,156
s_waitcnt lgkmcnt(0)
s_barrier
v_mfma_f32_16x16x32_bf16 v[64:67], a[64:67], a[128:131], 0
TR 0,16,33792
s_add_u32 m0, s55, 101376
MAA 64,68,144
buffer_load_dwordx4 v12, s[80:83], s54 offen   lds
v_smfmac_f32_16x16x64_bf16 a[216:219], a[208:211], a[192:199], v6
TR 2,16,34304
s_mul_i32 s66, s13, 114688
v_smfmac_f32_16x16x64_bf16 a[216:219], a[208:211], a[200:207], v6
TR 4,16,42240
s_mul_i32 s65, s10, 1818624
v_mfma_f32_16x16x32_bf16 v[68:71], a[64:67], a[132:135], 0
TR 6,16,42752
s_add_u32 s66, s66, s65
MAA 68,68,148
TR 8,16,33824
s_add_u32 s66, s66, 12582912
v_mfma_f32_16x16x32_bf16 v[84:87], a[72:75], a[132:135], 0
buffer_load_dwordx4 v13, s[80:83], s54 offen offset:1056   lds
MAA 84,76,148
TR 10,16,34336
s_add_u32 s65, s66, 49152
v_mfma_f32_16x16x32_bf16 v[80:83], a[72:75], a[128:131], 0
TR 12,16,42272
s_lshl_b32 s62, s12, 16
MAA 80,76,144
TR 14,16,42784
s_add_u32 s62, s62, s66
v_mfma_f32_16x16x32_bf16 v[128:131], a[80:83], a[128:131], 0
TR 16,16,33856
s_add_u32 s63, s62, 16384
MAA 128,84,144
buffer_load_dwordx4 v14, s[80:83], s54 offen offset:2112   lds
v_mfma_f32_16x16x32_bf16 v[132:135], a[80:83], a[132:135], 0
TR 18,16,34368
s_add_u32 s64, s62, 32768
MAA 132,84,148
TR 20,16,42304
s_lshl_b32 s72, s10, 1
v_mfma_f32_16x16x32_bf16 v[148:151], a[88:91], a[132:135], 0
TR 22,16,42816
s_lshr_b32 s74, s11, 4
MAA 148,92,148
TR 24,16,33888
s_add_u32 s72, s72, s74
v_mfma_f32_16x16x32_bf16 v[144:147], a[88:91], a[128:131], 0
buffer_load_dwordx4 v15, s[80:83], s54 offen offset:3168   lds
MAA 144,92,144
TR 26,16,34400
s_add_u32 s54, s54, 458752
v_mfma_f32_16x16x32_bf16 v[192:195], a[96:99], a[128:131], 0
TR 28,16,42336
s_add_u32 m0, s57, 0
MAA 192,100,144
TR 30,16,42848
s_mov_b32 s58, 29622272
v_mfma_f32_16x16x32_bf16 v[196:199], a[96:99], a[132:135], 0
TR 32,16,33920
s_lshl_b32 s72, s72, 10
MAA 196,100,148
buffer_load_dwordx4 v4, s[16:19], s58 offen sc1 lds
v_mfma_f32_16x16x32_bf16 v[212:215], a[104:107], a[132:135], 0
TR 34,16,34432
s_add_u32 s72, s72, 30457856
MAA 212,108,148
TR 36,16,42368
s_and_b32 s73, s6, 14
v_mfma_f32_16x16x32_bf16 v[208:211], a[104:107], a[128:131], 0
TR 38,16,42880
s_and_b32 s74, s7, 1
MAA 208,108,144
TR 40,16,33952
s_add_u32 s73, s73, s74
v_mfma_f32_16x16x32_bf16 v[240:243], a[112:115], a[128:131], 0
buffer_load_dwordx4 v4, s[16:19], s58 offen offset:1024 sc1 lds
MAA 240,116,144
TR 42,16,34464
s_lshl_b32 s73, s73, 10
v_mfma_f32_16x16x32_bf16 v[244:247], a[112:115], a[132:135], 0
TR 44,16,42400
s_add_u32 s73, s73, 30457856
MAA 244,116,148
TR 46,16,42912
s_lshr_b32 s67, s5, 2
v_mfma_f32_16x16x32_bf16 v[252:255], a[120:123], a[132:135], 0
TR 48,17,33792
MAA 252,124,148
TR 50,17,34304
v_mfma_f32_16x16x32_bf16 v[248:251], a[120:123], a[128:131], 0
buffer_load_dwordx4 a[128:131], v10, s[16:19], s52 offen sc1
MAA 248,124,144
TR 52,17,42240
v_mfma_f32_16x16x32_bf16 v[220:223], a[104:107], a[140:143], 0
TR 54,17,42752
MAA 220,108,156
TR 56,17,33824
v_mfma_f32_16x16x32_bf16 v[216:219], a[104:107], a[136:139], 0
TR 58,17,34336
MAA 216,108,152
buffer_load_dwordx4 a[132:135], v10, s[16:19], s52 offen offset:1024 sc1
v_mfma_f32_16x16x32_bf16 v[200:203], a[96:99], a[136:139], 0
TR 60,17,42272
s_add_u32 s52, s52, 131072
MAA 200,100,152
TR 62,17,42784
v_mfma_f32_16x16x32_bf16 v[204:207], a[96:99], a[140:143], 0
RD 192,9,33792
MAA 204,100,156
RD 196,9,34848
v_mfma_f32_16x16x32_bf16 v[156:159], a[88:91], a[140:143], 0
buffer_load_dwordx4 a[144:147], v10, s[16:19], s52 offen sc1
MAA 156,92,156
RD 200,9,35904
v_mfma_f32_16x16x32_bf16 v[152:155], a[88:91], a[136:139], 0
RD 204,9,36960
MAA 152,92,152
v_mfma_f32_16x16x32_bf16 v[136:139], a[80:83], a[136:139], 0
MAA 136,84,152
buffer_load_dwordx4 a[148:151], v10, s[16:19], s52 offen offset:1024 sc1
v_mfma_f32_16x16x32_bf16 v[140:143], a[80:83], a[140:143], 0
s_add_u32 s52, s52, 131072
MAA 140,84,156
v_mfma_f32_16x16x32_bf16 v[92:95], a[72:75], a[140:143], 0
MAA 92,76,156
v_mfma_f32_16x16x32_bf16 v[88:91], a[72:75], a[136:139], 0
MAA 88,76,152
v_mfma_f32_16x16x32_bf16 v[72:75], a[64:67], a[136:139], 0
MAA 72,68,152
v_mfma_f32_16x16x32_bf16 v[76:79], a[64:67], a[140:143], 0
MAA 76,68,156
s_waitcnt vmcnt(18) lgkmcnt(0)
s_barrier
MAA 32,0,160
buffer_load_dwordx4 a[136:139], v11, s[16:19], s53 offen sc1
MAA 32,4,176
TR 64,16,50688
s_and_b32 s67, s67, 3
v_smfmac_f32_16x16x64_bf16 a[212:215], a[208:211], a[192:199], v6
TR 66,16,51200
s_lshl_b32 s67, s67, 7
v_smfmac_f32_16x16x64_bf16 a[212:215], a[208:211], a[200:207], v6
TR 68,16,59136
s_add_u32 s73, s73, s67
MAA 36,4,180
TR 70,16,59648
s_and_b32 s74, s7, 1
MAA 36,0,164
buffer_load_dwordx4 a[140:143], v11, s[16:19], s53 offen offset:1024 sc1
MAA 52,8,164
TR 72,16,50720
s_add_u32 s53, s53, 131072
MAA 52,12,180
TR 74,16,51232
s_mul_i32 s87, s74, 917504
MAA 48,12,176
TR 76,16,59168
s_lshr_b32 s75, s6, 1
MAA 48,8,160
TR 78,16,59680
s_mul_i32 s75, s75, 1818624
MAA 96,16,160
buffer_load_dwordx4 a[152:155], v11, s[16:19], s53 offen sc1
MAA 96,20,176
TR 80,16,50752
s_add_u32 s87, s87, s75
MAA 100,20,180
TR 82,16,51264
s_add_u32 s87, s87, 12582912
MAA 100,16,164
TR 84,16,59200
s_and_b32 s74, s6, 3
MAA 116,24,164
TR 86,16,59712
s_xor_b32 s75, s74, 0
MAA 116,28,180
buffer_load_dwordx4 a[156:159], v11, s[16:19], s53 offen offset:1024 sc1
MAA 112,28,176
TR 88,16,50784
s_add_u32 s53, s53, 131072
MAA 112,24,160
TR 90,16,51296
s_add_u32 m0, s55, 118272
MAA 160,32,160
TR 92,16,59232
s_sub_u32 s75, s75, 0
MAA 160,36,176
TR 94,16,59744
s_mul_i32 s98, s75, 458752
MAA 164,36,180
buffer_load_dwordx4 v12, s[32:35], s54 offen   lds
MAA 164,32,164
TR 96,16,50816
s_mul_i32 s75, s75, 114688
MAA 180,40,164
TR 98,16,51328
s_add_u32 s76, s87, s75
MAA 180,44,180
TR 100,16,59264
s_xor_b32 s75, s74, 1
MAA 176,44,176
TR 102,16,59776
s_sub_u32 s75, s75, 1
MAA 176,40,160
buffer_load_dwordx4 v13, s[32:35], s54 offen offset:1056   lds
MAA 224,48,160
TR 104,16,50848
s_mul_i32 s99, s75, 458752
MAA 224,52,176
TR 106,16,51360
s_mul_i32 s75, s75, 114688
MAA 228,52,180
TR 108,16,59296
s_add_u32 s77, s87, s75
MAA 228,48,164
TR 110,16,59808
MAA 236,56,164
buffer_load_dwordx4 v14, s[32:35], s54 offen offset:2112   lds
MAA 236,60,180
TR 112,17,50688
MAA 232,60,176
TR 114,17,51200
MAA 232,56,160
TR 116,17,59136
s_waitcnt vmcnt(21)
MAA 188,40,172
TR 118,17,59648
MAA 188,44,188
buffer_load_dwordx4 v15, s[32:35], s54 offen offset:3168   lds
MAA 184,44,184
TR 120,17,50720
s_add_u32 m0, s57, 2048
MAA 184,40,168
TR 122,17,51232
s_mov_b32 s58, 29624320
MAA 168,32,168
TR 124,17,59168
MAA 168,36,184
TR 126,17,59680
MAA 172,36,188
buffer_load_dwordx4 v4, s[16:19], s58 offen sc1 lds
MAA 172,32,172
RD 192,9,50688
MAA 124,24,172
RD 196,9,51744
MAA 124,28,188
RD 200,9,52800
MAA 120,28,184
RD 204,9,53856
MAA 120,24,168
buffer_load_dwordx4 v4, s[16:19], s58 offen offset:1024 sc1 lds
MAA 104,16,168
MAA 104,20,184
MAA 108,20,188
MAA 108,16,172
MAA 60,8,172
MAA 60,12,188
MAA 56,12,184
MAA 56,8,168
MAA 40,0,168
MAA 40,4,184
MAA 44,4,188
MAA 44,0,172
s_waitcnt vmcnt(20) lgkmcnt(0)
s_barrier
MAA 64,64,160
ds_read_b64_tr_b16 a[0:1], v16
s_add_u32 m0, s55, 135168
MAA 64,68,176
buffer_load_dwordx4 v12, s[80:83], s54 offen   lds
v_smfmac_f32_16x16x64_bf16 a[216:219], a[208:211], a[192:199], v6
TR 2,16,512
s_xor_b32 s75, s74, 2
v_smfmac_f32_16x16x64_bf16 a[216:219], a[208:211], a[200:207], v6
TR 4,16,8448
s_sub_u32 s75, s75, 2
MAA 68,68,180
TR 6,16,8960
s_mul_i32 s100, s75, 458752
MAA 68,64,164
TR 8,16,32
s_mul_i32 s75, s75, 114688
MAA 84,72,164
buffer_load_dwordx4 v13, s[80:83], s54 offen offset:1056   lds
MAA 84,76,180
TR 10,16,544
s_add_u32 s78, s87, s75
MAA 80,76,176
TR 12,16,8480
s_xor_b32 s75, s74, 3
MAA 80,72,160
TR 14,16,8992
s_sub_u32 s75, s75, 3
MAA 128,80,160
TR 16,16,64
s_mul_i32 s101, s75, 458752
MAA 128,84,176
buffer_load_dwordx4 v14, s[80:83], s54 offen offset:2112   lds
MAA 132,84,180
TR 18,16,576
s_mul_i32 s75, s75, 114688
MAA 132,80,164
TR 20,16,8512
s_add_u32 s79, s87, s75
MAA 148,88,164
TR 22,16,9024
s_and_b32 s87, s6, 3
MAA 148,92,180
TR 24,16,96
s_mov_b32 s46, 0
MAA 144,92,176
buffer_load_dwordx4 v15, s[80:83], s54 offen offset:3168   lds
MAA 144,88,160
TR 26,16,608
s_add_u32 s54, s54, 458752
MAA 192,96,160
TR 28,16,8544
s_add_u32 m0, s57, 4096
MAA 192,100,176
TR 30,16,9056
s_mov_b32 s58, 29626368
MAA 196,100,180
TR 32,16,128
s_lshl_b32 s74, s3, 10
MAA 196,96,164
buffer_load_dwordx4 v4, s[16:19], s58 offen sc1 lds
MAA 212,104,164
TR 34,16,640
s_lshl_b32 s75, s12, 9
MAA 212,108,180
TR 36,16,8576
s_add_u32 s74, s74, s75
MAA 208,108,176
TR 38,16,9088
s_add_u32 s74, s74, 152576
MAA 208,104,160
TR 40,16,160
v_and_b32 v18, 15, v1
MAA 240,112,160
buffer_load_dwordx4 v4, s[16:19], s58 offen offset:1024 sc1 lds
MAA 240,116,176
TR 42,16,672
v_lshl_add_u32 v18, v18, 4, s74
MAA 244,116,180
TR 44,16,8608
v_xor_b32 v19, 512, v18
MAA 244,112,164
TR 46,16,9120
MAA 252,120,164
ds_read_b64_tr_b16 a[48:49], v17
MAA 252,124,180
TR 50,17,512
MAA 248,124,176
TR 52,17,8448
MAA 248,120,160
buffer_load_dwordx4 a[160:163], v10, s[16:19], s52 offen sc1
MAA 220,104,172
TR 54,17,8960
MAA 220,108,188
TR 56,17,32
MAA 216,108,184
TR 58,17,544
MAA 216,104,168
TR 60,17,8480
MAA 200,96,168
buffer_load_dwordx4 a[164:167], v10, s[16:19], s52 offen offset:1024 sc1
MAA 200,100,184
TR 62,17,8992
s_add_u32 s52, s52, 131072
MAA 204,100,188
ds_read_b128 a[192:195], v9
MAA 204,96,172
RD 196,9,1056
MAA 156,88,172
RD 200,9,2112
MAA 156,92,188
buffer_load_dwordx4 a[176:179], v10, s[16:19], s52 offen sc1
MAA 152,92,184
RD 204,9,3168
MAA 152,88,168
MAA 136,80,168
MAA 136,84,184
MAA 140,84,188
buffer_load_dwordx4 a[180:183], v10, s[16:19], s52 offen offset:1024 sc1
MAA 140,80,172
s_add_u32 s52, s52, 131072
MAA 92,72,172
MAA 92,76,188
MAA 88,76,184
MAA 88,72,168
MAA 72,64,168
MAA 72,68,184
MAA 76,68,188
MAA 76,64,172
s_waitcnt vmcnt(20) lgkmcnt(0)
s_barrier
MAA 32,0,128
buffer_load_dwordx4 a[168:171], v11, s[16:19], s53 offen sc1
MAA 32,4,144
ds_read_b128 v[20:23], v2
v_smfmac_f32_16x16x64_bf16 a[212:215], a[208:211], a[192:199], v6
ds_read_b128 v[28:31], v2 offset:1024
v_smfmac_f32_16x16x64_bf16 a[212:215], a[208:211], a[200:207], v6
s_waitcnt vmcnt(11)
ds_read_b128 v[24:27], v2 offset:2048
MAA 36,4,148
TR 64,16,16896
MAA 36,0,132
buffer_load_dwordx4 a[172:175], v11, s[16:19], s53 offen offset:1024 sc1
MAA 52,8,132
TR 66,16,17408
s_add_u32 s53, s53, 131072
MAA 52,12,148
TR 68,16,25344
MAA 48,12,144
TR 70,16,25856
MAA 48,8,128
TR 72,16,16928
MAA 96,16,128
buffer_load_dwordx4 a[184:187], v11, s[16:19], s53 offen sc1
MAA 96,20,144
TR 74,16,17440
s_waitcnt lgkmcnt(7)
v_add_f32 v20, v20, v28
MAA 100,20,148
TR 76,16,25376
v_add_f32 v21, v21, v29
MAA 100,16,132
TR 78,16,25888
v_add_f32 v22, v22, v30
MAA 116,24,132
TR 80,16,16960
v_add_f32 v23, v23, v31
MAA 116,28,148
buffer_load_dwordx4 a[188:191], v11, s[16:19], s53 offen offset:1024 sc1
MAA 112,28,144
ds_read_b128 v[28:31], v2 offset:3072
s_add_u32 s53, s53, 131072
MAA 112,24,128
TR 82,16,17472
s_add_u32 m0, s55, 84480
MAA 160,32,128
TR 84,16,25408
s_waitcnt lgkmcnt(12)
v_add_f32 v20, v20, v24
MAA 160,36,144
TR 86,16,25920
v_add_f32 v21, v21, v25
MAA 164,36,148
buffer_load_dwordx4 v12, s[32:35], s54 offen   lds
MAA 164,32,132
TR 88,16,16992
v_add_f32 v22, v22, v26
MAA 180,40,132
TR 90,16,17504
v_add_f32 v23, v23, v27
MAA 180,44,148
TR 92,16,25440
MAA 176,44,144
TR 94,16,25952
MAA 176,40,128
buffer_load_dwordx4 v13, s[32:35], s54 offen offset:1056   lds
MAA 224,48,128
TR 96,16,17024
MAA 224,52,144
TR 98,16,17536
MAA 228,52,148
TR 100,16,25472
MAA 228,48,132
TR 102,16,25984
MAA 236,56,132
buffer_load_dwordx4 v14, s[32:35], s54 offen offset:2112   lds
MAA 236,60,148
TR 104,16,17056
MAA 232,60,144
TR 106,16,17568
MAA 232,56,128
TR 108,16,25504
MAA 188,40,140
TR 110,16,26016
MAA 188,44,156
buffer_load_dwordx4 v15, s[32:35], s54 offen offset:3168   lds
MAA 184,44,152
TR 112,17,16896
s_add_u32 m0, s57, 6144
MAA 184,40,136
TR 114,17,17408
s_mov_b32 s58, 29628416
MAA 168,32,136
TR 116,17,25344
MAA 168,36,152
TR 118,17,25856
MAA 172,36,156
buffer_load_dwordx4 v4, s[16:19], s58 offen sc1 lds
MAA 172,32,140
TR 120,17,16928
MAA 124,24,140
TR 122,17,17440
MAA 124,28,156
TR 124,17,25376
MAA 120,28,152
TR 126,17,25888
MAA 120,24,136
buffer_load_dwordx4 v4, s[16:19], s58 offen offset:1024 sc1 lds
MAA 104,16,136
RD 192,9,16896
MAA 104,20,152
RD 196,9,17952
MAA 108,20,156
RD 200,9,19008
MAA 108,16,140
RD 204,9,20064
MAA 60,8,140
MAA 60,12,156
MAA 56,12,152
MAA 56,8,136
MAA 40,0,136
MAA 40,4,152
MAA 44,4,156
s_sub_u32 s47, s47, 1
s_cbranch_scc1 .Lx39
.Lx39b:
MAA 44,0,140
s_waitcnt lgkmcnt(0)
s_barrier
MAA 64,64,128
s_waitcnt vmcnt(14)
ds_read_b128 v[24:27], v2 offset:4096
s_add_u32 m0, s55, 101376
MAA 64,68,144
buffer_load_dwordx4 v12, s[80:83], s54 offen   lds
v_smfmac_f32_16x16x64_bf16 a[216:219], a[208:211], a[192:199], v6
TR 0,16,33792
v_add_f32 v20, v20, v28
v_smfmac_f32_16x16x64_bf16 a[216:219], a[208:211], a[200:207], v6
TR 2,16,34304
v_add_f32 v21, v21, v29
MAA 68,68,148
TR 4,16,42240
v_add_f32 v22, v22, v30
MAA 68,64,132
TR 6,16,42752
v_add_f32 v23, v23, v31
.Lpad3:
s_cbranch_execz .Lnopoll34r
MAA 84,72,132
ds_read_b128 v[28:31], v2 offset:5120
MAA 84,76,148
TR 8,16,33824
MAA 80,76,144
buffer_load_dwordx4 v13, s[80:83], s54 offen offset:1056   lds
MAA 80,72,128
TR 10,16,34336
s_waitcnt lgkmcnt(7)
v_add_f32 v20, v20, v24
MAA 128,80,128
TR 12,16,42272
v_add_f32 v21, v21, v25
MAA 128,84,144
TR 14,16,42784
v_add_f32 v22, v22, v26
MAA 132,84,148
TR 16,16,33856
v_add_f32 v23, v23, v27
MAA 132,80,132
TR 18,16,34368
MAA 148,88,132
TR 20,16,42304
MAA 148,92,148
buffer_load_dwordx4 v14, s[80:83], s54 offen offset:2112   lds
MAA 144,92,144
TR 22,16,42816
MAA 144,88,128
TR 24,16,33888
MAA 192,96,128
TR 26,16,34400
MAA 192,100,144
TR 28,16,42336
MAA 196,100,148
TR 30,16,42848
MAA 196,96,132
TR 32,16,33920
MAA 212,104,132
buffer_load_dwordx4 v15, s[80:83], s54 offen offset:3168   lds
MAA 212,108,148
TR 34,16,34432
s_add_u32 s54, s54, 458752
MAA 208,108,144
TR 36,16,42368
MAA 208,104,128
TR 38,16,42880
MAA 240,112,128
TR 40,16,33952
MAA 240,116,144
TR 42,16,34464
MAA 244,116,148
TR 44,16,42400
MAA 244,112,132
TR 46,16,42912
MAA 252,120,132
TR 48,17,33792
MAA 252,124,148
TR 50,17,34304
MAA 248,124,144
TR 52,17,42240
MAA 248,120,128
buffer_load_dwordx4 a[128:131], v10, s[16:19], s52 offen sc1
MAA 220,104,140
TR 54,17,42752
MAA 220,108,156
TR 56,17,33824
MAA 216,108,152
TR 58,17,34336
MAA 216,104,136
TR 60,17,42272
MAA 200,96,136
TR 62,17,42784
MAA 200,100,152
RD 192,9,33792
MAA 204,100,156
buffer_load_dwordx4 a[132:135], v10, s[16:19], s52 offen offset:1024 sc1
MAA 204,96,140
RD 196,9,34848
s_add_u32 s52, s52, 131072
MAA 156,88,140
RD 200,9,35904
MAA 156,92,156
RD 204,9,36960
MAA 152,92,152
MAA 152,88,136
MAA 136,80,136
MAA 136,84,152
buffer_load_dwordx4 a[144:147], v10, s[16:19], s52 offen sc1
MAA 140,84,156
MAA 140,80,140
MAA 92,72,140
MAA 92,76,156
MAA 88,76,152
MAA 88,72,136
MAA 72,64,136
buffer_load_dwordx4 a[148:151], v10, s[16:19], s52 offen offset:1024 sc1
MAA 72,68,152
s_add_u32 s52, s52, 131072
MAA 76,68,156
s_sub_u32 s47, s47, 1
s_cbranch_scc1 .Lx40
.Lx40b:
MAA 76,64,140
s_waitcnt vmcnt(18) lgkmcnt(0)
s_barrier
MAA 32,0,160
buffer_load_dwordx4 a[136:139], v11, s[16:19], s53 offen sc1
MAA 32,4,176
s_waitcnt vmcnt(9)
ds_read_b128 v[24:27], v2 offset:6144
v_add_f32 v20, v20, v28
v_smfmac_f32_16x16x64_bf16 a[212:215], a[208:211], a[192:199], v6
TR 64,16,50688
v_add_f32 v21, v21, v29
v_smfmac_f32_16x16x64_bf16 a[212:215], a[208:211], a[200:207], v6
TR 66,16,51200
v_add_f32 v22, v22, v30
MAA 36,4,180
TR 68,16,59136
v_add_f32 v23, v23, v31
MAA 36,0,164
ds_read_b128 v[28:31], v2 offset:7168
MAA 52,8,164
TR 70,16,59648
MAA 52,12,180
buffer_load_dwordx4 a[140:143], v11, s[16:19], s53 offen offset:1024 sc1
MAA 48,12,176
TR 72,16,50720
s_add_u32 s53, s53, 131072
MAA 48,8,160
TR 74,16,51232
s_waitcnt lgkmcnt(7)
v_add_f32 v20, v20, v24
MAA 96,16,160
TR 76,16,59168
v_add_f32 v21, v21, v25
MAA 96,20,176
TR 78,16,59680
v_add_f32 v22, v22, v26
MAA 100,20,180
TR 80,16,50752
v_add_f32 v23, v23, v27
MAA 100,16,164
TR 82,16,51264
s_waitcnt lgkmcnt(7)
v_add_f32 v20, v20, v28
MAA 116,24,164
buffer_load_dwordx4 a[152:155], v11, s[16:19], s53 offen sc1
MAA 116,28,180
TR 84,16,59200
v_add_f32 v21, v21, v29
MAA 112,28,176
TR 86,16,59712
v_add_f32 v22, v22, v30
MAA 112,24,160
TR 88,16,50784
v_add_f32 v23, v23, v31
MAA 160,32,160
TR 90,16,51296
MAA 160,36,176
TR 92,16,59232
MAA 164,36,180
TR 94,16,59744
MAA 164,32,164
buffer_load_dwordx4 a[156:159], v11, s[16:19], s53 offen offset:1024 sc1
MAA 180,40,164
TR 96,16,50816
s_add_u32 s53, s53, 131072
MAA 180,44,180
TR 98,16,51328
s_add_u32 m0, s55, 118272
MAA 176,44,176
TR 100,16,59264
MAA 176,40,160
TR 102,16,59776
MAA 224,48,160
TR 104,16,50848
MAA 224,52,176
TR 106,16,51360
MAA 228,52,180
buffer_load_dwordx4 v12, s[32:35], s54 offen   lds
MAA 228,48,164
TR 108,16,59296
MAA 236,56,164
TR 110,16,59808
MAA 236,60,180
TR 112,17,50688
MAA 232,60,176
TR 114,17,51200
MAA 232,56,160
TR 116,17,59136
MAA 188,40,172
TR 118,17,59648
MAA 188,44,188
buffer_load_dwordx4 v13, s[32:35], s54 offen offset:1056   lds
MAA 184,44,184
TR 120,17,50720
MAA 184,40,168
TR 122,17,51232
MAA 168,32,168
TR 124,17,59168
MAA 168,36,184
TR 126,17,59680
MAA 172,36,188
RD 192,9,50688
MAA 172,32,172
RD 196,9,51744
MAA 124,24,172
buffer_load_dwordx4 v14, s[32:35], s54 offen offset:2112   lds
MAA 124,28,188
RD 200,9,52800
MAA 120,28,184
RD 204,9,53856
MAA 120,24,168
MAA 104,16,168
MAA 104,20,184
MAA 108,20,188
MAA 108,16,172
buffer_load_dwordx4 v15, s[32:35], s54 offen offset:3168   lds
MAA 60,8,172
MAA 60,12,188
MAA 56,12,184
MAA 56,8,168
MAA 40,0,168
MAA 40,4,184
MAA 44,4,188
s_sub_u32 s47, s47, 1
s_cbranch_scc1 .Lx41
.Lx41b:
MAA 44,0,172
s_waitcnt lgkmcnt(0)
s_barrier
MAA 64,64,160
ds_read_b64_tr_b16 a[0:1], v16
s_add_u32 m0, s55, 135168
MAA 64,68,176
buffer_load_dwordx4 v12, s[80:83], s54 offen   lds
v_smfmac_f32_16x16x64_bf16 a[216:219], a[208:211], a[192:199], v6
TR 2,16,512
v_permlane32_swap_b32 v20, v22
v_smfmac_f32_16x16x64_bf16 a[216:219], a[208:211], a[200:207], v6
TR 4,16,8448
v_permlane32_swap_b32 v21, v23
MAA 68,68,180
TR 6,16,8960
v_add_f32 v20, v20, v22
MAA 68,64,164
TR 8,16,32
v_add_f32 v21, v21, v23
MAA 84,72,164
TR 10,16,544
v_mul_f32 v20, 0xba800000, v20
MAA 84,76,180
buffer_load_dwordx4 v13, s[80:83], s54 offen offset:1056   lds
MAA 80,76,176
TR 12,16,8480
v_mul_f32 v21, 0x3a800000, v21
MAA 80,72,160
TR 14,16,8992
v_fma_f32 v21, -v20, v20, v21
MAA 128,80,160
TR 16,16,64
v_max_f32 v21, 0, v21
MAA 128,84,176
TR 18,16,576
v_add_f32 v21, 0x3727c5ac, v21
MAA 132,84,180
TR 20,16,8512
v_rsq_f32 v22, v21
MAA 132,80,164
TR 22,16,9024
v_and_b32 v24, 31, v1
MAA 148,88,164
buffer_load_dwordx4 v14, s[80:83], s54 offen offset:2112   lds
MAA 148,92,180
TR 24,16,96
v_lshrrev_b32 v25, 5, v1
MAA 144,92,176
TR 26,16,608
v_lshl_add_u32 v24, v24, 1, v25
MAA 144,88,160
TR 28,16,8544
v_and_b32 v25, 0xc0, v0
MAA 192,96,160
TR 30,16,9056
v_add_u32 v24, v24, v25
MAA 192,100,176
TR 32,16,128
v_lshlrev_b32 v24, 4, v24
MAA 196,100,180
TR 34,16,640
v_add_u32 v24, 152576, v24
MAA 196,96,164
buffer_load_dwordx4 v15, s[80:83], s54 offen offset:3168   lds
MAA 212,104,164
TR 36,16,8576
s_add_u32 s54, s54, 458752
MAA 212,108,180
TR 38,16,9088
v_mul_f32 v22, 0xbfb8aa3b, v22
MAA 208,108,176
ds_write_b128 v24, v[20:23]
s_mov_b32 s58, s98
MAA 208,104,160
ds_read_b64 v[20:21], v18
s_mov_b32 s67, s59
MAA 240,112,160
ds_read_b64 v[22:23], v18 offset:256
MAA 240,116,176
ds_read_b64 v[24:25], v19
MAA 244,116,180
ds_read_b64 v[26:27], v19 offset:256
MAA 244,112,164
ds_read_b32 v28, v18 offset:8
MAA 252,120,164
ds_read_b32 v29, v18 offset:264
v_mov_b32 v18, v5
MAA 252,124,180
ds_read_b32 v30, v19 offset:8
MAA 248,124,176
ds_read_b32 v31, v19 offset:264
v_add_u32 v19, 992, v5
MAA 248,120,160
buffer_load_dwordx4 a[160:163], v10, s[16:19], s52 offen sc1
MAA 220,104,172
TR 40,16,160
MAA 220,108,188
TR 42,16,672
MAA 216,108,184
TR 44,16,8608
MAA 216,104,168
TR 46,16,9120
MAA 200,96,168
ds_read_b64_tr_b16 a[48:49], v17
MAA 200,100,184
TR 50,17,512
MAA 204,100,188
buffer_load_dwordx4 a[164:167], v10, s[16:19], s52 offen offset:1024 sc1
MAA 204,96,172
TR 52,17,8448
s_add_u32 s52, s52, 131072
MAA 156,88,172
TR 54,17,8960
MAA 156,92,188
TR 56,17,32
MAA 152,92,184
TR 58,17,544
MAA 152,88,168
TR 60,17,8480
MAA 136,80,168
TR 62,17,8992
MAA 136,84,184
buffer_load_dwordx4 a[176:179], v10, s[16:19], s52 offen sc1
MAA 140,84,188
ds_read_b128 a[192:195], v9
MAA 140,80,172
RD 196,9,1056
MAA 92,72,172
RD 200,9,2112
MAA 92,76,188
RD 204,9,3168
MAA 88,76,184
MAA 88,72,168
MAA 72,64,168
buffer_load_dwordx4 a[180:183], v10, s[16:19], s52 offen offset:1024 sc1
MAA 72,68,184
s_add_u32 s52, s52, 131072
MAA 76,68,188
s_sub_u32 s47, s47, 1
s_cbranch_scc1 .Lx42
.Lx42b:
MAA 76,64,172
s_mov_b32 s15, -5
.p2align 6
.Lk43:
s_waitcnt vmcnt(16) lgkmcnt(0)
s_barrier
MAA 32,0,128
TR 64,16,16896
MAA 32,4,144
buffer_load_dwordx4 a[168:171], v11, s[16:19], s53 offen sc1
v_smfmac_f32_16x16x64_bf16 a[212:215], a[208:211], a[192:199], v6
s_sub_u32 s47, s47, 1
s_cbranch_scc1 .Lx44
.Lx44b:
v_smfmac_f32_16x16x64_bf16 a[212:215], a[208:211], a[200:207], v6
TR 66,16,17408
MAA 36,4,148
TR 68,16,25344
MAA 36,0,132
TR 70,16,25856
MAA 52,8,132
TR 72,16,16928
MAA 52,12,148
buffer_load_dwordx4 a[172:175], v11, s[16:19], s53 offen offset:1024 sc1
MAA 48,12,144
TR 74,16,17440
s_add_u32 s53, s53, 131072
MAA 48,8,128
MAA 96,16,128
TR 76,16,25376
MAA 96,20,144
TR 78,16,25888
MAA 100,20,148
TR 80,16,16960
MAA 100,16,132
buffer_load_dwordx4 a[184:187], v11, s[16:19], s53 offen sc1
MAA 116,24,132
TR 82,16,17472
MAA 116,28,148
TR 84,16,25408
MAA 112,28,144
MAA 112,24,128
TR 86,16,25920
MAA 160,32,128
TR 88,16,16992
MAA 160,36,144
buffer_load_dwordx4 a[188:191], v11, s[16:19], s53 offen offset:1024 sc1
MAA 164,36,148
TR 90,16,17504
s_add_u32 s53, s53, 131072
MAA 164,32,132
TR 92,16,25440
MAA 180,40,132
TR 94,16,25952
MAA 180,44,148
MAA 176,44,144
TR 96,16,17024
s_add_u32 m0, s55, 84480
MAA 176,40,128
buffer_load_dwordx4 v12, s[32:35], s54 offen   lds
MAA 224,48,128
TR 98,16,17536
MAA 224,52,144
TR 100,16,25472
MAA 228,52,148
TR 102,16,25984
MAA 228,48,132
TR 104,16,17056
MAA 236,56,132
MAA 236,60,148
TR 106,16,17568
MAA 232,60,144
TR 108,16,25504
MAA 232,56,128
TR 110,16,26016
s_waitcnt vmcnt(17)
MAA 188,40,140
TR 112,17,16896
MAA 188,44,156
buffer_load_dwordx4 v13, s[32:35], s54 offen offset:1056   lds
MAA 184,44,152
TR 114,17,17408
MAA 184,40,136
MAA 168,32,136
TR 116,17,25344
MAA 168,36,152
buffer_load_dwordx4 v14, s[32:35], s54 offen offset:2112   lds
MAA 172,36,156
TR 118,17,25856
MAA 172,32,140
TR 120,17,16928
MAA 124,24,140
TR 122,17,17440
MAA 124,28,156
TR 124,17,25376
MAA 120,28,152
MAA 120,24,136
buffer_load_dwordx4 v15, s[32:35], s54 offen offset:3168   lds
MAA 104,16,136
TR 126,17,25888
MAA 104,20,152
RD 192,9,16896
MAA 108,20,156
RD 196,9,17952
MAA 108,16,140
RD 200,9,19008
MAA 60,8,140
RD 204,9,20064
s_mov_b32 m0, s67
MAA 60,12,156
buffer_load_dwordx4 v18, s[28:31], s58 offen lds
MAA 56,12,152
MAA 56,8,136
MAA 40,0,136
MAA 40,4,152
MAA 44,4,156
MAA 44,0,140
s_waitcnt vmcnt(17) lgkmcnt(0)
s_barrier
MAA 64,64,128
TR 0,16,33792
s_add_u32 m0, s55, 101376
MAA 64,68,144
buffer_load_dwordx4 v12, s[80:83], s54 offen   lds
v_smfmac_f32_16x16x64_bf16 a[216:219], a[208:211], a[192:199], v6
s_sub_u32 s47, s47, 1
s_cbranch_scc1 .Lx45
.Lx45b:
v_smfmac_f32_16x16x64_bf16 a[216:219], a[208:211], a[200:207], v6
TR 2,16,34304
MAA 68,68,148
TR 4,16,42240
MAA 68,64,132
TR 6,16,42752
MAA 84,72,132
TR 8,16,33824
MAA 84,76,148
buffer_load_dwordx4 v13, s[80:83], s54 offen offset:1056   lds
MAA 80,76,144
TR 10,16,34336
MAA 80,72,128
MAA 128,80,128
TR 12,16,42272
MAA 128,84,144
TR 14,16,42784
MAA 132,84,148
TR 16,16,33856
MAA 132,80,132
buffer_load_dwordx4 v14, s[80:83], s54 offen offset:2112   lds
MAA 148,88,132
TR 18,16,34368
MAA 148,92,148
TR 20,16,42304
MAA 144,92,144
TR 22,16,42816
MAA 144,88,128
MAA 192,96,128
TR 24,16,33888
MAA 192,100,144
buffer_load_dwordx4 v15, s[80:83], s54 offen offset:3168   lds
MAA 196,100,148
TR 26,16,34400
s_add_u32 s54, s54, 458752
MAA 196,96,132
TR 28,16,42336
MAA 212,104,132
TR 30,16,42848
MAA 212,108,148
TR 32,16,33920
MAA 208,108,144
TR 34,16,34432
.Lpad4:
s_cbranch_execz .Lnopoll34r
s_mov_b32 m0, s67
MAA 208,104,128
buffer_load_dwordx4 v19, s[28:31], s58 offen offset:1056 lds
MAA 240,112,128
s_add_u32 s67, s67, 8448
s_add_u32 s58, s58, 0x40000
MAA 240,116,144
MAA 244,116,148
TR 36,16,42368
MAA 244,112,132
TR 38,16,42880
MAA 252,120,132
TR 40,16,33952
MAA 252,124,148
TR 42,16,34464
MAA 248,124,144
TR 44,16,42400
MAA 248,120,128
buffer_load_dwordx4 a[128:131], v10, s[16:19], s52 offen sc1
MAA 220,104,140
TR 46,16,42912
MAA 220,108,156
MAA 216,108,152
TR 48,17,33792
MAA 216,104,136
TR 50,17,34304
MAA 200,96,136
TR 52,17,42240
MAA 200,100,152
buffer_load_dwordx4 a[132:135], v10, s[16:19], s52 offen offset:1024 sc1
MAA 204,100,156
TR 54,17,42752
s_add_u32 s52, s52, 131072
MAA 204,96,140
TR 56,17,33824
MAA 156,88,140
TR 58,17,34336
MAA 156,92,156
MAA 152,92,152
TR 60,17,42272
MAA 152,88,136
buffer_load_dwordx4 a[144:147], v10, s[16:19], s52 offen sc1
MAA 136,80,136
TR 62,17,42784
MAA 136,84,152
RD 192,9,33792
MAA 140,84,156
RD 196,9,34848
MAA 140,80,140
RD 200,9,35904
MAA 92,72,140
RD 204,9,36960
MAA 92,76,156
buffer_load_dwordx4 a[148:151], v10, s[16:19], s52 offen offset:1024 sc1
MAA 88,76,152
s_add_u32 s52, s52, 131072
MAA 88,72,136
MAA 72,64,136
MAA 72,68,152
MAA 76,68,156
MAA 76,64,140
s_waitcnt vmcnt(18) lgkmcnt(0)
s_barrier
MAA 32,0,160
TR 64,16,50688
MAA 32,4,176
buffer_load_dwordx4 a[136:139], v11, s[16:19], s53 offen sc1
v_smfmac_f32_16x16x64_bf16 a[212:215], a[208:211], a[192:199], v6
s_sub_u32 s47, s47, 1
s_cbranch_scc1 .Lx46
.Lx46b:
v_smfmac_f32_16x16x64_bf16 a[212:215], a[208:211], a[200:207], v6
TR 66,16,51200
MAA 36,4,180
TR 68,16,59136
MAA 36,0,164
TR 70,16,59648
MAA 52,8,164
TR 72,16,50720
MAA 52,12,180
buffer_load_dwordx4 a[140:143], v11, s[16:19], s53 offen offset:1024 sc1
MAA 48,12,176
TR 74,16,51232
s_add_u32 s53, s53, 131072
MAA 48,8,160
MAA 96,16,160
TR 76,16,59168
MAA 96,20,176
TR 78,16,59680
MAA 100,20,180
TR 80,16,50752
MAA 100,16,164
buffer_load_dwordx4 a[152:155], v11, s[16:19], s53 offen sc1
MAA 116,24,164
TR 82,16,51264
MAA 116,28,180
TR 84,16,59200
MAA 112,28,176
MAA 112,24,160
TR 86,16,59712
MAA 160,32,160
TR 88,16,50784
MAA 160,36,176
buffer_load_dwordx4 a[156:159], v11, s[16:19], s53 offen offset:1024 sc1
MAA 164,36,180
TR 90,16,51296
s_add_u32 s53, s53, 131072
MAA 164,32,164
TR 92,16,59232
MAA 180,40,164
TR 94,16,59744
MAA 180,44,180
MAA 176,44,176
TR 96,16,50816
s_add_u32 m0, s55, 118272
MAA 176,40,160
buffer_load_dwordx4 v12, s[32:35], s54 offen   lds
MAA 224,48,160
TR 98,16,51328
MAA 224,52,176
TR 100,16,59264
MAA 228,52,180
TR 102,16,59776
MAA 228,48,164
TR 104,16,50848
MAA 236,56,164
MAA 236,60,180
TR 106,16,51360
MAA 232,60,176
TR 108,16,59296
MAA 232,56,160
TR 110,16,59808
s_waitcnt vmcnt(19)
MAA 188,40,172
TR 112,17,50688
MAA 188,44,188
buffer_load_dwordx4 v13, s[32:35], s54 offen offset:1056   lds
MAA 184,44,184
TR 114,17,51200
MAA 184,40,168
MAA 168,32,168
TR 116,17,59136
MAA 168,36,184
buffer_load_dwordx4 v14, s[32:35], s54 offen offset:2112   lds
MAA 172,36,188
TR 118,17,59648
MAA 172,32,172
TR 120,17,50720
MAA 124,24,172
TR 122,17,51232
MAA 124,28,188
TR 124,17,59168
MAA 120,28,184
MAA 120,24,168
buffer_load_dwordx4 v15, s[32:35], s54 offen offset:3168   lds
MAA 104,16,168
TR 126,17,59680
MAA 104,20,184
RD 192,9,50688
MAA 108,20,188
RD 196,9,51744
MAA 108,16,172
RD 200,9,52800
MAA 60,8,172
RD 204,9,53856
s_mov_b32 m0, s67
MAA 60,12,188
buffer_load_dwordx4 v18, s[28:31], s58 offen lds
MAA 56,12,184
MAA 56,8,168
MAA 40,0,168
MAA 40,4,184
MAA 44,4,188
MAA 44,0,172
s_waitcnt vmcnt(19) lgkmcnt(0)
s_barrier
MAA 64,64,160
ds_read_b64_tr_b16 a[0:1], v16
s_add_u32 m0, s55, 135168
MAA 64,68,176
buffer_load_dwordx4 v12, s[80:83], s54 offen   lds
v_smfmac_f32_16x16x64_bf16 a[216:219], a[208:211], a[192:199], v6
s_sub_u32 s47, s47, 1
s_cbranch_scc1 .Lx47
.Lx47b:
v_smfmac_f32_16x16x64_bf16 a[216:219], a[208:211], a[200:207], v6
TR 2,16,512
MAA 68,68,180
TR 4,16,8448
MAA 68,64,164
TR 6,16,8960
MAA 84,72,164
TR 8,16,32
MAA 84,76,180
buffer_load_dwordx4 v13, s[80:83], s54 offen offset:1056   lds
MAA 80,76,176
TR 10,16,544
MAA 80,72,160
MAA 128,80,160
TR 12,16,8480
MAA 128,84,176
TR 14,16,8992
MAA 132,84,180
TR 16,16,64
MAA 132,80,164
buffer_load_dwordx4 v14, s[80:83], s54 offen offset:2112   lds
MAA 148,88,164
TR 18,16,576
MAA 148,92,180
TR 20,16,8512
MAA 144,92,176
TR 22,16,9024
MAA 144,88,160
MAA 192,96,160
TR 24,16,96
MAA 192,100,176
buffer_load_dwordx4 v15, s[80:83], s54 offen offset:3168   lds
MAA 196,100,180
TR 26,16,608
s_add_u32 s54, s54, 458752
MAA 196,96,164
TR 28,16,8544
MAA 212,104,164
TR 30,16,9056
MAA 212,108,180
TR 32,16,128
MAA 208,108,176
TR 34,16,640
s_mov_b32 m0, s67
MAA 208,104,160
buffer_load_dwordx4 v19, s[28:31], s58 offen offset:1056 lds
MAA 240,112,160
s_add_u32 s67, s67, 8448
s_add_u32 s46, s46, 1
s_xor_b32 s58, s46, s87
s_mul_i32 s58, s58, 458752
MAA 240,116,176
MAA 244,116,180
TR 36,16,8576
MAA 244,112,164
TR 38,16,9088
MAA 252,120,164
TR 40,16,160
MAA 252,124,180
TR 42,16,672
MAA 248,124,176
TR 44,16,8608
MAA 248,120,160
buffer_load_dwordx4 a[160:163], v10, s[16:19], s52 offen sc1
MAA 220,104,172
TR 46,16,9120
MAA 220,108,188
MAA 216,108,184
ds_read_b64_tr_b16 a[48:49], v17
MAA 216,104,168
TR 50,17,512
MAA 200,96,168
TR 52,17,8448
MAA 200,100,184
buffer_load_dwordx4 a[164:167], v10, s[16:19], s52 offen offset:1024 sc1
MAA 204,100,188
TR 54,17,8960
s_add_u32 s52, s52, 131072
MAA 204,96,172
TR 56,17,32
MAA 156,88,172
TR 58,17,544
MAA 156,92,188
MAA 152,92,184
TR 60,17,8480
MAA 152,88,168
buffer_load_dwordx4 a[176:179], v10, s[16:19], s52 offen sc1
MAA 136,80,168
TR 62,17,8992
MAA 136,84,184
ds_read_b128 a[192:195], v9
MAA 140,84,188
RD 196,9,1056
MAA 140,80,172
RD 200,9,2112
MAA 92,72,172
RD 204,9,3168
MAA 92,76,188
buffer_load_dwordx4 a[180:183], v10, s[16:19], s52 offen offset:1024 sc1
MAA 88,76,184
s_add_u32 s52, s52, 131072
MAA 88,72,168
MAA 72,64,168
MAA 72,68,184
MAA 76,68,188
s_add_u32 s15, s15, 1
MAA 76,64,172
s_cbranch_scc0 .Lk43
s_branch .Lj48
.Lx39:
buffer_load_dword a220, v8, s[40:43], s45 offen
buffer_load_dword a220, v7, s[28:31], s44 offen
s_add_u32 s44, s44, 655360
s_add_u32 s45, s45, 917504
s_mov_b32 s47, 3
s_branch .Lx39b
.Lx40:
buffer_load_dword a220, v8, s[40:43], s45 offen
buffer_load_dword a220, v7, s[28:31], s44 offen
s_add_u32 s44, s44, 655360
s_add_u32 s45, s45, 917504
s_mov_b32 s47, 3
s_branch .Lx40b
.Lx41:
buffer_load_dword a220, v8, s[40:43], s45 offen
buffer_load_dword a220, v7, s[28:31], s44 offen
s_add_u32 s44, s44, 655360
s_add_u32 s45, s45, 917504
s_mov_b32 s47, 3
s_branch .Lx41b
.Lx42:
buffer_load_dword a220, v8, s[40:43], s45 offen
buffer_load_dword a220, v7, s[28:31], s44 offen
s_add_u32 s44, s44, 655360
s_add_u32 s45, s45, 917504
s_mov_b32 s47, 3
s_branch .Lx42b
.Lx44:
buffer_load_dword a220, v8, s[40:43], s45 offen
buffer_load_dword a220, v7, s[28:31], s44 offen
s_add_u32 s44, s44, 655360
s_add_u32 s45, s45, 917504
s_mov_b32 s47, 3
s_branch .Lx44b
.Lx45:
buffer_load_dword a220, v8, s[40:43], s45 offen
buffer_load_dword a220, v7, s[28:31], s44 offen
s_add_u32 s44, s44, 655360
s_add_u32 s45, s45, 917504
s_mov_b32 s47, 3
s_branch .Lx45b
.Lx46:
buffer_load_dword a220, v8, s[40:43], s45 offen
buffer_load_dword a220, v7, s[28:31], s44 offen
s_add_u32 s44, s44, 655360
s_add_u32 s45, s45, 917504
s_mov_b32 s47, 3
s_branch .Lx46b
.Lx47:
buffer_load_dword a220, v8, s[40:43], s45 offen
buffer_load_dword a220, v7, s[28:31], s44 offen
s_add_u32 s44, s44, 655360
s_add_u32 s45, s45, 917504
s_mov_b32 s47, 3
s_branch .Lx47b
.Lj48:
s_waitcnt vmcnt(10) lgkmcnt(0)
s_barrier
v_smfmac_f32_16x16x64_bf16 a[212:215], a[208:211], a[192:199], v6
RD 112,9,16896
s_lshl_b32 s74, s3, 10
v_smfmac_f32_16x16x64_bf16 a[212:215], a[208:211], a[200:207], v6
RD 116,9,17952
s_add_u32 s74, s74, 152576
MAA 32,0,128
RD 120,9,19008
s_sub_u32 s75, 156672, s74
MAA 32,4,144
RD 124,9,20064
v_and_b32 v7, 15, v1
MAA 48,12,144
RD 192,9,33792
v_lshl_add_u32 v7, v7, 5, s74
MAA 48,8,128
RD 196,9,34848
v_bfe_u32 v2, v1, 4, 1
MAA 36,0,132
RD 200,9,35904
v_lshl_add_u32 v7, v2, 4, v7
MAA 36,4,148
RD 204,9,36960
v_bfe_u32 v2, v1, 5, 1
MAA 52,12,148
buffer_load_dwordx4 a[168:171], v11, s[16:19], s53 offen sc1
MAA 52,8,132
TR 64,16,16896
v_mul_u32_u24 v2, s75, v2
s_waitcnt lgkmcnt(7)
v_smfmac_f32_16x16x64_bf16 a[216:219], a[208:211], a[112:119], v6
TR 66,16,17408
v_add_u32 v7, v7, v2
MAA 40,0,136
TR 68,16,25344
v_lshlrev_b32 v2, 4, v1
s_waitcnt lgkmcnt(7)
v_smfmac_f32_16x16x64_bf16 a[216:219], a[208:211], a[120:127], v6
buffer_load_dwordx4 a[172:175], v11, s[16:19], s53 offen offset:1024 sc1
MAA 40,4,152
TR 70,16,25856
s_add_u32 s53, s53, 131072
s_waitcnt lgkmcnt(6)
v_smfmac_f32_16x16x64_bf16 a[212:215], a[208:211], a[192:199], v6
TR 72,16,16928
v_add_u32 v2, 152576, v2
MAA 56,12,152
TR 74,16,17440
s_lshl_b32 s74, s12, 7
s_waitcnt lgkmcnt(6)
v_smfmac_f32_16x16x64_bf16 a[212:215], a[208:211], a[200:207], v6
buffer_load_dwordx4 a[184:187], v11, s[16:19], s53 offen sc1
MAA 56,8,136
TR 76,16,25376
s_add_u32 s74, s74, 161536
MAA 44,0,140
TR 78,16,25888
s_waitcnt vmcnt(8)
s_barrier
MAA 44,4,156
RD 112,9,50688
s_xor_b32 s75, s12, 1
MAA 60,12,156
RD 116,9,51744
s_mul_i32 s75, s75, 384
MAA 60,8,140
RD 120,9,52800
s_add_u32 s75, s75, 161536
MAA 96,16,128
RD 124,9,53856
v_lshrrev_b32 v9, 4, v1
MAA 96,20,144
ds_write_b128 v7, a[212:215]
v_lshlrev_b32 v9, 4, v9
MAA 112,28,144
buffer_load_dwordx4 a[188:191], v11, s[16:19], s53 offen offset:1024 sc1
MAA 112,24,128
TR 80,16,33792
s_add_u32 s53, s53, 131072
MAA 100,16,132
TR 82,16,34304
v_add_u32 v8, s75, v9
MAA 100,20,148
TR 84,16,42240
v_add_u32 v9, s74, v9
MAA 116,28,148
TR 86,16,42752
s_add_u32 s58, s99, 2293760
s_waitcnt lgkmcnt(7)
v_smfmac_f32_16x16x64_bf16 a[216:219], a[208:211], a[112:119], v6
TR 88,16,33824
s_lshl_b32 s74, s3, 11
MAA 116,24,132
TR 90,16,34336
s_add_u32 s74, s74, s84
s_waitcnt lgkmcnt(7)
v_smfmac_f32_16x16x64_bf16 a[216:219], a[208:211], a[120:127], v6
TR 92,16,42272
s_add_u32 s54, s98, 65536
MAA 104,16,136
TR 94,16,42784
s_mul_i32 s55, s3, 2112
MAA 104,20,152
TR 96,16,50688
s_mov_b32 s57, 67584
MAA 120,28,152
ds_write_b128 v7, a[216:219] offset:512
MAA 120,24,136
TR 98,16,51200
MAA 108,16,140
TR 100,16,59136
MAA 108,20,156
TR 102,16,59648
MAA 124,28,156
TR 104,16,50720
MAA 124,24,140
TR 106,16,51232
MAA 160,32,128
TR 108,16,59168
MAA 160,36,144
TR 110,16,59680
MAA 176,44,144
s_waitcnt lgkmcnt(7)
s_barrier
ds_read_b128 v[12:15], v2
MAA 176,40,128
ds_read_b128 v[4:7], v2 offset:1024
MAA 164,32,132
TR 192,16,16960
MAA 164,36,148
TR 194,16,17472
MAA 180,44,148
TR 196,16,25408
MAA 180,40,132
TR 198,16,25920
MAA 168,32,136
TR 200,16,16992
MAA 168,36,152
TR 202,16,17504
MAA 184,44,152
TR 204,16,25440
MAA 184,40,136
TR 206,16,25952
s_waitcnt lgkmcnt(8)
v_add_f32 v12, v12, v4
MAA 172,32,140
TR 112,16,33856
v_add_f32 v13, v13, v5
MAA 172,36,156
TR 114,16,34368
v_add_f32 v14, v14, v6
MAA 188,44,156
TR 116,16,42304
v_add_f32 v15, v15, v7
MAA 188,40,140
ds_read_b128 v[4:7], v2 offset:2048
MAA 224,48,128
TR 118,16,42816
MAA 224,52,144
TR 120,16,33888
MAA 232,60,144
TR 122,16,34400
MAA 232,56,128
TR 124,16,42336
MAA 228,48,132
TR 126,16,42848
MAA 228,52,148
TR 0,16,50752
MAA 236,60,148
TR 2,16,51264
MAA 236,56,132
TR 4,16,59200
s_waitcnt lgkmcnt(8)
v_add_f32 v12, v12, v4
MAA 64,64,128
TR 6,16,59712
v_add_f32 v13, v13, v5
MAA 64,68,144
TR 8,16,50784
v_add_f32 v14, v14, v6
s_waitcnt vmcnt(7)
MAA 64,96,160
TR 10,16,51296
v_add_f32 v15, v15, v7
s_waitcnt vmcnt(5)
MAA 64,100,176
ds_read_b128 v[4:7], v2 offset:3072
MAA 80,108,176
TR 12,16,59232
MAA 80,104,160
TR 14,16,59744
MAA 80,76,144
TR 16,16,17024
MAA 80,72,128
TR 18,16,17536
MAA 32,80,160
TR 20,16,25472
MAA 32,84,176
TR 22,16,25984
MAA 48,92,176
TR 24,16,17056
MAA 48,88,160
TR 26,16,17568
s_waitcnt lgkmcnt(8)
v_add_f32 v12, v12, v4
v_add_f32 v13, v13, v5
.Lpad5:
s_cbranch_execz .Lnopoll34r
v_add_f32 v14, v14, v6
v_add_f32 v15, v15, v7
ds_write_b128 v2, v[12:15] offset:8960
ds_read_b128 v[12:15], v9
ds_read_b128 v[4:7], v9 offset:64
v_lshrrev_b32 v2, 3, v1
v_cmp_eq_u32 vcc, 3, v2
TR 28,16,25504
TR 30,16,26016
TR 32,16,33920
TR 34,16,34432
TR 36,16,42368
TR 38,16,42880
TR 40,16,33952
TR 42,16,34464
TR 44,16,42400
TR 46,16,42912
TR 48,16,50816
TR 50,16,51328
TR 52,16,59264
s_waitcnt lgkmcnt(14)
v_pk_fma_f32 v[32:33], v[12:13], v[20:21], v[32:33] op_sel_hi:[1,0,1]
v_pk_fma_f32 v[34:35], v[14:15], v[20:21], v[34:35] op_sel_hi:[1,0,1]
v_pk_fma_f32 v[36:37], v[12:13], v[22:23], v[36:37] op_sel_hi:[1,0,1]
v_pk_fma_f32 v[38:39], v[14:15], v[22:23], v[38:39] op_sel_hi:[1,0,1]
v_pk_fma_f32 v[40:41], v[12:13], v[24:25], v[40:41] op_sel_hi:[1,0,1]
v_pk_fma_f32 v[42:43], v[14:15], v[24:25], v[42:43] op_sel_hi:[1,0,1]
v_pk_fma_f32 v[44:45], v[12:13], v[26:27], v[44:45] op_sel_hi:[1,0,1]
v_pk_fma_f32 v[46:47], v[14:15], v[26:27], v[46:47] op_sel_hi:[1,0,1]
ds_read_b128 v[12:15], v9 offset:512
s_waitcnt lgkmcnt(14)
v_pk_fma_f32 v[48:49], v[4:5], v[20:21], v[48:49] op_sel_hi:[1,0,1]
v_pk_fma_f32 v[50:51], v[6:7], v[20:21], v[50:51] op_sel_hi:[1,0,1]
v_pk_fma_f32 v[52:53], v[4:5], v[22:23], v[52:53] op_sel_hi:[1,0,1]
v_pk_fma_f32 v[54:55], v[6:7], v[22:23], v[54:55] op_sel_hi:[1,0,1]
v_pk_fma_f32 v[56:57], v[4:5], v[24:25], v[56:57] op_sel_hi:[1,0,1]
v_pk_fma_f32 v[58:59], v[6:7], v[24:25], v[58:59] op_sel_hi:[1,0,1]
v_pk_fma_f32 v[60:61], v[4:5], v[26:27], v[60:61] op_sel_hi:[1,0,1]
v_pk_fma_f32 v[62:63], v[6:7], v[26:27], v[62:63] op_sel_hi:[1,0,1]
ds_read_b128 v[4:7], v9 offset:576
TR 54,16,59776
TR 56,16,50848
TR 58,16,51360
TR 60,16,59296
TR 62,16,59808
s_waitcnt lgkmcnt(6)
v_pk_fma_f32 v[64:65], v[12:13], v[20:21], v[64:65] op_sel_hi:[1,0,1]
v_pk_fma_f32 v[66:67], v[14:15], v[20:21], v[66:67] op_sel_hi:[1,0,1]
v_pk_fma_f32 v[68:69], v[12:13], v[22:23], v[68:69] op_sel_hi:[1,0,1]
v_pk_fma_f32 v[70:71], v[14:15], v[22:23], v[70:71] op_sel_hi:[1,0,1]
v_pk_fma_f32 v[72:73], v[12:13], v[24:25], v[72:73] op_sel_hi:[1,0,1]
v_pk_fma_f32 v[74:75], v[14:15], v[24:25], v[74:75] op_sel_hi:[1,0,1]
v_pk_fma_f32 v[76:77], v[12:13], v[26:27], v[76:77] op_sel_hi:[1,0,1]
v_pk_fma_f32 v[78:79], v[14:15], v[26:27], v[78:79] op_sel_hi:[1,0,1]
ds_read_b128 v[12:15], v9 offset:832
s_waitcnt lgkmcnt(6)
v_pk_fma_f32 v[80:81], v[4:5], v[20:21], v[80:81] op_sel_hi:[1,0,1]
v_pk_fma_f32 v[82:83], v[6:7], v[20:21], v[82:83] op_sel_hi:[1,0,1]
v_pk_fma_f32 v[84:85], v[4:5], v[22:23], v[84:85] op_sel_hi:[1,0,1]
v_pk_fma_f32 v[86:87], v[6:7], v[22:23], v[86:87] op_sel_hi:[1,0,1]
v_pk_fma_f32 v[88:89], v[4:5], v[24:25], v[88:89] op_sel_hi:[1,0,1]
v_pk_fma_f32 v[90:91], v[6:7], v[24:25], v[90:91] op_sel_hi:[1,0,1]
v_pk_fma_f32 v[92:93], v[4:5], v[26:27], v[92:93] op_sel_hi:[1,0,1]
v_pk_fma_f32 v[94:95], v[6:7], v[26:27], v[94:95] op_sel_hi:[1,0,1]
ds_read_b128 v[4:7], v9 offset:704
v_pk_mul_f32 v[64:65], v[64:65], v[32:33]
v_pk_mul_f32 v[32:33], v[32:33], v[28:29] op_sel_hi:[1,0]
v_pk_mul_f32 v[66:67], v[66:67], v[34:35]
v_pk_mul_f32 v[34:35], v[34:35], v[28:29] op_sel_hi:[1,0]
v_pk_mul_f32 v[80:81], v[80:81], v[48:49]
v_pk_mul_f32 v[48:49], v[48:49], v[28:29] op_sel_hi:[1,0]
v_pk_mul_f32 v[82:83], v[82:83], v[50:51]
v_pk_mul_f32 v[50:51], v[50:51], v[28:29] op_sel_hi:[1,0]
v_exp_f32 v32, v32
v_exp_f32 v33, v33
MAA 68,64,132
v_exp_f32 v34, v34
MAA 68,68,148
v_exp_f32 v35, v35
MAA 68,96,164
v_exp_f32 v48, v48
s_waitcnt vmcnt(4)
MAA 68,100,180
v_exp_f32 v49, v49
MAA 84,108,180
v_exp_f32 v50, v50
MAA 84,104,164
v_exp_f32 v51, v51
MAA 84,76,148
MAA 84,72,132
MAA 36,80,164
MAA 36,84,180
MAA 52,92,180
MAA 52,88,164
s_nop 5
v_pk_mul_f32 v[68:69], v[68:69], v[36:37]
v_pk_fma_f32 v[32:33], v[32:33], v[20:21], v[20:21] op_sel:[0,1,1] op_sel_hi:[1,1,1]
v_pk_fma_f32 v[34:35], v[34:35], v[20:21], v[20:21] op_sel:[0,1,1] op_sel_hi:[1,1,1]
v_pk_fma_f32 v[48:49], v[48:49], v[20:21], v[20:21] op_sel:[0,1,1] op_sel_hi:[1,1,1]
v_pk_fma_f32 v[50:51], v[50:51], v[20:21], v[20:21] op_sel:[0,1,1] op_sel_hi:[1,1,1]
v_rcp_f32 v32, v32
v_pk_mul_f32 v[36:37], v[36:37], v[28:29] op_sel:[0,1] op_sel_hi:[1,1]
v_pk_mul_f32 v[70:71], v[70:71], v[38:39]
v_pk_mul_f32 v[38:39], v[38:39], v[28:29] op_sel:[0,1] op_sel_hi:[1,1]
v_pk_mul_f32 v[84:85], v[84:85], v[52:53]
v_pk_mul_f32 v[52:53], v[52:53], v[28:29] op_sel:[0,1] op_sel_hi:[1,1]
v_pk_mul_f32 v[86:87], v[86:87], v[54:55]
v_pk_mul_f32 v[54:55], v[54:55], v[28:29] op_sel:[0,1] op_sel_hi:[1,1]
v_rcp_f32 v33, v33
v_rcp_f32 v34, v34
MAA 72,64,136
v_rcp_f32 v35, v35
MAA 72,68,152
v_rcp_f32 v48, v48
s_waitcnt vmcnt(3)
MAA 72,96,168
v_rcp_f32 v49, v49
s_waitcnt vmcnt(1)
MAA 72,100,184
v_rcp_f32 v50, v50
MAA 88,108,184
v_rcp_f32 v51, v51
MAA 88,104,168
v_exp_f32 v36, v36
MAA 88,76,152
v_exp_f32 v37, v37
MAA 88,72,136
v_exp_f32 v38, v38
MAA 40,80,168
v_exp_f32 v39, v39
MAA 40,84,184
v_exp_f32 v52, v52
MAA 56,92,184
v_exp_f32 v53, v53
MAA 56,88,168
v_exp_f32 v54, v54
v_exp_f32 v55, v55
v_pk_mul_f32 v[64:65], v[64:65], v[32:33]
v_pk_mul_f32 v[66:67], v[66:67], v[34:35]
v_pk_mul_f32 v[80:81], v[80:81], v[48:49]
v_pk_mul_f32 v[82:83], v[82:83], v[50:51]
ds_read_b128 v[48:51], v9 offset:128
v_pk_mul_f32 v[72:73], v[72:73], v[40:41]
v_pk_mul_f32 v[40:41], v[40:41], v[30:31] op_sel_hi:[1,0]
v_pk_mul_f32 v[74:75], v[74:75], v[42:43]
v_pk_mul_f32 v[42:43], v[42:43], v[30:31] op_sel_hi:[1,0]
v_pk_mul_f32 v[88:89], v[88:89], v[56:57]
v_pk_mul_f32 v[56:57], v[56:57], v[30:31] op_sel_hi:[1,0]
v_pk_mul_f32 v[90:91], v[90:91], v[58:59]
v_pk_mul_f32 v[58:59], v[58:59], v[30:31] op_sel_hi:[1,0]
v_pk_fma_f32 v[36:37], v[36:37], v[22:23], v[22:23] op_sel:[0,1,1] op_sel_hi:[1,1,1]
v_pk_fma_f32 v[38:39], v[38:39], v[22:23], v[22:23] op_sel:[0,1,1] op_sel_hi:[1,1,1]
v_pk_fma_f32 v[52:53], v[52:53], v[22:23], v[22:23] op_sel:[0,1,1] op_sel_hi:[1,1,1]
v_pk_fma_f32 v[54:55], v[54:55], v[22:23], v[22:23] op_sel:[0,1,1] op_sel_hi:[1,1,1]
v_cvt_pk_bf16_f32 v32, v64, v65
v_cvt_pk_bf16_f32 v33, v66, v67
ds_read_b128 v[64:67], v9 offset:192
v_cvt_pk_bf16_f32 v34, v80, v81
v_cvt_pk_bf16_f32 v35, v82, v83
MAA 76,64,140
buffer_store_dwordx4 v[32:35], v10, s[16:19], s62 offen sc1
MAA 76,68,156
ds_read_b128 v[80:83], v9 offset:640
v_rcp_f32 v36, v36
MAA 76,96,172
TR 64,17,16896
v_rcp_f32 v37, v37
s_waitcnt vmcnt(1)
MAA 76,100,188
TR 66,17,17408
v_rcp_f32 v38, v38
MAA 92,108,188
TR 68,17,25344
v_rcp_f32 v39, v39
MAA 92,104,172
TR 70,17,25856
v_rcp_f32 v52, v52
MAA 92,76,156
TR 76,17,25376
v_rcp_f32 v53, v53
MAA 92,72,140
TR 72,17,16928
v_rcp_f32 v54, v54
MAA 44,80,172
TR 74,17,17440
v_rcp_f32 v55, v55
MAA 44,84,188
TR 78,17,25888
v_exp_f32 v40, v40
MAA 60,92,188
TR 80,17,33792
v_exp_f32 v41, v41
MAA 60,88,172
TR 82,17,34304
v_exp_f32 v42, v42
v_exp_f32 v43, v43
v_exp_f32 v56, v56
v_exp_f32 v57, v57
v_exp_f32 v58, v58
v_exp_f32 v59, v59
v_pk_mul_f32 v[68:69], v[68:69], v[36:37]
v_pk_mul_f32 v[70:71], v[70:71], v[38:39]
v_pk_mul_f32 v[84:85], v[84:85], v[52:53]
v_pk_mul_f32 v[86:87], v[86:87], v[54:55]
ds_read_b128 v[52:55], v8 offset:576
v_pk_mul_f32 v[76:77], v[76:77], v[44:45]
v_pk_mul_f32 v[44:45], v[44:45], v[30:31] op_sel:[0,1] op_sel_hi:[1,1]
v_pk_mul_f32 v[78:79], v[78:79], v[46:47]
v_pk_mul_f32 v[46:47], v[46:47], v[30:31] op_sel:[0,1] op_sel_hi:[1,1]
v_pk_mul_f32 v[92:93], v[92:93], v[60:61]
v_pk_mul_f32 v[60:61], v[60:61], v[30:31] op_sel:[0,1] op_sel_hi:[1,1]
v_pk_mul_f32 v[94:95], v[94:95], v[62:63]
v_pk_mul_f32 v[62:63], v[62:63], v[30:31] op_sel:[0,1] op_sel_hi:[1,1]
v_pk_fma_f32 v[40:41], v[40:41], v[24:25], v[24:25] op_sel:[0,1,1] op_sel_hi:[1,1,1]
v_pk_fma_f32 v[42:43], v[42:43], v[24:25], v[24:25] op_sel:[0,1,1] op_sel_hi:[1,1,1]
v_pk_fma_f32 v[56:57], v[56:57], v[24:25], v[24:25] op_sel:[0,1,1] op_sel_hi:[1,1,1]
v_pk_fma_f32 v[58:59], v[58:59], v[24:25], v[24:25] op_sel:[0,1,1] op_sel_hi:[1,1,1]
v_cvt_pk_bf16_f32 v36, v68, v69
v_cvt_pk_bf16_f32 v37, v70, v71
v_cvt_pk_bf16_f32 v38, v84, v85
v_cvt_pk_bf16_f32 v39, v86, v87
MAA 128,192,128
buffer_store_dwordx4 v[36:39], v10, s[16:19], s62 offen offset:1024 sc1
MAA 128,196,144
TR 84,17,42240
v_rcp_f32 v40, v40
MAA 128,0,160
TR 86,17,42752
v_rcp_f32 v41, v41
MAA 128,4,176
TR 88,17,33824
v_rcp_f32 v42, v42
MAA 144,12,176
TR 90,17,34336
v_rcp_f32 v43, v43
MAA 144,8,160
TR 92,17,42272
v_rcp_f32 v56, v56
MAA 144,204,144
TR 94,17,42784
v_rcp_f32 v57, v57
MAA 144,200,128
TR 96,17,50688
v_rcp_f32 v58, v58
MAA 96,112,160
TR 98,17,51200
v_rcp_f32 v59, v59
MAA 96,116,176
TR 100,17,59136
v_exp_f32 v44, v44
MAA 112,124,176
TR 102,17,59648
v_exp_f32 v45, v45
MAA 112,120,160
TR 104,17,50720
v_lshrrev_b32 v69, 2, v0
v_min_u32 v69, 1, v69
v_lshlrev_b32 v69, 28, v69
v_lshl_add_u32 v68, v0, 7, v69
v_xor_b32 v69, 64, v0
v_min_u32 v69, 1, v69
v_lshlrev_b32 v70, 4, v69
v_sub_u32 v70, 16, v70
v_lshlrev_b32 v69, 28, v69
v_mov_b32 v71, 1
v_mov_b32 v84, 0
v_mov_b32 v85, 0
v_mov_b32 v86, 0
v_exp_f32 v46, v46
v_exp_f32 v47, v47
v_exp_f32 v60, v60
v_exp_f32 v61, v61
v_exp_f32 v62, v62
v_exp_f32 v63, v63
v_pk_mul_f32 v[72:73], v[72:73], v[40:41]
v_pk_mul_f32 v[74:75], v[74:75], v[42:43]
v_pk_mul_f32 v[88:89], v[88:89], v[56:57]
v_pk_mul_f32 v[90:91], v[90:91], v[58:59]
s_waitcnt lgkmcnt(15)
v_pk_fma_f32 v[96:97], v[48:49], v[20:21], v[96:97] op_sel_hi:[1,0,1]
v_pk_fma_f32 v[98:99], v[50:51], v[20:21], v[98:99] op_sel_hi:[1,0,1]
v_pk_fma_f32 v[112:113], v[64:65], v[20:21], v[112:113] op_sel_hi:[1,0,1]
v_pk_fma_f32 v[114:115], v[66:67], v[20:21], v[114:115] op_sel_hi:[1,0,1]
v_pk_fma_f32 v[128:129], v[80:81], v[20:21], v[128:129] op_sel_hi:[1,0,1]
v_pk_fma_f32 v[130:131], v[82:83], v[20:21], v[130:131] op_sel_hi:[1,0,1]
v_pk_fma_f32 v[144:145], v[4:5], v[20:21], v[144:145] op_sel_hi:[1,0,1]
v_pk_fma_f32 v[146:147], v[6:7], v[20:21], v[146:147] op_sel_hi:[1,0,1]
v_pk_mul_f32 v[128:129], v[128:129], v[96:97]
v_pk_mul_f32 v[96:97], v[96:97], v[28:29] op_sel_hi:[1,0]
v_pk_mul_f32 v[130:131], v[130:131], v[98:99]
v_pk_mul_f32 v[98:99], v[98:99], v[28:29] op_sel_hi:[1,0]
v_pk_mul_f32 v[144:145], v[144:145], v[112:113]
v_pk_mul_f32 v[112:113], v[112:113], v[28:29] op_sel_hi:[1,0]
v_pk_mul_f32 v[146:147], v[146:147], v[114:115]
v_pk_mul_f32 v[114:115], v[114:115], v[28:29] op_sel_hi:[1,0]
v_pk_fma_f32 v[44:45], v[44:45], v[26:27], v[26:27] op_sel:[0,1,1] op_sel_hi:[1,1,1]
v_pk_fma_f32 v[46:47], v[46:47], v[26:27], v[26:27] op_sel:[0,1,1] op_sel_hi:[1,1,1]
v_pk_fma_f32 v[60:61], v[60:61], v[26:27], v[26:27] op_sel:[0,1,1] op_sel_hi:[1,1,1]
v_pk_fma_f32 v[62:63], v[62:63], v[26:27], v[26:27] op_sel:[0,1,1] op_sel_hi:[1,1,1]
v_cvt_pk_bf16_f32 v40, v72, v73
v_cvt_pk_bf16_f32 v41, v74, v75
v_cvt_pk_bf16_f32 v42, v88, v89
v_cvt_pk_bf16_f32 v43, v90, v91
MAA 132,192,132
buffer_store_dwordx4 v[40:43], v11, s[16:19], s62 offen sc1
MAA 132,196,148
TR 106,17,51232
v_rcp_f32 v44, v44
MAA 132,0,164
TR 108,17,59168
v_rcp_f32 v45, v45
MAA 132,4,180
TR 110,17,59680
v_rcp_f32 v46, v46
MAA 148,12,180
v_rcp_f32 v47, v47
MAA 148,8,164
v_rcp_f32 v60, v60
MAA 148,204,148
v_rcp_f32 v61, v61
MAA 148,200,132
v_rcp_f32 v62, v62
MAA 100,112,164
v_rcp_f32 v63, v63
MAA 100,116,180
v_exp_f32 v96, v96
MAA 116,124,180
v_exp_f32 v97, v97
MAA 116,120,164
s_waitcnt lgkmcnt(0)
s_barrier
s_add_u32 m0, s59, 84480
v_exp_f32 v98, v98
v_exp_f32 v99, v99
v_exp_f32 v112, v112
v_exp_f32 v113, v113
v_exp_f32 v114, v114
v_exp_f32 v115, v115
v_pk_mul_f32 v[76:77], v[76:77], v[44:45]
v_pk_mul_f32 v[78:79], v[78:79], v[46:47]
v_pk_mul_f32 v[92:93], v[92:93], v[60:61]
v_pk_mul_f32 v[94:95], v[94:95], v[62:63]
v_pk_fma_f32 v[100:101], v[48:49], v[22:23], v[100:101] op_sel_hi:[1,0,1]
v_pk_fma_f32 v[102:103], v[50:51], v[22:23], v[102:103] op_sel_hi:[1,0,1]
v_pk_fma_f32 v[116:117], v[64:65], v[22:23], v[116:117] op_sel_hi:[1,0,1]
v_pk_fma_f32 v[118:119], v[66:67], v[22:23], v[118:119] op_sel_hi:[1,0,1]
v_pk_fma_f32 v[132:133], v[80:81], v[22:23], v[132:133] op_sel_hi:[1,0,1]
v_pk_fma_f32 v[134:135], v[82:83], v[22:23], v[134:135] op_sel_hi:[1,0,1]
v_pk_fma_f32 v[148:149], v[4:5], v[22:23], v[148:149] op_sel_hi:[1,0,1]
v_pk_fma_f32 v[150:151], v[6:7], v[22:23], v[150:151] op_sel_hi:[1,0,1]
v_pk_mul_f32 v[132:133], v[132:133], v[100:101]
v_pk_mul_f32 v[100:101], v[100:101], v[28:29] op_sel:[0,1] op_sel_hi:[1,1]
v_pk_mul_f32 v[134:135], v[134:135], v[102:103]
v_pk_mul_f32 v[102:103], v[102:103], v[28:29] op_sel:[0,1] op_sel_hi:[1,1]
v_pk_mul_f32 v[148:149], v[148:149], v[116:117]
v_pk_mul_f32 v[116:117], v[116:117], v[28:29] op_sel:[0,1] op_sel_hi:[1,1]
v_pk_mul_f32 v[150:151], v[150:151], v[118:119]
v_pk_mul_f32 v[118:119], v[118:119], v[28:29] op_sel:[0,1] op_sel_hi:[1,1]
v_pk_fma_f32 v[96:97], v[96:97], v[20:21], v[20:21] op_sel:[0,1,1] op_sel_hi:[1,1,1]
v_pk_fma_f32 v[98:99], v[98:99], v[20:21], v[20:21] op_sel:[0,1,1] op_sel_hi:[1,1,1]
v_pk_fma_f32 v[112:113], v[112:113], v[20:21], v[20:21] op_sel:[0,1,1] op_sel_hi:[1,1,1]
v_pk_fma_f32 v[114:115], v[114:115], v[20:21], v[20:21] op_sel:[0,1,1] op_sel_hi:[1,1,1]
v_cvt_pk_bf16_f32 v44, v76, v77
v_cvt_pk_bf16_f32 v45, v78, v79
v_cvt_pk_bf16_f32 v46, v92, v93
v_cvt_pk_bf16_f32 v47, v94, v95
MAA 136,192,136
buffer_store_dwordx4 v[44:47], v11, s[16:19], s62 offen offset:1024 sc1
MAA 136,196,152
v_rcp_f32 v96, v96
MAA 136,0,168
v_rcp_f32 v97, v97
MAA 136,4,184
v_rcp_f32 v98, v98
MAA 152,12,184
buffer_load_dwordx4 v18, s[28:31], s58 offen lds
MAA 152,8,168
v_rcp_f32 v99, v99
MAA 152,204,152
v_rcp_f32 v112, v112
MAA 152,200,136
v_rcp_f32 v113, v113
MAA 104,112,168
buffer_load_dwordx4 v19, s[28:31], s58 offen offset:1056 lds
MAA 104,116,184
s_add_u32 m0, s59, 92928
s_add_u32 s58, s99, 2555904
v_rcp_f32 v114, v114
MAA 120,124,184
v_rcp_f32 v115, v115
MAA 120,120,168
v_exp_f32 v100, v100
v_exp_f32 v101, v101
v_exp_f32 v102, v102
v_exp_f32 v103, v103
v_exp_f32 v116, v116
v_exp_f32 v117, v117
v_exp_f32 v118, v118
v_exp_f32 v119, v119
v_pk_mul_f32 v[128:129], v[128:129], v[96:97]
v_pk_mul_f32 v[130:131], v[130:131], v[98:99]
v_pk_mul_f32 v[144:145], v[144:145], v[112:113]
v_pk_mul_f32 v[146:147], v[146:147], v[114:115]
ds_read_b128 v[112:115], v9 offset:256
v_pk_fma_f32 v[104:105], v[48:49], v[24:25], v[104:105] op_sel_hi:[1,0,1]
v_pk_fma_f32 v[106:107], v[50:51], v[24:25], v[106:107] op_sel_hi:[1,0,1]
v_pk_fma_f32 v[120:121], v[64:65], v[24:25], v[120:121] op_sel_hi:[1,0,1]
v_pk_fma_f32 v[122:123], v[66:67], v[24:25], v[122:123] op_sel_hi:[1,0,1]
v_pk_fma_f32 v[136:137], v[80:81], v[24:25], v[136:137] op_sel_hi:[1,0,1]
v_pk_fma_f32 v[138:139], v[82:83], v[24:25], v[138:139] op_sel_hi:[1,0,1]
v_pk_fma_f32 v[152:153], v[4:5], v[24:25], v[152:153] op_sel_hi:[1,0,1]
v_pk_fma_f32 v[154:155], v[6:7], v[24:25], v[154:155] op_sel_hi:[1,0,1]
v_pk_mul_f32 v[136:137], v[136:137], v[104:105]
v_pk_mul_f32 v[104:105], v[104:105], v[30:31] op_sel_hi:[1,0]
v_pk_mul_f32 v[138:139], v[138:139], v[106:107]
v_pk_mul_f32 v[106:107], v[106:107], v[30:31] op_sel_hi:[1,0]
v_pk_mul_f32 v[152:153], v[152:153], v[120:121]
v_pk_mul_f32 v[120:121], v[120:121], v[30:31] op_sel_hi:[1,0]
v_pk_mul_f32 v[154:155], v[154:155], v[122:123]
v_pk_mul_f32 v[122:123], v[122:123], v[30:31] op_sel_hi:[1,0]
v_pk_fma_f32 v[100:101], v[100:101], v[22:23], v[22:23] op_sel:[0,1,1] op_sel_hi:[1,1,1]
v_pk_fma_f32 v[102:103], v[102:103], v[22:23], v[22:23] op_sel:[0,1,1] op_sel_hi:[1,1,1]
v_pk_fma_f32 v[116:117], v[116:117], v[22:23], v[22:23] op_sel:[0,1,1] op_sel_hi:[1,1,1]
v_pk_fma_f32 v[118:119], v[118:119], v[22:23], v[22:23] op_sel:[0,1,1] op_sel_hi:[1,1,1]
v_cvt_pk_bf16_f32 v96, v128, v129
v_cvt_pk_bf16_f32 v97, v130, v131
ds_read_b128 v[128:131], v9 offset:320
v_cvt_pk_bf16_f32 v98, v144, v145
v_cvt_pk_bf16_f32 v99, v146, v147
MAA 140,192,140
buffer_store_dwordx4 v[96:99], v10, s[16:19], s63 offen sc1
MAA 140,196,156
ds_read_b128 v[144:147], v9 offset:768
v_rcp_f32 v100, v100
MAA 140,0,172
v_rcp_f32 v101, v101
MAA 140,4,188
v_rcp_f32 v102, v102
MAA 156,12,188
buffer_load_dwordx4 v18, s[28:31], s58 offen lds
MAA 156,8,172
v_rcp_f32 v103, v103
MAA 156,204,156
v_rcp_f32 v116, v116
MAA 156,200,140
v_rcp_f32 v117, v117
MAA 108,112,172
buffer_load_dwordx4 v19, s[28:31], s58 offen offset:1056 lds
MAA 108,116,188
s_add_u32 m0, s59, 101376
s_add_u32 s58, s100, 2752512
v_rcp_f32 v118, v118
MAA 124,124,188
v_rcp_f32 v119, v119
MAA 124,120,172
v_exp_f32 v104, v104
v_exp_f32 v105, v105
v_exp_f32 v106, v106
v_exp_f32 v107, v107
v_exp_f32 v120, v120
v_exp_f32 v121, v121
v_exp_f32 v122, v122
v_exp_f32 v123, v123
v_pk_mul_f32 v[132:133], v[132:133], v[100:101]
v_pk_mul_f32 v[134:135], v[134:135], v[102:103]
v_pk_mul_f32 v[148:149], v[148:149], v[116:117]
v_pk_mul_f32 v[150:151], v[150:151], v[118:119]
v_pk_fma_f32 v[108:109], v[48:49], v[26:27], v[108:109] op_sel_hi:[1,0,1]
v_pk_fma_f32 v[110:111], v[50:51], v[26:27], v[110:111] op_sel_hi:[1,0,1]
v_pk_fma_f32 v[124:125], v[64:65], v[26:27], v[124:125] op_sel_hi:[1,0,1]
v_pk_fma_f32 v[126:127], v[66:67], v[26:27], v[126:127] op_sel_hi:[1,0,1]
v_pk_fma_f32 v[140:141], v[80:81], v[26:27], v[140:141] op_sel_hi:[1,0,1]
v_pk_fma_f32 v[142:143], v[82:83], v[26:27], v[142:143] op_sel_hi:[1,0,1]
v_pk_fma_f32 v[156:157], v[4:5], v[26:27], v[156:157] op_sel_hi:[1,0,1]
v_pk_fma_f32 v[158:159], v[6:7], v[26:27], v[158:159] op_sel_hi:[1,0,1]
v_pk_mul_f32 v[140:141], v[140:141], v[108:109]
v_pk_mul_f32 v[108:109], v[108:109], v[30:31] op_sel:[0,1] op_sel_hi:[1,1]
v_pk_mul_f32 v[142:143], v[142:143], v[110:111]
v_pk_mul_f32 v[110:111], v[110:111], v[30:31] op_sel:[0,1] op_sel_hi:[1,1]
v_pk_mul_f32 v[156:157], v[156:157], v[124:125]
s_waitcnt vmcnt(5)
s_barrier
buffer_atomic_add v71, v68, s[16:19], s72 offen offset:512
v_pk_mul_f32 v[124:125], v[124:125], v[30:31] op_sel:[0,1] op_sel_hi:[1,1]
v_pk_mul_f32 v[158:159], v[158:159], v[126:127]
v_pk_mul_f32 v[126:127], v[126:127], v[30:31] op_sel:[0,1] op_sel_hi:[1,1]
v_pk_fma_f32 v[104:105], v[104:105], v[24:25], v[24:25] op_sel:[0,1,1] op_sel_hi:[1,1,1]
v_pk_fma_f32 v[106:107], v[106:107], v[24:25], v[24:25] op_sel:[0,1,1] op_sel_hi:[1,1,1]
v_pk_fma_f32 v[120:121], v[120:121], v[24:25], v[24:25] op_sel:[0,1,1] op_sel_hi:[1,1,1]
v_pk_fma_f32 v[122:123], v[122:123], v[24:25], v[24:25] op_sel:[0,1,1] op_sel_hi:[1,1,1]
v_cvt_pk_bf16_f32 v100, v132, v133
v_cvt_pk_bf16_f32 v101, v134, v135
v_cvt_pk_bf16_f32 v102, v148, v149
v_cvt_pk_bf16_f32 v103, v150, v151
MAA 192,16,128
v_rcp_f32 v104, v104
MAA 192,20,144
buffer_store_dwordx4 v[100:103], v10, s[16:19], s63 offen offset:1024 sc1
MAA 192,48,160
v_rcp_f32 v105, v105
MAA 192,52,176
v_rcp_f32 v106, v106
MAA 208,60,176
v_rcp_f32 v107, v107
MAA 208,56,160
buffer_load_dwordx4 v18, s[28:31], s58 offen lds
MAA 208,28,144
v_rcp_f32 v120, v120
MAA 208,24,128
v_rcp_f32 v121, v121
MAA 160,32,160
v_rcp_f32 v122, v122
MAA 160,36,176
buffer_load_dwordx4 v19, s[28:31], s58 offen offset:1056 lds
MAA 176,44,176
s_add_u32 m0, s59, 109824
s_add_u32 s58, s100, 3014656
v_rcp_f32 v123, v123
MAA 176,40,160
v_exp_f32 v108, v108
v_exp_f32 v109, v109
v_exp_f32 v110, v110
v_exp_f32 v111, v111
v_exp_f32 v124, v124
v_exp_f32 v125, v125
v_exp_f32 v126, v126
v_exp_f32 v127, v127
v_pk_mul_f32 v[136:137], v[136:137], v[104:105]
v_pk_mul_f32 v[138:139], v[138:139], v[106:107]
v_pk_mul_f32 v[152:153], v[152:153], v[120:121]
v_pk_mul_f32 v[154:155], v[154:155], v[122:123]
s_waitcnt lgkmcnt(2)
v_pk_fma_f32 v[160:161], v[112:113], v[20:21], v[160:161] op_sel_hi:[1,0,1]
v_pk_fma_f32 v[162:163], v[114:115], v[20:21], v[162:163] op_sel_hi:[1,0,1]
s_waitcnt lgkmcnt(1)
v_pk_fma_f32 v[176:177], v[128:129], v[20:21], v[176:177] op_sel_hi:[1,0,1]
v_pk_fma_f32 v[178:179], v[130:131], v[20:21], v[178:179] op_sel_hi:[1,0,1]
s_waitcnt lgkmcnt(0)
v_pk_fma_f32 v[192:193], v[144:145], v[20:21], v[192:193] op_sel_hi:[1,0,1]
v_pk_fma_f32 v[194:195], v[146:147], v[20:21], v[194:195] op_sel_hi:[1,0,1]
v_pk_fma_f32 v[208:209], v[12:13], v[20:21], v[208:209] op_sel_hi:[1,0,1]
v_pk_fma_f32 v[210:211], v[14:15], v[20:21], v[210:211] op_sel_hi:[1,0,1]
v_pk_mul_f32 v[192:193], v[192:193], v[160:161]
v_pk_mul_f32 v[160:161], v[160:161], v[28:29] op_sel_hi:[1,0]
v_pk_mul_f32 v[194:195], v[194:195], v[162:163]
v_pk_mul_f32 v[162:163], v[162:163], v[28:29] op_sel_hi:[1,0]
v_pk_mul_f32 v[208:209], v[208:209], v[176:177]
v_pk_mul_f32 v[176:177], v[176:177], v[28:29] op_sel_hi:[1,0]
v_pk_mul_f32 v[210:211], v[210:211], v[178:179]
v_pk_mul_f32 v[178:179], v[178:179], v[28:29] op_sel_hi:[1,0]
v_pk_fma_f32 v[108:109], v[108:109], v[26:27], v[26:27] op_sel:[0,1,1] op_sel_hi:[1,1,1]
v_pk_fma_f32 v[110:111], v[110:111], v[26:27], v[26:27] op_sel:[0,1,1] op_sel_hi:[1,1,1]
v_pk_fma_f32 v[124:125], v[124:125], v[26:27], v[26:27] op_sel:[0,1,1] op_sel_hi:[1,1,1]
v_pk_fma_f32 v[126:127], v[126:127], v[26:27], v[26:27] op_sel:[0,1,1] op_sel_hi:[1,1,1]
v_cvt_pk_bf16_f32 v104, v136, v137
v_cvt_pk_bf16_f32 v105, v138, v139
v_cvt_pk_bf16_f32 v106, v152, v153
v_cvt_pk_bf16_f32 v107, v154, v155
MAA 196,16,132
buffer_store_dwordx4 v[104:107], v11, s[16:19], s63 offen sc1
MAA 196,20,148
v_rcp_f32 v108, v108
MAA 196,48,164
v_rcp_f32 v109, v109
MAA 196,52,180
v_rcp_f32 v110, v110
MAA 212,60,180
buffer_load_dwordx4 v18, s[28:31], s58 offen lds
MAA 212,56,164
v_rcp_f32 v111, v111
MAA 212,28,148
v_rcp_f32 v124, v124
MAA 212,24,132
v_rcp_f32 v125, v125
MAA 164,32,164
buffer_load_dwordx4 v19, s[28:31], s58 offen offset:1056 lds
MAA 164,36,180
s_add_u32 m0, s59, 118272
s_add_u32 s58, s101, 3211264
v_rcp_f32 v126, v126
MAA 180,44,180
v_rcp_f32 v127, v127
MAA 180,40,164
v_lshl_add_u32 v4, v1, 4, s74
v_add_u32 v2, 67108480, v4
v_cndmask_b32 v4, v4, v2, vcc
s_and_b32 s74, s7, 1
v_bfe_u32 v7, v1, 2, 3
v_mul_u32_u24 v7, 1056, v7
v_bfe_u32 v2, v1, 5, 1
v_lshl_add_u32 v7, v2, 8, v7
v_and_b32 v2, 3, v1
v_lshl_add_u32 v7, v2, 3, v7
s_lshl_b32 s74, s74, 7
.Lpad6:
s_cbranch_execz .Lpad9
s_xor_b32 s75, s74, 128
v_add_u32 v6, s75, v7
v_add_u32 v7, s74, v7
v_exp_f32 v160, v160
v_exp_f32 v161, v161
v_exp_f32 v162, v162
v_exp_f32 v163, v163
v_exp_f32 v176, v176
v_exp_f32 v177, v177
v_exp_f32 v178, v178
v_exp_f32 v179, v179
v_pk_mul_f32 v[140:141], v[140:141], v[108:109]
v_pk_mul_f32 v[142:143], v[142:143], v[110:111]
v_pk_mul_f32 v[156:157], v[156:157], v[124:125]
v_pk_mul_f32 v[158:159], v[158:159], v[126:127]
v_pk_fma_f32 v[164:165], v[112:113], v[22:23], v[164:165] op_sel_hi:[1,0,1]
v_pk_fma_f32 v[166:167], v[114:115], v[22:23], v[166:167] op_sel_hi:[1,0,1]
v_pk_fma_f32 v[180:181], v[128:129], v[22:23], v[180:181] op_sel_hi:[1,0,1]
v_pk_fma_f32 v[182:183], v[130:131], v[22:23], v[182:183] op_sel_hi:[1,0,1]
v_pk_fma_f32 v[196:197], v[144:145], v[22:23], v[196:197] op_sel_hi:[1,0,1]
v_pk_fma_f32 v[198:199], v[146:147], v[22:23], v[198:199] op_sel_hi:[1,0,1]
v_pk_fma_f32 v[212:213], v[12:13], v[22:23], v[212:213] op_sel_hi:[1,0,1]
v_pk_fma_f32 v[214:215], v[14:15], v[22:23], v[214:215] op_sel_hi:[1,0,1]
v_pk_mul_f32 v[196:197], v[196:197], v[164:165]
v_pk_mul_f32 v[164:165], v[164:165], v[28:29] op_sel:[0,1] op_sel_hi:[1,1]
v_pk_mul_f32 v[198:199], v[198:199], v[166:167]
v_pk_mul_f32 v[166:167], v[166:167], v[28:29] op_sel:[0,1] op_sel_hi:[1,1]
v_pk_mul_f32 v[212:213], v[212:213], v[180:181]
v_pk_mul_f32 v[180:181], v[180:181], v[28:29] op_sel:[0,1] op_sel_hi:[1,1]
v_pk_mul_f32 v[214:215], v[214:215], v[182:183]
v_pk_mul_f32 v[182:183], v[182:183], v[28:29] op_sel:[0,1] op_sel_hi:[1,1]
v_pk_fma_f32 v[160:161], v[160:161], v[20:21], v[20:21] op_sel:[0,1,1] op_sel_hi:[1,1,1]
v_pk_fma_f32 v[162:163], v[162:163], v[20:21], v[20:21] op_sel:[0,1,1] op_sel_hi:[1,1,1]
v_pk_fma_f32 v[176:177], v[176:177], v[20:21], v[20:21] op_sel:[0,1,1] op_sel_hi:[1,1,1]
v_pk_fma_f32 v[178:179], v[178:179], v[20:21], v[20:21] op_sel:[0,1,1] op_sel_hi:[1,1,1]
v_cvt_pk_bf16_f32 v108, v140, v141
v_cvt_pk_bf16_f32 v109, v142, v143
v_cvt_pk_bf16_f32 v110, v156, v157
v_cvt_pk_bf16_f32 v111, v158, v159
MAA 200,16,136
buffer_store_dwordx4 v[108:111], v11, s[16:19], s63 offen offset:1024 sc1
MAA 200,20,152
v_rcp_f32 v160, v160
MAA 200,48,168
v_rcp_f32 v161, v161
MAA 200,52,184
v_rcp_f32 v162, v162
MAA 216,60,184
buffer_load_dwordx4 v18, s[28:31], s58 offen lds
MAA 216,56,168
v_rcp_f32 v163, v163
MAA 216,28,152
v_rcp_f32 v176, v176
MAA 216,24,136
v_rcp_f32 v177, v177
MAA 168,32,168
buffer_load_dwordx4 v19, s[28:31], s58 offen offset:1056 lds
MAA 168,36,184
s_add_u32 m0, s59, 126720
s_add_u32 s58, s101, 3473408
v_rcp_f32 v178, v178
MAA 184,44,184
v_rcp_f32 v179, v179
MAA 184,40,168
v_exp_f32 v164, v164
v_exp_f32 v165, v165
v_exp_f32 v166, v166
v_exp_f32 v167, v167
v_exp_f32 v180, v180
v_exp_f32 v181, v181
v_exp_f32 v182, v182
v_exp_f32 v183, v183
v_pk_mul_f32 v[192:193], v[192:193], v[160:161]
v_pk_mul_f32 v[194:195], v[194:195], v[162:163]
v_pk_mul_f32 v[208:209], v[208:209], v[176:177]
v_pk_mul_f32 v[210:211], v[210:211], v[178:179]
ds_read_b128 v[176:179], v8
v_pk_fma_f32 v[168:169], v[112:113], v[24:25], v[168:169] op_sel_hi:[1,0,1]
v_pk_fma_f32 v[170:171], v[114:115], v[24:25], v[170:171] op_sel_hi:[1,0,1]
v_pk_fma_f32 v[184:185], v[128:129], v[24:25], v[184:185] op_sel_hi:[1,0,1]
v_pk_fma_f32 v[186:187], v[130:131], v[24:25], v[186:187] op_sel_hi:[1,0,1]
v_pk_fma_f32 v[200:201], v[144:145], v[24:25], v[200:201] op_sel_hi:[1,0,1]
v_pk_fma_f32 v[202:203], v[146:147], v[24:25], v[202:203] op_sel_hi:[1,0,1]
v_pk_fma_f32 v[216:217], v[12:13], v[24:25], v[216:217] op_sel_hi:[1,0,1]
v_pk_fma_f32 v[218:219], v[14:15], v[24:25], v[218:219] op_sel_hi:[1,0,1]
v_pk_mul_f32 v[200:201], v[200:201], v[168:169]
v_pk_mul_f32 v[168:169], v[168:169], v[30:31] op_sel_hi:[1,0]
v_pk_mul_f32 v[202:203], v[202:203], v[170:171]
v_pk_mul_f32 v[170:171], v[170:171], v[30:31] op_sel_hi:[1,0]
v_pk_mul_f32 v[216:217], v[216:217], v[184:185]
v_pk_mul_f32 v[184:185], v[184:185], v[30:31] op_sel_hi:[1,0]
v_pk_mul_f32 v[218:219], v[218:219], v[186:187]
v_pk_mul_f32 v[186:187], v[186:187], v[30:31] op_sel_hi:[1,0]
v_pk_fma_f32 v[164:165], v[164:165], v[22:23], v[22:23] op_sel:[0,1,1] op_sel_hi:[1,1,1]
v_pk_fma_f32 v[166:167], v[166:167], v[22:23], v[22:23] op_sel:[0,1,1] op_sel_hi:[1,1,1]
v_pk_fma_f32 v[180:181], v[180:181], v[22:23], v[22:23] op_sel:[0,1,1] op_sel_hi:[1,1,1]
v_pk_fma_f32 v[182:183], v[182:183], v[22:23], v[22:23] op_sel:[0,1,1] op_sel_hi:[1,1,1]
v_cvt_pk_bf16_f32 v160, v192, v193
v_cvt_pk_bf16_f32 v161, v194, v195
ds_read_b128 v[192:195], v8 offset:64
v_cvt_pk_bf16_f32 v162, v208, v209
v_cvt_pk_bf16_f32 v163, v210, v211
MAA 204,16,140
buffer_store_dwordx4 v[160:163], v10, s[16:19], s64 offen sc1
MAA 204,20,156
ds_read_b128 v[208:211], v8 offset:512
v_rcp_f32 v164, v164
MAA 204,48,172
v_rcp_f32 v165, v165
MAA 204,52,188
v_rcp_f32 v166, v166
MAA 220,60,188
buffer_atomic_add v84, v69, s[16:19], s73 offen offset:512 sc0
MAA 220,56,172
v_rcp_f32 v167, v167
MAA 220,28,156
v_rcp_f32 v180, v180
MAA 220,24,140
v_rcp_f32 v181, v181
MAA 172,32,172
buffer_load_dwordx4 v18, s[28:31], s58 offen lds
MAA 172,36,188
v_rcp_f32 v182, v182
MAA 188,44,188
v_rcp_f32 v183, v183
MAA 188,40,172
v_exp_f32 v168, v168
v_exp_f32 v169, v169
v_exp_f32 v170, v170
v_exp_f32 v171, v171
v_exp_f32 v184, v184
v_exp_f32 v185, v185
v_exp_f32 v186, v186
v_exp_f32 v187, v187
v_pk_mul_f32 v[196:197], v[196:197], v[164:165]
v_pk_mul_f32 v[198:199], v[198:199], v[166:167]
v_pk_mul_f32 v[212:213], v[212:213], v[180:181]
v_pk_mul_f32 v[214:215], v[214:215], v[182:183]
v_pk_fma_f32 v[172:173], v[112:113], v[26:27], v[172:173] op_sel_hi:[1,0,1]
v_pk_fma_f32 v[174:175], v[114:115], v[26:27], v[174:175] op_sel_hi:[1,0,1]
v_pk_fma_f32 v[188:189], v[128:129], v[26:27], v[188:189] op_sel_hi:[1,0,1]
v_pk_fma_f32 v[190:191], v[130:131], v[26:27], v[190:191] op_sel_hi:[1,0,1]
v_pk_fma_f32 v[204:205], v[144:145], v[26:27], v[204:205] op_sel_hi:[1,0,1]
v_pk_fma_f32 v[206:207], v[146:147], v[26:27], v[206:207] op_sel_hi:[1,0,1]
v_pk_fma_f32 v[220:221], v[12:13], v[26:27], v[220:221] op_sel_hi:[1,0,1]
v_pk_fma_f32 v[222:223], v[14:15], v[26:27], v[222:223] op_sel_hi:[1,0,1]
v_pk_mul_f32 v[204:205], v[204:205], v[172:173]
v_pk_mul_f32 v[172:173], v[172:173], v[30:31] op_sel:[0,1] op_sel_hi:[1,1]
v_pk_mul_f32 v[206:207], v[206:207], v[174:175]
v_pk_mul_f32 v[174:175], v[174:175], v[30:31] op_sel:[0,1] op_sel_hi:[1,1]
v_pk_mul_f32 v[220:221], v[220:221], v[188:189]
v_pk_mul_f32 v[188:189], v[188:189], v[30:31] op_sel:[0,1] op_sel_hi:[1,1]
v_pk_mul_f32 v[222:223], v[222:223], v[190:191]
v_pk_mul_f32 v[190:191], v[190:191], v[30:31] op_sel:[0,1] op_sel_hi:[1,1]
v_pk_fma_f32 v[168:169], v[168:169], v[24:25], v[24:25] op_sel:[0,1,1] op_sel_hi:[1,1,1]
v_pk_fma_f32 v[170:171], v[170:171], v[24:25], v[24:25] op_sel:[0,1,1] op_sel_hi:[1,1,1]
v_pk_fma_f32 v[184:185], v[184:185], v[24:25], v[24:25] op_sel:[0,1,1] op_sel_hi:[1,1,1]
v_pk_fma_f32 v[186:187], v[186:187], v[24:25], v[24:25] op_sel:[0,1,1] op_sel_hi:[1,1,1]
v_cvt_pk_bf16_f32 v164, v196, v197
v_cvt_pk_bf16_f32 v165, v198, v199
v_cvt_pk_bf16_f32 v166, v212, v213
v_cvt_pk_bf16_f32 v167, v214, v215
MAA 240,64,128
buffer_store_dwordx4 v[164:167], v10, s[16:19], s64 offen offset:1024 sc1
MAA 240,68,144
v_rcp_f32 v168, v168
MAA 240,96,160
v_rcp_f32 v169, v169
MAA 240,100,176
v_rcp_f32 v170, v170
MAA 248,108,176
buffer_atomic_add v85, v69, s[16:19], s73 offen offset:512 sc0
MAA 248,104,160
v_rcp_f32 v171, v171
MAA 248,76,144
v_rcp_f32 v184, v184
MAA 248,72,128
v_rcp_f32 v185, v185
MAA 224,80,160
buffer_load_dwordx4 v19, s[28:31], s58 offen offset:1056 lds
MAA 224,84,176
v_rcp_f32 v186, v186
MAA 232,92,176
v_rcp_f32 v187, v187
MAA 232,88,160
v_exp_f32 v172, v172
v_exp_f32 v173, v173
v_exp_f32 v174, v174
v_exp_f32 v175, v175
v_exp_f32 v188, v188
v_exp_f32 v189, v189
v_exp_f32 v190, v190
v_exp_f32 v191, v191
v_pk_mul_f32 v[200:201], v[200:201], v[168:169]
v_pk_mul_f32 v[202:203], v[202:203], v[170:171]
v_pk_mul_f32 v[216:217], v[216:217], v[184:185]
v_pk_mul_f32 v[218:219], v[218:219], v[186:187]
s_waitcnt lgkmcnt(2)
v_pk_fma_f32 v[224:225], v[176:177], v[20:21], v[224:225] op_sel_hi:[1,0,1]
v_pk_fma_f32 v[226:227], v[178:179], v[20:21], v[226:227] op_sel_hi:[1,0,1]
s_waitcnt lgkmcnt(1)
v_pk_fma_f32 v[232:233], v[192:193], v[20:21], v[232:233] op_sel_hi:[1,0,1]
v_pk_fma_f32 v[234:235], v[194:195], v[20:21], v[234:235] op_sel_hi:[1,0,1]
s_waitcnt lgkmcnt(0)
v_pk_fma_f32 v[240:241], v[208:209], v[20:21], v[240:241] op_sel_hi:[1,0,1]
v_pk_fma_f32 v[242:243], v[210:211], v[20:21], v[242:243] op_sel_hi:[1,0,1]
v_pk_fma_f32 v[248:249], v[52:53], v[20:21], v[248:249] op_sel_hi:[1,0,1]
v_pk_fma_f32 v[250:251], v[54:55], v[20:21], v[250:251] op_sel_hi:[1,0,1]
v_pk_mul_f32 v[240:241], v[240:241], v[224:225]
v_pk_mul_f32 v[224:225], v[224:225], v[28:29] op_sel_hi:[1,0]
v_pk_mul_f32 v[242:243], v[242:243], v[226:227]
v_pk_mul_f32 v[226:227], v[226:227], v[28:29] op_sel_hi:[1,0]
v_pk_mul_f32 v[248:249], v[248:249], v[232:233]
v_pk_mul_f32 v[232:233], v[232:233], v[28:29] op_sel_hi:[1,0]
v_pk_mul_f32 v[250:251], v[250:251], v[234:235]
v_pk_mul_f32 v[234:235], v[234:235], v[28:29] op_sel_hi:[1,0]
v_pk_fma_f32 v[172:173], v[172:173], v[26:27], v[26:27] op_sel:[0,1,1] op_sel_hi:[1,1,1]
v_pk_fma_f32 v[174:175], v[174:175], v[26:27], v[26:27] op_sel:[0,1,1] op_sel_hi:[1,1,1]
v_pk_fma_f32 v[188:189], v[188:189], v[26:27], v[26:27] op_sel:[0,1,1] op_sel_hi:[1,1,1]
v_pk_fma_f32 v[190:191], v[190:191], v[26:27], v[26:27] op_sel:[0,1,1] op_sel_hi:[1,1,1]
v_cvt_pk_bf16_f32 v168, v200, v201
v_cvt_pk_bf16_f32 v169, v202, v203
v_cvt_pk_bf16_f32 v170, v216, v217
v_cvt_pk_bf16_f32 v171, v218, v219
buffer_store_dwordx4 v[168:171], v11, s[16:19], s64 offen sc1
buffer_atomic_add v86, v69, s[16:19], s73 offen offset:512 sc0
s_waitcnt vmcnt(6)
v_cmp_gt_u32 vcc, v70, v84
s_nop 0
s_cbranch_vccz .Lok49
s_waitcnt vmcnt(3)
v_cmp_gt_u32 vcc, v70, v85
s_nop 0
s_cbranch_vccz .Lok49
s_waitcnt vmcnt(0)
v_cmp_gt_u32 vcc, v70, v86
s_nop 0
s_cbranch_vccz .Lok49
s_mov_b32 s15, 0
.Lok49l:
v_mov_b32 v84, 0
buffer_atomic_add v84, v69, s[16:19], s73 offen offset:512 sc0
s_add_u32 s15, s15, 1
s_cmp_gt_u32 s15, 100000
s_waitcnt vmcnt(0)
s_cbranch_scc1 .Lok49
v_cmp_gt_u32 vcc, v70, v84
s_nop 0
s_cbranch_vccnz .Lok49l
.Lok49:
s_waitcnt vmcnt(2)
s_barrier
MAA 244,64,132
ds_read_b64_tr_b16 a[0:1], v7
s_add_u32 s52, s76, 0
MAA 244,68,148
buffer_load_dwordx4 v[96:99], v4, s[16:19], s52 offen sc1
MAA 244,96,164
TR 2,7,512
v_rcp_f32 v172, v172
MAA 244,100,180
TR 4,7,32
v_rcp_f32 v173, v173
MAA 252,108,180
TR 6,7,544
v_rcp_f32 v174, v174
MAA 252,104,164
buffer_load_dwordx4 v[100:103], v4, s[16:19], s52 offen offset:1024 sc1
MAA 252,76,148
TR 8,7,64
s_add_u32 s52, s76, 65536
MAA 252,72,132
TR 10,7,576
v_rcp_f32 v175, v175
MAA 228,80,164
TR 12,7,96
v_rcp_f32 v188, v188
MAA 228,84,180
buffer_load_dwordx4 v[104:107], v4, s[16:19], s52 offen sc1
MAA 236,92,180
TR 14,7,608
v_rcp_f32 v189, v189
MAA 236,88,164
TR 16,7,8448
v_rcp_f32 v190, v190
v_rcp_f32 v191, v191
v_exp_f32 v224, v224
v_exp_f32 v225, v225
v_exp_f32 v226, v226
v_exp_f32 v227, v227
v_exp_f32 v232, v232
v_exp_f32 v233, v233
v_exp_f32 v234, v234
v_exp_f32 v235, v235
v_pk_mul_f32 v[204:205], v[204:205], v[172:173]
buffer_load_dwordx4 v[108:111], v4, s[16:19], s52 offen offset:1024 sc1
s_add_u32 s52, s77, 114688
v_pk_mul_f32 v[206:207], v[206:207], v[174:175]
v_pk_mul_f32 v[220:221], v[220:221], v[188:189]
v_pk_mul_f32 v[222:223], v[222:223], v[190:191]
v_pk_fma_f32 v[228:229], v[176:177], v[22:23], v[228:229] op_sel_hi:[1,0,1]
v_pk_fma_f32 v[230:231], v[178:179], v[22:23], v[230:231] op_sel_hi:[1,0,1]
v_pk_fma_f32 v[236:237], v[192:193], v[22:23], v[236:237] op_sel_hi:[1,0,1]
v_pk_fma_f32 v[238:239], v[194:195], v[22:23], v[238:239] op_sel_hi:[1,0,1]
v_pk_fma_f32 v[244:245], v[208:209], v[22:23], v[244:245] op_sel_hi:[1,0,1]
v_pk_fma_f32 v[246:247], v[210:211], v[22:23], v[246:247] op_sel_hi:[1,0,1]
v_pk_fma_f32 v[252:253], v[52:53], v[22:23], v[252:253] op_sel_hi:[1,0,1]
v_pk_fma_f32 v[254:255], v[54:55], v[22:23], v[254:255] op_sel_hi:[1,0,1]
v_pk_mul_f32 v[244:245], v[244:245], v[228:229]
buffer_load_dwordx4 v[112:115], v4, s[16:19], s52 offen sc1
v_pk_mul_f32 v[228:229], v[228:229], v[28:29] op_sel:[0,1] op_sel_hi:[1,1]
v_pk_mul_f32 v[246:247], v[246:247], v[230:231]
v_pk_mul_f32 v[230:231], v[230:231], v[28:29] op_sel:[0,1] op_sel_hi:[1,1]
v_pk_mul_f32 v[252:253], v[252:253], v[236:237]
v_pk_mul_f32 v[236:237], v[236:237], v[28:29] op_sel:[0,1] op_sel_hi:[1,1]
v_pk_mul_f32 v[254:255], v[254:255], v[238:239]
v_pk_mul_f32 v[238:239], v[238:239], v[28:29] op_sel:[0,1] op_sel_hi:[1,1]
v_pk_fma_f32 v[224:225], v[224:225], v[20:21], v[20:21] op_sel:[0,1,1] op_sel_hi:[1,1,1]
v_pk_fma_f32 v[226:227], v[226:227], v[20:21], v[20:21] op_sel:[0,1,1] op_sel_hi:[1,1,1]
v_pk_fma_f32 v[232:233], v[232:233], v[20:21], v[20:21] op_sel:[0,1,1] op_sel_hi:[1,1,1]
v_pk_fma_f32 v[234:235], v[234:235], v[20:21], v[20:21] op_sel:[0,1,1] op_sel_hi:[1,1,1]
v_cvt_pk_bf16_f32 v172, v204, v205
v_cvt_pk_bf16_f32 v173, v206, v207
buffer_load_dwordx4 v[116:119], v4, s[16:19], s52 offen offset:1024 sc1
s_add_u32 s52, s77, 180224
v_cvt_pk_bf16_f32 v174, v220, v221
v_cvt_pk_bf16_f32 v175, v222, v223
TR 18,7,8960
TR 20,7,8480
TR 22,7,8992
TR 24,7,8512
TR 26,7,9024
buffer_store_dwordx4 v[172:175], v11, s[16:19], s64 offen offset:1024 sc1
TR 28,7,8544
TR 30,7,9056
v_rcp_f32 v224, v224
v_rcp_f32 v225, v225
v_rcp_f32 v226, v226
v_rcp_f32 v227, v227
v_rcp_f32 v232, v232
v_rcp_f32 v233, v233
v_rcp_f32 v234, v234
v_rcp_f32 v235, v235
v_exp_f32 v228, v228
v_exp_f32 v229, v229
v_exp_f32 v230, v230
v_exp_f32 v231, v231
v_exp_f32 v236, v236
v_exp_f32 v237, v237
v_exp_f32 v238, v238
v_exp_f32 v239, v239
v_pk_mul_f32 v[240:241], v[240:241], v[224:225]
buffer_load_dwordx4 v[120:123], v4, s[16:19], s52 offen sc1
v_pk_mul_f32 v[242:243], v[242:243], v[226:227]
v_pk_mul_f32 v[248:249], v[248:249], v[232:233]
v_pk_mul_f32 v[250:251], v[250:251], v[234:235]
v_pk_fma_f32 v[228:229], v[228:229], v[22:23], v[22:23] op_sel:[0,1,1] op_sel_hi:[1,1,1]
v_pk_fma_f32 v[230:231], v[230:231], v[22:23], v[22:23] op_sel:[0,1,1] op_sel_hi:[1,1,1]
v_pk_fma_f32 v[236:237], v[236:237], v[22:23], v[22:23] op_sel:[0,1,1] op_sel_hi:[1,1,1]
v_pk_fma_f32 v[238:239], v[238:239], v[22:23], v[22:23] op_sel:[0,1,1] op_sel_hi:[1,1,1]
v_cvt_pk_bf16_f32 v224, v240, v241
v_cvt_pk_bf16_f32 v225, v242, v243
v_cvt_pk_bf16_f32 v226, v248, v249
v_cvt_pk_bf16_f32 v227, v250, v251
v_rcp_f32 v228, v228
v_rcp_f32 v229, v229
v_rcp_f32 v230, v230
v_rcp_f32 v231, v231
v_rcp_f32 v236, v236
v_rcp_f32 v237, v237
v_rcp_f32 v238, v238
v_rcp_f32 v239, v239
v_pk_mul_f32 v[244:245], v[244:245], v[228:229]
buffer_store_dwordx4 v[224:227], v10, s[16:19], s65 offen sc1
v_pk_mul_f32 v[246:247], v[246:247], v[230:231]
v_pk_mul_f32 v[252:253], v[252:253], v[236:237]
v_pk_mul_f32 v[254:255], v[254:255], v[238:239]
v_cvt_pk_bf16_f32 v228, v244, v245
v_cvt_pk_bf16_f32 v229, v246, v247
v_cvt_pk_bf16_f32 v230, v252, v253
v_cvt_pk_bf16_f32 v231, v254, v255
buffer_store_dwordx4 v[228:231], v10, s[16:19], s65 offen offset:1024 sc1
buffer_load_dwordx4 v[124:127], v4, s[16:19], s52 offen offset:1024 sc1
v_mov_b32 v21, v68
v_mov_b32 v22, v69
v_mov_b32 v23, v70
v_mov_b32 v24, v71
v_mov_b32 v25, 0
s_waitcnt vmcnt(7) lgkmcnt(0)
s_barrier
v_mfma_f32_16x16x32_bf16 v[32:35], a[0:3], v[96:99], 0
ds_read_b64_tr_b16 a[32:33], v6
s_add_u32 s52, s78, 229376
MAV 32,16,104
buffer_load_dwordx4 v[128:131], v4, s[16:19], s52 offen sc1
v_mfma_f32_16x16x32_bf16 v[48:51], a[0:3], v[100:103], 0
TR 34,6,512
MAV 48,16,108
TR 36,6,32
TR 38,6,544
v_mfma_f32_16x16x32_bf16 v[52:55], a[4:7], v[100:103], 0
TR 48,6,8448
MAV 52,20,108
buffer_load_dwordx4 v[132:135], v4, s[16:19], s52 offen offset:1024 sc1
v_mfma_f32_16x16x32_bf16 v[36:39], a[4:7], v[96:99], 0
TR 50,6,8960
MAV 36,20,104
TR 52,6,8480
TR 54,6,8992
v_mfma_f32_16x16x32_bf16 v[40:43], a[8:11], v[96:99], 0
TR 40,6,64
s_add_u32 s52, s78, 294912
MAV 40,24,104
buffer_load_dwordx4 v[136:139], v4, s[16:19], s52 offen sc1
v_mfma_f32_16x16x32_bf16 v[56:59], a[8:11], v[100:103], 0
TR 42,6,576
MAV 56,24,108
TR 44,6,96
TR 46,6,608
v_mfma_f32_16x16x32_bf16 v[60:63], a[12:15], v[100:103], 0
TR 56,6,8512
MAV 60,28,108
buffer_load_dwordx4 v[140:143], v4, s[16:19], s52 offen offset:1024 sc1
v_mfma_f32_16x16x32_bf16 v[44:47], a[12:15], v[96:99], 0
TR 58,6,9024
MAV 44,28,104
TR 60,6,8544
TR 62,6,9056
s_waitcnt lgkmcnt(8)
v_mfma_f32_16x16x32_bf16 v[64:67], a[32:35], v[96:99], 0
TR 0,7,16896
s_add_u32 s52, s79, 344064
MAV 64,48,104
buffer_load_dwordx4 v[144:147], v4, s[16:19], s52 offen sc1
v_mfma_f32_16x16x32_bf16 v[80:83], a[32:35], v[100:103], 0
TR 2,7,17408
MAV 80,48,108
TR 4,7,16928
TR 6,7,17440
v_mfma_f32_16x16x32_bf16 v[84:87], a[36:39], v[100:103], 0
TR 16,7,25344
MAV 84,52,108
buffer_load_dwordx4 v[148:151], v4, s[16:19], s52 offen offset:1024 sc1
v_mfma_f32_16x16x32_bf16 v[68:71], a[36:39], v[96:99], 0
TR 18,7,25856
MAV 68,52,104
TR 20,7,25376
TR 22,7,25888
s_waitcnt lgkmcnt(8)
v_mfma_f32_16x16x32_bf16 v[72:75], a[40:43], v[96:99], 0
TR 8,7,16960
s_add_u32 s52, s79, 409600
MAV 72,56,104
buffer_load_dwordx4 v[152:155], v4, s[16:19], s52 offen sc1
v_mfma_f32_16x16x32_bf16 v[88:91], a[40:43], v[100:103], 0
TR 10,7,17472
MAV 88,56,108
TR 12,7,16992
TR 14,7,17504
v_mfma_f32_16x16x32_bf16 v[92:95], a[44:47], v[100:103], 0
TR 24,7,25408
MAV 92,60,108
buffer_load_dwordx4 v[156:159], v4, s[16:19], s52 offen offset:1024 sc1
v_mfma_f32_16x16x32_bf16 v[76:79], a[44:47], v[96:99], 0
TR 26,7,25920
MAV 76,60,104
TR 28,7,25440
TR 30,7,25952
s_waitcnt vmcnt(8) lgkmcnt(8)
s_barrier
MAV 32,0,112
TR 32,6,16896
MAV 32,16,120
buffer_atomic_add v24, v21, s[16:19], s72 offen
MAV 48,16,124
TR 34,6,17408
MAV 48,0,116
TR 36,6,16928
TR 38,6,17440
TR 48,6,25344
MAV 52,4,116
TR 50,6,25856
s_add_u32 m0, s55, 0
MAV 52,20,124
buffer_load_dwordx4 v18, s[28:31], s54 offen lds
MAV 36,20,120
TR 52,6,25376
MAV 36,4,112
TR 54,6,25888
TR 40,6,16960
s_waitcnt lgkmcnt(9)
MAV 40,8,112
TR 42,6,17472
s_add_u32 s52, s76, 458752
MAV 40,24,120
buffer_load_dwordx4 v[96:99], v4, s[16:19], s52 offen sc1
MAV 56,24,124
TR 44,6,16992
MAV 56,8,116
buffer_load_dwordx4 v19, s[28:31], s54 offen offset:1056 lds
MAV 60,12,116
TR 46,6,17504
s_add_u32 s54, s98, 327680
MAV 60,28,124
buffer_load_dwordx4 v[100:103], v4, s[16:19], s52 offen offset:1024 sc1
MAV 44,28,120
TR 56,6,25408
MAV 44,12,112
TR 58,6,25920
TR 60,6,25440
TR 62,6,25952
s_waitcnt lgkmcnt(8)
MAV 64,32,112
TR 0,7,33792
s_add_u32 m0, s55, 8448
MAV 64,48,120
buffer_load_dwordx4 v18, s[28:31], s54 offen lds
MAV 80,48,124
TR 2,7,34304
MAV 80,32,116
TR 4,7,33824
TR 6,7,34336
MAV 84,36,116
TR 16,7,42240
s_add_u32 s52, s76, 524288
MAV 84,52,124
buffer_load_dwordx4 v[104:107], v4, s[16:19], s52 offen sc1
MAV 68,52,120
TR 18,7,42752
MAV 68,36,112
TR 20,7,42272
TR 22,7,42784
s_waitcnt lgkmcnt(8)
MAV 72,40,112
TR 8,7,33856
MAV 72,56,120
buffer_load_dwordx4 v19, s[28:31], s54 offen offset:1056 lds
MAV 88,56,124
TR 10,7,34368
s_add_u32 s54, s99, 524288
MAV 88,40,116
TR 12,7,33888
TR 14,7,34400
MAV 92,44,116
TR 24,7,42304
MAV 92,60,124
buffer_load_dwordx4 v[108:111], v4, s[16:19], s52 offen offset:1024 sc1
MAV 76,60,120
TR 26,7,42816
MAV 76,44,112
TR 28,7,42336
TR 30,7,42848
s_waitcnt vmcnt(13) lgkmcnt(8)
s_barrier
MAV 32,0,128
TR 32,6,33792
s_add_u32 m0, s55, 16896
MAV 32,16,136
buffer_load_dwordx4 v18, s[28:31], s54 offen lds
MAV 48,16,140
TR 34,6,34304
MAV 48,0,132
TR 36,6,33824
TR 38,6,34336
MAV 52,4,132
TR 48,6,42240
s_add_u32 s52, s77, 573440
MAV 52,20,140
buffer_load_dwordx4 v[112:115], v4, s[16:19], s52 offen sc1
MAV 36,20,136
TR 50,6,42752
MAV 36,4,128
TR 52,6,42272
TR 54,6,42784
s_waitcnt lgkmcnt(8)
MAV 40,8,128
TR 40,6,33856
MAV 40,24,136
buffer_load_dwordx4 v19, s[28:31], s54 offen offset:1056 lds
MAV 56,24,140
TR 42,6,34368
s_add_u32 s54, s99, 786432
MAV 56,8,132
TR 44,6,33888
TR 46,6,34400
.Lpad7:
s_cbranch_execz .Lpad10
MAV 60,12,132
TR 56,6,42304
MAV 60,28,140
buffer_load_dwordx4 v[116:119], v4, s[16:19], s52 offen offset:1024 sc1
MAV 44,28,136
TR 58,6,42816
MAV 44,12,128
TR 60,6,42336
TR 62,6,42848
s_waitcnt lgkmcnt(8)
MAV 64,32,128
TR 0,7,50688
s_add_u32 m0, s55, 25344
MAV 64,48,136
buffer_load_dwordx4 v18, s[28:31], s54 offen lds
MAV 80,48,140
TR 2,7,51200
MAV 80,32,132
TR 4,7,50720
TR 6,7,51232
TR 16,7,59136
MAV 84,36,132
TR 18,7,59648
s_add_u32 s52, s77, 638976
MAV 84,52,140
buffer_load_dwordx4 v[120:123], v4, s[16:19], s52 offen sc1
MAV 68,52,136
TR 20,7,59168
MAV 68,36,128
TR 22,7,59680
TR 8,7,50752
s_waitcnt lgkmcnt(9)
MAV 72,40,128
TR 10,7,51264
MAV 72,56,136
buffer_load_dwordx4 v19, s[28:31], s54 offen offset:1056 lds
MAV 88,56,140
TR 12,7,50784
s_add_u32 s54, s100, 983040
MAV 88,40,132
buffer_load_dwordx4 v[124:127], v4, s[16:19], s52 offen offset:1024 sc1
MAV 92,44,132
TR 14,7,51296
MAV 92,60,140
buffer_atomic_add v25, v22, s[16:19], s73 offen sc0
MAV 76,60,136
TR 24,7,59200
MAV 76,44,128
TR 26,7,59712
TR 28,7,59232
TR 30,7,59744
s_waitcnt vmcnt(18) lgkmcnt(8)
s_barrier
MAV 32,0,144
TR 32,6,50688
s_add_u32 m0, s55, 33792
MAV 32,16,152
buffer_load_dwordx4 v18, s[28:31], s54 offen lds
MAV 48,16,156
TR 34,6,51200
MAV 48,0,148
TR 36,6,50720
TR 38,6,51232
MAV 52,4,148
TR 48,6,59136
s_add_u32 s52, s78, 688128
MAV 52,20,156
buffer_load_dwordx4 v[128:131], v4, s[16:19], s52 offen sc1
MAV 36,20,152
TR 50,6,59648
MAV 36,4,144
TR 52,6,59168
TR 54,6,59680
s_waitcnt lgkmcnt(8)
MAV 40,8,144
TR 40,6,50752
MAV 40,24,152
buffer_load_dwordx4 v19, s[28:31], s54 offen offset:1056 lds
MAV 56,24,156
TR 42,6,51264
s_add_u32 s54, s100, 1245184
MAV 56,8,148
TR 44,6,50784
TR 46,6,51296
MAV 60,12,148
TR 56,6,59200
MAV 60,28,156
buffer_load_dwordx4 v[132:135], v4, s[16:19], s52 offen offset:1024 sc1
MAV 44,28,152
TR 58,6,59712
MAV 44,12,144
TR 60,6,59232
TR 62,6,59744
v_add_u32 v7, s57, v7
v_add_u32 v6, s57, v6
s_sub_u32 s57, 0, s57
s_waitcnt lgkmcnt(8)
MAV 64,32,144
ds_read_b64_tr_b16 a[0:1], v7
s_add_u32 m0, s55, 42240
MAV 64,48,152
buffer_load_dwordx4 v18, s[28:31], s54 offen lds
MAV 80,48,156
TR 2,7,512
MAV 80,32,148
TR 4,7,32
TR 6,7,544
MAV 84,36,148
TR 16,7,8448
s_add_u32 s52, s78, 753664
MAV 84,52,156
buffer_load_dwordx4 v[136:139], v4, s[16:19], s52 offen sc1
MAV 68,52,152
TR 18,7,8960
MAV 68,36,144
TR 20,7,8480
TR 22,7,8992
s_waitcnt lgkmcnt(8)
MAV 72,40,144
TR 8,7,64
MAV 72,56,152
buffer_load_dwordx4 v19, s[28:31], s54 offen offset:1056 lds
MAV 88,56,156
TR 10,7,576
s_add_u32 s54, s101, 1441792
MAV 88,40,148
TR 12,7,96
TR 14,7,608
MAV 92,44,148
TR 24,7,8512
MAV 92,60,156
buffer_load_dwordx4 v[140:143], v4, s[16:19], s52 offen offset:1024 sc1
MAV 76,60,152
TR 26,7,9024
MAV 76,44,144
TR 28,7,8544
TR 30,7,9056
s_waitcnt vmcnt(17) lgkmcnt(8)
s_barrier
MAV 32,0,96
ds_read_b64_tr_b16 a[32:33], v6
s_add_u32 m0, s55, 50688
MAV 32,16,104
buffer_load_dwordx4 v18, s[28:31], s54 offen lds
MAV 48,16,108
TR 34,6,512
MAV 48,0,100
TR 36,6,32
TR 38,6,544
MAV 52,4,100
TR 48,6,8448
s_add_u32 s52, s79, 802816
MAV 52,20,108
buffer_load_dwordx4 v[144:147], v4, s[16:19], s52 offen sc1
MAV 36,20,104
TR 50,6,8960
MAV 36,4,96
TR 52,6,8480
TR 54,6,8992
s_waitcnt lgkmcnt(8)
MAV 40,8,96
TR 40,6,64
MAV 40,24,104
buffer_load_dwordx4 v19, s[28:31], s54 offen offset:1056 lds
MAV 56,24,108
TR 42,6,576
s_add_u32 s54, s101, 1703936
MAV 56,8,100
TR 44,6,96
TR 46,6,608
MAV 60,12,100
TR 56,6,8512
MAV 60,28,108
buffer_load_dwordx4 v[148:151], v4, s[16:19], s52 offen offset:1024 sc1
MAV 44,28,104
TR 58,6,9024
MAV 44,12,96
TR 60,6,8544
TR 62,6,9056
s_waitcnt lgkmcnt(8)
MAV 64,32,96
TR 0,7,16896
s_add_u32 m0, s55, 59136
MAV 64,48,104
buffer_load_dwordx4 v18, s[28:31], s54 offen lds
MAV 80,48,108
TR 2,7,17408
MAV 80,32,100
TR 4,7,16928
TR 6,7,17440
MAV 84,36,100
TR 16,7,25344
s_add_u32 s52, s79, 868352
MAV 84,52,108
buffer_load_dwordx4 v[152:155], v4, s[16:19], s52 offen sc1
MAV 68,52,104
TR 18,7,25856
MAV 68,36,96
TR 20,7,25376
TR 22,7,25888
s_waitcnt lgkmcnt(8)
MAV 72,40,96
TR 8,7,16960
MAV 72,56,104
buffer_load_dwordx4 v19, s[28:31], s54 offen offset:1056 lds
MAV 88,56,108
TR 10,7,17472
s_add_u32 s54, s98, 1900544
MAV 88,40,100
TR 12,7,16992
TR 14,7,17504
MAV 92,44,100
TR 24,7,25408
MAV 92,60,108
buffer_load_dwordx4 v[156:159], v4, s[16:19], s52 offen offset:1024 sc1
MAV 76,60,104
TR 26,7,25920
MAV 76,44,96
TR 28,7,25440
TR 30,7,25952
s_waitcnt vmcnt(16)
v_cmp_gt_u32 vcc, v23, v25
s_nop 0
s_cbranch_vccnz .Lsp50
.Lsp50b:
s_waitcnt lgkmcnt(8)
s_barrier
MAV 32,0,112
TR 32,6,16896
s_add_u32 m0, s55, 67584
MAV 32,16,120
buffer_load_dwordx4 v18, s[28:31], s54 offen lds
MAV 48,16,124
TR 34,6,17408
MAV 48,0,116
TR 36,6,16928
TR 38,6,17440
MAV 52,4,116
TR 48,6,25344
s_add_u32 s52, s76, 16384
MAV 52,20,124
buffer_load_dwordx4 v[96:99], v4, s[16:19], s52 offen sc1
MAV 36,20,120
TR 50,6,25856
MAV 36,4,112
TR 52,6,25376
TR 54,6,25888
s_waitcnt lgkmcnt(8)
MAV 40,8,112
TR 40,6,16960
MAV 40,24,120
buffer_load_dwordx4 v19, s[28:31], s54 offen offset:1056 lds
MAV 56,24,124
TR 42,6,17472
s_add_u32 s54, s98, 2162688
MAV 56,8,116
TR 44,6,16992
TR 46,6,17504
MAV 60,12,116
TR 56,6,25408
MAV 60,28,124
buffer_load_dwordx4 v[100:103], v4, s[16:19], s52 offen offset:1024 sc1
MAV 44,28,120
TR 58,6,25920
MAV 44,12,112
TR 60,6,25440
TR 62,6,25952
s_waitcnt lgkmcnt(8)
MAV 64,32,112
TR 0,7,33792
s_add_u32 m0, s55, 76032
MAV 64,48,120
buffer_load_dwordx4 v18, s[28:31], s54 offen lds
MAV 80,48,124
TR 2,7,34304
MAV 80,32,116
TR 4,7,33824
TR 6,7,34336
MAV 84,36,116
TR 16,7,42240
s_add_u32 s52, s76, 81920
MAV 84,52,124
buffer_load_dwordx4 v[104:107], v4, s[16:19], s52 offen sc1
MAV 68,52,120
TR 18,7,42752
MAV 68,36,112
TR 20,7,42272
TR 22,7,42784
s_waitcnt lgkmcnt(8)
MAV 72,40,112
TR 8,7,33856
MAV 72,56,120
buffer_load_dwordx4 v19, s[28:31], s54 offen offset:1056 lds
MAV 88,56,124
TR 10,7,34368
s_add_u32 s54, s99, 2359296
MAV 88,40,116
TR 12,7,33888
TR 14,7,34400
MAV 92,44,116
TR 24,7,42304
MAV 92,60,124
buffer_load_dwordx4 v[108:111], v4, s[16:19], s52 offen offset:1024 sc1
MAV 76,60,120
TR 26,7,42816
MAV 76,44,112
TR 28,7,42336
TR 30,7,42848
s_waitcnt vmcnt(16) lgkmcnt(8)
s_barrier
MAV 32,0,128
TR 32,6,33792
s_add_u32 m0, s55, 84480
MAV 32,16,136
buffer_load_dwordx4 v18, s[28:31], s54 offen lds
MAV 48,16,140
TR 34,6,34304
MAV 48,0,132
TR 36,6,33824
TR 38,6,34336
MAV 52,4,132
TR 48,6,42240
s_add_u32 s52, s77, 131072
MAV 52,20,140
buffer_load_dwordx4 v[112:115], v4, s[16:19], s52 offen sc1
MAV 36,20,136
TR 50,6,42752
MAV 36,4,128
TR 52,6,42272
TR 54,6,42784
s_waitcnt lgkmcnt(8)
MAV 40,8,128
TR 40,6,33856
MAV 40,24,136
buffer_load_dwordx4 v19, s[28:31], s54 offen offset:1056 lds
MAV 56,24,140
TR 42,6,34368
s_add_u32 s54, s99, 2621440
MAV 56,8,132
TR 44,6,33888
TR 46,6,34400
MAV 60,12,132
TR 56,6,42304
MAV 60,28,140
buffer_load_dwordx4 v[116:119], v4, s[16:19], s52 offen offset:1024 sc1
MAV 44,28,136
TR 58,6,42816
MAV 44,12,128
TR 60,6,42336
TR 62,6,42848
s_waitcnt lgkmcnt(8)
MAV 64,32,128
TR 0,7,50688
s_add_u32 m0, s55, 92928
MAV 64,48,136
buffer_load_dwordx4 v18, s[28:31], s54 offen lds
MAV 80,48,140
TR 2,7,51200
MAV 80,32,132
TR 4,7,50720
TR 6,7,51232
MAV 84,36,132
TR 16,7,59136
s_add_u32 s52, s77, 196608
MAV 84,52,140
buffer_load_dwordx4 v[120:123], v4, s[16:19], s52 offen sc1
MAV 68,52,136
TR 18,7,59648
MAV 68,36,128
TR 20,7,59168
TR 22,7,59680
s_waitcnt lgkmcnt(8)
MAV 72,40,128
TR 8,7,50752
MAV 72,56,136
buffer_load_dwordx4 v19, s[28:31], s54 offen offset:1056 lds
MAV 88,56,140
TR 10,7,51264
s_add_u32 s54, s100, 2818048
MAV 88,40,132
TR 12,7,50784
TR 14,7,51296
MAV 92,44,132
TR 24,7,59200
MAV 92,60,140
buffer_load_dwordx4 v[124:127], v4, s[16:19], s52 offen offset:1024 sc1
MAV 76,60,136
TR 26,7,59712
MAV 76,44,128
TR 28,7,59232
TR 30,7,59744
s_waitcnt vmcnt(16) lgkmcnt(8)
s_barrier
MAV 32,0,144
TR 32,6,50688
s_add_u32 m0, s55, 101376
MAV 32,16,152
buffer_load_dwordx4 v18, s[28:31], s54 offen lds
MAV 48,16,156
TR 34,6,51200
MAV 48,0,148
TR 36,6,50720
TR 38,6,51232
MAV 52,4,148
TR 48,6,59136
s_add_u32 s52, s78, 245760
MAV 52,20,156
buffer_load_dwordx4 v[128:131], v4, s[16:19], s52 offen sc1
MAV 36,20,152
TR 50,6,59648
MAV 36,4,144
TR 52,6,59168
TR 54,6,59680
s_waitcnt lgkmcnt(8)
MAV 40,8,144
TR 40,6,50752
MAV 40,24,152
buffer_load_dwordx4 v19, s[28:31], s54 offen offset:1056 lds
MAV 56,24,156
TR 42,6,51264
s_add_u32 s54, s100, 3080192
MAV 56,8,148
TR 44,6,50784
TR 46,6,51296
MAV 60,12,148
TR 56,6,59200
MAV 60,28,156
buffer_load_dwordx4 v[132:135], v4, s[16:19], s52 offen offset:1024 sc1
MAV 44,28,152
TR 58,6,59712
MAV 44,12,144
TR 60,6,59232
TR 62,6,59744
v_add_u32 v7, s57, v7
v_add_u32 v6, s57, v6
s_sub_u32 s57, 0, s57
s_waitcnt lgkmcnt(8)
MAV 64,32,144
ds_read_b64_tr_b16 a[0:1], v7
s_add_u32 m0, s55, 109824
MAV 64,48,152
buffer_load_dwordx4 v18, s[28:31], s54 offen lds
MAV 80,48,156
TR 2,7,512
MAV 80,32,148
TR 4,7,32
TR 6,7,544
MAV 84,36,148
TR 16,7,8448
s_add_u32 s52, s78, 311296
MAV 84,52,156
buffer_load_dwordx4 v[136:139], v4, s[16:19], s52 offen sc1
MAV 68,52,152
TR 18,7,8960
MAV 68,36,144
TR 20,7,8480
TR 22,7,8992
s_waitcnt lgkmcnt(8)
MAV 72,40,144
TR 8,7,64
MAV 72,56,152
buffer_load_dwordx4 v19, s[28:31], s54 offen offset:1056 lds
MAV 88,56,156
TR 10,7,576
s_add_u32 s54, s101, 3276800
MAV 88,40,148
TR 12,7,96
TR 14,7,608
MAV 92,44,148
TR 24,7,8512
MAV 92,60,156
buffer_load_dwordx4 v[140:143], v4, s[16:19], s52 offen offset:1024 sc1
MAV 76,60,152
TR 26,7,9024
MAV 76,44,144
TR 28,7,8544
TR 30,7,9056
s_waitcnt vmcnt(16) lgkmcnt(8)
s_barrier
MAV 32,0,96
ds_read_b64_tr_b16 a[32:33], v6
s_add_u32 m0, s55, 118272
MAV 32,16,104
buffer_load_dwordx4 v18, s[28:31], s54 offen lds
MAV 48,16,108
TR 34,6,512
MAV 48,0,100
TR 36,6,32
TR 38,6,544
MAV 52,4,100
TR 48,6,8448
s_add_u32 s52, s79, 360448
MAV 52,20,108
buffer_load_dwordx4 v[144:147], v4, s[16:19], s52 offen sc1
MAV 36,20,104
TR 50,6,8960
MAV 36,4,96
TR 52,6,8480
TR 54,6,8992
s_waitcnt lgkmcnt(8)
MAV 40,8,96
TR 40,6,64
MAV 40,24,104
buffer_load_dwordx4 v19, s[28:31], s54 offen offset:1056 lds
MAV 56,24,108
TR 42,6,576
s_add_u32 s54, s101, 3538944
MAV 56,8,100
TR 44,6,96
TR 46,6,608
MAV 60,12,100
TR 56,6,8512
MAV 60,28,108
buffer_load_dwordx4 v[148:151], v4, s[16:19], s52 offen offset:1024 sc1
MAV 44,28,104
TR 58,6,9024
MAV 44,12,96
TR 60,6,8544
TR 62,6,9056
s_waitcnt lgkmcnt(8)
MAV 64,32,96
TR 0,7,16896
s_add_u32 m0, s55, 126720
MAV 64,48,104
buffer_load_dwordx4 v18, s[28:31], s54 offen lds
MAV 80,48,108
TR 2,7,17408
MAV 80,32,100
TR 4,7,16928
TR 6,7,17440
MAV 84,36,100
TR 16,7,25344
s_add_u32 s52, s79, 425984
.Lpad8:
s_cbranch_execz .Lpad11
MAV 84,52,108
buffer_load_dwordx4 v[152:155], v4, s[16:19], s52 offen sc1
MAV 68,52,104
TR 18,7,25856
MAV 68,36,96
TR 20,7,25376
TR 22,7,25888
s_waitcnt lgkmcnt(8)
MAV 72,40,96
TR 8,7,16960
MAV 72,56,104
buffer_load_dwordx4 v19, s[28:31], s54 offen offset:1056 lds
MAV 88,56,108
TR 10,7,17472
s_add_u32 s54, s98, 131072
MAV 88,40,100
TR 12,7,16992
TR 14,7,17504
MAV 92,44,100
TR 24,7,25408
MAV 92,60,108
buffer_load_dwordx4 v[156:159], v4, s[16:19], s52 offen offset:1024 sc1
MAV 76,60,104
TR 26,7,25920
MAV 76,44,96
TR 28,7,25440
TR 30,7,25952
s_waitcnt vmcnt(16) lgkmcnt(8)
s_barrier
MAV 32,0,112
TR 32,6,16896
s_add_u32 m0, s55, 0
MAV 32,16,120
buffer_load_dwordx4 v18, s[28:31], s54 offen lds
MAV 48,16,124
TR 34,6,17408
MAV 48,0,116
TR 36,6,16928
TR 38,6,17440
MAV 52,4,116
TR 48,6,25344
s_add_u32 s52, s76, 475136
MAV 52,20,124
buffer_load_dwordx4 v[96:99], v4, s[16:19], s52 offen sc1
MAV 36,20,120
TR 50,6,25856
MAV 36,4,112
TR 52,6,25376
TR 54,6,25888
s_waitcnt lgkmcnt(8)
MAV 40,8,112
TR 40,6,16960
MAV 40,24,120
buffer_load_dwordx4 v19, s[28:31], s54 offen offset:1056 lds
MAV 56,24,124
TR 42,6,17472
s_add_u32 s54, s98, 393216
MAV 56,8,116
TR 44,6,16992
TR 46,6,17504
MAV 60,12,116
TR 56,6,25408
MAV 60,28,124
buffer_load_dwordx4 v[100:103], v4, s[16:19], s52 offen offset:1024 sc1
MAV 44,28,120
TR 58,6,25920
MAV 44,12,112
TR 60,6,25440
TR 62,6,25952
s_waitcnt lgkmcnt(8)
MAV 64,32,112
TR 0,7,33792
s_add_u32 m0, s55, 8448
MAV 64,48,120
buffer_load_dwordx4 v18, s[28:31], s54 offen lds
MAV 80,48,124
TR 2,7,34304
MAV 80,32,116
TR 4,7,33824
TR 6,7,34336
MAV 84,36,116
TR 16,7,42240
s_add_u32 s52, s76, 540672
MAV 84,52,124
buffer_load_dwordx4 v[104:107], v4, s[16:19], s52 offen sc1
MAV 68,52,120
TR 18,7,42752
MAV 68,36,112
TR 20,7,42272
TR 22,7,42784
s_waitcnt lgkmcnt(8)
MAV 72,40,112
TR 8,7,33856
MAV 72,56,120
buffer_load_dwordx4 v19, s[28:31], s54 offen offset:1056 lds
MAV 88,56,124
TR 10,7,34368
s_add_u32 s54, s99, 589824
MAV 88,40,116
TR 12,7,33888
TR 14,7,34400
MAV 92,44,116
TR 24,7,42304
MAV 92,60,124
buffer_load_dwordx4 v[108:111], v4, s[16:19], s52 offen offset:1024 sc1
MAV 76,60,120
TR 26,7,42816
MAV 76,44,112
TR 28,7,42336
TR 30,7,42848
s_waitcnt vmcnt(16) lgkmcnt(8)
s_barrier
MAV 32,0,128
TR 32,6,33792
s_add_u32 m0, s55, 16896
MAV 32,16,136
buffer_load_dwordx4 v18, s[28:31], s54 offen lds
MAV 48,16,140
TR 34,6,34304
MAV 48,0,132
TR 36,6,33824
TR 38,6,34336
MAV 52,4,132
TR 48,6,42240
s_add_u32 s52, s77, 589824
MAV 52,20,140
buffer_load_dwordx4 v[112:115], v4, s[16:19], s52 offen sc1
MAV 36,20,136
TR 50,6,42752
MAV 36,4,128
TR 52,6,42272
TR 54,6,42784
s_waitcnt lgkmcnt(8)
MAV 40,8,128
TR 40,6,33856
MAV 40,24,136
buffer_load_dwordx4 v19, s[28:31], s54 offen offset:1056 lds
MAV 56,24,140
TR 42,6,34368
s_add_u32 s54, s99, 851968
MAV 56,8,132
TR 44,6,33888
TR 46,6,34400
MAV 60,12,132
TR 56,6,42304
MAV 60,28,140
buffer_load_dwordx4 v[116:119], v4, s[16:19], s52 offen offset:1024 sc1
MAV 44,28,136
TR 58,6,42816
MAV 44,12,128
TR 60,6,42336
TR 62,6,42848
s_waitcnt lgkmcnt(8)
MAV 64,32,128
TR 0,7,50688
s_add_u32 m0, s55, 25344
MAV 64,48,136
buffer_load_dwordx4 v18, s[28:31], s54 offen lds
MAV 80,48,140
TR 2,7,51200
MAV 80,32,132
TR 4,7,50720
TR 6,7,51232
MAV 84,36,132
TR 16,7,59136
s_add_u32 s52, s77, 655360
MAV 84,52,140
buffer_load_dwordx4 v[120:123], v4, s[16:19], s52 offen sc1
MAV 68,52,136
TR 18,7,59648
MAV 68,36,128
TR 20,7,59168
TR 22,7,59680
s_waitcnt lgkmcnt(8)
MAV 72,40,128
TR 8,7,50752
MAV 72,56,136
buffer_load_dwordx4 v19, s[28:31], s54 offen offset:1056 lds
MAV 88,56,140
TR 10,7,51264
s_add_u32 s54, s100, 1048576
MAV 88,40,132
TR 12,7,50784
TR 14,7,51296
MAV 92,44,132
TR 24,7,59200
MAV 92,60,140
buffer_load_dwordx4 v[124:127], v4, s[16:19], s52 offen offset:1024 sc1
MAV 76,60,136
TR 26,7,59712
MAV 76,44,128
TR 28,7,59232
TR 30,7,59744
s_waitcnt vmcnt(16) lgkmcnt(8)
s_barrier
MAV 32,0,144
TR 32,6,50688
s_add_u32 m0, s55, 33792
MAV 32,16,152
buffer_load_dwordx4 v18, s[28:31], s54 offen lds
MAV 48,16,156
TR 34,6,51200
MAV 48,0,148
TR 36,6,50720
TR 38,6,51232
MAV 52,4,148
TR 48,6,59136
s_add_u32 s52, s78, 704512
MAV 52,20,156
buffer_load_dwordx4 v[128:131], v4, s[16:19], s52 offen sc1
MAV 36,20,152
TR 50,6,59648
MAV 36,4,144
TR 52,6,59168
TR 54,6,59680
s_waitcnt lgkmcnt(8)
MAV 40,8,144
TR 40,6,50752
MAV 40,24,152
buffer_load_dwordx4 v19, s[28:31], s54 offen offset:1056 lds
MAV 56,24,156
TR 42,6,51264
s_add_u32 s54, s100, 1310720
MAV 56,8,148
TR 44,6,50784
TR 46,6,51296
MAV 60,12,148
TR 56,6,59200
MAV 60,28,156
buffer_load_dwordx4 v[132:135], v4, s[16:19], s52 offen offset:1024 sc1
MAV 44,28,152
TR 58,6,59712
MAV 44,12,144
TR 60,6,59232
TR 62,6,59744
v_add_u32 v7, s57, v7
v_add_u32 v6, s57, v6
s_sub_u32 s57, 0, s57
s_waitcnt lgkmcnt(8)
MAV 64,32,144
ds_read_b64_tr_b16 a[0:1], v7
s_add_u32 m0, s55, 42240
MAV 64,48,152
buffer_load_dwordx4 v18, s[28:31], s54 offen lds
MAV 80,48,156
TR 2,7,512
MAV 80,32,148
TR 4,7,32
TR 6,7,544
MAV 84,36,148
TR 16,7,8448
s_add_u32 s52, s78, 770048
MAV 84,52,156
buffer_load_dwordx4 v[136:139], v4, s[16:19], s52 offen sc1
MAV 68,52,152
TR 18,7,8960
MAV 68,36,144
TR 20,7,8480
TR 22,7,8992
s_waitcnt lgkmcnt(8)
MAV 72,40,144
TR 8,7,64
MAV 72,56,152
buffer_load_dwordx4 v19, s[28:31], s54 offen offset:1056 lds
MAV 88,56,156
TR 10,7,576
s_add_u32 s54, s101, 1507328
MAV 88,40,148
TR 12,7,96
TR 14,7,608
MAV 92,44,148
TR 24,7,8512
MAV 92,60,156
buffer_load_dwordx4 v[140:143], v4, s[16:19], s52 offen offset:1024 sc1
MAV 76,60,152
TR 26,7,9024
MAV 76,44,144
TR 28,7,8544
TR 30,7,9056
s_waitcnt vmcnt(16) lgkmcnt(8)
s_barrier
MAV 32,0,96
ds_read_b64_tr_b16 a[32:33], v6
s_add_u32 m0, s55, 50688
MAV 32,16,104
buffer_load_dwordx4 v18, s[28:31], s54 offen lds
MAV 48,16,108
TR 34,6,512
MAV 48,0,100
TR 36,6,32
TR 38,6,544
MAV 52,4,100
TR 48,6,8448
s_add_u32 s52, s79, 819200
MAV 52,20,108
buffer_load_dwordx4 v[144:147], v4, s[16:19], s52 offen sc1
MAV 36,20,104
TR 50,6,8960
MAV 36,4,96
TR 52,6,8480
TR 54,6,8992
s_waitcnt lgkmcnt(8)
MAV 40,8,96
TR 40,6,64
MAV 40,24,104
buffer_load_dwordx4 v19, s[28:31], s54 offen offset:1056 lds
MAV 56,24,108
TR 42,6,576
s_add_u32 s54, s101, 1769472
MAV 56,8,100
TR 44,6,96
TR 46,6,608
MAV 60,12,100
TR 56,6,8512
MAV 60,28,108
buffer_load_dwordx4 v[148:151], v4, s[16:19], s52 offen offset:1024 sc1
MAV 44,28,104
TR 58,6,9024
MAV 44,12,96
TR 60,6,8544
TR 62,6,9056
s_waitcnt lgkmcnt(8)
MAV 64,32,96
TR 0,7,16896
s_add_u32 m0, s55, 59136
MAV 64,48,104
buffer_load_dwordx4 v18, s[28:31], s54 offen lds
MAV 80,48,108
TR 2,7,17408
MAV 80,32,100
TR 4,7,16928
TR 6,7,17440
MAV 84,36,100
TR 16,7,25344
s_add_u32 s52, s79, 884736
MAV 84,52,108
buffer_load_dwordx4 v[152:155], v4, s[16:19], s52 offen sc1
MAV 68,52,104
TR 18,7,25856
MAV 68,36,96
TR 20,7,25376
TR 22,7,25888
s_waitcnt lgkmcnt(8)
MAV 72,40,96
TR 8,7,16960
MAV 72,56,104
buffer_load_dwordx4 v19, s[28:31], s54 offen offset:1056 lds
MAV 88,56,108
TR 10,7,17472
s_add_u32 s54, s98, 1966080
MAV 88,40,100
TR 12,7,16992
TR 14,7,17504
MAV 92,44,100
TR 24,7,25408
MAV 92,60,108
buffer_load_dwordx4 v[156:159], v4, s[16:19], s52 offen offset:1024 sc1
MAV 76,60,104
TR 26,7,25920
MAV 76,44,96
TR 28,7,25440
TR 30,7,25952
s_waitcnt vmcnt(16) lgkmcnt(8)
s_barrier
MAV 32,0,112
TR 32,6,16896
s_add_u32 m0, s55, 67584
MAV 32,16,120
buffer_load_dwordx4 v18, s[28:31], s54 offen lds
MAV 48,16,124
TR 34,6,17408
MAV 48,0,116
TR 36,6,16928
TR 38,6,17440
MAV 52,4,116
TR 48,6,25344
s_add_u32 s52, s76, 32768
MAV 52,20,124
buffer_load_dwordx4 v[96:99], v4, s[16:19], s52 offen sc1
MAV 36,20,120
TR 50,6,25856
MAV 36,4,112
TR 52,6,25376
TR 54,6,25888
s_waitcnt lgkmcnt(8)
MAV 40,8,112
TR 40,6,16960
MAV 40,24,120
buffer_load_dwordx4 v19, s[28:31], s54 offen offset:1056 lds
MAV 56,24,124
TR 42,6,17472
s_add_u32 s54, s98, 2228224
MAV 56,8,116
TR 44,6,16992
TR 46,6,17504
MAV 60,12,116
TR 56,6,25408
MAV 60,28,124
buffer_load_dwordx4 v[100:103], v4, s[16:19], s52 offen offset:1024 sc1
MAV 44,28,120
TR 58,6,25920
MAV 44,12,112
TR 60,6,25440
TR 62,6,25952
s_waitcnt lgkmcnt(8)
MAV 64,32,112
TR 0,7,33792
s_add_u32 m0, s55, 76032
MAV 64,48,120
buffer_load_dwordx4 v18, s[28:31], s54 offen lds
MAV 80,48,124
TR 2,7,34304
MAV 80,32,116
TR 4,7,33824
TR 6,7,34336
MAV 84,36,116
TR 16,7,42240
s_add_u32 s52, s76, 98304
MAV 84,52,124
buffer_load_dwordx4 v[104:107], v4, s[16:19], s52 offen sc1
MAV 68,52,120
TR 18,7,42752
MAV 68,36,112
TR 20,7,42272
TR 22,7,42784
s_waitcnt lgkmcnt(8)
MAV 72,40,112
TR 8,7,33856
MAV 72,56,120
buffer_load_dwordx4 v19, s[28:31], s54 offen offset:1056 lds
MAV 88,56,124
TR 10,7,34368
s_add_u32 s54, s99, 2424832
MAV 88,40,116
TR 12,7,33888
TR 14,7,34400
MAV 92,44,116
TR 24,7,42304
MAV 92,60,124
buffer_load_dwordx4 v[108:111], v4, s[16:19], s52 offen offset:1024 sc1
MAV 76,60,120
TR 26,7,42816
MAV 76,44,112
TR 28,7,42336
TR 30,7,42848
s_waitcnt vmcnt(16) lgkmcnt(8)
s_barrier
MAV 32,0,128
TR 32,6,33792
s_add_u32 m0, s55, 84480
MAV 32,16,136
buffer_load_dwordx4 v18, s[28:31], s54 offen lds
MAV 48,16,140
TR 34,6,34304
MAV 48,0,132
TR 36,6,33824
TR 38,6,34336
MAV 52,4,132
TR 48,6,42240
s_add_u32 s52, s77, 147456
MAV 52,20,140
buffer_load_dwordx4 v[112:115], v4, s[16:19], s52 offen sc1
MAV 36,20,136
TR 50,6,42752
MAV 36,4,128
TR 52,6,42272
TR 54,6,42784
s_waitcnt lgkmcnt(8)
MAV 40,8,128
TR 40,6,33856
MAV 40,24,136
buffer_load_dwordx4 v19, s[28:31], s54 offen offset:1056 lds
MAV 56,24,140
TR 42,6,34368
s_add_u32 s54, s99, 2686976
MAV 56,8,132
TR 44,6,33888
TR 46,6,34400
MAV 60,12,132
TR 56,6,42304
MAV 60,28,140
buffer_load_dwordx4 v[116:119], v4, s[16:19], s52 offen offset:1024 sc1
MAV 44,28,136
TR 58,6,42816
MAV 44,12,128
TR 60,6,42336
TR 62,6,42848
s_waitcnt lgkmcnt(8)
MAV 64,32,128
TR 0,7,50688
s_add_u32 m0, s55, 92928
MAV 64,48,136
buffer_load_dwordx4 v18, s[28:31], s54 offen lds
MAV 80,48,140
TR 2,7,51200
MAV 80,32,132
TR 4,7,50720
TR 6,7,51232
MAV 84,36,132
TR 16,7,59136
s_add_u32 s52, s77, 212992
MAV 84,52,140
buffer_load_dwordx4 v[120:123], v4, s[16:19], s52 offen sc1
MAV 68,52,136
TR 18,7,59648
MAV 68,36,128
TR 20,7,59168
TR 22,7,59680
s_waitcnt lgkmcnt(8)
MAV 72,40,128
TR 8,7,50752
MAV 72,56,136
buffer_load_dwordx4 v19, s[28:31], s54 offen offset:1056 lds
MAV 88,56,140
TR 10,7,51264
s_add_u32 s54, s100, 2883584
MAV 88,40,132
TR 12,7,50784
TR 14,7,51296
MAV 92,44,132
TR 24,7,59200
MAV 92,60,140
buffer_load_dwordx4 v[124:127], v4, s[16:19], s52 offen offset:1024 sc1
MAV 76,60,136
TR 26,7,59712
MAV 76,44,128
TR 28,7,59232
TR 30,7,59744
s_waitcnt vmcnt(16) lgkmcnt(8)
.Lpad9:
s_cbranch_execz .Lnopoll37r
s_barrier
MAV 32,0,144
TR 32,6,50688
s_add_u32 m0, s55, 101376
MAV 32,16,152
buffer_load_dwordx4 v18, s[28:31], s54 offen lds
MAV 48,16,156
TR 34,6,51200
MAV 48,0,148
TR 36,6,50720
TR 38,6,51232
MAV 52,4,148
TR 48,6,59136
s_add_u32 s52, s78, 262144
MAV 52,20,156
buffer_load_dwordx4 v[128:131], v4, s[16:19], s52 offen sc1
MAV 36,20,152
TR 50,6,59648
MAV 36,4,144
TR 52,6,59168
TR 54,6,59680
s_waitcnt lgkmcnt(8)
MAV 40,8,144
TR 40,6,50752
MAV 40,24,152
buffer_load_dwordx4 v19, s[28:31], s54 offen offset:1056 lds
MAV 56,24,156
TR 42,6,51264
s_add_u32 s54, s100, 3145728
MAV 56,8,148
TR 44,6,50784
TR 46,6,51296
MAV 60,12,148
TR 56,6,59200
MAV 60,28,156
buffer_load_dwordx4 v[132:135], v4, s[16:19], s52 offen offset:1024 sc1
MAV 44,28,152
TR 58,6,59712
MAV 44,12,144
TR 60,6,59232
TR 62,6,59744
v_add_u32 v7, s57, v7
v_add_u32 v6, s57, v6
s_sub_u32 s57, 0, s57
s_waitcnt lgkmcnt(8)
MAV 64,32,144
ds_read_b64_tr_b16 a[0:1], v7
s_add_u32 m0, s55, 109824
MAV 64,48,152
buffer_load_dwordx4 v18, s[28:31], s54 offen lds
MAV 80,48,156
TR 2,7,512
MAV 80,32,148
TR 4,7,32
TR 6,7,544
MAV 84,36,148
TR 16,7,8448
s_add_u32 s52, s78, 327680
MAV 84,52,156
buffer_load_dwordx4 v[136:139], v4, s[16:19], s52 offen sc1
MAV 68,52,152
TR 18,7,8960
MAV 68,36,144
TR 20,7,8480
TR 22,7,8992
s_waitcnt lgkmcnt(8)
MAV 72,40,144
TR 8,7,64
MAV 72,56,152
buffer_load_dwordx4 v19, s[28:31], s54 offen offset:1056 lds
MAV 88,56,156
TR 10,7,576
s_add_u32 s54, s101, 3342336
MAV 88,40,148
TR 12,7,96
TR 14,7,608
MAV 92,44,148
TR 24,7,8512
MAV 92,60,156
buffer_load_dwordx4 v[140:143], v4, s[16:19], s52 offen offset:1024 sc1
MAV 76,60,152
TR 26,7,9024
MAV 76,44,144
TR 28,7,8544
TR 30,7,9056
s_waitcnt vmcnt(16) lgkmcnt(8)
s_barrier
MAV 32,0,96
ds_read_b64_tr_b16 a[32:33], v6
s_add_u32 m0, s55, 118272
MAV 32,16,104
buffer_load_dwordx4 v18, s[28:31], s54 offen lds
MAV 48,16,108
TR 34,6,512
MAV 48,0,100
TR 36,6,32
TR 38,6,544
MAV 52,4,100
TR 48,6,8448
s_add_u32 s52, s79, 376832
MAV 52,20,108
buffer_load_dwordx4 v[144:147], v4, s[16:19], s52 offen sc1
MAV 36,20,104
TR 50,6,8960
MAV 36,4,96
TR 52,6,8480
TR 54,6,8992
s_waitcnt lgkmcnt(8)
MAV 40,8,96
TR 40,6,64
MAV 40,24,104
buffer_load_dwordx4 v19, s[28:31], s54 offen offset:1056 lds
MAV 56,24,108
TR 42,6,576
s_add_u32 s54, s101, 3604480
MAV 56,8,100
TR 44,6,96
TR 46,6,608
MAV 60,12,100
TR 56,6,8512
MAV 60,28,108
buffer_load_dwordx4 v[148:151], v4, s[16:19], s52 offen offset:1024 sc1
MAV 44,28,104
TR 58,6,9024
MAV 44,12,96
TR 60,6,8544
TR 62,6,9056
s_waitcnt lgkmcnt(8)
MAV 64,32,96
TR 0,7,16896
s_add_u32 m0, s55, 126720
MAV 64,48,104
buffer_load_dwordx4 v18, s[28:31], s54 offen lds
MAV 80,48,108
TR 2,7,17408
MAV 80,32,100
TR 4,7,16928
TR 6,7,17440
MAV 84,36,100
TR 16,7,25344
s_add_u32 s52, s79, 442368
MAV 84,52,108
buffer_load_dwordx4 v[152:155], v4, s[16:19], s52 offen sc1
MAV 68,52,104
TR 18,7,25856
MAV 68,36,96
TR 20,7,25376
TR 22,7,25888
s_waitcnt lgkmcnt(8)
MAV 72,40,96
TR 8,7,16960
MAV 72,56,104
buffer_load_dwordx4 v19, s[28:31], s54 offen offset:1056 lds
MAV 88,56,108
TR 10,7,17472
s_add_u32 s54, s98, 196608
MAV 88,40,100
TR 12,7,16992
TR 14,7,17504
MAV 92,44,100
TR 24,7,25408
MAV 92,60,108
buffer_load_dwordx4 v[156:159], v4, s[16:19], s52 offen offset:1024 sc1
MAV 76,60,104
TR 26,7,25920
MAV 76,44,96
TR 28,7,25440
TR 30,7,25952
s_waitcnt vmcnt(16) lgkmcnt(8)
s_barrier
MAV 32,0,112
TR 32,6,16896
s_add_u32 m0, s55, 0
MAV 32,16,120
buffer_load_dwordx4 v18, s[28:31], s54 offen lds
MAV 48,16,124
TR 34,6,17408
MAV 48,0,116
TR 36,6,16928
TR 38,6,17440
MAV 52,4,116
TR 48,6,25344
s_add_u32 s52, s76, 491520
MAV 52,20,124
buffer_load_dwordx4 v[96:99], v4, s[16:19], s52 offen sc1
MAV 36,20,120
TR 50,6,25856
MAV 36,4,112
TR 52,6,25376
TR 54,6,25888
s_waitcnt lgkmcnt(8)
MAV 40,8,112
TR 40,6,16960
MAV 40,24,120
buffer_load_dwordx4 v19, s[28:31], s54 offen offset:1056 lds
MAV 56,24,124
TR 42,6,17472
s_add_u32 s54, s99, 655360
MAV 56,8,116
TR 44,6,16992
TR 46,6,17504
MAV 60,12,116
TR 56,6,25408
MAV 60,28,124
buffer_load_dwordx4 v[100:103], v4, s[16:19], s52 offen offset:1024 sc1
MAV 44,28,120
TR 58,6,25920
MAV 44,12,112
TR 60,6,25440
TR 62,6,25952
s_waitcnt lgkmcnt(8)
MAV 64,32,112
TR 0,7,33792
s_add_u32 m0, s55, 8448
MAV 64,48,120
buffer_load_dwordx4 v18, s[28:31], s54 offen lds
MAV 80,48,124
TR 2,7,34304
MAV 80,32,116
TR 4,7,33824
TR 6,7,34336
MAV 84,36,116
TR 16,7,42240
s_add_u32 s52, s76, 557056
MAV 84,52,124
buffer_load_dwordx4 v[104:107], v4, s[16:19], s52 offen sc1
MAV 68,52,120
TR 18,7,42752
MAV 68,36,112
TR 20,7,42272
TR 22,7,42784
s_waitcnt lgkmcnt(8)
MAV 72,40,112
TR 8,7,33856
MAV 72,56,120
buffer_load_dwordx4 v19, s[28:31], s54 offen offset:1056 lds
MAV 88,56,124
TR 10,7,34368
s_add_u32 s54, s100, 1114112
MAV 88,40,116
TR 12,7,33888
TR 14,7,34400
MAV 92,44,116
TR 24,7,42304
MAV 92,60,124
buffer_load_dwordx4 v[108:111], v4, s[16:19], s52 offen offset:1024 sc1
MAV 76,60,120
TR 26,7,42816
MAV 76,44,112
TR 28,7,42336
TR 30,7,42848
s_waitcnt vmcnt(16) lgkmcnt(8)
s_barrier
MAV 32,0,128
TR 32,6,33792
s_add_u32 m0, s55, 16896
MAV 32,16,136
buffer_load_dwordx4 v18, s[28:31], s54 offen lds
MAV 48,16,140
TR 34,6,34304
MAV 48,0,132
TR 36,6,33824
TR 38,6,34336
MAV 52,4,132
TR 48,6,42240
s_add_u32 s52, s77, 606208
MAV 52,20,140
buffer_load_dwordx4 v[112:115], v4, s[16:19], s52 offen sc1
MAV 36,20,136
TR 50,6,42752
MAV 36,4,128
TR 52,6,42272
TR 54,6,42784
s_waitcnt lgkmcnt(8)
MAV 40,8,128
TR 40,6,33856
MAV 40,24,136
buffer_load_dwordx4 v19, s[28:31], s54 offen offset:1056 lds
MAV 56,24,140
TR 42,6,34368
s_add_u32 s54, s101, 1572864
MAV 56,8,132
TR 44,6,33888
TR 46,6,34400
MAV 60,12,132
TR 56,6,42304
MAV 60,28,140
buffer_load_dwordx4 v[116:119], v4, s[16:19], s52 offen offset:1024 sc1
MAV 44,28,136
TR 58,6,42816
MAV 44,12,128
TR 60,6,42336
TR 62,6,42848
s_waitcnt lgkmcnt(8)
MAV 64,32,128
TR 0,7,50688
s_add_u32 m0, s55, 25344
MAV 64,48,136
buffer_load_dwordx4 v18, s[28:31], s54 offen lds
MAV 80,48,140
TR 2,7,51200
MAV 80,32,132
TR 4,7,50720
TR 6,7,51232
MAV 84,36,132
TR 16,7,59136
s_add_u32 s52, s77, 671744
MAV 84,52,140
buffer_load_dwordx4 v[120:123], v4, s[16:19], s52 offen sc1
MAV 68,52,136
TR 18,7,59648
MAV 68,36,128
TR 20,7,59168
TR 22,7,59680
s_waitcnt lgkmcnt(8)
MAV 72,40,128
TR 8,7,50752
MAV 72,56,136
buffer_load_dwordx4 v19, s[28:31], s54 offen offset:1056 lds
MAV 88,56,140
TR 10,7,51264
s_add_u32 s54, s98, 2031616
MAV 88,40,132
TR 12,7,50784
TR 14,7,51296
MAV 92,44,132
TR 24,7,59200
MAV 92,60,140
buffer_load_dwordx4 v[124:127], v4, s[16:19], s52 offen offset:1024 sc1
MAV 76,60,136
TR 26,7,59712
MAV 76,44,128
TR 28,7,59232
TR 30,7,59744
s_waitcnt vmcnt(16) lgkmcnt(8)
s_barrier
MAV 32,0,144
TR 32,6,50688
s_add_u32 m0, s55, 33792
MAV 32,16,152
buffer_load_dwordx4 v18, s[28:31], s54 offen lds
MAV 48,16,156
TR 34,6,51200
MAV 48,0,148
TR 36,6,50720
TR 38,6,51232
MAV 52,4,148
TR 48,6,59136
s_add_u32 s52, s78, 720896
MAV 52,20,156
buffer_load_dwordx4 v[128:131], v4, s[16:19], s52 offen sc1
MAV 36,20,152
TR 50,6,59648
MAV 36,4,144
TR 52,6,59168
TR 54,6,59680
s_waitcnt lgkmcnt(8)
MAV 40,8,144
TR 40,6,50752
MAV 40,24,152
buffer_load_dwordx4 v19, s[28:31], s54 offen offset:1056 lds
MAV 56,24,156
TR 42,6,51264
s_add_u32 s54, s99, 2490368
MAV 56,8,148
TR 44,6,50784
TR 46,6,51296
MAV 60,12,148
TR 56,6,59200
MAV 60,28,156
buffer_load_dwordx4 v[132:135], v4, s[16:19], s52 offen offset:1024 sc1
MAV 44,28,152
TR 58,6,59712
MAV 44,12,144
TR 60,6,59232
TR 62,6,59744
v_add_u32 v7, s57, v7
v_add_u32 v6, s57, v6
s_sub_u32 s57, 0, s57
s_waitcnt lgkmcnt(8)
MAV 64,32,144
ds_read_b64_tr_b16 a[0:1], v7
s_add_u32 m0, s55, 42240
MAV 64,48,152
buffer_load_dwordx4 v18, s[28:31], s54 offen lds
MAV 80,48,156
TR 2,7,512
MAV 80,32,148
TR 4,7,32
TR 6,7,544
MAV 84,36,148
TR 16,7,8448
s_add_u32 s52, s78, 786432
MAV 84,52,156
buffer_load_dwordx4 v[136:139], v4, s[16:19], s52 offen sc1
MAV 68,52,152
TR 18,7,8960
MAV 68,36,144
TR 20,7,8480
TR 22,7,8992
s_waitcnt lgkmcnt(8)
MAV 72,40,144
TR 8,7,64
MAV 72,56,152
buffer_load_dwordx4 v19, s[28:31], s54 offen offset:1056 lds
MAV 88,56,156
TR 10,7,576
s_add_u32 s54, s100, 2949120
MAV 88,40,148
TR 12,7,96
TR 14,7,608
MAV 92,44,148
TR 24,7,8512
MAV 92,60,156
buffer_load_dwordx4 v[140:143], v4, s[16:19], s52 offen offset:1024 sc1
MAV 76,60,152
TR 26,7,9024
MAV 76,44,144
TR 28,7,8544
TR 30,7,9056
s_waitcnt vmcnt(16) lgkmcnt(8)
s_barrier
MAV 32,0,96
ds_read_b64_tr_b16 a[32:33], v6
s_add_u32 m0, s55, 50688
MAV 32,16,104
buffer_load_dwordx4 v18, s[28:31], s54 offen lds
MAV 48,16,108
TR 34,6,512
MAV 48,0,100
TR 36,6,32
TR 38,6,544
MAV 52,4,100
TR 48,6,8448
s_add_u32 s52, s79, 835584
MAV 52,20,108
buffer_load_dwordx4 v[144:147], v4, s[16:19], s52 offen sc1
MAV 36,20,104
TR 50,6,8960
MAV 36,4,96
TR 52,6,8480
TR 54,6,8992
s_waitcnt lgkmcnt(8)
MAV 40,8,96
TR 40,6,64
MAV 40,24,104
buffer_load_dwordx4 v19, s[28:31], s54 offen offset:1056 lds
MAV 56,24,108
TR 42,6,576
s_add_u32 s54, s101, 3407872
MAV 56,8,100
TR 44,6,96
TR 46,6,608
MAV 60,12,100
TR 56,6,8512
MAV 60,28,108
buffer_load_dwordx4 v[148:151], v4, s[16:19], s52 offen offset:1024 sc1
MAV 44,28,104
TR 58,6,9024
MAV 44,12,96
TR 60,6,8544
TR 62,6,9056
s_waitcnt lgkmcnt(8)
MAV 64,32,96
TR 0,6,16896
s_add_u32 m0, s55, 59136
MAV 64,48,104
buffer_load_dwordx4 v18, s[28:31], s54 offen lds
MAV 80,48,108
TR 2,6,17408
MAV 80,32,100
TR 4,6,16928
TR 6,6,17440
MAV 84,36,100
TR 16,6,25344
s_add_u32 s52, s79, 901120
MAV 84,52,108
buffer_load_dwordx4 v[152:155], v4, s[16:19], s52 offen sc1
MAV 68,52,104
TR 18,6,25856
MAV 68,36,96
TR 20,6,25376
TR 22,6,25888
s_waitcnt lgkmcnt(8)
MAV 72,40,96
TR 8,6,16960
MAV 72,56,104
buffer_load_dwordx4 v19, s[28:31], s54 offen offset:1056 lds
MAV 88,56,108
TR 10,6,17472
MAV 88,40,100
TR 12,6,16992
TR 14,6,17504
MAV 92,44,100
TR 24,6,25408
MAV 92,60,108
buffer_load_dwordx4 v[156:159], v4, s[16:19], s52 offen offset:1024 sc1
MAV 76,60,104
TR 26,6,25920
MAV 76,44,96
TR 28,6,25440
TR 30,6,25952
s_waitcnt vmcnt(16) lgkmcnt(8)
MAV 64,0,112
TR 32,6,33792
s_add_u32 s52, s76, 49152
MAV 64,16,120
buffer_load_dwordx4 v[160:163], v4, s[16:19], s52 offen sc1
MAV 80,16,124
TR 34,6,34304
MAV 80,0,116
TR 36,6,33824
TR 38,6,34336
MAV 84,4,116
TR 48,6,42240
MAV 84,20,124
buffer_load_dwordx4 v[164:167], v4, s[16:19], s52 offen offset:1024 sc1
MAV 68,20,120
TR 50,6,42752
MAV 68,4,112
TR 52,6,42272
TR 54,6,42784
s_waitcnt lgkmcnt(8)
MAV 72,8,112
TR 40,6,33856
s_add_u32 s52, s77, 163840
MAV 72,24,120
buffer_load_dwordx4 v[168:171], v4, s[16:19], s52 offen sc1
MAV 88,24,124
TR 42,6,34368
MAV 88,8,116
.Lpad10:
s_cbranch_execz .Lnopoll37r
TR 44,6,33888
TR 46,6,34400
MAV 92,12,116
TR 56,6,42304
MAV 92,28,124
buffer_load_dwordx4 v[172:175], v4, s[16:19], s52 offen offset:1024 sc1
MAV 76,28,120
TR 58,6,42816
MAV 76,12,112
TR 60,6,42336
TR 62,6,42848
s_waitcnt vmcnt(12) lgkmcnt(8)
MAV 64,32,128
TR 0,6,50688
s_add_u32 s52, s78, 278528
s_lshl_b32 s70, s2, 10
s_lshl_b32 s62, s3, 7
MAV 64,48,136
buffer_load_dwordx4 v[176:179], v4, s[16:19], s52 offen sc1
s_add_u32 s70, s70, s62
MAV 80,48,140
TR 2,6,51200
s_add_u32 s70, s70, 31457280
MAV 80,32,132
TR 4,6,50720
TR 6,6,51232
s_xor_b32 s71, s70, 1024
MAV 84,36,132
TR 16,6,59136
v_min_u32 v12, 1, v1
MAV 84,52,140
buffer_load_dwordx4 v[180:183], v4, s[16:19], s52 offen offset:1024 sc1
v_lshlrev_b32 v12, 28, v12
MAV 68,52,136
TR 18,6,59648
v_mov_b32 v13, 1
v_mov_b32 v15, 0
MAV 68,36,128
TR 20,6,59168
TR 22,6,59680
s_waitcnt lgkmcnt(8)
MAV 72,40,128
TR 8,6,50752
s_add_u32 s52, s79, 393216
s_lshl_b32 s68, s7, 18
MAV 72,56,136
buffer_load_dwordx4 v[184:187], v4, s[16:19], s52 offen sc1
s_add_u32 s68, s68, 33554432
s_xor_b32 s69, s68, 262144
MAV 88,56,140
TR 10,6,51264
v_mov_b32 v11, v4
MAV 88,40,132
TR 12,6,50784
TR 14,6,51296
v_and_b32 v2, 1, v1
MAV 92,44,132
TR 24,6,59200
v_lshlrev_b32 v2, 4, v2
MAV 92,60,140
buffer_load_dwordx4 v[188:191], v4, s[16:19], s52 offen offset:1024 sc1
v_mov_b32 v224, 0x3f80
MAV 76,60,136
TR 26,6,59712
v_lshlrev_b32 v2, v2, v224
v_bfe_u32 v224, v1, 2, 2
MAV 76,44,128
TR 28,6,59232
TR 30,6,59744
s_waitcnt vmcnt(8) lgkmcnt(8)
s_barrier
v_add_u32 v6, s57, v6
MAV 64,0,144
ds_read_b64_tr_b16 a[32:33], v6
s_add_u32 s52, s76, 507904
v_lshrrev_b32 v225, 4, v1
v_cmp_eq_u32 vcc, v224, v225
MAV 64,16,152
buffer_load_dwordx4 v[192:195], v4, s[16:19], s52 offen sc1
v_cndmask_b32 v2, 0, v2, vcc
MAV 80,16,156
TR 34,6,512
v_and_b32 v224, 2, v1
MAV 80,0,148
TR 36,6,32
TR 38,6,544
v_cmp_eq_u32 vcc, 0, v224
MAV 84,4,148
TR 48,6,8448
v_cndmask_b32 v226, 0, v2, vcc
MAV 84,20,156
buffer_load_dwordx4 v[196:199], v4, s[16:19], s52 offen offset:1024 sc1
v_cndmask_b32 v227, v2, 0, vcc
MAV 68,20,152
TR 50,6,8960
v_mov_b32 v224, 0
v_mov_b32 v225, 0
MAV 68,4,144
TR 52,6,8480
TR 54,6,8992
s_waitcnt lgkmcnt(8)
MAV 72,8,144
TR 40,6,64
s_add_u32 s52, s77, 622592
v_mov_b32 v228, 0
MAV 72,24,152
buffer_load_dwordx4 v[200:203], v4, s[16:19], s52 offen sc1
v_mov_b32 v229, 0
v_bfe_u32 v18, v1, 3, 1
MAV 88,24,156
TR 42,6,576
v_lshrrev_b32 v2, 4, v1
MAV 88,8,148
TR 44,6,96
TR 46,6,608
v_lshl_add_u32 v18, v2, 3, v18
MAV 92,12,148
TR 56,6,8512
s_lshl_b32 s62, s3, 1
MAV 92,28,156
buffer_load_dwordx4 v[204:207], v4, s[16:19], s52 offen offset:1024 sc1
v_add_u32 v18, s62, v18
MAV 76,28,152
TR 58,6,9024
v_mul_u32_u24 v18, 6144, v18
v_and_b32 v2, 7, v1
MAV 76,12,144
TR 60,6,8544
TR 62,6,9056
s_waitcnt vmcnt(8) lgkmcnt(8)
MAV 64,32,160
TR 0,6,16896
s_add_u32 s52, s78, 737280
v_lshl_add_u32 v18, v2, 4, v18
s_lshl_b32 s62, s9, 7
MAV 64,48,168
buffer_load_dwordx4 v[208:211], v4, s[16:19], s52 offen sc1
v_add_u32 v18, s62, v18
MAV 80,48,172
TR 2,6,17408
v_add_u32 v19, 1024, v18
MAV 80,32,164
TR 4,6,16928
TR 6,6,17440
v_add_u32 v20, 2048, v18
MAV 84,36,164
TR 16,6,25344
s_mul_i32 s59, s3, 3104
MAV 84,52,172
buffer_load_dwordx4 v[212:215], v4, s[16:19], s52 offen offset:1024 sc1
s_mov_b32 s58, 0
MAV 68,52,168
TR 18,6,25856
v_accvgpr_read_b32 v28, a224
v_add_f32 v32, v32, v28
MAV 68,36,160
TR 20,6,25376
TR 22,6,25888
s_waitcnt lgkmcnt(8)
MAV 72,40,160
TR 8,6,16960
s_add_u32 s52, s79, 851968
v_accvgpr_read_b32 v29, a225
MAV 72,56,168
buffer_load_dwordx4 v[216:219], v4, s[16:19], s52 offen sc1
v_add_f32 v33, v33, v29
v_accvgpr_read_b32 v28, a226
MAV 88,56,172
TR 10,6,17472
v_add_f32 v34, v34, v28
MAV 88,40,164
TR 12,6,16992
TR 14,6,17504
v_accvgpr_read_b32 v29, a227
MAV 92,44,164
TR 24,6,25408
v_add_f32 v35, v35, v29
MAV 92,60,172
buffer_load_dwordx4 v[220:223], v4, s[16:19], s52 offen offset:1024 sc1
v_accvgpr_read_b32 v28, a228
MAV 76,60,168
TR 26,6,25920
v_add_f32 v36, v36, v28
v_accvgpr_read_b32 v29, a229
MAV 76,44,160
TR 28,6,25440
TR 30,6,25952
s_waitcnt vmcnt(8) lgkmcnt(8)
MAV 64,0,176
TR 32,6,33792
v_add_f32 v37, v37, v29
MAV 64,16,184
TR 34,6,34304
v_accvgpr_read_b32 v28, a230
v_add_f32 v38, v38, v28
MAV 80,16,188
TR 36,6,33824
v_accvgpr_read_b32 v29, a231
MAV 80,0,180
TR 38,6,34336
v_add_f32 v39, v39, v29
MAV 84,4,180
TR 48,6,42240
v_accvgpr_read_b32 v28, a232
MAV 84,20,188
TR 50,6,42752
v_add_f32 v40, v40, v28
v_accvgpr_read_b32 v29, a233
MAV 68,20,184
TR 52,6,42272
MAV 68,4,176
TR 54,6,42784
v_add_f32 v41, v41, v29
s_waitcnt lgkmcnt(8)
MAV 72,8,176
TR 40,6,33856
v_accvgpr_read_b32 v28, a234
MAV 72,24,184
TR 42,6,34368
v_add_f32 v42, v42, v28
MAV 88,24,188
TR 44,6,33888
v_accvgpr_read_b32 v29, a235
MAV 88,8,180
TR 46,6,34400
v_add_f32 v43, v43, v29
v_accvgpr_read_b32 v28, a236
MAV 92,12,180
TR 56,6,42304
v_add_f32 v44, v44, v28
MAV 92,28,188
TR 58,6,42816
v_accvgpr_read_b32 v29, a237
MAV 76,28,184
TR 60,6,42336
v_add_f32 v45, v45, v29
MAV 76,12,176
TR 62,6,42848
v_accvgpr_read_b32 v28, a238
s_waitcnt vmcnt(4) lgkmcnt(8)
MAV 64,32,192
TR 0,6,50688
v_add_f32 v46, v46, v28
MAV 64,48,200
TR 2,6,51200
v_accvgpr_read_b32 v29, a239
v_add_f32 v47, v47, v29
MAV 80,48,204
TR 4,6,50720
v_accvgpr_read_b32 v28, a240
MAV 80,32,196
TR 6,6,51232
v_add_f32 v48, v48, v28
MAV 84,36,196
TR 16,6,59136
v_accvgpr_read_b32 v29, a241
MAV 84,52,204
TR 18,6,59648
v_add_f32 v49, v49, v29
v_accvgpr_read_b32 v28, a242
MAV 68,52,200
TR 20,6,59168
MAV 68,36,192
TR 22,6,59680
v_add_f32 v50, v50, v28
s_waitcnt lgkmcnt(8)
MAV 72,40,192
TR 8,6,50752
v_accvgpr_read_b32 v29, a243
MAV 72,56,200
TR 10,6,51264
v_add_f32 v51, v51, v29
MAV 88,56,204
TR 12,6,50784
v_accvgpr_read_b32 v28, a244
MAV 88,40,196
TR 14,6,51296
v_add_f32 v52, v52, v28
v_accvgpr_read_b32 v29, a245
MAV 92,44,196
TR 24,6,59200
v_add_f32 v53, v53, v29
MAV 92,60,204
TR 26,6,59712
v_accvgpr_read_b32 v28, a246
MAV 76,60,200
TR 28,6,59232
v_add_f32 v54, v54, v28
MAV 76,44,192
TR 30,6,59744
v_accvgpr_read_b32 v29, a247
s_waitcnt vmcnt(0) lgkmcnt(8)
MAV 64,0,208
TR 32,7,16896
v_add_f32 v55, v55, v29
MAV 64,16,216
TR 34,7,17408
v_accvgpr_read_b32 v28, a248
v_add_f32 v56, v56, v28
MAV 80,16,220
TR 36,7,16928
MAV 80,0,212
TR 38,7,17440
v_accvgpr_read_b32 v29, a249
v_add_f32 v57, v57, v29
MAV 84,4,212
TR 48,7,25344
v_accvgpr_read_b32 v28, a250
MAV 84,20,220
TR 50,7,25856
v_add_f32 v58, v58, v28
MAV 68,20,216
TR 52,7,25376
v_accvgpr_read_b32 v29, a251
MAV 68,4,208
TR 54,7,25888
v_add_f32 v59, v59, v29
s_waitcnt lgkmcnt(8)
MAV 72,8,208
TR 40,7,16960
MAV 72,24,216
TR 42,7,17472
v_accvgpr_read_b32 v28, a252
v_add_f32 v60, v60, v28
MAV 88,24,220
TR 44,7,16992
v_accvgpr_read_b32 v29, a253
MAV 88,8,212
TR 46,7,17504
v_add_f32 v61, v61, v29
MAV 92,12,212
TR 56,7,25408
v_accvgpr_read_b32 v28, a254
MAV 92,28,220
TR 58,7,25920
v_add_f32 v62, v62, v28
MAV 76,28,216
TR 60,7,25440
v_accvgpr_read_b32 v29, a255
MAV 76,12,208
TR 62,7,25952
v_add_f32 v63, v63, v29
s_waitcnt lgkmcnt(8)
MAV 32,32,112
TR 0,7,33792
v_cvt_pk_bf16_f32 v232, v64, v65
MAV 32,48,120
TR 2,7,34304
v_cvt_pk_bf16_f32 v233, v66, v67
v_cvt_pk_bf16_f32 v234, v68, v69
MAV 48,48,124
TR 4,7,33824
v_cvt_pk_bf16_f32 v235, v70, v71
MAV 48,32,116
TR 6,7,34336
buffer_store_dwordx4 v[232:235], v11, s[16:19], s69 offen sc1
s_add_u32 s69, s69, 131072
MAV 52,36,116
TR 16,7,42240
v_cvt_pk_bf16_f32 v236, v72, v73
MAV 52,52,124
TR 18,7,42752
v_cvt_pk_bf16_f32 v237, v74, v75
v_cvt_pk_bf16_f32 v238, v76, v77
MAV 36,52,120
TR 20,7,42272
v_cvt_pk_bf16_f32 v239, v78, v79
MAV 36,36,112
TR 22,7,42784
buffer_store_dwordx4 v[236:239], v11, s[16:19], s69 offen sc1
s_waitcnt lgkmcnt(8)
MAV 40,40,112
TR 8,7,33856
s_add_u32 s69, s69, -130048
MAV 40,56,120
TR 10,7,34368
v_cvt_pk_bf16_f32 v240, v80, v81
v_cvt_pk_bf16_f32 v241, v82, v83
MAV 56,56,124
TR 12,7,33888
v_cvt_pk_bf16_f32 v242, v84, v85
MAV 56,40,116
TR 14,7,34400
v_cvt_pk_bf16_f32 v243, v86, v87
buffer_store_dwordx4 v[240:243], v11, s[16:19], s69 offen sc1
MAV 60,44,116
TR 24,7,42304
s_add_u32 s69, s69, 131072
MAV 60,60,124
TR 26,7,42816
v_cvt_pk_bf16_f32 v244, v88, v89
v_cvt_pk_bf16_f32 v245, v90, v91
MAV 44,60,120
TR 28,7,42336
v_cvt_pk_bf16_f32 v246, v92, v93
MAV 44,44,112
TR 30,7,42848
v_cvt_pk_bf16_f32 v247, v94, v95
buffer_store_dwordx4 v[244:247], v11, s[16:19], s69 offen sc1
s_waitcnt lgkmcnt(8)
MAV 32,0,128
TR 32,7,50688
MAV 32,16,136
TR 34,7,51200
MAV 48,16,140
TR 36,7,50720
MAV 48,0,132
TR 38,7,51232
MAV 52,4,132
TR 48,7,59136
MAV 52,20,140
TR 50,7,59648
MAV 36,20,136
TR 52,7,59168
MAV 36,4,128
TR 54,7,59680
s_waitcnt lgkmcnt(8)
MAV 40,8,128
TR 40,7,50752
MAV 40,24,136
TR 42,7,51264
MAV 56,24,140
TR 44,7,50784
MAV 56,8,132
TR 46,7,51296
MAV 60,12,132
TR 56,7,59200
MAV 60,28,140
TR 58,7,59712
MAV 44,28,136
TR 60,7,59232
MAV 44,12,128
TR 62,7,59744
v_add_u32 v7, s57, v7
s_waitcnt lgkmcnt(8)
MAV 32,32,144
ds_read_b64_tr_b16 a[0:1], v7
MAV 32,48,152
TR 2,7,512
MAV 48,48,156
TR 4,7,32
MAV 48,32,148
TR 6,7,544
MAV 52,36,148
TR 16,7,8448
MAV 52,52,156
TR 18,7,8960
MAV 36,52,152
TR 20,7,8480
MAV 36,36,144
TR 22,7,8992
s_waitcnt lgkmcnt(8)
MAV 40,40,144
TR 8,7,64
MAV 40,56,152
TR 10,7,576
MAV 56,56,156
TR 12,7,96
MAV 56,40,148
TR 14,7,608
MAV 60,44,148
TR 24,7,8512
MAV 60,60,156
TR 26,7,9024
MAV 44,60,152
TR 28,7,8544
MAV 44,44,144
TR 30,7,9056
s_waitcnt lgkmcnt(8)
s_barrier
MAV 32,0,160
TR 32,7,16896
TR 34,7,17408
MAV 32,16,168
s_waitcnt vmcnt(0)
buffer_atomic_add v13, v12, s[16:19], s71 offen
MAV 48,16,172
TR 36,7,16928
TR 38,7,17440
MAV 48,0,164
TR 48,7,25344
MAV 52,4,164
TR 50,7,25856
s_add_u32 m0, s59, 117248
MAV 52,20,172
TR 52,7,25376
buffer_load_dwordx4 v18, s[20:23], s58 offen lds
MAV 36,20,168
TR 54,7,25888
MAV 36,4,160
TR 40,7,16960
s_waitcnt lgkmcnt(9)
MAV 40,8,160
TR 42,7,17472
MAV 40,24,168
TR 44,7,16992
buffer_load_dwordx4 v19, s[20:23], s58 offen offset:1024 lds
MAV 56,24,172
TR 46,7,17504
MAV 56,8,164
TR 56,7,25408
buffer_load_dwordx4 v20, s[20:23], s58 offen offset:2048 lds
MAV 60,12,164
s_add_u32 s58, s58, 196608
s_add_u32 m0, s59, 129664
MAV 60,28,172
TR 58,7,25920
buffer_load_dwordx4 v18, s[20:23], s58 offen lds
MAV 44,28,168
TR 60,7,25440
MAV 44,12,160
TR 62,7,25952
s_waitcnt lgkmcnt(8)
MAV 32,32,176
TR 0,7,33792
TR 2,7,34304
MAV 32,48,184
buffer_atomic_add v15, v12, s[16:19], s70 offen sc0
MAV 48,48,188
TR 4,7,33824
TR 6,7,34336
MAV 48,32,180
TR 16,7,42240
MAV 52,36,180
TR 18,7,42752
MAV 52,52,188
TR 20,7,42272
buffer_load_dwordx4 v19, s[20:23], s58 offen offset:1024 lds
MAV 36,52,184
TR 22,7,42784
MAV 36,36,176
TR 8,7,33856
s_waitcnt lgkmcnt(9)
MAV 40,40,176
TR 10,7,34368
MAV 40,56,184
TR 12,7,33888
buffer_load_dwordx4 v20, s[20:23], s58 offen offset:2048 lds
MAV 56,56,188
TR 14,7,34400
s_add_u32 s58, s58, 196608
s_add_u32 m0, s59, 67584
MAV 56,40,180
buffer_load_dwordx4 v18, s[20:23], s58 offen lds
MAV 60,44,180
TR 24,7,42304
MAV 60,60,188
TR 26,7,42816
buffer_load_dwordx4 v19, s[20:23], s58 offen offset:1024 lds
MAV 44,60,184
TR 28,7,42336
MAV 44,44,176
TR 30,7,42848
s_waitcnt vmcnt(4)
v_cmp_ne_u32 vcc, 0, v15
s_nop 0
s_cbranch_vccz .Lxs51
.Lxs51b:
.Lpad11:
s_cbranch_execz .Lnopoll37r
s_waitcnt lgkmcnt(8)
MAV 32,0,192
TR 32,7,50688
TR 34,7,51200
MAV 32,16,200
TR 36,7,50720
buffer_load_dwordx4 v[232:235], v11, s[16:19], s68 offen sc1
MAV 48,16,204
TR 38,7,51232
s_add_u32 s68, s68, 131072
MAV 48,0,196
TR 48,7,59136
buffer_load_dwordx4 v[236:239], v11, s[16:19], s68 offen sc1
MAV 52,4,196
TR 50,7,59648
s_add_u32 s68, s68, -130048
MAV 52,20,204
TR 52,7,59168
buffer_load_dwordx4 v[240:243], v11, s[16:19], s68 offen sc1
MAV 36,20,200
TR 54,7,59680
s_add_u32 s68, s68, 131072
MAV 36,4,192
TR 40,7,50752
s_waitcnt lgkmcnt(9)
MAV 40,8,192
TR 42,7,51264
TR 44,7,50784
MAV 40,24,200
buffer_load_dwordx4 v[244:247], v11, s[16:19], s68 offen sc1
MAV 56,24,204
TR 46,7,51296
TR 56,7,59200
MAV 56,8,196
TR 58,7,59712
buffer_load_dwordx4 v20, s[20:23], s58 offen offset:2048 lds
MAV 60,12,196
s_add_u32 s58, s58, 196608
s_add_u32 m0, s59, 80000
MAV 60,28,204
TR 60,7,59232
buffer_load_dwordx4 v18, s[20:23], s58 offen lds
MAV 44,28,200
TR 62,7,59744
MAV 44,12,192
buffer_load_dwordx4 v19, s[20:23], s58 offen offset:1024 lds
buffer_load_dwordx4 v20, s[20:23], s58 offen offset:2048 lds
s_add_u32 s58, s58, 196608
s_waitcnt lgkmcnt(8)
MAV 32,32,208
s_add_u32 m0, s59, 92416
MAV 32,48,216
buffer_load_dwordx4 v18, s[20:23], s58 offen lds
MAV 48,48,220
MAV 48,32,212
MAV 52,36,212
MAV 52,52,220
MAV 36,52,216
MAV 36,36,208
s_waitcnt lgkmcnt(0)
MAV 40,40,208
MAV 40,56,216
buffer_load_dwordx4 v19, s[20:23], s58 offen offset:1024 lds
MAV 56,56,220
MAV 56,40,212
buffer_load_dwordx4 v20, s[20:23], s58 offen offset:2048 lds
MAV 60,44,212
s_add_u32 s58, s58, 196608
MAV 60,60,220
MAV 44,60,216
MAV 44,44,208
s_waitcnt vmcnt(10)
v_mfma_f32_16x16x32_bf16 v[32:35], v[226:229], v[232:235], v[32:35]
s_lshl_b32 s64, s6, 14
s_lshl_b32 s65, s49, 13
s_add_u32 s64, s64, s65
v_mfma_f32_16x16x32_bf16 v[36:39], v[224:227], v[232:235], v[36:39]
s_lshl_b32 s65, s7, 9
s_add_u32 s64, s64, s65
s_lshl_b32 s65, s48, 8
s_waitcnt vmcnt(9)
v_mfma_f32_16x16x32_bf16 v[40:43], v[226:229], v[236:239], v[40:43]
s_add_u32 s64, s64, s65
s_add_u32 s64, s64, 62914560
v_and_b32 v152, 31, v1
v_mfma_f32_16x16x32_bf16 v[44:47], v[224:227], v[236:239], v[44:47]
s_lshl_b32 s62, s7, 18
v_lshlrev_b32 v152, 3, v152
v_lshrrev_b32 v153, 5, v1
s_waitcnt vmcnt(8)
v_mfma_f32_16x16x32_bf16 v[48:51], v[226:229], v[240:243], v[48:51]
s_add_u32 s62, s62, 33554432
v_lshl_add_u32 v152, v153, 28, v152
s_add_u32 s63, s62, 131072
v_mfma_f32_16x16x32_bf16 v[52:55], v[224:227], v[240:243], v[52:55]
v_cvt_pk_bf16_f32 v128, v32, v33
v_cvt_pk_bf16_f32 v129, v34, v35
s_waitcnt vmcnt(7)
v_mfma_f32_16x16x32_bf16 v[56:59], v[226:229], v[244:247], v[56:59]
v_cvt_pk_bf16_f32 v130, v36, v37
v_cvt_pk_bf16_f32 v131, v38, v39
v_mfma_f32_16x16x32_bf16 v[60:63], v[224:227], v[244:247], v[60:63]
buffer_store_dwordx4 v[128:131], v4, s[16:19], s62 offen sc1
v_cvt_pk_bf16_f32 v132, v40, v41
v_cvt_pk_bf16_f32 v133, v42, v43
v_cvt_pk_bf16_f32 v134, v44, v45
v_cvt_pk_bf16_f32 v135, v46, v47
v_cvt_pk_bf16_f32 v136, v48, v49
v_cvt_pk_bf16_f32 v137, v50, v51
v_cvt_pk_bf16_f32 v138, v52, v53
v_cvt_pk_bf16_f32 v139, v54, v55
v_cvt_pk_bf16_f32 v140, v56, v57
v_cvt_pk_bf16_f32 v141, v58, v59
v_cvt_pk_bf16_f32 v142, v60, v61
v_cvt_pk_bf16_f32 v143, v62, v63
v_pk_mul_f32 v[146:147], v[32:33], v[32:33]
buffer_store_dwordx4 v[132:135], v4, s[16:19], s63 offen sc1
v_pk_mul_f32 v[150:151], v[48:49], v[48:49]
v_pk_fma_f32 v[146:147], v[34:35], v[34:35], v[146:147]
v_pk_add_f32 v[144:145], v[32:33], v[34:35]
v_pk_fma_f32 v[150:151], v[50:51], v[50:51], v[150:151]
v_pk_add_f32 v[148:149], v[48:49], v[50:51]
v_pk_fma_f32 v[146:147], v[36:37], v[36:37], v[146:147]
v_pk_add_f32 v[144:145], v[144:145], v[36:37]
v_pk_fma_f32 v[150:151], v[52:53], v[52:53], v[150:151]
v_pk_add_f32 v[148:149], v[148:149], v[52:53]
v_pk_fma_f32 v[146:147], v[38:39], v[38:39], v[146:147]
v_pk_add_f32 v[144:145], v[144:145], v[38:39]
v_pk_fma_f32 v[150:151], v[54:55], v[54:55], v[150:151]
v_pk_add_f32 v[148:149], v[148:149], v[54:55]
buffer_store_dwordx4 v[136:139], v4, s[16:19], s62 offen offset:1024 sc1
v_pk_fma_f32 v[146:147], v[40:41], v[40:41], v[146:147]
v_pk_add_f32 v[144:145], v[144:145], v[40:41]
v_pk_fma_f32 v[150:151], v[56:57], v[56:57], v[150:151]
v_pk_add_f32 v[148:149], v[148:149], v[56:57]
v_pk_fma_f32 v[146:147], v[42:43], v[42:43], v[146:147]
v_pk_add_f32 v[144:145], v[144:145], v[42:43]
v_pk_fma_f32 v[150:151], v[58:59], v[58:59], v[150:151]
v_pk_add_f32 v[148:149], v[148:149], v[58:59]
v_pk_fma_f32 v[146:147], v[44:45], v[44:45], v[146:147]
v_pk_add_f32 v[144:145], v[144:145], v[44:45]
v_pk_fma_f32 v[150:151], v[60:61], v[60:61], v[150:151]
v_pk_add_f32 v[148:149], v[148:149], v[60:61]
v_pk_fma_f32 v[146:147], v[46:47], v[46:47], v[146:147]
buffer_store_dwordx4 v[140:143], v4, s[16:19], s63 offen offset:1024 sc1
v_pk_add_f32 v[144:145], v[144:145], v[46:47]
v_pk_fma_f32 v[150:151], v[62:63], v[62:63], v[150:151]
v_pk_add_f32 v[148:149], v[148:149], v[62:63]
v_add_f32 v144, v144, v145
v_add_f32 v146, v146, v147
v_add_f32 v148, v148, v149
v_add_f32 v150, v150, v151
s_nop 0
v_permlane16_swap_b32 v144, v148
v_permlane16_swap_b32 v146, v150
v_add_f32 v144, v144, v148
v_add_f32 v146, v146, v150
s_nop 1
v_permlane32_swap_b32 v144, v146
v_add_f32 v144, v144, v146
s_nop 1
v_permlane32_swap_b32 v144, v145
buffer_store_dwordx2 v[144:145], v152, s[16:19], s64 offen sc1
s_nop 1
v_accvgpr_write_b32 a224, v32
v_accvgpr_write_b32 a225, v33
v_accvgpr_write_b32 a226, v34
v_accvgpr_write_b32 a227, v35
v_accvgpr_write_b32 a228, v36
v_accvgpr_write_b32 a229, v37
v_accvgpr_write_b32 a230, v38
v_accvgpr_write_b32 a231, v39
v_accvgpr_write_b32 a232, v40
v_accvgpr_write_b32 a233, v41
v_accvgpr_write_b32 a234, v42
v_accvgpr_write_b32 a235, v43
v_accvgpr_write_b32 a236, v44
v_accvgpr_write_b32 a237, v45
v_accvgpr_write_b32 a238, v46
v_accvgpr_write_b32 a239, v47
v_accvgpr_write_b32 a240, v48
v_accvgpr_write_b32 a241, v49
v_accvgpr_write_b32 a242, v50
v_accvgpr_write_b32 a243, v51
v_accvgpr_write_b32 a244, v52
v_accvgpr_write_b32 a245, v53
v_accvgpr_write_b32 a246, v54
v_accvgpr_write_b32 a247, v55
v_accvgpr_write_b32 a248, v56
v_accvgpr_write_b32 a249, v57
v_accvgpr_write_b32 a250, v58
v_accvgpr_write_b32 a251, v59
v_accvgpr_write_b32 a252, v60
v_accvgpr_write_b32 a253, v61
v_accvgpr_write_b32 a254, v62
v_accvgpr_write_b32 a255, v63
s_lshl_b32 s62, s3, 11
s_add_u32 s62, s62, s85
v_lshl_add_u32 v21, v1, 4, s62
v_lshrrev_b32 v2, 3, v1
v_cmp_eq_u32 vcc, 3, v2
v_add_u32 v2, 67108480, v21
s_nop 0
v_cndmask_b32 v21, v21, v2, vcc
s_sub_u32 s62, s86, 2048
v_lshl_add_u32 v22, v0, 2, s62
v_lshrrev_b32 v2, 5, v0
v_cmp_eq_u32 vcc, 3, v2
v_add_u32 v2, 67108480, v22
s_nop 0
v_cndmask_b32 v22, v22, v2, vcc
s_mul_i32 s62, s48, 4608
v_lshl_add_u32 v23, v1, 4, s62
v_lshrrev_b32 v24, 4, v1
v_mul_u32_u24 v24, 2304, v24
v_and_b32 v2, 15, v1
v_lshl_add_u32 v24, v2, 4, v24
s_mov_b32 s52, 33554432
s_mov_b32 s54, s58
s_mov_b32 s56, s59
s_mul_i32 s55, s3, 2304
v_bfe_u32 v25, v1, 3, 2
v_mul_u32_u24 v25, 3104, v25
v_bfe_u32 v2, v1, 2, 1
v_lshl_add_u32 v25, v2, 7, v25
v_bfe_u32 v2, v1, 5, 1
v_lshl_add_u32 v25, v2, 8, v25
v_and_b32 v2, 3, v1
v_lshl_add_u32 v25, v2, 3, v25
s_lshl_b32 s62, s49, 6
s_add_u32 s62, s62, 67584
v_add_u32 v25, s62, v25
s_lshl_b32 s62, s8, 1
s_add_u32 s62, s62, s3
s_lshr_b32 s63, s50, 2
s_cmp_lt_u32 s3, 2
s_cselect_b32 s62, s62, s63
s_lshl_b32 s62, s62, 13
s_cmp_eq_u32 s3, 3
s_cselect_b32 s62, 268435456, s62
v_lshl_add_u32 v26, v1, 4, s62
s_lshr_b32 s63, s20, 7
s_sub_u32 s63, 3, s63
s_and_b32 s63, s63, 7
s_and_b32 s62, s9, 8
s_add_u32 s63, s63, s62
s_lshl_b32 s62, s5, 2
s_add_u32 s62, s62, s3
s_mul_i32 s62, s62, 12288
s_lshl_b32 s64, s63, 7
s_add_u32 s62, s62, s64
s_xor_b32 s63, s63, s9
s_cmp_lt_u32 s63, 4
s_cselect_b32 s62, s62, 16777216
v_lshrrev_b32 v14, 3, v1
v_min_u32 v14, 5, v14
v_lshl_add_u32 v14, v14, 11, s62
s_mov_b32 s44, 983040
buffer_load_dword v27, v14, s[20:23], s44 offen
s_mov_b32 s44, 2555904
s_mul_i32 s59, s3, 2080
s_and_b32 s87, s6, 3
s_lshl_b32 s87, s87, 17
v_bfe_u32 v5, v1, 3, 1
v_lshrrev_b32 v2, 4, v1
v_lshl_add_u32 v5, v2, 3, v5
s_lshl_b32 s62, s3, 1
v_add_u32 v5, s62, v5
v_mul_u32_u24 v5, 2048, v5
v_and_b32 v2, 7, v1
v_lshl_add_u32 v5, v2, 4, v5
s_lshl_b32 s62, s7, 7
v_add_u32 v5, s62, v5
v_add_u32 v6, 64512, v5
s_lshl_b32 s62, s6, 10
s_add_u32 s62, s62, 30474240
s_lshl_b32 s64, s8, 10
s_add_u32 s64, s64, 30474240
s_lshr_b32 s67, s9, 1
s_and_b32 s67, s67, 3
s_lshl_b32 s67, s67, 7
s_add_u32 s64, s64, s67
s_lshr_b32 s65, s50, 3
s_lshl_b32 s65, s65, 10
s_add_u32 s65, s65, 30474240
s_lshr_b32 s67, s9, 1
s_and_b32 s67, s67, 3
s_lshl_b32 s67, s67, 7
s_add_u32 s65, s65, s67
v_lshl_add_u32 v252, v1, 7, s62
v_mov_b32 v253, s64
v_mov_b32 v255, 1
v_writelane_b32 v253, s65, 1
s_waitcnt vmcnt(1) lgkmcnt(0)
s_cmp_lg_u32 s3, 1
s_barrier
s_cbranch_scc1 .Lfirst54
s_mov_b64 exec, 15
buffer_atomic_add v255, v252, s[16:19], 0 offen
s_mov_b64 exec, 3
v_mov_b32 v254, 0
buffer_atomic_add v254, v253, s[16:19], 0 offen sc0
s_mov_b64 exec, -1
.Lfirst54:
TR 80,25,49664
TR 82,25,50176
TR 84,25,62080
TR 86,25,62592
TR 88,25,50688
TR 90,25,51200
TR 92,25,63104
TR 94,25,63616
TR 96,25,51712
TR 98,25,52224
TR 100,25,64128
TR 102,25,64640
v_lshrrev_b32 v2, 4, v1
v_lshlrev_b32 v2, 2, v2
v_and_b32 v13, 15, v1
v_sub_u32 v2, v13, v2
v_mov_b32 v13, 0xff61b1e6
v_subrev_u32 v54, 0, v2
v_cmp_gt_u32 vcc, 8, v54
s_nop 1
v_cndmask_b32 v50, v13, 0, vcc
v_cmp_gt_i32 vcc, -8, v54
s_nop 1
v_cndmask_b32 v46, v13, 0, vcc
v_subrev_u32 v54, 1, v2
v_cmp_gt_u32 vcc, 8, v54
s_nop 1
v_cndmask_b32 v51, v13, 0, vcc
v_cmp_gt_i32 vcc, -8, v54
s_nop 1
v_cndmask_b32 v47, v13, 0, vcc
v_subrev_u32 v54, 2, v2
v_cmp_gt_u32 vcc, 8, v54
s_nop 1
v_cndmask_b32 v52, v13, 0, vcc
v_cmp_gt_i32 vcc, -8, v54
s_nop 1
v_cndmask_b32 v48, v13, 0, vcc
v_subrev_u32 v54, 3, v2
v_cmp_gt_u32 vcc, 8, v54
s_nop 1
v_cndmask_b32 v53, v13, 0, vcc
v_cmp_gt_i32 vcc, -8, v54
s_nop 1
v_cndmask_b32 v49, v13, 0, vcc
s_cmp_lt_u32 s8, 2
s_cselect_b64 vcc, -1, 0
v_cndmask_b32 v54, v46, v13, vcc
v_cndmask_b32 v55, v47, v13, vcc
v_cndmask_b32 v56, v48, v13, vcc
v_cndmask_b32 v57, v49, v13, vcc
v_mov_b64 v[60:61], 0
v_mov_b64 v[62:63], 0
v_mov_b64 v[64:65], 0
v_mov_b64 v[66:67], 0
v_mov_b64 v[68:69], 0
v_mov_b64 v[70:71], 0
v_mov_b64 v[72:73], 0
v_mov_b64 v[74:75], 0
v_mov_b64 v[76:77], 0
v_mov_b64 v[78:79], 0
v_mov_b64 v[80:81], 0
v_mov_b64 v[82:83], 0
v_mov_b64 v[84:85], 0
v_mov_b64 v[86:87], 0
v_mov_b64 v[88:89], 0
v_mov_b64 v[90:91], 0
v_mov_b64 v[92:93], 0
v_mov_b64 v[94:95], 0
v_mov_b64 v[96:97], 0
v_mov_b64 v[98:99], 0
v_mov_b64 v[100:101], 0
v_mov_b64 v[102:103], 0
v_mov_b64 v[104:105], 0
v_mov_b64 v[106:107], 0
v_mov_b64 v[108:109], 0
v_mov_b64 v[110:111], 0
v_mov_b64 v[112:113], 0
v_mov_b64 v[114:115], 0
v_mov_b64 v[116:117], 0
v_mov_b64 v[118:119], 0
v_mov_b64 v[120:121], 0
v_mov_b64 v[122:123], 0
v_mov_b64 v[124:125], 0
v_mov_b64 v[126:127], 0
v_mov_b64 v[128:129], 0
v_mov_b64 v[130:131], 0
v_mov_b64 v[132:133], 0
v_mov_b64 v[134:135], 0
v_mov_b64 v[136:137], 0
v_mov_b64 v[138:139], 0
v_mov_b64 v[140:141], 0
v_mov_b64 v[142:143], 0
v_mov_b64 v[144:145], 0
v_mov_b64 v[146:147], 0
v_mov_b64 v[148:149], 0
v_mov_b64 v[150:151], 0
v_mov_b64 v[152:153], 0
v_mov_b64 v[154:155], 0
v_mov_b64 v[156:157], 0
v_mov_b64 v[158:159], 0
v_mov_b64 v[160:161], 0
v_mov_b64 v[162:163], 0
v_mov_b64 v[164:165], 0
v_mov_b64 v[166:167], 0
v_mov_b64 v[168:169], 0
v_mov_b64 v[170:171], 0
v_mov_b64 v[172:173], 0
v_mov_b64 v[174:175], 0
s_mov_b32 s75, 62914560
v_and_b32 v10, 15, v1
v_lshlrev_b32 v12, 2, v10
v_lshlrev_b32 v10, 4, v10
v_add_u32 v10, 152576, v10
v_lshrrev_b32 v11, 4, v1
v_lshlrev_b32 v11, 4, v11
s_lshl_b32 s62, s49, 7
s_add_u32 s62, s62, 158720
v_add_u32 v12, s62, v12
v_add_u32 v13, s62, v11
v_add_u32 v11, 156672, v11
s_lshl_b32 s62, s3, 11
s_add_u32 s62, s62, 143360
v_lshl_add_u32 v8, v1, 4, s62
v_xor_b32 v9, 2048, v8
v_mov_b32 v248, 0x3f803f80
v_mov_b32 v249, 0x3f803f80
v_mov_b32 v250, 0x3f803f80
v_mov_b32 v251, 0x3f803f80
v_and_b32 v7, 31, v1
v_lshrrev_b32 v2, 5, v1
v_lshl_add_u32 v7, v7, 1, v2
v_and_b32 v2, 0xc0, v0
v_add_u32 v7, v7, v2
v_lshlrev_b32 v17, 2, v7
v_add_u32 v17, 156672, v17
v_lshlrev_b32 v7, 4, v7
v_add_u32 v7, 152576, v7
s_lshl_b32 s74, s9, 1
s_add_u32 s74, s74, s49
s_lshl_b32 s74, s74, 17
s_add_u32 s74, s74, s85
s_lshl_b32 s63, s48, 12
s_add_u32 s74, s74, s63
s_add_u32 s74, s74, 37748736
s_mov_b32 s62, 0
v_lshl_add_u32 v4, v1, 4, s62
v_lshrrev_b32 v2, 3, v1
v_cmp_eq_u32 vcc, 3, v2
v_add_u32 v2, 67108480, v4
s_nop 0
v_cndmask_b32 v4, v4, v2, vcc
ds_read_b128 v[28:31], v13
ds_read_b128 v[32:35], v13 offset:64
ds_read_b128 v[36:39], v13 offset:256
ds_read_b128 v[40:43], v13 offset:320
ds_read_b32 v44, v12 offset:512
ds_read_b32 v45, v12 offset:576
s_waitcnt lgkmcnt(0)
s_cmp_lg_u32 s3, 1
s_cbranch_scc1 .Lnopoll53
s_mov_b64 exec, 3
s_mov_b32 s15, 0
.Lpoll52:
v_mov_b32 v255, 0
buffer_atomic_add v255, v253, s[16:19], 0 offen sc0
s_waitcnt vmcnt(1)
v_cmp_gt_u32 vcc, 16, v254
s_add_u32 s15, s15, 1
s_cbranch_vccz .Lnopoll53r
v_mov_b32 v254, 0
buffer_atomic_add v254, v253, s[16:19], 0 offen sc0
s_waitcnt vmcnt(1)
v_cmp_gt_u32 vcc, 16, v255
s_add_u32 s15, s15, 1
s_cbranch_vccz .Lnopoll53r
s_cmp_le_u32 s15, 100000
s_cbranch_scc1 .Lpoll52
s_branch .Lnopoll53r
.Lnopoll53:
s_mov_b64 exec, 0
s_cmp_eq_u32 s3, 2
s_cbranch_scc1 .Lpad12
s_cmp_eq_u32 s3, 3
s_cbranch_scc1 .Lpad13
s_branch .Lpad14
.Lnopoll53r:
s_mov_b64 exec, -1
s_barrier
s_cmp_eq_u32 s48, 1
s_cbranch_scc1 .Lqkv55
s_add_u32 m0, s55, 36864
s_nop 0
buffer_load_dwordx4 v21, s[16:19], s52 offen sc1 lds
buffer_load_dwordx4 v21, s[16:19], s52 offen offset:1024 sc1 lds
buffer_load_dword v22, s[16:19], s52 offen offset:2048 sc1 lds
s_add_u32 s52, s52, 131072
s_add_u32 m0, s55, 46080
s_nop 0
buffer_load_dwordx4 v21, s[16:19], s52 offen sc1 lds
buffer_load_dwordx4 v21, s[16:19], s52 offen offset:1024 sc1 lds
buffer_load_dword v22, s[16:19], s52 offen offset:2048 sc1 lds
s_add_u32 s52, s52, 131072
s_add_u32 m0, s55, 0
s_nop 0
buffer_load_dwordx4 v21, s[16:19], s52 offen sc1 lds
buffer_load_dwordx4 v21, s[16:19], s52 offen offset:1024 sc1 lds
buffer_load_dword v22, s[16:19], s52 offen offset:2048 sc1 lds
s_add_u32 s52, s52, 131072
s_add_u32 m0, s55, 9216
s_nop 0
buffer_load_dwordx4 v21, s[16:19], s52 offen sc1 lds
buffer_load_dwordx4 v21, s[16:19], s52 offen offset:1024 sc1 lds
buffer_load_dword v22, s[16:19], s52 offen offset:2048 sc1 lds
s_add_u32 s52, s52, 131072
s_add_u32 m0, s55, 18432
s_nop 0
buffer_load_dwordx4 v21, s[16:19], s52 offen sc1 lds
buffer_load_dwordx4 v21, s[16:19], s52 offen offset:1024 sc1 lds
buffer_load_dword v22, s[16:19], s52 offen offset:2048 sc1 lds
s_add_u32 s52, s52, 131072
s_add_u32 m0, s55, 27648
s_nop 0
buffer_load_dwordx4 v21, s[16:19], s52 offen sc1 lds
buffer_load_dwordx4 v21, s[16:19], s52 offen offset:1024 sc1 lds
buffer_load_dword v22, s[16:19], s52 offen offset:2048 sc1 lds
s_add_u32 s52, s52, 131072
s_waitcnt vmcnt(12)
s_barrier
RD 0,23,36864
RD 4,23,37888
RD 8,23,39168
RD 12,23,40192
RD 16,24,38912
RD 20,23,46080
RD 24,23,47104
RD 28,23,48384
RD 32,23,49408
RD 36,24,48128
s_waitcnt lgkmcnt(0)
s_mov_b32 s15, -2
.p2align 6
.Lk57:
s_waitcnt vmcnt(9) lgkmcnt(8)
s_barrier
MAA 60,80,0
TR 104,25,49696
s_add_u32 m0, s56, 104832
MAA 60,84,20
buffer_load_dwordx4 v18, s[20:23], s54 offen lds
MAA 64,84,24
TR 106,25,50208
v_add_f32 v164, v164, v168
MAA 64,80,4
TR 108,25,62112
MAA 68,80,8
TR 110,25,62624
MAA 68,84,28
buffer_load_dwordx4 v19, s[20:23], s54 offen offset:1024 lds
MAA 72,84,32
TR 112,25,50720
v_add_f32 v165, v165, v169
MAA 72,80,12
TR 114,25,51232
s_waitcnt lgkmcnt(6)
MAA 156,88,16
TR 116,25,63136
MAA 156,92,36
buffer_load_dwordx4 v20, s[20:23], s54 offen offset:2048 lds
MAA 104,92,32
s_add_u32 s54, s54, 196608
s_add_u32 m0, s55, 36864
MAA 104,88,12
buffer_load_dwordx4 v21, s[16:19], s52 offen sc1 lds
MAA 100,88,8
TR 118,25,63648
MAA 100,92,28
TR 120,25,51744
v_add_f32 v166, v166, v170
MAA 96,92,24
TR 122,25,52256
MAA 96,88,4
buffer_load_dwordx4 v21, s[16:19], s52 offen offset:1024 sc1 lds
MAA 92,88,0
TR 124,25,64160
MAA 92,92,20
TR 126,25,64672
v_add_f32 v167, v167, v171
MAA 124,20,100
ds_read_b128 a[40:43], v23
MAA 124,0,96
buffer_load_dword v22, s[16:19], s52 offen offset:2048 sc1 lds
MAA 128,4,96
RD 44,23,1024
s_add_u32 s52, s52, 131072
MAA 128,24,100
buffer_load_dword v27, v14, s[20:23], s44 offen
MAA 132,28,100
RD 48,23,2304
s_add_u32 s44, s44, 1572864
MAA 132,8,96
RD 52,23,3328
MAA 136,12,96
RD 56,24,2048
MAA 136,32,100
s_waitcnt vmcnt(13) lgkmcnt(5)
s_barrier
MAA 76,104,0
RD 60,23,9216
s_add_u32 m0, s56, 117248
MAA 76,108,20
buffer_load_dwordx4 v18, s[20:23], s54 offen lds
MAA 80,108,24
RD 64,23,10240
MAA 80,104,4
RD 68,23,11520
MAA 84,104,8
RD 72,23,12544
MAA 84,108,28
buffer_load_dwordx4 v19, s[20:23], s54 offen offset:1024 lds
MAA 88,108,32
RD 76,24,11264
MAA 88,104,12
buffer_load_dwordx4 v20, s[20:23], s54 offen offset:2048 lds
MAA 160,112,16
ds_read_b64_tr_b16 a[80:81], v25
s_add_u32 s54, s54, 196608
MAA 160,116,36
TR 82,25,512
MAA 120,116,32
TR 84,25,12416
s_add_u32 m0, s55, 46080
MAA 120,112,12
buffer_load_dwordx4 v21, s[16:19], s52 offen sc1 lds
MAA 116,112,8
TR 86,25,12928
MAA 116,116,28
TR 88,25,1024
MAA 112,116,24
TR 90,25,1536
MAA 112,112,4
buffer_load_dwordx4 v21, s[16:19], s52 offen offset:1024 sc1 lds
MAA 108,112,0
TR 92,25,13440
.Lpad12:
s_cbranch_execz .Lpad15
MAA 108,116,20
TR 94,25,13952
MAA 140,20,124
TR 96,25,2048
MAA 140,0,120
buffer_load_dword v22, s[16:19], s52 offen offset:2048 sc1 lds
MAA 144,4,120
TR 98,25,2560
s_add_u32 s52, s52, 131072
MAA 144,24,124
buffer_load_dwordx4 v[168:171], v26, s[16:19], s75 offen sc1
MAA 148,28,124
TR 100,25,14464
MAA 148,8,120
TR 102,25,14976
MAA 152,12,120
MAA 152,32,124
s_waitcnt vmcnt(17) lgkmcnt(8)
s_barrier
MAA 60,80,40
TR 104,25,32
s_add_u32 m0, s56, 129664
MAA 60,84,60
buffer_load_dwordx4 v18, s[20:23], s54 offen lds
MAA 64,84,64
TR 106,25,544
v_add_f32 v164, v164, v172
MAA 64,80,44
TR 108,25,12448
MAA 68,80,48
TR 110,25,12960
MAA 68,84,68
buffer_load_dwordx4 v19, s[20:23], s54 offen offset:1024 lds
MAA 72,84,72
TR 112,25,1056
MAA 72,80,52
TR 114,25,1568
s_waitcnt lgkmcnt(6)
MAA 156,88,56
TR 116,25,13472
v_add_f32 v165, v165, v173
MAA 156,92,76
buffer_load_dwordx4 v20, s[20:23], s54 offen offset:2048 lds
MAA 104,92,72
TR 118,25,13984
s_add_u32 s54, s54, 196608
MAA 104,88,52
TR 120,25,2080
MAA 100,88,48
s_add_u32 m0, s55, 0
MAA 100,92,68
buffer_load_dwordx4 v21, s[16:19], s52 offen sc1 lds
MAA 96,92,64
TR 122,25,2592
v_add_f32 v166, v166, v174
MAA 96,88,44
TR 124,25,14496
MAA 92,88,40
TR 126,25,15008
MAA 92,92,60
buffer_load_dwordx4 v21, s[16:19], s52 offen offset:1024 sc1 lds
MAA 124,60,100
RD 0,23,18432
MAA 124,40,96
RD 4,23,19456
v_add_f32 v167, v167, v175
MAA 128,44,96
RD 8,23,20736
MAA 128,64,100
buffer_load_dword v22, s[16:19], s52 offen offset:2048 sc1 lds
MAA 132,68,100
RD 12,23,21760
s_add_u32 s52, s52, 131072
MAA 132,48,96
RD 16,24,20480
MAA 136,52,96
MAA 136,72,100
s_waitcnt vmcnt(17) lgkmcnt(5)
s_barrier
MAA 76,104,40
RD 20,23,27648
s_add_u32 m0, s56, 67584
MAA 76,108,60
buffer_load_dwordx4 v18, s[20:23], s54 offen lds
MAA 80,108,64
RD 24,23,28672
MAA 80,104,44
RD 28,23,29952
MAA 84,104,48
RD 32,23,30976
MAA 84,108,68
buffer_load_dwordx4 v19, s[20:23], s54 offen offset:1024 lds
MAA 88,108,72
RD 36,24,29696
MAA 88,104,52
buffer_load_dwordx4 v20, s[20:23], s54 offen offset:2048 lds
MAA 160,112,56
TR 80,25,24832
s_add_u32 s54, s54, 196608
MAA 160,116,76
TR 82,25,25344
MAA 120,116,72
TR 84,25,37248
s_add_u32 m0, s55, 9216
MAA 120,112,52
buffer_load_dwordx4 v21, s[16:19], s52 offen sc1 lds
MAA 116,112,48
TR 86,25,37760
MAA 116,116,68
TR 88,25,25856
MAA 112,116,64
TR 90,25,26368
MAA 112,112,44
buffer_load_dwordx4 v21, s[16:19], s52 offen offset:1024 sc1 lds
MAA 108,112,40
TR 92,25,38272
MAA 108,116,60
TR 94,25,38784
MAA 140,60,124
TR 96,25,26880
MAA 140,40,120
buffer_load_dword v22, s[16:19], s52 offen offset:2048 sc1 lds
MAA 144,44,120
TR 98,25,27392
s_add_u32 s52, s52, 131072
MAA 144,64,124
buffer_load_dwordx4 v[172:175], v26, s[16:19], s75 offen offset:1024 sc1
MAA 148,68,124
TR 100,25,39296
s_add_u32 s75, s75, 2048
MAA 148,48,120
TR 102,25,39808
MAA 152,52,120
MAA 152,72,124
s_waitcnt vmcnt(21) lgkmcnt(8)
s_barrier
MAA 60,80,0
TR 104,25,24864
s_add_u32 m0, s56, 80000
MAA 60,84,20
buffer_load_dwordx4 v18, s[20:23], s54 offen lds
MAA 64,84,24
TR 106,25,25376
MAA 64,80,4
TR 108,25,37280
MAA 68,80,8
TR 110,25,37792
MAA 68,84,28
buffer_load_dwordx4 v19, s[20:23], s54 offen offset:1024 lds
MAA 72,84,32
TR 112,25,25888
MAA 72,80,12
TR 114,25,26400
s_waitcnt lgkmcnt(6)
MAA 156,88,16
TR 116,25,38304
MAA 156,92,36
buffer_load_dwordx4 v20, s[20:23], s54 offen offset:2048 lds
MAA 104,92,32
TR 118,25,38816
s_add_u32 s54, s54, 196608
MAA 104,88,12
TR 120,25,26912
MAA 100,88,8
s_add_u32 m0, s55, 18432
MAA 100,92,28
buffer_load_dwordx4 v21, s[16:19], s52 offen sc1 lds
MAA 96,92,24
TR 122,25,27424
MAA 96,88,4
TR 124,25,39328
MAA 92,88,0
TR 126,25,39840
MAA 92,92,20
buffer_load_dwordx4 v21, s[16:19], s52 offen offset:1024 sc1 lds
MAA 124,20,100
RD 40,23,36864
MAA 124,0,96
RD 44,23,37888
MAA 128,4,96
RD 48,23,39168
MAA 128,24,100
buffer_load_dword v22, s[16:19], s52 offen offset:2048 sc1 lds
MAA 132,28,100
RD 52,23,40192
s_add_u32 s52, s52, 131072
MAA 132,8,96
RD 56,24,38912
MAA 136,12,96
MAA 136,32,100
s_waitcnt vmcnt(16) lgkmcnt(5)
s_barrier
MAA 76,104,0
RD 60,23,46080
s_add_u32 m0, s56, 92416
MAA 76,108,20
buffer_load_dwordx4 v18, s[20:23], s54 offen lds
MAA 80,108,24
RD 64,23,47104
MAA 80,104,4
RD 68,23,48384
MAA 84,104,8
RD 72,23,49408
MAA 84,108,28
buffer_load_dwordx4 v19, s[20:23], s54 offen offset:1024 lds
MAA 88,108,32
RD 76,24,48128
MAA 88,104,12
TR 80,25,49664
MAA 160,112,16
TR 82,25,50176
MAA 160,116,36
buffer_load_dwordx4 v20, s[20:23], s54 offen offset:2048 lds
MAA 120,116,32
TR 84,25,62080
s_add_u32 s54, s54, 196608
MAA 120,112,12
TR 86,25,62592
MAA 116,112,8
s_add_u32 m0, s55, 27648
MAA 116,116,28
buffer_load_dwordx4 v21, s[16:19], s52 offen sc1 lds
MAA 112,116,24
TR 88,25,50688
MAA 112,112,4
TR 90,25,51200
MAA 108,112,0
TR 92,25,63104
MAA 108,116,20
buffer_load_dwordx4 v21, s[16:19], s52 offen offset:1024 sc1 lds
MAA 140,20,124
TR 94,25,63616
MAA 140,0,120
TR 96,25,51712
MAA 144,4,120
TR 98,25,52224
MAA 144,24,124
buffer_load_dword v22, s[16:19], s52 offen offset:2048 sc1 lds
MAA 148,28,124
TR 100,25,64128
s_add_u32 s52, s52, 131072
MAA 148,8,120
TR 102,25,64640
MAA 152,12,120
MAA 152,32,124
s_waitcnt vmcnt(19) lgkmcnt(8)
s_barrier
MAA 60,80,40
TR 104,25,49696
s_add_u32 m0, s56, 104832
MAA 60,84,60
buffer_load_dwordx4 v18, s[20:23], s54 offen lds
MAA 64,84,64
TR 106,25,50208
v_add_f32 v164, v164, v168
MAA 64,80,44
TR 108,25,62112
MAA 68,80,48
TR 110,25,62624
MAA 68,84,68
buffer_load_dwordx4 v19, s[20:23], s54 offen offset:1024 lds
MAA 72,84,72
TR 112,25,50720
v_add_f32 v165, v165, v169
MAA 72,80,52
TR 114,25,51232
s_waitcnt lgkmcnt(6)
MAA 156,88,56
TR 116,25,63136
MAA 156,92,76
buffer_load_dwordx4 v20, s[20:23], s54 offen offset:2048 lds
MAA 104,92,72
s_add_u32 s54, s54, 196608
s_add_u32 m0, s55, 36864
MAA 104,88,52
buffer_load_dwordx4 v21, s[16:19], s52 offen sc1 lds
MAA 100,88,48
TR 118,25,63648
MAA 100,92,68
TR 120,25,51744
v_add_f32 v166, v166, v170
MAA 96,92,64
TR 122,25,52256
MAA 96,88,44
buffer_load_dwordx4 v21, s[16:19], s52 offen offset:1024 sc1 lds
MAA 92,88,40
TR 124,25,64160
MAA 92,92,60
TR 126,25,64672
v_add_f32 v167, v167, v171
MAA 124,60,100
ds_read_b128 a[0:3], v23
MAA 124,40,96
buffer_load_dword v22, s[16:19], s52 offen offset:2048 sc1 lds
MAA 128,44,96
RD 4,23,1024
s_add_u32 s52, s52, 131072
MAA 128,64,100
buffer_load_dword v27, v14, s[20:23], s44 offen
MAA 132,68,100
RD 8,23,2304
s_add_u32 s44, s44, 1572864
MAA 132,48,96
RD 12,23,3328
MAA 136,52,96
RD 16,24,2048
MAA 136,72,100
s_waitcnt vmcnt(16) lgkmcnt(5)
s_barrier
MAA 76,104,40
RD 20,23,9216
s_add_u32 m0, s56, 117248
MAA 76,108,60
buffer_load_dwordx4 v18, s[20:23], s54 offen lds
MAA 80,108,64
RD 24,23,10240
MAA 80,104,44
RD 28,23,11520
MAA 84,104,48
RD 32,23,12544
MAA 84,108,68
buffer_load_dwordx4 v19, s[20:23], s54 offen offset:1024 lds
MAA 88,108,72
RD 36,24,11264
MAA 88,104,52
buffer_load_dwordx4 v20, s[20:23], s54 offen offset:2048 lds
MAA 160,112,56
ds_read_b64_tr_b16 a[80:81], v25
s_add_u32 s54, s54, 196608
MAA 160,116,76
TR 82,25,512
MAA 120,116,72
TR 84,25,12416
s_add_u32 m0, s55, 46080
MAA 120,112,52
buffer_load_dwordx4 v21, s[16:19], s52 offen sc1 lds
MAA 116,112,48
TR 86,25,12928
MAA 116,116,68
TR 88,25,1024
MAA 112,116,64
TR 90,25,1536
MAA 112,112,44
buffer_load_dwordx4 v21, s[16:19], s52 offen offset:1024 sc1 lds
MAA 108,112,40
TR 92,25,13440
MAA 108,116,60
TR 94,25,13952
MAA 140,60,124
TR 96,25,2048
MAA 140,40,120
buffer_load_dword v22, s[16:19], s52 offen offset:2048 sc1 lds
MAA 144,44,120
TR 98,25,2560
s_add_u32 s52, s52, 131072
MAA 144,64,124
buffer_load_dwordx4 v[168:171], v26, s[16:19], s75 offen sc1
MAA 148,68,124
TR 100,25,14464
MAA 148,48,120
TR 102,25,14976
MAA 152,52,120
MAA 152,72,124
s_waitcnt vmcnt(20) lgkmcnt(8)
s_barrier
MAA 60,80,0
TR 104,25,32
s_add_u32 m0, s56, 129664
MAA 60,84,20
buffer_load_dwordx4 v18, s[20:23], s54 offen lds
MAA 64,84,24
TR 106,25,544
v_add_f32 v164, v164, v172
MAA 64,80,4
TR 108,25,12448
MAA 68,80,8
TR 110,25,12960
MAA 68,84,28
buffer_load_dwordx4 v19, s[20:23], s54 offen offset:1024 lds
MAA 72,84,32
TR 112,25,1056
MAA 72,80,12
TR 114,25,1568
s_waitcnt lgkmcnt(6)
MAA 156,88,16
TR 116,25,13472
v_add_f32 v165, v165, v173
MAA 156,92,36
buffer_load_dwordx4 v20, s[20:23], s54 offen offset:2048 lds
MAA 104,92,32
TR 118,25,13984
s_add_u32 s54, s54, 196608
MAA 104,88,12
TR 120,25,2080
MAA 100,88,8
s_add_u32 m0, s55, 0
MAA 100,92,28
buffer_load_dwordx4 v21, s[16:19], s52 offen sc1 lds
MAA 96,92,24
TR 122,25,2592
v_add_f32 v166, v166, v174
MAA 96,88,4
TR 124,25,14496
MAA 92,88,0
TR 126,25,15008
MAA 92,92,20
buffer_load_dwordx4 v21, s[16:19], s52 offen offset:1024 sc1 lds
MAA 124,20,100
RD 40,23,18432
MAA 124,0,96
RD 44,23,19456
v_add_f32 v167, v167, v175
MAA 128,4,96
RD 48,23,20736
MAA 128,24,100
buffer_load_dword v22, s[16:19], s52 offen offset:2048 sc1 lds
MAA 132,28,100
RD 52,23,21760
s_add_u32 s52, s52, 131072
MAA 132,8,96
RD 56,24,20480
MAA 136,12,96
MAA 136,32,100
s_waitcnt vmcnt(17) lgkmcnt(5)
s_barrier
MAA 76,104,0
RD 60,23,27648
s_add_u32 m0, s56, 67584
MAA 76,108,20
buffer_load_dwordx4 v18, s[20:23], s54 offen lds
MAA 80,108,24
RD 64,23,28672
MAA 80,104,4
RD 68,23,29952
MAA 84,104,8
RD 72,23,30976
MAA 84,108,28
buffer_load_dwordx4 v19, s[20:23], s54 offen offset:1024 lds
MAA 88,108,32
RD 76,24,29696
MAA 88,104,12
buffer_load_dwordx4 v20, s[20:23], s54 offen offset:2048 lds
MAA 160,112,16
TR 80,25,24832
s_add_u32 s54, s54, 196608
MAA 160,116,36
TR 82,25,25344
MAA 120,116,32
TR 84,25,37248
s_add_u32 m0, s55, 9216
MAA 120,112,12
buffer_load_dwordx4 v21, s[16:19], s52 offen sc1 lds
MAA 116,112,8
TR 86,25,37760
MAA 116,116,28
TR 88,25,25856
MAA 112,116,24
TR 90,25,26368
MAA 112,112,4
buffer_load_dwordx4 v21, s[16:19], s52 offen offset:1024 sc1 lds
MAA 108,112,0
TR 92,25,38272
MAA 108,116,20
TR 94,25,38784
MAA 140,20,124
TR 96,25,26880
MAA 140,0,120
buffer_load_dword v22, s[16:19], s52 offen offset:2048 sc1 lds
MAA 144,4,120
TR 98,25,27392
s_add_u32 s52, s52, 131072
MAA 144,24,124
buffer_load_dwordx4 v[172:175], v26, s[16:19], s75 offen offset:1024 sc1
MAA 148,28,124
TR 100,25,39296
s_add_u32 s75, s75, 2048
MAA 148,8,120
TR 102,25,39808
MAA 152,12,120
MAA 152,32,124
s_waitcnt vmcnt(21) lgkmcnt(8)
s_barrier
MAA 60,80,40
TR 104,25,24864
s_add_u32 m0, s56, 80000
MAA 60,84,60
buffer_load_dwordx4 v18, s[20:23], s54 offen lds
MAA 64,84,64
TR 106,25,25376
MAA 64,80,44
TR 108,25,37280
MAA 68,80,48
TR 110,25,37792
MAA 68,84,68
buffer_load_dwordx4 v19, s[20:23], s54 offen offset:1024 lds
MAA 72,84,72
TR 112,25,25888
MAA 72,80,52
TR 114,25,26400
s_waitcnt lgkmcnt(6)
MAA 156,88,56
TR 116,25,38304
MAA 156,92,76
buffer_load_dwordx4 v20, s[20:23], s54 offen offset:2048 lds
MAA 104,92,72
TR 118,25,38816
s_add_u32 s54, s54, 196608
MAA 104,88,52
TR 120,25,26912
MAA 100,88,48
s_add_u32 m0, s55, 18432
MAA 100,92,68
buffer_load_dwordx4 v21, s[16:19], s52 offen sc1 lds
MAA 96,92,64
TR 122,25,27424
MAA 96,88,44
TR 124,25,39328
MAA 92,88,40
TR 126,25,39840
MAA 92,92,60
buffer_load_dwordx4 v21, s[16:19], s52 offen offset:1024 sc1 lds
MAA 124,60,100
RD 0,23,36864
MAA 124,40,96
RD 4,23,37888
MAA 128,44,96
RD 8,23,39168
MAA 128,64,100
buffer_load_dword v22, s[16:19], s52 offen offset:2048 sc1 lds
MAA 132,68,100
.Lpad13:
s_cbranch_execz .Lpad16
RD 12,23,40192
s_add_u32 s52, s52, 131072
MAA 132,48,96
RD 16,24,38912
MAA 136,52,96
MAA 136,72,100
s_waitcnt vmcnt(16) lgkmcnt(5)
s_barrier
MAA 76,104,40
RD 20,23,46080
s_add_u32 m0, s56, 92416
MAA 76,108,60
buffer_load_dwordx4 v18, s[20:23], s54 offen lds
MAA 80,108,64
RD 24,23,47104
MAA 80,104,44
RD 28,23,48384
MAA 84,104,48
RD 32,23,49408
MAA 84,108,68
buffer_load_dwordx4 v19, s[20:23], s54 offen offset:1024 lds
MAA 88,108,72
RD 36,24,48128
MAA 88,104,52
TR 80,25,49664
MAA 160,112,56
TR 82,25,50176
MAA 160,116,76
buffer_load_dwordx4 v20, s[20:23], s54 offen offset:2048 lds
MAA 120,116,72
TR 84,25,62080
s_add_u32 s54, s54, 196608
MAA 120,112,52
TR 86,25,62592
MAA 116,112,48
s_add_u32 m0, s55, 27648
MAA 116,116,68
buffer_load_dwordx4 v21, s[16:19], s52 offen sc1 lds
MAA 112,116,64
TR 88,25,50688
MAA 112,112,44
TR 90,25,51200
MAA 108,112,40
TR 92,25,63104
MAA 108,116,60
buffer_load_dwordx4 v21, s[16:19], s52 offen offset:1024 sc1 lds
MAA 140,60,124
TR 94,25,63616
MAA 140,40,120
TR 96,25,51712
MAA 144,44,120
TR 98,25,52224
MAA 144,64,124
buffer_load_dword v22, s[16:19], s52 offen offset:2048 sc1 lds
MAA 148,68,124
TR 100,25,64128
s_add_u32 s52, s52, 131072
MAA 148,48,120
TR 102,25,64640
MAA 152,52,120
s_add_u32 s15, s15, 1
MAA 152,72,124
s_cbranch_scc0 .Lk57
s_waitcnt vmcnt(19) lgkmcnt(8)
s_barrier
MAA 60,80,0
TR 104,25,49696
s_add_u32 m0, s56, 104832
MAA 60,84,20
buffer_load_dwordx4 v18, s[20:23], s54 offen lds
MAA 64,84,24
TR 106,25,50208
v_add_f32 v164, v164, v168
MAA 64,80,4
TR 108,25,62112
v_add_f32 v165, v165, v169
MAA 68,80,8
TR 110,25,62624
v_add_f32 v166, v166, v170
MAA 68,84,28
buffer_load_dwordx4 v19, s[20:23], s54 offen offset:1024 lds
MAA 72,84,32
TR 112,25,50720
v_add_f32 v167, v167, v171
MAA 72,80,12
TR 114,25,51232
s_waitcnt lgkmcnt(6)
MAA 156,88,16
TR 116,25,63136
MAA 156,92,36
buffer_load_dwordx4 v20, s[20:23], s54 offen offset:2048 lds
MAA 104,92,32
TR 118,25,63648
s_add_u32 s54, s54, 196608
MAA 104,88,12
TR 120,25,51744
s_add_u32 m0, s55, 36864
MAA 100,88,8
TR 122,25,52256
MAA 100,92,28
buffer_load_dwordx4 v21, s[16:19], s52 offen sc1 lds
MAA 96,92,24
TR 124,25,64160
MAA 96,88,4
TR 126,25,64672
MAA 92,88,0
ds_read_b128 a[40:43], v23
MAA 92,92,20
buffer_load_dwordx4 v21, s[16:19], s52 offen offset:1024 sc1 lds
MAA 124,20,100
RD 44,23,1024
MAA 124,0,96
RD 48,23,2304
MAA 128,4,96
RD 52,23,3328
MAA 128,24,100
buffer_load_dword v22, s[16:19], s52 offen offset:2048 sc1 lds
MAA 132,28,100
RD 56,24,2048
s_add_u32 s52, s52, 131072
MAA 132,8,96
MAA 136,12,96
MAA 136,32,100
s_waitcnt vmcnt(15) lgkmcnt(5)
s_barrier
MAA 76,104,0
RD 60,23,9216
s_add_u32 m0, s56, 117248
MAA 76,108,20
buffer_load_dwordx4 v18, s[20:23], s54 offen lds
MAA 80,108,24
RD 64,23,10240
v_add_f32 v164, v164, v172
MAA 80,104,4
RD 68,23,11520
v_add_f32 v165, v165, v173
MAA 84,104,8
RD 72,23,12544
v_add_f32 v166, v166, v174
MAA 84,108,28
buffer_load_dwordx4 v19, s[20:23], s54 offen offset:1024 lds
MAA 88,108,32
RD 76,24,11264
v_add_f32 v167, v167, v175
MAA 88,104,12
ds_read_b64_tr_b16 a[80:81], v25
MAA 160,112,16
TR 82,25,512
MAA 160,116,36
buffer_load_dwordx4 v20, s[20:23], s54 offen offset:2048 lds
MAA 120,116,32
TR 84,25,12416
s_add_u32 s54, s54, 196608
MAA 120,112,12
TR 86,25,12928
s_add_u32 m0, s55, 46080
MAA 116,112,8
TR 88,25,1024
MAA 116,116,28
buffer_load_dwordx4 v21, s[16:19], s52 offen sc1 lds
MAA 112,116,24
TR 90,25,1536
MAA 112,112,4
TR 92,25,13440
MAA 108,112,0
TR 94,25,13952
MAA 108,116,20
buffer_load_dwordx4 v21, s[16:19], s52 offen offset:1024 sc1 lds
MAA 140,20,124
TR 96,25,2048
MAA 140,0,120
TR 98,25,2560
MAA 144,4,120
TR 100,25,14464
MAA 144,24,124
buffer_load_dword v22, s[16:19], s52 offen offset:2048 sc1 lds
MAA 148,28,124
TR 102,25,14976
s_add_u32 s52, s52, 131072
MAA 148,8,120
v_permlane32_swap_b32 v164, v166
MAA 152,12,120
v_permlane32_swap_b32 v165, v167
MAA 152,32,124
s_waitcnt vmcnt(18) lgkmcnt(8)
s_barrier
MAA 60,80,40
TR 104,25,32
s_add_u32 m0, s56, 129664
MAA 60,84,60
buffer_load_dwordx4 v18, s[20:23], s54 offen lds
MAA 64,84,64
TR 106,25,544
v_add_f32 v164, v164, v166
MAA 64,80,44
TR 108,25,12448
v_add_f32 v165, v165, v167
MAA 68,80,48
buffer_load_dwordx4 v19, s[20:23], s54 offen offset:1024 lds
MAA 68,84,68
TR 110,25,12960
v_mul_f32 v164, 0xba800000, v164
MAA 72,84,72
TR 112,25,1056
v_mul_f32 v165, 0x3a800000, v165
MAA 72,80,52
buffer_load_dwordx4 v20, s[20:23], s54 offen offset:2048 lds
s_waitcnt lgkmcnt(5)
MAA 156,88,56
TR 114,25,1568
s_add_u32 s54, s54, 196608
MAA 156,92,76
TR 116,25,13472
s_add_u32 m0, s59, 58240
MAA 104,92,72
TR 118,25,13984
s_xor_b32 s58, s87, 1966080
MAA 104,88,52
buffer_load_dwordx4 v5, s[24:27], s58 offen lds
MAA 100,88,48
TR 120,25,2080
v_fma_f32 v165, -v164, v164, v165
MAA 100,92,68
TR 122,25,2592
v_max_f32 v165, 0, v165
MAA 96,92,64
buffer_load_dwordx4 v6, s[24:27], s58 offen offset:1024 lds
MAA 96,88,44
TR 124,25,14496
s_add_u32 m0, s59, 0
MAA 92,88,40
TR 126,25,15008
s_xor_b32 s58, s87, 1048576
MAA 92,92,60
buffer_load_dwordx4 v5, s[24:27], s58 offen lds
MAA 124,60,100
RD 0,23,18432
v_add_f32 v165, 0x3727c5ac, v165
MAA 124,40,96
RD 4,23,19456
MAA 128,44,96
buffer_load_dwordx4 v6, s[24:27], s58 offen offset:1024 lds
MAA 128,64,100
RD 8,23,20736
MAA 132,68,100
RD 12,23,21760
MAA 132,48,96
RD 16,24,20480
MAA 136,52,96
v_rsq_f32 v166, v165
MAA 136,72,100
v_mov_b32 v165, v166
v_mul_f32 v166, 0x3e8293ee, v166
ds_write_b128 v7, v[164:167]
s_waitcnt vmcnt(16) lgkmcnt(6)
s_barrier
MAA 76,104,40
ds_write_b32 v17, v164
s_add_u32 m0, s59, 8320
MAA 76,108,60
ds_write_b32 v17, v165 offset:1024
s_xor_b32 s58, s87, 1179648
MAA 80,108,64
buffer_load_dwordx4 v5, s[24:27], s58 offen lds
MAA 80,104,44
RD 20,23,27648
MAA 84,104,48
RD 24,23,28672
MAA 84,108,68
RD 28,23,29952
MAA 88,108,72
buffer_load_dwordx4 v6, s[24:27], s58 offen offset:1024 lds
MAA 88,104,52
RD 32,23,30976
s_add_u32 m0, s59, 66560
MAA 160,112,56
RD 36,24,29696
s_xor_b32 s58, s87, 0
MAA 160,116,76
TR 80,25,24832
MAA 120,116,72
buffer_load_dwordx4 v5, s[24:27], s58 offen lds
MAA 120,112,52
TR 82,25,25344
MAA 116,112,48
TR 84,25,37248
MAA 116,116,68
TR 86,25,37760
MAA 112,116,64
buffer_load_dwordx4 v6, s[24:27], s58 offen offset:1024 lds
MAA 112,112,44
TR 88,25,25856
s_add_u32 m0, s59, 74880
MAA 108,112,40
TR 90,25,26368
s_xor_b32 s58, s87, 131072
MAA 108,116,60
TR 92,25,38272
MAA 140,60,124
buffer_load_dwordx4 v5, s[24:27], s58 offen lds
MAA 140,40,120
TR 94,25,38784
MAA 144,44,120
TR 96,25,26880
MAA 144,64,124
TR 98,25,27392
MAA 148,68,124
buffer_load_dwordx4 v6, s[24:27], s58 offen offset:1024 lds
MAA 148,48,120
TR 100,25,39296
MAA 152,52,120
TR 102,25,39808
MAA 152,72,124
s_waitcnt vmcnt(10) lgkmcnt(0)
s_barrier
MAA 156,88,16
TR 112,25,25888
s_add_u32 m0, s59, 83200
MAA 156,92,36
TR 114,25,26400
s_xor_b32 s58, s87, 262144
MAA 104,92,32
buffer_load_dwordx4 v5, s[24:27], s58 offen lds
MAA 104,88,12
TR 116,25,38304
MAA 100,88,8
TR 118,25,38816
MAA 100,92,28
TR 120,25,26912
MAA 96,92,24
buffer_load_dwordx4 v6, s[24:27], s58 offen offset:1024 lds
MAA 96,88,4
TR 122,25,27424
s_add_u32 m0, s59, 16640
MAA 92,88,0
TR 124,25,39328
s_xor_b32 s58, s87, 1310720
MAA 92,92,20
TR 126,25,39840
MAA 136,32,100
buffer_load_dwordx4 v5, s[24:27], s58 offen lds
MAA 136,12,96
TR 104,25,24864
MAA 72,80,12
TR 106,25,25376
MAA 72,84,32
TR 108,25,37280
MAA 68,84,28
buffer_load_dwordx4 v6, s[24:27], s58 offen offset:1024 lds
MAA 68,80,8
TR 110,25,37792
s_add_u32 m0, s59, 24960
MAA 64,80,4
RD 40,23,36864
s_xor_b32 s58, s87, 1441792
MAA 64,84,24
RD 44,23,37888
MAA 60,84,20
buffer_load_dwordx4 v5, s[24:27], s58 offen lds
MAA 60,80,0
RD 48,23,39168
s_waitcnt lgkmcnt(13)
MAA 160,112,16
RD 52,23,40192
s_waitcnt lgkmcnt(12)
MAA 160,116,36
RD 56,24,38912
MAA 120,116,32
buffer_load_dwordx4 v6, s[24:27], s58 offen offset:1024 lds
MAA 120,112,12
s_waitcnt lgkmcnt(5)
s_barrier
RD 60,23,46080
MAA 116,112,8
RD 64,23,47104
s_add_u32 m0, s59, 91520
MAA 116,116,28
RD 68,23,48384
s_xor_b32 s58, s87, 393216
MAA 112,116,24
RD 72,23,49408
MAA 112,112,4
RD 76,24,48128
MAA 108,112,0
TR 144,25,50688
MAA 108,116,20
TR 146,25,51200
MAA 152,32,124
TR 148,25,63104
MAA 152,12,120
TR 150,25,63616
MAA 88,104,12
TR 152,25,50720
MAA 88,108,32
TR 154,25,51232
MAA 84,108,28
TR 156,25,63136
MAA 84,104,8
TR 158,25,63648
MAA 80,104,4
TR 160,25,51712
MAA 80,108,24
TR 162,25,52224
MAA 76,108,20
TR 164,25,64128
MAA 76,104,0
TR 166,25,64640
s_waitcnt lgkmcnt(10)
MAA 156,144,56
TR 168,25,51744
s_waitcnt lgkmcnt(9)
MAA 156,148,76
TR 170,25,52256
MAA 104,148,72
TR 172,25,64160
MAA 104,144,52
TR 174,25,64672
MAA 100,144,48
TR 128,25,49664
MAA 100,148,68
TR 130,25,50176
MAA 96,148,64
TR 132,25,62080
MAA 96,144,44
TR 134,25,62592
MAA 92,144,40
TR 136,25,49696
MAA 92,148,60
TR 138,25,50208
s_waitcnt lgkmcnt(14)
MAA 160,156,76
TR 140,25,62112
MAA 160,152,56
TR 142,25,62624
MAA 120,152,52
ds_read_b128 v[232:235], v10 offset:768
MAA 120,156,72
ds_read_b128 v[236:239], v10 offset:2816
MAA 116,156,68
ds_read_b128 v[228:231], v10 offset:512
MAA 116,152,48
ds_read_b128 v[224:227], v10 offset:256
MAA 112,152,44
ds_read_b128 v[220:223], v10
MAA 112,156,64
buffer_load_dwordx4 v5, s[24:27], s58 offen lds
MAA 108,156,60
ds_read_b128 v[240:243], v11 offset:192
MAA 108,152,40
s_waitcnt lgkmcnt(6)
s_barrier
ds_read_b128 v[244:247], v11 offset:1216
MAA 136,52,160
ds_read_b128 v[18:21], v11 offset:128
MAA 136,72,164
buffer_load_dwordx4 v6, s[24:27], s58 offen offset:1024 lds
MAA 152,72,172
ds_read_b128 v[22:25], v11 offset:1152
s_add_u32 m0, s59, 99840
MAA 152,52,168
s_xor_b32 s58, s87, 524288
MAA 72,128,52
MAA 72,132,72
buffer_load_dwordx4 v5, s[24:27], s58 offen lds
MAA 68,132,68
MAA 68,128,48
MAA 64,128,44
MAA 64,132,64
buffer_load_dwordx4 v6, s[24:27], s58 offen offset:1024 lds
MAA 60,132,60
s_add_u32 m0, s59, 108160
s_xor_b32 s58, s87, 655360
MAA 60,128,40
MAA 88,136,52
MAA 88,140,72
buffer_load_dwordx4 v5, s[24:27], s58 offen lds
MAA 84,140,68
MAA 84,136,48
MAA 80,136,44
MAA 80,140,64
buffer_load_dwordx4 v6, s[24:27], s58 offen offset:1024 lds
MAA 76,140,60
s_add_u32 m0, s59, 33280
s_xor_b32 s58, s87, 1572864
MAA 76,136,40
s_waitcnt lgkmcnt(8)
v_pk_fma_f32 v[104:105], v[36:37], v[232:233], v[104:105] op_sel_hi:[1,0,1]
v_pk_mul_f32 v[104:105], v[104:105], v[232:233] op_sel:[0,1] op_sel_hi:[1,1]
v_cvt_pk_bf16_f32 v196, v104, v105
v_pk_fma_f32 v[106:107], v[38:39], v[232:233], v[106:107] op_sel_hi:[1,0,1]
v_pk_mul_f32 v[106:107], v[106:107], v[232:233] op_sel:[0,1] op_sel_hi:[1,1]
v_cvt_pk_bf16_f32 v197, v106, v107
v_pk_fma_f32 v[120:121], v[40:41], v[232:233], v[120:121] op_sel_hi:[1,0,1]
v_pk_mul_f32 v[120:121], v[120:121], v[232:233] op_sel:[0,1] op_sel_hi:[1,1]
v_cvt_pk_bf16_f32 v198, v120, v121
v_pk_fma_f32 v[122:123], v[42:43], v[232:233], v[122:123] op_sel_hi:[1,0,1]
v_pk_mul_f32 v[122:123], v[122:123], v[232:233] op_sel:[0,1] op_sel_hi:[1,1]
v_cvt_pk_bf16_f32 v199, v122, v123
s_waitcnt lgkmcnt(3)
v_pk_fma_f32 v[136:137], v[240:241], v[44:45], v[136:137] op_sel_hi:[1,0,1]
s_waitcnt lgkmcnt(2)
v_pk_mul_f32 v[136:137], v[136:137], v[244:245]
v_cvt_pk_bf16_f32 v208, v136, v137
v_pk_fma_f32 v[138:139], v[242:243], v[44:45], v[138:139] op_sel_hi:[1,0,1]
v_pk_mul_f32 v[138:139], v[138:139], v[246:247]
v_cvt_pk_bf16_f32 v209, v138, v139
v_pk_fma_f32 v[152:153], v[240:241], v[44:45], v[152:153] op_sel:[0,1,0] op_sel_hi:[1,1,1]
v_pk_mul_f32 v[152:153], v[152:153], v[244:245]
v_cvt_pk_bf16_f32 v218, v152, v153
v_pk_fma_f32 v[154:155], v[242:243], v[44:45], v[154:155] op_sel:[0,1,0] op_sel_hi:[1,1,1]
v_pk_mul_f32 v[154:155], v[154:155], v[246:247]
v_cvt_pk_bf16_f32 v219, v154, v155
ds_write_b128 v8, v[196:199]
ds_write_b64 v8, v[208:209] offset:1024
ds_write_b64 v8, v[218:219] offset:1032
v_pk_fma_f32 v[156:157], v[36:37], v[236:237], v[156:157] op_sel_hi:[1,0,1]
v_pk_mul_f32 v[156:157], v[156:157], v[236:237] op_sel:[0,1] op_sel_hi:[1,1]
v_cvt_pk_bf16_f32 v180, v156, v157
v_pk_fma_f32 v[158:159], v[38:39], v[236:237], v[158:159] op_sel_hi:[1,0,1]
v_pk_mul_f32 v[158:159], v[158:159], v[236:237] op_sel:[0,1] op_sel_hi:[1,1]
v_cvt_pk_bf16_f32 v181, v158, v159
v_pk_fma_f32 v[160:161], v[40:41], v[236:237], v[160:161] op_sel_hi:[1,0,1]
v_pk_mul_f32 v[160:161], v[160:161], v[236:237] op_sel:[0,1] op_sel_hi:[1,1]
v_cvt_pk_bf16_f32 v182, v160, v161
v_pk_fma_f32 v[162:163], v[42:43], v[236:237], v[162:163] op_sel_hi:[1,0,1]
v_pk_mul_f32 v[162:163], v[162:163], v[236:237] op_sel:[0,1] op_sel_hi:[1,1]
v_cvt_pk_bf16_f32 v183, v162, v163
v_pk_fma_f32 v[100:101], v[36:37], v[228:229], v[100:101] op_sel_hi:[1,0,1]
v_pk_mul_f32 v[100:101], v[100:101], v[228:229] op_sel:[0,1] op_sel_hi:[1,1]
v_cvt_pk_bf16_f32 v192, v100, v101
v_pk_fma_f32 v[102:103], v[38:39], v[228:229], v[102:103] op_sel_hi:[1,0,1]
v_pk_mul_f32 v[102:103], v[102:103], v[228:229] op_sel:[0,1] op_sel_hi:[1,1]
v_cvt_pk_bf16_f32 v193, v102, v103
v_pk_fma_f32 v[116:117], v[40:41], v[228:229], v[116:117] op_sel_hi:[1,0,1]
.Lpad14:
s_cbranch_execz .Lpad17
v_pk_mul_f32 v[116:117], v[116:117], v[228:229] op_sel:[0,1] op_sel_hi:[1,1]
v_cvt_pk_bf16_f32 v194, v116, v117
v_pk_fma_f32 v[118:119], v[42:43], v[228:229], v[118:119] op_sel_hi:[1,0,1]
v_pk_mul_f32 v[118:119], v[118:119], v[228:229] op_sel:[0,1] op_sel_hi:[1,1]
s_waitcnt lgkmcnt(0)
s_barrier
v_cvt_pk_bf16_f32 v195, v118, v119
v_pk_fma_f32 v[96:97], v[36:37], v[224:225], v[96:97] op_sel_hi:[1,0,1]
v_pk_mul_f32 v[96:97], v[96:97], v[224:225] op_sel:[0,1] op_sel_hi:[1,1]
v_cvt_pk_bf16_f32 v188, v96, v97
v_pk_fma_f32 v[98:99], v[38:39], v[224:225], v[98:99] op_sel_hi:[1,0,1]
v_pk_mul_f32 v[98:99], v[98:99], v[224:225] op_sel:[0,1] op_sel_hi:[1,1]
v_cvt_pk_bf16_f32 v189, v98, v99
v_pk_fma_f32 v[112:113], v[40:41], v[224:225], v[112:113] op_sel_hi:[1,0,1]
v_pk_mul_f32 v[112:113], v[112:113], v[224:225] op_sel:[0,1] op_sel_hi:[1,1]
v_cvt_pk_bf16_f32 v190, v112, v113
v_pk_fma_f32 v[114:115], v[42:43], v[224:225], v[114:115] op_sel_hi:[1,0,1]
v_pk_mul_f32 v[114:115], v[114:115], v[224:225] op_sel:[0,1] op_sel_hi:[1,1]
v_cvt_pk_bf16_f32 v191, v114, v115
v_pk_fma_f32 v[92:93], v[36:37], v[220:221], v[92:93] op_sel_hi:[1,0,1]
v_pk_mul_f32 v[92:93], v[92:93], v[220:221] op_sel:[0,1] op_sel_hi:[1,1]
v_cvt_pk_bf16_f32 v184, v92, v93
v_pk_fma_f32 v[94:95], v[38:39], v[220:221], v[94:95] op_sel_hi:[1,0,1]
v_pk_mul_f32 v[94:95], v[94:95], v[220:221] op_sel:[0,1] op_sel_hi:[1,1]
v_cvt_pk_bf16_f32 v185, v94, v95
v_pk_fma_f32 v[108:109], v[40:41], v[220:221], v[108:109] op_sel_hi:[1,0,1]
v_pk_mul_f32 v[108:109], v[108:109], v[220:221] op_sel:[0,1] op_sel_hi:[1,1]
v_cvt_pk_bf16_f32 v186, v108, v109
v_pk_fma_f32 v[110:111], v[42:43], v[220:221], v[110:111] op_sel_hi:[1,0,1]
v_pk_mul_f32 v[110:111], v[110:111], v[220:221] op_sel:[0,1] op_sel_hi:[1,1]
v_cvt_pk_bf16_f32 v187, v110, v111
v_pk_fma_f32 v[72:73], v[28:29], v[232:233], v[72:73] op_sel_hi:[1,0,1]
v_cvt_pk_bf16_f32 v176, v72, v73
v_pk_fma_f32 v[74:75], v[30:31], v[232:233], v[74:75] op_sel_hi:[1,0,1]
v_cvt_pk_bf16_f32 v177, v74, v75
v_pk_fma_f32 v[88:89], v[32:33], v[232:233], v[88:89] op_sel_hi:[1,0,1]
v_cvt_pk_bf16_f32 v178, v88, v89
v_pk_fma_f32 v[90:91], v[34:35], v[232:233], v[90:91] op_sel_hi:[1,0,1]
v_cvt_pk_bf16_f32 v179, v90, v91
v_pk_fma_f32 v[68:69], v[28:29], v[228:229], v[68:69] op_sel_hi:[1,0,1]
v_cvt_pk_bf16_f32 v172, v68, v69
v_pk_fma_f32 v[70:71], v[30:31], v[228:229], v[70:71] op_sel_hi:[1,0,1]
v_cvt_pk_bf16_f32 v173, v70, v71
v_pk_fma_f32 v[84:85], v[32:33], v[228:229], v[84:85] op_sel_hi:[1,0,1]
v_cvt_pk_bf16_f32 v174, v84, v85
v_pk_fma_f32 v[86:87], v[34:35], v[228:229], v[86:87] op_sel_hi:[1,0,1]
v_cvt_pk_bf16_f32 v175, v86, v87
v_pk_fma_f32 v[64:65], v[28:29], v[224:225], v[64:65] op_sel_hi:[1,0,1]
v_cvt_pk_bf16_f32 v168, v64, v65
v_pk_fma_f32 v[66:67], v[30:31], v[224:225], v[66:67] op_sel_hi:[1,0,1]
v_cvt_pk_bf16_f32 v169, v66, v67
v_pk_fma_f32 v[80:81], v[32:33], v[224:225], v[80:81] op_sel_hi:[1,0,1]
v_cvt_pk_bf16_f32 v170, v80, v81
v_pk_fma_f32 v[82:83], v[34:35], v[224:225], v[82:83] op_sel_hi:[1,0,1]
v_cvt_pk_bf16_f32 v171, v82, v83
v_pk_fma_f32 v[60:61], v[28:29], v[220:221], v[60:61] op_sel_hi:[1,0,1]
v_cvt_pk_bf16_f32 v164, v60, v61
v_pk_fma_f32 v[62:63], v[30:31], v[220:221], v[62:63] op_sel_hi:[1,0,1]
v_cvt_pk_bf16_f32 v165, v62, v63
v_pk_fma_f32 v[76:77], v[32:33], v[220:221], v[76:77] op_sel_hi:[1,0,1]
v_cvt_pk_bf16_f32 v166, v76, v77
v_pk_fma_f32 v[78:79], v[34:35], v[220:221], v[78:79] op_sel_hi:[1,0,1]
v_cvt_pk_bf16_f32 v167, v78, v79
s_nop 0
v_mfma_f32_16x16x32_bf16 v[120:123], v[196:199], v[176:179], v[50:53]
buffer_load_dwordx4 v5, s[24:27], s58 offen lds
v_mfma_f32_16x16x32_bf16 v[104:107], v[192:195], v[176:179], v[46:49]
ds_read_b64 v[200:201], v9 offset:1024
v_mfma_f32_16x16x32_bf16 v[116:119], v[192:195], v[172:175], v[50:53]
ds_read_b64 v[210:211], v9 offset:1032
v_mfma_f32_16x16x32_bf16 v[100:103], v[188:191], v[172:175], v[46:49]
ds_read_b128 v[240:243], v11 offset:64
v_mfma_f32_16x16x32_bf16 v[112:115], v[188:191], v[168:171], v[50:53]
buffer_load_dwordx4 v6, s[24:27], s58 offen offset:1024 lds
v_mfma_f32_16x16x32_bf16 v[96:99], v[184:187], v[168:171], v[46:49]
ds_read_b128 v[244:247], v11 offset:1088
s_add_u32 m0, s59, 41600
v_mfma_f32_16x16x32_bf16 v[108:111], v[184:187], v[164:167], v[50:53]
ds_read_b128 v[28:31], v11
s_xor_b32 s58, s87, 1703936
v_mfma_f32_16x16x32_bf16 v[92:95], v[180:183], v[164:167], v[54:57]
ds_read_b128 v[32:35], v11 offset:1024
v_max3_f32 v88, v104, v105, v106
MAA 132,8,96
buffer_load_dwordx4 v5, s[24:27], s58 offen lds
MAA 132,28,100
v_max3_f32 v89, v107, v120, v121
v_max3_f32 v88, v88, v122, v123
MAA 132,48,160
v_max_f32 v90, v88, v89
v_max_f32 v89, v88, v89
MAA 132,68,164
s_nop 0
v_permlane16_swap_b32 v90, v89
MAA 148,68,172
buffer_load_dwordx4 v6, s[24:27], s58 offen offset:1024 lds
MAA 148,48,168
s_add_u32 m0, s59, 49920
s_xor_b32 s58, s87, 1835008
v_max_f32 v88, v90, v89
MAA 148,28,124
v_max_f32 v89, v90, v89
v_max3_f32 v84, v100, v101, v102
MAA 148,8,120
v_permlane32_swap_b32 v88, v89
v_max3_f32 v85, v103, v116, v117
v_max_f32 v88, v88, v89
v_mul_f32 v88, v88, v234
v_max3_f32 v84, v84, v118, v119
v_max_f32 v86, v84, v85
v_max_f32 v85, v84, v85
v_max3_f32 v80, v96, v97, v98
v_max3_f32 v81, v99, v112, v113
v_permlane16_swap_b32 v86, v85
v_max3_f32 v80, v80, v114, v115
v_max_f32 v84, v86, v85
v_max_f32 v85, v86, v85
v_max_f32 v82, v80, v81
v_max_f32 v81, v80, v81
v_permlane32_swap_b32 v84, v85
v_max3_f32 v76, v92, v93, v94
v_max_f32 v84, v84, v85
v_mul_f32 v84, v84, v230
v_permlane16_swap_b32 v82, v81
v_max3_f32 v77, v95, v108, v109
v_max_f32 v80, v82, v81
v_max_f32 v81, v82, v81
v_max3_f32 v76, v76, v110, v111
v_max_f32 v78, v76, v77
v_permlane32_swap_b32 v80, v81
v_max_f32 v77, v76, v77
v_max_f32 v80, v80, v81
v_mul_f32 v80, v80, v226
v_permlane16_swap_b32 v78, v77
v_pk_fma_f32 v[104:105], v[104:105], v[234:235], v[88:89] op_sel_hi:[1,0,0] neg_lo:[0,0,1] neg_hi:[0,0,1]
v_max_f32 v76, v78, v77
v_max_f32 v77, v78, v77
v_pk_fma_f32 v[106:107], v[106:107], v[234:235], v[88:89] op_sel_hi:[1,0,0] neg_lo:[0,0,1] neg_hi:[0,0,1]
v_pk_fma_f32 v[120:121], v[120:121], v[234:235], v[88:89] op_sel_hi:[1,0,0] neg_lo:[0,0,1] neg_hi:[0,0,1]
v_permlane32_swap_b32 v76, v77
v_pk_fma_f32 v[122:123], v[122:123], v[234:235], v[88:89] op_sel_hi:[1,0,0] neg_lo:[0,0,1] neg_hi:[0,0,1]
v_max_f32 v76, v76, v77
v_mul_f32 v76, v76, v222
v_pk_fma_f32 v[100:101], v[100:101], v[230:231], v[84:85] op_sel_hi:[1,0,0] neg_lo:[0,0,1] neg_hi:[0,0,1]
v_pk_fma_f32 v[102:103], v[102:103], v[230:231], v[84:85] op_sel_hi:[1,0,0] neg_lo:[0,0,1] neg_hi:[0,0,1]
v_pk_fma_f32 v[116:117], v[116:117], v[230:231], v[84:85] op_sel_hi:[1,0,0] neg_lo:[0,0,1] neg_hi:[0,0,1]
v_pk_fma_f32 v[118:119], v[118:119], v[230:231], v[84:85] op_sel_hi:[1,0,0] neg_lo:[0,0,1] neg_hi:[0,0,1]
v_pk_fma_f32 v[96:97], v[96:97], v[226:227], v[80:81] op_sel_hi:[1,0,0] neg_lo:[0,0,1] neg_hi:[0,0,1]
v_pk_fma_f32 v[98:99], v[98:99], v[226:227], v[80:81] op_sel_hi:[1,0,0] neg_lo:[0,0,1] neg_hi:[0,0,1]
v_pk_fma_f32 v[112:113], v[112:113], v[226:227], v[80:81] op_sel_hi:[1,0,0] neg_lo:[0,0,1] neg_hi:[0,0,1]
v_pk_fma_f32 v[114:115], v[114:115], v[226:227], v[80:81] op_sel_hi:[1,0,0] neg_lo:[0,0,1] neg_hi:[0,0,1]
v_pk_fma_f32 v[92:93], v[92:93], v[222:223], v[76:77] op_sel_hi:[1,0,0] neg_lo:[0,0,1] neg_hi:[0,0,1]
v_pk_fma_f32 v[94:95], v[94:95], v[222:223], v[76:77] op_sel_hi:[1,0,0] neg_lo:[0,0,1] neg_hi:[0,0,1]
v_pk_fma_f32 v[108:109], v[108:109], v[222:223], v[76:77] op_sel_hi:[1,0,0] neg_lo:[0,0,1] neg_hi:[0,0,1]
v_pk_fma_f32 v[110:111], v[110:111], v[222:223], v[76:77] op_sel_hi:[1,0,0] neg_lo:[0,0,1] neg_hi:[0,0,1]
v_pk_fma_f32 v[132:133], v[18:19], v[44:45], v[132:133] op_sel_hi:[1,0,1]
v_pk_mul_f32 v[132:133], v[132:133], v[22:23]
v_pk_fma_f32 v[134:135], v[20:21], v[44:45], v[134:135] op_sel_hi:[1,0,1]
v_pk_mul_f32 v[134:135], v[134:135], v[24:25]
v_pk_fma_f32 v[148:149], v[18:19], v[44:45], v[148:149] op_sel:[0,1,0] op_sel_hi:[1,1,1]
v_pk_mul_f32 v[148:149], v[148:149], v[22:23]
v_pk_fma_f32 v[150:151], v[20:21], v[44:45], v[150:151] op_sel:[0,1,0] op_sel_hi:[1,1,1]
v_pk_mul_f32 v[150:151], v[150:151], v[24:25]
v_exp_f32 v104, v104
s_nop 0
MAA 128,4,96
buffer_load_dwordx4 v5, s[24:27], s58 offen lds
MAA 128,24,100
v_exp_f32 v105, v105
MAA 128,44,160
v_exp_f32 v106, v106
MAA 128,64,164
v_exp_f32 v107, v107
MAA 144,64,172
buffer_load_dwordx4 v6, s[24:27], s58 offen offset:1024 lds
MAA 144,44,168
s_add_u32 m0, s59, 116480
s_xor_b32 s58, s87, 786432
v_exp_f32 v120, v120
MAA 144,24,124
v_exp_f32 v121, v121
MAA 144,4,120
v_exp_f32 v122, v122
MAA 124,0,96
buffer_load_dwordx4 v5, s[24:27], s58 offen lds
MAA 124,20,100
v_exp_f32 v123, v123
MAA 124,40,160
v_exp_f32 v100, v100
MAA 124,60,164
v_exp_f32 v101, v101
MAA 140,60,172
buffer_load_dwordx4 v6, s[24:27], s58 offen offset:1024 lds
MAA 140,40,168
s_add_u32 m0, s59, 124800
s_xor_b32 s58, s87, 917504
v_exp_f32 v102, v102
MAA 140,20,124
v_exp_f32 v103, v103
MAA 140,0,120
v_cvt_pk_bf16_f32 v72, v104, v105
v_cvt_pk_bf16_f32 v73, v106, v107
v_cvt_pk_bf16_f32 v74, v120, v121
v_cvt_pk_bf16_f32 v75, v122, v123
v_exp_f32 v116, v116
v_exp_f32 v117, v117
v_exp_f32 v118, v118
v_exp_f32 v119, v119
v_cvt_pk_bf16_f32 v68, v100, v101
v_cvt_pk_bf16_f32 v69, v102, v103
v_cvt_pk_bf16_f32 v70, v116, v117
v_cvt_pk_bf16_f32 v71, v118, v119
v_exp_f32 v96, v96
v_exp_f32 v97, v97
v_exp_f32 v98, v98
v_exp_f32 v99, v99
v_exp_f32 v112, v112
v_exp_f32 v113, v113
v_exp_f32 v114, v114
v_exp_f32 v115, v115
v_cvt_pk_bf16_f32 v64, v96, v97
v_cvt_pk_bf16_f32 v65, v98, v99
v_cvt_pk_bf16_f32 v66, v112, v113
v_cvt_pk_bf16_f32 v67, v114, v115
v_cvt_pk_bf16_f32 v206, v132, v133
v_cvt_pk_bf16_f32 v207, v134, v135
v_cvt_pk_bf16_f32 v216, v148, v149
v_cvt_pk_bf16_f32 v217, v150, v151
s_waitcnt lgkmcnt(3)
v_pk_fma_f32 v[128:129], v[240:241], v[44:45], v[128:129] op_sel_hi:[1,0,1]
s_waitcnt lgkmcnt(2)
v_pk_mul_f32 v[128:129], v[128:129], v[244:245]
v_cvt_pk_bf16_f32 v204, v128, v129
v_pk_fma_f32 v[130:131], v[242:243], v[44:45], v[130:131] op_sel_hi:[1,0,1]
v_pk_mul_f32 v[130:131], v[130:131], v[246:247]
v_cvt_pk_bf16_f32 v205, v130, v131
v_pk_fma_f32 v[144:145], v[240:241], v[44:45], v[144:145] op_sel:[0,1,0] op_sel_hi:[1,1,1]
v_pk_mul_f32 v[144:145], v[144:145], v[244:245]
v_cvt_pk_bf16_f32 v214, v144, v145
v_pk_fma_f32 v[146:147], v[242:243], v[44:45], v[146:147] op_sel:[0,1,0] op_sel_hi:[1,1,1]
v_pk_mul_f32 v[146:147], v[146:147], v[246:247]
v_cvt_pk_bf16_f32 v215, v146, v147
s_waitcnt lgkmcnt(1)
v_pk_fma_f32 v[124:125], v[28:29], v[44:45], v[124:125] op_sel_hi:[1,0,1]
s_waitcnt lgkmcnt(0)
v_pk_mul_f32 v[124:125], v[124:125], v[32:33]
v_cvt_pk_bf16_f32 v202, v124, v125
v_pk_fma_f32 v[126:127], v[30:31], v[44:45], v[126:127] op_sel_hi:[1,0,1]
v_pk_mul_f32 v[126:127], v[126:127], v[34:35]
v_cvt_pk_bf16_f32 v203, v126, v127
v_pk_fma_f32 v[140:141], v[28:29], v[44:45], v[140:141] op_sel:[0,1,0] op_sel_hi:[1,1,1]
v_pk_mul_f32 v[140:141], v[140:141], v[32:33]
v_cvt_pk_bf16_f32 v212, v140, v141
v_pk_fma_f32 v[142:143], v[30:31], v[44:45], v[142:143] op_sel:[0,1,0] op_sel_hi:[1,1,1]
v_pk_mul_f32 v[142:143], v[142:143], v[34:35]
v_cvt_pk_bf16_f32 v213, v142, v143
s_nop 0
v_mfma_f32_16x16x32_bf16 v[88:91], v[248:251], v[72:75], 0
buffer_load_dwordx4 v5, s[24:27], s58 offen lds
v_mfma_f32_16x16x32_bf16 v[104:107], v[206:209], v[72:75], 0
v_exp_f32 v92, v92
v_mfma_f32_16x16x32_bf16 v[120:123], v[216:219], v[72:75], 0
v_exp_f32 v93, v93
v_mfma_f32_16x16x32_bf16 v[84:87], v[248:251], v[68:71], 0
v_exp_f32 v94, v94
v_mfma_f32_16x16x32_bf16 v[100:103], v[204:207], v[68:71], 0
buffer_load_dwordx4 v6, s[24:27], s58 offen offset:1024 lds
v_mfma_f32_16x16x32_bf16 v[116:119], v[214:217], v[68:71], 0
v_exp_f32 v95, v95
v_mfma_f32_16x16x32_bf16 v[80:83], v[248:251], v[64:67], 0
v_exp_f32 v108, v108
v_mfma_f32_16x16x32_bf16 v[96:99], v[202:205], v[64:67], 0
v_exp_f32 v109, v109
v_mfma_f32_16x16x32_bf16 v[112:115], v[212:215], v[64:67], 0
v_exp_f32 v110, v110
v_cvt_pk_bf16_f32 v60, v92, v93
v_cvt_pk_bf16_f32 v61, v94, v95
v_cvt_pk_bf16_f32 v62, v108, v109
v_rcp_f32 v88, v88
v_rcp_f32 v84, v84
v_rcp_f32 v80, v80
v_pk_mul_f32 v[104:105], v[104:105], v[88:89] op_sel_hi:[1,0]
v_pk_mul_f32 v[106:107], v[106:107], v[88:89] op_sel_hi:[1,0]
v_pk_mul_f32 v[120:121], v[120:121], v[88:89] op_sel_hi:[1,0]
v_pk_mul_f32 v[122:123], v[122:123], v[88:89] op_sel_hi:[1,0]
v_cvt_pk_bf16_f32 v176, v104, v105
v_cvt_pk_bf16_f32 v177, v106, v107
v_cvt_pk_bf16_f32 v178, v120, v121
v_cvt_pk_bf16_f32 v179, v122, v123
buffer_store_dwordx4 v[176:179], v4, s[16:19], s74 offen offset:3072 sc1
v_pk_mul_f32 v[100:101], v[100:101], v[84:85] op_sel_hi:[1,0]
v_pk_mul_f32 v[102:103], v[102:103], v[84:85] op_sel_hi:[1,0]
v_pk_mul_f32 v[116:117], v[116:117], v[84:85] op_sel_hi:[1,0]
v_pk_mul_f32 v[118:119], v[118:119], v[84:85] op_sel_hi:[1,0]
v_cvt_pk_bf16_f32 v172, v100, v101
v_cvt_pk_bf16_f32 v173, v102, v103
v_cvt_pk_bf16_f32 v174, v116, v117
v_cvt_pk_bf16_f32 v175, v118, v119
buffer_store_dwordx4 v[172:175], v4, s[16:19], s74 offen offset:2048 sc1
v_pk_mul_f32 v[96:97], v[96:97], v[80:81] op_sel_hi:[1,0]
v_pk_mul_f32 v[98:99], v[98:99], v[80:81] op_sel_hi:[1,0]
v_pk_mul_f32 v[112:113], v[112:113], v[80:81] op_sel_hi:[1,0]
v_pk_mul_f32 v[114:115], v[114:115], v[80:81] op_sel_hi:[1,0]
v_cvt_pk_bf16_f32 v168, v96, v97
v_cvt_pk_bf16_f32 v169, v98, v99
v_cvt_pk_bf16_f32 v170, v112, v113
v_cvt_pk_bf16_f32 v171, v114, v115
buffer_store_dwordx4 v[168:171], v4, s[16:19], s74 offen offset:1024 sc1
v_exp_f32 v111, v111
s_nop 0
v_cvt_pk_bf16_f32 v63, v110, v111
s_nop 1
v_mfma_f32_16x16x32_bf16 v[76:79], v[248:251], v[60:63], 0
v_mfma_f32_16x16x32_bf16 v[92:95], v[200:203], v[60:63], 0
v_mfma_f32_16x16x32_bf16 v[108:111], v[210:213], v[60:63], 0
s_nop 5
v_rcp_f32 v76, v76
s_nop 0
v_pk_mul_f32 v[92:93], v[92:93], v[76:77] op_sel_hi:[1,0]
v_cvt_pk_bf16_f32 v164, v92, v93
v_pk_mul_f32 v[94:95], v[94:95], v[76:77] op_sel_hi:[1,0]
v_cvt_pk_bf16_f32 v165, v94, v95
v_pk_mul_f32 v[108:109], v[108:109], v[76:77] op_sel_hi:[1,0]
v_cvt_pk_bf16_f32 v166, v108, v109
v_pk_mul_f32 v[110:111], v[110:111], v[76:77] op_sel_hi:[1,0]
v_cvt_pk_bf16_f32 v167, v110, v111
buffer_store_dwordx4 v[164:167], v4, s[16:19], s74 offen sc1
s_nop 1
s_branch .Lqkve56
.Lpad15:
s_cbranch_execz .Lpad18
.Lsp50:
s_mov_b32 s15, 0
.Lsp50l:
v_mov_b32 v25, 0
buffer_atomic_add v25, v22, s[16:19], s73 offen sc0
s_add_u32 s15, s15, 1
s_cmp_gt_u32 s15, 100000
s_waitcnt vmcnt(0)
s_cbranch_scc1 .Lsp50b
v_cmp_gt_u32 vcc, v23, v25
s_nop 0
s_cbranch_vccnz .Lsp50l
s_branch .Lsp50b
.Lxs51:
s_mov_b32 s15, 0
.Lxs51l:
v_mov_b32 v15, 0
buffer_atomic_add v15, v12, s[16:19], s70 offen sc0
s_add_u32 s15, s15, 1
s_cmp_gt_u32 s15, 100000
s_waitcnt vmcnt(0)
s_cbranch_scc1 .Lxs51b
v_cmp_ne_u32 vcc, 0, v15
s_nop 0
s_cbranch_vccz .Lxs51l
s_branch .Lxs51b
.Lqkv55:
.Lpad16:
s_cbranch_execz .Lpad19
s_add_u32 m0, s55, 36864
s_nop 0
buffer_load_dwordx4 v21, s[16:19], s52 offen sc1 lds
buffer_load_dwordx4 v21, s[16:19], s52 offen offset:1024 sc1 lds
buffer_load_dword v22, s[16:19], s52 offen offset:2048 sc1 lds
s_add_u32 s52, s52, 131072
s_add_u32 m0, s55, 46080
s_nop 0
buffer_load_dwordx4 v21, s[16:19], s52 offen sc1 lds
buffer_load_dwordx4 v21, s[16:19], s52 offen offset:1024 sc1 lds
buffer_load_dword v22, s[16:19], s52 offen offset:2048 sc1 lds
s_add_u32 s52, s52, 131072
s_add_u32 m0, s55, 0
s_nop 0
buffer_load_dwordx4 v21, s[16:19], s52 offen sc1 lds
buffer_load_dwordx4 v21, s[16:19], s52 offen offset:1024 sc1 lds
buffer_load_dword v22, s[16:19], s52 offen offset:2048 sc1 lds
s_add_u32 s52, s52, 131072
s_add_u32 m0, s55, 9216
s_nop 0
buffer_load_dwordx4 v21, s[16:19], s52 offen sc1 lds
buffer_load_dwordx4 v21, s[16:19], s52 offen offset:1024 sc1 lds
buffer_load_dword v22, s[16:19], s52 offen offset:2048 sc1 lds
s_add_u32 s52, s52, 131072
s_add_u32 m0, s55, 18432
s_nop 0
buffer_load_dwordx4 v21, s[16:19], s52 offen sc1 lds
buffer_load_dwordx4 v21, s[16:19], s52 offen offset:1024 sc1 lds
buffer_load_dword v22, s[16:19], s52 offen offset:2048 sc1 lds
s_add_u32 s52, s52, 131072
s_add_u32 m0, s55, 27648
s_nop 0
buffer_load_dwordx4 v21, s[16:19], s52 offen sc1 lds
buffer_load_dwordx4 v21, s[16:19], s52 offen offset:1024 sc1 lds
buffer_load_dword v22, s[16:19], s52 offen offset:2048 sc1 lds
s_add_u32 s52, s52, 131072
s_waitcnt vmcnt(12)
s_barrier
RD 0,23,36864
RD 4,23,37888
RD 8,23,39168
RD 12,23,40192
RD 16,24,38912
RD 20,23,46080
RD 24,23,47104
RD 28,23,48384
RD 32,23,49408
RD 36,24,48128
s_waitcnt lgkmcnt(0)
s_mov_b32 s15, -2
.p2align 6
.Lk58:
s_waitcnt vmcnt(9) lgkmcnt(8)
s_barrier
MAA 60,80,0
TR 104,25,49696
s_add_u32 m0, s56, 104832
MAA 60,84,20
buffer_load_dwordx4 v18, s[20:23], s54 offen lds
MAA 64,84,24
TR 106,25,50208
v_add_f32 v164, v164, v168
MAA 64,80,4
TR 108,25,62112
MAA 68,80,8
TR 110,25,62624
MAA 68,84,28
buffer_load_dwordx4 v19, s[20:23], s54 offen offset:1024 lds
MAA 72,84,32
TR 112,25,50720
v_add_f32 v165, v165, v169
MAA 72,80,12
TR 114,25,51232
s_waitcnt lgkmcnt(6)
MAA 104,88,12
TR 116,25,63136
MAA 104,92,32
buffer_load_dwordx4 v20, s[20:23], s54 offen offset:2048 lds
MAA 100,92,28
s_add_u32 s54, s54, 196608
s_add_u32 m0, s55, 36864
MAA 100,88,8
buffer_load_dwordx4 v21, s[16:19], s52 offen sc1 lds
MAA 96,88,4
TR 118,25,63648
MAA 96,92,24
TR 120,25,51744
v_add_f32 v166, v166, v170
MAA 92,92,20
TR 122,25,52256
MAA 92,88,0
buffer_load_dwordx4 v21, s[16:19], s52 offen offset:1024 sc1 lds
MAA 124,0,96
TR 124,25,64160
MAA 124,20,100
TR 126,25,64672
v_add_f32 v167, v167, v171
MAA 128,24,100
ds_read_b128 a[40:43], v23
MAA 128,4,96
buffer_load_dword v22, s[16:19], s52 offen offset:2048 sc1 lds
MAA 132,8,96
RD 44,23,1024
s_add_u32 s52, s52, 131072
MAA 132,28,100
buffer_load_dword v27, v14, s[20:23], s44 offen
MAA 136,32,100
RD 48,23,2304
s_add_u32 s44, s44, 1572864
MAA 136,12,96
RD 52,23,3328
MAA 156,16,96
RD 56,24,2048
MAA 156,36,100
s_waitcnt vmcnt(13) lgkmcnt(5)
s_barrier
MAA 76,104,0
RD 60,23,9216
s_add_u32 m0, s56, 117248
MAA 76,108,20
buffer_load_dwordx4 v18, s[20:23], s54 offen lds
MAA 80,108,24
RD 64,23,10240
MAA 80,104,4
RD 68,23,11520
MAA 84,104,8
RD 72,23,12544
MAA 84,108,28
buffer_load_dwordx4 v19, s[20:23], s54 offen offset:1024 lds
MAA 88,108,32
RD 76,24,11264
MAA 88,104,12
buffer_load_dwordx4 v20, s[20:23], s54 offen offset:2048 lds
MAA 120,112,12
ds_read_b64_tr_b16 a[80:81], v25
s_add_u32 s54, s54, 196608
MAA 120,116,32
TR 82,25,512
MAA 116,116,28
TR 84,25,12416
s_add_u32 m0, s55, 46080
MAA 116,112,8
buffer_load_dwordx4 v21, s[16:19], s52 offen sc1 lds
MAA 112,112,4
TR 86,25,12928
MAA 112,116,24
TR 88,25,1024
MAA 108,116,20
TR 90,25,1536
MAA 108,112,0
buffer_load_dwordx4 v21, s[16:19], s52 offen offset:1024 sc1 lds
MAA 140,0,120
TR 92,25,13440
MAA 140,20,124
TR 94,25,13952
MAA 144,24,124
TR 96,25,2048
MAA 144,4,120
buffer_load_dword v22, s[16:19], s52 offen offset:2048 sc1 lds
MAA 148,8,120
TR 98,25,2560
s_add_u32 s52, s52, 131072
MAA 148,28,124
buffer_load_dwordx4 v[168:171], v26, s[16:19], s75 offen sc1
MAA 152,32,124
TR 100,25,14464
MAA 152,12,120
TR 102,25,14976
MAA 160,16,120
MAA 160,36,124
s_waitcnt vmcnt(17) lgkmcnt(8)
s_barrier
MAA 60,80,40
TR 104,25,32
v_add_f32 v164, v164, v172
MAA 60,84,60
TR 106,25,544
MAA 64,84,64
TR 108,25,12448
s_add_u32 m0, s56, 129664
MAA 64,80,44
buffer_load_dwordx4 v18, s[20:23], s54 offen lds
MAA 68,80,48
TR 110,25,12960
MAA 68,84,68
TR 112,25,1056
MAA 72,84,72
TR 114,25,1568
v_add_f32 v165, v165, v173
MAA 72,80,52
TR 116,25,13472
s_waitcnt lgkmcnt(7)
MAA 104,88,52
TR 118,25,13984
MAA 104,92,72
buffer_load_dwordx4 v19, s[20:23], s54 offen offset:1024 lds
MAA 100,92,68
TR 120,25,2080
MAA 100,88,48
buffer_load_dwordx4 v20, s[20:23], s54 offen offset:2048 lds
MAA 96,88,44
s_add_u32 s54, s54, 196608
MAA 96,92,64
TR 122,25,2592
v_add_f32 v166, v166, v174
MAA 92,92,60
TR 124,25,14496
s_add_u32 m0, s55, 0
MAA 92,88,40
buffer_load_dwordx4 v21, s[16:19], s52 offen sc1 lds
MAA 124,40,96
TR 126,25,15008
MAA 124,60,100
RD 0,23,18432
MAA 128,64,100
RD 4,23,19456
MAA 128,44,96
buffer_load_dwordx4 v21, s[16:19], s52 offen offset:1024 sc1 lds
MAA 132,48,96
RD 8,23,20736
.Lpad17:
s_cbranch_execz .Lpad20
v_add_f32 v167, v167, v175
MAA 132,68,100
RD 12,23,21760
MAA 136,72,100
RD 16,24,20480
MAA 136,52,96
buffer_load_dword v22, s[16:19], s52 offen offset:2048 sc1 lds
MAA 156,56,96
s_add_u32 s52, s52, 131072
MAA 156,76,100
s_waitcnt vmcnt(17) lgkmcnt(5)
s_barrier
MAA 76,104,40
RD 20,23,27648
s_add_u32 m0, s56, 67584
MAA 76,108,60
buffer_load_dwordx4 v18, s[20:23], s54 offen lds
MAA 80,108,64
RD 24,23,28672
MAA 80,104,44
RD 28,23,29952
MAA 84,104,48
RD 32,23,30976
MAA 84,108,68
buffer_load_dwordx4 v19, s[20:23], s54 offen offset:1024 lds
MAA 88,108,72
RD 36,24,29696
MAA 88,104,52
buffer_load_dwordx4 v20, s[20:23], s54 offen offset:2048 lds
MAA 120,112,52
TR 80,25,24832
s_add_u32 s54, s54, 196608
MAA 120,116,72
TR 82,25,25344
MAA 116,116,68
TR 84,25,37248
s_add_u32 m0, s55, 9216
MAA 116,112,48
buffer_load_dwordx4 v21, s[16:19], s52 offen sc1 lds
MAA 112,112,44
TR 86,25,37760
MAA 112,116,64
TR 88,25,25856
MAA 108,116,60
TR 90,25,26368
MAA 108,112,40
buffer_load_dwordx4 v21, s[16:19], s52 offen offset:1024 sc1 lds
MAA 140,40,120
TR 92,25,38272
MAA 140,60,124
TR 94,25,38784
MAA 144,64,124
TR 96,25,26880
MAA 144,44,120
buffer_load_dword v22, s[16:19], s52 offen offset:2048 sc1 lds
MAA 148,48,120
TR 98,25,27392
s_add_u32 s52, s52, 131072
MAA 148,68,124
buffer_load_dwordx4 v[172:175], v26, s[16:19], s75 offen offset:1024 sc1
MAA 152,72,124
TR 100,25,39296
s_add_u32 s75, s75, 2048
MAA 152,52,120
TR 102,25,39808
MAA 160,56,120
MAA 160,76,124
s_waitcnt vmcnt(21) lgkmcnt(8)
s_barrier
MAA 60,80,0
TR 104,25,24864
MAA 60,84,20
TR 106,25,25376
MAA 64,84,24
TR 108,25,37280
s_add_u32 m0, s56, 80000
MAA 64,80,4
buffer_load_dwordx4 v18, s[20:23], s54 offen lds
MAA 68,80,8
TR 110,25,37792
MAA 68,84,28
TR 112,25,25888
MAA 72,84,32
TR 114,25,26400
MAA 72,80,12
TR 116,25,38304
s_waitcnt lgkmcnt(7)
MAA 104,88,12
TR 118,25,38816
MAA 104,92,32
buffer_load_dwordx4 v19, s[20:23], s54 offen offset:1024 lds
MAA 100,92,28
TR 120,25,26912
MAA 100,88,8
buffer_load_dwordx4 v20, s[20:23], s54 offen offset:2048 lds
MAA 96,88,4
s_add_u32 s54, s54, 196608
MAA 96,92,24
TR 122,25,27424
MAA 92,92,20
TR 124,25,39328
s_add_u32 m0, s55, 18432
MAA 92,88,0
buffer_load_dwordx4 v21, s[16:19], s52 offen sc1 lds
MAA 124,0,96
TR 126,25,39840
MAA 124,20,100
RD 40,23,36864
MAA 128,24,100
RD 44,23,37888
MAA 128,4,96
buffer_load_dwordx4 v21, s[16:19], s52 offen offset:1024 sc1 lds
MAA 132,8,96
RD 48,23,39168
MAA 132,28,100
RD 52,23,40192
MAA 136,32,100
RD 56,24,38912
MAA 136,12,96
buffer_load_dword v22, s[16:19], s52 offen offset:2048 sc1 lds
MAA 156,16,96
s_add_u32 s52, s52, 131072
MAA 156,36,100
s_waitcnt vmcnt(16) lgkmcnt(5)
s_barrier
MAA 76,104,0
RD 60,23,46080
MAA 76,108,20
RD 64,23,47104
MAA 80,108,24
RD 68,23,48384
s_add_u32 m0, s56, 92416
MAA 80,104,4
buffer_load_dwordx4 v18, s[20:23], s54 offen lds
MAA 84,104,8
RD 72,23,49408
MAA 84,108,28
RD 76,24,48128
MAA 88,108,32
TR 80,25,49664
MAA 88,104,12
buffer_load_dwordx4 v19, s[20:23], s54 offen offset:1024 lds
MAA 120,112,12
TR 82,25,50176
MAA 120,116,32
TR 84,25,62080
MAA 116,116,28
TR 86,25,62592
MAA 116,112,8
buffer_load_dwordx4 v20, s[20:23], s54 offen offset:2048 lds
MAA 112,112,4
s_add_u32 s54, s54, 196608
MAA 112,116,24
TR 88,25,50688
MAA 108,116,20
TR 90,25,51200
s_add_u32 m0, s55, 27648
MAA 108,112,0
buffer_load_dwordx4 v21, s[16:19], s52 offen sc1 lds
MAA 140,0,120
TR 92,25,63104
MAA 140,20,124
TR 94,25,63616
MAA 144,24,124
TR 96,25,51712
MAA 144,4,120
buffer_load_dwordx4 v21, s[16:19], s52 offen offset:1024 sc1 lds
MAA 148,8,120
TR 98,25,52224
MAA 148,28,124
TR 100,25,64128
MAA 152,32,124
TR 102,25,64640
MAA 152,12,120
buffer_load_dword v22, s[16:19], s52 offen offset:2048 sc1 lds
MAA 160,16,120
s_add_u32 s52, s52, 131072
MAA 160,36,124
s_waitcnt vmcnt(19) lgkmcnt(8)
s_barrier
MAA 60,80,40
TR 104,25,49696
s_add_u32 m0, s56, 104832
MAA 60,84,60
buffer_load_dwordx4 v18, s[20:23], s54 offen lds
MAA 64,84,64
TR 106,25,50208
v_add_f32 v164, v164, v168
MAA 64,80,44
TR 108,25,62112
MAA 68,80,48
TR 110,25,62624
MAA 68,84,68
buffer_load_dwordx4 v19, s[20:23], s54 offen offset:1024 lds
MAA 72,84,72
TR 112,25,50720
v_add_f32 v165, v165, v169
MAA 72,80,52
TR 114,25,51232
s_waitcnt lgkmcnt(6)
MAA 104,88,52
TR 116,25,63136
MAA 104,92,72
buffer_load_dwordx4 v20, s[20:23], s54 offen offset:2048 lds
MAA 100,92,68
s_add_u32 s54, s54, 196608
s_add_u32 m0, s55, 36864
MAA 100,88,48
buffer_load_dwordx4 v21, s[16:19], s52 offen sc1 lds
MAA 96,88,44
TR 118,25,63648
MAA 96,92,64
TR 120,25,51744
v_add_f32 v166, v166, v170
MAA 92,92,60
TR 122,25,52256
MAA 92,88,40
buffer_load_dwordx4 v21, s[16:19], s52 offen offset:1024 sc1 lds
MAA 124,40,96
TR 124,25,64160
MAA 124,60,100
TR 126,25,64672
v_add_f32 v167, v167, v171
MAA 128,64,100
ds_read_b128 a[0:3], v23
MAA 128,44,96
buffer_load_dword v22, s[16:19], s52 offen offset:2048 sc1 lds
MAA 132,48,96
RD 4,23,1024
s_add_u32 s52, s52, 131072
MAA 132,68,100
buffer_load_dword v27, v14, s[20:23], s44 offen
MAA 136,72,100
RD 8,23,2304
s_add_u32 s44, s44, 1572864
MAA 136,52,96
RD 12,23,3328
MAA 156,56,96
RD 16,24,2048
MAA 156,76,100
s_waitcnt vmcnt(16) lgkmcnt(5)
s_barrier
MAA 76,104,40
RD 20,23,9216
s_add_u32 m0, s56, 117248
MAA 76,108,60
buffer_load_dwordx4 v18, s[20:23], s54 offen lds
MAA 80,108,64
RD 24,23,10240
MAA 80,104,44
RD 28,23,11520
MAA 84,104,48
RD 32,23,12544
MAA 84,108,68
buffer_load_dwordx4 v19, s[20:23], s54 offen offset:1024 lds
MAA 88,108,72
RD 36,24,11264
MAA 88,104,52
buffer_load_dwordx4 v20, s[20:23], s54 offen offset:2048 lds
MAA 120,112,52
ds_read_b64_tr_b16 a[80:81], v25
s_add_u32 s54, s54, 196608
MAA 120,116,72
TR 82,25,512
MAA 116,116,68
TR 84,25,12416
s_add_u32 m0, s55, 46080
MAA 116,112,48
buffer_load_dwordx4 v21, s[16:19], s52 offen sc1 lds
MAA 112,112,44
TR 86,25,12928
MAA 112,116,64
TR 88,25,1024
MAA 108,116,60
TR 90,25,1536
MAA 108,112,40
buffer_load_dwordx4 v21, s[16:19], s52 offen offset:1024 sc1 lds
MAA 140,40,120
TR 92,25,13440
MAA 140,60,124
TR 94,25,13952
MAA 144,64,124
TR 96,25,2048
MAA 144,44,120
buffer_load_dword v22, s[16:19], s52 offen offset:2048 sc1 lds
MAA 148,48,120
TR 98,25,2560
s_add_u32 s52, s52, 131072
MAA 148,68,124
buffer_load_dwordx4 v[168:171], v26, s[16:19], s75 offen sc1
MAA 152,72,124
TR 100,25,14464
MAA 152,52,120
TR 102,25,14976
MAA 160,56,120
MAA 160,76,124
s_waitcnt vmcnt(20) lgkmcnt(8)
s_barrier
MAA 60,80,0
TR 104,25,32
v_add_f32 v164, v164, v172
MAA 60,84,20
TR 106,25,544
MAA 64,84,24
TR 108,25,12448
s_add_u32 m0, s56, 129664
MAA 64,80,4
buffer_load_dwordx4 v18, s[20:23], s54 offen lds
MAA 68,80,8
TR 110,25,12960
MAA 68,84,28
TR 112,25,1056
MAA 72,84,32
TR 114,25,1568
v_add_f32 v165, v165, v173
MAA 72,80,12
TR 116,25,13472
s_waitcnt lgkmcnt(7)
MAA 104,88,12
TR 118,25,13984
MAA 104,92,32
buffer_load_dwordx4 v19, s[20:23], s54 offen offset:1024 lds
MAA 100,92,28
TR 120,25,2080
MAA 100,88,8
buffer_load_dwordx4 v20, s[20:23], s54 offen offset:2048 lds
MAA 96,88,4
s_add_u32 s54, s54, 196608
MAA 96,92,24
TR 122,25,2592
v_add_f32 v166, v166, v174
MAA 92,92,20
TR 124,25,14496
s_add_u32 m0, s55, 0
MAA 92,88,0
buffer_load_dwordx4 v21, s[16:19], s52 offen sc1 lds
MAA 124,0,96
TR 126,25,15008
MAA 124,20,100
RD 40,23,18432
MAA 128,24,100
RD 44,23,19456
MAA 128,4,96
buffer_load_dwordx4 v21, s[16:19], s52 offen offset:1024 sc1 lds
MAA 132,8,96
RD 48,23,20736
v_add_f32 v167, v167, v175
MAA 132,28,100
RD 52,23,21760
MAA 136,32,100
RD 56,24,20480
MAA 136,12,96
buffer_load_dword v22, s[16:19], s52 offen offset:2048 sc1 lds
MAA 156,16,96
s_add_u32 s52, s52, 131072
MAA 156,36,100
s_waitcnt vmcnt(17) lgkmcnt(5)
s_barrier
MAA 76,104,0
RD 60,23,27648
s_add_u32 m0, s56, 67584
MAA 76,108,20
buffer_load_dwordx4 v18, s[20:23], s54 offen lds
MAA 80,108,24
RD 64,23,28672
MAA 80,104,4
RD 68,23,29952
MAA 84,104,8
RD 72,23,30976
MAA 84,108,28
buffer_load_dwordx4 v19, s[20:23], s54 offen offset:1024 lds
MAA 88,108,32
RD 76,24,29696
MAA 88,104,12
buffer_load_dwordx4 v20, s[20:23], s54 offen offset:2048 lds
MAA 120,112,12
TR 80,25,24832
s_add_u32 s54, s54, 196608
MAA 120,116,32
TR 82,25,25344
MAA 116,116,28
TR 84,25,37248
s_add_u32 m0, s55, 9216
MAA 116,112,8
buffer_load_dwordx4 v21, s[16:19], s52 offen sc1 lds
MAA 112,112,4
TR 86,25,37760
MAA 112,116,24
TR 88,25,25856
MAA 108,116,20
TR 90,25,26368
MAA 108,112,0
buffer_load_dwordx4 v21, s[16:19], s52 offen offset:1024 sc1 lds
MAA 140,0,120
TR 92,25,38272
MAA 140,20,124
TR 94,25,38784
MAA 144,24,124
TR 96,25,26880
MAA 144,4,120
buffer_load_dword v22, s[16:19], s52 offen offset:2048 sc1 lds
MAA 148,8,120
TR 98,25,27392
s_add_u32 s52, s52, 131072
MAA 148,28,124
buffer_load_dwordx4 v[172:175], v26, s[16:19], s75 offen offset:1024 sc1
MAA 152,32,124
TR 100,25,39296
s_add_u32 s75, s75, 2048
MAA 152,12,120
TR 102,25,39808
MAA 160,16,120
MAA 160,36,124
s_waitcnt vmcnt(21) lgkmcnt(8)
s_barrier
MAA 60,80,40
TR 104,25,24864
MAA 60,84,60
TR 106,25,25376
MAA 64,84,64
TR 108,25,37280
s_add_u32 m0, s56, 80000
MAA 64,80,44
buffer_load_dwordx4 v18, s[20:23], s54 offen lds
MAA 68,80,48
TR 110,25,37792
MAA 68,84,68
TR 112,25,25888
MAA 72,84,72
TR 114,25,26400
MAA 72,80,52
TR 116,25,38304
s_waitcnt lgkmcnt(7)
MAA 104,88,52
TR 118,25,38816
MAA 104,92,72
buffer_load_dwordx4 v19, s[20:23], s54 offen offset:1024 lds
MAA 100,92,68
TR 120,25,26912
MAA 100,88,48
buffer_load_dwordx4 v20, s[20:23], s54 offen offset:2048 lds
MAA 96,88,44
s_add_u32 s54, s54, 196608
MAA 96,92,64
TR 122,25,27424
MAA 92,92,60
TR 124,25,39328
s_add_u32 m0, s55, 18432
MAA 92,88,40
buffer_load_dwordx4 v21, s[16:19], s52 offen sc1 lds
MAA 124,40,96
TR 126,25,39840
MAA 124,60,100
RD 0,23,36864
MAA 128,64,100
RD 4,23,37888
MAA 128,44,96
buffer_load_dwordx4 v21, s[16:19], s52 offen offset:1024 sc1 lds
MAA 132,48,96
RD 8,23,39168
MAA 132,68,100
RD 12,23,40192
MAA 136,72,100
RD 16,24,38912
MAA 136,52,96
buffer_load_dword v22, s[16:19], s52 offen offset:2048 sc1 lds
MAA 156,56,96
s_add_u32 s52, s52, 131072
MAA 156,76,100
s_waitcnt vmcnt(16) lgkmcnt(5)
s_barrier
MAA 76,104,40
RD 20,23,46080
MAA 76,108,60
RD 24,23,47104
MAA 80,108,64
RD 28,23,48384
s_add_u32 m0, s56, 92416
MAA 80,104,44
buffer_load_dwordx4 v18, s[20:23], s54 offen lds
MAA 84,104,48
RD 32,23,49408
MAA 84,108,68
RD 36,24,48128
MAA 88,108,72
TR 80,25,49664
MAA 88,104,52
buffer_load_dwordx4 v19, s[20:23], s54 offen offset:1024 lds
MAA 120,112,52
TR 82,25,50176
MAA 120,116,72
TR 84,25,62080
MAA 116,116,68
TR 86,25,62592
MAA 116,112,48
buffer_load_dwordx4 v20, s[20:23], s54 offen offset:2048 lds
MAA 112,112,44
s_add_u32 s54, s54, 196608
MAA 112,116,64
TR 88,25,50688
MAA 108,116,60
TR 90,25,51200
s_add_u32 m0, s55, 27648
MAA 108,112,40
buffer_load_dwordx4 v21, s[16:19], s52 offen sc1 lds
MAA 140,40,120
TR 92,25,63104
MAA 140,60,124
TR 94,25,63616
MAA 144,64,124
TR 96,25,51712
MAA 144,44,120
buffer_load_dwordx4 v21, s[16:19], s52 offen offset:1024 sc1 lds
MAA 148,48,120
TR 98,25,52224
MAA 148,68,124
TR 100,25,64128
MAA 152,72,124
TR 102,25,64640
MAA 152,52,120
buffer_load_dword v22, s[16:19], s52 offen offset:2048 sc1 lds
MAA 160,56,120
s_add_u32 s52, s52, 131072
s_add_u32 s15, s15, 1
MAA 160,76,124
s_cbranch_scc0 .Lk58
s_waitcnt vmcnt(19) lgkmcnt(8)
s_barrier
MAA 60,80,0
TR 104,25,49696
.Lpad18:
s_cbranch_execz .Lnopoll53r
v_add_f32 v164, v164, v168
MAA 60,84,20
TR 106,25,50208
s_add_u32 m0, s56, 104832
MAA 64,84,24
buffer_load_dwordx4 v18, s[20:23], s54 offen lds
MAA 64,80,4
TR 108,25,62112
v_add_f32 v165, v165, v169
MAA 68,80,8
TR 110,25,62624
v_add_f32 v166, v166, v170
MAA 68,84,28
TR 112,25,50720
v_add_f32 v167, v167, v171
MAA 72,84,32
buffer_load_dwordx4 v19, s[20:23], s54 offen offset:1024 lds
MAA 72,80,12
TR 114,25,51232
s_waitcnt lgkmcnt(6)
MAA 104,88,12
TR 116,25,63136
MAA 104,92,32
TR 118,25,63648
MAA 100,92,28
buffer_load_dwordx4 v20, s[20:23], s54 offen offset:2048 lds
MAA 100,88,8
TR 120,25,51744
s_add_u32 s54, s54, 196608
MAA 96,88,4
TR 122,25,52256
s_add_u32 m0, s55, 36864
MAA 96,92,24
TR 124,25,64160
MAA 92,92,20
buffer_load_dwordx4 v21, s[16:19], s52 offen sc1 lds
MAA 92,88,0
TR 126,25,64672
MAA 124,0,96
ds_read_b128 a[40:43], v23
MAA 124,20,100
RD 44,23,1024
MAA 128,24,100
buffer_load_dwordx4 v21, s[16:19], s52 offen offset:1024 sc1 lds
MAA 128,4,96
RD 48,23,2304
MAA 132,8,96
RD 52,23,3328
MAA 132,28,100
RD 56,24,2048
MAA 136,32,100
buffer_load_dword v22, s[16:19], s52 offen offset:2048 sc1 lds
MAA 136,12,96
s_add_u32 s52, s52, 131072
MAA 156,16,96
MAA 156,36,100
s_waitcnt vmcnt(15) lgkmcnt(5)
s_barrier
MAA 76,104,0
RD 60,23,9216
v_add_f32 v164, v164, v172
MAA 76,108,20
RD 64,23,10240
s_add_u32 m0, s56, 117248
MAA 80,108,24
buffer_load_dwordx4 v18, s[20:23], s54 offen lds
MAA 80,104,4
RD 68,23,11520
v_add_f32 v165, v165, v173
MAA 84,104,8
RD 72,23,12544
v_add_f32 v166, v166, v174
MAA 84,108,28
RD 76,24,11264
v_add_f32 v167, v167, v175
MAA 88,108,32
buffer_load_dwordx4 v19, s[20:23], s54 offen offset:1024 lds
MAA 88,104,12
ds_read_b64_tr_b16 a[80:81], v25
MAA 120,112,12
TR 82,25,512
MAA 120,116,32
TR 84,25,12416
MAA 116,116,28
buffer_load_dwordx4 v20, s[20:23], s54 offen offset:2048 lds
MAA 116,112,8
TR 86,25,12928
s_add_u32 s54, s54, 196608
MAA 112,112,4
TR 88,25,1024
s_add_u32 m0, s55, 46080
MAA 112,116,24
TR 90,25,1536
MAA 108,116,20
buffer_load_dwordx4 v21, s[16:19], s52 offen sc1 lds
MAA 108,112,0
TR 92,25,13440
MAA 140,0,120
TR 94,25,13952
MAA 140,20,124
TR 96,25,2048
MAA 144,24,124
buffer_load_dwordx4 v21, s[16:19], s52 offen offset:1024 sc1 lds
MAA 144,4,120
TR 98,25,2560
MAA 148,8,120
TR 100,25,14464
MAA 148,28,124
TR 102,25,14976
MAA 152,32,124
buffer_load_dword v22, s[16:19], s52 offen offset:2048 sc1 lds
MAA 152,12,120
s_add_u32 s52, s52, 131072
v_permlane32_swap_b32 v164, v166
MAA 160,16,120
v_permlane32_swap_b32 v165, v167
MAA 160,36,124
s_waitcnt vmcnt(18) lgkmcnt(8)
s_barrier
MAA 60,80,40
TR 104,25,32
v_add_f32 v164, v164, v166
MAA 60,84,60
TR 106,25,544
s_add_u32 m0, s56, 129664
MAA 64,84,64
buffer_load_dwordx4 v18, s[20:23], s54 offen lds
MAA 64,80,44
TR 108,25,12448
v_add_f32 v165, v165, v167
MAA 68,80,48
TR 110,25,12960
v_mul_f32 v164, 0xba800000, v164
MAA 68,84,68
buffer_load_dwordx4 v19, s[20:23], s54 offen offset:1024 lds
MAA 72,84,72
TR 112,25,1056
v_mul_f32 v165, 0x3a800000, v165
MAA 72,80,52
TR 114,25,1568
v_fma_f32 v165, -v164, v164, v165
s_waitcnt lgkmcnt(6)
MAA 104,88,52
buffer_load_dwordx4 v20, s[20:23], s54 offen offset:2048 lds
MAA 104,92,72
TR 116,25,13472
s_add_u32 s54, s54, 196608
MAA 100,92,68
TR 118,25,13984
s_add_u32 m0, s59, 58240
MAA 100,88,48
TR 120,25,2080
s_xor_b32 s58, s87, 1966080
MAA 96,88,44
buffer_load_dwordx4 v5, s[24:27], s58 offen lds
MAA 96,92,64
TR 122,25,2592
v_max_f32 v165, 0, v165
MAA 92,92,60
TR 124,25,14496
v_add_f32 v165, 0x3727c5ac, v165
MAA 92,88,40
buffer_load_dwordx4 v6, s[24:27], s58 offen offset:1024 lds
MAA 124,40,96
TR 126,25,15008
s_add_u32 m0, s59, 0
MAA 124,60,100
RD 0,23,18432
s_xor_b32 s58, s87, 1048576
MAA 128,64,100
buffer_load_dwordx4 v5, s[24:27], s58 offen lds
MAA 128,44,96
RD 4,23,19456
MAA 132,48,96
RD 8,23,20736
MAA 132,68,100
buffer_load_dwordx4 v6, s[24:27], s58 offen offset:1024 lds
MAA 136,72,100
RD 12,23,21760
MAA 136,52,96
RD 16,24,20480
MAA 156,56,96
v_rsq_f32 v166, v165
MAA 156,76,100
v_mov_b32 v165, v166
v_mul_f32 v166, 0x3e8293ee, v166
ds_write_b128 v7, v[164:167]
s_waitcnt vmcnt(16) lgkmcnt(6)
s_barrier
MAA 76,104,40
ds_write_b32 v17, v164
MAA 76,108,60
ds_write_b32 v17, v165 offset:1024
s_add_u32 m0, s59, 8320
MAA 80,108,64
RD 20,23,27648
s_xor_b32 s58, s87, 1179648
MAA 80,104,44
buffer_load_dwordx4 v5, s[24:27], s58 offen lds
MAA 84,104,48
RD 24,23,28672
MAA 84,108,68
RD 28,23,29952
MAA 88,108,72
RD 32,23,30976
MAA 88,104,52
buffer_load_dwordx4 v6, s[24:27], s58 offen offset:1024 lds
MAA 120,112,52
RD 36,24,29696
s_add_u32 m0, s59, 66560
MAA 120,116,72
TR 80,25,24832
s_xor_b32 s58, s87, 0
MAA 116,116,68
TR 82,25,25344
MAA 116,112,48
buffer_load_dwordx4 v5, s[24:27], s58 offen lds
MAA 112,112,44
TR 84,25,37248
MAA 112,116,64
TR 86,25,37760
MAA 108,116,60
TR 88,25,25856
MAA 108,112,40
buffer_load_dwordx4 v6, s[24:27], s58 offen offset:1024 lds
MAA 140,40,120
TR 90,25,26368
s_add_u32 m0, s59, 74880
MAA 140,60,124
TR 92,25,38272
s_xor_b32 s58, s87, 131072
MAA 144,64,124
TR 94,25,38784
MAA 144,44,120
buffer_load_dwordx4 v5, s[24:27], s58 offen lds
MAA 148,48,120
TR 96,25,26880
MAA 148,68,124
TR 98,25,27392
MAA 152,72,124
TR 100,25,39296
MAA 152,52,120
buffer_load_dwordx4 v6, s[24:27], s58 offen offset:1024 lds
MAA 160,56,120
TR 102,25,39808
MAA 160,76,124
s_waitcnt vmcnt(10) lgkmcnt(0)
s_barrier
MAA 104,88,12
TR 112,25,25888
s_add_u32 m0, s59, 83200
MAA 104,92,32
TR 114,25,26400
s_xor_b32 s58, s87, 262144
MAA 100,92,28
buffer_load_dwordx4 v5, s[24:27], s58 offen lds
MAA 100,88,8
TR 116,25,38304
MAA 96,88,4
TR 118,25,38816
MAA 96,92,24
TR 120,25,26912
MAA 92,92,20
buffer_load_dwordx4 v6, s[24:27], s58 offen offset:1024 lds
MAA 92,88,0
TR 122,25,27424
s_add_u32 m0, s59, 16640
MAA 156,16,96
TR 124,25,39328
s_xor_b32 s58, s87, 1310720
MAA 156,36,100
TR 126,25,39840
MAA 72,84,32
buffer_load_dwordx4 v5, s[24:27], s58 offen lds
MAA 72,80,12
TR 104,25,24864
MAA 68,80,8
TR 106,25,25376
MAA 68,84,28
TR 108,25,37280
MAA 64,84,24
buffer_load_dwordx4 v6, s[24:27], s58 offen offset:1024 lds
MAA 64,80,4
TR 110,25,37792
s_add_u32 m0, s59, 24960
MAA 60,80,0
RD 40,23,36864
s_xor_b32 s58, s87, 1441792
MAA 60,84,20
RD 44,23,37888
s_waitcnt lgkmcnt(12)
MAA 120,112,12
buffer_load_dwordx4 v5, s[24:27], s58 offen lds
s_waitcnt lgkmcnt(10)
MAA 120,116,32
RD 48,23,39168
MAA 116,116,28
RD 52,23,40192
MAA 116,112,8
RD 56,24,38912
MAA 112,112,4
buffer_load_dwordx4 v6, s[24:27], s58 offen offset:1024 lds
MAA 112,116,24
s_waitcnt lgkmcnt(5)
s_barrier
RD 60,23,46080
MAA 108,116,20
RD 64,23,47104
s_add_u32 m0, s59, 91520
MAA 108,112,0
RD 68,23,48384
s_xor_b32 s58, s87, 393216
MAA 160,16,120
RD 72,23,49408
MAA 160,36,124
RD 76,24,48128
MAA 88,108,32
TR 144,25,50688
MAA 88,104,12
TR 146,25,51200
MAA 84,104,8
TR 148,25,63104
MAA 84,108,28
TR 150,25,63616
MAA 80,108,24
TR 152,25,50720
MAA 80,104,4
TR 154,25,51232
MAA 76,104,0
TR 156,25,63136
MAA 76,108,20
TR 158,25,63648
TR 160,25,51712
TR 162,25,52224
TR 164,25,64128
s_waitcnt lgkmcnt(9)
MAA 104,144,52
TR 166,25,64640
TR 168,25,51744
TR 170,25,52256
s_waitcnt lgkmcnt(10)
MAA 104,148,72
TR 172,25,64160
MAA 100,148,68
TR 174,25,64672
MAA 100,144,48
TR 136,25,49696
MAA 96,144,44
TR 138,25,50208
MAA 96,148,64
TR 140,25,62112
MAA 92,148,60
TR 142,25,62624
MAA 92,144,40
TR 128,25,49664
s_waitcnt lgkmcnt(15)
MAA 120,152,52
TR 130,25,50176
s_waitcnt lgkmcnt(14)
MAA 120,156,72
TR 132,25,62080
MAA 116,156,68
TR 134,25,62592
MAA 116,152,48
ds_read_b128 v[232:235], v10 offset:1792
MAA 112,152,44
ds_read_b128 v[228:231], v10 offset:1536
MAA 112,156,64
ds_read_b128 v[224:227], v10 offset:1280
MAA 108,156,60
ds_read_b128 v[220:223], v10 offset:1024
MAA 108,152,40
buffer_load_dwordx4 v5, s[24:27], s58 offen lds
s_waitcnt lgkmcnt(15)
MAA 156,56,160
ds_read_b128 v[240:243], v11 offset:704
MAA 156,76,164
ds_read_b128 v[244:247], v11 offset:1728
s_waitcnt lgkmcnt(14)
MAA 160,76,172
s_waitcnt lgkmcnt(6)
s_barrier
ds_read_b128 v[18:21], v11 offset:448
MAA 160,56,168
buffer_load_dwordx4 v6, s[24:27], s58 offen offset:1024 lds
MAA 88,136,52
ds_read_b128 v[22:25], v11 offset:1472
s_add_u32 m0, s59, 99840
MAA 88,140,72
s_xor_b32 s58, s87, 524288
MAA 84,140,68
MAA 84,136,48
buffer_load_dwordx4 v5, s[24:27], s58 offen lds
MAA 80,136,44
MAA 80,140,64
MAA 76,140,60
MAA 76,136,40
buffer_load_dwordx4 v6, s[24:27], s58 offen offset:1024 lds
MAA 72,128,52
s_add_u32 m0, s59, 108160
s_xor_b32 s58, s87, 655360
MAA 72,132,72
MAA 68,132,68
MAA 68,128,48
buffer_load_dwordx4 v5, s[24:27], s58 offen lds
MAA 64,128,44
MAA 64,132,64
MAA 60,132,60
MAA 60,128,40
buffer_load_dwordx4 v6, s[24:27], s58 offen offset:1024 lds
s_waitcnt lgkmcnt(3)
v_pk_fma_f32 v[156:157], v[240:241], v[44:45], v[156:157] op_sel_hi:[1,0,1]
s_waitcnt lgkmcnt(2)
v_pk_mul_f32 v[156:157], v[156:157], v[244:245]
v_cvt_pk_bf16_f32 v236, v156, v157
v_pk_fma_f32 v[158:159], v[242:243], v[44:45], v[158:159] op_sel_hi:[1,0,1]
v_pk_mul_f32 v[158:159], v[158:159], v[246:247]
v_cvt_pk_bf16_f32 v237, v158, v159
v_pk_fma_f32 v[160:161], v[240:241], v[44:45], v[160:161] op_sel:[0,1,0] op_sel_hi:[1,1,1]
v_pk_mul_f32 v[160:161], v[160:161], v[244:245]
v_cvt_pk_bf16_f32 v238, v160, v161
v_pk_fma_f32 v[162:163], v[242:243], v[44:45], v[162:163] op_sel:[0,1,0] op_sel_hi:[1,1,1]
v_pk_mul_f32 v[162:163], v[162:163], v[246:247]
v_cvt_pk_bf16_f32 v239, v162, v163
ds_write_b128 v8, v[236:239] offset:1024
v_pk_fma_f32 v[104:105], v[36:37], v[232:233], v[104:105] op_sel_hi:[1,0,1]
v_pk_mul_f32 v[104:105], v[104:105], v[232:233] op_sel:[0,1] op_sel_hi:[1,1]
v_cvt_pk_bf16_f32 v196, v104, v105
v_pk_fma_f32 v[106:107], v[38:39], v[232:233], v[106:107] op_sel_hi:[1,0,1]
v_pk_mul_f32 v[106:107], v[106:107], v[232:233] op_sel:[0,1] op_sel_hi:[1,1]
v_cvt_pk_bf16_f32 v197, v106, v107
v_pk_fma_f32 v[120:121], v[40:41], v[232:233], v[120:121] op_sel_hi:[1,0,1]
v_pk_mul_f32 v[120:121], v[120:121], v[232:233] op_sel:[0,1] op_sel_hi:[1,1]
v_cvt_pk_bf16_f32 v198, v120, v121
v_pk_fma_f32 v[122:123], v[42:43], v[232:233], v[122:123] op_sel_hi:[1,0,1]
v_pk_mul_f32 v[122:123], v[122:123], v[232:233] op_sel:[0,1] op_sel_hi:[1,1]
v_cvt_pk_bf16_f32 v199, v122, v123
v_pk_fma_f32 v[100:101], v[36:37], v[228:229], v[100:101] op_sel_hi:[1,0,1]
v_pk_mul_f32 v[100:101], v[100:101], v[228:229] op_sel:[0,1] op_sel_hi:[1,1]
v_cvt_pk_bf16_f32 v192, v100, v101
v_pk_fma_f32 v[102:103], v[38:39], v[228:229], v[102:103] op_sel_hi:[1,0,1]
v_pk_mul_f32 v[102:103], v[102:103], v[228:229] op_sel:[0,1] op_sel_hi:[1,1]
v_cvt_pk_bf16_f32 v193, v102, v103
v_pk_fma_f32 v[116:117], v[40:41], v[228:229], v[116:117] op_sel_hi:[1,0,1]
v_pk_mul_f32 v[116:117], v[116:117], v[228:229] op_sel:[0,1] op_sel_hi:[1,1]
v_cvt_pk_bf16_f32 v194, v116, v117
v_pk_fma_f32 v[118:119], v[42:43], v[228:229], v[118:119] op_sel_hi:[1,0,1]
v_pk_mul_f32 v[118:119], v[118:119], v[228:229] op_sel:[0,1] op_sel_hi:[1,1]
v_cvt_pk_bf16_f32 v195, v118, v119
v_pk_fma_f32 v[96:97], v[36:37], v[224:225], v[96:97] op_sel_hi:[1,0,1]
v_pk_mul_f32 v[96:97], v[96:97], v[224:225] op_sel:[0,1] op_sel_hi:[1,1]
v_cvt_pk_bf16_f32 v188, v96, v97
v_pk_fma_f32 v[98:99], v[38:39], v[224:225], v[98:99] op_sel_hi:[1,0,1]
v_pk_mul_f32 v[98:99], v[98:99], v[224:225] op_sel:[0,1] op_sel_hi:[1,1]
v_cvt_pk_bf16_f32 v189, v98, v99
v_pk_fma_f32 v[112:113], v[40:41], v[224:225], v[112:113] op_sel_hi:[1,0,1]
v_pk_mul_f32 v[112:113], v[112:113], v[224:225] op_sel:[0,1] op_sel_hi:[1,1]
v_cvt_pk_bf16_f32 v190, v112, v113
v_pk_fma_f32 v[114:115], v[42:43], v[224:225], v[114:115] op_sel_hi:[1,0,1]
v_pk_mul_f32 v[114:115], v[114:115], v[224:225] op_sel:[0,1] op_sel_hi:[1,1]
v_cvt_pk_bf16_f32 v191, v114, v115
v_pk_fma_f32 v[92:93], v[36:37], v[220:221], v[92:93] op_sel_hi:[1,0,1]
v_pk_mul_f32 v[92:93], v[92:93], v[220:221] op_sel:[0,1] op_sel_hi:[1,1]
v_cvt_pk_bf16_f32 v184, v92, v93
v_pk_fma_f32 v[94:95], v[38:39], v[220:221], v[94:95] op_sel_hi:[1,0,1]
v_pk_mul_f32 v[94:95], v[94:95], v[220:221] op_sel:[0,1] op_sel_hi:[1,1]
v_cvt_pk_bf16_f32 v185, v94, v95
v_pk_fma_f32 v[108:109], v[40:41], v[220:221], v[108:109] op_sel_hi:[1,0,1]
v_pk_mul_f32 v[108:109], v[108:109], v[220:221] op_sel:[0,1] op_sel_hi:[1,1]
v_cvt_pk_bf16_f32 v186, v108, v109
v_pk_fma_f32 v[110:111], v[42:43], v[220:221], v[110:111] op_sel_hi:[1,0,1]
v_pk_mul_f32 v[110:111], v[110:111], v[220:221] op_sel:[0,1] op_sel_hi:[1,1]
v_cvt_pk_bf16_f32 v187, v110, v111
v_pk_fma_f32 v[72:73], v[28:29], v[232:233], v[72:73] op_sel_hi:[1,0,1]
v_cvt_pk_bf16_f32 v176, v72, v73
v_pk_fma_f32 v[74:75], v[30:31], v[232:233], v[74:75] op_sel_hi:[1,0,1]
v_cvt_pk_bf16_f32 v177, v74, v75
v_pk_fma_f32 v[88:89], v[32:33], v[232:233], v[88:89] op_sel_hi:[1,0,1]
v_cvt_pk_bf16_f32 v178, v88, v89
v_pk_fma_f32 v[90:91], v[34:35], v[232:233], v[90:91] op_sel_hi:[1,0,1]
v_cvt_pk_bf16_f32 v179, v90, v91
v_pk_fma_f32 v[68:69], v[28:29], v[228:229], v[68:69] op_sel_hi:[1,0,1]
v_cvt_pk_bf16_f32 v172, v68, v69
v_pk_fma_f32 v[70:71], v[30:31], v[228:229], v[70:71] op_sel_hi:[1,0,1]
v_cvt_pk_bf16_f32 v173, v70, v71
v_pk_fma_f32 v[84:85], v[32:33], v[228:229], v[84:85] op_sel_hi:[1,0,1]
v_cvt_pk_bf16_f32 v174, v84, v85
v_pk_fma_f32 v[86:87], v[34:35], v[228:229], v[86:87] op_sel_hi:[1,0,1]
v_cvt_pk_bf16_f32 v175, v86, v87
v_pk_fma_f32 v[64:65], v[28:29], v[224:225], v[64:65] op_sel_hi:[1,0,1]
v_cvt_pk_bf16_f32 v168, v64, v65
v_pk_fma_f32 v[66:67], v[30:31], v[224:225], v[66:67] op_sel_hi:[1,0,1]
v_cvt_pk_bf16_f32 v169, v66, v67
v_pk_fma_f32 v[80:81], v[32:33], v[224:225], v[80:81] op_sel_hi:[1,0,1]
v_cvt_pk_bf16_f32 v170, v80, v81
v_pk_fma_f32 v[82:83], v[34:35], v[224:225], v[82:83] op_sel_hi:[1,0,1]
v_cvt_pk_bf16_f32 v171, v82, v83
v_pk_fma_f32 v[60:61], v[28:29], v[220:221], v[60:61] op_sel_hi:[1,0,1]
v_cvt_pk_bf16_f32 v164, v60, v61
v_pk_fma_f32 v[62:63], v[30:31], v[220:221], v[62:63] op_sel_hi:[1,0,1]
v_cvt_pk_bf16_f32 v165, v62, v63
v_pk_fma_f32 v[76:77], v[32:33], v[220:221], v[76:77] op_sel_hi:[1,0,1]
v_cvt_pk_bf16_f32 v166, v76, v77
v_pk_fma_f32 v[78:79], v[34:35], v[220:221], v[78:79] op_sel_hi:[1,0,1]
s_waitcnt lgkmcnt(0)
s_barrier
v_cvt_pk_bf16_f32 v167, v78, v79
v_mfma_f32_16x16x32_bf16 v[120:123], v[196:199], v[176:179], v[50:53]
ds_read_b128 v[180:183], v9
s_add_u32 m0, s59, 33280
v_mfma_f32_16x16x32_bf16 v[104:107], v[192:195], v[176:179], v[46:49]
ds_read_b64 v[200:201], v9 offset:1024
s_xor_b32 s58, s87, 1572864
v_mfma_f32_16x16x32_bf16 v[116:119], v[192:195], v[172:175], v[50:53]
buffer_load_dwordx4 v5, s[24:27], s58 offen lds
v_mfma_f32_16x16x32_bf16 v[100:103], v[188:191], v[172:175], v[46:49]
ds_read_b64 v[210:211], v9 offset:1032
v_mfma_f32_16x16x32_bf16 v[112:115], v[188:191], v[168:171], v[50:53]
ds_read_b128 v[240:243], v11 offset:384
v_max3_f32 v88, v104, v105, v106
v_mfma_f32_16x16x32_bf16 v[96:99], v[184:187], v[168:171], v[46:49]
ds_read_b128 v[244:247], v11 offset:1408
v_max3_f32 v89, v107, v120, v121
v_mfma_f32_16x16x32_bf16 v[108:111], v[184:187], v[164:167], v[50:53]
buffer_load_dwordx4 v6, s[24:27], s58 offen offset:1024 lds
v_max3_f32 v88, v88, v122, v123
v_max_f32 v90, v88, v89
v_max_f32 v89, v88, v89
v_max3_f32 v84, v100, v101, v102
v_max3_f32 v85, v103, v116, v117
s_waitcnt lgkmcnt(4)
v_mfma_f32_16x16x32_bf16 v[92:95], v[180:183], v[164:167], v[46:49]
ds_read_b128 v[28:31], v11 offset:320
s_add_u32 m0, s59, 41600
.Lpad19:
s_cbranch_execz .Lnopoll53r
MAA 136,12,96
ds_read_b128 v[32:35], v11 offset:1344
s_xor_b32 s58, s87, 1703936
MAA 136,32,100
buffer_load_dwordx4 v5, s[24:27], s58 offen lds
MAA 136,52,160
ds_read_b128 v[36:39], v11 offset:256
v_permlane16_swap_b32 v90, v89
MAA 136,72,164
ds_read_b128 v[40:43], v11 offset:1280
v_max_f32 v88, v90, v89
MAA 152,72,172
v_max_f32 v89, v90, v89
v_max3_f32 v84, v84, v118, v119
MAA 152,52,168
buffer_load_dwordx4 v6, s[24:27], s58 offen offset:1024 lds
MAA 152,32,124
s_add_u32 m0, s59, 49920
s_xor_b32 s58, s87, 1835008
v_permlane32_swap_b32 v88, v89
MAA 152,12,120
v_max_f32 v88, v88, v89
v_mul_f32 v88, v88, v234
v_max_f32 v86, v84, v85
v_max_f32 v85, v84, v85
v_max3_f32 v80, v96, v97, v98
v_max3_f32 v81, v99, v112, v113
v_permlane16_swap_b32 v86, v85
v_max3_f32 v80, v80, v114, v115
v_max_f32 v84, v86, v85
v_max_f32 v85, v86, v85
v_max_f32 v82, v80, v81
v_max_f32 v81, v80, v81
v_permlane32_swap_b32 v84, v85
v_max3_f32 v76, v92, v93, v94
v_max_f32 v84, v84, v85
v_mul_f32 v84, v84, v230
v_permlane16_swap_b32 v82, v81
v_max3_f32 v77, v95, v108, v109
v_max_f32 v80, v82, v81
v_max_f32 v81, v82, v81
v_max3_f32 v76, v76, v110, v111
v_max_f32 v78, v76, v77
v_permlane32_swap_b32 v80, v81
v_max_f32 v77, v76, v77
v_max_f32 v80, v80, v81
v_mul_f32 v80, v80, v226
v_permlane16_swap_b32 v78, v77
v_pk_fma_f32 v[104:105], v[104:105], v[234:235], v[88:89] op_sel_hi:[1,0,0] neg_lo:[0,0,1] neg_hi:[0,0,1]
v_max_f32 v76, v78, v77
v_max_f32 v77, v78, v77
v_pk_fma_f32 v[106:107], v[106:107], v[234:235], v[88:89] op_sel_hi:[1,0,0] neg_lo:[0,0,1] neg_hi:[0,0,1]
v_pk_fma_f32 v[120:121], v[120:121], v[234:235], v[88:89] op_sel_hi:[1,0,0] neg_lo:[0,0,1] neg_hi:[0,0,1]
v_permlane32_swap_b32 v76, v77
v_pk_fma_f32 v[122:123], v[122:123], v[234:235], v[88:89] op_sel_hi:[1,0,0] neg_lo:[0,0,1] neg_hi:[0,0,1]
v_max_f32 v76, v76, v77
v_mul_f32 v76, v76, v222
v_pk_fma_f32 v[100:101], v[100:101], v[230:231], v[84:85] op_sel_hi:[1,0,0] neg_lo:[0,0,1] neg_hi:[0,0,1]
v_pk_fma_f32 v[102:103], v[102:103], v[230:231], v[84:85] op_sel_hi:[1,0,0] neg_lo:[0,0,1] neg_hi:[0,0,1]
v_pk_fma_f32 v[116:117], v[116:117], v[230:231], v[84:85] op_sel_hi:[1,0,0] neg_lo:[0,0,1] neg_hi:[0,0,1]
v_pk_fma_f32 v[118:119], v[118:119], v[230:231], v[84:85] op_sel_hi:[1,0,0] neg_lo:[0,0,1] neg_hi:[0,0,1]
v_pk_fma_f32 v[96:97], v[96:97], v[226:227], v[80:81] op_sel_hi:[1,0,0] neg_lo:[0,0,1] neg_hi:[0,0,1]
v_pk_fma_f32 v[98:99], v[98:99], v[226:227], v[80:81] op_sel_hi:[1,0,0] neg_lo:[0,0,1] neg_hi:[0,0,1]
v_pk_fma_f32 v[112:113], v[112:113], v[226:227], v[80:81] op_sel_hi:[1,0,0] neg_lo:[0,0,1] neg_hi:[0,0,1]
v_pk_fma_f32 v[114:115], v[114:115], v[226:227], v[80:81] op_sel_hi:[1,0,0] neg_lo:[0,0,1] neg_hi:[0,0,1]
v_pk_fma_f32 v[92:93], v[92:93], v[222:223], v[76:77] op_sel_hi:[1,0,0] neg_lo:[0,0,1] neg_hi:[0,0,1]
v_pk_fma_f32 v[94:95], v[94:95], v[222:223], v[76:77] op_sel_hi:[1,0,0] neg_lo:[0,0,1] neg_hi:[0,0,1]
v_pk_fma_f32 v[108:109], v[108:109], v[222:223], v[76:77] op_sel_hi:[1,0,0] neg_lo:[0,0,1] neg_hi:[0,0,1]
v_pk_fma_f32 v[110:111], v[110:111], v[222:223], v[76:77] op_sel_hi:[1,0,0] neg_lo:[0,0,1] neg_hi:[0,0,1]
v_pk_fma_f32 v[136:137], v[18:19], v[44:45], v[136:137] op_sel_hi:[1,0,1]
v_pk_mul_f32 v[136:137], v[136:137], v[22:23]
v_pk_fma_f32 v[138:139], v[20:21], v[44:45], v[138:139] op_sel_hi:[1,0,1]
v_pk_mul_f32 v[138:139], v[138:139], v[24:25]
v_pk_fma_f32 v[152:153], v[18:19], v[44:45], v[152:153] op_sel:[0,1,0] op_sel_hi:[1,1,1]
v_pk_mul_f32 v[152:153], v[152:153], v[22:23]
v_pk_fma_f32 v[154:155], v[20:21], v[44:45], v[154:155] op_sel:[0,1,0] op_sel_hi:[1,1,1]
v_pk_mul_f32 v[154:155], v[154:155], v[24:25]
v_exp_f32 v104, v104
s_nop 0
MAA 132,8,96
buffer_load_dwordx4 v5, s[24:27], s58 offen lds
MAA 132,28,100
v_exp_f32 v105, v105
MAA 132,48,160
v_exp_f32 v106, v106
MAA 132,68,164
v_exp_f32 v107, v107
MAA 148,68,172
buffer_load_dwordx4 v6, s[24:27], s58 offen offset:1024 lds
MAA 148,48,168
s_add_u32 m0, s59, 116480
s_xor_b32 s58, s87, 786432
v_exp_f32 v120, v120
MAA 148,28,124
v_exp_f32 v121, v121
MAA 148,8,120
v_exp_f32 v122, v122
MAA 128,4,96
buffer_load_dwordx4 v5, s[24:27], s58 offen lds
MAA 128,24,100
v_exp_f32 v123, v123
MAA 128,44,160
v_exp_f32 v100, v100
MAA 128,64,164
v_exp_f32 v101, v101
MAA 144,64,172
buffer_load_dwordx4 v6, s[24:27], s58 offen offset:1024 lds
MAA 144,44,168
s_add_u32 m0, s59, 124800
s_xor_b32 s58, s87, 917504
v_exp_f32 v102, v102
MAA 144,24,124
v_exp_f32 v103, v103
MAA 144,4,120
v_exp_f32 v116, v116
MAA 124,0,96
buffer_load_dwordx4 v5, s[24:27], s58 offen lds
MAA 124,20,100
v_exp_f32 v117, v117
MAA 124,40,160
v_exp_f32 v118, v118
MAA 124,60,164
v_exp_f32 v119, v119
MAA 140,60,172
buffer_load_dwordx4 v6, s[24:27], s58 offen offset:1024 lds
MAA 140,40,168
v_exp_f32 v96, v96
MAA 140,20,124
v_exp_f32 v97, v97
MAA 140,0,120
v_cvt_pk_bf16_f32 v72, v104, v105
v_cvt_pk_bf16_f32 v73, v106, v107
v_cvt_pk_bf16_f32 v74, v120, v121
v_cvt_pk_bf16_f32 v75, v122, v123
v_cvt_pk_bf16_f32 v68, v100, v101
v_cvt_pk_bf16_f32 v69, v102, v103
v_cvt_pk_bf16_f32 v70, v116, v117
v_cvt_pk_bf16_f32 v71, v118, v119
v_exp_f32 v98, v98
v_exp_f32 v99, v99
v_exp_f32 v112, v112
v_exp_f32 v113, v113
v_exp_f32 v114, v114
v_exp_f32 v115, v115
v_cvt_pk_bf16_f32 v64, v96, v97
v_cvt_pk_bf16_f32 v65, v98, v99
v_cvt_pk_bf16_f32 v66, v112, v113
v_cvt_pk_bf16_f32 v67, v114, v115
v_cvt_pk_bf16_f32 v208, v136, v137
v_cvt_pk_bf16_f32 v209, v138, v139
v_cvt_pk_bf16_f32 v218, v152, v153
v_cvt_pk_bf16_f32 v219, v154, v155
s_waitcnt lgkmcnt(5)
v_pk_fma_f32 v[132:133], v[240:241], v[44:45], v[132:133] op_sel_hi:[1,0,1]
s_waitcnt lgkmcnt(4)
v_pk_mul_f32 v[132:133], v[132:133], v[244:245]
v_cvt_pk_bf16_f32 v206, v132, v133
v_pk_fma_f32 v[134:135], v[242:243], v[44:45], v[134:135] op_sel_hi:[1,0,1]
v_pk_mul_f32 v[134:135], v[134:135], v[246:247]
v_cvt_pk_bf16_f32 v207, v134, v135
v_pk_fma_f32 v[148:149], v[240:241], v[44:45], v[148:149] op_sel:[0,1,0] op_sel_hi:[1,1,1]
v_pk_mul_f32 v[148:149], v[148:149], v[244:245]
v_cvt_pk_bf16_f32 v216, v148, v149
v_pk_fma_f32 v[150:151], v[242:243], v[44:45], v[150:151] op_sel:[0,1,0] op_sel_hi:[1,1,1]
v_pk_mul_f32 v[150:151], v[150:151], v[246:247]
v_cvt_pk_bf16_f32 v217, v150, v151
s_waitcnt lgkmcnt(3)
v_pk_fma_f32 v[128:129], v[28:29], v[44:45], v[128:129] op_sel_hi:[1,0,1]
s_waitcnt lgkmcnt(2)
v_pk_mul_f32 v[128:129], v[128:129], v[32:33]
v_cvt_pk_bf16_f32 v204, v128, v129
v_pk_fma_f32 v[130:131], v[30:31], v[44:45], v[130:131] op_sel_hi:[1,0,1]
v_pk_mul_f32 v[130:131], v[130:131], v[34:35]
v_cvt_pk_bf16_f32 v205, v130, v131
v_pk_fma_f32 v[144:145], v[28:29], v[44:45], v[144:145] op_sel:[0,1,0] op_sel_hi:[1,1,1]
v_pk_mul_f32 v[144:145], v[144:145], v[32:33]
v_cvt_pk_bf16_f32 v214, v144, v145
v_pk_fma_f32 v[146:147], v[30:31], v[44:45], v[146:147] op_sel:[0,1,0] op_sel_hi:[1,1,1]
v_pk_mul_f32 v[146:147], v[146:147], v[34:35]
v_cvt_pk_bf16_f32 v215, v146, v147
s_waitcnt lgkmcnt(1)
v_pk_fma_f32 v[124:125], v[36:37], v[44:45], v[124:125] op_sel_hi:[1,0,1]
s_waitcnt lgkmcnt(0)
v_pk_mul_f32 v[124:125], v[124:125], v[40:41]
v_cvt_pk_bf16_f32 v202, v124, v125
v_pk_fma_f32 v[126:127], v[38:39], v[44:45], v[126:127] op_sel_hi:[1,0,1]
v_pk_mul_f32 v[126:127], v[126:127], v[42:43]
v_cvt_pk_bf16_f32 v203, v126, v127
v_pk_fma_f32 v[140:141], v[36:37], v[44:45], v[140:141] op_sel:[0,1,0] op_sel_hi:[1,1,1]
v_pk_mul_f32 v[140:141], v[140:141], v[40:41]
v_cvt_pk_bf16_f32 v212, v140, v141
v_pk_fma_f32 v[142:143], v[38:39], v[44:45], v[142:143] op_sel:[0,1,0] op_sel_hi:[1,1,1]
v_pk_mul_f32 v[142:143], v[142:143], v[42:43]
v_cvt_pk_bf16_f32 v213, v142, v143
s_nop 0
v_mfma_f32_16x16x32_bf16 v[88:91], v[248:251], v[72:75], 0
v_exp_f32 v92, v92
v_mfma_f32_16x16x32_bf16 v[104:107], v[206:209], v[72:75], 0
v_exp_f32 v93, v93
v_mfma_f32_16x16x32_bf16 v[120:123], v[216:219], v[72:75], 0
v_exp_f32 v94, v94
v_mfma_f32_16x16x32_bf16 v[84:87], v[248:251], v[68:71], 0
v_exp_f32 v95, v95
v_mfma_f32_16x16x32_bf16 v[100:103], v[204:207], v[68:71], 0
v_exp_f32 v108, v108
v_mfma_f32_16x16x32_bf16 v[116:119], v[214:217], v[68:71], 0
v_exp_f32 v109, v109
v_mfma_f32_16x16x32_bf16 v[80:83], v[248:251], v[64:67], 0
v_exp_f32 v110, v110
v_mfma_f32_16x16x32_bf16 v[96:99], v[202:205], v[64:67], 0
v_exp_f32 v111, v111
v_mfma_f32_16x16x32_bf16 v[112:115], v[212:215], v[64:67], 0
v_cvt_pk_bf16_f32 v60, v92, v93
v_cvt_pk_bf16_f32 v61, v94, v95
v_cvt_pk_bf16_f32 v62, v108, v109
v_cvt_pk_bf16_f32 v63, v110, v111
v_rcp_f32 v88, v88
v_rcp_f32 v84, v84
v_mfma_f32_16x16x32_bf16 v[76:79], v[248:251], v[60:63], 0
v_rcp_f32 v80, v80
v_mfma_f32_16x16x32_bf16 v[92:95], v[200:203], v[60:63], 0
v_mfma_f32_16x16x32_bf16 v[108:111], v[210:213], v[60:63], 0
s_nop 4
v_rcp_f32 v76, v76
v_pk_mul_f32 v[104:105], v[104:105], v[88:89] op_sel_hi:[1,0]
v_pk_mul_f32 v[106:107], v[106:107], v[88:89] op_sel_hi:[1,0]
v_pk_mul_f32 v[120:121], v[120:121], v[88:89] op_sel_hi:[1,0]
v_pk_mul_f32 v[122:123], v[122:123], v[88:89] op_sel_hi:[1,0]
v_cvt_pk_bf16_f32 v176, v104, v105
v_cvt_pk_bf16_f32 v177, v106, v107
v_cvt_pk_bf16_f32 v178, v120, v121
v_cvt_pk_bf16_f32 v179, v122, v123
buffer_store_dwordx4 v[176:179], v4, s[16:19], s74 offen offset:3072 sc1
v_pk_mul_f32 v[100:101], v[100:101], v[84:85] op_sel_hi:[1,0]
v_pk_mul_f32 v[102:103], v[102:103], v[84:85] op_sel_hi:[1,0]
v_pk_mul_f32 v[116:117], v[116:117], v[84:85] op_sel_hi:[1,0]
v_pk_mul_f32 v[118:119], v[118:119], v[84:85] op_sel_hi:[1,0]
v_cvt_pk_bf16_f32 v172, v100, v101
v_cvt_pk_bf16_f32 v173, v102, v103
v_cvt_pk_bf16_f32 v174, v116, v117
v_cvt_pk_bf16_f32 v175, v118, v119
buffer_store_dwordx4 v[172:175], v4, s[16:19], s74 offen offset:2048 sc1
v_pk_mul_f32 v[96:97], v[96:97], v[80:81] op_sel_hi:[1,0]
v_pk_mul_f32 v[98:99], v[98:99], v[80:81] op_sel_hi:[1,0]
v_pk_mul_f32 v[112:113], v[112:113], v[80:81] op_sel_hi:[1,0]
v_pk_mul_f32 v[114:115], v[114:115], v[80:81] op_sel_hi:[1,0]
v_cvt_pk_bf16_f32 v168, v96, v97
v_cvt_pk_bf16_f32 v169, v98, v99
v_cvt_pk_bf16_f32 v170, v112, v113
v_cvt_pk_bf16_f32 v171, v114, v115
buffer_store_dwordx4 v[168:171], v4, s[16:19], s74 offen offset:1024 sc1
v_pk_mul_f32 v[92:93], v[92:93], v[76:77] op_sel_hi:[1,0]
v_pk_mul_f32 v[94:95], v[94:95], v[76:77] op_sel_hi:[1,0]
v_pk_mul_f32 v[108:109], v[108:109], v[76:77] op_sel_hi:[1,0]
v_pk_mul_f32 v[110:111], v[110:111], v[76:77] op_sel_hi:[1,0]
v_cvt_pk_bf16_f32 v164, v92, v93
v_cvt_pk_bf16_f32 v165, v94, v95
v_cvt_pk_bf16_f32 v166, v108, v109
v_cvt_pk_bf16_f32 v167, v110, v111
buffer_store_dwordx4 v[164:167], v4, s[16:19], s74 offen sc1
s_nop 1
.Lqkve56:
.Lpad20:
s_cbranch_execz .Lnopoll53r
s_lshl_b32 s62, s3, 11
s_add_u32 s62, s62, s84
v_lshl_add_u32 v4, v1, 4, s62
v_lshrrev_b32 v2, 3, v1
v_cmp_eq_u32 vcc, 3, v2
v_add_u32 v2, 67108480, v4
s_nop 0
v_cndmask_b32 v4, v4, v2, vcc
v_bfe_u32 v5, v1, 3, 1
v_lshrrev_b32 v2, 4, v1
v_lshl_add_u32 v5, v2, 3, v5
s_lshl_b32 s62, s3, 1
v_add_u32 v5, s62, v5
v_mul_u32_u24 v5, 2048, v5
v_and_b32 v2, 7, v1
v_lshl_add_u32 v5, v2, 4, v5
s_lshl_b32 s62, s7, 7
v_add_u32 v5, s62, v5
v_add_u32 v6, 64512, v5
v_bfe_u32 v8, v1, 3, 2
v_mul_u32_u24 v8, 2080, v8
v_bfe_u32 v2, v1, 2, 1
v_lshl_add_u32 v8, v2, 7, v8
v_bfe_u32 v2, v1, 5, 1
v_lshl_add_u32 v8, v2, 8, v8
v_and_b32 v2, 3, v1
v_lshl_add_u32 v8, v2, 3, v8
s_mov_b32 s57, 66560
v_add_u32 v7, s57, v8
s_lshr_b32 s54, s87, 17
s_lshl_b32 s54, s54, 18
s_add_u32 s54, s54, 37748736
s_mov_b32 s52, s54
s_add_u32 s53, s54, 131072
v_accvgpr_read_b32 v32, a224
v_accvgpr_read_b32 v33, a225
v_accvgpr_read_b32 v34, a226
v_accvgpr_read_b32 v35, a227
v_accvgpr_read_b32 v36, a228
v_accvgpr_read_b32 v37, a229
v_accvgpr_read_b32 v38, a230
v_accvgpr_read_b32 v39, a231
v_accvgpr_read_b32 v40, a232
v_accvgpr_read_b32 v41, a233
v_accvgpr_read_b32 v42, a234
v_accvgpr_read_b32 v43, a235
v_accvgpr_read_b32 v44, a236
v_accvgpr_read_b32 v45, a237
v_accvgpr_read_b32 v46, a238
v_accvgpr_read_b32 v47, a239
v_accvgpr_read_b32 v48, a240
v_accvgpr_read_b32 v49, a241
v_accvgpr_read_b32 v50, a242
v_accvgpr_read_b32 v51, a243
v_accvgpr_read_b32 v52, a244
v_accvgpr_read_b32 v53, a245
v_accvgpr_read_b32 v54, a246
v_accvgpr_read_b32 v55, a247
v_accvgpr_read_b32 v56, a248
v_accvgpr_read_b32 v57, a249
v_accvgpr_read_b32 v58, a250
v_accvgpr_read_b32 v59, a251
v_accvgpr_read_b32 v60, a252
v_accvgpr_read_b32 v61, a253
v_accvgpr_read_b32 v62, a254
v_accvgpr_read_b32 v63, a255
s_lshl_b32 s62, s49, 3
s_add_u32 s62, s62, s48
s_mul_i32 s62, s62, 28672
s_add_u32 s62, s62, s51
v_lshrrev_b32 v12, 4, v1
v_mul_u32_u24 v12, 57344, v12
v_and_b32 v2, 15, v1
v_lshl_add_u32 v12, v2, 4, v12
v_add_u32 v12, s62, v12
v_add_u32 v13, 6112, v12
v_add_u32 v14, 12224, v12
v_add_u32 v15, 18336, v12
s_mul_i32 s59, s3, 4224
s_mov_b32 s58, 0
s_lshl_b32 s62, s8, 10
s_add_u32 s62, s62, 30490624
s_lshl_b32 s64, s6, 10
s_add_u32 s64, s64, 30490624
s_lshr_b32 s67, s5, 2
s_and_b32 s67, s67, 3
s_lshl_b32 s67, s67, 7
s_add_u32 s64, s64, s67
v_lshl_add_u32 v252, v1, 7, s62
v_mov_b32 v253, s64
v_mov_b32 v255, 1
s_waitcnt vmcnt(0) lgkmcnt(0)
s_cmp_lg_u32 s3, 1
s_barrier
s_cbranch_scc1 .Lnopoll60
s_mov_b64 exec, 15
buffer_atomic_add v255, v252, s[16:19], 0 offen
s_mov_b64 exec, 1
v_mov_b32 v254, 0
buffer_atomic_add v254, v253, s[16:19], 0 offen sc0
s_sleep 5
s_mov_b32 s15, 0
.Lpoll59:
v_mov_b32 v255, 0
buffer_atomic_add v255, v253, s[16:19], 0 offen sc0
s_waitcnt vmcnt(1)
v_cmp_gt_u32 vcc, 16, v254
s_add_u32 s15, s15, 1
s_cbranch_vccz .Lnopoll60r
v_mov_b32 v254, 0
buffer_atomic_add v254, v253, s[16:19], 0 offen sc0
s_waitcnt vmcnt(1)
v_cmp_gt_u32 vcc, 16, v255
s_add_u32 s15, s15, 1
s_cbranch_vccz .Lnopoll60r
s_cmp_le_u32 s15, 100000
s_cbranch_scc1 .Lpoll59
s_branch .Lnopoll60r
.Lnopoll60:
s_mov_b64 exec, 0
s_cmp_eq_u32 s3, 2
s_cbranch_scc1 .Lpad21
s_cmp_eq_u32 s3, 3
s_cbranch_scc1 .Lpad22
s_branch .Lpad23
.Lnopoll60r:
s_mov_b64 exec, -1
s_barrier
buffer_load_dwordx4 v[64:67], v4, s[16:19], s52 offen sc1
buffer_load_dwordx4 v[68:71], v4, s[16:19], s52 offen offset:1024 sc1
s_xor_b32 s52, s54, 262144
buffer_load_dwordx4 v[72:75], v4, s[16:19], s53 offen sc1
buffer_load_dwordx4 v[76:79], v4, s[16:19], s53 offen offset:1024 sc1
s_xor_b32 s53, s54, 393216
buffer_load_dwordx4 v[80:83], v4, s[16:19], s52 offen sc1
buffer_load_dwordx4 v[84:87], v4, s[16:19], s52 offen offset:1024 sc1
s_xor_b32 s52, s54, 524288
buffer_load_dwordx4 v[88:91], v4, s[16:19], s53 offen sc1
buffer_load_dwordx4 v[92:95], v4, s[16:19], s53 offen offset:1024 sc1
s_xor_b32 s53, s54, 655360
buffer_load_dwordx4 v[96:99], v4, s[16:19], s52 offen sc1
buffer_load_dwordx4 v[100:103], v4, s[16:19], s52 offen offset:1024 sc1
s_xor_b32 s52, s54, 786432
buffer_load_dwordx4 v[104:107], v4, s[16:19], s53 offen sc1
buffer_load_dwordx4 v[108:111], v4, s[16:19], s53 offen offset:1024 sc1
s_xor_b32 s53, s54, 917504
ds_read_b64_tr_b16 a[0:1], v7
TR 2,7,512
TR 16,7,1024
TR 18,7,1536
TR 4,7,32
TR 6,7,544
TR 20,7,1056
TR 22,7,1568
TR 8,7,64
TR 10,7,576
TR 24,7,1088
TR 26,7,1600
TR 12,7,96
TR 14,7,608
TR 28,7,1120
TR 30,7,1632
s_waitcnt vmcnt(8) lgkmcnt(14)
MAV 32,0,64
TR 32,7,8320
s_waitcnt lgkmcnt(13)
MAV 32,16,72
buffer_load_dwordx4 v[112:115], v4, s[16:19], s52 offen sc1
MAV 48,16,76
TR 34,7,8832
MAV 48,0,68
TR 48,7,9344
TR 50,7,9856
s_waitcnt lgkmcnt(14)
MAV 52,4,68
TR 36,7,8352
s_waitcnt lgkmcnt(13)
MAV 52,20,76
buffer_load_dwordx4 v[116:119], v4, s[16:19], s52 offen offset:1024 sc1
MAV 36,20,72
TR 38,7,8864
s_xor_b32 s52, s54, 1048576
MAV 36,4,64
TR 52,7,9376
TR 54,7,9888
s_waitcnt lgkmcnt(14)
MAV 40,8,64
TR 40,7,8384
s_waitcnt lgkmcnt(13)
MAV 40,24,72
buffer_load_dwordx4 v[120:123], v4, s[16:19], s53 offen sc1
MAV 56,24,76
TR 42,7,8896
MAV 56,8,68
TR 56,7,9408
TR 58,7,9920
s_waitcnt lgkmcnt(14)
MAV 60,12,68
TR 44,7,8416
s_waitcnt lgkmcnt(13)
MAV 60,28,76
buffer_load_dwordx4 v[124:127], v4, s[16:19], s53 offen offset:1024 sc1
MAV 44,28,72
TR 46,7,8928
s_xor_b32 s53, s54, 1179648
MAV 44,12,64
TR 60,7,9440
TR 62,7,9952
s_waitcnt vmcnt(8) lgkmcnt(8)
MAV 32,32,80
TR 0,7,16640
MAV 32,48,88
buffer_load_dwordx4 v[64:67], v4, s[16:19], s52 offen sc1
MAV 48,48,92
TR 2,7,17152
MAV 48,32,84
TR 16,7,17664
TR 18,7,18176
MAV 52,36,84
TR 4,7,16672
MAV 52,52,92
buffer_load_dwordx4 v[68:71], v4, s[16:19], s52 offen offset:1024 sc1
MAV 36,52,88
TR 6,7,17184
s_xor_b32 s52, s54, 1310720
MAV 36,36,80
TR 20,7,17696
TR 22,7,18208
s_waitcnt lgkmcnt(8)
MAV 40,40,80
TR 8,7,16704
MAV 40,56,88
buffer_load_dwordx4 v[72:75], v4, s[16:19], s53 offen sc1
MAV 56,56,92
TR 10,7,17216
MAV 56,40,84
TR 24,7,17728
TR 26,7,18240
MAV 60,44,84
TR 12,7,16736
MAV 60,60,92
buffer_load_dwordx4 v[76:79], v4, s[16:19], s53 offen offset:1024 sc1
MAV 44,60,88
TR 14,7,17248
s_xor_b32 s53, s54, 1441792
MAV 44,44,80
TR 28,7,17760
TR 30,7,18272
s_waitcnt vmcnt(8) lgkmcnt(8)
MAV 32,0,96
TR 32,7,24960
MAV 32,16,104
buffer_load_dwordx4 v[80:83], v4, s[16:19], s52 offen sc1
MAV 48,16,108
TR 34,7,25472
MAV 48,0,100
TR 48,7,25984
TR 50,7,26496
MAV 52,4,100
TR 36,7,24992
MAV 52,20,108
buffer_load_dwordx4 v[84:87], v4, s[16:19], s52 offen offset:1024 sc1
MAV 36,20,104
TR 38,7,25504
s_xor_b32 s52, s54, 1572864
MAV 36,4,96
TR 52,7,26016
TR 54,7,26528
s_waitcnt lgkmcnt(8)
MAV 40,8,96
TR 40,7,25024
MAV 40,24,104
buffer_load_dwordx4 v[88:91], v4, s[16:19], s53 offen sc1
MAV 56,24,108
TR 42,7,25536
MAV 56,8,100
TR 56,7,26048
TR 58,7,26560
MAV 60,12,100
TR 44,7,25056
MAV 60,28,108
buffer_load_dwordx4 v[92:95], v4, s[16:19], s53 offen offset:1024 sc1
MAV 44,28,104
TR 46,7,25568
s_xor_b32 s53, s54, 1703936
MAV 44,12,96
TR 60,7,26080
TR 62,7,26592
s_waitcnt vmcnt(8) lgkmcnt(8)
MAV 32,32,112
TR 0,7,33280
MAV 32,48,120
buffer_load_dwordx4 v[96:99], v4, s[16:19], s52 offen sc1
MAV 48,48,124
TR 2,7,33792
MAV 48,32,116
TR 16,7,34304
TR 18,7,34816
MAV 52,36,116
TR 4,7,33312
MAV 52,52,124
buffer_load_dwordx4 v[100:103], v4, s[16:19], s52 offen offset:1024 sc1
MAV 36,52,120
TR 6,7,33824
s_xor_b32 s52, s54, 1835008
MAV 36,36,112
TR 20,7,34336
TR 22,7,34848
s_waitcnt lgkmcnt(8)
MAV 40,40,112
TR 8,7,33344
MAV 40,56,120
buffer_load_dwordx4 v[104:107], v4, s[16:19], s53 offen sc1
MAV 56,56,124
TR 10,7,33856
MAV 56,40,116
TR 24,7,34368
TR 26,7,34880
MAV 60,44,116
TR 12,7,33376
MAV 60,60,124
buffer_load_dwordx4 v[108:111], v4, s[16:19], s53 offen offset:1024 sc1
MAV 44,60,120
TR 14,7,33888
s_xor_b32 s53, s54, 1966080
MAV 44,44,112
TR 28,7,34400
TR 30,7,34912
s_waitcnt vmcnt(8) lgkmcnt(8)
.Lpad21:
s_cbranch_execz .Lpad24
MAV 32,0,64
TR 32,7,41600
MAV 32,16,72
buffer_load_dwordx4 v[112:115], v4, s[16:19], s52 offen sc1
MAV 48,16,76
TR 34,7,42112
MAV 48,0,68
TR 48,7,42624
TR 50,7,43136
MAV 52,4,68
TR 36,7,41632
MAV 52,20,76
buffer_load_dwordx4 v[116:119], v4, s[16:19], s52 offen offset:1024 sc1
MAV 36,20,72
TR 38,7,42144
s_xor_b32 s52, s54, 2097152
MAV 36,4,64
TR 52,7,42656
TR 54,7,43168
s_waitcnt lgkmcnt(8)
MAV 40,8,64
TR 40,7,41664
MAV 40,24,72
buffer_load_dwordx4 v[120:123], v4, s[16:19], s53 offen sc1
MAV 56,24,76
TR 42,7,42176
MAV 56,8,68
TR 56,7,42688
TR 58,7,43200
MAV 60,12,68
TR 44,7,41696
MAV 60,28,76
buffer_load_dwordx4 v[124:127], v4, s[16:19], s53 offen offset:1024 sc1
MAV 44,28,72
TR 46,7,42208
s_xor_b32 s53, s54, 2228224
MAV 44,12,64
TR 60,7,42720
TR 62,7,43232
s_waitcnt vmcnt(8) lgkmcnt(8)
MAV 32,32,80
TR 0,7,49920
MAV 32,48,88
buffer_load_dwordx4 v[64:67], v4, s[16:19], s52 offen sc1
MAV 48,48,92
TR 2,7,50432
MAV 48,32,84
TR 16,7,50944
TR 18,7,51456
MAV 52,36,84
TR 4,7,49952
MAV 52,52,92
buffer_load_dwordx4 v[68:71], v4, s[16:19], s52 offen offset:1024 sc1
MAV 36,52,88
TR 6,7,50464
s_xor_b32 s52, s54, 2359296
MAV 36,36,80
TR 20,7,50976
TR 22,7,51488
s_waitcnt lgkmcnt(8)
MAV 40,40,80
TR 8,7,49984
MAV 40,56,88
buffer_load_dwordx4 v[72:75], v4, s[16:19], s53 offen sc1
MAV 56,56,92
TR 10,7,50496
MAV 56,40,84
TR 24,7,51008
TR 26,7,51520
MAV 60,44,84
TR 12,7,50016
MAV 60,60,92
buffer_load_dwordx4 v[76:79], v4, s[16:19], s53 offen offset:1024 sc1
MAV 44,60,88
TR 14,7,50528
s_xor_b32 s53, s54, 2490368
MAV 44,44,80
TR 28,7,51040
TR 30,7,51552
s_waitcnt vmcnt(8) lgkmcnt(8)
MAV 32,0,96
TR 32,7,58240
MAV 32,16,104
buffer_load_dwordx4 v[80:83], v4, s[16:19], s52 offen sc1
MAV 48,16,108
TR 34,7,58752
MAV 48,0,100
TR 48,7,59264
TR 50,7,59776
MAV 52,4,100
TR 36,7,58272
MAV 52,20,108
buffer_load_dwordx4 v[84:87], v4, s[16:19], s52 offen offset:1024 sc1
MAV 36,20,104
TR 38,7,58784
s_xor_b32 s52, s54, 2621440
MAV 36,4,96
TR 52,7,59296
TR 54,7,59808
s_waitcnt lgkmcnt(8)
MAV 40,8,96
TR 40,7,58304
MAV 40,24,104
buffer_load_dwordx4 v[88:91], v4, s[16:19], s53 offen sc1
MAV 56,24,108
TR 42,7,58816
MAV 56,8,100
TR 56,7,59328
TR 58,7,59840
MAV 60,12,100
TR 44,7,58336
MAV 60,28,108
buffer_load_dwordx4 v[92:95], v4, s[16:19], s53 offen offset:1024 sc1
MAV 44,28,104
TR 46,7,58848
s_xor_b32 s53, s54, 2752512
MAV 44,12,96
TR 60,7,59360
TR 62,7,59872
s_xor_b32 s57, s57, 66560
v_add_u32 v7, s57, v8
s_waitcnt vmcnt(8) lgkmcnt(8)
MAV 32,32,112
ds_read_b64_tr_b16 a[0:1], v7
MAV 32,48,120
buffer_load_dwordx4 v[96:99], v4, s[16:19], s52 offen sc1
MAV 48,48,124
TR 2,7,512
MAV 48,32,116
TR 16,7,1024
TR 18,7,1536
MAV 52,36,116
TR 4,7,32
MAV 52,52,124
buffer_load_dwordx4 v[100:103], v4, s[16:19], s52 offen offset:1024 sc1
MAV 36,52,120
TR 6,7,544
s_xor_b32 s52, s54, 2883584
MAV 36,36,112
TR 20,7,1056
TR 22,7,1568
s_waitcnt lgkmcnt(8)
MAV 40,40,112
TR 8,7,64
MAV 40,56,120
buffer_load_dwordx4 v[104:107], v4, s[16:19], s53 offen sc1
MAV 56,56,124
TR 10,7,576
MAV 56,40,116
TR 24,7,1088
TR 26,7,1600
MAV 60,44,116
TR 12,7,96
MAV 60,60,124
buffer_load_dwordx4 v[108:111], v4, s[16:19], s53 offen offset:1024 sc1
MAV 44,60,120
TR 14,7,608
s_xor_b32 s53, s54, 3014656
MAV 44,44,112
TR 28,7,1120
TR 30,7,1632
s_waitcnt vmcnt(8) lgkmcnt(8)
MAV 32,0,64
TR 32,7,8320
MAV 32,16,72
buffer_load_dwordx4 v[112:115], v4, s[16:19], s52 offen sc1
MAV 48,16,76
TR 34,7,8832
MAV 48,0,68
TR 48,7,9344
TR 50,7,9856
MAV 52,4,68
TR 36,7,8352
MAV 52,20,76
buffer_load_dwordx4 v[116:119], v4, s[16:19], s52 offen offset:1024 sc1
MAV 36,20,72
TR 38,7,8864
s_xor_b32 s52, s54, 3145728
MAV 36,4,64
TR 52,7,9376
TR 54,7,9888
s_waitcnt lgkmcnt(8)
MAV 40,8,64
TR 40,7,8384
MAV 40,24,72
buffer_load_dwordx4 v[120:123], v4, s[16:19], s53 offen sc1
MAV 56,24,76
TR 42,7,8896
MAV 56,8,68
TR 56,7,9408
TR 58,7,9920
MAV 60,12,68
TR 44,7,8416
MAV 60,28,76
buffer_load_dwordx4 v[124:127], v4, s[16:19], s53 offen offset:1024 sc1
MAV 44,28,72
TR 46,7,8928
s_xor_b32 s53, s54, 3276800
MAV 44,12,64
TR 60,7,9440
TR 62,7,9952
s_waitcnt vmcnt(8) lgkmcnt(8)
MAV 32,32,80
TR 0,7,16640
MAV 32,48,88
buffer_load_dwordx4 v[64:67], v4, s[16:19], s52 offen sc1
MAV 48,48,92
TR 2,7,17152
MAV 48,32,84
TR 16,7,17664
TR 18,7,18176
MAV 52,36,84
TR 4,7,16672
MAV 52,52,92
buffer_load_dwordx4 v[68:71], v4, s[16:19], s52 offen offset:1024 sc1
MAV 36,52,88
TR 6,7,17184
s_xor_b32 s52, s54, 3407872
MAV 36,36,80
TR 20,7,17696
TR 22,7,18208
s_waitcnt lgkmcnt(8)
MAV 40,40,80
TR 8,7,16704
MAV 40,56,88
buffer_load_dwordx4 v[72:75], v4, s[16:19], s53 offen sc1
MAV 56,56,92
TR 10,7,17216
MAV 56,40,84
TR 24,7,17728
TR 26,7,18240
MAV 60,44,84
TR 12,7,16736
MAV 60,60,92
buffer_load_dwordx4 v[76:79], v4, s[16:19], s53 offen offset:1024 sc1
MAV 44,60,88
TR 14,7,17248
s_xor_b32 s53, s54, 3538944
MAV 44,44,80
TR 28,7,17760
TR 30,7,18272
s_waitcnt vmcnt(8) lgkmcnt(8)
MAV 32,0,96
TR 32,7,24960
MAV 32,16,104
buffer_load_dwordx4 v[80:83], v4, s[16:19], s52 offen sc1
MAV 48,16,108
TR 34,7,25472
MAV 48,0,100
TR 48,7,25984
TR 50,7,26496
MAV 52,4,100
TR 36,7,24992
MAV 52,20,108
buffer_load_dwordx4 v[84:87], v4, s[16:19], s52 offen offset:1024 sc1
MAV 36,20,104
TR 38,7,25504
s_xor_b32 s52, s54, 3670016
MAV 36,4,96
TR 52,7,26016
TR 54,7,26528
s_waitcnt lgkmcnt(8)
MAV 40,8,96
TR 40,7,25024
MAV 40,24,104
buffer_load_dwordx4 v[88:91], v4, s[16:19], s53 offen sc1
MAV 56,24,108
TR 42,7,25536
MAV 56,8,100
TR 56,7,26048
TR 58,7,26560
MAV 60,12,100
TR 44,7,25056
MAV 60,28,108
buffer_load_dwordx4 v[92:95], v4, s[16:19], s53 offen offset:1024 sc1
MAV 44,28,104
TR 46,7,25568
s_xor_b32 s53, s54, 3801088
MAV 44,12,96
TR 60,7,26080
TR 62,7,26592
s_waitcnt vmcnt(8) lgkmcnt(8)
MAV 32,32,112
TR 0,7,33280
MAV 32,48,120
buffer_load_dwordx4 v[96:99], v4, s[16:19], s52 offen sc1
MAV 48,48,124
TR 2,7,33792
MAV 48,32,116
TR 16,7,34304
TR 18,7,34816
MAV 52,36,116
TR 4,7,33312
MAV 52,52,124
buffer_load_dwordx4 v[100:103], v4, s[16:19], s52 offen offset:1024 sc1
MAV 36,52,120
TR 6,7,33824
s_xor_b32 s52, s54, 3932160
MAV 36,36,112
TR 20,7,34336
TR 22,7,34848
s_waitcnt lgkmcnt(8)
MAV 40,40,112
TR 8,7,33344
MAV 40,56,120
buffer_load_dwordx4 v[104:107], v4, s[16:19], s53 offen sc1
MAV 56,56,124
TR 10,7,33856
MAV 56,40,116
TR 24,7,34368
TR 26,7,34880
MAV 60,44,116
TR 12,7,33376
MAV 60,60,124
buffer_load_dwordx4 v[108:111], v4, s[16:19], s53 offen offset:1024 sc1
MAV 44,60,120
TR 14,7,33888
s_xor_b32 s53, s54, 4063232
MAV 44,44,112
TR 28,7,34400
TR 30,7,34912
s_waitcnt vmcnt(8) lgkmcnt(8)
MAV 32,0,64
TR 32,7,41600
MAV 32,16,72
buffer_load_dwordx4 v[112:115], v4, s[16:19], s52 offen sc1
MAV 48,16,76
TR 34,7,42112
MAV 48,0,68
TR 48,7,42624
TR 50,7,43136
MAV 52,4,68
TR 36,7,41632
MAV 52,20,76
buffer_load_dwordx4 v[116:119], v4, s[16:19], s52 offen offset:1024 sc1
MAV 36,20,72
TR 38,7,42144
MAV 36,4,64
TR 52,7,42656
TR 54,7,43168
s_waitcnt lgkmcnt(8)
MAV 40,8,64
TR 40,7,41664
MAV 40,24,72
buffer_load_dwordx4 v[120:123], v4, s[16:19], s53 offen sc1
MAV 56,24,76
TR 42,7,42176
MAV 56,8,68
TR 56,7,42688
TR 58,7,43200
MAV 60,12,68
TR 44,7,41696
MAV 60,28,76
buffer_load_dwordx4 v[124:127], v4, s[16:19], s53 offen offset:1024 sc1
MAV 44,28,72
TR 46,7,42208
MAV 44,12,64
TR 60,7,42720
TR 62,7,43232
s_barrier
s_waitcnt vmcnt(8) lgkmcnt(8)
MAV 32,32,80
TR 0,7,49920
s_add_u32 m0, s59, 84480
MAV 32,48,88
buffer_load_dwordx4 v12, s[32:35], s58 offen   lds
MAV 48,48,92
TR 2,7,50432
MAV 48,32,84
TR 16,7,50944
TR 18,7,51456
MAV 52,36,84
TR 4,7,49952
MAV 52,52,92
buffer_load_dwordx4 v13, s[32:35], s58 offen offset:1056   lds
MAV 36,52,88
TR 6,7,50464
MAV 36,36,80
TR 20,7,50976
TR 22,7,51488
s_waitcnt lgkmcnt(8)
MAV 40,40,80
TR 8,7,49984
MAV 40,56,88
buffer_load_dwordx4 v14, s[32:35], s58 offen offset:2112   lds
MAV 56,56,92
TR 10,7,50496
MAV 56,40,84
TR 24,7,51008
TR 26,7,51520
MAV 60,44,84
TR 12,7,50016
MAV 60,60,92
buffer_load_dwordx4 v15, s[32:35], s58 offen offset:3168   lds
MAV 44,60,88
TR 14,7,50528
MAV 44,44,80
TR 28,7,51040
TR 30,7,51552
s_waitcnt vmcnt(8) lgkmcnt(8)
MAV 32,0,96
TR 32,7,58240
s_add_u32 m0, s59, 101376
MAV 32,16,104
buffer_load_dwordx4 v12, s[80:83], s58 offen   lds
MAV 48,16,108
TR 34,7,58752
MAV 48,0,100
TR 48,7,59264
TR 50,7,59776
MAV 52,4,100
TR 36,7,58272
MAV 52,20,108
buffer_load_dwordx4 v13, s[80:83], s58 offen offset:1056   lds
MAV 36,20,104
TR 38,7,58784
MAV 36,4,96
TR 52,7,59296
TR 54,7,59808
s_waitcnt lgkmcnt(8)
MAV 40,8,96
TR 40,7,58304
MAV 40,24,104
buffer_load_dwordx4 v14, s[80:83], s58 offen offset:2112   lds
MAV 56,24,108
TR 42,7,58816
MAV 56,8,100
TR 56,7,59328
TR 58,7,59840
MAV 60,12,100
TR 44,7,58336
MAV 60,28,108
buffer_load_dwordx4 v15, s[80:83], s58 offen offset:3168   lds
MAV 44,28,104
TR 46,7,58848
s_add_u32 s58, s58, 458752
MAV 44,12,96
TR 60,7,59360
TR 62,7,59872
s_waitcnt vmcnt(11) lgkmcnt(14)
MAV 32,32,112
s_add_u32 m0, s59, 118272
s_lshl_b32 s64, s6, 14
s_lshl_b32 s65, s49, 13
s_waitcnt vmcnt(9) lgkmcnt(12)
MAV 32,48,120
buffer_load_dwordx4 v12, s[32:35], s58 offen   lds
s_waitcnt vmcnt(9)
MAV 48,48,124
s_add_u32 s64, s64, s65
s_lshl_b32 s65, s7, 9
s_add_u32 s64, s64, s65
MAV 48,32,116
s_lshl_b32 s65, s48, 8
s_add_u32 s64, s64, s65
s_add_u32 s64, s64, 63176704
s_waitcnt lgkmcnt(10)
MAV 52,36,116
s_lshl_b32 s62, s7, 18
v_and_b32 v152, 31, v1
v_lshlrev_b32 v152, 3, v152
s_waitcnt lgkmcnt(8)
MAV 52,52,124
buffer_load_dwordx4 v13, s[32:35], s58 offen offset:1056   lds
MAV 36,52,120
s_add_u32 s62, s62, 41943040
v_lshrrev_b32 v153, 5, v1
v_lshl_add_u32 v152, v153, 28, v152
MAV 36,36,112
s_add_u32 s63, s62, 131072
v_cvt_pk_bf16_f32 v128, v32, v33
v_cvt_pk_bf16_f32 v129, v34, v35
s_waitcnt lgkmcnt(6)
MAV 40,40,112
v_cvt_pk_bf16_f32 v136, v48, v49
v_cvt_pk_bf16_f32 v137, v50, v51
s_waitcnt lgkmcnt(4)
MAV 40,56,120
buffer_load_dwordx4 v14, s[32:35], s58 offen offset:2112   lds
MAV 56,56,124
v_cvt_pk_bf16_f32 v130, v36, v37
v_cvt_pk_bf16_f32 v131, v38, v39
MAV 56,40,116
v_cvt_pk_bf16_f32 v138, v52, v53
v_cvt_pk_bf16_f32 v139, v54, v55
s_waitcnt lgkmcnt(2)
MAV 60,44,116
v_cvt_pk_bf16_f32 v132, v40, v41
v_cvt_pk_bf16_f32 v133, v42, v43
s_waitcnt lgkmcnt(0)
MAV 60,60,124
buffer_load_dwordx4 v15, s[32:35], s58 offen offset:3168   lds
MAV 44,60,120
v_cvt_pk_bf16_f32 v140, v56, v57
v_cvt_pk_bf16_f32 v141, v58, v59
MAV 44,44,112
s_nop 2
v_cvt_pk_bf16_f32 v142, v60, v61
v_cvt_pk_bf16_f32 v143, v62, v63
v_pk_mul_f32 v[146:147], v[32:33], v[32:33]
buffer_store_dwordx4 v[128:131], v4, s[16:19], s62 offen sc1
v_pk_mul_f32 v[150:151], v[48:49], v[48:49]
v_pk_fma_f32 v[146:147], v[34:35], v[34:35], v[146:147]
v_pk_add_f32 v[144:145], v[32:33], v[34:35]
v_pk_fma_f32 v[150:151], v[50:51], v[50:51], v[150:151]
v_cvt_pk_bf16_f32 v134, v44, v45
v_cvt_pk_bf16_f32 v135, v46, v47
v_pk_add_f32 v[148:149], v[48:49], v[50:51]
v_pk_fma_f32 v[146:147], v[36:37], v[36:37], v[146:147]
v_pk_add_f32 v[144:145], v[144:145], v[36:37]
v_pk_fma_f32 v[150:151], v[52:53], v[52:53], v[150:151]
v_pk_add_f32 v[148:149], v[148:149], v[52:53]
v_pk_fma_f32 v[146:147], v[38:39], v[38:39], v[146:147]
v_pk_add_f32 v[144:145], v[144:145], v[38:39]
buffer_store_dwordx4 v[132:135], v4, s[16:19], s63 offen sc1
v_pk_fma_f32 v[150:151], v[54:55], v[54:55], v[150:151]
v_pk_add_f32 v[148:149], v[148:149], v[54:55]
v_pk_fma_f32 v[146:147], v[40:41], v[40:41], v[146:147]
v_pk_add_f32 v[144:145], v[144:145], v[40:41]
v_pk_fma_f32 v[150:151], v[56:57], v[56:57], v[150:151]
v_pk_add_f32 v[148:149], v[148:149], v[56:57]
v_pk_fma_f32 v[146:147], v[42:43], v[42:43], v[146:147]
v_pk_add_f32 v[144:145], v[144:145], v[42:43]
v_pk_fma_f32 v[150:151], v[58:59], v[58:59], v[150:151]
v_pk_add_f32 v[148:149], v[148:149], v[58:59]
v_pk_fma_f32 v[146:147], v[44:45], v[44:45], v[146:147]
v_pk_add_f32 v[144:145], v[144:145], v[44:45]
v_pk_fma_f32 v[150:151], v[60:61], v[60:61], v[150:151]
buffer_store_dwordx4 v[136:139], v4, s[16:19], s62 offen offset:1024 sc1
v_pk_add_f32 v[148:149], v[148:149], v[60:61]
v_pk_fma_f32 v[146:147], v[46:47], v[46:47], v[146:147]
v_pk_add_f32 v[144:145], v[144:145], v[46:47]
v_pk_fma_f32 v[150:151], v[62:63], v[62:63], v[150:151]
v_pk_add_f32 v[148:149], v[148:149], v[62:63]
.Lpad22:
s_cbranch_execz .Lpad25
v_add_f32 v144, v144, v145
v_add_f32 v146, v146, v147
v_add_f32 v148, v148, v149
v_add_f32 v150, v150, v151
s_nop 0
v_permlane16_swap_b32 v144, v148
buffer_store_dwordx4 v[140:143], v4, s[16:19], s63 offen offset:1024 sc1
v_permlane16_swap_b32 v146, v150
v_add_f32 v144, v144, v148
v_add_f32 v146, v146, v150
s_nop 1
v_permlane32_swap_b32 v144, v146
v_add_f32 v144, v144, v146
s_nop 1
v_permlane32_swap_b32 v144, v145
buffer_store_dwordx2 v[144:145], v152, s[16:19], s64 offen sc1
s_nop 1
v_accvgpr_write_b32 a224, v32
v_accvgpr_write_b32 a225, v33
v_accvgpr_write_b32 a226, v34
v_accvgpr_write_b32 a227, v35
v_accvgpr_write_b32 a228, v36
v_accvgpr_write_b32 a229, v37
v_accvgpr_write_b32 a230, v38
v_accvgpr_write_b32 a231, v39
v_accvgpr_write_b32 a232, v40
v_accvgpr_write_b32 a233, v41
v_accvgpr_write_b32 a234, v42
v_accvgpr_write_b32 a235, v43
v_accvgpr_write_b32 a236, v44
v_accvgpr_write_b32 a237, v45
v_accvgpr_write_b32 a238, v46
v_accvgpr_write_b32 a239, v47
v_accvgpr_write_b32 a240, v48
v_accvgpr_write_b32 a241, v49
v_accvgpr_write_b32 a242, v50
v_accvgpr_write_b32 a243, v51
v_accvgpr_write_b32 a244, v52
v_accvgpr_write_b32 a245, v53
v_accvgpr_write_b32 a246, v54
v_accvgpr_write_b32 a247, v55
v_accvgpr_write_b32 a248, v56
v_accvgpr_write_b32 a249, v57
v_accvgpr_write_b32 a250, v58
v_accvgpr_write_b32 a251, v59
v_accvgpr_write_b32 a252, v60
v_accvgpr_write_b32 a253, v61
v_accvgpr_write_b32 a254, v62
v_accvgpr_write_b32 a255, v63
s_lshl_b32 s62, s10, 14
s_lshl_b32 s63, s3, 12
s_add_u32 s62, s62, s63
s_lshl_b32 s63, s12, 11
s_add_u32 s62, s62, s63
v_lshl_add_u32 v10, v1, 4, s62
v_lshrrev_b32 v2, 3, v1
v_cmp_eq_u32 vcc, 3, v2
v_add_u32 v2, 67108480, v10
s_nop 0
v_cndmask_b32 v10, v10, v2, vcc
v_xor_b32 v11, 2048, v10
v_bfe_u32 v16, v1, 2, 3
v_mul_u32_u24 v16, 1056, v16
v_bfe_u32 v2, v1, 5, 1
v_lshl_add_u32 v16, v2, 8, v16
v_and_b32 v2, 3, v1
v_lshl_add_u32 v16, v2, 3, v16
s_lshl_b32 s62, s12, 6
s_add_u32 s62, s62, 84480
s_xor_b32 s63, s12, 1
s_mul_i32 s63, s63, 192
s_add_u32 s63, s63, 84480
v_add_u32 v17, s63, v16
v_add_u32 v16, s62, v16
s_mov_b32 s52, 41943040
s_mov_b32 s53, 41943040
s_mov_b32 s54, s58
s_mov_b32 s55, s59
s_mul_i32 s59, s3, 2112
s_and_b32 s62, s7, 1
s_mul_i32 s62, s62, 3670016
s_lshr_b32 s63, s7, 1
s_lshl_b32 s63, s63, 8
s_add_u32 s62, s62, s63
s_lshl_b32 s63, s3, 12
s_add_u32 s62, s62, s63
v_lshrrev_b32 v5, 4, v1
v_lshlrev_b32 v5, 14, v5
v_and_b32 v2, 15, v1
v_lshl_add_u32 v5, v2, 4, v5
v_add_u32 v5, s62, v5
v_add_u32 v6, 992, v5
s_lshl_b32 s62, s10, 15
s_lshl_b32 s63, s3, 13
s_add_u32 s62, s62, s63
v_lshl_add_u32 v4, v1, 4, s62
s_lshl_b32 s62, s6, 10
s_add_u32 s62, s62, 30507008
s_lshl_b32 s64, s10, 1
s_lshl_b32 s64, s64, 10
s_add_u32 s64, s64, 30507008
s_lshr_b32 s67, s5, 2
s_and_b32 s67, s67, 3
s_lshl_b32 s67, s67, 7
s_add_u32 s64, s64, s67
s_add_u32 s65, s64, 1024
v_lshl_add_u32 v252, v1, 7, s62
v_mov_b32 v253, s64
v_mov_b32 v255, 1
v_writelane_b32 v253, s65, 1
s_waitcnt vmcnt(0) lgkmcnt(0)
s_cmp_lg_u32 s3, 1
s_barrier
s_cbranch_scc1 .Lnopoll63
s_mov_b64 exec, 15
buffer_atomic_add v255, v252, s[16:19], 0 offen
s_mov_b64 exec, 3
v_mov_b32 v254, 0
buffer_atomic_add v254, v253, s[16:19], 0 offen sc0
s_sleep 5
s_mov_b32 s15, 0
.Lpoll62:
v_mov_b32 v255, 0
buffer_atomic_add v255, v253, s[16:19], 0 offen sc0
s_waitcnt vmcnt(1)
v_cmp_gt_u32 vcc, 16, v254
s_add_u32 s15, s15, 1
s_cbranch_vccz .Lnopoll63r
v_mov_b32 v254, 0
buffer_atomic_add v254, v253, s[16:19], 0 offen sc0
s_waitcnt vmcnt(1)
v_cmp_gt_u32 vcc, 16, v255
s_add_u32 s15, s15, 1
s_cbranch_vccz .Lnopoll63r
s_cmp_le_u32 s15, 100000
s_cbranch_scc1 .Lpoll62
s_branch .Lnopoll63r
.Lnopoll63:
s_mov_b64 exec, 0
s_cmp_eq_u32 s3, 2
s_cbranch_scc1 .Lpad27
s_cmp_eq_u32 s3, 3
s_cbranch_scc1 .Lpad28
s_branch .Lpad29
.Lnopoll63r:
s_mov_b64 exec, -1
s_barrier
buffer_load_dwordx4 a[128:131], v10, s[16:19], s52 offen sc1
buffer_load_dwordx4 a[132:135], v10, s[16:19], s52 offen offset:1024 sc1
s_add_u32 s52, s52, 131072
buffer_load_dwordx4 a[144:147], v10, s[16:19], s52 offen sc1
buffer_load_dwordx4 a[148:151], v10, s[16:19], s52 offen offset:1024 sc1
s_add_u32 s52, s52, 131072
buffer_load_dwordx4 a[136:139], v11, s[16:19], s53 offen sc1
buffer_load_dwordx4 a[140:143], v11, s[16:19], s53 offen offset:1024 sc1
s_add_u32 s53, s53, 131072
buffer_load_dwordx4 a[152:155], v11, s[16:19], s53 offen sc1
buffer_load_dwordx4 a[156:159], v11, s[16:19], s53 offen offset:1024 sc1
s_add_u32 s53, s53, 131072
ds_read_b64_tr_b16 a[0:1], v16
TR 2,16,512
TR 4,16,8448
TR 6,16,8960
TR 8,16,32
TR 10,16,544
TR 12,16,8480
TR 14,16,8992
TR 16,16,64
TR 18,16,576
TR 20,16,8512
TR 22,16,9024
TR 24,16,96
TR 26,16,608
TR 28,16,8544
TR 30,16,9056
TR 32,16,128
TR 34,16,640
TR 36,16,8576
TR 38,16,9088
TR 40,16,160
TR 42,16,672
TR 44,16,8608
TR 46,16,9120
ds_read_b64_tr_b16 a[48:49], v17
TR 50,17,512
TR 52,17,8448
TR 54,17,8960
TR 56,17,32
TR 58,17,544
TR 60,17,8480
TR 62,17,8992
s_add_u32 m0, s55, 135168
s_nop 0
buffer_load_dwordx4 v12, s[80:83], s54 offen   lds
buffer_load_dwordx4 v13, s[80:83], s54 offen offset:1056   lds
buffer_load_dwordx4 v14, s[80:83], s54 offen offset:2112   lds
buffer_load_dwordx4 v15, s[80:83], s54 offen offset:3168   lds
s_add_u32 s54, s54, 458752
s_lshl_b32 s57, s3, 13
s_add_u32 s57, s57, 49920
v_lshl_add_u32 v2, v1, 4, s57
s_waitcnt lgkmcnt(0)
s_barrier
s_waitcnt vmcnt(11)
v_mfma_f32_16x16x32_bf16 v[32:35], a[0:3], a[128:131], 0
buffer_load_dwordx4 a[160:163], v10, s[16:19], s52 offen sc1
s_waitcnt vmcnt(10)
MAA 32,4,144
TR 64,16,16896
v_mfma_f32_16x16x32_bf16 v[36:39], a[0:3], a[132:135], 0
TR 66,16,17408
s_waitcnt vmcnt(9)
MAA 36,4,148
TR 68,16,25344
v_mfma_f32_16x16x32_bf16 v[52:55], a[8:11], a[132:135], 0
buffer_load_dwordx4 a[164:167], v10, s[16:19], s52 offen offset:1024 sc1
MAA 52,12,148
TR 70,16,25856
s_add_u32 s52, s52, 131072
v_mfma_f32_16x16x32_bf16 v[48:51], a[8:11], a[128:131], 0
TR 72,16,16928
MAA 48,12,144
TR 74,16,17440
v_mfma_f32_16x16x32_bf16 v[96:99], a[16:19], a[128:131], 0
buffer_load_dwordx4 a[176:179], v10, s[16:19], s52 offen sc1
MAA 96,20,144
TR 76,16,25376
v_mfma_f32_16x16x32_bf16 v[100:103], a[16:19], a[132:135], 0
TR 78,16,25888
MAA 100,20,148
TR 80,16,16960
v_mfma_f32_16x16x32_bf16 v[116:119], a[24:27], a[132:135], 0
buffer_load_dwordx4 a[180:183], v10, s[16:19], s52 offen offset:1024 sc1
MAA 116,28,148
TR 82,16,17472
s_add_u32 s52, s52, 131072
v_mfma_f32_16x16x32_bf16 v[112:115], a[24:27], a[128:131], 0
TR 84,16,25408
MAA 112,28,144
TR 86,16,25920
v_mfma_f32_16x16x32_bf16 v[160:163], a[32:35], a[128:131], 0
buffer_load_dwordx4 a[168:171], v11, s[16:19], s53 offen sc1
MAA 160,36,144
TR 88,16,16992
v_mfma_f32_16x16x32_bf16 v[164:167], a[32:35], a[132:135], 0
TR 90,16,17504
MAA 164,36,148
TR 92,16,25440
v_mfma_f32_16x16x32_bf16 v[180:183], a[40:43], a[132:135], 0
buffer_load_dwordx4 a[172:175], v11, s[16:19], s53 offen offset:1024 sc1
MAA 180,44,148
TR 94,16,25952
s_add_u32 s53, s53, 131072
v_mfma_f32_16x16x32_bf16 v[176:179], a[40:43], a[128:131], 0
TR 96,16,17024
MAA 176,44,144
TR 98,16,17536
v_mfma_f32_16x16x32_bf16 v[224:227], a[48:51], a[128:131], 0
buffer_load_dwordx4 a[184:187], v11, s[16:19], s53 offen sc1
MAA 224,52,144
TR 100,16,25472
v_mfma_f32_16x16x32_bf16 v[228:231], a[48:51], a[132:135], 0
TR 102,16,25984
MAA 228,52,148
TR 104,16,17056
v_mfma_f32_16x16x32_bf16 v[236:239], a[56:59], a[132:135], 0
buffer_load_dwordx4 a[188:191], v11, s[16:19], s53 offen offset:1024 sc1
MAA 236,60,148
TR 106,16,17568
s_add_u32 s53, s53, 131072
v_mfma_f32_16x16x32_bf16 v[232:235], a[56:59], a[128:131], 0
TR 108,16,25504
s_add_u32 m0, s55, 84480
MAA 232,60,144
TR 110,16,26016
s_waitcnt vmcnt(12)
v_mfma_f32_16x16x32_bf16 v[188:191], a[40:43], a[140:143], 0
buffer_load_dwordx4 v12, s[32:35], s54 offen   lds
MAA 188,44,156
TR 112,17,16896
v_mfma_f32_16x16x32_bf16 v[184:187], a[40:43], a[136:139], 0
TR 114,17,17408
MAA 184,44,152
TR 116,17,25344
v_mfma_f32_16x16x32_bf16 v[168:171], a[32:35], a[136:139], 0
buffer_load_dwordx4 v13, s[32:35], s54 offen offset:1056   lds
MAA 168,36,152
TR 118,17,25856
v_mfma_f32_16x16x32_bf16 v[172:175], a[32:35], a[140:143], 0
TR 120,17,16928
MAA 172,36,156
TR 122,17,17440
v_mfma_f32_16x16x32_bf16 v[124:127], a[24:27], a[140:143], 0
buffer_load_dwordx4 v14, s[32:35], s54 offen offset:2112   lds
MAA 124,28,156
TR 124,17,25376
v_mfma_f32_16x16x32_bf16 v[120:123], a[24:27], a[136:139], 0
TR 126,17,25888
MAA 120,28,152
v_mfma_f32_16x16x32_bf16 v[104:107], a[16:19], a[136:139], 0
buffer_load_dwordx4 v15, s[32:35], s54 offen offset:3168   lds
MAA 104,20,152
v_mfma_f32_16x16x32_bf16 v[108:111], a[16:19], a[140:143], 0
MAA 108,20,156
v_mfma_f32_16x16x32_bf16 v[60:63], a[8:11], a[140:143], 0
MAA 60,12,156
v_mfma_f32_16x16x32_bf16 v[56:59], a[8:11], a[136:139], 0
MAA 56,12,152
v_mfma_f32_16x16x32_bf16 v[40:43], a[0:3], a[136:139], 0
MAA 40,4,152
v_mfma_f32_16x16x32_bf16 v[44:47], a[0:3], a[140:143], 0
MAA 44,4,156
s_waitcnt lgkmcnt(0)
s_barrier
v_mfma_f32_16x16x32_bf16 v[64:67], a[64:67], a[128:131], 0
TR 0,16,33792
s_add_u32 m0, s55, 101376
MAA 64,68,144
buffer_load_dwordx4 v12, s[80:83], s54 offen   lds
v_mfma_f32_16x16x32_bf16 v[68:71], a[64:67], a[132:135], 0
TR 2,16,34304
s_mul_i32 s66, s13, 114688
MAA 68,68,148
TR 4,16,42240
s_mul_i32 s65, s10, 1818624
v_mfma_f32_16x16x32_bf16 v[84:87], a[72:75], a[132:135], 0
TR 6,16,42752
s_add_u32 s66, s66, s65
MAA 84,76,148
TR 8,16,33824
s_add_u32 s66, s66, 46137344
v_mfma_f32_16x16x32_bf16 v[80:83], a[72:75], a[128:131], 0
buffer_load_dwordx4 v13, s[80:83], s54 offen offset:1056   lds
MAA 80,76,144
TR 10,16,34336
s_add_u32 s65, s66, 49152
v_mfma_f32_16x16x32_bf16 v[128:131], a[80:83], a[128:131], 0
TR 12,16,42272
s_lshl_b32 s62, s12, 16
MAA 128,84,144
TR 14,16,42784
s_add_u32 s62, s62, s66
v_mfma_f32_16x16x32_bf16 v[132:135], a[80:83], a[132:135], 0
TR 16,16,33856
s_add_u32 s63, s62, 16384
MAA 132,84,148
buffer_load_dwordx4 v14, s[80:83], s54 offen offset:2112   lds
v_mfma_f32_16x16x32_bf16 v[148:151], a[88:91], a[132:135], 0
TR 18,16,34368
s_add_u32 s64, s62, 32768
MAA 148,92,148
TR 20,16,42304
s_lshl_b32 s72, s10, 1
v_mfma_f32_16x16x32_bf16 v[144:147], a[88:91], a[128:131], 0
TR 22,16,42816
s_lshr_b32 s74, s11, 4
MAA 144,92,144
TR 24,16,33888
s_add_u32 s72, s72, s74
v_mfma_f32_16x16x32_bf16 v[192:195], a[96:99], a[128:131], 0
buffer_load_dwordx4 v15, s[80:83], s54 offen offset:3168   lds
MAA 192,100,144
TR 26,16,34400
s_add_u32 s54, s54, 458752
v_mfma_f32_16x16x32_bf16 v[196:199], a[96:99], a[132:135], 0
TR 28,16,42336
s_add_u32 m0, s57, 0
MAA 196,100,148
TR 30,16,42848
s_mov_b32 s58, 63176704
v_mfma_f32_16x16x32_bf16 v[212:215], a[104:107], a[132:135], 0
TR 32,16,33920
s_lshl_b32 s72, s72, 10
MAA 212,108,148
buffer_load_dwordx4 v4, s[16:19], s58 offen sc1 lds
v_mfma_f32_16x16x32_bf16 v[208:211], a[104:107], a[128:131], 0
TR 34,16,34432
s_add_u32 s72, s72, 30523392
MAA 208,108,144
TR 36,16,42368
s_and_b32 s73, s6, 14
v_mfma_f32_16x16x32_bf16 v[240:243], a[112:115], a[128:131], 0
TR 38,16,42880
s_and_b32 s74, s7, 1
MAA 240,116,144
TR 40,16,33952
s_add_u32 s73, s73, s74
v_mfma_f32_16x16x32_bf16 v[244:247], a[112:115], a[132:135], 0
buffer_load_dwordx4 v4, s[16:19], s58 offen offset:1024 sc1 lds
MAA 244,116,148
TR 42,16,34464
s_lshl_b32 s73, s73, 10
v_mfma_f32_16x16x32_bf16 v[252:255], a[120:123], a[132:135], 0
TR 44,16,42400
s_add_u32 s73, s73, 30523392
MAA 252,124,148
TR 46,16,42912
s_lshr_b32 s67, s5, 2
v_mfma_f32_16x16x32_bf16 v[248:251], a[120:123], a[128:131], 0
TR 48,17,33792
s_and_b32 s67, s67, 3
MAA 248,124,144
buffer_load_dwordx4 a[128:131], v10, s[16:19], s52 offen sc1
v_mfma_f32_16x16x32_bf16 v[220:223], a[104:107], a[140:143], 0
TR 50,17,34304
s_lshl_b32 s67, s67, 7
MAA 220,108,156
TR 52,17,42240
s_add_u32 s73, s73, s67
v_mfma_f32_16x16x32_bf16 v[216:219], a[104:107], a[136:139], 0
TR 54,17,42752
MAA 216,108,152
TR 56,17,33824
v_mfma_f32_16x16x32_bf16 v[200:203], a[96:99], a[136:139], 0
buffer_load_dwordx4 a[132:135], v10, s[16:19], s52 offen offset:1024 sc1
MAA 200,100,152
TR 58,17,34336
s_add_u32 s52, s52, 131072
v_mfma_f32_16x16x32_bf16 v[204:207], a[96:99], a[140:143], 0
TR 60,17,42272
MAA 204,100,156
TR 62,17,42784
v_mfma_f32_16x16x32_bf16 v[156:159], a[88:91], a[140:143], 0
MAA 156,92,156
buffer_load_dwordx4 a[144:147], v10, s[16:19], s52 offen sc1
v_mfma_f32_16x16x32_bf16 v[152:155], a[88:91], a[136:139], 0
MAA 152,92,152
v_mfma_f32_16x16x32_bf16 v[136:139], a[80:83], a[136:139], 0
MAA 136,84,152
v_mfma_f32_16x16x32_bf16 v[140:143], a[80:83], a[140:143], 0
buffer_load_dwordx4 a[148:151], v10, s[16:19], s52 offen offset:1024 sc1
MAA 140,84,156
s_add_u32 s52, s52, 131072
v_mfma_f32_16x16x32_bf16 v[92:95], a[72:75], a[140:143], 0
MAA 92,76,156
v_mfma_f32_16x16x32_bf16 v[88:91], a[72:75], a[136:139], 0
MAA 88,76,152
v_mfma_f32_16x16x32_bf16 v[72:75], a[64:67], a[136:139], 0
MAA 72,68,152
v_mfma_f32_16x16x32_bf16 v[76:79], a[64:67], a[140:143], 0
MAA 76,68,156
s_waitcnt vmcnt(18) lgkmcnt(0)
s_barrier
MAA 32,0,160
buffer_load_dwordx4 a[136:139], v11, s[16:19], s53 offen sc1
MAA 32,4,176
TR 64,16,50688
s_and_b32 s74, s7, 1
MAA 36,4,180
TR 66,16,51200
s_mul_i32 s87, s74, 917504
MAA 36,0,164
TR 68,16,59136
s_lshr_b32 s75, s6, 1
MAA 52,8,164
TR 70,16,59648
s_mul_i32 s75, s75, 1818624
MAA 52,12,180
buffer_load_dwordx4 a[140:143], v11, s[16:19], s53 offen offset:1024 sc1
MAA 48,12,176
TR 72,16,50720
s_add_u32 s53, s53, 131072
MAA 48,8,160
TR 74,16,51232
s_add_u32 s87, s87, s75
MAA 96,16,160
TR 76,16,59168
s_add_u32 s87, s87, 46137344
MAA 96,20,176
TR 78,16,59680
s_and_b32 s74, s6, 3
MAA 100,20,180
buffer_load_dwordx4 a[152:155], v11, s[16:19], s53 offen sc1
MAA 100,16,164
TR 80,16,50752
s_xor_b32 s75, s74, 0
MAA 116,24,164
TR 82,16,51264
s_sub_u32 s75, s75, 0
MAA 116,28,180
TR 84,16,59200
s_mul_i32 s98, s75, 458752
MAA 112,28,176
TR 86,16,59712
s_mul_i32 s75, s75, 114688
MAA 112,24,160
buffer_load_dwordx4 a[156:159], v11, s[16:19], s53 offen offset:1024 sc1
MAA 160,32,160
TR 88,16,50784
s_add_u32 s53, s53, 131072
MAA 160,36,176
TR 90,16,51296
s_add_u32 m0, s55, 118272
MAA 164,36,180
TR 92,16,59232
s_add_u32 s76, s87, s75
MAA 164,32,164
TR 94,16,59744
s_xor_b32 s75, s74, 1
MAA 180,40,164
buffer_load_dwordx4 v12, s[32:35], s54 offen   lds
MAA 180,44,180
TR 96,16,50816
s_sub_u32 s75, s75, 1
MAA 176,44,176
TR 98,16,51328
s_mul_i32 s99, s75, 458752
MAA 176,40,160
TR 100,16,59264
s_mul_i32 s75, s75, 114688
MAA 224,48,160
TR 102,16,59776
s_add_u32 s77, s87, s75
MAA 224,52,176
buffer_load_dwordx4 v13, s[32:35], s54 offen offset:1056   lds
MAA 228,52,180
TR 104,16,50848
s_xor_b32 s75, s74, 2
MAA 228,48,164
TR 106,16,51360
s_sub_u32 s75, s75, 2
MAA 236,56,164
TR 108,16,59296
s_mul_i32 s100, s75, 458752
MAA 236,60,180
TR 110,16,59808
s_mul_i32 s75, s75, 114688
MAA 232,60,176
buffer_load_dwordx4 v14, s[32:35], s54 offen offset:2112   lds
MAA 232,56,160
TR 112,17,50688
s_add_u32 s78, s87, s75
s_waitcnt vmcnt(21)
MAA 188,40,172
TR 114,17,51200
s_xor_b32 s75, s74, 3
MAA 188,44,188
TR 116,17,59136
MAA 184,44,184
TR 118,17,59648
MAA 184,40,168
buffer_load_dwordx4 v15, s[32:35], s54 offen offset:3168   lds
MAA 168,32,168
TR 120,17,50720
s_add_u32 m0, s57, 2048
MAA 168,36,184
TR 122,17,51232
s_mov_b32 s58, 63178752
MAA 172,36,188
TR 124,17,59168
MAA 172,32,172
TR 126,17,59680
MAA 124,24,172
buffer_load_dwordx4 v4, s[16:19], s58 offen sc1 lds
MAA 124,28,188
MAA 120,28,184
MAA 120,24,168
MAA 104,16,168
MAA 104,20,184
buffer_load_dwordx4 v4, s[16:19], s58 offen offset:1024 sc1 lds
MAA 108,20,188
MAA 108,16,172
MAA 60,8,172
MAA 60,12,188
MAA 56,12,184
MAA 56,8,168
MAA 40,0,168
MAA 40,4,184
MAA 44,4,188
MAA 44,0,172
s_waitcnt vmcnt(20) lgkmcnt(0)
s_barrier
MAA 64,64,160
ds_read_b64_tr_b16 a[0:1], v16
s_add_u32 m0, s55, 135168
MAA 64,68,176
buffer_load_dwordx4 v12, s[80:83], s54 offen   lds
MAA 68,68,180
.Lpad23:
s_cbranch_execz .Lpad26
TR 2,16,512
s_sub_u32 s75, s75, 3
MAA 68,64,164
TR 4,16,8448
s_mul_i32 s101, s75, 458752
MAA 84,72,164
TR 6,16,8960
s_mul_i32 s75, s75, 114688
MAA 84,76,180
TR 8,16,32
s_add_u32 s79, s87, s75
MAA 80,76,176
buffer_load_dwordx4 v13, s[80:83], s54 offen offset:1056   lds
MAA 80,72,160
TR 10,16,544
s_and_b32 s87, s6, 3
MAA 128,80,160
TR 12,16,8480
s_mov_b32 s46, 0
MAA 128,84,176
TR 14,16,8992
s_lshl_b32 s74, s3, 10
MAA 132,84,180
TR 16,16,64
s_lshl_b32 s75, s12, 9
MAA 132,80,164
buffer_load_dwordx4 v14, s[80:83], s54 offen offset:2112   lds
MAA 148,88,164
TR 18,16,576
s_add_u32 s74, s74, s75
MAA 148,92,180
TR 20,16,8512
s_add_u32 s74, s74, 152576
MAA 144,92,176
TR 22,16,9024
v_and_b32 v18, 15, v1
MAA 144,88,160
TR 24,16,96
v_lshl_add_u32 v18, v18, 4, s74
MAA 192,96,160
buffer_load_dwordx4 v15, s[80:83], s54 offen offset:3168   lds
MAA 192,100,176
TR 26,16,608
s_add_u32 s54, s54, 458752
MAA 196,100,180
TR 28,16,8544
s_add_u32 m0, s57, 4096
MAA 196,96,164
TR 30,16,9056
s_mov_b32 s58, 63180800
MAA 212,104,164
TR 32,16,128
v_xor_b32 v19, 512, v18
MAA 212,108,180
buffer_load_dwordx4 v4, s[16:19], s58 offen sc1 lds
MAA 208,108,176
TR 34,16,640
s_lshl_b32 s74, s12, 7
MAA 208,104,160
TR 36,16,8576
s_add_u32 s74, s74, 161536
MAA 240,112,160
TR 38,16,9088
s_xor_b32 s75, s12, 1
MAA 240,116,176
TR 40,16,160
s_mul_i32 s75, s75, 384
MAA 244,116,180
buffer_load_dwordx4 v4, s[16:19], s58 offen offset:1024 sc1 lds
MAA 244,112,164
TR 42,16,672
s_add_u32 s75, s75, 161536
MAA 252,120,164
TR 44,16,8608
v_lshrrev_b32 v9, 4, v1
MAA 252,124,180
TR 46,16,9120
v_lshlrev_b32 v9, 4, v9
MAA 248,124,176
ds_read_b64_tr_b16 a[48:49], v17
v_add_u32 v8, s75, v9
MAA 248,120,160
buffer_load_dwordx4 a[160:163], v10, s[16:19], s52 offen sc1
MAA 220,104,172
TR 50,17,512
v_add_u32 v9, s74, v9
MAA 220,108,188
TR 52,17,8448
MAA 216,108,184
TR 54,17,8960
MAA 216,104,168
TR 56,17,32
MAA 200,96,168
buffer_load_dwordx4 a[164:167], v10, s[16:19], s52 offen offset:1024 sc1
MAA 200,100,184
TR 58,17,544
s_add_u32 s52, s52, 131072
MAA 204,100,188
TR 60,17,8480
MAA 204,96,172
TR 62,17,8992
MAA 156,88,172
MAA 156,92,188
buffer_load_dwordx4 a[176:179], v10, s[16:19], s52 offen sc1
MAA 152,92,184
MAA 152,88,168
MAA 136,80,168
MAA 136,84,184
MAA 140,84,188
buffer_load_dwordx4 a[180:183], v10, s[16:19], s52 offen offset:1024 sc1
MAA 140,80,172
s_add_u32 s52, s52, 131072
MAA 92,72,172
MAA 92,76,188
MAA 88,76,184
MAA 88,72,168
MAA 72,64,168
MAA 72,68,184
MAA 76,68,188
MAA 76,64,172
s_waitcnt vmcnt(20) lgkmcnt(0)
s_barrier
MAA 32,0,128
buffer_load_dwordx4 a[168:171], v11, s[16:19], s53 offen sc1
MAA 32,4,144
ds_read_b128 v[20:23], v2
MAA 36,4,148
ds_read_b128 v[28:31], v2 offset:1024
MAA 36,0,132
s_waitcnt vmcnt(11)
ds_read_b128 v[24:27], v2 offset:2048
MAA 52,8,132
TR 64,16,16896
MAA 52,12,148
buffer_load_dwordx4 a[172:175], v11, s[16:19], s53 offen offset:1024 sc1
MAA 48,12,144
TR 66,16,17408
s_add_u32 s53, s53, 131072
MAA 48,8,128
TR 68,16,25344
MAA 96,16,128
TR 70,16,25856
MAA 96,20,144
TR 72,16,16928
MAA 100,20,148
buffer_load_dwordx4 a[184:187], v11, s[16:19], s53 offen sc1
MAA 100,16,132
TR 74,16,17440
s_waitcnt lgkmcnt(7)
v_add_f32 v20, v20, v28
MAA 116,24,132
TR 76,16,25376
v_add_f32 v21, v21, v29
MAA 116,28,148
TR 78,16,25888
v_add_f32 v22, v22, v30
MAA 112,28,144
TR 80,16,16960
v_add_f32 v23, v23, v31
MAA 112,24,128
buffer_load_dwordx4 a[188:191], v11, s[16:19], s53 offen offset:1024 sc1
MAA 160,32,128
ds_read_b128 v[28:31], v2 offset:3072
s_add_u32 s53, s53, 131072
MAA 160,36,144
TR 82,16,17472
s_add_u32 m0, s55, 84480
MAA 164,36,148
TR 84,16,25408
s_waitcnt lgkmcnt(12)
v_add_f32 v20, v20, v24
MAA 164,32,132
TR 86,16,25920
v_add_f32 v21, v21, v25
MAA 180,40,132
buffer_load_dwordx4 v12, s[32:35], s54 offen   lds
MAA 180,44,148
TR 88,16,16992
v_add_f32 v22, v22, v26
MAA 176,44,144
TR 90,16,17504
v_add_f32 v23, v23, v27
MAA 176,40,128
TR 92,16,25440
MAA 224,48,128
TR 94,16,25952
MAA 224,52,144
buffer_load_dwordx4 v13, s[32:35], s54 offen offset:1056   lds
MAA 228,52,148
TR 96,16,17024
MAA 228,48,132
TR 98,16,17536
MAA 236,56,132
TR 100,16,25472
MAA 236,60,148
TR 102,16,25984
MAA 232,60,144
buffer_load_dwordx4 v14, s[32:35], s54 offen offset:2112   lds
MAA 232,56,128
TR 104,16,17056
MAA 188,40,140
TR 106,16,17568
MAA 188,44,156
TR 108,16,25504
MAA 184,44,152
TR 110,16,26016
MAA 184,40,136
buffer_load_dwordx4 v15, s[32:35], s54 offen offset:3168   lds
MAA 168,32,136
TR 112,17,16896
s_add_u32 m0, s57, 6144
MAA 168,36,152
TR 114,17,17408
s_mov_b32 s58, 63182848
MAA 172,36,156
TR 116,17,25344
MAA 172,32,140
TR 118,17,25856
MAA 124,24,140
buffer_load_dwordx4 v4, s[16:19], s58 offen sc1 lds
MAA 124,28,156
TR 120,17,16928
MAA 120,28,152
TR 122,17,17440
MAA 120,24,136
TR 124,17,25376
MAA 104,16,136
TR 126,17,25888
MAA 104,20,152
buffer_load_dwordx4 v4, s[16:19], s58 offen offset:1024 sc1 lds
MAA 108,20,156
MAA 108,16,140
MAA 60,8,140
MAA 60,12,156
MAA 56,12,152
MAA 56,8,136
MAA 40,0,136
MAA 40,4,152
MAA 44,4,156
MAA 44,0,140
s_waitcnt lgkmcnt(0)
s_barrier
MAA 64,64,128
s_waitcnt vmcnt(14)
ds_read_b128 v[24:27], v2 offset:4096
s_add_u32 m0, s55, 101376
MAA 64,68,144
buffer_load_dwordx4 v12, s[80:83], s54 offen   lds
MAA 68,68,148
TR 0,16,33792
v_add_f32 v20, v20, v28
MAA 68,64,132
TR 2,16,34304
v_add_f32 v21, v21, v29
MAA 84,72,132
TR 4,16,42240
v_add_f32 v22, v22, v30
MAA 84,76,148
TR 6,16,42752
v_add_f32 v23, v23, v31
MAA 80,76,144
ds_read_b128 v[28:31], v2 offset:5120
MAA 80,72,128
TR 8,16,33824
MAA 128,80,128
buffer_load_dwordx4 v13, s[80:83], s54 offen offset:1056   lds
MAA 128,84,144
TR 10,16,34336
s_waitcnt lgkmcnt(7)
v_add_f32 v20, v20, v24
MAA 132,84,148
TR 12,16,42272
v_add_f32 v21, v21, v25
MAA 132,80,132
TR 14,16,42784
v_add_f32 v22, v22, v26
MAA 148,88,132
TR 16,16,33856
v_add_f32 v23, v23, v27
MAA 148,92,148
TR 18,16,34368
MAA 144,92,144
TR 20,16,42304
MAA 144,88,128
buffer_load_dwordx4 v14, s[80:83], s54 offen offset:2112   lds
MAA 192,96,128
TR 22,16,42816
MAA 192,100,144
TR 24,16,33888
MAA 196,100,148
TR 26,16,34400
MAA 196,96,132
TR 28,16,42336
MAA 212,104,132
TR 30,16,42848
MAA 212,108,148
TR 32,16,33920
MAA 208,108,144
buffer_load_dwordx4 v15, s[80:83], s54 offen offset:3168   lds
MAA 208,104,128
TR 34,16,34432
s_add_u32 s54, s54, 458752
MAA 240,112,128
TR 36,16,42368
MAA 240,116,144
TR 38,16,42880
MAA 244,116,148
TR 40,16,33952
MAA 244,112,132
TR 42,16,34464
MAA 252,120,132
TR 44,16,42400
MAA 252,124,148
TR 46,16,42912
MAA 248,124,144
TR 48,17,33792
MAA 248,120,128
buffer_load_dwordx4 a[128:131], v10, s[16:19], s52 offen sc1
MAA 220,104,140
TR 50,17,34304
MAA 220,108,156
TR 52,17,42240
MAA 216,108,152
TR 54,17,42752
MAA 216,104,136
TR 56,17,33824
MAA 200,96,136
TR 58,17,34336
MAA 200,100,152
TR 60,17,42272
MAA 204,100,156
buffer_load_dwordx4 a[132:135], v10, s[16:19], s52 offen offset:1024 sc1
MAA 204,96,140
TR 62,17,42784
s_add_u32 s52, s52, 131072
MAA 156,88,140
MAA 156,92,156
MAA 152,92,152
MAA 152,88,136
MAA 136,80,136
MAA 136,84,152
buffer_load_dwordx4 a[144:147], v10, s[16:19], s52 offen sc1
MAA 140,84,156
MAA 140,80,140
MAA 92,72,140
MAA 92,76,156
MAA 88,76,152
MAA 88,72,136
MAA 72,64,136
buffer_load_dwordx4 a[148:151], v10, s[16:19], s52 offen offset:1024 sc1
MAA 72,68,152
s_add_u32 s52, s52, 131072
MAA 76,68,156
MAA 76,64,140
s_waitcnt vmcnt(18) lgkmcnt(0)
s_barrier
MAA 32,0,160
buffer_load_dwordx4 a[136:139], v11, s[16:19], s53 offen sc1
MAA 32,4,176
s_waitcnt vmcnt(9)
ds_read_b128 v[24:27], v2 offset:6144
v_add_f32 v20, v20, v28
MAA 36,4,180
TR 64,16,50688
v_add_f32 v21, v21, v29
MAA 36,0,164
TR 66,16,51200
v_add_f32 v22, v22, v30
MAA 52,8,164
TR 68,16,59136
v_add_f32 v23, v23, v31
MAA 52,12,180
ds_read_b128 v[28:31], v2 offset:7168
MAA 48,12,176
TR 70,16,59648
MAA 48,8,160
buffer_load_dwordx4 a[140:143], v11, s[16:19], s53 offen offset:1024 sc1
MAA 96,16,160
TR 72,16,50720
s_add_u32 s53, s53, 131072
MAA 96,20,176
TR 74,16,51232
s_waitcnt lgkmcnt(7)
v_add_f32 v20, v20, v24
MAA 100,20,180
TR 76,16,59168
v_add_f32 v21, v21, v25
MAA 100,16,164
TR 78,16,59680
v_add_f32 v22, v22, v26
MAA 116,24,164
TR 80,16,50752
v_add_f32 v23, v23, v27
MAA 116,28,180
TR 82,16,51264
s_waitcnt lgkmcnt(7)
v_add_f32 v20, v20, v28
MAA 112,28,176
buffer_load_dwordx4 a[152:155], v11, s[16:19], s53 offen sc1
MAA 112,24,160
TR 84,16,59200
v_add_f32 v21, v21, v29
MAA 160,32,160
TR 86,16,59712
v_add_f32 v22, v22, v30
MAA 160,36,176
TR 88,16,50784
v_add_f32 v23, v23, v31
MAA 164,36,180
TR 90,16,51296
MAA 164,32,164
TR 92,16,59232
MAA 180,40,164
TR 94,16,59744
MAA 180,44,180
buffer_load_dwordx4 a[156:159], v11, s[16:19], s53 offen offset:1024 sc1
MAA 176,44,176
TR 96,16,50816
s_add_u32 s53, s53, 131072
MAA 176,40,160
TR 98,16,51328
s_add_u32 m0, s55, 118272
MAA 224,48,160
TR 100,16,59264
MAA 224,52,176
TR 102,16,59776
MAA 228,52,180
TR 104,16,50848
MAA 228,48,164
TR 106,16,51360
MAA 236,56,164
buffer_load_dwordx4 v12, s[32:35], s54 offen   lds
MAA 236,60,180
TR 108,16,59296
MAA 232,60,176
TR 110,16,59808
MAA 232,56,160
TR 112,17,50688
MAA 188,40,172
TR 114,17,51200
MAA 188,44,188
TR 116,17,59136
MAA 184,44,184
TR 118,17,59648
MAA 184,40,168
buffer_load_dwordx4 v13, s[32:35], s54 offen offset:1056   lds
MAA 168,32,168
TR 120,17,50720
MAA 168,36,184
TR 122,17,51232
MAA 172,36,188
TR 124,17,59168
MAA 172,32,172
TR 126,17,59680
MAA 124,24,172
MAA 124,28,188
MAA 120,28,184
buffer_load_dwordx4 v14, s[32:35], s54 offen offset:2112   lds
MAA 120,24,168
MAA 104,16,168
MAA 104,20,184
MAA 108,20,188
MAA 108,16,172
MAA 60,8,172
MAA 60,12,188
buffer_load_dwordx4 v15, s[32:35], s54 offen offset:3168   lds
MAA 56,12,184
MAA 56,8,168
MAA 40,0,168
MAA 40,4,184
MAA 44,4,188
MAA 44,0,172
s_waitcnt lgkmcnt(0)
s_barrier
MAA 64,64,160
ds_read_b64_tr_b16 a[0:1], v16
s_add_u32 m0, s55, 135168
MAA 64,68,176
buffer_load_dwordx4 v12, s[80:83], s54 offen   lds
MAA 68,68,180
TR 2,16,512
v_permlane32_swap_b32 v20, v22
MAA 68,64,164
TR 4,16,8448
v_permlane32_swap_b32 v21, v23
MAA 84,72,164
TR 6,16,8960
v_add_f32 v20, v20, v22
MAA 84,76,180
TR 8,16,32
v_add_f32 v21, v21, v23
MAA 80,76,176
TR 10,16,544
v_mul_f32 v20, 0xba800000, v20
MAA 80,72,160
buffer_load_dwordx4 v13, s[80:83], s54 offen offset:1056   lds
MAA 128,80,160
TR 12,16,8480
v_mul_f32 v21, 0x3a800000, v21
MAA 128,84,176
TR 14,16,8992
v_fma_f32 v21, -v20, v20, v21
MAA 132,84,180
TR 16,16,64
v_max_f32 v21, 0, v21
MAA 132,80,164
TR 18,16,576
v_add_f32 v21, 0x3727c5ac, v21
MAA 148,88,164
TR 20,16,8512
v_rsq_f32 v22, v21
MAA 148,92,180
buffer_load_dwordx4 v14, s[80:83], s54 offen offset:2112   lds
MAA 144,92,176
TR 22,16,9024
v_and_b32 v24, 31, v1
MAA 144,88,160
TR 24,16,96
v_lshrrev_b32 v25, 5, v1
MAA 192,96,160
TR 26,16,608
v_lshl_add_u32 v24, v24, 1, v25
MAA 192,100,176
TR 28,16,8544
v_and_b32 v25, 0xc0, v0
MAA 196,100,180
TR 30,16,9056
v_add_u32 v24, v24, v25
MAA 196,96,164
TR 32,16,128
v_lshlrev_b32 v24, 4, v24
MAA 212,104,164
buffer_load_dwordx4 v15, s[80:83], s54 offen offset:3168   lds
MAA 212,108,180
TR 34,16,640
s_add_u32 s54, s54, 458752
MAA 208,108,176
TR 36,16,8576
v_add_u32 v24, 152576, v24
MAA 208,104,160
TR 38,16,9088
v_mul_f32 v22, 0xbfb8aa3b, v22
MAA 240,112,160
ds_write_b128 v24, v[20:23]
s_mov_b32 s58, s98
MAA 240,116,176
.Lpad24:
s_cbranch_execz .Lnopoll60r
ds_read_b64 v[20:21], v18
s_mov_b32 s67, s59
MAA 244,116,180
ds_read_b64 v[22:23], v18 offset:256
MAA 244,112,164
ds_read_b64 v[24:25], v19
MAA 252,120,164
ds_read_b64 v[26:27], v19 offset:256
MAA 252,124,180
ds_read_b32 a192, v18 offset:8
MAA 248,124,176
ds_read_b32 a193, v18 offset:264
v_mov_b32 v18, v5
MAA 248,120,160
buffer_load_dwordx4 a[160:163], v10, s[16:19], s52 offen sc1
MAA 220,104,172
ds_read_b32 a194, v19 offset:8
MAA 220,108,188
ds_read_b32 a195, v19 offset:264
v_add_u32 v19, 992, v5
MAA 216,108,184
TR 40,16,160
MAA 216,104,168
TR 42,16,672
MAA 200,96,168
TR 44,16,8608
MAA 200,100,184
TR 46,16,9120
MAA 204,100,188
buffer_load_dwordx4 a[164:167], v10, s[16:19], s52 offen offset:1024 sc1
MAA 204,96,172
ds_read_b64_tr_b16 a[48:49], v17
s_add_u32 s52, s52, 131072
MAA 156,88,172
TR 50,17,512
MAA 156,92,188
TR 52,17,8448
MAA 152,92,184
TR 54,17,8960
MAA 152,88,168
TR 56,17,32
MAA 136,80,168
TR 58,17,544
MAA 136,84,184
buffer_load_dwordx4 a[176:179], v10, s[16:19], s52 offen sc1
MAA 140,84,188
TR 60,17,8480
MAA 140,80,172
TR 62,17,8992
MAA 92,72,172
MAA 92,76,188
MAA 88,76,184
MAA 88,72,168
MAA 72,64,168
buffer_load_dwordx4 a[180:183], v10, s[16:19], s52 offen offset:1024 sc1
MAA 72,68,184
s_add_u32 s52, s52, 131072
MAA 76,68,188
MAA 76,64,172
s_waitcnt vmcnt(16) lgkmcnt(0)
s_barrier
MAA 32,0,128
ds_read_b128 v[28:31], v9 offset:512
MAA 32,4,144
ds_read_b128 v[4:7], v9 offset:576
MAA 36,4,148
buffer_load_dwordx4 a[168:171], v11, s[16:19], s53 offen sc1
MAA 36,0,132
TR 64,16,16896
MAA 52,8,132
TR 66,16,17408
MAA 52,12,148
TR 68,16,25344
MAA 48,12,144
TR 70,16,25856
MAA 48,8,128
TR 72,16,16928
MAA 96,16,128
buffer_load_dwordx4 a[172:175], v11, s[16:19], s53 offen offset:1024 sc1
MAA 96,20,144
TR 74,16,17440
s_add_u32 s53, s53, 131072
MAA 100,20,148
TR 76,16,25376
s_waitcnt lgkmcnt(8)
v_fmac_f32 v64, v28, v20
MAA 100,16,132
TR 78,16,25888
v_fmac_f32 v65, v29, v20
MAA 116,24,132
TR 80,16,16960
v_fmac_f32 v66, v30, v20
MAA 116,28,148
TR 82,16,17472
v_fmac_f32 v67, v31, v20
MAA 112,28,144
buffer_load_dwordx4 a[184:187], v11, s[16:19], s53 offen sc1
MAA 112,24,128
TR 84,16,25408
v_fmac_f32 v68, v28, v22
MAA 160,32,128
TR 86,16,25920
v_fmac_f32 v69, v29, v22
MAA 160,36,144
TR 88,16,16992
v_fmac_f32 v70, v30, v22
MAA 164,36,148
TR 90,16,17504
v_fmac_f32 v71, v31, v22
MAA 164,32,132
TR 92,16,25440
v_fmac_f32 v72, v28, v24
MAA 180,40,132
buffer_load_dwordx4 a[188:191], v11, s[16:19], s53 offen offset:1024 sc1
MAA 180,44,148
TR 94,16,25952
s_add_u32 s53, s53, 131072
MAA 176,44,144
TR 96,16,17024
s_add_u32 m0, s55, 84480
MAA 176,40,128
TR 98,16,17536
v_fmac_f32 v73, v29, v24
MAA 224,48,128
TR 100,16,25472
v_fmac_f32 v74, v30, v24
MAA 224,52,144
TR 102,16,25984
v_fmac_f32 v75, v31, v24
MAA 228,52,148
buffer_load_dwordx4 v12, s[32:35], s54 offen   lds
MAA 228,48,132
TR 104,16,17056
v_fmac_f32 v76, v28, v26
MAA 236,56,132
TR 106,16,17568
v_fmac_f32 v77, v29, v26
MAA 236,60,148
TR 108,16,25504
v_fmac_f32 v78, v30, v26
MAA 232,60,144
TR 110,16,26016
v_fmac_f32 v79, v31, v26
MAA 232,56,128
ds_read_b128 v[28:31], v9 offset:640
s_waitcnt lgkmcnt(15)
v_fmac_f32 v80, v4, v20
s_waitcnt vmcnt(17)
MAA 188,40,140
buffer_load_dwordx4 v13, s[32:35], s54 offen offset:1056   lds
MAA 188,44,156
TR 112,17,16896
v_fmac_f32 v81, v5, v20
MAA 184,44,152
TR 114,17,17408
v_fmac_f32 v82, v6, v20
MAA 184,40,136
TR 116,17,25344
v_fmac_f32 v83, v7, v20
MAA 168,32,136
TR 118,17,25856
v_fmac_f32 v84, v4, v22
MAA 168,36,152
TR 120,17,16928
v_fmac_f32 v85, v5, v22
MAA 172,36,156
buffer_load_dwordx4 v14, s[32:35], s54 offen offset:2112   lds
MAA 172,32,140
TR 122,17,17440
v_fmac_f32 v86, v6, v22
MAA 124,24,140
TR 124,17,25376
v_fmac_f32 v87, v7, v22
MAA 124,28,156
TR 126,17,25888
v_fmac_f32 v88, v4, v24
MAA 120,28,152
v_fmac_f32 v89, v5, v24
v_fmac_f32 v90, v6, v24
MAA 120,24,136
v_fmac_f32 v91, v7, v24
v_fmac_f32 v92, v4, v26
MAA 104,16,136
buffer_load_dwordx4 v15, s[32:35], s54 offen offset:3168   lds
MAA 104,20,152
s_mov_b32 m0, s67
v_fmac_f32 v93, v5, v26
v_fmac_f32 v94, v6, v26
MAA 108,20,156
v_fmac_f32 v95, v7, v26
s_waitcnt lgkmcnt(8)
v_fmac_f32 v128, v28, v20
MAA 108,16,140
ds_read_b128 v[4:7], v8 offset:512
v_fmac_f32 v129, v29, v20
MAA 60,8,140
v_fmac_f32 v130, v30, v20
v_fmac_f32 v131, v31, v20
MAA 60,12,156
v_fmac_f32 v132, v28, v22
v_fmac_f32 v133, v29, v22
MAA 56,12,152
buffer_load_dwordx4 v18, s[28:31], s58 offen lds
MAA 56,8,136
v_fmac_f32 v134, v30, v22
v_fmac_f32 v135, v31, v22
MAA 40,0,136
v_fmac_f32 v136, v28, v24
v_fmac_f32 v137, v29, v24
MAA 40,4,152
v_fmac_f32 v138, v30, v24
v_fmac_f32 v139, v31, v24
MAA 44,4,156
v_fmac_f32 v140, v28, v26
v_fmac_f32 v141, v29, v26
MAA 44,0,140
v_fmac_f32 v142, v30, v26
v_fmac_f32 v143, v31, v26
s_waitcnt lgkmcnt(0)
v_fmac_f32 v240, v4, v20
v_fmac_f32 v241, v5, v20
v_fmac_f32 v242, v6, v20
v_fmac_f32 v243, v7, v20
v_fmac_f32 v244, v4, v22
v_fmac_f32 v245, v5, v22
v_fmac_f32 v246, v6, v22
v_fmac_f32 v247, v7, v22
s_waitcnt vmcnt(17) lgkmcnt(0)
s_barrier
MAA 64,64,128
ds_read_b128 v[28:31], v9
s_add_u32 m0, s55, 101376
MAA 64,68,144
ds_read_b128 v[4:7], v9 offset:64
MAA 68,68,148
buffer_load_dwordx4 v12, s[80:83], s54 offen   lds
MAA 68,64,132
TR 0,16,33792
MAA 84,72,132
TR 2,16,34304
MAA 84,76,148
TR 4,16,42240
MAA 80,76,144
TR 6,16,42752
MAA 80,72,128
TR 8,16,33824
MAA 128,80,128
buffer_load_dwordx4 v13, s[80:83], s54 offen offset:1056   lds
MAA 128,84,144
TR 10,16,34336
s_waitcnt lgkmcnt(7)
v_fmac_f32 v32, v28, v20
MAA 132,84,148
TR 12,16,42272
v_fmac_f32 v33, v29, v20
MAA 132,80,132
TR 14,16,42784
v_fmac_f32 v34, v30, v20
MAA 148,88,132
TR 16,16,33856
v_fmac_f32 v35, v31, v20
MAA 148,92,148
TR 18,16,34368
v_fmac_f32 v36, v28, v22
MAA 144,92,144
buffer_load_dwordx4 v14, s[80:83], s54 offen offset:2112   lds
MAA 144,88,128
TR 20,16,42304
v_fmac_f32 v37, v29, v22
MAA 192,96,128
TR 22,16,42816
v_fmac_f32 v38, v30, v22
MAA 192,100,144
TR 24,16,33888
v_fmac_f32 v39, v31, v22
MAA 196,100,148
TR 26,16,34400
v_fmac_f32 v40, v28, v24
MAA 196,96,132
TR 28,16,42336
v_fmac_f32 v41, v29, v24
MAA 212,104,132
buffer_load_dwordx4 v15, s[80:83], s54 offen offset:3168   lds
MAA 212,108,148
TR 30,16,42848
s_add_u32 s54, s54, 458752
MAA 208,108,144
TR 32,16,33920
s_mov_b32 m0, s67
MAA 208,104,128
TR 34,16,34432
v_fmac_f32 v42, v30, v24
MAA 240,112,128
TR 36,16,42368
v_fmac_f32 v43, v31, v24
MAA 240,116,144
TR 38,16,42880
v_fmac_f32 v44, v28, v26
MAA 244,116,148
buffer_load_dwordx4 v19, s[28:31], s58 offen offset:1056 lds
MAA 244,112,132
TR 40,16,33952
s_add_u32 s67, s67, 8448
MAA 252,120,132
TR 42,16,34464
s_add_u32 s58, s58, 0x40000
MAA 252,124,148
TR 44,16,42400
v_fmac_f32 v45, v29, v26
MAA 248,124,144
TR 46,16,42912
v_fmac_f32 v46, v30, v26
MAA 248,120,128
TR 48,17,33792
v_fmac_f32 v47, v31, v26
MAA 220,104,140
ds_read_b128 v[28:31], v9 offset:128
s_waitcnt lgkmcnt(15)
v_fmac_f32 v48, v4, v20
MAA 220,108,156
buffer_load_dwordx4 a[128:131], v10, s[16:19], s52 offen sc1
MAA 216,108,152
TR 50,17,34304
v_fmac_f32 v49, v5, v20
MAA 216,104,136
TR 52,17,42240
v_fmac_f32 v50, v6, v20
MAA 200,96,136
TR 54,17,42752
v_fmac_f32 v51, v7, v20
MAA 200,100,152
TR 56,17,33824
v_fmac_f32 v52, v4, v22
MAA 204,100,156
TR 58,17,34336
v_fmac_f32 v53, v5, v22
MAA 204,96,140
buffer_load_dwordx4 a[132:135], v10, s[16:19], s52 offen offset:1024 sc1
MAA 156,88,140
TR 60,17,42272
s_add_u32 s52, s52, 131072
MAA 156,92,156
TR 62,17,42784
v_fmac_f32 v54, v6, v22
MAA 152,92,152
v_fmac_f32 v55, v7, v22
v_fmac_f32 v56, v4, v24
MAA 152,88,136
v_fmac_f32 v57, v5, v24
v_fmac_f32 v58, v6, v24
MAA 136,80,136
v_fmac_f32 v59, v7, v24
v_fmac_f32 v60, v4, v26
MAA 136,84,152
buffer_load_dwordx4 a[144:147], v10, s[16:19], s52 offen sc1
MAA 140,84,156
v_fmac_f32 v61, v5, v26
v_fmac_f32 v62, v6, v26
MAA 140,80,140
v_fmac_f32 v63, v7, v26
s_waitcnt lgkmcnt(7)
v_fmac_f32 v96, v28, v20
MAA 92,72,140
ds_read_b128 v[4:7], v8
v_fmac_f32 v97, v29, v20
MAA 92,76,156
v_fmac_f32 v98, v30, v20
v_fmac_f32 v99, v31, v20
MAA 88,76,152
v_fmac_f32 v100, v28, v22
v_fmac_f32 v101, v29, v22
MAA 88,72,136
buffer_load_dwordx4 a[148:151], v10, s[16:19], s52 offen offset:1024 sc1
MAA 72,64,136
s_add_u32 s52, s52, 131072
v_fmac_f32 v102, v30, v22
v_fmac_f32 v103, v31, v22
MAA 72,68,152
v_fmac_f32 v104, v28, v24
v_fmac_f32 v105, v29, v24
MAA 76,68,156
v_fmac_f32 v106, v30, v24
v_fmac_f32 v107, v31, v24
MAA 76,64,140
v_fmac_f32 v108, v28, v26
v_fmac_f32 v109, v29, v26
v_fmac_f32 v110, v30, v26
v_fmac_f32 v111, v31, v26
s_waitcnt lgkmcnt(0)
v_fmac_f32 v224, v4, v20
v_fmac_f32 v225, v5, v20
v_fmac_f32 v226, v6, v20
v_fmac_f32 v227, v7, v20
v_fmac_f32 v228, v4, v22
v_fmac_f32 v229, v5, v22
v_fmac_f32 v230, v6, v22
v_fmac_f32 v231, v7, v22
s_waitcnt vmcnt(18) lgkmcnt(0)
s_barrier
MAA 32,0,160
ds_read_b128 v[28:31], v9 offset:704
MAA 32,4,176
ds_read_b128 v[4:7], v9 offset:768
MAA 36,4,180
buffer_load_dwordx4 a[136:139], v11, s[16:19], s53 offen sc1
MAA 36,0,164
TR 64,16,50688
MAA 52,8,164
TR 66,16,51200
MAA 52,12,180
TR 68,16,59136
MAA 48,12,176
TR 70,16,59648
MAA 48,8,160
TR 72,16,50720
MAA 96,16,160
buffer_load_dwordx4 a[140:143], v11, s[16:19], s53 offen offset:1024 sc1
MAA 96,20,176
TR 74,16,51232
s_add_u32 s53, s53, 131072
MAA 100,20,180
TR 76,16,59168
s_waitcnt lgkmcnt(8)
v_fmac_f32 v144, v28, v20
MAA 100,16,164
TR 78,16,59680
v_fmac_f32 v145, v29, v20
MAA 116,24,164
TR 80,16,50752
v_fmac_f32 v146, v30, v20
MAA 116,28,180
TR 82,16,51264
v_fmac_f32 v147, v31, v20
MAA 112,28,176
buffer_load_dwordx4 a[152:155], v11, s[16:19], s53 offen sc1
MAA 112,24,160
TR 84,16,59200
v_fmac_f32 v148, v28, v22
MAA 160,32,160
TR 86,16,59712
v_fmac_f32 v149, v29, v22
MAA 160,36,176
TR 88,16,50784
v_fmac_f32 v150, v30, v22
MAA 164,36,180
TR 90,16,51296
v_fmac_f32 v151, v31, v22
MAA 164,32,164
TR 92,16,59232
v_fmac_f32 v152, v28, v24
MAA 180,40,164
buffer_load_dwordx4 a[156:159], v11, s[16:19], s53 offen offset:1024 sc1
MAA 180,44,180
TR 94,16,59744
s_add_u32 s53, s53, 131072
MAA 176,44,176
TR 96,16,50816
s_add_u32 m0, s55, 118272
MAA 176,40,160
TR 98,16,51328
v_fmac_f32 v153, v29, v24
MAA 224,48,160
TR 100,16,59264
v_fmac_f32 v154, v30, v24
MAA 224,52,176
TR 102,16,59776
v_fmac_f32 v155, v31, v24
MAA 228,52,180
buffer_load_dwordx4 v12, s[32:35], s54 offen   lds
MAA 228,48,164
TR 104,16,50848
v_fmac_f32 v156, v28, v26
MAA 236,56,164
TR 106,16,51360
v_fmac_f32 v157, v29, v26
MAA 236,60,180
TR 108,16,59296
v_fmac_f32 v158, v30, v26
MAA 232,60,176
TR 110,16,59808
v_fmac_f32 v159, v31, v26
MAA 232,56,160
ds_read_b128 v[28:31], v9 offset:832
s_waitcnt lgkmcnt(15)
v_fmac_f32 v192, v4, v20
s_waitcnt vmcnt(19)
MAA 188,40,172
buffer_load_dwordx4 v13, s[32:35], s54 offen offset:1056   lds
MAA 188,44,188
TR 112,17,50688
v_fmac_f32 v193, v5, v20
MAA 184,44,184
TR 114,17,51200
v_fmac_f32 v194, v6, v20
MAA 184,40,168
TR 116,17,59136
v_fmac_f32 v195, v7, v20
MAA 168,32,168
TR 118,17,59648
v_fmac_f32 v196, v4, v22
MAA 168,36,184
TR 120,17,50720
v_fmac_f32 v197, v5, v22
MAA 172,36,188
buffer_load_dwordx4 v14, s[32:35], s54 offen offset:2112   lds
MAA 172,32,172
TR 122,17,51232
v_fmac_f32 v198, v6, v22
MAA 124,24,172
TR 124,17,59168
v_fmac_f32 v199, v7, v22
MAA 124,28,188
TR 126,17,59680
v_fmac_f32 v200, v4, v24
MAA 120,28,184
v_fmac_f32 v201, v5, v24
v_fmac_f32 v202, v6, v24
MAA 120,24,168
v_fmac_f32 v203, v7, v24
v_fmac_f32 v204, v4, v26
MAA 104,16,168
buffer_load_dwordx4 v15, s[32:35], s54 offen offset:3168   lds
MAA 104,20,184
s_mov_b32 m0, s67
v_fmac_f32 v205, v5, v26
v_fmac_f32 v206, v6, v26
MAA 108,20,188
v_fmac_f32 v207, v7, v26
s_waitcnt lgkmcnt(8)
v_fmac_f32 v208, v28, v20
MAA 108,16,172
ds_read_b128 v[4:7], v8 offset:576
v_fmac_f32 v209, v29, v20
MAA 60,8,172
v_fmac_f32 v210, v30, v20
v_fmac_f32 v211, v31, v20
MAA 60,12,188
v_fmac_f32 v212, v28, v22
v_fmac_f32 v213, v29, v22
MAA 56,12,184
buffer_load_dwordx4 v18, s[28:31], s58 offen lds
MAA 56,8,168
v_fmac_f32 v214, v30, v22
v_fmac_f32 v215, v31, v22
MAA 40,0,168
v_fmac_f32 v216, v28, v24
v_fmac_f32 v217, v29, v24
MAA 40,4,184
v_fmac_f32 v218, v30, v24
v_fmac_f32 v219, v31, v24
MAA 44,4,188
v_fmac_f32 v220, v28, v26
v_fmac_f32 v221, v29, v26
MAA 44,0,172
v_fmac_f32 v222, v30, v26
v_fmac_f32 v223, v31, v26
s_waitcnt lgkmcnt(0)
v_fmac_f32 v248, v4, v20
v_fmac_f32 v249, v5, v20
v_fmac_f32 v250, v6, v20
v_fmac_f32 v251, v7, v20
v_fmac_f32 v252, v4, v22
v_fmac_f32 v253, v5, v22
v_fmac_f32 v254, v6, v22
v_fmac_f32 v255, v7, v22
s_waitcnt vmcnt(19) lgkmcnt(0)
s_barrier
MAA 64,64,160
ds_read_b128 v[28:31], v9 offset:192
s_add_u32 m0, s55, 135168
MAA 64,68,176
ds_read_b128 v[4:7], v9 offset:256
MAA 68,68,180
buffer_load_dwordx4 v12, s[80:83], s54 offen   lds
MAA 68,64,164
ds_read_b64_tr_b16 a[0:1], v16
MAA 84,72,164
TR 2,16,512
MAA 84,76,180
TR 4,16,8448
MAA 80,76,176
TR 6,16,8960
MAA 80,72,160
TR 8,16,32
MAA 128,80,160
buffer_load_dwordx4 v13, s[80:83], s54 offen offset:1056   lds
MAA 128,84,176
TR 10,16,544
s_waitcnt lgkmcnt(7)
v_fmac_f32 v112, v28, v20
MAA 132,84,180
TR 12,16,8480
v_fmac_f32 v113, v29, v20
MAA 132,80,164
TR 14,16,8992
v_fmac_f32 v114, v30, v20
MAA 148,88,164
TR 16,16,64
v_fmac_f32 v115, v31, v20
MAA 148,92,180
TR 18,16,576
v_fmac_f32 v116, v28, v22
MAA 144,92,176
buffer_load_dwordx4 v14, s[80:83], s54 offen offset:2112   lds
MAA 144,88,160
TR 20,16,8512
v_fmac_f32 v117, v29, v22
MAA 192,96,160
TR 22,16,9024
v_fmac_f32 v118, v30, v22
MAA 192,100,176
TR 24,16,96
v_fmac_f32 v119, v31, v22
.Lpad25:
s_cbranch_execz .Lnopoll60r
MAA 196,100,180
TR 26,16,608
v_fmac_f32 v120, v28, v24
MAA 196,96,164
TR 28,16,8544
v_fmac_f32 v121, v29, v24
MAA 212,104,164
buffer_load_dwordx4 v15, s[80:83], s54 offen offset:3168   lds
MAA 212,108,180
TR 30,16,9056
s_add_u32 s54, s54, 458752
MAA 208,108,176
TR 32,16,128
s_mov_b32 m0, s67
MAA 208,104,160
TR 34,16,640
v_fmac_f32 v122, v30, v24
MAA 240,112,160
TR 36,16,8576
v_fmac_f32 v123, v31, v24
MAA 240,116,176
TR 38,16,9088
v_fmac_f32 v124, v28, v26
MAA 244,116,180
buffer_load_dwordx4 v19, s[28:31], s58 offen offset:1056 lds
MAA 244,112,164
TR 40,16,160
s_add_u32 s67, s67, 8448
MAA 252,120,164
TR 42,16,672
s_add_u32 s46, s46, 1
MAA 252,124,180
TR 44,16,8608
s_xor_b32 s58, s46, s87
MAA 248,124,176
TR 46,16,9120
s_mul_i32 s58, s58, 458752
MAA 248,120,160
ds_read_b64_tr_b16 a[48:49], v17
v_fmac_f32 v125, v29, v26
MAA 220,104,172
buffer_load_dwordx4 a[160:163], v10, s[16:19], s52 offen sc1
MAA 220,108,188
TR 50,17,512
v_fmac_f32 v126, v30, v26
MAA 216,108,184
TR 52,17,8448
v_fmac_f32 v127, v31, v26
MAA 216,104,168
ds_read_b128 v[28:31], v9 offset:320
s_waitcnt lgkmcnt(15)
v_fmac_f32 v160, v4, v20
MAA 200,96,168
TR 54,17,8960
v_fmac_f32 v161, v5, v20
MAA 200,100,184
TR 56,17,32
v_fmac_f32 v162, v6, v20
MAA 204,100,188
buffer_load_dwordx4 a[164:167], v10, s[16:19], s52 offen offset:1024 sc1
MAA 204,96,172
TR 58,17,544
s_add_u32 s52, s52, 131072
MAA 156,88,172
TR 60,17,8480
v_fmac_f32 v163, v7, v20
MAA 156,92,188
TR 62,17,8992
v_fmac_f32 v164, v4, v22
MAA 152,92,184
v_fmac_f32 v165, v5, v22
v_fmac_f32 v166, v6, v22
MAA 152,88,168
v_fmac_f32 v167, v7, v22
v_fmac_f32 v168, v4, v24
MAA 136,80,168
buffer_load_dwordx4 a[176:179], v10, s[16:19], s52 offen sc1
MAA 136,84,184
v_fmac_f32 v169, v5, v24
v_fmac_f32 v170, v6, v24
MAA 140,84,188
v_fmac_f32 v171, v7, v24
v_fmac_f32 v172, v4, v26
MAA 140,80,172
v_fmac_f32 v173, v5, v26
v_fmac_f32 v174, v6, v26
MAA 92,72,172
v_fmac_f32 v175, v7, v26
s_waitcnt lgkmcnt(5)
v_fmac_f32 v176, v28, v20
MAA 92,76,188
ds_read_b128 v[4:7], v8 offset:64
v_fmac_f32 v177, v29, v20
MAA 88,76,184
buffer_load_dwordx4 a[180:183], v10, s[16:19], s52 offen offset:1024 sc1
MAA 88,72,168
s_add_u32 s52, s52, 131072
v_fmac_f32 v178, v30, v20
v_fmac_f32 v179, v31, v20
MAA 72,64,168
v_fmac_f32 v180, v28, v22
v_fmac_f32 v181, v29, v22
MAA 72,68,184
v_fmac_f32 v182, v30, v22
v_fmac_f32 v183, v31, v22
MAA 76,68,188
v_fmac_f32 v184, v28, v24
v_fmac_f32 v185, v29, v24
MAA 76,64,172
v_fmac_f32 v186, v30, v24
v_fmac_f32 v187, v31, v24
v_fmac_f32 v188, v28, v26
v_fmac_f32 v189, v29, v26
v_fmac_f32 v190, v30, v26
v_fmac_f32 v191, v31, v26
v_accvgpr_read_b32 v28, a192
s_waitcnt lgkmcnt(0)
v_fmac_f32 v232, v4, v20
v_fmac_f32 v233, v5, v20
v_fmac_f32 v234, v6, v20
v_fmac_f32 v235, v7, v20
v_fmac_f32 v236, v4, v22
v_fmac_f32 v237, v5, v22
v_fmac_f32 v238, v6, v22
v_fmac_f32 v239, v7, v22
v_accvgpr_read_b32 v29, a193
v_accvgpr_read_b32 v30, a194
v_accvgpr_read_b32 v31, a195
s_mov_b32 s15, -4
.p2align 6
.Lk65:
s_waitcnt vmcnt(18) lgkmcnt(0)
s_barrier
MAA 32,0,128
TR 64,16,16896
MAA 32,4,144
buffer_load_dwordx4 a[168:171], v11, s[16:19], s53 offen sc1
MAA 36,4,148
TR 66,16,17408
MAA 36,0,132
TR 68,16,25344
MAA 52,8,132
TR 70,16,25856
MAA 52,12,148
MAA 48,12,144
TR 72,16,16928
MAA 48,8,128
buffer_load_dwordx4 a[172:175], v11, s[16:19], s53 offen offset:1024 sc1
MAA 96,16,128
TR 74,16,17440
s_add_u32 s53, s53, 131072
MAA 96,20,144
TR 76,16,25376
MAA 100,20,148
MAA 100,16,132
TR 78,16,25888
MAA 116,24,132
TR 80,16,16960
MAA 116,28,148
buffer_load_dwordx4 a[184:187], v11, s[16:19], s53 offen sc1
MAA 112,28,144
TR 82,16,17472
MAA 112,24,128
MAA 160,32,128
TR 84,16,25408
MAA 160,36,144
TR 86,16,25920
MAA 164,36,148
TR 88,16,16992
MAA 164,32,132
buffer_load_dwordx4 a[188:191], v11, s[16:19], s53 offen offset:1024 sc1
MAA 180,40,132
s_add_u32 s53, s53, 131072
MAA 180,44,148
TR 90,16,17504
MAA 176,44,144
TR 92,16,25440
MAA 176,40,128
TR 94,16,25952
MAA 224,48,128
s_add_u32 m0, s55, 84480
MAA 224,52,144
buffer_load_dwordx4 v12, s[32:35], s54 offen   lds
MAA 228,52,148
TR 96,16,17024
MAA 228,48,132
TR 98,16,17536
MAA 236,56,132
TR 100,16,25472
MAA 236,60,148
TR 102,16,25984
MAA 232,60,144
MAA 232,56,128
TR 104,16,17056
s_waitcnt vmcnt(19)
MAA 188,40,140
TR 106,16,17568
MAA 188,44,156
buffer_load_dwordx4 v13, s[32:35], s54 offen offset:1056   lds
MAA 184,44,152
TR 108,16,25504
MAA 184,40,136
MAA 168,32,136
TR 110,16,26016
MAA 168,36,152
buffer_load_dwordx4 v14, s[32:35], s54 offen offset:2112   lds
MAA 172,36,156
TR 112,17,16896
MAA 172,32,140
TR 114,17,17408
MAA 124,24,140
MAA 124,28,156
TR 116,17,25344
MAA 120,28,152
TR 118,17,25856
MAA 120,24,136
buffer_load_dwordx4 v15, s[32:35], s54 offen offset:3168   lds
MAA 104,16,136
TR 120,17,16928
MAA 104,20,152
MAA 108,20,156
TR 122,17,17440
MAA 108,16,140
TR 124,17,25376
MAA 60,8,140
TR 126,17,25888
s_mov_b32 m0, s67
MAA 60,12,156
buffer_load_dwordx4 v18, s[28:31], s58 offen lds
MAA 56,12,152
MAA 56,8,136
MAA 40,0,136
MAA 40,4,152
MAA 44,4,156
MAA 44,0,140
s_waitcnt vmcnt(19) lgkmcnt(0)
s_barrier
MAA 64,64,128
TR 0,16,33792
s_add_u32 m0, s55, 101376
MAA 64,68,144
buffer_load_dwordx4 v12, s[80:83], s54 offen   lds
MAA 68,68,148
TR 2,16,34304
MAA 68,64,132
TR 4,16,42240
MAA 84,72,132
TR 6,16,42752
MAA 84,76,148
MAA 80,76,144
TR 8,16,33824
MAA 80,72,128
buffer_load_dwordx4 v13, s[80:83], s54 offen offset:1056   lds
MAA 128,80,128
TR 10,16,34336
MAA 128,84,144
TR 12,16,42272
MAA 132,84,148
TR 14,16,42784
MAA 132,80,132
MAA 148,88,132
TR 16,16,33856
MAA 148,92,148
buffer_load_dwordx4 v14, s[80:83], s54 offen offset:2112   lds
MAA 144,92,144
TR 18,16,34368
MAA 144,88,128
TR 20,16,42304
MAA 192,96,128
MAA 192,100,144
TR 22,16,42816
MAA 196,100,148
TR 24,16,33888
MAA 196,96,132
buffer_load_dwordx4 v15, s[80:83], s54 offen offset:3168   lds
MAA 212,104,132
TR 26,16,34400
s_add_u32 s54, s54, 458752
MAA 212,108,148
TR 28,16,42336
MAA 208,108,144
MAA 208,104,128
TR 30,16,42848
MAA 240,112,128
TR 32,16,33920
s_mov_b32 m0, s67
MAA 240,116,144
buffer_load_dwordx4 v19, s[28:31], s58 offen offset:1056 lds
MAA 244,116,148
s_add_u32 s67, s67, 8448
s_add_u32 s58, s58, 0x40000
MAA 244,112,132
TR 34,16,34432
MAA 252,120,132
MAA 252,124,148
TR 36,16,42368
MAA 248,124,144
TR 38,16,42880
MAA 248,120,128
buffer_load_dwordx4 a[128:131], v10, s[16:19], s52 offen sc1
MAA 220,104,140
TR 40,16,33952
MAA 220,108,156
TR 42,16,34464
MAA 216,108,152
MAA 216,104,136
TR 44,16,42400
MAA 200,96,136
TR 46,16,42912
MAA 200,100,152
buffer_load_dwordx4 a[132:135], v10, s[16:19], s52 offen offset:1024 sc1
MAA 204,100,156
TR 48,17,33792
s_add_u32 s52, s52, 131072
MAA 204,96,140
MAA 156,88,140
TR 50,17,34304
MAA 156,92,156
TR 52,17,42240
MAA 152,92,152
TR 54,17,42752
MAA 152,88,136
buffer_load_dwordx4 a[144:147], v10, s[16:19], s52 offen sc1
MAA 136,80,136
TR 56,17,33824
MAA 136,84,152
MAA 140,84,156
TR 58,17,34336
MAA 140,80,140
TR 60,17,42272
MAA 92,72,140
TR 62,17,42784
MAA 92,76,156
buffer_load_dwordx4 a[148:151], v10, s[16:19], s52 offen offset:1024 sc1
MAA 88,76,152
s_add_u32 s52, s52, 131072
MAA 88,72,136
MAA 72,64,136
MAA 72,68,152
MAA 76,68,156
MAA 76,64,140
s_waitcnt vmcnt(18) lgkmcnt(0)
s_barrier
MAA 32,0,160
TR 64,16,50688
MAA 32,4,176
buffer_load_dwordx4 a[136:139], v11, s[16:19], s53 offen sc1
MAA 36,4,180
TR 66,16,51200
MAA 36,0,164
TR 68,16,59136
MAA 52,8,164
TR 70,16,59648
MAA 52,12,180
MAA 48,12,176
TR 72,16,50720
MAA 48,8,160
buffer_load_dwordx4 a[140:143], v11, s[16:19], s53 offen offset:1024 sc1
MAA 96,16,160
TR 74,16,51232
s_add_u32 s53, s53, 131072
MAA 96,20,176
TR 76,16,59168
MAA 100,20,180
MAA 100,16,164
TR 78,16,59680
MAA 116,24,164
TR 80,16,50752
MAA 116,28,180
buffer_load_dwordx4 a[152:155], v11, s[16:19], s53 offen sc1
MAA 112,28,176
TR 82,16,51264
MAA 112,24,160
MAA 160,32,160
TR 84,16,59200
MAA 160,36,176
TR 86,16,59712
MAA 164,36,180
TR 88,16,50784
MAA 164,32,164
buffer_load_dwordx4 a[156:159], v11, s[16:19], s53 offen offset:1024 sc1
MAA 180,40,164
s_add_u32 s53, s53, 131072
MAA 180,44,180
TR 90,16,51296
MAA 176,44,176
TR 92,16,59232
MAA 176,40,160
TR 94,16,59744
MAA 224,48,160
s_add_u32 m0, s55, 118272
MAA 224,52,176
buffer_load_dwordx4 v12, s[32:35], s54 offen   lds
MAA 228,52,180
TR 96,16,50816
MAA 228,48,164
TR 98,16,51328
MAA 236,56,164
TR 100,16,59264
MAA 236,60,180
TR 102,16,59776
MAA 232,60,176
MAA 232,56,160
TR 104,16,50848
s_waitcnt vmcnt(19)
MAA 188,40,172
TR 106,16,51360
MAA 188,44,188
buffer_load_dwordx4 v13, s[32:35], s54 offen offset:1056   lds
MAA 184,44,184
TR 108,16,59296
MAA 184,40,168
MAA 168,32,168
TR 110,16,59808
MAA 168,36,184
buffer_load_dwordx4 v14, s[32:35], s54 offen offset:2112   lds
MAA 172,36,188
TR 112,17,50688
MAA 172,32,172
TR 114,17,51200
MAA 124,24,172
MAA 124,28,188
TR 116,17,59136
MAA 120,28,184
TR 118,17,59648
MAA 120,24,168
buffer_load_dwordx4 v15, s[32:35], s54 offen offset:3168   lds
MAA 104,16,168
TR 120,17,50720
MAA 104,20,184
MAA 108,20,188
TR 122,17,51232
MAA 108,16,172
TR 124,17,59168
MAA 60,8,172
TR 126,17,59680
s_mov_b32 m0, s67
MAA 60,12,188
buffer_load_dwordx4 v18, s[28:31], s58 offen lds
MAA 56,12,184
MAA 56,8,168
MAA 40,0,168
MAA 40,4,184
MAA 44,4,188
MAA 44,0,172
s_waitcnt vmcnt(19) lgkmcnt(0)
s_barrier
MAA 64,64,160
ds_read_b64_tr_b16 a[0:1], v16
s_add_u32 m0, s55, 135168
MAA 64,68,176
buffer_load_dwordx4 v12, s[80:83], s54 offen   lds
MAA 68,68,180
TR 2,16,512
MAA 68,64,164
TR 4,16,8448
MAA 84,72,164
TR 6,16,8960
MAA 84,76,180
MAA 80,76,176
TR 8,16,32
MAA 80,72,160
buffer_load_dwordx4 v13, s[80:83], s54 offen offset:1056   lds
MAA 128,80,160
TR 10,16,544
MAA 128,84,176
TR 12,16,8480
MAA 132,84,180
TR 14,16,8992
MAA 132,80,164
MAA 148,88,164
TR 16,16,64
MAA 148,92,180
buffer_load_dwordx4 v14, s[80:83], s54 offen offset:2112   lds
MAA 144,92,176
TR 18,16,576
MAA 144,88,160
TR 20,16,8512
MAA 192,96,160
MAA 192,100,176
TR 22,16,9024
MAA 196,100,180
TR 24,16,96
MAA 196,96,164
buffer_load_dwordx4 v15, s[80:83], s54 offen offset:3168   lds
MAA 212,104,164
TR 26,16,608
s_add_u32 s54, s54, 458752
MAA 212,108,180
TR 28,16,8544
MAA 208,108,176
MAA 208,104,160
TR 30,16,9056
MAA 240,112,160
TR 32,16,128
s_mov_b32 m0, s67
MAA 240,116,176
buffer_load_dwordx4 v19, s[28:31], s58 offen offset:1056 lds
MAA 244,116,180
s_add_u32 s67, s67, 8448
s_add_u32 s46, s46, 1
s_xor_b32 s58, s46, s87
s_mul_i32 s58, s58, 458752
MAA 244,112,164
TR 34,16,640
MAA 252,120,164
MAA 252,124,180
TR 36,16,8576
MAA 248,124,176
TR 38,16,9088
MAA 248,120,160
buffer_load_dwordx4 a[160:163], v10, s[16:19], s52 offen sc1
MAA 220,104,172
TR 40,16,160
MAA 220,108,188
TR 42,16,672
MAA 216,108,184
MAA 216,104,168
TR 44,16,8608
MAA 200,96,168
TR 46,16,9120
MAA 200,100,184
buffer_load_dwordx4 a[164:167], v10, s[16:19], s52 offen offset:1024 sc1
MAA 204,100,188
ds_read_b64_tr_b16 a[48:49], v17
s_add_u32 s52, s52, 131072
MAA 204,96,172
MAA 156,88,172
TR 50,17,512
MAA 156,92,188
TR 52,17,8448
MAA 152,92,184
TR 54,17,8960
MAA 152,88,168
buffer_load_dwordx4 a[176:179], v10, s[16:19], s52 offen sc1
MAA 136,80,168
TR 56,17,32
MAA 136,84,184
MAA 140,84,188
TR 58,17,544
MAA 140,80,172
TR 60,17,8480
MAA 92,72,172
TR 62,17,8992
MAA 92,76,188
buffer_load_dwordx4 a[180:183], v10, s[16:19], s52 offen offset:1024 sc1
MAA 88,76,184
.Lpad26:
s_cbranch_execz .Lnopoll60r
s_add_u32 s52, s52, 131072
MAA 88,72,168
MAA 72,64,168
MAA 72,68,184
MAA 76,68,188
s_add_u32 s15, s15, 1
MAA 76,64,172
s_cbranch_scc0 .Lk65
s_waitcnt vmcnt(10) lgkmcnt(0)
s_barrier
MAA 32,0,128
buffer_load_dwordx4 a[168:171], v11, s[16:19], s53 offen sc1
MAA 32,4,144
TR 64,16,16896
s_add_u32 s58, s99, 2293760
MAA 48,12,144
TR 66,16,17408
s_lshl_b32 s74, s3, 11
MAA 48,8,128
TR 68,16,25344
s_add_u32 s74, s74, s84
MAA 36,0,132
buffer_load_dwordx4 a[172:175], v11, s[16:19], s53 offen offset:1024 sc1
MAA 36,4,148
TR 70,16,25856
s_add_u32 s53, s53, 131072
MAA 52,12,148
TR 72,16,16928
v_lshl_add_u32 v4, v1, 4, s74
MAA 52,8,132
TR 74,16,17440
v_lshrrev_b32 v2, 3, v1
MAA 40,0,136
buffer_load_dwordx4 a[184:187], v11, s[16:19], s53 offen sc1
MAA 40,4,152
TR 76,16,25376
v_cmp_eq_u32 vcc, 3, v2
MAA 56,12,152
TR 78,16,25888
v_add_u32 v2, 67108480, v4
MAA 56,8,136
TR 80,16,33792
v_cndmask_b32 v4, v4, v2, vcc
MAA 44,0,140
buffer_load_dwordx4 a[188:191], v11, s[16:19], s53 offen offset:1024 sc1
MAA 44,4,156
TR 82,16,34304
s_add_u32 s53, s53, 131072
MAA 60,12,156
TR 84,16,42240
s_and_b32 s74, s7, 1
MAA 60,8,140
TR 86,16,42752
s_add_u32 s54, s98, 65536
MAA 96,16,128
TR 88,16,33824
v_bfe_u32 v7, v1, 2, 3
MAA 96,20,144
TR 90,16,34336
v_mul_u32_u24 v7, 1056, v7
MAA 112,28,144
TR 92,16,42272
s_waitcnt vmcnt(9)
s_barrier
MAA 112,24,128
TR 94,16,42784
v_bfe_u32 v2, v1, 5, 1
MAA 100,16,132
TR 96,16,50688
v_lshl_add_u32 v7, v2, 8, v7
MAA 100,20,148
TR 98,16,51200
v_and_b32 v2, 3, v1
MAA 116,28,148
TR 100,16,59136
v_lshl_add_u32 v7, v2, 3, v7
MAA 116,24,132
TR 102,16,59648
s_lshl_b32 s74, s74, 7
MAA 104,16,136
TR 104,16,50720
s_xor_b32 s75, s74, 128
MAA 104,20,152
TR 106,16,51232
v_add_u32 v6, s75, v7
MAA 120,28,152
TR 108,16,59168
v_add_u32 v7, s74, v7
MAA 120,24,136
TR 110,16,59680
s_mul_i32 s55, s3, 2112
MAA 108,16,140
TR 112,16,16960
s_mov_b32 s57, 67584
MAA 108,20,156
TR 114,16,17472
MAA 124,28,156
TR 116,16,25408
MAA 124,24,140
TR 118,16,25920
MAA 160,32,128
TR 120,16,16992
MAA 160,36,144
TR 122,16,17504
MAA 176,44,144
TR 124,16,25440
MAA 176,40,128
TR 126,16,25952
MAA 164,32,132
TR 192,16,33856
MAA 164,36,148
TR 194,16,34368
MAA 180,44,148
TR 196,16,42304
MAA 180,40,132
TR 198,16,42816
MAA 168,32,136
TR 200,16,33888
MAA 168,36,152
TR 202,16,34400
MAA 184,44,152
TR 204,16,42336
MAA 184,40,136
TR 206,16,42848
MAA 172,32,140
TR 208,16,50752
MAA 172,36,156
TR 210,16,51264
MAA 188,44,156
TR 212,16,59200
MAA 188,40,140
TR 214,16,59712
MAA 224,48,128
TR 216,16,50784
MAA 224,52,144
TR 218,16,51296
MAA 232,60,144
TR 220,16,59232
MAA 232,56,128
TR 222,16,59744
MAA 228,48,132
TR 0,16,17024
MAA 228,52,148
TR 2,16,17536
MAA 236,60,148
TR 4,16,25472
MAA 236,56,132
TR 6,16,25984
s_waitcnt lgkmcnt(15)
MAA 64,64,128
TR 8,16,17056
MAA 64,68,144
TR 10,16,17568
s_waitcnt vmcnt(7)
MAA 64,96,160
TR 12,16,25504
s_waitcnt vmcnt(5)
MAA 64,100,176
TR 14,16,26016
MAA 80,108,176
TR 16,16,33920
MAA 80,104,160
TR 18,16,34432
MAA 80,76,144
TR 20,16,42368
MAA 80,72,128
TR 22,16,42880
MAA 32,80,160
TR 24,16,33952
MAA 32,84,176
TR 26,16,34464
MAA 48,92,176
TR 28,16,42400
MAA 48,88,160
TR 30,16,42912
s_nop 2
v_pk_mul_f32 v[64:65], v[64:65], v[32:33]
TR 32,16,50816
TR 34,16,51328
v_pk_mul_f32 v[32:33], v[32:33], v[28:29] op_sel_hi:[1,0]
v_pk_mul_f32 v[66:67], v[66:67], v[34:35]
v_pk_mul_f32 v[34:35], v[34:35], v[28:29] op_sel_hi:[1,0]
v_exp_f32 v32, v32
v_pk_mul_f32 v[80:81], v[80:81], v[48:49]
v_pk_mul_f32 v[48:49], v[48:49], v[28:29] op_sel_hi:[1,0]
v_pk_mul_f32 v[82:83], v[82:83], v[50:51]
v_pk_mul_f32 v[50:51], v[50:51], v[28:29] op_sel_hi:[1,0]
v_exp_f32 v33, v33
v_exp_f32 v34, v34
MAA 68,64,132
TR 36,16,59264
v_exp_f32 v35, v35
MAA 68,68,148
TR 38,16,59776
v_exp_f32 v48, v48
MAA 68,96,164
TR 40,16,50848
v_exp_f32 v49, v49
s_waitcnt vmcnt(4)
MAA 68,100,180
TR 42,16,51360
v_exp_f32 v50, v50
MAA 84,108,180
TR 44,16,59296
v_exp_f32 v51, v51
MAA 84,104,164
TR 46,16,59808
MAA 84,76,148
TR 48,17,16896
MAA 84,72,132
TR 50,17,17408
MAA 36,80,164
TR 52,17,25344
MAA 36,84,180
TR 54,17,25856
MAA 52,92,180
TR 56,17,16928
MAA 52,88,164
TR 58,17,17440
s_nop 2
v_pk_mul_f32 v[68:69], v[68:69], v[36:37]
v_pk_fma_f32 v[32:33], v[32:33], v[20:21], v[20:21] op_sel:[0,1,1] op_sel_hi:[1,1,1]
v_pk_fma_f32 v[34:35], v[34:35], v[20:21], v[20:21] op_sel:[0,1,1] op_sel_hi:[1,1,1]
v_pk_mul_f32 v[36:37], v[36:37], v[28:29] op_sel:[0,1] op_sel_hi:[1,1]
v_pk_mul_f32 v[70:71], v[70:71], v[38:39]
v_pk_mul_f32 v[38:39], v[38:39], v[28:29] op_sel:[0,1] op_sel_hi:[1,1]
v_pk_fma_f32 v[48:49], v[48:49], v[20:21], v[20:21] op_sel:[0,1,1] op_sel_hi:[1,1,1]
v_pk_mul_f32 v[84:85], v[84:85], v[52:53]
v_pk_mul_f32 v[52:53], v[52:53], v[28:29] op_sel:[0,1] op_sel_hi:[1,1]
v_pk_mul_f32 v[86:87], v[86:87], v[54:55]
v_pk_mul_f32 v[54:55], v[54:55], v[28:29] op_sel:[0,1] op_sel_hi:[1,1]
v_pk_fma_f32 v[50:51], v[50:51], v[20:21], v[20:21] op_sel:[0,1,1] op_sel_hi:[1,1,1]
v_rcp_f32 v32, v32
v_rcp_f32 v33, v33
MAA 72,64,136
TR 60,17,25376
v_rcp_f32 v34, v34
MAA 72,68,152
TR 62,17,25888
v_rcp_f32 v35, v35
s_waitcnt vmcnt(3)
MAA 72,96,168
v_rcp_f32 v48, v48
s_waitcnt vmcnt(1)
MAA 72,100,184
v_rcp_f32 v49, v49
MAA 88,108,184
v_rcp_f32 v50, v50
MAA 88,104,168
v_rcp_f32 v51, v51
MAA 88,76,152
v_exp_f32 v36, v36
MAA 88,72,136
v_exp_f32 v37, v37
MAA 40,80,168
v_exp_f32 v38, v38
MAA 40,84,184
v_exp_f32 v39, v39
MAA 56,92,184
v_exp_f32 v52, v52
MAA 56,88,168
v_exp_f32 v53, v53
v_exp_f32 v54, v54
v_exp_f32 v55, v55
v_pk_mul_f32 v[64:65], v[64:65], v[32:33]
v_pk_mul_f32 v[66:67], v[66:67], v[34:35]
v_pk_mul_f32 v[80:81], v[80:81], v[48:49]
v_pk_mul_f32 v[82:83], v[82:83], v[50:51]
v_pk_mul_f32 v[72:73], v[72:73], v[40:41]
v_pk_mul_f32 v[40:41], v[40:41], v[30:31] op_sel_hi:[1,0]
v_pk_mul_f32 v[74:75], v[74:75], v[42:43]
v_pk_mul_f32 v[42:43], v[42:43], v[30:31] op_sel_hi:[1,0]
v_pk_mul_f32 v[88:89], v[88:89], v[56:57]
v_pk_mul_f32 v[56:57], v[56:57], v[30:31] op_sel_hi:[1,0]
v_pk_mul_f32 v[90:91], v[90:91], v[58:59]
v_pk_mul_f32 v[58:59], v[58:59], v[30:31] op_sel_hi:[1,0]
v_pk_fma_f32 v[36:37], v[36:37], v[22:23], v[22:23] op_sel:[0,1,1] op_sel_hi:[1,1,1]
v_pk_fma_f32 v[38:39], v[38:39], v[22:23], v[22:23] op_sel:[0,1,1] op_sel_hi:[1,1,1]
v_pk_fma_f32 v[52:53], v[52:53], v[22:23], v[22:23] op_sel:[0,1,1] op_sel_hi:[1,1,1]
v_pk_fma_f32 v[54:55], v[54:55], v[22:23], v[22:23] op_sel:[0,1,1] op_sel_hi:[1,1,1]
v_cvt_pk_bf16_f32 v32, v64, v65
v_cvt_pk_bf16_f32 v33, v66, v67
v_cvt_pk_bf16_f32 v34, v80, v81
v_cvt_pk_bf16_f32 v35, v82, v83
MAA 76,64,140
buffer_store_dwordx4 v[32:35], v10, s[16:19], s62 offen sc1
MAA 76,68,156
TR 64,17,33792
v_rcp_f32 v36, v36
MAA 76,96,172
TR 66,17,34304
v_rcp_f32 v37, v37
s_waitcnt vmcnt(1)
MAA 76,100,188
TR 68,17,42240
v_rcp_f32 v38, v38
MAA 92,108,188
TR 70,17,42752
v_rcp_f32 v39, v39
MAA 92,104,172
v_rcp_f32 v52, v52
MAA 92,76,156
TR 76,17,42272
v_rcp_f32 v53, v53
MAA 92,72,140
TR 72,17,33824
v_rcp_f32 v54, v54
MAA 44,80,172
TR 74,17,34336
v_rcp_f32 v55, v55
MAA 44,84,188
TR 78,17,42784
v_exp_f32 v40, v40
MAA 60,92,188
TR 80,17,50688
v_exp_f32 v41, v41
MAA 60,88,172
TR 82,17,51200
v_exp_f32 v42, v42
v_exp_f32 v43, v43
v_exp_f32 v56, v56
v_exp_f32 v57, v57
v_exp_f32 v58, v58
v_exp_f32 v59, v59
v_pk_mul_f32 v[68:69], v[68:69], v[36:37]
v_pk_mul_f32 v[70:71], v[70:71], v[38:39]
v_pk_mul_f32 v[84:85], v[84:85], v[52:53]
v_pk_mul_f32 v[86:87], v[86:87], v[54:55]
v_pk_mul_f32 v[76:77], v[76:77], v[44:45]
v_pk_mul_f32 v[44:45], v[44:45], v[30:31] op_sel:[0,1] op_sel_hi:[1,1]
v_pk_mul_f32 v[78:79], v[78:79], v[46:47]
v_pk_mul_f32 v[46:47], v[46:47], v[30:31] op_sel:[0,1] op_sel_hi:[1,1]
v_pk_mul_f32 v[92:93], v[92:93], v[60:61]
v_pk_mul_f32 v[60:61], v[60:61], v[30:31] op_sel:[0,1] op_sel_hi:[1,1]
v_pk_mul_f32 v[94:95], v[94:95], v[62:63]
v_pk_mul_f32 v[62:63], v[62:63], v[30:31] op_sel:[0,1] op_sel_hi:[1,1]
v_pk_fma_f32 v[40:41], v[40:41], v[24:25], v[24:25] op_sel:[0,1,1] op_sel_hi:[1,1,1]
v_pk_fma_f32 v[42:43], v[42:43], v[24:25], v[24:25] op_sel:[0,1,1] op_sel_hi:[1,1,1]
v_pk_fma_f32 v[56:57], v[56:57], v[24:25], v[24:25] op_sel:[0,1,1] op_sel_hi:[1,1,1]
v_pk_fma_f32 v[58:59], v[58:59], v[24:25], v[24:25] op_sel:[0,1,1] op_sel_hi:[1,1,1]
v_cvt_pk_bf16_f32 v36, v68, v69
v_cvt_pk_bf16_f32 v37, v70, v71
v_cvt_pk_bf16_f32 v38, v84, v85
v_cvt_pk_bf16_f32 v39, v86, v87
MAA 128,112,128
buffer_store_dwordx4 v[36:39], v10, s[16:19], s62 offen offset:1024 sc1
MAA 128,116,144
TR 84,17,59136
v_rcp_f32 v40, v40
s_waitcnt lgkmcnt(15)
MAA 128,208,160
TR 86,17,59648
v_rcp_f32 v41, v41
MAA 128,212,176
TR 88,17,50720
v_rcp_f32 v42, v42
MAA 144,220,176
TR 90,17,51232
v_rcp_f32 v43, v43
MAA 144,216,160
TR 92,17,59168
v_rcp_f32 v56, v56
MAA 144,124,144
TR 94,17,59680
v_rcp_f32 v57, v57
MAA 144,120,128
v_rcp_f32 v58, v58
MAA 96,192,160
v_rcp_f32 v59, v59
MAA 96,196,176
v_exp_f32 v44, v44
MAA 112,204,176
v_exp_f32 v45, v45
MAA 112,200,160
v_lshrrev_b32 v69, 2, v0
v_min_u32 v69, 1, v69
v_lshlrev_b32 v69, 28, v69
v_lshl_add_u32 v68, v0, 7, v69
v_xor_b32 v69, 64, v0
v_min_u32 v69, 1, v69
v_lshlrev_b32 v70, 4, v69
v_sub_u32 v70, 16, v70
v_lshlrev_b32 v69, 28, v69
v_mov_b32 v71, 1
s_waitcnt lgkmcnt(0)
s_barrier
v_mov_b32 v84, 0
v_mov_b32 v85, 0
v_mov_b32 v86, 0
v_exp_f32 v46, v46
v_exp_f32 v47, v47
v_exp_f32 v60, v60
v_exp_f32 v61, v61
v_exp_f32 v62, v62
v_exp_f32 v63, v63
v_pk_mul_f32 v[72:73], v[72:73], v[40:41]
v_pk_mul_f32 v[74:75], v[74:75], v[42:43]
v_pk_mul_f32 v[88:89], v[88:89], v[56:57]
v_pk_mul_f32 v[90:91], v[90:91], v[58:59]
v_pk_mul_f32 v[128:129], v[128:129], v[96:97]
v_pk_mul_f32 v[96:97], v[96:97], v[28:29] op_sel_hi:[1,0]
v_pk_mul_f32 v[130:131], v[130:131], v[98:99]
v_pk_mul_f32 v[98:99], v[98:99], v[28:29] op_sel_hi:[1,0]
v_pk_mul_f32 v[144:145], v[144:145], v[112:113]
v_pk_mul_f32 v[112:113], v[112:113], v[28:29] op_sel_hi:[1,0]
v_pk_mul_f32 v[146:147], v[146:147], v[114:115]
v_pk_mul_f32 v[114:115], v[114:115], v[28:29] op_sel_hi:[1,0]
v_pk_fma_f32 v[44:45], v[44:45], v[26:27], v[26:27] op_sel:[0,1,1] op_sel_hi:[1,1,1]
v_pk_fma_f32 v[46:47], v[46:47], v[26:27], v[26:27] op_sel:[0,1,1] op_sel_hi:[1,1,1]
v_pk_fma_f32 v[60:61], v[60:61], v[26:27], v[26:27] op_sel:[0,1,1] op_sel_hi:[1,1,1]
v_pk_fma_f32 v[62:63], v[62:63], v[26:27], v[26:27] op_sel:[0,1,1] op_sel_hi:[1,1,1]
v_cvt_pk_bf16_f32 v40, v72, v73
v_cvt_pk_bf16_f32 v41, v74, v75
v_cvt_pk_bf16_f32 v42, v88, v89
v_cvt_pk_bf16_f32 v43, v90, v91
MAA 132,112,132
buffer_store_dwordx4 v[40:43], v11, s[16:19], s62 offen sc1
MAA 132,116,148
s_add_u32 m0, s59, 84480
v_rcp_f32 v44, v44
MAA 132,208,164
v_rcp_f32 v45, v45
MAA 132,212,180
v_rcp_f32 v46, v46
MAA 148,220,180
buffer_load_dwordx4 v18, s[28:31], s58 offen lds
MAA 148,216,164
v_rcp_f32 v47, v47
MAA 148,124,148
v_rcp_f32 v60, v60
MAA 148,120,132
v_rcp_f32 v61, v61
MAA 100,192,164
buffer_load_dwordx4 v19, s[28:31], s58 offen offset:1056 lds
MAA 100,196,180
s_add_u32 m0, s59, 92928
s_add_u32 s58, s99, 2555904
v_rcp_f32 v62, v62
MAA 116,204,180
v_rcp_f32 v63, v63
MAA 116,200,164
v_exp_f32 v96, v96
v_exp_f32 v97, v97
v_exp_f32 v98, v98
v_exp_f32 v99, v99
v_exp_f32 v112, v112
v_exp_f32 v113, v113
v_exp_f32 v114, v114
v_exp_f32 v115, v115
v_pk_mul_f32 v[76:77], v[76:77], v[44:45]
v_pk_mul_f32 v[78:79], v[78:79], v[46:47]
v_pk_mul_f32 v[92:93], v[92:93], v[60:61]
v_pk_mul_f32 v[94:95], v[94:95], v[62:63]
v_pk_mul_f32 v[132:133], v[132:133], v[100:101]
v_pk_mul_f32 v[100:101], v[100:101], v[28:29] op_sel:[0,1] op_sel_hi:[1,1]
v_pk_mul_f32 v[134:135], v[134:135], v[102:103]
v_pk_mul_f32 v[102:103], v[102:103], v[28:29] op_sel:[0,1] op_sel_hi:[1,1]
v_pk_mul_f32 v[148:149], v[148:149], v[116:117]
v_pk_mul_f32 v[116:117], v[116:117], v[28:29] op_sel:[0,1] op_sel_hi:[1,1]
v_pk_mul_f32 v[150:151], v[150:151], v[118:119]
v_pk_mul_f32 v[118:119], v[118:119], v[28:29] op_sel:[0,1] op_sel_hi:[1,1]
v_pk_fma_f32 v[96:97], v[96:97], v[20:21], v[20:21] op_sel:[0,1,1] op_sel_hi:[1,1,1]
v_pk_fma_f32 v[98:99], v[98:99], v[20:21], v[20:21] op_sel:[0,1,1] op_sel_hi:[1,1,1]
v_pk_fma_f32 v[112:113], v[112:113], v[20:21], v[20:21] op_sel:[0,1,1] op_sel_hi:[1,1,1]
v_pk_fma_f32 v[114:115], v[114:115], v[20:21], v[20:21] op_sel:[0,1,1] op_sel_hi:[1,1,1]
v_cvt_pk_bf16_f32 v44, v76, v77
v_cvt_pk_bf16_f32 v45, v78, v79
v_cvt_pk_bf16_f32 v46, v92, v93
v_cvt_pk_bf16_f32 v47, v94, v95
MAA 136,112,136
buffer_store_dwordx4 v[44:47], v11, s[16:19], s62 offen offset:1024 sc1
MAA 136,116,152
v_rcp_f32 v96, v96
MAA 136,208,168
v_rcp_f32 v97, v97
MAA 136,212,184
v_rcp_f32 v98, v98
MAA 152,220,184
buffer_load_dwordx4 v18, s[28:31], s58 offen lds
MAA 152,216,168
v_rcp_f32 v99, v99
MAA 152,124,152
v_rcp_f32 v112, v112
MAA 152,120,136
v_rcp_f32 v113, v113
MAA 104,192,168
buffer_load_dwordx4 v19, s[28:31], s58 offen offset:1056 lds
MAA 104,196,184
s_add_u32 m0, s59, 101376
s_add_u32 s58, s100, 2752512
v_rcp_f32 v114, v114
MAA 120,204,184
v_rcp_f32 v115, v115
MAA 120,200,168
v_exp_f32 v100, v100
v_exp_f32 v101, v101
v_exp_f32 v102, v102
v_exp_f32 v103, v103
v_exp_f32 v116, v116
v_exp_f32 v117, v117
v_exp_f32 v118, v118
v_exp_f32 v119, v119
v_pk_mul_f32 v[128:129], v[128:129], v[96:97]
v_pk_mul_f32 v[130:131], v[130:131], v[98:99]
v_pk_mul_f32 v[144:145], v[144:145], v[112:113]
v_pk_mul_f32 v[146:147], v[146:147], v[114:115]
v_pk_mul_f32 v[136:137], v[136:137], v[104:105]
v_pk_mul_f32 v[104:105], v[104:105], v[30:31] op_sel_hi:[1,0]
v_pk_mul_f32 v[138:139], v[138:139], v[106:107]
v_pk_mul_f32 v[106:107], v[106:107], v[30:31] op_sel_hi:[1,0]
v_pk_mul_f32 v[152:153], v[152:153], v[120:121]
v_pk_mul_f32 v[120:121], v[120:121], v[30:31] op_sel_hi:[1,0]
v_pk_mul_f32 v[154:155], v[154:155], v[122:123]
v_pk_mul_f32 v[122:123], v[122:123], v[30:31] op_sel_hi:[1,0]
v_pk_fma_f32 v[100:101], v[100:101], v[22:23], v[22:23] op_sel:[0,1,1] op_sel_hi:[1,1,1]
v_pk_fma_f32 v[102:103], v[102:103], v[22:23], v[22:23] op_sel:[0,1,1] op_sel_hi:[1,1,1]
v_pk_fma_f32 v[116:117], v[116:117], v[22:23], v[22:23] op_sel:[0,1,1] op_sel_hi:[1,1,1]
v_pk_fma_f32 v[118:119], v[118:119], v[22:23], v[22:23] op_sel:[0,1,1] op_sel_hi:[1,1,1]
v_cvt_pk_bf16_f32 v96, v128, v129
v_cvt_pk_bf16_f32 v97, v130, v131
v_cvt_pk_bf16_f32 v98, v144, v145
v_cvt_pk_bf16_f32 v99, v146, v147
MAA 140,112,140
buffer_store_dwordx4 v[96:99], v10, s[16:19], s63 offen sc1
MAA 140,116,156
v_rcp_f32 v100, v100
MAA 140,208,172
v_rcp_f32 v101, v101
MAA 140,212,188
v_rcp_f32 v102, v102
MAA 156,220,188
buffer_load_dwordx4 v18, s[28:31], s58 offen lds
MAA 156,216,172
v_rcp_f32 v103, v103
MAA 156,124,156
v_rcp_f32 v116, v116
MAA 156,120,140
v_rcp_f32 v117, v117
MAA 108,192,172
buffer_load_dwordx4 v19, s[28:31], s58 offen offset:1056 lds
MAA 108,196,188
s_add_u32 m0, s59, 109824
s_add_u32 s58, s100, 3014656
v_rcp_f32 v118, v118
MAA 124,204,188
v_rcp_f32 v119, v119
MAA 124,200,172
v_exp_f32 v104, v104
v_exp_f32 v105, v105
v_exp_f32 v106, v106
v_exp_f32 v107, v107
v_exp_f32 v120, v120
v_exp_f32 v121, v121
v_exp_f32 v122, v122
v_exp_f32 v123, v123
v_pk_mul_f32 v[132:133], v[132:133], v[100:101]
v_pk_mul_f32 v[134:135], v[134:135], v[102:103]
v_pk_mul_f32 v[148:149], v[148:149], v[116:117]
v_pk_mul_f32 v[150:151], v[150:151], v[118:119]
v_pk_mul_f32 v[140:141], v[140:141], v[108:109]
v_pk_mul_f32 v[108:109], v[108:109], v[30:31] op_sel:[0,1] op_sel_hi:[1,1]
v_pk_mul_f32 v[142:143], v[142:143], v[110:111]
v_pk_mul_f32 v[110:111], v[110:111], v[30:31] op_sel:[0,1] op_sel_hi:[1,1]
v_pk_mul_f32 v[156:157], v[156:157], v[124:125]
v_pk_mul_f32 v[124:125], v[124:125], v[30:31] op_sel:[0,1] op_sel_hi:[1,1]
v_pk_mul_f32 v[158:159], v[158:159], v[126:127]
v_pk_mul_f32 v[126:127], v[126:127], v[30:31] op_sel:[0,1] op_sel_hi:[1,1]
v_pk_fma_f32 v[104:105], v[104:105], v[24:25], v[24:25] op_sel:[0,1,1] op_sel_hi:[1,1,1]
v_pk_fma_f32 v[106:107], v[106:107], v[24:25], v[24:25] op_sel:[0,1,1] op_sel_hi:[1,1,1]
v_pk_fma_f32 v[120:121], v[120:121], v[24:25], v[24:25] op_sel:[0,1,1] op_sel_hi:[1,1,1]
v_pk_fma_f32 v[122:123], v[122:123], v[24:25], v[24:25] op_sel:[0,1,1] op_sel_hi:[1,1,1]
v_cvt_pk_bf16_f32 v100, v132, v133
v_cvt_pk_bf16_f32 v101, v134, v135
v_cvt_pk_bf16_f32 v102, v148, v149
v_cvt_pk_bf16_f32 v103, v150, v151
MAA 192,0,128
buffer_store_dwordx4 v[100:103], v10, s[16:19], s63 offen offset:1024 sc1
MAA 192,4,144
v_rcp_f32 v104, v104
MAA 192,32,160
s_waitcnt vmcnt(6)
s_barrier
v_rcp_f32 v105, v105
MAA 192,36,176
v_rcp_f32 v106, v106
MAA 208,44,176
.Lpad27:
s_cbranch_execz .Lpad30
buffer_atomic_add v71, v68, s[16:19], s72 offen offset:512
MAA 208,40,160
v_rcp_f32 v107, v107
MAA 208,12,144
v_rcp_f32 v120, v120
MAA 208,8,128
v_rcp_f32 v121, v121
MAA 160,16,160
buffer_load_dwordx4 v18, s[28:31], s58 offen lds
MAA 160,20,176
v_rcp_f32 v122, v122
MAA 176,28,176
v_rcp_f32 v123, v123
MAA 176,24,160
v_exp_f32 v108, v108
v_exp_f32 v109, v109
v_exp_f32 v110, v110
v_exp_f32 v111, v111
v_exp_f32 v124, v124
v_exp_f32 v125, v125
v_exp_f32 v126, v126
v_exp_f32 v127, v127
v_pk_mul_f32 v[136:137], v[136:137], v[104:105]
v_pk_mul_f32 v[138:139], v[138:139], v[106:107]
v_pk_mul_f32 v[152:153], v[152:153], v[120:121]
v_pk_mul_f32 v[154:155], v[154:155], v[122:123]
v_pk_mul_f32 v[192:193], v[192:193], v[160:161]
v_pk_mul_f32 v[160:161], v[160:161], v[28:29] op_sel_hi:[1,0]
v_pk_mul_f32 v[194:195], v[194:195], v[162:163]
v_pk_mul_f32 v[162:163], v[162:163], v[28:29] op_sel_hi:[1,0]
v_pk_mul_f32 v[208:209], v[208:209], v[176:177]
v_pk_mul_f32 v[176:177], v[176:177], v[28:29] op_sel_hi:[1,0]
v_pk_mul_f32 v[210:211], v[210:211], v[178:179]
v_pk_mul_f32 v[178:179], v[178:179], v[28:29] op_sel_hi:[1,0]
v_pk_fma_f32 v[108:109], v[108:109], v[26:27], v[26:27] op_sel:[0,1,1] op_sel_hi:[1,1,1]
v_pk_fma_f32 v[110:111], v[110:111], v[26:27], v[26:27] op_sel:[0,1,1] op_sel_hi:[1,1,1]
v_pk_fma_f32 v[124:125], v[124:125], v[26:27], v[26:27] op_sel:[0,1,1] op_sel_hi:[1,1,1]
v_pk_fma_f32 v[126:127], v[126:127], v[26:27], v[26:27] op_sel:[0,1,1] op_sel_hi:[1,1,1]
v_cvt_pk_bf16_f32 v104, v136, v137
v_cvt_pk_bf16_f32 v105, v138, v139
v_cvt_pk_bf16_f32 v106, v152, v153
v_cvt_pk_bf16_f32 v107, v154, v155
MAA 196,0,132
buffer_store_dwordx4 v[104:107], v11, s[16:19], s63 offen sc1
MAA 196,4,148
v_rcp_f32 v108, v108
MAA 196,32,164
v_rcp_f32 v109, v109
MAA 196,36,180
v_rcp_f32 v110, v110
MAA 212,44,180
buffer_load_dwordx4 v19, s[28:31], s58 offen offset:1056 lds
MAA 212,40,164
s_add_u32 m0, s59, 118272
s_add_u32 s58, s101, 3211264
v_rcp_f32 v111, v111
MAA 212,12,148
v_rcp_f32 v124, v124
MAA 212,8,132
v_rcp_f32 v125, v125
MAA 164,16,164
buffer_load_dwordx4 v18, s[28:31], s58 offen lds
MAA 164,20,180
v_rcp_f32 v126, v126
MAA 180,28,180
v_rcp_f32 v127, v127
MAA 180,24,164
v_exp_f32 v160, v160
v_exp_f32 v161, v161
v_exp_f32 v162, v162
v_exp_f32 v163, v163
v_exp_f32 v176, v176
v_exp_f32 v177, v177
v_exp_f32 v178, v178
v_exp_f32 v179, v179
v_pk_mul_f32 v[140:141], v[140:141], v[108:109]
v_pk_mul_f32 v[142:143], v[142:143], v[110:111]
v_pk_mul_f32 v[156:157], v[156:157], v[124:125]
v_pk_mul_f32 v[158:159], v[158:159], v[126:127]
v_pk_mul_f32 v[196:197], v[196:197], v[164:165]
v_pk_mul_f32 v[164:165], v[164:165], v[28:29] op_sel:[0,1] op_sel_hi:[1,1]
v_pk_mul_f32 v[198:199], v[198:199], v[166:167]
v_pk_mul_f32 v[166:167], v[166:167], v[28:29] op_sel:[0,1] op_sel_hi:[1,1]
v_pk_mul_f32 v[212:213], v[212:213], v[180:181]
v_pk_mul_f32 v[180:181], v[180:181], v[28:29] op_sel:[0,1] op_sel_hi:[1,1]
v_pk_mul_f32 v[214:215], v[214:215], v[182:183]
v_pk_mul_f32 v[182:183], v[182:183], v[28:29] op_sel:[0,1] op_sel_hi:[1,1]
v_pk_fma_f32 v[160:161], v[160:161], v[20:21], v[20:21] op_sel:[0,1,1] op_sel_hi:[1,1,1]
v_pk_fma_f32 v[162:163], v[162:163], v[20:21], v[20:21] op_sel:[0,1,1] op_sel_hi:[1,1,1]
v_pk_fma_f32 v[176:177], v[176:177], v[20:21], v[20:21] op_sel:[0,1,1] op_sel_hi:[1,1,1]
v_pk_fma_f32 v[178:179], v[178:179], v[20:21], v[20:21] op_sel:[0,1,1] op_sel_hi:[1,1,1]
v_cvt_pk_bf16_f32 v108, v140, v141
v_cvt_pk_bf16_f32 v109, v142, v143
v_cvt_pk_bf16_f32 v110, v156, v157
v_cvt_pk_bf16_f32 v111, v158, v159
MAA 200,0,136
buffer_store_dwordx4 v[108:111], v11, s[16:19], s63 offen offset:1024 sc1
MAA 200,4,152
v_rcp_f32 v160, v160
MAA 200,32,168
v_rcp_f32 v161, v161
MAA 200,36,184
v_rcp_f32 v162, v162
MAA 216,44,184
buffer_load_dwordx4 v19, s[28:31], s58 offen offset:1056 lds
MAA 216,40,168
s_add_u32 m0, s59, 126720
s_add_u32 s58, s101, 3473408
v_rcp_f32 v163, v163
MAA 216,12,152
v_rcp_f32 v176, v176
MAA 216,8,136
v_rcp_f32 v177, v177
MAA 168,16,168
buffer_load_dwordx4 v18, s[28:31], s58 offen lds
MAA 168,20,184
v_rcp_f32 v178, v178
MAA 184,28,184
v_rcp_f32 v179, v179
MAA 184,24,168
v_exp_f32 v164, v164
v_exp_f32 v165, v165
v_exp_f32 v166, v166
v_exp_f32 v167, v167
v_exp_f32 v180, v180
v_exp_f32 v181, v181
v_exp_f32 v182, v182
v_exp_f32 v183, v183
v_pk_mul_f32 v[192:193], v[192:193], v[160:161]
v_pk_mul_f32 v[194:195], v[194:195], v[162:163]
v_pk_mul_f32 v[208:209], v[208:209], v[176:177]
v_pk_mul_f32 v[210:211], v[210:211], v[178:179]
v_pk_mul_f32 v[200:201], v[200:201], v[168:169]
v_pk_mul_f32 v[168:169], v[168:169], v[30:31] op_sel_hi:[1,0]
v_pk_mul_f32 v[202:203], v[202:203], v[170:171]
v_pk_mul_f32 v[170:171], v[170:171], v[30:31] op_sel_hi:[1,0]
v_pk_mul_f32 v[216:217], v[216:217], v[184:185]
v_pk_mul_f32 v[184:185], v[184:185], v[30:31] op_sel_hi:[1,0]
v_pk_mul_f32 v[218:219], v[218:219], v[186:187]
v_pk_mul_f32 v[186:187], v[186:187], v[30:31] op_sel_hi:[1,0]
v_pk_fma_f32 v[164:165], v[164:165], v[22:23], v[22:23] op_sel:[0,1,1] op_sel_hi:[1,1,1]
v_pk_fma_f32 v[166:167], v[166:167], v[22:23], v[22:23] op_sel:[0,1,1] op_sel_hi:[1,1,1]
v_pk_fma_f32 v[180:181], v[180:181], v[22:23], v[22:23] op_sel:[0,1,1] op_sel_hi:[1,1,1]
v_pk_fma_f32 v[182:183], v[182:183], v[22:23], v[22:23] op_sel:[0,1,1] op_sel_hi:[1,1,1]
v_cvt_pk_bf16_f32 v160, v192, v193
v_cvt_pk_bf16_f32 v161, v194, v195
v_cvt_pk_bf16_f32 v162, v208, v209
v_cvt_pk_bf16_f32 v163, v210, v211
MAA 204,0,140
buffer_store_dwordx4 v[160:163], v10, s[16:19], s64 offen sc1
MAA 204,4,156
v_rcp_f32 v164, v164
MAA 204,32,172
v_rcp_f32 v165, v165
MAA 204,36,188
v_rcp_f32 v166, v166
MAA 220,44,188
buffer_atomic_add v84, v69, s[16:19], s73 offen offset:512 sc0
MAA 220,40,172
v_rcp_f32 v167, v167
MAA 220,12,156
v_rcp_f32 v180, v180
MAA 220,8,140
v_rcp_f32 v181, v181
MAA 172,16,172
buffer_load_dwordx4 v19, s[28:31], s58 offen offset:1056 lds
MAA 172,20,188
v_rcp_f32 v182, v182
MAA 188,28,188
v_rcp_f32 v183, v183
MAA 188,24,172
v_exp_f32 v168, v168
v_exp_f32 v169, v169
v_exp_f32 v170, v170
v_exp_f32 v171, v171
v_exp_f32 v184, v184
v_exp_f32 v185, v185
v_exp_f32 v186, v186
v_exp_f32 v187, v187
v_pk_mul_f32 v[196:197], v[196:197], v[164:165]
v_pk_mul_f32 v[198:199], v[198:199], v[166:167]
v_pk_mul_f32 v[212:213], v[212:213], v[180:181]
v_pk_mul_f32 v[214:215], v[214:215], v[182:183]
v_pk_mul_f32 v[204:205], v[204:205], v[172:173]
v_pk_mul_f32 v[172:173], v[172:173], v[30:31] op_sel:[0,1] op_sel_hi:[1,1]
v_pk_mul_f32 v[206:207], v[206:207], v[174:175]
v_pk_mul_f32 v[174:175], v[174:175], v[30:31] op_sel:[0,1] op_sel_hi:[1,1]
v_pk_mul_f32 v[220:221], v[220:221], v[188:189]
v_pk_mul_f32 v[188:189], v[188:189], v[30:31] op_sel:[0,1] op_sel_hi:[1,1]
v_pk_mul_f32 v[222:223], v[222:223], v[190:191]
v_pk_mul_f32 v[190:191], v[190:191], v[30:31] op_sel:[0,1] op_sel_hi:[1,1]
v_pk_fma_f32 v[168:169], v[168:169], v[24:25], v[24:25] op_sel:[0,1,1] op_sel_hi:[1,1,1]
v_pk_fma_f32 v[170:171], v[170:171], v[24:25], v[24:25] op_sel:[0,1,1] op_sel_hi:[1,1,1]
v_pk_fma_f32 v[184:185], v[184:185], v[24:25], v[24:25] op_sel:[0,1,1] op_sel_hi:[1,1,1]
v_pk_fma_f32 v[186:187], v[186:187], v[24:25], v[24:25] op_sel:[0,1,1] op_sel_hi:[1,1,1]
v_cvt_pk_bf16_f32 v164, v196, v197
v_cvt_pk_bf16_f32 v165, v198, v199
v_cvt_pk_bf16_f32 v166, v212, v213
v_cvt_pk_bf16_f32 v167, v214, v215
MAA 240,48,128
buffer_store_dwordx4 v[164:167], v10, s[16:19], s64 offen offset:1024 sc1
MAA 240,52,144
v_rcp_f32 v168, v168
MAA 240,80,160
v_rcp_f32 v169, v169
MAA 240,84,176
v_rcp_f32 v170, v170
MAA 248,92,176
buffer_atomic_add v85, v69, s[16:19], s73 offen offset:512 sc0
MAA 248,88,160
v_rcp_f32 v171, v171
MAA 248,60,144
v_rcp_f32 v184, v184
MAA 248,56,128
v_rcp_f32 v185, v185
MAA 224,64,160
v_rcp_f32 v186, v186
MAA 224,68,176
v_rcp_f32 v187, v187
MAA 232,76,176
v_exp_f32 v172, v172
MAA 232,72,160
v_exp_f32 v173, v173
v_exp_f32 v174, v174
v_exp_f32 v175, v175
v_exp_f32 v188, v188
v_exp_f32 v189, v189
v_exp_f32 v190, v190
v_exp_f32 v191, v191
v_pk_mul_f32 v[200:201], v[200:201], v[168:169]
v_pk_mul_f32 v[202:203], v[202:203], v[170:171]
v_pk_mul_f32 v[216:217], v[216:217], v[184:185]
v_pk_mul_f32 v[218:219], v[218:219], v[186:187]
v_pk_mul_f32 v[240:241], v[240:241], v[224:225]
v_pk_mul_f32 v[224:225], v[224:225], v[28:29] op_sel_hi:[1,0]
v_pk_mul_f32 v[242:243], v[242:243], v[226:227]
v_pk_mul_f32 v[226:227], v[226:227], v[28:29] op_sel_hi:[1,0]
v_pk_mul_f32 v[248:249], v[248:249], v[232:233]
v_pk_mul_f32 v[232:233], v[232:233], v[28:29] op_sel_hi:[1,0]
v_pk_mul_f32 v[250:251], v[250:251], v[234:235]
v_pk_mul_f32 v[234:235], v[234:235], v[28:29] op_sel_hi:[1,0]
v_pk_fma_f32 v[172:173], v[172:173], v[26:27], v[26:27] op_sel:[0,1,1] op_sel_hi:[1,1,1]
v_pk_fma_f32 v[174:175], v[174:175], v[26:27], v[26:27] op_sel:[0,1,1] op_sel_hi:[1,1,1]
v_pk_fma_f32 v[188:189], v[188:189], v[26:27], v[26:27] op_sel:[0,1,1] op_sel_hi:[1,1,1]
v_pk_fma_f32 v[190:191], v[190:191], v[26:27], v[26:27] op_sel:[0,1,1] op_sel_hi:[1,1,1]
v_cvt_pk_bf16_f32 v168, v200, v201
v_cvt_pk_bf16_f32 v169, v202, v203
v_cvt_pk_bf16_f32 v170, v216, v217
v_cvt_pk_bf16_f32 v171, v218, v219
buffer_store_dwordx4 v[168:171], v11, s[16:19], s64 offen sc1
buffer_atomic_add v86, v69, s[16:19], s73 offen offset:512 sc0
s_waitcnt vmcnt(5)
v_cmp_gt_u32 vcc, v70, v84
s_nop 0
s_cbranch_vccz .Lok66
s_waitcnt vmcnt(2)
v_cmp_gt_u32 vcc, v70, v85
s_nop 0
s_cbranch_vccz .Lok66
s_waitcnt vmcnt(0)
v_cmp_gt_u32 vcc, v70, v86
s_nop 0
s_cbranch_vccz .Lok66
s_mov_b32 s15, 0
.Lok66l:
v_mov_b32 v84, 0
buffer_atomic_add v84, v69, s[16:19], s73 offen offset:512 sc0
s_add_u32 s15, s15, 1
s_cmp_gt_u32 s15, 100000
s_waitcnt vmcnt(0)
s_cbranch_scc1 .Lok66
v_cmp_gt_u32 vcc, v70, v84
s_nop 0
s_cbranch_vccnz .Lok66l
.Lok66:
s_waitcnt vmcnt(4)
s_barrier
MAA 244,48,132
ds_read_b64_tr_b16 a[0:1], v7
s_add_u32 s52, s76, 0
MAA 244,52,148
buffer_load_dwordx4 v[96:99], v4, s[16:19], s52 offen sc1
MAA 244,80,164
TR 2,7,512
v_rcp_f32 v172, v172
MAA 244,84,180
TR 4,7,32
v_rcp_f32 v173, v173
MAA 252,92,180
TR 6,7,544
v_rcp_f32 v174, v174
MAA 252,88,164
buffer_load_dwordx4 v[100:103], v4, s[16:19], s52 offen offset:1024 sc1
MAA 252,60,148
TR 8,7,64
s_add_u32 s52, s76, 65536
MAA 252,56,132
TR 10,7,576
v_rcp_f32 v175, v175
MAA 228,64,164
TR 12,7,96
v_rcp_f32 v188, v188
MAA 228,68,180
buffer_load_dwordx4 v[104:107], v4, s[16:19], s52 offen sc1
MAA 236,76,180
TR 14,7,608
v_rcp_f32 v189, v189
MAA 236,72,164
TR 16,7,8448
v_rcp_f32 v190, v190
v_rcp_f32 v191, v191
v_exp_f32 v224, v224
v_exp_f32 v225, v225
v_exp_f32 v226, v226
v_exp_f32 v227, v227
v_exp_f32 v232, v232
v_exp_f32 v233, v233
v_exp_f32 v234, v234
v_exp_f32 v235, v235
v_pk_mul_f32 v[204:205], v[204:205], v[172:173]
buffer_load_dwordx4 v[108:111], v4, s[16:19], s52 offen offset:1024 sc1
s_add_u32 s52, s77, 114688
v_pk_mul_f32 v[206:207], v[206:207], v[174:175]
v_pk_mul_f32 v[220:221], v[220:221], v[188:189]
v_pk_mul_f32 v[222:223], v[222:223], v[190:191]
v_pk_mul_f32 v[244:245], v[244:245], v[228:229]
v_pk_mul_f32 v[228:229], v[228:229], v[28:29] op_sel:[0,1] op_sel_hi:[1,1]
v_pk_mul_f32 v[246:247], v[246:247], v[230:231]
v_pk_mul_f32 v[230:231], v[230:231], v[28:29] op_sel:[0,1] op_sel_hi:[1,1]
v_pk_mul_f32 v[252:253], v[252:253], v[236:237]
v_pk_mul_f32 v[236:237], v[236:237], v[28:29] op_sel:[0,1] op_sel_hi:[1,1]
v_pk_mul_f32 v[254:255], v[254:255], v[238:239]
v_pk_mul_f32 v[238:239], v[238:239], v[28:29] op_sel:[0,1] op_sel_hi:[1,1]
v_pk_fma_f32 v[224:225], v[224:225], v[20:21], v[20:21] op_sel:[0,1,1] op_sel_hi:[1,1,1]
buffer_load_dwordx4 v[112:115], v4, s[16:19], s52 offen sc1
v_pk_fma_f32 v[226:227], v[226:227], v[20:21], v[20:21] op_sel:[0,1,1] op_sel_hi:[1,1,1]
v_pk_fma_f32 v[232:233], v[232:233], v[20:21], v[20:21] op_sel:[0,1,1] op_sel_hi:[1,1,1]
v_pk_fma_f32 v[234:235], v[234:235], v[20:21], v[20:21] op_sel:[0,1,1] op_sel_hi:[1,1,1]
v_cvt_pk_bf16_f32 v172, v204, v205
v_cvt_pk_bf16_f32 v173, v206, v207
v_cvt_pk_bf16_f32 v174, v220, v221
v_cvt_pk_bf16_f32 v175, v222, v223
TR 18,7,8960
TR 20,7,8480
TR 22,7,8992
buffer_store_dwordx4 v[172:175], v11, s[16:19], s64 offen offset:1024 sc1
TR 24,7,8512
TR 26,7,9024
TR 28,7,8544
TR 30,7,9056
v_rcp_f32 v224, v224
v_rcp_f32 v225, v225
v_rcp_f32 v226, v226
v_rcp_f32 v227, v227
v_rcp_f32 v232, v232
v_rcp_f32 v233, v233
v_rcp_f32 v234, v234
v_rcp_f32 v235, v235
v_exp_f32 v228, v228
v_exp_f32 v229, v229
v_exp_f32 v230, v230
v_exp_f32 v231, v231
v_exp_f32 v236, v236
v_exp_f32 v237, v237
v_exp_f32 v238, v238
v_exp_f32 v239, v239
v_pk_mul_f32 v[240:241], v[240:241], v[224:225]
buffer_load_dwordx4 v[116:119], v4, s[16:19], s52 offen offset:1024 sc1
s_add_u32 s52, s77, 180224
v_pk_mul_f32 v[242:243], v[242:243], v[226:227]
v_pk_mul_f32 v[248:249], v[248:249], v[232:233]
v_pk_mul_f32 v[250:251], v[250:251], v[234:235]
v_pk_fma_f32 v[228:229], v[228:229], v[22:23], v[22:23] op_sel:[0,1,1] op_sel_hi:[1,1,1]
v_pk_fma_f32 v[230:231], v[230:231], v[22:23], v[22:23] op_sel:[0,1,1] op_sel_hi:[1,1,1]
v_pk_fma_f32 v[236:237], v[236:237], v[22:23], v[22:23] op_sel:[0,1,1] op_sel_hi:[1,1,1]
v_pk_fma_f32 v[238:239], v[238:239], v[22:23], v[22:23] op_sel:[0,1,1] op_sel_hi:[1,1,1]
v_cvt_pk_bf16_f32 v224, v240, v241
v_cvt_pk_bf16_f32 v225, v242, v243
v_cvt_pk_bf16_f32 v226, v248, v249
v_cvt_pk_bf16_f32 v227, v250, v251
v_rcp_f32 v228, v228
v_rcp_f32 v229, v229
v_rcp_f32 v230, v230
v_rcp_f32 v231, v231
v_rcp_f32 v236, v236
v_rcp_f32 v237, v237
v_rcp_f32 v238, v238
v_rcp_f32 v239, v239
v_pk_mul_f32 v[244:245], v[244:245], v[228:229]
buffer_store_dwordx4 v[224:227], v10, s[16:19], s65 offen sc1
v_pk_mul_f32 v[246:247], v[246:247], v[230:231]
v_pk_mul_f32 v[252:253], v[252:253], v[236:237]
v_pk_mul_f32 v[254:255], v[254:255], v[238:239]
v_cvt_pk_bf16_f32 v228, v244, v245
v_cvt_pk_bf16_f32 v229, v246, v247
v_cvt_pk_bf16_f32 v230, v252, v253
v_cvt_pk_bf16_f32 v231, v254, v255
buffer_store_dwordx4 v[228:231], v10, s[16:19], s65 offen offset:1024 sc1
buffer_load_dwordx4 v[120:123], v4, s[16:19], s52 offen sc1
buffer_load_dwordx4 v[124:127], v4, s[16:19], s52 offen offset:1024 sc1
v_mov_b32 v21, v68
v_mov_b32 v22, v69
v_mov_b32 v23, v70
v_mov_b32 v24, v71
v_mov_b32 v25, 0
s_waitcnt vmcnt(7) lgkmcnt(0)
s_barrier
v_mfma_f32_16x16x32_bf16 v[32:35], a[0:3], v[96:99], 0
ds_read_b64_tr_b16 a[32:33], v6
s_add_u32 s52, s78, 229376
MAV 32,16,104
buffer_load_dwordx4 v[128:131], v4, s[16:19], s52 offen sc1
v_mfma_f32_16x16x32_bf16 v[48:51], a[0:3], v[100:103], 0
TR 34,6,512
MAV 48,16,108
TR 36,6,32
TR 38,6,544
v_mfma_f32_16x16x32_bf16 v[52:55], a[4:7], v[100:103], 0
TR 48,6,8448
MAV 52,20,108
buffer_load_dwordx4 v[132:135], v4, s[16:19], s52 offen offset:1024 sc1
v_mfma_f32_16x16x32_bf16 v[36:39], a[4:7], v[96:99], 0
TR 50,6,8960
MAV 36,20,104
TR 52,6,8480
TR 54,6,8992
v_mfma_f32_16x16x32_bf16 v[40:43], a[8:11], v[96:99], 0
TR 40,6,64
s_add_u32 s52, s78, 294912
MAV 40,24,104
buffer_load_dwordx4 v[136:139], v4, s[16:19], s52 offen sc1
v_mfma_f32_16x16x32_bf16 v[56:59], a[8:11], v[100:103], 0
TR 42,6,576
MAV 56,24,108
TR 44,6,96
TR 46,6,608
v_mfma_f32_16x16x32_bf16 v[60:63], a[12:15], v[100:103], 0
TR 56,6,8512
MAV 60,28,108
buffer_load_dwordx4 v[140:143], v4, s[16:19], s52 offen offset:1024 sc1
v_mfma_f32_16x16x32_bf16 v[44:47], a[12:15], v[96:99], 0
TR 58,6,9024
MAV 44,28,104
TR 60,6,8544
TR 62,6,9056
s_waitcnt lgkmcnt(8)
v_mfma_f32_16x16x32_bf16 v[64:67], a[32:35], v[96:99], 0
TR 0,7,16896
s_add_u32 s52, s79, 344064
MAV 64,48,104
buffer_load_dwordx4 v[144:147], v4, s[16:19], s52 offen sc1
v_mfma_f32_16x16x32_bf16 v[80:83], a[32:35], v[100:103], 0
TR 2,7,17408
MAV 80,48,108
TR 4,7,16928
TR 6,7,17440
v_mfma_f32_16x16x32_bf16 v[84:87], a[36:39], v[100:103], 0
TR 16,7,25344
MAV 84,52,108
buffer_load_dwordx4 v[148:151], v4, s[16:19], s52 offen offset:1024 sc1
v_mfma_f32_16x16x32_bf16 v[68:71], a[36:39], v[96:99], 0
TR 18,7,25856
MAV 68,52,104
TR 20,7,25376
TR 22,7,25888
s_waitcnt lgkmcnt(8)
v_mfma_f32_16x16x32_bf16 v[72:75], a[40:43], v[96:99], 0
TR 8,7,16960
s_add_u32 s52, s79, 409600
MAV 72,56,104
buffer_load_dwordx4 v[152:155], v4, s[16:19], s52 offen sc1
v_mfma_f32_16x16x32_bf16 v[88:91], a[40:43], v[100:103], 0
TR 10,7,17472
MAV 88,56,108
TR 12,7,16992
TR 14,7,17504
v_mfma_f32_16x16x32_bf16 v[92:95], a[44:47], v[100:103], 0
TR 24,7,25408
MAV 92,60,108
buffer_load_dwordx4 v[156:159], v4, s[16:19], s52 offen offset:1024 sc1
v_mfma_f32_16x16x32_bf16 v[76:79], a[44:47], v[96:99], 0
TR 26,7,25920
MAV 76,60,104
TR 28,7,25440
TR 30,7,25952
s_waitcnt vmcnt(8) lgkmcnt(8)
s_barrier
MAV 32,0,112
TR 32,6,16896
MAV 32,16,120
buffer_atomic_add v24, v21, s[16:19], s72 offen
MAV 48,16,124
TR 34,6,17408
MAV 48,0,116
TR 36,6,16928
TR 38,6,17440
TR 48,6,25344
MAV 52,4,116
TR 50,6,25856
s_add_u32 m0, s55, 0
MAV 52,20,124
buffer_load_dwordx4 v18, s[28:31], s54 offen lds
MAV 36,20,120
TR 52,6,25376
MAV 36,4,112
TR 54,6,25888
TR 40,6,16960
s_waitcnt lgkmcnt(9)
MAV 40,8,112
TR 42,6,17472
s_add_u32 s52, s76, 458752
MAV 40,24,120
buffer_load_dwordx4 v[96:99], v4, s[16:19], s52 offen sc1
MAV 56,24,124
TR 44,6,16992
MAV 56,8,116
buffer_load_dwordx4 v19, s[28:31], s54 offen offset:1056 lds
MAV 60,12,116
TR 46,6,17504
s_add_u32 s54, s98, 327680
MAV 60,28,124
buffer_load_dwordx4 v[100:103], v4, s[16:19], s52 offen offset:1024 sc1
MAV 44,28,120
TR 56,6,25408
MAV 44,12,112
TR 58,6,25920
TR 60,6,25440
TR 62,6,25952
s_waitcnt lgkmcnt(8)
MAV 64,32,112
TR 0,7,33792
s_add_u32 m0, s55, 8448
MAV 64,48,120
buffer_load_dwordx4 v18, s[28:31], s54 offen lds
MAV 80,48,124
TR 2,7,34304
MAV 80,32,116
TR 4,7,33824
TR 6,7,34336
MAV 84,36,116
TR 16,7,42240
s_add_u32 s52, s76, 524288
MAV 84,52,124
buffer_load_dwordx4 v[104:107], v4, s[16:19], s52 offen sc1
MAV 68,52,120
TR 18,7,42752
MAV 68,36,112
TR 20,7,42272
TR 22,7,42784
s_waitcnt lgkmcnt(8)
MAV 72,40,112
TR 8,7,33856
MAV 72,56,120
buffer_load_dwordx4 v19, s[28:31], s54 offen offset:1056 lds
MAV 88,56,124
TR 10,7,34368
s_add_u32 s54, s99, 524288
MAV 88,40,116
TR 12,7,33888
TR 14,7,34400
MAV 92,44,116
TR 24,7,42304
MAV 92,60,124
buffer_load_dwordx4 v[108:111], v4, s[16:19], s52 offen offset:1024 sc1
MAV 76,60,120
TR 26,7,42816
MAV 76,44,112
TR 28,7,42336
TR 30,7,42848
s_waitcnt vmcnt(13) lgkmcnt(8)
s_barrier
MAV 32,0,128
TR 32,6,33792
s_add_u32 m0, s55, 16896
MAV 32,16,136
buffer_load_dwordx4 v18, s[28:31], s54 offen lds
MAV 48,16,140
TR 34,6,34304
MAV 48,0,132
TR 36,6,33824
TR 38,6,34336
MAV 52,4,132
TR 48,6,42240
s_add_u32 s52, s77, 573440
MAV 52,20,140
buffer_load_dwordx4 v[112:115], v4, s[16:19], s52 offen sc1
MAV 36,20,136
TR 50,6,42752
MAV 36,4,128
TR 52,6,42272
TR 54,6,42784
s_waitcnt lgkmcnt(8)
MAV 40,8,128
.Lpad28:
s_cbranch_execz .Lpad31
TR 40,6,33856
MAV 40,24,136
buffer_load_dwordx4 v19, s[28:31], s54 offen offset:1056 lds
MAV 56,24,140
TR 42,6,34368
s_add_u32 s54, s99, 786432
MAV 56,8,132
TR 44,6,33888
TR 46,6,34400
MAV 60,12,132
TR 56,6,42304
MAV 60,28,140
buffer_load_dwordx4 v[116:119], v4, s[16:19], s52 offen offset:1024 sc1
MAV 44,28,136
TR 58,6,42816
MAV 44,12,128
TR 60,6,42336
TR 62,6,42848
s_waitcnt lgkmcnt(8)
MAV 64,32,128
TR 0,7,50688
s_add_u32 m0, s55, 25344
MAV 64,48,136
buffer_load_dwordx4 v18, s[28:31], s54 offen lds
MAV 80,48,140
TR 2,7,51200
MAV 80,32,132
TR 4,7,50720
TR 6,7,51232
TR 16,7,59136
MAV 84,36,132
TR 18,7,59648
s_add_u32 s52, s77, 638976
MAV 84,52,140
buffer_load_dwordx4 v[120:123], v4, s[16:19], s52 offen sc1
MAV 68,52,136
TR 20,7,59168
MAV 68,36,128
TR 22,7,59680
TR 8,7,50752
s_waitcnt lgkmcnt(9)
MAV 72,40,128
TR 10,7,51264
MAV 72,56,136
buffer_load_dwordx4 v19, s[28:31], s54 offen offset:1056 lds
MAV 88,56,140
TR 12,7,50784
s_add_u32 s54, s100, 983040
MAV 88,40,132
buffer_load_dwordx4 v[124:127], v4, s[16:19], s52 offen offset:1024 sc1
MAV 92,44,132
TR 14,7,51296
MAV 92,60,140
buffer_atomic_add v25, v22, s[16:19], s73 offen sc0
MAV 76,60,136
TR 24,7,59200
MAV 76,44,128
TR 26,7,59712
TR 28,7,59232
TR 30,7,59744
s_waitcnt vmcnt(18) lgkmcnt(8)
s_barrier
MAV 32,0,144
TR 32,6,50688
s_add_u32 m0, s55, 33792
MAV 32,16,152
buffer_load_dwordx4 v18, s[28:31], s54 offen lds
MAV 48,16,156
TR 34,6,51200
MAV 48,0,148
TR 36,6,50720
TR 38,6,51232
MAV 52,4,148
TR 48,6,59136
s_add_u32 s52, s78, 688128
MAV 52,20,156
buffer_load_dwordx4 v[128:131], v4, s[16:19], s52 offen sc1
MAV 36,20,152
TR 50,6,59648
MAV 36,4,144
TR 52,6,59168
TR 54,6,59680
s_waitcnt lgkmcnt(8)
MAV 40,8,144
TR 40,6,50752
MAV 40,24,152
buffer_load_dwordx4 v19, s[28:31], s54 offen offset:1056 lds
MAV 56,24,156
TR 42,6,51264
s_add_u32 s54, s100, 1245184
MAV 56,8,148
TR 44,6,50784
TR 46,6,51296
MAV 60,12,148
TR 56,6,59200
MAV 60,28,156
buffer_load_dwordx4 v[132:135], v4, s[16:19], s52 offen offset:1024 sc1
MAV 44,28,152
TR 58,6,59712
MAV 44,12,144
TR 60,6,59232
TR 62,6,59744
v_add_u32 v7, s57, v7
v_add_u32 v6, s57, v6
s_sub_u32 s57, 0, s57
s_waitcnt lgkmcnt(8)
MAV 64,32,144
ds_read_b64_tr_b16 a[0:1], v7
s_add_u32 m0, s55, 42240
MAV 64,48,152
buffer_load_dwordx4 v18, s[28:31], s54 offen lds
MAV 80,48,156
TR 2,7,512
MAV 80,32,148
TR 4,7,32
TR 6,7,544
MAV 84,36,148
TR 16,7,8448
s_add_u32 s52, s78, 753664
MAV 84,52,156
buffer_load_dwordx4 v[136:139], v4, s[16:19], s52 offen sc1
MAV 68,52,152
TR 18,7,8960
MAV 68,36,144
TR 20,7,8480
TR 22,7,8992
s_waitcnt lgkmcnt(8)
MAV 72,40,144
TR 8,7,64
MAV 72,56,152
buffer_load_dwordx4 v19, s[28:31], s54 offen offset:1056 lds
MAV 88,56,156
TR 10,7,576
s_add_u32 s54, s101, 1441792
MAV 88,40,148
TR 12,7,96
TR 14,7,608
MAV 92,44,148
TR 24,7,8512
MAV 92,60,156
buffer_load_dwordx4 v[140:143], v4, s[16:19], s52 offen offset:1024 sc1
MAV 76,60,152
TR 26,7,9024
MAV 76,44,144
TR 28,7,8544
TR 30,7,9056
s_waitcnt vmcnt(17) lgkmcnt(8)
s_barrier
MAV 32,0,96
ds_read_b64_tr_b16 a[32:33], v6
s_add_u32 m0, s55, 50688
MAV 32,16,104
buffer_load_dwordx4 v18, s[28:31], s54 offen lds
MAV 48,16,108
TR 34,6,512
MAV 48,0,100
TR 36,6,32
TR 38,6,544
MAV 52,4,100
TR 48,6,8448
s_add_u32 s52, s79, 802816
MAV 52,20,108
buffer_load_dwordx4 v[144:147], v4, s[16:19], s52 offen sc1
MAV 36,20,104
TR 50,6,8960
MAV 36,4,96
TR 52,6,8480
TR 54,6,8992
s_waitcnt lgkmcnt(8)
MAV 40,8,96
TR 40,6,64
MAV 40,24,104
buffer_load_dwordx4 v19, s[28:31], s54 offen offset:1056 lds
MAV 56,24,108
TR 42,6,576
s_add_u32 s54, s101, 1703936
MAV 56,8,100
TR 44,6,96
TR 46,6,608
MAV 60,12,100
TR 56,6,8512
MAV 60,28,108
buffer_load_dwordx4 v[148:151], v4, s[16:19], s52 offen offset:1024 sc1
MAV 44,28,104
TR 58,6,9024
MAV 44,12,96
TR 60,6,8544
TR 62,6,9056
s_waitcnt lgkmcnt(8)
MAV 64,32,96
TR 0,7,16896
s_add_u32 m0, s55, 59136
MAV 64,48,104
buffer_load_dwordx4 v18, s[28:31], s54 offen lds
MAV 80,48,108
TR 2,7,17408
MAV 80,32,100
TR 4,7,16928
TR 6,7,17440
MAV 84,36,100
TR 16,7,25344
s_add_u32 s52, s79, 868352
MAV 84,52,108
buffer_load_dwordx4 v[152:155], v4, s[16:19], s52 offen sc1
MAV 68,52,104
TR 18,7,25856
MAV 68,36,96
TR 20,7,25376
TR 22,7,25888
s_waitcnt lgkmcnt(8)
MAV 72,40,96
TR 8,7,16960
MAV 72,56,104
buffer_load_dwordx4 v19, s[28:31], s54 offen offset:1056 lds
MAV 88,56,108
TR 10,7,17472
s_add_u32 s54, s98, 1900544
MAV 88,40,100
TR 12,7,16992
TR 14,7,17504
MAV 92,44,100
TR 24,7,25408
MAV 92,60,108
buffer_load_dwordx4 v[156:159], v4, s[16:19], s52 offen offset:1024 sc1
MAV 76,60,104
TR 26,7,25920
MAV 76,44,96
TR 28,7,25440
TR 30,7,25952
s_waitcnt vmcnt(16)
v_cmp_gt_u32 vcc, v23, v25
s_nop 0
s_cbranch_vccnz .Lsp67
.Lsp67b:
s_waitcnt lgkmcnt(8)
s_barrier
MAV 32,0,112
TR 32,6,16896
s_add_u32 m0, s55, 67584
MAV 32,16,120
buffer_load_dwordx4 v18, s[28:31], s54 offen lds
MAV 48,16,124
TR 34,6,17408
MAV 48,0,116
TR 36,6,16928
TR 38,6,17440
MAV 52,4,116
TR 48,6,25344
s_add_u32 s52, s76, 16384
MAV 52,20,124
buffer_load_dwordx4 v[96:99], v4, s[16:19], s52 offen sc1
MAV 36,20,120
TR 50,6,25856
MAV 36,4,112
TR 52,6,25376
TR 54,6,25888
s_waitcnt lgkmcnt(8)
MAV 40,8,112
TR 40,6,16960
MAV 40,24,120
buffer_load_dwordx4 v19, s[28:31], s54 offen offset:1056 lds
MAV 56,24,124
TR 42,6,17472
s_add_u32 s54, s98, 2162688
MAV 56,8,116
TR 44,6,16992
TR 46,6,17504
MAV 60,12,116
TR 56,6,25408
MAV 60,28,124
buffer_load_dwordx4 v[100:103], v4, s[16:19], s52 offen offset:1024 sc1
MAV 44,28,120
TR 58,6,25920
MAV 44,12,112
TR 60,6,25440
TR 62,6,25952
s_waitcnt lgkmcnt(8)
MAV 64,32,112
TR 0,7,33792
s_add_u32 m0, s55, 76032
MAV 64,48,120
buffer_load_dwordx4 v18, s[28:31], s54 offen lds
MAV 80,48,124
TR 2,7,34304
MAV 80,32,116
TR 4,7,33824
TR 6,7,34336
MAV 84,36,116
TR 16,7,42240
s_add_u32 s52, s76, 81920
MAV 84,52,124
buffer_load_dwordx4 v[104:107], v4, s[16:19], s52 offen sc1
MAV 68,52,120
TR 18,7,42752
MAV 68,36,112
TR 20,7,42272
TR 22,7,42784
s_waitcnt lgkmcnt(8)
MAV 72,40,112
TR 8,7,33856
MAV 72,56,120
buffer_load_dwordx4 v19, s[28:31], s54 offen offset:1056 lds
MAV 88,56,124
TR 10,7,34368
s_add_u32 s54, s99, 2359296
MAV 88,40,116
TR 12,7,33888
TR 14,7,34400
MAV 92,44,116
TR 24,7,42304
MAV 92,60,124
buffer_load_dwordx4 v[108:111], v4, s[16:19], s52 offen offset:1024 sc1
MAV 76,60,120
TR 26,7,42816
MAV 76,44,112
TR 28,7,42336
TR 30,7,42848
s_waitcnt vmcnt(16) lgkmcnt(8)
s_barrier
MAV 32,0,128
TR 32,6,33792
s_add_u32 m0, s55, 84480
MAV 32,16,136
buffer_load_dwordx4 v18, s[28:31], s54 offen lds
MAV 48,16,140
TR 34,6,34304
MAV 48,0,132
TR 36,6,33824
TR 38,6,34336
MAV 52,4,132
TR 48,6,42240
s_add_u32 s52, s77, 131072
MAV 52,20,140
buffer_load_dwordx4 v[112:115], v4, s[16:19], s52 offen sc1
MAV 36,20,136
TR 50,6,42752
MAV 36,4,128
TR 52,6,42272
TR 54,6,42784
s_waitcnt lgkmcnt(8)
MAV 40,8,128
TR 40,6,33856
MAV 40,24,136
buffer_load_dwordx4 v19, s[28:31], s54 offen offset:1056 lds
MAV 56,24,140
TR 42,6,34368
s_add_u32 s54, s99, 2621440
MAV 56,8,132
TR 44,6,33888
TR 46,6,34400
MAV 60,12,132
TR 56,6,42304
MAV 60,28,140
buffer_load_dwordx4 v[116:119], v4, s[16:19], s52 offen offset:1024 sc1
MAV 44,28,136
TR 58,6,42816
MAV 44,12,128
TR 60,6,42336
TR 62,6,42848
s_waitcnt lgkmcnt(8)
MAV 64,32,128
TR 0,7,50688
s_add_u32 m0, s55, 92928
MAV 64,48,136
buffer_load_dwordx4 v18, s[28:31], s54 offen lds
MAV 80,48,140
TR 2,7,51200
MAV 80,32,132
TR 4,7,50720
TR 6,7,51232
MAV 84,36,132
TR 16,7,59136
s_add_u32 s52, s77, 196608
MAV 84,52,140
buffer_load_dwordx4 v[120:123], v4, s[16:19], s52 offen sc1
MAV 68,52,136
TR 18,7,59648
MAV 68,36,128
TR 20,7,59168
TR 22,7,59680
s_waitcnt lgkmcnt(8)
MAV 72,40,128
TR 8,7,50752
MAV 72,56,136
buffer_load_dwordx4 v19, s[28:31], s54 offen offset:1056 lds
MAV 88,56,140
TR 10,7,51264
s_add_u32 s54, s100, 2818048
MAV 88,40,132
TR 12,7,50784
TR 14,7,51296
MAV 92,44,132
TR 24,7,59200
MAV 92,60,140
buffer_load_dwordx4 v[124:127], v4, s[16:19], s52 offen offset:1024 sc1
MAV 76,60,136
TR 26,7,59712
MAV 76,44,128
TR 28,7,59232
TR 30,7,59744
s_waitcnt vmcnt(16) lgkmcnt(8)
s_barrier
MAV 32,0,144
TR 32,6,50688
s_add_u32 m0, s55, 101376
MAV 32,16,152
buffer_load_dwordx4 v18, s[28:31], s54 offen lds
MAV 48,16,156
TR 34,6,51200
MAV 48,0,148
TR 36,6,50720
TR 38,6,51232
MAV 52,4,148
TR 48,6,59136
s_add_u32 s52, s78, 245760
MAV 52,20,156
buffer_load_dwordx4 v[128:131], v4, s[16:19], s52 offen sc1
MAV 36,20,152
TR 50,6,59648
MAV 36,4,144
TR 52,6,59168
TR 54,6,59680
s_waitcnt lgkmcnt(8)
MAV 40,8,144
TR 40,6,50752
MAV 40,24,152
buffer_load_dwordx4 v19, s[28:31], s54 offen offset:1056 lds
MAV 56,24,156
TR 42,6,51264
s_add_u32 s54, s100, 3080192
MAV 56,8,148
TR 44,6,50784
TR 46,6,51296
MAV 60,12,148
TR 56,6,59200
MAV 60,28,156
buffer_load_dwordx4 v[132:135], v4, s[16:19], s52 offen offset:1024 sc1
MAV 44,28,152
TR 58,6,59712
MAV 44,12,144
TR 60,6,59232
TR 62,6,59744
v_add_u32 v7, s57, v7
v_add_u32 v6, s57, v6
s_sub_u32 s57, 0, s57
s_waitcnt lgkmcnt(8)
MAV 64,32,144
ds_read_b64_tr_b16 a[0:1], v7
s_add_u32 m0, s55, 109824
MAV 64,48,152
buffer_load_dwordx4 v18, s[28:31], s54 offen lds
MAV 80,48,156
TR 2,7,512
MAV 80,32,148
TR 4,7,32
TR 6,7,544
MAV 84,36,148
TR 16,7,8448
s_add_u32 s52, s78, 311296
MAV 84,52,156
buffer_load_dwordx4 v[136:139], v4, s[16:19], s52 offen sc1
MAV 68,52,152
TR 18,7,8960
MAV 68,36,144
TR 20,7,8480
TR 22,7,8992
s_waitcnt lgkmcnt(8)
MAV 72,40,144
TR 8,7,64
MAV 72,56,152
buffer_load_dwordx4 v19, s[28:31], s54 offen offset:1056 lds
MAV 88,56,156
TR 10,7,576
s_add_u32 s54, s101, 3276800
MAV 88,40,148
TR 12,7,96
TR 14,7,608
MAV 92,44,148
TR 24,7,8512
MAV 92,60,156
buffer_load_dwordx4 v[140:143], v4, s[16:19], s52 offen offset:1024 sc1
MAV 76,60,152
TR 26,7,9024
MAV 76,44,144
TR 28,7,8544
TR 30,7,9056
s_waitcnt vmcnt(16) lgkmcnt(8)
s_barrier
MAV 32,0,96
ds_read_b64_tr_b16 a[32:33], v6
s_add_u32 m0, s55, 118272
MAV 32,16,104
buffer_load_dwordx4 v18, s[28:31], s54 offen lds
MAV 48,16,108
TR 34,6,512
MAV 48,0,100
TR 36,6,32
TR 38,6,544
MAV 52,4,100
TR 48,6,8448
s_add_u32 s52, s79, 360448
MAV 52,20,108
buffer_load_dwordx4 v[144:147], v4, s[16:19], s52 offen sc1
MAV 36,20,104
TR 50,6,8960
MAV 36,4,96
TR 52,6,8480
TR 54,6,8992
s_waitcnt lgkmcnt(8)
MAV 40,8,96
TR 40,6,64
MAV 40,24,104
buffer_load_dwordx4 v19, s[28:31], s54 offen offset:1056 lds
MAV 56,24,108
TR 42,6,576
s_add_u32 s54, s101, 3538944
MAV 56,8,100
TR 44,6,96
TR 46,6,608
MAV 60,12,100
TR 56,6,8512
MAV 60,28,108
buffer_load_dwordx4 v[148:151], v4, s[16:19], s52 offen offset:1024 sc1
MAV 44,28,104
TR 58,6,9024
MAV 44,12,96
TR 60,6,8544
TR 62,6,9056
s_waitcnt lgkmcnt(8)
MAV 64,32,96
TR 0,7,16896
s_add_u32 m0, s55, 126720
MAV 64,48,104
.Lpad29:
s_cbranch_execz .Lpad32
buffer_load_dwordx4 v18, s[28:31], s54 offen lds
MAV 80,48,108
TR 2,7,17408
MAV 80,32,100
TR 4,7,16928
TR 6,7,17440
MAV 84,36,100
TR 16,7,25344
s_add_u32 s52, s79, 425984
MAV 84,52,108
buffer_load_dwordx4 v[152:155], v4, s[16:19], s52 offen sc1
MAV 68,52,104
TR 18,7,25856
MAV 68,36,96
TR 20,7,25376
TR 22,7,25888
s_waitcnt lgkmcnt(8)
MAV 72,40,96
TR 8,7,16960
MAV 72,56,104
buffer_load_dwordx4 v19, s[28:31], s54 offen offset:1056 lds
MAV 88,56,108
TR 10,7,17472
s_add_u32 s54, s98, 131072
MAV 88,40,100
TR 12,7,16992
TR 14,7,17504
MAV 92,44,100
TR 24,7,25408
MAV 92,60,108
buffer_load_dwordx4 v[156:159], v4, s[16:19], s52 offen offset:1024 sc1
MAV 76,60,104
TR 26,7,25920
MAV 76,44,96
TR 28,7,25440
TR 30,7,25952
s_waitcnt vmcnt(16) lgkmcnt(8)
s_barrier
MAV 32,0,112
TR 32,6,16896
s_add_u32 m0, s55, 0
MAV 32,16,120
buffer_load_dwordx4 v18, s[28:31], s54 offen lds
MAV 48,16,124
TR 34,6,17408
MAV 48,0,116
TR 36,6,16928
TR 38,6,17440
MAV 52,4,116
TR 48,6,25344
s_add_u32 s52, s76, 475136
MAV 52,20,124
buffer_load_dwordx4 v[96:99], v4, s[16:19], s52 offen sc1
MAV 36,20,120
TR 50,6,25856
MAV 36,4,112
TR 52,6,25376
TR 54,6,25888
s_waitcnt lgkmcnt(8)
MAV 40,8,112
TR 40,6,16960
MAV 40,24,120
buffer_load_dwordx4 v19, s[28:31], s54 offen offset:1056 lds
MAV 56,24,124
TR 42,6,17472
s_add_u32 s54, s98, 393216
MAV 56,8,116
TR 44,6,16992
TR 46,6,17504
MAV 60,12,116
TR 56,6,25408
MAV 60,28,124
buffer_load_dwordx4 v[100:103], v4, s[16:19], s52 offen offset:1024 sc1
MAV 44,28,120
TR 58,6,25920
MAV 44,12,112
TR 60,6,25440
TR 62,6,25952
s_waitcnt lgkmcnt(8)
MAV 64,32,112
TR 0,7,33792
s_add_u32 m0, s55, 8448
MAV 64,48,120
buffer_load_dwordx4 v18, s[28:31], s54 offen lds
MAV 80,48,124
TR 2,7,34304
MAV 80,32,116
TR 4,7,33824
TR 6,7,34336
MAV 84,36,116
TR 16,7,42240
s_add_u32 s52, s76, 540672
MAV 84,52,124
buffer_load_dwordx4 v[104:107], v4, s[16:19], s52 offen sc1
MAV 68,52,120
TR 18,7,42752
MAV 68,36,112
TR 20,7,42272
TR 22,7,42784
s_waitcnt lgkmcnt(8)
MAV 72,40,112
TR 8,7,33856
MAV 72,56,120
buffer_load_dwordx4 v19, s[28:31], s54 offen offset:1056 lds
MAV 88,56,124
TR 10,7,34368
s_add_u32 s54, s99, 589824
MAV 88,40,116
TR 12,7,33888
TR 14,7,34400
MAV 92,44,116
TR 24,7,42304
MAV 92,60,124
buffer_load_dwordx4 v[108:111], v4, s[16:19], s52 offen offset:1024 sc1
MAV 76,60,120
TR 26,7,42816
MAV 76,44,112
TR 28,7,42336
TR 30,7,42848
s_waitcnt vmcnt(16) lgkmcnt(8)
s_barrier
MAV 32,0,128
TR 32,6,33792
s_add_u32 m0, s55, 16896
MAV 32,16,136
buffer_load_dwordx4 v18, s[28:31], s54 offen lds
MAV 48,16,140
TR 34,6,34304
MAV 48,0,132
TR 36,6,33824
TR 38,6,34336
MAV 52,4,132
TR 48,6,42240
s_add_u32 s52, s77, 589824
MAV 52,20,140
buffer_load_dwordx4 v[112:115], v4, s[16:19], s52 offen sc1
MAV 36,20,136
TR 50,6,42752
MAV 36,4,128
TR 52,6,42272
TR 54,6,42784
s_waitcnt lgkmcnt(8)
MAV 40,8,128
TR 40,6,33856
MAV 40,24,136
buffer_load_dwordx4 v19, s[28:31], s54 offen offset:1056 lds
MAV 56,24,140
TR 42,6,34368
s_add_u32 s54, s99, 851968
MAV 56,8,132
TR 44,6,33888
TR 46,6,34400
MAV 60,12,132
TR 56,6,42304
MAV 60,28,140
buffer_load_dwordx4 v[116:119], v4, s[16:19], s52 offen offset:1024 sc1
MAV 44,28,136
TR 58,6,42816
MAV 44,12,128
TR 60,6,42336
TR 62,6,42848
s_waitcnt lgkmcnt(8)
MAV 64,32,128
TR 0,7,50688
s_add_u32 m0, s55, 25344
MAV 64,48,136
buffer_load_dwordx4 v18, s[28:31], s54 offen lds
MAV 80,48,140
TR 2,7,51200
MAV 80,32,132
TR 4,7,50720
TR 6,7,51232
MAV 84,36,132
TR 16,7,59136
s_add_u32 s52, s77, 655360
MAV 84,52,140
buffer_load_dwordx4 v[120:123], v4, s[16:19], s52 offen sc1
MAV 68,52,136
TR 18,7,59648
MAV 68,36,128
TR 20,7,59168
TR 22,7,59680
s_waitcnt lgkmcnt(8)
MAV 72,40,128
TR 8,7,50752
MAV 72,56,136
buffer_load_dwordx4 v19, s[28:31], s54 offen offset:1056 lds
MAV 88,56,140
TR 10,7,51264
s_add_u32 s54, s100, 1048576
MAV 88,40,132
TR 12,7,50784
TR 14,7,51296
MAV 92,44,132
TR 24,7,59200
MAV 92,60,140
buffer_load_dwordx4 v[124:127], v4, s[16:19], s52 offen offset:1024 sc1
MAV 76,60,136
TR 26,7,59712
MAV 76,44,128
TR 28,7,59232
TR 30,7,59744
s_waitcnt vmcnt(16) lgkmcnt(8)
s_barrier
MAV 32,0,144
TR 32,6,50688
s_add_u32 m0, s55, 33792
MAV 32,16,152
buffer_load_dwordx4 v18, s[28:31], s54 offen lds
MAV 48,16,156
TR 34,6,51200
MAV 48,0,148
TR 36,6,50720
TR 38,6,51232
MAV 52,4,148
TR 48,6,59136
s_add_u32 s52, s78, 704512
MAV 52,20,156
buffer_load_dwordx4 v[128:131], v4, s[16:19], s52 offen sc1
MAV 36,20,152
TR 50,6,59648
MAV 36,4,144
TR 52,6,59168
TR 54,6,59680
s_waitcnt lgkmcnt(8)
MAV 40,8,144
TR 40,6,50752
MAV 40,24,152
buffer_load_dwordx4 v19, s[28:31], s54 offen offset:1056 lds
MAV 56,24,156
TR 42,6,51264
s_add_u32 s54, s100, 1310720
MAV 56,8,148
TR 44,6,50784
TR 46,6,51296
MAV 60,12,148
TR 56,6,59200
MAV 60,28,156
buffer_load_dwordx4 v[132:135], v4, s[16:19], s52 offen offset:1024 sc1
MAV 44,28,152
TR 58,6,59712
MAV 44,12,144
TR 60,6,59232
TR 62,6,59744
v_add_u32 v7, s57, v7
v_add_u32 v6, s57, v6
s_sub_u32 s57, 0, s57
s_waitcnt lgkmcnt(8)
MAV 64,32,144
ds_read_b64_tr_b16 a[0:1], v7
s_add_u32 m0, s55, 42240
MAV 64,48,152
buffer_load_dwordx4 v18, s[28:31], s54 offen lds
MAV 80,48,156
TR 2,7,512
MAV 80,32,148
TR 4,7,32
TR 6,7,544
MAV 84,36,148
TR 16,7,8448
s_add_u32 s52, s78, 770048
MAV 84,52,156
buffer_load_dwordx4 v[136:139], v4, s[16:19], s52 offen sc1
MAV 68,52,152
TR 18,7,8960
MAV 68,36,144
TR 20,7,8480
TR 22,7,8992
s_waitcnt lgkmcnt(8)
MAV 72,40,144
TR 8,7,64
MAV 72,56,152
buffer_load_dwordx4 v19, s[28:31], s54 offen offset:1056 lds
MAV 88,56,156
TR 10,7,576
s_add_u32 s54, s101, 1507328
MAV 88,40,148
TR 12,7,96
TR 14,7,608
MAV 92,44,148
TR 24,7,8512
MAV 92,60,156
buffer_load_dwordx4 v[140:143], v4, s[16:19], s52 offen offset:1024 sc1
MAV 76,60,152
TR 26,7,9024
MAV 76,44,144
TR 28,7,8544
TR 30,7,9056
s_waitcnt vmcnt(16) lgkmcnt(8)
s_barrier
MAV 32,0,96
ds_read_b64_tr_b16 a[32:33], v6
s_add_u32 m0, s55, 50688
MAV 32,16,104
buffer_load_dwordx4 v18, s[28:31], s54 offen lds
MAV 48,16,108
TR 34,6,512
MAV 48,0,100
TR 36,6,32
TR 38,6,544
MAV 52,4,100
TR 48,6,8448
s_add_u32 s52, s79, 819200
MAV 52,20,108
buffer_load_dwordx4 v[144:147], v4, s[16:19], s52 offen sc1
MAV 36,20,104
TR 50,6,8960
MAV 36,4,96
TR 52,6,8480
TR 54,6,8992
s_waitcnt lgkmcnt(8)
MAV 40,8,96
TR 40,6,64
MAV 40,24,104
buffer_load_dwordx4 v19, s[28:31], s54 offen offset:1056 lds
MAV 56,24,108
TR 42,6,576
s_add_u32 s54, s101, 1769472
MAV 56,8,100
TR 44,6,96
TR 46,6,608
MAV 60,12,100
TR 56,6,8512
MAV 60,28,108
buffer_load_dwordx4 v[148:151], v4, s[16:19], s52 offen offset:1024 sc1
MAV 44,28,104
TR 58,6,9024
MAV 44,12,96
TR 60,6,8544
TR 62,6,9056
s_waitcnt lgkmcnt(8)
MAV 64,32,96
TR 0,7,16896
s_add_u32 m0, s55, 59136
MAV 64,48,104
buffer_load_dwordx4 v18, s[28:31], s54 offen lds
MAV 80,48,108
TR 2,7,17408
MAV 80,32,100
TR 4,7,16928
TR 6,7,17440
MAV 84,36,100
TR 16,7,25344
s_add_u32 s52, s79, 884736
MAV 84,52,108
buffer_load_dwordx4 v[152:155], v4, s[16:19], s52 offen sc1
MAV 68,52,104
TR 18,7,25856
MAV 68,36,96
TR 20,7,25376
TR 22,7,25888
s_waitcnt lgkmcnt(8)
MAV 72,40,96
TR 8,7,16960
MAV 72,56,104
buffer_load_dwordx4 v19, s[28:31], s54 offen offset:1056 lds
MAV 88,56,108
TR 10,7,17472
s_add_u32 s54, s98, 1966080
MAV 88,40,100
TR 12,7,16992
TR 14,7,17504
MAV 92,44,100
TR 24,7,25408
MAV 92,60,108
buffer_load_dwordx4 v[156:159], v4, s[16:19], s52 offen offset:1024 sc1
MAV 76,60,104
TR 26,7,25920
MAV 76,44,96
TR 28,7,25440
TR 30,7,25952
s_waitcnt vmcnt(16) lgkmcnt(8)
s_barrier
MAV 32,0,112
TR 32,6,16896
s_add_u32 m0, s55, 67584
MAV 32,16,120
buffer_load_dwordx4 v18, s[28:31], s54 offen lds
MAV 48,16,124
TR 34,6,17408
MAV 48,0,116
TR 36,6,16928
TR 38,6,17440
MAV 52,4,116
TR 48,6,25344
s_add_u32 s52, s76, 32768
MAV 52,20,124
buffer_load_dwordx4 v[96:99], v4, s[16:19], s52 offen sc1
MAV 36,20,120
TR 50,6,25856
MAV 36,4,112
TR 52,6,25376
TR 54,6,25888
s_waitcnt lgkmcnt(8)
MAV 40,8,112
TR 40,6,16960
MAV 40,24,120
buffer_load_dwordx4 v19, s[28:31], s54 offen offset:1056 lds
MAV 56,24,124
TR 42,6,17472
s_add_u32 s54, s98, 2228224
MAV 56,8,116
TR 44,6,16992
TR 46,6,17504
MAV 60,12,116
TR 56,6,25408
MAV 60,28,124
buffer_load_dwordx4 v[100:103], v4, s[16:19], s52 offen offset:1024 sc1
MAV 44,28,120
TR 58,6,25920
MAV 44,12,112
TR 60,6,25440
TR 62,6,25952
s_waitcnt lgkmcnt(8)
MAV 64,32,112
TR 0,7,33792
s_add_u32 m0, s55, 76032
MAV 64,48,120
buffer_load_dwordx4 v18, s[28:31], s54 offen lds
MAV 80,48,124
TR 2,7,34304
MAV 80,32,116
TR 4,7,33824
TR 6,7,34336
MAV 84,36,116
TR 16,7,42240
s_add_u32 s52, s76, 98304
MAV 84,52,124
buffer_load_dwordx4 v[104:107], v4, s[16:19], s52 offen sc1
MAV 68,52,120
TR 18,7,42752
MAV 68,36,112
TR 20,7,42272
TR 22,7,42784
s_waitcnt lgkmcnt(8)
MAV 72,40,112
TR 8,7,33856
MAV 72,56,120
buffer_load_dwordx4 v19, s[28:31], s54 offen offset:1056 lds
MAV 88,56,124
TR 10,7,34368
s_add_u32 s54, s99, 2424832
MAV 88,40,116
TR 12,7,33888
TR 14,7,34400
MAV 92,44,116
TR 24,7,42304
MAV 92,60,124
buffer_load_dwordx4 v[108:111], v4, s[16:19], s52 offen offset:1024 sc1
MAV 76,60,120
TR 26,7,42816
MAV 76,44,112
TR 28,7,42336
TR 30,7,42848
s_waitcnt vmcnt(16) lgkmcnt(8)
s_barrier
MAV 32,0,128
TR 32,6,33792
s_add_u32 m0, s55, 84480
MAV 32,16,136
buffer_load_dwordx4 v18, s[28:31], s54 offen lds
MAV 48,16,140
TR 34,6,34304
MAV 48,0,132
TR 36,6,33824
TR 38,6,34336
MAV 52,4,132
TR 48,6,42240
s_add_u32 s52, s77, 147456
MAV 52,20,140
buffer_load_dwordx4 v[112:115], v4, s[16:19], s52 offen sc1
MAV 36,20,136
TR 50,6,42752
MAV 36,4,128
TR 52,6,42272
TR 54,6,42784
s_waitcnt lgkmcnt(8)
MAV 40,8,128
TR 40,6,33856
MAV 40,24,136
buffer_load_dwordx4 v19, s[28:31], s54 offen offset:1056 lds
MAV 56,24,140
TR 42,6,34368
s_add_u32 s54, s99, 2686976
MAV 56,8,132
TR 44,6,33888
TR 46,6,34400
MAV 60,12,132
TR 56,6,42304
MAV 60,28,140
buffer_load_dwordx4 v[116:119], v4, s[16:19], s52 offen offset:1024 sc1
MAV 44,28,136
TR 58,6,42816
MAV 44,12,128
TR 60,6,42336
TR 62,6,42848
s_waitcnt lgkmcnt(8)
MAV 64,32,128
TR 0,7,50688
s_add_u32 m0, s55, 92928
MAV 64,48,136
buffer_load_dwordx4 v18, s[28:31], s54 offen lds
MAV 80,48,140
TR 2,7,51200
MAV 80,32,132
TR 4,7,50720
TR 6,7,51232
MAV 84,36,132
TR 16,7,59136
s_add_u32 s52, s77, 212992
MAV 84,52,140
buffer_load_dwordx4 v[120:123], v4, s[16:19], s52 offen sc1
MAV 68,52,136
TR 18,7,59648
MAV 68,36,128
TR 20,7,59168
TR 22,7,59680
s_waitcnt lgkmcnt(8)
MAV 72,40,128
TR 8,7,50752
MAV 72,56,136
buffer_load_dwordx4 v19, s[28:31], s54 offen offset:1056 lds
MAV 88,56,140
TR 10,7,51264
s_add_u32 s54, s100, 2883584
MAV 88,40,132
TR 12,7,50784
TR 14,7,51296
MAV 92,44,132
.Lpad30:
s_cbranch_execz .Lnopoll63r
TR 24,7,59200
MAV 92,60,140
buffer_load_dwordx4 v[124:127], v4, s[16:19], s52 offen offset:1024 sc1
MAV 76,60,136
TR 26,7,59712
MAV 76,44,128
TR 28,7,59232
TR 30,7,59744
s_waitcnt vmcnt(16) lgkmcnt(8)
s_barrier
MAV 32,0,144
TR 32,6,50688
s_add_u32 m0, s55, 101376
MAV 32,16,152
buffer_load_dwordx4 v18, s[28:31], s54 offen lds
MAV 48,16,156
TR 34,6,51200
MAV 48,0,148
TR 36,6,50720
TR 38,6,51232
MAV 52,4,148
TR 48,6,59136
s_add_u32 s52, s78, 262144
MAV 52,20,156
buffer_load_dwordx4 v[128:131], v4, s[16:19], s52 offen sc1
MAV 36,20,152
TR 50,6,59648
MAV 36,4,144
TR 52,6,59168
TR 54,6,59680
s_waitcnt lgkmcnt(8)
MAV 40,8,144
TR 40,6,50752
MAV 40,24,152
buffer_load_dwordx4 v19, s[28:31], s54 offen offset:1056 lds
MAV 56,24,156
TR 42,6,51264
s_add_u32 s54, s100, 3145728
MAV 56,8,148
TR 44,6,50784
TR 46,6,51296
MAV 60,12,148
TR 56,6,59200
MAV 60,28,156
buffer_load_dwordx4 v[132:135], v4, s[16:19], s52 offen offset:1024 sc1
MAV 44,28,152
TR 58,6,59712
MAV 44,12,144
TR 60,6,59232
TR 62,6,59744
v_add_u32 v7, s57, v7
v_add_u32 v6, s57, v6
s_sub_u32 s57, 0, s57
s_waitcnt lgkmcnt(8)
MAV 64,32,144
ds_read_b64_tr_b16 a[0:1], v7
s_add_u32 m0, s55, 109824
MAV 64,48,152
buffer_load_dwordx4 v18, s[28:31], s54 offen lds
MAV 80,48,156
TR 2,7,512
MAV 80,32,148
TR 4,7,32
TR 6,7,544
MAV 84,36,148
TR 16,7,8448
s_add_u32 s52, s78, 327680
MAV 84,52,156
buffer_load_dwordx4 v[136:139], v4, s[16:19], s52 offen sc1
MAV 68,52,152
TR 18,7,8960
MAV 68,36,144
TR 20,7,8480
TR 22,7,8992
s_waitcnt lgkmcnt(8)
MAV 72,40,144
TR 8,7,64
MAV 72,56,152
buffer_load_dwordx4 v19, s[28:31], s54 offen offset:1056 lds
MAV 88,56,156
TR 10,7,576
s_add_u32 s54, s101, 3342336
MAV 88,40,148
TR 12,7,96
TR 14,7,608
MAV 92,44,148
TR 24,7,8512
MAV 92,60,156
buffer_load_dwordx4 v[140:143], v4, s[16:19], s52 offen offset:1024 sc1
MAV 76,60,152
TR 26,7,9024
MAV 76,44,144
TR 28,7,8544
TR 30,7,9056
s_waitcnt vmcnt(16) lgkmcnt(8)
s_barrier
MAV 32,0,96
ds_read_b64_tr_b16 a[32:33], v6
s_add_u32 m0, s55, 118272
MAV 32,16,104
buffer_load_dwordx4 v18, s[28:31], s54 offen lds
MAV 48,16,108
TR 34,6,512
MAV 48,0,100
TR 36,6,32
TR 38,6,544
MAV 52,4,100
TR 48,6,8448
s_add_u32 s52, s79, 376832
MAV 52,20,108
buffer_load_dwordx4 v[144:147], v4, s[16:19], s52 offen sc1
MAV 36,20,104
TR 50,6,8960
MAV 36,4,96
TR 52,6,8480
TR 54,6,8992
s_waitcnt lgkmcnt(8)
MAV 40,8,96
TR 40,6,64
MAV 40,24,104
buffer_load_dwordx4 v19, s[28:31], s54 offen offset:1056 lds
MAV 56,24,108
TR 42,6,576
s_add_u32 s54, s101, 3604480
MAV 56,8,100
TR 44,6,96
TR 46,6,608
MAV 60,12,100
TR 56,6,8512
MAV 60,28,108
buffer_load_dwordx4 v[148:151], v4, s[16:19], s52 offen offset:1024 sc1
MAV 44,28,104
TR 58,6,9024
MAV 44,12,96
TR 60,6,8544
TR 62,6,9056
s_waitcnt lgkmcnt(8)
MAV 64,32,96
TR 0,7,16896
s_add_u32 m0, s55, 126720
MAV 64,48,104
buffer_load_dwordx4 v18, s[28:31], s54 offen lds
MAV 80,48,108
TR 2,7,17408
MAV 80,32,100
TR 4,7,16928
TR 6,7,17440
MAV 84,36,100
TR 16,7,25344
s_add_u32 s52, s79, 442368
MAV 84,52,108
buffer_load_dwordx4 v[152:155], v4, s[16:19], s52 offen sc1
MAV 68,52,104
TR 18,7,25856
MAV 68,36,96
TR 20,7,25376
TR 22,7,25888
s_waitcnt lgkmcnt(8)
MAV 72,40,96
TR 8,7,16960
MAV 72,56,104
buffer_load_dwordx4 v19, s[28:31], s54 offen offset:1056 lds
MAV 88,56,108
TR 10,7,17472
s_add_u32 s54, s98, 196608
MAV 88,40,100
TR 12,7,16992
TR 14,7,17504
MAV 92,44,100
TR 24,7,25408
MAV 92,60,108
buffer_load_dwordx4 v[156:159], v4, s[16:19], s52 offen offset:1024 sc1
MAV 76,60,104
TR 26,7,25920
MAV 76,44,96
TR 28,7,25440
TR 30,7,25952
s_waitcnt vmcnt(16) lgkmcnt(8)
s_barrier
MAV 32,0,112
TR 32,6,16896
s_add_u32 m0, s55, 0
MAV 32,16,120
buffer_load_dwordx4 v18, s[28:31], s54 offen lds
MAV 48,16,124
TR 34,6,17408
MAV 48,0,116
TR 36,6,16928
TR 38,6,17440
MAV 52,4,116
TR 48,6,25344
s_add_u32 s52, s76, 491520
MAV 52,20,124
buffer_load_dwordx4 v[96:99], v4, s[16:19], s52 offen sc1
MAV 36,20,120
TR 50,6,25856
MAV 36,4,112
TR 52,6,25376
TR 54,6,25888
s_waitcnt lgkmcnt(8)
MAV 40,8,112
TR 40,6,16960
MAV 40,24,120
buffer_load_dwordx4 v19, s[28:31], s54 offen offset:1056 lds
MAV 56,24,124
TR 42,6,17472
s_add_u32 s54, s99, 655360
MAV 56,8,116
TR 44,6,16992
TR 46,6,17504
MAV 60,12,116
TR 56,6,25408
MAV 60,28,124
buffer_load_dwordx4 v[100:103], v4, s[16:19], s52 offen offset:1024 sc1
MAV 44,28,120
TR 58,6,25920
MAV 44,12,112
TR 60,6,25440
TR 62,6,25952
s_waitcnt lgkmcnt(8)
MAV 64,32,112
TR 0,7,33792
s_add_u32 m0, s55, 8448
MAV 64,48,120
buffer_load_dwordx4 v18, s[28:31], s54 offen lds
MAV 80,48,124
TR 2,7,34304
MAV 80,32,116
TR 4,7,33824
TR 6,7,34336
MAV 84,36,116
TR 16,7,42240
s_add_u32 s52, s76, 557056
MAV 84,52,124
buffer_load_dwordx4 v[104:107], v4, s[16:19], s52 offen sc1
MAV 68,52,120
TR 18,7,42752
MAV 68,36,112
TR 20,7,42272
TR 22,7,42784
s_waitcnt lgkmcnt(8)
MAV 72,40,112
TR 8,7,33856
MAV 72,56,120
buffer_load_dwordx4 v19, s[28:31], s54 offen offset:1056 lds
MAV 88,56,124
TR 10,7,34368
s_add_u32 s54, s100, 1114112
MAV 88,40,116
TR 12,7,33888
TR 14,7,34400
MAV 92,44,116
TR 24,7,42304
MAV 92,60,124
buffer_load_dwordx4 v[108:111], v4, s[16:19], s52 offen offset:1024 sc1
MAV 76,60,120
TR 26,7,42816
MAV 76,44,112
TR 28,7,42336
TR 30,7,42848
s_waitcnt vmcnt(16) lgkmcnt(8)
s_barrier
MAV 32,0,128
TR 32,6,33792
s_add_u32 m0, s55, 16896
MAV 32,16,136
buffer_load_dwordx4 v18, s[28:31], s54 offen lds
MAV 48,16,140
TR 34,6,34304
MAV 48,0,132
TR 36,6,33824
TR 38,6,34336
MAV 52,4,132
TR 48,6,42240
s_add_u32 s52, s77, 606208
MAV 52,20,140
buffer_load_dwordx4 v[112:115], v4, s[16:19], s52 offen sc1
MAV 36,20,136
TR 50,6,42752
MAV 36,4,128
TR 52,6,42272
TR 54,6,42784
s_waitcnt lgkmcnt(8)
MAV 40,8,128
TR 40,6,33856
MAV 40,24,136
buffer_load_dwordx4 v19, s[28:31], s54 offen offset:1056 lds
MAV 56,24,140
TR 42,6,34368
s_add_u32 s54, s101, 1572864
MAV 56,8,132
TR 44,6,33888
TR 46,6,34400
MAV 60,12,132
TR 56,6,42304
MAV 60,28,140
buffer_load_dwordx4 v[116:119], v4, s[16:19], s52 offen offset:1024 sc1
MAV 44,28,136
TR 58,6,42816
MAV 44,12,128
TR 60,6,42336
TR 62,6,42848
s_waitcnt lgkmcnt(8)
MAV 64,32,128
TR 0,7,50688
s_add_u32 m0, s55, 25344
MAV 64,48,136
buffer_load_dwordx4 v18, s[28:31], s54 offen lds
MAV 80,48,140
TR 2,7,51200
MAV 80,32,132
TR 4,7,50720
TR 6,7,51232
MAV 84,36,132
TR 16,7,59136
s_add_u32 s52, s77, 671744
MAV 84,52,140
buffer_load_dwordx4 v[120:123], v4, s[16:19], s52 offen sc1
MAV 68,52,136
TR 18,7,59648
MAV 68,36,128
TR 20,7,59168
TR 22,7,59680
s_waitcnt lgkmcnt(8)
MAV 72,40,128
TR 8,7,50752
MAV 72,56,136
buffer_load_dwordx4 v19, s[28:31], s54 offen offset:1056 lds
MAV 88,56,140
TR 10,7,51264
s_add_u32 s54, s98, 2031616
MAV 88,40,132
TR 12,7,50784
TR 14,7,51296
MAV 92,44,132
TR 24,7,59200
MAV 92,60,140
buffer_load_dwordx4 v[124:127], v4, s[16:19], s52 offen offset:1024 sc1
MAV 76,60,136
TR 26,7,59712
MAV 76,44,128
TR 28,7,59232
TR 30,7,59744
s_waitcnt vmcnt(16) lgkmcnt(8)
s_barrier
MAV 32,0,144
TR 32,6,50688
s_add_u32 m0, s55, 33792
MAV 32,16,152
buffer_load_dwordx4 v18, s[28:31], s54 offen lds
MAV 48,16,156
TR 34,6,51200
MAV 48,0,148
TR 36,6,50720
TR 38,6,51232
MAV 52,4,148
TR 48,6,59136
s_add_u32 s52, s78, 720896
MAV 52,20,156
buffer_load_dwordx4 v[128:131], v4, s[16:19], s52 offen sc1
MAV 36,20,152
TR 50,6,59648
MAV 36,4,144
TR 52,6,59168
TR 54,6,59680
s_waitcnt lgkmcnt(8)
MAV 40,8,144
TR 40,6,50752
MAV 40,24,152
buffer_load_dwordx4 v19, s[28:31], s54 offen offset:1056 lds
MAV 56,24,156
TR 42,6,51264
s_add_u32 s54, s99, 2490368
MAV 56,8,148
TR 44,6,50784
TR 46,6,51296
MAV 60,12,148
TR 56,6,59200
MAV 60,28,156
buffer_load_dwordx4 v[132:135], v4, s[16:19], s52 offen offset:1024 sc1
MAV 44,28,152
TR 58,6,59712
MAV 44,12,144
TR 60,6,59232
TR 62,6,59744
v_add_u32 v7, s57, v7
v_add_u32 v6, s57, v6
s_sub_u32 s57, 0, s57
s_waitcnt lgkmcnt(8)
MAV 64,32,144
ds_read_b64_tr_b16 a[0:1], v7
s_add_u32 m0, s55, 42240
MAV 64,48,152
buffer_load_dwordx4 v18, s[28:31], s54 offen lds
MAV 80,48,156
TR 2,7,512
MAV 80,32,148
TR 4,7,32
TR 6,7,544
MAV 84,36,148
TR 16,7,8448
s_add_u32 s52, s78, 786432
MAV 84,52,156
buffer_load_dwordx4 v[136:139], v4, s[16:19], s52 offen sc1
MAV 68,52,152
TR 18,7,8960
MAV 68,36,144
TR 20,7,8480
TR 22,7,8992
s_waitcnt lgkmcnt(8)
MAV 72,40,144
TR 8,7,64
MAV 72,56,152
buffer_load_dwordx4 v19, s[28:31], s54 offen offset:1056 lds
MAV 88,56,156
TR 10,7,576
s_add_u32 s54, s100, 2949120
MAV 88,40,148
TR 12,7,96
TR 14,7,608
MAV 92,44,148
TR 24,7,8512
MAV 92,60,156
buffer_load_dwordx4 v[140:143], v4, s[16:19], s52 offen offset:1024 sc1
MAV 76,60,152
TR 26,7,9024
MAV 76,44,144
TR 28,7,8544
TR 30,7,9056
s_waitcnt vmcnt(16) lgkmcnt(8)
s_barrier
MAV 32,0,96
ds_read_b64_tr_b16 a[32:33], v6
s_add_u32 m0, s55, 50688
MAV 32,16,104
buffer_load_dwordx4 v18, s[28:31], s54 offen lds
MAV 48,16,108
TR 34,6,512
MAV 48,0,100
TR 36,6,32
TR 38,6,544
MAV 52,4,100
TR 48,6,8448
s_add_u32 s52, s79, 835584
MAV 52,20,108
buffer_load_dwordx4 v[144:147], v4, s[16:19], s52 offen sc1
MAV 36,20,104
TR 50,6,8960
MAV 36,4,96
TR 52,6,8480
TR 54,6,8992
s_waitcnt lgkmcnt(8)
MAV 40,8,96
TR 40,6,64
MAV 40,24,104
buffer_load_dwordx4 v19, s[28:31], s54 offen offset:1056 lds
MAV 56,24,108
TR 42,6,576
s_add_u32 s54, s101, 3407872
MAV 56,8,100
TR 44,6,96
TR 46,6,608
MAV 60,12,100
TR 56,6,8512
MAV 60,28,108
buffer_load_dwordx4 v[148:151], v4, s[16:19], s52 offen offset:1024 sc1
MAV 44,28,104
TR 58,6,9024
MAV 44,12,96
TR 60,6,8544
TR 62,6,9056
s_waitcnt lgkmcnt(8)
MAV 64,32,96
TR 0,6,16896
s_add_u32 m0, s55, 59136
MAV 64,48,104
buffer_load_dwordx4 v18, s[28:31], s54 offen lds
MAV 80,48,108
TR 2,6,17408
MAV 80,32,100
TR 4,6,16928
TR 6,6,17440
MAV 84,36,100
TR 16,6,25344
s_add_u32 s52, s79, 901120
MAV 84,52,108
buffer_load_dwordx4 v[152:155], v4, s[16:19], s52 offen sc1
MAV 68,52,104
TR 18,6,25856
MAV 68,36,96
TR 20,6,25376
TR 22,6,25888
s_waitcnt lgkmcnt(8)
MAV 72,40,96
TR 8,6,16960
MAV 72,56,104
buffer_load_dwordx4 v19, s[28:31], s54 offen offset:1056 lds
MAV 88,56,108
TR 10,6,17472
MAV 88,40,100
TR 12,6,16992
TR 14,6,17504
MAV 92,44,100
TR 24,6,25408
MAV 92,60,108
buffer_load_dwordx4 v[156:159], v4, s[16:19], s52 offen offset:1024 sc1
MAV 76,60,104
TR 26,6,25920
MAV 76,44,96
TR 28,6,25440
TR 30,6,25952
s_waitcnt vmcnt(16) lgkmcnt(8)
MAV 64,0,112
TR 32,6,33792
s_add_u32 s52, s76, 49152
MAV 64,16,120
buffer_load_dwordx4 v[160:163], v4, s[16:19], s52 offen sc1
MAV 80,16,124
TR 34,6,34304
MAV 80,0,116
TR 36,6,33824
TR 38,6,34336
MAV 84,4,116
TR 48,6,42240
MAV 84,20,124
buffer_load_dwordx4 v[164:167], v4, s[16:19], s52 offen offset:1024 sc1
MAV 68,20,120
TR 50,6,42752
MAV 68,4,112
TR 52,6,42272
.Lpad31:
s_cbranch_execz .Lnopoll63r
TR 54,6,42784
s_waitcnt lgkmcnt(8)
MAV 72,8,112
TR 40,6,33856
s_add_u32 s52, s77, 163840
MAV 72,24,120
buffer_load_dwordx4 v[168:171], v4, s[16:19], s52 offen sc1
MAV 88,24,124
TR 42,6,34368
MAV 88,8,116
TR 44,6,33888
TR 46,6,34400
MAV 92,12,116
TR 56,6,42304
MAV 92,28,124
buffer_load_dwordx4 v[172:175], v4, s[16:19], s52 offen offset:1024 sc1
MAV 76,28,120
TR 58,6,42816
MAV 76,12,112
TR 60,6,42336
TR 62,6,42848
s_waitcnt vmcnt(12) lgkmcnt(8)
MAV 64,32,128
TR 0,6,50688
s_add_u32 s52, s78, 278528
s_lshl_b32 s70, s2, 10
s_lshl_b32 s62, s3, 7
MAV 64,48,136
buffer_load_dwordx4 v[176:179], v4, s[16:19], s52 offen sc1
s_add_u32 s70, s70, s62
MAV 80,48,140
TR 2,6,51200
s_add_u32 s70, s70, 31457792
MAV 80,32,132
TR 4,6,50720
TR 6,6,51232
s_xor_b32 s71, s70, 1024
MAV 84,36,132
TR 16,6,59136
v_min_u32 v12, 1, v1
v_lshlrev_b32 v12, 28, v12
MAV 84,52,140
buffer_load_dwordx4 v[180:183], v4, s[16:19], s52 offen offset:1024 sc1
v_mov_b32 v13, 1
MAV 68,52,136
TR 18,6,59648
v_mov_b32 v15, 0
s_lshl_b32 s68, s7, 18
MAV 68,36,128
TR 20,6,59168
TR 22,6,59680
s_waitcnt lgkmcnt(8)
MAV 72,40,128
TR 8,6,50752
s_add_u32 s52, s79, 393216
s_add_u32 s68, s68, 146800640
s_xor_b32 s69, s68, 262144
MAV 72,56,136
buffer_load_dwordx4 v[184:187], v4, s[16:19], s52 offen sc1
v_mov_b32 v11, v4
MAV 88,56,140
TR 10,6,51264
v_and_b32 v2, 1, v1
MAV 88,40,132
TR 12,6,50784
TR 14,6,51296
v_lshlrev_b32 v2, 4, v2
MAV 92,44,132
TR 24,6,59200
v_mov_b32 v224, 0x3f80
v_lshlrev_b32 v2, v2, v224
MAV 92,60,140
buffer_load_dwordx4 v[188:191], v4, s[16:19], s52 offen offset:1024 sc1
v_bfe_u32 v224, v1, 2, 2
MAV 76,60,136
TR 26,6,59712
v_lshrrev_b32 v225, 4, v1
v_cmp_eq_u32 vcc, v224, v225
MAV 76,44,128
TR 28,6,59232
TR 30,6,59744
s_waitcnt vmcnt(8) lgkmcnt(8)
s_barrier
v_add_u32 v6, s57, v6
MAV 64,0,144
ds_read_b64_tr_b16 a[32:33], v6
s_add_u32 s52, s76, 507904
v_cndmask_b32 v2, 0, v2, vcc
v_and_b32 v224, 2, v1
MAV 64,16,152
buffer_load_dwordx4 v[192:195], v4, s[16:19], s52 offen sc1
v_cmp_eq_u32 vcc, 0, v224
MAV 80,16,156
TR 34,6,512
v_cndmask_b32 v226, 0, v2, vcc
MAV 80,0,148
TR 36,6,32
TR 38,6,544
v_cndmask_b32 v227, v2, 0, vcc
MAV 84,4,148
TR 48,6,8448
v_mov_b32 v224, 0
v_mov_b32 v225, 0
MAV 84,20,156
buffer_load_dwordx4 v[196:199], v4, s[16:19], s52 offen offset:1024 sc1
v_mov_b32 v228, 0
MAV 68,20,152
TR 50,6,8960
v_mov_b32 v229, 0
s_lshr_b32 s62, s6, 1
MAV 68,4,144
TR 52,6,8480
TR 54,6,8992
s_waitcnt lgkmcnt(8)
MAV 72,8,144
TR 40,6,64
s_add_u32 s52, s77, 622592
s_lshl_b32 s62, s62, 8
s_and_b32 s67, s6, 1
MAV 72,24,152
buffer_load_dwordx4 v[200:203], v4, s[16:19], s52 offen sc1
s_add_u32 s62, s62, s67
MAV 88,24,156
TR 42,6,576
s_lshl_b32 s62, s62, 11
MAV 88,8,148
TR 44,6,96
TR 46,6,608
s_lshl_b32 s63, s3, 17
MAV 92,12,148
TR 56,6,8512
s_add_u32 s62, s62, s63
s_lshl_b32 s63, s7, 7
MAV 92,28,156
buffer_load_dwordx4 v[204:207], v4, s[16:19], s52 offen offset:1024 sc1
s_add_u32 s62, s62, s63
MAV 76,28,152
TR 58,6,9024
s_mov_b32 s64, 0x8000
v_lshrrev_b32 v21, 3, v1
MAV 76,12,144
TR 60,6,8544
TR 62,6,9056
s_waitcnt vmcnt(8) lgkmcnt(8)
MAV 64,32,160
TR 0,6,16896
s_add_u32 s52, s78, 737280
v_and_b32 v2, 7, v1
v_lshlrev_b32 v2, 4, v2
MAV 64,48,168
buffer_load_dwordx4 v[208:211], v4, s[16:19], s52 offen sc1
v_lshl_add_u32 v16, v21, 12, v2
MAV 80,48,172
TR 2,6,17408
v_add_u32 v16, s62, v16
MAV 80,32,164
TR 4,6,16928
TR 6,6,17440
v_add_u32 v17, 0x10000, v16
MAV 84,36,164
TR 16,6,25344
s_mul_i32 s62, s3, 4608
s_add_u32 s62, s62, 135168
MAV 84,52,172
buffer_load_dwordx4 v[212:215], v4, s[16:19], s52 offen offset:1024 sc1
v_mul_u32_u24 v21, 144, v21
MAV 68,52,168
TR 18,6,25856
v_add3_u32 v21, v21, v2, s62
v_and_b32 v20, 15, v1
MAV 68,36,160
TR 20,6,25376
TR 22,6,25888
s_waitcnt lgkmcnt(8)
MAV 72,40,160
TR 8,6,16960
s_add_u32 s52, s79, 851968
v_mul_u32_u24 v20, 144, v20
v_lshrrev_b32 v2, 4, v1
MAV 72,56,168
buffer_load_dwordx4 v[216:219], v4, s[16:19], s52 offen sc1
v_lshlrev_b32 v2, 3, v2
MAV 88,56,172
TR 10,6,17472
v_add3_u32 v20, v20, v2, s62
MAV 88,40,164
TR 12,6,16992
TR 14,6,17504
v_accvgpr_read_b32 v28, a224
MAV 92,44,164
TR 24,6,25408
v_add_f32 v32, v32, v28
v_accvgpr_read_b32 v29, a225
MAV 92,60,172
buffer_load_dwordx4 v[220:223], v4, s[16:19], s52 offen offset:1024 sc1
v_add_f32 v33, v33, v29
MAV 76,60,168
TR 26,6,25920
v_accvgpr_read_b32 v28, a226
v_add_f32 v34, v34, v28
MAV 76,44,160
TR 28,6,25440
TR 30,6,25952
s_waitcnt vmcnt(8) lgkmcnt(8)
MAV 64,0,176
TR 32,6,33792
v_accvgpr_read_b32 v29, a227
MAV 64,16,184
TR 34,6,34304
v_add_f32 v35, v35, v29
v_accvgpr_read_b32 v28, a228
MAV 80,16,188
TR 36,6,33824
v_add_f32 v36, v36, v28
MAV 80,0,180
TR 38,6,34336
v_accvgpr_read_b32 v29, a229
v_add_f32 v37, v37, v29
MAV 84,4,180
TR 48,6,42240
v_accvgpr_read_b32 v28, a230
MAV 84,20,188
TR 50,6,42752
v_add_f32 v38, v38, v28
MAV 68,20,184
TR 52,6,42272
v_accvgpr_read_b32 v29, a231
MAV 68,4,176
TR 54,6,42784
v_add_f32 v39, v39, v29
s_waitcnt lgkmcnt(8)
MAV 72,8,176
TR 40,6,33856
v_accvgpr_read_b32 v28, a232
MAV 72,24,184
TR 42,6,34368
v_add_f32 v40, v40, v28
v_accvgpr_read_b32 v29, a233
MAV 88,24,188
TR 44,6,33888
v_add_f32 v41, v41, v29
MAV 88,8,180
TR 46,6,34400
v_accvgpr_read_b32 v28, a234
MAV 92,12,180
TR 56,6,42304
v_add_f32 v42, v42, v28
MAV 92,28,188
TR 58,6,42816
v_accvgpr_read_b32 v29, a235
v_add_f32 v43, v43, v29
MAV 76,28,184
TR 60,6,42336
v_accvgpr_read_b32 v28, a236
MAV 76,12,176
TR 62,6,42848
v_add_f32 v44, v44, v28
s_waitcnt vmcnt(4) lgkmcnt(8)
MAV 64,32,192
TR 0,6,50688
v_accvgpr_read_b32 v29, a237
MAV 64,48,200
TR 2,6,51200
v_add_f32 v45, v45, v29
v_accvgpr_read_b32 v28, a238
MAV 80,48,204
TR 4,6,50720
v_add_f32 v46, v46, v28
MAV 80,32,196
TR 6,6,51232
v_accvgpr_read_b32 v29, a239
v_add_f32 v47, v47, v29
MAV 84,36,196
TR 16,6,59136
v_accvgpr_read_b32 v28, a240
MAV 84,52,204
TR 18,6,59648
v_add_f32 v48, v48, v28
MAV 68,52,200
TR 20,6,59168
v_accvgpr_read_b32 v29, a241
MAV 68,36,192
TR 22,6,59680
v_add_f32 v49, v49, v29
s_waitcnt lgkmcnt(8)
MAV 72,40,192
TR 8,6,50752
v_accvgpr_read_b32 v28, a242
MAV 72,56,200
TR 10,6,51264
v_add_f32 v50, v50, v28
v_accvgpr_read_b32 v29, a243
MAV 88,56,204
TR 12,6,50784
v_add_f32 v51, v51, v29
MAV 88,40,196
TR 14,6,51296
v_accvgpr_read_b32 v28, a244
MAV 92,44,196
TR 24,6,59200
v_add_f32 v52, v52, v28
MAV 92,60,204
TR 26,6,59712
v_accvgpr_read_b32 v29, a245
v_add_f32 v53, v53, v29
MAV 76,60,200
TR 28,6,59232
v_accvgpr_read_b32 v28, a246
MAV 76,44,192
TR 30,6,59744
v_add_f32 v54, v54, v28
s_waitcnt vmcnt(0) lgkmcnt(8)
MAV 64,0,208
TR 32,7,16896
v_accvgpr_read_b32 v29, a247
MAV 64,16,216
TR 34,7,17408
v_add_f32 v55, v55, v29
v_accvgpr_read_b32 v28, a248
MAV 80,16,220
TR 36,7,16928
v_add_f32 v56, v56, v28
MAV 80,0,212
TR 38,7,17440
v_accvgpr_read_b32 v29, a249
MAV 84,4,212
TR 48,7,25344
v_add_f32 v57, v57, v29
MAV 84,20,220
TR 50,7,25856
v_accvgpr_read_b32 v28, a250
v_add_f32 v58, v58, v28
MAV 68,20,216
TR 52,7,25376
MAV 68,4,208
TR 54,7,25888
v_accvgpr_read_b32 v29, a251
s_waitcnt lgkmcnt(8)
MAV 72,8,208
TR 40,7,16960
v_add_f32 v59, v59, v29
MAV 72,24,216
TR 42,7,17472
v_accvgpr_read_b32 v28, a252
MAV 88,24,220
TR 44,7,16992
v_add_f32 v60, v60, v28
MAV 88,8,212
TR 46,7,17504
v_accvgpr_read_b32 v29, a253
v_add_f32 v61, v61, v29
MAV 92,12,212
TR 56,7,25408
v_accvgpr_read_b32 v28, a254
MAV 92,28,220
TR 58,7,25920
v_add_f32 v62, v62, v28
MAV 76,28,216
TR 60,7,25440
v_accvgpr_read_b32 v29, a255
MAV 76,12,208
TR 62,7,25952
v_add_f32 v63, v63, v29
s_waitcnt lgkmcnt(8)
MAV 32,32,112
TR 0,7,33792
v_cvt_pk_bf16_f32 v232, v64, v65
MAV 32,48,120
TR 2,7,34304
v_cvt_pk_bf16_f32 v233, v66, v67
v_cvt_pk_bf16_f32 v234, v68, v69
MAV 48,48,124
TR 4,7,33824
v_cvt_pk_bf16_f32 v235, v70, v71
MAV 48,32,116
TR 6,7,34336
buffer_store_dwordx4 v[232:235], v11, s[16:19], s69 offen sc1
s_add_u32 s69, s69, 131072
MAV 52,36,116
TR 16,7,42240
v_cvt_pk_bf16_f32 v236, v72, v73
MAV 52,52,124
TR 18,7,42752
v_cvt_pk_bf16_f32 v237, v74, v75
v_cvt_pk_bf16_f32 v238, v76, v77
MAV 36,52,120
TR 20,7,42272
v_cvt_pk_bf16_f32 v239, v78, v79
MAV 36,36,112
TR 22,7,42784
buffer_store_dwordx4 v[236:239], v11, s[16:19], s69 offen sc1
s_waitcnt lgkmcnt(8)
MAV 40,40,112
TR 8,7,33856
s_add_u32 s69, s69, -130048
MAV 40,56,120
TR 10,7,34368
v_cvt_pk_bf16_f32 v240, v80, v81
v_cvt_pk_bf16_f32 v241, v82, v83
MAV 56,56,124
TR 12,7,33888
v_cvt_pk_bf16_f32 v242, v84, v85
MAV 56,40,116
TR 14,7,34400
v_cvt_pk_bf16_f32 v243, v86, v87
buffer_store_dwordx4 v[240:243], v11, s[16:19], s69 offen sc1
MAV 60,44,116
TR 24,7,42304
s_add_u32 s69, s69, 131072
MAV 60,60,124
TR 26,7,42816
v_cvt_pk_bf16_f32 v244, v88, v89
v_cvt_pk_bf16_f32 v245, v90, v91
MAV 44,60,120
TR 28,7,42336
v_cvt_pk_bf16_f32 v246, v92, v93
MAV 44,44,112
TR 30,7,42848
v_cvt_pk_bf16_f32 v247, v94, v95
buffer_store_dwordx4 v[244:247], v11, s[16:19], s69 offen sc1
s_waitcnt lgkmcnt(8)
MAV 32,0,128
TR 32,7,50688
MAV 32,16,136
TR 34,7,51200
MAV 48,16,140
TR 36,7,50720
MAV 48,0,132
TR 38,7,51232
MAV 52,4,132
TR 48,7,59136
MAV 52,20,140
TR 50,7,59648
MAV 36,20,136
TR 52,7,59168
MAV 36,4,128
TR 54,7,59680
s_waitcnt lgkmcnt(8)
MAV 40,8,128
TR 40,7,50752
MAV 40,24,136
TR 42,7,51264
MAV 56,24,140
TR 44,7,50784
MAV 56,8,132
TR 46,7,51296
MAV 60,12,132
TR 56,7,59200
MAV 60,28,140
TR 58,7,59712
MAV 44,28,136
TR 60,7,59232
MAV 44,12,128
TR 62,7,59744
v_add_u32 v7, s57, v7
s_waitcnt lgkmcnt(8)
MAV 32,32,144
ds_read_b64_tr_b16 a[0:1], v7
MAV 32,48,152
TR 2,7,512
MAV 48,48,156
TR 4,7,32
MAV 48,32,148
TR 6,7,544
MAV 52,36,148
TR 16,7,8448
MAV 52,52,156
TR 18,7,8960
MAV 36,52,152
TR 20,7,8480
MAV 36,36,144
TR 22,7,8992
s_waitcnt lgkmcnt(8)
MAV 40,40,144
TR 8,7,64
MAV 40,56,152
TR 10,7,576
MAV 56,56,156
TR 12,7,96
MAV 56,40,148
TR 14,7,608
MAV 60,44,148
TR 24,7,8512
MAV 60,60,156
TR 26,7,9024
MAV 44,60,152
TR 28,7,8544
MAV 44,44,144
TR 30,7,9056
s_waitcnt lgkmcnt(8)
MAV 32,0,160
TR 32,7,16896
MAV 32,16,168
s_waitcnt vmcnt(0)
buffer_atomic_add v13, v12, s[16:19], s71 offen
MAV 48,16,172
TR 34,7,17408
MAV 48,0,164
TR 36,7,16928
TR 38,7,17440
MAV 52,4,164
MAV 52,20,172
TR 48,7,25344
TR 50,7,25856
MAV 36,20,168
TR 52,7,25376
MAV 36,4,160
s_waitcnt lgkmcnt(7)
MAV 40,8,160
TR 54,7,25888
MAV 40,24,168
TR 40,7,16960
TR 42,7,17472
MAV 56,24,172
MAV 56,8,164
TR 44,7,16992
TR 46,7,17504
MAV 60,12,164
TR 56,7,25408
MAV 60,28,172
TR 58,7,25920
MAV 44,28,168
TR 60,7,25440
MAV 44,12,160
TR 62,7,25952
s_waitcnt lgkmcnt(8)
MAV 32,32,176
TR 0,7,33792
MAV 32,48,184
buffer_atomic_add v15, v12, s[16:19], s70 offen sc0
MAV 48,48,188
TR 2,7,34304
MAV 48,32,180
TR 4,7,33824
TR 6,7,34336
MAV 52,36,180
MAV 52,52,188
TR 16,7,42240
TR 18,7,42752
MAV 36,52,184
TR 20,7,42272
MAV 36,36,176
s_waitcnt lgkmcnt(7)
MAV 40,40,176
TR 22,7,42784
MAV 40,56,184
TR 8,7,33856
TR 10,7,34368
MAV 56,56,188
MAV 56,40,180
TR 12,7,33888
TR 14,7,34400
MAV 60,44,180
TR 24,7,42304
MAV 60,60,188
TR 26,7,42816
MAV 44,60,184
TR 28,7,42336
MAV 44,44,176
TR 30,7,42848
.Lpad32:
s_cbranch_execz .Lnopoll63r
s_waitcnt vmcnt(0)
v_cmp_ne_u32 vcc, 0, v15
s_nop 0
s_cbranch_vccz .Lxs68
.Lxs68b:
s_waitcnt lgkmcnt(8)
MAV 32,0,192
TR 32,7,50688
MAV 32,16,200
buffer_load_dwordx4 v[232:235], v11, s[16:19], s68 offen sc1
MAV 48,16,204
TR 34,7,51200
s_add_u32 s68, s68, 131072
MAV 48,0,196
TR 36,7,50720
TR 38,7,51232
MAV 52,4,196
TR 48,7,59136
MAV 52,20,204
buffer_load_dwordx4 v[236:239], v11, s[16:19], s68 offen sc1
MAV 36,20,200
TR 50,7,59648
s_add_u32 s68, s68, -130048
MAV 36,4,192
TR 52,7,59168
TR 54,7,59680
s_waitcnt lgkmcnt(8)
MAV 40,8,192
TR 40,7,50752
MAV 40,24,200
buffer_load_dwordx4 v[240:243], v11, s[16:19], s68 offen sc1
MAV 56,24,204
TR 42,7,51264
s_add_u32 s68, s68, 131072
MAV 56,8,196
TR 44,7,50784
TR 46,7,51296
MAV 60,12,196
TR 56,7,59200
MAV 60,28,204
buffer_load_dwordx4 v[244:247], v11, s[16:19], s68 offen sc1
MAV 44,28,200
TR 58,7,59712
MAV 44,12,192
TR 60,7,59232
TR 62,7,59744
s_waitcnt lgkmcnt(8)
MAV 32,32,208
MAV 32,48,216
MAV 48,48,220
MAV 48,32,212
MAV 52,36,212
MAV 52,52,220
MAV 36,52,216
MAV 36,36,208
s_waitcnt lgkmcnt(0)
MAV 40,40,208
MAV 40,56,216
MAV 56,56,220
MAV 56,40,212
MAV 60,44,212
MAV 60,60,220
MAV 44,60,216
MAV 44,44,208
s_waitcnt vmcnt(3)
v_mfma_f32_16x16x32_bf16 v[32:35], v[226:229], v[232:235], v[32:35]
v_mfma_f32_16x16x32_bf16 v[36:39], v[224:227], v[232:235], v[36:39]
s_waitcnt vmcnt(2)
v_mfma_f32_16x16x32_bf16 v[40:43], v[226:229], v[236:239], v[40:43]
v_mfma_f32_16x16x32_bf16 v[44:47], v[224:227], v[236:239], v[44:47]
s_waitcnt vmcnt(1)
v_mfma_f32_16x16x32_bf16 v[48:51], v[226:229], v[240:243], v[48:51]
v_mfma_f32_16x16x32_bf16 v[52:55], v[224:227], v[240:243], v[52:55]
s_waitcnt vmcnt(0)
v_mfma_f32_16x16x32_bf16 v[56:59], v[226:229], v[244:247], v[56:59]
v_cvt_pk_bf16_f32 v128, v32, v33
v_mfma_f32_16x16x32_bf16 v[60:63], v[224:227], v[244:247], v[60:63]
v_cvt_pk_bf16_f32 v129, v34, v35
ds_write_b64 v20, v[128:129]
v_cvt_pk_bf16_f32 v130, v36, v37
v_cvt_pk_bf16_f32 v131, v38, v39
ds_write_b64 v20, v[130:131] offset:32
v_cvt_pk_bf16_f32 v132, v40, v41
v_cvt_pk_bf16_f32 v133, v42, v43
ds_write_b64 v20, v[132:133] offset:64
v_cvt_pk_bf16_f32 v134, v44, v45
v_cvt_pk_bf16_f32 v135, v46, v47
ds_write_b64 v20, v[134:135] offset:96
ds_read_b128 v[144:147], v21
ds_read_b128 v[148:151], v21 offset:1152
v_cvt_pk_bf16_f32 v136, v48, v49
v_cvt_pk_bf16_f32 v137, v50, v51
ds_write_b64 v20, v[136:137] offset:2304
v_cvt_pk_bf16_f32 v138, v52, v53
v_cvt_pk_bf16_f32 v139, v54, v55
ds_write_b64 v20, v[138:139] offset:2336
v_cvt_pk_bf16_f32 v140, v56, v57
v_cvt_pk_bf16_f32 v141, v58, v59
ds_write_b64 v20, v[140:141] offset:2368
v_cvt_pk_bf16_f32 v142, v60, v61
v_cvt_pk_bf16_f32 v143, v62, v63
ds_write_b64 v20, v[142:143] offset:2400
ds_read_b128 v[152:155], v21 offset:2304
ds_read_b128 v[156:159], v21 offset:3456
s_waitcnt lgkmcnt(7)
buffer_store_dwordx4 v[144:147], v16, s[36:39], 0 offen sc1
s_waitcnt lgkmcnt(6)
buffer_store_dwordx4 v[148:151], v16, s[36:39], s64 offen sc1
s_waitcnt lgkmcnt(1)
buffer_store_dwordx4 v[152:155], v17, s[36:39], 0 offen sc1
s_waitcnt lgkmcnt(0)
buffer_store_dwordx4 v[156:159], v17, s[36:39], s64 offen sc1
s_nop 1
.Lend:
s_endpgm
.Lsp67:
s_mov_b32 s15, 0
.Lsp67l:
v_mov_b32 v25, 0
buffer_atomic_add v25, v22, s[16:19], s73 offen sc0
s_add_u32 s15, s15, 1
s_cmp_gt_u32 s15, 100000
s_waitcnt vmcnt(0)
s_cbranch_scc1 .Lsp67b
v_cmp_gt_u32 vcc, v23, v25
s_nop 0
s_cbranch_vccnz .Lsp67l
s_branch .Lsp67b
.Lxs68:
s_mov_b32 s15, 0
.Lxs68l:
v_mov_b32 v15, 0
buffer_atomic_add v15, v12, s[16:19], s70 offen sc0
s_add_u32 s15, s15, 1
s_cmp_gt_u32 s15, 100000
s_waitcnt vmcnt(0)
s_cbranch_scc1 .Lxs68b
v_cmp_ne_u32 vcc, 0, v15
s_nop 0
s_cbranch_vccz .Lxs68l
s_branch .Lxs68b
.section .rodata,"a"
.p2align 6
.amdhsa_kernel interleave_layers__sliding_local_dilated__swiglu_ffn__prompt_kernel
  .amdhsa_next_free_vgpr 512
  .amdhsa_next_free_sgpr 102
  .amdhsa_accum_offset 256
  .amdhsa_group_segment_fixed_size 0
  .amdhsa_kernarg_size 80
  .amdhsa_user_sgpr_count 2
  .amdhsa_user_sgpr_kernarg_segment_ptr 1
  .amdhsa_system_sgpr_workgroup_id_x 1
  .amdhsa_float_denorm_mode_32 3
.end_amdhsa_kernel
```

```asm
; @launch grid=(256,1,1) block=(256,1,1) lds=162560
.amdgcn_target "amdgcn-amd-amdhsa--gfx950"
.macro MAA d,a,b
v_mfma_f32_16x16x32_bf16 v[\d:\d+3], a[\a:\a+3], a[\b:\b+3], v[\d:\d+3]
.endm
.macro MAV d,a,b
v_mfma_f32_16x16x32_bf16 v[\d:\d+3], a[\a:\a+3], v[\b:\b+3], v[\d:\d+3]
.endm
.macro TR d,v,o
ds_read_b64_tr_b16 a[\d:\d+1], v\v offset:\o
.endm
.macro RD d,v,o
ds_read_b128 a[\d:\d+3], v\v offset:\o
.endm
.text
.globl interleave_layers__sliding_local_dilated__swiglu_ffn__prompt_kernel
.p2align 8
.type interleave_layers__sliding_local_dilated__swiglu_ffn__prompt_kernel,@function
interleave_layers__sliding_local_dilated__swiglu_ffn__prompt_kernel:
s_load_dwordx4 s[68:71], s[0:1], 0
s_load_dwordx2 s[72:73], s[0:1], 16
s_load_dwordx8 s[76:83], s[0:1], 32
s_load_dwordx4 s[84:87], s[0:1], 64
s_cmp_lt_u32 s2, 256
s_cbranch_scc1 .Lgo
s_endpgm
.p2align 12
.Lgo:
v_lshrrev_b32 v2, 6, v0
v_and_b32 v1, 63, v0
v_readfirstlane_b32 s3, v2
s_and_b32 s4, s2, 7
s_lshr_b32 s5, s2, 3
s_lshr_b32 s8, s4, 2
s_lshl_b32 s8, s8, 3
s_and_b32 s62, s5, 7
s_add_u32 s8, s8, s62
s_and_b32 s9, s4, 3
s_lshl_b32 s9, s9, 2
s_lshr_b32 s62, s5, 3
s_add_u32 s9, s9, s62
s_and_b32 s48, s3, 1
s_lshr_b32 s49, s3, 1
s_lshl_b32 s50, s8, 3
s_sub_u32 s50, s50, 9
s_cmp_lt_u32 s8, 2
s_cselect_b32 s50, 7, s50
v_bfe_u32 v18, v1, 3, 1
v_bfe_u32 v2, v1, 5, 1
v_lshl_add_u32 v18, v2, 2, v18
v_and_b32 v2, 16, v1
v_add_u32 v18, v18, v2
s_lshl_b32 s62, s49, 2
s_add_u32 s62, s62, s48
s_lshl_b32 s62, s62, 1
v_add_u32 v18, s62, v18
v_mul_u32_u24 v18, 6144, v18
v_and_b32 v2, 7, v1
v_lshl_add_u32 v18, v2, 4, v18
s_lshl_b32 s62, s9, 7
v_add_u32 v18, s62, v18
v_add_u32 v19, 1024, v18
v_add_u32 v20, 2048, v18
s_mul_i32 s59, s3, 3104
s_mov_b32 s58, 0
s_lshr_b32 s62, s8, 1
s_lshl_b32 s62, s62, 8
s_and_b32 s67, s8, 1
s_add_u32 s62, s62, s67
s_lshl_b32 s62, s62, 11
s_lshl_b32 s63, s3, 17
s_add_u32 s62, s62, s63
v_lshrrev_b32 v2, 4, v1
v_xor_b32 v2, v2, v1
v_and_b32 v2, 7, v2
v_lshlrev_b32 v2, 4, v2
v_lshrrev_b32 v21, 3, v1
v_lshl_add_u32 v21, v21, 12, v2
v_add_u32 v21, s62, v21
v_xor_b32 v28, 64, v21
v_add_u32 v28, 31744, v28
s_lshr_b32 s63, s50, 3
s_lshr_b32 s62, s63, 1
s_lshl_b32 s62, s62, 8
s_and_b32 s67, s63, 1
s_add_u32 s62, s62, s67
s_lshl_b32 s62, s62, 11
s_lshl_b32 s63, s3, 14
s_add_u32 s62, s62, s63
s_add_u32 s62, s62, 456704
s_lshl_b32 s63, s3, 5
v_and_b32 v2, 31, v1
v_lshlrev_b32 v2, 2, v2
v_xor_b32 v2, s63, v2
v_lshrrev_b32 v22, 5, v1
v_lshl_add_u32 v22, v22, 12, v2
v_add_u32 v22, s62, v22
v_xor_b32 v29, 16, v22
v_add_u32 v29, -57344, v29
s_mov_b32 s52, 0
s_mov_b32 s53, 65536
s_mul_i32 s55, s3, 4608
s_mov_b32 s54, 0
s_mul_i32 s56, s3, 3104
s_waitcnt lgkmcnt(0)
s_mov_b32 s36, s68
s_mov_b32 s37, s69
s_mov_b32 s38, 4194304
s_mov_b32 s39, 0x20000
s_mov_b32 s20, s70
s_mov_b32 s21, s71
s_mov_b32 s22, 6291456
s_mov_b32 s23, 0x20000
s_lshr_b32 s6, s4, 1
s_lshl_b32 s6, s6, 2
s_and_b32 s62, s5, 3
s_add_u32 s6, s6, s62
s_and_b32 s7, s4, 1
s_lshr_b32 s62, s5, 2
s_lshl_b32 s62, s62, 1
s_add_u32 s7, s7, s62
s_lshr_b32 s62, s6, 1
s_lshl_b32 s62, s62, 8
s_and_b32 s63, s6, 1
s_add_u32 s62, s62, s63
s_lshl_b32 s63, s3, 6
s_add_u32 s62, s62, s63
s_lshl_b32 s62, s62, 11
s_lshl_b32 s63, s7, 7
s_add_u32 s62, s62, s63
v_and_b32 v228, 15, v1
v_lshlrev_b32 v228, 12, v228
v_bfe_u32 v2, v1, 4, 1
v_lshl_add_u32 v228, v2, 5, v228
v_bfe_u32 v2, v1, 5, 1
v_lshl_add_u32 v228, v2, 4, v228
v_add_u32 v228, s62, v228
v_add_u32 v229, 0x10000, v228
s_sub_u32 s64, s3, 1
s_max_i32 s64, s64, 0
s_lshl_b32 s64, s64, 11
s_lshl_b32 s66, s9, 7
s_add_u32 s66, s66, s64
s_cmp_eq_u32 s3, 1
s_cselect_b32 s66, 8388608, s66
s_mul_i32 s65, s8, 122880
s_add_u32 s65, s65, s66
v_lshrrev_b32 v9, 1, v1
v_min_u32 v9, 19, v9
v_mul_u32_u24 v9, 6144, v9
s_mov_b32 s16, s86
s_mov_b32 s17, s87
s_mov_b32 s18, 268435456
s_mov_b32 s19, 0x20000
s_xor_b32 s14, s3, 3
s_lshl_b32 s14, s14, 8
s_add_u32 s14, s14, s2
v_lshlrev_b32 v230, 4, v1
v_mov_b64 v[224:225], 0
v_mov_b64 v[226:227], 0
s_cmp_ge_u32 s14, 16
s_cbranch_scc1 .Lz3
s_lshl_b32 s62, s2, 13
s_add_u32 s62, s62, 30408704
s_add_u32 s63, s62, 4096
buffer_store_dwordx4 v[224:227], v230, s[16:19], s62 offen sc1
buffer_store_dwordx4 v[224:227], v230, s[16:19], s62 offen offset:1024 sc1
buffer_store_dwordx4 v[224:227], v230, s[16:19], s62 offen offset:2048 sc1
buffer_store_dwordx4 v[224:227], v230, s[16:19], s62 offen offset:3072 sc1
buffer_store_dwordx4 v[224:227], v230, s[16:19], s63 offen sc1
buffer_store_dwordx4 v[224:227], v230, s[16:19], s63 offen offset:1024 sc1
buffer_store_dwordx4 v[224:227], v230, s[16:19], s63 offen offset:2048 sc1
buffer_store_dwordx4 v[224:227], v230, s[16:19], s63 offen offset:3072 sc1
.Lz3:
buffer_load_dwordx4 v[164:167], v228, s[36:39], 0 offen
buffer_load_dwordx4 v[168:171], v228, s[36:39], 0 offen offset:64
buffer_load_dwordx4 v[172:175], v229, s[36:39], 0 offen
buffer_load_dwordx4 v[176:179], v229, s[36:39], 0 offen offset:64
buffer_load_dword v58, v9, s[20:23], s65 offen
s_mov_b32 s40, s84
s_mov_b32 s41, s85
s_mov_b32 s42, 256
s_mov_b32 s43, 0x20000
s_getpc_b64 s[62:63]
.Lpc:
s_lshl_b32 s64, s5, 12
v_lshrrev_b32 v59, 3, v0
v_lshl_add_u32 v59, v59, 7, s64
v_add_u32 v2, 0x20000, v59
v_min_u32 v2, .Lend-.Lpc, v2
v_min_u32 v59, .Lend-.Lpc, v59
global_load_dword v59, v59, s[62:63]
global_load_dword v58, v2, s[62:63]
s_mov_b32 s24, s72
s_mov_b32 s25, s73
s_mov_b32 s26, 2097152
s_mov_b32 s27, 0x20000
s_mov_b32 s28, s80
s_mov_b32 s29, s81
s_mov_b32 s30, 7340032
s_mov_b32 s31, 0x20000
s_mov_b32 s0, s82
s_mov_b32 s1, s83
s_mov_b32 s32, s76
s_mov_b32 s33, s77
s_mov_b32 s34, 7340032
s_mov_b32 s35, 0x20000
s_mov_b32 s80, s78
s_mov_b32 s81, s79
s_mov_b32 s82, 7340032
s_mov_b32 s83, 0x20000
s_lshr_b32 s10, s4, 2
s_lshl_b32 s10, s10, 2
s_and_b32 s62, s5, 3
s_add_u32 s10, s10, s62
s_and_b32 s11, s4, 3
s_lshl_b32 s11, s11, 3
s_lshr_b32 s62, s5, 2
s_add_u32 s11, s11, s62
s_and_b32 s12, s11, 1
s_lshr_b32 s13, s11, 1
s_mul_i32 s51, s13, 448
s_mul_i32 s62, s12, 192
s_add_u32 s51, s51, s62
s_lshl_b32 s62, s6, 3
s_lshr_b32 s84, s62, 4
s_lshl_b32 s84, s84, 14
s_and_b32 s62, s62, 15
s_lshl_b32 s62, s62, 10
s_add_u32 s84, s84, s62
s_lshl_b32 s62, s8, 3
s_lshr_b32 s85, s62, 4
s_lshl_b32 s85, s85, 14
s_and_b32 s62, s62, 15
s_lshl_b32 s62, s62, 10
s_add_u32 s85, s85, s62
s_lshl_b32 s62, s50, 0
s_lshr_b32 s86, s62, 4
s_lshl_b32 s86, s86, 14
s_and_b32 s62, s62, 15
s_lshl_b32 s62, s62, 10
s_add_u32 s86, s86, s62
s_mul_i32 s62, s8, 393216
s_add_u32 s62, s62, s66
v_mul_u32_u24 v14, 6144, v1
v_add_u32 v14, s62, v14
s_lshl_b32 s62, s8, 4
s_add_u32 s62, s62, s9
s_lshl_b32 s62, s62, 2
s_add_u32 s62, s62, s3
s_mul_i32 s62, s62, 6656
v_min_u32 v15, 51, v1
v_lshl_add_u32 v15, v15, 7, s62
s_sub_u32 s63, s8, 4
s_lshl_b32 s64, s8, 1
s_add_u32 s64, s64, 1
s_cmp_lt_u32 s8, 5
s_cselect_b64 vcc, -1, 0
s_cselect_b32 s46, s64, s63
v_cndmask_b32 v14, v14, v15, vcc
s_lshl_b32 s62, s2, 1
s_add_u32 s62, s62, s48
s_mul_i32 s62, s62, 5376
v_min_u32 v16, 41, v1
v_lshl_add_u32 v16, v16, 7, s62
s_cmp_lt_u32 s46, 6
s_cselect_b64 vcc, -1, 0
v_cndmask_b32 v15, v14, v16, vcc
v_cndmask_b32 v14, v16, v14, vcc
s_cmp_lt_u32 s3, 2
s_cselect_b32 s65, s32, s80
s_cselect_b32 s66, s33, s81
s_cselect_b32 s67, s34, s82
s_cmp_lt_u32 s8, 5
s_cselect_b32 s62, s24, s20
s_cselect_b32 s63, s25, s21
s_cselect_b32 s64, s26, s22
s_sub_u32 s47, s46, 6
s_cmp_lt_u32 s46, 6
s_cselect_b32 s47, s46, s47
s_cselect_b32 s76, s62, s65
s_cselect_b32 s98, s65, s62
s_cselect_b32 s77, s63, s66
s_cselect_b32 s99, s66, s63
s_cselect_b32 s78, s64, s67
s_cselect_b32 s100, s67, s64
s_mov_b32 s79, 0x20000
v_bfe_u32 v24, v1, 1, 3
v_lshrrev_b32 v2, 4, v1
v_xor_b32 v2, v2, v24
v_lshlrev_b32 v2, 4, v2
v_and_b32 v23, 15, v1
v_lshl_add_u32 v23, v23, 7, v2
s_mul_i32 s62, s48, 9216
v_add_u32 v23, s62, v23
v_xor_b32 v30, 64, v23
v_mul_u32_u24 v24, 2304, v24
v_add_u32 v24, v24, v2
v_and_b32 v2, 1, v1
v_lshl_add_u32 v24, v2, 7, v24
v_add_u32 v24, 2048, v24
v_xor_b32 v31, 64, v24
v_and_b32 v2, 15, v1
v_cmp_eq_u32 vcc, 0, v2
v_mov_b32 v2, 18432
s_nop 0
v_cndmask_b32 v24, v24, v2, vcc
v_cndmask_b32 v31, v31, v2, vcc
v_bfe_u32 v25, v1, 3, 2
v_mul_u32_u24 v25, 3104, v25
v_bfe_u32 v2, v1, 2, 1
v_lshl_add_u32 v25, v2, 7, v25
v_bfe_u32 v2, v1, 5, 1
v_lshl_add_u32 v25, v2, 8, v25
v_and_b32 v2, 3, v1
v_lshl_add_u32 v25, v2, 3, v25
s_lshl_b32 s62, s49, 6
s_add_u32 s62, s62, 73984
v_add_u32 v25, s62, v25
s_lshl_b32 s62, s8, 1
s_add_u32 s62, s62, s3
s_lshr_b32 s63, s50, 2
s_cmp_lt_u32 s3, 2
s_cselect_b32 s62, s62, s63
s_lshl_b32 s62, s62, 13
s_cmp_eq_u32 s3, 3
s_cselect_b32 s62, 268435456, s62
v_lshl_add_u32 v26, v1, 4, s62
s_mul_i32 s59, s3, 2080
s_and_b32 s87, s6, 3
s_lshl_b32 s87, s87, 17
v_bfe_u32 v5, v1, 3, 1
v_lshrrev_b32 v2, 4, v1
v_lshl_add_u32 v5, v2, 3, v5
s_lshl_b32 s62, s3, 1
v_add_u32 v5, s62, v5
v_mul_u32_u24 v5, 2048, v5
v_and_b32 v2, 7, v1
v_lshl_add_u32 v5, v2, 4, v5
s_lshl_b32 s62, s7, 7
v_add_u32 v5, s62, v5
v_add_u32 v6, 64512, v5
s_lshl_b32 s62, s6, 10
s_add_u32 s62, s62, 30408704
s_lshl_b32 s64, s8, 10
s_add_u32 s64, s64, 30408704
s_lshr_b32 s67, s9, 1
s_and_b32 s67, s67, 3
s_lshl_b32 s67, s67, 7
s_add_u32 s64, s64, s67
s_lshr_b32 s65, s50, 3
s_lshl_b32 s65, s65, 10
s_add_u32 s65, s65, 30408704
s_lshr_b32 s67, s9, 1
s_and_b32 s67, s67, 3
s_lshl_b32 s67, s67, 7
s_add_u32 s65, s65, s67
v_mov_b32 v2, 268435456
v_cmp_eq_u32 vcc, 65, v0
v_mov_b32 v33, s65
s_nop 0
v_cndmask_b32 v33, v2, v33, vcc
v_cndmask_b32 v36, 0, 16, vcc
v_cmp_eq_u32 vcc, 64, v0
v_mov_b32 v32, s64
s_nop 0
v_cndmask_b32 v33, v33, v32, vcc
v_lshl_add_u32 v32, v1, 7, s62
v_cndmask_b32 v34, v2, 0, vcc
v_cndmask_b32 v35, 0, 16, vcc
v_cndmask_b32 v36, v36, 16, vcc
v_lshrrev_b32 v37, 3, v0
v_cmp_eq_u32 vcc, 8, v37
s_nop 1
v_cndmask_b32 v32, v2, v32, vcc
v_mov_b32 v38, 1
v_lshrrev_b32 v2, 4, v1
v_lshlrev_b32 v2, 2, v2
v_and_b32 v13, 15, v1
v_sub_u32 v2, v13, v2
v_mov_b32 v13, 0xff61b1e6
v_subrev_u32 v54, 0, v2
v_cmp_gt_u32 vcc, 8, v54
s_nop 1
v_cndmask_b32 v50, v13, 0, vcc
v_cmp_gt_i32 vcc, -8, v54
s_nop 1
v_cndmask_b32 v46, v13, 0, vcc
v_subrev_u32 v54, 1, v2
v_cmp_gt_u32 vcc, 8, v54
s_nop 1
v_cndmask_b32 v51, v13, 0, vcc
v_cmp_gt_i32 vcc, -8, v54
s_nop 1
v_cndmask_b32 v47, v13, 0, vcc
v_subrev_u32 v54, 2, v2
v_cmp_gt_u32 vcc, 8, v54
s_nop 1
v_cndmask_b32 v52, v13, 0, vcc
v_cmp_gt_i32 vcc, -8, v54
s_nop 1
v_cndmask_b32 v48, v13, 0, vcc
v_subrev_u32 v54, 3, v2
v_cmp_gt_u32 vcc, 8, v54
s_nop 1
v_cndmask_b32 v53, v13, 0, vcc
v_cmp_gt_i32 vcc, -8, v54
s_nop 1
v_cndmask_b32 v49, v13, 0, vcc
s_cmp_lt_u32 s8, 2
s_cselect_b64 vcc, -1, 0
v_cndmask_b32 v54, v46, v13, vcc
v_cndmask_b32 v55, v47, v13, vcc
v_cndmask_b32 v56, v48, v13, vcc
v_cndmask_b32 v57, v49, v13, vcc
s_mov_b32 s75, 29360128
v_and_b32 v10, 15, v1
v_lshlrev_b32 v12, 2, v10
v_lshlrev_b32 v10, 4, v10
v_add_u32 v10, 152576, v10
v_lshrrev_b32 v11, 4, v1
v_lshlrev_b32 v11, 4, v11
s_lshl_b32 s62, s49, 7
s_add_u32 s62, s62, 158720
v_add_u32 v12, s62, v12
v_add_u32 v13, s62, v11
v_add_u32 v11, 156672, v11
s_lshl_b32 s62, s3, 11
s_add_u32 s62, s62, 143360
v_lshl_add_u32 v8, v1, 4, s62
v_xor_b32 v9, 2048, v8
v_mov_b32 v248, 0x3f803f80
v_mov_b32 v249, 0x3f803f80
v_mov_b32 v250, 0x3f803f80
v_mov_b32 v251, 0x3f803f80
s_mul_i32 s62, s3, 18496
s_add_u32 s62, s62, 18432
v_mov_b32 v2, s62
ds_write_b128 v2, v[248:251]
v_and_b32 v7, 31, v1
v_lshrrev_b32 v2, 5, v1
v_lshl_add_u32 v7, v7, 1, v2
v_and_b32 v2, 0xc0, v0
v_add_u32 v7, v7, v2
v_lshlrev_b32 v17, 2, v7
v_add_u32 v17, 156672, v17
v_lshlrev_b32 v7, 4, v7
v_add_u32 v7, 152576, v7
s_lshl_b32 s74, s9, 1
s_add_u32 s74, s74, s49
s_lshl_b32 s74, s74, 17
s_add_u32 s74, s74, s85
s_lshl_b32 s63, s48, 12
s_add_u32 s74, s74, s63
s_add_u32 s74, s74, 4194304
s_mov_b32 s62, 0
v_lshl_add_u32 v4, v1, 4, s62
v_lshrrev_b32 v2, 3, v1
v_cmp_eq_u32 vcc, 3, v2
v_add_u32 v2, 67108480, v4
s_nop 0
v_cndmask_b32 v4, v4, v2, vcc
s_mov_b64 exec, 0
s_cmp_eq_u32 s3, 2
s_cbranch_scc1 .Lpad1
s_cmp_eq_u32 s3, 3
s_cbranch_scc1 .Lpad2
s_cmp_eq_u32 s3, 1
s_cbranch_scc1 .Lpad4
s_branch .Lpad3
.Lt0r:
s_mov_b64 exec, -1
s_add_u32 m0, s55, 0
s_nop 0
buffer_load_dwordx4 v21, s[36:39], s52 offen lds
buffer_load_dwordx4 v28, s[36:39], s52 offen offset:1024 lds
buffer_load_dword v22, s[36:39], s52 offen offset:2048 lds
s_add_u32 s52, s52, 128
s_add_u32 m0, s55, 2304
s_nop 0
buffer_load_dwordx4 v21, s[36:39], s53 offen lds
buffer_load_dwordx4 v28, s[36:39], s53 offen offset:1024 lds
buffer_load_dword v29, s[36:39], s53 offen offset:2048 lds
s_add_u32 s53, s53, 128
s_add_u32 m0, s56, 123648
s_nop 0
buffer_load_dwordx4 v18, s[20:23], s54 offen lds
buffer_load_dwordx4 v19, s[20:23], s54 offen offset:1024 lds
buffer_load_dwordx4 v20, s[20:23], s54 offen offset:2048 lds
s_add_u32 s54, s54, 196608
s_add_u32 m0, s56, 136064
s_nop 0
buffer_load_dwordx4 v18, s[20:23], s54 offen lds
buffer_load_dwordx4 v19, s[20:23], s54 offen offset:1024 lds
buffer_load_dwordx4 v20, s[20:23], s54 offen offset:2048 lds
s_add_u32 s54, s54, 196608
s_cmp_eq_u32 s48, 1
s_cbranch_scc1 .Lqkv1
s_cmp_lt_u32 s14, 16
s_cselect_b32 s62, 0, 4096
v_mov_b32 v231, 1
v_lshlrev_b32 v232, 8, v1
s_waitcnt vmcnt(18)
v_permlane16_swap_b32 v164, v166
v_permlane16_swap_b32 v165, v167
s_waitcnt vmcnt(17)
v_permlane16_swap_b32 v168, v170
v_permlane16_swap_b32 v169, v171
s_waitcnt vmcnt(16)
v_permlane16_swap_b32 v172, v174
v_permlane16_swap_b32 v173, v175
s_waitcnt vmcnt(15)
v_permlane16_swap_b32 v176, v178
v_permlane16_swap_b32 v177, v179
buffer_atomic_add v231, v232, s[40:43], s62 offen
v_lshlrev_b32 v192, 16, v164
v_and_b32 v193, 0xffff0000, v164
v_lshlrev_b32 v194, 16, v165
v_and_b32 v195, 0xffff0000, v165
v_lshlrev_b32 v196, 16, v166
v_and_b32 v197, 0xffff0000, v166
v_lshlrev_b32 v198, 16, v167
v_and_b32 v199, 0xffff0000, v167
v_lshlrev_b32 v200, 16, v168
v_and_b32 v201, 0xffff0000, v168
v_lshlrev_b32 v202, 16, v169
v_and_b32 v203, 0xffff0000, v169
v_lshlrev_b32 v204, 16, v170
v_and_b32 v205, 0xffff0000, v170
v_lshlrev_b32 v206, 16, v171
v_and_b32 v207, 0xffff0000, v171
v_lshlrev_b32 v208, 16, v172
v_and_b32 v209, 0xffff0000, v172
v_lshlrev_b32 v210, 16, v173
v_and_b32 v211, 0xffff0000, v173
v_lshlrev_b32 v212, 16, v174
v_and_b32 v213, 0xffff0000, v174
v_lshlrev_b32 v214, 16, v175
v_and_b32 v215, 0xffff0000, v175
v_lshlrev_b32 v216, 16, v176
v_and_b32 v217, 0xffff0000, v176
v_lshlrev_b32 v218, 16, v177
v_and_b32 v219, 0xffff0000, v177
v_lshlrev_b32 v220, 16, v178
v_and_b32 v221, 0xffff0000, v178
v_lshlrev_b32 v222, 16, v179
v_and_b32 v223, 0xffff0000, v179
s_lshl_b32 s64, s6, 14
s_lshl_b32 s65, s49, 13
s_add_u32 s64, s64, s65
s_lshl_b32 s65, s7, 9
s_add_u32 s64, s64, s65
s_lshl_b32 s65, s48, 8
s_add_u32 s64, s64, s65
s_add_u32 s64, s64, 29360128
v_and_b32 v188, 31, v1
v_lshlrev_b32 v188, 3, v188
v_lshrrev_b32 v189, 5, v1
v_lshl_add_u32 v188, v189, 28, v188
s_lshl_b32 s62, s7, 18
s_add_u32 s62, s62, 0
s_add_u32 s63, s62, 131072
v_pk_mul_f32 v[182:183], v[192:193], v[192:193]
v_pk_mul_f32 v[186:187], v[208:209], v[208:209]
v_pk_fma_f32 v[182:183], v[194:195], v[194:195], v[182:183]
v_pk_add_f32 v[180:181], v[192:193], v[194:195]
v_pk_fma_f32 v[186:187], v[210:211], v[210:211], v[186:187]
v_pk_add_f32 v[184:185], v[208:209], v[210:211]
v_pk_fma_f32 v[182:183], v[196:197], v[196:197], v[182:183]
v_pk_add_f32 v[180:181], v[180:181], v[196:197]
v_pk_fma_f32 v[186:187], v[212:213], v[212:213], v[186:187]
v_pk_add_f32 v[184:185], v[184:185], v[212:213]
v_pk_fma_f32 v[182:183], v[198:199], v[198:199], v[182:183]
v_pk_add_f32 v[180:181], v[180:181], v[198:199]
v_pk_fma_f32 v[186:187], v[214:215], v[214:215], v[186:187]
v_pk_add_f32 v[184:185], v[184:185], v[214:215]
v_pk_fma_f32 v[182:183], v[200:201], v[200:201], v[182:183]
v_pk_add_f32 v[180:181], v[180:181], v[200:201]
v_pk_fma_f32 v[186:187], v[216:217], v[216:217], v[186:187]
v_pk_add_f32 v[184:185], v[184:185], v[216:217]
v_pk_fma_f32 v[182:183], v[202:203], v[202:203], v[182:183]
v_pk_add_f32 v[180:181], v[180:181], v[202:203]
v_pk_fma_f32 v[186:187], v[218:219], v[218:219], v[186:187]
v_pk_add_f32 v[184:185], v[184:185], v[218:219]
v_pk_fma_f32 v[182:183], v[204:205], v[204:205], v[182:183]
v_pk_add_f32 v[180:181], v[180:181], v[204:205]
v_pk_fma_f32 v[186:187], v[220:221], v[220:221], v[186:187]
v_pk_add_f32 v[184:185], v[184:185], v[220:221]
v_pk_fma_f32 v[182:183], v[206:207], v[206:207], v[182:183]
v_pk_add_f32 v[180:181], v[180:181], v[206:207]
v_pk_fma_f32 v[186:187], v[222:223], v[222:223], v[186:187]
v_pk_add_f32 v[184:185], v[184:185], v[222:223]
v_add_f32 v180, v180, v181
v_add_f32 v182, v182, v183
v_add_f32 v184, v184, v185
v_add_f32 v186, v186, v187
s_nop 0
v_permlane16_swap_b32 v180, v184
v_permlane16_swap_b32 v182, v186
v_add_f32 v180, v180, v184
v_add_f32 v182, v182, v186
s_nop 1
v_permlane32_swap_b32 v180, v182
v_add_f32 v180, v180, v182
s_nop 1
v_permlane32_swap_b32 v180, v181
buffer_store_dwordx2 v[180:181], v188, s[16:19], s64 offen sc1
s_lshl_b32 s62, s2, 10
s_add_u32 s62, s62, 31457280
s_cmp_eq_u32 s3, 0
s_cselect_b32 s62, s62, 268435456
buffer_store_dwordx4 v[224:227], v230, s[16:19], s62 offen sc1
v_accvgpr_write_b32 a224, v192
v_accvgpr_write_b32 a225, v193
v_accvgpr_write_b32 a226, v194
v_accvgpr_write_b32 a227, v195
v_accvgpr_write_b32 a228, v196
v_accvgpr_write_b32 a229, v197
v_accvgpr_write_b32 a230, v198
v_accvgpr_write_b32 a231, v199
v_accvgpr_write_b32 a232, v200
v_accvgpr_write_b32 a233, v201
v_accvgpr_write_b32 a234, v202
v_accvgpr_write_b32 a235, v203
v_accvgpr_write_b32 a236, v204
v_accvgpr_write_b32 a237, v205
v_accvgpr_write_b32 a238, v206
v_accvgpr_write_b32 a239, v207
v_accvgpr_write_b32 a240, v208
v_accvgpr_write_b32 a241, v209
v_accvgpr_write_b32 a242, v210
v_accvgpr_write_b32 a243, v211
v_accvgpr_write_b32 a244, v212
v_accvgpr_write_b32 a245, v213
v_accvgpr_write_b32 a246, v214
v_accvgpr_write_b32 a247, v215
v_accvgpr_write_b32 a248, v216
v_accvgpr_write_b32 a249, v217
v_accvgpr_write_b32 a250, v218
v_accvgpr_write_b32 a251, v219
v_accvgpr_write_b32 a252, v220
v_accvgpr_write_b32 a253, v221
v_accvgpr_write_b32 a254, v222
v_accvgpr_write_b32 a255, v223
s_add_u32 m0, s55, 18496
s_nop 0
buffer_load_dwordx4 v21, s[36:39], s52 offen lds
buffer_load_dwordx4 v28, s[36:39], s52 offen offset:1024 lds
buffer_load_dword v22, s[36:39], s52 offen offset:2048 lds
s_add_u32 s52, s52, 128
s_add_u32 m0, s55, 20800
s_nop 0
buffer_load_dwordx4 v21, s[36:39], s53 offen lds
buffer_load_dwordx4 v28, s[36:39], s53 offen offset:1024 lds
buffer_load_dword v29, s[36:39], s53 offen offset:2048 lds
s_add_u32 s53, s53, 128
s_add_u32 m0, s56, 73984
s_nop 0
buffer_load_dwordx4 v18, s[20:23], s54 offen lds
buffer_load_dwordx4 v19, s[20:23], s54 offen offset:1024 lds
buffer_load_dwordx4 v20, s[20:23], s54 offen offset:2048 lds
s_add_u32 s54, s54, 196608
s_waitcnt vmcnt(12) lgkmcnt(0)
s_barrier
ds_read_b128 a[0:3], v23
RD 4,23,2304
RD 8,23,4608
RD 12,23,6912
ds_read_b128 a[16:19], v24
ds_read_b128 a[20:23], v30
RD 24,30,2304
RD 28,30,4608
RD 32,30,6912
ds_read_b128 a[36:39], v31
TR 80,25,49664
TR 82,25,50176
TR 84,25,62080
TR 86,25,62592
TR 88,25,50688
TR 90,25,51200
TR 92,25,63104
TR 94,25,63616
TR 96,25,51712
TR 98,25,52224
TR 100,25,64128
TR 102,25,64640
s_waitcnt vmcnt(3) lgkmcnt(0)
s_barrier
v_mfma_f32_16x16x32_bf16 v[60:63], a[80:83], a[0:3], 0
TR 104,25,49696
s_add_u32 m0, s56, 86400
MAA 60,84,20
buffer_load_dwordx4 v18, s[20:23], s54 offen lds
v_mfma_f32_16x16x32_bf16 v[64:67], a[80:83], a[4:7], 0
s_sub_u32 s47, s47, 1
s_cbranch_scc1 .Lx4
.Lx4b:
MAA 64,84,24
buffer_load_dwordx4 v19, s[20:23], s54 offen offset:1024 lds
v_mfma_f32_16x16x32_bf16 v[68:71], a[80:83], a[8:11], 0
TR 106,25,50208
MAA 68,84,28
TR 108,25,62112
TR 110,25,62624
v_mfma_f32_16x16x32_bf16 v[72:75], a[80:83], a[12:15], 0
TR 112,25,50720
MAA 72,84,32
TR 114,25,51232
v_mfma_f32_16x16x32_bf16 v[244:247], a[80:83], a[16:19], 0
TR 116,25,63136
MAA 244,84,36
buffer_load_dwordx4 v20, s[20:23], s54 offen offset:2048 lds
v_mfma_f32_16x16x32_bf16 v[156:159], a[88:91], a[16:19], 0
s_add_u32 s54, s54, 196608
s_add_u32 m0, s55, 36992
MAA 156,92,36
buffer_load_dwordx4 v21, s[36:39], s52 offen lds
v_mfma_f32_16x16x32_bf16 v[104:107], a[88:91], a[12:15], 0
TR 118,25,63648
MAA 104,92,32
buffer_load_dwordx4 v28, s[36:39], s52 offen offset:1024 lds
v_mfma_f32_16x16x32_bf16 v[100:103], a[88:91], a[8:11], 0
TR 120,25,51744
MAA 100,92,28
buffer_load_dword v22, s[36:39], s52 offen offset:2048 lds
v_mfma_f32_16x16x32_bf16 v[96:99], a[88:91], a[4:7], 0
s_add_u32 s52, s52, 128
MAA 96,92,24
TR 122,25,52256
TR 124,25,64160
v_mfma_f32_16x16x32_bf16 v[92:95], a[88:91], a[0:3], 0
TR 126,25,64672
s_add_u32 m0, s55, 39296
MAA 92,92,20
buffer_load_dwordx4 v21, s[36:39], s53 offen lds
v_mfma_f32_16x16x32_bf16 v[124:127], a[0:3], a[96:99], 0
.Lpad1:
s_cbranch_execz .Lpad5
RD 40,23,18496
MAA 124,20,100
buffer_load_dwordx4 v28, s[36:39], s53 offen offset:1024 lds
v_mfma_f32_16x16x32_bf16 v[128:131], a[4:7], a[96:99], 0
RD 44,23,20800
MAA 128,24,100
RD 48,23,23104
RD 52,23,25408
v_mfma_f32_16x16x32_bf16 v[132:135], a[8:11], a[96:99], 0
RD 56,24,18496
MAA 132,28,100
buffer_load_dword v29, s[36:39], s53 offen offset:2048 lds
v_mfma_f32_16x16x32_bf16 v[136:139], a[12:15], a[96:99], 0
s_add_u32 s53, s53, 128
MAA 136,32,100
s_waitcnt vmcnt(6) lgkmcnt(5)
s_barrier
v_mfma_f32_16x16x32_bf16 v[76:79], a[104:107], a[0:3], 0
RD 60,30,18496
s_add_u32 m0, s56, 98816
MAA 76,108,20
buffer_load_dwordx4 v18, s[20:23], s54 offen lds
v_mfma_f32_16x16x32_bf16 v[80:83], a[104:107], a[4:7], 0
RD 64,30,20800
MAA 80,108,24
buffer_load_dwordx4 v19, s[20:23], s54 offen offset:1024 lds
v_mfma_f32_16x16x32_bf16 v[84:87], a[104:107], a[8:11], 0
RD 68,30,23104
MAA 84,108,28
RD 72,30,25408
RD 76,31,18496
v_mfma_f32_16x16x32_bf16 v[88:91], a[104:107], a[12:15], 0
ds_read_b64_tr_b16 a[80:81], v25
MAA 88,108,32
buffer_load_dwordx4 v20, s[20:23], s54 offen offset:2048 lds
v_mfma_f32_16x16x32_bf16 v[160:163], a[112:115], a[16:19], 0
s_add_u32 s54, s54, 196608
s_add_u32 m0, s56, 111232
MAA 160,116,36
buffer_load_dwordx4 v18, s[20:23], s54 offen lds
v_mfma_f32_16x16x32_bf16 v[120:123], a[112:115], a[12:15], 0
TR 82,25,512
MAA 120,116,32
buffer_load_dwordx4 v19, s[20:23], s54 offen offset:1024 lds
v_mfma_f32_16x16x32_bf16 v[116:119], a[112:115], a[8:11], 0
TR 84,25,12416
MAA 116,116,28
TR 86,25,12928
TR 88,25,1024
v_mfma_f32_16x16x32_bf16 v[112:115], a[112:115], a[4:7], 0
TR 90,25,1536
MAA 112,116,24
buffer_load_dwordx4 v20, s[20:23], s54 offen offset:2048 lds
v_mfma_f32_16x16x32_bf16 v[108:111], a[112:115], a[0:3], 0
s_add_u32 s54, s54, 196608
s_add_u32 m0, s55, 55488
MAA 108,116,20
buffer_load_dwordx4 v21, s[36:39], s52 offen lds
v_mfma_f32_16x16x32_bf16 v[140:143], a[0:3], a[120:123], 0
TR 92,25,13440
MAA 140,20,124
buffer_load_dwordx4 v28, s[36:39], s52 offen offset:1024 lds
v_mfma_f32_16x16x32_bf16 v[144:147], a[4:7], a[120:123], 0
TR 94,25,13952
MAA 144,24,124
TR 96,25,2048
TR 98,25,2560
v_mfma_f32_16x16x32_bf16 v[148:151], a[8:11], a[120:123], 0
TR 100,25,14464
MAA 148,28,124
buffer_load_dword v22, s[36:39], s52 offen offset:2048 lds
v_mfma_f32_16x16x32_bf16 v[152:155], a[12:15], a[120:123], 0
TR 102,25,14976
s_add_u32 s52, s52, 128
MAA 152,32,124
s_waitcnt vmcnt(9) lgkmcnt(8)
s_barrier
MAA 60,80,40
TR 104,25,32
s_add_u32 m0, s55, 57792
MAA 60,84,60
buffer_load_dwordx4 v21, s[36:39], s53 offen lds
MAA 64,84,64
s_sub_u32 s47, s47, 1
s_cbranch_scc1 .Lx5
.Lx5b:
MAA 64,80,44
buffer_load_dwordx4 v28, s[36:39], s53 offen offset:1024 lds
MAA 68,80,48
TR 106,25,544
MAA 68,84,68
TR 108,25,12448
TR 110,25,12960
MAA 72,84,72
TR 112,25,1056
MAA 72,80,52
TR 114,25,1568
s_waitcnt lgkmcnt(6)
MAA 244,80,56
TR 116,25,13472
MAA 244,84,76
buffer_load_dword v29, s[36:39], s53 offen offset:2048 lds
MAA 156,92,76
s_add_u32 s53, s53, 128
s_add_u32 m0, s56, 123648
MAA 156,88,56
buffer_load_dwordx4 v18, s[20:23], s54 offen lds
MAA 104,88,52
TR 118,25,13984
MAA 104,92,72
buffer_load_dwordx4 v19, s[20:23], s54 offen offset:1024 lds
MAA 100,92,68
TR 120,25,2080
MAA 100,88,48
buffer_load_dwordx4 v20, s[20:23], s54 offen offset:2048 lds
MAA 96,88,44
s_add_u32 s54, s54, 196608
MAA 96,92,64
TR 122,25,2592
TR 124,25,14496
MAA 92,92,60
TR 126,25,15008
s_add_u32 m0, s56, 136064
MAA 92,88,40
buffer_load_dwordx4 v18, s[20:23], s54 offen lds
MAA 124,40,96
RD 0,23,36992
MAA 124,60,100
buffer_load_dwordx4 v19, s[20:23], s54 offen offset:1024 lds
MAA 128,64,100
RD 4,23,39296
MAA 128,44,96
RD 8,23,41600
RD 12,23,43904
MAA 132,48,96
RD 16,24,36992
MAA 132,68,100
buffer_load_dwordx4 v20, s[20:23], s54 offen offset:2048 lds
MAA 136,72,100
s_add_u32 s54, s54, 196608
MAA 136,52,96
s_waitcnt vmcnt(12) lgkmcnt(5)
s_barrier
MAA 76,104,40
RD 20,30,36992
s_add_u32 m0, s55, 0
MAA 76,108,60
buffer_load_dwordx4 v21, s[36:39], s52 offen lds
MAA 80,108,64
RD 24,30,39296
MAA 80,104,44
buffer_load_dwordx4 v28, s[36:39], s52 offen offset:1024 lds
MAA 84,104,48
RD 28,30,41600
MAA 84,108,68
buffer_load_dword v22, s[36:39], s52 offen offset:2048 lds
MAA 88,108,72
RD 32,30,43904
s_add_u32 s52, s52, 128
MAA 88,104,52
RD 36,31,36992
TR 80,25,24832
TR 82,25,25344
MAA 160,112,56
TR 84,25,37248
s_add_u32 m0, s55, 2304
MAA 160,116,76
buffer_load_dwordx4 v21, s[36:39], s53 offen lds
MAA 120,116,72
TR 86,25,37760
MAA 120,112,52
buffer_load_dwordx4 v28, s[36:39], s53 offen offset:1024 lds
MAA 116,112,48
TR 88,25,25856
MAA 116,116,68
buffer_load_dword v29, s[36:39], s53 offen offset:2048 lds
MAA 112,116,64
s_add_u32 s53, s53, 128
s_add_u32 m0, s56, 73984
MAA 112,112,44
buffer_load_dwordx4 v18, s[20:23], s54 offen lds
MAA 108,112,40
TR 90,25,26368
MAA 108,116,60
buffer_load_dwordx4 v19, s[20:23], s54 offen offset:1024 lds
MAA 140,60,124
TR 92,25,38272
MAA 140,40,120
TR 94,25,38784
TR 96,25,26880
TR 98,25,27392
MAA 144,44,120
TR 100,25,39296
MAA 144,64,124
buffer_load_dwordx4 v20, s[20:23], s54 offen offset:2048 lds
MAA 148,68,124
TR 102,25,39808
s_add_u32 s54, s54, 196608
MAA 148,48,120
buffer_load_dword v37, v34, s[40:43], 0 offen sc1
MAA 152,52,120
MAA 152,72,124
s_waitcnt vmcnt(16) lgkmcnt(8)
s_barrier
MAA 60,80,0
TR 104,25,24864
s_add_u32 m0, s56, 86400
MAA 60,84,20
buffer_load_dwordx4 v18, s[20:23], s54 offen lds
MAA 64,84,24
s_sub_u32 s47, s47, 1
s_cbranch_scc1 .Lx6
.Lx6b:
MAA 64,80,4
buffer_load_dwordx4 v19, s[20:23], s54 offen offset:1024 lds
MAA 68,80,8
TR 106,25,25376
MAA 68,84,28
TR 108,25,37280
TR 110,25,37792
MAA 72,84,32
TR 112,25,25888
MAA 72,80,12
TR 114,25,26400
s_waitcnt lgkmcnt(6)
MAA 244,80,16
TR 116,25,38304
MAA 244,84,36
buffer_load_dwordx4 v20, s[20:23], s54 offen offset:2048 lds
MAA 156,92,36
s_add_u32 s54, s54, 196608
s_add_u32 m0, s55, 18496
MAA 156,88,16
buffer_load_dwordx4 v21, s[36:39], s52 offen lds
MAA 104,88,12
TR 118,25,38816
MAA 104,92,32
buffer_load_dwordx4 v28, s[36:39], s52 offen offset:1024 lds
MAA 100,92,28
TR 120,25,26912
MAA 100,88,8
buffer_load_dword v22, s[36:39], s52 offen offset:2048 lds
MAA 96,88,4
s_add_u32 s52, s52, 128
MAA 96,92,24
TR 122,25,27424
TR 124,25,39328
MAA 92,92,20
TR 126,25,39840
s_add_u32 m0, s55, 20800
MAA 92,88,0
buffer_load_dwordx4 v21, s[36:39], s53 offen lds
MAA 124,0,96
RD 40,23,55488
MAA 124,20,100
buffer_load_dwordx4 v28, s[36:39], s53 offen offset:1024 lds
MAA 128,24,100
RD 44,23,57792
MAA 128,4,96
RD 48,23,60096
RD 52,23,62400
MAA 132,8,96
RD 56,24,55488
MAA 132,28,100
buffer_load_dword v29, s[36:39], s53 offen offset:2048 lds
MAA 136,32,100
s_add_u32 s53, s53, 128
MAA 136,12,96
s_waitcnt vmcnt(19) lgkmcnt(5)
s_barrier
MAA 76,104,0
RD 60,30,55488
s_add_u32 m0, s56, 98816
MAA 76,108,20
buffer_load_dwordx4 v18, s[20:23], s54 offen lds
MAA 80,108,24
RD 64,30,57792
MAA 80,104,4
buffer_load_dwordx4 v19, s[20:23], s54 offen offset:1024 lds
MAA 84,104,8
RD 68,30,60096
MAA 84,108,28
RD 72,30,62400
RD 76,31,55488
MAA 88,108,32
TR 80,25,49664
MAA 88,104,12
buffer_load_dwordx4 v20, s[20:23], s54 offen offset:2048 lds
MAA 160,112,16
s_add_u32 s54, s54, 196608
s_add_u32 m0, s55, 36992
MAA 160,116,36
buffer_load_dwordx4 v21, s[36:39], s52 offen lds
MAA 120,116,32
TR 82,25,50176
MAA 120,112,12
buffer_load_dwordx4 v28, s[36:39], s52 offen offset:1024 lds
MAA 116,112,8
TR 84,25,62080
MAA 116,116,28
TR 86,25,62592
TR 88,25,50688
MAA 112,116,24
TR 90,25,51200
MAA 112,112,4
buffer_load_dword v22, s[36:39], s52 offen offset:2048 lds
MAA 108,112,0
s_add_u32 s52, s52, 128
s_add_u32 m0, s55, 39296
MAA 108,116,20
buffer_load_dwordx4 v21, s[36:39], s53 offen lds
MAA 140,20,124
TR 92,25,63104
MAA 140,0,120
buffer_load_dwordx4 v28, s[36:39], s53 offen offset:1024 lds
MAA 144,4,120
TR 94,25,63616
MAA 144,24,124
TR 96,25,51712
TR 98,25,52224
MAA 148,28,124
TR 100,25,64128
MAA 148,8,120
buffer_load_dword v29, s[36:39], s53 offen offset:2048 lds
MAA 152,12,120
TR 102,25,64640
s_add_u32 s53, s53, 128
MAA 152,32,124
s_waitcnt vmcnt(22) lgkmcnt(8)
s_barrier
MAA 60,80,40
TR 104,25,49696
s_add_u32 m0, s56, 111232
MAA 60,84,60
buffer_load_dwordx4 v18, s[20:23], s54 offen lds
MAA 64,84,64
s_sub_u32 s47, s47, 1
s_cbranch_scc1 .Lx7
.Lx7b:
MAA 64,80,44
TR 106,25,50208
MAA 68,80,48
TR 108,25,62112
MAA 68,84,68
buffer_load_dwordx4 v19, s[20:23], s54 offen offset:1024 lds
MAA 72,84,72
TR 110,25,62624
MAA 72,80,52
TR 112,25,50720
s_waitcnt lgkmcnt(5)
MAA 244,80,56
TR 114,25,51232
MAA 244,84,76
buffer_load_dwordx4 v20, s[20:23], s54 offen offset:2048 lds
MAA 156,92,76
s_add_u32 s54, s54, 196608
MAA 156,88,56
TR 116,25,63136
MAA 104,88,52
TR 118,25,63648
MAA 104,92,72
TR 120,25,51744
MAA 100,92,68
TR 122,25,52256
s_add_u32 m0, s55, 55488
MAA 100,88,48
buffer_load_dwordx4 v21, s[36:39], s52 offen lds
MAA 96,88,44
TR 124,25,64160
MAA 96,92,64
TR 126,25,64672
MAA 92,92,60
MAA 92,88,40
buffer_load_dwordx4 v28, s[36:39], s52 offen offset:1024 lds
MAA 124,40,96
ds_read_b128 a[0:3], v23
MAA 124,60,100
RD 4,23,2304
MAA 128,64,100
RD 8,23,4608
MAA 128,44,96
buffer_load_dword v22, s[36:39], s52 offen offset:2048 lds
MAA 132,48,96
RD 12,23,6912
s_add_u32 s52, s52, 128
MAA 132,68,100
ds_read_b128 a[16:19], v24
MAA 136,72,100
MAA 136,52,96
s_waitcnt vmcnt(21) lgkmcnt(5)
s_barrier
v_cmp_gt_u32 vcc, v35, v37
s_nop 0
s_cbranch_vccnz .Lsp8
.Lsp8b:
v_mov_b32 v37, 0
MAA 76,104,40
ds_read_b128 a[20:23], v30
MAA 76,108,60
buffer_atomic_add v38, v32, s[16:19], 0 offen
MAA 80,108,64
RD 24,30,2304
MAA 80,104,44
RD 28,30,4608
MAA 84,104,48
RD 32,30,6912
s_add_u32 m0, s56, 123648
MAA 84,108,68
buffer_load_dwordx4 v18, s[20:23], s54 offen lds
MAA 88,108,72
ds_read_b128 a[36:39], v31
MAA 88,104,52
buffer_load_dwordx4 v19, s[20:23], s54 offen offset:1024 lds
MAA 160,112,56
ds_read_b64_tr_b16 a[80:81], v25
MAA 160,116,76
TR 82,25,512
MAA 120,116,72
TR 84,25,12416
MAA 120,112,52
buffer_load_dwordx4 v20, s[20:23], s54 offen offset:2048 lds
MAA 116,112,48
TR 86,25,12928
s_add_u32 s54, s54, 196608
MAA 116,116,68
TR 88,25,1024
MAA 112,116,64
TR 90,25,1536
s_add_u32 m0, s55, 57792
MAA 112,112,44
buffer_load_dwordx4 v21, s[36:39], s53 offen lds
MAA 108,112,40
TR 92,25,13440
MAA 108,116,60
TR 94,25,13952
MAA 140,60,124
TR 96,25,2048
MAA 140,40,120
buffer_load_dwordx4 v28, s[36:39], s53 offen offset:1024 lds
MAA 144,44,120
TR 98,25,2560
MAA 144,64,124
buffer_load_dword v29, s[36:39], s53 offen offset:2048 lds
MAA 148,68,124
TR 100,25,14464
s_add_u32 s53, s53, 128
MAA 148,48,120
TR 102,25,14976
MAA 152,52,120
MAA 152,72,124
s_waitcnt vmcnt(22) lgkmcnt(8)
s_barrier
MAA 60,80,0
TR 104,25,32
s_add_u32 m0, s56, 136064
MAA 60,84,20
buffer_load_dwordx4 v18, s[20:23], s54 offen lds
MAA 64,84,24
s_sub_u32 s47, s47, 1
s_cbranch_scc1 .Lx9
.Lx9b:
MAA 64,80,4
TR 106,25,544
MAA 68,80,8
TR 108,25,12448
MAA 68,84,28
buffer_load_dwordx4 v19, s[20:23], s54 offen offset:1024 lds
MAA 72,84,32
TR 110,25,12960
MAA 72,80,12
TR 112,25,1056
s_waitcnt lgkmcnt(5)
MAA 244,80,16
TR 114,25,1568
MAA 244,84,36
buffer_load_dwordx4 v20, s[20:23], s54 offen offset:2048 lds
MAA 156,92,36
s_add_u32 s54, s54, 196608
MAA 156,88,16
TR 116,25,13472
MAA 104,88,12
TR 118,25,13984
MAA 104,92,32
TR 120,25,2080
MAA 100,92,28
TR 122,25,2592
s_add_u32 m0, s55, 0
MAA 100,88,8
buffer_load_dwordx4 v21, s[36:39], s52 offen lds
MAA 96,88,4
TR 124,25,14496
MAA 96,92,24
TR 126,25,15008
MAA 92,92,20
MAA 92,88,0
buffer_load_dwordx4 v28, s[36:39], s52 offen offset:1024 lds
MAA 124,0,96
RD 40,23,18496
MAA 124,20,100
RD 44,23,20800
MAA 128,24,100
RD 48,23,23104
MAA 128,4,96
buffer_load_dword v22, s[36:39], s52 offen offset:2048 lds
MAA 132,8,96
RD 52,23,25408
s_add_u32 s52, s52, 128
MAA 132,28,100
RD 56,24,18496
MAA 136,32,100
MAA 136,12,96
s_waitcnt vmcnt(16) lgkmcnt(5)
s_barrier
MAA 76,104,0
RD 60,30,18496
s_add_u32 m0, s56, 73984
MAA 76,108,20
buffer_load_dwordx4 v18, s[20:23], s54 offen lds
MAA 80,108,24
RD 64,30,20800
MAA 80,104,4
RD 68,30,23104
MAA 84,104,8
RD 72,30,25408
MAA 84,108,28
buffer_load_dwordx4 v19, s[20:23], s54 offen offset:1024 lds
MAA 88,108,32
RD 76,31,18496
MAA 88,104,12
TR 80,25,24832
MAA 160,112,16
TR 82,25,25344
MAA 160,116,36
buffer_load_dwordx4 v20, s[20:23], s54 offen offset:2048 lds
.Lpad2:
s_cbranch_execz .Lpad6
MAA 120,116,32
TR 84,25,37248
s_add_u32 s54, s54, 196608
MAA 120,112,12
TR 86,25,37760
MAA 116,112,8
s_add_u32 m0, s55, 2304
MAA 116,116,28
buffer_load_dwordx4 v21, s[36:39], s53 offen lds
MAA 112,116,24
TR 88,25,25856
MAA 112,112,4
TR 90,25,26368
MAA 108,112,0
TR 92,25,38272
MAA 108,116,20
buffer_load_dwordx4 v28, s[36:39], s53 offen offset:1024 lds
MAA 140,20,124
TR 94,25,38784
MAA 140,0,120
TR 96,25,26880
MAA 144,4,120
TR 98,25,27392
MAA 144,24,124
buffer_load_dword v29, s[36:39], s53 offen offset:2048 lds
MAA 148,28,124
TR 100,25,39296
s_add_u32 s53, s53, 128
MAA 148,8,120
TR 102,25,39808
MAA 152,12,120
MAA 152,32,124
s_waitcnt lgkmcnt(8)
s_barrier
MAA 60,80,40
TR 104,25,24864
s_add_u32 m0, s56, 86400
MAA 60,84,60
buffer_load_dwordx4 v18, s[20:23], s54 offen lds
MAA 64,84,64
s_sub_u32 s47, s47, 1
s_cbranch_scc1 .Lx10
.Lx10b:
MAA 64,80,44
TR 106,25,25376
MAA 68,80,48
TR 108,25,37280
MAA 68,84,68
buffer_load_dwordx4 v19, s[20:23], s54 offen offset:1024 lds
MAA 72,84,72
TR 110,25,37792
MAA 72,80,52
TR 112,25,25888
s_waitcnt lgkmcnt(5)
MAA 244,80,56
TR 114,25,26400
MAA 244,84,76
buffer_load_dwordx4 v20, s[20:23], s54 offen offset:2048 lds
MAA 156,92,76
s_add_u32 s54, s54, 196608
MAA 156,88,56
TR 116,25,38304
MAA 104,88,52
TR 118,25,38816
MAA 104,92,72
TR 120,25,26912
MAA 100,92,68
TR 122,25,27424
s_add_u32 m0, s55, 18496
MAA 100,88,48
buffer_load_dwordx4 v21, s[36:39], s52 offen lds
MAA 96,88,44
TR 124,25,39328
MAA 96,92,64
TR 126,25,39840
MAA 92,92,60
MAA 92,88,40
buffer_load_dwordx4 v28, s[36:39], s52 offen offset:1024 lds
MAA 124,40,96
RD 0,23,36992
MAA 124,60,100
RD 4,23,39296
MAA 128,64,100
RD 8,23,41600
MAA 128,44,96
buffer_load_dword v22, s[36:39], s52 offen offset:2048 lds
MAA 132,48,96
RD 12,23,43904
s_add_u32 s52, s52, 128
MAA 132,68,100
RD 16,24,36992
MAA 136,72,100
MAA 136,52,96
s_waitcnt vmcnt(15) lgkmcnt(5)
s_barrier
MAA 76,104,40
RD 20,30,36992
s_add_u32 m0, s56, 98816
MAA 76,108,60
buffer_load_dwordx4 v18, s[20:23], s54 offen lds
MAA 80,108,64
RD 24,30,39296
MAA 80,104,44
RD 28,30,41600
MAA 84,104,48
RD 32,30,43904
MAA 84,108,68
buffer_load_dwordx4 v19, s[20:23], s54 offen offset:1024 lds
MAA 88,108,72
RD 36,31,36992
MAA 88,104,52
buffer_load_dwordx4 v20, s[20:23], s54 offen offset:2048 lds
MAA 160,112,56
TR 80,25,49664
s_add_u32 s54, s54, 196608
MAA 160,116,76
TR 82,25,50176
MAA 120,116,72
TR 84,25,62080
s_add_u32 m0, s55, 20800
MAA 120,112,52
buffer_load_dwordx4 v21, s[36:39], s53 offen lds
MAA 116,112,48
TR 86,25,62592
MAA 116,116,68
TR 88,25,50688
MAA 112,116,64
TR 90,25,51200
MAA 112,112,44
buffer_load_dwordx4 v28, s[36:39], s53 offen offset:1024 lds
MAA 108,112,40
TR 92,25,63104
MAA 108,116,60
TR 94,25,63616
MAA 140,60,124
TR 96,25,51712
MAA 140,40,120
buffer_load_dword v29, s[36:39], s53 offen offset:2048 lds
MAA 144,44,120
TR 98,25,52224
s_add_u32 s53, s53, 128
MAA 144,64,124
buffer_atomic_add v37, v33, s[16:19], 0 offen sc0
MAA 148,68,124
TR 100,25,64128
MAA 148,48,120
TR 102,25,64640
MAA 152,52,120
MAA 152,72,124
s_waitcnt lgkmcnt(8)
s_barrier
MAA 60,80,0
TR 104,25,49696
s_add_u32 m0, s56, 111232
MAA 60,84,20
buffer_load_dwordx4 v18, s[20:23], s54 offen lds
MAA 64,84,24
s_sub_u32 s47, s47, 1
s_cbranch_scc1 .Lx11
.Lx11b:
MAA 64,80,4
TR 106,25,50208
MAA 68,80,8
TR 108,25,62112
MAA 68,84,28
buffer_load_dwordx4 v19, s[20:23], s54 offen offset:1024 lds
MAA 72,84,32
TR 110,25,62624
MAA 72,80,12
TR 112,25,50720
s_waitcnt lgkmcnt(5)
MAA 244,80,16
TR 114,25,51232
MAA 244,84,36
buffer_load_dwordx4 v20, s[20:23], s54 offen offset:2048 lds
MAA 156,92,36
s_add_u32 s54, s54, 196608
MAA 156,88,16
TR 116,25,63136
MAA 104,88,12
TR 118,25,63648
MAA 104,92,32
TR 120,25,51744
MAA 100,92,28
TR 122,25,52256
s_add_u32 m0, s55, 36992
MAA 100,88,8
buffer_load_dwordx4 v21, s[36:39], s52 offen lds
MAA 96,88,4
TR 124,25,64160
MAA 96,92,24
TR 126,25,64672
MAA 92,92,20
MAA 92,88,0
buffer_load_dwordx4 v28, s[36:39], s52 offen offset:1024 lds
MAA 124,0,96
RD 40,23,55488
MAA 124,20,100
RD 44,23,57792
MAA 128,24,100
RD 48,23,60096
MAA 128,4,96
buffer_load_dword v22, s[36:39], s52 offen offset:2048 lds
MAA 132,8,96
RD 52,23,62400
s_add_u32 s52, s52, 128
MAA 132,28,100
RD 56,24,55488
MAA 136,32,100
MAA 136,12,96
s_waitcnt vmcnt(16) lgkmcnt(5)
s_barrier
MAA 76,104,0
RD 60,30,55488
s_add_u32 m0, s56, 123648
MAA 76,108,20
buffer_load_dwordx4 v18, s[20:23], s54 offen lds
MAA 80,108,24
RD 64,30,57792
MAA 80,104,4
RD 68,30,60096
MAA 84,104,8
RD 72,30,62400
MAA 84,108,28
buffer_load_dwordx4 v19, s[20:23], s54 offen offset:1024 lds
MAA 88,108,32
RD 76,31,55488
MAA 88,104,12
ds_read_b64_tr_b16 a[80:81], v25
MAA 160,112,16
TR 82,25,512
MAA 160,116,36
buffer_load_dwordx4 v20, s[20:23], s54 offen offset:2048 lds
MAA 120,116,32
TR 84,25,12416
s_add_u32 s54, s54, 196608
MAA 120,112,12
TR 86,25,12928
MAA 116,112,8
s_add_u32 m0, s55, 39296
MAA 116,116,28
buffer_load_dwordx4 v21, s[36:39], s53 offen lds
MAA 112,116,24
TR 88,25,1024
MAA 112,112,4
TR 90,25,1536
MAA 108,112,0
TR 92,25,13440
MAA 108,116,20
buffer_load_dwordx4 v28, s[36:39], s53 offen offset:1024 lds
MAA 140,20,124
TR 94,25,13952
MAA 140,0,120
TR 96,25,2048
MAA 144,4,120
TR 98,25,2560
MAA 144,24,124
buffer_load_dword v29, s[36:39], s53 offen offset:2048 lds
MAA 148,28,124
TR 100,25,14464
s_add_u32 s53, s53, 128
MAA 148,8,120
TR 102,25,14976
MAA 152,12,120
MAA 152,32,124
s_waitcnt lgkmcnt(8)
s_barrier
MAA 60,80,40
TR 104,25,32
s_add_u32 m0, s56, 136064
MAA 60,84,60
buffer_load_dwordx4 v18, s[20:23], s54 offen lds
MAA 64,84,64
s_sub_u32 s47, s47, 1
s_cbranch_scc1 .Lx12
.Lx12b:
MAA 64,80,44
TR 106,25,544
MAA 68,80,48
TR 108,25,12448
MAA 68,84,68
buffer_load_dwordx4 v19, s[20:23], s54 offen offset:1024 lds
MAA 72,84,72
TR 110,25,12960
MAA 72,80,52
TR 112,25,1056
s_waitcnt lgkmcnt(5)
MAA 244,80,56
TR 114,25,1568
MAA 244,84,76
buffer_load_dwordx4 v20, s[20:23], s54 offen offset:2048 lds
MAA 156,92,76
s_add_u32 s54, s54, 196608
MAA 156,88,56
TR 116,25,13472
MAA 104,88,52
TR 118,25,13984
MAA 104,92,72
TR 120,25,2080
MAA 100,92,68
TR 122,25,2592
s_add_u32 m0, s55, 55488
MAA 100,88,48
buffer_load_dwordx4 v21, s[36:39], s52 offen lds
MAA 96,88,44
TR 124,25,14496
MAA 96,92,64
TR 126,25,15008
MAA 92,92,60
MAA 92,88,40
buffer_load_dwordx4 v28, s[36:39], s52 offen offset:1024 lds
MAA 124,40,96
ds_read_b128 a[0:3], v23
MAA 124,60,100
RD 4,23,2304
MAA 128,64,100
RD 8,23,4608
MAA 128,44,96
buffer_load_dword v22, s[36:39], s52 offen offset:2048 lds
MAA 132,48,96
RD 12,23,6912
s_add_u32 s52, s52, 128
MAA 132,68,100
ds_read_b128 a[16:19], v24
MAA 136,72,100
MAA 136,52,96
s_waitcnt vmcnt(18)
v_cmp_gt_u32 vcc, v36, v37
s_nop 0
s_cbranch_vccnz .Lsp13
.Lsp13b:
s_waitcnt vmcnt(15) lgkmcnt(5)
s_barrier
MAA 76,104,40
ds_read_b128 a[20:23], v30
s_add_u32 m0, s56, 73984
MAA 76,108,60
buffer_load_dwordx4 v18, s[20:23], s54 offen lds
MAA 80,108,64
RD 24,30,2304
MAA 80,104,44
RD 28,30,4608
MAA 84,104,48
RD 32,30,6912
MAA 84,108,68
buffer_load_dwordx4 v19, s[20:23], s54 offen offset:1024 lds
MAA 88,108,72
ds_read_b128 a[36:39], v31
MAA 88,104,52
buffer_load_dwordx4 v20, s[20:23], s54 offen offset:2048 lds
MAA 160,112,56
TR 80,25,24832
s_add_u32 s54, s54, 196608
MAA 160,116,76
TR 82,25,25344
MAA 120,116,72
TR 84,25,37248
s_add_u32 m0, s55, 57792
MAA 120,112,52
buffer_load_dwordx4 v21, s[36:39], s53 offen lds
MAA 116,112,48
TR 86,25,37760
MAA 116,116,68
TR 88,25,25856
MAA 112,116,64
TR 90,25,26368
MAA 112,112,44
buffer_load_dwordx4 v28, s[36:39], s53 offen offset:1024 lds
MAA 108,112,40
TR 92,25,38272
MAA 108,116,60
TR 94,25,38784
MAA 140,60,124
TR 96,25,26880
MAA 140,40,120
buffer_load_dword v29, s[36:39], s53 offen offset:2048 lds
MAA 144,44,120
TR 98,25,27392
s_add_u32 s53, s53, 128
MAA 144,64,124
buffer_load_dwordx4 v[164:167], v26, s[16:19], s75 offen sc1
MAA 148,68,124
TR 100,25,39296
MAA 148,48,120
TR 102,25,39808
MAA 152,52,120
MAA 152,72,124
s_waitcnt lgkmcnt(8)
s_barrier
MAA 60,80,0
TR 104,25,24864
s_add_u32 m0, s56, 86400
MAA 60,84,20
buffer_load_dwordx4 v18, s[20:23], s54 offen lds
MAA 64,84,24
s_sub_u32 s47, s47, 1
s_cbranch_scc1 .Lx14
.Lx14b:
MAA 64,80,4
TR 106,25,25376
MAA 68,80,8
TR 108,25,37280
MAA 68,84,28
buffer_load_dwordx4 v19, s[20:23], s54 offen offset:1024 lds
MAA 72,84,32
TR 110,25,37792
MAA 72,80,12
TR 112,25,25888
s_waitcnt lgkmcnt(5)
MAA 244,80,16
TR 114,25,26400
MAA 244,84,36
buffer_load_dwordx4 v20, s[20:23], s54 offen offset:2048 lds
MAA 156,92,36
TR 116,25,38304
s_add_u32 s54, s54, 196608
MAA 156,88,16
TR 118,25,38816
MAA 104,88,12
TR 120,25,26912
s_add_u32 m0, s55, 0
MAA 104,92,32
buffer_load_dwordx4 v21, s[36:39], s52 offen lds
MAA 100,92,28
MAA 100,88,8
buffer_load_dwordx4 v28, s[36:39], s52 offen offset:1024 lds
MAA 96,88,4
TR 122,25,27424
MAA 96,92,24
TR 124,25,39328
MAA 92,92,20
TR 126,25,39840
MAA 92,88,0
buffer_load_dword v22, s[36:39], s52 offen offset:2048 lds
MAA 124,0,96
RD 40,23,18496
s_add_u32 s52, s52, 128
MAA 124,20,100
RD 44,23,20800
MAA 128,24,100
RD 48,23,23104
MAA 128,4,96
buffer_load_dwordx4 v[168:171], v26, s[16:19], s75 offen offset:1024 sc1
MAA 132,8,96
RD 52,23,25408
MAA 132,28,100
RD 56,24,18496
MAA 136,32,100
MAA 136,12,96
s_waitcnt vmcnt(17) lgkmcnt(5)
s_barrier
MAA 76,104,0
RD 60,30,18496
s_add_u32 m0, s56, 98816
MAA 76,108,20
buffer_load_dwordx4 v18, s[20:23], s54 offen lds
MAA 80,108,24
RD 64,30,20800
MAA 80,104,4
RD 68,30,23104
MAA 84,104,8
RD 72,30,25408
MAA 84,108,28
buffer_load_dwordx4 v19, s[20:23], s54 offen offset:1024 lds
MAA 88,108,32
RD 76,31,18496
MAA 88,104,12
buffer_load_dwordx4 v20, s[20:23], s54 offen offset:2048 lds
MAA 160,112,16
TR 80,25,49664
s_add_u32 s54, s54, 196608
MAA 160,116,36
TR 82,25,50176
MAA 120,116,32
TR 84,25,62080
s_add_u32 m0, s55, 2304
MAA 120,112,12
buffer_load_dwordx4 v21, s[36:39], s53 offen lds
MAA 116,112,8
TR 86,25,62592
MAA 116,116,28
TR 88,25,50688
MAA 112,116,24
TR 90,25,51200
MAA 112,112,4
buffer_load_dwordx4 v28, s[36:39], s53 offen offset:1024 lds
MAA 108,112,0
TR 92,25,63104
MAA 108,116,20
TR 94,25,63616
MAA 140,20,124
TR 96,25,51712
MAA 140,0,120
buffer_load_dword v29, s[36:39], s53 offen offset:2048 lds
MAA 144,4,120
TR 98,25,52224
s_add_u32 s53, s53, 128
MAA 144,24,124
buffer_load_dwordx4 v[172:175], v26, s[16:19], s75 offen offset:2048 sc1
MAA 148,28,124
TR 100,25,64128
MAA 148,8,120
TR 102,25,64640
MAA 152,12,120
MAA 152,32,124
s_waitcnt lgkmcnt(8)
s_barrier
MAA 60,80,40
TR 104,25,49696
s_add_u32 m0, s56, 111232
MAA 60,84,60
buffer_load_dwordx4 v18, s[20:23], s54 offen lds
MAA 64,84,64
s_sub_u32 s47, s47, 1
s_cbranch_scc1 .Lx15
.Lx15b:
MAA 64,80,44
TR 106,25,50208
MAA 68,80,48
TR 108,25,62112
MAA 68,84,68
buffer_load_dwordx4 v19, s[20:23], s54 offen offset:1024 lds
MAA 72,84,72
TR 110,25,62624
MAA 72,80,52
TR 112,25,50720
s_waitcnt lgkmcnt(5)
MAA 244,80,56
TR 114,25,51232
MAA 244,84,76
buffer_load_dwordx4 v20, s[20:23], s54 offen offset:2048 lds
MAA 156,92,76
TR 116,25,63136
s_add_u32 s54, s54, 196608
MAA 156,88,56
TR 118,25,63648
MAA 104,88,52
.Lpad3:
s_cbranch_execz .Lpad7
TR 120,25,51744
s_add_u32 m0, s55, 18496
MAA 104,92,72
buffer_load_dwordx4 v21, s[36:39], s52 offen lds
MAA 100,92,68
MAA 100,88,48
buffer_load_dwordx4 v28, s[36:39], s52 offen offset:1024 lds
MAA 96,88,44
TR 122,25,52256
MAA 96,92,64
TR 124,25,64160
MAA 92,92,60
TR 126,25,64672
MAA 92,88,40
buffer_load_dword v22, s[36:39], s52 offen offset:2048 lds
MAA 124,40,96
RD 0,23,36992
s_add_u32 s52, s52, 128
MAA 124,60,100
RD 4,23,39296
MAA 128,64,100
RD 8,23,41600
MAA 128,44,96
buffer_load_dwordx4 v[176:179], v26, s[16:19], s75 offen offset:3072 sc1
MAA 132,48,96
RD 12,23,43904
s_add_u32 s75, s75, 4096
MAA 132,68,100
RD 16,24,36992
MAA 136,72,100
MAA 136,52,96
s_waitcnt vmcnt(18) lgkmcnt(5)
s_barrier
MAA 76,104,40
RD 20,30,36992
s_add_u32 m0, s56, 123648
MAA 76,108,60
buffer_load_dwordx4 v18, s[20:23], s54 offen lds
MAA 80,108,64
RD 24,30,39296
s_waitcnt vmcnt(15)
v_add_f32 v164, v164, v168
MAA 80,104,44
RD 28,30,41600
MAA 84,104,48
RD 32,30,43904
MAA 84,108,68
buffer_load_dwordx4 v19, s[20:23], s54 offen offset:1024 lds
MAA 88,108,72
RD 36,31,36992
v_add_f32 v165, v165, v169
MAA 88,104,52
buffer_load_dwordx4 v20, s[20:23], s54 offen offset:2048 lds
MAA 160,112,56
ds_read_b64_tr_b16 a[80:81], v25
s_add_u32 s54, s54, 196608
MAA 160,116,76
TR 82,25,512
MAA 120,116,72
TR 84,25,12416
s_add_u32 m0, s55, 20800
MAA 120,112,52
buffer_load_dwordx4 v21, s[36:39], s53 offen lds
MAA 116,112,48
TR 86,25,12928
MAA 116,116,68
TR 88,25,1024
MAA 112,116,64
TR 90,25,1536
v_add_f32 v166, v166, v170
MAA 112,112,44
buffer_load_dwordx4 v28, s[36:39], s53 offen offset:1024 lds
MAA 108,112,40
TR 92,25,13440
MAA 108,116,60
TR 94,25,13952
MAA 140,60,124
TR 96,25,2048
MAA 140,40,120
buffer_load_dword v29, s[36:39], s53 offen offset:2048 lds
MAA 144,44,120
TR 98,25,2560
s_add_u32 s53, s53, 128
MAA 144,64,124
buffer_load_dwordx4 v[180:183], v26, s[16:19], s75 offen sc1
MAA 148,68,124
TR 100,25,14464
v_add_f32 v167, v167, v171
MAA 148,48,120
TR 102,25,14976
MAA 152,52,120
MAA 152,72,124
s_waitcnt lgkmcnt(8)
s_barrier
MAA 60,80,0
TR 104,25,32
s_add_u32 m0, s56, 136064
MAA 60,84,20
buffer_load_dwordx4 v18, s[20:23], s54 offen lds
MAA 64,84,24
s_sub_u32 s47, s47, 1
s_cbranch_scc1 .Lx16
.Lx16b:
MAA 64,80,4
TR 106,25,544
s_waitcnt vmcnt(15)
v_add_f32 v164, v164, v172
MAA 68,80,8
TR 108,25,12448
MAA 68,84,28
buffer_load_dwordx4 v19, s[20:23], s54 offen offset:1024 lds
MAA 72,84,32
TR 110,25,12960
MAA 72,80,12
TR 112,25,1056
s_waitcnt lgkmcnt(5)
MAA 244,80,16
TR 114,25,1568
MAA 244,84,36
buffer_load_dwordx4 v20, s[20:23], s54 offen offset:2048 lds
MAA 156,92,36
TR 116,25,13472
s_add_u32 s54, s54, 196608
MAA 156,88,16
TR 118,25,13984
v_add_f32 v165, v165, v173
MAA 104,88,12
TR 120,25,2080
s_add_u32 m0, s55, 36992
MAA 104,92,32
buffer_load_dwordx4 v21, s[36:39], s52 offen lds
MAA 100,92,28
MAA 100,88,8
buffer_load_dwordx4 v28, s[36:39], s52 offen offset:1024 lds
MAA 96,88,4
TR 122,25,2592
MAA 96,92,24
TR 124,25,14496
v_add_f32 v166, v166, v174
MAA 92,92,20
TR 126,25,15008
MAA 92,88,0
buffer_load_dword v22, s[36:39], s52 offen offset:2048 lds
MAA 124,0,96
RD 40,23,55488
s_add_u32 s52, s52, 128
MAA 124,20,100
RD 44,23,57792
MAA 128,24,100
RD 48,23,60096
MAA 128,4,96
buffer_load_dwordx4 v[184:187], v26, s[16:19], s75 offen offset:1024 sc1
MAA 132,8,96
RD 52,23,62400
v_add_f32 v167, v167, v175
MAA 132,28,100
RD 56,24,55488
MAA 136,32,100
MAA 136,12,96
s_waitcnt vmcnt(18) lgkmcnt(5)
s_barrier
MAA 76,104,0
RD 60,30,55488
s_add_u32 m0, s56, 73984
MAA 76,108,20
buffer_load_dwordx4 v18, s[20:23], s54 offen lds
MAA 80,108,24
RD 64,30,57792
s_waitcnt vmcnt(15)
v_add_f32 v164, v164, v176
MAA 80,104,4
RD 68,30,60096
v_add_f32 v165, v165, v177
MAA 84,104,8
buffer_load_dwordx4 v19, s[20:23], s54 offen offset:1024 lds
MAA 84,108,28
RD 72,30,62400
v_add_f32 v166, v166, v178
MAA 88,108,32
RD 76,31,55488
v_add_f32 v167, v167, v179
MAA 88,104,12
buffer_load_dwordx4 v20, s[20:23], s54 offen offset:2048 lds
MAA 160,112,16
TR 80,25,24832
s_add_u32 s54, s54, 196608
MAA 160,116,36
TR 82,25,25344
s_add_u32 m0, s55, 39296
MAA 120,116,32
buffer_load_dwordx4 v21, s[36:39], s53 offen lds
MAA 120,112,12
TR 84,25,37248
MAA 116,112,8
TR 86,25,37760
MAA 116,116,28
buffer_load_dwordx4 v28, s[36:39], s53 offen offset:1024 lds
MAA 112,116,24
TR 88,25,25856
MAA 112,112,4
TR 90,25,26368
MAA 108,112,0
buffer_load_dword v29, s[36:39], s53 offen offset:2048 lds
MAA 108,116,20
TR 92,25,38272
s_add_u32 s53, s53, 128
MAA 140,20,124
TR 94,25,38784
MAA 140,0,120
buffer_load_dwordx4 v[188:191], v26, s[16:19], s75 offen offset:2048 sc1
MAA 144,4,120
TR 96,25,26880
MAA 144,24,124
TR 98,25,27392
MAA 148,28,124
TR 100,25,39296
MAA 148,8,120
TR 102,25,39808
MAA 152,12,120
MAA 152,32,124
s_waitcnt lgkmcnt(8)
s_barrier
MAA 60,80,40
TR 104,25,24864
s_add_u32 m0, s56, 86400
MAA 60,84,60
buffer_load_dwordx4 v18, s[20:23], s54 offen lds
MAA 64,84,64
s_sub_u32 s47, s47, 1
s_cbranch_scc1 .Lx17
.Lx17b:
MAA 64,80,44
TR 106,25,25376
s_waitcnt vmcnt(15)
v_add_f32 v164, v164, v180
MAA 68,80,48
TR 108,25,37280
MAA 68,84,68
buffer_load_dwordx4 v19, s[20:23], s54 offen offset:1024 lds
MAA 72,84,72
TR 110,25,37792
MAA 72,80,52
TR 112,25,25888
s_waitcnt lgkmcnt(5)
MAA 244,80,56
TR 114,25,26400
MAA 244,84,76
buffer_load_dwordx4 v20, s[20:23], s54 offen offset:2048 lds
MAA 156,92,76
TR 116,25,38304
s_add_u32 s54, s54, 196608
MAA 156,88,56
TR 118,25,38816
v_add_f32 v165, v165, v181
MAA 104,88,52
TR 120,25,26912
s_add_u32 m0, s55, 55488
MAA 104,92,72
buffer_load_dwordx4 v21, s[36:39], s52 offen lds
MAA 100,92,68
MAA 100,88,48
buffer_load_dwordx4 v28, s[36:39], s52 offen offset:1024 lds
MAA 96,88,44
TR 122,25,27424
MAA 96,92,64
TR 124,25,39328
v_add_f32 v166, v166, v182
MAA 92,92,60
TR 126,25,39840
MAA 92,88,40
buffer_load_dword v22, s[36:39], s52 offen offset:2048 lds
MAA 124,40,96
ds_read_b128 a[0:3], v23
s_add_u32 s52, s52, 128
MAA 124,60,100
RD 4,23,2304
MAA 128,64,100
RD 8,23,4608
MAA 128,44,96
buffer_load_dwordx4 v[192:195], v26, s[16:19], s75 offen offset:3072 sc1
MAA 132,48,96
RD 12,23,6912
v_add_f32 v167, v167, v183
MAA 132,68,100
ds_read_b128 a[16:19], v24
MAA 136,72,100
MAA 136,52,96
s_waitcnt vmcnt(18) lgkmcnt(5)
s_barrier
MAA 76,104,40
ds_read_b128 a[20:23], v30
s_add_u32 m0, s56, 98816
MAA 76,108,60
buffer_load_dwordx4 v18, s[20:23], s54 offen lds
MAA 80,108,64
RD 24,30,2304
s_waitcnt vmcnt(15)
v_add_f32 v164, v164, v184
MAA 80,104,44
RD 28,30,4608
v_add_f32 v165, v165, v185
MAA 84,104,48
RD 32,30,6912
v_add_f32 v166, v166, v186
MAA 84,108,68
buffer_load_dwordx4 v19, s[20:23], s54 offen offset:1024 lds
MAA 88,108,72
ds_read_b128 a[36:39], v31
v_add_f32 v167, v167, v187
MAA 88,104,52
TR 80,25,49664
MAA 160,112,56
TR 82,25,50176
MAA 160,116,76
buffer_load_dwordx4 v20, s[20:23], s54 offen offset:2048 lds
MAA 120,116,72
TR 84,25,62080
s_add_u32 s54, s54, 196608
MAA 120,112,52
TR 86,25,62592
s_add_u32 m0, s55, 57792
MAA 116,112,48
TR 88,25,50688
MAA 116,116,68
buffer_load_dwordx4 v21, s[36:39], s53 offen lds
MAA 112,116,64
TR 90,25,51200
MAA 112,112,44
TR 92,25,63104
MAA 108,112,40
TR 94,25,63616
MAA 108,116,60
buffer_load_dwordx4 v28, s[36:39], s53 offen offset:1024 lds
MAA 140,60,124
TR 96,25,51712
MAA 140,40,120
TR 98,25,52224
MAA 144,44,120
TR 100,25,64128
MAA 144,64,124
buffer_load_dword v29, s[36:39], s53 offen offset:2048 lds
MAA 148,68,124
TR 102,25,64640
s_add_u32 s53, s53, 128
MAA 148,48,120
MAA 152,52,120
MAA 152,72,124
s_waitcnt lgkmcnt(8)
s_barrier
MAA 60,80,0
TR 104,25,49696
s_add_u32 m0, s56, 111232
MAA 60,84,20
buffer_load_dwordx4 v18, s[20:23], s54 offen lds
MAA 64,84,24
TR 106,25,50208
s_waitcnt vmcnt(14)
v_add_f32 v164, v164, v188
MAA 64,80,4
TR 108,25,62112
v_add_f32 v165, v165, v189
MAA 68,80,8
buffer_load_dwordx4 v19, s[20:23], s54 offen offset:1024 lds
MAA 68,84,28
TR 110,25,62624
v_add_f32 v166, v166, v190
MAA 72,84,32
TR 112,25,50720
v_add_f32 v167, v167, v191
MAA 72,80,12
buffer_load_dwordx4 v20, s[20:23], s54 offen offset:2048 lds
s_waitcnt lgkmcnt(5)
MAA 244,80,16
TR 114,25,51232
s_add_u32 s54, s54, 196608
MAA 244,84,36
TR 116,25,63136
s_add_u32 m0, s59, 0
MAA 156,92,36
TR 118,25,63648
s_xor_b32 s58, s87, 1048576
MAA 156,88,16
buffer_load_dwordx4 v5, s[24:27], s58 offen lds
MAA 104,88,12
TR 120,25,51744
MAA 104,92,32
TR 122,25,52256
MAA 100,92,28
buffer_load_dwordx4 v6, s[24:27], s58 offen offset:1024 lds
MAA 100,88,8
TR 124,25,64160
s_add_u32 m0, s59, 8320
MAA 96,88,4
TR 126,25,64672
s_xor_b32 s58, s87, 1179648
MAA 96,92,24
buffer_load_dwordx4 v5, s[24:27], s58 offen lds
MAA 92,92,20
RD 40,23,18496
MAA 92,88,0
RD 44,23,20800
MAA 124,0,96
buffer_load_dwordx4 v6, s[24:27], s58 offen offset:1024 lds
MAA 124,20,100
RD 48,23,23104
MAA 128,24,100
RD 52,23,25408
MAA 128,4,96
RD 56,24,18496
MAA 132,8,96
MAA 132,28,100
MAA 136,32,100
MAA 136,12,96
s_waitcnt vmcnt(17) lgkmcnt(5)
s_barrier
MAA 76,104,0
RD 60,30,18496
s_add_u32 m0, s56, 123648
MAA 76,108,20
buffer_load_dwordx4 v18, s[20:23], s54 offen lds
MAA 80,108,24
RD 64,30,20800
s_waitcnt vmcnt(14)
v_add_f32 v164, v164, v192
MAA 80,104,4
RD 68,30,23104
v_add_f32 v165, v165, v193
MAA 84,104,8
RD 72,30,25408
v_add_f32 v166, v166, v194
MAA 84,108,28
RD 76,31,18496
v_add_f32 v167, v167, v195
MAA 88,108,32
ds_read_b64_tr_b16 a[80:81], v25
MAA 88,104,12
TR 82,25,512
MAA 160,112,16
TR 84,25,12416
MAA 160,116,36
buffer_load_dwordx4 v19, s[20:23], s54 offen offset:1024 lds
MAA 120,116,32
TR 86,25,12928
MAA 120,112,12
TR 88,25,1024
MAA 116,112,8
TR 90,25,1536
MAA 116,116,28
TR 92,25,13440
MAA 112,116,24
TR 94,25,13952
MAA 112,112,4
TR 96,25,2048
MAA 108,112,0
TR 98,25,2560
MAA 108,116,20
buffer_load_dwordx4 v20, s[20:23], s54 offen offset:2048 lds
MAA 140,20,124
TR 100,25,14464
s_add_u32 s54, s54, 196608
MAA 140,0,120
TR 102,25,14976
MAA 144,4,120
MAA 144,24,124
MAA 148,28,124
MAA 148,8,120
MAA 152,12,120
MAA 152,32,124
s_waitcnt lgkmcnt(8)
s_barrier
MAA 60,80,40
TR 104,25,32
s_add_u32 m0, s56, 136064
MAA 60,84,60
buffer_load_dwordx4 v18, s[20:23], s54 offen lds
MAA 64,84,64
TR 106,25,544
MAA 64,80,44
TR 108,25,12448
MAA 68,80,48
buffer_load_dwordx4 v19, s[20:23], s54 offen offset:1024 lds
MAA 68,84,68
TR 110,25,12960
MAA 72,84,72
TR 112,25,1056
MAA 72,80,52
buffer_load_dwordx4 v20, s[20:23], s54 offen offset:2048 lds
s_waitcnt lgkmcnt(5)
MAA 244,80,56
TR 114,25,1568
s_add_u32 s54, s54, 196608
MAA 244,84,76
TR 116,25,13472
s_add_u32 m0, s59, 16640
MAA 156,92,76
TR 118,25,13984
s_xor_b32 s58, s87, 1310720
MAA 156,88,56
buffer_load_dwordx4 v5, s[24:27], s58 offen lds
MAA 104,88,52
TR 120,25,2080
MAA 104,92,72
TR 122,25,2592
MAA 100,92,68
buffer_load_dwordx4 v6, s[24:27], s58 offen offset:1024 lds
MAA 100,88,48
TR 124,25,14496
s_add_u32 m0, s59, 24960
MAA 96,88,44
TR 126,25,15008
s_xor_b32 s58, s87, 1441792
MAA 96,92,64
buffer_load_dwordx4 v5, s[24:27], s58 offen lds
MAA 92,92,60
RD 0,23,36992
MAA 92,88,40
RD 4,23,39296
MAA 124,40,96
buffer_load_dwordx4 v6, s[24:27], s58 offen offset:1024 lds
MAA 124,60,100
RD 8,23,41600
MAA 128,64,100
RD 12,23,43904
MAA 128,44,96
RD 16,24,36992
MAA 132,48,96
v_permlane32_swap_b32 v164, v166
MAA 132,68,100
v_permlane32_swap_b32 v165, v167
MAA 136,72,100
v_add_f32 v164, v164, v166
v_add_f32 v165, v165, v167
MAA 136,52,96
v_mul_f32 v164, 0xba800000, v164
v_mul_f32 v165, 0x3a800000, v165
v_fma_f32 v165, -v164, v164, v165
v_max_f32 v165, 0, v165
v_add_f32 v165, 0x3727c5ac, v165
v_rsq_f32 v166, v165
s_nop 0
v_mov_b32 v165, v166
v_mul_f32 v166, 0x3e8293ee, v166
s_waitcnt vmcnt(14) lgkmcnt(5)
s_barrier
MAA 76,104,40
ds_write_b128 v7, v[164:167]
s_add_u32 m0, s59, 74880
MAA 76,108,60
.Lpad4:
s_cbranch_execz .Lpad8
ds_write_b32 v17, v164
s_xor_b32 s58, s87, 131072
MAA 80,108,64
ds_write_b32 v17, v165 offset:1024
MAA 80,104,44
buffer_load_dwordx4 v5, s[24:27], s58 offen lds
MAA 84,104,48
RD 20,30,36992
MAA 84,108,68
RD 24,30,39296
MAA 88,108,72
RD 28,30,41600
MAA 88,104,52
RD 32,30,43904
MAA 160,112,56
RD 36,31,36992
MAA 160,116,76
buffer_load_dwordx4 v6, s[24:27], s58 offen offset:1024 lds
MAA 120,116,72
TR 80,25,24832
s_add_u32 m0, s59, 83200
MAA 120,112,52
TR 82,25,25344
s_xor_b32 s58, s87, 262144
MAA 116,112,48
TR 84,25,37248
MAA 116,116,68
TR 86,25,37760
MAA 112,116,64
TR 88,25,25856
MAA 112,112,44
buffer_load_dwordx4 v5, s[24:27], s58 offen lds
MAA 108,112,40
TR 90,25,26368
MAA 108,116,60
TR 92,25,38272
MAA 140,60,124
TR 94,25,38784
MAA 140,40,120
TR 96,25,26880
MAA 144,44,120
TR 98,25,27392
MAA 144,64,124
buffer_load_dwordx4 v6, s[24:27], s58 offen offset:1024 lds
MAA 148,68,124
TR 100,25,39296
MAA 148,48,120
TR 102,25,39808
MAA 152,52,120
MAA 152,72,124
s_waitcnt vmcnt(8) lgkmcnt(0)
s_barrier
MAA 156,88,16
TR 112,25,25888
s_add_u32 m0, s59, 33280
MAA 156,92,36
TR 114,25,26400
s_xor_b32 s58, s87, 1572864
MAA 104,92,32
buffer_load_dwordx4 v5, s[24:27], s58 offen lds
MAA 104,88,12
TR 116,25,38304
MAA 100,88,8
TR 118,25,38816
MAA 100,92,28
TR 120,25,26912
MAA 96,92,24
buffer_load_dwordx4 v6, s[24:27], s58 offen offset:1024 lds
MAA 96,88,4
TR 122,25,27424
s_add_u32 m0, s59, 41600
MAA 92,88,0
TR 124,25,39328
s_xor_b32 s58, s87, 1703936
MAA 92,92,20
TR 126,25,39840
MAA 136,32,100
buffer_load_dwordx4 v5, s[24:27], s58 offen lds
MAA 136,12,96
TR 104,25,24864
MAA 244,80,16
TR 106,25,25376
MAA 244,84,36
TR 108,25,37280
MAA 72,84,32
buffer_load_dwordx4 v6, s[24:27], s58 offen offset:1024 lds
MAA 72,80,12
TR 110,25,37792
s_xor_b32 s58, s87, 393216
MAA 68,80,8
RD 40,23,55488
MAA 68,84,28
RD 44,23,57792
MAA 64,84,24
RD 48,23,60096
MAA 64,80,4
RD 52,23,62400
MAA 60,80,0
RD 56,24,55488
MAA 60,84,20
RD 60,30,55488
s_waitcnt lgkmcnt(15)
MAA 160,112,16
RD 64,30,57792
s_waitcnt lgkmcnt(15)
MAA 160,116,36
s_waitcnt lgkmcnt(7)
s_barrier
RD 68,30,60096
MAA 120,116,32
RD 72,30,62400
s_add_u32 m0, s59, 91520
MAA 120,112,12
RD 76,31,55488
MAA 116,112,8
TR 144,25,50688
MAA 116,116,28
TR 146,25,51200
MAA 112,116,24
TR 148,25,63104
MAA 112,112,4
TR 150,25,63616
MAA 108,112,0
TR 152,25,50720
MAA 108,116,20
TR 154,25,51232
MAA 152,32,124
TR 156,25,63136
MAA 152,12,120
TR 158,25,63648
MAA 88,104,12
TR 160,25,51712
MAA 88,108,32
TR 162,25,52224
MAA 84,108,28
TR 164,25,64128
MAA 84,104,8
TR 166,25,64640
MAA 80,104,4
TR 168,25,51744
MAA 80,108,24
TR 170,25,52256
MAA 76,108,20
TR 172,25,64160
MAA 76,104,0
TR 174,25,64672
s_waitcnt lgkmcnt(14)
MAA 156,144,56
TR 128,25,49664
s_waitcnt lgkmcnt(13)
MAA 156,148,76
TR 130,25,50176
MAA 104,148,72
TR 132,25,62080
MAA 104,144,52
TR 134,25,62592
MAA 100,144,48
TR 136,25,49696
MAA 100,148,68
TR 138,25,50208
MAA 96,148,64
TR 140,25,62112
MAA 96,144,44
TR 142,25,62624
MAA 92,144,40
ds_read_b128 v[232:235], v10 offset:768
MAA 92,148,60
ds_read_b128 v[236:239], v10 offset:2816
s_waitcnt lgkmcnt(15)
MAA 160,156,76
ds_read_b128 v[228:231], v10 offset:512
MAA 160,152,56
ds_read_b128 v[224:227], v10 offset:256
MAA 120,152,52
ds_read_b128 v[220:223], v10
MAA 120,156,72
buffer_load_dwordx4 v5, s[24:27], s58 offen lds
MAA 116,156,68
MAA 116,152,48
s_waitcnt lgkmcnt(5)
s_barrier
MAA 112,152,44
MAA 112,156,64
buffer_load_dwordx4 v6, s[24:27], s58 offen offset:1024 lds
MAA 108,156,60
s_add_u32 m0, s59, 99840
s_xor_b32 s58, s87, 524288
MAA 108,152,40
MAA 136,52,160
MAA 136,72,164
buffer_load_dwordx4 v5, s[24:27], s58 offen lds
MAA 152,72,172
MAA 152,52,168
MAA 244,128,56
MAA 244,132,76
buffer_load_dwordx4 v6, s[24:27], s58 offen offset:1024 lds
MAA 72,132,72
s_add_u32 m0, s59, 108160
s_xor_b32 s58, s87, 655360
MAA 72,128,52
MAA 68,128,48
MAA 68,132,68
buffer_load_dwordx4 v5, s[24:27], s58 offen lds
buffer_load_dwordx4 v6, s[24:27], s58 offen offset:1024 lds
s_mov_b32 exec_lo, 0x10001
s_mov_b32 exec_hi, 0x10001
ds_write_b128 v13, v[244:247]
ds_write_b128 v13, v[156:159] offset:256
ds_write_b128 v13, v[160:163] offset:320
s_mov_b64 exec, -1
MAA 64,128,44
MAA 64,132,64
MAA 60,132,60
MAA 60,128,40
MAA 88,136,52
MAA 88,140,72
s_waitcnt lgkmcnt(0)
s_barrier
MAA 84,136,48
ds_read_b128 v[28:31], v13
s_add_u32 m0, s59, 49920
MAA 84,140,68
ds_read_b128 v[32:35], v13 offset:64
s_xor_b32 s58, s87, 1835008
MAA 80,140,64
ds_read_b128 v[36:39], v13 offset:256
MAA 80,136,44
ds_read_b128 v[40:43], v13 offset:320
MAA 76,136,40
ds_read_b32 v44, v12 offset:512
MAA 76,140,60
ds_read_b32 v45, v12 offset:576
ds_read_b128 v[240:243], v11 offset:192
ds_read_b128 v[244:247], v11 offset:1216
ds_read_b128 v[18:21], v11 offset:128
ds_read_b128 v[22:25], v11 offset:1152
buffer_load_dwordx4 v5, s[24:27], s58 offen lds
s_waitcnt lgkmcnt(9)
v_pk_fma_f32 v[72:73], v[28:29], v[232:233], v[72:73] op_sel_hi:[1,0,1]
v_cvt_pk_bf16_f32 v176, v72, v73
v_pk_fma_f32 v[74:75], v[30:31], v[232:233], v[74:75] op_sel_hi:[1,0,1]
v_cvt_pk_bf16_f32 v177, v74, v75
s_waitcnt lgkmcnt(8)
v_pk_fma_f32 v[88:89], v[32:33], v[232:233], v[88:89] op_sel_hi:[1,0,1]
v_cvt_pk_bf16_f32 v178, v88, v89
v_pk_fma_f32 v[90:91], v[34:35], v[232:233], v[90:91] op_sel_hi:[1,0,1]
s_waitcnt lgkmcnt(7)
v_pk_fma_f32 v[104:105], v[36:37], v[232:233], v[104:105] op_sel_hi:[1,0,1]
v_pk_mul_f32 v[104:105], v[104:105], v[232:233] op_sel:[0,1] op_sel_hi:[1,1]
v_cvt_pk_bf16_f32 v196, v104, v105
v_pk_fma_f32 v[106:107], v[38:39], v[232:233], v[106:107] op_sel_hi:[1,0,1]
v_pk_mul_f32 v[106:107], v[106:107], v[232:233] op_sel:[0,1] op_sel_hi:[1,1]
v_cvt_pk_bf16_f32 v197, v106, v107
s_waitcnt lgkmcnt(6)
v_pk_fma_f32 v[120:121], v[40:41], v[232:233], v[120:121] op_sel_hi:[1,0,1]
v_pk_mul_f32 v[120:121], v[120:121], v[232:233] op_sel:[0,1] op_sel_hi:[1,1]
v_cvt_pk_bf16_f32 v198, v120, v121
v_pk_fma_f32 v[122:123], v[42:43], v[232:233], v[122:123] op_sel_hi:[1,0,1]
v_pk_mul_f32 v[122:123], v[122:123], v[232:233] op_sel:[0,1] op_sel_hi:[1,1]
v_cvt_pk_bf16_f32 v199, v122, v123
ds_write_b128 v8, v[196:199]
s_waitcnt lgkmcnt(4)
v_pk_fma_f32 v[136:137], v[240:241], v[44:45], v[136:137] op_sel_hi:[1,0,1]
v_pk_fma_f32 v[138:139], v[242:243], v[44:45], v[138:139] op_sel_hi:[1,0,1]
s_waitcnt lgkmcnt(3)
v_pk_mul_f32 v[136:137], v[136:137], v[244:245]
v_cvt_pk_bf16_f32 v208, v136, v137
v_pk_mul_f32 v[138:139], v[138:139], v[246:247]
v_cvt_pk_bf16_f32 v209, v138, v139
v_pk_fma_f32 v[152:153], v[240:241], v[44:45], v[152:153] op_sel:[0,1,0] op_sel_hi:[1,1,1]
v_pk_mul_f32 v[152:153], v[152:153], v[244:245]
v_cvt_pk_bf16_f32 v218, v152, v153
v_pk_fma_f32 v[154:155], v[242:243], v[44:45], v[154:155] op_sel:[0,1,0] op_sel_hi:[1,1,1]
v_pk_mul_f32 v[154:155], v[154:155], v[246:247]
v_cvt_pk_bf16_f32 v219, v154, v155
ds_write_b64 v8, v[208:209] offset:1024
ds_write_b64 v8, v[218:219] offset:1032
v_pk_fma_f32 v[156:157], v[36:37], v[236:237], v[156:157] op_sel_hi:[1,0,1]
v_pk_mul_f32 v[156:157], v[156:157], v[236:237] op_sel:[0,1] op_sel_hi:[1,1]
v_cvt_pk_bf16_f32 v180, v156, v157
v_pk_fma_f32 v[158:159], v[38:39], v[236:237], v[158:159] op_sel_hi:[1,0,1]
v_pk_mul_f32 v[158:159], v[158:159], v[236:237] op_sel:[0,1] op_sel_hi:[1,1]
v_cvt_pk_bf16_f32 v181, v158, v159
v_pk_fma_f32 v[160:161], v[40:41], v[236:237], v[160:161] op_sel_hi:[1,0,1]
v_pk_mul_f32 v[160:161], v[160:161], v[236:237] op_sel:[0,1] op_sel_hi:[1,1]
v_cvt_pk_bf16_f32 v182, v160, v161
v_pk_fma_f32 v[162:163], v[42:43], v[236:237], v[162:163] op_sel_hi:[1,0,1]
v_pk_mul_f32 v[162:163], v[162:163], v[236:237] op_sel:[0,1] op_sel_hi:[1,1]
v_cvt_pk_bf16_f32 v183, v162, v163
v_pk_fma_f32 v[100:101], v[36:37], v[228:229], v[100:101] op_sel_hi:[1,0,1]
v_pk_mul_f32 v[100:101], v[100:101], v[228:229] op_sel:[0,1] op_sel_hi:[1,1]
v_cvt_pk_bf16_f32 v192, v100, v101
v_pk_fma_f32 v[102:103], v[38:39], v[228:229], v[102:103] op_sel_hi:[1,0,1]
v_pk_mul_f32 v[102:103], v[102:103], v[228:229] op_sel:[0,1] op_sel_hi:[1,1]
v_cvt_pk_bf16_f32 v193, v102, v103
v_pk_fma_f32 v[116:117], v[40:41], v[228:229], v[116:117] op_sel_hi:[1,0,1]
v_pk_mul_f32 v[116:117], v[116:117], v[228:229] op_sel:[0,1] op_sel_hi:[1,1]
v_cvt_pk_bf16_f32 v194, v116, v117
v_pk_fma_f32 v[118:119], v[42:43], v[228:229], v[118:119] op_sel_hi:[1,0,1]
v_pk_mul_f32 v[118:119], v[118:119], v[228:229] op_sel:[0,1] op_sel_hi:[1,1]
s_waitcnt lgkmcnt(0)
s_barrier
v_cvt_pk_bf16_f32 v195, v118, v119
v_pk_fma_f32 v[96:97], v[36:37], v[224:225], v[96:97] op_sel_hi:[1,0,1]
v_pk_mul_f32 v[96:97], v[96:97], v[224:225] op_sel:[0,1] op_sel_hi:[1,1]
v_cvt_pk_bf16_f32 v188, v96, v97
v_pk_fma_f32 v[98:99], v[38:39], v[224:225], v[98:99] op_sel_hi:[1,0,1]
v_pk_mul_f32 v[98:99], v[98:99], v[224:225] op_sel:[0,1] op_sel_hi:[1,1]
v_cvt_pk_bf16_f32 v189, v98, v99
v_pk_fma_f32 v[112:113], v[40:41], v[224:225], v[112:113] op_sel_hi:[1,0,1]
v_pk_mul_f32 v[112:113], v[112:113], v[224:225] op_sel:[0,1] op_sel_hi:[1,1]
v_cvt_pk_bf16_f32 v190, v112, v113
v_pk_fma_f32 v[114:115], v[42:43], v[224:225], v[114:115] op_sel_hi:[1,0,1]
v_pk_mul_f32 v[114:115], v[114:115], v[224:225] op_sel:[0,1] op_sel_hi:[1,1]
v_cvt_pk_bf16_f32 v191, v114, v115
v_pk_fma_f32 v[92:93], v[36:37], v[220:221], v[92:93] op_sel_hi:[1,0,1]
v_pk_mul_f32 v[92:93], v[92:93], v[220:221] op_sel:[0,1] op_sel_hi:[1,1]
v_cvt_pk_bf16_f32 v184, v92, v93
v_pk_fma_f32 v[94:95], v[38:39], v[220:221], v[94:95] op_sel_hi:[1,0,1]
v_pk_mul_f32 v[94:95], v[94:95], v[220:221] op_sel:[0,1] op_sel_hi:[1,1]
v_cvt_pk_bf16_f32 v185, v94, v95
v_pk_fma_f32 v[108:109], v[40:41], v[220:221], v[108:109] op_sel_hi:[1,0,1]
v_pk_mul_f32 v[108:109], v[108:109], v[220:221] op_sel:[0,1] op_sel_hi:[1,1]
v_cvt_pk_bf16_f32 v186, v108, v109
v_pk_fma_f32 v[110:111], v[42:43], v[220:221], v[110:111] op_sel_hi:[1,0,1]
v_pk_mul_f32 v[110:111], v[110:111], v[220:221] op_sel:[0,1] op_sel_hi:[1,1]
v_cvt_pk_bf16_f32 v187, v110, v111
v_cvt_pk_bf16_f32 v179, v90, v91
v_pk_fma_f32 v[68:69], v[28:29], v[228:229], v[68:69] op_sel_hi:[1,0,1]
v_cvt_pk_bf16_f32 v172, v68, v69
v_pk_fma_f32 v[70:71], v[30:31], v[228:229], v[70:71] op_sel_hi:[1,0,1]
v_cvt_pk_bf16_f32 v173, v70, v71
v_pk_fma_f32 v[84:85], v[32:33], v[228:229], v[84:85] op_sel_hi:[1,0,1]
v_cvt_pk_bf16_f32 v174, v84, v85
v_pk_fma_f32 v[86:87], v[34:35], v[228:229], v[86:87] op_sel_hi:[1,0,1]
v_cvt_pk_bf16_f32 v175, v86, v87
v_pk_fma_f32 v[64:65], v[28:29], v[224:225], v[64:65] op_sel_hi:[1,0,1]
v_cvt_pk_bf16_f32 v168, v64, v65
v_pk_fma_f32 v[66:67], v[30:31], v[224:225], v[66:67] op_sel_hi:[1,0,1]
v_cvt_pk_bf16_f32 v169, v66, v67
v_pk_fma_f32 v[80:81], v[32:33], v[224:225], v[80:81] op_sel_hi:[1,0,1]
v_cvt_pk_bf16_f32 v170, v80, v81
v_pk_fma_f32 v[82:83], v[34:35], v[224:225], v[82:83] op_sel_hi:[1,0,1]
v_cvt_pk_bf16_f32 v171, v82, v83
v_pk_fma_f32 v[60:61], v[28:29], v[220:221], v[60:61] op_sel_hi:[1,0,1]
v_cvt_pk_bf16_f32 v164, v60, v61
v_pk_fma_f32 v[62:63], v[30:31], v[220:221], v[62:63] op_sel_hi:[1,0,1]
v_cvt_pk_bf16_f32 v165, v62, v63
v_pk_fma_f32 v[76:77], v[32:33], v[220:221], v[76:77] op_sel_hi:[1,0,1]
v_cvt_pk_bf16_f32 v166, v76, v77
v_pk_fma_f32 v[78:79], v[34:35], v[220:221], v[78:79] op_sel_hi:[1,0,1]
v_cvt_pk_bf16_f32 v167, v78, v79
s_nop 0
v_mfma_f32_16x16x32_bf16 v[120:123], v[196:199], v[176:179], v[50:53]
buffer_load_dwordx4 v6, s[24:27], s58 offen offset:1024 lds
v_mfma_f32_16x16x32_bf16 v[104:107], v[192:195], v[176:179], v[46:49]
ds_read_b64 v[200:201], v9 offset:1024
s_add_u32 m0, s59, 58240
v_mfma_f32_16x16x32_bf16 v[116:119], v[192:195], v[172:175], v[50:53]
ds_read_b64 v[210:211], v9 offset:1032
s_xor_b32 s58, s87, 1966080
v_mfma_f32_16x16x32_bf16 v[100:103], v[188:191], v[172:175], v[46:49]
ds_read_b128 v[240:243], v11 offset:64
v_mfma_f32_16x16x32_bf16 v[112:115], v[188:191], v[168:171], v[50:53]
buffer_load_dwordx4 v5, s[24:27], s58 offen lds
v_mfma_f32_16x16x32_bf16 v[96:99], v[184:187], v[168:171], v[46:49]
ds_read_b128 v[244:247], v11 offset:1088
v_max3_f32 v88, v104, v105, v106
v_mfma_f32_16x16x32_bf16 v[108:111], v[184:187], v[164:167], v[50:53]
ds_read_b128 v[28:31], v11
v_max3_f32 v89, v107, v120, v121
v_mfma_f32_16x16x32_bf16 v[92:95], v[180:183], v[164:167], v[54:57]
ds_read_b128 v[32:35], v11 offset:1024
v_max3_f32 v88, v88, v122, v123
MAA 132,8,96
buffer_load_dwordx4 v6, s[24:27], s58 offen offset:1024 lds
MAA 132,28,100
s_add_u32 m0, s59, 66560
s_xor_b32 s58, s87, 0
v_max_f32 v90, v88, v89
MAA 132,48,160
v_max_f32 v89, v88, v89
v_max3_f32 v84, v100, v101, v102
MAA 132,68,164
v_permlane16_swap_b32 v90, v89
MAA 148,68,172
buffer_load_dwordx4 v5, s[24:27], s58 offen lds
MAA 148,48,168
v_max_f32 v88, v90, v89
v_max_f32 v89, v90, v89
MAA 148,28,124
s_nop 0
v_permlane32_swap_b32 v88, v89
MAA 148,8,120
v_max_f32 v88, v88, v89
v_mul_f32 v88, v88, v234
v_max3_f32 v85, v103, v116, v117
v_max3_f32 v84, v84, v118, v119
v_max_f32 v86, v84, v85
v_max_f32 v85, v84, v85
v_max3_f32 v80, v96, v97, v98
v_max3_f32 v81, v99, v112, v113
v_permlane16_swap_b32 v86, v85
v_max3_f32 v80, v80, v114, v115
v_max_f32 v84, v86, v85
v_max_f32 v85, v86, v85
v_max_f32 v82, v80, v81
v_max_f32 v81, v80, v81
v_permlane32_swap_b32 v84, v85
v_max3_f32 v76, v92, v93, v94
v_max_f32 v84, v84, v85
v_mul_f32 v84, v84, v230
v_permlane16_swap_b32 v82, v81
v_max3_f32 v77, v95, v108, v109
v_max_f32 v80, v82, v81
v_max_f32 v81, v82, v81
v_max3_f32 v76, v76, v110, v111
v_max_f32 v78, v76, v77
v_permlane32_swap_b32 v80, v81
v_max_f32 v77, v76, v77
v_max_f32 v80, v80, v81
v_mul_f32 v80, v80, v226
v_permlane16_swap_b32 v78, v77
v_pk_fma_f32 v[104:105], v[104:105], v[234:235], v[88:89] op_sel_hi:[1,0,0] neg_lo:[0,0,1] neg_hi:[0,0,1]
v_max_f32 v76, v78, v77
v_max_f32 v77, v78, v77
v_pk_fma_f32 v[106:107], v[106:107], v[234:235], v[88:89] op_sel_hi:[1,0,0] neg_lo:[0,0,1] neg_hi:[0,0,1]
v_pk_fma_f32 v[120:121], v[120:121], v[234:235], v[88:89] op_sel_hi:[1,0,0] neg_lo:[0,0,1] neg_hi:[0,0,1]
v_permlane32_swap_b32 v76, v77
v_pk_fma_f32 v[122:123], v[122:123], v[234:235], v[88:89] op_sel_hi:[1,0,0] neg_lo:[0,0,1] neg_hi:[0,0,1]
v_max_f32 v76, v76, v77
v_mul_f32 v76, v76, v222
v_pk_fma_f32 v[100:101], v[100:101], v[230:231], v[84:85] op_sel_hi:[1,0,0] neg_lo:[0,0,1] neg_hi:[0,0,1]
v_pk_fma_f32 v[102:103], v[102:103], v[230:231], v[84:85] op_sel_hi:[1,0,0] neg_lo:[0,0,1] neg_hi:[0,0,1]
v_pk_fma_f32 v[116:117], v[116:117], v[230:231], v[84:85] op_sel_hi:[1,0,0] neg_lo:[0,0,1] neg_hi:[0,0,1]
v_pk_fma_f32 v[118:119], v[118:119], v[230:231], v[84:85] op_sel_hi:[1,0,0] neg_lo:[0,0,1] neg_hi:[0,0,1]
v_pk_fma_f32 v[96:97], v[96:97], v[226:227], v[80:81] op_sel_hi:[1,0,0] neg_lo:[0,0,1] neg_hi:[0,0,1]
v_pk_fma_f32 v[98:99], v[98:99], v[226:227], v[80:81] op_sel_hi:[1,0,0] neg_lo:[0,0,1] neg_hi:[0,0,1]
v_pk_fma_f32 v[112:113], v[112:113], v[226:227], v[80:81] op_sel_hi:[1,0,0] neg_lo:[0,0,1] neg_hi:[0,0,1]
v_pk_fma_f32 v[114:115], v[114:115], v[226:227], v[80:81] op_sel_hi:[1,0,0] neg_lo:[0,0,1] neg_hi:[0,0,1]
v_pk_fma_f32 v[92:93], v[92:93], v[222:223], v[76:77] op_sel_hi:[1,0,0] neg_lo:[0,0,1] neg_hi:[0,0,1]
v_pk_fma_f32 v[94:95], v[94:95], v[222:223], v[76:77] op_sel_hi:[1,0,0] neg_lo:[0,0,1] neg_hi:[0,0,1]
v_pk_fma_f32 v[108:109], v[108:109], v[222:223], v[76:77] op_sel_hi:[1,0,0] neg_lo:[0,0,1] neg_hi:[0,0,1]
v_pk_fma_f32 v[110:111], v[110:111], v[222:223], v[76:77] op_sel_hi:[1,0,0] neg_lo:[0,0,1] neg_hi:[0,0,1]
v_pk_fma_f32 v[132:133], v[18:19], v[44:45], v[132:133] op_sel_hi:[1,0,1]
v_pk_mul_f32 v[132:133], v[132:133], v[22:23]
v_pk_fma_f32 v[134:135], v[20:21], v[44:45], v[134:135] op_sel_hi:[1,0,1]
v_pk_mul_f32 v[134:135], v[134:135], v[24:25]
v_pk_fma_f32 v[148:149], v[18:19], v[44:45], v[148:149] op_sel:[0,1,0] op_sel_hi:[1,1,1]
v_pk_mul_f32 v[148:149], v[148:149], v[22:23]
v_pk_fma_f32 v[150:151], v[20:21], v[44:45], v[150:151] op_sel:[0,1,0] op_sel_hi:[1,1,1]
v_pk_mul_f32 v[150:151], v[150:151], v[24:25]
v_exp_f32 v104, v104
s_nop 0
MAA 128,4,96
buffer_load_dwordx4 v6, s[24:27], s58 offen offset:1024 lds
MAA 128,24,100
s_add_u32 m0, s59, 116480
s_xor_b32 s58, s87, 786432
v_exp_f32 v105, v105
MAA 128,44,160
v_exp_f32 v106, v106
MAA 128,64,164
v_exp_f32 v107, v107
MAA 144,64,172
buffer_load_dwordx4 v5, s[24:27], s58 offen lds
MAA 144,44,168
v_exp_f32 v120, v120
MAA 144,24,124
v_exp_f32 v121, v121
MAA 144,4,120
v_exp_f32 v122, v122
MAA 124,0,96
buffer_load_dwordx4 v6, s[24:27], s58 offen offset:1024 lds
MAA 124,20,100
s_add_u32 m0, s59, 124800
s_xor_b32 s58, s87, 917504
v_exp_f32 v123, v123
MAA 124,40,160
v_exp_f32 v100, v100
MAA 124,60,164
v_exp_f32 v101, v101
MAA 140,60,172
buffer_load_dwordx4 v5, s[24:27], s58 offen lds
MAA 140,40,168
v_exp_f32 v102, v102
MAA 140,20,124
v_exp_f32 v103, v103
MAA 140,0,120
v_cvt_pk_bf16_f32 v72, v104, v105
v_cvt_pk_bf16_f32 v73, v106, v107
v_cvt_pk_bf16_f32 v74, v120, v121
v_cvt_pk_bf16_f32 v75, v122, v123
v_exp_f32 v116, v116
v_exp_f32 v117, v117
v_exp_f32 v118, v118
v_exp_f32 v119, v119
v_cvt_pk_bf16_f32 v68, v100, v101
v_cvt_pk_bf16_f32 v69, v102, v103
v_cvt_pk_bf16_f32 v70, v116, v117
v_cvt_pk_bf16_f32 v71, v118, v119
v_exp_f32 v96, v96
v_exp_f32 v97, v97
v_exp_f32 v98, v98
v_exp_f32 v99, v99
v_exp_f32 v112, v112
v_exp_f32 v113, v113
v_exp_f32 v114, v114
v_exp_f32 v115, v115
v_cvt_pk_bf16_f32 v64, v96, v97
v_cvt_pk_bf16_f32 v65, v98, v99
v_cvt_pk_bf16_f32 v66, v112, v113
v_cvt_pk_bf16_f32 v67, v114, v115
v_cvt_pk_bf16_f32 v206, v132, v133
v_cvt_pk_bf16_f32 v207, v134, v135
v_cvt_pk_bf16_f32 v216, v148, v149
v_cvt_pk_bf16_f32 v217, v150, v151
s_waitcnt lgkmcnt(3)
v_pk_fma_f32 v[128:129], v[240:241], v[44:45], v[128:129] op_sel_hi:[1,0,1]
s_waitcnt lgkmcnt(2)
v_pk_mul_f32 v[128:129], v[128:129], v[244:245]
v_cvt_pk_bf16_f32 v204, v128, v129
v_pk_fma_f32 v[130:131], v[242:243], v[44:45], v[130:131] op_sel_hi:[1,0,1]
v_pk_mul_f32 v[130:131], v[130:131], v[246:247]
v_cvt_pk_bf16_f32 v205, v130, v131
v_pk_fma_f32 v[144:145], v[240:241], v[44:45], v[144:145] op_sel:[0,1,0] op_sel_hi:[1,1,1]
v_pk_mul_f32 v[144:145], v[144:145], v[244:245]
v_cvt_pk_bf16_f32 v214, v144, v145
v_pk_fma_f32 v[146:147], v[242:243], v[44:45], v[146:147] op_sel:[0,1,0] op_sel_hi:[1,1,1]
v_pk_mul_f32 v[146:147], v[146:147], v[246:247]
v_cvt_pk_bf16_f32 v215, v146, v147
s_waitcnt lgkmcnt(1)
v_pk_fma_f32 v[124:125], v[28:29], v[44:45], v[124:125] op_sel_hi:[1,0,1]
s_waitcnt lgkmcnt(0)
v_pk_mul_f32 v[124:125], v[124:125], v[32:33]
v_cvt_pk_bf16_f32 v202, v124, v125
v_pk_fma_f32 v[126:127], v[30:31], v[44:45], v[126:127] op_sel_hi:[1,0,1]
v_pk_mul_f32 v[126:127], v[126:127], v[34:35]
v_cvt_pk_bf16_f32 v203, v126, v127
v_pk_fma_f32 v[140:141], v[28:29], v[44:45], v[140:141] op_sel:[0,1,0] op_sel_hi:[1,1,1]
v_pk_mul_f32 v[140:141], v[140:141], v[32:33]
v_cvt_pk_bf16_f32 v212, v140, v141
v_pk_fma_f32 v[142:143], v[30:31], v[44:45], v[142:143] op_sel:[0,1,0] op_sel_hi:[1,1,1]
v_pk_mul_f32 v[142:143], v[142:143], v[34:35]
v_cvt_pk_bf16_f32 v213, v142, v143
s_nop 0
v_mfma_f32_16x16x32_bf16 v[88:91], v[248:251], v[72:75], 0
buffer_load_dwordx4 v6, s[24:27], s58 offen offset:1024 lds
v_mfma_f32_16x16x32_bf16 v[104:107], v[206:209], v[72:75], 0
v_exp_f32 v92, v92
v_mfma_f32_16x16x32_bf16 v[120:123], v[216:219], v[72:75], 0
v_exp_f32 v93, v93
v_mfma_f32_16x16x32_bf16 v[84:87], v[248:251], v[68:71], 0
v_exp_f32 v94, v94
v_mfma_f32_16x16x32_bf16 v[100:103], v[204:207], v[68:71], 0
v_exp_f32 v95, v95
v_mfma_f32_16x16x32_bf16 v[116:119], v[214:217], v[68:71], 0
.Lpad5:
s_cbranch_execz .Lpad9
v_exp_f32 v108, v108
v_mfma_f32_16x16x32_bf16 v[80:83], v[248:251], v[64:67], 0
v_exp_f32 v109, v109
v_mfma_f32_16x16x32_bf16 v[96:99], v[202:205], v[64:67], 0
v_exp_f32 v110, v110
v_mfma_f32_16x16x32_bf16 v[112:115], v[212:215], v[64:67], 0
v_exp_f32 v111, v111
v_cvt_pk_bf16_f32 v60, v92, v93
v_cvt_pk_bf16_f32 v61, v94, v95
v_cvt_pk_bf16_f32 v62, v108, v109
v_cvt_pk_bf16_f32 v63, v110, v111
v_rcp_f32 v88, v88
v_rcp_f32 v84, v84
v_mfma_f32_16x16x32_bf16 v[76:79], v[248:251], v[60:63], 0
v_rcp_f32 v80, v80
v_mfma_f32_16x16x32_bf16 v[92:95], v[200:203], v[60:63], 0
v_mfma_f32_16x16x32_bf16 v[108:111], v[210:213], v[60:63], 0
s_nop 4
v_rcp_f32 v76, v76
v_pk_mul_f32 v[104:105], v[104:105], v[88:89] op_sel_hi:[1,0]
v_pk_mul_f32 v[106:107], v[106:107], v[88:89] op_sel_hi:[1,0]
v_pk_mul_f32 v[120:121], v[120:121], v[88:89] op_sel_hi:[1,0]
v_pk_mul_f32 v[122:123], v[122:123], v[88:89] op_sel_hi:[1,0]
v_cvt_pk_bf16_f32 v176, v104, v105
v_cvt_pk_bf16_f32 v177, v106, v107
v_cvt_pk_bf16_f32 v178, v120, v121
v_cvt_pk_bf16_f32 v179, v122, v123
buffer_store_dwordx4 v[176:179], v4, s[16:19], s74 offen offset:3072 sc1
v_pk_mul_f32 v[100:101], v[100:101], v[84:85] op_sel_hi:[1,0]
v_pk_mul_f32 v[102:103], v[102:103], v[84:85] op_sel_hi:[1,0]
v_pk_mul_f32 v[116:117], v[116:117], v[84:85] op_sel_hi:[1,0]
v_pk_mul_f32 v[118:119], v[118:119], v[84:85] op_sel_hi:[1,0]
v_cvt_pk_bf16_f32 v172, v100, v101
v_cvt_pk_bf16_f32 v173, v102, v103
v_cvt_pk_bf16_f32 v174, v116, v117
v_cvt_pk_bf16_f32 v175, v118, v119
buffer_store_dwordx4 v[172:175], v4, s[16:19], s74 offen offset:2048 sc1
v_pk_mul_f32 v[96:97], v[96:97], v[80:81] op_sel_hi:[1,0]
v_pk_mul_f32 v[98:99], v[98:99], v[80:81] op_sel_hi:[1,0]
v_pk_mul_f32 v[112:113], v[112:113], v[80:81] op_sel_hi:[1,0]
v_pk_mul_f32 v[114:115], v[114:115], v[80:81] op_sel_hi:[1,0]
v_cvt_pk_bf16_f32 v168, v96, v97
v_cvt_pk_bf16_f32 v169, v98, v99
v_cvt_pk_bf16_f32 v170, v112, v113
v_cvt_pk_bf16_f32 v171, v114, v115
buffer_store_dwordx4 v[168:171], v4, s[16:19], s74 offen offset:1024 sc1
v_pk_mul_f32 v[92:93], v[92:93], v[76:77] op_sel_hi:[1,0]
v_pk_mul_f32 v[94:95], v[94:95], v[76:77] op_sel_hi:[1,0]
v_pk_mul_f32 v[108:109], v[108:109], v[76:77] op_sel_hi:[1,0]
v_pk_mul_f32 v[110:111], v[110:111], v[76:77] op_sel_hi:[1,0]
v_cvt_pk_bf16_f32 v164, v92, v93
v_cvt_pk_bf16_f32 v165, v94, v95
v_cvt_pk_bf16_f32 v166, v108, v109
v_cvt_pk_bf16_f32 v167, v110, v111
buffer_store_dwordx4 v[164:167], v4, s[16:19], s74 offen sc1
s_nop 1
s_branch .Lqkve2
.Lx4:
buffer_load_dword v27, v14, s[76:79], 0 offen
s_mov_b32 s76, s98
s_mov_b32 s77, s99
s_mov_b32 s78, s100
v_mov_b32 v14, v15
s_mov_b32 s47, 5
s_branch .Lx4b
.Lx5:
buffer_load_dword v27, v14, s[76:79], 0 offen
s_mov_b32 s76, s98
s_mov_b32 s77, s99
s_mov_b32 s78, s100
v_mov_b32 v14, v15
s_mov_b32 s47, 5
s_branch .Lx5b
.Lx6:
buffer_load_dword v27, v14, s[76:79], 0 offen
s_mov_b32 s76, s98
s_mov_b32 s77, s99
s_mov_b32 s78, s100
v_mov_b32 v14, v15
s_mov_b32 s47, 5
s_branch .Lx6b
.Lx7:
buffer_load_dword v27, v14, s[76:79], 0 offen
s_mov_b32 s76, s98
s_mov_b32 s77, s99
s_mov_b32 s78, s100
v_mov_b32 v14, v15
s_mov_b32 s47, 5
s_branch .Lx7b
.Lsp8:
s_mov_b32 s15, 0
.Lsp8l:
v_mov_b32 v37, 0
buffer_atomic_add v37, v34, s[40:43], 0 offen sc0
s_add_u32 s15, s15, 1
s_cmp_gt_u32 s15, 100000
s_waitcnt vmcnt(0)
s_cbranch_scc1 .Lsp8b
v_cmp_gt_u32 vcc, v35, v37
s_nop 0
s_cbranch_vccnz .Lsp8l
s_branch .Lsp8b
.Lx9:
buffer_load_dword v27, v14, s[76:79], 0 offen
s_mov_b32 s76, s98
s_mov_b32 s77, s99
s_mov_b32 s78, s100
v_mov_b32 v14, v15
s_mov_b32 s47, 5
s_branch .Lx9b
.Lx10:
buffer_load_dword v27, v14, s[76:79], 0 offen
s_mov_b32 s76, s98
s_mov_b32 s77, s99
s_mov_b32 s78, s100
v_mov_b32 v14, v15
s_mov_b32 s47, 5
s_branch .Lx10b
.Lx11:
buffer_load_dword v27, v14, s[76:79], 0 offen
s_mov_b32 s76, s98
s_mov_b32 s77, s99
s_mov_b32 s78, s100
v_mov_b32 v14, v15
s_mov_b32 s47, 5
s_branch .Lx11b
.Lx12:
buffer_load_dword v27, v14, s[76:79], 0 offen
s_mov_b32 s76, s98
s_mov_b32 s77, s99
s_mov_b32 s78, s100
v_mov_b32 v14, v15
s_mov_b32 s47, 5
s_branch .Lx12b
.Lsp13:
s_mov_b32 s15, 0
.Lsp13l:
v_mov_b32 v37, 0
buffer_atomic_add v37, v33, s[16:19], 0 offen sc0
s_add_u32 s15, s15, 1
s_cmp_gt_u32 s15, 100000
s_waitcnt vmcnt(0)
s_cbranch_scc1 .Lsp13b
v_cmp_gt_u32 vcc, v36, v37
s_nop 0
s_cbranch_vccnz .Lsp13l
s_branch .Lsp13b
.Lx14:
buffer_load_dword v27, v14, s[76:79], 0 offen
s_mov_b32 s76, s98
s_mov_b32 s77, s99
s_mov_b32 s78, s100
v_mov_b32 v14, v15
s_mov_b32 s47, 5
s_branch .Lx14b
.Lx15:
buffer_load_dword v27, v14, s[76:79], 0 offen
s_mov_b32 s76, s98
s_mov_b32 s77, s99
s_mov_b32 s78, s100
v_mov_b32 v14, v15
s_mov_b32 s47, 5
s_branch .Lx15b
.Lx16:
buffer_load_dword v27, v14, s[76:79], 0 offen
s_mov_b32 s76, s98
s_mov_b32 s77, s99
s_mov_b32 s78, s100
v_mov_b32 v14, v15
s_mov_b32 s47, 5
s_branch .Lx16b
.Lx17:
buffer_load_dword v27, v14, s[76:79], 0 offen
s_mov_b32 s76, s98
s_mov_b32 s77, s99
s_mov_b32 s78, s100
v_mov_b32 v14, v15
s_mov_b32 s47, 5
s_branch .Lx17b
.Lx19:
buffer_load_dword v27, v14, s[76:79], 0 offen
s_mov_b32 s76, s98
s_mov_b32 s77, s99
s_mov_b32 s78, s100
v_mov_b32 v14, v15
s_mov_b32 s47, 5
s_branch .Lx19b
.Lx20:
buffer_load_dword v27, v14, s[76:79], 0 offen
s_mov_b32 s76, s98
s_mov_b32 s77, s99
s_mov_b32 s78, s100
v_mov_b32 v14, v15
s_mov_b32 s47, 5
s_branch .Lx20b
.Lx21:
buffer_load_dword v27, v14, s[76:79], 0 offen
s_mov_b32 s76, s98
s_mov_b32 s77, s99
s_mov_b32 s78, s100
v_mov_b32 v14, v15
s_mov_b32 s47, 5
s_branch .Lx21b
.Lx22:
buffer_load_dword v27, v14, s[76:79], 0 offen
s_mov_b32 s76, s98
s_mov_b32 s77, s99
s_mov_b32 s78, s100
v_mov_b32 v14, v15
s_mov_b32 s47, 5
s_branch .Lx22b
.Lsp23:
s_mov_b32 s15, 0
.Lsp23l:
v_mov_b32 v37, 0
buffer_atomic_add v37, v34, s[40:43], 0 offen sc0
s_add_u32 s15, s15, 1
s_cmp_gt_u32 s15, 100000
s_waitcnt vmcnt(0)
s_cbranch_scc1 .Lsp23b
v_cmp_gt_u32 vcc, v35, v37
s_nop 0
s_cbranch_vccnz .Lsp23l
s_branch .Lsp23b
.Lx24:
buffer_load_dword v27, v14, s[76:79], 0 offen
s_mov_b32 s76, s98
s_mov_b32 s77, s99
s_mov_b32 s78, s100
v_mov_b32 v14, v15
s_mov_b32 s47, 5
s_branch .Lx24b
.Lx25:
buffer_load_dword v27, v14, s[76:79], 0 offen
s_mov_b32 s76, s98
s_mov_b32 s77, s99
s_mov_b32 s78, s100
v_mov_b32 v14, v15
s_mov_b32 s47, 5
s_branch .Lx25b
.Lx26:
buffer_load_dword v27, v14, s[76:79], 0 offen
s_mov_b32 s76, s98
s_mov_b32 s77, s99
s_mov_b32 s78, s100
v_mov_b32 v14, v15
s_mov_b32 s47, 5
s_branch .Lx26b
.Lx27:
buffer_load_dword v27, v14, s[76:79], 0 offen
s_mov_b32 s76, s98
s_mov_b32 s77, s99
s_mov_b32 s78, s100
v_mov_b32 v14, v15
s_mov_b32 s47, 5
s_branch .Lx27b
.Lsp28:
s_mov_b32 s15, 0
.Lsp28l:
v_mov_b32 v37, 0
buffer_atomic_add v37, v33, s[16:19], 0 offen sc0
s_add_u32 s15, s15, 1
s_cmp_gt_u32 s15, 100000
s_waitcnt vmcnt(0)
s_cbranch_scc1 .Lsp28b
v_cmp_gt_u32 vcc, v36, v37
s_nop 0
s_cbranch_vccnz .Lsp28l
s_branch .Lsp28b
.Lx29:
buffer_load_dword v27, v14, s[76:79], 0 offen
s_mov_b32 s76, s98
s_mov_b32 s77, s99
s_mov_b32 s78, s100
v_mov_b32 v14, v15
s_mov_b32 s47, 5
s_branch .Lx29b
.Lx30:
buffer_load_dword v27, v14, s[76:79], 0 offen
s_mov_b32 s76, s98
s_mov_b32 s77, s99
s_mov_b32 s78, s100
v_mov_b32 v14, v15
s_mov_b32 s47, 5
s_branch .Lx30b
.Lx31:
buffer_load_dword v27, v14, s[76:79], 0 offen
s_mov_b32 s76, s98
s_mov_b32 s77, s99
s_mov_b32 s78, s100
v_mov_b32 v14, v15
s_mov_b32 s47, 5
s_branch .Lx31b
.Lx32:
buffer_load_dword v27, v14, s[76:79], 0 offen
s_mov_b32 s76, s98
s_mov_b32 s77, s99
s_mov_b32 s78, s100
v_mov_b32 v14, v15
s_mov_b32 s47, 5
s_branch .Lx32b
.p2align 12
.Lqkv1:
.Lpad6:
s_cbranch_execz .Lpad10
s_cmp_lt_u32 s14, 16
s_cselect_b32 s62, 0, 4096
v_mov_b32 v231, 1
v_lshlrev_b32 v232, 8, v1
s_waitcnt vmcnt(18)
v_permlane16_swap_b32 v164, v166
v_permlane16_swap_b32 v165, v167
s_waitcnt vmcnt(17)
v_permlane16_swap_b32 v168, v170
v_permlane16_swap_b32 v169, v171
s_waitcnt vmcnt(16)
v_permlane16_swap_b32 v172, v174
v_permlane16_swap_b32 v173, v175
s_waitcnt vmcnt(15)
v_permlane16_swap_b32 v176, v178
v_permlane16_swap_b32 v177, v179
buffer_atomic_add v231, v232, s[40:43], s62 offen
v_lshlrev_b32 v192, 16, v164
v_and_b32 v193, 0xffff0000, v164
v_lshlrev_b32 v194, 16, v165
v_and_b32 v195, 0xffff0000, v165
v_lshlrev_b32 v196, 16, v166
v_and_b32 v197, 0xffff0000, v166
v_lshlrev_b32 v198, 16, v167
v_and_b32 v199, 0xffff0000, v167
v_lshlrev_b32 v200, 16, v168
v_and_b32 v201, 0xffff0000, v168
v_lshlrev_b32 v202, 16, v169
v_and_b32 v203, 0xffff0000, v169
v_lshlrev_b32 v204, 16, v170
v_and_b32 v205, 0xffff0000, v170
v_lshlrev_b32 v206, 16, v171
v_and_b32 v207, 0xffff0000, v171
v_lshlrev_b32 v208, 16, v172
v_and_b32 v209, 0xffff0000, v172
v_lshlrev_b32 v210, 16, v173
v_and_b32 v211, 0xffff0000, v173
v_lshlrev_b32 v212, 16, v174
v_and_b32 v213, 0xffff0000, v174
v_lshlrev_b32 v214, 16, v175
v_and_b32 v215, 0xffff0000, v175
v_lshlrev_b32 v216, 16, v176
v_and_b32 v217, 0xffff0000, v176
v_lshlrev_b32 v218, 16, v177
v_and_b32 v219, 0xffff0000, v177
v_lshlrev_b32 v220, 16, v178
v_and_b32 v221, 0xffff0000, v178
v_lshlrev_b32 v222, 16, v179
v_and_b32 v223, 0xffff0000, v179
s_lshl_b32 s64, s6, 14
s_lshl_b32 s65, s49, 13
s_add_u32 s64, s64, s65
s_lshl_b32 s65, s7, 9
s_add_u32 s64, s64, s65
s_lshl_b32 s65, s48, 8
s_add_u32 s64, s64, s65
s_add_u32 s64, s64, 29360128
v_and_b32 v188, 31, v1
v_lshlrev_b32 v188, 3, v188
v_lshrrev_b32 v189, 5, v1
v_lshl_add_u32 v188, v189, 28, v188
s_lshl_b32 s62, s7, 18
s_add_u32 s62, s62, 0
s_add_u32 s63, s62, 131072
v_pk_mul_f32 v[182:183], v[192:193], v[192:193]
v_pk_mul_f32 v[186:187], v[208:209], v[208:209]
v_pk_fma_f32 v[182:183], v[194:195], v[194:195], v[182:183]
v_pk_add_f32 v[180:181], v[192:193], v[194:195]
v_pk_fma_f32 v[186:187], v[210:211], v[210:211], v[186:187]
v_pk_add_f32 v[184:185], v[208:209], v[210:211]
v_pk_fma_f32 v[182:183], v[196:197], v[196:197], v[182:183]
v_pk_add_f32 v[180:181], v[180:181], v[196:197]
v_pk_fma_f32 v[186:187], v[212:213], v[212:213], v[186:187]
v_pk_add_f32 v[184:185], v[184:185], v[212:213]
v_pk_fma_f32 v[182:183], v[198:199], v[198:199], v[182:183]
v_pk_add_f32 v[180:181], v[180:181], v[198:199]
v_pk_fma_f32 v[186:187], v[214:215], v[214:215], v[186:187]
v_pk_add_f32 v[184:185], v[184:185], v[214:215]
v_pk_fma_f32 v[182:183], v[200:201], v[200:201], v[182:183]
v_pk_add_f32 v[180:181], v[180:181], v[200:201]
v_pk_fma_f32 v[186:187], v[216:217], v[216:217], v[186:187]
v_pk_add_f32 v[184:185], v[184:185], v[216:217]
v_pk_fma_f32 v[182:183], v[202:203], v[202:203], v[182:183]
v_pk_add_f32 v[180:181], v[180:181], v[202:203]
v_pk_fma_f32 v[186:187], v[218:219], v[218:219], v[186:187]
v_pk_add_f32 v[184:185], v[184:185], v[218:219]
v_pk_fma_f32 v[182:183], v[204:205], v[204:205], v[182:183]
v_pk_add_f32 v[180:181], v[180:181], v[204:205]
v_pk_fma_f32 v[186:187], v[220:221], v[220:221], v[186:187]
v_pk_add_f32 v[184:185], v[184:185], v[220:221]
v_pk_fma_f32 v[182:183], v[206:207], v[206:207], v[182:183]
v_pk_add_f32 v[180:181], v[180:181], v[206:207]
v_pk_fma_f32 v[186:187], v[222:223], v[222:223], v[186:187]
v_pk_add_f32 v[184:185], v[184:185], v[222:223]
v_add_f32 v180, v180, v181
v_add_f32 v182, v182, v183
v_add_f32 v184, v184, v185
v_add_f32 v186, v186, v187
s_nop 0
v_permlane16_swap_b32 v180, v184
v_permlane16_swap_b32 v182, v186
v_add_f32 v180, v180, v184
v_add_f32 v182, v182, v186
s_nop 1
v_permlane32_swap_b32 v180, v182
v_add_f32 v180, v180, v182
s_nop 1
v_permlane32_swap_b32 v180, v181
buffer_store_dwordx2 v[180:181], v188, s[16:19], s64 offen sc1
s_lshl_b32 s62, s2, 10
s_add_u32 s62, s62, 31457280
s_cmp_eq_u32 s3, 0
s_cselect_b32 s62, s62, 268435456
buffer_store_dwordx4 v[224:227], v230, s[16:19], s62 offen sc1
v_accvgpr_write_b32 a224, v192
v_accvgpr_write_b32 a225, v193
v_accvgpr_write_b32 a226, v194
v_accvgpr_write_b32 a227, v195
v_accvgpr_write_b32 a228, v196
v_accvgpr_write_b32 a229, v197
v_accvgpr_write_b32 a230, v198
v_accvgpr_write_b32 a231, v199
v_accvgpr_write_b32 a232, v200
v_accvgpr_write_b32 a233, v201
v_accvgpr_write_b32 a234, v202
v_accvgpr_write_b32 a235, v203
v_accvgpr_write_b32 a236, v204
v_accvgpr_write_b32 a237, v205
v_accvgpr_write_b32 a238, v206
v_accvgpr_write_b32 a239, v207
v_accvgpr_write_b32 a240, v208
v_accvgpr_write_b32 a241, v209
v_accvgpr_write_b32 a242, v210
v_accvgpr_write_b32 a243, v211
v_accvgpr_write_b32 a244, v212
v_accvgpr_write_b32 a245, v213
v_accvgpr_write_b32 a246, v214
v_accvgpr_write_b32 a247, v215
v_accvgpr_write_b32 a248, v216
v_accvgpr_write_b32 a249, v217
v_accvgpr_write_b32 a250, v218
v_accvgpr_write_b32 a251, v219
v_accvgpr_write_b32 a252, v220
v_accvgpr_write_b32 a253, v221
v_accvgpr_write_b32 a254, v222
v_accvgpr_write_b32 a255, v223
s_add_u32 m0, s55, 18496
s_nop 0
buffer_load_dwordx4 v21, s[36:39], s52 offen lds
buffer_load_dwordx4 v28, s[36:39], s52 offen offset:1024 lds
buffer_load_dword v22, s[36:39], s52 offen offset:2048 lds
s_add_u32 s52, s52, 128
s_add_u32 m0, s55, 20800
s_nop 0
buffer_load_dwordx4 v21, s[36:39], s53 offen lds
buffer_load_dwordx4 v28, s[36:39], s53 offen offset:1024 lds
buffer_load_dword v29, s[36:39], s53 offen offset:2048 lds
s_add_u32 s53, s53, 128
s_add_u32 m0, s56, 73984
s_nop 0
buffer_load_dwordx4 v18, s[20:23], s54 offen lds
buffer_load_dwordx4 v19, s[20:23], s54 offen offset:1024 lds
buffer_load_dwordx4 v20, s[20:23], s54 offen offset:2048 lds
s_add_u32 s54, s54, 196608
s_waitcnt vmcnt(12) lgkmcnt(0)
s_barrier
ds_read_b128 a[0:3], v23
RD 4,23,2304
RD 8,23,4608
RD 12,23,6912
ds_read_b128 a[16:19], v24
ds_read_b128 a[20:23], v30
RD 24,30,2304
RD 28,30,4608
RD 32,30,6912
ds_read_b128 a[36:39], v31
TR 80,25,49664
TR 82,25,50176
TR 84,25,62080
TR 86,25,62592
TR 88,25,50688
TR 90,25,51200
TR 92,25,63104
TR 94,25,63616
TR 96,25,51712
TR 98,25,52224
TR 100,25,64128
TR 102,25,64640
s_waitcnt vmcnt(3) lgkmcnt(0)
s_barrier
v_mfma_f32_16x16x32_bf16 v[60:63], a[80:83], a[0:3], 0
TR 104,25,49696
s_add_u32 m0, s56, 86400
MAA 60,84,20
buffer_load_dwordx4 v18, s[20:23], s54 offen lds
v_mfma_f32_16x16x32_bf16 v[64:67], a[80:83], a[4:7], 0
s_sub_u32 s47, s47, 1
s_cbranch_scc1 .Lx19
.Lx19b:
MAA 64,84,24
buffer_load_dwordx4 v19, s[20:23], s54 offen offset:1024 lds
v_mfma_f32_16x16x32_bf16 v[68:71], a[80:83], a[8:11], 0
TR 106,25,50208
MAA 68,84,28
TR 108,25,62112
TR 110,25,62624
TR 112,25,50720
v_mfma_f32_16x16x32_bf16 v[72:75], a[80:83], a[12:15], 0
TR 114,25,51232
MAA 72,84,32
TR 116,25,63136
TR 118,25,63648
v_mfma_f32_16x16x32_bf16 v[104:107], a[88:91], a[12:15], 0
TR 120,25,51744
MAA 104,92,32
buffer_load_dwordx4 v20, s[20:23], s54 offen offset:2048 lds
v_mfma_f32_16x16x32_bf16 v[100:103], a[88:91], a[8:11], 0
s_add_u32 s54, s54, 196608
s_add_u32 m0, s55, 36992
MAA 100,92,28
buffer_load_dwordx4 v21, s[36:39], s52 offen lds
v_mfma_f32_16x16x32_bf16 v[96:99], a[88:91], a[4:7], 0
TR 122,25,52256
MAA 96,92,24
buffer_load_dwordx4 v28, s[36:39], s52 offen offset:1024 lds
v_mfma_f32_16x16x32_bf16 v[92:95], a[88:91], a[0:3], 0
TR 124,25,64160
MAA 92,92,20
buffer_load_dword v22, s[36:39], s52 offen offset:2048 lds
v_mfma_f32_16x16x32_bf16 v[124:127], a[0:3], a[96:99], 0
s_add_u32 s52, s52, 128
s_add_u32 m0, s55, 39296
MAA 124,20,100
buffer_load_dwordx4 v21, s[36:39], s53 offen lds
v_mfma_f32_16x16x32_bf16 v[128:131], a[4:7], a[96:99], 0
TR 126,25,64672
MAA 128,24,100
buffer_load_dwordx4 v28, s[36:39], s53 offen offset:1024 lds
v_mfma_f32_16x16x32_bf16 v[132:135], a[8:11], a[96:99], 0
RD 40,23,18496
MAA 132,28,100
RD 44,23,20800
RD 48,23,23104
RD 52,23,25408
v_mfma_f32_16x16x32_bf16 v[136:139], a[12:15], a[96:99], 0
RD 56,24,18496
MAA 136,32,100
buffer_load_dword v29, s[36:39], s53 offen offset:2048 lds
v_mfma_f32_16x16x32_bf16 v[156:159], a[16:19], a[96:99], 0
s_add_u32 s53, s53, 128
MAA 156,36,100
s_waitcnt vmcnt(6) lgkmcnt(5)
s_barrier
v_mfma_f32_16x16x32_bf16 v[76:79], a[104:107], a[0:3], 0
RD 60,30,18496
s_add_u32 m0, s56, 98816
MAA 76,108,20
buffer_load_dwordx4 v18, s[20:23], s54 offen lds
v_mfma_f32_16x16x32_bf16 v[80:83], a[104:107], a[4:7], 0
RD 64,30,20800
MAA 80,108,24
buffer_load_dwordx4 v19, s[20:23], s54 offen offset:1024 lds
v_mfma_f32_16x16x32_bf16 v[84:87], a[104:107], a[8:11], 0
RD 68,30,23104
MAA 84,108,28
RD 72,30,25408
v_mfma_f32_16x16x32_bf16 v[88:91], a[104:107], a[12:15], 0
RD 76,31,18496
MAA 88,108,32
buffer_load_dwordx4 v20, s[20:23], s54 offen offset:2048 lds
v_mfma_f32_16x16x32_bf16 v[244:247], a[104:107], a[16:19], 0
s_add_u32 s54, s54, 196608
s_add_u32 m0, s56, 111232
MAA 244,108,36
buffer_load_dwordx4 v18, s[20:23], s54 offen lds
v_mfma_f32_16x16x32_bf16 v[120:123], a[112:115], a[12:15], 0
ds_read_b64_tr_b16 a[80:81], v25
MAA 120,116,32
TR 82,25,512
v_mfma_f32_16x16x32_bf16 v[116:119], a[112:115], a[8:11], 0
TR 84,25,12416
MAA 116,116,28
buffer_load_dwordx4 v19, s[20:23], s54 offen offset:1024 lds
v_mfma_f32_16x16x32_bf16 v[112:115], a[112:115], a[4:7], 0
TR 86,25,12928
MAA 112,116,24
buffer_load_dwordx4 v20, s[20:23], s54 offen offset:2048 lds
v_mfma_f32_16x16x32_bf16 v[108:111], a[112:115], a[0:3], 0
TR 88,25,1024
s_add_u32 s54, s54, 196608
MAA 108,116,20
TR 90,25,1536
v_mfma_f32_16x16x32_bf16 v[140:143], a[0:3], a[120:123], 0
TR 92,25,13440
s_add_u32 m0, s55, 55488
MAA 140,20,124
buffer_load_dwordx4 v21, s[36:39], s52 offen lds
v_mfma_f32_16x16x32_bf16 v[144:147], a[4:7], a[120:123], 0
TR 94,25,13952
MAA 144,24,124
buffer_load_dwordx4 v28, s[36:39], s52 offen offset:1024 lds
v_mfma_f32_16x16x32_bf16 v[148:151], a[8:11], a[120:123], 0
TR 96,25,2048
MAA 148,28,124
TR 98,25,2560
v_mfma_f32_16x16x32_bf16 v[152:155], a[12:15], a[120:123], 0
TR 100,25,14464
MAA 152,32,124
buffer_load_dword v22, s[36:39], s52 offen offset:2048 lds
v_mfma_f32_16x16x32_bf16 v[160:163], a[16:19], a[120:123], 0
TR 102,25,14976
s_add_u32 s52, s52, 128
MAA 160,36,124
s_waitcnt vmcnt(9) lgkmcnt(8)
s_barrier
MAA 60,80,40
TR 104,25,32
s_add_u32 m0, s55, 57792
MAA 60,84,60
buffer_load_dwordx4 v21, s[36:39], s53 offen lds
MAA 64,84,64
s_sub_u32 s47, s47, 1
s_cbranch_scc1 .Lx20
.Lx20b:
MAA 64,80,44
buffer_load_dwordx4 v28, s[36:39], s53 offen offset:1024 lds
MAA 68,80,48
TR 106,25,544
MAA 68,84,68
TR 108,25,12448
TR 110,25,12960
TR 112,25,1056
MAA 72,84,72
TR 114,25,1568
MAA 72,80,52
TR 116,25,13472
TR 118,25,13984
s_waitcnt lgkmcnt(8)
MAA 104,88,52
TR 120,25,2080
MAA 104,92,72
buffer_load_dword v29, s[36:39], s53 offen offset:2048 lds
MAA 100,92,68
s_add_u32 s53, s53, 128
s_add_u32 m0, s56, 123648
MAA 100,88,48
buffer_load_dwordx4 v18, s[20:23], s54 offen lds
MAA 96,88,44
TR 122,25,2592
MAA 96,92,64
buffer_load_dwordx4 v19, s[20:23], s54 offen offset:1024 lds
MAA 92,92,60
TR 124,25,14496
MAA 92,88,40
buffer_load_dwordx4 v20, s[20:23], s54 offen offset:2048 lds
MAA 124,40,96
s_add_u32 s54, s54, 196608
s_add_u32 m0, s56, 136064
MAA 124,60,100
buffer_load_dwordx4 v18, s[20:23], s54 offen lds
MAA 128,64,100
TR 126,25,15008
MAA 128,44,96
buffer_load_dwordx4 v19, s[20:23], s54 offen offset:1024 lds
MAA 132,48,96
RD 0,23,36992
MAA 132,68,100
RD 4,23,39296
RD 8,23,41600
RD 12,23,43904
MAA 136,72,100
RD 16,24,36992
MAA 136,52,96
buffer_load_dwordx4 v20, s[20:23], s54 offen offset:2048 lds
MAA 156,56,96
s_add_u32 s54, s54, 196608
MAA 156,76,100
s_waitcnt vmcnt(12) lgkmcnt(5)
s_barrier
MAA 76,104,40
RD 20,30,36992
s_add_u32 m0, s55, 0
MAA 76,108,60
buffer_load_dwordx4 v21, s[36:39], s52 offen lds
MAA 80,108,64
RD 24,30,39296
MAA 80,104,44
buffer_load_dwordx4 v28, s[36:39], s52 offen offset:1024 lds
MAA 84,104,48
RD 28,30,41600
MAA 84,108,68
RD 32,30,43904
RD 36,31,36992
MAA 88,108,72
TR 80,25,24832
MAA 88,104,52
buffer_load_dword v22, s[36:39], s52 offen offset:2048 lds
MAA 244,104,56
s_add_u32 s52, s52, 128
s_add_u32 m0, s55, 2304
MAA 244,108,76
buffer_load_dwordx4 v21, s[36:39], s53 offen lds
MAA 120,116,72
TR 82,25,25344
MAA 120,112,52
buffer_load_dwordx4 v28, s[36:39], s53 offen offset:1024 lds
MAA 116,112,48
TR 84,25,37248
MAA 116,116,68
TR 86,25,37760
TR 88,25,25856
MAA 112,116,64
TR 90,25,26368
MAA 112,112,44
buffer_load_dword v29, s[36:39], s53 offen offset:2048 lds
MAA 108,112,40
s_add_u32 s53, s53, 128
s_add_u32 m0, s56, 73984
MAA 108,116,60
buffer_load_dwordx4 v18, s[20:23], s54 offen lds
MAA 140,60,124
TR 92,25,38272
MAA 140,40,120
buffer_load_dwordx4 v19, s[20:23], s54 offen offset:1024 lds
MAA 144,44,120
TR 94,25,38784
MAA 144,64,124
buffer_load_dwordx4 v20, s[20:23], s54 offen offset:2048 lds
MAA 148,68,124
TR 96,25,26880
s_add_u32 s54, s54, 196608
MAA 148,48,120
TR 98,25,27392
TR 100,25,39296
MAA 152,52,120
TR 102,25,39808
MAA 152,72,124
buffer_load_dword v37, v34, s[40:43], 0 offen sc1
MAA 160,76,124
MAA 160,56,120
s_waitcnt vmcnt(16) lgkmcnt(8)
s_barrier
MAA 60,80,0
TR 104,25,24864
s_add_u32 m0, s56, 86400
MAA 60,84,20
buffer_load_dwordx4 v18, s[20:23], s54 offen lds
MAA 64,84,24
s_sub_u32 s47, s47, 1
s_cbranch_scc1 .Lx21
.Lx21b:
MAA 64,80,4
buffer_load_dwordx4 v19, s[20:23], s54 offen offset:1024 lds
MAA 68,80,8
TR 106,25,25376
MAA 68,84,28
TR 108,25,37280
TR 110,25,37792
TR 112,25,25888
MAA 72,84,32
TR 114,25,26400
MAA 72,80,12
TR 116,25,38304
TR 118,25,38816
s_waitcnt lgkmcnt(8)
MAA 104,88,12
TR 120,25,26912
MAA 104,92,32
buffer_load_dwordx4 v20, s[20:23], s54 offen offset:2048 lds
MAA 100,92,28
s_add_u32 s54, s54, 196608
s_add_u32 m0, s55, 18496
MAA 100,88,8
buffer_load_dwordx4 v21, s[36:39], s52 offen lds
MAA 96,88,4
TR 122,25,27424
MAA 96,92,24
buffer_load_dwordx4 v28, s[36:39], s52 offen offset:1024 lds
MAA 92,92,20
TR 124,25,39328
MAA 92,88,0
buffer_load_dword v22, s[36:39], s52 offen offset:2048 lds
MAA 124,0,96
s_add_u32 s52, s52, 128
s_add_u32 m0, s55, 20800
MAA 124,20,100
buffer_load_dwordx4 v21, s[36:39], s53 offen lds
MAA 128,24,100
TR 126,25,39840
MAA 128,4,96
buffer_load_dwordx4 v28, s[36:39], s53 offen offset:1024 lds
MAA 132,8,96
RD 40,23,55488
MAA 132,28,100
RD 44,23,57792
RD 48,23,60096
RD 52,23,62400
MAA 136,32,100
RD 56,24,55488
MAA 136,12,96
buffer_load_dword v29, s[36:39], s53 offen offset:2048 lds
MAA 156,16,96
s_add_u32 s53, s53, 128
MAA 156,36,100
s_waitcnt vmcnt(19) lgkmcnt(5)
s_barrier
MAA 76,104,0
RD 60,30,55488
s_add_u32 m0, s56, 98816
MAA 76,108,20
buffer_load_dwordx4 v18, s[20:23], s54 offen lds
MAA 80,108,24
RD 64,30,57792
MAA 80,104,4
buffer_load_dwordx4 v19, s[20:23], s54 offen offset:1024 lds
MAA 84,104,8
RD 68,30,60096
MAA 84,108,28
RD 72,30,62400
MAA 88,108,32
RD 76,31,55488
MAA 88,104,12
buffer_load_dwordx4 v20, s[20:23], s54 offen offset:2048 lds
MAA 244,104,16
s_add_u32 s54, s54, 196608
s_add_u32 m0, s55, 36992
MAA 244,108,36
buffer_load_dwordx4 v21, s[36:39], s52 offen lds
MAA 120,116,32
TR 80,25,49664
MAA 120,112,12
TR 82,25,50176
MAA 116,112,8
TR 84,25,62080
MAA 116,116,28
buffer_load_dwordx4 v28, s[36:39], s52 offen offset:1024 lds
MAA 112,116,24
TR 86,25,62592
MAA 112,112,4
buffer_load_dword v22, s[36:39], s52 offen offset:2048 lds
MAA 108,112,0
TR 88,25,50688
s_add_u32 s52, s52, 128
MAA 108,116,20
TR 90,25,51200
MAA 140,20,124
TR 92,25,63104
s_add_u32 m0, s55, 39296
MAA 140,0,120
buffer_load_dwordx4 v21, s[36:39], s53 offen lds
MAA 144,4,120
TR 94,25,63616
MAA 144,24,124
buffer_load_dwordx4 v28, s[36:39], s53 offen offset:1024 lds
MAA 148,28,124
TR 96,25,51712
MAA 148,8,120
.Lpad7:
s_cbranch_execz .Lt0r
TR 98,25,52224
MAA 152,12,120
TR 100,25,64128
MAA 152,32,124
buffer_load_dword v29, s[36:39], s53 offen offset:2048 lds
MAA 160,36,124
TR 102,25,64640
s_add_u32 s53, s53, 128
MAA 160,16,120
s_waitcnt vmcnt(22) lgkmcnt(8)
s_barrier
MAA 60,80,40
TR 104,25,49696
MAA 60,84,60
TR 106,25,50208
MAA 64,84,64
TR 108,25,62112
s_add_u32 m0, s56, 111232
MAA 64,80,44
buffer_load_dwordx4 v18, s[20:23], s54 offen lds
MAA 68,80,48
s_sub_u32 s47, s47, 1
s_cbranch_scc1 .Lx22
.Lx22b:
MAA 68,84,68
TR 110,25,62624
MAA 72,84,72
TR 112,25,50720
MAA 72,80,52
TR 114,25,51232
s_waitcnt lgkmcnt(6)
MAA 104,88,52
TR 116,25,63136
MAA 104,92,72
buffer_load_dwordx4 v19, s[20:23], s54 offen offset:1024 lds
MAA 100,92,68
TR 118,25,63648
MAA 100,88,48
buffer_load_dwordx4 v20, s[20:23], s54 offen offset:2048 lds
MAA 96,88,44
TR 120,25,51744
s_add_u32 s54, s54, 196608
MAA 96,92,64
TR 122,25,52256
MAA 92,92,60
TR 124,25,64160
s_add_u32 m0, s55, 55488
MAA 92,88,40
buffer_load_dwordx4 v21, s[36:39], s52 offen lds
MAA 124,40,96
TR 126,25,64672
MAA 124,60,100
ds_read_b128 a[0:3], v23
MAA 128,64,100
RD 4,23,2304
MAA 128,44,96
buffer_load_dwordx4 v28, s[36:39], s52 offen offset:1024 lds
MAA 132,48,96
RD 8,23,4608
MAA 132,68,100
RD 12,23,6912
MAA 136,72,100
ds_read_b128 a[16:19], v24
MAA 136,52,96
buffer_load_dword v22, s[36:39], s52 offen offset:2048 lds
MAA 156,56,96
s_add_u32 s52, s52, 128
MAA 156,76,100
s_waitcnt vmcnt(21) lgkmcnt(5)
s_barrier
v_cmp_gt_u32 vcc, v35, v37
s_nop 0
s_cbranch_vccnz .Lsp23
.Lsp23b:
v_mov_b32 v37, 0
MAA 76,104,40
ds_read_b128 a[20:23], v30
MAA 76,108,60
buffer_atomic_add v38, v32, s[16:19], 0 offen
MAA 80,108,64
RD 24,30,2304
MAA 80,104,44
RD 28,30,4608
MAA 84,104,48
RD 32,30,6912
s_add_u32 m0, s56, 123648
MAA 84,108,68
buffer_load_dwordx4 v18, s[20:23], s54 offen lds
MAA 88,108,72
ds_read_b128 a[36:39], v31
MAA 88,104,52
ds_read_b64_tr_b16 a[80:81], v25
MAA 244,104,56
TR 82,25,512
MAA 244,108,76
buffer_load_dwordx4 v19, s[20:23], s54 offen offset:1024 lds
MAA 120,116,72
TR 84,25,12416
MAA 120,112,52
TR 86,25,12928
MAA 116,112,48
MAA 116,116,68
buffer_load_dwordx4 v20, s[20:23], s54 offen offset:2048 lds
MAA 112,116,64
s_add_u32 s54, s54, 196608
s_add_u32 m0, s55, 57792
MAA 112,112,44
buffer_load_dwordx4 v21, s[36:39], s53 offen lds
MAA 108,112,40
TR 88,25,1024
MAA 108,116,60
TR 90,25,1536
MAA 140,60,124
TR 92,25,13440
MAA 140,40,120
buffer_load_dwordx4 v28, s[36:39], s53 offen offset:1024 lds
MAA 144,44,120
TR 94,25,13952
MAA 144,64,124
TR 96,25,2048
MAA 148,68,124
TR 98,25,2560
MAA 148,48,120
buffer_load_dword v29, s[36:39], s53 offen offset:2048 lds
MAA 152,52,120
TR 100,25,14464
s_add_u32 s53, s53, 128
MAA 152,72,124
TR 102,25,14976
MAA 160,76,124
MAA 160,56,120
s_waitcnt vmcnt(22) lgkmcnt(8)
s_barrier
MAA 60,80,0
TR 104,25,32
MAA 60,84,20
TR 106,25,544
MAA 64,84,24
TR 108,25,12448
s_add_u32 m0, s56, 136064
MAA 64,80,4
buffer_load_dwordx4 v18, s[20:23], s54 offen lds
MAA 68,80,8
s_sub_u32 s47, s47, 1
s_cbranch_scc1 .Lx24
.Lx24b:
MAA 68,84,28
TR 110,25,12960
MAA 72,84,32
TR 112,25,1056
MAA 72,80,12
TR 114,25,1568
s_waitcnt lgkmcnt(6)
MAA 104,88,12
TR 116,25,13472
MAA 104,92,32
buffer_load_dwordx4 v19, s[20:23], s54 offen offset:1024 lds
MAA 100,92,28
TR 118,25,13984
MAA 100,88,8
buffer_load_dwordx4 v20, s[20:23], s54 offen offset:2048 lds
MAA 96,88,4
TR 120,25,2080
s_add_u32 s54, s54, 196608
MAA 96,92,24
TR 122,25,2592
MAA 92,92,20
TR 124,25,14496
s_add_u32 m0, s55, 0
MAA 92,88,0
buffer_load_dwordx4 v21, s[36:39], s52 offen lds
MAA 124,0,96
TR 126,25,15008
MAA 124,20,100
RD 40,23,18496
MAA 128,24,100
RD 44,23,20800
MAA 128,4,96
buffer_load_dwordx4 v28, s[36:39], s52 offen offset:1024 lds
MAA 132,8,96
RD 48,23,23104
MAA 132,28,100
RD 52,23,25408
MAA 136,32,100
RD 56,24,18496
MAA 136,12,96
buffer_load_dword v22, s[36:39], s52 offen offset:2048 lds
MAA 156,16,96
s_add_u32 s52, s52, 128
MAA 156,36,100
s_waitcnt vmcnt(16) lgkmcnt(5)
s_barrier
MAA 76,104,0
RD 60,30,18496
MAA 76,108,20
RD 64,30,20800
MAA 80,108,24
RD 68,30,23104
s_add_u32 m0, s56, 73984
MAA 80,104,4
buffer_load_dwordx4 v18, s[20:23], s54 offen lds
MAA 84,104,8
RD 72,30,25408
MAA 84,108,28
RD 76,31,18496
MAA 88,108,32
MAA 88,104,12
buffer_load_dwordx4 v19, s[20:23], s54 offen offset:1024 lds
MAA 244,104,16
TR 80,25,24832
MAA 244,108,36
TR 82,25,25344
MAA 120,116,32
TR 84,25,37248
MAA 120,112,12
buffer_load_dwordx4 v20, s[20:23], s54 offen offset:2048 lds
MAA 116,112,8
TR 86,25,37760
s_add_u32 s54, s54, 196608
MAA 116,116,28
MAA 112,116,24
TR 88,25,25856
MAA 112,112,4
TR 90,25,26368
MAA 108,112,0
TR 92,25,38272
s_add_u32 m0, s55, 2304
MAA 108,116,20
buffer_load_dwordx4 v21, s[36:39], s53 offen lds
MAA 140,20,124
TR 94,25,38784
MAA 140,0,120
MAA 144,4,120
TR 96,25,26880
MAA 144,24,124
buffer_load_dwordx4 v28, s[36:39], s53 offen offset:1024 lds
MAA 148,28,124
TR 98,25,27392
MAA 148,8,120
TR 100,25,39296
MAA 152,12,120
TR 102,25,39808
MAA 152,32,124
buffer_load_dword v29, s[36:39], s53 offen offset:2048 lds
MAA 160,36,124
s_add_u32 s53, s53, 128
MAA 160,16,120
s_waitcnt lgkmcnt(8)
s_barrier
MAA 60,80,40
TR 104,25,24864
MAA 60,84,60
TR 106,25,25376
MAA 64,84,64
TR 108,25,37280
s_add_u32 m0, s56, 86400
MAA 64,80,44
buffer_load_dwordx4 v18, s[20:23], s54 offen lds
MAA 68,80,48
s_sub_u32 s47, s47, 1
s_cbranch_scc1 .Lx25
.Lx25b:
MAA 68,84,68
TR 110,25,37792
MAA 72,84,72
TR 112,25,25888
MAA 72,80,52
TR 114,25,26400
s_waitcnt lgkmcnt(6)
MAA 104,88,52
TR 116,25,38304
MAA 104,92,72
buffer_load_dwordx4 v19, s[20:23], s54 offen offset:1024 lds
MAA 100,92,68
TR 118,25,38816
MAA 100,88,48
buffer_load_dwordx4 v20, s[20:23], s54 offen offset:2048 lds
MAA 96,88,44
TR 120,25,26912
s_add_u32 s54, s54, 196608
MAA 96,92,64
TR 122,25,27424
MAA 92,92,60
TR 124,25,39328
s_add_u32 m0, s55, 18496
MAA 92,88,40
buffer_load_dwordx4 v21, s[36:39], s52 offen lds
MAA 124,40,96
TR 126,25,39840
MAA 124,60,100
RD 0,23,36992
MAA 128,64,100
RD 4,23,39296
MAA 128,44,96
buffer_load_dwordx4 v28, s[36:39], s52 offen offset:1024 lds
MAA 132,48,96
RD 8,23,41600
MAA 132,68,100
RD 12,23,43904
MAA 136,72,100
RD 16,24,36992
MAA 136,52,96
buffer_load_dword v22, s[36:39], s52 offen offset:2048 lds
MAA 156,56,96
s_add_u32 s52, s52, 128
MAA 156,76,100
s_waitcnt vmcnt(15) lgkmcnt(5)
s_barrier
MAA 76,104,40
RD 20,30,36992
s_add_u32 m0, s56, 98816
MAA 76,108,60
buffer_load_dwordx4 v18, s[20:23], s54 offen lds
MAA 80,108,64
RD 24,30,39296
MAA 80,104,44
RD 28,30,41600
MAA 84,104,48
RD 32,30,43904
MAA 84,108,68
buffer_load_dwordx4 v19, s[20:23], s54 offen offset:1024 lds
MAA 88,108,72
RD 36,31,36992
MAA 88,104,52
TR 80,25,49664
MAA 244,104,56
MAA 244,108,76
buffer_load_dwordx4 v20, s[20:23], s54 offen offset:2048 lds
MAA 120,116,72
TR 82,25,50176
s_add_u32 s54, s54, 196608
MAA 120,112,52
TR 84,25,62080
MAA 116,112,48
TR 86,25,62592
s_add_u32 m0, s55, 20800
MAA 116,116,68
buffer_load_dwordx4 v21, s[36:39], s53 offen lds
MAA 112,116,64
TR 88,25,50688
MAA 112,112,44
buffer_load_dwordx4 v28, s[36:39], s53 offen offset:1024 lds
MAA 108,112,40
TR 90,25,51200
MAA 108,116,60
TR 92,25,63104
MAA 140,60,124
MAA 140,40,120
buffer_load_dword v29, s[36:39], s53 offen offset:2048 lds
MAA 144,44,120
TR 94,25,63616
s_add_u32 s53, s53, 128
MAA 144,64,124
TR 96,25,51712
MAA 148,68,124
TR 98,25,52224
MAA 148,48,120
buffer_atomic_add v37, v33, s[16:19], 0 offen sc0
MAA 152,52,120
TR 100,25,64128
MAA 152,72,124
TR 102,25,64640
MAA 160,76,124
MAA 160,56,120
s_waitcnt lgkmcnt(8)
s_barrier
MAA 60,80,0
TR 104,25,49696
MAA 60,84,20
TR 106,25,50208
MAA 64,84,24
TR 108,25,62112
s_add_u32 m0, s56, 111232
MAA 64,80,4
buffer_load_dwordx4 v18, s[20:23], s54 offen lds
MAA 68,80,8
s_sub_u32 s47, s47, 1
s_cbranch_scc1 .Lx26
.Lx26b:
MAA 68,84,28
TR 110,25,62624
MAA 72,84,32
TR 112,25,50720
MAA 72,80,12
TR 114,25,51232
s_waitcnt lgkmcnt(6)
MAA 104,88,12
TR 116,25,63136
MAA 104,92,32
buffer_load_dwordx4 v19, s[20:23], s54 offen offset:1024 lds
MAA 100,92,28
TR 118,25,63648
MAA 100,88,8
buffer_load_dwordx4 v20, s[20:23], s54 offen offset:2048 lds
MAA 96,88,4
TR 120,25,51744
s_add_u32 s54, s54, 196608
MAA 96,92,24
TR 122,25,52256
MAA 92,92,20
TR 124,25,64160
s_add_u32 m0, s55, 36992
MAA 92,88,0
buffer_load_dwordx4 v21, s[36:39], s52 offen lds
MAA 124,0,96
TR 126,25,64672
MAA 124,20,100
RD 40,23,55488
MAA 128,24,100
RD 44,23,57792
MAA 128,4,96
buffer_load_dwordx4 v28, s[36:39], s52 offen offset:1024 lds
MAA 132,8,96
RD 48,23,60096
MAA 132,28,100
RD 52,23,62400
MAA 136,32,100
RD 56,24,55488
MAA 136,12,96
buffer_load_dword v22, s[36:39], s52 offen offset:2048 lds
MAA 156,16,96
s_add_u32 s52, s52, 128
MAA 156,36,100
s_waitcnt vmcnt(16) lgkmcnt(5)
s_barrier
MAA 76,104,0
RD 60,30,55488
MAA 76,108,20
RD 64,30,57792
MAA 80,108,24
RD 68,30,60096
s_add_u32 m0, s56, 123648
MAA 80,104,4
buffer_load_dwordx4 v18, s[20:23], s54 offen lds
MAA 84,104,8
RD 72,30,62400
MAA 84,108,28
RD 76,31,55488
MAA 88,108,32
MAA 88,104,12
buffer_load_dwordx4 v19, s[20:23], s54 offen offset:1024 lds
MAA 244,104,16
ds_read_b64_tr_b16 a[80:81], v25
MAA 244,108,36
TR 82,25,512
MAA 120,116,32
TR 84,25,12416
MAA 120,112,12
buffer_load_dwordx4 v20, s[20:23], s54 offen offset:2048 lds
MAA 116,112,8
TR 86,25,12928
s_add_u32 s54, s54, 196608
MAA 116,116,28
MAA 112,116,24
TR 88,25,1024
MAA 112,112,4
TR 90,25,1536
MAA 108,112,0
TR 92,25,13440
s_add_u32 m0, s55, 39296
MAA 108,116,20
buffer_load_dwordx4 v21, s[36:39], s53 offen lds
MAA 140,20,124
TR 94,25,13952
MAA 140,0,120
MAA 144,4,120
TR 96,25,2048
MAA 144,24,124
buffer_load_dwordx4 v28, s[36:39], s53 offen offset:1024 lds
MAA 148,28,124
TR 98,25,2560
MAA 148,8,120
TR 100,25,14464
MAA 152,12,120
TR 102,25,14976
MAA 152,32,124
buffer_load_dword v29, s[36:39], s53 offen offset:2048 lds
MAA 160,36,124
s_add_u32 s53, s53, 128
MAA 160,16,120
s_waitcnt lgkmcnt(8)
s_barrier
MAA 60,80,40
TR 104,25,32
MAA 60,84,60
TR 106,25,544
MAA 64,84,64
TR 108,25,12448
s_add_u32 m0, s56, 136064
MAA 64,80,44
buffer_load_dwordx4 v18, s[20:23], s54 offen lds
MAA 68,80,48
s_sub_u32 s47, s47, 1
s_cbranch_scc1 .Lx27
.Lx27b:
MAA 68,84,68
TR 110,25,12960
MAA 72,84,72
TR 112,25,1056
MAA 72,80,52
TR 114,25,1568
s_waitcnt lgkmcnt(6)
MAA 104,88,52
TR 116,25,13472
MAA 104,92,72
buffer_load_dwordx4 v19, s[20:23], s54 offen offset:1024 lds
MAA 100,92,68
TR 118,25,13984
MAA 100,88,48
buffer_load_dwordx4 v20, s[20:23], s54 offen offset:2048 lds
MAA 96,88,44
TR 120,25,2080
s_add_u32 s54, s54, 196608
MAA 96,92,64
TR 122,25,2592
MAA 92,92,60
TR 124,25,14496
s_add_u32 m0, s55, 55488
MAA 92,88,40
buffer_load_dwordx4 v21, s[36:39], s52 offen lds
MAA 124,40,96
TR 126,25,15008
MAA 124,60,100
ds_read_b128 a[0:3], v23
MAA 128,64,100
RD 4,23,2304
MAA 128,44,96
buffer_load_dwordx4 v28, s[36:39], s52 offen offset:1024 lds
MAA 132,48,96
RD 8,23,4608
MAA 132,68,100
RD 12,23,6912
MAA 136,72,100
ds_read_b128 a[16:19], v24
MAA 136,52,96
buffer_load_dword v22, s[36:39], s52 offen offset:2048 lds
MAA 156,56,96
.Lpad8:
s_cbranch_execz .Lt0r
s_add_u32 s52, s52, 128
MAA 156,76,100
s_waitcnt vmcnt(18)
v_cmp_gt_u32 vcc, v36, v37
s_nop 0
s_cbranch_vccnz .Lsp28
.Lsp28b:
s_waitcnt vmcnt(15) lgkmcnt(5)
s_barrier
MAA 76,104,40
ds_read_b128 a[20:23], v30
s_add_u32 m0, s56, 73984
MAA 76,108,60
buffer_load_dwordx4 v18, s[20:23], s54 offen lds
MAA 80,108,64
RD 24,30,2304
MAA 80,104,44
RD 28,30,4608
MAA 84,104,48
RD 32,30,6912
MAA 84,108,68
buffer_load_dwordx4 v19, s[20:23], s54 offen offset:1024 lds
MAA 88,108,72
ds_read_b128 a[36:39], v31
MAA 88,104,52
TR 80,25,24832
MAA 244,104,56
MAA 244,108,76
buffer_load_dwordx4 v20, s[20:23], s54 offen offset:2048 lds
MAA 120,116,72
TR 82,25,25344
s_add_u32 s54, s54, 196608
MAA 120,112,52
TR 84,25,37248
MAA 116,112,48
TR 86,25,37760
s_add_u32 m0, s55, 57792
MAA 116,116,68
buffer_load_dwordx4 v21, s[36:39], s53 offen lds
MAA 112,116,64
TR 88,25,25856
MAA 112,112,44
buffer_load_dwordx4 v28, s[36:39], s53 offen offset:1024 lds
MAA 108,112,40
TR 90,25,26368
MAA 108,116,60
TR 92,25,38272
MAA 140,60,124
MAA 140,40,120
buffer_load_dword v29, s[36:39], s53 offen offset:2048 lds
MAA 144,44,120
TR 94,25,38784
s_add_u32 s53, s53, 128
MAA 144,64,124
TR 96,25,26880
MAA 148,68,124
TR 98,25,27392
MAA 148,48,120
buffer_load_dwordx4 v[164:167], v26, s[16:19], s75 offen sc1
MAA 152,52,120
TR 100,25,39296
MAA 152,72,124
TR 102,25,39808
MAA 160,76,124
MAA 160,56,120
s_waitcnt lgkmcnt(8)
s_barrier
MAA 60,80,0
TR 104,25,24864
s_add_u32 m0, s56, 86400
MAA 60,84,20
buffer_load_dwordx4 v18, s[20:23], s54 offen lds
MAA 64,84,24
s_sub_u32 s47, s47, 1
s_cbranch_scc1 .Lx29
.Lx29b:
MAA 64,80,4
TR 106,25,25376
TR 108,25,37280
MAA 68,80,8
TR 110,25,37792
MAA 68,84,28
buffer_load_dwordx4 v19, s[20:23], s54 offen offset:1024 lds
MAA 72,84,32
TR 112,25,25888
MAA 72,80,12
TR 114,25,26400
s_waitcnt lgkmcnt(6)
MAA 104,88,12
MAA 104,92,32
buffer_load_dwordx4 v20, s[20:23], s54 offen offset:2048 lds
MAA 100,92,28
s_add_u32 s54, s54, 196608
s_add_u32 m0, s55, 0
MAA 100,88,8
buffer_load_dwordx4 v21, s[36:39], s52 offen lds
MAA 96,88,4
TR 116,25,38304
MAA 96,92,24
TR 118,25,38816
TR 120,25,26912
MAA 92,92,20
TR 122,25,27424
MAA 92,88,0
buffer_load_dwordx4 v28, s[36:39], s52 offen offset:1024 lds
MAA 124,0,96
TR 124,25,39328
MAA 124,20,100
TR 126,25,39840
MAA 128,24,100
RD 40,23,18496
MAA 128,4,96
buffer_load_dword v22, s[36:39], s52 offen offset:2048 lds
MAA 132,8,96
RD 44,23,20800
s_add_u32 s52, s52, 128
MAA 132,28,100
buffer_load_dwordx4 v[168:171], v26, s[16:19], s75 offen offset:1024 sc1
MAA 136,32,100
RD 48,23,23104
MAA 136,12,96
RD 52,23,25408
RD 56,24,18496
MAA 156,16,96
MAA 156,36,100
s_waitcnt vmcnt(17) lgkmcnt(5)
s_barrier
MAA 76,104,0
RD 60,30,18496
s_add_u32 m0, s56, 98816
MAA 76,108,20
buffer_load_dwordx4 v18, s[20:23], s54 offen lds
MAA 80,108,24
RD 64,30,20800
MAA 80,104,4
RD 68,30,23104
MAA 84,104,8
RD 72,30,25408
MAA 84,108,28
buffer_load_dwordx4 v19, s[20:23], s54 offen offset:1024 lds
MAA 88,108,32
RD 76,31,18496
MAA 88,104,12
TR 80,25,49664
MAA 244,104,16
MAA 244,108,36
buffer_load_dwordx4 v20, s[20:23], s54 offen offset:2048 lds
MAA 120,116,32
TR 82,25,50176
s_add_u32 s54, s54, 196608
MAA 120,112,12
TR 84,25,62080
MAA 116,112,8
TR 86,25,62592
s_add_u32 m0, s55, 2304
MAA 116,116,28
buffer_load_dwordx4 v21, s[36:39], s53 offen lds
MAA 112,116,24
TR 88,25,50688
MAA 112,112,4
buffer_load_dwordx4 v28, s[36:39], s53 offen offset:1024 lds
MAA 108,112,0
TR 90,25,51200
MAA 108,116,20
TR 92,25,63104
MAA 140,20,124
MAA 140,0,120
buffer_load_dword v29, s[36:39], s53 offen offset:2048 lds
MAA 144,4,120
TR 94,25,63616
s_add_u32 s53, s53, 128
MAA 144,24,124
TR 96,25,51712
MAA 148,28,124
TR 98,25,52224
MAA 148,8,120
buffer_load_dwordx4 v[172:175], v26, s[16:19], s75 offen offset:2048 sc1
MAA 152,12,120
TR 100,25,64128
MAA 152,32,124
TR 102,25,64640
MAA 160,36,124
MAA 160,16,120
s_waitcnt lgkmcnt(8)
s_barrier
MAA 60,80,40
TR 104,25,49696
s_add_u32 m0, s56, 111232
MAA 60,84,60
buffer_load_dwordx4 v18, s[20:23], s54 offen lds
MAA 64,84,64
s_sub_u32 s47, s47, 1
s_cbranch_scc1 .Lx30
.Lx30b:
MAA 64,80,44
TR 106,25,50208
TR 108,25,62112
MAA 68,80,48
TR 110,25,62624
MAA 68,84,68
buffer_load_dwordx4 v19, s[20:23], s54 offen offset:1024 lds
MAA 72,84,72
TR 112,25,50720
MAA 72,80,52
TR 114,25,51232
s_waitcnt lgkmcnt(6)
MAA 104,88,52
MAA 104,92,72
buffer_load_dwordx4 v20, s[20:23], s54 offen offset:2048 lds
MAA 100,92,68
s_add_u32 s54, s54, 196608
s_add_u32 m0, s55, 18496
MAA 100,88,48
buffer_load_dwordx4 v21, s[36:39], s52 offen lds
MAA 96,88,44
TR 116,25,63136
MAA 96,92,64
TR 118,25,63648
TR 120,25,51744
MAA 92,92,60
TR 122,25,52256
MAA 92,88,40
buffer_load_dwordx4 v28, s[36:39], s52 offen offset:1024 lds
MAA 124,40,96
TR 124,25,64160
MAA 124,60,100
TR 126,25,64672
MAA 128,64,100
RD 0,23,36992
MAA 128,44,96
buffer_load_dword v22, s[36:39], s52 offen offset:2048 lds
MAA 132,48,96
RD 4,23,39296
s_add_u32 s52, s52, 128
MAA 132,68,100
buffer_load_dwordx4 v[176:179], v26, s[16:19], s75 offen offset:3072 sc1
MAA 136,72,100
RD 8,23,41600
s_add_u32 s75, s75, 4096
MAA 136,52,96
RD 12,23,43904
RD 16,24,36992
MAA 156,56,96
MAA 156,76,100
s_waitcnt vmcnt(18) lgkmcnt(5)
s_barrier
MAA 76,104,40
RD 20,30,36992
s_add_u32 m0, s56, 123648
MAA 76,108,60
buffer_load_dwordx4 v18, s[20:23], s54 offen lds
MAA 80,108,64
RD 24,30,39296
s_waitcnt vmcnt(15)
v_add_f32 v164, v164, v168
MAA 80,104,44
RD 28,30,41600
MAA 84,104,48
RD 32,30,43904
MAA 84,108,68
buffer_load_dwordx4 v19, s[20:23], s54 offen offset:1024 lds
MAA 88,108,72
RD 36,31,36992
MAA 88,104,52
ds_read_b64_tr_b16 a[80:81], v25
v_add_f32 v165, v165, v169
MAA 244,104,56
MAA 244,108,76
buffer_load_dwordx4 v20, s[20:23], s54 offen offset:2048 lds
MAA 120,116,72
TR 82,25,512
s_add_u32 s54, s54, 196608
MAA 120,112,52
TR 84,25,12416
MAA 116,112,48
TR 86,25,12928
s_add_u32 m0, s55, 20800
MAA 116,116,68
buffer_load_dwordx4 v21, s[36:39], s53 offen lds
MAA 112,116,64
TR 88,25,1024
MAA 112,112,44
buffer_load_dwordx4 v28, s[36:39], s53 offen offset:1024 lds
MAA 108,112,40
TR 90,25,1536
v_add_f32 v166, v166, v170
MAA 108,116,60
TR 92,25,13440
MAA 140,60,124
MAA 140,40,120
buffer_load_dword v29, s[36:39], s53 offen offset:2048 lds
MAA 144,44,120
TR 94,25,13952
s_add_u32 s53, s53, 128
MAA 144,64,124
TR 96,25,2048
MAA 148,68,124
TR 98,25,2560
v_add_f32 v167, v167, v171
MAA 148,48,120
buffer_load_dwordx4 v[180:183], v26, s[16:19], s75 offen sc1
MAA 152,52,120
TR 100,25,14464
MAA 152,72,124
TR 102,25,14976
MAA 160,76,124
MAA 160,56,120
s_waitcnt lgkmcnt(8)
s_barrier
MAA 60,80,0
TR 104,25,32
s_add_u32 m0, s56, 136064
MAA 60,84,20
buffer_load_dwordx4 v18, s[20:23], s54 offen lds
MAA 64,84,24
s_sub_u32 s47, s47, 1
s_cbranch_scc1 .Lx31
.Lx31b:
MAA 64,80,4
TR 106,25,544
TR 108,25,12448
MAA 68,80,8
TR 110,25,12960
s_waitcnt vmcnt(15)
v_add_f32 v164, v164, v172
MAA 68,84,28
buffer_load_dwordx4 v19, s[20:23], s54 offen offset:1024 lds
MAA 72,84,32
TR 112,25,1056
MAA 72,80,12
TR 114,25,1568
s_waitcnt lgkmcnt(6)
MAA 104,88,12
v_add_f32 v165, v165, v173
MAA 104,92,32
buffer_load_dwordx4 v20, s[20:23], s54 offen offset:2048 lds
MAA 100,92,28
s_add_u32 s54, s54, 196608
s_add_u32 m0, s55, 36992
MAA 100,88,8
buffer_load_dwordx4 v21, s[36:39], s52 offen lds
MAA 96,88,4
TR 116,25,13472
MAA 96,92,24
TR 118,25,13984
TR 120,25,2080
MAA 92,92,20
TR 122,25,2592
v_add_f32 v166, v166, v174
MAA 92,88,0
buffer_load_dwordx4 v28, s[36:39], s52 offen offset:1024 lds
MAA 124,0,96
TR 124,25,14496
MAA 124,20,100
TR 126,25,15008
MAA 128,24,100
RD 40,23,55488
v_add_f32 v167, v167, v175
MAA 128,4,96
buffer_load_dword v22, s[36:39], s52 offen offset:2048 lds
MAA 132,8,96
RD 44,23,57792
s_add_u32 s52, s52, 128
MAA 132,28,100
buffer_load_dwordx4 v[184:187], v26, s[16:19], s75 offen offset:1024 sc1
MAA 136,32,100
RD 48,23,60096
MAA 136,12,96
RD 52,23,62400
RD 56,24,55488
MAA 156,16,96
MAA 156,36,100
s_waitcnt vmcnt(18) lgkmcnt(5)
s_barrier
MAA 76,104,0
RD 60,30,55488
s_waitcnt vmcnt(14)
v_add_f32 v164, v164, v176
MAA 76,108,20
RD 64,30,57792
s_add_u32 m0, s56, 73984
MAA 80,108,24
buffer_load_dwordx4 v18, s[20:23], s54 offen lds
MAA 80,104,4
RD 68,30,60096
v_add_f32 v165, v165, v177
MAA 84,104,8
RD 72,30,62400
v_add_f32 v166, v166, v178
MAA 84,108,28
buffer_load_dwordx4 v19, s[20:23], s54 offen offset:1024 lds
MAA 88,108,32
RD 76,31,55488
v_add_f32 v167, v167, v179
MAA 88,104,12
TR 80,25,24832
MAA 244,104,16
buffer_load_dwordx4 v20, s[20:23], s54 offen offset:2048 lds
MAA 244,108,36
TR 82,25,25344
s_add_u32 s54, s54, 196608
MAA 120,116,32
TR 84,25,37248
s_add_u32 m0, s55, 39296
MAA 120,112,12
buffer_load_dwordx4 v21, s[36:39], s53 offen lds
MAA 116,112,8
TR 86,25,37760
MAA 116,116,28
TR 88,25,25856
MAA 112,116,24
buffer_load_dwordx4 v28, s[36:39], s53 offen offset:1024 lds
MAA 112,112,4
TR 90,25,26368
MAA 108,112,0
TR 92,25,38272
MAA 108,116,20
buffer_load_dword v29, s[36:39], s53 offen offset:2048 lds
MAA 140,20,124
TR 94,25,38784
s_add_u32 s53, s53, 128
MAA 140,0,120
TR 96,25,26880
MAA 144,4,120
buffer_load_dwordx4 v[188:191], v26, s[16:19], s75 offen offset:2048 sc1
MAA 144,24,124
TR 98,25,27392
MAA 148,28,124
TR 100,25,39296
MAA 148,8,120
TR 102,25,39808
MAA 152,12,120
MAA 152,32,124
MAA 160,36,124
MAA 160,16,120
s_waitcnt lgkmcnt(8)
s_barrier
MAA 60,80,40
TR 104,25,24864
s_add_u32 m0, s56, 86400
MAA 60,84,60
buffer_load_dwordx4 v18, s[20:23], s54 offen lds
MAA 64,84,64
s_sub_u32 s47, s47, 1
s_cbranch_scc1 .Lx32
.Lx32b:
MAA 64,80,44
TR 106,25,25376
TR 108,25,37280
MAA 68,80,48
TR 110,25,37792
s_waitcnt vmcnt(15)
v_add_f32 v164, v164, v180
MAA 68,84,68
buffer_load_dwordx4 v19, s[20:23], s54 offen offset:1024 lds
MAA 72,84,72
TR 112,25,25888
MAA 72,80,52
TR 114,25,26400
s_waitcnt lgkmcnt(6)
MAA 104,88,52
v_add_f32 v165, v165, v181
MAA 104,92,72
buffer_load_dwordx4 v20, s[20:23], s54 offen offset:2048 lds
MAA 100,92,68
s_add_u32 s54, s54, 196608
s_add_u32 m0, s55, 55488
MAA 100,88,48
buffer_load_dwordx4 v21, s[36:39], s52 offen lds
MAA 96,88,44
TR 116,25,38304
MAA 96,92,64
TR 118,25,38816
TR 120,25,26912
MAA 92,92,60
TR 122,25,27424
v_add_f32 v166, v166, v182
MAA 92,88,40
buffer_load_dwordx4 v28, s[36:39], s52 offen offset:1024 lds
MAA 124,40,96
TR 124,25,39328
MAA 124,60,100
TR 126,25,39840
MAA 128,64,100
ds_read_b128 a[0:3], v23
v_add_f32 v167, v167, v183
MAA 128,44,96
buffer_load_dword v22, s[36:39], s52 offen offset:2048 lds
MAA 132,48,96
RD 4,23,2304
s_add_u32 s52, s52, 128
MAA 132,68,100
buffer_load_dwordx4 v[192:195], v26, s[16:19], s75 offen offset:3072 sc1
MAA 136,72,100
RD 8,23,4608
MAA 136,52,96
RD 12,23,6912
ds_read_b128 a[16:19], v24
MAA 156,56,96
MAA 156,76,100
s_waitcnt vmcnt(18) lgkmcnt(5)
s_barrier
MAA 76,104,40
ds_read_b128 a[20:23], v30
s_waitcnt vmcnt(14)
v_add_f32 v164, v164, v184
MAA 76,108,60
RD 24,30,2304
s_add_u32 m0, s56, 98816
MAA 80,108,64
buffer_load_dwordx4 v18, s[20:23], s54 offen lds
MAA 80,104,44
RD 28,30,4608
v_add_f32 v165, v165, v185
MAA 84,104,48
RD 32,30,6912
v_add_f32 v166, v166, v186
MAA 84,108,68
ds_read_b128 a[36:39], v31
v_add_f32 v167, v167, v187
MAA 88,108,72
buffer_load_dwordx4 v19, s[20:23], s54 offen offset:1024 lds
MAA 88,104,52
TR 80,25,49664
MAA 244,104,56
TR 82,25,50176
MAA 244,108,76
TR 84,25,62080
MAA 120,116,72
buffer_load_dwordx4 v20, s[20:23], s54 offen offset:2048 lds
MAA 120,112,52
TR 86,25,62592
s_add_u32 s54, s54, 196608
MAA 116,112,48
TR 88,25,50688
s_add_u32 m0, s55, 57792
MAA 116,116,68
TR 90,25,51200
MAA 112,116,64
buffer_load_dwordx4 v21, s[36:39], s53 offen lds
MAA 112,112,44
TR 92,25,63104
MAA 108,112,40
TR 94,25,63616
MAA 108,116,60
TR 96,25,51712
.Lpad9:
s_cbranch_execz .Lt0r
MAA 140,60,124
buffer_load_dwordx4 v28, s[36:39], s53 offen offset:1024 lds
MAA 140,40,120
TR 98,25,52224
MAA 144,44,120
TR 100,25,64128
MAA 144,64,124
TR 102,25,64640
MAA 148,68,124
buffer_load_dword v29, s[36:39], s53 offen offset:2048 lds
MAA 148,48,120
s_add_u32 s53, s53, 128
MAA 152,52,120
MAA 152,72,124
MAA 160,76,124
MAA 160,56,120
s_waitcnt lgkmcnt(8)
s_barrier
MAA 60,80,0
TR 104,25,49696
s_waitcnt vmcnt(13)
v_add_f32 v164, v164, v188
MAA 60,84,20
TR 106,25,50208
s_add_u32 m0, s56, 111232
MAA 64,84,24
buffer_load_dwordx4 v18, s[20:23], s54 offen lds
MAA 64,80,4
TR 108,25,62112
v_add_f32 v165, v165, v189
MAA 68,80,8
TR 110,25,62624
v_add_f32 v166, v166, v190
MAA 68,84,28
buffer_load_dwordx4 v19, s[20:23], s54 offen offset:1024 lds
MAA 72,84,32
TR 112,25,50720
v_add_f32 v167, v167, v191
MAA 72,80,12
TR 114,25,51232
s_waitcnt lgkmcnt(6)
MAA 104,88,12
buffer_load_dwordx4 v20, s[20:23], s54 offen offset:2048 lds
MAA 104,92,32
TR 116,25,63136
s_add_u32 s54, s54, 196608
MAA 100,92,28
TR 118,25,63648
s_add_u32 m0, s59, 0
MAA 100,88,8
TR 120,25,51744
s_xor_b32 s58, s87, 1048576
MAA 96,88,4
buffer_load_dwordx4 v5, s[24:27], s58 offen lds
MAA 96,92,24
TR 122,25,52256
MAA 92,92,20
TR 124,25,64160
MAA 92,88,0
buffer_load_dwordx4 v6, s[24:27], s58 offen offset:1024 lds
MAA 124,0,96
TR 126,25,64672
s_add_u32 m0, s59, 8320
MAA 124,20,100
RD 40,23,18496
s_xor_b32 s58, s87, 1179648
MAA 128,24,100
buffer_load_dwordx4 v5, s[24:27], s58 offen lds
MAA 128,4,96
RD 44,23,20800
MAA 132,8,96
RD 48,23,23104
MAA 132,28,100
buffer_load_dwordx4 v6, s[24:27], s58 offen offset:1024 lds
MAA 136,32,100
RD 52,23,25408
MAA 136,12,96
RD 56,24,18496
MAA 156,16,96
MAA 156,36,100
s_waitcnt vmcnt(17) lgkmcnt(5)
s_barrier
MAA 76,104,0
RD 60,30,18496
s_waitcnt vmcnt(13)
v_add_f32 v164, v164, v192
MAA 76,108,20
RD 64,30,20800
s_add_u32 m0, s56, 123648
MAA 80,108,24
buffer_load_dwordx4 v18, s[20:23], s54 offen lds
MAA 80,104,4
RD 68,30,23104
v_add_f32 v165, v165, v193
MAA 84,104,8
RD 72,30,25408
v_add_f32 v166, v166, v194
MAA 84,108,28
RD 76,31,18496
v_add_f32 v167, v167, v195
MAA 88,108,32
ds_read_b64_tr_b16 a[80:81], v25
MAA 88,104,12
TR 82,25,512
MAA 244,104,16
TR 84,25,12416
MAA 244,108,36
TR 86,25,12928
MAA 120,116,32
buffer_load_dwordx4 v19, s[20:23], s54 offen offset:1024 lds
MAA 120,112,12
TR 88,25,1024
MAA 116,112,8
TR 90,25,1536
MAA 116,116,28
TR 92,25,13440
MAA 112,116,24
TR 94,25,13952
MAA 112,112,4
TR 96,25,2048
MAA 108,112,0
TR 98,25,2560
MAA 108,116,20
TR 100,25,14464
MAA 140,20,124
buffer_load_dwordx4 v20, s[20:23], s54 offen offset:2048 lds
MAA 140,0,120
TR 102,25,14976
s_add_u32 s54, s54, 196608
MAA 144,4,120
MAA 144,24,124
MAA 148,28,124
MAA 148,8,120
MAA 152,12,120
MAA 152,32,124
MAA 160,36,124
MAA 160,16,120
s_waitcnt lgkmcnt(8)
s_barrier
MAA 60,80,40
TR 104,25,32
MAA 60,84,60
TR 106,25,544
s_add_u32 m0, s56, 136064
MAA 64,84,64
buffer_load_dwordx4 v18, s[20:23], s54 offen lds
MAA 64,80,44
TR 108,25,12448
MAA 68,80,48
TR 110,25,12960
MAA 68,84,68
buffer_load_dwordx4 v19, s[20:23], s54 offen offset:1024 lds
MAA 72,84,72
TR 112,25,1056
MAA 72,80,52
TR 114,25,1568
s_waitcnt lgkmcnt(6)
MAA 104,88,52
buffer_load_dwordx4 v20, s[20:23], s54 offen offset:2048 lds
MAA 104,92,72
TR 116,25,13472
s_add_u32 s54, s54, 196608
MAA 100,92,68
TR 118,25,13984
s_add_u32 m0, s59, 16640
MAA 100,88,48
TR 120,25,2080
s_xor_b32 s58, s87, 1310720
MAA 96,88,44
buffer_load_dwordx4 v5, s[24:27], s58 offen lds
MAA 96,92,64
TR 122,25,2592
MAA 92,92,60
TR 124,25,14496
MAA 92,88,40
buffer_load_dwordx4 v6, s[24:27], s58 offen offset:1024 lds
MAA 124,40,96
TR 126,25,15008
s_add_u32 m0, s59, 24960
MAA 124,60,100
RD 0,23,36992
s_xor_b32 s58, s87, 1441792
MAA 128,64,100
buffer_load_dwordx4 v5, s[24:27], s58 offen lds
MAA 128,44,96
RD 4,23,39296
MAA 132,48,96
RD 8,23,41600
MAA 132,68,100
buffer_load_dwordx4 v6, s[24:27], s58 offen offset:1024 lds
MAA 136,72,100
RD 12,23,43904
MAA 136,52,96
RD 16,24,36992
MAA 156,56,96
v_permlane32_swap_b32 v164, v166
MAA 156,76,100
v_permlane32_swap_b32 v165, v167
v_add_f32 v164, v164, v166
v_add_f32 v165, v165, v167
v_mul_f32 v164, 0xba800000, v164
v_mul_f32 v165, 0x3a800000, v165
v_fma_f32 v165, -v164, v164, v165
v_max_f32 v165, 0, v165
v_add_f32 v165, 0x3727c5ac, v165
v_rsq_f32 v166, v165
s_nop 0
v_mov_b32 v165, v166
v_mul_f32 v166, 0x3e8293ee, v166
s_waitcnt vmcnt(14) lgkmcnt(5)
s_barrier
MAA 76,104,40
ds_write_b128 v7, v[164:167]
MAA 76,108,60
ds_write_b32 v17, v164
s_add_u32 m0, s59, 74880
MAA 80,108,64
ds_write_b32 v17, v165 offset:1024
s_xor_b32 s58, s87, 131072
MAA 80,104,44
buffer_load_dwordx4 v5, s[24:27], s58 offen lds
MAA 84,104,48
RD 20,30,36992
MAA 84,108,68
RD 24,30,39296
MAA 88,108,72
RD 28,30,41600
MAA 88,104,52
RD 32,30,43904
MAA 244,104,56
RD 36,31,36992
MAA 244,108,76
buffer_load_dwordx4 v6, s[24:27], s58 offen offset:1024 lds
MAA 120,116,72
TR 80,25,24832
s_add_u32 m0, s59, 83200
MAA 120,112,52
TR 82,25,25344
s_xor_b32 s58, s87, 262144
MAA 116,112,48
TR 84,25,37248
MAA 116,116,68
TR 86,25,37760
MAA 112,116,64
TR 88,25,25856
MAA 112,112,44
buffer_load_dwordx4 v5, s[24:27], s58 offen lds
MAA 108,112,40
TR 90,25,26368
MAA 108,116,60
TR 92,25,38272
MAA 140,60,124
TR 94,25,38784
MAA 140,40,120
TR 96,25,26880
MAA 144,44,120
TR 98,25,27392
MAA 144,64,124
buffer_load_dwordx4 v6, s[24:27], s58 offen offset:1024 lds
MAA 148,68,124
TR 100,25,39296
MAA 148,48,120
TR 102,25,39808
MAA 152,52,120
MAA 152,72,124
MAA 160,76,124
MAA 160,56,120
s_waitcnt vmcnt(8) lgkmcnt(0)
s_barrier
MAA 104,88,12
TR 112,25,25888
s_add_u32 m0, s59, 33280
MAA 104,92,32
TR 114,25,26400
s_xor_b32 s58, s87, 1572864
MAA 100,92,28
buffer_load_dwordx4 v5, s[24:27], s58 offen lds
MAA 100,88,8
TR 116,25,38304
MAA 96,88,4
TR 118,25,38816
MAA 96,92,24
TR 120,25,26912
MAA 92,92,20
buffer_load_dwordx4 v6, s[24:27], s58 offen offset:1024 lds
MAA 92,88,0
TR 122,25,27424
s_add_u32 m0, s59, 41600
MAA 156,16,96
TR 124,25,39328
s_xor_b32 s58, s87, 1703936
MAA 156,36,100
TR 126,25,39840
MAA 72,84,32
buffer_load_dwordx4 v5, s[24:27], s58 offen lds
MAA 72,80,12
TR 104,25,24864
MAA 68,80,8
TR 106,25,25376
MAA 68,84,28
TR 108,25,37280
MAA 64,84,24
buffer_load_dwordx4 v6, s[24:27], s58 offen offset:1024 lds
MAA 64,80,4
TR 110,25,37792
s_xor_b32 s58, s87, 393216
MAA 60,80,0
RD 40,23,55488
MAA 60,84,20
RD 44,23,57792
s_waitcnt lgkmcnt(12)
MAA 120,112,12
RD 48,23,60096
s_waitcnt lgkmcnt(11)
MAA 120,116,32
RD 52,23,62400
MAA 116,116,28
RD 56,24,55488
MAA 116,112,8
RD 60,30,55488
MAA 112,112,4
RD 64,30,57792
MAA 112,116,24
s_waitcnt lgkmcnt(7)
s_barrier
RD 68,30,60096
MAA 108,116,20
RD 72,30,62400
s_add_u32 m0, s59, 91520
MAA 108,112,0
RD 76,31,55488
MAA 160,16,120
TR 144,25,50688
MAA 160,36,124
TR 146,25,51200
MAA 244,108,36
TR 148,25,63104
MAA 244,104,16
TR 150,25,63616
MAA 88,104,12
TR 152,25,50720
MAA 88,108,32
TR 154,25,51232
MAA 84,108,28
TR 156,25,63136
MAA 84,104,8
TR 158,25,63648
MAA 80,104,4
TR 160,25,51712
MAA 80,108,24
TR 162,25,52224
MAA 76,108,20
TR 164,25,64128
MAA 76,104,0
TR 166,25,64640
s_waitcnt lgkmcnt(10)
MAA 104,144,52
TR 168,25,51744
s_waitcnt lgkmcnt(9)
MAA 104,148,72
TR 170,25,52256
MAA 100,148,68
TR 172,25,64160
MAA 100,144,48
TR 174,25,64672
MAA 96,144,44
TR 136,25,49696
MAA 96,148,64
TR 138,25,50208
MAA 92,148,60
TR 140,25,62112
MAA 92,144,40
TR 142,25,62624
s_waitcnt lgkmcnt(14)
MAA 120,152,52
TR 128,25,49664
s_waitcnt lgkmcnt(13)
MAA 120,156,72
TR 130,25,50176
MAA 116,156,68
TR 132,25,62080
MAA 116,152,48
TR 134,25,62592
MAA 112,152,44
ds_read_b128 v[232:235], v10 offset:1792
MAA 112,156,64
ds_read_b128 v[228:231], v10 offset:1536
MAA 108,156,60
ds_read_b128 v[224:227], v10 offset:1280
MAA 108,152,40
ds_read_b128 v[220:223], v10 offset:1024
s_waitcnt lgkmcnt(15)
MAA 156,56,160
buffer_load_dwordx4 v5, s[24:27], s58 offen lds
MAA 156,76,164
s_waitcnt lgkmcnt(12)
MAA 160,76,172
MAA 160,56,168
s_waitcnt lgkmcnt(4)
s_barrier
MAA 244,136,56
buffer_load_dwordx4 v6, s[24:27], s58 offen offset:1024 lds
MAA 244,140,76
s_add_u32 m0, s59, 99840
s_xor_b32 s58, s87, 524288
MAA 88,140,72
MAA 88,136,52
MAA 84,136,48
buffer_load_dwordx4 v5, s[24:27], s58 offen lds
MAA 84,140,68
buffer_load_dwordx4 v6, s[24:27], s58 offen offset:1024 lds
s_add_u32 m0, s59, 108160
s_xor_b32 s58, s87, 655360
buffer_load_dwordx4 v5, s[24:27], s58 offen lds
buffer_load_dwordx4 v6, s[24:27], s58 offen offset:1024 lds
s_mov_b32 exec_lo, 0x10001
s_mov_b32 exec_hi, 0x10001
ds_write_b128 v13, v[244:247] offset:64
s_mov_b64 exec, 0xffff
ds_write_b32 v12, v156 offset:512
ds_write_b32 v12, v160 offset:576
s_mov_b64 exec, -1
MAA 80,136,44
MAA 80,140,64
MAA 76,140,60
MAA 76,136,40
MAA 72,128,52
MAA 72,132,72
s_waitcnt lgkmcnt(0)
s_barrier
MAA 68,128,48
ds_read_b128 v[28:31], v13
s_add_u32 m0, s59, 49920
MAA 68,132,68
ds_read_b128 v[32:35], v13 offset:64
s_xor_b32 s58, s87, 1835008
MAA 64,132,64
ds_read_b128 v[36:39], v13 offset:256
MAA 64,128,44
ds_read_b128 v[40:43], v13 offset:320
MAA 60,128,40
ds_read_b32 v44, v12 offset:512
MAA 60,132,60
ds_read_b32 v45, v12 offset:576
ds_read_b128 v[240:243], v11 offset:704
ds_read_b128 v[244:247], v11 offset:1728
ds_read_b128 v[18:21], v11 offset:448
ds_read_b128 v[22:25], v11 offset:1472
buffer_load_dwordx4 v5, s[24:27], s58 offen lds
s_waitcnt lgkmcnt(9)
v_pk_fma_f32 v[72:73], v[28:29], v[232:233], v[72:73] op_sel_hi:[1,0,1]
v_cvt_pk_bf16_f32 v176, v72, v73
v_pk_fma_f32 v[74:75], v[30:31], v[232:233], v[74:75] op_sel_hi:[1,0,1]
v_cvt_pk_bf16_f32 v177, v74, v75
s_waitcnt lgkmcnt(8)
v_pk_fma_f32 v[88:89], v[32:33], v[232:233], v[88:89] op_sel_hi:[1,0,1]
v_cvt_pk_bf16_f32 v178, v88, v89
v_pk_fma_f32 v[90:91], v[34:35], v[232:233], v[90:91] op_sel_hi:[1,0,1]
s_waitcnt lgkmcnt(7)
v_pk_fma_f32 v[104:105], v[36:37], v[232:233], v[104:105] op_sel_hi:[1,0,1]
v_pk_mul_f32 v[104:105], v[104:105], v[232:233] op_sel:[0,1] op_sel_hi:[1,1]
v_cvt_pk_bf16_f32 v196, v104, v105
v_pk_fma_f32 v[106:107], v[38:39], v[232:233], v[106:107] op_sel_hi:[1,0,1]
v_pk_mul_f32 v[106:107], v[106:107], v[232:233] op_sel:[0,1] op_sel_hi:[1,1]
v_cvt_pk_bf16_f32 v197, v106, v107
s_waitcnt lgkmcnt(6)
v_pk_fma_f32 v[120:121], v[40:41], v[232:233], v[120:121] op_sel_hi:[1,0,1]
v_pk_mul_f32 v[120:121], v[120:121], v[232:233] op_sel:[0,1] op_sel_hi:[1,1]
v_cvt_pk_bf16_f32 v198, v120, v121
v_pk_fma_f32 v[122:123], v[42:43], v[232:233], v[122:123] op_sel_hi:[1,0,1]
v_pk_mul_f32 v[122:123], v[122:123], v[232:233] op_sel:[0,1] op_sel_hi:[1,1]
v_cvt_pk_bf16_f32 v199, v122, v123
v_pk_fma_f32 v[100:101], v[36:37], v[228:229], v[100:101] op_sel_hi:[1,0,1]
v_pk_mul_f32 v[100:101], v[100:101], v[228:229] op_sel:[0,1] op_sel_hi:[1,1]
s_waitcnt lgkmcnt(3)
v_pk_fma_f32 v[156:157], v[240:241], v[44:45], v[156:157] op_sel_hi:[1,0,1]
v_pk_fma_f32 v[158:159], v[242:243], v[44:45], v[158:159] op_sel_hi:[1,0,1]
s_waitcnt lgkmcnt(2)
v_pk_mul_f32 v[156:157], v[156:157], v[244:245]
v_cvt_pk_bf16_f32 v236, v156, v157
v_pk_mul_f32 v[158:159], v[158:159], v[246:247]
v_cvt_pk_bf16_f32 v237, v158, v159
v_pk_fma_f32 v[160:161], v[240:241], v[44:45], v[160:161] op_sel:[0,1,0] op_sel_hi:[1,1,1]
v_pk_mul_f32 v[160:161], v[160:161], v[244:245]
v_cvt_pk_bf16_f32 v238, v160, v161
v_pk_fma_f32 v[162:163], v[242:243], v[44:45], v[162:163] op_sel:[0,1,0] op_sel_hi:[1,1,1]
v_pk_mul_f32 v[162:163], v[162:163], v[246:247]
v_cvt_pk_bf16_f32 v239, v162, v163
ds_write_b128 v8, v[236:239] offset:1024
v_cvt_pk_bf16_f32 v192, v100, v101
v_pk_fma_f32 v[102:103], v[38:39], v[228:229], v[102:103] op_sel_hi:[1,0,1]
v_pk_mul_f32 v[102:103], v[102:103], v[228:229] op_sel:[0,1] op_sel_hi:[1,1]
v_cvt_pk_bf16_f32 v193, v102, v103
v_pk_fma_f32 v[116:117], v[40:41], v[228:229], v[116:117] op_sel_hi:[1,0,1]
v_pk_mul_f32 v[116:117], v[116:117], v[228:229] op_sel:[0,1] op_sel_hi:[1,1]
v_cvt_pk_bf16_f32 v194, v116, v117
v_pk_fma_f32 v[118:119], v[42:43], v[228:229], v[118:119] op_sel_hi:[1,0,1]
v_pk_mul_f32 v[118:119], v[118:119], v[228:229] op_sel:[0,1] op_sel_hi:[1,1]
v_cvt_pk_bf16_f32 v195, v118, v119
v_pk_fma_f32 v[96:97], v[36:37], v[224:225], v[96:97] op_sel_hi:[1,0,1]
v_pk_mul_f32 v[96:97], v[96:97], v[224:225] op_sel:[0,1] op_sel_hi:[1,1]
v_cvt_pk_bf16_f32 v188, v96, v97
v_pk_fma_f32 v[98:99], v[38:39], v[224:225], v[98:99] op_sel_hi:[1,0,1]
v_pk_mul_f32 v[98:99], v[98:99], v[224:225] op_sel:[0,1] op_sel_hi:[1,1]
v_cvt_pk_bf16_f32 v189, v98, v99
v_pk_fma_f32 v[112:113], v[40:41], v[224:225], v[112:113] op_sel_hi:[1,0,1]
v_pk_mul_f32 v[112:113], v[112:113], v[224:225] op_sel:[0,1] op_sel_hi:[1,1]
v_cvt_pk_bf16_f32 v190, v112, v113
v_pk_fma_f32 v[114:115], v[42:43], v[224:225], v[114:115] op_sel_hi:[1,0,1]
v_pk_mul_f32 v[114:115], v[114:115], v[224:225] op_sel:[0,1] op_sel_hi:[1,1]
v_cvt_pk_bf16_f32 v191, v114, v115
v_pk_fma_f32 v[92:93], v[36:37], v[220:221], v[92:93] op_sel_hi:[1,0,1]
v_pk_mul_f32 v[92:93], v[92:93], v[220:221] op_sel:[0,1] op_sel_hi:[1,1]
v_cvt_pk_bf16_f32 v184, v92, v93
v_pk_fma_f32 v[94:95], v[38:39], v[220:221], v[94:95] op_sel_hi:[1,0,1]
v_pk_mul_f32 v[94:95], v[94:95], v[220:221] op_sel:[0,1] op_sel_hi:[1,1]
v_cvt_pk_bf16_f32 v185, v94, v95
v_pk_fma_f32 v[108:109], v[40:41], v[220:221], v[108:109] op_sel_hi:[1,0,1]
v_pk_mul_f32 v[108:109], v[108:109], v[220:221] op_sel:[0,1] op_sel_hi:[1,1]
v_cvt_pk_bf16_f32 v186, v108, v109
v_pk_fma_f32 v[110:111], v[42:43], v[220:221], v[110:111] op_sel_hi:[1,0,1]
v_pk_mul_f32 v[110:111], v[110:111], v[220:221] op_sel:[0,1] op_sel_hi:[1,1]
v_cvt_pk_bf16_f32 v187, v110, v111
v_cvt_pk_bf16_f32 v179, v90, v91
v_pk_fma_f32 v[68:69], v[28:29], v[228:229], v[68:69] op_sel_hi:[1,0,1]
v_cvt_pk_bf16_f32 v172, v68, v69
v_pk_fma_f32 v[70:71], v[30:31], v[228:229], v[70:71] op_sel_hi:[1,0,1]
v_cvt_pk_bf16_f32 v173, v70, v71
v_pk_fma_f32 v[84:85], v[32:33], v[228:229], v[84:85] op_sel_hi:[1,0,1]
v_cvt_pk_bf16_f32 v174, v84, v85
v_pk_fma_f32 v[86:87], v[34:35], v[228:229], v[86:87] op_sel_hi:[1,0,1]
v_cvt_pk_bf16_f32 v175, v86, v87
v_pk_fma_f32 v[64:65], v[28:29], v[224:225], v[64:65] op_sel_hi:[1,0,1]
v_cvt_pk_bf16_f32 v168, v64, v65
v_pk_fma_f32 v[66:67], v[30:31], v[224:225], v[66:67] op_sel_hi:[1,0,1]
v_cvt_pk_bf16_f32 v169, v66, v67
v_pk_fma_f32 v[80:81], v[32:33], v[224:225], v[80:81] op_sel_hi:[1,0,1]
v_cvt_pk_bf16_f32 v170, v80, v81
.Lpad10:
s_cbranch_execz .Lt0r
v_pk_fma_f32 v[82:83], v[34:35], v[224:225], v[82:83] op_sel_hi:[1,0,1]
v_cvt_pk_bf16_f32 v171, v82, v83
v_pk_fma_f32 v[60:61], v[28:29], v[220:221], v[60:61] op_sel_hi:[1,0,1]
v_cvt_pk_bf16_f32 v164, v60, v61
v_pk_fma_f32 v[62:63], v[30:31], v[220:221], v[62:63] op_sel_hi:[1,0,1]
v_cvt_pk_bf16_f32 v165, v62, v63
v_pk_fma_f32 v[76:77], v[32:33], v[220:221], v[76:77] op_sel_hi:[1,0,1]
v_cvt_pk_bf16_f32 v166, v76, v77
v_pk_fma_f32 v[78:79], v[34:35], v[220:221], v[78:79] op_sel_hi:[1,0,1]
s_waitcnt lgkmcnt(0)
s_barrier
v_cvt_pk_bf16_f32 v167, v78, v79
v_mfma_f32_16x16x32_bf16 v[120:123], v[196:199], v[176:179], v[50:53]
ds_read_b128 v[180:183], v9
v_mfma_f32_16x16x32_bf16 v[104:107], v[192:195], v[176:179], v[46:49]
buffer_load_dwordx4 v6, s[24:27], s58 offen offset:1024 lds
v_mfma_f32_16x16x32_bf16 v[116:119], v[192:195], v[172:175], v[50:53]
ds_read_b64 v[200:201], v9 offset:1024
s_add_u32 m0, s59, 58240
v_mfma_f32_16x16x32_bf16 v[100:103], v[188:191], v[172:175], v[46:49]
ds_read_b64 v[210:211], v9 offset:1032
s_xor_b32 s58, s87, 1966080
v_mfma_f32_16x16x32_bf16 v[112:115], v[188:191], v[168:171], v[50:53]
ds_read_b128 v[240:243], v11 offset:384
v_max3_f32 v88, v104, v105, v106
v_mfma_f32_16x16x32_bf16 v[96:99], v[184:187], v[168:171], v[46:49]
buffer_load_dwordx4 v5, s[24:27], s58 offen lds
v_mfma_f32_16x16x32_bf16 v[108:111], v[184:187], v[164:167], v[50:53]
ds_read_b128 v[244:247], v11 offset:1408
v_max3_f32 v89, v107, v120, v121
v_max3_f32 v88, v88, v122, v123
v_max_f32 v90, v88, v89
v_max_f32 v89, v88, v89
v_max3_f32 v84, v100, v101, v102
v_max3_f32 v85, v103, v116, v117
s_waitcnt lgkmcnt(4)
v_mfma_f32_16x16x32_bf16 v[92:95], v[180:183], v[164:167], v[46:49]
ds_read_b128 v[28:31], v11 offset:320
v_permlane16_swap_b32 v90, v89
MAA 136,12,96
buffer_load_dwordx4 v6, s[24:27], s58 offen offset:1024 lds
MAA 136,32,100
ds_read_b128 v[32:35], v11 offset:1344
s_add_u32 m0, s59, 66560
MAA 136,52,160
ds_read_b128 v[36:39], v11 offset:256
s_xor_b32 s58, s87, 0
MAA 136,72,164
ds_read_b128 v[40:43], v11 offset:1280
v_max_f32 v88, v90, v89
MAA 152,72,172
buffer_load_dwordx4 v5, s[24:27], s58 offen lds
MAA 152,52,168
v_max_f32 v89, v90, v89
v_max3_f32 v84, v84, v118, v119
MAA 152,32,124
v_permlane32_swap_b32 v88, v89
MAA 152,12,120
v_max_f32 v88, v88, v89
v_mul_f32 v88, v88, v234
v_max_f32 v86, v84, v85
v_max_f32 v85, v84, v85
v_max3_f32 v80, v96, v97, v98
v_max3_f32 v81, v99, v112, v113
v_permlane16_swap_b32 v86, v85
v_max3_f32 v80, v80, v114, v115
v_max_f32 v84, v86, v85
v_max_f32 v85, v86, v85
v_max_f32 v82, v80, v81
v_max_f32 v81, v80, v81
v_permlane32_swap_b32 v84, v85
v_max3_f32 v76, v92, v93, v94
v_max_f32 v84, v84, v85
v_mul_f32 v84, v84, v230
v_permlane16_swap_b32 v82, v81
v_max3_f32 v77, v95, v108, v109
v_max_f32 v80, v82, v81
v_max_f32 v81, v82, v81
v_max3_f32 v76, v76, v110, v111
v_max_f32 v78, v76, v77
v_permlane32_swap_b32 v80, v81
v_max_f32 v77, v76, v77
v_max_f32 v80, v80, v81
v_mul_f32 v80, v80, v226
v_permlane16_swap_b32 v78, v77
v_pk_fma_f32 v[104:105], v[104:105], v[234:235], v[88:89] op_sel_hi:[1,0,0] neg_lo:[0,0,1] neg_hi:[0,0,1]
v_max_f32 v76, v78, v77
v_max_f32 v77, v78, v77
v_pk_fma_f32 v[106:107], v[106:107], v[234:235], v[88:89] op_sel_hi:[1,0,0] neg_lo:[0,0,1] neg_hi:[0,0,1]
v_pk_fma_f32 v[120:121], v[120:121], v[234:235], v[88:89] op_sel_hi:[1,0,0] neg_lo:[0,0,1] neg_hi:[0,0,1]
v_permlane32_swap_b32 v76, v77
v_pk_fma_f32 v[122:123], v[122:123], v[234:235], v[88:89] op_sel_hi:[1,0,0] neg_lo:[0,0,1] neg_hi:[0,0,1]
v_max_f32 v76, v76, v77
v_mul_f32 v76, v76, v222
v_pk_fma_f32 v[100:101], v[100:101], v[230:231], v[84:85] op_sel_hi:[1,0,0] neg_lo:[0,0,1] neg_hi:[0,0,1]
v_pk_fma_f32 v[102:103], v[102:103], v[230:231], v[84:85] op_sel_hi:[1,0,0] neg_lo:[0,0,1] neg_hi:[0,0,1]
v_pk_fma_f32 v[116:117], v[116:117], v[230:231], v[84:85] op_sel_hi:[1,0,0] neg_lo:[0,0,1] neg_hi:[0,0,1]
v_pk_fma_f32 v[118:119], v[118:119], v[230:231], v[84:85] op_sel_hi:[1,0,0] neg_lo:[0,0,1] neg_hi:[0,0,1]
v_pk_fma_f32 v[96:97], v[96:97], v[226:227], v[80:81] op_sel_hi:[1,0,0] neg_lo:[0,0,1] neg_hi:[0,0,1]
v_pk_fma_f32 v[98:99], v[98:99], v[226:227], v[80:81] op_sel_hi:[1,0,0] neg_lo:[0,0,1] neg_hi:[0,0,1]
v_pk_fma_f32 v[112:113], v[112:113], v[226:227], v[80:81] op_sel_hi:[1,0,0] neg_lo:[0,0,1] neg_hi:[0,0,1]
v_pk_fma_f32 v[114:115], v[114:115], v[226:227], v[80:81] op_sel_hi:[1,0,0] neg_lo:[0,0,1] neg_hi:[0,0,1]
v_pk_fma_f32 v[92:93], v[92:93], v[222:223], v[76:77] op_sel_hi:[1,0,0] neg_lo:[0,0,1] neg_hi:[0,0,1]
v_pk_fma_f32 v[94:95], v[94:95], v[222:223], v[76:77] op_sel_hi:[1,0,0] neg_lo:[0,0,1] neg_hi:[0,0,1]
v_pk_fma_f32 v[108:109], v[108:109], v[222:223], v[76:77] op_sel_hi:[1,0,0] neg_lo:[0,0,1] neg_hi:[0,0,1]
v_pk_fma_f32 v[110:111], v[110:111], v[222:223], v[76:77] op_sel_hi:[1,0,0] neg_lo:[0,0,1] neg_hi:[0,0,1]
v_pk_fma_f32 v[136:137], v[18:19], v[44:45], v[136:137] op_sel_hi:[1,0,1]
v_pk_mul_f32 v[136:137], v[136:137], v[22:23]
v_pk_fma_f32 v[138:139], v[20:21], v[44:45], v[138:139] op_sel_hi:[1,0,1]
v_pk_mul_f32 v[138:139], v[138:139], v[24:25]
v_pk_fma_f32 v[152:153], v[18:19], v[44:45], v[152:153] op_sel:[0,1,0] op_sel_hi:[1,1,1]
v_pk_mul_f32 v[152:153], v[152:153], v[22:23]
v_pk_fma_f32 v[154:155], v[20:21], v[44:45], v[154:155] op_sel:[0,1,0] op_sel_hi:[1,1,1]
v_pk_mul_f32 v[154:155], v[154:155], v[24:25]
v_exp_f32 v104, v104
s_nop 0
MAA 132,8,96
buffer_load_dwordx4 v6, s[24:27], s58 offen offset:1024 lds
MAA 132,28,100
s_add_u32 m0, s59, 116480
s_xor_b32 s58, s87, 786432
v_exp_f32 v105, v105
MAA 132,48,160
v_exp_f32 v106, v106
MAA 132,68,164
v_exp_f32 v107, v107
MAA 148,68,172
buffer_load_dwordx4 v5, s[24:27], s58 offen lds
MAA 148,48,168
v_exp_f32 v120, v120
MAA 148,28,124
v_exp_f32 v121, v121
MAA 148,8,120
v_exp_f32 v122, v122
MAA 128,4,96
buffer_load_dwordx4 v6, s[24:27], s58 offen offset:1024 lds
MAA 128,24,100
s_add_u32 m0, s59, 124800
s_xor_b32 s58, s87, 917504
v_exp_f32 v123, v123
MAA 128,44,160
v_exp_f32 v100, v100
MAA 128,64,164
v_exp_f32 v101, v101
MAA 144,64,172
buffer_load_dwordx4 v5, s[24:27], s58 offen lds
MAA 144,44,168
v_exp_f32 v102, v102
MAA 144,24,124
v_exp_f32 v103, v103
MAA 144,4,120
v_exp_f32 v116, v116
MAA 124,0,96
buffer_load_dwordx4 v6, s[24:27], s58 offen offset:1024 lds
MAA 124,20,100
v_exp_f32 v117, v117
MAA 124,40,160
v_exp_f32 v118, v118
MAA 124,60,164
v_exp_f32 v119, v119
MAA 140,60,172
v_exp_f32 v96, v96
MAA 140,40,168
v_exp_f32 v97, v97
MAA 140,20,124
v_exp_f32 v98, v98
MAA 140,0,120
v_cvt_pk_bf16_f32 v72, v104, v105
v_cvt_pk_bf16_f32 v73, v106, v107
v_cvt_pk_bf16_f32 v74, v120, v121
v_cvt_pk_bf16_f32 v75, v122, v123
v_cvt_pk_bf16_f32 v68, v100, v101
v_cvt_pk_bf16_f32 v69, v102, v103
v_cvt_pk_bf16_f32 v70, v116, v117
v_cvt_pk_bf16_f32 v71, v118, v119
v_exp_f32 v99, v99
v_exp_f32 v112, v112
v_exp_f32 v113, v113
v_exp_f32 v114, v114
v_exp_f32 v115, v115
v_cvt_pk_bf16_f32 v64, v96, v97
v_cvt_pk_bf16_f32 v65, v98, v99
v_cvt_pk_bf16_f32 v66, v112, v113
v_cvt_pk_bf16_f32 v67, v114, v115
v_cvt_pk_bf16_f32 v208, v136, v137
v_cvt_pk_bf16_f32 v209, v138, v139
v_cvt_pk_bf16_f32 v218, v152, v153
v_cvt_pk_bf16_f32 v219, v154, v155
s_waitcnt lgkmcnt(5)
v_pk_fma_f32 v[132:133], v[240:241], v[44:45], v[132:133] op_sel_hi:[1,0,1]
s_waitcnt lgkmcnt(4)
v_pk_mul_f32 v[132:133], v[132:133], v[244:245]
v_cvt_pk_bf16_f32 v206, v132, v133
v_pk_fma_f32 v[134:135], v[242:243], v[44:45], v[134:135] op_sel_hi:[1,0,1]
v_pk_mul_f32 v[134:135], v[134:135], v[246:247]
v_cvt_pk_bf16_f32 v207, v134, v135
v_pk_fma_f32 v[148:149], v[240:241], v[44:45], v[148:149] op_sel:[0,1,0] op_sel_hi:[1,1,1]
v_pk_mul_f32 v[148:149], v[148:149], v[244:245]
v_cvt_pk_bf16_f32 v216, v148, v149
v_pk_fma_f32 v[150:151], v[242:243], v[44:45], v[150:151] op_sel:[0,1,0] op_sel_hi:[1,1,1]
v_pk_mul_f32 v[150:151], v[150:151], v[246:247]
v_cvt_pk_bf16_f32 v217, v150, v151
s_waitcnt lgkmcnt(3)
v_pk_fma_f32 v[128:129], v[28:29], v[44:45], v[128:129] op_sel_hi:[1,0,1]
s_waitcnt lgkmcnt(2)
v_pk_mul_f32 v[128:129], v[128:129], v[32:33]
v_cvt_pk_bf16_f32 v204, v128, v129
v_pk_fma_f32 v[130:131], v[30:31], v[44:45], v[130:131] op_sel_hi:[1,0,1]
v_pk_mul_f32 v[130:131], v[130:131], v[34:35]
v_cvt_pk_bf16_f32 v205, v130, v131
v_pk_fma_f32 v[144:145], v[28:29], v[44:45], v[144:145] op_sel:[0,1,0] op_sel_hi:[1,1,1]
v_pk_mul_f32 v[144:145], v[144:145], v[32:33]
v_cvt_pk_bf16_f32 v214, v144, v145
v_pk_fma_f32 v[146:147], v[30:31], v[44:45], v[146:147] op_sel:[0,1,0] op_sel_hi:[1,1,1]
v_pk_mul_f32 v[146:147], v[146:147], v[34:35]
v_cvt_pk_bf16_f32 v215, v146, v147
s_waitcnt lgkmcnt(1)
v_pk_fma_f32 v[124:125], v[36:37], v[44:45], v[124:125] op_sel_hi:[1,0,1]
s_waitcnt lgkmcnt(0)
v_pk_mul_f32 v[124:125], v[124:125], v[40:41]
v_cvt_pk_bf16_f32 v202, v124, v125
v_pk_fma_f32 v[126:127], v[38:39], v[44:45], v[126:127] op_sel_hi:[1,0,1]
v_pk_mul_f32 v[126:127], v[126:127], v[42:43]
v_cvt_pk_bf16_f32 v203, v126, v127
v_pk_fma_f32 v[140:141], v[36:37], v[44:45], v[140:141] op_sel:[0,1,0] op_sel_hi:[1,1,1]
v_pk_mul_f32 v[140:141], v[140:141], v[40:41]
v_cvt_pk_bf16_f32 v212, v140, v141
v_pk_fma_f32 v[142:143], v[38:39], v[44:45], v[142:143] op_sel:[0,1,0] op_sel_hi:[1,1,1]
v_pk_mul_f32 v[142:143], v[142:143], v[42:43]
v_cvt_pk_bf16_f32 v213, v142, v143
s_nop 0
v_mfma_f32_16x16x32_bf16 v[88:91], v[248:251], v[72:75], 0
v_exp_f32 v92, v92
v_mfma_f32_16x16x32_bf16 v[104:107], v[206:209], v[72:75], 0
v_exp_f32 v93, v93
v_mfma_f32_16x16x32_bf16 v[120:123], v[216:219], v[72:75], 0
v_exp_f32 v94, v94
v_mfma_f32_16x16x32_bf16 v[84:87], v[248:251], v[68:71], 0
v_exp_f32 v95, v95
v_mfma_f32_16x16x32_bf16 v[100:103], v[204:207], v[68:71], 0
v_exp_f32 v108, v108
v_mfma_f32_16x16x32_bf16 v[116:119], v[214:217], v[68:71], 0
v_exp_f32 v109, v109
v_mfma_f32_16x16x32_bf16 v[80:83], v[248:251], v[64:67], 0
v_exp_f32 v110, v110
v_mfma_f32_16x16x32_bf16 v[96:99], v[202:205], v[64:67], 0
v_exp_f32 v111, v111
v_mfma_f32_16x16x32_bf16 v[112:115], v[212:215], v[64:67], 0
v_cvt_pk_bf16_f32 v60, v92, v93
v_cvt_pk_bf16_f32 v61, v94, v95
v_cvt_pk_bf16_f32 v62, v108, v109
v_cvt_pk_bf16_f32 v63, v110, v111
v_rcp_f32 v88, v88
v_rcp_f32 v84, v84
v_mfma_f32_16x16x32_bf16 v[76:79], v[248:251], v[60:63], 0
v_rcp_f32 v80, v80
v_mfma_f32_16x16x32_bf16 v[92:95], v[200:203], v[60:63], 0
v_mfma_f32_16x16x32_bf16 v[108:111], v[210:213], v[60:63], 0
s_nop 4
v_rcp_f32 v76, v76
v_pk_mul_f32 v[104:105], v[104:105], v[88:89] op_sel_hi:[1,0]
v_pk_mul_f32 v[106:107], v[106:107], v[88:89] op_sel_hi:[1,0]
v_pk_mul_f32 v[120:121], v[120:121], v[88:89] op_sel_hi:[1,0]
v_pk_mul_f32 v[122:123], v[122:123], v[88:89] op_sel_hi:[1,0]
v_cvt_pk_bf16_f32 v176, v104, v105
v_cvt_pk_bf16_f32 v177, v106, v107
v_cvt_pk_bf16_f32 v178, v120, v121
v_cvt_pk_bf16_f32 v179, v122, v123
buffer_store_dwordx4 v[176:179], v4, s[16:19], s74 offen offset:3072 sc1
v_pk_mul_f32 v[100:101], v[100:101], v[84:85] op_sel_hi:[1,0]
v_pk_mul_f32 v[102:103], v[102:103], v[84:85] op_sel_hi:[1,0]
v_pk_mul_f32 v[116:117], v[116:117], v[84:85] op_sel_hi:[1,0]
v_pk_mul_f32 v[118:119], v[118:119], v[84:85] op_sel_hi:[1,0]
v_cvt_pk_bf16_f32 v172, v100, v101
v_cvt_pk_bf16_f32 v173, v102, v103
v_cvt_pk_bf16_f32 v174, v116, v117
v_cvt_pk_bf16_f32 v175, v118, v119
buffer_store_dwordx4 v[172:175], v4, s[16:19], s74 offen offset:2048 sc1
v_pk_mul_f32 v[96:97], v[96:97], v[80:81] op_sel_hi:[1,0]
v_pk_mul_f32 v[98:99], v[98:99], v[80:81] op_sel_hi:[1,0]
v_pk_mul_f32 v[112:113], v[112:113], v[80:81] op_sel_hi:[1,0]
v_pk_mul_f32 v[114:115], v[114:115], v[80:81] op_sel_hi:[1,0]
v_cvt_pk_bf16_f32 v168, v96, v97
v_cvt_pk_bf16_f32 v169, v98, v99
v_cvt_pk_bf16_f32 v170, v112, v113
v_cvt_pk_bf16_f32 v171, v114, v115
buffer_store_dwordx4 v[168:171], v4, s[16:19], s74 offen offset:1024 sc1
v_pk_mul_f32 v[92:93], v[92:93], v[76:77] op_sel_hi:[1,0]
v_pk_mul_f32 v[94:95], v[94:95], v[76:77] op_sel_hi:[1,0]
v_pk_mul_f32 v[108:109], v[108:109], v[76:77] op_sel_hi:[1,0]
v_pk_mul_f32 v[110:111], v[110:111], v[76:77] op_sel_hi:[1,0]
v_cvt_pk_bf16_f32 v164, v92, v93
v_cvt_pk_bf16_f32 v165, v94, v95
v_cvt_pk_bf16_f32 v166, v108, v109
v_cvt_pk_bf16_f32 v167, v110, v111
buffer_store_dwordx4 v[164:167], v4, s[16:19], s74 offen sc1
s_nop 1
.Lqkve2:
s_lshl_b32 s62, s3, 11
s_add_u32 s62, s62, s84
v_lshl_add_u32 v4, v1, 4, s62
v_lshrrev_b32 v2, 3, v1
v_cmp_eq_u32 vcc, 3, v2
v_add_u32 v2, 67108480, v4
s_nop 0
v_cndmask_b32 v4, v4, v2, vcc
v_bfe_u32 v5, v1, 3, 1
v_lshrrev_b32 v2, 4, v1
v_lshl_add_u32 v5, v2, 3, v5
s_lshl_b32 s62, s3, 1
v_add_u32 v5, s62, v5
v_mul_u32_u24 v5, 2048, v5
v_and_b32 v2, 7, v1
v_lshl_add_u32 v5, v2, 4, v5
s_lshl_b32 s62, s7, 7
v_add_u32 v5, s62, v5
v_add_u32 v6, 64512, v5
v_bfe_u32 v8, v1, 3, 2
v_mul_u32_u24 v8, 2080, v8
v_bfe_u32 v2, v1, 2, 1
v_lshl_add_u32 v8, v2, 7, v8
v_bfe_u32 v2, v1, 5, 1
v_lshl_add_u32 v8, v2, 8, v8
v_and_b32 v2, 3, v1
v_lshl_add_u32 v8, v2, 3, v8
s_mov_b32 s57, 66560
v_add_u32 v7, s57, v8
s_lshr_b32 s54, s87, 17
s_lshl_b32 s54, s54, 18
s_add_u32 s54, s54, 4194304
s_mov_b32 s52, s54
s_add_u32 s53, s54, 131072
v_accvgpr_read_b32 v32, a224
v_accvgpr_read_b32 v33, a225
v_accvgpr_read_b32 v34, a226
v_accvgpr_read_b32 v35, a227
v_accvgpr_read_b32 v36, a228
v_accvgpr_read_b32 v37, a229
v_accvgpr_read_b32 v38, a230
v_accvgpr_read_b32 v39, a231
v_accvgpr_read_b32 v40, a232
v_accvgpr_read_b32 v41, a233
v_accvgpr_read_b32 v42, a234
v_accvgpr_read_b32 v43, a235
v_accvgpr_read_b32 v44, a236
v_accvgpr_read_b32 v45, a237
v_accvgpr_read_b32 v46, a238
v_accvgpr_read_b32 v47, a239
v_accvgpr_read_b32 v48, a240
v_accvgpr_read_b32 v49, a241
v_accvgpr_read_b32 v50, a242
v_accvgpr_read_b32 v51, a243
v_accvgpr_read_b32 v52, a244
v_accvgpr_read_b32 v53, a245
v_accvgpr_read_b32 v54, a246
v_accvgpr_read_b32 v55, a247
v_accvgpr_read_b32 v56, a248
v_accvgpr_read_b32 v57, a249
v_accvgpr_read_b32 v58, a250
v_accvgpr_read_b32 v59, a251
v_accvgpr_read_b32 v60, a252
v_accvgpr_read_b32 v61, a253
v_accvgpr_read_b32 v62, a254
v_accvgpr_read_b32 v63, a255
s_lshl_b32 s62, s49, 3
s_add_u32 s62, s62, s48
s_mul_i32 s62, s62, 28672
s_add_u32 s62, s62, s51
v_lshrrev_b32 v12, 4, v1
v_mul_u32_u24 v12, 57344, v12
v_and_b32 v2, 15, v1
v_lshl_add_u32 v12, v2, 4, v12
v_add_u32 v12, s62, v12
v_add_u32 v13, 6112, v12
v_add_u32 v14, 12224, v12
v_add_u32 v15, 18336, v12
s_mul_i32 s59, s3, 4224
s_mov_b32 s58, 0
s_mov_b32 s36, s0
s_mov_b32 s37, s1
s_lshl_b32 s62, s8, 10
s_add_u32 s62, s62, 30425088
s_lshl_b32 s64, s6, 10
s_add_u32 s64, s64, 30425088
s_lshr_b32 s67, s5, 2
s_and_b32 s67, s67, 3
s_lshl_b32 s67, s67, 7
s_add_u32 s64, s64, s67
v_lshl_add_u32 v252, v1, 7, s62
v_mov_b32 v253, s64
v_mov_b32 v255, 1
s_waitcnt vmcnt(0) lgkmcnt(0)
s_cmp_lg_u32 s3, 1
s_barrier
s_cbranch_scc1 .Lnopoll34
s_mov_b64 exec, 15
buffer_atomic_add v255, v252, s[16:19], 0 offen
s_mov_b64 exec, 1
v_mov_b32 v254, 0
buffer_atomic_add v254, v253, s[16:19], 0 offen sc0
s_sleep 5
s_mov_b32 s15, 0
.Lpoll33:
v_mov_b32 v255, 0
buffer_atomic_add v255, v253, s[16:19], 0 offen sc0
s_waitcnt vmcnt(1)
v_cmp_gt_u32 vcc, 16, v254
s_add_u32 s15, s15, 1
s_cbranch_vccz .Lnopoll34r
v_mov_b32 v254, 0
buffer_atomic_add v254, v253, s[16:19], 0 offen sc0
s_waitcnt vmcnt(1)
v_cmp_gt_u32 vcc, 16, v255
s_add_u32 s15, s15, 1
s_cbranch_vccz .Lnopoll34r
s_cmp_le_u32 s15, 100000
s_cbranch_scc1 .Lpoll33
s_branch .Lnopoll34r
.Lnopoll34:
s_mov_b64 exec, 0
s_cmp_eq_u32 s3, 2
s_cbranch_scc1 .Lpad11
s_cmp_eq_u32 s3, 3
s_cbranch_scc1 .Lpad12
s_branch .Lpad13
.Lnopoll34r:
s_mov_b64 exec, -1
s_barrier
buffer_load_dwordx4 v[64:67], v4, s[16:19], s52 offen sc1
buffer_load_dwordx4 v[68:71], v4, s[16:19], s52 offen offset:1024 sc1
s_xor_b32 s52, s54, 262144
buffer_load_dwordx4 v[72:75], v4, s[16:19], s53 offen sc1
buffer_load_dwordx4 v[76:79], v4, s[16:19], s53 offen offset:1024 sc1
s_xor_b32 s53, s54, 393216
buffer_load_dwordx4 v[80:83], v4, s[16:19], s52 offen sc1
buffer_load_dwordx4 v[84:87], v4, s[16:19], s52 offen offset:1024 sc1
s_xor_b32 s52, s54, 524288
buffer_load_dwordx4 v[88:91], v4, s[16:19], s53 offen sc1
buffer_load_dwordx4 v[92:95], v4, s[16:19], s53 offen offset:1024 sc1
s_xor_b32 s53, s54, 655360
buffer_load_dwordx4 v[96:99], v4, s[16:19], s52 offen sc1
buffer_load_dwordx4 v[100:103], v4, s[16:19], s52 offen offset:1024 sc1
s_xor_b32 s52, s54, 786432
buffer_load_dwordx4 v[104:107], v4, s[16:19], s53 offen sc1
buffer_load_dwordx4 v[108:111], v4, s[16:19], s53 offen offset:1024 sc1
s_xor_b32 s53, s54, 917504
ds_read_b64_tr_b16 a[0:1], v7
TR 2,7,512
TR 16,7,1024
TR 18,7,1536
TR 4,7,32
TR 6,7,544
TR 20,7,1056
TR 22,7,1568
TR 8,7,64
TR 10,7,576
TR 24,7,1088
TR 26,7,1600
TR 12,7,96
TR 14,7,608
TR 28,7,1120
TR 30,7,1632
s_waitcnt vmcnt(8) lgkmcnt(14)
MAV 32,0,64
TR 32,7,8320
s_waitcnt lgkmcnt(13)
MAV 32,16,72
buffer_load_dwordx4 v[112:115], v4, s[16:19], s52 offen sc1
MAV 48,16,76
TR 34,7,8832
MAV 48,0,68
TR 48,7,9344
TR 50,7,9856
s_waitcnt lgkmcnt(14)
MAV 52,4,68
TR 36,7,8352
s_waitcnt lgkmcnt(13)
MAV 52,20,76
buffer_load_dwordx4 v[116:119], v4, s[16:19], s52 offen offset:1024 sc1
MAV 36,20,72
TR 38,7,8864
s_xor_b32 s52, s54, 1048576
MAV 36,4,64
TR 52,7,9376
TR 54,7,9888
s_waitcnt lgkmcnt(14)
MAV 40,8,64
TR 40,7,8384
s_waitcnt lgkmcnt(13)
MAV 40,24,72
buffer_load_dwordx4 v[120:123], v4, s[16:19], s53 offen sc1
MAV 56,24,76
TR 42,7,8896
MAV 56,8,68
TR 56,7,9408
TR 58,7,9920
s_waitcnt lgkmcnt(14)
MAV 60,12,68
TR 44,7,8416
s_waitcnt lgkmcnt(13)
MAV 60,28,76
buffer_load_dwordx4 v[124:127], v4, s[16:19], s53 offen offset:1024 sc1
MAV 44,28,72
TR 46,7,8928
s_xor_b32 s53, s54, 1179648
MAV 44,12,64
TR 60,7,9440
TR 62,7,9952
s_waitcnt vmcnt(8) lgkmcnt(8)
MAV 32,32,80
TR 0,7,16640
MAV 32,48,88
buffer_load_dwordx4 v[64:67], v4, s[16:19], s52 offen sc1
MAV 48,48,92
TR 2,7,17152
MAV 48,32,84
TR 16,7,17664
TR 18,7,18176
MAV 52,36,84
TR 4,7,16672
MAV 52,52,92
buffer_load_dwordx4 v[68:71], v4, s[16:19], s52 offen offset:1024 sc1
MAV 36,52,88
TR 6,7,17184
s_xor_b32 s52, s54, 1310720
MAV 36,36,80
TR 20,7,17696
TR 22,7,18208
s_waitcnt lgkmcnt(8)
MAV 40,40,80
TR 8,7,16704
MAV 40,56,88
buffer_load_dwordx4 v[72:75], v4, s[16:19], s53 offen sc1
MAV 56,56,92
TR 10,7,17216
MAV 56,40,84
TR 24,7,17728
TR 26,7,18240
MAV 60,44,84
TR 12,7,16736
MAV 60,60,92
buffer_load_dwordx4 v[76:79], v4, s[16:19], s53 offen offset:1024 sc1
MAV 44,60,88
TR 14,7,17248
s_xor_b32 s53, s54, 1441792
MAV 44,44,80
TR 28,7,17760
TR 30,7,18272
s_waitcnt vmcnt(8) lgkmcnt(8)
MAV 32,0,96
TR 32,7,24960
MAV 32,16,104
buffer_load_dwordx4 v[80:83], v4, s[16:19], s52 offen sc1
MAV 48,16,108
TR 34,7,25472
MAV 48,0,100
TR 48,7,25984
TR 50,7,26496
MAV 52,4,100
TR 36,7,24992
MAV 52,20,108
buffer_load_dwordx4 v[84:87], v4, s[16:19], s52 offen offset:1024 sc1
MAV 36,20,104
TR 38,7,25504
s_xor_b32 s52, s54, 1572864
MAV 36,4,96
TR 52,7,26016
TR 54,7,26528
s_waitcnt lgkmcnt(8)
MAV 40,8,96
TR 40,7,25024
MAV 40,24,104
buffer_load_dwordx4 v[88:91], v4, s[16:19], s53 offen sc1
MAV 56,24,108
TR 42,7,25536
MAV 56,8,100
TR 56,7,26048
TR 58,7,26560
MAV 60,12,100
TR 44,7,25056
MAV 60,28,108
buffer_load_dwordx4 v[92:95], v4, s[16:19], s53 offen offset:1024 sc1
MAV 44,28,104
TR 46,7,25568
s_xor_b32 s53, s54, 1703936
MAV 44,12,96
TR 60,7,26080
TR 62,7,26592
s_waitcnt vmcnt(8) lgkmcnt(8)
MAV 32,32,112
TR 0,7,33280
MAV 32,48,120
buffer_load_dwordx4 v[96:99], v4, s[16:19], s52 offen sc1
MAV 48,48,124
.Lpad11:
s_cbranch_execz .Lpad14
TR 2,7,33792
MAV 48,32,116
TR 16,7,34304
TR 18,7,34816
MAV 52,36,116
TR 4,7,33312
MAV 52,52,124
buffer_load_dwordx4 v[100:103], v4, s[16:19], s52 offen offset:1024 sc1
MAV 36,52,120
TR 6,7,33824
s_xor_b32 s52, s54, 1835008
MAV 36,36,112
TR 20,7,34336
TR 22,7,34848
s_waitcnt lgkmcnt(8)
MAV 40,40,112
TR 8,7,33344
MAV 40,56,120
buffer_load_dwordx4 v[104:107], v4, s[16:19], s53 offen sc1
MAV 56,56,124
TR 10,7,33856
MAV 56,40,116
TR 24,7,34368
TR 26,7,34880
MAV 60,44,116
TR 12,7,33376
MAV 60,60,124
buffer_load_dwordx4 v[108:111], v4, s[16:19], s53 offen offset:1024 sc1
MAV 44,60,120
TR 14,7,33888
s_xor_b32 s53, s54, 1966080
MAV 44,44,112
TR 28,7,34400
TR 30,7,34912
s_waitcnt vmcnt(8) lgkmcnt(8)
MAV 32,0,64
TR 32,7,41600
MAV 32,16,72
buffer_load_dwordx4 v[112:115], v4, s[16:19], s52 offen sc1
MAV 48,16,76
TR 34,7,42112
MAV 48,0,68
TR 48,7,42624
TR 50,7,43136
MAV 52,4,68
TR 36,7,41632
MAV 52,20,76
buffer_load_dwordx4 v[116:119], v4, s[16:19], s52 offen offset:1024 sc1
MAV 36,20,72
TR 38,7,42144
s_xor_b32 s52, s54, 2097152
MAV 36,4,64
TR 52,7,42656
TR 54,7,43168
s_waitcnt lgkmcnt(8)
MAV 40,8,64
TR 40,7,41664
MAV 40,24,72
buffer_load_dwordx4 v[120:123], v4, s[16:19], s53 offen sc1
MAV 56,24,76
TR 42,7,42176
MAV 56,8,68
TR 56,7,42688
TR 58,7,43200
MAV 60,12,68
TR 44,7,41696
MAV 60,28,76
buffer_load_dwordx4 v[124:127], v4, s[16:19], s53 offen offset:1024 sc1
MAV 44,28,72
TR 46,7,42208
s_xor_b32 s53, s54, 2228224
MAV 44,12,64
TR 60,7,42720
TR 62,7,43232
s_waitcnt vmcnt(8) lgkmcnt(8)
MAV 32,32,80
TR 0,7,49920
MAV 32,48,88
buffer_load_dwordx4 v[64:67], v4, s[16:19], s52 offen sc1
MAV 48,48,92
TR 2,7,50432
MAV 48,32,84
TR 16,7,50944
TR 18,7,51456
MAV 52,36,84
TR 4,7,49952
MAV 52,52,92
buffer_load_dwordx4 v[68:71], v4, s[16:19], s52 offen offset:1024 sc1
MAV 36,52,88
TR 6,7,50464
s_xor_b32 s52, s54, 2359296
MAV 36,36,80
TR 20,7,50976
TR 22,7,51488
s_waitcnt lgkmcnt(8)
MAV 40,40,80
TR 8,7,49984
MAV 40,56,88
buffer_load_dwordx4 v[72:75], v4, s[16:19], s53 offen sc1
MAV 56,56,92
TR 10,7,50496
MAV 56,40,84
TR 24,7,51008
TR 26,7,51520
MAV 60,44,84
TR 12,7,50016
MAV 60,60,92
buffer_load_dwordx4 v[76:79], v4, s[16:19], s53 offen offset:1024 sc1
MAV 44,60,88
TR 14,7,50528
s_xor_b32 s53, s54, 2490368
MAV 44,44,80
TR 28,7,51040
TR 30,7,51552
s_waitcnt vmcnt(8) lgkmcnt(8)
MAV 32,0,96
TR 32,7,58240
MAV 32,16,104
buffer_load_dwordx4 v[80:83], v4, s[16:19], s52 offen sc1
MAV 48,16,108
TR 34,7,58752
MAV 48,0,100
TR 48,7,59264
TR 50,7,59776
MAV 52,4,100
TR 36,7,58272
MAV 52,20,108
buffer_load_dwordx4 v[84:87], v4, s[16:19], s52 offen offset:1024 sc1
MAV 36,20,104
TR 38,7,58784
s_xor_b32 s52, s54, 2621440
MAV 36,4,96
TR 52,7,59296
TR 54,7,59808
s_waitcnt lgkmcnt(8)
MAV 40,8,96
TR 40,7,58304
MAV 40,24,104
buffer_load_dwordx4 v[88:91], v4, s[16:19], s53 offen sc1
MAV 56,24,108
TR 42,7,58816
MAV 56,8,100
TR 56,7,59328
TR 58,7,59840
MAV 60,12,100
TR 44,7,58336
MAV 60,28,108
buffer_load_dwordx4 v[92:95], v4, s[16:19], s53 offen offset:1024 sc1
MAV 44,28,104
TR 46,7,58848
s_xor_b32 s53, s54, 2752512
MAV 44,12,96
TR 60,7,59360
TR 62,7,59872
s_xor_b32 s57, s57, 66560
v_add_u32 v7, s57, v8
s_waitcnt vmcnt(8) lgkmcnt(8)
MAV 32,32,112
ds_read_b64_tr_b16 a[0:1], v7
MAV 32,48,120
buffer_load_dwordx4 v[96:99], v4, s[16:19], s52 offen sc1
MAV 48,48,124
TR 2,7,512
MAV 48,32,116
TR 16,7,1024
TR 18,7,1536
MAV 52,36,116
TR 4,7,32
MAV 52,52,124
buffer_load_dwordx4 v[100:103], v4, s[16:19], s52 offen offset:1024 sc1
MAV 36,52,120
TR 6,7,544
s_xor_b32 s52, s54, 2883584
MAV 36,36,112
TR 20,7,1056
TR 22,7,1568
s_waitcnt lgkmcnt(8)
MAV 40,40,112
TR 8,7,64
MAV 40,56,120
buffer_load_dwordx4 v[104:107], v4, s[16:19], s53 offen sc1
MAV 56,56,124
TR 10,7,576
MAV 56,40,116
TR 24,7,1088
TR 26,7,1600
MAV 60,44,116
TR 12,7,96
MAV 60,60,124
buffer_load_dwordx4 v[108:111], v4, s[16:19], s53 offen offset:1024 sc1
MAV 44,60,120
TR 14,7,608
s_xor_b32 s53, s54, 3014656
MAV 44,44,112
TR 28,7,1120
TR 30,7,1632
s_waitcnt vmcnt(8) lgkmcnt(8)
MAV 32,0,64
TR 32,7,8320
MAV 32,16,72
buffer_load_dwordx4 v[112:115], v4, s[16:19], s52 offen sc1
MAV 48,16,76
TR 34,7,8832
MAV 48,0,68
TR 48,7,9344
TR 50,7,9856
MAV 52,4,68
TR 36,7,8352
MAV 52,20,76
buffer_load_dwordx4 v[116:119], v4, s[16:19], s52 offen offset:1024 sc1
MAV 36,20,72
TR 38,7,8864
s_xor_b32 s52, s54, 3145728
MAV 36,4,64
TR 52,7,9376
TR 54,7,9888
s_waitcnt lgkmcnt(8)
MAV 40,8,64
TR 40,7,8384
MAV 40,24,72
buffer_load_dwordx4 v[120:123], v4, s[16:19], s53 offen sc1
MAV 56,24,76
TR 42,7,8896
MAV 56,8,68
TR 56,7,9408
TR 58,7,9920
MAV 60,12,68
TR 44,7,8416
MAV 60,28,76
buffer_load_dwordx4 v[124:127], v4, s[16:19], s53 offen offset:1024 sc1
MAV 44,28,72
TR 46,7,8928
s_xor_b32 s53, s54, 3276800
MAV 44,12,64
TR 60,7,9440
TR 62,7,9952
s_waitcnt vmcnt(8) lgkmcnt(8)
MAV 32,32,80
TR 0,7,16640
MAV 32,48,88
buffer_load_dwordx4 v[64:67], v4, s[16:19], s52 offen sc1
MAV 48,48,92
TR 2,7,17152
MAV 48,32,84
TR 16,7,17664
TR 18,7,18176
MAV 52,36,84
TR 4,7,16672
MAV 52,52,92
buffer_load_dwordx4 v[68:71], v4, s[16:19], s52 offen offset:1024 sc1
MAV 36,52,88
TR 6,7,17184
s_xor_b32 s52, s54, 3407872
MAV 36,36,80
TR 20,7,17696
TR 22,7,18208
s_waitcnt lgkmcnt(8)
MAV 40,40,80
TR 8,7,16704
MAV 40,56,88
buffer_load_dwordx4 v[72:75], v4, s[16:19], s53 offen sc1
MAV 56,56,92
TR 10,7,17216
MAV 56,40,84
TR 24,7,17728
TR 26,7,18240
MAV 60,44,84
TR 12,7,16736
MAV 60,60,92
buffer_load_dwordx4 v[76:79], v4, s[16:19], s53 offen offset:1024 sc1
MAV 44,60,88
TR 14,7,17248
s_xor_b32 s53, s54, 3538944
MAV 44,44,80
TR 28,7,17760
TR 30,7,18272
s_waitcnt vmcnt(8) lgkmcnt(8)
MAV 32,0,96
TR 32,7,24960
MAV 32,16,104
buffer_load_dwordx4 v[80:83], v4, s[16:19], s52 offen sc1
MAV 48,16,108
TR 34,7,25472
MAV 48,0,100
TR 48,7,25984
TR 50,7,26496
MAV 52,4,100
TR 36,7,24992
MAV 52,20,108
buffer_load_dwordx4 v[84:87], v4, s[16:19], s52 offen offset:1024 sc1
MAV 36,20,104
TR 38,7,25504
s_xor_b32 s52, s54, 3670016
MAV 36,4,96
TR 52,7,26016
TR 54,7,26528
s_waitcnt lgkmcnt(8)
MAV 40,8,96
TR 40,7,25024
MAV 40,24,104
buffer_load_dwordx4 v[88:91], v4, s[16:19], s53 offen sc1
MAV 56,24,108
TR 42,7,25536
MAV 56,8,100
TR 56,7,26048
TR 58,7,26560
MAV 60,12,100
TR 44,7,25056
MAV 60,28,108
buffer_load_dwordx4 v[92:95], v4, s[16:19], s53 offen offset:1024 sc1
MAV 44,28,104
TR 46,7,25568
s_xor_b32 s53, s54, 3801088
MAV 44,12,96
TR 60,7,26080
TR 62,7,26592
s_waitcnt vmcnt(8) lgkmcnt(8)
MAV 32,32,112
TR 0,7,33280
MAV 32,48,120
buffer_load_dwordx4 v[96:99], v4, s[16:19], s52 offen sc1
MAV 48,48,124
TR 2,7,33792
MAV 48,32,116
TR 16,7,34304
TR 18,7,34816
MAV 52,36,116
TR 4,7,33312
MAV 52,52,124
buffer_load_dwordx4 v[100:103], v4, s[16:19], s52 offen offset:1024 sc1
MAV 36,52,120
TR 6,7,33824
s_xor_b32 s52, s54, 3932160
MAV 36,36,112
TR 20,7,34336
TR 22,7,34848
s_waitcnt lgkmcnt(8)
MAV 40,40,112
TR 8,7,33344
MAV 40,56,120
buffer_load_dwordx4 v[104:107], v4, s[16:19], s53 offen sc1
MAV 56,56,124
TR 10,7,33856
MAV 56,40,116
TR 24,7,34368
TR 26,7,34880
MAV 60,44,116
TR 12,7,33376
MAV 60,60,124
buffer_load_dwordx4 v[108:111], v4, s[16:19], s53 offen offset:1024 sc1
MAV 44,60,120
TR 14,7,33888
s_xor_b32 s53, s54, 4063232
MAV 44,44,112
TR 28,7,34400
TR 30,7,34912
s_waitcnt vmcnt(8) lgkmcnt(8)
MAV 32,0,64
TR 32,7,41600
MAV 32,16,72
buffer_load_dwordx4 v[112:115], v4, s[16:19], s52 offen sc1
MAV 48,16,76
TR 34,7,42112
MAV 48,0,68
TR 48,7,42624
TR 50,7,43136
MAV 52,4,68
TR 36,7,41632
MAV 52,20,76
buffer_load_dwordx4 v[116:119], v4, s[16:19], s52 offen offset:1024 sc1
MAV 36,20,72
TR 38,7,42144
MAV 36,4,64
TR 52,7,42656
TR 54,7,43168
s_waitcnt lgkmcnt(8)
MAV 40,8,64
TR 40,7,41664
MAV 40,24,72
buffer_load_dwordx4 v[120:123], v4, s[16:19], s53 offen sc1
MAV 56,24,76
TR 42,7,42176
MAV 56,8,68
TR 56,7,42688
TR 58,7,43200
MAV 60,12,68
TR 44,7,41696
MAV 60,28,76
buffer_load_dwordx4 v[124:127], v4, s[16:19], s53 offen offset:1024 sc1
MAV 44,28,72
TR 46,7,42208
MAV 44,12,64
TR 60,7,42720
TR 62,7,43232
s_barrier
s_waitcnt vmcnt(8) lgkmcnt(8)
MAV 32,32,80
TR 0,7,49920
s_add_u32 m0, s59, 84480
MAV 32,48,88
buffer_load_dwordx4 v12, s[32:35], s58 offen   lds
MAV 48,48,92
TR 2,7,50432
MAV 48,32,84
TR 16,7,50944
TR 18,7,51456
MAV 52,36,84
TR 4,7,49952
MAV 52,52,92
buffer_load_dwordx4 v13, s[32:35], s58 offen offset:1056   lds
MAV 36,52,88
TR 6,7,50464
MAV 36,36,80
TR 20,7,50976
TR 22,7,51488
s_waitcnt lgkmcnt(8)
MAV 40,40,80
TR 8,7,49984
MAV 40,56,88
buffer_load_dwordx4 v14, s[32:35], s58 offen offset:2112   lds
MAV 56,56,92
TR 10,7,50496
MAV 56,40,84
TR 24,7,51008
TR 26,7,51520
MAV 60,44,84
TR 12,7,50016
MAV 60,60,92
buffer_load_dwordx4 v15, s[32:35], s58 offen offset:3168   lds
MAV 44,60,88
TR 14,7,50528
MAV 44,44,80
TR 28,7,51040
TR 30,7,51552
s_waitcnt vmcnt(8) lgkmcnt(8)
MAV 32,0,96
TR 32,7,58240
s_add_u32 m0, s59, 101376
MAV 32,16,104
buffer_load_dwordx4 v12, s[80:83], s58 offen   lds
MAV 48,16,108
TR 34,7,58752
MAV 48,0,100
TR 48,7,59264
TR 50,7,59776
MAV 52,4,100
TR 36,7,58272
MAV 52,20,108
buffer_load_dwordx4 v13, s[80:83], s58 offen offset:1056   lds
MAV 36,20,104
TR 38,7,58784
MAV 36,4,96
TR 52,7,59296
TR 54,7,59808
s_waitcnt lgkmcnt(8)
MAV 40,8,96
TR 40,7,58304
MAV 40,24,104
buffer_load_dwordx4 v14, s[80:83], s58 offen offset:2112   lds
MAV 56,24,108
TR 42,7,58816
MAV 56,8,100
TR 56,7,59328
TR 58,7,59840
MAV 60,12,100
TR 44,7,58336
MAV 60,28,108
buffer_load_dwordx4 v15, s[80:83], s58 offen offset:3168   lds
MAV 44,28,104
TR 46,7,58848
s_add_u32 s58, s58, 458752
MAV 44,12,96
TR 60,7,59360
TR 62,7,59872
s_waitcnt vmcnt(11) lgkmcnt(14)
MAV 32,32,112
s_add_u32 m0, s59, 118272
s_lshl_b32 s64, s6, 14
s_lshl_b32 s65, s49, 13
s_waitcnt vmcnt(9) lgkmcnt(12)
MAV 32,48,120
buffer_load_dwordx4 v12, s[32:35], s58 offen   lds
s_waitcnt vmcnt(9)
MAV 48,48,124
s_add_u32 s64, s64, s65
s_lshl_b32 s65, s7, 9
s_add_u32 s64, s64, s65
MAV 48,32,116
s_lshl_b32 s65, s48, 8
s_add_u32 s64, s64, s65
s_add_u32 s64, s64, 29622272
s_waitcnt lgkmcnt(10)
MAV 52,36,116
s_lshl_b32 s62, s7, 18
v_and_b32 v152, 31, v1
v_lshlrev_b32 v152, 3, v152
s_waitcnt lgkmcnt(8)
MAV 52,52,124
buffer_load_dwordx4 v13, s[32:35], s58 offen offset:1056   lds
MAV 36,52,120
s_add_u32 s62, s62, 8388608
v_lshrrev_b32 v153, 5, v1
v_lshl_add_u32 v152, v153, 28, v152
MAV 36,36,112
s_add_u32 s63, s62, 131072
v_cvt_pk_bf16_f32 v128, v32, v33
v_cvt_pk_bf16_f32 v129, v34, v35
s_waitcnt lgkmcnt(6)
MAV 40,40,112
v_cvt_pk_bf16_f32 v136, v48, v49
v_cvt_pk_bf16_f32 v137, v50, v51
s_waitcnt lgkmcnt(4)
MAV 40,56,120
buffer_load_dwordx4 v14, s[32:35], s58 offen offset:2112   lds
MAV 56,56,124
v_cvt_pk_bf16_f32 v130, v36, v37
v_cvt_pk_bf16_f32 v131, v38, v39
MAV 56,40,116
v_cvt_pk_bf16_f32 v138, v52, v53
v_cvt_pk_bf16_f32 v139, v54, v55
s_waitcnt lgkmcnt(2)
MAV 60,44,116
v_cvt_pk_bf16_f32 v132, v40, v41
v_cvt_pk_bf16_f32 v133, v42, v43
s_waitcnt lgkmcnt(0)
MAV 60,60,124
buffer_load_dwordx4 v15, s[32:35], s58 offen offset:3168   lds
MAV 44,60,120
v_cvt_pk_bf16_f32 v140, v56, v57
v_cvt_pk_bf16_f32 v141, v58, v59
MAV 44,44,112
s_nop 2
v_cvt_pk_bf16_f32 v142, v60, v61
v_cvt_pk_bf16_f32 v143, v62, v63
v_pk_mul_f32 v[146:147], v[32:33], v[32:33]
.Lpad12:
s_cbranch_execz .Lpad15
buffer_store_dwordx4 v[128:131], v4, s[16:19], s62 offen sc1
v_pk_mul_f32 v[150:151], v[48:49], v[48:49]
v_pk_fma_f32 v[146:147], v[34:35], v[34:35], v[146:147]
v_pk_add_f32 v[144:145], v[32:33], v[34:35]
v_pk_fma_f32 v[150:151], v[50:51], v[50:51], v[150:151]
v_cvt_pk_bf16_f32 v134, v44, v45
v_cvt_pk_bf16_f32 v135, v46, v47
v_pk_add_f32 v[148:149], v[48:49], v[50:51]
v_pk_fma_f32 v[146:147], v[36:37], v[36:37], v[146:147]
v_pk_add_f32 v[144:145], v[144:145], v[36:37]
v_pk_fma_f32 v[150:151], v[52:53], v[52:53], v[150:151]
v_pk_add_f32 v[148:149], v[148:149], v[52:53]
v_pk_fma_f32 v[146:147], v[38:39], v[38:39], v[146:147]
v_pk_add_f32 v[144:145], v[144:145], v[38:39]
buffer_store_dwordx4 v[132:135], v4, s[16:19], s63 offen sc1
v_pk_fma_f32 v[150:151], v[54:55], v[54:55], v[150:151]
v_pk_add_f32 v[148:149], v[148:149], v[54:55]
v_pk_fma_f32 v[146:147], v[40:41], v[40:41], v[146:147]
v_pk_add_f32 v[144:145], v[144:145], v[40:41]
v_pk_fma_f32 v[150:151], v[56:57], v[56:57], v[150:151]
v_pk_add_f32 v[148:149], v[148:149], v[56:57]
v_pk_fma_f32 v[146:147], v[42:43], v[42:43], v[146:147]
v_pk_add_f32 v[144:145], v[144:145], v[42:43]
v_pk_fma_f32 v[150:151], v[58:59], v[58:59], v[150:151]
v_pk_add_f32 v[148:149], v[148:149], v[58:59]
v_pk_fma_f32 v[146:147], v[44:45], v[44:45], v[146:147]
v_pk_add_f32 v[144:145], v[144:145], v[44:45]
v_pk_fma_f32 v[150:151], v[60:61], v[60:61], v[150:151]
buffer_store_dwordx4 v[136:139], v4, s[16:19], s62 offen offset:1024 sc1
v_pk_add_f32 v[148:149], v[148:149], v[60:61]
v_pk_fma_f32 v[146:147], v[46:47], v[46:47], v[146:147]
v_pk_add_f32 v[144:145], v[144:145], v[46:47]
v_pk_fma_f32 v[150:151], v[62:63], v[62:63], v[150:151]
v_pk_add_f32 v[148:149], v[148:149], v[62:63]
v_add_f32 v144, v144, v145
v_add_f32 v146, v146, v147
v_add_f32 v148, v148, v149
v_add_f32 v150, v150, v151
s_nop 0
v_permlane16_swap_b32 v144, v148
buffer_store_dwordx4 v[140:143], v4, s[16:19], s63 offen offset:1024 sc1
v_permlane16_swap_b32 v146, v150
v_add_f32 v144, v144, v148
v_add_f32 v146, v146, v150
s_nop 1
v_permlane32_swap_b32 v144, v146
v_add_f32 v144, v144, v146
s_nop 1
v_permlane32_swap_b32 v144, v145
buffer_store_dwordx2 v[144:145], v152, s[16:19], s64 offen sc1
s_nop 1
v_accvgpr_write_b32 a224, v32
v_accvgpr_write_b32 a225, v33
v_accvgpr_write_b32 a226, v34
v_accvgpr_write_b32 a227, v35
v_accvgpr_write_b32 a228, v36
v_accvgpr_write_b32 a229, v37
v_accvgpr_write_b32 a230, v38
v_accvgpr_write_b32 a231, v39
v_accvgpr_write_b32 a232, v40
v_accvgpr_write_b32 a233, v41
v_accvgpr_write_b32 a234, v42
v_accvgpr_write_b32 a235, v43
v_accvgpr_write_b32 a236, v44
v_accvgpr_write_b32 a237, v45
v_accvgpr_write_b32 a238, v46
v_accvgpr_write_b32 a239, v47
v_accvgpr_write_b32 a240, v48
v_accvgpr_write_b32 a241, v49
v_accvgpr_write_b32 a242, v50
v_accvgpr_write_b32 a243, v51
v_accvgpr_write_b32 a244, v52
v_accvgpr_write_b32 a245, v53
v_accvgpr_write_b32 a246, v54
v_accvgpr_write_b32 a247, v55
v_accvgpr_write_b32 a248, v56
v_accvgpr_write_b32 a249, v57
v_accvgpr_write_b32 a250, v58
v_accvgpr_write_b32 a251, v59
v_accvgpr_write_b32 a252, v60
v_accvgpr_write_b32 a253, v61
v_accvgpr_write_b32 a254, v62
v_accvgpr_write_b32 a255, v63
s_lshl_b32 s62, s10, 14
s_lshl_b32 s63, s3, 12
s_add_u32 s62, s62, s63
s_lshl_b32 s63, s12, 11
s_add_u32 s62, s62, s63
v_lshl_add_u32 v10, v1, 4, s62
v_lshrrev_b32 v2, 3, v1
v_cmp_eq_u32 vcc, 3, v2
v_add_u32 v2, 67108480, v10
s_nop 0
v_cndmask_b32 v10, v10, v2, vcc
v_xor_b32 v11, 2048, v10
v_bfe_u32 v16, v1, 2, 3
v_mul_u32_u24 v16, 1056, v16
v_bfe_u32 v2, v1, 5, 1
v_lshl_add_u32 v16, v2, 8, v16
v_and_b32 v2, 3, v1
v_lshl_add_u32 v16, v2, 3, v16
s_lshl_b32 s62, s12, 6
s_add_u32 s62, s62, 84480
s_xor_b32 s63, s12, 1
s_mul_i32 s63, s63, 192
s_add_u32 s63, s63, 84480
v_add_u32 v17, s63, v16
v_add_u32 v16, s62, v16
s_mov_b32 s52, 8388608
s_mov_b32 s53, 8388608
s_mov_b32 s54, s58
s_mov_b32 s55, s59
s_mul_i32 s59, s3, 2112
s_and_b32 s62, s7, 1
s_mul_i32 s62, s62, 3670016
s_lshr_b32 s63, s7, 1
s_lshl_b32 s63, s63, 8
s_add_u32 s62, s62, s63
s_lshl_b32 s63, s3, 12
s_add_u32 s62, s62, s63
v_lshrrev_b32 v5, 4, v1
v_lshlrev_b32 v5, 14, v5
v_and_b32 v2, 15, v1
v_lshl_add_u32 v5, v2, 4, v5
v_add_u32 v5, s62, v5
v_add_u32 v6, 992, v5
s_lshl_b32 s62, s10, 15
s_lshl_b32 s63, s3, 13
s_add_u32 s62, s62, s63
v_lshl_add_u32 v4, v1, 4, s62
s_and_b32 s47, s5, 3
s_lshr_b32 s63, s5, 2
s_lshl_b32 s63, s63, 3
s_add_u32 s63, s63, s4
s_lshl_b32 s62, s63, 1
s_add_u32 s62, s62, s48
s_mul_i32 s62, s62, 1792
v_lshrrev_b32 v7, 2, v1
v_min_u32 v8, 13, v7
v_lshl_add_u32 v8, v8, 7, s62
s_lshl_b32 s62, s63, 2
s_add_u32 s62, s62, s3
s_mul_i32 s62, s62, 640
v_and_b32 v7, 7, v7
v_min_u32 v7, 4, v7
v_lshl_add_u32 v7, v7, 7, s62
v_lshrrev_b32 v2, 5, v1
v_mul_u32_u24 v2, 3670016, v2
v_add_u32 v7, v7, v2
s_mul_i32 s44, s47, 163840
s_add_u32 s45, s47, 12
s_mul_i32 s45, s45, 229376
v_and_b32 v6, 3, v1
v_cmp_eq_u32 vcc, 3, v6
v_mov_b32 v2, 0x3f80
v_mov_b32 v20, 1.0
v_cndmask_b32 v2, v2, v20, vcc
v_cndmask_b32 v6, v6, 0, vcc
v_or_b32 v6, 12, v6
v_mul_u32_u24 v6, 0x1111, v6
v_lshl_or_b32 v6, v6, 16, v6
v_bfe_u32 v22, v1, 2, 2
v_cmp_eq_u32 vcc, 0, v22
s_nop 1
v_cndmask_b32 v20, 0, v2, vcc
v_cmp_eq_u32 vcc, 1, v22
s_nop 1
v_cndmask_b32 v21, 0, v2, vcc
v_accvgpr_write_b32 a208, v20
v_accvgpr_write_b32 a209, v21
v_accvgpr_write_b32 a210, v20
v_accvgpr_write_b32 a211, v21
v_accvgpr_write_b32 a212, 0
v_accvgpr_write_b32 a213, 0
v_accvgpr_write_b32 a214, 0
v_accvgpr_write_b32 a215, 0
v_accvgpr_write_b32 a216, 0
v_accvgpr_write_b32 a217, 0
v_accvgpr_write_b32 a218, 0
v_accvgpr_write_b32 a219, 0
s_cmp_lt_u32 s3, 2
s_cselect_b32 s40, s32, s80
s_cselect_b32 s41, s33, s81
s_cselect_b32 s42, s34, s82
s_add_u32 s62, s55, 84480
v_lshl_add_u32 v9, v1, 4, s62
s_lshl_b32 s62, s6, 10
s_add_u32 s62, s62, 30441472
s_lshl_b32 s64, s10, 1
s_lshl_b32 s64, s64, 10
s_add_u32 s64, s64, 30441472
s_lshr_b32 s67, s5, 2
s_and_b32 s67, s67, 3
s_lshl_b32 s67, s67, 7
s_add_u32 s64, s64, s67
s_add_u32 s65, s64, 1024
v_lshl_add_u32 v252, v1, 7, s62
v_mov_b32 v253, s64
v_mov_b32 v255, 1
v_writelane_b32 v253, s65, 1
s_waitcnt vmcnt(0) lgkmcnt(0)
s_cmp_lg_u32 s3, 1
s_barrier
s_cbranch_scc1 .Lnopoll37
s_mov_b64 exec, 15
buffer_atomic_add v255, v252, s[16:19], 0 offen
s_mov_b64 exec, 3
v_mov_b32 v254, 0
buffer_atomic_add v254, v253, s[16:19], 0 offen sc0
s_sleep 5
s_mov_b32 s15, 0
.Lpoll36:
v_mov_b32 v255, 0
buffer_atomic_add v255, v253, s[16:19], 0 offen sc0
s_waitcnt vmcnt(1)
v_cmp_gt_u32 vcc, 16, v254
s_add_u32 s15, s15, 1
s_cbranch_vccz .Lnopoll37r
v_mov_b32 v254, 0
buffer_atomic_add v254, v253, s[16:19], 0 offen sc0
s_waitcnt vmcnt(1)
v_cmp_gt_u32 vcc, 16, v255
s_add_u32 s15, s15, 1
s_cbranch_vccz .Lnopoll37r
s_cmp_le_u32 s15, 100000
s_cbranch_scc1 .Lpoll36
s_branch .Lnopoll37r
.Lnopoll37:
s_mov_b64 exec, 0
s_cmp_eq_u32 s3, 2
s_cbranch_scc1 .Lpad17
s_cmp_eq_u32 s3, 3
s_cbranch_scc1 .Lpad18
s_branch .Lpad19
.Lnopoll37r:
s_mov_b64 exec, -1
s_barrier
buffer_load_dwordx4 a[128:131], v10, s[16:19], s52 offen sc1
buffer_load_dwordx4 a[132:135], v10, s[16:19], s52 offen offset:1024 sc1
s_add_u32 s52, s52, 131072
buffer_load_dwordx4 a[144:147], v10, s[16:19], s52 offen sc1
buffer_load_dwordx4 a[148:151], v10, s[16:19], s52 offen offset:1024 sc1
s_add_u32 s52, s52, 131072
buffer_load_dwordx4 a[136:139], v11, s[16:19], s53 offen sc1
buffer_load_dwordx4 a[140:143], v11, s[16:19], s53 offen offset:1024 sc1
s_add_u32 s53, s53, 131072
buffer_load_dwordx4 a[152:155], v11, s[16:19], s53 offen sc1
buffer_load_dwordx4 a[156:159], v11, s[16:19], s53 offen offset:1024 sc1
s_add_u32 s53, s53, 131072
ds_read_b64_tr_b16 a[0:1], v16
TR 2,16,512
TR 4,16,8448
TR 6,16,8960
TR 8,16,32
TR 10,16,544
TR 12,16,8480
TR 14,16,8992
TR 16,16,64
TR 18,16,576
TR 20,16,8512
TR 22,16,9024
TR 24,16,96
TR 26,16,608
TR 28,16,8544
TR 30,16,9056
TR 32,16,128
TR 34,16,640
TR 36,16,8576
TR 38,16,9088
TR 40,16,160
TR 42,16,672
TR 44,16,8608
TR 46,16,9120
ds_read_b64_tr_b16 a[48:49], v17
TR 50,17,512
TR 52,17,8448
TR 54,17,8960
TR 56,17,32
TR 58,17,544
TR 60,17,8480
TR 62,17,8992
ds_read_b128 a[192:195], v9
RD 196,9,1056
RD 200,9,2112
RD 204,9,3168
s_add_u32 m0, s55, 135168
s_nop 0
buffer_load_dwordx4 v12, s[80:83], s54 offen   lds
buffer_load_dwordx4 v13, s[80:83], s54 offen offset:1056   lds
buffer_load_dwordx4 v14, s[80:83], s54 offen offset:2112   lds
buffer_load_dwordx4 v15, s[80:83], s54 offen offset:3168   lds
s_add_u32 s54, s54, 458752
s_lshl_b32 s57, s3, 13
s_add_u32 s57, s57, 49920
v_lshl_add_u32 v2, v1, 4, s57
s_waitcnt lgkmcnt(0)
s_barrier
s_waitcnt vmcnt(11)
v_mfma_f32_16x16x32_bf16 v[32:35], a[0:3], a[128:131], 0
buffer_load_dwordx4 a[160:163], v10, s[16:19], s52 offen sc1
s_waitcnt vmcnt(10)
MAA 32,4,144
TR 64,16,16896
v_smfmac_f32_16x16x64_bf16 a[212:215], a[208:211], a[192:199], v6
TR 66,16,17408
v_smfmac_f32_16x16x64_bf16 a[212:215], a[208:211], a[200:207], v6
TR 68,16,25344
v_mfma_f32_16x16x32_bf16 v[36:39], a[0:3], a[132:135], 0
TR 70,16,25856
s_waitcnt vmcnt(9)
MAA 36,4,148
buffer_load_dwordx4 a[164:167], v10, s[16:19], s52 offen offset:1024 sc1
v_mfma_f32_16x16x32_bf16 v[52:55], a[8:11], a[132:135], 0
TR 72,16,16928
s_add_u32 s52, s52, 131072
MAA 52,12,148
TR 74,16,17440
v_mfma_f32_16x16x32_bf16 v[48:51], a[8:11], a[128:131], 0
TR 76,16,25376
MAA 48,12,144
TR 78,16,25888
v_mfma_f32_16x16x32_bf16 v[96:99], a[16:19], a[128:131], 0
buffer_load_dwordx4 a[176:179], v10, s[16:19], s52 offen sc1
MAA 96,20,144
TR 80,16,16960
v_mfma_f32_16x16x32_bf16 v[100:103], a[16:19], a[132:135], 0
TR 82,16,17472
MAA 100,20,148
TR 84,16,25408
v_mfma_f32_16x16x32_bf16 v[116:119], a[24:27], a[132:135], 0
TR 86,16,25920
MAA 116,28,148
buffer_load_dwordx4 a[180:183], v10, s[16:19], s52 offen offset:1024 sc1
v_mfma_f32_16x16x32_bf16 v[112:115], a[24:27], a[128:131], 0
TR 88,16,16992
s_add_u32 s52, s52, 131072
MAA 112,28,144
TR 90,16,17504
v_mfma_f32_16x16x32_bf16 v[160:163], a[32:35], a[128:131], 0
TR 92,16,25440
MAA 160,36,144
TR 94,16,25952
v_mfma_f32_16x16x32_bf16 v[164:167], a[32:35], a[132:135], 0
buffer_load_dwordx4 a[168:171], v11, s[16:19], s53 offen sc1
MAA 164,36,148
TR 96,16,17024
v_mfma_f32_16x16x32_bf16 v[180:183], a[40:43], a[132:135], 0
TR 98,16,17536
MAA 180,44,148
TR 100,16,25472
v_mfma_f32_16x16x32_bf16 v[176:179], a[40:43], a[128:131], 0
TR 102,16,25984
MAA 176,44,144
buffer_load_dwordx4 a[172:175], v11, s[16:19], s53 offen offset:1024 sc1
v_mfma_f32_16x16x32_bf16 v[224:227], a[48:51], a[128:131], 0
TR 104,16,17056
s_add_u32 s53, s53, 131072
MAA 224,52,144
TR 106,16,17568
v_mfma_f32_16x16x32_bf16 v[228:231], a[48:51], a[132:135], 0
TR 108,16,25504
MAA 228,52,148
TR 110,16,26016
v_mfma_f32_16x16x32_bf16 v[236:239], a[56:59], a[132:135], 0
buffer_load_dwordx4 a[184:187], v11, s[16:19], s53 offen sc1
MAA 236,60,148
TR 112,17,16896
v_mfma_f32_16x16x32_bf16 v[232:235], a[56:59], a[128:131], 0
TR 114,17,17408
MAA 232,60,144
TR 116,17,25344
s_waitcnt vmcnt(11)
v_mfma_f32_16x16x32_bf16 v[188:191], a[40:43], a[140:143], 0
TR 118,17,25856
MAA 188,44,156
buffer_load_dwordx4 a[188:191], v11, s[16:19], s53 offen offset:1024 sc1
v_mfma_f32_16x16x32_bf16 v[184:187], a[40:43], a[136:139], 0
TR 120,17,16928
s_add_u32 s53, s53, 131072
MAA 184,44,152
TR 122,17,17440
s_add_u32 m0, s55, 84480
v_mfma_f32_16x16x32_bf16 v[168:171], a[32:35], a[136:139], 0
TR 124,17,25376
MAA 168,36,152
TR 126,17,25888
v_mfma_f32_16x16x32_bf16 v[172:175], a[32:35], a[140:143], 0
buffer_load_dwordx4 v12, s[32:35], s54 offen   lds
MAA 172,36,156
RD 192,9,16896
v_mfma_f32_16x16x32_bf16 v[124:127], a[24:27], a[140:143], 0
RD 196,9,17952
MAA 124,28,156
RD 200,9,19008
v_mfma_f32_16x16x32_bf16 v[120:123], a[24:27], a[136:139], 0
RD 204,9,20064
MAA 120,28,152
buffer_load_dwordx4 v13, s[32:35], s54 offen offset:1056   lds
v_mfma_f32_16x16x32_bf16 v[104:107], a[16:19], a[136:139], 0
MAA 104,20,152
v_mfma_f32_16x16x32_bf16 v[108:111], a[16:19], a[140:143], 0
MAA 108,20,156
v_mfma_f32_16x16x32_bf16 v[60:63], a[8:11], a[140:143], 0
buffer_load_dwordx4 v14, s[32:35], s54 offen offset:2112   lds
MAA 60,12,156
v_mfma_f32_16x16x32_bf16 v[56:59], a[8:11], a[136:139], 0
MAA 56,12,152
v_mfma_f32_16x16x32_bf16 v[40:43], a[0:3], a[136:139], 0
MAA 40,4,152
buffer_load_dwordx4 v15, s[32:35], s54 offen offset:3168   lds
v_mfma_f32_16x16x32_bf16 v[44:47], a[0:3], a[140:143], 0
MAA 44,4,156
s_waitcnt lgkmcnt(0)
s_barrier
v_mfma_f32_16x16x32_bf16 v[64:67], a[64:67], a[128:131], 0
TR 0,16,33792
s_add_u32 m0, s55, 101376
MAA 64,68,144
buffer_load_dwordx4 v12, s[80:83], s54 offen   lds
v_smfmac_f32_16x16x64_bf16 a[216:219], a[208:211], a[192:199], v6
TR 2,16,34304
s_mul_i32 s66, s13, 114688
v_smfmac_f32_16x16x64_bf16 a[216:219], a[208:211], a[200:207], v6
TR 4,16,42240
s_mul_i32 s65, s10, 1818624
v_mfma_f32_16x16x32_bf16 v[68:71], a[64:67], a[132:135], 0
TR 6,16,42752
s_add_u32 s66, s66, s65
MAA 68,68,148
TR 8,16,33824
s_add_u32 s66, s66, 12582912
v_mfma_f32_16x16x32_bf16 v[84:87], a[72:75], a[132:135], 0
buffer_load_dwordx4 v13, s[80:83], s54 offen offset:1056   lds
MAA 84,76,148
TR 10,16,34336
s_add_u32 s65, s66, 49152
v_mfma_f32_16x16x32_bf16 v[80:83], a[72:75], a[128:131], 0
TR 12,16,42272
s_lshl_b32 s62, s12, 16
MAA 80,76,144
TR 14,16,42784
s_add_u32 s62, s62, s66
v_mfma_f32_16x16x32_bf16 v[128:131], a[80:83], a[128:131], 0
TR 16,16,33856
s_add_u32 s63, s62, 16384
MAA 128,84,144
buffer_load_dwordx4 v14, s[80:83], s54 offen offset:2112   lds
v_mfma_f32_16x16x32_bf16 v[132:135], a[80:83], a[132:135], 0
TR 18,16,34368
s_add_u32 s64, s62, 32768
MAA 132,84,148
TR 20,16,42304
s_lshl_b32 s72, s10, 1
v_mfma_f32_16x16x32_bf16 v[148:151], a[88:91], a[132:135], 0
TR 22,16,42816
s_lshr_b32 s74, s11, 4
MAA 148,92,148
TR 24,16,33888
s_add_u32 s72, s72, s74
v_mfma_f32_16x16x32_bf16 v[144:147], a[88:91], a[128:131], 0
buffer_load_dwordx4 v15, s[80:83], s54 offen offset:3168   lds
MAA 144,92,144
TR 26,16,34400
s_add_u32 s54, s54, 458752
v_mfma_f32_16x16x32_bf16 v[192:195], a[96:99], a[128:131], 0
TR 28,16,42336
s_add_u32 m0, s57, 0
MAA 192,100,144
TR 30,16,42848
s_mov_b32 s58, 29622272
v_mfma_f32_16x16x32_bf16 v[196:199], a[96:99], a[132:135], 0
TR 32,16,33920
s_lshl_b32 s72, s72, 10
MAA 196,100,148
buffer_load_dwordx4 v4, s[16:19], s58 offen sc1 lds
v_mfma_f32_16x16x32_bf16 v[212:215], a[104:107], a[132:135], 0
TR 34,16,34432
s_add_u32 s72, s72, 30457856
MAA 212,108,148
TR 36,16,42368
s_and_b32 s73, s6, 14
v_mfma_f32_16x16x32_bf16 v[208:211], a[104:107], a[128:131], 0
TR 38,16,42880
s_and_b32 s74, s7, 1
MAA 208,108,144
TR 40,16,33952
s_add_u32 s73, s73, s74
v_mfma_f32_16x16x32_bf16 v[240:243], a[112:115], a[128:131], 0
buffer_load_dwordx4 v4, s[16:19], s58 offen offset:1024 sc1 lds
MAA 240,116,144
TR 42,16,34464
s_lshl_b32 s73, s73, 10
v_mfma_f32_16x16x32_bf16 v[244:247], a[112:115], a[132:135], 0
TR 44,16,42400
s_add_u32 s73, s73, 30457856
MAA 244,116,148
TR 46,16,42912
s_lshr_b32 s67, s5, 2
v_mfma_f32_16x16x32_bf16 v[252:255], a[120:123], a[132:135], 0
TR 48,17,33792
MAA 252,124,148
TR 50,17,34304
v_mfma_f32_16x16x32_bf16 v[248:251], a[120:123], a[128:131], 0
buffer_load_dwordx4 a[128:131], v10, s[16:19], s52 offen sc1
MAA 248,124,144
TR 52,17,42240
v_mfma_f32_16x16x32_bf16 v[220:223], a[104:107], a[140:143], 0
TR 54,17,42752
MAA 220,108,156
TR 56,17,33824
v_mfma_f32_16x16x32_bf16 v[216:219], a[104:107], a[136:139], 0
TR 58,17,34336
MAA 216,108,152
buffer_load_dwordx4 a[132:135], v10, s[16:19], s52 offen offset:1024 sc1
v_mfma_f32_16x16x32_bf16 v[200:203], a[96:99], a[136:139], 0
TR 60,17,42272
s_add_u32 s52, s52, 131072
MAA 200,100,152
TR 62,17,42784
v_mfma_f32_16x16x32_bf16 v[204:207], a[96:99], a[140:143], 0
RD 192,9,33792
MAA 204,100,156
RD 196,9,34848
v_mfma_f32_16x16x32_bf16 v[156:159], a[88:91], a[140:143], 0
buffer_load_dwordx4 a[144:147], v10, s[16:19], s52 offen sc1
MAA 156,92,156
RD 200,9,35904
v_mfma_f32_16x16x32_bf16 v[152:155], a[88:91], a[136:139], 0
RD 204,9,36960
MAA 152,92,152
v_mfma_f32_16x16x32_bf16 v[136:139], a[80:83], a[136:139], 0
MAA 136,84,152
buffer_load_dwordx4 a[148:151], v10, s[16:19], s52 offen offset:1024 sc1
v_mfma_f32_16x16x32_bf16 v[140:143], a[80:83], a[140:143], 0
s_add_u32 s52, s52, 131072
MAA 140,84,156
v_mfma_f32_16x16x32_bf16 v[92:95], a[72:75], a[140:143], 0
MAA 92,76,156
v_mfma_f32_16x16x32_bf16 v[88:91], a[72:75], a[136:139], 0
MAA 88,76,152
v_mfma_f32_16x16x32_bf16 v[72:75], a[64:67], a[136:139], 0
MAA 72,68,152
v_mfma_f32_16x16x32_bf16 v[76:79], a[64:67], a[140:143], 0
MAA 76,68,156
s_waitcnt vmcnt(18) lgkmcnt(0)
s_barrier
MAA 32,0,160
buffer_load_dwordx4 a[136:139], v11, s[16:19], s53 offen sc1
MAA 32,4,176
TR 64,16,50688
s_and_b32 s67, s67, 3
v_smfmac_f32_16x16x64_bf16 a[212:215], a[208:211], a[192:199], v6
TR 66,16,51200
s_lshl_b32 s67, s67, 7
v_smfmac_f32_16x16x64_bf16 a[212:215], a[208:211], a[200:207], v6
TR 68,16,59136
s_add_u32 s73, s73, s67
MAA 36,4,180
TR 70,16,59648
s_and_b32 s74, s7, 1
MAA 36,0,164
buffer_load_dwordx4 a[140:143], v11, s[16:19], s53 offen offset:1024 sc1
MAA 52,8,164
TR 72,16,50720
s_add_u32 s53, s53, 131072
MAA 52,12,180
TR 74,16,51232
s_mul_i32 s87, s74, 917504
MAA 48,12,176
TR 76,16,59168
s_lshr_b32 s75, s6, 1
MAA 48,8,160
TR 78,16,59680
s_mul_i32 s75, s75, 1818624
MAA 96,16,160
buffer_load_dwordx4 a[152:155], v11, s[16:19], s53 offen sc1
MAA 96,20,176
TR 80,16,50752
s_add_u32 s87, s87, s75
MAA 100,20,180
TR 82,16,51264
s_add_u32 s87, s87, 12582912
MAA 100,16,164
TR 84,16,59200
s_and_b32 s74, s6, 3
MAA 116,24,164
.Lpad13:
s_cbranch_execz .Lpad16
TR 86,16,59712
s_xor_b32 s75, s74, 0
MAA 116,28,180
buffer_load_dwordx4 a[156:159], v11, s[16:19], s53 offen offset:1024 sc1
MAA 112,28,176
TR 88,16,50784
s_add_u32 s53, s53, 131072
MAA 112,24,160
TR 90,16,51296
s_add_u32 m0, s55, 118272
MAA 160,32,160
TR 92,16,59232
s_sub_u32 s75, s75, 0
MAA 160,36,176
TR 94,16,59744
s_mul_i32 s98, s75, 458752
MAA 164,36,180
buffer_load_dwordx4 v12, s[32:35], s54 offen   lds
MAA 164,32,164
TR 96,16,50816
s_mul_i32 s75, s75, 114688
MAA 180,40,164
TR 98,16,51328
s_add_u32 s76, s87, s75
MAA 180,44,180
TR 100,16,59264
s_xor_b32 s75, s74, 1
MAA 176,44,176
TR 102,16,59776
s_sub_u32 s75, s75, 1
MAA 176,40,160
buffer_load_dwordx4 v13, s[32:35], s54 offen offset:1056   lds
MAA 224,48,160
TR 104,16,50848
s_mul_i32 s99, s75, 458752
MAA 224,52,176
TR 106,16,51360
s_mul_i32 s75, s75, 114688
MAA 228,52,180
TR 108,16,59296
s_add_u32 s77, s87, s75
MAA 228,48,164
TR 110,16,59808
MAA 236,56,164
buffer_load_dwordx4 v14, s[32:35], s54 offen offset:2112   lds
MAA 236,60,180
TR 112,17,50688
MAA 232,60,176
TR 114,17,51200
MAA 232,56,160
TR 116,17,59136
s_waitcnt vmcnt(21)
MAA 188,40,172
TR 118,17,59648
MAA 188,44,188
buffer_load_dwordx4 v15, s[32:35], s54 offen offset:3168   lds
MAA 184,44,184
TR 120,17,50720
s_add_u32 m0, s57, 2048
MAA 184,40,168
TR 122,17,51232
s_mov_b32 s58, 29624320
MAA 168,32,168
TR 124,17,59168
MAA 168,36,184
TR 126,17,59680
MAA 172,36,188
buffer_load_dwordx4 v4, s[16:19], s58 offen sc1 lds
MAA 172,32,172
RD 192,9,50688
MAA 124,24,172
RD 196,9,51744
MAA 124,28,188
RD 200,9,52800
MAA 120,28,184
RD 204,9,53856
MAA 120,24,168
buffer_load_dwordx4 v4, s[16:19], s58 offen offset:1024 sc1 lds
MAA 104,16,168
MAA 104,20,184
MAA 108,20,188
MAA 108,16,172
MAA 60,8,172
MAA 60,12,188
MAA 56,12,184
MAA 56,8,168
MAA 40,0,168
MAA 40,4,184
MAA 44,4,188
MAA 44,0,172
s_waitcnt vmcnt(20) lgkmcnt(0)
s_barrier
MAA 64,64,160
ds_read_b64_tr_b16 a[0:1], v16
s_add_u32 m0, s55, 135168
MAA 64,68,176
buffer_load_dwordx4 v12, s[80:83], s54 offen   lds
v_smfmac_f32_16x16x64_bf16 a[216:219], a[208:211], a[192:199], v6
TR 2,16,512
s_xor_b32 s75, s74, 2
v_smfmac_f32_16x16x64_bf16 a[216:219], a[208:211], a[200:207], v6
TR 4,16,8448
s_sub_u32 s75, s75, 2
MAA 68,68,180
TR 6,16,8960
s_mul_i32 s100, s75, 458752
MAA 68,64,164
TR 8,16,32
s_mul_i32 s75, s75, 114688
MAA 84,72,164
buffer_load_dwordx4 v13, s[80:83], s54 offen offset:1056   lds
MAA 84,76,180
TR 10,16,544
s_add_u32 s78, s87, s75
MAA 80,76,176
TR 12,16,8480
s_xor_b32 s75, s74, 3
MAA 80,72,160
TR 14,16,8992
s_sub_u32 s75, s75, 3
MAA 128,80,160
TR 16,16,64
s_mul_i32 s101, s75, 458752
MAA 128,84,176
buffer_load_dwordx4 v14, s[80:83], s54 offen offset:2112   lds
MAA 132,84,180
TR 18,16,576
s_mul_i32 s75, s75, 114688
MAA 132,80,164
TR 20,16,8512
s_add_u32 s79, s87, s75
MAA 148,88,164
TR 22,16,9024
s_and_b32 s87, s6, 3
MAA 148,92,180
TR 24,16,96
s_mov_b32 s46, 0
MAA 144,92,176
buffer_load_dwordx4 v15, s[80:83], s54 offen offset:3168   lds
MAA 144,88,160
TR 26,16,608
s_add_u32 s54, s54, 458752
MAA 192,96,160
TR 28,16,8544
s_add_u32 m0, s57, 4096
MAA 192,100,176
TR 30,16,9056
s_mov_b32 s58, 29626368
MAA 196,100,180
TR 32,16,128
s_lshl_b32 s74, s3, 10
MAA 196,96,164
buffer_load_dwordx4 v4, s[16:19], s58 offen sc1 lds
MAA 212,104,164
TR 34,16,640
s_lshl_b32 s75, s12, 9
MAA 212,108,180
TR 36,16,8576
s_add_u32 s74, s74, s75
MAA 208,108,176
TR 38,16,9088
s_add_u32 s74, s74, 152576
MAA 208,104,160
TR 40,16,160
v_and_b32 v18, 15, v1
MAA 240,112,160
buffer_load_dwordx4 v4, s[16:19], s58 offen offset:1024 sc1 lds
MAA 240,116,176
TR 42,16,672
v_lshl_add_u32 v18, v18, 4, s74
MAA 244,116,180
TR 44,16,8608
v_xor_b32 v19, 512, v18
MAA 244,112,164
TR 46,16,9120
MAA 252,120,164
ds_read_b64_tr_b16 a[48:49], v17
MAA 252,124,180
TR 50,17,512
MAA 248,124,176
TR 52,17,8448
MAA 248,120,160
buffer_load_dwordx4 a[160:163], v10, s[16:19], s52 offen sc1
MAA 220,104,172
TR 54,17,8960
MAA 220,108,188
TR 56,17,32
MAA 216,108,184
TR 58,17,544
MAA 216,104,168
TR 60,17,8480
MAA 200,96,168
buffer_load_dwordx4 a[164:167], v10, s[16:19], s52 offen offset:1024 sc1
MAA 200,100,184
TR 62,17,8992
s_add_u32 s52, s52, 131072
MAA 204,100,188
ds_read_b128 a[192:195], v9
MAA 204,96,172
RD 196,9,1056
MAA 156,88,172
RD 200,9,2112
MAA 156,92,188
buffer_load_dwordx4 a[176:179], v10, s[16:19], s52 offen sc1
MAA 152,92,184
RD 204,9,3168
MAA 152,88,168
MAA 136,80,168
MAA 136,84,184
MAA 140,84,188
buffer_load_dwordx4 a[180:183], v10, s[16:19], s52 offen offset:1024 sc1
MAA 140,80,172
s_add_u32 s52, s52, 131072
MAA 92,72,172
MAA 92,76,188
MAA 88,76,184
MAA 88,72,168
MAA 72,64,168
MAA 72,68,184
MAA 76,68,188
MAA 76,64,172
s_waitcnt vmcnt(20) lgkmcnt(0)
s_barrier
MAA 32,0,128
buffer_load_dwordx4 a[168:171], v11, s[16:19], s53 offen sc1
MAA 32,4,144
ds_read_b128 v[20:23], v2
v_smfmac_f32_16x16x64_bf16 a[212:215], a[208:211], a[192:199], v6
ds_read_b128 v[28:31], v2 offset:1024
v_smfmac_f32_16x16x64_bf16 a[212:215], a[208:211], a[200:207], v6
s_waitcnt vmcnt(11)
ds_read_b128 v[24:27], v2 offset:2048
MAA 36,4,148
TR 64,16,16896
MAA 36,0,132
buffer_load_dwordx4 a[172:175], v11, s[16:19], s53 offen offset:1024 sc1
MAA 52,8,132
TR 66,16,17408
s_add_u32 s53, s53, 131072
MAA 52,12,148
TR 68,16,25344
MAA 48,12,144
TR 70,16,25856
MAA 48,8,128
TR 72,16,16928
MAA 96,16,128
buffer_load_dwordx4 a[184:187], v11, s[16:19], s53 offen sc1
MAA 96,20,144
TR 74,16,17440
s_waitcnt lgkmcnt(7)
v_add_f32 v20, v20, v28
MAA 100,20,148
TR 76,16,25376
v_add_f32 v21, v21, v29
MAA 100,16,132
TR 78,16,25888
v_add_f32 v22, v22, v30
MAA 116,24,132
TR 80,16,16960
v_add_f32 v23, v23, v31
MAA 116,28,148
buffer_load_dwordx4 a[188:191], v11, s[16:19], s53 offen offset:1024 sc1
MAA 112,28,144
ds_read_b128 v[28:31], v2 offset:3072
s_add_u32 s53, s53, 131072
MAA 112,24,128
TR 82,16,17472
s_add_u32 m0, s55, 84480
MAA 160,32,128
TR 84,16,25408
s_waitcnt lgkmcnt(12)
v_add_f32 v20, v20, v24
MAA 160,36,144
TR 86,16,25920
v_add_f32 v21, v21, v25
MAA 164,36,148
buffer_load_dwordx4 v12, s[32:35], s54 offen   lds
MAA 164,32,132
TR 88,16,16992
v_add_f32 v22, v22, v26
MAA 180,40,132
TR 90,16,17504
v_add_f32 v23, v23, v27
MAA 180,44,148
TR 92,16,25440
MAA 176,44,144
TR 94,16,25952
MAA 176,40,128
buffer_load_dwordx4 v13, s[32:35], s54 offen offset:1056   lds
MAA 224,48,128
TR 96,16,17024
MAA 224,52,144
TR 98,16,17536
MAA 228,52,148
TR 100,16,25472
MAA 228,48,132
TR 102,16,25984
MAA 236,56,132
buffer_load_dwordx4 v14, s[32:35], s54 offen offset:2112   lds
MAA 236,60,148
TR 104,16,17056
MAA 232,60,144
TR 106,16,17568
MAA 232,56,128
TR 108,16,25504
MAA 188,40,140
TR 110,16,26016
MAA 188,44,156
buffer_load_dwordx4 v15, s[32:35], s54 offen offset:3168   lds
MAA 184,44,152
TR 112,17,16896
s_add_u32 m0, s57, 6144
MAA 184,40,136
TR 114,17,17408
s_mov_b32 s58, 29628416
MAA 168,32,136
TR 116,17,25344
MAA 168,36,152
TR 118,17,25856
MAA 172,36,156
buffer_load_dwordx4 v4, s[16:19], s58 offen sc1 lds
MAA 172,32,140
TR 120,17,16928
MAA 124,24,140
TR 122,17,17440
MAA 124,28,156
TR 124,17,25376
MAA 120,28,152
TR 126,17,25888
MAA 120,24,136
buffer_load_dwordx4 v4, s[16:19], s58 offen offset:1024 sc1 lds
MAA 104,16,136
RD 192,9,16896
MAA 104,20,152
RD 196,9,17952
MAA 108,20,156
RD 200,9,19008
MAA 108,16,140
RD 204,9,20064
MAA 60,8,140
MAA 60,12,156
MAA 56,12,152
MAA 56,8,136
MAA 40,0,136
MAA 40,4,152
MAA 44,4,156
s_sub_u32 s47, s47, 1
s_cbranch_scc1 .Lx39
.Lx39b:
MAA 44,0,140
s_waitcnt lgkmcnt(0)
s_barrier
MAA 64,64,128
s_waitcnt vmcnt(14)
ds_read_b128 v[24:27], v2 offset:4096
s_add_u32 m0, s55, 101376
MAA 64,68,144
buffer_load_dwordx4 v12, s[80:83], s54 offen   lds
v_smfmac_f32_16x16x64_bf16 a[216:219], a[208:211], a[192:199], v6
TR 0,16,33792
v_add_f32 v20, v20, v28
v_smfmac_f32_16x16x64_bf16 a[216:219], a[208:211], a[200:207], v6
TR 2,16,34304
v_add_f32 v21, v21, v29
MAA 68,68,148
TR 4,16,42240
v_add_f32 v22, v22, v30
MAA 68,64,132
TR 6,16,42752
v_add_f32 v23, v23, v31
MAA 84,72,132
ds_read_b128 v[28:31], v2 offset:5120
MAA 84,76,148
TR 8,16,33824
MAA 80,76,144
buffer_load_dwordx4 v13, s[80:83], s54 offen offset:1056   lds
MAA 80,72,128
TR 10,16,34336
s_waitcnt lgkmcnt(7)
v_add_f32 v20, v20, v24
MAA 128,80,128
TR 12,16,42272
v_add_f32 v21, v21, v25
MAA 128,84,144
TR 14,16,42784
v_add_f32 v22, v22, v26
MAA 132,84,148
TR 16,16,33856
v_add_f32 v23, v23, v27
MAA 132,80,132
TR 18,16,34368
MAA 148,88,132
TR 20,16,42304
MAA 148,92,148
buffer_load_dwordx4 v14, s[80:83], s54 offen offset:2112   lds
MAA 144,92,144
TR 22,16,42816
MAA 144,88,128
TR 24,16,33888
MAA 192,96,128
TR 26,16,34400
MAA 192,100,144
TR 28,16,42336
MAA 196,100,148
TR 30,16,42848
MAA 196,96,132
TR 32,16,33920
MAA 212,104,132
buffer_load_dwordx4 v15, s[80:83], s54 offen offset:3168   lds
MAA 212,108,148
TR 34,16,34432
s_add_u32 s54, s54, 458752
MAA 208,108,144
TR 36,16,42368
MAA 208,104,128
TR 38,16,42880
MAA 240,112,128
TR 40,16,33952
MAA 240,116,144
TR 42,16,34464
MAA 244,116,148
TR 44,16,42400
MAA 244,112,132
TR 46,16,42912
MAA 252,120,132
TR 48,17,33792
MAA 252,124,148
TR 50,17,34304
MAA 248,124,144
TR 52,17,42240
MAA 248,120,128
buffer_load_dwordx4 a[128:131], v10, s[16:19], s52 offen sc1
MAA 220,104,140
TR 54,17,42752
MAA 220,108,156
TR 56,17,33824
MAA 216,108,152
TR 58,17,34336
MAA 216,104,136
TR 60,17,42272
MAA 200,96,136
TR 62,17,42784
MAA 200,100,152
RD 192,9,33792
MAA 204,100,156
buffer_load_dwordx4 a[132:135], v10, s[16:19], s52 offen offset:1024 sc1
MAA 204,96,140
RD 196,9,34848
s_add_u32 s52, s52, 131072
MAA 156,88,140
RD 200,9,35904
MAA 156,92,156
RD 204,9,36960
MAA 152,92,152
MAA 152,88,136
MAA 136,80,136
MAA 136,84,152
buffer_load_dwordx4 a[144:147], v10, s[16:19], s52 offen sc1
MAA 140,84,156
MAA 140,80,140
MAA 92,72,140
MAA 92,76,156
MAA 88,76,152
MAA 88,72,136
MAA 72,64,136
buffer_load_dwordx4 a[148:151], v10, s[16:19], s52 offen offset:1024 sc1
MAA 72,68,152
s_add_u32 s52, s52, 131072
MAA 76,68,156
s_sub_u32 s47, s47, 1
s_cbranch_scc1 .Lx40
.Lx40b:
MAA 76,64,140
s_waitcnt vmcnt(18) lgkmcnt(0)
s_barrier
MAA 32,0,160
buffer_load_dwordx4 a[136:139], v11, s[16:19], s53 offen sc1
MAA 32,4,176
s_waitcnt vmcnt(9)
ds_read_b128 v[24:27], v2 offset:6144
v_add_f32 v20, v20, v28
v_smfmac_f32_16x16x64_bf16 a[212:215], a[208:211], a[192:199], v6
TR 64,16,50688
v_add_f32 v21, v21, v29
v_smfmac_f32_16x16x64_bf16 a[212:215], a[208:211], a[200:207], v6
TR 66,16,51200
v_add_f32 v22, v22, v30
MAA 36,4,180
TR 68,16,59136
v_add_f32 v23, v23, v31
MAA 36,0,164
ds_read_b128 v[28:31], v2 offset:7168
MAA 52,8,164
TR 70,16,59648
MAA 52,12,180
buffer_load_dwordx4 a[140:143], v11, s[16:19], s53 offen offset:1024 sc1
MAA 48,12,176
TR 72,16,50720
s_add_u32 s53, s53, 131072
MAA 48,8,160
TR 74,16,51232
s_waitcnt lgkmcnt(7)
v_add_f32 v20, v20, v24
MAA 96,16,160
TR 76,16,59168
v_add_f32 v21, v21, v25
MAA 96,20,176
TR 78,16,59680
v_add_f32 v22, v22, v26
MAA 100,20,180
TR 80,16,50752
v_add_f32 v23, v23, v27
MAA 100,16,164
TR 82,16,51264
s_waitcnt lgkmcnt(7)
v_add_f32 v20, v20, v28
MAA 116,24,164
buffer_load_dwordx4 a[152:155], v11, s[16:19], s53 offen sc1
MAA 116,28,180
TR 84,16,59200
v_add_f32 v21, v21, v29
MAA 112,28,176
TR 86,16,59712
v_add_f32 v22, v22, v30
MAA 112,24,160
TR 88,16,50784
v_add_f32 v23, v23, v31
MAA 160,32,160
TR 90,16,51296
MAA 160,36,176
TR 92,16,59232
MAA 164,36,180
TR 94,16,59744
MAA 164,32,164
buffer_load_dwordx4 a[156:159], v11, s[16:19], s53 offen offset:1024 sc1
MAA 180,40,164
TR 96,16,50816
s_add_u32 s53, s53, 131072
MAA 180,44,180
TR 98,16,51328
s_add_u32 m0, s55, 118272
MAA 176,44,176
TR 100,16,59264
MAA 176,40,160
TR 102,16,59776
MAA 224,48,160
TR 104,16,50848
.Lpad14:
s_cbranch_execz .Lnopoll34r
MAA 224,52,176
TR 106,16,51360
MAA 228,52,180
buffer_load_dwordx4 v12, s[32:35], s54 offen   lds
MAA 228,48,164
TR 108,16,59296
MAA 236,56,164
TR 110,16,59808
MAA 236,60,180
TR 112,17,50688
MAA 232,60,176
TR 114,17,51200
MAA 232,56,160
TR 116,17,59136
MAA 188,40,172
TR 118,17,59648
MAA 188,44,188
buffer_load_dwordx4 v13, s[32:35], s54 offen offset:1056   lds
MAA 184,44,184
TR 120,17,50720
MAA 184,40,168
TR 122,17,51232
MAA 168,32,168
TR 124,17,59168
MAA 168,36,184
TR 126,17,59680
MAA 172,36,188
RD 192,9,50688
MAA 172,32,172
RD 196,9,51744
MAA 124,24,172
buffer_load_dwordx4 v14, s[32:35], s54 offen offset:2112   lds
MAA 124,28,188
RD 200,9,52800
MAA 120,28,184
RD 204,9,53856
MAA 120,24,168
MAA 104,16,168
MAA 104,20,184
MAA 108,20,188
MAA 108,16,172
buffer_load_dwordx4 v15, s[32:35], s54 offen offset:3168   lds
MAA 60,8,172
MAA 60,12,188
MAA 56,12,184
MAA 56,8,168
MAA 40,0,168
MAA 40,4,184
MAA 44,4,188
s_sub_u32 s47, s47, 1
s_cbranch_scc1 .Lx41
.Lx41b:
MAA 44,0,172
s_waitcnt lgkmcnt(0)
s_barrier
MAA 64,64,160
ds_read_b64_tr_b16 a[0:1], v16
s_add_u32 m0, s55, 135168
MAA 64,68,176
buffer_load_dwordx4 v12, s[80:83], s54 offen   lds
v_smfmac_f32_16x16x64_bf16 a[216:219], a[208:211], a[192:199], v6
TR 2,16,512
v_permlane32_swap_b32 v20, v22
v_smfmac_f32_16x16x64_bf16 a[216:219], a[208:211], a[200:207], v6
TR 4,16,8448
v_permlane32_swap_b32 v21, v23
MAA 68,68,180
TR 6,16,8960
v_add_f32 v20, v20, v22
MAA 68,64,164
TR 8,16,32
v_add_f32 v21, v21, v23
MAA 84,72,164
TR 10,16,544
v_mul_f32 v20, 0xba800000, v20
MAA 84,76,180
buffer_load_dwordx4 v13, s[80:83], s54 offen offset:1056   lds
MAA 80,76,176
TR 12,16,8480
v_mul_f32 v21, 0x3a800000, v21
MAA 80,72,160
TR 14,16,8992
v_fma_f32 v21, -v20, v20, v21
MAA 128,80,160
TR 16,16,64
v_max_f32 v21, 0, v21
MAA 128,84,176
TR 18,16,576
v_add_f32 v21, 0x3727c5ac, v21
MAA 132,84,180
TR 20,16,8512
v_rsq_f32 v22, v21
MAA 132,80,164
TR 22,16,9024
v_and_b32 v24, 31, v1
MAA 148,88,164
buffer_load_dwordx4 v14, s[80:83], s54 offen offset:2112   lds
MAA 148,92,180
TR 24,16,96
v_lshrrev_b32 v25, 5, v1
MAA 144,92,176
TR 26,16,608
v_lshl_add_u32 v24, v24, 1, v25
MAA 144,88,160
TR 28,16,8544
v_and_b32 v25, 0xc0, v0
MAA 192,96,160
TR 30,16,9056
v_add_u32 v24, v24, v25
MAA 192,100,176
TR 32,16,128
v_lshlrev_b32 v24, 4, v24
MAA 196,100,180
TR 34,16,640
v_add_u32 v24, 152576, v24
MAA 196,96,164
buffer_load_dwordx4 v15, s[80:83], s54 offen offset:3168   lds
MAA 212,104,164
TR 36,16,8576
s_add_u32 s54, s54, 458752
MAA 212,108,180
TR 38,16,9088
v_mul_f32 v22, 0xbfb8aa3b, v22
MAA 208,108,176
ds_write_b128 v24, v[20:23]
s_mov_b32 s58, s98
MAA 208,104,160
ds_read_b64 v[20:21], v18
s_mov_b32 s67, s59
MAA 240,112,160
ds_read_b64 v[22:23], v18 offset:256
MAA 240,116,176
ds_read_b64 v[24:25], v19
MAA 244,116,180
ds_read_b64 v[26:27], v19 offset:256
MAA 244,112,164
ds_read_b32 v28, v18 offset:8
MAA 252,120,164
ds_read_b32 v29, v18 offset:264
v_mov_b32 v18, v5
MAA 252,124,180
ds_read_b32 v30, v19 offset:8
MAA 248,124,176
ds_read_b32 v31, v19 offset:264
v_add_u32 v19, 992, v5
MAA 248,120,160
buffer_load_dwordx4 a[160:163], v10, s[16:19], s52 offen sc1
MAA 220,104,172
TR 40,16,160
MAA 220,108,188
TR 42,16,672
MAA 216,108,184
TR 44,16,8608
MAA 216,104,168
TR 46,16,9120
MAA 200,96,168
ds_read_b64_tr_b16 a[48:49], v17
MAA 200,100,184
TR 50,17,512
MAA 204,100,188
buffer_load_dwordx4 a[164:167], v10, s[16:19], s52 offen offset:1024 sc1
MAA 204,96,172
TR 52,17,8448
s_add_u32 s52, s52, 131072
MAA 156,88,172
TR 54,17,8960
MAA 156,92,188
TR 56,17,32
MAA 152,92,184
TR 58,17,544
MAA 152,88,168
TR 60,17,8480
MAA 136,80,168
TR 62,17,8992
MAA 136,84,184
buffer_load_dwordx4 a[176:179], v10, s[16:19], s52 offen sc1
MAA 140,84,188
ds_read_b128 a[192:195], v9
MAA 140,80,172
RD 196,9,1056
MAA 92,72,172
RD 200,9,2112
MAA 92,76,188
RD 204,9,3168
MAA 88,76,184
MAA 88,72,168
MAA 72,64,168
buffer_load_dwordx4 a[180:183], v10, s[16:19], s52 offen offset:1024 sc1
MAA 72,68,184
s_add_u32 s52, s52, 131072
MAA 76,68,188
s_sub_u32 s47, s47, 1
s_cbranch_scc1 .Lx42
.Lx42b:
MAA 76,64,172
s_mov_b32 s15, -5
.p2align 6
.Lk43:
s_waitcnt vmcnt(16) lgkmcnt(0)
s_barrier
MAA 32,0,128
TR 64,16,16896
MAA 32,4,144
buffer_load_dwordx4 a[168:171], v11, s[16:19], s53 offen sc1
v_smfmac_f32_16x16x64_bf16 a[212:215], a[208:211], a[192:199], v6
s_sub_u32 s47, s47, 1
s_cbranch_scc1 .Lx44
.Lx44b:
v_smfmac_f32_16x16x64_bf16 a[212:215], a[208:211], a[200:207], v6
TR 66,16,17408
MAA 36,4,148
TR 68,16,25344
MAA 36,0,132
TR 70,16,25856
MAA 52,8,132
TR 72,16,16928
MAA 52,12,148
buffer_load_dwordx4 a[172:175], v11, s[16:19], s53 offen offset:1024 sc1
MAA 48,12,144
TR 74,16,17440
s_add_u32 s53, s53, 131072
MAA 48,8,128
MAA 96,16,128
TR 76,16,25376
MAA 96,20,144
TR 78,16,25888
MAA 100,20,148
TR 80,16,16960
MAA 100,16,132
buffer_load_dwordx4 a[184:187], v11, s[16:19], s53 offen sc1
MAA 116,24,132
TR 82,16,17472
MAA 116,28,148
TR 84,16,25408
MAA 112,28,144
MAA 112,24,128
TR 86,16,25920
MAA 160,32,128
TR 88,16,16992
MAA 160,36,144
buffer_load_dwordx4 a[188:191], v11, s[16:19], s53 offen offset:1024 sc1
MAA 164,36,148
TR 90,16,17504
s_add_u32 s53, s53, 131072
MAA 164,32,132
TR 92,16,25440
MAA 180,40,132
TR 94,16,25952
MAA 180,44,148
MAA 176,44,144
TR 96,16,17024
s_add_u32 m0, s55, 84480
MAA 176,40,128
buffer_load_dwordx4 v12, s[32:35], s54 offen   lds
MAA 224,48,128
TR 98,16,17536
MAA 224,52,144
TR 100,16,25472
MAA 228,52,148
TR 102,16,25984
MAA 228,48,132
TR 104,16,17056
MAA 236,56,132
MAA 236,60,148
TR 106,16,17568
MAA 232,60,144
TR 108,16,25504
MAA 232,56,128
TR 110,16,26016
s_waitcnt vmcnt(17)
MAA 188,40,140
TR 112,17,16896
MAA 188,44,156
buffer_load_dwordx4 v13, s[32:35], s54 offen offset:1056   lds
MAA 184,44,152
TR 114,17,17408
MAA 184,40,136
MAA 168,32,136
TR 116,17,25344
MAA 168,36,152
buffer_load_dwordx4 v14, s[32:35], s54 offen offset:2112   lds
MAA 172,36,156
TR 118,17,25856
MAA 172,32,140
TR 120,17,16928
MAA 124,24,140
TR 122,17,17440
MAA 124,28,156
TR 124,17,25376
MAA 120,28,152
MAA 120,24,136
buffer_load_dwordx4 v15, s[32:35], s54 offen offset:3168   lds
MAA 104,16,136
TR 126,17,25888
MAA 104,20,152
RD 192,9,16896
MAA 108,20,156
RD 196,9,17952
MAA 108,16,140
RD 200,9,19008
MAA 60,8,140
RD 204,9,20064
s_mov_b32 m0, s67
MAA 60,12,156
buffer_load_dwordx4 v18, s[28:31], s58 offen lds
MAA 56,12,152
MAA 56,8,136
MAA 40,0,136
MAA 40,4,152
MAA 44,4,156
MAA 44,0,140
s_waitcnt vmcnt(17) lgkmcnt(0)
s_barrier
MAA 64,64,128
TR 0,16,33792
s_add_u32 m0, s55, 101376
MAA 64,68,144
buffer_load_dwordx4 v12, s[80:83], s54 offen   lds
v_smfmac_f32_16x16x64_bf16 a[216:219], a[208:211], a[192:199], v6
s_sub_u32 s47, s47, 1
s_cbranch_scc1 .Lx45
.Lx45b:
v_smfmac_f32_16x16x64_bf16 a[216:219], a[208:211], a[200:207], v6
TR 2,16,34304
MAA 68,68,148
TR 4,16,42240
MAA 68,64,132
TR 6,16,42752
MAA 84,72,132
TR 8,16,33824
MAA 84,76,148
buffer_load_dwordx4 v13, s[80:83], s54 offen offset:1056   lds
MAA 80,76,144
TR 10,16,34336
MAA 80,72,128
MAA 128,80,128
TR 12,16,42272
MAA 128,84,144
TR 14,16,42784
MAA 132,84,148
TR 16,16,33856
MAA 132,80,132
buffer_load_dwordx4 v14, s[80:83], s54 offen offset:2112   lds
MAA 148,88,132
TR 18,16,34368
MAA 148,92,148
TR 20,16,42304
MAA 144,92,144
TR 22,16,42816
MAA 144,88,128
MAA 192,96,128
TR 24,16,33888
MAA 192,100,144
buffer_load_dwordx4 v15, s[80:83], s54 offen offset:3168   lds
MAA 196,100,148
TR 26,16,34400
s_add_u32 s54, s54, 458752
MAA 196,96,132
TR 28,16,42336
MAA 212,104,132
TR 30,16,42848
MAA 212,108,148
TR 32,16,33920
MAA 208,108,144
TR 34,16,34432
s_mov_b32 m0, s67
MAA 208,104,128
buffer_load_dwordx4 v19, s[28:31], s58 offen offset:1056 lds
MAA 240,112,128
s_add_u32 s67, s67, 8448
s_add_u32 s58, s58, 0x40000
MAA 240,116,144
MAA 244,116,148
TR 36,16,42368
MAA 244,112,132
TR 38,16,42880
MAA 252,120,132
TR 40,16,33952
MAA 252,124,148
TR 42,16,34464
MAA 248,124,144
TR 44,16,42400
MAA 248,120,128
buffer_load_dwordx4 a[128:131], v10, s[16:19], s52 offen sc1
MAA 220,104,140
TR 46,16,42912
MAA 220,108,156
MAA 216,108,152
TR 48,17,33792
MAA 216,104,136
TR 50,17,34304
MAA 200,96,136
TR 52,17,42240
MAA 200,100,152
buffer_load_dwordx4 a[132:135], v10, s[16:19], s52 offen offset:1024 sc1
MAA 204,100,156
TR 54,17,42752
s_add_u32 s52, s52, 131072
MAA 204,96,140
TR 56,17,33824
MAA 156,88,140
TR 58,17,34336
MAA 156,92,156
MAA 152,92,152
TR 60,17,42272
MAA 152,88,136
buffer_load_dwordx4 a[144:147], v10, s[16:19], s52 offen sc1
MAA 136,80,136
TR 62,17,42784
MAA 136,84,152
RD 192,9,33792
MAA 140,84,156
RD 196,9,34848
MAA 140,80,140
RD 200,9,35904
MAA 92,72,140
RD 204,9,36960
MAA 92,76,156
buffer_load_dwordx4 a[148:151], v10, s[16:19], s52 offen offset:1024 sc1
MAA 88,76,152
s_add_u32 s52, s52, 131072
MAA 88,72,136
MAA 72,64,136
MAA 72,68,152
MAA 76,68,156
MAA 76,64,140
s_waitcnt vmcnt(18) lgkmcnt(0)
s_barrier
MAA 32,0,160
TR 64,16,50688
MAA 32,4,176
buffer_load_dwordx4 a[136:139], v11, s[16:19], s53 offen sc1
v_smfmac_f32_16x16x64_bf16 a[212:215], a[208:211], a[192:199], v6
s_sub_u32 s47, s47, 1
s_cbranch_scc1 .Lx46
.Lx46b:
v_smfmac_f32_16x16x64_bf16 a[212:215], a[208:211], a[200:207], v6
TR 66,16,51200
MAA 36,4,180
TR 68,16,59136
MAA 36,0,164
TR 70,16,59648
MAA 52,8,164
TR 72,16,50720
MAA 52,12,180
buffer_load_dwordx4 a[140:143], v11, s[16:19], s53 offen offset:1024 sc1
MAA 48,12,176
TR 74,16,51232
s_add_u32 s53, s53, 131072
MAA 48,8,160
MAA 96,16,160
TR 76,16,59168
MAA 96,20,176
TR 78,16,59680
MAA 100,20,180
TR 80,16,50752
MAA 100,16,164
buffer_load_dwordx4 a[152:155], v11, s[16:19], s53 offen sc1
MAA 116,24,164
TR 82,16,51264
MAA 116,28,180
TR 84,16,59200
MAA 112,28,176
MAA 112,24,160
TR 86,16,59712
MAA 160,32,160
TR 88,16,50784
MAA 160,36,176
buffer_load_dwordx4 a[156:159], v11, s[16:19], s53 offen offset:1024 sc1
MAA 164,36,180
TR 90,16,51296
s_add_u32 s53, s53, 131072
MAA 164,32,164
TR 92,16,59232
MAA 180,40,164
TR 94,16,59744
MAA 180,44,180
MAA 176,44,176
TR 96,16,50816
s_add_u32 m0, s55, 118272
MAA 176,40,160
buffer_load_dwordx4 v12, s[32:35], s54 offen   lds
MAA 224,48,160
TR 98,16,51328
MAA 224,52,176
TR 100,16,59264
MAA 228,52,180
TR 102,16,59776
MAA 228,48,164
TR 104,16,50848
MAA 236,56,164
MAA 236,60,180
TR 106,16,51360
MAA 232,60,176
TR 108,16,59296
MAA 232,56,160
TR 110,16,59808
s_waitcnt vmcnt(19)
MAA 188,40,172
TR 112,17,50688
MAA 188,44,188
buffer_load_dwordx4 v13, s[32:35], s54 offen offset:1056   lds
MAA 184,44,184
TR 114,17,51200
MAA 184,40,168
MAA 168,32,168
TR 116,17,59136
MAA 168,36,184
buffer_load_dwordx4 v14, s[32:35], s54 offen offset:2112   lds
MAA 172,36,188
TR 118,17,59648
MAA 172,32,172
TR 120,17,50720
MAA 124,24,172
TR 122,17,51232
MAA 124,28,188
TR 124,17,59168
MAA 120,28,184
MAA 120,24,168
buffer_load_dwordx4 v15, s[32:35], s54 offen offset:3168   lds
MAA 104,16,168
TR 126,17,59680
MAA 104,20,184
RD 192,9,50688
MAA 108,20,188
RD 196,9,51744
MAA 108,16,172
RD 200,9,52800
MAA 60,8,172
.Lpad15:
s_cbranch_execz .Lnopoll34r
RD 204,9,53856
s_mov_b32 m0, s67
MAA 60,12,188
buffer_load_dwordx4 v18, s[28:31], s58 offen lds
MAA 56,12,184
MAA 56,8,168
MAA 40,0,168
MAA 40,4,184
MAA 44,4,188
MAA 44,0,172
s_waitcnt vmcnt(19) lgkmcnt(0)
s_barrier
MAA 64,64,160
ds_read_b64_tr_b16 a[0:1], v16
s_add_u32 m0, s55, 135168
MAA 64,68,176
buffer_load_dwordx4 v12, s[80:83], s54 offen   lds
v_smfmac_f32_16x16x64_bf16 a[216:219], a[208:211], a[192:199], v6
s_sub_u32 s47, s47, 1
s_cbranch_scc1 .Lx47
.Lx47b:
v_smfmac_f32_16x16x64_bf16 a[216:219], a[208:211], a[200:207], v6
TR 2,16,512
MAA 68,68,180
TR 4,16,8448
MAA 68,64,164
TR 6,16,8960
MAA 84,72,164
TR 8,16,32
MAA 84,76,180
buffer_load_dwordx4 v13, s[80:83], s54 offen offset:1056   lds
MAA 80,76,176
TR 10,16,544
MAA 80,72,160
MAA 128,80,160
TR 12,16,8480
MAA 128,84,176
TR 14,16,8992
MAA 132,84,180
TR 16,16,64
MAA 132,80,164
buffer_load_dwordx4 v14, s[80:83], s54 offen offset:2112   lds
MAA 148,88,164
TR 18,16,576
MAA 148,92,180
TR 20,16,8512
MAA 144,92,176
TR 22,16,9024
MAA 144,88,160
MAA 192,96,160
TR 24,16,96
MAA 192,100,176
buffer_load_dwordx4 v15, s[80:83], s54 offen offset:3168   lds
MAA 196,100,180
TR 26,16,608
s_add_u32 s54, s54, 458752
MAA 196,96,164
TR 28,16,8544
MAA 212,104,164
TR 30,16,9056
MAA 212,108,180
TR 32,16,128
MAA 208,108,176
TR 34,16,640
s_mov_b32 m0, s67
MAA 208,104,160
buffer_load_dwordx4 v19, s[28:31], s58 offen offset:1056 lds
MAA 240,112,160
s_add_u32 s67, s67, 8448
s_add_u32 s46, s46, 1
s_xor_b32 s58, s46, s87
s_mul_i32 s58, s58, 458752
MAA 240,116,176
MAA 244,116,180
TR 36,16,8576
MAA 244,112,164
TR 38,16,9088
MAA 252,120,164
TR 40,16,160
MAA 252,124,180
TR 42,16,672
MAA 248,124,176
TR 44,16,8608
MAA 248,120,160
buffer_load_dwordx4 a[160:163], v10, s[16:19], s52 offen sc1
MAA 220,104,172
TR 46,16,9120
MAA 220,108,188
MAA 216,108,184
ds_read_b64_tr_b16 a[48:49], v17
MAA 216,104,168
TR 50,17,512
MAA 200,96,168
TR 52,17,8448
MAA 200,100,184
buffer_load_dwordx4 a[164:167], v10, s[16:19], s52 offen offset:1024 sc1
MAA 204,100,188
TR 54,17,8960
s_add_u32 s52, s52, 131072
MAA 204,96,172
TR 56,17,32
MAA 156,88,172
TR 58,17,544
MAA 156,92,188
MAA 152,92,184
TR 60,17,8480
MAA 152,88,168
buffer_load_dwordx4 a[176:179], v10, s[16:19], s52 offen sc1
MAA 136,80,168
TR 62,17,8992
MAA 136,84,184
ds_read_b128 a[192:195], v9
MAA 140,84,188
RD 196,9,1056
MAA 140,80,172
RD 200,9,2112
MAA 92,72,172
RD 204,9,3168
MAA 92,76,188
buffer_load_dwordx4 a[180:183], v10, s[16:19], s52 offen offset:1024 sc1
MAA 88,76,184
s_add_u32 s52, s52, 131072
MAA 88,72,168
MAA 72,64,168
MAA 72,68,184
MAA 76,68,188
s_add_u32 s15, s15, 1
MAA 76,64,172
s_cbranch_scc0 .Lk43
s_branch .Lj48
.Lx39:
buffer_load_dword a220, v8, s[40:43], s45 offen
buffer_load_dword a220, v7, s[28:31], s44 offen
s_add_u32 s44, s44, 655360
s_add_u32 s45, s45, 917504
s_mov_b32 s47, 3
s_branch .Lx39b
.Lx40:
buffer_load_dword a220, v8, s[40:43], s45 offen
buffer_load_dword a220, v7, s[28:31], s44 offen
s_add_u32 s44, s44, 655360
s_add_u32 s45, s45, 917504
s_mov_b32 s47, 3
s_branch .Lx40b
.Lx41:
buffer_load_dword a220, v8, s[40:43], s45 offen
buffer_load_dword a220, v7, s[28:31], s44 offen
s_add_u32 s44, s44, 655360
s_add_u32 s45, s45, 917504
s_mov_b32 s47, 3
s_branch .Lx41b
.Lx42:
buffer_load_dword a220, v8, s[40:43], s45 offen
buffer_load_dword a220, v7, s[28:31], s44 offen
s_add_u32 s44, s44, 655360
s_add_u32 s45, s45, 917504
s_mov_b32 s47, 3
s_branch .Lx42b
.Lx44:
buffer_load_dword a220, v8, s[40:43], s45 offen
buffer_load_dword a220, v7, s[28:31], s44 offen
s_add_u32 s44, s44, 655360
s_add_u32 s45, s45, 917504
s_mov_b32 s47, 3
s_branch .Lx44b
.Lx45:
buffer_load_dword a220, v8, s[40:43], s45 offen
buffer_load_dword a220, v7, s[28:31], s44 offen
s_add_u32 s44, s44, 655360
s_add_u32 s45, s45, 917504
s_mov_b32 s47, 3
s_branch .Lx45b
.Lx46:
buffer_load_dword a220, v8, s[40:43], s45 offen
buffer_load_dword a220, v7, s[28:31], s44 offen
s_add_u32 s44, s44, 655360
s_add_u32 s45, s45, 917504
s_mov_b32 s47, 3
s_branch .Lx46b
.Lx47:
buffer_load_dword a220, v8, s[40:43], s45 offen
buffer_load_dword a220, v7, s[28:31], s44 offen
s_add_u32 s44, s44, 655360
s_add_u32 s45, s45, 917504
s_mov_b32 s47, 3
s_branch .Lx47b
.Lj48:
s_waitcnt vmcnt(10) lgkmcnt(0)
s_barrier
v_smfmac_f32_16x16x64_bf16 a[212:215], a[208:211], a[192:199], v6
RD 112,9,16896
s_lshl_b32 s74, s3, 10
v_smfmac_f32_16x16x64_bf16 a[212:215], a[208:211], a[200:207], v6
RD 116,9,17952
s_add_u32 s74, s74, 152576
MAA 32,0,128
RD 120,9,19008
s_sub_u32 s75, 156672, s74
MAA 32,4,144
RD 124,9,20064
v_and_b32 v7, 15, v1
MAA 48,12,144
RD 192,9,33792
v_lshl_add_u32 v7, v7, 5, s74
MAA 48,8,128
RD 196,9,34848
v_bfe_u32 v2, v1, 4, 1
MAA 36,0,132
RD 200,9,35904
v_lshl_add_u32 v7, v2, 4, v7
MAA 36,4,148
RD 204,9,36960
v_bfe_u32 v2, v1, 5, 1
MAA 52,12,148
buffer_load_dwordx4 a[168:171], v11, s[16:19], s53 offen sc1
MAA 52,8,132
TR 64,16,16896
v_mul_u32_u24 v2, s75, v2
s_waitcnt lgkmcnt(7)
v_smfmac_f32_16x16x64_bf16 a[216:219], a[208:211], a[112:119], v6
TR 66,16,17408
v_add_u32 v7, v7, v2
MAA 40,0,136
TR 68,16,25344
v_lshlrev_b32 v2, 4, v1
s_waitcnt lgkmcnt(7)
v_smfmac_f32_16x16x64_bf16 a[216:219], a[208:211], a[120:127], v6
buffer_load_dwordx4 a[172:175], v11, s[16:19], s53 offen offset:1024 sc1
MAA 40,4,152
TR 70,16,25856
s_add_u32 s53, s53, 131072
s_waitcnt lgkmcnt(6)
v_smfmac_f32_16x16x64_bf16 a[212:215], a[208:211], a[192:199], v6
TR 72,16,16928
v_add_u32 v2, 152576, v2
MAA 56,12,152
TR 74,16,17440
s_lshl_b32 s74, s12, 7
s_waitcnt lgkmcnt(6)
v_smfmac_f32_16x16x64_bf16 a[212:215], a[208:211], a[200:207], v6
buffer_load_dwordx4 a[184:187], v11, s[16:19], s53 offen sc1
MAA 56,8,136
TR 76,16,25376
s_add_u32 s74, s74, 161536
MAA 44,0,140
TR 78,16,25888
s_waitcnt vmcnt(8)
s_barrier
MAA 44,4,156
RD 112,9,50688
s_xor_b32 s75, s12, 1
MAA 60,12,156
RD 116,9,51744
s_mul_i32 s75, s75, 384
MAA 60,8,140
RD 120,9,52800
s_add_u32 s75, s75, 161536
MAA 96,16,128
RD 124,9,53856
v_lshrrev_b32 v9, 4, v1
MAA 96,20,144
ds_write_b128 v7, a[212:215]
v_lshlrev_b32 v9, 4, v9
MAA 112,28,144
buffer_load_dwordx4 a[188:191], v11, s[16:19], s53 offen offset:1024 sc1
MAA 112,24,128
TR 80,16,33792
s_add_u32 s53, s53, 131072
MAA 100,16,132
TR 82,16,34304
v_add_u32 v8, s75, v9
MAA 100,20,148
TR 84,16,42240
v_add_u32 v9, s74, v9
MAA 116,28,148
TR 86,16,42752
s_add_u32 s58, s99, 2293760
s_waitcnt lgkmcnt(7)
v_smfmac_f32_16x16x64_bf16 a[216:219], a[208:211], a[112:119], v6
TR 88,16,33824
s_lshl_b32 s74, s3, 11
MAA 116,24,132
TR 90,16,34336
s_add_u32 s74, s74, s84
s_waitcnt lgkmcnt(7)
v_smfmac_f32_16x16x64_bf16 a[216:219], a[208:211], a[120:127], v6
TR 92,16,42272
s_add_u32 s54, s98, 65536
MAA 104,16,136
TR 94,16,42784
s_mul_i32 s55, s3, 2112
MAA 104,20,152
TR 96,16,50688
s_mov_b32 s57, 67584
MAA 120,28,152
ds_write_b128 v7, a[216:219] offset:512
MAA 120,24,136
TR 98,16,51200
MAA 108,16,140
TR 100,16,59136
MAA 108,20,156
TR 102,16,59648
MAA 124,28,156
TR 104,16,50720
MAA 124,24,140
TR 106,16,51232
MAA 160,32,128
TR 108,16,59168
MAA 160,36,144
TR 110,16,59680
MAA 176,44,144
s_waitcnt lgkmcnt(7)
s_barrier
ds_read_b128 v[12:15], v2
MAA 176,40,128
ds_read_b128 v[4:7], v2 offset:1024
MAA 164,32,132
TR 192,16,16960
MAA 164,36,148
TR 194,16,17472
MAA 180,44,148
TR 196,16,25408
MAA 180,40,132
TR 198,16,25920
MAA 168,32,136
TR 200,16,16992
MAA 168,36,152
TR 202,16,17504
MAA 184,44,152
TR 204,16,25440
MAA 184,40,136
TR 206,16,25952
s_waitcnt lgkmcnt(8)
v_add_f32 v12, v12, v4
MAA 172,32,140
TR 112,16,33856
v_add_f32 v13, v13, v5
MAA 172,36,156
TR 114,16,34368
v_add_f32 v14, v14, v6
MAA 188,44,156
TR 116,16,42304
v_add_f32 v15, v15, v7
MAA 188,40,140
ds_read_b128 v[4:7], v2 offset:2048
MAA 224,48,128
TR 118,16,42816
MAA 224,52,144
TR 120,16,33888
MAA 232,60,144
TR 122,16,34400
MAA 232,56,128
TR 124,16,42336
MAA 228,48,132
TR 126,16,42848
MAA 228,52,148
TR 0,16,50752
MAA 236,60,148
TR 2,16,51264
MAA 236,56,132
TR 4,16,59200
s_waitcnt lgkmcnt(8)
v_add_f32 v12, v12, v4
MAA 64,64,128
TR 6,16,59712
v_add_f32 v13, v13, v5
MAA 64,68,144
TR 8,16,50784
v_add_f32 v14, v14, v6
s_waitcnt vmcnt(7)
MAA 64,96,160
TR 10,16,51296
v_add_f32 v15, v15, v7
s_waitcnt vmcnt(5)
MAA 64,100,176
ds_read_b128 v[4:7], v2 offset:3072
MAA 80,108,176
TR 12,16,59232
MAA 80,104,160
TR 14,16,59744
MAA 80,76,144
TR 16,16,17024
MAA 80,72,128
TR 18,16,17536
MAA 32,80,160
TR 20,16,25472
MAA 32,84,176
TR 22,16,25984
MAA 48,92,176
TR 24,16,17056
MAA 48,88,160
TR 26,16,17568
s_waitcnt lgkmcnt(8)
v_add_f32 v12, v12, v4
v_add_f32 v13, v13, v5
v_add_f32 v14, v14, v6
v_add_f32 v15, v15, v7
ds_write_b128 v2, v[12:15] offset:8960
ds_read_b128 v[12:15], v9
ds_read_b128 v[4:7], v9 offset:64
v_lshrrev_b32 v2, 3, v1
v_cmp_eq_u32 vcc, 3, v2
TR 28,16,25504
TR 30,16,26016
TR 32,16,33920
TR 34,16,34432
TR 36,16,42368
TR 38,16,42880
TR 40,16,33952
TR 42,16,34464
TR 44,16,42400
TR 46,16,42912
TR 48,16,50816
TR 50,16,51328
TR 52,16,59264
s_waitcnt lgkmcnt(14)
v_pk_fma_f32 v[32:33], v[12:13], v[20:21], v[32:33] op_sel_hi:[1,0,1]
v_pk_fma_f32 v[34:35], v[14:15], v[20:21], v[34:35] op_sel_hi:[1,0,1]
v_pk_fma_f32 v[36:37], v[12:13], v[22:23], v[36:37] op_sel_hi:[1,0,1]
v_pk_fma_f32 v[38:39], v[14:15], v[22:23], v[38:39] op_sel_hi:[1,0,1]
v_pk_fma_f32 v[40:41], v[12:13], v[24:25], v[40:41] op_sel_hi:[1,0,1]
v_pk_fma_f32 v[42:43], v[14:15], v[24:25], v[42:43] op_sel_hi:[1,0,1]
v_pk_fma_f32 v[44:45], v[12:13], v[26:27], v[44:45] op_sel_hi:[1,0,1]
v_pk_fma_f32 v[46:47], v[14:15], v[26:27], v[46:47] op_sel_hi:[1,0,1]
ds_read_b128 v[12:15], v9 offset:512
s_waitcnt lgkmcnt(14)
v_pk_fma_f32 v[48:49], v[4:5], v[20:21], v[48:49] op_sel_hi:[1,0,1]
v_pk_fma_f32 v[50:51], v[6:7], v[20:21], v[50:51] op_sel_hi:[1,0,1]
v_pk_fma_f32 v[52:53], v[4:5], v[22:23], v[52:53] op_sel_hi:[1,0,1]
v_pk_fma_f32 v[54:55], v[6:7], v[22:23], v[54:55] op_sel_hi:[1,0,1]
v_pk_fma_f32 v[56:57], v[4:5], v[24:25], v[56:57] op_sel_hi:[1,0,1]
v_pk_fma_f32 v[58:59], v[6:7], v[24:25], v[58:59] op_sel_hi:[1,0,1]
v_pk_fma_f32 v[60:61], v[4:5], v[26:27], v[60:61] op_sel_hi:[1,0,1]
v_pk_fma_f32 v[62:63], v[6:7], v[26:27], v[62:63] op_sel_hi:[1,0,1]
ds_read_b128 v[4:7], v9 offset:576
TR 54,16,59776
TR 56,16,50848
TR 58,16,51360
TR 60,16,59296
TR 62,16,59808
s_waitcnt lgkmcnt(6)
v_pk_fma_f32 v[64:65], v[12:13], v[20:21], v[64:65] op_sel_hi:[1,0,1]
v_pk_fma_f32 v[66:67], v[14:15], v[20:21], v[66:67] op_sel_hi:[1,0,1]
v_pk_fma_f32 v[68:69], v[12:13], v[22:23], v[68:69] op_sel_hi:[1,0,1]
v_pk_fma_f32 v[70:71], v[14:15], v[22:23], v[70:71] op_sel_hi:[1,0,1]
v_pk_fma_f32 v[72:73], v[12:13], v[24:25], v[72:73] op_sel_hi:[1,0,1]
v_pk_fma_f32 v[74:75], v[14:15], v[24:25], v[74:75] op_sel_hi:[1,0,1]
v_pk_fma_f32 v[76:77], v[12:13], v[26:27], v[76:77] op_sel_hi:[1,0,1]
v_pk_fma_f32 v[78:79], v[14:15], v[26:27], v[78:79] op_sel_hi:[1,0,1]
ds_read_b128 v[12:15], v9 offset:832
s_waitcnt lgkmcnt(6)
v_pk_fma_f32 v[80:81], v[4:5], v[20:21], v[80:81] op_sel_hi:[1,0,1]
v_pk_fma_f32 v[82:83], v[6:7], v[20:21], v[82:83] op_sel_hi:[1,0,1]
v_pk_fma_f32 v[84:85], v[4:5], v[22:23], v[84:85] op_sel_hi:[1,0,1]
v_pk_fma_f32 v[86:87], v[6:7], v[22:23], v[86:87] op_sel_hi:[1,0,1]
v_pk_fma_f32 v[88:89], v[4:5], v[24:25], v[88:89] op_sel_hi:[1,0,1]
v_pk_fma_f32 v[90:91], v[6:7], v[24:25], v[90:91] op_sel_hi:[1,0,1]
v_pk_fma_f32 v[92:93], v[4:5], v[26:27], v[92:93] op_sel_hi:[1,0,1]
v_pk_fma_f32 v[94:95], v[6:7], v[26:27], v[94:95] op_sel_hi:[1,0,1]
ds_read_b128 v[4:7], v9 offset:704
v_pk_mul_f32 v[64:65], v[64:65], v[32:33]
v_pk_mul_f32 v[32:33], v[32:33], v[28:29] op_sel_hi:[1,0]
v_pk_mul_f32 v[66:67], v[66:67], v[34:35]
v_pk_mul_f32 v[34:35], v[34:35], v[28:29] op_sel_hi:[1,0]
v_pk_mul_f32 v[80:81], v[80:81], v[48:49]
v_pk_mul_f32 v[48:49], v[48:49], v[28:29] op_sel_hi:[1,0]
v_pk_mul_f32 v[82:83], v[82:83], v[50:51]
v_pk_mul_f32 v[50:51], v[50:51], v[28:29] op_sel_hi:[1,0]
v_exp_f32 v32, v32
v_exp_f32 v33, v33
MAA 68,64,132
v_exp_f32 v34, v34
MAA 68,68,148
v_exp_f32 v35, v35
MAA 68,96,164
v_exp_f32 v48, v48
s_waitcnt vmcnt(4)
MAA 68,100,180
v_exp_f32 v49, v49
MAA 84,108,180
v_exp_f32 v50, v50
MAA 84,104,164
v_exp_f32 v51, v51
MAA 84,76,148
MAA 84,72,132
MAA 36,80,164
MAA 36,84,180
MAA 52,92,180
MAA 52,88,164
s_nop 5
v_pk_mul_f32 v[68:69], v[68:69], v[36:37]
v_pk_fma_f32 v[32:33], v[32:33], v[20:21], v[20:21] op_sel:[0,1,1] op_sel_hi:[1,1,1]
v_pk_fma_f32 v[34:35], v[34:35], v[20:21], v[20:21] op_sel:[0,1,1] op_sel_hi:[1,1,1]
v_pk_fma_f32 v[48:49], v[48:49], v[20:21], v[20:21] op_sel:[0,1,1] op_sel_hi:[1,1,1]
v_pk_fma_f32 v[50:51], v[50:51], v[20:21], v[20:21] op_sel:[0,1,1] op_sel_hi:[1,1,1]
v_rcp_f32 v32, v32
v_pk_mul_f32 v[36:37], v[36:37], v[28:29] op_sel:[0,1] op_sel_hi:[1,1]
v_pk_mul_f32 v[70:71], v[70:71], v[38:39]
v_pk_mul_f32 v[38:39], v[38:39], v[28:29] op_sel:[0,1] op_sel_hi:[1,1]
v_pk_mul_f32 v[84:85], v[84:85], v[52:53]
v_pk_mul_f32 v[52:53], v[52:53], v[28:29] op_sel:[0,1] op_sel_hi:[1,1]
v_pk_mul_f32 v[86:87], v[86:87], v[54:55]
v_pk_mul_f32 v[54:55], v[54:55], v[28:29] op_sel:[0,1] op_sel_hi:[1,1]
v_rcp_f32 v33, v33
v_rcp_f32 v34, v34
MAA 72,64,136
v_rcp_f32 v35, v35
MAA 72,68,152
v_rcp_f32 v48, v48
s_waitcnt vmcnt(3)
MAA 72,96,168
v_rcp_f32 v49, v49
s_waitcnt vmcnt(1)
MAA 72,100,184
v_rcp_f32 v50, v50
MAA 88,108,184
v_rcp_f32 v51, v51
MAA 88,104,168
v_exp_f32 v36, v36
MAA 88,76,152
v_exp_f32 v37, v37
MAA 88,72,136
v_exp_f32 v38, v38
MAA 40,80,168
v_exp_f32 v39, v39
MAA 40,84,184
v_exp_f32 v52, v52
MAA 56,92,184
v_exp_f32 v53, v53
MAA 56,88,168
v_exp_f32 v54, v54
v_exp_f32 v55, v55
v_pk_mul_f32 v[64:65], v[64:65], v[32:33]
v_pk_mul_f32 v[66:67], v[66:67], v[34:35]
v_pk_mul_f32 v[80:81], v[80:81], v[48:49]
v_pk_mul_f32 v[82:83], v[82:83], v[50:51]
ds_read_b128 v[48:51], v9 offset:128
v_pk_mul_f32 v[72:73], v[72:73], v[40:41]
v_pk_mul_f32 v[40:41], v[40:41], v[30:31] op_sel_hi:[1,0]
v_pk_mul_f32 v[74:75], v[74:75], v[42:43]
v_pk_mul_f32 v[42:43], v[42:43], v[30:31] op_sel_hi:[1,0]
v_pk_mul_f32 v[88:89], v[88:89], v[56:57]
v_pk_mul_f32 v[56:57], v[56:57], v[30:31] op_sel_hi:[1,0]
v_pk_mul_f32 v[90:91], v[90:91], v[58:59]
v_pk_mul_f32 v[58:59], v[58:59], v[30:31] op_sel_hi:[1,0]
v_pk_fma_f32 v[36:37], v[36:37], v[22:23], v[22:23] op_sel:[0,1,1] op_sel_hi:[1,1,1]
v_pk_fma_f32 v[38:39], v[38:39], v[22:23], v[22:23] op_sel:[0,1,1] op_sel_hi:[1,1,1]
v_pk_fma_f32 v[52:53], v[52:53], v[22:23], v[22:23] op_sel:[0,1,1] op_sel_hi:[1,1,1]
v_pk_fma_f32 v[54:55], v[54:55], v[22:23], v[22:23] op_sel:[0,1,1] op_sel_hi:[1,1,1]
v_cvt_pk_bf16_f32 v32, v64, v65
v_cvt_pk_bf16_f32 v33, v66, v67
ds_read_b128 v[64:67], v9 offset:192
v_cvt_pk_bf16_f32 v34, v80, v81
v_cvt_pk_bf16_f32 v35, v82, v83
MAA 76,64,140
buffer_store_dwordx4 v[32:35], v10, s[16:19], s62 offen sc1
MAA 76,68,156
ds_read_b128 v[80:83], v9 offset:640
v_rcp_f32 v36, v36
MAA 76,96,172
TR 64,17,16896
v_rcp_f32 v37, v37
s_waitcnt vmcnt(1)
MAA 76,100,188
TR 66,17,17408
v_rcp_f32 v38, v38
MAA 92,108,188
TR 68,17,25344
v_rcp_f32 v39, v39
MAA 92,104,172
TR 70,17,25856
v_rcp_f32 v52, v52
MAA 92,76,156
TR 76,17,25376
v_rcp_f32 v53, v53
MAA 92,72,140
TR 72,17,16928
.Lpad16:
s_cbranch_execz .Lnopoll34r
v_rcp_f32 v54, v54
MAA 44,80,172
TR 74,17,17440
v_rcp_f32 v55, v55
MAA 44,84,188
TR 78,17,25888
v_exp_f32 v40, v40
MAA 60,92,188
TR 80,17,33792
v_exp_f32 v41, v41
MAA 60,88,172
TR 82,17,34304
v_exp_f32 v42, v42
v_exp_f32 v43, v43
v_exp_f32 v56, v56
v_exp_f32 v57, v57
v_exp_f32 v58, v58
v_exp_f32 v59, v59
v_pk_mul_f32 v[68:69], v[68:69], v[36:37]
v_pk_mul_f32 v[70:71], v[70:71], v[38:39]
v_pk_mul_f32 v[84:85], v[84:85], v[52:53]
v_pk_mul_f32 v[86:87], v[86:87], v[54:55]
ds_read_b128 v[52:55], v8 offset:576
v_pk_mul_f32 v[76:77], v[76:77], v[44:45]
v_pk_mul_f32 v[44:45], v[44:45], v[30:31] op_sel:[0,1] op_sel_hi:[1,1]
v_pk_mul_f32 v[78:79], v[78:79], v[46:47]
v_pk_mul_f32 v[46:47], v[46:47], v[30:31] op_sel:[0,1] op_sel_hi:[1,1]
v_pk_mul_f32 v[92:93], v[92:93], v[60:61]
v_pk_mul_f32 v[60:61], v[60:61], v[30:31] op_sel:[0,1] op_sel_hi:[1,1]
v_pk_mul_f32 v[94:95], v[94:95], v[62:63]
v_pk_mul_f32 v[62:63], v[62:63], v[30:31] op_sel:[0,1] op_sel_hi:[1,1]
v_pk_fma_f32 v[40:41], v[40:41], v[24:25], v[24:25] op_sel:[0,1,1] op_sel_hi:[1,1,1]
v_pk_fma_f32 v[42:43], v[42:43], v[24:25], v[24:25] op_sel:[0,1,1] op_sel_hi:[1,1,1]
v_pk_fma_f32 v[56:57], v[56:57], v[24:25], v[24:25] op_sel:[0,1,1] op_sel_hi:[1,1,1]
v_pk_fma_f32 v[58:59], v[58:59], v[24:25], v[24:25] op_sel:[0,1,1] op_sel_hi:[1,1,1]
v_cvt_pk_bf16_f32 v36, v68, v69
v_cvt_pk_bf16_f32 v37, v70, v71
v_cvt_pk_bf16_f32 v38, v84, v85
v_cvt_pk_bf16_f32 v39, v86, v87
MAA 128,192,128
buffer_store_dwordx4 v[36:39], v10, s[16:19], s62 offen offset:1024 sc1
MAA 128,196,144
TR 84,17,42240
v_rcp_f32 v40, v40
MAA 128,0,160
TR 86,17,42752
v_rcp_f32 v41, v41
MAA 128,4,176
TR 88,17,33824
v_rcp_f32 v42, v42
MAA 144,12,176
TR 90,17,34336
v_rcp_f32 v43, v43
MAA 144,8,160
TR 92,17,42272
v_rcp_f32 v56, v56
MAA 144,204,144
TR 94,17,42784
v_rcp_f32 v57, v57
MAA 144,200,128
TR 96,17,50688
v_rcp_f32 v58, v58
MAA 96,112,160
TR 98,17,51200
v_rcp_f32 v59, v59
MAA 96,116,176
TR 100,17,59136
v_exp_f32 v44, v44
MAA 112,124,176
TR 102,17,59648
v_exp_f32 v45, v45
MAA 112,120,160
TR 104,17,50720
v_lshrrev_b32 v69, 2, v0
v_min_u32 v69, 1, v69
v_lshlrev_b32 v69, 28, v69
v_lshl_add_u32 v68, v0, 7, v69
v_xor_b32 v69, 64, v0
v_min_u32 v69, 1, v69
v_lshlrev_b32 v70, 4, v69
v_sub_u32 v70, 16, v70
v_lshlrev_b32 v69, 28, v69
v_mov_b32 v71, 1
v_mov_b32 v84, 0
v_mov_b32 v85, 0
v_mov_b32 v86, 0
v_exp_f32 v46, v46
v_exp_f32 v47, v47
v_exp_f32 v60, v60
v_exp_f32 v61, v61
v_exp_f32 v62, v62
v_exp_f32 v63, v63
v_pk_mul_f32 v[72:73], v[72:73], v[40:41]
v_pk_mul_f32 v[74:75], v[74:75], v[42:43]
v_pk_mul_f32 v[88:89], v[88:89], v[56:57]
v_pk_mul_f32 v[90:91], v[90:91], v[58:59]
s_waitcnt lgkmcnt(15)
v_pk_fma_f32 v[96:97], v[48:49], v[20:21], v[96:97] op_sel_hi:[1,0,1]
v_pk_fma_f32 v[98:99], v[50:51], v[20:21], v[98:99] op_sel_hi:[1,0,1]
v_pk_fma_f32 v[112:113], v[64:65], v[20:21], v[112:113] op_sel_hi:[1,0,1]
v_pk_fma_f32 v[114:115], v[66:67], v[20:21], v[114:115] op_sel_hi:[1,0,1]
v_pk_fma_f32 v[128:129], v[80:81], v[20:21], v[128:129] op_sel_hi:[1,0,1]
v_pk_fma_f32 v[130:131], v[82:83], v[20:21], v[130:131] op_sel_hi:[1,0,1]
v_pk_fma_f32 v[144:145], v[4:5], v[20:21], v[144:145] op_sel_hi:[1,0,1]
v_pk_fma_f32 v[146:147], v[6:7], v[20:21], v[146:147] op_sel_hi:[1,0,1]
v_pk_mul_f32 v[128:129], v[128:129], v[96:97]
v_pk_mul_f32 v[96:97], v[96:97], v[28:29] op_sel_hi:[1,0]
v_pk_mul_f32 v[130:131], v[130:131], v[98:99]
v_pk_mul_f32 v[98:99], v[98:99], v[28:29] op_sel_hi:[1,0]
v_pk_mul_f32 v[144:145], v[144:145], v[112:113]
v_pk_mul_f32 v[112:113], v[112:113], v[28:29] op_sel_hi:[1,0]
v_pk_mul_f32 v[146:147], v[146:147], v[114:115]
v_pk_mul_f32 v[114:115], v[114:115], v[28:29] op_sel_hi:[1,0]
v_pk_fma_f32 v[44:45], v[44:45], v[26:27], v[26:27] op_sel:[0,1,1] op_sel_hi:[1,1,1]
v_pk_fma_f32 v[46:47], v[46:47], v[26:27], v[26:27] op_sel:[0,1,1] op_sel_hi:[1,1,1]
v_pk_fma_f32 v[60:61], v[60:61], v[26:27], v[26:27] op_sel:[0,1,1] op_sel_hi:[1,1,1]
v_pk_fma_f32 v[62:63], v[62:63], v[26:27], v[26:27] op_sel:[0,1,1] op_sel_hi:[1,1,1]
v_cvt_pk_bf16_f32 v40, v72, v73
v_cvt_pk_bf16_f32 v41, v74, v75
v_cvt_pk_bf16_f32 v42, v88, v89
v_cvt_pk_bf16_f32 v43, v90, v91
MAA 132,192,132
buffer_store_dwordx4 v[40:43], v11, s[16:19], s62 offen sc1
MAA 132,196,148
TR 106,17,51232
v_rcp_f32 v44, v44
MAA 132,0,164
TR 108,17,59168
v_rcp_f32 v45, v45
MAA 132,4,180
TR 110,17,59680
v_rcp_f32 v46, v46
MAA 148,12,180
v_rcp_f32 v47, v47
MAA 148,8,164
v_rcp_f32 v60, v60
MAA 148,204,148
v_rcp_f32 v61, v61
MAA 148,200,132
v_rcp_f32 v62, v62
MAA 100,112,164
v_rcp_f32 v63, v63
MAA 100,116,180
v_exp_f32 v96, v96
MAA 116,124,180
v_exp_f32 v97, v97
MAA 116,120,164
s_waitcnt lgkmcnt(0)
s_barrier
s_add_u32 m0, s59, 84480
v_exp_f32 v98, v98
v_exp_f32 v99, v99
v_exp_f32 v112, v112
v_exp_f32 v113, v113
v_exp_f32 v114, v114
v_exp_f32 v115, v115
v_pk_mul_f32 v[76:77], v[76:77], v[44:45]
v_pk_mul_f32 v[78:79], v[78:79], v[46:47]
v_pk_mul_f32 v[92:93], v[92:93], v[60:61]
v_pk_mul_f32 v[94:95], v[94:95], v[62:63]
v_pk_fma_f32 v[100:101], v[48:49], v[22:23], v[100:101] op_sel_hi:[1,0,1]
v_pk_fma_f32 v[102:103], v[50:51], v[22:23], v[102:103] op_sel_hi:[1,0,1]
v_pk_fma_f32 v[116:117], v[64:65], v[22:23], v[116:117] op_sel_hi:[1,0,1]
v_pk_fma_f32 v[118:119], v[66:67], v[22:23], v[118:119] op_sel_hi:[1,0,1]
v_pk_fma_f32 v[132:133], v[80:81], v[22:23], v[132:133] op_sel_hi:[1,0,1]
v_pk_fma_f32 v[134:135], v[82:83], v[22:23], v[134:135] op_sel_hi:[1,0,1]
v_pk_fma_f32 v[148:149], v[4:5], v[22:23], v[148:149] op_sel_hi:[1,0,1]
v_pk_fma_f32 v[150:151], v[6:7], v[22:23], v[150:151] op_sel_hi:[1,0,1]
v_pk_mul_f32 v[132:133], v[132:133], v[100:101]
v_pk_mul_f32 v[100:101], v[100:101], v[28:29] op_sel:[0,1] op_sel_hi:[1,1]
v_pk_mul_f32 v[134:135], v[134:135], v[102:103]
v_pk_mul_f32 v[102:103], v[102:103], v[28:29] op_sel:[0,1] op_sel_hi:[1,1]
v_pk_mul_f32 v[148:149], v[148:149], v[116:117]
v_pk_mul_f32 v[116:117], v[116:117], v[28:29] op_sel:[0,1] op_sel_hi:[1,1]
v_pk_mul_f32 v[150:151], v[150:151], v[118:119]
v_pk_mul_f32 v[118:119], v[118:119], v[28:29] op_sel:[0,1] op_sel_hi:[1,1]
v_pk_fma_f32 v[96:97], v[96:97], v[20:21], v[20:21] op_sel:[0,1,1] op_sel_hi:[1,1,1]
v_pk_fma_f32 v[98:99], v[98:99], v[20:21], v[20:21] op_sel:[0,1,1] op_sel_hi:[1,1,1]
v_pk_fma_f32 v[112:113], v[112:113], v[20:21], v[20:21] op_sel:[0,1,1] op_sel_hi:[1,1,1]
v_pk_fma_f32 v[114:115], v[114:115], v[20:21], v[20:21] op_sel:[0,1,1] op_sel_hi:[1,1,1]
v_cvt_pk_bf16_f32 v44, v76, v77
v_cvt_pk_bf16_f32 v45, v78, v79
v_cvt_pk_bf16_f32 v46, v92, v93
v_cvt_pk_bf16_f32 v47, v94, v95
MAA 136,192,136
buffer_store_dwordx4 v[44:47], v11, s[16:19], s62 offen offset:1024 sc1
MAA 136,196,152
v_rcp_f32 v96, v96
MAA 136,0,168
v_rcp_f32 v97, v97
MAA 136,4,184
v_rcp_f32 v98, v98
MAA 152,12,184
buffer_load_dwordx4 v18, s[28:31], s58 offen lds
MAA 152,8,168
v_rcp_f32 v99, v99
MAA 152,204,152
v_rcp_f32 v112, v112
MAA 152,200,136
v_rcp_f32 v113, v113
MAA 104,112,168
buffer_load_dwordx4 v19, s[28:31], s58 offen offset:1056 lds
MAA 104,116,184
s_add_u32 m0, s59, 92928
s_add_u32 s58, s99, 2555904
v_rcp_f32 v114, v114
MAA 120,124,184
v_rcp_f32 v115, v115
MAA 120,120,168
v_exp_f32 v100, v100
v_exp_f32 v101, v101
v_exp_f32 v102, v102
v_exp_f32 v103, v103
v_exp_f32 v116, v116
v_exp_f32 v117, v117
v_exp_f32 v118, v118
v_exp_f32 v119, v119
v_pk_mul_f32 v[128:129], v[128:129], v[96:97]
v_pk_mul_f32 v[130:131], v[130:131], v[98:99]
v_pk_mul_f32 v[144:145], v[144:145], v[112:113]
v_pk_mul_f32 v[146:147], v[146:147], v[114:115]
ds_read_b128 v[112:115], v9 offset:256
v_pk_fma_f32 v[104:105], v[48:49], v[24:25], v[104:105] op_sel_hi:[1,0,1]
v_pk_fma_f32 v[106:107], v[50:51], v[24:25], v[106:107] op_sel_hi:[1,0,1]
v_pk_fma_f32 v[120:121], v[64:65], v[24:25], v[120:121] op_sel_hi:[1,0,1]
v_pk_fma_f32 v[122:123], v[66:67], v[24:25], v[122:123] op_sel_hi:[1,0,1]
v_pk_fma_f32 v[136:137], v[80:81], v[24:25], v[136:137] op_sel_hi:[1,0,1]
v_pk_fma_f32 v[138:139], v[82:83], v[24:25], v[138:139] op_sel_hi:[1,0,1]
v_pk_fma_f32 v[152:153], v[4:5], v[24:25], v[152:153] op_sel_hi:[1,0,1]
v_pk_fma_f32 v[154:155], v[6:7], v[24:25], v[154:155] op_sel_hi:[1,0,1]
v_pk_mul_f32 v[136:137], v[136:137], v[104:105]
v_pk_mul_f32 v[104:105], v[104:105], v[30:31] op_sel_hi:[1,0]
v_pk_mul_f32 v[138:139], v[138:139], v[106:107]
v_pk_mul_f32 v[106:107], v[106:107], v[30:31] op_sel_hi:[1,0]
v_pk_mul_f32 v[152:153], v[152:153], v[120:121]
v_pk_mul_f32 v[120:121], v[120:121], v[30:31] op_sel_hi:[1,0]
v_pk_mul_f32 v[154:155], v[154:155], v[122:123]
v_pk_mul_f32 v[122:123], v[122:123], v[30:31] op_sel_hi:[1,0]
v_pk_fma_f32 v[100:101], v[100:101], v[22:23], v[22:23] op_sel:[0,1,1] op_sel_hi:[1,1,1]
v_pk_fma_f32 v[102:103], v[102:103], v[22:23], v[22:23] op_sel:[0,1,1] op_sel_hi:[1,1,1]
v_pk_fma_f32 v[116:117], v[116:117], v[22:23], v[22:23] op_sel:[0,1,1] op_sel_hi:[1,1,1]
v_pk_fma_f32 v[118:119], v[118:119], v[22:23], v[22:23] op_sel:[0,1,1] op_sel_hi:[1,1,1]
v_cvt_pk_bf16_f32 v96, v128, v129
v_cvt_pk_bf16_f32 v97, v130, v131
ds_read_b128 v[128:131], v9 offset:320
v_cvt_pk_bf16_f32 v98, v144, v145
v_cvt_pk_bf16_f32 v99, v146, v147
MAA 140,192,140
buffer_store_dwordx4 v[96:99], v10, s[16:19], s63 offen sc1
MAA 140,196,156
ds_read_b128 v[144:147], v9 offset:768
v_rcp_f32 v100, v100
MAA 140,0,172
v_rcp_f32 v101, v101
MAA 140,4,188
v_rcp_f32 v102, v102
MAA 156,12,188
buffer_load_dwordx4 v18, s[28:31], s58 offen lds
MAA 156,8,172
v_rcp_f32 v103, v103
MAA 156,204,156
v_rcp_f32 v116, v116
MAA 156,200,140
v_rcp_f32 v117, v117
MAA 108,112,172
buffer_load_dwordx4 v19, s[28:31], s58 offen offset:1056 lds
MAA 108,116,188
s_add_u32 m0, s59, 101376
s_add_u32 s58, s100, 2752512
v_rcp_f32 v118, v118
MAA 124,124,188
v_rcp_f32 v119, v119
MAA 124,120,172
v_exp_f32 v104, v104
v_exp_f32 v105, v105
v_exp_f32 v106, v106
v_exp_f32 v107, v107
v_exp_f32 v120, v120
v_exp_f32 v121, v121
v_exp_f32 v122, v122
v_exp_f32 v123, v123
v_pk_mul_f32 v[132:133], v[132:133], v[100:101]
v_pk_mul_f32 v[134:135], v[134:135], v[102:103]
v_pk_mul_f32 v[148:149], v[148:149], v[116:117]
v_pk_mul_f32 v[150:151], v[150:151], v[118:119]
v_pk_fma_f32 v[108:109], v[48:49], v[26:27], v[108:109] op_sel_hi:[1,0,1]
v_pk_fma_f32 v[110:111], v[50:51], v[26:27], v[110:111] op_sel_hi:[1,0,1]
v_pk_fma_f32 v[124:125], v[64:65], v[26:27], v[124:125] op_sel_hi:[1,0,1]
v_pk_fma_f32 v[126:127], v[66:67], v[26:27], v[126:127] op_sel_hi:[1,0,1]
v_pk_fma_f32 v[140:141], v[80:81], v[26:27], v[140:141] op_sel_hi:[1,0,1]
v_pk_fma_f32 v[142:143], v[82:83], v[26:27], v[142:143] op_sel_hi:[1,0,1]
v_pk_fma_f32 v[156:157], v[4:5], v[26:27], v[156:157] op_sel_hi:[1,0,1]
v_pk_fma_f32 v[158:159], v[6:7], v[26:27], v[158:159] op_sel_hi:[1,0,1]
v_pk_mul_f32 v[140:141], v[140:141], v[108:109]
v_pk_mul_f32 v[108:109], v[108:109], v[30:31] op_sel:[0,1] op_sel_hi:[1,1]
v_pk_mul_f32 v[142:143], v[142:143], v[110:111]
v_pk_mul_f32 v[110:111], v[110:111], v[30:31] op_sel:[0,1] op_sel_hi:[1,1]
v_pk_mul_f32 v[156:157], v[156:157], v[124:125]
s_waitcnt vmcnt(5)
s_barrier
buffer_atomic_add v71, v68, s[16:19], s72 offen offset:512
v_pk_mul_f32 v[124:125], v[124:125], v[30:31] op_sel:[0,1] op_sel_hi:[1,1]
v_pk_mul_f32 v[158:159], v[158:159], v[126:127]
v_pk_mul_f32 v[126:127], v[126:127], v[30:31] op_sel:[0,1] op_sel_hi:[1,1]
v_pk_fma_f32 v[104:105], v[104:105], v[24:25], v[24:25] op_sel:[0,1,1] op_sel_hi:[1,1,1]
v_pk_fma_f32 v[106:107], v[106:107], v[24:25], v[24:25] op_sel:[0,1,1] op_sel_hi:[1,1,1]
v_pk_fma_f32 v[120:121], v[120:121], v[24:25], v[24:25] op_sel:[0,1,1] op_sel_hi:[1,1,1]
v_pk_fma_f32 v[122:123], v[122:123], v[24:25], v[24:25] op_sel:[0,1,1] op_sel_hi:[1,1,1]
v_cvt_pk_bf16_f32 v100, v132, v133
v_cvt_pk_bf16_f32 v101, v134, v135
v_cvt_pk_bf16_f32 v102, v148, v149
v_cvt_pk_bf16_f32 v103, v150, v151
MAA 192,16,128
v_rcp_f32 v104, v104
MAA 192,20,144
buffer_store_dwordx4 v[100:103], v10, s[16:19], s63 offen offset:1024 sc1
MAA 192,48,160
v_rcp_f32 v105, v105
MAA 192,52,176
v_rcp_f32 v106, v106
MAA 208,60,176
v_rcp_f32 v107, v107
MAA 208,56,160
buffer_load_dwordx4 v18, s[28:31], s58 offen lds
MAA 208,28,144
v_rcp_f32 v120, v120
MAA 208,24,128
v_rcp_f32 v121, v121
MAA 160,32,160
v_rcp_f32 v122, v122
MAA 160,36,176
buffer_load_dwordx4 v19, s[28:31], s58 offen offset:1056 lds
MAA 176,44,176
s_add_u32 m0, s59, 109824
s_add_u32 s58, s100, 3014656
v_rcp_f32 v123, v123
MAA 176,40,160
v_exp_f32 v108, v108
v_exp_f32 v109, v109
v_exp_f32 v110, v110
v_exp_f32 v111, v111
v_exp_f32 v124, v124
v_exp_f32 v125, v125
v_exp_f32 v126, v126
v_exp_f32 v127, v127
v_pk_mul_f32 v[136:137], v[136:137], v[104:105]
v_pk_mul_f32 v[138:139], v[138:139], v[106:107]
v_pk_mul_f32 v[152:153], v[152:153], v[120:121]
v_pk_mul_f32 v[154:155], v[154:155], v[122:123]
s_waitcnt lgkmcnt(2)
v_pk_fma_f32 v[160:161], v[112:113], v[20:21], v[160:161] op_sel_hi:[1,0,1]
v_pk_fma_f32 v[162:163], v[114:115], v[20:21], v[162:163] op_sel_hi:[1,0,1]
s_waitcnt lgkmcnt(1)
v_pk_fma_f32 v[176:177], v[128:129], v[20:21], v[176:177] op_sel_hi:[1,0,1]
v_pk_fma_f32 v[178:179], v[130:131], v[20:21], v[178:179] op_sel_hi:[1,0,1]
s_waitcnt lgkmcnt(0)
v_pk_fma_f32 v[192:193], v[144:145], v[20:21], v[192:193] op_sel_hi:[1,0,1]
v_pk_fma_f32 v[194:195], v[146:147], v[20:21], v[194:195] op_sel_hi:[1,0,1]
v_pk_fma_f32 v[208:209], v[12:13], v[20:21], v[208:209] op_sel_hi:[1,0,1]
v_pk_fma_f32 v[210:211], v[14:15], v[20:21], v[210:211] op_sel_hi:[1,0,1]
v_pk_mul_f32 v[192:193], v[192:193], v[160:161]
v_pk_mul_f32 v[160:161], v[160:161], v[28:29] op_sel_hi:[1,0]
v_pk_mul_f32 v[194:195], v[194:195], v[162:163]
v_pk_mul_f32 v[162:163], v[162:163], v[28:29] op_sel_hi:[1,0]
v_pk_mul_f32 v[208:209], v[208:209], v[176:177]
v_pk_mul_f32 v[176:177], v[176:177], v[28:29] op_sel_hi:[1,0]
v_pk_mul_f32 v[210:211], v[210:211], v[178:179]
v_pk_mul_f32 v[178:179], v[178:179], v[28:29] op_sel_hi:[1,0]
v_pk_fma_f32 v[108:109], v[108:109], v[26:27], v[26:27] op_sel:[0,1,1] op_sel_hi:[1,1,1]
v_pk_fma_f32 v[110:111], v[110:111], v[26:27], v[26:27] op_sel:[0,1,1] op_sel_hi:[1,1,1]
v_pk_fma_f32 v[124:125], v[124:125], v[26:27], v[26:27] op_sel:[0,1,1] op_sel_hi:[1,1,1]
v_pk_fma_f32 v[126:127], v[126:127], v[26:27], v[26:27] op_sel:[0,1,1] op_sel_hi:[1,1,1]
v_cvt_pk_bf16_f32 v104, v136, v137
v_cvt_pk_bf16_f32 v105, v138, v139
v_cvt_pk_bf16_f32 v106, v152, v153
v_cvt_pk_bf16_f32 v107, v154, v155
MAA 196,16,132
buffer_store_dwordx4 v[104:107], v11, s[16:19], s63 offen sc1
MAA 196,20,148
v_rcp_f32 v108, v108
MAA 196,48,164
v_rcp_f32 v109, v109
MAA 196,52,180
v_rcp_f32 v110, v110
MAA 212,60,180
buffer_load_dwordx4 v18, s[28:31], s58 offen lds
MAA 212,56,164
v_rcp_f32 v111, v111
MAA 212,28,148
v_rcp_f32 v124, v124
MAA 212,24,132
v_rcp_f32 v125, v125
MAA 164,32,164
buffer_load_dwordx4 v19, s[28:31], s58 offen offset:1056 lds
MAA 164,36,180
s_add_u32 m0, s59, 118272
s_add_u32 s58, s101, 3211264
v_rcp_f32 v126, v126
MAA 180,44,180
v_rcp_f32 v127, v127
MAA 180,40,164
v_lshl_add_u32 v4, v1, 4, s74
v_add_u32 v2, 67108480, v4
v_cndmask_b32 v4, v4, v2, vcc
s_and_b32 s74, s7, 1
v_bfe_u32 v7, v1, 2, 3
v_mul_u32_u24 v7, 1056, v7
v_bfe_u32 v2, v1, 5, 1
v_lshl_add_u32 v7, v2, 8, v7
v_and_b32 v2, 3, v1
v_lshl_add_u32 v7, v2, 3, v7
s_lshl_b32 s74, s74, 7
s_xor_b32 s75, s74, 128
v_add_u32 v6, s75, v7
v_add_u32 v7, s74, v7
v_exp_f32 v160, v160
v_exp_f32 v161, v161
v_exp_f32 v162, v162
v_exp_f32 v163, v163
v_exp_f32 v176, v176
v_exp_f32 v177, v177
v_exp_f32 v178, v178
v_exp_f32 v179, v179
v_pk_mul_f32 v[140:141], v[140:141], v[108:109]
v_pk_mul_f32 v[142:143], v[142:143], v[110:111]
v_pk_mul_f32 v[156:157], v[156:157], v[124:125]
v_pk_mul_f32 v[158:159], v[158:159], v[126:127]
v_pk_fma_f32 v[164:165], v[112:113], v[22:23], v[164:165] op_sel_hi:[1,0,1]
v_pk_fma_f32 v[166:167], v[114:115], v[22:23], v[166:167] op_sel_hi:[1,0,1]
v_pk_fma_f32 v[180:181], v[128:129], v[22:23], v[180:181] op_sel_hi:[1,0,1]
v_pk_fma_f32 v[182:183], v[130:131], v[22:23], v[182:183] op_sel_hi:[1,0,1]
v_pk_fma_f32 v[196:197], v[144:145], v[22:23], v[196:197] op_sel_hi:[1,0,1]
v_pk_fma_f32 v[198:199], v[146:147], v[22:23], v[198:199] op_sel_hi:[1,0,1]
v_pk_fma_f32 v[212:213], v[12:13], v[22:23], v[212:213] op_sel_hi:[1,0,1]
v_pk_fma_f32 v[214:215], v[14:15], v[22:23], v[214:215] op_sel_hi:[1,0,1]
v_pk_mul_f32 v[196:197], v[196:197], v[164:165]
v_pk_mul_f32 v[164:165], v[164:165], v[28:29] op_sel:[0,1] op_sel_hi:[1,1]
v_pk_mul_f32 v[198:199], v[198:199], v[166:167]
v_pk_mul_f32 v[166:167], v[166:167], v[28:29] op_sel:[0,1] op_sel_hi:[1,1]
v_pk_mul_f32 v[212:213], v[212:213], v[180:181]
v_pk_mul_f32 v[180:181], v[180:181], v[28:29] op_sel:[0,1] op_sel_hi:[1,1]
v_pk_mul_f32 v[214:215], v[214:215], v[182:183]
v_pk_mul_f32 v[182:183], v[182:183], v[28:29] op_sel:[0,1] op_sel_hi:[1,1]
v_pk_fma_f32 v[160:161], v[160:161], v[20:21], v[20:21] op_sel:[0,1,1] op_sel_hi:[1,1,1]
v_pk_fma_f32 v[162:163], v[162:163], v[20:21], v[20:21] op_sel:[0,1,1] op_sel_hi:[1,1,1]
v_pk_fma_f32 v[176:177], v[176:177], v[20:21], v[20:21] op_sel:[0,1,1] op_sel_hi:[1,1,1]
v_pk_fma_f32 v[178:179], v[178:179], v[20:21], v[20:21] op_sel:[0,1,1] op_sel_hi:[1,1,1]
v_cvt_pk_bf16_f32 v108, v140, v141
v_cvt_pk_bf16_f32 v109, v142, v143
v_cvt_pk_bf16_f32 v110, v156, v157
v_cvt_pk_bf16_f32 v111, v158, v159
MAA 200,16,136
buffer_store_dwordx4 v[108:111], v11, s[16:19], s63 offen offset:1024 sc1
MAA 200,20,152
v_rcp_f32 v160, v160
MAA 200,48,168
v_rcp_f32 v161, v161
MAA 200,52,184
v_rcp_f32 v162, v162
MAA 216,60,184
buffer_load_dwordx4 v18, s[28:31], s58 offen lds
MAA 216,56,168
v_rcp_f32 v163, v163
MAA 216,28,152
v_rcp_f32 v176, v176
MAA 216,24,136
v_rcp_f32 v177, v177
MAA 168,32,168
buffer_load_dwordx4 v19, s[28:31], s58 offen offset:1056 lds
MAA 168,36,184
s_add_u32 m0, s59, 126720
s_add_u32 s58, s101, 3473408
v_rcp_f32 v178, v178
MAA 184,44,184
v_rcp_f32 v179, v179
MAA 184,40,168
v_exp_f32 v164, v164
v_exp_f32 v165, v165
v_exp_f32 v166, v166
v_exp_f32 v167, v167
v_exp_f32 v180, v180
v_exp_f32 v181, v181
v_exp_f32 v182, v182
v_exp_f32 v183, v183
v_pk_mul_f32 v[192:193], v[192:193], v[160:161]
v_pk_mul_f32 v[194:195], v[194:195], v[162:163]
v_pk_mul_f32 v[208:209], v[208:209], v[176:177]
v_pk_mul_f32 v[210:211], v[210:211], v[178:179]
ds_read_b128 v[176:179], v8
v_pk_fma_f32 v[168:169], v[112:113], v[24:25], v[168:169] op_sel_hi:[1,0,1]
v_pk_fma_f32 v[170:171], v[114:115], v[24:25], v[170:171] op_sel_hi:[1,0,1]
v_pk_fma_f32 v[184:185], v[128:129], v[24:25], v[184:185] op_sel_hi:[1,0,1]
v_pk_fma_f32 v[186:187], v[130:131], v[24:25], v[186:187] op_sel_hi:[1,0,1]
v_pk_fma_f32 v[200:201], v[144:145], v[24:25], v[200:201] op_sel_hi:[1,0,1]
v_pk_fma_f32 v[202:203], v[146:147], v[24:25], v[202:203] op_sel_hi:[1,0,1]
v_pk_fma_f32 v[216:217], v[12:13], v[24:25], v[216:217] op_sel_hi:[1,0,1]
v_pk_fma_f32 v[218:219], v[14:15], v[24:25], v[218:219] op_sel_hi:[1,0,1]
v_pk_mul_f32 v[200:201], v[200:201], v[168:169]
v_pk_mul_f32 v[168:169], v[168:169], v[30:31] op_sel_hi:[1,0]
v_pk_mul_f32 v[202:203], v[202:203], v[170:171]
v_pk_mul_f32 v[170:171], v[170:171], v[30:31] op_sel_hi:[1,0]
v_pk_mul_f32 v[216:217], v[216:217], v[184:185]
v_pk_mul_f32 v[184:185], v[184:185], v[30:31] op_sel_hi:[1,0]
v_pk_mul_f32 v[218:219], v[218:219], v[186:187]
v_pk_mul_f32 v[186:187], v[186:187], v[30:31] op_sel_hi:[1,0]
v_pk_fma_f32 v[164:165], v[164:165], v[22:23], v[22:23] op_sel:[0,1,1] op_sel_hi:[1,1,1]
v_pk_fma_f32 v[166:167], v[166:167], v[22:23], v[22:23] op_sel:[0,1,1] op_sel_hi:[1,1,1]
v_pk_fma_f32 v[180:181], v[180:181], v[22:23], v[22:23] op_sel:[0,1,1] op_sel_hi:[1,1,1]
v_pk_fma_f32 v[182:183], v[182:183], v[22:23], v[22:23] op_sel:[0,1,1] op_sel_hi:[1,1,1]
v_cvt_pk_bf16_f32 v160, v192, v193
v_cvt_pk_bf16_f32 v161, v194, v195
ds_read_b128 v[192:195], v8 offset:64
v_cvt_pk_bf16_f32 v162, v208, v209
v_cvt_pk_bf16_f32 v163, v210, v211
MAA 204,16,140
buffer_store_dwordx4 v[160:163], v10, s[16:19], s64 offen sc1
MAA 204,20,156
ds_read_b128 v[208:211], v8 offset:512
v_rcp_f32 v164, v164
MAA 204,48,172
v_rcp_f32 v165, v165
MAA 204,52,188
v_rcp_f32 v166, v166
MAA 220,60,188
buffer_atomic_add v84, v69, s[16:19], s73 offen offset:512 sc0
MAA 220,56,172
v_rcp_f32 v167, v167
MAA 220,28,156
v_rcp_f32 v180, v180
MAA 220,24,140
v_rcp_f32 v181, v181
MAA 172,32,172
buffer_load_dwordx4 v18, s[28:31], s58 offen lds
MAA 172,36,188
v_rcp_f32 v182, v182
MAA 188,44,188
v_rcp_f32 v183, v183
MAA 188,40,172
v_exp_f32 v168, v168
v_exp_f32 v169, v169
v_exp_f32 v170, v170
v_exp_f32 v171, v171
v_exp_f32 v184, v184
v_exp_f32 v185, v185
v_exp_f32 v186, v186
v_exp_f32 v187, v187
v_pk_mul_f32 v[196:197], v[196:197], v[164:165]
v_pk_mul_f32 v[198:199], v[198:199], v[166:167]
v_pk_mul_f32 v[212:213], v[212:213], v[180:181]
v_pk_mul_f32 v[214:215], v[214:215], v[182:183]
v_pk_fma_f32 v[172:173], v[112:113], v[26:27], v[172:173] op_sel_hi:[1,0,1]
v_pk_fma_f32 v[174:175], v[114:115], v[26:27], v[174:175] op_sel_hi:[1,0,1]
v_pk_fma_f32 v[188:189], v[128:129], v[26:27], v[188:189] op_sel_hi:[1,0,1]
v_pk_fma_f32 v[190:191], v[130:131], v[26:27], v[190:191] op_sel_hi:[1,0,1]
v_pk_fma_f32 v[204:205], v[144:145], v[26:27], v[204:205] op_sel_hi:[1,0,1]
v_pk_fma_f32 v[206:207], v[146:147], v[26:27], v[206:207] op_sel_hi:[1,0,1]
v_pk_fma_f32 v[220:221], v[12:13], v[26:27], v[220:221] op_sel_hi:[1,0,1]
v_pk_fma_f32 v[222:223], v[14:15], v[26:27], v[222:223] op_sel_hi:[1,0,1]
v_pk_mul_f32 v[204:205], v[204:205], v[172:173]
v_pk_mul_f32 v[172:173], v[172:173], v[30:31] op_sel:[0,1] op_sel_hi:[1,1]
v_pk_mul_f32 v[206:207], v[206:207], v[174:175]
v_pk_mul_f32 v[174:175], v[174:175], v[30:31] op_sel:[0,1] op_sel_hi:[1,1]
v_pk_mul_f32 v[220:221], v[220:221], v[188:189]
v_pk_mul_f32 v[188:189], v[188:189], v[30:31] op_sel:[0,1] op_sel_hi:[1,1]
v_pk_mul_f32 v[222:223], v[222:223], v[190:191]
v_pk_mul_f32 v[190:191], v[190:191], v[30:31] op_sel:[0,1] op_sel_hi:[1,1]
v_pk_fma_f32 v[168:169], v[168:169], v[24:25], v[24:25] op_sel:[0,1,1] op_sel_hi:[1,1,1]
v_pk_fma_f32 v[170:171], v[170:171], v[24:25], v[24:25] op_sel:[0,1,1] op_sel_hi:[1,1,1]
v_pk_fma_f32 v[184:185], v[184:185], v[24:25], v[24:25] op_sel:[0,1,1] op_sel_hi:[1,1,1]
v_pk_fma_f32 v[186:187], v[186:187], v[24:25], v[24:25] op_sel:[0,1,1] op_sel_hi:[1,1,1]
v_cvt_pk_bf16_f32 v164, v196, v197
v_cvt_pk_bf16_f32 v165, v198, v199
v_cvt_pk_bf16_f32 v166, v212, v213
v_cvt_pk_bf16_f32 v167, v214, v215
MAA 240,64,128
buffer_store_dwordx4 v[164:167], v10, s[16:19], s64 offen offset:1024 sc1
MAA 240,68,144
v_rcp_f32 v168, v168
MAA 240,96,160
v_rcp_f32 v169, v169
MAA 240,100,176
v_rcp_f32 v170, v170
MAA 248,108,176
buffer_atomic_add v85, v69, s[16:19], s73 offen offset:512 sc0
MAA 248,104,160
v_rcp_f32 v171, v171
MAA 248,76,144
v_rcp_f32 v184, v184
MAA 248,72,128
v_rcp_f32 v185, v185
MAA 224,80,160
buffer_load_dwordx4 v19, s[28:31], s58 offen offset:1056 lds
MAA 224,84,176
v_rcp_f32 v186, v186
MAA 232,92,176
v_rcp_f32 v187, v187
MAA 232,88,160
.Lpad17:
s_cbranch_execz .Lpad20
v_exp_f32 v172, v172
v_exp_f32 v173, v173
v_exp_f32 v174, v174
v_exp_f32 v175, v175
v_exp_f32 v188, v188
v_exp_f32 v189, v189
v_exp_f32 v190, v190
v_exp_f32 v191, v191
v_pk_mul_f32 v[200:201], v[200:201], v[168:169]
v_pk_mul_f32 v[202:203], v[202:203], v[170:171]
v_pk_mul_f32 v[216:217], v[216:217], v[184:185]
v_pk_mul_f32 v[218:219], v[218:219], v[186:187]
s_waitcnt lgkmcnt(2)
v_pk_fma_f32 v[224:225], v[176:177], v[20:21], v[224:225] op_sel_hi:[1,0,1]
v_pk_fma_f32 v[226:227], v[178:179], v[20:21], v[226:227] op_sel_hi:[1,0,1]
s_waitcnt lgkmcnt(1)
v_pk_fma_f32 v[232:233], v[192:193], v[20:21], v[232:233] op_sel_hi:[1,0,1]
v_pk_fma_f32 v[234:235], v[194:195], v[20:21], v[234:235] op_sel_hi:[1,0,1]
s_waitcnt lgkmcnt(0)
v_pk_fma_f32 v[240:241], v[208:209], v[20:21], v[240:241] op_sel_hi:[1,0,1]
v_pk_fma_f32 v[242:243], v[210:211], v[20:21], v[242:243] op_sel_hi:[1,0,1]
v_pk_fma_f32 v[248:249], v[52:53], v[20:21], v[248:249] op_sel_hi:[1,0,1]
v_pk_fma_f32 v[250:251], v[54:55], v[20:21], v[250:251] op_sel_hi:[1,0,1]
v_pk_mul_f32 v[240:241], v[240:241], v[224:225]
v_pk_mul_f32 v[224:225], v[224:225], v[28:29] op_sel_hi:[1,0]
v_pk_mul_f32 v[242:243], v[242:243], v[226:227]
v_pk_mul_f32 v[226:227], v[226:227], v[28:29] op_sel_hi:[1,0]
v_pk_mul_f32 v[248:249], v[248:249], v[232:233]
v_pk_mul_f32 v[232:233], v[232:233], v[28:29] op_sel_hi:[1,0]
v_pk_mul_f32 v[250:251], v[250:251], v[234:235]
v_pk_mul_f32 v[234:235], v[234:235], v[28:29] op_sel_hi:[1,0]
v_pk_fma_f32 v[172:173], v[172:173], v[26:27], v[26:27] op_sel:[0,1,1] op_sel_hi:[1,1,1]
v_pk_fma_f32 v[174:175], v[174:175], v[26:27], v[26:27] op_sel:[0,1,1] op_sel_hi:[1,1,1]
v_pk_fma_f32 v[188:189], v[188:189], v[26:27], v[26:27] op_sel:[0,1,1] op_sel_hi:[1,1,1]
v_pk_fma_f32 v[190:191], v[190:191], v[26:27], v[26:27] op_sel:[0,1,1] op_sel_hi:[1,1,1]
v_cvt_pk_bf16_f32 v168, v200, v201
v_cvt_pk_bf16_f32 v169, v202, v203
v_cvt_pk_bf16_f32 v170, v216, v217
v_cvt_pk_bf16_f32 v171, v218, v219
buffer_store_dwordx4 v[168:171], v11, s[16:19], s64 offen sc1
buffer_atomic_add v86, v69, s[16:19], s73 offen offset:512 sc0
s_waitcnt vmcnt(6)
v_cmp_gt_u32 vcc, v70, v84
s_nop 0
s_cbranch_vccz .Lok49
s_waitcnt vmcnt(3)
v_cmp_gt_u32 vcc, v70, v85
s_nop 0
s_cbranch_vccz .Lok49
s_waitcnt vmcnt(0)
v_cmp_gt_u32 vcc, v70, v86
s_nop 0
s_cbranch_vccz .Lok49
s_mov_b32 s15, 0
.Lok49l:
v_mov_b32 v84, 0
buffer_atomic_add v84, v69, s[16:19], s73 offen offset:512 sc0
s_add_u32 s15, s15, 1
s_cmp_gt_u32 s15, 100000
s_waitcnt vmcnt(0)
s_cbranch_scc1 .Lok49
v_cmp_gt_u32 vcc, v70, v84
s_nop 0
s_cbranch_vccnz .Lok49l
.Lok49:
s_waitcnt vmcnt(2)
s_barrier
MAA 244,64,132
ds_read_b64_tr_b16 a[0:1], v7
s_add_u32 s52, s76, 0
MAA 244,68,148
buffer_load_dwordx4 v[96:99], v4, s[16:19], s52 offen sc1
MAA 244,96,164
TR 2,7,512
v_rcp_f32 v172, v172
MAA 244,100,180
TR 4,7,32
v_rcp_f32 v173, v173
MAA 252,108,180
TR 6,7,544
v_rcp_f32 v174, v174
MAA 252,104,164
buffer_load_dwordx4 v[100:103], v4, s[16:19], s52 offen offset:1024 sc1
MAA 252,76,148
TR 8,7,64
s_add_u32 s52, s76, 65536
MAA 252,72,132
TR 10,7,576
v_rcp_f32 v175, v175
MAA 228,80,164
TR 12,7,96
v_rcp_f32 v188, v188
MAA 228,84,180
buffer_load_dwordx4 v[104:107], v4, s[16:19], s52 offen sc1
MAA 236,92,180
TR 14,7,608
v_rcp_f32 v189, v189
MAA 236,88,164
TR 16,7,8448
v_rcp_f32 v190, v190
v_rcp_f32 v191, v191
v_exp_f32 v224, v224
v_exp_f32 v225, v225
v_exp_f32 v226, v226
v_exp_f32 v227, v227
v_exp_f32 v232, v232
v_exp_f32 v233, v233
v_exp_f32 v234, v234
v_exp_f32 v235, v235
v_pk_mul_f32 v[204:205], v[204:205], v[172:173]
buffer_load_dwordx4 v[108:111], v4, s[16:19], s52 offen offset:1024 sc1
s_add_u32 s52, s77, 114688
v_pk_mul_f32 v[206:207], v[206:207], v[174:175]
v_pk_mul_f32 v[220:221], v[220:221], v[188:189]
v_pk_mul_f32 v[222:223], v[222:223], v[190:191]
v_pk_fma_f32 v[228:229], v[176:177], v[22:23], v[228:229] op_sel_hi:[1,0,1]
v_pk_fma_f32 v[230:231], v[178:179], v[22:23], v[230:231] op_sel_hi:[1,0,1]
v_pk_fma_f32 v[236:237], v[192:193], v[22:23], v[236:237] op_sel_hi:[1,0,1]
v_pk_fma_f32 v[238:239], v[194:195], v[22:23], v[238:239] op_sel_hi:[1,0,1]
v_pk_fma_f32 v[244:245], v[208:209], v[22:23], v[244:245] op_sel_hi:[1,0,1]
v_pk_fma_f32 v[246:247], v[210:211], v[22:23], v[246:247] op_sel_hi:[1,0,1]
v_pk_fma_f32 v[252:253], v[52:53], v[22:23], v[252:253] op_sel_hi:[1,0,1]
v_pk_fma_f32 v[254:255], v[54:55], v[22:23], v[254:255] op_sel_hi:[1,0,1]
v_pk_mul_f32 v[244:245], v[244:245], v[228:229]
buffer_load_dwordx4 v[112:115], v4, s[16:19], s52 offen sc1
v_pk_mul_f32 v[228:229], v[228:229], v[28:29] op_sel:[0,1] op_sel_hi:[1,1]
v_pk_mul_f32 v[246:247], v[246:247], v[230:231]
v_pk_mul_f32 v[230:231], v[230:231], v[28:29] op_sel:[0,1] op_sel_hi:[1,1]
v_pk_mul_f32 v[252:253], v[252:253], v[236:237]
v_pk_mul_f32 v[236:237], v[236:237], v[28:29] op_sel:[0,1] op_sel_hi:[1,1]
v_pk_mul_f32 v[254:255], v[254:255], v[238:239]
v_pk_mul_f32 v[238:239], v[238:239], v[28:29] op_sel:[0,1] op_sel_hi:[1,1]
v_pk_fma_f32 v[224:225], v[224:225], v[20:21], v[20:21] op_sel:[0,1,1] op_sel_hi:[1,1,1]
v_pk_fma_f32 v[226:227], v[226:227], v[20:21], v[20:21] op_sel:[0,1,1] op_sel_hi:[1,1,1]
v_pk_fma_f32 v[232:233], v[232:233], v[20:21], v[20:21] op_sel:[0,1,1] op_sel_hi:[1,1,1]
v_pk_fma_f32 v[234:235], v[234:235], v[20:21], v[20:21] op_sel:[0,1,1] op_sel_hi:[1,1,1]
v_cvt_pk_bf16_f32 v172, v204, v205
v_cvt_pk_bf16_f32 v173, v206, v207
buffer_load_dwordx4 v[116:119], v4, s[16:19], s52 offen offset:1024 sc1
s_add_u32 s52, s77, 180224
v_cvt_pk_bf16_f32 v174, v220, v221
v_cvt_pk_bf16_f32 v175, v222, v223
TR 18,7,8960
TR 20,7,8480
TR 22,7,8992
TR 24,7,8512
TR 26,7,9024
buffer_store_dwordx4 v[172:175], v11, s[16:19], s64 offen offset:1024 sc1
TR 28,7,8544
TR 30,7,9056
v_rcp_f32 v224, v224
v_rcp_f32 v225, v225
v_rcp_f32 v226, v226
v_rcp_f32 v227, v227
v_rcp_f32 v232, v232
v_rcp_f32 v233, v233
v_rcp_f32 v234, v234
v_rcp_f32 v235, v235
v_exp_f32 v228, v228
v_exp_f32 v229, v229
v_exp_f32 v230, v230
v_exp_f32 v231, v231
v_exp_f32 v236, v236
v_exp_f32 v237, v237
v_exp_f32 v238, v238
v_exp_f32 v239, v239
v_pk_mul_f32 v[240:241], v[240:241], v[224:225]
buffer_load_dwordx4 v[120:123], v4, s[16:19], s52 offen sc1
v_pk_mul_f32 v[242:243], v[242:243], v[226:227]
v_pk_mul_f32 v[248:249], v[248:249], v[232:233]
v_pk_mul_f32 v[250:251], v[250:251], v[234:235]
v_pk_fma_f32 v[228:229], v[228:229], v[22:23], v[22:23] op_sel:[0,1,1] op_sel_hi:[1,1,1]
v_pk_fma_f32 v[230:231], v[230:231], v[22:23], v[22:23] op_sel:[0,1,1] op_sel_hi:[1,1,1]
v_pk_fma_f32 v[236:237], v[236:237], v[22:23], v[22:23] op_sel:[0,1,1] op_sel_hi:[1,1,1]
v_pk_fma_f32 v[238:239], v[238:239], v[22:23], v[22:23] op_sel:[0,1,1] op_sel_hi:[1,1,1]
v_cvt_pk_bf16_f32 v224, v240, v241
v_cvt_pk_bf16_f32 v225, v242, v243
v_cvt_pk_bf16_f32 v226, v248, v249
v_cvt_pk_bf16_f32 v227, v250, v251
v_rcp_f32 v228, v228
v_rcp_f32 v229, v229
v_rcp_f32 v230, v230
v_rcp_f32 v231, v231
v_rcp_f32 v236, v236
v_rcp_f32 v237, v237
v_rcp_f32 v238, v238
v_rcp_f32 v239, v239
v_pk_mul_f32 v[244:245], v[244:245], v[228:229]
buffer_store_dwordx4 v[224:227], v10, s[16:19], s65 offen sc1
v_pk_mul_f32 v[246:247], v[246:247], v[230:231]
v_pk_mul_f32 v[252:253], v[252:253], v[236:237]
v_pk_mul_f32 v[254:255], v[254:255], v[238:239]
v_cvt_pk_bf16_f32 v228, v244, v245
v_cvt_pk_bf16_f32 v229, v246, v247
v_cvt_pk_bf16_f32 v230, v252, v253
v_cvt_pk_bf16_f32 v231, v254, v255
buffer_store_dwordx4 v[228:231], v10, s[16:19], s65 offen offset:1024 sc1
buffer_load_dwordx4 v[124:127], v4, s[16:19], s52 offen offset:1024 sc1
v_mov_b32 v21, v68
v_mov_b32 v22, v69
v_mov_b32 v23, v70
v_mov_b32 v24, v71
v_mov_b32 v25, 0
s_waitcnt vmcnt(7) lgkmcnt(0)
s_barrier
v_mfma_f32_16x16x32_bf16 v[32:35], a[0:3], v[96:99], 0
ds_read_b64_tr_b16 a[32:33], v6
s_add_u32 s52, s78, 229376
MAV 32,16,104
buffer_load_dwordx4 v[128:131], v4, s[16:19], s52 offen sc1
v_mfma_f32_16x16x32_bf16 v[48:51], a[0:3], v[100:103], 0
TR 34,6,512
MAV 48,16,108
TR 36,6,32
TR 38,6,544
v_mfma_f32_16x16x32_bf16 v[52:55], a[4:7], v[100:103], 0
TR 48,6,8448
MAV 52,20,108
buffer_load_dwordx4 v[132:135], v4, s[16:19], s52 offen offset:1024 sc1
v_mfma_f32_16x16x32_bf16 v[36:39], a[4:7], v[96:99], 0
TR 50,6,8960
MAV 36,20,104
TR 52,6,8480
TR 54,6,8992
v_mfma_f32_16x16x32_bf16 v[40:43], a[8:11], v[96:99], 0
TR 40,6,64
s_add_u32 s52, s78, 294912
MAV 40,24,104
buffer_load_dwordx4 v[136:139], v4, s[16:19], s52 offen sc1
v_mfma_f32_16x16x32_bf16 v[56:59], a[8:11], v[100:103], 0
TR 42,6,576
MAV 56,24,108
TR 44,6,96
TR 46,6,608
v_mfma_f32_16x16x32_bf16 v[60:63], a[12:15], v[100:103], 0
TR 56,6,8512
MAV 60,28,108
buffer_load_dwordx4 v[140:143], v4, s[16:19], s52 offen offset:1024 sc1
v_mfma_f32_16x16x32_bf16 v[44:47], a[12:15], v[96:99], 0
TR 58,6,9024
MAV 44,28,104
TR 60,6,8544
TR 62,6,9056
s_waitcnt lgkmcnt(8)
v_mfma_f32_16x16x32_bf16 v[64:67], a[32:35], v[96:99], 0
TR 0,7,16896
s_add_u32 s52, s79, 344064
MAV 64,48,104
buffer_load_dwordx4 v[144:147], v4, s[16:19], s52 offen sc1
v_mfma_f32_16x16x32_bf16 v[80:83], a[32:35], v[100:103], 0
TR 2,7,17408
MAV 80,48,108
TR 4,7,16928
TR 6,7,17440
v_mfma_f32_16x16x32_bf16 v[84:87], a[36:39], v[100:103], 0
TR 16,7,25344
MAV 84,52,108
buffer_load_dwordx4 v[148:151], v4, s[16:19], s52 offen offset:1024 sc1
v_mfma_f32_16x16x32_bf16 v[68:71], a[36:39], v[96:99], 0
TR 18,7,25856
MAV 68,52,104
TR 20,7,25376
TR 22,7,25888
s_waitcnt lgkmcnt(8)
v_mfma_f32_16x16x32_bf16 v[72:75], a[40:43], v[96:99], 0
TR 8,7,16960
s_add_u32 s52, s79, 409600
MAV 72,56,104
buffer_load_dwordx4 v[152:155], v4, s[16:19], s52 offen sc1
v_mfma_f32_16x16x32_bf16 v[88:91], a[40:43], v[100:103], 0
TR 10,7,17472
MAV 88,56,108
TR 12,7,16992
TR 14,7,17504
v_mfma_f32_16x16x32_bf16 v[92:95], a[44:47], v[100:103], 0
TR 24,7,25408
MAV 92,60,108
buffer_load_dwordx4 v[156:159], v4, s[16:19], s52 offen offset:1024 sc1
v_mfma_f32_16x16x32_bf16 v[76:79], a[44:47], v[96:99], 0
TR 26,7,25920
MAV 76,60,104
TR 28,7,25440
TR 30,7,25952
s_waitcnt vmcnt(8) lgkmcnt(8)
s_barrier
MAV 32,0,112
TR 32,6,16896
MAV 32,16,120
buffer_atomic_add v24, v21, s[16:19], s72 offen
MAV 48,16,124
TR 34,6,17408
MAV 48,0,116
TR 36,6,16928
TR 38,6,17440
TR 48,6,25344
MAV 52,4,116
TR 50,6,25856
s_add_u32 m0, s55, 0
MAV 52,20,124
buffer_load_dwordx4 v18, s[28:31], s54 offen lds
MAV 36,20,120
TR 52,6,25376
MAV 36,4,112
TR 54,6,25888
TR 40,6,16960
s_waitcnt lgkmcnt(9)
MAV 40,8,112
TR 42,6,17472
s_add_u32 s52, s76, 458752
MAV 40,24,120
buffer_load_dwordx4 v[96:99], v4, s[16:19], s52 offen sc1
MAV 56,24,124
TR 44,6,16992
MAV 56,8,116
buffer_load_dwordx4 v19, s[28:31], s54 offen offset:1056 lds
MAV 60,12,116
TR 46,6,17504
s_add_u32 s54, s98, 327680
MAV 60,28,124
buffer_load_dwordx4 v[100:103], v4, s[16:19], s52 offen offset:1024 sc1
MAV 44,28,120
TR 56,6,25408
MAV 44,12,112
TR 58,6,25920
TR 60,6,25440
TR 62,6,25952
s_waitcnt lgkmcnt(8)
MAV 64,32,112
TR 0,7,33792
s_add_u32 m0, s55, 8448
MAV 64,48,120
buffer_load_dwordx4 v18, s[28:31], s54 offen lds
MAV 80,48,124
TR 2,7,34304
MAV 80,32,116
TR 4,7,33824
TR 6,7,34336
MAV 84,36,116
TR 16,7,42240
s_add_u32 s52, s76, 524288
MAV 84,52,124
buffer_load_dwordx4 v[104:107], v4, s[16:19], s52 offen sc1
MAV 68,52,120
TR 18,7,42752
MAV 68,36,112
TR 20,7,42272
TR 22,7,42784
s_waitcnt lgkmcnt(8)
MAV 72,40,112
TR 8,7,33856
MAV 72,56,120
buffer_load_dwordx4 v19, s[28:31], s54 offen offset:1056 lds
MAV 88,56,124
TR 10,7,34368
s_add_u32 s54, s99, 524288
MAV 88,40,116
TR 12,7,33888
TR 14,7,34400
MAV 92,44,116
TR 24,7,42304
MAV 92,60,124
buffer_load_dwordx4 v[108:111], v4, s[16:19], s52 offen offset:1024 sc1
MAV 76,60,120
TR 26,7,42816
MAV 76,44,112
TR 28,7,42336
TR 30,7,42848
s_waitcnt vmcnt(13) lgkmcnt(8)
s_barrier
MAV 32,0,128
TR 32,6,33792
s_add_u32 m0, s55, 16896
MAV 32,16,136
buffer_load_dwordx4 v18, s[28:31], s54 offen lds
MAV 48,16,140
TR 34,6,34304
MAV 48,0,132
TR 36,6,33824
TR 38,6,34336
MAV 52,4,132
TR 48,6,42240
s_add_u32 s52, s77, 573440
MAV 52,20,140
buffer_load_dwordx4 v[112:115], v4, s[16:19], s52 offen sc1
MAV 36,20,136
TR 50,6,42752
MAV 36,4,128
TR 52,6,42272
TR 54,6,42784
s_waitcnt lgkmcnt(8)
MAV 40,8,128
TR 40,6,33856
MAV 40,24,136
buffer_load_dwordx4 v19, s[28:31], s54 offen offset:1056 lds
MAV 56,24,140
TR 42,6,34368
s_add_u32 s54, s99, 786432
MAV 56,8,132
TR 44,6,33888
TR 46,6,34400
MAV 60,12,132
TR 56,6,42304
MAV 60,28,140
buffer_load_dwordx4 v[116:119], v4, s[16:19], s52 offen offset:1024 sc1
MAV 44,28,136
TR 58,6,42816
MAV 44,12,128
TR 60,6,42336
TR 62,6,42848
s_waitcnt lgkmcnt(8)
MAV 64,32,128
TR 0,7,50688
s_add_u32 m0, s55, 25344
MAV 64,48,136
buffer_load_dwordx4 v18, s[28:31], s54 offen lds
MAV 80,48,140
TR 2,7,51200
MAV 80,32,132
TR 4,7,50720
TR 6,7,51232
TR 16,7,59136
MAV 84,36,132
TR 18,7,59648
s_add_u32 s52, s77, 638976
MAV 84,52,140
buffer_load_dwordx4 v[120:123], v4, s[16:19], s52 offen sc1
MAV 68,52,136
TR 20,7,59168
MAV 68,36,128
TR 22,7,59680
TR 8,7,50752
s_waitcnt lgkmcnt(9)
MAV 72,40,128
TR 10,7,51264
MAV 72,56,136
buffer_load_dwordx4 v19, s[28:31], s54 offen offset:1056 lds
MAV 88,56,140
TR 12,7,50784
s_add_u32 s54, s100, 983040
MAV 88,40,132
buffer_load_dwordx4 v[124:127], v4, s[16:19], s52 offen offset:1024 sc1
MAV 92,44,132
TR 14,7,51296
MAV 92,60,140
buffer_atomic_add v25, v22, s[16:19], s73 offen sc0
MAV 76,60,136
TR 24,7,59200
MAV 76,44,128
TR 26,7,59712
TR 28,7,59232
TR 30,7,59744
s_waitcnt vmcnt(18) lgkmcnt(8)
s_barrier
MAV 32,0,144
TR 32,6,50688
s_add_u32 m0, s55, 33792
MAV 32,16,152
buffer_load_dwordx4 v18, s[28:31], s54 offen lds
MAV 48,16,156
TR 34,6,51200
MAV 48,0,148
TR 36,6,50720
TR 38,6,51232
MAV 52,4,148
TR 48,6,59136
s_add_u32 s52, s78, 688128
MAV 52,20,156
buffer_load_dwordx4 v[128:131], v4, s[16:19], s52 offen sc1
MAV 36,20,152
TR 50,6,59648
MAV 36,4,144
TR 52,6,59168
TR 54,6,59680
s_waitcnt lgkmcnt(8)
MAV 40,8,144
TR 40,6,50752
MAV 40,24,152
buffer_load_dwordx4 v19, s[28:31], s54 offen offset:1056 lds
MAV 56,24,156
TR 42,6,51264
s_add_u32 s54, s100, 1245184
MAV 56,8,148
TR 44,6,50784
TR 46,6,51296
MAV 60,12,148
TR 56,6,59200
MAV 60,28,156
buffer_load_dwordx4 v[132:135], v4, s[16:19], s52 offen offset:1024 sc1
MAV 44,28,152
TR 58,6,59712
MAV 44,12,144
TR 60,6,59232
TR 62,6,59744
v_add_u32 v7, s57, v7
v_add_u32 v6, s57, v6
s_sub_u32 s57, 0, s57
s_waitcnt lgkmcnt(8)
MAV 64,32,144
ds_read_b64_tr_b16 a[0:1], v7
s_add_u32 m0, s55, 42240
MAV 64,48,152
buffer_load_dwordx4 v18, s[28:31], s54 offen lds
MAV 80,48,156
TR 2,7,512
MAV 80,32,148
TR 4,7,32
TR 6,7,544
MAV 84,36,148
TR 16,7,8448
s_add_u32 s52, s78, 753664
MAV 84,52,156
buffer_load_dwordx4 v[136:139], v4, s[16:19], s52 offen sc1
MAV 68,52,152
TR 18,7,8960
MAV 68,36,144
TR 20,7,8480
TR 22,7,8992
s_waitcnt lgkmcnt(8)
MAV 72,40,144
TR 8,7,64
MAV 72,56,152
buffer_load_dwordx4 v19, s[28:31], s54 offen offset:1056 lds
MAV 88,56,156
TR 10,7,576
s_add_u32 s54, s101, 1441792
MAV 88,40,148
TR 12,7,96
TR 14,7,608
MAV 92,44,148
TR 24,7,8512
MAV 92,60,156
buffer_load_dwordx4 v[140:143], v4, s[16:19], s52 offen offset:1024 sc1
MAV 76,60,152
TR 26,7,9024
MAV 76,44,144
TR 28,7,8544
TR 30,7,9056
s_waitcnt vmcnt(17) lgkmcnt(8)
s_barrier
MAV 32,0,96
ds_read_b64_tr_b16 a[32:33], v6
s_add_u32 m0, s55, 50688
MAV 32,16,104
buffer_load_dwordx4 v18, s[28:31], s54 offen lds
MAV 48,16,108
TR 34,6,512
MAV 48,0,100
TR 36,6,32
TR 38,6,544
MAV 52,4,100
TR 48,6,8448
s_add_u32 s52, s79, 802816
MAV 52,20,108
buffer_load_dwordx4 v[144:147], v4, s[16:19], s52 offen sc1
MAV 36,20,104
TR 50,6,8960
MAV 36,4,96
TR 52,6,8480
TR 54,6,8992
s_waitcnt lgkmcnt(8)
MAV 40,8,96
TR 40,6,64
MAV 40,24,104
buffer_load_dwordx4 v19, s[28:31], s54 offen offset:1056 lds
MAV 56,24,108
TR 42,6,576
.Lpad18:
s_cbranch_execz .Lpad21
s_add_u32 s54, s101, 1703936
MAV 56,8,100
TR 44,6,96
TR 46,6,608
MAV 60,12,100
TR 56,6,8512
MAV 60,28,108
buffer_load_dwordx4 v[148:151], v4, s[16:19], s52 offen offset:1024 sc1
MAV 44,28,104
TR 58,6,9024
MAV 44,12,96
TR 60,6,8544
TR 62,6,9056
s_waitcnt lgkmcnt(8)
MAV 64,32,96
TR 0,7,16896
s_add_u32 m0, s55, 59136
MAV 64,48,104
buffer_load_dwordx4 v18, s[28:31], s54 offen lds
MAV 80,48,108
TR 2,7,17408
MAV 80,32,100
TR 4,7,16928
TR 6,7,17440
MAV 84,36,100
TR 16,7,25344
s_add_u32 s52, s79, 868352
MAV 84,52,108
buffer_load_dwordx4 v[152:155], v4, s[16:19], s52 offen sc1
MAV 68,52,104
TR 18,7,25856
MAV 68,36,96
TR 20,7,25376
TR 22,7,25888
s_waitcnt lgkmcnt(8)
MAV 72,40,96
TR 8,7,16960
MAV 72,56,104
buffer_load_dwordx4 v19, s[28:31], s54 offen offset:1056 lds
MAV 88,56,108
TR 10,7,17472
s_add_u32 s54, s98, 1900544
MAV 88,40,100
TR 12,7,16992
TR 14,7,17504
MAV 92,44,100
TR 24,7,25408
MAV 92,60,108
buffer_load_dwordx4 v[156:159], v4, s[16:19], s52 offen offset:1024 sc1
MAV 76,60,104
TR 26,7,25920
MAV 76,44,96
TR 28,7,25440
TR 30,7,25952
s_waitcnt vmcnt(16)
v_cmp_gt_u32 vcc, v23, v25
s_nop 0
s_cbranch_vccnz .Lsp50
.Lsp50b:
s_waitcnt lgkmcnt(8)
s_barrier
MAV 32,0,112
TR 32,6,16896
s_add_u32 m0, s55, 67584
MAV 32,16,120
buffer_load_dwordx4 v18, s[28:31], s54 offen lds
MAV 48,16,124
TR 34,6,17408
MAV 48,0,116
TR 36,6,16928
TR 38,6,17440
MAV 52,4,116
TR 48,6,25344
s_add_u32 s52, s76, 16384
MAV 52,20,124
buffer_load_dwordx4 v[96:99], v4, s[16:19], s52 offen sc1
MAV 36,20,120
TR 50,6,25856
MAV 36,4,112
TR 52,6,25376
TR 54,6,25888
s_waitcnt lgkmcnt(8)
MAV 40,8,112
TR 40,6,16960
MAV 40,24,120
buffer_load_dwordx4 v19, s[28:31], s54 offen offset:1056 lds
MAV 56,24,124
TR 42,6,17472
s_add_u32 s54, s98, 2162688
MAV 56,8,116
TR 44,6,16992
TR 46,6,17504
MAV 60,12,116
TR 56,6,25408
MAV 60,28,124
buffer_load_dwordx4 v[100:103], v4, s[16:19], s52 offen offset:1024 sc1
MAV 44,28,120
TR 58,6,25920
MAV 44,12,112
TR 60,6,25440
TR 62,6,25952
s_waitcnt lgkmcnt(8)
MAV 64,32,112
TR 0,7,33792
s_add_u32 m0, s55, 76032
MAV 64,48,120
buffer_load_dwordx4 v18, s[28:31], s54 offen lds
MAV 80,48,124
TR 2,7,34304
MAV 80,32,116
TR 4,7,33824
TR 6,7,34336
MAV 84,36,116
TR 16,7,42240
s_add_u32 s52, s76, 81920
MAV 84,52,124
buffer_load_dwordx4 v[104:107], v4, s[16:19], s52 offen sc1
MAV 68,52,120
TR 18,7,42752
MAV 68,36,112
TR 20,7,42272
TR 22,7,42784
s_waitcnt lgkmcnt(8)
MAV 72,40,112
TR 8,7,33856
MAV 72,56,120
buffer_load_dwordx4 v19, s[28:31], s54 offen offset:1056 lds
MAV 88,56,124
TR 10,7,34368
s_add_u32 s54, s99, 2359296
MAV 88,40,116
TR 12,7,33888
TR 14,7,34400
MAV 92,44,116
TR 24,7,42304
MAV 92,60,124
buffer_load_dwordx4 v[108:111], v4, s[16:19], s52 offen offset:1024 sc1
MAV 76,60,120
TR 26,7,42816
MAV 76,44,112
TR 28,7,42336
TR 30,7,42848
s_waitcnt vmcnt(16) lgkmcnt(8)
s_barrier
MAV 32,0,128
TR 32,6,33792
s_add_u32 m0, s55, 84480
MAV 32,16,136
buffer_load_dwordx4 v18, s[28:31], s54 offen lds
MAV 48,16,140
TR 34,6,34304
MAV 48,0,132
TR 36,6,33824
TR 38,6,34336
MAV 52,4,132
TR 48,6,42240
s_add_u32 s52, s77, 131072
MAV 52,20,140
buffer_load_dwordx4 v[112:115], v4, s[16:19], s52 offen sc1
MAV 36,20,136
TR 50,6,42752
MAV 36,4,128
TR 52,6,42272
TR 54,6,42784
s_waitcnt lgkmcnt(8)
MAV 40,8,128
TR 40,6,33856
MAV 40,24,136
buffer_load_dwordx4 v19, s[28:31], s54 offen offset:1056 lds
MAV 56,24,140
TR 42,6,34368
s_add_u32 s54, s99, 2621440
MAV 56,8,132
TR 44,6,33888
TR 46,6,34400
MAV 60,12,132
TR 56,6,42304
MAV 60,28,140
buffer_load_dwordx4 v[116:119], v4, s[16:19], s52 offen offset:1024 sc1
MAV 44,28,136
TR 58,6,42816
MAV 44,12,128
TR 60,6,42336
TR 62,6,42848
s_waitcnt lgkmcnt(8)
MAV 64,32,128
TR 0,7,50688
s_add_u32 m0, s55, 92928
MAV 64,48,136
buffer_load_dwordx4 v18, s[28:31], s54 offen lds
MAV 80,48,140
TR 2,7,51200
MAV 80,32,132
TR 4,7,50720
TR 6,7,51232
MAV 84,36,132
TR 16,7,59136
s_add_u32 s52, s77, 196608
MAV 84,52,140
buffer_load_dwordx4 v[120:123], v4, s[16:19], s52 offen sc1
MAV 68,52,136
TR 18,7,59648
MAV 68,36,128
TR 20,7,59168
TR 22,7,59680
s_waitcnt lgkmcnt(8)
MAV 72,40,128
TR 8,7,50752
MAV 72,56,136
buffer_load_dwordx4 v19, s[28:31], s54 offen offset:1056 lds
MAV 88,56,140
TR 10,7,51264
s_add_u32 s54, s100, 2818048
MAV 88,40,132
TR 12,7,50784
TR 14,7,51296
MAV 92,44,132
TR 24,7,59200
MAV 92,60,140
buffer_load_dwordx4 v[124:127], v4, s[16:19], s52 offen offset:1024 sc1
MAV 76,60,136
TR 26,7,59712
MAV 76,44,128
TR 28,7,59232
TR 30,7,59744
s_waitcnt vmcnt(16) lgkmcnt(8)
s_barrier
MAV 32,0,144
TR 32,6,50688
s_add_u32 m0, s55, 101376
MAV 32,16,152
buffer_load_dwordx4 v18, s[28:31], s54 offen lds
MAV 48,16,156
TR 34,6,51200
MAV 48,0,148
TR 36,6,50720
TR 38,6,51232
MAV 52,4,148
TR 48,6,59136
s_add_u32 s52, s78, 245760
MAV 52,20,156
buffer_load_dwordx4 v[128:131], v4, s[16:19], s52 offen sc1
MAV 36,20,152
TR 50,6,59648
MAV 36,4,144
TR 52,6,59168
TR 54,6,59680
s_waitcnt lgkmcnt(8)
MAV 40,8,144
TR 40,6,50752
MAV 40,24,152
buffer_load_dwordx4 v19, s[28:31], s54 offen offset:1056 lds
MAV 56,24,156
TR 42,6,51264
s_add_u32 s54, s100, 3080192
MAV 56,8,148
TR 44,6,50784
TR 46,6,51296
MAV 60,12,148
TR 56,6,59200
MAV 60,28,156
buffer_load_dwordx4 v[132:135], v4, s[16:19], s52 offen offset:1024 sc1
MAV 44,28,152
TR 58,6,59712
MAV 44,12,144
TR 60,6,59232
TR 62,6,59744
v_add_u32 v7, s57, v7
v_add_u32 v6, s57, v6
s_sub_u32 s57, 0, s57
s_waitcnt lgkmcnt(8)
MAV 64,32,144
ds_read_b64_tr_b16 a[0:1], v7
s_add_u32 m0, s55, 109824
MAV 64,48,152
buffer_load_dwordx4 v18, s[28:31], s54 offen lds
MAV 80,48,156
TR 2,7,512
MAV 80,32,148
TR 4,7,32
TR 6,7,544
MAV 84,36,148
TR 16,7,8448
s_add_u32 s52, s78, 311296
MAV 84,52,156
buffer_load_dwordx4 v[136:139], v4, s[16:19], s52 offen sc1
MAV 68,52,152
TR 18,7,8960
MAV 68,36,144
TR 20,7,8480
TR 22,7,8992
s_waitcnt lgkmcnt(8)
MAV 72,40,144
TR 8,7,64
MAV 72,56,152
buffer_load_dwordx4 v19, s[28:31], s54 offen offset:1056 lds
MAV 88,56,156
TR 10,7,576
s_add_u32 s54, s101, 3276800
MAV 88,40,148
TR 12,7,96
TR 14,7,608
MAV 92,44,148
TR 24,7,8512
MAV 92,60,156
buffer_load_dwordx4 v[140:143], v4, s[16:19], s52 offen offset:1024 sc1
MAV 76,60,152
TR 26,7,9024
MAV 76,44,144
TR 28,7,8544
TR 30,7,9056
s_waitcnt vmcnt(16) lgkmcnt(8)
s_barrier
MAV 32,0,96
ds_read_b64_tr_b16 a[32:33], v6
s_add_u32 m0, s55, 118272
MAV 32,16,104
buffer_load_dwordx4 v18, s[28:31], s54 offen lds
MAV 48,16,108
TR 34,6,512
MAV 48,0,100
TR 36,6,32
TR 38,6,544
MAV 52,4,100
TR 48,6,8448
s_add_u32 s52, s79, 360448
MAV 52,20,108
buffer_load_dwordx4 v[144:147], v4, s[16:19], s52 offen sc1
MAV 36,20,104
TR 50,6,8960
MAV 36,4,96
TR 52,6,8480
TR 54,6,8992
s_waitcnt lgkmcnt(8)
MAV 40,8,96
TR 40,6,64
MAV 40,24,104
buffer_load_dwordx4 v19, s[28:31], s54 offen offset:1056 lds
MAV 56,24,108
TR 42,6,576
s_add_u32 s54, s101, 3538944
MAV 56,8,100
TR 44,6,96
TR 46,6,608
MAV 60,12,100
TR 56,6,8512
MAV 60,28,108
buffer_load_dwordx4 v[148:151], v4, s[16:19], s52 offen offset:1024 sc1
MAV 44,28,104
TR 58,6,9024
MAV 44,12,96
TR 60,6,8544
TR 62,6,9056
s_waitcnt lgkmcnt(8)
MAV 64,32,96
TR 0,7,16896
s_add_u32 m0, s55, 126720
MAV 64,48,104
buffer_load_dwordx4 v18, s[28:31], s54 offen lds
MAV 80,48,108
TR 2,7,17408
MAV 80,32,100
TR 4,7,16928
TR 6,7,17440
MAV 84,36,100
TR 16,7,25344
s_add_u32 s52, s79, 425984
MAV 84,52,108
buffer_load_dwordx4 v[152:155], v4, s[16:19], s52 offen sc1
MAV 68,52,104
TR 18,7,25856
MAV 68,36,96
TR 20,7,25376
TR 22,7,25888
s_waitcnt lgkmcnt(8)
MAV 72,40,96
TR 8,7,16960
MAV 72,56,104
buffer_load_dwordx4 v19, s[28:31], s54 offen offset:1056 lds
MAV 88,56,108
TR 10,7,17472
s_add_u32 s54, s98, 131072
MAV 88,40,100
TR 12,7,16992
TR 14,7,17504
MAV 92,44,100
TR 24,7,25408
MAV 92,60,108
buffer_load_dwordx4 v[156:159], v4, s[16:19], s52 offen offset:1024 sc1
MAV 76,60,104
TR 26,7,25920
MAV 76,44,96
TR 28,7,25440
TR 30,7,25952
s_waitcnt vmcnt(16) lgkmcnt(8)
s_barrier
MAV 32,0,112
TR 32,6,16896
s_add_u32 m0, s55, 0
MAV 32,16,120
buffer_load_dwordx4 v18, s[28:31], s54 offen lds
MAV 48,16,124
TR 34,6,17408
MAV 48,0,116
TR 36,6,16928
TR 38,6,17440
MAV 52,4,116
TR 48,6,25344
s_add_u32 s52, s76, 475136
MAV 52,20,124
buffer_load_dwordx4 v[96:99], v4, s[16:19], s52 offen sc1
MAV 36,20,120
TR 50,6,25856
MAV 36,4,112
TR 52,6,25376
TR 54,6,25888
s_waitcnt lgkmcnt(8)
MAV 40,8,112
TR 40,6,16960
MAV 40,24,120
buffer_load_dwordx4 v19, s[28:31], s54 offen offset:1056 lds
MAV 56,24,124
TR 42,6,17472
s_add_u32 s54, s98, 393216
MAV 56,8,116
TR 44,6,16992
TR 46,6,17504
MAV 60,12,116
TR 56,6,25408
MAV 60,28,124
buffer_load_dwordx4 v[100:103], v4, s[16:19], s52 offen offset:1024 sc1
MAV 44,28,120
TR 58,6,25920
MAV 44,12,112
TR 60,6,25440
TR 62,6,25952
s_waitcnt lgkmcnt(8)
MAV 64,32,112
TR 0,7,33792
s_add_u32 m0, s55, 8448
MAV 64,48,120
buffer_load_dwordx4 v18, s[28:31], s54 offen lds
MAV 80,48,124
TR 2,7,34304
MAV 80,32,116
TR 4,7,33824
TR 6,7,34336
MAV 84,36,116
TR 16,7,42240
s_add_u32 s52, s76, 540672
MAV 84,52,124
buffer_load_dwordx4 v[104:107], v4, s[16:19], s52 offen sc1
MAV 68,52,120
TR 18,7,42752
MAV 68,36,112
TR 20,7,42272
TR 22,7,42784
s_waitcnt lgkmcnt(8)
MAV 72,40,112
TR 8,7,33856
MAV 72,56,120
buffer_load_dwordx4 v19, s[28:31], s54 offen offset:1056 lds
MAV 88,56,124
TR 10,7,34368
s_add_u32 s54, s99, 589824
MAV 88,40,116
TR 12,7,33888
TR 14,7,34400
MAV 92,44,116
TR 24,7,42304
MAV 92,60,124
buffer_load_dwordx4 v[108:111], v4, s[16:19], s52 offen offset:1024 sc1
MAV 76,60,120
TR 26,7,42816
MAV 76,44,112
TR 28,7,42336
TR 30,7,42848
s_waitcnt vmcnt(16) lgkmcnt(8)
s_barrier
MAV 32,0,128
TR 32,6,33792
s_add_u32 m0, s55, 16896
MAV 32,16,136
buffer_load_dwordx4 v18, s[28:31], s54 offen lds
MAV 48,16,140
TR 34,6,34304
MAV 48,0,132
TR 36,6,33824
TR 38,6,34336
MAV 52,4,132
TR 48,6,42240
s_add_u32 s52, s77, 589824
MAV 52,20,140
buffer_load_dwordx4 v[112:115], v4, s[16:19], s52 offen sc1
MAV 36,20,136
TR 50,6,42752
MAV 36,4,128
TR 52,6,42272
TR 54,6,42784
s_waitcnt lgkmcnt(8)
MAV 40,8,128
TR 40,6,33856
MAV 40,24,136
buffer_load_dwordx4 v19, s[28:31], s54 offen offset:1056 lds
MAV 56,24,140
TR 42,6,34368
s_add_u32 s54, s99, 851968
MAV 56,8,132
TR 44,6,33888
TR 46,6,34400
MAV 60,12,132
TR 56,6,42304
MAV 60,28,140
buffer_load_dwordx4 v[116:119], v4, s[16:19], s52 offen offset:1024 sc1
MAV 44,28,136
TR 58,6,42816
MAV 44,12,128
TR 60,6,42336
TR 62,6,42848
s_waitcnt lgkmcnt(8)
MAV 64,32,128
TR 0,7,50688
s_add_u32 m0, s55, 25344
MAV 64,48,136
buffer_load_dwordx4 v18, s[28:31], s54 offen lds
MAV 80,48,140
TR 2,7,51200
MAV 80,32,132
TR 4,7,50720
TR 6,7,51232
MAV 84,36,132
TR 16,7,59136
.Lpad19:
s_cbranch_execz .Lpad22
s_add_u32 s52, s77, 655360
MAV 84,52,140
buffer_load_dwordx4 v[120:123], v4, s[16:19], s52 offen sc1
MAV 68,52,136
TR 18,7,59648
MAV 68,36,128
TR 20,7,59168
TR 22,7,59680
s_waitcnt lgkmcnt(8)
MAV 72,40,128
TR 8,7,50752
MAV 72,56,136
buffer_load_dwordx4 v19, s[28:31], s54 offen offset:1056 lds
MAV 88,56,140
TR 10,7,51264
s_add_u32 s54, s100, 1048576
MAV 88,40,132
TR 12,7,50784
TR 14,7,51296
MAV 92,44,132
TR 24,7,59200
MAV 92,60,140
buffer_load_dwordx4 v[124:127], v4, s[16:19], s52 offen offset:1024 sc1
MAV 76,60,136
TR 26,7,59712
MAV 76,44,128
TR 28,7,59232
TR 30,7,59744
s_waitcnt vmcnt(16) lgkmcnt(8)
s_barrier
MAV 32,0,144
TR 32,6,50688
s_add_u32 m0, s55, 33792
MAV 32,16,152
buffer_load_dwordx4 v18, s[28:31], s54 offen lds
MAV 48,16,156
TR 34,6,51200
MAV 48,0,148
TR 36,6,50720
TR 38,6,51232
MAV 52,4,148
TR 48,6,59136
s_add_u32 s52, s78, 704512
MAV 52,20,156
buffer_load_dwordx4 v[128:131], v4, s[16:19], s52 offen sc1
MAV 36,20,152
TR 50,6,59648
MAV 36,4,144
TR 52,6,59168
TR 54,6,59680
s_waitcnt lgkmcnt(8)
MAV 40,8,144
TR 40,6,50752
MAV 40,24,152
buffer_load_dwordx4 v19, s[28:31], s54 offen offset:1056 lds
MAV 56,24,156
TR 42,6,51264
s_add_u32 s54, s100, 1310720
MAV 56,8,148
TR 44,6,50784
TR 46,6,51296
MAV 60,12,148
TR 56,6,59200
MAV 60,28,156
buffer_load_dwordx4 v[132:135], v4, s[16:19], s52 offen offset:1024 sc1
MAV 44,28,152
TR 58,6,59712
MAV 44,12,144
TR 60,6,59232
TR 62,6,59744
v_add_u32 v7, s57, v7
v_add_u32 v6, s57, v6
s_sub_u32 s57, 0, s57
s_waitcnt lgkmcnt(8)
MAV 64,32,144
ds_read_b64_tr_b16 a[0:1], v7
s_add_u32 m0, s55, 42240
MAV 64,48,152
buffer_load_dwordx4 v18, s[28:31], s54 offen lds
MAV 80,48,156
TR 2,7,512
MAV 80,32,148
TR 4,7,32
TR 6,7,544
MAV 84,36,148
TR 16,7,8448
s_add_u32 s52, s78, 770048
MAV 84,52,156
buffer_load_dwordx4 v[136:139], v4, s[16:19], s52 offen sc1
MAV 68,52,152
TR 18,7,8960
MAV 68,36,144
TR 20,7,8480
TR 22,7,8992
s_waitcnt lgkmcnt(8)
MAV 72,40,144
TR 8,7,64
MAV 72,56,152
buffer_load_dwordx4 v19, s[28:31], s54 offen offset:1056 lds
MAV 88,56,156
TR 10,7,576
s_add_u32 s54, s101, 1507328
MAV 88,40,148
TR 12,7,96
TR 14,7,608
MAV 92,44,148
TR 24,7,8512
MAV 92,60,156
buffer_load_dwordx4 v[140:143], v4, s[16:19], s52 offen offset:1024 sc1
MAV 76,60,152
TR 26,7,9024
MAV 76,44,144
TR 28,7,8544
TR 30,7,9056
s_waitcnt vmcnt(16) lgkmcnt(8)
s_barrier
MAV 32,0,96
ds_read_b64_tr_b16 a[32:33], v6
s_add_u32 m0, s55, 50688
MAV 32,16,104
buffer_load_dwordx4 v18, s[28:31], s54 offen lds
MAV 48,16,108
TR 34,6,512
MAV 48,0,100
TR 36,6,32
TR 38,6,544
MAV 52,4,100
TR 48,6,8448
s_add_u32 s52, s79, 819200
MAV 52,20,108
buffer_load_dwordx4 v[144:147], v4, s[16:19], s52 offen sc1
MAV 36,20,104
TR 50,6,8960
MAV 36,4,96
TR 52,6,8480
TR 54,6,8992
s_waitcnt lgkmcnt(8)
MAV 40,8,96
TR 40,6,64
MAV 40,24,104
buffer_load_dwordx4 v19, s[28:31], s54 offen offset:1056 lds
MAV 56,24,108
TR 42,6,576
s_add_u32 s54, s101, 1769472
MAV 56,8,100
TR 44,6,96
TR 46,6,608
MAV 60,12,100
TR 56,6,8512
MAV 60,28,108
buffer_load_dwordx4 v[148:151], v4, s[16:19], s52 offen offset:1024 sc1
MAV 44,28,104
TR 58,6,9024
MAV 44,12,96
TR 60,6,8544
TR 62,6,9056
s_waitcnt lgkmcnt(8)
MAV 64,32,96
TR 0,7,16896
s_add_u32 m0, s55, 59136
MAV 64,48,104
buffer_load_dwordx4 v18, s[28:31], s54 offen lds
MAV 80,48,108
TR 2,7,17408
MAV 80,32,100
TR 4,7,16928
TR 6,7,17440
MAV 84,36,100
TR 16,7,25344
s_add_u32 s52, s79, 884736
MAV 84,52,108
buffer_load_dwordx4 v[152:155], v4, s[16:19], s52 offen sc1
MAV 68,52,104
TR 18,7,25856
MAV 68,36,96
TR 20,7,25376
TR 22,7,25888
s_waitcnt lgkmcnt(8)
MAV 72,40,96
TR 8,7,16960
MAV 72,56,104
buffer_load_dwordx4 v19, s[28:31], s54 offen offset:1056 lds
MAV 88,56,108
TR 10,7,17472
s_add_u32 s54, s98, 1966080
MAV 88,40,100
TR 12,7,16992
TR 14,7,17504
MAV 92,44,100
TR 24,7,25408
MAV 92,60,108
buffer_load_dwordx4 v[156:159], v4, s[16:19], s52 offen offset:1024 sc1
MAV 76,60,104
TR 26,7,25920
MAV 76,44,96
TR 28,7,25440
TR 30,7,25952
s_waitcnt vmcnt(16) lgkmcnt(8)
s_barrier
MAV 32,0,112
TR 32,6,16896
s_add_u32 m0, s55, 67584
MAV 32,16,120
buffer_load_dwordx4 v18, s[28:31], s54 offen lds
MAV 48,16,124
TR 34,6,17408
MAV 48,0,116
TR 36,6,16928
TR 38,6,17440
MAV 52,4,116
TR 48,6,25344
s_add_u32 s52, s76, 32768
MAV 52,20,124
buffer_load_dwordx4 v[96:99], v4, s[16:19], s52 offen sc1
MAV 36,20,120
TR 50,6,25856
MAV 36,4,112
TR 52,6,25376
TR 54,6,25888
s_waitcnt lgkmcnt(8)
MAV 40,8,112
TR 40,6,16960
MAV 40,24,120
buffer_load_dwordx4 v19, s[28:31], s54 offen offset:1056 lds
MAV 56,24,124
TR 42,6,17472
s_add_u32 s54, s98, 2228224
MAV 56,8,116
TR 44,6,16992
TR 46,6,17504
MAV 60,12,116
TR 56,6,25408
MAV 60,28,124
buffer_load_dwordx4 v[100:103], v4, s[16:19], s52 offen offset:1024 sc1
MAV 44,28,120
TR 58,6,25920
MAV 44,12,112
TR 60,6,25440
TR 62,6,25952
s_waitcnt lgkmcnt(8)
MAV 64,32,112
TR 0,7,33792
s_add_u32 m0, s55, 76032
MAV 64,48,120
buffer_load_dwordx4 v18, s[28:31], s54 offen lds
MAV 80,48,124
TR 2,7,34304
MAV 80,32,116
TR 4,7,33824
TR 6,7,34336
MAV 84,36,116
TR 16,7,42240
s_add_u32 s52, s76, 98304
MAV 84,52,124
buffer_load_dwordx4 v[104:107], v4, s[16:19], s52 offen sc1
MAV 68,52,120
TR 18,7,42752
MAV 68,36,112
TR 20,7,42272
TR 22,7,42784
s_waitcnt lgkmcnt(8)
MAV 72,40,112
TR 8,7,33856
MAV 72,56,120
buffer_load_dwordx4 v19, s[28:31], s54 offen offset:1056 lds
MAV 88,56,124
TR 10,7,34368
s_add_u32 s54, s99, 2424832
MAV 88,40,116
TR 12,7,33888
TR 14,7,34400
MAV 92,44,116
TR 24,7,42304
MAV 92,60,124
buffer_load_dwordx4 v[108:111], v4, s[16:19], s52 offen offset:1024 sc1
MAV 76,60,120
TR 26,7,42816
MAV 76,44,112
TR 28,7,42336
TR 30,7,42848
s_waitcnt vmcnt(16) lgkmcnt(8)
s_barrier
MAV 32,0,128
TR 32,6,33792
s_add_u32 m0, s55, 84480
MAV 32,16,136
buffer_load_dwordx4 v18, s[28:31], s54 offen lds
MAV 48,16,140
TR 34,6,34304
MAV 48,0,132
TR 36,6,33824
TR 38,6,34336
MAV 52,4,132
TR 48,6,42240
s_add_u32 s52, s77, 147456
MAV 52,20,140
buffer_load_dwordx4 v[112:115], v4, s[16:19], s52 offen sc1
MAV 36,20,136
TR 50,6,42752
MAV 36,4,128
TR 52,6,42272
TR 54,6,42784
s_waitcnt lgkmcnt(8)
MAV 40,8,128
TR 40,6,33856
MAV 40,24,136
buffer_load_dwordx4 v19, s[28:31], s54 offen offset:1056 lds
MAV 56,24,140
TR 42,6,34368
s_add_u32 s54, s99, 2686976
MAV 56,8,132
TR 44,6,33888
TR 46,6,34400
MAV 60,12,132
TR 56,6,42304
MAV 60,28,140
buffer_load_dwordx4 v[116:119], v4, s[16:19], s52 offen offset:1024 sc1
MAV 44,28,136
TR 58,6,42816
MAV 44,12,128
TR 60,6,42336
TR 62,6,42848
s_waitcnt lgkmcnt(8)
MAV 64,32,128
TR 0,7,50688
s_add_u32 m0, s55, 92928
MAV 64,48,136
buffer_load_dwordx4 v18, s[28:31], s54 offen lds
MAV 80,48,140
TR 2,7,51200
MAV 80,32,132
TR 4,7,50720
TR 6,7,51232
MAV 84,36,132
TR 16,7,59136
s_add_u32 s52, s77, 212992
MAV 84,52,140
buffer_load_dwordx4 v[120:123], v4, s[16:19], s52 offen sc1
MAV 68,52,136
TR 18,7,59648
MAV 68,36,128
TR 20,7,59168
TR 22,7,59680
s_waitcnt lgkmcnt(8)
MAV 72,40,128
TR 8,7,50752
MAV 72,56,136
buffer_load_dwordx4 v19, s[28:31], s54 offen offset:1056 lds
MAV 88,56,140
TR 10,7,51264
s_add_u32 s54, s100, 2883584
MAV 88,40,132
TR 12,7,50784
TR 14,7,51296
MAV 92,44,132
TR 24,7,59200
MAV 92,60,140
buffer_load_dwordx4 v[124:127], v4, s[16:19], s52 offen offset:1024 sc1
MAV 76,60,136
TR 26,7,59712
MAV 76,44,128
TR 28,7,59232
TR 30,7,59744
s_waitcnt vmcnt(16) lgkmcnt(8)
s_barrier
MAV 32,0,144
TR 32,6,50688
s_add_u32 m0, s55, 101376
MAV 32,16,152
buffer_load_dwordx4 v18, s[28:31], s54 offen lds
MAV 48,16,156
TR 34,6,51200
MAV 48,0,148
TR 36,6,50720
TR 38,6,51232
MAV 52,4,148
TR 48,6,59136
s_add_u32 s52, s78, 262144
MAV 52,20,156
buffer_load_dwordx4 v[128:131], v4, s[16:19], s52 offen sc1
MAV 36,20,152
TR 50,6,59648
MAV 36,4,144
TR 52,6,59168
TR 54,6,59680
s_waitcnt lgkmcnt(8)
MAV 40,8,144
TR 40,6,50752
MAV 40,24,152
buffer_load_dwordx4 v19, s[28:31], s54 offen offset:1056 lds
MAV 56,24,156
TR 42,6,51264
s_add_u32 s54, s100, 3145728
MAV 56,8,148
TR 44,6,50784
TR 46,6,51296
MAV 60,12,148
TR 56,6,59200
MAV 60,28,156
buffer_load_dwordx4 v[132:135], v4, s[16:19], s52 offen offset:1024 sc1
MAV 44,28,152
TR 58,6,59712
MAV 44,12,144
TR 60,6,59232
TR 62,6,59744
v_add_u32 v7, s57, v7
v_add_u32 v6, s57, v6
s_sub_u32 s57, 0, s57
s_waitcnt lgkmcnt(8)
MAV 64,32,144
ds_read_b64_tr_b16 a[0:1], v7
s_add_u32 m0, s55, 109824
MAV 64,48,152
buffer_load_dwordx4 v18, s[28:31], s54 offen lds
MAV 80,48,156
TR 2,7,512
MAV 80,32,148
TR 4,7,32
TR 6,7,544
MAV 84,36,148
TR 16,7,8448
s_add_u32 s52, s78, 327680
MAV 84,52,156
buffer_load_dwordx4 v[136:139], v4, s[16:19], s52 offen sc1
MAV 68,52,152
TR 18,7,8960
MAV 68,36,144
TR 20,7,8480
TR 22,7,8992
s_waitcnt lgkmcnt(8)
MAV 72,40,144
TR 8,7,64
MAV 72,56,152
buffer_load_dwordx4 v19, s[28:31], s54 offen offset:1056 lds
MAV 88,56,156
TR 10,7,576
s_add_u32 s54, s101, 3342336
MAV 88,40,148
TR 12,7,96
TR 14,7,608
MAV 92,44,148
TR 24,7,8512
MAV 92,60,156
buffer_load_dwordx4 v[140:143], v4, s[16:19], s52 offen offset:1024 sc1
MAV 76,60,152
TR 26,7,9024
MAV 76,44,144
TR 28,7,8544
TR 30,7,9056
s_waitcnt vmcnt(16) lgkmcnt(8)
s_barrier
MAV 32,0,96
ds_read_b64_tr_b16 a[32:33], v6
s_add_u32 m0, s55, 118272
MAV 32,16,104
buffer_load_dwordx4 v18, s[28:31], s54 offen lds
MAV 48,16,108
TR 34,6,512
MAV 48,0,100
TR 36,6,32
TR 38,6,544
MAV 52,4,100
TR 48,6,8448
s_add_u32 s52, s79, 376832
MAV 52,20,108
buffer_load_dwordx4 v[144:147], v4, s[16:19], s52 offen sc1
MAV 36,20,104
TR 50,6,8960
MAV 36,4,96
TR 52,6,8480
TR 54,6,8992
s_waitcnt lgkmcnt(8)
MAV 40,8,96
TR 40,6,64
MAV 40,24,104
buffer_load_dwordx4 v19, s[28:31], s54 offen offset:1056 lds
MAV 56,24,108
TR 42,6,576
s_add_u32 s54, s101, 3604480
MAV 56,8,100
TR 44,6,96
TR 46,6,608
MAV 60,12,100
TR 56,6,8512
MAV 60,28,108
buffer_load_dwordx4 v[148:151], v4, s[16:19], s52 offen offset:1024 sc1
MAV 44,28,104
TR 58,6,9024
MAV 44,12,96
TR 60,6,8544
TR 62,6,9056
s_waitcnt lgkmcnt(8)
MAV 64,32,96
TR 0,7,16896
s_add_u32 m0, s55, 126720
MAV 64,48,104
buffer_load_dwordx4 v18, s[28:31], s54 offen lds
MAV 80,48,108
TR 2,7,17408
MAV 80,32,100
TR 4,7,16928
TR 6,7,17440
MAV 84,36,100
TR 16,7,25344
s_add_u32 s52, s79, 442368
MAV 84,52,108
buffer_load_dwordx4 v[152:155], v4, s[16:19], s52 offen sc1
MAV 68,52,104
TR 18,7,25856
MAV 68,36,96
TR 20,7,25376
TR 22,7,25888
s_waitcnt lgkmcnt(8)
MAV 72,40,96
TR 8,7,16960
MAV 72,56,104
buffer_load_dwordx4 v19, s[28:31], s54 offen offset:1056 lds
MAV 88,56,108
TR 10,7,17472
s_add_u32 s54, s98, 196608
MAV 88,40,100
TR 12,7,16992
TR 14,7,17504
MAV 92,44,100
TR 24,7,25408
MAV 92,60,108
buffer_load_dwordx4 v[156:159], v4, s[16:19], s52 offen offset:1024 sc1
MAV 76,60,104
TR 26,7,25920
MAV 76,44,96
.Lpad20:
s_cbranch_execz .Lnopoll37r
TR 28,7,25440
TR 30,7,25952
s_waitcnt vmcnt(16) lgkmcnt(8)
s_barrier
MAV 32,0,112
TR 32,6,16896
s_add_u32 m0, s55, 0
MAV 32,16,120
buffer_load_dwordx4 v18, s[28:31], s54 offen lds
MAV 48,16,124
TR 34,6,17408
MAV 48,0,116
TR 36,6,16928
TR 38,6,17440
MAV 52,4,116
TR 48,6,25344
s_add_u32 s52, s76, 491520
MAV 52,20,124
buffer_load_dwordx4 v[96:99], v4, s[16:19], s52 offen sc1
MAV 36,20,120
TR 50,6,25856
MAV 36,4,112
TR 52,6,25376
TR 54,6,25888
s_waitcnt lgkmcnt(8)
MAV 40,8,112
TR 40,6,16960
MAV 40,24,120
buffer_load_dwordx4 v19, s[28:31], s54 offen offset:1056 lds
MAV 56,24,124
TR 42,6,17472
s_add_u32 s54, s99, 655360
MAV 56,8,116
TR 44,6,16992
TR 46,6,17504
MAV 60,12,116
TR 56,6,25408
MAV 60,28,124
buffer_load_dwordx4 v[100:103], v4, s[16:19], s52 offen offset:1024 sc1
MAV 44,28,120
TR 58,6,25920
MAV 44,12,112
TR 60,6,25440
TR 62,6,25952
s_waitcnt lgkmcnt(8)
MAV 64,32,112
TR 0,7,33792
s_add_u32 m0, s55, 8448
MAV 64,48,120
buffer_load_dwordx4 v18, s[28:31], s54 offen lds
MAV 80,48,124
TR 2,7,34304
MAV 80,32,116
TR 4,7,33824
TR 6,7,34336
MAV 84,36,116
TR 16,7,42240
s_add_u32 s52, s76, 557056
MAV 84,52,124
buffer_load_dwordx4 v[104:107], v4, s[16:19], s52 offen sc1
MAV 68,52,120
TR 18,7,42752
MAV 68,36,112
TR 20,7,42272
TR 22,7,42784
s_waitcnt lgkmcnt(8)
MAV 72,40,112
TR 8,7,33856
MAV 72,56,120
buffer_load_dwordx4 v19, s[28:31], s54 offen offset:1056 lds
MAV 88,56,124
TR 10,7,34368
s_add_u32 s54, s100, 1114112
MAV 88,40,116
TR 12,7,33888
TR 14,7,34400
MAV 92,44,116
TR 24,7,42304
MAV 92,60,124
buffer_load_dwordx4 v[108:111], v4, s[16:19], s52 offen offset:1024 sc1
MAV 76,60,120
TR 26,7,42816
MAV 76,44,112
TR 28,7,42336
TR 30,7,42848
s_waitcnt vmcnt(16) lgkmcnt(8)
s_barrier
MAV 32,0,128
TR 32,6,33792
s_add_u32 m0, s55, 16896
MAV 32,16,136
buffer_load_dwordx4 v18, s[28:31], s54 offen lds
MAV 48,16,140
TR 34,6,34304
MAV 48,0,132
TR 36,6,33824
TR 38,6,34336
MAV 52,4,132
TR 48,6,42240
s_add_u32 s52, s77, 606208
MAV 52,20,140
buffer_load_dwordx4 v[112:115], v4, s[16:19], s52 offen sc1
MAV 36,20,136
TR 50,6,42752
MAV 36,4,128
TR 52,6,42272
TR 54,6,42784
s_waitcnt lgkmcnt(8)
MAV 40,8,128
TR 40,6,33856
MAV 40,24,136
buffer_load_dwordx4 v19, s[28:31], s54 offen offset:1056 lds
MAV 56,24,140
TR 42,6,34368
s_add_u32 s54, s101, 1572864
MAV 56,8,132
TR 44,6,33888
TR 46,6,34400
MAV 60,12,132
TR 56,6,42304
MAV 60,28,140
buffer_load_dwordx4 v[116:119], v4, s[16:19], s52 offen offset:1024 sc1
MAV 44,28,136
TR 58,6,42816
MAV 44,12,128
TR 60,6,42336
TR 62,6,42848
s_waitcnt lgkmcnt(8)
MAV 64,32,128
TR 0,7,50688
s_add_u32 m0, s55, 25344
MAV 64,48,136
buffer_load_dwordx4 v18, s[28:31], s54 offen lds
MAV 80,48,140
TR 2,7,51200
MAV 80,32,132
TR 4,7,50720
TR 6,7,51232
MAV 84,36,132
TR 16,7,59136
s_add_u32 s52, s77, 671744
MAV 84,52,140
buffer_load_dwordx4 v[120:123], v4, s[16:19], s52 offen sc1
MAV 68,52,136
TR 18,7,59648
MAV 68,36,128
TR 20,7,59168
TR 22,7,59680
s_waitcnt lgkmcnt(8)
MAV 72,40,128
TR 8,7,50752
MAV 72,56,136
buffer_load_dwordx4 v19, s[28:31], s54 offen offset:1056 lds
MAV 88,56,140
TR 10,7,51264
s_add_u32 s54, s98, 2031616
MAV 88,40,132
TR 12,7,50784
TR 14,7,51296
MAV 92,44,132
TR 24,7,59200
MAV 92,60,140
buffer_load_dwordx4 v[124:127], v4, s[16:19], s52 offen offset:1024 sc1
MAV 76,60,136
TR 26,7,59712
MAV 76,44,128
TR 28,7,59232
TR 30,7,59744
s_waitcnt vmcnt(16) lgkmcnt(8)
s_barrier
MAV 32,0,144
TR 32,6,50688
s_add_u32 m0, s55, 33792
MAV 32,16,152
buffer_load_dwordx4 v18, s[28:31], s54 offen lds
MAV 48,16,156
TR 34,6,51200
MAV 48,0,148
TR 36,6,50720
TR 38,6,51232
MAV 52,4,148
TR 48,6,59136
s_add_u32 s52, s78, 720896
MAV 52,20,156
buffer_load_dwordx4 v[128:131], v4, s[16:19], s52 offen sc1
MAV 36,20,152
TR 50,6,59648
MAV 36,4,144
TR 52,6,59168
TR 54,6,59680
s_waitcnt lgkmcnt(8)
MAV 40,8,144
TR 40,6,50752
MAV 40,24,152
buffer_load_dwordx4 v19, s[28:31], s54 offen offset:1056 lds
MAV 56,24,156
TR 42,6,51264
s_add_u32 s54, s99, 2490368
MAV 56,8,148
TR 44,6,50784
TR 46,6,51296
MAV 60,12,148
TR 56,6,59200
MAV 60,28,156
buffer_load_dwordx4 v[132:135], v4, s[16:19], s52 offen offset:1024 sc1
MAV 44,28,152
TR 58,6,59712
MAV 44,12,144
TR 60,6,59232
TR 62,6,59744
v_add_u32 v7, s57, v7
v_add_u32 v6, s57, v6
s_sub_u32 s57, 0, s57
s_waitcnt lgkmcnt(8)
MAV 64,32,144
ds_read_b64_tr_b16 a[0:1], v6
s_add_u32 m0, s55, 42240
MAV 64,48,152
buffer_load_dwordx4 v18, s[28:31], s54 offen lds
MAV 80,48,156
TR 2,6,512
MAV 80,32,148
TR 4,6,32
TR 6,6,544
MAV 84,36,148
TR 16,6,8448
s_add_u32 s52, s78, 786432
MAV 84,52,156
buffer_load_dwordx4 v[136:139], v4, s[16:19], s52 offen sc1
MAV 68,52,152
TR 18,6,8960
MAV 68,36,144
TR 20,6,8480
TR 22,6,8992
s_waitcnt lgkmcnt(8)
MAV 72,40,144
TR 8,6,64
MAV 72,56,152
buffer_load_dwordx4 v19, s[28:31], s54 offen offset:1056 lds
MAV 88,56,156
TR 10,6,576
s_add_u32 s54, s100, 2949120
MAV 88,40,148
TR 12,6,96
TR 14,6,608
MAV 92,44,148
TR 24,6,8512
MAV 92,60,156
buffer_load_dwordx4 v[140:143], v4, s[16:19], s52 offen offset:1024 sc1
MAV 76,60,152
TR 26,6,9024
MAV 76,44,144
TR 28,6,8544
TR 30,6,9056
s_waitcnt vmcnt(16) lgkmcnt(8)
s_barrier
MAV 64,0,96
TR 32,6,16896
TR 34,6,17408
s_add_u32 m0, s55, 50688
MAV 64,16,104
TR 36,6,16928
buffer_load_dwordx4 v18, s[28:31], s54 offen lds
MAV 80,16,108
TR 38,6,17440
MAV 80,0,100
TR 48,6,25344
buffer_load_dwordx4 v19, s[28:31], s54 offen offset:1056 lds
MAV 84,4,100
TR 50,6,25856
s_add_u32 s54, s101, 3407872
s_add_u32 s52, s79, 835584
MAV 84,20,108
buffer_load_dwordx4 v[144:147], v4, s[16:19], s52 offen sc1
MAV 68,20,104
TR 52,6,25376
TR 54,6,25888
MAV 68,4,96
TR 40,6,16960
s_waitcnt lgkmcnt(9)
MAV 72,8,96
TR 42,6,17472
MAV 72,24,104
TR 44,6,16992
buffer_load_dwordx4 v[148:151], v4, s[16:19], s52 offen offset:1024 sc1
MAV 88,24,108
TR 46,6,17504
s_add_u32 m0, s55, 59136
MAV 88,8,100
TR 56,6,25408
buffer_load_dwordx4 v18, s[28:31], s54 offen lds
MAV 92,12,100
TR 58,6,25920
MAV 92,28,108
TR 60,6,25440
buffer_load_dwordx4 v19, s[28:31], s54 offen offset:1056 lds
MAV 76,28,104
TR 62,6,25952
s_add_u32 s52, s79, 901120
MAV 76,12,96
buffer_load_dwordx4 v[152:155], v4, s[16:19], s52 offen sc1
buffer_load_dwordx4 v[156:159], v4, s[16:19], s52 offen offset:1024 sc1
s_waitcnt vmcnt(16) lgkmcnt(8)
MAV 64,32,112
TR 0,6,33792
s_add_u32 s52, s76, 49152
s_lshl_b32 s70, s2, 10
MAV 64,48,120
buffer_load_dwordx4 v[160:163], v4, s[16:19], s52 offen sc1
s_lshl_b32 s62, s3, 7
MAV 80,48,124
TR 2,6,34304
s_add_u32 s70, s70, s62
s_add_u32 s70, s70, 31457280
MAV 80,32,116
TR 4,6,33824
TR 6,6,34336
MAV 84,36,116
TR 16,6,42240
s_xor_b32 s71, s70, 1024
v_min_u32 v12, 1, v1
MAV 84,52,124
buffer_load_dwordx4 v[164:167], v4, s[16:19], s52 offen offset:1024 sc1
v_lshlrev_b32 v12, 28, v12
MAV 68,52,120
TR 18,6,42752
v_mov_b32 v13, 1
MAV 68,36,112
TR 20,6,42272
TR 22,6,42784
s_waitcnt lgkmcnt(8)
MAV 72,40,112
TR 8,6,33856
s_add_u32 s52, s77, 163840
v_mov_b32 v15, 0
MAV 72,56,120
buffer_load_dwordx4 v[168:171], v4, s[16:19], s52 offen sc1
s_lshl_b32 s68, s7, 18
MAV 88,56,124
TR 10,6,34368
s_add_u32 s68, s68, 33554432
s_xor_b32 s69, s68, 262144
MAV 88,40,116
TR 12,6,33888
TR 14,6,34400
MAV 92,44,116
TR 24,6,42304
v_mov_b32 v11, v4
v_and_b32 v2, 1, v1
MAV 92,60,124
buffer_load_dwordx4 v[172:175], v4, s[16:19], s52 offen offset:1024 sc1
v_lshlrev_b32 v2, 4, v2
MAV 76,60,120
TR 26,6,42816
v_mov_b32 v224, 0x3f80
MAV 76,44,112
TR 28,6,42336
TR 30,6,42848
s_waitcnt vmcnt(12) lgkmcnt(8)
MAV 64,0,128
TR 32,6,50688
s_add_u32 s52, s78, 278528
v_lshlrev_b32 v2, v2, v224
MAV 64,16,136
buffer_load_dwordx4 v[176:179], v4, s[16:19], s52 offen sc1
v_bfe_u32 v224, v1, 2, 2
MAV 80,16,140
TR 34,6,51200
v_lshrrev_b32 v225, 4, v1
v_cmp_eq_u32 vcc, v224, v225
MAV 80,0,132
TR 36,6,50720
TR 38,6,51232
MAV 84,4,132
TR 48,6,59136
v_cndmask_b32 v2, 0, v2, vcc
v_and_b32 v224, 2, v1
MAV 84,20,140
buffer_load_dwordx4 v[180:183], v4, s[16:19], s52 offen offset:1024 sc1
v_cmp_eq_u32 vcc, 0, v224
MAV 68,20,136
TR 50,6,59648
v_cndmask_b32 v226, 0, v2, vcc
MAV 68,4,128
TR 52,6,59168
TR 54,6,59680
s_waitcnt lgkmcnt(8)
MAV 72,8,128
TR 40,6,50752
s_add_u32 s52, s79, 393216
v_cndmask_b32 v227, v2, 0, vcc
MAV 72,24,136
buffer_load_dwordx4 v[184:187], v4, s[16:19], s52 offen sc1
v_mov_b32 v224, 0
MAV 88,24,140
TR 42,6,51264
v_mov_b32 v225, 0
v_mov_b32 v228, 0
MAV 88,8,132
TR 44,6,50784
TR 46,6,51296
MAV 92,12,132
TR 56,6,59200
v_mov_b32 v229, 0
v_bfe_u32 v18, v1, 3, 1
MAV 92,28,140
buffer_load_dwordx4 v[188:191], v4, s[16:19], s52 offen offset:1024 sc1
v_lshrrev_b32 v2, 4, v1
MAV 76,28,136
TR 58,6,59712
v_lshl_add_u32 v18, v2, 3, v18
MAV 76,12,128
TR 60,6,59232
TR 62,6,59744
s_waitcnt vmcnt(8) lgkmcnt(8)
s_barrier
v_add_u32 v6, s57, v6
MAV 64,32,144
ds_read_b64_tr_b16 a[0:1], v6
s_add_u32 s52, s76, 507904
s_lshl_b32 s62, s3, 1
MAV 64,48,152
buffer_load_dwordx4 v[192:195], v4, s[16:19], s52 offen sc1
v_add_u32 v18, s62, v18
MAV 80,48,156
TR 2,6,512
v_mul_u32_u24 v18, 6144, v18
v_and_b32 v2, 7, v1
MAV 80,32,148
TR 4,6,32
TR 6,6,544
MAV 84,36,148
TR 16,6,8448
v_lshl_add_u32 v18, v2, 4, v18
s_lshl_b32 s62, s9, 7
MAV 84,52,156
buffer_load_dwordx4 v[196:199], v4, s[16:19], s52 offen offset:1024 sc1
v_add_u32 v18, s62, v18
MAV 68,52,152
TR 18,6,8960
v_add_u32 v19, 1024, v18
MAV 68,36,144
TR 20,6,8480
TR 22,6,8992
s_waitcnt lgkmcnt(8)
MAV 72,40,144
TR 8,6,64
s_add_u32 s52, s77, 622592
v_add_u32 v20, 2048, v18
MAV 72,56,152
buffer_load_dwordx4 v[200:203], v4, s[16:19], s52 offen sc1
s_mul_i32 s59, s3, 3104
MAV 88,56,156
TR 10,6,576
s_mov_b32 s58, 0
v_accvgpr_read_b32 v28, a224
MAV 88,40,148
TR 12,6,96
TR 14,6,608
MAV 92,44,148
TR 24,6,8512
v_add_f32 v32, v32, v28
v_accvgpr_read_b32 v29, a225
MAV 92,60,156
buffer_load_dwordx4 v[204:207], v4, s[16:19], s52 offen offset:1024 sc1
v_add_f32 v33, v33, v29
MAV 76,60,152
TR 26,6,9024
v_accvgpr_read_b32 v28, a226
MAV 76,44,144
TR 28,6,8544
TR 30,6,9056
s_waitcnt vmcnt(8) lgkmcnt(8)
MAV 64,0,160
TR 32,6,16896
s_add_u32 s52, s78, 737280
v_add_f32 v34, v34, v28
MAV 64,16,168
buffer_load_dwordx4 v[208:211], v4, s[16:19], s52 offen sc1
v_accvgpr_read_b32 v29, a227
MAV 80,16,172
TR 34,6,17408
v_add_f32 v35, v35, v29
v_accvgpr_read_b32 v28, a228
MAV 80,0,164
TR 36,6,16928
TR 38,6,17440
MAV 84,4,164
TR 48,6,25344
v_add_f32 v36, v36, v28
v_accvgpr_read_b32 v29, a229
MAV 84,20,172
buffer_load_dwordx4 v[212:215], v4, s[16:19], s52 offen offset:1024 sc1
v_add_f32 v37, v37, v29
MAV 68,20,168
TR 50,6,25856
v_accvgpr_read_b32 v28, a230
MAV 68,4,160
TR 52,6,25376
TR 54,6,25888
s_waitcnt lgkmcnt(8)
MAV 72,8,160
TR 40,6,16960
s_add_u32 s52, s79, 851968
v_add_f32 v38, v38, v28
MAV 72,24,168
buffer_load_dwordx4 v[216:219], v4, s[16:19], s52 offen sc1
v_accvgpr_read_b32 v29, a231
MAV 88,24,172
TR 42,6,17472
v_add_f32 v39, v39, v29
v_accvgpr_read_b32 v28, a232
MAV 88,8,164
TR 44,6,16992
TR 46,6,17504
MAV 92,12,164
TR 56,6,25408
v_add_f32 v40, v40, v28
v_accvgpr_read_b32 v29, a233
MAV 92,28,172
buffer_load_dwordx4 v[220:223], v4, s[16:19], s52 offen offset:1024 sc1
v_add_f32 v41, v41, v29
MAV 76,28,168
TR 58,6,25920
v_accvgpr_read_b32 v28, a234
MAV 76,12,160
TR 60,6,25440
TR 62,6,25952
s_waitcnt vmcnt(8) lgkmcnt(8)
MAV 64,32,176
TR 0,6,33792
v_add_f32 v42, v42, v28
MAV 64,48,184
TR 2,6,34304
v_accvgpr_read_b32 v29, a235
v_add_f32 v43, v43, v29
MAV 80,48,188
TR 4,6,33824
MAV 80,32,180
TR 6,6,34336
v_accvgpr_read_b32 v28, a236
v_add_f32 v44, v44, v28
MAV 84,36,180
TR 16,6,42240
MAV 84,52,188
TR 18,6,42752
v_accvgpr_read_b32 v29, a237
v_add_f32 v45, v45, v29
MAV 68,52,184
TR 20,6,42272
.Lpad21:
s_cbranch_execz .Lnopoll37r
MAV 68,36,176
TR 22,6,42784
v_accvgpr_read_b32 v28, a238
s_waitcnt lgkmcnt(8)
MAV 72,40,176
TR 8,6,33856
v_add_f32 v46, v46, v28
MAV 72,56,184
TR 10,6,34368
v_accvgpr_read_b32 v29, a239
MAV 88,56,188
TR 12,6,33888
v_add_f32 v47, v47, v29
MAV 88,40,180
TR 14,6,34400
v_accvgpr_read_b32 v28, a240
MAV 92,44,180
TR 24,6,42304
v_add_f32 v48, v48, v28
MAV 92,60,188
TR 26,6,42816
v_accvgpr_read_b32 v29, a241
MAV 76,60,184
TR 28,6,42336
v_add_f32 v49, v49, v29
MAV 76,44,176
TR 30,6,42848
v_accvgpr_read_b32 v28, a242
s_waitcnt vmcnt(4) lgkmcnt(8)
MAV 64,0,192
TR 32,6,50688
v_add_f32 v50, v50, v28
MAV 64,16,200
TR 34,6,51200
v_accvgpr_read_b32 v29, a243
v_add_f32 v51, v51, v29
MAV 80,16,204
TR 36,6,50720
MAV 80,0,196
TR 38,6,51232
v_accvgpr_read_b32 v28, a244
v_add_f32 v52, v52, v28
MAV 84,4,196
TR 48,6,59136
MAV 84,20,204
TR 50,6,59648
v_accvgpr_read_b32 v29, a245
v_add_f32 v53, v53, v29
MAV 68,20,200
TR 52,6,59168
MAV 68,4,192
TR 54,6,59680
v_accvgpr_read_b32 v28, a246
s_waitcnt lgkmcnt(8)
MAV 72,8,192
TR 40,6,50752
v_add_f32 v54, v54, v28
MAV 72,24,200
TR 42,6,51264
v_accvgpr_read_b32 v29, a247
MAV 88,24,204
TR 44,6,50784
v_add_f32 v55, v55, v29
MAV 88,8,196
TR 46,6,51296
v_accvgpr_read_b32 v28, a248
MAV 92,12,196
TR 56,6,59200
v_add_f32 v56, v56, v28
MAV 92,28,204
TR 58,6,59712
v_accvgpr_read_b32 v29, a249
MAV 76,28,200
TR 60,6,59232
v_add_f32 v57, v57, v29
MAV 76,12,192
TR 62,6,59744
v_accvgpr_read_b32 v28, a250
s_waitcnt vmcnt(0) lgkmcnt(8)
MAV 64,32,208
ds_read_b64_tr_b16 a[0:1], v7
v_add_f32 v58, v58, v28
MAV 64,48,216
TR 2,7,512
v_accvgpr_read_b32 v29, a251
MAV 80,48,220
TR 4,7,32
v_add_f32 v59, v59, v29
MAV 80,32,212
TR 6,7,544
MAV 84,36,212
TR 16,7,8448
v_accvgpr_read_b32 v28, a252
MAV 84,52,220
TR 18,7,8960
v_add_f32 v60, v60, v28
MAV 68,52,216
TR 20,7,8480
v_accvgpr_read_b32 v29, a253
MAV 68,36,208
TR 22,7,8992
s_waitcnt lgkmcnt(8)
MAV 72,40,208
TR 8,7,64
MAV 72,56,216
TR 10,7,576
v_add_f32 v61, v61, v29
MAV 88,56,220
TR 12,7,96
v_accvgpr_read_b32 v28, a254
MAV 88,40,212
TR 14,7,608
v_add_f32 v62, v62, v28
MAV 92,44,212
TR 24,7,8512
MAV 92,60,220
TR 26,7,9024
v_accvgpr_read_b32 v29, a255
MAV 76,60,216
TR 28,7,8544
v_add_f32 v63, v63, v29
MAV 76,44,208
TR 30,7,9056
s_waitcnt lgkmcnt(8)
MAV 32,0,96
TR 32,7,16896
v_cvt_pk_bf16_f32 v232, v64, v65
MAV 32,16,104
TR 34,7,17408
v_cvt_pk_bf16_f32 v233, v66, v67
v_cvt_pk_bf16_f32 v234, v68, v69
MAV 48,16,108
TR 36,7,16928
v_cvt_pk_bf16_f32 v235, v70, v71
MAV 48,0,100
TR 38,7,17440
buffer_store_dwordx4 v[232:235], v11, s[16:19], s69 offen sc1
s_add_u32 s69, s69, 131072
MAV 52,4,100
TR 48,7,25344
v_cvt_pk_bf16_f32 v236, v72, v73
MAV 52,20,108
TR 50,7,25856
v_cvt_pk_bf16_f32 v237, v74, v75
v_cvt_pk_bf16_f32 v238, v76, v77
MAV 36,20,104
TR 52,7,25376
v_cvt_pk_bf16_f32 v239, v78, v79
MAV 36,4,96
TR 54,7,25888
buffer_store_dwordx4 v[236:239], v11, s[16:19], s69 offen sc1
s_waitcnt lgkmcnt(8)
MAV 40,8,96
TR 40,7,16960
s_add_u32 s69, s69, -130048
MAV 40,24,104
TR 42,7,17472
v_cvt_pk_bf16_f32 v240, v80, v81
v_cvt_pk_bf16_f32 v241, v82, v83
MAV 56,24,108
TR 44,7,16992
v_cvt_pk_bf16_f32 v242, v84, v85
MAV 56,8,100
TR 46,7,17504
v_cvt_pk_bf16_f32 v243, v86, v87
buffer_store_dwordx4 v[240:243], v11, s[16:19], s69 offen sc1
MAV 60,12,100
TR 56,7,25408
s_add_u32 s69, s69, 131072
MAV 60,28,108
TR 58,7,25920
v_cvt_pk_bf16_f32 v244, v88, v89
v_cvt_pk_bf16_f32 v245, v90, v91
MAV 44,28,104
TR 60,7,25440
v_cvt_pk_bf16_f32 v246, v92, v93
MAV 44,12,96
TR 62,7,25952
v_cvt_pk_bf16_f32 v247, v94, v95
buffer_store_dwordx4 v[244:247], v11, s[16:19], s69 offen sc1
s_waitcnt lgkmcnt(8)
MAV 32,32,112
TR 0,7,33792
MAV 32,48,120
TR 2,7,34304
MAV 48,48,124
TR 4,7,33824
MAV 48,32,116
TR 6,7,34336
MAV 52,36,116
TR 16,7,42240
MAV 52,52,124
TR 18,7,42752
MAV 36,52,120
TR 20,7,42272
MAV 36,36,112
TR 22,7,42784
s_waitcnt lgkmcnt(8)
MAV 40,40,112
TR 8,7,33856
MAV 40,56,120
TR 10,7,34368
MAV 56,56,124
TR 12,7,33888
MAV 56,40,116
TR 14,7,34400
MAV 60,44,116
TR 24,7,42304
MAV 60,60,124
TR 26,7,42816
MAV 44,60,120
TR 28,7,42336
MAV 44,44,112
TR 30,7,42848
s_waitcnt lgkmcnt(8)
MAV 32,0,128
TR 32,7,50688
MAV 32,16,136
TR 34,7,51200
MAV 48,16,140
TR 36,7,50720
MAV 48,0,132
TR 38,7,51232
MAV 52,4,132
TR 48,7,59136
MAV 52,20,140
TR 50,7,59648
MAV 36,20,136
TR 52,7,59168
MAV 36,4,128
TR 54,7,59680
s_waitcnt lgkmcnt(8)
MAV 40,8,128
TR 40,7,50752
MAV 40,24,136
TR 42,7,51264
MAV 56,24,140
TR 44,7,50784
MAV 56,8,132
TR 46,7,51296
MAV 60,12,132
TR 56,7,59200
MAV 60,28,140
TR 58,7,59712
MAV 44,28,136
TR 60,7,59232
MAV 44,12,128
TR 62,7,59744
v_add_u32 v7, s57, v7
s_waitcnt lgkmcnt(8)
MAV 32,32,144
ds_read_b64_tr_b16 a[0:1], v7
MAV 32,48,152
s_waitcnt vmcnt(0)
buffer_atomic_add v13, v12, s[16:19], s71 offen
MAV 48,48,156
TR 2,7,512
MAV 48,32,148
TR 4,7,32
TR 6,7,544
MAV 52,36,148
MAV 52,52,156
TR 16,7,8448
TR 18,7,8960
MAV 36,52,152
TR 20,7,8480
MAV 36,36,144
s_waitcnt lgkmcnt(7)
MAV 40,40,144
TR 22,7,8992
MAV 40,56,152
TR 8,7,64
TR 10,7,576
MAV 56,56,156
MAV 56,40,148
TR 12,7,96
TR 14,7,608
MAV 60,44,148
TR 24,7,8512
MAV 60,60,156
TR 26,7,9024
MAV 44,60,152
TR 28,7,8544
MAV 44,44,144
TR 30,7,9056
s_waitcnt lgkmcnt(8)
s_barrier
MAV 32,0,160
TR 32,7,16896
TR 34,7,17408
MAV 32,16,168
buffer_atomic_add v15, v12, s[16:19], s70 offen sc0
MAV 48,16,172
TR 36,7,16928
TR 38,7,17440
MAV 48,0,164
TR 48,7,25344
MAV 52,4,164
TR 50,7,25856
s_add_u32 m0, s59, 117248
MAV 52,20,172
TR 52,7,25376
buffer_load_dwordx4 v18, s[20:23], s58 offen lds
MAV 36,20,168
TR 54,7,25888
MAV 36,4,160
TR 40,7,16960
s_waitcnt lgkmcnt(9)
MAV 40,8,160
TR 42,7,17472
MAV 40,24,168
TR 44,7,16992
buffer_load_dwordx4 v19, s[20:23], s58 offen offset:1024 lds
MAV 56,24,172
TR 46,7,17504
MAV 56,8,164
TR 56,7,25408
buffer_load_dwordx4 v20, s[20:23], s58 offen offset:2048 lds
MAV 60,12,164
s_add_u32 s58, s58, 196608
s_add_u32 m0, s59, 129664
MAV 60,28,172
TR 58,7,25920
buffer_load_dwordx4 v18, s[20:23], s58 offen lds
MAV 44,28,168
TR 60,7,25440
MAV 44,12,160
TR 62,7,25952
s_waitcnt lgkmcnt(8)
MAV 32,32,176
TR 0,7,33792
MAV 32,48,184
buffer_load_dwordx4 v19, s[20:23], s58 offen offset:1024 lds
MAV 48,48,188
TR 2,7,34304
MAV 48,32,180
TR 4,7,33824
TR 6,7,34336
MAV 52,36,180
TR 16,7,42240
MAV 52,52,188
buffer_load_dwordx4 v20, s[20:23], s58 offen offset:2048 lds
MAV 36,52,184
TR 18,7,42752
s_add_u32 s58, s58, 196608
MAV 36,36,176
TR 20,7,42272
TR 22,7,42784
s_waitcnt lgkmcnt(8)
MAV 40,40,176
TR 8,7,33856
s_add_u32 m0, s59, 67584
MAV 40,56,184
buffer_load_dwordx4 v18, s[20:23], s58 offen lds
MAV 56,56,188
TR 10,7,34368
MAV 56,40,180
TR 12,7,33888
TR 14,7,34400
MAV 60,44,180
TR 24,7,42304
MAV 60,60,188
buffer_load_dwordx4 v19, s[20:23], s58 offen offset:1024 lds
MAV 44,60,184
TR 26,7,42816
MAV 44,44,176
TR 28,7,42336
TR 30,7,42848
s_waitcnt vmcnt(8)
v_cmp_ne_u32 vcc, 0, v15
s_nop 0
s_cbranch_vccz .Lxs51
.Lxs51b:
s_waitcnt lgkmcnt(8)
MAV 32,0,192
TR 32,7,50688
TR 34,7,51200
MAV 32,16,200
TR 36,7,50720
buffer_load_dwordx4 v[232:235], v11, s[16:19], s68 offen sc1
MAV 48,16,204
TR 38,7,51232
s_add_u32 s68, s68, 131072
MAV 48,0,196
TR 48,7,59136
buffer_load_dwordx4 v[236:239], v11, s[16:19], s68 offen sc1
MAV 52,4,196
TR 50,7,59648
s_add_u32 s68, s68, -130048
MAV 52,20,204
TR 52,7,59168
buffer_load_dwordx4 v[240:243], v11, s[16:19], s68 offen sc1
MAV 36,20,200
TR 54,7,59680
s_add_u32 s68, s68, 131072
MAV 36,4,192
TR 40,7,50752
s_waitcnt lgkmcnt(9)
MAV 40,8,192
TR 42,7,51264
TR 44,7,50784
MAV 40,24,200
buffer_load_dwordx4 v[244:247], v11, s[16:19], s68 offen sc1
MAV 56,24,204
TR 46,7,51296
TR 56,7,59200
MAV 56,8,196
TR 58,7,59712
buffer_load_dwordx4 v20, s[20:23], s58 offen offset:2048 lds
MAV 60,12,196
s_add_u32 s58, s58, 196608
s_add_u32 m0, s59, 80000
MAV 60,28,204
TR 60,7,59232
buffer_load_dwordx4 v18, s[20:23], s58 offen lds
MAV 44,28,200
TR 62,7,59744
MAV 44,12,192
buffer_load_dwordx4 v19, s[20:23], s58 offen offset:1024 lds
buffer_load_dwordx4 v20, s[20:23], s58 offen offset:2048 lds
s_add_u32 s58, s58, 196608
s_waitcnt lgkmcnt(8)
MAV 32,32,208
s_add_u32 m0, s59, 92416
MAV 32,48,216
buffer_load_dwordx4 v18, s[20:23], s58 offen lds
MAV 48,48,220
MAV 48,32,212
MAV 52,36,212
MAV 52,52,220
MAV 36,52,216
MAV 36,36,208
s_waitcnt lgkmcnt(0)
MAV 40,40,208
MAV 40,56,216
buffer_load_dwordx4 v19, s[20:23], s58 offen offset:1024 lds
MAV 56,56,220
MAV 56,40,212
buffer_load_dwordx4 v20, s[20:23], s58 offen offset:2048 lds
MAV 60,44,212
s_add_u32 s58, s58, 196608
MAV 60,60,220
MAV 44,60,216
MAV 44,44,208
s_waitcnt vmcnt(10)
v_mfma_f32_16x16x32_bf16 v[32:35], v[226:229], v[232:235], v[32:35]
s_lshl_b32 s64, s6, 14
s_lshl_b32 s65, s49, 13
s_add_u32 s64, s64, s65
v_mfma_f32_16x16x32_bf16 v[36:39], v[224:227], v[232:235], v[36:39]
s_lshl_b32 s65, s7, 9
s_add_u32 s64, s64, s65
s_lshl_b32 s65, s48, 8
s_waitcnt vmcnt(9)
v_mfma_f32_16x16x32_bf16 v[40:43], v[226:229], v[236:239], v[40:43]
s_add_u32 s64, s64, s65
s_add_u32 s64, s64, 62914560
v_and_b32 v152, 31, v1
v_mfma_f32_16x16x32_bf16 v[44:47], v[224:227], v[236:239], v[44:47]
s_lshl_b32 s62, s7, 18
v_lshlrev_b32 v152, 3, v152
v_lshrrev_b32 v153, 5, v1
s_waitcnt vmcnt(8)
v_mfma_f32_16x16x32_bf16 v[48:51], v[226:229], v[240:243], v[48:51]
s_add_u32 s62, s62, 33554432
v_lshl_add_u32 v152, v153, 28, v152
s_add_u32 s63, s62, 131072
v_mfma_f32_16x16x32_bf16 v[52:55], v[224:227], v[240:243], v[52:55]
v_cvt_pk_bf16_f32 v128, v32, v33
v_cvt_pk_bf16_f32 v129, v34, v35
s_waitcnt vmcnt(7)
v_mfma_f32_16x16x32_bf16 v[56:59], v[226:229], v[244:247], v[56:59]
v_cvt_pk_bf16_f32 v130, v36, v37
v_cvt_pk_bf16_f32 v131, v38, v39
v_mfma_f32_16x16x32_bf16 v[60:63], v[224:227], v[244:247], v[60:63]
buffer_store_dwordx4 v[128:131], v4, s[16:19], s62 offen sc1
v_cvt_pk_bf16_f32 v132, v40, v41
v_cvt_pk_bf16_f32 v133, v42, v43
v_cvt_pk_bf16_f32 v134, v44, v45
v_cvt_pk_bf16_f32 v135, v46, v47
v_cvt_pk_bf16_f32 v136, v48, v49
v_cvt_pk_bf16_f32 v137, v50, v51
v_cvt_pk_bf16_f32 v138, v52, v53
v_cvt_pk_bf16_f32 v139, v54, v55
v_cvt_pk_bf16_f32 v140, v56, v57
v_cvt_pk_bf16_f32 v141, v58, v59
v_cvt_pk_bf16_f32 v142, v60, v61
v_cvt_pk_bf16_f32 v143, v62, v63
v_pk_mul_f32 v[146:147], v[32:33], v[32:33]
buffer_store_dwordx4 v[132:135], v4, s[16:19], s63 offen sc1
v_pk_mul_f32 v[150:151], v[48:49], v[48:49]
v_pk_fma_f32 v[146:147], v[34:35], v[34:35], v[146:147]
v_pk_add_f32 v[144:145], v[32:33], v[34:35]
v_pk_fma_f32 v[150:151], v[50:51], v[50:51], v[150:151]
v_pk_add_f32 v[148:149], v[48:49], v[50:51]
v_pk_fma_f32 v[146:147], v[36:37], v[36:37], v[146:147]
v_pk_add_f32 v[144:145], v[144:145], v[36:37]
v_pk_fma_f32 v[150:151], v[52:53], v[52:53], v[150:151]
v_pk_add_f32 v[148:149], v[148:149], v[52:53]
v_pk_fma_f32 v[146:147], v[38:39], v[38:39], v[146:147]
v_pk_add_f32 v[144:145], v[144:145], v[38:39]
v_pk_fma_f32 v[150:151], v[54:55], v[54:55], v[150:151]
v_pk_add_f32 v[148:149], v[148:149], v[54:55]
buffer_store_dwordx4 v[136:139], v4, s[16:19], s62 offen offset:1024 sc1
v_pk_fma_f32 v[146:147], v[40:41], v[40:41], v[146:147]
v_pk_add_f32 v[144:145], v[144:145], v[40:41]
v_pk_fma_f32 v[150:151], v[56:57], v[56:57], v[150:151]
v_pk_add_f32 v[148:149], v[148:149], v[56:57]
v_pk_fma_f32 v[146:147], v[42:43], v[42:43], v[146:147]
v_pk_add_f32 v[144:145], v[144:145], v[42:43]
v_pk_fma_f32 v[150:151], v[58:59], v[58:59], v[150:151]
v_pk_add_f32 v[148:149], v[148:149], v[58:59]
v_pk_fma_f32 v[146:147], v[44:45], v[44:45], v[146:147]
v_pk_add_f32 v[144:145], v[144:145], v[44:45]
v_pk_fma_f32 v[150:151], v[60:61], v[60:61], v[150:151]
v_pk_add_f32 v[148:149], v[148:149], v[60:61]
v_pk_fma_f32 v[146:147], v[46:47], v[46:47], v[146:147]
buffer_store_dwordx4 v[140:143], v4, s[16:19], s63 offen offset:1024 sc1
v_pk_add_f32 v[144:145], v[144:145], v[46:47]
v_pk_fma_f32 v[150:151], v[62:63], v[62:63], v[150:151]
v_pk_add_f32 v[148:149], v[148:149], v[62:63]
v_add_f32 v144, v144, v145
v_add_f32 v146, v146, v147
v_add_f32 v148, v148, v149
v_add_f32 v150, v150, v151
s_nop 0
v_permlane16_swap_b32 v144, v148
v_permlane16_swap_b32 v146, v150
v_add_f32 v144, v144, v148
v_add_f32 v146, v146, v150
s_nop 1
v_permlane32_swap_b32 v144, v146
v_add_f32 v144, v144, v146
s_nop 1
v_permlane32_swap_b32 v144, v145
buffer_store_dwordx2 v[144:145], v152, s[16:19], s64 offen sc1
s_nop 1
v_accvgpr_write_b32 a224, v32
v_accvgpr_write_b32 a225, v33
v_accvgpr_write_b32 a226, v34
v_accvgpr_write_b32 a227, v35
v_accvgpr_write_b32 a228, v36
v_accvgpr_write_b32 a229, v37
v_accvgpr_write_b32 a230, v38
v_accvgpr_write_b32 a231, v39
v_accvgpr_write_b32 a232, v40
v_accvgpr_write_b32 a233, v41
v_accvgpr_write_b32 a234, v42
v_accvgpr_write_b32 a235, v43
v_accvgpr_write_b32 a236, v44
.Lpad22:
s_cbranch_execz .Lnopoll37r
v_accvgpr_write_b32 a237, v45
v_accvgpr_write_b32 a238, v46
v_accvgpr_write_b32 a239, v47
v_accvgpr_write_b32 a240, v48
v_accvgpr_write_b32 a241, v49
v_accvgpr_write_b32 a242, v50
v_accvgpr_write_b32 a243, v51
v_accvgpr_write_b32 a244, v52
v_accvgpr_write_b32 a245, v53
v_accvgpr_write_b32 a246, v54
v_accvgpr_write_b32 a247, v55
v_accvgpr_write_b32 a248, v56
v_accvgpr_write_b32 a249, v57
v_accvgpr_write_b32 a250, v58
v_accvgpr_write_b32 a251, v59
v_accvgpr_write_b32 a252, v60
v_accvgpr_write_b32 a253, v61
v_accvgpr_write_b32 a254, v62
v_accvgpr_write_b32 a255, v63
s_lshl_b32 s62, s3, 11
s_add_u32 s62, s62, s85
v_lshl_add_u32 v21, v1, 4, s62
v_lshrrev_b32 v2, 3, v1
v_cmp_eq_u32 vcc, 3, v2
v_add_u32 v2, 67108480, v21
s_nop 0
v_cndmask_b32 v21, v21, v2, vcc
s_sub_u32 s62, s86, 2048
v_lshl_add_u32 v22, v0, 2, s62
v_lshrrev_b32 v2, 5, v0
v_cmp_eq_u32 vcc, 3, v2
v_add_u32 v2, 67108480, v22
s_nop 0
v_cndmask_b32 v22, v22, v2, vcc
s_mul_i32 s62, s48, 4608
v_lshl_add_u32 v23, v1, 4, s62
v_lshrrev_b32 v24, 4, v1
v_mul_u32_u24 v24, 2304, v24
v_and_b32 v2, 15, v1
v_lshl_add_u32 v24, v2, 4, v24
s_mov_b32 s52, 33554432
s_mov_b32 s54, s58
s_mov_b32 s56, s59
s_mul_i32 s55, s3, 2304
v_bfe_u32 v25, v1, 3, 2
v_mul_u32_u24 v25, 3104, v25
v_bfe_u32 v2, v1, 2, 1
v_lshl_add_u32 v25, v2, 7, v25
v_bfe_u32 v2, v1, 5, 1
v_lshl_add_u32 v25, v2, 8, v25
v_and_b32 v2, 3, v1
v_lshl_add_u32 v25, v2, 3, v25
s_lshl_b32 s62, s49, 6
s_add_u32 s62, s62, 67584
v_add_u32 v25, s62, v25
s_lshl_b32 s62, s8, 1
s_add_u32 s62, s62, s3
s_lshr_b32 s63, s50, 2
s_cmp_lt_u32 s3, 2
s_cselect_b32 s62, s62, s63
s_lshl_b32 s62, s62, 13
s_cmp_eq_u32 s3, 3
s_cselect_b32 s62, 268435456, s62
v_lshl_add_u32 v26, v1, 4, s62
s_lshr_b32 s63, s20, 7
s_sub_u32 s63, 3, s63
s_and_b32 s63, s63, 7
s_and_b32 s62, s9, 8
s_add_u32 s63, s63, s62
s_lshl_b32 s62, s5, 2
s_add_u32 s62, s62, s3
s_mul_i32 s62, s62, 12288
s_lshl_b32 s64, s63, 7
s_add_u32 s62, s62, s64
s_xor_b32 s63, s63, s9
s_cmp_lt_u32 s63, 4
s_cselect_b32 s62, s62, 16777216
v_lshrrev_b32 v14, 3, v1
v_min_u32 v14, 5, v14
v_lshl_add_u32 v14, v14, 11, s62
s_mov_b32 s44, 983040
buffer_load_dword v27, v14, s[20:23], s44 offen
s_mov_b32 s44, 2555904
s_mul_i32 s59, s3, 2080
s_and_b32 s87, s6, 3
s_lshl_b32 s87, s87, 17
v_bfe_u32 v5, v1, 3, 1
v_lshrrev_b32 v2, 4, v1
v_lshl_add_u32 v5, v2, 3, v5
s_lshl_b32 s62, s3, 1
v_add_u32 v5, s62, v5
v_mul_u32_u24 v5, 2048, v5
v_and_b32 v2, 7, v1
v_lshl_add_u32 v5, v2, 4, v5
s_lshl_b32 s62, s7, 7
v_add_u32 v5, s62, v5
v_add_u32 v6, 64512, v5
s_lshl_b32 s62, s6, 10
s_add_u32 s62, s62, 30474240
s_lshl_b32 s64, s8, 10
s_add_u32 s64, s64, 30474240
s_lshr_b32 s67, s9, 1
s_and_b32 s67, s67, 3
s_lshl_b32 s67, s67, 7
s_add_u32 s64, s64, s67
s_lshr_b32 s65, s50, 3
s_lshl_b32 s65, s65, 10
s_add_u32 s65, s65, 30474240
s_lshr_b32 s67, s9, 1
s_and_b32 s67, s67, 3
s_lshl_b32 s67, s67, 7
s_add_u32 s65, s65, s67
v_lshl_add_u32 v252, v1, 7, s62
v_mov_b32 v253, s64
v_mov_b32 v255, 1
v_writelane_b32 v253, s65, 1
s_waitcnt vmcnt(1) lgkmcnt(0)
s_cmp_lg_u32 s3, 1
s_barrier
s_cbranch_scc1 .Lfirst54
s_mov_b64 exec, 15
buffer_atomic_add v255, v252, s[16:19], 0 offen
s_mov_b64 exec, 3
v_mov_b32 v254, 0
buffer_atomic_add v254, v253, s[16:19], 0 offen sc0
s_mov_b64 exec, -1
.Lfirst54:
TR 80,25,49664
TR 82,25,50176
TR 84,25,62080
TR 86,25,62592
TR 88,25,50688
TR 90,25,51200
TR 92,25,63104
TR 94,25,63616
TR 96,25,51712
TR 98,25,52224
TR 100,25,64128
TR 102,25,64640
v_lshrrev_b32 v2, 4, v1
v_lshlrev_b32 v2, 2, v2
v_and_b32 v13, 15, v1
v_sub_u32 v2, v13, v2
v_mov_b32 v13, 0xff61b1e6
v_subrev_u32 v54, 0, v2
v_cmp_gt_u32 vcc, 8, v54
s_nop 1
v_cndmask_b32 v50, v13, 0, vcc
v_cmp_gt_i32 vcc, -8, v54
s_nop 1
v_cndmask_b32 v46, v13, 0, vcc
v_subrev_u32 v54, 1, v2
v_cmp_gt_u32 vcc, 8, v54
s_nop 1
v_cndmask_b32 v51, v13, 0, vcc
v_cmp_gt_i32 vcc, -8, v54
s_nop 1
v_cndmask_b32 v47, v13, 0, vcc
v_subrev_u32 v54, 2, v2
v_cmp_gt_u32 vcc, 8, v54
s_nop 1
v_cndmask_b32 v52, v13, 0, vcc
v_cmp_gt_i32 vcc, -8, v54
s_nop 1
v_cndmask_b32 v48, v13, 0, vcc
v_subrev_u32 v54, 3, v2
v_cmp_gt_u32 vcc, 8, v54
s_nop 1
v_cndmask_b32 v53, v13, 0, vcc
v_cmp_gt_i32 vcc, -8, v54
s_nop 1
v_cndmask_b32 v49, v13, 0, vcc
s_cmp_lt_u32 s8, 2
s_cselect_b64 vcc, -1, 0
v_cndmask_b32 v54, v46, v13, vcc
v_cndmask_b32 v55, v47, v13, vcc
v_cndmask_b32 v56, v48, v13, vcc
v_cndmask_b32 v57, v49, v13, vcc
v_mov_b64 v[60:61], 0
v_mov_b64 v[62:63], 0
v_mov_b64 v[64:65], 0
v_mov_b64 v[66:67], 0
v_mov_b64 v[68:69], 0
v_mov_b64 v[70:71], 0
v_mov_b64 v[72:73], 0
v_mov_b64 v[74:75], 0
v_mov_b64 v[76:77], 0
v_mov_b64 v[78:79], 0
v_mov_b64 v[80:81], 0
v_mov_b64 v[82:83], 0
v_mov_b64 v[84:85], 0
v_mov_b64 v[86:87], 0
v_mov_b64 v[88:89], 0
v_mov_b64 v[90:91], 0
v_mov_b64 v[92:93], 0
v_mov_b64 v[94:95], 0
v_mov_b64 v[96:97], 0
v_mov_b64 v[98:99], 0
v_mov_b64 v[100:101], 0
v_mov_b64 v[102:103], 0
v_mov_b64 v[104:105], 0
v_mov_b64 v[106:107], 0
v_mov_b64 v[108:109], 0
v_mov_b64 v[110:111], 0
v_mov_b64 v[112:113], 0
v_mov_b64 v[114:115], 0
v_mov_b64 v[116:117], 0
v_mov_b64 v[118:119], 0
v_mov_b64 v[120:121], 0
v_mov_b64 v[122:123], 0
v_mov_b64 v[124:125], 0
v_mov_b64 v[126:127], 0
v_mov_b64 v[128:129], 0
v_mov_b64 v[130:131], 0
v_mov_b64 v[132:133], 0
v_mov_b64 v[134:135], 0
v_mov_b64 v[136:137], 0
v_mov_b64 v[138:139], 0
v_mov_b64 v[140:141], 0
v_mov_b64 v[142:143], 0
v_mov_b64 v[144:145], 0
v_mov_b64 v[146:147], 0
v_mov_b64 v[148:149], 0
v_mov_b64 v[150:151], 0
v_mov_b64 v[152:153], 0
v_mov_b64 v[154:155], 0
v_mov_b64 v[156:157], 0
v_mov_b64 v[158:159], 0
v_mov_b64 v[160:161], 0
v_mov_b64 v[162:163], 0
v_mov_b64 v[164:165], 0
v_mov_b64 v[166:167], 0
v_mov_b64 v[168:169], 0
v_mov_b64 v[170:171], 0
v_mov_b64 v[172:173], 0
v_mov_b64 v[174:175], 0
s_mov_b32 s75, 62914560
v_and_b32 v10, 15, v1
v_lshlrev_b32 v12, 2, v10
v_lshlrev_b32 v10, 4, v10
v_add_u32 v10, 152576, v10
v_lshrrev_b32 v11, 4, v1
v_lshlrev_b32 v11, 4, v11
s_lshl_b32 s62, s49, 7
s_add_u32 s62, s62, 158720
v_add_u32 v12, s62, v12
v_add_u32 v13, s62, v11
v_add_u32 v11, 156672, v11
s_lshl_b32 s62, s3, 11
s_add_u32 s62, s62, 143360
v_lshl_add_u32 v8, v1, 4, s62
v_xor_b32 v9, 2048, v8
v_mov_b32 v248, 0x3f803f80
v_mov_b32 v249, 0x3f803f80
v_mov_b32 v250, 0x3f803f80
v_mov_b32 v251, 0x3f803f80
v_and_b32 v7, 31, v1
v_lshrrev_b32 v2, 5, v1
v_lshl_add_u32 v7, v7, 1, v2
v_and_b32 v2, 0xc0, v0
v_add_u32 v7, v7, v2
v_lshlrev_b32 v17, 2, v7
v_add_u32 v17, 156672, v17
v_lshlrev_b32 v7, 4, v7
v_add_u32 v7, 152576, v7
s_lshl_b32 s74, s9, 1
s_add_u32 s74, s74, s49
s_lshl_b32 s74, s74, 17
s_add_u32 s74, s74, s85
s_lshl_b32 s63, s48, 12
s_add_u32 s74, s74, s63
s_add_u32 s74, s74, 37748736
s_mov_b32 s62, 0
v_lshl_add_u32 v4, v1, 4, s62
v_lshrrev_b32 v2, 3, v1
v_cmp_eq_u32 vcc, 3, v2
v_add_u32 v2, 67108480, v4
s_nop 0
v_cndmask_b32 v4, v4, v2, vcc
ds_read_b128 v[28:31], v13
ds_read_b128 v[32:35], v13 offset:64
ds_read_b128 v[36:39], v13 offset:256
ds_read_b128 v[40:43], v13 offset:320
ds_read_b32 v44, v12 offset:512
ds_read_b32 v45, v12 offset:576
s_waitcnt lgkmcnt(0)
s_cmp_lg_u32 s3, 1
s_cbranch_scc1 .Lnopoll53
s_mov_b64 exec, 3
s_mov_b32 s15, 0
.Lpoll52:
v_mov_b32 v255, 0
buffer_atomic_add v255, v253, s[16:19], 0 offen sc0
s_waitcnt vmcnt(1)
v_cmp_gt_u32 vcc, 16, v254
s_add_u32 s15, s15, 1
s_cbranch_vccz .Lnopoll53r
v_mov_b32 v254, 0
buffer_atomic_add v254, v253, s[16:19], 0 offen sc0
s_waitcnt vmcnt(1)
v_cmp_gt_u32 vcc, 16, v255
s_add_u32 s15, s15, 1
s_cbranch_vccz .Lnopoll53r
s_cmp_le_u32 s15, 100000
s_cbranch_scc1 .Lpoll52
s_branch .Lnopoll53r
.Lnopoll53:
s_mov_b64 exec, 0
s_cmp_eq_u32 s3, 2
s_cbranch_scc1 .Lpad23
s_cmp_eq_u32 s3, 3
s_cbranch_scc1 .Lpad24
s_branch .Lpad25
.Lnopoll53r:
s_mov_b64 exec, -1
s_barrier
s_cmp_eq_u32 s48, 1
s_cbranch_scc1 .Lqkv55
s_add_u32 m0, s55, 36864
s_nop 0
buffer_load_dwordx4 v21, s[16:19], s52 offen sc1 lds
buffer_load_dwordx4 v21, s[16:19], s52 offen offset:1024 sc1 lds
buffer_load_dword v22, s[16:19], s52 offen offset:2048 sc1 lds
s_add_u32 s52, s52, 131072
s_add_u32 m0, s55, 46080
s_nop 0
buffer_load_dwordx4 v21, s[16:19], s52 offen sc1 lds
buffer_load_dwordx4 v21, s[16:19], s52 offen offset:1024 sc1 lds
buffer_load_dword v22, s[16:19], s52 offen offset:2048 sc1 lds
s_add_u32 s52, s52, 131072
s_add_u32 m0, s55, 0
s_nop 0
buffer_load_dwordx4 v21, s[16:19], s52 offen sc1 lds
buffer_load_dwordx4 v21, s[16:19], s52 offen offset:1024 sc1 lds
buffer_load_dword v22, s[16:19], s52 offen offset:2048 sc1 lds
s_add_u32 s52, s52, 131072
s_add_u32 m0, s55, 9216
s_nop 0
buffer_load_dwordx4 v21, s[16:19], s52 offen sc1 lds
buffer_load_dwordx4 v21, s[16:19], s52 offen offset:1024 sc1 lds
buffer_load_dword v22, s[16:19], s52 offen offset:2048 sc1 lds
s_add_u32 s52, s52, 131072
s_add_u32 m0, s55, 18432
s_nop 0
buffer_load_dwordx4 v21, s[16:19], s52 offen sc1 lds
buffer_load_dwordx4 v21, s[16:19], s52 offen offset:1024 sc1 lds
buffer_load_dword v22, s[16:19], s52 offen offset:2048 sc1 lds
s_add_u32 s52, s52, 131072
s_add_u32 m0, s55, 27648
s_nop 0
buffer_load_dwordx4 v21, s[16:19], s52 offen sc1 lds
buffer_load_dwordx4 v21, s[16:19], s52 offen offset:1024 sc1 lds
buffer_load_dword v22, s[16:19], s52 offen offset:2048 sc1 lds
s_add_u32 s52, s52, 131072
s_waitcnt vmcnt(12)
s_barrier
RD 0,23,36864
RD 4,23,37888
RD 8,23,39168
RD 12,23,40192
RD 16,24,38912
RD 20,23,46080
RD 24,23,47104
RD 28,23,48384
RD 32,23,49408
RD 36,24,48128
s_waitcnt lgkmcnt(0)
s_mov_b32 s15, -2
.p2align 6
.Lk57:
s_waitcnt vmcnt(9) lgkmcnt(8)
s_barrier
MAA 60,80,0
TR 104,25,49696
s_add_u32 m0, s56, 104832
MAA 60,84,20
buffer_load_dwordx4 v18, s[20:23], s54 offen lds
MAA 64,84,24
TR 106,25,50208
v_add_f32 v164, v164, v168
MAA 64,80,4
TR 108,25,62112
MAA 68,80,8
TR 110,25,62624
MAA 68,84,28
buffer_load_dwordx4 v19, s[20:23], s54 offen offset:1024 lds
MAA 72,84,32
TR 112,25,50720
v_add_f32 v165, v165, v169
MAA 72,80,12
TR 114,25,51232
s_waitcnt lgkmcnt(6)
MAA 156,88,16
TR 116,25,63136
MAA 156,92,36
buffer_load_dwordx4 v20, s[20:23], s54 offen offset:2048 lds
MAA 104,92,32
s_add_u32 s54, s54, 196608
s_add_u32 m0, s55, 36864
MAA 104,88,12
buffer_load_dwordx4 v21, s[16:19], s52 offen sc1 lds
MAA 100,88,8
TR 118,25,63648
MAA 100,92,28
TR 120,25,51744
v_add_f32 v166, v166, v170
MAA 96,92,24
TR 122,25,52256
MAA 96,88,4
buffer_load_dwordx4 v21, s[16:19], s52 offen offset:1024 sc1 lds
MAA 92,88,0
TR 124,25,64160
MAA 92,92,20
TR 126,25,64672
v_add_f32 v167, v167, v171
MAA 124,20,100
ds_read_b128 a[40:43], v23
MAA 124,0,96
buffer_load_dword v22, s[16:19], s52 offen offset:2048 sc1 lds
MAA 128,4,96
RD 44,23,1024
s_add_u32 s52, s52, 131072
MAA 128,24,100
buffer_load_dword v27, v14, s[20:23], s44 offen
MAA 132,28,100
RD 48,23,2304
s_add_u32 s44, s44, 1572864
MAA 132,8,96
RD 52,23,3328
MAA 136,12,96
RD 56,24,2048
MAA 136,32,100
s_waitcnt vmcnt(13) lgkmcnt(5)
s_barrier
MAA 76,104,0
RD 60,23,9216
s_add_u32 m0, s56, 117248
MAA 76,108,20
buffer_load_dwordx4 v18, s[20:23], s54 offen lds
MAA 80,108,24
RD 64,23,10240
MAA 80,104,4
RD 68,23,11520
MAA 84,104,8
RD 72,23,12544
MAA 84,108,28
buffer_load_dwordx4 v19, s[20:23], s54 offen offset:1024 lds
MAA 88,108,32
RD 76,24,11264
MAA 88,104,12
buffer_load_dwordx4 v20, s[20:23], s54 offen offset:2048 lds
MAA 160,112,16
ds_read_b64_tr_b16 a[80:81], v25
s_add_u32 s54, s54, 196608
MAA 160,116,36
TR 82,25,512
MAA 120,116,32
TR 84,25,12416
s_add_u32 m0, s55, 46080
MAA 120,112,12
buffer_load_dwordx4 v21, s[16:19], s52 offen sc1 lds
MAA 116,112,8
TR 86,25,12928
MAA 116,116,28
TR 88,25,1024
MAA 112,116,24
TR 90,25,1536
MAA 112,112,4
buffer_load_dwordx4 v21, s[16:19], s52 offen offset:1024 sc1 lds
MAA 108,112,0
TR 92,25,13440
MAA 108,116,20
TR 94,25,13952
MAA 140,20,124
TR 96,25,2048
MAA 140,0,120
buffer_load_dword v22, s[16:19], s52 offen offset:2048 sc1 lds
MAA 144,4,120
TR 98,25,2560
s_add_u32 s52, s52, 131072
MAA 144,24,124
buffer_load_dwordx4 v[168:171], v26, s[16:19], s75 offen sc1
MAA 148,28,124
TR 100,25,14464
MAA 148,8,120
TR 102,25,14976
MAA 152,12,120
MAA 152,32,124
s_waitcnt vmcnt(17) lgkmcnt(8)
s_barrier
MAA 60,80,40
TR 104,25,32
s_add_u32 m0, s56, 129664
MAA 60,84,60
buffer_load_dwordx4 v18, s[20:23], s54 offen lds
MAA 64,84,64
TR 106,25,544
v_add_f32 v164, v164, v172
MAA 64,80,44
TR 108,25,12448
MAA 68,80,48
TR 110,25,12960
MAA 68,84,68
buffer_load_dwordx4 v19, s[20:23], s54 offen offset:1024 lds
MAA 72,84,72
TR 112,25,1056
MAA 72,80,52
TR 114,25,1568
s_waitcnt lgkmcnt(6)
MAA 156,88,56
TR 116,25,13472
v_add_f32 v165, v165, v173
MAA 156,92,76
buffer_load_dwordx4 v20, s[20:23], s54 offen offset:2048 lds
MAA 104,92,72
TR 118,25,13984
s_add_u32 s54, s54, 196608
MAA 104,88,52
TR 120,25,2080
MAA 100,88,48
s_add_u32 m0, s55, 0
MAA 100,92,68
buffer_load_dwordx4 v21, s[16:19], s52 offen sc1 lds
MAA 96,92,64
TR 122,25,2592
v_add_f32 v166, v166, v174
MAA 96,88,44
TR 124,25,14496
MAA 92,88,40
TR 126,25,15008
MAA 92,92,60
buffer_load_dwordx4 v21, s[16:19], s52 offen offset:1024 sc1 lds
MAA 124,60,100
RD 0,23,18432
MAA 124,40,96
RD 4,23,19456
v_add_f32 v167, v167, v175
MAA 128,44,96
RD 8,23,20736
MAA 128,64,100
buffer_load_dword v22, s[16:19], s52 offen offset:2048 sc1 lds
MAA 132,68,100
RD 12,23,21760
s_add_u32 s52, s52, 131072
MAA 132,48,96
RD 16,24,20480
MAA 136,52,96
MAA 136,72,100
s_waitcnt vmcnt(17) lgkmcnt(5)
s_barrier
MAA 76,104,40
RD 20,23,27648
s_add_u32 m0, s56, 67584
MAA 76,108,60
buffer_load_dwordx4 v18, s[20:23], s54 offen lds
MAA 80,108,64
RD 24,23,28672
MAA 80,104,44
RD 28,23,29952
MAA 84,104,48
RD 32,23,30976
MAA 84,108,68
buffer_load_dwordx4 v19, s[20:23], s54 offen offset:1024 lds
MAA 88,108,72
RD 36,24,29696
MAA 88,104,52
buffer_load_dwordx4 v20, s[20:23], s54 offen offset:2048 lds
MAA 160,112,56
TR 80,25,24832
s_add_u32 s54, s54, 196608
MAA 160,116,76
TR 82,25,25344
MAA 120,116,72
TR 84,25,37248
s_add_u32 m0, s55, 9216
MAA 120,112,52
buffer_load_dwordx4 v21, s[16:19], s52 offen sc1 lds
MAA 116,112,48
TR 86,25,37760
MAA 116,116,68
TR 88,25,25856
MAA 112,116,64
TR 90,25,26368
MAA 112,112,44
buffer_load_dwordx4 v21, s[16:19], s52 offen offset:1024 sc1 lds
MAA 108,112,40
TR 92,25,38272
MAA 108,116,60
TR 94,25,38784
MAA 140,60,124
TR 96,25,26880
MAA 140,40,120
buffer_load_dword v22, s[16:19], s52 offen offset:2048 sc1 lds
MAA 144,44,120
TR 98,25,27392
s_add_u32 s52, s52, 131072
MAA 144,64,124
buffer_load_dwordx4 v[172:175], v26, s[16:19], s75 offen offset:1024 sc1
MAA 148,68,124
TR 100,25,39296
s_add_u32 s75, s75, 2048
MAA 148,48,120
TR 102,25,39808
MAA 152,52,120
MAA 152,72,124
s_waitcnt vmcnt(21) lgkmcnt(8)
s_barrier
MAA 60,80,0
TR 104,25,24864
s_add_u32 m0, s56, 80000
MAA 60,84,20
buffer_load_dwordx4 v18, s[20:23], s54 offen lds
MAA 64,84,24
TR 106,25,25376
MAA 64,80,4
TR 108,25,37280
MAA 68,80,8
TR 110,25,37792
MAA 68,84,28
buffer_load_dwordx4 v19, s[20:23], s54 offen offset:1024 lds
MAA 72,84,32
TR 112,25,25888
MAA 72,80,12
TR 114,25,26400
s_waitcnt lgkmcnt(6)
MAA 156,88,16
TR 116,25,38304
MAA 156,92,36
buffer_load_dwordx4 v20, s[20:23], s54 offen offset:2048 lds
MAA 104,92,32
TR 118,25,38816
s_add_u32 s54, s54, 196608
MAA 104,88,12
TR 120,25,26912
MAA 100,88,8
s_add_u32 m0, s55, 18432
MAA 100,92,28
.Lpad23:
s_cbranch_execz .Lpad26
buffer_load_dwordx4 v21, s[16:19], s52 offen sc1 lds
MAA 96,92,24
TR 122,25,27424
MAA 96,88,4
TR 124,25,39328
MAA 92,88,0
TR 126,25,39840
MAA 92,92,20
buffer_load_dwordx4 v21, s[16:19], s52 offen offset:1024 sc1 lds
MAA 124,20,100
RD 40,23,36864
MAA 124,0,96
RD 44,23,37888
MAA 128,4,96
RD 48,23,39168
MAA 128,24,100
buffer_load_dword v22, s[16:19], s52 offen offset:2048 sc1 lds
MAA 132,28,100
RD 52,23,40192
s_add_u32 s52, s52, 131072
MAA 132,8,96
RD 56,24,38912
MAA 136,12,96
MAA 136,32,100
s_waitcnt vmcnt(16) lgkmcnt(5)
s_barrier
MAA 76,104,0
RD 60,23,46080
s_add_u32 m0, s56, 92416
MAA 76,108,20
buffer_load_dwordx4 v18, s[20:23], s54 offen lds
MAA 80,108,24
RD 64,23,47104
MAA 80,104,4
RD 68,23,48384
MAA 84,104,8
RD 72,23,49408
MAA 84,108,28
buffer_load_dwordx4 v19, s[20:23], s54 offen offset:1024 lds
MAA 88,108,32
RD 76,24,48128
MAA 88,104,12
TR 80,25,49664
MAA 160,112,16
TR 82,25,50176
MAA 160,116,36
buffer_load_dwordx4 v20, s[20:23], s54 offen offset:2048 lds
MAA 120,116,32
TR 84,25,62080
s_add_u32 s54, s54, 196608
MAA 120,112,12
TR 86,25,62592
MAA 116,112,8
s_add_u32 m0, s55, 27648
MAA 116,116,28
buffer_load_dwordx4 v21, s[16:19], s52 offen sc1 lds
MAA 112,116,24
TR 88,25,50688
MAA 112,112,4
TR 90,25,51200
MAA 108,112,0
TR 92,25,63104
MAA 108,116,20
buffer_load_dwordx4 v21, s[16:19], s52 offen offset:1024 sc1 lds
MAA 140,20,124
TR 94,25,63616
MAA 140,0,120
TR 96,25,51712
MAA 144,4,120
TR 98,25,52224
MAA 144,24,124
buffer_load_dword v22, s[16:19], s52 offen offset:2048 sc1 lds
MAA 148,28,124
TR 100,25,64128
s_add_u32 s52, s52, 131072
MAA 148,8,120
TR 102,25,64640
MAA 152,12,120
MAA 152,32,124
s_waitcnt vmcnt(19) lgkmcnt(8)
s_barrier
MAA 60,80,40
TR 104,25,49696
s_add_u32 m0, s56, 104832
MAA 60,84,60
buffer_load_dwordx4 v18, s[20:23], s54 offen lds
MAA 64,84,64
TR 106,25,50208
v_add_f32 v164, v164, v168
MAA 64,80,44
TR 108,25,62112
MAA 68,80,48
TR 110,25,62624
MAA 68,84,68
buffer_load_dwordx4 v19, s[20:23], s54 offen offset:1024 lds
MAA 72,84,72
TR 112,25,50720
v_add_f32 v165, v165, v169
MAA 72,80,52
TR 114,25,51232
s_waitcnt lgkmcnt(6)
MAA 156,88,56
TR 116,25,63136
MAA 156,92,76
buffer_load_dwordx4 v20, s[20:23], s54 offen offset:2048 lds
MAA 104,92,72
s_add_u32 s54, s54, 196608
s_add_u32 m0, s55, 36864
MAA 104,88,52
buffer_load_dwordx4 v21, s[16:19], s52 offen sc1 lds
MAA 100,88,48
TR 118,25,63648
MAA 100,92,68
TR 120,25,51744
v_add_f32 v166, v166, v170
MAA 96,92,64
TR 122,25,52256
MAA 96,88,44
buffer_load_dwordx4 v21, s[16:19], s52 offen offset:1024 sc1 lds
MAA 92,88,40
TR 124,25,64160
MAA 92,92,60
TR 126,25,64672
v_add_f32 v167, v167, v171
MAA 124,60,100
ds_read_b128 a[0:3], v23
MAA 124,40,96
buffer_load_dword v22, s[16:19], s52 offen offset:2048 sc1 lds
MAA 128,44,96
RD 4,23,1024
s_add_u32 s52, s52, 131072
MAA 128,64,100
buffer_load_dword v27, v14, s[20:23], s44 offen
MAA 132,68,100
RD 8,23,2304
s_add_u32 s44, s44, 1572864
MAA 132,48,96
RD 12,23,3328
MAA 136,52,96
RD 16,24,2048
MAA 136,72,100
s_waitcnt vmcnt(16) lgkmcnt(5)
s_barrier
MAA 76,104,40
RD 20,23,9216
s_add_u32 m0, s56, 117248
MAA 76,108,60
buffer_load_dwordx4 v18, s[20:23], s54 offen lds
MAA 80,108,64
RD 24,23,10240
MAA 80,104,44
RD 28,23,11520
MAA 84,104,48
RD 32,23,12544
MAA 84,108,68
buffer_load_dwordx4 v19, s[20:23], s54 offen offset:1024 lds
MAA 88,108,72
RD 36,24,11264
MAA 88,104,52
buffer_load_dwordx4 v20, s[20:23], s54 offen offset:2048 lds
MAA 160,112,56
ds_read_b64_tr_b16 a[80:81], v25
s_add_u32 s54, s54, 196608
MAA 160,116,76
TR 82,25,512
MAA 120,116,72
TR 84,25,12416
s_add_u32 m0, s55, 46080
MAA 120,112,52
buffer_load_dwordx4 v21, s[16:19], s52 offen sc1 lds
MAA 116,112,48
TR 86,25,12928
MAA 116,116,68
TR 88,25,1024
MAA 112,116,64
TR 90,25,1536
MAA 112,112,44
buffer_load_dwordx4 v21, s[16:19], s52 offen offset:1024 sc1 lds
MAA 108,112,40
TR 92,25,13440
MAA 108,116,60
TR 94,25,13952
MAA 140,60,124
TR 96,25,2048
MAA 140,40,120
buffer_load_dword v22, s[16:19], s52 offen offset:2048 sc1 lds
MAA 144,44,120
TR 98,25,2560
s_add_u32 s52, s52, 131072
MAA 144,64,124
buffer_load_dwordx4 v[168:171], v26, s[16:19], s75 offen sc1
MAA 148,68,124
TR 100,25,14464
MAA 148,48,120
TR 102,25,14976
MAA 152,52,120
MAA 152,72,124
s_waitcnt vmcnt(20) lgkmcnt(8)
s_barrier
MAA 60,80,0
TR 104,25,32
s_add_u32 m0, s56, 129664
MAA 60,84,20
buffer_load_dwordx4 v18, s[20:23], s54 offen lds
MAA 64,84,24
TR 106,25,544
v_add_f32 v164, v164, v172
MAA 64,80,4
TR 108,25,12448
MAA 68,80,8
TR 110,25,12960
MAA 68,84,28
buffer_load_dwordx4 v19, s[20:23], s54 offen offset:1024 lds
MAA 72,84,32
TR 112,25,1056
MAA 72,80,12
TR 114,25,1568
s_waitcnt lgkmcnt(6)
MAA 156,88,16
TR 116,25,13472
v_add_f32 v165, v165, v173
MAA 156,92,36
buffer_load_dwordx4 v20, s[20:23], s54 offen offset:2048 lds
MAA 104,92,32
TR 118,25,13984
s_add_u32 s54, s54, 196608
MAA 104,88,12
TR 120,25,2080
MAA 100,88,8
s_add_u32 m0, s55, 0
MAA 100,92,28
buffer_load_dwordx4 v21, s[16:19], s52 offen sc1 lds
MAA 96,92,24
TR 122,25,2592
v_add_f32 v166, v166, v174
MAA 96,88,4
TR 124,25,14496
MAA 92,88,0
TR 126,25,15008
MAA 92,92,20
buffer_load_dwordx4 v21, s[16:19], s52 offen offset:1024 sc1 lds
MAA 124,20,100
RD 40,23,18432
MAA 124,0,96
RD 44,23,19456
v_add_f32 v167, v167, v175
MAA 128,4,96
RD 48,23,20736
MAA 128,24,100
buffer_load_dword v22, s[16:19], s52 offen offset:2048 sc1 lds
MAA 132,28,100
RD 52,23,21760
s_add_u32 s52, s52, 131072
MAA 132,8,96
RD 56,24,20480
MAA 136,12,96
MAA 136,32,100
s_waitcnt vmcnt(17) lgkmcnt(5)
s_barrier
MAA 76,104,0
RD 60,23,27648
s_add_u32 m0, s56, 67584
MAA 76,108,20
buffer_load_dwordx4 v18, s[20:23], s54 offen lds
MAA 80,108,24
RD 64,23,28672
MAA 80,104,4
RD 68,23,29952
MAA 84,104,8
RD 72,23,30976
MAA 84,108,28
buffer_load_dwordx4 v19, s[20:23], s54 offen offset:1024 lds
MAA 88,108,32
RD 76,24,29696
MAA 88,104,12
buffer_load_dwordx4 v20, s[20:23], s54 offen offset:2048 lds
MAA 160,112,16
TR 80,25,24832
s_add_u32 s54, s54, 196608
MAA 160,116,36
TR 82,25,25344
MAA 120,116,32
TR 84,25,37248
s_add_u32 m0, s55, 9216
MAA 120,112,12
buffer_load_dwordx4 v21, s[16:19], s52 offen sc1 lds
MAA 116,112,8
TR 86,25,37760
MAA 116,116,28
TR 88,25,25856
MAA 112,116,24
TR 90,25,26368
MAA 112,112,4
buffer_load_dwordx4 v21, s[16:19], s52 offen offset:1024 sc1 lds
MAA 108,112,0
TR 92,25,38272
MAA 108,116,20
TR 94,25,38784
MAA 140,20,124
TR 96,25,26880
MAA 140,0,120
buffer_load_dword v22, s[16:19], s52 offen offset:2048 sc1 lds
MAA 144,4,120
TR 98,25,27392
s_add_u32 s52, s52, 131072
MAA 144,24,124
buffer_load_dwordx4 v[172:175], v26, s[16:19], s75 offen offset:1024 sc1
MAA 148,28,124
TR 100,25,39296
s_add_u32 s75, s75, 2048
MAA 148,8,120
TR 102,25,39808
MAA 152,12,120
MAA 152,32,124
s_waitcnt vmcnt(21) lgkmcnt(8)
s_barrier
MAA 60,80,40
TR 104,25,24864
s_add_u32 m0, s56, 80000
MAA 60,84,60
buffer_load_dwordx4 v18, s[20:23], s54 offen lds
MAA 64,84,64
TR 106,25,25376
MAA 64,80,44
TR 108,25,37280
MAA 68,80,48
TR 110,25,37792
MAA 68,84,68
buffer_load_dwordx4 v19, s[20:23], s54 offen offset:1024 lds
MAA 72,84,72
TR 112,25,25888
MAA 72,80,52
TR 114,25,26400
s_waitcnt lgkmcnt(6)
MAA 156,88,56
TR 116,25,38304
MAA 156,92,76
buffer_load_dwordx4 v20, s[20:23], s54 offen offset:2048 lds
MAA 104,92,72
TR 118,25,38816
s_add_u32 s54, s54, 196608
MAA 104,88,52
TR 120,25,26912
MAA 100,88,48
s_add_u32 m0, s55, 18432
MAA 100,92,68
buffer_load_dwordx4 v21, s[16:19], s52 offen sc1 lds
MAA 96,92,64
TR 122,25,27424
MAA 96,88,44
TR 124,25,39328
MAA 92,88,40
TR 126,25,39840
MAA 92,92,60
buffer_load_dwordx4 v21, s[16:19], s52 offen offset:1024 sc1 lds
MAA 124,60,100
RD 0,23,36864
MAA 124,40,96
RD 4,23,37888
MAA 128,44,96
RD 8,23,39168
MAA 128,64,100
buffer_load_dword v22, s[16:19], s52 offen offset:2048 sc1 lds
MAA 132,68,100
RD 12,23,40192
s_add_u32 s52, s52, 131072
MAA 132,48,96
RD 16,24,38912
MAA 136,52,96
MAA 136,72,100
s_waitcnt vmcnt(16) lgkmcnt(5)
s_barrier
MAA 76,104,40
RD 20,23,46080
s_add_u32 m0, s56, 92416
MAA 76,108,60
buffer_load_dwordx4 v18, s[20:23], s54 offen lds
MAA 80,108,64
RD 24,23,47104
MAA 80,104,44
RD 28,23,48384
MAA 84,104,48
RD 32,23,49408
MAA 84,108,68
buffer_load_dwordx4 v19, s[20:23], s54 offen offset:1024 lds
MAA 88,108,72
RD 36,24,48128
MAA 88,104,52
TR 80,25,49664
MAA 160,112,56
TR 82,25,50176
MAA 160,116,76
buffer_load_dwordx4 v20, s[20:23], s54 offen offset:2048 lds
MAA 120,116,72
TR 84,25,62080
s_add_u32 s54, s54, 196608
MAA 120,112,52
TR 86,25,62592
MAA 116,112,48
s_add_u32 m0, s55, 27648
MAA 116,116,68
buffer_load_dwordx4 v21, s[16:19], s52 offen sc1 lds
MAA 112,116,64
TR 88,25,50688
MAA 112,112,44
TR 90,25,51200
MAA 108,112,40
TR 92,25,63104
MAA 108,116,60
buffer_load_dwordx4 v21, s[16:19], s52 offen offset:1024 sc1 lds
MAA 140,60,124
TR 94,25,63616
MAA 140,40,120
TR 96,25,51712
MAA 144,44,120
TR 98,25,52224
MAA 144,64,124
buffer_load_dword v22, s[16:19], s52 offen offset:2048 sc1 lds
MAA 148,68,124
TR 100,25,64128
s_add_u32 s52, s52, 131072
MAA 148,48,120
TR 102,25,64640
MAA 152,52,120
s_add_u32 s15, s15, 1
MAA 152,72,124
s_cbranch_scc0 .Lk57
s_waitcnt vmcnt(19) lgkmcnt(8)
s_barrier
MAA 60,80,0
TR 104,25,49696
s_add_u32 m0, s56, 104832
MAA 60,84,20
buffer_load_dwordx4 v18, s[20:23], s54 offen lds
MAA 64,84,24
TR 106,25,50208
v_add_f32 v164, v164, v168
MAA 64,80,4
TR 108,25,62112
v_add_f32 v165, v165, v169
MAA 68,80,8
TR 110,25,62624
v_add_f32 v166, v166, v170
MAA 68,84,28
buffer_load_dwordx4 v19, s[20:23], s54 offen offset:1024 lds
MAA 72,84,32
TR 112,25,50720
v_add_f32 v167, v167, v171
MAA 72,80,12
TR 114,25,51232
s_waitcnt lgkmcnt(6)
MAA 156,88,16
TR 116,25,63136
MAA 156,92,36
buffer_load_dwordx4 v20, s[20:23], s54 offen offset:2048 lds
MAA 104,92,32
TR 118,25,63648
s_add_u32 s54, s54, 196608
MAA 104,88,12
TR 120,25,51744
s_add_u32 m0, s55, 36864
MAA 100,88,8
TR 122,25,52256
MAA 100,92,28
buffer_load_dwordx4 v21, s[16:19], s52 offen sc1 lds
MAA 96,92,24
TR 124,25,64160
MAA 96,88,4
TR 126,25,64672
MAA 92,88,0
ds_read_b128 a[40:43], v23
MAA 92,92,20
buffer_load_dwordx4 v21, s[16:19], s52 offen offset:1024 sc1 lds
MAA 124,20,100
RD 44,23,1024
MAA 124,0,96
RD 48,23,2304
MAA 128,4,96
RD 52,23,3328
MAA 128,24,100
buffer_load_dword v22, s[16:19], s52 offen offset:2048 sc1 lds
MAA 132,28,100
RD 56,24,2048
s_add_u32 s52, s52, 131072
MAA 132,8,96
MAA 136,12,96
MAA 136,32,100
s_waitcnt vmcnt(15) lgkmcnt(5)
s_barrier
MAA 76,104,0
RD 60,23,9216
s_add_u32 m0, s56, 117248
MAA 76,108,20
buffer_load_dwordx4 v18, s[20:23], s54 offen lds
MAA 80,108,24
RD 64,23,10240
v_add_f32 v164, v164, v172
MAA 80,104,4
RD 68,23,11520
v_add_f32 v165, v165, v173
MAA 84,104,8
RD 72,23,12544
v_add_f32 v166, v166, v174
MAA 84,108,28
buffer_load_dwordx4 v19, s[20:23], s54 offen offset:1024 lds
MAA 88,108,32
RD 76,24,11264
v_add_f32 v167, v167, v175
MAA 88,104,12
ds_read_b64_tr_b16 a[80:81], v25
MAA 160,112,16
TR 82,25,512
MAA 160,116,36
buffer_load_dwordx4 v20, s[20:23], s54 offen offset:2048 lds
MAA 120,116,32
TR 84,25,12416
s_add_u32 s54, s54, 196608
MAA 120,112,12
TR 86,25,12928
s_add_u32 m0, s55, 46080
MAA 116,112,8
TR 88,25,1024
MAA 116,116,28
buffer_load_dwordx4 v21, s[16:19], s52 offen sc1 lds
MAA 112,116,24
TR 90,25,1536
MAA 112,112,4
TR 92,25,13440
MAA 108,112,0
TR 94,25,13952
MAA 108,116,20
buffer_load_dwordx4 v21, s[16:19], s52 offen offset:1024 sc1 lds
.Lpad24:
s_cbranch_execz .Lpad27
MAA 140,20,124
TR 96,25,2048
MAA 140,0,120
TR 98,25,2560
MAA 144,4,120
TR 100,25,14464
MAA 144,24,124
buffer_load_dword v22, s[16:19], s52 offen offset:2048 sc1 lds
MAA 148,28,124
TR 102,25,14976
s_add_u32 s52, s52, 131072
MAA 148,8,120
v_permlane32_swap_b32 v164, v166
MAA 152,12,120
v_permlane32_swap_b32 v165, v167
MAA 152,32,124
s_waitcnt vmcnt(18) lgkmcnt(8)
s_barrier
MAA 60,80,40
TR 104,25,32
s_add_u32 m0, s56, 129664
MAA 60,84,60
buffer_load_dwordx4 v18, s[20:23], s54 offen lds
MAA 64,84,64
TR 106,25,544
v_add_f32 v164, v164, v166
MAA 64,80,44
TR 108,25,12448
v_add_f32 v165, v165, v167
MAA 68,80,48
buffer_load_dwordx4 v19, s[20:23], s54 offen offset:1024 lds
MAA 68,84,68
TR 110,25,12960
v_mul_f32 v164, 0xba800000, v164
MAA 72,84,72
TR 112,25,1056
v_mul_f32 v165, 0x3a800000, v165
MAA 72,80,52
buffer_load_dwordx4 v20, s[20:23], s54 offen offset:2048 lds
s_waitcnt lgkmcnt(5)
MAA 156,88,56
TR 114,25,1568
s_add_u32 s54, s54, 196608
MAA 156,92,76
TR 116,25,13472
s_add_u32 m0, s59, 58240
MAA 104,92,72
TR 118,25,13984
s_xor_b32 s58, s87, 1966080
MAA 104,88,52
buffer_load_dwordx4 v5, s[24:27], s58 offen lds
MAA 100,88,48
TR 120,25,2080
v_fma_f32 v165, -v164, v164, v165
MAA 100,92,68
TR 122,25,2592
v_max_f32 v165, 0, v165
MAA 96,92,64
buffer_load_dwordx4 v6, s[24:27], s58 offen offset:1024 lds
MAA 96,88,44
TR 124,25,14496
s_add_u32 m0, s59, 0
MAA 92,88,40
TR 126,25,15008
s_xor_b32 s58, s87, 1048576
MAA 92,92,60
buffer_load_dwordx4 v5, s[24:27], s58 offen lds
MAA 124,60,100
RD 0,23,18432
v_add_f32 v165, 0x3727c5ac, v165
MAA 124,40,96
RD 4,23,19456
MAA 128,44,96
buffer_load_dwordx4 v6, s[24:27], s58 offen offset:1024 lds
MAA 128,64,100
RD 8,23,20736
MAA 132,68,100
RD 12,23,21760
MAA 132,48,96
RD 16,24,20480
MAA 136,52,96
v_rsq_f32 v166, v165
MAA 136,72,100
v_mov_b32 v165, v166
v_mul_f32 v166, 0x3e8293ee, v166
ds_write_b128 v7, v[164:167]
s_waitcnt vmcnt(16) lgkmcnt(6)
s_barrier
MAA 76,104,40
ds_write_b32 v17, v164
s_add_u32 m0, s59, 8320
MAA 76,108,60
ds_write_b32 v17, v165 offset:1024
s_xor_b32 s58, s87, 1179648
MAA 80,108,64
buffer_load_dwordx4 v5, s[24:27], s58 offen lds
MAA 80,104,44
RD 20,23,27648
MAA 84,104,48
RD 24,23,28672
MAA 84,108,68
RD 28,23,29952
MAA 88,108,72
buffer_load_dwordx4 v6, s[24:27], s58 offen offset:1024 lds
MAA 88,104,52
RD 32,23,30976
s_add_u32 m0, s59, 66560
MAA 160,112,56
RD 36,24,29696
s_xor_b32 s58, s87, 0
MAA 160,116,76
TR 80,25,24832
MAA 120,116,72
buffer_load_dwordx4 v5, s[24:27], s58 offen lds
MAA 120,112,52
TR 82,25,25344
MAA 116,112,48
TR 84,25,37248
MAA 116,116,68
TR 86,25,37760
MAA 112,116,64
buffer_load_dwordx4 v6, s[24:27], s58 offen offset:1024 lds
MAA 112,112,44
TR 88,25,25856
s_add_u32 m0, s59, 74880
MAA 108,112,40
TR 90,25,26368
s_xor_b32 s58, s87, 131072
MAA 108,116,60
TR 92,25,38272
MAA 140,60,124
buffer_load_dwordx4 v5, s[24:27], s58 offen lds
MAA 140,40,120
TR 94,25,38784
MAA 144,44,120
TR 96,25,26880
MAA 144,64,124
TR 98,25,27392
MAA 148,68,124
buffer_load_dwordx4 v6, s[24:27], s58 offen offset:1024 lds
MAA 148,48,120
TR 100,25,39296
MAA 152,52,120
TR 102,25,39808
MAA 152,72,124
s_waitcnt vmcnt(10) lgkmcnt(0)
s_barrier
MAA 156,88,16
TR 112,25,25888
s_add_u32 m0, s59, 83200
MAA 156,92,36
TR 114,25,26400
s_xor_b32 s58, s87, 262144
MAA 104,92,32
buffer_load_dwordx4 v5, s[24:27], s58 offen lds
MAA 104,88,12
TR 116,25,38304
MAA 100,88,8
TR 118,25,38816
MAA 100,92,28
TR 120,25,26912
MAA 96,92,24
buffer_load_dwordx4 v6, s[24:27], s58 offen offset:1024 lds
MAA 96,88,4
TR 122,25,27424
s_add_u32 m0, s59, 16640
MAA 92,88,0
TR 124,25,39328
s_xor_b32 s58, s87, 1310720
MAA 92,92,20
TR 126,25,39840
MAA 136,32,100
buffer_load_dwordx4 v5, s[24:27], s58 offen lds
MAA 136,12,96
TR 104,25,24864
MAA 72,80,12
TR 106,25,25376
MAA 72,84,32
TR 108,25,37280
MAA 68,84,28
buffer_load_dwordx4 v6, s[24:27], s58 offen offset:1024 lds
MAA 68,80,8
TR 110,25,37792
s_add_u32 m0, s59, 24960
MAA 64,80,4
RD 40,23,36864
s_xor_b32 s58, s87, 1441792
MAA 64,84,24
RD 44,23,37888
MAA 60,84,20
buffer_load_dwordx4 v5, s[24:27], s58 offen lds
MAA 60,80,0
RD 48,23,39168
s_waitcnt lgkmcnt(13)
MAA 160,112,16
RD 52,23,40192
s_waitcnt lgkmcnt(12)
MAA 160,116,36
RD 56,24,38912
MAA 120,116,32
buffer_load_dwordx4 v6, s[24:27], s58 offen offset:1024 lds
MAA 120,112,12
s_waitcnt lgkmcnt(5)
s_barrier
RD 60,23,46080
MAA 116,112,8
RD 64,23,47104
s_add_u32 m0, s59, 91520
MAA 116,116,28
RD 68,23,48384
s_xor_b32 s58, s87, 393216
MAA 112,116,24
RD 72,23,49408
MAA 112,112,4
RD 76,24,48128
MAA 108,112,0
TR 144,25,50688
MAA 108,116,20
TR 146,25,51200
MAA 152,32,124
TR 148,25,63104
MAA 152,12,120
TR 150,25,63616
MAA 88,104,12
TR 152,25,50720
MAA 88,108,32
TR 154,25,51232
MAA 84,108,28
TR 156,25,63136
MAA 84,104,8
TR 158,25,63648
MAA 80,104,4
TR 160,25,51712
MAA 80,108,24
TR 162,25,52224
MAA 76,108,20
TR 164,25,64128
MAA 76,104,0
TR 166,25,64640
s_waitcnt lgkmcnt(10)
MAA 156,144,56
TR 168,25,51744
s_waitcnt lgkmcnt(9)
MAA 156,148,76
TR 170,25,52256
MAA 104,148,72
TR 172,25,64160
MAA 104,144,52
TR 174,25,64672
MAA 100,144,48
TR 128,25,49664
MAA 100,148,68
TR 130,25,50176
MAA 96,148,64
TR 132,25,62080
MAA 96,144,44
TR 134,25,62592
MAA 92,144,40
TR 136,25,49696
MAA 92,148,60
TR 138,25,50208
s_waitcnt lgkmcnt(14)
MAA 160,156,76
TR 140,25,62112
MAA 160,152,56
TR 142,25,62624
MAA 120,152,52
ds_read_b128 v[232:235], v10 offset:768
MAA 120,156,72
ds_read_b128 v[236:239], v10 offset:2816
MAA 116,156,68
ds_read_b128 v[228:231], v10 offset:512
MAA 116,152,48
ds_read_b128 v[224:227], v10 offset:256
MAA 112,152,44
ds_read_b128 v[220:223], v10
MAA 112,156,64
buffer_load_dwordx4 v5, s[24:27], s58 offen lds
MAA 108,156,60
ds_read_b128 v[240:243], v11 offset:192
MAA 108,152,40
s_waitcnt lgkmcnt(6)
s_barrier
ds_read_b128 v[244:247], v11 offset:1216
MAA 136,52,160
ds_read_b128 v[18:21], v11 offset:128
MAA 136,72,164
buffer_load_dwordx4 v6, s[24:27], s58 offen offset:1024 lds
MAA 152,72,172
ds_read_b128 v[22:25], v11 offset:1152
s_add_u32 m0, s59, 99840
MAA 152,52,168
s_xor_b32 s58, s87, 524288
MAA 72,128,52
MAA 72,132,72
buffer_load_dwordx4 v5, s[24:27], s58 offen lds
MAA 68,132,68
MAA 68,128,48
MAA 64,128,44
MAA 64,132,64
buffer_load_dwordx4 v6, s[24:27], s58 offen offset:1024 lds
MAA 60,132,60
s_add_u32 m0, s59, 108160
s_xor_b32 s58, s87, 655360
MAA 60,128,40
MAA 88,136,52
MAA 88,140,72
buffer_load_dwordx4 v5, s[24:27], s58 offen lds
MAA 84,140,68
MAA 84,136,48
MAA 80,136,44
MAA 80,140,64
buffer_load_dwordx4 v6, s[24:27], s58 offen offset:1024 lds
MAA 76,140,60
s_add_u32 m0, s59, 33280
s_xor_b32 s58, s87, 1572864
MAA 76,136,40
s_waitcnt lgkmcnt(8)
v_pk_fma_f32 v[104:105], v[36:37], v[232:233], v[104:105] op_sel_hi:[1,0,1]
v_pk_mul_f32 v[104:105], v[104:105], v[232:233] op_sel:[0,1] op_sel_hi:[1,1]
v_cvt_pk_bf16_f32 v196, v104, v105
v_pk_fma_f32 v[106:107], v[38:39], v[232:233], v[106:107] op_sel_hi:[1,0,1]
v_pk_mul_f32 v[106:107], v[106:107], v[232:233] op_sel:[0,1] op_sel_hi:[1,1]
v_cvt_pk_bf16_f32 v197, v106, v107
v_pk_fma_f32 v[120:121], v[40:41], v[232:233], v[120:121] op_sel_hi:[1,0,1]
v_pk_mul_f32 v[120:121], v[120:121], v[232:233] op_sel:[0,1] op_sel_hi:[1,1]
v_cvt_pk_bf16_f32 v198, v120, v121
v_pk_fma_f32 v[122:123], v[42:43], v[232:233], v[122:123] op_sel_hi:[1,0,1]
v_pk_mul_f32 v[122:123], v[122:123], v[232:233] op_sel:[0,1] op_sel_hi:[1,1]
v_cvt_pk_bf16_f32 v199, v122, v123
s_waitcnt lgkmcnt(3)
v_pk_fma_f32 v[136:137], v[240:241], v[44:45], v[136:137] op_sel_hi:[1,0,1]
s_waitcnt lgkmcnt(2)
v_pk_mul_f32 v[136:137], v[136:137], v[244:245]
v_cvt_pk_bf16_f32 v208, v136, v137
v_pk_fma_f32 v[138:139], v[242:243], v[44:45], v[138:139] op_sel_hi:[1,0,1]
v_pk_mul_f32 v[138:139], v[138:139], v[246:247]
v_cvt_pk_bf16_f32 v209, v138, v139
v_pk_fma_f32 v[152:153], v[240:241], v[44:45], v[152:153] op_sel:[0,1,0] op_sel_hi:[1,1,1]
v_pk_mul_f32 v[152:153], v[152:153], v[244:245]
v_cvt_pk_bf16_f32 v218, v152, v153
v_pk_fma_f32 v[154:155], v[242:243], v[44:45], v[154:155] op_sel:[0,1,0] op_sel_hi:[1,1,1]
v_pk_mul_f32 v[154:155], v[154:155], v[246:247]
v_cvt_pk_bf16_f32 v219, v154, v155
ds_write_b128 v8, v[196:199]
ds_write_b64 v8, v[208:209] offset:1024
ds_write_b64 v8, v[218:219] offset:1032
v_pk_fma_f32 v[156:157], v[36:37], v[236:237], v[156:157] op_sel_hi:[1,0,1]
v_pk_mul_f32 v[156:157], v[156:157], v[236:237] op_sel:[0,1] op_sel_hi:[1,1]
v_cvt_pk_bf16_f32 v180, v156, v157
v_pk_fma_f32 v[158:159], v[38:39], v[236:237], v[158:159] op_sel_hi:[1,0,1]
v_pk_mul_f32 v[158:159], v[158:159], v[236:237] op_sel:[0,1] op_sel_hi:[1,1]
v_cvt_pk_bf16_f32 v181, v158, v159
v_pk_fma_f32 v[160:161], v[40:41], v[236:237], v[160:161] op_sel_hi:[1,0,1]
v_pk_mul_f32 v[160:161], v[160:161], v[236:237] op_sel:[0,1] op_sel_hi:[1,1]
v_cvt_pk_bf16_f32 v182, v160, v161
v_pk_fma_f32 v[162:163], v[42:43], v[236:237], v[162:163] op_sel_hi:[1,0,1]
v_pk_mul_f32 v[162:163], v[162:163], v[236:237] op_sel:[0,1] op_sel_hi:[1,1]
v_cvt_pk_bf16_f32 v183, v162, v163
v_pk_fma_f32 v[100:101], v[36:37], v[228:229], v[100:101] op_sel_hi:[1,0,1]
v_pk_mul_f32 v[100:101], v[100:101], v[228:229] op_sel:[0,1] op_sel_hi:[1,1]
v_cvt_pk_bf16_f32 v192, v100, v101
v_pk_fma_f32 v[102:103], v[38:39], v[228:229], v[102:103] op_sel_hi:[1,0,1]
v_pk_mul_f32 v[102:103], v[102:103], v[228:229] op_sel:[0,1] op_sel_hi:[1,1]
v_cvt_pk_bf16_f32 v193, v102, v103
v_pk_fma_f32 v[116:117], v[40:41], v[228:229], v[116:117] op_sel_hi:[1,0,1]
v_pk_mul_f32 v[116:117], v[116:117], v[228:229] op_sel:[0,1] op_sel_hi:[1,1]
v_cvt_pk_bf16_f32 v194, v116, v117
v_pk_fma_f32 v[118:119], v[42:43], v[228:229], v[118:119] op_sel_hi:[1,0,1]
v_pk_mul_f32 v[118:119], v[118:119], v[228:229] op_sel:[0,1] op_sel_hi:[1,1]
s_waitcnt lgkmcnt(0)
s_barrier
v_cvt_pk_bf16_f32 v195, v118, v119
v_pk_fma_f32 v[96:97], v[36:37], v[224:225], v[96:97] op_sel_hi:[1,0,1]
v_pk_mul_f32 v[96:97], v[96:97], v[224:225] op_sel:[0,1] op_sel_hi:[1,1]
v_cvt_pk_bf16_f32 v188, v96, v97
v_pk_fma_f32 v[98:99], v[38:39], v[224:225], v[98:99] op_sel_hi:[1,0,1]
v_pk_mul_f32 v[98:99], v[98:99], v[224:225] op_sel:[0,1] op_sel_hi:[1,1]
v_cvt_pk_bf16_f32 v189, v98, v99
v_pk_fma_f32 v[112:113], v[40:41], v[224:225], v[112:113] op_sel_hi:[1,0,1]
v_pk_mul_f32 v[112:113], v[112:113], v[224:225] op_sel:[0,1] op_sel_hi:[1,1]
v_cvt_pk_bf16_f32 v190, v112, v113
v_pk_fma_f32 v[114:115], v[42:43], v[224:225], v[114:115] op_sel_hi:[1,0,1]
v_pk_mul_f32 v[114:115], v[114:115], v[224:225] op_sel:[0,1] op_sel_hi:[1,1]
v_cvt_pk_bf16_f32 v191, v114, v115
v_pk_fma_f32 v[92:93], v[36:37], v[220:221], v[92:93] op_sel_hi:[1,0,1]
v_pk_mul_f32 v[92:93], v[92:93], v[220:221] op_sel:[0,1] op_sel_hi:[1,1]
v_cvt_pk_bf16_f32 v184, v92, v93
v_pk_fma_f32 v[94:95], v[38:39], v[220:221], v[94:95] op_sel_hi:[1,0,1]
v_pk_mul_f32 v[94:95], v[94:95], v[220:221] op_sel:[0,1] op_sel_hi:[1,1]
v_cvt_pk_bf16_f32 v185, v94, v95
v_pk_fma_f32 v[108:109], v[40:41], v[220:221], v[108:109] op_sel_hi:[1,0,1]
v_pk_mul_f32 v[108:109], v[108:109], v[220:221] op_sel:[0,1] op_sel_hi:[1,1]
v_cvt_pk_bf16_f32 v186, v108, v109
v_pk_fma_f32 v[110:111], v[42:43], v[220:221], v[110:111] op_sel_hi:[1,0,1]
v_pk_mul_f32 v[110:111], v[110:111], v[220:221] op_sel:[0,1] op_sel_hi:[1,1]
v_cvt_pk_bf16_f32 v187, v110, v111
v_pk_fma_f32 v[72:73], v[28:29], v[232:233], v[72:73] op_sel_hi:[1,0,1]
v_cvt_pk_bf16_f32 v176, v72, v73
v_pk_fma_f32 v[74:75], v[30:31], v[232:233], v[74:75] op_sel_hi:[1,0,1]
v_cvt_pk_bf16_f32 v177, v74, v75
v_pk_fma_f32 v[88:89], v[32:33], v[232:233], v[88:89] op_sel_hi:[1,0,1]
v_cvt_pk_bf16_f32 v178, v88, v89
v_pk_fma_f32 v[90:91], v[34:35], v[232:233], v[90:91] op_sel_hi:[1,0,1]
v_cvt_pk_bf16_f32 v179, v90, v91
v_pk_fma_f32 v[68:69], v[28:29], v[228:229], v[68:69] op_sel_hi:[1,0,1]
v_cvt_pk_bf16_f32 v172, v68, v69
v_pk_fma_f32 v[70:71], v[30:31], v[228:229], v[70:71] op_sel_hi:[1,0,1]
v_cvt_pk_bf16_f32 v173, v70, v71
v_pk_fma_f32 v[84:85], v[32:33], v[228:229], v[84:85] op_sel_hi:[1,0,1]
v_cvt_pk_bf16_f32 v174, v84, v85
v_pk_fma_f32 v[86:87], v[34:35], v[228:229], v[86:87] op_sel_hi:[1,0,1]
v_cvt_pk_bf16_f32 v175, v86, v87
v_pk_fma_f32 v[64:65], v[28:29], v[224:225], v[64:65] op_sel_hi:[1,0,1]
v_cvt_pk_bf16_f32 v168, v64, v65
v_pk_fma_f32 v[66:67], v[30:31], v[224:225], v[66:67] op_sel_hi:[1,0,1]
v_cvt_pk_bf16_f32 v169, v66, v67
v_pk_fma_f32 v[80:81], v[32:33], v[224:225], v[80:81] op_sel_hi:[1,0,1]
v_cvt_pk_bf16_f32 v170, v80, v81
v_pk_fma_f32 v[82:83], v[34:35], v[224:225], v[82:83] op_sel_hi:[1,0,1]
v_cvt_pk_bf16_f32 v171, v82, v83
v_pk_fma_f32 v[60:61], v[28:29], v[220:221], v[60:61] op_sel_hi:[1,0,1]
v_cvt_pk_bf16_f32 v164, v60, v61
v_pk_fma_f32 v[62:63], v[30:31], v[220:221], v[62:63] op_sel_hi:[1,0,1]
v_cvt_pk_bf16_f32 v165, v62, v63
v_pk_fma_f32 v[76:77], v[32:33], v[220:221], v[76:77] op_sel_hi:[1,0,1]
v_cvt_pk_bf16_f32 v166, v76, v77
v_pk_fma_f32 v[78:79], v[34:35], v[220:221], v[78:79] op_sel_hi:[1,0,1]
v_cvt_pk_bf16_f32 v167, v78, v79
s_nop 0
v_mfma_f32_16x16x32_bf16 v[120:123], v[196:199], v[176:179], v[50:53]
buffer_load_dwordx4 v5, s[24:27], s58 offen lds
v_mfma_f32_16x16x32_bf16 v[104:107], v[192:195], v[176:179], v[46:49]
ds_read_b64 v[200:201], v9 offset:1024
v_mfma_f32_16x16x32_bf16 v[116:119], v[192:195], v[172:175], v[50:53]
ds_read_b64 v[210:211], v9 offset:1032
v_mfma_f32_16x16x32_bf16 v[100:103], v[188:191], v[172:175], v[46:49]
ds_read_b128 v[240:243], v11 offset:64
v_mfma_f32_16x16x32_bf16 v[112:115], v[188:191], v[168:171], v[50:53]
buffer_load_dwordx4 v6, s[24:27], s58 offen offset:1024 lds
v_mfma_f32_16x16x32_bf16 v[96:99], v[184:187], v[168:171], v[46:49]
ds_read_b128 v[244:247], v11 offset:1088
s_add_u32 m0, s59, 41600
v_mfma_f32_16x16x32_bf16 v[108:111], v[184:187], v[164:167], v[50:53]
ds_read_b128 v[28:31], v11
s_xor_b32 s58, s87, 1703936
v_mfma_f32_16x16x32_bf16 v[92:95], v[180:183], v[164:167], v[54:57]
ds_read_b128 v[32:35], v11 offset:1024
v_max3_f32 v88, v104, v105, v106
MAA 132,8,96
buffer_load_dwordx4 v5, s[24:27], s58 offen lds
MAA 132,28,100
v_max3_f32 v89, v107, v120, v121
v_max3_f32 v88, v88, v122, v123
MAA 132,48,160
v_max_f32 v90, v88, v89
v_max_f32 v89, v88, v89
MAA 132,68,164
s_nop 0
v_permlane16_swap_b32 v90, v89
MAA 148,68,172
buffer_load_dwordx4 v6, s[24:27], s58 offen offset:1024 lds
MAA 148,48,168
s_add_u32 m0, s59, 49920
s_xor_b32 s58, s87, 1835008
v_max_f32 v88, v90, v89
MAA 148,28,124
v_max_f32 v89, v90, v89
v_max3_f32 v84, v100, v101, v102
MAA 148,8,120
v_permlane32_swap_b32 v88, v89
v_max3_f32 v85, v103, v116, v117
v_max_f32 v88, v88, v89
v_mul_f32 v88, v88, v234
v_max3_f32 v84, v84, v118, v119
v_max_f32 v86, v84, v85
v_max_f32 v85, v84, v85
v_max3_f32 v80, v96, v97, v98
v_max3_f32 v81, v99, v112, v113
v_permlane16_swap_b32 v86, v85
v_max3_f32 v80, v80, v114, v115
v_max_f32 v84, v86, v85
v_max_f32 v85, v86, v85
v_max_f32 v82, v80, v81
v_max_f32 v81, v80, v81
v_permlane32_swap_b32 v84, v85
v_max3_f32 v76, v92, v93, v94
v_max_f32 v84, v84, v85
v_mul_f32 v84, v84, v230
v_permlane16_swap_b32 v82, v81
v_max3_f32 v77, v95, v108, v109
v_max_f32 v80, v82, v81
v_max_f32 v81, v82, v81
v_max3_f32 v76, v76, v110, v111
v_max_f32 v78, v76, v77
v_permlane32_swap_b32 v80, v81
v_max_f32 v77, v76, v77
v_max_f32 v80, v80, v81
v_mul_f32 v80, v80, v226
v_permlane16_swap_b32 v78, v77
v_pk_fma_f32 v[104:105], v[104:105], v[234:235], v[88:89] op_sel_hi:[1,0,0] neg_lo:[0,0,1] neg_hi:[0,0,1]
v_max_f32 v76, v78, v77
v_max_f32 v77, v78, v77
v_pk_fma_f32 v[106:107], v[106:107], v[234:235], v[88:89] op_sel_hi:[1,0,0] neg_lo:[0,0,1] neg_hi:[0,0,1]
v_pk_fma_f32 v[120:121], v[120:121], v[234:235], v[88:89] op_sel_hi:[1,0,0] neg_lo:[0,0,1] neg_hi:[0,0,1]
v_permlane32_swap_b32 v76, v77
v_pk_fma_f32 v[122:123], v[122:123], v[234:235], v[88:89] op_sel_hi:[1,0,0] neg_lo:[0,0,1] neg_hi:[0,0,1]
v_max_f32 v76, v76, v77
v_mul_f32 v76, v76, v222
v_pk_fma_f32 v[100:101], v[100:101], v[230:231], v[84:85] op_sel_hi:[1,0,0] neg_lo:[0,0,1] neg_hi:[0,0,1]
v_pk_fma_f32 v[102:103], v[102:103], v[230:231], v[84:85] op_sel_hi:[1,0,0] neg_lo:[0,0,1] neg_hi:[0,0,1]
v_pk_fma_f32 v[116:117], v[116:117], v[230:231], v[84:85] op_sel_hi:[1,0,0] neg_lo:[0,0,1] neg_hi:[0,0,1]
v_pk_fma_f32 v[118:119], v[118:119], v[230:231], v[84:85] op_sel_hi:[1,0,0] neg_lo:[0,0,1] neg_hi:[0,0,1]
v_pk_fma_f32 v[96:97], v[96:97], v[226:227], v[80:81] op_sel_hi:[1,0,0] neg_lo:[0,0,1] neg_hi:[0,0,1]
v_pk_fma_f32 v[98:99], v[98:99], v[226:227], v[80:81] op_sel_hi:[1,0,0] neg_lo:[0,0,1] neg_hi:[0,0,1]
v_pk_fma_f32 v[112:113], v[112:113], v[226:227], v[80:81] op_sel_hi:[1,0,0] neg_lo:[0,0,1] neg_hi:[0,0,1]
v_pk_fma_f32 v[114:115], v[114:115], v[226:227], v[80:81] op_sel_hi:[1,0,0] neg_lo:[0,0,1] neg_hi:[0,0,1]
v_pk_fma_f32 v[92:93], v[92:93], v[222:223], v[76:77] op_sel_hi:[1,0,0] neg_lo:[0,0,1] neg_hi:[0,0,1]
v_pk_fma_f32 v[94:95], v[94:95], v[222:223], v[76:77] op_sel_hi:[1,0,0] neg_lo:[0,0,1] neg_hi:[0,0,1]
v_pk_fma_f32 v[108:109], v[108:109], v[222:223], v[76:77] op_sel_hi:[1,0,0] neg_lo:[0,0,1] neg_hi:[0,0,1]
v_pk_fma_f32 v[110:111], v[110:111], v[222:223], v[76:77] op_sel_hi:[1,0,0] neg_lo:[0,0,1] neg_hi:[0,0,1]
v_pk_fma_f32 v[132:133], v[18:19], v[44:45], v[132:133] op_sel_hi:[1,0,1]
v_pk_mul_f32 v[132:133], v[132:133], v[22:23]
v_pk_fma_f32 v[134:135], v[20:21], v[44:45], v[134:135] op_sel_hi:[1,0,1]
v_pk_mul_f32 v[134:135], v[134:135], v[24:25]
v_pk_fma_f32 v[148:149], v[18:19], v[44:45], v[148:149] op_sel:[0,1,0] op_sel_hi:[1,1,1]
v_pk_mul_f32 v[148:149], v[148:149], v[22:23]
v_pk_fma_f32 v[150:151], v[20:21], v[44:45], v[150:151] op_sel:[0,1,0] op_sel_hi:[1,1,1]
v_pk_mul_f32 v[150:151], v[150:151], v[24:25]
v_exp_f32 v104, v104
s_nop 0
MAA 128,4,96
buffer_load_dwordx4 v5, s[24:27], s58 offen lds
MAA 128,24,100
v_exp_f32 v105, v105
MAA 128,44,160
v_exp_f32 v106, v106
MAA 128,64,164
v_exp_f32 v107, v107
MAA 144,64,172
buffer_load_dwordx4 v6, s[24:27], s58 offen offset:1024 lds
MAA 144,44,168
s_add_u32 m0, s59, 116480
s_xor_b32 s58, s87, 786432
v_exp_f32 v120, v120
MAA 144,24,124
v_exp_f32 v121, v121
.Lpad25:
s_cbranch_execz .Lpad28
MAA 144,4,120
v_exp_f32 v122, v122
MAA 124,0,96
buffer_load_dwordx4 v5, s[24:27], s58 offen lds
MAA 124,20,100
v_exp_f32 v123, v123
MAA 124,40,160
v_exp_f32 v100, v100
MAA 124,60,164
v_exp_f32 v101, v101
MAA 140,60,172
buffer_load_dwordx4 v6, s[24:27], s58 offen offset:1024 lds
MAA 140,40,168
s_add_u32 m0, s59, 124800
s_xor_b32 s58, s87, 917504
v_exp_f32 v102, v102
MAA 140,20,124
v_exp_f32 v103, v103
MAA 140,0,120
v_cvt_pk_bf16_f32 v72, v104, v105
v_cvt_pk_bf16_f32 v73, v106, v107
v_cvt_pk_bf16_f32 v74, v120, v121
v_cvt_pk_bf16_f32 v75, v122, v123
v_exp_f32 v116, v116
v_exp_f32 v117, v117
v_exp_f32 v118, v118
v_exp_f32 v119, v119
v_cvt_pk_bf16_f32 v68, v100, v101
v_cvt_pk_bf16_f32 v69, v102, v103
v_cvt_pk_bf16_f32 v70, v116, v117
v_cvt_pk_bf16_f32 v71, v118, v119
v_exp_f32 v96, v96
v_exp_f32 v97, v97
v_exp_f32 v98, v98
v_exp_f32 v99, v99
v_exp_f32 v112, v112
v_exp_f32 v113, v113
v_exp_f32 v114, v114
v_exp_f32 v115, v115
v_cvt_pk_bf16_f32 v64, v96, v97
v_cvt_pk_bf16_f32 v65, v98, v99
v_cvt_pk_bf16_f32 v66, v112, v113
v_cvt_pk_bf16_f32 v67, v114, v115
v_cvt_pk_bf16_f32 v206, v132, v133
v_cvt_pk_bf16_f32 v207, v134, v135
v_cvt_pk_bf16_f32 v216, v148, v149
v_cvt_pk_bf16_f32 v217, v150, v151
s_waitcnt lgkmcnt(3)
v_pk_fma_f32 v[128:129], v[240:241], v[44:45], v[128:129] op_sel_hi:[1,0,1]
s_waitcnt lgkmcnt(2)
v_pk_mul_f32 v[128:129], v[128:129], v[244:245]
v_cvt_pk_bf16_f32 v204, v128, v129
v_pk_fma_f32 v[130:131], v[242:243], v[44:45], v[130:131] op_sel_hi:[1,0,1]
v_pk_mul_f32 v[130:131], v[130:131], v[246:247]
v_cvt_pk_bf16_f32 v205, v130, v131
v_pk_fma_f32 v[144:145], v[240:241], v[44:45], v[144:145] op_sel:[0,1,0] op_sel_hi:[1,1,1]
v_pk_mul_f32 v[144:145], v[144:145], v[244:245]
v_cvt_pk_bf16_f32 v214, v144, v145
v_pk_fma_f32 v[146:147], v[242:243], v[44:45], v[146:147] op_sel:[0,1,0] op_sel_hi:[1,1,1]
v_pk_mul_f32 v[146:147], v[146:147], v[246:247]
v_cvt_pk_bf16_f32 v215, v146, v147
s_waitcnt lgkmcnt(1)
v_pk_fma_f32 v[124:125], v[28:29], v[44:45], v[124:125] op_sel_hi:[1,0,1]
s_waitcnt lgkmcnt(0)
v_pk_mul_f32 v[124:125], v[124:125], v[32:33]
v_cvt_pk_bf16_f32 v202, v124, v125
v_pk_fma_f32 v[126:127], v[30:31], v[44:45], v[126:127] op_sel_hi:[1,0,1]
v_pk_mul_f32 v[126:127], v[126:127], v[34:35]
v_cvt_pk_bf16_f32 v203, v126, v127
v_pk_fma_f32 v[140:141], v[28:29], v[44:45], v[140:141] op_sel:[0,1,0] op_sel_hi:[1,1,1]
v_pk_mul_f32 v[140:141], v[140:141], v[32:33]
v_cvt_pk_bf16_f32 v212, v140, v141
v_pk_fma_f32 v[142:143], v[30:31], v[44:45], v[142:143] op_sel:[0,1,0] op_sel_hi:[1,1,1]
v_pk_mul_f32 v[142:143], v[142:143], v[34:35]
v_cvt_pk_bf16_f32 v213, v142, v143
s_nop 0
v_mfma_f32_16x16x32_bf16 v[88:91], v[248:251], v[72:75], 0
buffer_load_dwordx4 v5, s[24:27], s58 offen lds
v_mfma_f32_16x16x32_bf16 v[104:107], v[206:209], v[72:75], 0
v_exp_f32 v92, v92
v_mfma_f32_16x16x32_bf16 v[120:123], v[216:219], v[72:75], 0
v_exp_f32 v93, v93
v_mfma_f32_16x16x32_bf16 v[84:87], v[248:251], v[68:71], 0
v_exp_f32 v94, v94
v_mfma_f32_16x16x32_bf16 v[100:103], v[204:207], v[68:71], 0
buffer_load_dwordx4 v6, s[24:27], s58 offen offset:1024 lds
v_mfma_f32_16x16x32_bf16 v[116:119], v[214:217], v[68:71], 0
v_exp_f32 v95, v95
v_mfma_f32_16x16x32_bf16 v[80:83], v[248:251], v[64:67], 0
v_exp_f32 v108, v108
v_mfma_f32_16x16x32_bf16 v[96:99], v[202:205], v[64:67], 0
v_exp_f32 v109, v109
v_mfma_f32_16x16x32_bf16 v[112:115], v[212:215], v[64:67], 0
v_exp_f32 v110, v110
v_cvt_pk_bf16_f32 v60, v92, v93
v_cvt_pk_bf16_f32 v61, v94, v95
v_cvt_pk_bf16_f32 v62, v108, v109
v_rcp_f32 v88, v88
v_rcp_f32 v84, v84
v_rcp_f32 v80, v80
v_pk_mul_f32 v[104:105], v[104:105], v[88:89] op_sel_hi:[1,0]
v_pk_mul_f32 v[106:107], v[106:107], v[88:89] op_sel_hi:[1,0]
v_pk_mul_f32 v[120:121], v[120:121], v[88:89] op_sel_hi:[1,0]
v_pk_mul_f32 v[122:123], v[122:123], v[88:89] op_sel_hi:[1,0]
v_cvt_pk_bf16_f32 v176, v104, v105
v_cvt_pk_bf16_f32 v177, v106, v107
v_cvt_pk_bf16_f32 v178, v120, v121
v_cvt_pk_bf16_f32 v179, v122, v123
buffer_store_dwordx4 v[176:179], v4, s[16:19], s74 offen offset:3072 sc1
v_pk_mul_f32 v[100:101], v[100:101], v[84:85] op_sel_hi:[1,0]
v_pk_mul_f32 v[102:103], v[102:103], v[84:85] op_sel_hi:[1,0]
v_pk_mul_f32 v[116:117], v[116:117], v[84:85] op_sel_hi:[1,0]
v_pk_mul_f32 v[118:119], v[118:119], v[84:85] op_sel_hi:[1,0]
v_cvt_pk_bf16_f32 v172, v100, v101
v_cvt_pk_bf16_f32 v173, v102, v103
v_cvt_pk_bf16_f32 v174, v116, v117
v_cvt_pk_bf16_f32 v175, v118, v119
buffer_store_dwordx4 v[172:175], v4, s[16:19], s74 offen offset:2048 sc1
v_pk_mul_f32 v[96:97], v[96:97], v[80:81] op_sel_hi:[1,0]
v_pk_mul_f32 v[98:99], v[98:99], v[80:81] op_sel_hi:[1,0]
v_pk_mul_f32 v[112:113], v[112:113], v[80:81] op_sel_hi:[1,0]
v_pk_mul_f32 v[114:115], v[114:115], v[80:81] op_sel_hi:[1,0]
v_cvt_pk_bf16_f32 v168, v96, v97
v_cvt_pk_bf16_f32 v169, v98, v99
v_cvt_pk_bf16_f32 v170, v112, v113
v_cvt_pk_bf16_f32 v171, v114, v115
buffer_store_dwordx4 v[168:171], v4, s[16:19], s74 offen offset:1024 sc1
v_exp_f32 v111, v111
s_nop 0
v_cvt_pk_bf16_f32 v63, v110, v111
s_nop 1
v_mfma_f32_16x16x32_bf16 v[76:79], v[248:251], v[60:63], 0
v_mfma_f32_16x16x32_bf16 v[92:95], v[200:203], v[60:63], 0
v_mfma_f32_16x16x32_bf16 v[108:111], v[210:213], v[60:63], 0
s_nop 5
v_rcp_f32 v76, v76
s_nop 0
v_pk_mul_f32 v[92:93], v[92:93], v[76:77] op_sel_hi:[1,0]
v_cvt_pk_bf16_f32 v164, v92, v93
v_pk_mul_f32 v[94:95], v[94:95], v[76:77] op_sel_hi:[1,0]
v_cvt_pk_bf16_f32 v165, v94, v95
v_pk_mul_f32 v[108:109], v[108:109], v[76:77] op_sel_hi:[1,0]
v_cvt_pk_bf16_f32 v166, v108, v109
v_pk_mul_f32 v[110:111], v[110:111], v[76:77] op_sel_hi:[1,0]
v_cvt_pk_bf16_f32 v167, v110, v111
buffer_store_dwordx4 v[164:167], v4, s[16:19], s74 offen sc1
s_nop 1
s_branch .Lqkve56
.Lsp50:
s_mov_b32 s15, 0
.Lsp50l:
v_mov_b32 v25, 0
buffer_atomic_add v25, v22, s[16:19], s73 offen sc0
s_add_u32 s15, s15, 1
s_cmp_gt_u32 s15, 100000
s_waitcnt vmcnt(0)
s_cbranch_scc1 .Lsp50b
v_cmp_gt_u32 vcc, v23, v25
s_nop 0
s_cbranch_vccnz .Lsp50l
s_branch .Lsp50b
.Lxs51:
s_mov_b32 s15, 0
.Lxs51l:
v_mov_b32 v15, 0
buffer_atomic_add v15, v12, s[16:19], s70 offen sc0
s_add_u32 s15, s15, 1
s_cmp_gt_u32 s15, 100000
s_waitcnt vmcnt(0)
s_cbranch_scc1 .Lxs51b
v_cmp_ne_u32 vcc, 0, v15
s_nop 0
s_cbranch_vccz .Lxs51l
s_branch .Lxs51b
.p2align 12
.Lqkv55:
.Lpad26:
s_cbranch_execz .Lpad29
s_add_u32 m0, s55, 36864
s_nop 0
buffer_load_dwordx4 v21, s[16:19], s52 offen sc1 lds
buffer_load_dwordx4 v21, s[16:19], s52 offen offset:1024 sc1 lds
buffer_load_dword v22, s[16:19], s52 offen offset:2048 sc1 lds
s_add_u32 s52, s52, 131072
s_add_u32 m0, s55, 46080
s_nop 0
buffer_load_dwordx4 v21, s[16:19], s52 offen sc1 lds
buffer_load_dwordx4 v21, s[16:19], s52 offen offset:1024 sc1 lds
buffer_load_dword v22, s[16:19], s52 offen offset:2048 sc1 lds
s_add_u32 s52, s52, 131072
s_add_u32 m0, s55, 0
s_nop 0
buffer_load_dwordx4 v21, s[16:19], s52 offen sc1 lds
buffer_load_dwordx4 v21, s[16:19], s52 offen offset:1024 sc1 lds
buffer_load_dword v22, s[16:19], s52 offen offset:2048 sc1 lds
s_add_u32 s52, s52, 131072
s_add_u32 m0, s55, 9216
s_nop 0
buffer_load_dwordx4 v21, s[16:19], s52 offen sc1 lds
buffer_load_dwordx4 v21, s[16:19], s52 offen offset:1024 sc1 lds
buffer_load_dword v22, s[16:19], s52 offen offset:2048 sc1 lds
s_add_u32 s52, s52, 131072
s_add_u32 m0, s55, 18432
s_nop 0
buffer_load_dwordx4 v21, s[16:19], s52 offen sc1 lds
buffer_load_dwordx4 v21, s[16:19], s52 offen offset:1024 sc1 lds
buffer_load_dword v22, s[16:19], s52 offen offset:2048 sc1 lds
s_add_u32 s52, s52, 131072
s_add_u32 m0, s55, 27648
s_nop 0
buffer_load_dwordx4 v21, s[16:19], s52 offen sc1 lds
buffer_load_dwordx4 v21, s[16:19], s52 offen offset:1024 sc1 lds
buffer_load_dword v22, s[16:19], s52 offen offset:2048 sc1 lds
s_add_u32 s52, s52, 131072
s_waitcnt vmcnt(12)
s_barrier
RD 0,23,36864
RD 4,23,37888
RD 8,23,39168
RD 12,23,40192
RD 16,24,38912
RD 20,23,46080
RD 24,23,47104
RD 28,23,48384
RD 32,23,49408
RD 36,24,48128
s_waitcnt lgkmcnt(0)
s_mov_b32 s15, -2
.p2align 6
.Lk58:
s_waitcnt vmcnt(9) lgkmcnt(8)
s_barrier
MAA 60,80,0
TR 104,25,49696
s_add_u32 m0, s56, 104832
MAA 60,84,20
buffer_load_dwordx4 v18, s[20:23], s54 offen lds
MAA 64,84,24
TR 106,25,50208
v_add_f32 v164, v164, v168
MAA 64,80,4
TR 108,25,62112
MAA 68,80,8
TR 110,25,62624
MAA 68,84,28
buffer_load_dwordx4 v19, s[20:23], s54 offen offset:1024 lds
MAA 72,84,32
TR 112,25,50720
v_add_f32 v165, v165, v169
MAA 72,80,12
TR 114,25,51232
s_waitcnt lgkmcnt(6)
MAA 104,88,12
TR 116,25,63136
MAA 104,92,32
buffer_load_dwordx4 v20, s[20:23], s54 offen offset:2048 lds
MAA 100,92,28
s_add_u32 s54, s54, 196608
s_add_u32 m0, s55, 36864
MAA 100,88,8
buffer_load_dwordx4 v21, s[16:19], s52 offen sc1 lds
MAA 96,88,4
TR 118,25,63648
MAA 96,92,24
TR 120,25,51744
v_add_f32 v166, v166, v170
MAA 92,92,20
TR 122,25,52256
MAA 92,88,0
buffer_load_dwordx4 v21, s[16:19], s52 offen offset:1024 sc1 lds
MAA 124,0,96
TR 124,25,64160
MAA 124,20,100
TR 126,25,64672
v_add_f32 v167, v167, v171
MAA 128,24,100
ds_read_b128 a[40:43], v23
MAA 128,4,96
buffer_load_dword v22, s[16:19], s52 offen offset:2048 sc1 lds
MAA 132,8,96
RD 44,23,1024
s_add_u32 s52, s52, 131072
MAA 132,28,100
buffer_load_dword v27, v14, s[20:23], s44 offen
MAA 136,32,100
RD 48,23,2304
s_add_u32 s44, s44, 1572864
MAA 136,12,96
RD 52,23,3328
MAA 156,16,96
RD 56,24,2048
MAA 156,36,100
s_waitcnt vmcnt(13) lgkmcnt(5)
s_barrier
MAA 76,104,0
RD 60,23,9216
s_add_u32 m0, s56, 117248
MAA 76,108,20
buffer_load_dwordx4 v18, s[20:23], s54 offen lds
MAA 80,108,24
RD 64,23,10240
MAA 80,104,4
RD 68,23,11520
MAA 84,104,8
RD 72,23,12544
MAA 84,108,28
buffer_load_dwordx4 v19, s[20:23], s54 offen offset:1024 lds
MAA 88,108,32
RD 76,24,11264
MAA 88,104,12
buffer_load_dwordx4 v20, s[20:23], s54 offen offset:2048 lds
MAA 120,112,12
ds_read_b64_tr_b16 a[80:81], v25
s_add_u32 s54, s54, 196608
MAA 120,116,32
TR 82,25,512
MAA 116,116,28
TR 84,25,12416
s_add_u32 m0, s55, 46080
MAA 116,112,8
buffer_load_dwordx4 v21, s[16:19], s52 offen sc1 lds
MAA 112,112,4
TR 86,25,12928
MAA 112,116,24
TR 88,25,1024
MAA 108,116,20
TR 90,25,1536
MAA 108,112,0
buffer_load_dwordx4 v21, s[16:19], s52 offen offset:1024 sc1 lds
MAA 140,0,120
TR 92,25,13440
MAA 140,20,124
TR 94,25,13952
MAA 144,24,124
TR 96,25,2048
MAA 144,4,120
buffer_load_dword v22, s[16:19], s52 offen offset:2048 sc1 lds
MAA 148,8,120
TR 98,25,2560
s_add_u32 s52, s52, 131072
MAA 148,28,124
buffer_load_dwordx4 v[168:171], v26, s[16:19], s75 offen sc1
MAA 152,32,124
TR 100,25,14464
MAA 152,12,120
TR 102,25,14976
MAA 160,16,120
MAA 160,36,124
s_waitcnt vmcnt(17) lgkmcnt(8)
s_barrier
MAA 60,80,40
TR 104,25,32
v_add_f32 v164, v164, v172
MAA 60,84,60
TR 106,25,544
MAA 64,84,64
TR 108,25,12448
s_add_u32 m0, s56, 129664
MAA 64,80,44
buffer_load_dwordx4 v18, s[20:23], s54 offen lds
MAA 68,80,48
TR 110,25,12960
MAA 68,84,68
TR 112,25,1056
MAA 72,84,72
TR 114,25,1568
v_add_f32 v165, v165, v173
MAA 72,80,52
TR 116,25,13472
s_waitcnt lgkmcnt(7)
MAA 104,88,52
TR 118,25,13984
MAA 104,92,72
buffer_load_dwordx4 v19, s[20:23], s54 offen offset:1024 lds
MAA 100,92,68
TR 120,25,2080
MAA 100,88,48
buffer_load_dwordx4 v20, s[20:23], s54 offen offset:2048 lds
MAA 96,88,44
s_add_u32 s54, s54, 196608
MAA 96,92,64
TR 122,25,2592
v_add_f32 v166, v166, v174
MAA 92,92,60
TR 124,25,14496
s_add_u32 m0, s55, 0
MAA 92,88,40
buffer_load_dwordx4 v21, s[16:19], s52 offen sc1 lds
MAA 124,40,96
TR 126,25,15008
MAA 124,60,100
RD 0,23,18432
MAA 128,64,100
RD 4,23,19456
MAA 128,44,96
buffer_load_dwordx4 v21, s[16:19], s52 offen offset:1024 sc1 lds
MAA 132,48,96
RD 8,23,20736
v_add_f32 v167, v167, v175
MAA 132,68,100
RD 12,23,21760
MAA 136,72,100
RD 16,24,20480
MAA 136,52,96
buffer_load_dword v22, s[16:19], s52 offen offset:2048 sc1 lds
MAA 156,56,96
s_add_u32 s52, s52, 131072
MAA 156,76,100
s_waitcnt vmcnt(17) lgkmcnt(5)
s_barrier
MAA 76,104,40
RD 20,23,27648
s_add_u32 m0, s56, 67584
MAA 76,108,60
buffer_load_dwordx4 v18, s[20:23], s54 offen lds
MAA 80,108,64
RD 24,23,28672
MAA 80,104,44
RD 28,23,29952
MAA 84,104,48
RD 32,23,30976
MAA 84,108,68
buffer_load_dwordx4 v19, s[20:23], s54 offen offset:1024 lds
MAA 88,108,72
RD 36,24,29696
MAA 88,104,52
buffer_load_dwordx4 v20, s[20:23], s54 offen offset:2048 lds
MAA 120,112,52
TR 80,25,24832
s_add_u32 s54, s54, 196608
MAA 120,116,72
TR 82,25,25344
MAA 116,116,68
TR 84,25,37248
s_add_u32 m0, s55, 9216
MAA 116,112,48
buffer_load_dwordx4 v21, s[16:19], s52 offen sc1 lds
MAA 112,112,44
TR 86,25,37760
MAA 112,116,64
TR 88,25,25856
MAA 108,116,60
TR 90,25,26368
MAA 108,112,40
buffer_load_dwordx4 v21, s[16:19], s52 offen offset:1024 sc1 lds
MAA 140,40,120
TR 92,25,38272
MAA 140,60,124
TR 94,25,38784
MAA 144,64,124
TR 96,25,26880
MAA 144,44,120
buffer_load_dword v22, s[16:19], s52 offen offset:2048 sc1 lds
MAA 148,48,120
TR 98,25,27392
s_add_u32 s52, s52, 131072
MAA 148,68,124
buffer_load_dwordx4 v[172:175], v26, s[16:19], s75 offen offset:1024 sc1
MAA 152,72,124
TR 100,25,39296
s_add_u32 s75, s75, 2048
MAA 152,52,120
TR 102,25,39808
MAA 160,56,120
MAA 160,76,124
s_waitcnt vmcnt(21) lgkmcnt(8)
s_barrier
MAA 60,80,0
TR 104,25,24864
MAA 60,84,20
TR 106,25,25376
MAA 64,84,24
TR 108,25,37280
s_add_u32 m0, s56, 80000
MAA 64,80,4
buffer_load_dwordx4 v18, s[20:23], s54 offen lds
MAA 68,80,8
TR 110,25,37792
MAA 68,84,28
TR 112,25,25888
MAA 72,84,32
TR 114,25,26400
MAA 72,80,12
TR 116,25,38304
s_waitcnt lgkmcnt(7)
MAA 104,88,12
TR 118,25,38816
MAA 104,92,32
buffer_load_dwordx4 v19, s[20:23], s54 offen offset:1024 lds
MAA 100,92,28
TR 120,25,26912
MAA 100,88,8
buffer_load_dwordx4 v20, s[20:23], s54 offen offset:2048 lds
MAA 96,88,4
s_add_u32 s54, s54, 196608
MAA 96,92,24
TR 122,25,27424
MAA 92,92,20
TR 124,25,39328
s_add_u32 m0, s55, 18432
MAA 92,88,0
buffer_load_dwordx4 v21, s[16:19], s52 offen sc1 lds
MAA 124,0,96
TR 126,25,39840
MAA 124,20,100
RD 40,23,36864
MAA 128,24,100
RD 44,23,37888
MAA 128,4,96
buffer_load_dwordx4 v21, s[16:19], s52 offen offset:1024 sc1 lds
MAA 132,8,96
RD 48,23,39168
MAA 132,28,100
RD 52,23,40192
MAA 136,32,100
RD 56,24,38912
MAA 136,12,96
buffer_load_dword v22, s[16:19], s52 offen offset:2048 sc1 lds
MAA 156,16,96
s_add_u32 s52, s52, 131072
MAA 156,36,100
s_waitcnt vmcnt(16) lgkmcnt(5)
s_barrier
MAA 76,104,0
RD 60,23,46080
MAA 76,108,20
RD 64,23,47104
MAA 80,108,24
RD 68,23,48384
s_add_u32 m0, s56, 92416
MAA 80,104,4
buffer_load_dwordx4 v18, s[20:23], s54 offen lds
MAA 84,104,8
RD 72,23,49408
MAA 84,108,28
RD 76,24,48128
MAA 88,108,32
TR 80,25,49664
MAA 88,104,12
buffer_load_dwordx4 v19, s[20:23], s54 offen offset:1024 lds
MAA 120,112,12
TR 82,25,50176
MAA 120,116,32
TR 84,25,62080
MAA 116,116,28
TR 86,25,62592
MAA 116,112,8
buffer_load_dwordx4 v20, s[20:23], s54 offen offset:2048 lds
MAA 112,112,4
s_add_u32 s54, s54, 196608
MAA 112,116,24
TR 88,25,50688
MAA 108,116,20
TR 90,25,51200
s_add_u32 m0, s55, 27648
MAA 108,112,0
buffer_load_dwordx4 v21, s[16:19], s52 offen sc1 lds
MAA 140,0,120
TR 92,25,63104
MAA 140,20,124
TR 94,25,63616
MAA 144,24,124
TR 96,25,51712
MAA 144,4,120
buffer_load_dwordx4 v21, s[16:19], s52 offen offset:1024 sc1 lds
MAA 148,8,120
TR 98,25,52224
MAA 148,28,124
TR 100,25,64128
MAA 152,32,124
TR 102,25,64640
MAA 152,12,120
buffer_load_dword v22, s[16:19], s52 offen offset:2048 sc1 lds
MAA 160,16,120
s_add_u32 s52, s52, 131072
MAA 160,36,124
s_waitcnt vmcnt(19) lgkmcnt(8)
s_barrier
MAA 60,80,40
TR 104,25,49696
s_add_u32 m0, s56, 104832
MAA 60,84,60
buffer_load_dwordx4 v18, s[20:23], s54 offen lds
MAA 64,84,64
TR 106,25,50208
v_add_f32 v164, v164, v168
MAA 64,80,44
TR 108,25,62112
MAA 68,80,48
TR 110,25,62624
MAA 68,84,68
buffer_load_dwordx4 v19, s[20:23], s54 offen offset:1024 lds
MAA 72,84,72
TR 112,25,50720
v_add_f32 v165, v165, v169
MAA 72,80,52
TR 114,25,51232
s_waitcnt lgkmcnt(6)
MAA 104,88,52
TR 116,25,63136
MAA 104,92,72
buffer_load_dwordx4 v20, s[20:23], s54 offen offset:2048 lds
MAA 100,92,68
s_add_u32 s54, s54, 196608
s_add_u32 m0, s55, 36864
MAA 100,88,48
buffer_load_dwordx4 v21, s[16:19], s52 offen sc1 lds
MAA 96,88,44
TR 118,25,63648
MAA 96,92,64
TR 120,25,51744
v_add_f32 v166, v166, v170
MAA 92,92,60
TR 122,25,52256
MAA 92,88,40
buffer_load_dwordx4 v21, s[16:19], s52 offen offset:1024 sc1 lds
MAA 124,40,96
TR 124,25,64160
MAA 124,60,100
TR 126,25,64672
v_add_f32 v167, v167, v171
MAA 128,64,100
ds_read_b128 a[0:3], v23
MAA 128,44,96
buffer_load_dword v22, s[16:19], s52 offen offset:2048 sc1 lds
MAA 132,48,96
RD 4,23,1024
s_add_u32 s52, s52, 131072
MAA 132,68,100
buffer_load_dword v27, v14, s[20:23], s44 offen
MAA 136,72,100
RD 8,23,2304
s_add_u32 s44, s44, 1572864
MAA 136,52,96
RD 12,23,3328
MAA 156,56,96
RD 16,24,2048
MAA 156,76,100
s_waitcnt vmcnt(16) lgkmcnt(5)
s_barrier
MAA 76,104,40
RD 20,23,9216
s_add_u32 m0, s56, 117248
MAA 76,108,60
buffer_load_dwordx4 v18, s[20:23], s54 offen lds
MAA 80,108,64
RD 24,23,10240
MAA 80,104,44
RD 28,23,11520
MAA 84,104,48
RD 32,23,12544
MAA 84,108,68
buffer_load_dwordx4 v19, s[20:23], s54 offen offset:1024 lds
MAA 88,108,72
RD 36,24,11264
MAA 88,104,52
buffer_load_dwordx4 v20, s[20:23], s54 offen offset:2048 lds
MAA 120,112,52
ds_read_b64_tr_b16 a[80:81], v25
s_add_u32 s54, s54, 196608
MAA 120,116,72
TR 82,25,512
MAA 116,116,68
TR 84,25,12416
s_add_u32 m0, s55, 46080
MAA 116,112,48
buffer_load_dwordx4 v21, s[16:19], s52 offen sc1 lds
MAA 112,112,44
TR 86,25,12928
MAA 112,116,64
TR 88,25,1024
MAA 108,116,60
TR 90,25,1536
MAA 108,112,40
buffer_load_dwordx4 v21, s[16:19], s52 offen offset:1024 sc1 lds
MAA 140,40,120
TR 92,25,13440
MAA 140,60,124
TR 94,25,13952
MAA 144,64,124
TR 96,25,2048
MAA 144,44,120
buffer_load_dword v22, s[16:19], s52 offen offset:2048 sc1 lds
MAA 148,48,120
TR 98,25,2560
s_add_u32 s52, s52, 131072
MAA 148,68,124
buffer_load_dwordx4 v[168:171], v26, s[16:19], s75 offen sc1
MAA 152,72,124
TR 100,25,14464
MAA 152,52,120
TR 102,25,14976
MAA 160,56,120
MAA 160,76,124
s_waitcnt vmcnt(20) lgkmcnt(8)
s_barrier
MAA 60,80,0
TR 104,25,32
v_add_f32 v164, v164, v172
MAA 60,84,20
TR 106,25,544
MAA 64,84,24
TR 108,25,12448
s_add_u32 m0, s56, 129664
MAA 64,80,4
buffer_load_dwordx4 v18, s[20:23], s54 offen lds
MAA 68,80,8
TR 110,25,12960
MAA 68,84,28
TR 112,25,1056
MAA 72,84,32
TR 114,25,1568
.Lpad27:
s_cbranch_execz .Lnopoll53r
v_add_f32 v165, v165, v173
MAA 72,80,12
TR 116,25,13472
s_waitcnt lgkmcnt(7)
MAA 104,88,12
TR 118,25,13984
MAA 104,92,32
buffer_load_dwordx4 v19, s[20:23], s54 offen offset:1024 lds
MAA 100,92,28
TR 120,25,2080
MAA 100,88,8
buffer_load_dwordx4 v20, s[20:23], s54 offen offset:2048 lds
MAA 96,88,4
s_add_u32 s54, s54, 196608
MAA 96,92,24
TR 122,25,2592
v_add_f32 v166, v166, v174
MAA 92,92,20
TR 124,25,14496
s_add_u32 m0, s55, 0
MAA 92,88,0
buffer_load_dwordx4 v21, s[16:19], s52 offen sc1 lds
MAA 124,0,96
TR 126,25,15008
MAA 124,20,100
RD 40,23,18432
MAA 128,24,100
RD 44,23,19456
MAA 128,4,96
buffer_load_dwordx4 v21, s[16:19], s52 offen offset:1024 sc1 lds
MAA 132,8,96
RD 48,23,20736
v_add_f32 v167, v167, v175
MAA 132,28,100
RD 52,23,21760
MAA 136,32,100
RD 56,24,20480
MAA 136,12,96
buffer_load_dword v22, s[16:19], s52 offen offset:2048 sc1 lds
MAA 156,16,96
s_add_u32 s52, s52, 131072
MAA 156,36,100
s_waitcnt vmcnt(17) lgkmcnt(5)
s_barrier
MAA 76,104,0
RD 60,23,27648
s_add_u32 m0, s56, 67584
MAA 76,108,20
buffer_load_dwordx4 v18, s[20:23], s54 offen lds
MAA 80,108,24
RD 64,23,28672
MAA 80,104,4
RD 68,23,29952
MAA 84,104,8
RD 72,23,30976
MAA 84,108,28
buffer_load_dwordx4 v19, s[20:23], s54 offen offset:1024 lds
MAA 88,108,32
RD 76,24,29696
MAA 88,104,12
buffer_load_dwordx4 v20, s[20:23], s54 offen offset:2048 lds
MAA 120,112,12
TR 80,25,24832
s_add_u32 s54, s54, 196608
MAA 120,116,32
TR 82,25,25344
MAA 116,116,28
TR 84,25,37248
s_add_u32 m0, s55, 9216
MAA 116,112,8
buffer_load_dwordx4 v21, s[16:19], s52 offen sc1 lds
MAA 112,112,4
TR 86,25,37760
MAA 112,116,24
TR 88,25,25856
MAA 108,116,20
TR 90,25,26368
MAA 108,112,0
buffer_load_dwordx4 v21, s[16:19], s52 offen offset:1024 sc1 lds
MAA 140,0,120
TR 92,25,38272
MAA 140,20,124
TR 94,25,38784
MAA 144,24,124
TR 96,25,26880
MAA 144,4,120
buffer_load_dword v22, s[16:19], s52 offen offset:2048 sc1 lds
MAA 148,8,120
TR 98,25,27392
s_add_u32 s52, s52, 131072
MAA 148,28,124
buffer_load_dwordx4 v[172:175], v26, s[16:19], s75 offen offset:1024 sc1
MAA 152,32,124
TR 100,25,39296
s_add_u32 s75, s75, 2048
MAA 152,12,120
TR 102,25,39808
MAA 160,16,120
MAA 160,36,124
s_waitcnt vmcnt(21) lgkmcnt(8)
s_barrier
MAA 60,80,40
TR 104,25,24864
MAA 60,84,60
TR 106,25,25376
MAA 64,84,64
TR 108,25,37280
s_add_u32 m0, s56, 80000
MAA 64,80,44
buffer_load_dwordx4 v18, s[20:23], s54 offen lds
MAA 68,80,48
TR 110,25,37792
MAA 68,84,68
TR 112,25,25888
MAA 72,84,72
TR 114,25,26400
MAA 72,80,52
TR 116,25,38304
s_waitcnt lgkmcnt(7)
MAA 104,88,52
TR 118,25,38816
MAA 104,92,72
buffer_load_dwordx4 v19, s[20:23], s54 offen offset:1024 lds
MAA 100,92,68
TR 120,25,26912
MAA 100,88,48
buffer_load_dwordx4 v20, s[20:23], s54 offen offset:2048 lds
MAA 96,88,44
s_add_u32 s54, s54, 196608
MAA 96,92,64
TR 122,25,27424
MAA 92,92,60
TR 124,25,39328
s_add_u32 m0, s55, 18432
MAA 92,88,40
buffer_load_dwordx4 v21, s[16:19], s52 offen sc1 lds
MAA 124,40,96
TR 126,25,39840
MAA 124,60,100
RD 0,23,36864
MAA 128,64,100
RD 4,23,37888
MAA 128,44,96
buffer_load_dwordx4 v21, s[16:19], s52 offen offset:1024 sc1 lds
MAA 132,48,96
RD 8,23,39168
MAA 132,68,100
RD 12,23,40192
MAA 136,72,100
RD 16,24,38912
MAA 136,52,96
buffer_load_dword v22, s[16:19], s52 offen offset:2048 sc1 lds
MAA 156,56,96
s_add_u32 s52, s52, 131072
MAA 156,76,100
s_waitcnt vmcnt(16) lgkmcnt(5)
s_barrier
MAA 76,104,40
RD 20,23,46080
MAA 76,108,60
RD 24,23,47104
MAA 80,108,64
RD 28,23,48384
s_add_u32 m0, s56, 92416
MAA 80,104,44
buffer_load_dwordx4 v18, s[20:23], s54 offen lds
MAA 84,104,48
RD 32,23,49408
MAA 84,108,68
RD 36,24,48128
MAA 88,108,72
TR 80,25,49664
MAA 88,104,52
buffer_load_dwordx4 v19, s[20:23], s54 offen offset:1024 lds
MAA 120,112,52
TR 82,25,50176
MAA 120,116,72
TR 84,25,62080
MAA 116,116,68
TR 86,25,62592
MAA 116,112,48
buffer_load_dwordx4 v20, s[20:23], s54 offen offset:2048 lds
MAA 112,112,44
s_add_u32 s54, s54, 196608
MAA 112,116,64
TR 88,25,50688
MAA 108,116,60
TR 90,25,51200
s_add_u32 m0, s55, 27648
MAA 108,112,40
buffer_load_dwordx4 v21, s[16:19], s52 offen sc1 lds
MAA 140,40,120
TR 92,25,63104
MAA 140,60,124
TR 94,25,63616
MAA 144,64,124
TR 96,25,51712
MAA 144,44,120
buffer_load_dwordx4 v21, s[16:19], s52 offen offset:1024 sc1 lds
MAA 148,48,120
TR 98,25,52224
MAA 148,68,124
TR 100,25,64128
MAA 152,72,124
TR 102,25,64640
MAA 152,52,120
buffer_load_dword v22, s[16:19], s52 offen offset:2048 sc1 lds
MAA 160,56,120
s_add_u32 s52, s52, 131072
s_add_u32 s15, s15, 1
MAA 160,76,124
s_cbranch_scc0 .Lk58
s_waitcnt vmcnt(19) lgkmcnt(8)
s_barrier
MAA 60,80,0
TR 104,25,49696
v_add_f32 v164, v164, v168
MAA 60,84,20
TR 106,25,50208
s_add_u32 m0, s56, 104832
MAA 64,84,24
buffer_load_dwordx4 v18, s[20:23], s54 offen lds
MAA 64,80,4
TR 108,25,62112
v_add_f32 v165, v165, v169
MAA 68,80,8
TR 110,25,62624
v_add_f32 v166, v166, v170
MAA 68,84,28
TR 112,25,50720
v_add_f32 v167, v167, v171
MAA 72,84,32
buffer_load_dwordx4 v19, s[20:23], s54 offen offset:1024 lds
MAA 72,80,12
TR 114,25,51232
s_waitcnt lgkmcnt(6)
MAA 104,88,12
TR 116,25,63136
MAA 104,92,32
TR 118,25,63648
MAA 100,92,28
buffer_load_dwordx4 v20, s[20:23], s54 offen offset:2048 lds
MAA 100,88,8
TR 120,25,51744
s_add_u32 s54, s54, 196608
MAA 96,88,4
TR 122,25,52256
s_add_u32 m0, s55, 36864
MAA 96,92,24
TR 124,25,64160
MAA 92,92,20
buffer_load_dwordx4 v21, s[16:19], s52 offen sc1 lds
MAA 92,88,0
TR 126,25,64672
MAA 124,0,96
ds_read_b128 a[40:43], v23
MAA 124,20,100
RD 44,23,1024
MAA 128,24,100
buffer_load_dwordx4 v21, s[16:19], s52 offen offset:1024 sc1 lds
MAA 128,4,96
RD 48,23,2304
MAA 132,8,96
RD 52,23,3328
MAA 132,28,100
RD 56,24,2048
MAA 136,32,100
buffer_load_dword v22, s[16:19], s52 offen offset:2048 sc1 lds
MAA 136,12,96
s_add_u32 s52, s52, 131072
MAA 156,16,96
MAA 156,36,100
s_waitcnt vmcnt(15) lgkmcnt(5)
s_barrier
MAA 76,104,0
RD 60,23,9216
v_add_f32 v164, v164, v172
MAA 76,108,20
RD 64,23,10240
s_add_u32 m0, s56, 117248
MAA 80,108,24
buffer_load_dwordx4 v18, s[20:23], s54 offen lds
MAA 80,104,4
RD 68,23,11520
v_add_f32 v165, v165, v173
MAA 84,104,8
RD 72,23,12544
v_add_f32 v166, v166, v174
MAA 84,108,28
RD 76,24,11264
v_add_f32 v167, v167, v175
MAA 88,108,32
buffer_load_dwordx4 v19, s[20:23], s54 offen offset:1024 lds
MAA 88,104,12
ds_read_b64_tr_b16 a[80:81], v25
MAA 120,112,12
TR 82,25,512
MAA 120,116,32
TR 84,25,12416
MAA 116,116,28
buffer_load_dwordx4 v20, s[20:23], s54 offen offset:2048 lds
MAA 116,112,8
TR 86,25,12928
s_add_u32 s54, s54, 196608
MAA 112,112,4
TR 88,25,1024
s_add_u32 m0, s55, 46080
MAA 112,116,24
TR 90,25,1536
MAA 108,116,20
buffer_load_dwordx4 v21, s[16:19], s52 offen sc1 lds
MAA 108,112,0
TR 92,25,13440
MAA 140,0,120
TR 94,25,13952
MAA 140,20,124
TR 96,25,2048
MAA 144,24,124
buffer_load_dwordx4 v21, s[16:19], s52 offen offset:1024 sc1 lds
MAA 144,4,120
TR 98,25,2560
MAA 148,8,120
TR 100,25,14464
MAA 148,28,124
TR 102,25,14976
MAA 152,32,124
buffer_load_dword v22, s[16:19], s52 offen offset:2048 sc1 lds
MAA 152,12,120
s_add_u32 s52, s52, 131072
v_permlane32_swap_b32 v164, v166
MAA 160,16,120
v_permlane32_swap_b32 v165, v167
MAA 160,36,124
s_waitcnt vmcnt(18) lgkmcnt(8)
s_barrier
MAA 60,80,40
TR 104,25,32
v_add_f32 v164, v164, v166
MAA 60,84,60
TR 106,25,544
s_add_u32 m0, s56, 129664
MAA 64,84,64
buffer_load_dwordx4 v18, s[20:23], s54 offen lds
MAA 64,80,44
TR 108,25,12448
v_add_f32 v165, v165, v167
MAA 68,80,48
TR 110,25,12960
v_mul_f32 v164, 0xba800000, v164
MAA 68,84,68
buffer_load_dwordx4 v19, s[20:23], s54 offen offset:1024 lds
MAA 72,84,72
TR 112,25,1056
v_mul_f32 v165, 0x3a800000, v165
MAA 72,80,52
TR 114,25,1568
v_fma_f32 v165, -v164, v164, v165
s_waitcnt lgkmcnt(6)
MAA 104,88,52
buffer_load_dwordx4 v20, s[20:23], s54 offen offset:2048 lds
MAA 104,92,72
TR 116,25,13472
s_add_u32 s54, s54, 196608
MAA 100,92,68
TR 118,25,13984
s_add_u32 m0, s59, 58240
MAA 100,88,48
TR 120,25,2080
s_xor_b32 s58, s87, 1966080
MAA 96,88,44
buffer_load_dwordx4 v5, s[24:27], s58 offen lds
MAA 96,92,64
TR 122,25,2592
v_max_f32 v165, 0, v165
MAA 92,92,60
TR 124,25,14496
v_add_f32 v165, 0x3727c5ac, v165
MAA 92,88,40
buffer_load_dwordx4 v6, s[24:27], s58 offen offset:1024 lds
MAA 124,40,96
TR 126,25,15008
s_add_u32 m0, s59, 0
MAA 124,60,100
RD 0,23,18432
s_xor_b32 s58, s87, 1048576
MAA 128,64,100
buffer_load_dwordx4 v5, s[24:27], s58 offen lds
MAA 128,44,96
RD 4,23,19456
MAA 132,48,96
RD 8,23,20736
MAA 132,68,100
buffer_load_dwordx4 v6, s[24:27], s58 offen offset:1024 lds
MAA 136,72,100
RD 12,23,21760
MAA 136,52,96
RD 16,24,20480
MAA 156,56,96
v_rsq_f32 v166, v165
MAA 156,76,100
v_mov_b32 v165, v166
v_mul_f32 v166, 0x3e8293ee, v166
ds_write_b128 v7, v[164:167]
s_waitcnt vmcnt(16) lgkmcnt(6)
s_barrier
MAA 76,104,40
ds_write_b32 v17, v164
MAA 76,108,60
ds_write_b32 v17, v165 offset:1024
s_add_u32 m0, s59, 8320
MAA 80,108,64
RD 20,23,27648
s_xor_b32 s58, s87, 1179648
MAA 80,104,44
buffer_load_dwordx4 v5, s[24:27], s58 offen lds
MAA 84,104,48
RD 24,23,28672
MAA 84,108,68
RD 28,23,29952
MAA 88,108,72
RD 32,23,30976
MAA 88,104,52
buffer_load_dwordx4 v6, s[24:27], s58 offen offset:1024 lds
MAA 120,112,52
RD 36,24,29696
s_add_u32 m0, s59, 66560
MAA 120,116,72
TR 80,25,24832
s_xor_b32 s58, s87, 0
MAA 116,116,68
TR 82,25,25344
MAA 116,112,48
buffer_load_dwordx4 v5, s[24:27], s58 offen lds
MAA 112,112,44
TR 84,25,37248
MAA 112,116,64
TR 86,25,37760
MAA 108,116,60
TR 88,25,25856
MAA 108,112,40
buffer_load_dwordx4 v6, s[24:27], s58 offen offset:1024 lds
MAA 140,40,120
TR 90,25,26368
s_add_u32 m0, s59, 74880
MAA 140,60,124
TR 92,25,38272
s_xor_b32 s58, s87, 131072
MAA 144,64,124
TR 94,25,38784
MAA 144,44,120
buffer_load_dwordx4 v5, s[24:27], s58 offen lds
MAA 148,48,120
TR 96,25,26880
MAA 148,68,124
TR 98,25,27392
MAA 152,72,124
TR 100,25,39296
MAA 152,52,120
buffer_load_dwordx4 v6, s[24:27], s58 offen offset:1024 lds
MAA 160,56,120
TR 102,25,39808
MAA 160,76,124
s_waitcnt vmcnt(10) lgkmcnt(0)
s_barrier
MAA 104,88,12
TR 112,25,25888
s_add_u32 m0, s59, 83200
MAA 104,92,32
TR 114,25,26400
s_xor_b32 s58, s87, 262144
MAA 100,92,28
buffer_load_dwordx4 v5, s[24:27], s58 offen lds
MAA 100,88,8
TR 116,25,38304
MAA 96,88,4
TR 118,25,38816
MAA 96,92,24
TR 120,25,26912
MAA 92,92,20
buffer_load_dwordx4 v6, s[24:27], s58 offen offset:1024 lds
MAA 92,88,0
TR 122,25,27424
s_add_u32 m0, s59, 16640
MAA 156,16,96
TR 124,25,39328
s_xor_b32 s58, s87, 1310720
MAA 156,36,100
TR 126,25,39840
MAA 72,84,32
buffer_load_dwordx4 v5, s[24:27], s58 offen lds
MAA 72,80,12
TR 104,25,24864
MAA 68,80,8
TR 106,25,25376
MAA 68,84,28
TR 108,25,37280
MAA 64,84,24
buffer_load_dwordx4 v6, s[24:27], s58 offen offset:1024 lds
MAA 64,80,4
TR 110,25,37792
s_add_u32 m0, s59, 24960
MAA 60,80,0
RD 40,23,36864
s_xor_b32 s58, s87, 1441792
MAA 60,84,20
RD 44,23,37888
s_waitcnt lgkmcnt(12)
MAA 120,112,12
buffer_load_dwordx4 v5, s[24:27], s58 offen lds
s_waitcnt lgkmcnt(10)
MAA 120,116,32
RD 48,23,39168
MAA 116,116,28
RD 52,23,40192
MAA 116,112,8
RD 56,24,38912
MAA 112,112,4
buffer_load_dwordx4 v6, s[24:27], s58 offen offset:1024 lds
MAA 112,116,24
s_waitcnt lgkmcnt(5)
s_barrier
RD 60,23,46080
MAA 108,116,20
RD 64,23,47104
s_add_u32 m0, s59, 91520
MAA 108,112,0
RD 68,23,48384
s_xor_b32 s58, s87, 393216
MAA 160,16,120
RD 72,23,49408
MAA 160,36,124
RD 76,24,48128
MAA 88,108,32
TR 144,25,50688
MAA 88,104,12
.Lpad28:
s_cbranch_execz .Lnopoll53r
TR 146,25,51200
MAA 84,104,8
TR 148,25,63104
MAA 84,108,28
TR 150,25,63616
MAA 80,108,24
TR 152,25,50720
MAA 80,104,4
TR 154,25,51232
MAA 76,104,0
TR 156,25,63136
MAA 76,108,20
TR 158,25,63648
TR 160,25,51712
TR 162,25,52224
TR 164,25,64128
s_waitcnt lgkmcnt(9)
MAA 104,144,52
TR 166,25,64640
TR 168,25,51744
TR 170,25,52256
s_waitcnt lgkmcnt(10)
MAA 104,148,72
TR 172,25,64160
MAA 100,148,68
TR 174,25,64672
MAA 100,144,48
TR 136,25,49696
MAA 96,144,44
TR 138,25,50208
MAA 96,148,64
TR 140,25,62112
MAA 92,148,60
TR 142,25,62624
MAA 92,144,40
TR 128,25,49664
s_waitcnt lgkmcnt(15)
MAA 120,152,52
TR 130,25,50176
s_waitcnt lgkmcnt(14)
MAA 120,156,72
TR 132,25,62080
MAA 116,156,68
TR 134,25,62592
MAA 116,152,48
ds_read_b128 v[232:235], v10 offset:1792
MAA 112,152,44
ds_read_b128 v[228:231], v10 offset:1536
MAA 112,156,64
ds_read_b128 v[224:227], v10 offset:1280
MAA 108,156,60
ds_read_b128 v[220:223], v10 offset:1024
MAA 108,152,40
buffer_load_dwordx4 v5, s[24:27], s58 offen lds
s_waitcnt lgkmcnt(15)
MAA 156,56,160
ds_read_b128 v[240:243], v11 offset:704
MAA 156,76,164
ds_read_b128 v[244:247], v11 offset:1728
s_waitcnt lgkmcnt(14)
MAA 160,76,172
s_waitcnt lgkmcnt(6)
s_barrier
ds_read_b128 v[18:21], v11 offset:448
MAA 160,56,168
buffer_load_dwordx4 v6, s[24:27], s58 offen offset:1024 lds
MAA 88,136,52
ds_read_b128 v[22:25], v11 offset:1472
s_add_u32 m0, s59, 99840
MAA 88,140,72
s_xor_b32 s58, s87, 524288
MAA 84,140,68
MAA 84,136,48
buffer_load_dwordx4 v5, s[24:27], s58 offen lds
MAA 80,136,44
MAA 80,140,64
MAA 76,140,60
MAA 76,136,40
buffer_load_dwordx4 v6, s[24:27], s58 offen offset:1024 lds
MAA 72,128,52
s_add_u32 m0, s59, 108160
s_xor_b32 s58, s87, 655360
MAA 72,132,72
MAA 68,132,68
MAA 68,128,48
buffer_load_dwordx4 v5, s[24:27], s58 offen lds
MAA 64,128,44
MAA 64,132,64
MAA 60,132,60
MAA 60,128,40
buffer_load_dwordx4 v6, s[24:27], s58 offen offset:1024 lds
s_waitcnt lgkmcnt(3)
v_pk_fma_f32 v[156:157], v[240:241], v[44:45], v[156:157] op_sel_hi:[1,0,1]
s_waitcnt lgkmcnt(2)
v_pk_mul_f32 v[156:157], v[156:157], v[244:245]
v_cvt_pk_bf16_f32 v236, v156, v157
v_pk_fma_f32 v[158:159], v[242:243], v[44:45], v[158:159] op_sel_hi:[1,0,1]
v_pk_mul_f32 v[158:159], v[158:159], v[246:247]
v_cvt_pk_bf16_f32 v237, v158, v159
v_pk_fma_f32 v[160:161], v[240:241], v[44:45], v[160:161] op_sel:[0,1,0] op_sel_hi:[1,1,1]
v_pk_mul_f32 v[160:161], v[160:161], v[244:245]
v_cvt_pk_bf16_f32 v238, v160, v161
v_pk_fma_f32 v[162:163], v[242:243], v[44:45], v[162:163] op_sel:[0,1,0] op_sel_hi:[1,1,1]
v_pk_mul_f32 v[162:163], v[162:163], v[246:247]
v_cvt_pk_bf16_f32 v239, v162, v163
ds_write_b128 v8, v[236:239] offset:1024
v_pk_fma_f32 v[104:105], v[36:37], v[232:233], v[104:105] op_sel_hi:[1,0,1]
v_pk_mul_f32 v[104:105], v[104:105], v[232:233] op_sel:[0,1] op_sel_hi:[1,1]
v_cvt_pk_bf16_f32 v196, v104, v105
v_pk_fma_f32 v[106:107], v[38:39], v[232:233], v[106:107] op_sel_hi:[1,0,1]
v_pk_mul_f32 v[106:107], v[106:107], v[232:233] op_sel:[0,1] op_sel_hi:[1,1]
v_cvt_pk_bf16_f32 v197, v106, v107
v_pk_fma_f32 v[120:121], v[40:41], v[232:233], v[120:121] op_sel_hi:[1,0,1]
v_pk_mul_f32 v[120:121], v[120:121], v[232:233] op_sel:[0,1] op_sel_hi:[1,1]
v_cvt_pk_bf16_f32 v198, v120, v121
v_pk_fma_f32 v[122:123], v[42:43], v[232:233], v[122:123] op_sel_hi:[1,0,1]
v_pk_mul_f32 v[122:123], v[122:123], v[232:233] op_sel:[0,1] op_sel_hi:[1,1]
v_cvt_pk_bf16_f32 v199, v122, v123
v_pk_fma_f32 v[100:101], v[36:37], v[228:229], v[100:101] op_sel_hi:[1,0,1]
v_pk_mul_f32 v[100:101], v[100:101], v[228:229] op_sel:[0,1] op_sel_hi:[1,1]
v_cvt_pk_bf16_f32 v192, v100, v101
v_pk_fma_f32 v[102:103], v[38:39], v[228:229], v[102:103] op_sel_hi:[1,0,1]
v_pk_mul_f32 v[102:103], v[102:103], v[228:229] op_sel:[0,1] op_sel_hi:[1,1]
v_cvt_pk_bf16_f32 v193, v102, v103
v_pk_fma_f32 v[116:117], v[40:41], v[228:229], v[116:117] op_sel_hi:[1,0,1]
v_pk_mul_f32 v[116:117], v[116:117], v[228:229] op_sel:[0,1] op_sel_hi:[1,1]
v_cvt_pk_bf16_f32 v194, v116, v117
v_pk_fma_f32 v[118:119], v[42:43], v[228:229], v[118:119] op_sel_hi:[1,0,1]
v_pk_mul_f32 v[118:119], v[118:119], v[228:229] op_sel:[0,1] op_sel_hi:[1,1]
v_cvt_pk_bf16_f32 v195, v118, v119
v_pk_fma_f32 v[96:97], v[36:37], v[224:225], v[96:97] op_sel_hi:[1,0,1]
v_pk_mul_f32 v[96:97], v[96:97], v[224:225] op_sel:[0,1] op_sel_hi:[1,1]
v_cvt_pk_bf16_f32 v188, v96, v97
v_pk_fma_f32 v[98:99], v[38:39], v[224:225], v[98:99] op_sel_hi:[1,0,1]
v_pk_mul_f32 v[98:99], v[98:99], v[224:225] op_sel:[0,1] op_sel_hi:[1,1]
v_cvt_pk_bf16_f32 v189, v98, v99
v_pk_fma_f32 v[112:113], v[40:41], v[224:225], v[112:113] op_sel_hi:[1,0,1]
v_pk_mul_f32 v[112:113], v[112:113], v[224:225] op_sel:[0,1] op_sel_hi:[1,1]
v_cvt_pk_bf16_f32 v190, v112, v113
v_pk_fma_f32 v[114:115], v[42:43], v[224:225], v[114:115] op_sel_hi:[1,0,1]
v_pk_mul_f32 v[114:115], v[114:115], v[224:225] op_sel:[0,1] op_sel_hi:[1,1]
v_cvt_pk_bf16_f32 v191, v114, v115
v_pk_fma_f32 v[92:93], v[36:37], v[220:221], v[92:93] op_sel_hi:[1,0,1]
v_pk_mul_f32 v[92:93], v[92:93], v[220:221] op_sel:[0,1] op_sel_hi:[1,1]
v_cvt_pk_bf16_f32 v184, v92, v93
v_pk_fma_f32 v[94:95], v[38:39], v[220:221], v[94:95] op_sel_hi:[1,0,1]
v_pk_mul_f32 v[94:95], v[94:95], v[220:221] op_sel:[0,1] op_sel_hi:[1,1]
v_cvt_pk_bf16_f32 v185, v94, v95
v_pk_fma_f32 v[108:109], v[40:41], v[220:221], v[108:109] op_sel_hi:[1,0,1]
v_pk_mul_f32 v[108:109], v[108:109], v[220:221] op_sel:[0,1] op_sel_hi:[1,1]
v_cvt_pk_bf16_f32 v186, v108, v109
v_pk_fma_f32 v[110:111], v[42:43], v[220:221], v[110:111] op_sel_hi:[1,0,1]
v_pk_mul_f32 v[110:111], v[110:111], v[220:221] op_sel:[0,1] op_sel_hi:[1,1]
v_cvt_pk_bf16_f32 v187, v110, v111
v_pk_fma_f32 v[72:73], v[28:29], v[232:233], v[72:73] op_sel_hi:[1,0,1]
v_cvt_pk_bf16_f32 v176, v72, v73
v_pk_fma_f32 v[74:75], v[30:31], v[232:233], v[74:75] op_sel_hi:[1,0,1]
v_cvt_pk_bf16_f32 v177, v74, v75
v_pk_fma_f32 v[88:89], v[32:33], v[232:233], v[88:89] op_sel_hi:[1,0,1]
v_cvt_pk_bf16_f32 v178, v88, v89
v_pk_fma_f32 v[90:91], v[34:35], v[232:233], v[90:91] op_sel_hi:[1,0,1]
v_cvt_pk_bf16_f32 v179, v90, v91
v_pk_fma_f32 v[68:69], v[28:29], v[228:229], v[68:69] op_sel_hi:[1,0,1]
v_cvt_pk_bf16_f32 v172, v68, v69
v_pk_fma_f32 v[70:71], v[30:31], v[228:229], v[70:71] op_sel_hi:[1,0,1]
v_cvt_pk_bf16_f32 v173, v70, v71
v_pk_fma_f32 v[84:85], v[32:33], v[228:229], v[84:85] op_sel_hi:[1,0,1]
v_cvt_pk_bf16_f32 v174, v84, v85
v_pk_fma_f32 v[86:87], v[34:35], v[228:229], v[86:87] op_sel_hi:[1,0,1]
v_cvt_pk_bf16_f32 v175, v86, v87
v_pk_fma_f32 v[64:65], v[28:29], v[224:225], v[64:65] op_sel_hi:[1,0,1]
v_cvt_pk_bf16_f32 v168, v64, v65
v_pk_fma_f32 v[66:67], v[30:31], v[224:225], v[66:67] op_sel_hi:[1,0,1]
v_cvt_pk_bf16_f32 v169, v66, v67
v_pk_fma_f32 v[80:81], v[32:33], v[224:225], v[80:81] op_sel_hi:[1,0,1]
v_cvt_pk_bf16_f32 v170, v80, v81
v_pk_fma_f32 v[82:83], v[34:35], v[224:225], v[82:83] op_sel_hi:[1,0,1]
v_cvt_pk_bf16_f32 v171, v82, v83
v_pk_fma_f32 v[60:61], v[28:29], v[220:221], v[60:61] op_sel_hi:[1,0,1]
v_cvt_pk_bf16_f32 v164, v60, v61
v_pk_fma_f32 v[62:63], v[30:31], v[220:221], v[62:63] op_sel_hi:[1,0,1]
v_cvt_pk_bf16_f32 v165, v62, v63
v_pk_fma_f32 v[76:77], v[32:33], v[220:221], v[76:77] op_sel_hi:[1,0,1]
v_cvt_pk_bf16_f32 v166, v76, v77
v_pk_fma_f32 v[78:79], v[34:35], v[220:221], v[78:79] op_sel_hi:[1,0,1]
s_waitcnt lgkmcnt(0)
s_barrier
v_cvt_pk_bf16_f32 v167, v78, v79
v_mfma_f32_16x16x32_bf16 v[120:123], v[196:199], v[176:179], v[50:53]
ds_read_b128 v[180:183], v9
s_add_u32 m0, s59, 33280
v_mfma_f32_16x16x32_bf16 v[104:107], v[192:195], v[176:179], v[46:49]
ds_read_b64 v[200:201], v9 offset:1024
s_xor_b32 s58, s87, 1572864
v_mfma_f32_16x16x32_bf16 v[116:119], v[192:195], v[172:175], v[50:53]
buffer_load_dwordx4 v5, s[24:27], s58 offen lds
v_mfma_f32_16x16x32_bf16 v[100:103], v[188:191], v[172:175], v[46:49]
ds_read_b64 v[210:211], v9 offset:1032
v_mfma_f32_16x16x32_bf16 v[112:115], v[188:191], v[168:171], v[50:53]
ds_read_b128 v[240:243], v11 offset:384
v_max3_f32 v88, v104, v105, v106
v_mfma_f32_16x16x32_bf16 v[96:99], v[184:187], v[168:171], v[46:49]
ds_read_b128 v[244:247], v11 offset:1408
v_max3_f32 v89, v107, v120, v121
v_mfma_f32_16x16x32_bf16 v[108:111], v[184:187], v[164:167], v[50:53]
buffer_load_dwordx4 v6, s[24:27], s58 offen offset:1024 lds
v_max3_f32 v88, v88, v122, v123
v_max_f32 v90, v88, v89
v_max_f32 v89, v88, v89
v_max3_f32 v84, v100, v101, v102
v_max3_f32 v85, v103, v116, v117
s_waitcnt lgkmcnt(4)
v_mfma_f32_16x16x32_bf16 v[92:95], v[180:183], v[164:167], v[46:49]
ds_read_b128 v[28:31], v11 offset:320
s_add_u32 m0, s59, 41600
MAA 136,12,96
ds_read_b128 v[32:35], v11 offset:1344
s_xor_b32 s58, s87, 1703936
MAA 136,32,100
buffer_load_dwordx4 v5, s[24:27], s58 offen lds
MAA 136,52,160
ds_read_b128 v[36:39], v11 offset:256
v_permlane16_swap_b32 v90, v89
MAA 136,72,164
ds_read_b128 v[40:43], v11 offset:1280
v_max_f32 v88, v90, v89
MAA 152,72,172
v_max_f32 v89, v90, v89
v_max3_f32 v84, v84, v118, v119
MAA 152,52,168
buffer_load_dwordx4 v6, s[24:27], s58 offen offset:1024 lds
MAA 152,32,124
s_add_u32 m0, s59, 49920
s_xor_b32 s58, s87, 1835008
v_permlane32_swap_b32 v88, v89
MAA 152,12,120
v_max_f32 v88, v88, v89
v_mul_f32 v88, v88, v234
v_max_f32 v86, v84, v85
v_max_f32 v85, v84, v85
v_max3_f32 v80, v96, v97, v98
v_max3_f32 v81, v99, v112, v113
v_permlane16_swap_b32 v86, v85
v_max3_f32 v80, v80, v114, v115
v_max_f32 v84, v86, v85
v_max_f32 v85, v86, v85
v_max_f32 v82, v80, v81
v_max_f32 v81, v80, v81
v_permlane32_swap_b32 v84, v85
v_max3_f32 v76, v92, v93, v94
v_max_f32 v84, v84, v85
v_mul_f32 v84, v84, v230
v_permlane16_swap_b32 v82, v81
v_max3_f32 v77, v95, v108, v109
v_max_f32 v80, v82, v81
v_max_f32 v81, v82, v81
v_max3_f32 v76, v76, v110, v111
v_max_f32 v78, v76, v77
v_permlane32_swap_b32 v80, v81
v_max_f32 v77, v76, v77
v_max_f32 v80, v80, v81
v_mul_f32 v80, v80, v226
v_permlane16_swap_b32 v78, v77
v_pk_fma_f32 v[104:105], v[104:105], v[234:235], v[88:89] op_sel_hi:[1,0,0] neg_lo:[0,0,1] neg_hi:[0,0,1]
v_max_f32 v76, v78, v77
v_max_f32 v77, v78, v77
v_pk_fma_f32 v[106:107], v[106:107], v[234:235], v[88:89] op_sel_hi:[1,0,0] neg_lo:[0,0,1] neg_hi:[0,0,1]
v_pk_fma_f32 v[120:121], v[120:121], v[234:235], v[88:89] op_sel_hi:[1,0,0] neg_lo:[0,0,1] neg_hi:[0,0,1]
v_permlane32_swap_b32 v76, v77
v_pk_fma_f32 v[122:123], v[122:123], v[234:235], v[88:89] op_sel_hi:[1,0,0] neg_lo:[0,0,1] neg_hi:[0,0,1]
v_max_f32 v76, v76, v77
v_mul_f32 v76, v76, v222
v_pk_fma_f32 v[100:101], v[100:101], v[230:231], v[84:85] op_sel_hi:[1,0,0] neg_lo:[0,0,1] neg_hi:[0,0,1]
v_pk_fma_f32 v[102:103], v[102:103], v[230:231], v[84:85] op_sel_hi:[1,0,0] neg_lo:[0,0,1] neg_hi:[0,0,1]
v_pk_fma_f32 v[116:117], v[116:117], v[230:231], v[84:85] op_sel_hi:[1,0,0] neg_lo:[0,0,1] neg_hi:[0,0,1]
v_pk_fma_f32 v[118:119], v[118:119], v[230:231], v[84:85] op_sel_hi:[1,0,0] neg_lo:[0,0,1] neg_hi:[0,0,1]
v_pk_fma_f32 v[96:97], v[96:97], v[226:227], v[80:81] op_sel_hi:[1,0,0] neg_lo:[0,0,1] neg_hi:[0,0,1]
v_pk_fma_f32 v[98:99], v[98:99], v[226:227], v[80:81] op_sel_hi:[1,0,0] neg_lo:[0,0,1] neg_hi:[0,0,1]
v_pk_fma_f32 v[112:113], v[112:113], v[226:227], v[80:81] op_sel_hi:[1,0,0] neg_lo:[0,0,1] neg_hi:[0,0,1]
v_pk_fma_f32 v[114:115], v[114:115], v[226:227], v[80:81] op_sel_hi:[1,0,0] neg_lo:[0,0,1] neg_hi:[0,0,1]
v_pk_fma_f32 v[92:93], v[92:93], v[222:223], v[76:77] op_sel_hi:[1,0,0] neg_lo:[0,0,1] neg_hi:[0,0,1]
v_pk_fma_f32 v[94:95], v[94:95], v[222:223], v[76:77] op_sel_hi:[1,0,0] neg_lo:[0,0,1] neg_hi:[0,0,1]
v_pk_fma_f32 v[108:109], v[108:109], v[222:223], v[76:77] op_sel_hi:[1,0,0] neg_lo:[0,0,1] neg_hi:[0,0,1]
v_pk_fma_f32 v[110:111], v[110:111], v[222:223], v[76:77] op_sel_hi:[1,0,0] neg_lo:[0,0,1] neg_hi:[0,0,1]
v_pk_fma_f32 v[136:137], v[18:19], v[44:45], v[136:137] op_sel_hi:[1,0,1]
v_pk_mul_f32 v[136:137], v[136:137], v[22:23]
v_pk_fma_f32 v[138:139], v[20:21], v[44:45], v[138:139] op_sel_hi:[1,0,1]
v_pk_mul_f32 v[138:139], v[138:139], v[24:25]
v_pk_fma_f32 v[152:153], v[18:19], v[44:45], v[152:153] op_sel:[0,1,0] op_sel_hi:[1,1,1]
v_pk_mul_f32 v[152:153], v[152:153], v[22:23]
v_pk_fma_f32 v[154:155], v[20:21], v[44:45], v[154:155] op_sel:[0,1,0] op_sel_hi:[1,1,1]
v_pk_mul_f32 v[154:155], v[154:155], v[24:25]
v_exp_f32 v104, v104
s_nop 0
MAA 132,8,96
buffer_load_dwordx4 v5, s[24:27], s58 offen lds
MAA 132,28,100
v_exp_f32 v105, v105
MAA 132,48,160
v_exp_f32 v106, v106
MAA 132,68,164
v_exp_f32 v107, v107
MAA 148,68,172
buffer_load_dwordx4 v6, s[24:27], s58 offen offset:1024 lds
MAA 148,48,168
s_add_u32 m0, s59, 116480
s_xor_b32 s58, s87, 786432
v_exp_f32 v120, v120
MAA 148,28,124
v_exp_f32 v121, v121
MAA 148,8,120
v_exp_f32 v122, v122
MAA 128,4,96
buffer_load_dwordx4 v5, s[24:27], s58 offen lds
MAA 128,24,100
v_exp_f32 v123, v123
MAA 128,44,160
v_exp_f32 v100, v100
MAA 128,64,164
v_exp_f32 v101, v101
MAA 144,64,172
buffer_load_dwordx4 v6, s[24:27], s58 offen offset:1024 lds
MAA 144,44,168
s_add_u32 m0, s59, 124800
s_xor_b32 s58, s87, 917504
v_exp_f32 v102, v102
MAA 144,24,124
v_exp_f32 v103, v103
MAA 144,4,120
v_exp_f32 v116, v116
MAA 124,0,96
buffer_load_dwordx4 v5, s[24:27], s58 offen lds
MAA 124,20,100
v_exp_f32 v117, v117
MAA 124,40,160
v_exp_f32 v118, v118
MAA 124,60,164
v_exp_f32 v119, v119
MAA 140,60,172
buffer_load_dwordx4 v6, s[24:27], s58 offen offset:1024 lds
MAA 140,40,168
v_exp_f32 v96, v96
MAA 140,20,124
v_exp_f32 v97, v97
MAA 140,0,120
v_cvt_pk_bf16_f32 v72, v104, v105
v_cvt_pk_bf16_f32 v73, v106, v107
v_cvt_pk_bf16_f32 v74, v120, v121
v_cvt_pk_bf16_f32 v75, v122, v123
v_cvt_pk_bf16_f32 v68, v100, v101
v_cvt_pk_bf16_f32 v69, v102, v103
v_cvt_pk_bf16_f32 v70, v116, v117
v_cvt_pk_bf16_f32 v71, v118, v119
v_exp_f32 v98, v98
v_exp_f32 v99, v99
v_exp_f32 v112, v112
v_exp_f32 v113, v113
v_exp_f32 v114, v114
v_exp_f32 v115, v115
v_cvt_pk_bf16_f32 v64, v96, v97
v_cvt_pk_bf16_f32 v65, v98, v99
v_cvt_pk_bf16_f32 v66, v112, v113
v_cvt_pk_bf16_f32 v67, v114, v115
v_cvt_pk_bf16_f32 v208, v136, v137
v_cvt_pk_bf16_f32 v209, v138, v139
v_cvt_pk_bf16_f32 v218, v152, v153
v_cvt_pk_bf16_f32 v219, v154, v155
s_waitcnt lgkmcnt(5)
v_pk_fma_f32 v[132:133], v[240:241], v[44:45], v[132:133] op_sel_hi:[1,0,1]
s_waitcnt lgkmcnt(4)
v_pk_mul_f32 v[132:133], v[132:133], v[244:245]
v_cvt_pk_bf16_f32 v206, v132, v133
v_pk_fma_f32 v[134:135], v[242:243], v[44:45], v[134:135] op_sel_hi:[1,0,1]
v_pk_mul_f32 v[134:135], v[134:135], v[246:247]
v_cvt_pk_bf16_f32 v207, v134, v135
v_pk_fma_f32 v[148:149], v[240:241], v[44:45], v[148:149] op_sel:[0,1,0] op_sel_hi:[1,1,1]
v_pk_mul_f32 v[148:149], v[148:149], v[244:245]
v_cvt_pk_bf16_f32 v216, v148, v149
v_pk_fma_f32 v[150:151], v[242:243], v[44:45], v[150:151] op_sel:[0,1,0] op_sel_hi:[1,1,1]
v_pk_mul_f32 v[150:151], v[150:151], v[246:247]
v_cvt_pk_bf16_f32 v217, v150, v151
s_waitcnt lgkmcnt(3)
v_pk_fma_f32 v[128:129], v[28:29], v[44:45], v[128:129] op_sel_hi:[1,0,1]
s_waitcnt lgkmcnt(2)
v_pk_mul_f32 v[128:129], v[128:129], v[32:33]
v_cvt_pk_bf16_f32 v204, v128, v129
v_pk_fma_f32 v[130:131], v[30:31], v[44:45], v[130:131] op_sel_hi:[1,0,1]
v_pk_mul_f32 v[130:131], v[130:131], v[34:35]
v_cvt_pk_bf16_f32 v205, v130, v131
v_pk_fma_f32 v[144:145], v[28:29], v[44:45], v[144:145] op_sel:[0,1,0] op_sel_hi:[1,1,1]
v_pk_mul_f32 v[144:145], v[144:145], v[32:33]
v_cvt_pk_bf16_f32 v214, v144, v145
v_pk_fma_f32 v[146:147], v[30:31], v[44:45], v[146:147] op_sel:[0,1,0] op_sel_hi:[1,1,1]
v_pk_mul_f32 v[146:147], v[146:147], v[34:35]
v_cvt_pk_bf16_f32 v215, v146, v147
s_waitcnt lgkmcnt(1)
v_pk_fma_f32 v[124:125], v[36:37], v[44:45], v[124:125] op_sel_hi:[1,0,1]
s_waitcnt lgkmcnt(0)
v_pk_mul_f32 v[124:125], v[124:125], v[40:41]
v_cvt_pk_bf16_f32 v202, v124, v125
v_pk_fma_f32 v[126:127], v[38:39], v[44:45], v[126:127] op_sel_hi:[1,0,1]
v_pk_mul_f32 v[126:127], v[126:127], v[42:43]
v_cvt_pk_bf16_f32 v203, v126, v127
v_pk_fma_f32 v[140:141], v[36:37], v[44:45], v[140:141] op_sel:[0,1,0] op_sel_hi:[1,1,1]
v_pk_mul_f32 v[140:141], v[140:141], v[40:41]
v_cvt_pk_bf16_f32 v212, v140, v141
v_pk_fma_f32 v[142:143], v[38:39], v[44:45], v[142:143] op_sel:[0,1,0] op_sel_hi:[1,1,1]
v_pk_mul_f32 v[142:143], v[142:143], v[42:43]
v_cvt_pk_bf16_f32 v213, v142, v143
s_nop 0
v_mfma_f32_16x16x32_bf16 v[88:91], v[248:251], v[72:75], 0
v_exp_f32 v92, v92
v_mfma_f32_16x16x32_bf16 v[104:107], v[206:209], v[72:75], 0
v_exp_f32 v93, v93
v_mfma_f32_16x16x32_bf16 v[120:123], v[216:219], v[72:75], 0
v_exp_f32 v94, v94
v_mfma_f32_16x16x32_bf16 v[84:87], v[248:251], v[68:71], 0
v_exp_f32 v95, v95
v_mfma_f32_16x16x32_bf16 v[100:103], v[204:207], v[68:71], 0
v_exp_f32 v108, v108
v_mfma_f32_16x16x32_bf16 v[116:119], v[214:217], v[68:71], 0
v_exp_f32 v109, v109
v_mfma_f32_16x16x32_bf16 v[80:83], v[248:251], v[64:67], 0
v_exp_f32 v110, v110
v_mfma_f32_16x16x32_bf16 v[96:99], v[202:205], v[64:67], 0
v_exp_f32 v111, v111
v_mfma_f32_16x16x32_bf16 v[112:115], v[212:215], v[64:67], 0
v_cvt_pk_bf16_f32 v60, v92, v93
v_cvt_pk_bf16_f32 v61, v94, v95
v_cvt_pk_bf16_f32 v62, v108, v109
v_cvt_pk_bf16_f32 v63, v110, v111
v_rcp_f32 v88, v88
v_rcp_f32 v84, v84
v_mfma_f32_16x16x32_bf16 v[76:79], v[248:251], v[60:63], 0
v_rcp_f32 v80, v80
v_mfma_f32_16x16x32_bf16 v[92:95], v[200:203], v[60:63], 0
v_mfma_f32_16x16x32_bf16 v[108:111], v[210:213], v[60:63], 0
s_nop 4
v_rcp_f32 v76, v76
v_pk_mul_f32 v[104:105], v[104:105], v[88:89] op_sel_hi:[1,0]
v_pk_mul_f32 v[106:107], v[106:107], v[88:89] op_sel_hi:[1,0]
v_pk_mul_f32 v[120:121], v[120:121], v[88:89] op_sel_hi:[1,0]
v_pk_mul_f32 v[122:123], v[122:123], v[88:89] op_sel_hi:[1,0]
v_cvt_pk_bf16_f32 v176, v104, v105
v_cvt_pk_bf16_f32 v177, v106, v107
v_cvt_pk_bf16_f32 v178, v120, v121
v_cvt_pk_bf16_f32 v179, v122, v123
buffer_store_dwordx4 v[176:179], v4, s[16:19], s74 offen offset:3072 sc1
v_pk_mul_f32 v[100:101], v[100:101], v[84:85] op_sel_hi:[1,0]
v_pk_mul_f32 v[102:103], v[102:103], v[84:85] op_sel_hi:[1,0]
v_pk_mul_f32 v[116:117], v[116:117], v[84:85] op_sel_hi:[1,0]
v_pk_mul_f32 v[118:119], v[118:119], v[84:85] op_sel_hi:[1,0]
v_cvt_pk_bf16_f32 v172, v100, v101
v_cvt_pk_bf16_f32 v173, v102, v103
v_cvt_pk_bf16_f32 v174, v116, v117
v_cvt_pk_bf16_f32 v175, v118, v119
buffer_store_dwordx4 v[172:175], v4, s[16:19], s74 offen offset:2048 sc1
v_pk_mul_f32 v[96:97], v[96:97], v[80:81] op_sel_hi:[1,0]
v_pk_mul_f32 v[98:99], v[98:99], v[80:81] op_sel_hi:[1,0]
v_pk_mul_f32 v[112:113], v[112:113], v[80:81] op_sel_hi:[1,0]
v_pk_mul_f32 v[114:115], v[114:115], v[80:81] op_sel_hi:[1,0]
v_cvt_pk_bf16_f32 v168, v96, v97
v_cvt_pk_bf16_f32 v169, v98, v99
v_cvt_pk_bf16_f32 v170, v112, v113
v_cvt_pk_bf16_f32 v171, v114, v115
buffer_store_dwordx4 v[168:171], v4, s[16:19], s74 offen offset:1024 sc1
v_pk_mul_f32 v[92:93], v[92:93], v[76:77] op_sel_hi:[1,0]
v_pk_mul_f32 v[94:95], v[94:95], v[76:77] op_sel_hi:[1,0]
v_pk_mul_f32 v[108:109], v[108:109], v[76:77] op_sel_hi:[1,0]
v_pk_mul_f32 v[110:111], v[110:111], v[76:77] op_sel_hi:[1,0]
v_cvt_pk_bf16_f32 v164, v92, v93
v_cvt_pk_bf16_f32 v165, v94, v95
v_cvt_pk_bf16_f32 v166, v108, v109
v_cvt_pk_bf16_f32 v167, v110, v111
buffer_store_dwordx4 v[164:167], v4, s[16:19], s74 offen sc1
s_nop 1
.Lqkve56:
s_lshl_b32 s62, s3, 11
s_add_u32 s62, s62, s84
v_lshl_add_u32 v4, v1, 4, s62
v_lshrrev_b32 v2, 3, v1
v_cmp_eq_u32 vcc, 3, v2
v_add_u32 v2, 67108480, v4
s_nop 0
v_cndmask_b32 v4, v4, v2, vcc
v_bfe_u32 v5, v1, 3, 1
v_lshrrev_b32 v2, 4, v1
v_lshl_add_u32 v5, v2, 3, v5
s_lshl_b32 s62, s3, 1
v_add_u32 v5, s62, v5
v_mul_u32_u24 v5, 2048, v5
v_and_b32 v2, 7, v1
v_lshl_add_u32 v5, v2, 4, v5
s_lshl_b32 s62, s7, 7
v_add_u32 v5, s62, v5
v_add_u32 v6, 64512, v5
v_bfe_u32 v8, v1, 3, 2
v_mul_u32_u24 v8, 2080, v8
v_bfe_u32 v2, v1, 2, 1
v_lshl_add_u32 v8, v2, 7, v8
v_bfe_u32 v2, v1, 5, 1
v_lshl_add_u32 v8, v2, 8, v8
v_and_b32 v2, 3, v1
v_lshl_add_u32 v8, v2, 3, v8
s_mov_b32 s57, 66560
v_add_u32 v7, s57, v8
s_lshr_b32 s54, s87, 17
s_lshl_b32 s54, s54, 18
s_add_u32 s54, s54, 37748736
s_mov_b32 s52, s54
s_add_u32 s53, s54, 131072
v_accvgpr_read_b32 v32, a224
v_accvgpr_read_b32 v33, a225
v_accvgpr_read_b32 v34, a226
v_accvgpr_read_b32 v35, a227
v_accvgpr_read_b32 v36, a228
v_accvgpr_read_b32 v37, a229
v_accvgpr_read_b32 v38, a230
v_accvgpr_read_b32 v39, a231
v_accvgpr_read_b32 v40, a232
v_accvgpr_read_b32 v41, a233
v_accvgpr_read_b32 v42, a234
v_accvgpr_read_b32 v43, a235
v_accvgpr_read_b32 v44, a236
v_accvgpr_read_b32 v45, a237
v_accvgpr_read_b32 v46, a238
v_accvgpr_read_b32 v47, a239
v_accvgpr_read_b32 v48, a240
v_accvgpr_read_b32 v49, a241
v_accvgpr_read_b32 v50, a242
v_accvgpr_read_b32 v51, a243
v_accvgpr_read_b32 v52, a244
v_accvgpr_read_b32 v53, a245
v_accvgpr_read_b32 v54, a246
v_accvgpr_read_b32 v55, a247
v_accvgpr_read_b32 v56, a248
v_accvgpr_read_b32 v57, a249
v_accvgpr_read_b32 v58, a250
v_accvgpr_read_b32 v59, a251
v_accvgpr_read_b32 v60, a252
v_accvgpr_read_b32 v61, a253
v_accvgpr_read_b32 v62, a254
v_accvgpr_read_b32 v63, a255
s_lshl_b32 s62, s49, 3
s_add_u32 s62, s62, s48
s_mul_i32 s62, s62, 28672
s_add_u32 s62, s62, s51
v_lshrrev_b32 v12, 4, v1
v_mul_u32_u24 v12, 57344, v12
v_and_b32 v2, 15, v1
v_lshl_add_u32 v12, v2, 4, v12
v_add_u32 v12, s62, v12
v_add_u32 v13, 6112, v12
v_add_u32 v14, 12224, v12
v_add_u32 v15, 18336, v12
s_mul_i32 s59, s3, 4224
s_mov_b32 s58, 0
s_lshl_b32 s62, s8, 10
s_add_u32 s62, s62, 30490624
s_lshl_b32 s64, s6, 10
s_add_u32 s64, s64, 30490624
s_lshr_b32 s67, s5, 2
s_and_b32 s67, s67, 3
s_lshl_b32 s67, s67, 7
s_add_u32 s64, s64, s67
v_lshl_add_u32 v252, v1, 7, s62
v_mov_b32 v253, s64
v_mov_b32 v255, 1
s_waitcnt vmcnt(0) lgkmcnt(0)
s_cmp_lg_u32 s3, 1
s_barrier
s_cbranch_scc1 .Lnopoll60
s_mov_b64 exec, 15
buffer_atomic_add v255, v252, s[16:19], 0 offen
s_mov_b64 exec, 1
v_mov_b32 v254, 0
buffer_atomic_add v254, v253, s[16:19], 0 offen sc0
s_sleep 5
.Lpad29:
s_cbranch_execz .Lnopoll53r
s_mov_b32 s15, 0
.Lpoll59:
v_mov_b32 v255, 0
buffer_atomic_add v255, v253, s[16:19], 0 offen sc0
s_waitcnt vmcnt(1)
v_cmp_gt_u32 vcc, 16, v254
s_add_u32 s15, s15, 1
s_cbranch_vccz .Lnopoll60r
v_mov_b32 v254, 0
buffer_atomic_add v254, v253, s[16:19], 0 offen sc0
s_waitcnt vmcnt(1)
v_cmp_gt_u32 vcc, 16, v255
s_add_u32 s15, s15, 1
s_cbranch_vccz .Lnopoll60r
s_cmp_le_u32 s15, 100000
s_cbranch_scc1 .Lpoll59
s_branch .Lnopoll60r
.Lnopoll60:
s_mov_b64 exec, 0
s_cmp_eq_u32 s3, 2
s_cbranch_scc1 .Lpad30
s_cmp_eq_u32 s3, 3
s_cbranch_scc1 .Lpad31
s_branch .Lpad32
.Lnopoll60r:
s_mov_b64 exec, -1
s_barrier
buffer_load_dwordx4 v[64:67], v4, s[16:19], s52 offen sc1
buffer_load_dwordx4 v[68:71], v4, s[16:19], s52 offen offset:1024 sc1
s_xor_b32 s52, s54, 262144
buffer_load_dwordx4 v[72:75], v4, s[16:19], s53 offen sc1
buffer_load_dwordx4 v[76:79], v4, s[16:19], s53 offen offset:1024 sc1
s_xor_b32 s53, s54, 393216
buffer_load_dwordx4 v[80:83], v4, s[16:19], s52 offen sc1
buffer_load_dwordx4 v[84:87], v4, s[16:19], s52 offen offset:1024 sc1
s_xor_b32 s52, s54, 524288
buffer_load_dwordx4 v[88:91], v4, s[16:19], s53 offen sc1
buffer_load_dwordx4 v[92:95], v4, s[16:19], s53 offen offset:1024 sc1
s_xor_b32 s53, s54, 655360
buffer_load_dwordx4 v[96:99], v4, s[16:19], s52 offen sc1
buffer_load_dwordx4 v[100:103], v4, s[16:19], s52 offen offset:1024 sc1
s_xor_b32 s52, s54, 786432
buffer_load_dwordx4 v[104:107], v4, s[16:19], s53 offen sc1
buffer_load_dwordx4 v[108:111], v4, s[16:19], s53 offen offset:1024 sc1
s_xor_b32 s53, s54, 917504
ds_read_b64_tr_b16 a[0:1], v7
TR 2,7,512
TR 16,7,1024
TR 18,7,1536
TR 4,7,32
TR 6,7,544
TR 20,7,1056
TR 22,7,1568
TR 8,7,64
TR 10,7,576
TR 24,7,1088
TR 26,7,1600
TR 12,7,96
TR 14,7,608
TR 28,7,1120
TR 30,7,1632
s_waitcnt vmcnt(8) lgkmcnt(14)
MAV 32,0,64
TR 32,7,8320
s_waitcnt lgkmcnt(13)
MAV 32,16,72
buffer_load_dwordx4 v[112:115], v4, s[16:19], s52 offen sc1
MAV 48,16,76
TR 34,7,8832
MAV 48,0,68
TR 48,7,9344
TR 50,7,9856
s_waitcnt lgkmcnt(14)
MAV 52,4,68
TR 36,7,8352
s_waitcnt lgkmcnt(13)
MAV 52,20,76
buffer_load_dwordx4 v[116:119], v4, s[16:19], s52 offen offset:1024 sc1
MAV 36,20,72
TR 38,7,8864
s_xor_b32 s52, s54, 1048576
MAV 36,4,64
TR 52,7,9376
TR 54,7,9888
s_waitcnt lgkmcnt(14)
MAV 40,8,64
TR 40,7,8384
s_waitcnt lgkmcnt(13)
MAV 40,24,72
buffer_load_dwordx4 v[120:123], v4, s[16:19], s53 offen sc1
MAV 56,24,76
TR 42,7,8896
MAV 56,8,68
TR 56,7,9408
TR 58,7,9920
s_waitcnt lgkmcnt(14)
MAV 60,12,68
TR 44,7,8416
s_waitcnt lgkmcnt(13)
MAV 60,28,76
buffer_load_dwordx4 v[124:127], v4, s[16:19], s53 offen offset:1024 sc1
MAV 44,28,72
TR 46,7,8928
s_xor_b32 s53, s54, 1179648
MAV 44,12,64
TR 60,7,9440
TR 62,7,9952
s_waitcnt vmcnt(8) lgkmcnt(8)
MAV 32,32,80
TR 0,7,16640
MAV 32,48,88
buffer_load_dwordx4 v[64:67], v4, s[16:19], s52 offen sc1
MAV 48,48,92
TR 2,7,17152
MAV 48,32,84
TR 16,7,17664
TR 18,7,18176
MAV 52,36,84
TR 4,7,16672
MAV 52,52,92
buffer_load_dwordx4 v[68:71], v4, s[16:19], s52 offen offset:1024 sc1
MAV 36,52,88
TR 6,7,17184
s_xor_b32 s52, s54, 1310720
MAV 36,36,80
TR 20,7,17696
TR 22,7,18208
s_waitcnt lgkmcnt(8)
MAV 40,40,80
TR 8,7,16704
MAV 40,56,88
buffer_load_dwordx4 v[72:75], v4, s[16:19], s53 offen sc1
MAV 56,56,92
TR 10,7,17216
MAV 56,40,84
TR 24,7,17728
TR 26,7,18240
MAV 60,44,84
TR 12,7,16736
MAV 60,60,92
buffer_load_dwordx4 v[76:79], v4, s[16:19], s53 offen offset:1024 sc1
MAV 44,60,88
TR 14,7,17248
s_xor_b32 s53, s54, 1441792
MAV 44,44,80
TR 28,7,17760
TR 30,7,18272
s_waitcnt vmcnt(8) lgkmcnt(8)
MAV 32,0,96
TR 32,7,24960
MAV 32,16,104
buffer_load_dwordx4 v[80:83], v4, s[16:19], s52 offen sc1
MAV 48,16,108
TR 34,7,25472
MAV 48,0,100
TR 48,7,25984
TR 50,7,26496
MAV 52,4,100
TR 36,7,24992
MAV 52,20,108
buffer_load_dwordx4 v[84:87], v4, s[16:19], s52 offen offset:1024 sc1
MAV 36,20,104
TR 38,7,25504
s_xor_b32 s52, s54, 1572864
MAV 36,4,96
TR 52,7,26016
TR 54,7,26528
s_waitcnt lgkmcnt(8)
MAV 40,8,96
TR 40,7,25024
MAV 40,24,104
buffer_load_dwordx4 v[88:91], v4, s[16:19], s53 offen sc1
MAV 56,24,108
TR 42,7,25536
MAV 56,8,100
TR 56,7,26048
TR 58,7,26560
MAV 60,12,100
TR 44,7,25056
MAV 60,28,108
buffer_load_dwordx4 v[92:95], v4, s[16:19], s53 offen offset:1024 sc1
MAV 44,28,104
TR 46,7,25568
s_xor_b32 s53, s54, 1703936
MAV 44,12,96
TR 60,7,26080
TR 62,7,26592
s_waitcnt vmcnt(8) lgkmcnt(8)
MAV 32,32,112
TR 0,7,33280
MAV 32,48,120
buffer_load_dwordx4 v[96:99], v4, s[16:19], s52 offen sc1
MAV 48,48,124
TR 2,7,33792
MAV 48,32,116
TR 16,7,34304
TR 18,7,34816
MAV 52,36,116
TR 4,7,33312
MAV 52,52,124
buffer_load_dwordx4 v[100:103], v4, s[16:19], s52 offen offset:1024 sc1
MAV 36,52,120
TR 6,7,33824
s_xor_b32 s52, s54, 1835008
MAV 36,36,112
TR 20,7,34336
TR 22,7,34848
s_waitcnt lgkmcnt(8)
MAV 40,40,112
TR 8,7,33344
MAV 40,56,120
buffer_load_dwordx4 v[104:107], v4, s[16:19], s53 offen sc1
MAV 56,56,124
TR 10,7,33856
MAV 56,40,116
TR 24,7,34368
TR 26,7,34880
MAV 60,44,116
TR 12,7,33376
MAV 60,60,124
buffer_load_dwordx4 v[108:111], v4, s[16:19], s53 offen offset:1024 sc1
MAV 44,60,120
TR 14,7,33888
s_xor_b32 s53, s54, 1966080
MAV 44,44,112
TR 28,7,34400
TR 30,7,34912
s_waitcnt vmcnt(8) lgkmcnt(8)
MAV 32,0,64
TR 32,7,41600
MAV 32,16,72
buffer_load_dwordx4 v[112:115], v4, s[16:19], s52 offen sc1
MAV 48,16,76
TR 34,7,42112
MAV 48,0,68
TR 48,7,42624
TR 50,7,43136
MAV 52,4,68
TR 36,7,41632
MAV 52,20,76
buffer_load_dwordx4 v[116:119], v4, s[16:19], s52 offen offset:1024 sc1
MAV 36,20,72
TR 38,7,42144
s_xor_b32 s52, s54, 2097152
MAV 36,4,64
TR 52,7,42656
TR 54,7,43168
s_waitcnt lgkmcnt(8)
MAV 40,8,64
TR 40,7,41664
MAV 40,24,72
buffer_load_dwordx4 v[120:123], v4, s[16:19], s53 offen sc1
MAV 56,24,76
TR 42,7,42176
MAV 56,8,68
TR 56,7,42688
TR 58,7,43200
MAV 60,12,68
TR 44,7,41696
MAV 60,28,76
buffer_load_dwordx4 v[124:127], v4, s[16:19], s53 offen offset:1024 sc1
MAV 44,28,72
TR 46,7,42208
s_xor_b32 s53, s54, 2228224
MAV 44,12,64
TR 60,7,42720
TR 62,7,43232
s_waitcnt vmcnt(8) lgkmcnt(8)
MAV 32,32,80
TR 0,7,49920
MAV 32,48,88
buffer_load_dwordx4 v[64:67], v4, s[16:19], s52 offen sc1
MAV 48,48,92
TR 2,7,50432
MAV 48,32,84
TR 16,7,50944
TR 18,7,51456
MAV 52,36,84
TR 4,7,49952
MAV 52,52,92
buffer_load_dwordx4 v[68:71], v4, s[16:19], s52 offen offset:1024 sc1
MAV 36,52,88
TR 6,7,50464
s_xor_b32 s52, s54, 2359296
MAV 36,36,80
TR 20,7,50976
TR 22,7,51488
s_waitcnt lgkmcnt(8)
MAV 40,40,80
TR 8,7,49984
MAV 40,56,88
buffer_load_dwordx4 v[72:75], v4, s[16:19], s53 offen sc1
MAV 56,56,92
TR 10,7,50496
MAV 56,40,84
TR 24,7,51008
TR 26,7,51520
MAV 60,44,84
TR 12,7,50016
MAV 60,60,92
buffer_load_dwordx4 v[76:79], v4, s[16:19], s53 offen offset:1024 sc1
MAV 44,60,88
TR 14,7,50528
s_xor_b32 s53, s54, 2490368
MAV 44,44,80
TR 28,7,51040
TR 30,7,51552
s_waitcnt vmcnt(8) lgkmcnt(8)
MAV 32,0,96
TR 32,7,58240
MAV 32,16,104
buffer_load_dwordx4 v[80:83], v4, s[16:19], s52 offen sc1
MAV 48,16,108
TR 34,7,58752
MAV 48,0,100
TR 48,7,59264
TR 50,7,59776
MAV 52,4,100
TR 36,7,58272
MAV 52,20,108
buffer_load_dwordx4 v[84:87], v4, s[16:19], s52 offen offset:1024 sc1
MAV 36,20,104
TR 38,7,58784
s_xor_b32 s52, s54, 2621440
MAV 36,4,96
TR 52,7,59296
TR 54,7,59808
s_waitcnt lgkmcnt(8)
MAV 40,8,96
TR 40,7,58304
MAV 40,24,104
buffer_load_dwordx4 v[88:91], v4, s[16:19], s53 offen sc1
MAV 56,24,108
TR 42,7,58816
MAV 56,8,100
TR 56,7,59328
TR 58,7,59840
MAV 60,12,100
TR 44,7,58336
MAV 60,28,108
buffer_load_dwordx4 v[92:95], v4, s[16:19], s53 offen offset:1024 sc1
MAV 44,28,104
TR 46,7,58848
s_xor_b32 s53, s54, 2752512
MAV 44,12,96
TR 60,7,59360
TR 62,7,59872
s_xor_b32 s57, s57, 66560
v_add_u32 v7, s57, v8
s_waitcnt vmcnt(8) lgkmcnt(8)
MAV 32,32,112
ds_read_b64_tr_b16 a[0:1], v7
MAV 32,48,120
buffer_load_dwordx4 v[96:99], v4, s[16:19], s52 offen sc1
MAV 48,48,124
TR 2,7,512
MAV 48,32,116
TR 16,7,1024
TR 18,7,1536
MAV 52,36,116
TR 4,7,32
MAV 52,52,124
buffer_load_dwordx4 v[100:103], v4, s[16:19], s52 offen offset:1024 sc1
MAV 36,52,120
TR 6,7,544
s_xor_b32 s52, s54, 2883584
MAV 36,36,112
TR 20,7,1056
TR 22,7,1568
s_waitcnt lgkmcnt(8)
MAV 40,40,112
TR 8,7,64
MAV 40,56,120
buffer_load_dwordx4 v[104:107], v4, s[16:19], s53 offen sc1
MAV 56,56,124
TR 10,7,576
MAV 56,40,116
TR 24,7,1088
TR 26,7,1600
MAV 60,44,116
TR 12,7,96
MAV 60,60,124
buffer_load_dwordx4 v[108:111], v4, s[16:19], s53 offen offset:1024 sc1
MAV 44,60,120
TR 14,7,608
s_xor_b32 s53, s54, 3014656
MAV 44,44,112
TR 28,7,1120
TR 30,7,1632
s_waitcnt vmcnt(8) lgkmcnt(8)
MAV 32,0,64
TR 32,7,8320
MAV 32,16,72
buffer_load_dwordx4 v[112:115], v4, s[16:19], s52 offen sc1
MAV 48,16,76
TR 34,7,8832
MAV 48,0,68
TR 48,7,9344
TR 50,7,9856
MAV 52,4,68
TR 36,7,8352
MAV 52,20,76
buffer_load_dwordx4 v[116:119], v4, s[16:19], s52 offen offset:1024 sc1
MAV 36,20,72
TR 38,7,8864
s_xor_b32 s52, s54, 3145728
MAV 36,4,64
TR 52,7,9376
TR 54,7,9888
s_waitcnt lgkmcnt(8)
MAV 40,8,64
TR 40,7,8384
MAV 40,24,72
buffer_load_dwordx4 v[120:123], v4, s[16:19], s53 offen sc1
MAV 56,24,76
TR 42,7,8896
MAV 56,8,68
TR 56,7,9408
TR 58,7,9920
MAV 60,12,68
TR 44,7,8416
MAV 60,28,76
buffer_load_dwordx4 v[124:127], v4, s[16:19], s53 offen offset:1024 sc1
MAV 44,28,72
TR 46,7,8928
s_xor_b32 s53, s54, 3276800
MAV 44,12,64
TR 60,7,9440
TR 62,7,9952
s_waitcnt vmcnt(8) lgkmcnt(8)
MAV 32,32,80
TR 0,7,16640
MAV 32,48,88
buffer_load_dwordx4 v[64:67], v4, s[16:19], s52 offen sc1
MAV 48,48,92
TR 2,7,17152
MAV 48,32,84
TR 16,7,17664
TR 18,7,18176
MAV 52,36,84
TR 4,7,16672
MAV 52,52,92
buffer_load_dwordx4 v[68:71], v4, s[16:19], s52 offen offset:1024 sc1
MAV 36,52,88
TR 6,7,17184
s_xor_b32 s52, s54, 3407872
MAV 36,36,80
TR 20,7,17696
TR 22,7,18208
s_waitcnt lgkmcnt(8)
MAV 40,40,80
TR 8,7,16704
MAV 40,56,88
buffer_load_dwordx4 v[72:75], v4, s[16:19], s53 offen sc1
MAV 56,56,92
TR 10,7,17216
MAV 56,40,84
TR 24,7,17728
TR 26,7,18240
MAV 60,44,84
TR 12,7,16736
MAV 60,60,92
buffer_load_dwordx4 v[76:79], v4, s[16:19], s53 offen offset:1024 sc1
MAV 44,60,88
TR 14,7,17248
s_xor_b32 s53, s54, 3538944
MAV 44,44,80
TR 28,7,17760
TR 30,7,18272
s_waitcnt vmcnt(8) lgkmcnt(8)
MAV 32,0,96
TR 32,7,24960
MAV 32,16,104
buffer_load_dwordx4 v[80:83], v4, s[16:19], s52 offen sc1
MAV 48,16,108
TR 34,7,25472
MAV 48,0,100
TR 48,7,25984
TR 50,7,26496
MAV 52,4,100
TR 36,7,24992
MAV 52,20,108
buffer_load_dwordx4 v[84:87], v4, s[16:19], s52 offen offset:1024 sc1
MAV 36,20,104
TR 38,7,25504
s_xor_b32 s52, s54, 3670016
MAV 36,4,96
TR 52,7,26016
TR 54,7,26528
s_waitcnt lgkmcnt(8)
MAV 40,8,96
TR 40,7,25024
MAV 40,24,104
buffer_load_dwordx4 v[88:91], v4, s[16:19], s53 offen sc1
MAV 56,24,108
TR 42,7,25536
MAV 56,8,100
TR 56,7,26048
TR 58,7,26560
MAV 60,12,100
TR 44,7,25056
MAV 60,28,108
buffer_load_dwordx4 v[92:95], v4, s[16:19], s53 offen offset:1024 sc1
MAV 44,28,104
TR 46,7,25568
s_xor_b32 s53, s54, 3801088
MAV 44,12,96
TR 60,7,26080
TR 62,7,26592
s_waitcnt vmcnt(8) lgkmcnt(8)
MAV 32,32,112
TR 0,7,33280
MAV 32,48,120
buffer_load_dwordx4 v[96:99], v4, s[16:19], s52 offen sc1
MAV 48,48,124
TR 2,7,33792
MAV 48,32,116
TR 16,7,34304
TR 18,7,34816
MAV 52,36,116
TR 4,7,33312
MAV 52,52,124
buffer_load_dwordx4 v[100:103], v4, s[16:19], s52 offen offset:1024 sc1
MAV 36,52,120
TR 6,7,33824
s_xor_b32 s52, s54, 3932160
MAV 36,36,112
TR 20,7,34336
TR 22,7,34848
s_waitcnt lgkmcnt(8)
MAV 40,40,112
TR 8,7,33344
MAV 40,56,120
buffer_load_dwordx4 v[104:107], v4, s[16:19], s53 offen sc1
MAV 56,56,124
TR 10,7,33856
MAV 56,40,116
TR 24,7,34368
TR 26,7,34880
MAV 60,44,116
TR 12,7,33376
.Lpad30:
s_cbranch_execz .Lpad33
MAV 60,60,124
buffer_load_dwordx4 v[108:111], v4, s[16:19], s53 offen offset:1024 sc1
MAV 44,60,120
TR 14,7,33888
s_xor_b32 s53, s54, 4063232
MAV 44,44,112
TR 28,7,34400
TR 30,7,34912
s_waitcnt vmcnt(8) lgkmcnt(8)
MAV 32,0,64
TR 32,7,41600
MAV 32,16,72
buffer_load_dwordx4 v[112:115], v4, s[16:19], s52 offen sc1
MAV 48,16,76
TR 34,7,42112
MAV 48,0,68
TR 48,7,42624
TR 50,7,43136
MAV 52,4,68
TR 36,7,41632
MAV 52,20,76
buffer_load_dwordx4 v[116:119], v4, s[16:19], s52 offen offset:1024 sc1
MAV 36,20,72
TR 38,7,42144
MAV 36,4,64
TR 52,7,42656
TR 54,7,43168
s_waitcnt lgkmcnt(8)
MAV 40,8,64
TR 40,7,41664
MAV 40,24,72
buffer_load_dwordx4 v[120:123], v4, s[16:19], s53 offen sc1
MAV 56,24,76
TR 42,7,42176
MAV 56,8,68
TR 56,7,42688
TR 58,7,43200
MAV 60,12,68
TR 44,7,41696
MAV 60,28,76
buffer_load_dwordx4 v[124:127], v4, s[16:19], s53 offen offset:1024 sc1
MAV 44,28,72
TR 46,7,42208
MAV 44,12,64
TR 60,7,42720
TR 62,7,43232
s_barrier
s_waitcnt vmcnt(8) lgkmcnt(8)
MAV 32,32,80
TR 0,7,49920
s_add_u32 m0, s59, 84480
MAV 32,48,88
buffer_load_dwordx4 v12, s[32:35], s58 offen   lds
MAV 48,48,92
TR 2,7,50432
MAV 48,32,84
TR 16,7,50944
TR 18,7,51456
MAV 52,36,84
TR 4,7,49952
MAV 52,52,92
buffer_load_dwordx4 v13, s[32:35], s58 offen offset:1056   lds
MAV 36,52,88
TR 6,7,50464
MAV 36,36,80
TR 20,7,50976
TR 22,7,51488
s_waitcnt lgkmcnt(8)
MAV 40,40,80
TR 8,7,49984
MAV 40,56,88
buffer_load_dwordx4 v14, s[32:35], s58 offen offset:2112   lds
MAV 56,56,92
TR 10,7,50496
MAV 56,40,84
TR 24,7,51008
TR 26,7,51520
MAV 60,44,84
TR 12,7,50016
MAV 60,60,92
buffer_load_dwordx4 v15, s[32:35], s58 offen offset:3168   lds
MAV 44,60,88
TR 14,7,50528
MAV 44,44,80
TR 28,7,51040
TR 30,7,51552
s_waitcnt vmcnt(8) lgkmcnt(8)
MAV 32,0,96
TR 32,7,58240
s_add_u32 m0, s59, 101376
MAV 32,16,104
buffer_load_dwordx4 v12, s[80:83], s58 offen   lds
MAV 48,16,108
TR 34,7,58752
MAV 48,0,100
TR 48,7,59264
TR 50,7,59776
MAV 52,4,100
TR 36,7,58272
MAV 52,20,108
buffer_load_dwordx4 v13, s[80:83], s58 offen offset:1056   lds
MAV 36,20,104
TR 38,7,58784
MAV 36,4,96
TR 52,7,59296
TR 54,7,59808
s_waitcnt lgkmcnt(8)
MAV 40,8,96
TR 40,7,58304
MAV 40,24,104
buffer_load_dwordx4 v14, s[80:83], s58 offen offset:2112   lds
MAV 56,24,108
TR 42,7,58816
MAV 56,8,100
TR 56,7,59328
TR 58,7,59840
MAV 60,12,100
TR 44,7,58336
MAV 60,28,108
buffer_load_dwordx4 v15, s[80:83], s58 offen offset:3168   lds
MAV 44,28,104
TR 46,7,58848
s_add_u32 s58, s58, 458752
MAV 44,12,96
TR 60,7,59360
TR 62,7,59872
s_waitcnt vmcnt(11) lgkmcnt(14)
MAV 32,32,112
s_add_u32 m0, s59, 118272
s_lshl_b32 s64, s6, 14
s_lshl_b32 s65, s49, 13
s_waitcnt vmcnt(9) lgkmcnt(12)
MAV 32,48,120
buffer_load_dwordx4 v12, s[32:35], s58 offen   lds
s_waitcnt vmcnt(9)
MAV 48,48,124
s_add_u32 s64, s64, s65
s_lshl_b32 s65, s7, 9
s_add_u32 s64, s64, s65
MAV 48,32,116
s_lshl_b32 s65, s48, 8
s_add_u32 s64, s64, s65
s_add_u32 s64, s64, 63176704
s_waitcnt lgkmcnt(10)
MAV 52,36,116
s_lshl_b32 s62, s7, 18
v_and_b32 v152, 31, v1
v_lshlrev_b32 v152, 3, v152
s_waitcnt lgkmcnt(8)
MAV 52,52,124
buffer_load_dwordx4 v13, s[32:35], s58 offen offset:1056   lds
MAV 36,52,120
s_add_u32 s62, s62, 41943040
v_lshrrev_b32 v153, 5, v1
v_lshl_add_u32 v152, v153, 28, v152
MAV 36,36,112
s_add_u32 s63, s62, 131072
v_cvt_pk_bf16_f32 v128, v32, v33
v_cvt_pk_bf16_f32 v129, v34, v35
s_waitcnt lgkmcnt(6)
MAV 40,40,112
v_cvt_pk_bf16_f32 v136, v48, v49
v_cvt_pk_bf16_f32 v137, v50, v51
s_waitcnt lgkmcnt(4)
MAV 40,56,120
buffer_load_dwordx4 v14, s[32:35], s58 offen offset:2112   lds
MAV 56,56,124
v_cvt_pk_bf16_f32 v130, v36, v37
v_cvt_pk_bf16_f32 v131, v38, v39
MAV 56,40,116
v_cvt_pk_bf16_f32 v138, v52, v53
v_cvt_pk_bf16_f32 v139, v54, v55
s_waitcnt lgkmcnt(2)
MAV 60,44,116
v_cvt_pk_bf16_f32 v132, v40, v41
v_cvt_pk_bf16_f32 v133, v42, v43
s_waitcnt lgkmcnt(0)
MAV 60,60,124
buffer_load_dwordx4 v15, s[32:35], s58 offen offset:3168   lds
MAV 44,60,120
v_cvt_pk_bf16_f32 v140, v56, v57
v_cvt_pk_bf16_f32 v141, v58, v59
MAV 44,44,112
s_nop 2
v_cvt_pk_bf16_f32 v142, v60, v61
v_cvt_pk_bf16_f32 v143, v62, v63
v_pk_mul_f32 v[146:147], v[32:33], v[32:33]
buffer_store_dwordx4 v[128:131], v4, s[16:19], s62 offen sc1
v_pk_mul_f32 v[150:151], v[48:49], v[48:49]
v_pk_fma_f32 v[146:147], v[34:35], v[34:35], v[146:147]
v_pk_add_f32 v[144:145], v[32:33], v[34:35]
v_pk_fma_f32 v[150:151], v[50:51], v[50:51], v[150:151]
v_cvt_pk_bf16_f32 v134, v44, v45
v_cvt_pk_bf16_f32 v135, v46, v47
v_pk_add_f32 v[148:149], v[48:49], v[50:51]
v_pk_fma_f32 v[146:147], v[36:37], v[36:37], v[146:147]
v_pk_add_f32 v[144:145], v[144:145], v[36:37]
v_pk_fma_f32 v[150:151], v[52:53], v[52:53], v[150:151]
v_pk_add_f32 v[148:149], v[148:149], v[52:53]
v_pk_fma_f32 v[146:147], v[38:39], v[38:39], v[146:147]
v_pk_add_f32 v[144:145], v[144:145], v[38:39]
buffer_store_dwordx4 v[132:135], v4, s[16:19], s63 offen sc1
v_pk_fma_f32 v[150:151], v[54:55], v[54:55], v[150:151]
v_pk_add_f32 v[148:149], v[148:149], v[54:55]
v_pk_fma_f32 v[146:147], v[40:41], v[40:41], v[146:147]
v_pk_add_f32 v[144:145], v[144:145], v[40:41]
v_pk_fma_f32 v[150:151], v[56:57], v[56:57], v[150:151]
v_pk_add_f32 v[148:149], v[148:149], v[56:57]
v_pk_fma_f32 v[146:147], v[42:43], v[42:43], v[146:147]
v_pk_add_f32 v[144:145], v[144:145], v[42:43]
v_pk_fma_f32 v[150:151], v[58:59], v[58:59], v[150:151]
v_pk_add_f32 v[148:149], v[148:149], v[58:59]
v_pk_fma_f32 v[146:147], v[44:45], v[44:45], v[146:147]
v_pk_add_f32 v[144:145], v[144:145], v[44:45]
v_pk_fma_f32 v[150:151], v[60:61], v[60:61], v[150:151]
buffer_store_dwordx4 v[136:139], v4, s[16:19], s62 offen offset:1024 sc1
v_pk_add_f32 v[148:149], v[148:149], v[60:61]
v_pk_fma_f32 v[146:147], v[46:47], v[46:47], v[146:147]
v_pk_add_f32 v[144:145], v[144:145], v[46:47]
v_pk_fma_f32 v[150:151], v[62:63], v[62:63], v[150:151]
v_pk_add_f32 v[148:149], v[148:149], v[62:63]
v_add_f32 v144, v144, v145
v_add_f32 v146, v146, v147
v_add_f32 v148, v148, v149
v_add_f32 v150, v150, v151
s_nop 0
v_permlane16_swap_b32 v144, v148
buffer_store_dwordx4 v[140:143], v4, s[16:19], s63 offen offset:1024 sc1
v_permlane16_swap_b32 v146, v150
v_add_f32 v144, v144, v148
v_add_f32 v146, v146, v150
s_nop 1
v_permlane32_swap_b32 v144, v146
v_add_f32 v144, v144, v146
s_nop 1
v_permlane32_swap_b32 v144, v145
buffer_store_dwordx2 v[144:145], v152, s[16:19], s64 offen sc1
s_nop 1
v_accvgpr_write_b32 a224, v32
v_accvgpr_write_b32 a225, v33
v_accvgpr_write_b32 a226, v34
v_accvgpr_write_b32 a227, v35
v_accvgpr_write_b32 a228, v36
v_accvgpr_write_b32 a229, v37
v_accvgpr_write_b32 a230, v38
v_accvgpr_write_b32 a231, v39
v_accvgpr_write_b32 a232, v40
v_accvgpr_write_b32 a233, v41
v_accvgpr_write_b32 a234, v42
v_accvgpr_write_b32 a235, v43
v_accvgpr_write_b32 a236, v44
v_accvgpr_write_b32 a237, v45
v_accvgpr_write_b32 a238, v46
v_accvgpr_write_b32 a239, v47
v_accvgpr_write_b32 a240, v48
v_accvgpr_write_b32 a241, v49
v_accvgpr_write_b32 a242, v50
v_accvgpr_write_b32 a243, v51
v_accvgpr_write_b32 a244, v52
v_accvgpr_write_b32 a245, v53
v_accvgpr_write_b32 a246, v54
v_accvgpr_write_b32 a247, v55
v_accvgpr_write_b32 a248, v56
v_accvgpr_write_b32 a249, v57
v_accvgpr_write_b32 a250, v58
v_accvgpr_write_b32 a251, v59
v_accvgpr_write_b32 a252, v60
v_accvgpr_write_b32 a253, v61
v_accvgpr_write_b32 a254, v62
v_accvgpr_write_b32 a255, v63
s_lshl_b32 s62, s10, 14
s_lshl_b32 s63, s3, 12
s_add_u32 s62, s62, s63
s_lshl_b32 s63, s12, 11
s_add_u32 s62, s62, s63
v_lshl_add_u32 v10, v1, 4, s62
v_lshrrev_b32 v2, 3, v1
v_cmp_eq_u32 vcc, 3, v2
v_add_u32 v2, 67108480, v10
s_nop 0
v_cndmask_b32 v10, v10, v2, vcc
v_xor_b32 v11, 2048, v10
v_bfe_u32 v16, v1, 2, 3
v_mul_u32_u24 v16, 1056, v16
v_bfe_u32 v2, v1, 5, 1
v_lshl_add_u32 v16, v2, 8, v16
v_and_b32 v2, 3, v1
v_lshl_add_u32 v16, v2, 3, v16
s_lshl_b32 s62, s12, 6
s_add_u32 s62, s62, 84480
s_xor_b32 s63, s12, 1
s_mul_i32 s63, s63, 192
s_add_u32 s63, s63, 84480
v_add_u32 v17, s63, v16
v_add_u32 v16, s62, v16
s_mov_b32 s52, 41943040
s_mov_b32 s53, 41943040
s_mov_b32 s54, s58
s_mov_b32 s55, s59
s_mul_i32 s59, s3, 2112
s_and_b32 s62, s7, 1
s_mul_i32 s62, s62, 3670016
s_lshr_b32 s63, s7, 1
s_lshl_b32 s63, s63, 8
s_add_u32 s62, s62, s63
s_lshl_b32 s63, s3, 12
s_add_u32 s62, s62, s63
v_lshrrev_b32 v5, 4, v1
v_lshlrev_b32 v5, 14, v5
v_and_b32 v2, 15, v1
v_lshl_add_u32 v5, v2, 4, v5
v_add_u32 v5, s62, v5
v_add_u32 v6, 992, v5
s_lshl_b32 s62, s10, 15
s_lshl_b32 s63, s3, 13
s_add_u32 s62, s62, s63
v_lshl_add_u32 v4, v1, 4, s62
s_lshl_b32 s62, s6, 10
s_add_u32 s62, s62, 30507008
s_lshl_b32 s64, s10, 1
s_lshl_b32 s64, s64, 10
s_add_u32 s64, s64, 30507008
s_lshr_b32 s67, s5, 2
s_and_b32 s67, s67, 3
s_lshl_b32 s67, s67, 7
s_add_u32 s64, s64, s67
s_add_u32 s65, s64, 1024
v_lshl_add_u32 v252, v1, 7, s62
v_mov_b32 v253, s64
v_mov_b32 v255, 1
v_writelane_b32 v253, s65, 1
s_waitcnt vmcnt(0) lgkmcnt(0)
s_cmp_lg_u32 s3, 1
s_barrier
s_cbranch_scc1 .Lnopoll63
s_mov_b64 exec, 15
buffer_atomic_add v255, v252, s[16:19], 0 offen
s_mov_b64 exec, 3
v_mov_b32 v254, 0
buffer_atomic_add v254, v253, s[16:19], 0 offen sc0
s_sleep 5
s_mov_b32 s15, 0
.Lpoll62:
v_mov_b32 v255, 0
buffer_atomic_add v255, v253, s[16:19], 0 offen sc0
s_waitcnt vmcnt(1)
v_cmp_gt_u32 vcc, 16, v254
s_add_u32 s15, s15, 1
s_cbranch_vccz .Lnopoll63r
v_mov_b32 v254, 0
buffer_atomic_add v254, v253, s[16:19], 0 offen sc0
s_waitcnt vmcnt(1)
v_cmp_gt_u32 vcc, 16, v255
s_add_u32 s15, s15, 1
s_cbranch_vccz .Lnopoll63r
s_cmp_le_u32 s15, 100000
s_cbranch_scc1 .Lpoll62
s_branch .Lnopoll63r
.Lnopoll63:
s_mov_b64 exec, 0
s_cmp_eq_u32 s3, 2
s_cbranch_scc1 .Lpad35
s_cmp_eq_u32 s3, 3
s_cbranch_scc1 .Lpad36
s_branch .Lpad37
.Lnopoll63r:
s_mov_b64 exec, -1
s_barrier
buffer_load_dwordx4 a[128:131], v10, s[16:19], s52 offen sc1
buffer_load_dwordx4 a[132:135], v10, s[16:19], s52 offen offset:1024 sc1
s_add_u32 s52, s52, 131072
buffer_load_dwordx4 a[144:147], v10, s[16:19], s52 offen sc1
buffer_load_dwordx4 a[148:151], v10, s[16:19], s52 offen offset:1024 sc1
s_add_u32 s52, s52, 131072
buffer_load_dwordx4 a[136:139], v11, s[16:19], s53 offen sc1
buffer_load_dwordx4 a[140:143], v11, s[16:19], s53 offen offset:1024 sc1
s_add_u32 s53, s53, 131072
buffer_load_dwordx4 a[152:155], v11, s[16:19], s53 offen sc1
buffer_load_dwordx4 a[156:159], v11, s[16:19], s53 offen offset:1024 sc1
s_add_u32 s53, s53, 131072
ds_read_b64_tr_b16 a[0:1], v16
TR 2,16,512
TR 4,16,8448
TR 6,16,8960
TR 8,16,32
TR 10,16,544
TR 12,16,8480
TR 14,16,8992
TR 16,16,64
TR 18,16,576
TR 20,16,8512
TR 22,16,9024
TR 24,16,96
TR 26,16,608
TR 28,16,8544
TR 30,16,9056
TR 32,16,128
TR 34,16,640
TR 36,16,8576
TR 38,16,9088
TR 40,16,160
TR 42,16,672
TR 44,16,8608
TR 46,16,9120
ds_read_b64_tr_b16 a[48:49], v17
TR 50,17,512
TR 52,17,8448
TR 54,17,8960
TR 56,17,32
TR 58,17,544
TR 60,17,8480
TR 62,17,8992
s_add_u32 m0, s55, 135168
s_nop 0
buffer_load_dwordx4 v12, s[80:83], s54 offen   lds
buffer_load_dwordx4 v13, s[80:83], s54 offen offset:1056   lds
buffer_load_dwordx4 v14, s[80:83], s54 offen offset:2112   lds
buffer_load_dwordx4 v15, s[80:83], s54 offen offset:3168   lds
s_add_u32 s54, s54, 458752
s_lshl_b32 s57, s3, 13
s_add_u32 s57, s57, 49920
v_lshl_add_u32 v2, v1, 4, s57
s_waitcnt lgkmcnt(0)
s_barrier
s_waitcnt vmcnt(11)
v_mfma_f32_16x16x32_bf16 v[32:35], a[0:3], a[128:131], 0
buffer_load_dwordx4 a[160:163], v10, s[16:19], s52 offen sc1
s_waitcnt vmcnt(10)
MAA 32,4,144
TR 64,16,16896
v_mfma_f32_16x16x32_bf16 v[36:39], a[0:3], a[132:135], 0
TR 66,16,17408
s_waitcnt vmcnt(9)
MAA 36,4,148
TR 68,16,25344
v_mfma_f32_16x16x32_bf16 v[52:55], a[8:11], a[132:135], 0
buffer_load_dwordx4 a[164:167], v10, s[16:19], s52 offen offset:1024 sc1
MAA 52,12,148
TR 70,16,25856
s_add_u32 s52, s52, 131072
v_mfma_f32_16x16x32_bf16 v[48:51], a[8:11], a[128:131], 0
TR 72,16,16928
MAA 48,12,144
TR 74,16,17440
v_mfma_f32_16x16x32_bf16 v[96:99], a[16:19], a[128:131], 0
buffer_load_dwordx4 a[176:179], v10, s[16:19], s52 offen sc1
MAA 96,20,144
TR 76,16,25376
v_mfma_f32_16x16x32_bf16 v[100:103], a[16:19], a[132:135], 0
TR 78,16,25888
MAA 100,20,148
TR 80,16,16960
v_mfma_f32_16x16x32_bf16 v[116:119], a[24:27], a[132:135], 0
buffer_load_dwordx4 a[180:183], v10, s[16:19], s52 offen offset:1024 sc1
MAA 116,28,148
TR 82,16,17472
s_add_u32 s52, s52, 131072
v_mfma_f32_16x16x32_bf16 v[112:115], a[24:27], a[128:131], 0
TR 84,16,25408
MAA 112,28,144
TR 86,16,25920
v_mfma_f32_16x16x32_bf16 v[160:163], a[32:35], a[128:131], 0
buffer_load_dwordx4 a[168:171], v11, s[16:19], s53 offen sc1
MAA 160,36,144
TR 88,16,16992
v_mfma_f32_16x16x32_bf16 v[164:167], a[32:35], a[132:135], 0
TR 90,16,17504
MAA 164,36,148
TR 92,16,25440
v_mfma_f32_16x16x32_bf16 v[180:183], a[40:43], a[132:135], 0
buffer_load_dwordx4 a[172:175], v11, s[16:19], s53 offen offset:1024 sc1
MAA 180,44,148
TR 94,16,25952
s_add_u32 s53, s53, 131072
v_mfma_f32_16x16x32_bf16 v[176:179], a[40:43], a[128:131], 0
TR 96,16,17024
MAA 176,44,144
TR 98,16,17536
v_mfma_f32_16x16x32_bf16 v[224:227], a[48:51], a[128:131], 0
buffer_load_dwordx4 a[184:187], v11, s[16:19], s53 offen sc1
MAA 224,52,144
TR 100,16,25472
v_mfma_f32_16x16x32_bf16 v[228:231], a[48:51], a[132:135], 0
TR 102,16,25984
MAA 228,52,148
TR 104,16,17056
v_mfma_f32_16x16x32_bf16 v[236:239], a[56:59], a[132:135], 0
buffer_load_dwordx4 a[188:191], v11, s[16:19], s53 offen offset:1024 sc1
MAA 236,60,148
TR 106,16,17568
s_add_u32 s53, s53, 131072
v_mfma_f32_16x16x32_bf16 v[232:235], a[56:59], a[128:131], 0
TR 108,16,25504
s_add_u32 m0, s55, 84480
MAA 232,60,144
TR 110,16,26016
s_waitcnt vmcnt(12)
v_mfma_f32_16x16x32_bf16 v[188:191], a[40:43], a[140:143], 0
buffer_load_dwordx4 v12, s[32:35], s54 offen   lds
MAA 188,44,156
TR 112,17,16896
v_mfma_f32_16x16x32_bf16 v[184:187], a[40:43], a[136:139], 0
TR 114,17,17408
MAA 184,44,152
TR 116,17,25344
v_mfma_f32_16x16x32_bf16 v[168:171], a[32:35], a[136:139], 0
buffer_load_dwordx4 v13, s[32:35], s54 offen offset:1056   lds
MAA 168,36,152
TR 118,17,25856
v_mfma_f32_16x16x32_bf16 v[172:175], a[32:35], a[140:143], 0
TR 120,17,16928
MAA 172,36,156
TR 122,17,17440
v_mfma_f32_16x16x32_bf16 v[124:127], a[24:27], a[140:143], 0
buffer_load_dwordx4 v14, s[32:35], s54 offen offset:2112   lds
MAA 124,28,156
TR 124,17,25376
v_mfma_f32_16x16x32_bf16 v[120:123], a[24:27], a[136:139], 0
TR 126,17,25888
MAA 120,28,152
v_mfma_f32_16x16x32_bf16 v[104:107], a[16:19], a[136:139], 0
buffer_load_dwordx4 v15, s[32:35], s54 offen offset:3168   lds
MAA 104,20,152
v_mfma_f32_16x16x32_bf16 v[108:111], a[16:19], a[140:143], 0
MAA 108,20,156
v_mfma_f32_16x16x32_bf16 v[60:63], a[8:11], a[140:143], 0
MAA 60,12,156
v_mfma_f32_16x16x32_bf16 v[56:59], a[8:11], a[136:139], 0
MAA 56,12,152
v_mfma_f32_16x16x32_bf16 v[40:43], a[0:3], a[136:139], 0
MAA 40,4,152
v_mfma_f32_16x16x32_bf16 v[44:47], a[0:3], a[140:143], 0
MAA 44,4,156
s_waitcnt lgkmcnt(0)
s_barrier
v_mfma_f32_16x16x32_bf16 v[64:67], a[64:67], a[128:131], 0
TR 0,16,33792
s_add_u32 m0, s55, 101376
MAA 64,68,144
buffer_load_dwordx4 v12, s[80:83], s54 offen   lds
v_mfma_f32_16x16x32_bf16 v[68:71], a[64:67], a[132:135], 0
TR 2,16,34304
s_mul_i32 s66, s13, 114688
MAA 68,68,148
TR 4,16,42240
s_mul_i32 s65, s10, 1818624
v_mfma_f32_16x16x32_bf16 v[84:87], a[72:75], a[132:135], 0
TR 6,16,42752
s_add_u32 s66, s66, s65
MAA 84,76,148
TR 8,16,33824
s_add_u32 s66, s66, 46137344
v_mfma_f32_16x16x32_bf16 v[80:83], a[72:75], a[128:131], 0
buffer_load_dwordx4 v13, s[80:83], s54 offen offset:1056   lds
MAA 80,76,144
TR 10,16,34336
s_add_u32 s65, s66, 49152
v_mfma_f32_16x16x32_bf16 v[128:131], a[80:83], a[128:131], 0
TR 12,16,42272
s_lshl_b32 s62, s12, 16
MAA 128,84,144
TR 14,16,42784
s_add_u32 s62, s62, s66
v_mfma_f32_16x16x32_bf16 v[132:135], a[80:83], a[132:135], 0
TR 16,16,33856
s_add_u32 s63, s62, 16384
MAA 132,84,148
buffer_load_dwordx4 v14, s[80:83], s54 offen offset:2112   lds
v_mfma_f32_16x16x32_bf16 v[148:151], a[88:91], a[132:135], 0
TR 18,16,34368
s_add_u32 s64, s62, 32768
MAA 148,92,148
TR 20,16,42304
s_lshl_b32 s72, s10, 1
v_mfma_f32_16x16x32_bf16 v[144:147], a[88:91], a[128:131], 0
TR 22,16,42816
.Lpad31:
s_cbranch_execz .Lpad34
s_lshr_b32 s74, s11, 4
MAA 144,92,144
TR 24,16,33888
s_add_u32 s72, s72, s74
v_mfma_f32_16x16x32_bf16 v[192:195], a[96:99], a[128:131], 0
buffer_load_dwordx4 v15, s[80:83], s54 offen offset:3168   lds
MAA 192,100,144
TR 26,16,34400
s_add_u32 s54, s54, 458752
v_mfma_f32_16x16x32_bf16 v[196:199], a[96:99], a[132:135], 0
TR 28,16,42336
s_add_u32 m0, s57, 0
MAA 196,100,148
TR 30,16,42848
s_mov_b32 s58, 63176704
v_mfma_f32_16x16x32_bf16 v[212:215], a[104:107], a[132:135], 0
TR 32,16,33920
s_lshl_b32 s72, s72, 10
MAA 212,108,148
buffer_load_dwordx4 v4, s[16:19], s58 offen sc1 lds
v_mfma_f32_16x16x32_bf16 v[208:211], a[104:107], a[128:131], 0
TR 34,16,34432
s_add_u32 s72, s72, 30523392
MAA 208,108,144
TR 36,16,42368
s_and_b32 s73, s6, 14
v_mfma_f32_16x16x32_bf16 v[240:243], a[112:115], a[128:131], 0
TR 38,16,42880
s_and_b32 s74, s7, 1
MAA 240,116,144
TR 40,16,33952
s_add_u32 s73, s73, s74
v_mfma_f32_16x16x32_bf16 v[244:247], a[112:115], a[132:135], 0
buffer_load_dwordx4 v4, s[16:19], s58 offen offset:1024 sc1 lds
MAA 244,116,148
TR 42,16,34464
s_lshl_b32 s73, s73, 10
v_mfma_f32_16x16x32_bf16 v[252:255], a[120:123], a[132:135], 0
TR 44,16,42400
s_add_u32 s73, s73, 30523392
MAA 252,124,148
TR 46,16,42912
s_lshr_b32 s67, s5, 2
v_mfma_f32_16x16x32_bf16 v[248:251], a[120:123], a[128:131], 0
TR 48,17,33792
s_and_b32 s67, s67, 3
MAA 248,124,144
buffer_load_dwordx4 a[128:131], v10, s[16:19], s52 offen sc1
v_mfma_f32_16x16x32_bf16 v[220:223], a[104:107], a[140:143], 0
TR 50,17,34304
s_lshl_b32 s67, s67, 7
MAA 220,108,156
TR 52,17,42240
s_add_u32 s73, s73, s67
v_mfma_f32_16x16x32_bf16 v[216:219], a[104:107], a[136:139], 0
TR 54,17,42752
MAA 216,108,152
TR 56,17,33824
v_mfma_f32_16x16x32_bf16 v[200:203], a[96:99], a[136:139], 0
buffer_load_dwordx4 a[132:135], v10, s[16:19], s52 offen offset:1024 sc1
MAA 200,100,152
TR 58,17,34336
s_add_u32 s52, s52, 131072
v_mfma_f32_16x16x32_bf16 v[204:207], a[96:99], a[140:143], 0
TR 60,17,42272
MAA 204,100,156
TR 62,17,42784
v_mfma_f32_16x16x32_bf16 v[156:159], a[88:91], a[140:143], 0
MAA 156,92,156
buffer_load_dwordx4 a[144:147], v10, s[16:19], s52 offen sc1
v_mfma_f32_16x16x32_bf16 v[152:155], a[88:91], a[136:139], 0
MAA 152,92,152
v_mfma_f32_16x16x32_bf16 v[136:139], a[80:83], a[136:139], 0
MAA 136,84,152
v_mfma_f32_16x16x32_bf16 v[140:143], a[80:83], a[140:143], 0
buffer_load_dwordx4 a[148:151], v10, s[16:19], s52 offen offset:1024 sc1
MAA 140,84,156
s_add_u32 s52, s52, 131072
v_mfma_f32_16x16x32_bf16 v[92:95], a[72:75], a[140:143], 0
MAA 92,76,156
v_mfma_f32_16x16x32_bf16 v[88:91], a[72:75], a[136:139], 0
MAA 88,76,152
v_mfma_f32_16x16x32_bf16 v[72:75], a[64:67], a[136:139], 0
MAA 72,68,152
v_mfma_f32_16x16x32_bf16 v[76:79], a[64:67], a[140:143], 0
MAA 76,68,156
s_waitcnt vmcnt(18) lgkmcnt(0)
s_barrier
MAA 32,0,160
buffer_load_dwordx4 a[136:139], v11, s[16:19], s53 offen sc1
MAA 32,4,176
TR 64,16,50688
s_and_b32 s74, s7, 1
MAA 36,4,180
TR 66,16,51200
s_mul_i32 s87, s74, 917504
MAA 36,0,164
TR 68,16,59136
s_lshr_b32 s75, s6, 1
MAA 52,8,164
TR 70,16,59648
s_mul_i32 s75, s75, 1818624
MAA 52,12,180
buffer_load_dwordx4 a[140:143], v11, s[16:19], s53 offen offset:1024 sc1
MAA 48,12,176
TR 72,16,50720
s_add_u32 s53, s53, 131072
MAA 48,8,160
TR 74,16,51232
s_add_u32 s87, s87, s75
MAA 96,16,160
TR 76,16,59168
s_add_u32 s87, s87, 46137344
MAA 96,20,176
TR 78,16,59680
s_and_b32 s74, s6, 3
MAA 100,20,180
buffer_load_dwordx4 a[152:155], v11, s[16:19], s53 offen sc1
MAA 100,16,164
TR 80,16,50752
s_xor_b32 s75, s74, 0
MAA 116,24,164
TR 82,16,51264
s_sub_u32 s75, s75, 0
MAA 116,28,180
TR 84,16,59200
s_mul_i32 s98, s75, 458752
MAA 112,28,176
TR 86,16,59712
s_mul_i32 s75, s75, 114688
MAA 112,24,160
buffer_load_dwordx4 a[156:159], v11, s[16:19], s53 offen offset:1024 sc1
MAA 160,32,160
TR 88,16,50784
s_add_u32 s53, s53, 131072
MAA 160,36,176
TR 90,16,51296
s_add_u32 m0, s55, 118272
MAA 164,36,180
TR 92,16,59232
s_add_u32 s76, s87, s75
MAA 164,32,164
TR 94,16,59744
s_xor_b32 s75, s74, 1
MAA 180,40,164
buffer_load_dwordx4 v12, s[32:35], s54 offen   lds
MAA 180,44,180
TR 96,16,50816
s_sub_u32 s75, s75, 1
MAA 176,44,176
TR 98,16,51328
s_mul_i32 s99, s75, 458752
MAA 176,40,160
TR 100,16,59264
s_mul_i32 s75, s75, 114688
MAA 224,48,160
TR 102,16,59776
s_add_u32 s77, s87, s75
MAA 224,52,176
buffer_load_dwordx4 v13, s[32:35], s54 offen offset:1056   lds
MAA 228,52,180
TR 104,16,50848
s_xor_b32 s75, s74, 2
MAA 228,48,164
TR 106,16,51360
s_sub_u32 s75, s75, 2
MAA 236,56,164
TR 108,16,59296
s_mul_i32 s100, s75, 458752
MAA 236,60,180
TR 110,16,59808
s_mul_i32 s75, s75, 114688
MAA 232,60,176
buffer_load_dwordx4 v14, s[32:35], s54 offen offset:2112   lds
MAA 232,56,160
TR 112,17,50688
s_add_u32 s78, s87, s75
s_waitcnt vmcnt(21)
MAA 188,40,172
TR 114,17,51200
s_xor_b32 s75, s74, 3
MAA 188,44,188
TR 116,17,59136
MAA 184,44,184
TR 118,17,59648
MAA 184,40,168
buffer_load_dwordx4 v15, s[32:35], s54 offen offset:3168   lds
MAA 168,32,168
TR 120,17,50720
s_add_u32 m0, s57, 2048
MAA 168,36,184
TR 122,17,51232
s_mov_b32 s58, 63178752
MAA 172,36,188
TR 124,17,59168
MAA 172,32,172
TR 126,17,59680
MAA 124,24,172
buffer_load_dwordx4 v4, s[16:19], s58 offen sc1 lds
MAA 124,28,188
MAA 120,28,184
MAA 120,24,168
MAA 104,16,168
MAA 104,20,184
buffer_load_dwordx4 v4, s[16:19], s58 offen offset:1024 sc1 lds
MAA 108,20,188
MAA 108,16,172
MAA 60,8,172
MAA 60,12,188
MAA 56,12,184
MAA 56,8,168
MAA 40,0,168
MAA 40,4,184
MAA 44,4,188
MAA 44,0,172
s_waitcnt vmcnt(20) lgkmcnt(0)
s_barrier
MAA 64,64,160
ds_read_b64_tr_b16 a[0:1], v16
s_add_u32 m0, s55, 135168
MAA 64,68,176
buffer_load_dwordx4 v12, s[80:83], s54 offen   lds
MAA 68,68,180
TR 2,16,512
s_sub_u32 s75, s75, 3
MAA 68,64,164
TR 4,16,8448
s_mul_i32 s101, s75, 458752
MAA 84,72,164
TR 6,16,8960
s_mul_i32 s75, s75, 114688
MAA 84,76,180
TR 8,16,32
s_add_u32 s79, s87, s75
MAA 80,76,176
buffer_load_dwordx4 v13, s[80:83], s54 offen offset:1056   lds
MAA 80,72,160
TR 10,16,544
s_and_b32 s87, s6, 3
MAA 128,80,160
TR 12,16,8480
s_mov_b32 s46, 0
MAA 128,84,176
TR 14,16,8992
s_lshl_b32 s74, s3, 10
MAA 132,84,180
TR 16,16,64
s_lshl_b32 s75, s12, 9
MAA 132,80,164
buffer_load_dwordx4 v14, s[80:83], s54 offen offset:2112   lds
MAA 148,88,164
TR 18,16,576
s_add_u32 s74, s74, s75
MAA 148,92,180
TR 20,16,8512
s_add_u32 s74, s74, 152576
MAA 144,92,176
TR 22,16,9024
v_and_b32 v18, 15, v1
MAA 144,88,160
TR 24,16,96
v_lshl_add_u32 v18, v18, 4, s74
MAA 192,96,160
buffer_load_dwordx4 v15, s[80:83], s54 offen offset:3168   lds
MAA 192,100,176
TR 26,16,608
s_add_u32 s54, s54, 458752
MAA 196,100,180
TR 28,16,8544
s_add_u32 m0, s57, 4096
MAA 196,96,164
TR 30,16,9056
s_mov_b32 s58, 63180800
MAA 212,104,164
TR 32,16,128
v_xor_b32 v19, 512, v18
MAA 212,108,180
buffer_load_dwordx4 v4, s[16:19], s58 offen sc1 lds
MAA 208,108,176
TR 34,16,640
s_lshl_b32 s74, s12, 7
MAA 208,104,160
TR 36,16,8576
s_add_u32 s74, s74, 161536
MAA 240,112,160
TR 38,16,9088
s_xor_b32 s75, s12, 1
MAA 240,116,176
TR 40,16,160
s_mul_i32 s75, s75, 384
MAA 244,116,180
buffer_load_dwordx4 v4, s[16:19], s58 offen offset:1024 sc1 lds
MAA 244,112,164
TR 42,16,672
s_add_u32 s75, s75, 161536
MAA 252,120,164
TR 44,16,8608
v_lshrrev_b32 v9, 4, v1
MAA 252,124,180
TR 46,16,9120
v_lshlrev_b32 v9, 4, v9
MAA 248,124,176
ds_read_b64_tr_b16 a[48:49], v17
v_add_u32 v8, s75, v9
MAA 248,120,160
buffer_load_dwordx4 a[160:163], v10, s[16:19], s52 offen sc1
MAA 220,104,172
TR 50,17,512
v_add_u32 v9, s74, v9
MAA 220,108,188
TR 52,17,8448
MAA 216,108,184
TR 54,17,8960
MAA 216,104,168
TR 56,17,32
MAA 200,96,168
buffer_load_dwordx4 a[164:167], v10, s[16:19], s52 offen offset:1024 sc1
MAA 200,100,184
TR 58,17,544
s_add_u32 s52, s52, 131072
MAA 204,100,188
TR 60,17,8480
MAA 204,96,172
TR 62,17,8992
MAA 156,88,172
MAA 156,92,188
buffer_load_dwordx4 a[176:179], v10, s[16:19], s52 offen sc1
MAA 152,92,184
MAA 152,88,168
MAA 136,80,168
MAA 136,84,184
MAA 140,84,188
buffer_load_dwordx4 a[180:183], v10, s[16:19], s52 offen offset:1024 sc1
MAA 140,80,172
s_add_u32 s52, s52, 131072
MAA 92,72,172
MAA 92,76,188
MAA 88,76,184
MAA 88,72,168
MAA 72,64,168
MAA 72,68,184
MAA 76,68,188
MAA 76,64,172
s_waitcnt vmcnt(20) lgkmcnt(0)
s_barrier
MAA 32,0,128
buffer_load_dwordx4 a[168:171], v11, s[16:19], s53 offen sc1
MAA 32,4,144
ds_read_b128 v[20:23], v2
MAA 36,4,148
ds_read_b128 v[28:31], v2 offset:1024
MAA 36,0,132
s_waitcnt vmcnt(11)
ds_read_b128 v[24:27], v2 offset:2048
MAA 52,8,132
TR 64,16,16896
MAA 52,12,148
buffer_load_dwordx4 a[172:175], v11, s[16:19], s53 offen offset:1024 sc1
MAA 48,12,144
TR 66,16,17408
s_add_u32 s53, s53, 131072
MAA 48,8,128
TR 68,16,25344
MAA 96,16,128
TR 70,16,25856
MAA 96,20,144
TR 72,16,16928
MAA 100,20,148
buffer_load_dwordx4 a[184:187], v11, s[16:19], s53 offen sc1
MAA 100,16,132
TR 74,16,17440
s_waitcnt lgkmcnt(7)
v_add_f32 v20, v20, v28
MAA 116,24,132
TR 76,16,25376
v_add_f32 v21, v21, v29
MAA 116,28,148
TR 78,16,25888
v_add_f32 v22, v22, v30
MAA 112,28,144
TR 80,16,16960
v_add_f32 v23, v23, v31
MAA 112,24,128
buffer_load_dwordx4 a[188:191], v11, s[16:19], s53 offen offset:1024 sc1
MAA 160,32,128
ds_read_b128 v[28:31], v2 offset:3072
s_add_u32 s53, s53, 131072
MAA 160,36,144
TR 82,16,17472
s_add_u32 m0, s55, 84480
MAA 164,36,148
TR 84,16,25408
s_waitcnt lgkmcnt(12)
v_add_f32 v20, v20, v24
MAA 164,32,132
TR 86,16,25920
v_add_f32 v21, v21, v25
MAA 180,40,132
buffer_load_dwordx4 v12, s[32:35], s54 offen   lds
MAA 180,44,148
TR 88,16,16992
v_add_f32 v22, v22, v26
MAA 176,44,144
TR 90,16,17504
v_add_f32 v23, v23, v27
MAA 176,40,128
TR 92,16,25440
MAA 224,48,128
TR 94,16,25952
MAA 224,52,144
buffer_load_dwordx4 v13, s[32:35], s54 offen offset:1056   lds
MAA 228,52,148
TR 96,16,17024
MAA 228,48,132
TR 98,16,17536
MAA 236,56,132
TR 100,16,25472
MAA 236,60,148
TR 102,16,25984
MAA 232,60,144
buffer_load_dwordx4 v14, s[32:35], s54 offen offset:2112   lds
MAA 232,56,128
TR 104,16,17056
MAA 188,40,140
TR 106,16,17568
MAA 188,44,156
TR 108,16,25504
MAA 184,44,152
TR 110,16,26016
MAA 184,40,136
buffer_load_dwordx4 v15, s[32:35], s54 offen offset:3168   lds
MAA 168,32,136
TR 112,17,16896
s_add_u32 m0, s57, 6144
MAA 168,36,152
TR 114,17,17408
s_mov_b32 s58, 63182848
MAA 172,36,156
TR 116,17,25344
MAA 172,32,140
TR 118,17,25856
MAA 124,24,140
buffer_load_dwordx4 v4, s[16:19], s58 offen sc1 lds
MAA 124,28,156
TR 120,17,16928
MAA 120,28,152
TR 122,17,17440
MAA 120,24,136
TR 124,17,25376
MAA 104,16,136
TR 126,17,25888
MAA 104,20,152
buffer_load_dwordx4 v4, s[16:19], s58 offen offset:1024 sc1 lds
MAA 108,20,156
MAA 108,16,140
MAA 60,8,140
MAA 60,12,156
MAA 56,12,152
MAA 56,8,136
MAA 40,0,136
MAA 40,4,152
MAA 44,4,156
MAA 44,0,140
s_waitcnt lgkmcnt(0)
s_barrier
MAA 64,64,128
s_waitcnt vmcnt(14)
ds_read_b128 v[24:27], v2 offset:4096
s_add_u32 m0, s55, 101376
MAA 64,68,144
buffer_load_dwordx4 v12, s[80:83], s54 offen   lds
MAA 68,68,148
TR 0,16,33792
v_add_f32 v20, v20, v28
MAA 68,64,132
TR 2,16,34304
v_add_f32 v21, v21, v29
MAA 84,72,132
TR 4,16,42240
v_add_f32 v22, v22, v30
MAA 84,76,148
TR 6,16,42752
v_add_f32 v23, v23, v31
MAA 80,76,144
ds_read_b128 v[28:31], v2 offset:5120
MAA 80,72,128
TR 8,16,33824
MAA 128,80,128
buffer_load_dwordx4 v13, s[80:83], s54 offen offset:1056   lds
MAA 128,84,144
TR 10,16,34336
s_waitcnt lgkmcnt(7)
v_add_f32 v20, v20, v24
MAA 132,84,148
TR 12,16,42272
v_add_f32 v21, v21, v25
MAA 132,80,132
TR 14,16,42784
v_add_f32 v22, v22, v26
MAA 148,88,132
TR 16,16,33856
v_add_f32 v23, v23, v27
MAA 148,92,148
TR 18,16,34368
MAA 144,92,144
TR 20,16,42304
MAA 144,88,128
buffer_load_dwordx4 v14, s[80:83], s54 offen offset:2112   lds
MAA 192,96,128
TR 22,16,42816
MAA 192,100,144
TR 24,16,33888
MAA 196,100,148
TR 26,16,34400
MAA 196,96,132
TR 28,16,42336
MAA 212,104,132
TR 30,16,42848
MAA 212,108,148
TR 32,16,33920
MAA 208,108,144
buffer_load_dwordx4 v15, s[80:83], s54 offen offset:3168   lds
MAA 208,104,128
TR 34,16,34432
s_add_u32 s54, s54, 458752
MAA 240,112,128
TR 36,16,42368
MAA 240,116,144
TR 38,16,42880
MAA 244,116,148
TR 40,16,33952
MAA 244,112,132
TR 42,16,34464
MAA 252,120,132
TR 44,16,42400
MAA 252,124,148
TR 46,16,42912
MAA 248,124,144
TR 48,17,33792
MAA 248,120,128
buffer_load_dwordx4 a[128:131], v10, s[16:19], s52 offen sc1
MAA 220,104,140
TR 50,17,34304
MAA 220,108,156
TR 52,17,42240
MAA 216,108,152
TR 54,17,42752
.Lpad32:
s_cbranch_execz .Lnopoll60r
MAA 216,104,136
TR 56,17,33824
MAA 200,96,136
TR 58,17,34336
MAA 200,100,152
TR 60,17,42272
MAA 204,100,156
buffer_load_dwordx4 a[132:135], v10, s[16:19], s52 offen offset:1024 sc1
MAA 204,96,140
TR 62,17,42784
s_add_u32 s52, s52, 131072
MAA 156,88,140
MAA 156,92,156
MAA 152,92,152
MAA 152,88,136
MAA 136,80,136
MAA 136,84,152
buffer_load_dwordx4 a[144:147], v10, s[16:19], s52 offen sc1
MAA 140,84,156
MAA 140,80,140
MAA 92,72,140
MAA 92,76,156
MAA 88,76,152
MAA 88,72,136
MAA 72,64,136
buffer_load_dwordx4 a[148:151], v10, s[16:19], s52 offen offset:1024 sc1
MAA 72,68,152
s_add_u32 s52, s52, 131072
MAA 76,68,156
MAA 76,64,140
s_waitcnt vmcnt(18) lgkmcnt(0)
s_barrier
MAA 32,0,160
buffer_load_dwordx4 a[136:139], v11, s[16:19], s53 offen sc1
MAA 32,4,176
s_waitcnt vmcnt(9)
ds_read_b128 v[24:27], v2 offset:6144
v_add_f32 v20, v20, v28
MAA 36,4,180
TR 64,16,50688
v_add_f32 v21, v21, v29
MAA 36,0,164
TR 66,16,51200
v_add_f32 v22, v22, v30
MAA 52,8,164
TR 68,16,59136
v_add_f32 v23, v23, v31
MAA 52,12,180
ds_read_b128 v[28:31], v2 offset:7168
MAA 48,12,176
TR 70,16,59648
MAA 48,8,160
buffer_load_dwordx4 a[140:143], v11, s[16:19], s53 offen offset:1024 sc1
MAA 96,16,160
TR 72,16,50720
s_add_u32 s53, s53, 131072
MAA 96,20,176
TR 74,16,51232
s_waitcnt lgkmcnt(7)
v_add_f32 v20, v20, v24
MAA 100,20,180
TR 76,16,59168
v_add_f32 v21, v21, v25
MAA 100,16,164
TR 78,16,59680
v_add_f32 v22, v22, v26
MAA 116,24,164
TR 80,16,50752
v_add_f32 v23, v23, v27
MAA 116,28,180
TR 82,16,51264
s_waitcnt lgkmcnt(7)
v_add_f32 v20, v20, v28
MAA 112,28,176
buffer_load_dwordx4 a[152:155], v11, s[16:19], s53 offen sc1
MAA 112,24,160
TR 84,16,59200
v_add_f32 v21, v21, v29
MAA 160,32,160
TR 86,16,59712
v_add_f32 v22, v22, v30
MAA 160,36,176
TR 88,16,50784
v_add_f32 v23, v23, v31
MAA 164,36,180
TR 90,16,51296
MAA 164,32,164
TR 92,16,59232
MAA 180,40,164
TR 94,16,59744
MAA 180,44,180
buffer_load_dwordx4 a[156:159], v11, s[16:19], s53 offen offset:1024 sc1
MAA 176,44,176
TR 96,16,50816
s_add_u32 s53, s53, 131072
MAA 176,40,160
TR 98,16,51328
s_add_u32 m0, s55, 118272
MAA 224,48,160
TR 100,16,59264
MAA 224,52,176
TR 102,16,59776
MAA 228,52,180
TR 104,16,50848
MAA 228,48,164
TR 106,16,51360
MAA 236,56,164
buffer_load_dwordx4 v12, s[32:35], s54 offen   lds
MAA 236,60,180
TR 108,16,59296
MAA 232,60,176
TR 110,16,59808
MAA 232,56,160
TR 112,17,50688
MAA 188,40,172
TR 114,17,51200
MAA 188,44,188
TR 116,17,59136
MAA 184,44,184
TR 118,17,59648
MAA 184,40,168
buffer_load_dwordx4 v13, s[32:35], s54 offen offset:1056   lds
MAA 168,32,168
TR 120,17,50720
MAA 168,36,184
TR 122,17,51232
MAA 172,36,188
TR 124,17,59168
MAA 172,32,172
TR 126,17,59680
MAA 124,24,172
MAA 124,28,188
MAA 120,28,184
buffer_load_dwordx4 v14, s[32:35], s54 offen offset:2112   lds
MAA 120,24,168
MAA 104,16,168
MAA 104,20,184
MAA 108,20,188
MAA 108,16,172
MAA 60,8,172
MAA 60,12,188
buffer_load_dwordx4 v15, s[32:35], s54 offen offset:3168   lds
MAA 56,12,184
MAA 56,8,168
MAA 40,0,168
MAA 40,4,184
MAA 44,4,188
MAA 44,0,172
s_waitcnt lgkmcnt(0)
s_barrier
MAA 64,64,160
ds_read_b64_tr_b16 a[0:1], v16
s_add_u32 m0, s55, 135168
MAA 64,68,176
buffer_load_dwordx4 v12, s[80:83], s54 offen   lds
MAA 68,68,180
TR 2,16,512
v_permlane32_swap_b32 v20, v22
MAA 68,64,164
TR 4,16,8448
v_permlane32_swap_b32 v21, v23
MAA 84,72,164
TR 6,16,8960
v_add_f32 v20, v20, v22
MAA 84,76,180
TR 8,16,32
v_add_f32 v21, v21, v23
MAA 80,76,176
TR 10,16,544
v_mul_f32 v20, 0xba800000, v20
MAA 80,72,160
buffer_load_dwordx4 v13, s[80:83], s54 offen offset:1056   lds
MAA 128,80,160
TR 12,16,8480
v_mul_f32 v21, 0x3a800000, v21
MAA 128,84,176
TR 14,16,8992
v_fma_f32 v21, -v20, v20, v21
MAA 132,84,180
TR 16,16,64
v_max_f32 v21, 0, v21
MAA 132,80,164
TR 18,16,576
v_add_f32 v21, 0x3727c5ac, v21
MAA 148,88,164
TR 20,16,8512
v_rsq_f32 v22, v21
MAA 148,92,180
buffer_load_dwordx4 v14, s[80:83], s54 offen offset:2112   lds
MAA 144,92,176
TR 22,16,9024
v_and_b32 v24, 31, v1
MAA 144,88,160
TR 24,16,96
v_lshrrev_b32 v25, 5, v1
MAA 192,96,160
TR 26,16,608
v_lshl_add_u32 v24, v24, 1, v25
MAA 192,100,176
TR 28,16,8544
v_and_b32 v25, 0xc0, v0
MAA 196,100,180
TR 30,16,9056
v_add_u32 v24, v24, v25
MAA 196,96,164
TR 32,16,128
v_lshlrev_b32 v24, 4, v24
MAA 212,104,164
buffer_load_dwordx4 v15, s[80:83], s54 offen offset:3168   lds
MAA 212,108,180
TR 34,16,640
s_add_u32 s54, s54, 458752
MAA 208,108,176
TR 36,16,8576
v_add_u32 v24, 152576, v24
MAA 208,104,160
TR 38,16,9088
v_mul_f32 v22, 0xbfb8aa3b, v22
MAA 240,112,160
ds_write_b128 v24, v[20:23]
s_mov_b32 s58, s98
MAA 240,116,176
ds_read_b64 v[20:21], v18
s_mov_b32 s67, s59
MAA 244,116,180
ds_read_b64 v[22:23], v18 offset:256
MAA 244,112,164
ds_read_b64 v[24:25], v19
MAA 252,120,164
ds_read_b64 v[26:27], v19 offset:256
MAA 252,124,180
ds_read_b32 a192, v18 offset:8
MAA 248,124,176
ds_read_b32 a193, v18 offset:264
v_mov_b32 v18, v5
MAA 248,120,160
buffer_load_dwordx4 a[160:163], v10, s[16:19], s52 offen sc1
MAA 220,104,172
ds_read_b32 a194, v19 offset:8
MAA 220,108,188
ds_read_b32 a195, v19 offset:264
v_add_u32 v19, 992, v5
MAA 216,108,184
TR 40,16,160
MAA 216,104,168
TR 42,16,672
MAA 200,96,168
TR 44,16,8608
MAA 200,100,184
TR 46,16,9120
MAA 204,100,188
buffer_load_dwordx4 a[164:167], v10, s[16:19], s52 offen offset:1024 sc1
MAA 204,96,172
ds_read_b64_tr_b16 a[48:49], v17
s_add_u32 s52, s52, 131072
MAA 156,88,172
TR 50,17,512
MAA 156,92,188
TR 52,17,8448
MAA 152,92,184
TR 54,17,8960
MAA 152,88,168
TR 56,17,32
MAA 136,80,168
TR 58,17,544
MAA 136,84,184
buffer_load_dwordx4 a[176:179], v10, s[16:19], s52 offen sc1
MAA 140,84,188
TR 60,17,8480
MAA 140,80,172
TR 62,17,8992
MAA 92,72,172
MAA 92,76,188
MAA 88,76,184
MAA 88,72,168
MAA 72,64,168
buffer_load_dwordx4 a[180:183], v10, s[16:19], s52 offen offset:1024 sc1
MAA 72,68,184
s_add_u32 s52, s52, 131072
MAA 76,68,188
MAA 76,64,172
s_waitcnt vmcnt(16) lgkmcnt(0)
s_barrier
MAA 32,0,128
ds_read_b128 v[28:31], v9 offset:512
MAA 32,4,144
ds_read_b128 v[4:7], v9 offset:576
MAA 36,4,148
buffer_load_dwordx4 a[168:171], v11, s[16:19], s53 offen sc1
MAA 36,0,132
TR 64,16,16896
MAA 52,8,132
TR 66,16,17408
MAA 52,12,148
TR 68,16,25344
MAA 48,12,144
TR 70,16,25856
MAA 48,8,128
TR 72,16,16928
MAA 96,16,128
buffer_load_dwordx4 a[172:175], v11, s[16:19], s53 offen offset:1024 sc1
MAA 96,20,144
TR 74,16,17440
s_add_u32 s53, s53, 131072
MAA 100,20,148
TR 76,16,25376
s_waitcnt lgkmcnt(8)
v_fmac_f32 v64, v28, v20
MAA 100,16,132
TR 78,16,25888
v_fmac_f32 v65, v29, v20
MAA 116,24,132
TR 80,16,16960
v_fmac_f32 v66, v30, v20
MAA 116,28,148
TR 82,16,17472
v_fmac_f32 v67, v31, v20
MAA 112,28,144
buffer_load_dwordx4 a[184:187], v11, s[16:19], s53 offen sc1
MAA 112,24,128
TR 84,16,25408
v_fmac_f32 v68, v28, v22
MAA 160,32,128
TR 86,16,25920
v_fmac_f32 v69, v29, v22
MAA 160,36,144
TR 88,16,16992
v_fmac_f32 v70, v30, v22
MAA 164,36,148
TR 90,16,17504
v_fmac_f32 v71, v31, v22
MAA 164,32,132
TR 92,16,25440
v_fmac_f32 v72, v28, v24
MAA 180,40,132
buffer_load_dwordx4 a[188:191], v11, s[16:19], s53 offen offset:1024 sc1
MAA 180,44,148
TR 94,16,25952
s_add_u32 s53, s53, 131072
MAA 176,44,144
TR 96,16,17024
s_add_u32 m0, s55, 84480
MAA 176,40,128
TR 98,16,17536
v_fmac_f32 v73, v29, v24
MAA 224,48,128
TR 100,16,25472
v_fmac_f32 v74, v30, v24
MAA 224,52,144
TR 102,16,25984
v_fmac_f32 v75, v31, v24
MAA 228,52,148
buffer_load_dwordx4 v12, s[32:35], s54 offen   lds
MAA 228,48,132
TR 104,16,17056
v_fmac_f32 v76, v28, v26
MAA 236,56,132
TR 106,16,17568
v_fmac_f32 v77, v29, v26
MAA 236,60,148
TR 108,16,25504
v_fmac_f32 v78, v30, v26
MAA 232,60,144
TR 110,16,26016
v_fmac_f32 v79, v31, v26
MAA 232,56,128
ds_read_b128 v[28:31], v9 offset:640
s_waitcnt lgkmcnt(15)
v_fmac_f32 v80, v4, v20
s_waitcnt vmcnt(17)
MAA 188,40,140
buffer_load_dwordx4 v13, s[32:35], s54 offen offset:1056   lds
MAA 188,44,156
TR 112,17,16896
v_fmac_f32 v81, v5, v20
MAA 184,44,152
TR 114,17,17408
v_fmac_f32 v82, v6, v20
MAA 184,40,136
TR 116,17,25344
v_fmac_f32 v83, v7, v20
MAA 168,32,136
TR 118,17,25856
v_fmac_f32 v84, v4, v22
MAA 168,36,152
TR 120,17,16928
v_fmac_f32 v85, v5, v22
MAA 172,36,156
buffer_load_dwordx4 v14, s[32:35], s54 offen offset:2112   lds
MAA 172,32,140
TR 122,17,17440
v_fmac_f32 v86, v6, v22
MAA 124,24,140
TR 124,17,25376
v_fmac_f32 v87, v7, v22
MAA 124,28,156
TR 126,17,25888
v_fmac_f32 v88, v4, v24
MAA 120,28,152
v_fmac_f32 v89, v5, v24
v_fmac_f32 v90, v6, v24
MAA 120,24,136
v_fmac_f32 v91, v7, v24
v_fmac_f32 v92, v4, v26
MAA 104,16,136
buffer_load_dwordx4 v15, s[32:35], s54 offen offset:3168   lds
MAA 104,20,152
s_mov_b32 m0, s67
v_fmac_f32 v93, v5, v26
v_fmac_f32 v94, v6, v26
MAA 108,20,156
v_fmac_f32 v95, v7, v26
s_waitcnt lgkmcnt(8)
v_fmac_f32 v128, v28, v20
MAA 108,16,140
ds_read_b128 v[4:7], v8 offset:512
v_fmac_f32 v129, v29, v20
MAA 60,8,140
v_fmac_f32 v130, v30, v20
v_fmac_f32 v131, v31, v20
MAA 60,12,156
v_fmac_f32 v132, v28, v22
v_fmac_f32 v133, v29, v22
MAA 56,12,152
buffer_load_dwordx4 v18, s[28:31], s58 offen lds
MAA 56,8,136
v_fmac_f32 v134, v30, v22
v_fmac_f32 v135, v31, v22
MAA 40,0,136
v_fmac_f32 v136, v28, v24
v_fmac_f32 v137, v29, v24
MAA 40,4,152
v_fmac_f32 v138, v30, v24
v_fmac_f32 v139, v31, v24
MAA 44,4,156
v_fmac_f32 v140, v28, v26
v_fmac_f32 v141, v29, v26
MAA 44,0,140
v_fmac_f32 v142, v30, v26
v_fmac_f32 v143, v31, v26
s_waitcnt lgkmcnt(0)
v_fmac_f32 v240, v4, v20
v_fmac_f32 v241, v5, v20
v_fmac_f32 v242, v6, v20
v_fmac_f32 v243, v7, v20
v_fmac_f32 v244, v4, v22
v_fmac_f32 v245, v5, v22
v_fmac_f32 v246, v6, v22
v_fmac_f32 v247, v7, v22
s_waitcnt vmcnt(17) lgkmcnt(0)
s_barrier
MAA 64,64,128
ds_read_b128 v[28:31], v9
s_add_u32 m0, s55, 101376
MAA 64,68,144
ds_read_b128 v[4:7], v9 offset:64
MAA 68,68,148
buffer_load_dwordx4 v12, s[80:83], s54 offen   lds
MAA 68,64,132
TR 0,16,33792
MAA 84,72,132
TR 2,16,34304
MAA 84,76,148
TR 4,16,42240
MAA 80,76,144
TR 6,16,42752
MAA 80,72,128
TR 8,16,33824
MAA 128,80,128
buffer_load_dwordx4 v13, s[80:83], s54 offen offset:1056   lds
MAA 128,84,144
TR 10,16,34336
s_waitcnt lgkmcnt(7)
v_fmac_f32 v32, v28, v20
MAA 132,84,148
TR 12,16,42272
v_fmac_f32 v33, v29, v20
MAA 132,80,132
TR 14,16,42784
v_fmac_f32 v34, v30, v20
MAA 148,88,132
TR 16,16,33856
v_fmac_f32 v35, v31, v20
MAA 148,92,148
TR 18,16,34368
v_fmac_f32 v36, v28, v22
MAA 144,92,144
buffer_load_dwordx4 v14, s[80:83], s54 offen offset:2112   lds
MAA 144,88,128
TR 20,16,42304
v_fmac_f32 v37, v29, v22
MAA 192,96,128
TR 22,16,42816
v_fmac_f32 v38, v30, v22
MAA 192,100,144
TR 24,16,33888
v_fmac_f32 v39, v31, v22
MAA 196,100,148
TR 26,16,34400
v_fmac_f32 v40, v28, v24
MAA 196,96,132
TR 28,16,42336
v_fmac_f32 v41, v29, v24
MAA 212,104,132
buffer_load_dwordx4 v15, s[80:83], s54 offen offset:3168   lds
MAA 212,108,148
TR 30,16,42848
s_add_u32 s54, s54, 458752
MAA 208,108,144
TR 32,16,33920
s_mov_b32 m0, s67
MAA 208,104,128
TR 34,16,34432
v_fmac_f32 v42, v30, v24
MAA 240,112,128
TR 36,16,42368
v_fmac_f32 v43, v31, v24
MAA 240,116,144
TR 38,16,42880
v_fmac_f32 v44, v28, v26
MAA 244,116,148
buffer_load_dwordx4 v19, s[28:31], s58 offen offset:1056 lds
MAA 244,112,132
TR 40,16,33952
s_add_u32 s67, s67, 8448
MAA 252,120,132
TR 42,16,34464
s_add_u32 s58, s58, 0x40000
MAA 252,124,148
TR 44,16,42400
v_fmac_f32 v45, v29, v26
MAA 248,124,144
TR 46,16,42912
v_fmac_f32 v46, v30, v26
MAA 248,120,128
TR 48,17,33792
v_fmac_f32 v47, v31, v26
MAA 220,104,140
ds_read_b128 v[28:31], v9 offset:128
s_waitcnt lgkmcnt(15)
v_fmac_f32 v48, v4, v20
MAA 220,108,156
buffer_load_dwordx4 a[128:131], v10, s[16:19], s52 offen sc1
MAA 216,108,152
TR 50,17,34304
v_fmac_f32 v49, v5, v20
MAA 216,104,136
TR 52,17,42240
v_fmac_f32 v50, v6, v20
MAA 200,96,136
TR 54,17,42752
v_fmac_f32 v51, v7, v20
MAA 200,100,152
TR 56,17,33824
v_fmac_f32 v52, v4, v22
MAA 204,100,156
TR 58,17,34336
v_fmac_f32 v53, v5, v22
MAA 204,96,140
buffer_load_dwordx4 a[132:135], v10, s[16:19], s52 offen offset:1024 sc1
MAA 156,88,140
TR 60,17,42272
s_add_u32 s52, s52, 131072
MAA 156,92,156
TR 62,17,42784
v_fmac_f32 v54, v6, v22
MAA 152,92,152
v_fmac_f32 v55, v7, v22
v_fmac_f32 v56, v4, v24
MAA 152,88,136
v_fmac_f32 v57, v5, v24
v_fmac_f32 v58, v6, v24
MAA 136,80,136
v_fmac_f32 v59, v7, v24
v_fmac_f32 v60, v4, v26
MAA 136,84,152
.Lpad33:
s_cbranch_execz .Lnopoll60r
buffer_load_dwordx4 a[144:147], v10, s[16:19], s52 offen sc1
MAA 140,84,156
v_fmac_f32 v61, v5, v26
v_fmac_f32 v62, v6, v26
MAA 140,80,140
v_fmac_f32 v63, v7, v26
s_waitcnt lgkmcnt(7)
v_fmac_f32 v96, v28, v20
MAA 92,72,140
ds_read_b128 v[4:7], v8
v_fmac_f32 v97, v29, v20
MAA 92,76,156
v_fmac_f32 v98, v30, v20
v_fmac_f32 v99, v31, v20
MAA 88,76,152
v_fmac_f32 v100, v28, v22
v_fmac_f32 v101, v29, v22
MAA 88,72,136
buffer_load_dwordx4 a[148:151], v10, s[16:19], s52 offen offset:1024 sc1
MAA 72,64,136
s_add_u32 s52, s52, 131072
v_fmac_f32 v102, v30, v22
v_fmac_f32 v103, v31, v22
MAA 72,68,152
v_fmac_f32 v104, v28, v24
v_fmac_f32 v105, v29, v24
MAA 76,68,156
v_fmac_f32 v106, v30, v24
v_fmac_f32 v107, v31, v24
MAA 76,64,140
v_fmac_f32 v108, v28, v26
v_fmac_f32 v109, v29, v26
v_fmac_f32 v110, v30, v26
v_fmac_f32 v111, v31, v26
s_waitcnt lgkmcnt(0)
v_fmac_f32 v224, v4, v20
v_fmac_f32 v225, v5, v20
v_fmac_f32 v226, v6, v20
v_fmac_f32 v227, v7, v20
v_fmac_f32 v228, v4, v22
v_fmac_f32 v229, v5, v22
v_fmac_f32 v230, v6, v22
v_fmac_f32 v231, v7, v22
s_waitcnt vmcnt(18) lgkmcnt(0)
s_barrier
MAA 32,0,160
ds_read_b128 v[28:31], v9 offset:704
MAA 32,4,176
ds_read_b128 v[4:7], v9 offset:768
MAA 36,4,180
buffer_load_dwordx4 a[136:139], v11, s[16:19], s53 offen sc1
MAA 36,0,164
TR 64,16,50688
MAA 52,8,164
TR 66,16,51200
MAA 52,12,180
TR 68,16,59136
MAA 48,12,176
TR 70,16,59648
MAA 48,8,160
TR 72,16,50720
MAA 96,16,160
buffer_load_dwordx4 a[140:143], v11, s[16:19], s53 offen offset:1024 sc1
MAA 96,20,176
TR 74,16,51232
s_add_u32 s53, s53, 131072
MAA 100,20,180
TR 76,16,59168
s_waitcnt lgkmcnt(8)
v_fmac_f32 v144, v28, v20
MAA 100,16,164
TR 78,16,59680
v_fmac_f32 v145, v29, v20
MAA 116,24,164
TR 80,16,50752
v_fmac_f32 v146, v30, v20
MAA 116,28,180
TR 82,16,51264
v_fmac_f32 v147, v31, v20
MAA 112,28,176
buffer_load_dwordx4 a[152:155], v11, s[16:19], s53 offen sc1
MAA 112,24,160
TR 84,16,59200
v_fmac_f32 v148, v28, v22
MAA 160,32,160
TR 86,16,59712
v_fmac_f32 v149, v29, v22
MAA 160,36,176
TR 88,16,50784
v_fmac_f32 v150, v30, v22
MAA 164,36,180
TR 90,16,51296
v_fmac_f32 v151, v31, v22
MAA 164,32,164
TR 92,16,59232
v_fmac_f32 v152, v28, v24
MAA 180,40,164
buffer_load_dwordx4 a[156:159], v11, s[16:19], s53 offen offset:1024 sc1
MAA 180,44,180
TR 94,16,59744
s_add_u32 s53, s53, 131072
MAA 176,44,176
TR 96,16,50816
s_add_u32 m0, s55, 118272
MAA 176,40,160
TR 98,16,51328
v_fmac_f32 v153, v29, v24
MAA 224,48,160
TR 100,16,59264
v_fmac_f32 v154, v30, v24
MAA 224,52,176
TR 102,16,59776
v_fmac_f32 v155, v31, v24
MAA 228,52,180
buffer_load_dwordx4 v12, s[32:35], s54 offen   lds
MAA 228,48,164
TR 104,16,50848
v_fmac_f32 v156, v28, v26
MAA 236,56,164
TR 106,16,51360
v_fmac_f32 v157, v29, v26
MAA 236,60,180
TR 108,16,59296
v_fmac_f32 v158, v30, v26
MAA 232,60,176
TR 110,16,59808
v_fmac_f32 v159, v31, v26
MAA 232,56,160
ds_read_b128 v[28:31], v9 offset:832
s_waitcnt lgkmcnt(15)
v_fmac_f32 v192, v4, v20
s_waitcnt vmcnt(19)
MAA 188,40,172
buffer_load_dwordx4 v13, s[32:35], s54 offen offset:1056   lds
MAA 188,44,188
TR 112,17,50688
v_fmac_f32 v193, v5, v20
MAA 184,44,184
TR 114,17,51200
v_fmac_f32 v194, v6, v20
MAA 184,40,168
TR 116,17,59136
v_fmac_f32 v195, v7, v20
MAA 168,32,168
TR 118,17,59648
v_fmac_f32 v196, v4, v22
MAA 168,36,184
TR 120,17,50720
v_fmac_f32 v197, v5, v22
MAA 172,36,188
buffer_load_dwordx4 v14, s[32:35], s54 offen offset:2112   lds
MAA 172,32,172
TR 122,17,51232
v_fmac_f32 v198, v6, v22
MAA 124,24,172
TR 124,17,59168
v_fmac_f32 v199, v7, v22
MAA 124,28,188
TR 126,17,59680
v_fmac_f32 v200, v4, v24
MAA 120,28,184
v_fmac_f32 v201, v5, v24
v_fmac_f32 v202, v6, v24
MAA 120,24,168
v_fmac_f32 v203, v7, v24
v_fmac_f32 v204, v4, v26
MAA 104,16,168
buffer_load_dwordx4 v15, s[32:35], s54 offen offset:3168   lds
MAA 104,20,184
s_mov_b32 m0, s67
v_fmac_f32 v205, v5, v26
v_fmac_f32 v206, v6, v26
MAA 108,20,188
v_fmac_f32 v207, v7, v26
s_waitcnt lgkmcnt(8)
v_fmac_f32 v208, v28, v20
MAA 108,16,172
ds_read_b128 v[4:7], v8 offset:576
v_fmac_f32 v209, v29, v20
MAA 60,8,172
v_fmac_f32 v210, v30, v20
v_fmac_f32 v211, v31, v20
MAA 60,12,188
v_fmac_f32 v212, v28, v22
v_fmac_f32 v213, v29, v22
MAA 56,12,184
buffer_load_dwordx4 v18, s[28:31], s58 offen lds
MAA 56,8,168
v_fmac_f32 v214, v30, v22
v_fmac_f32 v215, v31, v22
MAA 40,0,168
v_fmac_f32 v216, v28, v24
v_fmac_f32 v217, v29, v24
MAA 40,4,184
v_fmac_f32 v218, v30, v24
v_fmac_f32 v219, v31, v24
MAA 44,4,188
v_fmac_f32 v220, v28, v26
v_fmac_f32 v221, v29, v26
MAA 44,0,172
v_fmac_f32 v222, v30, v26
v_fmac_f32 v223, v31, v26
s_waitcnt lgkmcnt(0)
v_fmac_f32 v248, v4, v20
v_fmac_f32 v249, v5, v20
v_fmac_f32 v250, v6, v20
v_fmac_f32 v251, v7, v20
v_fmac_f32 v252, v4, v22
v_fmac_f32 v253, v5, v22
v_fmac_f32 v254, v6, v22
v_fmac_f32 v255, v7, v22
s_waitcnt vmcnt(19) lgkmcnt(0)
s_barrier
MAA 64,64,160
ds_read_b128 v[28:31], v9 offset:192
s_add_u32 m0, s55, 135168
MAA 64,68,176
ds_read_b128 v[4:7], v9 offset:256
MAA 68,68,180
buffer_load_dwordx4 v12, s[80:83], s54 offen   lds
MAA 68,64,164
ds_read_b64_tr_b16 a[0:1], v16
MAA 84,72,164
TR 2,16,512
MAA 84,76,180
TR 4,16,8448
MAA 80,76,176
TR 6,16,8960
MAA 80,72,160
TR 8,16,32
MAA 128,80,160
buffer_load_dwordx4 v13, s[80:83], s54 offen offset:1056   lds
MAA 128,84,176
TR 10,16,544
s_waitcnt lgkmcnt(7)
v_fmac_f32 v112, v28, v20
MAA 132,84,180
TR 12,16,8480
v_fmac_f32 v113, v29, v20
MAA 132,80,164
TR 14,16,8992
v_fmac_f32 v114, v30, v20
MAA 148,88,164
TR 16,16,64
v_fmac_f32 v115, v31, v20
MAA 148,92,180
TR 18,16,576
v_fmac_f32 v116, v28, v22
MAA 144,92,176
buffer_load_dwordx4 v14, s[80:83], s54 offen offset:2112   lds
MAA 144,88,160
TR 20,16,8512
v_fmac_f32 v117, v29, v22
MAA 192,96,160
TR 22,16,9024
v_fmac_f32 v118, v30, v22
MAA 192,100,176
TR 24,16,96
v_fmac_f32 v119, v31, v22
MAA 196,100,180
TR 26,16,608
v_fmac_f32 v120, v28, v24
MAA 196,96,164
TR 28,16,8544
v_fmac_f32 v121, v29, v24
MAA 212,104,164
buffer_load_dwordx4 v15, s[80:83], s54 offen offset:3168   lds
MAA 212,108,180
TR 30,16,9056
s_add_u32 s54, s54, 458752
MAA 208,108,176
TR 32,16,128
s_mov_b32 m0, s67
MAA 208,104,160
TR 34,16,640
v_fmac_f32 v122, v30, v24
MAA 240,112,160
TR 36,16,8576
v_fmac_f32 v123, v31, v24
MAA 240,116,176
TR 38,16,9088
v_fmac_f32 v124, v28, v26
MAA 244,116,180
buffer_load_dwordx4 v19, s[28:31], s58 offen offset:1056 lds
MAA 244,112,164
TR 40,16,160
s_add_u32 s67, s67, 8448
MAA 252,120,164
TR 42,16,672
s_add_u32 s46, s46, 1
MAA 252,124,180
TR 44,16,8608
s_xor_b32 s58, s46, s87
MAA 248,124,176
TR 46,16,9120
s_mul_i32 s58, s58, 458752
MAA 248,120,160
ds_read_b64_tr_b16 a[48:49], v17
v_fmac_f32 v125, v29, v26
MAA 220,104,172
buffer_load_dwordx4 a[160:163], v10, s[16:19], s52 offen sc1
MAA 220,108,188
TR 50,17,512
v_fmac_f32 v126, v30, v26
MAA 216,108,184
TR 52,17,8448
v_fmac_f32 v127, v31, v26
MAA 216,104,168
ds_read_b128 v[28:31], v9 offset:320
s_waitcnt lgkmcnt(15)
v_fmac_f32 v160, v4, v20
MAA 200,96,168
TR 54,17,8960
v_fmac_f32 v161, v5, v20
MAA 200,100,184
TR 56,17,32
v_fmac_f32 v162, v6, v20
MAA 204,100,188
buffer_load_dwordx4 a[164:167], v10, s[16:19], s52 offen offset:1024 sc1
MAA 204,96,172
TR 58,17,544
s_add_u32 s52, s52, 131072
MAA 156,88,172
TR 60,17,8480
v_fmac_f32 v163, v7, v20
MAA 156,92,188
TR 62,17,8992
v_fmac_f32 v164, v4, v22
MAA 152,92,184
v_fmac_f32 v165, v5, v22
v_fmac_f32 v166, v6, v22
MAA 152,88,168
v_fmac_f32 v167, v7, v22
v_fmac_f32 v168, v4, v24
MAA 136,80,168
buffer_load_dwordx4 a[176:179], v10, s[16:19], s52 offen sc1
MAA 136,84,184
v_fmac_f32 v169, v5, v24
v_fmac_f32 v170, v6, v24
MAA 140,84,188
v_fmac_f32 v171, v7, v24
v_fmac_f32 v172, v4, v26
MAA 140,80,172
v_fmac_f32 v173, v5, v26
v_fmac_f32 v174, v6, v26
MAA 92,72,172
v_fmac_f32 v175, v7, v26
s_waitcnt lgkmcnt(5)
v_fmac_f32 v176, v28, v20
MAA 92,76,188
ds_read_b128 v[4:7], v8 offset:64
v_fmac_f32 v177, v29, v20
MAA 88,76,184
buffer_load_dwordx4 a[180:183], v10, s[16:19], s52 offen offset:1024 sc1
MAA 88,72,168
s_add_u32 s52, s52, 131072
v_fmac_f32 v178, v30, v20
v_fmac_f32 v179, v31, v20
MAA 72,64,168
v_fmac_f32 v180, v28, v22
v_fmac_f32 v181, v29, v22
MAA 72,68,184
v_fmac_f32 v182, v30, v22
v_fmac_f32 v183, v31, v22
MAA 76,68,188
v_fmac_f32 v184, v28, v24
v_fmac_f32 v185, v29, v24
MAA 76,64,172
v_fmac_f32 v186, v30, v24
v_fmac_f32 v187, v31, v24
v_fmac_f32 v188, v28, v26
v_fmac_f32 v189, v29, v26
v_fmac_f32 v190, v30, v26
v_fmac_f32 v191, v31, v26
v_accvgpr_read_b32 v28, a192
s_waitcnt lgkmcnt(0)
v_fmac_f32 v232, v4, v20
v_fmac_f32 v233, v5, v20
v_fmac_f32 v234, v6, v20
v_fmac_f32 v235, v7, v20
v_fmac_f32 v236, v4, v22
v_fmac_f32 v237, v5, v22
v_fmac_f32 v238, v6, v22
v_fmac_f32 v239, v7, v22
v_accvgpr_read_b32 v29, a193
v_accvgpr_read_b32 v30, a194
v_accvgpr_read_b32 v31, a195
s_mov_b32 s15, -4
.p2align 6
.Lk65:
s_waitcnt vmcnt(18) lgkmcnt(0)
s_barrier
MAA 32,0,128
TR 64,16,16896
MAA 32,4,144
buffer_load_dwordx4 a[168:171], v11, s[16:19], s53 offen sc1
MAA 36,4,148
TR 66,16,17408
MAA 36,0,132
TR 68,16,25344
MAA 52,8,132
TR 70,16,25856
MAA 52,12,148
MAA 48,12,144
TR 72,16,16928
MAA 48,8,128
buffer_load_dwordx4 a[172:175], v11, s[16:19], s53 offen offset:1024 sc1
MAA 96,16,128
TR 74,16,17440
s_add_u32 s53, s53, 131072
MAA 96,20,144
TR 76,16,25376
MAA 100,20,148
MAA 100,16,132
TR 78,16,25888
MAA 116,24,132
TR 80,16,16960
MAA 116,28,148
buffer_load_dwordx4 a[184:187], v11, s[16:19], s53 offen sc1
MAA 112,28,144
TR 82,16,17472
MAA 112,24,128
MAA 160,32,128
TR 84,16,25408
MAA 160,36,144
TR 86,16,25920
MAA 164,36,148
TR 88,16,16992
MAA 164,32,132
buffer_load_dwordx4 a[188:191], v11, s[16:19], s53 offen offset:1024 sc1
MAA 180,40,132
s_add_u32 s53, s53, 131072
MAA 180,44,148
TR 90,16,17504
MAA 176,44,144
TR 92,16,25440
MAA 176,40,128
TR 94,16,25952
MAA 224,48,128
s_add_u32 m0, s55, 84480
MAA 224,52,144
buffer_load_dwordx4 v12, s[32:35], s54 offen   lds
MAA 228,52,148
TR 96,16,17024
MAA 228,48,132
TR 98,16,17536
MAA 236,56,132
TR 100,16,25472
MAA 236,60,148
TR 102,16,25984
MAA 232,60,144
MAA 232,56,128
TR 104,16,17056
s_waitcnt vmcnt(19)
MAA 188,40,140
TR 106,16,17568
MAA 188,44,156
buffer_load_dwordx4 v13, s[32:35], s54 offen offset:1056   lds
MAA 184,44,152
TR 108,16,25504
MAA 184,40,136
MAA 168,32,136
TR 110,16,26016
MAA 168,36,152
buffer_load_dwordx4 v14, s[32:35], s54 offen offset:2112   lds
MAA 172,36,156
TR 112,17,16896
MAA 172,32,140
TR 114,17,17408
MAA 124,24,140
MAA 124,28,156
TR 116,17,25344
MAA 120,28,152
TR 118,17,25856
MAA 120,24,136
buffer_load_dwordx4 v15, s[32:35], s54 offen offset:3168   lds
MAA 104,16,136
TR 120,17,16928
MAA 104,20,152
MAA 108,20,156
TR 122,17,17440
MAA 108,16,140
TR 124,17,25376
MAA 60,8,140
TR 126,17,25888
s_mov_b32 m0, s67
MAA 60,12,156
buffer_load_dwordx4 v18, s[28:31], s58 offen lds
MAA 56,12,152
MAA 56,8,136
MAA 40,0,136
MAA 40,4,152
MAA 44,4,156
MAA 44,0,140
s_waitcnt vmcnt(19) lgkmcnt(0)
s_barrier
MAA 64,64,128
TR 0,16,33792
s_add_u32 m0, s55, 101376
MAA 64,68,144
buffer_load_dwordx4 v12, s[80:83], s54 offen   lds
MAA 68,68,148
TR 2,16,34304
MAA 68,64,132
TR 4,16,42240
MAA 84,72,132
TR 6,16,42752
MAA 84,76,148
MAA 80,76,144
TR 8,16,33824
MAA 80,72,128
buffer_load_dwordx4 v13, s[80:83], s54 offen offset:1056   lds
MAA 128,80,128
TR 10,16,34336
MAA 128,84,144
TR 12,16,42272
MAA 132,84,148
TR 14,16,42784
MAA 132,80,132
MAA 148,88,132
TR 16,16,33856
MAA 148,92,148
buffer_load_dwordx4 v14, s[80:83], s54 offen offset:2112   lds
MAA 144,92,144
TR 18,16,34368
MAA 144,88,128
TR 20,16,42304
MAA 192,96,128
MAA 192,100,144
TR 22,16,42816
MAA 196,100,148
TR 24,16,33888
MAA 196,96,132
buffer_load_dwordx4 v15, s[80:83], s54 offen offset:3168   lds
MAA 212,104,132
TR 26,16,34400
s_add_u32 s54, s54, 458752
MAA 212,108,148
TR 28,16,42336
MAA 208,108,144
MAA 208,104,128
TR 30,16,42848
MAA 240,112,128
TR 32,16,33920
s_mov_b32 m0, s67
MAA 240,116,144
buffer_load_dwordx4 v19, s[28:31], s58 offen offset:1056 lds
MAA 244,116,148
s_add_u32 s67, s67, 8448
s_add_u32 s58, s58, 0x40000
MAA 244,112,132
TR 34,16,34432
MAA 252,120,132
MAA 252,124,148
TR 36,16,42368
MAA 248,124,144
TR 38,16,42880
MAA 248,120,128
buffer_load_dwordx4 a[128:131], v10, s[16:19], s52 offen sc1
MAA 220,104,140
TR 40,16,33952
MAA 220,108,156
TR 42,16,34464
MAA 216,108,152
MAA 216,104,136
TR 44,16,42400
MAA 200,96,136
TR 46,16,42912
MAA 200,100,152
buffer_load_dwordx4 a[132:135], v10, s[16:19], s52 offen offset:1024 sc1
MAA 204,100,156
TR 48,17,33792
s_add_u32 s52, s52, 131072
MAA 204,96,140
MAA 156,88,140
TR 50,17,34304
MAA 156,92,156
TR 52,17,42240
MAA 152,92,152
TR 54,17,42752
MAA 152,88,136
buffer_load_dwordx4 a[144:147], v10, s[16:19], s52 offen sc1
MAA 136,80,136
TR 56,17,33824
MAA 136,84,152
MAA 140,84,156
TR 58,17,34336
MAA 140,80,140
TR 60,17,42272
MAA 92,72,140
TR 62,17,42784
MAA 92,76,156
buffer_load_dwordx4 a[148:151], v10, s[16:19], s52 offen offset:1024 sc1
MAA 88,76,152
.Lpad34:
s_cbranch_execz .Lnopoll60r
s_add_u32 s52, s52, 131072
MAA 88,72,136
MAA 72,64,136
MAA 72,68,152
MAA 76,68,156
MAA 76,64,140
s_waitcnt vmcnt(18) lgkmcnt(0)
s_barrier
MAA 32,0,160
TR 64,16,50688
MAA 32,4,176
buffer_load_dwordx4 a[136:139], v11, s[16:19], s53 offen sc1
MAA 36,4,180
TR 66,16,51200
MAA 36,0,164
TR 68,16,59136
MAA 52,8,164
TR 70,16,59648
MAA 52,12,180
MAA 48,12,176
TR 72,16,50720
MAA 48,8,160
buffer_load_dwordx4 a[140:143], v11, s[16:19], s53 offen offset:1024 sc1
MAA 96,16,160
TR 74,16,51232
s_add_u32 s53, s53, 131072
MAA 96,20,176
TR 76,16,59168
MAA 100,20,180
MAA 100,16,164
TR 78,16,59680
MAA 116,24,164
TR 80,16,50752
MAA 116,28,180
buffer_load_dwordx4 a[152:155], v11, s[16:19], s53 offen sc1
MAA 112,28,176
TR 82,16,51264
MAA 112,24,160
MAA 160,32,160
TR 84,16,59200
MAA 160,36,176
TR 86,16,59712
MAA 164,36,180
TR 88,16,50784
MAA 164,32,164
buffer_load_dwordx4 a[156:159], v11, s[16:19], s53 offen offset:1024 sc1
MAA 180,40,164
s_add_u32 s53, s53, 131072
MAA 180,44,180
TR 90,16,51296
MAA 176,44,176
TR 92,16,59232
MAA 176,40,160
TR 94,16,59744
MAA 224,48,160
s_add_u32 m0, s55, 118272
MAA 224,52,176
buffer_load_dwordx4 v12, s[32:35], s54 offen   lds
MAA 228,52,180
TR 96,16,50816
MAA 228,48,164
TR 98,16,51328
MAA 236,56,164
TR 100,16,59264
MAA 236,60,180
TR 102,16,59776
MAA 232,60,176
MAA 232,56,160
TR 104,16,50848
s_waitcnt vmcnt(19)
MAA 188,40,172
TR 106,16,51360
MAA 188,44,188
buffer_load_dwordx4 v13, s[32:35], s54 offen offset:1056   lds
MAA 184,44,184
TR 108,16,59296
MAA 184,40,168
MAA 168,32,168
TR 110,16,59808
MAA 168,36,184
buffer_load_dwordx4 v14, s[32:35], s54 offen offset:2112   lds
MAA 172,36,188
TR 112,17,50688
MAA 172,32,172
TR 114,17,51200
MAA 124,24,172
MAA 124,28,188
TR 116,17,59136
MAA 120,28,184
TR 118,17,59648
MAA 120,24,168
buffer_load_dwordx4 v15, s[32:35], s54 offen offset:3168   lds
MAA 104,16,168
TR 120,17,50720
MAA 104,20,184
MAA 108,20,188
TR 122,17,51232
MAA 108,16,172
TR 124,17,59168
MAA 60,8,172
TR 126,17,59680
s_mov_b32 m0, s67
MAA 60,12,188
buffer_load_dwordx4 v18, s[28:31], s58 offen lds
MAA 56,12,184
MAA 56,8,168
MAA 40,0,168
MAA 40,4,184
MAA 44,4,188
MAA 44,0,172
s_waitcnt vmcnt(19) lgkmcnt(0)
s_barrier
MAA 64,64,160
ds_read_b64_tr_b16 a[0:1], v16
s_add_u32 m0, s55, 135168
MAA 64,68,176
buffer_load_dwordx4 v12, s[80:83], s54 offen   lds
MAA 68,68,180
TR 2,16,512
MAA 68,64,164
TR 4,16,8448
MAA 84,72,164
TR 6,16,8960
MAA 84,76,180
MAA 80,76,176
TR 8,16,32
MAA 80,72,160
buffer_load_dwordx4 v13, s[80:83], s54 offen offset:1056   lds
MAA 128,80,160
TR 10,16,544
MAA 128,84,176
TR 12,16,8480
MAA 132,84,180
TR 14,16,8992
MAA 132,80,164
MAA 148,88,164
TR 16,16,64
MAA 148,92,180
buffer_load_dwordx4 v14, s[80:83], s54 offen offset:2112   lds
MAA 144,92,176
TR 18,16,576
MAA 144,88,160
TR 20,16,8512
MAA 192,96,160
MAA 192,100,176
TR 22,16,9024
MAA 196,100,180
TR 24,16,96
MAA 196,96,164
buffer_load_dwordx4 v15, s[80:83], s54 offen offset:3168   lds
MAA 212,104,164
TR 26,16,608
s_add_u32 s54, s54, 458752
MAA 212,108,180
TR 28,16,8544
MAA 208,108,176
MAA 208,104,160
TR 30,16,9056
MAA 240,112,160
TR 32,16,128
s_mov_b32 m0, s67
MAA 240,116,176
buffer_load_dwordx4 v19, s[28:31], s58 offen offset:1056 lds
MAA 244,116,180
s_add_u32 s67, s67, 8448
s_add_u32 s46, s46, 1
s_xor_b32 s58, s46, s87
s_mul_i32 s58, s58, 458752
MAA 244,112,164
TR 34,16,640
MAA 252,120,164
MAA 252,124,180
TR 36,16,8576
MAA 248,124,176
TR 38,16,9088
MAA 248,120,160
buffer_load_dwordx4 a[160:163], v10, s[16:19], s52 offen sc1
MAA 220,104,172
TR 40,16,160
MAA 220,108,188
TR 42,16,672
MAA 216,108,184
MAA 216,104,168
TR 44,16,8608
MAA 200,96,168
TR 46,16,9120
MAA 200,100,184
buffer_load_dwordx4 a[164:167], v10, s[16:19], s52 offen offset:1024 sc1
MAA 204,100,188
ds_read_b64_tr_b16 a[48:49], v17
s_add_u32 s52, s52, 131072
MAA 204,96,172
MAA 156,88,172
TR 50,17,512
MAA 156,92,188
TR 52,17,8448
MAA 152,92,184
TR 54,17,8960
MAA 152,88,168
buffer_load_dwordx4 a[176:179], v10, s[16:19], s52 offen sc1
MAA 136,80,168
TR 56,17,32
MAA 136,84,184
MAA 140,84,188
TR 58,17,544
MAA 140,80,172
TR 60,17,8480
MAA 92,72,172
TR 62,17,8992
MAA 92,76,188
buffer_load_dwordx4 a[180:183], v10, s[16:19], s52 offen offset:1024 sc1
MAA 88,76,184
s_add_u32 s52, s52, 131072
MAA 88,72,168
MAA 72,64,168
MAA 72,68,184
MAA 76,68,188
s_add_u32 s15, s15, 1
MAA 76,64,172
s_cbranch_scc0 .Lk65
s_waitcnt vmcnt(10) lgkmcnt(0)
s_barrier
MAA 32,0,128
buffer_load_dwordx4 a[168:171], v11, s[16:19], s53 offen sc1
MAA 32,4,144
TR 64,16,16896
s_add_u32 s58, s99, 2293760
MAA 48,12,144
TR 66,16,17408
s_lshl_b32 s74, s3, 11
MAA 48,8,128
TR 68,16,25344
s_add_u32 s74, s74, s84
MAA 36,0,132
buffer_load_dwordx4 a[172:175], v11, s[16:19], s53 offen offset:1024 sc1
MAA 36,4,148
TR 70,16,25856
s_add_u32 s53, s53, 131072
MAA 52,12,148
TR 72,16,16928
v_lshl_add_u32 v4, v1, 4, s74
MAA 52,8,132
TR 74,16,17440
v_lshrrev_b32 v2, 3, v1
MAA 40,0,136
buffer_load_dwordx4 a[184:187], v11, s[16:19], s53 offen sc1
MAA 40,4,152
TR 76,16,25376
v_cmp_eq_u32 vcc, 3, v2
MAA 56,12,152
TR 78,16,25888
v_add_u32 v2, 67108480, v4
MAA 56,8,136
TR 80,16,33792
v_cndmask_b32 v4, v4, v2, vcc
MAA 44,0,140
buffer_load_dwordx4 a[188:191], v11, s[16:19], s53 offen offset:1024 sc1
MAA 44,4,156
TR 82,16,34304
s_add_u32 s53, s53, 131072
MAA 60,12,156
TR 84,16,42240
s_and_b32 s74, s7, 1
MAA 60,8,140
TR 86,16,42752
s_add_u32 s54, s98, 65536
MAA 96,16,128
TR 88,16,33824
v_bfe_u32 v7, v1, 2, 3
MAA 96,20,144
TR 90,16,34336
v_mul_u32_u24 v7, 1056, v7
MAA 112,28,144
TR 92,16,42272
s_waitcnt vmcnt(9)
s_barrier
MAA 112,24,128
TR 94,16,42784
v_bfe_u32 v2, v1, 5, 1
MAA 100,16,132
TR 96,16,50688
v_lshl_add_u32 v7, v2, 8, v7
MAA 100,20,148
TR 98,16,51200
v_and_b32 v2, 3, v1
MAA 116,28,148
TR 100,16,59136
v_lshl_add_u32 v7, v2, 3, v7
MAA 116,24,132
TR 102,16,59648
s_lshl_b32 s74, s74, 7
MAA 104,16,136
TR 104,16,50720
s_xor_b32 s75, s74, 128
MAA 104,20,152
TR 106,16,51232
v_add_u32 v6, s75, v7
MAA 120,28,152
TR 108,16,59168
v_add_u32 v7, s74, v7
MAA 120,24,136
TR 110,16,59680
s_mul_i32 s55, s3, 2112
MAA 108,16,140
TR 112,16,16960
s_mov_b32 s57, 67584
MAA 108,20,156
TR 114,16,17472
MAA 124,28,156
TR 116,16,25408
MAA 124,24,140
TR 118,16,25920
MAA 160,32,128
TR 120,16,16992
MAA 160,36,144
TR 122,16,17504
MAA 176,44,144
TR 124,16,25440
MAA 176,40,128
TR 126,16,25952
MAA 164,32,132
TR 192,16,33856
MAA 164,36,148
TR 194,16,34368
MAA 180,44,148
TR 196,16,42304
MAA 180,40,132
TR 198,16,42816
MAA 168,32,136
TR 200,16,33888
MAA 168,36,152
TR 202,16,34400
MAA 184,44,152
TR 204,16,42336
MAA 184,40,136
TR 206,16,42848
MAA 172,32,140
TR 208,16,50752
MAA 172,36,156
TR 210,16,51264
MAA 188,44,156
TR 212,16,59200
MAA 188,40,140
TR 214,16,59712
MAA 224,48,128
TR 216,16,50784
MAA 224,52,144
TR 218,16,51296
MAA 232,60,144
TR 220,16,59232
MAA 232,56,128
TR 222,16,59744
MAA 228,48,132
TR 0,16,17024
MAA 228,52,148
TR 2,16,17536
MAA 236,60,148
TR 4,16,25472
MAA 236,56,132
TR 6,16,25984
s_waitcnt lgkmcnt(15)
MAA 64,64,128
TR 8,16,17056
MAA 64,68,144
TR 10,16,17568
s_waitcnt vmcnt(7)
MAA 64,96,160
TR 12,16,25504
s_waitcnt vmcnt(5)
MAA 64,100,176
TR 14,16,26016
MAA 80,108,176
TR 16,16,33920
MAA 80,104,160
TR 18,16,34432
MAA 80,76,144
TR 20,16,42368
MAA 80,72,128
TR 22,16,42880
MAA 32,80,160
TR 24,16,33952
MAA 32,84,176
TR 26,16,34464
MAA 48,92,176
TR 28,16,42400
MAA 48,88,160
TR 30,16,42912
s_nop 2
v_pk_mul_f32 v[64:65], v[64:65], v[32:33]
TR 32,16,50816
TR 34,16,51328
v_pk_mul_f32 v[32:33], v[32:33], v[28:29] op_sel_hi:[1,0]
v_pk_mul_f32 v[66:67], v[66:67], v[34:35]
v_pk_mul_f32 v[34:35], v[34:35], v[28:29] op_sel_hi:[1,0]
v_exp_f32 v32, v32
v_pk_mul_f32 v[80:81], v[80:81], v[48:49]
v_pk_mul_f32 v[48:49], v[48:49], v[28:29] op_sel_hi:[1,0]
v_pk_mul_f32 v[82:83], v[82:83], v[50:51]
v_pk_mul_f32 v[50:51], v[50:51], v[28:29] op_sel_hi:[1,0]
v_exp_f32 v33, v33
v_exp_f32 v34, v34
MAA 68,64,132
TR 36,16,59264
v_exp_f32 v35, v35
MAA 68,68,148
TR 38,16,59776
v_exp_f32 v48, v48
MAA 68,96,164
TR 40,16,50848
v_exp_f32 v49, v49
s_waitcnt vmcnt(4)
MAA 68,100,180
TR 42,16,51360
v_exp_f32 v50, v50
MAA 84,108,180
TR 44,16,59296
v_exp_f32 v51, v51
MAA 84,104,164
TR 46,16,59808
MAA 84,76,148
TR 48,17,16896
MAA 84,72,132
TR 50,17,17408
MAA 36,80,164
TR 52,17,25344
MAA 36,84,180
TR 54,17,25856
MAA 52,92,180
TR 56,17,16928
MAA 52,88,164
TR 58,17,17440
s_nop 2
v_pk_mul_f32 v[68:69], v[68:69], v[36:37]
v_pk_fma_f32 v[32:33], v[32:33], v[20:21], v[20:21] op_sel:[0,1,1] op_sel_hi:[1,1,1]
v_pk_fma_f32 v[34:35], v[34:35], v[20:21], v[20:21] op_sel:[0,1,1] op_sel_hi:[1,1,1]
v_pk_mul_f32 v[36:37], v[36:37], v[28:29] op_sel:[0,1] op_sel_hi:[1,1]
v_pk_mul_f32 v[70:71], v[70:71], v[38:39]
v_pk_mul_f32 v[38:39], v[38:39], v[28:29] op_sel:[0,1] op_sel_hi:[1,1]
v_pk_fma_f32 v[48:49], v[48:49], v[20:21], v[20:21] op_sel:[0,1,1] op_sel_hi:[1,1,1]
v_pk_mul_f32 v[84:85], v[84:85], v[52:53]
v_pk_mul_f32 v[52:53], v[52:53], v[28:29] op_sel:[0,1] op_sel_hi:[1,1]
v_pk_mul_f32 v[86:87], v[86:87], v[54:55]
v_pk_mul_f32 v[54:55], v[54:55], v[28:29] op_sel:[0,1] op_sel_hi:[1,1]
v_pk_fma_f32 v[50:51], v[50:51], v[20:21], v[20:21] op_sel:[0,1,1] op_sel_hi:[1,1,1]
v_rcp_f32 v32, v32
v_rcp_f32 v33, v33
MAA 72,64,136
TR 60,17,25376
v_rcp_f32 v34, v34
MAA 72,68,152
TR 62,17,25888
v_rcp_f32 v35, v35
s_waitcnt vmcnt(3)
MAA 72,96,168
v_rcp_f32 v48, v48
s_waitcnt vmcnt(1)
MAA 72,100,184
v_rcp_f32 v49, v49
MAA 88,108,184
v_rcp_f32 v50, v50
MAA 88,104,168
v_rcp_f32 v51, v51
MAA 88,76,152
v_exp_f32 v36, v36
MAA 88,72,136
v_exp_f32 v37, v37
MAA 40,80,168
v_exp_f32 v38, v38
MAA 40,84,184
v_exp_f32 v39, v39
MAA 56,92,184
v_exp_f32 v52, v52
MAA 56,88,168
v_exp_f32 v53, v53
v_exp_f32 v54, v54
v_exp_f32 v55, v55
v_pk_mul_f32 v[64:65], v[64:65], v[32:33]
v_pk_mul_f32 v[66:67], v[66:67], v[34:35]
v_pk_mul_f32 v[80:81], v[80:81], v[48:49]
v_pk_mul_f32 v[82:83], v[82:83], v[50:51]
v_pk_mul_f32 v[72:73], v[72:73], v[40:41]
v_pk_mul_f32 v[40:41], v[40:41], v[30:31] op_sel_hi:[1,0]
v_pk_mul_f32 v[74:75], v[74:75], v[42:43]
v_pk_mul_f32 v[42:43], v[42:43], v[30:31] op_sel_hi:[1,0]
v_pk_mul_f32 v[88:89], v[88:89], v[56:57]
v_pk_mul_f32 v[56:57], v[56:57], v[30:31] op_sel_hi:[1,0]
v_pk_mul_f32 v[90:91], v[90:91], v[58:59]
v_pk_mul_f32 v[58:59], v[58:59], v[30:31] op_sel_hi:[1,0]
v_pk_fma_f32 v[36:37], v[36:37], v[22:23], v[22:23] op_sel:[0,1,1] op_sel_hi:[1,1,1]
v_pk_fma_f32 v[38:39], v[38:39], v[22:23], v[22:23] op_sel:[0,1,1] op_sel_hi:[1,1,1]
v_pk_fma_f32 v[52:53], v[52:53], v[22:23], v[22:23] op_sel:[0,1,1] op_sel_hi:[1,1,1]
v_pk_fma_f32 v[54:55], v[54:55], v[22:23], v[22:23] op_sel:[0,1,1] op_sel_hi:[1,1,1]
v_cvt_pk_bf16_f32 v32, v64, v65
v_cvt_pk_bf16_f32 v33, v66, v67
v_cvt_pk_bf16_f32 v34, v80, v81
v_cvt_pk_bf16_f32 v35, v82, v83
MAA 76,64,140
buffer_store_dwordx4 v[32:35], v10, s[16:19], s62 offen sc1
MAA 76,68,156
TR 64,17,33792
v_rcp_f32 v36, v36
MAA 76,96,172
TR 66,17,34304
v_rcp_f32 v37, v37
s_waitcnt vmcnt(1)
MAA 76,100,188
TR 68,17,42240
v_rcp_f32 v38, v38
MAA 92,108,188
TR 70,17,42752
v_rcp_f32 v39, v39
MAA 92,104,172
v_rcp_f32 v52, v52
MAA 92,76,156
TR 76,17,42272
v_rcp_f32 v53, v53
MAA 92,72,140
TR 72,17,33824
v_rcp_f32 v54, v54
MAA 44,80,172
TR 74,17,34336
v_rcp_f32 v55, v55
MAA 44,84,188
TR 78,17,42784
v_exp_f32 v40, v40
MAA 60,92,188
TR 80,17,50688
v_exp_f32 v41, v41
MAA 60,88,172
TR 82,17,51200
v_exp_f32 v42, v42
v_exp_f32 v43, v43
v_exp_f32 v56, v56
v_exp_f32 v57, v57
v_exp_f32 v58, v58
v_exp_f32 v59, v59
v_pk_mul_f32 v[68:69], v[68:69], v[36:37]
v_pk_mul_f32 v[70:71], v[70:71], v[38:39]
v_pk_mul_f32 v[84:85], v[84:85], v[52:53]
v_pk_mul_f32 v[86:87], v[86:87], v[54:55]
v_pk_mul_f32 v[76:77], v[76:77], v[44:45]
v_pk_mul_f32 v[44:45], v[44:45], v[30:31] op_sel:[0,1] op_sel_hi:[1,1]
v_pk_mul_f32 v[78:79], v[78:79], v[46:47]
v_pk_mul_f32 v[46:47], v[46:47], v[30:31] op_sel:[0,1] op_sel_hi:[1,1]
v_pk_mul_f32 v[92:93], v[92:93], v[60:61]
v_pk_mul_f32 v[60:61], v[60:61], v[30:31] op_sel:[0,1] op_sel_hi:[1,1]
v_pk_mul_f32 v[94:95], v[94:95], v[62:63]
v_pk_mul_f32 v[62:63], v[62:63], v[30:31] op_sel:[0,1] op_sel_hi:[1,1]
.Lpad35:
s_cbranch_execz .Lpad38
v_pk_fma_f32 v[40:41], v[40:41], v[24:25], v[24:25] op_sel:[0,1,1] op_sel_hi:[1,1,1]
v_pk_fma_f32 v[42:43], v[42:43], v[24:25], v[24:25] op_sel:[0,1,1] op_sel_hi:[1,1,1]
v_pk_fma_f32 v[56:57], v[56:57], v[24:25], v[24:25] op_sel:[0,1,1] op_sel_hi:[1,1,1]
v_pk_fma_f32 v[58:59], v[58:59], v[24:25], v[24:25] op_sel:[0,1,1] op_sel_hi:[1,1,1]
v_cvt_pk_bf16_f32 v36, v68, v69
v_cvt_pk_bf16_f32 v37, v70, v71
v_cvt_pk_bf16_f32 v38, v84, v85
v_cvt_pk_bf16_f32 v39, v86, v87
MAA 128,112,128
buffer_store_dwordx4 v[36:39], v10, s[16:19], s62 offen offset:1024 sc1
MAA 128,116,144
TR 84,17,59136
v_rcp_f32 v40, v40
s_waitcnt lgkmcnt(15)
MAA 128,208,160
TR 86,17,59648
v_rcp_f32 v41, v41
MAA 128,212,176
TR 88,17,50720
v_rcp_f32 v42, v42
MAA 144,220,176
TR 90,17,51232
v_rcp_f32 v43, v43
MAA 144,216,160
TR 92,17,59168
v_rcp_f32 v56, v56
MAA 144,124,144
TR 94,17,59680
v_rcp_f32 v57, v57
MAA 144,120,128
v_rcp_f32 v58, v58
MAA 96,192,160
v_rcp_f32 v59, v59
MAA 96,196,176
v_exp_f32 v44, v44
MAA 112,204,176
v_exp_f32 v45, v45
MAA 112,200,160
v_lshrrev_b32 v69, 2, v0
v_min_u32 v69, 1, v69
v_lshlrev_b32 v69, 28, v69
v_lshl_add_u32 v68, v0, 7, v69
v_xor_b32 v69, 64, v0
v_min_u32 v69, 1, v69
v_lshlrev_b32 v70, 4, v69
v_sub_u32 v70, 16, v70
v_lshlrev_b32 v69, 28, v69
v_mov_b32 v71, 1
s_waitcnt lgkmcnt(0)
s_barrier
v_mov_b32 v84, 0
v_mov_b32 v85, 0
v_mov_b32 v86, 0
v_exp_f32 v46, v46
v_exp_f32 v47, v47
v_exp_f32 v60, v60
v_exp_f32 v61, v61
v_exp_f32 v62, v62
v_exp_f32 v63, v63
v_pk_mul_f32 v[72:73], v[72:73], v[40:41]
v_pk_mul_f32 v[74:75], v[74:75], v[42:43]
v_pk_mul_f32 v[88:89], v[88:89], v[56:57]
v_pk_mul_f32 v[90:91], v[90:91], v[58:59]
v_pk_mul_f32 v[128:129], v[128:129], v[96:97]
v_pk_mul_f32 v[96:97], v[96:97], v[28:29] op_sel_hi:[1,0]
v_pk_mul_f32 v[130:131], v[130:131], v[98:99]
v_pk_mul_f32 v[98:99], v[98:99], v[28:29] op_sel_hi:[1,0]
v_pk_mul_f32 v[144:145], v[144:145], v[112:113]
v_pk_mul_f32 v[112:113], v[112:113], v[28:29] op_sel_hi:[1,0]
v_pk_mul_f32 v[146:147], v[146:147], v[114:115]
v_pk_mul_f32 v[114:115], v[114:115], v[28:29] op_sel_hi:[1,0]
v_pk_fma_f32 v[44:45], v[44:45], v[26:27], v[26:27] op_sel:[0,1,1] op_sel_hi:[1,1,1]
v_pk_fma_f32 v[46:47], v[46:47], v[26:27], v[26:27] op_sel:[0,1,1] op_sel_hi:[1,1,1]
v_pk_fma_f32 v[60:61], v[60:61], v[26:27], v[26:27] op_sel:[0,1,1] op_sel_hi:[1,1,1]
v_pk_fma_f32 v[62:63], v[62:63], v[26:27], v[26:27] op_sel:[0,1,1] op_sel_hi:[1,1,1]
v_cvt_pk_bf16_f32 v40, v72, v73
v_cvt_pk_bf16_f32 v41, v74, v75
v_cvt_pk_bf16_f32 v42, v88, v89
v_cvt_pk_bf16_f32 v43, v90, v91
MAA 132,112,132
buffer_store_dwordx4 v[40:43], v11, s[16:19], s62 offen sc1
MAA 132,116,148
s_add_u32 m0, s59, 84480
v_rcp_f32 v44, v44
MAA 132,208,164
v_rcp_f32 v45, v45
MAA 132,212,180
v_rcp_f32 v46, v46
MAA 148,220,180
buffer_load_dwordx4 v18, s[28:31], s58 offen lds
MAA 148,216,164
v_rcp_f32 v47, v47
MAA 148,124,148
v_rcp_f32 v60, v60
MAA 148,120,132
v_rcp_f32 v61, v61
MAA 100,192,164
buffer_load_dwordx4 v19, s[28:31], s58 offen offset:1056 lds
MAA 100,196,180
s_add_u32 m0, s59, 92928
s_add_u32 s58, s99, 2555904
v_rcp_f32 v62, v62
MAA 116,204,180
v_rcp_f32 v63, v63
MAA 116,200,164
v_exp_f32 v96, v96
v_exp_f32 v97, v97
v_exp_f32 v98, v98
v_exp_f32 v99, v99
v_exp_f32 v112, v112
v_exp_f32 v113, v113
v_exp_f32 v114, v114
v_exp_f32 v115, v115
v_pk_mul_f32 v[76:77], v[76:77], v[44:45]
v_pk_mul_f32 v[78:79], v[78:79], v[46:47]
v_pk_mul_f32 v[92:93], v[92:93], v[60:61]
v_pk_mul_f32 v[94:95], v[94:95], v[62:63]
v_pk_mul_f32 v[132:133], v[132:133], v[100:101]
v_pk_mul_f32 v[100:101], v[100:101], v[28:29] op_sel:[0,1] op_sel_hi:[1,1]
v_pk_mul_f32 v[134:135], v[134:135], v[102:103]
v_pk_mul_f32 v[102:103], v[102:103], v[28:29] op_sel:[0,1] op_sel_hi:[1,1]
v_pk_mul_f32 v[148:149], v[148:149], v[116:117]
v_pk_mul_f32 v[116:117], v[116:117], v[28:29] op_sel:[0,1] op_sel_hi:[1,1]
v_pk_mul_f32 v[150:151], v[150:151], v[118:119]
v_pk_mul_f32 v[118:119], v[118:119], v[28:29] op_sel:[0,1] op_sel_hi:[1,1]
v_pk_fma_f32 v[96:97], v[96:97], v[20:21], v[20:21] op_sel:[0,1,1] op_sel_hi:[1,1,1]
v_pk_fma_f32 v[98:99], v[98:99], v[20:21], v[20:21] op_sel:[0,1,1] op_sel_hi:[1,1,1]
v_pk_fma_f32 v[112:113], v[112:113], v[20:21], v[20:21] op_sel:[0,1,1] op_sel_hi:[1,1,1]
v_pk_fma_f32 v[114:115], v[114:115], v[20:21], v[20:21] op_sel:[0,1,1] op_sel_hi:[1,1,1]
v_cvt_pk_bf16_f32 v44, v76, v77
v_cvt_pk_bf16_f32 v45, v78, v79
v_cvt_pk_bf16_f32 v46, v92, v93
v_cvt_pk_bf16_f32 v47, v94, v95
MAA 136,112,136
buffer_store_dwordx4 v[44:47], v11, s[16:19], s62 offen offset:1024 sc1
MAA 136,116,152
v_rcp_f32 v96, v96
MAA 136,208,168
v_rcp_f32 v97, v97
MAA 136,212,184
v_rcp_f32 v98, v98
MAA 152,220,184
buffer_load_dwordx4 v18, s[28:31], s58 offen lds
MAA 152,216,168
v_rcp_f32 v99, v99
MAA 152,124,152
v_rcp_f32 v112, v112
MAA 152,120,136
v_rcp_f32 v113, v113
MAA 104,192,168
buffer_load_dwordx4 v19, s[28:31], s58 offen offset:1056 lds
MAA 104,196,184
s_add_u32 m0, s59, 101376
s_add_u32 s58, s100, 2752512
v_rcp_f32 v114, v114
MAA 120,204,184
v_rcp_f32 v115, v115
MAA 120,200,168
v_exp_f32 v100, v100
v_exp_f32 v101, v101
v_exp_f32 v102, v102
v_exp_f32 v103, v103
v_exp_f32 v116, v116
v_exp_f32 v117, v117
v_exp_f32 v118, v118
v_exp_f32 v119, v119
v_pk_mul_f32 v[128:129], v[128:129], v[96:97]
v_pk_mul_f32 v[130:131], v[130:131], v[98:99]
v_pk_mul_f32 v[144:145], v[144:145], v[112:113]
v_pk_mul_f32 v[146:147], v[146:147], v[114:115]
v_pk_mul_f32 v[136:137], v[136:137], v[104:105]
v_pk_mul_f32 v[104:105], v[104:105], v[30:31] op_sel_hi:[1,0]
v_pk_mul_f32 v[138:139], v[138:139], v[106:107]
v_pk_mul_f32 v[106:107], v[106:107], v[30:31] op_sel_hi:[1,0]
v_pk_mul_f32 v[152:153], v[152:153], v[120:121]
v_pk_mul_f32 v[120:121], v[120:121], v[30:31] op_sel_hi:[1,0]
v_pk_mul_f32 v[154:155], v[154:155], v[122:123]
v_pk_mul_f32 v[122:123], v[122:123], v[30:31] op_sel_hi:[1,0]
v_pk_fma_f32 v[100:101], v[100:101], v[22:23], v[22:23] op_sel:[0,1,1] op_sel_hi:[1,1,1]
v_pk_fma_f32 v[102:103], v[102:103], v[22:23], v[22:23] op_sel:[0,1,1] op_sel_hi:[1,1,1]
v_pk_fma_f32 v[116:117], v[116:117], v[22:23], v[22:23] op_sel:[0,1,1] op_sel_hi:[1,1,1]
v_pk_fma_f32 v[118:119], v[118:119], v[22:23], v[22:23] op_sel:[0,1,1] op_sel_hi:[1,1,1]
v_cvt_pk_bf16_f32 v96, v128, v129
v_cvt_pk_bf16_f32 v97, v130, v131
v_cvt_pk_bf16_f32 v98, v144, v145
v_cvt_pk_bf16_f32 v99, v146, v147
MAA 140,112,140
buffer_store_dwordx4 v[96:99], v10, s[16:19], s63 offen sc1
MAA 140,116,156
v_rcp_f32 v100, v100
MAA 140,208,172
v_rcp_f32 v101, v101
MAA 140,212,188
v_rcp_f32 v102, v102
MAA 156,220,188
buffer_load_dwordx4 v18, s[28:31], s58 offen lds
MAA 156,216,172
v_rcp_f32 v103, v103
MAA 156,124,156
v_rcp_f32 v116, v116
MAA 156,120,140
v_rcp_f32 v117, v117
MAA 108,192,172
buffer_load_dwordx4 v19, s[28:31], s58 offen offset:1056 lds
MAA 108,196,188
s_add_u32 m0, s59, 109824
s_add_u32 s58, s100, 3014656
v_rcp_f32 v118, v118
MAA 124,204,188
v_rcp_f32 v119, v119
MAA 124,200,172
v_exp_f32 v104, v104
v_exp_f32 v105, v105
v_exp_f32 v106, v106
v_exp_f32 v107, v107
v_exp_f32 v120, v120
v_exp_f32 v121, v121
v_exp_f32 v122, v122
v_exp_f32 v123, v123
v_pk_mul_f32 v[132:133], v[132:133], v[100:101]
v_pk_mul_f32 v[134:135], v[134:135], v[102:103]
v_pk_mul_f32 v[148:149], v[148:149], v[116:117]
v_pk_mul_f32 v[150:151], v[150:151], v[118:119]
v_pk_mul_f32 v[140:141], v[140:141], v[108:109]
v_pk_mul_f32 v[108:109], v[108:109], v[30:31] op_sel:[0,1] op_sel_hi:[1,1]
v_pk_mul_f32 v[142:143], v[142:143], v[110:111]
v_pk_mul_f32 v[110:111], v[110:111], v[30:31] op_sel:[0,1] op_sel_hi:[1,1]
v_pk_mul_f32 v[156:157], v[156:157], v[124:125]
v_pk_mul_f32 v[124:125], v[124:125], v[30:31] op_sel:[0,1] op_sel_hi:[1,1]
v_pk_mul_f32 v[158:159], v[158:159], v[126:127]
v_pk_mul_f32 v[126:127], v[126:127], v[30:31] op_sel:[0,1] op_sel_hi:[1,1]
v_pk_fma_f32 v[104:105], v[104:105], v[24:25], v[24:25] op_sel:[0,1,1] op_sel_hi:[1,1,1]
v_pk_fma_f32 v[106:107], v[106:107], v[24:25], v[24:25] op_sel:[0,1,1] op_sel_hi:[1,1,1]
v_pk_fma_f32 v[120:121], v[120:121], v[24:25], v[24:25] op_sel:[0,1,1] op_sel_hi:[1,1,1]
v_pk_fma_f32 v[122:123], v[122:123], v[24:25], v[24:25] op_sel:[0,1,1] op_sel_hi:[1,1,1]
v_cvt_pk_bf16_f32 v100, v132, v133
v_cvt_pk_bf16_f32 v101, v134, v135
v_cvt_pk_bf16_f32 v102, v148, v149
v_cvt_pk_bf16_f32 v103, v150, v151
MAA 192,0,128
buffer_store_dwordx4 v[100:103], v10, s[16:19], s63 offen offset:1024 sc1
MAA 192,4,144
v_rcp_f32 v104, v104
MAA 192,32,160
s_waitcnt vmcnt(6)
s_barrier
v_rcp_f32 v105, v105
MAA 192,36,176
v_rcp_f32 v106, v106
MAA 208,44,176
buffer_atomic_add v71, v68, s[16:19], s72 offen offset:512
MAA 208,40,160
v_rcp_f32 v107, v107
MAA 208,12,144
v_rcp_f32 v120, v120
MAA 208,8,128
v_rcp_f32 v121, v121
MAA 160,16,160
buffer_load_dwordx4 v18, s[28:31], s58 offen lds
MAA 160,20,176
v_rcp_f32 v122, v122
MAA 176,28,176
v_rcp_f32 v123, v123
MAA 176,24,160
v_exp_f32 v108, v108
v_exp_f32 v109, v109
v_exp_f32 v110, v110
v_exp_f32 v111, v111
v_exp_f32 v124, v124
v_exp_f32 v125, v125
v_exp_f32 v126, v126
v_exp_f32 v127, v127
v_pk_mul_f32 v[136:137], v[136:137], v[104:105]
v_pk_mul_f32 v[138:139], v[138:139], v[106:107]
v_pk_mul_f32 v[152:153], v[152:153], v[120:121]
v_pk_mul_f32 v[154:155], v[154:155], v[122:123]
v_pk_mul_f32 v[192:193], v[192:193], v[160:161]
v_pk_mul_f32 v[160:161], v[160:161], v[28:29] op_sel_hi:[1,0]
v_pk_mul_f32 v[194:195], v[194:195], v[162:163]
v_pk_mul_f32 v[162:163], v[162:163], v[28:29] op_sel_hi:[1,0]
v_pk_mul_f32 v[208:209], v[208:209], v[176:177]
v_pk_mul_f32 v[176:177], v[176:177], v[28:29] op_sel_hi:[1,0]
v_pk_mul_f32 v[210:211], v[210:211], v[178:179]
v_pk_mul_f32 v[178:179], v[178:179], v[28:29] op_sel_hi:[1,0]
v_pk_fma_f32 v[108:109], v[108:109], v[26:27], v[26:27] op_sel:[0,1,1] op_sel_hi:[1,1,1]
v_pk_fma_f32 v[110:111], v[110:111], v[26:27], v[26:27] op_sel:[0,1,1] op_sel_hi:[1,1,1]
v_pk_fma_f32 v[124:125], v[124:125], v[26:27], v[26:27] op_sel:[0,1,1] op_sel_hi:[1,1,1]
v_pk_fma_f32 v[126:127], v[126:127], v[26:27], v[26:27] op_sel:[0,1,1] op_sel_hi:[1,1,1]
v_cvt_pk_bf16_f32 v104, v136, v137
v_cvt_pk_bf16_f32 v105, v138, v139
v_cvt_pk_bf16_f32 v106, v152, v153
v_cvt_pk_bf16_f32 v107, v154, v155
MAA 196,0,132
buffer_store_dwordx4 v[104:107], v11, s[16:19], s63 offen sc1
MAA 196,4,148
v_rcp_f32 v108, v108
MAA 196,32,164
v_rcp_f32 v109, v109
MAA 196,36,180
v_rcp_f32 v110, v110
MAA 212,44,180
buffer_load_dwordx4 v19, s[28:31], s58 offen offset:1056 lds
MAA 212,40,164
s_add_u32 m0, s59, 118272
s_add_u32 s58, s101, 3211264
v_rcp_f32 v111, v111
MAA 212,12,148
v_rcp_f32 v124, v124
MAA 212,8,132
v_rcp_f32 v125, v125
MAA 164,16,164
buffer_load_dwordx4 v18, s[28:31], s58 offen lds
MAA 164,20,180
v_rcp_f32 v126, v126
MAA 180,28,180
v_rcp_f32 v127, v127
MAA 180,24,164
v_exp_f32 v160, v160
v_exp_f32 v161, v161
v_exp_f32 v162, v162
v_exp_f32 v163, v163
v_exp_f32 v176, v176
v_exp_f32 v177, v177
v_exp_f32 v178, v178
v_exp_f32 v179, v179
v_pk_mul_f32 v[140:141], v[140:141], v[108:109]
v_pk_mul_f32 v[142:143], v[142:143], v[110:111]
v_pk_mul_f32 v[156:157], v[156:157], v[124:125]
v_pk_mul_f32 v[158:159], v[158:159], v[126:127]
v_pk_mul_f32 v[196:197], v[196:197], v[164:165]
v_pk_mul_f32 v[164:165], v[164:165], v[28:29] op_sel:[0,1] op_sel_hi:[1,1]
v_pk_mul_f32 v[198:199], v[198:199], v[166:167]
v_pk_mul_f32 v[166:167], v[166:167], v[28:29] op_sel:[0,1] op_sel_hi:[1,1]
v_pk_mul_f32 v[212:213], v[212:213], v[180:181]
v_pk_mul_f32 v[180:181], v[180:181], v[28:29] op_sel:[0,1] op_sel_hi:[1,1]
v_pk_mul_f32 v[214:215], v[214:215], v[182:183]
v_pk_mul_f32 v[182:183], v[182:183], v[28:29] op_sel:[0,1] op_sel_hi:[1,1]
v_pk_fma_f32 v[160:161], v[160:161], v[20:21], v[20:21] op_sel:[0,1,1] op_sel_hi:[1,1,1]
v_pk_fma_f32 v[162:163], v[162:163], v[20:21], v[20:21] op_sel:[0,1,1] op_sel_hi:[1,1,1]
v_pk_fma_f32 v[176:177], v[176:177], v[20:21], v[20:21] op_sel:[0,1,1] op_sel_hi:[1,1,1]
v_pk_fma_f32 v[178:179], v[178:179], v[20:21], v[20:21] op_sel:[0,1,1] op_sel_hi:[1,1,1]
v_cvt_pk_bf16_f32 v108, v140, v141
v_cvt_pk_bf16_f32 v109, v142, v143
v_cvt_pk_bf16_f32 v110, v156, v157
v_cvt_pk_bf16_f32 v111, v158, v159
MAA 200,0,136
buffer_store_dwordx4 v[108:111], v11, s[16:19], s63 offen offset:1024 sc1
MAA 200,4,152
v_rcp_f32 v160, v160
MAA 200,32,168
v_rcp_f32 v161, v161
MAA 200,36,184
v_rcp_f32 v162, v162
MAA 216,44,184
buffer_load_dwordx4 v19, s[28:31], s58 offen offset:1056 lds
MAA 216,40,168
s_add_u32 m0, s59, 126720
s_add_u32 s58, s101, 3473408
v_rcp_f32 v163, v163
MAA 216,12,152
v_rcp_f32 v176, v176
MAA 216,8,136
v_rcp_f32 v177, v177
MAA 168,16,168
buffer_load_dwordx4 v18, s[28:31], s58 offen lds
MAA 168,20,184
v_rcp_f32 v178, v178
MAA 184,28,184
v_rcp_f32 v179, v179
MAA 184,24,168
v_exp_f32 v164, v164
v_exp_f32 v165, v165
v_exp_f32 v166, v166
v_exp_f32 v167, v167
v_exp_f32 v180, v180
v_exp_f32 v181, v181
v_exp_f32 v182, v182
v_exp_f32 v183, v183
v_pk_mul_f32 v[192:193], v[192:193], v[160:161]
v_pk_mul_f32 v[194:195], v[194:195], v[162:163]
v_pk_mul_f32 v[208:209], v[208:209], v[176:177]
v_pk_mul_f32 v[210:211], v[210:211], v[178:179]
v_pk_mul_f32 v[200:201], v[200:201], v[168:169]
v_pk_mul_f32 v[168:169], v[168:169], v[30:31] op_sel_hi:[1,0]
v_pk_mul_f32 v[202:203], v[202:203], v[170:171]
v_pk_mul_f32 v[170:171], v[170:171], v[30:31] op_sel_hi:[1,0]
v_pk_mul_f32 v[216:217], v[216:217], v[184:185]
v_pk_mul_f32 v[184:185], v[184:185], v[30:31] op_sel_hi:[1,0]
v_pk_mul_f32 v[218:219], v[218:219], v[186:187]
v_pk_mul_f32 v[186:187], v[186:187], v[30:31] op_sel_hi:[1,0]
v_pk_fma_f32 v[164:165], v[164:165], v[22:23], v[22:23] op_sel:[0,1,1] op_sel_hi:[1,1,1]
v_pk_fma_f32 v[166:167], v[166:167], v[22:23], v[22:23] op_sel:[0,1,1] op_sel_hi:[1,1,1]
v_pk_fma_f32 v[180:181], v[180:181], v[22:23], v[22:23] op_sel:[0,1,1] op_sel_hi:[1,1,1]
v_pk_fma_f32 v[182:183], v[182:183], v[22:23], v[22:23] op_sel:[0,1,1] op_sel_hi:[1,1,1]
v_cvt_pk_bf16_f32 v160, v192, v193
v_cvt_pk_bf16_f32 v161, v194, v195
v_cvt_pk_bf16_f32 v162, v208, v209
v_cvt_pk_bf16_f32 v163, v210, v211
MAA 204,0,140
buffer_store_dwordx4 v[160:163], v10, s[16:19], s64 offen sc1
MAA 204,4,156
v_rcp_f32 v164, v164
MAA 204,32,172
v_rcp_f32 v165, v165
MAA 204,36,188
v_rcp_f32 v166, v166
MAA 220,44,188
buffer_atomic_add v84, v69, s[16:19], s73 offen offset:512 sc0
MAA 220,40,172
v_rcp_f32 v167, v167
MAA 220,12,156
v_rcp_f32 v180, v180
MAA 220,8,140
v_rcp_f32 v181, v181
MAA 172,16,172
buffer_load_dwordx4 v19, s[28:31], s58 offen offset:1056 lds
MAA 172,20,188
v_rcp_f32 v182, v182
MAA 188,28,188
v_rcp_f32 v183, v183
MAA 188,24,172
v_exp_f32 v168, v168
v_exp_f32 v169, v169
v_exp_f32 v170, v170
v_exp_f32 v171, v171
v_exp_f32 v184, v184
v_exp_f32 v185, v185
v_exp_f32 v186, v186
v_exp_f32 v187, v187
v_pk_mul_f32 v[196:197], v[196:197], v[164:165]
v_pk_mul_f32 v[198:199], v[198:199], v[166:167]
v_pk_mul_f32 v[212:213], v[212:213], v[180:181]
v_pk_mul_f32 v[214:215], v[214:215], v[182:183]
v_pk_mul_f32 v[204:205], v[204:205], v[172:173]
v_pk_mul_f32 v[172:173], v[172:173], v[30:31] op_sel:[0,1] op_sel_hi:[1,1]
v_pk_mul_f32 v[206:207], v[206:207], v[174:175]
v_pk_mul_f32 v[174:175], v[174:175], v[30:31] op_sel:[0,1] op_sel_hi:[1,1]
v_pk_mul_f32 v[220:221], v[220:221], v[188:189]
v_pk_mul_f32 v[188:189], v[188:189], v[30:31] op_sel:[0,1] op_sel_hi:[1,1]
v_pk_mul_f32 v[222:223], v[222:223], v[190:191]
v_pk_mul_f32 v[190:191], v[190:191], v[30:31] op_sel:[0,1] op_sel_hi:[1,1]
v_pk_fma_f32 v[168:169], v[168:169], v[24:25], v[24:25] op_sel:[0,1,1] op_sel_hi:[1,1,1]
v_pk_fma_f32 v[170:171], v[170:171], v[24:25], v[24:25] op_sel:[0,1,1] op_sel_hi:[1,1,1]
v_pk_fma_f32 v[184:185], v[184:185], v[24:25], v[24:25] op_sel:[0,1,1] op_sel_hi:[1,1,1]
v_pk_fma_f32 v[186:187], v[186:187], v[24:25], v[24:25] op_sel:[0,1,1] op_sel_hi:[1,1,1]
v_cvt_pk_bf16_f32 v164, v196, v197
v_cvt_pk_bf16_f32 v165, v198, v199
v_cvt_pk_bf16_f32 v166, v212, v213
v_cvt_pk_bf16_f32 v167, v214, v215
MAA 240,48,128
buffer_store_dwordx4 v[164:167], v10, s[16:19], s64 offen offset:1024 sc1
MAA 240,52,144
v_rcp_f32 v168, v168
MAA 240,80,160
v_rcp_f32 v169, v169
MAA 240,84,176
v_rcp_f32 v170, v170
MAA 248,92,176
buffer_atomic_add v85, v69, s[16:19], s73 offen offset:512 sc0
MAA 248,88,160
v_rcp_f32 v171, v171
MAA 248,60,144
v_rcp_f32 v184, v184
MAA 248,56,128
v_rcp_f32 v185, v185
MAA 224,64,160
v_rcp_f32 v186, v186
MAA 224,68,176
v_rcp_f32 v187, v187
MAA 232,76,176
v_exp_f32 v172, v172
MAA 232,72,160
v_exp_f32 v173, v173
v_exp_f32 v174, v174
v_exp_f32 v175, v175
v_exp_f32 v188, v188
v_exp_f32 v189, v189
v_exp_f32 v190, v190
v_exp_f32 v191, v191
v_pk_mul_f32 v[200:201], v[200:201], v[168:169]
v_pk_mul_f32 v[202:203], v[202:203], v[170:171]
v_pk_mul_f32 v[216:217], v[216:217], v[184:185]
v_pk_mul_f32 v[218:219], v[218:219], v[186:187]
v_pk_mul_f32 v[240:241], v[240:241], v[224:225]
v_pk_mul_f32 v[224:225], v[224:225], v[28:29] op_sel_hi:[1,0]
v_pk_mul_f32 v[242:243], v[242:243], v[226:227]
v_pk_mul_f32 v[226:227], v[226:227], v[28:29] op_sel_hi:[1,0]
v_pk_mul_f32 v[248:249], v[248:249], v[232:233]
v_pk_mul_f32 v[232:233], v[232:233], v[28:29] op_sel_hi:[1,0]
v_pk_mul_f32 v[250:251], v[250:251], v[234:235]
v_pk_mul_f32 v[234:235], v[234:235], v[28:29] op_sel_hi:[1,0]
v_pk_fma_f32 v[172:173], v[172:173], v[26:27], v[26:27] op_sel:[0,1,1] op_sel_hi:[1,1,1]
v_pk_fma_f32 v[174:175], v[174:175], v[26:27], v[26:27] op_sel:[0,1,1] op_sel_hi:[1,1,1]
v_pk_fma_f32 v[188:189], v[188:189], v[26:27], v[26:27] op_sel:[0,1,1] op_sel_hi:[1,1,1]
v_pk_fma_f32 v[190:191], v[190:191], v[26:27], v[26:27] op_sel:[0,1,1] op_sel_hi:[1,1,1]
v_cvt_pk_bf16_f32 v168, v200, v201
v_cvt_pk_bf16_f32 v169, v202, v203
v_cvt_pk_bf16_f32 v170, v216, v217
v_cvt_pk_bf16_f32 v171, v218, v219
buffer_store_dwordx4 v[168:171], v11, s[16:19], s64 offen sc1
buffer_atomic_add v86, v69, s[16:19], s73 offen offset:512 sc0
s_waitcnt vmcnt(5)
v_cmp_gt_u32 vcc, v70, v84
s_nop 0
s_cbranch_vccz .Lok66
s_waitcnt vmcnt(2)
v_cmp_gt_u32 vcc, v70, v85
s_nop 0
s_cbranch_vccz .Lok66
s_waitcnt vmcnt(0)
v_cmp_gt_u32 vcc, v70, v86
s_nop 0
s_cbranch_vccz .Lok66
s_mov_b32 s15, 0
.Lok66l:
v_mov_b32 v84, 0
buffer_atomic_add v84, v69, s[16:19], s73 offen offset:512 sc0
s_add_u32 s15, s15, 1
s_cmp_gt_u32 s15, 100000
s_waitcnt vmcnt(0)
s_cbranch_scc1 .Lok66
v_cmp_gt_u32 vcc, v70, v84
s_nop 0
s_cbranch_vccnz .Lok66l
.Lok66:
s_waitcnt vmcnt(4)
s_barrier
MAA 244,48,132
ds_read_b64_tr_b16 a[0:1], v7
s_add_u32 s52, s76, 0
MAA 244,52,148
buffer_load_dwordx4 v[96:99], v4, s[16:19], s52 offen sc1
MAA 244,80,164
TR 2,7,512
v_rcp_f32 v172, v172
MAA 244,84,180
TR 4,7,32
v_rcp_f32 v173, v173
MAA 252,92,180
TR 6,7,544
v_rcp_f32 v174, v174
MAA 252,88,164
buffer_load_dwordx4 v[100:103], v4, s[16:19], s52 offen offset:1024 sc1
MAA 252,60,148
TR 8,7,64
s_add_u32 s52, s76, 65536
MAA 252,56,132
TR 10,7,576
v_rcp_f32 v175, v175
MAA 228,64,164
TR 12,7,96
v_rcp_f32 v188, v188
MAA 228,68,180
buffer_load_dwordx4 v[104:107], v4, s[16:19], s52 offen sc1
MAA 236,76,180
TR 14,7,608
v_rcp_f32 v189, v189
MAA 236,72,164
TR 16,7,8448
v_rcp_f32 v190, v190
v_rcp_f32 v191, v191
v_exp_f32 v224, v224
v_exp_f32 v225, v225
v_exp_f32 v226, v226
v_exp_f32 v227, v227
v_exp_f32 v232, v232
v_exp_f32 v233, v233
v_exp_f32 v234, v234
v_exp_f32 v235, v235
v_pk_mul_f32 v[204:205], v[204:205], v[172:173]
buffer_load_dwordx4 v[108:111], v4, s[16:19], s52 offen offset:1024 sc1
s_add_u32 s52, s77, 114688
v_pk_mul_f32 v[206:207], v[206:207], v[174:175]
v_pk_mul_f32 v[220:221], v[220:221], v[188:189]
v_pk_mul_f32 v[222:223], v[222:223], v[190:191]
v_pk_mul_f32 v[244:245], v[244:245], v[228:229]
v_pk_mul_f32 v[228:229], v[228:229], v[28:29] op_sel:[0,1] op_sel_hi:[1,1]
v_pk_mul_f32 v[246:247], v[246:247], v[230:231]
v_pk_mul_f32 v[230:231], v[230:231], v[28:29] op_sel:[0,1] op_sel_hi:[1,1]
v_pk_mul_f32 v[252:253], v[252:253], v[236:237]
v_pk_mul_f32 v[236:237], v[236:237], v[28:29] op_sel:[0,1] op_sel_hi:[1,1]
v_pk_mul_f32 v[254:255], v[254:255], v[238:239]
v_pk_mul_f32 v[238:239], v[238:239], v[28:29] op_sel:[0,1] op_sel_hi:[1,1]
v_pk_fma_f32 v[224:225], v[224:225], v[20:21], v[20:21] op_sel:[0,1,1] op_sel_hi:[1,1,1]
buffer_load_dwordx4 v[112:115], v4, s[16:19], s52 offen sc1
v_pk_fma_f32 v[226:227], v[226:227], v[20:21], v[20:21] op_sel:[0,1,1] op_sel_hi:[1,1,1]
v_pk_fma_f32 v[232:233], v[232:233], v[20:21], v[20:21] op_sel:[0,1,1] op_sel_hi:[1,1,1]
v_pk_fma_f32 v[234:235], v[234:235], v[20:21], v[20:21] op_sel:[0,1,1] op_sel_hi:[1,1,1]
v_cvt_pk_bf16_f32 v172, v204, v205
v_cvt_pk_bf16_f32 v173, v206, v207
v_cvt_pk_bf16_f32 v174, v220, v221
v_cvt_pk_bf16_f32 v175, v222, v223
TR 18,7,8960
TR 20,7,8480
TR 22,7,8992
buffer_store_dwordx4 v[172:175], v11, s[16:19], s64 offen offset:1024 sc1
TR 24,7,8512
TR 26,7,9024
TR 28,7,8544
TR 30,7,9056
v_rcp_f32 v224, v224
v_rcp_f32 v225, v225
v_rcp_f32 v226, v226
v_rcp_f32 v227, v227
v_rcp_f32 v232, v232
v_rcp_f32 v233, v233
v_rcp_f32 v234, v234
v_rcp_f32 v235, v235
v_exp_f32 v228, v228
v_exp_f32 v229, v229
v_exp_f32 v230, v230
v_exp_f32 v231, v231
v_exp_f32 v236, v236
v_exp_f32 v237, v237
v_exp_f32 v238, v238
v_exp_f32 v239, v239
v_pk_mul_f32 v[240:241], v[240:241], v[224:225]
buffer_load_dwordx4 v[116:119], v4, s[16:19], s52 offen offset:1024 sc1
s_add_u32 s52, s77, 180224
v_pk_mul_f32 v[242:243], v[242:243], v[226:227]
v_pk_mul_f32 v[248:249], v[248:249], v[232:233]
v_pk_mul_f32 v[250:251], v[250:251], v[234:235]
.Lpad36:
s_cbranch_execz .Lpad39
v_pk_fma_f32 v[228:229], v[228:229], v[22:23], v[22:23] op_sel:[0,1,1] op_sel_hi:[1,1,1]
v_pk_fma_f32 v[230:231], v[230:231], v[22:23], v[22:23] op_sel:[0,1,1] op_sel_hi:[1,1,1]
v_pk_fma_f32 v[236:237], v[236:237], v[22:23], v[22:23] op_sel:[0,1,1] op_sel_hi:[1,1,1]
v_pk_fma_f32 v[238:239], v[238:239], v[22:23], v[22:23] op_sel:[0,1,1] op_sel_hi:[1,1,1]
v_cvt_pk_bf16_f32 v224, v240, v241
v_cvt_pk_bf16_f32 v225, v242, v243
v_cvt_pk_bf16_f32 v226, v248, v249
v_cvt_pk_bf16_f32 v227, v250, v251
v_rcp_f32 v228, v228
v_rcp_f32 v229, v229
v_rcp_f32 v230, v230
v_rcp_f32 v231, v231
v_rcp_f32 v236, v236
v_rcp_f32 v237, v237
v_rcp_f32 v238, v238
v_rcp_f32 v239, v239
v_pk_mul_f32 v[244:245], v[244:245], v[228:229]
buffer_store_dwordx4 v[224:227], v10, s[16:19], s65 offen sc1
v_pk_mul_f32 v[246:247], v[246:247], v[230:231]
v_pk_mul_f32 v[252:253], v[252:253], v[236:237]
v_pk_mul_f32 v[254:255], v[254:255], v[238:239]
v_cvt_pk_bf16_f32 v228, v244, v245
v_cvt_pk_bf16_f32 v229, v246, v247
v_cvt_pk_bf16_f32 v230, v252, v253
v_cvt_pk_bf16_f32 v231, v254, v255
buffer_store_dwordx4 v[228:231], v10, s[16:19], s65 offen offset:1024 sc1
buffer_load_dwordx4 v[120:123], v4, s[16:19], s52 offen sc1
buffer_load_dwordx4 v[124:127], v4, s[16:19], s52 offen offset:1024 sc1
v_mov_b32 v21, v68
v_mov_b32 v22, v69
v_mov_b32 v23, v70
v_mov_b32 v24, v71
v_mov_b32 v25, 0
s_waitcnt vmcnt(7) lgkmcnt(0)
s_barrier
v_mfma_f32_16x16x32_bf16 v[32:35], a[0:3], v[96:99], 0
ds_read_b64_tr_b16 a[32:33], v6
s_add_u32 s52, s78, 229376
MAV 32,16,104
buffer_load_dwordx4 v[128:131], v4, s[16:19], s52 offen sc1
v_mfma_f32_16x16x32_bf16 v[48:51], a[0:3], v[100:103], 0
TR 34,6,512
MAV 48,16,108
TR 36,6,32
TR 38,6,544
v_mfma_f32_16x16x32_bf16 v[52:55], a[4:7], v[100:103], 0
TR 48,6,8448
MAV 52,20,108
buffer_load_dwordx4 v[132:135], v4, s[16:19], s52 offen offset:1024 sc1
v_mfma_f32_16x16x32_bf16 v[36:39], a[4:7], v[96:99], 0
TR 50,6,8960
MAV 36,20,104
TR 52,6,8480
TR 54,6,8992
v_mfma_f32_16x16x32_bf16 v[40:43], a[8:11], v[96:99], 0
TR 40,6,64
s_add_u32 s52, s78, 294912
MAV 40,24,104
buffer_load_dwordx4 v[136:139], v4, s[16:19], s52 offen sc1
v_mfma_f32_16x16x32_bf16 v[56:59], a[8:11], v[100:103], 0
TR 42,6,576
MAV 56,24,108
TR 44,6,96
TR 46,6,608
v_mfma_f32_16x16x32_bf16 v[60:63], a[12:15], v[100:103], 0
TR 56,6,8512
MAV 60,28,108
buffer_load_dwordx4 v[140:143], v4, s[16:19], s52 offen offset:1024 sc1
v_mfma_f32_16x16x32_bf16 v[44:47], a[12:15], v[96:99], 0
TR 58,6,9024
MAV 44,28,104
TR 60,6,8544
TR 62,6,9056
s_waitcnt lgkmcnt(8)
v_mfma_f32_16x16x32_bf16 v[64:67], a[32:35], v[96:99], 0
TR 0,7,16896
s_add_u32 s52, s79, 344064
MAV 64,48,104
buffer_load_dwordx4 v[144:147], v4, s[16:19], s52 offen sc1
v_mfma_f32_16x16x32_bf16 v[80:83], a[32:35], v[100:103], 0
TR 2,7,17408
MAV 80,48,108
TR 4,7,16928
TR 6,7,17440
v_mfma_f32_16x16x32_bf16 v[84:87], a[36:39], v[100:103], 0
TR 16,7,25344
MAV 84,52,108
buffer_load_dwordx4 v[148:151], v4, s[16:19], s52 offen offset:1024 sc1
v_mfma_f32_16x16x32_bf16 v[68:71], a[36:39], v[96:99], 0
TR 18,7,25856
MAV 68,52,104
TR 20,7,25376
TR 22,7,25888
s_waitcnt lgkmcnt(8)
v_mfma_f32_16x16x32_bf16 v[72:75], a[40:43], v[96:99], 0
TR 8,7,16960
s_add_u32 s52, s79, 409600
MAV 72,56,104
buffer_load_dwordx4 v[152:155], v4, s[16:19], s52 offen sc1
v_mfma_f32_16x16x32_bf16 v[88:91], a[40:43], v[100:103], 0
TR 10,7,17472
MAV 88,56,108
TR 12,7,16992
TR 14,7,17504
v_mfma_f32_16x16x32_bf16 v[92:95], a[44:47], v[100:103], 0
TR 24,7,25408
MAV 92,60,108
buffer_load_dwordx4 v[156:159], v4, s[16:19], s52 offen offset:1024 sc1
v_mfma_f32_16x16x32_bf16 v[76:79], a[44:47], v[96:99], 0
TR 26,7,25920
MAV 76,60,104
TR 28,7,25440
TR 30,7,25952
s_waitcnt vmcnt(8) lgkmcnt(8)
s_barrier
MAV 32,0,112
TR 32,6,16896
MAV 32,16,120
buffer_atomic_add v24, v21, s[16:19], s72 offen
MAV 48,16,124
TR 34,6,17408
MAV 48,0,116
TR 36,6,16928
TR 38,6,17440
TR 48,6,25344
MAV 52,4,116
TR 50,6,25856
s_add_u32 m0, s55, 0
MAV 52,20,124
buffer_load_dwordx4 v18, s[28:31], s54 offen lds
MAV 36,20,120
TR 52,6,25376
MAV 36,4,112
TR 54,6,25888
TR 40,6,16960
s_waitcnt lgkmcnt(9)
MAV 40,8,112
TR 42,6,17472
s_add_u32 s52, s76, 458752
MAV 40,24,120
buffer_load_dwordx4 v[96:99], v4, s[16:19], s52 offen sc1
MAV 56,24,124
TR 44,6,16992
MAV 56,8,116
buffer_load_dwordx4 v19, s[28:31], s54 offen offset:1056 lds
MAV 60,12,116
TR 46,6,17504
s_add_u32 s54, s98, 327680
MAV 60,28,124
buffer_load_dwordx4 v[100:103], v4, s[16:19], s52 offen offset:1024 sc1
MAV 44,28,120
TR 56,6,25408
MAV 44,12,112
TR 58,6,25920
TR 60,6,25440
TR 62,6,25952
s_waitcnt lgkmcnt(8)
MAV 64,32,112
TR 0,7,33792
s_add_u32 m0, s55, 8448
MAV 64,48,120
buffer_load_dwordx4 v18, s[28:31], s54 offen lds
MAV 80,48,124
TR 2,7,34304
MAV 80,32,116
TR 4,7,33824
TR 6,7,34336
MAV 84,36,116
TR 16,7,42240
s_add_u32 s52, s76, 524288
MAV 84,52,124
buffer_load_dwordx4 v[104:107], v4, s[16:19], s52 offen sc1
MAV 68,52,120
TR 18,7,42752
MAV 68,36,112
TR 20,7,42272
TR 22,7,42784
s_waitcnt lgkmcnt(8)
MAV 72,40,112
TR 8,7,33856
MAV 72,56,120
buffer_load_dwordx4 v19, s[28:31], s54 offen offset:1056 lds
MAV 88,56,124
TR 10,7,34368
s_add_u32 s54, s99, 524288
MAV 88,40,116
TR 12,7,33888
TR 14,7,34400
MAV 92,44,116
TR 24,7,42304
MAV 92,60,124
buffer_load_dwordx4 v[108:111], v4, s[16:19], s52 offen offset:1024 sc1
MAV 76,60,120
TR 26,7,42816
MAV 76,44,112
TR 28,7,42336
TR 30,7,42848
s_waitcnt vmcnt(13) lgkmcnt(8)
s_barrier
MAV 32,0,128
TR 32,6,33792
s_add_u32 m0, s55, 16896
MAV 32,16,136
buffer_load_dwordx4 v18, s[28:31], s54 offen lds
MAV 48,16,140
TR 34,6,34304
MAV 48,0,132
TR 36,6,33824
TR 38,6,34336
MAV 52,4,132
TR 48,6,42240
s_add_u32 s52, s77, 573440
MAV 52,20,140
buffer_load_dwordx4 v[112:115], v4, s[16:19], s52 offen sc1
MAV 36,20,136
TR 50,6,42752
MAV 36,4,128
TR 52,6,42272
TR 54,6,42784
s_waitcnt lgkmcnt(8)
MAV 40,8,128
TR 40,6,33856
MAV 40,24,136
buffer_load_dwordx4 v19, s[28:31], s54 offen offset:1056 lds
MAV 56,24,140
TR 42,6,34368
s_add_u32 s54, s99, 786432
MAV 56,8,132
TR 44,6,33888
TR 46,6,34400
MAV 60,12,132
TR 56,6,42304
MAV 60,28,140
buffer_load_dwordx4 v[116:119], v4, s[16:19], s52 offen offset:1024 sc1
MAV 44,28,136
TR 58,6,42816
MAV 44,12,128
TR 60,6,42336
TR 62,6,42848
s_waitcnt lgkmcnt(8)
MAV 64,32,128
TR 0,7,50688
s_add_u32 m0, s55, 25344
MAV 64,48,136
buffer_load_dwordx4 v18, s[28:31], s54 offen lds
MAV 80,48,140
TR 2,7,51200
MAV 80,32,132
TR 4,7,50720
TR 6,7,51232
TR 16,7,59136
MAV 84,36,132
TR 18,7,59648
s_add_u32 s52, s77, 638976
MAV 84,52,140
buffer_load_dwordx4 v[120:123], v4, s[16:19], s52 offen sc1
MAV 68,52,136
TR 20,7,59168
MAV 68,36,128
TR 22,7,59680
TR 8,7,50752
s_waitcnt lgkmcnt(9)
MAV 72,40,128
TR 10,7,51264
MAV 72,56,136
buffer_load_dwordx4 v19, s[28:31], s54 offen offset:1056 lds
MAV 88,56,140
TR 12,7,50784
s_add_u32 s54, s100, 983040
MAV 88,40,132
buffer_load_dwordx4 v[124:127], v4, s[16:19], s52 offen offset:1024 sc1
MAV 92,44,132
TR 14,7,51296
MAV 92,60,140
buffer_atomic_add v25, v22, s[16:19], s73 offen sc0
MAV 76,60,136
TR 24,7,59200
MAV 76,44,128
TR 26,7,59712
TR 28,7,59232
TR 30,7,59744
s_waitcnt vmcnt(18) lgkmcnt(8)
s_barrier
MAV 32,0,144
TR 32,6,50688
s_add_u32 m0, s55, 33792
MAV 32,16,152
buffer_load_dwordx4 v18, s[28:31], s54 offen lds
MAV 48,16,156
TR 34,6,51200
MAV 48,0,148
TR 36,6,50720
TR 38,6,51232
MAV 52,4,148
TR 48,6,59136
s_add_u32 s52, s78, 688128
MAV 52,20,156
buffer_load_dwordx4 v[128:131], v4, s[16:19], s52 offen sc1
MAV 36,20,152
TR 50,6,59648
MAV 36,4,144
TR 52,6,59168
TR 54,6,59680
s_waitcnt lgkmcnt(8)
MAV 40,8,144
TR 40,6,50752
MAV 40,24,152
buffer_load_dwordx4 v19, s[28:31], s54 offen offset:1056 lds
MAV 56,24,156
TR 42,6,51264
s_add_u32 s54, s100, 1245184
MAV 56,8,148
TR 44,6,50784
TR 46,6,51296
MAV 60,12,148
TR 56,6,59200
MAV 60,28,156
buffer_load_dwordx4 v[132:135], v4, s[16:19], s52 offen offset:1024 sc1
MAV 44,28,152
TR 58,6,59712
MAV 44,12,144
TR 60,6,59232
TR 62,6,59744
v_add_u32 v7, s57, v7
v_add_u32 v6, s57, v6
s_sub_u32 s57, 0, s57
s_waitcnt lgkmcnt(8)
MAV 64,32,144
ds_read_b64_tr_b16 a[0:1], v7
s_add_u32 m0, s55, 42240
MAV 64,48,152
buffer_load_dwordx4 v18, s[28:31], s54 offen lds
MAV 80,48,156
TR 2,7,512
MAV 80,32,148
TR 4,7,32
TR 6,7,544
MAV 84,36,148
TR 16,7,8448
s_add_u32 s52, s78, 753664
MAV 84,52,156
buffer_load_dwordx4 v[136:139], v4, s[16:19], s52 offen sc1
MAV 68,52,152
TR 18,7,8960
MAV 68,36,144
TR 20,7,8480
TR 22,7,8992
s_waitcnt lgkmcnt(8)
MAV 72,40,144
TR 8,7,64
MAV 72,56,152
buffer_load_dwordx4 v19, s[28:31], s54 offen offset:1056 lds
MAV 88,56,156
TR 10,7,576
s_add_u32 s54, s101, 1441792
MAV 88,40,148
TR 12,7,96
TR 14,7,608
MAV 92,44,148
TR 24,7,8512
MAV 92,60,156
buffer_load_dwordx4 v[140:143], v4, s[16:19], s52 offen offset:1024 sc1
MAV 76,60,152
TR 26,7,9024
MAV 76,44,144
TR 28,7,8544
TR 30,7,9056
s_waitcnt vmcnt(17) lgkmcnt(8)
s_barrier
MAV 32,0,96
ds_read_b64_tr_b16 a[32:33], v6
s_add_u32 m0, s55, 50688
MAV 32,16,104
buffer_load_dwordx4 v18, s[28:31], s54 offen lds
MAV 48,16,108
TR 34,6,512
MAV 48,0,100
TR 36,6,32
TR 38,6,544
MAV 52,4,100
TR 48,6,8448
s_add_u32 s52, s79, 802816
MAV 52,20,108
buffer_load_dwordx4 v[144:147], v4, s[16:19], s52 offen sc1
MAV 36,20,104
TR 50,6,8960
MAV 36,4,96
TR 52,6,8480
TR 54,6,8992
s_waitcnt lgkmcnt(8)
MAV 40,8,96
TR 40,6,64
MAV 40,24,104
buffer_load_dwordx4 v19, s[28:31], s54 offen offset:1056 lds
MAV 56,24,108
TR 42,6,576
s_add_u32 s54, s101, 1703936
MAV 56,8,100
TR 44,6,96
TR 46,6,608
MAV 60,12,100
TR 56,6,8512
MAV 60,28,108
buffer_load_dwordx4 v[148:151], v4, s[16:19], s52 offen offset:1024 sc1
MAV 44,28,104
TR 58,6,9024
MAV 44,12,96
TR 60,6,8544
TR 62,6,9056
s_waitcnt lgkmcnt(8)
MAV 64,32,96
TR 0,7,16896
s_add_u32 m0, s55, 59136
MAV 64,48,104
buffer_load_dwordx4 v18, s[28:31], s54 offen lds
MAV 80,48,108
TR 2,7,17408
MAV 80,32,100
TR 4,7,16928
TR 6,7,17440
MAV 84,36,100
TR 16,7,25344
s_add_u32 s52, s79, 868352
MAV 84,52,108
buffer_load_dwordx4 v[152:155], v4, s[16:19], s52 offen sc1
MAV 68,52,104
TR 18,7,25856
MAV 68,36,96
TR 20,7,25376
TR 22,7,25888
s_waitcnt lgkmcnt(8)
MAV 72,40,96
TR 8,7,16960
MAV 72,56,104
buffer_load_dwordx4 v19, s[28:31], s54 offen offset:1056 lds
MAV 88,56,108
TR 10,7,17472
s_add_u32 s54, s98, 1900544
MAV 88,40,100
TR 12,7,16992
TR 14,7,17504
MAV 92,44,100
TR 24,7,25408
MAV 92,60,108
buffer_load_dwordx4 v[156:159], v4, s[16:19], s52 offen offset:1024 sc1
MAV 76,60,104
TR 26,7,25920
MAV 76,44,96
TR 28,7,25440
TR 30,7,25952
s_waitcnt vmcnt(16)
v_cmp_gt_u32 vcc, v23, v25
s_nop 0
s_cbranch_vccnz .Lsp67
.Lsp67b:
s_waitcnt lgkmcnt(8)
s_barrier
MAV 32,0,112
TR 32,6,16896
s_add_u32 m0, s55, 67584
MAV 32,16,120
buffer_load_dwordx4 v18, s[28:31], s54 offen lds
MAV 48,16,124
TR 34,6,17408
MAV 48,0,116
TR 36,6,16928
TR 38,6,17440
MAV 52,4,116
TR 48,6,25344
s_add_u32 s52, s76, 16384
MAV 52,20,124
buffer_load_dwordx4 v[96:99], v4, s[16:19], s52 offen sc1
MAV 36,20,120
TR 50,6,25856
MAV 36,4,112
TR 52,6,25376
TR 54,6,25888
s_waitcnt lgkmcnt(8)
MAV 40,8,112
TR 40,6,16960
MAV 40,24,120
buffer_load_dwordx4 v19, s[28:31], s54 offen offset:1056 lds
MAV 56,24,124
TR 42,6,17472
s_add_u32 s54, s98, 2162688
MAV 56,8,116
TR 44,6,16992
TR 46,6,17504
MAV 60,12,116
TR 56,6,25408
MAV 60,28,124
buffer_load_dwordx4 v[100:103], v4, s[16:19], s52 offen offset:1024 sc1
MAV 44,28,120
TR 58,6,25920
MAV 44,12,112
TR 60,6,25440
TR 62,6,25952
s_waitcnt lgkmcnt(8)
MAV 64,32,112
TR 0,7,33792
s_add_u32 m0, s55, 76032
MAV 64,48,120
buffer_load_dwordx4 v18, s[28:31], s54 offen lds
MAV 80,48,124
TR 2,7,34304
MAV 80,32,116
TR 4,7,33824
TR 6,7,34336
MAV 84,36,116
TR 16,7,42240
s_add_u32 s52, s76, 81920
MAV 84,52,124
buffer_load_dwordx4 v[104:107], v4, s[16:19], s52 offen sc1
MAV 68,52,120
TR 18,7,42752
MAV 68,36,112
TR 20,7,42272
TR 22,7,42784
s_waitcnt lgkmcnt(8)
MAV 72,40,112
TR 8,7,33856
MAV 72,56,120
buffer_load_dwordx4 v19, s[28:31], s54 offen offset:1056 lds
MAV 88,56,124
TR 10,7,34368
s_add_u32 s54, s99, 2359296
MAV 88,40,116
TR 12,7,33888
TR 14,7,34400
MAV 92,44,116
TR 24,7,42304
MAV 92,60,124
buffer_load_dwordx4 v[108:111], v4, s[16:19], s52 offen offset:1024 sc1
MAV 76,60,120
TR 26,7,42816
MAV 76,44,112
TR 28,7,42336
.Lpad37:
s_cbranch_execz .Lpad40
TR 30,7,42848
s_waitcnt vmcnt(16) lgkmcnt(8)
s_barrier
MAV 32,0,128
TR 32,6,33792
s_add_u32 m0, s55, 84480
MAV 32,16,136
buffer_load_dwordx4 v18, s[28:31], s54 offen lds
MAV 48,16,140
TR 34,6,34304
MAV 48,0,132
TR 36,6,33824
TR 38,6,34336
MAV 52,4,132
TR 48,6,42240
s_add_u32 s52, s77, 131072
MAV 52,20,140
buffer_load_dwordx4 v[112:115], v4, s[16:19], s52 offen sc1
MAV 36,20,136
TR 50,6,42752
MAV 36,4,128
TR 52,6,42272
TR 54,6,42784
s_waitcnt lgkmcnt(8)
MAV 40,8,128
TR 40,6,33856
MAV 40,24,136
buffer_load_dwordx4 v19, s[28:31], s54 offen offset:1056 lds
MAV 56,24,140
TR 42,6,34368
s_add_u32 s54, s99, 2621440
MAV 56,8,132
TR 44,6,33888
TR 46,6,34400
MAV 60,12,132
TR 56,6,42304
MAV 60,28,140
buffer_load_dwordx4 v[116:119], v4, s[16:19], s52 offen offset:1024 sc1
MAV 44,28,136
TR 58,6,42816
MAV 44,12,128
TR 60,6,42336
TR 62,6,42848
s_waitcnt lgkmcnt(8)
MAV 64,32,128
TR 0,7,50688
s_add_u32 m0, s55, 92928
MAV 64,48,136
buffer_load_dwordx4 v18, s[28:31], s54 offen lds
MAV 80,48,140
TR 2,7,51200
MAV 80,32,132
TR 4,7,50720
TR 6,7,51232
MAV 84,36,132
TR 16,7,59136
s_add_u32 s52, s77, 196608
MAV 84,52,140
buffer_load_dwordx4 v[120:123], v4, s[16:19], s52 offen sc1
MAV 68,52,136
TR 18,7,59648
MAV 68,36,128
TR 20,7,59168
TR 22,7,59680
s_waitcnt lgkmcnt(8)
MAV 72,40,128
TR 8,7,50752
MAV 72,56,136
buffer_load_dwordx4 v19, s[28:31], s54 offen offset:1056 lds
MAV 88,56,140
TR 10,7,51264
s_add_u32 s54, s100, 2818048
MAV 88,40,132
TR 12,7,50784
TR 14,7,51296
MAV 92,44,132
TR 24,7,59200
MAV 92,60,140
buffer_load_dwordx4 v[124:127], v4, s[16:19], s52 offen offset:1024 sc1
MAV 76,60,136
TR 26,7,59712
MAV 76,44,128
TR 28,7,59232
TR 30,7,59744
s_waitcnt vmcnt(16) lgkmcnt(8)
s_barrier
MAV 32,0,144
TR 32,6,50688
s_add_u32 m0, s55, 101376
MAV 32,16,152
buffer_load_dwordx4 v18, s[28:31], s54 offen lds
MAV 48,16,156
TR 34,6,51200
MAV 48,0,148
TR 36,6,50720
TR 38,6,51232
MAV 52,4,148
TR 48,6,59136
s_add_u32 s52, s78, 245760
MAV 52,20,156
buffer_load_dwordx4 v[128:131], v4, s[16:19], s52 offen sc1
MAV 36,20,152
TR 50,6,59648
MAV 36,4,144
TR 52,6,59168
TR 54,6,59680
s_waitcnt lgkmcnt(8)
MAV 40,8,144
TR 40,6,50752
MAV 40,24,152
buffer_load_dwordx4 v19, s[28:31], s54 offen offset:1056 lds
MAV 56,24,156
TR 42,6,51264
s_add_u32 s54, s100, 3080192
MAV 56,8,148
TR 44,6,50784
TR 46,6,51296
MAV 60,12,148
TR 56,6,59200
MAV 60,28,156
buffer_load_dwordx4 v[132:135], v4, s[16:19], s52 offen offset:1024 sc1
MAV 44,28,152
TR 58,6,59712
MAV 44,12,144
TR 60,6,59232
TR 62,6,59744
v_add_u32 v7, s57, v7
v_add_u32 v6, s57, v6
s_sub_u32 s57, 0, s57
s_waitcnt lgkmcnt(8)
MAV 64,32,144
ds_read_b64_tr_b16 a[0:1], v7
s_add_u32 m0, s55, 109824
MAV 64,48,152
buffer_load_dwordx4 v18, s[28:31], s54 offen lds
MAV 80,48,156
TR 2,7,512
MAV 80,32,148
TR 4,7,32
TR 6,7,544
MAV 84,36,148
TR 16,7,8448
s_add_u32 s52, s78, 311296
MAV 84,52,156
buffer_load_dwordx4 v[136:139], v4, s[16:19], s52 offen sc1
MAV 68,52,152
TR 18,7,8960
MAV 68,36,144
TR 20,7,8480
TR 22,7,8992
s_waitcnt lgkmcnt(8)
MAV 72,40,144
TR 8,7,64
MAV 72,56,152
buffer_load_dwordx4 v19, s[28:31], s54 offen offset:1056 lds
MAV 88,56,156
TR 10,7,576
s_add_u32 s54, s101, 3276800
MAV 88,40,148
TR 12,7,96
TR 14,7,608
MAV 92,44,148
TR 24,7,8512
MAV 92,60,156
buffer_load_dwordx4 v[140:143], v4, s[16:19], s52 offen offset:1024 sc1
MAV 76,60,152
TR 26,7,9024
MAV 76,44,144
TR 28,7,8544
TR 30,7,9056
s_waitcnt vmcnt(16) lgkmcnt(8)
s_barrier
MAV 32,0,96
ds_read_b64_tr_b16 a[32:33], v6
s_add_u32 m0, s55, 118272
MAV 32,16,104
buffer_load_dwordx4 v18, s[28:31], s54 offen lds
MAV 48,16,108
TR 34,6,512
MAV 48,0,100
TR 36,6,32
TR 38,6,544
MAV 52,4,100
TR 48,6,8448
s_add_u32 s52, s79, 360448
MAV 52,20,108
buffer_load_dwordx4 v[144:147], v4, s[16:19], s52 offen sc1
MAV 36,20,104
TR 50,6,8960
MAV 36,4,96
TR 52,6,8480
TR 54,6,8992
s_waitcnt lgkmcnt(8)
MAV 40,8,96
TR 40,6,64
MAV 40,24,104
buffer_load_dwordx4 v19, s[28:31], s54 offen offset:1056 lds
MAV 56,24,108
TR 42,6,576
s_add_u32 s54, s101, 3538944
MAV 56,8,100
TR 44,6,96
TR 46,6,608
MAV 60,12,100
TR 56,6,8512
MAV 60,28,108
buffer_load_dwordx4 v[148:151], v4, s[16:19], s52 offen offset:1024 sc1
MAV 44,28,104
TR 58,6,9024
MAV 44,12,96
TR 60,6,8544
TR 62,6,9056
s_waitcnt lgkmcnt(8)
MAV 64,32,96
TR 0,7,16896
s_add_u32 m0, s55, 126720
MAV 64,48,104
buffer_load_dwordx4 v18, s[28:31], s54 offen lds
MAV 80,48,108
TR 2,7,17408
MAV 80,32,100
TR 4,7,16928
TR 6,7,17440
MAV 84,36,100
TR 16,7,25344
s_add_u32 s52, s79, 425984
MAV 84,52,108
buffer_load_dwordx4 v[152:155], v4, s[16:19], s52 offen sc1
MAV 68,52,104
TR 18,7,25856
MAV 68,36,96
TR 20,7,25376
TR 22,7,25888
s_waitcnt lgkmcnt(8)
MAV 72,40,96
TR 8,7,16960
MAV 72,56,104
buffer_load_dwordx4 v19, s[28:31], s54 offen offset:1056 lds
MAV 88,56,108
TR 10,7,17472
s_add_u32 s54, s98, 131072
MAV 88,40,100
TR 12,7,16992
TR 14,7,17504
MAV 92,44,100
TR 24,7,25408
MAV 92,60,108
buffer_load_dwordx4 v[156:159], v4, s[16:19], s52 offen offset:1024 sc1
MAV 76,60,104
TR 26,7,25920
MAV 76,44,96
TR 28,7,25440
TR 30,7,25952
s_waitcnt vmcnt(16) lgkmcnt(8)
s_barrier
MAV 32,0,112
TR 32,6,16896
s_add_u32 m0, s55, 0
MAV 32,16,120
buffer_load_dwordx4 v18, s[28:31], s54 offen lds
MAV 48,16,124
TR 34,6,17408
MAV 48,0,116
TR 36,6,16928
TR 38,6,17440
MAV 52,4,116
TR 48,6,25344
s_add_u32 s52, s76, 475136
MAV 52,20,124
buffer_load_dwordx4 v[96:99], v4, s[16:19], s52 offen sc1
MAV 36,20,120
TR 50,6,25856
MAV 36,4,112
TR 52,6,25376
TR 54,6,25888
s_waitcnt lgkmcnt(8)
MAV 40,8,112
TR 40,6,16960
MAV 40,24,120
buffer_load_dwordx4 v19, s[28:31], s54 offen offset:1056 lds
MAV 56,24,124
TR 42,6,17472
s_add_u32 s54, s98, 393216
MAV 56,8,116
TR 44,6,16992
TR 46,6,17504
MAV 60,12,116
TR 56,6,25408
MAV 60,28,124
buffer_load_dwordx4 v[100:103], v4, s[16:19], s52 offen offset:1024 sc1
MAV 44,28,120
TR 58,6,25920
MAV 44,12,112
TR 60,6,25440
TR 62,6,25952
s_waitcnt lgkmcnt(8)
MAV 64,32,112
TR 0,7,33792
s_add_u32 m0, s55, 8448
MAV 64,48,120
buffer_load_dwordx4 v18, s[28:31], s54 offen lds
MAV 80,48,124
TR 2,7,34304
MAV 80,32,116
TR 4,7,33824
TR 6,7,34336
MAV 84,36,116
TR 16,7,42240
s_add_u32 s52, s76, 540672
MAV 84,52,124
buffer_load_dwordx4 v[104:107], v4, s[16:19], s52 offen sc1
MAV 68,52,120
TR 18,7,42752
MAV 68,36,112
TR 20,7,42272
TR 22,7,42784
s_waitcnt lgkmcnt(8)
MAV 72,40,112
TR 8,7,33856
MAV 72,56,120
buffer_load_dwordx4 v19, s[28:31], s54 offen offset:1056 lds
MAV 88,56,124
TR 10,7,34368
s_add_u32 s54, s99, 589824
MAV 88,40,116
TR 12,7,33888
TR 14,7,34400
MAV 92,44,116
TR 24,7,42304
MAV 92,60,124
buffer_load_dwordx4 v[108:111], v4, s[16:19], s52 offen offset:1024 sc1
MAV 76,60,120
TR 26,7,42816
MAV 76,44,112
TR 28,7,42336
TR 30,7,42848
s_waitcnt vmcnt(16) lgkmcnt(8)
s_barrier
MAV 32,0,128
TR 32,6,33792
s_add_u32 m0, s55, 16896
MAV 32,16,136
buffer_load_dwordx4 v18, s[28:31], s54 offen lds
MAV 48,16,140
TR 34,6,34304
MAV 48,0,132
TR 36,6,33824
TR 38,6,34336
MAV 52,4,132
TR 48,6,42240
s_add_u32 s52, s77, 589824
MAV 52,20,140
buffer_load_dwordx4 v[112:115], v4, s[16:19], s52 offen sc1
MAV 36,20,136
TR 50,6,42752
MAV 36,4,128
TR 52,6,42272
TR 54,6,42784
s_waitcnt lgkmcnt(8)
MAV 40,8,128
TR 40,6,33856
MAV 40,24,136
buffer_load_dwordx4 v19, s[28:31], s54 offen offset:1056 lds
MAV 56,24,140
TR 42,6,34368
s_add_u32 s54, s99, 851968
MAV 56,8,132
TR 44,6,33888
TR 46,6,34400
MAV 60,12,132
TR 56,6,42304
MAV 60,28,140
buffer_load_dwordx4 v[116:119], v4, s[16:19], s52 offen offset:1024 sc1
MAV 44,28,136
TR 58,6,42816
MAV 44,12,128
TR 60,6,42336
TR 62,6,42848
s_waitcnt lgkmcnt(8)
MAV 64,32,128
TR 0,7,50688
s_add_u32 m0, s55, 25344
MAV 64,48,136
buffer_load_dwordx4 v18, s[28:31], s54 offen lds
MAV 80,48,140
TR 2,7,51200
MAV 80,32,132
TR 4,7,50720
TR 6,7,51232
MAV 84,36,132
TR 16,7,59136
s_add_u32 s52, s77, 655360
MAV 84,52,140
buffer_load_dwordx4 v[120:123], v4, s[16:19], s52 offen sc1
MAV 68,52,136
TR 18,7,59648
MAV 68,36,128
TR 20,7,59168
TR 22,7,59680
s_waitcnt lgkmcnt(8)
MAV 72,40,128
TR 8,7,50752
MAV 72,56,136
buffer_load_dwordx4 v19, s[28:31], s54 offen offset:1056 lds
MAV 88,56,140
TR 10,7,51264
s_add_u32 s54, s100, 1048576
MAV 88,40,132
TR 12,7,50784
TR 14,7,51296
MAV 92,44,132
TR 24,7,59200
MAV 92,60,140
buffer_load_dwordx4 v[124:127], v4, s[16:19], s52 offen offset:1024 sc1
MAV 76,60,136
TR 26,7,59712
MAV 76,44,128
TR 28,7,59232
TR 30,7,59744
s_waitcnt vmcnt(16) lgkmcnt(8)
s_barrier
MAV 32,0,144
TR 32,6,50688
s_add_u32 m0, s55, 33792
MAV 32,16,152
buffer_load_dwordx4 v18, s[28:31], s54 offen lds
MAV 48,16,156
TR 34,6,51200
MAV 48,0,148
TR 36,6,50720
TR 38,6,51232
MAV 52,4,148
TR 48,6,59136
s_add_u32 s52, s78, 704512
MAV 52,20,156
buffer_load_dwordx4 v[128:131], v4, s[16:19], s52 offen sc1
MAV 36,20,152
TR 50,6,59648
MAV 36,4,144
TR 52,6,59168
TR 54,6,59680
s_waitcnt lgkmcnt(8)
MAV 40,8,144
TR 40,6,50752
MAV 40,24,152
buffer_load_dwordx4 v19, s[28:31], s54 offen offset:1056 lds
MAV 56,24,156
TR 42,6,51264
s_add_u32 s54, s100, 1310720
MAV 56,8,148
TR 44,6,50784
TR 46,6,51296
MAV 60,12,148
TR 56,6,59200
MAV 60,28,156
buffer_load_dwordx4 v[132:135], v4, s[16:19], s52 offen offset:1024 sc1
MAV 44,28,152
TR 58,6,59712
MAV 44,12,144
TR 60,6,59232
TR 62,6,59744
v_add_u32 v7, s57, v7
v_add_u32 v6, s57, v6
s_sub_u32 s57, 0, s57
s_waitcnt lgkmcnt(8)
MAV 64,32,144
ds_read_b64_tr_b16 a[0:1], v7
s_add_u32 m0, s55, 42240
MAV 64,48,152
buffer_load_dwordx4 v18, s[28:31], s54 offen lds
MAV 80,48,156
TR 2,7,512
MAV 80,32,148
TR 4,7,32
TR 6,7,544
MAV 84,36,148
TR 16,7,8448
s_add_u32 s52, s78, 770048
MAV 84,52,156
buffer_load_dwordx4 v[136:139], v4, s[16:19], s52 offen sc1
MAV 68,52,152
TR 18,7,8960
MAV 68,36,144
TR 20,7,8480
TR 22,7,8992
s_waitcnt lgkmcnt(8)
MAV 72,40,144
TR 8,7,64
MAV 72,56,152
buffer_load_dwordx4 v19, s[28:31], s54 offen offset:1056 lds
MAV 88,56,156
TR 10,7,576
s_add_u32 s54, s101, 1507328
MAV 88,40,148
TR 12,7,96
TR 14,7,608
MAV 92,44,148
TR 24,7,8512
MAV 92,60,156
buffer_load_dwordx4 v[140:143], v4, s[16:19], s52 offen offset:1024 sc1
MAV 76,60,152
TR 26,7,9024
MAV 76,44,144
TR 28,7,8544
TR 30,7,9056
s_waitcnt vmcnt(16) lgkmcnt(8)
s_barrier
MAV 32,0,96
ds_read_b64_tr_b16 a[32:33], v6
s_add_u32 m0, s55, 50688
MAV 32,16,104
buffer_load_dwordx4 v18, s[28:31], s54 offen lds
MAV 48,16,108
TR 34,6,512
MAV 48,0,100
TR 36,6,32
TR 38,6,544
MAV 52,4,100
TR 48,6,8448
s_add_u32 s52, s79, 819200
MAV 52,20,108
buffer_load_dwordx4 v[144:147], v4, s[16:19], s52 offen sc1
MAV 36,20,104
TR 50,6,8960
MAV 36,4,96
TR 52,6,8480
TR 54,6,8992
s_waitcnt lgkmcnt(8)
MAV 40,8,96
TR 40,6,64
MAV 40,24,104
buffer_load_dwordx4 v19, s[28:31], s54 offen offset:1056 lds
.Lpad38:
s_cbranch_execz .Lnopoll63r
MAV 56,24,108
TR 42,6,576
s_add_u32 s54, s101, 1769472
MAV 56,8,100
TR 44,6,96
TR 46,6,608
MAV 60,12,100
TR 56,6,8512
MAV 60,28,108
buffer_load_dwordx4 v[148:151], v4, s[16:19], s52 offen offset:1024 sc1
MAV 44,28,104
TR 58,6,9024
MAV 44,12,96
TR 60,6,8544
TR 62,6,9056
s_waitcnt lgkmcnt(8)
MAV 64,32,96
TR 0,7,16896
s_add_u32 m0, s55, 59136
MAV 64,48,104
buffer_load_dwordx4 v18, s[28:31], s54 offen lds
MAV 80,48,108
TR 2,7,17408
MAV 80,32,100
TR 4,7,16928
TR 6,7,17440
MAV 84,36,100
TR 16,7,25344
s_add_u32 s52, s79, 884736
MAV 84,52,108
buffer_load_dwordx4 v[152:155], v4, s[16:19], s52 offen sc1
MAV 68,52,104
TR 18,7,25856
MAV 68,36,96
TR 20,7,25376
TR 22,7,25888
s_waitcnt lgkmcnt(8)
MAV 72,40,96
TR 8,7,16960
MAV 72,56,104
buffer_load_dwordx4 v19, s[28:31], s54 offen offset:1056 lds
MAV 88,56,108
TR 10,7,17472
s_add_u32 s54, s98, 1966080
MAV 88,40,100
TR 12,7,16992
TR 14,7,17504
MAV 92,44,100
TR 24,7,25408
MAV 92,60,108
buffer_load_dwordx4 v[156:159], v4, s[16:19], s52 offen offset:1024 sc1
MAV 76,60,104
TR 26,7,25920
MAV 76,44,96
TR 28,7,25440
TR 30,7,25952
s_waitcnt vmcnt(16) lgkmcnt(8)
s_barrier
MAV 32,0,112
TR 32,6,16896
s_add_u32 m0, s55, 67584
MAV 32,16,120
buffer_load_dwordx4 v18, s[28:31], s54 offen lds
MAV 48,16,124
TR 34,6,17408
MAV 48,0,116
TR 36,6,16928
TR 38,6,17440
MAV 52,4,116
TR 48,6,25344
s_add_u32 s52, s76, 32768
MAV 52,20,124
buffer_load_dwordx4 v[96:99], v4, s[16:19], s52 offen sc1
MAV 36,20,120
TR 50,6,25856
MAV 36,4,112
TR 52,6,25376
TR 54,6,25888
s_waitcnt lgkmcnt(8)
MAV 40,8,112
TR 40,6,16960
MAV 40,24,120
buffer_load_dwordx4 v19, s[28:31], s54 offen offset:1056 lds
MAV 56,24,124
TR 42,6,17472
s_add_u32 s54, s98, 2228224
MAV 56,8,116
TR 44,6,16992
TR 46,6,17504
MAV 60,12,116
TR 56,6,25408
MAV 60,28,124
buffer_load_dwordx4 v[100:103], v4, s[16:19], s52 offen offset:1024 sc1
MAV 44,28,120
TR 58,6,25920
MAV 44,12,112
TR 60,6,25440
TR 62,6,25952
s_waitcnt lgkmcnt(8)
MAV 64,32,112
TR 0,7,33792
s_add_u32 m0, s55, 76032
MAV 64,48,120
buffer_load_dwordx4 v18, s[28:31], s54 offen lds
MAV 80,48,124
TR 2,7,34304
MAV 80,32,116
TR 4,7,33824
TR 6,7,34336
MAV 84,36,116
TR 16,7,42240
s_add_u32 s52, s76, 98304
MAV 84,52,124
buffer_load_dwordx4 v[104:107], v4, s[16:19], s52 offen sc1
MAV 68,52,120
TR 18,7,42752
MAV 68,36,112
TR 20,7,42272
TR 22,7,42784
s_waitcnt lgkmcnt(8)
MAV 72,40,112
TR 8,7,33856
MAV 72,56,120
buffer_load_dwordx4 v19, s[28:31], s54 offen offset:1056 lds
MAV 88,56,124
TR 10,7,34368
s_add_u32 s54, s99, 2424832
MAV 88,40,116
TR 12,7,33888
TR 14,7,34400
MAV 92,44,116
TR 24,7,42304
MAV 92,60,124
buffer_load_dwordx4 v[108:111], v4, s[16:19], s52 offen offset:1024 sc1
MAV 76,60,120
TR 26,7,42816
MAV 76,44,112
TR 28,7,42336
TR 30,7,42848
s_waitcnt vmcnt(16) lgkmcnt(8)
s_barrier
MAV 32,0,128
TR 32,6,33792
s_add_u32 m0, s55, 84480
MAV 32,16,136
buffer_load_dwordx4 v18, s[28:31], s54 offen lds
MAV 48,16,140
TR 34,6,34304
MAV 48,0,132
TR 36,6,33824
TR 38,6,34336
MAV 52,4,132
TR 48,6,42240
s_add_u32 s52, s77, 147456
MAV 52,20,140
buffer_load_dwordx4 v[112:115], v4, s[16:19], s52 offen sc1
MAV 36,20,136
TR 50,6,42752
MAV 36,4,128
TR 52,6,42272
TR 54,6,42784
s_waitcnt lgkmcnt(8)
MAV 40,8,128
TR 40,6,33856
MAV 40,24,136
buffer_load_dwordx4 v19, s[28:31], s54 offen offset:1056 lds
MAV 56,24,140
TR 42,6,34368
s_add_u32 s54, s99, 2686976
MAV 56,8,132
TR 44,6,33888
TR 46,6,34400
MAV 60,12,132
TR 56,6,42304
MAV 60,28,140
buffer_load_dwordx4 v[116:119], v4, s[16:19], s52 offen offset:1024 sc1
MAV 44,28,136
TR 58,6,42816
MAV 44,12,128
TR 60,6,42336
TR 62,6,42848
s_waitcnt lgkmcnt(8)
MAV 64,32,128
TR 0,7,50688
s_add_u32 m0, s55, 92928
MAV 64,48,136
buffer_load_dwordx4 v18, s[28:31], s54 offen lds
MAV 80,48,140
TR 2,7,51200
MAV 80,32,132
TR 4,7,50720
TR 6,7,51232
MAV 84,36,132
TR 16,7,59136
s_add_u32 s52, s77, 212992
MAV 84,52,140
buffer_load_dwordx4 v[120:123], v4, s[16:19], s52 offen sc1
MAV 68,52,136
TR 18,7,59648
MAV 68,36,128
TR 20,7,59168
TR 22,7,59680
s_waitcnt lgkmcnt(8)
MAV 72,40,128
TR 8,7,50752
MAV 72,56,136
buffer_load_dwordx4 v19, s[28:31], s54 offen offset:1056 lds
MAV 88,56,140
TR 10,7,51264
s_add_u32 s54, s100, 2883584
MAV 88,40,132
TR 12,7,50784
TR 14,7,51296
MAV 92,44,132
TR 24,7,59200
MAV 92,60,140
buffer_load_dwordx4 v[124:127], v4, s[16:19], s52 offen offset:1024 sc1
MAV 76,60,136
TR 26,7,59712
MAV 76,44,128
TR 28,7,59232
TR 30,7,59744
s_waitcnt vmcnt(16) lgkmcnt(8)
s_barrier
MAV 32,0,144
TR 32,6,50688
s_add_u32 m0, s55, 101376
MAV 32,16,152
buffer_load_dwordx4 v18, s[28:31], s54 offen lds
MAV 48,16,156
TR 34,6,51200
MAV 48,0,148
TR 36,6,50720
TR 38,6,51232
MAV 52,4,148
TR 48,6,59136
s_add_u32 s52, s78, 262144
MAV 52,20,156
buffer_load_dwordx4 v[128:131], v4, s[16:19], s52 offen sc1
MAV 36,20,152
TR 50,6,59648
MAV 36,4,144
TR 52,6,59168
TR 54,6,59680
s_waitcnt lgkmcnt(8)
MAV 40,8,144
TR 40,6,50752
MAV 40,24,152
buffer_load_dwordx4 v19, s[28:31], s54 offen offset:1056 lds
MAV 56,24,156
TR 42,6,51264
s_add_u32 s54, s100, 3145728
MAV 56,8,148
TR 44,6,50784
TR 46,6,51296
MAV 60,12,148
TR 56,6,59200
MAV 60,28,156
buffer_load_dwordx4 v[132:135], v4, s[16:19], s52 offen offset:1024 sc1
MAV 44,28,152
TR 58,6,59712
MAV 44,12,144
TR 60,6,59232
TR 62,6,59744
v_add_u32 v7, s57, v7
v_add_u32 v6, s57, v6
s_sub_u32 s57, 0, s57
s_waitcnt lgkmcnt(8)
MAV 64,32,144
ds_read_b64_tr_b16 a[0:1], v7
s_add_u32 m0, s55, 109824
MAV 64,48,152
buffer_load_dwordx4 v18, s[28:31], s54 offen lds
MAV 80,48,156
TR 2,7,512
MAV 80,32,148
TR 4,7,32
TR 6,7,544
MAV 84,36,148
TR 16,7,8448
s_add_u32 s52, s78, 327680
MAV 84,52,156
buffer_load_dwordx4 v[136:139], v4, s[16:19], s52 offen sc1
MAV 68,52,152
TR 18,7,8960
MAV 68,36,144
TR 20,7,8480
TR 22,7,8992
s_waitcnt lgkmcnt(8)
MAV 72,40,144
TR 8,7,64
MAV 72,56,152
buffer_load_dwordx4 v19, s[28:31], s54 offen offset:1056 lds
MAV 88,56,156
TR 10,7,576
s_add_u32 s54, s101, 3342336
MAV 88,40,148
TR 12,7,96
TR 14,7,608
MAV 92,44,148
TR 24,7,8512
MAV 92,60,156
buffer_load_dwordx4 v[140:143], v4, s[16:19], s52 offen offset:1024 sc1
MAV 76,60,152
TR 26,7,9024
MAV 76,44,144
TR 28,7,8544
TR 30,7,9056
s_waitcnt vmcnt(16) lgkmcnt(8)
s_barrier
MAV 32,0,96
ds_read_b64_tr_b16 a[32:33], v6
s_add_u32 m0, s55, 118272
MAV 32,16,104
buffer_load_dwordx4 v18, s[28:31], s54 offen lds
MAV 48,16,108
TR 34,6,512
MAV 48,0,100
TR 36,6,32
TR 38,6,544
MAV 52,4,100
TR 48,6,8448
s_add_u32 s52, s79, 376832
MAV 52,20,108
buffer_load_dwordx4 v[144:147], v4, s[16:19], s52 offen sc1
MAV 36,20,104
TR 50,6,8960
MAV 36,4,96
TR 52,6,8480
TR 54,6,8992
s_waitcnt lgkmcnt(8)
MAV 40,8,96
TR 40,6,64
MAV 40,24,104
buffer_load_dwordx4 v19, s[28:31], s54 offen offset:1056 lds
MAV 56,24,108
TR 42,6,576
s_add_u32 s54, s101, 3604480
MAV 56,8,100
TR 44,6,96
TR 46,6,608
MAV 60,12,100
TR 56,6,8512
MAV 60,28,108
buffer_load_dwordx4 v[148:151], v4, s[16:19], s52 offen offset:1024 sc1
MAV 44,28,104
TR 58,6,9024
MAV 44,12,96
TR 60,6,8544
TR 62,6,9056
s_waitcnt lgkmcnt(8)
MAV 64,32,96
TR 0,7,16896
s_add_u32 m0, s55, 126720
MAV 64,48,104
buffer_load_dwordx4 v18, s[28:31], s54 offen lds
MAV 80,48,108
TR 2,7,17408
MAV 80,32,100
TR 4,7,16928
TR 6,7,17440
MAV 84,36,100
TR 16,7,25344
s_add_u32 s52, s79, 442368
MAV 84,52,108
buffer_load_dwordx4 v[152:155], v4, s[16:19], s52 offen sc1
MAV 68,52,104
TR 18,7,25856
MAV 68,36,96
TR 20,7,25376
TR 22,7,25888
s_waitcnt lgkmcnt(8)
MAV 72,40,96
TR 8,7,16960
MAV 72,56,104
buffer_load_dwordx4 v19, s[28:31], s54 offen offset:1056 lds
MAV 88,56,108
TR 10,7,17472
s_add_u32 s54, s98, 196608
MAV 88,40,100
TR 12,7,16992
TR 14,7,17504
MAV 92,44,100
TR 24,7,25408
MAV 92,60,108
buffer_load_dwordx4 v[156:159], v4, s[16:19], s52 offen offset:1024 sc1
MAV 76,60,104
TR 26,7,25920
MAV 76,44,96
TR 28,7,25440
TR 30,7,25952
s_waitcnt vmcnt(16) lgkmcnt(8)
s_barrier
MAV 32,0,112
TR 32,6,16896
s_add_u32 m0, s55, 0
MAV 32,16,120
buffer_load_dwordx4 v18, s[28:31], s54 offen lds
MAV 48,16,124
TR 34,6,17408
MAV 48,0,116
TR 36,6,16928
TR 38,6,17440
MAV 52,4,116
TR 48,6,25344
s_add_u32 s52, s76, 491520
MAV 52,20,124
buffer_load_dwordx4 v[96:99], v4, s[16:19], s52 offen sc1
MAV 36,20,120
TR 50,6,25856
MAV 36,4,112
TR 52,6,25376
TR 54,6,25888
s_waitcnt lgkmcnt(8)
MAV 40,8,112
TR 40,6,16960
MAV 40,24,120
buffer_load_dwordx4 v19, s[28:31], s54 offen offset:1056 lds
MAV 56,24,124
TR 42,6,17472
s_add_u32 s54, s99, 655360
MAV 56,8,116
TR 44,6,16992
TR 46,6,17504
MAV 60,12,116
TR 56,6,25408
MAV 60,28,124
buffer_load_dwordx4 v[100:103], v4, s[16:19], s52 offen offset:1024 sc1
MAV 44,28,120
TR 58,6,25920
MAV 44,12,112
TR 60,6,25440
TR 62,6,25952
s_waitcnt lgkmcnt(8)
MAV 64,32,112
TR 0,7,33792
s_add_u32 m0, s55, 8448
MAV 64,48,120
buffer_load_dwordx4 v18, s[28:31], s54 offen lds
MAV 80,48,124
TR 2,7,34304
MAV 80,32,116
TR 4,7,33824
TR 6,7,34336
MAV 84,36,116
TR 16,7,42240
s_add_u32 s52, s76, 557056
MAV 84,52,124
buffer_load_dwordx4 v[104:107], v4, s[16:19], s52 offen sc1
MAV 68,52,120
TR 18,7,42752
MAV 68,36,112
TR 20,7,42272
TR 22,7,42784
s_waitcnt lgkmcnt(8)
MAV 72,40,112
TR 8,7,33856
MAV 72,56,120
buffer_load_dwordx4 v19, s[28:31], s54 offen offset:1056 lds
MAV 88,56,124
TR 10,7,34368
s_add_u32 s54, s100, 1114112
MAV 88,40,116
TR 12,7,33888
TR 14,7,34400
MAV 92,44,116
TR 24,7,42304
MAV 92,60,124
buffer_load_dwordx4 v[108:111], v4, s[16:19], s52 offen offset:1024 sc1
MAV 76,60,120
TR 26,7,42816
MAV 76,44,112
TR 28,7,42336
TR 30,7,42848
s_waitcnt vmcnt(16) lgkmcnt(8)
s_barrier
MAV 32,0,128
TR 32,6,33792
s_add_u32 m0, s55, 16896
MAV 32,16,136
buffer_load_dwordx4 v18, s[28:31], s54 offen lds
MAV 48,16,140
TR 34,6,34304
MAV 48,0,132
TR 36,6,33824
TR 38,6,34336
MAV 52,4,132
TR 48,6,42240
s_add_u32 s52, s77, 606208
MAV 52,20,140
buffer_load_dwordx4 v[112:115], v4, s[16:19], s52 offen sc1
MAV 36,20,136
TR 50,6,42752
MAV 36,4,128
TR 52,6,42272
TR 54,6,42784
s_waitcnt lgkmcnt(8)
MAV 40,8,128
TR 40,6,33856
MAV 40,24,136
buffer_load_dwordx4 v19, s[28:31], s54 offen offset:1056 lds
MAV 56,24,140
TR 42,6,34368
s_add_u32 s54, s101, 1572864
MAV 56,8,132
TR 44,6,33888
TR 46,6,34400
MAV 60,12,132
TR 56,6,42304
MAV 60,28,140
buffer_load_dwordx4 v[116:119], v4, s[16:19], s52 offen offset:1024 sc1
MAV 44,28,136
TR 58,6,42816
MAV 44,12,128
TR 60,6,42336
TR 62,6,42848
s_waitcnt lgkmcnt(8)
MAV 64,32,128
TR 0,7,50688
s_add_u32 m0, s55, 25344
MAV 64,48,136
buffer_load_dwordx4 v18, s[28:31], s54 offen lds
MAV 80,48,140
TR 2,7,51200
MAV 80,32,132
TR 4,7,50720
TR 6,7,51232
MAV 84,36,132
TR 16,7,59136
.Lpad39:
s_cbranch_execz .Lnopoll63r
s_add_u32 s52, s77, 671744
MAV 84,52,140
buffer_load_dwordx4 v[120:123], v4, s[16:19], s52 offen sc1
MAV 68,52,136
TR 18,7,59648
MAV 68,36,128
TR 20,7,59168
TR 22,7,59680
s_waitcnt lgkmcnt(8)
MAV 72,40,128
TR 8,7,50752
MAV 72,56,136
buffer_load_dwordx4 v19, s[28:31], s54 offen offset:1056 lds
MAV 88,56,140
TR 10,7,51264
s_add_u32 s54, s98, 2031616
MAV 88,40,132
TR 12,7,50784
TR 14,7,51296
MAV 92,44,132
TR 24,7,59200
MAV 92,60,140
buffer_load_dwordx4 v[124:127], v4, s[16:19], s52 offen offset:1024 sc1
MAV 76,60,136
TR 26,7,59712
MAV 76,44,128
TR 28,7,59232
TR 30,7,59744
s_waitcnt vmcnt(16) lgkmcnt(8)
s_barrier
MAV 32,0,144
TR 32,6,50688
s_add_u32 m0, s55, 33792
MAV 32,16,152
buffer_load_dwordx4 v18, s[28:31], s54 offen lds
MAV 48,16,156
TR 34,6,51200
MAV 48,0,148
TR 36,6,50720
TR 38,6,51232
MAV 52,4,148
TR 48,6,59136
s_add_u32 s52, s78, 720896
MAV 52,20,156
buffer_load_dwordx4 v[128:131], v4, s[16:19], s52 offen sc1
MAV 36,20,152
TR 50,6,59648
MAV 36,4,144
TR 52,6,59168
TR 54,6,59680
s_waitcnt lgkmcnt(8)
MAV 40,8,144
TR 40,6,50752
MAV 40,24,152
buffer_load_dwordx4 v19, s[28:31], s54 offen offset:1056 lds
MAV 56,24,156
TR 42,6,51264
s_add_u32 s54, s99, 2490368
MAV 56,8,148
TR 44,6,50784
TR 46,6,51296
MAV 60,12,148
TR 56,6,59200
MAV 60,28,156
buffer_load_dwordx4 v[132:135], v4, s[16:19], s52 offen offset:1024 sc1
MAV 44,28,152
TR 58,6,59712
MAV 44,12,144
TR 60,6,59232
TR 62,6,59744
v_add_u32 v7, s57, v7
v_add_u32 v6, s57, v6
s_sub_u32 s57, 0, s57
s_waitcnt lgkmcnt(8)
MAV 64,32,144
ds_read_b64_tr_b16 a[0:1], v6
s_add_u32 m0, s55, 42240
MAV 64,48,152
buffer_load_dwordx4 v18, s[28:31], s54 offen lds
MAV 80,48,156
TR 2,6,512
MAV 80,32,148
TR 4,6,32
TR 6,6,544
MAV 84,36,148
TR 16,6,8448
s_add_u32 s52, s78, 786432
MAV 84,52,156
buffer_load_dwordx4 v[136:139], v4, s[16:19], s52 offen sc1
MAV 68,52,152
TR 18,6,8960
MAV 68,36,144
TR 20,6,8480
TR 22,6,8992
s_waitcnt lgkmcnt(8)
MAV 72,40,144
TR 8,6,64
MAV 72,56,152
buffer_load_dwordx4 v19, s[28:31], s54 offen offset:1056 lds
MAV 88,56,156
TR 10,6,576
s_add_u32 s54, s100, 2949120
MAV 88,40,148
TR 12,6,96
TR 14,6,608
MAV 92,44,148
TR 24,6,8512
MAV 92,60,156
buffer_load_dwordx4 v[140:143], v4, s[16:19], s52 offen offset:1024 sc1
MAV 76,60,152
TR 26,6,9024
MAV 76,44,144
TR 28,6,8544
TR 30,6,9056
s_waitcnt vmcnt(16) lgkmcnt(8)
s_barrier
MAV 64,0,96
TR 32,6,16896
TR 34,6,17408
s_add_u32 m0, s55, 50688
MAV 64,16,104
TR 36,6,16928
buffer_load_dwordx4 v18, s[28:31], s54 offen lds
MAV 80,16,108
TR 38,6,17440
MAV 80,0,100
TR 48,6,25344
buffer_load_dwordx4 v19, s[28:31], s54 offen offset:1056 lds
MAV 84,4,100
TR 50,6,25856
s_add_u32 s54, s101, 3407872
s_add_u32 s52, s79, 835584
MAV 84,20,108
buffer_load_dwordx4 v[144:147], v4, s[16:19], s52 offen sc1
MAV 68,20,104
TR 52,6,25376
TR 54,6,25888
MAV 68,4,96
TR 40,6,16960
s_waitcnt lgkmcnt(9)
MAV 72,8,96
TR 42,6,17472
MAV 72,24,104
TR 44,6,16992
buffer_load_dwordx4 v[148:151], v4, s[16:19], s52 offen offset:1024 sc1
MAV 88,24,108
TR 46,6,17504
s_add_u32 m0, s55, 59136
MAV 88,8,100
TR 56,6,25408
buffer_load_dwordx4 v18, s[28:31], s54 offen lds
MAV 92,12,100
TR 58,6,25920
MAV 92,28,108
TR 60,6,25440
buffer_load_dwordx4 v19, s[28:31], s54 offen offset:1056 lds
MAV 76,28,104
TR 62,6,25952
s_add_u32 s52, s79, 901120
MAV 76,12,96
buffer_load_dwordx4 v[152:155], v4, s[16:19], s52 offen sc1
buffer_load_dwordx4 v[156:159], v4, s[16:19], s52 offen offset:1024 sc1
s_waitcnt vmcnt(16) lgkmcnt(8)
MAV 64,32,112
TR 0,6,33792
s_add_u32 s52, s76, 49152
s_lshl_b32 s70, s2, 10
s_lshl_b32 s62, s3, 7
MAV 64,48,120
buffer_load_dwordx4 v[160:163], v4, s[16:19], s52 offen sc1
s_add_u32 s70, s70, s62
MAV 80,48,124
TR 2,6,34304
s_add_u32 s70, s70, 31457792
MAV 80,32,116
TR 4,6,33824
TR 6,6,34336
s_xor_b32 s71, s70, 1024
MAV 84,36,116
TR 16,6,42240
v_min_u32 v12, 1, v1
MAV 84,52,124
buffer_load_dwordx4 v[164:167], v4, s[16:19], s52 offen offset:1024 sc1
v_lshlrev_b32 v12, 28, v12
MAV 68,52,120
TR 18,6,42752
v_mov_b32 v13, 1
MAV 68,36,112
TR 20,6,42272
TR 22,6,42784
v_mov_b32 v15, 0
s_waitcnt lgkmcnt(8)
MAV 72,40,112
TR 8,6,33856
s_add_u32 s52, s77, 163840
s_lshl_b32 s68, s7, 18
MAV 72,56,120
buffer_load_dwordx4 v[168:171], v4, s[16:19], s52 offen sc1
s_add_u32 s68, s68, 146800640
MAV 88,56,124
TR 10,6,34368
s_xor_b32 s69, s68, 262144
MAV 88,40,116
TR 12,6,33888
TR 14,6,34400
v_mov_b32 v11, v4
MAV 92,44,116
TR 24,6,42304
v_and_b32 v2, 1, v1
MAV 92,60,124
buffer_load_dwordx4 v[172:175], v4, s[16:19], s52 offen offset:1024 sc1
v_lshlrev_b32 v2, 4, v2
MAV 76,60,120
TR 26,6,42816
v_mov_b32 v224, 0x3f80
v_lshlrev_b32 v2, v2, v224
MAV 76,44,112
TR 28,6,42336
TR 30,6,42848
s_waitcnt vmcnt(12) lgkmcnt(8)
MAV 64,0,128
TR 32,6,50688
s_add_u32 s52, s78, 278528
v_bfe_u32 v224, v1, 2, 2
v_lshrrev_b32 v225, 4, v1
MAV 64,16,136
buffer_load_dwordx4 v[176:179], v4, s[16:19], s52 offen sc1
v_cmp_eq_u32 vcc, v224, v225
MAV 80,16,140
TR 34,6,51200
v_cndmask_b32 v2, 0, v2, vcc
MAV 80,0,132
TR 36,6,50720
TR 38,6,51232
v_and_b32 v224, 2, v1
MAV 84,4,132
TR 48,6,59136
v_cmp_eq_u32 vcc, 0, v224
MAV 84,20,140
buffer_load_dwordx4 v[180:183], v4, s[16:19], s52 offen offset:1024 sc1
v_cndmask_b32 v226, 0, v2, vcc
MAV 68,20,136
TR 50,6,59648
v_cndmask_b32 v227, v2, 0, vcc
MAV 68,4,128
TR 52,6,59168
TR 54,6,59680
v_mov_b32 v224, 0
s_waitcnt lgkmcnt(8)
MAV 72,8,128
TR 40,6,50752
s_add_u32 s52, s79, 393216
v_mov_b32 v225, 0
MAV 72,24,136
buffer_load_dwordx4 v[184:187], v4, s[16:19], s52 offen sc1
v_mov_b32 v228, 0
MAV 88,24,140
TR 42,6,51264
v_mov_b32 v229, 0
MAV 88,8,132
TR 44,6,50784
TR 46,6,51296
s_lshr_b32 s62, s6, 1
MAV 92,12,132
TR 56,6,59200
s_lshl_b32 s62, s62, 8
MAV 92,28,140
buffer_load_dwordx4 v[188:191], v4, s[16:19], s52 offen offset:1024 sc1
s_and_b32 s67, s6, 1
MAV 76,28,136
TR 58,6,59712
s_add_u32 s62, s62, s67
s_lshl_b32 s62, s62, 11
MAV 76,12,128
TR 60,6,59232
TR 62,6,59744
s_waitcnt vmcnt(8) lgkmcnt(8)
s_barrier
v_add_u32 v6, s57, v6
MAV 64,32,144
ds_read_b64_tr_b16 a[0:1], v6
s_add_u32 s52, s76, 507904
s_lshl_b32 s63, s3, 17
s_add_u32 s62, s62, s63
MAV 64,48,152
buffer_load_dwordx4 v[192:195], v4, s[16:19], s52 offen sc1
s_lshl_b32 s63, s7, 7
MAV 80,48,156
TR 2,6,512
s_add_u32 s62, s62, s63
MAV 80,32,148
TR 4,6,32
TR 6,6,544
s_mov_b32 s64, 0x8000
MAV 84,36,148
TR 16,6,8448
v_lshrrev_b32 v21, 3, v1
MAV 84,52,156
buffer_load_dwordx4 v[196:199], v4, s[16:19], s52 offen offset:1024 sc1
v_and_b32 v2, 7, v1
MAV 68,52,152
TR 18,6,8960
v_lshlrev_b32 v2, 4, v2
MAV 68,36,144
TR 20,6,8480
TR 22,6,8992
v_lshl_add_u32 v16, v21, 12, v2
s_waitcnt lgkmcnt(8)
MAV 72,40,144
TR 8,6,64
s_add_u32 s52, s77, 622592
v_add_u32 v16, s62, v16
MAV 72,56,152
buffer_load_dwordx4 v[200:203], v4, s[16:19], s52 offen sc1
v_add_u32 v17, 0x10000, v16
MAV 88,56,156
TR 10,6,576
s_mul_i32 s62, s3, 4608
MAV 88,40,148
TR 12,6,96
TR 14,6,608
s_add_u32 s62, s62, 135168
MAV 92,44,148
TR 24,6,8512
v_mul_u32_u24 v21, 144, v21
MAV 92,60,156
buffer_load_dwordx4 v[204:207], v4, s[16:19], s52 offen offset:1024 sc1
v_add3_u32 v21, v21, v2, s62
MAV 76,60,152
TR 26,6,9024
v_and_b32 v20, 15, v1
v_mul_u32_u24 v20, 144, v20
MAV 76,44,144
TR 28,6,8544
TR 30,6,9056
s_waitcnt vmcnt(8) lgkmcnt(8)
MAV 64,0,160
TR 32,6,16896
s_add_u32 s52, s78, 737280
v_lshrrev_b32 v2, 4, v1
v_lshlrev_b32 v2, 3, v2
MAV 64,16,168
buffer_load_dwordx4 v[208:211], v4, s[16:19], s52 offen sc1
v_add3_u32 v20, v20, v2, s62
MAV 80,16,172
TR 34,6,17408
v_accvgpr_read_b32 v28, a224
MAV 80,0,164
TR 36,6,16928
TR 38,6,17440
v_add_f32 v32, v32, v28
MAV 84,4,164
TR 48,6,25344
v_accvgpr_read_b32 v29, a225
MAV 84,20,172
buffer_load_dwordx4 v[212:215], v4, s[16:19], s52 offen offset:1024 sc1
v_add_f32 v33, v33, v29
MAV 68,20,168
TR 50,6,25856
v_accvgpr_read_b32 v28, a226
MAV 68,4,160
TR 52,6,25376
TR 54,6,25888
v_add_f32 v34, v34, v28
s_waitcnt lgkmcnt(8)
MAV 72,8,160
TR 40,6,16960
s_add_u32 s52, s79, 851968
v_accvgpr_read_b32 v29, a227
MAV 72,24,168
buffer_load_dwordx4 v[216:219], v4, s[16:19], s52 offen sc1
v_add_f32 v35, v35, v29
MAV 88,24,172
TR 42,6,17472
v_accvgpr_read_b32 v28, a228
MAV 88,8,164
TR 44,6,16992
TR 46,6,17504
v_add_f32 v36, v36, v28
MAV 92,12,164
TR 56,6,25408
v_accvgpr_read_b32 v29, a229
MAV 92,28,172
buffer_load_dwordx4 v[220:223], v4, s[16:19], s52 offen offset:1024 sc1
v_add_f32 v37, v37, v29
MAV 76,28,168
TR 58,6,25920
v_accvgpr_read_b32 v28, a230
v_add_f32 v38, v38, v28
MAV 76,12,160
TR 60,6,25440
TR 62,6,25952
s_waitcnt vmcnt(8) lgkmcnt(8)
MAV 64,32,176
TR 0,6,33792
v_accvgpr_read_b32 v29, a231
MAV 64,48,184
TR 2,6,34304
v_add_f32 v39, v39, v29
v_accvgpr_read_b32 v28, a232
MAV 80,48,188
TR 4,6,33824
MAV 80,32,180
TR 6,6,34336
v_add_f32 v40, v40, v28
v_accvgpr_read_b32 v29, a233
MAV 84,36,180
TR 16,6,42240
v_add_f32 v41, v41, v29
MAV 84,52,188
TR 18,6,42752
v_accvgpr_read_b32 v28, a234
MAV 68,52,184
TR 20,6,42272
v_add_f32 v42, v42, v28
MAV 68,36,176
TR 22,6,42784
v_accvgpr_read_b32 v29, a235
s_waitcnt lgkmcnt(8)
MAV 72,40,176
TR 8,6,33856
MAV 72,56,184
TR 10,6,34368
v_add_f32 v43, v43, v29
v_accvgpr_read_b32 v28, a236
MAV 88,56,188
TR 12,6,33888
v_add_f32 v44, v44, v28
MAV 88,40,180
TR 14,6,34400
v_accvgpr_read_b32 v29, a237
MAV 92,44,180
TR 24,6,42304
v_add_f32 v45, v45, v29
MAV 92,60,188
TR 26,6,42816
v_accvgpr_read_b32 v28, a238
MAV 76,60,184
TR 28,6,42336
v_add_f32 v46, v46, v28
MAV 76,44,176
TR 30,6,42848
v_accvgpr_read_b32 v29, a239
s_waitcnt vmcnt(4) lgkmcnt(8)
MAV 64,0,192
TR 32,6,50688
v_add_f32 v47, v47, v29
MAV 64,16,200
TR 34,6,51200
v_accvgpr_read_b32 v28, a240
v_add_f32 v48, v48, v28
MAV 80,16,204
TR 36,6,50720
MAV 80,0,196
TR 38,6,51232
v_accvgpr_read_b32 v29, a241
v_add_f32 v49, v49, v29
MAV 84,4,196
TR 48,6,59136
v_accvgpr_read_b32 v28, a242
MAV 84,20,204
TR 50,6,59648
v_add_f32 v50, v50, v28
MAV 68,20,200
TR 52,6,59168
v_accvgpr_read_b32 v29, a243
MAV 68,4,192
TR 54,6,59680
v_add_f32 v51, v51, v29
s_waitcnt lgkmcnt(8)
MAV 72,8,192
TR 40,6,50752
MAV 72,24,200
TR 42,6,51264
v_accvgpr_read_b32 v28, a244
v_add_f32 v52, v52, v28
MAV 88,24,204
TR 44,6,50784
v_accvgpr_read_b32 v29, a245
MAV 88,8,196
TR 46,6,51296
v_add_f32 v53, v53, v29
MAV 92,12,196
TR 56,6,59200
v_accvgpr_read_b32 v28, a246
MAV 92,28,204
TR 58,6,59712
v_add_f32 v54, v54, v28
MAV 76,28,200
TR 60,6,59232
v_accvgpr_read_b32 v29, a247
MAV 76,12,192
TR 62,6,59744
v_add_f32 v55, v55, v29
s_waitcnt vmcnt(0) lgkmcnt(8)
MAV 64,32,208
ds_read_b64_tr_b16 a[0:1], v7
v_accvgpr_read_b32 v28, a248
MAV 64,48,216
TR 2,7,512
v_add_f32 v56, v56, v28
v_accvgpr_read_b32 v29, a249
MAV 80,48,220
TR 4,7,32
MAV 80,32,212
TR 6,7,544
v_add_f32 v57, v57, v29
v_accvgpr_read_b32 v28, a250
MAV 84,36,212
TR 16,7,8448
MAV 84,52,220
TR 18,7,8960
v_add_f32 v58, v58, v28
v_accvgpr_read_b32 v29, a251
MAV 68,52,216
TR 20,7,8480
MAV 68,36,208
TR 22,7,8992
v_add_f32 v59, v59, v29
s_waitcnt lgkmcnt(8)
MAV 72,40,208
TR 8,7,64
v_accvgpr_read_b32 v28, a252
MAV 72,56,216
TR 10,7,576
v_add_f32 v60, v60, v28
MAV 88,56,220
TR 12,7,96
v_accvgpr_read_b32 v29, a253
MAV 88,40,212
TR 14,7,608
v_add_f32 v61, v61, v29
MAV 92,44,212
TR 24,7,8512
v_accvgpr_read_b32 v28, a254
MAV 92,60,220
TR 26,7,9024
v_add_f32 v62, v62, v28
MAV 76,60,216
TR 28,7,8544
v_accvgpr_read_b32 v29, a255
MAV 76,44,208
TR 30,7,9056
v_add_f32 v63, v63, v29
s_waitcnt lgkmcnt(8)
MAV 32,0,96
TR 32,7,16896
v_cvt_pk_bf16_f32 v232, v64, v65
MAV 32,16,104
TR 34,7,17408
v_cvt_pk_bf16_f32 v233, v66, v67
v_cvt_pk_bf16_f32 v234, v68, v69
MAV 48,16,108
TR 36,7,16928
v_cvt_pk_bf16_f32 v235, v70, v71
MAV 48,0,100
TR 38,7,17440
buffer_store_dwordx4 v[232:235], v11, s[16:19], s69 offen sc1
s_add_u32 s69, s69, 131072
MAV 52,4,100
TR 48,7,25344
.Lpad40:
s_cbranch_execz .Lnopoll63r
v_cvt_pk_bf16_f32 v236, v72, v73
MAV 52,20,108
TR 50,7,25856
v_cvt_pk_bf16_f32 v237, v74, v75
v_cvt_pk_bf16_f32 v238, v76, v77
MAV 36,20,104
TR 52,7,25376
v_cvt_pk_bf16_f32 v239, v78, v79
MAV 36,4,96
TR 54,7,25888
buffer_store_dwordx4 v[236:239], v11, s[16:19], s69 offen sc1
s_waitcnt lgkmcnt(8)
MAV 40,8,96
TR 40,7,16960
s_add_u32 s69, s69, -130048
MAV 40,24,104
TR 42,7,17472
v_cvt_pk_bf16_f32 v240, v80, v81
v_cvt_pk_bf16_f32 v241, v82, v83
MAV 56,24,108
TR 44,7,16992
v_cvt_pk_bf16_f32 v242, v84, v85
MAV 56,8,100
TR 46,7,17504
v_cvt_pk_bf16_f32 v243, v86, v87
buffer_store_dwordx4 v[240:243], v11, s[16:19], s69 offen sc1
MAV 60,12,100
TR 56,7,25408
s_add_u32 s69, s69, 131072
MAV 60,28,108
TR 58,7,25920
v_cvt_pk_bf16_f32 v244, v88, v89
v_cvt_pk_bf16_f32 v245, v90, v91
MAV 44,28,104
TR 60,7,25440
v_cvt_pk_bf16_f32 v246, v92, v93
MAV 44,12,96
TR 62,7,25952
v_cvt_pk_bf16_f32 v247, v94, v95
buffer_store_dwordx4 v[244:247], v11, s[16:19], s69 offen sc1
s_waitcnt lgkmcnt(8)
MAV 32,32,112
TR 0,7,33792
MAV 32,48,120
TR 2,7,34304
MAV 48,48,124
TR 4,7,33824
MAV 48,32,116
TR 6,7,34336
MAV 52,36,116
TR 16,7,42240
MAV 52,52,124
TR 18,7,42752
MAV 36,52,120
TR 20,7,42272
MAV 36,36,112
TR 22,7,42784
s_waitcnt lgkmcnt(8)
MAV 40,40,112
TR 8,7,33856
MAV 40,56,120
TR 10,7,34368
MAV 56,56,124
TR 12,7,33888
MAV 56,40,116
TR 14,7,34400
MAV 60,44,116
TR 24,7,42304
MAV 60,60,124
TR 26,7,42816
MAV 44,60,120
TR 28,7,42336
MAV 44,44,112
TR 30,7,42848
s_waitcnt lgkmcnt(8)
MAV 32,0,128
TR 32,7,50688
MAV 32,16,136
TR 34,7,51200
MAV 48,16,140
TR 36,7,50720
MAV 48,0,132
TR 38,7,51232
MAV 52,4,132
TR 48,7,59136
MAV 52,20,140
TR 50,7,59648
MAV 36,20,136
TR 52,7,59168
MAV 36,4,128
TR 54,7,59680
s_waitcnt lgkmcnt(8)
MAV 40,8,128
TR 40,7,50752
MAV 40,24,136
TR 42,7,51264
MAV 56,24,140
TR 44,7,50784
MAV 56,8,132
TR 46,7,51296
MAV 60,12,132
TR 56,7,59200
MAV 60,28,140
TR 58,7,59712
MAV 44,28,136
TR 60,7,59232
MAV 44,12,128
TR 62,7,59744
v_add_u32 v7, s57, v7
s_waitcnt lgkmcnt(8)
MAV 32,32,144
ds_read_b64_tr_b16 a[0:1], v7
MAV 32,48,152
s_waitcnt vmcnt(0)
buffer_atomic_add v13, v12, s[16:19], s71 offen
MAV 48,48,156
TR 2,7,512
MAV 48,32,148
TR 4,7,32
TR 6,7,544
MAV 52,36,148
MAV 52,52,156
TR 16,7,8448
TR 18,7,8960
MAV 36,52,152
TR 20,7,8480
MAV 36,36,144
s_waitcnt lgkmcnt(7)
MAV 40,40,144
TR 22,7,8992
MAV 40,56,152
TR 8,7,64
TR 10,7,576
MAV 56,56,156
MAV 56,40,148
TR 12,7,96
TR 14,7,608
MAV 60,44,148
TR 24,7,8512
MAV 60,60,156
TR 26,7,9024
MAV 44,60,152
TR 28,7,8544
MAV 44,44,144
TR 30,7,9056
s_waitcnt lgkmcnt(8)
MAV 32,0,160
TR 32,7,16896
MAV 32,16,168
buffer_atomic_add v15, v12, s[16:19], s70 offen sc0
MAV 48,16,172
TR 34,7,17408
MAV 48,0,164
TR 36,7,16928
TR 38,7,17440
MAV 52,4,164
MAV 52,20,172
TR 48,7,25344
TR 50,7,25856
MAV 36,20,168
TR 52,7,25376
MAV 36,4,160
s_waitcnt lgkmcnt(7)
MAV 40,8,160
TR 54,7,25888
MAV 40,24,168
TR 40,7,16960
TR 42,7,17472
MAV 56,24,172
MAV 56,8,164
TR 44,7,16992
TR 46,7,17504
MAV 60,12,164
TR 56,7,25408
MAV 60,28,172
TR 58,7,25920
MAV 44,28,168
TR 60,7,25440
MAV 44,12,160
TR 62,7,25952
s_waitcnt lgkmcnt(8)
MAV 32,32,176
TR 0,7,33792
MAV 32,48,184
TR 2,7,34304
MAV 48,48,188
TR 4,7,33824
MAV 48,32,180
TR 6,7,34336
MAV 52,36,180
TR 16,7,42240
MAV 52,52,188
TR 18,7,42752
MAV 36,52,184
TR 20,7,42272
MAV 36,36,176
TR 22,7,42784
s_waitcnt lgkmcnt(8)
MAV 40,40,176
TR 8,7,33856
MAV 40,56,184
TR 10,7,34368
MAV 56,56,188
TR 12,7,33888
MAV 56,40,180
TR 14,7,34400
MAV 60,44,180
TR 24,7,42304
MAV 60,60,188
TR 26,7,42816
MAV 44,60,184
TR 28,7,42336
MAV 44,44,176
TR 30,7,42848
s_waitcnt vmcnt(0)
v_cmp_ne_u32 vcc, 0, v15
s_nop 0
s_cbranch_vccz .Lxs68
.Lxs68b:
s_waitcnt lgkmcnt(8)
MAV 32,0,192
TR 32,7,50688
MAV 32,16,200
buffer_load_dwordx4 v[232:235], v11, s[16:19], s68 offen sc1
MAV 48,16,204
TR 34,7,51200
s_add_u32 s68, s68, 131072
MAV 48,0,196
TR 36,7,50720
TR 38,7,51232
MAV 52,4,196
TR 48,7,59136
MAV 52,20,204
buffer_load_dwordx4 v[236:239], v11, s[16:19], s68 offen sc1
MAV 36,20,200
TR 50,7,59648
s_add_u32 s68, s68, -130048
MAV 36,4,192
TR 52,7,59168
TR 54,7,59680
s_waitcnt lgkmcnt(8)
MAV 40,8,192
TR 40,7,50752
MAV 40,24,200
buffer_load_dwordx4 v[240:243], v11, s[16:19], s68 offen sc1
MAV 56,24,204
TR 42,7,51264
s_add_u32 s68, s68, 131072
MAV 56,8,196
TR 44,7,50784
TR 46,7,51296
MAV 60,12,196
TR 56,7,59200
MAV 60,28,204
buffer_load_dwordx4 v[244:247], v11, s[16:19], s68 offen sc1
MAV 44,28,200
TR 58,7,59712
MAV 44,12,192
TR 60,7,59232
TR 62,7,59744
s_waitcnt lgkmcnt(8)
MAV 32,32,208
MAV 32,48,216
MAV 48,48,220
MAV 48,32,212
MAV 52,36,212
MAV 52,52,220
MAV 36,52,216
MAV 36,36,208
s_waitcnt lgkmcnt(0)
MAV 40,40,208
MAV 40,56,216
MAV 56,56,220
MAV 56,40,212
MAV 60,44,212
MAV 60,60,220
MAV 44,60,216
MAV 44,44,208
s_waitcnt vmcnt(3)
v_mfma_f32_16x16x32_bf16 v[32:35], v[226:229], v[232:235], v[32:35]
v_mfma_f32_16x16x32_bf16 v[36:39], v[224:227], v[232:235], v[36:39]
s_waitcnt vmcnt(2)
v_mfma_f32_16x16x32_bf16 v[40:43], v[226:229], v[236:239], v[40:43]
v_mfma_f32_16x16x32_bf16 v[44:47], v[224:227], v[236:239], v[44:47]
s_waitcnt vmcnt(1)
v_mfma_f32_16x16x32_bf16 v[48:51], v[226:229], v[240:243], v[48:51]
v_mfma_f32_16x16x32_bf16 v[52:55], v[224:227], v[240:243], v[52:55]
s_waitcnt vmcnt(0)
v_mfma_f32_16x16x32_bf16 v[56:59], v[226:229], v[244:247], v[56:59]
v_cvt_pk_bf16_f32 v128, v32, v33
v_mfma_f32_16x16x32_bf16 v[60:63], v[224:227], v[244:247], v[60:63]
v_cvt_pk_bf16_f32 v129, v34, v35
ds_write_b64 v20, v[128:129]
v_cvt_pk_bf16_f32 v130, v36, v37
v_cvt_pk_bf16_f32 v131, v38, v39
ds_write_b64 v20, v[130:131] offset:32
v_cvt_pk_bf16_f32 v132, v40, v41
v_cvt_pk_bf16_f32 v133, v42, v43
ds_write_b64 v20, v[132:133] offset:64
v_cvt_pk_bf16_f32 v134, v44, v45
v_cvt_pk_bf16_f32 v135, v46, v47
ds_write_b64 v20, v[134:135] offset:96
ds_read_b128 v[144:147], v21
ds_read_b128 v[148:151], v21 offset:1152
v_cvt_pk_bf16_f32 v136, v48, v49
v_cvt_pk_bf16_f32 v137, v50, v51
ds_write_b64 v20, v[136:137] offset:2304
v_cvt_pk_bf16_f32 v138, v52, v53
v_cvt_pk_bf16_f32 v139, v54, v55
ds_write_b64 v20, v[138:139] offset:2336
v_cvt_pk_bf16_f32 v140, v56, v57
v_cvt_pk_bf16_f32 v141, v58, v59
ds_write_b64 v20, v[140:141] offset:2368
v_cvt_pk_bf16_f32 v142, v60, v61
v_cvt_pk_bf16_f32 v143, v62, v63
ds_write_b64 v20, v[142:143] offset:2400
ds_read_b128 v[152:155], v21 offset:2304
ds_read_b128 v[156:159], v21 offset:3456
s_waitcnt lgkmcnt(7)
buffer_store_dwordx4 v[144:147], v16, s[36:39], 0 offen sc1
s_waitcnt lgkmcnt(6)
buffer_store_dwordx4 v[148:151], v16, s[36:39], s64 offen sc1
s_waitcnt lgkmcnt(1)
buffer_store_dwordx4 v[152:155], v17, s[36:39], 0 offen sc1
s_waitcnt lgkmcnt(0)
buffer_store_dwordx4 v[156:159], v17, s[36:39], s64 offen sc1
s_nop 1
.Lend:
s_endpgm
.Lsp67:
s_mov_b32 s15, 0
.Lsp67l:
v_mov_b32 v25, 0
buffer_atomic_add v25, v22, s[16:19], s73 offen sc0
s_add_u32 s15, s15, 1
s_cmp_gt_u32 s15, 100000
s_waitcnt vmcnt(0)
s_cbranch_scc1 .Lsp67b
v_cmp_gt_u32 vcc, v23, v25
s_nop 0
s_cbranch_vccnz .Lsp67l
s_branch .Lsp67b
.Lxs68:
s_mov_b32 s15, 0
.Lxs68l:
v_mov_b32 v15, 0
buffer_atomic_add v15, v12, s[16:19], s70 offen sc0
s_add_u32 s15, s15, 1
s_cmp_gt_u32 s15, 100000
s_waitcnt vmcnt(0)
s_cbranch_scc1 .Lxs68b
v_cmp_ne_u32 vcc, 0, v15
s_nop 0
s_cbranch_vccz .Lxs68l
s_branch .Lxs68b
.section .rodata,"a"
.p2align 6
.amdhsa_kernel interleave_layers__sliding_local_dilated__swiglu_ffn__prompt_kernel
  .amdhsa_next_free_vgpr 512
  .amdhsa_next_free_sgpr 102
  .amdhsa_accum_offset 256
  .amdhsa_group_segment_fixed_size 0
  .amdhsa_kernarg_size 80
  .amdhsa_user_sgpr_count 2
  .amdhsa_user_sgpr_kernarg_segment_ptr 1
  .amdhsa_system_sgpr_workgroup_id_x 1
  .amdhsa_float_denorm_mode_32 3
.end_amdhsa_kernel
```

```asm
; @launch grid=(256,1,1) block=(256,1,1) lds=162560
.amdgcn_target "amdgcn-amd-amdhsa--gfx950"
.macro MAA d,a,b
v_mfma_f32_16x16x32_bf16 v[\d:\d+3], a[\a:\a+3], a[\b:\b+3], v[\d:\d+3]
.endm
.macro MAV d,a,b
v_mfma_f32_16x16x32_bf16 v[\d:\d+3], a[\a:\a+3], v[\b:\b+3], v[\d:\d+3]
.endm
.macro TR d,v,o
ds_read_b64_tr_b16 a[\d:\d+1], v\v offset:\o
.endm
.macro RD d,v,o
ds_read_b128 a[\d:\d+3], v\v offset:\o
.endm
.text
.globl interleave_layers__sliding_local_dilated__swiglu_ffn__prompt_kernel
.p2align 8
.type interleave_layers__sliding_local_dilated__swiglu_ffn__prompt_kernel,@function
interleave_layers__sliding_local_dilated__swiglu_ffn__prompt_kernel:
s_load_dwordx4 s[68:71], s[0:1], 0
s_load_dwordx2 s[72:73], s[0:1], 16
s_load_dwordx8 s[76:83], s[0:1], 32
s_load_dwordx4 s[84:87], s[0:1], 64
s_cmp_lt_u32 s2, 256
s_cbranch_scc1 .Lgo
s_endpgm
.p2align 12
.Lgo:
v_lshrrev_b32 v2, 6, v0
v_and_b32 v1, 63, v0
v_readfirstlane_b32 s3, v2
s_and_b32 s4, s2, 7
s_lshr_b32 s5, s2, 3
s_lshr_b32 s8, s4, 2
s_lshl_b32 s8, s8, 3
s_and_b32 s62, s5, 7
s_add_u32 s8, s8, s62
s_and_b32 s9, s4, 3
s_lshl_b32 s9, s9, 2
s_lshr_b32 s62, s5, 3
s_add_u32 s9, s9, s62
s_and_b32 s48, s3, 1
s_lshr_b32 s49, s3, 1
s_lshl_b32 s50, s8, 3
s_sub_u32 s50, s50, 9
s_cmp_lt_u32 s8, 2
s_cselect_b32 s50, 7, s50
s_lshr_b32 s6, s4, 1
s_lshl_b32 s6, s6, 2
s_and_b32 s62, s5, 3
s_add_u32 s6, s6, s62
s_and_b32 s7, s4, 1
s_lshr_b32 s62, s5, 2
s_lshl_b32 s62, s62, 1
s_add_u32 s7, s7, s62
s_lshr_b32 s62, s6, 1
s_lshl_b32 s62, s62, 8
s_and_b32 s63, s6, 1
s_add_u32 s62, s62, s63
s_lshl_b32 s63, s3, 6
s_add_u32 s62, s62, s63
s_lshl_b32 s62, s62, 11
s_lshl_b32 s63, s7, 7
s_add_u32 s62, s62, s63
v_and_b32 v228, 15, v1
v_lshlrev_b32 v228, 12, v228
v_bfe_u32 v2, v1, 4, 1
v_lshl_add_u32 v228, v2, 5, v228
v_bfe_u32 v2, v1, 5, 1
v_lshl_add_u32 v228, v2, 4, v228
v_add_u32 v228, s62, v228
v_add_u32 v229, 0x10000, v228
s_sub_u32 s64, s3, 1
s_max_i32 s64, s64, 0
s_lshl_b32 s64, s64, 11
s_lshl_b32 s66, s9, 7
s_add_u32 s66, s66, s64
s_cmp_eq_u32 s3, 1
s_cselect_b32 s66, 8388608, s66
s_mul_i32 s65, s8, 122880
s_add_u32 s65, s65, s66
v_lshrrev_b32 v9, 1, v1
v_min_u32 v9, 19, v9
v_mul_u32_u24 v9, 6144, v9
s_xor_b32 s14, s3, 3
s_lshl_b32 s14, s14, 8
s_add_u32 s14, s14, s2
v_lshlrev_b32 v230, 4, v1
v_mov_b64 v[224:225], 0
v_mov_b64 v[226:227], 0
s_waitcnt lgkmcnt(0)
s_mov_b32 s16, s86
s_mov_b32 s17, s87
s_mov_b32 s18, 268435456
s_mov_b32 s19, 0x20000
s_mov_b32 s36, s68
s_mov_b32 s37, s69
s_mov_b32 s38, 4194304
s_mov_b32 s39, 0x20000
s_cmp_ge_u32 s14, 16
s_cbranch_scc1 .Lz3
s_lshl_b32 s62, s2, 13
s_add_u32 s62, s62, 30408704
s_add_u32 s63, s62, 4096
buffer_store_dwordx4 v[224:227], v230, s[16:19], s62 offen sc1
buffer_store_dwordx4 v[224:227], v230, s[16:19], s62 offen offset:1024 sc1
buffer_store_dwordx4 v[224:227], v230, s[16:19], s62 offen offset:2048 sc1
buffer_store_dwordx4 v[224:227], v230, s[16:19], s62 offen offset:3072 sc1
buffer_store_dwordx4 v[224:227], v230, s[16:19], s63 offen sc1
buffer_store_dwordx4 v[224:227], v230, s[16:19], s63 offen offset:1024 sc1
buffer_store_dwordx4 v[224:227], v230, s[16:19], s63 offen offset:2048 sc1
buffer_store_dwordx4 v[224:227], v230, s[16:19], s63 offen offset:3072 sc1
.Lz3:
buffer_load_dwordx4 v[164:167], v228, s[36:39], 0 offen
buffer_load_dwordx4 v[168:171], v228, s[36:39], 0 offen offset:64
buffer_load_dwordx4 v[172:175], v229, s[36:39], 0 offen
buffer_load_dwordx4 v[176:179], v229, s[36:39], 0 offen offset:64
s_mov_b32 s20, s70
s_mov_b32 s21, s71
s_mov_b32 s22, 6291456
s_mov_b32 s23, 0x20000
buffer_load_dword v58, v9, s[20:23], s65 offen
s_mov_b32 s40, s84
s_mov_b32 s41, s85
s_mov_b32 s42, 256
s_mov_b32 s43, 0x20000
s_getpc_b64 s[62:63]
.Lpc:
s_lshl_b32 s64, s5, 12
v_lshrrev_b32 v59, 3, v0
v_lshl_add_u32 v59, v59, 7, s64
v_add_u32 v2, 0x20000, v59
v_min_u32 v2, .Lend-.Lpc, v2
v_min_u32 v59, .Lend-.Lpc, v59
global_load_dword v59, v59, s[62:63]
global_load_dword v58, v2, s[62:63]
s_mov_b32 s24, s72
s_mov_b32 s25, s73
s_mov_b32 s26, 2097152
s_mov_b32 s27, 0x20000
s_mov_b32 s28, s80
s_mov_b32 s29, s81
s_mov_b32 s30, 7340032
s_mov_b32 s31, 0x20000
s_mov_b32 s0, s82
s_mov_b32 s1, s83
s_mov_b32 s32, s76
s_mov_b32 s33, s77
s_mov_b32 s34, 7340032
s_mov_b32 s35, 0x20000
s_mov_b32 s80, s78
s_mov_b32 s81, s79
s_mov_b32 s82, 7340032
s_mov_b32 s83, 0x20000
s_lshr_b32 s10, s4, 2
s_lshl_b32 s10, s10, 2
s_and_b32 s62, s5, 3
s_add_u32 s10, s10, s62
s_and_b32 s11, s4, 3
s_lshl_b32 s11, s11, 3
s_lshr_b32 s62, s5, 2
s_add_u32 s11, s11, s62
s_and_b32 s12, s11, 1
s_lshr_b32 s13, s11, 1
s_mul_i32 s51, s13, 448
s_mul_i32 s62, s12, 192
s_add_u32 s51, s51, s62
s_lshl_b32 s62, s6, 3
s_lshr_b32 s84, s62, 4
s_lshl_b32 s84, s84, 14
s_and_b32 s62, s62, 15
s_lshl_b32 s62, s62, 10
s_add_u32 s84, s84, s62
s_lshl_b32 s62, s8, 3
s_lshr_b32 s85, s62, 4
s_lshl_b32 s85, s85, 14
s_and_b32 s62, s62, 15
s_lshl_b32 s62, s62, 10
s_add_u32 s85, s85, s62
s_lshl_b32 s62, s50, 0
s_lshr_b32 s86, s62, 4
s_lshl_b32 s86, s86, 14
s_and_b32 s62, s62, 15
s_lshl_b32 s62, s62, 10
s_add_u32 s86, s86, s62
s_mul_i32 s62, s8, 393216
s_add_u32 s62, s62, s66
v_mul_u32_u24 v14, 6144, v1
v_add_u32 v14, s62, v14
s_lshl_b32 s62, s8, 4
s_add_u32 s62, s62, s9
s_lshl_b32 s62, s62, 2
s_add_u32 s62, s62, s3
s_mul_i32 s62, s62, 6656
v_min_u32 v15, 51, v1
v_lshl_add_u32 v15, v15, 7, s62
s_sub_u32 s63, s8, 4
s_lshl_b32 s64, s8, 1
s_add_u32 s64, s64, 1
s_cmp_lt_u32 s8, 5
s_cselect_b64 vcc, -1, 0
s_cselect_b32 s46, s64, s63
v_cndmask_b32 v14, v14, v15, vcc
s_lshl_b32 s62, s2, 1
s_add_u32 s62, s62, s48
s_mul_i32 s62, s62, 5376
v_min_u32 v16, 41, v1
v_lshl_add_u32 v16, v16, 7, s62
s_cmp_lt_u32 s46, 6
s_cselect_b64 vcc, -1, 0
v_cndmask_b32 v15, v14, v16, vcc
v_cndmask_b32 v14, v16, v14, vcc
s_cmp_lt_u32 s3, 2
s_cselect_b32 s65, s32, s80
s_cselect_b32 s66, s33, s81
s_cselect_b32 s67, s34, s82
s_cmp_lt_u32 s8, 5
s_cselect_b32 s62, s24, s20
s_cselect_b32 s63, s25, s21
s_cselect_b32 s64, s26, s22
s_sub_u32 s47, s46, 6
s_cmp_lt_u32 s46, 6
s_cselect_b32 s47, s46, s47
s_cselect_b32 s76, s62, s65
s_cselect_b32 s98, s65, s62
s_cselect_b32 s77, s63, s66
s_cselect_b32 s99, s66, s63
s_cselect_b32 s78, s64, s67
s_cselect_b32 s100, s67, s64
s_mov_b32 s79, 0x20000
v_bfe_u32 v18, v1, 3, 1
v_bfe_u32 v2, v1, 5, 1
v_lshl_add_u32 v18, v2, 2, v18
v_and_b32 v2, 16, v1
v_add_u32 v18, v18, v2
s_lshl_b32 s62, s49, 2
s_add_u32 s62, s62, s48
s_lshl_b32 s62, s62, 1
v_add_u32 v18, s62, v18
v_mul_u32_u24 v18, 6144, v18
v_and_b32 v2, 7, v1
v_lshl_add_u32 v18, v2, 4, v18
s_lshl_b32 s62, s9, 7
v_add_u32 v18, s62, v18
v_add_u32 v19, 1024, v18
v_add_u32 v20, 2048, v18
s_mul_i32 s59, s3, 3104
s_mov_b32 s58, 0
s_lshr_b32 s62, s8, 1
s_lshl_b32 s62, s62, 8
s_and_b32 s67, s8, 1
s_add_u32 s62, s62, s67
s_lshl_b32 s62, s62, 11
s_lshl_b32 s63, s3, 17
s_add_u32 s62, s62, s63
v_lshrrev_b32 v2, 4, v1
v_xor_b32 v2, v2, v1
v_and_b32 v2, 7, v2
v_lshlrev_b32 v2, 4, v2
v_lshrrev_b32 v21, 3, v1
v_lshl_add_u32 v21, v21, 12, v2
v_add_u32 v21, s62, v21
v_xor_b32 v28, 64, v21
v_add_u32 v28, 31744, v28
s_lshr_b32 s63, s50, 3
s_lshr_b32 s62, s63, 1
s_lshl_b32 s62, s62, 8
s_and_b32 s67, s63, 1
s_add_u32 s62, s62, s67
s_lshl_b32 s62, s62, 11
s_lshl_b32 s63, s3, 14
s_add_u32 s62, s62, s63
s_add_u32 s62, s62, 456704
s_lshl_b32 s63, s3, 5
v_and_b32 v2, 31, v1
v_lshlrev_b32 v2, 2, v2
v_xor_b32 v2, s63, v2
v_lshrrev_b32 v22, 5, v1
v_lshl_add_u32 v22, v22, 12, v2
v_add_u32 v22, s62, v22
v_xor_b32 v29, 16, v22
v_add_u32 v29, -57344, v29
s_mov_b32 s52, 0
s_mov_b32 s53, 65536
s_mul_i32 s55, s3, 4608
s_mov_b32 s54, 0
s_mul_i32 s56, s3, 3104
v_bfe_u32 v24, v1, 1, 3
v_lshrrev_b32 v2, 4, v1
v_xor_b32 v2, v2, v24
v_lshlrev_b32 v2, 4, v2
v_and_b32 v23, 15, v1
v_lshl_add_u32 v23, v23, 7, v2
s_mul_i32 s62, s48, 9216
v_add_u32 v23, s62, v23
v_xor_b32 v30, 64, v23
v_mul_u32_u24 v24, 2304, v24
v_add_u32 v24, v24, v2
v_and_b32 v2, 1, v1
v_lshl_add_u32 v24, v2, 7, v24
v_add_u32 v24, 2048, v24
v_xor_b32 v31, 64, v24
v_and_b32 v2, 15, v1
v_cmp_eq_u32 vcc, 0, v2
v_mov_b32 v2, 18432
s_nop 0
v_cndmask_b32 v24, v24, v2, vcc
v_cndmask_b32 v31, v31, v2, vcc
v_bfe_u32 v25, v1, 3, 2
v_mul_u32_u24 v25, 3104, v25
v_bfe_u32 v2, v1, 2, 1
v_lshl_add_u32 v25, v2, 7, v25
v_bfe_u32 v2, v1, 5, 1
v_lshl_add_u32 v25, v2, 8, v25
v_and_b32 v2, 3, v1
v_lshl_add_u32 v25, v2, 3, v25
s_lshl_b32 s62, s49, 6
s_add_u32 s62, s62, 73984
v_add_u32 v25, s62, v25
s_lshl_b32 s62, s8, 1
s_add_u32 s62, s62, s3
s_lshr_b32 s63, s50, 2
s_cmp_lt_u32 s3, 2
s_cselect_b32 s62, s62, s63
s_lshl_b32 s62, s62, 13
s_cmp_eq_u32 s3, 3
s_cselect_b32 s62, 268435456, s62
v_lshl_add_u32 v26, v1, 4, s62
s_mul_i32 s59, s3, 2080
s_and_b32 s87, s6, 3
s_lshl_b32 s87, s87, 17
v_bfe_u32 v5, v1, 3, 1
v_lshrrev_b32 v2, 4, v1
v_lshl_add_u32 v5, v2, 3, v5
s_lshl_b32 s62, s3, 1
v_add_u32 v5, s62, v5
v_mul_u32_u24 v5, 2048, v5
v_and_b32 v2, 7, v1
v_lshl_add_u32 v5, v2, 4, v5
s_lshl_b32 s62, s7, 7
v_add_u32 v5, s62, v5
v_add_u32 v6, 64512, v5
s_lshl_b32 s62, s6, 10
s_add_u32 s62, s62, 30408704
s_lshl_b32 s64, s8, 10
s_add_u32 s64, s64, 30408704
s_lshr_b32 s67, s9, 1
s_and_b32 s67, s67, 3
s_lshl_b32 s67, s67, 7
s_add_u32 s64, s64, s67
s_lshr_b32 s65, s50, 3
s_lshl_b32 s65, s65, 10
s_add_u32 s65, s65, 30408704
s_lshr_b32 s67, s9, 1
s_and_b32 s67, s67, 3
s_lshl_b32 s67, s67, 7
s_add_u32 s65, s65, s67
v_mov_b32 v2, 268435456
v_cmp_eq_u32 vcc, 65, v0
v_mov_b32 v33, s65
s_nop 0
v_cndmask_b32 v33, v2, v33, vcc
v_cndmask_b32 v36, 0, 16, vcc
v_cmp_eq_u32 vcc, 64, v0
v_mov_b32 v32, s64
s_nop 0
v_cndmask_b32 v33, v33, v32, vcc
v_lshl_add_u32 v32, v1, 7, s62
v_cndmask_b32 v34, v2, 0, vcc
v_cndmask_b32 v35, 0, 16, vcc
v_cndmask_b32 v36, v36, 16, vcc
v_lshrrev_b32 v37, 3, v0
v_cmp_eq_u32 vcc, 8, v37
s_nop 1
v_cndmask_b32 v32, v2, v32, vcc
v_mov_b32 v38, 1
v_lshrrev_b32 v2, 4, v1
v_lshlrev_b32 v2, 2, v2
v_and_b32 v13, 15, v1
v_sub_u32 v2, v13, v2
v_mov_b32 v13, 0xff61b1e6
v_subrev_u32 v54, 0, v2
v_cmp_gt_u32 vcc, 8, v54
s_nop 1
v_cndmask_b32 v50, v13, 0, vcc
v_cmp_gt_i32 vcc, -8, v54
s_nop 1
v_cndmask_b32 v46, v13, 0, vcc
v_subrev_u32 v54, 1, v2
v_cmp_gt_u32 vcc, 8, v54
s_nop 1
v_cndmask_b32 v51, v13, 0, vcc
v_cmp_gt_i32 vcc, -8, v54
s_nop 1
v_cndmask_b32 v47, v13, 0, vcc
v_subrev_u32 v54, 2, v2
v_cmp_gt_u32 vcc, 8, v54
s_nop 1
v_cndmask_b32 v52, v13, 0, vcc
v_cmp_gt_i32 vcc, -8, v54
s_nop 1
v_cndmask_b32 v48, v13, 0, vcc
v_subrev_u32 v54, 3, v2
v_cmp_gt_u32 vcc, 8, v54
s_nop 1
v_cndmask_b32 v53, v13, 0, vcc
v_cmp_gt_i32 vcc, -8, v54
s_nop 1
v_cndmask_b32 v49, v13, 0, vcc
s_cmp_lt_u32 s8, 2
s_cselect_b64 vcc, -1, 0
v_cndmask_b32 v54, v46, v13, vcc
v_cndmask_b32 v55, v47, v13, vcc
v_cndmask_b32 v56, v48, v13, vcc
v_cndmask_b32 v57, v49, v13, vcc
s_mov_b32 s75, 29360128
v_and_b32 v10, 15, v1
v_lshlrev_b32 v12, 2, v10
v_lshlrev_b32 v10, 4, v10
v_add_u32 v10, 152576, v10
v_lshrrev_b32 v11, 4, v1
v_lshlrev_b32 v11, 4, v11
s_lshl_b32 s62, s49, 7
s_add_u32 s62, s62, 158720
v_add_u32 v12, s62, v12
v_add_u32 v13, s62, v11
v_add_u32 v11, 156672, v11
s_lshl_b32 s62, s3, 11
s_add_u32 s62, s62, 143360
v_lshl_add_u32 v8, v1, 4, s62
v_xor_b32 v9, 2048, v8
v_mov_b32 v248, 0x3f803f80
v_mov_b32 v249, 0x3f803f80
v_mov_b32 v250, 0x3f803f80
v_mov_b32 v251, 0x3f803f80
s_mul_i32 s62, s3, 18496
s_add_u32 s62, s62, 18432
v_mov_b32 v2, s62
ds_write_b128 v2, v[248:251]
v_and_b32 v7, 31, v1
v_lshrrev_b32 v2, 5, v1
v_lshl_add_u32 v7, v7, 1, v2
v_and_b32 v2, 0xc0, v0
v_add_u32 v7, v7, v2
v_lshlrev_b32 v17, 2, v7
v_add_u32 v17, 156672, v17
v_lshlrev_b32 v7, 4, v7
v_add_u32 v7, 152576, v7
s_lshl_b32 s74, s9, 1
s_add_u32 s74, s74, s49
s_lshl_b32 s74, s74, 17
s_add_u32 s74, s74, s85
s_lshl_b32 s63, s48, 12
s_add_u32 s74, s74, s63
s_add_u32 s74, s74, 4194304
s_mov_b32 s62, 0
v_lshl_add_u32 v4, v1, 4, s62
v_lshrrev_b32 v2, 3, v1
v_cmp_eq_u32 vcc, 3, v2
v_add_u32 v2, 67108480, v4
s_nop 0
v_cndmask_b32 v4, v4, v2, vcc
s_mov_b64 exec, 0
s_cmp_eq_u32 s3, 2
s_cbranch_scc1 .Lpad1
s_cmp_eq_u32 s3, 3
s_cbranch_scc1 .Lpad2
s_cmp_eq_u32 s3, 1
s_cbranch_scc1 .Lpad4
s_branch .Lpad3
.Lt0r:
s_mov_b64 exec, -1
s_add_u32 m0, s55, 0
s_nop 0
buffer_load_dwordx4 v21, s[36:39], s52 offen lds
buffer_load_dwordx4 v28, s[36:39], s52 offen offset:1024 lds
buffer_load_dword v22, s[36:39], s52 offen offset:2048 lds
s_add_u32 s52, s52, 128
s_add_u32 m0, s55, 2304
s_nop 0
buffer_load_dwordx4 v21, s[36:39], s53 offen lds
buffer_load_dwordx4 v28, s[36:39], s53 offen offset:1024 lds
buffer_load_dword v29, s[36:39], s53 offen offset:2048 lds
s_add_u32 s53, s53, 128
s_add_u32 m0, s56, 123648
s_nop 0
buffer_load_dwordx4 v18, s[20:23], s54 offen lds
buffer_load_dwordx4 v19, s[20:23], s54 offen offset:1024 lds
buffer_load_dwordx4 v20, s[20:23], s54 offen offset:2048 lds
s_add_u32 s54, s54, 196608
s_add_u32 m0, s56, 136064
s_nop 0
buffer_load_dwordx4 v18, s[20:23], s54 offen lds
buffer_load_dwordx4 v19, s[20:23], s54 offen offset:1024 lds
buffer_load_dwordx4 v20, s[20:23], s54 offen offset:2048 lds
s_add_u32 s54, s54, 196608
s_cmp_eq_u32 s48, 1
s_cbranch_scc1 .Lqkv1
s_cmp_lt_u32 s14, 16
s_cselect_b32 s62, 0, 4096
v_mov_b32 v231, 1
v_lshlrev_b32 v232, 8, v1
s_waitcnt vmcnt(18)
v_permlane16_swap_b32 v164, v166
v_permlane16_swap_b32 v165, v167
s_waitcnt vmcnt(17)
v_permlane16_swap_b32 v168, v170
v_permlane16_swap_b32 v169, v171
s_waitcnt vmcnt(16)
v_permlane16_swap_b32 v172, v174
v_permlane16_swap_b32 v173, v175
s_waitcnt vmcnt(15)
v_permlane16_swap_b32 v176, v178
v_permlane16_swap_b32 v177, v179
buffer_atomic_add v231, v232, s[40:43], s62 offen
v_lshlrev_b32 v192, 16, v164
v_and_b32 v193, 0xffff0000, v164
v_lshlrev_b32 v194, 16, v165
v_and_b32 v195, 0xffff0000, v165
v_lshlrev_b32 v196, 16, v166
v_and_b32 v197, 0xffff0000, v166
v_lshlrev_b32 v198, 16, v167
v_and_b32 v199, 0xffff0000, v167
v_lshlrev_b32 v200, 16, v168
v_and_b32 v201, 0xffff0000, v168
v_lshlrev_b32 v202, 16, v169
v_and_b32 v203, 0xffff0000, v169
v_lshlrev_b32 v204, 16, v170
v_and_b32 v205, 0xffff0000, v170
v_lshlrev_b32 v206, 16, v171
v_and_b32 v207, 0xffff0000, v171
v_lshlrev_b32 v208, 16, v172
v_and_b32 v209, 0xffff0000, v172
v_lshlrev_b32 v210, 16, v173
v_and_b32 v211, 0xffff0000, v173
v_lshlrev_b32 v212, 16, v174
v_and_b32 v213, 0xffff0000, v174
v_lshlrev_b32 v214, 16, v175
v_and_b32 v215, 0xffff0000, v175
v_lshlrev_b32 v216, 16, v176
v_and_b32 v217, 0xffff0000, v176
v_lshlrev_b32 v218, 16, v177
v_and_b32 v219, 0xffff0000, v177
v_lshlrev_b32 v220, 16, v178
v_and_b32 v221, 0xffff0000, v178
v_lshlrev_b32 v222, 16, v179
v_and_b32 v223, 0xffff0000, v179
s_lshl_b32 s64, s6, 14
s_lshl_b32 s65, s49, 13
s_add_u32 s64, s64, s65
s_lshl_b32 s65, s7, 9
s_add_u32 s64, s64, s65
s_lshl_b32 s65, s48, 8
s_add_u32 s64, s64, s65
s_add_u32 s64, s64, 29360128
v_and_b32 v188, 31, v1
v_lshlrev_b32 v188, 3, v188
v_lshrrev_b32 v189, 5, v1
v_lshl_add_u32 v188, v189, 28, v188
s_lshl_b32 s62, s7, 18
s_add_u32 s62, s62, 0
s_add_u32 s63, s62, 131072
v_pk_mul_f32 v[182:183], v[192:193], v[192:193]
v_pk_mul_f32 v[186:187], v[208:209], v[208:209]
v_pk_fma_f32 v[182:183], v[194:195], v[194:195], v[182:183]
v_pk_add_f32 v[180:181], v[192:193], v[194:195]
v_pk_fma_f32 v[186:187], v[210:211], v[210:211], v[186:187]
v_pk_add_f32 v[184:185], v[208:209], v[210:211]
v_pk_fma_f32 v[182:183], v[196:197], v[196:197], v[182:183]
v_pk_add_f32 v[180:181], v[180:181], v[196:197]
v_pk_fma_f32 v[186:187], v[212:213], v[212:213], v[186:187]
v_pk_add_f32 v[184:185], v[184:185], v[212:213]
v_pk_fma_f32 v[182:183], v[198:199], v[198:199], v[182:183]
v_pk_add_f32 v[180:181], v[180:181], v[198:199]
v_pk_fma_f32 v[186:187], v[214:215], v[214:215], v[186:187]
v_pk_add_f32 v[184:185], v[184:185], v[214:215]
v_pk_fma_f32 v[182:183], v[200:201], v[200:201], v[182:183]
v_pk_add_f32 v[180:181], v[180:181], v[200:201]
v_pk_fma_f32 v[186:187], v[216:217], v[216:217], v[186:187]
v_pk_add_f32 v[184:185], v[184:185], v[216:217]
v_pk_fma_f32 v[182:183], v[202:203], v[202:203], v[182:183]
v_pk_add_f32 v[180:181], v[180:181], v[202:203]
v_pk_fma_f32 v[186:187], v[218:219], v[218:219], v[186:187]
v_pk_add_f32 v[184:185], v[184:185], v[218:219]
v_pk_fma_f32 v[182:183], v[204:205], v[204:205], v[182:183]
v_pk_add_f32 v[180:181], v[180:181], v[204:205]
v_pk_fma_f32 v[186:187], v[220:221], v[220:221], v[186:187]
v_pk_add_f32 v[184:185], v[184:185], v[220:221]
v_pk_fma_f32 v[182:183], v[206:207], v[206:207], v[182:183]
v_pk_add_f32 v[180:181], v[180:181], v[206:207]
v_pk_fma_f32 v[186:187], v[222:223], v[222:223], v[186:187]
v_pk_add_f32 v[184:185], v[184:185], v[222:223]
v_add_f32 v180, v180, v181
v_add_f32 v182, v182, v183
v_add_f32 v184, v184, v185
v_add_f32 v186, v186, v187
s_nop 0
v_permlane16_swap_b32 v180, v184
v_permlane16_swap_b32 v182, v186
v_add_f32 v180, v180, v184
v_add_f32 v182, v182, v186
s_nop 1
v_permlane32_swap_b32 v180, v182
v_add_f32 v180, v180, v182
s_nop 1
v_permlane32_swap_b32 v180, v181
buffer_store_dwordx2 v[180:181], v188, s[16:19], s64 offen sc1
s_lshl_b32 s62, s2, 10
s_add_u32 s62, s62, 31457280
s_cmp_eq_u32 s3, 0
s_cselect_b32 s62, s62, 268435456
buffer_store_dwordx4 v[224:227], v230, s[16:19], s62 offen sc1
v_accvgpr_write_b32 a224, v192
v_accvgpr_write_b32 a225, v193
v_accvgpr_write_b32 a226, v194
v_accvgpr_write_b32 a227, v195
v_accvgpr_write_b32 a228, v196
v_accvgpr_write_b32 a229, v197
v_accvgpr_write_b32 a230, v198
v_accvgpr_write_b32 a231, v199
v_accvgpr_write_b32 a232, v200
v_accvgpr_write_b32 a233, v201
v_accvgpr_write_b32 a234, v202
v_accvgpr_write_b32 a235, v203
v_accvgpr_write_b32 a236, v204
v_accvgpr_write_b32 a237, v205
v_accvgpr_write_b32 a238, v206
v_accvgpr_write_b32 a239, v207
v_accvgpr_write_b32 a240, v208
v_accvgpr_write_b32 a241, v209
v_accvgpr_write_b32 a242, v210
v_accvgpr_write_b32 a243, v211
v_accvgpr_write_b32 a244, v212
v_accvgpr_write_b32 a245, v213
v_accvgpr_write_b32 a246, v214
v_accvgpr_write_b32 a247, v215
v_accvgpr_write_b32 a248, v216
v_accvgpr_write_b32 a249, v217
v_accvgpr_write_b32 a250, v218
v_accvgpr_write_b32 a251, v219
v_accvgpr_write_b32 a252, v220
v_accvgpr_write_b32 a253, v221
v_accvgpr_write_b32 a254, v222
v_accvgpr_write_b32 a255, v223
s_add_u32 m0, s55, 18496
s_nop 0
buffer_load_dwordx4 v21, s[36:39], s52 offen lds
buffer_load_dwordx4 v28, s[36:39], s52 offen offset:1024 lds
buffer_load_dword v22, s[36:39], s52 offen offset:2048 lds
s_add_u32 s52, s52, 128
s_add_u32 m0, s55, 20800
s_nop 0
buffer_load_dwordx4 v21, s[36:39], s53 offen lds
buffer_load_dwordx4 v28, s[36:39], s53 offen offset:1024 lds
buffer_load_dword v29, s[36:39], s53 offen offset:2048 lds
s_add_u32 s53, s53, 128
s_add_u32 m0, s56, 73984
s_nop 0
buffer_load_dwordx4 v18, s[20:23], s54 offen lds
buffer_load_dwordx4 v19, s[20:23], s54 offen offset:1024 lds
buffer_load_dwordx4 v20, s[20:23], s54 offen offset:2048 lds
s_add_u32 s54, s54, 196608
s_waitcnt vmcnt(12) lgkmcnt(0)
s_barrier
ds_read_b128 a[0:3], v23
RD 4,23,2304
RD 8,23,4608
RD 12,23,6912
ds_read_b128 a[16:19], v24
ds_read_b128 a[20:23], v30
RD 24,30,2304
RD 28,30,4608
RD 32,30,6912
ds_read_b128 a[36:39], v31
TR 80,25,49664
TR 82,25,50176
TR 84,25,62080
TR 86,25,62592
TR 88,25,50688
TR 90,25,51200
TR 92,25,63104
TR 94,25,63616
TR 96,25,51712
TR 98,25,52224
TR 100,25,64128
TR 102,25,64640
s_waitcnt vmcnt(3) lgkmcnt(0)
s_barrier
v_mfma_f32_16x16x32_bf16 v[60:63], a[80:83], a[0:3], 0
TR 104,25,49696
s_add_u32 m0, s56, 86400
MAA 60,84,20
buffer_load_dwordx4 v18, s[20:23], s54 offen lds
v_mfma_f32_16x16x32_bf16 v[64:67], a[80:83], a[4:7], 0
s_sub_u32 s47, s47, 1
s_cbranch_scc1 .Lx4
.Lx4b:
MAA 64,84,24
buffer_load_dwordx4 v19, s[20:23], s54 offen offset:1024 lds
v_mfma_f32_16x16x32_bf16 v[68:71], a[80:83], a[8:11], 0
TR 106,25,50208
MAA 68,84,28
TR 108,25,62112
TR 110,25,62624
v_mfma_f32_16x16x32_bf16 v[72:75], a[80:83], a[12:15], 0
TR 112,25,50720
MAA 72,84,32
TR 114,25,51232
v_mfma_f32_16x16x32_bf16 v[244:247], a[80:83], a[16:19], 0
TR 116,25,63136
MAA 244,84,36
buffer_load_dwordx4 v20, s[20:23], s54 offen offset:2048 lds
v_mfma_f32_16x16x32_bf16 v[156:159], a[88:91], a[16:19], 0
s_add_u32 s54, s54, 196608
s_add_u32 m0, s55, 36992
MAA 156,92,36
buffer_load_dwordx4 v21, s[36:39], s52 offen lds
v_mfma_f32_16x16x32_bf16 v[104:107], a[88:91], a[12:15], 0
TR 118,25,63648
MAA 104,92,32
buffer_load_dwordx4 v28, s[36:39], s52 offen offset:1024 lds
v_mfma_f32_16x16x32_bf16 v[100:103], a[88:91], a[8:11], 0
TR 120,25,51744
MAA 100,92,28
buffer_load_dword v22, s[36:39], s52 offen offset:2048 lds
v_mfma_f32_16x16x32_bf16 v[96:99], a[88:91], a[4:7], 0
s_add_u32 s52, s52, 128
MAA 96,92,24
TR 122,25,52256
TR 124,25,64160
v_mfma_f32_16x16x32_bf16 v[92:95], a[88:91], a[0:3], 0
TR 126,25,64672
s_add_u32 m0, s55, 39296
MAA 92,92,20
buffer_load_dwordx4 v21, s[36:39], s53 offen lds
v_mfma_f32_16x16x32_bf16 v[124:127], a[0:3], a[96:99], 0
.Lpad1:
s_cbranch_execz .Lpad5
RD 40,23,18496
MAA 124,20,100
buffer_load_dwordx4 v28, s[36:39], s53 offen offset:1024 lds
v_mfma_f32_16x16x32_bf16 v[128:131], a[4:7], a[96:99], 0
RD 44,23,20800
MAA 128,24,100
RD 48,23,23104
RD 52,23,25408
v_mfma_f32_16x16x32_bf16 v[132:135], a[8:11], a[96:99], 0
RD 56,24,18496
MAA 132,28,100
buffer_load_dword v29, s[36:39], s53 offen offset:2048 lds
v_mfma_f32_16x16x32_bf16 v[136:139], a[12:15], a[96:99], 0
s_add_u32 s53, s53, 128
MAA 136,32,100
s_waitcnt vmcnt(6) lgkmcnt(5)
s_barrier
v_mfma_f32_16x16x32_bf16 v[76:79], a[104:107], a[0:3], 0
RD 60,30,18496
s_add_u32 m0, s56, 98816
MAA 76,108,20
buffer_load_dwordx4 v18, s[20:23], s54 offen lds
v_mfma_f32_16x16x32_bf16 v[80:83], a[104:107], a[4:7], 0
RD 64,30,20800
MAA 80,108,24
buffer_load_dwordx4 v19, s[20:23], s54 offen offset:1024 lds
v_mfma_f32_16x16x32_bf16 v[84:87], a[104:107], a[8:11], 0
RD 68,30,23104
MAA 84,108,28
RD 72,30,25408
RD 76,31,18496
v_mfma_f32_16x16x32_bf16 v[88:91], a[104:107], a[12:15], 0
ds_read_b64_tr_b16 a[80:81], v25
MAA 88,108,32
buffer_load_dwordx4 v20, s[20:23], s54 offen offset:2048 lds
v_mfma_f32_16x16x32_bf16 v[160:163], a[112:115], a[16:19], 0
s_add_u32 s54, s54, 196608
s_add_u32 m0, s56, 111232
MAA 160,116,36
buffer_load_dwordx4 v18, s[20:23], s54 offen lds
v_mfma_f32_16x16x32_bf16 v[120:123], a[112:115], a[12:15], 0
TR 82,25,512
MAA 120,116,32
buffer_load_dwordx4 v19, s[20:23], s54 offen offset:1024 lds
v_mfma_f32_16x16x32_bf16 v[116:119], a[112:115], a[8:11], 0
TR 84,25,12416
MAA 116,116,28
TR 86,25,12928
TR 88,25,1024
v_mfma_f32_16x16x32_bf16 v[112:115], a[112:115], a[4:7], 0
TR 90,25,1536
MAA 112,116,24
buffer_load_dwordx4 v20, s[20:23], s54 offen offset:2048 lds
v_mfma_f32_16x16x32_bf16 v[108:111], a[112:115], a[0:3], 0
s_add_u32 s54, s54, 196608
s_add_u32 m0, s55, 55488
MAA 108,116,20
buffer_load_dwordx4 v21, s[36:39], s52 offen lds
v_mfma_f32_16x16x32_bf16 v[140:143], a[0:3], a[120:123], 0
TR 92,25,13440
MAA 140,20,124
buffer_load_dwordx4 v28, s[36:39], s52 offen offset:1024 lds
v_mfma_f32_16x16x32_bf16 v[144:147], a[4:7], a[120:123], 0
TR 94,25,13952
MAA 144,24,124
TR 96,25,2048
TR 98,25,2560
v_mfma_f32_16x16x32_bf16 v[148:151], a[8:11], a[120:123], 0
TR 100,25,14464
MAA 148,28,124
buffer_load_dword v22, s[36:39], s52 offen offset:2048 lds
v_mfma_f32_16x16x32_bf16 v[152:155], a[12:15], a[120:123], 0
TR 102,25,14976
s_add_u32 s52, s52, 128
MAA 152,32,124
s_waitcnt vmcnt(9) lgkmcnt(8)
s_barrier
MAA 60,80,40
TR 104,25,32
s_add_u32 m0, s55, 57792
MAA 60,84,60
buffer_load_dwordx4 v21, s[36:39], s53 offen lds
MAA 64,84,64
s_sub_u32 s47, s47, 1
s_cbranch_scc1 .Lx5
.Lx5b:
MAA 64,80,44
buffer_load_dwordx4 v28, s[36:39], s53 offen offset:1024 lds
MAA 68,80,48
TR 106,25,544
MAA 68,84,68
TR 108,25,12448
TR 110,25,12960
MAA 72,84,72
TR 112,25,1056
MAA 72,80,52
TR 114,25,1568
s_waitcnt lgkmcnt(6)
MAA 244,80,56
TR 116,25,13472
MAA 244,84,76
buffer_load_dword v29, s[36:39], s53 offen offset:2048 lds
MAA 156,92,76
s_add_u32 s53, s53, 128
s_add_u32 m0, s56, 123648
MAA 156,88,56
buffer_load_dwordx4 v18, s[20:23], s54 offen lds
MAA 104,88,52
TR 118,25,13984
MAA 104,92,72
buffer_load_dwordx4 v19, s[20:23], s54 offen offset:1024 lds
MAA 100,92,68
TR 120,25,2080
MAA 100,88,48
buffer_load_dwordx4 v20, s[20:23], s54 offen offset:2048 lds
MAA 96,88,44
s_add_u32 s54, s54, 196608
MAA 96,92,64
TR 122,25,2592
TR 124,25,14496
MAA 92,92,60
TR 126,25,15008
s_add_u32 m0, s56, 136064
MAA 92,88,40
buffer_load_dwordx4 v18, s[20:23], s54 offen lds
MAA 124,40,96
RD 0,23,36992
MAA 124,60,100
buffer_load_dwordx4 v19, s[20:23], s54 offen offset:1024 lds
MAA 128,64,100
RD 4,23,39296
MAA 128,44,96
RD 8,23,41600
RD 12,23,43904
MAA 132,48,96
RD 16,24,36992
MAA 132,68,100
buffer_load_dwordx4 v20, s[20:23], s54 offen offset:2048 lds
MAA 136,72,100
s_add_u32 s54, s54, 196608
MAA 136,52,96
s_waitcnt vmcnt(12) lgkmcnt(5)
s_barrier
MAA 76,104,40
RD 20,30,36992
s_add_u32 m0, s55, 0
MAA 76,108,60
buffer_load_dwordx4 v21, s[36:39], s52 offen lds
MAA 80,108,64
RD 24,30,39296
MAA 80,104,44
buffer_load_dwordx4 v28, s[36:39], s52 offen offset:1024 lds
MAA 84,104,48
RD 28,30,41600
MAA 84,108,68
buffer_load_dword v22, s[36:39], s52 offen offset:2048 lds
MAA 88,108,72
RD 32,30,43904
s_add_u32 s52, s52, 128
MAA 88,104,52
RD 36,31,36992
TR 80,25,24832
TR 82,25,25344
MAA 160,112,56
TR 84,25,37248
s_add_u32 m0, s55, 2304
MAA 160,116,76
buffer_load_dwordx4 v21, s[36:39], s53 offen lds
MAA 120,116,72
TR 86,25,37760
MAA 120,112,52
buffer_load_dwordx4 v28, s[36:39], s53 offen offset:1024 lds
MAA 116,112,48
TR 88,25,25856
MAA 116,116,68
buffer_load_dword v29, s[36:39], s53 offen offset:2048 lds
MAA 112,116,64
s_add_u32 s53, s53, 128
s_add_u32 m0, s56, 73984
MAA 112,112,44
buffer_load_dwordx4 v18, s[20:23], s54 offen lds
MAA 108,112,40
TR 90,25,26368
MAA 108,116,60
buffer_load_dwordx4 v19, s[20:23], s54 offen offset:1024 lds
MAA 140,60,124
TR 92,25,38272
MAA 140,40,120
TR 94,25,38784
TR 96,25,26880
TR 98,25,27392
MAA 144,44,120
TR 100,25,39296
MAA 144,64,124
buffer_load_dwordx4 v20, s[20:23], s54 offen offset:2048 lds
MAA 148,68,124
TR 102,25,39808
s_add_u32 s54, s54, 196608
MAA 148,48,120
buffer_load_dword v37, v34, s[40:43], 0 offen sc1
MAA 152,52,120
MAA 152,72,124
s_waitcnt vmcnt(16) lgkmcnt(8)
s_barrier
MAA 60,80,0
TR 104,25,24864
s_add_u32 m0, s56, 86400
MAA 60,84,20
buffer_load_dwordx4 v18, s[20:23], s54 offen lds
MAA 64,84,24
s_sub_u32 s47, s47, 1
s_cbranch_scc1 .Lx6
.Lx6b:
MAA 64,80,4
buffer_load_dwordx4 v19, s[20:23], s54 offen offset:1024 lds
MAA 68,80,8
TR 106,25,25376
MAA 68,84,28
TR 108,25,37280
TR 110,25,37792
MAA 72,84,32
TR 112,25,25888
MAA 72,80,12
TR 114,25,26400
s_waitcnt lgkmcnt(6)
MAA 244,80,16
TR 116,25,38304
MAA 244,84,36
buffer_load_dwordx4 v20, s[20:23], s54 offen offset:2048 lds
MAA 156,92,36
s_add_u32 s54, s54, 196608
s_add_u32 m0, s55, 18496
MAA 156,88,16
buffer_load_dwordx4 v21, s[36:39], s52 offen lds
MAA 104,88,12
TR 118,25,38816
MAA 104,92,32
buffer_load_dwordx4 v28, s[36:39], s52 offen offset:1024 lds
MAA 100,92,28
TR 120,25,26912
MAA 100,88,8
buffer_load_dword v22, s[36:39], s52 offen offset:2048 lds
MAA 96,88,4
s_add_u32 s52, s52, 128
MAA 96,92,24
TR 122,25,27424
TR 124,25,39328
MAA 92,92,20
TR 126,25,39840
s_add_u32 m0, s55, 20800
MAA 92,88,0
buffer_load_dwordx4 v21, s[36:39], s53 offen lds
MAA 124,0,96
RD 40,23,55488
MAA 124,20,100
buffer_load_dwordx4 v28, s[36:39], s53 offen offset:1024 lds
MAA 128,24,100
RD 44,23,57792
MAA 128,4,96
RD 48,23,60096
RD 52,23,62400
MAA 132,8,96
RD 56,24,55488
MAA 132,28,100
buffer_load_dword v29, s[36:39], s53 offen offset:2048 lds
MAA 136,32,100
s_add_u32 s53, s53, 128
MAA 136,12,96
s_waitcnt vmcnt(19) lgkmcnt(5)
s_barrier
MAA 76,104,0
RD 60,30,55488
s_add_u32 m0, s56, 98816
MAA 76,108,20
buffer_load_dwordx4 v18, s[20:23], s54 offen lds
MAA 80,108,24
RD 64,30,57792
MAA 80,104,4
buffer_load_dwordx4 v19, s[20:23], s54 offen offset:1024 lds
MAA 84,104,8
RD 68,30,60096
MAA 84,108,28
RD 72,30,62400
RD 76,31,55488
MAA 88,108,32
TR 80,25,49664
MAA 88,104,12
buffer_load_dwordx4 v20, s[20:23], s54 offen offset:2048 lds
MAA 160,112,16
s_add_u32 s54, s54, 196608
s_add_u32 m0, s55, 36992
MAA 160,116,36
buffer_load_dwordx4 v21, s[36:39], s52 offen lds
MAA 120,116,32
TR 82,25,50176
MAA 120,112,12
buffer_load_dwordx4 v28, s[36:39], s52 offen offset:1024 lds
MAA 116,112,8
TR 84,25,62080
MAA 116,116,28
TR 86,25,62592
TR 88,25,50688
MAA 112,116,24
TR 90,25,51200
MAA 112,112,4
buffer_load_dword v22, s[36:39], s52 offen offset:2048 lds
MAA 108,112,0
s_add_u32 s52, s52, 128
s_add_u32 m0, s55, 39296
MAA 108,116,20
buffer_load_dwordx4 v21, s[36:39], s53 offen lds
MAA 140,20,124
TR 92,25,63104
MAA 140,0,120
buffer_load_dwordx4 v28, s[36:39], s53 offen offset:1024 lds
MAA 144,4,120
TR 94,25,63616
MAA 144,24,124
TR 96,25,51712
TR 98,25,52224
MAA 148,28,124
TR 100,25,64128
MAA 148,8,120
buffer_load_dword v29, s[36:39], s53 offen offset:2048 lds
MAA 152,12,120
TR 102,25,64640
s_add_u32 s53, s53, 128
MAA 152,32,124
s_waitcnt vmcnt(22) lgkmcnt(8)
s_barrier
MAA 60,80,40
TR 104,25,49696
s_add_u32 m0, s56, 111232
MAA 60,84,60
buffer_load_dwordx4 v18, s[20:23], s54 offen lds
MAA 64,84,64
s_sub_u32 s47, s47, 1
s_cbranch_scc1 .Lx7
.Lx7b:
MAA 64,80,44
TR 106,25,50208
MAA 68,80,48
TR 108,25,62112
MAA 68,84,68
buffer_load_dwordx4 v19, s[20:23], s54 offen offset:1024 lds
MAA 72,84,72
TR 110,25,62624
MAA 72,80,52
TR 112,25,50720
s_waitcnt lgkmcnt(5)
MAA 244,80,56
TR 114,25,51232
MAA 244,84,76
buffer_load_dwordx4 v20, s[20:23], s54 offen offset:2048 lds
MAA 156,92,76
s_add_u32 s54, s54, 196608
MAA 156,88,56
TR 116,25,63136
MAA 104,88,52
TR 118,25,63648
MAA 104,92,72
TR 120,25,51744
MAA 100,92,68
TR 122,25,52256
s_add_u32 m0, s55, 55488
MAA 100,88,48
buffer_load_dwordx4 v21, s[36:39], s52 offen lds
MAA 96,88,44
TR 124,25,64160
MAA 96,92,64
TR 126,25,64672
MAA 92,92,60
MAA 92,88,40
buffer_load_dwordx4 v28, s[36:39], s52 offen offset:1024 lds
MAA 124,40,96
ds_read_b128 a[0:3], v23
MAA 124,60,100
RD 4,23,2304
MAA 128,64,100
RD 8,23,4608
MAA 128,44,96
buffer_load_dword v22, s[36:39], s52 offen offset:2048 lds
MAA 132,48,96
RD 12,23,6912
s_add_u32 s52, s52, 128
MAA 132,68,100
ds_read_b128 a[16:19], v24
MAA 136,72,100
MAA 136,52,96
s_waitcnt vmcnt(21) lgkmcnt(5)
s_barrier
v_cmp_gt_u32 vcc, v35, v37
s_nop 0
s_cbranch_vccnz .Lsp8
.Lsp8b:
v_mov_b32 v37, 0
MAA 76,104,40
ds_read_b128 a[20:23], v30
MAA 76,108,60
buffer_atomic_add v38, v32, s[16:19], 0 offen
MAA 80,108,64
RD 24,30,2304
MAA 80,104,44
RD 28,30,4608
MAA 84,104,48
RD 32,30,6912
s_add_u32 m0, s56, 123648
MAA 84,108,68
buffer_load_dwordx4 v18, s[20:23], s54 offen lds
MAA 88,108,72
ds_read_b128 a[36:39], v31
MAA 88,104,52
buffer_load_dwordx4 v19, s[20:23], s54 offen offset:1024 lds
MAA 160,112,56
ds_read_b64_tr_b16 a[80:81], v25
MAA 160,116,76
TR 82,25,512
MAA 120,116,72
TR 84,25,12416
MAA 120,112,52
buffer_load_dwordx4 v20, s[20:23], s54 offen offset:2048 lds
MAA 116,112,48
TR 86,25,12928
s_add_u32 s54, s54, 196608
MAA 116,116,68
TR 88,25,1024
MAA 112,116,64
TR 90,25,1536
s_add_u32 m0, s55, 57792
MAA 112,112,44
buffer_load_dwordx4 v21, s[36:39], s53 offen lds
MAA 108,112,40
TR 92,25,13440
MAA 108,116,60
TR 94,25,13952
MAA 140,60,124
TR 96,25,2048
MAA 140,40,120
buffer_load_dwordx4 v28, s[36:39], s53 offen offset:1024 lds
MAA 144,44,120
TR 98,25,2560
MAA 144,64,124
buffer_load_dword v29, s[36:39], s53 offen offset:2048 lds
MAA 148,68,124
TR 100,25,14464
s_add_u32 s53, s53, 128
MAA 148,48,120
TR 102,25,14976
MAA 152,52,120
MAA 152,72,124
s_waitcnt vmcnt(22) lgkmcnt(8)
s_barrier
MAA 60,80,0
TR 104,25,32
s_add_u32 m0, s56, 136064
MAA 60,84,20
buffer_load_dwordx4 v18, s[20:23], s54 offen lds
MAA 64,84,24
s_sub_u32 s47, s47, 1
s_cbranch_scc1 .Lx9
.Lx9b:
MAA 64,80,4
TR 106,25,544
MAA 68,80,8
TR 108,25,12448
MAA 68,84,28
buffer_load_dwordx4 v19, s[20:23], s54 offen offset:1024 lds
MAA 72,84,32
TR 110,25,12960
MAA 72,80,12
TR 112,25,1056
s_waitcnt lgkmcnt(5)
MAA 244,80,16
TR 114,25,1568
MAA 244,84,36
buffer_load_dwordx4 v20, s[20:23], s54 offen offset:2048 lds
MAA 156,92,36
s_add_u32 s54, s54, 196608
MAA 156,88,16
TR 116,25,13472
MAA 104,88,12
TR 118,25,13984
MAA 104,92,32
TR 120,25,2080
MAA 100,92,28
TR 122,25,2592
s_add_u32 m0, s55, 0
MAA 100,88,8
buffer_load_dwordx4 v21, s[36:39], s52 offen lds
MAA 96,88,4
TR 124,25,14496
MAA 96,92,24
TR 126,25,15008
MAA 92,92,20
MAA 92,88,0
buffer_load_dwordx4 v28, s[36:39], s52 offen offset:1024 lds
MAA 124,0,96
RD 40,23,18496
MAA 124,20,100
RD 44,23,20800
MAA 128,24,100
RD 48,23,23104
MAA 128,4,96
buffer_load_dword v22, s[36:39], s52 offen offset:2048 lds
MAA 132,8,96
RD 52,23,25408
s_add_u32 s52, s52, 128
MAA 132,28,100
RD 56,24,18496
MAA 136,32,100
MAA 136,12,96
s_waitcnt vmcnt(16) lgkmcnt(5)
s_barrier
MAA 76,104,0
RD 60,30,18496
s_add_u32 m0, s56, 73984
MAA 76,108,20
buffer_load_dwordx4 v18, s[20:23], s54 offen lds
MAA 80,108,24
RD 64,30,20800
MAA 80,104,4
RD 68,30,23104
MAA 84,104,8
RD 72,30,25408
MAA 84,108,28
buffer_load_dwordx4 v19, s[20:23], s54 offen offset:1024 lds
MAA 88,108,32
RD 76,31,18496
MAA 88,104,12
TR 80,25,24832
MAA 160,112,16
TR 82,25,25344
MAA 160,116,36
buffer_load_dwordx4 v20, s[20:23], s54 offen offset:2048 lds
.Lpad2:
s_cbranch_execz .Lpad6
MAA 120,116,32
TR 84,25,37248
s_add_u32 s54, s54, 196608
MAA 120,112,12
TR 86,25,37760
MAA 116,112,8
s_add_u32 m0, s55, 2304
MAA 116,116,28
buffer_load_dwordx4 v21, s[36:39], s53 offen lds
MAA 112,116,24
TR 88,25,25856
MAA 112,112,4
TR 90,25,26368
MAA 108,112,0
TR 92,25,38272
MAA 108,116,20
buffer_load_dwordx4 v28, s[36:39], s53 offen offset:1024 lds
MAA 140,20,124
TR 94,25,38784
MAA 140,0,120
TR 96,25,26880
MAA 144,4,120
TR 98,25,27392
MAA 144,24,124
buffer_load_dword v29, s[36:39], s53 offen offset:2048 lds
MAA 148,28,124
TR 100,25,39296
s_add_u32 s53, s53, 128
MAA 148,8,120
TR 102,25,39808
MAA 152,12,120
MAA 152,32,124
s_waitcnt lgkmcnt(8)
s_barrier
MAA 60,80,40
TR 104,25,24864
s_add_u32 m0, s56, 86400
MAA 60,84,60
buffer_load_dwordx4 v18, s[20:23], s54 offen lds
MAA 64,84,64
s_sub_u32 s47, s47, 1
s_cbranch_scc1 .Lx10
.Lx10b:
MAA 64,80,44
TR 106,25,25376
MAA 68,80,48
TR 108,25,37280
MAA 68,84,68
buffer_load_dwordx4 v19, s[20:23], s54 offen offset:1024 lds
MAA 72,84,72
TR 110,25,37792
MAA 72,80,52
TR 112,25,25888
s_waitcnt lgkmcnt(5)
MAA 244,80,56
TR 114,25,26400
MAA 244,84,76
buffer_load_dwordx4 v20, s[20:23], s54 offen offset:2048 lds
MAA 156,92,76
s_add_u32 s54, s54, 196608
MAA 156,88,56
TR 116,25,38304
MAA 104,88,52
TR 118,25,38816
MAA 104,92,72
TR 120,25,26912
MAA 100,92,68
TR 122,25,27424
s_add_u32 m0, s55, 18496
MAA 100,88,48
buffer_load_dwordx4 v21, s[36:39], s52 offen lds
MAA 96,88,44
TR 124,25,39328
MAA 96,92,64
TR 126,25,39840
MAA 92,92,60
MAA 92,88,40
buffer_load_dwordx4 v28, s[36:39], s52 offen offset:1024 lds
MAA 124,40,96
RD 0,23,36992
MAA 124,60,100
RD 4,23,39296
MAA 128,64,100
RD 8,23,41600
MAA 128,44,96
buffer_load_dword v22, s[36:39], s52 offen offset:2048 lds
MAA 132,48,96
RD 12,23,43904
s_add_u32 s52, s52, 128
MAA 132,68,100
RD 16,24,36992
MAA 136,72,100
MAA 136,52,96
s_waitcnt vmcnt(15) lgkmcnt(5)
s_barrier
MAA 76,104,40
RD 20,30,36992
s_add_u32 m0, s56, 98816
MAA 76,108,60
buffer_load_dwordx4 v18, s[20:23], s54 offen lds
MAA 80,108,64
RD 24,30,39296
MAA 80,104,44
RD 28,30,41600
MAA 84,104,48
RD 32,30,43904
MAA 84,108,68
buffer_load_dwordx4 v19, s[20:23], s54 offen offset:1024 lds
MAA 88,108,72
RD 36,31,36992
MAA 88,104,52
buffer_load_dwordx4 v20, s[20:23], s54 offen offset:2048 lds
MAA 160,112,56
TR 80,25,49664
s_add_u32 s54, s54, 196608
MAA 160,116,76
TR 82,25,50176
MAA 120,116,72
TR 84,25,62080
s_add_u32 m0, s55, 20800
MAA 120,112,52
buffer_load_dwordx4 v21, s[36:39], s53 offen lds
MAA 116,112,48
TR 86,25,62592
MAA 116,116,68
TR 88,25,50688
MAA 112,116,64
TR 90,25,51200
MAA 112,112,44
buffer_load_dwordx4 v28, s[36:39], s53 offen offset:1024 lds
MAA 108,112,40
TR 92,25,63104
MAA 108,116,60
TR 94,25,63616
MAA 140,60,124
TR 96,25,51712
MAA 140,40,120
buffer_load_dword v29, s[36:39], s53 offen offset:2048 lds
MAA 144,44,120
TR 98,25,52224
s_add_u32 s53, s53, 128
MAA 144,64,124
buffer_atomic_add v37, v33, s[16:19], 0 offen sc0
MAA 148,68,124
TR 100,25,64128
MAA 148,48,120
TR 102,25,64640
MAA 152,52,120
MAA 152,72,124
s_waitcnt lgkmcnt(8)
s_barrier
MAA 60,80,0
TR 104,25,49696
s_add_u32 m0, s56, 111232
MAA 60,84,20
buffer_load_dwordx4 v18, s[20:23], s54 offen lds
MAA 64,84,24
s_sub_u32 s47, s47, 1
s_cbranch_scc1 .Lx11
.Lx11b:
MAA 64,80,4
TR 106,25,50208
MAA 68,80,8
TR 108,25,62112
MAA 68,84,28
buffer_load_dwordx4 v19, s[20:23], s54 offen offset:1024 lds
MAA 72,84,32
TR 110,25,62624
MAA 72,80,12
TR 112,25,50720
s_waitcnt lgkmcnt(5)
MAA 244,80,16
TR 114,25,51232
MAA 244,84,36
buffer_load_dwordx4 v20, s[20:23], s54 offen offset:2048 lds
MAA 156,92,36
s_add_u32 s54, s54, 196608
MAA 156,88,16
TR 116,25,63136
MAA 104,88,12
TR 118,25,63648
MAA 104,92,32
TR 120,25,51744
MAA 100,92,28
TR 122,25,52256
s_add_u32 m0, s55, 36992
MAA 100,88,8
buffer_load_dwordx4 v21, s[36:39], s52 offen lds
MAA 96,88,4
TR 124,25,64160
MAA 96,92,24
TR 126,25,64672
MAA 92,92,20
MAA 92,88,0
buffer_load_dwordx4 v28, s[36:39], s52 offen offset:1024 lds
MAA 124,0,96
RD 40,23,55488
MAA 124,20,100
RD 44,23,57792
MAA 128,24,100
RD 48,23,60096
MAA 128,4,96
buffer_load_dword v22, s[36:39], s52 offen offset:2048 lds
MAA 132,8,96
RD 52,23,62400
s_add_u32 s52, s52, 128
MAA 132,28,100
RD 56,24,55488
MAA 136,32,100
MAA 136,12,96
s_waitcnt vmcnt(16) lgkmcnt(5)
s_barrier
MAA 76,104,0
RD 60,30,55488
s_add_u32 m0, s56, 123648
MAA 76,108,20
buffer_load_dwordx4 v18, s[20:23], s54 offen lds
MAA 80,108,24
RD 64,30,57792
MAA 80,104,4
RD 68,30,60096
MAA 84,104,8
RD 72,30,62400
MAA 84,108,28
buffer_load_dwordx4 v19, s[20:23], s54 offen offset:1024 lds
MAA 88,108,32
RD 76,31,55488
MAA 88,104,12
ds_read_b64_tr_b16 a[80:81], v25
MAA 160,112,16
TR 82,25,512
MAA 160,116,36
buffer_load_dwordx4 v20, s[20:23], s54 offen offset:2048 lds
MAA 120,116,32
TR 84,25,12416
s_add_u32 s54, s54, 196608
MAA 120,112,12
TR 86,25,12928
MAA 116,112,8
s_add_u32 m0, s55, 39296
MAA 116,116,28
buffer_load_dwordx4 v21, s[36:39], s53 offen lds
MAA 112,116,24
TR 88,25,1024
MAA 112,112,4
TR 90,25,1536
MAA 108,112,0
TR 92,25,13440
MAA 108,116,20
buffer_load_dwordx4 v28, s[36:39], s53 offen offset:1024 lds
MAA 140,20,124
TR 94,25,13952
MAA 140,0,120
TR 96,25,2048
MAA 144,4,120
TR 98,25,2560
MAA 144,24,124
buffer_load_dword v29, s[36:39], s53 offen offset:2048 lds
MAA 148,28,124
TR 100,25,14464
s_add_u32 s53, s53, 128
MAA 148,8,120
TR 102,25,14976
MAA 152,12,120
MAA 152,32,124
s_waitcnt lgkmcnt(8)
s_barrier
MAA 60,80,40
TR 104,25,32
s_add_u32 m0, s56, 136064
MAA 60,84,60
buffer_load_dwordx4 v18, s[20:23], s54 offen lds
MAA 64,84,64
s_sub_u32 s47, s47, 1
s_cbranch_scc1 .Lx12
.Lx12b:
MAA 64,80,44
TR 106,25,544
MAA 68,80,48
TR 108,25,12448
MAA 68,84,68
buffer_load_dwordx4 v19, s[20:23], s54 offen offset:1024 lds
MAA 72,84,72
TR 110,25,12960
MAA 72,80,52
TR 112,25,1056
s_waitcnt lgkmcnt(5)
MAA 244,80,56
TR 114,25,1568
MAA 244,84,76
buffer_load_dwordx4 v20, s[20:23], s54 offen offset:2048 lds
MAA 156,92,76
s_add_u32 s54, s54, 196608
MAA 156,88,56
TR 116,25,13472
MAA 104,88,52
TR 118,25,13984
MAA 104,92,72
TR 120,25,2080
MAA 100,92,68
TR 122,25,2592
s_add_u32 m0, s55, 55488
MAA 100,88,48
buffer_load_dwordx4 v21, s[36:39], s52 offen lds
MAA 96,88,44
TR 124,25,14496
MAA 96,92,64
TR 126,25,15008
MAA 92,92,60
MAA 92,88,40
buffer_load_dwordx4 v28, s[36:39], s52 offen offset:1024 lds
MAA 124,40,96
ds_read_b128 a[0:3], v23
MAA 124,60,100
RD 4,23,2304
MAA 128,64,100
RD 8,23,4608
MAA 128,44,96
buffer_load_dword v22, s[36:39], s52 offen offset:2048 lds
MAA 132,48,96
RD 12,23,6912
s_add_u32 s52, s52, 128
MAA 132,68,100
ds_read_b128 a[16:19], v24
MAA 136,72,100
MAA 136,52,96
s_waitcnt vmcnt(18)
v_cmp_gt_u32 vcc, v36, v37
s_nop 0
s_cbranch_vccnz .Lsp13
.Lsp13b:
s_waitcnt vmcnt(15) lgkmcnt(5)
s_barrier
MAA 76,104,40
ds_read_b128 a[20:23], v30
s_add_u32 m0, s56, 73984
MAA 76,108,60
buffer_load_dwordx4 v18, s[20:23], s54 offen lds
MAA 80,108,64
RD 24,30,2304
MAA 80,104,44
RD 28,30,4608
MAA 84,104,48
RD 32,30,6912
MAA 84,108,68
buffer_load_dwordx4 v19, s[20:23], s54 offen offset:1024 lds
MAA 88,108,72
ds_read_b128 a[36:39], v31
MAA 88,104,52
buffer_load_dwordx4 v20, s[20:23], s54 offen offset:2048 lds
MAA 160,112,56
TR 80,25,24832
s_add_u32 s54, s54, 196608
MAA 160,116,76
TR 82,25,25344
MAA 120,116,72
TR 84,25,37248
s_add_u32 m0, s55, 57792
MAA 120,112,52
buffer_load_dwordx4 v21, s[36:39], s53 offen lds
MAA 116,112,48
TR 86,25,37760
MAA 116,116,68
TR 88,25,25856
MAA 112,116,64
TR 90,25,26368
MAA 112,112,44
buffer_load_dwordx4 v28, s[36:39], s53 offen offset:1024 lds
MAA 108,112,40
TR 92,25,38272
MAA 108,116,60
TR 94,25,38784
MAA 140,60,124
TR 96,25,26880
MAA 140,40,120
buffer_load_dword v29, s[36:39], s53 offen offset:2048 lds
MAA 144,44,120
TR 98,25,27392
s_add_u32 s53, s53, 128
MAA 144,64,124
buffer_load_dwordx4 v[164:167], v26, s[16:19], s75 offen sc1
MAA 148,68,124
TR 100,25,39296
MAA 148,48,120
TR 102,25,39808
MAA 152,52,120
MAA 152,72,124
s_waitcnt lgkmcnt(8)
s_barrier
MAA 60,80,0
TR 104,25,24864
s_add_u32 m0, s56, 86400
MAA 60,84,20
buffer_load_dwordx4 v18, s[20:23], s54 offen lds
MAA 64,84,24
s_sub_u32 s47, s47, 1
s_cbranch_scc1 .Lx14
.Lx14b:
MAA 64,80,4
TR 106,25,25376
MAA 68,80,8
TR 108,25,37280
MAA 68,84,28
buffer_load_dwordx4 v19, s[20:23], s54 offen offset:1024 lds
MAA 72,84,32
TR 110,25,37792
MAA 72,80,12
TR 112,25,25888
s_waitcnt lgkmcnt(5)
MAA 244,80,16
TR 114,25,26400
MAA 244,84,36
buffer_load_dwordx4 v20, s[20:23], s54 offen offset:2048 lds
MAA 156,92,36
TR 116,25,38304
s_add_u32 s54, s54, 196608
MAA 156,88,16
TR 118,25,38816
MAA 104,88,12
TR 120,25,26912
s_add_u32 m0, s55, 0
MAA 104,92,32
buffer_load_dwordx4 v21, s[36:39], s52 offen lds
MAA 100,92,28
MAA 100,88,8
buffer_load_dwordx4 v28, s[36:39], s52 offen offset:1024 lds
MAA 96,88,4
TR 122,25,27424
MAA 96,92,24
TR 124,25,39328
MAA 92,92,20
TR 126,25,39840
MAA 92,88,0
buffer_load_dword v22, s[36:39], s52 offen offset:2048 lds
MAA 124,0,96
RD 40,23,18496
s_add_u32 s52, s52, 128
MAA 124,20,100
RD 44,23,20800
MAA 128,24,100
RD 48,23,23104
MAA 128,4,96
buffer_load_dwordx4 v[168:171], v26, s[16:19], s75 offen offset:1024 sc1
MAA 132,8,96
RD 52,23,25408
MAA 132,28,100
RD 56,24,18496
MAA 136,32,100
MAA 136,12,96
s_waitcnt vmcnt(17) lgkmcnt(5)
s_barrier
MAA 76,104,0
RD 60,30,18496
s_add_u32 m0, s56, 98816
MAA 76,108,20
buffer_load_dwordx4 v18, s[20:23], s54 offen lds
MAA 80,108,24
RD 64,30,20800
MAA 80,104,4
RD 68,30,23104
MAA 84,104,8
RD 72,30,25408
MAA 84,108,28
buffer_load_dwordx4 v19, s[20:23], s54 offen offset:1024 lds
MAA 88,108,32
RD 76,31,18496
MAA 88,104,12
buffer_load_dwordx4 v20, s[20:23], s54 offen offset:2048 lds
MAA 160,112,16
TR 80,25,49664
s_add_u32 s54, s54, 196608
MAA 160,116,36
TR 82,25,50176
MAA 120,116,32
TR 84,25,62080
s_add_u32 m0, s55, 2304
MAA 120,112,12
buffer_load_dwordx4 v21, s[36:39], s53 offen lds
MAA 116,112,8
TR 86,25,62592
MAA 116,116,28
TR 88,25,50688
MAA 112,116,24
TR 90,25,51200
MAA 112,112,4
buffer_load_dwordx4 v28, s[36:39], s53 offen offset:1024 lds
MAA 108,112,0
TR 92,25,63104
MAA 108,116,20
TR 94,25,63616
MAA 140,20,124
TR 96,25,51712
MAA 140,0,120
buffer_load_dword v29, s[36:39], s53 offen offset:2048 lds
MAA 144,4,120
TR 98,25,52224
s_add_u32 s53, s53, 128
MAA 144,24,124
buffer_load_dwordx4 v[172:175], v26, s[16:19], s75 offen offset:2048 sc1
MAA 148,28,124
TR 100,25,64128
MAA 148,8,120
TR 102,25,64640
MAA 152,12,120
MAA 152,32,124
s_waitcnt lgkmcnt(8)
s_barrier
MAA 60,80,40
TR 104,25,49696
s_add_u32 m0, s56, 111232
MAA 60,84,60
buffer_load_dwordx4 v18, s[20:23], s54 offen lds
MAA 64,84,64
s_sub_u32 s47, s47, 1
s_cbranch_scc1 .Lx15
.Lx15b:
MAA 64,80,44
TR 106,25,50208
MAA 68,80,48
TR 108,25,62112
MAA 68,84,68
buffer_load_dwordx4 v19, s[20:23], s54 offen offset:1024 lds
MAA 72,84,72
TR 110,25,62624
MAA 72,80,52
TR 112,25,50720
s_waitcnt lgkmcnt(5)
MAA 244,80,56
TR 114,25,51232
MAA 244,84,76
buffer_load_dwordx4 v20, s[20:23], s54 offen offset:2048 lds
MAA 156,92,76
TR 116,25,63136
s_add_u32 s54, s54, 196608
MAA 156,88,56
TR 118,25,63648
MAA 104,88,52
.Lpad3:
s_cbranch_execz .Lpad7
TR 120,25,51744
s_add_u32 m0, s55, 18496
MAA 104,92,72
buffer_load_dwordx4 v21, s[36:39], s52 offen lds
MAA 100,92,68
MAA 100,88,48
buffer_load_dwordx4 v28, s[36:39], s52 offen offset:1024 lds
MAA 96,88,44
TR 122,25,52256
MAA 96,92,64
TR 124,25,64160
MAA 92,92,60
TR 126,25,64672
MAA 92,88,40
buffer_load_dword v22, s[36:39], s52 offen offset:2048 lds
MAA 124,40,96
RD 0,23,36992
s_add_u32 s52, s52, 128
MAA 124,60,100
RD 4,23,39296
MAA 128,64,100
RD 8,23,41600
MAA 128,44,96
buffer_load_dwordx4 v[176:179], v26, s[16:19], s75 offen offset:3072 sc1
MAA 132,48,96
RD 12,23,43904
s_add_u32 s75, s75, 4096
MAA 132,68,100
RD 16,24,36992
MAA 136,72,100
MAA 136,52,96
s_waitcnt vmcnt(18) lgkmcnt(5)
s_barrier
MAA 76,104,40
RD 20,30,36992
s_add_u32 m0, s56, 123648
MAA 76,108,60
buffer_load_dwordx4 v18, s[20:23], s54 offen lds
MAA 80,108,64
RD 24,30,39296
s_waitcnt vmcnt(15)
v_add_f32 v164, v164, v168
MAA 80,104,44
RD 28,30,41600
MAA 84,104,48
RD 32,30,43904
MAA 84,108,68
buffer_load_dwordx4 v19, s[20:23], s54 offen offset:1024 lds
MAA 88,108,72
RD 36,31,36992
v_add_f32 v165, v165, v169
MAA 88,104,52
buffer_load_dwordx4 v20, s[20:23], s54 offen offset:2048 lds
MAA 160,112,56
ds_read_b64_tr_b16 a[80:81], v25
s_add_u32 s54, s54, 196608
MAA 160,116,76
TR 82,25,512
MAA 120,116,72
TR 84,25,12416
s_add_u32 m0, s55, 20800
MAA 120,112,52
buffer_load_dwordx4 v21, s[36:39], s53 offen lds
MAA 116,112,48
TR 86,25,12928
MAA 116,116,68
TR 88,25,1024
MAA 112,116,64
TR 90,25,1536
v_add_f32 v166, v166, v170
MAA 112,112,44
buffer_load_dwordx4 v28, s[36:39], s53 offen offset:1024 lds
MAA 108,112,40
TR 92,25,13440
MAA 108,116,60
TR 94,25,13952
MAA 140,60,124
TR 96,25,2048
MAA 140,40,120
buffer_load_dword v29, s[36:39], s53 offen offset:2048 lds
MAA 144,44,120
TR 98,25,2560
s_add_u32 s53, s53, 128
MAA 144,64,124
buffer_load_dwordx4 v[180:183], v26, s[16:19], s75 offen sc1
MAA 148,68,124
TR 100,25,14464
v_add_f32 v167, v167, v171
MAA 148,48,120
TR 102,25,14976
MAA 152,52,120
MAA 152,72,124
s_waitcnt lgkmcnt(8)
s_barrier
MAA 60,80,0
TR 104,25,32
s_add_u32 m0, s56, 136064
MAA 60,84,20
buffer_load_dwordx4 v18, s[20:23], s54 offen lds
MAA 64,84,24
s_sub_u32 s47, s47, 1
s_cbranch_scc1 .Lx16
.Lx16b:
MAA 64,80,4
TR 106,25,544
s_waitcnt vmcnt(15)
v_add_f32 v164, v164, v172
MAA 68,80,8
TR 108,25,12448
MAA 68,84,28
buffer_load_dwordx4 v19, s[20:23], s54 offen offset:1024 lds
MAA 72,84,32
TR 110,25,12960
MAA 72,80,12
TR 112,25,1056
s_waitcnt lgkmcnt(5)
MAA 244,80,16
TR 114,25,1568
MAA 244,84,36
buffer_load_dwordx4 v20, s[20:23], s54 offen offset:2048 lds
MAA 156,92,36
TR 116,25,13472
s_add_u32 s54, s54, 196608
MAA 156,88,16
TR 118,25,13984
v_add_f32 v165, v165, v173
MAA 104,88,12
TR 120,25,2080
s_add_u32 m0, s55, 36992
MAA 104,92,32
buffer_load_dwordx4 v21, s[36:39], s52 offen lds
MAA 100,92,28
MAA 100,88,8
buffer_load_dwordx4 v28, s[36:39], s52 offen offset:1024 lds
MAA 96,88,4
TR 122,25,2592
MAA 96,92,24
TR 124,25,14496
v_add_f32 v166, v166, v174
MAA 92,92,20
TR 126,25,15008
MAA 92,88,0
buffer_load_dword v22, s[36:39], s52 offen offset:2048 lds
MAA 124,0,96
RD 40,23,55488
s_add_u32 s52, s52, 128
MAA 124,20,100
RD 44,23,57792
MAA 128,24,100
RD 48,23,60096
MAA 128,4,96
buffer_load_dwordx4 v[184:187], v26, s[16:19], s75 offen offset:1024 sc1
MAA 132,8,96
RD 52,23,62400
v_add_f32 v167, v167, v175
MAA 132,28,100
RD 56,24,55488
MAA 136,32,100
MAA 136,12,96
s_waitcnt vmcnt(18) lgkmcnt(5)
s_barrier
MAA 76,104,0
RD 60,30,55488
s_add_u32 m0, s56, 73984
MAA 76,108,20
buffer_load_dwordx4 v18, s[20:23], s54 offen lds
MAA 80,108,24
RD 64,30,57792
s_waitcnt vmcnt(15)
v_add_f32 v164, v164, v176
MAA 80,104,4
RD 68,30,60096
v_add_f32 v165, v165, v177
MAA 84,104,8
buffer_load_dwordx4 v19, s[20:23], s54 offen offset:1024 lds
MAA 84,108,28
RD 72,30,62400
v_add_f32 v166, v166, v178
MAA 88,108,32
RD 76,31,55488
v_add_f32 v167, v167, v179
MAA 88,104,12
buffer_load_dwordx4 v20, s[20:23], s54 offen offset:2048 lds
MAA 160,112,16
TR 80,25,24832
s_add_u32 s54, s54, 196608
MAA 160,116,36
TR 82,25,25344
s_add_u32 m0, s55, 39296
MAA 120,116,32
buffer_load_dwordx4 v21, s[36:39], s53 offen lds
MAA 120,112,12
TR 84,25,37248
MAA 116,112,8
TR 86,25,37760
MAA 116,116,28
buffer_load_dwordx4 v28, s[36:39], s53 offen offset:1024 lds
MAA 112,116,24
TR 88,25,25856
MAA 112,112,4
TR 90,25,26368
MAA 108,112,0
buffer_load_dword v29, s[36:39], s53 offen offset:2048 lds
MAA 108,116,20
TR 92,25,38272
s_add_u32 s53, s53, 128
MAA 140,20,124
TR 94,25,38784
MAA 140,0,120
buffer_load_dwordx4 v[188:191], v26, s[16:19], s75 offen offset:2048 sc1
MAA 144,4,120
TR 96,25,26880
MAA 144,24,124
TR 98,25,27392
MAA 148,28,124
TR 100,25,39296
MAA 148,8,120
TR 102,25,39808
MAA 152,12,120
MAA 152,32,124
s_waitcnt lgkmcnt(8)
s_barrier
MAA 60,80,40
TR 104,25,24864
s_add_u32 m0, s56, 86400
MAA 60,84,60
buffer_load_dwordx4 v18, s[20:23], s54 offen lds
MAA 64,84,64
s_sub_u32 s47, s47, 1
s_cbranch_scc1 .Lx17
.Lx17b:
MAA 64,80,44
TR 106,25,25376
s_waitcnt vmcnt(15)
v_add_f32 v164, v164, v180
MAA 68,80,48
TR 108,25,37280
MAA 68,84,68
buffer_load_dwordx4 v19, s[20:23], s54 offen offset:1024 lds
MAA 72,84,72
TR 110,25,37792
MAA 72,80,52
TR 112,25,25888
s_waitcnt lgkmcnt(5)
MAA 244,80,56
TR 114,25,26400
MAA 244,84,76
buffer_load_dwordx4 v20, s[20:23], s54 offen offset:2048 lds
MAA 156,92,76
TR 116,25,38304
s_add_u32 s54, s54, 196608
MAA 156,88,56
TR 118,25,38816
v_add_f32 v165, v165, v181
MAA 104,88,52
TR 120,25,26912
s_add_u32 m0, s55, 55488
MAA 104,92,72
buffer_load_dwordx4 v21, s[36:39], s52 offen lds
MAA 100,92,68
MAA 100,88,48
buffer_load_dwordx4 v28, s[36:39], s52 offen offset:1024 lds
MAA 96,88,44
TR 122,25,27424
MAA 96,92,64
TR 124,25,39328
v_add_f32 v166, v166, v182
MAA 92,92,60
TR 126,25,39840
MAA 92,88,40
buffer_load_dword v22, s[36:39], s52 offen offset:2048 lds
MAA 124,40,96
ds_read_b128 a[0:3], v23
s_add_u32 s52, s52, 128
MAA 124,60,100
RD 4,23,2304
MAA 128,64,100
RD 8,23,4608
MAA 128,44,96
buffer_load_dwordx4 v[192:195], v26, s[16:19], s75 offen offset:3072 sc1
MAA 132,48,96
RD 12,23,6912
v_add_f32 v167, v167, v183
MAA 132,68,100
ds_read_b128 a[16:19], v24
MAA 136,72,100
MAA 136,52,96
s_waitcnt vmcnt(18) lgkmcnt(5)
s_barrier
MAA 76,104,40
ds_read_b128 a[20:23], v30
s_add_u32 m0, s56, 98816
MAA 76,108,60
buffer_load_dwordx4 v18, s[20:23], s54 offen lds
MAA 80,108,64
RD 24,30,2304
s_waitcnt vmcnt(15)
v_add_f32 v164, v164, v184
MAA 80,104,44
RD 28,30,4608
v_add_f32 v165, v165, v185
MAA 84,104,48
RD 32,30,6912
v_add_f32 v166, v166, v186
MAA 84,108,68
buffer_load_dwordx4 v19, s[20:23], s54 offen offset:1024 lds
MAA 88,108,72
ds_read_b128 a[36:39], v31
v_add_f32 v167, v167, v187
MAA 88,104,52
TR 80,25,49664
MAA 160,112,56
TR 82,25,50176
MAA 160,116,76
buffer_load_dwordx4 v20, s[20:23], s54 offen offset:2048 lds
MAA 120,116,72
TR 84,25,62080
s_add_u32 s54, s54, 196608
MAA 120,112,52
TR 86,25,62592
s_add_u32 m0, s55, 57792
MAA 116,112,48
TR 88,25,50688
MAA 116,116,68
buffer_load_dwordx4 v21, s[36:39], s53 offen lds
MAA 112,116,64
TR 90,25,51200
MAA 112,112,44
TR 92,25,63104
MAA 108,112,40
TR 94,25,63616
MAA 108,116,60
buffer_load_dwordx4 v28, s[36:39], s53 offen offset:1024 lds
MAA 140,60,124
TR 96,25,51712
MAA 140,40,120
TR 98,25,52224
MAA 144,44,120
TR 100,25,64128
MAA 144,64,124
buffer_load_dword v29, s[36:39], s53 offen offset:2048 lds
MAA 148,68,124
TR 102,25,64640
s_add_u32 s53, s53, 128
MAA 148,48,120
MAA 152,52,120
MAA 152,72,124
s_waitcnt lgkmcnt(8)
s_barrier
MAA 60,80,0
TR 104,25,49696
s_add_u32 m0, s56, 111232
MAA 60,84,20
buffer_load_dwordx4 v18, s[20:23], s54 offen lds
MAA 64,84,24
TR 106,25,50208
s_waitcnt vmcnt(14)
v_add_f32 v164, v164, v188
MAA 64,80,4
TR 108,25,62112
v_add_f32 v165, v165, v189
MAA 68,80,8
buffer_load_dwordx4 v19, s[20:23], s54 offen offset:1024 lds
MAA 68,84,28
TR 110,25,62624
v_add_f32 v166, v166, v190
MAA 72,84,32
TR 112,25,50720
v_add_f32 v167, v167, v191
MAA 72,80,12
buffer_load_dwordx4 v20, s[20:23], s54 offen offset:2048 lds
s_waitcnt lgkmcnt(5)
MAA 244,80,16
TR 114,25,51232
s_add_u32 s54, s54, 196608
MAA 244,84,36
TR 116,25,63136
s_add_u32 m0, s59, 0
MAA 156,92,36
TR 118,25,63648
s_xor_b32 s58, s87, 1048576
MAA 156,88,16
buffer_load_dwordx4 v5, s[24:27], s58 offen lds
MAA 104,88,12
TR 120,25,51744
MAA 104,92,32
TR 122,25,52256
MAA 100,92,28
buffer_load_dwordx4 v6, s[24:27], s58 offen offset:1024 lds
MAA 100,88,8
TR 124,25,64160
s_add_u32 m0, s59, 8320
MAA 96,88,4
TR 126,25,64672
s_xor_b32 s58, s87, 1179648
MAA 96,92,24
buffer_load_dwordx4 v5, s[24:27], s58 offen lds
MAA 92,92,20
RD 40,23,18496
MAA 92,88,0
RD 44,23,20800
MAA 124,0,96
buffer_load_dwordx4 v6, s[24:27], s58 offen offset:1024 lds
MAA 124,20,100
RD 48,23,23104
MAA 128,24,100
RD 52,23,25408
MAA 128,4,96
RD 56,24,18496
MAA 132,8,96
MAA 132,28,100
MAA 136,32,100
MAA 136,12,96
s_waitcnt vmcnt(17) lgkmcnt(5)
s_barrier
MAA 76,104,0
RD 60,30,18496
s_add_u32 m0, s56, 123648
MAA 76,108,20
buffer_load_dwordx4 v18, s[20:23], s54 offen lds
MAA 80,108,24
RD 64,30,20800
s_waitcnt vmcnt(14)
v_add_f32 v164, v164, v192
MAA 80,104,4
RD 68,30,23104
v_add_f32 v165, v165, v193
MAA 84,104,8
RD 72,30,25408
v_add_f32 v166, v166, v194
MAA 84,108,28
RD 76,31,18496
v_add_f32 v167, v167, v195
MAA 88,108,32
ds_read_b64_tr_b16 a[80:81], v25
MAA 88,104,12
TR 82,25,512
MAA 160,112,16
TR 84,25,12416
MAA 160,116,36
buffer_load_dwordx4 v19, s[20:23], s54 offen offset:1024 lds
MAA 120,116,32
TR 86,25,12928
MAA 120,112,12
TR 88,25,1024
MAA 116,112,8
TR 90,25,1536
MAA 116,116,28
TR 92,25,13440
MAA 112,116,24
TR 94,25,13952
MAA 112,112,4
TR 96,25,2048
MAA 108,112,0
TR 98,25,2560
MAA 108,116,20
buffer_load_dwordx4 v20, s[20:23], s54 offen offset:2048 lds
MAA 140,20,124
TR 100,25,14464
s_add_u32 s54, s54, 196608
MAA 140,0,120
TR 102,25,14976
MAA 144,4,120
MAA 144,24,124
MAA 148,28,124
MAA 148,8,120
MAA 152,12,120
MAA 152,32,124
s_waitcnt lgkmcnt(8)
s_barrier
MAA 60,80,40
TR 104,25,32
s_add_u32 m0, s56, 136064
MAA 60,84,60
buffer_load_dwordx4 v18, s[20:23], s54 offen lds
MAA 64,84,64
TR 106,25,544
MAA 64,80,44
TR 108,25,12448
MAA 68,80,48
buffer_load_dwordx4 v19, s[20:23], s54 offen offset:1024 lds
MAA 68,84,68
TR 110,25,12960
MAA 72,84,72
TR 112,25,1056
MAA 72,80,52
buffer_load_dwordx4 v20, s[20:23], s54 offen offset:2048 lds
s_waitcnt lgkmcnt(5)
MAA 244,80,56
TR 114,25,1568
s_add_u32 s54, s54, 196608
MAA 244,84,76
TR 116,25,13472
s_add_u32 m0, s59, 16640
MAA 156,92,76
TR 118,25,13984
s_xor_b32 s58, s87, 1310720
MAA 156,88,56
buffer_load_dwordx4 v5, s[24:27], s58 offen lds
MAA 104,88,52
TR 120,25,2080
MAA 104,92,72
TR 122,25,2592
MAA 100,92,68
buffer_load_dwordx4 v6, s[24:27], s58 offen offset:1024 lds
MAA 100,88,48
TR 124,25,14496
s_add_u32 m0, s59, 24960
MAA 96,88,44
TR 126,25,15008
s_xor_b32 s58, s87, 1441792
MAA 96,92,64
buffer_load_dwordx4 v5, s[24:27], s58 offen lds
MAA 92,92,60
RD 0,23,36992
MAA 92,88,40
RD 4,23,39296
MAA 124,40,96
buffer_load_dwordx4 v6, s[24:27], s58 offen offset:1024 lds
MAA 124,60,100
RD 8,23,41600
MAA 128,64,100
RD 12,23,43904
MAA 128,44,96
RD 16,24,36992
MAA 132,48,96
v_permlane32_swap_b32 v164, v166
MAA 132,68,100
v_permlane32_swap_b32 v165, v167
MAA 136,72,100
v_add_f32 v164, v164, v166
v_add_f32 v165, v165, v167
MAA 136,52,96
v_mul_f32 v164, 0xba800000, v164
v_mul_f32 v165, 0x3a800000, v165
v_fma_f32 v165, -v164, v164, v165
v_max_f32 v165, 0, v165
v_add_f32 v165, 0x3727c5ac, v165
v_rsq_f32 v166, v165
s_nop 0
v_mov_b32 v165, v166
v_mul_f32 v166, 0x3e8293ee, v166
s_waitcnt vmcnt(14) lgkmcnt(5)
s_barrier
MAA 76,104,40
ds_write_b128 v7, v[164:167]
s_add_u32 m0, s59, 74880
MAA 76,108,60
.Lpad4:
s_cbranch_execz .Lpad8
ds_write_b32 v17, v164
s_xor_b32 s58, s87, 131072
MAA 80,108,64
ds_write_b32 v17, v165 offset:1024
MAA 80,104,44
buffer_load_dwordx4 v5, s[24:27], s58 offen lds
MAA 84,104,48
RD 20,30,36992
MAA 84,108,68
RD 24,30,39296
MAA 88,108,72
RD 28,30,41600
MAA 88,104,52
RD 32,30,43904
MAA 160,112,56
RD 36,31,36992
MAA 160,116,76
buffer_load_dwordx4 v6, s[24:27], s58 offen offset:1024 lds
MAA 120,116,72
TR 80,25,24832
s_add_u32 m0, s59, 83200
MAA 120,112,52
TR 82,25,25344
s_xor_b32 s58, s87, 262144
MAA 116,112,48
TR 84,25,37248
MAA 116,116,68
TR 86,25,37760
MAA 112,116,64
TR 88,25,25856
MAA 112,112,44
buffer_load_dwordx4 v5, s[24:27], s58 offen lds
MAA 108,112,40
TR 90,25,26368
MAA 108,116,60
TR 92,25,38272
MAA 140,60,124
TR 94,25,38784
MAA 140,40,120
TR 96,25,26880
MAA 144,44,120
TR 98,25,27392
MAA 144,64,124
buffer_load_dwordx4 v6, s[24:27], s58 offen offset:1024 lds
MAA 148,68,124
TR 100,25,39296
MAA 148,48,120
TR 102,25,39808
MAA 152,52,120
MAA 152,72,124
s_waitcnt vmcnt(8) lgkmcnt(0)
s_barrier
MAA 156,88,16
TR 112,25,25888
s_add_u32 m0, s59, 33280
MAA 156,92,36
TR 114,25,26400
s_xor_b32 s58, s87, 1572864
MAA 104,92,32
buffer_load_dwordx4 v5, s[24:27], s58 offen lds
MAA 104,88,12
TR 116,25,38304
MAA 100,88,8
TR 118,25,38816
MAA 100,92,28
TR 120,25,26912
MAA 96,92,24
buffer_load_dwordx4 v6, s[24:27], s58 offen offset:1024 lds
MAA 96,88,4
TR 122,25,27424
s_add_u32 m0, s59, 41600
MAA 92,88,0
TR 124,25,39328
s_xor_b32 s58, s87, 1703936
MAA 92,92,20
TR 126,25,39840
MAA 136,32,100
buffer_load_dwordx4 v5, s[24:27], s58 offen lds
MAA 136,12,96
TR 104,25,24864
MAA 244,80,16
TR 106,25,25376
MAA 244,84,36
TR 108,25,37280
MAA 72,84,32
buffer_load_dwordx4 v6, s[24:27], s58 offen offset:1024 lds
MAA 72,80,12
TR 110,25,37792
s_xor_b32 s58, s87, 393216
MAA 68,80,8
RD 40,23,55488
MAA 68,84,28
RD 44,23,57792
MAA 64,84,24
RD 48,23,60096
MAA 64,80,4
RD 52,23,62400
MAA 60,80,0
RD 56,24,55488
MAA 60,84,20
RD 60,30,55488
s_waitcnt lgkmcnt(15)
MAA 160,112,16
RD 64,30,57792
s_waitcnt lgkmcnt(15)
MAA 160,116,36
s_waitcnt lgkmcnt(7)
s_barrier
RD 68,30,60096
MAA 120,116,32
RD 72,30,62400
s_add_u32 m0, s59, 91520
MAA 120,112,12
RD 76,31,55488
MAA 116,112,8
TR 144,25,50688
MAA 116,116,28
TR 146,25,51200
MAA 112,116,24
TR 148,25,63104
MAA 112,112,4
TR 150,25,63616
MAA 108,112,0
TR 152,25,50720
MAA 108,116,20
TR 154,25,51232
MAA 152,32,124
TR 156,25,63136
MAA 152,12,120
TR 158,25,63648
MAA 88,104,12
TR 160,25,51712
MAA 88,108,32
TR 162,25,52224
MAA 84,108,28
TR 164,25,64128
MAA 84,104,8
TR 166,25,64640
MAA 80,104,4
TR 168,25,51744
MAA 80,108,24
TR 170,25,52256
MAA 76,108,20
TR 172,25,64160
MAA 76,104,0
TR 174,25,64672
s_waitcnt lgkmcnt(14)
MAA 156,144,56
TR 128,25,49664
s_waitcnt lgkmcnt(13)
MAA 156,148,76
TR 130,25,50176
MAA 104,148,72
TR 132,25,62080
MAA 104,144,52
TR 134,25,62592
MAA 100,144,48
TR 136,25,49696
MAA 100,148,68
TR 138,25,50208
MAA 96,148,64
TR 140,25,62112
MAA 96,144,44
TR 142,25,62624
MAA 92,144,40
ds_read_b128 v[232:235], v10 offset:768
MAA 92,148,60
ds_read_b128 v[236:239], v10 offset:2816
s_waitcnt lgkmcnt(15)
MAA 160,156,76
ds_read_b128 v[228:231], v10 offset:512
MAA 160,152,56
ds_read_b128 v[224:227], v10 offset:256
MAA 120,152,52
ds_read_b128 v[220:223], v10
MAA 120,156,72
buffer_load_dwordx4 v5, s[24:27], s58 offen lds
MAA 116,156,68
MAA 116,152,48
s_waitcnt lgkmcnt(5)
s_barrier
MAA 112,152,44
MAA 112,156,64
buffer_load_dwordx4 v6, s[24:27], s58 offen offset:1024 lds
MAA 108,156,60
s_add_u32 m0, s59, 99840
s_xor_b32 s58, s87, 524288
MAA 108,152,40
MAA 136,52,160
MAA 136,72,164
buffer_load_dwordx4 v5, s[24:27], s58 offen lds
MAA 152,72,172
MAA 152,52,168
MAA 244,128,56
MAA 244,132,76
buffer_load_dwordx4 v6, s[24:27], s58 offen offset:1024 lds
MAA 72,132,72
s_add_u32 m0, s59, 108160
s_xor_b32 s58, s87, 655360
MAA 72,128,52
MAA 68,128,48
MAA 68,132,68
buffer_load_dwordx4 v5, s[24:27], s58 offen lds
buffer_load_dwordx4 v6, s[24:27], s58 offen offset:1024 lds
s_mov_b32 exec_lo, 0x10001
s_mov_b32 exec_hi, 0x10001
ds_write_b128 v13, v[244:247]
ds_write_b128 v13, v[156:159] offset:256
ds_write_b128 v13, v[160:163] offset:320
s_mov_b64 exec, -1
MAA 64,128,44
MAA 64,132,64
MAA 60,132,60
MAA 60,128,40
MAA 88,136,52
MAA 88,140,72
s_waitcnt lgkmcnt(0)
s_barrier
MAA 84,136,48
ds_read_b128 v[28:31], v13
s_add_u32 m0, s59, 49920
MAA 84,140,68
ds_read_b128 v[32:35], v13 offset:64
s_xor_b32 s58, s87, 1835008
MAA 80,140,64
ds_read_b128 v[36:39], v13 offset:256
MAA 80,136,44
ds_read_b128 v[40:43], v13 offset:320
MAA 76,136,40
ds_read_b32 v44, v12 offset:512
MAA 76,140,60
ds_read_b32 v45, v12 offset:576
ds_read_b128 v[240:243], v11 offset:192
ds_read_b128 v[244:247], v11 offset:1216
ds_read_b128 v[18:21], v11 offset:128
ds_read_b128 v[22:25], v11 offset:1152
buffer_load_dwordx4 v5, s[24:27], s58 offen lds
s_waitcnt lgkmcnt(9)
v_pk_fma_f32 v[72:73], v[28:29], v[232:233], v[72:73] op_sel_hi:[1,0,1]
v_cvt_pk_bf16_f32 v176, v72, v73
v_pk_fma_f32 v[74:75], v[30:31], v[232:233], v[74:75] op_sel_hi:[1,0,1]
v_cvt_pk_bf16_f32 v177, v74, v75
s_waitcnt lgkmcnt(8)
v_pk_fma_f32 v[88:89], v[32:33], v[232:233], v[88:89] op_sel_hi:[1,0,1]
v_cvt_pk_bf16_f32 v178, v88, v89
v_pk_fma_f32 v[90:91], v[34:35], v[232:233], v[90:91] op_sel_hi:[1,0,1]
s_waitcnt lgkmcnt(7)
v_pk_fma_f32 v[104:105], v[36:37], v[232:233], v[104:105] op_sel_hi:[1,0,1]
v_pk_mul_f32 v[104:105], v[104:105], v[232:233] op_sel:[0,1] op_sel_hi:[1,1]
v_cvt_pk_bf16_f32 v196, v104, v105
v_pk_fma_f32 v[106:107], v[38:39], v[232:233], v[106:107] op_sel_hi:[1,0,1]
v_pk_mul_f32 v[106:107], v[106:107], v[232:233] op_sel:[0,1] op_sel_hi:[1,1]
v_cvt_pk_bf16_f32 v197, v106, v107
s_waitcnt lgkmcnt(6)
v_pk_fma_f32 v[120:121], v[40:41], v[232:233], v[120:121] op_sel_hi:[1,0,1]
v_pk_mul_f32 v[120:121], v[120:121], v[232:233] op_sel:[0,1] op_sel_hi:[1,1]
v_cvt_pk_bf16_f32 v198, v120, v121
v_pk_fma_f32 v[122:123], v[42:43], v[232:233], v[122:123] op_sel_hi:[1,0,1]
v_pk_mul_f32 v[122:123], v[122:123], v[232:233] op_sel:[0,1] op_sel_hi:[1,1]
v_cvt_pk_bf16_f32 v199, v122, v123
ds_write_b128 v8, v[196:199]
s_waitcnt lgkmcnt(4)
v_pk_fma_f32 v[136:137], v[240:241], v[44:45], v[136:137] op_sel_hi:[1,0,1]
v_pk_fma_f32 v[138:139], v[242:243], v[44:45], v[138:139] op_sel_hi:[1,0,1]
s_waitcnt lgkmcnt(3)
v_pk_mul_f32 v[136:137], v[136:137], v[244:245]
v_cvt_pk_bf16_f32 v208, v136, v137
v_pk_mul_f32 v[138:139], v[138:139], v[246:247]
v_cvt_pk_bf16_f32 v209, v138, v139
v_pk_fma_f32 v[152:153], v[240:241], v[44:45], v[152:153] op_sel:[0,1,0] op_sel_hi:[1,1,1]
v_pk_mul_f32 v[152:153], v[152:153], v[244:245]
v_cvt_pk_bf16_f32 v218, v152, v153
v_pk_fma_f32 v[154:155], v[242:243], v[44:45], v[154:155] op_sel:[0,1,0] op_sel_hi:[1,1,1]
v_pk_mul_f32 v[154:155], v[154:155], v[246:247]
v_cvt_pk_bf16_f32 v219, v154, v155
ds_write_b64 v8, v[208:209] offset:1024
ds_write_b64 v8, v[218:219] offset:1032
v_pk_fma_f32 v[156:157], v[36:37], v[236:237], v[156:157] op_sel_hi:[1,0,1]
v_pk_mul_f32 v[156:157], v[156:157], v[236:237] op_sel:[0,1] op_sel_hi:[1,1]
v_cvt_pk_bf16_f32 v180, v156, v157
v_pk_fma_f32 v[158:159], v[38:39], v[236:237], v[158:159] op_sel_hi:[1,0,1]
v_pk_mul_f32 v[158:159], v[158:159], v[236:237] op_sel:[0,1] op_sel_hi:[1,1]
v_cvt_pk_bf16_f32 v181, v158, v159
v_pk_fma_f32 v[160:161], v[40:41], v[236:237], v[160:161] op_sel_hi:[1,0,1]
v_pk_mul_f32 v[160:161], v[160:161], v[236:237] op_sel:[0,1] op_sel_hi:[1,1]
v_cvt_pk_bf16_f32 v182, v160, v161
v_pk_fma_f32 v[162:163], v[42:43], v[236:237], v[162:163] op_sel_hi:[1,0,1]
v_pk_mul_f32 v[162:163], v[162:163], v[236:237] op_sel:[0,1] op_sel_hi:[1,1]
v_cvt_pk_bf16_f32 v183, v162, v163
v_pk_fma_f32 v[100:101], v[36:37], v[228:229], v[100:101] op_sel_hi:[1,0,1]
v_pk_mul_f32 v[100:101], v[100:101], v[228:229] op_sel:[0,1] op_sel_hi:[1,1]
v_cvt_pk_bf16_f32 v192, v100, v101
v_pk_fma_f32 v[102:103], v[38:39], v[228:229], v[102:103] op_sel_hi:[1,0,1]
v_pk_mul_f32 v[102:103], v[102:103], v[228:229] op_sel:[0,1] op_sel_hi:[1,1]
v_cvt_pk_bf16_f32 v193, v102, v103
v_pk_fma_f32 v[116:117], v[40:41], v[228:229], v[116:117] op_sel_hi:[1,0,1]
v_pk_mul_f32 v[116:117], v[116:117], v[228:229] op_sel:[0,1] op_sel_hi:[1,1]
v_cvt_pk_bf16_f32 v194, v116, v117
v_pk_fma_f32 v[118:119], v[42:43], v[228:229], v[118:119] op_sel_hi:[1,0,1]
v_pk_mul_f32 v[118:119], v[118:119], v[228:229] op_sel:[0,1] op_sel_hi:[1,1]
s_waitcnt lgkmcnt(0)
s_barrier
v_cvt_pk_bf16_f32 v195, v118, v119
v_pk_fma_f32 v[96:97], v[36:37], v[224:225], v[96:97] op_sel_hi:[1,0,1]
v_pk_mul_f32 v[96:97], v[96:97], v[224:225] op_sel:[0,1] op_sel_hi:[1,1]
v_cvt_pk_bf16_f32 v188, v96, v97
v_pk_fma_f32 v[98:99], v[38:39], v[224:225], v[98:99] op_sel_hi:[1,0,1]
v_pk_mul_f32 v[98:99], v[98:99], v[224:225] op_sel:[0,1] op_sel_hi:[1,1]
v_cvt_pk_bf16_f32 v189, v98, v99
v_pk_fma_f32 v[112:113], v[40:41], v[224:225], v[112:113] op_sel_hi:[1,0,1]
v_pk_mul_f32 v[112:113], v[112:113], v[224:225] op_sel:[0,1] op_sel_hi:[1,1]
v_cvt_pk_bf16_f32 v190, v112, v113
v_pk_fma_f32 v[114:115], v[42:43], v[224:225], v[114:115] op_sel_hi:[1,0,1]
v_pk_mul_f32 v[114:115], v[114:115], v[224:225] op_sel:[0,1] op_sel_hi:[1,1]
v_cvt_pk_bf16_f32 v191, v114, v115
v_pk_fma_f32 v[92:93], v[36:37], v[220:221], v[92:93] op_sel_hi:[1,0,1]
v_pk_mul_f32 v[92:93], v[92:93], v[220:221] op_sel:[0,1] op_sel_hi:[1,1]
v_cvt_pk_bf16_f32 v184, v92, v93
v_pk_fma_f32 v[94:95], v[38:39], v[220:221], v[94:95] op_sel_hi:[1,0,1]
v_pk_mul_f32 v[94:95], v[94:95], v[220:221] op_sel:[0,1] op_sel_hi:[1,1]
v_cvt_pk_bf16_f32 v185, v94, v95
v_pk_fma_f32 v[108:109], v[40:41], v[220:221], v[108:109] op_sel_hi:[1,0,1]
v_pk_mul_f32 v[108:109], v[108:109], v[220:221] op_sel:[0,1] op_sel_hi:[1,1]
v_cvt_pk_bf16_f32 v186, v108, v109
v_pk_fma_f32 v[110:111], v[42:43], v[220:221], v[110:111] op_sel_hi:[1,0,1]
v_pk_mul_f32 v[110:111], v[110:111], v[220:221] op_sel:[0,1] op_sel_hi:[1,1]
v_cvt_pk_bf16_f32 v187, v110, v111
v_cvt_pk_bf16_f32 v179, v90, v91
v_pk_fma_f32 v[68:69], v[28:29], v[228:229], v[68:69] op_sel_hi:[1,0,1]
v_cvt_pk_bf16_f32 v172, v68, v69
v_pk_fma_f32 v[70:71], v[30:31], v[228:229], v[70:71] op_sel_hi:[1,0,1]
v_cvt_pk_bf16_f32 v173, v70, v71
v_pk_fma_f32 v[84:85], v[32:33], v[228:229], v[84:85] op_sel_hi:[1,0,1]
v_cvt_pk_bf16_f32 v174, v84, v85
v_pk_fma_f32 v[86:87], v[34:35], v[228:229], v[86:87] op_sel_hi:[1,0,1]
v_cvt_pk_bf16_f32 v175, v86, v87
v_pk_fma_f32 v[64:65], v[28:29], v[224:225], v[64:65] op_sel_hi:[1,0,1]
v_cvt_pk_bf16_f32 v168, v64, v65
v_pk_fma_f32 v[66:67], v[30:31], v[224:225], v[66:67] op_sel_hi:[1,0,1]
v_cvt_pk_bf16_f32 v169, v66, v67
v_pk_fma_f32 v[80:81], v[32:33], v[224:225], v[80:81] op_sel_hi:[1,0,1]
v_cvt_pk_bf16_f32 v170, v80, v81
v_pk_fma_f32 v[82:83], v[34:35], v[224:225], v[82:83] op_sel_hi:[1,0,1]
v_cvt_pk_bf16_f32 v171, v82, v83
v_pk_fma_f32 v[60:61], v[28:29], v[220:221], v[60:61] op_sel_hi:[1,0,1]
v_cvt_pk_bf16_f32 v164, v60, v61
v_pk_fma_f32 v[62:63], v[30:31], v[220:221], v[62:63] op_sel_hi:[1,0,1]
v_cvt_pk_bf16_f32 v165, v62, v63
v_pk_fma_f32 v[76:77], v[32:33], v[220:221], v[76:77] op_sel_hi:[1,0,1]
v_cvt_pk_bf16_f32 v166, v76, v77
v_pk_fma_f32 v[78:79], v[34:35], v[220:221], v[78:79] op_sel_hi:[1,0,1]
v_cvt_pk_bf16_f32 v167, v78, v79
s_nop 0
v_mfma_f32_16x16x32_bf16 v[120:123], v[196:199], v[176:179], v[50:53]
buffer_load_dwordx4 v6, s[24:27], s58 offen offset:1024 lds
v_mfma_f32_16x16x32_bf16 v[104:107], v[192:195], v[176:179], v[46:49]
ds_read_b64 v[200:201], v9 offset:1024
s_add_u32 m0, s59, 58240
v_mfma_f32_16x16x32_bf16 v[116:119], v[192:195], v[172:175], v[50:53]
ds_read_b64 v[210:211], v9 offset:1032
s_xor_b32 s58, s87, 1966080
v_mfma_f32_16x16x32_bf16 v[100:103], v[188:191], v[172:175], v[46:49]
ds_read_b128 v[240:243], v11 offset:64
v_mfma_f32_16x16x32_bf16 v[112:115], v[188:191], v[168:171], v[50:53]
buffer_load_dwordx4 v5, s[24:27], s58 offen lds
v_mfma_f32_16x16x32_bf16 v[96:99], v[184:187], v[168:171], v[46:49]
ds_read_b128 v[244:247], v11 offset:1088
v_max3_f32 v88, v104, v105, v106
v_mfma_f32_16x16x32_bf16 v[108:111], v[184:187], v[164:167], v[50:53]
ds_read_b128 v[28:31], v11
v_max3_f32 v89, v107, v120, v121
v_mfma_f32_16x16x32_bf16 v[92:95], v[180:183], v[164:167], v[54:57]
ds_read_b128 v[32:35], v11 offset:1024
v_max3_f32 v88, v88, v122, v123
MAA 132,8,96
buffer_load_dwordx4 v6, s[24:27], s58 offen offset:1024 lds
MAA 132,28,100
s_add_u32 m0, s59, 66560
s_xor_b32 s58, s87, 0
v_max_f32 v90, v88, v89
MAA 132,48,160
v_max_f32 v89, v88, v89
v_max3_f32 v84, v100, v101, v102
MAA 132,68,164
v_permlane16_swap_b32 v90, v89
MAA 148,68,172
buffer_load_dwordx4 v5, s[24:27], s58 offen lds
MAA 148,48,168
v_max_f32 v88, v90, v89
v_max_f32 v89, v90, v89
MAA 148,28,124
s_nop 0
v_permlane32_swap_b32 v88, v89
MAA 148,8,120
v_max_f32 v88, v88, v89
v_mul_f32 v88, v88, v234
v_max3_f32 v85, v103, v116, v117
v_max3_f32 v84, v84, v118, v119
v_max_f32 v86, v84, v85
v_max_f32 v85, v84, v85
v_max3_f32 v80, v96, v97, v98
v_max3_f32 v81, v99, v112, v113
v_permlane16_swap_b32 v86, v85
v_max3_f32 v80, v80, v114, v115
v_max_f32 v84, v86, v85
v_max_f32 v85, v86, v85
v_max_f32 v82, v80, v81
v_max_f32 v81, v80, v81
v_permlane32_swap_b32 v84, v85
v_max3_f32 v76, v92, v93, v94
v_max_f32 v84, v84, v85
v_mul_f32 v84, v84, v230
v_permlane16_swap_b32 v82, v81
v_max3_f32 v77, v95, v108, v109
v_max_f32 v80, v82, v81
v_max_f32 v81, v82, v81
v_max3_f32 v76, v76, v110, v111
v_max_f32 v78, v76, v77
v_permlane32_swap_b32 v80, v81
v_max_f32 v77, v76, v77
v_max_f32 v80, v80, v81
v_mul_f32 v80, v80, v226
v_permlane16_swap_b32 v78, v77
v_pk_fma_f32 v[104:105], v[104:105], v[234:235], v[88:89] op_sel_hi:[1,0,0] neg_lo:[0,0,1] neg_hi:[0,0,1]
v_max_f32 v76, v78, v77
v_max_f32 v77, v78, v77
v_pk_fma_f32 v[106:107], v[106:107], v[234:235], v[88:89] op_sel_hi:[1,0,0] neg_lo:[0,0,1] neg_hi:[0,0,1]
v_pk_fma_f32 v[120:121], v[120:121], v[234:235], v[88:89] op_sel_hi:[1,0,0] neg_lo:[0,0,1] neg_hi:[0,0,1]
v_permlane32_swap_b32 v76, v77
v_pk_fma_f32 v[122:123], v[122:123], v[234:235], v[88:89] op_sel_hi:[1,0,0] neg_lo:[0,0,1] neg_hi:[0,0,1]
v_max_f32 v76, v76, v77
v_mul_f32 v76, v76, v222
v_pk_fma_f32 v[100:101], v[100:101], v[230:231], v[84:85] op_sel_hi:[1,0,0] neg_lo:[0,0,1] neg_hi:[0,0,1]
v_pk_fma_f32 v[102:103], v[102:103], v[230:231], v[84:85] op_sel_hi:[1,0,0] neg_lo:[0,0,1] neg_hi:[0,0,1]
v_pk_fma_f32 v[116:117], v[116:117], v[230:231], v[84:85] op_sel_hi:[1,0,0] neg_lo:[0,0,1] neg_hi:[0,0,1]
v_pk_fma_f32 v[118:119], v[118:119], v[230:231], v[84:85] op_sel_hi:[1,0,0] neg_lo:[0,0,1] neg_hi:[0,0,1]
v_pk_fma_f32 v[96:97], v[96:97], v[226:227], v[80:81] op_sel_hi:[1,0,0] neg_lo:[0,0,1] neg_hi:[0,0,1]
v_pk_fma_f32 v[98:99], v[98:99], v[226:227], v[80:81] op_sel_hi:[1,0,0] neg_lo:[0,0,1] neg_hi:[0,0,1]
v_pk_fma_f32 v[112:113], v[112:113], v[226:227], v[80:81] op_sel_hi:[1,0,0] neg_lo:[0,0,1] neg_hi:[0,0,1]
v_pk_fma_f32 v[114:115], v[114:115], v[226:227], v[80:81] op_sel_hi:[1,0,0] neg_lo:[0,0,1] neg_hi:[0,0,1]
v_pk_fma_f32 v[92:93], v[92:93], v[222:223], v[76:77] op_sel_hi:[1,0,0] neg_lo:[0,0,1] neg_hi:[0,0,1]
v_pk_fma_f32 v[94:95], v[94:95], v[222:223], v[76:77] op_sel_hi:[1,0,0] neg_lo:[0,0,1] neg_hi:[0,0,1]
v_pk_fma_f32 v[108:109], v[108:109], v[222:223], v[76:77] op_sel_hi:[1,0,0] neg_lo:[0,0,1] neg_hi:[0,0,1]
v_pk_fma_f32 v[110:111], v[110:111], v[222:223], v[76:77] op_sel_hi:[1,0,0] neg_lo:[0,0,1] neg_hi:[0,0,1]
v_pk_fma_f32 v[132:133], v[18:19], v[44:45], v[132:133] op_sel_hi:[1,0,1]
v_pk_mul_f32 v[132:133], v[132:133], v[22:23]
v_pk_fma_f32 v[134:135], v[20:21], v[44:45], v[134:135] op_sel_hi:[1,0,1]
v_pk_mul_f32 v[134:135], v[134:135], v[24:25]
v_pk_fma_f32 v[148:149], v[18:19], v[44:45], v[148:149] op_sel:[0,1,0] op_sel_hi:[1,1,1]
v_pk_mul_f32 v[148:149], v[148:149], v[22:23]
v_pk_fma_f32 v[150:151], v[20:21], v[44:45], v[150:151] op_sel:[0,1,0] op_sel_hi:[1,1,1]
v_pk_mul_f32 v[150:151], v[150:151], v[24:25]
v_exp_f32 v104, v104
s_nop 0
MAA 128,4,96
buffer_load_dwordx4 v6, s[24:27], s58 offen offset:1024 lds
MAA 128,24,100
s_add_u32 m0, s59, 116480
s_xor_b32 s58, s87, 786432
v_exp_f32 v105, v105
MAA 128,44,160
v_exp_f32 v106, v106
MAA 128,64,164
v_exp_f32 v107, v107
MAA 144,64,172
buffer_load_dwordx4 v5, s[24:27], s58 offen lds
MAA 144,44,168
v_exp_f32 v120, v120
MAA 144,24,124
v_exp_f32 v121, v121
MAA 144,4,120
v_exp_f32 v122, v122
MAA 124,0,96
buffer_load_dwordx4 v6, s[24:27], s58 offen offset:1024 lds
MAA 124,20,100
s_add_u32 m0, s59, 124800
s_xor_b32 s58, s87, 917504
v_exp_f32 v123, v123
MAA 124,40,160
v_exp_f32 v100, v100
MAA 124,60,164
v_exp_f32 v101, v101
MAA 140,60,172
buffer_load_dwordx4 v5, s[24:27], s58 offen lds
MAA 140,40,168
v_exp_f32 v102, v102
MAA 140,20,124
v_exp_f32 v103, v103
MAA 140,0,120
v_cvt_pk_bf16_f32 v72, v104, v105
v_cvt_pk_bf16_f32 v73, v106, v107
v_cvt_pk_bf16_f32 v74, v120, v121
v_cvt_pk_bf16_f32 v75, v122, v123
v_exp_f32 v116, v116
v_exp_f32 v117, v117
v_exp_f32 v118, v118
v_exp_f32 v119, v119
v_cvt_pk_bf16_f32 v68, v100, v101
v_cvt_pk_bf16_f32 v69, v102, v103
v_cvt_pk_bf16_f32 v70, v116, v117
v_cvt_pk_bf16_f32 v71, v118, v119
v_exp_f32 v96, v96
v_exp_f32 v97, v97
v_exp_f32 v98, v98
v_exp_f32 v99, v99
v_exp_f32 v112, v112
v_exp_f32 v113, v113
v_exp_f32 v114, v114
v_exp_f32 v115, v115
v_cvt_pk_bf16_f32 v64, v96, v97
v_cvt_pk_bf16_f32 v65, v98, v99
v_cvt_pk_bf16_f32 v66, v112, v113
v_cvt_pk_bf16_f32 v67, v114, v115
v_cvt_pk_bf16_f32 v206, v132, v133
v_cvt_pk_bf16_f32 v207, v134, v135
v_cvt_pk_bf16_f32 v216, v148, v149
v_cvt_pk_bf16_f32 v217, v150, v151
s_waitcnt lgkmcnt(3)
v_pk_fma_f32 v[128:129], v[240:241], v[44:45], v[128:129] op_sel_hi:[1,0,1]
s_waitcnt lgkmcnt(2)
v_pk_mul_f32 v[128:129], v[128:129], v[244:245]
v_cvt_pk_bf16_f32 v204, v128, v129
v_pk_fma_f32 v[130:131], v[242:243], v[44:45], v[130:131] op_sel_hi:[1,0,1]
v_pk_mul_f32 v[130:131], v[130:131], v[246:247]
v_cvt_pk_bf16_f32 v205, v130, v131
v_pk_fma_f32 v[144:145], v[240:241], v[44:45], v[144:145] op_sel:[0,1,0] op_sel_hi:[1,1,1]
v_pk_mul_f32 v[144:145], v[144:145], v[244:245]
v_cvt_pk_bf16_f32 v214, v144, v145
v_pk_fma_f32 v[146:147], v[242:243], v[44:45], v[146:147] op_sel:[0,1,0] op_sel_hi:[1,1,1]
v_pk_mul_f32 v[146:147], v[146:147], v[246:247]
v_cvt_pk_bf16_f32 v215, v146, v147
s_waitcnt lgkmcnt(1)
v_pk_fma_f32 v[124:125], v[28:29], v[44:45], v[124:125] op_sel_hi:[1,0,1]
s_waitcnt lgkmcnt(0)
v_pk_mul_f32 v[124:125], v[124:125], v[32:33]
v_cvt_pk_bf16_f32 v202, v124, v125
v_pk_fma_f32 v[126:127], v[30:31], v[44:45], v[126:127] op_sel_hi:[1,0,1]
v_pk_mul_f32 v[126:127], v[126:127], v[34:35]
v_cvt_pk_bf16_f32 v203, v126, v127
v_pk_fma_f32 v[140:141], v[28:29], v[44:45], v[140:141] op_sel:[0,1,0] op_sel_hi:[1,1,1]
v_pk_mul_f32 v[140:141], v[140:141], v[32:33]
v_cvt_pk_bf16_f32 v212, v140, v141
v_pk_fma_f32 v[142:143], v[30:31], v[44:45], v[142:143] op_sel:[0,1,0] op_sel_hi:[1,1,1]
v_pk_mul_f32 v[142:143], v[142:143], v[34:35]
v_cvt_pk_bf16_f32 v213, v142, v143
s_nop 0
v_mfma_f32_16x16x32_bf16 v[88:91], v[248:251], v[72:75], 0
buffer_load_dwordx4 v6, s[24:27], s58 offen offset:1024 lds
v_mfma_f32_16x16x32_bf16 v[104:107], v[206:209], v[72:75], 0
v_exp_f32 v92, v92
v_mfma_f32_16x16x32_bf16 v[120:123], v[216:219], v[72:75], 0
v_exp_f32 v93, v93
v_mfma_f32_16x16x32_bf16 v[84:87], v[248:251], v[68:71], 0
v_exp_f32 v94, v94
v_mfma_f32_16x16x32_bf16 v[100:103], v[204:207], v[68:71], 0
v_exp_f32 v95, v95
v_mfma_f32_16x16x32_bf16 v[116:119], v[214:217], v[68:71], 0
.Lpad5:
s_cbranch_execz .Lpad9
v_exp_f32 v108, v108
v_mfma_f32_16x16x32_bf16 v[80:83], v[248:251], v[64:67], 0
v_exp_f32 v109, v109
v_mfma_f32_16x16x32_bf16 v[96:99], v[202:205], v[64:67], 0
v_exp_f32 v110, v110
v_mfma_f32_16x16x32_bf16 v[112:115], v[212:215], v[64:67], 0
v_exp_f32 v111, v111
v_cvt_pk_bf16_f32 v60, v92, v93
v_cvt_pk_bf16_f32 v61, v94, v95
v_cvt_pk_bf16_f32 v62, v108, v109
v_cvt_pk_bf16_f32 v63, v110, v111
v_rcp_f32 v88, v88
v_rcp_f32 v84, v84
v_mfma_f32_16x16x32_bf16 v[76:79], v[248:251], v[60:63], 0
v_rcp_f32 v80, v80
v_mfma_f32_16x16x32_bf16 v[92:95], v[200:203], v[60:63], 0
v_mfma_f32_16x16x32_bf16 v[108:111], v[210:213], v[60:63], 0
s_nop 4
v_rcp_f32 v76, v76
v_pk_mul_f32 v[104:105], v[104:105], v[88:89] op_sel_hi:[1,0]
v_pk_mul_f32 v[106:107], v[106:107], v[88:89] op_sel_hi:[1,0]
v_pk_mul_f32 v[120:121], v[120:121], v[88:89] op_sel_hi:[1,0]
v_pk_mul_f32 v[122:123], v[122:123], v[88:89] op_sel_hi:[1,0]
v_cvt_pk_bf16_f32 v176, v104, v105
v_cvt_pk_bf16_f32 v177, v106, v107
v_cvt_pk_bf16_f32 v178, v120, v121
v_cvt_pk_bf16_f32 v179, v122, v123
buffer_store_dwordx4 v[176:179], v4, s[16:19], s74 offen offset:3072 sc1
v_pk_mul_f32 v[100:101], v[100:101], v[84:85] op_sel_hi:[1,0]
v_pk_mul_f32 v[102:103], v[102:103], v[84:85] op_sel_hi:[1,0]
v_pk_mul_f32 v[116:117], v[116:117], v[84:85] op_sel_hi:[1,0]
v_pk_mul_f32 v[118:119], v[118:119], v[84:85] op_sel_hi:[1,0]
v_cvt_pk_bf16_f32 v172, v100, v101
v_cvt_pk_bf16_f32 v173, v102, v103
v_cvt_pk_bf16_f32 v174, v116, v117
v_cvt_pk_bf16_f32 v175, v118, v119
buffer_store_dwordx4 v[172:175], v4, s[16:19], s74 offen offset:2048 sc1
v_pk_mul_f32 v[96:97], v[96:97], v[80:81] op_sel_hi:[1,0]
v_pk_mul_f32 v[98:99], v[98:99], v[80:81] op_sel_hi:[1,0]
v_pk_mul_f32 v[112:113], v[112:113], v[80:81] op_sel_hi:[1,0]
v_pk_mul_f32 v[114:115], v[114:115], v[80:81] op_sel_hi:[1,0]
v_cvt_pk_bf16_f32 v168, v96, v97
v_cvt_pk_bf16_f32 v169, v98, v99
v_cvt_pk_bf16_f32 v170, v112, v113
v_cvt_pk_bf16_f32 v171, v114, v115
buffer_store_dwordx4 v[168:171], v4, s[16:19], s74 offen offset:1024 sc1
v_pk_mul_f32 v[92:93], v[92:93], v[76:77] op_sel_hi:[1,0]
v_pk_mul_f32 v[94:95], v[94:95], v[76:77] op_sel_hi:[1,0]
v_pk_mul_f32 v[108:109], v[108:109], v[76:77] op_sel_hi:[1,0]
v_pk_mul_f32 v[110:111], v[110:111], v[76:77] op_sel_hi:[1,0]
v_cvt_pk_bf16_f32 v164, v92, v93
v_cvt_pk_bf16_f32 v165, v94, v95
v_cvt_pk_bf16_f32 v166, v108, v109
v_cvt_pk_bf16_f32 v167, v110, v111
buffer_store_dwordx4 v[164:167], v4, s[16:19], s74 offen sc1
s_nop 1
s_branch .Lqkve2
.Lx4:
buffer_load_dword v27, v14, s[76:79], 0 offen
s_mov_b32 s76, s98
s_mov_b32 s77, s99
s_mov_b32 s78, s100
v_mov_b32 v14, v15
s_mov_b32 s47, 5
s_branch .Lx4b
.Lx5:
buffer_load_dword v27, v14, s[76:79], 0 offen
s_mov_b32 s76, s98
s_mov_b32 s77, s99
s_mov_b32 s78, s100
v_mov_b32 v14, v15
s_mov_b32 s47, 5
s_branch .Lx5b
.Lx6:
buffer_load_dword v27, v14, s[76:79], 0 offen
s_mov_b32 s76, s98
s_mov_b32 s77, s99
s_mov_b32 s78, s100
v_mov_b32 v14, v15
s_mov_b32 s47, 5
s_branch .Lx6b
.Lx7:
buffer_load_dword v27, v14, s[76:79], 0 offen
s_mov_b32 s76, s98
s_mov_b32 s77, s99
s_mov_b32 s78, s100
v_mov_b32 v14, v15
s_mov_b32 s47, 5
s_branch .Lx7b
.Lsp8:
s_mov_b32 s15, 0
.Lsp8l:
v_mov_b32 v37, 0
buffer_atomic_add v37, v34, s[40:43], 0 offen sc0
s_add_u32 s15, s15, 1
s_cmp_gt_u32 s15, 100000
s_waitcnt vmcnt(0)
s_cbranch_scc1 .Lsp8b
v_cmp_gt_u32 vcc, v35, v37
s_nop 0
s_cbranch_vccnz .Lsp8l
s_branch .Lsp8b
.Lx9:
buffer_load_dword v27, v14, s[76:79], 0 offen
s_mov_b32 s76, s98
s_mov_b32 s77, s99
s_mov_b32 s78, s100
v_mov_b32 v14, v15
s_mov_b32 s47, 5
s_branch .Lx9b
.Lx10:
buffer_load_dword v27, v14, s[76:79], 0 offen
s_mov_b32 s76, s98
s_mov_b32 s77, s99
s_mov_b32 s78, s100
v_mov_b32 v14, v15
s_mov_b32 s47, 5
s_branch .Lx10b
.Lx11:
buffer_load_dword v27, v14, s[76:79], 0 offen
s_mov_b32 s76, s98
s_mov_b32 s77, s99
s_mov_b32 s78, s100
v_mov_b32 v14, v15
s_mov_b32 s47, 5
s_branch .Lx11b
.Lx12:
buffer_load_dword v27, v14, s[76:79], 0 offen
s_mov_b32 s76, s98
s_mov_b32 s77, s99
s_mov_b32 s78, s100
v_mov_b32 v14, v15
s_mov_b32 s47, 5
s_branch .Lx12b
.Lsp13:
s_mov_b32 s15, 0
.Lsp13l:
v_mov_b32 v37, 0
buffer_atomic_add v37, v33, s[16:19], 0 offen sc0
s_add_u32 s15, s15, 1
s_cmp_gt_u32 s15, 100000
s_waitcnt vmcnt(0)
s_cbranch_scc1 .Lsp13b
v_cmp_gt_u32 vcc, v36, v37
s_nop 0
s_cbranch_vccnz .Lsp13l
s_branch .Lsp13b
.Lx14:
buffer_load_dword v27, v14, s[76:79], 0 offen
s_mov_b32 s76, s98
s_mov_b32 s77, s99
s_mov_b32 s78, s100
v_mov_b32 v14, v15
s_mov_b32 s47, 5
s_branch .Lx14b
.Lx15:
buffer_load_dword v27, v14, s[76:79], 0 offen
s_mov_b32 s76, s98
s_mov_b32 s77, s99
s_mov_b32 s78, s100
v_mov_b32 v14, v15
s_mov_b32 s47, 5
s_branch .Lx15b
.Lx16:
buffer_load_dword v27, v14, s[76:79], 0 offen
s_mov_b32 s76, s98
s_mov_b32 s77, s99
s_mov_b32 s78, s100
v_mov_b32 v14, v15
s_mov_b32 s47, 5
s_branch .Lx16b
.Lx17:
buffer_load_dword v27, v14, s[76:79], 0 offen
s_mov_b32 s76, s98
s_mov_b32 s77, s99
s_mov_b32 s78, s100
v_mov_b32 v14, v15
s_mov_b32 s47, 5
s_branch .Lx17b
.Lx19:
buffer_load_dword v27, v14, s[76:79], 0 offen
s_mov_b32 s76, s98
s_mov_b32 s77, s99
s_mov_b32 s78, s100
v_mov_b32 v14, v15
s_mov_b32 s47, 5
s_branch .Lx19b
.Lx20:
buffer_load_dword v27, v14, s[76:79], 0 offen
s_mov_b32 s76, s98
s_mov_b32 s77, s99
s_mov_b32 s78, s100
v_mov_b32 v14, v15
s_mov_b32 s47, 5
s_branch .Lx20b
.Lx21:
buffer_load_dword v27, v14, s[76:79], 0 offen
s_mov_b32 s76, s98
s_mov_b32 s77, s99
s_mov_b32 s78, s100
v_mov_b32 v14, v15
s_mov_b32 s47, 5
s_branch .Lx21b
.Lx22:
buffer_load_dword v27, v14, s[76:79], 0 offen
s_mov_b32 s76, s98
s_mov_b32 s77, s99
s_mov_b32 s78, s100
v_mov_b32 v14, v15
s_mov_b32 s47, 5
s_branch .Lx22b
.Lsp23:
s_mov_b32 s15, 0
.Lsp23l:
v_mov_b32 v37, 0
buffer_atomic_add v37, v34, s[40:43], 0 offen sc0
s_add_u32 s15, s15, 1
s_cmp_gt_u32 s15, 100000
s_waitcnt vmcnt(0)
s_cbranch_scc1 .Lsp23b
v_cmp_gt_u32 vcc, v35, v37
s_nop 0
s_cbranch_vccnz .Lsp23l
s_branch .Lsp23b
.Lx24:
buffer_load_dword v27, v14, s[76:79], 0 offen
s_mov_b32 s76, s98
s_mov_b32 s77, s99
s_mov_b32 s78, s100
v_mov_b32 v14, v15
s_mov_b32 s47, 5
s_branch .Lx24b
.Lx25:
buffer_load_dword v27, v14, s[76:79], 0 offen
s_mov_b32 s76, s98
s_mov_b32 s77, s99
s_mov_b32 s78, s100
v_mov_b32 v14, v15
s_mov_b32 s47, 5
s_branch .Lx25b
.Lx26:
buffer_load_dword v27, v14, s[76:79], 0 offen
s_mov_b32 s76, s98
s_mov_b32 s77, s99
s_mov_b32 s78, s100
v_mov_b32 v14, v15
s_mov_b32 s47, 5
s_branch .Lx26b
.Lx27:
buffer_load_dword v27, v14, s[76:79], 0 offen
s_mov_b32 s76, s98
s_mov_b32 s77, s99
s_mov_b32 s78, s100
v_mov_b32 v14, v15
s_mov_b32 s47, 5
s_branch .Lx27b
.Lsp28:
s_mov_b32 s15, 0
.Lsp28l:
v_mov_b32 v37, 0
buffer_atomic_add v37, v33, s[16:19], 0 offen sc0
s_add_u32 s15, s15, 1
s_cmp_gt_u32 s15, 100000
s_waitcnt vmcnt(0)
s_cbranch_scc1 .Lsp28b
v_cmp_gt_u32 vcc, v36, v37
s_nop 0
s_cbranch_vccnz .Lsp28l
s_branch .Lsp28b
.Lx29:
buffer_load_dword v27, v14, s[76:79], 0 offen
s_mov_b32 s76, s98
s_mov_b32 s77, s99
s_mov_b32 s78, s100
v_mov_b32 v14, v15
s_mov_b32 s47, 5
s_branch .Lx29b
.Lx30:
buffer_load_dword v27, v14, s[76:79], 0 offen
s_mov_b32 s76, s98
s_mov_b32 s77, s99
s_mov_b32 s78, s100
v_mov_b32 v14, v15
s_mov_b32 s47, 5
s_branch .Lx30b
.Lx31:
buffer_load_dword v27, v14, s[76:79], 0 offen
s_mov_b32 s76, s98
s_mov_b32 s77, s99
s_mov_b32 s78, s100
v_mov_b32 v14, v15
s_mov_b32 s47, 5
s_branch .Lx31b
.Lx32:
buffer_load_dword v27, v14, s[76:79], 0 offen
s_mov_b32 s76, s98
s_mov_b32 s77, s99
s_mov_b32 s78, s100
v_mov_b32 v14, v15
s_mov_b32 s47, 5
s_branch .Lx32b
.p2align 12
.Lqkv1:
.Lpad6:
s_cbranch_execz .Lpad10
s_cmp_lt_u32 s14, 16
s_cselect_b32 s62, 0, 4096
v_mov_b32 v231, 1
v_lshlrev_b32 v232, 8, v1
s_waitcnt vmcnt(18)
v_permlane16_swap_b32 v164, v166
v_permlane16_swap_b32 v165, v167
s_waitcnt vmcnt(17)
v_permlane16_swap_b32 v168, v170
v_permlane16_swap_b32 v169, v171
s_waitcnt vmcnt(16)
v_permlane16_swap_b32 v172, v174
v_permlane16_swap_b32 v173, v175
s_waitcnt vmcnt(15)
v_permlane16_swap_b32 v176, v178
v_permlane16_swap_b32 v177, v179
buffer_atomic_add v231, v232, s[40:43], s62 offen
v_lshlrev_b32 v192, 16, v164
v_and_b32 v193, 0xffff0000, v164
v_lshlrev_b32 v194, 16, v165
v_and_b32 v195, 0xffff0000, v165
v_lshlrev_b32 v196, 16, v166
v_and_b32 v197, 0xffff0000, v166
v_lshlrev_b32 v198, 16, v167
v_and_b32 v199, 0xffff0000, v167
v_lshlrev_b32 v200, 16, v168
v_and_b32 v201, 0xffff0000, v168
v_lshlrev_b32 v202, 16, v169
v_and_b32 v203, 0xffff0000, v169
v_lshlrev_b32 v204, 16, v170
v_and_b32 v205, 0xffff0000, v170
v_lshlrev_b32 v206, 16, v171
v_and_b32 v207, 0xffff0000, v171
v_lshlrev_b32 v208, 16, v172
v_and_b32 v209, 0xffff0000, v172
v_lshlrev_b32 v210, 16, v173
v_and_b32 v211, 0xffff0000, v173
v_lshlrev_b32 v212, 16, v174
v_and_b32 v213, 0xffff0000, v174
v_lshlrev_b32 v214, 16, v175
v_and_b32 v215, 0xffff0000, v175
v_lshlrev_b32 v216, 16, v176
v_and_b32 v217, 0xffff0000, v176
v_lshlrev_b32 v218, 16, v177
v_and_b32 v219, 0xffff0000, v177
v_lshlrev_b32 v220, 16, v178
v_and_b32 v221, 0xffff0000, v178
v_lshlrev_b32 v222, 16, v179
v_and_b32 v223, 0xffff0000, v179
s_lshl_b32 s64, s6, 14
s_lshl_b32 s65, s49, 13
s_add_u32 s64, s64, s65
s_lshl_b32 s65, s7, 9
s_add_u32 s64, s64, s65
s_lshl_b32 s65, s48, 8
s_add_u32 s64, s64, s65
s_add_u32 s64, s64, 29360128
v_and_b32 v188, 31, v1
v_lshlrev_b32 v188, 3, v188
v_lshrrev_b32 v189, 5, v1
v_lshl_add_u32 v188, v189, 28, v188
s_lshl_b32 s62, s7, 18
s_add_u32 s62, s62, 0
s_add_u32 s63, s62, 131072
v_pk_mul_f32 v[182:183], v[192:193], v[192:193]
v_pk_mul_f32 v[186:187], v[208:209], v[208:209]
v_pk_fma_f32 v[182:183], v[194:195], v[194:195], v[182:183]
v_pk_add_f32 v[180:181], v[192:193], v[194:195]
v_pk_fma_f32 v[186:187], v[210:211], v[210:211], v[186:187]
v_pk_add_f32 v[184:185], v[208:209], v[210:211]
v_pk_fma_f32 v[182:183], v[196:197], v[196:197], v[182:183]
v_pk_add_f32 v[180:181], v[180:181], v[196:197]
v_pk_fma_f32 v[186:187], v[212:213], v[212:213], v[186:187]
v_pk_add_f32 v[184:185], v[184:185], v[212:213]
v_pk_fma_f32 v[182:183], v[198:199], v[198:199], v[182:183]
v_pk_add_f32 v[180:181], v[180:181], v[198:199]
v_pk_fma_f32 v[186:187], v[214:215], v[214:215], v[186:187]
v_pk_add_f32 v[184:185], v[184:185], v[214:215]
v_pk_fma_f32 v[182:183], v[200:201], v[200:201], v[182:183]
v_pk_add_f32 v[180:181], v[180:181], v[200:201]
v_pk_fma_f32 v[186:187], v[216:217], v[216:217], v[186:187]
v_pk_add_f32 v[184:185], v[184:185], v[216:217]
v_pk_fma_f32 v[182:183], v[202:203], v[202:203], v[182:183]
v_pk_add_f32 v[180:181], v[180:181], v[202:203]
v_pk_fma_f32 v[186:187], v[218:219], v[218:219], v[186:187]
v_pk_add_f32 v[184:185], v[184:185], v[218:219]
v_pk_fma_f32 v[182:183], v[204:205], v[204:205], v[182:183]
v_pk_add_f32 v[180:181], v[180:181], v[204:205]
v_pk_fma_f32 v[186:187], v[220:221], v[220:221], v[186:187]
v_pk_add_f32 v[184:185], v[184:185], v[220:221]
v_pk_fma_f32 v[182:183], v[206:207], v[206:207], v[182:183]
v_pk_add_f32 v[180:181], v[180:181], v[206:207]
v_pk_fma_f32 v[186:187], v[222:223], v[222:223], v[186:187]
v_pk_add_f32 v[184:185], v[184:185], v[222:223]
v_add_f32 v180, v180, v181
v_add_f32 v182, v182, v183
v_add_f32 v184, v184, v185
v_add_f32 v186, v186, v187
s_nop 0
v_permlane16_swap_b32 v180, v184
v_permlane16_swap_b32 v182, v186
v_add_f32 v180, v180, v184
v_add_f32 v182, v182, v186
s_nop 1
v_permlane32_swap_b32 v180, v182
v_add_f32 v180, v180, v182
s_nop 1
v_permlane32_swap_b32 v180, v181
buffer_store_dwordx2 v[180:181], v188, s[16:19], s64 offen sc1
s_lshl_b32 s62, s2, 10
s_add_u32 s62, s62, 31457280
s_cmp_eq_u32 s3, 0
s_cselect_b32 s62, s62, 268435456
buffer_store_dwordx4 v[224:227], v230, s[16:19], s62 offen sc1
v_accvgpr_write_b32 a224, v192
v_accvgpr_write_b32 a225, v193
v_accvgpr_write_b32 a226, v194
v_accvgpr_write_b32 a227, v195
v_accvgpr_write_b32 a228, v196
v_accvgpr_write_b32 a229, v197
v_accvgpr_write_b32 a230, v198
v_accvgpr_write_b32 a231, v199
v_accvgpr_write_b32 a232, v200
v_accvgpr_write_b32 a233, v201
v_accvgpr_write_b32 a234, v202
v_accvgpr_write_b32 a235, v203
v_accvgpr_write_b32 a236, v204
v_accvgpr_write_b32 a237, v205
v_accvgpr_write_b32 a238, v206
v_accvgpr_write_b32 a239, v207
v_accvgpr_write_b32 a240, v208
v_accvgpr_write_b32 a241, v209
v_accvgpr_write_b32 a242, v210
v_accvgpr_write_b32 a243, v211
v_accvgpr_write_b32 a244, v212
v_accvgpr_write_b32 a245, v213
v_accvgpr_write_b32 a246, v214
v_accvgpr_write_b32 a247, v215
v_accvgpr_write_b32 a248, v216
v_accvgpr_write_b32 a249, v217
v_accvgpr_write_b32 a250, v218
v_accvgpr_write_b32 a251, v219
v_accvgpr_write_b32 a252, v220
v_accvgpr_write_b32 a253, v221
v_accvgpr_write_b32 a254, v222
v_accvgpr_write_b32 a255, v223
s_add_u32 m0, s55, 18496
s_nop 0
buffer_load_dwordx4 v21, s[36:39], s52 offen lds
buffer_load_dwordx4 v28, s[36:39], s52 offen offset:1024 lds
buffer_load_dword v22, s[36:39], s52 offen offset:2048 lds
s_add_u32 s52, s52, 128
s_add_u32 m0, s55, 20800
s_nop 0
buffer_load_dwordx4 v21, s[36:39], s53 offen lds
buffer_load_dwordx4 v28, s[36:39], s53 offen offset:1024 lds
buffer_load_dword v29, s[36:39], s53 offen offset:2048 lds
s_add_u32 s53, s53, 128
s_add_u32 m0, s56, 73984
s_nop 0
buffer_load_dwordx4 v18, s[20:23], s54 offen lds
buffer_load_dwordx4 v19, s[20:23], s54 offen offset:1024 lds
buffer_load_dwordx4 v20, s[20:23], s54 offen offset:2048 lds
s_add_u32 s54, s54, 196608
s_waitcnt vmcnt(12) lgkmcnt(0)
s_barrier
ds_read_b128 a[0:3], v23
RD 4,23,2304
RD 8,23,4608
RD 12,23,6912
ds_read_b128 a[16:19], v24
ds_read_b128 a[20:23], v30
RD 24,30,2304
RD 28,30,4608
RD 32,30,6912
ds_read_b128 a[36:39], v31
TR 80,25,49664
TR 82,25,50176
TR 84,25,62080
TR 86,25,62592
TR 88,25,50688
TR 90,25,51200
TR 92,25,63104
TR 94,25,63616
TR 96,25,51712
TR 98,25,52224
TR 100,25,64128
TR 102,25,64640
s_waitcnt vmcnt(3) lgkmcnt(0)
s_barrier
v_mfma_f32_16x16x32_bf16 v[60:63], a[80:83], a[0:3], 0
TR 104,25,49696
s_add_u32 m0, s56, 86400
MAA 60,84,20
buffer_load_dwordx4 v18, s[20:23], s54 offen lds
v_mfma_f32_16x16x32_bf16 v[64:67], a[80:83], a[4:7], 0
s_sub_u32 s47, s47, 1
s_cbranch_scc1 .Lx19
.Lx19b:
MAA 64,84,24
buffer_load_dwordx4 v19, s[20:23], s54 offen offset:1024 lds
v_mfma_f32_16x16x32_bf16 v[68:71], a[80:83], a[8:11], 0
TR 106,25,50208
MAA 68,84,28
TR 108,25,62112
TR 110,25,62624
TR 112,25,50720
v_mfma_f32_16x16x32_bf16 v[72:75], a[80:83], a[12:15], 0
TR 114,25,51232
MAA 72,84,32
TR 116,25,63136
TR 118,25,63648
v_mfma_f32_16x16x32_bf16 v[104:107], a[88:91], a[12:15], 0
TR 120,25,51744
MAA 104,92,32
buffer_load_dwordx4 v20, s[20:23], s54 offen offset:2048 lds
v_mfma_f32_16x16x32_bf16 v[100:103], a[88:91], a[8:11], 0
s_add_u32 s54, s54, 196608
s_add_u32 m0, s55, 36992
MAA 100,92,28
buffer_load_dwordx4 v21, s[36:39], s52 offen lds
v_mfma_f32_16x16x32_bf16 v[96:99], a[88:91], a[4:7], 0
TR 122,25,52256
MAA 96,92,24
buffer_load_dwordx4 v28, s[36:39], s52 offen offset:1024 lds
v_mfma_f32_16x16x32_bf16 v[92:95], a[88:91], a[0:3], 0
TR 124,25,64160
MAA 92,92,20
buffer_load_dword v22, s[36:39], s52 offen offset:2048 lds
v_mfma_f32_16x16x32_bf16 v[124:127], a[0:3], a[96:99], 0
s_add_u32 s52, s52, 128
s_add_u32 m0, s55, 39296
MAA 124,20,100
buffer_load_dwordx4 v21, s[36:39], s53 offen lds
v_mfma_f32_16x16x32_bf16 v[128:131], a[4:7], a[96:99], 0
TR 126,25,64672
MAA 128,24,100
buffer_load_dwordx4 v28, s[36:39], s53 offen offset:1024 lds
v_mfma_f32_16x16x32_bf16 v[132:135], a[8:11], a[96:99], 0
RD 40,23,18496
MAA 132,28,100
RD 44,23,20800
RD 48,23,23104
RD 52,23,25408
v_mfma_f32_16x16x32_bf16 v[136:139], a[12:15], a[96:99], 0
RD 56,24,18496
MAA 136,32,100
buffer_load_dword v29, s[36:39], s53 offen offset:2048 lds
v_mfma_f32_16x16x32_bf16 v[156:159], a[16:19], a[96:99], 0
s_add_u32 s53, s53, 128
MAA 156,36,100
s_waitcnt vmcnt(6) lgkmcnt(5)
s_barrier
v_mfma_f32_16x16x32_bf16 v[76:79], a[104:107], a[0:3], 0
RD 60,30,18496
s_add_u32 m0, s56, 98816
MAA 76,108,20
buffer_load_dwordx4 v18, s[20:23], s54 offen lds
v_mfma_f32_16x16x32_bf16 v[80:83], a[104:107], a[4:7], 0
RD 64,30,20800
MAA 80,108,24
buffer_load_dwordx4 v19, s[20:23], s54 offen offset:1024 lds
v_mfma_f32_16x16x32_bf16 v[84:87], a[104:107], a[8:11], 0
RD 68,30,23104
MAA 84,108,28
RD 72,30,25408
v_mfma_f32_16x16x32_bf16 v[88:91], a[104:107], a[12:15], 0
RD 76,31,18496
MAA 88,108,32
buffer_load_dwordx4 v20, s[20:23], s54 offen offset:2048 lds
v_mfma_f32_16x16x32_bf16 v[244:247], a[104:107], a[16:19], 0
s_add_u32 s54, s54, 196608
s_add_u32 m0, s56, 111232
MAA 244,108,36
buffer_load_dwordx4 v18, s[20:23], s54 offen lds
v_mfma_f32_16x16x32_bf16 v[120:123], a[112:115], a[12:15], 0
ds_read_b64_tr_b16 a[80:81], v25
MAA 120,116,32
TR 82,25,512
v_mfma_f32_16x16x32_bf16 v[116:119], a[112:115], a[8:11], 0
TR 84,25,12416
MAA 116,116,28
buffer_load_dwordx4 v19, s[20:23], s54 offen offset:1024 lds
v_mfma_f32_16x16x32_bf16 v[112:115], a[112:115], a[4:7], 0
TR 86,25,12928
MAA 112,116,24
buffer_load_dwordx4 v20, s[20:23], s54 offen offset:2048 lds
v_mfma_f32_16x16x32_bf16 v[108:111], a[112:115], a[0:3], 0
TR 88,25,1024
s_add_u32 s54, s54, 196608
MAA 108,116,20
TR 90,25,1536
v_mfma_f32_16x16x32_bf16 v[140:143], a[0:3], a[120:123], 0
TR 92,25,13440
s_add_u32 m0, s55, 55488
MAA 140,20,124
buffer_load_dwordx4 v21, s[36:39], s52 offen lds
v_mfma_f32_16x16x32_bf16 v[144:147], a[4:7], a[120:123], 0
TR 94,25,13952
MAA 144,24,124
buffer_load_dwordx4 v28, s[36:39], s52 offen offset:1024 lds
v_mfma_f32_16x16x32_bf16 v[148:151], a[8:11], a[120:123], 0
TR 96,25,2048
MAA 148,28,124
TR 98,25,2560
v_mfma_f32_16x16x32_bf16 v[152:155], a[12:15], a[120:123], 0
TR 100,25,14464
MAA 152,32,124
buffer_load_dword v22, s[36:39], s52 offen offset:2048 lds
v_mfma_f32_16x16x32_bf16 v[160:163], a[16:19], a[120:123], 0
TR 102,25,14976
s_add_u32 s52, s52, 128
MAA 160,36,124
s_waitcnt vmcnt(9) lgkmcnt(8)
s_barrier
MAA 60,80,40
TR 104,25,32
s_add_u32 m0, s55, 57792
MAA 60,84,60
buffer_load_dwordx4 v21, s[36:39], s53 offen lds
MAA 64,84,64
s_sub_u32 s47, s47, 1
s_cbranch_scc1 .Lx20
.Lx20b:
MAA 64,80,44
buffer_load_dwordx4 v28, s[36:39], s53 offen offset:1024 lds
MAA 68,80,48
TR 106,25,544
MAA 68,84,68
TR 108,25,12448
TR 110,25,12960
TR 112,25,1056
MAA 72,84,72
TR 114,25,1568
MAA 72,80,52
TR 116,25,13472
TR 118,25,13984
s_waitcnt lgkmcnt(8)
MAA 104,88,52
TR 120,25,2080
MAA 104,92,72
buffer_load_dword v29, s[36:39], s53 offen offset:2048 lds
MAA 100,92,68
s_add_u32 s53, s53, 128
s_add_u32 m0, s56, 123648
MAA 100,88,48
buffer_load_dwordx4 v18, s[20:23], s54 offen lds
MAA 96,88,44
TR 122,25,2592
MAA 96,92,64
buffer_load_dwordx4 v19, s[20:23], s54 offen offset:1024 lds
MAA 92,92,60
TR 124,25,14496
MAA 92,88,40
buffer_load_dwordx4 v20, s[20:23], s54 offen offset:2048 lds
MAA 124,40,96
s_add_u32 s54, s54, 196608
s_add_u32 m0, s56, 136064
MAA 124,60,100
buffer_load_dwordx4 v18, s[20:23], s54 offen lds
MAA 128,64,100
TR 126,25,15008
MAA 128,44,96
buffer_load_dwordx4 v19, s[20:23], s54 offen offset:1024 lds
MAA 132,48,96
RD 0,23,36992
MAA 132,68,100
RD 4,23,39296
RD 8,23,41600
RD 12,23,43904
MAA 136,72,100
RD 16,24,36992
MAA 136,52,96
buffer_load_dwordx4 v20, s[20:23], s54 offen offset:2048 lds
MAA 156,56,96
s_add_u32 s54, s54, 196608
MAA 156,76,100
s_waitcnt vmcnt(12) lgkmcnt(5)
s_barrier
MAA 76,104,40
RD 20,30,36992
s_add_u32 m0, s55, 0
MAA 76,108,60
buffer_load_dwordx4 v21, s[36:39], s52 offen lds
MAA 80,108,64
RD 24,30,39296
MAA 80,104,44
buffer_load_dwordx4 v28, s[36:39], s52 offen offset:1024 lds
MAA 84,104,48
RD 28,30,41600
MAA 84,108,68
RD 32,30,43904
RD 36,31,36992
MAA 88,108,72
TR 80,25,24832
MAA 88,104,52
buffer_load_dword v22, s[36:39], s52 offen offset:2048 lds
MAA 244,104,56
s_add_u32 s52, s52, 128
s_add_u32 m0, s55, 2304
MAA 244,108,76
buffer_load_dwordx4 v21, s[36:39], s53 offen lds
MAA 120,116,72
TR 82,25,25344
MAA 120,112,52
buffer_load_dwordx4 v28, s[36:39], s53 offen offset:1024 lds
MAA 116,112,48
TR 84,25,37248
MAA 116,116,68
TR 86,25,37760
TR 88,25,25856
MAA 112,116,64
TR 90,25,26368
MAA 112,112,44
buffer_load_dword v29, s[36:39], s53 offen offset:2048 lds
MAA 108,112,40
s_add_u32 s53, s53, 128
s_add_u32 m0, s56, 73984
MAA 108,116,60
buffer_load_dwordx4 v18, s[20:23], s54 offen lds
MAA 140,60,124
TR 92,25,38272
MAA 140,40,120
buffer_load_dwordx4 v19, s[20:23], s54 offen offset:1024 lds
MAA 144,44,120
TR 94,25,38784
MAA 144,64,124
buffer_load_dwordx4 v20, s[20:23], s54 offen offset:2048 lds
MAA 148,68,124
TR 96,25,26880
s_add_u32 s54, s54, 196608
MAA 148,48,120
TR 98,25,27392
TR 100,25,39296
MAA 152,52,120
TR 102,25,39808
MAA 152,72,124
buffer_load_dword v37, v34, s[40:43], 0 offen sc1
MAA 160,76,124
MAA 160,56,120
s_waitcnt vmcnt(16) lgkmcnt(8)
s_barrier
MAA 60,80,0
TR 104,25,24864
s_add_u32 m0, s56, 86400
MAA 60,84,20
buffer_load_dwordx4 v18, s[20:23], s54 offen lds
MAA 64,84,24
s_sub_u32 s47, s47, 1
s_cbranch_scc1 .Lx21
.Lx21b:
MAA 64,80,4
buffer_load_dwordx4 v19, s[20:23], s54 offen offset:1024 lds
MAA 68,80,8
TR 106,25,25376
MAA 68,84,28
TR 108,25,37280
TR 110,25,37792
TR 112,25,25888
MAA 72,84,32
TR 114,25,26400
MAA 72,80,12
TR 116,25,38304
TR 118,25,38816
s_waitcnt lgkmcnt(8)
MAA 104,88,12
TR 120,25,26912
MAA 104,92,32
buffer_load_dwordx4 v20, s[20:23], s54 offen offset:2048 lds
MAA 100,92,28
s_add_u32 s54, s54, 196608
s_add_u32 m0, s55, 18496
MAA 100,88,8
buffer_load_dwordx4 v21, s[36:39], s52 offen lds
MAA 96,88,4
TR 122,25,27424
MAA 96,92,24
buffer_load_dwordx4 v28, s[36:39], s52 offen offset:1024 lds
MAA 92,92,20
TR 124,25,39328
MAA 92,88,0
buffer_load_dword v22, s[36:39], s52 offen offset:2048 lds
MAA 124,0,96
s_add_u32 s52, s52, 128
s_add_u32 m0, s55, 20800
MAA 124,20,100
buffer_load_dwordx4 v21, s[36:39], s53 offen lds
MAA 128,24,100
TR 126,25,39840
MAA 128,4,96
buffer_load_dwordx4 v28, s[36:39], s53 offen offset:1024 lds
MAA 132,8,96
RD 40,23,55488
MAA 132,28,100
RD 44,23,57792
RD 48,23,60096
RD 52,23,62400
MAA 136,32,100
RD 56,24,55488
MAA 136,12,96
buffer_load_dword v29, s[36:39], s53 offen offset:2048 lds
MAA 156,16,96
s_add_u32 s53, s53, 128
MAA 156,36,100
s_waitcnt vmcnt(19) lgkmcnt(5)
s_barrier
MAA 76,104,0
RD 60,30,55488
s_add_u32 m0, s56, 98816
MAA 76,108,20
buffer_load_dwordx4 v18, s[20:23], s54 offen lds
MAA 80,108,24
RD 64,30,57792
MAA 80,104,4
buffer_load_dwordx4 v19, s[20:23], s54 offen offset:1024 lds
MAA 84,104,8
RD 68,30,60096
MAA 84,108,28
RD 72,30,62400
MAA 88,108,32
RD 76,31,55488
MAA 88,104,12
buffer_load_dwordx4 v20, s[20:23], s54 offen offset:2048 lds
MAA 244,104,16
s_add_u32 s54, s54, 196608
s_add_u32 m0, s55, 36992
MAA 244,108,36
buffer_load_dwordx4 v21, s[36:39], s52 offen lds
MAA 120,116,32
TR 80,25,49664
MAA 120,112,12
TR 82,25,50176
MAA 116,112,8
TR 84,25,62080
MAA 116,116,28
buffer_load_dwordx4 v28, s[36:39], s52 offen offset:1024 lds
MAA 112,116,24
TR 86,25,62592
MAA 112,112,4
buffer_load_dword v22, s[36:39], s52 offen offset:2048 lds
MAA 108,112,0
TR 88,25,50688
s_add_u32 s52, s52, 128
MAA 108,116,20
TR 90,25,51200
MAA 140,20,124
TR 92,25,63104
s_add_u32 m0, s55, 39296
MAA 140,0,120
buffer_load_dwordx4 v21, s[36:39], s53 offen lds
MAA 144,4,120
TR 94,25,63616
MAA 144,24,124
buffer_load_dwordx4 v28, s[36:39], s53 offen offset:1024 lds
MAA 148,28,124
TR 96,25,51712
MAA 148,8,120
.Lpad7:
s_cbranch_execz .Lt0r
TR 98,25,52224
MAA 152,12,120
TR 100,25,64128
MAA 152,32,124
buffer_load_dword v29, s[36:39], s53 offen offset:2048 lds
MAA 160,36,124
TR 102,25,64640
s_add_u32 s53, s53, 128
MAA 160,16,120
s_waitcnt vmcnt(22) lgkmcnt(8)
s_barrier
MAA 60,80,40
TR 104,25,49696
MAA 60,84,60
TR 106,25,50208
MAA 64,84,64
TR 108,25,62112
s_add_u32 m0, s56, 111232
MAA 64,80,44
buffer_load_dwordx4 v18, s[20:23], s54 offen lds
MAA 68,80,48
s_sub_u32 s47, s47, 1
s_cbranch_scc1 .Lx22
.Lx22b:
MAA 68,84,68
TR 110,25,62624
MAA 72,84,72
TR 112,25,50720
MAA 72,80,52
TR 114,25,51232
s_waitcnt lgkmcnt(6)
MAA 104,88,52
TR 116,25,63136
MAA 104,92,72
buffer_load_dwordx4 v19, s[20:23], s54 offen offset:1024 lds
MAA 100,92,68
TR 118,25,63648
MAA 100,88,48
buffer_load_dwordx4 v20, s[20:23], s54 offen offset:2048 lds
MAA 96,88,44
TR 120,25,51744
s_add_u32 s54, s54, 196608
MAA 96,92,64
TR 122,25,52256
MAA 92,92,60
TR 124,25,64160
s_add_u32 m0, s55, 55488
MAA 92,88,40
buffer_load_dwordx4 v21, s[36:39], s52 offen lds
MAA 124,40,96
TR 126,25,64672
MAA 124,60,100
ds_read_b128 a[0:3], v23
MAA 128,64,100
RD 4,23,2304
MAA 128,44,96
buffer_load_dwordx4 v28, s[36:39], s52 offen offset:1024 lds
MAA 132,48,96
RD 8,23,4608
MAA 132,68,100
RD 12,23,6912
MAA 136,72,100
ds_read_b128 a[16:19], v24
MAA 136,52,96
buffer_load_dword v22, s[36:39], s52 offen offset:2048 lds
MAA 156,56,96
s_add_u32 s52, s52, 128
MAA 156,76,100
s_waitcnt vmcnt(21) lgkmcnt(5)
s_barrier
v_cmp_gt_u32 vcc, v35, v37
s_nop 0
s_cbranch_vccnz .Lsp23
.Lsp23b:
v_mov_b32 v37, 0
MAA 76,104,40
ds_read_b128 a[20:23], v30
MAA 76,108,60
buffer_atomic_add v38, v32, s[16:19], 0 offen
MAA 80,108,64
RD 24,30,2304
MAA 80,104,44
RD 28,30,4608
MAA 84,104,48
RD 32,30,6912
s_add_u32 m0, s56, 123648
MAA 84,108,68
buffer_load_dwordx4 v18, s[20:23], s54 offen lds
MAA 88,108,72
ds_read_b128 a[36:39], v31
MAA 88,104,52
ds_read_b64_tr_b16 a[80:81], v25
MAA 244,104,56
TR 82,25,512
MAA 244,108,76
buffer_load_dwordx4 v19, s[20:23], s54 offen offset:1024 lds
MAA 120,116,72
TR 84,25,12416
MAA 120,112,52
TR 86,25,12928
MAA 116,112,48
MAA 116,116,68
buffer_load_dwordx4 v20, s[20:23], s54 offen offset:2048 lds
MAA 112,116,64
s_add_u32 s54, s54, 196608
s_add_u32 m0, s55, 57792
MAA 112,112,44
buffer_load_dwordx4 v21, s[36:39], s53 offen lds
MAA 108,112,40
TR 88,25,1024
MAA 108,116,60
TR 90,25,1536
MAA 140,60,124
TR 92,25,13440
MAA 140,40,120
buffer_load_dwordx4 v28, s[36:39], s53 offen offset:1024 lds
MAA 144,44,120
TR 94,25,13952
MAA 144,64,124
TR 96,25,2048
MAA 148,68,124
TR 98,25,2560
MAA 148,48,120
buffer_load_dword v29, s[36:39], s53 offen offset:2048 lds
MAA 152,52,120
TR 100,25,14464
s_add_u32 s53, s53, 128
MAA 152,72,124
TR 102,25,14976
MAA 160,76,124
MAA 160,56,120
s_waitcnt vmcnt(22) lgkmcnt(8)
s_barrier
MAA 60,80,0
TR 104,25,32
MAA 60,84,20
TR 106,25,544
MAA 64,84,24
TR 108,25,12448
s_add_u32 m0, s56, 136064
MAA 64,80,4
buffer_load_dwordx4 v18, s[20:23], s54 offen lds
MAA 68,80,8
s_sub_u32 s47, s47, 1
s_cbranch_scc1 .Lx24
.Lx24b:
MAA 68,84,28
TR 110,25,12960
MAA 72,84,32
TR 112,25,1056
MAA 72,80,12
TR 114,25,1568
s_waitcnt lgkmcnt(6)
MAA 104,88,12
TR 116,25,13472
MAA 104,92,32
buffer_load_dwordx4 v19, s[20:23], s54 offen offset:1024 lds
MAA 100,92,28
TR 118,25,13984
MAA 100,88,8
buffer_load_dwordx4 v20, s[20:23], s54 offen offset:2048 lds
MAA 96,88,4
TR 120,25,2080
s_add_u32 s54, s54, 196608
MAA 96,92,24
TR 122,25,2592
MAA 92,92,20
TR 124,25,14496
s_add_u32 m0, s55, 0
MAA 92,88,0
buffer_load_dwordx4 v21, s[36:39], s52 offen lds
MAA 124,0,96
TR 126,25,15008
MAA 124,20,100
RD 40,23,18496
MAA 128,24,100
RD 44,23,20800
MAA 128,4,96
buffer_load_dwordx4 v28, s[36:39], s52 offen offset:1024 lds
MAA 132,8,96
RD 48,23,23104
MAA 132,28,100
RD 52,23,25408
MAA 136,32,100
RD 56,24,18496
MAA 136,12,96
buffer_load_dword v22, s[36:39], s52 offen offset:2048 lds
MAA 156,16,96
s_add_u32 s52, s52, 128
MAA 156,36,100
s_waitcnt vmcnt(16) lgkmcnt(5)
s_barrier
MAA 76,104,0
RD 60,30,18496
MAA 76,108,20
RD 64,30,20800
MAA 80,108,24
RD 68,30,23104
s_add_u32 m0, s56, 73984
MAA 80,104,4
buffer_load_dwordx4 v18, s[20:23], s54 offen lds
MAA 84,104,8
RD 72,30,25408
MAA 84,108,28
RD 76,31,18496
MAA 88,108,32
MAA 88,104,12
buffer_load_dwordx4 v19, s[20:23], s54 offen offset:1024 lds
MAA 244,104,16
TR 80,25,24832
MAA 244,108,36
TR 82,25,25344
MAA 120,116,32
TR 84,25,37248
MAA 120,112,12
buffer_load_dwordx4 v20, s[20:23], s54 offen offset:2048 lds
MAA 116,112,8
TR 86,25,37760
s_add_u32 s54, s54, 196608
MAA 116,116,28
MAA 112,116,24
TR 88,25,25856
MAA 112,112,4
TR 90,25,26368
MAA 108,112,0
TR 92,25,38272
s_add_u32 m0, s55, 2304
MAA 108,116,20
buffer_load_dwordx4 v21, s[36:39], s53 offen lds
MAA 140,20,124
TR 94,25,38784
MAA 140,0,120
MAA 144,4,120
TR 96,25,26880
MAA 144,24,124
buffer_load_dwordx4 v28, s[36:39], s53 offen offset:1024 lds
MAA 148,28,124
TR 98,25,27392
MAA 148,8,120
TR 100,25,39296
MAA 152,12,120
TR 102,25,39808
MAA 152,32,124
buffer_load_dword v29, s[36:39], s53 offen offset:2048 lds
MAA 160,36,124
s_add_u32 s53, s53, 128
MAA 160,16,120
s_waitcnt lgkmcnt(8)
s_barrier
MAA 60,80,40
TR 104,25,24864
MAA 60,84,60
TR 106,25,25376
MAA 64,84,64
TR 108,25,37280
s_add_u32 m0, s56, 86400
MAA 64,80,44
buffer_load_dwordx4 v18, s[20:23], s54 offen lds
MAA 68,80,48
s_sub_u32 s47, s47, 1
s_cbranch_scc1 .Lx25
.Lx25b:
MAA 68,84,68
TR 110,25,37792
MAA 72,84,72
TR 112,25,25888
MAA 72,80,52
TR 114,25,26400
s_waitcnt lgkmcnt(6)
MAA 104,88,52
TR 116,25,38304
MAA 104,92,72
buffer_load_dwordx4 v19, s[20:23], s54 offen offset:1024 lds
MAA 100,92,68
TR 118,25,38816
MAA 100,88,48
buffer_load_dwordx4 v20, s[20:23], s54 offen offset:2048 lds
MAA 96,88,44
TR 120,25,26912
s_add_u32 s54, s54, 196608
MAA 96,92,64
TR 122,25,27424
MAA 92,92,60
TR 124,25,39328
s_add_u32 m0, s55, 18496
MAA 92,88,40
buffer_load_dwordx4 v21, s[36:39], s52 offen lds
MAA 124,40,96
TR 126,25,39840
MAA 124,60,100
RD 0,23,36992
MAA 128,64,100
RD 4,23,39296
MAA 128,44,96
buffer_load_dwordx4 v28, s[36:39], s52 offen offset:1024 lds
MAA 132,48,96
RD 8,23,41600
MAA 132,68,100
RD 12,23,43904
MAA 136,72,100
RD 16,24,36992
MAA 136,52,96
buffer_load_dword v22, s[36:39], s52 offen offset:2048 lds
MAA 156,56,96
s_add_u32 s52, s52, 128
MAA 156,76,100
s_waitcnt vmcnt(15) lgkmcnt(5)
s_barrier
MAA 76,104,40
RD 20,30,36992
s_add_u32 m0, s56, 98816
MAA 76,108,60
buffer_load_dwordx4 v18, s[20:23], s54 offen lds
MAA 80,108,64
RD 24,30,39296
MAA 80,104,44
RD 28,30,41600
MAA 84,104,48
RD 32,30,43904
MAA 84,108,68
buffer_load_dwordx4 v19, s[20:23], s54 offen offset:1024 lds
MAA 88,108,72
RD 36,31,36992
MAA 88,104,52
TR 80,25,49664
MAA 244,104,56
MAA 244,108,76
buffer_load_dwordx4 v20, s[20:23], s54 offen offset:2048 lds
MAA 120,116,72
TR 82,25,50176
s_add_u32 s54, s54, 196608
MAA 120,112,52
TR 84,25,62080
MAA 116,112,48
TR 86,25,62592
s_add_u32 m0, s55, 20800
MAA 116,116,68
buffer_load_dwordx4 v21, s[36:39], s53 offen lds
MAA 112,116,64
TR 88,25,50688
MAA 112,112,44
buffer_load_dwordx4 v28, s[36:39], s53 offen offset:1024 lds
MAA 108,112,40
TR 90,25,51200
MAA 108,116,60
TR 92,25,63104
MAA 140,60,124
MAA 140,40,120
buffer_load_dword v29, s[36:39], s53 offen offset:2048 lds
MAA 144,44,120
TR 94,25,63616
s_add_u32 s53, s53, 128
MAA 144,64,124
TR 96,25,51712
MAA 148,68,124
TR 98,25,52224
MAA 148,48,120
buffer_atomic_add v37, v33, s[16:19], 0 offen sc0
MAA 152,52,120
TR 100,25,64128
MAA 152,72,124
TR 102,25,64640
MAA 160,76,124
MAA 160,56,120
s_waitcnt lgkmcnt(8)
s_barrier
MAA 60,80,0
TR 104,25,49696
MAA 60,84,20
TR 106,25,50208
MAA 64,84,24
TR 108,25,62112
s_add_u32 m0, s56, 111232
MAA 64,80,4
buffer_load_dwordx4 v18, s[20:23], s54 offen lds
MAA 68,80,8
s_sub_u32 s47, s47, 1
s_cbranch_scc1 .Lx26
.Lx26b:
MAA 68,84,28
TR 110,25,62624
MAA 72,84,32
TR 112,25,50720
MAA 72,80,12
TR 114,25,51232
s_waitcnt lgkmcnt(6)
MAA 104,88,12
TR 116,25,63136
MAA 104,92,32
buffer_load_dwordx4 v19, s[20:23], s54 offen offset:1024 lds
MAA 100,92,28
TR 118,25,63648
MAA 100,88,8
buffer_load_dwordx4 v20, s[20:23], s54 offen offset:2048 lds
MAA 96,88,4
TR 120,25,51744
s_add_u32 s54, s54, 196608
MAA 96,92,24
TR 122,25,52256
MAA 92,92,20
TR 124,25,64160
s_add_u32 m0, s55, 36992
MAA 92,88,0
buffer_load_dwordx4 v21, s[36:39], s52 offen lds
MAA 124,0,96
TR 126,25,64672
MAA 124,20,100
RD 40,23,55488
MAA 128,24,100
RD 44,23,57792
MAA 128,4,96
buffer_load_dwordx4 v28, s[36:39], s52 offen offset:1024 lds
MAA 132,8,96
RD 48,23,60096
MAA 132,28,100
RD 52,23,62400
MAA 136,32,100
RD 56,24,55488
MAA 136,12,96
buffer_load_dword v22, s[36:39], s52 offen offset:2048 lds
MAA 156,16,96
s_add_u32 s52, s52, 128
MAA 156,36,100
s_waitcnt vmcnt(16) lgkmcnt(5)
s_barrier
MAA 76,104,0
RD 60,30,55488
MAA 76,108,20
RD 64,30,57792
MAA 80,108,24
RD 68,30,60096
s_add_u32 m0, s56, 123648
MAA 80,104,4
buffer_load_dwordx4 v18, s[20:23], s54 offen lds
MAA 84,104,8
RD 72,30,62400
MAA 84,108,28
RD 76,31,55488
MAA 88,108,32
MAA 88,104,12
buffer_load_dwordx4 v19, s[20:23], s54 offen offset:1024 lds
MAA 244,104,16
ds_read_b64_tr_b16 a[80:81], v25
MAA 244,108,36
TR 82,25,512
MAA 120,116,32
TR 84,25,12416
MAA 120,112,12
buffer_load_dwordx4 v20, s[20:23], s54 offen offset:2048 lds
MAA 116,112,8
TR 86,25,12928
s_add_u32 s54, s54, 196608
MAA 116,116,28
MAA 112,116,24
TR 88,25,1024
MAA 112,112,4
TR 90,25,1536
MAA 108,112,0
TR 92,25,13440
s_add_u32 m0, s55, 39296
MAA 108,116,20
buffer_load_dwordx4 v21, s[36:39], s53 offen lds
MAA 140,20,124
TR 94,25,13952
MAA 140,0,120
MAA 144,4,120
TR 96,25,2048
MAA 144,24,124
buffer_load_dwordx4 v28, s[36:39], s53 offen offset:1024 lds
MAA 148,28,124
TR 98,25,2560
MAA 148,8,120
TR 100,25,14464
MAA 152,12,120
TR 102,25,14976
MAA 152,32,124
buffer_load_dword v29, s[36:39], s53 offen offset:2048 lds
MAA 160,36,124
s_add_u32 s53, s53, 128
MAA 160,16,120
s_waitcnt lgkmcnt(8)
s_barrier
MAA 60,80,40
TR 104,25,32
MAA 60,84,60
TR 106,25,544
MAA 64,84,64
TR 108,25,12448
s_add_u32 m0, s56, 136064
MAA 64,80,44
buffer_load_dwordx4 v18, s[20:23], s54 offen lds
MAA 68,80,48
s_sub_u32 s47, s47, 1
s_cbranch_scc1 .Lx27
.Lx27b:
MAA 68,84,68
TR 110,25,12960
MAA 72,84,72
TR 112,25,1056
MAA 72,80,52
TR 114,25,1568
s_waitcnt lgkmcnt(6)
MAA 104,88,52
TR 116,25,13472
MAA 104,92,72
buffer_load_dwordx4 v19, s[20:23], s54 offen offset:1024 lds
MAA 100,92,68
TR 118,25,13984
MAA 100,88,48
buffer_load_dwordx4 v20, s[20:23], s54 offen offset:2048 lds
MAA 96,88,44
TR 120,25,2080
s_add_u32 s54, s54, 196608
MAA 96,92,64
TR 122,25,2592
MAA 92,92,60
TR 124,25,14496
s_add_u32 m0, s55, 55488
MAA 92,88,40
buffer_load_dwordx4 v21, s[36:39], s52 offen lds
MAA 124,40,96
TR 126,25,15008
MAA 124,60,100
ds_read_b128 a[0:3], v23
MAA 128,64,100
RD 4,23,2304
MAA 128,44,96
buffer_load_dwordx4 v28, s[36:39], s52 offen offset:1024 lds
MAA 132,48,96
RD 8,23,4608
MAA 132,68,100
RD 12,23,6912
MAA 136,72,100
ds_read_b128 a[16:19], v24
MAA 136,52,96
buffer_load_dword v22, s[36:39], s52 offen offset:2048 lds
MAA 156,56,96
.Lpad8:
s_cbranch_execz .Lt0r
s_add_u32 s52, s52, 128
MAA 156,76,100
s_waitcnt vmcnt(18)
v_cmp_gt_u32 vcc, v36, v37
s_nop 0
s_cbranch_vccnz .Lsp28
.Lsp28b:
s_waitcnt vmcnt(15) lgkmcnt(5)
s_barrier
MAA 76,104,40
ds_read_b128 a[20:23], v30
s_add_u32 m0, s56, 73984
MAA 76,108,60
buffer_load_dwordx4 v18, s[20:23], s54 offen lds
MAA 80,108,64
RD 24,30,2304
MAA 80,104,44
RD 28,30,4608
MAA 84,104,48
RD 32,30,6912
MAA 84,108,68
buffer_load_dwordx4 v19, s[20:23], s54 offen offset:1024 lds
MAA 88,108,72
ds_read_b128 a[36:39], v31
MAA 88,104,52
TR 80,25,24832
MAA 244,104,56
MAA 244,108,76
buffer_load_dwordx4 v20, s[20:23], s54 offen offset:2048 lds
MAA 120,116,72
TR 82,25,25344
s_add_u32 s54, s54, 196608
MAA 120,112,52
TR 84,25,37248
MAA 116,112,48
TR 86,25,37760
s_add_u32 m0, s55, 57792
MAA 116,116,68
buffer_load_dwordx4 v21, s[36:39], s53 offen lds
MAA 112,116,64
TR 88,25,25856
MAA 112,112,44
buffer_load_dwordx4 v28, s[36:39], s53 offen offset:1024 lds
MAA 108,112,40
TR 90,25,26368
MAA 108,116,60
TR 92,25,38272
MAA 140,60,124
MAA 140,40,120
buffer_load_dword v29, s[36:39], s53 offen offset:2048 lds
MAA 144,44,120
TR 94,25,38784
s_add_u32 s53, s53, 128
MAA 144,64,124
TR 96,25,26880
MAA 148,68,124
TR 98,25,27392
MAA 148,48,120
buffer_load_dwordx4 v[164:167], v26, s[16:19], s75 offen sc1
MAA 152,52,120
TR 100,25,39296
MAA 152,72,124
TR 102,25,39808
MAA 160,76,124
MAA 160,56,120
s_waitcnt lgkmcnt(8)
s_barrier
MAA 60,80,0
TR 104,25,24864
s_add_u32 m0, s56, 86400
MAA 60,84,20
buffer_load_dwordx4 v18, s[20:23], s54 offen lds
MAA 64,84,24
s_sub_u32 s47, s47, 1
s_cbranch_scc1 .Lx29
.Lx29b:
MAA 64,80,4
TR 106,25,25376
TR 108,25,37280
MAA 68,80,8
TR 110,25,37792
MAA 68,84,28
buffer_load_dwordx4 v19, s[20:23], s54 offen offset:1024 lds
MAA 72,84,32
TR 112,25,25888
MAA 72,80,12
TR 114,25,26400
s_waitcnt lgkmcnt(6)
MAA 104,88,12
MAA 104,92,32
buffer_load_dwordx4 v20, s[20:23], s54 offen offset:2048 lds
MAA 100,92,28
s_add_u32 s54, s54, 196608
s_add_u32 m0, s55, 0
MAA 100,88,8
buffer_load_dwordx4 v21, s[36:39], s52 offen lds
MAA 96,88,4
TR 116,25,38304
MAA 96,92,24
TR 118,25,38816
TR 120,25,26912
MAA 92,92,20
TR 122,25,27424
MAA 92,88,0
buffer_load_dwordx4 v28, s[36:39], s52 offen offset:1024 lds
MAA 124,0,96
TR 124,25,39328
MAA 124,20,100
TR 126,25,39840
MAA 128,24,100
RD 40,23,18496
MAA 128,4,96
buffer_load_dword v22, s[36:39], s52 offen offset:2048 lds
MAA 132,8,96
RD 44,23,20800
s_add_u32 s52, s52, 128
MAA 132,28,100
buffer_load_dwordx4 v[168:171], v26, s[16:19], s75 offen offset:1024 sc1
MAA 136,32,100
RD 48,23,23104
MAA 136,12,96
RD 52,23,25408
RD 56,24,18496
MAA 156,16,96
MAA 156,36,100
s_waitcnt vmcnt(17) lgkmcnt(5)
s_barrier
MAA 76,104,0
RD 60,30,18496
s_add_u32 m0, s56, 98816
MAA 76,108,20
buffer_load_dwordx4 v18, s[20:23], s54 offen lds
MAA 80,108,24
RD 64,30,20800
MAA 80,104,4
RD 68,30,23104
MAA 84,104,8
RD 72,30,25408
MAA 84,108,28
buffer_load_dwordx4 v19, s[20:23], s54 offen offset:1024 lds
MAA 88,108,32
RD 76,31,18496
MAA 88,104,12
TR 80,25,49664
MAA 244,104,16
MAA 244,108,36
buffer_load_dwordx4 v20, s[20:23], s54 offen offset:2048 lds
MAA 120,116,32
TR 82,25,50176
s_add_u32 s54, s54, 196608
MAA 120,112,12
TR 84,25,62080
MAA 116,112,8
TR 86,25,62592
s_add_u32 m0, s55, 2304
MAA 116,116,28
buffer_load_dwordx4 v21, s[36:39], s53 offen lds
MAA 112,116,24
TR 88,25,50688
MAA 112,112,4
buffer_load_dwordx4 v28, s[36:39], s53 offen offset:1024 lds
MAA 108,112,0
TR 90,25,51200
MAA 108,116,20
TR 92,25,63104
MAA 140,20,124
MAA 140,0,120
buffer_load_dword v29, s[36:39], s53 offen offset:2048 lds
MAA 144,4,120
TR 94,25,63616
s_add_u32 s53, s53, 128
MAA 144,24,124
TR 96,25,51712
MAA 148,28,124
TR 98,25,52224
MAA 148,8,120
buffer_load_dwordx4 v[172:175], v26, s[16:19], s75 offen offset:2048 sc1
MAA 152,12,120
TR 100,25,64128
MAA 152,32,124
TR 102,25,64640
MAA 160,36,124
MAA 160,16,120
s_waitcnt lgkmcnt(8)
s_barrier
MAA 60,80,40
TR 104,25,49696
s_add_u32 m0, s56, 111232
MAA 60,84,60
buffer_load_dwordx4 v18, s[20:23], s54 offen lds
MAA 64,84,64
s_sub_u32 s47, s47, 1
s_cbranch_scc1 .Lx30
.Lx30b:
MAA 64,80,44
TR 106,25,50208
TR 108,25,62112
MAA 68,80,48
TR 110,25,62624
MAA 68,84,68
buffer_load_dwordx4 v19, s[20:23], s54 offen offset:1024 lds
MAA 72,84,72
TR 112,25,50720
MAA 72,80,52
TR 114,25,51232
s_waitcnt lgkmcnt(6)
MAA 104,88,52
MAA 104,92,72
buffer_load_dwordx4 v20, s[20:23], s54 offen offset:2048 lds
MAA 100,92,68
s_add_u32 s54, s54, 196608
s_add_u32 m0, s55, 18496
MAA 100,88,48
buffer_load_dwordx4 v21, s[36:39], s52 offen lds
MAA 96,88,44
TR 116,25,63136
MAA 96,92,64
TR 118,25,63648
TR 120,25,51744
MAA 92,92,60
TR 122,25,52256
MAA 92,88,40
buffer_load_dwordx4 v28, s[36:39], s52 offen offset:1024 lds
MAA 124,40,96
TR 124,25,64160
MAA 124,60,100
TR 126,25,64672
MAA 128,64,100
RD 0,23,36992
MAA 128,44,96
buffer_load_dword v22, s[36:39], s52 offen offset:2048 lds
MAA 132,48,96
RD 4,23,39296
s_add_u32 s52, s52, 128
MAA 132,68,100
buffer_load_dwordx4 v[176:179], v26, s[16:19], s75 offen offset:3072 sc1
MAA 136,72,100
RD 8,23,41600
s_add_u32 s75, s75, 4096
MAA 136,52,96
RD 12,23,43904
RD 16,24,36992
MAA 156,56,96
MAA 156,76,100
s_waitcnt vmcnt(18) lgkmcnt(5)
s_barrier
MAA 76,104,40
RD 20,30,36992
s_add_u32 m0, s56, 123648
MAA 76,108,60
buffer_load_dwordx4 v18, s[20:23], s54 offen lds
MAA 80,108,64
RD 24,30,39296
s_waitcnt vmcnt(15)
v_add_f32 v164, v164, v168
MAA 80,104,44
RD 28,30,41600
MAA 84,104,48
RD 32,30,43904
MAA 84,108,68
buffer_load_dwordx4 v19, s[20:23], s54 offen offset:1024 lds
MAA 88,108,72
RD 36,31,36992
MAA 88,104,52
ds_read_b64_tr_b16 a[80:81], v25
v_add_f32 v165, v165, v169
MAA 244,104,56
MAA 244,108,76
buffer_load_dwordx4 v20, s[20:23], s54 offen offset:2048 lds
MAA 120,116,72
TR 82,25,512
s_add_u32 s54, s54, 196608
MAA 120,112,52
TR 84,25,12416
MAA 116,112,48
TR 86,25,12928
s_add_u32 m0, s55, 20800
MAA 116,116,68
buffer_load_dwordx4 v21, s[36:39], s53 offen lds
MAA 112,116,64
TR 88,25,1024
MAA 112,112,44
buffer_load_dwordx4 v28, s[36:39], s53 offen offset:1024 lds
MAA 108,112,40
TR 90,25,1536
v_add_f32 v166, v166, v170
MAA 108,116,60
TR 92,25,13440
MAA 140,60,124
MAA 140,40,120
buffer_load_dword v29, s[36:39], s53 offen offset:2048 lds
MAA 144,44,120
TR 94,25,13952
s_add_u32 s53, s53, 128
MAA 144,64,124
TR 96,25,2048
MAA 148,68,124
TR 98,25,2560
v_add_f32 v167, v167, v171
MAA 148,48,120
buffer_load_dwordx4 v[180:183], v26, s[16:19], s75 offen sc1
MAA 152,52,120
TR 100,25,14464
MAA 152,72,124
TR 102,25,14976
MAA 160,76,124
MAA 160,56,120
s_waitcnt lgkmcnt(8)
s_barrier
MAA 60,80,0
TR 104,25,32
s_add_u32 m0, s56, 136064
MAA 60,84,20
buffer_load_dwordx4 v18, s[20:23], s54 offen lds
MAA 64,84,24
s_sub_u32 s47, s47, 1
s_cbranch_scc1 .Lx31
.Lx31b:
MAA 64,80,4
TR 106,25,544
TR 108,25,12448
MAA 68,80,8
TR 110,25,12960
s_waitcnt vmcnt(15)
v_add_f32 v164, v164, v172
MAA 68,84,28
buffer_load_dwordx4 v19, s[20:23], s54 offen offset:1024 lds
MAA 72,84,32
TR 112,25,1056
MAA 72,80,12
TR 114,25,1568
s_waitcnt lgkmcnt(6)
MAA 104,88,12
v_add_f32 v165, v165, v173
MAA 104,92,32
buffer_load_dwordx4 v20, s[20:23], s54 offen offset:2048 lds
MAA 100,92,28
s_add_u32 s54, s54, 196608
s_add_u32 m0, s55, 36992
MAA 100,88,8
buffer_load_dwordx4 v21, s[36:39], s52 offen lds
MAA 96,88,4
TR 116,25,13472
MAA 96,92,24
TR 118,25,13984
TR 120,25,2080
MAA 92,92,20
TR 122,25,2592
v_add_f32 v166, v166, v174
MAA 92,88,0
buffer_load_dwordx4 v28, s[36:39], s52 offen offset:1024 lds
MAA 124,0,96
TR 124,25,14496
MAA 124,20,100
TR 126,25,15008
MAA 128,24,100
RD 40,23,55488
v_add_f32 v167, v167, v175
MAA 128,4,96
buffer_load_dword v22, s[36:39], s52 offen offset:2048 lds
MAA 132,8,96
RD 44,23,57792
s_add_u32 s52, s52, 128
MAA 132,28,100
buffer_load_dwordx4 v[184:187], v26, s[16:19], s75 offen offset:1024 sc1
MAA 136,32,100
RD 48,23,60096
MAA 136,12,96
RD 52,23,62400
RD 56,24,55488
MAA 156,16,96
MAA 156,36,100
s_waitcnt vmcnt(18) lgkmcnt(5)
s_barrier
MAA 76,104,0
RD 60,30,55488
s_waitcnt vmcnt(14)
v_add_f32 v164, v164, v176
MAA 76,108,20
RD 64,30,57792
s_add_u32 m0, s56, 73984
MAA 80,108,24
buffer_load_dwordx4 v18, s[20:23], s54 offen lds
MAA 80,104,4
RD 68,30,60096
v_add_f32 v165, v165, v177
MAA 84,104,8
RD 72,30,62400
v_add_f32 v166, v166, v178
MAA 84,108,28
buffer_load_dwordx4 v19, s[20:23], s54 offen offset:1024 lds
MAA 88,108,32
RD 76,31,55488
v_add_f32 v167, v167, v179
MAA 88,104,12
TR 80,25,24832
MAA 244,104,16
buffer_load_dwordx4 v20, s[20:23], s54 offen offset:2048 lds
MAA 244,108,36
TR 82,25,25344
s_add_u32 s54, s54, 196608
MAA 120,116,32
TR 84,25,37248
s_add_u32 m0, s55, 39296
MAA 120,112,12
buffer_load_dwordx4 v21, s[36:39], s53 offen lds
MAA 116,112,8
TR 86,25,37760
MAA 116,116,28
TR 88,25,25856
MAA 112,116,24
buffer_load_dwordx4 v28, s[36:39], s53 offen offset:1024 lds
MAA 112,112,4
TR 90,25,26368
MAA 108,112,0
TR 92,25,38272
MAA 108,116,20
buffer_load_dword v29, s[36:39], s53 offen offset:2048 lds
MAA 140,20,124
TR 94,25,38784
s_add_u32 s53, s53, 128
MAA 140,0,120
TR 96,25,26880
MAA 144,4,120
buffer_load_dwordx4 v[188:191], v26, s[16:19], s75 offen offset:2048 sc1
MAA 144,24,124
TR 98,25,27392
MAA 148,28,124
TR 100,25,39296
MAA 148,8,120
TR 102,25,39808
MAA 152,12,120
MAA 152,32,124
MAA 160,36,124
MAA 160,16,120
s_waitcnt lgkmcnt(8)
s_barrier
MAA 60,80,40
TR 104,25,24864
s_add_u32 m0, s56, 86400
MAA 60,84,60
buffer_load_dwordx4 v18, s[20:23], s54 offen lds
MAA 64,84,64
s_sub_u32 s47, s47, 1
s_cbranch_scc1 .Lx32
.Lx32b:
MAA 64,80,44
TR 106,25,25376
TR 108,25,37280
MAA 68,80,48
TR 110,25,37792
s_waitcnt vmcnt(15)
v_add_f32 v164, v164, v180
MAA 68,84,68
buffer_load_dwordx4 v19, s[20:23], s54 offen offset:1024 lds
MAA 72,84,72
TR 112,25,25888
MAA 72,80,52
TR 114,25,26400
s_waitcnt lgkmcnt(6)
MAA 104,88,52
v_add_f32 v165, v165, v181
MAA 104,92,72
buffer_load_dwordx4 v20, s[20:23], s54 offen offset:2048 lds
MAA 100,92,68
s_add_u32 s54, s54, 196608
s_add_u32 m0, s55, 55488
MAA 100,88,48
buffer_load_dwordx4 v21, s[36:39], s52 offen lds
MAA 96,88,44
TR 116,25,38304
MAA 96,92,64
TR 118,25,38816
TR 120,25,26912
MAA 92,92,60
TR 122,25,27424
v_add_f32 v166, v166, v182
MAA 92,88,40
buffer_load_dwordx4 v28, s[36:39], s52 offen offset:1024 lds
MAA 124,40,96
TR 124,25,39328
MAA 124,60,100
TR 126,25,39840
MAA 128,64,100
ds_read_b128 a[0:3], v23
v_add_f32 v167, v167, v183
MAA 128,44,96
buffer_load_dword v22, s[36:39], s52 offen offset:2048 lds
MAA 132,48,96
RD 4,23,2304
s_add_u32 s52, s52, 128
MAA 132,68,100
buffer_load_dwordx4 v[192:195], v26, s[16:19], s75 offen offset:3072 sc1
MAA 136,72,100
RD 8,23,4608
MAA 136,52,96
RD 12,23,6912
ds_read_b128 a[16:19], v24
MAA 156,56,96
MAA 156,76,100
s_waitcnt vmcnt(18) lgkmcnt(5)
s_barrier
MAA 76,104,40
ds_read_b128 a[20:23], v30
s_waitcnt vmcnt(14)
v_add_f32 v164, v164, v184
MAA 76,108,60
RD 24,30,2304
s_add_u32 m0, s56, 98816
MAA 80,108,64
buffer_load_dwordx4 v18, s[20:23], s54 offen lds
MAA 80,104,44
RD 28,30,4608
v_add_f32 v165, v165, v185
MAA 84,104,48
RD 32,30,6912
v_add_f32 v166, v166, v186
MAA 84,108,68
ds_read_b128 a[36:39], v31
v_add_f32 v167, v167, v187
MAA 88,108,72
buffer_load_dwordx4 v19, s[20:23], s54 offen offset:1024 lds
MAA 88,104,52
TR 80,25,49664
MAA 244,104,56
TR 82,25,50176
MAA 244,108,76
TR 84,25,62080
MAA 120,116,72
buffer_load_dwordx4 v20, s[20:23], s54 offen offset:2048 lds
MAA 120,112,52
TR 86,25,62592
s_add_u32 s54, s54, 196608
MAA 116,112,48
TR 88,25,50688
s_add_u32 m0, s55, 57792
MAA 116,116,68
TR 90,25,51200
MAA 112,116,64
buffer_load_dwordx4 v21, s[36:39], s53 offen lds
MAA 112,112,44
TR 92,25,63104
MAA 108,112,40
TR 94,25,63616
MAA 108,116,60
TR 96,25,51712
.Lpad9:
s_cbranch_execz .Lt0r
MAA 140,60,124
buffer_load_dwordx4 v28, s[36:39], s53 offen offset:1024 lds
MAA 140,40,120
TR 98,25,52224
MAA 144,44,120
TR 100,25,64128
MAA 144,64,124
TR 102,25,64640
MAA 148,68,124
buffer_load_dword v29, s[36:39], s53 offen offset:2048 lds
MAA 148,48,120
s_add_u32 s53, s53, 128
MAA 152,52,120
MAA 152,72,124
MAA 160,76,124
MAA 160,56,120
s_waitcnt lgkmcnt(8)
s_barrier
MAA 60,80,0
TR 104,25,49696
s_waitcnt vmcnt(13)
v_add_f32 v164, v164, v188
MAA 60,84,20
TR 106,25,50208
s_add_u32 m0, s56, 111232
MAA 64,84,24
buffer_load_dwordx4 v18, s[20:23], s54 offen lds
MAA 64,80,4
TR 108,25,62112
v_add_f32 v165, v165, v189
MAA 68,80,8
TR 110,25,62624
v_add_f32 v166, v166, v190
MAA 68,84,28
buffer_load_dwordx4 v19, s[20:23], s54 offen offset:1024 lds
MAA 72,84,32
TR 112,25,50720
v_add_f32 v167, v167, v191
MAA 72,80,12
TR 114,25,51232
s_waitcnt lgkmcnt(6)
MAA 104,88,12
buffer_load_dwordx4 v20, s[20:23], s54 offen offset:2048 lds
MAA 104,92,32
TR 116,25,63136
s_add_u32 s54, s54, 196608
MAA 100,92,28
TR 118,25,63648
s_add_u32 m0, s59, 0
MAA 100,88,8
TR 120,25,51744
s_xor_b32 s58, s87, 1048576
MAA 96,88,4
buffer_load_dwordx4 v5, s[24:27], s58 offen lds
MAA 96,92,24
TR 122,25,52256
MAA 92,92,20
TR 124,25,64160
MAA 92,88,0
buffer_load_dwordx4 v6, s[24:27], s58 offen offset:1024 lds
MAA 124,0,96
TR 126,25,64672
s_add_u32 m0, s59, 8320
MAA 124,20,100
RD 40,23,18496
s_xor_b32 s58, s87, 1179648
MAA 128,24,100
buffer_load_dwordx4 v5, s[24:27], s58 offen lds
MAA 128,4,96
RD 44,23,20800
MAA 132,8,96
RD 48,23,23104
MAA 132,28,100
buffer_load_dwordx4 v6, s[24:27], s58 offen offset:1024 lds
MAA 136,32,100
RD 52,23,25408
MAA 136,12,96
RD 56,24,18496
MAA 156,16,96
MAA 156,36,100
s_waitcnt vmcnt(17) lgkmcnt(5)
s_barrier
MAA 76,104,0
RD 60,30,18496
s_waitcnt vmcnt(13)
v_add_f32 v164, v164, v192
MAA 76,108,20
RD 64,30,20800
s_add_u32 m0, s56, 123648
MAA 80,108,24
buffer_load_dwordx4 v18, s[20:23], s54 offen lds
MAA 80,104,4
RD 68,30,23104
v_add_f32 v165, v165, v193
MAA 84,104,8
RD 72,30,25408
v_add_f32 v166, v166, v194
MAA 84,108,28
RD 76,31,18496
v_add_f32 v167, v167, v195
MAA 88,108,32
ds_read_b64_tr_b16 a[80:81], v25
MAA 88,104,12
TR 82,25,512
MAA 244,104,16
TR 84,25,12416
MAA 244,108,36
TR 86,25,12928
MAA 120,116,32
buffer_load_dwordx4 v19, s[20:23], s54 offen offset:1024 lds
MAA 120,112,12
TR 88,25,1024
MAA 116,112,8
TR 90,25,1536
MAA 116,116,28
TR 92,25,13440
MAA 112,116,24
TR 94,25,13952
MAA 112,112,4
TR 96,25,2048
MAA 108,112,0
TR 98,25,2560
MAA 108,116,20
TR 100,25,14464
MAA 140,20,124
buffer_load_dwordx4 v20, s[20:23], s54 offen offset:2048 lds
MAA 140,0,120
TR 102,25,14976
s_add_u32 s54, s54, 196608
MAA 144,4,120
MAA 144,24,124
MAA 148,28,124
MAA 148,8,120
MAA 152,12,120
MAA 152,32,124
MAA 160,36,124
MAA 160,16,120
s_waitcnt lgkmcnt(8)
s_barrier
MAA 60,80,40
TR 104,25,32
MAA 60,84,60
TR 106,25,544
s_add_u32 m0, s56, 136064
MAA 64,84,64
buffer_load_dwordx4 v18, s[20:23], s54 offen lds
MAA 64,80,44
TR 108,25,12448
MAA 68,80,48
TR 110,25,12960
MAA 68,84,68
buffer_load_dwordx4 v19, s[20:23], s54 offen offset:1024 lds
MAA 72,84,72
TR 112,25,1056
MAA 72,80,52
TR 114,25,1568
s_waitcnt lgkmcnt(6)
MAA 104,88,52
buffer_load_dwordx4 v20, s[20:23], s54 offen offset:2048 lds
MAA 104,92,72
TR 116,25,13472
s_add_u32 s54, s54, 196608
MAA 100,92,68
TR 118,25,13984
s_add_u32 m0, s59, 16640
MAA 100,88,48
TR 120,25,2080
s_xor_b32 s58, s87, 1310720
MAA 96,88,44
buffer_load_dwordx4 v5, s[24:27], s58 offen lds
MAA 96,92,64
TR 122,25,2592
MAA 92,92,60
TR 124,25,14496
MAA 92,88,40
buffer_load_dwordx4 v6, s[24:27], s58 offen offset:1024 lds
MAA 124,40,96
TR 126,25,15008
s_add_u32 m0, s59, 24960
MAA 124,60,100
RD 0,23,36992
s_xor_b32 s58, s87, 1441792
MAA 128,64,100
buffer_load_dwordx4 v5, s[24:27], s58 offen lds
MAA 128,44,96
RD 4,23,39296
MAA 132,48,96
RD 8,23,41600
MAA 132,68,100
buffer_load_dwordx4 v6, s[24:27], s58 offen offset:1024 lds
MAA 136,72,100
RD 12,23,43904
MAA 136,52,96
RD 16,24,36992
MAA 156,56,96
v_permlane32_swap_b32 v164, v166
MAA 156,76,100
v_permlane32_swap_b32 v165, v167
v_add_f32 v164, v164, v166
v_add_f32 v165, v165, v167
v_mul_f32 v164, 0xba800000, v164
v_mul_f32 v165, 0x3a800000, v165
v_fma_f32 v165, -v164, v164, v165
v_max_f32 v165, 0, v165
v_add_f32 v165, 0x3727c5ac, v165
v_rsq_f32 v166, v165
s_nop 0
v_mov_b32 v165, v166
v_mul_f32 v166, 0x3e8293ee, v166
s_waitcnt vmcnt(14) lgkmcnt(5)
s_barrier
MAA 76,104,40
ds_write_b128 v7, v[164:167]
MAA 76,108,60
ds_write_b32 v17, v164
s_add_u32 m0, s59, 74880
MAA 80,108,64
ds_write_b32 v17, v165 offset:1024
s_xor_b32 s58, s87, 131072
MAA 80,104,44
buffer_load_dwordx4 v5, s[24:27], s58 offen lds
MAA 84,104,48
RD 20,30,36992
MAA 84,108,68
RD 24,30,39296
MAA 88,108,72
RD 28,30,41600
MAA 88,104,52
RD 32,30,43904
MAA 244,104,56
RD 36,31,36992
MAA 244,108,76
buffer_load_dwordx4 v6, s[24:27], s58 offen offset:1024 lds
MAA 120,116,72
TR 80,25,24832
s_add_u32 m0, s59, 83200
MAA 120,112,52
TR 82,25,25344
s_xor_b32 s58, s87, 262144
MAA 116,112,48
TR 84,25,37248
MAA 116,116,68
TR 86,25,37760
MAA 112,116,64
TR 88,25,25856
MAA 112,112,44
buffer_load_dwordx4 v5, s[24:27], s58 offen lds
MAA 108,112,40
TR 90,25,26368
MAA 108,116,60
TR 92,25,38272
MAA 140,60,124
TR 94,25,38784
MAA 140,40,120
TR 96,25,26880
MAA 144,44,120
TR 98,25,27392
MAA 144,64,124
buffer_load_dwordx4 v6, s[24:27], s58 offen offset:1024 lds
MAA 148,68,124
TR 100,25,39296
MAA 148,48,120
TR 102,25,39808
MAA 152,52,120
MAA 152,72,124
MAA 160,76,124
MAA 160,56,120
s_waitcnt vmcnt(8) lgkmcnt(0)
s_barrier
MAA 104,88,12
TR 112,25,25888
s_add_u32 m0, s59, 33280
MAA 104,92,32
TR 114,25,26400
s_xor_b32 s58, s87, 1572864
MAA 100,92,28
buffer_load_dwordx4 v5, s[24:27], s58 offen lds
MAA 100,88,8
TR 116,25,38304
MAA 96,88,4
TR 118,25,38816
MAA 96,92,24
TR 120,25,26912
MAA 92,92,20
buffer_load_dwordx4 v6, s[24:27], s58 offen offset:1024 lds
MAA 92,88,0
TR 122,25,27424
s_add_u32 m0, s59, 41600
MAA 156,16,96
TR 124,25,39328
s_xor_b32 s58, s87, 1703936
MAA 156,36,100
TR 126,25,39840
MAA 72,84,32
buffer_load_dwordx4 v5, s[24:27], s58 offen lds
MAA 72,80,12
TR 104,25,24864
MAA 68,80,8
TR 106,25,25376
MAA 68,84,28
TR 108,25,37280
MAA 64,84,24
buffer_load_dwordx4 v6, s[24:27], s58 offen offset:1024 lds
MAA 64,80,4
TR 110,25,37792
s_xor_b32 s58, s87, 393216
MAA 60,80,0
RD 40,23,55488
MAA 60,84,20
RD 44,23,57792
s_waitcnt lgkmcnt(12)
MAA 120,112,12
RD 48,23,60096
s_waitcnt lgkmcnt(11)
MAA 120,116,32
RD 52,23,62400
MAA 116,116,28
RD 56,24,55488
MAA 116,112,8
RD 60,30,55488
MAA 112,112,4
RD 64,30,57792
MAA 112,116,24
s_waitcnt lgkmcnt(7)
s_barrier
RD 68,30,60096
MAA 108,116,20
RD 72,30,62400
s_add_u32 m0, s59, 91520
MAA 108,112,0
RD 76,31,55488
MAA 160,16,120
TR 144,25,50688
MAA 160,36,124
TR 146,25,51200
MAA 244,108,36
TR 148,25,63104
MAA 244,104,16
TR 150,25,63616
MAA 88,104,12
TR 152,25,50720
MAA 88,108,32
TR 154,25,51232
MAA 84,108,28
TR 156,25,63136
MAA 84,104,8
TR 158,25,63648
MAA 80,104,4
TR 160,25,51712
MAA 80,108,24
TR 162,25,52224
MAA 76,108,20
TR 164,25,64128
MAA 76,104,0
TR 166,25,64640
s_waitcnt lgkmcnt(10)
MAA 104,144,52
TR 168,25,51744
s_waitcnt lgkmcnt(9)
MAA 104,148,72
TR 170,25,52256
MAA 100,148,68
TR 172,25,64160
MAA 100,144,48
TR 174,25,64672
MAA 96,144,44
TR 136,25,49696
MAA 96,148,64
TR 138,25,50208
MAA 92,148,60
TR 140,25,62112
MAA 92,144,40
TR 142,25,62624
s_waitcnt lgkmcnt(14)
MAA 120,152,52
TR 128,25,49664
s_waitcnt lgkmcnt(13)
MAA 120,156,72
TR 130,25,50176
MAA 116,156,68
TR 132,25,62080
MAA 116,152,48
TR 134,25,62592
MAA 112,152,44
ds_read_b128 v[232:235], v10 offset:1792
MAA 112,156,64
ds_read_b128 v[228:231], v10 offset:1536
MAA 108,156,60
ds_read_b128 v[224:227], v10 offset:1280
MAA 108,152,40
ds_read_b128 v[220:223], v10 offset:1024
s_waitcnt lgkmcnt(15)
MAA 156,56,160
buffer_load_dwordx4 v5, s[24:27], s58 offen lds
MAA 156,76,164
s_waitcnt lgkmcnt(12)
MAA 160,76,172
MAA 160,56,168
s_waitcnt lgkmcnt(4)
s_barrier
MAA 244,136,56
buffer_load_dwordx4 v6, s[24:27], s58 offen offset:1024 lds
MAA 244,140,76
s_add_u32 m0, s59, 99840
s_xor_b32 s58, s87, 524288
MAA 88,140,72
MAA 88,136,52
MAA 84,136,48
buffer_load_dwordx4 v5, s[24:27], s58 offen lds
MAA 84,140,68
buffer_load_dwordx4 v6, s[24:27], s58 offen offset:1024 lds
s_add_u32 m0, s59, 108160
s_xor_b32 s58, s87, 655360
buffer_load_dwordx4 v5, s[24:27], s58 offen lds
buffer_load_dwordx4 v6, s[24:27], s58 offen offset:1024 lds
s_mov_b32 exec_lo, 0x10001
s_mov_b32 exec_hi, 0x10001
ds_write_b128 v13, v[244:247] offset:64
s_mov_b64 exec, 0xffff
ds_write_b32 v12, v156 offset:512
ds_write_b32 v12, v160 offset:576
s_mov_b64 exec, -1
MAA 80,136,44
MAA 80,140,64
MAA 76,140,60
MAA 76,136,40
MAA 72,128,52
MAA 72,132,72
s_waitcnt lgkmcnt(0)
s_barrier
MAA 68,128,48
ds_read_b128 v[28:31], v13
s_add_u32 m0, s59, 49920
MAA 68,132,68
ds_read_b128 v[32:35], v13 offset:64
s_xor_b32 s58, s87, 1835008
MAA 64,132,64
ds_read_b128 v[36:39], v13 offset:256
MAA 64,128,44
ds_read_b128 v[40:43], v13 offset:320
MAA 60,128,40
ds_read_b32 v44, v12 offset:512
MAA 60,132,60
ds_read_b32 v45, v12 offset:576
ds_read_b128 v[240:243], v11 offset:704
ds_read_b128 v[244:247], v11 offset:1728
ds_read_b128 v[18:21], v11 offset:448
ds_read_b128 v[22:25], v11 offset:1472
buffer_load_dwordx4 v5, s[24:27], s58 offen lds
s_waitcnt lgkmcnt(9)
v_pk_fma_f32 v[72:73], v[28:29], v[232:233], v[72:73] op_sel_hi:[1,0,1]
v_cvt_pk_bf16_f32 v176, v72, v73
v_pk_fma_f32 v[74:75], v[30:31], v[232:233], v[74:75] op_sel_hi:[1,0,1]
v_cvt_pk_bf16_f32 v177, v74, v75
s_waitcnt lgkmcnt(8)
v_pk_fma_f32 v[88:89], v[32:33], v[232:233], v[88:89] op_sel_hi:[1,0,1]
v_cvt_pk_bf16_f32 v178, v88, v89
v_pk_fma_f32 v[90:91], v[34:35], v[232:233], v[90:91] op_sel_hi:[1,0,1]
s_waitcnt lgkmcnt(7)
v_pk_fma_f32 v[104:105], v[36:37], v[232:233], v[104:105] op_sel_hi:[1,0,1]
v_pk_mul_f32 v[104:105], v[104:105], v[232:233] op_sel:[0,1] op_sel_hi:[1,1]
v_cvt_pk_bf16_f32 v196, v104, v105
v_pk_fma_f32 v[106:107], v[38:39], v[232:233], v[106:107] op_sel_hi:[1,0,1]
v_pk_mul_f32 v[106:107], v[106:107], v[232:233] op_sel:[0,1] op_sel_hi:[1,1]
v_cvt_pk_bf16_f32 v197, v106, v107
s_waitcnt lgkmcnt(6)
v_pk_fma_f32 v[120:121], v[40:41], v[232:233], v[120:121] op_sel_hi:[1,0,1]
v_pk_mul_f32 v[120:121], v[120:121], v[232:233] op_sel:[0,1] op_sel_hi:[1,1]
v_cvt_pk_bf16_f32 v198, v120, v121
v_pk_fma_f32 v[122:123], v[42:43], v[232:233], v[122:123] op_sel_hi:[1,0,1]
v_pk_mul_f32 v[122:123], v[122:123], v[232:233] op_sel:[0,1] op_sel_hi:[1,1]
v_cvt_pk_bf16_f32 v199, v122, v123
v_pk_fma_f32 v[100:101], v[36:37], v[228:229], v[100:101] op_sel_hi:[1,0,1]
v_pk_mul_f32 v[100:101], v[100:101], v[228:229] op_sel:[0,1] op_sel_hi:[1,1]
s_waitcnt lgkmcnt(3)
v_pk_fma_f32 v[156:157], v[240:241], v[44:45], v[156:157] op_sel_hi:[1,0,1]
v_pk_fma_f32 v[158:159], v[242:243], v[44:45], v[158:159] op_sel_hi:[1,0,1]
s_waitcnt lgkmcnt(2)
v_pk_mul_f32 v[156:157], v[156:157], v[244:245]
v_cvt_pk_bf16_f32 v236, v156, v157
v_pk_mul_f32 v[158:159], v[158:159], v[246:247]
v_cvt_pk_bf16_f32 v237, v158, v159
v_pk_fma_f32 v[160:161], v[240:241], v[44:45], v[160:161] op_sel:[0,1,0] op_sel_hi:[1,1,1]
v_pk_mul_f32 v[160:161], v[160:161], v[244:245]
v_cvt_pk_bf16_f32 v238, v160, v161
v_pk_fma_f32 v[162:163], v[242:243], v[44:45], v[162:163] op_sel:[0,1,0] op_sel_hi:[1,1,1]
v_pk_mul_f32 v[162:163], v[162:163], v[246:247]
v_cvt_pk_bf16_f32 v239, v162, v163
ds_write_b128 v8, v[236:239] offset:1024
v_cvt_pk_bf16_f32 v192, v100, v101
v_pk_fma_f32 v[102:103], v[38:39], v[228:229], v[102:103] op_sel_hi:[1,0,1]
v_pk_mul_f32 v[102:103], v[102:103], v[228:229] op_sel:[0,1] op_sel_hi:[1,1]
v_cvt_pk_bf16_f32 v193, v102, v103
v_pk_fma_f32 v[116:117], v[40:41], v[228:229], v[116:117] op_sel_hi:[1,0,1]
v_pk_mul_f32 v[116:117], v[116:117], v[228:229] op_sel:[0,1] op_sel_hi:[1,1]
v_cvt_pk_bf16_f32 v194, v116, v117
v_pk_fma_f32 v[118:119], v[42:43], v[228:229], v[118:119] op_sel_hi:[1,0,1]
v_pk_mul_f32 v[118:119], v[118:119], v[228:229] op_sel:[0,1] op_sel_hi:[1,1]
v_cvt_pk_bf16_f32 v195, v118, v119
v_pk_fma_f32 v[96:97], v[36:37], v[224:225], v[96:97] op_sel_hi:[1,0,1]
v_pk_mul_f32 v[96:97], v[96:97], v[224:225] op_sel:[0,1] op_sel_hi:[1,1]
v_cvt_pk_bf16_f32 v188, v96, v97
v_pk_fma_f32 v[98:99], v[38:39], v[224:225], v[98:99] op_sel_hi:[1,0,1]
v_pk_mul_f32 v[98:99], v[98:99], v[224:225] op_sel:[0,1] op_sel_hi:[1,1]
v_cvt_pk_bf16_f32 v189, v98, v99
v_pk_fma_f32 v[112:113], v[40:41], v[224:225], v[112:113] op_sel_hi:[1,0,1]
v_pk_mul_f32 v[112:113], v[112:113], v[224:225] op_sel:[0,1] op_sel_hi:[1,1]
v_cvt_pk_bf16_f32 v190, v112, v113
v_pk_fma_f32 v[114:115], v[42:43], v[224:225], v[114:115] op_sel_hi:[1,0,1]
v_pk_mul_f32 v[114:115], v[114:115], v[224:225] op_sel:[0,1] op_sel_hi:[1,1]
v_cvt_pk_bf16_f32 v191, v114, v115
v_pk_fma_f32 v[92:93], v[36:37], v[220:221], v[92:93] op_sel_hi:[1,0,1]
v_pk_mul_f32 v[92:93], v[92:93], v[220:221] op_sel:[0,1] op_sel_hi:[1,1]
v_cvt_pk_bf16_f32 v184, v92, v93
v_pk_fma_f32 v[94:95], v[38:39], v[220:221], v[94:95] op_sel_hi:[1,0,1]
v_pk_mul_f32 v[94:95], v[94:95], v[220:221] op_sel:[0,1] op_sel_hi:[1,1]
v_cvt_pk_bf16_f32 v185, v94, v95
v_pk_fma_f32 v[108:109], v[40:41], v[220:221], v[108:109] op_sel_hi:[1,0,1]
v_pk_mul_f32 v[108:109], v[108:109], v[220:221] op_sel:[0,1] op_sel_hi:[1,1]
v_cvt_pk_bf16_f32 v186, v108, v109
v_pk_fma_f32 v[110:111], v[42:43], v[220:221], v[110:111] op_sel_hi:[1,0,1]
v_pk_mul_f32 v[110:111], v[110:111], v[220:221] op_sel:[0,1] op_sel_hi:[1,1]
v_cvt_pk_bf16_f32 v187, v110, v111
v_cvt_pk_bf16_f32 v179, v90, v91
v_pk_fma_f32 v[68:69], v[28:29], v[228:229], v[68:69] op_sel_hi:[1,0,1]
v_cvt_pk_bf16_f32 v172, v68, v69
v_pk_fma_f32 v[70:71], v[30:31], v[228:229], v[70:71] op_sel_hi:[1,0,1]
v_cvt_pk_bf16_f32 v173, v70, v71
v_pk_fma_f32 v[84:85], v[32:33], v[228:229], v[84:85] op_sel_hi:[1,0,1]
v_cvt_pk_bf16_f32 v174, v84, v85
v_pk_fma_f32 v[86:87], v[34:35], v[228:229], v[86:87] op_sel_hi:[1,0,1]
v_cvt_pk_bf16_f32 v175, v86, v87
v_pk_fma_f32 v[64:65], v[28:29], v[224:225], v[64:65] op_sel_hi:[1,0,1]
v_cvt_pk_bf16_f32 v168, v64, v65
v_pk_fma_f32 v[66:67], v[30:31], v[224:225], v[66:67] op_sel_hi:[1,0,1]
v_cvt_pk_bf16_f32 v169, v66, v67
v_pk_fma_f32 v[80:81], v[32:33], v[224:225], v[80:81] op_sel_hi:[1,0,1]
v_cvt_pk_bf16_f32 v170, v80, v81
.Lpad10:
s_cbranch_execz .Lt0r
v_pk_fma_f32 v[82:83], v[34:35], v[224:225], v[82:83] op_sel_hi:[1,0,1]
v_cvt_pk_bf16_f32 v171, v82, v83
v_pk_fma_f32 v[60:61], v[28:29], v[220:221], v[60:61] op_sel_hi:[1,0,1]
v_cvt_pk_bf16_f32 v164, v60, v61
v_pk_fma_f32 v[62:63], v[30:31], v[220:221], v[62:63] op_sel_hi:[1,0,1]
v_cvt_pk_bf16_f32 v165, v62, v63
v_pk_fma_f32 v[76:77], v[32:33], v[220:221], v[76:77] op_sel_hi:[1,0,1]
v_cvt_pk_bf16_f32 v166, v76, v77
v_pk_fma_f32 v[78:79], v[34:35], v[220:221], v[78:79] op_sel_hi:[1,0,1]
s_waitcnt lgkmcnt(0)
s_barrier
v_cvt_pk_bf16_f32 v167, v78, v79
v_mfma_f32_16x16x32_bf16 v[120:123], v[196:199], v[176:179], v[50:53]
ds_read_b128 v[180:183], v9
v_mfma_f32_16x16x32_bf16 v[104:107], v[192:195], v[176:179], v[46:49]
buffer_load_dwordx4 v6, s[24:27], s58 offen offset:1024 lds
v_mfma_f32_16x16x32_bf16 v[116:119], v[192:195], v[172:175], v[50:53]
ds_read_b64 v[200:201], v9 offset:1024
s_add_u32 m0, s59, 58240
v_mfma_f32_16x16x32_bf16 v[100:103], v[188:191], v[172:175], v[46:49]
ds_read_b64 v[210:211], v9 offset:1032
s_xor_b32 s58, s87, 1966080
v_mfma_f32_16x16x32_bf16 v[112:115], v[188:191], v[168:171], v[50:53]
ds_read_b128 v[240:243], v11 offset:384
v_max3_f32 v88, v104, v105, v106
v_mfma_f32_16x16x32_bf16 v[96:99], v[184:187], v[168:171], v[46:49]
buffer_load_dwordx4 v5, s[24:27], s58 offen lds
v_mfma_f32_16x16x32_bf16 v[108:111], v[184:187], v[164:167], v[50:53]
ds_read_b128 v[244:247], v11 offset:1408
v_max3_f32 v89, v107, v120, v121
v_max3_f32 v88, v88, v122, v123
v_max_f32 v90, v88, v89
v_max_f32 v89, v88, v89
v_max3_f32 v84, v100, v101, v102
v_max3_f32 v85, v103, v116, v117
s_waitcnt lgkmcnt(4)
v_mfma_f32_16x16x32_bf16 v[92:95], v[180:183], v[164:167], v[46:49]
ds_read_b128 v[28:31], v11 offset:320
v_permlane16_swap_b32 v90, v89
MAA 136,12,96
buffer_load_dwordx4 v6, s[24:27], s58 offen offset:1024 lds
MAA 136,32,100
ds_read_b128 v[32:35], v11 offset:1344
s_add_u32 m0, s59, 66560
MAA 136,52,160
ds_read_b128 v[36:39], v11 offset:256
s_xor_b32 s58, s87, 0
MAA 136,72,164
ds_read_b128 v[40:43], v11 offset:1280
v_max_f32 v88, v90, v89
MAA 152,72,172
buffer_load_dwordx4 v5, s[24:27], s58 offen lds
MAA 152,52,168
v_max_f32 v89, v90, v89
v_max3_f32 v84, v84, v118, v119
MAA 152,32,124
v_permlane32_swap_b32 v88, v89
MAA 152,12,120
v_max_f32 v88, v88, v89
v_mul_f32 v88, v88, v234
v_max_f32 v86, v84, v85
v_max_f32 v85, v84, v85
v_max3_f32 v80, v96, v97, v98
v_max3_f32 v81, v99, v112, v113
v_permlane16_swap_b32 v86, v85
v_max3_f32 v80, v80, v114, v115
v_max_f32 v84, v86, v85
v_max_f32 v85, v86, v85
v_max_f32 v82, v80, v81
v_max_f32 v81, v80, v81
v_permlane32_swap_b32 v84, v85
v_max3_f32 v76, v92, v93, v94
v_max_f32 v84, v84, v85
v_mul_f32 v84, v84, v230
v_permlane16_swap_b32 v82, v81
v_max3_f32 v77, v95, v108, v109
v_max_f32 v80, v82, v81
v_max_f32 v81, v82, v81
v_max3_f32 v76, v76, v110, v111
v_max_f32 v78, v76, v77
v_permlane32_swap_b32 v80, v81
v_max_f32 v77, v76, v77
v_max_f32 v80, v80, v81
v_mul_f32 v80, v80, v226
v_permlane16_swap_b32 v78, v77
v_pk_fma_f32 v[104:105], v[104:105], v[234:235], v[88:89] op_sel_hi:[1,0,0] neg_lo:[0,0,1] neg_hi:[0,0,1]
v_max_f32 v76, v78, v77
v_max_f32 v77, v78, v77
v_pk_fma_f32 v[106:107], v[106:107], v[234:235], v[88:89] op_sel_hi:[1,0,0] neg_lo:[0,0,1] neg_hi:[0,0,1]
v_pk_fma_f32 v[120:121], v[120:121], v[234:235], v[88:89] op_sel_hi:[1,0,0] neg_lo:[0,0,1] neg_hi:[0,0,1]
v_permlane32_swap_b32 v76, v77
v_pk_fma_f32 v[122:123], v[122:123], v[234:235], v[88:89] op_sel_hi:[1,0,0] neg_lo:[0,0,1] neg_hi:[0,0,1]
v_max_f32 v76, v76, v77
v_mul_f32 v76, v76, v222
v_pk_fma_f32 v[100:101], v[100:101], v[230:231], v[84:85] op_sel_hi:[1,0,0] neg_lo:[0,0,1] neg_hi:[0,0,1]
v_pk_fma_f32 v[102:103], v[102:103], v[230:231], v[84:85] op_sel_hi:[1,0,0] neg_lo:[0,0,1] neg_hi:[0,0,1]
v_pk_fma_f32 v[116:117], v[116:117], v[230:231], v[84:85] op_sel_hi:[1,0,0] neg_lo:[0,0,1] neg_hi:[0,0,1]
v_pk_fma_f32 v[118:119], v[118:119], v[230:231], v[84:85] op_sel_hi:[1,0,0] neg_lo:[0,0,1] neg_hi:[0,0,1]
v_pk_fma_f32 v[96:97], v[96:97], v[226:227], v[80:81] op_sel_hi:[1,0,0] neg_lo:[0,0,1] neg_hi:[0,0,1]
v_pk_fma_f32 v[98:99], v[98:99], v[226:227], v[80:81] op_sel_hi:[1,0,0] neg_lo:[0,0,1] neg_hi:[0,0,1]
v_pk_fma_f32 v[112:113], v[112:113], v[226:227], v[80:81] op_sel_hi:[1,0,0] neg_lo:[0,0,1] neg_hi:[0,0,1]
v_pk_fma_f32 v[114:115], v[114:115], v[226:227], v[80:81] op_sel_hi:[1,0,0] neg_lo:[0,0,1] neg_hi:[0,0,1]
v_pk_fma_f32 v[92:93], v[92:93], v[222:223], v[76:77] op_sel_hi:[1,0,0] neg_lo:[0,0,1] neg_hi:[0,0,1]
v_pk_fma_f32 v[94:95], v[94:95], v[222:223], v[76:77] op_sel_hi:[1,0,0] neg_lo:[0,0,1] neg_hi:[0,0,1]
v_pk_fma_f32 v[108:109], v[108:109], v[222:223], v[76:77] op_sel_hi:[1,0,0] neg_lo:[0,0,1] neg_hi:[0,0,1]
v_pk_fma_f32 v[110:111], v[110:111], v[222:223], v[76:77] op_sel_hi:[1,0,0] neg_lo:[0,0,1] neg_hi:[0,0,1]
v_pk_fma_f32 v[136:137], v[18:19], v[44:45], v[136:137] op_sel_hi:[1,0,1]
v_pk_mul_f32 v[136:137], v[136:137], v[22:23]
v_pk_fma_f32 v[138:139], v[20:21], v[44:45], v[138:139] op_sel_hi:[1,0,1]
v_pk_mul_f32 v[138:139], v[138:139], v[24:25]
v_pk_fma_f32 v[152:153], v[18:19], v[44:45], v[152:153] op_sel:[0,1,0] op_sel_hi:[1,1,1]
v_pk_mul_f32 v[152:153], v[152:153], v[22:23]
v_pk_fma_f32 v[154:155], v[20:21], v[44:45], v[154:155] op_sel:[0,1,0] op_sel_hi:[1,1,1]
v_pk_mul_f32 v[154:155], v[154:155], v[24:25]
v_exp_f32 v104, v104
s_nop 0
MAA 132,8,96
buffer_load_dwordx4 v6, s[24:27], s58 offen offset:1024 lds
MAA 132,28,100
s_add_u32 m0, s59, 116480
s_xor_b32 s58, s87, 786432
v_exp_f32 v105, v105
MAA 132,48,160
v_exp_f32 v106, v106
MAA 132,68,164
v_exp_f32 v107, v107
MAA 148,68,172
buffer_load_dwordx4 v5, s[24:27], s58 offen lds
MAA 148,48,168
v_exp_f32 v120, v120
MAA 148,28,124
v_exp_f32 v121, v121
MAA 148,8,120
v_exp_f32 v122, v122
MAA 128,4,96
buffer_load_dwordx4 v6, s[24:27], s58 offen offset:1024 lds
MAA 128,24,100
s_add_u32 m0, s59, 124800
s_xor_b32 s58, s87, 917504
v_exp_f32 v123, v123
MAA 128,44,160
v_exp_f32 v100, v100
MAA 128,64,164
v_exp_f32 v101, v101
MAA 144,64,172
buffer_load_dwordx4 v5, s[24:27], s58 offen lds
MAA 144,44,168
v_exp_f32 v102, v102
MAA 144,24,124
v_exp_f32 v103, v103
MAA 144,4,120
v_exp_f32 v116, v116
MAA 124,0,96
buffer_load_dwordx4 v6, s[24:27], s58 offen offset:1024 lds
MAA 124,20,100
v_exp_f32 v117, v117
MAA 124,40,160
v_exp_f32 v118, v118
MAA 124,60,164
v_exp_f32 v119, v119
MAA 140,60,172
v_exp_f32 v96, v96
MAA 140,40,168
v_exp_f32 v97, v97
MAA 140,20,124
v_exp_f32 v98, v98
MAA 140,0,120
v_cvt_pk_bf16_f32 v72, v104, v105
v_cvt_pk_bf16_f32 v73, v106, v107
v_cvt_pk_bf16_f32 v74, v120, v121
v_cvt_pk_bf16_f32 v75, v122, v123
v_cvt_pk_bf16_f32 v68, v100, v101
v_cvt_pk_bf16_f32 v69, v102, v103
v_cvt_pk_bf16_f32 v70, v116, v117
v_cvt_pk_bf16_f32 v71, v118, v119
v_exp_f32 v99, v99
v_exp_f32 v112, v112
v_exp_f32 v113, v113
v_exp_f32 v114, v114
v_exp_f32 v115, v115
v_cvt_pk_bf16_f32 v64, v96, v97
v_cvt_pk_bf16_f32 v65, v98, v99
v_cvt_pk_bf16_f32 v66, v112, v113
v_cvt_pk_bf16_f32 v67, v114, v115
v_cvt_pk_bf16_f32 v208, v136, v137
v_cvt_pk_bf16_f32 v209, v138, v139
v_cvt_pk_bf16_f32 v218, v152, v153
v_cvt_pk_bf16_f32 v219, v154, v155
s_waitcnt lgkmcnt(5)
v_pk_fma_f32 v[132:133], v[240:241], v[44:45], v[132:133] op_sel_hi:[1,0,1]
s_waitcnt lgkmcnt(4)
v_pk_mul_f32 v[132:133], v[132:133], v[244:245]
v_cvt_pk_bf16_f32 v206, v132, v133
v_pk_fma_f32 v[134:135], v[242:243], v[44:45], v[134:135] op_sel_hi:[1,0,1]
v_pk_mul_f32 v[134:135], v[134:135], v[246:247]
v_cvt_pk_bf16_f32 v207, v134, v135
v_pk_fma_f32 v[148:149], v[240:241], v[44:45], v[148:149] op_sel:[0,1,0] op_sel_hi:[1,1,1]
v_pk_mul_f32 v[148:149], v[148:149], v[244:245]
v_cvt_pk_bf16_f32 v216, v148, v149
v_pk_fma_f32 v[150:151], v[242:243], v[44:45], v[150:151] op_sel:[0,1,0] op_sel_hi:[1,1,1]
v_pk_mul_f32 v[150:151], v[150:151], v[246:247]
v_cvt_pk_bf16_f32 v217, v150, v151
s_waitcnt lgkmcnt(3)
v_pk_fma_f32 v[128:129], v[28:29], v[44:45], v[128:129] op_sel_hi:[1,0,1]
s_waitcnt lgkmcnt(2)
v_pk_mul_f32 v[128:129], v[128:129], v[32:33]
v_cvt_pk_bf16_f32 v204, v128, v129
v_pk_fma_f32 v[130:131], v[30:31], v[44:45], v[130:131] op_sel_hi:[1,0,1]
v_pk_mul_f32 v[130:131], v[130:131], v[34:35]
v_cvt_pk_bf16_f32 v205, v130, v131
v_pk_fma_f32 v[144:145], v[28:29], v[44:45], v[144:145] op_sel:[0,1,0] op_sel_hi:[1,1,1]
v_pk_mul_f32 v[144:145], v[144:145], v[32:33]
v_cvt_pk_bf16_f32 v214, v144, v145
v_pk_fma_f32 v[146:147], v[30:31], v[44:45], v[146:147] op_sel:[0,1,0] op_sel_hi:[1,1,1]
v_pk_mul_f32 v[146:147], v[146:147], v[34:35]
v_cvt_pk_bf16_f32 v215, v146, v147
s_waitcnt lgkmcnt(1)
v_pk_fma_f32 v[124:125], v[36:37], v[44:45], v[124:125] op_sel_hi:[1,0,1]
s_waitcnt lgkmcnt(0)
v_pk_mul_f32 v[124:125], v[124:125], v[40:41]
v_cvt_pk_bf16_f32 v202, v124, v125
v_pk_fma_f32 v[126:127], v[38:39], v[44:45], v[126:127] op_sel_hi:[1,0,1]
v_pk_mul_f32 v[126:127], v[126:127], v[42:43]
v_cvt_pk_bf16_f32 v203, v126, v127
v_pk_fma_f32 v[140:141], v[36:37], v[44:45], v[140:141] op_sel:[0,1,0] op_sel_hi:[1,1,1]
v_pk_mul_f32 v[140:141], v[140:141], v[40:41]
v_cvt_pk_bf16_f32 v212, v140, v141
v_pk_fma_f32 v[142:143], v[38:39], v[44:45], v[142:143] op_sel:[0,1,0] op_sel_hi:[1,1,1]
v_pk_mul_f32 v[142:143], v[142:143], v[42:43]
v_cvt_pk_bf16_f32 v213, v142, v143
s_nop 0
v_mfma_f32_16x16x32_bf16 v[88:91], v[248:251], v[72:75], 0
v_exp_f32 v92, v92
v_mfma_f32_16x16x32_bf16 v[104:107], v[206:209], v[72:75], 0
v_exp_f32 v93, v93
v_mfma_f32_16x16x32_bf16 v[120:123], v[216:219], v[72:75], 0
v_exp_f32 v94, v94
v_mfma_f32_16x16x32_bf16 v[84:87], v[248:251], v[68:71], 0
v_exp_f32 v95, v95
v_mfma_f32_16x16x32_bf16 v[100:103], v[204:207], v[68:71], 0
v_exp_f32 v108, v108
v_mfma_f32_16x16x32_bf16 v[116:119], v[214:217], v[68:71], 0
v_exp_f32 v109, v109
v_mfma_f32_16x16x32_bf16 v[80:83], v[248:251], v[64:67], 0
v_exp_f32 v110, v110
v_mfma_f32_16x16x32_bf16 v[96:99], v[202:205], v[64:67], 0
v_exp_f32 v111, v111
v_mfma_f32_16x16x32_bf16 v[112:115], v[212:215], v[64:67], 0
v_cvt_pk_bf16_f32 v60, v92, v93
v_cvt_pk_bf16_f32 v61, v94, v95
v_cvt_pk_bf16_f32 v62, v108, v109
v_cvt_pk_bf16_f32 v63, v110, v111
v_rcp_f32 v88, v88
v_rcp_f32 v84, v84
v_mfma_f32_16x16x32_bf16 v[76:79], v[248:251], v[60:63], 0
v_rcp_f32 v80, v80
v_mfma_f32_16x16x32_bf16 v[92:95], v[200:203], v[60:63], 0
v_mfma_f32_16x16x32_bf16 v[108:111], v[210:213], v[60:63], 0
s_nop 4
v_rcp_f32 v76, v76
v_pk_mul_f32 v[104:105], v[104:105], v[88:89] op_sel_hi:[1,0]
v_pk_mul_f32 v[106:107], v[106:107], v[88:89] op_sel_hi:[1,0]
v_pk_mul_f32 v[120:121], v[120:121], v[88:89] op_sel_hi:[1,0]
v_pk_mul_f32 v[122:123], v[122:123], v[88:89] op_sel_hi:[1,0]
v_cvt_pk_bf16_f32 v176, v104, v105
v_cvt_pk_bf16_f32 v177, v106, v107
v_cvt_pk_bf16_f32 v178, v120, v121
v_cvt_pk_bf16_f32 v179, v122, v123
buffer_store_dwordx4 v[176:179], v4, s[16:19], s74 offen offset:3072 sc1
v_pk_mul_f32 v[100:101], v[100:101], v[84:85] op_sel_hi:[1,0]
v_pk_mul_f32 v[102:103], v[102:103], v[84:85] op_sel_hi:[1,0]
v_pk_mul_f32 v[116:117], v[116:117], v[84:85] op_sel_hi:[1,0]
v_pk_mul_f32 v[118:119], v[118:119], v[84:85] op_sel_hi:[1,0]
v_cvt_pk_bf16_f32 v172, v100, v101
v_cvt_pk_bf16_f32 v173, v102, v103
v_cvt_pk_bf16_f32 v174, v116, v117
v_cvt_pk_bf16_f32 v175, v118, v119
buffer_store_dwordx4 v[172:175], v4, s[16:19], s74 offen offset:2048 sc1
v_pk_mul_f32 v[96:97], v[96:97], v[80:81] op_sel_hi:[1,0]
v_pk_mul_f32 v[98:99], v[98:99], v[80:81] op_sel_hi:[1,0]
v_pk_mul_f32 v[112:113], v[112:113], v[80:81] op_sel_hi:[1,0]
v_pk_mul_f32 v[114:115], v[114:115], v[80:81] op_sel_hi:[1,0]
v_cvt_pk_bf16_f32 v168, v96, v97
v_cvt_pk_bf16_f32 v169, v98, v99
v_cvt_pk_bf16_f32 v170, v112, v113
v_cvt_pk_bf16_f32 v171, v114, v115
buffer_store_dwordx4 v[168:171], v4, s[16:19], s74 offen offset:1024 sc1
v_pk_mul_f32 v[92:93], v[92:93], v[76:77] op_sel_hi:[1,0]
v_pk_mul_f32 v[94:95], v[94:95], v[76:77] op_sel_hi:[1,0]
v_pk_mul_f32 v[108:109], v[108:109], v[76:77] op_sel_hi:[1,0]
v_pk_mul_f32 v[110:111], v[110:111], v[76:77] op_sel_hi:[1,0]
v_cvt_pk_bf16_f32 v164, v92, v93
v_cvt_pk_bf16_f32 v165, v94, v95
v_cvt_pk_bf16_f32 v166, v108, v109
v_cvt_pk_bf16_f32 v167, v110, v111
buffer_store_dwordx4 v[164:167], v4, s[16:19], s74 offen sc1
s_nop 1
.Lqkve2:
s_lshl_b32 s62, s3, 11
s_add_u32 s62, s62, s84
v_lshl_add_u32 v4, v1, 4, s62
v_lshrrev_b32 v2, 3, v1
v_cmp_eq_u32 vcc, 3, v2
v_add_u32 v2, 67108480, v4
s_nop 0
v_cndmask_b32 v4, v4, v2, vcc
v_bfe_u32 v5, v1, 3, 1
v_lshrrev_b32 v2, 4, v1
v_lshl_add_u32 v5, v2, 3, v5
s_lshl_b32 s62, s3, 1
v_add_u32 v5, s62, v5
v_mul_u32_u24 v5, 2048, v5
v_and_b32 v2, 7, v1
v_lshl_add_u32 v5, v2, 4, v5
s_lshl_b32 s62, s7, 7
v_add_u32 v5, s62, v5
v_add_u32 v6, 64512, v5
v_bfe_u32 v8, v1, 3, 2
v_mul_u32_u24 v8, 2080, v8
v_bfe_u32 v2, v1, 2, 1
v_lshl_add_u32 v8, v2, 7, v8
v_bfe_u32 v2, v1, 5, 1
v_lshl_add_u32 v8, v2, 8, v8
v_and_b32 v2, 3, v1
v_lshl_add_u32 v8, v2, 3, v8
s_mov_b32 s57, 66560
v_add_u32 v7, s57, v8
s_lshr_b32 s54, s87, 17
s_lshl_b32 s54, s54, 18
s_add_u32 s54, s54, 4194304
s_mov_b32 s52, s54
s_add_u32 s53, s54, 131072
v_accvgpr_read_b32 v32, a224
v_accvgpr_read_b32 v33, a225
v_accvgpr_read_b32 v34, a226
v_accvgpr_read_b32 v35, a227
v_accvgpr_read_b32 v36, a228
v_accvgpr_read_b32 v37, a229
v_accvgpr_read_b32 v38, a230
v_accvgpr_read_b32 v39, a231
v_accvgpr_read_b32 v40, a232
v_accvgpr_read_b32 v41, a233
v_accvgpr_read_b32 v42, a234
v_accvgpr_read_b32 v43, a235
v_accvgpr_read_b32 v44, a236
v_accvgpr_read_b32 v45, a237
v_accvgpr_read_b32 v46, a238
v_accvgpr_read_b32 v47, a239
v_accvgpr_read_b32 v48, a240
v_accvgpr_read_b32 v49, a241
v_accvgpr_read_b32 v50, a242
v_accvgpr_read_b32 v51, a243
v_accvgpr_read_b32 v52, a244
v_accvgpr_read_b32 v53, a245
v_accvgpr_read_b32 v54, a246
v_accvgpr_read_b32 v55, a247
v_accvgpr_read_b32 v56, a248
v_accvgpr_read_b32 v57, a249
v_accvgpr_read_b32 v58, a250
v_accvgpr_read_b32 v59, a251
v_accvgpr_read_b32 v60, a252
v_accvgpr_read_b32 v61, a253
v_accvgpr_read_b32 v62, a254
v_accvgpr_read_b32 v63, a255
s_lshl_b32 s62, s49, 3
s_add_u32 s62, s62, s48
s_mul_i32 s62, s62, 28672
s_add_u32 s62, s62, s51
v_lshrrev_b32 v12, 4, v1
v_mul_u32_u24 v12, 57344, v12
v_and_b32 v2, 15, v1
v_lshl_add_u32 v12, v2, 4, v12
v_add_u32 v12, s62, v12
v_add_u32 v13, 6112, v12
v_add_u32 v14, 12224, v12
v_add_u32 v15, 18336, v12
s_mul_i32 s59, s3, 4224
s_mov_b32 s58, 0
s_mov_b32 s36, s0
s_mov_b32 s37, s1
s_lshl_b32 s62, s8, 10
s_add_u32 s62, s62, 30425088
s_lshl_b32 s64, s6, 10
s_add_u32 s64, s64, 30425088
s_lshr_b32 s67, s5, 2
s_and_b32 s67, s67, 3
s_lshl_b32 s67, s67, 7
s_add_u32 s64, s64, s67
v_lshl_add_u32 v252, v1, 7, s62
v_mov_b32 v253, s64
v_mov_b32 v255, 1
s_waitcnt vmcnt(0) lgkmcnt(0)
s_cmp_lg_u32 s3, 1
s_barrier
s_cbranch_scc1 .Lnopoll34
s_mov_b64 exec, 15
buffer_atomic_add v255, v252, s[16:19], 0 offen
s_mov_b64 exec, 1
v_mov_b32 v254, 0
buffer_atomic_add v254, v253, s[16:19], 0 offen sc0
s_sleep 5
s_mov_b32 s15, 0
.Lpoll33:
v_mov_b32 v255, 0
buffer_atomic_add v255, v253, s[16:19], 0 offen sc0
s_waitcnt vmcnt(1)
v_cmp_gt_u32 vcc, 16, v254
s_add_u32 s15, s15, 1
s_cbranch_vccz .Lnopoll34r
v_mov_b32 v254, 0
buffer_atomic_add v254, v253, s[16:19], 0 offen sc0
s_waitcnt vmcnt(1)
v_cmp_gt_u32 vcc, 16, v255
s_add_u32 s15, s15, 1
s_cbranch_vccz .Lnopoll34r
s_cmp_le_u32 s15, 100000
s_cbranch_scc1 .Lpoll33
s_branch .Lnopoll34r
.Lnopoll34:
s_mov_b64 exec, 0
s_cmp_eq_u32 s3, 2
s_cbranch_scc1 .Lpad11
s_cmp_eq_u32 s3, 3
s_cbranch_scc1 .Lpad12
s_branch .Lpad13
.Lnopoll34r:
s_mov_b64 exec, -1
s_barrier
buffer_load_dwordx4 v[64:67], v4, s[16:19], s52 offen sc1
buffer_load_dwordx4 v[68:71], v4, s[16:19], s52 offen offset:1024 sc1
s_xor_b32 s52, s54, 262144
buffer_load_dwordx4 v[72:75], v4, s[16:19], s53 offen sc1
buffer_load_dwordx4 v[76:79], v4, s[16:19], s53 offen offset:1024 sc1
s_xor_b32 s53, s54, 393216
buffer_load_dwordx4 v[80:83], v4, s[16:19], s52 offen sc1
buffer_load_dwordx4 v[84:87], v4, s[16:19], s52 offen offset:1024 sc1
s_xor_b32 s52, s54, 524288
buffer_load_dwordx4 v[88:91], v4, s[16:19], s53 offen sc1
buffer_load_dwordx4 v[92:95], v4, s[16:19], s53 offen offset:1024 sc1
s_xor_b32 s53, s54, 655360
buffer_load_dwordx4 v[96:99], v4, s[16:19], s52 offen sc1
buffer_load_dwordx4 v[100:103], v4, s[16:19], s52 offen offset:1024 sc1
s_xor_b32 s52, s54, 786432
buffer_load_dwordx4 v[104:107], v4, s[16:19], s53 offen sc1
buffer_load_dwordx4 v[108:111], v4, s[16:19], s53 offen offset:1024 sc1
s_xor_b32 s53, s54, 917504
ds_read_b64_tr_b16 a[0:1], v7
TR 2,7,512
TR 16,7,1024
TR 18,7,1536
TR 4,7,32
TR 6,7,544
TR 20,7,1056
TR 22,7,1568
TR 8,7,64
TR 10,7,576
TR 24,7,1088
TR 26,7,1600
TR 12,7,96
TR 14,7,608
TR 28,7,1120
TR 30,7,1632
s_waitcnt vmcnt(8) lgkmcnt(14)
MAV 32,0,64
TR 32,7,8320
s_waitcnt lgkmcnt(13)
MAV 32,16,72
buffer_load_dwordx4 v[112:115], v4, s[16:19], s52 offen sc1
MAV 48,16,76
TR 34,7,8832
MAV 48,0,68
TR 48,7,9344
TR 50,7,9856
s_waitcnt lgkmcnt(14)
MAV 52,4,68
TR 36,7,8352
s_waitcnt lgkmcnt(13)
MAV 52,20,76
buffer_load_dwordx4 v[116:119], v4, s[16:19], s52 offen offset:1024 sc1
MAV 36,20,72
TR 38,7,8864
s_xor_b32 s52, s54, 1048576
MAV 36,4,64
TR 52,7,9376
TR 54,7,9888
s_waitcnt lgkmcnt(14)
MAV 40,8,64
TR 40,7,8384
s_waitcnt lgkmcnt(13)
MAV 40,24,72
buffer_load_dwordx4 v[120:123], v4, s[16:19], s53 offen sc1
MAV 56,24,76
TR 42,7,8896
MAV 56,8,68
TR 56,7,9408
TR 58,7,9920
s_waitcnt lgkmcnt(14)
MAV 60,12,68
TR 44,7,8416
s_waitcnt lgkmcnt(13)
MAV 60,28,76
buffer_load_dwordx4 v[124:127], v4, s[16:19], s53 offen offset:1024 sc1
MAV 44,28,72
TR 46,7,8928
s_xor_b32 s53, s54, 1179648
MAV 44,12,64
TR 60,7,9440
TR 62,7,9952
s_waitcnt vmcnt(8) lgkmcnt(8)
MAV 32,32,80
TR 0,7,16640
MAV 32,48,88
buffer_load_dwordx4 v[64:67], v4, s[16:19], s52 offen sc1
MAV 48,48,92
TR 2,7,17152
MAV 48,32,84
TR 16,7,17664
TR 18,7,18176
MAV 52,36,84
TR 4,7,16672
MAV 52,52,92
buffer_load_dwordx4 v[68:71], v4, s[16:19], s52 offen offset:1024 sc1
MAV 36,52,88
TR 6,7,17184
s_xor_b32 s52, s54, 1310720
MAV 36,36,80
TR 20,7,17696
TR 22,7,18208
s_waitcnt lgkmcnt(8)
MAV 40,40,80
TR 8,7,16704
MAV 40,56,88
buffer_load_dwordx4 v[72:75], v4, s[16:19], s53 offen sc1
MAV 56,56,92
TR 10,7,17216
MAV 56,40,84
TR 24,7,17728
TR 26,7,18240
MAV 60,44,84
TR 12,7,16736
MAV 60,60,92
buffer_load_dwordx4 v[76:79], v4, s[16:19], s53 offen offset:1024 sc1
MAV 44,60,88
TR 14,7,17248
s_xor_b32 s53, s54, 1441792
MAV 44,44,80
TR 28,7,17760
TR 30,7,18272
s_waitcnt vmcnt(8) lgkmcnt(8)
MAV 32,0,96
TR 32,7,24960
MAV 32,16,104
buffer_load_dwordx4 v[80:83], v4, s[16:19], s52 offen sc1
MAV 48,16,108
TR 34,7,25472
MAV 48,0,100
TR 48,7,25984
TR 50,7,26496
MAV 52,4,100
TR 36,7,24992
MAV 52,20,108
buffer_load_dwordx4 v[84:87], v4, s[16:19], s52 offen offset:1024 sc1
MAV 36,20,104
TR 38,7,25504
s_xor_b32 s52, s54, 1572864
MAV 36,4,96
TR 52,7,26016
TR 54,7,26528
s_waitcnt lgkmcnt(8)
MAV 40,8,96
TR 40,7,25024
MAV 40,24,104
buffer_load_dwordx4 v[88:91], v4, s[16:19], s53 offen sc1
MAV 56,24,108
TR 42,7,25536
MAV 56,8,100
TR 56,7,26048
TR 58,7,26560
MAV 60,12,100
TR 44,7,25056
MAV 60,28,108
buffer_load_dwordx4 v[92:95], v4, s[16:19], s53 offen offset:1024 sc1
MAV 44,28,104
TR 46,7,25568
s_xor_b32 s53, s54, 1703936
MAV 44,12,96
TR 60,7,26080
TR 62,7,26592
s_waitcnt vmcnt(8) lgkmcnt(8)
MAV 32,32,112
TR 0,7,33280
MAV 32,48,120
buffer_load_dwordx4 v[96:99], v4, s[16:19], s52 offen sc1
MAV 48,48,124
.Lpad11:
s_cbranch_execz .Lpad14
TR 2,7,33792
MAV 48,32,116
TR 16,7,34304
TR 18,7,34816
MAV 52,36,116
TR 4,7,33312
MAV 52,52,124
buffer_load_dwordx4 v[100:103], v4, s[16:19], s52 offen offset:1024 sc1
MAV 36,52,120
TR 6,7,33824
s_xor_b32 s52, s54, 1835008
MAV 36,36,112
TR 20,7,34336
TR 22,7,34848
s_waitcnt lgkmcnt(8)
MAV 40,40,112
TR 8,7,33344
MAV 40,56,120
buffer_load_dwordx4 v[104:107], v4, s[16:19], s53 offen sc1
MAV 56,56,124
TR 10,7,33856
MAV 56,40,116
TR 24,7,34368
TR 26,7,34880
MAV 60,44,116
TR 12,7,33376
MAV 60,60,124
buffer_load_dwordx4 v[108:111], v4, s[16:19], s53 offen offset:1024 sc1
MAV 44,60,120
TR 14,7,33888
s_xor_b32 s53, s54, 1966080
MAV 44,44,112
TR 28,7,34400
TR 30,7,34912
s_waitcnt vmcnt(8) lgkmcnt(8)
MAV 32,0,64
TR 32,7,41600
MAV 32,16,72
buffer_load_dwordx4 v[112:115], v4, s[16:19], s52 offen sc1
MAV 48,16,76
TR 34,7,42112
MAV 48,0,68
TR 48,7,42624
TR 50,7,43136
MAV 52,4,68
TR 36,7,41632
MAV 52,20,76
buffer_load_dwordx4 v[116:119], v4, s[16:19], s52 offen offset:1024 sc1
MAV 36,20,72
TR 38,7,42144
s_xor_b32 s52, s54, 2097152
MAV 36,4,64
TR 52,7,42656
TR 54,7,43168
s_waitcnt lgkmcnt(8)
MAV 40,8,64
TR 40,7,41664
MAV 40,24,72
buffer_load_dwordx4 v[120:123], v4, s[16:19], s53 offen sc1
MAV 56,24,76
TR 42,7,42176
MAV 56,8,68
TR 56,7,42688
TR 58,7,43200
MAV 60,12,68
TR 44,7,41696
MAV 60,28,76
buffer_load_dwordx4 v[124:127], v4, s[16:19], s53 offen offset:1024 sc1
MAV 44,28,72
TR 46,7,42208
s_xor_b32 s53, s54, 2228224
MAV 44,12,64
TR 60,7,42720
TR 62,7,43232
s_waitcnt vmcnt(8) lgkmcnt(8)
MAV 32,32,80
TR 0,7,49920
MAV 32,48,88
buffer_load_dwordx4 v[64:67], v4, s[16:19], s52 offen sc1
MAV 48,48,92
TR 2,7,50432
MAV 48,32,84
TR 16,7,50944
TR 18,7,51456
MAV 52,36,84
TR 4,7,49952
MAV 52,52,92
buffer_load_dwordx4 v[68:71], v4, s[16:19], s52 offen offset:1024 sc1
MAV 36,52,88
TR 6,7,50464
s_xor_b32 s52, s54, 2359296
MAV 36,36,80
TR 20,7,50976
TR 22,7,51488
s_waitcnt lgkmcnt(8)
MAV 40,40,80
TR 8,7,49984
MAV 40,56,88
buffer_load_dwordx4 v[72:75], v4, s[16:19], s53 offen sc1
MAV 56,56,92
TR 10,7,50496
MAV 56,40,84
TR 24,7,51008
TR 26,7,51520
MAV 60,44,84
TR 12,7,50016
MAV 60,60,92
buffer_load_dwordx4 v[76:79], v4, s[16:19], s53 offen offset:1024 sc1
MAV 44,60,88
TR 14,7,50528
s_xor_b32 s53, s54, 2490368
MAV 44,44,80
TR 28,7,51040
TR 30,7,51552
s_waitcnt vmcnt(8) lgkmcnt(8)
MAV 32,0,96
TR 32,7,58240
MAV 32,16,104
buffer_load_dwordx4 v[80:83], v4, s[16:19], s52 offen sc1
MAV 48,16,108
TR 34,7,58752
MAV 48,0,100
TR 48,7,59264
TR 50,7,59776
MAV 52,4,100
TR 36,7,58272
MAV 52,20,108
buffer_load_dwordx4 v[84:87], v4, s[16:19], s52 offen offset:1024 sc1
MAV 36,20,104
TR 38,7,58784
s_xor_b32 s52, s54, 2621440
MAV 36,4,96
TR 52,7,59296
TR 54,7,59808
s_waitcnt lgkmcnt(8)
MAV 40,8,96
TR 40,7,58304
MAV 40,24,104
buffer_load_dwordx4 v[88:91], v4, s[16:19], s53 offen sc1
MAV 56,24,108
TR 42,7,58816
MAV 56,8,100
TR 56,7,59328
TR 58,7,59840
MAV 60,12,100
TR 44,7,58336
MAV 60,28,108
buffer_load_dwordx4 v[92:95], v4, s[16:19], s53 offen offset:1024 sc1
MAV 44,28,104
TR 46,7,58848
s_xor_b32 s53, s54, 2752512
MAV 44,12,96
TR 60,7,59360
TR 62,7,59872
s_xor_b32 s57, s57, 66560
v_add_u32 v7, s57, v8
s_waitcnt vmcnt(8) lgkmcnt(8)
MAV 32,32,112
ds_read_b64_tr_b16 a[0:1], v7
MAV 32,48,120
buffer_load_dwordx4 v[96:99], v4, s[16:19], s52 offen sc1
MAV 48,48,124
TR 2,7,512
MAV 48,32,116
TR 16,7,1024
TR 18,7,1536
MAV 52,36,116
TR 4,7,32
MAV 52,52,124
buffer_load_dwordx4 v[100:103], v4, s[16:19], s52 offen offset:1024 sc1
MAV 36,52,120
TR 6,7,544
s_xor_b32 s52, s54, 2883584
MAV 36,36,112
TR 20,7,1056
TR 22,7,1568
s_waitcnt lgkmcnt(8)
MAV 40,40,112
TR 8,7,64
MAV 40,56,120
buffer_load_dwordx4 v[104:107], v4, s[16:19], s53 offen sc1
MAV 56,56,124
TR 10,7,576
MAV 56,40,116
TR 24,7,1088
TR 26,7,1600
MAV 60,44,116
TR 12,7,96
MAV 60,60,124
buffer_load_dwordx4 v[108:111], v4, s[16:19], s53 offen offset:1024 sc1
MAV 44,60,120
TR 14,7,608
s_xor_b32 s53, s54, 3014656
MAV 44,44,112
TR 28,7,1120
TR 30,7,1632
s_waitcnt vmcnt(8) lgkmcnt(8)
MAV 32,0,64
TR 32,7,8320
MAV 32,16,72
buffer_load_dwordx4 v[112:115], v4, s[16:19], s52 offen sc1
MAV 48,16,76
TR 34,7,8832
MAV 48,0,68
TR 48,7,9344
TR 50,7,9856
MAV 52,4,68
TR 36,7,8352
MAV 52,20,76
buffer_load_dwordx4 v[116:119], v4, s[16:19], s52 offen offset:1024 sc1
MAV 36,20,72
TR 38,7,8864
s_xor_b32 s52, s54, 3145728
MAV 36,4,64
TR 52,7,9376
TR 54,7,9888
s_waitcnt lgkmcnt(8)
MAV 40,8,64
TR 40,7,8384
MAV 40,24,72
buffer_load_dwordx4 v[120:123], v4, s[16:19], s53 offen sc1
MAV 56,24,76
TR 42,7,8896
MAV 56,8,68
TR 56,7,9408
TR 58,7,9920
MAV 60,12,68
TR 44,7,8416
MAV 60,28,76
buffer_load_dwordx4 v[124:127], v4, s[16:19], s53 offen offset:1024 sc1
MAV 44,28,72
TR 46,7,8928
s_xor_b32 s53, s54, 3276800
MAV 44,12,64
TR 60,7,9440
TR 62,7,9952
s_waitcnt vmcnt(8) lgkmcnt(8)
MAV 32,32,80
TR 0,7,16640
MAV 32,48,88
buffer_load_dwordx4 v[64:67], v4, s[16:19], s52 offen sc1
MAV 48,48,92
TR 2,7,17152
MAV 48,32,84
TR 16,7,17664
TR 18,7,18176
MAV 52,36,84
TR 4,7,16672
MAV 52,52,92
buffer_load_dwordx4 v[68:71], v4, s[16:19], s52 offen offset:1024 sc1
MAV 36,52,88
TR 6,7,17184
s_xor_b32 s52, s54, 3407872
MAV 36,36,80
TR 20,7,17696
TR 22,7,18208
s_waitcnt lgkmcnt(8)
MAV 40,40,80
TR 8,7,16704
MAV 40,56,88
buffer_load_dwordx4 v[72:75], v4, s[16:19], s53 offen sc1
MAV 56,56,92
TR 10,7,17216
MAV 56,40,84
TR 24,7,17728
TR 26,7,18240
MAV 60,44,84
TR 12,7,16736
MAV 60,60,92
buffer_load_dwordx4 v[76:79], v4, s[16:19], s53 offen offset:1024 sc1
MAV 44,60,88
TR 14,7,17248
s_xor_b32 s53, s54, 3538944
MAV 44,44,80
TR 28,7,17760
TR 30,7,18272
s_waitcnt vmcnt(8) lgkmcnt(8)
MAV 32,0,96
TR 32,7,24960
MAV 32,16,104
buffer_load_dwordx4 v[80:83], v4, s[16:19], s52 offen sc1
MAV 48,16,108
TR 34,7,25472
MAV 48,0,100
TR 48,7,25984
TR 50,7,26496
MAV 52,4,100
TR 36,7,24992
MAV 52,20,108
buffer_load_dwordx4 v[84:87], v4, s[16:19], s52 offen offset:1024 sc1
MAV 36,20,104
TR 38,7,25504
s_xor_b32 s52, s54, 3670016
MAV 36,4,96
TR 52,7,26016
TR 54,7,26528
s_waitcnt lgkmcnt(8)
MAV 40,8,96
TR 40,7,25024
MAV 40,24,104
buffer_load_dwordx4 v[88:91], v4, s[16:19], s53 offen sc1
MAV 56,24,108
TR 42,7,25536
MAV 56,8,100
TR 56,7,26048
TR 58,7,26560
MAV 60,12,100
TR 44,7,25056
MAV 60,28,108
buffer_load_dwordx4 v[92:95], v4, s[16:19], s53 offen offset:1024 sc1
MAV 44,28,104
TR 46,7,25568
s_xor_b32 s53, s54, 3801088
MAV 44,12,96
TR 60,7,26080
TR 62,7,26592
s_waitcnt vmcnt(8) lgkmcnt(8)
MAV 32,32,112
TR 0,7,33280
MAV 32,48,120
buffer_load_dwordx4 v[96:99], v4, s[16:19], s52 offen sc1
MAV 48,48,124
TR 2,7,33792
MAV 48,32,116
TR 16,7,34304
TR 18,7,34816
MAV 52,36,116
TR 4,7,33312
MAV 52,52,124
buffer_load_dwordx4 v[100:103], v4, s[16:19], s52 offen offset:1024 sc1
MAV 36,52,120
TR 6,7,33824
s_xor_b32 s52, s54, 3932160
MAV 36,36,112
TR 20,7,34336
TR 22,7,34848
s_waitcnt lgkmcnt(8)
MAV 40,40,112
TR 8,7,33344
MAV 40,56,120
buffer_load_dwordx4 v[104:107], v4, s[16:19], s53 offen sc1
MAV 56,56,124
TR 10,7,33856
MAV 56,40,116
TR 24,7,34368
TR 26,7,34880
MAV 60,44,116
TR 12,7,33376
MAV 60,60,124
buffer_load_dwordx4 v[108:111], v4, s[16:19], s53 offen offset:1024 sc1
MAV 44,60,120
TR 14,7,33888
s_xor_b32 s53, s54, 4063232
MAV 44,44,112
TR 28,7,34400
TR 30,7,34912
s_waitcnt vmcnt(8) lgkmcnt(8)
MAV 32,0,64
TR 32,7,41600
MAV 32,16,72
buffer_load_dwordx4 v[112:115], v4, s[16:19], s52 offen sc1
MAV 48,16,76
TR 34,7,42112
MAV 48,0,68
TR 48,7,42624
TR 50,7,43136
MAV 52,4,68
TR 36,7,41632
MAV 52,20,76
buffer_load_dwordx4 v[116:119], v4, s[16:19], s52 offen offset:1024 sc1
MAV 36,20,72
TR 38,7,42144
MAV 36,4,64
TR 52,7,42656
TR 54,7,43168
s_waitcnt lgkmcnt(8)
MAV 40,8,64
TR 40,7,41664
MAV 40,24,72
buffer_load_dwordx4 v[120:123], v4, s[16:19], s53 offen sc1
MAV 56,24,76
TR 42,7,42176
MAV 56,8,68
TR 56,7,42688
TR 58,7,43200
MAV 60,12,68
TR 44,7,41696
MAV 60,28,76
buffer_load_dwordx4 v[124:127], v4, s[16:19], s53 offen offset:1024 sc1
MAV 44,28,72
TR 46,7,42208
MAV 44,12,64
TR 60,7,42720
TR 62,7,43232
s_barrier
s_waitcnt vmcnt(8) lgkmcnt(8)
MAV 32,32,80
TR 0,7,49920
s_add_u32 m0, s59, 84480
MAV 32,48,88
buffer_load_dwordx4 v12, s[32:35], s58 offen   lds
MAV 48,48,92
TR 2,7,50432
MAV 48,32,84
TR 16,7,50944
TR 18,7,51456
MAV 52,36,84
TR 4,7,49952
MAV 52,52,92
buffer_load_dwordx4 v13, s[32:35], s58 offen offset:1056   lds
MAV 36,52,88
TR 6,7,50464
MAV 36,36,80
TR 20,7,50976
TR 22,7,51488
s_waitcnt lgkmcnt(8)
MAV 40,40,80
TR 8,7,49984
MAV 40,56,88
buffer_load_dwordx4 v14, s[32:35], s58 offen offset:2112   lds
MAV 56,56,92
TR 10,7,50496
MAV 56,40,84
TR 24,7,51008
TR 26,7,51520
MAV 60,44,84
TR 12,7,50016
MAV 60,60,92
buffer_load_dwordx4 v15, s[32:35], s58 offen offset:3168   lds
MAV 44,60,88
TR 14,7,50528
MAV 44,44,80
TR 28,7,51040
TR 30,7,51552
s_waitcnt vmcnt(8) lgkmcnt(8)
MAV 32,0,96
TR 32,7,58240
s_add_u32 m0, s59, 101376
MAV 32,16,104
buffer_load_dwordx4 v12, s[80:83], s58 offen   lds
MAV 48,16,108
TR 34,7,58752
MAV 48,0,100
TR 48,7,59264
TR 50,7,59776
MAV 52,4,100
TR 36,7,58272
MAV 52,20,108
buffer_load_dwordx4 v13, s[80:83], s58 offen offset:1056   lds
MAV 36,20,104
TR 38,7,58784
MAV 36,4,96
TR 52,7,59296
TR 54,7,59808
s_waitcnt lgkmcnt(8)
MAV 40,8,96
TR 40,7,58304
MAV 40,24,104
buffer_load_dwordx4 v14, s[80:83], s58 offen offset:2112   lds
MAV 56,24,108
TR 42,7,58816
MAV 56,8,100
TR 56,7,59328
TR 58,7,59840
MAV 60,12,100
TR 44,7,58336
MAV 60,28,108
buffer_load_dwordx4 v15, s[80:83], s58 offen offset:3168   lds
MAV 44,28,104
TR 46,7,58848
s_add_u32 s58, s58, 458752
MAV 44,12,96
TR 60,7,59360
TR 62,7,59872
s_waitcnt vmcnt(11) lgkmcnt(14)
MAV 32,32,112
s_add_u32 m0, s59, 118272
s_lshl_b32 s64, s6, 14
s_lshl_b32 s65, s49, 13
s_waitcnt vmcnt(9) lgkmcnt(12)
MAV 32,48,120
buffer_load_dwordx4 v12, s[32:35], s58 offen   lds
s_waitcnt vmcnt(9)
MAV 48,48,124
s_add_u32 s64, s64, s65
s_lshl_b32 s65, s7, 9
s_add_u32 s64, s64, s65
MAV 48,32,116
s_lshl_b32 s65, s48, 8
s_add_u32 s64, s64, s65
s_add_u32 s64, s64, 29622272
s_waitcnt lgkmcnt(10)
MAV 52,36,116
s_lshl_b32 s62, s7, 18
v_and_b32 v152, 31, v1
v_lshlrev_b32 v152, 3, v152
s_waitcnt lgkmcnt(8)
MAV 52,52,124
buffer_load_dwordx4 v13, s[32:35], s58 offen offset:1056   lds
MAV 36,52,120
s_add_u32 s62, s62, 8388608
v_lshrrev_b32 v153, 5, v1
v_lshl_add_u32 v152, v153, 28, v152
MAV 36,36,112
s_add_u32 s63, s62, 131072
v_cvt_pk_bf16_f32 v128, v32, v33
v_cvt_pk_bf16_f32 v129, v34, v35
s_waitcnt lgkmcnt(6)
MAV 40,40,112
v_cvt_pk_bf16_f32 v136, v48, v49
v_cvt_pk_bf16_f32 v137, v50, v51
s_waitcnt lgkmcnt(4)
MAV 40,56,120
buffer_load_dwordx4 v14, s[32:35], s58 offen offset:2112   lds
MAV 56,56,124
v_cvt_pk_bf16_f32 v130, v36, v37
v_cvt_pk_bf16_f32 v131, v38, v39
MAV 56,40,116
v_cvt_pk_bf16_f32 v138, v52, v53
v_cvt_pk_bf16_f32 v139, v54, v55
s_waitcnt lgkmcnt(2)
MAV 60,44,116
v_cvt_pk_bf16_f32 v132, v40, v41
v_cvt_pk_bf16_f32 v133, v42, v43
s_waitcnt lgkmcnt(0)
MAV 60,60,124
buffer_load_dwordx4 v15, s[32:35], s58 offen offset:3168   lds
MAV 44,60,120
v_cvt_pk_bf16_f32 v140, v56, v57
v_cvt_pk_bf16_f32 v141, v58, v59
MAV 44,44,112
s_nop 2
v_cvt_pk_bf16_f32 v142, v60, v61
v_cvt_pk_bf16_f32 v143, v62, v63
v_pk_mul_f32 v[146:147], v[32:33], v[32:33]
.Lpad12:
s_cbranch_execz .Lpad15
buffer_store_dwordx4 v[128:131], v4, s[16:19], s62 offen sc1
v_pk_mul_f32 v[150:151], v[48:49], v[48:49]
v_pk_fma_f32 v[146:147], v[34:35], v[34:35], v[146:147]
v_pk_add_f32 v[144:145], v[32:33], v[34:35]
v_pk_fma_f32 v[150:151], v[50:51], v[50:51], v[150:151]
v_cvt_pk_bf16_f32 v134, v44, v45
v_cvt_pk_bf16_f32 v135, v46, v47
v_pk_add_f32 v[148:149], v[48:49], v[50:51]
v_pk_fma_f32 v[146:147], v[36:37], v[36:37], v[146:147]
v_pk_add_f32 v[144:145], v[144:145], v[36:37]
v_pk_fma_f32 v[150:151], v[52:53], v[52:53], v[150:151]
v_pk_add_f32 v[148:149], v[148:149], v[52:53]
v_pk_fma_f32 v[146:147], v[38:39], v[38:39], v[146:147]
v_pk_add_f32 v[144:145], v[144:145], v[38:39]
buffer_store_dwordx4 v[132:135], v4, s[16:19], s63 offen sc1
v_pk_fma_f32 v[150:151], v[54:55], v[54:55], v[150:151]
v_pk_add_f32 v[148:149], v[148:149], v[54:55]
v_pk_fma_f32 v[146:147], v[40:41], v[40:41], v[146:147]
v_pk_add_f32 v[144:145], v[144:145], v[40:41]
v_pk_fma_f32 v[150:151], v[56:57], v[56:57], v[150:151]
v_pk_add_f32 v[148:149], v[148:149], v[56:57]
v_pk_fma_f32 v[146:147], v[42:43], v[42:43], v[146:147]
v_pk_add_f32 v[144:145], v[144:145], v[42:43]
v_pk_fma_f32 v[150:151], v[58:59], v[58:59], v[150:151]
v_pk_add_f32 v[148:149], v[148:149], v[58:59]
v_pk_fma_f32 v[146:147], v[44:45], v[44:45], v[146:147]
v_pk_add_f32 v[144:145], v[144:145], v[44:45]
v_pk_fma_f32 v[150:151], v[60:61], v[60:61], v[150:151]
buffer_store_dwordx4 v[136:139], v4, s[16:19], s62 offen offset:1024 sc1
v_pk_add_f32 v[148:149], v[148:149], v[60:61]
v_pk_fma_f32 v[146:147], v[46:47], v[46:47], v[146:147]
v_pk_add_f32 v[144:145], v[144:145], v[46:47]
v_pk_fma_f32 v[150:151], v[62:63], v[62:63], v[150:151]
v_pk_add_f32 v[148:149], v[148:149], v[62:63]
v_add_f32 v144, v144, v145
v_add_f32 v146, v146, v147
v_add_f32 v148, v148, v149
v_add_f32 v150, v150, v151
s_nop 0
v_permlane16_swap_b32 v144, v148
buffer_store_dwordx4 v[140:143], v4, s[16:19], s63 offen offset:1024 sc1
v_permlane16_swap_b32 v146, v150
v_add_f32 v144, v144, v148
v_add_f32 v146, v146, v150
s_nop 1
v_permlane32_swap_b32 v144, v146
v_add_f32 v144, v144, v146
s_nop 1
v_permlane32_swap_b32 v144, v145
buffer_store_dwordx2 v[144:145], v152, s[16:19], s64 offen sc1
s_nop 1
v_accvgpr_write_b32 a224, v32
v_accvgpr_write_b32 a225, v33
v_accvgpr_write_b32 a226, v34
v_accvgpr_write_b32 a227, v35
v_accvgpr_write_b32 a228, v36
v_accvgpr_write_b32 a229, v37
v_accvgpr_write_b32 a230, v38
v_accvgpr_write_b32 a231, v39
v_accvgpr_write_b32 a232, v40
v_accvgpr_write_b32 a233, v41
v_accvgpr_write_b32 a234, v42
v_accvgpr_write_b32 a235, v43
v_accvgpr_write_b32 a236, v44
v_accvgpr_write_b32 a237, v45
v_accvgpr_write_b32 a238, v46
v_accvgpr_write_b32 a239, v47
v_accvgpr_write_b32 a240, v48
v_accvgpr_write_b32 a241, v49
v_accvgpr_write_b32 a242, v50
v_accvgpr_write_b32 a243, v51
v_accvgpr_write_b32 a244, v52
v_accvgpr_write_b32 a245, v53
v_accvgpr_write_b32 a246, v54
v_accvgpr_write_b32 a247, v55
v_accvgpr_write_b32 a248, v56
v_accvgpr_write_b32 a249, v57
v_accvgpr_write_b32 a250, v58
v_accvgpr_write_b32 a251, v59
v_accvgpr_write_b32 a252, v60
v_accvgpr_write_b32 a253, v61
v_accvgpr_write_b32 a254, v62
v_accvgpr_write_b32 a255, v63
s_lshl_b32 s62, s10, 14
s_lshl_b32 s63, s3, 12
s_add_u32 s62, s62, s63
s_lshl_b32 s63, s12, 11
s_add_u32 s62, s62, s63
v_lshl_add_u32 v10, v1, 4, s62
v_lshrrev_b32 v2, 3, v1
v_cmp_eq_u32 vcc, 3, v2
v_add_u32 v2, 67108480, v10
s_nop 0
v_cndmask_b32 v10, v10, v2, vcc
v_xor_b32 v11, 2048, v10
v_bfe_u32 v16, v1, 2, 3
v_mul_u32_u24 v16, 1056, v16
v_bfe_u32 v2, v1, 5, 1
v_lshl_add_u32 v16, v2, 8, v16
v_and_b32 v2, 3, v1
v_lshl_add_u32 v16, v2, 3, v16
s_lshl_b32 s62, s12, 6
s_add_u32 s62, s62, 84480
s_xor_b32 s63, s12, 1
s_mul_i32 s63, s63, 192
s_add_u32 s63, s63, 84480
v_add_u32 v17, s63, v16
v_add_u32 v16, s62, v16
s_mov_b32 s52, 8388608
s_mov_b32 s53, 8388608
s_mov_b32 s54, s58
s_mov_b32 s55, s59
s_mul_i32 s59, s3, 2112
s_and_b32 s62, s7, 1
s_mul_i32 s62, s62, 3670016
s_lshr_b32 s63, s7, 1
s_lshl_b32 s63, s63, 8
s_add_u32 s62, s62, s63
s_lshl_b32 s63, s3, 12
s_add_u32 s62, s62, s63
v_lshrrev_b32 v5, 4, v1
v_lshlrev_b32 v5, 14, v5
v_and_b32 v2, 15, v1
v_lshl_add_u32 v5, v2, 4, v5
v_add_u32 v5, s62, v5
v_add_u32 v6, 992, v5
s_lshl_b32 s62, s10, 15
s_lshl_b32 s63, s3, 13
s_add_u32 s62, s62, s63
v_lshl_add_u32 v4, v1, 4, s62
s_and_b32 s47, s5, 3
s_lshr_b32 s63, s5, 2
s_lshl_b32 s63, s63, 3
s_add_u32 s63, s63, s4
s_lshl_b32 s62, s63, 1
s_add_u32 s62, s62, s48
s_mul_i32 s62, s62, 1792
v_lshrrev_b32 v7, 1, v1
v_min_u32 v8, 13, v7
v_lshl_add_u32 v8, v8, 7, s62
s_lshl_b32 s62, s63, 2
s_add_u32 s62, s62, s3
s_mul_i32 s62, s62, 640
v_and_b32 v7, 15, v7
v_min_u32 v7, 4, v7
v_lshl_add_u32 v7, v7, 7, s62
v_lshrrev_b32 v2, 5, v1
v_mul_u32_u24 v2, 3670016, v2
v_add_u32 v7, v7, v2
s_mul_i32 s44, s47, 163840
s_add_u32 s45, s47, 12
s_mul_i32 s45, s45, 229376
v_and_b32 v6, 3, v1
v_cmp_eq_u32 vcc, 3, v6
v_mov_b32 v2, 0x3f80
v_mov_b32 v20, 1.0
v_cndmask_b32 v2, v2, v20, vcc
v_cndmask_b32 v6, v6, 0, vcc
v_or_b32 v6, 12, v6
v_mul_u32_u24 v6, 0x1111, v6
v_lshl_or_b32 v6, v6, 16, v6
v_bfe_u32 v22, v1, 2, 2
v_cmp_eq_u32 vcc, 0, v22
s_nop 1
v_cndmask_b32 v20, 0, v2, vcc
v_cmp_eq_u32 vcc, 1, v22
s_nop 1
v_cndmask_b32 v21, 0, v2, vcc
v_accvgpr_write_b32 a208, v20
v_accvgpr_write_b32 a209, v21
v_accvgpr_write_b32 a210, v20
v_accvgpr_write_b32 a211, v21
v_accvgpr_write_b32 a212, 0
v_accvgpr_write_b32 a213, 0
v_accvgpr_write_b32 a214, 0
v_accvgpr_write_b32 a215, 0
v_accvgpr_write_b32 a216, 0
v_accvgpr_write_b32 a217, 0
v_accvgpr_write_b32 a218, 0
v_accvgpr_write_b32 a219, 0
s_cmp_lt_u32 s3, 2
s_cselect_b32 s40, s32, s80
s_cselect_b32 s41, s33, s81
s_cselect_b32 s42, s34, s82
s_add_u32 s62, s55, 84480
v_lshl_add_u32 v9, v1, 4, s62
s_lshl_b32 s62, s6, 10
s_add_u32 s62, s62, 30441472
s_lshl_b32 s64, s10, 1
s_lshl_b32 s64, s64, 10
s_add_u32 s64, s64, 30441472
s_lshr_b32 s67, s5, 2
s_and_b32 s67, s67, 3
s_lshl_b32 s67, s67, 7
s_add_u32 s64, s64, s67
s_add_u32 s65, s64, 1024
v_lshl_add_u32 v252, v1, 7, s62
v_mov_b32 v253, s64
v_mov_b32 v255, 1
v_writelane_b32 v253, s65, 1
s_waitcnt vmcnt(0) lgkmcnt(0)
s_cmp_lg_u32 s3, 1
s_barrier
s_cbranch_scc1 .Lnopoll37
s_mov_b64 exec, 15
buffer_atomic_add v255, v252, s[16:19], 0 offen
s_mov_b64 exec, 3
v_mov_b32 v254, 0
buffer_atomic_add v254, v253, s[16:19], 0 offen sc0
s_sleep 5
s_mov_b32 s15, 0
.Lpoll36:
v_mov_b32 v255, 0
buffer_atomic_add v255, v253, s[16:19], 0 offen sc0
s_waitcnt vmcnt(1)
v_cmp_gt_u32 vcc, 16, v254
s_add_u32 s15, s15, 1
s_cbranch_vccz .Lnopoll37r
v_mov_b32 v254, 0
buffer_atomic_add v254, v253, s[16:19], 0 offen sc0
s_waitcnt vmcnt(1)
v_cmp_gt_u32 vcc, 16, v255
s_add_u32 s15, s15, 1
s_cbranch_vccz .Lnopoll37r
s_cmp_le_u32 s15, 100000
s_cbranch_scc1 .Lpoll36
s_branch .Lnopoll37r
.Lnopoll37:
s_mov_b64 exec, 0
s_cmp_eq_u32 s3, 2
s_cbranch_scc1 .Lpad17
s_cmp_eq_u32 s3, 3
s_cbranch_scc1 .Lpad18
s_branch .Lpad19
.Lnopoll37r:
s_mov_b64 exec, -1
s_barrier
buffer_load_dwordx4 a[128:131], v10, s[16:19], s52 offen sc1
buffer_load_dwordx4 a[132:135], v10, s[16:19], s52 offen offset:1024 sc1
s_add_u32 s52, s52, 131072
buffer_load_dwordx4 a[144:147], v10, s[16:19], s52 offen sc1
buffer_load_dwordx4 a[148:151], v10, s[16:19], s52 offen offset:1024 sc1
s_add_u32 s52, s52, 131072
buffer_load_dwordx4 a[136:139], v11, s[16:19], s53 offen sc1
buffer_load_dwordx4 a[140:143], v11, s[16:19], s53 offen offset:1024 sc1
s_add_u32 s53, s53, 131072
buffer_load_dwordx4 a[152:155], v11, s[16:19], s53 offen sc1
buffer_load_dwordx4 a[156:159], v11, s[16:19], s53 offen offset:1024 sc1
s_add_u32 s53, s53, 131072
ds_read_b64_tr_b16 a[0:1], v16
TR 2,16,512
TR 4,16,8448
TR 6,16,8960
TR 8,16,32
TR 10,16,544
TR 12,16,8480
TR 14,16,8992
TR 16,16,64
TR 18,16,576
TR 20,16,8512
TR 22,16,9024
TR 24,16,96
TR 26,16,608
TR 28,16,8544
TR 30,16,9056
TR 32,16,128
TR 34,16,640
TR 36,16,8576
TR 38,16,9088
TR 40,16,160
TR 42,16,672
TR 44,16,8608
TR 46,16,9120
ds_read_b64_tr_b16 a[48:49], v17
TR 50,17,512
TR 52,17,8448
TR 54,17,8960
TR 56,17,32
TR 58,17,544
TR 60,17,8480
TR 62,17,8992
ds_read_b128 a[192:195], v9
RD 196,9,1056
RD 200,9,2112
RD 204,9,3168
s_add_u32 m0, s55, 135168
s_nop 0
buffer_load_dwordx4 v12, s[80:83], s54 offen   lds
buffer_load_dwordx4 v13, s[80:83], s54 offen offset:1056   lds
buffer_load_dwordx4 v14, s[80:83], s54 offen offset:2112   lds
buffer_load_dwordx4 v15, s[80:83], s54 offen offset:3168   lds
s_add_u32 s54, s54, 458752
s_lshl_b32 s57, s3, 13
s_add_u32 s57, s57, 49920
v_lshl_add_u32 v2, v1, 4, s57
s_waitcnt lgkmcnt(0)
s_barrier
s_waitcnt vmcnt(11)
v_mfma_f32_16x16x32_bf16 v[32:35], a[0:3], a[128:131], 0
buffer_load_dwordx4 a[160:163], v10, s[16:19], s52 offen sc1
s_waitcnt vmcnt(10)
MAA 32,4,144
TR 64,16,16896
v_smfmac_f32_16x16x64_bf16 a[212:215], a[208:211], a[192:199], v6
TR 66,16,17408
v_smfmac_f32_16x16x64_bf16 a[212:215], a[208:211], a[200:207], v6
TR 68,16,25344
v_mfma_f32_16x16x32_bf16 v[36:39], a[0:3], a[132:135], 0
TR 70,16,25856
s_waitcnt vmcnt(9)
MAA 36,4,148
buffer_load_dwordx4 a[164:167], v10, s[16:19], s52 offen offset:1024 sc1
v_mfma_f32_16x16x32_bf16 v[52:55], a[8:11], a[132:135], 0
TR 72,16,16928
s_add_u32 s52, s52, 131072
MAA 52,12,148
TR 74,16,17440
v_mfma_f32_16x16x32_bf16 v[48:51], a[8:11], a[128:131], 0
TR 76,16,25376
MAA 48,12,144
TR 78,16,25888
v_mfma_f32_16x16x32_bf16 v[96:99], a[16:19], a[128:131], 0
buffer_load_dwordx4 a[176:179], v10, s[16:19], s52 offen sc1
MAA 96,20,144
TR 80,16,16960
v_mfma_f32_16x16x32_bf16 v[100:103], a[16:19], a[132:135], 0
TR 82,16,17472
MAA 100,20,148
TR 84,16,25408
v_mfma_f32_16x16x32_bf16 v[116:119], a[24:27], a[132:135], 0
TR 86,16,25920
MAA 116,28,148
buffer_load_dwordx4 a[180:183], v10, s[16:19], s52 offen offset:1024 sc1
v_mfma_f32_16x16x32_bf16 v[112:115], a[24:27], a[128:131], 0
TR 88,16,16992
s_add_u32 s52, s52, 131072
MAA 112,28,144
TR 90,16,17504
v_mfma_f32_16x16x32_bf16 v[160:163], a[32:35], a[128:131], 0
TR 92,16,25440
MAA 160,36,144
TR 94,16,25952
v_mfma_f32_16x16x32_bf16 v[164:167], a[32:35], a[132:135], 0
buffer_load_dwordx4 a[168:171], v11, s[16:19], s53 offen sc1
MAA 164,36,148
TR 96,16,17024
v_mfma_f32_16x16x32_bf16 v[180:183], a[40:43], a[132:135], 0
TR 98,16,17536
MAA 180,44,148
TR 100,16,25472
v_mfma_f32_16x16x32_bf16 v[176:179], a[40:43], a[128:131], 0
TR 102,16,25984
MAA 176,44,144
buffer_load_dwordx4 a[172:175], v11, s[16:19], s53 offen offset:1024 sc1
v_mfma_f32_16x16x32_bf16 v[224:227], a[48:51], a[128:131], 0
TR 104,16,17056
s_add_u32 s53, s53, 131072
MAA 224,52,144
TR 106,16,17568
v_mfma_f32_16x16x32_bf16 v[228:231], a[48:51], a[132:135], 0
TR 108,16,25504
MAA 228,52,148
TR 110,16,26016
v_mfma_f32_16x16x32_bf16 v[236:239], a[56:59], a[132:135], 0
buffer_load_dwordx4 a[184:187], v11, s[16:19], s53 offen sc1
MAA 236,60,148
TR 112,17,16896
v_mfma_f32_16x16x32_bf16 v[232:235], a[56:59], a[128:131], 0
TR 114,17,17408
MAA 232,60,144
TR 116,17,25344
s_waitcnt vmcnt(11)
v_mfma_f32_16x16x32_bf16 v[188:191], a[40:43], a[140:143], 0
TR 118,17,25856
MAA 188,44,156
buffer_load_dwordx4 a[188:191], v11, s[16:19], s53 offen offset:1024 sc1
v_mfma_f32_16x16x32_bf16 v[184:187], a[40:43], a[136:139], 0
TR 120,17,16928
s_add_u32 s53, s53, 131072
MAA 184,44,152
TR 122,17,17440
s_add_u32 m0, s55, 84480
v_mfma_f32_16x16x32_bf16 v[168:171], a[32:35], a[136:139], 0
TR 124,17,25376
MAA 168,36,152
TR 126,17,25888
v_mfma_f32_16x16x32_bf16 v[172:175], a[32:35], a[140:143], 0
buffer_load_dwordx4 v12, s[32:35], s54 offen   lds
MAA 172,36,156
RD 192,9,16896
v_mfma_f32_16x16x32_bf16 v[124:127], a[24:27], a[140:143], 0
RD 196,9,17952
MAA 124,28,156
RD 200,9,19008
v_mfma_f32_16x16x32_bf16 v[120:123], a[24:27], a[136:139], 0
RD 204,9,20064
MAA 120,28,152
buffer_load_dwordx4 v13, s[32:35], s54 offen offset:1056   lds
v_mfma_f32_16x16x32_bf16 v[104:107], a[16:19], a[136:139], 0
MAA 104,20,152
v_mfma_f32_16x16x32_bf16 v[108:111], a[16:19], a[140:143], 0
MAA 108,20,156
v_mfma_f32_16x16x32_bf16 v[60:63], a[8:11], a[140:143], 0
buffer_load_dwordx4 v14, s[32:35], s54 offen offset:2112   lds
MAA 60,12,156
v_mfma_f32_16x16x32_bf16 v[56:59], a[8:11], a[136:139], 0
MAA 56,12,152
v_mfma_f32_16x16x32_bf16 v[40:43], a[0:3], a[136:139], 0
MAA 40,4,152
buffer_load_dwordx4 v15, s[32:35], s54 offen offset:3168   lds
v_mfma_f32_16x16x32_bf16 v[44:47], a[0:3], a[140:143], 0
MAA 44,4,156
s_waitcnt lgkmcnt(0)
s_barrier
v_mfma_f32_16x16x32_bf16 v[64:67], a[64:67], a[128:131], 0
TR 0,16,33792
s_add_u32 m0, s55, 101376
MAA 64,68,144
buffer_load_dwordx4 v12, s[80:83], s54 offen   lds
v_smfmac_f32_16x16x64_bf16 a[216:219], a[208:211], a[192:199], v6
TR 2,16,34304
s_mul_i32 s66, s13, 114688
v_smfmac_f32_16x16x64_bf16 a[216:219], a[208:211], a[200:207], v6
TR 4,16,42240
s_mul_i32 s65, s10, 1818624
v_mfma_f32_16x16x32_bf16 v[68:71], a[64:67], a[132:135], 0
TR 6,16,42752
s_add_u32 s66, s66, s65
MAA 68,68,148
TR 8,16,33824
s_add_u32 s66, s66, 12582912
v_mfma_f32_16x16x32_bf16 v[84:87], a[72:75], a[132:135], 0
buffer_load_dwordx4 v13, s[80:83], s54 offen offset:1056   lds
MAA 84,76,148
TR 10,16,34336
s_add_u32 s65, s66, 49152
v_mfma_f32_16x16x32_bf16 v[80:83], a[72:75], a[128:131], 0
TR 12,16,42272
s_lshl_b32 s62, s12, 16
MAA 80,76,144
TR 14,16,42784
s_add_u32 s62, s62, s66
v_mfma_f32_16x16x32_bf16 v[128:131], a[80:83], a[128:131], 0
TR 16,16,33856
s_add_u32 s63, s62, 16384
MAA 128,84,144
buffer_load_dwordx4 v14, s[80:83], s54 offen offset:2112   lds
v_mfma_f32_16x16x32_bf16 v[132:135], a[80:83], a[132:135], 0
TR 18,16,34368
s_add_u32 s64, s62, 32768
MAA 132,84,148
TR 20,16,42304
s_lshl_b32 s72, s10, 1
v_mfma_f32_16x16x32_bf16 v[148:151], a[88:91], a[132:135], 0
TR 22,16,42816
s_lshr_b32 s74, s11, 4
MAA 148,92,148
TR 24,16,33888
s_add_u32 s72, s72, s74
v_mfma_f32_16x16x32_bf16 v[144:147], a[88:91], a[128:131], 0
buffer_load_dwordx4 v15, s[80:83], s54 offen offset:3168   lds
MAA 144,92,144
TR 26,16,34400
s_add_u32 s54, s54, 458752
v_mfma_f32_16x16x32_bf16 v[192:195], a[96:99], a[128:131], 0
TR 28,16,42336
s_add_u32 m0, s57, 0
MAA 192,100,144
TR 30,16,42848
s_mov_b32 s58, 29622272
v_mfma_f32_16x16x32_bf16 v[196:199], a[96:99], a[132:135], 0
TR 32,16,33920
s_lshl_b32 s72, s72, 10
MAA 196,100,148
buffer_load_dwordx4 v4, s[16:19], s58 offen sc1 lds
v_mfma_f32_16x16x32_bf16 v[212:215], a[104:107], a[132:135], 0
TR 34,16,34432
s_add_u32 s72, s72, 30457856
MAA 212,108,148
TR 36,16,42368
s_and_b32 s73, s6, 14
v_mfma_f32_16x16x32_bf16 v[208:211], a[104:107], a[128:131], 0
TR 38,16,42880
s_and_b32 s74, s7, 1
MAA 208,108,144
TR 40,16,33952
s_add_u32 s73, s73, s74
v_mfma_f32_16x16x32_bf16 v[240:243], a[112:115], a[128:131], 0
buffer_load_dwordx4 v4, s[16:19], s58 offen offset:1024 sc1 lds
MAA 240,116,144
TR 42,16,34464
s_lshl_b32 s73, s73, 10
v_mfma_f32_16x16x32_bf16 v[244:247], a[112:115], a[132:135], 0
TR 44,16,42400
s_add_u32 s73, s73, 30457856
MAA 244,116,148
TR 46,16,42912
s_lshr_b32 s67, s5, 2
v_mfma_f32_16x16x32_bf16 v[252:255], a[120:123], a[132:135], 0
TR 48,17,33792
MAA 252,124,148
TR 50,17,34304
v_mfma_f32_16x16x32_bf16 v[248:251], a[120:123], a[128:131], 0
buffer_load_dwordx4 a[128:131], v10, s[16:19], s52 offen sc1
MAA 248,124,144
TR 52,17,42240
v_mfma_f32_16x16x32_bf16 v[220:223], a[104:107], a[140:143], 0
TR 54,17,42752
MAA 220,108,156
TR 56,17,33824
v_mfma_f32_16x16x32_bf16 v[216:219], a[104:107], a[136:139], 0
TR 58,17,34336
MAA 216,108,152
buffer_load_dwordx4 a[132:135], v10, s[16:19], s52 offen offset:1024 sc1
v_mfma_f32_16x16x32_bf16 v[200:203], a[96:99], a[136:139], 0
TR 60,17,42272
s_add_u32 s52, s52, 131072
MAA 200,100,152
TR 62,17,42784
v_mfma_f32_16x16x32_bf16 v[204:207], a[96:99], a[140:143], 0
RD 192,9,33792
MAA 204,100,156
RD 196,9,34848
v_mfma_f32_16x16x32_bf16 v[156:159], a[88:91], a[140:143], 0
buffer_load_dwordx4 a[144:147], v10, s[16:19], s52 offen sc1
MAA 156,92,156
RD 200,9,35904
v_mfma_f32_16x16x32_bf16 v[152:155], a[88:91], a[136:139], 0
RD 204,9,36960
MAA 152,92,152
v_mfma_f32_16x16x32_bf16 v[136:139], a[80:83], a[136:139], 0
MAA 136,84,152
buffer_load_dwordx4 a[148:151], v10, s[16:19], s52 offen offset:1024 sc1
v_mfma_f32_16x16x32_bf16 v[140:143], a[80:83], a[140:143], 0
s_add_u32 s52, s52, 131072
MAA 140,84,156
v_mfma_f32_16x16x32_bf16 v[92:95], a[72:75], a[140:143], 0
MAA 92,76,156
v_mfma_f32_16x16x32_bf16 v[88:91], a[72:75], a[136:139], 0
MAA 88,76,152
v_mfma_f32_16x16x32_bf16 v[72:75], a[64:67], a[136:139], 0
MAA 72,68,152
v_mfma_f32_16x16x32_bf16 v[76:79], a[64:67], a[140:143], 0
MAA 76,68,156
s_waitcnt vmcnt(18) lgkmcnt(0)
s_barrier
MAA 32,0,160
buffer_load_dwordx4 a[136:139], v11, s[16:19], s53 offen sc1
MAA 32,4,176
TR 64,16,50688
s_and_b32 s67, s67, 3
v_smfmac_f32_16x16x64_bf16 a[212:215], a[208:211], a[192:199], v6
TR 66,16,51200
s_lshl_b32 s67, s67, 7
v_smfmac_f32_16x16x64_bf16 a[212:215], a[208:211], a[200:207], v6
TR 68,16,59136
s_add_u32 s73, s73, s67
MAA 36,4,180
TR 70,16,59648
s_and_b32 s74, s7, 1
MAA 36,0,164
buffer_load_dwordx4 a[140:143], v11, s[16:19], s53 offen offset:1024 sc1
MAA 52,8,164
TR 72,16,50720
s_add_u32 s53, s53, 131072
MAA 52,12,180
TR 74,16,51232
s_mul_i32 s87, s74, 917504
MAA 48,12,176
TR 76,16,59168
s_lshr_b32 s75, s6, 1
MAA 48,8,160
TR 78,16,59680
s_mul_i32 s75, s75, 1818624
MAA 96,16,160
buffer_load_dwordx4 a[152:155], v11, s[16:19], s53 offen sc1
MAA 96,20,176
TR 80,16,50752
s_add_u32 s87, s87, s75
MAA 100,20,180
TR 82,16,51264
s_add_u32 s87, s87, 12582912
MAA 100,16,164
TR 84,16,59200
s_and_b32 s74, s6, 3
MAA 116,24,164
.Lpad13:
s_cbranch_execz .Lpad16
TR 86,16,59712
s_xor_b32 s75, s74, 0
MAA 116,28,180
buffer_load_dwordx4 a[156:159], v11, s[16:19], s53 offen offset:1024 sc1
MAA 112,28,176
TR 88,16,50784
s_add_u32 s53, s53, 131072
MAA 112,24,160
TR 90,16,51296
s_add_u32 m0, s55, 118272
MAA 160,32,160
TR 92,16,59232
s_sub_u32 s75, s75, 0
MAA 160,36,176
TR 94,16,59744
s_mul_i32 s98, s75, 458752
MAA 164,36,180
buffer_load_dwordx4 v12, s[32:35], s54 offen   lds
MAA 164,32,164
TR 96,16,50816
s_mul_i32 s75, s75, 114688
MAA 180,40,164
TR 98,16,51328
s_add_u32 s76, s87, s75
MAA 180,44,180
TR 100,16,59264
s_xor_b32 s75, s74, 1
MAA 176,44,176
TR 102,16,59776
s_sub_u32 s75, s75, 1
MAA 176,40,160
buffer_load_dwordx4 v13, s[32:35], s54 offen offset:1056   lds
MAA 224,48,160
TR 104,16,50848
s_mul_i32 s99, s75, 458752
MAA 224,52,176
TR 106,16,51360
s_mul_i32 s75, s75, 114688
MAA 228,52,180
TR 108,16,59296
s_add_u32 s77, s87, s75
MAA 228,48,164
TR 110,16,59808
MAA 236,56,164
buffer_load_dwordx4 v14, s[32:35], s54 offen offset:2112   lds
MAA 236,60,180
TR 112,17,50688
MAA 232,60,176
TR 114,17,51200
MAA 232,56,160
TR 116,17,59136
s_waitcnt vmcnt(21)
MAA 188,40,172
TR 118,17,59648
MAA 188,44,188
buffer_load_dwordx4 v15, s[32:35], s54 offen offset:3168   lds
MAA 184,44,184
TR 120,17,50720
s_add_u32 m0, s57, 2048
MAA 184,40,168
TR 122,17,51232
s_mov_b32 s58, 29624320
MAA 168,32,168
TR 124,17,59168
MAA 168,36,184
TR 126,17,59680
MAA 172,36,188
buffer_load_dwordx4 v4, s[16:19], s58 offen sc1 lds
MAA 172,32,172
RD 192,9,50688
MAA 124,24,172
RD 196,9,51744
MAA 124,28,188
RD 200,9,52800
MAA 120,28,184
RD 204,9,53856
MAA 120,24,168
buffer_load_dwordx4 v4, s[16:19], s58 offen offset:1024 sc1 lds
MAA 104,16,168
MAA 104,20,184
MAA 108,20,188
MAA 108,16,172
MAA 60,8,172
MAA 60,12,188
MAA 56,12,184
MAA 56,8,168
MAA 40,0,168
MAA 40,4,184
MAA 44,4,188
MAA 44,0,172
s_waitcnt vmcnt(20) lgkmcnt(0)
s_barrier
MAA 64,64,160
ds_read_b64_tr_b16 a[0:1], v16
s_add_u32 m0, s55, 135168
MAA 64,68,176
buffer_load_dwordx4 v12, s[80:83], s54 offen   lds
v_smfmac_f32_16x16x64_bf16 a[216:219], a[208:211], a[192:199], v6
TR 2,16,512
s_xor_b32 s75, s74, 2
v_smfmac_f32_16x16x64_bf16 a[216:219], a[208:211], a[200:207], v6
TR 4,16,8448
s_sub_u32 s75, s75, 2
MAA 68,68,180
TR 6,16,8960
s_mul_i32 s100, s75, 458752
MAA 68,64,164
TR 8,16,32
s_mul_i32 s75, s75, 114688
MAA 84,72,164
buffer_load_dwordx4 v13, s[80:83], s54 offen offset:1056   lds
MAA 84,76,180
TR 10,16,544
s_add_u32 s78, s87, s75
MAA 80,76,176
TR 12,16,8480
s_xor_b32 s75, s74, 3
MAA 80,72,160
TR 14,16,8992
s_sub_u32 s75, s75, 3
MAA 128,80,160
TR 16,16,64
s_mul_i32 s101, s75, 458752
MAA 128,84,176
buffer_load_dwordx4 v14, s[80:83], s54 offen offset:2112   lds
MAA 132,84,180
TR 18,16,576
s_mul_i32 s75, s75, 114688
MAA 132,80,164
TR 20,16,8512
s_add_u32 s79, s87, s75
MAA 148,88,164
TR 22,16,9024
s_and_b32 s87, s6, 3
MAA 148,92,180
TR 24,16,96
s_mov_b32 s46, 0
MAA 144,92,176
buffer_load_dwordx4 v15, s[80:83], s54 offen offset:3168   lds
MAA 144,88,160
TR 26,16,608
s_add_u32 s54, s54, 458752
MAA 192,96,160
TR 28,16,8544
s_add_u32 m0, s57, 4096
MAA 192,100,176
TR 30,16,9056
s_mov_b32 s58, 29626368
MAA 196,100,180
TR 32,16,128
s_lshl_b32 s74, s3, 10
MAA 196,96,164
buffer_load_dwordx4 v4, s[16:19], s58 offen sc1 lds
MAA 212,104,164
TR 34,16,640
s_lshl_b32 s75, s12, 9
MAA 212,108,180
TR 36,16,8576
s_add_u32 s74, s74, s75
MAA 208,108,176
TR 38,16,9088
s_add_u32 s74, s74, 152576
MAA 208,104,160
TR 40,16,160
v_and_b32 v18, 15, v1
MAA 240,112,160
buffer_load_dwordx4 v4, s[16:19], s58 offen offset:1024 sc1 lds
MAA 240,116,176
TR 42,16,672
v_lshl_add_u32 v18, v18, 4, s74
MAA 244,116,180
TR 44,16,8608
v_xor_b32 v19, 512, v18
MAA 244,112,164
TR 46,16,9120
MAA 252,120,164
ds_read_b64_tr_b16 a[48:49], v17
MAA 252,124,180
TR 50,17,512
MAA 248,124,176
TR 52,17,8448
MAA 248,120,160
buffer_load_dwordx4 a[160:163], v10, s[16:19], s52 offen sc1
MAA 220,104,172
TR 54,17,8960
MAA 220,108,188
TR 56,17,32
MAA 216,108,184
TR 58,17,544
MAA 216,104,168
TR 60,17,8480
MAA 200,96,168
buffer_load_dwordx4 a[164:167], v10, s[16:19], s52 offen offset:1024 sc1
MAA 200,100,184
TR 62,17,8992
s_add_u32 s52, s52, 131072
MAA 204,100,188
ds_read_b128 a[192:195], v9
MAA 204,96,172
RD 196,9,1056
MAA 156,88,172
RD 200,9,2112
MAA 156,92,188
buffer_load_dwordx4 a[176:179], v10, s[16:19], s52 offen sc1
MAA 152,92,184
RD 204,9,3168
MAA 152,88,168
MAA 136,80,168
MAA 136,84,184
MAA 140,84,188
buffer_load_dwordx4 a[180:183], v10, s[16:19], s52 offen offset:1024 sc1
MAA 140,80,172
s_add_u32 s52, s52, 131072
MAA 92,72,172
MAA 92,76,188
MAA 88,76,184
MAA 88,72,168
MAA 72,64,168
MAA 72,68,184
MAA 76,68,188
MAA 76,64,172
s_waitcnt vmcnt(20) lgkmcnt(0)
s_barrier
MAA 32,0,128
buffer_load_dwordx4 a[168:171], v11, s[16:19], s53 offen sc1
MAA 32,4,144
ds_read_b128 v[20:23], v2
v_smfmac_f32_16x16x64_bf16 a[212:215], a[208:211], a[192:199], v6
ds_read_b128 v[28:31], v2 offset:1024
v_smfmac_f32_16x16x64_bf16 a[212:215], a[208:211], a[200:207], v6
s_waitcnt vmcnt(11)
ds_read_b128 v[24:27], v2 offset:2048
MAA 36,4,148
TR 64,16,16896
MAA 36,0,132
buffer_load_dwordx4 a[172:175], v11, s[16:19], s53 offen offset:1024 sc1
MAA 52,8,132
TR 66,16,17408
s_add_u32 s53, s53, 131072
MAA 52,12,148
TR 68,16,25344
MAA 48,12,144
TR 70,16,25856
MAA 48,8,128
TR 72,16,16928
MAA 96,16,128
buffer_load_dwordx4 a[184:187], v11, s[16:19], s53 offen sc1
MAA 96,20,144
TR 74,16,17440
s_waitcnt lgkmcnt(7)
v_add_f32 v20, v20, v28
MAA 100,20,148
TR 76,16,25376
v_add_f32 v21, v21, v29
MAA 100,16,132
TR 78,16,25888
v_add_f32 v22, v22, v30
MAA 116,24,132
TR 80,16,16960
v_add_f32 v23, v23, v31
MAA 116,28,148
buffer_load_dwordx4 a[188:191], v11, s[16:19], s53 offen offset:1024 sc1
MAA 112,28,144
ds_read_b128 v[28:31], v2 offset:3072
s_add_u32 s53, s53, 131072
MAA 112,24,128
TR 82,16,17472
s_add_u32 m0, s55, 84480
MAA 160,32,128
TR 84,16,25408
s_waitcnt lgkmcnt(12)
v_add_f32 v20, v20, v24
MAA 160,36,144
TR 86,16,25920
v_add_f32 v21, v21, v25
MAA 164,36,148
buffer_load_dwordx4 v12, s[32:35], s54 offen   lds
MAA 164,32,132
TR 88,16,16992
v_add_f32 v22, v22, v26
MAA 180,40,132
TR 90,16,17504
v_add_f32 v23, v23, v27
MAA 180,44,148
TR 92,16,25440
MAA 176,44,144
TR 94,16,25952
MAA 176,40,128
buffer_load_dwordx4 v13, s[32:35], s54 offen offset:1056   lds
MAA 224,48,128
TR 96,16,17024
MAA 224,52,144
TR 98,16,17536
MAA 228,52,148
TR 100,16,25472
MAA 228,48,132
TR 102,16,25984
MAA 236,56,132
buffer_load_dwordx4 v14, s[32:35], s54 offen offset:2112   lds
MAA 236,60,148
TR 104,16,17056
MAA 232,60,144
TR 106,16,17568
MAA 232,56,128
TR 108,16,25504
MAA 188,40,140
TR 110,16,26016
MAA 188,44,156
buffer_load_dwordx4 v15, s[32:35], s54 offen offset:3168   lds
MAA 184,44,152
TR 112,17,16896
s_add_u32 m0, s57, 6144
MAA 184,40,136
TR 114,17,17408
s_mov_b32 s58, 29628416
MAA 168,32,136
TR 116,17,25344
MAA 168,36,152
TR 118,17,25856
MAA 172,36,156
buffer_load_dwordx4 v4, s[16:19], s58 offen sc1 lds
MAA 172,32,140
TR 120,17,16928
MAA 124,24,140
TR 122,17,17440
MAA 124,28,156
TR 124,17,25376
MAA 120,28,152
TR 126,17,25888
MAA 120,24,136
buffer_load_dwordx4 v4, s[16:19], s58 offen offset:1024 sc1 lds
MAA 104,16,136
RD 192,9,16896
MAA 104,20,152
RD 196,9,17952
MAA 108,20,156
RD 200,9,19008
MAA 108,16,140
RD 204,9,20064
MAA 60,8,140
MAA 60,12,156
MAA 56,12,152
MAA 56,8,136
MAA 40,0,136
MAA 40,4,152
MAA 44,4,156
s_sub_u32 s47, s47, 1
s_cbranch_scc1 .Lx39
.Lx39b:
MAA 44,0,140
s_waitcnt lgkmcnt(0)
s_barrier
MAA 64,64,128
s_waitcnt vmcnt(14)
ds_read_b128 v[24:27], v2 offset:4096
s_add_u32 m0, s55, 101376
MAA 64,68,144
buffer_load_dwordx4 v12, s[80:83], s54 offen   lds
v_smfmac_f32_16x16x64_bf16 a[216:219], a[208:211], a[192:199], v6
TR 0,16,33792
v_add_f32 v20, v20, v28
v_smfmac_f32_16x16x64_bf16 a[216:219], a[208:211], a[200:207], v6
TR 2,16,34304
v_add_f32 v21, v21, v29
MAA 68,68,148
TR 4,16,42240
v_add_f32 v22, v22, v30
MAA 68,64,132
TR 6,16,42752
v_add_f32 v23, v23, v31
MAA 84,72,132
ds_read_b128 v[28:31], v2 offset:5120
MAA 84,76,148
TR 8,16,33824
MAA 80,76,144
buffer_load_dwordx4 v13, s[80:83], s54 offen offset:1056   lds
MAA 80,72,128
TR 10,16,34336
s_waitcnt lgkmcnt(7)
v_add_f32 v20, v20, v24
MAA 128,80,128
TR 12,16,42272
v_add_f32 v21, v21, v25
MAA 128,84,144
TR 14,16,42784
v_add_f32 v22, v22, v26
MAA 132,84,148
TR 16,16,33856
v_add_f32 v23, v23, v27
MAA 132,80,132
TR 18,16,34368
MAA 148,88,132
TR 20,16,42304
MAA 148,92,148
buffer_load_dwordx4 v14, s[80:83], s54 offen offset:2112   lds
MAA 144,92,144
TR 22,16,42816
MAA 144,88,128
TR 24,16,33888
MAA 192,96,128
TR 26,16,34400
MAA 192,100,144
TR 28,16,42336
MAA 196,100,148
TR 30,16,42848
MAA 196,96,132
TR 32,16,33920
MAA 212,104,132
buffer_load_dwordx4 v15, s[80:83], s54 offen offset:3168   lds
MAA 212,108,148
TR 34,16,34432
s_add_u32 s54, s54, 458752
MAA 208,108,144
TR 36,16,42368
MAA 208,104,128
TR 38,16,42880
MAA 240,112,128
TR 40,16,33952
MAA 240,116,144
TR 42,16,34464
MAA 244,116,148
TR 44,16,42400
MAA 244,112,132
TR 46,16,42912
MAA 252,120,132
TR 48,17,33792
MAA 252,124,148
TR 50,17,34304
MAA 248,124,144
TR 52,17,42240
MAA 248,120,128
buffer_load_dwordx4 a[128:131], v10, s[16:19], s52 offen sc1
MAA 220,104,140
TR 54,17,42752
MAA 220,108,156
TR 56,17,33824
MAA 216,108,152
TR 58,17,34336
MAA 216,104,136
TR 60,17,42272
MAA 200,96,136
TR 62,17,42784
MAA 200,100,152
RD 192,9,33792
MAA 204,100,156
buffer_load_dwordx4 a[132:135], v10, s[16:19], s52 offen offset:1024 sc1
MAA 204,96,140
RD 196,9,34848
s_add_u32 s52, s52, 131072
MAA 156,88,140
RD 200,9,35904
MAA 156,92,156
RD 204,9,36960
MAA 152,92,152
MAA 152,88,136
MAA 136,80,136
MAA 136,84,152
buffer_load_dwordx4 a[144:147], v10, s[16:19], s52 offen sc1
MAA 140,84,156
MAA 140,80,140
MAA 92,72,140
MAA 92,76,156
MAA 88,76,152
MAA 88,72,136
MAA 72,64,136
buffer_load_dwordx4 a[148:151], v10, s[16:19], s52 offen offset:1024 sc1
MAA 72,68,152
s_add_u32 s52, s52, 131072
MAA 76,68,156
s_sub_u32 s47, s47, 1
s_cbranch_scc1 .Lx40
.Lx40b:
MAA 76,64,140
s_waitcnt vmcnt(18) lgkmcnt(0)
s_barrier
MAA 32,0,160
buffer_load_dwordx4 a[136:139], v11, s[16:19], s53 offen sc1
MAA 32,4,176
s_waitcnt vmcnt(9)
ds_read_b128 v[24:27], v2 offset:6144
v_add_f32 v20, v20, v28
v_smfmac_f32_16x16x64_bf16 a[212:215], a[208:211], a[192:199], v6
TR 64,16,50688
v_add_f32 v21, v21, v29
v_smfmac_f32_16x16x64_bf16 a[212:215], a[208:211], a[200:207], v6
TR 66,16,51200
v_add_f32 v22, v22, v30
MAA 36,4,180
TR 68,16,59136
v_add_f32 v23, v23, v31
MAA 36,0,164
ds_read_b128 v[28:31], v2 offset:7168
MAA 52,8,164
TR 70,16,59648
MAA 52,12,180
buffer_load_dwordx4 a[140:143], v11, s[16:19], s53 offen offset:1024 sc1
MAA 48,12,176
TR 72,16,50720
s_add_u32 s53, s53, 131072
MAA 48,8,160
TR 74,16,51232
s_waitcnt lgkmcnt(7)
v_add_f32 v20, v20, v24
MAA 96,16,160
TR 76,16,59168
v_add_f32 v21, v21, v25
MAA 96,20,176
TR 78,16,59680
v_add_f32 v22, v22, v26
MAA 100,20,180
TR 80,16,50752
v_add_f32 v23, v23, v27
MAA 100,16,164
TR 82,16,51264
s_waitcnt lgkmcnt(7)
v_add_f32 v20, v20, v28
MAA 116,24,164
buffer_load_dwordx4 a[152:155], v11, s[16:19], s53 offen sc1
MAA 116,28,180
TR 84,16,59200
v_add_f32 v21, v21, v29
MAA 112,28,176
TR 86,16,59712
v_add_f32 v22, v22, v30
MAA 112,24,160
TR 88,16,50784
v_add_f32 v23, v23, v31
MAA 160,32,160
TR 90,16,51296
MAA 160,36,176
TR 92,16,59232
MAA 164,36,180
TR 94,16,59744
MAA 164,32,164
buffer_load_dwordx4 a[156:159], v11, s[16:19], s53 offen offset:1024 sc1
MAA 180,40,164
TR 96,16,50816
s_add_u32 s53, s53, 131072
MAA 180,44,180
TR 98,16,51328
s_add_u32 m0, s55, 118272
MAA 176,44,176
TR 100,16,59264
MAA 176,40,160
TR 102,16,59776
MAA 224,48,160
TR 104,16,50848
.Lpad14:
s_cbranch_execz .Lnopoll34r
MAA 224,52,176
TR 106,16,51360
MAA 228,52,180
buffer_load_dwordx4 v12, s[32:35], s54 offen   lds
MAA 228,48,164
TR 108,16,59296
MAA 236,56,164
TR 110,16,59808
MAA 236,60,180
TR 112,17,50688
MAA 232,60,176
TR 114,17,51200
MAA 232,56,160
TR 116,17,59136
MAA 188,40,172
TR 118,17,59648
MAA 188,44,188
buffer_load_dwordx4 v13, s[32:35], s54 offen offset:1056   lds
MAA 184,44,184
TR 120,17,50720
MAA 184,40,168
TR 122,17,51232
MAA 168,32,168
TR 124,17,59168
MAA 168,36,184
TR 126,17,59680
MAA 172,36,188
RD 192,9,50688
MAA 172,32,172
RD 196,9,51744
MAA 124,24,172
buffer_load_dwordx4 v14, s[32:35], s54 offen offset:2112   lds
MAA 124,28,188
RD 200,9,52800
MAA 120,28,184
RD 204,9,53856
MAA 120,24,168
MAA 104,16,168
MAA 104,20,184
MAA 108,20,188
MAA 108,16,172
buffer_load_dwordx4 v15, s[32:35], s54 offen offset:3168   lds
MAA 60,8,172
MAA 60,12,188
MAA 56,12,184
MAA 56,8,168
MAA 40,0,168
MAA 40,4,184
MAA 44,4,188
s_sub_u32 s47, s47, 1
s_cbranch_scc1 .Lx41
.Lx41b:
MAA 44,0,172
s_waitcnt lgkmcnt(0)
s_barrier
MAA 64,64,160
ds_read_b64_tr_b16 a[0:1], v16
s_add_u32 m0, s55, 135168
MAA 64,68,176
buffer_load_dwordx4 v12, s[80:83], s54 offen   lds
v_smfmac_f32_16x16x64_bf16 a[216:219], a[208:211], a[192:199], v6
TR 2,16,512
v_permlane32_swap_b32 v20, v22
v_smfmac_f32_16x16x64_bf16 a[216:219], a[208:211], a[200:207], v6
TR 4,16,8448
v_permlane32_swap_b32 v21, v23
MAA 68,68,180
TR 6,16,8960
v_add_f32 v20, v20, v22
MAA 68,64,164
TR 8,16,32
v_add_f32 v21, v21, v23
MAA 84,72,164
TR 10,16,544
v_mul_f32 v20, 0xba800000, v20
MAA 84,76,180
buffer_load_dwordx4 v13, s[80:83], s54 offen offset:1056   lds
MAA 80,76,176
TR 12,16,8480
v_mul_f32 v21, 0x3a800000, v21
MAA 80,72,160
TR 14,16,8992
v_fma_f32 v21, -v20, v20, v21
MAA 128,80,160
TR 16,16,64
v_max_f32 v21, 0, v21
MAA 128,84,176
TR 18,16,576
v_add_f32 v21, 0x3727c5ac, v21
MAA 132,84,180
TR 20,16,8512
v_rsq_f32 v22, v21
MAA 132,80,164
TR 22,16,9024
v_and_b32 v24, 31, v1
MAA 148,88,164
buffer_load_dwordx4 v14, s[80:83], s54 offen offset:2112   lds
MAA 148,92,180
TR 24,16,96
v_lshrrev_b32 v25, 5, v1
MAA 144,92,176
TR 26,16,608
v_lshl_add_u32 v24, v24, 1, v25
MAA 144,88,160
TR 28,16,8544
v_and_b32 v25, 0xc0, v0
MAA 192,96,160
TR 30,16,9056
v_add_u32 v24, v24, v25
MAA 192,100,176
TR 32,16,128
v_lshlrev_b32 v24, 4, v24
MAA 196,100,180
TR 34,16,640
v_add_u32 v24, 152576, v24
MAA 196,96,164
buffer_load_dwordx4 v15, s[80:83], s54 offen offset:3168   lds
MAA 212,104,164
TR 36,16,8576
s_add_u32 s54, s54, 458752
MAA 212,108,180
TR 38,16,9088
v_mul_f32 v22, 0xbfb8aa3b, v22
MAA 208,108,176
ds_write_b128 v24, v[20:23]
s_mov_b32 s58, s98
MAA 208,104,160
ds_read_b64 v[20:21], v18
s_mov_b32 s67, s59
MAA 240,112,160
ds_read_b64 v[22:23], v18 offset:256
MAA 240,116,176
ds_read_b64 v[24:25], v19
MAA 244,116,180
ds_read_b64 v[26:27], v19 offset:256
MAA 244,112,164
ds_read_b32 v28, v18 offset:8
MAA 252,120,164
ds_read_b32 v29, v18 offset:264
v_mov_b32 v18, v5
MAA 252,124,180
ds_read_b32 v30, v19 offset:8
MAA 248,124,176
ds_read_b32 v31, v19 offset:264
v_add_u32 v19, 992, v5
MAA 248,120,160
buffer_load_dwordx4 a[160:163], v10, s[16:19], s52 offen sc1
MAA 220,104,172
TR 40,16,160
MAA 220,108,188
TR 42,16,672
MAA 216,108,184
TR 44,16,8608
MAA 216,104,168
TR 46,16,9120
MAA 200,96,168
ds_read_b64_tr_b16 a[48:49], v17
MAA 200,100,184
TR 50,17,512
MAA 204,100,188
buffer_load_dwordx4 a[164:167], v10, s[16:19], s52 offen offset:1024 sc1
MAA 204,96,172
TR 52,17,8448
s_add_u32 s52, s52, 131072
MAA 156,88,172
TR 54,17,8960
MAA 156,92,188
TR 56,17,32
MAA 152,92,184
TR 58,17,544
MAA 152,88,168
TR 60,17,8480
MAA 136,80,168
TR 62,17,8992
MAA 136,84,184
buffer_load_dwordx4 a[176:179], v10, s[16:19], s52 offen sc1
MAA 140,84,188
ds_read_b128 a[192:195], v9
MAA 140,80,172
RD 196,9,1056
MAA 92,72,172
RD 200,9,2112
MAA 92,76,188
RD 204,9,3168
MAA 88,76,184
MAA 88,72,168
MAA 72,64,168
buffer_load_dwordx4 a[180:183], v10, s[16:19], s52 offen offset:1024 sc1
MAA 72,68,184
s_add_u32 s52, s52, 131072
MAA 76,68,188
s_sub_u32 s47, s47, 1
s_cbranch_scc1 .Lx42
.Lx42b:
MAA 76,64,172
s_mov_b32 s15, -5
.p2align 6
.Lk43:
s_waitcnt vmcnt(16) lgkmcnt(0)
s_barrier
MAA 32,0,128
TR 64,16,16896
MAA 32,4,144
buffer_load_dwordx4 a[168:171], v11, s[16:19], s53 offen sc1
v_smfmac_f32_16x16x64_bf16 a[212:215], a[208:211], a[192:199], v6
s_sub_u32 s47, s47, 1
s_cbranch_scc1 .Lx44
.Lx44b:
v_smfmac_f32_16x16x64_bf16 a[212:215], a[208:211], a[200:207], v6
TR 66,16,17408
MAA 36,4,148
TR 68,16,25344
MAA 36,0,132
TR 70,16,25856
MAA 52,8,132
TR 72,16,16928
MAA 52,12,148
buffer_load_dwordx4 a[172:175], v11, s[16:19], s53 offen offset:1024 sc1
MAA 48,12,144
TR 74,16,17440
s_add_u32 s53, s53, 131072
MAA 48,8,128
MAA 96,16,128
TR 76,16,25376
MAA 96,20,144
TR 78,16,25888
MAA 100,20,148
TR 80,16,16960
MAA 100,16,132
buffer_load_dwordx4 a[184:187], v11, s[16:19], s53 offen sc1
MAA 116,24,132
TR 82,16,17472
MAA 116,28,148
TR 84,16,25408
MAA 112,28,144
MAA 112,24,128
TR 86,16,25920
MAA 160,32,128
TR 88,16,16992
MAA 160,36,144
buffer_load_dwordx4 a[188:191], v11, s[16:19], s53 offen offset:1024 sc1
MAA 164,36,148
TR 90,16,17504
s_add_u32 s53, s53, 131072
MAA 164,32,132
TR 92,16,25440
MAA 180,40,132
TR 94,16,25952
MAA 180,44,148
MAA 176,44,144
TR 96,16,17024
s_add_u32 m0, s55, 84480
MAA 176,40,128
buffer_load_dwordx4 v12, s[32:35], s54 offen   lds
MAA 224,48,128
TR 98,16,17536
MAA 224,52,144
TR 100,16,25472
MAA 228,52,148
TR 102,16,25984
MAA 228,48,132
TR 104,16,17056
MAA 236,56,132
MAA 236,60,148
TR 106,16,17568
MAA 232,60,144
TR 108,16,25504
MAA 232,56,128
TR 110,16,26016
s_waitcnt vmcnt(17)
MAA 188,40,140
TR 112,17,16896
MAA 188,44,156
buffer_load_dwordx4 v13, s[32:35], s54 offen offset:1056   lds
MAA 184,44,152
TR 114,17,17408
MAA 184,40,136
MAA 168,32,136
TR 116,17,25344
MAA 168,36,152
buffer_load_dwordx4 v14, s[32:35], s54 offen offset:2112   lds
MAA 172,36,156
TR 118,17,25856
MAA 172,32,140
TR 120,17,16928
MAA 124,24,140
TR 122,17,17440
MAA 124,28,156
TR 124,17,25376
MAA 120,28,152
MAA 120,24,136
buffer_load_dwordx4 v15, s[32:35], s54 offen offset:3168   lds
MAA 104,16,136
TR 126,17,25888
MAA 104,20,152
RD 192,9,16896
MAA 108,20,156
RD 196,9,17952
MAA 108,16,140
RD 200,9,19008
MAA 60,8,140
RD 204,9,20064
s_mov_b32 m0, s67
MAA 60,12,156
buffer_load_dwordx4 v18, s[28:31], s58 offen lds
MAA 56,12,152
MAA 56,8,136
MAA 40,0,136
MAA 40,4,152
MAA 44,4,156
MAA 44,0,140
s_waitcnt vmcnt(17) lgkmcnt(0)
s_barrier
MAA 64,64,128
TR 0,16,33792
s_add_u32 m0, s55, 101376
MAA 64,68,144
buffer_load_dwordx4 v12, s[80:83], s54 offen   lds
v_smfmac_f32_16x16x64_bf16 a[216:219], a[208:211], a[192:199], v6
s_sub_u32 s47, s47, 1
s_cbranch_scc1 .Lx45
.Lx45b:
v_smfmac_f32_16x16x64_bf16 a[216:219], a[208:211], a[200:207], v6
TR 2,16,34304
MAA 68,68,148
TR 4,16,42240
MAA 68,64,132
TR 6,16,42752
MAA 84,72,132
TR 8,16,33824
MAA 84,76,148
buffer_load_dwordx4 v13, s[80:83], s54 offen offset:1056   lds
MAA 80,76,144
TR 10,16,34336
MAA 80,72,128
MAA 128,80,128
TR 12,16,42272
MAA 128,84,144
TR 14,16,42784
MAA 132,84,148
TR 16,16,33856
MAA 132,80,132
buffer_load_dwordx4 v14, s[80:83], s54 offen offset:2112   lds
MAA 148,88,132
TR 18,16,34368
MAA 148,92,148
TR 20,16,42304
MAA 144,92,144
TR 22,16,42816
MAA 144,88,128
MAA 192,96,128
TR 24,16,33888
MAA 192,100,144
buffer_load_dwordx4 v15, s[80:83], s54 offen offset:3168   lds
MAA 196,100,148
TR 26,16,34400
s_add_u32 s54, s54, 458752
MAA 196,96,132
TR 28,16,42336
MAA 212,104,132
TR 30,16,42848
MAA 212,108,148
TR 32,16,33920
MAA 208,108,144
TR 34,16,34432
s_mov_b32 m0, s67
MAA 208,104,128
buffer_load_dwordx4 v19, s[28:31], s58 offen offset:1056 lds
MAA 240,112,128
s_add_u32 s67, s67, 8448
s_add_u32 s58, s58, 0x40000
MAA 240,116,144
MAA 244,116,148
TR 36,16,42368
MAA 244,112,132
TR 38,16,42880
MAA 252,120,132
TR 40,16,33952
MAA 252,124,148
TR 42,16,34464
MAA 248,124,144
TR 44,16,42400
MAA 248,120,128
buffer_load_dwordx4 a[128:131], v10, s[16:19], s52 offen sc1
MAA 220,104,140
TR 46,16,42912
MAA 220,108,156
MAA 216,108,152
TR 48,17,33792
MAA 216,104,136
TR 50,17,34304
MAA 200,96,136
TR 52,17,42240
MAA 200,100,152
buffer_load_dwordx4 a[132:135], v10, s[16:19], s52 offen offset:1024 sc1
MAA 204,100,156
TR 54,17,42752
s_add_u32 s52, s52, 131072
MAA 204,96,140
TR 56,17,33824
MAA 156,88,140
TR 58,17,34336
MAA 156,92,156
MAA 152,92,152
TR 60,17,42272
MAA 152,88,136
buffer_load_dwordx4 a[144:147], v10, s[16:19], s52 offen sc1
MAA 136,80,136
TR 62,17,42784
MAA 136,84,152
RD 192,9,33792
MAA 140,84,156
RD 196,9,34848
MAA 140,80,140
RD 200,9,35904
MAA 92,72,140
RD 204,9,36960
MAA 92,76,156
buffer_load_dwordx4 a[148:151], v10, s[16:19], s52 offen offset:1024 sc1
MAA 88,76,152
s_add_u32 s52, s52, 131072
MAA 88,72,136
MAA 72,64,136
MAA 72,68,152
MAA 76,68,156
MAA 76,64,140
s_waitcnt vmcnt(18) lgkmcnt(0)
s_barrier
MAA 32,0,160
TR 64,16,50688
MAA 32,4,176
buffer_load_dwordx4 a[136:139], v11, s[16:19], s53 offen sc1
v_smfmac_f32_16x16x64_bf16 a[212:215], a[208:211], a[192:199], v6
s_sub_u32 s47, s47, 1
s_cbranch_scc1 .Lx46
.Lx46b:
v_smfmac_f32_16x16x64_bf16 a[212:215], a[208:211], a[200:207], v6
TR 66,16,51200
MAA 36,4,180
TR 68,16,59136
MAA 36,0,164
TR 70,16,59648
MAA 52,8,164
TR 72,16,50720
MAA 52,12,180
buffer_load_dwordx4 a[140:143], v11, s[16:19], s53 offen offset:1024 sc1
MAA 48,12,176
TR 74,16,51232
s_add_u32 s53, s53, 131072
MAA 48,8,160
MAA 96,16,160
TR 76,16,59168
MAA 96,20,176
TR 78,16,59680
MAA 100,20,180
TR 80,16,50752
MAA 100,16,164
buffer_load_dwordx4 a[152:155], v11, s[16:19], s53 offen sc1
MAA 116,24,164
TR 82,16,51264
MAA 116,28,180
TR 84,16,59200
MAA 112,28,176
MAA 112,24,160
TR 86,16,59712
MAA 160,32,160
TR 88,16,50784
MAA 160,36,176
buffer_load_dwordx4 a[156:159], v11, s[16:19], s53 offen offset:1024 sc1
MAA 164,36,180
TR 90,16,51296
s_add_u32 s53, s53, 131072
MAA 164,32,164
TR 92,16,59232
MAA 180,40,164
TR 94,16,59744
MAA 180,44,180
MAA 176,44,176
TR 96,16,50816
s_add_u32 m0, s55, 118272
MAA 176,40,160
buffer_load_dwordx4 v12, s[32:35], s54 offen   lds
MAA 224,48,160
TR 98,16,51328
MAA 224,52,176
TR 100,16,59264
MAA 228,52,180
TR 102,16,59776
MAA 228,48,164
TR 104,16,50848
MAA 236,56,164
MAA 236,60,180
TR 106,16,51360
MAA 232,60,176
TR 108,16,59296
MAA 232,56,160
TR 110,16,59808
s_waitcnt vmcnt(19)
MAA 188,40,172
TR 112,17,50688
MAA 188,44,188
buffer_load_dwordx4 v13, s[32:35], s54 offen offset:1056   lds
MAA 184,44,184
TR 114,17,51200
MAA 184,40,168
MAA 168,32,168
TR 116,17,59136
MAA 168,36,184
buffer_load_dwordx4 v14, s[32:35], s54 offen offset:2112   lds
MAA 172,36,188
TR 118,17,59648
MAA 172,32,172
TR 120,17,50720
MAA 124,24,172
TR 122,17,51232
MAA 124,28,188
TR 124,17,59168
MAA 120,28,184
MAA 120,24,168
buffer_load_dwordx4 v15, s[32:35], s54 offen offset:3168   lds
MAA 104,16,168
TR 126,17,59680
MAA 104,20,184
RD 192,9,50688
MAA 108,20,188
RD 196,9,51744
MAA 108,16,172
RD 200,9,52800
MAA 60,8,172
.Lpad15:
s_cbranch_execz .Lnopoll34r
RD 204,9,53856
s_mov_b32 m0, s67
MAA 60,12,188
buffer_load_dwordx4 v18, s[28:31], s58 offen lds
MAA 56,12,184
MAA 56,8,168
MAA 40,0,168
MAA 40,4,184
MAA 44,4,188
MAA 44,0,172
s_waitcnt vmcnt(19) lgkmcnt(0)
s_barrier
MAA 64,64,160
ds_read_b64_tr_b16 a[0:1], v16
s_add_u32 m0, s55, 135168
MAA 64,68,176
buffer_load_dwordx4 v12, s[80:83], s54 offen   lds
v_smfmac_f32_16x16x64_bf16 a[216:219], a[208:211], a[192:199], v6
s_sub_u32 s47, s47, 1
s_cbranch_scc1 .Lx47
.Lx47b:
v_smfmac_f32_16x16x64_bf16 a[216:219], a[208:211], a[200:207], v6
TR 2,16,512
MAA 68,68,180
TR 4,16,8448
MAA 68,64,164
TR 6,16,8960
MAA 84,72,164
TR 8,16,32
MAA 84,76,180
buffer_load_dwordx4 v13, s[80:83], s54 offen offset:1056   lds
MAA 80,76,176
TR 10,16,544
MAA 80,72,160
MAA 128,80,160
TR 12,16,8480
MAA 128,84,176
TR 14,16,8992
MAA 132,84,180
TR 16,16,64
MAA 132,80,164
buffer_load_dwordx4 v14, s[80:83], s54 offen offset:2112   lds
MAA 148,88,164
TR 18,16,576
MAA 148,92,180
TR 20,16,8512
MAA 144,92,176
TR 22,16,9024
MAA 144,88,160
MAA 192,96,160
TR 24,16,96
MAA 192,100,176
buffer_load_dwordx4 v15, s[80:83], s54 offen offset:3168   lds
MAA 196,100,180
TR 26,16,608
s_add_u32 s54, s54, 458752
MAA 196,96,164
TR 28,16,8544
MAA 212,104,164
TR 30,16,9056
MAA 212,108,180
TR 32,16,128
MAA 208,108,176
TR 34,16,640
s_mov_b32 m0, s67
MAA 208,104,160
buffer_load_dwordx4 v19, s[28:31], s58 offen offset:1056 lds
MAA 240,112,160
s_add_u32 s67, s67, 8448
s_add_u32 s46, s46, 1
s_xor_b32 s58, s46, s87
s_mul_i32 s58, s58, 458752
MAA 240,116,176
MAA 244,116,180
TR 36,16,8576
MAA 244,112,164
TR 38,16,9088
MAA 252,120,164
TR 40,16,160
MAA 252,124,180
TR 42,16,672
MAA 248,124,176
TR 44,16,8608
MAA 248,120,160
buffer_load_dwordx4 a[160:163], v10, s[16:19], s52 offen sc1
MAA 220,104,172
TR 46,16,9120
MAA 220,108,188
MAA 216,108,184
ds_read_b64_tr_b16 a[48:49], v17
MAA 216,104,168
TR 50,17,512
MAA 200,96,168
TR 52,17,8448
MAA 200,100,184
buffer_load_dwordx4 a[164:167], v10, s[16:19], s52 offen offset:1024 sc1
MAA 204,100,188
TR 54,17,8960
s_add_u32 s52, s52, 131072
MAA 204,96,172
TR 56,17,32
MAA 156,88,172
TR 58,17,544
MAA 156,92,188
MAA 152,92,184
TR 60,17,8480
MAA 152,88,168
buffer_load_dwordx4 a[176:179], v10, s[16:19], s52 offen sc1
MAA 136,80,168
TR 62,17,8992
MAA 136,84,184
ds_read_b128 a[192:195], v9
MAA 140,84,188
RD 196,9,1056
MAA 140,80,172
RD 200,9,2112
MAA 92,72,172
RD 204,9,3168
MAA 92,76,188
buffer_load_dwordx4 a[180:183], v10, s[16:19], s52 offen offset:1024 sc1
MAA 88,76,184
s_add_u32 s52, s52, 131072
MAA 88,72,168
MAA 72,64,168
MAA 72,68,184
MAA 76,68,188
s_add_u32 s15, s15, 1
MAA 76,64,172
s_cbranch_scc0 .Lk43
s_branch .Lj48
.Lx39:
buffer_load_dword a220, v8, s[40:43], s45 offen
buffer_load_dword a220, v7, s[28:31], s44 offen
s_add_u32 s44, s44, 655360
s_add_u32 s45, s45, 917504
s_mov_b32 s47, 3
s_branch .Lx39b
.Lx40:
buffer_load_dword a220, v8, s[40:43], s45 offen
buffer_load_dword a220, v7, s[28:31], s44 offen
s_add_u32 s44, s44, 655360
s_add_u32 s45, s45, 917504
s_mov_b32 s47, 3
s_branch .Lx40b
.Lx41:
buffer_load_dword a220, v8, s[40:43], s45 offen
buffer_load_dword a220, v7, s[28:31], s44 offen
s_add_u32 s44, s44, 655360
s_add_u32 s45, s45, 917504
s_mov_b32 s47, 3
s_branch .Lx41b
.Lx42:
buffer_load_dword a220, v8, s[40:43], s45 offen
buffer_load_dword a220, v7, s[28:31], s44 offen
s_add_u32 s44, s44, 655360
s_add_u32 s45, s45, 917504
s_mov_b32 s47, 3
s_branch .Lx42b
.Lx44:
buffer_load_dword a220, v8, s[40:43], s45 offen
buffer_load_dword a220, v7, s[28:31], s44 offen
s_add_u32 s44, s44, 655360
s_add_u32 s45, s45, 917504
s_mov_b32 s47, 3
s_branch .Lx44b
.Lx45:
buffer_load_dword a220, v8, s[40:43], s45 offen
buffer_load_dword a220, v7, s[28:31], s44 offen
s_add_u32 s44, s44, 655360
s_add_u32 s45, s45, 917504
s_mov_b32 s47, 3
s_branch .Lx45b
.Lx46:
buffer_load_dword a220, v8, s[40:43], s45 offen
buffer_load_dword a220, v7, s[28:31], s44 offen
s_add_u32 s44, s44, 655360
s_add_u32 s45, s45, 917504
s_mov_b32 s47, 3
s_branch .Lx46b
.Lx47:
buffer_load_dword a220, v8, s[40:43], s45 offen
buffer_load_dword a220, v7, s[28:31], s44 offen
s_add_u32 s44, s44, 655360
s_add_u32 s45, s45, 917504
s_mov_b32 s47, 3
s_branch .Lx47b
.Lj48:
s_waitcnt vmcnt(10) lgkmcnt(0)
s_barrier
v_smfmac_f32_16x16x64_bf16 a[212:215], a[208:211], a[192:199], v6
RD 112,9,16896
s_lshl_b32 s74, s3, 10
v_smfmac_f32_16x16x64_bf16 a[212:215], a[208:211], a[200:207], v6
RD 116,9,17952
s_add_u32 s74, s74, 152576
MAA 32,0,128
RD 120,9,19008
s_sub_u32 s75, 156672, s74
MAA 32,4,144
RD 124,9,20064
v_and_b32 v7, 15, v1
MAA 48,12,144
RD 192,9,33792
v_lshl_add_u32 v7, v7, 5, s74
MAA 48,8,128
RD 196,9,34848
v_bfe_u32 v2, v1, 4, 1
MAA 36,0,132
RD 200,9,35904
v_lshl_add_u32 v7, v2, 4, v7
MAA 36,4,148
RD 204,9,36960
v_bfe_u32 v2, v1, 5, 1
MAA 52,12,148
buffer_load_dwordx4 a[168:171], v11, s[16:19], s53 offen sc1
MAA 52,8,132
TR 64,16,16896
v_mul_u32_u24 v2, s75, v2
s_waitcnt lgkmcnt(7)
v_smfmac_f32_16x16x64_bf16 a[216:219], a[208:211], a[112:119], v6
TR 66,16,17408
v_add_u32 v7, v7, v2
MAA 40,0,136
TR 68,16,25344
v_lshlrev_b32 v2, 4, v1
s_waitcnt lgkmcnt(7)
v_smfmac_f32_16x16x64_bf16 a[216:219], a[208:211], a[120:127], v6
buffer_load_dwordx4 a[172:175], v11, s[16:19], s53 offen offset:1024 sc1
MAA 40,4,152
TR 70,16,25856
s_add_u32 s53, s53, 131072
s_waitcnt lgkmcnt(6)
v_smfmac_f32_16x16x64_bf16 a[212:215], a[208:211], a[192:199], v6
TR 72,16,16928
v_add_u32 v2, 152576, v2
MAA 56,12,152
TR 74,16,17440
s_lshl_b32 s74, s12, 7
s_waitcnt lgkmcnt(6)
v_smfmac_f32_16x16x64_bf16 a[212:215], a[208:211], a[200:207], v6
buffer_load_dwordx4 a[184:187], v11, s[16:19], s53 offen sc1
MAA 56,8,136
TR 76,16,25376
s_add_u32 s74, s74, 161536
MAA 44,0,140
TR 78,16,25888
s_waitcnt vmcnt(8)
s_barrier
MAA 44,4,156
RD 112,9,50688
s_xor_b32 s75, s12, 1
MAA 60,12,156
RD 116,9,51744
s_mul_i32 s75, s75, 384
MAA 60,8,140
RD 120,9,52800
s_add_u32 s75, s75, 161536
MAA 96,16,128
RD 124,9,53856
v_lshrrev_b32 v9, 4, v1
MAA 96,20,144
ds_write_b128 v7, a[212:215]
v_lshlrev_b32 v9, 4, v9
MAA 112,28,144
buffer_load_dwordx4 a[188:191], v11, s[16:19], s53 offen offset:1024 sc1
MAA 112,24,128
TR 80,16,33792
s_add_u32 s53, s53, 131072
MAA 100,16,132
TR 82,16,34304
v_add_u32 v8, s75, v9
MAA 100,20,148
TR 84,16,42240
v_add_u32 v9, s74, v9
MAA 116,28,148
TR 86,16,42752
s_add_u32 s58, s99, 2293760
s_waitcnt lgkmcnt(7)
v_smfmac_f32_16x16x64_bf16 a[216:219], a[208:211], a[112:119], v6
TR 88,16,33824
s_lshl_b32 s74, s3, 11
MAA 116,24,132
TR 90,16,34336
s_add_u32 s74, s74, s84
s_waitcnt lgkmcnt(7)
v_smfmac_f32_16x16x64_bf16 a[216:219], a[208:211], a[120:127], v6
TR 92,16,42272
s_add_u32 s54, s98, 65536
MAA 104,16,136
TR 94,16,42784
s_mul_i32 s55, s3, 2112
MAA 104,20,152
TR 96,16,50688
s_mov_b32 s57, 67584
MAA 120,28,152
ds_write_b128 v7, a[216:219] offset:512
MAA 120,24,136
TR 98,16,51200
MAA 108,16,140
TR 100,16,59136
MAA 108,20,156
TR 102,16,59648
MAA 124,28,156
TR 104,16,50720
MAA 124,24,140
TR 106,16,51232
MAA 160,32,128
TR 108,16,59168
MAA 160,36,144
TR 110,16,59680
MAA 176,44,144
s_waitcnt lgkmcnt(7)
s_barrier
ds_read_b128 v[12:15], v2
MAA 176,40,128
ds_read_b128 v[4:7], v2 offset:1024
MAA 164,32,132
TR 192,16,16960
MAA 164,36,148
TR 194,16,17472
MAA 180,44,148
TR 196,16,25408
MAA 180,40,132
TR 198,16,25920
MAA 168,32,136
TR 200,16,16992
MAA 168,36,152
TR 202,16,17504
MAA 184,44,152
TR 204,16,25440
MAA 184,40,136
TR 206,16,25952
s_waitcnt lgkmcnt(8)
v_add_f32 v12, v12, v4
MAA 172,32,140
TR 112,16,33856
v_add_f32 v13, v13, v5
MAA 172,36,156
TR 114,16,34368
v_add_f32 v14, v14, v6
MAA 188,44,156
TR 116,16,42304
v_add_f32 v15, v15, v7
MAA 188,40,140
ds_read_b128 v[4:7], v2 offset:2048
MAA 224,48,128
TR 118,16,42816
MAA 224,52,144
TR 120,16,33888
MAA 232,60,144
TR 122,16,34400
MAA 232,56,128
TR 124,16,42336
MAA 228,48,132
TR 126,16,42848
MAA 228,52,148
TR 0,16,50752
MAA 236,60,148
TR 2,16,51264
MAA 236,56,132
TR 4,16,59200
s_waitcnt lgkmcnt(8)
v_add_f32 v12, v12, v4
MAA 64,64,128
TR 6,16,59712
v_add_f32 v13, v13, v5
MAA 64,68,144
TR 8,16,50784
v_add_f32 v14, v14, v6
s_waitcnt vmcnt(7)
MAA 64,96,160
TR 10,16,51296
v_add_f32 v15, v15, v7
s_waitcnt vmcnt(5)
MAA 64,100,176
ds_read_b128 v[4:7], v2 offset:3072
MAA 80,108,176
TR 12,16,59232
MAA 80,104,160
TR 14,16,59744
MAA 80,76,144
TR 16,16,17024
MAA 80,72,128
TR 18,16,17536
MAA 32,80,160
TR 20,16,25472
MAA 32,84,176
TR 22,16,25984
MAA 48,92,176
TR 24,16,17056
MAA 48,88,160
TR 26,16,17568
s_waitcnt lgkmcnt(8)
v_add_f32 v12, v12, v4
v_add_f32 v13, v13, v5
v_add_f32 v14, v14, v6
v_add_f32 v15, v15, v7
ds_write_b128 v2, v[12:15] offset:8960
ds_read_b128 v[12:15], v9
ds_read_b128 v[4:7], v9 offset:64
v_lshrrev_b32 v2, 3, v1
v_cmp_eq_u32 vcc, 3, v2
TR 28,16,25504
TR 30,16,26016
TR 32,16,33920
TR 34,16,34432
TR 36,16,42368
TR 38,16,42880
TR 40,16,33952
TR 42,16,34464
TR 44,16,42400
TR 46,16,42912
TR 48,16,50816
TR 50,16,51328
TR 52,16,59264
s_waitcnt lgkmcnt(14)
v_pk_fma_f32 v[32:33], v[12:13], v[20:21], v[32:33] op_sel_hi:[1,0,1]
v_pk_fma_f32 v[34:35], v[14:15], v[20:21], v[34:35] op_sel_hi:[1,0,1]
v_pk_fma_f32 v[36:37], v[12:13], v[22:23], v[36:37] op_sel_hi:[1,0,1]
v_pk_fma_f32 v[38:39], v[14:15], v[22:23], v[38:39] op_sel_hi:[1,0,1]
v_pk_fma_f32 v[40:41], v[12:13], v[24:25], v[40:41] op_sel_hi:[1,0,1]
v_pk_fma_f32 v[42:43], v[14:15], v[24:25], v[42:43] op_sel_hi:[1,0,1]
v_pk_fma_f32 v[44:45], v[12:13], v[26:27], v[44:45] op_sel_hi:[1,0,1]
v_pk_fma_f32 v[46:47], v[14:15], v[26:27], v[46:47] op_sel_hi:[1,0,1]
ds_read_b128 v[12:15], v9 offset:512
s_waitcnt lgkmcnt(14)
v_pk_fma_f32 v[48:49], v[4:5], v[20:21], v[48:49] op_sel_hi:[1,0,1]
v_pk_fma_f32 v[50:51], v[6:7], v[20:21], v[50:51] op_sel_hi:[1,0,1]
v_pk_fma_f32 v[52:53], v[4:5], v[22:23], v[52:53] op_sel_hi:[1,0,1]
v_pk_fma_f32 v[54:55], v[6:7], v[22:23], v[54:55] op_sel_hi:[1,0,1]
v_pk_fma_f32 v[56:57], v[4:5], v[24:25], v[56:57] op_sel_hi:[1,0,1]
v_pk_fma_f32 v[58:59], v[6:7], v[24:25], v[58:59] op_sel_hi:[1,0,1]
v_pk_fma_f32 v[60:61], v[4:5], v[26:27], v[60:61] op_sel_hi:[1,0,1]
v_pk_fma_f32 v[62:63], v[6:7], v[26:27], v[62:63] op_sel_hi:[1,0,1]
ds_read_b128 v[4:7], v9 offset:576
TR 54,16,59776
TR 56,16,50848
TR 58,16,51360
TR 60,16,59296
TR 62,16,59808
s_waitcnt lgkmcnt(6)
v_pk_fma_f32 v[64:65], v[12:13], v[20:21], v[64:65] op_sel_hi:[1,0,1]
v_pk_fma_f32 v[66:67], v[14:15], v[20:21], v[66:67] op_sel_hi:[1,0,1]
v_pk_fma_f32 v[68:69], v[12:13], v[22:23], v[68:69] op_sel_hi:[1,0,1]
v_pk_fma_f32 v[70:71], v[14:15], v[22:23], v[70:71] op_sel_hi:[1,0,1]
v_pk_fma_f32 v[72:73], v[12:13], v[24:25], v[72:73] op_sel_hi:[1,0,1]
v_pk_fma_f32 v[74:75], v[14:15], v[24:25], v[74:75] op_sel_hi:[1,0,1]
v_pk_fma_f32 v[76:77], v[12:13], v[26:27], v[76:77] op_sel_hi:[1,0,1]
v_pk_fma_f32 v[78:79], v[14:15], v[26:27], v[78:79] op_sel_hi:[1,0,1]
ds_read_b128 v[12:15], v9 offset:832
s_waitcnt lgkmcnt(6)
v_pk_fma_f32 v[80:81], v[4:5], v[20:21], v[80:81] op_sel_hi:[1,0,1]
v_pk_fma_f32 v[82:83], v[6:7], v[20:21], v[82:83] op_sel_hi:[1,0,1]
v_pk_fma_f32 v[84:85], v[4:5], v[22:23], v[84:85] op_sel_hi:[1,0,1]
v_pk_fma_f32 v[86:87], v[6:7], v[22:23], v[86:87] op_sel_hi:[1,0,1]
v_pk_fma_f32 v[88:89], v[4:5], v[24:25], v[88:89] op_sel_hi:[1,0,1]
v_pk_fma_f32 v[90:91], v[6:7], v[24:25], v[90:91] op_sel_hi:[1,0,1]
v_pk_fma_f32 v[92:93], v[4:5], v[26:27], v[92:93] op_sel_hi:[1,0,1]
v_pk_fma_f32 v[94:95], v[6:7], v[26:27], v[94:95] op_sel_hi:[1,0,1]
ds_read_b128 v[4:7], v9 offset:704
v_pk_mul_f32 v[64:65], v[64:65], v[32:33]
v_pk_mul_f32 v[32:33], v[32:33], v[28:29] op_sel_hi:[1,0]
v_pk_mul_f32 v[66:67], v[66:67], v[34:35]
v_pk_mul_f32 v[34:35], v[34:35], v[28:29] op_sel_hi:[1,0]
v_pk_mul_f32 v[80:81], v[80:81], v[48:49]
v_pk_mul_f32 v[48:49], v[48:49], v[28:29] op_sel_hi:[1,0]
v_pk_mul_f32 v[82:83], v[82:83], v[50:51]
v_pk_mul_f32 v[50:51], v[50:51], v[28:29] op_sel_hi:[1,0]
v_exp_f32 v32, v32
v_exp_f32 v33, v33
MAA 68,64,132
v_exp_f32 v34, v34
MAA 68,68,148
v_exp_f32 v35, v35
MAA 68,96,164
v_exp_f32 v48, v48
s_waitcnt vmcnt(4)
MAA 68,100,180
v_exp_f32 v49, v49
MAA 84,108,180
v_exp_f32 v50, v50
MAA 84,104,164
v_exp_f32 v51, v51
MAA 84,76,148
MAA 84,72,132
MAA 36,80,164
MAA 36,84,180
MAA 52,92,180
MAA 52,88,164
s_nop 5
v_pk_mul_f32 v[68:69], v[68:69], v[36:37]
v_pk_fma_f32 v[32:33], v[32:33], v[20:21], v[20:21] op_sel:[0,1,1] op_sel_hi:[1,1,1]
v_pk_fma_f32 v[34:35], v[34:35], v[20:21], v[20:21] op_sel:[0,1,1] op_sel_hi:[1,1,1]
v_pk_fma_f32 v[48:49], v[48:49], v[20:21], v[20:21] op_sel:[0,1,1] op_sel_hi:[1,1,1]
v_pk_fma_f32 v[50:51], v[50:51], v[20:21], v[20:21] op_sel:[0,1,1] op_sel_hi:[1,1,1]
v_rcp_f32 v32, v32
v_pk_mul_f32 v[36:37], v[36:37], v[28:29] op_sel:[0,1] op_sel_hi:[1,1]
v_pk_mul_f32 v[70:71], v[70:71], v[38:39]
v_pk_mul_f32 v[38:39], v[38:39], v[28:29] op_sel:[0,1] op_sel_hi:[1,1]
v_pk_mul_f32 v[84:85], v[84:85], v[52:53]
v_pk_mul_f32 v[52:53], v[52:53], v[28:29] op_sel:[0,1] op_sel_hi:[1,1]
v_pk_mul_f32 v[86:87], v[86:87], v[54:55]
v_pk_mul_f32 v[54:55], v[54:55], v[28:29] op_sel:[0,1] op_sel_hi:[1,1]
v_rcp_f32 v33, v33
v_rcp_f32 v34, v34
MAA 72,64,136
v_rcp_f32 v35, v35
MAA 72,68,152
v_rcp_f32 v48, v48
s_waitcnt vmcnt(3)
MAA 72,96,168
v_rcp_f32 v49, v49
s_waitcnt vmcnt(1)
MAA 72,100,184
v_rcp_f32 v50, v50
MAA 88,108,184
v_rcp_f32 v51, v51
MAA 88,104,168
v_exp_f32 v36, v36
MAA 88,76,152
v_exp_f32 v37, v37
MAA 88,72,136
v_exp_f32 v38, v38
MAA 40,80,168
v_exp_f32 v39, v39
MAA 40,84,184
v_exp_f32 v52, v52
MAA 56,92,184
v_exp_f32 v53, v53
MAA 56,88,168
v_exp_f32 v54, v54
v_exp_f32 v55, v55
v_pk_mul_f32 v[64:65], v[64:65], v[32:33]
v_pk_mul_f32 v[66:67], v[66:67], v[34:35]
v_pk_mul_f32 v[80:81], v[80:81], v[48:49]
v_pk_mul_f32 v[82:83], v[82:83], v[50:51]
ds_read_b128 v[48:51], v9 offset:128
v_pk_mul_f32 v[72:73], v[72:73], v[40:41]
v_pk_mul_f32 v[40:41], v[40:41], v[30:31] op_sel_hi:[1,0]
v_pk_mul_f32 v[74:75], v[74:75], v[42:43]
v_pk_mul_f32 v[42:43], v[42:43], v[30:31] op_sel_hi:[1,0]
v_pk_mul_f32 v[88:89], v[88:89], v[56:57]
v_pk_mul_f32 v[56:57], v[56:57], v[30:31] op_sel_hi:[1,0]
v_pk_mul_f32 v[90:91], v[90:91], v[58:59]
v_pk_mul_f32 v[58:59], v[58:59], v[30:31] op_sel_hi:[1,0]
v_pk_fma_f32 v[36:37], v[36:37], v[22:23], v[22:23] op_sel:[0,1,1] op_sel_hi:[1,1,1]
v_pk_fma_f32 v[38:39], v[38:39], v[22:23], v[22:23] op_sel:[0,1,1] op_sel_hi:[1,1,1]
v_pk_fma_f32 v[52:53], v[52:53], v[22:23], v[22:23] op_sel:[0,1,1] op_sel_hi:[1,1,1]
v_pk_fma_f32 v[54:55], v[54:55], v[22:23], v[22:23] op_sel:[0,1,1] op_sel_hi:[1,1,1]
v_cvt_pk_bf16_f32 v32, v64, v65
v_cvt_pk_bf16_f32 v33, v66, v67
ds_read_b128 v[64:67], v9 offset:192
v_cvt_pk_bf16_f32 v34, v80, v81
v_cvt_pk_bf16_f32 v35, v82, v83
MAA 76,64,140
buffer_store_dwordx4 v[32:35], v10, s[16:19], s62 offen sc1
MAA 76,68,156
ds_read_b128 v[80:83], v9 offset:640
v_rcp_f32 v36, v36
MAA 76,96,172
TR 64,17,16896
v_rcp_f32 v37, v37
s_waitcnt vmcnt(1)
MAA 76,100,188
TR 66,17,17408
v_rcp_f32 v38, v38
MAA 92,108,188
TR 68,17,25344
v_rcp_f32 v39, v39
MAA 92,104,172
TR 70,17,25856
v_rcp_f32 v52, v52
MAA 92,76,156
TR 76,17,25376
v_rcp_f32 v53, v53
MAA 92,72,140
TR 72,17,16928
.Lpad16:
s_cbranch_execz .Lnopoll34r
v_rcp_f32 v54, v54
MAA 44,80,172
TR 74,17,17440
v_rcp_f32 v55, v55
MAA 44,84,188
TR 78,17,25888
v_exp_f32 v40, v40
MAA 60,92,188
TR 80,17,33792
v_exp_f32 v41, v41
MAA 60,88,172
TR 82,17,34304
v_exp_f32 v42, v42
v_exp_f32 v43, v43
v_exp_f32 v56, v56
v_exp_f32 v57, v57
v_exp_f32 v58, v58
v_exp_f32 v59, v59
v_pk_mul_f32 v[68:69], v[68:69], v[36:37]
v_pk_mul_f32 v[70:71], v[70:71], v[38:39]
v_pk_mul_f32 v[84:85], v[84:85], v[52:53]
v_pk_mul_f32 v[86:87], v[86:87], v[54:55]
ds_read_b128 v[52:55], v8 offset:576
v_pk_mul_f32 v[76:77], v[76:77], v[44:45]
v_pk_mul_f32 v[44:45], v[44:45], v[30:31] op_sel:[0,1] op_sel_hi:[1,1]
v_pk_mul_f32 v[78:79], v[78:79], v[46:47]
v_pk_mul_f32 v[46:47], v[46:47], v[30:31] op_sel:[0,1] op_sel_hi:[1,1]
v_pk_mul_f32 v[92:93], v[92:93], v[60:61]
v_pk_mul_f32 v[60:61], v[60:61], v[30:31] op_sel:[0,1] op_sel_hi:[1,1]
v_pk_mul_f32 v[94:95], v[94:95], v[62:63]
v_pk_mul_f32 v[62:63], v[62:63], v[30:31] op_sel:[0,1] op_sel_hi:[1,1]
v_pk_fma_f32 v[40:41], v[40:41], v[24:25], v[24:25] op_sel:[0,1,1] op_sel_hi:[1,1,1]
v_pk_fma_f32 v[42:43], v[42:43], v[24:25], v[24:25] op_sel:[0,1,1] op_sel_hi:[1,1,1]
v_pk_fma_f32 v[56:57], v[56:57], v[24:25], v[24:25] op_sel:[0,1,1] op_sel_hi:[1,1,1]
v_pk_fma_f32 v[58:59], v[58:59], v[24:25], v[24:25] op_sel:[0,1,1] op_sel_hi:[1,1,1]
v_cvt_pk_bf16_f32 v36, v68, v69
v_cvt_pk_bf16_f32 v37, v70, v71
v_cvt_pk_bf16_f32 v38, v84, v85
v_cvt_pk_bf16_f32 v39, v86, v87
MAA 128,192,128
buffer_store_dwordx4 v[36:39], v10, s[16:19], s62 offen offset:1024 sc1
MAA 128,196,144
TR 84,17,42240
v_rcp_f32 v40, v40
MAA 128,0,160
TR 86,17,42752
v_rcp_f32 v41, v41
MAA 128,4,176
TR 88,17,33824
v_rcp_f32 v42, v42
MAA 144,12,176
TR 90,17,34336
v_rcp_f32 v43, v43
MAA 144,8,160
TR 92,17,42272
v_rcp_f32 v56, v56
MAA 144,204,144
TR 94,17,42784
v_rcp_f32 v57, v57
MAA 144,200,128
TR 96,17,50688
v_rcp_f32 v58, v58
MAA 96,112,160
TR 98,17,51200
v_rcp_f32 v59, v59
MAA 96,116,176
TR 100,17,59136
v_exp_f32 v44, v44
MAA 112,124,176
TR 102,17,59648
v_exp_f32 v45, v45
MAA 112,120,160
TR 104,17,50720
v_lshrrev_b32 v69, 2, v0
v_min_u32 v69, 1, v69
v_lshlrev_b32 v69, 28, v69
v_lshl_add_u32 v68, v0, 7, v69
v_xor_b32 v69, 64, v0
v_min_u32 v69, 1, v69
v_lshlrev_b32 v70, 4, v69
v_sub_u32 v70, 16, v70
v_lshlrev_b32 v69, 28, v69
v_mov_b32 v71, 1
v_mov_b32 v84, 0
v_mov_b32 v85, 0
v_mov_b32 v86, 0
v_exp_f32 v46, v46
v_exp_f32 v47, v47
v_exp_f32 v60, v60
v_exp_f32 v61, v61
v_exp_f32 v62, v62
v_exp_f32 v63, v63
v_pk_mul_f32 v[72:73], v[72:73], v[40:41]
v_pk_mul_f32 v[74:75], v[74:75], v[42:43]
v_pk_mul_f32 v[88:89], v[88:89], v[56:57]
v_pk_mul_f32 v[90:91], v[90:91], v[58:59]
s_waitcnt lgkmcnt(15)
v_pk_fma_f32 v[96:97], v[48:49], v[20:21], v[96:97] op_sel_hi:[1,0,1]
v_pk_fma_f32 v[98:99], v[50:51], v[20:21], v[98:99] op_sel_hi:[1,0,1]
v_pk_fma_f32 v[112:113], v[64:65], v[20:21], v[112:113] op_sel_hi:[1,0,1]
v_pk_fma_f32 v[114:115], v[66:67], v[20:21], v[114:115] op_sel_hi:[1,0,1]
v_pk_fma_f32 v[128:129], v[80:81], v[20:21], v[128:129] op_sel_hi:[1,0,1]
v_pk_fma_f32 v[130:131], v[82:83], v[20:21], v[130:131] op_sel_hi:[1,0,1]
v_pk_fma_f32 v[144:145], v[4:5], v[20:21], v[144:145] op_sel_hi:[1,0,1]
v_pk_fma_f32 v[146:147], v[6:7], v[20:21], v[146:147] op_sel_hi:[1,0,1]
v_pk_mul_f32 v[128:129], v[128:129], v[96:97]
v_pk_mul_f32 v[96:97], v[96:97], v[28:29] op_sel_hi:[1,0]
v_pk_mul_f32 v[130:131], v[130:131], v[98:99]
v_pk_mul_f32 v[98:99], v[98:99], v[28:29] op_sel_hi:[1,0]
v_pk_mul_f32 v[144:145], v[144:145], v[112:113]
v_pk_mul_f32 v[112:113], v[112:113], v[28:29] op_sel_hi:[1,0]
v_pk_mul_f32 v[146:147], v[146:147], v[114:115]
v_pk_mul_f32 v[114:115], v[114:115], v[28:29] op_sel_hi:[1,0]
v_pk_fma_f32 v[44:45], v[44:45], v[26:27], v[26:27] op_sel:[0,1,1] op_sel_hi:[1,1,1]
v_pk_fma_f32 v[46:47], v[46:47], v[26:27], v[26:27] op_sel:[0,1,1] op_sel_hi:[1,1,1]
v_pk_fma_f32 v[60:61], v[60:61], v[26:27], v[26:27] op_sel:[0,1,1] op_sel_hi:[1,1,1]
v_pk_fma_f32 v[62:63], v[62:63], v[26:27], v[26:27] op_sel:[0,1,1] op_sel_hi:[1,1,1]
v_cvt_pk_bf16_f32 v40, v72, v73
v_cvt_pk_bf16_f32 v41, v74, v75
v_cvt_pk_bf16_f32 v42, v88, v89
v_cvt_pk_bf16_f32 v43, v90, v91
MAA 132,192,132
buffer_store_dwordx4 v[40:43], v11, s[16:19], s62 offen sc1
MAA 132,196,148
TR 106,17,51232
v_rcp_f32 v44, v44
MAA 132,0,164
TR 108,17,59168
v_rcp_f32 v45, v45
MAA 132,4,180
TR 110,17,59680
v_rcp_f32 v46, v46
MAA 148,12,180
v_rcp_f32 v47, v47
MAA 148,8,164
v_rcp_f32 v60, v60
MAA 148,204,148
v_rcp_f32 v61, v61
MAA 148,200,132
v_rcp_f32 v62, v62
MAA 100,112,164
v_rcp_f32 v63, v63
MAA 100,116,180
v_exp_f32 v96, v96
MAA 116,124,180
v_exp_f32 v97, v97
MAA 116,120,164
s_waitcnt lgkmcnt(0)
s_barrier
s_add_u32 m0, s59, 84480
v_exp_f32 v98, v98
v_exp_f32 v99, v99
v_exp_f32 v112, v112
v_exp_f32 v113, v113
v_exp_f32 v114, v114
v_exp_f32 v115, v115
v_pk_mul_f32 v[76:77], v[76:77], v[44:45]
v_pk_mul_f32 v[78:79], v[78:79], v[46:47]
v_pk_mul_f32 v[92:93], v[92:93], v[60:61]
v_pk_mul_f32 v[94:95], v[94:95], v[62:63]
v_pk_fma_f32 v[100:101], v[48:49], v[22:23], v[100:101] op_sel_hi:[1,0,1]
v_pk_fma_f32 v[102:103], v[50:51], v[22:23], v[102:103] op_sel_hi:[1,0,1]
v_pk_fma_f32 v[116:117], v[64:65], v[22:23], v[116:117] op_sel_hi:[1,0,1]
v_pk_fma_f32 v[118:119], v[66:67], v[22:23], v[118:119] op_sel_hi:[1,0,1]
v_pk_fma_f32 v[132:133], v[80:81], v[22:23], v[132:133] op_sel_hi:[1,0,1]
v_pk_fma_f32 v[134:135], v[82:83], v[22:23], v[134:135] op_sel_hi:[1,0,1]
v_pk_fma_f32 v[148:149], v[4:5], v[22:23], v[148:149] op_sel_hi:[1,0,1]
v_pk_fma_f32 v[150:151], v[6:7], v[22:23], v[150:151] op_sel_hi:[1,0,1]
v_pk_mul_f32 v[132:133], v[132:133], v[100:101]
v_pk_mul_f32 v[100:101], v[100:101], v[28:29] op_sel:[0,1] op_sel_hi:[1,1]
v_pk_mul_f32 v[134:135], v[134:135], v[102:103]
v_pk_mul_f32 v[102:103], v[102:103], v[28:29] op_sel:[0,1] op_sel_hi:[1,1]
v_pk_mul_f32 v[148:149], v[148:149], v[116:117]
v_pk_mul_f32 v[116:117], v[116:117], v[28:29] op_sel:[0,1] op_sel_hi:[1,1]
v_pk_mul_f32 v[150:151], v[150:151], v[118:119]
v_pk_mul_f32 v[118:119], v[118:119], v[28:29] op_sel:[0,1] op_sel_hi:[1,1]
v_pk_fma_f32 v[96:97], v[96:97], v[20:21], v[20:21] op_sel:[0,1,1] op_sel_hi:[1,1,1]
v_pk_fma_f32 v[98:99], v[98:99], v[20:21], v[20:21] op_sel:[0,1,1] op_sel_hi:[1,1,1]
v_pk_fma_f32 v[112:113], v[112:113], v[20:21], v[20:21] op_sel:[0,1,1] op_sel_hi:[1,1,1]
v_pk_fma_f32 v[114:115], v[114:115], v[20:21], v[20:21] op_sel:[0,1,1] op_sel_hi:[1,1,1]
v_cvt_pk_bf16_f32 v44, v76, v77
v_cvt_pk_bf16_f32 v45, v78, v79
v_cvt_pk_bf16_f32 v46, v92, v93
v_cvt_pk_bf16_f32 v47, v94, v95
MAA 136,192,136
buffer_store_dwordx4 v[44:47], v11, s[16:19], s62 offen offset:1024 sc1
MAA 136,196,152
v_rcp_f32 v96, v96
MAA 136,0,168
v_rcp_f32 v97, v97
MAA 136,4,184
v_rcp_f32 v98, v98
MAA 152,12,184
buffer_load_dwordx4 v18, s[28:31], s58 offen lds
MAA 152,8,168
v_rcp_f32 v99, v99
MAA 152,204,152
v_rcp_f32 v112, v112
MAA 152,200,136
v_rcp_f32 v113, v113
MAA 104,112,168
buffer_load_dwordx4 v19, s[28:31], s58 offen offset:1056 lds
MAA 104,116,184
s_add_u32 m0, s59, 92928
s_add_u32 s58, s99, 2555904
v_rcp_f32 v114, v114
MAA 120,124,184
v_rcp_f32 v115, v115
MAA 120,120,168
v_exp_f32 v100, v100
v_exp_f32 v101, v101
v_exp_f32 v102, v102
v_exp_f32 v103, v103
v_exp_f32 v116, v116
v_exp_f32 v117, v117
v_exp_f32 v118, v118
v_exp_f32 v119, v119
v_pk_mul_f32 v[128:129], v[128:129], v[96:97]
v_pk_mul_f32 v[130:131], v[130:131], v[98:99]
v_pk_mul_f32 v[144:145], v[144:145], v[112:113]
v_pk_mul_f32 v[146:147], v[146:147], v[114:115]
ds_read_b128 v[112:115], v9 offset:256
v_pk_fma_f32 v[104:105], v[48:49], v[24:25], v[104:105] op_sel_hi:[1,0,1]
v_pk_fma_f32 v[106:107], v[50:51], v[24:25], v[106:107] op_sel_hi:[1,0,1]
v_pk_fma_f32 v[120:121], v[64:65], v[24:25], v[120:121] op_sel_hi:[1,0,1]
v_pk_fma_f32 v[122:123], v[66:67], v[24:25], v[122:123] op_sel_hi:[1,0,1]
v_pk_fma_f32 v[136:137], v[80:81], v[24:25], v[136:137] op_sel_hi:[1,0,1]
v_pk_fma_f32 v[138:139], v[82:83], v[24:25], v[138:139] op_sel_hi:[1,0,1]
v_pk_fma_f32 v[152:153], v[4:5], v[24:25], v[152:153] op_sel_hi:[1,0,1]
v_pk_fma_f32 v[154:155], v[6:7], v[24:25], v[154:155] op_sel_hi:[1,0,1]
v_pk_mul_f32 v[136:137], v[136:137], v[104:105]
v_pk_mul_f32 v[104:105], v[104:105], v[30:31] op_sel_hi:[1,0]
v_pk_mul_f32 v[138:139], v[138:139], v[106:107]
v_pk_mul_f32 v[106:107], v[106:107], v[30:31] op_sel_hi:[1,0]
v_pk_mul_f32 v[152:153], v[152:153], v[120:121]
v_pk_mul_f32 v[120:121], v[120:121], v[30:31] op_sel_hi:[1,0]
v_pk_mul_f32 v[154:155], v[154:155], v[122:123]
v_pk_mul_f32 v[122:123], v[122:123], v[30:31] op_sel_hi:[1,0]
v_pk_fma_f32 v[100:101], v[100:101], v[22:23], v[22:23] op_sel:[0,1,1] op_sel_hi:[1,1,1]
v_pk_fma_f32 v[102:103], v[102:103], v[22:23], v[22:23] op_sel:[0,1,1] op_sel_hi:[1,1,1]
v_pk_fma_f32 v[116:117], v[116:117], v[22:23], v[22:23] op_sel:[0,1,1] op_sel_hi:[1,1,1]
v_pk_fma_f32 v[118:119], v[118:119], v[22:23], v[22:23] op_sel:[0,1,1] op_sel_hi:[1,1,1]
v_cvt_pk_bf16_f32 v96, v128, v129
v_cvt_pk_bf16_f32 v97, v130, v131
ds_read_b128 v[128:131], v9 offset:320
v_cvt_pk_bf16_f32 v98, v144, v145
v_cvt_pk_bf16_f32 v99, v146, v147
MAA 140,192,140
buffer_store_dwordx4 v[96:99], v10, s[16:19], s63 offen sc1
MAA 140,196,156
ds_read_b128 v[144:147], v9 offset:768
v_rcp_f32 v100, v100
MAA 140,0,172
v_rcp_f32 v101, v101
MAA 140,4,188
v_rcp_f32 v102, v102
MAA 156,12,188
buffer_load_dwordx4 v18, s[28:31], s58 offen lds
MAA 156,8,172
v_rcp_f32 v103, v103
MAA 156,204,156
v_rcp_f32 v116, v116
MAA 156,200,140
v_rcp_f32 v117, v117
MAA 108,112,172
buffer_load_dwordx4 v19, s[28:31], s58 offen offset:1056 lds
MAA 108,116,188
s_add_u32 m0, s59, 101376
s_add_u32 s58, s100, 2752512
v_rcp_f32 v118, v118
MAA 124,124,188
v_rcp_f32 v119, v119
MAA 124,120,172
v_exp_f32 v104, v104
v_exp_f32 v105, v105
v_exp_f32 v106, v106
v_exp_f32 v107, v107
v_exp_f32 v120, v120
v_exp_f32 v121, v121
v_exp_f32 v122, v122
v_exp_f32 v123, v123
v_pk_mul_f32 v[132:133], v[132:133], v[100:101]
v_pk_mul_f32 v[134:135], v[134:135], v[102:103]
v_pk_mul_f32 v[148:149], v[148:149], v[116:117]
v_pk_mul_f32 v[150:151], v[150:151], v[118:119]
v_pk_fma_f32 v[108:109], v[48:49], v[26:27], v[108:109] op_sel_hi:[1,0,1]
v_pk_fma_f32 v[110:111], v[50:51], v[26:27], v[110:111] op_sel_hi:[1,0,1]
v_pk_fma_f32 v[124:125], v[64:65], v[26:27], v[124:125] op_sel_hi:[1,0,1]
v_pk_fma_f32 v[126:127], v[66:67], v[26:27], v[126:127] op_sel_hi:[1,0,1]
v_pk_fma_f32 v[140:141], v[80:81], v[26:27], v[140:141] op_sel_hi:[1,0,1]
v_pk_fma_f32 v[142:143], v[82:83], v[26:27], v[142:143] op_sel_hi:[1,0,1]
v_pk_fma_f32 v[156:157], v[4:5], v[26:27], v[156:157] op_sel_hi:[1,0,1]
v_pk_fma_f32 v[158:159], v[6:7], v[26:27], v[158:159] op_sel_hi:[1,0,1]
v_pk_mul_f32 v[140:141], v[140:141], v[108:109]
v_pk_mul_f32 v[108:109], v[108:109], v[30:31] op_sel:[0,1] op_sel_hi:[1,1]
v_pk_mul_f32 v[142:143], v[142:143], v[110:111]
v_pk_mul_f32 v[110:111], v[110:111], v[30:31] op_sel:[0,1] op_sel_hi:[1,1]
v_pk_mul_f32 v[156:157], v[156:157], v[124:125]
s_waitcnt vmcnt(5)
s_barrier
buffer_atomic_add v71, v68, s[16:19], s72 offen offset:512
v_pk_mul_f32 v[124:125], v[124:125], v[30:31] op_sel:[0,1] op_sel_hi:[1,1]
v_pk_mul_f32 v[158:159], v[158:159], v[126:127]
v_pk_mul_f32 v[126:127], v[126:127], v[30:31] op_sel:[0,1] op_sel_hi:[1,1]
v_pk_fma_f32 v[104:105], v[104:105], v[24:25], v[24:25] op_sel:[0,1,1] op_sel_hi:[1,1,1]
v_pk_fma_f32 v[106:107], v[106:107], v[24:25], v[24:25] op_sel:[0,1,1] op_sel_hi:[1,1,1]
v_pk_fma_f32 v[120:121], v[120:121], v[24:25], v[24:25] op_sel:[0,1,1] op_sel_hi:[1,1,1]
v_pk_fma_f32 v[122:123], v[122:123], v[24:25], v[24:25] op_sel:[0,1,1] op_sel_hi:[1,1,1]
v_cvt_pk_bf16_f32 v100, v132, v133
v_cvt_pk_bf16_f32 v101, v134, v135
v_cvt_pk_bf16_f32 v102, v148, v149
v_cvt_pk_bf16_f32 v103, v150, v151
MAA 192,16,128
v_rcp_f32 v104, v104
MAA 192,20,144
buffer_store_dwordx4 v[100:103], v10, s[16:19], s63 offen offset:1024 sc1
MAA 192,48,160
v_rcp_f32 v105, v105
MAA 192,52,176
v_rcp_f32 v106, v106
MAA 208,60,176
v_rcp_f32 v107, v107
MAA 208,56,160
buffer_load_dwordx4 v18, s[28:31], s58 offen lds
MAA 208,28,144
v_rcp_f32 v120, v120
MAA 208,24,128
v_rcp_f32 v121, v121
MAA 160,32,160
v_rcp_f32 v122, v122
MAA 160,36,176
buffer_load_dwordx4 v19, s[28:31], s58 offen offset:1056 lds
MAA 176,44,176
s_add_u32 m0, s59, 109824
s_add_u32 s58, s100, 3014656
v_rcp_f32 v123, v123
MAA 176,40,160
v_exp_f32 v108, v108
v_exp_f32 v109, v109
v_exp_f32 v110, v110
v_exp_f32 v111, v111
v_exp_f32 v124, v124
v_exp_f32 v125, v125
v_exp_f32 v126, v126
v_exp_f32 v127, v127
v_pk_mul_f32 v[136:137], v[136:137], v[104:105]
v_pk_mul_f32 v[138:139], v[138:139], v[106:107]
v_pk_mul_f32 v[152:153], v[152:153], v[120:121]
v_pk_mul_f32 v[154:155], v[154:155], v[122:123]
s_waitcnt lgkmcnt(2)
v_pk_fma_f32 v[160:161], v[112:113], v[20:21], v[160:161] op_sel_hi:[1,0,1]
v_pk_fma_f32 v[162:163], v[114:115], v[20:21], v[162:163] op_sel_hi:[1,0,1]
s_waitcnt lgkmcnt(1)
v_pk_fma_f32 v[176:177], v[128:129], v[20:21], v[176:177] op_sel_hi:[1,0,1]
v_pk_fma_f32 v[178:179], v[130:131], v[20:21], v[178:179] op_sel_hi:[1,0,1]
s_waitcnt lgkmcnt(0)
v_pk_fma_f32 v[192:193], v[144:145], v[20:21], v[192:193] op_sel_hi:[1,0,1]
v_pk_fma_f32 v[194:195], v[146:147], v[20:21], v[194:195] op_sel_hi:[1,0,1]
v_pk_fma_f32 v[208:209], v[12:13], v[20:21], v[208:209] op_sel_hi:[1,0,1]
v_pk_fma_f32 v[210:211], v[14:15], v[20:21], v[210:211] op_sel_hi:[1,0,1]
v_pk_mul_f32 v[192:193], v[192:193], v[160:161]
v_pk_mul_f32 v[160:161], v[160:161], v[28:29] op_sel_hi:[1,0]
v_pk_mul_f32 v[194:195], v[194:195], v[162:163]
v_pk_mul_f32 v[162:163], v[162:163], v[28:29] op_sel_hi:[1,0]
v_pk_mul_f32 v[208:209], v[208:209], v[176:177]
v_pk_mul_f32 v[176:177], v[176:177], v[28:29] op_sel_hi:[1,0]
v_pk_mul_f32 v[210:211], v[210:211], v[178:179]
v_pk_mul_f32 v[178:179], v[178:179], v[28:29] op_sel_hi:[1,0]
v_pk_fma_f32 v[108:109], v[108:109], v[26:27], v[26:27] op_sel:[0,1,1] op_sel_hi:[1,1,1]
v_pk_fma_f32 v[110:111], v[110:111], v[26:27], v[26:27] op_sel:[0,1,1] op_sel_hi:[1,1,1]
v_pk_fma_f32 v[124:125], v[124:125], v[26:27], v[26:27] op_sel:[0,1,1] op_sel_hi:[1,1,1]
v_pk_fma_f32 v[126:127], v[126:127], v[26:27], v[26:27] op_sel:[0,1,1] op_sel_hi:[1,1,1]
v_cvt_pk_bf16_f32 v104, v136, v137
v_cvt_pk_bf16_f32 v105, v138, v139
v_cvt_pk_bf16_f32 v106, v152, v153
v_cvt_pk_bf16_f32 v107, v154, v155
MAA 196,16,132
buffer_store_dwordx4 v[104:107], v11, s[16:19], s63 offen sc1
MAA 196,20,148
v_rcp_f32 v108, v108
MAA 196,48,164
v_rcp_f32 v109, v109
MAA 196,52,180
v_rcp_f32 v110, v110
MAA 212,60,180
buffer_load_dwordx4 v18, s[28:31], s58 offen lds
MAA 212,56,164
v_rcp_f32 v111, v111
MAA 212,28,148
v_rcp_f32 v124, v124
MAA 212,24,132
v_rcp_f32 v125, v125
MAA 164,32,164
buffer_load_dwordx4 v19, s[28:31], s58 offen offset:1056 lds
MAA 164,36,180
s_add_u32 m0, s59, 118272
s_add_u32 s58, s101, 3211264
v_rcp_f32 v126, v126
MAA 180,44,180
v_rcp_f32 v127, v127
MAA 180,40,164
v_lshl_add_u32 v4, v1, 4, s74
v_add_u32 v2, 67108480, v4
v_cndmask_b32 v4, v4, v2, vcc
s_and_b32 s74, s7, 1
v_bfe_u32 v7, v1, 2, 3
v_mul_u32_u24 v7, 1056, v7
v_bfe_u32 v2, v1, 5, 1
v_lshl_add_u32 v7, v2, 8, v7
v_and_b32 v2, 3, v1
v_lshl_add_u32 v7, v2, 3, v7
s_lshl_b32 s74, s74, 7
s_xor_b32 s75, s74, 128
v_add_u32 v6, s75, v7
v_add_u32 v7, s74, v7
v_exp_f32 v160, v160
v_exp_f32 v161, v161
v_exp_f32 v162, v162
v_exp_f32 v163, v163
v_exp_f32 v176, v176
v_exp_f32 v177, v177
v_exp_f32 v178, v178
v_exp_f32 v179, v179
v_pk_mul_f32 v[140:141], v[140:141], v[108:109]
v_pk_mul_f32 v[142:143], v[142:143], v[110:111]
v_pk_mul_f32 v[156:157], v[156:157], v[124:125]
v_pk_mul_f32 v[158:159], v[158:159], v[126:127]
v_pk_fma_f32 v[164:165], v[112:113], v[22:23], v[164:165] op_sel_hi:[1,0,1]
v_pk_fma_f32 v[166:167], v[114:115], v[22:23], v[166:167] op_sel_hi:[1,0,1]
v_pk_fma_f32 v[180:181], v[128:129], v[22:23], v[180:181] op_sel_hi:[1,0,1]
v_pk_fma_f32 v[182:183], v[130:131], v[22:23], v[182:183] op_sel_hi:[1,0,1]
v_pk_fma_f32 v[196:197], v[144:145], v[22:23], v[196:197] op_sel_hi:[1,0,1]
v_pk_fma_f32 v[198:199], v[146:147], v[22:23], v[198:199] op_sel_hi:[1,0,1]
v_pk_fma_f32 v[212:213], v[12:13], v[22:23], v[212:213] op_sel_hi:[1,0,1]
v_pk_fma_f32 v[214:215], v[14:15], v[22:23], v[214:215] op_sel_hi:[1,0,1]
v_pk_mul_f32 v[196:197], v[196:197], v[164:165]
v_pk_mul_f32 v[164:165], v[164:165], v[28:29] op_sel:[0,1] op_sel_hi:[1,1]
v_pk_mul_f32 v[198:199], v[198:199], v[166:167]
v_pk_mul_f32 v[166:167], v[166:167], v[28:29] op_sel:[0,1] op_sel_hi:[1,1]
v_pk_mul_f32 v[212:213], v[212:213], v[180:181]
v_pk_mul_f32 v[180:181], v[180:181], v[28:29] op_sel:[0,1] op_sel_hi:[1,1]
v_pk_mul_f32 v[214:215], v[214:215], v[182:183]
v_pk_mul_f32 v[182:183], v[182:183], v[28:29] op_sel:[0,1] op_sel_hi:[1,1]
v_pk_fma_f32 v[160:161], v[160:161], v[20:21], v[20:21] op_sel:[0,1,1] op_sel_hi:[1,1,1]
v_pk_fma_f32 v[162:163], v[162:163], v[20:21], v[20:21] op_sel:[0,1,1] op_sel_hi:[1,1,1]
v_pk_fma_f32 v[176:177], v[176:177], v[20:21], v[20:21] op_sel:[0,1,1] op_sel_hi:[1,1,1]
v_pk_fma_f32 v[178:179], v[178:179], v[20:21], v[20:21] op_sel:[0,1,1] op_sel_hi:[1,1,1]
v_cvt_pk_bf16_f32 v108, v140, v141
v_cvt_pk_bf16_f32 v109, v142, v143
v_cvt_pk_bf16_f32 v110, v156, v157
v_cvt_pk_bf16_f32 v111, v158, v159
MAA 200,16,136
buffer_store_dwordx4 v[108:111], v11, s[16:19], s63 offen offset:1024 sc1
MAA 200,20,152
v_rcp_f32 v160, v160
MAA 200,48,168
v_rcp_f32 v161, v161
MAA 200,52,184
v_rcp_f32 v162, v162
MAA 216,60,184
buffer_load_dwordx4 v18, s[28:31], s58 offen lds
MAA 216,56,168
v_rcp_f32 v163, v163
MAA 216,28,152
v_rcp_f32 v176, v176
MAA 216,24,136
v_rcp_f32 v177, v177
MAA 168,32,168
buffer_load_dwordx4 v19, s[28:31], s58 offen offset:1056 lds
MAA 168,36,184
s_add_u32 m0, s59, 126720
s_add_u32 s58, s101, 3473408
v_rcp_f32 v178, v178
MAA 184,44,184
v_rcp_f32 v179, v179
MAA 184,40,168
v_exp_f32 v164, v164
v_exp_f32 v165, v165
v_exp_f32 v166, v166
v_exp_f32 v167, v167
v_exp_f32 v180, v180
v_exp_f32 v181, v181
v_exp_f32 v182, v182
v_exp_f32 v183, v183
v_pk_mul_f32 v[192:193], v[192:193], v[160:161]
v_pk_mul_f32 v[194:195], v[194:195], v[162:163]
v_pk_mul_f32 v[208:209], v[208:209], v[176:177]
v_pk_mul_f32 v[210:211], v[210:211], v[178:179]
ds_read_b128 v[176:179], v8
v_pk_fma_f32 v[168:169], v[112:113], v[24:25], v[168:169] op_sel_hi:[1,0,1]
v_pk_fma_f32 v[170:171], v[114:115], v[24:25], v[170:171] op_sel_hi:[1,0,1]
v_pk_fma_f32 v[184:185], v[128:129], v[24:25], v[184:185] op_sel_hi:[1,0,1]
v_pk_fma_f32 v[186:187], v[130:131], v[24:25], v[186:187] op_sel_hi:[1,0,1]
v_pk_fma_f32 v[200:201], v[144:145], v[24:25], v[200:201] op_sel_hi:[1,0,1]
v_pk_fma_f32 v[202:203], v[146:147], v[24:25], v[202:203] op_sel_hi:[1,0,1]
v_pk_fma_f32 v[216:217], v[12:13], v[24:25], v[216:217] op_sel_hi:[1,0,1]
v_pk_fma_f32 v[218:219], v[14:15], v[24:25], v[218:219] op_sel_hi:[1,0,1]
v_pk_mul_f32 v[200:201], v[200:201], v[168:169]
v_pk_mul_f32 v[168:169], v[168:169], v[30:31] op_sel_hi:[1,0]
v_pk_mul_f32 v[202:203], v[202:203], v[170:171]
v_pk_mul_f32 v[170:171], v[170:171], v[30:31] op_sel_hi:[1,0]
v_pk_mul_f32 v[216:217], v[216:217], v[184:185]
v_pk_mul_f32 v[184:185], v[184:185], v[30:31] op_sel_hi:[1,0]
v_pk_mul_f32 v[218:219], v[218:219], v[186:187]
v_pk_mul_f32 v[186:187], v[186:187], v[30:31] op_sel_hi:[1,0]
v_pk_fma_f32 v[164:165], v[164:165], v[22:23], v[22:23] op_sel:[0,1,1] op_sel_hi:[1,1,1]
v_pk_fma_f32 v[166:167], v[166:167], v[22:23], v[22:23] op_sel:[0,1,1] op_sel_hi:[1,1,1]
v_pk_fma_f32 v[180:181], v[180:181], v[22:23], v[22:23] op_sel:[0,1,1] op_sel_hi:[1,1,1]
v_pk_fma_f32 v[182:183], v[182:183], v[22:23], v[22:23] op_sel:[0,1,1] op_sel_hi:[1,1,1]
v_cvt_pk_bf16_f32 v160, v192, v193
v_cvt_pk_bf16_f32 v161, v194, v195
ds_read_b128 v[192:195], v8 offset:64
v_cvt_pk_bf16_f32 v162, v208, v209
v_cvt_pk_bf16_f32 v163, v210, v211
MAA 204,16,140
buffer_store_dwordx4 v[160:163], v10, s[16:19], s64 offen sc1
MAA 204,20,156
ds_read_b128 v[208:211], v8 offset:512
v_rcp_f32 v164, v164
MAA 204,48,172
v_rcp_f32 v165, v165
MAA 204,52,188
v_rcp_f32 v166, v166
MAA 220,60,188
buffer_atomic_add v84, v69, s[16:19], s73 offen offset:512 sc0
MAA 220,56,172
v_rcp_f32 v167, v167
MAA 220,28,156
v_rcp_f32 v180, v180
MAA 220,24,140
v_rcp_f32 v181, v181
MAA 172,32,172
buffer_load_dwordx4 v18, s[28:31], s58 offen lds
MAA 172,36,188
v_rcp_f32 v182, v182
MAA 188,44,188
v_rcp_f32 v183, v183
MAA 188,40,172
v_exp_f32 v168, v168
v_exp_f32 v169, v169
v_exp_f32 v170, v170
v_exp_f32 v171, v171
v_exp_f32 v184, v184
v_exp_f32 v185, v185
v_exp_f32 v186, v186
v_exp_f32 v187, v187
v_pk_mul_f32 v[196:197], v[196:197], v[164:165]
v_pk_mul_f32 v[198:199], v[198:199], v[166:167]
v_pk_mul_f32 v[212:213], v[212:213], v[180:181]
v_pk_mul_f32 v[214:215], v[214:215], v[182:183]
v_pk_fma_f32 v[172:173], v[112:113], v[26:27], v[172:173] op_sel_hi:[1,0,1]
v_pk_fma_f32 v[174:175], v[114:115], v[26:27], v[174:175] op_sel_hi:[1,0,1]
v_pk_fma_f32 v[188:189], v[128:129], v[26:27], v[188:189] op_sel_hi:[1,0,1]
v_pk_fma_f32 v[190:191], v[130:131], v[26:27], v[190:191] op_sel_hi:[1,0,1]
v_pk_fma_f32 v[204:205], v[144:145], v[26:27], v[204:205] op_sel_hi:[1,0,1]
v_pk_fma_f32 v[206:207], v[146:147], v[26:27], v[206:207] op_sel_hi:[1,0,1]
v_pk_fma_f32 v[220:221], v[12:13], v[26:27], v[220:221] op_sel_hi:[1,0,1]
v_pk_fma_f32 v[222:223], v[14:15], v[26:27], v[222:223] op_sel_hi:[1,0,1]
v_pk_mul_f32 v[204:205], v[204:205], v[172:173]
v_pk_mul_f32 v[172:173], v[172:173], v[30:31] op_sel:[0,1] op_sel_hi:[1,1]
v_pk_mul_f32 v[206:207], v[206:207], v[174:175]
v_pk_mul_f32 v[174:175], v[174:175], v[30:31] op_sel:[0,1] op_sel_hi:[1,1]
v_pk_mul_f32 v[220:221], v[220:221], v[188:189]
v_pk_mul_f32 v[188:189], v[188:189], v[30:31] op_sel:[0,1] op_sel_hi:[1,1]
v_pk_mul_f32 v[222:223], v[222:223], v[190:191]
v_pk_mul_f32 v[190:191], v[190:191], v[30:31] op_sel:[0,1] op_sel_hi:[1,1]
v_pk_fma_f32 v[168:169], v[168:169], v[24:25], v[24:25] op_sel:[0,1,1] op_sel_hi:[1,1,1]
v_pk_fma_f32 v[170:171], v[170:171], v[24:25], v[24:25] op_sel:[0,1,1] op_sel_hi:[1,1,1]
v_pk_fma_f32 v[184:185], v[184:185], v[24:25], v[24:25] op_sel:[0,1,1] op_sel_hi:[1,1,1]
v_pk_fma_f32 v[186:187], v[186:187], v[24:25], v[24:25] op_sel:[0,1,1] op_sel_hi:[1,1,1]
v_cvt_pk_bf16_f32 v164, v196, v197
v_cvt_pk_bf16_f32 v165, v198, v199
v_cvt_pk_bf16_f32 v166, v212, v213
v_cvt_pk_bf16_f32 v167, v214, v215
MAA 240,64,128
buffer_store_dwordx4 v[164:167], v10, s[16:19], s64 offen offset:1024 sc1
MAA 240,68,144
v_rcp_f32 v168, v168
MAA 240,96,160
v_rcp_f32 v169, v169
MAA 240,100,176
v_rcp_f32 v170, v170
MAA 248,108,176
buffer_atomic_add v85, v69, s[16:19], s73 offen offset:512 sc0
MAA 248,104,160
v_rcp_f32 v171, v171
MAA 248,76,144
v_rcp_f32 v184, v184
MAA 248,72,128
v_rcp_f32 v185, v185
MAA 224,80,160
buffer_load_dwordx4 v19, s[28:31], s58 offen offset:1056 lds
MAA 224,84,176
v_rcp_f32 v186, v186
MAA 232,92,176
v_rcp_f32 v187, v187
MAA 232,88,160
.Lpad17:
s_cbranch_execz .Lpad20
v_exp_f32 v172, v172
v_exp_f32 v173, v173
v_exp_f32 v174, v174
v_exp_f32 v175, v175
v_exp_f32 v188, v188
v_exp_f32 v189, v189
v_exp_f32 v190, v190
v_exp_f32 v191, v191
v_pk_mul_f32 v[200:201], v[200:201], v[168:169]
v_pk_mul_f32 v[202:203], v[202:203], v[170:171]
v_pk_mul_f32 v[216:217], v[216:217], v[184:185]
v_pk_mul_f32 v[218:219], v[218:219], v[186:187]
s_waitcnt lgkmcnt(2)
v_pk_fma_f32 v[224:225], v[176:177], v[20:21], v[224:225] op_sel_hi:[1,0,1]
v_pk_fma_f32 v[226:227], v[178:179], v[20:21], v[226:227] op_sel_hi:[1,0,1]
s_waitcnt lgkmcnt(1)
v_pk_fma_f32 v[232:233], v[192:193], v[20:21], v[232:233] op_sel_hi:[1,0,1]
v_pk_fma_f32 v[234:235], v[194:195], v[20:21], v[234:235] op_sel_hi:[1,0,1]
s_waitcnt lgkmcnt(0)
v_pk_fma_f32 v[240:241], v[208:209], v[20:21], v[240:241] op_sel_hi:[1,0,1]
v_pk_fma_f32 v[242:243], v[210:211], v[20:21], v[242:243] op_sel_hi:[1,0,1]
v_pk_fma_f32 v[248:249], v[52:53], v[20:21], v[248:249] op_sel_hi:[1,0,1]
v_pk_fma_f32 v[250:251], v[54:55], v[20:21], v[250:251] op_sel_hi:[1,0,1]
v_pk_mul_f32 v[240:241], v[240:241], v[224:225]
v_pk_mul_f32 v[224:225], v[224:225], v[28:29] op_sel_hi:[1,0]
v_pk_mul_f32 v[242:243], v[242:243], v[226:227]
v_pk_mul_f32 v[226:227], v[226:227], v[28:29] op_sel_hi:[1,0]
v_pk_mul_f32 v[248:249], v[248:249], v[232:233]
v_pk_mul_f32 v[232:233], v[232:233], v[28:29] op_sel_hi:[1,0]
v_pk_mul_f32 v[250:251], v[250:251], v[234:235]
v_pk_mul_f32 v[234:235], v[234:235], v[28:29] op_sel_hi:[1,0]
v_pk_fma_f32 v[172:173], v[172:173], v[26:27], v[26:27] op_sel:[0,1,1] op_sel_hi:[1,1,1]
v_pk_fma_f32 v[174:175], v[174:175], v[26:27], v[26:27] op_sel:[0,1,1] op_sel_hi:[1,1,1]
v_pk_fma_f32 v[188:189], v[188:189], v[26:27], v[26:27] op_sel:[0,1,1] op_sel_hi:[1,1,1]
v_pk_fma_f32 v[190:191], v[190:191], v[26:27], v[26:27] op_sel:[0,1,1] op_sel_hi:[1,1,1]
v_cvt_pk_bf16_f32 v168, v200, v201
v_cvt_pk_bf16_f32 v169, v202, v203
v_cvt_pk_bf16_f32 v170, v216, v217
v_cvt_pk_bf16_f32 v171, v218, v219
buffer_store_dwordx4 v[168:171], v11, s[16:19], s64 offen sc1
buffer_atomic_add v86, v69, s[16:19], s73 offen offset:512 sc0
s_waitcnt vmcnt(6)
v_cmp_gt_u32 vcc, v70, v84
s_nop 0
s_cbranch_vccz .Lok49
s_waitcnt vmcnt(3)
v_cmp_gt_u32 vcc, v70, v85
s_nop 0
s_cbranch_vccz .Lok49
s_waitcnt vmcnt(0)
v_cmp_gt_u32 vcc, v70, v86
s_nop 0
s_cbranch_vccz .Lok49
s_mov_b32 s15, 0
.Lok49l:
v_mov_b32 v84, 0
buffer_atomic_add v84, v69, s[16:19], s73 offen offset:512 sc0
s_add_u32 s15, s15, 1
s_cmp_gt_u32 s15, 100000
s_waitcnt vmcnt(0)
s_cbranch_scc1 .Lok49
v_cmp_gt_u32 vcc, v70, v84
s_nop 0
s_cbranch_vccnz .Lok49l
.Lok49:
s_waitcnt vmcnt(2)
s_barrier
MAA 244,64,132
ds_read_b64_tr_b16 a[0:1], v7
s_add_u32 s52, s76, 0
MAA 244,68,148
buffer_load_dwordx4 v[96:99], v4, s[16:19], s52 offen sc1
MAA 244,96,164
TR 2,7,512
v_rcp_f32 v172, v172
MAA 244,100,180
TR 4,7,32
v_rcp_f32 v173, v173
MAA 252,108,180
TR 6,7,544
v_rcp_f32 v174, v174
MAA 252,104,164
buffer_load_dwordx4 v[100:103], v4, s[16:19], s52 offen offset:1024 sc1
MAA 252,76,148
TR 8,7,64
s_add_u32 s52, s76, 65536
MAA 252,72,132
TR 10,7,576
v_rcp_f32 v175, v175
MAA 228,80,164
TR 12,7,96
v_rcp_f32 v188, v188
MAA 228,84,180
buffer_load_dwordx4 v[104:107], v4, s[16:19], s52 offen sc1
MAA 236,92,180
TR 14,7,608
v_rcp_f32 v189, v189
MAA 236,88,164
TR 16,7,8448
v_rcp_f32 v190, v190
v_rcp_f32 v191, v191
v_exp_f32 v224, v224
v_exp_f32 v225, v225
v_exp_f32 v226, v226
v_exp_f32 v227, v227
v_exp_f32 v232, v232
v_exp_f32 v233, v233
v_exp_f32 v234, v234
v_exp_f32 v235, v235
v_pk_mul_f32 v[204:205], v[204:205], v[172:173]
buffer_load_dwordx4 v[108:111], v4, s[16:19], s52 offen offset:1024 sc1
s_add_u32 s52, s77, 114688
v_pk_mul_f32 v[206:207], v[206:207], v[174:175]
v_pk_mul_f32 v[220:221], v[220:221], v[188:189]
v_pk_mul_f32 v[222:223], v[222:223], v[190:191]
v_pk_fma_f32 v[228:229], v[176:177], v[22:23], v[228:229] op_sel_hi:[1,0,1]
v_pk_fma_f32 v[230:231], v[178:179], v[22:23], v[230:231] op_sel_hi:[1,0,1]
v_pk_fma_f32 v[236:237], v[192:193], v[22:23], v[236:237] op_sel_hi:[1,0,1]
v_pk_fma_f32 v[238:239], v[194:195], v[22:23], v[238:239] op_sel_hi:[1,0,1]
v_pk_fma_f32 v[244:245], v[208:209], v[22:23], v[244:245] op_sel_hi:[1,0,1]
v_pk_fma_f32 v[246:247], v[210:211], v[22:23], v[246:247] op_sel_hi:[1,0,1]
v_pk_fma_f32 v[252:253], v[52:53], v[22:23], v[252:253] op_sel_hi:[1,0,1]
v_pk_fma_f32 v[254:255], v[54:55], v[22:23], v[254:255] op_sel_hi:[1,0,1]
v_pk_mul_f32 v[244:245], v[244:245], v[228:229]
buffer_load_dwordx4 v[112:115], v4, s[16:19], s52 offen sc1
v_pk_mul_f32 v[228:229], v[228:229], v[28:29] op_sel:[0,1] op_sel_hi:[1,1]
v_pk_mul_f32 v[246:247], v[246:247], v[230:231]
v_pk_mul_f32 v[230:231], v[230:231], v[28:29] op_sel:[0,1] op_sel_hi:[1,1]
v_pk_mul_f32 v[252:253], v[252:253], v[236:237]
v_pk_mul_f32 v[236:237], v[236:237], v[28:29] op_sel:[0,1] op_sel_hi:[1,1]
v_pk_mul_f32 v[254:255], v[254:255], v[238:239]
v_pk_mul_f32 v[238:239], v[238:239], v[28:29] op_sel:[0,1] op_sel_hi:[1,1]
v_pk_fma_f32 v[224:225], v[224:225], v[20:21], v[20:21] op_sel:[0,1,1] op_sel_hi:[1,1,1]
v_pk_fma_f32 v[226:227], v[226:227], v[20:21], v[20:21] op_sel:[0,1,1] op_sel_hi:[1,1,1]
v_pk_fma_f32 v[232:233], v[232:233], v[20:21], v[20:21] op_sel:[0,1,1] op_sel_hi:[1,1,1]
v_pk_fma_f32 v[234:235], v[234:235], v[20:21], v[20:21] op_sel:[0,1,1] op_sel_hi:[1,1,1]
v_cvt_pk_bf16_f32 v172, v204, v205
v_cvt_pk_bf16_f32 v173, v206, v207
buffer_load_dwordx4 v[116:119], v4, s[16:19], s52 offen offset:1024 sc1
s_add_u32 s52, s77, 180224
v_cvt_pk_bf16_f32 v174, v220, v221
v_cvt_pk_bf16_f32 v175, v222, v223
TR 18,7,8960
TR 20,7,8480
TR 22,7,8992
TR 24,7,8512
TR 26,7,9024
buffer_store_dwordx4 v[172:175], v11, s[16:19], s64 offen offset:1024 sc1
TR 28,7,8544
TR 30,7,9056
v_rcp_f32 v224, v224
v_rcp_f32 v225, v225
v_rcp_f32 v226, v226
v_rcp_f32 v227, v227
v_rcp_f32 v232, v232
v_rcp_f32 v233, v233
v_rcp_f32 v234, v234
v_rcp_f32 v235, v235
v_exp_f32 v228, v228
v_exp_f32 v229, v229
v_exp_f32 v230, v230
v_exp_f32 v231, v231
v_exp_f32 v236, v236
v_exp_f32 v237, v237
v_exp_f32 v238, v238
v_exp_f32 v239, v239
v_pk_mul_f32 v[240:241], v[240:241], v[224:225]
buffer_load_dwordx4 v[120:123], v4, s[16:19], s52 offen sc1
v_pk_mul_f32 v[242:243], v[242:243], v[226:227]
v_pk_mul_f32 v[248:249], v[248:249], v[232:233]
v_pk_mul_f32 v[250:251], v[250:251], v[234:235]
v_pk_fma_f32 v[228:229], v[228:229], v[22:23], v[22:23] op_sel:[0,1,1] op_sel_hi:[1,1,1]
v_pk_fma_f32 v[230:231], v[230:231], v[22:23], v[22:23] op_sel:[0,1,1] op_sel_hi:[1,1,1]
v_pk_fma_f32 v[236:237], v[236:237], v[22:23], v[22:23] op_sel:[0,1,1] op_sel_hi:[1,1,1]
v_pk_fma_f32 v[238:239], v[238:239], v[22:23], v[22:23] op_sel:[0,1,1] op_sel_hi:[1,1,1]
v_cvt_pk_bf16_f32 v224, v240, v241
v_cvt_pk_bf16_f32 v225, v242, v243
v_cvt_pk_bf16_f32 v226, v248, v249
v_cvt_pk_bf16_f32 v227, v250, v251
v_rcp_f32 v228, v228
v_rcp_f32 v229, v229
v_rcp_f32 v230, v230
v_rcp_f32 v231, v231
v_rcp_f32 v236, v236
v_rcp_f32 v237, v237
v_rcp_f32 v238, v238
v_rcp_f32 v239, v239
v_pk_mul_f32 v[244:245], v[244:245], v[228:229]
buffer_store_dwordx4 v[224:227], v10, s[16:19], s65 offen sc1
v_pk_mul_f32 v[246:247], v[246:247], v[230:231]
v_pk_mul_f32 v[252:253], v[252:253], v[236:237]
v_pk_mul_f32 v[254:255], v[254:255], v[238:239]
v_cvt_pk_bf16_f32 v228, v244, v245
v_cvt_pk_bf16_f32 v229, v246, v247
v_cvt_pk_bf16_f32 v230, v252, v253
v_cvt_pk_bf16_f32 v231, v254, v255
buffer_store_dwordx4 v[228:231], v10, s[16:19], s65 offen offset:1024 sc1
buffer_load_dwordx4 v[124:127], v4, s[16:19], s52 offen offset:1024 sc1
v_mov_b32 v21, v68
v_mov_b32 v22, v69
v_mov_b32 v23, v70
v_mov_b32 v24, v71
v_mov_b32 v25, 0
s_waitcnt vmcnt(7) lgkmcnt(0)
s_barrier
v_mfma_f32_16x16x32_bf16 v[32:35], a[0:3], v[96:99], 0
ds_read_b64_tr_b16 a[32:33], v6
s_add_u32 s52, s78, 229376
MAV 32,16,104
buffer_load_dwordx4 v[128:131], v4, s[16:19], s52 offen sc1
v_mfma_f32_16x16x32_bf16 v[48:51], a[0:3], v[100:103], 0
TR 34,6,512
MAV 48,16,108
TR 36,6,32
TR 38,6,544
v_mfma_f32_16x16x32_bf16 v[52:55], a[4:7], v[100:103], 0
TR 48,6,8448
MAV 52,20,108
buffer_load_dwordx4 v[132:135], v4, s[16:19], s52 offen offset:1024 sc1
v_mfma_f32_16x16x32_bf16 v[36:39], a[4:7], v[96:99], 0
TR 50,6,8960
MAV 36,20,104
TR 52,6,8480
TR 54,6,8992
v_mfma_f32_16x16x32_bf16 v[40:43], a[8:11], v[96:99], 0
TR 40,6,64
s_add_u32 s52, s78, 294912
MAV 40,24,104
buffer_load_dwordx4 v[136:139], v4, s[16:19], s52 offen sc1
v_mfma_f32_16x16x32_bf16 v[56:59], a[8:11], v[100:103], 0
TR 42,6,576
MAV 56,24,108
TR 44,6,96
TR 46,6,608
v_mfma_f32_16x16x32_bf16 v[60:63], a[12:15], v[100:103], 0
TR 56,6,8512
MAV 60,28,108
buffer_load_dwordx4 v[140:143], v4, s[16:19], s52 offen offset:1024 sc1
v_mfma_f32_16x16x32_bf16 v[44:47], a[12:15], v[96:99], 0
TR 58,6,9024
MAV 44,28,104
TR 60,6,8544
TR 62,6,9056
s_waitcnt lgkmcnt(8)
v_mfma_f32_16x16x32_bf16 v[64:67], a[32:35], v[96:99], 0
TR 0,7,16896
s_add_u32 s52, s79, 344064
MAV 64,48,104
buffer_load_dwordx4 v[144:147], v4, s[16:19], s52 offen sc1
v_mfma_f32_16x16x32_bf16 v[80:83], a[32:35], v[100:103], 0
TR 2,7,17408
MAV 80,48,108
TR 4,7,16928
TR 6,7,17440
v_mfma_f32_16x16x32_bf16 v[84:87], a[36:39], v[100:103], 0
TR 16,7,25344
MAV 84,52,108
buffer_load_dwordx4 v[148:151], v4, s[16:19], s52 offen offset:1024 sc1
v_mfma_f32_16x16x32_bf16 v[68:71], a[36:39], v[96:99], 0
TR 18,7,25856
MAV 68,52,104
TR 20,7,25376
TR 22,7,25888
s_waitcnt lgkmcnt(8)
v_mfma_f32_16x16x32_bf16 v[72:75], a[40:43], v[96:99], 0
TR 8,7,16960
s_add_u32 s52, s79, 409600
MAV 72,56,104
buffer_load_dwordx4 v[152:155], v4, s[16:19], s52 offen sc1
v_mfma_f32_16x16x32_bf16 v[88:91], a[40:43], v[100:103], 0
TR 10,7,17472
MAV 88,56,108
TR 12,7,16992
TR 14,7,17504
v_mfma_f32_16x16x32_bf16 v[92:95], a[44:47], v[100:103], 0
TR 24,7,25408
MAV 92,60,108
buffer_load_dwordx4 v[156:159], v4, s[16:19], s52 offen offset:1024 sc1
v_mfma_f32_16x16x32_bf16 v[76:79], a[44:47], v[96:99], 0
TR 26,7,25920
MAV 76,60,104
TR 28,7,25440
TR 30,7,25952
s_waitcnt vmcnt(8) lgkmcnt(8)
s_barrier
MAV 32,0,112
TR 32,6,16896
s_add_u32 m0, s55, 0
MAV 32,16,120
buffer_load_dwordx4 v18, s[28:31], s54 offen lds
MAV 48,16,124
TR 34,6,17408
MAV 48,0,116
TR 36,6,16928
TR 38,6,17440
MAV 52,4,116
TR 48,6,25344
s_add_u32 s52, s76, 458752
MAV 52,20,124
buffer_load_dwordx4 v[96:99], v4, s[16:19], s52 offen sc1
MAV 36,20,120
TR 50,6,25856
MAV 36,4,112
TR 52,6,25376
TR 54,6,25888
s_waitcnt lgkmcnt(8)
MAV 40,8,112
TR 40,6,16960
MAV 40,24,120
buffer_load_dwordx4 v19, s[28:31], s54 offen offset:1056 lds
MAV 56,24,124
TR 42,6,17472
s_add_u32 s54, s98, 327680
MAV 56,8,116
TR 44,6,16992
TR 46,6,17504
MAV 60,12,116
TR 56,6,25408
MAV 60,28,124
buffer_load_dwordx4 v[100:103], v4, s[16:19], s52 offen offset:1024 sc1
MAV 44,28,120
TR 58,6,25920
MAV 44,12,112
TR 60,6,25440
TR 62,6,25952
s_waitcnt lgkmcnt(8)
MAV 64,32,112
TR 0,7,33792
s_add_u32 m0, s55, 8448
MAV 64,48,120
buffer_load_dwordx4 v18, s[28:31], s54 offen lds
MAV 80,48,124
TR 2,7,34304
MAV 80,32,116
TR 4,7,33824
TR 6,7,34336
MAV 84,36,116
TR 16,7,42240
s_add_u32 s52, s76, 524288
MAV 84,52,124
buffer_load_dwordx4 v[104:107], v4, s[16:19], s52 offen sc1
MAV 68,52,120
TR 18,7,42752
MAV 68,36,112
TR 20,7,42272
TR 22,7,42784
s_waitcnt lgkmcnt(8)
MAV 72,40,112
TR 8,7,33856
MAV 72,56,120
buffer_load_dwordx4 v19, s[28:31], s54 offen offset:1056 lds
MAV 88,56,124
TR 10,7,34368
s_add_u32 s54, s99, 524288
MAV 88,40,116
TR 12,7,33888
TR 14,7,34400
MAV 92,44,116
TR 24,7,42304
MAV 92,60,124
buffer_load_dwordx4 v[108:111], v4, s[16:19], s52 offen offset:1024 sc1
MAV 76,60,120
TR 26,7,42816
MAV 76,44,112
TR 28,7,42336
TR 30,7,42848
s_waitcnt vmcnt(12) lgkmcnt(8)
s_barrier
MAV 32,0,128
TR 32,6,33792
MAV 32,16,136
buffer_atomic_add v24, v21, s[16:19], s72 offen
MAV 48,16,140
TR 34,6,34304
MAV 48,0,132
TR 36,6,33824
TR 38,6,34336
TR 48,6,42240
MAV 52,4,132
TR 50,6,42752
s_add_u32 m0, s55, 16896
MAV 52,20,140
buffer_load_dwordx4 v18, s[28:31], s54 offen lds
MAV 36,20,136
TR 52,6,42272
MAV 36,4,128
TR 54,6,42784
TR 40,6,33856
s_waitcnt lgkmcnt(9)
MAV 40,8,128
TR 42,6,34368
s_add_u32 s52, s77, 573440
MAV 40,24,136
buffer_load_dwordx4 v[112:115], v4, s[16:19], s52 offen sc1
MAV 56,24,140
TR 44,6,33888
MAV 56,8,132
buffer_load_dwordx4 v19, s[28:31], s54 offen offset:1056 lds
MAV 60,12,132
TR 46,6,34400
s_add_u32 s54, s99, 786432
MAV 60,28,140
buffer_load_dwordx4 v[116:119], v4, s[16:19], s52 offen offset:1024 sc1
MAV 44,28,136
TR 56,6,42304
MAV 44,12,128
TR 58,6,42816
TR 60,6,42336
TR 62,6,42848
s_waitcnt lgkmcnt(8)
MAV 64,32,128
TR 0,7,50688
s_add_u32 m0, s55, 25344
MAV 64,48,136
buffer_load_dwordx4 v18, s[28:31], s54 offen lds
MAV 80,48,140
TR 2,7,51200
MAV 80,32,132
TR 4,7,50720
TR 6,7,51232
MAV 84,36,132
TR 16,7,59136
s_add_u32 s52, s77, 638976
MAV 84,52,140
buffer_load_dwordx4 v[120:123], v4, s[16:19], s52 offen sc1
MAV 68,52,136
TR 18,7,59648
MAV 68,36,128
TR 20,7,59168
TR 22,7,59680
s_waitcnt lgkmcnt(8)
MAV 72,40,128
TR 8,7,50752
MAV 72,56,136
buffer_load_dwordx4 v19, s[28:31], s54 offen offset:1056 lds
MAV 88,56,140
TR 10,7,51264
s_add_u32 s54, s100, 983040
MAV 88,40,132
TR 12,7,50784
TR 14,7,51296
MAV 92,44,132
TR 24,7,59200
MAV 92,60,140
buffer_load_dwordx4 v[124:127], v4, s[16:19], s52 offen offset:1024 sc1
MAV 76,60,136
TR 26,7,59712
MAV 76,44,128
TR 28,7,59232
TR 30,7,59744
s_waitcnt vmcnt(17) lgkmcnt(8)
s_barrier
MAV 32,0,144
TR 32,6,50688
s_add_u32 m0, s55, 33792
MAV 32,16,152
buffer_load_dwordx4 v18, s[28:31], s54 offen lds
MAV 48,16,156
TR 34,6,51200
MAV 48,0,148
TR 36,6,50720
TR 38,6,51232
MAV 52,4,148
TR 48,6,59136
s_add_u32 s52, s78, 688128
MAV 52,20,156
buffer_load_dwordx4 v[128:131], v4, s[16:19], s52 offen sc1
MAV 36,20,152
TR 50,6,59648
MAV 36,4,144
TR 52,6,59168
TR 54,6,59680
s_waitcnt lgkmcnt(8)
MAV 40,8,144
TR 40,6,50752
MAV 40,24,152
buffer_load_dwordx4 v19, s[28:31], s54 offen offset:1056 lds
MAV 56,24,156
TR 42,6,51264
s_add_u32 s54, s100, 1245184
MAV 56,8,148
TR 44,6,50784
TR 46,6,51296
MAV 60,12,148
TR 56,6,59200
MAV 60,28,156
buffer_load_dwordx4 v[132:135], v4, s[16:19], s52 offen offset:1024 sc1
MAV 44,28,152
TR 58,6,59712
MAV 44,12,144
TR 60,6,59232
TR 62,6,59744
v_add_u32 v7, s57, v7
v_add_u32 v6, s57, v6
s_sub_u32 s57, 0, s57
s_waitcnt lgkmcnt(8)
MAV 64,32,144
ds_read_b64_tr_b16 a[0:1], v7
s_add_u32 m0, s55, 42240
MAV 64,48,152
buffer_load_dwordx4 v18, s[28:31], s54 offen lds
MAV 80,48,156
TR 2,7,512
MAV 80,32,148
TR 4,7,32
TR 6,7,544
TR 16,7,8448
MAV 84,36,148
TR 18,7,8960
s_add_u32 s52, s78, 753664
MAV 84,52,156
buffer_load_dwordx4 v[136:139], v4, s[16:19], s52 offen sc1
MAV 68,52,152
TR 20,7,8480
MAV 68,36,144
TR 22,7,8992
TR 8,7,64
s_waitcnt lgkmcnt(9)
MAV 72,40,144
TR 10,7,576
MAV 72,56,152
buffer_load_dwordx4 v19, s[28:31], s54 offen offset:1056 lds
MAV 88,56,156
TR 12,7,96
s_add_u32 s54, s101, 1441792
MAV 88,40,148
buffer_load_dwordx4 v[140:143], v4, s[16:19], s52 offen offset:1024 sc1
MAV 92,44,148
TR 14,7,608
MAV 92,60,156
buffer_atomic_add v25, v22, s[16:19], s73 offen sc0
MAV 76,60,152
TR 24,7,8512
MAV 76,44,144
TR 26,7,9024
TR 28,7,8544
TR 30,7,9056
s_waitcnt vmcnt(18) lgkmcnt(8)
s_barrier
MAV 32,0,96
ds_read_b64_tr_b16 a[32:33], v6
s_add_u32 m0, s55, 50688
MAV 32,16,104
buffer_load_dwordx4 v18, s[28:31], s54 offen lds
MAV 48,16,108
TR 34,6,512
MAV 48,0,100
TR 36,6,32
TR 38,6,544
MAV 52,4,100
TR 48,6,8448
s_add_u32 s52, s79, 802816
MAV 52,20,108
buffer_load_dwordx4 v[144:147], v4, s[16:19], s52 offen sc1
MAV 36,20,104
TR 50,6,8960
MAV 36,4,96
TR 52,6,8480
TR 54,6,8992
s_waitcnt lgkmcnt(8)
MAV 40,8,96
TR 40,6,64
MAV 40,24,104
buffer_load_dwordx4 v19, s[28:31], s54 offen offset:1056 lds
MAV 56,24,108
TR 42,6,576
.Lpad18:
s_cbranch_execz .Lpad21
s_add_u32 s54, s101, 1703936
MAV 56,8,100
TR 44,6,96
TR 46,6,608
MAV 60,12,100
TR 56,6,8512
MAV 60,28,108
buffer_load_dwordx4 v[148:151], v4, s[16:19], s52 offen offset:1024 sc1
MAV 44,28,104
TR 58,6,9024
MAV 44,12,96
TR 60,6,8544
TR 62,6,9056
s_waitcnt lgkmcnt(8)
MAV 64,32,96
TR 0,7,16896
s_add_u32 m0, s55, 59136
MAV 64,48,104
buffer_load_dwordx4 v18, s[28:31], s54 offen lds
MAV 80,48,108
TR 2,7,17408
MAV 80,32,100
TR 4,7,16928
TR 6,7,17440
MAV 84,36,100
TR 16,7,25344
s_add_u32 s52, s79, 868352
MAV 84,52,108
buffer_load_dwordx4 v[152:155], v4, s[16:19], s52 offen sc1
MAV 68,52,104
TR 18,7,25856
MAV 68,36,96
TR 20,7,25376
TR 22,7,25888
s_waitcnt lgkmcnt(8)
MAV 72,40,96
TR 8,7,16960
MAV 72,56,104
buffer_load_dwordx4 v19, s[28:31], s54 offen offset:1056 lds
MAV 88,56,108
TR 10,7,17472
s_add_u32 s54, s98, 1900544
MAV 88,40,100
TR 12,7,16992
TR 14,7,17504
MAV 92,44,100
TR 24,7,25408
MAV 92,60,108
buffer_load_dwordx4 v[156:159], v4, s[16:19], s52 offen offset:1024 sc1
MAV 76,60,104
TR 26,7,25920
MAV 76,44,96
TR 28,7,25440
TR 30,7,25952
s_waitcnt vmcnt(8)
v_cmp_gt_u32 vcc, v23, v25
s_nop 0
s_cbranch_vccnz .Lsp50
.Lsp50b:
s_waitcnt lgkmcnt(8)
s_barrier
MAV 32,0,112
TR 32,6,16896
s_add_u32 m0, s55, 67584
MAV 32,16,120
buffer_load_dwordx4 v18, s[28:31], s54 offen lds
MAV 48,16,124
TR 34,6,17408
MAV 48,0,116
TR 36,6,16928
TR 38,6,17440
MAV 52,4,116
TR 48,6,25344
s_add_u32 s52, s76, 16384
MAV 52,20,124
buffer_load_dwordx4 v[96:99], v4, s[16:19], s52 offen sc1
MAV 36,20,120
TR 50,6,25856
MAV 36,4,112
TR 52,6,25376
TR 54,6,25888
s_waitcnt lgkmcnt(8)
MAV 40,8,112
TR 40,6,16960
MAV 40,24,120
buffer_load_dwordx4 v19, s[28:31], s54 offen offset:1056 lds
MAV 56,24,124
TR 42,6,17472
s_add_u32 s54, s98, 2162688
MAV 56,8,116
TR 44,6,16992
TR 46,6,17504
MAV 60,12,116
TR 56,6,25408
MAV 60,28,124
buffer_load_dwordx4 v[100:103], v4, s[16:19], s52 offen offset:1024 sc1
MAV 44,28,120
TR 58,6,25920
MAV 44,12,112
TR 60,6,25440
TR 62,6,25952
s_waitcnt lgkmcnt(8)
MAV 64,32,112
TR 0,7,33792
s_add_u32 m0, s55, 76032
MAV 64,48,120
buffer_load_dwordx4 v18, s[28:31], s54 offen lds
MAV 80,48,124
TR 2,7,34304
MAV 80,32,116
TR 4,7,33824
TR 6,7,34336
MAV 84,36,116
TR 16,7,42240
s_add_u32 s52, s76, 81920
MAV 84,52,124
buffer_load_dwordx4 v[104:107], v4, s[16:19], s52 offen sc1
MAV 68,52,120
TR 18,7,42752
MAV 68,36,112
TR 20,7,42272
TR 22,7,42784
s_waitcnt lgkmcnt(8)
MAV 72,40,112
TR 8,7,33856
MAV 72,56,120
buffer_load_dwordx4 v19, s[28:31], s54 offen offset:1056 lds
MAV 88,56,124
TR 10,7,34368
s_add_u32 s54, s99, 2359296
MAV 88,40,116
TR 12,7,33888
TR 14,7,34400
MAV 92,44,116
TR 24,7,42304
MAV 92,60,124
buffer_load_dwordx4 v[108:111], v4, s[16:19], s52 offen offset:1024 sc1
MAV 76,60,120
TR 26,7,42816
MAV 76,44,112
TR 28,7,42336
TR 30,7,42848
s_waitcnt lgkmcnt(8)
s_barrier
MAV 32,0,128
TR 32,6,33792
s_add_u32 m0, s55, 84480
MAV 32,16,136
buffer_load_dwordx4 v18, s[28:31], s54 offen lds
MAV 48,16,140
TR 34,6,34304
MAV 48,0,132
TR 36,6,33824
TR 38,6,34336
MAV 52,4,132
TR 48,6,42240
s_add_u32 s52, s77, 131072
MAV 52,20,140
buffer_load_dwordx4 v[112:115], v4, s[16:19], s52 offen sc1
MAV 36,20,136
TR 50,6,42752
MAV 36,4,128
TR 52,6,42272
TR 54,6,42784
s_waitcnt lgkmcnt(8)
MAV 40,8,128
TR 40,6,33856
MAV 40,24,136
buffer_load_dwordx4 v19, s[28:31], s54 offen offset:1056 lds
MAV 56,24,140
TR 42,6,34368
s_add_u32 s54, s99, 2621440
MAV 56,8,132
TR 44,6,33888
TR 46,6,34400
MAV 60,12,132
TR 56,6,42304
MAV 60,28,140
buffer_load_dwordx4 v[116:119], v4, s[16:19], s52 offen offset:1024 sc1
MAV 44,28,136
TR 58,6,42816
MAV 44,12,128
TR 60,6,42336
TR 62,6,42848
s_waitcnt lgkmcnt(8)
MAV 64,32,128
TR 0,7,50688
s_add_u32 m0, s55, 92928
MAV 64,48,136
buffer_load_dwordx4 v18, s[28:31], s54 offen lds
MAV 80,48,140
TR 2,7,51200
MAV 80,32,132
TR 4,7,50720
TR 6,7,51232
MAV 84,36,132
TR 16,7,59136
s_add_u32 s52, s77, 196608
MAV 84,52,140
buffer_load_dwordx4 v[120:123], v4, s[16:19], s52 offen sc1
MAV 68,52,136
TR 18,7,59648
MAV 68,36,128
TR 20,7,59168
TR 22,7,59680
s_waitcnt lgkmcnt(8)
MAV 72,40,128
TR 8,7,50752
MAV 72,56,136
buffer_load_dwordx4 v19, s[28:31], s54 offen offset:1056 lds
MAV 88,56,140
TR 10,7,51264
s_add_u32 s54, s100, 2818048
MAV 88,40,132
TR 12,7,50784
TR 14,7,51296
MAV 92,44,132
TR 24,7,59200
MAV 92,60,140
buffer_load_dwordx4 v[124:127], v4, s[16:19], s52 offen offset:1024 sc1
MAV 76,60,136
TR 26,7,59712
MAV 76,44,128
TR 28,7,59232
TR 30,7,59744
s_waitcnt vmcnt(16) lgkmcnt(8)
s_barrier
MAV 32,0,144
TR 32,6,50688
s_add_u32 m0, s55, 101376
MAV 32,16,152
buffer_load_dwordx4 v18, s[28:31], s54 offen lds
MAV 48,16,156
TR 34,6,51200
MAV 48,0,148
TR 36,6,50720
TR 38,6,51232
MAV 52,4,148
TR 48,6,59136
s_add_u32 s52, s78, 245760
MAV 52,20,156
buffer_load_dwordx4 v[128:131], v4, s[16:19], s52 offen sc1
MAV 36,20,152
TR 50,6,59648
MAV 36,4,144
TR 52,6,59168
TR 54,6,59680
s_waitcnt lgkmcnt(8)
MAV 40,8,144
TR 40,6,50752
MAV 40,24,152
buffer_load_dwordx4 v19, s[28:31], s54 offen offset:1056 lds
MAV 56,24,156
TR 42,6,51264
s_add_u32 s54, s100, 3080192
MAV 56,8,148
TR 44,6,50784
TR 46,6,51296
MAV 60,12,148
TR 56,6,59200
MAV 60,28,156
buffer_load_dwordx4 v[132:135], v4, s[16:19], s52 offen offset:1024 sc1
MAV 44,28,152
TR 58,6,59712
MAV 44,12,144
TR 60,6,59232
TR 62,6,59744
v_add_u32 v7, s57, v7
v_add_u32 v6, s57, v6
s_sub_u32 s57, 0, s57
s_waitcnt lgkmcnt(8)
MAV 64,32,144
ds_read_b64_tr_b16 a[0:1], v7
s_add_u32 m0, s55, 109824
MAV 64,48,152
buffer_load_dwordx4 v18, s[28:31], s54 offen lds
MAV 80,48,156
TR 2,7,512
MAV 80,32,148
TR 4,7,32
TR 6,7,544
MAV 84,36,148
TR 16,7,8448
s_add_u32 s52, s78, 311296
MAV 84,52,156
buffer_load_dwordx4 v[136:139], v4, s[16:19], s52 offen sc1
MAV 68,52,152
TR 18,7,8960
MAV 68,36,144
TR 20,7,8480
TR 22,7,8992
s_waitcnt lgkmcnt(8)
MAV 72,40,144
TR 8,7,64
MAV 72,56,152
buffer_load_dwordx4 v19, s[28:31], s54 offen offset:1056 lds
MAV 88,56,156
TR 10,7,576
s_add_u32 s54, s101, 3276800
MAV 88,40,148
TR 12,7,96
TR 14,7,608
MAV 92,44,148
TR 24,7,8512
MAV 92,60,156
buffer_load_dwordx4 v[140:143], v4, s[16:19], s52 offen offset:1024 sc1
MAV 76,60,152
TR 26,7,9024
MAV 76,44,144
TR 28,7,8544
TR 30,7,9056
s_waitcnt vmcnt(16) lgkmcnt(8)
s_barrier
MAV 32,0,96
ds_read_b64_tr_b16 a[32:33], v6
s_add_u32 m0, s55, 118272
MAV 32,16,104
buffer_load_dwordx4 v18, s[28:31], s54 offen lds
MAV 48,16,108
TR 34,6,512
MAV 48,0,100
TR 36,6,32
TR 38,6,544
MAV 52,4,100
TR 48,6,8448
s_add_u32 s52, s79, 360448
MAV 52,20,108
buffer_load_dwordx4 v[144:147], v4, s[16:19], s52 offen sc1
MAV 36,20,104
TR 50,6,8960
MAV 36,4,96
TR 52,6,8480
TR 54,6,8992
s_waitcnt lgkmcnt(8)
MAV 40,8,96
TR 40,6,64
MAV 40,24,104
buffer_load_dwordx4 v19, s[28:31], s54 offen offset:1056 lds
MAV 56,24,108
TR 42,6,576
s_add_u32 s54, s101, 3538944
MAV 56,8,100
TR 44,6,96
TR 46,6,608
MAV 60,12,100
TR 56,6,8512
MAV 60,28,108
buffer_load_dwordx4 v[148:151], v4, s[16:19], s52 offen offset:1024 sc1
MAV 44,28,104
TR 58,6,9024
MAV 44,12,96
TR 60,6,8544
TR 62,6,9056
s_waitcnt lgkmcnt(8)
MAV 64,32,96
TR 0,7,16896
s_add_u32 m0, s55, 126720
MAV 64,48,104
buffer_load_dwordx4 v18, s[28:31], s54 offen lds
MAV 80,48,108
TR 2,7,17408
MAV 80,32,100
TR 4,7,16928
TR 6,7,17440
MAV 84,36,100
TR 16,7,25344
s_add_u32 s52, s79, 425984
MAV 84,52,108
buffer_load_dwordx4 v[152:155], v4, s[16:19], s52 offen sc1
MAV 68,52,104
TR 18,7,25856
MAV 68,36,96
TR 20,7,25376
TR 22,7,25888
s_waitcnt lgkmcnt(8)
MAV 72,40,96
TR 8,7,16960
MAV 72,56,104
buffer_load_dwordx4 v19, s[28:31], s54 offen offset:1056 lds
MAV 88,56,108
TR 10,7,17472
s_add_u32 s54, s98, 131072
MAV 88,40,100
TR 12,7,16992
TR 14,7,17504
MAV 92,44,100
TR 24,7,25408
MAV 92,60,108
buffer_load_dwordx4 v[156:159], v4, s[16:19], s52 offen offset:1024 sc1
MAV 76,60,104
TR 26,7,25920
MAV 76,44,96
TR 28,7,25440
TR 30,7,25952
s_waitcnt vmcnt(16) lgkmcnt(8)
s_barrier
MAV 32,0,112
TR 32,6,16896
s_add_u32 m0, s55, 0
MAV 32,16,120
buffer_load_dwordx4 v18, s[28:31], s54 offen lds
MAV 48,16,124
TR 34,6,17408
MAV 48,0,116
TR 36,6,16928
TR 38,6,17440
MAV 52,4,116
TR 48,6,25344
s_add_u32 s52, s76, 475136
MAV 52,20,124
buffer_load_dwordx4 v[96:99], v4, s[16:19], s52 offen sc1
MAV 36,20,120
TR 50,6,25856
MAV 36,4,112
TR 52,6,25376
TR 54,6,25888
s_waitcnt lgkmcnt(8)
MAV 40,8,112
TR 40,6,16960
MAV 40,24,120
buffer_load_dwordx4 v19, s[28:31], s54 offen offset:1056 lds
MAV 56,24,124
TR 42,6,17472
s_add_u32 s54, s98, 393216
MAV 56,8,116
TR 44,6,16992
TR 46,6,17504
MAV 60,12,116
TR 56,6,25408
MAV 60,28,124
buffer_load_dwordx4 v[100:103], v4, s[16:19], s52 offen offset:1024 sc1
MAV 44,28,120
TR 58,6,25920
MAV 44,12,112
TR 60,6,25440
TR 62,6,25952
s_waitcnt lgkmcnt(8)
MAV 64,32,112
TR 0,7,33792
s_add_u32 m0, s55, 8448
MAV 64,48,120
buffer_load_dwordx4 v18, s[28:31], s54 offen lds
MAV 80,48,124
TR 2,7,34304
MAV 80,32,116
TR 4,7,33824
TR 6,7,34336
MAV 84,36,116
TR 16,7,42240
s_add_u32 s52, s76, 540672
MAV 84,52,124
buffer_load_dwordx4 v[104:107], v4, s[16:19], s52 offen sc1
MAV 68,52,120
TR 18,7,42752
MAV 68,36,112
TR 20,7,42272
TR 22,7,42784
s_waitcnt lgkmcnt(8)
MAV 72,40,112
TR 8,7,33856
MAV 72,56,120
buffer_load_dwordx4 v19, s[28:31], s54 offen offset:1056 lds
MAV 88,56,124
TR 10,7,34368
s_add_u32 s54, s99, 589824
MAV 88,40,116
TR 12,7,33888
TR 14,7,34400
MAV 92,44,116
TR 24,7,42304
MAV 92,60,124
buffer_load_dwordx4 v[108:111], v4, s[16:19], s52 offen offset:1024 sc1
MAV 76,60,120
TR 26,7,42816
MAV 76,44,112
TR 28,7,42336
TR 30,7,42848
s_waitcnt vmcnt(16) lgkmcnt(8)
s_barrier
MAV 32,0,128
TR 32,6,33792
s_add_u32 m0, s55, 16896
MAV 32,16,136
buffer_load_dwordx4 v18, s[28:31], s54 offen lds
MAV 48,16,140
TR 34,6,34304
MAV 48,0,132
TR 36,6,33824
TR 38,6,34336
MAV 52,4,132
TR 48,6,42240
s_add_u32 s52, s77, 589824
MAV 52,20,140
buffer_load_dwordx4 v[112:115], v4, s[16:19], s52 offen sc1
MAV 36,20,136
TR 50,6,42752
MAV 36,4,128
TR 52,6,42272
TR 54,6,42784
s_waitcnt lgkmcnt(8)
MAV 40,8,128
TR 40,6,33856
MAV 40,24,136
buffer_load_dwordx4 v19, s[28:31], s54 offen offset:1056 lds
MAV 56,24,140
TR 42,6,34368
s_add_u32 s54, s99, 851968
MAV 56,8,132
TR 44,6,33888
TR 46,6,34400
MAV 60,12,132
TR 56,6,42304
MAV 60,28,140
buffer_load_dwordx4 v[116:119], v4, s[16:19], s52 offen offset:1024 sc1
MAV 44,28,136
TR 58,6,42816
MAV 44,12,128
TR 60,6,42336
TR 62,6,42848
s_waitcnt lgkmcnt(8)
MAV 64,32,128
TR 0,7,50688
s_add_u32 m0, s55, 25344
MAV 64,48,136
buffer_load_dwordx4 v18, s[28:31], s54 offen lds
MAV 80,48,140
TR 2,7,51200
MAV 80,32,132
TR 4,7,50720
TR 6,7,51232
MAV 84,36,132
TR 16,7,59136
.Lpad19:
s_cbranch_execz .Lpad22
s_add_u32 s52, s77, 655360
MAV 84,52,140
buffer_load_dwordx4 v[120:123], v4, s[16:19], s52 offen sc1
MAV 68,52,136
TR 18,7,59648
MAV 68,36,128
TR 20,7,59168
TR 22,7,59680
s_waitcnt lgkmcnt(8)
MAV 72,40,128
TR 8,7,50752
MAV 72,56,136
buffer_load_dwordx4 v19, s[28:31], s54 offen offset:1056 lds
MAV 88,56,140
TR 10,7,51264
s_add_u32 s54, s100, 1048576
MAV 88,40,132
TR 12,7,50784
TR 14,7,51296
MAV 92,44,132
TR 24,7,59200
MAV 92,60,140
buffer_load_dwordx4 v[124:127], v4, s[16:19], s52 offen offset:1024 sc1
MAV 76,60,136
TR 26,7,59712
MAV 76,44,128
TR 28,7,59232
TR 30,7,59744
s_waitcnt vmcnt(16) lgkmcnt(8)
s_barrier
MAV 32,0,144
TR 32,6,50688
s_add_u32 m0, s55, 33792
MAV 32,16,152
buffer_load_dwordx4 v18, s[28:31], s54 offen lds
MAV 48,16,156
TR 34,6,51200
MAV 48,0,148
TR 36,6,50720
TR 38,6,51232
MAV 52,4,148
TR 48,6,59136
s_add_u32 s52, s78, 704512
MAV 52,20,156
buffer_load_dwordx4 v[128:131], v4, s[16:19], s52 offen sc1
MAV 36,20,152
TR 50,6,59648
MAV 36,4,144
TR 52,6,59168
TR 54,6,59680
s_waitcnt lgkmcnt(8)
MAV 40,8,144
TR 40,6,50752
MAV 40,24,152
buffer_load_dwordx4 v19, s[28:31], s54 offen offset:1056 lds
MAV 56,24,156
TR 42,6,51264
s_add_u32 s54, s100, 1310720
MAV 56,8,148
TR 44,6,50784
TR 46,6,51296
MAV 60,12,148
TR 56,6,59200
MAV 60,28,156
buffer_load_dwordx4 v[132:135], v4, s[16:19], s52 offen offset:1024 sc1
MAV 44,28,152
TR 58,6,59712
MAV 44,12,144
TR 60,6,59232
TR 62,6,59744
v_add_u32 v7, s57, v7
v_add_u32 v6, s57, v6
s_sub_u32 s57, 0, s57
s_waitcnt lgkmcnt(8)
MAV 64,32,144
ds_read_b64_tr_b16 a[0:1], v7
s_add_u32 m0, s55, 42240
MAV 64,48,152
buffer_load_dwordx4 v18, s[28:31], s54 offen lds
MAV 80,48,156
TR 2,7,512
MAV 80,32,148
TR 4,7,32
TR 6,7,544
MAV 84,36,148
TR 16,7,8448
s_add_u32 s52, s78, 770048
MAV 84,52,156
buffer_load_dwordx4 v[136:139], v4, s[16:19], s52 offen sc1
MAV 68,52,152
TR 18,7,8960
MAV 68,36,144
TR 20,7,8480
TR 22,7,8992
s_waitcnt lgkmcnt(8)
MAV 72,40,144
TR 8,7,64
MAV 72,56,152
buffer_load_dwordx4 v19, s[28:31], s54 offen offset:1056 lds
MAV 88,56,156
TR 10,7,576
s_add_u32 s54, s101, 1507328
MAV 88,40,148
TR 12,7,96
TR 14,7,608
MAV 92,44,148
TR 24,7,8512
MAV 92,60,156
buffer_load_dwordx4 v[140:143], v4, s[16:19], s52 offen offset:1024 sc1
MAV 76,60,152
TR 26,7,9024
MAV 76,44,144
TR 28,7,8544
TR 30,7,9056
s_waitcnt vmcnt(16) lgkmcnt(8)
s_barrier
MAV 32,0,96
ds_read_b64_tr_b16 a[32:33], v6
s_add_u32 m0, s55, 50688
MAV 32,16,104
buffer_load_dwordx4 v18, s[28:31], s54 offen lds
MAV 48,16,108
TR 34,6,512
MAV 48,0,100
TR 36,6,32
TR 38,6,544
MAV 52,4,100
TR 48,6,8448
s_add_u32 s52, s79, 819200
MAV 52,20,108
buffer_load_dwordx4 v[144:147], v4, s[16:19], s52 offen sc1
MAV 36,20,104
TR 50,6,8960
MAV 36,4,96
TR 52,6,8480
TR 54,6,8992
s_waitcnt lgkmcnt(8)
MAV 40,8,96
TR 40,6,64
MAV 40,24,104
buffer_load_dwordx4 v19, s[28:31], s54 offen offset:1056 lds
MAV 56,24,108
TR 42,6,576
s_add_u32 s54, s101, 1769472
MAV 56,8,100
TR 44,6,96
TR 46,6,608
MAV 60,12,100
TR 56,6,8512
MAV 60,28,108
buffer_load_dwordx4 v[148:151], v4, s[16:19], s52 offen offset:1024 sc1
MAV 44,28,104
TR 58,6,9024
MAV 44,12,96
TR 60,6,8544
TR 62,6,9056
s_waitcnt lgkmcnt(8)
MAV 64,32,96
TR 0,7,16896
s_add_u32 m0, s55, 59136
MAV 64,48,104
buffer_load_dwordx4 v18, s[28:31], s54 offen lds
MAV 80,48,108
TR 2,7,17408
MAV 80,32,100
TR 4,7,16928
TR 6,7,17440
MAV 84,36,100
TR 16,7,25344
s_add_u32 s52, s79, 884736
MAV 84,52,108
buffer_load_dwordx4 v[152:155], v4, s[16:19], s52 offen sc1
MAV 68,52,104
TR 18,7,25856
MAV 68,36,96
TR 20,7,25376
TR 22,7,25888
s_waitcnt lgkmcnt(8)
MAV 72,40,96
TR 8,7,16960
MAV 72,56,104
buffer_load_dwordx4 v19, s[28:31], s54 offen offset:1056 lds
MAV 88,56,108
TR 10,7,17472
s_add_u32 s54, s98, 1966080
MAV 88,40,100
TR 12,7,16992
TR 14,7,17504
MAV 92,44,100
TR 24,7,25408
MAV 92,60,108
buffer_load_dwordx4 v[156:159], v4, s[16:19], s52 offen offset:1024 sc1
MAV 76,60,104
TR 26,7,25920
MAV 76,44,96
TR 28,7,25440
TR 30,7,25952
s_waitcnt vmcnt(16) lgkmcnt(8)
s_barrier
MAV 32,0,112
TR 32,6,16896
s_add_u32 m0, s55, 67584
MAV 32,16,120
buffer_load_dwordx4 v18, s[28:31], s54 offen lds
MAV 48,16,124
TR 34,6,17408
MAV 48,0,116
TR 36,6,16928
TR 38,6,17440
MAV 52,4,116
TR 48,6,25344
s_add_u32 s52, s76, 32768
MAV 52,20,124
buffer_load_dwordx4 v[96:99], v4, s[16:19], s52 offen sc1
MAV 36,20,120
TR 50,6,25856
MAV 36,4,112
TR 52,6,25376
TR 54,6,25888
s_waitcnt lgkmcnt(8)
MAV 40,8,112
TR 40,6,16960
MAV 40,24,120
buffer_load_dwordx4 v19, s[28:31], s54 offen offset:1056 lds
MAV 56,24,124
TR 42,6,17472
s_add_u32 s54, s98, 2228224
MAV 56,8,116
TR 44,6,16992
TR 46,6,17504
MAV 60,12,116
TR 56,6,25408
MAV 60,28,124
buffer_load_dwordx4 v[100:103], v4, s[16:19], s52 offen offset:1024 sc1
MAV 44,28,120
TR 58,6,25920
MAV 44,12,112
TR 60,6,25440
TR 62,6,25952
s_waitcnt lgkmcnt(8)
MAV 64,32,112
TR 0,7,33792
s_add_u32 m0, s55, 76032
MAV 64,48,120
buffer_load_dwordx4 v18, s[28:31], s54 offen lds
MAV 80,48,124
TR 2,7,34304
MAV 80,32,116
TR 4,7,33824
TR 6,7,34336
MAV 84,36,116
TR 16,7,42240
s_add_u32 s52, s76, 98304
MAV 84,52,124
buffer_load_dwordx4 v[104:107], v4, s[16:19], s52 offen sc1
MAV 68,52,120
TR 18,7,42752
MAV 68,36,112
TR 20,7,42272
TR 22,7,42784
s_waitcnt lgkmcnt(8)
MAV 72,40,112
TR 8,7,33856
MAV 72,56,120
buffer_load_dwordx4 v19, s[28:31], s54 offen offset:1056 lds
MAV 88,56,124
TR 10,7,34368
s_add_u32 s54, s99, 2424832
MAV 88,40,116
TR 12,7,33888
TR 14,7,34400
MAV 92,44,116
TR 24,7,42304
MAV 92,60,124
buffer_load_dwordx4 v[108:111], v4, s[16:19], s52 offen offset:1024 sc1
MAV 76,60,120
TR 26,7,42816
MAV 76,44,112
TR 28,7,42336
TR 30,7,42848
s_waitcnt vmcnt(16) lgkmcnt(8)
s_barrier
MAV 32,0,128
TR 32,6,33792
s_add_u32 m0, s55, 84480
MAV 32,16,136
buffer_load_dwordx4 v18, s[28:31], s54 offen lds
MAV 48,16,140
TR 34,6,34304
MAV 48,0,132
TR 36,6,33824
TR 38,6,34336
MAV 52,4,132
TR 48,6,42240
s_add_u32 s52, s77, 147456
MAV 52,20,140
buffer_load_dwordx4 v[112:115], v4, s[16:19], s52 offen sc1
MAV 36,20,136
TR 50,6,42752
MAV 36,4,128
TR 52,6,42272
TR 54,6,42784
s_waitcnt lgkmcnt(8)
MAV 40,8,128
TR 40,6,33856
MAV 40,24,136
buffer_load_dwordx4 v19, s[28:31], s54 offen offset:1056 lds
MAV 56,24,140
TR 42,6,34368
s_add_u32 s54, s99, 2686976
MAV 56,8,132
TR 44,6,33888
TR 46,6,34400
MAV 60,12,132
TR 56,6,42304
MAV 60,28,140
buffer_load_dwordx4 v[116:119], v4, s[16:19], s52 offen offset:1024 sc1
MAV 44,28,136
TR 58,6,42816
MAV 44,12,128
TR 60,6,42336
TR 62,6,42848
s_waitcnt lgkmcnt(8)
MAV 64,32,128
TR 0,7,50688
s_add_u32 m0, s55, 92928
MAV 64,48,136
buffer_load_dwordx4 v18, s[28:31], s54 offen lds
MAV 80,48,140
TR 2,7,51200
MAV 80,32,132
TR 4,7,50720
TR 6,7,51232
MAV 84,36,132
TR 16,7,59136
s_add_u32 s52, s77, 212992
MAV 84,52,140
buffer_load_dwordx4 v[120:123], v4, s[16:19], s52 offen sc1
MAV 68,52,136
TR 18,7,59648
MAV 68,36,128
TR 20,7,59168
TR 22,7,59680
s_waitcnt lgkmcnt(8)
MAV 72,40,128
TR 8,7,50752
MAV 72,56,136
buffer_load_dwordx4 v19, s[28:31], s54 offen offset:1056 lds
MAV 88,56,140
TR 10,7,51264
s_add_u32 s54, s100, 2883584
MAV 88,40,132
TR 12,7,50784
TR 14,7,51296
MAV 92,44,132
TR 24,7,59200
MAV 92,60,140
buffer_load_dwordx4 v[124:127], v4, s[16:19], s52 offen offset:1024 sc1
MAV 76,60,136
TR 26,7,59712
MAV 76,44,128
TR 28,7,59232
TR 30,7,59744
s_waitcnt vmcnt(16) lgkmcnt(8)
s_barrier
MAV 32,0,144
TR 32,6,50688
s_add_u32 m0, s55, 101376
MAV 32,16,152
buffer_load_dwordx4 v18, s[28:31], s54 offen lds
MAV 48,16,156
TR 34,6,51200
MAV 48,0,148
TR 36,6,50720
TR 38,6,51232
MAV 52,4,148
TR 48,6,59136
s_add_u32 s52, s78, 262144
MAV 52,20,156
buffer_load_dwordx4 v[128:131], v4, s[16:19], s52 offen sc1
MAV 36,20,152
TR 50,6,59648
MAV 36,4,144
TR 52,6,59168
TR 54,6,59680
s_waitcnt lgkmcnt(8)
MAV 40,8,144
TR 40,6,50752
MAV 40,24,152
buffer_load_dwordx4 v19, s[28:31], s54 offen offset:1056 lds
MAV 56,24,156
TR 42,6,51264
s_add_u32 s54, s100, 3145728
MAV 56,8,148
TR 44,6,50784
TR 46,6,51296
MAV 60,12,148
TR 56,6,59200
MAV 60,28,156
buffer_load_dwordx4 v[132:135], v4, s[16:19], s52 offen offset:1024 sc1
MAV 44,28,152
TR 58,6,59712
MAV 44,12,144
TR 60,6,59232
TR 62,6,59744
v_add_u32 v7, s57, v7
v_add_u32 v6, s57, v6
s_sub_u32 s57, 0, s57
s_waitcnt lgkmcnt(8)
MAV 64,32,144
ds_read_b64_tr_b16 a[0:1], v7
s_add_u32 m0, s55, 109824
MAV 64,48,152
buffer_load_dwordx4 v18, s[28:31], s54 offen lds
MAV 80,48,156
TR 2,7,512
MAV 80,32,148
TR 4,7,32
TR 6,7,544
MAV 84,36,148
TR 16,7,8448
s_add_u32 s52, s78, 327680
MAV 84,52,156
buffer_load_dwordx4 v[136:139], v4, s[16:19], s52 offen sc1
MAV 68,52,152
TR 18,7,8960
MAV 68,36,144
TR 20,7,8480
TR 22,7,8992
s_waitcnt lgkmcnt(8)
MAV 72,40,144
TR 8,7,64
MAV 72,56,152
buffer_load_dwordx4 v19, s[28:31], s54 offen offset:1056 lds
MAV 88,56,156
TR 10,7,576
s_add_u32 s54, s101, 3342336
MAV 88,40,148
TR 12,7,96
TR 14,7,608
MAV 92,44,148
TR 24,7,8512
MAV 92,60,156
buffer_load_dwordx4 v[140:143], v4, s[16:19], s52 offen offset:1024 sc1
MAV 76,60,152
TR 26,7,9024
MAV 76,44,144
TR 28,7,8544
TR 30,7,9056
s_waitcnt vmcnt(16) lgkmcnt(8)
s_barrier
MAV 32,0,96
ds_read_b64_tr_b16 a[32:33], v6
s_add_u32 m0, s55, 118272
MAV 32,16,104
buffer_load_dwordx4 v18, s[28:31], s54 offen lds
MAV 48,16,108
TR 34,6,512
MAV 48,0,100
TR 36,6,32
TR 38,6,544
MAV 52,4,100
TR 48,6,8448
s_add_u32 s52, s79, 376832
MAV 52,20,108
buffer_load_dwordx4 v[144:147], v4, s[16:19], s52 offen sc1
MAV 36,20,104
TR 50,6,8960
MAV 36,4,96
TR 52,6,8480
TR 54,6,8992
s_waitcnt lgkmcnt(8)
MAV 40,8,96
TR 40,6,64
MAV 40,24,104
buffer_load_dwordx4 v19, s[28:31], s54 offen offset:1056 lds
MAV 56,24,108
TR 42,6,576
s_add_u32 s54, s101, 3604480
MAV 56,8,100
TR 44,6,96
TR 46,6,608
MAV 60,12,100
TR 56,6,8512
MAV 60,28,108
buffer_load_dwordx4 v[148:151], v4, s[16:19], s52 offen offset:1024 sc1
MAV 44,28,104
TR 58,6,9024
MAV 44,12,96
TR 60,6,8544
TR 62,6,9056
s_waitcnt lgkmcnt(8)
MAV 64,32,96
TR 0,7,16896
s_add_u32 m0, s55, 126720
MAV 64,48,104
buffer_load_dwordx4 v18, s[28:31], s54 offen lds
MAV 80,48,108
TR 2,7,17408
MAV 80,32,100
TR 4,7,16928
TR 6,7,17440
MAV 84,36,100
TR 16,7,25344
s_add_u32 s52, s79, 442368
MAV 84,52,108
buffer_load_dwordx4 v[152:155], v4, s[16:19], s52 offen sc1
MAV 68,52,104
TR 18,7,25856
MAV 68,36,96
TR 20,7,25376
TR 22,7,25888
s_waitcnt lgkmcnt(8)
MAV 72,40,96
TR 8,7,16960
MAV 72,56,104
buffer_load_dwordx4 v19, s[28:31], s54 offen offset:1056 lds
MAV 88,56,108
TR 10,7,17472
s_add_u32 s54, s98, 196608
MAV 88,40,100
TR 12,7,16992
TR 14,7,17504
MAV 92,44,100
TR 24,7,25408
MAV 92,60,108
buffer_load_dwordx4 v[156:159], v4, s[16:19], s52 offen offset:1024 sc1
MAV 76,60,104
TR 26,7,25920
MAV 76,44,96
.Lpad20:
s_cbranch_execz .Lnopoll37r
TR 28,7,25440
TR 30,7,25952
s_waitcnt vmcnt(16) lgkmcnt(8)
s_barrier
MAV 32,0,112
TR 32,6,16896
s_add_u32 m0, s55, 0
MAV 32,16,120
buffer_load_dwordx4 v18, s[28:31], s54 offen lds
MAV 48,16,124
TR 34,6,17408
MAV 48,0,116
TR 36,6,16928
TR 38,6,17440
MAV 52,4,116
TR 48,6,25344
s_add_u32 s52, s76, 491520
MAV 52,20,124
buffer_load_dwordx4 v[96:99], v4, s[16:19], s52 offen sc1
MAV 36,20,120
TR 50,6,25856
MAV 36,4,112
TR 52,6,25376
TR 54,6,25888
s_waitcnt lgkmcnt(8)
MAV 40,8,112
TR 40,6,16960
MAV 40,24,120
buffer_load_dwordx4 v19, s[28:31], s54 offen offset:1056 lds
MAV 56,24,124
TR 42,6,17472
s_add_u32 s54, s99, 655360
MAV 56,8,116
TR 44,6,16992
TR 46,6,17504
MAV 60,12,116
TR 56,6,25408
MAV 60,28,124
buffer_load_dwordx4 v[100:103], v4, s[16:19], s52 offen offset:1024 sc1
MAV 44,28,120
TR 58,6,25920
MAV 44,12,112
TR 60,6,25440
TR 62,6,25952
s_waitcnt lgkmcnt(8)
MAV 64,32,112
TR 0,7,33792
s_add_u32 m0, s55, 8448
MAV 64,48,120
buffer_load_dwordx4 v18, s[28:31], s54 offen lds
MAV 80,48,124
TR 2,7,34304
MAV 80,32,116
TR 4,7,33824
TR 6,7,34336
MAV 84,36,116
TR 16,7,42240
s_add_u32 s52, s76, 557056
MAV 84,52,124
buffer_load_dwordx4 v[104:107], v4, s[16:19], s52 offen sc1
MAV 68,52,120
TR 18,7,42752
MAV 68,36,112
TR 20,7,42272
TR 22,7,42784
s_waitcnt lgkmcnt(8)
MAV 72,40,112
TR 8,7,33856
MAV 72,56,120
buffer_load_dwordx4 v19, s[28:31], s54 offen offset:1056 lds
MAV 88,56,124
TR 10,7,34368
s_add_u32 s54, s100, 1114112
MAV 88,40,116
TR 12,7,33888
TR 14,7,34400
MAV 92,44,116
TR 24,7,42304
MAV 92,60,124
buffer_load_dwordx4 v[108:111], v4, s[16:19], s52 offen offset:1024 sc1
MAV 76,60,120
TR 26,7,42816
MAV 76,44,112
TR 28,7,42336
TR 30,7,42848
s_waitcnt vmcnt(16) lgkmcnt(8)
s_barrier
MAV 32,0,128
TR 32,6,33792
s_add_u32 m0, s55, 16896
MAV 32,16,136
buffer_load_dwordx4 v18, s[28:31], s54 offen lds
MAV 48,16,140
TR 34,6,34304
MAV 48,0,132
TR 36,6,33824
TR 38,6,34336
MAV 52,4,132
TR 48,6,42240
s_add_u32 s52, s77, 606208
MAV 52,20,140
buffer_load_dwordx4 v[112:115], v4, s[16:19], s52 offen sc1
MAV 36,20,136
TR 50,6,42752
MAV 36,4,128
TR 52,6,42272
TR 54,6,42784
s_waitcnt lgkmcnt(8)
MAV 40,8,128
TR 40,6,33856
MAV 40,24,136
buffer_load_dwordx4 v19, s[28:31], s54 offen offset:1056 lds
MAV 56,24,140
TR 42,6,34368
s_add_u32 s54, s101, 1572864
MAV 56,8,132
TR 44,6,33888
TR 46,6,34400
MAV 60,12,132
TR 56,6,42304
MAV 60,28,140
buffer_load_dwordx4 v[116:119], v4, s[16:19], s52 offen offset:1024 sc1
MAV 44,28,136
TR 58,6,42816
MAV 44,12,128
TR 60,6,42336
TR 62,6,42848
s_waitcnt lgkmcnt(8)
MAV 64,32,128
TR 0,7,50688
s_add_u32 m0, s55, 25344
MAV 64,48,136
buffer_load_dwordx4 v18, s[28:31], s54 offen lds
MAV 80,48,140
TR 2,7,51200
MAV 80,32,132
TR 4,7,50720
TR 6,7,51232
MAV 84,36,132
TR 16,7,59136
s_add_u32 s52, s77, 671744
MAV 84,52,140
buffer_load_dwordx4 v[120:123], v4, s[16:19], s52 offen sc1
MAV 68,52,136
TR 18,7,59648
MAV 68,36,128
TR 20,7,59168
TR 22,7,59680
s_waitcnt lgkmcnt(8)
MAV 72,40,128
TR 8,7,50752
MAV 72,56,136
buffer_load_dwordx4 v19, s[28:31], s54 offen offset:1056 lds
MAV 88,56,140
TR 10,7,51264
s_add_u32 s54, s98, 2031616
MAV 88,40,132
TR 12,7,50784
TR 14,7,51296
MAV 92,44,132
TR 24,7,59200
MAV 92,60,140
buffer_load_dwordx4 v[124:127], v4, s[16:19], s52 offen offset:1024 sc1
MAV 76,60,136
TR 26,7,59712
MAV 76,44,128
TR 28,7,59232
TR 30,7,59744
s_waitcnt vmcnt(16) lgkmcnt(8)
s_barrier
MAV 32,0,144
TR 32,6,50688
s_add_u32 m0, s55, 33792
MAV 32,16,152
buffer_load_dwordx4 v18, s[28:31], s54 offen lds
MAV 48,16,156
TR 34,6,51200
MAV 48,0,148
TR 36,6,50720
TR 38,6,51232
MAV 52,4,148
TR 48,6,59136
s_add_u32 s52, s78, 720896
MAV 52,20,156
buffer_load_dwordx4 v[128:131], v4, s[16:19], s52 offen sc1
MAV 36,20,152
TR 50,6,59648
MAV 36,4,144
TR 52,6,59168
TR 54,6,59680
s_waitcnt lgkmcnt(8)
MAV 40,8,144
TR 40,6,50752
MAV 40,24,152
buffer_load_dwordx4 v19, s[28:31], s54 offen offset:1056 lds
MAV 56,24,156
TR 42,6,51264
s_add_u32 s54, s99, 2490368
MAV 56,8,148
TR 44,6,50784
TR 46,6,51296
MAV 60,12,148
TR 56,6,59200
MAV 60,28,156
buffer_load_dwordx4 v[132:135], v4, s[16:19], s52 offen offset:1024 sc1
MAV 44,28,152
TR 58,6,59712
MAV 44,12,144
TR 60,6,59232
TR 62,6,59744
v_add_u32 v7, s57, v7
v_add_u32 v6, s57, v6
s_sub_u32 s57, 0, s57
s_waitcnt lgkmcnt(8)
MAV 64,32,144
ds_read_b64_tr_b16 a[0:1], v6
s_add_u32 m0, s55, 42240
MAV 64,48,152
buffer_load_dwordx4 v18, s[28:31], s54 offen lds
MAV 80,48,156
TR 2,6,512
MAV 80,32,148
TR 4,6,32
TR 6,6,544
MAV 84,36,148
TR 16,6,8448
s_add_u32 s52, s78, 786432
MAV 84,52,156
buffer_load_dwordx4 v[136:139], v4, s[16:19], s52 offen sc1
MAV 68,52,152
TR 18,6,8960
MAV 68,36,144
TR 20,6,8480
TR 22,6,8992
s_waitcnt lgkmcnt(8)
MAV 72,40,144
TR 8,6,64
MAV 72,56,152
buffer_load_dwordx4 v19, s[28:31], s54 offen offset:1056 lds
MAV 88,56,156
TR 10,6,576
s_add_u32 s54, s100, 2949120
MAV 88,40,148
TR 12,6,96
TR 14,6,608
MAV 92,44,148
TR 24,6,8512
MAV 92,60,156
buffer_load_dwordx4 v[140:143], v4, s[16:19], s52 offen offset:1024 sc1
MAV 76,60,152
TR 26,6,9024
MAV 76,44,144
TR 28,6,8544
TR 30,6,9056
s_waitcnt vmcnt(16) lgkmcnt(8)
s_barrier
MAV 64,0,96
TR 32,6,16896
TR 34,6,17408
s_add_u32 m0, s55, 50688
MAV 64,16,104
TR 36,6,16928
buffer_load_dwordx4 v18, s[28:31], s54 offen lds
MAV 80,16,108
TR 38,6,17440
MAV 80,0,100
TR 48,6,25344
buffer_load_dwordx4 v19, s[28:31], s54 offen offset:1056 lds
MAV 84,4,100
TR 50,6,25856
s_add_u32 s54, s101, 3407872
s_add_u32 s52, s79, 835584
MAV 84,20,108
buffer_load_dwordx4 v[144:147], v4, s[16:19], s52 offen sc1
MAV 68,20,104
TR 52,6,25376
TR 54,6,25888
MAV 68,4,96
TR 40,6,16960
s_waitcnt lgkmcnt(9)
MAV 72,8,96
TR 42,6,17472
MAV 72,24,104
TR 44,6,16992
buffer_load_dwordx4 v[148:151], v4, s[16:19], s52 offen offset:1024 sc1
MAV 88,24,108
TR 46,6,17504
s_add_u32 m0, s55, 59136
MAV 88,8,100
TR 56,6,25408
buffer_load_dwordx4 v18, s[28:31], s54 offen lds
MAV 92,12,100
TR 58,6,25920
MAV 92,28,108
TR 60,6,25440
buffer_load_dwordx4 v19, s[28:31], s54 offen offset:1056 lds
MAV 76,28,104
TR 62,6,25952
s_add_u32 s52, s79, 901120
MAV 76,12,96
buffer_load_dwordx4 v[152:155], v4, s[16:19], s52 offen sc1
buffer_load_dwordx4 v[156:159], v4, s[16:19], s52 offen offset:1024 sc1
s_waitcnt vmcnt(16) lgkmcnt(8)
MAV 64,32,112
TR 0,6,33792
s_add_u32 s52, s76, 49152
s_lshl_b32 s70, s2, 10
MAV 64,48,120
buffer_load_dwordx4 v[160:163], v4, s[16:19], s52 offen sc1
s_lshl_b32 s62, s3, 7
MAV 80,48,124
TR 2,6,34304
s_add_u32 s70, s70, s62
s_add_u32 s70, s70, 31457280
MAV 80,32,116
TR 4,6,33824
TR 6,6,34336
MAV 84,36,116
TR 16,6,42240
s_xor_b32 s71, s70, 1024
v_min_u32 v12, 1, v1
MAV 84,52,124
buffer_load_dwordx4 v[164:167], v4, s[16:19], s52 offen offset:1024 sc1
v_lshlrev_b32 v12, 28, v12
MAV 68,52,120
TR 18,6,42752
v_mov_b32 v13, 1
MAV 68,36,112
TR 20,6,42272
TR 22,6,42784
s_waitcnt lgkmcnt(8)
MAV 72,40,112
TR 8,6,33856
s_add_u32 s52, s77, 163840
v_mov_b32 v15, 0
MAV 72,56,120
buffer_load_dwordx4 v[168:171], v4, s[16:19], s52 offen sc1
s_lshl_b32 s68, s7, 18
MAV 88,56,124
TR 10,6,34368
s_add_u32 s68, s68, 33554432
s_xor_b32 s69, s68, 262144
MAV 88,40,116
TR 12,6,33888
TR 14,6,34400
MAV 92,44,116
TR 24,6,42304
v_mov_b32 v11, v4
v_and_b32 v2, 1, v1
MAV 92,60,124
buffer_load_dwordx4 v[172:175], v4, s[16:19], s52 offen offset:1024 sc1
v_lshlrev_b32 v2, 4, v2
MAV 76,60,120
TR 26,6,42816
v_mov_b32 v224, 0x3f80
MAV 76,44,112
TR 28,6,42336
TR 30,6,42848
s_waitcnt vmcnt(12) lgkmcnt(8)
MAV 64,0,128
TR 32,6,50688
s_add_u32 s52, s78, 278528
v_lshlrev_b32 v2, v2, v224
MAV 64,16,136
buffer_load_dwordx4 v[176:179], v4, s[16:19], s52 offen sc1
v_bfe_u32 v224, v1, 2, 2
MAV 80,16,140
TR 34,6,51200
v_lshrrev_b32 v225, 4, v1
v_cmp_eq_u32 vcc, v224, v225
MAV 80,0,132
TR 36,6,50720
TR 38,6,51232
MAV 84,4,132
TR 48,6,59136
v_cndmask_b32 v2, 0, v2, vcc
v_and_b32 v224, 2, v1
MAV 84,20,140
buffer_load_dwordx4 v[180:183], v4, s[16:19], s52 offen offset:1024 sc1
v_cmp_eq_u32 vcc, 0, v224
MAV 68,20,136
TR 50,6,59648
v_cndmask_b32 v226, 0, v2, vcc
MAV 68,4,128
TR 52,6,59168
TR 54,6,59680
s_waitcnt lgkmcnt(8)
MAV 72,8,128
TR 40,6,50752
s_add_u32 s52, s79, 393216
v_cndmask_b32 v227, v2, 0, vcc
MAV 72,24,136
buffer_load_dwordx4 v[184:187], v4, s[16:19], s52 offen sc1
v_mov_b32 v224, 0
MAV 88,24,140
TR 42,6,51264
v_mov_b32 v225, 0
v_mov_b32 v228, 0
MAV 88,8,132
TR 44,6,50784
TR 46,6,51296
MAV 92,12,132
TR 56,6,59200
v_mov_b32 v229, 0
v_bfe_u32 v18, v1, 3, 1
MAV 92,28,140
buffer_load_dwordx4 v[188:191], v4, s[16:19], s52 offen offset:1024 sc1
v_lshrrev_b32 v2, 4, v1
MAV 76,28,136
TR 58,6,59712
v_lshl_add_u32 v18, v2, 3, v18
MAV 76,12,128
TR 60,6,59232
TR 62,6,59744
s_waitcnt vmcnt(8) lgkmcnt(8)
s_barrier
v_add_u32 v6, s57, v6
MAV 64,32,144
ds_read_b64_tr_b16 a[0:1], v6
s_add_u32 s52, s76, 507904
s_lshl_b32 s62, s3, 1
MAV 64,48,152
buffer_load_dwordx4 v[192:195], v4, s[16:19], s52 offen sc1
v_add_u32 v18, s62, v18
MAV 80,48,156
TR 2,6,512
v_mul_u32_u24 v18, 6144, v18
v_and_b32 v2, 7, v1
MAV 80,32,148
TR 4,6,32
TR 6,6,544
MAV 84,36,148
TR 16,6,8448
v_lshl_add_u32 v18, v2, 4, v18
s_lshl_b32 s62, s9, 7
MAV 84,52,156
buffer_load_dwordx4 v[196:199], v4, s[16:19], s52 offen offset:1024 sc1
v_add_u32 v18, s62, v18
MAV 68,52,152
TR 18,6,8960
v_add_u32 v19, 1024, v18
MAV 68,36,144
TR 20,6,8480
TR 22,6,8992
s_waitcnt lgkmcnt(8)
MAV 72,40,144
TR 8,6,64
s_add_u32 s52, s77, 622592
v_add_u32 v20, 2048, v18
MAV 72,56,152
buffer_load_dwordx4 v[200:203], v4, s[16:19], s52 offen sc1
s_mul_i32 s59, s3, 3104
MAV 88,56,156
TR 10,6,576
s_mov_b32 s58, 0
v_accvgpr_read_b32 v28, a224
MAV 88,40,148
TR 12,6,96
TR 14,6,608
MAV 92,44,148
TR 24,6,8512
v_add_f32 v32, v32, v28
v_accvgpr_read_b32 v29, a225
MAV 92,60,156
buffer_load_dwordx4 v[204:207], v4, s[16:19], s52 offen offset:1024 sc1
v_add_f32 v33, v33, v29
MAV 76,60,152
TR 26,6,9024
v_accvgpr_read_b32 v28, a226
MAV 76,44,144
TR 28,6,8544
TR 30,6,9056
s_waitcnt vmcnt(8) lgkmcnt(8)
MAV 64,0,160
TR 32,6,16896
s_add_u32 s52, s78, 737280
v_add_f32 v34, v34, v28
MAV 64,16,168
buffer_load_dwordx4 v[208:211], v4, s[16:19], s52 offen sc1
v_accvgpr_read_b32 v29, a227
MAV 80,16,172
TR 34,6,17408
v_add_f32 v35, v35, v29
v_accvgpr_read_b32 v28, a228
MAV 80,0,164
TR 36,6,16928
TR 38,6,17440
MAV 84,4,164
TR 48,6,25344
v_add_f32 v36, v36, v28
v_accvgpr_read_b32 v29, a229
MAV 84,20,172
buffer_load_dwordx4 v[212:215], v4, s[16:19], s52 offen offset:1024 sc1
v_add_f32 v37, v37, v29
MAV 68,20,168
TR 50,6,25856
v_accvgpr_read_b32 v28, a230
MAV 68,4,160
TR 52,6,25376
TR 54,6,25888
s_waitcnt lgkmcnt(8)
MAV 72,8,160
TR 40,6,16960
s_add_u32 s52, s79, 851968
v_add_f32 v38, v38, v28
MAV 72,24,168
buffer_load_dwordx4 v[216:219], v4, s[16:19], s52 offen sc1
v_accvgpr_read_b32 v29, a231
MAV 88,24,172
TR 42,6,17472
v_add_f32 v39, v39, v29
v_accvgpr_read_b32 v28, a232
MAV 88,8,164
TR 44,6,16992
TR 46,6,17504
MAV 92,12,164
TR 56,6,25408
v_add_f32 v40, v40, v28
v_accvgpr_read_b32 v29, a233
MAV 92,28,172
buffer_load_dwordx4 v[220:223], v4, s[16:19], s52 offen offset:1024 sc1
v_add_f32 v41, v41, v29
MAV 76,28,168
TR 58,6,25920
v_accvgpr_read_b32 v28, a234
MAV 76,12,160
TR 60,6,25440
TR 62,6,25952
s_waitcnt vmcnt(8) lgkmcnt(8)
MAV 64,32,176
TR 0,6,33792
v_add_f32 v42, v42, v28
MAV 64,48,184
TR 2,6,34304
v_accvgpr_read_b32 v29, a235
v_add_f32 v43, v43, v29
MAV 80,48,188
TR 4,6,33824
MAV 80,32,180
TR 6,6,34336
v_accvgpr_read_b32 v28, a236
v_add_f32 v44, v44, v28
MAV 84,36,180
TR 16,6,42240
MAV 84,52,188
TR 18,6,42752
v_accvgpr_read_b32 v29, a237
v_add_f32 v45, v45, v29
MAV 68,52,184
TR 20,6,42272
.Lpad21:
s_cbranch_execz .Lnopoll37r
MAV 68,36,176
TR 22,6,42784
v_accvgpr_read_b32 v28, a238
s_waitcnt lgkmcnt(8)
MAV 72,40,176
TR 8,6,33856
v_add_f32 v46, v46, v28
MAV 72,56,184
TR 10,6,34368
v_accvgpr_read_b32 v29, a239
MAV 88,56,188
TR 12,6,33888
v_add_f32 v47, v47, v29
MAV 88,40,180
TR 14,6,34400
v_accvgpr_read_b32 v28, a240
MAV 92,44,180
TR 24,6,42304
v_add_f32 v48, v48, v28
MAV 92,60,188
TR 26,6,42816
v_accvgpr_read_b32 v29, a241
MAV 76,60,184
TR 28,6,42336
v_add_f32 v49, v49, v29
MAV 76,44,176
TR 30,6,42848
v_accvgpr_read_b32 v28, a242
s_waitcnt vmcnt(4) lgkmcnt(8)
MAV 64,0,192
TR 32,6,50688
v_add_f32 v50, v50, v28
MAV 64,16,200
TR 34,6,51200
v_accvgpr_read_b32 v29, a243
v_add_f32 v51, v51, v29
MAV 80,16,204
TR 36,6,50720
MAV 80,0,196
TR 38,6,51232
v_accvgpr_read_b32 v28, a244
v_add_f32 v52, v52, v28
MAV 84,4,196
TR 48,6,59136
MAV 84,20,204
TR 50,6,59648
v_accvgpr_read_b32 v29, a245
v_add_f32 v53, v53, v29
MAV 68,20,200
TR 52,6,59168
MAV 68,4,192
TR 54,6,59680
v_accvgpr_read_b32 v28, a246
s_waitcnt lgkmcnt(8)
MAV 72,8,192
TR 40,6,50752
v_add_f32 v54, v54, v28
MAV 72,24,200
TR 42,6,51264
v_accvgpr_read_b32 v29, a247
MAV 88,24,204
TR 44,6,50784
v_add_f32 v55, v55, v29
MAV 88,8,196
TR 46,6,51296
v_accvgpr_read_b32 v28, a248
MAV 92,12,196
TR 56,6,59200
v_add_f32 v56, v56, v28
MAV 92,28,204
TR 58,6,59712
v_accvgpr_read_b32 v29, a249
MAV 76,28,200
TR 60,6,59232
v_add_f32 v57, v57, v29
MAV 76,12,192
TR 62,6,59744
v_accvgpr_read_b32 v28, a250
s_waitcnt vmcnt(0) lgkmcnt(8)
MAV 64,32,208
ds_read_b64_tr_b16 a[0:1], v7
v_add_f32 v58, v58, v28
MAV 64,48,216
TR 2,7,512
v_accvgpr_read_b32 v29, a251
MAV 80,48,220
TR 4,7,32
v_add_f32 v59, v59, v29
MAV 80,32,212
TR 6,7,544
MAV 84,36,212
TR 16,7,8448
v_accvgpr_read_b32 v28, a252
MAV 84,52,220
TR 18,7,8960
v_add_f32 v60, v60, v28
MAV 68,52,216
TR 20,7,8480
v_accvgpr_read_b32 v29, a253
MAV 68,36,208
TR 22,7,8992
s_waitcnt lgkmcnt(8)
MAV 72,40,208
TR 8,7,64
MAV 72,56,216
TR 10,7,576
v_add_f32 v61, v61, v29
MAV 88,56,220
TR 12,7,96
v_accvgpr_read_b32 v28, a254
MAV 88,40,212
TR 14,7,608
v_add_f32 v62, v62, v28
MAV 92,44,212
TR 24,7,8512
MAV 92,60,220
TR 26,7,9024
v_accvgpr_read_b32 v29, a255
MAV 76,60,216
TR 28,7,8544
v_add_f32 v63, v63, v29
MAV 76,44,208
TR 30,7,9056
s_waitcnt lgkmcnt(8)
MAV 32,0,96
TR 32,7,16896
v_cvt_pk_bf16_f32 v232, v64, v65
MAV 32,16,104
TR 34,7,17408
v_cvt_pk_bf16_f32 v233, v66, v67
v_cvt_pk_bf16_f32 v234, v68, v69
MAV 48,16,108
TR 36,7,16928
v_cvt_pk_bf16_f32 v235, v70, v71
MAV 48,0,100
TR 38,7,17440
buffer_store_dwordx4 v[232:235], v11, s[16:19], s69 offen sc1
s_add_u32 s69, s69, 131072
MAV 52,4,100
TR 48,7,25344
v_cvt_pk_bf16_f32 v236, v72, v73
MAV 52,20,108
TR 50,7,25856
v_cvt_pk_bf16_f32 v237, v74, v75
v_cvt_pk_bf16_f32 v238, v76, v77
MAV 36,20,104
TR 52,7,25376
v_cvt_pk_bf16_f32 v239, v78, v79
MAV 36,4,96
TR 54,7,25888
buffer_store_dwordx4 v[236:239], v11, s[16:19], s69 offen sc1
s_waitcnt lgkmcnt(8)
MAV 40,8,96
TR 40,7,16960
s_add_u32 s69, s69, -130048
MAV 40,24,104
TR 42,7,17472
v_cvt_pk_bf16_f32 v240, v80, v81
v_cvt_pk_bf16_f32 v241, v82, v83
MAV 56,24,108
TR 44,7,16992
v_cvt_pk_bf16_f32 v242, v84, v85
MAV 56,8,100
TR 46,7,17504
v_cvt_pk_bf16_f32 v243, v86, v87
buffer_store_dwordx4 v[240:243], v11, s[16:19], s69 offen sc1
MAV 60,12,100
TR 56,7,25408
s_add_u32 s69, s69, 131072
MAV 60,28,108
TR 58,7,25920
v_cvt_pk_bf16_f32 v244, v88, v89
v_cvt_pk_bf16_f32 v245, v90, v91
MAV 44,28,104
TR 60,7,25440
v_cvt_pk_bf16_f32 v246, v92, v93
MAV 44,12,96
TR 62,7,25952
v_cvt_pk_bf16_f32 v247, v94, v95
buffer_store_dwordx4 v[244:247], v11, s[16:19], s69 offen sc1
s_waitcnt lgkmcnt(8)
MAV 32,32,112
TR 0,7,33792
MAV 32,48,120
TR 2,7,34304
MAV 48,48,124
TR 4,7,33824
MAV 48,32,116
TR 6,7,34336
MAV 52,36,116
TR 16,7,42240
MAV 52,52,124
TR 18,7,42752
MAV 36,52,120
TR 20,7,42272
MAV 36,36,112
TR 22,7,42784
s_waitcnt lgkmcnt(8)
MAV 40,40,112
TR 8,7,33856
MAV 40,56,120
TR 10,7,34368
MAV 56,56,124
TR 12,7,33888
MAV 56,40,116
TR 14,7,34400
MAV 60,44,116
TR 24,7,42304
MAV 60,60,124
TR 26,7,42816
MAV 44,60,120
TR 28,7,42336
MAV 44,44,112
TR 30,7,42848
s_waitcnt lgkmcnt(8)
MAV 32,0,128
TR 32,7,50688
MAV 32,16,136
TR 34,7,51200
MAV 48,16,140
TR 36,7,50720
MAV 48,0,132
TR 38,7,51232
MAV 52,4,132
TR 48,7,59136
MAV 52,20,140
TR 50,7,59648
MAV 36,20,136
TR 52,7,59168
MAV 36,4,128
TR 54,7,59680
s_waitcnt lgkmcnt(8)
MAV 40,8,128
TR 40,7,50752
MAV 40,24,136
TR 42,7,51264
MAV 56,24,140
TR 44,7,50784
MAV 56,8,132
TR 46,7,51296
MAV 60,12,132
TR 56,7,59200
MAV 60,28,140
TR 58,7,59712
MAV 44,28,136
TR 60,7,59232
MAV 44,12,128
TR 62,7,59744
v_add_u32 v7, s57, v7
s_waitcnt lgkmcnt(8)
MAV 32,32,144
ds_read_b64_tr_b16 a[0:1], v7
MAV 32,48,152
s_waitcnt vmcnt(0)
buffer_atomic_add v13, v12, s[16:19], s71 offen
MAV 48,48,156
TR 2,7,512
MAV 48,32,148
TR 4,7,32
TR 6,7,544
MAV 52,36,148
MAV 52,52,156
TR 16,7,8448
TR 18,7,8960
MAV 36,52,152
TR 20,7,8480
MAV 36,36,144
s_waitcnt lgkmcnt(7)
MAV 40,40,144
TR 22,7,8992
MAV 40,56,152
TR 8,7,64
TR 10,7,576
MAV 56,56,156
MAV 56,40,148
TR 12,7,96
TR 14,7,608
MAV 60,44,148
TR 24,7,8512
MAV 60,60,156
TR 26,7,9024
MAV 44,60,152
TR 28,7,8544
MAV 44,44,144
TR 30,7,9056
s_waitcnt lgkmcnt(8)
s_barrier
MAV 32,0,160
TR 32,7,16896
TR 34,7,17408
MAV 32,16,168
buffer_atomic_add v15, v12, s[16:19], s70 offen sc0
MAV 48,16,172
TR 36,7,16928
TR 38,7,17440
MAV 48,0,164
TR 48,7,25344
MAV 52,4,164
TR 50,7,25856
s_add_u32 m0, s59, 117248
MAV 52,20,172
TR 52,7,25376
buffer_load_dwordx4 v18, s[20:23], s58 offen lds
MAV 36,20,168
TR 54,7,25888
MAV 36,4,160
TR 40,7,16960
s_waitcnt lgkmcnt(9)
MAV 40,8,160
TR 42,7,17472
MAV 40,24,168
TR 44,7,16992
buffer_load_dwordx4 v19, s[20:23], s58 offen offset:1024 lds
MAV 56,24,172
TR 46,7,17504
MAV 56,8,164
TR 56,7,25408
buffer_load_dwordx4 v20, s[20:23], s58 offen offset:2048 lds
MAV 60,12,164
s_add_u32 s58, s58, 196608
s_add_u32 m0, s59, 129664
MAV 60,28,172
TR 58,7,25920
buffer_load_dwordx4 v18, s[20:23], s58 offen lds
MAV 44,28,168
TR 60,7,25440
MAV 44,12,160
TR 62,7,25952
s_waitcnt lgkmcnt(8)
MAV 32,32,176
TR 0,7,33792
MAV 32,48,184
buffer_load_dwordx4 v19, s[20:23], s58 offen offset:1024 lds
MAV 48,48,188
TR 2,7,34304
MAV 48,32,180
TR 4,7,33824
TR 6,7,34336
MAV 52,36,180
TR 16,7,42240
MAV 52,52,188
buffer_load_dwordx4 v20, s[20:23], s58 offen offset:2048 lds
MAV 36,52,184
TR 18,7,42752
s_add_u32 s58, s58, 196608
MAV 36,36,176
TR 20,7,42272
TR 22,7,42784
s_waitcnt lgkmcnt(8)
MAV 40,40,176
TR 8,7,33856
s_add_u32 m0, s59, 67584
MAV 40,56,184
buffer_load_dwordx4 v18, s[20:23], s58 offen lds
MAV 56,56,188
TR 10,7,34368
MAV 56,40,180
TR 12,7,33888
TR 14,7,34400
MAV 60,44,180
TR 24,7,42304
MAV 60,60,188
buffer_load_dwordx4 v19, s[20:23], s58 offen offset:1024 lds
MAV 44,60,184
TR 26,7,42816
MAV 44,44,176
TR 28,7,42336
TR 30,7,42848
s_waitcnt vmcnt(8)
v_cmp_ne_u32 vcc, 0, v15
s_nop 0
s_cbranch_vccz .Lxs51
.Lxs51b:
s_waitcnt lgkmcnt(8)
MAV 32,0,192
TR 32,7,50688
TR 34,7,51200
MAV 32,16,200
TR 36,7,50720
buffer_load_dwordx4 v[232:235], v11, s[16:19], s68 offen sc1
MAV 48,16,204
TR 38,7,51232
s_add_u32 s68, s68, 131072
MAV 48,0,196
TR 48,7,59136
buffer_load_dwordx4 v[236:239], v11, s[16:19], s68 offen sc1
MAV 52,4,196
TR 50,7,59648
s_add_u32 s68, s68, -130048
MAV 52,20,204
TR 52,7,59168
buffer_load_dwordx4 v[240:243], v11, s[16:19], s68 offen sc1
MAV 36,20,200
TR 54,7,59680
s_add_u32 s68, s68, 131072
MAV 36,4,192
TR 40,7,50752
s_waitcnt lgkmcnt(9)
MAV 40,8,192
TR 42,7,51264
TR 44,7,50784
MAV 40,24,200
buffer_load_dwordx4 v[244:247], v11, s[16:19], s68 offen sc1
MAV 56,24,204
TR 46,7,51296
TR 56,7,59200
MAV 56,8,196
TR 58,7,59712
buffer_load_dwordx4 v20, s[20:23], s58 offen offset:2048 lds
MAV 60,12,196
s_add_u32 s58, s58, 196608
s_add_u32 m0, s59, 80000
MAV 60,28,204
TR 60,7,59232
buffer_load_dwordx4 v18, s[20:23], s58 offen lds
MAV 44,28,200
TR 62,7,59744
MAV 44,12,192
buffer_load_dwordx4 v19, s[20:23], s58 offen offset:1024 lds
buffer_load_dwordx4 v20, s[20:23], s58 offen offset:2048 lds
s_add_u32 s58, s58, 196608
s_waitcnt lgkmcnt(8)
MAV 32,32,208
s_add_u32 m0, s59, 92416
MAV 32,48,216
buffer_load_dwordx4 v18, s[20:23], s58 offen lds
MAV 48,48,220
MAV 48,32,212
MAV 52,36,212
MAV 52,52,220
MAV 36,52,216
MAV 36,36,208
s_waitcnt lgkmcnt(0)
MAV 40,40,208
MAV 40,56,216
buffer_load_dwordx4 v19, s[20:23], s58 offen offset:1024 lds
MAV 56,56,220
MAV 56,40,212
buffer_load_dwordx4 v20, s[20:23], s58 offen offset:2048 lds
MAV 60,44,212
s_add_u32 s58, s58, 196608
MAV 60,60,220
MAV 44,60,216
MAV 44,44,208
s_waitcnt vmcnt(10)
v_mfma_f32_16x16x32_bf16 v[32:35], v[226:229], v[232:235], v[32:35]
s_lshl_b32 s64, s6, 14
s_lshl_b32 s65, s49, 13
s_add_u32 s64, s64, s65
v_mfma_f32_16x16x32_bf16 v[36:39], v[224:227], v[232:235], v[36:39]
s_lshl_b32 s65, s7, 9
s_add_u32 s64, s64, s65
s_lshl_b32 s65, s48, 8
s_waitcnt vmcnt(9)
v_mfma_f32_16x16x32_bf16 v[40:43], v[226:229], v[236:239], v[40:43]
s_add_u32 s64, s64, s65
s_add_u32 s64, s64, 62914560
v_and_b32 v152, 31, v1
v_mfma_f32_16x16x32_bf16 v[44:47], v[224:227], v[236:239], v[44:47]
s_lshl_b32 s62, s7, 18
v_lshlrev_b32 v152, 3, v152
v_lshrrev_b32 v153, 5, v1
s_waitcnt vmcnt(8)
v_mfma_f32_16x16x32_bf16 v[48:51], v[226:229], v[240:243], v[48:51]
s_add_u32 s62, s62, 33554432
v_lshl_add_u32 v152, v153, 28, v152
s_add_u32 s63, s62, 131072
v_mfma_f32_16x16x32_bf16 v[52:55], v[224:227], v[240:243], v[52:55]
v_cvt_pk_bf16_f32 v128, v32, v33
v_cvt_pk_bf16_f32 v129, v34, v35
s_waitcnt vmcnt(7)
v_mfma_f32_16x16x32_bf16 v[56:59], v[226:229], v[244:247], v[56:59]
v_cvt_pk_bf16_f32 v130, v36, v37
v_cvt_pk_bf16_f32 v131, v38, v39
v_mfma_f32_16x16x32_bf16 v[60:63], v[224:227], v[244:247], v[60:63]
buffer_store_dwordx4 v[128:131], v4, s[16:19], s62 offen sc1
v_cvt_pk_bf16_f32 v132, v40, v41
v_cvt_pk_bf16_f32 v133, v42, v43
v_cvt_pk_bf16_f32 v134, v44, v45
v_cvt_pk_bf16_f32 v135, v46, v47
v_cvt_pk_bf16_f32 v136, v48, v49
v_cvt_pk_bf16_f32 v137, v50, v51
v_cvt_pk_bf16_f32 v138, v52, v53
v_cvt_pk_bf16_f32 v139, v54, v55
v_cvt_pk_bf16_f32 v140, v56, v57
v_cvt_pk_bf16_f32 v141, v58, v59
v_cvt_pk_bf16_f32 v142, v60, v61
v_cvt_pk_bf16_f32 v143, v62, v63
v_pk_mul_f32 v[146:147], v[32:33], v[32:33]
buffer_store_dwordx4 v[132:135], v4, s[16:19], s63 offen sc1
v_pk_mul_f32 v[150:151], v[48:49], v[48:49]
v_pk_fma_f32 v[146:147], v[34:35], v[34:35], v[146:147]
v_pk_add_f32 v[144:145], v[32:33], v[34:35]
v_pk_fma_f32 v[150:151], v[50:51], v[50:51], v[150:151]
v_pk_add_f32 v[148:149], v[48:49], v[50:51]
v_pk_fma_f32 v[146:147], v[36:37], v[36:37], v[146:147]
v_pk_add_f32 v[144:145], v[144:145], v[36:37]
v_pk_fma_f32 v[150:151], v[52:53], v[52:53], v[150:151]
v_pk_add_f32 v[148:149], v[148:149], v[52:53]
v_pk_fma_f32 v[146:147], v[38:39], v[38:39], v[146:147]
v_pk_add_f32 v[144:145], v[144:145], v[38:39]
v_pk_fma_f32 v[150:151], v[54:55], v[54:55], v[150:151]
v_pk_add_f32 v[148:149], v[148:149], v[54:55]
buffer_store_dwordx4 v[136:139], v4, s[16:19], s62 offen offset:1024 sc1
v_pk_fma_f32 v[146:147], v[40:41], v[40:41], v[146:147]
v_pk_add_f32 v[144:145], v[144:145], v[40:41]
v_pk_fma_f32 v[150:151], v[56:57], v[56:57], v[150:151]
v_pk_add_f32 v[148:149], v[148:149], v[56:57]
v_pk_fma_f32 v[146:147], v[42:43], v[42:43], v[146:147]
v_pk_add_f32 v[144:145], v[144:145], v[42:43]
v_pk_fma_f32 v[150:151], v[58:59], v[58:59], v[150:151]
v_pk_add_f32 v[148:149], v[148:149], v[58:59]
v_pk_fma_f32 v[146:147], v[44:45], v[44:45], v[146:147]
v_pk_add_f32 v[144:145], v[144:145], v[44:45]
v_pk_fma_f32 v[150:151], v[60:61], v[60:61], v[150:151]
v_pk_add_f32 v[148:149], v[148:149], v[60:61]
v_pk_fma_f32 v[146:147], v[46:47], v[46:47], v[146:147]
buffer_store_dwordx4 v[140:143], v4, s[16:19], s63 offen offset:1024 sc1
v_pk_add_f32 v[144:145], v[144:145], v[46:47]
v_pk_fma_f32 v[150:151], v[62:63], v[62:63], v[150:151]
v_pk_add_f32 v[148:149], v[148:149], v[62:63]
v_add_f32 v144, v144, v145
v_add_f32 v146, v146, v147
v_add_f32 v148, v148, v149
v_add_f32 v150, v150, v151
s_nop 0
v_permlane16_swap_b32 v144, v148
v_permlane16_swap_b32 v146, v150
v_add_f32 v144, v144, v148
v_add_f32 v146, v146, v150
s_nop 1
v_permlane32_swap_b32 v144, v146
v_add_f32 v144, v144, v146
s_nop 1
v_permlane32_swap_b32 v144, v145
buffer_store_dwordx2 v[144:145], v152, s[16:19], s64 offen sc1
s_nop 1
v_accvgpr_write_b32 a224, v32
v_accvgpr_write_b32 a225, v33
v_accvgpr_write_b32 a226, v34
v_accvgpr_write_b32 a227, v35
v_accvgpr_write_b32 a228, v36
v_accvgpr_write_b32 a229, v37
v_accvgpr_write_b32 a230, v38
v_accvgpr_write_b32 a231, v39
v_accvgpr_write_b32 a232, v40
v_accvgpr_write_b32 a233, v41
v_accvgpr_write_b32 a234, v42
v_accvgpr_write_b32 a235, v43
v_accvgpr_write_b32 a236, v44
.Lpad22:
s_cbranch_execz .Lnopoll37r
v_accvgpr_write_b32 a237, v45
v_accvgpr_write_b32 a238, v46
v_accvgpr_write_b32 a239, v47
v_accvgpr_write_b32 a240, v48
v_accvgpr_write_b32 a241, v49
v_accvgpr_write_b32 a242, v50
v_accvgpr_write_b32 a243, v51
v_accvgpr_write_b32 a244, v52
v_accvgpr_write_b32 a245, v53
v_accvgpr_write_b32 a246, v54
v_accvgpr_write_b32 a247, v55
v_accvgpr_write_b32 a248, v56
v_accvgpr_write_b32 a249, v57
v_accvgpr_write_b32 a250, v58
v_accvgpr_write_b32 a251, v59
v_accvgpr_write_b32 a252, v60
v_accvgpr_write_b32 a253, v61
v_accvgpr_write_b32 a254, v62
v_accvgpr_write_b32 a255, v63
s_lshl_b32 s62, s3, 11
s_add_u32 s62, s62, s85
v_lshl_add_u32 v21, v1, 4, s62
v_lshrrev_b32 v2, 3, v1
v_cmp_eq_u32 vcc, 3, v2
v_add_u32 v2, 67108480, v21
s_nop 0
v_cndmask_b32 v21, v21, v2, vcc
s_sub_u32 s62, s86, 2048
v_lshl_add_u32 v22, v0, 2, s62
v_lshrrev_b32 v2, 5, v0
v_cmp_eq_u32 vcc, 3, v2
v_add_u32 v2, 67108480, v22
s_nop 0
v_cndmask_b32 v22, v22, v2, vcc
s_mul_i32 s62, s48, 4608
v_lshl_add_u32 v23, v1, 4, s62
v_lshrrev_b32 v24, 4, v1
v_mul_u32_u24 v24, 2304, v24
v_and_b32 v2, 15, v1
v_lshl_add_u32 v24, v2, 4, v24
s_mov_b32 s52, 33554432
s_mov_b32 s54, s58
s_mov_b32 s56, s59
s_mul_i32 s55, s3, 2304
v_bfe_u32 v25, v1, 3, 2
v_mul_u32_u24 v25, 3104, v25
v_bfe_u32 v2, v1, 2, 1
v_lshl_add_u32 v25, v2, 7, v25
v_bfe_u32 v2, v1, 5, 1
v_lshl_add_u32 v25, v2, 8, v25
v_and_b32 v2, 3, v1
v_lshl_add_u32 v25, v2, 3, v25
s_lshl_b32 s62, s49, 6
s_add_u32 s62, s62, 67584
v_add_u32 v25, s62, v25
s_lshl_b32 s62, s8, 1
s_add_u32 s62, s62, s3
s_lshr_b32 s63, s50, 2
s_cmp_lt_u32 s3, 2
s_cselect_b32 s62, s62, s63
s_lshl_b32 s62, s62, 13
s_cmp_eq_u32 s3, 3
s_cselect_b32 s62, 268435456, s62
v_lshl_add_u32 v26, v1, 4, s62
s_lshr_b32 s63, s20, 7
s_sub_u32 s63, 3, s63
s_and_b32 s63, s63, 7
s_and_b32 s62, s9, 8
s_add_u32 s63, s63, s62
s_lshl_b32 s62, s5, 2
s_add_u32 s62, s62, s3
s_mul_i32 s62, s62, 12288
s_lshl_b32 s64, s63, 7
s_add_u32 s62, s62, s64
s_xor_b32 s63, s63, s9
s_cmp_lt_u32 s63, 4
s_cselect_b32 s62, s62, 16777216
v_lshrrev_b32 v14, 3, v1
v_min_u32 v14, 5, v14
v_lshl_add_u32 v14, v14, 11, s62
s_mov_b32 s44, 983040
buffer_load_dword v27, v14, s[20:23], s44 offen
s_mov_b32 s44, 2555904
s_mul_i32 s59, s3, 2080
s_and_b32 s87, s6, 3
s_lshl_b32 s87, s87, 17
v_bfe_u32 v5, v1, 3, 1
v_lshrrev_b32 v2, 4, v1
v_lshl_add_u32 v5, v2, 3, v5
s_lshl_b32 s62, s3, 1
v_add_u32 v5, s62, v5
v_mul_u32_u24 v5, 2048, v5
v_and_b32 v2, 7, v1
v_lshl_add_u32 v5, v2, 4, v5
s_lshl_b32 s62, s7, 7
v_add_u32 v5, s62, v5
v_add_u32 v6, 64512, v5
s_lshl_b32 s62, s6, 10
s_add_u32 s62, s62, 30474240
s_lshl_b32 s64, s8, 10
s_add_u32 s64, s64, 30474240
s_lshr_b32 s67, s9, 1
s_and_b32 s67, s67, 3
s_lshl_b32 s67, s67, 7
s_add_u32 s64, s64, s67
s_lshr_b32 s65, s50, 3
s_lshl_b32 s65, s65, 10
s_add_u32 s65, s65, 30474240
s_lshr_b32 s67, s9, 1
s_and_b32 s67, s67, 3
s_lshl_b32 s67, s67, 7
s_add_u32 s65, s65, s67
v_lshl_add_u32 v252, v1, 7, s62
v_mov_b32 v253, s64
v_mov_b32 v255, 1
v_writelane_b32 v253, s65, 1
s_waitcnt vmcnt(1) lgkmcnt(0)
s_cmp_lg_u32 s3, 1
s_barrier
s_cbranch_scc1 .Lfirst54
s_mov_b64 exec, 15
buffer_atomic_add v255, v252, s[16:19], 0 offen
s_mov_b64 exec, 3
v_mov_b32 v254, 0
buffer_atomic_add v254, v253, s[16:19], 0 offen sc0
s_mov_b64 exec, -1
.Lfirst54:
TR 80,25,49664
TR 82,25,50176
TR 84,25,62080
TR 86,25,62592
TR 88,25,50688
TR 90,25,51200
TR 92,25,63104
TR 94,25,63616
TR 96,25,51712
TR 98,25,52224
TR 100,25,64128
TR 102,25,64640
v_lshrrev_b32 v2, 4, v1
v_lshlrev_b32 v2, 2, v2
v_and_b32 v13, 15, v1
v_sub_u32 v2, v13, v2
v_mov_b32 v13, 0xff61b1e6
v_subrev_u32 v54, 0, v2
v_cmp_gt_u32 vcc, 8, v54
s_nop 1
v_cndmask_b32 v50, v13, 0, vcc
v_cmp_gt_i32 vcc, -8, v54
s_nop 1
v_cndmask_b32 v46, v13, 0, vcc
v_subrev_u32 v54, 1, v2
v_cmp_gt_u32 vcc, 8, v54
s_nop 1
v_cndmask_b32 v51, v13, 0, vcc
v_cmp_gt_i32 vcc, -8, v54
s_nop 1
v_cndmask_b32 v47, v13, 0, vcc
v_subrev_u32 v54, 2, v2
v_cmp_gt_u32 vcc, 8, v54
s_nop 1
v_cndmask_b32 v52, v13, 0, vcc
v_cmp_gt_i32 vcc, -8, v54
s_nop 1
v_cndmask_b32 v48, v13, 0, vcc
v_subrev_u32 v54, 3, v2
v_cmp_gt_u32 vcc, 8, v54
s_nop 1
v_cndmask_b32 v53, v13, 0, vcc
v_cmp_gt_i32 vcc, -8, v54
s_nop 1
v_cndmask_b32 v49, v13, 0, vcc
s_cmp_lt_u32 s8, 2
s_cselect_b64 vcc, -1, 0
v_cndmask_b32 v54, v46, v13, vcc
v_cndmask_b32 v55, v47, v13, vcc
v_cndmask_b32 v56, v48, v13, vcc
v_cndmask_b32 v57, v49, v13, vcc
v_mov_b64 v[60:61], 0
v_mov_b64 v[62:63], 0
v_mov_b64 v[64:65], 0
v_mov_b64 v[66:67], 0
v_mov_b64 v[68:69], 0
v_mov_b64 v[70:71], 0
v_mov_b64 v[72:73], 0
v_mov_b64 v[74:75], 0
v_mov_b64 v[76:77], 0
v_mov_b64 v[78:79], 0
v_mov_b64 v[80:81], 0
v_mov_b64 v[82:83], 0
v_mov_b64 v[84:85], 0
v_mov_b64 v[86:87], 0
v_mov_b64 v[88:89], 0
v_mov_b64 v[90:91], 0
v_mov_b64 v[92:93], 0
v_mov_b64 v[94:95], 0
v_mov_b64 v[96:97], 0
v_mov_b64 v[98:99], 0
v_mov_b64 v[100:101], 0
v_mov_b64 v[102:103], 0
v_mov_b64 v[104:105], 0
v_mov_b64 v[106:107], 0
v_mov_b64 v[108:109], 0
v_mov_b64 v[110:111], 0
v_mov_b64 v[112:113], 0
v_mov_b64 v[114:115], 0
v_mov_b64 v[116:117], 0
v_mov_b64 v[118:119], 0
v_mov_b64 v[120:121], 0
v_mov_b64 v[122:123], 0
v_mov_b64 v[124:125], 0
v_mov_b64 v[126:127], 0
v_mov_b64 v[128:129], 0
v_mov_b64 v[130:131], 0
v_mov_b64 v[132:133], 0
v_mov_b64 v[134:135], 0
v_mov_b64 v[136:137], 0
v_mov_b64 v[138:139], 0
v_mov_b64 v[140:141], 0
v_mov_b64 v[142:143], 0
v_mov_b64 v[144:145], 0
v_mov_b64 v[146:147], 0
v_mov_b64 v[148:149], 0
v_mov_b64 v[150:151], 0
v_mov_b64 v[152:153], 0
v_mov_b64 v[154:155], 0
v_mov_b64 v[156:157], 0
v_mov_b64 v[158:159], 0
v_mov_b64 v[160:161], 0
v_mov_b64 v[162:163], 0
v_mov_b64 v[164:165], 0
v_mov_b64 v[166:167], 0
v_mov_b64 v[168:169], 0
v_mov_b64 v[170:171], 0
v_mov_b64 v[172:173], 0
v_mov_b64 v[174:175], 0
s_mov_b32 s75, 62914560
v_and_b32 v10, 15, v1
v_lshlrev_b32 v12, 2, v10
v_lshlrev_b32 v10, 4, v10
v_add_u32 v10, 152576, v10
v_lshrrev_b32 v11, 4, v1
v_lshlrev_b32 v11, 4, v11
s_lshl_b32 s62, s49, 7
s_add_u32 s62, s62, 158720
v_add_u32 v12, s62, v12
v_add_u32 v13, s62, v11
v_add_u32 v11, 156672, v11
s_lshl_b32 s62, s3, 11
s_add_u32 s62, s62, 143360
v_lshl_add_u32 v8, v1, 4, s62
v_xor_b32 v9, 2048, v8
v_mov_b32 v248, 0x3f803f80
v_mov_b32 v249, 0x3f803f80
v_mov_b32 v250, 0x3f803f80
v_mov_b32 v251, 0x3f803f80
v_and_b32 v7, 31, v1
v_lshrrev_b32 v2, 5, v1
v_lshl_add_u32 v7, v7, 1, v2
v_and_b32 v2, 0xc0, v0
v_add_u32 v7, v7, v2
v_lshlrev_b32 v17, 2, v7
v_add_u32 v17, 156672, v17
v_lshlrev_b32 v7, 4, v7
v_add_u32 v7, 152576, v7
s_lshl_b32 s74, s9, 1
s_add_u32 s74, s74, s49
s_lshl_b32 s74, s74, 17
s_add_u32 s74, s74, s85
s_lshl_b32 s63, s48, 12
s_add_u32 s74, s74, s63
s_add_u32 s74, s74, 37748736
s_mov_b32 s62, 0
v_lshl_add_u32 v4, v1, 4, s62
v_lshrrev_b32 v2, 3, v1
v_cmp_eq_u32 vcc, 3, v2
v_add_u32 v2, 67108480, v4
s_nop 0
v_cndmask_b32 v4, v4, v2, vcc
ds_read_b128 v[28:31], v13
ds_read_b128 v[32:35], v13 offset:64
ds_read_b128 v[36:39], v13 offset:256
ds_read_b128 v[40:43], v13 offset:320
ds_read_b32 v44, v12 offset:512
ds_read_b32 v45, v12 offset:576
s_waitcnt lgkmcnt(0)
s_cmp_lg_u32 s3, 1
s_cbranch_scc1 .Lnopoll53
s_mov_b64 exec, 3
s_mov_b32 s15, 0
.Lpoll52:
v_mov_b32 v255, 0
buffer_atomic_add v255, v253, s[16:19], 0 offen sc0
s_waitcnt vmcnt(1)
v_cmp_gt_u32 vcc, 16, v254
s_add_u32 s15, s15, 1
s_cbranch_vccz .Lnopoll53r
v_mov_b32 v254, 0
buffer_atomic_add v254, v253, s[16:19], 0 offen sc0
s_waitcnt vmcnt(1)
v_cmp_gt_u32 vcc, 16, v255
s_add_u32 s15, s15, 1
s_cbranch_vccz .Lnopoll53r
s_cmp_le_u32 s15, 100000
s_cbranch_scc1 .Lpoll52
s_branch .Lnopoll53r
.Lnopoll53:
s_mov_b64 exec, 0
s_cmp_eq_u32 s3, 2
s_cbranch_scc1 .Lpad23
s_cmp_eq_u32 s3, 3
s_cbranch_scc1 .Lpad24
s_branch .Lpad25
.Lnopoll53r:
s_mov_b64 exec, -1
s_barrier
s_cmp_eq_u32 s48, 1
s_cbranch_scc1 .Lqkv55
s_add_u32 m0, s55, 36864
s_nop 0
buffer_load_dwordx4 v21, s[16:19], s52 offen sc1 lds
buffer_load_dwordx4 v21, s[16:19], s52 offen offset:1024 sc1 lds
buffer_load_dword v22, s[16:19], s52 offen offset:2048 sc1 lds
s_add_u32 s52, s52, 131072
s_add_u32 m0, s55, 46080
s_nop 0
buffer_load_dwordx4 v21, s[16:19], s52 offen sc1 lds
buffer_load_dwordx4 v21, s[16:19], s52 offen offset:1024 sc1 lds
buffer_load_dword v22, s[16:19], s52 offen offset:2048 sc1 lds
s_add_u32 s52, s52, 131072
s_add_u32 m0, s55, 0
s_nop 0
buffer_load_dwordx4 v21, s[16:19], s52 offen sc1 lds
buffer_load_dwordx4 v21, s[16:19], s52 offen offset:1024 sc1 lds
buffer_load_dword v22, s[16:19], s52 offen offset:2048 sc1 lds
s_add_u32 s52, s52, 131072
s_add_u32 m0, s55, 9216
s_nop 0
buffer_load_dwordx4 v21, s[16:19], s52 offen sc1 lds
buffer_load_dwordx4 v21, s[16:19], s52 offen offset:1024 sc1 lds
buffer_load_dword v22, s[16:19], s52 offen offset:2048 sc1 lds
s_add_u32 s52, s52, 131072
s_add_u32 m0, s55, 18432
s_nop 0
buffer_load_dwordx4 v21, s[16:19], s52 offen sc1 lds
buffer_load_dwordx4 v21, s[16:19], s52 offen offset:1024 sc1 lds
buffer_load_dword v22, s[16:19], s52 offen offset:2048 sc1 lds
s_add_u32 s52, s52, 131072
s_add_u32 m0, s55, 27648
s_nop 0
buffer_load_dwordx4 v21, s[16:19], s52 offen sc1 lds
buffer_load_dwordx4 v21, s[16:19], s52 offen offset:1024 sc1 lds
buffer_load_dword v22, s[16:19], s52 offen offset:2048 sc1 lds
s_add_u32 s52, s52, 131072
s_waitcnt vmcnt(12)
s_barrier
RD 0,23,36864
RD 4,23,37888
RD 8,23,39168
RD 12,23,40192
RD 16,24,38912
RD 20,23,46080
RD 24,23,47104
RD 28,23,48384
RD 32,23,49408
RD 36,24,48128
s_waitcnt lgkmcnt(0)
s_mov_b32 s15, -2
.p2align 6
.Lk57:
s_waitcnt vmcnt(9) lgkmcnt(8)
s_barrier
MAA 60,80,0
TR 104,25,49696
s_add_u32 m0, s56, 104832
MAA 60,84,20
buffer_load_dwordx4 v18, s[20:23], s54 offen lds
MAA 64,84,24
TR 106,25,50208
v_add_f32 v164, v164, v168
MAA 64,80,4
TR 108,25,62112
MAA 68,80,8
TR 110,25,62624
MAA 68,84,28
buffer_load_dwordx4 v19, s[20:23], s54 offen offset:1024 lds
MAA 72,84,32
TR 112,25,50720
v_add_f32 v165, v165, v169
MAA 72,80,12
TR 114,25,51232
s_waitcnt lgkmcnt(6)
MAA 156,88,16
TR 116,25,63136
MAA 156,92,36
buffer_load_dwordx4 v20, s[20:23], s54 offen offset:2048 lds
MAA 104,92,32
s_add_u32 s54, s54, 196608
s_add_u32 m0, s55, 36864
MAA 104,88,12
buffer_load_dwordx4 v21, s[16:19], s52 offen sc1 lds
MAA 100,88,8
TR 118,25,63648
MAA 100,92,28
TR 120,25,51744
v_add_f32 v166, v166, v170
MAA 96,92,24
TR 122,25,52256
MAA 96,88,4
buffer_load_dwordx4 v21, s[16:19], s52 offen offset:1024 sc1 lds
MAA 92,88,0
TR 124,25,64160
MAA 92,92,20
TR 126,25,64672
v_add_f32 v167, v167, v171
MAA 124,20,100
ds_read_b128 a[40:43], v23
MAA 124,0,96
buffer_load_dword v22, s[16:19], s52 offen offset:2048 sc1 lds
MAA 128,4,96
RD 44,23,1024
s_add_u32 s52, s52, 131072
MAA 128,24,100
buffer_load_dword v27, v14, s[20:23], s44 offen
MAA 132,28,100
RD 48,23,2304
s_add_u32 s44, s44, 1572864
MAA 132,8,96
RD 52,23,3328
MAA 136,12,96
RD 56,24,2048
MAA 136,32,100
s_waitcnt vmcnt(13) lgkmcnt(5)
s_barrier
MAA 76,104,0
RD 60,23,9216
s_add_u32 m0, s56, 117248
MAA 76,108,20
buffer_load_dwordx4 v18, s[20:23], s54 offen lds
MAA 80,108,24
RD 64,23,10240
MAA 80,104,4
RD 68,23,11520
MAA 84,104,8
RD 72,23,12544
MAA 84,108,28
buffer_load_dwordx4 v19, s[20:23], s54 offen offset:1024 lds
MAA 88,108,32
RD 76,24,11264
MAA 88,104,12
buffer_load_dwordx4 v20, s[20:23], s54 offen offset:2048 lds
MAA 160,112,16
ds_read_b64_tr_b16 a[80:81], v25
s_add_u32 s54, s54, 196608
MAA 160,116,36
TR 82,25,512
MAA 120,116,32
TR 84,25,12416
s_add_u32 m0, s55, 46080
MAA 120,112,12
buffer_load_dwordx4 v21, s[16:19], s52 offen sc1 lds
MAA 116,112,8
TR 86,25,12928
MAA 116,116,28
TR 88,25,1024
MAA 112,116,24
TR 90,25,1536
MAA 112,112,4
buffer_load_dwordx4 v21, s[16:19], s52 offen offset:1024 sc1 lds
MAA 108,112,0
TR 92,25,13440
MAA 108,116,20
TR 94,25,13952
MAA 140,20,124
TR 96,25,2048
MAA 140,0,120
buffer_load_dword v22, s[16:19], s52 offen offset:2048 sc1 lds
MAA 144,4,120
TR 98,25,2560
s_add_u32 s52, s52, 131072
MAA 144,24,124
buffer_load_dwordx4 v[168:171], v26, s[16:19], s75 offen sc1
MAA 148,28,124
TR 100,25,14464
MAA 148,8,120
TR 102,25,14976
MAA 152,12,120
MAA 152,32,124
s_waitcnt vmcnt(17) lgkmcnt(8)
s_barrier
MAA 60,80,40
TR 104,25,32
s_add_u32 m0, s56, 129664
MAA 60,84,60
buffer_load_dwordx4 v18, s[20:23], s54 offen lds
MAA 64,84,64
TR 106,25,544
v_add_f32 v164, v164, v172
MAA 64,80,44
TR 108,25,12448
MAA 68,80,48
TR 110,25,12960
MAA 68,84,68
buffer_load_dwordx4 v19, s[20:23], s54 offen offset:1024 lds
MAA 72,84,72
TR 112,25,1056
MAA 72,80,52
TR 114,25,1568
s_waitcnt lgkmcnt(6)
MAA 156,88,56
TR 116,25,13472
v_add_f32 v165, v165, v173
MAA 156,92,76
buffer_load_dwordx4 v20, s[20:23], s54 offen offset:2048 lds
MAA 104,92,72
TR 118,25,13984
s_add_u32 s54, s54, 196608
MAA 104,88,52
TR 120,25,2080
MAA 100,88,48
s_add_u32 m0, s55, 0
MAA 100,92,68
buffer_load_dwordx4 v21, s[16:19], s52 offen sc1 lds
MAA 96,92,64
TR 122,25,2592
v_add_f32 v166, v166, v174
MAA 96,88,44
TR 124,25,14496
MAA 92,88,40
TR 126,25,15008
MAA 92,92,60
buffer_load_dwordx4 v21, s[16:19], s52 offen offset:1024 sc1 lds
MAA 124,60,100
RD 0,23,18432
MAA 124,40,96
RD 4,23,19456
v_add_f32 v167, v167, v175
MAA 128,44,96
RD 8,23,20736
MAA 128,64,100
buffer_load_dword v22, s[16:19], s52 offen offset:2048 sc1 lds
MAA 132,68,100
RD 12,23,21760
s_add_u32 s52, s52, 131072
MAA 132,48,96
RD 16,24,20480
MAA 136,52,96
MAA 136,72,100
s_waitcnt vmcnt(17) lgkmcnt(5)
s_barrier
MAA 76,104,40
RD 20,23,27648
s_add_u32 m0, s56, 67584
MAA 76,108,60
buffer_load_dwordx4 v18, s[20:23], s54 offen lds
MAA 80,108,64
RD 24,23,28672
MAA 80,104,44
RD 28,23,29952
MAA 84,104,48
RD 32,23,30976
MAA 84,108,68
buffer_load_dwordx4 v19, s[20:23], s54 offen offset:1024 lds
MAA 88,108,72
RD 36,24,29696
MAA 88,104,52
buffer_load_dwordx4 v20, s[20:23], s54 offen offset:2048 lds
MAA 160,112,56
TR 80,25,24832
s_add_u32 s54, s54, 196608
MAA 160,116,76
TR 82,25,25344
MAA 120,116,72
TR 84,25,37248
s_add_u32 m0, s55, 9216
MAA 120,112,52
buffer_load_dwordx4 v21, s[16:19], s52 offen sc1 lds
MAA 116,112,48
TR 86,25,37760
MAA 116,116,68
TR 88,25,25856
MAA 112,116,64
TR 90,25,26368
MAA 112,112,44
buffer_load_dwordx4 v21, s[16:19], s52 offen offset:1024 sc1 lds
MAA 108,112,40
TR 92,25,38272
MAA 108,116,60
TR 94,25,38784
MAA 140,60,124
TR 96,25,26880
MAA 140,40,120
buffer_load_dword v22, s[16:19], s52 offen offset:2048 sc1 lds
MAA 144,44,120
TR 98,25,27392
s_add_u32 s52, s52, 131072
MAA 144,64,124
buffer_load_dwordx4 v[172:175], v26, s[16:19], s75 offen offset:1024 sc1
MAA 148,68,124
TR 100,25,39296
s_add_u32 s75, s75, 2048
MAA 148,48,120
TR 102,25,39808
MAA 152,52,120
MAA 152,72,124
s_waitcnt vmcnt(21) lgkmcnt(8)
s_barrier
MAA 60,80,0
TR 104,25,24864
s_add_u32 m0, s56, 80000
MAA 60,84,20
buffer_load_dwordx4 v18, s[20:23], s54 offen lds
MAA 64,84,24
TR 106,25,25376
MAA 64,80,4
TR 108,25,37280
MAA 68,80,8
TR 110,25,37792
MAA 68,84,28
buffer_load_dwordx4 v19, s[20:23], s54 offen offset:1024 lds
MAA 72,84,32
TR 112,25,25888
MAA 72,80,12
TR 114,25,26400
s_waitcnt lgkmcnt(6)
MAA 156,88,16
TR 116,25,38304
MAA 156,92,36
buffer_load_dwordx4 v20, s[20:23], s54 offen offset:2048 lds
MAA 104,92,32
TR 118,25,38816
s_add_u32 s54, s54, 196608
MAA 104,88,12
TR 120,25,26912
MAA 100,88,8
s_add_u32 m0, s55, 18432
MAA 100,92,28
.Lpad23:
s_cbranch_execz .Lpad26
buffer_load_dwordx4 v21, s[16:19], s52 offen sc1 lds
MAA 96,92,24
TR 122,25,27424
MAA 96,88,4
TR 124,25,39328
MAA 92,88,0
TR 126,25,39840
MAA 92,92,20
buffer_load_dwordx4 v21, s[16:19], s52 offen offset:1024 sc1 lds
MAA 124,20,100
RD 40,23,36864
MAA 124,0,96
RD 44,23,37888
MAA 128,4,96
RD 48,23,39168
MAA 128,24,100
buffer_load_dword v22, s[16:19], s52 offen offset:2048 sc1 lds
MAA 132,28,100
RD 52,23,40192
s_add_u32 s52, s52, 131072
MAA 132,8,96
RD 56,24,38912
MAA 136,12,96
MAA 136,32,100
s_waitcnt vmcnt(16) lgkmcnt(5)
s_barrier
MAA 76,104,0
RD 60,23,46080
s_add_u32 m0, s56, 92416
MAA 76,108,20
buffer_load_dwordx4 v18, s[20:23], s54 offen lds
MAA 80,108,24
RD 64,23,47104
MAA 80,104,4
RD 68,23,48384
MAA 84,104,8
RD 72,23,49408
MAA 84,108,28
buffer_load_dwordx4 v19, s[20:23], s54 offen offset:1024 lds
MAA 88,108,32
RD 76,24,48128
MAA 88,104,12
TR 80,25,49664
MAA 160,112,16
TR 82,25,50176
MAA 160,116,36
buffer_load_dwordx4 v20, s[20:23], s54 offen offset:2048 lds
MAA 120,116,32
TR 84,25,62080
s_add_u32 s54, s54, 196608
MAA 120,112,12
TR 86,25,62592
MAA 116,112,8
s_add_u32 m0, s55, 27648
MAA 116,116,28
buffer_load_dwordx4 v21, s[16:19], s52 offen sc1 lds
MAA 112,116,24
TR 88,25,50688
MAA 112,112,4
TR 90,25,51200
MAA 108,112,0
TR 92,25,63104
MAA 108,116,20
buffer_load_dwordx4 v21, s[16:19], s52 offen offset:1024 sc1 lds
MAA 140,20,124
TR 94,25,63616
MAA 140,0,120
TR 96,25,51712
MAA 144,4,120
TR 98,25,52224
MAA 144,24,124
buffer_load_dword v22, s[16:19], s52 offen offset:2048 sc1 lds
MAA 148,28,124
TR 100,25,64128
s_add_u32 s52, s52, 131072
MAA 148,8,120
TR 102,25,64640
MAA 152,12,120
MAA 152,32,124
s_waitcnt vmcnt(19) lgkmcnt(8)
s_barrier
MAA 60,80,40
TR 104,25,49696
s_add_u32 m0, s56, 104832
MAA 60,84,60
buffer_load_dwordx4 v18, s[20:23], s54 offen lds
MAA 64,84,64
TR 106,25,50208
v_add_f32 v164, v164, v168
MAA 64,80,44
TR 108,25,62112
MAA 68,80,48
TR 110,25,62624
MAA 68,84,68
buffer_load_dwordx4 v19, s[20:23], s54 offen offset:1024 lds
MAA 72,84,72
TR 112,25,50720
v_add_f32 v165, v165, v169
MAA 72,80,52
TR 114,25,51232
s_waitcnt lgkmcnt(6)
MAA 156,88,56
TR 116,25,63136
MAA 156,92,76
buffer_load_dwordx4 v20, s[20:23], s54 offen offset:2048 lds
MAA 104,92,72
s_add_u32 s54, s54, 196608
s_add_u32 m0, s55, 36864
MAA 104,88,52
buffer_load_dwordx4 v21, s[16:19], s52 offen sc1 lds
MAA 100,88,48
TR 118,25,63648
MAA 100,92,68
TR 120,25,51744
v_add_f32 v166, v166, v170
MAA 96,92,64
TR 122,25,52256
MAA 96,88,44
buffer_load_dwordx4 v21, s[16:19], s52 offen offset:1024 sc1 lds
MAA 92,88,40
TR 124,25,64160
MAA 92,92,60
TR 126,25,64672
v_add_f32 v167, v167, v171
MAA 124,60,100
ds_read_b128 a[0:3], v23
MAA 124,40,96
buffer_load_dword v22, s[16:19], s52 offen offset:2048 sc1 lds
MAA 128,44,96
RD 4,23,1024
s_add_u32 s52, s52, 131072
MAA 128,64,100
buffer_load_dword v27, v14, s[20:23], s44 offen
MAA 132,68,100
RD 8,23,2304
s_add_u32 s44, s44, 1572864
MAA 132,48,96
RD 12,23,3328
MAA 136,52,96
RD 16,24,2048
MAA 136,72,100
s_waitcnt vmcnt(16) lgkmcnt(5)
s_barrier
MAA 76,104,40
RD 20,23,9216
s_add_u32 m0, s56, 117248
MAA 76,108,60
buffer_load_dwordx4 v18, s[20:23], s54 offen lds
MAA 80,108,64
RD 24,23,10240
MAA 80,104,44
RD 28,23,11520
MAA 84,104,48
RD 32,23,12544
MAA 84,108,68
buffer_load_dwordx4 v19, s[20:23], s54 offen offset:1024 lds
MAA 88,108,72
RD 36,24,11264
MAA 88,104,52
buffer_load_dwordx4 v20, s[20:23], s54 offen offset:2048 lds
MAA 160,112,56
ds_read_b64_tr_b16 a[80:81], v25
s_add_u32 s54, s54, 196608
MAA 160,116,76
TR 82,25,512
MAA 120,116,72
TR 84,25,12416
s_add_u32 m0, s55, 46080
MAA 120,112,52
buffer_load_dwordx4 v21, s[16:19], s52 offen sc1 lds
MAA 116,112,48
TR 86,25,12928
MAA 116,116,68
TR 88,25,1024
MAA 112,116,64
TR 90,25,1536
MAA 112,112,44
buffer_load_dwordx4 v21, s[16:19], s52 offen offset:1024 sc1 lds
MAA 108,112,40
TR 92,25,13440
MAA 108,116,60
TR 94,25,13952
MAA 140,60,124
TR 96,25,2048
MAA 140,40,120
buffer_load_dword v22, s[16:19], s52 offen offset:2048 sc1 lds
MAA 144,44,120
TR 98,25,2560
s_add_u32 s52, s52, 131072
MAA 144,64,124
buffer_load_dwordx4 v[168:171], v26, s[16:19], s75 offen sc1
MAA 148,68,124
TR 100,25,14464
MAA 148,48,120
TR 102,25,14976
MAA 152,52,120
MAA 152,72,124
s_waitcnt vmcnt(20) lgkmcnt(8)
s_barrier
MAA 60,80,0
TR 104,25,32
s_add_u32 m0, s56, 129664
MAA 60,84,20
buffer_load_dwordx4 v18, s[20:23], s54 offen lds
MAA 64,84,24
TR 106,25,544
v_add_f32 v164, v164, v172
MAA 64,80,4
TR 108,25,12448
MAA 68,80,8
TR 110,25,12960
MAA 68,84,28
buffer_load_dwordx4 v19, s[20:23], s54 offen offset:1024 lds
MAA 72,84,32
TR 112,25,1056
MAA 72,80,12
TR 114,25,1568
s_waitcnt lgkmcnt(6)
MAA 156,88,16
TR 116,25,13472
v_add_f32 v165, v165, v173
MAA 156,92,36
buffer_load_dwordx4 v20, s[20:23], s54 offen offset:2048 lds
MAA 104,92,32
TR 118,25,13984
s_add_u32 s54, s54, 196608
MAA 104,88,12
TR 120,25,2080
MAA 100,88,8
s_add_u32 m0, s55, 0
MAA 100,92,28
buffer_load_dwordx4 v21, s[16:19], s52 offen sc1 lds
MAA 96,92,24
TR 122,25,2592
v_add_f32 v166, v166, v174
MAA 96,88,4
TR 124,25,14496
MAA 92,88,0
TR 126,25,15008
MAA 92,92,20
buffer_load_dwordx4 v21, s[16:19], s52 offen offset:1024 sc1 lds
MAA 124,20,100
RD 40,23,18432
MAA 124,0,96
RD 44,23,19456
v_add_f32 v167, v167, v175
MAA 128,4,96
RD 48,23,20736
MAA 128,24,100
buffer_load_dword v22, s[16:19], s52 offen offset:2048 sc1 lds
MAA 132,28,100
RD 52,23,21760
s_add_u32 s52, s52, 131072
MAA 132,8,96
RD 56,24,20480
MAA 136,12,96
MAA 136,32,100
s_waitcnt vmcnt(17) lgkmcnt(5)
s_barrier
MAA 76,104,0
RD 60,23,27648
s_add_u32 m0, s56, 67584
MAA 76,108,20
buffer_load_dwordx4 v18, s[20:23], s54 offen lds
MAA 80,108,24
RD 64,23,28672
MAA 80,104,4
RD 68,23,29952
MAA 84,104,8
RD 72,23,30976
MAA 84,108,28
buffer_load_dwordx4 v19, s[20:23], s54 offen offset:1024 lds
MAA 88,108,32
RD 76,24,29696
MAA 88,104,12
buffer_load_dwordx4 v20, s[20:23], s54 offen offset:2048 lds
MAA 160,112,16
TR 80,25,24832
s_add_u32 s54, s54, 196608
MAA 160,116,36
TR 82,25,25344
MAA 120,116,32
TR 84,25,37248
s_add_u32 m0, s55, 9216
MAA 120,112,12
buffer_load_dwordx4 v21, s[16:19], s52 offen sc1 lds
MAA 116,112,8
TR 86,25,37760
MAA 116,116,28
TR 88,25,25856
MAA 112,116,24
TR 90,25,26368
MAA 112,112,4
buffer_load_dwordx4 v21, s[16:19], s52 offen offset:1024 sc1 lds
MAA 108,112,0
TR 92,25,38272
MAA 108,116,20
TR 94,25,38784
MAA 140,20,124
TR 96,25,26880
MAA 140,0,120
buffer_load_dword v22, s[16:19], s52 offen offset:2048 sc1 lds
MAA 144,4,120
TR 98,25,27392
s_add_u32 s52, s52, 131072
MAA 144,24,124
buffer_load_dwordx4 v[172:175], v26, s[16:19], s75 offen offset:1024 sc1
MAA 148,28,124
TR 100,25,39296
s_add_u32 s75, s75, 2048
MAA 148,8,120
TR 102,25,39808
MAA 152,12,120
MAA 152,32,124
s_waitcnt vmcnt(21) lgkmcnt(8)
s_barrier
MAA 60,80,40
TR 104,25,24864
s_add_u32 m0, s56, 80000
MAA 60,84,60
buffer_load_dwordx4 v18, s[20:23], s54 offen lds
MAA 64,84,64
TR 106,25,25376
MAA 64,80,44
TR 108,25,37280
MAA 68,80,48
TR 110,25,37792
MAA 68,84,68
buffer_load_dwordx4 v19, s[20:23], s54 offen offset:1024 lds
MAA 72,84,72
TR 112,25,25888
MAA 72,80,52
TR 114,25,26400
s_waitcnt lgkmcnt(6)
MAA 156,88,56
TR 116,25,38304
MAA 156,92,76
buffer_load_dwordx4 v20, s[20:23], s54 offen offset:2048 lds
MAA 104,92,72
TR 118,25,38816
s_add_u32 s54, s54, 196608
MAA 104,88,52
TR 120,25,26912
MAA 100,88,48
s_add_u32 m0, s55, 18432
MAA 100,92,68
buffer_load_dwordx4 v21, s[16:19], s52 offen sc1 lds
MAA 96,92,64
TR 122,25,27424
MAA 96,88,44
TR 124,25,39328
MAA 92,88,40
TR 126,25,39840
MAA 92,92,60
buffer_load_dwordx4 v21, s[16:19], s52 offen offset:1024 sc1 lds
MAA 124,60,100
RD 0,23,36864
MAA 124,40,96
RD 4,23,37888
MAA 128,44,96
RD 8,23,39168
MAA 128,64,100
buffer_load_dword v22, s[16:19], s52 offen offset:2048 sc1 lds
MAA 132,68,100
RD 12,23,40192
s_add_u32 s52, s52, 131072
MAA 132,48,96
RD 16,24,38912
MAA 136,52,96
MAA 136,72,100
s_waitcnt vmcnt(16) lgkmcnt(5)
s_barrier
MAA 76,104,40
RD 20,23,46080
s_add_u32 m0, s56, 92416
MAA 76,108,60
buffer_load_dwordx4 v18, s[20:23], s54 offen lds
MAA 80,108,64
RD 24,23,47104
MAA 80,104,44
RD 28,23,48384
MAA 84,104,48
RD 32,23,49408
MAA 84,108,68
buffer_load_dwordx4 v19, s[20:23], s54 offen offset:1024 lds
MAA 88,108,72
RD 36,24,48128
MAA 88,104,52
TR 80,25,49664
MAA 160,112,56
TR 82,25,50176
MAA 160,116,76
buffer_load_dwordx4 v20, s[20:23], s54 offen offset:2048 lds
MAA 120,116,72
TR 84,25,62080
s_add_u32 s54, s54, 196608
MAA 120,112,52
TR 86,25,62592
MAA 116,112,48
s_add_u32 m0, s55, 27648
MAA 116,116,68
buffer_load_dwordx4 v21, s[16:19], s52 offen sc1 lds
MAA 112,116,64
TR 88,25,50688
MAA 112,112,44
TR 90,25,51200
MAA 108,112,40
TR 92,25,63104
MAA 108,116,60
buffer_load_dwordx4 v21, s[16:19], s52 offen offset:1024 sc1 lds
MAA 140,60,124
TR 94,25,63616
MAA 140,40,120
TR 96,25,51712
MAA 144,44,120
TR 98,25,52224
MAA 144,64,124
buffer_load_dword v22, s[16:19], s52 offen offset:2048 sc1 lds
MAA 148,68,124
TR 100,25,64128
s_add_u32 s52, s52, 131072
MAA 148,48,120
TR 102,25,64640
MAA 152,52,120
s_add_u32 s15, s15, 1
MAA 152,72,124
s_cbranch_scc0 .Lk57
s_waitcnt vmcnt(19) lgkmcnt(8)
s_barrier
MAA 60,80,0
TR 104,25,49696
s_add_u32 m0, s56, 104832
MAA 60,84,20
buffer_load_dwordx4 v18, s[20:23], s54 offen lds
MAA 64,84,24
TR 106,25,50208
v_add_f32 v164, v164, v168
MAA 64,80,4
TR 108,25,62112
v_add_f32 v165, v165, v169
MAA 68,80,8
TR 110,25,62624
v_add_f32 v166, v166, v170
MAA 68,84,28
buffer_load_dwordx4 v19, s[20:23], s54 offen offset:1024 lds
MAA 72,84,32
TR 112,25,50720
v_add_f32 v167, v167, v171
MAA 72,80,12
TR 114,25,51232
s_waitcnt lgkmcnt(6)
MAA 156,88,16
TR 116,25,63136
MAA 156,92,36
buffer_load_dwordx4 v20, s[20:23], s54 offen offset:2048 lds
MAA 104,92,32
TR 118,25,63648
s_add_u32 s54, s54, 196608
MAA 104,88,12
TR 120,25,51744
s_add_u32 m0, s55, 36864
MAA 100,88,8
TR 122,25,52256
MAA 100,92,28
buffer_load_dwordx4 v21, s[16:19], s52 offen sc1 lds
MAA 96,92,24
TR 124,25,64160
MAA 96,88,4
TR 126,25,64672
MAA 92,88,0
ds_read_b128 a[40:43], v23
MAA 92,92,20
buffer_load_dwordx4 v21, s[16:19], s52 offen offset:1024 sc1 lds
MAA 124,20,100
RD 44,23,1024
MAA 124,0,96
RD 48,23,2304
MAA 128,4,96
RD 52,23,3328
MAA 128,24,100
buffer_load_dword v22, s[16:19], s52 offen offset:2048 sc1 lds
MAA 132,28,100
RD 56,24,2048
s_add_u32 s52, s52, 131072
MAA 132,8,96
MAA 136,12,96
MAA 136,32,100
s_waitcnt vmcnt(15) lgkmcnt(5)
s_barrier
MAA 76,104,0
RD 60,23,9216
s_add_u32 m0, s56, 117248
MAA 76,108,20
buffer_load_dwordx4 v18, s[20:23], s54 offen lds
MAA 80,108,24
RD 64,23,10240
v_add_f32 v164, v164, v172
MAA 80,104,4
RD 68,23,11520
v_add_f32 v165, v165, v173
MAA 84,104,8
RD 72,23,12544
v_add_f32 v166, v166, v174
MAA 84,108,28
buffer_load_dwordx4 v19, s[20:23], s54 offen offset:1024 lds
MAA 88,108,32
RD 76,24,11264
v_add_f32 v167, v167, v175
MAA 88,104,12
ds_read_b64_tr_b16 a[80:81], v25
MAA 160,112,16
TR 82,25,512
MAA 160,116,36
buffer_load_dwordx4 v20, s[20:23], s54 offen offset:2048 lds
MAA 120,116,32
TR 84,25,12416
s_add_u32 s54, s54, 196608
MAA 120,112,12
TR 86,25,12928
s_add_u32 m0, s55, 46080
MAA 116,112,8
TR 88,25,1024
MAA 116,116,28
buffer_load_dwordx4 v21, s[16:19], s52 offen sc1 lds
MAA 112,116,24
TR 90,25,1536
MAA 112,112,4
TR 92,25,13440
MAA 108,112,0
TR 94,25,13952
MAA 108,116,20
buffer_load_dwordx4 v21, s[16:19], s52 offen offset:1024 sc1 lds
.Lpad24:
s_cbranch_execz .Lpad27
MAA 140,20,124
TR 96,25,2048
MAA 140,0,120
TR 98,25,2560
MAA 144,4,120
TR 100,25,14464
MAA 144,24,124
buffer_load_dword v22, s[16:19], s52 offen offset:2048 sc1 lds
MAA 148,28,124
TR 102,25,14976
s_add_u32 s52, s52, 131072
MAA 148,8,120
v_permlane32_swap_b32 v164, v166
MAA 152,12,120
v_permlane32_swap_b32 v165, v167
MAA 152,32,124
s_waitcnt vmcnt(18) lgkmcnt(8)
s_barrier
MAA 60,80,40
TR 104,25,32
s_add_u32 m0, s56, 129664
MAA 60,84,60
buffer_load_dwordx4 v18, s[20:23], s54 offen lds
MAA 64,84,64
TR 106,25,544
v_add_f32 v164, v164, v166
MAA 64,80,44
TR 108,25,12448
v_add_f32 v165, v165, v167
MAA 68,80,48
buffer_load_dwordx4 v19, s[20:23], s54 offen offset:1024 lds
MAA 68,84,68
TR 110,25,12960
v_mul_f32 v164, 0xba800000, v164
MAA 72,84,72
TR 112,25,1056
v_mul_f32 v165, 0x3a800000, v165
MAA 72,80,52
buffer_load_dwordx4 v20, s[20:23], s54 offen offset:2048 lds
s_waitcnt lgkmcnt(5)
MAA 156,88,56
TR 114,25,1568
s_add_u32 s54, s54, 196608
MAA 156,92,76
TR 116,25,13472
s_add_u32 m0, s59, 58240
MAA 104,92,72
TR 118,25,13984
s_xor_b32 s58, s87, 1966080
MAA 104,88,52
buffer_load_dwordx4 v5, s[24:27], s58 offen lds
MAA 100,88,48
TR 120,25,2080
v_fma_f32 v165, -v164, v164, v165
MAA 100,92,68
TR 122,25,2592
v_max_f32 v165, 0, v165
MAA 96,92,64
buffer_load_dwordx4 v6, s[24:27], s58 offen offset:1024 lds
MAA 96,88,44
TR 124,25,14496
s_add_u32 m0, s59, 0
MAA 92,88,40
TR 126,25,15008
s_xor_b32 s58, s87, 1048576
MAA 92,92,60
buffer_load_dwordx4 v5, s[24:27], s58 offen lds
MAA 124,60,100
RD 0,23,18432
v_add_f32 v165, 0x3727c5ac, v165
MAA 124,40,96
RD 4,23,19456
MAA 128,44,96
buffer_load_dwordx4 v6, s[24:27], s58 offen offset:1024 lds
MAA 128,64,100
RD 8,23,20736
MAA 132,68,100
RD 12,23,21760
MAA 132,48,96
RD 16,24,20480
MAA 136,52,96
v_rsq_f32 v166, v165
MAA 136,72,100
v_mov_b32 v165, v166
v_mul_f32 v166, 0x3e8293ee, v166
ds_write_b128 v7, v[164:167]
s_waitcnt vmcnt(16) lgkmcnt(6)
s_barrier
MAA 76,104,40
ds_write_b32 v17, v164
s_add_u32 m0, s59, 8320
MAA 76,108,60
ds_write_b32 v17, v165 offset:1024
s_xor_b32 s58, s87, 1179648
MAA 80,108,64
buffer_load_dwordx4 v5, s[24:27], s58 offen lds
MAA 80,104,44
RD 20,23,27648
MAA 84,104,48
RD 24,23,28672
MAA 84,108,68
RD 28,23,29952
MAA 88,108,72
buffer_load_dwordx4 v6, s[24:27], s58 offen offset:1024 lds
MAA 88,104,52
RD 32,23,30976
s_add_u32 m0, s59, 66560
MAA 160,112,56
RD 36,24,29696
s_xor_b32 s58, s87, 0
MAA 160,116,76
TR 80,25,24832
MAA 120,116,72
buffer_load_dwordx4 v5, s[24:27], s58 offen lds
MAA 120,112,52
TR 82,25,25344
MAA 116,112,48
TR 84,25,37248
MAA 116,116,68
TR 86,25,37760
MAA 112,116,64
buffer_load_dwordx4 v6, s[24:27], s58 offen offset:1024 lds
MAA 112,112,44
TR 88,25,25856
s_add_u32 m0, s59, 74880
MAA 108,112,40
TR 90,25,26368
s_xor_b32 s58, s87, 131072
MAA 108,116,60
TR 92,25,38272
MAA 140,60,124
buffer_load_dwordx4 v5, s[24:27], s58 offen lds
MAA 140,40,120
TR 94,25,38784
MAA 144,44,120
TR 96,25,26880
MAA 144,64,124
TR 98,25,27392
MAA 148,68,124
buffer_load_dwordx4 v6, s[24:27], s58 offen offset:1024 lds
MAA 148,48,120
TR 100,25,39296
MAA 152,52,120
TR 102,25,39808
MAA 152,72,124
s_waitcnt vmcnt(10) lgkmcnt(0)
s_barrier
MAA 156,88,16
TR 112,25,25888
s_add_u32 m0, s59, 83200
MAA 156,92,36
TR 114,25,26400
s_xor_b32 s58, s87, 262144
MAA 104,92,32
buffer_load_dwordx4 v5, s[24:27], s58 offen lds
MAA 104,88,12
TR 116,25,38304
MAA 100,88,8
TR 118,25,38816
MAA 100,92,28
TR 120,25,26912
MAA 96,92,24
buffer_load_dwordx4 v6, s[24:27], s58 offen offset:1024 lds
MAA 96,88,4
TR 122,25,27424
s_add_u32 m0, s59, 16640
MAA 92,88,0
TR 124,25,39328
s_xor_b32 s58, s87, 1310720
MAA 92,92,20
TR 126,25,39840
MAA 136,32,100
buffer_load_dwordx4 v5, s[24:27], s58 offen lds
MAA 136,12,96
TR 104,25,24864
MAA 72,80,12
TR 106,25,25376
MAA 72,84,32
TR 108,25,37280
MAA 68,84,28
buffer_load_dwordx4 v6, s[24:27], s58 offen offset:1024 lds
MAA 68,80,8
TR 110,25,37792
s_add_u32 m0, s59, 24960
MAA 64,80,4
RD 40,23,36864
s_xor_b32 s58, s87, 1441792
MAA 64,84,24
RD 44,23,37888
MAA 60,84,20
buffer_load_dwordx4 v5, s[24:27], s58 offen lds
MAA 60,80,0
RD 48,23,39168
s_waitcnt lgkmcnt(13)
MAA 160,112,16
RD 52,23,40192
s_waitcnt lgkmcnt(12)
MAA 160,116,36
RD 56,24,38912
MAA 120,116,32
buffer_load_dwordx4 v6, s[24:27], s58 offen offset:1024 lds
MAA 120,112,12
s_waitcnt lgkmcnt(5)
s_barrier
RD 60,23,46080
MAA 116,112,8
RD 64,23,47104
s_add_u32 m0, s59, 91520
MAA 116,116,28
RD 68,23,48384
s_xor_b32 s58, s87, 393216
MAA 112,116,24
RD 72,23,49408
MAA 112,112,4
RD 76,24,48128
MAA 108,112,0
TR 144,25,50688
MAA 108,116,20
TR 146,25,51200
MAA 152,32,124
TR 148,25,63104
MAA 152,12,120
TR 150,25,63616
MAA 88,104,12
TR 152,25,50720
MAA 88,108,32
TR 154,25,51232
MAA 84,108,28
TR 156,25,63136
MAA 84,104,8
TR 158,25,63648
MAA 80,104,4
TR 160,25,51712
MAA 80,108,24
TR 162,25,52224
MAA 76,108,20
TR 164,25,64128
MAA 76,104,0
TR 166,25,64640
s_waitcnt lgkmcnt(10)
MAA 156,144,56
TR 168,25,51744
s_waitcnt lgkmcnt(9)
MAA 156,148,76
TR 170,25,52256
MAA 104,148,72
TR 172,25,64160
MAA 104,144,52
TR 174,25,64672
MAA 100,144,48
TR 128,25,49664
MAA 100,148,68
TR 130,25,50176
MAA 96,148,64
TR 132,25,62080
MAA 96,144,44
TR 134,25,62592
MAA 92,144,40
TR 136,25,49696
MAA 92,148,60
TR 138,25,50208
s_waitcnt lgkmcnt(14)
MAA 160,156,76
TR 140,25,62112
MAA 160,152,56
TR 142,25,62624
MAA 120,152,52
ds_read_b128 v[232:235], v10 offset:768
MAA 120,156,72
ds_read_b128 v[236:239], v10 offset:2816
MAA 116,156,68
ds_read_b128 v[228:231], v10 offset:512
MAA 116,152,48
ds_read_b128 v[224:227], v10 offset:256
MAA 112,152,44
ds_read_b128 v[220:223], v10
MAA 112,156,64
buffer_load_dwordx4 v5, s[24:27], s58 offen lds
MAA 108,156,60
ds_read_b128 v[240:243], v11 offset:192
MAA 108,152,40
s_waitcnt lgkmcnt(6)
s_barrier
ds_read_b128 v[244:247], v11 offset:1216
MAA 136,52,160
ds_read_b128 v[18:21], v11 offset:128
MAA 136,72,164
buffer_load_dwordx4 v6, s[24:27], s58 offen offset:1024 lds
MAA 152,72,172
ds_read_b128 v[22:25], v11 offset:1152
s_add_u32 m0, s59, 99840
MAA 152,52,168
s_xor_b32 s58, s87, 524288
MAA 72,128,52
MAA 72,132,72
buffer_load_dwordx4 v5, s[24:27], s58 offen lds
MAA 68,132,68
MAA 68,128,48
MAA 64,128,44
MAA 64,132,64
buffer_load_dwordx4 v6, s[24:27], s58 offen offset:1024 lds
MAA 60,132,60
s_add_u32 m0, s59, 108160
s_xor_b32 s58, s87, 655360
MAA 60,128,40
MAA 88,136,52
MAA 88,140,72
buffer_load_dwordx4 v5, s[24:27], s58 offen lds
MAA 84,140,68
MAA 84,136,48
MAA 80,136,44
MAA 80,140,64
buffer_load_dwordx4 v6, s[24:27], s58 offen offset:1024 lds
MAA 76,140,60
s_add_u32 m0, s59, 33280
s_xor_b32 s58, s87, 1572864
MAA 76,136,40
s_waitcnt lgkmcnt(8)
v_pk_fma_f32 v[104:105], v[36:37], v[232:233], v[104:105] op_sel_hi:[1,0,1]
v_pk_mul_f32 v[104:105], v[104:105], v[232:233] op_sel:[0,1] op_sel_hi:[1,1]
v_cvt_pk_bf16_f32 v196, v104, v105
v_pk_fma_f32 v[106:107], v[38:39], v[232:233], v[106:107] op_sel_hi:[1,0,1]
v_pk_mul_f32 v[106:107], v[106:107], v[232:233] op_sel:[0,1] op_sel_hi:[1,1]
v_cvt_pk_bf16_f32 v197, v106, v107
v_pk_fma_f32 v[120:121], v[40:41], v[232:233], v[120:121] op_sel_hi:[1,0,1]
v_pk_mul_f32 v[120:121], v[120:121], v[232:233] op_sel:[0,1] op_sel_hi:[1,1]
v_cvt_pk_bf16_f32 v198, v120, v121
v_pk_fma_f32 v[122:123], v[42:43], v[232:233], v[122:123] op_sel_hi:[1,0,1]
v_pk_mul_f32 v[122:123], v[122:123], v[232:233] op_sel:[0,1] op_sel_hi:[1,1]
v_cvt_pk_bf16_f32 v199, v122, v123
s_waitcnt lgkmcnt(3)
v_pk_fma_f32 v[136:137], v[240:241], v[44:45], v[136:137] op_sel_hi:[1,0,1]
s_waitcnt lgkmcnt(2)
v_pk_mul_f32 v[136:137], v[136:137], v[244:245]
v_cvt_pk_bf16_f32 v208, v136, v137
v_pk_fma_f32 v[138:139], v[242:243], v[44:45], v[138:139] op_sel_hi:[1,0,1]
v_pk_mul_f32 v[138:139], v[138:139], v[246:247]
v_cvt_pk_bf16_f32 v209, v138, v139
v_pk_fma_f32 v[152:153], v[240:241], v[44:45], v[152:153] op_sel:[0,1,0] op_sel_hi:[1,1,1]
v_pk_mul_f32 v[152:153], v[152:153], v[244:245]
v_cvt_pk_bf16_f32 v218, v152, v153
v_pk_fma_f32 v[154:155], v[242:243], v[44:45], v[154:155] op_sel:[0,1,0] op_sel_hi:[1,1,1]
v_pk_mul_f32 v[154:155], v[154:155], v[246:247]
v_cvt_pk_bf16_f32 v219, v154, v155
ds_write_b128 v8, v[196:199]
ds_write_b64 v8, v[208:209] offset:1024
ds_write_b64 v8, v[218:219] offset:1032
v_pk_fma_f32 v[156:157], v[36:37], v[236:237], v[156:157] op_sel_hi:[1,0,1]
v_pk_mul_f32 v[156:157], v[156:157], v[236:237] op_sel:[0,1] op_sel_hi:[1,1]
v_cvt_pk_bf16_f32 v180, v156, v157
v_pk_fma_f32 v[158:159], v[38:39], v[236:237], v[158:159] op_sel_hi:[1,0,1]
v_pk_mul_f32 v[158:159], v[158:159], v[236:237] op_sel:[0,1] op_sel_hi:[1,1]
v_cvt_pk_bf16_f32 v181, v158, v159
v_pk_fma_f32 v[160:161], v[40:41], v[236:237], v[160:161] op_sel_hi:[1,0,1]
v_pk_mul_f32 v[160:161], v[160:161], v[236:237] op_sel:[0,1] op_sel_hi:[1,1]
v_cvt_pk_bf16_f32 v182, v160, v161
v_pk_fma_f32 v[162:163], v[42:43], v[236:237], v[162:163] op_sel_hi:[1,0,1]
v_pk_mul_f32 v[162:163], v[162:163], v[236:237] op_sel:[0,1] op_sel_hi:[1,1]
v_cvt_pk_bf16_f32 v183, v162, v163
v_pk_fma_f32 v[100:101], v[36:37], v[228:229], v[100:101] op_sel_hi:[1,0,1]
v_pk_mul_f32 v[100:101], v[100:101], v[228:229] op_sel:[0,1] op_sel_hi:[1,1]
v_cvt_pk_bf16_f32 v192, v100, v101
v_pk_fma_f32 v[102:103], v[38:39], v[228:229], v[102:103] op_sel_hi:[1,0,1]
v_pk_mul_f32 v[102:103], v[102:103], v[228:229] op_sel:[0,1] op_sel_hi:[1,1]
v_cvt_pk_bf16_f32 v193, v102, v103
v_pk_fma_f32 v[116:117], v[40:41], v[228:229], v[116:117] op_sel_hi:[1,0,1]
v_pk_mul_f32 v[116:117], v[116:117], v[228:229] op_sel:[0,1] op_sel_hi:[1,1]
v_cvt_pk_bf16_f32 v194, v116, v117
v_pk_fma_f32 v[118:119], v[42:43], v[228:229], v[118:119] op_sel_hi:[1,0,1]
v_pk_mul_f32 v[118:119], v[118:119], v[228:229] op_sel:[0,1] op_sel_hi:[1,1]
s_waitcnt lgkmcnt(0)
s_barrier
v_cvt_pk_bf16_f32 v195, v118, v119
v_pk_fma_f32 v[96:97], v[36:37], v[224:225], v[96:97] op_sel_hi:[1,0,1]
v_pk_mul_f32 v[96:97], v[96:97], v[224:225] op_sel:[0,1] op_sel_hi:[1,1]
v_cvt_pk_bf16_f32 v188, v96, v97
v_pk_fma_f32 v[98:99], v[38:39], v[224:225], v[98:99] op_sel_hi:[1,0,1]
v_pk_mul_f32 v[98:99], v[98:99], v[224:225] op_sel:[0,1] op_sel_hi:[1,1]
v_cvt_pk_bf16_f32 v189, v98, v99
v_pk_fma_f32 v[112:113], v[40:41], v[224:225], v[112:113] op_sel_hi:[1,0,1]
v_pk_mul_f32 v[112:113], v[112:113], v[224:225] op_sel:[0,1] op_sel_hi:[1,1]
v_cvt_pk_bf16_f32 v190, v112, v113
v_pk_fma_f32 v[114:115], v[42:43], v[224:225], v[114:115] op_sel_hi:[1,0,1]
v_pk_mul_f32 v[114:115], v[114:115], v[224:225] op_sel:[0,1] op_sel_hi:[1,1]
v_cvt_pk_bf16_f32 v191, v114, v115
v_pk_fma_f32 v[92:93], v[36:37], v[220:221], v[92:93] op_sel_hi:[1,0,1]
v_pk_mul_f32 v[92:93], v[92:93], v[220:221] op_sel:[0,1] op_sel_hi:[1,1]
v_cvt_pk_bf16_f32 v184, v92, v93
v_pk_fma_f32 v[94:95], v[38:39], v[220:221], v[94:95] op_sel_hi:[1,0,1]
v_pk_mul_f32 v[94:95], v[94:95], v[220:221] op_sel:[0,1] op_sel_hi:[1,1]
v_cvt_pk_bf16_f32 v185, v94, v95
v_pk_fma_f32 v[108:109], v[40:41], v[220:221], v[108:109] op_sel_hi:[1,0,1]
v_pk_mul_f32 v[108:109], v[108:109], v[220:221] op_sel:[0,1] op_sel_hi:[1,1]
v_cvt_pk_bf16_f32 v186, v108, v109
v_pk_fma_f32 v[110:111], v[42:43], v[220:221], v[110:111] op_sel_hi:[1,0,1]
v_pk_mul_f32 v[110:111], v[110:111], v[220:221] op_sel:[0,1] op_sel_hi:[1,1]
v_cvt_pk_bf16_f32 v187, v110, v111
v_pk_fma_f32 v[72:73], v[28:29], v[232:233], v[72:73] op_sel_hi:[1,0,1]
v_cvt_pk_bf16_f32 v176, v72, v73
v_pk_fma_f32 v[74:75], v[30:31], v[232:233], v[74:75] op_sel_hi:[1,0,1]
v_cvt_pk_bf16_f32 v177, v74, v75
v_pk_fma_f32 v[88:89], v[32:33], v[232:233], v[88:89] op_sel_hi:[1,0,1]
v_cvt_pk_bf16_f32 v178, v88, v89
v_pk_fma_f32 v[90:91], v[34:35], v[232:233], v[90:91] op_sel_hi:[1,0,1]
v_cvt_pk_bf16_f32 v179, v90, v91
v_pk_fma_f32 v[68:69], v[28:29], v[228:229], v[68:69] op_sel_hi:[1,0,1]
v_cvt_pk_bf16_f32 v172, v68, v69
v_pk_fma_f32 v[70:71], v[30:31], v[228:229], v[70:71] op_sel_hi:[1,0,1]
v_cvt_pk_bf16_f32 v173, v70, v71
v_pk_fma_f32 v[84:85], v[32:33], v[228:229], v[84:85] op_sel_hi:[1,0,1]
v_cvt_pk_bf16_f32 v174, v84, v85
v_pk_fma_f32 v[86:87], v[34:35], v[228:229], v[86:87] op_sel_hi:[1,0,1]
v_cvt_pk_bf16_f32 v175, v86, v87
v_pk_fma_f32 v[64:65], v[28:29], v[224:225], v[64:65] op_sel_hi:[1,0,1]
v_cvt_pk_bf16_f32 v168, v64, v65
v_pk_fma_f32 v[66:67], v[30:31], v[224:225], v[66:67] op_sel_hi:[1,0,1]
v_cvt_pk_bf16_f32 v169, v66, v67
v_pk_fma_f32 v[80:81], v[32:33], v[224:225], v[80:81] op_sel_hi:[1,0,1]
v_cvt_pk_bf16_f32 v170, v80, v81
v_pk_fma_f32 v[82:83], v[34:35], v[224:225], v[82:83] op_sel_hi:[1,0,1]
v_cvt_pk_bf16_f32 v171, v82, v83
v_pk_fma_f32 v[60:61], v[28:29], v[220:221], v[60:61] op_sel_hi:[1,0,1]
v_cvt_pk_bf16_f32 v164, v60, v61
v_pk_fma_f32 v[62:63], v[30:31], v[220:221], v[62:63] op_sel_hi:[1,0,1]
v_cvt_pk_bf16_f32 v165, v62, v63
v_pk_fma_f32 v[76:77], v[32:33], v[220:221], v[76:77] op_sel_hi:[1,0,1]
v_cvt_pk_bf16_f32 v166, v76, v77
v_pk_fma_f32 v[78:79], v[34:35], v[220:221], v[78:79] op_sel_hi:[1,0,1]
v_cvt_pk_bf16_f32 v167, v78, v79
s_nop 0
v_mfma_f32_16x16x32_bf16 v[120:123], v[196:199], v[176:179], v[50:53]
buffer_load_dwordx4 v5, s[24:27], s58 offen lds
v_mfma_f32_16x16x32_bf16 v[104:107], v[192:195], v[176:179], v[46:49]
ds_read_b64 v[200:201], v9 offset:1024
v_mfma_f32_16x16x32_bf16 v[116:119], v[192:195], v[172:175], v[50:53]
ds_read_b64 v[210:211], v9 offset:1032
v_mfma_f32_16x16x32_bf16 v[100:103], v[188:191], v[172:175], v[46:49]
ds_read_b128 v[240:243], v11 offset:64
v_mfma_f32_16x16x32_bf16 v[112:115], v[188:191], v[168:171], v[50:53]
buffer_load_dwordx4 v6, s[24:27], s58 offen offset:1024 lds
v_mfma_f32_16x16x32_bf16 v[96:99], v[184:187], v[168:171], v[46:49]
ds_read_b128 v[244:247], v11 offset:1088
s_add_u32 m0, s59, 41600
v_mfma_f32_16x16x32_bf16 v[108:111], v[184:187], v[164:167], v[50:53]
ds_read_b128 v[28:31], v11
s_xor_b32 s58, s87, 1703936
v_mfma_f32_16x16x32_bf16 v[92:95], v[180:183], v[164:167], v[54:57]
ds_read_b128 v[32:35], v11 offset:1024
v_max3_f32 v88, v104, v105, v106
MAA 132,8,96
buffer_load_dwordx4 v5, s[24:27], s58 offen lds
MAA 132,28,100
v_max3_f32 v89, v107, v120, v121
v_max3_f32 v88, v88, v122, v123
MAA 132,48,160
v_max_f32 v90, v88, v89
v_max_f32 v89, v88, v89
MAA 132,68,164
s_nop 0
v_permlane16_swap_b32 v90, v89
MAA 148,68,172
buffer_load_dwordx4 v6, s[24:27], s58 offen offset:1024 lds
MAA 148,48,168
s_add_u32 m0, s59, 49920
s_xor_b32 s58, s87, 1835008
v_max_f32 v88, v90, v89
MAA 148,28,124
v_max_f32 v89, v90, v89
v_max3_f32 v84, v100, v101, v102
MAA 148,8,120
v_permlane32_swap_b32 v88, v89
v_max3_f32 v85, v103, v116, v117
v_max_f32 v88, v88, v89
v_mul_f32 v88, v88, v234
v_max3_f32 v84, v84, v118, v119
v_max_f32 v86, v84, v85
v_max_f32 v85, v84, v85
v_max3_f32 v80, v96, v97, v98
v_max3_f32 v81, v99, v112, v113
v_permlane16_swap_b32 v86, v85
v_max3_f32 v80, v80, v114, v115
v_max_f32 v84, v86, v85
v_max_f32 v85, v86, v85
v_max_f32 v82, v80, v81
v_max_f32 v81, v80, v81
v_permlane32_swap_b32 v84, v85
v_max3_f32 v76, v92, v93, v94
v_max_f32 v84, v84, v85
v_mul_f32 v84, v84, v230
v_permlane16_swap_b32 v82, v81
v_max3_f32 v77, v95, v108, v109
v_max_f32 v80, v82, v81
v_max_f32 v81, v82, v81
v_max3_f32 v76, v76, v110, v111
v_max_f32 v78, v76, v77
v_permlane32_swap_b32 v80, v81
v_max_f32 v77, v76, v77
v_max_f32 v80, v80, v81
v_mul_f32 v80, v80, v226
v_permlane16_swap_b32 v78, v77
v_pk_fma_f32 v[104:105], v[104:105], v[234:235], v[88:89] op_sel_hi:[1,0,0] neg_lo:[0,0,1] neg_hi:[0,0,1]
v_max_f32 v76, v78, v77
v_max_f32 v77, v78, v77
v_pk_fma_f32 v[106:107], v[106:107], v[234:235], v[88:89] op_sel_hi:[1,0,0] neg_lo:[0,0,1] neg_hi:[0,0,1]
v_pk_fma_f32 v[120:121], v[120:121], v[234:235], v[88:89] op_sel_hi:[1,0,0] neg_lo:[0,0,1] neg_hi:[0,0,1]
v_permlane32_swap_b32 v76, v77
v_pk_fma_f32 v[122:123], v[122:123], v[234:235], v[88:89] op_sel_hi:[1,0,0] neg_lo:[0,0,1] neg_hi:[0,0,1]
v_max_f32 v76, v76, v77
v_mul_f32 v76, v76, v222
v_pk_fma_f32 v[100:101], v[100:101], v[230:231], v[84:85] op_sel_hi:[1,0,0] neg_lo:[0,0,1] neg_hi:[0,0,1]
v_pk_fma_f32 v[102:103], v[102:103], v[230:231], v[84:85] op_sel_hi:[1,0,0] neg_lo:[0,0,1] neg_hi:[0,0,1]
v_pk_fma_f32 v[116:117], v[116:117], v[230:231], v[84:85] op_sel_hi:[1,0,0] neg_lo:[0,0,1] neg_hi:[0,0,1]
v_pk_fma_f32 v[118:119], v[118:119], v[230:231], v[84:85] op_sel_hi:[1,0,0] neg_lo:[0,0,1] neg_hi:[0,0,1]
v_pk_fma_f32 v[96:97], v[96:97], v[226:227], v[80:81] op_sel_hi:[1,0,0] neg_lo:[0,0,1] neg_hi:[0,0,1]
v_pk_fma_f32 v[98:99], v[98:99], v[226:227], v[80:81] op_sel_hi:[1,0,0] neg_lo:[0,0,1] neg_hi:[0,0,1]
v_pk_fma_f32 v[112:113], v[112:113], v[226:227], v[80:81] op_sel_hi:[1,0,0] neg_lo:[0,0,1] neg_hi:[0,0,1]
v_pk_fma_f32 v[114:115], v[114:115], v[226:227], v[80:81] op_sel_hi:[1,0,0] neg_lo:[0,0,1] neg_hi:[0,0,1]
v_pk_fma_f32 v[92:93], v[92:93], v[222:223], v[76:77] op_sel_hi:[1,0,0] neg_lo:[0,0,1] neg_hi:[0,0,1]
v_pk_fma_f32 v[94:95], v[94:95], v[222:223], v[76:77] op_sel_hi:[1,0,0] neg_lo:[0,0,1] neg_hi:[0,0,1]
v_pk_fma_f32 v[108:109], v[108:109], v[222:223], v[76:77] op_sel_hi:[1,0,0] neg_lo:[0,0,1] neg_hi:[0,0,1]
v_pk_fma_f32 v[110:111], v[110:111], v[222:223], v[76:77] op_sel_hi:[1,0,0] neg_lo:[0,0,1] neg_hi:[0,0,1]
v_pk_fma_f32 v[132:133], v[18:19], v[44:45], v[132:133] op_sel_hi:[1,0,1]
v_pk_mul_f32 v[132:133], v[132:133], v[22:23]
v_pk_fma_f32 v[134:135], v[20:21], v[44:45], v[134:135] op_sel_hi:[1,0,1]
v_pk_mul_f32 v[134:135], v[134:135], v[24:25]
v_pk_fma_f32 v[148:149], v[18:19], v[44:45], v[148:149] op_sel:[0,1,0] op_sel_hi:[1,1,1]
v_pk_mul_f32 v[148:149], v[148:149], v[22:23]
v_pk_fma_f32 v[150:151], v[20:21], v[44:45], v[150:151] op_sel:[0,1,0] op_sel_hi:[1,1,1]
v_pk_mul_f32 v[150:151], v[150:151], v[24:25]
v_exp_f32 v104, v104
s_nop 0
MAA 128,4,96
buffer_load_dwordx4 v5, s[24:27], s58 offen lds
MAA 128,24,100
v_exp_f32 v105, v105
MAA 128,44,160
v_exp_f32 v106, v106
MAA 128,64,164
v_exp_f32 v107, v107
MAA 144,64,172
buffer_load_dwordx4 v6, s[24:27], s58 offen offset:1024 lds
MAA 144,44,168
s_add_u32 m0, s59, 116480
s_xor_b32 s58, s87, 786432
v_exp_f32 v120, v120
MAA 144,24,124
v_exp_f32 v121, v121
.Lpad25:
s_cbranch_execz .Lpad28
MAA 144,4,120
v_exp_f32 v122, v122
MAA 124,0,96
buffer_load_dwordx4 v5, s[24:27], s58 offen lds
MAA 124,20,100
v_exp_f32 v123, v123
MAA 124,40,160
v_exp_f32 v100, v100
MAA 124,60,164
v_exp_f32 v101, v101
MAA 140,60,172
buffer_load_dwordx4 v6, s[24:27], s58 offen offset:1024 lds
MAA 140,40,168
s_add_u32 m0, s59, 124800
s_xor_b32 s58, s87, 917504
v_exp_f32 v102, v102
MAA 140,20,124
v_exp_f32 v103, v103
MAA 140,0,120
v_cvt_pk_bf16_f32 v72, v104, v105
v_cvt_pk_bf16_f32 v73, v106, v107
v_cvt_pk_bf16_f32 v74, v120, v121
v_cvt_pk_bf16_f32 v75, v122, v123
v_exp_f32 v116, v116
v_exp_f32 v117, v117
v_exp_f32 v118, v118
v_exp_f32 v119, v119
v_cvt_pk_bf16_f32 v68, v100, v101
v_cvt_pk_bf16_f32 v69, v102, v103
v_cvt_pk_bf16_f32 v70, v116, v117
v_cvt_pk_bf16_f32 v71, v118, v119
v_exp_f32 v96, v96
v_exp_f32 v97, v97
v_exp_f32 v98, v98
v_exp_f32 v99, v99
v_exp_f32 v112, v112
v_exp_f32 v113, v113
v_exp_f32 v114, v114
v_exp_f32 v115, v115
v_cvt_pk_bf16_f32 v64, v96, v97
v_cvt_pk_bf16_f32 v65, v98, v99
v_cvt_pk_bf16_f32 v66, v112, v113
v_cvt_pk_bf16_f32 v67, v114, v115
v_cvt_pk_bf16_f32 v206, v132, v133
v_cvt_pk_bf16_f32 v207, v134, v135
v_cvt_pk_bf16_f32 v216, v148, v149
v_cvt_pk_bf16_f32 v217, v150, v151
s_waitcnt lgkmcnt(3)
v_pk_fma_f32 v[128:129], v[240:241], v[44:45], v[128:129] op_sel_hi:[1,0,1]
s_waitcnt lgkmcnt(2)
v_pk_mul_f32 v[128:129], v[128:129], v[244:245]
v_cvt_pk_bf16_f32 v204, v128, v129
v_pk_fma_f32 v[130:131], v[242:243], v[44:45], v[130:131] op_sel_hi:[1,0,1]
v_pk_mul_f32 v[130:131], v[130:131], v[246:247]
v_cvt_pk_bf16_f32 v205, v130, v131
v_pk_fma_f32 v[144:145], v[240:241], v[44:45], v[144:145] op_sel:[0,1,0] op_sel_hi:[1,1,1]
v_pk_mul_f32 v[144:145], v[144:145], v[244:245]
v_cvt_pk_bf16_f32 v214, v144, v145
v_pk_fma_f32 v[146:147], v[242:243], v[44:45], v[146:147] op_sel:[0,1,0] op_sel_hi:[1,1,1]
v_pk_mul_f32 v[146:147], v[146:147], v[246:247]
v_cvt_pk_bf16_f32 v215, v146, v147
s_waitcnt lgkmcnt(1)
v_pk_fma_f32 v[124:125], v[28:29], v[44:45], v[124:125] op_sel_hi:[1,0,1]
s_waitcnt lgkmcnt(0)
v_pk_mul_f32 v[124:125], v[124:125], v[32:33]
v_cvt_pk_bf16_f32 v202, v124, v125
v_pk_fma_f32 v[126:127], v[30:31], v[44:45], v[126:127] op_sel_hi:[1,0,1]
v_pk_mul_f32 v[126:127], v[126:127], v[34:35]
v_cvt_pk_bf16_f32 v203, v126, v127
v_pk_fma_f32 v[140:141], v[28:29], v[44:45], v[140:141] op_sel:[0,1,0] op_sel_hi:[1,1,1]
v_pk_mul_f32 v[140:141], v[140:141], v[32:33]
v_cvt_pk_bf16_f32 v212, v140, v141
v_pk_fma_f32 v[142:143], v[30:31], v[44:45], v[142:143] op_sel:[0,1,0] op_sel_hi:[1,1,1]
v_pk_mul_f32 v[142:143], v[142:143], v[34:35]
v_cvt_pk_bf16_f32 v213, v142, v143
s_nop 0
v_mfma_f32_16x16x32_bf16 v[88:91], v[248:251], v[72:75], 0
buffer_load_dwordx4 v5, s[24:27], s58 offen lds
v_mfma_f32_16x16x32_bf16 v[104:107], v[206:209], v[72:75], 0
v_exp_f32 v92, v92
v_mfma_f32_16x16x32_bf16 v[120:123], v[216:219], v[72:75], 0
v_exp_f32 v93, v93
v_mfma_f32_16x16x32_bf16 v[84:87], v[248:251], v[68:71], 0
v_exp_f32 v94, v94
v_mfma_f32_16x16x32_bf16 v[100:103], v[204:207], v[68:71], 0
buffer_load_dwordx4 v6, s[24:27], s58 offen offset:1024 lds
v_mfma_f32_16x16x32_bf16 v[116:119], v[214:217], v[68:71], 0
v_exp_f32 v95, v95
v_mfma_f32_16x16x32_bf16 v[80:83], v[248:251], v[64:67], 0
v_exp_f32 v108, v108
v_mfma_f32_16x16x32_bf16 v[96:99], v[202:205], v[64:67], 0
v_exp_f32 v109, v109
v_mfma_f32_16x16x32_bf16 v[112:115], v[212:215], v[64:67], 0
v_exp_f32 v110, v110
v_cvt_pk_bf16_f32 v60, v92, v93
v_cvt_pk_bf16_f32 v61, v94, v95
v_cvt_pk_bf16_f32 v62, v108, v109
v_rcp_f32 v88, v88
v_rcp_f32 v84, v84
v_rcp_f32 v80, v80
v_pk_mul_f32 v[104:105], v[104:105], v[88:89] op_sel_hi:[1,0]
v_pk_mul_f32 v[106:107], v[106:107], v[88:89] op_sel_hi:[1,0]
v_pk_mul_f32 v[120:121], v[120:121], v[88:89] op_sel_hi:[1,0]
v_pk_mul_f32 v[122:123], v[122:123], v[88:89] op_sel_hi:[1,0]
v_cvt_pk_bf16_f32 v176, v104, v105
v_cvt_pk_bf16_f32 v177, v106, v107
v_cvt_pk_bf16_f32 v178, v120, v121
v_cvt_pk_bf16_f32 v179, v122, v123
buffer_store_dwordx4 v[176:179], v4, s[16:19], s74 offen offset:3072 sc1
v_pk_mul_f32 v[100:101], v[100:101], v[84:85] op_sel_hi:[1,0]
v_pk_mul_f32 v[102:103], v[102:103], v[84:85] op_sel_hi:[1,0]
v_pk_mul_f32 v[116:117], v[116:117], v[84:85] op_sel_hi:[1,0]
v_pk_mul_f32 v[118:119], v[118:119], v[84:85] op_sel_hi:[1,0]
v_cvt_pk_bf16_f32 v172, v100, v101
v_cvt_pk_bf16_f32 v173, v102, v103
v_cvt_pk_bf16_f32 v174, v116, v117
v_cvt_pk_bf16_f32 v175, v118, v119
buffer_store_dwordx4 v[172:175], v4, s[16:19], s74 offen offset:2048 sc1
v_pk_mul_f32 v[96:97], v[96:97], v[80:81] op_sel_hi:[1,0]
v_pk_mul_f32 v[98:99], v[98:99], v[80:81] op_sel_hi:[1,0]
v_pk_mul_f32 v[112:113], v[112:113], v[80:81] op_sel_hi:[1,0]
v_pk_mul_f32 v[114:115], v[114:115], v[80:81] op_sel_hi:[1,0]
v_cvt_pk_bf16_f32 v168, v96, v97
v_cvt_pk_bf16_f32 v169, v98, v99
v_cvt_pk_bf16_f32 v170, v112, v113
v_cvt_pk_bf16_f32 v171, v114, v115
buffer_store_dwordx4 v[168:171], v4, s[16:19], s74 offen offset:1024 sc1
v_exp_f32 v111, v111
s_nop 0
v_cvt_pk_bf16_f32 v63, v110, v111
s_nop 1
v_mfma_f32_16x16x32_bf16 v[76:79], v[248:251], v[60:63], 0
v_mfma_f32_16x16x32_bf16 v[92:95], v[200:203], v[60:63], 0
v_mfma_f32_16x16x32_bf16 v[108:111], v[210:213], v[60:63], 0
s_nop 5
v_rcp_f32 v76, v76
s_nop 0
v_pk_mul_f32 v[92:93], v[92:93], v[76:77] op_sel_hi:[1,0]
v_cvt_pk_bf16_f32 v164, v92, v93
v_pk_mul_f32 v[94:95], v[94:95], v[76:77] op_sel_hi:[1,0]
v_cvt_pk_bf16_f32 v165, v94, v95
v_pk_mul_f32 v[108:109], v[108:109], v[76:77] op_sel_hi:[1,0]
v_cvt_pk_bf16_f32 v166, v108, v109
v_pk_mul_f32 v[110:111], v[110:111], v[76:77] op_sel_hi:[1,0]
v_cvt_pk_bf16_f32 v167, v110, v111
buffer_store_dwordx4 v[164:167], v4, s[16:19], s74 offen sc1
s_nop 1
s_branch .Lqkve56
.Lsp50:
s_mov_b32 s15, 0
.Lsp50l:
v_mov_b32 v25, 0
buffer_atomic_add v25, v22, s[16:19], s73 offen sc0
s_add_u32 s15, s15, 1
s_cmp_gt_u32 s15, 100000
s_waitcnt vmcnt(0)
s_cbranch_scc1 .Lsp50b
v_cmp_gt_u32 vcc, v23, v25
s_nop 0
s_cbranch_vccnz .Lsp50l
s_branch .Lsp50b
.Lxs51:
s_mov_b32 s15, 0
.Lxs51l:
v_mov_b32 v15, 0
buffer_atomic_add v15, v12, s[16:19], s70 offen sc0
s_add_u32 s15, s15, 1
s_cmp_gt_u32 s15, 100000
s_waitcnt vmcnt(0)
s_cbranch_scc1 .Lxs51b
v_cmp_ne_u32 vcc, 0, v15
s_nop 0
s_cbranch_vccz .Lxs51l
s_branch .Lxs51b
.p2align 12
.Lqkv55:
.Lpad26:
s_cbranch_execz .Lpad29
s_add_u32 m0, s55, 36864
s_nop 0
buffer_load_dwordx4 v21, s[16:19], s52 offen sc1 lds
buffer_load_dwordx4 v21, s[16:19], s52 offen offset:1024 sc1 lds
buffer_load_dword v22, s[16:19], s52 offen offset:2048 sc1 lds
s_add_u32 s52, s52, 131072
s_add_u32 m0, s55, 46080
s_nop 0
buffer_load_dwordx4 v21, s[16:19], s52 offen sc1 lds
buffer_load_dwordx4 v21, s[16:19], s52 offen offset:1024 sc1 lds
buffer_load_dword v22, s[16:19], s52 offen offset:2048 sc1 lds
s_add_u32 s52, s52, 131072
s_add_u32 m0, s55, 0
s_nop 0
buffer_load_dwordx4 v21, s[16:19], s52 offen sc1 lds
buffer_load_dwordx4 v21, s[16:19], s52 offen offset:1024 sc1 lds
buffer_load_dword v22, s[16:19], s52 offen offset:2048 sc1 lds
s_add_u32 s52, s52, 131072
s_add_u32 m0, s55, 9216
s_nop 0
buffer_load_dwordx4 v21, s[16:19], s52 offen sc1 lds
buffer_load_dwordx4 v21, s[16:19], s52 offen offset:1024 sc1 lds
buffer_load_dword v22, s[16:19], s52 offen offset:2048 sc1 lds
s_add_u32 s52, s52, 131072
s_add_u32 m0, s55, 18432
s_nop 0
buffer_load_dwordx4 v21, s[16:19], s52 offen sc1 lds
buffer_load_dwordx4 v21, s[16:19], s52 offen offset:1024 sc1 lds
buffer_load_dword v22, s[16:19], s52 offen offset:2048 sc1 lds
s_add_u32 s52, s52, 131072
s_add_u32 m0, s55, 27648
s_nop 0
buffer_load_dwordx4 v21, s[16:19], s52 offen sc1 lds
buffer_load_dwordx4 v21, s[16:19], s52 offen offset:1024 sc1 lds
buffer_load_dword v22, s[16:19], s52 offen offset:2048 sc1 lds
s_add_u32 s52, s52, 131072
s_waitcnt vmcnt(12)
s_barrier
RD 0,23,36864
RD 4,23,37888
RD 8,23,39168
RD 12,23,40192
RD 16,24,38912
RD 20,23,46080
RD 24,23,47104
RD 28,23,48384
RD 32,23,49408
RD 36,24,48128
s_waitcnt lgkmcnt(0)
s_mov_b32 s15, -2
.p2align 6
.Lk58:
s_waitcnt vmcnt(9) lgkmcnt(8)
s_barrier
MAA 60,80,0
TR 104,25,49696
s_add_u32 m0, s56, 104832
MAA 60,84,20
buffer_load_dwordx4 v18, s[20:23], s54 offen lds
MAA 64,84,24
TR 106,25,50208
v_add_f32 v164, v164, v168
MAA 64,80,4
TR 108,25,62112
MAA 68,80,8
TR 110,25,62624
MAA 68,84,28
buffer_load_dwordx4 v19, s[20:23], s54 offen offset:1024 lds
MAA 72,84,32
TR 112,25,50720
v_add_f32 v165, v165, v169
MAA 72,80,12
TR 114,25,51232
s_waitcnt lgkmcnt(6)
MAA 104,88,12
TR 116,25,63136
MAA 104,92,32
buffer_load_dwordx4 v20, s[20:23], s54 offen offset:2048 lds
MAA 100,92,28
s_add_u32 s54, s54, 196608
s_add_u32 m0, s55, 36864
MAA 100,88,8
buffer_load_dwordx4 v21, s[16:19], s52 offen sc1 lds
MAA 96,88,4
TR 118,25,63648
MAA 96,92,24
TR 120,25,51744
v_add_f32 v166, v166, v170
MAA 92,92,20
TR 122,25,52256
MAA 92,88,0
buffer_load_dwordx4 v21, s[16:19], s52 offen offset:1024 sc1 lds
MAA 124,0,96
TR 124,25,64160
MAA 124,20,100
TR 126,25,64672
v_add_f32 v167, v167, v171
MAA 128,24,100
ds_read_b128 a[40:43], v23
MAA 128,4,96
buffer_load_dword v22, s[16:19], s52 offen offset:2048 sc1 lds
MAA 132,8,96
RD 44,23,1024
s_add_u32 s52, s52, 131072
MAA 132,28,100
buffer_load_dword v27, v14, s[20:23], s44 offen
MAA 136,32,100
RD 48,23,2304
s_add_u32 s44, s44, 1572864
MAA 136,12,96
RD 52,23,3328
MAA 156,16,96
RD 56,24,2048
MAA 156,36,100
s_waitcnt vmcnt(13) lgkmcnt(5)
s_barrier
MAA 76,104,0
RD 60,23,9216
s_add_u32 m0, s56, 117248
MAA 76,108,20
buffer_load_dwordx4 v18, s[20:23], s54 offen lds
MAA 80,108,24
RD 64,23,10240
MAA 80,104,4
RD 68,23,11520
MAA 84,104,8
RD 72,23,12544
MAA 84,108,28
buffer_load_dwordx4 v19, s[20:23], s54 offen offset:1024 lds
MAA 88,108,32
RD 76,24,11264
MAA 88,104,12
buffer_load_dwordx4 v20, s[20:23], s54 offen offset:2048 lds
MAA 120,112,12
ds_read_b64_tr_b16 a[80:81], v25
s_add_u32 s54, s54, 196608
MAA 120,116,32
TR 82,25,512
MAA 116,116,28
TR 84,25,12416
s_add_u32 m0, s55, 46080
MAA 116,112,8
buffer_load_dwordx4 v21, s[16:19], s52 offen sc1 lds
MAA 112,112,4
TR 86,25,12928
MAA 112,116,24
TR 88,25,1024
MAA 108,116,20
TR 90,25,1536
MAA 108,112,0
buffer_load_dwordx4 v21, s[16:19], s52 offen offset:1024 sc1 lds
MAA 140,0,120
TR 92,25,13440
MAA 140,20,124
TR 94,25,13952
MAA 144,24,124
TR 96,25,2048
MAA 144,4,120
buffer_load_dword v22, s[16:19], s52 offen offset:2048 sc1 lds
MAA 148,8,120
TR 98,25,2560
s_add_u32 s52, s52, 131072
MAA 148,28,124
buffer_load_dwordx4 v[168:171], v26, s[16:19], s75 offen sc1
MAA 152,32,124
TR 100,25,14464
MAA 152,12,120
TR 102,25,14976
MAA 160,16,120
MAA 160,36,124
s_waitcnt vmcnt(17) lgkmcnt(8)
s_barrier
MAA 60,80,40
TR 104,25,32
v_add_f32 v164, v164, v172
MAA 60,84,60
TR 106,25,544
MAA 64,84,64
TR 108,25,12448
s_add_u32 m0, s56, 129664
MAA 64,80,44
buffer_load_dwordx4 v18, s[20:23], s54 offen lds
MAA 68,80,48
TR 110,25,12960
MAA 68,84,68
TR 112,25,1056
MAA 72,84,72
TR 114,25,1568
v_add_f32 v165, v165, v173
MAA 72,80,52
TR 116,25,13472
s_waitcnt lgkmcnt(7)
MAA 104,88,52
TR 118,25,13984
MAA 104,92,72
buffer_load_dwordx4 v19, s[20:23], s54 offen offset:1024 lds
MAA 100,92,68
TR 120,25,2080
MAA 100,88,48
buffer_load_dwordx4 v20, s[20:23], s54 offen offset:2048 lds
MAA 96,88,44
s_add_u32 s54, s54, 196608
MAA 96,92,64
TR 122,25,2592
v_add_f32 v166, v166, v174
MAA 92,92,60
TR 124,25,14496
s_add_u32 m0, s55, 0
MAA 92,88,40
buffer_load_dwordx4 v21, s[16:19], s52 offen sc1 lds
MAA 124,40,96
TR 126,25,15008
MAA 124,60,100
RD 0,23,18432
MAA 128,64,100
RD 4,23,19456
MAA 128,44,96
buffer_load_dwordx4 v21, s[16:19], s52 offen offset:1024 sc1 lds
MAA 132,48,96
RD 8,23,20736
v_add_f32 v167, v167, v175
MAA 132,68,100
RD 12,23,21760
MAA 136,72,100
RD 16,24,20480
MAA 136,52,96
buffer_load_dword v22, s[16:19], s52 offen offset:2048 sc1 lds
MAA 156,56,96
s_add_u32 s52, s52, 131072
MAA 156,76,100
s_waitcnt vmcnt(17) lgkmcnt(5)
s_barrier
MAA 76,104,40
RD 20,23,27648
s_add_u32 m0, s56, 67584
MAA 76,108,60
buffer_load_dwordx4 v18, s[20:23], s54 offen lds
MAA 80,108,64
RD 24,23,28672
MAA 80,104,44
RD 28,23,29952
MAA 84,104,48
RD 32,23,30976
MAA 84,108,68
buffer_load_dwordx4 v19, s[20:23], s54 offen offset:1024 lds
MAA 88,108,72
RD 36,24,29696
MAA 88,104,52
buffer_load_dwordx4 v20, s[20:23], s54 offen offset:2048 lds
MAA 120,112,52
TR 80,25,24832
s_add_u32 s54, s54, 196608
MAA 120,116,72
TR 82,25,25344
MAA 116,116,68
TR 84,25,37248
s_add_u32 m0, s55, 9216
MAA 116,112,48
buffer_load_dwordx4 v21, s[16:19], s52 offen sc1 lds
MAA 112,112,44
TR 86,25,37760
MAA 112,116,64
TR 88,25,25856
MAA 108,116,60
TR 90,25,26368
MAA 108,112,40
buffer_load_dwordx4 v21, s[16:19], s52 offen offset:1024 sc1 lds
MAA 140,40,120
TR 92,25,38272
MAA 140,60,124
TR 94,25,38784
MAA 144,64,124
TR 96,25,26880
MAA 144,44,120
buffer_load_dword v22, s[16:19], s52 offen offset:2048 sc1 lds
MAA 148,48,120
TR 98,25,27392
s_add_u32 s52, s52, 131072
MAA 148,68,124
buffer_load_dwordx4 v[172:175], v26, s[16:19], s75 offen offset:1024 sc1
MAA 152,72,124
TR 100,25,39296
s_add_u32 s75, s75, 2048
MAA 152,52,120
TR 102,25,39808
MAA 160,56,120
MAA 160,76,124
s_waitcnt vmcnt(21) lgkmcnt(8)
s_barrier
MAA 60,80,0
TR 104,25,24864
MAA 60,84,20
TR 106,25,25376
MAA 64,84,24
TR 108,25,37280
s_add_u32 m0, s56, 80000
MAA 64,80,4
buffer_load_dwordx4 v18, s[20:23], s54 offen lds
MAA 68,80,8
TR 110,25,37792
MAA 68,84,28
TR 112,25,25888
MAA 72,84,32
TR 114,25,26400
MAA 72,80,12
TR 116,25,38304
s_waitcnt lgkmcnt(7)
MAA 104,88,12
TR 118,25,38816
MAA 104,92,32
buffer_load_dwordx4 v19, s[20:23], s54 offen offset:1024 lds
MAA 100,92,28
TR 120,25,26912
MAA 100,88,8
buffer_load_dwordx4 v20, s[20:23], s54 offen offset:2048 lds
MAA 96,88,4
s_add_u32 s54, s54, 196608
MAA 96,92,24
TR 122,25,27424
MAA 92,92,20
TR 124,25,39328
s_add_u32 m0, s55, 18432
MAA 92,88,0
buffer_load_dwordx4 v21, s[16:19], s52 offen sc1 lds
MAA 124,0,96
TR 126,25,39840
MAA 124,20,100
RD 40,23,36864
MAA 128,24,100
RD 44,23,37888
MAA 128,4,96
buffer_load_dwordx4 v21, s[16:19], s52 offen offset:1024 sc1 lds
MAA 132,8,96
RD 48,23,39168
MAA 132,28,100
RD 52,23,40192
MAA 136,32,100
RD 56,24,38912
MAA 136,12,96
buffer_load_dword v22, s[16:19], s52 offen offset:2048 sc1 lds
MAA 156,16,96
s_add_u32 s52, s52, 131072
MAA 156,36,100
s_waitcnt vmcnt(16) lgkmcnt(5)
s_barrier
MAA 76,104,0
RD 60,23,46080
MAA 76,108,20
RD 64,23,47104
MAA 80,108,24
RD 68,23,48384
s_add_u32 m0, s56, 92416
MAA 80,104,4
buffer_load_dwordx4 v18, s[20:23], s54 offen lds
MAA 84,104,8
RD 72,23,49408
MAA 84,108,28
RD 76,24,48128
MAA 88,108,32
TR 80,25,49664
MAA 88,104,12
buffer_load_dwordx4 v19, s[20:23], s54 offen offset:1024 lds
MAA 120,112,12
TR 82,25,50176
MAA 120,116,32
TR 84,25,62080
MAA 116,116,28
TR 86,25,62592
MAA 116,112,8
buffer_load_dwordx4 v20, s[20:23], s54 offen offset:2048 lds
MAA 112,112,4
s_add_u32 s54, s54, 196608
MAA 112,116,24
TR 88,25,50688
MAA 108,116,20
TR 90,25,51200
s_add_u32 m0, s55, 27648
MAA 108,112,0
buffer_load_dwordx4 v21, s[16:19], s52 offen sc1 lds
MAA 140,0,120
TR 92,25,63104
MAA 140,20,124
TR 94,25,63616
MAA 144,24,124
TR 96,25,51712
MAA 144,4,120
buffer_load_dwordx4 v21, s[16:19], s52 offen offset:1024 sc1 lds
MAA 148,8,120
TR 98,25,52224
MAA 148,28,124
TR 100,25,64128
MAA 152,32,124
TR 102,25,64640
MAA 152,12,120
buffer_load_dword v22, s[16:19], s52 offen offset:2048 sc1 lds
MAA 160,16,120
s_add_u32 s52, s52, 131072
MAA 160,36,124
s_waitcnt vmcnt(19) lgkmcnt(8)
s_barrier
MAA 60,80,40
TR 104,25,49696
s_add_u32 m0, s56, 104832
MAA 60,84,60
buffer_load_dwordx4 v18, s[20:23], s54 offen lds
MAA 64,84,64
TR 106,25,50208
v_add_f32 v164, v164, v168
MAA 64,80,44
TR 108,25,62112
MAA 68,80,48
TR 110,25,62624
MAA 68,84,68
buffer_load_dwordx4 v19, s[20:23], s54 offen offset:1024 lds
MAA 72,84,72
TR 112,25,50720
v_add_f32 v165, v165, v169
MAA 72,80,52
TR 114,25,51232
s_waitcnt lgkmcnt(6)
MAA 104,88,52
TR 116,25,63136
MAA 104,92,72
buffer_load_dwordx4 v20, s[20:23], s54 offen offset:2048 lds
MAA 100,92,68
s_add_u32 s54, s54, 196608
s_add_u32 m0, s55, 36864
MAA 100,88,48
buffer_load_dwordx4 v21, s[16:19], s52 offen sc1 lds
MAA 96,88,44
TR 118,25,63648
MAA 96,92,64
TR 120,25,51744
v_add_f32 v166, v166, v170
MAA 92,92,60
TR 122,25,52256
MAA 92,88,40
buffer_load_dwordx4 v21, s[16:19], s52 offen offset:1024 sc1 lds
MAA 124,40,96
TR 124,25,64160
MAA 124,60,100
TR 126,25,64672
v_add_f32 v167, v167, v171
MAA 128,64,100
ds_read_b128 a[0:3], v23
MAA 128,44,96
buffer_load_dword v22, s[16:19], s52 offen offset:2048 sc1 lds
MAA 132,48,96
RD 4,23,1024
s_add_u32 s52, s52, 131072
MAA 132,68,100
buffer_load_dword v27, v14, s[20:23], s44 offen
MAA 136,72,100
RD 8,23,2304
s_add_u32 s44, s44, 1572864
MAA 136,52,96
RD 12,23,3328
MAA 156,56,96
RD 16,24,2048
MAA 156,76,100
s_waitcnt vmcnt(16) lgkmcnt(5)
s_barrier
MAA 76,104,40
RD 20,23,9216
s_add_u32 m0, s56, 117248
MAA 76,108,60
buffer_load_dwordx4 v18, s[20:23], s54 offen lds
MAA 80,108,64
RD 24,23,10240
MAA 80,104,44
RD 28,23,11520
MAA 84,104,48
RD 32,23,12544
MAA 84,108,68
buffer_load_dwordx4 v19, s[20:23], s54 offen offset:1024 lds
MAA 88,108,72
RD 36,24,11264
MAA 88,104,52
buffer_load_dwordx4 v20, s[20:23], s54 offen offset:2048 lds
MAA 120,112,52
ds_read_b64_tr_b16 a[80:81], v25
s_add_u32 s54, s54, 196608
MAA 120,116,72
TR 82,25,512
MAA 116,116,68
TR 84,25,12416
s_add_u32 m0, s55, 46080
MAA 116,112,48
buffer_load_dwordx4 v21, s[16:19], s52 offen sc1 lds
MAA 112,112,44
TR 86,25,12928
MAA 112,116,64
TR 88,25,1024
MAA 108,116,60
TR 90,25,1536
MAA 108,112,40
buffer_load_dwordx4 v21, s[16:19], s52 offen offset:1024 sc1 lds
MAA 140,40,120
TR 92,25,13440
MAA 140,60,124
TR 94,25,13952
MAA 144,64,124
TR 96,25,2048
MAA 144,44,120
buffer_load_dword v22, s[16:19], s52 offen offset:2048 sc1 lds
MAA 148,48,120
TR 98,25,2560
s_add_u32 s52, s52, 131072
MAA 148,68,124
buffer_load_dwordx4 v[168:171], v26, s[16:19], s75 offen sc1
MAA 152,72,124
TR 100,25,14464
MAA 152,52,120
TR 102,25,14976
MAA 160,56,120
MAA 160,76,124
s_waitcnt vmcnt(20) lgkmcnt(8)
s_barrier
MAA 60,80,0
TR 104,25,32
v_add_f32 v164, v164, v172
MAA 60,84,20
TR 106,25,544
MAA 64,84,24
TR 108,25,12448
s_add_u32 m0, s56, 129664
MAA 64,80,4
buffer_load_dwordx4 v18, s[20:23], s54 offen lds
MAA 68,80,8
TR 110,25,12960
MAA 68,84,28
TR 112,25,1056
MAA 72,84,32
TR 114,25,1568
.Lpad27:
s_cbranch_execz .Lnopoll53r
v_add_f32 v165, v165, v173
MAA 72,80,12
TR 116,25,13472
s_waitcnt lgkmcnt(7)
MAA 104,88,12
TR 118,25,13984
MAA 104,92,32
buffer_load_dwordx4 v19, s[20:23], s54 offen offset:1024 lds
MAA 100,92,28
TR 120,25,2080
MAA 100,88,8
buffer_load_dwordx4 v20, s[20:23], s54 offen offset:2048 lds
MAA 96,88,4
s_add_u32 s54, s54, 196608
MAA 96,92,24
TR 122,25,2592
v_add_f32 v166, v166, v174
MAA 92,92,20
TR 124,25,14496
s_add_u32 m0, s55, 0
MAA 92,88,0
buffer_load_dwordx4 v21, s[16:19], s52 offen sc1 lds
MAA 124,0,96
TR 126,25,15008
MAA 124,20,100
RD 40,23,18432
MAA 128,24,100
RD 44,23,19456
MAA 128,4,96
buffer_load_dwordx4 v21, s[16:19], s52 offen offset:1024 sc1 lds
MAA 132,8,96
RD 48,23,20736
v_add_f32 v167, v167, v175
MAA 132,28,100
RD 52,23,21760
MAA 136,32,100
RD 56,24,20480
MAA 136,12,96
buffer_load_dword v22, s[16:19], s52 offen offset:2048 sc1 lds
MAA 156,16,96
s_add_u32 s52, s52, 131072
MAA 156,36,100
s_waitcnt vmcnt(17) lgkmcnt(5)
s_barrier
MAA 76,104,0
RD 60,23,27648
s_add_u32 m0, s56, 67584
MAA 76,108,20
buffer_load_dwordx4 v18, s[20:23], s54 offen lds
MAA 80,108,24
RD 64,23,28672
MAA 80,104,4
RD 68,23,29952
MAA 84,104,8
RD 72,23,30976
MAA 84,108,28
buffer_load_dwordx4 v19, s[20:23], s54 offen offset:1024 lds
MAA 88,108,32
RD 76,24,29696
MAA 88,104,12
buffer_load_dwordx4 v20, s[20:23], s54 offen offset:2048 lds
MAA 120,112,12
TR 80,25,24832
s_add_u32 s54, s54, 196608
MAA 120,116,32
TR 82,25,25344
MAA 116,116,28
TR 84,25,37248
s_add_u32 m0, s55, 9216
MAA 116,112,8
buffer_load_dwordx4 v21, s[16:19], s52 offen sc1 lds
MAA 112,112,4
TR 86,25,37760
MAA 112,116,24
TR 88,25,25856
MAA 108,116,20
TR 90,25,26368
MAA 108,112,0
buffer_load_dwordx4 v21, s[16:19], s52 offen offset:1024 sc1 lds
MAA 140,0,120
TR 92,25,38272
MAA 140,20,124
TR 94,25,38784
MAA 144,24,124
TR 96,25,26880
MAA 144,4,120
buffer_load_dword v22, s[16:19], s52 offen offset:2048 sc1 lds
MAA 148,8,120
TR 98,25,27392
s_add_u32 s52, s52, 131072
MAA 148,28,124
buffer_load_dwordx4 v[172:175], v26, s[16:19], s75 offen offset:1024 sc1
MAA 152,32,124
TR 100,25,39296
s_add_u32 s75, s75, 2048
MAA 152,12,120
TR 102,25,39808
MAA 160,16,120
MAA 160,36,124
s_waitcnt vmcnt(21) lgkmcnt(8)
s_barrier
MAA 60,80,40
TR 104,25,24864
MAA 60,84,60
TR 106,25,25376
MAA 64,84,64
TR 108,25,37280
s_add_u32 m0, s56, 80000
MAA 64,80,44
buffer_load_dwordx4 v18, s[20:23], s54 offen lds
MAA 68,80,48
TR 110,25,37792
MAA 68,84,68
TR 112,25,25888
MAA 72,84,72
TR 114,25,26400
MAA 72,80,52
TR 116,25,38304
s_waitcnt lgkmcnt(7)
MAA 104,88,52
TR 118,25,38816
MAA 104,92,72
buffer_load_dwordx4 v19, s[20:23], s54 offen offset:1024 lds
MAA 100,92,68
TR 120,25,26912
MAA 100,88,48
buffer_load_dwordx4 v20, s[20:23], s54 offen offset:2048 lds
MAA 96,88,44
s_add_u32 s54, s54, 196608
MAA 96,92,64
TR 122,25,27424
MAA 92,92,60
TR 124,25,39328
s_add_u32 m0, s55, 18432
MAA 92,88,40
buffer_load_dwordx4 v21, s[16:19], s52 offen sc1 lds
MAA 124,40,96
TR 126,25,39840
MAA 124,60,100
RD 0,23,36864
MAA 128,64,100
RD 4,23,37888
MAA 128,44,96
buffer_load_dwordx4 v21, s[16:19], s52 offen offset:1024 sc1 lds
MAA 132,48,96
RD 8,23,39168
MAA 132,68,100
RD 12,23,40192
MAA 136,72,100
RD 16,24,38912
MAA 136,52,96
buffer_load_dword v22, s[16:19], s52 offen offset:2048 sc1 lds
MAA 156,56,96
s_add_u32 s52, s52, 131072
MAA 156,76,100
s_waitcnt vmcnt(16) lgkmcnt(5)
s_barrier
MAA 76,104,40
RD 20,23,46080
MAA 76,108,60
RD 24,23,47104
MAA 80,108,64
RD 28,23,48384
s_add_u32 m0, s56, 92416
MAA 80,104,44
buffer_load_dwordx4 v18, s[20:23], s54 offen lds
MAA 84,104,48
RD 32,23,49408
MAA 84,108,68
RD 36,24,48128
MAA 88,108,72
TR 80,25,49664
MAA 88,104,52
buffer_load_dwordx4 v19, s[20:23], s54 offen offset:1024 lds
MAA 120,112,52
TR 82,25,50176
MAA 120,116,72
TR 84,25,62080
MAA 116,116,68
TR 86,25,62592
MAA 116,112,48
buffer_load_dwordx4 v20, s[20:23], s54 offen offset:2048 lds
MAA 112,112,44
s_add_u32 s54, s54, 196608
MAA 112,116,64
TR 88,25,50688
MAA 108,116,60
TR 90,25,51200
s_add_u32 m0, s55, 27648
MAA 108,112,40
buffer_load_dwordx4 v21, s[16:19], s52 offen sc1 lds
MAA 140,40,120
TR 92,25,63104
MAA 140,60,124
TR 94,25,63616
MAA 144,64,124
TR 96,25,51712
MAA 144,44,120
buffer_load_dwordx4 v21, s[16:19], s52 offen offset:1024 sc1 lds
MAA 148,48,120
TR 98,25,52224
MAA 148,68,124
TR 100,25,64128
MAA 152,72,124
TR 102,25,64640
MAA 152,52,120
buffer_load_dword v22, s[16:19], s52 offen offset:2048 sc1 lds
MAA 160,56,120
s_add_u32 s52, s52, 131072
s_add_u32 s15, s15, 1
MAA 160,76,124
s_cbranch_scc0 .Lk58
s_waitcnt vmcnt(19) lgkmcnt(8)
s_barrier
MAA 60,80,0
TR 104,25,49696
v_add_f32 v164, v164, v168
MAA 60,84,20
TR 106,25,50208
s_add_u32 m0, s56, 104832
MAA 64,84,24
buffer_load_dwordx4 v18, s[20:23], s54 offen lds
MAA 64,80,4
TR 108,25,62112
v_add_f32 v165, v165, v169
MAA 68,80,8
TR 110,25,62624
v_add_f32 v166, v166, v170
MAA 68,84,28
TR 112,25,50720
v_add_f32 v167, v167, v171
MAA 72,84,32
buffer_load_dwordx4 v19, s[20:23], s54 offen offset:1024 lds
MAA 72,80,12
TR 114,25,51232
s_waitcnt lgkmcnt(6)
MAA 104,88,12
TR 116,25,63136
MAA 104,92,32
TR 118,25,63648
MAA 100,92,28
buffer_load_dwordx4 v20, s[20:23], s54 offen offset:2048 lds
MAA 100,88,8
TR 120,25,51744
s_add_u32 s54, s54, 196608
MAA 96,88,4
TR 122,25,52256
s_add_u32 m0, s55, 36864
MAA 96,92,24
TR 124,25,64160
MAA 92,92,20
buffer_load_dwordx4 v21, s[16:19], s52 offen sc1 lds
MAA 92,88,0
TR 126,25,64672
MAA 124,0,96
ds_read_b128 a[40:43], v23
MAA 124,20,100
RD 44,23,1024
MAA 128,24,100
buffer_load_dwordx4 v21, s[16:19], s52 offen offset:1024 sc1 lds
MAA 128,4,96
RD 48,23,2304
MAA 132,8,96
RD 52,23,3328
MAA 132,28,100
RD 56,24,2048
MAA 136,32,100
buffer_load_dword v22, s[16:19], s52 offen offset:2048 sc1 lds
MAA 136,12,96
s_add_u32 s52, s52, 131072
MAA 156,16,96
MAA 156,36,100
s_waitcnt vmcnt(15) lgkmcnt(5)
s_barrier
MAA 76,104,0
RD 60,23,9216
v_add_f32 v164, v164, v172
MAA 76,108,20
RD 64,23,10240
s_add_u32 m0, s56, 117248
MAA 80,108,24
buffer_load_dwordx4 v18, s[20:23], s54 offen lds
MAA 80,104,4
RD 68,23,11520
v_add_f32 v165, v165, v173
MAA 84,104,8
RD 72,23,12544
v_add_f32 v166, v166, v174
MAA 84,108,28
RD 76,24,11264
v_add_f32 v167, v167, v175
MAA 88,108,32
buffer_load_dwordx4 v19, s[20:23], s54 offen offset:1024 lds
MAA 88,104,12
ds_read_b64_tr_b16 a[80:81], v25
MAA 120,112,12
TR 82,25,512
MAA 120,116,32
TR 84,25,12416
MAA 116,116,28
buffer_load_dwordx4 v20, s[20:23], s54 offen offset:2048 lds
MAA 116,112,8
TR 86,25,12928
s_add_u32 s54, s54, 196608
MAA 112,112,4
TR 88,25,1024
s_add_u32 m0, s55, 46080
MAA 112,116,24
TR 90,25,1536
MAA 108,116,20
buffer_load_dwordx4 v21, s[16:19], s52 offen sc1 lds
MAA 108,112,0
TR 92,25,13440
MAA 140,0,120
TR 94,25,13952
MAA 140,20,124
TR 96,25,2048
MAA 144,24,124
buffer_load_dwordx4 v21, s[16:19], s52 offen offset:1024 sc1 lds
MAA 144,4,120
TR 98,25,2560
MAA 148,8,120
TR 100,25,14464
MAA 148,28,124
TR 102,25,14976
MAA 152,32,124
buffer_load_dword v22, s[16:19], s52 offen offset:2048 sc1 lds
MAA 152,12,120
s_add_u32 s52, s52, 131072
v_permlane32_swap_b32 v164, v166
MAA 160,16,120
v_permlane32_swap_b32 v165, v167
MAA 160,36,124
s_waitcnt vmcnt(18) lgkmcnt(8)
s_barrier
MAA 60,80,40
TR 104,25,32
v_add_f32 v164, v164, v166
MAA 60,84,60
TR 106,25,544
s_add_u32 m0, s56, 129664
MAA 64,84,64
buffer_load_dwordx4 v18, s[20:23], s54 offen lds
MAA 64,80,44
TR 108,25,12448
v_add_f32 v165, v165, v167
MAA 68,80,48
TR 110,25,12960
v_mul_f32 v164, 0xba800000, v164
MAA 68,84,68
buffer_load_dwordx4 v19, s[20:23], s54 offen offset:1024 lds
MAA 72,84,72
TR 112,25,1056
v_mul_f32 v165, 0x3a800000, v165
MAA 72,80,52
TR 114,25,1568
v_fma_f32 v165, -v164, v164, v165
s_waitcnt lgkmcnt(6)
MAA 104,88,52
buffer_load_dwordx4 v20, s[20:23], s54 offen offset:2048 lds
MAA 104,92,72
TR 116,25,13472
s_add_u32 s54, s54, 196608
MAA 100,92,68
TR 118,25,13984
s_add_u32 m0, s59, 58240
MAA 100,88,48
TR 120,25,2080
s_xor_b32 s58, s87, 1966080
MAA 96,88,44
buffer_load_dwordx4 v5, s[24:27], s58 offen lds
MAA 96,92,64
TR 122,25,2592
v_max_f32 v165, 0, v165
MAA 92,92,60
TR 124,25,14496
v_add_f32 v165, 0x3727c5ac, v165
MAA 92,88,40
buffer_load_dwordx4 v6, s[24:27], s58 offen offset:1024 lds
MAA 124,40,96
TR 126,25,15008
s_add_u32 m0, s59, 0
MAA 124,60,100
RD 0,23,18432
s_xor_b32 s58, s87, 1048576
MAA 128,64,100
buffer_load_dwordx4 v5, s[24:27], s58 offen lds
MAA 128,44,96
RD 4,23,19456
MAA 132,48,96
RD 8,23,20736
MAA 132,68,100
buffer_load_dwordx4 v6, s[24:27], s58 offen offset:1024 lds
MAA 136,72,100
RD 12,23,21760
MAA 136,52,96
RD 16,24,20480
MAA 156,56,96
v_rsq_f32 v166, v165
MAA 156,76,100
v_mov_b32 v165, v166
v_mul_f32 v166, 0x3e8293ee, v166
ds_write_b128 v7, v[164:167]
s_waitcnt vmcnt(16) lgkmcnt(6)
s_barrier
MAA 76,104,40
ds_write_b32 v17, v164
MAA 76,108,60
ds_write_b32 v17, v165 offset:1024
s_add_u32 m0, s59, 8320
MAA 80,108,64
RD 20,23,27648
s_xor_b32 s58, s87, 1179648
MAA 80,104,44
buffer_load_dwordx4 v5, s[24:27], s58 offen lds
MAA 84,104,48
RD 24,23,28672
MAA 84,108,68
RD 28,23,29952
MAA 88,108,72
RD 32,23,30976
MAA 88,104,52
buffer_load_dwordx4 v6, s[24:27], s58 offen offset:1024 lds
MAA 120,112,52
RD 36,24,29696
s_add_u32 m0, s59, 66560
MAA 120,116,72
TR 80,25,24832
s_xor_b32 s58, s87, 0
MAA 116,116,68
TR 82,25,25344
MAA 116,112,48
buffer_load_dwordx4 v5, s[24:27], s58 offen lds
MAA 112,112,44
TR 84,25,37248
MAA 112,116,64
TR 86,25,37760
MAA 108,116,60
TR 88,25,25856
MAA 108,112,40
buffer_load_dwordx4 v6, s[24:27], s58 offen offset:1024 lds
MAA 140,40,120
TR 90,25,26368
s_add_u32 m0, s59, 74880
MAA 140,60,124
TR 92,25,38272
s_xor_b32 s58, s87, 131072
MAA 144,64,124
TR 94,25,38784
MAA 144,44,120
buffer_load_dwordx4 v5, s[24:27], s58 offen lds
MAA 148,48,120
TR 96,25,26880
MAA 148,68,124
TR 98,25,27392
MAA 152,72,124
TR 100,25,39296
MAA 152,52,120
buffer_load_dwordx4 v6, s[24:27], s58 offen offset:1024 lds
MAA 160,56,120
TR 102,25,39808
MAA 160,76,124
s_waitcnt vmcnt(10) lgkmcnt(0)
s_barrier
MAA 104,88,12
TR 112,25,25888
s_add_u32 m0, s59, 83200
MAA 104,92,32
TR 114,25,26400
s_xor_b32 s58, s87, 262144
MAA 100,92,28
buffer_load_dwordx4 v5, s[24:27], s58 offen lds
MAA 100,88,8
TR 116,25,38304
MAA 96,88,4
TR 118,25,38816
MAA 96,92,24
TR 120,25,26912
MAA 92,92,20
buffer_load_dwordx4 v6, s[24:27], s58 offen offset:1024 lds
MAA 92,88,0
TR 122,25,27424
s_add_u32 m0, s59, 16640
MAA 156,16,96
TR 124,25,39328
s_xor_b32 s58, s87, 1310720
MAA 156,36,100
TR 126,25,39840
MAA 72,84,32
buffer_load_dwordx4 v5, s[24:27], s58 offen lds
MAA 72,80,12
TR 104,25,24864
MAA 68,80,8
TR 106,25,25376
MAA 68,84,28
TR 108,25,37280
MAA 64,84,24
buffer_load_dwordx4 v6, s[24:27], s58 offen offset:1024 lds
MAA 64,80,4
TR 110,25,37792
s_add_u32 m0, s59, 24960
MAA 60,80,0
RD 40,23,36864
s_xor_b32 s58, s87, 1441792
MAA 60,84,20
RD 44,23,37888
s_waitcnt lgkmcnt(12)
MAA 120,112,12
buffer_load_dwordx4 v5, s[24:27], s58 offen lds
s_waitcnt lgkmcnt(10)
MAA 120,116,32
RD 48,23,39168
MAA 116,116,28
RD 52,23,40192
MAA 116,112,8
RD 56,24,38912
MAA 112,112,4
buffer_load_dwordx4 v6, s[24:27], s58 offen offset:1024 lds
MAA 112,116,24
s_waitcnt lgkmcnt(5)
s_barrier
RD 60,23,46080
MAA 108,116,20
RD 64,23,47104
s_add_u32 m0, s59, 91520
MAA 108,112,0
RD 68,23,48384
s_xor_b32 s58, s87, 393216
MAA 160,16,120
RD 72,23,49408
MAA 160,36,124
RD 76,24,48128
MAA 88,108,32
TR 144,25,50688
MAA 88,104,12
.Lpad28:
s_cbranch_execz .Lnopoll53r
TR 146,25,51200
MAA 84,104,8
TR 148,25,63104
MAA 84,108,28
TR 150,25,63616
MAA 80,108,24
TR 152,25,50720
MAA 80,104,4
TR 154,25,51232
MAA 76,104,0
TR 156,25,63136
MAA 76,108,20
TR 158,25,63648
TR 160,25,51712
TR 162,25,52224
TR 164,25,64128
s_waitcnt lgkmcnt(9)
MAA 104,144,52
TR 166,25,64640
TR 168,25,51744
TR 170,25,52256
s_waitcnt lgkmcnt(10)
MAA 104,148,72
TR 172,25,64160
MAA 100,148,68
TR 174,25,64672
MAA 100,144,48
TR 136,25,49696
MAA 96,144,44
TR 138,25,50208
MAA 96,148,64
TR 140,25,62112
MAA 92,148,60
TR 142,25,62624
MAA 92,144,40
TR 128,25,49664
s_waitcnt lgkmcnt(15)
MAA 120,152,52
TR 130,25,50176
s_waitcnt lgkmcnt(14)
MAA 120,156,72
TR 132,25,62080
MAA 116,156,68
TR 134,25,62592
MAA 116,152,48
ds_read_b128 v[232:235], v10 offset:1792
MAA 112,152,44
ds_read_b128 v[228:231], v10 offset:1536
MAA 112,156,64
ds_read_b128 v[224:227], v10 offset:1280
MAA 108,156,60
ds_read_b128 v[220:223], v10 offset:1024
MAA 108,152,40
buffer_load_dwordx4 v5, s[24:27], s58 offen lds
s_waitcnt lgkmcnt(15)
MAA 156,56,160
ds_read_b128 v[240:243], v11 offset:704
MAA 156,76,164
ds_read_b128 v[244:247], v11 offset:1728
s_waitcnt lgkmcnt(14)
MAA 160,76,172
s_waitcnt lgkmcnt(6)
s_barrier
ds_read_b128 v[18:21], v11 offset:448
MAA 160,56,168
buffer_load_dwordx4 v6, s[24:27], s58 offen offset:1024 lds
MAA 88,136,52
ds_read_b128 v[22:25], v11 offset:1472
s_add_u32 m0, s59, 99840
MAA 88,140,72
s_xor_b32 s58, s87, 524288
MAA 84,140,68
MAA 84,136,48
buffer_load_dwordx4 v5, s[24:27], s58 offen lds
MAA 80,136,44
MAA 80,140,64
MAA 76,140,60
MAA 76,136,40
buffer_load_dwordx4 v6, s[24:27], s58 offen offset:1024 lds
MAA 72,128,52
s_add_u32 m0, s59, 108160
s_xor_b32 s58, s87, 655360
MAA 72,132,72
MAA 68,132,68
MAA 68,128,48
buffer_load_dwordx4 v5, s[24:27], s58 offen lds
MAA 64,128,44
MAA 64,132,64
MAA 60,132,60
MAA 60,128,40
buffer_load_dwordx4 v6, s[24:27], s58 offen offset:1024 lds
s_waitcnt lgkmcnt(3)
v_pk_fma_f32 v[156:157], v[240:241], v[44:45], v[156:157] op_sel_hi:[1,0,1]
s_waitcnt lgkmcnt(2)
v_pk_mul_f32 v[156:157], v[156:157], v[244:245]
v_cvt_pk_bf16_f32 v236, v156, v157
v_pk_fma_f32 v[158:159], v[242:243], v[44:45], v[158:159] op_sel_hi:[1,0,1]
v_pk_mul_f32 v[158:159], v[158:159], v[246:247]
v_cvt_pk_bf16_f32 v237, v158, v159
v_pk_fma_f32 v[160:161], v[240:241], v[44:45], v[160:161] op_sel:[0,1,0] op_sel_hi:[1,1,1]
v_pk_mul_f32 v[160:161], v[160:161], v[244:245]
v_cvt_pk_bf16_f32 v238, v160, v161
v_pk_fma_f32 v[162:163], v[242:243], v[44:45], v[162:163] op_sel:[0,1,0] op_sel_hi:[1,1,1]
v_pk_mul_f32 v[162:163], v[162:163], v[246:247]
v_cvt_pk_bf16_f32 v239, v162, v163
ds_write_b128 v8, v[236:239] offset:1024
v_pk_fma_f32 v[104:105], v[36:37], v[232:233], v[104:105] op_sel_hi:[1,0,1]
v_pk_mul_f32 v[104:105], v[104:105], v[232:233] op_sel:[0,1] op_sel_hi:[1,1]
v_cvt_pk_bf16_f32 v196, v104, v105
v_pk_fma_f32 v[106:107], v[38:39], v[232:233], v[106:107] op_sel_hi:[1,0,1]
v_pk_mul_f32 v[106:107], v[106:107], v[232:233] op_sel:[0,1] op_sel_hi:[1,1]
v_cvt_pk_bf16_f32 v197, v106, v107
v_pk_fma_f32 v[120:121], v[40:41], v[232:233], v[120:121] op_sel_hi:[1,0,1]
v_pk_mul_f32 v[120:121], v[120:121], v[232:233] op_sel:[0,1] op_sel_hi:[1,1]
v_cvt_pk_bf16_f32 v198, v120, v121
v_pk_fma_f32 v[122:123], v[42:43], v[232:233], v[122:123] op_sel_hi:[1,0,1]
v_pk_mul_f32 v[122:123], v[122:123], v[232:233] op_sel:[0,1] op_sel_hi:[1,1]
v_cvt_pk_bf16_f32 v199, v122, v123
v_pk_fma_f32 v[100:101], v[36:37], v[228:229], v[100:101] op_sel_hi:[1,0,1]
v_pk_mul_f32 v[100:101], v[100:101], v[228:229] op_sel:[0,1] op_sel_hi:[1,1]
v_cvt_pk_bf16_f32 v192, v100, v101
v_pk_fma_f32 v[102:103], v[38:39], v[228:229], v[102:103] op_sel_hi:[1,0,1]
v_pk_mul_f32 v[102:103], v[102:103], v[228:229] op_sel:[0,1] op_sel_hi:[1,1]
v_cvt_pk_bf16_f32 v193, v102, v103
v_pk_fma_f32 v[116:117], v[40:41], v[228:229], v[116:117] op_sel_hi:[1,0,1]
v_pk_mul_f32 v[116:117], v[116:117], v[228:229] op_sel:[0,1] op_sel_hi:[1,1]
v_cvt_pk_bf16_f32 v194, v116, v117
v_pk_fma_f32 v[118:119], v[42:43], v[228:229], v[118:119] op_sel_hi:[1,0,1]
v_pk_mul_f32 v[118:119], v[118:119], v[228:229] op_sel:[0,1] op_sel_hi:[1,1]
v_cvt_pk_bf16_f32 v195, v118, v119
v_pk_fma_f32 v[96:97], v[36:37], v[224:225], v[96:97] op_sel_hi:[1,0,1]
v_pk_mul_f32 v[96:97], v[96:97], v[224:225] op_sel:[0,1] op_sel_hi:[1,1]
v_cvt_pk_bf16_f32 v188, v96, v97
v_pk_fma_f32 v[98:99], v[38:39], v[224:225], v[98:99] op_sel_hi:[1,0,1]
v_pk_mul_f32 v[98:99], v[98:99], v[224:225] op_sel:[0,1] op_sel_hi:[1,1]
v_cvt_pk_bf16_f32 v189, v98, v99
v_pk_fma_f32 v[112:113], v[40:41], v[224:225], v[112:113] op_sel_hi:[1,0,1]
v_pk_mul_f32 v[112:113], v[112:113], v[224:225] op_sel:[0,1] op_sel_hi:[1,1]
v_cvt_pk_bf16_f32 v190, v112, v113
v_pk_fma_f32 v[114:115], v[42:43], v[224:225], v[114:115] op_sel_hi:[1,0,1]
v_pk_mul_f32 v[114:115], v[114:115], v[224:225] op_sel:[0,1] op_sel_hi:[1,1]
v_cvt_pk_bf16_f32 v191, v114, v115
v_pk_fma_f32 v[92:93], v[36:37], v[220:221], v[92:93] op_sel_hi:[1,0,1]
v_pk_mul_f32 v[92:93], v[92:93], v[220:221] op_sel:[0,1] op_sel_hi:[1,1]
v_cvt_pk_bf16_f32 v184, v92, v93
v_pk_fma_f32 v[94:95], v[38:39], v[220:221], v[94:95] op_sel_hi:[1,0,1]
v_pk_mul_f32 v[94:95], v[94:95], v[220:221] op_sel:[0,1] op_sel_hi:[1,1]
v_cvt_pk_bf16_f32 v185, v94, v95
v_pk_fma_f32 v[108:109], v[40:41], v[220:221], v[108:109] op_sel_hi:[1,0,1]
v_pk_mul_f32 v[108:109], v[108:109], v[220:221] op_sel:[0,1] op_sel_hi:[1,1]
v_cvt_pk_bf16_f32 v186, v108, v109
v_pk_fma_f32 v[110:111], v[42:43], v[220:221], v[110:111] op_sel_hi:[1,0,1]
v_pk_mul_f32 v[110:111], v[110:111], v[220:221] op_sel:[0,1] op_sel_hi:[1,1]
v_cvt_pk_bf16_f32 v187, v110, v111
v_pk_fma_f32 v[72:73], v[28:29], v[232:233], v[72:73] op_sel_hi:[1,0,1]
v_cvt_pk_bf16_f32 v176, v72, v73
v_pk_fma_f32 v[74:75], v[30:31], v[232:233], v[74:75] op_sel_hi:[1,0,1]
v_cvt_pk_bf16_f32 v177, v74, v75
v_pk_fma_f32 v[88:89], v[32:33], v[232:233], v[88:89] op_sel_hi:[1,0,1]
v_cvt_pk_bf16_f32 v178, v88, v89
v_pk_fma_f32 v[90:91], v[34:35], v[232:233], v[90:91] op_sel_hi:[1,0,1]
v_cvt_pk_bf16_f32 v179, v90, v91
v_pk_fma_f32 v[68:69], v[28:29], v[228:229], v[68:69] op_sel_hi:[1,0,1]
v_cvt_pk_bf16_f32 v172, v68, v69
v_pk_fma_f32 v[70:71], v[30:31], v[228:229], v[70:71] op_sel_hi:[1,0,1]
v_cvt_pk_bf16_f32 v173, v70, v71
v_pk_fma_f32 v[84:85], v[32:33], v[228:229], v[84:85] op_sel_hi:[1,0,1]
v_cvt_pk_bf16_f32 v174, v84, v85
v_pk_fma_f32 v[86:87], v[34:35], v[228:229], v[86:87] op_sel_hi:[1,0,1]
v_cvt_pk_bf16_f32 v175, v86, v87
v_pk_fma_f32 v[64:65], v[28:29], v[224:225], v[64:65] op_sel_hi:[1,0,1]
v_cvt_pk_bf16_f32 v168, v64, v65
v_pk_fma_f32 v[66:67], v[30:31], v[224:225], v[66:67] op_sel_hi:[1,0,1]
v_cvt_pk_bf16_f32 v169, v66, v67
v_pk_fma_f32 v[80:81], v[32:33], v[224:225], v[80:81] op_sel_hi:[1,0,1]
v_cvt_pk_bf16_f32 v170, v80, v81
v_pk_fma_f32 v[82:83], v[34:35], v[224:225], v[82:83] op_sel_hi:[1,0,1]
v_cvt_pk_bf16_f32 v171, v82, v83
v_pk_fma_f32 v[60:61], v[28:29], v[220:221], v[60:61] op_sel_hi:[1,0,1]
v_cvt_pk_bf16_f32 v164, v60, v61
v_pk_fma_f32 v[62:63], v[30:31], v[220:221], v[62:63] op_sel_hi:[1,0,1]
v_cvt_pk_bf16_f32 v165, v62, v63
v_pk_fma_f32 v[76:77], v[32:33], v[220:221], v[76:77] op_sel_hi:[1,0,1]
v_cvt_pk_bf16_f32 v166, v76, v77
v_pk_fma_f32 v[78:79], v[34:35], v[220:221], v[78:79] op_sel_hi:[1,0,1]
s_waitcnt lgkmcnt(0)
s_barrier
v_cvt_pk_bf16_f32 v167, v78, v79
v_mfma_f32_16x16x32_bf16 v[120:123], v[196:199], v[176:179], v[50:53]
ds_read_b128 v[180:183], v9
s_add_u32 m0, s59, 33280
v_mfma_f32_16x16x32_bf16 v[104:107], v[192:195], v[176:179], v[46:49]
ds_read_b64 v[200:201], v9 offset:1024
s_xor_b32 s58, s87, 1572864
v_mfma_f32_16x16x32_bf16 v[116:119], v[192:195], v[172:175], v[50:53]
buffer_load_dwordx4 v5, s[24:27], s58 offen lds
v_mfma_f32_16x16x32_bf16 v[100:103], v[188:191], v[172:175], v[46:49]
ds_read_b64 v[210:211], v9 offset:1032
v_mfma_f32_16x16x32_bf16 v[112:115], v[188:191], v[168:171], v[50:53]
ds_read_b128 v[240:243], v11 offset:384
v_max3_f32 v88, v104, v105, v106
v_mfma_f32_16x16x32_bf16 v[96:99], v[184:187], v[168:171], v[46:49]
ds_read_b128 v[244:247], v11 offset:1408
v_max3_f32 v89, v107, v120, v121
v_mfma_f32_16x16x32_bf16 v[108:111], v[184:187], v[164:167], v[50:53]
buffer_load_dwordx4 v6, s[24:27], s58 offen offset:1024 lds
v_max3_f32 v88, v88, v122, v123
v_max_f32 v90, v88, v89
v_max_f32 v89, v88, v89
v_max3_f32 v84, v100, v101, v102
v_max3_f32 v85, v103, v116, v117
s_waitcnt lgkmcnt(4)
v_mfma_f32_16x16x32_bf16 v[92:95], v[180:183], v[164:167], v[46:49]
ds_read_b128 v[28:31], v11 offset:320
s_add_u32 m0, s59, 41600
MAA 136,12,96
ds_read_b128 v[32:35], v11 offset:1344
s_xor_b32 s58, s87, 1703936
MAA 136,32,100
buffer_load_dwordx4 v5, s[24:27], s58 offen lds
MAA 136,52,160
ds_read_b128 v[36:39], v11 offset:256
v_permlane16_swap_b32 v90, v89
MAA 136,72,164
ds_read_b128 v[40:43], v11 offset:1280
v_max_f32 v88, v90, v89
MAA 152,72,172
v_max_f32 v89, v90, v89
v_max3_f32 v84, v84, v118, v119
MAA 152,52,168
buffer_load_dwordx4 v6, s[24:27], s58 offen offset:1024 lds
MAA 152,32,124
s_add_u32 m0, s59, 49920
s_xor_b32 s58, s87, 1835008
v_permlane32_swap_b32 v88, v89
MAA 152,12,120
v_max_f32 v88, v88, v89
v_mul_f32 v88, v88, v234
v_max_f32 v86, v84, v85
v_max_f32 v85, v84, v85
v_max3_f32 v80, v96, v97, v98
v_max3_f32 v81, v99, v112, v113
v_permlane16_swap_b32 v86, v85
v_max3_f32 v80, v80, v114, v115
v_max_f32 v84, v86, v85
v_max_f32 v85, v86, v85
v_max_f32 v82, v80, v81
v_max_f32 v81, v80, v81
v_permlane32_swap_b32 v84, v85
v_max3_f32 v76, v92, v93, v94
v_max_f32 v84, v84, v85
v_mul_f32 v84, v84, v230
v_permlane16_swap_b32 v82, v81
v_max3_f32 v77, v95, v108, v109
v_max_f32 v80, v82, v81
v_max_f32 v81, v82, v81
v_max3_f32 v76, v76, v110, v111
v_max_f32 v78, v76, v77
v_permlane32_swap_b32 v80, v81
v_max_f32 v77, v76, v77
v_max_f32 v80, v80, v81
v_mul_f32 v80, v80, v226
v_permlane16_swap_b32 v78, v77
v_pk_fma_f32 v[104:105], v[104:105], v[234:235], v[88:89] op_sel_hi:[1,0,0] neg_lo:[0,0,1] neg_hi:[0,0,1]
v_max_f32 v76, v78, v77
v_max_f32 v77, v78, v77
v_pk_fma_f32 v[106:107], v[106:107], v[234:235], v[88:89] op_sel_hi:[1,0,0] neg_lo:[0,0,1] neg_hi:[0,0,1]
v_pk_fma_f32 v[120:121], v[120:121], v[234:235], v[88:89] op_sel_hi:[1,0,0] neg_lo:[0,0,1] neg_hi:[0,0,1]
v_permlane32_swap_b32 v76, v77
v_pk_fma_f32 v[122:123], v[122:123], v[234:235], v[88:89] op_sel_hi:[1,0,0] neg_lo:[0,0,1] neg_hi:[0,0,1]
v_max_f32 v76, v76, v77
v_mul_f32 v76, v76, v222
v_pk_fma_f32 v[100:101], v[100:101], v[230:231], v[84:85] op_sel_hi:[1,0,0] neg_lo:[0,0,1] neg_hi:[0,0,1]
v_pk_fma_f32 v[102:103], v[102:103], v[230:231], v[84:85] op_sel_hi:[1,0,0] neg_lo:[0,0,1] neg_hi:[0,0,1]
v_pk_fma_f32 v[116:117], v[116:117], v[230:231], v[84:85] op_sel_hi:[1,0,0] neg_lo:[0,0,1] neg_hi:[0,0,1]
v_pk_fma_f32 v[118:119], v[118:119], v[230:231], v[84:85] op_sel_hi:[1,0,0] neg_lo:[0,0,1] neg_hi:[0,0,1]
v_pk_fma_f32 v[96:97], v[96:97], v[226:227], v[80:81] op_sel_hi:[1,0,0] neg_lo:[0,0,1] neg_hi:[0,0,1]
v_pk_fma_f32 v[98:99], v[98:99], v[226:227], v[80:81] op_sel_hi:[1,0,0] neg_lo:[0,0,1] neg_hi:[0,0,1]
v_pk_fma_f32 v[112:113], v[112:113], v[226:227], v[80:81] op_sel_hi:[1,0,0] neg_lo:[0,0,1] neg_hi:[0,0,1]
v_pk_fma_f32 v[114:115], v[114:115], v[226:227], v[80:81] op_sel_hi:[1,0,0] neg_lo:[0,0,1] neg_hi:[0,0,1]
v_pk_fma_f32 v[92:93], v[92:93], v[222:223], v[76:77] op_sel_hi:[1,0,0] neg_lo:[0,0,1] neg_hi:[0,0,1]
v_pk_fma_f32 v[94:95], v[94:95], v[222:223], v[76:77] op_sel_hi:[1,0,0] neg_lo:[0,0,1] neg_hi:[0,0,1]
v_pk_fma_f32 v[108:109], v[108:109], v[222:223], v[76:77] op_sel_hi:[1,0,0] neg_lo:[0,0,1] neg_hi:[0,0,1]
v_pk_fma_f32 v[110:111], v[110:111], v[222:223], v[76:77] op_sel_hi:[1,0,0] neg_lo:[0,0,1] neg_hi:[0,0,1]
v_pk_fma_f32 v[136:137], v[18:19], v[44:45], v[136:137] op_sel_hi:[1,0,1]
v_pk_mul_f32 v[136:137], v[136:137], v[22:23]
v_pk_fma_f32 v[138:139], v[20:21], v[44:45], v[138:139] op_sel_hi:[1,0,1]
v_pk_mul_f32 v[138:139], v[138:139], v[24:25]
v_pk_fma_f32 v[152:153], v[18:19], v[44:45], v[152:153] op_sel:[0,1,0] op_sel_hi:[1,1,1]
v_pk_mul_f32 v[152:153], v[152:153], v[22:23]
v_pk_fma_f32 v[154:155], v[20:21], v[44:45], v[154:155] op_sel:[0,1,0] op_sel_hi:[1,1,1]
v_pk_mul_f32 v[154:155], v[154:155], v[24:25]
v_exp_f32 v104, v104
s_nop 0
MAA 132,8,96
buffer_load_dwordx4 v5, s[24:27], s58 offen lds
MAA 132,28,100
v_exp_f32 v105, v105
MAA 132,48,160
v_exp_f32 v106, v106
MAA 132,68,164
v_exp_f32 v107, v107
MAA 148,68,172
buffer_load_dwordx4 v6, s[24:27], s58 offen offset:1024 lds
MAA 148,48,168
s_add_u32 m0, s59, 116480
s_xor_b32 s58, s87, 786432
v_exp_f32 v120, v120
MAA 148,28,124
v_exp_f32 v121, v121
MAA 148,8,120
v_exp_f32 v122, v122
MAA 128,4,96
buffer_load_dwordx4 v5, s[24:27], s58 offen lds
MAA 128,24,100
v_exp_f32 v123, v123
MAA 128,44,160
v_exp_f32 v100, v100
MAA 128,64,164
v_exp_f32 v101, v101
MAA 144,64,172
buffer_load_dwordx4 v6, s[24:27], s58 offen offset:1024 lds
MAA 144,44,168
s_add_u32 m0, s59, 124800
s_xor_b32 s58, s87, 917504
v_exp_f32 v102, v102
MAA 144,24,124
v_exp_f32 v103, v103
MAA 144,4,120
v_exp_f32 v116, v116
MAA 124,0,96
buffer_load_dwordx4 v5, s[24:27], s58 offen lds
MAA 124,20,100
v_exp_f32 v117, v117
MAA 124,40,160
v_exp_f32 v118, v118
MAA 124,60,164
v_exp_f32 v119, v119
MAA 140,60,172
buffer_load_dwordx4 v6, s[24:27], s58 offen offset:1024 lds
MAA 140,40,168
v_exp_f32 v96, v96
MAA 140,20,124
v_exp_f32 v97, v97
MAA 140,0,120
v_cvt_pk_bf16_f32 v72, v104, v105
v_cvt_pk_bf16_f32 v73, v106, v107
v_cvt_pk_bf16_f32 v74, v120, v121
v_cvt_pk_bf16_f32 v75, v122, v123
v_cvt_pk_bf16_f32 v68, v100, v101
v_cvt_pk_bf16_f32 v69, v102, v103
v_cvt_pk_bf16_f32 v70, v116, v117
v_cvt_pk_bf16_f32 v71, v118, v119
v_exp_f32 v98, v98
v_exp_f32 v99, v99
v_exp_f32 v112, v112
v_exp_f32 v113, v113
v_exp_f32 v114, v114
v_exp_f32 v115, v115
v_cvt_pk_bf16_f32 v64, v96, v97
v_cvt_pk_bf16_f32 v65, v98, v99
v_cvt_pk_bf16_f32 v66, v112, v113
v_cvt_pk_bf16_f32 v67, v114, v115
v_cvt_pk_bf16_f32 v208, v136, v137
v_cvt_pk_bf16_f32 v209, v138, v139
v_cvt_pk_bf16_f32 v218, v152, v153
v_cvt_pk_bf16_f32 v219, v154, v155
s_waitcnt lgkmcnt(5)
v_pk_fma_f32 v[132:133], v[240:241], v[44:45], v[132:133] op_sel_hi:[1,0,1]
s_waitcnt lgkmcnt(4)
v_pk_mul_f32 v[132:133], v[132:133], v[244:245]
v_cvt_pk_bf16_f32 v206, v132, v133
v_pk_fma_f32 v[134:135], v[242:243], v[44:45], v[134:135] op_sel_hi:[1,0,1]
v_pk_mul_f32 v[134:135], v[134:135], v[246:247]
v_cvt_pk_bf16_f32 v207, v134, v135
v_pk_fma_f32 v[148:149], v[240:241], v[44:45], v[148:149] op_sel:[0,1,0] op_sel_hi:[1,1,1]
v_pk_mul_f32 v[148:149], v[148:149], v[244:245]
v_cvt_pk_bf16_f32 v216, v148, v149
v_pk_fma_f32 v[150:151], v[242:243], v[44:45], v[150:151] op_sel:[0,1,0] op_sel_hi:[1,1,1]
v_pk_mul_f32 v[150:151], v[150:151], v[246:247]
v_cvt_pk_bf16_f32 v217, v150, v151
s_waitcnt lgkmcnt(3)
v_pk_fma_f32 v[128:129], v[28:29], v[44:45], v[128:129] op_sel_hi:[1,0,1]
s_waitcnt lgkmcnt(2)
v_pk_mul_f32 v[128:129], v[128:129], v[32:33]
v_cvt_pk_bf16_f32 v204, v128, v129
v_pk_fma_f32 v[130:131], v[30:31], v[44:45], v[130:131] op_sel_hi:[1,0,1]
v_pk_mul_f32 v[130:131], v[130:131], v[34:35]
v_cvt_pk_bf16_f32 v205, v130, v131
v_pk_fma_f32 v[144:145], v[28:29], v[44:45], v[144:145] op_sel:[0,1,0] op_sel_hi:[1,1,1]
v_pk_mul_f32 v[144:145], v[144:145], v[32:33]
v_cvt_pk_bf16_f32 v214, v144, v145
v_pk_fma_f32 v[146:147], v[30:31], v[44:45], v[146:147] op_sel:[0,1,0] op_sel_hi:[1,1,1]
v_pk_mul_f32 v[146:147], v[146:147], v[34:35]
v_cvt_pk_bf16_f32 v215, v146, v147
s_waitcnt lgkmcnt(1)
v_pk_fma_f32 v[124:125], v[36:37], v[44:45], v[124:125] op_sel_hi:[1,0,1]
s_waitcnt lgkmcnt(0)
v_pk_mul_f32 v[124:125], v[124:125], v[40:41]
v_cvt_pk_bf16_f32 v202, v124, v125
v_pk_fma_f32 v[126:127], v[38:39], v[44:45], v[126:127] op_sel_hi:[1,0,1]
v_pk_mul_f32 v[126:127], v[126:127], v[42:43]
v_cvt_pk_bf16_f32 v203, v126, v127
v_pk_fma_f32 v[140:141], v[36:37], v[44:45], v[140:141] op_sel:[0,1,0] op_sel_hi:[1,1,1]
v_pk_mul_f32 v[140:141], v[140:141], v[40:41]
v_cvt_pk_bf16_f32 v212, v140, v141
v_pk_fma_f32 v[142:143], v[38:39], v[44:45], v[142:143] op_sel:[0,1,0] op_sel_hi:[1,1,1]
v_pk_mul_f32 v[142:143], v[142:143], v[42:43]
v_cvt_pk_bf16_f32 v213, v142, v143
s_nop 0
v_mfma_f32_16x16x32_bf16 v[88:91], v[248:251], v[72:75], 0
v_exp_f32 v92, v92
v_mfma_f32_16x16x32_bf16 v[104:107], v[206:209], v[72:75], 0
v_exp_f32 v93, v93
v_mfma_f32_16x16x32_bf16 v[120:123], v[216:219], v[72:75], 0
v_exp_f32 v94, v94
v_mfma_f32_16x16x32_bf16 v[84:87], v[248:251], v[68:71], 0
v_exp_f32 v95, v95
v_mfma_f32_16x16x32_bf16 v[100:103], v[204:207], v[68:71], 0
v_exp_f32 v108, v108
v_mfma_f32_16x16x32_bf16 v[116:119], v[214:217], v[68:71], 0
v_exp_f32 v109, v109
v_mfma_f32_16x16x32_bf16 v[80:83], v[248:251], v[64:67], 0
v_exp_f32 v110, v110
v_mfma_f32_16x16x32_bf16 v[96:99], v[202:205], v[64:67], 0
v_exp_f32 v111, v111
v_mfma_f32_16x16x32_bf16 v[112:115], v[212:215], v[64:67], 0
v_cvt_pk_bf16_f32 v60, v92, v93
v_cvt_pk_bf16_f32 v61, v94, v95
v_cvt_pk_bf16_f32 v62, v108, v109
v_cvt_pk_bf16_f32 v63, v110, v111
v_rcp_f32 v88, v88
v_rcp_f32 v84, v84
v_mfma_f32_16x16x32_bf16 v[76:79], v[248:251], v[60:63], 0
v_rcp_f32 v80, v80
v_mfma_f32_16x16x32_bf16 v[92:95], v[200:203], v[60:63], 0
v_mfma_f32_16x16x32_bf16 v[108:111], v[210:213], v[60:63], 0
s_nop 4
v_rcp_f32 v76, v76
v_pk_mul_f32 v[104:105], v[104:105], v[88:89] op_sel_hi:[1,0]
v_pk_mul_f32 v[106:107], v[106:107], v[88:89] op_sel_hi:[1,0]
v_pk_mul_f32 v[120:121], v[120:121], v[88:89] op_sel_hi:[1,0]
v_pk_mul_f32 v[122:123], v[122:123], v[88:89] op_sel_hi:[1,0]
v_cvt_pk_bf16_f32 v176, v104, v105
v_cvt_pk_bf16_f32 v177, v106, v107
v_cvt_pk_bf16_f32 v178, v120, v121
v_cvt_pk_bf16_f32 v179, v122, v123
buffer_store_dwordx4 v[176:179], v4, s[16:19], s74 offen offset:3072 sc1
v_pk_mul_f32 v[100:101], v[100:101], v[84:85] op_sel_hi:[1,0]
v_pk_mul_f32 v[102:103], v[102:103], v[84:85] op_sel_hi:[1,0]
v_pk_mul_f32 v[116:117], v[116:117], v[84:85] op_sel_hi:[1,0]
v_pk_mul_f32 v[118:119], v[118:119], v[84:85] op_sel_hi:[1,0]
v_cvt_pk_bf16_f32 v172, v100, v101
v_cvt_pk_bf16_f32 v173, v102, v103
v_cvt_pk_bf16_f32 v174, v116, v117
v_cvt_pk_bf16_f32 v175, v118, v119
buffer_store_dwordx4 v[172:175], v4, s[16:19], s74 offen offset:2048 sc1
v_pk_mul_f32 v[96:97], v[96:97], v[80:81] op_sel_hi:[1,0]
v_pk_mul_f32 v[98:99], v[98:99], v[80:81] op_sel_hi:[1,0]
v_pk_mul_f32 v[112:113], v[112:113], v[80:81] op_sel_hi:[1,0]
v_pk_mul_f32 v[114:115], v[114:115], v[80:81] op_sel_hi:[1,0]
v_cvt_pk_bf16_f32 v168, v96, v97
v_cvt_pk_bf16_f32 v169, v98, v99
v_cvt_pk_bf16_f32 v170, v112, v113
v_cvt_pk_bf16_f32 v171, v114, v115
buffer_store_dwordx4 v[168:171], v4, s[16:19], s74 offen offset:1024 sc1
v_pk_mul_f32 v[92:93], v[92:93], v[76:77] op_sel_hi:[1,0]
v_pk_mul_f32 v[94:95], v[94:95], v[76:77] op_sel_hi:[1,0]
v_pk_mul_f32 v[108:109], v[108:109], v[76:77] op_sel_hi:[1,0]
v_pk_mul_f32 v[110:111], v[110:111], v[76:77] op_sel_hi:[1,0]
v_cvt_pk_bf16_f32 v164, v92, v93
v_cvt_pk_bf16_f32 v165, v94, v95
v_cvt_pk_bf16_f32 v166, v108, v109
v_cvt_pk_bf16_f32 v167, v110, v111
buffer_store_dwordx4 v[164:167], v4, s[16:19], s74 offen sc1
s_nop 1
.Lqkve56:
s_lshl_b32 s62, s3, 11
s_add_u32 s62, s62, s84
v_lshl_add_u32 v4, v1, 4, s62
v_lshrrev_b32 v2, 3, v1
v_cmp_eq_u32 vcc, 3, v2
v_add_u32 v2, 67108480, v4
s_nop 0
v_cndmask_b32 v4, v4, v2, vcc
v_bfe_u32 v5, v1, 3, 1
v_lshrrev_b32 v2, 4, v1
v_lshl_add_u32 v5, v2, 3, v5
s_lshl_b32 s62, s3, 1
v_add_u32 v5, s62, v5
v_mul_u32_u24 v5, 2048, v5
v_and_b32 v2, 7, v1
v_lshl_add_u32 v5, v2, 4, v5
s_lshl_b32 s62, s7, 7
v_add_u32 v5, s62, v5
v_add_u32 v6, 64512, v5
v_bfe_u32 v8, v1, 3, 2
v_mul_u32_u24 v8, 2080, v8
v_bfe_u32 v2, v1, 2, 1
v_lshl_add_u32 v8, v2, 7, v8
v_bfe_u32 v2, v1, 5, 1
v_lshl_add_u32 v8, v2, 8, v8
v_and_b32 v2, 3, v1
v_lshl_add_u32 v8, v2, 3, v8
s_mov_b32 s57, 66560
v_add_u32 v7, s57, v8
s_lshr_b32 s54, s87, 17
s_lshl_b32 s54, s54, 18
s_add_u32 s54, s54, 37748736
s_mov_b32 s52, s54
s_add_u32 s53, s54, 131072
v_accvgpr_read_b32 v32, a224
v_accvgpr_read_b32 v33, a225
v_accvgpr_read_b32 v34, a226
v_accvgpr_read_b32 v35, a227
v_accvgpr_read_b32 v36, a228
v_accvgpr_read_b32 v37, a229
v_accvgpr_read_b32 v38, a230
v_accvgpr_read_b32 v39, a231
v_accvgpr_read_b32 v40, a232
v_accvgpr_read_b32 v41, a233
v_accvgpr_read_b32 v42, a234
v_accvgpr_read_b32 v43, a235
v_accvgpr_read_b32 v44, a236
v_accvgpr_read_b32 v45, a237
v_accvgpr_read_b32 v46, a238
v_accvgpr_read_b32 v47, a239
v_accvgpr_read_b32 v48, a240
v_accvgpr_read_b32 v49, a241
v_accvgpr_read_b32 v50, a242
v_accvgpr_read_b32 v51, a243
v_accvgpr_read_b32 v52, a244
v_accvgpr_read_b32 v53, a245
v_accvgpr_read_b32 v54, a246
v_accvgpr_read_b32 v55, a247
v_accvgpr_read_b32 v56, a248
v_accvgpr_read_b32 v57, a249
v_accvgpr_read_b32 v58, a250
v_accvgpr_read_b32 v59, a251
v_accvgpr_read_b32 v60, a252
v_accvgpr_read_b32 v61, a253
v_accvgpr_read_b32 v62, a254
v_accvgpr_read_b32 v63, a255
s_lshl_b32 s62, s49, 3
s_add_u32 s62, s62, s48
s_mul_i32 s62, s62, 28672
s_add_u32 s62, s62, s51
v_lshrrev_b32 v12, 4, v1
v_mul_u32_u24 v12, 57344, v12
v_and_b32 v2, 15, v1
v_lshl_add_u32 v12, v2, 4, v12
v_add_u32 v12, s62, v12
v_add_u32 v13, 6112, v12
v_add_u32 v14, 12224, v12
v_add_u32 v15, 18336, v12
s_mul_i32 s59, s3, 4224
s_mov_b32 s58, 0
s_lshl_b32 s62, s8, 10
s_add_u32 s62, s62, 30490624
s_lshl_b32 s64, s6, 10
s_add_u32 s64, s64, 30490624
s_lshr_b32 s67, s5, 2
s_and_b32 s67, s67, 3
s_lshl_b32 s67, s67, 7
s_add_u32 s64, s64, s67
v_lshl_add_u32 v252, v1, 7, s62
v_mov_b32 v253, s64
v_mov_b32 v255, 1
s_waitcnt vmcnt(0) lgkmcnt(0)
s_cmp_lg_u32 s3, 1
s_barrier
s_cbranch_scc1 .Lnopoll60
s_mov_b64 exec, 15
buffer_atomic_add v255, v252, s[16:19], 0 offen
s_mov_b64 exec, 1
v_mov_b32 v254, 0
buffer_atomic_add v254, v253, s[16:19], 0 offen sc0
s_sleep 5
.Lpad29:
s_cbranch_execz .Lnopoll53r
s_mov_b32 s15, 0
.Lpoll59:
v_mov_b32 v255, 0
buffer_atomic_add v255, v253, s[16:19], 0 offen sc0
s_waitcnt vmcnt(1)
v_cmp_gt_u32 vcc, 16, v254
s_add_u32 s15, s15, 1
s_cbranch_vccz .Lnopoll60r
v_mov_b32 v254, 0
buffer_atomic_add v254, v253, s[16:19], 0 offen sc0
s_waitcnt vmcnt(1)
v_cmp_gt_u32 vcc, 16, v255
s_add_u32 s15, s15, 1
s_cbranch_vccz .Lnopoll60r
s_cmp_le_u32 s15, 100000
s_cbranch_scc1 .Lpoll59
s_branch .Lnopoll60r
.Lnopoll60:
s_mov_b64 exec, 0
s_cmp_eq_u32 s3, 2
s_cbranch_scc1 .Lpad30
s_cmp_eq_u32 s3, 3
s_cbranch_scc1 .Lpad31
s_branch .Lpad32
.Lnopoll60r:
s_mov_b64 exec, -1
s_barrier
buffer_load_dwordx4 v[64:67], v4, s[16:19], s52 offen sc1
buffer_load_dwordx4 v[68:71], v4, s[16:19], s52 offen offset:1024 sc1
s_xor_b32 s52, s54, 262144
buffer_load_dwordx4 v[72:75], v4, s[16:19], s53 offen sc1
buffer_load_dwordx4 v[76:79], v4, s[16:19], s53 offen offset:1024 sc1
s_xor_b32 s53, s54, 393216
buffer_load_dwordx4 v[80:83], v4, s[16:19], s52 offen sc1
buffer_load_dwordx4 v[84:87], v4, s[16:19], s52 offen offset:1024 sc1
s_xor_b32 s52, s54, 524288
buffer_load_dwordx4 v[88:91], v4, s[16:19], s53 offen sc1
buffer_load_dwordx4 v[92:95], v4, s[16:19], s53 offen offset:1024 sc1
s_xor_b32 s53, s54, 655360
buffer_load_dwordx4 v[96:99], v4, s[16:19], s52 offen sc1
buffer_load_dwordx4 v[100:103], v4, s[16:19], s52 offen offset:1024 sc1
s_xor_b32 s52, s54, 786432
buffer_load_dwordx4 v[104:107], v4, s[16:19], s53 offen sc1
buffer_load_dwordx4 v[108:111], v4, s[16:19], s53 offen offset:1024 sc1
s_xor_b32 s53, s54, 917504
ds_read_b64_tr_b16 a[0:1], v7
TR 2,7,512
TR 16,7,1024
TR 18,7,1536
TR 4,7,32
TR 6,7,544
TR 20,7,1056
TR 22,7,1568
TR 8,7,64
TR 10,7,576
TR 24,7,1088
TR 26,7,1600
TR 12,7,96
TR 14,7,608
TR 28,7,1120
TR 30,7,1632
s_waitcnt vmcnt(8) lgkmcnt(14)
MAV 32,0,64
TR 32,7,8320
s_waitcnt lgkmcnt(13)
MAV 32,16,72
buffer_load_dwordx4 v[112:115], v4, s[16:19], s52 offen sc1
MAV 48,16,76
TR 34,7,8832
MAV 48,0,68
TR 48,7,9344
TR 50,7,9856
s_waitcnt lgkmcnt(14)
MAV 52,4,68
TR 36,7,8352
s_waitcnt lgkmcnt(13)
MAV 52,20,76
buffer_load_dwordx4 v[116:119], v4, s[16:19], s52 offen offset:1024 sc1
MAV 36,20,72
TR 38,7,8864
s_xor_b32 s52, s54, 1048576
MAV 36,4,64
TR 52,7,9376
TR 54,7,9888
s_waitcnt lgkmcnt(14)
MAV 40,8,64
TR 40,7,8384
s_waitcnt lgkmcnt(13)
MAV 40,24,72
buffer_load_dwordx4 v[120:123], v4, s[16:19], s53 offen sc1
MAV 56,24,76
TR 42,7,8896
MAV 56,8,68
TR 56,7,9408
TR 58,7,9920
s_waitcnt lgkmcnt(14)
MAV 60,12,68
TR 44,7,8416
s_waitcnt lgkmcnt(13)
MAV 60,28,76
buffer_load_dwordx4 v[124:127], v4, s[16:19], s53 offen offset:1024 sc1
MAV 44,28,72
TR 46,7,8928
s_xor_b32 s53, s54, 1179648
MAV 44,12,64
TR 60,7,9440
TR 62,7,9952
s_waitcnt vmcnt(8) lgkmcnt(8)
MAV 32,32,80
TR 0,7,16640
MAV 32,48,88
buffer_load_dwordx4 v[64:67], v4, s[16:19], s52 offen sc1
MAV 48,48,92
TR 2,7,17152
MAV 48,32,84
TR 16,7,17664
TR 18,7,18176
MAV 52,36,84
TR 4,7,16672
MAV 52,52,92
buffer_load_dwordx4 v[68:71], v4, s[16:19], s52 offen offset:1024 sc1
MAV 36,52,88
TR 6,7,17184
s_xor_b32 s52, s54, 1310720
MAV 36,36,80
TR 20,7,17696
TR 22,7,18208
s_waitcnt lgkmcnt(8)
MAV 40,40,80
TR 8,7,16704
MAV 40,56,88
buffer_load_dwordx4 v[72:75], v4, s[16:19], s53 offen sc1
MAV 56,56,92
TR 10,7,17216
MAV 56,40,84
TR 24,7,17728
TR 26,7,18240
MAV 60,44,84
TR 12,7,16736
MAV 60,60,92
buffer_load_dwordx4 v[76:79], v4, s[16:19], s53 offen offset:1024 sc1
MAV 44,60,88
TR 14,7,17248
s_xor_b32 s53, s54, 1441792
MAV 44,44,80
TR 28,7,17760
TR 30,7,18272
s_waitcnt vmcnt(8) lgkmcnt(8)
MAV 32,0,96
TR 32,7,24960
MAV 32,16,104
buffer_load_dwordx4 v[80:83], v4, s[16:19], s52 offen sc1
MAV 48,16,108
TR 34,7,25472
MAV 48,0,100
TR 48,7,25984
TR 50,7,26496
MAV 52,4,100
TR 36,7,24992
MAV 52,20,108
buffer_load_dwordx4 v[84:87], v4, s[16:19], s52 offen offset:1024 sc1
MAV 36,20,104
TR 38,7,25504
s_xor_b32 s52, s54, 1572864
MAV 36,4,96
TR 52,7,26016
TR 54,7,26528
s_waitcnt lgkmcnt(8)
MAV 40,8,96
TR 40,7,25024
MAV 40,24,104
buffer_load_dwordx4 v[88:91], v4, s[16:19], s53 offen sc1
MAV 56,24,108
TR 42,7,25536
MAV 56,8,100
TR 56,7,26048
TR 58,7,26560
MAV 60,12,100
TR 44,7,25056
MAV 60,28,108
buffer_load_dwordx4 v[92:95], v4, s[16:19], s53 offen offset:1024 sc1
MAV 44,28,104
TR 46,7,25568
s_xor_b32 s53, s54, 1703936
MAV 44,12,96
TR 60,7,26080
TR 62,7,26592
s_waitcnt vmcnt(8) lgkmcnt(8)
MAV 32,32,112
TR 0,7,33280
MAV 32,48,120
buffer_load_dwordx4 v[96:99], v4, s[16:19], s52 offen sc1
MAV 48,48,124
TR 2,7,33792
MAV 48,32,116
TR 16,7,34304
TR 18,7,34816
MAV 52,36,116
TR 4,7,33312
MAV 52,52,124
buffer_load_dwordx4 v[100:103], v4, s[16:19], s52 offen offset:1024 sc1
MAV 36,52,120
TR 6,7,33824
s_xor_b32 s52, s54, 1835008
MAV 36,36,112
TR 20,7,34336
TR 22,7,34848
s_waitcnt lgkmcnt(8)
MAV 40,40,112
TR 8,7,33344
MAV 40,56,120
buffer_load_dwordx4 v[104:107], v4, s[16:19], s53 offen sc1
MAV 56,56,124
TR 10,7,33856
MAV 56,40,116
TR 24,7,34368
TR 26,7,34880
MAV 60,44,116
TR 12,7,33376
MAV 60,60,124
buffer_load_dwordx4 v[108:111], v4, s[16:19], s53 offen offset:1024 sc1
MAV 44,60,120
TR 14,7,33888
s_xor_b32 s53, s54, 1966080
MAV 44,44,112
TR 28,7,34400
TR 30,7,34912
s_waitcnt vmcnt(8) lgkmcnt(8)
MAV 32,0,64
TR 32,7,41600
MAV 32,16,72
buffer_load_dwordx4 v[112:115], v4, s[16:19], s52 offen sc1
MAV 48,16,76
TR 34,7,42112
MAV 48,0,68
TR 48,7,42624
TR 50,7,43136
MAV 52,4,68
TR 36,7,41632
MAV 52,20,76
buffer_load_dwordx4 v[116:119], v4, s[16:19], s52 offen offset:1024 sc1
MAV 36,20,72
TR 38,7,42144
s_xor_b32 s52, s54, 2097152
MAV 36,4,64
TR 52,7,42656
TR 54,7,43168
s_waitcnt lgkmcnt(8)
MAV 40,8,64
TR 40,7,41664
MAV 40,24,72
buffer_load_dwordx4 v[120:123], v4, s[16:19], s53 offen sc1
MAV 56,24,76
TR 42,7,42176
MAV 56,8,68
TR 56,7,42688
TR 58,7,43200
MAV 60,12,68
TR 44,7,41696
MAV 60,28,76
buffer_load_dwordx4 v[124:127], v4, s[16:19], s53 offen offset:1024 sc1
MAV 44,28,72
TR 46,7,42208
s_xor_b32 s53, s54, 2228224
MAV 44,12,64
TR 60,7,42720
TR 62,7,43232
s_waitcnt vmcnt(8) lgkmcnt(8)
MAV 32,32,80
TR 0,7,49920
MAV 32,48,88
buffer_load_dwordx4 v[64:67], v4, s[16:19], s52 offen sc1
MAV 48,48,92
TR 2,7,50432
MAV 48,32,84
TR 16,7,50944
TR 18,7,51456
MAV 52,36,84
TR 4,7,49952
MAV 52,52,92
buffer_load_dwordx4 v[68:71], v4, s[16:19], s52 offen offset:1024 sc1
MAV 36,52,88
TR 6,7,50464
s_xor_b32 s52, s54, 2359296
MAV 36,36,80
TR 20,7,50976
TR 22,7,51488
s_waitcnt lgkmcnt(8)
MAV 40,40,80
TR 8,7,49984
MAV 40,56,88
buffer_load_dwordx4 v[72:75], v4, s[16:19], s53 offen sc1
MAV 56,56,92
TR 10,7,50496
MAV 56,40,84
TR 24,7,51008
TR 26,7,51520
MAV 60,44,84
TR 12,7,50016
MAV 60,60,92
buffer_load_dwordx4 v[76:79], v4, s[16:19], s53 offen offset:1024 sc1
MAV 44,60,88
TR 14,7,50528
s_xor_b32 s53, s54, 2490368
MAV 44,44,80
TR 28,7,51040
TR 30,7,51552
s_waitcnt vmcnt(8) lgkmcnt(8)
MAV 32,0,96
TR 32,7,58240
MAV 32,16,104
buffer_load_dwordx4 v[80:83], v4, s[16:19], s52 offen sc1
MAV 48,16,108
TR 34,7,58752
MAV 48,0,100
TR 48,7,59264
TR 50,7,59776
MAV 52,4,100
TR 36,7,58272
MAV 52,20,108
buffer_load_dwordx4 v[84:87], v4, s[16:19], s52 offen offset:1024 sc1
MAV 36,20,104
TR 38,7,58784
s_xor_b32 s52, s54, 2621440
MAV 36,4,96
TR 52,7,59296
TR 54,7,59808
s_waitcnt lgkmcnt(8)
MAV 40,8,96
TR 40,7,58304
MAV 40,24,104
buffer_load_dwordx4 v[88:91], v4, s[16:19], s53 offen sc1
MAV 56,24,108
TR 42,7,58816
MAV 56,8,100
TR 56,7,59328
TR 58,7,59840
MAV 60,12,100
TR 44,7,58336
MAV 60,28,108
buffer_load_dwordx4 v[92:95], v4, s[16:19], s53 offen offset:1024 sc1
MAV 44,28,104
TR 46,7,58848
s_xor_b32 s53, s54, 2752512
MAV 44,12,96
TR 60,7,59360
TR 62,7,59872
s_xor_b32 s57, s57, 66560
v_add_u32 v7, s57, v8
s_waitcnt vmcnt(8) lgkmcnt(8)
MAV 32,32,112
ds_read_b64_tr_b16 a[0:1], v7
MAV 32,48,120
buffer_load_dwordx4 v[96:99], v4, s[16:19], s52 offen sc1
MAV 48,48,124
TR 2,7,512
MAV 48,32,116
TR 16,7,1024
TR 18,7,1536
MAV 52,36,116
TR 4,7,32
MAV 52,52,124
buffer_load_dwordx4 v[100:103], v4, s[16:19], s52 offen offset:1024 sc1
MAV 36,52,120
TR 6,7,544
s_xor_b32 s52, s54, 2883584
MAV 36,36,112
TR 20,7,1056
TR 22,7,1568
s_waitcnt lgkmcnt(8)
MAV 40,40,112
TR 8,7,64
MAV 40,56,120
buffer_load_dwordx4 v[104:107], v4, s[16:19], s53 offen sc1
MAV 56,56,124
TR 10,7,576
MAV 56,40,116
TR 24,7,1088
TR 26,7,1600
MAV 60,44,116
TR 12,7,96
MAV 60,60,124
buffer_load_dwordx4 v[108:111], v4, s[16:19], s53 offen offset:1024 sc1
MAV 44,60,120
TR 14,7,608
s_xor_b32 s53, s54, 3014656
MAV 44,44,112
TR 28,7,1120
TR 30,7,1632
s_waitcnt vmcnt(8) lgkmcnt(8)
MAV 32,0,64
TR 32,7,8320
MAV 32,16,72
buffer_load_dwordx4 v[112:115], v4, s[16:19], s52 offen sc1
MAV 48,16,76
TR 34,7,8832
MAV 48,0,68
TR 48,7,9344
TR 50,7,9856
MAV 52,4,68
TR 36,7,8352
MAV 52,20,76
buffer_load_dwordx4 v[116:119], v4, s[16:19], s52 offen offset:1024 sc1
MAV 36,20,72
TR 38,7,8864
s_xor_b32 s52, s54, 3145728
MAV 36,4,64
TR 52,7,9376
TR 54,7,9888
s_waitcnt lgkmcnt(8)
MAV 40,8,64
TR 40,7,8384
MAV 40,24,72
buffer_load_dwordx4 v[120:123], v4, s[16:19], s53 offen sc1
MAV 56,24,76
TR 42,7,8896
MAV 56,8,68
TR 56,7,9408
TR 58,7,9920
MAV 60,12,68
TR 44,7,8416
MAV 60,28,76
buffer_load_dwordx4 v[124:127], v4, s[16:19], s53 offen offset:1024 sc1
MAV 44,28,72
TR 46,7,8928
s_xor_b32 s53, s54, 3276800
MAV 44,12,64
TR 60,7,9440
TR 62,7,9952
s_waitcnt vmcnt(8) lgkmcnt(8)
MAV 32,32,80
TR 0,7,16640
MAV 32,48,88
buffer_load_dwordx4 v[64:67], v4, s[16:19], s52 offen sc1
MAV 48,48,92
TR 2,7,17152
MAV 48,32,84
TR 16,7,17664
TR 18,7,18176
MAV 52,36,84
TR 4,7,16672
MAV 52,52,92
buffer_load_dwordx4 v[68:71], v4, s[16:19], s52 offen offset:1024 sc1
MAV 36,52,88
TR 6,7,17184
s_xor_b32 s52, s54, 3407872
MAV 36,36,80
TR 20,7,17696
TR 22,7,18208
s_waitcnt lgkmcnt(8)
MAV 40,40,80
TR 8,7,16704
MAV 40,56,88
buffer_load_dwordx4 v[72:75], v4, s[16:19], s53 offen sc1
MAV 56,56,92
TR 10,7,17216
MAV 56,40,84
TR 24,7,17728
TR 26,7,18240
MAV 60,44,84
TR 12,7,16736
MAV 60,60,92
buffer_load_dwordx4 v[76:79], v4, s[16:19], s53 offen offset:1024 sc1
MAV 44,60,88
TR 14,7,17248
s_xor_b32 s53, s54, 3538944
MAV 44,44,80
TR 28,7,17760
TR 30,7,18272
s_waitcnt vmcnt(8) lgkmcnt(8)
MAV 32,0,96
TR 32,7,24960
MAV 32,16,104
buffer_load_dwordx4 v[80:83], v4, s[16:19], s52 offen sc1
MAV 48,16,108
TR 34,7,25472
MAV 48,0,100
TR 48,7,25984
TR 50,7,26496
MAV 52,4,100
TR 36,7,24992
MAV 52,20,108
buffer_load_dwordx4 v[84:87], v4, s[16:19], s52 offen offset:1024 sc1
MAV 36,20,104
TR 38,7,25504
s_xor_b32 s52, s54, 3670016
MAV 36,4,96
TR 52,7,26016
TR 54,7,26528
s_waitcnt lgkmcnt(8)
MAV 40,8,96
TR 40,7,25024
MAV 40,24,104
buffer_load_dwordx4 v[88:91], v4, s[16:19], s53 offen sc1
MAV 56,24,108
TR 42,7,25536
MAV 56,8,100
TR 56,7,26048
TR 58,7,26560
MAV 60,12,100
TR 44,7,25056
MAV 60,28,108
buffer_load_dwordx4 v[92:95], v4, s[16:19], s53 offen offset:1024 sc1
MAV 44,28,104
TR 46,7,25568
s_xor_b32 s53, s54, 3801088
MAV 44,12,96
TR 60,7,26080
TR 62,7,26592
s_waitcnt vmcnt(8) lgkmcnt(8)
MAV 32,32,112
TR 0,7,33280
MAV 32,48,120
buffer_load_dwordx4 v[96:99], v4, s[16:19], s52 offen sc1
MAV 48,48,124
TR 2,7,33792
MAV 48,32,116
TR 16,7,34304
TR 18,7,34816
MAV 52,36,116
TR 4,7,33312
MAV 52,52,124
buffer_load_dwordx4 v[100:103], v4, s[16:19], s52 offen offset:1024 sc1
MAV 36,52,120
TR 6,7,33824
s_xor_b32 s52, s54, 3932160
MAV 36,36,112
TR 20,7,34336
TR 22,7,34848
s_waitcnt lgkmcnt(8)
MAV 40,40,112
TR 8,7,33344
MAV 40,56,120
buffer_load_dwordx4 v[104:107], v4, s[16:19], s53 offen sc1
MAV 56,56,124
TR 10,7,33856
MAV 56,40,116
TR 24,7,34368
TR 26,7,34880
MAV 60,44,116
TR 12,7,33376
.Lpad30:
s_cbranch_execz .Lpad33
MAV 60,60,124
buffer_load_dwordx4 v[108:111], v4, s[16:19], s53 offen offset:1024 sc1
MAV 44,60,120
TR 14,7,33888
s_xor_b32 s53, s54, 4063232
MAV 44,44,112
TR 28,7,34400
TR 30,7,34912
s_waitcnt vmcnt(8) lgkmcnt(8)
MAV 32,0,64
TR 32,7,41600
MAV 32,16,72
buffer_load_dwordx4 v[112:115], v4, s[16:19], s52 offen sc1
MAV 48,16,76
TR 34,7,42112
MAV 48,0,68
TR 48,7,42624
TR 50,7,43136
MAV 52,4,68
TR 36,7,41632
MAV 52,20,76
buffer_load_dwordx4 v[116:119], v4, s[16:19], s52 offen offset:1024 sc1
MAV 36,20,72
TR 38,7,42144
MAV 36,4,64
TR 52,7,42656
TR 54,7,43168
s_waitcnt lgkmcnt(8)
MAV 40,8,64
TR 40,7,41664
MAV 40,24,72
buffer_load_dwordx4 v[120:123], v4, s[16:19], s53 offen sc1
MAV 56,24,76
TR 42,7,42176
MAV 56,8,68
TR 56,7,42688
TR 58,7,43200
MAV 60,12,68
TR 44,7,41696
MAV 60,28,76
buffer_load_dwordx4 v[124:127], v4, s[16:19], s53 offen offset:1024 sc1
MAV 44,28,72
TR 46,7,42208
MAV 44,12,64
TR 60,7,42720
TR 62,7,43232
s_barrier
s_waitcnt vmcnt(8) lgkmcnt(8)
MAV 32,32,80
TR 0,7,49920
s_add_u32 m0, s59, 84480
MAV 32,48,88
buffer_load_dwordx4 v12, s[32:35], s58 offen   lds
MAV 48,48,92
TR 2,7,50432
MAV 48,32,84
TR 16,7,50944
TR 18,7,51456
MAV 52,36,84
TR 4,7,49952
MAV 52,52,92
buffer_load_dwordx4 v13, s[32:35], s58 offen offset:1056   lds
MAV 36,52,88
TR 6,7,50464
MAV 36,36,80
TR 20,7,50976
TR 22,7,51488
s_waitcnt lgkmcnt(8)
MAV 40,40,80
TR 8,7,49984
MAV 40,56,88
buffer_load_dwordx4 v14, s[32:35], s58 offen offset:2112   lds
MAV 56,56,92
TR 10,7,50496
MAV 56,40,84
TR 24,7,51008
TR 26,7,51520
MAV 60,44,84
TR 12,7,50016
MAV 60,60,92
buffer_load_dwordx4 v15, s[32:35], s58 offen offset:3168   lds
MAV 44,60,88
TR 14,7,50528
MAV 44,44,80
TR 28,7,51040
TR 30,7,51552
s_waitcnt vmcnt(8) lgkmcnt(8)
MAV 32,0,96
TR 32,7,58240
s_add_u32 m0, s59, 101376
MAV 32,16,104
buffer_load_dwordx4 v12, s[80:83], s58 offen   lds
MAV 48,16,108
TR 34,7,58752
MAV 48,0,100
TR 48,7,59264
TR 50,7,59776
MAV 52,4,100
TR 36,7,58272
MAV 52,20,108
buffer_load_dwordx4 v13, s[80:83], s58 offen offset:1056   lds
MAV 36,20,104
TR 38,7,58784
MAV 36,4,96
TR 52,7,59296
TR 54,7,59808
s_waitcnt lgkmcnt(8)
MAV 40,8,96
TR 40,7,58304
MAV 40,24,104
buffer_load_dwordx4 v14, s[80:83], s58 offen offset:2112   lds
MAV 56,24,108
TR 42,7,58816
MAV 56,8,100
TR 56,7,59328
TR 58,7,59840
MAV 60,12,100
TR 44,7,58336
MAV 60,28,108
buffer_load_dwordx4 v15, s[80:83], s58 offen offset:3168   lds
MAV 44,28,104
TR 46,7,58848
s_add_u32 s58, s58, 458752
MAV 44,12,96
TR 60,7,59360
TR 62,7,59872
s_waitcnt vmcnt(11) lgkmcnt(14)
MAV 32,32,112
s_add_u32 m0, s59, 118272
s_lshl_b32 s64, s6, 14
s_lshl_b32 s65, s49, 13
s_waitcnt vmcnt(9) lgkmcnt(12)
MAV 32,48,120
buffer_load_dwordx4 v12, s[32:35], s58 offen   lds
s_waitcnt vmcnt(9)
MAV 48,48,124
s_add_u32 s64, s64, s65
s_lshl_b32 s65, s7, 9
s_add_u32 s64, s64, s65
MAV 48,32,116
s_lshl_b32 s65, s48, 8
s_add_u32 s64, s64, s65
s_add_u32 s64, s64, 63176704
s_waitcnt lgkmcnt(10)
MAV 52,36,116
s_lshl_b32 s62, s7, 18
v_and_b32 v152, 31, v1
v_lshlrev_b32 v152, 3, v152
s_waitcnt lgkmcnt(8)
MAV 52,52,124
buffer_load_dwordx4 v13, s[32:35], s58 offen offset:1056   lds
MAV 36,52,120
s_add_u32 s62, s62, 41943040
v_lshrrev_b32 v153, 5, v1
v_lshl_add_u32 v152, v153, 28, v152
MAV 36,36,112
s_add_u32 s63, s62, 131072
v_cvt_pk_bf16_f32 v128, v32, v33
v_cvt_pk_bf16_f32 v129, v34, v35
s_waitcnt lgkmcnt(6)
MAV 40,40,112
v_cvt_pk_bf16_f32 v136, v48, v49
v_cvt_pk_bf16_f32 v137, v50, v51
s_waitcnt lgkmcnt(4)
MAV 40,56,120
buffer_load_dwordx4 v14, s[32:35], s58 offen offset:2112   lds
MAV 56,56,124
v_cvt_pk_bf16_f32 v130, v36, v37
v_cvt_pk_bf16_f32 v131, v38, v39
MAV 56,40,116
v_cvt_pk_bf16_f32 v138, v52, v53
v_cvt_pk_bf16_f32 v139, v54, v55
s_waitcnt lgkmcnt(2)
MAV 60,44,116
v_cvt_pk_bf16_f32 v132, v40, v41
v_cvt_pk_bf16_f32 v133, v42, v43
s_waitcnt lgkmcnt(0)
MAV 60,60,124
buffer_load_dwordx4 v15, s[32:35], s58 offen offset:3168   lds
MAV 44,60,120
v_cvt_pk_bf16_f32 v140, v56, v57
v_cvt_pk_bf16_f32 v141, v58, v59
MAV 44,44,112
s_nop 2
v_cvt_pk_bf16_f32 v142, v60, v61
v_cvt_pk_bf16_f32 v143, v62, v63
v_pk_mul_f32 v[146:147], v[32:33], v[32:33]
buffer_store_dwordx4 v[128:131], v4, s[16:19], s62 offen sc1
v_pk_mul_f32 v[150:151], v[48:49], v[48:49]
v_pk_fma_f32 v[146:147], v[34:35], v[34:35], v[146:147]
v_pk_add_f32 v[144:145], v[32:33], v[34:35]
v_pk_fma_f32 v[150:151], v[50:51], v[50:51], v[150:151]
v_cvt_pk_bf16_f32 v134, v44, v45
v_cvt_pk_bf16_f32 v135, v46, v47
v_pk_add_f32 v[148:149], v[48:49], v[50:51]
v_pk_fma_f32 v[146:147], v[36:37], v[36:37], v[146:147]
v_pk_add_f32 v[144:145], v[144:145], v[36:37]
v_pk_fma_f32 v[150:151], v[52:53], v[52:53], v[150:151]
v_pk_add_f32 v[148:149], v[148:149], v[52:53]
v_pk_fma_f32 v[146:147], v[38:39], v[38:39], v[146:147]
v_pk_add_f32 v[144:145], v[144:145], v[38:39]
buffer_store_dwordx4 v[132:135], v4, s[16:19], s63 offen sc1
v_pk_fma_f32 v[150:151], v[54:55], v[54:55], v[150:151]
v_pk_add_f32 v[148:149], v[148:149], v[54:55]
v_pk_fma_f32 v[146:147], v[40:41], v[40:41], v[146:147]
v_pk_add_f32 v[144:145], v[144:145], v[40:41]
v_pk_fma_f32 v[150:151], v[56:57], v[56:57], v[150:151]
v_pk_add_f32 v[148:149], v[148:149], v[56:57]
v_pk_fma_f32 v[146:147], v[42:43], v[42:43], v[146:147]
v_pk_add_f32 v[144:145], v[144:145], v[42:43]
v_pk_fma_f32 v[150:151], v[58:59], v[58:59], v[150:151]
v_pk_add_f32 v[148:149], v[148:149], v[58:59]
v_pk_fma_f32 v[146:147], v[44:45], v[44:45], v[146:147]
v_pk_add_f32 v[144:145], v[144:145], v[44:45]
v_pk_fma_f32 v[150:151], v[60:61], v[60:61], v[150:151]
buffer_store_dwordx4 v[136:139], v4, s[16:19], s62 offen offset:1024 sc1
v_pk_add_f32 v[148:149], v[148:149], v[60:61]
v_pk_fma_f32 v[146:147], v[46:47], v[46:47], v[146:147]
v_pk_add_f32 v[144:145], v[144:145], v[46:47]
v_pk_fma_f32 v[150:151], v[62:63], v[62:63], v[150:151]
v_pk_add_f32 v[148:149], v[148:149], v[62:63]
v_add_f32 v144, v144, v145
v_add_f32 v146, v146, v147
v_add_f32 v148, v148, v149
v_add_f32 v150, v150, v151
s_nop 0
v_permlane16_swap_b32 v144, v148
buffer_store_dwordx4 v[140:143], v4, s[16:19], s63 offen offset:1024 sc1
v_permlane16_swap_b32 v146, v150
v_add_f32 v144, v144, v148
v_add_f32 v146, v146, v150
s_nop 1
v_permlane32_swap_b32 v144, v146
v_add_f32 v144, v144, v146
s_nop 1
v_permlane32_swap_b32 v144, v145
buffer_store_dwordx2 v[144:145], v152, s[16:19], s64 offen sc1
s_nop 1
v_accvgpr_write_b32 a224, v32
v_accvgpr_write_b32 a225, v33
v_accvgpr_write_b32 a226, v34
v_accvgpr_write_b32 a227, v35
v_accvgpr_write_b32 a228, v36
v_accvgpr_write_b32 a229, v37
v_accvgpr_write_b32 a230, v38
v_accvgpr_write_b32 a231, v39
v_accvgpr_write_b32 a232, v40
v_accvgpr_write_b32 a233, v41
v_accvgpr_write_b32 a234, v42
v_accvgpr_write_b32 a235, v43
v_accvgpr_write_b32 a236, v44
v_accvgpr_write_b32 a237, v45
v_accvgpr_write_b32 a238, v46
v_accvgpr_write_b32 a239, v47
v_accvgpr_write_b32 a240, v48
v_accvgpr_write_b32 a241, v49
v_accvgpr_write_b32 a242, v50
v_accvgpr_write_b32 a243, v51
v_accvgpr_write_b32 a244, v52
v_accvgpr_write_b32 a245, v53
v_accvgpr_write_b32 a246, v54
v_accvgpr_write_b32 a247, v55
v_accvgpr_write_b32 a248, v56
v_accvgpr_write_b32 a249, v57
v_accvgpr_write_b32 a250, v58
v_accvgpr_write_b32 a251, v59
v_accvgpr_write_b32 a252, v60
v_accvgpr_write_b32 a253, v61
v_accvgpr_write_b32 a254, v62
v_accvgpr_write_b32 a255, v63
s_lshl_b32 s62, s10, 14
s_lshl_b32 s63, s3, 12
s_add_u32 s62, s62, s63
s_lshl_b32 s63, s12, 11
s_add_u32 s62, s62, s63
v_lshl_add_u32 v10, v1, 4, s62
v_lshrrev_b32 v2, 3, v1
v_cmp_eq_u32 vcc, 3, v2
v_add_u32 v2, 67108480, v10
s_nop 0
v_cndmask_b32 v10, v10, v2, vcc
v_xor_b32 v11, 2048, v10
v_bfe_u32 v16, v1, 2, 3
v_mul_u32_u24 v16, 1056, v16
v_bfe_u32 v2, v1, 5, 1
v_lshl_add_u32 v16, v2, 8, v16
v_and_b32 v2, 3, v1
v_lshl_add_u32 v16, v2, 3, v16
s_lshl_b32 s62, s12, 6
s_add_u32 s62, s62, 84480
s_xor_b32 s63, s12, 1
s_mul_i32 s63, s63, 192
s_add_u32 s63, s63, 84480
v_add_u32 v17, s63, v16
v_add_u32 v16, s62, v16
s_mov_b32 s52, 41943040
s_mov_b32 s53, 41943040
s_mov_b32 s54, s58
s_mov_b32 s55, s59
s_mul_i32 s59, s3, 2112
s_and_b32 s62, s7, 1
s_mul_i32 s62, s62, 3670016
s_lshr_b32 s63, s7, 1
s_lshl_b32 s63, s63, 8
s_add_u32 s62, s62, s63
s_lshl_b32 s63, s3, 12
s_add_u32 s62, s62, s63
v_lshrrev_b32 v5, 4, v1
v_lshlrev_b32 v5, 14, v5
v_and_b32 v2, 15, v1
v_lshl_add_u32 v5, v2, 4, v5
v_add_u32 v5, s62, v5
v_add_u32 v6, 992, v5
s_lshl_b32 s62, s10, 15
s_lshl_b32 s63, s3, 13
s_add_u32 s62, s62, s63
v_lshl_add_u32 v4, v1, 4, s62
s_lshl_b32 s62, s6, 10
s_add_u32 s62, s62, 30507008
s_lshl_b32 s64, s10, 1
s_lshl_b32 s64, s64, 10
s_add_u32 s64, s64, 30507008
s_lshr_b32 s67, s5, 2
s_and_b32 s67, s67, 3
s_lshl_b32 s67, s67, 7
s_add_u32 s64, s64, s67
s_add_u32 s65, s64, 1024
v_lshl_add_u32 v252, v1, 7, s62
v_mov_b32 v253, s64
v_mov_b32 v255, 1
v_writelane_b32 v253, s65, 1
s_waitcnt vmcnt(0) lgkmcnt(0)
s_cmp_lg_u32 s3, 1
s_barrier
s_cbranch_scc1 .Lnopoll63
s_mov_b64 exec, 15
buffer_atomic_add v255, v252, s[16:19], 0 offen
s_mov_b64 exec, 3
v_mov_b32 v254, 0
buffer_atomic_add v254, v253, s[16:19], 0 offen sc0
s_sleep 5
s_mov_b32 s15, 0
.Lpoll62:
v_mov_b32 v255, 0
buffer_atomic_add v255, v253, s[16:19], 0 offen sc0
s_waitcnt vmcnt(1)
v_cmp_gt_u32 vcc, 16, v254
s_add_u32 s15, s15, 1
s_cbranch_vccz .Lnopoll63r
v_mov_b32 v254, 0
buffer_atomic_add v254, v253, s[16:19], 0 offen sc0
s_waitcnt vmcnt(1)
v_cmp_gt_u32 vcc, 16, v255
s_add_u32 s15, s15, 1
s_cbranch_vccz .Lnopoll63r
s_cmp_le_u32 s15, 100000
s_cbranch_scc1 .Lpoll62
s_branch .Lnopoll63r
.Lnopoll63:
s_mov_b64 exec, 0
s_cmp_eq_u32 s3, 2
s_cbranch_scc1 .Lpad35
s_cmp_eq_u32 s3, 3
s_cbranch_scc1 .Lpad36
s_branch .Lpad37
.Lnopoll63r:
s_mov_b64 exec, -1
s_barrier
buffer_load_dwordx4 a[128:131], v10, s[16:19], s52 offen sc1
buffer_load_dwordx4 a[132:135], v10, s[16:19], s52 offen offset:1024 sc1
s_add_u32 s52, s52, 131072
buffer_load_dwordx4 a[144:147], v10, s[16:19], s52 offen sc1
buffer_load_dwordx4 a[148:151], v10, s[16:19], s52 offen offset:1024 sc1
s_add_u32 s52, s52, 131072
buffer_load_dwordx4 a[136:139], v11, s[16:19], s53 offen sc1
buffer_load_dwordx4 a[140:143], v11, s[16:19], s53 offen offset:1024 sc1
s_add_u32 s53, s53, 131072
buffer_load_dwordx4 a[152:155], v11, s[16:19], s53 offen sc1
buffer_load_dwordx4 a[156:159], v11, s[16:19], s53 offen offset:1024 sc1
s_add_u32 s53, s53, 131072
ds_read_b64_tr_b16 a[0:1], v16
TR 2,16,512
TR 4,16,8448
TR 6,16,8960
TR 8,16,32
TR 10,16,544
TR 12,16,8480
TR 14,16,8992
TR 16,16,64
TR 18,16,576
TR 20,16,8512
TR 22,16,9024
TR 24,16,96
TR 26,16,608
TR 28,16,8544
TR 30,16,9056
TR 32,16,128
TR 34,16,640
TR 36,16,8576
TR 38,16,9088
TR 40,16,160
TR 42,16,672
TR 44,16,8608
TR 46,16,9120
ds_read_b64_tr_b16 a[48:49], v17
TR 50,17,512
TR 52,17,8448
TR 54,17,8960
TR 56,17,32
TR 58,17,544
TR 60,17,8480
TR 62,17,8992
s_add_u32 m0, s55, 135168
s_nop 0
buffer_load_dwordx4 v12, s[80:83], s54 offen   lds
buffer_load_dwordx4 v13, s[80:83], s54 offen offset:1056   lds
buffer_load_dwordx4 v14, s[80:83], s54 offen offset:2112   lds
buffer_load_dwordx4 v15, s[80:83], s54 offen offset:3168   lds
s_add_u32 s54, s54, 458752
s_lshl_b32 s57, s3, 13
s_add_u32 s57, s57, 49920
v_lshl_add_u32 v2, v1, 4, s57
s_waitcnt lgkmcnt(0)
s_barrier
s_waitcnt vmcnt(11)
v_mfma_f32_16x16x32_bf16 v[32:35], a[0:3], a[128:131], 0
buffer_load_dwordx4 a[160:163], v10, s[16:19], s52 offen sc1
s_waitcnt vmcnt(10)
MAA 32,4,144
TR 64,16,16896
v_mfma_f32_16x16x32_bf16 v[36:39], a[0:3], a[132:135], 0
TR 66,16,17408
s_waitcnt vmcnt(9)
MAA 36,4,148
TR 68,16,25344
v_mfma_f32_16x16x32_bf16 v[52:55], a[8:11], a[132:135], 0
buffer_load_dwordx4 a[164:167], v10, s[16:19], s52 offen offset:1024 sc1
MAA 52,12,148
TR 70,16,25856
s_add_u32 s52, s52, 131072
v_mfma_f32_16x16x32_bf16 v[48:51], a[8:11], a[128:131], 0
TR 72,16,16928
MAA 48,12,144
TR 74,16,17440
v_mfma_f32_16x16x32_bf16 v[96:99], a[16:19], a[128:131], 0
buffer_load_dwordx4 a[176:179], v10, s[16:19], s52 offen sc1
MAA 96,20,144
TR 76,16,25376
v_mfma_f32_16x16x32_bf16 v[100:103], a[16:19], a[132:135], 0
TR 78,16,25888
MAA 100,20,148
TR 80,16,16960
v_mfma_f32_16x16x32_bf16 v[116:119], a[24:27], a[132:135], 0
buffer_load_dwordx4 a[180:183], v10, s[16:19], s52 offen offset:1024 sc1
MAA 116,28,148
TR 82,16,17472
s_add_u32 s52, s52, 131072
v_mfma_f32_16x16x32_bf16 v[112:115], a[24:27], a[128:131], 0
TR 84,16,25408
MAA 112,28,144
TR 86,16,25920
v_mfma_f32_16x16x32_bf16 v[160:163], a[32:35], a[128:131], 0
buffer_load_dwordx4 a[168:171], v11, s[16:19], s53 offen sc1
MAA 160,36,144
TR 88,16,16992
v_mfma_f32_16x16x32_bf16 v[164:167], a[32:35], a[132:135], 0
TR 90,16,17504
MAA 164,36,148
TR 92,16,25440
v_mfma_f32_16x16x32_bf16 v[180:183], a[40:43], a[132:135], 0
buffer_load_dwordx4 a[172:175], v11, s[16:19], s53 offen offset:1024 sc1
MAA 180,44,148
TR 94,16,25952
s_add_u32 s53, s53, 131072
v_mfma_f32_16x16x32_bf16 v[176:179], a[40:43], a[128:131], 0
TR 96,16,17024
MAA 176,44,144
TR 98,16,17536
v_mfma_f32_16x16x32_bf16 v[224:227], a[48:51], a[128:131], 0
buffer_load_dwordx4 a[184:187], v11, s[16:19], s53 offen sc1
MAA 224,52,144
TR 100,16,25472
v_mfma_f32_16x16x32_bf16 v[228:231], a[48:51], a[132:135], 0
TR 102,16,25984
MAA 228,52,148
TR 104,16,17056
v_mfma_f32_16x16x32_bf16 v[236:239], a[56:59], a[132:135], 0
buffer_load_dwordx4 a[188:191], v11, s[16:19], s53 offen offset:1024 sc1
MAA 236,60,148
TR 106,16,17568
s_add_u32 s53, s53, 131072
v_mfma_f32_16x16x32_bf16 v[232:235], a[56:59], a[128:131], 0
TR 108,16,25504
s_add_u32 m0, s55, 84480
MAA 232,60,144
TR 110,16,26016
s_waitcnt vmcnt(12)
v_mfma_f32_16x16x32_bf16 v[188:191], a[40:43], a[140:143], 0
buffer_load_dwordx4 v12, s[32:35], s54 offen   lds
MAA 188,44,156
TR 112,17,16896
v_mfma_f32_16x16x32_bf16 v[184:187], a[40:43], a[136:139], 0
TR 114,17,17408
MAA 184,44,152
TR 116,17,25344
v_mfma_f32_16x16x32_bf16 v[168:171], a[32:35], a[136:139], 0
buffer_load_dwordx4 v13, s[32:35], s54 offen offset:1056   lds
MAA 168,36,152
TR 118,17,25856
v_mfma_f32_16x16x32_bf16 v[172:175], a[32:35], a[140:143], 0
TR 120,17,16928
MAA 172,36,156
TR 122,17,17440
v_mfma_f32_16x16x32_bf16 v[124:127], a[24:27], a[140:143], 0
buffer_load_dwordx4 v14, s[32:35], s54 offen offset:2112   lds
MAA 124,28,156
TR 124,17,25376
v_mfma_f32_16x16x32_bf16 v[120:123], a[24:27], a[136:139], 0
TR 126,17,25888
MAA 120,28,152
v_mfma_f32_16x16x32_bf16 v[104:107], a[16:19], a[136:139], 0
buffer_load_dwordx4 v15, s[32:35], s54 offen offset:3168   lds
MAA 104,20,152
v_mfma_f32_16x16x32_bf16 v[108:111], a[16:19], a[140:143], 0
MAA 108,20,156
v_mfma_f32_16x16x32_bf16 v[60:63], a[8:11], a[140:143], 0
MAA 60,12,156
v_mfma_f32_16x16x32_bf16 v[56:59], a[8:11], a[136:139], 0
MAA 56,12,152
v_mfma_f32_16x16x32_bf16 v[40:43], a[0:3], a[136:139], 0
MAA 40,4,152
v_mfma_f32_16x16x32_bf16 v[44:47], a[0:3], a[140:143], 0
MAA 44,4,156
s_waitcnt lgkmcnt(0)
s_barrier
v_mfma_f32_16x16x32_bf16 v[64:67], a[64:67], a[128:131], 0
TR 0,16,33792
s_add_u32 m0, s55, 101376
MAA 64,68,144
buffer_load_dwordx4 v12, s[80:83], s54 offen   lds
v_mfma_f32_16x16x32_bf16 v[68:71], a[64:67], a[132:135], 0
TR 2,16,34304
s_mul_i32 s66, s13, 114688
MAA 68,68,148
TR 4,16,42240
s_mul_i32 s65, s10, 1818624
v_mfma_f32_16x16x32_bf16 v[84:87], a[72:75], a[132:135], 0
TR 6,16,42752
s_add_u32 s66, s66, s65
MAA 84,76,148
TR 8,16,33824
s_add_u32 s66, s66, 46137344
v_mfma_f32_16x16x32_bf16 v[80:83], a[72:75], a[128:131], 0
buffer_load_dwordx4 v13, s[80:83], s54 offen offset:1056   lds
MAA 80,76,144
TR 10,16,34336
s_add_u32 s65, s66, 49152
v_mfma_f32_16x16x32_bf16 v[128:131], a[80:83], a[128:131], 0
TR 12,16,42272
s_lshl_b32 s62, s12, 16
MAA 128,84,144
TR 14,16,42784
s_add_u32 s62, s62, s66
v_mfma_f32_16x16x32_bf16 v[132:135], a[80:83], a[132:135], 0
TR 16,16,33856
s_add_u32 s63, s62, 16384
MAA 132,84,148
buffer_load_dwordx4 v14, s[80:83], s54 offen offset:2112   lds
v_mfma_f32_16x16x32_bf16 v[148:151], a[88:91], a[132:135], 0
TR 18,16,34368
s_add_u32 s64, s62, 32768
MAA 148,92,148
TR 20,16,42304
s_lshl_b32 s72, s10, 1
v_mfma_f32_16x16x32_bf16 v[144:147], a[88:91], a[128:131], 0
TR 22,16,42816
.Lpad31:
s_cbranch_execz .Lpad34
s_lshr_b32 s74, s11, 4
MAA 144,92,144
TR 24,16,33888
s_add_u32 s72, s72, s74
v_mfma_f32_16x16x32_bf16 v[192:195], a[96:99], a[128:131], 0
buffer_load_dwordx4 v15, s[80:83], s54 offen offset:3168   lds
MAA 192,100,144
TR 26,16,34400
s_add_u32 s54, s54, 458752
v_mfma_f32_16x16x32_bf16 v[196:199], a[96:99], a[132:135], 0
TR 28,16,42336
s_add_u32 m0, s57, 0
MAA 196,100,148
TR 30,16,42848
s_mov_b32 s58, 63176704
v_mfma_f32_16x16x32_bf16 v[212:215], a[104:107], a[132:135], 0
TR 32,16,33920
s_lshl_b32 s72, s72, 10
MAA 212,108,148
buffer_load_dwordx4 v4, s[16:19], s58 offen sc1 lds
v_mfma_f32_16x16x32_bf16 v[208:211], a[104:107], a[128:131], 0
TR 34,16,34432
s_add_u32 s72, s72, 30523392
MAA 208,108,144
TR 36,16,42368
s_and_b32 s73, s6, 14
v_mfma_f32_16x16x32_bf16 v[240:243], a[112:115], a[128:131], 0
TR 38,16,42880
s_and_b32 s74, s7, 1
MAA 240,116,144
TR 40,16,33952
s_add_u32 s73, s73, s74
v_mfma_f32_16x16x32_bf16 v[244:247], a[112:115], a[132:135], 0
buffer_load_dwordx4 v4, s[16:19], s58 offen offset:1024 sc1 lds
MAA 244,116,148
TR 42,16,34464
s_lshl_b32 s73, s73, 10
v_mfma_f32_16x16x32_bf16 v[252:255], a[120:123], a[132:135], 0
TR 44,16,42400
s_add_u32 s73, s73, 30523392
MAA 252,124,148
TR 46,16,42912
s_lshr_b32 s67, s5, 2
v_mfma_f32_16x16x32_bf16 v[248:251], a[120:123], a[128:131], 0
TR 48,17,33792
s_and_b32 s67, s67, 3
MAA 248,124,144
buffer_load_dwordx4 a[128:131], v10, s[16:19], s52 offen sc1
v_mfma_f32_16x16x32_bf16 v[220:223], a[104:107], a[140:143], 0
TR 50,17,34304
s_lshl_b32 s67, s67, 7
MAA 220,108,156
TR 52,17,42240
s_add_u32 s73, s73, s67
v_mfma_f32_16x16x32_bf16 v[216:219], a[104:107], a[136:139], 0
TR 54,17,42752
MAA 216,108,152
TR 56,17,33824
v_mfma_f32_16x16x32_bf16 v[200:203], a[96:99], a[136:139], 0
buffer_load_dwordx4 a[132:135], v10, s[16:19], s52 offen offset:1024 sc1
MAA 200,100,152
TR 58,17,34336
s_add_u32 s52, s52, 131072
v_mfma_f32_16x16x32_bf16 v[204:207], a[96:99], a[140:143], 0
TR 60,17,42272
MAA 204,100,156
TR 62,17,42784
v_mfma_f32_16x16x32_bf16 v[156:159], a[88:91], a[140:143], 0
MAA 156,92,156
buffer_load_dwordx4 a[144:147], v10, s[16:19], s52 offen sc1
v_mfma_f32_16x16x32_bf16 v[152:155], a[88:91], a[136:139], 0
MAA 152,92,152
v_mfma_f32_16x16x32_bf16 v[136:139], a[80:83], a[136:139], 0
MAA 136,84,152
v_mfma_f32_16x16x32_bf16 v[140:143], a[80:83], a[140:143], 0
buffer_load_dwordx4 a[148:151], v10, s[16:19], s52 offen offset:1024 sc1
MAA 140,84,156
s_add_u32 s52, s52, 131072
v_mfma_f32_16x16x32_bf16 v[92:95], a[72:75], a[140:143], 0
MAA 92,76,156
v_mfma_f32_16x16x32_bf16 v[88:91], a[72:75], a[136:139], 0
MAA 88,76,152
v_mfma_f32_16x16x32_bf16 v[72:75], a[64:67], a[136:139], 0
MAA 72,68,152
v_mfma_f32_16x16x32_bf16 v[76:79], a[64:67], a[140:143], 0
MAA 76,68,156
s_waitcnt vmcnt(18) lgkmcnt(0)
s_barrier
MAA 32,0,160
buffer_load_dwordx4 a[136:139], v11, s[16:19], s53 offen sc1
MAA 32,4,176
TR 64,16,50688
s_and_b32 s74, s7, 1
MAA 36,4,180
TR 66,16,51200
s_mul_i32 s87, s74, 917504
MAA 36,0,164
TR 68,16,59136
s_lshr_b32 s75, s6, 1
MAA 52,8,164
TR 70,16,59648
s_mul_i32 s75, s75, 1818624
MAA 52,12,180
buffer_load_dwordx4 a[140:143], v11, s[16:19], s53 offen offset:1024 sc1
MAA 48,12,176
TR 72,16,50720
s_add_u32 s53, s53, 131072
MAA 48,8,160
TR 74,16,51232
s_add_u32 s87, s87, s75
MAA 96,16,160
TR 76,16,59168
s_add_u32 s87, s87, 46137344
MAA 96,20,176
TR 78,16,59680
s_and_b32 s74, s6, 3
MAA 100,20,180
buffer_load_dwordx4 a[152:155], v11, s[16:19], s53 offen sc1
MAA 100,16,164
TR 80,16,50752
s_xor_b32 s75, s74, 0
MAA 116,24,164
TR 82,16,51264
s_sub_u32 s75, s75, 0
MAA 116,28,180
TR 84,16,59200
s_mul_i32 s98, s75, 458752
MAA 112,28,176
TR 86,16,59712
s_mul_i32 s75, s75, 114688
MAA 112,24,160
buffer_load_dwordx4 a[156:159], v11, s[16:19], s53 offen offset:1024 sc1
MAA 160,32,160
TR 88,16,50784
s_add_u32 s53, s53, 131072
MAA 160,36,176
TR 90,16,51296
s_add_u32 m0, s55, 118272
MAA 164,36,180
TR 92,16,59232
s_add_u32 s76, s87, s75
MAA 164,32,164
TR 94,16,59744
s_xor_b32 s75, s74, 1
MAA 180,40,164
buffer_load_dwordx4 v12, s[32:35], s54 offen   lds
MAA 180,44,180
TR 96,16,50816
s_sub_u32 s75, s75, 1
MAA 176,44,176
TR 98,16,51328
s_mul_i32 s99, s75, 458752
MAA 176,40,160
TR 100,16,59264
s_mul_i32 s75, s75, 114688
MAA 224,48,160
TR 102,16,59776
s_add_u32 s77, s87, s75
MAA 224,52,176
buffer_load_dwordx4 v13, s[32:35], s54 offen offset:1056   lds
MAA 228,52,180
TR 104,16,50848
s_xor_b32 s75, s74, 2
MAA 228,48,164
TR 106,16,51360
s_sub_u32 s75, s75, 2
MAA 236,56,164
TR 108,16,59296
s_mul_i32 s100, s75, 458752
MAA 236,60,180
TR 110,16,59808
s_mul_i32 s75, s75, 114688
MAA 232,60,176
buffer_load_dwordx4 v14, s[32:35], s54 offen offset:2112   lds
MAA 232,56,160
TR 112,17,50688
s_add_u32 s78, s87, s75
s_waitcnt vmcnt(21)
MAA 188,40,172
TR 114,17,51200
s_xor_b32 s75, s74, 3
MAA 188,44,188
TR 116,17,59136
MAA 184,44,184
TR 118,17,59648
MAA 184,40,168
buffer_load_dwordx4 v15, s[32:35], s54 offen offset:3168   lds
MAA 168,32,168
TR 120,17,50720
s_add_u32 m0, s57, 2048
MAA 168,36,184
TR 122,17,51232
s_mov_b32 s58, 63178752
MAA 172,36,188
TR 124,17,59168
MAA 172,32,172
TR 126,17,59680
MAA 124,24,172
buffer_load_dwordx4 v4, s[16:19], s58 offen sc1 lds
MAA 124,28,188
MAA 120,28,184
MAA 120,24,168
MAA 104,16,168
MAA 104,20,184
buffer_load_dwordx4 v4, s[16:19], s58 offen offset:1024 sc1 lds
MAA 108,20,188
MAA 108,16,172
MAA 60,8,172
MAA 60,12,188
MAA 56,12,184
MAA 56,8,168
MAA 40,0,168
MAA 40,4,184
MAA 44,4,188
MAA 44,0,172
s_waitcnt vmcnt(20) lgkmcnt(0)
s_barrier
MAA 64,64,160
ds_read_b64_tr_b16 a[0:1], v16
s_add_u32 m0, s55, 135168
MAA 64,68,176
buffer_load_dwordx4 v12, s[80:83], s54 offen   lds
MAA 68,68,180
TR 2,16,512
s_sub_u32 s75, s75, 3
MAA 68,64,164
TR 4,16,8448
s_mul_i32 s101, s75, 458752
MAA 84,72,164
TR 6,16,8960
s_mul_i32 s75, s75, 114688
MAA 84,76,180
TR 8,16,32
s_add_u32 s79, s87, s75
MAA 80,76,176
buffer_load_dwordx4 v13, s[80:83], s54 offen offset:1056   lds
MAA 80,72,160
TR 10,16,544
s_and_b32 s87, s6, 3
MAA 128,80,160
TR 12,16,8480
s_mov_b32 s46, 0
MAA 128,84,176
TR 14,16,8992
s_lshl_b32 s74, s3, 10
MAA 132,84,180
TR 16,16,64
s_lshl_b32 s75, s12, 9
MAA 132,80,164
buffer_load_dwordx4 v14, s[80:83], s54 offen offset:2112   lds
MAA 148,88,164
TR 18,16,576
s_add_u32 s74, s74, s75
MAA 148,92,180
TR 20,16,8512
s_add_u32 s74, s74, 152576
MAA 144,92,176
TR 22,16,9024
v_and_b32 v18, 15, v1
MAA 144,88,160
TR 24,16,96
v_lshl_add_u32 v18, v18, 4, s74
MAA 192,96,160
buffer_load_dwordx4 v15, s[80:83], s54 offen offset:3168   lds
MAA 192,100,176
TR 26,16,608
s_add_u32 s54, s54, 458752
MAA 196,100,180
TR 28,16,8544
s_add_u32 m0, s57, 4096
MAA 196,96,164
TR 30,16,9056
s_mov_b32 s58, 63180800
MAA 212,104,164
TR 32,16,128
v_xor_b32 v19, 512, v18
MAA 212,108,180
buffer_load_dwordx4 v4, s[16:19], s58 offen sc1 lds
MAA 208,108,176
TR 34,16,640
s_lshl_b32 s74, s12, 7
MAA 208,104,160
TR 36,16,8576
s_add_u32 s74, s74, 161536
MAA 240,112,160
TR 38,16,9088
s_xor_b32 s75, s12, 1
MAA 240,116,176
TR 40,16,160
s_mul_i32 s75, s75, 384
MAA 244,116,180
buffer_load_dwordx4 v4, s[16:19], s58 offen offset:1024 sc1 lds
MAA 244,112,164
TR 42,16,672
s_add_u32 s75, s75, 161536
MAA 252,120,164
TR 44,16,8608
v_lshrrev_b32 v9, 4, v1
MAA 252,124,180
TR 46,16,9120
v_lshlrev_b32 v9, 4, v9
MAA 248,124,176
ds_read_b64_tr_b16 a[48:49], v17
v_add_u32 v8, s75, v9
MAA 248,120,160
buffer_load_dwordx4 a[160:163], v10, s[16:19], s52 offen sc1
MAA 220,104,172
TR 50,17,512
v_add_u32 v9, s74, v9
MAA 220,108,188
TR 52,17,8448
MAA 216,108,184
TR 54,17,8960
MAA 216,104,168
TR 56,17,32
MAA 200,96,168
buffer_load_dwordx4 a[164:167], v10, s[16:19], s52 offen offset:1024 sc1
MAA 200,100,184
TR 58,17,544
s_add_u32 s52, s52, 131072
MAA 204,100,188
TR 60,17,8480
MAA 204,96,172
TR 62,17,8992
MAA 156,88,172
MAA 156,92,188
buffer_load_dwordx4 a[176:179], v10, s[16:19], s52 offen sc1
MAA 152,92,184
MAA 152,88,168
MAA 136,80,168
MAA 136,84,184
MAA 140,84,188
buffer_load_dwordx4 a[180:183], v10, s[16:19], s52 offen offset:1024 sc1
MAA 140,80,172
s_add_u32 s52, s52, 131072
MAA 92,72,172
MAA 92,76,188
MAA 88,76,184
MAA 88,72,168
MAA 72,64,168
MAA 72,68,184
MAA 76,68,188
MAA 76,64,172
s_waitcnt vmcnt(20) lgkmcnt(0)
s_barrier
MAA 32,0,128
buffer_load_dwordx4 a[168:171], v11, s[16:19], s53 offen sc1
MAA 32,4,144
ds_read_b128 v[20:23], v2
MAA 36,4,148
ds_read_b128 v[28:31], v2 offset:1024
MAA 36,0,132
s_waitcnt vmcnt(11)
ds_read_b128 v[24:27], v2 offset:2048
MAA 52,8,132
TR 64,16,16896
MAA 52,12,148
buffer_load_dwordx4 a[172:175], v11, s[16:19], s53 offen offset:1024 sc1
MAA 48,12,144
TR 66,16,17408
s_add_u32 s53, s53, 131072
MAA 48,8,128
TR 68,16,25344
MAA 96,16,128
TR 70,16,25856
MAA 96,20,144
TR 72,16,16928
MAA 100,20,148
buffer_load_dwordx4 a[184:187], v11, s[16:19], s53 offen sc1
MAA 100,16,132
TR 74,16,17440
s_waitcnt lgkmcnt(7)
v_add_f32 v20, v20, v28
MAA 116,24,132
TR 76,16,25376
v_add_f32 v21, v21, v29
MAA 116,28,148
TR 78,16,25888
v_add_f32 v22, v22, v30
MAA 112,28,144
TR 80,16,16960
v_add_f32 v23, v23, v31
MAA 112,24,128
buffer_load_dwordx4 a[188:191], v11, s[16:19], s53 offen offset:1024 sc1
MAA 160,32,128
ds_read_b128 v[28:31], v2 offset:3072
s_add_u32 s53, s53, 131072
MAA 160,36,144
TR 82,16,17472
s_add_u32 m0, s55, 84480
MAA 164,36,148
TR 84,16,25408
s_waitcnt lgkmcnt(12)
v_add_f32 v20, v20, v24
MAA 164,32,132
TR 86,16,25920
v_add_f32 v21, v21, v25
MAA 180,40,132
buffer_load_dwordx4 v12, s[32:35], s54 offen   lds
MAA 180,44,148
TR 88,16,16992
v_add_f32 v22, v22, v26
MAA 176,44,144
TR 90,16,17504
v_add_f32 v23, v23, v27
MAA 176,40,128
TR 92,16,25440
MAA 224,48,128
TR 94,16,25952
MAA 224,52,144
buffer_load_dwordx4 v13, s[32:35], s54 offen offset:1056   lds
MAA 228,52,148
TR 96,16,17024
MAA 228,48,132
TR 98,16,17536
MAA 236,56,132
TR 100,16,25472
MAA 236,60,148
TR 102,16,25984
MAA 232,60,144
buffer_load_dwordx4 v14, s[32:35], s54 offen offset:2112   lds
MAA 232,56,128
TR 104,16,17056
MAA 188,40,140
TR 106,16,17568
MAA 188,44,156
TR 108,16,25504
MAA 184,44,152
TR 110,16,26016
MAA 184,40,136
buffer_load_dwordx4 v15, s[32:35], s54 offen offset:3168   lds
MAA 168,32,136
TR 112,17,16896
s_add_u32 m0, s57, 6144
MAA 168,36,152
TR 114,17,17408
s_mov_b32 s58, 63182848
MAA 172,36,156
TR 116,17,25344
MAA 172,32,140
TR 118,17,25856
MAA 124,24,140
buffer_load_dwordx4 v4, s[16:19], s58 offen sc1 lds
MAA 124,28,156
TR 120,17,16928
MAA 120,28,152
TR 122,17,17440
MAA 120,24,136
TR 124,17,25376
MAA 104,16,136
TR 126,17,25888
MAA 104,20,152
buffer_load_dwordx4 v4, s[16:19], s58 offen offset:1024 sc1 lds
MAA 108,20,156
MAA 108,16,140
MAA 60,8,140
MAA 60,12,156
MAA 56,12,152
MAA 56,8,136
MAA 40,0,136
MAA 40,4,152
MAA 44,4,156
MAA 44,0,140
s_waitcnt lgkmcnt(0)
s_barrier
MAA 64,64,128
s_waitcnt vmcnt(14)
ds_read_b128 v[24:27], v2 offset:4096
s_add_u32 m0, s55, 101376
MAA 64,68,144
buffer_load_dwordx4 v12, s[80:83], s54 offen   lds
MAA 68,68,148
TR 0,16,33792
v_add_f32 v20, v20, v28
MAA 68,64,132
TR 2,16,34304
v_add_f32 v21, v21, v29
MAA 84,72,132
TR 4,16,42240
v_add_f32 v22, v22, v30
MAA 84,76,148
TR 6,16,42752
v_add_f32 v23, v23, v31
MAA 80,76,144
ds_read_b128 v[28:31], v2 offset:5120
MAA 80,72,128
TR 8,16,33824
MAA 128,80,128
buffer_load_dwordx4 v13, s[80:83], s54 offen offset:1056   lds
MAA 128,84,144
TR 10,16,34336
s_waitcnt lgkmcnt(7)
v_add_f32 v20, v20, v24
MAA 132,84,148
TR 12,16,42272
v_add_f32 v21, v21, v25
MAA 132,80,132
TR 14,16,42784
v_add_f32 v22, v22, v26
MAA 148,88,132
TR 16,16,33856
v_add_f32 v23, v23, v27
MAA 148,92,148
TR 18,16,34368
MAA 144,92,144
TR 20,16,42304
MAA 144,88,128
buffer_load_dwordx4 v14, s[80:83], s54 offen offset:2112   lds
MAA 192,96,128
TR 22,16,42816
MAA 192,100,144
TR 24,16,33888
MAA 196,100,148
TR 26,16,34400
MAA 196,96,132
TR 28,16,42336
MAA 212,104,132
TR 30,16,42848
MAA 212,108,148
TR 32,16,33920
MAA 208,108,144
buffer_load_dwordx4 v15, s[80:83], s54 offen offset:3168   lds
MAA 208,104,128
TR 34,16,34432
s_add_u32 s54, s54, 458752
MAA 240,112,128
TR 36,16,42368
MAA 240,116,144
TR 38,16,42880
MAA 244,116,148
TR 40,16,33952
MAA 244,112,132
TR 42,16,34464
MAA 252,120,132
TR 44,16,42400
MAA 252,124,148
TR 46,16,42912
MAA 248,124,144
TR 48,17,33792
MAA 248,120,128
buffer_load_dwordx4 a[128:131], v10, s[16:19], s52 offen sc1
MAA 220,104,140
TR 50,17,34304
MAA 220,108,156
TR 52,17,42240
MAA 216,108,152
TR 54,17,42752
.Lpad32:
s_cbranch_execz .Lnopoll60r
MAA 216,104,136
TR 56,17,33824
MAA 200,96,136
TR 58,17,34336
MAA 200,100,152
TR 60,17,42272
MAA 204,100,156
buffer_load_dwordx4 a[132:135], v10, s[16:19], s52 offen offset:1024 sc1
MAA 204,96,140
TR 62,17,42784
s_add_u32 s52, s52, 131072
MAA 156,88,140
MAA 156,92,156
MAA 152,92,152
MAA 152,88,136
MAA 136,80,136
MAA 136,84,152
buffer_load_dwordx4 a[144:147], v10, s[16:19], s52 offen sc1
MAA 140,84,156
MAA 140,80,140
MAA 92,72,140
MAA 92,76,156
MAA 88,76,152
MAA 88,72,136
MAA 72,64,136
buffer_load_dwordx4 a[148:151], v10, s[16:19], s52 offen offset:1024 sc1
MAA 72,68,152
s_add_u32 s52, s52, 131072
MAA 76,68,156
MAA 76,64,140
s_waitcnt vmcnt(18) lgkmcnt(0)
s_barrier
MAA 32,0,160
buffer_load_dwordx4 a[136:139], v11, s[16:19], s53 offen sc1
MAA 32,4,176
s_waitcnt vmcnt(9)
ds_read_b128 v[24:27], v2 offset:6144
v_add_f32 v20, v20, v28
MAA 36,4,180
TR 64,16,50688
v_add_f32 v21, v21, v29
MAA 36,0,164
TR 66,16,51200
v_add_f32 v22, v22, v30
MAA 52,8,164
TR 68,16,59136
v_add_f32 v23, v23, v31
MAA 52,12,180
ds_read_b128 v[28:31], v2 offset:7168
MAA 48,12,176
TR 70,16,59648
MAA 48,8,160
buffer_load_dwordx4 a[140:143], v11, s[16:19], s53 offen offset:1024 sc1
MAA 96,16,160
TR 72,16,50720
s_add_u32 s53, s53, 131072
MAA 96,20,176
TR 74,16,51232
s_waitcnt lgkmcnt(7)
v_add_f32 v20, v20, v24
MAA 100,20,180
TR 76,16,59168
v_add_f32 v21, v21, v25
MAA 100,16,164
TR 78,16,59680
v_add_f32 v22, v22, v26
MAA 116,24,164
TR 80,16,50752
v_add_f32 v23, v23, v27
MAA 116,28,180
TR 82,16,51264
s_waitcnt lgkmcnt(7)
v_add_f32 v20, v20, v28
MAA 112,28,176
buffer_load_dwordx4 a[152:155], v11, s[16:19], s53 offen sc1
MAA 112,24,160
TR 84,16,59200
v_add_f32 v21, v21, v29
MAA 160,32,160
TR 86,16,59712
v_add_f32 v22, v22, v30
MAA 160,36,176
TR 88,16,50784
v_add_f32 v23, v23, v31
MAA 164,36,180
TR 90,16,51296
MAA 164,32,164
TR 92,16,59232
MAA 180,40,164
TR 94,16,59744
MAA 180,44,180
buffer_load_dwordx4 a[156:159], v11, s[16:19], s53 offen offset:1024 sc1
MAA 176,44,176
TR 96,16,50816
s_add_u32 s53, s53, 131072
MAA 176,40,160
TR 98,16,51328
s_add_u32 m0, s55, 118272
MAA 224,48,160
TR 100,16,59264
MAA 224,52,176
TR 102,16,59776
MAA 228,52,180
TR 104,16,50848
MAA 228,48,164
TR 106,16,51360
MAA 236,56,164
buffer_load_dwordx4 v12, s[32:35], s54 offen   lds
MAA 236,60,180
TR 108,16,59296
MAA 232,60,176
TR 110,16,59808
MAA 232,56,160
TR 112,17,50688
MAA 188,40,172
TR 114,17,51200
MAA 188,44,188
TR 116,17,59136
MAA 184,44,184
TR 118,17,59648
MAA 184,40,168
buffer_load_dwordx4 v13, s[32:35], s54 offen offset:1056   lds
MAA 168,32,168
TR 120,17,50720
MAA 168,36,184
TR 122,17,51232
MAA 172,36,188
TR 124,17,59168
MAA 172,32,172
TR 126,17,59680
MAA 124,24,172
MAA 124,28,188
MAA 120,28,184
buffer_load_dwordx4 v14, s[32:35], s54 offen offset:2112   lds
MAA 120,24,168
MAA 104,16,168
MAA 104,20,184
MAA 108,20,188
MAA 108,16,172
MAA 60,8,172
MAA 60,12,188
buffer_load_dwordx4 v15, s[32:35], s54 offen offset:3168   lds
MAA 56,12,184
MAA 56,8,168
MAA 40,0,168
MAA 40,4,184
MAA 44,4,188
MAA 44,0,172
s_waitcnt lgkmcnt(0)
s_barrier
MAA 64,64,160
ds_read_b64_tr_b16 a[0:1], v16
s_add_u32 m0, s55, 135168
MAA 64,68,176
buffer_load_dwordx4 v12, s[80:83], s54 offen   lds
MAA 68,68,180
TR 2,16,512
v_permlane32_swap_b32 v20, v22
MAA 68,64,164
TR 4,16,8448
v_permlane32_swap_b32 v21, v23
MAA 84,72,164
TR 6,16,8960
v_add_f32 v20, v20, v22
MAA 84,76,180
TR 8,16,32
v_add_f32 v21, v21, v23
MAA 80,76,176
TR 10,16,544
v_mul_f32 v20, 0xba800000, v20
MAA 80,72,160
buffer_load_dwordx4 v13, s[80:83], s54 offen offset:1056   lds
MAA 128,80,160
TR 12,16,8480
v_mul_f32 v21, 0x3a800000, v21
MAA 128,84,176
TR 14,16,8992
v_fma_f32 v21, -v20, v20, v21
MAA 132,84,180
TR 16,16,64
v_max_f32 v21, 0, v21
MAA 132,80,164
TR 18,16,576
v_add_f32 v21, 0x3727c5ac, v21
MAA 148,88,164
TR 20,16,8512
v_rsq_f32 v22, v21
MAA 148,92,180
buffer_load_dwordx4 v14, s[80:83], s54 offen offset:2112   lds
MAA 144,92,176
TR 22,16,9024
v_and_b32 v24, 31, v1
MAA 144,88,160
TR 24,16,96
v_lshrrev_b32 v25, 5, v1
MAA 192,96,160
TR 26,16,608
v_lshl_add_u32 v24, v24, 1, v25
MAA 192,100,176
TR 28,16,8544
v_and_b32 v25, 0xc0, v0
MAA 196,100,180
TR 30,16,9056
v_add_u32 v24, v24, v25
MAA 196,96,164
TR 32,16,128
v_lshlrev_b32 v24, 4, v24
MAA 212,104,164
buffer_load_dwordx4 v15, s[80:83], s54 offen offset:3168   lds
MAA 212,108,180
TR 34,16,640
s_add_u32 s54, s54, 458752
MAA 208,108,176
TR 36,16,8576
v_add_u32 v24, 152576, v24
MAA 208,104,160
TR 38,16,9088
v_mul_f32 v22, 0xbfb8aa3b, v22
MAA 240,112,160
ds_write_b128 v24, v[20:23]
s_mov_b32 s58, s98
MAA 240,116,176
ds_read_b64 v[20:21], v18
s_mov_b32 s67, s59
MAA 244,116,180
ds_read_b64 v[22:23], v18 offset:256
MAA 244,112,164
ds_read_b64 v[24:25], v19
MAA 252,120,164
ds_read_b64 v[26:27], v19 offset:256
MAA 252,124,180
ds_read_b32 a192, v18 offset:8
MAA 248,124,176
ds_read_b32 a193, v18 offset:264
v_mov_b32 v18, v5
MAA 248,120,160
buffer_load_dwordx4 a[160:163], v10, s[16:19], s52 offen sc1
MAA 220,104,172
ds_read_b32 a194, v19 offset:8
MAA 220,108,188
ds_read_b32 a195, v19 offset:264
v_add_u32 v19, 992, v5
MAA 216,108,184
TR 40,16,160
MAA 216,104,168
TR 42,16,672
MAA 200,96,168
TR 44,16,8608
MAA 200,100,184
TR 46,16,9120
MAA 204,100,188
buffer_load_dwordx4 a[164:167], v10, s[16:19], s52 offen offset:1024 sc1
MAA 204,96,172
ds_read_b64_tr_b16 a[48:49], v17
s_add_u32 s52, s52, 131072
MAA 156,88,172
TR 50,17,512
MAA 156,92,188
TR 52,17,8448
MAA 152,92,184
TR 54,17,8960
MAA 152,88,168
TR 56,17,32
MAA 136,80,168
TR 58,17,544
MAA 136,84,184
buffer_load_dwordx4 a[176:179], v10, s[16:19], s52 offen sc1
MAA 140,84,188
TR 60,17,8480
MAA 140,80,172
TR 62,17,8992
MAA 92,72,172
MAA 92,76,188
MAA 88,76,184
MAA 88,72,168
MAA 72,64,168
buffer_load_dwordx4 a[180:183], v10, s[16:19], s52 offen offset:1024 sc1
MAA 72,68,184
s_add_u32 s52, s52, 131072
MAA 76,68,188
MAA 76,64,172
s_waitcnt vmcnt(16) lgkmcnt(0)
s_barrier
MAA 32,0,128
ds_read_b128 v[28:31], v9 offset:512
MAA 32,4,144
ds_read_b128 v[4:7], v9 offset:576
MAA 36,4,148
buffer_load_dwordx4 a[168:171], v11, s[16:19], s53 offen sc1
MAA 36,0,132
TR 64,16,16896
MAA 52,8,132
TR 66,16,17408
MAA 52,12,148
TR 68,16,25344
MAA 48,12,144
TR 70,16,25856
MAA 48,8,128
TR 72,16,16928
MAA 96,16,128
buffer_load_dwordx4 a[172:175], v11, s[16:19], s53 offen offset:1024 sc1
MAA 96,20,144
TR 74,16,17440
s_add_u32 s53, s53, 131072
MAA 100,20,148
TR 76,16,25376
s_waitcnt lgkmcnt(8)
v_fmac_f32 v64, v28, v20
MAA 100,16,132
TR 78,16,25888
v_fmac_f32 v65, v29, v20
MAA 116,24,132
TR 80,16,16960
v_fmac_f32 v66, v30, v20
MAA 116,28,148
TR 82,16,17472
v_fmac_f32 v67, v31, v20
MAA 112,28,144
buffer_load_dwordx4 a[184:187], v11, s[16:19], s53 offen sc1
MAA 112,24,128
TR 84,16,25408
v_fmac_f32 v68, v28, v22
MAA 160,32,128
TR 86,16,25920
v_fmac_f32 v69, v29, v22
MAA 160,36,144
TR 88,16,16992
v_fmac_f32 v70, v30, v22
MAA 164,36,148
TR 90,16,17504
v_fmac_f32 v71, v31, v22
MAA 164,32,132
TR 92,16,25440
v_fmac_f32 v72, v28, v24
MAA 180,40,132
buffer_load_dwordx4 a[188:191], v11, s[16:19], s53 offen offset:1024 sc1
MAA 180,44,148
TR 94,16,25952
s_add_u32 s53, s53, 131072
MAA 176,44,144
TR 96,16,17024
s_add_u32 m0, s55, 84480
MAA 176,40,128
TR 98,16,17536
v_fmac_f32 v73, v29, v24
MAA 224,48,128
TR 100,16,25472
v_fmac_f32 v74, v30, v24
MAA 224,52,144
TR 102,16,25984
v_fmac_f32 v75, v31, v24
MAA 228,52,148
buffer_load_dwordx4 v12, s[32:35], s54 offen   lds
MAA 228,48,132
TR 104,16,17056
v_fmac_f32 v76, v28, v26
MAA 236,56,132
TR 106,16,17568
v_fmac_f32 v77, v29, v26
MAA 236,60,148
TR 108,16,25504
v_fmac_f32 v78, v30, v26
MAA 232,60,144
TR 110,16,26016
v_fmac_f32 v79, v31, v26
MAA 232,56,128
ds_read_b128 v[28:31], v9 offset:640
s_waitcnt lgkmcnt(15)
v_fmac_f32 v80, v4, v20
s_waitcnt vmcnt(17)
MAA 188,40,140
buffer_load_dwordx4 v13, s[32:35], s54 offen offset:1056   lds
MAA 188,44,156
TR 112,17,16896
v_fmac_f32 v81, v5, v20
MAA 184,44,152
TR 114,17,17408
v_fmac_f32 v82, v6, v20
MAA 184,40,136
TR 116,17,25344
v_fmac_f32 v83, v7, v20
MAA 168,32,136
TR 118,17,25856
v_fmac_f32 v84, v4, v22
MAA 168,36,152
TR 120,17,16928
v_fmac_f32 v85, v5, v22
MAA 172,36,156
buffer_load_dwordx4 v14, s[32:35], s54 offen offset:2112   lds
MAA 172,32,140
TR 122,17,17440
v_fmac_f32 v86, v6, v22
MAA 124,24,140
TR 124,17,25376
v_fmac_f32 v87, v7, v22
MAA 124,28,156
TR 126,17,25888
v_fmac_f32 v88, v4, v24
MAA 120,28,152
v_fmac_f32 v89, v5, v24
v_fmac_f32 v90, v6, v24
MAA 120,24,136
v_fmac_f32 v91, v7, v24
v_fmac_f32 v92, v4, v26
MAA 104,16,136
buffer_load_dwordx4 v15, s[32:35], s54 offen offset:3168   lds
MAA 104,20,152
s_mov_b32 m0, s67
v_fmac_f32 v93, v5, v26
v_fmac_f32 v94, v6, v26
MAA 108,20,156
v_fmac_f32 v95, v7, v26
s_waitcnt lgkmcnt(8)
v_fmac_f32 v128, v28, v20
MAA 108,16,140
ds_read_b128 v[4:7], v8 offset:512
v_fmac_f32 v129, v29, v20
MAA 60,8,140
v_fmac_f32 v130, v30, v20
v_fmac_f32 v131, v31, v20
MAA 60,12,156
v_fmac_f32 v132, v28, v22
v_fmac_f32 v133, v29, v22
MAA 56,12,152
buffer_load_dwordx4 v18, s[28:31], s58 offen lds
MAA 56,8,136
v_fmac_f32 v134, v30, v22
v_fmac_f32 v135, v31, v22
MAA 40,0,136
v_fmac_f32 v136, v28, v24
v_fmac_f32 v137, v29, v24
MAA 40,4,152
v_fmac_f32 v138, v30, v24
v_fmac_f32 v139, v31, v24
MAA 44,4,156
v_fmac_f32 v140, v28, v26
v_fmac_f32 v141, v29, v26
MAA 44,0,140
v_fmac_f32 v142, v30, v26
v_fmac_f32 v143, v31, v26
s_waitcnt lgkmcnt(0)
v_fmac_f32 v240, v4, v20
v_fmac_f32 v241, v5, v20
v_fmac_f32 v242, v6, v20
v_fmac_f32 v243, v7, v20
v_fmac_f32 v244, v4, v22
v_fmac_f32 v245, v5, v22
v_fmac_f32 v246, v6, v22
v_fmac_f32 v247, v7, v22
s_waitcnt vmcnt(17) lgkmcnt(0)
s_barrier
MAA 64,64,128
ds_read_b128 v[28:31], v9
s_add_u32 m0, s55, 101376
MAA 64,68,144
ds_read_b128 v[4:7], v9 offset:64
MAA 68,68,148
buffer_load_dwordx4 v12, s[80:83], s54 offen   lds
MAA 68,64,132
TR 0,16,33792
MAA 84,72,132
TR 2,16,34304
MAA 84,76,148
TR 4,16,42240
MAA 80,76,144
TR 6,16,42752
MAA 80,72,128
TR 8,16,33824
MAA 128,80,128
buffer_load_dwordx4 v13, s[80:83], s54 offen offset:1056   lds
MAA 128,84,144
TR 10,16,34336
s_waitcnt lgkmcnt(7)
v_fmac_f32 v32, v28, v20
MAA 132,84,148
TR 12,16,42272
v_fmac_f32 v33, v29, v20
MAA 132,80,132
TR 14,16,42784
v_fmac_f32 v34, v30, v20
MAA 148,88,132
TR 16,16,33856
v_fmac_f32 v35, v31, v20
MAA 148,92,148
TR 18,16,34368
v_fmac_f32 v36, v28, v22
MAA 144,92,144
buffer_load_dwordx4 v14, s[80:83], s54 offen offset:2112   lds
MAA 144,88,128
TR 20,16,42304
v_fmac_f32 v37, v29, v22
MAA 192,96,128
TR 22,16,42816
v_fmac_f32 v38, v30, v22
MAA 192,100,144
TR 24,16,33888
v_fmac_f32 v39, v31, v22
MAA 196,100,148
TR 26,16,34400
v_fmac_f32 v40, v28, v24
MAA 196,96,132
TR 28,16,42336
v_fmac_f32 v41, v29, v24
MAA 212,104,132
buffer_load_dwordx4 v15, s[80:83], s54 offen offset:3168   lds
MAA 212,108,148
TR 30,16,42848
s_add_u32 s54, s54, 458752
MAA 208,108,144
TR 32,16,33920
s_mov_b32 m0, s67
MAA 208,104,128
TR 34,16,34432
v_fmac_f32 v42, v30, v24
MAA 240,112,128
TR 36,16,42368
v_fmac_f32 v43, v31, v24
MAA 240,116,144
TR 38,16,42880
v_fmac_f32 v44, v28, v26
MAA 244,116,148
buffer_load_dwordx4 v19, s[28:31], s58 offen offset:1056 lds
MAA 244,112,132
TR 40,16,33952
s_add_u32 s67, s67, 8448
MAA 252,120,132
TR 42,16,34464
s_add_u32 s58, s58, 0x40000
MAA 252,124,148
TR 44,16,42400
v_fmac_f32 v45, v29, v26
MAA 248,124,144
TR 46,16,42912
v_fmac_f32 v46, v30, v26
MAA 248,120,128
TR 48,17,33792
v_fmac_f32 v47, v31, v26
MAA 220,104,140
ds_read_b128 v[28:31], v9 offset:128
s_waitcnt lgkmcnt(15)
v_fmac_f32 v48, v4, v20
MAA 220,108,156
buffer_load_dwordx4 a[128:131], v10, s[16:19], s52 offen sc1
MAA 216,108,152
TR 50,17,34304
v_fmac_f32 v49, v5, v20
MAA 216,104,136
TR 52,17,42240
v_fmac_f32 v50, v6, v20
MAA 200,96,136
TR 54,17,42752
v_fmac_f32 v51, v7, v20
MAA 200,100,152
TR 56,17,33824
v_fmac_f32 v52, v4, v22
MAA 204,100,156
TR 58,17,34336
v_fmac_f32 v53, v5, v22
MAA 204,96,140
buffer_load_dwordx4 a[132:135], v10, s[16:19], s52 offen offset:1024 sc1
MAA 156,88,140
TR 60,17,42272
s_add_u32 s52, s52, 131072
MAA 156,92,156
TR 62,17,42784
v_fmac_f32 v54, v6, v22
MAA 152,92,152
v_fmac_f32 v55, v7, v22
v_fmac_f32 v56, v4, v24
MAA 152,88,136
v_fmac_f32 v57, v5, v24
v_fmac_f32 v58, v6, v24
MAA 136,80,136
v_fmac_f32 v59, v7, v24
v_fmac_f32 v60, v4, v26
MAA 136,84,152
.Lpad33:
s_cbranch_execz .Lnopoll60r
buffer_load_dwordx4 a[144:147], v10, s[16:19], s52 offen sc1
MAA 140,84,156
v_fmac_f32 v61, v5, v26
v_fmac_f32 v62, v6, v26
MAA 140,80,140
v_fmac_f32 v63, v7, v26
s_waitcnt lgkmcnt(7)
v_fmac_f32 v96, v28, v20
MAA 92,72,140
ds_read_b128 v[4:7], v8
v_fmac_f32 v97, v29, v20
MAA 92,76,156
v_fmac_f32 v98, v30, v20
v_fmac_f32 v99, v31, v20
MAA 88,76,152
v_fmac_f32 v100, v28, v22
v_fmac_f32 v101, v29, v22
MAA 88,72,136
buffer_load_dwordx4 a[148:151], v10, s[16:19], s52 offen offset:1024 sc1
MAA 72,64,136
s_add_u32 s52, s52, 131072
v_fmac_f32 v102, v30, v22
v_fmac_f32 v103, v31, v22
MAA 72,68,152
v_fmac_f32 v104, v28, v24
v_fmac_f32 v105, v29, v24
MAA 76,68,156
v_fmac_f32 v106, v30, v24
v_fmac_f32 v107, v31, v24
MAA 76,64,140
v_fmac_f32 v108, v28, v26
v_fmac_f32 v109, v29, v26
v_fmac_f32 v110, v30, v26
v_fmac_f32 v111, v31, v26
s_waitcnt lgkmcnt(0)
v_fmac_f32 v224, v4, v20
v_fmac_f32 v225, v5, v20
v_fmac_f32 v226, v6, v20
v_fmac_f32 v227, v7, v20
v_fmac_f32 v228, v4, v22
v_fmac_f32 v229, v5, v22
v_fmac_f32 v230, v6, v22
v_fmac_f32 v231, v7, v22
s_waitcnt vmcnt(18) lgkmcnt(0)
s_barrier
MAA 32,0,160
ds_read_b128 v[28:31], v9 offset:704
MAA 32,4,176
ds_read_b128 v[4:7], v9 offset:768
MAA 36,4,180
buffer_load_dwordx4 a[136:139], v11, s[16:19], s53 offen sc1
MAA 36,0,164
TR 64,16,50688
MAA 52,8,164
TR 66,16,51200
MAA 52,12,180
TR 68,16,59136
MAA 48,12,176
TR 70,16,59648
MAA 48,8,160
TR 72,16,50720
MAA 96,16,160
buffer_load_dwordx4 a[140:143], v11, s[16:19], s53 offen offset:1024 sc1
MAA 96,20,176
TR 74,16,51232
s_add_u32 s53, s53, 131072
MAA 100,20,180
TR 76,16,59168
s_waitcnt lgkmcnt(8)
v_fmac_f32 v144, v28, v20
MAA 100,16,164
TR 78,16,59680
v_fmac_f32 v145, v29, v20
MAA 116,24,164
TR 80,16,50752
v_fmac_f32 v146, v30, v20
MAA 116,28,180
TR 82,16,51264
v_fmac_f32 v147, v31, v20
MAA 112,28,176
buffer_load_dwordx4 a[152:155], v11, s[16:19], s53 offen sc1
MAA 112,24,160
TR 84,16,59200
v_fmac_f32 v148, v28, v22
MAA 160,32,160
TR 86,16,59712
v_fmac_f32 v149, v29, v22
MAA 160,36,176
TR 88,16,50784
v_fmac_f32 v150, v30, v22
MAA 164,36,180
TR 90,16,51296
v_fmac_f32 v151, v31, v22
MAA 164,32,164
TR 92,16,59232
v_fmac_f32 v152, v28, v24
MAA 180,40,164
buffer_load_dwordx4 a[156:159], v11, s[16:19], s53 offen offset:1024 sc1
MAA 180,44,180
TR 94,16,59744
s_add_u32 s53, s53, 131072
MAA 176,44,176
TR 96,16,50816
s_add_u32 m0, s55, 118272
MAA 176,40,160
TR 98,16,51328
v_fmac_f32 v153, v29, v24
MAA 224,48,160
TR 100,16,59264
v_fmac_f32 v154, v30, v24
MAA 224,52,176
TR 102,16,59776
v_fmac_f32 v155, v31, v24
MAA 228,52,180
buffer_load_dwordx4 v12, s[32:35], s54 offen   lds
MAA 228,48,164
TR 104,16,50848
v_fmac_f32 v156, v28, v26
MAA 236,56,164
TR 106,16,51360
v_fmac_f32 v157, v29, v26
MAA 236,60,180
TR 108,16,59296
v_fmac_f32 v158, v30, v26
MAA 232,60,176
TR 110,16,59808
v_fmac_f32 v159, v31, v26
MAA 232,56,160
ds_read_b128 v[28:31], v9 offset:832
s_waitcnt lgkmcnt(15)
v_fmac_f32 v192, v4, v20
s_waitcnt vmcnt(19)
MAA 188,40,172
buffer_load_dwordx4 v13, s[32:35], s54 offen offset:1056   lds
MAA 188,44,188
TR 112,17,50688
v_fmac_f32 v193, v5, v20
MAA 184,44,184
TR 114,17,51200
v_fmac_f32 v194, v6, v20
MAA 184,40,168
TR 116,17,59136
v_fmac_f32 v195, v7, v20
MAA 168,32,168
TR 118,17,59648
v_fmac_f32 v196, v4, v22
MAA 168,36,184
TR 120,17,50720
v_fmac_f32 v197, v5, v22
MAA 172,36,188
buffer_load_dwordx4 v14, s[32:35], s54 offen offset:2112   lds
MAA 172,32,172
TR 122,17,51232
v_fmac_f32 v198, v6, v22
MAA 124,24,172
TR 124,17,59168
v_fmac_f32 v199, v7, v22
MAA 124,28,188
TR 126,17,59680
v_fmac_f32 v200, v4, v24
MAA 120,28,184
v_fmac_f32 v201, v5, v24
v_fmac_f32 v202, v6, v24
MAA 120,24,168
v_fmac_f32 v203, v7, v24
v_fmac_f32 v204, v4, v26
MAA 104,16,168
buffer_load_dwordx4 v15, s[32:35], s54 offen offset:3168   lds
MAA 104,20,184
s_mov_b32 m0, s67
v_fmac_f32 v205, v5, v26
v_fmac_f32 v206, v6, v26
MAA 108,20,188
v_fmac_f32 v207, v7, v26
s_waitcnt lgkmcnt(8)
v_fmac_f32 v208, v28, v20
MAA 108,16,172
ds_read_b128 v[4:7], v8 offset:576
v_fmac_f32 v209, v29, v20
MAA 60,8,172
v_fmac_f32 v210, v30, v20
v_fmac_f32 v211, v31, v20
MAA 60,12,188
v_fmac_f32 v212, v28, v22
v_fmac_f32 v213, v29, v22
MAA 56,12,184
buffer_load_dwordx4 v18, s[28:31], s58 offen lds
MAA 56,8,168
v_fmac_f32 v214, v30, v22
v_fmac_f32 v215, v31, v22
MAA 40,0,168
v_fmac_f32 v216, v28, v24
v_fmac_f32 v217, v29, v24
MAA 40,4,184
v_fmac_f32 v218, v30, v24
v_fmac_f32 v219, v31, v24
MAA 44,4,188
v_fmac_f32 v220, v28, v26
v_fmac_f32 v221, v29, v26
MAA 44,0,172
v_fmac_f32 v222, v30, v26
v_fmac_f32 v223, v31, v26
s_waitcnt lgkmcnt(0)
v_fmac_f32 v248, v4, v20
v_fmac_f32 v249, v5, v20
v_fmac_f32 v250, v6, v20
v_fmac_f32 v251, v7, v20
v_fmac_f32 v252, v4, v22
v_fmac_f32 v253, v5, v22
v_fmac_f32 v254, v6, v22
v_fmac_f32 v255, v7, v22
s_waitcnt vmcnt(19) lgkmcnt(0)
s_barrier
MAA 64,64,160
ds_read_b128 v[28:31], v9 offset:192
s_add_u32 m0, s55, 135168
MAA 64,68,176
ds_read_b128 v[4:7], v9 offset:256
MAA 68,68,180
buffer_load_dwordx4 v12, s[80:83], s54 offen   lds
MAA 68,64,164
ds_read_b64_tr_b16 a[0:1], v16
MAA 84,72,164
TR 2,16,512
MAA 84,76,180
TR 4,16,8448
MAA 80,76,176
TR 6,16,8960
MAA 80,72,160
TR 8,16,32
MAA 128,80,160
buffer_load_dwordx4 v13, s[80:83], s54 offen offset:1056   lds
MAA 128,84,176
TR 10,16,544
s_waitcnt lgkmcnt(7)
v_fmac_f32 v112, v28, v20
MAA 132,84,180
TR 12,16,8480
v_fmac_f32 v113, v29, v20
MAA 132,80,164
TR 14,16,8992
v_fmac_f32 v114, v30, v20
MAA 148,88,164
TR 16,16,64
v_fmac_f32 v115, v31, v20
MAA 148,92,180
TR 18,16,576
v_fmac_f32 v116, v28, v22
MAA 144,92,176
buffer_load_dwordx4 v14, s[80:83], s54 offen offset:2112   lds
MAA 144,88,160
TR 20,16,8512
v_fmac_f32 v117, v29, v22
MAA 192,96,160
TR 22,16,9024
v_fmac_f32 v118, v30, v22
MAA 192,100,176
TR 24,16,96
v_fmac_f32 v119, v31, v22
MAA 196,100,180
TR 26,16,608
v_fmac_f32 v120, v28, v24
MAA 196,96,164
TR 28,16,8544
v_fmac_f32 v121, v29, v24
MAA 212,104,164
buffer_load_dwordx4 v15, s[80:83], s54 offen offset:3168   lds
MAA 212,108,180
TR 30,16,9056
s_add_u32 s54, s54, 458752
MAA 208,108,176
TR 32,16,128
s_mov_b32 m0, s67
MAA 208,104,160
TR 34,16,640
v_fmac_f32 v122, v30, v24
MAA 240,112,160
TR 36,16,8576
v_fmac_f32 v123, v31, v24
MAA 240,116,176
TR 38,16,9088
v_fmac_f32 v124, v28, v26
MAA 244,116,180
buffer_load_dwordx4 v19, s[28:31], s58 offen offset:1056 lds
MAA 244,112,164
TR 40,16,160
s_add_u32 s67, s67, 8448
MAA 252,120,164
TR 42,16,672
s_add_u32 s46, s46, 1
MAA 252,124,180
TR 44,16,8608
s_xor_b32 s58, s46, s87
MAA 248,124,176
TR 46,16,9120
s_mul_i32 s58, s58, 458752
MAA 248,120,160
ds_read_b64_tr_b16 a[48:49], v17
v_fmac_f32 v125, v29, v26
MAA 220,104,172
buffer_load_dwordx4 a[160:163], v10, s[16:19], s52 offen sc1
MAA 220,108,188
TR 50,17,512
v_fmac_f32 v126, v30, v26
MAA 216,108,184
TR 52,17,8448
v_fmac_f32 v127, v31, v26
MAA 216,104,168
ds_read_b128 v[28:31], v9 offset:320
s_waitcnt lgkmcnt(15)
v_fmac_f32 v160, v4, v20
MAA 200,96,168
TR 54,17,8960
v_fmac_f32 v161, v5, v20
MAA 200,100,184
TR 56,17,32
v_fmac_f32 v162, v6, v20
MAA 204,100,188
buffer_load_dwordx4 a[164:167], v10, s[16:19], s52 offen offset:1024 sc1
MAA 204,96,172
TR 58,17,544
s_add_u32 s52, s52, 131072
MAA 156,88,172
TR 60,17,8480
v_fmac_f32 v163, v7, v20
MAA 156,92,188
TR 62,17,8992
v_fmac_f32 v164, v4, v22
MAA 152,92,184
v_fmac_f32 v165, v5, v22
v_fmac_f32 v166, v6, v22
MAA 152,88,168
v_fmac_f32 v167, v7, v22
v_fmac_f32 v168, v4, v24
MAA 136,80,168
buffer_load_dwordx4 a[176:179], v10, s[16:19], s52 offen sc1
MAA 136,84,184
v_fmac_f32 v169, v5, v24
v_fmac_f32 v170, v6, v24
MAA 140,84,188
v_fmac_f32 v171, v7, v24
v_fmac_f32 v172, v4, v26
MAA 140,80,172
v_fmac_f32 v173, v5, v26
v_fmac_f32 v174, v6, v26
MAA 92,72,172
v_fmac_f32 v175, v7, v26
s_waitcnt lgkmcnt(5)
v_fmac_f32 v176, v28, v20
MAA 92,76,188
ds_read_b128 v[4:7], v8 offset:64
v_fmac_f32 v177, v29, v20
MAA 88,76,184
buffer_load_dwordx4 a[180:183], v10, s[16:19], s52 offen offset:1024 sc1
MAA 88,72,168
s_add_u32 s52, s52, 131072
v_fmac_f32 v178, v30, v20
v_fmac_f32 v179, v31, v20
MAA 72,64,168
v_fmac_f32 v180, v28, v22
v_fmac_f32 v181, v29, v22
MAA 72,68,184
v_fmac_f32 v182, v30, v22
v_fmac_f32 v183, v31, v22
MAA 76,68,188
v_fmac_f32 v184, v28, v24
v_fmac_f32 v185, v29, v24
MAA 76,64,172
v_fmac_f32 v186, v30, v24
v_fmac_f32 v187, v31, v24
v_fmac_f32 v188, v28, v26
v_fmac_f32 v189, v29, v26
v_fmac_f32 v190, v30, v26
v_fmac_f32 v191, v31, v26
v_accvgpr_read_b32 v28, a192
s_waitcnt lgkmcnt(0)
v_fmac_f32 v232, v4, v20
v_fmac_f32 v233, v5, v20
v_fmac_f32 v234, v6, v20
v_fmac_f32 v235, v7, v20
v_fmac_f32 v236, v4, v22
v_fmac_f32 v237, v5, v22
v_fmac_f32 v238, v6, v22
v_fmac_f32 v239, v7, v22
v_accvgpr_read_b32 v29, a193
v_accvgpr_read_b32 v30, a194
v_accvgpr_read_b32 v31, a195
s_mov_b32 s15, -4
.p2align 6
.Lk65:
s_waitcnt vmcnt(18) lgkmcnt(0)
s_barrier
MAA 32,0,128
TR 64,16,16896
MAA 32,4,144
buffer_load_dwordx4 a[168:171], v11, s[16:19], s53 offen sc1
MAA 36,4,148
TR 66,16,17408
MAA 36,0,132
TR 68,16,25344
MAA 52,8,132
TR 70,16,25856
MAA 52,12,148
MAA 48,12,144
TR 72,16,16928
MAA 48,8,128
buffer_load_dwordx4 a[172:175], v11, s[16:19], s53 offen offset:1024 sc1
MAA 96,16,128
TR 74,16,17440
s_add_u32 s53, s53, 131072
MAA 96,20,144
TR 76,16,25376
MAA 100,20,148
MAA 100,16,132
TR 78,16,25888
MAA 116,24,132
TR 80,16,16960
MAA 116,28,148
buffer_load_dwordx4 a[184:187], v11, s[16:19], s53 offen sc1
MAA 112,28,144
TR 82,16,17472
MAA 112,24,128
MAA 160,32,128
TR 84,16,25408
MAA 160,36,144
TR 86,16,25920
MAA 164,36,148
TR 88,16,16992
MAA 164,32,132
buffer_load_dwordx4 a[188:191], v11, s[16:19], s53 offen offset:1024 sc1
MAA 180,40,132
s_add_u32 s53, s53, 131072
MAA 180,44,148
TR 90,16,17504
MAA 176,44,144
TR 92,16,25440
MAA 176,40,128
TR 94,16,25952
MAA 224,48,128
s_add_u32 m0, s55, 84480
MAA 224,52,144
buffer_load_dwordx4 v12, s[32:35], s54 offen   lds
MAA 228,52,148
TR 96,16,17024
MAA 228,48,132
TR 98,16,17536
MAA 236,56,132
TR 100,16,25472
MAA 236,60,148
TR 102,16,25984
MAA 232,60,144
MAA 232,56,128
TR 104,16,17056
s_waitcnt vmcnt(19)
MAA 188,40,140
TR 106,16,17568
MAA 188,44,156
buffer_load_dwordx4 v13, s[32:35], s54 offen offset:1056   lds
MAA 184,44,152
TR 108,16,25504
MAA 184,40,136
MAA 168,32,136
TR 110,16,26016
MAA 168,36,152
buffer_load_dwordx4 v14, s[32:35], s54 offen offset:2112   lds
MAA 172,36,156
TR 112,17,16896
MAA 172,32,140
TR 114,17,17408
MAA 124,24,140
MAA 124,28,156
TR 116,17,25344
MAA 120,28,152
TR 118,17,25856
MAA 120,24,136
buffer_load_dwordx4 v15, s[32:35], s54 offen offset:3168   lds
MAA 104,16,136
TR 120,17,16928
MAA 104,20,152
MAA 108,20,156
TR 122,17,17440
MAA 108,16,140
TR 124,17,25376
MAA 60,8,140
TR 126,17,25888
s_mov_b32 m0, s67
MAA 60,12,156
buffer_load_dwordx4 v18, s[28:31], s58 offen lds
MAA 56,12,152
MAA 56,8,136
MAA 40,0,136
MAA 40,4,152
MAA 44,4,156
MAA 44,0,140
s_waitcnt vmcnt(19) lgkmcnt(0)
s_barrier
MAA 64,64,128
TR 0,16,33792
s_add_u32 m0, s55, 101376
MAA 64,68,144
buffer_load_dwordx4 v12, s[80:83], s54 offen   lds
MAA 68,68,148
TR 2,16,34304
MAA 68,64,132
TR 4,16,42240
MAA 84,72,132
TR 6,16,42752
MAA 84,76,148
MAA 80,76,144
TR 8,16,33824
MAA 80,72,128
buffer_load_dwordx4 v13, s[80:83], s54 offen offset:1056   lds
MAA 128,80,128
TR 10,16,34336
MAA 128,84,144
TR 12,16,42272
MAA 132,84,148
TR 14,16,42784
MAA 132,80,132
MAA 148,88,132
TR 16,16,33856
MAA 148,92,148
buffer_load_dwordx4 v14, s[80:83], s54 offen offset:2112   lds
MAA 144,92,144
TR 18,16,34368
MAA 144,88,128
TR 20,16,42304
MAA 192,96,128
MAA 192,100,144
TR 22,16,42816
MAA 196,100,148
TR 24,16,33888
MAA 196,96,132
buffer_load_dwordx4 v15, s[80:83], s54 offen offset:3168   lds
MAA 212,104,132
TR 26,16,34400
s_add_u32 s54, s54, 458752
MAA 212,108,148
TR 28,16,42336
MAA 208,108,144
MAA 208,104,128
TR 30,16,42848
MAA 240,112,128
TR 32,16,33920
s_mov_b32 m0, s67
MAA 240,116,144
buffer_load_dwordx4 v19, s[28:31], s58 offen offset:1056 lds
MAA 244,116,148
s_add_u32 s67, s67, 8448
s_add_u32 s58, s58, 0x40000
MAA 244,112,132
TR 34,16,34432
MAA 252,120,132
MAA 252,124,148
TR 36,16,42368
MAA 248,124,144
TR 38,16,42880
MAA 248,120,128
buffer_load_dwordx4 a[128:131], v10, s[16:19], s52 offen sc1
MAA 220,104,140
TR 40,16,33952
MAA 220,108,156
TR 42,16,34464
MAA 216,108,152
MAA 216,104,136
TR 44,16,42400
MAA 200,96,136
TR 46,16,42912
MAA 200,100,152
buffer_load_dwordx4 a[132:135], v10, s[16:19], s52 offen offset:1024 sc1
MAA 204,100,156
TR 48,17,33792
s_add_u32 s52, s52, 131072
MAA 204,96,140
MAA 156,88,140
TR 50,17,34304
MAA 156,92,156
TR 52,17,42240
MAA 152,92,152
TR 54,17,42752
MAA 152,88,136
buffer_load_dwordx4 a[144:147], v10, s[16:19], s52 offen sc1
MAA 136,80,136
TR 56,17,33824
MAA 136,84,152
MAA 140,84,156
TR 58,17,34336
MAA 140,80,140
TR 60,17,42272
MAA 92,72,140
TR 62,17,42784
MAA 92,76,156
buffer_load_dwordx4 a[148:151], v10, s[16:19], s52 offen offset:1024 sc1
MAA 88,76,152
.Lpad34:
s_cbranch_execz .Lnopoll60r
s_add_u32 s52, s52, 131072
MAA 88,72,136
MAA 72,64,136
MAA 72,68,152
MAA 76,68,156
MAA 76,64,140
s_waitcnt vmcnt(18) lgkmcnt(0)
s_barrier
MAA 32,0,160
TR 64,16,50688
MAA 32,4,176
buffer_load_dwordx4 a[136:139], v11, s[16:19], s53 offen sc1
MAA 36,4,180
TR 66,16,51200
MAA 36,0,164
TR 68,16,59136
MAA 52,8,164
TR 70,16,59648
MAA 52,12,180
MAA 48,12,176
TR 72,16,50720
MAA 48,8,160
buffer_load_dwordx4 a[140:143], v11, s[16:19], s53 offen offset:1024 sc1
MAA 96,16,160
TR 74,16,51232
s_add_u32 s53, s53, 131072
MAA 96,20,176
TR 76,16,59168
MAA 100,20,180
MAA 100,16,164
TR 78,16,59680
MAA 116,24,164
TR 80,16,50752
MAA 116,28,180
buffer_load_dwordx4 a[152:155], v11, s[16:19], s53 offen sc1
MAA 112,28,176
TR 82,16,51264
MAA 112,24,160
MAA 160,32,160
TR 84,16,59200
MAA 160,36,176
TR 86,16,59712
MAA 164,36,180
TR 88,16,50784
MAA 164,32,164
buffer_load_dwordx4 a[156:159], v11, s[16:19], s53 offen offset:1024 sc1
MAA 180,40,164
s_add_u32 s53, s53, 131072
MAA 180,44,180
TR 90,16,51296
MAA 176,44,176
TR 92,16,59232
MAA 176,40,160
TR 94,16,59744
MAA 224,48,160
s_add_u32 m0, s55, 118272
MAA 224,52,176
buffer_load_dwordx4 v12, s[32:35], s54 offen   lds
MAA 228,52,180
TR 96,16,50816
MAA 228,48,164
TR 98,16,51328
MAA 236,56,164
TR 100,16,59264
MAA 236,60,180
TR 102,16,59776
MAA 232,60,176
MAA 232,56,160
TR 104,16,50848
s_waitcnt vmcnt(19)
MAA 188,40,172
TR 106,16,51360
MAA 188,44,188
buffer_load_dwordx4 v13, s[32:35], s54 offen offset:1056   lds
MAA 184,44,184
TR 108,16,59296
MAA 184,40,168
MAA 168,32,168
TR 110,16,59808
MAA 168,36,184
buffer_load_dwordx4 v14, s[32:35], s54 offen offset:2112   lds
MAA 172,36,188
TR 112,17,50688
MAA 172,32,172
TR 114,17,51200
MAA 124,24,172
MAA 124,28,188
TR 116,17,59136
MAA 120,28,184
TR 118,17,59648
MAA 120,24,168
buffer_load_dwordx4 v15, s[32:35], s54 offen offset:3168   lds
MAA 104,16,168
TR 120,17,50720
MAA 104,20,184
MAA 108,20,188
TR 122,17,51232
MAA 108,16,172
TR 124,17,59168
MAA 60,8,172
TR 126,17,59680
s_mov_b32 m0, s67
MAA 60,12,188
buffer_load_dwordx4 v18, s[28:31], s58 offen lds
MAA 56,12,184
MAA 56,8,168
MAA 40,0,168
MAA 40,4,184
MAA 44,4,188
MAA 44,0,172
s_waitcnt vmcnt(19) lgkmcnt(0)
s_barrier
MAA 64,64,160
ds_read_b64_tr_b16 a[0:1], v16
s_add_u32 m0, s55, 135168
MAA 64,68,176
buffer_load_dwordx4 v12, s[80:83], s54 offen   lds
MAA 68,68,180
TR 2,16,512
MAA 68,64,164
TR 4,16,8448
MAA 84,72,164
TR 6,16,8960
MAA 84,76,180
MAA 80,76,176
TR 8,16,32
MAA 80,72,160
buffer_load_dwordx4 v13, s[80:83], s54 offen offset:1056   lds
MAA 128,80,160
TR 10,16,544
MAA 128,84,176
TR 12,16,8480
MAA 132,84,180
TR 14,16,8992
MAA 132,80,164
MAA 148,88,164
TR 16,16,64
MAA 148,92,180
buffer_load_dwordx4 v14, s[80:83], s54 offen offset:2112   lds
MAA 144,92,176
TR 18,16,576
MAA 144,88,160
TR 20,16,8512
MAA 192,96,160
MAA 192,100,176
TR 22,16,9024
MAA 196,100,180
TR 24,16,96
MAA 196,96,164
buffer_load_dwordx4 v15, s[80:83], s54 offen offset:3168   lds
MAA 212,104,164
TR 26,16,608
s_add_u32 s54, s54, 458752
MAA 212,108,180
TR 28,16,8544
MAA 208,108,176
MAA 208,104,160
TR 30,16,9056
MAA 240,112,160
TR 32,16,128
s_mov_b32 m0, s67
MAA 240,116,176
buffer_load_dwordx4 v19, s[28:31], s58 offen offset:1056 lds
MAA 244,116,180
s_add_u32 s67, s67, 8448
s_add_u32 s46, s46, 1
s_xor_b32 s58, s46, s87
s_mul_i32 s58, s58, 458752
MAA 244,112,164
TR 34,16,640
MAA 252,120,164
MAA 252,124,180
TR 36,16,8576
MAA 248,124,176
TR 38,16,9088
MAA 248,120,160
buffer_load_dwordx4 a[160:163], v10, s[16:19], s52 offen sc1
MAA 220,104,172
TR 40,16,160
MAA 220,108,188
TR 42,16,672
MAA 216,108,184
MAA 216,104,168
TR 44,16,8608
MAA 200,96,168
TR 46,16,9120
MAA 200,100,184
buffer_load_dwordx4 a[164:167], v10, s[16:19], s52 offen offset:1024 sc1
MAA 204,100,188
ds_read_b64_tr_b16 a[48:49], v17
s_add_u32 s52, s52, 131072
MAA 204,96,172
MAA 156,88,172
TR 50,17,512
MAA 156,92,188
TR 52,17,8448
MAA 152,92,184
TR 54,17,8960
MAA 152,88,168
buffer_load_dwordx4 a[176:179], v10, s[16:19], s52 offen sc1
MAA 136,80,168
TR 56,17,32
MAA 136,84,184
MAA 140,84,188
TR 58,17,544
MAA 140,80,172
TR 60,17,8480
MAA 92,72,172
TR 62,17,8992
MAA 92,76,188
buffer_load_dwordx4 a[180:183], v10, s[16:19], s52 offen offset:1024 sc1
MAA 88,76,184
s_add_u32 s52, s52, 131072
MAA 88,72,168
MAA 72,64,168
MAA 72,68,184
MAA 76,68,188
s_add_u32 s15, s15, 1
MAA 76,64,172
s_cbranch_scc0 .Lk65
s_waitcnt vmcnt(10) lgkmcnt(0)
s_barrier
MAA 32,0,128
buffer_load_dwordx4 a[168:171], v11, s[16:19], s53 offen sc1
MAA 32,4,144
TR 64,16,16896
s_add_u32 s58, s99, 2293760
MAA 48,12,144
TR 66,16,17408
s_lshl_b32 s74, s3, 11
MAA 48,8,128
TR 68,16,25344
s_add_u32 s74, s74, s84
MAA 36,0,132
buffer_load_dwordx4 a[172:175], v11, s[16:19], s53 offen offset:1024 sc1
MAA 36,4,148
TR 70,16,25856
s_add_u32 s53, s53, 131072
MAA 52,12,148
TR 72,16,16928
v_lshl_add_u32 v4, v1, 4, s74
MAA 52,8,132
TR 74,16,17440
v_lshrrev_b32 v2, 3, v1
MAA 40,0,136
buffer_load_dwordx4 a[184:187], v11, s[16:19], s53 offen sc1
MAA 40,4,152
TR 76,16,25376
v_cmp_eq_u32 vcc, 3, v2
MAA 56,12,152
TR 78,16,25888
v_add_u32 v2, 67108480, v4
MAA 56,8,136
TR 80,16,33792
v_cndmask_b32 v4, v4, v2, vcc
MAA 44,0,140
buffer_load_dwordx4 a[188:191], v11, s[16:19], s53 offen offset:1024 sc1
MAA 44,4,156
TR 82,16,34304
s_add_u32 s53, s53, 131072
MAA 60,12,156
TR 84,16,42240
s_and_b32 s74, s7, 1
MAA 60,8,140
TR 86,16,42752
s_add_u32 s54, s98, 65536
MAA 96,16,128
TR 88,16,33824
v_bfe_u32 v7, v1, 2, 3
MAA 96,20,144
TR 90,16,34336
v_mul_u32_u24 v7, 1056, v7
MAA 112,28,144
TR 92,16,42272
s_waitcnt vmcnt(9)
s_barrier
MAA 112,24,128
TR 94,16,42784
v_bfe_u32 v2, v1, 5, 1
MAA 100,16,132
TR 96,16,50688
v_lshl_add_u32 v7, v2, 8, v7
MAA 100,20,148
TR 98,16,51200
v_and_b32 v2, 3, v1
MAA 116,28,148
TR 100,16,59136
v_lshl_add_u32 v7, v2, 3, v7
MAA 116,24,132
TR 102,16,59648
s_lshl_b32 s74, s74, 7
MAA 104,16,136
TR 104,16,50720
s_xor_b32 s75, s74, 128
MAA 104,20,152
TR 106,16,51232
v_add_u32 v6, s75, v7
MAA 120,28,152
TR 108,16,59168
v_add_u32 v7, s74, v7
MAA 120,24,136
TR 110,16,59680
s_mul_i32 s55, s3, 2112
MAA 108,16,140
TR 112,16,16960
s_mov_b32 s57, 67584
MAA 108,20,156
TR 114,16,17472
MAA 124,28,156
TR 116,16,25408
MAA 124,24,140
TR 118,16,25920
MAA 160,32,128
TR 120,16,16992
MAA 160,36,144
TR 122,16,17504
MAA 176,44,144
TR 124,16,25440
MAA 176,40,128
TR 126,16,25952
MAA 164,32,132
TR 192,16,33856
MAA 164,36,148
TR 194,16,34368
MAA 180,44,148
TR 196,16,42304
MAA 180,40,132
TR 198,16,42816
MAA 168,32,136
TR 200,16,33888
MAA 168,36,152
TR 202,16,34400
MAA 184,44,152
TR 204,16,42336
MAA 184,40,136
TR 206,16,42848
MAA 172,32,140
TR 208,16,50752
MAA 172,36,156
TR 210,16,51264
MAA 188,44,156
TR 212,16,59200
MAA 188,40,140
TR 214,16,59712
MAA 224,48,128
TR 216,16,50784
MAA 224,52,144
TR 218,16,51296
MAA 232,60,144
TR 220,16,59232
MAA 232,56,128
TR 222,16,59744
MAA 228,48,132
TR 0,16,17024
MAA 228,52,148
TR 2,16,17536
MAA 236,60,148
TR 4,16,25472
MAA 236,56,132
TR 6,16,25984
s_waitcnt lgkmcnt(15)
MAA 64,64,128
TR 8,16,17056
MAA 64,68,144
TR 10,16,17568
s_waitcnt vmcnt(7)
MAA 64,96,160
TR 12,16,25504
s_waitcnt vmcnt(5)
MAA 64,100,176
TR 14,16,26016
MAA 80,108,176
TR 16,16,33920
MAA 80,104,160
TR 18,16,34432
MAA 80,76,144
TR 20,16,42368
MAA 80,72,128
TR 22,16,42880
MAA 32,80,160
TR 24,16,33952
MAA 32,84,176
TR 26,16,34464
MAA 48,92,176
TR 28,16,42400
MAA 48,88,160
TR 30,16,42912
s_nop 2
v_pk_mul_f32 v[64:65], v[64:65], v[32:33]
TR 32,16,50816
TR 34,16,51328
v_pk_mul_f32 v[32:33], v[32:33], v[28:29] op_sel_hi:[1,0]
v_pk_mul_f32 v[66:67], v[66:67], v[34:35]
v_pk_mul_f32 v[34:35], v[34:35], v[28:29] op_sel_hi:[1,0]
v_exp_f32 v32, v32
v_pk_mul_f32 v[80:81], v[80:81], v[48:49]
v_pk_mul_f32 v[48:49], v[48:49], v[28:29] op_sel_hi:[1,0]
v_pk_mul_f32 v[82:83], v[82:83], v[50:51]
v_pk_mul_f32 v[50:51], v[50:51], v[28:29] op_sel_hi:[1,0]
v_exp_f32 v33, v33
v_exp_f32 v34, v34
MAA 68,64,132
TR 36,16,59264
v_exp_f32 v35, v35
MAA 68,68,148
TR 38,16,59776
v_exp_f32 v48, v48
MAA 68,96,164
TR 40,16,50848
v_exp_f32 v49, v49
s_waitcnt vmcnt(4)
MAA 68,100,180
TR 42,16,51360
v_exp_f32 v50, v50
MAA 84,108,180
TR 44,16,59296
v_exp_f32 v51, v51
MAA 84,104,164
TR 46,16,59808
MAA 84,76,148
TR 48,17,16896
MAA 84,72,132
TR 50,17,17408
MAA 36,80,164
TR 52,17,25344
MAA 36,84,180
TR 54,17,25856
MAA 52,92,180
TR 56,17,16928
MAA 52,88,164
TR 58,17,17440
s_nop 2
v_pk_mul_f32 v[68:69], v[68:69], v[36:37]
v_pk_fma_f32 v[32:33], v[32:33], v[20:21], v[20:21] op_sel:[0,1,1] op_sel_hi:[1,1,1]
v_pk_fma_f32 v[34:35], v[34:35], v[20:21], v[20:21] op_sel:[0,1,1] op_sel_hi:[1,1,1]
v_pk_mul_f32 v[36:37], v[36:37], v[28:29] op_sel:[0,1] op_sel_hi:[1,1]
v_pk_mul_f32 v[70:71], v[70:71], v[38:39]
v_pk_mul_f32 v[38:39], v[38:39], v[28:29] op_sel:[0,1] op_sel_hi:[1,1]
v_pk_fma_f32 v[48:49], v[48:49], v[20:21], v[20:21] op_sel:[0,1,1] op_sel_hi:[1,1,1]
v_pk_mul_f32 v[84:85], v[84:85], v[52:53]
v_pk_mul_f32 v[52:53], v[52:53], v[28:29] op_sel:[0,1] op_sel_hi:[1,1]
v_pk_mul_f32 v[86:87], v[86:87], v[54:55]
v_pk_mul_f32 v[54:55], v[54:55], v[28:29] op_sel:[0,1] op_sel_hi:[1,1]
v_pk_fma_f32 v[50:51], v[50:51], v[20:21], v[20:21] op_sel:[0,1,1] op_sel_hi:[1,1,1]
v_rcp_f32 v32, v32
v_rcp_f32 v33, v33
MAA 72,64,136
TR 60,17,25376
v_rcp_f32 v34, v34
MAA 72,68,152
TR 62,17,25888
v_rcp_f32 v35, v35
s_waitcnt vmcnt(3)
MAA 72,96,168
v_rcp_f32 v48, v48
s_waitcnt vmcnt(1)
MAA 72,100,184
v_rcp_f32 v49, v49
MAA 88,108,184
v_rcp_f32 v50, v50
MAA 88,104,168
v_rcp_f32 v51, v51
MAA 88,76,152
v_exp_f32 v36, v36
MAA 88,72,136
v_exp_f32 v37, v37
MAA 40,80,168
v_exp_f32 v38, v38
MAA 40,84,184
v_exp_f32 v39, v39
MAA 56,92,184
v_exp_f32 v52, v52
MAA 56,88,168
v_exp_f32 v53, v53
v_exp_f32 v54, v54
v_exp_f32 v55, v55
v_pk_mul_f32 v[64:65], v[64:65], v[32:33]
v_pk_mul_f32 v[66:67], v[66:67], v[34:35]
v_pk_mul_f32 v[80:81], v[80:81], v[48:49]
v_pk_mul_f32 v[82:83], v[82:83], v[50:51]
v_pk_mul_f32 v[72:73], v[72:73], v[40:41]
v_pk_mul_f32 v[40:41], v[40:41], v[30:31] op_sel_hi:[1,0]
v_pk_mul_f32 v[74:75], v[74:75], v[42:43]
v_pk_mul_f32 v[42:43], v[42:43], v[30:31] op_sel_hi:[1,0]
v_pk_mul_f32 v[88:89], v[88:89], v[56:57]
v_pk_mul_f32 v[56:57], v[56:57], v[30:31] op_sel_hi:[1,0]
v_pk_mul_f32 v[90:91], v[90:91], v[58:59]
v_pk_mul_f32 v[58:59], v[58:59], v[30:31] op_sel_hi:[1,0]
v_pk_fma_f32 v[36:37], v[36:37], v[22:23], v[22:23] op_sel:[0,1,1] op_sel_hi:[1,1,1]
v_pk_fma_f32 v[38:39], v[38:39], v[22:23], v[22:23] op_sel:[0,1,1] op_sel_hi:[1,1,1]
v_pk_fma_f32 v[52:53], v[52:53], v[22:23], v[22:23] op_sel:[0,1,1] op_sel_hi:[1,1,1]
v_pk_fma_f32 v[54:55], v[54:55], v[22:23], v[22:23] op_sel:[0,1,1] op_sel_hi:[1,1,1]
v_cvt_pk_bf16_f32 v32, v64, v65
v_cvt_pk_bf16_f32 v33, v66, v67
v_cvt_pk_bf16_f32 v34, v80, v81
v_cvt_pk_bf16_f32 v35, v82, v83
MAA 76,64,140
buffer_store_dwordx4 v[32:35], v10, s[16:19], s62 offen sc1
MAA 76,68,156
TR 64,17,33792
v_rcp_f32 v36, v36
MAA 76,96,172
TR 66,17,34304
v_rcp_f32 v37, v37
s_waitcnt vmcnt(1)
MAA 76,100,188
TR 68,17,42240
v_rcp_f32 v38, v38
MAA 92,108,188
TR 70,17,42752
v_rcp_f32 v39, v39
MAA 92,104,172
v_rcp_f32 v52, v52
MAA 92,76,156
TR 76,17,42272
v_rcp_f32 v53, v53
MAA 92,72,140
TR 72,17,33824
v_rcp_f32 v54, v54
MAA 44,80,172
TR 74,17,34336
v_rcp_f32 v55, v55
MAA 44,84,188
TR 78,17,42784
v_exp_f32 v40, v40
MAA 60,92,188
TR 80,17,50688
v_exp_f32 v41, v41
MAA 60,88,172
TR 82,17,51200
v_exp_f32 v42, v42
v_exp_f32 v43, v43
v_exp_f32 v56, v56
v_exp_f32 v57, v57
v_exp_f32 v58, v58
v_exp_f32 v59, v59
v_pk_mul_f32 v[68:69], v[68:69], v[36:37]
v_pk_mul_f32 v[70:71], v[70:71], v[38:39]
v_pk_mul_f32 v[84:85], v[84:85], v[52:53]
v_pk_mul_f32 v[86:87], v[86:87], v[54:55]
v_pk_mul_f32 v[76:77], v[76:77], v[44:45]
v_pk_mul_f32 v[44:45], v[44:45], v[30:31] op_sel:[0,1] op_sel_hi:[1,1]
v_pk_mul_f32 v[78:79], v[78:79], v[46:47]
v_pk_mul_f32 v[46:47], v[46:47], v[30:31] op_sel:[0,1] op_sel_hi:[1,1]
v_pk_mul_f32 v[92:93], v[92:93], v[60:61]
v_pk_mul_f32 v[60:61], v[60:61], v[30:31] op_sel:[0,1] op_sel_hi:[1,1]
v_pk_mul_f32 v[94:95], v[94:95], v[62:63]
v_pk_mul_f32 v[62:63], v[62:63], v[30:31] op_sel:[0,1] op_sel_hi:[1,1]
.Lpad35:
s_cbranch_execz .Lpad38
v_pk_fma_f32 v[40:41], v[40:41], v[24:25], v[24:25] op_sel:[0,1,1] op_sel_hi:[1,1,1]
v_pk_fma_f32 v[42:43], v[42:43], v[24:25], v[24:25] op_sel:[0,1,1] op_sel_hi:[1,1,1]
v_pk_fma_f32 v[56:57], v[56:57], v[24:25], v[24:25] op_sel:[0,1,1] op_sel_hi:[1,1,1]
v_pk_fma_f32 v[58:59], v[58:59], v[24:25], v[24:25] op_sel:[0,1,1] op_sel_hi:[1,1,1]
v_cvt_pk_bf16_f32 v36, v68, v69
v_cvt_pk_bf16_f32 v37, v70, v71
v_cvt_pk_bf16_f32 v38, v84, v85
v_cvt_pk_bf16_f32 v39, v86, v87
MAA 128,112,128
buffer_store_dwordx4 v[36:39], v10, s[16:19], s62 offen offset:1024 sc1
MAA 128,116,144
TR 84,17,59136
v_rcp_f32 v40, v40
s_waitcnt lgkmcnt(15)
MAA 128,208,160
TR 86,17,59648
v_rcp_f32 v41, v41
MAA 128,212,176
TR 88,17,50720
v_rcp_f32 v42, v42
MAA 144,220,176
TR 90,17,51232
v_rcp_f32 v43, v43
MAA 144,216,160
TR 92,17,59168
v_rcp_f32 v56, v56
MAA 144,124,144
TR 94,17,59680
v_rcp_f32 v57, v57
MAA 144,120,128
v_rcp_f32 v58, v58
MAA 96,192,160
v_rcp_f32 v59, v59
MAA 96,196,176
v_exp_f32 v44, v44
MAA 112,204,176
v_exp_f32 v45, v45
MAA 112,200,160
v_lshrrev_b32 v69, 2, v0
v_min_u32 v69, 1, v69
v_lshlrev_b32 v69, 28, v69
v_lshl_add_u32 v68, v0, 7, v69
v_xor_b32 v69, 64, v0
v_min_u32 v69, 1, v69
v_lshlrev_b32 v70, 4, v69
v_sub_u32 v70, 16, v70
v_lshlrev_b32 v69, 28, v69
v_mov_b32 v71, 1
s_waitcnt lgkmcnt(0)
s_barrier
v_mov_b32 v84, 0
v_mov_b32 v85, 0
v_mov_b32 v86, 0
v_exp_f32 v46, v46
v_exp_f32 v47, v47
v_exp_f32 v60, v60
v_exp_f32 v61, v61
v_exp_f32 v62, v62
v_exp_f32 v63, v63
v_pk_mul_f32 v[72:73], v[72:73], v[40:41]
v_pk_mul_f32 v[74:75], v[74:75], v[42:43]
v_pk_mul_f32 v[88:89], v[88:89], v[56:57]
v_pk_mul_f32 v[90:91], v[90:91], v[58:59]
v_pk_mul_f32 v[128:129], v[128:129], v[96:97]
v_pk_mul_f32 v[96:97], v[96:97], v[28:29] op_sel_hi:[1,0]
v_pk_mul_f32 v[130:131], v[130:131], v[98:99]
v_pk_mul_f32 v[98:99], v[98:99], v[28:29] op_sel_hi:[1,0]
v_pk_mul_f32 v[144:145], v[144:145], v[112:113]
v_pk_mul_f32 v[112:113], v[112:113], v[28:29] op_sel_hi:[1,0]
v_pk_mul_f32 v[146:147], v[146:147], v[114:115]
v_pk_mul_f32 v[114:115], v[114:115], v[28:29] op_sel_hi:[1,0]
v_pk_fma_f32 v[44:45], v[44:45], v[26:27], v[26:27] op_sel:[0,1,1] op_sel_hi:[1,1,1]
v_pk_fma_f32 v[46:47], v[46:47], v[26:27], v[26:27] op_sel:[0,1,1] op_sel_hi:[1,1,1]
v_pk_fma_f32 v[60:61], v[60:61], v[26:27], v[26:27] op_sel:[0,1,1] op_sel_hi:[1,1,1]
v_pk_fma_f32 v[62:63], v[62:63], v[26:27], v[26:27] op_sel:[0,1,1] op_sel_hi:[1,1,1]
v_cvt_pk_bf16_f32 v40, v72, v73
v_cvt_pk_bf16_f32 v41, v74, v75
v_cvt_pk_bf16_f32 v42, v88, v89
v_cvt_pk_bf16_f32 v43, v90, v91
MAA 132,112,132
buffer_store_dwordx4 v[40:43], v11, s[16:19], s62 offen sc1
MAA 132,116,148
s_add_u32 m0, s59, 84480
v_rcp_f32 v44, v44
MAA 132,208,164
v_rcp_f32 v45, v45
MAA 132,212,180
v_rcp_f32 v46, v46
MAA 148,220,180
buffer_load_dwordx4 v18, s[28:31], s58 offen lds
MAA 148,216,164
v_rcp_f32 v47, v47
MAA 148,124,148
v_rcp_f32 v60, v60
MAA 148,120,132
v_rcp_f32 v61, v61
MAA 100,192,164
buffer_load_dwordx4 v19, s[28:31], s58 offen offset:1056 lds
MAA 100,196,180
s_add_u32 m0, s59, 92928
s_add_u32 s58, s99, 2555904
v_rcp_f32 v62, v62
MAA 116,204,180
v_rcp_f32 v63, v63
MAA 116,200,164
v_exp_f32 v96, v96
v_exp_f32 v97, v97
v_exp_f32 v98, v98
v_exp_f32 v99, v99
v_exp_f32 v112, v112
v_exp_f32 v113, v113
v_exp_f32 v114, v114
v_exp_f32 v115, v115
v_pk_mul_f32 v[76:77], v[76:77], v[44:45]
v_pk_mul_f32 v[78:79], v[78:79], v[46:47]
v_pk_mul_f32 v[92:93], v[92:93], v[60:61]
v_pk_mul_f32 v[94:95], v[94:95], v[62:63]
v_pk_mul_f32 v[132:133], v[132:133], v[100:101]
v_pk_mul_f32 v[100:101], v[100:101], v[28:29] op_sel:[0,1] op_sel_hi:[1,1]
v_pk_mul_f32 v[134:135], v[134:135], v[102:103]
v_pk_mul_f32 v[102:103], v[102:103], v[28:29] op_sel:[0,1] op_sel_hi:[1,1]
v_pk_mul_f32 v[148:149], v[148:149], v[116:117]
v_pk_mul_f32 v[116:117], v[116:117], v[28:29] op_sel:[0,1] op_sel_hi:[1,1]
v_pk_mul_f32 v[150:151], v[150:151], v[118:119]
v_pk_mul_f32 v[118:119], v[118:119], v[28:29] op_sel:[0,1] op_sel_hi:[1,1]
v_pk_fma_f32 v[96:97], v[96:97], v[20:21], v[20:21] op_sel:[0,1,1] op_sel_hi:[1,1,1]
v_pk_fma_f32 v[98:99], v[98:99], v[20:21], v[20:21] op_sel:[0,1,1] op_sel_hi:[1,1,1]
v_pk_fma_f32 v[112:113], v[112:113], v[20:21], v[20:21] op_sel:[0,1,1] op_sel_hi:[1,1,1]
v_pk_fma_f32 v[114:115], v[114:115], v[20:21], v[20:21] op_sel:[0,1,1] op_sel_hi:[1,1,1]
v_cvt_pk_bf16_f32 v44, v76, v77
v_cvt_pk_bf16_f32 v45, v78, v79
v_cvt_pk_bf16_f32 v46, v92, v93
v_cvt_pk_bf16_f32 v47, v94, v95
MAA 136,112,136
buffer_store_dwordx4 v[44:47], v11, s[16:19], s62 offen offset:1024 sc1
MAA 136,116,152
v_rcp_f32 v96, v96
MAA 136,208,168
v_rcp_f32 v97, v97
MAA 136,212,184
v_rcp_f32 v98, v98
MAA 152,220,184
buffer_load_dwordx4 v18, s[28:31], s58 offen lds
MAA 152,216,168
v_rcp_f32 v99, v99
MAA 152,124,152
v_rcp_f32 v112, v112
MAA 152,120,136
v_rcp_f32 v113, v113
MAA 104,192,168
buffer_load_dwordx4 v19, s[28:31], s58 offen offset:1056 lds
MAA 104,196,184
s_add_u32 m0, s59, 101376
s_add_u32 s58, s100, 2752512
v_rcp_f32 v114, v114
MAA 120,204,184
v_rcp_f32 v115, v115
MAA 120,200,168
v_exp_f32 v100, v100
v_exp_f32 v101, v101
v_exp_f32 v102, v102
v_exp_f32 v103, v103
v_exp_f32 v116, v116
v_exp_f32 v117, v117
v_exp_f32 v118, v118
v_exp_f32 v119, v119
v_pk_mul_f32 v[128:129], v[128:129], v[96:97]
v_pk_mul_f32 v[130:131], v[130:131], v[98:99]
v_pk_mul_f32 v[144:145], v[144:145], v[112:113]
v_pk_mul_f32 v[146:147], v[146:147], v[114:115]
v_pk_mul_f32 v[136:137], v[136:137], v[104:105]
v_pk_mul_f32 v[104:105], v[104:105], v[30:31] op_sel_hi:[1,0]
v_pk_mul_f32 v[138:139], v[138:139], v[106:107]
v_pk_mul_f32 v[106:107], v[106:107], v[30:31] op_sel_hi:[1,0]
v_pk_mul_f32 v[152:153], v[152:153], v[120:121]
v_pk_mul_f32 v[120:121], v[120:121], v[30:31] op_sel_hi:[1,0]
v_pk_mul_f32 v[154:155], v[154:155], v[122:123]
v_pk_mul_f32 v[122:123], v[122:123], v[30:31] op_sel_hi:[1,0]
v_pk_fma_f32 v[100:101], v[100:101], v[22:23], v[22:23] op_sel:[0,1,1] op_sel_hi:[1,1,1]
v_pk_fma_f32 v[102:103], v[102:103], v[22:23], v[22:23] op_sel:[0,1,1] op_sel_hi:[1,1,1]
v_pk_fma_f32 v[116:117], v[116:117], v[22:23], v[22:23] op_sel:[0,1,1] op_sel_hi:[1,1,1]
v_pk_fma_f32 v[118:119], v[118:119], v[22:23], v[22:23] op_sel:[0,1,1] op_sel_hi:[1,1,1]
v_cvt_pk_bf16_f32 v96, v128, v129
v_cvt_pk_bf16_f32 v97, v130, v131
v_cvt_pk_bf16_f32 v98, v144, v145
v_cvt_pk_bf16_f32 v99, v146, v147
MAA 140,112,140
buffer_store_dwordx4 v[96:99], v10, s[16:19], s63 offen sc1
MAA 140,116,156
v_rcp_f32 v100, v100
MAA 140,208,172
v_rcp_f32 v101, v101
MAA 140,212,188
v_rcp_f32 v102, v102
MAA 156,220,188
buffer_load_dwordx4 v18, s[28:31], s58 offen lds
MAA 156,216,172
v_rcp_f32 v103, v103
MAA 156,124,156
v_rcp_f32 v116, v116
MAA 156,120,140
v_rcp_f32 v117, v117
MAA 108,192,172
buffer_load_dwordx4 v19, s[28:31], s58 offen offset:1056 lds
MAA 108,196,188
s_add_u32 m0, s59, 109824
s_add_u32 s58, s100, 3014656
v_rcp_f32 v118, v118
MAA 124,204,188
v_rcp_f32 v119, v119
MAA 124,200,172
v_exp_f32 v104, v104
v_exp_f32 v105, v105
v_exp_f32 v106, v106
v_exp_f32 v107, v107
v_exp_f32 v120, v120
v_exp_f32 v121, v121
v_exp_f32 v122, v122
v_exp_f32 v123, v123
v_pk_mul_f32 v[132:133], v[132:133], v[100:101]
v_pk_mul_f32 v[134:135], v[134:135], v[102:103]
v_pk_mul_f32 v[148:149], v[148:149], v[116:117]
v_pk_mul_f32 v[150:151], v[150:151], v[118:119]
v_pk_mul_f32 v[140:141], v[140:141], v[108:109]
v_pk_mul_f32 v[108:109], v[108:109], v[30:31] op_sel:[0,1] op_sel_hi:[1,1]
v_pk_mul_f32 v[142:143], v[142:143], v[110:111]
v_pk_mul_f32 v[110:111], v[110:111], v[30:31] op_sel:[0,1] op_sel_hi:[1,1]
v_pk_mul_f32 v[156:157], v[156:157], v[124:125]
v_pk_mul_f32 v[124:125], v[124:125], v[30:31] op_sel:[0,1] op_sel_hi:[1,1]
v_pk_mul_f32 v[158:159], v[158:159], v[126:127]
v_pk_mul_f32 v[126:127], v[126:127], v[30:31] op_sel:[0,1] op_sel_hi:[1,1]
v_pk_fma_f32 v[104:105], v[104:105], v[24:25], v[24:25] op_sel:[0,1,1] op_sel_hi:[1,1,1]
v_pk_fma_f32 v[106:107], v[106:107], v[24:25], v[24:25] op_sel:[0,1,1] op_sel_hi:[1,1,1]
v_pk_fma_f32 v[120:121], v[120:121], v[24:25], v[24:25] op_sel:[0,1,1] op_sel_hi:[1,1,1]
v_pk_fma_f32 v[122:123], v[122:123], v[24:25], v[24:25] op_sel:[0,1,1] op_sel_hi:[1,1,1]
v_cvt_pk_bf16_f32 v100, v132, v133
v_cvt_pk_bf16_f32 v101, v134, v135
v_cvt_pk_bf16_f32 v102, v148, v149
v_cvt_pk_bf16_f32 v103, v150, v151
MAA 192,0,128
buffer_store_dwordx4 v[100:103], v10, s[16:19], s63 offen offset:1024 sc1
MAA 192,4,144
v_rcp_f32 v104, v104
MAA 192,32,160
s_waitcnt vmcnt(6)
s_barrier
v_rcp_f32 v105, v105
MAA 192,36,176
v_rcp_f32 v106, v106
MAA 208,44,176
buffer_atomic_add v71, v68, s[16:19], s72 offen offset:512
MAA 208,40,160
v_rcp_f32 v107, v107
MAA 208,12,144
v_rcp_f32 v120, v120
MAA 208,8,128
v_rcp_f32 v121, v121
MAA 160,16,160
buffer_load_dwordx4 v18, s[28:31], s58 offen lds
MAA 160,20,176
v_rcp_f32 v122, v122
MAA 176,28,176
v_rcp_f32 v123, v123
MAA 176,24,160
v_exp_f32 v108, v108
v_exp_f32 v109, v109
v_exp_f32 v110, v110
v_exp_f32 v111, v111
v_exp_f32 v124, v124
v_exp_f32 v125, v125
v_exp_f32 v126, v126
v_exp_f32 v127, v127
v_pk_mul_f32 v[136:137], v[136:137], v[104:105]
v_pk_mul_f32 v[138:139], v[138:139], v[106:107]
v_pk_mul_f32 v[152:153], v[152:153], v[120:121]
v_pk_mul_f32 v[154:155], v[154:155], v[122:123]
v_pk_mul_f32 v[192:193], v[192:193], v[160:161]
v_pk_mul_f32 v[160:161], v[160:161], v[28:29] op_sel_hi:[1,0]
v_pk_mul_f32 v[194:195], v[194:195], v[162:163]
v_pk_mul_f32 v[162:163], v[162:163], v[28:29] op_sel_hi:[1,0]
v_pk_mul_f32 v[208:209], v[208:209], v[176:177]
v_pk_mul_f32 v[176:177], v[176:177], v[28:29] op_sel_hi:[1,0]
v_pk_mul_f32 v[210:211], v[210:211], v[178:179]
v_pk_mul_f32 v[178:179], v[178:179], v[28:29] op_sel_hi:[1,0]
v_pk_fma_f32 v[108:109], v[108:109], v[26:27], v[26:27] op_sel:[0,1,1] op_sel_hi:[1,1,1]
v_pk_fma_f32 v[110:111], v[110:111], v[26:27], v[26:27] op_sel:[0,1,1] op_sel_hi:[1,1,1]
v_pk_fma_f32 v[124:125], v[124:125], v[26:27], v[26:27] op_sel:[0,1,1] op_sel_hi:[1,1,1]
v_pk_fma_f32 v[126:127], v[126:127], v[26:27], v[26:27] op_sel:[0,1,1] op_sel_hi:[1,1,1]
v_cvt_pk_bf16_f32 v104, v136, v137
v_cvt_pk_bf16_f32 v105, v138, v139
v_cvt_pk_bf16_f32 v106, v152, v153
v_cvt_pk_bf16_f32 v107, v154, v155
MAA 196,0,132
buffer_store_dwordx4 v[104:107], v11, s[16:19], s63 offen sc1
MAA 196,4,148
v_rcp_f32 v108, v108
MAA 196,32,164
v_rcp_f32 v109, v109
MAA 196,36,180
v_rcp_f32 v110, v110
MAA 212,44,180
buffer_load_dwordx4 v19, s[28:31], s58 offen offset:1056 lds
MAA 212,40,164
s_add_u32 m0, s59, 118272
s_add_u32 s58, s101, 3211264
v_rcp_f32 v111, v111
MAA 212,12,148
v_rcp_f32 v124, v124
MAA 212,8,132
v_rcp_f32 v125, v125
MAA 164,16,164
buffer_load_dwordx4 v18, s[28:31], s58 offen lds
MAA 164,20,180
v_rcp_f32 v126, v126
MAA 180,28,180
v_rcp_f32 v127, v127
MAA 180,24,164
v_exp_f32 v160, v160
v_exp_f32 v161, v161
v_exp_f32 v162, v162
v_exp_f32 v163, v163
v_exp_f32 v176, v176
v_exp_f32 v177, v177
v_exp_f32 v178, v178
v_exp_f32 v179, v179
v_pk_mul_f32 v[140:141], v[140:141], v[108:109]
v_pk_mul_f32 v[142:143], v[142:143], v[110:111]
v_pk_mul_f32 v[156:157], v[156:157], v[124:125]
v_pk_mul_f32 v[158:159], v[158:159], v[126:127]
v_pk_mul_f32 v[196:197], v[196:197], v[164:165]
v_pk_mul_f32 v[164:165], v[164:165], v[28:29] op_sel:[0,1] op_sel_hi:[1,1]
v_pk_mul_f32 v[198:199], v[198:199], v[166:167]
v_pk_mul_f32 v[166:167], v[166:167], v[28:29] op_sel:[0,1] op_sel_hi:[1,1]
v_pk_mul_f32 v[212:213], v[212:213], v[180:181]
v_pk_mul_f32 v[180:181], v[180:181], v[28:29] op_sel:[0,1] op_sel_hi:[1,1]
v_pk_mul_f32 v[214:215], v[214:215], v[182:183]
v_pk_mul_f32 v[182:183], v[182:183], v[28:29] op_sel:[0,1] op_sel_hi:[1,1]
v_pk_fma_f32 v[160:161], v[160:161], v[20:21], v[20:21] op_sel:[0,1,1] op_sel_hi:[1,1,1]
v_pk_fma_f32 v[162:163], v[162:163], v[20:21], v[20:21] op_sel:[0,1,1] op_sel_hi:[1,1,1]
v_pk_fma_f32 v[176:177], v[176:177], v[20:21], v[20:21] op_sel:[0,1,1] op_sel_hi:[1,1,1]
v_pk_fma_f32 v[178:179], v[178:179], v[20:21], v[20:21] op_sel:[0,1,1] op_sel_hi:[1,1,1]
v_cvt_pk_bf16_f32 v108, v140, v141
v_cvt_pk_bf16_f32 v109, v142, v143
v_cvt_pk_bf16_f32 v110, v156, v157
v_cvt_pk_bf16_f32 v111, v158, v159
MAA 200,0,136
buffer_store_dwordx4 v[108:111], v11, s[16:19], s63 offen offset:1024 sc1
MAA 200,4,152
v_rcp_f32 v160, v160
MAA 200,32,168
v_rcp_f32 v161, v161
MAA 200,36,184
v_rcp_f32 v162, v162
MAA 216,44,184
buffer_load_dwordx4 v19, s[28:31], s58 offen offset:1056 lds
MAA 216,40,168
s_add_u32 m0, s59, 126720
s_add_u32 s58, s101, 3473408
v_rcp_f32 v163, v163
MAA 216,12,152
v_rcp_f32 v176, v176
MAA 216,8,136
v_rcp_f32 v177, v177
MAA 168,16,168
buffer_load_dwordx4 v18, s[28:31], s58 offen lds
MAA 168,20,184
v_rcp_f32 v178, v178
MAA 184,28,184
v_rcp_f32 v179, v179
MAA 184,24,168
v_exp_f32 v164, v164
v_exp_f32 v165, v165
v_exp_f32 v166, v166
v_exp_f32 v167, v167
v_exp_f32 v180, v180
v_exp_f32 v181, v181
v_exp_f32 v182, v182
v_exp_f32 v183, v183
v_pk_mul_f32 v[192:193], v[192:193], v[160:161]
v_pk_mul_f32 v[194:195], v[194:195], v[162:163]
v_pk_mul_f32 v[208:209], v[208:209], v[176:177]
v_pk_mul_f32 v[210:211], v[210:211], v[178:179]
v_pk_mul_f32 v[200:201], v[200:201], v[168:169]
v_pk_mul_f32 v[168:169], v[168:169], v[30:31] op_sel_hi:[1,0]
v_pk_mul_f32 v[202:203], v[202:203], v[170:171]
v_pk_mul_f32 v[170:171], v[170:171], v[30:31] op_sel_hi:[1,0]
v_pk_mul_f32 v[216:217], v[216:217], v[184:185]
v_pk_mul_f32 v[184:185], v[184:185], v[30:31] op_sel_hi:[1,0]
v_pk_mul_f32 v[218:219], v[218:219], v[186:187]
v_pk_mul_f32 v[186:187], v[186:187], v[30:31] op_sel_hi:[1,0]
v_pk_fma_f32 v[164:165], v[164:165], v[22:23], v[22:23] op_sel:[0,1,1] op_sel_hi:[1,1,1]
v_pk_fma_f32 v[166:167], v[166:167], v[22:23], v[22:23] op_sel:[0,1,1] op_sel_hi:[1,1,1]
v_pk_fma_f32 v[180:181], v[180:181], v[22:23], v[22:23] op_sel:[0,1,1] op_sel_hi:[1,1,1]
v_pk_fma_f32 v[182:183], v[182:183], v[22:23], v[22:23] op_sel:[0,1,1] op_sel_hi:[1,1,1]
v_cvt_pk_bf16_f32 v160, v192, v193
v_cvt_pk_bf16_f32 v161, v194, v195
v_cvt_pk_bf16_f32 v162, v208, v209
v_cvt_pk_bf16_f32 v163, v210, v211
MAA 204,0,140
buffer_store_dwordx4 v[160:163], v10, s[16:19], s64 offen sc1
MAA 204,4,156
v_rcp_f32 v164, v164
MAA 204,32,172
v_rcp_f32 v165, v165
MAA 204,36,188
v_rcp_f32 v166, v166
MAA 220,44,188
buffer_atomic_add v84, v69, s[16:19], s73 offen offset:512 sc0
MAA 220,40,172
v_rcp_f32 v167, v167
MAA 220,12,156
v_rcp_f32 v180, v180
MAA 220,8,140
v_rcp_f32 v181, v181
MAA 172,16,172
buffer_load_dwordx4 v19, s[28:31], s58 offen offset:1056 lds
MAA 172,20,188
v_rcp_f32 v182, v182
MAA 188,28,188
v_rcp_f32 v183, v183
MAA 188,24,172
v_exp_f32 v168, v168
v_exp_f32 v169, v169
v_exp_f32 v170, v170
v_exp_f32 v171, v171
v_exp_f32 v184, v184
v_exp_f32 v185, v185
v_exp_f32 v186, v186
v_exp_f32 v187, v187
v_pk_mul_f32 v[196:197], v[196:197], v[164:165]
v_pk_mul_f32 v[198:199], v[198:199], v[166:167]
v_pk_mul_f32 v[212:213], v[212:213], v[180:181]
v_pk_mul_f32 v[214:215], v[214:215], v[182:183]
v_pk_mul_f32 v[204:205], v[204:205], v[172:173]
v_pk_mul_f32 v[172:173], v[172:173], v[30:31] op_sel:[0,1] op_sel_hi:[1,1]
v_pk_mul_f32 v[206:207], v[206:207], v[174:175]
v_pk_mul_f32 v[174:175], v[174:175], v[30:31] op_sel:[0,1] op_sel_hi:[1,1]
v_pk_mul_f32 v[220:221], v[220:221], v[188:189]
v_pk_mul_f32 v[188:189], v[188:189], v[30:31] op_sel:[0,1] op_sel_hi:[1,1]
v_pk_mul_f32 v[222:223], v[222:223], v[190:191]
v_pk_mul_f32 v[190:191], v[190:191], v[30:31] op_sel:[0,1] op_sel_hi:[1,1]
v_pk_fma_f32 v[168:169], v[168:169], v[24:25], v[24:25] op_sel:[0,1,1] op_sel_hi:[1,1,1]
v_pk_fma_f32 v[170:171], v[170:171], v[24:25], v[24:25] op_sel:[0,1,1] op_sel_hi:[1,1,1]
v_pk_fma_f32 v[184:185], v[184:185], v[24:25], v[24:25] op_sel:[0,1,1] op_sel_hi:[1,1,1]
v_pk_fma_f32 v[186:187], v[186:187], v[24:25], v[24:25] op_sel:[0,1,1] op_sel_hi:[1,1,1]
v_cvt_pk_bf16_f32 v164, v196, v197
v_cvt_pk_bf16_f32 v165, v198, v199
v_cvt_pk_bf16_f32 v166, v212, v213
v_cvt_pk_bf16_f32 v167, v214, v215
MAA 240,48,128
buffer_store_dwordx4 v[164:167], v10, s[16:19], s64 offen offset:1024 sc1
MAA 240,52,144
v_rcp_f32 v168, v168
MAA 240,80,160
v_rcp_f32 v169, v169
MAA 240,84,176
v_rcp_f32 v170, v170
MAA 248,92,176
buffer_atomic_add v85, v69, s[16:19], s73 offen offset:512 sc0
MAA 248,88,160
v_rcp_f32 v171, v171
MAA 248,60,144
v_rcp_f32 v184, v184
MAA 248,56,128
v_rcp_f32 v185, v185
MAA 224,64,160
v_rcp_f32 v186, v186
MAA 224,68,176
v_rcp_f32 v187, v187
MAA 232,76,176
v_exp_f32 v172, v172
MAA 232,72,160
v_exp_f32 v173, v173
v_exp_f32 v174, v174
v_exp_f32 v175, v175
v_exp_f32 v188, v188
v_exp_f32 v189, v189
v_exp_f32 v190, v190
v_exp_f32 v191, v191
v_pk_mul_f32 v[200:201], v[200:201], v[168:169]
v_pk_mul_f32 v[202:203], v[202:203], v[170:171]
v_pk_mul_f32 v[216:217], v[216:217], v[184:185]
v_pk_mul_f32 v[218:219], v[218:219], v[186:187]
v_pk_mul_f32 v[240:241], v[240:241], v[224:225]
v_pk_mul_f32 v[224:225], v[224:225], v[28:29] op_sel_hi:[1,0]
v_pk_mul_f32 v[242:243], v[242:243], v[226:227]
v_pk_mul_f32 v[226:227], v[226:227], v[28:29] op_sel_hi:[1,0]
v_pk_mul_f32 v[248:249], v[248:249], v[232:233]
v_pk_mul_f32 v[232:233], v[232:233], v[28:29] op_sel_hi:[1,0]
v_pk_mul_f32 v[250:251], v[250:251], v[234:235]
v_pk_mul_f32 v[234:235], v[234:235], v[28:29] op_sel_hi:[1,0]
v_pk_fma_f32 v[172:173], v[172:173], v[26:27], v[26:27] op_sel:[0,1,1] op_sel_hi:[1,1,1]
v_pk_fma_f32 v[174:175], v[174:175], v[26:27], v[26:27] op_sel:[0,1,1] op_sel_hi:[1,1,1]
v_pk_fma_f32 v[188:189], v[188:189], v[26:27], v[26:27] op_sel:[0,1,1] op_sel_hi:[1,1,1]
v_pk_fma_f32 v[190:191], v[190:191], v[26:27], v[26:27] op_sel:[0,1,1] op_sel_hi:[1,1,1]
v_cvt_pk_bf16_f32 v168, v200, v201
v_cvt_pk_bf16_f32 v169, v202, v203
v_cvt_pk_bf16_f32 v170, v216, v217
v_cvt_pk_bf16_f32 v171, v218, v219
buffer_store_dwordx4 v[168:171], v11, s[16:19], s64 offen sc1
buffer_atomic_add v86, v69, s[16:19], s73 offen offset:512 sc0
s_waitcnt vmcnt(5)
v_cmp_gt_u32 vcc, v70, v84
s_nop 0
s_cbranch_vccz .Lok66
s_waitcnt vmcnt(2)
v_cmp_gt_u32 vcc, v70, v85
s_nop 0
s_cbranch_vccz .Lok66
s_waitcnt vmcnt(0)
v_cmp_gt_u32 vcc, v70, v86
s_nop 0
s_cbranch_vccz .Lok66
s_mov_b32 s15, 0
.Lok66l:
v_mov_b32 v84, 0
buffer_atomic_add v84, v69, s[16:19], s73 offen offset:512 sc0
s_add_u32 s15, s15, 1
s_cmp_gt_u32 s15, 100000
s_waitcnt vmcnt(0)
s_cbranch_scc1 .Lok66
v_cmp_gt_u32 vcc, v70, v84
s_nop 0
s_cbranch_vccnz .Lok66l
.Lok66:
s_waitcnt vmcnt(4)
s_barrier
MAA 244,48,132
ds_read_b64_tr_b16 a[0:1], v7
s_add_u32 s52, s76, 0
MAA 244,52,148
buffer_load_dwordx4 v[96:99], v4, s[16:19], s52 offen sc1
MAA 244,80,164
TR 2,7,512
v_rcp_f32 v172, v172
MAA 244,84,180
TR 4,7,32
v_rcp_f32 v173, v173
MAA 252,92,180
TR 6,7,544
v_rcp_f32 v174, v174
MAA 252,88,164
buffer_load_dwordx4 v[100:103], v4, s[16:19], s52 offen offset:1024 sc1
MAA 252,60,148
TR 8,7,64
s_add_u32 s52, s76, 65536
MAA 252,56,132
TR 10,7,576
v_rcp_f32 v175, v175
MAA 228,64,164
TR 12,7,96
v_rcp_f32 v188, v188
MAA 228,68,180
buffer_load_dwordx4 v[104:107], v4, s[16:19], s52 offen sc1
MAA 236,76,180
TR 14,7,608
v_rcp_f32 v189, v189
MAA 236,72,164
TR 16,7,8448
v_rcp_f32 v190, v190
v_rcp_f32 v191, v191
v_exp_f32 v224, v224
v_exp_f32 v225, v225
v_exp_f32 v226, v226
v_exp_f32 v227, v227
v_exp_f32 v232, v232
v_exp_f32 v233, v233
v_exp_f32 v234, v234
v_exp_f32 v235, v235
v_pk_mul_f32 v[204:205], v[204:205], v[172:173]
buffer_load_dwordx4 v[108:111], v4, s[16:19], s52 offen offset:1024 sc1
s_add_u32 s52, s77, 114688
v_pk_mul_f32 v[206:207], v[206:207], v[174:175]
v_pk_mul_f32 v[220:221], v[220:221], v[188:189]
v_pk_mul_f32 v[222:223], v[222:223], v[190:191]
v_pk_mul_f32 v[244:245], v[244:245], v[228:229]
v_pk_mul_f32 v[228:229], v[228:229], v[28:29] op_sel:[0,1] op_sel_hi:[1,1]
v_pk_mul_f32 v[246:247], v[246:247], v[230:231]
v_pk_mul_f32 v[230:231], v[230:231], v[28:29] op_sel:[0,1] op_sel_hi:[1,1]
v_pk_mul_f32 v[252:253], v[252:253], v[236:237]
v_pk_mul_f32 v[236:237], v[236:237], v[28:29] op_sel:[0,1] op_sel_hi:[1,1]
v_pk_mul_f32 v[254:255], v[254:255], v[238:239]
v_pk_mul_f32 v[238:239], v[238:239], v[28:29] op_sel:[0,1] op_sel_hi:[1,1]
v_pk_fma_f32 v[224:225], v[224:225], v[20:21], v[20:21] op_sel:[0,1,1] op_sel_hi:[1,1,1]
buffer_load_dwordx4 v[112:115], v4, s[16:19], s52 offen sc1
v_pk_fma_f32 v[226:227], v[226:227], v[20:21], v[20:21] op_sel:[0,1,1] op_sel_hi:[1,1,1]
v_pk_fma_f32 v[232:233], v[232:233], v[20:21], v[20:21] op_sel:[0,1,1] op_sel_hi:[1,1,1]
v_pk_fma_f32 v[234:235], v[234:235], v[20:21], v[20:21] op_sel:[0,1,1] op_sel_hi:[1,1,1]
v_cvt_pk_bf16_f32 v172, v204, v205
v_cvt_pk_bf16_f32 v173, v206, v207
v_cvt_pk_bf16_f32 v174, v220, v221
v_cvt_pk_bf16_f32 v175, v222, v223
TR 18,7,8960
TR 20,7,8480
TR 22,7,8992
buffer_store_dwordx4 v[172:175], v11, s[16:19], s64 offen offset:1024 sc1
TR 24,7,8512
TR 26,7,9024
TR 28,7,8544
TR 30,7,9056
v_rcp_f32 v224, v224
v_rcp_f32 v225, v225
v_rcp_f32 v226, v226
v_rcp_f32 v227, v227
v_rcp_f32 v232, v232
v_rcp_f32 v233, v233
v_rcp_f32 v234, v234
v_rcp_f32 v235, v235
v_exp_f32 v228, v228
v_exp_f32 v229, v229
v_exp_f32 v230, v230
v_exp_f32 v231, v231
v_exp_f32 v236, v236
v_exp_f32 v237, v237
v_exp_f32 v238, v238
v_exp_f32 v239, v239
v_pk_mul_f32 v[240:241], v[240:241], v[224:225]
buffer_load_dwordx4 v[116:119], v4, s[16:19], s52 offen offset:1024 sc1
s_add_u32 s52, s77, 180224
v_pk_mul_f32 v[242:243], v[242:243], v[226:227]
v_pk_mul_f32 v[248:249], v[248:249], v[232:233]
v_pk_mul_f32 v[250:251], v[250:251], v[234:235]
.Lpad36:
s_cbranch_execz .Lpad39
v_pk_fma_f32 v[228:229], v[228:229], v[22:23], v[22:23] op_sel:[0,1,1] op_sel_hi:[1,1,1]
v_pk_fma_f32 v[230:231], v[230:231], v[22:23], v[22:23] op_sel:[0,1,1] op_sel_hi:[1,1,1]
v_pk_fma_f32 v[236:237], v[236:237], v[22:23], v[22:23] op_sel:[0,1,1] op_sel_hi:[1,1,1]
v_pk_fma_f32 v[238:239], v[238:239], v[22:23], v[22:23] op_sel:[0,1,1] op_sel_hi:[1,1,1]
v_cvt_pk_bf16_f32 v224, v240, v241
v_cvt_pk_bf16_f32 v225, v242, v243
v_cvt_pk_bf16_f32 v226, v248, v249
v_cvt_pk_bf16_f32 v227, v250, v251
v_rcp_f32 v228, v228
v_rcp_f32 v229, v229
v_rcp_f32 v230, v230
v_rcp_f32 v231, v231
v_rcp_f32 v236, v236
v_rcp_f32 v237, v237
v_rcp_f32 v238, v238
v_rcp_f32 v239, v239
v_pk_mul_f32 v[244:245], v[244:245], v[228:229]
buffer_store_dwordx4 v[224:227], v10, s[16:19], s65 offen sc1
v_pk_mul_f32 v[246:247], v[246:247], v[230:231]
v_pk_mul_f32 v[252:253], v[252:253], v[236:237]
v_pk_mul_f32 v[254:255], v[254:255], v[238:239]
v_cvt_pk_bf16_f32 v228, v244, v245
v_cvt_pk_bf16_f32 v229, v246, v247
v_cvt_pk_bf16_f32 v230, v252, v253
v_cvt_pk_bf16_f32 v231, v254, v255
buffer_store_dwordx4 v[228:231], v10, s[16:19], s65 offen offset:1024 sc1
buffer_load_dwordx4 v[120:123], v4, s[16:19], s52 offen sc1
buffer_load_dwordx4 v[124:127], v4, s[16:19], s52 offen offset:1024 sc1
v_mov_b32 v21, v68
v_mov_b32 v22, v69
v_mov_b32 v23, v70
v_mov_b32 v24, v71
v_mov_b32 v25, 0
s_waitcnt vmcnt(7) lgkmcnt(0)
s_barrier
v_mfma_f32_16x16x32_bf16 v[32:35], a[0:3], v[96:99], 0
ds_read_b64_tr_b16 a[32:33], v6
s_add_u32 s52, s78, 229376
MAV 32,16,104
buffer_load_dwordx4 v[128:131], v4, s[16:19], s52 offen sc1
v_mfma_f32_16x16x32_bf16 v[48:51], a[0:3], v[100:103], 0
TR 34,6,512
MAV 48,16,108
TR 36,6,32
TR 38,6,544
v_mfma_f32_16x16x32_bf16 v[52:55], a[4:7], v[100:103], 0
TR 48,6,8448
MAV 52,20,108
buffer_load_dwordx4 v[132:135], v4, s[16:19], s52 offen offset:1024 sc1
v_mfma_f32_16x16x32_bf16 v[36:39], a[4:7], v[96:99], 0
TR 50,6,8960
MAV 36,20,104
TR 52,6,8480
TR 54,6,8992
v_mfma_f32_16x16x32_bf16 v[40:43], a[8:11], v[96:99], 0
TR 40,6,64
s_add_u32 s52, s78, 294912
MAV 40,24,104
buffer_load_dwordx4 v[136:139], v4, s[16:19], s52 offen sc1
v_mfma_f32_16x16x32_bf16 v[56:59], a[8:11], v[100:103], 0
TR 42,6,576
MAV 56,24,108
TR 44,6,96
TR 46,6,608
v_mfma_f32_16x16x32_bf16 v[60:63], a[12:15], v[100:103], 0
TR 56,6,8512
MAV 60,28,108
buffer_load_dwordx4 v[140:143], v4, s[16:19], s52 offen offset:1024 sc1
v_mfma_f32_16x16x32_bf16 v[44:47], a[12:15], v[96:99], 0
TR 58,6,9024
MAV 44,28,104
TR 60,6,8544
TR 62,6,9056
s_waitcnt lgkmcnt(8)
v_mfma_f32_16x16x32_bf16 v[64:67], a[32:35], v[96:99], 0
TR 0,7,16896
s_add_u32 s52, s79, 344064
MAV 64,48,104
buffer_load_dwordx4 v[144:147], v4, s[16:19], s52 offen sc1
v_mfma_f32_16x16x32_bf16 v[80:83], a[32:35], v[100:103], 0
TR 2,7,17408
MAV 80,48,108
TR 4,7,16928
TR 6,7,17440
v_mfma_f32_16x16x32_bf16 v[84:87], a[36:39], v[100:103], 0
TR 16,7,25344
MAV 84,52,108
buffer_load_dwordx4 v[148:151], v4, s[16:19], s52 offen offset:1024 sc1
v_mfma_f32_16x16x32_bf16 v[68:71], a[36:39], v[96:99], 0
TR 18,7,25856
MAV 68,52,104
TR 20,7,25376
TR 22,7,25888
s_waitcnt lgkmcnt(8)
v_mfma_f32_16x16x32_bf16 v[72:75], a[40:43], v[96:99], 0
TR 8,7,16960
s_add_u32 s52, s79, 409600
MAV 72,56,104
buffer_load_dwordx4 v[152:155], v4, s[16:19], s52 offen sc1
v_mfma_f32_16x16x32_bf16 v[88:91], a[40:43], v[100:103], 0
TR 10,7,17472
MAV 88,56,108
TR 12,7,16992
TR 14,7,17504
v_mfma_f32_16x16x32_bf16 v[92:95], a[44:47], v[100:103], 0
TR 24,7,25408
MAV 92,60,108
buffer_load_dwordx4 v[156:159], v4, s[16:19], s52 offen offset:1024 sc1
v_mfma_f32_16x16x32_bf16 v[76:79], a[44:47], v[96:99], 0
TR 26,7,25920
MAV 76,60,104
TR 28,7,25440
TR 30,7,25952
s_waitcnt vmcnt(8) lgkmcnt(8)
s_barrier
MAV 32,0,112
TR 32,6,16896
s_add_u32 m0, s55, 0
MAV 32,16,120
buffer_load_dwordx4 v18, s[28:31], s54 offen lds
MAV 48,16,124
TR 34,6,17408
MAV 48,0,116
TR 36,6,16928
TR 38,6,17440
MAV 52,4,116
TR 48,6,25344
s_add_u32 s52, s76, 458752
MAV 52,20,124
buffer_load_dwordx4 v[96:99], v4, s[16:19], s52 offen sc1
MAV 36,20,120
TR 50,6,25856
MAV 36,4,112
TR 52,6,25376
TR 54,6,25888
s_waitcnt lgkmcnt(8)
MAV 40,8,112
TR 40,6,16960
MAV 40,24,120
buffer_load_dwordx4 v19, s[28:31], s54 offen offset:1056 lds
MAV 56,24,124
TR 42,6,17472
s_add_u32 s54, s98, 327680
MAV 56,8,116
TR 44,6,16992
TR 46,6,17504
MAV 60,12,116
TR 56,6,25408
MAV 60,28,124
buffer_load_dwordx4 v[100:103], v4, s[16:19], s52 offen offset:1024 sc1
MAV 44,28,120
TR 58,6,25920
MAV 44,12,112
TR 60,6,25440
TR 62,6,25952
s_waitcnt lgkmcnt(8)
MAV 64,32,112
TR 0,7,33792
s_add_u32 m0, s55, 8448
MAV 64,48,120
buffer_load_dwordx4 v18, s[28:31], s54 offen lds
MAV 80,48,124
TR 2,7,34304
MAV 80,32,116
TR 4,7,33824
TR 6,7,34336
MAV 84,36,116
TR 16,7,42240
s_add_u32 s52, s76, 524288
MAV 84,52,124
buffer_load_dwordx4 v[104:107], v4, s[16:19], s52 offen sc1
MAV 68,52,120
TR 18,7,42752
MAV 68,36,112
TR 20,7,42272
TR 22,7,42784
s_waitcnt lgkmcnt(8)
MAV 72,40,112
TR 8,7,33856
MAV 72,56,120
buffer_load_dwordx4 v19, s[28:31], s54 offen offset:1056 lds
MAV 88,56,124
TR 10,7,34368
s_add_u32 s54, s99, 524288
MAV 88,40,116
TR 12,7,33888
TR 14,7,34400
MAV 92,44,116
TR 24,7,42304
MAV 92,60,124
buffer_load_dwordx4 v[108:111], v4, s[16:19], s52 offen offset:1024 sc1
MAV 76,60,120
TR 26,7,42816
MAV 76,44,112
TR 28,7,42336
TR 30,7,42848
s_waitcnt vmcnt(12) lgkmcnt(8)
s_barrier
MAV 32,0,128
TR 32,6,33792
MAV 32,16,136
buffer_atomic_add v24, v21, s[16:19], s72 offen
MAV 48,16,140
TR 34,6,34304
MAV 48,0,132
TR 36,6,33824
TR 38,6,34336
TR 48,6,42240
MAV 52,4,132
TR 50,6,42752
s_add_u32 m0, s55, 16896
MAV 52,20,140
buffer_load_dwordx4 v18, s[28:31], s54 offen lds
MAV 36,20,136
TR 52,6,42272
MAV 36,4,128
TR 54,6,42784
TR 40,6,33856
s_waitcnt lgkmcnt(9)
MAV 40,8,128
TR 42,6,34368
s_add_u32 s52, s77, 573440
MAV 40,24,136
buffer_load_dwordx4 v[112:115], v4, s[16:19], s52 offen sc1
MAV 56,24,140
TR 44,6,33888
MAV 56,8,132
buffer_load_dwordx4 v19, s[28:31], s54 offen offset:1056 lds
MAV 60,12,132
TR 46,6,34400
s_add_u32 s54, s99, 786432
MAV 60,28,140
buffer_load_dwordx4 v[116:119], v4, s[16:19], s52 offen offset:1024 sc1
MAV 44,28,136
TR 56,6,42304
MAV 44,12,128
TR 58,6,42816
TR 60,6,42336
TR 62,6,42848
s_waitcnt lgkmcnt(8)
MAV 64,32,128
TR 0,7,50688
s_add_u32 m0, s55, 25344
MAV 64,48,136
buffer_load_dwordx4 v18, s[28:31], s54 offen lds
MAV 80,48,140
TR 2,7,51200
MAV 80,32,132
TR 4,7,50720
TR 6,7,51232
MAV 84,36,132
TR 16,7,59136
s_add_u32 s52, s77, 638976
MAV 84,52,140
buffer_load_dwordx4 v[120:123], v4, s[16:19], s52 offen sc1
MAV 68,52,136
TR 18,7,59648
MAV 68,36,128
TR 20,7,59168
TR 22,7,59680
s_waitcnt lgkmcnt(8)
MAV 72,40,128
TR 8,7,50752
MAV 72,56,136
buffer_load_dwordx4 v19, s[28:31], s54 offen offset:1056 lds
MAV 88,56,140
TR 10,7,51264
s_add_u32 s54, s100, 983040
MAV 88,40,132
TR 12,7,50784
TR 14,7,51296
MAV 92,44,132
TR 24,7,59200
MAV 92,60,140
buffer_load_dwordx4 v[124:127], v4, s[16:19], s52 offen offset:1024 sc1
MAV 76,60,136
TR 26,7,59712
MAV 76,44,128
TR 28,7,59232
TR 30,7,59744
s_waitcnt vmcnt(17) lgkmcnt(8)
s_barrier
MAV 32,0,144
TR 32,6,50688
s_add_u32 m0, s55, 33792
MAV 32,16,152
buffer_load_dwordx4 v18, s[28:31], s54 offen lds
MAV 48,16,156
TR 34,6,51200
MAV 48,0,148
TR 36,6,50720
TR 38,6,51232
MAV 52,4,148
TR 48,6,59136
s_add_u32 s52, s78, 688128
MAV 52,20,156
buffer_load_dwordx4 v[128:131], v4, s[16:19], s52 offen sc1
MAV 36,20,152
TR 50,6,59648
MAV 36,4,144
TR 52,6,59168
TR 54,6,59680
s_waitcnt lgkmcnt(8)
MAV 40,8,144
TR 40,6,50752
MAV 40,24,152
buffer_load_dwordx4 v19, s[28:31], s54 offen offset:1056 lds
MAV 56,24,156
TR 42,6,51264
s_add_u32 s54, s100, 1245184
MAV 56,8,148
TR 44,6,50784
TR 46,6,51296
MAV 60,12,148
TR 56,6,59200
MAV 60,28,156
buffer_load_dwordx4 v[132:135], v4, s[16:19], s52 offen offset:1024 sc1
MAV 44,28,152
TR 58,6,59712
MAV 44,12,144
TR 60,6,59232
TR 62,6,59744
v_add_u32 v7, s57, v7
v_add_u32 v6, s57, v6
s_sub_u32 s57, 0, s57
s_waitcnt lgkmcnt(8)
MAV 64,32,144
ds_read_b64_tr_b16 a[0:1], v7
s_add_u32 m0, s55, 42240
MAV 64,48,152
buffer_load_dwordx4 v18, s[28:31], s54 offen lds
MAV 80,48,156
TR 2,7,512
MAV 80,32,148
TR 4,7,32
TR 6,7,544
TR 16,7,8448
MAV 84,36,148
TR 18,7,8960
s_add_u32 s52, s78, 753664
MAV 84,52,156
buffer_load_dwordx4 v[136:139], v4, s[16:19], s52 offen sc1
MAV 68,52,152
TR 20,7,8480
MAV 68,36,144
TR 22,7,8992
TR 8,7,64
s_waitcnt lgkmcnt(9)
MAV 72,40,144
TR 10,7,576
MAV 72,56,152
buffer_load_dwordx4 v19, s[28:31], s54 offen offset:1056 lds
MAV 88,56,156
TR 12,7,96
s_add_u32 s54, s101, 1441792
MAV 88,40,148
buffer_load_dwordx4 v[140:143], v4, s[16:19], s52 offen offset:1024 sc1
MAV 92,44,148
TR 14,7,608
MAV 92,60,156
buffer_atomic_add v25, v22, s[16:19], s73 offen sc0
MAV 76,60,152
TR 24,7,8512
MAV 76,44,144
TR 26,7,9024
TR 28,7,8544
TR 30,7,9056
s_waitcnt vmcnt(18) lgkmcnt(8)
s_barrier
MAV 32,0,96
ds_read_b64_tr_b16 a[32:33], v6
s_add_u32 m0, s55, 50688
MAV 32,16,104
buffer_load_dwordx4 v18, s[28:31], s54 offen lds
MAV 48,16,108
TR 34,6,512
MAV 48,0,100
TR 36,6,32
TR 38,6,544
MAV 52,4,100
TR 48,6,8448
s_add_u32 s52, s79, 802816
MAV 52,20,108
buffer_load_dwordx4 v[144:147], v4, s[16:19], s52 offen sc1
MAV 36,20,104
TR 50,6,8960
MAV 36,4,96
TR 52,6,8480
TR 54,6,8992
s_waitcnt lgkmcnt(8)
MAV 40,8,96
TR 40,6,64
MAV 40,24,104
buffer_load_dwordx4 v19, s[28:31], s54 offen offset:1056 lds
MAV 56,24,108
TR 42,6,576
s_add_u32 s54, s101, 1703936
MAV 56,8,100
TR 44,6,96
TR 46,6,608
MAV 60,12,100
TR 56,6,8512
MAV 60,28,108
buffer_load_dwordx4 v[148:151], v4, s[16:19], s52 offen offset:1024 sc1
MAV 44,28,104
TR 58,6,9024
MAV 44,12,96
TR 60,6,8544
TR 62,6,9056
s_waitcnt lgkmcnt(8)
MAV 64,32,96
TR 0,7,16896
s_add_u32 m0, s55, 59136
MAV 64,48,104
buffer_load_dwordx4 v18, s[28:31], s54 offen lds
MAV 80,48,108
TR 2,7,17408
MAV 80,32,100
TR 4,7,16928
TR 6,7,17440
MAV 84,36,100
TR 16,7,25344
s_add_u32 s52, s79, 868352
MAV 84,52,108
buffer_load_dwordx4 v[152:155], v4, s[16:19], s52 offen sc1
MAV 68,52,104
TR 18,7,25856
MAV 68,36,96
TR 20,7,25376
TR 22,7,25888
s_waitcnt lgkmcnt(8)
MAV 72,40,96
TR 8,7,16960
MAV 72,56,104
buffer_load_dwordx4 v19, s[28:31], s54 offen offset:1056 lds
MAV 88,56,108
TR 10,7,17472
s_add_u32 s54, s98, 1900544
MAV 88,40,100
TR 12,7,16992
TR 14,7,17504
MAV 92,44,100
TR 24,7,25408
MAV 92,60,108
buffer_load_dwordx4 v[156:159], v4, s[16:19], s52 offen offset:1024 sc1
MAV 76,60,104
TR 26,7,25920
MAV 76,44,96
TR 28,7,25440
TR 30,7,25952
s_waitcnt vmcnt(8)
v_cmp_gt_u32 vcc, v23, v25
s_nop 0
s_cbranch_vccnz .Lsp67
.Lsp67b:
s_waitcnt lgkmcnt(8)
s_barrier
MAV 32,0,112
TR 32,6,16896
s_add_u32 m0, s55, 67584
MAV 32,16,120
buffer_load_dwordx4 v18, s[28:31], s54 offen lds
MAV 48,16,124
TR 34,6,17408
MAV 48,0,116
TR 36,6,16928
TR 38,6,17440
MAV 52,4,116
TR 48,6,25344
s_add_u32 s52, s76, 16384
MAV 52,20,124
buffer_load_dwordx4 v[96:99], v4, s[16:19], s52 offen sc1
MAV 36,20,120
TR 50,6,25856
MAV 36,4,112
TR 52,6,25376
TR 54,6,25888
s_waitcnt lgkmcnt(8)
MAV 40,8,112
TR 40,6,16960
MAV 40,24,120
buffer_load_dwordx4 v19, s[28:31], s54 offen offset:1056 lds
MAV 56,24,124
TR 42,6,17472
s_add_u32 s54, s98, 2162688
MAV 56,8,116
TR 44,6,16992
TR 46,6,17504
MAV 60,12,116
TR 56,6,25408
MAV 60,28,124
buffer_load_dwordx4 v[100:103], v4, s[16:19], s52 offen offset:1024 sc1
MAV 44,28,120
TR 58,6,25920
MAV 44,12,112
TR 60,6,25440
TR 62,6,25952
s_waitcnt lgkmcnt(8)
MAV 64,32,112
TR 0,7,33792
s_add_u32 m0, s55, 76032
MAV 64,48,120
buffer_load_dwordx4 v18, s[28:31], s54 offen lds
MAV 80,48,124
TR 2,7,34304
MAV 80,32,116
TR 4,7,33824
TR 6,7,34336
MAV 84,36,116
TR 16,7,42240
s_add_u32 s52, s76, 81920
MAV 84,52,124
buffer_load_dwordx4 v[104:107], v4, s[16:19], s52 offen sc1
MAV 68,52,120
TR 18,7,42752
MAV 68,36,112
TR 20,7,42272
TR 22,7,42784
s_waitcnt lgkmcnt(8)
MAV 72,40,112
TR 8,7,33856
MAV 72,56,120
buffer_load_dwordx4 v19, s[28:31], s54 offen offset:1056 lds
MAV 88,56,124
TR 10,7,34368
s_add_u32 s54, s99, 2359296
MAV 88,40,116
TR 12,7,33888
TR 14,7,34400
MAV 92,44,116
TR 24,7,42304
MAV 92,60,124
buffer_load_dwordx4 v[108:111], v4, s[16:19], s52 offen offset:1024 sc1
MAV 76,60,120
TR 26,7,42816
MAV 76,44,112
TR 28,7,42336
.Lpad37:
s_cbranch_execz .Lpad40
TR 30,7,42848
s_waitcnt lgkmcnt(8)
s_barrier
MAV 32,0,128
TR 32,6,33792
s_add_u32 m0, s55, 84480
MAV 32,16,136
buffer_load_dwordx4 v18, s[28:31], s54 offen lds
MAV 48,16,140
TR 34,6,34304
MAV 48,0,132
TR 36,6,33824
TR 38,6,34336
MAV 52,4,132
TR 48,6,42240
s_add_u32 s52, s77, 131072
MAV 52,20,140
buffer_load_dwordx4 v[112:115], v4, s[16:19], s52 offen sc1
MAV 36,20,136
TR 50,6,42752
MAV 36,4,128
TR 52,6,42272
TR 54,6,42784
s_waitcnt lgkmcnt(8)
MAV 40,8,128
TR 40,6,33856
MAV 40,24,136
buffer_load_dwordx4 v19, s[28:31], s54 offen offset:1056 lds
MAV 56,24,140
TR 42,6,34368
s_add_u32 s54, s99, 2621440
MAV 56,8,132
TR 44,6,33888
TR 46,6,34400
MAV 60,12,132
TR 56,6,42304
MAV 60,28,140
buffer_load_dwordx4 v[116:119], v4, s[16:19], s52 offen offset:1024 sc1
MAV 44,28,136
TR 58,6,42816
MAV 44,12,128
TR 60,6,42336
TR 62,6,42848
s_waitcnt lgkmcnt(8)
MAV 64,32,128
TR 0,7,50688
s_add_u32 m0, s55, 92928
MAV 64,48,136
buffer_load_dwordx4 v18, s[28:31], s54 offen lds
MAV 80,48,140
TR 2,7,51200
MAV 80,32,132
TR 4,7,50720
TR 6,7,51232
MAV 84,36,132
TR 16,7,59136
s_add_u32 s52, s77, 196608
MAV 84,52,140
buffer_load_dwordx4 v[120:123], v4, s[16:19], s52 offen sc1
MAV 68,52,136
TR 18,7,59648
MAV 68,36,128
TR 20,7,59168
TR 22,7,59680
s_waitcnt lgkmcnt(8)
MAV 72,40,128
TR 8,7,50752
MAV 72,56,136
buffer_load_dwordx4 v19, s[28:31], s54 offen offset:1056 lds
MAV 88,56,140
TR 10,7,51264
s_add_u32 s54, s100, 2818048
MAV 88,40,132
TR 12,7,50784
TR 14,7,51296
MAV 92,44,132
TR 24,7,59200
MAV 92,60,140
buffer_load_dwordx4 v[124:127], v4, s[16:19], s52 offen offset:1024 sc1
MAV 76,60,136
TR 26,7,59712
MAV 76,44,128
TR 28,7,59232
TR 30,7,59744
s_waitcnt vmcnt(16) lgkmcnt(8)
s_barrier
MAV 32,0,144
TR 32,6,50688
s_add_u32 m0, s55, 101376
MAV 32,16,152
buffer_load_dwordx4 v18, s[28:31], s54 offen lds
MAV 48,16,156
TR 34,6,51200
MAV 48,0,148
TR 36,6,50720
TR 38,6,51232
MAV 52,4,148
TR 48,6,59136
s_add_u32 s52, s78, 245760
MAV 52,20,156
buffer_load_dwordx4 v[128:131], v4, s[16:19], s52 offen sc1
MAV 36,20,152
TR 50,6,59648
MAV 36,4,144
TR 52,6,59168
TR 54,6,59680
s_waitcnt lgkmcnt(8)
MAV 40,8,144
TR 40,6,50752
MAV 40,24,152
buffer_load_dwordx4 v19, s[28:31], s54 offen offset:1056 lds
MAV 56,24,156
TR 42,6,51264
s_add_u32 s54, s100, 3080192
MAV 56,8,148
TR 44,6,50784
TR 46,6,51296
MAV 60,12,148
TR 56,6,59200
MAV 60,28,156
buffer_load_dwordx4 v[132:135], v4, s[16:19], s52 offen offset:1024 sc1
MAV 44,28,152
TR 58,6,59712
MAV 44,12,144
TR 60,6,59232
TR 62,6,59744
v_add_u32 v7, s57, v7
v_add_u32 v6, s57, v6
s_sub_u32 s57, 0, s57
s_waitcnt lgkmcnt(8)
MAV 64,32,144
ds_read_b64_tr_b16 a[0:1], v7
s_add_u32 m0, s55, 109824
MAV 64,48,152
buffer_load_dwordx4 v18, s[28:31], s54 offen lds
MAV 80,48,156
TR 2,7,512
MAV 80,32,148
TR 4,7,32
TR 6,7,544
MAV 84,36,148
TR 16,7,8448
s_add_u32 s52, s78, 311296
MAV 84,52,156
buffer_load_dwordx4 v[136:139], v4, s[16:19], s52 offen sc1
MAV 68,52,152
TR 18,7,8960
MAV 68,36,144
TR 20,7,8480
TR 22,7,8992
s_waitcnt lgkmcnt(8)
MAV 72,40,144
TR 8,7,64
MAV 72,56,152
buffer_load_dwordx4 v19, s[28:31], s54 offen offset:1056 lds
MAV 88,56,156
TR 10,7,576
s_add_u32 s54, s101, 3276800
MAV 88,40,148
TR 12,7,96
TR 14,7,608
MAV 92,44,148
TR 24,7,8512
MAV 92,60,156
buffer_load_dwordx4 v[140:143], v4, s[16:19], s52 offen offset:1024 sc1
MAV 76,60,152
TR 26,7,9024
MAV 76,44,144
TR 28,7,8544
TR 30,7,9056
s_waitcnt vmcnt(16) lgkmcnt(8)
s_barrier
MAV 32,0,96
ds_read_b64_tr_b16 a[32:33], v6
s_add_u32 m0, s55, 118272
MAV 32,16,104
buffer_load_dwordx4 v18, s[28:31], s54 offen lds
MAV 48,16,108
TR 34,6,512
MAV 48,0,100
TR 36,6,32
TR 38,6,544
MAV 52,4,100
TR 48,6,8448
s_add_u32 s52, s79, 360448
MAV 52,20,108
buffer_load_dwordx4 v[144:147], v4, s[16:19], s52 offen sc1
MAV 36,20,104
TR 50,6,8960
MAV 36,4,96
TR 52,6,8480
TR 54,6,8992
s_waitcnt lgkmcnt(8)
MAV 40,8,96
TR 40,6,64
MAV 40,24,104
buffer_load_dwordx4 v19, s[28:31], s54 offen offset:1056 lds
MAV 56,24,108
TR 42,6,576
s_add_u32 s54, s101, 3538944
MAV 56,8,100
TR 44,6,96
TR 46,6,608
MAV 60,12,100
TR 56,6,8512
MAV 60,28,108
buffer_load_dwordx4 v[148:151], v4, s[16:19], s52 offen offset:1024 sc1
MAV 44,28,104
TR 58,6,9024
MAV 44,12,96
TR 60,6,8544
TR 62,6,9056
s_waitcnt lgkmcnt(8)
MAV 64,32,96
TR 0,7,16896
s_add_u32 m0, s55, 126720
MAV 64,48,104
buffer_load_dwordx4 v18, s[28:31], s54 offen lds
MAV 80,48,108
TR 2,7,17408
MAV 80,32,100
TR 4,7,16928
TR 6,7,17440
MAV 84,36,100
TR 16,7,25344
s_add_u32 s52, s79, 425984
MAV 84,52,108
buffer_load_dwordx4 v[152:155], v4, s[16:19], s52 offen sc1
MAV 68,52,104
TR 18,7,25856
MAV 68,36,96
TR 20,7,25376
TR 22,7,25888
s_waitcnt lgkmcnt(8)
MAV 72,40,96
TR 8,7,16960
MAV 72,56,104
buffer_load_dwordx4 v19, s[28:31], s54 offen offset:1056 lds
MAV 88,56,108
TR 10,7,17472
s_add_u32 s54, s98, 131072
MAV 88,40,100
TR 12,7,16992
TR 14,7,17504
MAV 92,44,100
TR 24,7,25408
MAV 92,60,108
buffer_load_dwordx4 v[156:159], v4, s[16:19], s52 offen offset:1024 sc1
MAV 76,60,104
TR 26,7,25920
MAV 76,44,96
TR 28,7,25440
TR 30,7,25952
s_waitcnt vmcnt(16) lgkmcnt(8)
s_barrier
MAV 32,0,112
TR 32,6,16896
s_add_u32 m0, s55, 0
MAV 32,16,120
buffer_load_dwordx4 v18, s[28:31], s54 offen lds
MAV 48,16,124
TR 34,6,17408
MAV 48,0,116
TR 36,6,16928
TR 38,6,17440
MAV 52,4,116
TR 48,6,25344
s_add_u32 s52, s76, 475136
MAV 52,20,124
buffer_load_dwordx4 v[96:99], v4, s[16:19], s52 offen sc1
MAV 36,20,120
TR 50,6,25856
MAV 36,4,112
TR 52,6,25376
TR 54,6,25888
s_waitcnt lgkmcnt(8)
MAV 40,8,112
TR 40,6,16960
MAV 40,24,120
buffer_load_dwordx4 v19, s[28:31], s54 offen offset:1056 lds
MAV 56,24,124
TR 42,6,17472
s_add_u32 s54, s98, 393216
MAV 56,8,116
TR 44,6,16992
TR 46,6,17504
MAV 60,12,116
TR 56,6,25408
MAV 60,28,124
buffer_load_dwordx4 v[100:103], v4, s[16:19], s52 offen offset:1024 sc1
MAV 44,28,120
TR 58,6,25920
MAV 44,12,112
TR 60,6,25440
TR 62,6,25952
s_waitcnt lgkmcnt(8)
MAV 64,32,112
TR 0,7,33792
s_add_u32 m0, s55, 8448
MAV 64,48,120
buffer_load_dwordx4 v18, s[28:31], s54 offen lds
MAV 80,48,124
TR 2,7,34304
MAV 80,32,116
TR 4,7,33824
TR 6,7,34336
MAV 84,36,116
TR 16,7,42240
s_add_u32 s52, s76, 540672
MAV 84,52,124
buffer_load_dwordx4 v[104:107], v4, s[16:19], s52 offen sc1
MAV 68,52,120
TR 18,7,42752
MAV 68,36,112
TR 20,7,42272
TR 22,7,42784
s_waitcnt lgkmcnt(8)
MAV 72,40,112
TR 8,7,33856
MAV 72,56,120
buffer_load_dwordx4 v19, s[28:31], s54 offen offset:1056 lds
MAV 88,56,124
TR 10,7,34368
s_add_u32 s54, s99, 589824
MAV 88,40,116
TR 12,7,33888
TR 14,7,34400
MAV 92,44,116
TR 24,7,42304
MAV 92,60,124
buffer_load_dwordx4 v[108:111], v4, s[16:19], s52 offen offset:1024 sc1
MAV 76,60,120
TR 26,7,42816
MAV 76,44,112
TR 28,7,42336
TR 30,7,42848
s_waitcnt vmcnt(16) lgkmcnt(8)
s_barrier
MAV 32,0,128
TR 32,6,33792
s_add_u32 m0, s55, 16896
MAV 32,16,136
buffer_load_dwordx4 v18, s[28:31], s54 offen lds
MAV 48,16,140
TR 34,6,34304
MAV 48,0,132
TR 36,6,33824
TR 38,6,34336
MAV 52,4,132
TR 48,6,42240
s_add_u32 s52, s77, 589824
MAV 52,20,140
buffer_load_dwordx4 v[112:115], v4, s[16:19], s52 offen sc1
MAV 36,20,136
TR 50,6,42752
MAV 36,4,128
TR 52,6,42272
TR 54,6,42784
s_waitcnt lgkmcnt(8)
MAV 40,8,128
TR 40,6,33856
MAV 40,24,136
buffer_load_dwordx4 v19, s[28:31], s54 offen offset:1056 lds
MAV 56,24,140
TR 42,6,34368
s_add_u32 s54, s99, 851968
MAV 56,8,132
TR 44,6,33888
TR 46,6,34400
MAV 60,12,132
TR 56,6,42304
MAV 60,28,140
buffer_load_dwordx4 v[116:119], v4, s[16:19], s52 offen offset:1024 sc1
MAV 44,28,136
TR 58,6,42816
MAV 44,12,128
TR 60,6,42336
TR 62,6,42848
s_waitcnt lgkmcnt(8)
MAV 64,32,128
TR 0,7,50688
s_add_u32 m0, s55, 25344
MAV 64,48,136
buffer_load_dwordx4 v18, s[28:31], s54 offen lds
MAV 80,48,140
TR 2,7,51200
MAV 80,32,132
TR 4,7,50720
TR 6,7,51232
MAV 84,36,132
TR 16,7,59136
s_add_u32 s52, s77, 655360
MAV 84,52,140
buffer_load_dwordx4 v[120:123], v4, s[16:19], s52 offen sc1
MAV 68,52,136
TR 18,7,59648
MAV 68,36,128
TR 20,7,59168
TR 22,7,59680
s_waitcnt lgkmcnt(8)
MAV 72,40,128
TR 8,7,50752
MAV 72,56,136
buffer_load_dwordx4 v19, s[28:31], s54 offen offset:1056 lds
MAV 88,56,140
TR 10,7,51264
s_add_u32 s54, s100, 1048576
MAV 88,40,132
TR 12,7,50784
TR 14,7,51296
MAV 92,44,132
TR 24,7,59200
MAV 92,60,140
buffer_load_dwordx4 v[124:127], v4, s[16:19], s52 offen offset:1024 sc1
MAV 76,60,136
TR 26,7,59712
MAV 76,44,128
TR 28,7,59232
TR 30,7,59744
s_waitcnt vmcnt(16) lgkmcnt(8)
s_barrier
MAV 32,0,144
TR 32,6,50688
s_add_u32 m0, s55, 33792
MAV 32,16,152
buffer_load_dwordx4 v18, s[28:31], s54 offen lds
MAV 48,16,156
TR 34,6,51200
MAV 48,0,148
TR 36,6,50720
TR 38,6,51232
MAV 52,4,148
TR 48,6,59136
s_add_u32 s52, s78, 704512
MAV 52,20,156
buffer_load_dwordx4 v[128:131], v4, s[16:19], s52 offen sc1
MAV 36,20,152
TR 50,6,59648
MAV 36,4,144
TR 52,6,59168
TR 54,6,59680
s_waitcnt lgkmcnt(8)
MAV 40,8,144
TR 40,6,50752
MAV 40,24,152
buffer_load_dwordx4 v19, s[28:31], s54 offen offset:1056 lds
MAV 56,24,156
TR 42,6,51264
s_add_u32 s54, s100, 1310720
MAV 56,8,148
TR 44,6,50784
TR 46,6,51296
MAV 60,12,148
TR 56,6,59200
MAV 60,28,156
buffer_load_dwordx4 v[132:135], v4, s[16:19], s52 offen offset:1024 sc1
MAV 44,28,152
TR 58,6,59712
MAV 44,12,144
TR 60,6,59232
TR 62,6,59744
v_add_u32 v7, s57, v7
v_add_u32 v6, s57, v6
s_sub_u32 s57, 0, s57
s_waitcnt lgkmcnt(8)
MAV 64,32,144
ds_read_b64_tr_b16 a[0:1], v7
s_add_u32 m0, s55, 42240
MAV 64,48,152
buffer_load_dwordx4 v18, s[28:31], s54 offen lds
MAV 80,48,156
TR 2,7,512
MAV 80,32,148
TR 4,7,32
TR 6,7,544
MAV 84,36,148
TR 16,7,8448
s_add_u32 s52, s78, 770048
MAV 84,52,156
buffer_load_dwordx4 v[136:139], v4, s[16:19], s52 offen sc1
MAV 68,52,152
TR 18,7,8960
MAV 68,36,144
TR 20,7,8480
TR 22,7,8992
s_waitcnt lgkmcnt(8)
MAV 72,40,144
TR 8,7,64
MAV 72,56,152
buffer_load_dwordx4 v19, s[28:31], s54 offen offset:1056 lds
MAV 88,56,156
TR 10,7,576
s_add_u32 s54, s101, 1507328
MAV 88,40,148
TR 12,7,96
TR 14,7,608
MAV 92,44,148
TR 24,7,8512
MAV 92,60,156
buffer_load_dwordx4 v[140:143], v4, s[16:19], s52 offen offset:1024 sc1
MAV 76,60,152
TR 26,7,9024
MAV 76,44,144
TR 28,7,8544
TR 30,7,9056
s_waitcnt vmcnt(16) lgkmcnt(8)
s_barrier
MAV 32,0,96
ds_read_b64_tr_b16 a[32:33], v6
s_add_u32 m0, s55, 50688
MAV 32,16,104
buffer_load_dwordx4 v18, s[28:31], s54 offen lds
MAV 48,16,108
TR 34,6,512
MAV 48,0,100
TR 36,6,32
TR 38,6,544
MAV 52,4,100
TR 48,6,8448
s_add_u32 s52, s79, 819200
MAV 52,20,108
buffer_load_dwordx4 v[144:147], v4, s[16:19], s52 offen sc1
MAV 36,20,104
TR 50,6,8960
MAV 36,4,96
TR 52,6,8480
TR 54,6,8992
s_waitcnt lgkmcnt(8)
MAV 40,8,96
TR 40,6,64
MAV 40,24,104
buffer_load_dwordx4 v19, s[28:31], s54 offen offset:1056 lds
.Lpad38:
s_cbranch_execz .Lnopoll63r
MAV 56,24,108
TR 42,6,576
s_add_u32 s54, s101, 1769472
MAV 56,8,100
TR 44,6,96
TR 46,6,608
MAV 60,12,100
TR 56,6,8512
MAV 60,28,108
buffer_load_dwordx4 v[148:151], v4, s[16:19], s52 offen offset:1024 sc1
MAV 44,28,104
TR 58,6,9024
MAV 44,12,96
TR 60,6,8544
TR 62,6,9056
s_waitcnt lgkmcnt(8)
MAV 64,32,96
TR 0,7,16896
s_add_u32 m0, s55, 59136
MAV 64,48,104
buffer_load_dwordx4 v18, s[28:31], s54 offen lds
MAV 80,48,108
TR 2,7,17408
MAV 80,32,100
TR 4,7,16928
TR 6,7,17440
MAV 84,36,100
TR 16,7,25344
s_add_u32 s52, s79, 884736
MAV 84,52,108
buffer_load_dwordx4 v[152:155], v4, s[16:19], s52 offen sc1
MAV 68,52,104
TR 18,7,25856
MAV 68,36,96
TR 20,7,25376
TR 22,7,25888
s_waitcnt lgkmcnt(8)
MAV 72,40,96
TR 8,7,16960
MAV 72,56,104
buffer_load_dwordx4 v19, s[28:31], s54 offen offset:1056 lds
MAV 88,56,108
TR 10,7,17472
s_add_u32 s54, s98, 1966080
MAV 88,40,100
TR 12,7,16992
TR 14,7,17504
MAV 92,44,100
TR 24,7,25408
MAV 92,60,108
buffer_load_dwordx4 v[156:159], v4, s[16:19], s52 offen offset:1024 sc1
MAV 76,60,104
TR 26,7,25920
MAV 76,44,96
TR 28,7,25440
TR 30,7,25952
s_waitcnt vmcnt(16) lgkmcnt(8)
s_barrier
MAV 32,0,112
TR 32,6,16896
s_add_u32 m0, s55, 67584
MAV 32,16,120
buffer_load_dwordx4 v18, s[28:31], s54 offen lds
MAV 48,16,124
TR 34,6,17408
MAV 48,0,116
TR 36,6,16928
TR 38,6,17440
MAV 52,4,116
TR 48,6,25344
s_add_u32 s52, s76, 32768
MAV 52,20,124
buffer_load_dwordx4 v[96:99], v4, s[16:19], s52 offen sc1
MAV 36,20,120
TR 50,6,25856
MAV 36,4,112
TR 52,6,25376
TR 54,6,25888
s_waitcnt lgkmcnt(8)
MAV 40,8,112
TR 40,6,16960
MAV 40,24,120
buffer_load_dwordx4 v19, s[28:31], s54 offen offset:1056 lds
MAV 56,24,124
TR 42,6,17472
s_add_u32 s54, s98, 2228224
MAV 56,8,116
TR 44,6,16992
TR 46,6,17504
MAV 60,12,116
TR 56,6,25408
MAV 60,28,124
buffer_load_dwordx4 v[100:103], v4, s[16:19], s52 offen offset:1024 sc1
MAV 44,28,120
TR 58,6,25920
MAV 44,12,112
TR 60,6,25440
TR 62,6,25952
s_waitcnt lgkmcnt(8)
MAV 64,32,112
TR 0,7,33792
s_add_u32 m0, s55, 76032
MAV 64,48,120
buffer_load_dwordx4 v18, s[28:31], s54 offen lds
MAV 80,48,124
TR 2,7,34304
MAV 80,32,116
TR 4,7,33824
TR 6,7,34336
MAV 84,36,116
TR 16,7,42240
s_add_u32 s52, s76, 98304
MAV 84,52,124
buffer_load_dwordx4 v[104:107], v4, s[16:19], s52 offen sc1
MAV 68,52,120
TR 18,7,42752
MAV 68,36,112
TR 20,7,42272
TR 22,7,42784
s_waitcnt lgkmcnt(8)
MAV 72,40,112
TR 8,7,33856
MAV 72,56,120
buffer_load_dwordx4 v19, s[28:31], s54 offen offset:1056 lds
MAV 88,56,124
TR 10,7,34368
s_add_u32 s54, s99, 2424832
MAV 88,40,116
TR 12,7,33888
TR 14,7,34400
MAV 92,44,116
TR 24,7,42304
MAV 92,60,124
buffer_load_dwordx4 v[108:111], v4, s[16:19], s52 offen offset:1024 sc1
MAV 76,60,120
TR 26,7,42816
MAV 76,44,112
TR 28,7,42336
TR 30,7,42848
s_waitcnt vmcnt(16) lgkmcnt(8)
s_barrier
MAV 32,0,128
TR 32,6,33792
s_add_u32 m0, s55, 84480
MAV 32,16,136
buffer_load_dwordx4 v18, s[28:31], s54 offen lds
MAV 48,16,140
TR 34,6,34304
MAV 48,0,132
TR 36,6,33824
TR 38,6,34336
MAV 52,4,132
TR 48,6,42240
s_add_u32 s52, s77, 147456
MAV 52,20,140
buffer_load_dwordx4 v[112:115], v4, s[16:19], s52 offen sc1
MAV 36,20,136
TR 50,6,42752
MAV 36,4,128
TR 52,6,42272
TR 54,6,42784
s_waitcnt lgkmcnt(8)
MAV 40,8,128
TR 40,6,33856
MAV 40,24,136
buffer_load_dwordx4 v19, s[28:31], s54 offen offset:1056 lds
MAV 56,24,140
TR 42,6,34368
s_add_u32 s54, s99, 2686976
MAV 56,8,132
TR 44,6,33888
TR 46,6,34400
MAV 60,12,132
TR 56,6,42304
MAV 60,28,140
buffer_load_dwordx4 v[116:119], v4, s[16:19], s52 offen offset:1024 sc1
MAV 44,28,136
TR 58,6,42816
MAV 44,12,128
TR 60,6,42336
TR 62,6,42848
s_waitcnt lgkmcnt(8)
MAV 64,32,128
TR 0,7,50688
s_add_u32 m0, s55, 92928
MAV 64,48,136
buffer_load_dwordx4 v18, s[28:31], s54 offen lds
MAV 80,48,140
TR 2,7,51200
MAV 80,32,132
TR 4,7,50720
TR 6,7,51232
MAV 84,36,132
TR 16,7,59136
s_add_u32 s52, s77, 212992
MAV 84,52,140
buffer_load_dwordx4 v[120:123], v4, s[16:19], s52 offen sc1
MAV 68,52,136
TR 18,7,59648
MAV 68,36,128
TR 20,7,59168
TR 22,7,59680
s_waitcnt lgkmcnt(8)
MAV 72,40,128
TR 8,7,50752
MAV 72,56,136
buffer_load_dwordx4 v19, s[28:31], s54 offen offset:1056 lds
MAV 88,56,140
TR 10,7,51264
s_add_u32 s54, s100, 2883584
MAV 88,40,132
TR 12,7,50784
TR 14,7,51296
MAV 92,44,132
TR 24,7,59200
MAV 92,60,140
buffer_load_dwordx4 v[124:127], v4, s[16:19], s52 offen offset:1024 sc1
MAV 76,60,136
TR 26,7,59712
MAV 76,44,128
TR 28,7,59232
TR 30,7,59744
s_waitcnt vmcnt(16) lgkmcnt(8)
s_barrier
MAV 32,0,144
TR 32,6,50688
s_add_u32 m0, s55, 101376
MAV 32,16,152
buffer_load_dwordx4 v18, s[28:31], s54 offen lds
MAV 48,16,156
TR 34,6,51200
MAV 48,0,148
TR 36,6,50720
TR 38,6,51232
MAV 52,4,148
TR 48,6,59136
s_add_u32 s52, s78, 262144
MAV 52,20,156
buffer_load_dwordx4 v[128:131], v4, s[16:19], s52 offen sc1
MAV 36,20,152
TR 50,6,59648
MAV 36,4,144
TR 52,6,59168
TR 54,6,59680
s_waitcnt lgkmcnt(8)
MAV 40,8,144
TR 40,6,50752
MAV 40,24,152
buffer_load_dwordx4 v19, s[28:31], s54 offen offset:1056 lds
MAV 56,24,156
TR 42,6,51264
s_add_u32 s54, s100, 3145728
MAV 56,8,148
TR 44,6,50784
TR 46,6,51296
MAV 60,12,148
TR 56,6,59200
MAV 60,28,156
buffer_load_dwordx4 v[132:135], v4, s[16:19], s52 offen offset:1024 sc1
MAV 44,28,152
TR 58,6,59712
MAV 44,12,144
TR 60,6,59232
TR 62,6,59744
v_add_u32 v7, s57, v7
v_add_u32 v6, s57, v6
s_sub_u32 s57, 0, s57
s_waitcnt lgkmcnt(8)
MAV 64,32,144
ds_read_b64_tr_b16 a[0:1], v7
s_add_u32 m0, s55, 109824
MAV 64,48,152
buffer_load_dwordx4 v18, s[28:31], s54 offen lds
MAV 80,48,156
TR 2,7,512
MAV 80,32,148
TR 4,7,32
TR 6,7,544
MAV 84,36,148
TR 16,7,8448
s_add_u32 s52, s78, 327680
MAV 84,52,156
buffer_load_dwordx4 v[136:139], v4, s[16:19], s52 offen sc1
MAV 68,52,152
TR 18,7,8960
MAV 68,36,144
TR 20,7,8480
TR 22,7,8992
s_waitcnt lgkmcnt(8)
MAV 72,40,144
TR 8,7,64
MAV 72,56,152
buffer_load_dwordx4 v19, s[28:31], s54 offen offset:1056 lds
MAV 88,56,156
TR 10,7,576
s_add_u32 s54, s101, 3342336
MAV 88,40,148
TR 12,7,96
TR 14,7,608
MAV 92,44,148
TR 24,7,8512
MAV 92,60,156
buffer_load_dwordx4 v[140:143], v4, s[16:19], s52 offen offset:1024 sc1
MAV 76,60,152
TR 26,7,9024
MAV 76,44,144
TR 28,7,8544
TR 30,7,9056
s_waitcnt vmcnt(16) lgkmcnt(8)
s_barrier
MAV 32,0,96
ds_read_b64_tr_b16 a[32:33], v6
s_add_u32 m0, s55, 118272
MAV 32,16,104
buffer_load_dwordx4 v18, s[28:31], s54 offen lds
MAV 48,16,108
TR 34,6,512
MAV 48,0,100
TR 36,6,32
TR 38,6,544
MAV 52,4,100
TR 48,6,8448
s_add_u32 s52, s79, 376832
MAV 52,20,108
buffer_load_dwordx4 v[144:147], v4, s[16:19], s52 offen sc1
MAV 36,20,104
TR 50,6,8960
MAV 36,4,96
TR 52,6,8480
TR 54,6,8992
s_waitcnt lgkmcnt(8)
MAV 40,8,96
TR 40,6,64
MAV 40,24,104
buffer_load_dwordx4 v19, s[28:31], s54 offen offset:1056 lds
MAV 56,24,108
TR 42,6,576
s_add_u32 s54, s101, 3604480
MAV 56,8,100
TR 44,6,96
TR 46,6,608
MAV 60,12,100
TR 56,6,8512
MAV 60,28,108
buffer_load_dwordx4 v[148:151], v4, s[16:19], s52 offen offset:1024 sc1
MAV 44,28,104
TR 58,6,9024
MAV 44,12,96
TR 60,6,8544
TR 62,6,9056
s_waitcnt lgkmcnt(8)
MAV 64,32,96
TR 0,7,16896
s_add_u32 m0, s55, 126720
MAV 64,48,104
buffer_load_dwordx4 v18, s[28:31], s54 offen lds
MAV 80,48,108
TR 2,7,17408
MAV 80,32,100
TR 4,7,16928
TR 6,7,17440
MAV 84,36,100
TR 16,7,25344
s_add_u32 s52, s79, 442368
MAV 84,52,108
buffer_load_dwordx4 v[152:155], v4, s[16:19], s52 offen sc1
MAV 68,52,104
TR 18,7,25856
MAV 68,36,96
TR 20,7,25376
TR 22,7,25888
s_waitcnt lgkmcnt(8)
MAV 72,40,96
TR 8,7,16960
MAV 72,56,104
buffer_load_dwordx4 v19, s[28:31], s54 offen offset:1056 lds
MAV 88,56,108
TR 10,7,17472
s_add_u32 s54, s98, 196608
MAV 88,40,100
TR 12,7,16992
TR 14,7,17504
MAV 92,44,100
TR 24,7,25408
MAV 92,60,108
buffer_load_dwordx4 v[156:159], v4, s[16:19], s52 offen offset:1024 sc1
MAV 76,60,104
TR 26,7,25920
MAV 76,44,96
TR 28,7,25440
TR 30,7,25952
s_waitcnt vmcnt(16) lgkmcnt(8)
s_barrier
MAV 32,0,112
TR 32,6,16896
s_add_u32 m0, s55, 0
MAV 32,16,120
buffer_load_dwordx4 v18, s[28:31], s54 offen lds
MAV 48,16,124
TR 34,6,17408
MAV 48,0,116
TR 36,6,16928
TR 38,6,17440
MAV 52,4,116
TR 48,6,25344
s_add_u32 s52, s76, 491520
MAV 52,20,124
buffer_load_dwordx4 v[96:99], v4, s[16:19], s52 offen sc1
MAV 36,20,120
TR 50,6,25856
MAV 36,4,112
TR 52,6,25376
TR 54,6,25888
s_waitcnt lgkmcnt(8)
MAV 40,8,112
TR 40,6,16960
MAV 40,24,120
buffer_load_dwordx4 v19, s[28:31], s54 offen offset:1056 lds
MAV 56,24,124
TR 42,6,17472
s_add_u32 s54, s99, 655360
MAV 56,8,116
TR 44,6,16992
TR 46,6,17504
MAV 60,12,116
TR 56,6,25408
MAV 60,28,124
buffer_load_dwordx4 v[100:103], v4, s[16:19], s52 offen offset:1024 sc1
MAV 44,28,120
TR 58,6,25920
MAV 44,12,112
TR 60,6,25440
TR 62,6,25952
s_waitcnt lgkmcnt(8)
MAV 64,32,112
TR 0,7,33792
s_add_u32 m0, s55, 8448
MAV 64,48,120
buffer_load_dwordx4 v18, s[28:31], s54 offen lds
MAV 80,48,124
TR 2,7,34304
MAV 80,32,116
TR 4,7,33824
TR 6,7,34336
MAV 84,36,116
TR 16,7,42240
s_add_u32 s52, s76, 557056
MAV 84,52,124
buffer_load_dwordx4 v[104:107], v4, s[16:19], s52 offen sc1
MAV 68,52,120
TR 18,7,42752
MAV 68,36,112
TR 20,7,42272
TR 22,7,42784
s_waitcnt lgkmcnt(8)
MAV 72,40,112
TR 8,7,33856
MAV 72,56,120
buffer_load_dwordx4 v19, s[28:31], s54 offen offset:1056 lds
MAV 88,56,124
TR 10,7,34368
s_add_u32 s54, s100, 1114112
MAV 88,40,116
TR 12,7,33888
TR 14,7,34400
MAV 92,44,116
TR 24,7,42304
MAV 92,60,124
buffer_load_dwordx4 v[108:111], v4, s[16:19], s52 offen offset:1024 sc1
MAV 76,60,120
TR 26,7,42816
MAV 76,44,112
TR 28,7,42336
TR 30,7,42848
s_waitcnt vmcnt(16) lgkmcnt(8)
s_barrier
MAV 32,0,128
TR 32,6,33792
s_add_u32 m0, s55, 16896
MAV 32,16,136
buffer_load_dwordx4 v18, s[28:31], s54 offen lds
MAV 48,16,140
TR 34,6,34304
MAV 48,0,132
TR 36,6,33824
TR 38,6,34336
MAV 52,4,132
TR 48,6,42240
s_add_u32 s52, s77, 606208
MAV 52,20,140
buffer_load_dwordx4 v[112:115], v4, s[16:19], s52 offen sc1
MAV 36,20,136
TR 50,6,42752
MAV 36,4,128
TR 52,6,42272
TR 54,6,42784
s_waitcnt lgkmcnt(8)
MAV 40,8,128
TR 40,6,33856
MAV 40,24,136
buffer_load_dwordx4 v19, s[28:31], s54 offen offset:1056 lds
MAV 56,24,140
TR 42,6,34368
s_add_u32 s54, s101, 1572864
MAV 56,8,132
TR 44,6,33888
TR 46,6,34400
MAV 60,12,132
TR 56,6,42304
MAV 60,28,140
buffer_load_dwordx4 v[116:119], v4, s[16:19], s52 offen offset:1024 sc1
MAV 44,28,136
TR 58,6,42816
MAV 44,12,128
TR 60,6,42336
TR 62,6,42848
s_waitcnt lgkmcnt(8)
MAV 64,32,128
TR 0,7,50688
s_add_u32 m0, s55, 25344
MAV 64,48,136
buffer_load_dwordx4 v18, s[28:31], s54 offen lds
MAV 80,48,140
TR 2,7,51200
MAV 80,32,132
TR 4,7,50720
TR 6,7,51232
MAV 84,36,132
TR 16,7,59136
.Lpad39:
s_cbranch_execz .Lnopoll63r
s_add_u32 s52, s77, 671744
MAV 84,52,140
buffer_load_dwordx4 v[120:123], v4, s[16:19], s52 offen sc1
MAV 68,52,136
TR 18,7,59648
MAV 68,36,128
TR 20,7,59168
TR 22,7,59680
s_waitcnt lgkmcnt(8)
MAV 72,40,128
TR 8,7,50752
MAV 72,56,136
buffer_load_dwordx4 v19, s[28:31], s54 offen offset:1056 lds
MAV 88,56,140
TR 10,7,51264
s_add_u32 s54, s98, 2031616
MAV 88,40,132
TR 12,7,50784
TR 14,7,51296
MAV 92,44,132
TR 24,7,59200
MAV 92,60,140
buffer_load_dwordx4 v[124:127], v4, s[16:19], s52 offen offset:1024 sc1
MAV 76,60,136
TR 26,7,59712
MAV 76,44,128
TR 28,7,59232
TR 30,7,59744
s_waitcnt vmcnt(16) lgkmcnt(8)
s_barrier
MAV 32,0,144
TR 32,6,50688
s_add_u32 m0, s55, 33792
MAV 32,16,152
buffer_load_dwordx4 v18, s[28:31], s54 offen lds
MAV 48,16,156
TR 34,6,51200
MAV 48,0,148
TR 36,6,50720
TR 38,6,51232
MAV 52,4,148
TR 48,6,59136
s_add_u32 s52, s78, 720896
MAV 52,20,156
buffer_load_dwordx4 v[128:131], v4, s[16:19], s52 offen sc1
MAV 36,20,152
TR 50,6,59648
MAV 36,4,144
TR 52,6,59168
TR 54,6,59680
s_waitcnt lgkmcnt(8)
MAV 40,8,144
TR 40,6,50752
MAV 40,24,152
buffer_load_dwordx4 v19, s[28:31], s54 offen offset:1056 lds
MAV 56,24,156
TR 42,6,51264
s_add_u32 s54, s99, 2490368
MAV 56,8,148
TR 44,6,50784
TR 46,6,51296
MAV 60,12,148
TR 56,6,59200
MAV 60,28,156
buffer_load_dwordx4 v[132:135], v4, s[16:19], s52 offen offset:1024 sc1
MAV 44,28,152
TR 58,6,59712
MAV 44,12,144
TR 60,6,59232
TR 62,6,59744
v_add_u32 v7, s57, v7
v_add_u32 v6, s57, v6
s_sub_u32 s57, 0, s57
s_waitcnt lgkmcnt(8)
MAV 64,32,144
ds_read_b64_tr_b16 a[0:1], v6
s_add_u32 m0, s55, 42240
MAV 64,48,152
buffer_load_dwordx4 v18, s[28:31], s54 offen lds
MAV 80,48,156
TR 2,6,512
MAV 80,32,148
TR 4,6,32
TR 6,6,544
MAV 84,36,148
TR 16,6,8448
s_add_u32 s52, s78, 786432
MAV 84,52,156
buffer_load_dwordx4 v[136:139], v4, s[16:19], s52 offen sc1
MAV 68,52,152
TR 18,6,8960
MAV 68,36,144
TR 20,6,8480
TR 22,6,8992
s_waitcnt lgkmcnt(8)
MAV 72,40,144
TR 8,6,64
MAV 72,56,152
buffer_load_dwordx4 v19, s[28:31], s54 offen offset:1056 lds
MAV 88,56,156
TR 10,6,576
s_add_u32 s54, s100, 2949120
MAV 88,40,148
TR 12,6,96
TR 14,6,608
MAV 92,44,148
TR 24,6,8512
MAV 92,60,156
buffer_load_dwordx4 v[140:143], v4, s[16:19], s52 offen offset:1024 sc1
MAV 76,60,152
TR 26,6,9024
MAV 76,44,144
TR 28,6,8544
TR 30,6,9056
s_waitcnt vmcnt(16) lgkmcnt(8)
s_barrier
MAV 64,0,96
TR 32,6,16896
TR 34,6,17408
s_add_u32 m0, s55, 50688
MAV 64,16,104
TR 36,6,16928
buffer_load_dwordx4 v18, s[28:31], s54 offen lds
MAV 80,16,108
TR 38,6,17440
MAV 80,0,100
TR 48,6,25344
buffer_load_dwordx4 v19, s[28:31], s54 offen offset:1056 lds
MAV 84,4,100
TR 50,6,25856
s_add_u32 s54, s101, 3407872
s_add_u32 s52, s79, 835584
MAV 84,20,108
buffer_load_dwordx4 v[144:147], v4, s[16:19], s52 offen sc1
MAV 68,20,104
TR 52,6,25376
TR 54,6,25888
MAV 68,4,96
TR 40,6,16960
s_waitcnt lgkmcnt(9)
MAV 72,8,96
TR 42,6,17472
MAV 72,24,104
TR 44,6,16992
buffer_load_dwordx4 v[148:151], v4, s[16:19], s52 offen offset:1024 sc1
MAV 88,24,108
TR 46,6,17504
s_add_u32 m0, s55, 59136
MAV 88,8,100
TR 56,6,25408
buffer_load_dwordx4 v18, s[28:31], s54 offen lds
MAV 92,12,100
TR 58,6,25920
MAV 92,28,108
TR 60,6,25440
buffer_load_dwordx4 v19, s[28:31], s54 offen offset:1056 lds
MAV 76,28,104
TR 62,6,25952
s_add_u32 s52, s79, 901120
MAV 76,12,96
buffer_load_dwordx4 v[152:155], v4, s[16:19], s52 offen sc1
buffer_load_dwordx4 v[156:159], v4, s[16:19], s52 offen offset:1024 sc1
s_waitcnt vmcnt(16) lgkmcnt(8)
MAV 64,32,112
TR 0,6,33792
s_add_u32 s52, s76, 49152
s_lshl_b32 s70, s2, 10
s_lshl_b32 s62, s3, 7
MAV 64,48,120
buffer_load_dwordx4 v[160:163], v4, s[16:19], s52 offen sc1
s_add_u32 s70, s70, s62
MAV 80,48,124
TR 2,6,34304
s_add_u32 s70, s70, 31457792
MAV 80,32,116
TR 4,6,33824
TR 6,6,34336
s_xor_b32 s71, s70, 1024
MAV 84,36,116
TR 16,6,42240
v_min_u32 v12, 1, v1
MAV 84,52,124
buffer_load_dwordx4 v[164:167], v4, s[16:19], s52 offen offset:1024 sc1
v_lshlrev_b32 v12, 28, v12
MAV 68,52,120
TR 18,6,42752
v_mov_b32 v13, 1
MAV 68,36,112
TR 20,6,42272
TR 22,6,42784
v_mov_b32 v15, 0
s_waitcnt lgkmcnt(8)
MAV 72,40,112
TR 8,6,33856
s_add_u32 s52, s77, 163840
s_lshl_b32 s68, s7, 18
MAV 72,56,120
buffer_load_dwordx4 v[168:171], v4, s[16:19], s52 offen sc1
s_add_u32 s68, s68, 146800640
MAV 88,56,124
TR 10,6,34368
s_xor_b32 s69, s68, 262144
MAV 88,40,116
TR 12,6,33888
TR 14,6,34400
v_mov_b32 v11, v4
MAV 92,44,116
TR 24,6,42304
v_and_b32 v2, 1, v1
MAV 92,60,124
buffer_load_dwordx4 v[172:175], v4, s[16:19], s52 offen offset:1024 sc1
v_lshlrev_b32 v2, 4, v2
MAV 76,60,120
TR 26,6,42816
v_mov_b32 v224, 0x3f80
v_lshlrev_b32 v2, v2, v224
MAV 76,44,112
TR 28,6,42336
TR 30,6,42848
s_waitcnt vmcnt(12) lgkmcnt(8)
MAV 64,0,128
TR 32,6,50688
s_add_u32 s52, s78, 278528
v_bfe_u32 v224, v1, 2, 2
v_lshrrev_b32 v225, 4, v1
MAV 64,16,136
buffer_load_dwordx4 v[176:179], v4, s[16:19], s52 offen sc1
v_cmp_eq_u32 vcc, v224, v225
MAV 80,16,140
TR 34,6,51200
v_cndmask_b32 v2, 0, v2, vcc
MAV 80,0,132
TR 36,6,50720
TR 38,6,51232
v_and_b32 v224, 2, v1
MAV 84,4,132
TR 48,6,59136
v_cmp_eq_u32 vcc, 0, v224
MAV 84,20,140
buffer_load_dwordx4 v[180:183], v4, s[16:19], s52 offen offset:1024 sc1
v_cndmask_b32 v226, 0, v2, vcc
MAV 68,20,136
TR 50,6,59648
v_cndmask_b32 v227, v2, 0, vcc
MAV 68,4,128
TR 52,6,59168
TR 54,6,59680
v_mov_b32 v224, 0
s_waitcnt lgkmcnt(8)
MAV 72,8,128
TR 40,6,50752
s_add_u32 s52, s79, 393216
v_mov_b32 v225, 0
MAV 72,24,136
buffer_load_dwordx4 v[184:187], v4, s[16:19], s52 offen sc1
v_mov_b32 v228, 0
MAV 88,24,140
TR 42,6,51264
v_mov_b32 v229, 0
MAV 88,8,132
TR 44,6,50784
TR 46,6,51296
s_lshr_b32 s62, s6, 1
MAV 92,12,132
TR 56,6,59200
s_lshl_b32 s62, s62, 8
MAV 92,28,140
buffer_load_dwordx4 v[188:191], v4, s[16:19], s52 offen offset:1024 sc1
s_and_b32 s67, s6, 1
MAV 76,28,136
TR 58,6,59712
s_add_u32 s62, s62, s67
s_lshl_b32 s62, s62, 11
MAV 76,12,128
TR 60,6,59232
TR 62,6,59744
s_waitcnt vmcnt(8) lgkmcnt(8)
s_barrier
v_add_u32 v6, s57, v6
MAV 64,32,144
ds_read_b64_tr_b16 a[0:1], v6
s_add_u32 s52, s76, 507904
s_lshl_b32 s63, s3, 17
s_add_u32 s62, s62, s63
MAV 64,48,152
buffer_load_dwordx4 v[192:195], v4, s[16:19], s52 offen sc1
s_lshl_b32 s63, s7, 7
MAV 80,48,156
TR 2,6,512
s_add_u32 s62, s62, s63
MAV 80,32,148
TR 4,6,32
TR 6,6,544
s_mov_b32 s64, 0x8000
MAV 84,36,148
TR 16,6,8448
v_lshrrev_b32 v21, 3, v1
MAV 84,52,156
buffer_load_dwordx4 v[196:199], v4, s[16:19], s52 offen offset:1024 sc1
v_and_b32 v2, 7, v1
MAV 68,52,152
TR 18,6,8960
v_lshlrev_b32 v2, 4, v2
MAV 68,36,144
TR 20,6,8480
TR 22,6,8992
v_lshl_add_u32 v16, v21, 12, v2
s_waitcnt lgkmcnt(8)
MAV 72,40,144
TR 8,6,64
s_add_u32 s52, s77, 622592
v_add_u32 v16, s62, v16
MAV 72,56,152
buffer_load_dwordx4 v[200:203], v4, s[16:19], s52 offen sc1
v_add_u32 v17, 0x10000, v16
MAV 88,56,156
TR 10,6,576
s_mul_i32 s62, s3, 4608
MAV 88,40,148
TR 12,6,96
TR 14,6,608
s_add_u32 s62, s62, 135168
MAV 92,44,148
TR 24,6,8512
v_mul_u32_u24 v21, 144, v21
MAV 92,60,156
buffer_load_dwordx4 v[204:207], v4, s[16:19], s52 offen offset:1024 sc1
v_add3_u32 v21, v21, v2, s62
MAV 76,60,152
TR 26,6,9024
v_and_b32 v20, 15, v1
v_mul_u32_u24 v20, 144, v20
MAV 76,44,144
TR 28,6,8544
TR 30,6,9056
s_waitcnt vmcnt(8) lgkmcnt(8)
MAV 64,0,160
TR 32,6,16896
s_add_u32 s52, s78, 737280
v_lshrrev_b32 v2, 4, v1
v_lshlrev_b32 v2, 3, v2
MAV 64,16,168
buffer_load_dwordx4 v[208:211], v4, s[16:19], s52 offen sc1
v_add3_u32 v20, v20, v2, s62
MAV 80,16,172
TR 34,6,17408
v_accvgpr_read_b32 v28, a224
MAV 80,0,164
TR 36,6,16928
TR 38,6,17440
v_add_f32 v32, v32, v28
MAV 84,4,164
TR 48,6,25344
v_accvgpr_read_b32 v29, a225
MAV 84,20,172
buffer_load_dwordx4 v[212:215], v4, s[16:19], s52 offen offset:1024 sc1
v_add_f32 v33, v33, v29
MAV 68,20,168
TR 50,6,25856
v_accvgpr_read_b32 v28, a226
MAV 68,4,160
TR 52,6,25376
TR 54,6,25888
v_add_f32 v34, v34, v28
s_waitcnt lgkmcnt(8)
MAV 72,8,160
TR 40,6,16960
s_add_u32 s52, s79, 851968
v_accvgpr_read_b32 v29, a227
MAV 72,24,168
buffer_load_dwordx4 v[216:219], v4, s[16:19], s52 offen sc1
v_add_f32 v35, v35, v29
MAV 88,24,172
TR 42,6,17472
v_accvgpr_read_b32 v28, a228
MAV 88,8,164
TR 44,6,16992
TR 46,6,17504
v_add_f32 v36, v36, v28
MAV 92,12,164
TR 56,6,25408
v_accvgpr_read_b32 v29, a229
MAV 92,28,172
buffer_load_dwordx4 v[220:223], v4, s[16:19], s52 offen offset:1024 sc1
v_add_f32 v37, v37, v29
MAV 76,28,168
TR 58,6,25920
v_accvgpr_read_b32 v28, a230
v_add_f32 v38, v38, v28
MAV 76,12,160
TR 60,6,25440
TR 62,6,25952
s_waitcnt vmcnt(8) lgkmcnt(8)
MAV 64,32,176
TR 0,6,33792
v_accvgpr_read_b32 v29, a231
MAV 64,48,184
TR 2,6,34304
v_add_f32 v39, v39, v29
v_accvgpr_read_b32 v28, a232
MAV 80,48,188
TR 4,6,33824
MAV 80,32,180
TR 6,6,34336
v_add_f32 v40, v40, v28
v_accvgpr_read_b32 v29, a233
MAV 84,36,180
TR 16,6,42240
v_add_f32 v41, v41, v29
MAV 84,52,188
TR 18,6,42752
v_accvgpr_read_b32 v28, a234
MAV 68,52,184
TR 20,6,42272
v_add_f32 v42, v42, v28
MAV 68,36,176
TR 22,6,42784
v_accvgpr_read_b32 v29, a235
s_waitcnt lgkmcnt(8)
MAV 72,40,176
TR 8,6,33856
MAV 72,56,184
TR 10,6,34368
v_add_f32 v43, v43, v29
v_accvgpr_read_b32 v28, a236
MAV 88,56,188
TR 12,6,33888
v_add_f32 v44, v44, v28
MAV 88,40,180
TR 14,6,34400
v_accvgpr_read_b32 v29, a237
MAV 92,44,180
TR 24,6,42304
v_add_f32 v45, v45, v29
MAV 92,60,188
TR 26,6,42816
v_accvgpr_read_b32 v28, a238
MAV 76,60,184
TR 28,6,42336
v_add_f32 v46, v46, v28
MAV 76,44,176
TR 30,6,42848
v_accvgpr_read_b32 v29, a239
s_waitcnt vmcnt(4) lgkmcnt(8)
MAV 64,0,192
TR 32,6,50688
v_add_f32 v47, v47, v29
MAV 64,16,200
TR 34,6,51200
v_accvgpr_read_b32 v28, a240
v_add_f32 v48, v48, v28
MAV 80,16,204
TR 36,6,50720
MAV 80,0,196
TR 38,6,51232
v_accvgpr_read_b32 v29, a241
v_add_f32 v49, v49, v29
MAV 84,4,196
TR 48,6,59136
v_accvgpr_read_b32 v28, a242
MAV 84,20,204
TR 50,6,59648
v_add_f32 v50, v50, v28
MAV 68,20,200
TR 52,6,59168
v_accvgpr_read_b32 v29, a243
MAV 68,4,192
TR 54,6,59680
v_add_f32 v51, v51, v29
s_waitcnt lgkmcnt(8)
MAV 72,8,192
TR 40,6,50752
MAV 72,24,200
TR 42,6,51264
v_accvgpr_read_b32 v28, a244
v_add_f32 v52, v52, v28
MAV 88,24,204
TR 44,6,50784
v_accvgpr_read_b32 v29, a245
MAV 88,8,196
TR 46,6,51296
v_add_f32 v53, v53, v29
MAV 92,12,196
TR 56,6,59200
v_accvgpr_read_b32 v28, a246
MAV 92,28,204
TR 58,6,59712
v_add_f32 v54, v54, v28
MAV 76,28,200
TR 60,6,59232
v_accvgpr_read_b32 v29, a247
MAV 76,12,192
TR 62,6,59744
v_add_f32 v55, v55, v29
s_waitcnt vmcnt(0) lgkmcnt(8)
MAV 64,32,208
ds_read_b64_tr_b16 a[0:1], v7
v_accvgpr_read_b32 v28, a248
MAV 64,48,216
TR 2,7,512
v_add_f32 v56, v56, v28
v_accvgpr_read_b32 v29, a249
MAV 80,48,220
TR 4,7,32
MAV 80,32,212
TR 6,7,544
v_add_f32 v57, v57, v29
v_accvgpr_read_b32 v28, a250
MAV 84,36,212
TR 16,7,8448
MAV 84,52,220
TR 18,7,8960
v_add_f32 v58, v58, v28
v_accvgpr_read_b32 v29, a251
MAV 68,52,216
TR 20,7,8480
MAV 68,36,208
TR 22,7,8992
v_add_f32 v59, v59, v29
s_waitcnt lgkmcnt(8)
MAV 72,40,208
TR 8,7,64
v_accvgpr_read_b32 v28, a252
MAV 72,56,216
TR 10,7,576
v_add_f32 v60, v60, v28
MAV 88,56,220
TR 12,7,96
v_accvgpr_read_b32 v29, a253
MAV 88,40,212
TR 14,7,608
v_add_f32 v61, v61, v29
MAV 92,44,212
TR 24,7,8512
v_accvgpr_read_b32 v28, a254
MAV 92,60,220
TR 26,7,9024
v_add_f32 v62, v62, v28
MAV 76,60,216
TR 28,7,8544
v_accvgpr_read_b32 v29, a255
MAV 76,44,208
TR 30,7,9056
v_add_f32 v63, v63, v29
s_waitcnt lgkmcnt(8)
MAV 32,0,96
TR 32,7,16896
v_cvt_pk_bf16_f32 v232, v64, v65
MAV 32,16,104
TR 34,7,17408
v_cvt_pk_bf16_f32 v233, v66, v67
v_cvt_pk_bf16_f32 v234, v68, v69
MAV 48,16,108
TR 36,7,16928
v_cvt_pk_bf16_f32 v235, v70, v71
MAV 48,0,100
TR 38,7,17440
buffer_store_dwordx4 v[232:235], v11, s[16:19], s69 offen sc1
s_add_u32 s69, s69, 131072
MAV 52,4,100
TR 48,7,25344
.Lpad40:
s_cbranch_execz .Lnopoll63r
v_cvt_pk_bf16_f32 v236, v72, v73
MAV 52,20,108
TR 50,7,25856
v_cvt_pk_bf16_f32 v237, v74, v75
v_cvt_pk_bf16_f32 v238, v76, v77
MAV 36,20,104
TR 52,7,25376
v_cvt_pk_bf16_f32 v239, v78, v79
MAV 36,4,96
TR 54,7,25888
buffer_store_dwordx4 v[236:239], v11, s[16:19], s69 offen sc1
s_waitcnt lgkmcnt(8)
MAV 40,8,96
TR 40,7,16960
s_add_u32 s69, s69, -130048
MAV 40,24,104
TR 42,7,17472
v_cvt_pk_bf16_f32 v240, v80, v81
v_cvt_pk_bf16_f32 v241, v82, v83
MAV 56,24,108
TR 44,7,16992
v_cvt_pk_bf16_f32 v242, v84, v85
MAV 56,8,100
TR 46,7,17504
v_cvt_pk_bf16_f32 v243, v86, v87
buffer_store_dwordx4 v[240:243], v11, s[16:19], s69 offen sc1
MAV 60,12,100
TR 56,7,25408
s_add_u32 s69, s69, 131072
MAV 60,28,108
TR 58,7,25920
v_cvt_pk_bf16_f32 v244, v88, v89
v_cvt_pk_bf16_f32 v245, v90, v91
MAV 44,28,104
TR 60,7,25440
v_cvt_pk_bf16_f32 v246, v92, v93
MAV 44,12,96
TR 62,7,25952
v_cvt_pk_bf16_f32 v247, v94, v95
buffer_store_dwordx4 v[244:247], v11, s[16:19], s69 offen sc1
s_waitcnt lgkmcnt(8)
MAV 32,32,112
TR 0,7,33792
MAV 32,48,120
TR 2,7,34304
MAV 48,48,124
TR 4,7,33824
MAV 48,32,116
TR 6,7,34336
MAV 52,36,116
TR 16,7,42240
MAV 52,52,124
TR 18,7,42752
MAV 36,52,120
TR 20,7,42272
MAV 36,36,112
TR 22,7,42784
s_waitcnt lgkmcnt(8)
MAV 40,40,112
TR 8,7,33856
MAV 40,56,120
TR 10,7,34368
MAV 56,56,124
TR 12,7,33888
MAV 56,40,116
TR 14,7,34400
MAV 60,44,116
TR 24,7,42304
MAV 60,60,124
TR 26,7,42816
MAV 44,60,120
TR 28,7,42336
MAV 44,44,112
TR 30,7,42848
s_waitcnt lgkmcnt(8)
MAV 32,0,128
TR 32,7,50688
MAV 32,16,136
TR 34,7,51200
MAV 48,16,140
TR 36,7,50720
MAV 48,0,132
TR 38,7,51232
MAV 52,4,132
TR 48,7,59136
MAV 52,20,140
TR 50,7,59648
MAV 36,20,136
TR 52,7,59168
MAV 36,4,128
TR 54,7,59680
s_waitcnt lgkmcnt(8)
MAV 40,8,128
TR 40,7,50752
MAV 40,24,136
TR 42,7,51264
MAV 56,24,140
TR 44,7,50784
MAV 56,8,132
TR 46,7,51296
MAV 60,12,132
TR 56,7,59200
MAV 60,28,140
TR 58,7,59712
MAV 44,28,136
TR 60,7,59232
MAV 44,12,128
TR 62,7,59744
v_add_u32 v7, s57, v7
s_waitcnt lgkmcnt(8)
MAV 32,32,144
ds_read_b64_tr_b16 a[0:1], v7
MAV 32,48,152
s_waitcnt vmcnt(0)
buffer_atomic_add v13, v12, s[16:19], s71 offen
MAV 48,48,156
TR 2,7,512
MAV 48,32,148
TR 4,7,32
TR 6,7,544
MAV 52,36,148
MAV 52,52,156
TR 16,7,8448
TR 18,7,8960
MAV 36,52,152
TR 20,7,8480
MAV 36,36,144
s_waitcnt lgkmcnt(7)
MAV 40,40,144
TR 22,7,8992
MAV 40,56,152
TR 8,7,64
TR 10,7,576
MAV 56,56,156
MAV 56,40,148
TR 12,7,96
TR 14,7,608
MAV 60,44,148
TR 24,7,8512
MAV 60,60,156
TR 26,7,9024
MAV 44,60,152
TR 28,7,8544
MAV 44,44,144
TR 30,7,9056
s_waitcnt lgkmcnt(8)
MAV 32,0,160
TR 32,7,16896
MAV 32,16,168
buffer_atomic_add v15, v12, s[16:19], s70 offen sc0
MAV 48,16,172
TR 34,7,17408
MAV 48,0,164
TR 36,7,16928
TR 38,7,17440
MAV 52,4,164
MAV 52,20,172
TR 48,7,25344
TR 50,7,25856
MAV 36,20,168
TR 52,7,25376
MAV 36,4,160
s_waitcnt lgkmcnt(7)
MAV 40,8,160
TR 54,7,25888
MAV 40,24,168
TR 40,7,16960
TR 42,7,17472
MAV 56,24,172
MAV 56,8,164
TR 44,7,16992
TR 46,7,17504
MAV 60,12,164
TR 56,7,25408
MAV 60,28,172
TR 58,7,25920
MAV 44,28,168
TR 60,7,25440
MAV 44,12,160
TR 62,7,25952
s_waitcnt lgkmcnt(8)
MAV 32,32,176
TR 0,7,33792
MAV 32,48,184
TR 2,7,34304
MAV 48,48,188
TR 4,7,33824
MAV 48,32,180
TR 6,7,34336
MAV 52,36,180
TR 16,7,42240
MAV 52,52,188
TR 18,7,42752
MAV 36,52,184
TR 20,7,42272
MAV 36,36,176
TR 22,7,42784
s_waitcnt lgkmcnt(8)
MAV 40,40,176
TR 8,7,33856
MAV 40,56,184
TR 10,7,34368
MAV 56,56,188
TR 12,7,33888
MAV 56,40,180
TR 14,7,34400
MAV 60,44,180
TR 24,7,42304
MAV 60,60,188
TR 26,7,42816
MAV 44,60,184
TR 28,7,42336
MAV 44,44,176
TR 30,7,42848
s_waitcnt vmcnt(0)
v_cmp_ne_u32 vcc, 0, v15
s_nop 0
s_cbranch_vccz .Lxs68
.Lxs68b:
s_waitcnt lgkmcnt(8)
MAV 32,0,192
TR 32,7,50688
MAV 32,16,200
buffer_load_dwordx4 v[232:235], v11, s[16:19], s68 offen sc1
MAV 48,16,204
TR 34,7,51200
s_add_u32 s68, s68, 131072
MAV 48,0,196
TR 36,7,50720
TR 38,7,51232
MAV 52,4,196
TR 48,7,59136
MAV 52,20,204
buffer_load_dwordx4 v[236:239], v11, s[16:19], s68 offen sc1
MAV 36,20,200
TR 50,7,59648
s_add_u32 s68, s68, -130048
MAV 36,4,192
TR 52,7,59168
TR 54,7,59680
s_waitcnt lgkmcnt(8)
MAV 40,8,192
TR 40,7,50752
MAV 40,24,200
buffer_load_dwordx4 v[240:243], v11, s[16:19], s68 offen sc1
MAV 56,24,204
TR 42,7,51264
s_add_u32 s68, s68, 131072
MAV 56,8,196
TR 44,7,50784
TR 46,7,51296
MAV 60,12,196
TR 56,7,59200
MAV 60,28,204
buffer_load_dwordx4 v[244:247], v11, s[16:19], s68 offen sc1
MAV 44,28,200
TR 58,7,59712
MAV 44,12,192
TR 60,7,59232
TR 62,7,59744
s_waitcnt lgkmcnt(8)
MAV 32,32,208
MAV 32,48,216
MAV 48,48,220
MAV 48,32,212
MAV 52,36,212
MAV 52,52,220
MAV 36,52,216
MAV 36,36,208
s_waitcnt lgkmcnt(0)
MAV 40,40,208
MAV 40,56,216
MAV 56,56,220
MAV 56,40,212
MAV 60,44,212
MAV 60,60,220
MAV 44,60,216
MAV 44,44,208
s_waitcnt vmcnt(3)
v_mfma_f32_16x16x32_bf16 v[32:35], v[226:229], v[232:235], v[32:35]
v_mfma_f32_16x16x32_bf16 v[36:39], v[224:227], v[232:235], v[36:39]
s_waitcnt vmcnt(2)
v_mfma_f32_16x16x32_bf16 v[40:43], v[226:229], v[236:239], v[40:43]
v_mfma_f32_16x16x32_bf16 v[44:47], v[224:227], v[236:239], v[44:47]
s_waitcnt vmcnt(1)
v_mfma_f32_16x16x32_bf16 v[48:51], v[226:229], v[240:243], v[48:51]
v_mfma_f32_16x16x32_bf16 v[52:55], v[224:227], v[240:243], v[52:55]
s_waitcnt vmcnt(0)
v_mfma_f32_16x16x32_bf16 v[56:59], v[226:229], v[244:247], v[56:59]
v_cvt_pk_bf16_f32 v128, v32, v33
v_mfma_f32_16x16x32_bf16 v[60:63], v[224:227], v[244:247], v[60:63]
v_cvt_pk_bf16_f32 v129, v34, v35
ds_write_b64 v20, v[128:129]
v_cvt_pk_bf16_f32 v130, v36, v37
v_cvt_pk_bf16_f32 v131, v38, v39
ds_write_b64 v20, v[130:131] offset:32
v_cvt_pk_bf16_f32 v132, v40, v41
v_cvt_pk_bf16_f32 v133, v42, v43
ds_write_b64 v20, v[132:133] offset:64
v_cvt_pk_bf16_f32 v134, v44, v45
v_cvt_pk_bf16_f32 v135, v46, v47
ds_write_b64 v20, v[134:135] offset:96
ds_read_b128 v[144:147], v21
ds_read_b128 v[148:151], v21 offset:1152
v_cvt_pk_bf16_f32 v136, v48, v49
v_cvt_pk_bf16_f32 v137, v50, v51
ds_write_b64 v20, v[136:137] offset:2304
v_cvt_pk_bf16_f32 v138, v52, v53
v_cvt_pk_bf16_f32 v139, v54, v55
ds_write_b64 v20, v[138:139] offset:2336
v_cvt_pk_bf16_f32 v140, v56, v57
v_cvt_pk_bf16_f32 v141, v58, v59
ds_write_b64 v20, v[140:141] offset:2368
v_cvt_pk_bf16_f32 v142, v60, v61
v_cvt_pk_bf16_f32 v143, v62, v63
ds_write_b64 v20, v[142:143] offset:2400
ds_read_b128 v[152:155], v21 offset:2304
ds_read_b128 v[156:159], v21 offset:3456
s_waitcnt lgkmcnt(7)
buffer_store_dwordx4 v[144:147], v16, s[36:39], 0 offen sc1
s_waitcnt lgkmcnt(6)
buffer_store_dwordx4 v[148:151], v16, s[36:39], s64 offen sc1
s_waitcnt lgkmcnt(1)
buffer_store_dwordx4 v[152:155], v17, s[36:39], 0 offen sc1
s_waitcnt lgkmcnt(0)
buffer_store_dwordx4 v[156:159], v17, s[36:39], s64 offen sc1
s_nop 1
.Lend:
s_endpgm
.Lsp67:
s_mov_b32 s15, 0
.Lsp67l:
v_mov_b32 v25, 0
buffer_atomic_add v25, v22, s[16:19], s73 offen sc0
s_add_u32 s15, s15, 1
s_cmp_gt_u32 s15, 100000
s_waitcnt vmcnt(0)
s_cbranch_scc1 .Lsp67b
v_cmp_gt_u32 vcc, v23, v25
s_nop 0
s_cbranch_vccnz .Lsp67l
s_branch .Lsp67b
.Lxs68:
s_mov_b32 s15, 0
.Lxs68l:
v_mov_b32 v15, 0
buffer_atomic_add v15, v12, s[16:19], s70 offen sc0
s_add_u32 s15, s15, 1
s_cmp_gt_u32 s15, 100000
s_waitcnt vmcnt(0)
s_cbranch_scc1 .Lxs68b
v_cmp_ne_u32 vcc, 0, v15
s_nop 0
s_cbranch_vccz .Lxs68l
s_branch .Lxs68b
.section .rodata,"a"
.p2align 6
.amdhsa_kernel interleave_layers__sliding_local_dilated__swiglu_ffn__prompt_kernel
  .amdhsa_next_free_vgpr 512
  .amdhsa_next_free_sgpr 102
  .amdhsa_accum_offset 256
  .amdhsa_group_segment_fixed_size 0
  .amdhsa_kernarg_size 80
  .amdhsa_user_sgpr_count 2
  .amdhsa_user_sgpr_kernarg_segment_ptr 1
  .amdhsa_system_sgpr_workgroup_id_x 1
  .amdhsa_float_denorm_mode_32 3
.end_amdhsa_kernel
```

```asm
; @launch grid=(256,1,1) block=(256,1,1) lds=162560
.amdgcn_target "amdgcn-amd-amdhsa--gfx950"
.macro MAA d,a,b
v_mfma_f32_16x16x32_bf16 v[\d:\d+3], a[\a:\a+3], a[\b:\b+3], v[\d:\d+3]
.endm
.macro MAV d,a,b
v_mfma_f32_16x16x32_bf16 v[\d:\d+3], a[\a:\a+3], v[\b:\b+3], v[\d:\d+3]
.endm
.macro TR d,v,o
ds_read_b64_tr_b16 a[\d:\d+1], v\v offset:\o
.endm
.macro RD d,v,o
ds_read_b128 a[\d:\d+3], v\v offset:\o
.endm
.text
.globl interleave_layers__sliding_local_dilated__swiglu_ffn__prompt_kernel
.p2align 8
.type interleave_layers__sliding_local_dilated__swiglu_ffn__prompt_kernel,@function
interleave_layers__sliding_local_dilated__swiglu_ffn__prompt_kernel:
s_load_dwordx4 s[68:71], s[0:1], 0
s_load_dwordx2 s[72:73], s[0:1], 16
s_load_dwordx8 s[76:83], s[0:1], 32
s_load_dwordx4 s[84:87], s[0:1], 64
s_cmp_lt_u32 s2, 256
s_cbranch_scc1 .Lgo
s_endpgm
.p2align 12
.Lgo:
v_lshrrev_b32 v2, 6, v0
v_and_b32 v1, 63, v0
v_readfirstlane_b32 s3, v2
s_and_b32 s4, s2, 7
s_lshr_b32 s5, s2, 3
s_lshr_b32 s8, s4, 2
s_lshl_b32 s8, s8, 3
s_and_b32 s62, s5, 7
s_add_u32 s8, s8, s62
s_and_b32 s9, s4, 3
s_lshl_b32 s9, s9, 2
s_lshr_b32 s62, s5, 3
s_add_u32 s9, s9, s62
s_and_b32 s48, s3, 1
s_lshr_b32 s49, s3, 1
s_lshl_b32 s50, s8, 3
s_sub_u32 s50, s50, 9
s_cmp_lt_u32 s8, 2
s_cselect_b32 s50, 7, s50
s_lshr_b32 s6, s4, 1
s_lshl_b32 s6, s6, 2
s_and_b32 s62, s5, 3
s_add_u32 s6, s6, s62
s_and_b32 s7, s4, 1
s_lshr_b32 s62, s5, 2
s_lshl_b32 s62, s62, 1
s_add_u32 s7, s7, s62
s_lshr_b32 s62, s6, 1
s_lshl_b32 s62, s62, 8
s_and_b32 s63, s6, 1
s_add_u32 s62, s62, s63
s_lshl_b32 s63, s3, 6
s_add_u32 s62, s62, s63
s_lshl_b32 s62, s62, 11
s_lshl_b32 s63, s7, 7
s_add_u32 s62, s62, s63
v_and_b32 v228, 15, v1
v_lshlrev_b32 v228, 12, v228
v_bfe_u32 v2, v1, 4, 1
v_lshl_add_u32 v228, v2, 5, v228
v_bfe_u32 v2, v1, 5, 1
v_lshl_add_u32 v228, v2, 4, v228
v_add_u32 v228, s62, v228
v_add_u32 v229, 0x10000, v228
s_sub_u32 s64, s3, 1
s_max_i32 s64, s64, 0
s_lshl_b32 s64, s64, 11
s_lshl_b32 s66, s9, 7
s_add_u32 s66, s66, s64
s_cmp_eq_u32 s3, 1
s_cselect_b32 s66, 8388608, s66
s_mul_i32 s65, s8, 122880
s_add_u32 s65, s65, s66
v_lshrrev_b32 v9, 1, v1
v_min_u32 v9, 19, v9
v_mul_u32_u24 v9, 6144, v9
s_xor_b32 s14, s3, 3
s_lshl_b32 s14, s14, 8
s_add_u32 s14, s14, s2
v_lshlrev_b32 v230, 4, v1
v_mov_b64 v[224:225], 0
v_mov_b64 v[226:227], 0
s_waitcnt lgkmcnt(0)
s_mov_b32 s16, s86
s_mov_b32 s17, s87
s_mov_b32 s18, 268435456
s_mov_b32 s19, 0x20000
s_mov_b32 s36, s68
s_mov_b32 s37, s69
s_mov_b32 s38, 4194304
s_mov_b32 s39, 0x20000
s_cmp_ge_u32 s14, 16
s_cbranch_scc1 .Lz3
s_lshl_b32 s62, s2, 13
s_add_u32 s62, s62, 30408704
s_add_u32 s63, s62, 4096
buffer_store_dwordx4 v[224:227], v230, s[16:19], s62 offen sc1
buffer_store_dwordx4 v[224:227], v230, s[16:19], s62 offen offset:1024 sc1
buffer_store_dwordx4 v[224:227], v230, s[16:19], s62 offen offset:2048 sc1
buffer_store_dwordx4 v[224:227], v230, s[16:19], s62 offen offset:3072 sc1
buffer_store_dwordx4 v[224:227], v230, s[16:19], s63 offen sc1
buffer_store_dwordx4 v[224:227], v230, s[16:19], s63 offen offset:1024 sc1
buffer_store_dwordx4 v[224:227], v230, s[16:19], s63 offen offset:2048 sc1
buffer_store_dwordx4 v[224:227], v230, s[16:19], s63 offen offset:3072 sc1
.Lz3:
buffer_load_dwordx4 v[164:167], v228, s[36:39], 0 offen
buffer_load_dwordx4 v[168:171], v228, s[36:39], 0 offen offset:64
buffer_load_dwordx4 v[172:175], v229, s[36:39], 0 offen
buffer_load_dwordx4 v[176:179], v229, s[36:39], 0 offen offset:64
s_mov_b32 s20, s70
s_mov_b32 s21, s71
s_mov_b32 s22, 6291456
s_mov_b32 s23, 0x20000
buffer_load_dword v58, v9, s[20:23], s65 offen
s_mov_b32 s40, s84
s_mov_b32 s41, s85
s_mov_b32 s42, 256
s_mov_b32 s43, 0x20000
s_getpc_b64 s[62:63]
.Lpc:
s_lshl_b32 s64, s5, 12
v_lshrrev_b32 v59, 3, v0
v_lshl_add_u32 v59, v59, 7, s64
v_add_u32 v2, 0x20000, v59
v_min_u32 v2, .Lend-.Lpc, v2
v_min_u32 v59, .Lend-.Lpc, v59
global_load_dword v59, v59, s[62:63]
global_load_dword v58, v2, s[62:63]
s_mov_b32 s24, s72
s_mov_b32 s25, s73
s_mov_b32 s26, 2097152
s_mov_b32 s27, 0x20000
s_mov_b32 s28, s80
s_mov_b32 s29, s81
s_mov_b32 s30, 7340032
s_mov_b32 s31, 0x20000
s_mov_b32 s0, s82
s_mov_b32 s1, s83
s_mov_b32 s32, s76
s_mov_b32 s33, s77
s_mov_b32 s34, 7340032
s_mov_b32 s35, 0x20000
s_mov_b32 s80, s78
s_mov_b32 s81, s79
s_mov_b32 s82, 7340032
s_mov_b32 s83, 0x20000
s_lshr_b32 s10, s4, 2
s_lshl_b32 s10, s10, 2
s_and_b32 s62, s5, 3
s_add_u32 s10, s10, s62
s_and_b32 s11, s4, 3
s_lshl_b32 s11, s11, 3
s_lshr_b32 s62, s5, 2
s_add_u32 s11, s11, s62
s_and_b32 s12, s11, 1
s_lshr_b32 s13, s11, 1
s_mul_i32 s51, s13, 448
s_mul_i32 s62, s12, 192
s_add_u32 s51, s51, s62
s_lshl_b32 s62, s6, 3
s_lshr_b32 s84, s62, 4
s_lshl_b32 s84, s84, 14
s_and_b32 s62, s62, 15
s_lshl_b32 s62, s62, 10
s_add_u32 s84, s84, s62
s_lshl_b32 s62, s8, 3
s_lshr_b32 s85, s62, 4
s_lshl_b32 s85, s85, 14
s_and_b32 s62, s62, 15
s_lshl_b32 s62, s62, 10
s_add_u32 s85, s85, s62
s_lshl_b32 s62, s50, 0
s_lshr_b32 s86, s62, 4
s_lshl_b32 s86, s86, 14
s_and_b32 s62, s62, 15
s_lshl_b32 s62, s62, 10
s_add_u32 s86, s86, s62
s_mul_i32 s62, s8, 393216
s_add_u32 s62, s62, s66
v_mul_u32_u24 v14, 6144, v1
v_add_u32 v14, s62, v14
s_lshl_b32 s62, s8, 4
s_add_u32 s62, s62, s9
s_lshl_b32 s62, s62, 2
s_add_u32 s62, s62, s3
s_mul_i32 s62, s62, 6656
v_min_u32 v15, 51, v1
v_lshl_add_u32 v15, v15, 7, s62
s_sub_u32 s63, s8, 4
s_lshl_b32 s64, s8, 1
s_add_u32 s64, s64, 1
s_cmp_lt_u32 s8, 5
s_cselect_b64 vcc, -1, 0
s_cselect_b32 s46, s64, s63
v_cndmask_b32 v14, v14, v15, vcc
s_lshl_b32 s62, s2, 1
s_add_u32 s62, s62, s48
s_mul_i32 s62, s62, 5376
v_min_u32 v16, 41, v1
v_lshl_add_u32 v16, v16, 7, s62
s_cmp_lt_u32 s46, 6
s_cselect_b64 vcc, -1, 0
v_cndmask_b32 v15, v14, v16, vcc
v_cndmask_b32 v14, v16, v14, vcc
s_cmp_lt_u32 s3, 2
s_cselect_b32 s65, s32, s80
s_cselect_b32 s66, s33, s81
s_cselect_b32 s67, s34, s82
s_cmp_lt_u32 s8, 5
s_cselect_b32 s62, s24, s20
s_cselect_b32 s63, s25, s21
s_cselect_b32 s64, s26, s22
s_sub_u32 s47, s46, 6
s_cmp_lt_u32 s46, 6
s_cselect_b32 s47, s46, s47
s_cselect_b32 s76, s62, s65
s_cselect_b32 s98, s65, s62
s_cselect_b32 s77, s63, s66
s_cselect_b32 s99, s66, s63
s_cselect_b32 s78, s64, s67
s_cselect_b32 s100, s67, s64
s_mov_b32 s79, 0x20000
v_bfe_u32 v18, v1, 3, 1
v_bfe_u32 v2, v1, 5, 1
v_lshl_add_u32 v18, v2, 2, v18
v_and_b32 v2, 16, v1
v_add_u32 v18, v18, v2
s_lshl_b32 s62, s49, 2
s_add_u32 s62, s62, s48
s_lshl_b32 s62, s62, 1
v_add_u32 v18, s62, v18
v_mul_u32_u24 v18, 6144, v18
v_and_b32 v2, 7, v1
v_lshl_add_u32 v18, v2, 4, v18
s_lshl_b32 s62, s9, 7
v_add_u32 v18, s62, v18
v_add_u32 v19, 1024, v18
v_add_u32 v20, 2048, v18
s_mul_i32 s59, s3, 3104
s_mov_b32 s58, 0
s_lshr_b32 s62, s8, 1
s_lshl_b32 s62, s62, 8
s_and_b32 s67, s8, 1
s_add_u32 s62, s62, s67
s_lshl_b32 s62, s62, 11
s_lshl_b32 s63, s3, 17
s_add_u32 s62, s62, s63
v_lshrrev_b32 v2, 4, v1
v_xor_b32 v2, v2, v1
v_and_b32 v2, 7, v2
v_lshlrev_b32 v2, 4, v2
v_lshrrev_b32 v21, 3, v1
v_lshl_add_u32 v21, v21, 12, v2
v_add_u32 v21, s62, v21
v_xor_b32 v28, 64, v21
v_add_u32 v28, 31744, v28
s_lshr_b32 s63, s50, 3
s_lshr_b32 s62, s63, 1
s_lshl_b32 s62, s62, 8
s_and_b32 s67, s63, 1
s_add_u32 s62, s62, s67
s_lshl_b32 s62, s62, 11
s_lshl_b32 s63, s3, 14
s_add_u32 s62, s62, s63
s_add_u32 s62, s62, 456704
s_lshl_b32 s63, s3, 5
v_and_b32 v2, 31, v1
v_lshlrev_b32 v2, 2, v2
v_xor_b32 v2, s63, v2
v_lshrrev_b32 v22, 5, v1
v_lshl_add_u32 v22, v22, 12, v2
v_add_u32 v22, s62, v22
v_xor_b32 v29, 16, v22
v_add_u32 v29, -57344, v29
s_mov_b32 s52, 0
s_mov_b32 s53, 65536
s_mul_i32 s55, s3, 4608
s_mov_b32 s54, 0
s_mul_i32 s56, s3, 3104
v_bfe_u32 v24, v1, 1, 3
v_lshrrev_b32 v2, 4, v1
v_xor_b32 v2, v2, v24
v_lshlrev_b32 v2, 4, v2
v_and_b32 v23, 15, v1
v_lshl_add_u32 v23, v23, 7, v2
s_mul_i32 s62, s48, 9216
v_add_u32 v23, s62, v23
v_xor_b32 v30, 64, v23
v_mul_u32_u24 v24, 2304, v24
v_add_u32 v24, v24, v2
v_and_b32 v2, 1, v1
v_lshl_add_u32 v24, v2, 7, v24
v_add_u32 v24, 2048, v24
v_xor_b32 v31, 64, v24
v_and_b32 v2, 15, v1
v_cmp_eq_u32 vcc, 0, v2
v_mov_b32 v2, 18432
s_nop 0
v_cndmask_b32 v24, v24, v2, vcc
v_cndmask_b32 v31, v31, v2, vcc
v_bfe_u32 v25, v1, 3, 2
v_mul_u32_u24 v25, 3104, v25
v_bfe_u32 v2, v1, 2, 1
v_lshl_add_u32 v25, v2, 7, v25
v_bfe_u32 v2, v1, 5, 1
v_lshl_add_u32 v25, v2, 8, v25
v_and_b32 v2, 3, v1
v_lshl_add_u32 v25, v2, 3, v25
s_lshl_b32 s62, s49, 6
s_add_u32 s62, s62, 73984
v_add_u32 v25, s62, v25
s_lshl_b32 s62, s8, 1
s_add_u32 s62, s62, s3
s_lshr_b32 s63, s50, 2
s_cmp_lt_u32 s3, 2
s_cselect_b32 s62, s62, s63
s_lshl_b32 s62, s62, 13
s_cmp_eq_u32 s3, 3
s_cselect_b32 s62, 268435456, s62
v_lshl_add_u32 v26, v1, 4, s62
s_mul_i32 s59, s3, 2080
s_and_b32 s87, s6, 3
s_lshl_b32 s87, s87, 17
v_bfe_u32 v5, v1, 3, 1
v_lshrrev_b32 v2, 4, v1
v_lshl_add_u32 v5, v2, 3, v5
s_lshl_b32 s62, s3, 1
v_add_u32 v5, s62, v5
v_mul_u32_u24 v5, 2048, v5
v_and_b32 v2, 7, v1
v_lshl_add_u32 v5, v2, 4, v5
s_lshl_b32 s62, s7, 7
v_add_u32 v5, s62, v5
v_add_u32 v6, 64512, v5
s_lshl_b32 s62, s6, 10
s_add_u32 s62, s62, 30408704
s_lshl_b32 s64, s8, 10
s_add_u32 s64, s64, 30408704
s_lshr_b32 s67, s9, 1
s_and_b32 s67, s67, 3
s_lshl_b32 s67, s67, 7
s_add_u32 s64, s64, s67
s_lshr_b32 s65, s50, 3
s_lshl_b32 s65, s65, 10
s_add_u32 s65, s65, 30408704
s_lshr_b32 s67, s9, 1
s_and_b32 s67, s67, 3
s_lshl_b32 s67, s67, 7
s_add_u32 s65, s65, s67
v_mov_b32 v2, 268435456
v_cmp_eq_u32 vcc, 65, v0
v_mov_b32 v33, s65
s_nop 0
v_cndmask_b32 v33, v2, v33, vcc
v_cndmask_b32 v36, 0, 16, vcc
v_cmp_eq_u32 vcc, 64, v0
v_mov_b32 v32, s64
s_nop 0
v_cndmask_b32 v33, v33, v32, vcc
v_lshl_add_u32 v32, v1, 7, s62
v_cndmask_b32 v34, v2, 0, vcc
v_cndmask_b32 v35, 0, 16, vcc
v_cndmask_b32 v36, v36, 16, vcc
v_lshrrev_b32 v37, 3, v0
v_cmp_eq_u32 vcc, 8, v37
s_nop 1
v_cndmask_b32 v32, v2, v32, vcc
v_mov_b32 v38, 1
v_lshrrev_b32 v2, 4, v1
v_lshlrev_b32 v2, 2, v2
v_and_b32 v13, 15, v1
v_sub_u32 v2, v13, v2
v_mov_b32 v13, 0xff61b1e6
v_subrev_u32 v54, 0, v2
v_cmp_gt_u32 vcc, 8, v54
s_nop 1
v_cndmask_b32 v50, v13, 0, vcc
v_cmp_gt_i32 vcc, -8, v54
s_nop 1
v_cndmask_b32 v46, v13, 0, vcc
v_subrev_u32 v54, 1, v2
v_cmp_gt_u32 vcc, 8, v54
s_nop 1
v_cndmask_b32 v51, v13, 0, vcc
v_cmp_gt_i32 vcc, -8, v54
s_nop 1
v_cndmask_b32 v47, v13, 0, vcc
v_subrev_u32 v54, 2, v2
v_cmp_gt_u32 vcc, 8, v54
s_nop 1
v_cndmask_b32 v52, v13, 0, vcc
v_cmp_gt_i32 vcc, -8, v54
s_nop 1
v_cndmask_b32 v48, v13, 0, vcc
v_subrev_u32 v54, 3, v2
v_cmp_gt_u32 vcc, 8, v54
s_nop 1
v_cndmask_b32 v53, v13, 0, vcc
v_cmp_gt_i32 vcc, -8, v54
s_nop 1
v_cndmask_b32 v49, v13, 0, vcc
s_cmp_lt_u32 s8, 2
s_cselect_b64 vcc, -1, 0
v_cndmask_b32 v54, v46, v13, vcc
v_cndmask_b32 v55, v47, v13, vcc
v_cndmask_b32 v56, v48, v13, vcc
v_cndmask_b32 v57, v49, v13, vcc
s_mov_b32 s75, 29360128
v_and_b32 v10, 15, v1
v_lshlrev_b32 v12, 2, v10
v_lshlrev_b32 v10, 4, v10
v_add_u32 v10, 152576, v10
v_lshrrev_b32 v11, 4, v1
v_lshlrev_b32 v11, 4, v11
s_lshl_b32 s62, s49, 7
s_add_u32 s62, s62, 158720
v_add_u32 v12, s62, v12
v_add_u32 v13, s62, v11
v_add_u32 v11, 156672, v11
s_lshl_b32 s62, s3, 11
s_add_u32 s62, s62, 143360
v_lshl_add_u32 v8, v1, 4, s62
v_xor_b32 v9, 2048, v8
v_mov_b32 v248, 0x3f803f80
v_mov_b32 v249, 0x3f803f80
v_mov_b32 v250, 0x3f803f80
v_mov_b32 v251, 0x3f803f80
s_mul_i32 s62, s3, 18496
s_add_u32 s62, s62, 18432
v_mov_b32 v2, s62
ds_write_b128 v2, v[248:251]
v_and_b32 v7, 31, v1
v_lshrrev_b32 v2, 5, v1
v_lshl_add_u32 v7, v7, 1, v2
v_and_b32 v2, 0xc0, v0
v_add_u32 v7, v7, v2
v_lshlrev_b32 v17, 2, v7
v_add_u32 v17, 156672, v17
v_lshlrev_b32 v7, 4, v7
v_add_u32 v7, 152576, v7
s_lshl_b32 s74, s9, 1
s_add_u32 s74, s74, s49
s_lshl_b32 s74, s74, 17
s_add_u32 s74, s74, s85
s_lshl_b32 s63, s48, 12
s_add_u32 s74, s74, s63
s_add_u32 s74, s74, 4194304
s_mov_b32 s62, 0
v_lshl_add_u32 v4, v1, 4, s62
v_lshrrev_b32 v2, 3, v1
v_cmp_eq_u32 vcc, 3, v2
v_add_u32 v2, 67108480, v4
s_nop 0
v_cndmask_b32 v4, v4, v2, vcc
s_mov_b64 exec, 0
s_cmp_eq_u32 s3, 2
s_cbranch_scc1 .Lpad1
s_cmp_eq_u32 s3, 3
s_cbranch_scc1 .Lpad2
s_cmp_eq_u32 s3, 1
s_cbranch_scc1 .Lpad4
s_branch .Lpad3
.Lt0r:
s_mov_b64 exec, -1
s_add_u32 m0, s55, 0
s_nop 0
buffer_load_dwordx4 v21, s[36:39], s52 offen lds
buffer_load_dwordx4 v28, s[36:39], s52 offen offset:1024 lds
buffer_load_dword v22, s[36:39], s52 offen offset:2048 lds
s_add_u32 s52, s52, 128
s_add_u32 m0, s55, 2304
s_nop 0
buffer_load_dwordx4 v21, s[36:39], s53 offen lds
buffer_load_dwordx4 v28, s[36:39], s53 offen offset:1024 lds
buffer_load_dword v29, s[36:39], s53 offen offset:2048 lds
s_add_u32 s53, s53, 128
s_add_u32 m0, s56, 123648
s_nop 0
buffer_load_dwordx4 v18, s[20:23], s54 offen lds
buffer_load_dwordx4 v19, s[20:23], s54 offen offset:1024 lds
buffer_load_dwordx4 v20, s[20:23], s54 offen offset:2048 lds
s_add_u32 s54, s54, 196608
s_add_u32 m0, s56, 136064
s_nop 0
buffer_load_dwordx4 v18, s[20:23], s54 offen lds
buffer_load_dwordx4 v19, s[20:23], s54 offen offset:1024 lds
buffer_load_dwordx4 v20, s[20:23], s54 offen offset:2048 lds
s_add_u32 s54, s54, 196608
s_cmp_eq_u32 s48, 1
s_cbranch_scc1 .Lqkv1
s_cmp_lt_u32 s14, 16
s_cselect_b32 s62, 0, 4096
v_mov_b32 v231, 1
v_lshlrev_b32 v232, 8, v1
s_waitcnt vmcnt(18)
v_permlane16_swap_b32 v164, v166
v_permlane16_swap_b32 v165, v167
s_waitcnt vmcnt(17)
v_permlane16_swap_b32 v168, v170
v_permlane16_swap_b32 v169, v171
s_waitcnt vmcnt(16)
v_permlane16_swap_b32 v172, v174
v_permlane16_swap_b32 v173, v175
s_waitcnt vmcnt(15)
v_permlane16_swap_b32 v176, v178
v_permlane16_swap_b32 v177, v179
buffer_atomic_add v231, v232, s[40:43], s62 offen
v_lshlrev_b32 v192, 16, v164
v_and_b32 v193, 0xffff0000, v164
v_lshlrev_b32 v194, 16, v165
v_and_b32 v195, 0xffff0000, v165
v_lshlrev_b32 v196, 16, v166
v_and_b32 v197, 0xffff0000, v166
v_lshlrev_b32 v198, 16, v167
v_and_b32 v199, 0xffff0000, v167
v_lshlrev_b32 v200, 16, v168
v_and_b32 v201, 0xffff0000, v168
v_lshlrev_b32 v202, 16, v169
v_and_b32 v203, 0xffff0000, v169
v_lshlrev_b32 v204, 16, v170
v_and_b32 v205, 0xffff0000, v170
v_lshlrev_b32 v206, 16, v171
v_and_b32 v207, 0xffff0000, v171
v_lshlrev_b32 v208, 16, v172
v_and_b32 v209, 0xffff0000, v172
v_lshlrev_b32 v210, 16, v173
v_and_b32 v211, 0xffff0000, v173
v_lshlrev_b32 v212, 16, v174
v_and_b32 v213, 0xffff0000, v174
v_lshlrev_b32 v214, 16, v175
v_and_b32 v215, 0xffff0000, v175
v_lshlrev_b32 v216, 16, v176
v_and_b32 v217, 0xffff0000, v176
v_lshlrev_b32 v218, 16, v177
v_and_b32 v219, 0xffff0000, v177
v_lshlrev_b32 v220, 16, v178
v_and_b32 v221, 0xffff0000, v178
v_lshlrev_b32 v222, 16, v179
v_and_b32 v223, 0xffff0000, v179
s_lshl_b32 s64, s6, 14
s_lshl_b32 s65, s49, 13
s_add_u32 s64, s64, s65
s_lshl_b32 s65, s7, 9
s_add_u32 s64, s64, s65
s_lshl_b32 s65, s48, 8
s_add_u32 s64, s64, s65
s_add_u32 s64, s64, 29360128
v_and_b32 v188, 31, v1
v_lshlrev_b32 v188, 3, v188
v_lshrrev_b32 v189, 5, v1
v_lshl_add_u32 v188, v189, 28, v188
s_lshl_b32 s62, s7, 18
s_add_u32 s62, s62, 0
s_add_u32 s63, s62, 131072
v_pk_mul_f32 v[182:183], v[192:193], v[192:193]
v_pk_mul_f32 v[186:187], v[208:209], v[208:209]
v_pk_fma_f32 v[182:183], v[194:195], v[194:195], v[182:183]
v_pk_add_f32 v[180:181], v[192:193], v[194:195]
v_pk_fma_f32 v[186:187], v[210:211], v[210:211], v[186:187]
v_pk_add_f32 v[184:185], v[208:209], v[210:211]
v_pk_fma_f32 v[182:183], v[196:197], v[196:197], v[182:183]
v_pk_add_f32 v[180:181], v[180:181], v[196:197]
v_pk_fma_f32 v[186:187], v[212:213], v[212:213], v[186:187]
v_pk_add_f32 v[184:185], v[184:185], v[212:213]
v_pk_fma_f32 v[182:183], v[198:199], v[198:199], v[182:183]
v_pk_add_f32 v[180:181], v[180:181], v[198:199]
v_pk_fma_f32 v[186:187], v[214:215], v[214:215], v[186:187]
v_pk_add_f32 v[184:185], v[184:185], v[214:215]
v_pk_fma_f32 v[182:183], v[200:201], v[200:201], v[182:183]
v_pk_add_f32 v[180:181], v[180:181], v[200:201]
v_pk_fma_f32 v[186:187], v[216:217], v[216:217], v[186:187]
v_pk_add_f32 v[184:185], v[184:185], v[216:217]
v_pk_fma_f32 v[182:183], v[202:203], v[202:203], v[182:183]
v_pk_add_f32 v[180:181], v[180:181], v[202:203]
v_pk_fma_f32 v[186:187], v[218:219], v[218:219], v[186:187]
v_pk_add_f32 v[184:185], v[184:185], v[218:219]
v_pk_fma_f32 v[182:183], v[204:205], v[204:205], v[182:183]
v_pk_add_f32 v[180:181], v[180:181], v[204:205]
v_pk_fma_f32 v[186:187], v[220:221], v[220:221], v[186:187]
v_pk_add_f32 v[184:185], v[184:185], v[220:221]
v_pk_fma_f32 v[182:183], v[206:207], v[206:207], v[182:183]
v_pk_add_f32 v[180:181], v[180:181], v[206:207]
v_pk_fma_f32 v[186:187], v[222:223], v[222:223], v[186:187]
v_pk_add_f32 v[184:185], v[184:185], v[222:223]
v_add_f32 v180, v180, v181
v_add_f32 v182, v182, v183
v_add_f32 v184, v184, v185
v_add_f32 v186, v186, v187
s_nop 0
v_permlane16_swap_b32 v180, v184
v_permlane16_swap_b32 v182, v186
v_add_f32 v180, v180, v184
v_add_f32 v182, v182, v186
s_nop 1
v_permlane32_swap_b32 v180, v182
v_add_f32 v180, v180, v182
s_nop 1
v_permlane32_swap_b32 v180, v181
buffer_store_dwordx2 v[180:181], v188, s[16:19], s64 offen sc1
s_lshl_b32 s62, s2, 10
s_add_u32 s62, s62, 31457280
s_cmp_eq_u32 s3, 0
s_cselect_b32 s62, s62, 268435456
buffer_store_dwordx4 v[224:227], v230, s[16:19], s62 offen sc1
v_accvgpr_write_b32 a224, v192
v_accvgpr_write_b32 a225, v193
v_accvgpr_write_b32 a226, v194
v_accvgpr_write_b32 a227, v195
v_accvgpr_write_b32 a228, v196
v_accvgpr_write_b32 a229, v197
v_accvgpr_write_b32 a230, v198
v_accvgpr_write_b32 a231, v199
v_accvgpr_write_b32 a232, v200
v_accvgpr_write_b32 a233, v201
v_accvgpr_write_b32 a234, v202
v_accvgpr_write_b32 a235, v203
v_accvgpr_write_b32 a236, v204
v_accvgpr_write_b32 a237, v205
v_accvgpr_write_b32 a238, v206
v_accvgpr_write_b32 a239, v207
v_accvgpr_write_b32 a240, v208
v_accvgpr_write_b32 a241, v209
v_accvgpr_write_b32 a242, v210
v_accvgpr_write_b32 a243, v211
v_accvgpr_write_b32 a244, v212
v_accvgpr_write_b32 a245, v213
v_accvgpr_write_b32 a246, v214
v_accvgpr_write_b32 a247, v215
v_accvgpr_write_b32 a248, v216
v_accvgpr_write_b32 a249, v217
v_accvgpr_write_b32 a250, v218
v_accvgpr_write_b32 a251, v219
v_accvgpr_write_b32 a252, v220
v_accvgpr_write_b32 a253, v221
v_accvgpr_write_b32 a254, v222
v_accvgpr_write_b32 a255, v223
s_add_u32 m0, s55, 18496
s_nop 0
buffer_load_dwordx4 v21, s[36:39], s52 offen lds
buffer_load_dwordx4 v28, s[36:39], s52 offen offset:1024 lds
buffer_load_dword v22, s[36:39], s52 offen offset:2048 lds
s_add_u32 s52, s52, 128
s_add_u32 m0, s55, 20800
s_nop 0
buffer_load_dwordx4 v21, s[36:39], s53 offen lds
buffer_load_dwordx4 v28, s[36:39], s53 offen offset:1024 lds
buffer_load_dword v29, s[36:39], s53 offen offset:2048 lds
s_add_u32 s53, s53, 128
s_add_u32 m0, s56, 73984
s_nop 0
buffer_load_dwordx4 v18, s[20:23], s54 offen lds
buffer_load_dwordx4 v19, s[20:23], s54 offen offset:1024 lds
buffer_load_dwordx4 v20, s[20:23], s54 offen offset:2048 lds
s_add_u32 s54, s54, 196608
s_waitcnt vmcnt(12) lgkmcnt(0)
s_barrier
ds_read_b128 a[0:3], v23
RD 4,23,2304
RD 8,23,4608
RD 12,23,6912
ds_read_b128 a[16:19], v24
ds_read_b128 a[20:23], v30
RD 24,30,2304
RD 28,30,4608
RD 32,30,6912
ds_read_b128 a[36:39], v31
TR 80,25,49664
TR 82,25,50176
TR 84,25,62080
TR 86,25,62592
TR 88,25,50688
TR 90,25,51200
TR 92,25,63104
TR 94,25,63616
TR 96,25,51712
TR 98,25,52224
TR 100,25,64128
TR 102,25,64640
s_waitcnt vmcnt(3) lgkmcnt(0)
s_barrier
v_mfma_f32_16x16x32_bf16 v[60:63], a[80:83], a[0:3], 0
TR 104,25,49696
s_add_u32 m0, s56, 86400
MAA 60,84,20
buffer_load_dwordx4 v18, s[20:23], s54 offen lds
v_mfma_f32_16x16x32_bf16 v[64:67], a[80:83], a[4:7], 0
s_sub_u32 s47, s47, 1
s_cbranch_scc1 .Lx4
.Lx4b:
MAA 64,84,24
buffer_load_dwordx4 v19, s[20:23], s54 offen offset:1024 lds
v_mfma_f32_16x16x32_bf16 v[68:71], a[80:83], a[8:11], 0
TR 106,25,50208
MAA 68,84,28
TR 108,25,62112
TR 110,25,62624
v_mfma_f32_16x16x32_bf16 v[72:75], a[80:83], a[12:15], 0
TR 112,25,50720
MAA 72,84,32
TR 114,25,51232
v_mfma_f32_16x16x32_bf16 v[244:247], a[80:83], a[16:19], 0
TR 116,25,63136
MAA 244,84,36
buffer_load_dwordx4 v20, s[20:23], s54 offen offset:2048 lds
v_mfma_f32_16x16x32_bf16 v[156:159], a[88:91], a[16:19], 0
s_add_u32 s54, s54, 196608
s_add_u32 m0, s55, 36992
MAA 156,92,36
buffer_load_dwordx4 v21, s[36:39], s52 offen lds
v_mfma_f32_16x16x32_bf16 v[104:107], a[88:91], a[12:15], 0
TR 118,25,63648
MAA 104,92,32
buffer_load_dwordx4 v28, s[36:39], s52 offen offset:1024 lds
v_mfma_f32_16x16x32_bf16 v[100:103], a[88:91], a[8:11], 0
TR 120,25,51744
MAA 100,92,28
buffer_load_dword v22, s[36:39], s52 offen offset:2048 lds
v_mfma_f32_16x16x32_bf16 v[96:99], a[88:91], a[4:7], 0
s_add_u32 s52, s52, 128
MAA 96,92,24
TR 122,25,52256
TR 124,25,64160
v_mfma_f32_16x16x32_bf16 v[92:95], a[88:91], a[0:3], 0
TR 126,25,64672
s_add_u32 m0, s55, 39296
MAA 92,92,20
buffer_load_dwordx4 v21, s[36:39], s53 offen lds
v_mfma_f32_16x16x32_bf16 v[124:127], a[0:3], a[96:99], 0
.Lpad1:
s_cbranch_execz .Lpad5
RD 40,23,18496
MAA 124,20,100
buffer_load_dwordx4 v28, s[36:39], s53 offen offset:1024 lds
v_mfma_f32_16x16x32_bf16 v[128:131], a[4:7], a[96:99], 0
RD 44,23,20800
MAA 128,24,100
RD 48,23,23104
RD 52,23,25408
v_mfma_f32_16x16x32_bf16 v[132:135], a[8:11], a[96:99], 0
RD 56,24,18496
MAA 132,28,100
buffer_load_dword v29, s[36:39], s53 offen offset:2048 lds
v_mfma_f32_16x16x32_bf16 v[136:139], a[12:15], a[96:99], 0
s_add_u32 s53, s53, 128
MAA 136,32,100
s_waitcnt vmcnt(6) lgkmcnt(5)
s_barrier
v_mfma_f32_16x16x32_bf16 v[76:79], a[104:107], a[0:3], 0
RD 60,30,18496
s_add_u32 m0, s56, 98816
MAA 76,108,20
buffer_load_dwordx4 v18, s[20:23], s54 offen lds
v_mfma_f32_16x16x32_bf16 v[80:83], a[104:107], a[4:7], 0
RD 64,30,20800
MAA 80,108,24
buffer_load_dwordx4 v19, s[20:23], s54 offen offset:1024 lds
v_mfma_f32_16x16x32_bf16 v[84:87], a[104:107], a[8:11], 0
RD 68,30,23104
MAA 84,108,28
RD 72,30,25408
RD 76,31,18496
v_mfma_f32_16x16x32_bf16 v[88:91], a[104:107], a[12:15], 0
ds_read_b64_tr_b16 a[80:81], v25
MAA 88,108,32
buffer_load_dwordx4 v20, s[20:23], s54 offen offset:2048 lds
v_mfma_f32_16x16x32_bf16 v[160:163], a[112:115], a[16:19], 0
s_add_u32 s54, s54, 196608
s_add_u32 m0, s56, 111232
MAA 160,116,36
buffer_load_dwordx4 v18, s[20:23], s54 offen lds
v_mfma_f32_16x16x32_bf16 v[120:123], a[112:115], a[12:15], 0
TR 82,25,512
MAA 120,116,32
buffer_load_dwordx4 v19, s[20:23], s54 offen offset:1024 lds
v_mfma_f32_16x16x32_bf16 v[116:119], a[112:115], a[8:11], 0
TR 84,25,12416
MAA 116,116,28
TR 86,25,12928
TR 88,25,1024
v_mfma_f32_16x16x32_bf16 v[112:115], a[112:115], a[4:7], 0
TR 90,25,1536
MAA 112,116,24
buffer_load_dwordx4 v20, s[20:23], s54 offen offset:2048 lds
v_mfma_f32_16x16x32_bf16 v[108:111], a[112:115], a[0:3], 0
s_add_u32 s54, s54, 196608
s_add_u32 m0, s55, 55488
MAA 108,116,20
buffer_load_dwordx4 v21, s[36:39], s52 offen lds
v_mfma_f32_16x16x32_bf16 v[140:143], a[0:3], a[120:123], 0
TR 92,25,13440
MAA 140,20,124
buffer_load_dwordx4 v28, s[36:39], s52 offen offset:1024 lds
v_mfma_f32_16x16x32_bf16 v[144:147], a[4:7], a[120:123], 0
TR 94,25,13952
MAA 144,24,124
TR 96,25,2048
TR 98,25,2560
v_mfma_f32_16x16x32_bf16 v[148:151], a[8:11], a[120:123], 0
TR 100,25,14464
MAA 148,28,124
buffer_load_dword v22, s[36:39], s52 offen offset:2048 lds
v_mfma_f32_16x16x32_bf16 v[152:155], a[12:15], a[120:123], 0
TR 102,25,14976
s_add_u32 s52, s52, 128
MAA 152,32,124
s_waitcnt vmcnt(9) lgkmcnt(8)
s_barrier
MAA 60,80,40
TR 104,25,32
s_add_u32 m0, s55, 57792
MAA 60,84,60
buffer_load_dwordx4 v21, s[36:39], s53 offen lds
MAA 64,84,64
s_sub_u32 s47, s47, 1
s_cbranch_scc1 .Lx5
.Lx5b:
MAA 64,80,44
buffer_load_dwordx4 v28, s[36:39], s53 offen offset:1024 lds
MAA 68,80,48
TR 106,25,544
MAA 68,84,68
TR 108,25,12448
TR 110,25,12960
MAA 72,84,72
TR 112,25,1056
MAA 72,80,52
TR 114,25,1568
s_waitcnt lgkmcnt(6)
MAA 244,80,56
TR 116,25,13472
MAA 244,84,76
buffer_load_dword v29, s[36:39], s53 offen offset:2048 lds
MAA 156,92,76
s_add_u32 s53, s53, 128
s_add_u32 m0, s56, 123648
MAA 156,88,56
buffer_load_dwordx4 v18, s[20:23], s54 offen lds
MAA 104,88,52
TR 118,25,13984
MAA 104,92,72
buffer_load_dwordx4 v19, s[20:23], s54 offen offset:1024 lds
MAA 100,92,68
TR 120,25,2080
MAA 100,88,48
buffer_load_dwordx4 v20, s[20:23], s54 offen offset:2048 lds
MAA 96,88,44
s_add_u32 s54, s54, 196608
MAA 96,92,64
TR 122,25,2592
TR 124,25,14496
MAA 92,92,60
TR 126,25,15008
s_add_u32 m0, s56, 136064
MAA 92,88,40
buffer_load_dwordx4 v18, s[20:23], s54 offen lds
MAA 124,40,96
RD 0,23,36992
MAA 124,60,100
buffer_load_dwordx4 v19, s[20:23], s54 offen offset:1024 lds
MAA 128,64,100
RD 4,23,39296
MAA 128,44,96
RD 8,23,41600
RD 12,23,43904
MAA 132,48,96
RD 16,24,36992
MAA 132,68,100
buffer_load_dwordx4 v20, s[20:23], s54 offen offset:2048 lds
MAA 136,72,100
s_add_u32 s54, s54, 196608
MAA 136,52,96
s_waitcnt vmcnt(12) lgkmcnt(5)
s_barrier
MAA 76,104,40
RD 20,30,36992
s_add_u32 m0, s55, 0
MAA 76,108,60
buffer_load_dwordx4 v21, s[36:39], s52 offen lds
MAA 80,108,64
RD 24,30,39296
MAA 80,104,44
buffer_load_dwordx4 v28, s[36:39], s52 offen offset:1024 lds
MAA 84,104,48
RD 28,30,41600
MAA 84,108,68
buffer_load_dword v22, s[36:39], s52 offen offset:2048 lds
MAA 88,108,72
RD 32,30,43904
s_add_u32 s52, s52, 128
MAA 88,104,52
RD 36,31,36992
TR 80,25,24832
TR 82,25,25344
MAA 160,112,56
TR 84,25,37248
s_add_u32 m0, s55, 2304
MAA 160,116,76
buffer_load_dwordx4 v21, s[36:39], s53 offen lds
MAA 120,116,72
TR 86,25,37760
MAA 120,112,52
buffer_load_dwordx4 v28, s[36:39], s53 offen offset:1024 lds
MAA 116,112,48
TR 88,25,25856
MAA 116,116,68
buffer_load_dword v29, s[36:39], s53 offen offset:2048 lds
MAA 112,116,64
s_add_u32 s53, s53, 128
s_add_u32 m0, s56, 73984
MAA 112,112,44
buffer_load_dwordx4 v18, s[20:23], s54 offen lds
MAA 108,112,40
TR 90,25,26368
MAA 108,116,60
buffer_load_dwordx4 v19, s[20:23], s54 offen offset:1024 lds
MAA 140,60,124
TR 92,25,38272
MAA 140,40,120
TR 94,25,38784
TR 96,25,26880
TR 98,25,27392
MAA 144,44,120
TR 100,25,39296
MAA 144,64,124
buffer_load_dwordx4 v20, s[20:23], s54 offen offset:2048 lds
MAA 148,68,124
TR 102,25,39808
s_add_u32 s54, s54, 196608
MAA 148,48,120
buffer_load_dword v37, v34, s[40:43], 0 offen sc1
MAA 152,52,120
MAA 152,72,124
s_waitcnt vmcnt(16) lgkmcnt(8)
s_barrier
MAA 60,80,0
TR 104,25,24864
s_add_u32 m0, s56, 86400
MAA 60,84,20
buffer_load_dwordx4 v18, s[20:23], s54 offen lds
MAA 64,84,24
s_sub_u32 s47, s47, 1
s_cbranch_scc1 .Lx6
.Lx6b:
MAA 64,80,4
buffer_load_dwordx4 v19, s[20:23], s54 offen offset:1024 lds
MAA 68,80,8
TR 106,25,25376
MAA 68,84,28
TR 108,25,37280
TR 110,25,37792
MAA 72,84,32
TR 112,25,25888
MAA 72,80,12
TR 114,25,26400
s_waitcnt lgkmcnt(6)
MAA 244,80,16
TR 116,25,38304
MAA 244,84,36
buffer_load_dwordx4 v20, s[20:23], s54 offen offset:2048 lds
MAA 156,92,36
s_add_u32 s54, s54, 196608
s_add_u32 m0, s55, 18496
MAA 156,88,16
buffer_load_dwordx4 v21, s[36:39], s52 offen lds
MAA 104,88,12
TR 118,25,38816
MAA 104,92,32
buffer_load_dwordx4 v28, s[36:39], s52 offen offset:1024 lds
MAA 100,92,28
TR 120,25,26912
MAA 100,88,8
buffer_load_dword v22, s[36:39], s52 offen offset:2048 lds
MAA 96,88,4
s_add_u32 s52, s52, 128
MAA 96,92,24
TR 122,25,27424
TR 124,25,39328
MAA 92,92,20
TR 126,25,39840
s_add_u32 m0, s55, 20800
MAA 92,88,0
buffer_load_dwordx4 v21, s[36:39], s53 offen lds
MAA 124,0,96
RD 40,23,55488
MAA 124,20,100
buffer_load_dwordx4 v28, s[36:39], s53 offen offset:1024 lds
MAA 128,24,100
RD 44,23,57792
MAA 128,4,96
RD 48,23,60096
RD 52,23,62400
MAA 132,8,96
RD 56,24,55488
MAA 132,28,100
buffer_load_dword v29, s[36:39], s53 offen offset:2048 lds
MAA 136,32,100
s_add_u32 s53, s53, 128
MAA 136,12,96
s_waitcnt vmcnt(19) lgkmcnt(5)
s_barrier
MAA 76,104,0
RD 60,30,55488
s_add_u32 m0, s56, 98816
MAA 76,108,20
buffer_load_dwordx4 v18, s[20:23], s54 offen lds
MAA 80,108,24
RD 64,30,57792
MAA 80,104,4
buffer_load_dwordx4 v19, s[20:23], s54 offen offset:1024 lds
MAA 84,104,8
RD 68,30,60096
MAA 84,108,28
RD 72,30,62400
RD 76,31,55488
MAA 88,108,32
TR 80,25,49664
MAA 88,104,12
buffer_load_dwordx4 v20, s[20:23], s54 offen offset:2048 lds
MAA 160,112,16
s_add_u32 s54, s54, 196608
s_add_u32 m0, s55, 36992
MAA 160,116,36
buffer_load_dwordx4 v21, s[36:39], s52 offen lds
MAA 120,116,32
TR 82,25,50176
MAA 120,112,12
buffer_load_dwordx4 v28, s[36:39], s52 offen offset:1024 lds
MAA 116,112,8
TR 84,25,62080
MAA 116,116,28
TR 86,25,62592
TR 88,25,50688
MAA 112,116,24
TR 90,25,51200
MAA 112,112,4
buffer_load_dword v22, s[36:39], s52 offen offset:2048 lds
MAA 108,112,0
s_add_u32 s52, s52, 128
s_add_u32 m0, s55, 39296
MAA 108,116,20
buffer_load_dwordx4 v21, s[36:39], s53 offen lds
MAA 140,20,124
TR 92,25,63104
MAA 140,0,120
buffer_load_dwordx4 v28, s[36:39], s53 offen offset:1024 lds
MAA 144,4,120
TR 94,25,63616
MAA 144,24,124
TR 96,25,51712
TR 98,25,52224
MAA 148,28,124
TR 100,25,64128
MAA 148,8,120
buffer_load_dword v29, s[36:39], s53 offen offset:2048 lds
MAA 152,12,120
TR 102,25,64640
s_add_u32 s53, s53, 128
MAA 152,32,124
s_waitcnt vmcnt(22) lgkmcnt(8)
s_barrier
MAA 60,80,40
TR 104,25,49696
s_add_u32 m0, s56, 111232
MAA 60,84,60
buffer_load_dwordx4 v18, s[20:23], s54 offen lds
MAA 64,84,64
s_sub_u32 s47, s47, 1
s_cbranch_scc1 .Lx7
.Lx7b:
MAA 64,80,44
TR 106,25,50208
MAA 68,80,48
TR 108,25,62112
MAA 68,84,68
buffer_load_dwordx4 v19, s[20:23], s54 offen offset:1024 lds
MAA 72,84,72
TR 110,25,62624
MAA 72,80,52
TR 112,25,50720
s_waitcnt lgkmcnt(5)
MAA 244,80,56
TR 114,25,51232
MAA 244,84,76
buffer_load_dwordx4 v20, s[20:23], s54 offen offset:2048 lds
MAA 156,92,76
s_add_u32 s54, s54, 196608
MAA 156,88,56
TR 116,25,63136
MAA 104,88,52
TR 118,25,63648
MAA 104,92,72
TR 120,25,51744
MAA 100,92,68
TR 122,25,52256
s_add_u32 m0, s55, 55488
MAA 100,88,48
buffer_load_dwordx4 v21, s[36:39], s52 offen lds
MAA 96,88,44
TR 124,25,64160
MAA 96,92,64
TR 126,25,64672
MAA 92,92,60
MAA 92,88,40
buffer_load_dwordx4 v28, s[36:39], s52 offen offset:1024 lds
MAA 124,40,96
ds_read_b128 a[0:3], v23
MAA 124,60,100
RD 4,23,2304
MAA 128,64,100
RD 8,23,4608
MAA 128,44,96
buffer_load_dword v22, s[36:39], s52 offen offset:2048 lds
MAA 132,48,96
RD 12,23,6912
s_add_u32 s52, s52, 128
MAA 132,68,100
ds_read_b128 a[16:19], v24
MAA 136,72,100
MAA 136,52,96
s_waitcnt vmcnt(21) lgkmcnt(5)
s_barrier
v_cmp_gt_u32 vcc, v35, v37
s_nop 0
s_cbranch_vccnz .Lsp8
.Lsp8b:
v_mov_b32 v37, 0
MAA 76,104,40
ds_read_b128 a[20:23], v30
MAA 76,108,60
buffer_atomic_add v38, v32, s[16:19], 0 offen
MAA 80,108,64
RD 24,30,2304
MAA 80,104,44
RD 28,30,4608
MAA 84,104,48
RD 32,30,6912
s_add_u32 m0, s56, 123648
MAA 84,108,68
buffer_load_dwordx4 v18, s[20:23], s54 offen lds
MAA 88,108,72
ds_read_b128 a[36:39], v31
MAA 88,104,52
buffer_load_dwordx4 v19, s[20:23], s54 offen offset:1024 lds
MAA 160,112,56
ds_read_b64_tr_b16 a[80:81], v25
MAA 160,116,76
TR 82,25,512
MAA 120,116,72
TR 84,25,12416
MAA 120,112,52
buffer_load_dwordx4 v20, s[20:23], s54 offen offset:2048 lds
MAA 116,112,48
TR 86,25,12928
s_add_u32 s54, s54, 196608
MAA 116,116,68
TR 88,25,1024
MAA 112,116,64
TR 90,25,1536
s_add_u32 m0, s55, 57792
MAA 112,112,44
buffer_load_dwordx4 v21, s[36:39], s53 offen lds
MAA 108,112,40
TR 92,25,13440
MAA 108,116,60
TR 94,25,13952
MAA 140,60,124
TR 96,25,2048
MAA 140,40,120
buffer_load_dwordx4 v28, s[36:39], s53 offen offset:1024 lds
MAA 144,44,120
TR 98,25,2560
MAA 144,64,124
buffer_load_dword v29, s[36:39], s53 offen offset:2048 lds
MAA 148,68,124
TR 100,25,14464
s_add_u32 s53, s53, 128
MAA 148,48,120
TR 102,25,14976
MAA 152,52,120
MAA 152,72,124
s_waitcnt vmcnt(22) lgkmcnt(8)
s_barrier
MAA 60,80,0
TR 104,25,32
s_add_u32 m0, s56, 136064
MAA 60,84,20
buffer_load_dwordx4 v18, s[20:23], s54 offen lds
MAA 64,84,24
s_sub_u32 s47, s47, 1
s_cbranch_scc1 .Lx9
.Lx9b:
MAA 64,80,4
TR 106,25,544
MAA 68,80,8
TR 108,25,12448
MAA 68,84,28
buffer_load_dwordx4 v19, s[20:23], s54 offen offset:1024 lds
MAA 72,84,32
TR 110,25,12960
MAA 72,80,12
TR 112,25,1056
s_waitcnt lgkmcnt(5)
MAA 244,80,16
TR 114,25,1568
MAA 244,84,36
buffer_load_dwordx4 v20, s[20:23], s54 offen offset:2048 lds
MAA 156,92,36
s_add_u32 s54, s54, 196608
MAA 156,88,16
TR 116,25,13472
MAA 104,88,12
TR 118,25,13984
MAA 104,92,32
TR 120,25,2080
MAA 100,92,28
TR 122,25,2592
s_add_u32 m0, s55, 0
MAA 100,88,8
buffer_load_dwordx4 v21, s[36:39], s52 offen lds
MAA 96,88,4
TR 124,25,14496
MAA 96,92,24
TR 126,25,15008
MAA 92,92,20
MAA 92,88,0
buffer_load_dwordx4 v28, s[36:39], s52 offen offset:1024 lds
MAA 124,0,96
RD 40,23,18496
MAA 124,20,100
RD 44,23,20800
MAA 128,24,100
RD 48,23,23104
MAA 128,4,96
buffer_load_dword v22, s[36:39], s52 offen offset:2048 lds
MAA 132,8,96
RD 52,23,25408
s_add_u32 s52, s52, 128
MAA 132,28,100
RD 56,24,18496
MAA 136,32,100
MAA 136,12,96
s_waitcnt vmcnt(16) lgkmcnt(5)
s_barrier
MAA 76,104,0
RD 60,30,18496
s_add_u32 m0, s56, 73984
MAA 76,108,20
buffer_load_dwordx4 v18, s[20:23], s54 offen lds
MAA 80,108,24
RD 64,30,20800
MAA 80,104,4
RD 68,30,23104
MAA 84,104,8
RD 72,30,25408
MAA 84,108,28
buffer_load_dwordx4 v19, s[20:23], s54 offen offset:1024 lds
MAA 88,108,32
RD 76,31,18496
MAA 88,104,12
TR 80,25,24832
MAA 160,112,16
TR 82,25,25344
MAA 160,116,36
buffer_load_dwordx4 v20, s[20:23], s54 offen offset:2048 lds
.Lpad2:
s_cbranch_execz .Lpad6
MAA 120,116,32
TR 84,25,37248
s_add_u32 s54, s54, 196608
MAA 120,112,12
TR 86,25,37760
MAA 116,112,8
s_add_u32 m0, s55, 2304
MAA 116,116,28
buffer_load_dwordx4 v21, s[36:39], s53 offen lds
MAA 112,116,24
TR 88,25,25856
MAA 112,112,4
TR 90,25,26368
MAA 108,112,0
TR 92,25,38272
MAA 108,116,20
buffer_load_dwordx4 v28, s[36:39], s53 offen offset:1024 lds
MAA 140,20,124
TR 94,25,38784
MAA 140,0,120
TR 96,25,26880
MAA 144,4,120
TR 98,25,27392
MAA 144,24,124
buffer_load_dword v29, s[36:39], s53 offen offset:2048 lds
MAA 148,28,124
TR 100,25,39296
s_add_u32 s53, s53, 128
MAA 148,8,120
TR 102,25,39808
MAA 152,12,120
MAA 152,32,124
s_waitcnt lgkmcnt(8)
s_barrier
MAA 60,80,40
TR 104,25,24864
s_add_u32 m0, s56, 86400
MAA 60,84,60
buffer_load_dwordx4 v18, s[20:23], s54 offen lds
MAA 64,84,64
s_sub_u32 s47, s47, 1
s_cbranch_scc1 .Lx10
.Lx10b:
MAA 64,80,44
TR 106,25,25376
MAA 68,80,48
TR 108,25,37280
MAA 68,84,68
buffer_load_dwordx4 v19, s[20:23], s54 offen offset:1024 lds
MAA 72,84,72
TR 110,25,37792
MAA 72,80,52
TR 112,25,25888
s_waitcnt lgkmcnt(5)
MAA 244,80,56
TR 114,25,26400
MAA 244,84,76
buffer_load_dwordx4 v20, s[20:23], s54 offen offset:2048 lds
MAA 156,92,76
s_add_u32 s54, s54, 196608
MAA 156,88,56
TR 116,25,38304
MAA 104,88,52
TR 118,25,38816
MAA 104,92,72
TR 120,25,26912
MAA 100,92,68
TR 122,25,27424
s_add_u32 m0, s55, 18496
MAA 100,88,48
buffer_load_dwordx4 v21, s[36:39], s52 offen lds
MAA 96,88,44
TR 124,25,39328
MAA 96,92,64
TR 126,25,39840
MAA 92,92,60
MAA 92,88,40
buffer_load_dwordx4 v28, s[36:39], s52 offen offset:1024 lds
MAA 124,40,96
RD 0,23,36992
MAA 124,60,100
RD 4,23,39296
MAA 128,64,100
RD 8,23,41600
MAA 128,44,96
buffer_load_dword v22, s[36:39], s52 offen offset:2048 lds
MAA 132,48,96
RD 12,23,43904
s_add_u32 s52, s52, 128
MAA 132,68,100
RD 16,24,36992
MAA 136,72,100
MAA 136,52,96
s_waitcnt vmcnt(15) lgkmcnt(5)
s_barrier
MAA 76,104,40
RD 20,30,36992
s_add_u32 m0, s56, 98816
MAA 76,108,60
buffer_load_dwordx4 v18, s[20:23], s54 offen lds
MAA 80,108,64
RD 24,30,39296
MAA 80,104,44
RD 28,30,41600
MAA 84,104,48
RD 32,30,43904
MAA 84,108,68
buffer_load_dwordx4 v19, s[20:23], s54 offen offset:1024 lds
MAA 88,108,72
RD 36,31,36992
MAA 88,104,52
buffer_load_dwordx4 v20, s[20:23], s54 offen offset:2048 lds
MAA 160,112,56
TR 80,25,49664
s_add_u32 s54, s54, 196608
MAA 160,116,76
TR 82,25,50176
MAA 120,116,72
TR 84,25,62080
s_add_u32 m0, s55, 20800
MAA 120,112,52
buffer_load_dwordx4 v21, s[36:39], s53 offen lds
MAA 116,112,48
TR 86,25,62592
MAA 116,116,68
TR 88,25,50688
MAA 112,116,64
TR 90,25,51200
MAA 112,112,44
buffer_load_dwordx4 v28, s[36:39], s53 offen offset:1024 lds
MAA 108,112,40
TR 92,25,63104
MAA 108,116,60
TR 94,25,63616
MAA 140,60,124
TR 96,25,51712
MAA 140,40,120
buffer_load_dword v29, s[36:39], s53 offen offset:2048 lds
MAA 144,44,120
TR 98,25,52224
s_add_u32 s53, s53, 128
MAA 144,64,124
buffer_atomic_add v37, v33, s[16:19], 0 offen sc0
MAA 148,68,124
TR 100,25,64128
MAA 148,48,120
TR 102,25,64640
MAA 152,52,120
MAA 152,72,124
s_waitcnt lgkmcnt(8)
s_barrier
MAA 60,80,0
TR 104,25,49696
s_add_u32 m0, s56, 111232
MAA 60,84,20
buffer_load_dwordx4 v18, s[20:23], s54 offen lds
MAA 64,84,24
s_sub_u32 s47, s47, 1
s_cbranch_scc1 .Lx11
.Lx11b:
MAA 64,80,4
TR 106,25,50208
MAA 68,80,8
TR 108,25,62112
MAA 68,84,28
buffer_load_dwordx4 v19, s[20:23], s54 offen offset:1024 lds
MAA 72,84,32
TR 110,25,62624
MAA 72,80,12
TR 112,25,50720
s_waitcnt lgkmcnt(5)
MAA 244,80,16
TR 114,25,51232
MAA 244,84,36
buffer_load_dwordx4 v20, s[20:23], s54 offen offset:2048 lds
MAA 156,92,36
s_add_u32 s54, s54, 196608
MAA 156,88,16
TR 116,25,63136
MAA 104,88,12
TR 118,25,63648
MAA 104,92,32
TR 120,25,51744
MAA 100,92,28
TR 122,25,52256
s_add_u32 m0, s55, 36992
MAA 100,88,8
buffer_load_dwordx4 v21, s[36:39], s52 offen lds
MAA 96,88,4
TR 124,25,64160
MAA 96,92,24
TR 126,25,64672
MAA 92,92,20
MAA 92,88,0
buffer_load_dwordx4 v28, s[36:39], s52 offen offset:1024 lds
MAA 124,0,96
RD 40,23,55488
MAA 124,20,100
RD 44,23,57792
MAA 128,24,100
RD 48,23,60096
MAA 128,4,96
buffer_load_dword v22, s[36:39], s52 offen offset:2048 lds
MAA 132,8,96
RD 52,23,62400
s_add_u32 s52, s52, 128
MAA 132,28,100
RD 56,24,55488
MAA 136,32,100
MAA 136,12,96
s_waitcnt vmcnt(16) lgkmcnt(5)
s_barrier
MAA 76,104,0
RD 60,30,55488
s_add_u32 m0, s56, 123648
MAA 76,108,20
buffer_load_dwordx4 v18, s[20:23], s54 offen lds
MAA 80,108,24
RD 64,30,57792
MAA 80,104,4
RD 68,30,60096
MAA 84,104,8
RD 72,30,62400
MAA 84,108,28
buffer_load_dwordx4 v19, s[20:23], s54 offen offset:1024 lds
MAA 88,108,32
RD 76,31,55488
MAA 88,104,12
ds_read_b64_tr_b16 a[80:81], v25
MAA 160,112,16
TR 82,25,512
MAA 160,116,36
buffer_load_dwordx4 v20, s[20:23], s54 offen offset:2048 lds
MAA 120,116,32
TR 84,25,12416
s_add_u32 s54, s54, 196608
MAA 120,112,12
TR 86,25,12928
MAA 116,112,8
s_add_u32 m0, s55, 39296
MAA 116,116,28
buffer_load_dwordx4 v21, s[36:39], s53 offen lds
MAA 112,116,24
TR 88,25,1024
MAA 112,112,4
TR 90,25,1536
MAA 108,112,0
TR 92,25,13440
MAA 108,116,20
buffer_load_dwordx4 v28, s[36:39], s53 offen offset:1024 lds
MAA 140,20,124
TR 94,25,13952
MAA 140,0,120
TR 96,25,2048
MAA 144,4,120
TR 98,25,2560
MAA 144,24,124
buffer_load_dword v29, s[36:39], s53 offen offset:2048 lds
MAA 148,28,124
TR 100,25,14464
s_add_u32 s53, s53, 128
MAA 148,8,120
TR 102,25,14976
MAA 152,12,120
MAA 152,32,124
s_waitcnt lgkmcnt(8)
s_barrier
MAA 60,80,40
TR 104,25,32
s_add_u32 m0, s56, 136064
MAA 60,84,60
buffer_load_dwordx4 v18, s[20:23], s54 offen lds
MAA 64,84,64
s_sub_u32 s47, s47, 1
s_cbranch_scc1 .Lx12
.Lx12b:
MAA 64,80,44
TR 106,25,544
MAA 68,80,48
TR 108,25,12448
MAA 68,84,68
buffer_load_dwordx4 v19, s[20:23], s54 offen offset:1024 lds
MAA 72,84,72
TR 110,25,12960
MAA 72,80,52
TR 112,25,1056
s_waitcnt lgkmcnt(5)
MAA 244,80,56
TR 114,25,1568
MAA 244,84,76
buffer_load_dwordx4 v20, s[20:23], s54 offen offset:2048 lds
MAA 156,92,76
s_add_u32 s54, s54, 196608
MAA 156,88,56
TR 116,25,13472
MAA 104,88,52
TR 118,25,13984
MAA 104,92,72
TR 120,25,2080
MAA 100,92,68
TR 122,25,2592
s_add_u32 m0, s55, 55488
MAA 100,88,48
buffer_load_dwordx4 v21, s[36:39], s52 offen lds
MAA 96,88,44
TR 124,25,14496
MAA 96,92,64
TR 126,25,15008
MAA 92,92,60
MAA 92,88,40
buffer_load_dwordx4 v28, s[36:39], s52 offen offset:1024 lds
MAA 124,40,96
ds_read_b128 a[0:3], v23
MAA 124,60,100
RD 4,23,2304
MAA 128,64,100
RD 8,23,4608
MAA 128,44,96
buffer_load_dword v22, s[36:39], s52 offen offset:2048 lds
MAA 132,48,96
RD 12,23,6912
s_add_u32 s52, s52, 128
MAA 132,68,100
ds_read_b128 a[16:19], v24
MAA 136,72,100
MAA 136,52,96
s_waitcnt vmcnt(18)
v_cmp_gt_u32 vcc, v36, v37
s_nop 0
s_cbranch_vccnz .Lsp13
.Lsp13b:
s_waitcnt vmcnt(15) lgkmcnt(5)
s_barrier
MAA 76,104,40
ds_read_b128 a[20:23], v30
s_add_u32 m0, s56, 73984
MAA 76,108,60
buffer_load_dwordx4 v18, s[20:23], s54 offen lds
MAA 80,108,64
RD 24,30,2304
MAA 80,104,44
RD 28,30,4608
MAA 84,104,48
RD 32,30,6912
MAA 84,108,68
buffer_load_dwordx4 v19, s[20:23], s54 offen offset:1024 lds
MAA 88,108,72
ds_read_b128 a[36:39], v31
MAA 88,104,52
buffer_load_dwordx4 v20, s[20:23], s54 offen offset:2048 lds
MAA 160,112,56
TR 80,25,24832
s_add_u32 s54, s54, 196608
MAA 160,116,76
TR 82,25,25344
MAA 120,116,72
TR 84,25,37248
s_add_u32 m0, s55, 57792
MAA 120,112,52
buffer_load_dwordx4 v21, s[36:39], s53 offen lds
MAA 116,112,48
TR 86,25,37760
MAA 116,116,68
TR 88,25,25856
MAA 112,116,64
TR 90,25,26368
MAA 112,112,44
buffer_load_dwordx4 v28, s[36:39], s53 offen offset:1024 lds
MAA 108,112,40
TR 92,25,38272
MAA 108,116,60
TR 94,25,38784
MAA 140,60,124
TR 96,25,26880
MAA 140,40,120
buffer_load_dword v29, s[36:39], s53 offen offset:2048 lds
MAA 144,44,120
TR 98,25,27392
s_add_u32 s53, s53, 128
MAA 144,64,124
buffer_load_dwordx4 v[164:167], v26, s[16:19], s75 offen sc1
MAA 148,68,124
TR 100,25,39296
MAA 148,48,120
TR 102,25,39808
MAA 152,52,120
MAA 152,72,124
s_waitcnt lgkmcnt(8)
s_barrier
MAA 60,80,0
TR 104,25,24864
s_add_u32 m0, s56, 86400
MAA 60,84,20
buffer_load_dwordx4 v18, s[20:23], s54 offen lds
MAA 64,84,24
s_sub_u32 s47, s47, 1
s_cbranch_scc1 .Lx14
.Lx14b:
MAA 64,80,4
TR 106,25,25376
MAA 68,80,8
TR 108,25,37280
MAA 68,84,28
buffer_load_dwordx4 v19, s[20:23], s54 offen offset:1024 lds
MAA 72,84,32
TR 110,25,37792
MAA 72,80,12
TR 112,25,25888
s_waitcnt lgkmcnt(5)
MAA 244,80,16
TR 114,25,26400
MAA 244,84,36
buffer_load_dwordx4 v20, s[20:23], s54 offen offset:2048 lds
MAA 156,92,36
TR 116,25,38304
s_add_u32 s54, s54, 196608
MAA 156,88,16
TR 118,25,38816
MAA 104,88,12
TR 120,25,26912
s_add_u32 m0, s55, 0
MAA 104,92,32
buffer_load_dwordx4 v21, s[36:39], s52 offen lds
MAA 100,92,28
MAA 100,88,8
buffer_load_dwordx4 v28, s[36:39], s52 offen offset:1024 lds
MAA 96,88,4
TR 122,25,27424
MAA 96,92,24
TR 124,25,39328
MAA 92,92,20
TR 126,25,39840
MAA 92,88,0
buffer_load_dword v22, s[36:39], s52 offen offset:2048 lds
MAA 124,0,96
RD 40,23,18496
s_add_u32 s52, s52, 128
MAA 124,20,100
RD 44,23,20800
MAA 128,24,100
RD 48,23,23104
MAA 128,4,96
buffer_load_dwordx4 v[168:171], v26, s[16:19], s75 offen offset:1024 sc1
MAA 132,8,96
RD 52,23,25408
MAA 132,28,100
RD 56,24,18496
MAA 136,32,100
MAA 136,12,96
s_waitcnt vmcnt(17) lgkmcnt(5)
s_barrier
MAA 76,104,0
RD 60,30,18496
s_add_u32 m0, s56, 98816
MAA 76,108,20
buffer_load_dwordx4 v18, s[20:23], s54 offen lds
MAA 80,108,24
RD 64,30,20800
MAA 80,104,4
RD 68,30,23104
MAA 84,104,8
RD 72,30,25408
MAA 84,108,28
buffer_load_dwordx4 v19, s[20:23], s54 offen offset:1024 lds
MAA 88,108,32
RD 76,31,18496
MAA 88,104,12
buffer_load_dwordx4 v20, s[20:23], s54 offen offset:2048 lds
MAA 160,112,16
TR 80,25,49664
s_add_u32 s54, s54, 196608
MAA 160,116,36
TR 82,25,50176
MAA 120,116,32
TR 84,25,62080
s_add_u32 m0, s55, 2304
MAA 120,112,12
buffer_load_dwordx4 v21, s[36:39], s53 offen lds
MAA 116,112,8
TR 86,25,62592
MAA 116,116,28
TR 88,25,50688
MAA 112,116,24
TR 90,25,51200
MAA 112,112,4
buffer_load_dwordx4 v28, s[36:39], s53 offen offset:1024 lds
MAA 108,112,0
TR 92,25,63104
MAA 108,116,20
TR 94,25,63616
MAA 140,20,124
TR 96,25,51712
MAA 140,0,120
buffer_load_dword v29, s[36:39], s53 offen offset:2048 lds
MAA 144,4,120
TR 98,25,52224
s_add_u32 s53, s53, 128
MAA 144,24,124
buffer_load_dwordx4 v[172:175], v26, s[16:19], s75 offen offset:2048 sc1
MAA 148,28,124
TR 100,25,64128
MAA 148,8,120
TR 102,25,64640
MAA 152,12,120
MAA 152,32,124
s_waitcnt lgkmcnt(8)
s_barrier
MAA 60,80,40
TR 104,25,49696
s_add_u32 m0, s56, 111232
MAA 60,84,60
buffer_load_dwordx4 v18, s[20:23], s54 offen lds
MAA 64,84,64
s_sub_u32 s47, s47, 1
s_cbranch_scc1 .Lx15
.Lx15b:
MAA 64,80,44
TR 106,25,50208
MAA 68,80,48
TR 108,25,62112
MAA 68,84,68
buffer_load_dwordx4 v19, s[20:23], s54 offen offset:1024 lds
MAA 72,84,72
TR 110,25,62624
MAA 72,80,52
TR 112,25,50720
s_waitcnt lgkmcnt(5)
MAA 244,80,56
TR 114,25,51232
MAA 244,84,76
buffer_load_dwordx4 v20, s[20:23], s54 offen offset:2048 lds
MAA 156,92,76
TR 116,25,63136
s_add_u32 s54, s54, 196608
MAA 156,88,56
TR 118,25,63648
MAA 104,88,52
.Lpad3:
s_cbranch_execz .Lpad7
TR 120,25,51744
s_add_u32 m0, s55, 18496
MAA 104,92,72
buffer_load_dwordx4 v21, s[36:39], s52 offen lds
MAA 100,92,68
MAA 100,88,48
buffer_load_dwordx4 v28, s[36:39], s52 offen offset:1024 lds
MAA 96,88,44
TR 122,25,52256
MAA 96,92,64
TR 124,25,64160
MAA 92,92,60
TR 126,25,64672
MAA 92,88,40
buffer_load_dword v22, s[36:39], s52 offen offset:2048 lds
MAA 124,40,96
RD 0,23,36992
s_add_u32 s52, s52, 128
MAA 124,60,100
RD 4,23,39296
MAA 128,64,100
RD 8,23,41600
MAA 128,44,96
buffer_load_dwordx4 v[176:179], v26, s[16:19], s75 offen offset:3072 sc1
MAA 132,48,96
RD 12,23,43904
s_add_u32 s75, s75, 4096
MAA 132,68,100
RD 16,24,36992
MAA 136,72,100
MAA 136,52,96
s_waitcnt vmcnt(18) lgkmcnt(5)
s_barrier
MAA 76,104,40
RD 20,30,36992
s_add_u32 m0, s56, 123648
MAA 76,108,60
buffer_load_dwordx4 v18, s[20:23], s54 offen lds
MAA 80,108,64
RD 24,30,39296
s_waitcnt vmcnt(15)
v_add_f32 v164, v164, v168
MAA 80,104,44
RD 28,30,41600
MAA 84,104,48
RD 32,30,43904
MAA 84,108,68
buffer_load_dwordx4 v19, s[20:23], s54 offen offset:1024 lds
MAA 88,108,72
RD 36,31,36992
v_add_f32 v165, v165, v169
MAA 88,104,52
buffer_load_dwordx4 v20, s[20:23], s54 offen offset:2048 lds
MAA 160,112,56
ds_read_b64_tr_b16 a[80:81], v25
s_add_u32 s54, s54, 196608
MAA 160,116,76
TR 82,25,512
MAA 120,116,72
TR 84,25,12416
s_add_u32 m0, s55, 20800
MAA 120,112,52
buffer_load_dwordx4 v21, s[36:39], s53 offen lds
MAA 116,112,48
TR 86,25,12928
MAA 116,116,68
TR 88,25,1024
MAA 112,116,64
TR 90,25,1536
v_add_f32 v166, v166, v170
MAA 112,112,44
buffer_load_dwordx4 v28, s[36:39], s53 offen offset:1024 lds
MAA 108,112,40
TR 92,25,13440
MAA 108,116,60
TR 94,25,13952
MAA 140,60,124
TR 96,25,2048
MAA 140,40,120
buffer_load_dword v29, s[36:39], s53 offen offset:2048 lds
MAA 144,44,120
TR 98,25,2560
s_add_u32 s53, s53, 128
MAA 144,64,124
buffer_load_dwordx4 v[180:183], v26, s[16:19], s75 offen sc1
MAA 148,68,124
TR 100,25,14464
v_add_f32 v167, v167, v171
MAA 148,48,120
TR 102,25,14976
MAA 152,52,120
MAA 152,72,124
s_waitcnt lgkmcnt(8)
s_barrier
MAA 60,80,0
TR 104,25,32
s_add_u32 m0, s56, 136064
MAA 60,84,20
buffer_load_dwordx4 v18, s[20:23], s54 offen lds
MAA 64,84,24
s_sub_u32 s47, s47, 1
s_cbranch_scc1 .Lx16
.Lx16b:
MAA 64,80,4
TR 106,25,544
s_waitcnt vmcnt(15)
v_add_f32 v164, v164, v172
MAA 68,80,8
TR 108,25,12448
MAA 68,84,28
buffer_load_dwordx4 v19, s[20:23], s54 offen offset:1024 lds
MAA 72,84,32
TR 110,25,12960
MAA 72,80,12
TR 112,25,1056
s_waitcnt lgkmcnt(5)
MAA 244,80,16
TR 114,25,1568
MAA 244,84,36
buffer_load_dwordx4 v20, s[20:23], s54 offen offset:2048 lds
MAA 156,92,36
TR 116,25,13472
s_add_u32 s54, s54, 196608
MAA 156,88,16
TR 118,25,13984
v_add_f32 v165, v165, v173
MAA 104,88,12
TR 120,25,2080
s_add_u32 m0, s55, 36992
MAA 104,92,32
buffer_load_dwordx4 v21, s[36:39], s52 offen lds
MAA 100,92,28
MAA 100,88,8
buffer_load_dwordx4 v28, s[36:39], s52 offen offset:1024 lds
MAA 96,88,4
TR 122,25,2592
MAA 96,92,24
TR 124,25,14496
v_add_f32 v166, v166, v174
MAA 92,92,20
TR 126,25,15008
MAA 92,88,0
buffer_load_dword v22, s[36:39], s52 offen offset:2048 lds
MAA 124,0,96
RD 40,23,55488
s_add_u32 s52, s52, 128
MAA 124,20,100
RD 44,23,57792
MAA 128,24,100
RD 48,23,60096
MAA 128,4,96
buffer_load_dwordx4 v[184:187], v26, s[16:19], s75 offen offset:1024 sc1
MAA 132,8,96
RD 52,23,62400
v_add_f32 v167, v167, v175
MAA 132,28,100
RD 56,24,55488
MAA 136,32,100
MAA 136,12,96
s_waitcnt vmcnt(18) lgkmcnt(5)
s_barrier
MAA 76,104,0
RD 60,30,55488
s_add_u32 m0, s56, 73984
MAA 76,108,20
buffer_load_dwordx4 v18, s[20:23], s54 offen lds
MAA 80,108,24
RD 64,30,57792
s_waitcnt vmcnt(15)
v_add_f32 v164, v164, v176
MAA 80,104,4
RD 68,30,60096
v_add_f32 v165, v165, v177
MAA 84,104,8
buffer_load_dwordx4 v19, s[20:23], s54 offen offset:1024 lds
MAA 84,108,28
RD 72,30,62400
v_add_f32 v166, v166, v178
MAA 88,108,32
RD 76,31,55488
v_add_f32 v167, v167, v179
MAA 88,104,12
buffer_load_dwordx4 v20, s[20:23], s54 offen offset:2048 lds
MAA 160,112,16
TR 80,25,24832
s_add_u32 s54, s54, 196608
MAA 160,116,36
TR 82,25,25344
s_add_u32 m0, s55, 39296
MAA 120,116,32
buffer_load_dwordx4 v21, s[36:39], s53 offen lds
MAA 120,112,12
TR 84,25,37248
MAA 116,112,8
TR 86,25,37760
MAA 116,116,28
buffer_load_dwordx4 v28, s[36:39], s53 offen offset:1024 lds
MAA 112,116,24
TR 88,25,25856
MAA 112,112,4
TR 90,25,26368
MAA 108,112,0
buffer_load_dword v29, s[36:39], s53 offen offset:2048 lds
MAA 108,116,20
TR 92,25,38272
s_add_u32 s53, s53, 128
MAA 140,20,124
TR 94,25,38784
MAA 140,0,120
buffer_load_dwordx4 v[188:191], v26, s[16:19], s75 offen offset:2048 sc1
MAA 144,4,120
TR 96,25,26880
MAA 144,24,124
TR 98,25,27392
MAA 148,28,124
TR 100,25,39296
MAA 148,8,120
TR 102,25,39808
MAA 152,12,120
MAA 152,32,124
s_waitcnt lgkmcnt(8)
s_barrier
MAA 60,80,40
TR 104,25,24864
s_add_u32 m0, s56, 86400
MAA 60,84,60
buffer_load_dwordx4 v18, s[20:23], s54 offen lds
MAA 64,84,64
s_sub_u32 s47, s47, 1
s_cbranch_scc1 .Lx17
.Lx17b:
MAA 64,80,44
TR 106,25,25376
s_waitcnt vmcnt(15)
v_add_f32 v164, v164, v180
MAA 68,80,48
TR 108,25,37280
MAA 68,84,68
buffer_load_dwordx4 v19, s[20:23], s54 offen offset:1024 lds
MAA 72,84,72
TR 110,25,37792
MAA 72,80,52
TR 112,25,25888
s_waitcnt lgkmcnt(5)
MAA 244,80,56
TR 114,25,26400
MAA 244,84,76
buffer_load_dwordx4 v20, s[20:23], s54 offen offset:2048 lds
MAA 156,92,76
TR 116,25,38304
s_add_u32 s54, s54, 196608
MAA 156,88,56
TR 118,25,38816
v_add_f32 v165, v165, v181
MAA 104,88,52
TR 120,25,26912
s_add_u32 m0, s55, 55488
MAA 104,92,72
buffer_load_dwordx4 v21, s[36:39], s52 offen lds
MAA 100,92,68
MAA 100,88,48
buffer_load_dwordx4 v28, s[36:39], s52 offen offset:1024 lds
MAA 96,88,44
TR 122,25,27424
MAA 96,92,64
TR 124,25,39328
v_add_f32 v166, v166, v182
MAA 92,92,60
TR 126,25,39840
MAA 92,88,40
buffer_load_dword v22, s[36:39], s52 offen offset:2048 lds
MAA 124,40,96
ds_read_b128 a[0:3], v23
s_add_u32 s52, s52, 128
MAA 124,60,100
RD 4,23,2304
MAA 128,64,100
RD 8,23,4608
MAA 128,44,96
buffer_load_dwordx4 v[192:195], v26, s[16:19], s75 offen offset:3072 sc1
MAA 132,48,96
RD 12,23,6912
v_add_f32 v167, v167, v183
MAA 132,68,100
ds_read_b128 a[16:19], v24
MAA 136,72,100
MAA 136,52,96
s_waitcnt vmcnt(18) lgkmcnt(5)
s_barrier
MAA 76,104,40
ds_read_b128 a[20:23], v30
s_add_u32 m0, s56, 98816
MAA 76,108,60
buffer_load_dwordx4 v18, s[20:23], s54 offen lds
MAA 80,108,64
RD 24,30,2304
s_waitcnt vmcnt(15)
v_add_f32 v164, v164, v184
MAA 80,104,44
RD 28,30,4608
v_add_f32 v165, v165, v185
MAA 84,104,48
RD 32,30,6912
v_add_f32 v166, v166, v186
MAA 84,108,68
buffer_load_dwordx4 v19, s[20:23], s54 offen offset:1024 lds
MAA 88,108,72
ds_read_b128 a[36:39], v31
v_add_f32 v167, v167, v187
MAA 88,104,52
TR 80,25,49664
MAA 160,112,56
TR 82,25,50176
MAA 160,116,76
buffer_load_dwordx4 v20, s[20:23], s54 offen offset:2048 lds
MAA 120,116,72
TR 84,25,62080
s_add_u32 s54, s54, 196608
MAA 120,112,52
TR 86,25,62592
s_add_u32 m0, s55, 57792
MAA 116,112,48
TR 88,25,50688
MAA 116,116,68
buffer_load_dwordx4 v21, s[36:39], s53 offen lds
MAA 112,116,64
TR 90,25,51200
MAA 112,112,44
TR 92,25,63104
MAA 108,112,40
TR 94,25,63616
MAA 108,116,60
buffer_load_dwordx4 v28, s[36:39], s53 offen offset:1024 lds
MAA 140,60,124
TR 96,25,51712
MAA 140,40,120
TR 98,25,52224
MAA 144,44,120
TR 100,25,64128
MAA 144,64,124
buffer_load_dword v29, s[36:39], s53 offen offset:2048 lds
MAA 148,68,124
TR 102,25,64640
s_add_u32 s53, s53, 128
MAA 148,48,120
MAA 152,52,120
MAA 152,72,124
s_waitcnt lgkmcnt(8)
s_barrier
MAA 60,80,0
TR 104,25,49696
s_add_u32 m0, s56, 111232
MAA 60,84,20
buffer_load_dwordx4 v18, s[20:23], s54 offen lds
MAA 64,84,24
TR 106,25,50208
s_waitcnt vmcnt(14)
v_add_f32 v164, v164, v188
MAA 64,80,4
TR 108,25,62112
v_add_f32 v165, v165, v189
MAA 68,80,8
buffer_load_dwordx4 v19, s[20:23], s54 offen offset:1024 lds
MAA 68,84,28
TR 110,25,62624
v_add_f32 v166, v166, v190
MAA 72,84,32
TR 112,25,50720
v_add_f32 v167, v167, v191
MAA 72,80,12
buffer_load_dwordx4 v20, s[20:23], s54 offen offset:2048 lds
s_waitcnt lgkmcnt(5)
MAA 244,80,16
TR 114,25,51232
s_add_u32 s54, s54, 196608
MAA 244,84,36
TR 116,25,63136
s_add_u32 m0, s59, 0
MAA 156,92,36
TR 118,25,63648
s_xor_b32 s58, s87, 1048576
MAA 156,88,16
buffer_load_dwordx4 v5, s[24:27], s58 offen lds
MAA 104,88,12
TR 120,25,51744
MAA 104,92,32
TR 122,25,52256
MAA 100,92,28
buffer_load_dwordx4 v6, s[24:27], s58 offen offset:1024 lds
MAA 100,88,8
TR 124,25,64160
s_add_u32 m0, s59, 8320
MAA 96,88,4
TR 126,25,64672
s_xor_b32 s58, s87, 1179648
MAA 96,92,24
buffer_load_dwordx4 v5, s[24:27], s58 offen lds
MAA 92,92,20
RD 40,23,18496
MAA 92,88,0
RD 44,23,20800
MAA 124,0,96
buffer_load_dwordx4 v6, s[24:27], s58 offen offset:1024 lds
MAA 124,20,100
RD 48,23,23104
MAA 128,24,100
RD 52,23,25408
MAA 128,4,96
RD 56,24,18496
MAA 132,8,96
MAA 132,28,100
MAA 136,32,100
MAA 136,12,96
s_waitcnt vmcnt(17) lgkmcnt(5)
s_barrier
MAA 76,104,0
RD 60,30,18496
s_add_u32 m0, s56, 123648
MAA 76,108,20
buffer_load_dwordx4 v18, s[20:23], s54 offen lds
MAA 80,108,24
RD 64,30,20800
s_waitcnt vmcnt(14)
v_add_f32 v164, v164, v192
MAA 80,104,4
RD 68,30,23104
v_add_f32 v165, v165, v193
MAA 84,104,8
RD 72,30,25408
v_add_f32 v166, v166, v194
MAA 84,108,28
RD 76,31,18496
v_add_f32 v167, v167, v195
MAA 88,108,32
ds_read_b64_tr_b16 a[80:81], v25
MAA 88,104,12
TR 82,25,512
MAA 160,112,16
TR 84,25,12416
MAA 160,116,36
buffer_load_dwordx4 v19, s[20:23], s54 offen offset:1024 lds
MAA 120,116,32
TR 86,25,12928
MAA 120,112,12
TR 88,25,1024
MAA 116,112,8
TR 90,25,1536
MAA 116,116,28
TR 92,25,13440
MAA 112,116,24
TR 94,25,13952
MAA 112,112,4
TR 96,25,2048
MAA 108,112,0
TR 98,25,2560
MAA 108,116,20
buffer_load_dwordx4 v20, s[20:23], s54 offen offset:2048 lds
MAA 140,20,124
TR 100,25,14464
s_add_u32 s54, s54, 196608
MAA 140,0,120
TR 102,25,14976
MAA 144,4,120
MAA 144,24,124
MAA 148,28,124
MAA 148,8,120
MAA 152,12,120
MAA 152,32,124
s_waitcnt lgkmcnt(8)
s_barrier
MAA 60,80,40
TR 104,25,32
s_add_u32 m0, s56, 136064
MAA 60,84,60
buffer_load_dwordx4 v18, s[20:23], s54 offen lds
MAA 64,84,64
TR 106,25,544
MAA 64,80,44
TR 108,25,12448
MAA 68,80,48
buffer_load_dwordx4 v19, s[20:23], s54 offen offset:1024 lds
MAA 68,84,68
TR 110,25,12960
MAA 72,84,72
TR 112,25,1056
MAA 72,80,52
buffer_load_dwordx4 v20, s[20:23], s54 offen offset:2048 lds
s_waitcnt lgkmcnt(5)
MAA 244,80,56
TR 114,25,1568
s_add_u32 s54, s54, 196608
MAA 244,84,76
TR 116,25,13472
s_add_u32 m0, s59, 16640
MAA 156,92,76
TR 118,25,13984
s_xor_b32 s58, s87, 1310720
MAA 156,88,56
buffer_load_dwordx4 v5, s[24:27], s58 offen lds
MAA 104,88,52
TR 120,25,2080
MAA 104,92,72
TR 122,25,2592
MAA 100,92,68
buffer_load_dwordx4 v6, s[24:27], s58 offen offset:1024 lds
MAA 100,88,48
TR 124,25,14496
s_add_u32 m0, s59, 24960
MAA 96,88,44
TR 126,25,15008
s_xor_b32 s58, s87, 1441792
MAA 96,92,64
buffer_load_dwordx4 v5, s[24:27], s58 offen lds
MAA 92,92,60
RD 0,23,36992
MAA 92,88,40
RD 4,23,39296
MAA 124,40,96
buffer_load_dwordx4 v6, s[24:27], s58 offen offset:1024 lds
MAA 124,60,100
RD 8,23,41600
MAA 128,64,100
RD 12,23,43904
MAA 128,44,96
RD 16,24,36992
MAA 132,48,96
v_permlane32_swap_b32 v164, v166
MAA 132,68,100
v_permlane32_swap_b32 v165, v167
MAA 136,72,100
v_add_f32 v164, v164, v166
v_add_f32 v165, v165, v167
MAA 136,52,96
v_mul_f32 v164, 0xba800000, v164
v_mul_f32 v165, 0x3a800000, v165
v_fma_f32 v165, -v164, v164, v165
v_max_f32 v165, 0, v165
v_add_f32 v165, 0x3727c5ac, v165
v_rsq_f32 v166, v165
s_nop 0
v_mov_b32 v165, v166
v_mul_f32 v166, 0x3e8293ee, v166
s_waitcnt vmcnt(14) lgkmcnt(5)
s_barrier
MAA 76,104,40
ds_write_b128 v7, v[164:167]
s_add_u32 m0, s59, 74880
MAA 76,108,60
.Lpad4:
s_cbranch_execz .Lpad8
ds_write_b32 v17, v164
s_xor_b32 s58, s87, 131072
MAA 80,108,64
ds_write_b32 v17, v165 offset:1024
MAA 80,104,44
buffer_load_dwordx4 v5, s[24:27], s58 offen lds
MAA 84,104,48
RD 20,30,36992
MAA 84,108,68
RD 24,30,39296
MAA 88,108,72
RD 28,30,41600
MAA 88,104,52
RD 32,30,43904
MAA 160,112,56
RD 36,31,36992
MAA 160,116,76
buffer_load_dwordx4 v6, s[24:27], s58 offen offset:1024 lds
MAA 120,116,72
TR 80,25,24832
s_add_u32 m0, s59, 83200
MAA 120,112,52
TR 82,25,25344
s_xor_b32 s58, s87, 262144
MAA 116,112,48
TR 84,25,37248
MAA 116,116,68
TR 86,25,37760
MAA 112,116,64
TR 88,25,25856
MAA 112,112,44
buffer_load_dwordx4 v5, s[24:27], s58 offen lds
MAA 108,112,40
TR 90,25,26368
MAA 108,116,60
TR 92,25,38272
MAA 140,60,124
TR 94,25,38784
MAA 140,40,120
TR 96,25,26880
MAA 144,44,120
TR 98,25,27392
MAA 144,64,124
buffer_load_dwordx4 v6, s[24:27], s58 offen offset:1024 lds
MAA 148,68,124
TR 100,25,39296
MAA 148,48,120
TR 102,25,39808
MAA 152,52,120
MAA 152,72,124
s_waitcnt vmcnt(8) lgkmcnt(0)
s_barrier
MAA 156,88,16
TR 112,25,25888
s_add_u32 m0, s59, 33280
MAA 156,92,36
TR 114,25,26400
s_xor_b32 s58, s87, 1572864
MAA 104,92,32
buffer_load_dwordx4 v5, s[24:27], s58 offen lds
MAA 104,88,12
TR 116,25,38304
MAA 100,88,8
TR 118,25,38816
MAA 100,92,28
TR 120,25,26912
MAA 96,92,24
buffer_load_dwordx4 v6, s[24:27], s58 offen offset:1024 lds
MAA 96,88,4
TR 122,25,27424
s_add_u32 m0, s59, 41600
MAA 92,88,0
TR 124,25,39328
s_xor_b32 s58, s87, 1703936
MAA 92,92,20
TR 126,25,39840
MAA 136,32,100
buffer_load_dwordx4 v5, s[24:27], s58 offen lds
MAA 136,12,96
TR 104,25,24864
MAA 244,80,16
TR 106,25,25376
MAA 244,84,36
TR 108,25,37280
MAA 72,84,32
buffer_load_dwordx4 v6, s[24:27], s58 offen offset:1024 lds
MAA 72,80,12
TR 110,25,37792
MAA 68,80,8
RD 40,23,55488
MAA 68,84,28
RD 44,23,57792
MAA 64,84,24
RD 48,23,60096
MAA 64,80,4
RD 52,23,62400
MAA 60,80,0
RD 56,24,55488
MAA 60,84,20
RD 60,30,55488
s_waitcnt lgkmcnt(15)
MAA 160,112,16
RD 64,30,57792
s_waitcnt lgkmcnt(15)
MAA 160,116,36
s_waitcnt lgkmcnt(7)
s_barrier
RD 68,30,60096
MAA 120,116,32
RD 72,30,62400
s_add_u32 m0, s59, 91520
MAA 120,112,12
RD 76,31,55488
s_xor_b32 s58, s87, 393216
MAA 116,112,8
TR 144,25,50688
MAA 116,116,28
TR 146,25,51200
MAA 112,116,24
TR 148,25,63104
MAA 112,112,4
TR 150,25,63616
MAA 108,112,0
TR 152,25,50720
MAA 108,116,20
TR 154,25,51232
MAA 152,32,124
TR 156,25,63136
MAA 152,12,120
TR 158,25,63648
MAA 88,104,12
TR 160,25,51712
MAA 88,108,32
TR 162,25,52224
MAA 84,108,28
TR 164,25,64128
MAA 84,104,8
TR 166,25,64640
MAA 80,104,4
TR 168,25,51744
MAA 80,108,24
TR 170,25,52256
MAA 76,108,20
TR 172,25,64160
MAA 76,104,0
TR 174,25,64672
s_waitcnt lgkmcnt(14)
MAA 156,144,56
TR 128,25,49664
s_waitcnt lgkmcnt(13)
MAA 156,148,76
TR 130,25,50176
MAA 104,148,72
TR 132,25,62080
MAA 104,144,52
TR 134,25,62592
MAA 100,144,48
TR 136,25,49696
MAA 100,148,68
TR 138,25,50208
MAA 96,148,64
TR 140,25,62112
MAA 96,144,44
TR 142,25,62624
MAA 92,144,40
ds_read_b128 v[232:235], v10 offset:768
MAA 92,148,60
ds_read_b128 v[236:239], v10 offset:2816
s_waitcnt lgkmcnt(15)
MAA 160,156,76
ds_read_b128 v[228:231], v10 offset:512
MAA 160,152,56
ds_read_b128 v[224:227], v10 offset:256
MAA 120,152,52
ds_read_b128 v[220:223], v10
MAA 120,156,72
buffer_load_dwordx4 v5, s[24:27], s58 offen lds
MAA 116,156,68
MAA 116,152,48
s_waitcnt lgkmcnt(5)
s_barrier
MAA 112,152,44
MAA 112,156,64
buffer_load_dwordx4 v6, s[24:27], s58 offen offset:1024 lds
MAA 108,156,60
s_add_u32 m0, s59, 99840
s_xor_b32 s58, s87, 524288
MAA 108,152,40
MAA 136,52,160
MAA 136,72,164
buffer_load_dwordx4 v5, s[24:27], s58 offen lds
MAA 152,72,172
MAA 152,52,168
MAA 244,128,56
MAA 244,132,76
buffer_load_dwordx4 v6, s[24:27], s58 offen offset:1024 lds
MAA 72,132,72
s_add_u32 m0, s59, 108160
s_xor_b32 s58, s87, 655360
MAA 72,128,52
MAA 68,128,48
MAA 68,132,68
buffer_load_dwordx4 v5, s[24:27], s58 offen lds
buffer_load_dwordx4 v6, s[24:27], s58 offen offset:1024 lds
s_mov_b32 exec_lo, 0x10001
s_mov_b32 exec_hi, 0x10001
ds_write_b128 v13, v[244:247]
ds_write_b128 v13, v[156:159] offset:256
ds_write_b128 v13, v[160:163] offset:320
s_mov_b64 exec, -1
MAA 64,128,44
MAA 64,132,64
MAA 60,132,60
MAA 60,128,40
MAA 88,136,52
MAA 88,140,72
s_waitcnt lgkmcnt(0)
s_barrier
MAA 84,136,48
ds_read_b128 v[28:31], v13
s_add_u32 m0, s59, 49920
MAA 84,140,68
ds_read_b128 v[32:35], v13 offset:64
s_xor_b32 s58, s87, 1835008
MAA 80,140,64
ds_read_b128 v[36:39], v13 offset:256
MAA 80,136,44
ds_read_b128 v[40:43], v13 offset:320
MAA 76,136,40
ds_read_b32 v44, v12 offset:512
MAA 76,140,60
ds_read_b32 v45, v12 offset:576
ds_read_b128 v[240:243], v11 offset:192
ds_read_b128 v[244:247], v11 offset:1216
ds_read_b128 v[18:21], v11 offset:128
ds_read_b128 v[22:25], v11 offset:1152
buffer_load_dwordx4 v5, s[24:27], s58 offen lds
s_waitcnt lgkmcnt(9)
v_pk_fma_f32 v[72:73], v[28:29], v[232:233], v[72:73] op_sel_hi:[1,0,1]
v_cvt_pk_bf16_f32 v176, v72, v73
v_pk_fma_f32 v[74:75], v[30:31], v[232:233], v[74:75] op_sel_hi:[1,0,1]
v_cvt_pk_bf16_f32 v177, v74, v75
s_waitcnt lgkmcnt(8)
v_pk_fma_f32 v[88:89], v[32:33], v[232:233], v[88:89] op_sel_hi:[1,0,1]
v_cvt_pk_bf16_f32 v178, v88, v89
v_pk_fma_f32 v[90:91], v[34:35], v[232:233], v[90:91] op_sel_hi:[1,0,1]
s_waitcnt lgkmcnt(7)
v_pk_fma_f32 v[104:105], v[36:37], v[232:233], v[104:105] op_sel_hi:[1,0,1]
v_pk_mul_f32 v[104:105], v[104:105], v[232:233] op_sel:[0,1] op_sel_hi:[1,1]
v_cvt_pk_bf16_f32 v196, v104, v105
v_pk_fma_f32 v[106:107], v[38:39], v[232:233], v[106:107] op_sel_hi:[1,0,1]
v_pk_mul_f32 v[106:107], v[106:107], v[232:233] op_sel:[0,1] op_sel_hi:[1,1]
v_cvt_pk_bf16_f32 v197, v106, v107
s_waitcnt lgkmcnt(6)
v_pk_fma_f32 v[120:121], v[40:41], v[232:233], v[120:121] op_sel_hi:[1,0,1]
v_pk_mul_f32 v[120:121], v[120:121], v[232:233] op_sel:[0,1] op_sel_hi:[1,1]
v_cvt_pk_bf16_f32 v198, v120, v121
v_pk_fma_f32 v[122:123], v[42:43], v[232:233], v[122:123] op_sel_hi:[1,0,1]
v_pk_mul_f32 v[122:123], v[122:123], v[232:233] op_sel:[0,1] op_sel_hi:[1,1]
v_cvt_pk_bf16_f32 v199, v122, v123
ds_write_b128 v8, v[196:199]
s_waitcnt lgkmcnt(4)
v_pk_fma_f32 v[136:137], v[240:241], v[44:45], v[136:137] op_sel_hi:[1,0,1]
v_pk_fma_f32 v[138:139], v[242:243], v[44:45], v[138:139] op_sel_hi:[1,0,1]
s_waitcnt lgkmcnt(3)
v_pk_mul_f32 v[136:137], v[136:137], v[244:245]
v_cvt_pk_bf16_f32 v208, v136, v137
v_pk_mul_f32 v[138:139], v[138:139], v[246:247]
v_cvt_pk_bf16_f32 v209, v138, v139
v_pk_fma_f32 v[152:153], v[240:241], v[44:45], v[152:153] op_sel:[0,1,0] op_sel_hi:[1,1,1]
v_pk_mul_f32 v[152:153], v[152:153], v[244:245]
v_cvt_pk_bf16_f32 v218, v152, v153
v_pk_fma_f32 v[154:155], v[242:243], v[44:45], v[154:155] op_sel:[0,1,0] op_sel_hi:[1,1,1]
v_pk_mul_f32 v[154:155], v[154:155], v[246:247]
v_cvt_pk_bf16_f32 v219, v154, v155
ds_write_b64 v8, v[208:209] offset:1024
ds_write_b64 v8, v[218:219] offset:1032
v_pk_fma_f32 v[156:157], v[36:37], v[236:237], v[156:157] op_sel_hi:[1,0,1]
v_pk_mul_f32 v[156:157], v[156:157], v[236:237] op_sel:[0,1] op_sel_hi:[1,1]
v_cvt_pk_bf16_f32 v180, v156, v157
v_pk_fma_f32 v[158:159], v[38:39], v[236:237], v[158:159] op_sel_hi:[1,0,1]
v_pk_mul_f32 v[158:159], v[158:159], v[236:237] op_sel:[0,1] op_sel_hi:[1,1]
v_cvt_pk_bf16_f32 v181, v158, v159
v_pk_fma_f32 v[160:161], v[40:41], v[236:237], v[160:161] op_sel_hi:[1,0,1]
v_pk_mul_f32 v[160:161], v[160:161], v[236:237] op_sel:[0,1] op_sel_hi:[1,1]
v_cvt_pk_bf16_f32 v182, v160, v161
v_pk_fma_f32 v[162:163], v[42:43], v[236:237], v[162:163] op_sel_hi:[1,0,1]
v_pk_mul_f32 v[162:163], v[162:163], v[236:237] op_sel:[0,1] op_sel_hi:[1,1]
v_cvt_pk_bf16_f32 v183, v162, v163
v_pk_fma_f32 v[100:101], v[36:37], v[228:229], v[100:101] op_sel_hi:[1,0,1]
v_pk_mul_f32 v[100:101], v[100:101], v[228:229] op_sel:[0,1] op_sel_hi:[1,1]
v_cvt_pk_bf16_f32 v192, v100, v101
v_pk_fma_f32 v[102:103], v[38:39], v[228:229], v[102:103] op_sel_hi:[1,0,1]
v_pk_mul_f32 v[102:103], v[102:103], v[228:229] op_sel:[0,1] op_sel_hi:[1,1]
v_cvt_pk_bf16_f32 v193, v102, v103
v_pk_fma_f32 v[116:117], v[40:41], v[228:229], v[116:117] op_sel_hi:[1,0,1]
v_pk_mul_f32 v[116:117], v[116:117], v[228:229] op_sel:[0,1] op_sel_hi:[1,1]
v_cvt_pk_bf16_f32 v194, v116, v117
v_pk_fma_f32 v[118:119], v[42:43], v[228:229], v[118:119] op_sel_hi:[1,0,1]
v_pk_mul_f32 v[118:119], v[118:119], v[228:229] op_sel:[0,1] op_sel_hi:[1,1]
s_waitcnt lgkmcnt(0)
s_barrier
v_cvt_pk_bf16_f32 v195, v118, v119
v_pk_fma_f32 v[96:97], v[36:37], v[224:225], v[96:97] op_sel_hi:[1,0,1]
v_pk_mul_f32 v[96:97], v[96:97], v[224:225] op_sel:[0,1] op_sel_hi:[1,1]
v_cvt_pk_bf16_f32 v188, v96, v97
v_pk_fma_f32 v[98:99], v[38:39], v[224:225], v[98:99] op_sel_hi:[1,0,1]
v_pk_mul_f32 v[98:99], v[98:99], v[224:225] op_sel:[0,1] op_sel_hi:[1,1]
v_cvt_pk_bf16_f32 v189, v98, v99
v_pk_fma_f32 v[112:113], v[40:41], v[224:225], v[112:113] op_sel_hi:[1,0,1]
v_pk_mul_f32 v[112:113], v[112:113], v[224:225] op_sel:[0,1] op_sel_hi:[1,1]
v_cvt_pk_bf16_f32 v190, v112, v113
v_pk_fma_f32 v[114:115], v[42:43], v[224:225], v[114:115] op_sel_hi:[1,0,1]
v_pk_mul_f32 v[114:115], v[114:115], v[224:225] op_sel:[0,1] op_sel_hi:[1,1]
v_cvt_pk_bf16_f32 v191, v114, v115
v_pk_fma_f32 v[92:93], v[36:37], v[220:221], v[92:93] op_sel_hi:[1,0,1]
v_pk_mul_f32 v[92:93], v[92:93], v[220:221] op_sel:[0,1] op_sel_hi:[1,1]
v_cvt_pk_bf16_f32 v184, v92, v93
v_pk_fma_f32 v[94:95], v[38:39], v[220:221], v[94:95] op_sel_hi:[1,0,1]
v_pk_mul_f32 v[94:95], v[94:95], v[220:221] op_sel:[0,1] op_sel_hi:[1,1]
v_cvt_pk_bf16_f32 v185, v94, v95
v_pk_fma_f32 v[108:109], v[40:41], v[220:221], v[108:109] op_sel_hi:[1,0,1]
v_pk_mul_f32 v[108:109], v[108:109], v[220:221] op_sel:[0,1] op_sel_hi:[1,1]
v_cvt_pk_bf16_f32 v186, v108, v109
v_pk_fma_f32 v[110:111], v[42:43], v[220:221], v[110:111] op_sel_hi:[1,0,1]
v_pk_mul_f32 v[110:111], v[110:111], v[220:221] op_sel:[0,1] op_sel_hi:[1,1]
v_cvt_pk_bf16_f32 v187, v110, v111
v_cvt_pk_bf16_f32 v179, v90, v91
v_pk_fma_f32 v[68:69], v[28:29], v[228:229], v[68:69] op_sel_hi:[1,0,1]
v_cvt_pk_bf16_f32 v172, v68, v69
v_pk_fma_f32 v[70:71], v[30:31], v[228:229], v[70:71] op_sel_hi:[1,0,1]
v_cvt_pk_bf16_f32 v173, v70, v71
v_pk_fma_f32 v[84:85], v[32:33], v[228:229], v[84:85] op_sel_hi:[1,0,1]
v_cvt_pk_bf16_f32 v174, v84, v85
v_pk_fma_f32 v[86:87], v[34:35], v[228:229], v[86:87] op_sel_hi:[1,0,1]
v_cvt_pk_bf16_f32 v175, v86, v87
v_pk_fma_f32 v[64:65], v[28:29], v[224:225], v[64:65] op_sel_hi:[1,0,1]
v_cvt_pk_bf16_f32 v168, v64, v65
v_pk_fma_f32 v[66:67], v[30:31], v[224:225], v[66:67] op_sel_hi:[1,0,1]
v_cvt_pk_bf16_f32 v169, v66, v67
v_pk_fma_f32 v[80:81], v[32:33], v[224:225], v[80:81] op_sel_hi:[1,0,1]
v_cvt_pk_bf16_f32 v170, v80, v81
v_pk_fma_f32 v[82:83], v[34:35], v[224:225], v[82:83] op_sel_hi:[1,0,1]
v_cvt_pk_bf16_f32 v171, v82, v83
v_pk_fma_f32 v[60:61], v[28:29], v[220:221], v[60:61] op_sel_hi:[1,0,1]
v_cvt_pk_bf16_f32 v164, v60, v61
v_pk_fma_f32 v[62:63], v[30:31], v[220:221], v[62:63] op_sel_hi:[1,0,1]
v_cvt_pk_bf16_f32 v165, v62, v63
v_pk_fma_f32 v[76:77], v[32:33], v[220:221], v[76:77] op_sel_hi:[1,0,1]
v_cvt_pk_bf16_f32 v166, v76, v77
v_pk_fma_f32 v[78:79], v[34:35], v[220:221], v[78:79] op_sel_hi:[1,0,1]
v_cvt_pk_bf16_f32 v167, v78, v79
s_nop 0
v_mfma_f32_16x16x32_bf16 v[120:123], v[196:199], v[176:179], v[50:53]
buffer_load_dwordx4 v6, s[24:27], s58 offen offset:1024 lds
v_mfma_f32_16x16x32_bf16 v[104:107], v[192:195], v[176:179], v[46:49]
ds_read_b64 v[200:201], v9 offset:1024
s_add_u32 m0, s59, 58240
v_mfma_f32_16x16x32_bf16 v[116:119], v[192:195], v[172:175], v[50:53]
ds_read_b64 v[210:211], v9 offset:1032
s_xor_b32 s58, s87, 1966080
v_mfma_f32_16x16x32_bf16 v[100:103], v[188:191], v[172:175], v[46:49]
ds_read_b128 v[240:243], v11 offset:64
v_mfma_f32_16x16x32_bf16 v[112:115], v[188:191], v[168:171], v[50:53]
buffer_load_dwordx4 v5, s[24:27], s58 offen lds
v_mfma_f32_16x16x32_bf16 v[96:99], v[184:187], v[168:171], v[46:49]
ds_read_b128 v[244:247], v11 offset:1088
v_max3_f32 v88, v104, v105, v106
v_mfma_f32_16x16x32_bf16 v[108:111], v[184:187], v[164:167], v[50:53]
ds_read_b128 v[28:31], v11
v_max3_f32 v89, v107, v120, v121
v_mfma_f32_16x16x32_bf16 v[92:95], v[180:183], v[164:167], v[54:57]
ds_read_b128 v[32:35], v11 offset:1024
v_max3_f32 v88, v88, v122, v123
MAA 132,8,96
buffer_load_dwordx4 v6, s[24:27], s58 offen offset:1024 lds
MAA 132,28,100
s_add_u32 m0, s59, 66560
s_xor_b32 s58, s87, 0
v_max_f32 v90, v88, v89
MAA 132,48,160
v_max_f32 v89, v88, v89
v_max3_f32 v84, v100, v101, v102
MAA 132,68,164
v_permlane16_swap_b32 v90, v89
MAA 148,68,172
buffer_load_dwordx4 v5, s[24:27], s58 offen lds
MAA 148,48,168
v_max_f32 v88, v90, v89
v_max_f32 v89, v90, v89
MAA 148,28,124
s_nop 0
v_permlane32_swap_b32 v88, v89
MAA 148,8,120
v_max_f32 v88, v88, v89
v_mul_f32 v88, v88, v234
v_max3_f32 v85, v103, v116, v117
v_max3_f32 v84, v84, v118, v119
v_max_f32 v86, v84, v85
v_max_f32 v85, v84, v85
v_max3_f32 v80, v96, v97, v98
v_max3_f32 v81, v99, v112, v113
v_permlane16_swap_b32 v86, v85
v_max3_f32 v80, v80, v114, v115
v_max_f32 v84, v86, v85
v_max_f32 v85, v86, v85
v_max_f32 v82, v80, v81
v_max_f32 v81, v80, v81
v_permlane32_swap_b32 v84, v85
v_max3_f32 v76, v92, v93, v94
v_max_f32 v84, v84, v85
v_mul_f32 v84, v84, v230
v_permlane16_swap_b32 v82, v81
v_max3_f32 v77, v95, v108, v109
v_max_f32 v80, v82, v81
v_max_f32 v81, v82, v81
v_max3_f32 v76, v76, v110, v111
v_max_f32 v78, v76, v77
v_permlane32_swap_b32 v80, v81
v_max_f32 v77, v76, v77
v_max_f32 v80, v80, v81
v_mul_f32 v80, v80, v226
v_permlane16_swap_b32 v78, v77
v_pk_fma_f32 v[104:105], v[104:105], v[234:235], v[88:89] op_sel_hi:[1,0,0] neg_lo:[0,0,1] neg_hi:[0,0,1]
v_max_f32 v76, v78, v77
v_max_f32 v77, v78, v77
v_pk_fma_f32 v[106:107], v[106:107], v[234:235], v[88:89] op_sel_hi:[1,0,0] neg_lo:[0,0,1] neg_hi:[0,0,1]
v_pk_fma_f32 v[120:121], v[120:121], v[234:235], v[88:89] op_sel_hi:[1,0,0] neg_lo:[0,0,1] neg_hi:[0,0,1]
v_permlane32_swap_b32 v76, v77
v_pk_fma_f32 v[122:123], v[122:123], v[234:235], v[88:89] op_sel_hi:[1,0,0] neg_lo:[0,0,1] neg_hi:[0,0,1]
v_max_f32 v76, v76, v77
v_mul_f32 v76, v76, v222
v_pk_fma_f32 v[100:101], v[100:101], v[230:231], v[84:85] op_sel_hi:[1,0,0] neg_lo:[0,0,1] neg_hi:[0,0,1]
v_pk_fma_f32 v[102:103], v[102:103], v[230:231], v[84:85] op_sel_hi:[1,0,0] neg_lo:[0,0,1] neg_hi:[0,0,1]
v_pk_fma_f32 v[116:117], v[116:117], v[230:231], v[84:85] op_sel_hi:[1,0,0] neg_lo:[0,0,1] neg_hi:[0,0,1]
v_pk_fma_f32 v[118:119], v[118:119], v[230:231], v[84:85] op_sel_hi:[1,0,0] neg_lo:[0,0,1] neg_hi:[0,0,1]
v_pk_fma_f32 v[96:97], v[96:97], v[226:227], v[80:81] op_sel_hi:[1,0,0] neg_lo:[0,0,1] neg_hi:[0,0,1]
v_pk_fma_f32 v[98:99], v[98:99], v[226:227], v[80:81] op_sel_hi:[1,0,0] neg_lo:[0,0,1] neg_hi:[0,0,1]
v_pk_fma_f32 v[112:113], v[112:113], v[226:227], v[80:81] op_sel_hi:[1,0,0] neg_lo:[0,0,1] neg_hi:[0,0,1]
v_pk_fma_f32 v[114:115], v[114:115], v[226:227], v[80:81] op_sel_hi:[1,0,0] neg_lo:[0,0,1] neg_hi:[0,0,1]
v_pk_fma_f32 v[92:93], v[92:93], v[222:223], v[76:77] op_sel_hi:[1,0,0] neg_lo:[0,0,1] neg_hi:[0,0,1]
v_pk_fma_f32 v[94:95], v[94:95], v[222:223], v[76:77] op_sel_hi:[1,0,0] neg_lo:[0,0,1] neg_hi:[0,0,1]
v_pk_fma_f32 v[108:109], v[108:109], v[222:223], v[76:77] op_sel_hi:[1,0,0] neg_lo:[0,0,1] neg_hi:[0,0,1]
v_pk_fma_f32 v[110:111], v[110:111], v[222:223], v[76:77] op_sel_hi:[1,0,0] neg_lo:[0,0,1] neg_hi:[0,0,1]
v_pk_fma_f32 v[132:133], v[18:19], v[44:45], v[132:133] op_sel_hi:[1,0,1]
v_pk_mul_f32 v[132:133], v[132:133], v[22:23]
v_pk_fma_f32 v[134:135], v[20:21], v[44:45], v[134:135] op_sel_hi:[1,0,1]
v_pk_mul_f32 v[134:135], v[134:135], v[24:25]
v_pk_fma_f32 v[148:149], v[18:19], v[44:45], v[148:149] op_sel:[0,1,0] op_sel_hi:[1,1,1]
v_pk_mul_f32 v[148:149], v[148:149], v[22:23]
v_pk_fma_f32 v[150:151], v[20:21], v[44:45], v[150:151] op_sel:[0,1,0] op_sel_hi:[1,1,1]
v_pk_mul_f32 v[150:151], v[150:151], v[24:25]
v_exp_f32 v104, v104
s_nop 0
MAA 128,4,96
buffer_load_dwordx4 v6, s[24:27], s58 offen offset:1024 lds
MAA 128,24,100
s_add_u32 m0, s59, 116480
s_xor_b32 s58, s87, 786432
v_exp_f32 v105, v105
MAA 128,44,160
v_exp_f32 v106, v106
MAA 128,64,164
v_exp_f32 v107, v107
MAA 144,64,172
buffer_load_dwordx4 v5, s[24:27], s58 offen lds
MAA 144,44,168
v_exp_f32 v120, v120
MAA 144,24,124
v_exp_f32 v121, v121
MAA 144,4,120
v_exp_f32 v122, v122
MAA 124,0,96
buffer_load_dwordx4 v6, s[24:27], s58 offen offset:1024 lds
MAA 124,20,100
s_add_u32 m0, s59, 124800
s_xor_b32 s58, s87, 917504
v_exp_f32 v123, v123
MAA 124,40,160
v_exp_f32 v100, v100
MAA 124,60,164
v_exp_f32 v101, v101
MAA 140,60,172
buffer_load_dwordx4 v5, s[24:27], s58 offen lds
MAA 140,40,168
v_exp_f32 v102, v102
MAA 140,20,124
v_exp_f32 v103, v103
MAA 140,0,120
v_cvt_pk_bf16_f32 v72, v104, v105
v_cvt_pk_bf16_f32 v73, v106, v107
v_cvt_pk_bf16_f32 v74, v120, v121
v_cvt_pk_bf16_f32 v75, v122, v123
v_exp_f32 v116, v116
v_exp_f32 v117, v117
v_exp_f32 v118, v118
v_exp_f32 v119, v119
v_cvt_pk_bf16_f32 v68, v100, v101
v_cvt_pk_bf16_f32 v69, v102, v103
v_cvt_pk_bf16_f32 v70, v116, v117
v_cvt_pk_bf16_f32 v71, v118, v119
v_exp_f32 v96, v96
v_exp_f32 v97, v97
v_exp_f32 v98, v98
v_exp_f32 v99, v99
v_exp_f32 v112, v112
v_exp_f32 v113, v113
v_exp_f32 v114, v114
v_exp_f32 v115, v115
v_cvt_pk_bf16_f32 v64, v96, v97
v_cvt_pk_bf16_f32 v65, v98, v99
v_cvt_pk_bf16_f32 v66, v112, v113
v_cvt_pk_bf16_f32 v67, v114, v115
v_cvt_pk_bf16_f32 v206, v132, v133
v_cvt_pk_bf16_f32 v207, v134, v135
v_cvt_pk_bf16_f32 v216, v148, v149
v_cvt_pk_bf16_f32 v217, v150, v151
s_waitcnt lgkmcnt(3)
v_pk_fma_f32 v[128:129], v[240:241], v[44:45], v[128:129] op_sel_hi:[1,0,1]
s_waitcnt lgkmcnt(2)
v_pk_mul_f32 v[128:129], v[128:129], v[244:245]
v_cvt_pk_bf16_f32 v204, v128, v129
v_pk_fma_f32 v[130:131], v[242:243], v[44:45], v[130:131] op_sel_hi:[1,0,1]
v_pk_mul_f32 v[130:131], v[130:131], v[246:247]
v_cvt_pk_bf16_f32 v205, v130, v131
v_pk_fma_f32 v[144:145], v[240:241], v[44:45], v[144:145] op_sel:[0,1,0] op_sel_hi:[1,1,1]
v_pk_mul_f32 v[144:145], v[144:145], v[244:245]
v_cvt_pk_bf16_f32 v214, v144, v145
v_pk_fma_f32 v[146:147], v[242:243], v[44:45], v[146:147] op_sel:[0,1,0] op_sel_hi:[1,1,1]
v_pk_mul_f32 v[146:147], v[146:147], v[246:247]
v_cvt_pk_bf16_f32 v215, v146, v147
s_waitcnt lgkmcnt(1)
v_pk_fma_f32 v[124:125], v[28:29], v[44:45], v[124:125] op_sel_hi:[1,0,1]
s_waitcnt lgkmcnt(0)
v_pk_mul_f32 v[124:125], v[124:125], v[32:33]
v_cvt_pk_bf16_f32 v202, v124, v125
v_pk_fma_f32 v[126:127], v[30:31], v[44:45], v[126:127] op_sel_hi:[1,0,1]
v_pk_mul_f32 v[126:127], v[126:127], v[34:35]
v_cvt_pk_bf16_f32 v203, v126, v127
v_pk_fma_f32 v[140:141], v[28:29], v[44:45], v[140:141] op_sel:[0,1,0] op_sel_hi:[1,1,1]
v_pk_mul_f32 v[140:141], v[140:141], v[32:33]
v_cvt_pk_bf16_f32 v212, v140, v141
v_pk_fma_f32 v[142:143], v[30:31], v[44:45], v[142:143] op_sel:[0,1,0] op_sel_hi:[1,1,1]
v_pk_mul_f32 v[142:143], v[142:143], v[34:35]
v_cvt_pk_bf16_f32 v213, v142, v143
s_nop 0
v_mfma_f32_16x16x32_bf16 v[88:91], v[248:251], v[72:75], 0
buffer_load_dwordx4 v6, s[24:27], s58 offen offset:1024 lds
v_mfma_f32_16x16x32_bf16 v[104:107], v[206:209], v[72:75], 0
v_exp_f32 v92, v92
v_mfma_f32_16x16x32_bf16 v[120:123], v[216:219], v[72:75], 0
v_exp_f32 v93, v93
v_mfma_f32_16x16x32_bf16 v[84:87], v[248:251], v[68:71], 0
v_exp_f32 v94, v94
v_mfma_f32_16x16x32_bf16 v[100:103], v[204:207], v[68:71], 0
v_exp_f32 v95, v95
v_mfma_f32_16x16x32_bf16 v[116:119], v[214:217], v[68:71], 0
.Lpad5:
s_cbranch_execz .Lpad9
v_exp_f32 v108, v108
v_mfma_f32_16x16x32_bf16 v[80:83], v[248:251], v[64:67], 0
v_exp_f32 v109, v109
v_mfma_f32_16x16x32_bf16 v[96:99], v[202:205], v[64:67], 0
v_exp_f32 v110, v110
v_mfma_f32_16x16x32_bf16 v[112:115], v[212:215], v[64:67], 0
v_exp_f32 v111, v111
v_cvt_pk_bf16_f32 v60, v92, v93
v_cvt_pk_bf16_f32 v61, v94, v95
v_cvt_pk_bf16_f32 v62, v108, v109
v_cvt_pk_bf16_f32 v63, v110, v111
v_rcp_f32 v88, v88
v_rcp_f32 v84, v84
v_mfma_f32_16x16x32_bf16 v[76:79], v[248:251], v[60:63], 0
v_rcp_f32 v80, v80
v_mfma_f32_16x16x32_bf16 v[92:95], v[200:203], v[60:63], 0
v_mfma_f32_16x16x32_bf16 v[108:111], v[210:213], v[60:63], 0
s_nop 4
v_rcp_f32 v76, v76
v_pk_mul_f32 v[104:105], v[104:105], v[88:89] op_sel_hi:[1,0]
v_pk_mul_f32 v[106:107], v[106:107], v[88:89] op_sel_hi:[1,0]
v_pk_mul_f32 v[120:121], v[120:121], v[88:89] op_sel_hi:[1,0]
v_pk_mul_f32 v[122:123], v[122:123], v[88:89] op_sel_hi:[1,0]
v_cvt_pk_bf16_f32 v176, v104, v105
v_cvt_pk_bf16_f32 v177, v106, v107
v_cvt_pk_bf16_f32 v178, v120, v121
v_cvt_pk_bf16_f32 v179, v122, v123
buffer_store_dwordx4 v[176:179], v4, s[16:19], s74 offen offset:3072 sc1
v_pk_mul_f32 v[100:101], v[100:101], v[84:85] op_sel_hi:[1,0]
v_pk_mul_f32 v[102:103], v[102:103], v[84:85] op_sel_hi:[1,0]
v_pk_mul_f32 v[116:117], v[116:117], v[84:85] op_sel_hi:[1,0]
v_pk_mul_f32 v[118:119], v[118:119], v[84:85] op_sel_hi:[1,0]
v_cvt_pk_bf16_f32 v172, v100, v101
v_cvt_pk_bf16_f32 v173, v102, v103
v_cvt_pk_bf16_f32 v174, v116, v117
v_cvt_pk_bf16_f32 v175, v118, v119
buffer_store_dwordx4 v[172:175], v4, s[16:19], s74 offen offset:2048 sc1
v_pk_mul_f32 v[96:97], v[96:97], v[80:81] op_sel_hi:[1,0]
v_pk_mul_f32 v[98:99], v[98:99], v[80:81] op_sel_hi:[1,0]
v_pk_mul_f32 v[112:113], v[112:113], v[80:81] op_sel_hi:[1,0]
v_pk_mul_f32 v[114:115], v[114:115], v[80:81] op_sel_hi:[1,0]
v_cvt_pk_bf16_f32 v168, v96, v97
v_cvt_pk_bf16_f32 v169, v98, v99
v_cvt_pk_bf16_f32 v170, v112, v113
v_cvt_pk_bf16_f32 v171, v114, v115
buffer_store_dwordx4 v[168:171], v4, s[16:19], s74 offen offset:1024 sc1
v_pk_mul_f32 v[92:93], v[92:93], v[76:77] op_sel_hi:[1,0]
v_pk_mul_f32 v[94:95], v[94:95], v[76:77] op_sel_hi:[1,0]
v_pk_mul_f32 v[108:109], v[108:109], v[76:77] op_sel_hi:[1,0]
v_pk_mul_f32 v[110:111], v[110:111], v[76:77] op_sel_hi:[1,0]
v_cvt_pk_bf16_f32 v164, v92, v93
v_cvt_pk_bf16_f32 v165, v94, v95
v_cvt_pk_bf16_f32 v166, v108, v109
v_cvt_pk_bf16_f32 v167, v110, v111
buffer_store_dwordx4 v[164:167], v4, s[16:19], s74 offen sc1
s_nop 1
s_branch .Lqkve2
.Lx4:
buffer_load_dword v27, v14, s[76:79], 0 offen
s_mov_b32 s76, s98
s_mov_b32 s77, s99
s_mov_b32 s78, s100
v_mov_b32 v14, v15
s_mov_b32 s47, 5
s_branch .Lx4b
.Lx5:
buffer_load_dword v27, v14, s[76:79], 0 offen
s_mov_b32 s76, s98
s_mov_b32 s77, s99
s_mov_b32 s78, s100
v_mov_b32 v14, v15
s_mov_b32 s47, 5
s_branch .Lx5b
.Lx6:
buffer_load_dword v27, v14, s[76:79], 0 offen
s_mov_b32 s76, s98
s_mov_b32 s77, s99
s_mov_b32 s78, s100
v_mov_b32 v14, v15
s_mov_b32 s47, 5
s_branch .Lx6b
.Lx7:
buffer_load_dword v27, v14, s[76:79], 0 offen
s_mov_b32 s76, s98
s_mov_b32 s77, s99
s_mov_b32 s78, s100
v_mov_b32 v14, v15
s_mov_b32 s47, 5
s_branch .Lx7b
.Lsp8:
s_mov_b32 s15, 0
.Lsp8l:
v_mov_b32 v37, 0
buffer_atomic_add v37, v34, s[40:43], 0 offen sc0
s_add_u32 s15, s15, 1
s_cmp_gt_u32 s15, 100000
s_waitcnt vmcnt(0)
s_cbranch_scc1 .Lsp8b
v_cmp_gt_u32 vcc, v35, v37
s_nop 0
s_cbranch_vccnz .Lsp8l
s_branch .Lsp8b
.Lx9:
buffer_load_dword v27, v14, s[76:79], 0 offen
s_mov_b32 s76, s98
s_mov_b32 s77, s99
s_mov_b32 s78, s100
v_mov_b32 v14, v15
s_mov_b32 s47, 5
s_branch .Lx9b
.Lx10:
buffer_load_dword v27, v14, s[76:79], 0 offen
s_mov_b32 s76, s98
s_mov_b32 s77, s99
s_mov_b32 s78, s100
v_mov_b32 v14, v15
s_mov_b32 s47, 5
s_branch .Lx10b
.Lx11:
buffer_load_dword v27, v14, s[76:79], 0 offen
s_mov_b32 s76, s98
s_mov_b32 s77, s99
s_mov_b32 s78, s100
v_mov_b32 v14, v15
s_mov_b32 s47, 5
s_branch .Lx11b
.Lx12:
buffer_load_dword v27, v14, s[76:79], 0 offen
s_mov_b32 s76, s98
s_mov_b32 s77, s99
s_mov_b32 s78, s100
v_mov_b32 v14, v15
s_mov_b32 s47, 5
s_branch .Lx12b
.Lsp13:
s_mov_b32 s15, 0
.Lsp13l:
v_mov_b32 v37, 0
buffer_atomic_add v37, v33, s[16:19], 0 offen sc0
s_add_u32 s15, s15, 1
s_cmp_gt_u32 s15, 100000
s_waitcnt vmcnt(0)
s_cbranch_scc1 .Lsp13b
v_cmp_gt_u32 vcc, v36, v37
s_nop 0
s_cbranch_vccnz .Lsp13l
s_branch .Lsp13b
.Lx14:
buffer_load_dword v27, v14, s[76:79], 0 offen
s_mov_b32 s76, s98
s_mov_b32 s77, s99
s_mov_b32 s78, s100
v_mov_b32 v14, v15
s_mov_b32 s47, 5
s_branch .Lx14b
.Lx15:
buffer_load_dword v27, v14, s[76:79], 0 offen
s_mov_b32 s76, s98
s_mov_b32 s77, s99
s_mov_b32 s78, s100
v_mov_b32 v14, v15
s_mov_b32 s47, 5
s_branch .Lx15b
.Lx16:
buffer_load_dword v27, v14, s[76:79], 0 offen
s_mov_b32 s76, s98
s_mov_b32 s77, s99
s_mov_b32 s78, s100
v_mov_b32 v14, v15
s_mov_b32 s47, 5
s_branch .Lx16b
.Lx17:
buffer_load_dword v27, v14, s[76:79], 0 offen
s_mov_b32 s76, s98
s_mov_b32 s77, s99
s_mov_b32 s78, s100
v_mov_b32 v14, v15
s_mov_b32 s47, 5
s_branch .Lx17b
.Lx19:
buffer_load_dword v27, v14, s[76:79], 0 offen
s_mov_b32 s76, s98
s_mov_b32 s77, s99
s_mov_b32 s78, s100
v_mov_b32 v14, v15
s_mov_b32 s47, 5
s_branch .Lx19b
.Lx20:
buffer_load_dword v27, v14, s[76:79], 0 offen
s_mov_b32 s76, s98
s_mov_b32 s77, s99
s_mov_b32 s78, s100
v_mov_b32 v14, v15
s_mov_b32 s47, 5
s_branch .Lx20b
.Lx21:
buffer_load_dword v27, v14, s[76:79], 0 offen
s_mov_b32 s76, s98
s_mov_b32 s77, s99
s_mov_b32 s78, s100
v_mov_b32 v14, v15
s_mov_b32 s47, 5
s_branch .Lx21b
.Lx22:
buffer_load_dword v27, v14, s[76:79], 0 offen
s_mov_b32 s76, s98
s_mov_b32 s77, s99
s_mov_b32 s78, s100
v_mov_b32 v14, v15
s_mov_b32 s47, 5
s_branch .Lx22b
.Lsp23:
s_mov_b32 s15, 0
.Lsp23l:
v_mov_b32 v37, 0
buffer_atomic_add v37, v34, s[40:43], 0 offen sc0
s_add_u32 s15, s15, 1
s_cmp_gt_u32 s15, 100000
s_waitcnt vmcnt(0)
s_cbranch_scc1 .Lsp23b
v_cmp_gt_u32 vcc, v35, v37
s_nop 0
s_cbranch_vccnz .Lsp23l
s_branch .Lsp23b
.Lx24:
buffer_load_dword v27, v14, s[76:79], 0 offen
s_mov_b32 s76, s98
s_mov_b32 s77, s99
s_mov_b32 s78, s100
v_mov_b32 v14, v15
s_mov_b32 s47, 5
s_branch .Lx24b
.Lx25:
buffer_load_dword v27, v14, s[76:79], 0 offen
s_mov_b32 s76, s98
s_mov_b32 s77, s99
s_mov_b32 s78, s100
v_mov_b32 v14, v15
s_mov_b32 s47, 5
s_branch .Lx25b
.Lx26:
buffer_load_dword v27, v14, s[76:79], 0 offen
s_mov_b32 s76, s98
s_mov_b32 s77, s99
s_mov_b32 s78, s100
v_mov_b32 v14, v15
s_mov_b32 s47, 5
s_branch .Lx26b
.Lx27:
buffer_load_dword v27, v14, s[76:79], 0 offen
s_mov_b32 s76, s98
s_mov_b32 s77, s99
s_mov_b32 s78, s100
v_mov_b32 v14, v15
s_mov_b32 s47, 5
s_branch .Lx27b
.Lsp28:
s_mov_b32 s15, 0
.Lsp28l:
v_mov_b32 v37, 0
buffer_atomic_add v37, v33, s[16:19], 0 offen sc0
s_add_u32 s15, s15, 1
s_cmp_gt_u32 s15, 100000
s_waitcnt vmcnt(0)
s_cbranch_scc1 .Lsp28b
v_cmp_gt_u32 vcc, v36, v37
s_nop 0
s_cbranch_vccnz .Lsp28l
s_branch .Lsp28b
.Lx29:
buffer_load_dword v27, v14, s[76:79], 0 offen
s_mov_b32 s76, s98
s_mov_b32 s77, s99
s_mov_b32 s78, s100
v_mov_b32 v14, v15
s_mov_b32 s47, 5
s_branch .Lx29b
.Lx30:
buffer_load_dword v27, v14, s[76:79], 0 offen
s_mov_b32 s76, s98
s_mov_b32 s77, s99
s_mov_b32 s78, s100
v_mov_b32 v14, v15
s_mov_b32 s47, 5
s_branch .Lx30b
.Lx31:
buffer_load_dword v27, v14, s[76:79], 0 offen
s_mov_b32 s76, s98
s_mov_b32 s77, s99
s_mov_b32 s78, s100
v_mov_b32 v14, v15
s_mov_b32 s47, 5
s_branch .Lx31b
.Lx32:
buffer_load_dword v27, v14, s[76:79], 0 offen
s_mov_b32 s76, s98
s_mov_b32 s77, s99
s_mov_b32 s78, s100
v_mov_b32 v14, v15
s_mov_b32 s47, 5
s_branch .Lx32b
.p2align 12
.Lqkv1:
.Lpad6:
s_cbranch_execz .Lpad10
s_cmp_lt_u32 s14, 16
s_cselect_b32 s62, 0, 4096
v_mov_b32 v231, 1
v_lshlrev_b32 v232, 8, v1
s_waitcnt vmcnt(18)
v_permlane16_swap_b32 v164, v166
v_permlane16_swap_b32 v165, v167
s_waitcnt vmcnt(17)
v_permlane16_swap_b32 v168, v170
v_permlane16_swap_b32 v169, v171
s_waitcnt vmcnt(16)
v_permlane16_swap_b32 v172, v174
v_permlane16_swap_b32 v173, v175
s_waitcnt vmcnt(15)
v_permlane16_swap_b32 v176, v178
v_permlane16_swap_b32 v177, v179
buffer_atomic_add v231, v232, s[40:43], s62 offen
v_lshlrev_b32 v192, 16, v164
v_and_b32 v193, 0xffff0000, v164
v_lshlrev_b32 v194, 16, v165
v_and_b32 v195, 0xffff0000, v165
v_lshlrev_b32 v196, 16, v166
v_and_b32 v197, 0xffff0000, v166
v_lshlrev_b32 v198, 16, v167
v_and_b32 v199, 0xffff0000, v167
v_lshlrev_b32 v200, 16, v168
v_and_b32 v201, 0xffff0000, v168
v_lshlrev_b32 v202, 16, v169
v_and_b32 v203, 0xffff0000, v169
v_lshlrev_b32 v204, 16, v170
v_and_b32 v205, 0xffff0000, v170
v_lshlrev_b32 v206, 16, v171
v_and_b32 v207, 0xffff0000, v171
v_lshlrev_b32 v208, 16, v172
v_and_b32 v209, 0xffff0000, v172
v_lshlrev_b32 v210, 16, v173
v_and_b32 v211, 0xffff0000, v173
v_lshlrev_b32 v212, 16, v174
v_and_b32 v213, 0xffff0000, v174
v_lshlrev_b32 v214, 16, v175
v_and_b32 v215, 0xffff0000, v175
v_lshlrev_b32 v216, 16, v176
v_and_b32 v217, 0xffff0000, v176
v_lshlrev_b32 v218, 16, v177
v_and_b32 v219, 0xffff0000, v177
v_lshlrev_b32 v220, 16, v178
v_and_b32 v221, 0xffff0000, v178
v_lshlrev_b32 v222, 16, v179
v_and_b32 v223, 0xffff0000, v179
s_lshl_b32 s64, s6, 14
s_lshl_b32 s65, s49, 13
s_add_u32 s64, s64, s65
s_lshl_b32 s65, s7, 9
s_add_u32 s64, s64, s65
s_lshl_b32 s65, s48, 8
s_add_u32 s64, s64, s65
s_add_u32 s64, s64, 29360128
v_and_b32 v188, 31, v1
v_lshlrev_b32 v188, 3, v188
v_lshrrev_b32 v189, 5, v1
v_lshl_add_u32 v188, v189, 28, v188
s_lshl_b32 s62, s7, 18
s_add_u32 s62, s62, 0
s_add_u32 s63, s62, 131072
v_pk_mul_f32 v[182:183], v[192:193], v[192:193]
v_pk_mul_f32 v[186:187], v[208:209], v[208:209]
v_pk_fma_f32 v[182:183], v[194:195], v[194:195], v[182:183]
v_pk_add_f32 v[180:181], v[192:193], v[194:195]
v_pk_fma_f32 v[186:187], v[210:211], v[210:211], v[186:187]
v_pk_add_f32 v[184:185], v[208:209], v[210:211]
v_pk_fma_f32 v[182:183], v[196:197], v[196:197], v[182:183]
v_pk_add_f32 v[180:181], v[180:181], v[196:197]
v_pk_fma_f32 v[186:187], v[212:213], v[212:213], v[186:187]
v_pk_add_f32 v[184:185], v[184:185], v[212:213]
v_pk_fma_f32 v[182:183], v[198:199], v[198:199], v[182:183]
v_pk_add_f32 v[180:181], v[180:181], v[198:199]
v_pk_fma_f32 v[186:187], v[214:215], v[214:215], v[186:187]
v_pk_add_f32 v[184:185], v[184:185], v[214:215]
v_pk_fma_f32 v[182:183], v[200:201], v[200:201], v[182:183]
v_pk_add_f32 v[180:181], v[180:181], v[200:201]
v_pk_fma_f32 v[186:187], v[216:217], v[216:217], v[186:187]
v_pk_add_f32 v[184:185], v[184:185], v[216:217]
v_pk_fma_f32 v[182:183], v[202:203], v[202:203], v[182:183]
v_pk_add_f32 v[180:181], v[180:181], v[202:203]
v_pk_fma_f32 v[186:187], v[218:219], v[218:219], v[186:187]
v_pk_add_f32 v[184:185], v[184:185], v[218:219]
v_pk_fma_f32 v[182:183], v[204:205], v[204:205], v[182:183]
v_pk_add_f32 v[180:181], v[180:181], v[204:205]
v_pk_fma_f32 v[186:187], v[220:221], v[220:221], v[186:187]
v_pk_add_f32 v[184:185], v[184:185], v[220:221]
v_pk_fma_f32 v[182:183], v[206:207], v[206:207], v[182:183]
v_pk_add_f32 v[180:181], v[180:181], v[206:207]
v_pk_fma_f32 v[186:187], v[222:223], v[222:223], v[186:187]
v_pk_add_f32 v[184:185], v[184:185], v[222:223]
v_add_f32 v180, v180, v181
v_add_f32 v182, v182, v183
v_add_f32 v184, v184, v185
v_add_f32 v186, v186, v187
s_nop 0
v_permlane16_swap_b32 v180, v184
v_permlane16_swap_b32 v182, v186
v_add_f32 v180, v180, v184
v_add_f32 v182, v182, v186
s_nop 1
v_permlane32_swap_b32 v180, v182
v_add_f32 v180, v180, v182
s_nop 1
v_permlane32_swap_b32 v180, v181
buffer_store_dwordx2 v[180:181], v188, s[16:19], s64 offen sc1
s_lshl_b32 s62, s2, 10
s_add_u32 s62, s62, 31457280
s_cmp_eq_u32 s3, 0
s_cselect_b32 s62, s62, 268435456
buffer_store_dwordx4 v[224:227], v230, s[16:19], s62 offen sc1
v_accvgpr_write_b32 a224, v192
v_accvgpr_write_b32 a225, v193
v_accvgpr_write_b32 a226, v194
v_accvgpr_write_b32 a227, v195
v_accvgpr_write_b32 a228, v196
v_accvgpr_write_b32 a229, v197
v_accvgpr_write_b32 a230, v198
v_accvgpr_write_b32 a231, v199
v_accvgpr_write_b32 a232, v200
v_accvgpr_write_b32 a233, v201
v_accvgpr_write_b32 a234, v202
v_accvgpr_write_b32 a235, v203
v_accvgpr_write_b32 a236, v204
v_accvgpr_write_b32 a237, v205
v_accvgpr_write_b32 a238, v206
v_accvgpr_write_b32 a239, v207
v_accvgpr_write_b32 a240, v208
v_accvgpr_write_b32 a241, v209
v_accvgpr_write_b32 a242, v210
v_accvgpr_write_b32 a243, v211
v_accvgpr_write_b32 a244, v212
v_accvgpr_write_b32 a245, v213
v_accvgpr_write_b32 a246, v214
v_accvgpr_write_b32 a247, v215
v_accvgpr_write_b32 a248, v216
v_accvgpr_write_b32 a249, v217
v_accvgpr_write_b32 a250, v218
v_accvgpr_write_b32 a251, v219
v_accvgpr_write_b32 a252, v220
v_accvgpr_write_b32 a253, v221
v_accvgpr_write_b32 a254, v222
v_accvgpr_write_b32 a255, v223
s_add_u32 m0, s55, 18496
s_nop 0
buffer_load_dwordx4 v21, s[36:39], s52 offen lds
buffer_load_dwordx4 v28, s[36:39], s52 offen offset:1024 lds
buffer_load_dword v22, s[36:39], s52 offen offset:2048 lds
s_add_u32 s52, s52, 128
s_add_u32 m0, s55, 20800
s_nop 0
buffer_load_dwordx4 v21, s[36:39], s53 offen lds
buffer_load_dwordx4 v28, s[36:39], s53 offen offset:1024 lds
buffer_load_dword v29, s[36:39], s53 offen offset:2048 lds
s_add_u32 s53, s53, 128
s_add_u32 m0, s56, 73984
s_nop 0
buffer_load_dwordx4 v18, s[20:23], s54 offen lds
buffer_load_dwordx4 v19, s[20:23], s54 offen offset:1024 lds
buffer_load_dwordx4 v20, s[20:23], s54 offen offset:2048 lds
s_add_u32 s54, s54, 196608
s_waitcnt vmcnt(12) lgkmcnt(0)
s_barrier
ds_read_b128 a[0:3], v23
RD 4,23,2304
RD 8,23,4608
RD 12,23,6912
ds_read_b128 a[16:19], v24
ds_read_b128 a[20:23], v30
RD 24,30,2304
RD 28,30,4608
RD 32,30,6912
ds_read_b128 a[36:39], v31
TR 80,25,49664
TR 82,25,50176
TR 84,25,62080
TR 86,25,62592
TR 88,25,50688
TR 90,25,51200
TR 92,25,63104
TR 94,25,63616
TR 96,25,51712
TR 98,25,52224
TR 100,25,64128
TR 102,25,64640
s_waitcnt vmcnt(3) lgkmcnt(0)
s_barrier
v_mfma_f32_16x16x32_bf16 v[60:63], a[80:83], a[0:3], 0
TR 104,25,49696
s_add_u32 m0, s56, 86400
MAA 60,84,20
buffer_load_dwordx4 v18, s[20:23], s54 offen lds
v_mfma_f32_16x16x32_bf16 v[64:67], a[80:83], a[4:7], 0
s_sub_u32 s47, s47, 1
s_cbranch_scc1 .Lx19
.Lx19b:
MAA 64,84,24
buffer_load_dwordx4 v19, s[20:23], s54 offen offset:1024 lds
v_mfma_f32_16x16x32_bf16 v[68:71], a[80:83], a[8:11], 0
TR 106,25,50208
MAA 68,84,28
TR 108,25,62112
TR 110,25,62624
TR 112,25,50720
v_mfma_f32_16x16x32_bf16 v[72:75], a[80:83], a[12:15], 0
TR 114,25,51232
MAA 72,84,32
TR 116,25,63136
TR 118,25,63648
v_mfma_f32_16x16x32_bf16 v[104:107], a[88:91], a[12:15], 0
TR 120,25,51744
MAA 104,92,32
buffer_load_dwordx4 v20, s[20:23], s54 offen offset:2048 lds
v_mfma_f32_16x16x32_bf16 v[100:103], a[88:91], a[8:11], 0
s_add_u32 s54, s54, 196608
s_add_u32 m0, s55, 36992
MAA 100,92,28
buffer_load_dwordx4 v21, s[36:39], s52 offen lds
v_mfma_f32_16x16x32_bf16 v[96:99], a[88:91], a[4:7], 0
TR 122,25,52256
MAA 96,92,24
buffer_load_dwordx4 v28, s[36:39], s52 offen offset:1024 lds
v_mfma_f32_16x16x32_bf16 v[92:95], a[88:91], a[0:3], 0
TR 124,25,64160
MAA 92,92,20
buffer_load_dword v22, s[36:39], s52 offen offset:2048 lds
v_mfma_f32_16x16x32_bf16 v[124:127], a[0:3], a[96:99], 0
s_add_u32 s52, s52, 128
s_add_u32 m0, s55, 39296
MAA 124,20,100
buffer_load_dwordx4 v21, s[36:39], s53 offen lds
v_mfma_f32_16x16x32_bf16 v[128:131], a[4:7], a[96:99], 0
TR 126,25,64672
MAA 128,24,100
buffer_load_dwordx4 v28, s[36:39], s53 offen offset:1024 lds
v_mfma_f32_16x16x32_bf16 v[132:135], a[8:11], a[96:99], 0
RD 40,23,18496
MAA 132,28,100
RD 44,23,20800
RD 48,23,23104
RD 52,23,25408
v_mfma_f32_16x16x32_bf16 v[136:139], a[12:15], a[96:99], 0
RD 56,24,18496
MAA 136,32,100
buffer_load_dword v29, s[36:39], s53 offen offset:2048 lds
v_mfma_f32_16x16x32_bf16 v[156:159], a[16:19], a[96:99], 0
s_add_u32 s53, s53, 128
MAA 156,36,100
s_waitcnt vmcnt(6) lgkmcnt(5)
s_barrier
v_mfma_f32_16x16x32_bf16 v[76:79], a[104:107], a[0:3], 0
RD 60,30,18496
s_add_u32 m0, s56, 98816
MAA 76,108,20
buffer_load_dwordx4 v18, s[20:23], s54 offen lds
v_mfma_f32_16x16x32_bf16 v[80:83], a[104:107], a[4:7], 0
RD 64,30,20800
MAA 80,108,24
buffer_load_dwordx4 v19, s[20:23], s54 offen offset:1024 lds
v_mfma_f32_16x16x32_bf16 v[84:87], a[104:107], a[8:11], 0
RD 68,30,23104
MAA 84,108,28
RD 72,30,25408
v_mfma_f32_16x16x32_bf16 v[88:91], a[104:107], a[12:15], 0
RD 76,31,18496
MAA 88,108,32
buffer_load_dwordx4 v20, s[20:23], s54 offen offset:2048 lds
v_mfma_f32_16x16x32_bf16 v[244:247], a[104:107], a[16:19], 0
s_add_u32 s54, s54, 196608
s_add_u32 m0, s56, 111232
MAA 244,108,36
buffer_load_dwordx4 v18, s[20:23], s54 offen lds
v_mfma_f32_16x16x32_bf16 v[120:123], a[112:115], a[12:15], 0
ds_read_b64_tr_b16 a[80:81], v25
MAA 120,116,32
TR 82,25,512
v_mfma_f32_16x16x32_bf16 v[116:119], a[112:115], a[8:11], 0
TR 84,25,12416
MAA 116,116,28
buffer_load_dwordx4 v19, s[20:23], s54 offen offset:1024 lds
v_mfma_f32_16x16x32_bf16 v[112:115], a[112:115], a[4:7], 0
TR 86,25,12928
MAA 112,116,24
buffer_load_dwordx4 v20, s[20:23], s54 offen offset:2048 lds
v_mfma_f32_16x16x32_bf16 v[108:111], a[112:115], a[0:3], 0
TR 88,25,1024
s_add_u32 s54, s54, 196608
MAA 108,116,20
TR 90,25,1536
v_mfma_f32_16x16x32_bf16 v[140:143], a[0:3], a[120:123], 0
TR 92,25,13440
s_add_u32 m0, s55, 55488
MAA 140,20,124
buffer_load_dwordx4 v21, s[36:39], s52 offen lds
v_mfma_f32_16x16x32_bf16 v[144:147], a[4:7], a[120:123], 0
TR 94,25,13952
MAA 144,24,124
buffer_load_dwordx4 v28, s[36:39], s52 offen offset:1024 lds
v_mfma_f32_16x16x32_bf16 v[148:151], a[8:11], a[120:123], 0
TR 96,25,2048
MAA 148,28,124
TR 98,25,2560
v_mfma_f32_16x16x32_bf16 v[152:155], a[12:15], a[120:123], 0
TR 100,25,14464
MAA 152,32,124
buffer_load_dword v22, s[36:39], s52 offen offset:2048 lds
v_mfma_f32_16x16x32_bf16 v[160:163], a[16:19], a[120:123], 0
TR 102,25,14976
s_add_u32 s52, s52, 128
MAA 160,36,124
s_waitcnt vmcnt(9) lgkmcnt(8)
s_barrier
MAA 60,80,40
TR 104,25,32
s_add_u32 m0, s55, 57792
MAA 60,84,60
buffer_load_dwordx4 v21, s[36:39], s53 offen lds
MAA 64,84,64
s_sub_u32 s47, s47, 1
s_cbranch_scc1 .Lx20
.Lx20b:
MAA 64,80,44
buffer_load_dwordx4 v28, s[36:39], s53 offen offset:1024 lds
MAA 68,80,48
TR 106,25,544
MAA 68,84,68
TR 108,25,12448
TR 110,25,12960
TR 112,25,1056
MAA 72,84,72
TR 114,25,1568
MAA 72,80,52
TR 116,25,13472
TR 118,25,13984
s_waitcnt lgkmcnt(8)
MAA 104,88,52
TR 120,25,2080
MAA 104,92,72
buffer_load_dword v29, s[36:39], s53 offen offset:2048 lds
MAA 100,92,68
s_add_u32 s53, s53, 128
s_add_u32 m0, s56, 123648
MAA 100,88,48
buffer_load_dwordx4 v18, s[20:23], s54 offen lds
MAA 96,88,44
TR 122,25,2592
MAA 96,92,64
buffer_load_dwordx4 v19, s[20:23], s54 offen offset:1024 lds
MAA 92,92,60
TR 124,25,14496
MAA 92,88,40
buffer_load_dwordx4 v20, s[20:23], s54 offen offset:2048 lds
MAA 124,40,96
s_add_u32 s54, s54, 196608
s_add_u32 m0, s56, 136064
MAA 124,60,100
buffer_load_dwordx4 v18, s[20:23], s54 offen lds
MAA 128,64,100
TR 126,25,15008
MAA 128,44,96
buffer_load_dwordx4 v19, s[20:23], s54 offen offset:1024 lds
MAA 132,48,96
RD 0,23,36992
MAA 132,68,100
RD 4,23,39296
RD 8,23,41600
RD 12,23,43904
MAA 136,72,100
RD 16,24,36992
MAA 136,52,96
buffer_load_dwordx4 v20, s[20:23], s54 offen offset:2048 lds
MAA 156,56,96
s_add_u32 s54, s54, 196608
MAA 156,76,100
s_waitcnt vmcnt(12) lgkmcnt(5)
s_barrier
MAA 76,104,40
RD 20,30,36992
s_add_u32 m0, s55, 0
MAA 76,108,60
buffer_load_dwordx4 v21, s[36:39], s52 offen lds
MAA 80,108,64
RD 24,30,39296
MAA 80,104,44
buffer_load_dwordx4 v28, s[36:39], s52 offen offset:1024 lds
MAA 84,104,48
RD 28,30,41600
MAA 84,108,68
RD 32,30,43904
RD 36,31,36992
MAA 88,108,72
TR 80,25,24832
MAA 88,104,52
buffer_load_dword v22, s[36:39], s52 offen offset:2048 lds
MAA 244,104,56
s_add_u32 s52, s52, 128
s_add_u32 m0, s55, 2304
MAA 244,108,76
buffer_load_dwordx4 v21, s[36:39], s53 offen lds
MAA 120,116,72
TR 82,25,25344
MAA 120,112,52
buffer_load_dwordx4 v28, s[36:39], s53 offen offset:1024 lds
MAA 116,112,48
TR 84,25,37248
MAA 116,116,68
TR 86,25,37760
TR 88,25,25856
MAA 112,116,64
TR 90,25,26368
MAA 112,112,44
buffer_load_dword v29, s[36:39], s53 offen offset:2048 lds
MAA 108,112,40
s_add_u32 s53, s53, 128
s_add_u32 m0, s56, 73984
MAA 108,116,60
buffer_load_dwordx4 v18, s[20:23], s54 offen lds
MAA 140,60,124
TR 92,25,38272
MAA 140,40,120
buffer_load_dwordx4 v19, s[20:23], s54 offen offset:1024 lds
MAA 144,44,120
TR 94,25,38784
MAA 144,64,124
buffer_load_dwordx4 v20, s[20:23], s54 offen offset:2048 lds
MAA 148,68,124
TR 96,25,26880
s_add_u32 s54, s54, 196608
MAA 148,48,120
TR 98,25,27392
TR 100,25,39296
MAA 152,52,120
TR 102,25,39808
MAA 152,72,124
buffer_load_dword v37, v34, s[40:43], 0 offen sc1
MAA 160,76,124
MAA 160,56,120
s_waitcnt vmcnt(16) lgkmcnt(8)
s_barrier
MAA 60,80,0
TR 104,25,24864
s_add_u32 m0, s56, 86400
MAA 60,84,20
buffer_load_dwordx4 v18, s[20:23], s54 offen lds
MAA 64,84,24
s_sub_u32 s47, s47, 1
s_cbranch_scc1 .Lx21
.Lx21b:
MAA 64,80,4
buffer_load_dwordx4 v19, s[20:23], s54 offen offset:1024 lds
MAA 68,80,8
TR 106,25,25376
MAA 68,84,28
TR 108,25,37280
TR 110,25,37792
TR 112,25,25888
MAA 72,84,32
TR 114,25,26400
MAA 72,80,12
TR 116,25,38304
TR 118,25,38816
s_waitcnt lgkmcnt(8)
MAA 104,88,12
TR 120,25,26912
MAA 104,92,32
buffer_load_dwordx4 v20, s[20:23], s54 offen offset:2048 lds
MAA 100,92,28
s_add_u32 s54, s54, 196608
s_add_u32 m0, s55, 18496
MAA 100,88,8
buffer_load_dwordx4 v21, s[36:39], s52 offen lds
MAA 96,88,4
TR 122,25,27424
MAA 96,92,24
buffer_load_dwordx4 v28, s[36:39], s52 offen offset:1024 lds
MAA 92,92,20
TR 124,25,39328
MAA 92,88,0
buffer_load_dword v22, s[36:39], s52 offen offset:2048 lds
MAA 124,0,96
s_add_u32 s52, s52, 128
s_add_u32 m0, s55, 20800
MAA 124,20,100
buffer_load_dwordx4 v21, s[36:39], s53 offen lds
MAA 128,24,100
TR 126,25,39840
MAA 128,4,96
buffer_load_dwordx4 v28, s[36:39], s53 offen offset:1024 lds
MAA 132,8,96
RD 40,23,55488
MAA 132,28,100
RD 44,23,57792
RD 48,23,60096
RD 52,23,62400
MAA 136,32,100
RD 56,24,55488
MAA 136,12,96
buffer_load_dword v29, s[36:39], s53 offen offset:2048 lds
MAA 156,16,96
s_add_u32 s53, s53, 128
MAA 156,36,100
s_waitcnt vmcnt(19) lgkmcnt(5)
s_barrier
MAA 76,104,0
RD 60,30,55488
s_add_u32 m0, s56, 98816
MAA 76,108,20
buffer_load_dwordx4 v18, s[20:23], s54 offen lds
MAA 80,108,24
RD 64,30,57792
MAA 80,104,4
buffer_load_dwordx4 v19, s[20:23], s54 offen offset:1024 lds
MAA 84,104,8
RD 68,30,60096
MAA 84,108,28
RD 72,30,62400
MAA 88,108,32
RD 76,31,55488
MAA 88,104,12
buffer_load_dwordx4 v20, s[20:23], s54 offen offset:2048 lds
MAA 244,104,16
s_add_u32 s54, s54, 196608
s_add_u32 m0, s55, 36992
MAA 244,108,36
buffer_load_dwordx4 v21, s[36:39], s52 offen lds
MAA 120,116,32
TR 80,25,49664
MAA 120,112,12
TR 82,25,50176
MAA 116,112,8
TR 84,25,62080
MAA 116,116,28
buffer_load_dwordx4 v28, s[36:39], s52 offen offset:1024 lds
MAA 112,116,24
TR 86,25,62592
MAA 112,112,4
buffer_load_dword v22, s[36:39], s52 offen offset:2048 lds
MAA 108,112,0
TR 88,25,50688
s_add_u32 s52, s52, 128
MAA 108,116,20
TR 90,25,51200
MAA 140,20,124
TR 92,25,63104
s_add_u32 m0, s55, 39296
MAA 140,0,120
buffer_load_dwordx4 v21, s[36:39], s53 offen lds
MAA 144,4,120
TR 94,25,63616
MAA 144,24,124
buffer_load_dwordx4 v28, s[36:39], s53 offen offset:1024 lds
MAA 148,28,124
TR 96,25,51712
MAA 148,8,120
.Lpad7:
s_cbranch_execz .Lt0r
TR 98,25,52224
MAA 152,12,120
TR 100,25,64128
MAA 152,32,124
buffer_load_dword v29, s[36:39], s53 offen offset:2048 lds
MAA 160,36,124
TR 102,25,64640
s_add_u32 s53, s53, 128
MAA 160,16,120
s_waitcnt vmcnt(22) lgkmcnt(8)
s_barrier
MAA 60,80,40
TR 104,25,49696
MAA 60,84,60
TR 106,25,50208
MAA 64,84,64
TR 108,25,62112
s_add_u32 m0, s56, 111232
MAA 64,80,44
buffer_load_dwordx4 v18, s[20:23], s54 offen lds
MAA 68,80,48
s_sub_u32 s47, s47, 1
s_cbranch_scc1 .Lx22
.Lx22b:
MAA 68,84,68
TR 110,25,62624
MAA 72,84,72
TR 112,25,50720
MAA 72,80,52
TR 114,25,51232
s_waitcnt lgkmcnt(6)
MAA 104,88,52
TR 116,25,63136
MAA 104,92,72
buffer_load_dwordx4 v19, s[20:23], s54 offen offset:1024 lds
MAA 100,92,68
TR 118,25,63648
MAA 100,88,48
buffer_load_dwordx4 v20, s[20:23], s54 offen offset:2048 lds
MAA 96,88,44
TR 120,25,51744
s_add_u32 s54, s54, 196608
MAA 96,92,64
TR 122,25,52256
MAA 92,92,60
TR 124,25,64160
s_add_u32 m0, s55, 55488
MAA 92,88,40
buffer_load_dwordx4 v21, s[36:39], s52 offen lds
MAA 124,40,96
TR 126,25,64672
MAA 124,60,100
ds_read_b128 a[0:3], v23
MAA 128,64,100
RD 4,23,2304
MAA 128,44,96
buffer_load_dwordx4 v28, s[36:39], s52 offen offset:1024 lds
MAA 132,48,96
RD 8,23,4608
MAA 132,68,100
RD 12,23,6912
MAA 136,72,100
ds_read_b128 a[16:19], v24
MAA 136,52,96
buffer_load_dword v22, s[36:39], s52 offen offset:2048 lds
MAA 156,56,96
s_add_u32 s52, s52, 128
MAA 156,76,100
s_waitcnt vmcnt(21) lgkmcnt(5)
s_barrier
v_cmp_gt_u32 vcc, v35, v37
s_nop 0
s_cbranch_vccnz .Lsp23
.Lsp23b:
v_mov_b32 v37, 0
MAA 76,104,40
ds_read_b128 a[20:23], v30
MAA 76,108,60
buffer_atomic_add v38, v32, s[16:19], 0 offen
MAA 80,108,64
RD 24,30,2304
MAA 80,104,44
RD 28,30,4608
MAA 84,104,48
RD 32,30,6912
s_add_u32 m0, s56, 123648
MAA 84,108,68
buffer_load_dwordx4 v18, s[20:23], s54 offen lds
MAA 88,108,72
ds_read_b128 a[36:39], v31
MAA 88,104,52
ds_read_b64_tr_b16 a[80:81], v25
MAA 244,104,56
TR 82,25,512
MAA 244,108,76
buffer_load_dwordx4 v19, s[20:23], s54 offen offset:1024 lds
MAA 120,116,72
TR 84,25,12416
MAA 120,112,52
TR 86,25,12928
MAA 116,112,48
MAA 116,116,68
buffer_load_dwordx4 v20, s[20:23], s54 offen offset:2048 lds
MAA 112,116,64
s_add_u32 s54, s54, 196608
s_add_u32 m0, s55, 57792
MAA 112,112,44
buffer_load_dwordx4 v21, s[36:39], s53 offen lds
MAA 108,112,40
TR 88,25,1024
MAA 108,116,60
TR 90,25,1536
MAA 140,60,124
TR 92,25,13440
MAA 140,40,120
buffer_load_dwordx4 v28, s[36:39], s53 offen offset:1024 lds
MAA 144,44,120
TR 94,25,13952
MAA 144,64,124
TR 96,25,2048
MAA 148,68,124
TR 98,25,2560
MAA 148,48,120
buffer_load_dword v29, s[36:39], s53 offen offset:2048 lds
MAA 152,52,120
TR 100,25,14464
s_add_u32 s53, s53, 128
MAA 152,72,124
TR 102,25,14976
MAA 160,76,124
MAA 160,56,120
s_waitcnt vmcnt(22) lgkmcnt(8)
s_barrier
MAA 60,80,0
TR 104,25,32
MAA 60,84,20
TR 106,25,544
MAA 64,84,24
TR 108,25,12448
s_add_u32 m0, s56, 136064
MAA 64,80,4
buffer_load_dwordx4 v18, s[20:23], s54 offen lds
MAA 68,80,8
s_sub_u32 s47, s47, 1
s_cbranch_scc1 .Lx24
.Lx24b:
MAA 68,84,28
TR 110,25,12960
MAA 72,84,32
TR 112,25,1056
MAA 72,80,12
TR 114,25,1568
s_waitcnt lgkmcnt(6)
MAA 104,88,12
TR 116,25,13472
MAA 104,92,32
buffer_load_dwordx4 v19, s[20:23], s54 offen offset:1024 lds
MAA 100,92,28
TR 118,25,13984
MAA 100,88,8
buffer_load_dwordx4 v20, s[20:23], s54 offen offset:2048 lds
MAA 96,88,4
TR 120,25,2080
s_add_u32 s54, s54, 196608
MAA 96,92,24
TR 122,25,2592
MAA 92,92,20
TR 124,25,14496
s_add_u32 m0, s55, 0
MAA 92,88,0
buffer_load_dwordx4 v21, s[36:39], s52 offen lds
MAA 124,0,96
TR 126,25,15008
MAA 124,20,100
RD 40,23,18496
MAA 128,24,100
RD 44,23,20800
MAA 128,4,96
buffer_load_dwordx4 v28, s[36:39], s52 offen offset:1024 lds
MAA 132,8,96
RD 48,23,23104
MAA 132,28,100
RD 52,23,25408
MAA 136,32,100
RD 56,24,18496
MAA 136,12,96
buffer_load_dword v22, s[36:39], s52 offen offset:2048 lds
MAA 156,16,96
s_add_u32 s52, s52, 128
MAA 156,36,100
s_waitcnt vmcnt(16) lgkmcnt(5)
s_barrier
MAA 76,104,0
RD 60,30,18496
MAA 76,108,20
RD 64,30,20800
MAA 80,108,24
RD 68,30,23104
s_add_u32 m0, s56, 73984
MAA 80,104,4
buffer_load_dwordx4 v18, s[20:23], s54 offen lds
MAA 84,104,8
RD 72,30,25408
MAA 84,108,28
RD 76,31,18496
MAA 88,108,32
MAA 88,104,12
buffer_load_dwordx4 v19, s[20:23], s54 offen offset:1024 lds
MAA 244,104,16
TR 80,25,24832
MAA 244,108,36
TR 82,25,25344
MAA 120,116,32
TR 84,25,37248
MAA 120,112,12
buffer_load_dwordx4 v20, s[20:23], s54 offen offset:2048 lds
MAA 116,112,8
TR 86,25,37760
s_add_u32 s54, s54, 196608
MAA 116,116,28
MAA 112,116,24
TR 88,25,25856
MAA 112,112,4
TR 90,25,26368
MAA 108,112,0
TR 92,25,38272
s_add_u32 m0, s55, 2304
MAA 108,116,20
buffer_load_dwordx4 v21, s[36:39], s53 offen lds
MAA 140,20,124
TR 94,25,38784
MAA 140,0,120
MAA 144,4,120
TR 96,25,26880
MAA 144,24,124
buffer_load_dwordx4 v28, s[36:39], s53 offen offset:1024 lds
MAA 148,28,124
TR 98,25,27392
MAA 148,8,120
TR 100,25,39296
MAA 152,12,120
TR 102,25,39808
MAA 152,32,124
buffer_load_dword v29, s[36:39], s53 offen offset:2048 lds
MAA 160,36,124
s_add_u32 s53, s53, 128
MAA 160,16,120
s_waitcnt lgkmcnt(8)
s_barrier
MAA 60,80,40
TR 104,25,24864
MAA 60,84,60
TR 106,25,25376
MAA 64,84,64
TR 108,25,37280
s_add_u32 m0, s56, 86400
MAA 64,80,44
buffer_load_dwordx4 v18, s[20:23], s54 offen lds
MAA 68,80,48
s_sub_u32 s47, s47, 1
s_cbranch_scc1 .Lx25
.Lx25b:
MAA 68,84,68
TR 110,25,37792
MAA 72,84,72
TR 112,25,25888
MAA 72,80,52
TR 114,25,26400
s_waitcnt lgkmcnt(6)
MAA 104,88,52
TR 116,25,38304
MAA 104,92,72
buffer_load_dwordx4 v19, s[20:23], s54 offen offset:1024 lds
MAA 100,92,68
TR 118,25,38816
MAA 100,88,48
buffer_load_dwordx4 v20, s[20:23], s54 offen offset:2048 lds
MAA 96,88,44
TR 120,25,26912
s_add_u32 s54, s54, 196608
MAA 96,92,64
TR 122,25,27424
MAA 92,92,60
TR 124,25,39328
s_add_u32 m0, s55, 18496
MAA 92,88,40
buffer_load_dwordx4 v21, s[36:39], s52 offen lds
MAA 124,40,96
TR 126,25,39840
MAA 124,60,100
RD 0,23,36992
MAA 128,64,100
RD 4,23,39296
MAA 128,44,96
buffer_load_dwordx4 v28, s[36:39], s52 offen offset:1024 lds
MAA 132,48,96
RD 8,23,41600
MAA 132,68,100
RD 12,23,43904
MAA 136,72,100
RD 16,24,36992
MAA 136,52,96
buffer_load_dword v22, s[36:39], s52 offen offset:2048 lds
MAA 156,56,96
s_add_u32 s52, s52, 128
MAA 156,76,100
s_waitcnt vmcnt(15) lgkmcnt(5)
s_barrier
MAA 76,104,40
RD 20,30,36992
s_add_u32 m0, s56, 98816
MAA 76,108,60
buffer_load_dwordx4 v18, s[20:23], s54 offen lds
MAA 80,108,64
RD 24,30,39296
MAA 80,104,44
RD 28,30,41600
MAA 84,104,48
RD 32,30,43904
MAA 84,108,68
buffer_load_dwordx4 v19, s[20:23], s54 offen offset:1024 lds
MAA 88,108,72
RD 36,31,36992
MAA 88,104,52
TR 80,25,49664
MAA 244,104,56
MAA 244,108,76
buffer_load_dwordx4 v20, s[20:23], s54 offen offset:2048 lds
MAA 120,116,72
TR 82,25,50176
s_add_u32 s54, s54, 196608
MAA 120,112,52
TR 84,25,62080
MAA 116,112,48
TR 86,25,62592
s_add_u32 m0, s55, 20800
MAA 116,116,68
buffer_load_dwordx4 v21, s[36:39], s53 offen lds
MAA 112,116,64
TR 88,25,50688
MAA 112,112,44
buffer_load_dwordx4 v28, s[36:39], s53 offen offset:1024 lds
MAA 108,112,40
TR 90,25,51200
MAA 108,116,60
TR 92,25,63104
MAA 140,60,124
MAA 140,40,120
buffer_load_dword v29, s[36:39], s53 offen offset:2048 lds
MAA 144,44,120
TR 94,25,63616
s_add_u32 s53, s53, 128
MAA 144,64,124
TR 96,25,51712
MAA 148,68,124
TR 98,25,52224
MAA 148,48,120
buffer_atomic_add v37, v33, s[16:19], 0 offen sc0
MAA 152,52,120
TR 100,25,64128
MAA 152,72,124
TR 102,25,64640
MAA 160,76,124
MAA 160,56,120
s_waitcnt lgkmcnt(8)
s_barrier
MAA 60,80,0
TR 104,25,49696
MAA 60,84,20
TR 106,25,50208
MAA 64,84,24
TR 108,25,62112
s_add_u32 m0, s56, 111232
MAA 64,80,4
buffer_load_dwordx4 v18, s[20:23], s54 offen lds
MAA 68,80,8
s_sub_u32 s47, s47, 1
s_cbranch_scc1 .Lx26
.Lx26b:
MAA 68,84,28
TR 110,25,62624
MAA 72,84,32
TR 112,25,50720
MAA 72,80,12
TR 114,25,51232
s_waitcnt lgkmcnt(6)
MAA 104,88,12
TR 116,25,63136
MAA 104,92,32
buffer_load_dwordx4 v19, s[20:23], s54 offen offset:1024 lds
MAA 100,92,28
TR 118,25,63648
MAA 100,88,8
buffer_load_dwordx4 v20, s[20:23], s54 offen offset:2048 lds
MAA 96,88,4
TR 120,25,51744
s_add_u32 s54, s54, 196608
MAA 96,92,24
TR 122,25,52256
MAA 92,92,20
TR 124,25,64160
s_add_u32 m0, s55, 36992
MAA 92,88,0
buffer_load_dwordx4 v21, s[36:39], s52 offen lds
MAA 124,0,96
TR 126,25,64672
MAA 124,20,100
RD 40,23,55488
MAA 128,24,100
RD 44,23,57792
MAA 128,4,96
buffer_load_dwordx4 v28, s[36:39], s52 offen offset:1024 lds
MAA 132,8,96
RD 48,23,60096
MAA 132,28,100
RD 52,23,62400
MAA 136,32,100
RD 56,24,55488
MAA 136,12,96
buffer_load_dword v22, s[36:39], s52 offen offset:2048 lds
MAA 156,16,96
s_add_u32 s52, s52, 128
MAA 156,36,100
s_waitcnt vmcnt(16) lgkmcnt(5)
s_barrier
MAA 76,104,0
RD 60,30,55488
MAA 76,108,20
RD 64,30,57792
MAA 80,108,24
RD 68,30,60096
s_add_u32 m0, s56, 123648
MAA 80,104,4
buffer_load_dwordx4 v18, s[20:23], s54 offen lds
MAA 84,104,8
RD 72,30,62400
MAA 84,108,28
RD 76,31,55488
MAA 88,108,32
MAA 88,104,12
buffer_load_dwordx4 v19, s[20:23], s54 offen offset:1024 lds
MAA 244,104,16
ds_read_b64_tr_b16 a[80:81], v25
MAA 244,108,36
TR 82,25,512
MAA 120,116,32
TR 84,25,12416
MAA 120,112,12
buffer_load_dwordx4 v20, s[20:23], s54 offen offset:2048 lds
MAA 116,112,8
TR 86,25,12928
s_add_u32 s54, s54, 196608
MAA 116,116,28
MAA 112,116,24
TR 88,25,1024
MAA 112,112,4
TR 90,25,1536
MAA 108,112,0
TR 92,25,13440
s_add_u32 m0, s55, 39296
MAA 108,116,20
buffer_load_dwordx4 v21, s[36:39], s53 offen lds
MAA 140,20,124
TR 94,25,13952
MAA 140,0,120
MAA 144,4,120
TR 96,25,2048
MAA 144,24,124
buffer_load_dwordx4 v28, s[36:39], s53 offen offset:1024 lds
MAA 148,28,124
TR 98,25,2560
MAA 148,8,120
TR 100,25,14464
MAA 152,12,120
TR 102,25,14976
MAA 152,32,124
buffer_load_dword v29, s[36:39], s53 offen offset:2048 lds
MAA 160,36,124
s_add_u32 s53, s53, 128
MAA 160,16,120
s_waitcnt lgkmcnt(8)
s_barrier
MAA 60,80,40
TR 104,25,32
MAA 60,84,60
TR 106,25,544
MAA 64,84,64
TR 108,25,12448
s_add_u32 m0, s56, 136064
MAA 64,80,44
buffer_load_dwordx4 v18, s[20:23], s54 offen lds
MAA 68,80,48
s_sub_u32 s47, s47, 1
s_cbranch_scc1 .Lx27
.Lx27b:
MAA 68,84,68
TR 110,25,12960
MAA 72,84,72
TR 112,25,1056
MAA 72,80,52
TR 114,25,1568
s_waitcnt lgkmcnt(6)
MAA 104,88,52
TR 116,25,13472
MAA 104,92,72
buffer_load_dwordx4 v19, s[20:23], s54 offen offset:1024 lds
MAA 100,92,68
TR 118,25,13984
MAA 100,88,48
buffer_load_dwordx4 v20, s[20:23], s54 offen offset:2048 lds
MAA 96,88,44
TR 120,25,2080
s_add_u32 s54, s54, 196608
MAA 96,92,64
TR 122,25,2592
MAA 92,92,60
TR 124,25,14496
s_add_u32 m0, s55, 55488
MAA 92,88,40
buffer_load_dwordx4 v21, s[36:39], s52 offen lds
MAA 124,40,96
TR 126,25,15008
MAA 124,60,100
ds_read_b128 a[0:3], v23
MAA 128,64,100
RD 4,23,2304
MAA 128,44,96
buffer_load_dwordx4 v28, s[36:39], s52 offen offset:1024 lds
MAA 132,48,96
RD 8,23,4608
MAA 132,68,100
RD 12,23,6912
MAA 136,72,100
ds_read_b128 a[16:19], v24
MAA 136,52,96
buffer_load_dword v22, s[36:39], s52 offen offset:2048 lds
MAA 156,56,96
.Lpad8:
s_cbranch_execz .Lt0r
s_add_u32 s52, s52, 128
MAA 156,76,100
s_waitcnt vmcnt(18)
v_cmp_gt_u32 vcc, v36, v37
s_nop 0
s_cbranch_vccnz .Lsp28
.Lsp28b:
s_waitcnt vmcnt(15) lgkmcnt(5)
s_barrier
MAA 76,104,40
ds_read_b128 a[20:23], v30
s_add_u32 m0, s56, 73984
MAA 76,108,60
buffer_load_dwordx4 v18, s[20:23], s54 offen lds
MAA 80,108,64
RD 24,30,2304
MAA 80,104,44
RD 28,30,4608
MAA 84,104,48
RD 32,30,6912
MAA 84,108,68
buffer_load_dwordx4 v19, s[20:23], s54 offen offset:1024 lds
MAA 88,108,72
ds_read_b128 a[36:39], v31
MAA 88,104,52
TR 80,25,24832
MAA 244,104,56
MAA 244,108,76
buffer_load_dwordx4 v20, s[20:23], s54 offen offset:2048 lds
MAA 120,116,72
TR 82,25,25344
s_add_u32 s54, s54, 196608
MAA 120,112,52
TR 84,25,37248
MAA 116,112,48
TR 86,25,37760
s_add_u32 m0, s55, 57792
MAA 116,116,68
buffer_load_dwordx4 v21, s[36:39], s53 offen lds
MAA 112,116,64
TR 88,25,25856
MAA 112,112,44
buffer_load_dwordx4 v28, s[36:39], s53 offen offset:1024 lds
MAA 108,112,40
TR 90,25,26368
MAA 108,116,60
TR 92,25,38272
MAA 140,60,124
MAA 140,40,120
buffer_load_dword v29, s[36:39], s53 offen offset:2048 lds
MAA 144,44,120
TR 94,25,38784
s_add_u32 s53, s53, 128
MAA 144,64,124
TR 96,25,26880
MAA 148,68,124
TR 98,25,27392
MAA 148,48,120
buffer_load_dwordx4 v[164:167], v26, s[16:19], s75 offen sc1
MAA 152,52,120
TR 100,25,39296
MAA 152,72,124
TR 102,25,39808
MAA 160,76,124
MAA 160,56,120
s_waitcnt lgkmcnt(8)
s_barrier
MAA 60,80,0
TR 104,25,24864
s_add_u32 m0, s56, 86400
MAA 60,84,20
buffer_load_dwordx4 v18, s[20:23], s54 offen lds
MAA 64,84,24
s_sub_u32 s47, s47, 1
s_cbranch_scc1 .Lx29
.Lx29b:
MAA 64,80,4
TR 106,25,25376
TR 108,25,37280
MAA 68,80,8
TR 110,25,37792
MAA 68,84,28
buffer_load_dwordx4 v19, s[20:23], s54 offen offset:1024 lds
MAA 72,84,32
TR 112,25,25888
MAA 72,80,12
TR 114,25,26400
s_waitcnt lgkmcnt(6)
MAA 104,88,12
MAA 104,92,32
buffer_load_dwordx4 v20, s[20:23], s54 offen offset:2048 lds
MAA 100,92,28
s_add_u32 s54, s54, 196608
s_add_u32 m0, s55, 0
MAA 100,88,8
buffer_load_dwordx4 v21, s[36:39], s52 offen lds
MAA 96,88,4
TR 116,25,38304
MAA 96,92,24
TR 118,25,38816
TR 120,25,26912
MAA 92,92,20
TR 122,25,27424
MAA 92,88,0
buffer_load_dwordx4 v28, s[36:39], s52 offen offset:1024 lds
MAA 124,0,96
TR 124,25,39328
MAA 124,20,100
TR 126,25,39840
MAA 128,24,100
RD 40,23,18496
MAA 128,4,96
buffer_load_dword v22, s[36:39], s52 offen offset:2048 lds
MAA 132,8,96
RD 44,23,20800
s_add_u32 s52, s52, 128
MAA 132,28,100
buffer_load_dwordx4 v[168:171], v26, s[16:19], s75 offen offset:1024 sc1
MAA 136,32,100
RD 48,23,23104
MAA 136,12,96
RD 52,23,25408
RD 56,24,18496
MAA 156,16,96
MAA 156,36,100
s_waitcnt vmcnt(17) lgkmcnt(5)
s_barrier
MAA 76,104,0
RD 60,30,18496
s_add_u32 m0, s56, 98816
MAA 76,108,20
buffer_load_dwordx4 v18, s[20:23], s54 offen lds
MAA 80,108,24
RD 64,30,20800
MAA 80,104,4
RD 68,30,23104
MAA 84,104,8
RD 72,30,25408
MAA 84,108,28
buffer_load_dwordx4 v19, s[20:23], s54 offen offset:1024 lds
MAA 88,108,32
RD 76,31,18496
MAA 88,104,12
TR 80,25,49664
MAA 244,104,16
MAA 244,108,36
buffer_load_dwordx4 v20, s[20:23], s54 offen offset:2048 lds
MAA 120,116,32
TR 82,25,50176
s_add_u32 s54, s54, 196608
MAA 120,112,12
TR 84,25,62080
MAA 116,112,8
TR 86,25,62592
s_add_u32 m0, s55, 2304
MAA 116,116,28
buffer_load_dwordx4 v21, s[36:39], s53 offen lds
MAA 112,116,24
TR 88,25,50688
MAA 112,112,4
buffer_load_dwordx4 v28, s[36:39], s53 offen offset:1024 lds
MAA 108,112,0
TR 90,25,51200
MAA 108,116,20
TR 92,25,63104
MAA 140,20,124
MAA 140,0,120
buffer_load_dword v29, s[36:39], s53 offen offset:2048 lds
MAA 144,4,120
TR 94,25,63616
s_add_u32 s53, s53, 128
MAA 144,24,124
TR 96,25,51712
MAA 148,28,124
TR 98,25,52224
MAA 148,8,120
buffer_load_dwordx4 v[172:175], v26, s[16:19], s75 offen offset:2048 sc1
MAA 152,12,120
TR 100,25,64128
MAA 152,32,124
TR 102,25,64640
MAA 160,36,124
MAA 160,16,120
s_waitcnt lgkmcnt(8)
s_barrier
MAA 60,80,40
TR 104,25,49696
s_add_u32 m0, s56, 111232
MAA 60,84,60
buffer_load_dwordx4 v18, s[20:23], s54 offen lds
MAA 64,84,64
s_sub_u32 s47, s47, 1
s_cbranch_scc1 .Lx30
.Lx30b:
MAA 64,80,44
TR 106,25,50208
TR 108,25,62112
MAA 68,80,48
TR 110,25,62624
MAA 68,84,68
buffer_load_dwordx4 v19, s[20:23], s54 offen offset:1024 lds
MAA 72,84,72
TR 112,25,50720
MAA 72,80,52
TR 114,25,51232
s_waitcnt lgkmcnt(6)
MAA 104,88,52
MAA 104,92,72
buffer_load_dwordx4 v20, s[20:23], s54 offen offset:2048 lds
MAA 100,92,68
s_add_u32 s54, s54, 196608
s_add_u32 m0, s55, 18496
MAA 100,88,48
buffer_load_dwordx4 v21, s[36:39], s52 offen lds
MAA 96,88,44
TR 116,25,63136
MAA 96,92,64
TR 118,25,63648
TR 120,25,51744
MAA 92,92,60
TR 122,25,52256
MAA 92,88,40
buffer_load_dwordx4 v28, s[36:39], s52 offen offset:1024 lds
MAA 124,40,96
TR 124,25,64160
MAA 124,60,100
TR 126,25,64672
MAA 128,64,100
RD 0,23,36992
MAA 128,44,96
buffer_load_dword v22, s[36:39], s52 offen offset:2048 lds
MAA 132,48,96
RD 4,23,39296
s_add_u32 s52, s52, 128
MAA 132,68,100
buffer_load_dwordx4 v[176:179], v26, s[16:19], s75 offen offset:3072 sc1
MAA 136,72,100
RD 8,23,41600
s_add_u32 s75, s75, 4096
MAA 136,52,96
RD 12,23,43904
RD 16,24,36992
MAA 156,56,96
MAA 156,76,100
s_waitcnt vmcnt(18) lgkmcnt(5)
s_barrier
MAA 76,104,40
RD 20,30,36992
s_add_u32 m0, s56, 123648
MAA 76,108,60
buffer_load_dwordx4 v18, s[20:23], s54 offen lds
MAA 80,108,64
RD 24,30,39296
s_waitcnt vmcnt(15)
v_add_f32 v164, v164, v168
MAA 80,104,44
RD 28,30,41600
MAA 84,104,48
RD 32,30,43904
MAA 84,108,68
buffer_load_dwordx4 v19, s[20:23], s54 offen offset:1024 lds
MAA 88,108,72
RD 36,31,36992
MAA 88,104,52
ds_read_b64_tr_b16 a[80:81], v25
v_add_f32 v165, v165, v169
MAA 244,104,56
MAA 244,108,76
buffer_load_dwordx4 v20, s[20:23], s54 offen offset:2048 lds
MAA 120,116,72
TR 82,25,512
s_add_u32 s54, s54, 196608
MAA 120,112,52
TR 84,25,12416
MAA 116,112,48
TR 86,25,12928
s_add_u32 m0, s55, 20800
MAA 116,116,68
buffer_load_dwordx4 v21, s[36:39], s53 offen lds
MAA 112,116,64
TR 88,25,1024
MAA 112,112,44
buffer_load_dwordx4 v28, s[36:39], s53 offen offset:1024 lds
MAA 108,112,40
TR 90,25,1536
v_add_f32 v166, v166, v170
MAA 108,116,60
TR 92,25,13440
MAA 140,60,124
MAA 140,40,120
buffer_load_dword v29, s[36:39], s53 offen offset:2048 lds
MAA 144,44,120
TR 94,25,13952
s_add_u32 s53, s53, 128
MAA 144,64,124
TR 96,25,2048
MAA 148,68,124
TR 98,25,2560
v_add_f32 v167, v167, v171
MAA 148,48,120
buffer_load_dwordx4 v[180:183], v26, s[16:19], s75 offen sc1
MAA 152,52,120
TR 100,25,14464
MAA 152,72,124
TR 102,25,14976
MAA 160,76,124
MAA 160,56,120
s_waitcnt lgkmcnt(8)
s_barrier
MAA 60,80,0
TR 104,25,32
s_add_u32 m0, s56, 136064
MAA 60,84,20
buffer_load_dwordx4 v18, s[20:23], s54 offen lds
MAA 64,84,24
s_sub_u32 s47, s47, 1
s_cbranch_scc1 .Lx31
.Lx31b:
MAA 64,80,4
TR 106,25,544
TR 108,25,12448
MAA 68,80,8
TR 110,25,12960
s_waitcnt vmcnt(15)
v_add_f32 v164, v164, v172
MAA 68,84,28
buffer_load_dwordx4 v19, s[20:23], s54 offen offset:1024 lds
MAA 72,84,32
TR 112,25,1056
MAA 72,80,12
TR 114,25,1568
s_waitcnt lgkmcnt(6)
MAA 104,88,12
v_add_f32 v165, v165, v173
MAA 104,92,32
buffer_load_dwordx4 v20, s[20:23], s54 offen offset:2048 lds
MAA 100,92,28
s_add_u32 s54, s54, 196608
s_add_u32 m0, s55, 36992
MAA 100,88,8
buffer_load_dwordx4 v21, s[36:39], s52 offen lds
MAA 96,88,4
TR 116,25,13472
MAA 96,92,24
TR 118,25,13984
TR 120,25,2080
MAA 92,92,20
TR 122,25,2592
v_add_f32 v166, v166, v174
MAA 92,88,0
buffer_load_dwordx4 v28, s[36:39], s52 offen offset:1024 lds
MAA 124,0,96
TR 124,25,14496
MAA 124,20,100
TR 126,25,15008
MAA 128,24,100
RD 40,23,55488
v_add_f32 v167, v167, v175
MAA 128,4,96
buffer_load_dword v22, s[36:39], s52 offen offset:2048 lds
MAA 132,8,96
RD 44,23,57792
s_add_u32 s52, s52, 128
MAA 132,28,100
buffer_load_dwordx4 v[184:187], v26, s[16:19], s75 offen offset:1024 sc1
MAA 136,32,100
RD 48,23,60096
MAA 136,12,96
RD 52,23,62400
RD 56,24,55488
MAA 156,16,96
MAA 156,36,100
s_waitcnt vmcnt(18) lgkmcnt(5)
s_barrier
MAA 76,104,0
RD 60,30,55488
s_waitcnt vmcnt(14)
v_add_f32 v164, v164, v176
MAA 76,108,20
RD 64,30,57792
s_add_u32 m0, s56, 73984
MAA 80,108,24
buffer_load_dwordx4 v18, s[20:23], s54 offen lds
MAA 80,104,4
RD 68,30,60096
v_add_f32 v165, v165, v177
MAA 84,104,8
RD 72,30,62400
v_add_f32 v166, v166, v178
MAA 84,108,28
buffer_load_dwordx4 v19, s[20:23], s54 offen offset:1024 lds
MAA 88,108,32
RD 76,31,55488
v_add_f32 v167, v167, v179
MAA 88,104,12
TR 80,25,24832
MAA 244,104,16
buffer_load_dwordx4 v20, s[20:23], s54 offen offset:2048 lds
MAA 244,108,36
TR 82,25,25344
s_add_u32 s54, s54, 196608
MAA 120,116,32
TR 84,25,37248
s_add_u32 m0, s55, 39296
MAA 120,112,12
buffer_load_dwordx4 v21, s[36:39], s53 offen lds
MAA 116,112,8
TR 86,25,37760
MAA 116,116,28
TR 88,25,25856
MAA 112,116,24
buffer_load_dwordx4 v28, s[36:39], s53 offen offset:1024 lds
MAA 112,112,4
TR 90,25,26368
MAA 108,112,0
TR 92,25,38272
MAA 108,116,20
buffer_load_dword v29, s[36:39], s53 offen offset:2048 lds
MAA 140,20,124
TR 94,25,38784
s_add_u32 s53, s53, 128
MAA 140,0,120
TR 96,25,26880
MAA 144,4,120
buffer_load_dwordx4 v[188:191], v26, s[16:19], s75 offen offset:2048 sc1
MAA 144,24,124
TR 98,25,27392
MAA 148,28,124
TR 100,25,39296
MAA 148,8,120
TR 102,25,39808
MAA 152,12,120
MAA 152,32,124
MAA 160,36,124
MAA 160,16,120
s_waitcnt lgkmcnt(8)
s_barrier
MAA 60,80,40
TR 104,25,24864
s_add_u32 m0, s56, 86400
MAA 60,84,60
buffer_load_dwordx4 v18, s[20:23], s54 offen lds
MAA 64,84,64
s_sub_u32 s47, s47, 1
s_cbranch_scc1 .Lx32
.Lx32b:
MAA 64,80,44
TR 106,25,25376
TR 108,25,37280
MAA 68,80,48
TR 110,25,37792
s_waitcnt vmcnt(15)
v_add_f32 v164, v164, v180
MAA 68,84,68
buffer_load_dwordx4 v19, s[20:23], s54 offen offset:1024 lds
MAA 72,84,72
TR 112,25,25888
MAA 72,80,52
TR 114,25,26400
s_waitcnt lgkmcnt(6)
MAA 104,88,52
v_add_f32 v165, v165, v181
MAA 104,92,72
buffer_load_dwordx4 v20, s[20:23], s54 offen offset:2048 lds
MAA 100,92,68
s_add_u32 s54, s54, 196608
s_add_u32 m0, s55, 55488
MAA 100,88,48
buffer_load_dwordx4 v21, s[36:39], s52 offen lds
MAA 96,88,44
TR 116,25,38304
MAA 96,92,64
TR 118,25,38816
TR 120,25,26912
MAA 92,92,60
TR 122,25,27424
v_add_f32 v166, v166, v182
MAA 92,88,40
buffer_load_dwordx4 v28, s[36:39], s52 offen offset:1024 lds
MAA 124,40,96
TR 124,25,39328
MAA 124,60,100
TR 126,25,39840
MAA 128,64,100
ds_read_b128 a[0:3], v23
v_add_f32 v167, v167, v183
MAA 128,44,96
buffer_load_dword v22, s[36:39], s52 offen offset:2048 lds
MAA 132,48,96
RD 4,23,2304
s_add_u32 s52, s52, 128
MAA 132,68,100
buffer_load_dwordx4 v[192:195], v26, s[16:19], s75 offen offset:3072 sc1
MAA 136,72,100
RD 8,23,4608
MAA 136,52,96
RD 12,23,6912
ds_read_b128 a[16:19], v24
MAA 156,56,96
MAA 156,76,100
s_waitcnt vmcnt(18) lgkmcnt(5)
s_barrier
MAA 76,104,40
ds_read_b128 a[20:23], v30
s_waitcnt vmcnt(14)
v_add_f32 v164, v164, v184
MAA 76,108,60
RD 24,30,2304
s_add_u32 m0, s56, 98816
MAA 80,108,64
buffer_load_dwordx4 v18, s[20:23], s54 offen lds
MAA 80,104,44
RD 28,30,4608
v_add_f32 v165, v165, v185
MAA 84,104,48
RD 32,30,6912
v_add_f32 v166, v166, v186
MAA 84,108,68
ds_read_b128 a[36:39], v31
v_add_f32 v167, v167, v187
MAA 88,108,72
buffer_load_dwordx4 v19, s[20:23], s54 offen offset:1024 lds
MAA 88,104,52
TR 80,25,49664
MAA 244,104,56
TR 82,25,50176
MAA 244,108,76
TR 84,25,62080
MAA 120,116,72
buffer_load_dwordx4 v20, s[20:23], s54 offen offset:2048 lds
MAA 120,112,52
TR 86,25,62592
s_add_u32 s54, s54, 196608
MAA 116,112,48
TR 88,25,50688
s_add_u32 m0, s55, 57792
MAA 116,116,68
TR 90,25,51200
MAA 112,116,64
buffer_load_dwordx4 v21, s[36:39], s53 offen lds
MAA 112,112,44
TR 92,25,63104
MAA 108,112,40
TR 94,25,63616
MAA 108,116,60
TR 96,25,51712
.Lpad9:
s_cbranch_execz .Lt0r
MAA 140,60,124
buffer_load_dwordx4 v28, s[36:39], s53 offen offset:1024 lds
MAA 140,40,120
TR 98,25,52224
MAA 144,44,120
TR 100,25,64128
MAA 144,64,124
TR 102,25,64640
MAA 148,68,124
buffer_load_dword v29, s[36:39], s53 offen offset:2048 lds
MAA 148,48,120
s_add_u32 s53, s53, 128
MAA 152,52,120
MAA 152,72,124
MAA 160,76,124
MAA 160,56,120
s_waitcnt lgkmcnt(8)
s_barrier
MAA 60,80,0
TR 104,25,49696
s_waitcnt vmcnt(13)
v_add_f32 v164, v164, v188
MAA 60,84,20
TR 106,25,50208
s_add_u32 m0, s56, 111232
MAA 64,84,24
buffer_load_dwordx4 v18, s[20:23], s54 offen lds
MAA 64,80,4
TR 108,25,62112
v_add_f32 v165, v165, v189
MAA 68,80,8
TR 110,25,62624
v_add_f32 v166, v166, v190
MAA 68,84,28
buffer_load_dwordx4 v19, s[20:23], s54 offen offset:1024 lds
MAA 72,84,32
TR 112,25,50720
v_add_f32 v167, v167, v191
MAA 72,80,12
TR 114,25,51232
s_waitcnt lgkmcnt(6)
MAA 104,88,12
buffer_load_dwordx4 v20, s[20:23], s54 offen offset:2048 lds
MAA 104,92,32
TR 116,25,63136
s_add_u32 s54, s54, 196608
MAA 100,92,28
TR 118,25,63648
s_add_u32 m0, s59, 0
MAA 100,88,8
TR 120,25,51744
s_xor_b32 s58, s87, 1048576
MAA 96,88,4
buffer_load_dwordx4 v5, s[24:27], s58 offen lds
MAA 96,92,24
TR 122,25,52256
MAA 92,92,20
TR 124,25,64160
MAA 92,88,0
buffer_load_dwordx4 v6, s[24:27], s58 offen offset:1024 lds
MAA 124,0,96
TR 126,25,64672
s_add_u32 m0, s59, 8320
MAA 124,20,100
RD 40,23,18496
s_xor_b32 s58, s87, 1179648
MAA 128,24,100
buffer_load_dwordx4 v5, s[24:27], s58 offen lds
MAA 128,4,96
RD 44,23,20800
MAA 132,8,96
RD 48,23,23104
MAA 132,28,100
buffer_load_dwordx4 v6, s[24:27], s58 offen offset:1024 lds
MAA 136,32,100
RD 52,23,25408
MAA 136,12,96
RD 56,24,18496
MAA 156,16,96
MAA 156,36,100
s_waitcnt vmcnt(17) lgkmcnt(5)
s_barrier
MAA 76,104,0
RD 60,30,18496
s_waitcnt vmcnt(13)
v_add_f32 v164, v164, v192
MAA 76,108,20
RD 64,30,20800
s_add_u32 m0, s56, 123648
MAA 80,108,24
buffer_load_dwordx4 v18, s[20:23], s54 offen lds
MAA 80,104,4
RD 68,30,23104
v_add_f32 v165, v165, v193
MAA 84,104,8
RD 72,30,25408
v_add_f32 v166, v166, v194
MAA 84,108,28
RD 76,31,18496
v_add_f32 v167, v167, v195
MAA 88,108,32
ds_read_b64_tr_b16 a[80:81], v25
MAA 88,104,12
TR 82,25,512
MAA 244,104,16
TR 84,25,12416
MAA 244,108,36
TR 86,25,12928
MAA 120,116,32
buffer_load_dwordx4 v19, s[20:23], s54 offen offset:1024 lds
MAA 120,112,12
TR 88,25,1024
MAA 116,112,8
TR 90,25,1536
MAA 116,116,28
TR 92,25,13440
MAA 112,116,24
TR 94,25,13952
MAA 112,112,4
TR 96,25,2048
MAA 108,112,0
TR 98,25,2560
MAA 108,116,20
TR 100,25,14464
MAA 140,20,124
buffer_load_dwordx4 v20, s[20:23], s54 offen offset:2048 lds
MAA 140,0,120
TR 102,25,14976
s_add_u32 s54, s54, 196608
MAA 144,4,120
MAA 144,24,124
MAA 148,28,124
MAA 148,8,120
MAA 152,12,120
MAA 152,32,124
MAA 160,36,124
MAA 160,16,120
s_waitcnt lgkmcnt(8)
s_barrier
MAA 60,80,40
TR 104,25,32
MAA 60,84,60
TR 106,25,544
s_add_u32 m0, s56, 136064
MAA 64,84,64
buffer_load_dwordx4 v18, s[20:23], s54 offen lds
MAA 64,80,44
TR 108,25,12448
MAA 68,80,48
TR 110,25,12960
MAA 68,84,68
buffer_load_dwordx4 v19, s[20:23], s54 offen offset:1024 lds
MAA 72,84,72
TR 112,25,1056
MAA 72,80,52
TR 114,25,1568
s_waitcnt lgkmcnt(6)
MAA 104,88,52
buffer_load_dwordx4 v20, s[20:23], s54 offen offset:2048 lds
MAA 104,92,72
TR 116,25,13472
s_add_u32 s54, s54, 196608
MAA 100,92,68
TR 118,25,13984
s_add_u32 m0, s59, 16640
MAA 100,88,48
TR 120,25,2080
s_xor_b32 s58, s87, 1310720
MAA 96,88,44
buffer_load_dwordx4 v5, s[24:27], s58 offen lds
MAA 96,92,64
TR 122,25,2592
MAA 92,92,60
TR 124,25,14496
MAA 92,88,40
buffer_load_dwordx4 v6, s[24:27], s58 offen offset:1024 lds
MAA 124,40,96
TR 126,25,15008
s_add_u32 m0, s59, 24960
MAA 124,60,100
RD 0,23,36992
s_xor_b32 s58, s87, 1441792
MAA 128,64,100
buffer_load_dwordx4 v5, s[24:27], s58 offen lds
MAA 128,44,96
RD 4,23,39296
MAA 132,48,96
RD 8,23,41600
MAA 132,68,100
buffer_load_dwordx4 v6, s[24:27], s58 offen offset:1024 lds
MAA 136,72,100
RD 12,23,43904
MAA 136,52,96
RD 16,24,36992
MAA 156,56,96
v_permlane32_swap_b32 v164, v166
MAA 156,76,100
v_permlane32_swap_b32 v165, v167
v_add_f32 v164, v164, v166
v_add_f32 v165, v165, v167
v_mul_f32 v164, 0xba800000, v164
v_mul_f32 v165, 0x3a800000, v165
v_fma_f32 v165, -v164, v164, v165
v_max_f32 v165, 0, v165
v_add_f32 v165, 0x3727c5ac, v165
v_rsq_f32 v166, v165
s_nop 0
v_mov_b32 v165, v166
v_mul_f32 v166, 0x3e8293ee, v166
s_waitcnt vmcnt(14) lgkmcnt(5)
s_barrier
MAA 76,104,40
ds_write_b128 v7, v[164:167]
MAA 76,108,60
ds_write_b32 v17, v164
s_add_u32 m0, s59, 74880
MAA 80,108,64
ds_write_b32 v17, v165 offset:1024
s_xor_b32 s58, s87, 131072
MAA 80,104,44
buffer_load_dwordx4 v5, s[24:27], s58 offen lds
MAA 84,104,48
RD 20,30,36992
MAA 84,108,68
RD 24,30,39296
MAA 88,108,72
RD 28,30,41600
MAA 88,104,52
RD 32,30,43904
MAA 244,104,56
RD 36,31,36992
MAA 244,108,76
buffer_load_dwordx4 v6, s[24:27], s58 offen offset:1024 lds
MAA 120,116,72
TR 80,25,24832
s_add_u32 m0, s59, 83200
MAA 120,112,52
TR 82,25,25344
s_xor_b32 s58, s87, 262144
MAA 116,112,48
TR 84,25,37248
MAA 116,116,68
TR 86,25,37760
MAA 112,116,64
TR 88,25,25856
MAA 112,112,44
buffer_load_dwordx4 v5, s[24:27], s58 offen lds
MAA 108,112,40
TR 90,25,26368
MAA 108,116,60
TR 92,25,38272
MAA 140,60,124
TR 94,25,38784
MAA 140,40,120
TR 96,25,26880
MAA 144,44,120
TR 98,25,27392
MAA 144,64,124
buffer_load_dwordx4 v6, s[24:27], s58 offen offset:1024 lds
MAA 148,68,124
TR 100,25,39296
MAA 148,48,120
TR 102,25,39808
MAA 152,52,120
MAA 152,72,124
MAA 160,76,124
MAA 160,56,120
s_waitcnt vmcnt(8) lgkmcnt(0)
s_barrier
MAA 104,88,12
TR 112,25,25888
s_add_u32 m0, s59, 33280
MAA 104,92,32
TR 114,25,26400
s_xor_b32 s58, s87, 1572864
MAA 100,92,28
buffer_load_dwordx4 v5, s[24:27], s58 offen lds
MAA 100,88,8
TR 116,25,38304
MAA 96,88,4
TR 118,25,38816
MAA 96,92,24
TR 120,25,26912
MAA 92,92,20
buffer_load_dwordx4 v6, s[24:27], s58 offen offset:1024 lds
MAA 92,88,0
TR 122,25,27424
s_add_u32 m0, s59, 41600
MAA 156,16,96
TR 124,25,39328
s_xor_b32 s58, s87, 1703936
MAA 156,36,100
TR 126,25,39840
MAA 72,84,32
buffer_load_dwordx4 v5, s[24:27], s58 offen lds
MAA 72,80,12
TR 104,25,24864
MAA 68,80,8
TR 106,25,25376
MAA 68,84,28
TR 108,25,37280
MAA 64,84,24
buffer_load_dwordx4 v6, s[24:27], s58 offen offset:1024 lds
MAA 64,80,4
TR 110,25,37792
MAA 60,80,0
RD 40,23,55488
MAA 60,84,20
RD 44,23,57792
s_waitcnt lgkmcnt(12)
MAA 120,112,12
RD 48,23,60096
s_waitcnt lgkmcnt(11)
MAA 120,116,32
RD 52,23,62400
MAA 116,116,28
RD 56,24,55488
MAA 116,112,8
RD 60,30,55488
MAA 112,112,4
RD 64,30,57792
MAA 112,116,24
s_waitcnt lgkmcnt(7)
s_barrier
RD 68,30,60096
MAA 108,116,20
RD 72,30,62400
s_add_u32 m0, s59, 91520
MAA 108,112,0
RD 76,31,55488
s_xor_b32 s58, s87, 393216
MAA 160,16,120
TR 144,25,50688
MAA 160,36,124
TR 146,25,51200
MAA 244,108,36
TR 148,25,63104
MAA 244,104,16
TR 150,25,63616
MAA 88,104,12
TR 152,25,50720
MAA 88,108,32
TR 154,25,51232
MAA 84,108,28
TR 156,25,63136
MAA 84,104,8
TR 158,25,63648
MAA 80,104,4
TR 160,25,51712
MAA 80,108,24
TR 162,25,52224
MAA 76,108,20
TR 164,25,64128
MAA 76,104,0
TR 166,25,64640
s_waitcnt lgkmcnt(10)
MAA 104,144,52
TR 168,25,51744
s_waitcnt lgkmcnt(9)
MAA 104,148,72
TR 170,25,52256
MAA 100,148,68
TR 172,25,64160
MAA 100,144,48
TR 174,25,64672
MAA 96,144,44
TR 136,25,49696
MAA 96,148,64
TR 138,25,50208
MAA 92,148,60
TR 140,25,62112
MAA 92,144,40
TR 142,25,62624
s_waitcnt lgkmcnt(14)
MAA 120,152,52
TR 128,25,49664
s_waitcnt lgkmcnt(13)
MAA 120,156,72
TR 130,25,50176
MAA 116,156,68
TR 132,25,62080
MAA 116,152,48
TR 134,25,62592
MAA 112,152,44
ds_read_b128 v[232:235], v10 offset:1792
MAA 112,156,64
ds_read_b128 v[228:231], v10 offset:1536
MAA 108,156,60
ds_read_b128 v[224:227], v10 offset:1280
MAA 108,152,40
ds_read_b128 v[220:223], v10 offset:1024
s_waitcnt lgkmcnt(15)
MAA 156,56,160
buffer_load_dwordx4 v5, s[24:27], s58 offen lds
MAA 156,76,164
s_waitcnt lgkmcnt(12)
MAA 160,76,172
MAA 160,56,168
s_waitcnt lgkmcnt(4)
s_barrier
MAA 244,136,56
buffer_load_dwordx4 v6, s[24:27], s58 offen offset:1024 lds
MAA 244,140,76
s_add_u32 m0, s59, 99840
s_xor_b32 s58, s87, 524288
MAA 88,140,72
MAA 88,136,52
MAA 84,136,48
buffer_load_dwordx4 v5, s[24:27], s58 offen lds
MAA 84,140,68
buffer_load_dwordx4 v6, s[24:27], s58 offen offset:1024 lds
s_add_u32 m0, s59, 108160
s_xor_b32 s58, s87, 655360
buffer_load_dwordx4 v5, s[24:27], s58 offen lds
buffer_load_dwordx4 v6, s[24:27], s58 offen offset:1024 lds
s_mov_b32 exec_lo, 0x10001
s_mov_b32 exec_hi, 0x10001
ds_write_b128 v13, v[244:247] offset:64
s_mov_b64 exec, 0xffff
ds_write_b32 v12, v156 offset:512
ds_write_b32 v12, v160 offset:576
s_mov_b64 exec, -1
MAA 80,136,44
MAA 80,140,64
MAA 76,140,60
MAA 76,136,40
MAA 72,128,52
MAA 72,132,72
s_waitcnt lgkmcnt(0)
s_barrier
MAA 68,128,48
ds_read_b128 v[28:31], v13
s_add_u32 m0, s59, 49920
MAA 68,132,68
ds_read_b128 v[32:35], v13 offset:64
s_xor_b32 s58, s87, 1835008
MAA 64,132,64
ds_read_b128 v[36:39], v13 offset:256
MAA 64,128,44
ds_read_b128 v[40:43], v13 offset:320
MAA 60,128,40
ds_read_b32 v44, v12 offset:512
MAA 60,132,60
ds_read_b32 v45, v12 offset:576
ds_read_b128 v[240:243], v11 offset:704
ds_read_b128 v[244:247], v11 offset:1728
ds_read_b128 v[18:21], v11 offset:448
ds_read_b128 v[22:25], v11 offset:1472
buffer_load_dwordx4 v5, s[24:27], s58 offen lds
s_waitcnt lgkmcnt(9)
v_pk_fma_f32 v[72:73], v[28:29], v[232:233], v[72:73] op_sel_hi:[1,0,1]
v_cvt_pk_bf16_f32 v176, v72, v73
v_pk_fma_f32 v[74:75], v[30:31], v[232:233], v[74:75] op_sel_hi:[1,0,1]
v_cvt_pk_bf16_f32 v177, v74, v75
s_waitcnt lgkmcnt(8)
v_pk_fma_f32 v[88:89], v[32:33], v[232:233], v[88:89] op_sel_hi:[1,0,1]
v_cvt_pk_bf16_f32 v178, v88, v89
v_pk_fma_f32 v[90:91], v[34:35], v[232:233], v[90:91] op_sel_hi:[1,0,1]
s_waitcnt lgkmcnt(7)
v_pk_fma_f32 v[104:105], v[36:37], v[232:233], v[104:105] op_sel_hi:[1,0,1]
v_pk_mul_f32 v[104:105], v[104:105], v[232:233] op_sel:[0,1] op_sel_hi:[1,1]
v_cvt_pk_bf16_f32 v196, v104, v105
v_pk_fma_f32 v[106:107], v[38:39], v[232:233], v[106:107] op_sel_hi:[1,0,1]
v_pk_mul_f32 v[106:107], v[106:107], v[232:233] op_sel:[0,1] op_sel_hi:[1,1]
v_cvt_pk_bf16_f32 v197, v106, v107
s_waitcnt lgkmcnt(6)
v_pk_fma_f32 v[120:121], v[40:41], v[232:233], v[120:121] op_sel_hi:[1,0,1]
v_pk_mul_f32 v[120:121], v[120:121], v[232:233] op_sel:[0,1] op_sel_hi:[1,1]
v_cvt_pk_bf16_f32 v198, v120, v121
v_pk_fma_f32 v[122:123], v[42:43], v[232:233], v[122:123] op_sel_hi:[1,0,1]
v_pk_mul_f32 v[122:123], v[122:123], v[232:233] op_sel:[0,1] op_sel_hi:[1,1]
v_cvt_pk_bf16_f32 v199, v122, v123
v_pk_fma_f32 v[100:101], v[36:37], v[228:229], v[100:101] op_sel_hi:[1,0,1]
v_pk_mul_f32 v[100:101], v[100:101], v[228:229] op_sel:[0,1] op_sel_hi:[1,1]
s_waitcnt lgkmcnt(3)
v_pk_fma_f32 v[156:157], v[240:241], v[44:45], v[156:157] op_sel_hi:[1,0,1]
v_pk_fma_f32 v[158:159], v[242:243], v[44:45], v[158:159] op_sel_hi:[1,0,1]
s_waitcnt lgkmcnt(2)
v_pk_mul_f32 v[156:157], v[156:157], v[244:245]
v_cvt_pk_bf16_f32 v236, v156, v157
v_pk_mul_f32 v[158:159], v[158:159], v[246:247]
v_cvt_pk_bf16_f32 v237, v158, v159
v_pk_fma_f32 v[160:161], v[240:241], v[44:45], v[160:161] op_sel:[0,1,0] op_sel_hi:[1,1,1]
v_pk_mul_f32 v[160:161], v[160:161], v[244:245]
v_cvt_pk_bf16_f32 v238, v160, v161
v_pk_fma_f32 v[162:163], v[242:243], v[44:45], v[162:163] op_sel:[0,1,0] op_sel_hi:[1,1,1]
v_pk_mul_f32 v[162:163], v[162:163], v[246:247]
v_cvt_pk_bf16_f32 v239, v162, v163
ds_write_b128 v8, v[236:239] offset:1024
v_cvt_pk_bf16_f32 v192, v100, v101
v_pk_fma_f32 v[102:103], v[38:39], v[228:229], v[102:103] op_sel_hi:[1,0,1]
v_pk_mul_f32 v[102:103], v[102:103], v[228:229] op_sel:[0,1] op_sel_hi:[1,1]
v_cvt_pk_bf16_f32 v193, v102, v103
v_pk_fma_f32 v[116:117], v[40:41], v[228:229], v[116:117] op_sel_hi:[1,0,1]
v_pk_mul_f32 v[116:117], v[116:117], v[228:229] op_sel:[0,1] op_sel_hi:[1,1]
v_cvt_pk_bf16_f32 v194, v116, v117
v_pk_fma_f32 v[118:119], v[42:43], v[228:229], v[118:119] op_sel_hi:[1,0,1]
v_pk_mul_f32 v[118:119], v[118:119], v[228:229] op_sel:[0,1] op_sel_hi:[1,1]
v_cvt_pk_bf16_f32 v195, v118, v119
v_pk_fma_f32 v[96:97], v[36:37], v[224:225], v[96:97] op_sel_hi:[1,0,1]
v_pk_mul_f32 v[96:97], v[96:97], v[224:225] op_sel:[0,1] op_sel_hi:[1,1]
v_cvt_pk_bf16_f32 v188, v96, v97
v_pk_fma_f32 v[98:99], v[38:39], v[224:225], v[98:99] op_sel_hi:[1,0,1]
v_pk_mul_f32 v[98:99], v[98:99], v[224:225] op_sel:[0,1] op_sel_hi:[1,1]
v_cvt_pk_bf16_f32 v189, v98, v99
v_pk_fma_f32 v[112:113], v[40:41], v[224:225], v[112:113] op_sel_hi:[1,0,1]
v_pk_mul_f32 v[112:113], v[112:113], v[224:225] op_sel:[0,1] op_sel_hi:[1,1]
v_cvt_pk_bf16_f32 v190, v112, v113
v_pk_fma_f32 v[114:115], v[42:43], v[224:225], v[114:115] op_sel_hi:[1,0,1]
v_pk_mul_f32 v[114:115], v[114:115], v[224:225] op_sel:[0,1] op_sel_hi:[1,1]
v_cvt_pk_bf16_f32 v191, v114, v115
v_pk_fma_f32 v[92:93], v[36:37], v[220:221], v[92:93] op_sel_hi:[1,0,1]
v_pk_mul_f32 v[92:93], v[92:93], v[220:221] op_sel:[0,1] op_sel_hi:[1,1]
v_cvt_pk_bf16_f32 v184, v92, v93
v_pk_fma_f32 v[94:95], v[38:39], v[220:221], v[94:95] op_sel_hi:[1,0,1]
v_pk_mul_f32 v[94:95], v[94:95], v[220:221] op_sel:[0,1] op_sel_hi:[1,1]
v_cvt_pk_bf16_f32 v185, v94, v95
v_pk_fma_f32 v[108:109], v[40:41], v[220:221], v[108:109] op_sel_hi:[1,0,1]
v_pk_mul_f32 v[108:109], v[108:109], v[220:221] op_sel:[0,1] op_sel_hi:[1,1]
v_cvt_pk_bf16_f32 v186, v108, v109
v_pk_fma_f32 v[110:111], v[42:43], v[220:221], v[110:111] op_sel_hi:[1,0,1]
v_pk_mul_f32 v[110:111], v[110:111], v[220:221] op_sel:[0,1] op_sel_hi:[1,1]
v_cvt_pk_bf16_f32 v187, v110, v111
v_cvt_pk_bf16_f32 v179, v90, v91
v_pk_fma_f32 v[68:69], v[28:29], v[228:229], v[68:69] op_sel_hi:[1,0,1]
v_cvt_pk_bf16_f32 v172, v68, v69
v_pk_fma_f32 v[70:71], v[30:31], v[228:229], v[70:71] op_sel_hi:[1,0,1]
v_cvt_pk_bf16_f32 v173, v70, v71
v_pk_fma_f32 v[84:85], v[32:33], v[228:229], v[84:85] op_sel_hi:[1,0,1]
v_cvt_pk_bf16_f32 v174, v84, v85
v_pk_fma_f32 v[86:87], v[34:35], v[228:229], v[86:87] op_sel_hi:[1,0,1]
v_cvt_pk_bf16_f32 v175, v86, v87
v_pk_fma_f32 v[64:65], v[28:29], v[224:225], v[64:65] op_sel_hi:[1,0,1]
v_cvt_pk_bf16_f32 v168, v64, v65
v_pk_fma_f32 v[66:67], v[30:31], v[224:225], v[66:67] op_sel_hi:[1,0,1]
v_cvt_pk_bf16_f32 v169, v66, v67
v_pk_fma_f32 v[80:81], v[32:33], v[224:225], v[80:81] op_sel_hi:[1,0,1]
v_cvt_pk_bf16_f32 v170, v80, v81
.Lpad10:
s_cbranch_execz .Lt0r
v_pk_fma_f32 v[82:83], v[34:35], v[224:225], v[82:83] op_sel_hi:[1,0,1]
v_cvt_pk_bf16_f32 v171, v82, v83
v_pk_fma_f32 v[60:61], v[28:29], v[220:221], v[60:61] op_sel_hi:[1,0,1]
v_cvt_pk_bf16_f32 v164, v60, v61
v_pk_fma_f32 v[62:63], v[30:31], v[220:221], v[62:63] op_sel_hi:[1,0,1]
v_cvt_pk_bf16_f32 v165, v62, v63
v_pk_fma_f32 v[76:77], v[32:33], v[220:221], v[76:77] op_sel_hi:[1,0,1]
v_cvt_pk_bf16_f32 v166, v76, v77
v_pk_fma_f32 v[78:79], v[34:35], v[220:221], v[78:79] op_sel_hi:[1,0,1]
s_waitcnt lgkmcnt(0)
s_barrier
v_cvt_pk_bf16_f32 v167, v78, v79
v_mfma_f32_16x16x32_bf16 v[120:123], v[196:199], v[176:179], v[50:53]
ds_read_b128 v[180:183], v9
v_mfma_f32_16x16x32_bf16 v[104:107], v[192:195], v[176:179], v[46:49]
buffer_load_dwordx4 v6, s[24:27], s58 offen offset:1024 lds
v_mfma_f32_16x16x32_bf16 v[116:119], v[192:195], v[172:175], v[50:53]
ds_read_b64 v[200:201], v9 offset:1024
s_add_u32 m0, s59, 58240
v_mfma_f32_16x16x32_bf16 v[100:103], v[188:191], v[172:175], v[46:49]
ds_read_b64 v[210:211], v9 offset:1032
s_xor_b32 s58, s87, 1966080
v_mfma_f32_16x16x32_bf16 v[112:115], v[188:191], v[168:171], v[50:53]
ds_read_b128 v[240:243], v11 offset:384
v_max3_f32 v88, v104, v105, v106
v_mfma_f32_16x16x32_bf16 v[96:99], v[184:187], v[168:171], v[46:49]
buffer_load_dwordx4 v5, s[24:27], s58 offen lds
v_mfma_f32_16x16x32_bf16 v[108:111], v[184:187], v[164:167], v[50:53]
ds_read_b128 v[244:247], v11 offset:1408
v_max3_f32 v89, v107, v120, v121
v_max3_f32 v88, v88, v122, v123
v_max_f32 v90, v88, v89
v_max_f32 v89, v88, v89
v_max3_f32 v84, v100, v101, v102
v_max3_f32 v85, v103, v116, v117
s_waitcnt lgkmcnt(4)
v_mfma_f32_16x16x32_bf16 v[92:95], v[180:183], v[164:167], v[46:49]
ds_read_b128 v[28:31], v11 offset:320
v_permlane16_swap_b32 v90, v89
MAA 136,12,96
buffer_load_dwordx4 v6, s[24:27], s58 offen offset:1024 lds
MAA 136,32,100
ds_read_b128 v[32:35], v11 offset:1344
s_add_u32 m0, s59, 66560
MAA 136,52,160
ds_read_b128 v[36:39], v11 offset:256
s_xor_b32 s58, s87, 0
MAA 136,72,164
ds_read_b128 v[40:43], v11 offset:1280
v_max_f32 v88, v90, v89
MAA 152,72,172
buffer_load_dwordx4 v5, s[24:27], s58 offen lds
MAA 152,52,168
v_max_f32 v89, v90, v89
v_max3_f32 v84, v84, v118, v119
MAA 152,32,124
v_permlane32_swap_b32 v88, v89
MAA 152,12,120
v_max_f32 v88, v88, v89
v_mul_f32 v88, v88, v234
v_max_f32 v86, v84, v85
v_max_f32 v85, v84, v85
v_max3_f32 v80, v96, v97, v98
v_max3_f32 v81, v99, v112, v113
v_permlane16_swap_b32 v86, v85
v_max3_f32 v80, v80, v114, v115
v_max_f32 v84, v86, v85
v_max_f32 v85, v86, v85
v_max_f32 v82, v80, v81
v_max_f32 v81, v80, v81
v_permlane32_swap_b32 v84, v85
v_max3_f32 v76, v92, v93, v94
v_max_f32 v84, v84, v85
v_mul_f32 v84, v84, v230
v_permlane16_swap_b32 v82, v81
v_max3_f32 v77, v95, v108, v109
v_max_f32 v80, v82, v81
v_max_f32 v81, v82, v81
v_max3_f32 v76, v76, v110, v111
v_max_f32 v78, v76, v77
v_permlane32_swap_b32 v80, v81
v_max_f32 v77, v76, v77
v_max_f32 v80, v80, v81
v_mul_f32 v80, v80, v226
v_permlane16_swap_b32 v78, v77
v_pk_fma_f32 v[104:105], v[104:105], v[234:235], v[88:89] op_sel_hi:[1,0,0] neg_lo:[0,0,1] neg_hi:[0,0,1]
v_max_f32 v76, v78, v77
v_max_f32 v77, v78, v77
v_pk_fma_f32 v[106:107], v[106:107], v[234:235], v[88:89] op_sel_hi:[1,0,0] neg_lo:[0,0,1] neg_hi:[0,0,1]
v_pk_fma_f32 v[120:121], v[120:121], v[234:235], v[88:89] op_sel_hi:[1,0,0] neg_lo:[0,0,1] neg_hi:[0,0,1]
v_permlane32_swap_b32 v76, v77
v_pk_fma_f32 v[122:123], v[122:123], v[234:235], v[88:89] op_sel_hi:[1,0,0] neg_lo:[0,0,1] neg_hi:[0,0,1]
v_max_f32 v76, v76, v77
v_mul_f32 v76, v76, v222
v_pk_fma_f32 v[100:101], v[100:101], v[230:231], v[84:85] op_sel_hi:[1,0,0] neg_lo:[0,0,1] neg_hi:[0,0,1]
v_pk_fma_f32 v[102:103], v[102:103], v[230:231], v[84:85] op_sel_hi:[1,0,0] neg_lo:[0,0,1] neg_hi:[0,0,1]
v_pk_fma_f32 v[116:117], v[116:117], v[230:231], v[84:85] op_sel_hi:[1,0,0] neg_lo:[0,0,1] neg_hi:[0,0,1]
v_pk_fma_f32 v[118:119], v[118:119], v[230:231], v[84:85] op_sel_hi:[1,0,0] neg_lo:[0,0,1] neg_hi:[0,0,1]
v_pk_fma_f32 v[96:97], v[96:97], v[226:227], v[80:81] op_sel_hi:[1,0,0] neg_lo:[0,0,1] neg_hi:[0,0,1]
v_pk_fma_f32 v[98:99], v[98:99], v[226:227], v[80:81] op_sel_hi:[1,0,0] neg_lo:[0,0,1] neg_hi:[0,0,1]
v_pk_fma_f32 v[112:113], v[112:113], v[226:227], v[80:81] op_sel_hi:[1,0,0] neg_lo:[0,0,1] neg_hi:[0,0,1]
v_pk_fma_f32 v[114:115], v[114:115], v[226:227], v[80:81] op_sel_hi:[1,0,0] neg_lo:[0,0,1] neg_hi:[0,0,1]
v_pk_fma_f32 v[92:93], v[92:93], v[222:223], v[76:77] op_sel_hi:[1,0,0] neg_lo:[0,0,1] neg_hi:[0,0,1]
v_pk_fma_f32 v[94:95], v[94:95], v[222:223], v[76:77] op_sel_hi:[1,0,0] neg_lo:[0,0,1] neg_hi:[0,0,1]
v_pk_fma_f32 v[108:109], v[108:109], v[222:223], v[76:77] op_sel_hi:[1,0,0] neg_lo:[0,0,1] neg_hi:[0,0,1]
v_pk_fma_f32 v[110:111], v[110:111], v[222:223], v[76:77] op_sel_hi:[1,0,0] neg_lo:[0,0,1] neg_hi:[0,0,1]
v_pk_fma_f32 v[136:137], v[18:19], v[44:45], v[136:137] op_sel_hi:[1,0,1]
v_pk_mul_f32 v[136:137], v[136:137], v[22:23]
v_pk_fma_f32 v[138:139], v[20:21], v[44:45], v[138:139] op_sel_hi:[1,0,1]
v_pk_mul_f32 v[138:139], v[138:139], v[24:25]
v_pk_fma_f32 v[152:153], v[18:19], v[44:45], v[152:153] op_sel:[0,1,0] op_sel_hi:[1,1,1]
v_pk_mul_f32 v[152:153], v[152:153], v[22:23]
v_pk_fma_f32 v[154:155], v[20:21], v[44:45], v[154:155] op_sel:[0,1,0] op_sel_hi:[1,1,1]
v_pk_mul_f32 v[154:155], v[154:155], v[24:25]
v_exp_f32 v104, v104
s_nop 0
MAA 132,8,96
buffer_load_dwordx4 v6, s[24:27], s58 offen offset:1024 lds
MAA 132,28,100
s_add_u32 m0, s59, 116480
s_xor_b32 s58, s87, 786432
v_exp_f32 v105, v105
MAA 132,48,160
v_exp_f32 v106, v106
MAA 132,68,164
v_exp_f32 v107, v107
MAA 148,68,172
buffer_load_dwordx4 v5, s[24:27], s58 offen lds
MAA 148,48,168
v_exp_f32 v120, v120
MAA 148,28,124
v_exp_f32 v121, v121
MAA 148,8,120
v_exp_f32 v122, v122
MAA 128,4,96
buffer_load_dwordx4 v6, s[24:27], s58 offen offset:1024 lds
MAA 128,24,100
s_add_u32 m0, s59, 124800
s_xor_b32 s58, s87, 917504
v_exp_f32 v123, v123
MAA 128,44,160
v_exp_f32 v100, v100
MAA 128,64,164
v_exp_f32 v101, v101
MAA 144,64,172
buffer_load_dwordx4 v5, s[24:27], s58 offen lds
MAA 144,44,168
v_exp_f32 v102, v102
MAA 144,24,124
v_exp_f32 v103, v103
MAA 144,4,120
v_exp_f32 v116, v116
MAA 124,0,96
buffer_load_dwordx4 v6, s[24:27], s58 offen offset:1024 lds
MAA 124,20,100
v_exp_f32 v117, v117
MAA 124,40,160
v_exp_f32 v118, v118
MAA 124,60,164
v_exp_f32 v119, v119
MAA 140,60,172
v_exp_f32 v96, v96
MAA 140,40,168
v_exp_f32 v97, v97
MAA 140,20,124
v_exp_f32 v98, v98
MAA 140,0,120
v_cvt_pk_bf16_f32 v72, v104, v105
v_cvt_pk_bf16_f32 v73, v106, v107
v_cvt_pk_bf16_f32 v74, v120, v121
v_cvt_pk_bf16_f32 v75, v122, v123
v_cvt_pk_bf16_f32 v68, v100, v101
v_cvt_pk_bf16_f32 v69, v102, v103
v_cvt_pk_bf16_f32 v70, v116, v117
v_cvt_pk_bf16_f32 v71, v118, v119
v_exp_f32 v99, v99
v_exp_f32 v112, v112
v_exp_f32 v113, v113
v_exp_f32 v114, v114
v_exp_f32 v115, v115
v_cvt_pk_bf16_f32 v64, v96, v97
v_cvt_pk_bf16_f32 v65, v98, v99
v_cvt_pk_bf16_f32 v66, v112, v113
v_cvt_pk_bf16_f32 v67, v114, v115
v_cvt_pk_bf16_f32 v208, v136, v137
v_cvt_pk_bf16_f32 v209, v138, v139
v_cvt_pk_bf16_f32 v218, v152, v153
v_cvt_pk_bf16_f32 v219, v154, v155
s_waitcnt lgkmcnt(5)
v_pk_fma_f32 v[132:133], v[240:241], v[44:45], v[132:133] op_sel_hi:[1,0,1]
s_waitcnt lgkmcnt(4)
v_pk_mul_f32 v[132:133], v[132:133], v[244:245]
v_cvt_pk_bf16_f32 v206, v132, v133
v_pk_fma_f32 v[134:135], v[242:243], v[44:45], v[134:135] op_sel_hi:[1,0,1]
v_pk_mul_f32 v[134:135], v[134:135], v[246:247]
v_cvt_pk_bf16_f32 v207, v134, v135
v_pk_fma_f32 v[148:149], v[240:241], v[44:45], v[148:149] op_sel:[0,1,0] op_sel_hi:[1,1,1]
v_pk_mul_f32 v[148:149], v[148:149], v[244:245]
v_cvt_pk_bf16_f32 v216, v148, v149
v_pk_fma_f32 v[150:151], v[242:243], v[44:45], v[150:151] op_sel:[0,1,0] op_sel_hi:[1,1,1]
v_pk_mul_f32 v[150:151], v[150:151], v[246:247]
v_cvt_pk_bf16_f32 v217, v150, v151
s_waitcnt lgkmcnt(3)
v_pk_fma_f32 v[128:129], v[28:29], v[44:45], v[128:129] op_sel_hi:[1,0,1]
s_waitcnt lgkmcnt(2)
v_pk_mul_f32 v[128:129], v[128:129], v[32:33]
v_cvt_pk_bf16_f32 v204, v128, v129
v_pk_fma_f32 v[130:131], v[30:31], v[44:45], v[130:131] op_sel_hi:[1,0,1]
v_pk_mul_f32 v[130:131], v[130:131], v[34:35]
v_cvt_pk_bf16_f32 v205, v130, v131
v_pk_fma_f32 v[144:145], v[28:29], v[44:45], v[144:145] op_sel:[0,1,0] op_sel_hi:[1,1,1]
v_pk_mul_f32 v[144:145], v[144:145], v[32:33]
v_cvt_pk_bf16_f32 v214, v144, v145
v_pk_fma_f32 v[146:147], v[30:31], v[44:45], v[146:147] op_sel:[0,1,0] op_sel_hi:[1,1,1]
v_pk_mul_f32 v[146:147], v[146:147], v[34:35]
v_cvt_pk_bf16_f32 v215, v146, v147
s_waitcnt lgkmcnt(1)
v_pk_fma_f32 v[124:125], v[36:37], v[44:45], v[124:125] op_sel_hi:[1,0,1]
s_waitcnt lgkmcnt(0)
v_pk_mul_f32 v[124:125], v[124:125], v[40:41]
v_cvt_pk_bf16_f32 v202, v124, v125
v_pk_fma_f32 v[126:127], v[38:39], v[44:45], v[126:127] op_sel_hi:[1,0,1]
v_pk_mul_f32 v[126:127], v[126:127], v[42:43]
v_cvt_pk_bf16_f32 v203, v126, v127
v_pk_fma_f32 v[140:141], v[36:37], v[44:45], v[140:141] op_sel:[0,1,0] op_sel_hi:[1,1,1]
v_pk_mul_f32 v[140:141], v[140:141], v[40:41]
v_cvt_pk_bf16_f32 v212, v140, v141
v_pk_fma_f32 v[142:143], v[38:39], v[44:45], v[142:143] op_sel:[0,1,0] op_sel_hi:[1,1,1]
v_pk_mul_f32 v[142:143], v[142:143], v[42:43]
v_cvt_pk_bf16_f32 v213, v142, v143
s_nop 0
v_mfma_f32_16x16x32_bf16 v[88:91], v[248:251], v[72:75], 0
v_exp_f32 v92, v92
v_mfma_f32_16x16x32_bf16 v[104:107], v[206:209], v[72:75], 0
v_exp_f32 v93, v93
v_mfma_f32_16x16x32_bf16 v[120:123], v[216:219], v[72:75], 0
v_exp_f32 v94, v94
v_mfma_f32_16x16x32_bf16 v[84:87], v[248:251], v[68:71], 0
v_exp_f32 v95, v95
v_mfma_f32_16x16x32_bf16 v[100:103], v[204:207], v[68:71], 0
v_exp_f32 v108, v108
v_mfma_f32_16x16x32_bf16 v[116:119], v[214:217], v[68:71], 0
v_exp_f32 v109, v109
v_mfma_f32_16x16x32_bf16 v[80:83], v[248:251], v[64:67], 0
v_exp_f32 v110, v110
v_mfma_f32_16x16x32_bf16 v[96:99], v[202:205], v[64:67], 0
v_exp_f32 v111, v111
v_mfma_f32_16x16x32_bf16 v[112:115], v[212:215], v[64:67], 0
v_cvt_pk_bf16_f32 v60, v92, v93
v_cvt_pk_bf16_f32 v61, v94, v95
v_cvt_pk_bf16_f32 v62, v108, v109
v_cvt_pk_bf16_f32 v63, v110, v111
v_rcp_f32 v88, v88
v_rcp_f32 v84, v84
v_mfma_f32_16x16x32_bf16 v[76:79], v[248:251], v[60:63], 0
v_rcp_f32 v80, v80
v_mfma_f32_16x16x32_bf16 v[92:95], v[200:203], v[60:63], 0
v_mfma_f32_16x16x32_bf16 v[108:111], v[210:213], v[60:63], 0
s_nop 4
v_rcp_f32 v76, v76
v_pk_mul_f32 v[104:105], v[104:105], v[88:89] op_sel_hi:[1,0]
v_pk_mul_f32 v[106:107], v[106:107], v[88:89] op_sel_hi:[1,0]
v_pk_mul_f32 v[120:121], v[120:121], v[88:89] op_sel_hi:[1,0]
v_pk_mul_f32 v[122:123], v[122:123], v[88:89] op_sel_hi:[1,0]
v_cvt_pk_bf16_f32 v176, v104, v105
v_cvt_pk_bf16_f32 v177, v106, v107
v_cvt_pk_bf16_f32 v178, v120, v121
v_cvt_pk_bf16_f32 v179, v122, v123
buffer_store_dwordx4 v[176:179], v4, s[16:19], s74 offen offset:3072 sc1
v_pk_mul_f32 v[100:101], v[100:101], v[84:85] op_sel_hi:[1,0]
v_pk_mul_f32 v[102:103], v[102:103], v[84:85] op_sel_hi:[1,0]
v_pk_mul_f32 v[116:117], v[116:117], v[84:85] op_sel_hi:[1,0]
v_pk_mul_f32 v[118:119], v[118:119], v[84:85] op_sel_hi:[1,0]
v_cvt_pk_bf16_f32 v172, v100, v101
v_cvt_pk_bf16_f32 v173, v102, v103
v_cvt_pk_bf16_f32 v174, v116, v117
v_cvt_pk_bf16_f32 v175, v118, v119
buffer_store_dwordx4 v[172:175], v4, s[16:19], s74 offen offset:2048 sc1
v_pk_mul_f32 v[96:97], v[96:97], v[80:81] op_sel_hi:[1,0]
v_pk_mul_f32 v[98:99], v[98:99], v[80:81] op_sel_hi:[1,0]
v_pk_mul_f32 v[112:113], v[112:113], v[80:81] op_sel_hi:[1,0]
v_pk_mul_f32 v[114:115], v[114:115], v[80:81] op_sel_hi:[1,0]
v_cvt_pk_bf16_f32 v168, v96, v97
v_cvt_pk_bf16_f32 v169, v98, v99
v_cvt_pk_bf16_f32 v170, v112, v113
v_cvt_pk_bf16_f32 v171, v114, v115
buffer_store_dwordx4 v[168:171], v4, s[16:19], s74 offen offset:1024 sc1
v_pk_mul_f32 v[92:93], v[92:93], v[76:77] op_sel_hi:[1,0]
v_pk_mul_f32 v[94:95], v[94:95], v[76:77] op_sel_hi:[1,0]
v_pk_mul_f32 v[108:109], v[108:109], v[76:77] op_sel_hi:[1,0]
v_pk_mul_f32 v[110:111], v[110:111], v[76:77] op_sel_hi:[1,0]
v_cvt_pk_bf16_f32 v164, v92, v93
v_cvt_pk_bf16_f32 v165, v94, v95
v_cvt_pk_bf16_f32 v166, v108, v109
v_cvt_pk_bf16_f32 v167, v110, v111
buffer_store_dwordx4 v[164:167], v4, s[16:19], s74 offen sc1
s_nop 1
.Lqkve2:
s_lshl_b32 s62, s3, 11
s_add_u32 s62, s62, s84
v_lshl_add_u32 v4, v1, 4, s62
v_lshrrev_b32 v2, 3, v1
v_cmp_eq_u32 vcc, 3, v2
v_add_u32 v2, 67108480, v4
s_nop 0
v_cndmask_b32 v4, v4, v2, vcc
v_bfe_u32 v5, v1, 3, 1
v_lshrrev_b32 v2, 4, v1
v_lshl_add_u32 v5, v2, 3, v5
s_lshl_b32 s62, s3, 1
v_add_u32 v5, s62, v5
v_mul_u32_u24 v5, 2048, v5
v_and_b32 v2, 7, v1
v_lshl_add_u32 v5, v2, 4, v5
s_lshl_b32 s62, s7, 7
v_add_u32 v5, s62, v5
v_add_u32 v6, 64512, v5
v_bfe_u32 v8, v1, 3, 2
v_mul_u32_u24 v8, 2080, v8
v_bfe_u32 v2, v1, 2, 1
v_lshl_add_u32 v8, v2, 7, v8
v_bfe_u32 v2, v1, 5, 1
v_lshl_add_u32 v8, v2, 8, v8
v_and_b32 v2, 3, v1
v_lshl_add_u32 v8, v2, 3, v8
s_mov_b32 s57, 66560
v_add_u32 v7, s57, v8
s_lshr_b32 s54, s87, 17
s_lshl_b32 s54, s54, 18
s_add_u32 s54, s54, 4194304
s_mov_b32 s52, s54
s_add_u32 s53, s54, 131072
v_accvgpr_read_b32 v32, a224
v_accvgpr_read_b32 v33, a225
v_accvgpr_read_b32 v34, a226
v_accvgpr_read_b32 v35, a227
v_accvgpr_read_b32 v36, a228
v_accvgpr_read_b32 v37, a229
v_accvgpr_read_b32 v38, a230
v_accvgpr_read_b32 v39, a231
v_accvgpr_read_b32 v40, a232
v_accvgpr_read_b32 v41, a233
v_accvgpr_read_b32 v42, a234
v_accvgpr_read_b32 v43, a235
v_accvgpr_read_b32 v44, a236
v_accvgpr_read_b32 v45, a237
v_accvgpr_read_b32 v46, a238
v_accvgpr_read_b32 v47, a239
v_accvgpr_read_b32 v48, a240
v_accvgpr_read_b32 v49, a241
v_accvgpr_read_b32 v50, a242
v_accvgpr_read_b32 v51, a243
v_accvgpr_read_b32 v52, a244
v_accvgpr_read_b32 v53, a245
v_accvgpr_read_b32 v54, a246
v_accvgpr_read_b32 v55, a247
v_accvgpr_read_b32 v56, a248
v_accvgpr_read_b32 v57, a249
v_accvgpr_read_b32 v58, a250
v_accvgpr_read_b32 v59, a251
v_accvgpr_read_b32 v60, a252
v_accvgpr_read_b32 v61, a253
v_accvgpr_read_b32 v62, a254
v_accvgpr_read_b32 v63, a255
s_lshl_b32 s62, s49, 3
s_add_u32 s62, s62, s48
s_mul_i32 s62, s62, 28672
s_add_u32 s62, s62, s51
v_lshrrev_b32 v12, 4, v1
v_mul_u32_u24 v12, 57344, v12
v_and_b32 v2, 15, v1
v_lshl_add_u32 v12, v2, 4, v12
v_add_u32 v12, s62, v12
v_add_u32 v13, 6112, v12
v_add_u32 v14, 12224, v12
v_add_u32 v15, 18336, v12
s_mul_i32 s59, s3, 4224
s_mov_b32 s58, 0
s_mov_b32 s36, s0
s_mov_b32 s37, s1
s_lshl_b32 s62, s8, 10
s_add_u32 s62, s62, 30425088
s_lshl_b32 s64, s6, 10
s_add_u32 s64, s64, 30425088
s_lshr_b32 s67, s5, 2
s_and_b32 s67, s67, 3
s_lshl_b32 s67, s67, 7
s_add_u32 s64, s64, s67
v_lshl_add_u32 v252, v1, 7, s62
v_mov_b32 v253, s64
v_mov_b32 v255, 1
s_waitcnt vmcnt(0) lgkmcnt(0)
s_cmp_lg_u32 s3, 1
s_barrier
s_cbranch_scc1 .Lfirst35
s_mov_b64 exec, 15
buffer_atomic_add v255, v252, s[16:19], 0 offen
s_mov_b64 exec, 1
v_mov_b32 v254, 0
buffer_atomic_add v254, v253, s[16:19], 0 offen sc0
s_mov_b64 exec, -1
.Lfirst35:
ds_read_b64_tr_b16 a[0:1], v7
TR 2,7,512
TR 16,7,1024
TR 18,7,1536
TR 4,7,32
TR 6,7,544
TR 20,7,1056
TR 22,7,1568
TR 8,7,64
TR 10,7,576
TR 24,7,1088
TR 26,7,1600
TR 12,7,96
TR 14,7,608
TR 28,7,1120
TR 30,7,1632
s_waitcnt lgkmcnt(0)
s_cmp_lg_u32 s3, 1
s_cbranch_scc1 .Lnopoll34
s_mov_b64 exec, 1
s_mov_b32 s15, 0
.Lpoll33:
v_mov_b32 v255, 0
buffer_atomic_add v255, v253, s[16:19], 0 offen sc0
s_waitcnt vmcnt(1)
v_cmp_gt_u32 vcc, 16, v254
s_add_u32 s15, s15, 1
s_cbranch_vccz .Lnopoll34r
v_mov_b32 v254, 0
buffer_atomic_add v254, v253, s[16:19], 0 offen sc0
s_waitcnt vmcnt(1)
v_cmp_gt_u32 vcc, 16, v255
s_add_u32 s15, s15, 1
s_cbranch_vccz .Lnopoll34r
s_cmp_le_u32 s15, 100000
s_cbranch_scc1 .Lpoll33
s_branch .Lnopoll34r
.Lnopoll34:
s_mov_b64 exec, 0
s_cmp_eq_u32 s3, 2
s_cbranch_scc1 .Lpad11
s_cmp_eq_u32 s3, 3
s_cbranch_scc1 .Lpad12
s_branch .Lpad13
.Lnopoll34r:
s_mov_b64 exec, -1
s_barrier
buffer_load_dwordx4 v[64:67], v4, s[16:19], s52 offen sc1
buffer_load_dwordx4 v[68:71], v4, s[16:19], s52 offen offset:1024 sc1
s_xor_b32 s52, s54, 262144
buffer_load_dwordx4 v[72:75], v4, s[16:19], s53 offen sc1
buffer_load_dwordx4 v[76:79], v4, s[16:19], s53 offen offset:1024 sc1
s_xor_b32 s53, s54, 393216
buffer_load_dwordx4 v[80:83], v4, s[16:19], s52 offen sc1
buffer_load_dwordx4 v[84:87], v4, s[16:19], s52 offen offset:1024 sc1
s_xor_b32 s52, s54, 524288
buffer_load_dwordx4 v[88:91], v4, s[16:19], s53 offen sc1
buffer_load_dwordx4 v[92:95], v4, s[16:19], s53 offen offset:1024 sc1
s_xor_b32 s53, s54, 655360
buffer_load_dwordx4 v[96:99], v4, s[16:19], s52 offen sc1
buffer_load_dwordx4 v[100:103], v4, s[16:19], s52 offen offset:1024 sc1
s_xor_b32 s52, s54, 786432
buffer_load_dwordx4 v[104:107], v4, s[16:19], s53 offen sc1
buffer_load_dwordx4 v[108:111], v4, s[16:19], s53 offen offset:1024 sc1
s_xor_b32 s53, s54, 917504
s_waitcnt vmcnt(8)
MAV 32,0,64
TR 32,7,8320
MAV 32,16,72
buffer_load_dwordx4 v[112:115], v4, s[16:19], s52 offen sc1
MAV 48,16,76
TR 34,7,8832
MAV 48,0,68
TR 48,7,9344
TR 50,7,9856
MAV 52,4,68
TR 36,7,8352
MAV 52,20,76
buffer_load_dwordx4 v[116:119], v4, s[16:19], s52 offen offset:1024 sc1
MAV 36,20,72
TR 38,7,8864
s_xor_b32 s52, s54, 1048576
MAV 36,4,64
TR 52,7,9376
TR 54,7,9888
MAV 40,8,64
TR 40,7,8384
MAV 40,24,72
buffer_load_dwordx4 v[120:123], v4, s[16:19], s53 offen sc1
MAV 56,24,76
TR 42,7,8896
MAV 56,8,68
TR 56,7,9408
TR 58,7,9920
MAV 60,12,68
TR 44,7,8416
MAV 60,28,76
buffer_load_dwordx4 v[124:127], v4, s[16:19], s53 offen offset:1024 sc1
MAV 44,28,72
TR 46,7,8928
s_xor_b32 s53, s54, 1179648
MAV 44,12,64
TR 60,7,9440
TR 62,7,9952
s_waitcnt vmcnt(8) lgkmcnt(8)
MAV 32,32,80
TR 0,7,16640
MAV 32,48,88
buffer_load_dwordx4 v[64:67], v4, s[16:19], s52 offen sc1
MAV 48,48,92
TR 2,7,17152
MAV 48,32,84
TR 16,7,17664
TR 18,7,18176
MAV 52,36,84
TR 4,7,16672
MAV 52,52,92
buffer_load_dwordx4 v[68:71], v4, s[16:19], s52 offen offset:1024 sc1
MAV 36,52,88
TR 6,7,17184
s_xor_b32 s52, s54, 1310720
MAV 36,36,80
TR 20,7,17696
TR 22,7,18208
s_waitcnt lgkmcnt(8)
MAV 40,40,80
TR 8,7,16704
MAV 40,56,88
buffer_load_dwordx4 v[72:75], v4, s[16:19], s53 offen sc1
MAV 56,56,92
TR 10,7,17216
MAV 56,40,84
TR 24,7,17728
TR 26,7,18240
MAV 60,44,84
TR 12,7,16736
MAV 60,60,92
buffer_load_dwordx4 v[76:79], v4, s[16:19], s53 offen offset:1024 sc1
MAV 44,60,88
TR 14,7,17248
s_xor_b32 s53, s54, 1441792
MAV 44,44,80
TR 28,7,17760
TR 30,7,18272
s_waitcnt vmcnt(8) lgkmcnt(8)
MAV 32,0,96
TR 32,7,24960
MAV 32,16,104
buffer_load_dwordx4 v[80:83], v4, s[16:19], s52 offen sc1
MAV 48,16,108
TR 34,7,25472
MAV 48,0,100
TR 48,7,25984
TR 50,7,26496
MAV 52,4,100
TR 36,7,24992
MAV 52,20,108
buffer_load_dwordx4 v[84:87], v4, s[16:19], s52 offen offset:1024 sc1
MAV 36,20,104
TR 38,7,25504
s_xor_b32 s52, s54, 1572864
MAV 36,4,96
TR 52,7,26016
TR 54,7,26528
s_waitcnt lgkmcnt(8)
MAV 40,8,96
TR 40,7,25024
MAV 40,24,104
buffer_load_dwordx4 v[88:91], v4, s[16:19], s53 offen sc1
MAV 56,24,108
TR 42,7,25536
MAV 56,8,100
TR 56,7,26048
TR 58,7,26560
MAV 60,12,100
TR 44,7,25056
MAV 60,28,108
buffer_load_dwordx4 v[92:95], v4, s[16:19], s53 offen offset:1024 sc1
MAV 44,28,104
TR 46,7,25568
s_xor_b32 s53, s54, 1703936
MAV 44,12,96
TR 60,7,26080
TR 62,7,26592
s_waitcnt vmcnt(8) lgkmcnt(8)
MAV 32,32,112
TR 0,7,33280
MAV 32,48,120
buffer_load_dwordx4 v[96:99], v4, s[16:19], s52 offen sc1
MAV 48,48,124
TR 2,7,33792
MAV 48,32,116
.Lpad11:
s_cbranch_execz .Lpad14
TR 16,7,34304
TR 18,7,34816
MAV 52,36,116
TR 4,7,33312
MAV 52,52,124
buffer_load_dwordx4 v[100:103], v4, s[16:19], s52 offen offset:1024 sc1
MAV 36,52,120
TR 6,7,33824
s_xor_b32 s52, s54, 1835008
MAV 36,36,112
TR 20,7,34336
TR 22,7,34848
s_waitcnt lgkmcnt(8)
MAV 40,40,112
TR 8,7,33344
MAV 40,56,120
buffer_load_dwordx4 v[104:107], v4, s[16:19], s53 offen sc1
MAV 56,56,124
TR 10,7,33856
MAV 56,40,116
TR 24,7,34368
TR 26,7,34880
MAV 60,44,116
TR 12,7,33376
MAV 60,60,124
buffer_load_dwordx4 v[108:111], v4, s[16:19], s53 offen offset:1024 sc1
MAV 44,60,120
TR 14,7,33888
s_xor_b32 s53, s54, 1966080
MAV 44,44,112
TR 28,7,34400
TR 30,7,34912
s_waitcnt vmcnt(8) lgkmcnt(8)
MAV 32,0,64
TR 32,7,41600
MAV 32,16,72
buffer_load_dwordx4 v[112:115], v4, s[16:19], s52 offen sc1
MAV 48,16,76
TR 34,7,42112
MAV 48,0,68
TR 48,7,42624
TR 50,7,43136
MAV 52,4,68
TR 36,7,41632
MAV 52,20,76
buffer_load_dwordx4 v[116:119], v4, s[16:19], s52 offen offset:1024 sc1
MAV 36,20,72
TR 38,7,42144
s_xor_b32 s52, s54, 2097152
MAV 36,4,64
TR 52,7,42656
TR 54,7,43168
s_waitcnt lgkmcnt(8)
MAV 40,8,64
TR 40,7,41664
MAV 40,24,72
buffer_load_dwordx4 v[120:123], v4, s[16:19], s53 offen sc1
MAV 56,24,76
TR 42,7,42176
MAV 56,8,68
TR 56,7,42688
TR 58,7,43200
MAV 60,12,68
TR 44,7,41696
MAV 60,28,76
buffer_load_dwordx4 v[124:127], v4, s[16:19], s53 offen offset:1024 sc1
MAV 44,28,72
TR 46,7,42208
s_xor_b32 s53, s54, 2228224
MAV 44,12,64
TR 60,7,42720
TR 62,7,43232
s_waitcnt vmcnt(8) lgkmcnt(8)
MAV 32,32,80
TR 0,7,49920
MAV 32,48,88
buffer_load_dwordx4 v[64:67], v4, s[16:19], s52 offen sc1
MAV 48,48,92
TR 2,7,50432
MAV 48,32,84
TR 16,7,50944
TR 18,7,51456
MAV 52,36,84
TR 4,7,49952
MAV 52,52,92
buffer_load_dwordx4 v[68:71], v4, s[16:19], s52 offen offset:1024 sc1
MAV 36,52,88
TR 6,7,50464
s_xor_b32 s52, s54, 2359296
MAV 36,36,80
TR 20,7,50976
TR 22,7,51488
s_waitcnt lgkmcnt(8)
MAV 40,40,80
TR 8,7,49984
MAV 40,56,88
buffer_load_dwordx4 v[72:75], v4, s[16:19], s53 offen sc1
MAV 56,56,92
TR 10,7,50496
MAV 56,40,84
TR 24,7,51008
TR 26,7,51520
MAV 60,44,84
TR 12,7,50016
MAV 60,60,92
buffer_load_dwordx4 v[76:79], v4, s[16:19], s53 offen offset:1024 sc1
MAV 44,60,88
TR 14,7,50528
s_xor_b32 s53, s54, 2490368
MAV 44,44,80
TR 28,7,51040
TR 30,7,51552
s_waitcnt vmcnt(8) lgkmcnt(8)
MAV 32,0,96
TR 32,7,58240
MAV 32,16,104
buffer_load_dwordx4 v[80:83], v4, s[16:19], s52 offen sc1
MAV 48,16,108
TR 34,7,58752
MAV 48,0,100
TR 48,7,59264
TR 50,7,59776
MAV 52,4,100
TR 36,7,58272
MAV 52,20,108
buffer_load_dwordx4 v[84:87], v4, s[16:19], s52 offen offset:1024 sc1
MAV 36,20,104
TR 38,7,58784
s_xor_b32 s52, s54, 2621440
MAV 36,4,96
TR 52,7,59296
TR 54,7,59808
s_waitcnt lgkmcnt(8)
MAV 40,8,96
TR 40,7,58304
MAV 40,24,104
buffer_load_dwordx4 v[88:91], v4, s[16:19], s53 offen sc1
MAV 56,24,108
TR 42,7,58816
MAV 56,8,100
TR 56,7,59328
TR 58,7,59840
MAV 60,12,100
TR 44,7,58336
MAV 60,28,108
buffer_load_dwordx4 v[92:95], v4, s[16:19], s53 offen offset:1024 sc1
MAV 44,28,104
TR 46,7,58848
s_xor_b32 s53, s54, 2752512
MAV 44,12,96
TR 60,7,59360
TR 62,7,59872
s_xor_b32 s57, s57, 66560
v_add_u32 v7, s57, v8
s_waitcnt vmcnt(8) lgkmcnt(8)
MAV 32,32,112
ds_read_b64_tr_b16 a[0:1], v7
MAV 32,48,120
buffer_load_dwordx4 v[96:99], v4, s[16:19], s52 offen sc1
MAV 48,48,124
TR 2,7,512
MAV 48,32,116
TR 16,7,1024
TR 18,7,1536
MAV 52,36,116
TR 4,7,32
MAV 52,52,124
buffer_load_dwordx4 v[100:103], v4, s[16:19], s52 offen offset:1024 sc1
MAV 36,52,120
TR 6,7,544
s_xor_b32 s52, s54, 2883584
MAV 36,36,112
TR 20,7,1056
TR 22,7,1568
s_waitcnt lgkmcnt(8)
MAV 40,40,112
TR 8,7,64
MAV 40,56,120
buffer_load_dwordx4 v[104:107], v4, s[16:19], s53 offen sc1
MAV 56,56,124
TR 10,7,576
MAV 56,40,116
TR 24,7,1088
TR 26,7,1600
MAV 60,44,116
TR 12,7,96
MAV 60,60,124
buffer_load_dwordx4 v[108:111], v4, s[16:19], s53 offen offset:1024 sc1
MAV 44,60,120
TR 14,7,608
s_xor_b32 s53, s54, 3014656
MAV 44,44,112
TR 28,7,1120
TR 30,7,1632
s_waitcnt vmcnt(8) lgkmcnt(8)
MAV 32,0,64
TR 32,7,8320
MAV 32,16,72
buffer_load_dwordx4 v[112:115], v4, s[16:19], s52 offen sc1
MAV 48,16,76
TR 34,7,8832
MAV 48,0,68
TR 48,7,9344
TR 50,7,9856
MAV 52,4,68
TR 36,7,8352
MAV 52,20,76
buffer_load_dwordx4 v[116:119], v4, s[16:19], s52 offen offset:1024 sc1
MAV 36,20,72
TR 38,7,8864
s_xor_b32 s52, s54, 3145728
MAV 36,4,64
TR 52,7,9376
TR 54,7,9888
s_waitcnt lgkmcnt(8)
MAV 40,8,64
TR 40,7,8384
MAV 40,24,72
buffer_load_dwordx4 v[120:123], v4, s[16:19], s53 offen sc1
MAV 56,24,76
TR 42,7,8896
MAV 56,8,68
TR 56,7,9408
TR 58,7,9920
MAV 60,12,68
TR 44,7,8416
MAV 60,28,76
buffer_load_dwordx4 v[124:127], v4, s[16:19], s53 offen offset:1024 sc1
MAV 44,28,72
TR 46,7,8928
s_xor_b32 s53, s54, 3276800
MAV 44,12,64
TR 60,7,9440
TR 62,7,9952
s_waitcnt vmcnt(8) lgkmcnt(8)
MAV 32,32,80
TR 0,7,16640
MAV 32,48,88
buffer_load_dwordx4 v[64:67], v4, s[16:19], s52 offen sc1
MAV 48,48,92
TR 2,7,17152
MAV 48,32,84
TR 16,7,17664
TR 18,7,18176
MAV 52,36,84
TR 4,7,16672
MAV 52,52,92
buffer_load_dwordx4 v[68:71], v4, s[16:19], s52 offen offset:1024 sc1
MAV 36,52,88
TR 6,7,17184
s_xor_b32 s52, s54, 3407872
MAV 36,36,80
TR 20,7,17696
TR 22,7,18208
s_waitcnt lgkmcnt(8)
MAV 40,40,80
TR 8,7,16704
MAV 40,56,88
buffer_load_dwordx4 v[72:75], v4, s[16:19], s53 offen sc1
MAV 56,56,92
TR 10,7,17216
MAV 56,40,84
TR 24,7,17728
TR 26,7,18240
MAV 60,44,84
TR 12,7,16736
MAV 60,60,92
buffer_load_dwordx4 v[76:79], v4, s[16:19], s53 offen offset:1024 sc1
MAV 44,60,88
TR 14,7,17248
s_xor_b32 s53, s54, 3538944
MAV 44,44,80
TR 28,7,17760
TR 30,7,18272
s_waitcnt vmcnt(8) lgkmcnt(8)
MAV 32,0,96
TR 32,7,24960
MAV 32,16,104
buffer_load_dwordx4 v[80:83], v4, s[16:19], s52 offen sc1
MAV 48,16,108
TR 34,7,25472
MAV 48,0,100
TR 48,7,25984
TR 50,7,26496
MAV 52,4,100
TR 36,7,24992
MAV 52,20,108
buffer_load_dwordx4 v[84:87], v4, s[16:19], s52 offen offset:1024 sc1
MAV 36,20,104
TR 38,7,25504
s_xor_b32 s52, s54, 3670016
MAV 36,4,96
TR 52,7,26016
TR 54,7,26528
s_waitcnt lgkmcnt(8)
MAV 40,8,96
TR 40,7,25024
MAV 40,24,104
buffer_load_dwordx4 v[88:91], v4, s[16:19], s53 offen sc1
MAV 56,24,108
TR 42,7,25536
MAV 56,8,100
TR 56,7,26048
TR 58,7,26560
MAV 60,12,100
TR 44,7,25056
MAV 60,28,108
buffer_load_dwordx4 v[92:95], v4, s[16:19], s53 offen offset:1024 sc1
MAV 44,28,104
TR 46,7,25568
s_xor_b32 s53, s54, 3801088
MAV 44,12,96
TR 60,7,26080
TR 62,7,26592
s_waitcnt vmcnt(8) lgkmcnt(8)
MAV 32,32,112
TR 0,7,33280
MAV 32,48,120
buffer_load_dwordx4 v[96:99], v4, s[16:19], s52 offen sc1
MAV 48,48,124
TR 2,7,33792
MAV 48,32,116
TR 16,7,34304
TR 18,7,34816
MAV 52,36,116
TR 4,7,33312
MAV 52,52,124
buffer_load_dwordx4 v[100:103], v4, s[16:19], s52 offen offset:1024 sc1
MAV 36,52,120
TR 6,7,33824
s_xor_b32 s52, s54, 3932160
MAV 36,36,112
TR 20,7,34336
TR 22,7,34848
s_waitcnt lgkmcnt(8)
MAV 40,40,112
TR 8,7,33344
MAV 40,56,120
buffer_load_dwordx4 v[104:107], v4, s[16:19], s53 offen sc1
MAV 56,56,124
TR 10,7,33856
MAV 56,40,116
TR 24,7,34368
TR 26,7,34880
MAV 60,44,116
TR 12,7,33376
MAV 60,60,124
buffer_load_dwordx4 v[108:111], v4, s[16:19], s53 offen offset:1024 sc1
MAV 44,60,120
TR 14,7,33888
s_xor_b32 s53, s54, 4063232
MAV 44,44,112
TR 28,7,34400
TR 30,7,34912
s_waitcnt vmcnt(8) lgkmcnt(8)
MAV 32,0,64
TR 32,7,41600
MAV 32,16,72
buffer_load_dwordx4 v[112:115], v4, s[16:19], s52 offen sc1
MAV 48,16,76
TR 34,7,42112
MAV 48,0,68
TR 48,7,42624
TR 50,7,43136
MAV 52,4,68
TR 36,7,41632
MAV 52,20,76
buffer_load_dwordx4 v[116:119], v4, s[16:19], s52 offen offset:1024 sc1
MAV 36,20,72
TR 38,7,42144
MAV 36,4,64
TR 52,7,42656
TR 54,7,43168
s_waitcnt lgkmcnt(8)
MAV 40,8,64
TR 40,7,41664
MAV 40,24,72
buffer_load_dwordx4 v[120:123], v4, s[16:19], s53 offen sc1
MAV 56,24,76
TR 42,7,42176
MAV 56,8,68
TR 56,7,42688
TR 58,7,43200
MAV 60,12,68
TR 44,7,41696
MAV 60,28,76
buffer_load_dwordx4 v[124:127], v4, s[16:19], s53 offen offset:1024 sc1
MAV 44,28,72
TR 46,7,42208
MAV 44,12,64
TR 60,7,42720
TR 62,7,43232
s_barrier
s_waitcnt vmcnt(8) lgkmcnt(8)
MAV 32,32,80
TR 0,7,49920
s_add_u32 m0, s59, 84480
MAV 32,48,88
buffer_load_dwordx4 v12, s[32:35], s58 offen   lds
MAV 48,48,92
TR 2,7,50432
MAV 48,32,84
TR 16,7,50944
TR 18,7,51456
MAV 52,36,84
TR 4,7,49952
MAV 52,52,92
buffer_load_dwordx4 v13, s[32:35], s58 offen offset:1056   lds
MAV 36,52,88
TR 6,7,50464
MAV 36,36,80
TR 20,7,50976
TR 22,7,51488
s_waitcnt lgkmcnt(8)
MAV 40,40,80
TR 8,7,49984
MAV 40,56,88
buffer_load_dwordx4 v14, s[32:35], s58 offen offset:2112   lds
MAV 56,56,92
TR 10,7,50496
MAV 56,40,84
TR 24,7,51008
TR 26,7,51520
MAV 60,44,84
TR 12,7,50016
MAV 60,60,92
buffer_load_dwordx4 v15, s[32:35], s58 offen offset:3168   lds
MAV 44,60,88
TR 14,7,50528
MAV 44,44,80
TR 28,7,51040
TR 30,7,51552
s_waitcnt vmcnt(8) lgkmcnt(8)
MAV 32,0,96
TR 32,7,58240
s_add_u32 m0, s59, 101376
MAV 32,16,104
buffer_load_dwordx4 v12, s[80:83], s58 offen   lds
MAV 48,16,108
TR 34,7,58752
MAV 48,0,100
TR 48,7,59264
TR 50,7,59776
MAV 52,4,100
TR 36,7,58272
MAV 52,20,108
buffer_load_dwordx4 v13, s[80:83], s58 offen offset:1056   lds
MAV 36,20,104
TR 38,7,58784
MAV 36,4,96
TR 52,7,59296
TR 54,7,59808
s_waitcnt lgkmcnt(8)
MAV 40,8,96
TR 40,7,58304
MAV 40,24,104
buffer_load_dwordx4 v14, s[80:83], s58 offen offset:2112   lds
MAV 56,24,108
TR 42,7,58816
MAV 56,8,100
TR 56,7,59328
TR 58,7,59840
MAV 60,12,100
TR 44,7,58336
MAV 60,28,108
buffer_load_dwordx4 v15, s[80:83], s58 offen offset:3168   lds
MAV 44,28,104
TR 46,7,58848
s_add_u32 s58, s58, 458752
MAV 44,12,96
TR 60,7,59360
TR 62,7,59872
s_waitcnt vmcnt(11) lgkmcnt(14)
MAV 32,32,112
s_add_u32 m0, s59, 118272
s_lshl_b32 s64, s6, 14
s_lshl_b32 s65, s49, 13
s_waitcnt vmcnt(9) lgkmcnt(12)
MAV 32,48,120
buffer_load_dwordx4 v12, s[32:35], s58 offen   lds
s_waitcnt vmcnt(9)
MAV 48,48,124
s_add_u32 s64, s64, s65
s_lshl_b32 s65, s7, 9
s_add_u32 s64, s64, s65
MAV 48,32,116
s_lshl_b32 s65, s48, 8
s_add_u32 s64, s64, s65
s_add_u32 s64, s64, 29622272
s_waitcnt lgkmcnt(10)
MAV 52,36,116
s_lshl_b32 s62, s7, 18
v_and_b32 v152, 31, v1
v_lshlrev_b32 v152, 3, v152
s_waitcnt lgkmcnt(8)
MAV 52,52,124
buffer_load_dwordx4 v13, s[32:35], s58 offen offset:1056   lds
MAV 36,52,120
s_add_u32 s62, s62, 8388608
v_lshrrev_b32 v153, 5, v1
v_lshl_add_u32 v152, v153, 28, v152
MAV 36,36,112
s_add_u32 s63, s62, 131072
v_cvt_pk_bf16_f32 v128, v32, v33
v_cvt_pk_bf16_f32 v129, v34, v35
s_waitcnt lgkmcnt(6)
MAV 40,40,112
v_cvt_pk_bf16_f32 v136, v48, v49
v_cvt_pk_bf16_f32 v137, v50, v51
s_waitcnt lgkmcnt(4)
MAV 40,56,120
buffer_load_dwordx4 v14, s[32:35], s58 offen offset:2112   lds
MAV 56,56,124
v_cvt_pk_bf16_f32 v130, v36, v37
v_cvt_pk_bf16_f32 v131, v38, v39
MAV 56,40,116
v_cvt_pk_bf16_f32 v138, v52, v53
v_cvt_pk_bf16_f32 v139, v54, v55
s_waitcnt lgkmcnt(2)
MAV 60,44,116
v_cvt_pk_bf16_f32 v132, v40, v41
v_cvt_pk_bf16_f32 v133, v42, v43
s_waitcnt lgkmcnt(0)
MAV 60,60,124
buffer_load_dwordx4 v15, s[32:35], s58 offen offset:3168   lds
MAV 44,60,120
v_cvt_pk_bf16_f32 v140, v56, v57
v_cvt_pk_bf16_f32 v141, v58, v59
MAV 44,44,112
s_nop 2
v_cvt_pk_bf16_f32 v142, v60, v61
v_cvt_pk_bf16_f32 v143, v62, v63
v_pk_mul_f32 v[146:147], v[32:33], v[32:33]
buffer_store_dwordx4 v[128:131], v4, s[16:19], s62 offen sc1
.Lpad12:
s_cbranch_execz .Lpad15
v_pk_mul_f32 v[150:151], v[48:49], v[48:49]
v_pk_fma_f32 v[146:147], v[34:35], v[34:35], v[146:147]
v_pk_add_f32 v[144:145], v[32:33], v[34:35]
v_pk_fma_f32 v[150:151], v[50:51], v[50:51], v[150:151]
v_cvt_pk_bf16_f32 v134, v44, v45
v_cvt_pk_bf16_f32 v135, v46, v47
v_pk_add_f32 v[148:149], v[48:49], v[50:51]
v_pk_fma_f32 v[146:147], v[36:37], v[36:37], v[146:147]
v_pk_add_f32 v[144:145], v[144:145], v[36:37]
v_pk_fma_f32 v[150:151], v[52:53], v[52:53], v[150:151]
v_pk_add_f32 v[148:149], v[148:149], v[52:53]
v_pk_fma_f32 v[146:147], v[38:39], v[38:39], v[146:147]
v_pk_add_f32 v[144:145], v[144:145], v[38:39]
buffer_store_dwordx4 v[132:135], v4, s[16:19], s63 offen sc1
v_pk_fma_f32 v[150:151], v[54:55], v[54:55], v[150:151]
v_pk_add_f32 v[148:149], v[148:149], v[54:55]
v_pk_fma_f32 v[146:147], v[40:41], v[40:41], v[146:147]
v_pk_add_f32 v[144:145], v[144:145], v[40:41]
v_pk_fma_f32 v[150:151], v[56:57], v[56:57], v[150:151]
v_pk_add_f32 v[148:149], v[148:149], v[56:57]
v_pk_fma_f32 v[146:147], v[42:43], v[42:43], v[146:147]
v_pk_add_f32 v[144:145], v[144:145], v[42:43]
v_pk_fma_f32 v[150:151], v[58:59], v[58:59], v[150:151]
v_pk_add_f32 v[148:149], v[148:149], v[58:59]
v_pk_fma_f32 v[146:147], v[44:45], v[44:45], v[146:147]
v_pk_add_f32 v[144:145], v[144:145], v[44:45]
v_pk_fma_f32 v[150:151], v[60:61], v[60:61], v[150:151]
buffer_store_dwordx4 v[136:139], v4, s[16:19], s62 offen offset:1024 sc1
v_pk_add_f32 v[148:149], v[148:149], v[60:61]
v_pk_fma_f32 v[146:147], v[46:47], v[46:47], v[146:147]
v_pk_add_f32 v[144:145], v[144:145], v[46:47]
v_pk_fma_f32 v[150:151], v[62:63], v[62:63], v[150:151]
v_pk_add_f32 v[148:149], v[148:149], v[62:63]
v_add_f32 v144, v144, v145
v_add_f32 v146, v146, v147
v_add_f32 v148, v148, v149
v_add_f32 v150, v150, v151
s_nop 0
v_permlane16_swap_b32 v144, v148
buffer_store_dwordx4 v[140:143], v4, s[16:19], s63 offen offset:1024 sc1
v_permlane16_swap_b32 v146, v150
v_add_f32 v144, v144, v148
v_add_f32 v146, v146, v150
s_nop 1
v_permlane32_swap_b32 v144, v146
v_add_f32 v144, v144, v146
s_nop 1
v_permlane32_swap_b32 v144, v145
buffer_store_dwordx2 v[144:145], v152, s[16:19], s64 offen sc1
s_nop 1
v_accvgpr_write_b32 a224, v32
v_accvgpr_write_b32 a225, v33
v_accvgpr_write_b32 a226, v34
v_accvgpr_write_b32 a227, v35
v_accvgpr_write_b32 a228, v36
v_accvgpr_write_b32 a229, v37
v_accvgpr_write_b32 a230, v38
v_accvgpr_write_b32 a231, v39
v_accvgpr_write_b32 a232, v40
v_accvgpr_write_b32 a233, v41
v_accvgpr_write_b32 a234, v42
v_accvgpr_write_b32 a235, v43
v_accvgpr_write_b32 a236, v44
v_accvgpr_write_b32 a237, v45
v_accvgpr_write_b32 a238, v46
v_accvgpr_write_b32 a239, v47
v_accvgpr_write_b32 a240, v48
v_accvgpr_write_b32 a241, v49
v_accvgpr_write_b32 a242, v50
v_accvgpr_write_b32 a243, v51
v_accvgpr_write_b32 a244, v52
v_accvgpr_write_b32 a245, v53
v_accvgpr_write_b32 a246, v54
v_accvgpr_write_b32 a247, v55
v_accvgpr_write_b32 a248, v56
v_accvgpr_write_b32 a249, v57
v_accvgpr_write_b32 a250, v58
v_accvgpr_write_b32 a251, v59
v_accvgpr_write_b32 a252, v60
v_accvgpr_write_b32 a253, v61
v_accvgpr_write_b32 a254, v62
v_accvgpr_write_b32 a255, v63
s_lshl_b32 s62, s10, 14
s_lshl_b32 s63, s3, 12
s_add_u32 s62, s62, s63
s_lshl_b32 s63, s12, 11
s_add_u32 s62, s62, s63
v_lshl_add_u32 v10, v1, 4, s62
v_lshrrev_b32 v2, 3, v1
v_cmp_eq_u32 vcc, 3, v2
v_add_u32 v2, 67108480, v10
s_nop 0
v_cndmask_b32 v10, v10, v2, vcc
v_xor_b32 v11, 2048, v10
v_bfe_u32 v16, v1, 2, 3
v_mul_u32_u24 v16, 1056, v16
v_bfe_u32 v2, v1, 5, 1
v_lshl_add_u32 v16, v2, 8, v16
v_and_b32 v2, 3, v1
v_lshl_add_u32 v16, v2, 3, v16
s_lshl_b32 s62, s12, 6
s_add_u32 s62, s62, 84480
s_xor_b32 s63, s12, 1
s_mul_i32 s63, s63, 192
s_add_u32 s63, s63, 84480
v_add_u32 v17, s63, v16
v_add_u32 v16, s62, v16
s_mov_b32 s52, 8388608
s_mov_b32 s53, 8388608
s_mov_b32 s54, s58
s_mov_b32 s55, s59
s_mul_i32 s59, s3, 2112
s_and_b32 s62, s7, 1
s_mul_i32 s62, s62, 3670016
s_lshr_b32 s63, s7, 1
s_lshl_b32 s63, s63, 8
s_add_u32 s62, s62, s63
s_lshl_b32 s63, s3, 12
s_add_u32 s62, s62, s63
v_lshrrev_b32 v5, 4, v1
v_lshlrev_b32 v5, 14, v5
v_and_b32 v2, 15, v1
v_lshl_add_u32 v5, v2, 4, v5
v_add_u32 v5, s62, v5
v_add_u32 v6, 992, v5
s_lshl_b32 s62, s10, 15
s_lshl_b32 s63, s3, 13
s_add_u32 s62, s62, s63
v_lshl_add_u32 v4, v1, 4, s62
s_and_b32 s47, s5, 3
s_lshr_b32 s63, s5, 2
s_lshl_b32 s63, s63, 3
s_add_u32 s63, s63, s4
s_lshl_b32 s62, s63, 1
s_add_u32 s62, s62, s48
s_mul_i32 s62, s62, 1792
v_lshrrev_b32 v7, 1, v1
v_min_u32 v8, 13, v7
v_lshl_add_u32 v8, v8, 7, s62
s_lshl_b32 s62, s63, 2
s_add_u32 s62, s62, s3
s_mul_i32 s62, s62, 640
v_and_b32 v7, 15, v7
v_min_u32 v7, 4, v7
v_lshl_add_u32 v7, v7, 7, s62
v_lshrrev_b32 v2, 5, v1
v_mul_u32_u24 v2, 3670016, v2
v_add_u32 v7, v7, v2
s_mul_i32 s44, s47, 163840
s_add_u32 s45, s47, 12
s_mul_i32 s45, s45, 229376
v_and_b32 v6, 3, v1
v_cmp_eq_u32 vcc, 3, v6
v_mov_b32 v2, 0x3f80
v_mov_b32 v20, 1.0
v_cndmask_b32 v2, v2, v20, vcc
v_cndmask_b32 v6, v6, 0, vcc
v_or_b32 v6, 12, v6
v_mul_u32_u24 v6, 0x1111, v6
v_lshl_or_b32 v6, v6, 16, v6
v_bfe_u32 v22, v1, 2, 2
v_cmp_eq_u32 vcc, 0, v22
s_nop 1
v_cndmask_b32 v20, 0, v2, vcc
v_cmp_eq_u32 vcc, 1, v22
s_nop 1
v_cndmask_b32 v21, 0, v2, vcc
v_accvgpr_write_b32 a208, v20
v_accvgpr_write_b32 a209, v21
v_accvgpr_write_b32 a210, v20
v_accvgpr_write_b32 a211, v21
v_accvgpr_write_b32 a212, 0
v_accvgpr_write_b32 a213, 0
v_accvgpr_write_b32 a214, 0
v_accvgpr_write_b32 a215, 0
v_accvgpr_write_b32 a216, 0
v_accvgpr_write_b32 a217, 0
v_accvgpr_write_b32 a218, 0
v_accvgpr_write_b32 a219, 0
s_cmp_lt_u32 s3, 2
s_cselect_b32 s40, s32, s80
s_cselect_b32 s41, s33, s81
s_cselect_b32 s42, s34, s82
s_add_u32 s62, s55, 84480
v_lshl_add_u32 v9, v1, 4, s62
s_lshl_b32 s62, s6, 10
s_add_u32 s62, s62, 30441472
s_lshl_b32 s64, s10, 1
s_lshl_b32 s64, s64, 10
s_add_u32 s64, s64, 30441472
s_lshr_b32 s67, s5, 2
s_and_b32 s67, s67, 3
s_lshl_b32 s67, s67, 7
s_add_u32 s64, s64, s67
s_add_u32 s65, s64, 1024
v_lshl_add_u32 v252, v1, 7, s62
v_mov_b32 v253, s64
v_mov_b32 v255, 1
v_writelane_b32 v253, s65, 1
s_waitcnt vmcnt(0) lgkmcnt(0)
s_cmp_lg_u32 s3, 1
s_barrier
s_cbranch_scc1 .Lfirst38
s_mov_b64 exec, 15
buffer_atomic_add v255, v252, s[16:19], 0 offen
s_mov_b64 exec, 3
v_mov_b32 v254, 0
buffer_atomic_add v254, v253, s[16:19], 0 offen sc0
s_mov_b64 exec, -1
.Lfirst38:
ds_read_b64_tr_b16 a[0:1], v16
TR 2,16,512
TR 4,16,8448
TR 6,16,8960
TR 8,16,32
TR 10,16,544
TR 12,16,8480
TR 14,16,8992
TR 16,16,64
TR 18,16,576
TR 20,16,8512
TR 22,16,9024
TR 24,16,96
TR 26,16,608
TR 28,16,8544
TR 30,16,9056
TR 32,16,128
TR 34,16,640
TR 36,16,8576
TR 38,16,9088
TR 40,16,160
TR 42,16,672
TR 44,16,8608
TR 46,16,9120
ds_read_b64_tr_b16 a[48:49], v17
TR 50,17,512
TR 52,17,8448
TR 54,17,8960
TR 56,17,32
TR 58,17,544
TR 60,17,8480
TR 62,17,8992
ds_read_b128 a[192:195], v9
RD 196,9,1056
RD 200,9,2112
RD 204,9,3168
s_waitcnt lgkmcnt(0)
s_cmp_lg_u32 s3, 1
s_cbranch_scc1 .Lnopoll37
s_mov_b64 exec, 3
s_mov_b32 s15, 0
.Lpoll36:
v_mov_b32 v255, 0
buffer_atomic_add v255, v253, s[16:19], 0 offen sc0
s_waitcnt vmcnt(1)
v_cmp_gt_u32 vcc, 16, v254
s_add_u32 s15, s15, 1
s_cbranch_vccz .Lnopoll37r
v_mov_b32 v254, 0
buffer_atomic_add v254, v253, s[16:19], 0 offen sc0
s_waitcnt vmcnt(1)
v_cmp_gt_u32 vcc, 16, v255
s_add_u32 s15, s15, 1
s_cbranch_vccz .Lnopoll37r
s_cmp_le_u32 s15, 100000
s_cbranch_scc1 .Lpoll36
s_branch .Lnopoll37r
.Lnopoll37:
s_mov_b64 exec, 0
s_cmp_eq_u32 s3, 2
s_cbranch_scc1 .Lpad17
s_cmp_eq_u32 s3, 3
s_cbranch_scc1 .Lpad18
s_branch .Lpad19
.Lnopoll37r:
s_mov_b64 exec, -1
s_barrier
buffer_load_dwordx4 a[128:131], v10, s[16:19], s52 offen sc1
buffer_load_dwordx4 a[132:135], v10, s[16:19], s52 offen offset:1024 sc1
s_add_u32 s52, s52, 131072
buffer_load_dwordx4 a[144:147], v10, s[16:19], s52 offen sc1
buffer_load_dwordx4 a[148:151], v10, s[16:19], s52 offen offset:1024 sc1
s_add_u32 s52, s52, 131072
buffer_load_dwordx4 a[136:139], v11, s[16:19], s53 offen sc1
buffer_load_dwordx4 a[140:143], v11, s[16:19], s53 offen offset:1024 sc1
s_add_u32 s53, s53, 131072
buffer_load_dwordx4 a[152:155], v11, s[16:19], s53 offen sc1
buffer_load_dwordx4 a[156:159], v11, s[16:19], s53 offen offset:1024 sc1
s_add_u32 s53, s53, 131072
s_add_u32 m0, s55, 135168
s_nop 0
buffer_load_dwordx4 v12, s[80:83], s54 offen   lds
buffer_load_dwordx4 v13, s[80:83], s54 offen offset:1056   lds
buffer_load_dwordx4 v14, s[80:83], s54 offen offset:2112   lds
buffer_load_dwordx4 v15, s[80:83], s54 offen offset:3168   lds
s_add_u32 s54, s54, 458752
s_lshl_b32 s57, s3, 13
s_add_u32 s57, s57, 49920
v_lshl_add_u32 v2, v1, 4, s57
s_waitcnt vmcnt(11)
v_mfma_f32_16x16x32_bf16 v[32:35], a[0:3], a[128:131], 0
buffer_load_dwordx4 a[160:163], v10, s[16:19], s52 offen sc1
s_waitcnt vmcnt(10)
MAA 32,4,144
TR 64,16,16896
v_smfmac_f32_16x16x64_bf16 a[212:215], a[208:211], a[192:199], v6
TR 66,16,17408
v_smfmac_f32_16x16x64_bf16 a[212:215], a[208:211], a[200:207], v6
TR 68,16,25344
v_mfma_f32_16x16x32_bf16 v[36:39], a[0:3], a[132:135], 0
TR 70,16,25856
s_waitcnt vmcnt(9)
MAA 36,4,148
buffer_load_dwordx4 a[164:167], v10, s[16:19], s52 offen offset:1024 sc1
v_mfma_f32_16x16x32_bf16 v[52:55], a[8:11], a[132:135], 0
TR 72,16,16928
s_add_u32 s52, s52, 131072
MAA 52,12,148
TR 74,16,17440
v_mfma_f32_16x16x32_bf16 v[48:51], a[8:11], a[128:131], 0
TR 76,16,25376
MAA 48,12,144
TR 78,16,25888
v_mfma_f32_16x16x32_bf16 v[96:99], a[16:19], a[128:131], 0
buffer_load_dwordx4 a[176:179], v10, s[16:19], s52 offen sc1
MAA 96,20,144
TR 80,16,16960
v_mfma_f32_16x16x32_bf16 v[100:103], a[16:19], a[132:135], 0
TR 82,16,17472
MAA 100,20,148
TR 84,16,25408
v_mfma_f32_16x16x32_bf16 v[116:119], a[24:27], a[132:135], 0
TR 86,16,25920
MAA 116,28,148
buffer_load_dwordx4 a[180:183], v10, s[16:19], s52 offen offset:1024 sc1
v_mfma_f32_16x16x32_bf16 v[112:115], a[24:27], a[128:131], 0
TR 88,16,16992
s_add_u32 s52, s52, 131072
MAA 112,28,144
TR 90,16,17504
v_mfma_f32_16x16x32_bf16 v[160:163], a[32:35], a[128:131], 0
TR 92,16,25440
MAA 160,36,144
TR 94,16,25952
v_mfma_f32_16x16x32_bf16 v[164:167], a[32:35], a[132:135], 0
buffer_load_dwordx4 a[168:171], v11, s[16:19], s53 offen sc1
MAA 164,36,148
TR 96,16,17024
v_mfma_f32_16x16x32_bf16 v[180:183], a[40:43], a[132:135], 0
TR 98,16,17536
MAA 180,44,148
TR 100,16,25472
v_mfma_f32_16x16x32_bf16 v[176:179], a[40:43], a[128:131], 0
TR 102,16,25984
MAA 176,44,144
buffer_load_dwordx4 a[172:175], v11, s[16:19], s53 offen offset:1024 sc1
v_mfma_f32_16x16x32_bf16 v[224:227], a[48:51], a[128:131], 0
TR 104,16,17056
s_add_u32 s53, s53, 131072
MAA 224,52,144
TR 106,16,17568
v_mfma_f32_16x16x32_bf16 v[228:231], a[48:51], a[132:135], 0
TR 108,16,25504
MAA 228,52,148
TR 110,16,26016
v_mfma_f32_16x16x32_bf16 v[236:239], a[56:59], a[132:135], 0
buffer_load_dwordx4 a[184:187], v11, s[16:19], s53 offen sc1
MAA 236,60,148
TR 112,17,16896
v_mfma_f32_16x16x32_bf16 v[232:235], a[56:59], a[128:131], 0
TR 114,17,17408
MAA 232,60,144
TR 116,17,25344
s_waitcnt vmcnt(11)
v_mfma_f32_16x16x32_bf16 v[188:191], a[40:43], a[140:143], 0
TR 118,17,25856
MAA 188,44,156
buffer_load_dwordx4 a[188:191], v11, s[16:19], s53 offen offset:1024 sc1
v_mfma_f32_16x16x32_bf16 v[184:187], a[40:43], a[136:139], 0
TR 120,17,16928
s_add_u32 s53, s53, 131072
MAA 184,44,152
TR 122,17,17440
s_add_u32 m0, s55, 84480
v_mfma_f32_16x16x32_bf16 v[168:171], a[32:35], a[136:139], 0
TR 124,17,25376
MAA 168,36,152
TR 126,17,25888
v_mfma_f32_16x16x32_bf16 v[172:175], a[32:35], a[140:143], 0
buffer_load_dwordx4 v12, s[32:35], s54 offen   lds
MAA 172,36,156
RD 192,9,16896
v_mfma_f32_16x16x32_bf16 v[124:127], a[24:27], a[140:143], 0
RD 196,9,17952
MAA 124,28,156
RD 200,9,19008
v_mfma_f32_16x16x32_bf16 v[120:123], a[24:27], a[136:139], 0
RD 204,9,20064
MAA 120,28,152
buffer_load_dwordx4 v13, s[32:35], s54 offen offset:1056   lds
v_mfma_f32_16x16x32_bf16 v[104:107], a[16:19], a[136:139], 0
MAA 104,20,152
v_mfma_f32_16x16x32_bf16 v[108:111], a[16:19], a[140:143], 0
MAA 108,20,156
v_mfma_f32_16x16x32_bf16 v[60:63], a[8:11], a[140:143], 0
buffer_load_dwordx4 v14, s[32:35], s54 offen offset:2112   lds
MAA 60,12,156
v_mfma_f32_16x16x32_bf16 v[56:59], a[8:11], a[136:139], 0
MAA 56,12,152
v_mfma_f32_16x16x32_bf16 v[40:43], a[0:3], a[136:139], 0
MAA 40,4,152
buffer_load_dwordx4 v15, s[32:35], s54 offen offset:3168   lds
v_mfma_f32_16x16x32_bf16 v[44:47], a[0:3], a[140:143], 0
MAA 44,4,156
s_waitcnt lgkmcnt(0)
s_barrier
v_mfma_f32_16x16x32_bf16 v[64:67], a[64:67], a[128:131], 0
TR 0,16,33792
s_add_u32 m0, s55, 101376
MAA 64,68,144
buffer_load_dwordx4 v12, s[80:83], s54 offen   lds
v_smfmac_f32_16x16x64_bf16 a[216:219], a[208:211], a[192:199], v6
TR 2,16,34304
s_mul_i32 s66, s13, 114688
v_smfmac_f32_16x16x64_bf16 a[216:219], a[208:211], a[200:207], v6
TR 4,16,42240
s_mul_i32 s65, s10, 1818624
v_mfma_f32_16x16x32_bf16 v[68:71], a[64:67], a[132:135], 0
TR 6,16,42752
s_add_u32 s66, s66, s65
MAA 68,68,148
TR 8,16,33824
s_add_u32 s66, s66, 12582912
v_mfma_f32_16x16x32_bf16 v[84:87], a[72:75], a[132:135], 0
buffer_load_dwordx4 v13, s[80:83], s54 offen offset:1056   lds
MAA 84,76,148
TR 10,16,34336
s_add_u32 s65, s66, 49152
v_mfma_f32_16x16x32_bf16 v[80:83], a[72:75], a[128:131], 0
TR 12,16,42272
s_lshl_b32 s62, s12, 16
MAA 80,76,144
TR 14,16,42784
s_add_u32 s62, s62, s66
v_mfma_f32_16x16x32_bf16 v[128:131], a[80:83], a[128:131], 0
TR 16,16,33856
s_add_u32 s63, s62, 16384
MAA 128,84,144
buffer_load_dwordx4 v14, s[80:83], s54 offen offset:2112   lds
v_mfma_f32_16x16x32_bf16 v[132:135], a[80:83], a[132:135], 0
TR 18,16,34368
s_add_u32 s64, s62, 32768
MAA 132,84,148
TR 20,16,42304
s_lshl_b32 s72, s10, 1
v_mfma_f32_16x16x32_bf16 v[148:151], a[88:91], a[132:135], 0
TR 22,16,42816
s_lshr_b32 s74, s11, 4
MAA 148,92,148
TR 24,16,33888
s_add_u32 s72, s72, s74
v_mfma_f32_16x16x32_bf16 v[144:147], a[88:91], a[128:131], 0
buffer_load_dwordx4 v15, s[80:83], s54 offen offset:3168   lds
MAA 144,92,144
TR 26,16,34400
s_add_u32 s54, s54, 458752
v_mfma_f32_16x16x32_bf16 v[192:195], a[96:99], a[128:131], 0
TR 28,16,42336
s_add_u32 m0, s57, 0
MAA 192,100,144
TR 30,16,42848
s_mov_b32 s58, 29622272
v_mfma_f32_16x16x32_bf16 v[196:199], a[96:99], a[132:135], 0
TR 32,16,33920
s_lshl_b32 s72, s72, 10
MAA 196,100,148
buffer_load_dwordx4 v4, s[16:19], s58 offen sc1 lds
v_mfma_f32_16x16x32_bf16 v[212:215], a[104:107], a[132:135], 0
TR 34,16,34432
s_add_u32 s72, s72, 30457856
MAA 212,108,148
TR 36,16,42368
s_and_b32 s73, s6, 14
v_mfma_f32_16x16x32_bf16 v[208:211], a[104:107], a[128:131], 0
TR 38,16,42880
s_and_b32 s74, s7, 1
MAA 208,108,144
TR 40,16,33952
s_add_u32 s73, s73, s74
v_mfma_f32_16x16x32_bf16 v[240:243], a[112:115], a[128:131], 0
buffer_load_dwordx4 v4, s[16:19], s58 offen offset:1024 sc1 lds
MAA 240,116,144
TR 42,16,34464
s_lshl_b32 s73, s73, 10
v_mfma_f32_16x16x32_bf16 v[244:247], a[112:115], a[132:135], 0
TR 44,16,42400
s_add_u32 s73, s73, 30457856
MAA 244,116,148
TR 46,16,42912
s_lshr_b32 s67, s5, 2
v_mfma_f32_16x16x32_bf16 v[252:255], a[120:123], a[132:135], 0
TR 48,17,33792
MAA 252,124,148
TR 50,17,34304
v_mfma_f32_16x16x32_bf16 v[248:251], a[120:123], a[128:131], 0
buffer_load_dwordx4 a[128:131], v10, s[16:19], s52 offen sc1
MAA 248,124,144
TR 52,17,42240
v_mfma_f32_16x16x32_bf16 v[220:223], a[104:107], a[140:143], 0
TR 54,17,42752
MAA 220,108,156
TR 56,17,33824
v_mfma_f32_16x16x32_bf16 v[216:219], a[104:107], a[136:139], 0
TR 58,17,34336
MAA 216,108,152
buffer_load_dwordx4 a[132:135], v10, s[16:19], s52 offen offset:1024 sc1
v_mfma_f32_16x16x32_bf16 v[200:203], a[96:99], a[136:139], 0
TR 60,17,42272
s_add_u32 s52, s52, 131072
MAA 200,100,152
TR 62,17,42784
v_mfma_f32_16x16x32_bf16 v[204:207], a[96:99], a[140:143], 0
RD 192,9,33792
MAA 204,100,156
RD 196,9,34848
v_mfma_f32_16x16x32_bf16 v[156:159], a[88:91], a[140:143], 0
buffer_load_dwordx4 a[144:147], v10, s[16:19], s52 offen sc1
MAA 156,92,156
RD 200,9,35904
v_mfma_f32_16x16x32_bf16 v[152:155], a[88:91], a[136:139], 0
RD 204,9,36960
MAA 152,92,152
v_mfma_f32_16x16x32_bf16 v[136:139], a[80:83], a[136:139], 0
MAA 136,84,152
buffer_load_dwordx4 a[148:151], v10, s[16:19], s52 offen offset:1024 sc1
v_mfma_f32_16x16x32_bf16 v[140:143], a[80:83], a[140:143], 0
s_add_u32 s52, s52, 131072
MAA 140,84,156
v_mfma_f32_16x16x32_bf16 v[92:95], a[72:75], a[140:143], 0
MAA 92,76,156
v_mfma_f32_16x16x32_bf16 v[88:91], a[72:75], a[136:139], 0
MAA 88,76,152
v_mfma_f32_16x16x32_bf16 v[72:75], a[64:67], a[136:139], 0
MAA 72,68,152
v_mfma_f32_16x16x32_bf16 v[76:79], a[64:67], a[140:143], 0
MAA 76,68,156
s_waitcnt vmcnt(18) lgkmcnt(0)
s_barrier
MAA 32,0,160
buffer_load_dwordx4 a[136:139], v11, s[16:19], s53 offen sc1
MAA 32,4,176
TR 64,16,50688
s_and_b32 s67, s67, 3
v_smfmac_f32_16x16x64_bf16 a[212:215], a[208:211], a[192:199], v6
TR 66,16,51200
s_lshl_b32 s67, s67, 7
v_smfmac_f32_16x16x64_bf16 a[212:215], a[208:211], a[200:207], v6
TR 68,16,59136
s_add_u32 s73, s73, s67
MAA 36,4,180
TR 70,16,59648
s_and_b32 s74, s7, 1
MAA 36,0,164
buffer_load_dwordx4 a[140:143], v11, s[16:19], s53 offen offset:1024 sc1
MAA 52,8,164
TR 72,16,50720
s_add_u32 s53, s53, 131072
MAA 52,12,180
TR 74,16,51232
s_mul_i32 s87, s74, 917504
MAA 48,12,176
TR 76,16,59168
s_lshr_b32 s75, s6, 1
MAA 48,8,160
TR 78,16,59680
s_mul_i32 s75, s75, 1818624
MAA 96,16,160
buffer_load_dwordx4 a[152:155], v11, s[16:19], s53 offen sc1
MAA 96,20,176
TR 80,16,50752
s_add_u32 s87, s87, s75
MAA 100,20,180
TR 82,16,51264
s_add_u32 s87, s87, 12582912
MAA 100,16,164
TR 84,16,59200
s_and_b32 s74, s6, 3
MAA 116,24,164
TR 86,16,59712
.Lpad13:
s_cbranch_execz .Lpad16
s_xor_b32 s75, s74, 0
MAA 116,28,180
buffer_load_dwordx4 a[156:159], v11, s[16:19], s53 offen offset:1024 sc1
MAA 112,28,176
TR 88,16,50784
s_add_u32 s53, s53, 131072
MAA 112,24,160
TR 90,16,51296
s_add_u32 m0, s55, 118272
MAA 160,32,160
TR 92,16,59232
s_sub_u32 s75, s75, 0
MAA 160,36,176
TR 94,16,59744
s_mul_i32 s98, s75, 458752
MAA 164,36,180
buffer_load_dwordx4 v12, s[32:35], s54 offen   lds
MAA 164,32,164
TR 96,16,50816
s_mul_i32 s75, s75, 114688
MAA 180,40,164
TR 98,16,51328
s_add_u32 s76, s87, s75
MAA 180,44,180
TR 100,16,59264
s_xor_b32 s75, s74, 1
MAA 176,44,176
TR 102,16,59776
s_sub_u32 s75, s75, 1
MAA 176,40,160
buffer_load_dwordx4 v13, s[32:35], s54 offen offset:1056   lds
MAA 224,48,160
TR 104,16,50848
s_mul_i32 s99, s75, 458752
MAA 224,52,176
TR 106,16,51360
s_mul_i32 s75, s75, 114688
MAA 228,52,180
TR 108,16,59296
s_add_u32 s77, s87, s75
MAA 228,48,164
TR 110,16,59808
MAA 236,56,164
buffer_load_dwordx4 v14, s[32:35], s54 offen offset:2112   lds
MAA 236,60,180
TR 112,17,50688
MAA 232,60,176
TR 114,17,51200
MAA 232,56,160
TR 116,17,59136
s_waitcnt vmcnt(21)
MAA 188,40,172
TR 118,17,59648
MAA 188,44,188
buffer_load_dwordx4 v15, s[32:35], s54 offen offset:3168   lds
MAA 184,44,184
TR 120,17,50720
s_add_u32 m0, s57, 2048
MAA 184,40,168
TR 122,17,51232
s_mov_b32 s58, 29624320
MAA 168,32,168
TR 124,17,59168
MAA 168,36,184
TR 126,17,59680
MAA 172,36,188
buffer_load_dwordx4 v4, s[16:19], s58 offen sc1 lds
MAA 172,32,172
RD 192,9,50688
MAA 124,24,172
RD 196,9,51744
MAA 124,28,188
RD 200,9,52800
MAA 120,28,184
RD 204,9,53856
MAA 120,24,168
buffer_load_dwordx4 v4, s[16:19], s58 offen offset:1024 sc1 lds
MAA 104,16,168
MAA 104,20,184
MAA 108,20,188
MAA 108,16,172
MAA 60,8,172
MAA 60,12,188
MAA 56,12,184
MAA 56,8,168
MAA 40,0,168
MAA 40,4,184
MAA 44,4,188
MAA 44,0,172
s_waitcnt vmcnt(20) lgkmcnt(0)
s_barrier
MAA 64,64,160
ds_read_b64_tr_b16 a[0:1], v16
s_add_u32 m0, s55, 135168
MAA 64,68,176
buffer_load_dwordx4 v12, s[80:83], s54 offen   lds
v_smfmac_f32_16x16x64_bf16 a[216:219], a[208:211], a[192:199], v6
TR 2,16,512
s_xor_b32 s75, s74, 2
v_smfmac_f32_16x16x64_bf16 a[216:219], a[208:211], a[200:207], v6
TR 4,16,8448
s_sub_u32 s75, s75, 2
MAA 68,68,180
TR 6,16,8960
s_mul_i32 s100, s75, 458752
MAA 68,64,164
TR 8,16,32
s_mul_i32 s75, s75, 114688
MAA 84,72,164
buffer_load_dwordx4 v13, s[80:83], s54 offen offset:1056   lds
MAA 84,76,180
TR 10,16,544
s_add_u32 s78, s87, s75
MAA 80,76,176
TR 12,16,8480
s_xor_b32 s75, s74, 3
MAA 80,72,160
TR 14,16,8992
s_sub_u32 s75, s75, 3
MAA 128,80,160
TR 16,16,64
s_mul_i32 s101, s75, 458752
MAA 128,84,176
buffer_load_dwordx4 v14, s[80:83], s54 offen offset:2112   lds
MAA 132,84,180
TR 18,16,576
s_mul_i32 s75, s75, 114688
MAA 132,80,164
TR 20,16,8512
s_add_u32 s79, s87, s75
MAA 148,88,164
TR 22,16,9024
s_and_b32 s87, s6, 3
MAA 148,92,180
TR 24,16,96
s_mov_b32 s46, 0
MAA 144,92,176
buffer_load_dwordx4 v15, s[80:83], s54 offen offset:3168   lds
MAA 144,88,160
TR 26,16,608
s_add_u32 s54, s54, 458752
MAA 192,96,160
TR 28,16,8544
s_add_u32 m0, s57, 4096
MAA 192,100,176
TR 30,16,9056
s_mov_b32 s58, 29626368
MAA 196,100,180
TR 32,16,128
s_lshl_b32 s74, s3, 10
MAA 196,96,164
buffer_load_dwordx4 v4, s[16:19], s58 offen sc1 lds
MAA 212,104,164
TR 34,16,640
s_lshl_b32 s75, s12, 9
MAA 212,108,180
TR 36,16,8576
s_add_u32 s74, s74, s75
MAA 208,108,176
TR 38,16,9088
s_add_u32 s74, s74, 152576
MAA 208,104,160
TR 40,16,160
v_and_b32 v18, 15, v1
MAA 240,112,160
buffer_load_dwordx4 v4, s[16:19], s58 offen offset:1024 sc1 lds
MAA 240,116,176
TR 42,16,672
v_lshl_add_u32 v18, v18, 4, s74
MAA 244,116,180
TR 44,16,8608
v_xor_b32 v19, 512, v18
MAA 244,112,164
TR 46,16,9120
MAA 252,120,164
ds_read_b64_tr_b16 a[48:49], v17
MAA 252,124,180
TR 50,17,512
MAA 248,124,176
TR 52,17,8448
MAA 248,120,160
buffer_load_dwordx4 a[160:163], v10, s[16:19], s52 offen sc1
MAA 220,104,172
TR 54,17,8960
MAA 220,108,188
TR 56,17,32
MAA 216,108,184
TR 58,17,544
MAA 216,104,168
TR 60,17,8480
MAA 200,96,168
buffer_load_dwordx4 a[164:167], v10, s[16:19], s52 offen offset:1024 sc1
MAA 200,100,184
TR 62,17,8992
s_add_u32 s52, s52, 131072
MAA 204,100,188
ds_read_b128 a[192:195], v9
MAA 204,96,172
RD 196,9,1056
MAA 156,88,172
RD 200,9,2112
MAA 156,92,188
buffer_load_dwordx4 a[176:179], v10, s[16:19], s52 offen sc1
MAA 152,92,184
RD 204,9,3168
MAA 152,88,168
MAA 136,80,168
MAA 136,84,184
MAA 140,84,188
buffer_load_dwordx4 a[180:183], v10, s[16:19], s52 offen offset:1024 sc1
MAA 140,80,172
s_add_u32 s52, s52, 131072
MAA 92,72,172
MAA 92,76,188
MAA 88,76,184
MAA 88,72,168
MAA 72,64,168
MAA 72,68,184
MAA 76,68,188
MAA 76,64,172
s_waitcnt vmcnt(20) lgkmcnt(0)
s_barrier
MAA 32,0,128
buffer_load_dwordx4 a[168:171], v11, s[16:19], s53 offen sc1
MAA 32,4,144
ds_read_b128 v[20:23], v2
v_smfmac_f32_16x16x64_bf16 a[212:215], a[208:211], a[192:199], v6
ds_read_b128 v[28:31], v2 offset:1024
v_smfmac_f32_16x16x64_bf16 a[212:215], a[208:211], a[200:207], v6
s_waitcnt vmcnt(11)
ds_read_b128 v[24:27], v2 offset:2048
MAA 36,4,148
TR 64,16,16896
MAA 36,0,132
buffer_load_dwordx4 a[172:175], v11, s[16:19], s53 offen offset:1024 sc1
MAA 52,8,132
TR 66,16,17408
s_add_u32 s53, s53, 131072
MAA 52,12,148
TR 68,16,25344
MAA 48,12,144
TR 70,16,25856
MAA 48,8,128
TR 72,16,16928
MAA 96,16,128
buffer_load_dwordx4 a[184:187], v11, s[16:19], s53 offen sc1
MAA 96,20,144
TR 74,16,17440
s_waitcnt lgkmcnt(7)
v_add_f32 v20, v20, v28
MAA 100,20,148
TR 76,16,25376
v_add_f32 v21, v21, v29
MAA 100,16,132
TR 78,16,25888
v_add_f32 v22, v22, v30
MAA 116,24,132
TR 80,16,16960
v_add_f32 v23, v23, v31
MAA 116,28,148
buffer_load_dwordx4 a[188:191], v11, s[16:19], s53 offen offset:1024 sc1
MAA 112,28,144
ds_read_b128 v[28:31], v2 offset:3072
s_add_u32 s53, s53, 131072
MAA 112,24,128
TR 82,16,17472
s_add_u32 m0, s55, 84480
MAA 160,32,128
TR 84,16,25408
s_waitcnt lgkmcnt(12)
v_add_f32 v20, v20, v24
MAA 160,36,144
TR 86,16,25920
v_add_f32 v21, v21, v25
MAA 164,36,148
buffer_load_dwordx4 v12, s[32:35], s54 offen   lds
MAA 164,32,132
TR 88,16,16992
v_add_f32 v22, v22, v26
MAA 180,40,132
TR 90,16,17504
v_add_f32 v23, v23, v27
MAA 180,44,148
TR 92,16,25440
MAA 176,44,144
TR 94,16,25952
MAA 176,40,128
buffer_load_dwordx4 v13, s[32:35], s54 offen offset:1056   lds
MAA 224,48,128
TR 96,16,17024
MAA 224,52,144
TR 98,16,17536
MAA 228,52,148
TR 100,16,25472
MAA 228,48,132
TR 102,16,25984
MAA 236,56,132
buffer_load_dwordx4 v14, s[32:35], s54 offen offset:2112   lds
MAA 236,60,148
TR 104,16,17056
MAA 232,60,144
TR 106,16,17568
MAA 232,56,128
TR 108,16,25504
MAA 188,40,140
TR 110,16,26016
MAA 188,44,156
buffer_load_dwordx4 v15, s[32:35], s54 offen offset:3168   lds
MAA 184,44,152
TR 112,17,16896
s_add_u32 m0, s57, 6144
MAA 184,40,136
TR 114,17,17408
s_mov_b32 s58, 29628416
MAA 168,32,136
TR 116,17,25344
MAA 168,36,152
TR 118,17,25856
MAA 172,36,156
buffer_load_dwordx4 v4, s[16:19], s58 offen sc1 lds
MAA 172,32,140
TR 120,17,16928
MAA 124,24,140
TR 122,17,17440
MAA 124,28,156
TR 124,17,25376
MAA 120,28,152
TR 126,17,25888
MAA 120,24,136
buffer_load_dwordx4 v4, s[16:19], s58 offen offset:1024 sc1 lds
MAA 104,16,136
RD 192,9,16896
MAA 104,20,152
RD 196,9,17952
MAA 108,20,156
RD 200,9,19008
MAA 108,16,140
RD 204,9,20064
MAA 60,8,140
MAA 60,12,156
MAA 56,12,152
MAA 56,8,136
MAA 40,0,136
MAA 40,4,152
MAA 44,4,156
s_sub_u32 s47, s47, 1
s_cbranch_scc1 .Lx39
.Lx39b:
MAA 44,0,140
s_waitcnt lgkmcnt(0)
s_barrier
MAA 64,64,128
s_waitcnt vmcnt(14)
ds_read_b128 v[24:27], v2 offset:4096
s_add_u32 m0, s55, 101376
MAA 64,68,144
buffer_load_dwordx4 v12, s[80:83], s54 offen   lds
v_smfmac_f32_16x16x64_bf16 a[216:219], a[208:211], a[192:199], v6
TR 0,16,33792
v_add_f32 v20, v20, v28
v_smfmac_f32_16x16x64_bf16 a[216:219], a[208:211], a[200:207], v6
TR 2,16,34304
v_add_f32 v21, v21, v29
MAA 68,68,148
TR 4,16,42240
v_add_f32 v22, v22, v30
MAA 68,64,132
TR 6,16,42752
v_add_f32 v23, v23, v31
MAA 84,72,132
ds_read_b128 v[28:31], v2 offset:5120
MAA 84,76,148
TR 8,16,33824
MAA 80,76,144
buffer_load_dwordx4 v13, s[80:83], s54 offen offset:1056   lds
MAA 80,72,128
TR 10,16,34336
s_waitcnt lgkmcnt(7)
v_add_f32 v20, v20, v24
MAA 128,80,128
TR 12,16,42272
v_add_f32 v21, v21, v25
MAA 128,84,144
TR 14,16,42784
v_add_f32 v22, v22, v26
MAA 132,84,148
TR 16,16,33856
v_add_f32 v23, v23, v27
MAA 132,80,132
TR 18,16,34368
MAA 148,88,132
TR 20,16,42304
MAA 148,92,148
buffer_load_dwordx4 v14, s[80:83], s54 offen offset:2112   lds
MAA 144,92,144
TR 22,16,42816
MAA 144,88,128
TR 24,16,33888
MAA 192,96,128
TR 26,16,34400
MAA 192,100,144
TR 28,16,42336
MAA 196,100,148
TR 30,16,42848
MAA 196,96,132
TR 32,16,33920
MAA 212,104,132
buffer_load_dwordx4 v15, s[80:83], s54 offen offset:3168   lds
MAA 212,108,148
TR 34,16,34432
s_add_u32 s54, s54, 458752
MAA 208,108,144
TR 36,16,42368
MAA 208,104,128
TR 38,16,42880
MAA 240,112,128
TR 40,16,33952
MAA 240,116,144
TR 42,16,34464
MAA 244,116,148
TR 44,16,42400
MAA 244,112,132
TR 46,16,42912
MAA 252,120,132
TR 48,17,33792
MAA 252,124,148
TR 50,17,34304
MAA 248,124,144
TR 52,17,42240
MAA 248,120,128
buffer_load_dwordx4 a[128:131], v10, s[16:19], s52 offen sc1
MAA 220,104,140
TR 54,17,42752
MAA 220,108,156
TR 56,17,33824
MAA 216,108,152
TR 58,17,34336
MAA 216,104,136
TR 60,17,42272
MAA 200,96,136
TR 62,17,42784
MAA 200,100,152
RD 192,9,33792
MAA 204,100,156
buffer_load_dwordx4 a[132:135], v10, s[16:19], s52 offen offset:1024 sc1
MAA 204,96,140
RD 196,9,34848
s_add_u32 s52, s52, 131072
MAA 156,88,140
RD 200,9,35904
MAA 156,92,156
RD 204,9,36960
MAA 152,92,152
MAA 152,88,136
MAA 136,80,136
MAA 136,84,152
buffer_load_dwordx4 a[144:147], v10, s[16:19], s52 offen sc1
MAA 140,84,156
MAA 140,80,140
MAA 92,72,140
MAA 92,76,156
MAA 88,76,152
MAA 88,72,136
MAA 72,64,136
buffer_load_dwordx4 a[148:151], v10, s[16:19], s52 offen offset:1024 sc1
MAA 72,68,152
s_add_u32 s52, s52, 131072
MAA 76,68,156
s_sub_u32 s47, s47, 1
s_cbranch_scc1 .Lx40
.Lx40b:
MAA 76,64,140
s_waitcnt vmcnt(18) lgkmcnt(0)
s_barrier
MAA 32,0,160
buffer_load_dwordx4 a[136:139], v11, s[16:19], s53 offen sc1
MAA 32,4,176
s_waitcnt vmcnt(9)
ds_read_b128 v[24:27], v2 offset:6144
v_add_f32 v20, v20, v28
v_smfmac_f32_16x16x64_bf16 a[212:215], a[208:211], a[192:199], v6
TR 64,16,50688
v_add_f32 v21, v21, v29
v_smfmac_f32_16x16x64_bf16 a[212:215], a[208:211], a[200:207], v6
TR 66,16,51200
v_add_f32 v22, v22, v30
MAA 36,4,180
TR 68,16,59136
v_add_f32 v23, v23, v31
MAA 36,0,164
ds_read_b128 v[28:31], v2 offset:7168
MAA 52,8,164
TR 70,16,59648
MAA 52,12,180
buffer_load_dwordx4 a[140:143], v11, s[16:19], s53 offen offset:1024 sc1
MAA 48,12,176
TR 72,16,50720
s_add_u32 s53, s53, 131072
MAA 48,8,160
TR 74,16,51232
s_waitcnt lgkmcnt(7)
v_add_f32 v20, v20, v24
MAA 96,16,160
TR 76,16,59168
v_add_f32 v21, v21, v25
MAA 96,20,176
TR 78,16,59680
v_add_f32 v22, v22, v26
MAA 100,20,180
TR 80,16,50752
v_add_f32 v23, v23, v27
MAA 100,16,164
TR 82,16,51264
s_waitcnt lgkmcnt(7)
v_add_f32 v20, v20, v28
MAA 116,24,164
buffer_load_dwordx4 a[152:155], v11, s[16:19], s53 offen sc1
MAA 116,28,180
TR 84,16,59200
v_add_f32 v21, v21, v29
MAA 112,28,176
TR 86,16,59712
v_add_f32 v22, v22, v30
MAA 112,24,160
TR 88,16,50784
v_add_f32 v23, v23, v31
MAA 160,32,160
TR 90,16,51296
MAA 160,36,176
TR 92,16,59232
MAA 164,36,180
TR 94,16,59744
MAA 164,32,164
buffer_load_dwordx4 a[156:159], v11, s[16:19], s53 offen offset:1024 sc1
MAA 180,40,164
TR 96,16,50816
s_add_u32 s53, s53, 131072
MAA 180,44,180
TR 98,16,51328
s_add_u32 m0, s55, 118272
MAA 176,44,176
TR 100,16,59264
MAA 176,40,160
TR 102,16,59776
MAA 224,48,160
TR 104,16,50848
MAA 224,52,176
.Lpad14:
s_cbranch_execz .Lnopoll34r
TR 106,16,51360
MAA 228,52,180
buffer_load_dwordx4 v12, s[32:35], s54 offen   lds
MAA 228,48,164
TR 108,16,59296
MAA 236,56,164
TR 110,16,59808
MAA 236,60,180
TR 112,17,50688
MAA 232,60,176
TR 114,17,51200
MAA 232,56,160
TR 116,17,59136
MAA 188,40,172
TR 118,17,59648
MAA 188,44,188
buffer_load_dwordx4 v13, s[32:35], s54 offen offset:1056   lds
MAA 184,44,184
TR 120,17,50720
MAA 184,40,168
TR 122,17,51232
MAA 168,32,168
TR 124,17,59168
MAA 168,36,184
TR 126,17,59680
MAA 172,36,188
RD 192,9,50688
MAA 172,32,172
RD 196,9,51744
MAA 124,24,172
buffer_load_dwordx4 v14, s[32:35], s54 offen offset:2112   lds
MAA 124,28,188
RD 200,9,52800
MAA 120,28,184
RD 204,9,53856
MAA 120,24,168
MAA 104,16,168
MAA 104,20,184
MAA 108,20,188
MAA 108,16,172
buffer_load_dwordx4 v15, s[32:35], s54 offen offset:3168   lds
MAA 60,8,172
MAA 60,12,188
MAA 56,12,184
MAA 56,8,168
MAA 40,0,168
MAA 40,4,184
MAA 44,4,188
s_sub_u32 s47, s47, 1
s_cbranch_scc1 .Lx41
.Lx41b:
MAA 44,0,172
s_waitcnt lgkmcnt(0)
s_barrier
MAA 64,64,160
ds_read_b64_tr_b16 a[0:1], v16
s_add_u32 m0, s55, 135168
MAA 64,68,176
buffer_load_dwordx4 v12, s[80:83], s54 offen   lds
v_smfmac_f32_16x16x64_bf16 a[216:219], a[208:211], a[192:199], v6
TR 2,16,512
v_permlane32_swap_b32 v20, v22
v_smfmac_f32_16x16x64_bf16 a[216:219], a[208:211], a[200:207], v6
TR 4,16,8448
v_permlane32_swap_b32 v21, v23
MAA 68,68,180
TR 6,16,8960
v_add_f32 v20, v20, v22
MAA 68,64,164
TR 8,16,32
v_add_f32 v21, v21, v23
MAA 84,72,164
TR 10,16,544
v_mul_f32 v20, 0xba800000, v20
MAA 84,76,180
buffer_load_dwordx4 v13, s[80:83], s54 offen offset:1056   lds
MAA 80,76,176
TR 12,16,8480
v_mul_f32 v21, 0x3a800000, v21
MAA 80,72,160
TR 14,16,8992
v_fma_f32 v21, -v20, v20, v21
MAA 128,80,160
TR 16,16,64
v_max_f32 v21, 0, v21
MAA 128,84,176
TR 18,16,576
v_add_f32 v21, 0x3727c5ac, v21
MAA 132,84,180
TR 20,16,8512
v_rsq_f32 v22, v21
MAA 132,80,164
TR 22,16,9024
v_and_b32 v24, 31, v1
MAA 148,88,164
buffer_load_dwordx4 v14, s[80:83], s54 offen offset:2112   lds
MAA 148,92,180
TR 24,16,96
v_lshrrev_b32 v25, 5, v1
MAA 144,92,176
TR 26,16,608
v_lshl_add_u32 v24, v24, 1, v25
MAA 144,88,160
TR 28,16,8544
v_and_b32 v25, 0xc0, v0
MAA 192,96,160
TR 30,16,9056
v_add_u32 v24, v24, v25
MAA 192,100,176
TR 32,16,128
v_lshlrev_b32 v24, 4, v24
MAA 196,100,180
TR 34,16,640
v_add_u32 v24, 152576, v24
MAA 196,96,164
buffer_load_dwordx4 v15, s[80:83], s54 offen offset:3168   lds
MAA 212,104,164
TR 36,16,8576
s_add_u32 s54, s54, 458752
MAA 212,108,180
TR 38,16,9088
v_mul_f32 v22, 0xbfb8aa3b, v22
MAA 208,108,176
ds_write_b128 v24, v[20:23]
s_mov_b32 s58, s98
MAA 208,104,160
ds_read_b64 v[20:21], v18
s_mov_b32 s67, s59
MAA 240,112,160
ds_read_b64 v[22:23], v18 offset:256
MAA 240,116,176
ds_read_b64 v[24:25], v19
MAA 244,116,180
ds_read_b64 v[26:27], v19 offset:256
MAA 244,112,164
ds_read_b32 v28, v18 offset:8
MAA 252,120,164
ds_read_b32 v29, v18 offset:264
v_mov_b32 v18, v5
MAA 252,124,180
ds_read_b32 v30, v19 offset:8
MAA 248,124,176
ds_read_b32 v31, v19 offset:264
v_add_u32 v19, 992, v5
MAA 248,120,160
buffer_load_dwordx4 a[160:163], v10, s[16:19], s52 offen sc1
MAA 220,104,172
TR 40,16,160
MAA 220,108,188
TR 42,16,672
MAA 216,108,184
TR 44,16,8608
MAA 216,104,168
TR 46,16,9120
MAA 200,96,168
ds_read_b64_tr_b16 a[48:49], v17
MAA 200,100,184
TR 50,17,512
MAA 204,100,188
buffer_load_dwordx4 a[164:167], v10, s[16:19], s52 offen offset:1024 sc1
MAA 204,96,172
TR 52,17,8448
s_add_u32 s52, s52, 131072
MAA 156,88,172
TR 54,17,8960
MAA 156,92,188
TR 56,17,32
MAA 152,92,184
TR 58,17,544
MAA 152,88,168
TR 60,17,8480
MAA 136,80,168
TR 62,17,8992
MAA 136,84,184
buffer_load_dwordx4 a[176:179], v10, s[16:19], s52 offen sc1
MAA 140,84,188
ds_read_b128 a[192:195], v9
MAA 140,80,172
RD 196,9,1056
MAA 92,72,172
RD 200,9,2112
MAA 92,76,188
RD 204,9,3168
MAA 88,76,184
MAA 88,72,168
MAA 72,64,168
buffer_load_dwordx4 a[180:183], v10, s[16:19], s52 offen offset:1024 sc1
MAA 72,68,184
s_add_u32 s52, s52, 131072
MAA 76,68,188
s_sub_u32 s47, s47, 1
s_cbranch_scc1 .Lx42
.Lx42b:
MAA 76,64,172
s_mov_b32 s15, -5
.p2align 6
.Lk43:
s_waitcnt vmcnt(16) lgkmcnt(0)
s_barrier
MAA 32,0,128
TR 64,16,16896
MAA 32,4,144
buffer_load_dwordx4 a[168:171], v11, s[16:19], s53 offen sc1
v_smfmac_f32_16x16x64_bf16 a[212:215], a[208:211], a[192:199], v6
s_sub_u32 s47, s47, 1
s_cbranch_scc1 .Lx44
.Lx44b:
v_smfmac_f32_16x16x64_bf16 a[212:215], a[208:211], a[200:207], v6
TR 66,16,17408
MAA 36,4,148
TR 68,16,25344
MAA 36,0,132
TR 70,16,25856
MAA 52,8,132
TR 72,16,16928
MAA 52,12,148
buffer_load_dwordx4 a[172:175], v11, s[16:19], s53 offen offset:1024 sc1
MAA 48,12,144
TR 74,16,17440
s_add_u32 s53, s53, 131072
MAA 48,8,128
MAA 96,16,128
TR 76,16,25376
MAA 96,20,144
TR 78,16,25888
MAA 100,20,148
TR 80,16,16960
MAA 100,16,132
buffer_load_dwordx4 a[184:187], v11, s[16:19], s53 offen sc1
MAA 116,24,132
TR 82,16,17472
MAA 116,28,148
TR 84,16,25408
MAA 112,28,144
MAA 112,24,128
TR 86,16,25920
MAA 160,32,128
TR 88,16,16992
MAA 160,36,144
buffer_load_dwordx4 a[188:191], v11, s[16:19], s53 offen offset:1024 sc1
MAA 164,36,148
TR 90,16,17504
s_add_u32 s53, s53, 131072
MAA 164,32,132
TR 92,16,25440
MAA 180,40,132
TR 94,16,25952
MAA 180,44,148
MAA 176,44,144
TR 96,16,17024
s_add_u32 m0, s55, 84480
MAA 176,40,128
buffer_load_dwordx4 v12, s[32:35], s54 offen   lds
MAA 224,48,128
TR 98,16,17536
MAA 224,52,144
TR 100,16,25472
MAA 228,52,148
TR 102,16,25984
MAA 228,48,132
TR 104,16,17056
MAA 236,56,132
MAA 236,60,148
TR 106,16,17568
MAA 232,60,144
TR 108,16,25504
MAA 232,56,128
TR 110,16,26016
s_waitcnt vmcnt(17)
MAA 188,40,140
TR 112,17,16896
MAA 188,44,156
buffer_load_dwordx4 v13, s[32:35], s54 offen offset:1056   lds
MAA 184,44,152
TR 114,17,17408
MAA 184,40,136
MAA 168,32,136
TR 116,17,25344
MAA 168,36,152
buffer_load_dwordx4 v14, s[32:35], s54 offen offset:2112   lds
MAA 172,36,156
TR 118,17,25856
MAA 172,32,140
TR 120,17,16928
MAA 124,24,140
TR 122,17,17440
MAA 124,28,156
TR 124,17,25376
MAA 120,28,152
MAA 120,24,136
buffer_load_dwordx4 v15, s[32:35], s54 offen offset:3168   lds
MAA 104,16,136
TR 126,17,25888
MAA 104,20,152
RD 192,9,16896
MAA 108,20,156
RD 196,9,17952
MAA 108,16,140
RD 200,9,19008
MAA 60,8,140
RD 204,9,20064
s_mov_b32 m0, s67
MAA 60,12,156
buffer_load_dwordx4 v18, s[28:31], s58 offen lds
MAA 56,12,152
MAA 56,8,136
MAA 40,0,136
MAA 40,4,152
MAA 44,4,156
MAA 44,0,140
s_waitcnt vmcnt(17) lgkmcnt(0)
s_barrier
MAA 64,64,128
TR 0,16,33792
s_add_u32 m0, s55, 101376
MAA 64,68,144
buffer_load_dwordx4 v12, s[80:83], s54 offen   lds
v_smfmac_f32_16x16x64_bf16 a[216:219], a[208:211], a[192:199], v6
s_sub_u32 s47, s47, 1
s_cbranch_scc1 .Lx45
.Lx45b:
v_smfmac_f32_16x16x64_bf16 a[216:219], a[208:211], a[200:207], v6
TR 2,16,34304
MAA 68,68,148
TR 4,16,42240
MAA 68,64,132
TR 6,16,42752
MAA 84,72,132
TR 8,16,33824
MAA 84,76,148
buffer_load_dwordx4 v13, s[80:83], s54 offen offset:1056   lds
MAA 80,76,144
TR 10,16,34336
MAA 80,72,128
MAA 128,80,128
TR 12,16,42272
MAA 128,84,144
TR 14,16,42784
MAA 132,84,148
TR 16,16,33856
MAA 132,80,132
buffer_load_dwordx4 v14, s[80:83], s54 offen offset:2112   lds
MAA 148,88,132
TR 18,16,34368
MAA 148,92,148
TR 20,16,42304
MAA 144,92,144
TR 22,16,42816
MAA 144,88,128
MAA 192,96,128
TR 24,16,33888
MAA 192,100,144
buffer_load_dwordx4 v15, s[80:83], s54 offen offset:3168   lds
MAA 196,100,148
TR 26,16,34400
s_add_u32 s54, s54, 458752
MAA 196,96,132
TR 28,16,42336
MAA 212,104,132
TR 30,16,42848
MAA 212,108,148
TR 32,16,33920
MAA 208,108,144
TR 34,16,34432
s_mov_b32 m0, s67
MAA 208,104,128
buffer_load_dwordx4 v19, s[28:31], s58 offen offset:1056 lds
MAA 240,112,128
s_add_u32 s67, s67, 8448
s_add_u32 s58, s58, 0x40000
MAA 240,116,144
MAA 244,116,148
TR 36,16,42368
MAA 244,112,132
TR 38,16,42880
MAA 252,120,132
TR 40,16,33952
MAA 252,124,148
TR 42,16,34464
MAA 248,124,144
TR 44,16,42400
MAA 248,120,128
buffer_load_dwordx4 a[128:131], v10, s[16:19], s52 offen sc1
MAA 220,104,140
TR 46,16,42912
MAA 220,108,156
MAA 216,108,152
TR 48,17,33792
MAA 216,104,136
TR 50,17,34304
MAA 200,96,136
TR 52,17,42240
MAA 200,100,152
buffer_load_dwordx4 a[132:135], v10, s[16:19], s52 offen offset:1024 sc1
MAA 204,100,156
TR 54,17,42752
s_add_u32 s52, s52, 131072
MAA 204,96,140
TR 56,17,33824
MAA 156,88,140
TR 58,17,34336
MAA 156,92,156
MAA 152,92,152
TR 60,17,42272
MAA 152,88,136
buffer_load_dwordx4 a[144:147], v10, s[16:19], s52 offen sc1
MAA 136,80,136
TR 62,17,42784
MAA 136,84,152
RD 192,9,33792
MAA 140,84,156
RD 196,9,34848
MAA 140,80,140
RD 200,9,35904
MAA 92,72,140
RD 204,9,36960
MAA 92,76,156
buffer_load_dwordx4 a[148:151], v10, s[16:19], s52 offen offset:1024 sc1
MAA 88,76,152
s_add_u32 s52, s52, 131072
MAA 88,72,136
MAA 72,64,136
MAA 72,68,152
MAA 76,68,156
MAA 76,64,140
s_waitcnt vmcnt(18) lgkmcnt(0)
s_barrier
MAA 32,0,160
TR 64,16,50688
MAA 32,4,176
buffer_load_dwordx4 a[136:139], v11, s[16:19], s53 offen sc1
v_smfmac_f32_16x16x64_bf16 a[212:215], a[208:211], a[192:199], v6
s_sub_u32 s47, s47, 1
s_cbranch_scc1 .Lx46
.Lx46b:
v_smfmac_f32_16x16x64_bf16 a[212:215], a[208:211], a[200:207], v6
TR 66,16,51200
MAA 36,4,180
TR 68,16,59136
MAA 36,0,164
TR 70,16,59648
MAA 52,8,164
TR 72,16,50720
MAA 52,12,180
buffer_load_dwordx4 a[140:143], v11, s[16:19], s53 offen offset:1024 sc1
MAA 48,12,176
TR 74,16,51232
s_add_u32 s53, s53, 131072
MAA 48,8,160
MAA 96,16,160
TR 76,16,59168
MAA 96,20,176
TR 78,16,59680
MAA 100,20,180
TR 80,16,50752
MAA 100,16,164
buffer_load_dwordx4 a[152:155], v11, s[16:19], s53 offen sc1
MAA 116,24,164
TR 82,16,51264
MAA 116,28,180
TR 84,16,59200
MAA 112,28,176
MAA 112,24,160
TR 86,16,59712
MAA 160,32,160
TR 88,16,50784
MAA 160,36,176
buffer_load_dwordx4 a[156:159], v11, s[16:19], s53 offen offset:1024 sc1
MAA 164,36,180
TR 90,16,51296
s_add_u32 s53, s53, 131072
MAA 164,32,164
TR 92,16,59232
MAA 180,40,164
TR 94,16,59744
MAA 180,44,180
MAA 176,44,176
TR 96,16,50816
s_add_u32 m0, s55, 118272
MAA 176,40,160
buffer_load_dwordx4 v12, s[32:35], s54 offen   lds
MAA 224,48,160
TR 98,16,51328
MAA 224,52,176
TR 100,16,59264
MAA 228,52,180
TR 102,16,59776
MAA 228,48,164
TR 104,16,50848
MAA 236,56,164
MAA 236,60,180
TR 106,16,51360
MAA 232,60,176
TR 108,16,59296
MAA 232,56,160
TR 110,16,59808
s_waitcnt vmcnt(19)
MAA 188,40,172
TR 112,17,50688
MAA 188,44,188
buffer_load_dwordx4 v13, s[32:35], s54 offen offset:1056   lds
MAA 184,44,184
TR 114,17,51200
MAA 184,40,168
MAA 168,32,168
TR 116,17,59136
MAA 168,36,184
buffer_load_dwordx4 v14, s[32:35], s54 offen offset:2112   lds
MAA 172,36,188
TR 118,17,59648
MAA 172,32,172
TR 120,17,50720
MAA 124,24,172
TR 122,17,51232
MAA 124,28,188
TR 124,17,59168
MAA 120,28,184
MAA 120,24,168
buffer_load_dwordx4 v15, s[32:35], s54 offen offset:3168   lds
MAA 104,16,168
TR 126,17,59680
MAA 104,20,184
RD 192,9,50688
MAA 108,20,188
RD 196,9,51744
MAA 108,16,172
RD 200,9,52800
MAA 60,8,172
RD 204,9,53856
s_mov_b32 m0, s67
MAA 60,12,188
buffer_load_dwordx4 v18, s[28:31], s58 offen lds
MAA 56,12,184
MAA 56,8,168
MAA 40,0,168
MAA 40,4,184
MAA 44,4,188
.Lpad15:
s_cbranch_execz .Lnopoll34r
MAA 44,0,172
s_waitcnt vmcnt(19) lgkmcnt(0)
s_barrier
MAA 64,64,160
ds_read_b64_tr_b16 a[0:1], v16
s_add_u32 m0, s55, 135168
MAA 64,68,176
buffer_load_dwordx4 v12, s[80:83], s54 offen   lds
v_smfmac_f32_16x16x64_bf16 a[216:219], a[208:211], a[192:199], v6
s_sub_u32 s47, s47, 1
s_cbranch_scc1 .Lx47
.Lx47b:
v_smfmac_f32_16x16x64_bf16 a[216:219], a[208:211], a[200:207], v6
TR 2,16,512
MAA 68,68,180
TR 4,16,8448
MAA 68,64,164
TR 6,16,8960
MAA 84,72,164
TR 8,16,32
MAA 84,76,180
buffer_load_dwordx4 v13, s[80:83], s54 offen offset:1056   lds
MAA 80,76,176
TR 10,16,544
MAA 80,72,160
MAA 128,80,160
TR 12,16,8480
MAA 128,84,176
TR 14,16,8992
MAA 132,84,180
TR 16,16,64
MAA 132,80,164
buffer_load_dwordx4 v14, s[80:83], s54 offen offset:2112   lds
MAA 148,88,164
TR 18,16,576
MAA 148,92,180
TR 20,16,8512
MAA 144,92,176
TR 22,16,9024
MAA 144,88,160
MAA 192,96,160
TR 24,16,96
MAA 192,100,176
buffer_load_dwordx4 v15, s[80:83], s54 offen offset:3168   lds
MAA 196,100,180
TR 26,16,608
s_add_u32 s54, s54, 458752
MAA 196,96,164
TR 28,16,8544
MAA 212,104,164
TR 30,16,9056
MAA 212,108,180
TR 32,16,128
MAA 208,108,176
TR 34,16,640
s_mov_b32 m0, s67
MAA 208,104,160
buffer_load_dwordx4 v19, s[28:31], s58 offen offset:1056 lds
MAA 240,112,160
s_add_u32 s67, s67, 8448
s_add_u32 s46, s46, 1
s_xor_b32 s58, s46, s87
s_mul_i32 s58, s58, 458752
MAA 240,116,176
MAA 244,116,180
TR 36,16,8576
MAA 244,112,164
TR 38,16,9088
MAA 252,120,164
TR 40,16,160
MAA 252,124,180
TR 42,16,672
MAA 248,124,176
TR 44,16,8608
MAA 248,120,160
buffer_load_dwordx4 a[160:163], v10, s[16:19], s52 offen sc1
MAA 220,104,172
TR 46,16,9120
MAA 220,108,188
MAA 216,108,184
ds_read_b64_tr_b16 a[48:49], v17
MAA 216,104,168
TR 50,17,512
MAA 200,96,168
TR 52,17,8448
MAA 200,100,184
buffer_load_dwordx4 a[164:167], v10, s[16:19], s52 offen offset:1024 sc1
MAA 204,100,188
TR 54,17,8960
s_add_u32 s52, s52, 131072
MAA 204,96,172
TR 56,17,32
MAA 156,88,172
TR 58,17,544
MAA 156,92,188
MAA 152,92,184
TR 60,17,8480
MAA 152,88,168
buffer_load_dwordx4 a[176:179], v10, s[16:19], s52 offen sc1
MAA 136,80,168
TR 62,17,8992
MAA 136,84,184
ds_read_b128 a[192:195], v9
MAA 140,84,188
RD 196,9,1056
MAA 140,80,172
RD 200,9,2112
MAA 92,72,172
RD 204,9,3168
MAA 92,76,188
buffer_load_dwordx4 a[180:183], v10, s[16:19], s52 offen offset:1024 sc1
MAA 88,76,184
s_add_u32 s52, s52, 131072
MAA 88,72,168
MAA 72,64,168
MAA 72,68,184
MAA 76,68,188
s_add_u32 s15, s15, 1
MAA 76,64,172
s_cbranch_scc0 .Lk43
s_branch .Lj48
.Lx39:
buffer_load_dword a220, v8, s[40:43], s45 offen
buffer_load_dword a220, v7, s[28:31], s44 offen
s_add_u32 s44, s44, 655360
s_add_u32 s45, s45, 917504
s_mov_b32 s47, 3
s_branch .Lx39b
.Lx40:
buffer_load_dword a220, v8, s[40:43], s45 offen
buffer_load_dword a220, v7, s[28:31], s44 offen
s_add_u32 s44, s44, 655360
s_add_u32 s45, s45, 917504
s_mov_b32 s47, 3
s_branch .Lx40b
.Lx41:
buffer_load_dword a220, v8, s[40:43], s45 offen
buffer_load_dword a220, v7, s[28:31], s44 offen
s_add_u32 s44, s44, 655360
s_add_u32 s45, s45, 917504
s_mov_b32 s47, 3
s_branch .Lx41b
.Lx42:
buffer_load_dword a220, v8, s[40:43], s45 offen
buffer_load_dword a220, v7, s[28:31], s44 offen
s_add_u32 s44, s44, 655360
s_add_u32 s45, s45, 917504
s_mov_b32 s47, 3
s_branch .Lx42b
.Lx44:
buffer_load_dword a220, v8, s[40:43], s45 offen
buffer_load_dword a220, v7, s[28:31], s44 offen
s_add_u32 s44, s44, 655360
s_add_u32 s45, s45, 917504
s_mov_b32 s47, 3
s_branch .Lx44b
.Lx45:
buffer_load_dword a220, v8, s[40:43], s45 offen
buffer_load_dword a220, v7, s[28:31], s44 offen
s_add_u32 s44, s44, 655360
s_add_u32 s45, s45, 917504
s_mov_b32 s47, 3
s_branch .Lx45b
.Lx46:
buffer_load_dword a220, v8, s[40:43], s45 offen
buffer_load_dword a220, v7, s[28:31], s44 offen
s_add_u32 s44, s44, 655360
s_add_u32 s45, s45, 917504
s_mov_b32 s47, 3
s_branch .Lx46b
.Lx47:
buffer_load_dword a220, v8, s[40:43], s45 offen
buffer_load_dword a220, v7, s[28:31], s44 offen
s_add_u32 s44, s44, 655360
s_add_u32 s45, s45, 917504
s_mov_b32 s47, 3
s_branch .Lx47b
.Lj48:
s_waitcnt vmcnt(10) lgkmcnt(0)
s_barrier
v_smfmac_f32_16x16x64_bf16 a[212:215], a[208:211], a[192:199], v6
RD 112,9,16896
s_lshl_b32 s74, s3, 10
v_smfmac_f32_16x16x64_bf16 a[212:215], a[208:211], a[200:207], v6
RD 116,9,17952
s_add_u32 s74, s74, 152576
MAA 32,0,128
RD 120,9,19008
s_sub_u32 s75, 156672, s74
MAA 32,4,144
RD 124,9,20064
v_and_b32 v7, 15, v1
MAA 48,12,144
RD 192,9,33792
v_lshl_add_u32 v7, v7, 5, s74
MAA 48,8,128
RD 196,9,34848
v_bfe_u32 v2, v1, 4, 1
MAA 36,0,132
RD 200,9,35904
v_lshl_add_u32 v7, v2, 4, v7
MAA 36,4,148
RD 204,9,36960
v_bfe_u32 v2, v1, 5, 1
MAA 52,12,148
buffer_load_dwordx4 a[168:171], v11, s[16:19], s53 offen sc1
MAA 52,8,132
TR 64,16,16896
v_mul_u32_u24 v2, s75, v2
s_waitcnt lgkmcnt(7)
v_smfmac_f32_16x16x64_bf16 a[216:219], a[208:211], a[112:119], v6
TR 66,16,17408
v_add_u32 v7, v7, v2
MAA 40,0,136
TR 68,16,25344
v_lshlrev_b32 v2, 4, v1
s_waitcnt lgkmcnt(7)
v_smfmac_f32_16x16x64_bf16 a[216:219], a[208:211], a[120:127], v6
buffer_load_dwordx4 a[172:175], v11, s[16:19], s53 offen offset:1024 sc1
MAA 40,4,152
TR 70,16,25856
s_add_u32 s53, s53, 131072
s_waitcnt lgkmcnt(6)
v_smfmac_f32_16x16x64_bf16 a[212:215], a[208:211], a[192:199], v6
TR 72,16,16928
v_add_u32 v2, 152576, v2
MAA 56,12,152
TR 74,16,17440
s_lshl_b32 s74, s12, 7
s_waitcnt lgkmcnt(6)
v_smfmac_f32_16x16x64_bf16 a[212:215], a[208:211], a[200:207], v6
buffer_load_dwordx4 a[184:187], v11, s[16:19], s53 offen sc1
MAA 56,8,136
TR 76,16,25376
s_add_u32 s74, s74, 161536
MAA 44,0,140
TR 78,16,25888
s_waitcnt vmcnt(8)
s_barrier
MAA 44,4,156
RD 112,9,50688
s_xor_b32 s75, s12, 1
MAA 60,12,156
RD 116,9,51744
s_mul_i32 s75, s75, 384
MAA 60,8,140
RD 120,9,52800
s_add_u32 s75, s75, 161536
MAA 96,16,128
RD 124,9,53856
v_lshrrev_b32 v9, 4, v1
MAA 96,20,144
ds_write_b128 v7, a[212:215]
v_lshlrev_b32 v9, 4, v9
MAA 112,28,144
buffer_load_dwordx4 a[188:191], v11, s[16:19], s53 offen offset:1024 sc1
MAA 112,24,128
TR 80,16,33792
s_add_u32 s53, s53, 131072
MAA 100,16,132
TR 82,16,34304
v_add_u32 v8, s75, v9
MAA 100,20,148
TR 84,16,42240
v_add_u32 v9, s74, v9
MAA 116,28,148
TR 86,16,42752
s_add_u32 s58, s99, 2293760
s_waitcnt lgkmcnt(7)
v_smfmac_f32_16x16x64_bf16 a[216:219], a[208:211], a[112:119], v6
TR 88,16,33824
s_lshl_b32 s74, s3, 11
MAA 116,24,132
TR 90,16,34336
s_add_u32 s74, s74, s84
s_waitcnt lgkmcnt(7)
v_smfmac_f32_16x16x64_bf16 a[216:219], a[208:211], a[120:127], v6
TR 92,16,42272
s_add_u32 s54, s98, 65536
MAA 104,16,136
TR 94,16,42784
s_mul_i32 s55, s3, 2112
MAA 104,20,152
TR 96,16,50688
s_mov_b32 s57, 67584
MAA 120,28,152
ds_write_b128 v7, a[216:219] offset:512
MAA 120,24,136
TR 98,16,51200
MAA 108,16,140
TR 100,16,59136
MAA 108,20,156
TR 102,16,59648
MAA 124,28,156
TR 104,16,50720
MAA 124,24,140
TR 106,16,51232
MAA 160,32,128
TR 108,16,59168
MAA 160,36,144
TR 110,16,59680
MAA 176,44,144
s_waitcnt lgkmcnt(7)
s_barrier
ds_read_b128 v[12:15], v2
MAA 176,40,128
ds_read_b128 v[4:7], v2 offset:1024
MAA 164,32,132
TR 192,16,16960
MAA 164,36,148
TR 194,16,17472
MAA 180,44,148
TR 196,16,25408
MAA 180,40,132
TR 198,16,25920
MAA 168,32,136
TR 200,16,16992
MAA 168,36,152
TR 202,16,17504
MAA 184,44,152
TR 204,16,25440
MAA 184,40,136
TR 206,16,25952
s_waitcnt lgkmcnt(8)
v_add_f32 v12, v12, v4
MAA 172,32,140
TR 112,16,33856
v_add_f32 v13, v13, v5
MAA 172,36,156
TR 114,16,34368
v_add_f32 v14, v14, v6
MAA 188,44,156
TR 116,16,42304
v_add_f32 v15, v15, v7
MAA 188,40,140
ds_read_b128 v[4:7], v2 offset:2048
MAA 224,48,128
TR 118,16,42816
MAA 224,52,144
TR 120,16,33888
MAA 232,60,144
TR 122,16,34400
MAA 232,56,128
TR 124,16,42336
MAA 228,48,132
TR 126,16,42848
MAA 228,52,148
TR 0,16,50752
MAA 236,60,148
TR 2,16,51264
MAA 236,56,132
TR 4,16,59200
s_waitcnt lgkmcnt(8)
v_add_f32 v12, v12, v4
MAA 64,64,128
TR 6,16,59712
v_add_f32 v13, v13, v5
MAA 64,68,144
TR 8,16,50784
v_add_f32 v14, v14, v6
s_waitcnt vmcnt(7)
MAA 64,96,160
TR 10,16,51296
v_add_f32 v15, v15, v7
s_waitcnt vmcnt(5)
MAA 64,100,176
ds_read_b128 v[4:7], v2 offset:3072
MAA 80,108,176
TR 12,16,59232
MAA 80,104,160
TR 14,16,59744
MAA 80,76,144
TR 16,16,17024
MAA 80,72,128
TR 18,16,17536
MAA 32,80,160
TR 20,16,25472
MAA 32,84,176
TR 22,16,25984
MAA 48,92,176
TR 24,16,17056
MAA 48,88,160
TR 26,16,17568
s_waitcnt lgkmcnt(8)
v_add_f32 v12, v12, v4
v_add_f32 v13, v13, v5
v_add_f32 v14, v14, v6
v_add_f32 v15, v15, v7
ds_write_b128 v2, v[12:15] offset:8960
ds_read_b128 v[12:15], v9
ds_read_b128 v[4:7], v9 offset:64
v_lshrrev_b32 v2, 3, v1
v_cmp_eq_u32 vcc, 3, v2
TR 28,16,25504
TR 30,16,26016
TR 32,16,33920
TR 34,16,34432
TR 36,16,42368
TR 38,16,42880
TR 40,16,33952
TR 42,16,34464
TR 44,16,42400
TR 46,16,42912
TR 48,16,50816
TR 50,16,51328
TR 52,16,59264
s_waitcnt lgkmcnt(14)
v_pk_fma_f32 v[32:33], v[12:13], v[20:21], v[32:33] op_sel_hi:[1,0,1]
v_pk_fma_f32 v[34:35], v[14:15], v[20:21], v[34:35] op_sel_hi:[1,0,1]
v_pk_fma_f32 v[36:37], v[12:13], v[22:23], v[36:37] op_sel_hi:[1,0,1]
v_pk_fma_f32 v[38:39], v[14:15], v[22:23], v[38:39] op_sel_hi:[1,0,1]
v_pk_fma_f32 v[40:41], v[12:13], v[24:25], v[40:41] op_sel_hi:[1,0,1]
v_pk_fma_f32 v[42:43], v[14:15], v[24:25], v[42:43] op_sel_hi:[1,0,1]
v_pk_fma_f32 v[44:45], v[12:13], v[26:27], v[44:45] op_sel_hi:[1,0,1]
v_pk_fma_f32 v[46:47], v[14:15], v[26:27], v[46:47] op_sel_hi:[1,0,1]
ds_read_b128 v[12:15], v9 offset:512
s_waitcnt lgkmcnt(14)
v_pk_fma_f32 v[48:49], v[4:5], v[20:21], v[48:49] op_sel_hi:[1,0,1]
v_pk_fma_f32 v[50:51], v[6:7], v[20:21], v[50:51] op_sel_hi:[1,0,1]
v_pk_fma_f32 v[52:53], v[4:5], v[22:23], v[52:53] op_sel_hi:[1,0,1]
v_pk_fma_f32 v[54:55], v[6:7], v[22:23], v[54:55] op_sel_hi:[1,0,1]
v_pk_fma_f32 v[56:57], v[4:5], v[24:25], v[56:57] op_sel_hi:[1,0,1]
v_pk_fma_f32 v[58:59], v[6:7], v[24:25], v[58:59] op_sel_hi:[1,0,1]
v_pk_fma_f32 v[60:61], v[4:5], v[26:27], v[60:61] op_sel_hi:[1,0,1]
v_pk_fma_f32 v[62:63], v[6:7], v[26:27], v[62:63] op_sel_hi:[1,0,1]
ds_read_b128 v[4:7], v9 offset:576
TR 54,16,59776
TR 56,16,50848
TR 58,16,51360
TR 60,16,59296
TR 62,16,59808
s_waitcnt lgkmcnt(6)
v_pk_fma_f32 v[64:65], v[12:13], v[20:21], v[64:65] op_sel_hi:[1,0,1]
v_pk_fma_f32 v[66:67], v[14:15], v[20:21], v[66:67] op_sel_hi:[1,0,1]
v_pk_fma_f32 v[68:69], v[12:13], v[22:23], v[68:69] op_sel_hi:[1,0,1]
v_pk_fma_f32 v[70:71], v[14:15], v[22:23], v[70:71] op_sel_hi:[1,0,1]
v_pk_fma_f32 v[72:73], v[12:13], v[24:25], v[72:73] op_sel_hi:[1,0,1]
v_pk_fma_f32 v[74:75], v[14:15], v[24:25], v[74:75] op_sel_hi:[1,0,1]
v_pk_fma_f32 v[76:77], v[12:13], v[26:27], v[76:77] op_sel_hi:[1,0,1]
v_pk_fma_f32 v[78:79], v[14:15], v[26:27], v[78:79] op_sel_hi:[1,0,1]
ds_read_b128 v[12:15], v9 offset:832
s_waitcnt lgkmcnt(6)
v_pk_fma_f32 v[80:81], v[4:5], v[20:21], v[80:81] op_sel_hi:[1,0,1]
v_pk_fma_f32 v[82:83], v[6:7], v[20:21], v[82:83] op_sel_hi:[1,0,1]
v_pk_fma_f32 v[84:85], v[4:5], v[22:23], v[84:85] op_sel_hi:[1,0,1]
v_pk_fma_f32 v[86:87], v[6:7], v[22:23], v[86:87] op_sel_hi:[1,0,1]
v_pk_fma_f32 v[88:89], v[4:5], v[24:25], v[88:89] op_sel_hi:[1,0,1]
v_pk_fma_f32 v[90:91], v[6:7], v[24:25], v[90:91] op_sel_hi:[1,0,1]
v_pk_fma_f32 v[92:93], v[4:5], v[26:27], v[92:93] op_sel_hi:[1,0,1]
v_pk_fma_f32 v[94:95], v[6:7], v[26:27], v[94:95] op_sel_hi:[1,0,1]
ds_read_b128 v[4:7], v9 offset:704
v_pk_mul_f32 v[64:65], v[64:65], v[32:33]
v_pk_mul_f32 v[32:33], v[32:33], v[28:29] op_sel_hi:[1,0]
v_pk_mul_f32 v[66:67], v[66:67], v[34:35]
v_pk_mul_f32 v[34:35], v[34:35], v[28:29] op_sel_hi:[1,0]
v_pk_mul_f32 v[80:81], v[80:81], v[48:49]
v_pk_mul_f32 v[48:49], v[48:49], v[28:29] op_sel_hi:[1,0]
v_pk_mul_f32 v[82:83], v[82:83], v[50:51]
v_pk_mul_f32 v[50:51], v[50:51], v[28:29] op_sel_hi:[1,0]
v_exp_f32 v32, v32
v_exp_f32 v33, v33
MAA 68,64,132
v_exp_f32 v34, v34
MAA 68,68,148
v_exp_f32 v35, v35
MAA 68,96,164
v_exp_f32 v48, v48
s_waitcnt vmcnt(4)
MAA 68,100,180
v_exp_f32 v49, v49
MAA 84,108,180
v_exp_f32 v50, v50
MAA 84,104,164
v_exp_f32 v51, v51
MAA 84,76,148
MAA 84,72,132
MAA 36,80,164
MAA 36,84,180
MAA 52,92,180
MAA 52,88,164
s_nop 5
v_pk_mul_f32 v[68:69], v[68:69], v[36:37]
v_pk_fma_f32 v[32:33], v[32:33], v[20:21], v[20:21] op_sel:[0,1,1] op_sel_hi:[1,1,1]
v_pk_fma_f32 v[34:35], v[34:35], v[20:21], v[20:21] op_sel:[0,1,1] op_sel_hi:[1,1,1]
v_pk_fma_f32 v[48:49], v[48:49], v[20:21], v[20:21] op_sel:[0,1,1] op_sel_hi:[1,1,1]
v_pk_fma_f32 v[50:51], v[50:51], v[20:21], v[20:21] op_sel:[0,1,1] op_sel_hi:[1,1,1]
v_rcp_f32 v32, v32
v_pk_mul_f32 v[36:37], v[36:37], v[28:29] op_sel:[0,1] op_sel_hi:[1,1]
v_pk_mul_f32 v[70:71], v[70:71], v[38:39]
v_pk_mul_f32 v[38:39], v[38:39], v[28:29] op_sel:[0,1] op_sel_hi:[1,1]
v_pk_mul_f32 v[84:85], v[84:85], v[52:53]
v_pk_mul_f32 v[52:53], v[52:53], v[28:29] op_sel:[0,1] op_sel_hi:[1,1]
v_pk_mul_f32 v[86:87], v[86:87], v[54:55]
v_pk_mul_f32 v[54:55], v[54:55], v[28:29] op_sel:[0,1] op_sel_hi:[1,1]
v_rcp_f32 v33, v33
v_rcp_f32 v34, v34
MAA 72,64,136
v_rcp_f32 v35, v35
MAA 72,68,152
v_rcp_f32 v48, v48
s_waitcnt vmcnt(3)
MAA 72,96,168
v_rcp_f32 v49, v49
s_waitcnt vmcnt(1)
MAA 72,100,184
v_rcp_f32 v50, v50
MAA 88,108,184
v_rcp_f32 v51, v51
MAA 88,104,168
v_exp_f32 v36, v36
MAA 88,76,152
v_exp_f32 v37, v37
MAA 88,72,136
v_exp_f32 v38, v38
MAA 40,80,168
v_exp_f32 v39, v39
MAA 40,84,184
v_exp_f32 v52, v52
MAA 56,92,184
v_exp_f32 v53, v53
MAA 56,88,168
v_exp_f32 v54, v54
v_exp_f32 v55, v55
v_pk_mul_f32 v[64:65], v[64:65], v[32:33]
v_pk_mul_f32 v[66:67], v[66:67], v[34:35]
v_pk_mul_f32 v[80:81], v[80:81], v[48:49]
v_pk_mul_f32 v[82:83], v[82:83], v[50:51]
ds_read_b128 v[48:51], v9 offset:128
v_pk_mul_f32 v[72:73], v[72:73], v[40:41]
v_pk_mul_f32 v[40:41], v[40:41], v[30:31] op_sel_hi:[1,0]
v_pk_mul_f32 v[74:75], v[74:75], v[42:43]
v_pk_mul_f32 v[42:43], v[42:43], v[30:31] op_sel_hi:[1,0]
v_pk_mul_f32 v[88:89], v[88:89], v[56:57]
v_pk_mul_f32 v[56:57], v[56:57], v[30:31] op_sel_hi:[1,0]
v_pk_mul_f32 v[90:91], v[90:91], v[58:59]
v_pk_mul_f32 v[58:59], v[58:59], v[30:31] op_sel_hi:[1,0]
v_pk_fma_f32 v[36:37], v[36:37], v[22:23], v[22:23] op_sel:[0,1,1] op_sel_hi:[1,1,1]
v_pk_fma_f32 v[38:39], v[38:39], v[22:23], v[22:23] op_sel:[0,1,1] op_sel_hi:[1,1,1]
v_pk_fma_f32 v[52:53], v[52:53], v[22:23], v[22:23] op_sel:[0,1,1] op_sel_hi:[1,1,1]
v_pk_fma_f32 v[54:55], v[54:55], v[22:23], v[22:23] op_sel:[0,1,1] op_sel_hi:[1,1,1]
v_cvt_pk_bf16_f32 v32, v64, v65
v_cvt_pk_bf16_f32 v33, v66, v67
ds_read_b128 v[64:67], v9 offset:192
v_cvt_pk_bf16_f32 v34, v80, v81
v_cvt_pk_bf16_f32 v35, v82, v83
MAA 76,64,140
buffer_store_dwordx4 v[32:35], v10, s[16:19], s62 offen sc1
MAA 76,68,156
ds_read_b128 v[80:83], v9 offset:640
v_rcp_f32 v36, v36
MAA 76,96,172
TR 64,17,16896
v_rcp_f32 v37, v37
s_waitcnt vmcnt(1)
MAA 76,100,188
TR 66,17,17408
v_rcp_f32 v38, v38
MAA 92,108,188
TR 68,17,25344
v_rcp_f32 v39, v39
MAA 92,104,172
TR 70,17,25856
v_rcp_f32 v52, v52
MAA 92,76,156
TR 76,17,25376
v_rcp_f32 v53, v53
MAA 92,72,140
TR 72,17,16928
v_rcp_f32 v54, v54
MAA 44,80,172
TR 74,17,17440
v_rcp_f32 v55, v55
MAA 44,84,188
TR 78,17,25888
v_exp_f32 v40, v40
MAA 60,92,188
TR 80,17,33792
.Lpad16:
s_cbranch_execz .Lnopoll34r
v_exp_f32 v41, v41
MAA 60,88,172
TR 82,17,34304
v_exp_f32 v42, v42
v_exp_f32 v43, v43
v_exp_f32 v56, v56
v_exp_f32 v57, v57
v_exp_f32 v58, v58
v_exp_f32 v59, v59
v_pk_mul_f32 v[68:69], v[68:69], v[36:37]
v_pk_mul_f32 v[70:71], v[70:71], v[38:39]
v_pk_mul_f32 v[84:85], v[84:85], v[52:53]
v_pk_mul_f32 v[86:87], v[86:87], v[54:55]
ds_read_b128 v[52:55], v8 offset:576
v_pk_mul_f32 v[76:77], v[76:77], v[44:45]
v_pk_mul_f32 v[44:45], v[44:45], v[30:31] op_sel:[0,1] op_sel_hi:[1,1]
v_pk_mul_f32 v[78:79], v[78:79], v[46:47]
v_pk_mul_f32 v[46:47], v[46:47], v[30:31] op_sel:[0,1] op_sel_hi:[1,1]
v_pk_mul_f32 v[92:93], v[92:93], v[60:61]
v_pk_mul_f32 v[60:61], v[60:61], v[30:31] op_sel:[0,1] op_sel_hi:[1,1]
v_pk_mul_f32 v[94:95], v[94:95], v[62:63]
v_pk_mul_f32 v[62:63], v[62:63], v[30:31] op_sel:[0,1] op_sel_hi:[1,1]
v_pk_fma_f32 v[40:41], v[40:41], v[24:25], v[24:25] op_sel:[0,1,1] op_sel_hi:[1,1,1]
v_pk_fma_f32 v[42:43], v[42:43], v[24:25], v[24:25] op_sel:[0,1,1] op_sel_hi:[1,1,1]
v_pk_fma_f32 v[56:57], v[56:57], v[24:25], v[24:25] op_sel:[0,1,1] op_sel_hi:[1,1,1]
v_pk_fma_f32 v[58:59], v[58:59], v[24:25], v[24:25] op_sel:[0,1,1] op_sel_hi:[1,1,1]
v_cvt_pk_bf16_f32 v36, v68, v69
v_cvt_pk_bf16_f32 v37, v70, v71
v_cvt_pk_bf16_f32 v38, v84, v85
v_cvt_pk_bf16_f32 v39, v86, v87
MAA 128,192,128
buffer_store_dwordx4 v[36:39], v10, s[16:19], s62 offen offset:1024 sc1
MAA 128,196,144
TR 84,17,42240
v_rcp_f32 v40, v40
MAA 128,0,160
TR 86,17,42752
v_rcp_f32 v41, v41
MAA 128,4,176
TR 88,17,33824
v_rcp_f32 v42, v42
MAA 144,12,176
TR 90,17,34336
v_rcp_f32 v43, v43
MAA 144,8,160
TR 92,17,42272
v_rcp_f32 v56, v56
MAA 144,204,144
TR 94,17,42784
v_rcp_f32 v57, v57
MAA 144,200,128
TR 96,17,50688
v_rcp_f32 v58, v58
MAA 96,112,160
TR 98,17,51200
v_rcp_f32 v59, v59
MAA 96,116,176
TR 100,17,59136
v_exp_f32 v44, v44
MAA 112,124,176
TR 102,17,59648
v_exp_f32 v45, v45
MAA 112,120,160
TR 104,17,50720
v_lshrrev_b32 v69, 2, v0
v_min_u32 v69, 1, v69
v_lshlrev_b32 v69, 28, v69
v_lshl_add_u32 v68, v0, 7, v69
v_xor_b32 v69, 64, v0
v_min_u32 v69, 1, v69
v_lshlrev_b32 v70, 4, v69
v_sub_u32 v70, 16, v70
v_lshlrev_b32 v69, 28, v69
v_mov_b32 v71, 1
v_mov_b32 v84, 0
v_mov_b32 v85, 0
v_mov_b32 v86, 0
v_exp_f32 v46, v46
v_exp_f32 v47, v47
v_exp_f32 v60, v60
v_exp_f32 v61, v61
v_exp_f32 v62, v62
v_exp_f32 v63, v63
v_pk_mul_f32 v[72:73], v[72:73], v[40:41]
v_pk_mul_f32 v[74:75], v[74:75], v[42:43]
v_pk_mul_f32 v[88:89], v[88:89], v[56:57]
v_pk_mul_f32 v[90:91], v[90:91], v[58:59]
s_waitcnt lgkmcnt(15)
v_pk_fma_f32 v[96:97], v[48:49], v[20:21], v[96:97] op_sel_hi:[1,0,1]
v_pk_fma_f32 v[98:99], v[50:51], v[20:21], v[98:99] op_sel_hi:[1,0,1]
v_pk_fma_f32 v[112:113], v[64:65], v[20:21], v[112:113] op_sel_hi:[1,0,1]
v_pk_fma_f32 v[114:115], v[66:67], v[20:21], v[114:115] op_sel_hi:[1,0,1]
v_pk_fma_f32 v[128:129], v[80:81], v[20:21], v[128:129] op_sel_hi:[1,0,1]
v_pk_fma_f32 v[130:131], v[82:83], v[20:21], v[130:131] op_sel_hi:[1,0,1]
v_pk_fma_f32 v[144:145], v[4:5], v[20:21], v[144:145] op_sel_hi:[1,0,1]
v_pk_fma_f32 v[146:147], v[6:7], v[20:21], v[146:147] op_sel_hi:[1,0,1]
v_pk_mul_f32 v[128:129], v[128:129], v[96:97]
v_pk_mul_f32 v[96:97], v[96:97], v[28:29] op_sel_hi:[1,0]
v_pk_mul_f32 v[130:131], v[130:131], v[98:99]
v_pk_mul_f32 v[98:99], v[98:99], v[28:29] op_sel_hi:[1,0]
v_pk_mul_f32 v[144:145], v[144:145], v[112:113]
v_pk_mul_f32 v[112:113], v[112:113], v[28:29] op_sel_hi:[1,0]
v_pk_mul_f32 v[146:147], v[146:147], v[114:115]
v_pk_mul_f32 v[114:115], v[114:115], v[28:29] op_sel_hi:[1,0]
v_pk_fma_f32 v[44:45], v[44:45], v[26:27], v[26:27] op_sel:[0,1,1] op_sel_hi:[1,1,1]
v_pk_fma_f32 v[46:47], v[46:47], v[26:27], v[26:27] op_sel:[0,1,1] op_sel_hi:[1,1,1]
v_pk_fma_f32 v[60:61], v[60:61], v[26:27], v[26:27] op_sel:[0,1,1] op_sel_hi:[1,1,1]
v_pk_fma_f32 v[62:63], v[62:63], v[26:27], v[26:27] op_sel:[0,1,1] op_sel_hi:[1,1,1]
v_cvt_pk_bf16_f32 v40, v72, v73
v_cvt_pk_bf16_f32 v41, v74, v75
v_cvt_pk_bf16_f32 v42, v88, v89
v_cvt_pk_bf16_f32 v43, v90, v91
MAA 132,192,132
buffer_store_dwordx4 v[40:43], v11, s[16:19], s62 offen sc1
MAA 132,196,148
TR 106,17,51232
v_rcp_f32 v44, v44
MAA 132,0,164
TR 108,17,59168
v_rcp_f32 v45, v45
MAA 132,4,180
TR 110,17,59680
v_rcp_f32 v46, v46
MAA 148,12,180
v_rcp_f32 v47, v47
MAA 148,8,164
v_rcp_f32 v60, v60
MAA 148,204,148
v_rcp_f32 v61, v61
MAA 148,200,132
v_rcp_f32 v62, v62
MAA 100,112,164
v_rcp_f32 v63, v63
MAA 100,116,180
v_exp_f32 v96, v96
MAA 116,124,180
v_exp_f32 v97, v97
MAA 116,120,164
s_waitcnt lgkmcnt(0)
s_barrier
s_add_u32 m0, s59, 84480
v_exp_f32 v98, v98
v_exp_f32 v99, v99
v_exp_f32 v112, v112
v_exp_f32 v113, v113
v_exp_f32 v114, v114
v_exp_f32 v115, v115
v_pk_mul_f32 v[76:77], v[76:77], v[44:45]
v_pk_mul_f32 v[78:79], v[78:79], v[46:47]
v_pk_mul_f32 v[92:93], v[92:93], v[60:61]
v_pk_mul_f32 v[94:95], v[94:95], v[62:63]
v_pk_fma_f32 v[100:101], v[48:49], v[22:23], v[100:101] op_sel_hi:[1,0,1]
v_pk_fma_f32 v[102:103], v[50:51], v[22:23], v[102:103] op_sel_hi:[1,0,1]
v_pk_fma_f32 v[116:117], v[64:65], v[22:23], v[116:117] op_sel_hi:[1,0,1]
v_pk_fma_f32 v[118:119], v[66:67], v[22:23], v[118:119] op_sel_hi:[1,0,1]
v_pk_fma_f32 v[132:133], v[80:81], v[22:23], v[132:133] op_sel_hi:[1,0,1]
v_pk_fma_f32 v[134:135], v[82:83], v[22:23], v[134:135] op_sel_hi:[1,0,1]
v_pk_fma_f32 v[148:149], v[4:5], v[22:23], v[148:149] op_sel_hi:[1,0,1]
v_pk_fma_f32 v[150:151], v[6:7], v[22:23], v[150:151] op_sel_hi:[1,0,1]
v_pk_mul_f32 v[132:133], v[132:133], v[100:101]
v_pk_mul_f32 v[100:101], v[100:101], v[28:29] op_sel:[0,1] op_sel_hi:[1,1]
v_pk_mul_f32 v[134:135], v[134:135], v[102:103]
v_pk_mul_f32 v[102:103], v[102:103], v[28:29] op_sel:[0,1] op_sel_hi:[1,1]
v_pk_mul_f32 v[148:149], v[148:149], v[116:117]
v_pk_mul_f32 v[116:117], v[116:117], v[28:29] op_sel:[0,1] op_sel_hi:[1,1]
v_pk_mul_f32 v[150:151], v[150:151], v[118:119]
v_pk_mul_f32 v[118:119], v[118:119], v[28:29] op_sel:[0,1] op_sel_hi:[1,1]
v_pk_fma_f32 v[96:97], v[96:97], v[20:21], v[20:21] op_sel:[0,1,1] op_sel_hi:[1,1,1]
v_pk_fma_f32 v[98:99], v[98:99], v[20:21], v[20:21] op_sel:[0,1,1] op_sel_hi:[1,1,1]
v_pk_fma_f32 v[112:113], v[112:113], v[20:21], v[20:21] op_sel:[0,1,1] op_sel_hi:[1,1,1]
v_pk_fma_f32 v[114:115], v[114:115], v[20:21], v[20:21] op_sel:[0,1,1] op_sel_hi:[1,1,1]
v_cvt_pk_bf16_f32 v44, v76, v77
v_cvt_pk_bf16_f32 v45, v78, v79
v_cvt_pk_bf16_f32 v46, v92, v93
v_cvt_pk_bf16_f32 v47, v94, v95
MAA 136,192,136
buffer_store_dwordx4 v[44:47], v11, s[16:19], s62 offen offset:1024 sc1
MAA 136,196,152
v_rcp_f32 v96, v96
MAA 136,0,168
v_rcp_f32 v97, v97
MAA 136,4,184
v_rcp_f32 v98, v98
MAA 152,12,184
buffer_load_dwordx4 v18, s[28:31], s58 offen lds
MAA 152,8,168
v_rcp_f32 v99, v99
MAA 152,204,152
v_rcp_f32 v112, v112
MAA 152,200,136
v_rcp_f32 v113, v113
MAA 104,112,168
buffer_load_dwordx4 v19, s[28:31], s58 offen offset:1056 lds
MAA 104,116,184
s_add_u32 m0, s59, 92928
s_add_u32 s58, s99, 2555904
v_rcp_f32 v114, v114
MAA 120,124,184
v_rcp_f32 v115, v115
MAA 120,120,168
v_exp_f32 v100, v100
v_exp_f32 v101, v101
v_exp_f32 v102, v102
v_exp_f32 v103, v103
v_exp_f32 v116, v116
v_exp_f32 v117, v117
v_exp_f32 v118, v118
v_exp_f32 v119, v119
v_pk_mul_f32 v[128:129], v[128:129], v[96:97]
v_pk_mul_f32 v[130:131], v[130:131], v[98:99]
v_pk_mul_f32 v[144:145], v[144:145], v[112:113]
v_pk_mul_f32 v[146:147], v[146:147], v[114:115]
ds_read_b128 v[112:115], v9 offset:256
v_pk_fma_f32 v[104:105], v[48:49], v[24:25], v[104:105] op_sel_hi:[1,0,1]
v_pk_fma_f32 v[106:107], v[50:51], v[24:25], v[106:107] op_sel_hi:[1,0,1]
v_pk_fma_f32 v[120:121], v[64:65], v[24:25], v[120:121] op_sel_hi:[1,0,1]
v_pk_fma_f32 v[122:123], v[66:67], v[24:25], v[122:123] op_sel_hi:[1,0,1]
v_pk_fma_f32 v[136:137], v[80:81], v[24:25], v[136:137] op_sel_hi:[1,0,1]
v_pk_fma_f32 v[138:139], v[82:83], v[24:25], v[138:139] op_sel_hi:[1,0,1]
v_pk_fma_f32 v[152:153], v[4:5], v[24:25], v[152:153] op_sel_hi:[1,0,1]
v_pk_fma_f32 v[154:155], v[6:7], v[24:25], v[154:155] op_sel_hi:[1,0,1]
v_pk_mul_f32 v[136:137], v[136:137], v[104:105]
v_pk_mul_f32 v[104:105], v[104:105], v[30:31] op_sel_hi:[1,0]
v_pk_mul_f32 v[138:139], v[138:139], v[106:107]
v_pk_mul_f32 v[106:107], v[106:107], v[30:31] op_sel_hi:[1,0]
v_pk_mul_f32 v[152:153], v[152:153], v[120:121]
v_pk_mul_f32 v[120:121], v[120:121], v[30:31] op_sel_hi:[1,0]
v_pk_mul_f32 v[154:155], v[154:155], v[122:123]
v_pk_mul_f32 v[122:123], v[122:123], v[30:31] op_sel_hi:[1,0]
v_pk_fma_f32 v[100:101], v[100:101], v[22:23], v[22:23] op_sel:[0,1,1] op_sel_hi:[1,1,1]
v_pk_fma_f32 v[102:103], v[102:103], v[22:23], v[22:23] op_sel:[0,1,1] op_sel_hi:[1,1,1]
v_pk_fma_f32 v[116:117], v[116:117], v[22:23], v[22:23] op_sel:[0,1,1] op_sel_hi:[1,1,1]
v_pk_fma_f32 v[118:119], v[118:119], v[22:23], v[22:23] op_sel:[0,1,1] op_sel_hi:[1,1,1]
v_cvt_pk_bf16_f32 v96, v128, v129
v_cvt_pk_bf16_f32 v97, v130, v131
ds_read_b128 v[128:131], v9 offset:320
v_cvt_pk_bf16_f32 v98, v144, v145
v_cvt_pk_bf16_f32 v99, v146, v147
MAA 140,192,140
buffer_store_dwordx4 v[96:99], v10, s[16:19], s63 offen sc1
MAA 140,196,156
ds_read_b128 v[144:147], v9 offset:768
v_rcp_f32 v100, v100
MAA 140,0,172
v_rcp_f32 v101, v101
MAA 140,4,188
v_rcp_f32 v102, v102
MAA 156,12,188
buffer_load_dwordx4 v18, s[28:31], s58 offen lds
MAA 156,8,172
v_rcp_f32 v103, v103
MAA 156,204,156
v_rcp_f32 v116, v116
MAA 156,200,140
v_rcp_f32 v117, v117
MAA 108,112,172
buffer_load_dwordx4 v19, s[28:31], s58 offen offset:1056 lds
MAA 108,116,188
s_add_u32 m0, s59, 101376
s_add_u32 s58, s100, 2752512
v_rcp_f32 v118, v118
MAA 124,124,188
v_rcp_f32 v119, v119
MAA 124,120,172
v_exp_f32 v104, v104
v_exp_f32 v105, v105
v_exp_f32 v106, v106
v_exp_f32 v107, v107
v_exp_f32 v120, v120
v_exp_f32 v121, v121
v_exp_f32 v122, v122
v_exp_f32 v123, v123
v_pk_mul_f32 v[132:133], v[132:133], v[100:101]
v_pk_mul_f32 v[134:135], v[134:135], v[102:103]
v_pk_mul_f32 v[148:149], v[148:149], v[116:117]
v_pk_mul_f32 v[150:151], v[150:151], v[118:119]
v_pk_fma_f32 v[108:109], v[48:49], v[26:27], v[108:109] op_sel_hi:[1,0,1]
v_pk_fma_f32 v[110:111], v[50:51], v[26:27], v[110:111] op_sel_hi:[1,0,1]
v_pk_fma_f32 v[124:125], v[64:65], v[26:27], v[124:125] op_sel_hi:[1,0,1]
v_pk_fma_f32 v[126:127], v[66:67], v[26:27], v[126:127] op_sel_hi:[1,0,1]
v_pk_fma_f32 v[140:141], v[80:81], v[26:27], v[140:141] op_sel_hi:[1,0,1]
v_pk_fma_f32 v[142:143], v[82:83], v[26:27], v[142:143] op_sel_hi:[1,0,1]
v_pk_fma_f32 v[156:157], v[4:5], v[26:27], v[156:157] op_sel_hi:[1,0,1]
v_pk_fma_f32 v[158:159], v[6:7], v[26:27], v[158:159] op_sel_hi:[1,0,1]
v_pk_mul_f32 v[140:141], v[140:141], v[108:109]
v_pk_mul_f32 v[108:109], v[108:109], v[30:31] op_sel:[0,1] op_sel_hi:[1,1]
v_pk_mul_f32 v[142:143], v[142:143], v[110:111]
v_pk_mul_f32 v[110:111], v[110:111], v[30:31] op_sel:[0,1] op_sel_hi:[1,1]
v_pk_mul_f32 v[156:157], v[156:157], v[124:125]
s_waitcnt vmcnt(5)
s_barrier
buffer_atomic_add v71, v68, s[16:19], s72 offen offset:512
v_pk_mul_f32 v[124:125], v[124:125], v[30:31] op_sel:[0,1] op_sel_hi:[1,1]
v_pk_mul_f32 v[158:159], v[158:159], v[126:127]
v_pk_mul_f32 v[126:127], v[126:127], v[30:31] op_sel:[0,1] op_sel_hi:[1,1]
v_pk_fma_f32 v[104:105], v[104:105], v[24:25], v[24:25] op_sel:[0,1,1] op_sel_hi:[1,1,1]
v_pk_fma_f32 v[106:107], v[106:107], v[24:25], v[24:25] op_sel:[0,1,1] op_sel_hi:[1,1,1]
v_pk_fma_f32 v[120:121], v[120:121], v[24:25], v[24:25] op_sel:[0,1,1] op_sel_hi:[1,1,1]
v_pk_fma_f32 v[122:123], v[122:123], v[24:25], v[24:25] op_sel:[0,1,1] op_sel_hi:[1,1,1]
v_cvt_pk_bf16_f32 v100, v132, v133
v_cvt_pk_bf16_f32 v101, v134, v135
v_cvt_pk_bf16_f32 v102, v148, v149
v_cvt_pk_bf16_f32 v103, v150, v151
MAA 192,16,128
v_rcp_f32 v104, v104
MAA 192,20,144
buffer_store_dwordx4 v[100:103], v10, s[16:19], s63 offen offset:1024 sc1
MAA 192,48,160
v_rcp_f32 v105, v105
MAA 192,52,176
v_rcp_f32 v106, v106
MAA 208,60,176
v_rcp_f32 v107, v107
MAA 208,56,160
buffer_load_dwordx4 v18, s[28:31], s58 offen lds
MAA 208,28,144
v_rcp_f32 v120, v120
MAA 208,24,128
v_rcp_f32 v121, v121
MAA 160,32,160
v_rcp_f32 v122, v122
MAA 160,36,176
buffer_load_dwordx4 v19, s[28:31], s58 offen offset:1056 lds
MAA 176,44,176
s_add_u32 m0, s59, 109824
s_add_u32 s58, s100, 3014656
v_rcp_f32 v123, v123
MAA 176,40,160
v_exp_f32 v108, v108
v_exp_f32 v109, v109
v_exp_f32 v110, v110
v_exp_f32 v111, v111
v_exp_f32 v124, v124
v_exp_f32 v125, v125
v_exp_f32 v126, v126
v_exp_f32 v127, v127
v_pk_mul_f32 v[136:137], v[136:137], v[104:105]
v_pk_mul_f32 v[138:139], v[138:139], v[106:107]
v_pk_mul_f32 v[152:153], v[152:153], v[120:121]
v_pk_mul_f32 v[154:155], v[154:155], v[122:123]
s_waitcnt lgkmcnt(2)
v_pk_fma_f32 v[160:161], v[112:113], v[20:21], v[160:161] op_sel_hi:[1,0,1]
v_pk_fma_f32 v[162:163], v[114:115], v[20:21], v[162:163] op_sel_hi:[1,0,1]
s_waitcnt lgkmcnt(1)
v_pk_fma_f32 v[176:177], v[128:129], v[20:21], v[176:177] op_sel_hi:[1,0,1]
v_pk_fma_f32 v[178:179], v[130:131], v[20:21], v[178:179] op_sel_hi:[1,0,1]
s_waitcnt lgkmcnt(0)
v_pk_fma_f32 v[192:193], v[144:145], v[20:21], v[192:193] op_sel_hi:[1,0,1]
v_pk_fma_f32 v[194:195], v[146:147], v[20:21], v[194:195] op_sel_hi:[1,0,1]
v_pk_fma_f32 v[208:209], v[12:13], v[20:21], v[208:209] op_sel_hi:[1,0,1]
v_pk_fma_f32 v[210:211], v[14:15], v[20:21], v[210:211] op_sel_hi:[1,0,1]
v_pk_mul_f32 v[192:193], v[192:193], v[160:161]
v_pk_mul_f32 v[160:161], v[160:161], v[28:29] op_sel_hi:[1,0]
v_pk_mul_f32 v[194:195], v[194:195], v[162:163]
v_pk_mul_f32 v[162:163], v[162:163], v[28:29] op_sel_hi:[1,0]
v_pk_mul_f32 v[208:209], v[208:209], v[176:177]
v_pk_mul_f32 v[176:177], v[176:177], v[28:29] op_sel_hi:[1,0]
v_pk_mul_f32 v[210:211], v[210:211], v[178:179]
v_pk_mul_f32 v[178:179], v[178:179], v[28:29] op_sel_hi:[1,0]
v_pk_fma_f32 v[108:109], v[108:109], v[26:27], v[26:27] op_sel:[0,1,1] op_sel_hi:[1,1,1]
v_pk_fma_f32 v[110:111], v[110:111], v[26:27], v[26:27] op_sel:[0,1,1] op_sel_hi:[1,1,1]
v_pk_fma_f32 v[124:125], v[124:125], v[26:27], v[26:27] op_sel:[0,1,1] op_sel_hi:[1,1,1]
v_pk_fma_f32 v[126:127], v[126:127], v[26:27], v[26:27] op_sel:[0,1,1] op_sel_hi:[1,1,1]
v_cvt_pk_bf16_f32 v104, v136, v137
v_cvt_pk_bf16_f32 v105, v138, v139
v_cvt_pk_bf16_f32 v106, v152, v153
v_cvt_pk_bf16_f32 v107, v154, v155
MAA 196,16,132
buffer_store_dwordx4 v[104:107], v11, s[16:19], s63 offen sc1
MAA 196,20,148
v_rcp_f32 v108, v108
MAA 196,48,164
v_rcp_f32 v109, v109
MAA 196,52,180
v_rcp_f32 v110, v110
MAA 212,60,180
buffer_load_dwordx4 v18, s[28:31], s58 offen lds
MAA 212,56,164
v_rcp_f32 v111, v111
MAA 212,28,148
v_rcp_f32 v124, v124
MAA 212,24,132
v_rcp_f32 v125, v125
MAA 164,32,164
buffer_load_dwordx4 v19, s[28:31], s58 offen offset:1056 lds
MAA 164,36,180
s_add_u32 m0, s59, 118272
s_add_u32 s58, s101, 3211264
v_rcp_f32 v126, v126
MAA 180,44,180
v_rcp_f32 v127, v127
MAA 180,40,164
v_lshl_add_u32 v4, v1, 4, s74
v_add_u32 v2, 67108480, v4
v_cndmask_b32 v4, v4, v2, vcc
s_and_b32 s74, s7, 1
v_bfe_u32 v7, v1, 2, 3
v_mul_u32_u24 v7, 1056, v7
v_bfe_u32 v2, v1, 5, 1
v_lshl_add_u32 v7, v2, 8, v7
v_and_b32 v2, 3, v1
v_lshl_add_u32 v7, v2, 3, v7
s_lshl_b32 s74, s74, 7
s_xor_b32 s75, s74, 128
v_add_u32 v6, s75, v7
v_add_u32 v7, s74, v7
v_exp_f32 v160, v160
v_exp_f32 v161, v161
v_exp_f32 v162, v162
v_exp_f32 v163, v163
v_exp_f32 v176, v176
v_exp_f32 v177, v177
v_exp_f32 v178, v178
v_exp_f32 v179, v179
v_pk_mul_f32 v[140:141], v[140:141], v[108:109]
v_pk_mul_f32 v[142:143], v[142:143], v[110:111]
v_pk_mul_f32 v[156:157], v[156:157], v[124:125]
v_pk_mul_f32 v[158:159], v[158:159], v[126:127]
v_pk_fma_f32 v[164:165], v[112:113], v[22:23], v[164:165] op_sel_hi:[1,0,1]
v_pk_fma_f32 v[166:167], v[114:115], v[22:23], v[166:167] op_sel_hi:[1,0,1]
v_pk_fma_f32 v[180:181], v[128:129], v[22:23], v[180:181] op_sel_hi:[1,0,1]
v_pk_fma_f32 v[182:183], v[130:131], v[22:23], v[182:183] op_sel_hi:[1,0,1]
v_pk_fma_f32 v[196:197], v[144:145], v[22:23], v[196:197] op_sel_hi:[1,0,1]
v_pk_fma_f32 v[198:199], v[146:147], v[22:23], v[198:199] op_sel_hi:[1,0,1]
v_pk_fma_f32 v[212:213], v[12:13], v[22:23], v[212:213] op_sel_hi:[1,0,1]
v_pk_fma_f32 v[214:215], v[14:15], v[22:23], v[214:215] op_sel_hi:[1,0,1]
v_pk_mul_f32 v[196:197], v[196:197], v[164:165]
v_pk_mul_f32 v[164:165], v[164:165], v[28:29] op_sel:[0,1] op_sel_hi:[1,1]
v_pk_mul_f32 v[198:199], v[198:199], v[166:167]
v_pk_mul_f32 v[166:167], v[166:167], v[28:29] op_sel:[0,1] op_sel_hi:[1,1]
v_pk_mul_f32 v[212:213], v[212:213], v[180:181]
v_pk_mul_f32 v[180:181], v[180:181], v[28:29] op_sel:[0,1] op_sel_hi:[1,1]
v_pk_mul_f32 v[214:215], v[214:215], v[182:183]
v_pk_mul_f32 v[182:183], v[182:183], v[28:29] op_sel:[0,1] op_sel_hi:[1,1]
v_pk_fma_f32 v[160:161], v[160:161], v[20:21], v[20:21] op_sel:[0,1,1] op_sel_hi:[1,1,1]
v_pk_fma_f32 v[162:163], v[162:163], v[20:21], v[20:21] op_sel:[0,1,1] op_sel_hi:[1,1,1]
v_pk_fma_f32 v[176:177], v[176:177], v[20:21], v[20:21] op_sel:[0,1,1] op_sel_hi:[1,1,1]
v_pk_fma_f32 v[178:179], v[178:179], v[20:21], v[20:21] op_sel:[0,1,1] op_sel_hi:[1,1,1]
v_cvt_pk_bf16_f32 v108, v140, v141
v_cvt_pk_bf16_f32 v109, v142, v143
v_cvt_pk_bf16_f32 v110, v156, v157
v_cvt_pk_bf16_f32 v111, v158, v159
MAA 200,16,136
buffer_store_dwordx4 v[108:111], v11, s[16:19], s63 offen offset:1024 sc1
MAA 200,20,152
v_rcp_f32 v160, v160
MAA 200,48,168
v_rcp_f32 v161, v161
MAA 200,52,184
v_rcp_f32 v162, v162
MAA 216,60,184
buffer_load_dwordx4 v18, s[28:31], s58 offen lds
MAA 216,56,168
v_rcp_f32 v163, v163
MAA 216,28,152
v_rcp_f32 v176, v176
MAA 216,24,136
v_rcp_f32 v177, v177
MAA 168,32,168
buffer_load_dwordx4 v19, s[28:31], s58 offen offset:1056 lds
MAA 168,36,184
s_add_u32 m0, s59, 126720
s_add_u32 s58, s101, 3473408
v_rcp_f32 v178, v178
MAA 184,44,184
v_rcp_f32 v179, v179
MAA 184,40,168
v_exp_f32 v164, v164
v_exp_f32 v165, v165
v_exp_f32 v166, v166
v_exp_f32 v167, v167
v_exp_f32 v180, v180
v_exp_f32 v181, v181
v_exp_f32 v182, v182
v_exp_f32 v183, v183
v_pk_mul_f32 v[192:193], v[192:193], v[160:161]
v_pk_mul_f32 v[194:195], v[194:195], v[162:163]
v_pk_mul_f32 v[208:209], v[208:209], v[176:177]
v_pk_mul_f32 v[210:211], v[210:211], v[178:179]
ds_read_b128 v[176:179], v8
v_pk_fma_f32 v[168:169], v[112:113], v[24:25], v[168:169] op_sel_hi:[1,0,1]
v_pk_fma_f32 v[170:171], v[114:115], v[24:25], v[170:171] op_sel_hi:[1,0,1]
v_pk_fma_f32 v[184:185], v[128:129], v[24:25], v[184:185] op_sel_hi:[1,0,1]
v_pk_fma_f32 v[186:187], v[130:131], v[24:25], v[186:187] op_sel_hi:[1,0,1]
v_pk_fma_f32 v[200:201], v[144:145], v[24:25], v[200:201] op_sel_hi:[1,0,1]
v_pk_fma_f32 v[202:203], v[146:147], v[24:25], v[202:203] op_sel_hi:[1,0,1]
v_pk_fma_f32 v[216:217], v[12:13], v[24:25], v[216:217] op_sel_hi:[1,0,1]
v_pk_fma_f32 v[218:219], v[14:15], v[24:25], v[218:219] op_sel_hi:[1,0,1]
v_pk_mul_f32 v[200:201], v[200:201], v[168:169]
v_pk_mul_f32 v[168:169], v[168:169], v[30:31] op_sel_hi:[1,0]
v_pk_mul_f32 v[202:203], v[202:203], v[170:171]
v_pk_mul_f32 v[170:171], v[170:171], v[30:31] op_sel_hi:[1,0]
v_pk_mul_f32 v[216:217], v[216:217], v[184:185]
v_pk_mul_f32 v[184:185], v[184:185], v[30:31] op_sel_hi:[1,0]
v_pk_mul_f32 v[218:219], v[218:219], v[186:187]
v_pk_mul_f32 v[186:187], v[186:187], v[30:31] op_sel_hi:[1,0]
v_pk_fma_f32 v[164:165], v[164:165], v[22:23], v[22:23] op_sel:[0,1,1] op_sel_hi:[1,1,1]
v_pk_fma_f32 v[166:167], v[166:167], v[22:23], v[22:23] op_sel:[0,1,1] op_sel_hi:[1,1,1]
v_pk_fma_f32 v[180:181], v[180:181], v[22:23], v[22:23] op_sel:[0,1,1] op_sel_hi:[1,1,1]
v_pk_fma_f32 v[182:183], v[182:183], v[22:23], v[22:23] op_sel:[0,1,1] op_sel_hi:[1,1,1]
v_cvt_pk_bf16_f32 v160, v192, v193
v_cvt_pk_bf16_f32 v161, v194, v195
ds_read_b128 v[192:195], v8 offset:64
v_cvt_pk_bf16_f32 v162, v208, v209
v_cvt_pk_bf16_f32 v163, v210, v211
MAA 204,16,140
buffer_store_dwordx4 v[160:163], v10, s[16:19], s64 offen sc1
MAA 204,20,156
ds_read_b128 v[208:211], v8 offset:512
v_rcp_f32 v164, v164
MAA 204,48,172
v_rcp_f32 v165, v165
MAA 204,52,188
v_rcp_f32 v166, v166
MAA 220,60,188
buffer_atomic_add v84, v69, s[16:19], s73 offen offset:512 sc0
MAA 220,56,172
v_rcp_f32 v167, v167
MAA 220,28,156
v_rcp_f32 v180, v180
MAA 220,24,140
v_rcp_f32 v181, v181
MAA 172,32,172
buffer_load_dwordx4 v18, s[28:31], s58 offen lds
MAA 172,36,188
v_rcp_f32 v182, v182
MAA 188,44,188
v_rcp_f32 v183, v183
MAA 188,40,172
v_exp_f32 v168, v168
v_exp_f32 v169, v169
v_exp_f32 v170, v170
v_exp_f32 v171, v171
v_exp_f32 v184, v184
v_exp_f32 v185, v185
v_exp_f32 v186, v186
v_exp_f32 v187, v187
v_pk_mul_f32 v[196:197], v[196:197], v[164:165]
v_pk_mul_f32 v[198:199], v[198:199], v[166:167]
v_pk_mul_f32 v[212:213], v[212:213], v[180:181]
v_pk_mul_f32 v[214:215], v[214:215], v[182:183]
v_pk_fma_f32 v[172:173], v[112:113], v[26:27], v[172:173] op_sel_hi:[1,0,1]
v_pk_fma_f32 v[174:175], v[114:115], v[26:27], v[174:175] op_sel_hi:[1,0,1]
v_pk_fma_f32 v[188:189], v[128:129], v[26:27], v[188:189] op_sel_hi:[1,0,1]
v_pk_fma_f32 v[190:191], v[130:131], v[26:27], v[190:191] op_sel_hi:[1,0,1]
v_pk_fma_f32 v[204:205], v[144:145], v[26:27], v[204:205] op_sel_hi:[1,0,1]
v_pk_fma_f32 v[206:207], v[146:147], v[26:27], v[206:207] op_sel_hi:[1,0,1]
v_pk_fma_f32 v[220:221], v[12:13], v[26:27], v[220:221] op_sel_hi:[1,0,1]
v_pk_fma_f32 v[222:223], v[14:15], v[26:27], v[222:223] op_sel_hi:[1,0,1]
v_pk_mul_f32 v[204:205], v[204:205], v[172:173]
v_pk_mul_f32 v[172:173], v[172:173], v[30:31] op_sel:[0,1] op_sel_hi:[1,1]
v_pk_mul_f32 v[206:207], v[206:207], v[174:175]
v_pk_mul_f32 v[174:175], v[174:175], v[30:31] op_sel:[0,1] op_sel_hi:[1,1]
v_pk_mul_f32 v[220:221], v[220:221], v[188:189]
v_pk_mul_f32 v[188:189], v[188:189], v[30:31] op_sel:[0,1] op_sel_hi:[1,1]
v_pk_mul_f32 v[222:223], v[222:223], v[190:191]
v_pk_mul_f32 v[190:191], v[190:191], v[30:31] op_sel:[0,1] op_sel_hi:[1,1]
v_pk_fma_f32 v[168:169], v[168:169], v[24:25], v[24:25] op_sel:[0,1,1] op_sel_hi:[1,1,1]
v_pk_fma_f32 v[170:171], v[170:171], v[24:25], v[24:25] op_sel:[0,1,1] op_sel_hi:[1,1,1]
v_pk_fma_f32 v[184:185], v[184:185], v[24:25], v[24:25] op_sel:[0,1,1] op_sel_hi:[1,1,1]
v_pk_fma_f32 v[186:187], v[186:187], v[24:25], v[24:25] op_sel:[0,1,1] op_sel_hi:[1,1,1]
v_cvt_pk_bf16_f32 v164, v196, v197
v_cvt_pk_bf16_f32 v165, v198, v199
v_cvt_pk_bf16_f32 v166, v212, v213
v_cvt_pk_bf16_f32 v167, v214, v215
MAA 240,64,128
buffer_store_dwordx4 v[164:167], v10, s[16:19], s64 offen offset:1024 sc1
MAA 240,68,144
v_rcp_f32 v168, v168
MAA 240,96,160
v_rcp_f32 v169, v169
MAA 240,100,176
v_rcp_f32 v170, v170
MAA 248,108,176
buffer_atomic_add v85, v69, s[16:19], s73 offen offset:512 sc0
MAA 248,104,160
v_rcp_f32 v171, v171
MAA 248,76,144
v_rcp_f32 v184, v184
MAA 248,72,128
v_rcp_f32 v185, v185
MAA 224,80,160
buffer_load_dwordx4 v19, s[28:31], s58 offen offset:1056 lds
MAA 224,84,176
v_rcp_f32 v186, v186
MAA 232,92,176
v_rcp_f32 v187, v187
MAA 232,88,160
v_exp_f32 v172, v172
v_exp_f32 v173, v173
v_exp_f32 v174, v174
v_exp_f32 v175, v175
v_exp_f32 v188, v188
v_exp_f32 v189, v189
v_exp_f32 v190, v190
v_exp_f32 v191, v191
v_pk_mul_f32 v[200:201], v[200:201], v[168:169]
v_pk_mul_f32 v[202:203], v[202:203], v[170:171]
v_pk_mul_f32 v[216:217], v[216:217], v[184:185]
v_pk_mul_f32 v[218:219], v[218:219], v[186:187]
.Lpad17:
s_cbranch_execz .Lpad20
s_waitcnt lgkmcnt(2)
v_pk_fma_f32 v[224:225], v[176:177], v[20:21], v[224:225] op_sel_hi:[1,0,1]
v_pk_fma_f32 v[226:227], v[178:179], v[20:21], v[226:227] op_sel_hi:[1,0,1]
s_waitcnt lgkmcnt(1)
v_pk_fma_f32 v[232:233], v[192:193], v[20:21], v[232:233] op_sel_hi:[1,0,1]
v_pk_fma_f32 v[234:235], v[194:195], v[20:21], v[234:235] op_sel_hi:[1,0,1]
s_waitcnt lgkmcnt(0)
v_pk_fma_f32 v[240:241], v[208:209], v[20:21], v[240:241] op_sel_hi:[1,0,1]
v_pk_fma_f32 v[242:243], v[210:211], v[20:21], v[242:243] op_sel_hi:[1,0,1]
v_pk_fma_f32 v[248:249], v[52:53], v[20:21], v[248:249] op_sel_hi:[1,0,1]
v_pk_fma_f32 v[250:251], v[54:55], v[20:21], v[250:251] op_sel_hi:[1,0,1]
v_pk_mul_f32 v[240:241], v[240:241], v[224:225]
v_pk_mul_f32 v[224:225], v[224:225], v[28:29] op_sel_hi:[1,0]
v_pk_mul_f32 v[242:243], v[242:243], v[226:227]
v_pk_mul_f32 v[226:227], v[226:227], v[28:29] op_sel_hi:[1,0]
v_pk_mul_f32 v[248:249], v[248:249], v[232:233]
v_pk_mul_f32 v[232:233], v[232:233], v[28:29] op_sel_hi:[1,0]
v_pk_mul_f32 v[250:251], v[250:251], v[234:235]
v_pk_mul_f32 v[234:235], v[234:235], v[28:29] op_sel_hi:[1,0]
v_pk_fma_f32 v[172:173], v[172:173], v[26:27], v[26:27] op_sel:[0,1,1] op_sel_hi:[1,1,1]
v_pk_fma_f32 v[174:175], v[174:175], v[26:27], v[26:27] op_sel:[0,1,1] op_sel_hi:[1,1,1]
v_pk_fma_f32 v[188:189], v[188:189], v[26:27], v[26:27] op_sel:[0,1,1] op_sel_hi:[1,1,1]
v_pk_fma_f32 v[190:191], v[190:191], v[26:27], v[26:27] op_sel:[0,1,1] op_sel_hi:[1,1,1]
v_cvt_pk_bf16_f32 v168, v200, v201
v_cvt_pk_bf16_f32 v169, v202, v203
v_cvt_pk_bf16_f32 v170, v216, v217
v_cvt_pk_bf16_f32 v171, v218, v219
buffer_store_dwordx4 v[168:171], v11, s[16:19], s64 offen sc1
buffer_atomic_add v86, v69, s[16:19], s73 offen offset:512 sc0
s_waitcnt vmcnt(6)
v_cmp_gt_u32 vcc, v70, v84
s_nop 0
s_cbranch_vccz .Lok49
s_waitcnt vmcnt(3)
v_cmp_gt_u32 vcc, v70, v85
s_nop 0
s_cbranch_vccz .Lok49
s_waitcnt vmcnt(0)
v_cmp_gt_u32 vcc, v70, v86
s_nop 0
s_cbranch_vccz .Lok49
s_mov_b32 s15, 0
.Lok49l:
v_mov_b32 v84, 0
buffer_atomic_add v84, v69, s[16:19], s73 offen offset:512 sc0
s_add_u32 s15, s15, 1
s_cmp_gt_u32 s15, 100000
s_waitcnt vmcnt(0)
s_cbranch_scc1 .Lok49
v_cmp_gt_u32 vcc, v70, v84
s_nop 0
s_cbranch_vccnz .Lok49l
.Lok49:
s_waitcnt vmcnt(2)
s_barrier
MAA 244,64,132
ds_read_b64_tr_b16 a[0:1], v7
s_add_u32 s52, s76, 0
MAA 244,68,148
buffer_load_dwordx4 v[96:99], v4, s[16:19], s52 offen sc1
MAA 244,96,164
TR 2,7,512
v_rcp_f32 v172, v172
MAA 244,100,180
TR 4,7,32
v_rcp_f32 v173, v173
MAA 252,108,180
TR 6,7,544
v_rcp_f32 v174, v174
MAA 252,104,164
buffer_load_dwordx4 v[100:103], v4, s[16:19], s52 offen offset:1024 sc1
MAA 252,76,148
TR 8,7,64
s_add_u32 s52, s76, 65536
MAA 252,72,132
TR 10,7,576
v_rcp_f32 v175, v175
MAA 228,80,164
TR 12,7,96
v_rcp_f32 v188, v188
MAA 228,84,180
buffer_load_dwordx4 v[104:107], v4, s[16:19], s52 offen sc1
MAA 236,92,180
TR 14,7,608
v_rcp_f32 v189, v189
MAA 236,88,164
TR 16,7,8448
v_rcp_f32 v190, v190
v_rcp_f32 v191, v191
v_exp_f32 v224, v224
v_exp_f32 v225, v225
v_exp_f32 v226, v226
v_exp_f32 v227, v227
v_exp_f32 v232, v232
v_exp_f32 v233, v233
v_exp_f32 v234, v234
v_exp_f32 v235, v235
v_pk_mul_f32 v[204:205], v[204:205], v[172:173]
buffer_load_dwordx4 v[108:111], v4, s[16:19], s52 offen offset:1024 sc1
s_add_u32 s52, s77, 114688
v_pk_mul_f32 v[206:207], v[206:207], v[174:175]
v_pk_mul_f32 v[220:221], v[220:221], v[188:189]
v_pk_mul_f32 v[222:223], v[222:223], v[190:191]
v_pk_fma_f32 v[228:229], v[176:177], v[22:23], v[228:229] op_sel_hi:[1,0,1]
v_pk_fma_f32 v[230:231], v[178:179], v[22:23], v[230:231] op_sel_hi:[1,0,1]
v_pk_fma_f32 v[236:237], v[192:193], v[22:23], v[236:237] op_sel_hi:[1,0,1]
v_pk_fma_f32 v[238:239], v[194:195], v[22:23], v[238:239] op_sel_hi:[1,0,1]
v_pk_fma_f32 v[244:245], v[208:209], v[22:23], v[244:245] op_sel_hi:[1,0,1]
v_pk_fma_f32 v[246:247], v[210:211], v[22:23], v[246:247] op_sel_hi:[1,0,1]
v_pk_fma_f32 v[252:253], v[52:53], v[22:23], v[252:253] op_sel_hi:[1,0,1]
v_pk_fma_f32 v[254:255], v[54:55], v[22:23], v[254:255] op_sel_hi:[1,0,1]
v_pk_mul_f32 v[244:245], v[244:245], v[228:229]
buffer_load_dwordx4 v[112:115], v4, s[16:19], s52 offen sc1
v_pk_mul_f32 v[228:229], v[228:229], v[28:29] op_sel:[0,1] op_sel_hi:[1,1]
v_pk_mul_f32 v[246:247], v[246:247], v[230:231]
v_pk_mul_f32 v[230:231], v[230:231], v[28:29] op_sel:[0,1] op_sel_hi:[1,1]
v_pk_mul_f32 v[252:253], v[252:253], v[236:237]
v_pk_mul_f32 v[236:237], v[236:237], v[28:29] op_sel:[0,1] op_sel_hi:[1,1]
v_pk_mul_f32 v[254:255], v[254:255], v[238:239]
v_pk_mul_f32 v[238:239], v[238:239], v[28:29] op_sel:[0,1] op_sel_hi:[1,1]
v_pk_fma_f32 v[224:225], v[224:225], v[20:21], v[20:21] op_sel:[0,1,1] op_sel_hi:[1,1,1]
v_pk_fma_f32 v[226:227], v[226:227], v[20:21], v[20:21] op_sel:[0,1,1] op_sel_hi:[1,1,1]
v_pk_fma_f32 v[232:233], v[232:233], v[20:21], v[20:21] op_sel:[0,1,1] op_sel_hi:[1,1,1]
v_pk_fma_f32 v[234:235], v[234:235], v[20:21], v[20:21] op_sel:[0,1,1] op_sel_hi:[1,1,1]
v_cvt_pk_bf16_f32 v172, v204, v205
v_cvt_pk_bf16_f32 v173, v206, v207
buffer_load_dwordx4 v[116:119], v4, s[16:19], s52 offen offset:1024 sc1
s_add_u32 s52, s77, 180224
v_cvt_pk_bf16_f32 v174, v220, v221
v_cvt_pk_bf16_f32 v175, v222, v223
TR 18,7,8960
TR 20,7,8480
TR 22,7,8992
TR 24,7,8512
TR 26,7,9024
buffer_store_dwordx4 v[172:175], v11, s[16:19], s64 offen offset:1024 sc1
TR 28,7,8544
TR 30,7,9056
v_rcp_f32 v224, v224
v_rcp_f32 v225, v225
v_rcp_f32 v226, v226
v_rcp_f32 v227, v227
v_rcp_f32 v232, v232
v_rcp_f32 v233, v233
v_rcp_f32 v234, v234
v_rcp_f32 v235, v235
v_exp_f32 v228, v228
v_exp_f32 v229, v229
v_exp_f32 v230, v230
v_exp_f32 v231, v231
v_exp_f32 v236, v236
v_exp_f32 v237, v237
v_exp_f32 v238, v238
v_exp_f32 v239, v239
v_pk_mul_f32 v[240:241], v[240:241], v[224:225]
buffer_load_dwordx4 v[120:123], v4, s[16:19], s52 offen sc1
v_pk_mul_f32 v[242:243], v[242:243], v[226:227]
v_pk_mul_f32 v[248:249], v[248:249], v[232:233]
v_pk_mul_f32 v[250:251], v[250:251], v[234:235]
v_pk_fma_f32 v[228:229], v[228:229], v[22:23], v[22:23] op_sel:[0,1,1] op_sel_hi:[1,1,1]
v_pk_fma_f32 v[230:231], v[230:231], v[22:23], v[22:23] op_sel:[0,1,1] op_sel_hi:[1,1,1]
v_pk_fma_f32 v[236:237], v[236:237], v[22:23], v[22:23] op_sel:[0,1,1] op_sel_hi:[1,1,1]
v_pk_fma_f32 v[238:239], v[238:239], v[22:23], v[22:23] op_sel:[0,1,1] op_sel_hi:[1,1,1]
v_cvt_pk_bf16_f32 v224, v240, v241
v_cvt_pk_bf16_f32 v225, v242, v243
v_cvt_pk_bf16_f32 v226, v248, v249
v_cvt_pk_bf16_f32 v227, v250, v251
v_rcp_f32 v228, v228
v_rcp_f32 v229, v229
v_rcp_f32 v230, v230
v_rcp_f32 v231, v231
v_rcp_f32 v236, v236
v_rcp_f32 v237, v237
v_rcp_f32 v238, v238
v_rcp_f32 v239, v239
v_pk_mul_f32 v[244:245], v[244:245], v[228:229]
buffer_store_dwordx4 v[224:227], v10, s[16:19], s65 offen sc1
v_pk_mul_f32 v[246:247], v[246:247], v[230:231]
v_pk_mul_f32 v[252:253], v[252:253], v[236:237]
v_pk_mul_f32 v[254:255], v[254:255], v[238:239]
v_cvt_pk_bf16_f32 v228, v244, v245
v_cvt_pk_bf16_f32 v229, v246, v247
v_cvt_pk_bf16_f32 v230, v252, v253
v_cvt_pk_bf16_f32 v231, v254, v255
buffer_store_dwordx4 v[228:231], v10, s[16:19], s65 offen offset:1024 sc1
buffer_load_dwordx4 v[124:127], v4, s[16:19], s52 offen offset:1024 sc1
v_mov_b32 v21, v68
v_mov_b32 v22, v69
v_mov_b32 v23, v70
v_mov_b32 v24, v71
v_mov_b32 v25, 0
s_waitcnt vmcnt(7) lgkmcnt(0)
s_barrier
v_mfma_f32_16x16x32_bf16 v[32:35], a[0:3], v[96:99], 0
ds_read_b64_tr_b16 a[32:33], v6
s_add_u32 s52, s78, 229376
MAV 32,16,104
buffer_load_dwordx4 v[128:131], v4, s[16:19], s52 offen sc1
v_mfma_f32_16x16x32_bf16 v[48:51], a[0:3], v[100:103], 0
TR 34,6,512
MAV 48,16,108
TR 36,6,32
TR 38,6,544
v_mfma_f32_16x16x32_bf16 v[52:55], a[4:7], v[100:103], 0
TR 48,6,8448
MAV 52,20,108
buffer_load_dwordx4 v[132:135], v4, s[16:19], s52 offen offset:1024 sc1
v_mfma_f32_16x16x32_bf16 v[36:39], a[4:7], v[96:99], 0
TR 50,6,8960
MAV 36,20,104
TR 52,6,8480
TR 54,6,8992
v_mfma_f32_16x16x32_bf16 v[40:43], a[8:11], v[96:99], 0
TR 40,6,64
s_add_u32 s52, s78, 294912
MAV 40,24,104
buffer_load_dwordx4 v[136:139], v4, s[16:19], s52 offen sc1
v_mfma_f32_16x16x32_bf16 v[56:59], a[8:11], v[100:103], 0
TR 42,6,576
MAV 56,24,108
TR 44,6,96
TR 46,6,608
v_mfma_f32_16x16x32_bf16 v[60:63], a[12:15], v[100:103], 0
TR 56,6,8512
MAV 60,28,108
buffer_load_dwordx4 v[140:143], v4, s[16:19], s52 offen offset:1024 sc1
v_mfma_f32_16x16x32_bf16 v[44:47], a[12:15], v[96:99], 0
TR 58,6,9024
MAV 44,28,104
TR 60,6,8544
TR 62,6,9056
s_waitcnt lgkmcnt(8)
v_mfma_f32_16x16x32_bf16 v[64:67], a[32:35], v[96:99], 0
TR 0,7,16896
s_add_u32 s52, s79, 344064
MAV 64,48,104
buffer_load_dwordx4 v[144:147], v4, s[16:19], s52 offen sc1
v_mfma_f32_16x16x32_bf16 v[80:83], a[32:35], v[100:103], 0
TR 2,7,17408
MAV 80,48,108
TR 4,7,16928
TR 6,7,17440
v_mfma_f32_16x16x32_bf16 v[84:87], a[36:39], v[100:103], 0
TR 16,7,25344
MAV 84,52,108
buffer_load_dwordx4 v[148:151], v4, s[16:19], s52 offen offset:1024 sc1
v_mfma_f32_16x16x32_bf16 v[68:71], a[36:39], v[96:99], 0
TR 18,7,25856
MAV 68,52,104
TR 20,7,25376
TR 22,7,25888
s_waitcnt lgkmcnt(8)
v_mfma_f32_16x16x32_bf16 v[72:75], a[40:43], v[96:99], 0
TR 8,7,16960
s_add_u32 s52, s79, 409600
MAV 72,56,104
buffer_load_dwordx4 v[152:155], v4, s[16:19], s52 offen sc1
v_mfma_f32_16x16x32_bf16 v[88:91], a[40:43], v[100:103], 0
TR 10,7,17472
MAV 88,56,108
TR 12,7,16992
TR 14,7,17504
v_mfma_f32_16x16x32_bf16 v[92:95], a[44:47], v[100:103], 0
TR 24,7,25408
MAV 92,60,108
buffer_load_dwordx4 v[156:159], v4, s[16:19], s52 offen offset:1024 sc1
v_mfma_f32_16x16x32_bf16 v[76:79], a[44:47], v[96:99], 0
TR 26,7,25920
MAV 76,60,104
TR 28,7,25440
TR 30,7,25952
s_waitcnt vmcnt(8) lgkmcnt(8)
s_barrier
MAV 32,0,112
TR 32,6,16896
s_add_u32 m0, s55, 0
MAV 32,16,120
buffer_load_dwordx4 v18, s[28:31], s54 offen lds
MAV 48,16,124
TR 34,6,17408
MAV 48,0,116
TR 36,6,16928
TR 38,6,17440
MAV 52,4,116
TR 48,6,25344
s_add_u32 s52, s76, 458752
MAV 52,20,124
buffer_load_dwordx4 v[96:99], v4, s[16:19], s52 offen sc1
MAV 36,20,120
TR 50,6,25856
MAV 36,4,112
TR 52,6,25376
TR 54,6,25888
s_waitcnt lgkmcnt(8)
MAV 40,8,112
TR 40,6,16960
MAV 40,24,120
buffer_load_dwordx4 v19, s[28:31], s54 offen offset:1056 lds
MAV 56,24,124
TR 42,6,17472
s_add_u32 s54, s98, 327680
MAV 56,8,116
TR 44,6,16992
TR 46,6,17504
MAV 60,12,116
TR 56,6,25408
MAV 60,28,124
buffer_load_dwordx4 v[100:103], v4, s[16:19], s52 offen offset:1024 sc1
MAV 44,28,120
TR 58,6,25920
MAV 44,12,112
TR 60,6,25440
TR 62,6,25952
s_waitcnt lgkmcnt(8)
MAV 64,32,112
TR 0,7,33792
s_add_u32 m0, s55, 8448
MAV 64,48,120
buffer_load_dwordx4 v18, s[28:31], s54 offen lds
MAV 80,48,124
TR 2,7,34304
MAV 80,32,116
TR 4,7,33824
TR 6,7,34336
MAV 84,36,116
TR 16,7,42240
s_add_u32 s52, s76, 524288
MAV 84,52,124
buffer_load_dwordx4 v[104:107], v4, s[16:19], s52 offen sc1
MAV 68,52,120
TR 18,7,42752
MAV 68,36,112
TR 20,7,42272
TR 22,7,42784
s_waitcnt lgkmcnt(8)
MAV 72,40,112
TR 8,7,33856
MAV 72,56,120
buffer_load_dwordx4 v19, s[28:31], s54 offen offset:1056 lds
MAV 88,56,124
TR 10,7,34368
s_add_u32 s54, s99, 524288
MAV 88,40,116
TR 12,7,33888
TR 14,7,34400
MAV 92,44,116
TR 24,7,42304
MAV 92,60,124
buffer_load_dwordx4 v[108:111], v4, s[16:19], s52 offen offset:1024 sc1
MAV 76,60,120
TR 26,7,42816
MAV 76,44,112
TR 28,7,42336
TR 30,7,42848
s_waitcnt vmcnt(12) lgkmcnt(8)
s_barrier
MAV 32,0,128
TR 32,6,33792
MAV 32,16,136
buffer_atomic_add v24, v21, s[16:19], s72 offen
MAV 48,16,140
TR 34,6,34304
MAV 48,0,132
TR 36,6,33824
TR 38,6,34336
TR 48,6,42240
MAV 52,4,132
TR 50,6,42752
s_add_u32 m0, s55, 16896
MAV 52,20,140
buffer_load_dwordx4 v18, s[28:31], s54 offen lds
MAV 36,20,136
TR 52,6,42272
MAV 36,4,128
TR 54,6,42784
TR 40,6,33856
s_waitcnt lgkmcnt(9)
MAV 40,8,128
TR 42,6,34368
s_add_u32 s52, s77, 573440
MAV 40,24,136
buffer_load_dwordx4 v[112:115], v4, s[16:19], s52 offen sc1
MAV 56,24,140
TR 44,6,33888
MAV 56,8,132
buffer_load_dwordx4 v19, s[28:31], s54 offen offset:1056 lds
MAV 60,12,132
TR 46,6,34400
s_add_u32 s54, s99, 786432
MAV 60,28,140
buffer_load_dwordx4 v[116:119], v4, s[16:19], s52 offen offset:1024 sc1
MAV 44,28,136
TR 56,6,42304
MAV 44,12,128
TR 58,6,42816
TR 60,6,42336
TR 62,6,42848
s_waitcnt lgkmcnt(8)
MAV 64,32,128
TR 0,7,50688
s_add_u32 m0, s55, 25344
MAV 64,48,136
buffer_load_dwordx4 v18, s[28:31], s54 offen lds
MAV 80,48,140
TR 2,7,51200
MAV 80,32,132
TR 4,7,50720
TR 6,7,51232
MAV 84,36,132
TR 16,7,59136
s_add_u32 s52, s77, 638976
MAV 84,52,140
buffer_load_dwordx4 v[120:123], v4, s[16:19], s52 offen sc1
MAV 68,52,136
TR 18,7,59648
MAV 68,36,128
TR 20,7,59168
TR 22,7,59680
s_waitcnt lgkmcnt(8)
MAV 72,40,128
TR 8,7,50752
MAV 72,56,136
buffer_load_dwordx4 v19, s[28:31], s54 offen offset:1056 lds
MAV 88,56,140
TR 10,7,51264
s_add_u32 s54, s100, 983040
MAV 88,40,132
TR 12,7,50784
TR 14,7,51296
MAV 92,44,132
TR 24,7,59200
MAV 92,60,140
buffer_load_dwordx4 v[124:127], v4, s[16:19], s52 offen offset:1024 sc1
MAV 76,60,136
TR 26,7,59712
MAV 76,44,128
TR 28,7,59232
TR 30,7,59744
s_waitcnt vmcnt(17) lgkmcnt(8)
s_barrier
MAV 32,0,144
TR 32,6,50688
s_add_u32 m0, s55, 33792
MAV 32,16,152
buffer_load_dwordx4 v18, s[28:31], s54 offen lds
MAV 48,16,156
TR 34,6,51200
MAV 48,0,148
TR 36,6,50720
TR 38,6,51232
MAV 52,4,148
TR 48,6,59136
s_add_u32 s52, s78, 688128
MAV 52,20,156
buffer_load_dwordx4 v[128:131], v4, s[16:19], s52 offen sc1
MAV 36,20,152
TR 50,6,59648
MAV 36,4,144
TR 52,6,59168
TR 54,6,59680
s_waitcnt lgkmcnt(8)
MAV 40,8,144
TR 40,6,50752
MAV 40,24,152
buffer_load_dwordx4 v19, s[28:31], s54 offen offset:1056 lds
MAV 56,24,156
TR 42,6,51264
s_add_u32 s54, s100, 1245184
MAV 56,8,148
TR 44,6,50784
TR 46,6,51296
MAV 60,12,148
TR 56,6,59200
MAV 60,28,156
buffer_load_dwordx4 v[132:135], v4, s[16:19], s52 offen offset:1024 sc1
MAV 44,28,152
TR 58,6,59712
MAV 44,12,144
TR 60,6,59232
TR 62,6,59744
v_add_u32 v7, s57, v7
v_add_u32 v6, s57, v6
s_sub_u32 s57, 0, s57
s_waitcnt lgkmcnt(8)
MAV 64,32,144
ds_read_b64_tr_b16 a[0:1], v7
s_add_u32 m0, s55, 42240
MAV 64,48,152
buffer_load_dwordx4 v18, s[28:31], s54 offen lds
MAV 80,48,156
TR 2,7,512
MAV 80,32,148
TR 4,7,32
TR 6,7,544
TR 16,7,8448
MAV 84,36,148
TR 18,7,8960
s_add_u32 s52, s78, 753664
MAV 84,52,156
buffer_load_dwordx4 v[136:139], v4, s[16:19], s52 offen sc1
MAV 68,52,152
TR 20,7,8480
MAV 68,36,144
TR 22,7,8992
TR 8,7,64
s_waitcnt lgkmcnt(9)
MAV 72,40,144
TR 10,7,576
MAV 72,56,152
buffer_load_dwordx4 v19, s[28:31], s54 offen offset:1056 lds
MAV 88,56,156
TR 12,7,96
s_add_u32 s54, s101, 1441792
MAV 88,40,148
buffer_load_dwordx4 v[140:143], v4, s[16:19], s52 offen offset:1024 sc1
MAV 92,44,148
TR 14,7,608
MAV 92,60,156
buffer_atomic_add v25, v22, s[16:19], s73 offen sc0
MAV 76,60,152
TR 24,7,8512
MAV 76,44,144
TR 26,7,9024
TR 28,7,8544
TR 30,7,9056
s_waitcnt vmcnt(18) lgkmcnt(8)
s_barrier
MAV 32,0,96
ds_read_b64_tr_b16 a[32:33], v6
s_add_u32 m0, s55, 50688
MAV 32,16,104
buffer_load_dwordx4 v18, s[28:31], s54 offen lds
MAV 48,16,108
TR 34,6,512
MAV 48,0,100
TR 36,6,32
TR 38,6,544
MAV 52,4,100
TR 48,6,8448
s_add_u32 s52, s79, 802816
MAV 52,20,108
buffer_load_dwordx4 v[144:147], v4, s[16:19], s52 offen sc1
MAV 36,20,104
TR 50,6,8960
MAV 36,4,96
TR 52,6,8480
TR 54,6,8992
s_waitcnt lgkmcnt(8)
MAV 40,8,96
TR 40,6,64
MAV 40,24,104
buffer_load_dwordx4 v19, s[28:31], s54 offen offset:1056 lds
MAV 56,24,108
TR 42,6,576
s_add_u32 s54, s101, 1703936
MAV 56,8,100
TR 44,6,96
TR 46,6,608
MAV 60,12,100
TR 56,6,8512
MAV 60,28,108
buffer_load_dwordx4 v[148:151], v4, s[16:19], s52 offen offset:1024 sc1
.Lpad18:
s_cbranch_execz .Lpad21
MAV 44,28,104
TR 58,6,9024
MAV 44,12,96
TR 60,6,8544
TR 62,6,9056
s_waitcnt lgkmcnt(8)
MAV 64,32,96
TR 0,7,16896
s_add_u32 m0, s55, 59136
MAV 64,48,104
buffer_load_dwordx4 v18, s[28:31], s54 offen lds
MAV 80,48,108
TR 2,7,17408
MAV 80,32,100
TR 4,7,16928
TR 6,7,17440
MAV 84,36,100
TR 16,7,25344
s_add_u32 s52, s79, 868352
MAV 84,52,108
buffer_load_dwordx4 v[152:155], v4, s[16:19], s52 offen sc1
MAV 68,52,104
TR 18,7,25856
MAV 68,36,96
TR 20,7,25376
TR 22,7,25888
s_waitcnt lgkmcnt(8)
MAV 72,40,96
TR 8,7,16960
MAV 72,56,104
buffer_load_dwordx4 v19, s[28:31], s54 offen offset:1056 lds
MAV 88,56,108
TR 10,7,17472
s_add_u32 s54, s98, 1900544
MAV 88,40,100
TR 12,7,16992
TR 14,7,17504
MAV 92,44,100
TR 24,7,25408
MAV 92,60,108
buffer_load_dwordx4 v[156:159], v4, s[16:19], s52 offen offset:1024 sc1
MAV 76,60,104
TR 26,7,25920
MAV 76,44,96
TR 28,7,25440
TR 30,7,25952
s_waitcnt vmcnt(8)
v_cmp_gt_u32 vcc, v23, v25
s_nop 0
s_cbranch_vccnz .Lsp50
.Lsp50b:
s_waitcnt lgkmcnt(8)
s_barrier
MAV 32,0,112
TR 32,6,16896
s_add_u32 m0, s55, 67584
MAV 32,16,120
buffer_load_dwordx4 v18, s[28:31], s54 offen lds
MAV 48,16,124
TR 34,6,17408
MAV 48,0,116
TR 36,6,16928
TR 38,6,17440
MAV 52,4,116
TR 48,6,25344
s_add_u32 s52, s76, 16384
MAV 52,20,124
buffer_load_dwordx4 v[96:99], v4, s[16:19], s52 offen sc1
MAV 36,20,120
TR 50,6,25856
MAV 36,4,112
TR 52,6,25376
TR 54,6,25888
s_waitcnt lgkmcnt(8)
MAV 40,8,112
TR 40,6,16960
MAV 40,24,120
buffer_load_dwordx4 v19, s[28:31], s54 offen offset:1056 lds
MAV 56,24,124
TR 42,6,17472
s_add_u32 s54, s98, 2162688
MAV 56,8,116
TR 44,6,16992
TR 46,6,17504
MAV 60,12,116
TR 56,6,25408
MAV 60,28,124
buffer_load_dwordx4 v[100:103], v4, s[16:19], s52 offen offset:1024 sc1
MAV 44,28,120
TR 58,6,25920
MAV 44,12,112
TR 60,6,25440
TR 62,6,25952
s_waitcnt lgkmcnt(8)
MAV 64,32,112
TR 0,7,33792
s_add_u32 m0, s55, 76032
MAV 64,48,120
buffer_load_dwordx4 v18, s[28:31], s54 offen lds
MAV 80,48,124
TR 2,7,34304
MAV 80,32,116
TR 4,7,33824
TR 6,7,34336
MAV 84,36,116
TR 16,7,42240
s_add_u32 s52, s76, 81920
MAV 84,52,124
buffer_load_dwordx4 v[104:107], v4, s[16:19], s52 offen sc1
MAV 68,52,120
TR 18,7,42752
MAV 68,36,112
TR 20,7,42272
TR 22,7,42784
s_waitcnt lgkmcnt(8)
MAV 72,40,112
TR 8,7,33856
MAV 72,56,120
buffer_load_dwordx4 v19, s[28:31], s54 offen offset:1056 lds
MAV 88,56,124
TR 10,7,34368
s_add_u32 s54, s99, 2359296
MAV 88,40,116
TR 12,7,33888
TR 14,7,34400
MAV 92,44,116
TR 24,7,42304
MAV 92,60,124
buffer_load_dwordx4 v[108:111], v4, s[16:19], s52 offen offset:1024 sc1
MAV 76,60,120
TR 26,7,42816
MAV 76,44,112
TR 28,7,42336
TR 30,7,42848
s_waitcnt lgkmcnt(8)
s_barrier
MAV 32,0,128
TR 32,6,33792
s_add_u32 m0, s55, 84480
MAV 32,16,136
buffer_load_dwordx4 v18, s[28:31], s54 offen lds
MAV 48,16,140
TR 34,6,34304
MAV 48,0,132
TR 36,6,33824
TR 38,6,34336
MAV 52,4,132
TR 48,6,42240
s_add_u32 s52, s77, 131072
MAV 52,20,140
buffer_load_dwordx4 v[112:115], v4, s[16:19], s52 offen sc1
MAV 36,20,136
TR 50,6,42752
MAV 36,4,128
TR 52,6,42272
TR 54,6,42784
s_waitcnt lgkmcnt(8)
MAV 40,8,128
TR 40,6,33856
MAV 40,24,136
buffer_load_dwordx4 v19, s[28:31], s54 offen offset:1056 lds
MAV 56,24,140
TR 42,6,34368
s_add_u32 s54, s99, 2621440
MAV 56,8,132
TR 44,6,33888
TR 46,6,34400
MAV 60,12,132
TR 56,6,42304
MAV 60,28,140
buffer_load_dwordx4 v[116:119], v4, s[16:19], s52 offen offset:1024 sc1
MAV 44,28,136
TR 58,6,42816
MAV 44,12,128
TR 60,6,42336
TR 62,6,42848
s_waitcnt lgkmcnt(8)
MAV 64,32,128
TR 0,7,50688
s_add_u32 m0, s55, 92928
MAV 64,48,136
buffer_load_dwordx4 v18, s[28:31], s54 offen lds
MAV 80,48,140
TR 2,7,51200
MAV 80,32,132
TR 4,7,50720
TR 6,7,51232
MAV 84,36,132
TR 16,7,59136
s_add_u32 s52, s77, 196608
MAV 84,52,140
buffer_load_dwordx4 v[120:123], v4, s[16:19], s52 offen sc1
MAV 68,52,136
TR 18,7,59648
MAV 68,36,128
TR 20,7,59168
TR 22,7,59680
s_waitcnt lgkmcnt(8)
MAV 72,40,128
TR 8,7,50752
MAV 72,56,136
buffer_load_dwordx4 v19, s[28:31], s54 offen offset:1056 lds
MAV 88,56,140
TR 10,7,51264
s_add_u32 s54, s100, 2818048
MAV 88,40,132
TR 12,7,50784
TR 14,7,51296
MAV 92,44,132
TR 24,7,59200
MAV 92,60,140
buffer_load_dwordx4 v[124:127], v4, s[16:19], s52 offen offset:1024 sc1
MAV 76,60,136
TR 26,7,59712
MAV 76,44,128
TR 28,7,59232
TR 30,7,59744
s_waitcnt vmcnt(16) lgkmcnt(8)
s_barrier
MAV 32,0,144
TR 32,6,50688
s_add_u32 m0, s55, 101376
MAV 32,16,152
buffer_load_dwordx4 v18, s[28:31], s54 offen lds
MAV 48,16,156
TR 34,6,51200
MAV 48,0,148
TR 36,6,50720
TR 38,6,51232
MAV 52,4,148
TR 48,6,59136
s_add_u32 s52, s78, 245760
MAV 52,20,156
buffer_load_dwordx4 v[128:131], v4, s[16:19], s52 offen sc1
MAV 36,20,152
TR 50,6,59648
MAV 36,4,144
TR 52,6,59168
TR 54,6,59680
s_waitcnt lgkmcnt(8)
MAV 40,8,144
TR 40,6,50752
MAV 40,24,152
buffer_load_dwordx4 v19, s[28:31], s54 offen offset:1056 lds
MAV 56,24,156
TR 42,6,51264
s_add_u32 s54, s100, 3080192
MAV 56,8,148
TR 44,6,50784
TR 46,6,51296
MAV 60,12,148
TR 56,6,59200
MAV 60,28,156
buffer_load_dwordx4 v[132:135], v4, s[16:19], s52 offen offset:1024 sc1
MAV 44,28,152
TR 58,6,59712
MAV 44,12,144
TR 60,6,59232
TR 62,6,59744
v_add_u32 v7, s57, v7
v_add_u32 v6, s57, v6
s_sub_u32 s57, 0, s57
s_waitcnt lgkmcnt(8)
MAV 64,32,144
ds_read_b64_tr_b16 a[0:1], v7
s_add_u32 m0, s55, 109824
MAV 64,48,152
buffer_load_dwordx4 v18, s[28:31], s54 offen lds
MAV 80,48,156
TR 2,7,512
MAV 80,32,148
TR 4,7,32
TR 6,7,544
MAV 84,36,148
TR 16,7,8448
s_add_u32 s52, s78, 311296
MAV 84,52,156
buffer_load_dwordx4 v[136:139], v4, s[16:19], s52 offen sc1
MAV 68,52,152
TR 18,7,8960
MAV 68,36,144
TR 20,7,8480
TR 22,7,8992
s_waitcnt lgkmcnt(8)
MAV 72,40,144
TR 8,7,64
MAV 72,56,152
buffer_load_dwordx4 v19, s[28:31], s54 offen offset:1056 lds
MAV 88,56,156
TR 10,7,576
s_add_u32 s54, s101, 3276800
MAV 88,40,148
TR 12,7,96
TR 14,7,608
MAV 92,44,148
TR 24,7,8512
MAV 92,60,156
buffer_load_dwordx4 v[140:143], v4, s[16:19], s52 offen offset:1024 sc1
MAV 76,60,152
TR 26,7,9024
MAV 76,44,144
TR 28,7,8544
TR 30,7,9056
s_waitcnt vmcnt(16) lgkmcnt(8)
s_barrier
MAV 32,0,96
ds_read_b64_tr_b16 a[32:33], v6
s_add_u32 m0, s55, 118272
MAV 32,16,104
buffer_load_dwordx4 v18, s[28:31], s54 offen lds
MAV 48,16,108
TR 34,6,512
MAV 48,0,100
TR 36,6,32
TR 38,6,544
MAV 52,4,100
TR 48,6,8448
s_add_u32 s52, s79, 360448
MAV 52,20,108
buffer_load_dwordx4 v[144:147], v4, s[16:19], s52 offen sc1
MAV 36,20,104
TR 50,6,8960
MAV 36,4,96
TR 52,6,8480
TR 54,6,8992
s_waitcnt lgkmcnt(8)
MAV 40,8,96
TR 40,6,64
MAV 40,24,104
buffer_load_dwordx4 v19, s[28:31], s54 offen offset:1056 lds
MAV 56,24,108
TR 42,6,576
s_add_u32 s54, s101, 3538944
MAV 56,8,100
TR 44,6,96
TR 46,6,608
MAV 60,12,100
TR 56,6,8512
MAV 60,28,108
buffer_load_dwordx4 v[148:151], v4, s[16:19], s52 offen offset:1024 sc1
MAV 44,28,104
TR 58,6,9024
MAV 44,12,96
TR 60,6,8544
TR 62,6,9056
s_waitcnt lgkmcnt(8)
MAV 64,32,96
TR 0,7,16896
s_add_u32 m0, s55, 126720
MAV 64,48,104
buffer_load_dwordx4 v18, s[28:31], s54 offen lds
MAV 80,48,108
TR 2,7,17408
MAV 80,32,100
TR 4,7,16928
TR 6,7,17440
MAV 84,36,100
TR 16,7,25344
s_add_u32 s52, s79, 425984
MAV 84,52,108
buffer_load_dwordx4 v[152:155], v4, s[16:19], s52 offen sc1
MAV 68,52,104
TR 18,7,25856
MAV 68,36,96
TR 20,7,25376
TR 22,7,25888
s_waitcnt lgkmcnt(8)
MAV 72,40,96
TR 8,7,16960
MAV 72,56,104
buffer_load_dwordx4 v19, s[28:31], s54 offen offset:1056 lds
MAV 88,56,108
TR 10,7,17472
s_add_u32 s54, s98, 131072
MAV 88,40,100
TR 12,7,16992
TR 14,7,17504
MAV 92,44,100
TR 24,7,25408
MAV 92,60,108
buffer_load_dwordx4 v[156:159], v4, s[16:19], s52 offen offset:1024 sc1
MAV 76,60,104
TR 26,7,25920
MAV 76,44,96
TR 28,7,25440
TR 30,7,25952
s_waitcnt vmcnt(16) lgkmcnt(8)
s_barrier
MAV 32,0,112
TR 32,6,16896
s_add_u32 m0, s55, 0
MAV 32,16,120
buffer_load_dwordx4 v18, s[28:31], s54 offen lds
MAV 48,16,124
TR 34,6,17408
MAV 48,0,116
TR 36,6,16928
TR 38,6,17440
MAV 52,4,116
TR 48,6,25344
s_add_u32 s52, s76, 475136
MAV 52,20,124
buffer_load_dwordx4 v[96:99], v4, s[16:19], s52 offen sc1
MAV 36,20,120
TR 50,6,25856
MAV 36,4,112
TR 52,6,25376
TR 54,6,25888
s_waitcnt lgkmcnt(8)
MAV 40,8,112
TR 40,6,16960
MAV 40,24,120
buffer_load_dwordx4 v19, s[28:31], s54 offen offset:1056 lds
MAV 56,24,124
TR 42,6,17472
s_add_u32 s54, s98, 393216
MAV 56,8,116
TR 44,6,16992
TR 46,6,17504
MAV 60,12,116
TR 56,6,25408
MAV 60,28,124
buffer_load_dwordx4 v[100:103], v4, s[16:19], s52 offen offset:1024 sc1
MAV 44,28,120
TR 58,6,25920
MAV 44,12,112
TR 60,6,25440
TR 62,6,25952
s_waitcnt lgkmcnt(8)
MAV 64,32,112
TR 0,7,33792
s_add_u32 m0, s55, 8448
MAV 64,48,120
buffer_load_dwordx4 v18, s[28:31], s54 offen lds
MAV 80,48,124
TR 2,7,34304
MAV 80,32,116
TR 4,7,33824
TR 6,7,34336
MAV 84,36,116
TR 16,7,42240
s_add_u32 s52, s76, 540672
MAV 84,52,124
buffer_load_dwordx4 v[104:107], v4, s[16:19], s52 offen sc1
MAV 68,52,120
TR 18,7,42752
MAV 68,36,112
TR 20,7,42272
TR 22,7,42784
s_waitcnt lgkmcnt(8)
MAV 72,40,112
TR 8,7,33856
MAV 72,56,120
buffer_load_dwordx4 v19, s[28:31], s54 offen offset:1056 lds
MAV 88,56,124
TR 10,7,34368
s_add_u32 s54, s99, 589824
MAV 88,40,116
TR 12,7,33888
TR 14,7,34400
MAV 92,44,116
TR 24,7,42304
MAV 92,60,124
buffer_load_dwordx4 v[108:111], v4, s[16:19], s52 offen offset:1024 sc1
MAV 76,60,120
TR 26,7,42816
MAV 76,44,112
TR 28,7,42336
TR 30,7,42848
s_waitcnt vmcnt(16) lgkmcnt(8)
s_barrier
MAV 32,0,128
TR 32,6,33792
s_add_u32 m0, s55, 16896
MAV 32,16,136
buffer_load_dwordx4 v18, s[28:31], s54 offen lds
MAV 48,16,140
TR 34,6,34304
MAV 48,0,132
TR 36,6,33824
TR 38,6,34336
MAV 52,4,132
TR 48,6,42240
s_add_u32 s52, s77, 589824
MAV 52,20,140
buffer_load_dwordx4 v[112:115], v4, s[16:19], s52 offen sc1
MAV 36,20,136
TR 50,6,42752
MAV 36,4,128
TR 52,6,42272
TR 54,6,42784
s_waitcnt lgkmcnt(8)
MAV 40,8,128
TR 40,6,33856
MAV 40,24,136
buffer_load_dwordx4 v19, s[28:31], s54 offen offset:1056 lds
MAV 56,24,140
TR 42,6,34368
s_add_u32 s54, s99, 851968
MAV 56,8,132
TR 44,6,33888
TR 46,6,34400
MAV 60,12,132
TR 56,6,42304
MAV 60,28,140
buffer_load_dwordx4 v[116:119], v4, s[16:19], s52 offen offset:1024 sc1
MAV 44,28,136
TR 58,6,42816
MAV 44,12,128
TR 60,6,42336
TR 62,6,42848
s_waitcnt lgkmcnt(8)
MAV 64,32,128
TR 0,7,50688
s_add_u32 m0, s55, 25344
MAV 64,48,136
buffer_load_dwordx4 v18, s[28:31], s54 offen lds
MAV 80,48,140
TR 2,7,51200
MAV 80,32,132
TR 4,7,50720
TR 6,7,51232
MAV 84,36,132
TR 16,7,59136
s_add_u32 s52, s77, 655360
MAV 84,52,140
buffer_load_dwordx4 v[120:123], v4, s[16:19], s52 offen sc1
MAV 68,52,136
TR 18,7,59648
MAV 68,36,128
TR 20,7,59168
TR 22,7,59680
.Lpad19:
s_cbranch_execz .Lpad22
s_waitcnt lgkmcnt(8)
MAV 72,40,128
TR 8,7,50752
MAV 72,56,136
buffer_load_dwordx4 v19, s[28:31], s54 offen offset:1056 lds
MAV 88,56,140
TR 10,7,51264
s_add_u32 s54, s100, 1048576
MAV 88,40,132
TR 12,7,50784
TR 14,7,51296
MAV 92,44,132
TR 24,7,59200
MAV 92,60,140
buffer_load_dwordx4 v[124:127], v4, s[16:19], s52 offen offset:1024 sc1
MAV 76,60,136
TR 26,7,59712
MAV 76,44,128
TR 28,7,59232
TR 30,7,59744
s_waitcnt vmcnt(16) lgkmcnt(8)
s_barrier
MAV 32,0,144
TR 32,6,50688
s_add_u32 m0, s55, 33792
MAV 32,16,152
buffer_load_dwordx4 v18, s[28:31], s54 offen lds
MAV 48,16,156
TR 34,6,51200
MAV 48,0,148
TR 36,6,50720
TR 38,6,51232
MAV 52,4,148
TR 48,6,59136
s_add_u32 s52, s78, 704512
MAV 52,20,156
buffer_load_dwordx4 v[128:131], v4, s[16:19], s52 offen sc1
MAV 36,20,152
TR 50,6,59648
MAV 36,4,144
TR 52,6,59168
TR 54,6,59680
s_waitcnt lgkmcnt(8)
MAV 40,8,144
TR 40,6,50752
MAV 40,24,152
buffer_load_dwordx4 v19, s[28:31], s54 offen offset:1056 lds
MAV 56,24,156
TR 42,6,51264
s_add_u32 s54, s100, 1310720
MAV 56,8,148
TR 44,6,50784
TR 46,6,51296
MAV 60,12,148
TR 56,6,59200
MAV 60,28,156
buffer_load_dwordx4 v[132:135], v4, s[16:19], s52 offen offset:1024 sc1
MAV 44,28,152
TR 58,6,59712
MAV 44,12,144
TR 60,6,59232
TR 62,6,59744
v_add_u32 v7, s57, v7
v_add_u32 v6, s57, v6
s_sub_u32 s57, 0, s57
s_waitcnt lgkmcnt(8)
MAV 64,32,144
ds_read_b64_tr_b16 a[0:1], v7
s_add_u32 m0, s55, 42240
MAV 64,48,152
buffer_load_dwordx4 v18, s[28:31], s54 offen lds
MAV 80,48,156
TR 2,7,512
MAV 80,32,148
TR 4,7,32
TR 6,7,544
MAV 84,36,148
TR 16,7,8448
s_add_u32 s52, s78, 770048
MAV 84,52,156
buffer_load_dwordx4 v[136:139], v4, s[16:19], s52 offen sc1
MAV 68,52,152
TR 18,7,8960
MAV 68,36,144
TR 20,7,8480
TR 22,7,8992
s_waitcnt lgkmcnt(8)
MAV 72,40,144
TR 8,7,64
MAV 72,56,152
buffer_load_dwordx4 v19, s[28:31], s54 offen offset:1056 lds
MAV 88,56,156
TR 10,7,576
s_add_u32 s54, s101, 1507328
MAV 88,40,148
TR 12,7,96
TR 14,7,608
MAV 92,44,148
TR 24,7,8512
MAV 92,60,156
buffer_load_dwordx4 v[140:143], v4, s[16:19], s52 offen offset:1024 sc1
MAV 76,60,152
TR 26,7,9024
MAV 76,44,144
TR 28,7,8544
TR 30,7,9056
s_waitcnt vmcnt(16) lgkmcnt(8)
s_barrier
MAV 32,0,96
ds_read_b64_tr_b16 a[32:33], v6
s_add_u32 m0, s55, 50688
MAV 32,16,104
buffer_load_dwordx4 v18, s[28:31], s54 offen lds
MAV 48,16,108
TR 34,6,512
MAV 48,0,100
TR 36,6,32
TR 38,6,544
MAV 52,4,100
TR 48,6,8448
s_add_u32 s52, s79, 819200
MAV 52,20,108
buffer_load_dwordx4 v[144:147], v4, s[16:19], s52 offen sc1
MAV 36,20,104
TR 50,6,8960
MAV 36,4,96
TR 52,6,8480
TR 54,6,8992
s_waitcnt lgkmcnt(8)
MAV 40,8,96
TR 40,6,64
MAV 40,24,104
buffer_load_dwordx4 v19, s[28:31], s54 offen offset:1056 lds
MAV 56,24,108
TR 42,6,576
s_add_u32 s54, s101, 1769472
MAV 56,8,100
TR 44,6,96
TR 46,6,608
MAV 60,12,100
TR 56,6,8512
MAV 60,28,108
buffer_load_dwordx4 v[148:151], v4, s[16:19], s52 offen offset:1024 sc1
MAV 44,28,104
TR 58,6,9024
MAV 44,12,96
TR 60,6,8544
TR 62,6,9056
s_waitcnt lgkmcnt(8)
MAV 64,32,96
TR 0,7,16896
s_add_u32 m0, s55, 59136
MAV 64,48,104
buffer_load_dwordx4 v18, s[28:31], s54 offen lds
MAV 80,48,108
TR 2,7,17408
MAV 80,32,100
TR 4,7,16928
TR 6,7,17440
MAV 84,36,100
TR 16,7,25344
s_add_u32 s52, s79, 884736
MAV 84,52,108
buffer_load_dwordx4 v[152:155], v4, s[16:19], s52 offen sc1
MAV 68,52,104
TR 18,7,25856
MAV 68,36,96
TR 20,7,25376
TR 22,7,25888
s_waitcnt lgkmcnt(8)
MAV 72,40,96
TR 8,7,16960
MAV 72,56,104
buffer_load_dwordx4 v19, s[28:31], s54 offen offset:1056 lds
MAV 88,56,108
TR 10,7,17472
s_add_u32 s54, s98, 1966080
MAV 88,40,100
TR 12,7,16992
TR 14,7,17504
MAV 92,44,100
TR 24,7,25408
MAV 92,60,108
buffer_load_dwordx4 v[156:159], v4, s[16:19], s52 offen offset:1024 sc1
MAV 76,60,104
TR 26,7,25920
MAV 76,44,96
TR 28,7,25440
TR 30,7,25952
s_waitcnt vmcnt(16) lgkmcnt(8)
s_barrier
MAV 32,0,112
TR 32,6,16896
s_add_u32 m0, s55, 67584
MAV 32,16,120
buffer_load_dwordx4 v18, s[28:31], s54 offen lds
MAV 48,16,124
TR 34,6,17408
MAV 48,0,116
TR 36,6,16928
TR 38,6,17440
MAV 52,4,116
TR 48,6,25344
s_add_u32 s52, s76, 32768
MAV 52,20,124
buffer_load_dwordx4 v[96:99], v4, s[16:19], s52 offen sc1
MAV 36,20,120
TR 50,6,25856
MAV 36,4,112
TR 52,6,25376
TR 54,6,25888
s_waitcnt lgkmcnt(8)
MAV 40,8,112
TR 40,6,16960
MAV 40,24,120
buffer_load_dwordx4 v19, s[28:31], s54 offen offset:1056 lds
MAV 56,24,124
TR 42,6,17472
s_add_u32 s54, s98, 2228224
MAV 56,8,116
TR 44,6,16992
TR 46,6,17504
MAV 60,12,116
TR 56,6,25408
MAV 60,28,124
buffer_load_dwordx4 v[100:103], v4, s[16:19], s52 offen offset:1024 sc1
MAV 44,28,120
TR 58,6,25920
MAV 44,12,112
TR 60,6,25440
TR 62,6,25952
s_waitcnt lgkmcnt(8)
MAV 64,32,112
TR 0,7,33792
s_add_u32 m0, s55, 76032
MAV 64,48,120
buffer_load_dwordx4 v18, s[28:31], s54 offen lds
MAV 80,48,124
TR 2,7,34304
MAV 80,32,116
TR 4,7,33824
TR 6,7,34336
MAV 84,36,116
TR 16,7,42240
s_add_u32 s52, s76, 98304
MAV 84,52,124
buffer_load_dwordx4 v[104:107], v4, s[16:19], s52 offen sc1
MAV 68,52,120
TR 18,7,42752
MAV 68,36,112
TR 20,7,42272
TR 22,7,42784
s_waitcnt lgkmcnt(8)
MAV 72,40,112
TR 8,7,33856
MAV 72,56,120
buffer_load_dwordx4 v19, s[28:31], s54 offen offset:1056 lds
MAV 88,56,124
TR 10,7,34368
s_add_u32 s54, s99, 2424832
MAV 88,40,116
TR 12,7,33888
TR 14,7,34400
MAV 92,44,116
TR 24,7,42304
MAV 92,60,124
buffer_load_dwordx4 v[108:111], v4, s[16:19], s52 offen offset:1024 sc1
MAV 76,60,120
TR 26,7,42816
MAV 76,44,112
TR 28,7,42336
TR 30,7,42848
s_waitcnt vmcnt(16) lgkmcnt(8)
s_barrier
MAV 32,0,128
TR 32,6,33792
s_add_u32 m0, s55, 84480
MAV 32,16,136
buffer_load_dwordx4 v18, s[28:31], s54 offen lds
MAV 48,16,140
TR 34,6,34304
MAV 48,0,132
TR 36,6,33824
TR 38,6,34336
MAV 52,4,132
TR 48,6,42240
s_add_u32 s52, s77, 147456
MAV 52,20,140
buffer_load_dwordx4 v[112:115], v4, s[16:19], s52 offen sc1
MAV 36,20,136
TR 50,6,42752
MAV 36,4,128
TR 52,6,42272
TR 54,6,42784
s_waitcnt lgkmcnt(8)
MAV 40,8,128
TR 40,6,33856
MAV 40,24,136
buffer_load_dwordx4 v19, s[28:31], s54 offen offset:1056 lds
MAV 56,24,140
TR 42,6,34368
s_add_u32 s54, s99, 2686976
MAV 56,8,132
TR 44,6,33888
TR 46,6,34400
MAV 60,12,132
TR 56,6,42304
MAV 60,28,140
buffer_load_dwordx4 v[116:119], v4, s[16:19], s52 offen offset:1024 sc1
MAV 44,28,136
TR 58,6,42816
MAV 44,12,128
TR 60,6,42336
TR 62,6,42848
s_waitcnt lgkmcnt(8)
MAV 64,32,128
TR 0,7,50688
s_add_u32 m0, s55, 92928
MAV 64,48,136
buffer_load_dwordx4 v18, s[28:31], s54 offen lds
MAV 80,48,140
TR 2,7,51200
MAV 80,32,132
TR 4,7,50720
TR 6,7,51232
MAV 84,36,132
TR 16,7,59136
s_add_u32 s52, s77, 212992
MAV 84,52,140
buffer_load_dwordx4 v[120:123], v4, s[16:19], s52 offen sc1
MAV 68,52,136
TR 18,7,59648
MAV 68,36,128
TR 20,7,59168
TR 22,7,59680
s_waitcnt lgkmcnt(8)
MAV 72,40,128
TR 8,7,50752
MAV 72,56,136
buffer_load_dwordx4 v19, s[28:31], s54 offen offset:1056 lds
MAV 88,56,140
TR 10,7,51264
s_add_u32 s54, s100, 2883584
MAV 88,40,132
TR 12,7,50784
TR 14,7,51296
MAV 92,44,132
TR 24,7,59200
MAV 92,60,140
buffer_load_dwordx4 v[124:127], v4, s[16:19], s52 offen offset:1024 sc1
MAV 76,60,136
TR 26,7,59712
MAV 76,44,128
TR 28,7,59232
TR 30,7,59744
s_waitcnt vmcnt(16) lgkmcnt(8)
s_barrier
MAV 32,0,144
TR 32,6,50688
s_add_u32 m0, s55, 101376
MAV 32,16,152
buffer_load_dwordx4 v18, s[28:31], s54 offen lds
MAV 48,16,156
TR 34,6,51200
MAV 48,0,148
TR 36,6,50720
TR 38,6,51232
MAV 52,4,148
TR 48,6,59136
s_add_u32 s52, s78, 262144
MAV 52,20,156
buffer_load_dwordx4 v[128:131], v4, s[16:19], s52 offen sc1
MAV 36,20,152
TR 50,6,59648
MAV 36,4,144
TR 52,6,59168
TR 54,6,59680
s_waitcnt lgkmcnt(8)
MAV 40,8,144
TR 40,6,50752
MAV 40,24,152
buffer_load_dwordx4 v19, s[28:31], s54 offen offset:1056 lds
MAV 56,24,156
TR 42,6,51264
s_add_u32 s54, s100, 3145728
MAV 56,8,148
TR 44,6,50784
TR 46,6,51296
MAV 60,12,148
TR 56,6,59200
MAV 60,28,156
buffer_load_dwordx4 v[132:135], v4, s[16:19], s52 offen offset:1024 sc1
MAV 44,28,152
TR 58,6,59712
MAV 44,12,144
TR 60,6,59232
TR 62,6,59744
v_add_u32 v7, s57, v7
v_add_u32 v6, s57, v6
s_sub_u32 s57, 0, s57
s_waitcnt lgkmcnt(8)
MAV 64,32,144
ds_read_b64_tr_b16 a[0:1], v7
s_add_u32 m0, s55, 109824
MAV 64,48,152
buffer_load_dwordx4 v18, s[28:31], s54 offen lds
MAV 80,48,156
TR 2,7,512
MAV 80,32,148
TR 4,7,32
TR 6,7,544
MAV 84,36,148
TR 16,7,8448
s_add_u32 s52, s78, 327680
MAV 84,52,156
buffer_load_dwordx4 v[136:139], v4, s[16:19], s52 offen sc1
MAV 68,52,152
TR 18,7,8960
MAV 68,36,144
TR 20,7,8480
TR 22,7,8992
s_waitcnt lgkmcnt(8)
MAV 72,40,144
TR 8,7,64
MAV 72,56,152
buffer_load_dwordx4 v19, s[28:31], s54 offen offset:1056 lds
MAV 88,56,156
TR 10,7,576
s_add_u32 s54, s101, 3342336
MAV 88,40,148
TR 12,7,96
TR 14,7,608
MAV 92,44,148
TR 24,7,8512
MAV 92,60,156
buffer_load_dwordx4 v[140:143], v4, s[16:19], s52 offen offset:1024 sc1
MAV 76,60,152
TR 26,7,9024
MAV 76,44,144
TR 28,7,8544
TR 30,7,9056
s_waitcnt vmcnt(16) lgkmcnt(8)
s_barrier
MAV 32,0,96
ds_read_b64_tr_b16 a[32:33], v6
s_add_u32 m0, s55, 118272
MAV 32,16,104
buffer_load_dwordx4 v18, s[28:31], s54 offen lds
MAV 48,16,108
TR 34,6,512
MAV 48,0,100
TR 36,6,32
TR 38,6,544
MAV 52,4,100
TR 48,6,8448
s_add_u32 s52, s79, 376832
MAV 52,20,108
buffer_load_dwordx4 v[144:147], v4, s[16:19], s52 offen sc1
MAV 36,20,104
TR 50,6,8960
MAV 36,4,96
TR 52,6,8480
TR 54,6,8992
s_waitcnt lgkmcnt(8)
MAV 40,8,96
TR 40,6,64
MAV 40,24,104
buffer_load_dwordx4 v19, s[28:31], s54 offen offset:1056 lds
MAV 56,24,108
TR 42,6,576
s_add_u32 s54, s101, 3604480
MAV 56,8,100
TR 44,6,96
TR 46,6,608
MAV 60,12,100
TR 56,6,8512
MAV 60,28,108
buffer_load_dwordx4 v[148:151], v4, s[16:19], s52 offen offset:1024 sc1
MAV 44,28,104
TR 58,6,9024
MAV 44,12,96
TR 60,6,8544
TR 62,6,9056
s_waitcnt lgkmcnt(8)
MAV 64,32,96
TR 0,7,16896
s_add_u32 m0, s55, 126720
MAV 64,48,104
buffer_load_dwordx4 v18, s[28:31], s54 offen lds
MAV 80,48,108
TR 2,7,17408
MAV 80,32,100
TR 4,7,16928
TR 6,7,17440
MAV 84,36,100
TR 16,7,25344
s_add_u32 s52, s79, 442368
MAV 84,52,108
buffer_load_dwordx4 v[152:155], v4, s[16:19], s52 offen sc1
MAV 68,52,104
TR 18,7,25856
MAV 68,36,96
TR 20,7,25376
TR 22,7,25888
s_waitcnt lgkmcnt(8)
MAV 72,40,96
TR 8,7,16960
MAV 72,56,104
buffer_load_dwordx4 v19, s[28:31], s54 offen offset:1056 lds
MAV 88,56,108
TR 10,7,17472
s_add_u32 s54, s98, 196608
MAV 88,40,100
TR 12,7,16992
TR 14,7,17504
MAV 92,44,100
TR 24,7,25408
MAV 92,60,108
buffer_load_dwordx4 v[156:159], v4, s[16:19], s52 offen offset:1024 sc1
MAV 76,60,104
TR 26,7,25920
MAV 76,44,96
TR 28,7,25440
TR 30,7,25952
s_waitcnt vmcnt(16) lgkmcnt(8)
s_barrier
MAV 32,0,112
TR 32,6,16896
s_add_u32 m0, s55, 0
MAV 32,16,120
buffer_load_dwordx4 v18, s[28:31], s54 offen lds
MAV 48,16,124
.Lpad20:
s_cbranch_execz .Lnopoll37r
TR 34,6,17408
MAV 48,0,116
TR 36,6,16928
TR 38,6,17440
MAV 52,4,116
TR 48,6,25344
s_add_u32 s52, s76, 491520
MAV 52,20,124
buffer_load_dwordx4 v[96:99], v4, s[16:19], s52 offen sc1
MAV 36,20,120
TR 50,6,25856
MAV 36,4,112
TR 52,6,25376
TR 54,6,25888
s_waitcnt lgkmcnt(8)
MAV 40,8,112
TR 40,6,16960
MAV 40,24,120
buffer_load_dwordx4 v19, s[28:31], s54 offen offset:1056 lds
MAV 56,24,124
TR 42,6,17472
s_add_u32 s54, s99, 655360
MAV 56,8,116
TR 44,6,16992
TR 46,6,17504
MAV 60,12,116
TR 56,6,25408
MAV 60,28,124
buffer_load_dwordx4 v[100:103], v4, s[16:19], s52 offen offset:1024 sc1
MAV 44,28,120
TR 58,6,25920
MAV 44,12,112
TR 60,6,25440
TR 62,6,25952
s_waitcnt lgkmcnt(8)
MAV 64,32,112
TR 0,7,33792
s_add_u32 m0, s55, 8448
MAV 64,48,120
buffer_load_dwordx4 v18, s[28:31], s54 offen lds
MAV 80,48,124
TR 2,7,34304
MAV 80,32,116
TR 4,7,33824
TR 6,7,34336
MAV 84,36,116
TR 16,7,42240
s_add_u32 s52, s76, 557056
MAV 84,52,124
buffer_load_dwordx4 v[104:107], v4, s[16:19], s52 offen sc1
MAV 68,52,120
TR 18,7,42752
MAV 68,36,112
TR 20,7,42272
TR 22,7,42784
s_waitcnt lgkmcnt(8)
MAV 72,40,112
TR 8,7,33856
MAV 72,56,120
buffer_load_dwordx4 v19, s[28:31], s54 offen offset:1056 lds
MAV 88,56,124
TR 10,7,34368
s_add_u32 s54, s100, 1114112
MAV 88,40,116
TR 12,7,33888
TR 14,7,34400
MAV 92,44,116
TR 24,7,42304
MAV 92,60,124
buffer_load_dwordx4 v[108:111], v4, s[16:19], s52 offen offset:1024 sc1
MAV 76,60,120
TR 26,7,42816
MAV 76,44,112
TR 28,7,42336
TR 30,7,42848
s_waitcnt vmcnt(16) lgkmcnt(8)
s_barrier
MAV 32,0,128
TR 32,6,33792
s_add_u32 m0, s55, 16896
MAV 32,16,136
buffer_load_dwordx4 v18, s[28:31], s54 offen lds
MAV 48,16,140
TR 34,6,34304
MAV 48,0,132
TR 36,6,33824
TR 38,6,34336
MAV 52,4,132
TR 48,6,42240
s_add_u32 s52, s77, 606208
MAV 52,20,140
buffer_load_dwordx4 v[112:115], v4, s[16:19], s52 offen sc1
MAV 36,20,136
TR 50,6,42752
MAV 36,4,128
TR 52,6,42272
TR 54,6,42784
s_waitcnt lgkmcnt(8)
MAV 40,8,128
TR 40,6,33856
MAV 40,24,136
buffer_load_dwordx4 v19, s[28:31], s54 offen offset:1056 lds
MAV 56,24,140
TR 42,6,34368
s_add_u32 s54, s101, 1572864
MAV 56,8,132
TR 44,6,33888
TR 46,6,34400
MAV 60,12,132
TR 56,6,42304
MAV 60,28,140
buffer_load_dwordx4 v[116:119], v4, s[16:19], s52 offen offset:1024 sc1
MAV 44,28,136
TR 58,6,42816
MAV 44,12,128
TR 60,6,42336
TR 62,6,42848
s_waitcnt lgkmcnt(8)
MAV 64,32,128
TR 0,7,50688
s_add_u32 m0, s55, 25344
MAV 64,48,136
buffer_load_dwordx4 v18, s[28:31], s54 offen lds
MAV 80,48,140
TR 2,7,51200
MAV 80,32,132
TR 4,7,50720
TR 6,7,51232
MAV 84,36,132
TR 16,7,59136
s_add_u32 s52, s77, 671744
MAV 84,52,140
buffer_load_dwordx4 v[120:123], v4, s[16:19], s52 offen sc1
MAV 68,52,136
TR 18,7,59648
MAV 68,36,128
TR 20,7,59168
TR 22,7,59680
s_waitcnt lgkmcnt(8)
MAV 72,40,128
TR 8,7,50752
MAV 72,56,136
buffer_load_dwordx4 v19, s[28:31], s54 offen offset:1056 lds
MAV 88,56,140
TR 10,7,51264
s_add_u32 s54, s98, 2031616
MAV 88,40,132
TR 12,7,50784
TR 14,7,51296
MAV 92,44,132
TR 24,7,59200
MAV 92,60,140
buffer_load_dwordx4 v[124:127], v4, s[16:19], s52 offen offset:1024 sc1
MAV 76,60,136
TR 26,7,59712
MAV 76,44,128
TR 28,7,59232
TR 30,7,59744
s_waitcnt vmcnt(16) lgkmcnt(8)
s_barrier
MAV 32,0,144
TR 32,6,50688
s_add_u32 m0, s55, 33792
MAV 32,16,152
buffer_load_dwordx4 v18, s[28:31], s54 offen lds
MAV 48,16,156
TR 34,6,51200
MAV 48,0,148
TR 36,6,50720
TR 38,6,51232
MAV 52,4,148
TR 48,6,59136
s_add_u32 s52, s78, 720896
MAV 52,20,156
buffer_load_dwordx4 v[128:131], v4, s[16:19], s52 offen sc1
MAV 36,20,152
TR 50,6,59648
MAV 36,4,144
TR 52,6,59168
TR 54,6,59680
s_waitcnt lgkmcnt(8)
MAV 40,8,144
TR 40,6,50752
MAV 40,24,152
buffer_load_dwordx4 v19, s[28:31], s54 offen offset:1056 lds
MAV 56,24,156
TR 42,6,51264
s_add_u32 s54, s99, 2490368
MAV 56,8,148
TR 44,6,50784
TR 46,6,51296
MAV 60,12,148
TR 56,6,59200
MAV 60,28,156
buffer_load_dwordx4 v[132:135], v4, s[16:19], s52 offen offset:1024 sc1
MAV 44,28,152
TR 58,6,59712
MAV 44,12,144
TR 60,6,59232
TR 62,6,59744
v_add_u32 v7, s57, v7
v_add_u32 v6, s57, v6
s_sub_u32 s57, 0, s57
s_waitcnt lgkmcnt(8)
MAV 64,32,144
ds_read_b64_tr_b16 a[0:1], v6
s_add_u32 m0, s55, 42240
MAV 64,48,152
buffer_load_dwordx4 v18, s[28:31], s54 offen lds
MAV 80,48,156
TR 2,6,512
MAV 80,32,148
TR 4,6,32
TR 6,6,544
MAV 84,36,148
TR 16,6,8448
s_add_u32 s52, s78, 786432
MAV 84,52,156
buffer_load_dwordx4 v[136:139], v4, s[16:19], s52 offen sc1
MAV 68,52,152
TR 18,6,8960
MAV 68,36,144
TR 20,6,8480
TR 22,6,8992
s_waitcnt lgkmcnt(8)
MAV 72,40,144
TR 8,6,64
MAV 72,56,152
buffer_load_dwordx4 v19, s[28:31], s54 offen offset:1056 lds
MAV 88,56,156
TR 10,6,576
s_add_u32 s54, s100, 2949120
MAV 88,40,148
TR 12,6,96
TR 14,6,608
MAV 92,44,148
TR 24,6,8512
MAV 92,60,156
buffer_load_dwordx4 v[140:143], v4, s[16:19], s52 offen offset:1024 sc1
MAV 76,60,152
TR 26,6,9024
MAV 76,44,144
TR 28,6,8544
TR 30,6,9056
s_waitcnt vmcnt(16) lgkmcnt(8)
s_barrier
MAV 64,0,96
TR 32,6,16896
TR 34,6,17408
s_add_u32 m0, s55, 50688
MAV 64,16,104
TR 36,6,16928
buffer_load_dwordx4 v18, s[28:31], s54 offen lds
MAV 80,16,108
TR 38,6,17440
MAV 80,0,100
TR 48,6,25344
buffer_load_dwordx4 v19, s[28:31], s54 offen offset:1056 lds
MAV 84,4,100
TR 50,6,25856
s_add_u32 s54, s101, 3407872
s_add_u32 s52, s79, 835584
MAV 84,20,108
buffer_load_dwordx4 v[144:147], v4, s[16:19], s52 offen sc1
MAV 68,20,104
TR 52,6,25376
TR 54,6,25888
MAV 68,4,96
TR 40,6,16960
s_waitcnt lgkmcnt(9)
MAV 72,8,96
TR 42,6,17472
MAV 72,24,104
TR 44,6,16992
buffer_load_dwordx4 v[148:151], v4, s[16:19], s52 offen offset:1024 sc1
MAV 88,24,108
TR 46,6,17504
s_add_u32 m0, s55, 59136
MAV 88,8,100
TR 56,6,25408
buffer_load_dwordx4 v18, s[28:31], s54 offen lds
MAV 92,12,100
TR 58,6,25920
MAV 92,28,108
TR 60,6,25440
buffer_load_dwordx4 v19, s[28:31], s54 offen offset:1056 lds
MAV 76,28,104
TR 62,6,25952
s_add_u32 s52, s79, 901120
MAV 76,12,96
buffer_load_dwordx4 v[152:155], v4, s[16:19], s52 offen sc1
buffer_load_dwordx4 v[156:159], v4, s[16:19], s52 offen offset:1024 sc1
s_waitcnt vmcnt(16) lgkmcnt(8)
MAV 64,32,112
TR 0,6,33792
s_add_u32 s52, s76, 49152
s_lshl_b32 s70, s2, 10
MAV 64,48,120
buffer_load_dwordx4 v[160:163], v4, s[16:19], s52 offen sc1
s_lshl_b32 s62, s3, 7
MAV 80,48,124
TR 2,6,34304
s_add_u32 s70, s70, s62
s_add_u32 s70, s70, 31457280
MAV 80,32,116
TR 4,6,33824
TR 6,6,34336
MAV 84,36,116
TR 16,6,42240
s_xor_b32 s71, s70, 1024
v_min_u32 v26, 1, v1
MAV 84,52,124
buffer_load_dwordx4 v[164:167], v4, s[16:19], s52 offen offset:1024 sc1
v_lshlrev_b32 v26, 28, v26
MAV 68,52,120
TR 18,6,42752
v_mov_b32 v30, 1
MAV 68,36,112
TR 20,6,42272
TR 22,6,42784
s_waitcnt lgkmcnt(8)
MAV 72,40,112
TR 8,6,33856
s_add_u32 s52, s77, 163840
v_mov_b32 v31, 0
MAV 72,56,120
buffer_load_dwordx4 v[168:171], v4, s[16:19], s52 offen sc1
s_lshl_b32 s68, s7, 18
MAV 88,56,124
TR 10,6,34368
s_add_u32 s68, s68, 33554432
s_xor_b32 s69, s68, 262144
MAV 88,40,116
TR 12,6,33888
TR 14,6,34400
MAV 92,44,116
TR 24,6,42304
v_and_b32 v2, 1, v1
v_lshlrev_b32 v2, 4, v2
MAV 92,60,124
buffer_load_dwordx4 v[172:175], v4, s[16:19], s52 offen offset:1024 sc1
v_mov_b32 v224, 0x3f80
MAV 76,60,120
TR 26,6,42816
v_lshlrev_b32 v2, v2, v224
MAV 76,44,112
TR 28,6,42336
TR 30,6,42848
s_waitcnt vmcnt(12) lgkmcnt(8)
MAV 64,0,128
TR 32,6,50688
s_add_u32 s52, s78, 278528
v_bfe_u32 v224, v1, 2, 2
MAV 64,16,136
buffer_load_dwordx4 v[176:179], v4, s[16:19], s52 offen sc1
v_lshrrev_b32 v225, 4, v1
MAV 80,16,140
TR 34,6,51200
v_cmp_eq_u32 vcc, v224, v225
s_nop 1
v_cndmask_b32 v2, 0, v2, vcc
MAV 80,0,132
TR 36,6,50720
TR 38,6,51232
MAV 84,4,132
TR 48,6,59136
v_and_b32 v224, 2, v1
v_cmp_eq_u32 vcc, 0, v224
MAV 84,20,140
buffer_load_dwordx4 v[180:183], v4, s[16:19], s52 offen offset:1024 sc1
v_cndmask_b32 v226, 0, v2, vcc
MAV 68,20,136
TR 50,6,59648
v_cndmask_b32 v227, v2, 0, vcc
MAV 68,4,128
TR 52,6,59168
TR 54,6,59680
s_waitcnt lgkmcnt(8)
MAV 72,8,128
TR 40,6,50752
s_add_u32 s52, s79, 393216
v_mov_b32 v224, 0
MAV 72,24,136
buffer_load_dwordx4 v[184:187], v4, s[16:19], s52 offen sc1
v_mov_b32 v225, 0
MAV 88,24,140
TR 42,6,51264
v_mov_b32 v228, 0
v_mov_b32 v229, 0
MAV 88,8,132
TR 44,6,50784
TR 46,6,51296
MAV 92,12,132
TR 56,6,59200
v_bfe_u32 v18, v1, 3, 1
v_lshrrev_b32 v2, 4, v1
MAV 92,28,140
buffer_load_dwordx4 v[188:191], v4, s[16:19], s52 offen offset:1024 sc1
v_lshl_add_u32 v18, v2, 3, v18
MAV 76,28,136
TR 58,6,59712
s_lshl_b32 s62, s3, 1
MAV 76,12,128
TR 60,6,59232
TR 62,6,59744
s_waitcnt vmcnt(8) lgkmcnt(8)
s_barrier
v_add_u32 v6, s57, v6
MAV 64,32,144
ds_read_b64_tr_b16 a[0:1], v6
s_add_u32 s52, s76, 507904
v_add_u32 v18, s62, v18
MAV 64,48,152
buffer_load_dwordx4 v[192:195], v4, s[16:19], s52 offen sc1
v_mul_u32_u24 v18, 6144, v18
MAV 80,48,156
TR 2,6,512
v_and_b32 v2, 7, v1
v_lshl_add_u32 v18, v2, 4, v18
MAV 80,32,148
TR 4,6,32
TR 6,6,544
MAV 84,36,148
TR 16,6,8448
s_lshl_b32 s62, s9, 7
v_add_u32 v18, s62, v18
MAV 84,52,156
buffer_load_dwordx4 v[196:199], v4, s[16:19], s52 offen offset:1024 sc1
v_add_u32 v19, 1024, v18
MAV 68,52,152
TR 18,6,8960
v_add_u32 v20, 2048, v18
MAV 68,36,144
TR 20,6,8480
TR 22,6,8992
s_waitcnt lgkmcnt(8)
MAV 72,40,144
TR 8,6,64
s_add_u32 s52, s77, 622592
s_mul_i32 s59, s3, 3104
MAV 72,56,152
buffer_load_dwordx4 v[200:203], v4, s[16:19], s52 offen sc1
s_mov_b32 s58, 0
MAV 88,56,156
TR 10,6,576
v_accvgpr_read_b32 v28, a224
v_add_f32 v32, v32, v28
MAV 88,40,148
TR 12,6,96
TR 14,6,608
MAV 92,44,148
TR 24,6,8512
v_accvgpr_read_b32 v29, a225
v_add_f32 v33, v33, v29
MAV 92,60,156
buffer_load_dwordx4 v[204:207], v4, s[16:19], s52 offen offset:1024 sc1
v_accvgpr_read_b32 v28, a226
MAV 76,60,152
TR 26,6,9024
v_add_f32 v34, v34, v28
MAV 76,44,144
TR 28,6,8544
TR 30,6,9056
s_waitcnt vmcnt(8) lgkmcnt(8)
MAV 64,0,160
TR 32,6,16896
s_add_u32 s52, s78, 737280
v_accvgpr_read_b32 v29, a227
MAV 64,16,168
buffer_load_dwordx4 v[208:211], v4, s[16:19], s52 offen sc1
v_add_f32 v35, v35, v29
MAV 80,16,172
TR 34,6,17408
v_accvgpr_read_b32 v28, a228
v_add_f32 v36, v36, v28
MAV 80,0,164
TR 36,6,16928
TR 38,6,17440
MAV 84,4,164
TR 48,6,25344
v_accvgpr_read_b32 v29, a229
v_add_f32 v37, v37, v29
MAV 84,20,172
buffer_load_dwordx4 v[212:215], v4, s[16:19], s52 offen offset:1024 sc1
v_accvgpr_read_b32 v28, a230
MAV 68,20,168
TR 50,6,25856
v_add_f32 v38, v38, v28
MAV 68,4,160
TR 52,6,25376
TR 54,6,25888
s_waitcnt lgkmcnt(8)
MAV 72,8,160
TR 40,6,16960
s_add_u32 s52, s79, 851968
v_accvgpr_read_b32 v29, a231
MAV 72,24,168
buffer_load_dwordx4 v[216:219], v4, s[16:19], s52 offen sc1
v_add_f32 v39, v39, v29
MAV 88,24,172
TR 42,6,17472
v_accvgpr_read_b32 v28, a232
v_add_f32 v40, v40, v28
MAV 88,8,164
TR 44,6,16992
TR 46,6,17504
MAV 92,12,164
TR 56,6,25408
v_accvgpr_read_b32 v29, a233
v_add_f32 v41, v41, v29
MAV 92,28,172
buffer_load_dwordx4 v[220:223], v4, s[16:19], s52 offen offset:1024 sc1
v_accvgpr_read_b32 v28, a234
MAV 76,28,168
TR 58,6,25920
v_add_f32 v42, v42, v28
MAV 76,12,160
TR 60,6,25440
TR 62,6,25952
s_waitcnt vmcnt(8) lgkmcnt(8)
MAV 64,32,176
TR 0,6,33792
v_accvgpr_read_b32 v29, a235
MAV 64,48,184
TR 2,6,34304
v_add_f32 v43, v43, v29
v_accvgpr_read_b32 v28, a236
MAV 80,48,188
TR 4,6,33824
MAV 80,32,180
TR 6,6,34336
v_add_f32 v44, v44, v28
v_accvgpr_read_b32 v29, a237
MAV 84,36,180
TR 16,6,42240
MAV 84,52,188
TR 18,6,42752
v_add_f32 v45, v45, v29
v_accvgpr_read_b32 v28, a238
MAV 68,52,184
TR 20,6,42272
MAV 68,36,176
TR 22,6,42784
v_add_f32 v46, v46, v28
s_waitcnt lgkmcnt(8)
MAV 72,40,176
TR 8,6,33856
v_accvgpr_read_b32 v29, a239
MAV 72,56,184
.Lpad21:
s_cbranch_execz .Lnopoll37r
TR 10,6,34368
v_add_f32 v47, v47, v29
MAV 88,56,188
TR 12,6,33888
v_accvgpr_read_b32 v28, a240
MAV 88,40,180
TR 14,6,34400
v_add_f32 v48, v48, v28
MAV 92,44,180
TR 24,6,42304
v_accvgpr_read_b32 v29, a241
MAV 92,60,188
TR 26,6,42816
v_add_f32 v49, v49, v29
MAV 76,60,184
TR 28,6,42336
v_accvgpr_read_b32 v28, a242
MAV 76,44,176
TR 30,6,42848
v_add_f32 v50, v50, v28
s_waitcnt vmcnt(4) lgkmcnt(8)
MAV 64,0,192
TR 32,6,50688
v_accvgpr_read_b32 v29, a243
MAV 64,16,200
TR 34,6,51200
v_add_f32 v51, v51, v29
v_accvgpr_read_b32 v28, a244
MAV 80,16,204
TR 36,6,50720
MAV 80,0,196
TR 38,6,51232
v_add_f32 v52, v52, v28
v_accvgpr_read_b32 v29, a245
MAV 84,4,196
TR 48,6,59136
MAV 84,20,204
TR 50,6,59648
v_add_f32 v53, v53, v29
v_accvgpr_read_b32 v28, a246
MAV 68,20,200
TR 52,6,59168
MAV 68,4,192
TR 54,6,59680
v_add_f32 v54, v54, v28
s_waitcnt lgkmcnt(8)
MAV 72,8,192
TR 40,6,50752
v_accvgpr_read_b32 v29, a247
MAV 72,24,200
TR 42,6,51264
v_add_f32 v55, v55, v29
MAV 88,24,204
TR 44,6,50784
v_accvgpr_read_b32 v28, a248
MAV 88,8,196
TR 46,6,51296
v_add_f32 v56, v56, v28
MAV 92,12,196
TR 56,6,59200
v_accvgpr_read_b32 v29, a249
MAV 92,28,204
TR 58,6,59712
v_add_f32 v57, v57, v29
MAV 76,28,200
TR 60,6,59232
v_accvgpr_read_b32 v28, a250
MAV 76,12,192
TR 62,6,59744
v_add_f32 v58, v58, v28
s_waitcnt vmcnt(0) lgkmcnt(8)
MAV 64,32,208
ds_read_b64_tr_b16 a[0:1], v7
v_accvgpr_read_b32 v29, a251
MAV 64,48,216
TR 2,7,512
v_add_f32 v59, v59, v29
MAV 80,48,220
TR 4,7,32
MAV 80,32,212
TR 6,7,544
v_accvgpr_read_b32 v28, a252
MAV 84,36,212
TR 16,7,8448
v_add_f32 v60, v60, v28
MAV 84,52,220
TR 18,7,8960
MAV 68,52,216
TR 20,7,8480
v_accvgpr_read_b32 v29, a253
MAV 68,36,208
TR 22,7,8992
s_waitcnt lgkmcnt(8)
MAV 72,40,208
TR 8,7,64
v_add_f32 v61, v61, v29
MAV 72,56,216
TR 10,7,576
MAV 88,56,220
TR 12,7,96
v_accvgpr_read_b32 v28, a254
MAV 88,40,212
TR 14,7,608
v_add_f32 v62, v62, v28
MAV 92,44,212
TR 24,7,8512
MAV 92,60,220
TR 26,7,9024
v_accvgpr_read_b32 v29, a255
MAV 76,60,216
TR 28,7,8544
v_add_f32 v63, v63, v29
MAV 76,44,208
TR 30,7,9056
s_waitcnt lgkmcnt(8)
MAV 32,0,96
TR 32,7,16896
v_cvt_pk_bf16_f32 v232, v64, v65
MAV 32,16,104
TR 34,7,17408
v_cvt_pk_bf16_f32 v233, v66, v67
v_cvt_pk_bf16_f32 v234, v68, v69
MAV 48,16,108
TR 36,7,16928
v_cvt_pk_bf16_f32 v235, v70, v71
MAV 48,0,100
TR 38,7,17440
buffer_store_dwordx4 v[232:235], v4, s[16:19], s69 offen sc1
s_add_u32 s69, s69, 131072
MAV 52,4,100
TR 48,7,25344
v_cvt_pk_bf16_f32 v236, v72, v73
MAV 52,20,108
TR 50,7,25856
v_cvt_pk_bf16_f32 v237, v74, v75
v_cvt_pk_bf16_f32 v238, v76, v77
MAV 36,20,104
TR 52,7,25376
v_cvt_pk_bf16_f32 v239, v78, v79
MAV 36,4,96
TR 54,7,25888
buffer_store_dwordx4 v[236:239], v4, s[16:19], s69 offen sc1
s_waitcnt lgkmcnt(8)
MAV 40,8,96
TR 40,7,16960
s_add_u32 s69, s69, -130048
MAV 40,24,104
TR 42,7,17472
v_cvt_pk_bf16_f32 v240, v80, v81
v_cvt_pk_bf16_f32 v241, v82, v83
MAV 56,24,108
TR 44,7,16992
v_cvt_pk_bf16_f32 v242, v84, v85
MAV 56,8,100
TR 46,7,17504
v_cvt_pk_bf16_f32 v243, v86, v87
buffer_store_dwordx4 v[240:243], v4, s[16:19], s69 offen sc1
MAV 60,12,100
TR 56,7,25408
s_add_u32 s69, s69, 131072
MAV 60,28,108
TR 58,7,25920
v_cvt_pk_bf16_f32 v244, v88, v89
v_cvt_pk_bf16_f32 v245, v90, v91
MAV 44,28,104
TR 60,7,25440
v_cvt_pk_bf16_f32 v246, v92, v93
MAV 44,12,96
TR 62,7,25952
v_cvt_pk_bf16_f32 v247, v94, v95
buffer_store_dwordx4 v[244:247], v4, s[16:19], s69 offen sc1
s_waitcnt lgkmcnt(8)
MAV 32,32,112
TR 0,7,33792
MAV 32,48,120
TR 2,7,34304
MAV 48,48,124
TR 4,7,33824
MAV 48,32,116
TR 6,7,34336
MAV 52,36,116
TR 16,7,42240
MAV 52,52,124
TR 18,7,42752
MAV 36,52,120
TR 20,7,42272
MAV 36,36,112
TR 22,7,42784
s_waitcnt lgkmcnt(8)
MAV 40,40,112
TR 8,7,33856
MAV 40,56,120
TR 10,7,34368
MAV 56,56,124
TR 12,7,33888
MAV 56,40,116
TR 14,7,34400
MAV 60,44,116
TR 24,7,42304
MAV 60,60,124
TR 26,7,42816
MAV 44,60,120
TR 28,7,42336
MAV 44,44,112
TR 30,7,42848
s_waitcnt lgkmcnt(8)
MAV 32,0,128
TR 32,7,50688
MAV 32,16,136
TR 34,7,51200
MAV 48,16,140
TR 36,7,50720
MAV 48,0,132
TR 38,7,51232
MAV 52,4,132
TR 48,7,59136
MAV 52,20,140
TR 50,7,59648
MAV 36,20,136
TR 52,7,59168
MAV 36,4,128
TR 54,7,59680
s_waitcnt lgkmcnt(8)
MAV 40,8,128
TR 40,7,50752
MAV 40,24,136
TR 42,7,51264
MAV 56,24,140
TR 44,7,50784
MAV 56,8,132
TR 46,7,51296
MAV 60,12,132
TR 56,7,59200
MAV 60,28,140
TR 58,7,59712
MAV 44,28,136
TR 60,7,59232
MAV 44,12,128
TR 62,7,59744
v_add_u32 v7, s57, v7
s_waitcnt lgkmcnt(8)
MAV 32,32,144
ds_read_b64_tr_b16 a[0:1], v7
MAV 32,48,152
s_waitcnt vmcnt(0)
buffer_atomic_add v30, v26, s[16:19], s71 offen
MAV 48,48,156
TR 2,7,512
MAV 48,32,148
TR 4,7,32
TR 6,7,544
MAV 52,36,148
MAV 52,52,156
TR 16,7,8448
TR 18,7,8960
MAV 36,52,152
TR 20,7,8480
MAV 36,36,144
s_waitcnt lgkmcnt(7)
MAV 40,40,144
TR 22,7,8992
MAV 40,56,152
TR 8,7,64
TR 10,7,576
MAV 56,56,156
MAV 56,40,148
TR 12,7,96
TR 14,7,608
MAV 60,44,148
TR 24,7,8512
MAV 60,60,156
TR 26,7,9024
MAV 44,60,152
TR 28,7,8544
MAV 44,44,144
TR 30,7,9056
s_waitcnt lgkmcnt(8)
s_barrier
MAV 32,0,160
TR 32,7,16896
TR 34,7,17408
MAV 32,16,168
buffer_atomic_add v31, v26, s[16:19], s70 offen sc0
MAV 48,16,172
TR 36,7,16928
TR 38,7,17440
MAV 48,0,164
TR 48,7,25344
MAV 52,4,164
TR 50,7,25856
s_add_u32 m0, s59, 117248
MAV 52,20,172
TR 52,7,25376
buffer_load_dwordx4 v18, s[20:23], s58 offen lds
MAV 36,20,168
TR 54,7,25888
MAV 36,4,160
TR 40,7,16960
s_waitcnt lgkmcnt(9)
MAV 40,8,160
TR 42,7,17472
MAV 40,24,168
TR 44,7,16992
buffer_load_dwordx4 v19, s[20:23], s58 offen offset:1024 lds
MAV 56,24,172
TR 46,7,17504
MAV 56,8,164
TR 56,7,25408
buffer_load_dwordx4 v20, s[20:23], s58 offen offset:2048 lds
MAV 60,12,164
s_add_u32 s58, s58, 196608
s_add_u32 m0, s59, 129664
MAV 60,28,172
TR 58,7,25920
buffer_load_dwordx4 v18, s[20:23], s58 offen lds
MAV 44,28,168
TR 60,7,25440
MAV 44,12,160
TR 62,7,25952
s_waitcnt lgkmcnt(8)
MAV 32,32,176
TR 0,7,33792
MAV 32,48,184
buffer_load_dwordx4 v19, s[20:23], s58 offen offset:1024 lds
MAV 48,48,188
TR 2,7,34304
MAV 48,32,180
TR 4,7,33824
TR 6,7,34336
MAV 52,36,180
TR 16,7,42240
MAV 52,52,188
buffer_load_dwordx4 v20, s[20:23], s58 offen offset:2048 lds
MAV 36,52,184
TR 18,7,42752
s_add_u32 s58, s58, 196608
MAV 36,36,176
TR 20,7,42272
TR 22,7,42784
s_waitcnt lgkmcnt(8)
MAV 40,40,176
TR 8,7,33856
s_add_u32 m0, s59, 67584
MAV 40,56,184
buffer_load_dwordx4 v18, s[20:23], s58 offen lds
MAV 56,56,188
TR 10,7,34368
MAV 56,40,180
TR 12,7,33888
TR 14,7,34400
MAV 60,44,180
TR 24,7,42304
MAV 60,60,188
buffer_load_dwordx4 v19, s[20:23], s58 offen offset:1024 lds
MAV 44,60,184
TR 26,7,42816
MAV 44,44,176
TR 28,7,42336
TR 30,7,42848
s_waitcnt vmcnt(8)
v_cmp_le_u32 vcc, 1, v31
s_nop 0
s_cbranch_vccnz .Lxs51
s_mov_b32 s15, 0
.Lxs51l:
v_mov_b32 v31, 0
buffer_atomic_add v31, v26, s[16:19], s70 offen sc0
s_add_u32 s15, s15, 1
s_cmp_gt_u32 s15, 100000
s_waitcnt vmcnt(0)
s_cbranch_scc1 .Lxs51
v_cmp_le_u32 vcc, 1, v31
s_nop 0
s_cbranch_vccz .Lxs51l
.Lxs51:
s_waitcnt lgkmcnt(8)
MAV 32,0,192
TR 32,7,50688
TR 34,7,51200
MAV 32,16,200
TR 36,7,50720
buffer_load_dwordx4 v[232:235], v4, s[16:19], s68 offen sc1
MAV 48,16,204
TR 38,7,51232
s_add_u32 s68, s68, 131072
MAV 48,0,196
TR 48,7,59136
buffer_load_dwordx4 v[236:239], v4, s[16:19], s68 offen sc1
MAV 52,4,196
TR 50,7,59648
s_add_u32 s68, s68, -130048
MAV 52,20,204
TR 52,7,59168
buffer_load_dwordx4 v[240:243], v4, s[16:19], s68 offen sc1
MAV 36,20,200
TR 54,7,59680
s_add_u32 s68, s68, 131072
MAV 36,4,192
TR 40,7,50752
s_waitcnt lgkmcnt(9)
MAV 40,8,192
TR 42,7,51264
TR 44,7,50784
MAV 40,24,200
buffer_load_dwordx4 v[244:247], v4, s[16:19], s68 offen sc1
MAV 56,24,204
TR 46,7,51296
TR 56,7,59200
MAV 56,8,196
TR 58,7,59712
buffer_load_dwordx4 v20, s[20:23], s58 offen offset:2048 lds
MAV 60,12,196
s_add_u32 s58, s58, 196608
s_add_u32 m0, s59, 80000
MAV 60,28,204
TR 60,7,59232
buffer_load_dwordx4 v18, s[20:23], s58 offen lds
MAV 44,28,200
TR 62,7,59744
MAV 44,12,192
buffer_load_dwordx4 v19, s[20:23], s58 offen offset:1024 lds
buffer_load_dwordx4 v20, s[20:23], s58 offen offset:2048 lds
s_add_u32 s58, s58, 196608
s_waitcnt lgkmcnt(8)
MAV 32,32,208
s_add_u32 m0, s59, 92416
MAV 32,48,216
buffer_load_dwordx4 v18, s[20:23], s58 offen lds
MAV 48,48,220
MAV 48,32,212
MAV 52,36,212
MAV 52,52,220
MAV 36,52,216
MAV 36,36,208
s_waitcnt lgkmcnt(0)
MAV 40,40,208
MAV 40,56,216
buffer_load_dwordx4 v19, s[20:23], s58 offen offset:1024 lds
MAV 56,56,220
MAV 56,40,212
buffer_load_dwordx4 v20, s[20:23], s58 offen offset:2048 lds
MAV 60,44,212
s_add_u32 s58, s58, 196608
MAV 60,60,220
MAV 44,60,216
MAV 44,44,208
s_waitcnt vmcnt(10)
v_mfma_f32_16x16x32_bf16 v[32:35], v[226:229], v[232:235], v[32:35]
s_lshl_b32 s64, s6, 14
s_lshl_b32 s65, s49, 13
s_add_u32 s64, s64, s65
v_mfma_f32_16x16x32_bf16 v[36:39], v[224:227], v[232:235], v[36:39]
s_lshl_b32 s65, s7, 9
s_add_u32 s64, s64, s65
s_lshl_b32 s65, s48, 8
s_waitcnt vmcnt(9)
v_mfma_f32_16x16x32_bf16 v[40:43], v[226:229], v[236:239], v[40:43]
s_add_u32 s64, s64, s65
s_add_u32 s64, s64, 62914560
v_and_b32 v152, 31, v1
v_mfma_f32_16x16x32_bf16 v[44:47], v[224:227], v[236:239], v[44:47]
s_lshl_b32 s62, s7, 18
v_lshlrev_b32 v152, 3, v152
v_lshrrev_b32 v153, 5, v1
s_waitcnt vmcnt(8)
v_mfma_f32_16x16x32_bf16 v[48:51], v[226:229], v[240:243], v[48:51]
s_add_u32 s62, s62, 33554432
v_lshl_add_u32 v152, v153, 28, v152
s_add_u32 s63, s62, 131072
v_mfma_f32_16x16x32_bf16 v[52:55], v[224:227], v[240:243], v[52:55]
v_cvt_pk_bf16_f32 v128, v32, v33
v_cvt_pk_bf16_f32 v129, v34, v35
s_waitcnt vmcnt(7)
v_mfma_f32_16x16x32_bf16 v[56:59], v[226:229], v[244:247], v[56:59]
v_cvt_pk_bf16_f32 v130, v36, v37
v_cvt_pk_bf16_f32 v131, v38, v39
v_mfma_f32_16x16x32_bf16 v[60:63], v[224:227], v[244:247], v[60:63]
buffer_store_dwordx4 v[128:131], v4, s[16:19], s62 offen sc1
v_cvt_pk_bf16_f32 v132, v40, v41
v_cvt_pk_bf16_f32 v133, v42, v43
v_cvt_pk_bf16_f32 v134, v44, v45
v_cvt_pk_bf16_f32 v135, v46, v47
v_cvt_pk_bf16_f32 v136, v48, v49
v_cvt_pk_bf16_f32 v137, v50, v51
v_cvt_pk_bf16_f32 v138, v52, v53
v_cvt_pk_bf16_f32 v139, v54, v55
v_cvt_pk_bf16_f32 v140, v56, v57
v_cvt_pk_bf16_f32 v141, v58, v59
v_cvt_pk_bf16_f32 v142, v60, v61
v_cvt_pk_bf16_f32 v143, v62, v63
v_pk_mul_f32 v[146:147], v[32:33], v[32:33]
buffer_store_dwordx4 v[132:135], v4, s[16:19], s63 offen sc1
v_pk_mul_f32 v[150:151], v[48:49], v[48:49]
v_pk_fma_f32 v[146:147], v[34:35], v[34:35], v[146:147]
v_pk_add_f32 v[144:145], v[32:33], v[34:35]
v_pk_fma_f32 v[150:151], v[50:51], v[50:51], v[150:151]
v_pk_add_f32 v[148:149], v[48:49], v[50:51]
v_pk_fma_f32 v[146:147], v[36:37], v[36:37], v[146:147]
v_pk_add_f32 v[144:145], v[144:145], v[36:37]
v_pk_fma_f32 v[150:151], v[52:53], v[52:53], v[150:151]
v_pk_add_f32 v[148:149], v[148:149], v[52:53]
v_pk_fma_f32 v[146:147], v[38:39], v[38:39], v[146:147]
v_pk_add_f32 v[144:145], v[144:145], v[38:39]
v_pk_fma_f32 v[150:151], v[54:55], v[54:55], v[150:151]
v_pk_add_f32 v[148:149], v[148:149], v[54:55]
buffer_store_dwordx4 v[136:139], v4, s[16:19], s62 offen offset:1024 sc1
v_pk_fma_f32 v[146:147], v[40:41], v[40:41], v[146:147]
v_pk_add_f32 v[144:145], v[144:145], v[40:41]
v_pk_fma_f32 v[150:151], v[56:57], v[56:57], v[150:151]
v_pk_add_f32 v[148:149], v[148:149], v[56:57]
v_pk_fma_f32 v[146:147], v[42:43], v[42:43], v[146:147]
v_pk_add_f32 v[144:145], v[144:145], v[42:43]
v_pk_fma_f32 v[150:151], v[58:59], v[58:59], v[150:151]
v_pk_add_f32 v[148:149], v[148:149], v[58:59]
v_pk_fma_f32 v[146:147], v[44:45], v[44:45], v[146:147]
v_pk_add_f32 v[144:145], v[144:145], v[44:45]
v_pk_fma_f32 v[150:151], v[60:61], v[60:61], v[150:151]
v_pk_add_f32 v[148:149], v[148:149], v[60:61]
v_pk_fma_f32 v[146:147], v[46:47], v[46:47], v[146:147]
buffer_store_dwordx4 v[140:143], v4, s[16:19], s63 offen offset:1024 sc1
v_pk_add_f32 v[144:145], v[144:145], v[46:47]
v_pk_fma_f32 v[150:151], v[62:63], v[62:63], v[150:151]
v_pk_add_f32 v[148:149], v[148:149], v[62:63]
v_add_f32 v144, v144, v145
v_add_f32 v146, v146, v147
v_add_f32 v148, v148, v149
v_add_f32 v150, v150, v151
s_nop 0
v_permlane16_swap_b32 v144, v148
v_permlane16_swap_b32 v146, v150
v_add_f32 v144, v144, v148
v_add_f32 v146, v146, v150
s_nop 1
v_permlane32_swap_b32 v144, v146
v_add_f32 v144, v144, v146
s_nop 1
v_permlane32_swap_b32 v144, v145
buffer_store_dwordx2 v[144:145], v152, s[16:19], s64 offen sc1
s_nop 1
v_accvgpr_write_b32 a224, v32
v_accvgpr_write_b32 a225, v33
v_accvgpr_write_b32 a226, v34
v_accvgpr_write_b32 a227, v35
v_accvgpr_write_b32 a228, v36
v_accvgpr_write_b32 a229, v37
v_accvgpr_write_b32 a230, v38
v_accvgpr_write_b32 a231, v39
v_accvgpr_write_b32 a232, v40
v_accvgpr_write_b32 a233, v41
v_accvgpr_write_b32 a234, v42
v_accvgpr_write_b32 a235, v43
v_accvgpr_write_b32 a236, v44
v_accvgpr_write_b32 a237, v45
v_accvgpr_write_b32 a238, v46
.Lpad22:
s_cbranch_execz .Lnopoll37r
v_accvgpr_write_b32 a239, v47
v_accvgpr_write_b32 a240, v48
v_accvgpr_write_b32 a241, v49
v_accvgpr_write_b32 a242, v50
v_accvgpr_write_b32 a243, v51
v_accvgpr_write_b32 a244, v52
v_accvgpr_write_b32 a245, v53
v_accvgpr_write_b32 a246, v54
v_accvgpr_write_b32 a247, v55
v_accvgpr_write_b32 a248, v56
v_accvgpr_write_b32 a249, v57
v_accvgpr_write_b32 a250, v58
v_accvgpr_write_b32 a251, v59
v_accvgpr_write_b32 a252, v60
v_accvgpr_write_b32 a253, v61
v_accvgpr_write_b32 a254, v62
v_accvgpr_write_b32 a255, v63
s_lshl_b32 s62, s3, 11
s_add_u32 s62, s62, s85
v_lshl_add_u32 v21, v1, 4, s62
v_lshrrev_b32 v2, 3, v1
v_cmp_eq_u32 vcc, 3, v2
v_add_u32 v2, 67108480, v21
s_nop 0
v_cndmask_b32 v21, v21, v2, vcc
s_sub_u32 s62, s86, 2048
v_lshl_add_u32 v22, v0, 2, s62
v_lshrrev_b32 v2, 5, v0
v_cmp_eq_u32 vcc, 3, v2
v_add_u32 v2, 67108480, v22
s_nop 0
v_cndmask_b32 v22, v22, v2, vcc
s_mul_i32 s62, s48, 4608
v_lshl_add_u32 v23, v1, 4, s62
v_lshrrev_b32 v24, 4, v1
v_mul_u32_u24 v24, 2304, v24
v_and_b32 v2, 15, v1
v_lshl_add_u32 v24, v2, 4, v24
s_mov_b32 s52, 33554432
s_mov_b32 s54, s58
s_mov_b32 s56, s59
s_mul_i32 s55, s3, 2304
v_bfe_u32 v25, v1, 3, 2
v_mul_u32_u24 v25, 3104, v25
v_bfe_u32 v2, v1, 2, 1
v_lshl_add_u32 v25, v2, 7, v25
v_bfe_u32 v2, v1, 5, 1
v_lshl_add_u32 v25, v2, 8, v25
v_and_b32 v2, 3, v1
v_lshl_add_u32 v25, v2, 3, v25
s_lshl_b32 s62, s49, 6
s_add_u32 s62, s62, 67584
v_add_u32 v25, s62, v25
s_lshl_b32 s62, s8, 1
s_add_u32 s62, s62, s3
s_lshr_b32 s63, s50, 2
s_cmp_lt_u32 s3, 2
s_cselect_b32 s62, s62, s63
s_lshl_b32 s62, s62, 13
s_cmp_eq_u32 s3, 3
s_cselect_b32 s62, 268435456, s62
v_lshl_add_u32 v26, v1, 4, s62
s_lshr_b32 s63, s20, 7
s_sub_u32 s63, 3, s63
s_and_b32 s63, s63, 7
s_and_b32 s62, s9, 8
s_add_u32 s63, s63, s62
s_lshl_b32 s62, s5, 2
s_add_u32 s62, s62, s3
s_mul_i32 s62, s62, 12288
s_lshl_b32 s64, s63, 7
s_add_u32 s62, s62, s64
s_xor_b32 s63, s63, s9
s_cmp_lt_u32 s63, 4
s_cselect_b32 s62, s62, 16777216
v_lshrrev_b32 v14, 3, v1
v_min_u32 v14, 5, v14
v_lshl_add_u32 v14, v14, 11, s62
s_mov_b32 s44, 983040
buffer_load_dword v27, v14, s[20:23], s44 offen
s_mov_b32 s44, 2555904
s_mul_i32 s59, s3, 2080
s_and_b32 s87, s6, 3
s_lshl_b32 s87, s87, 17
v_bfe_u32 v5, v1, 3, 1
v_lshrrev_b32 v2, 4, v1
v_lshl_add_u32 v5, v2, 3, v5
s_lshl_b32 s62, s3, 1
v_add_u32 v5, s62, v5
v_mul_u32_u24 v5, 2048, v5
v_and_b32 v2, 7, v1
v_lshl_add_u32 v5, v2, 4, v5
s_lshl_b32 s62, s7, 7
v_add_u32 v5, s62, v5
v_add_u32 v6, 64512, v5
s_lshl_b32 s62, s6, 10
s_add_u32 s62, s62, 30474240
s_lshl_b32 s64, s8, 10
s_add_u32 s64, s64, 30474240
s_lshr_b32 s67, s9, 1
s_and_b32 s67, s67, 3
s_lshl_b32 s67, s67, 7
s_add_u32 s64, s64, s67
s_lshr_b32 s65, s50, 3
s_lshl_b32 s65, s65, 10
s_add_u32 s65, s65, 30474240
s_lshr_b32 s67, s9, 1
s_and_b32 s67, s67, 3
s_lshl_b32 s67, s67, 7
s_add_u32 s65, s65, s67
v_lshl_add_u32 v252, v1, 7, s62
v_mov_b32 v253, s64
v_mov_b32 v255, 1
v_writelane_b32 v253, s65, 1
s_waitcnt vmcnt(1) lgkmcnt(0)
s_cmp_lg_u32 s3, 1
s_barrier
s_cbranch_scc1 .Lfirst54
s_mov_b64 exec, 15
buffer_atomic_add v255, v252, s[16:19], 0 offen
s_mov_b64 exec, 3
v_mov_b32 v254, 0
buffer_atomic_add v254, v253, s[16:19], 0 offen sc0
s_mov_b64 exec, -1
.Lfirst54:
TR 80,25,49664
TR 82,25,50176
TR 84,25,62080
TR 86,25,62592
TR 88,25,50688
TR 90,25,51200
TR 92,25,63104
TR 94,25,63616
TR 96,25,51712
TR 98,25,52224
TR 100,25,64128
TR 102,25,64640
v_lshrrev_b32 v2, 4, v1
v_lshlrev_b32 v2, 2, v2
v_and_b32 v13, 15, v1
v_sub_u32 v2, v13, v2
v_mov_b32 v13, 0xff61b1e6
v_subrev_u32 v54, 0, v2
v_cmp_gt_u32 vcc, 8, v54
s_nop 1
v_cndmask_b32 v50, v13, 0, vcc
v_cmp_gt_i32 vcc, -8, v54
s_nop 1
v_cndmask_b32 v46, v13, 0, vcc
v_subrev_u32 v54, 1, v2
v_cmp_gt_u32 vcc, 8, v54
s_nop 1
v_cndmask_b32 v51, v13, 0, vcc
v_cmp_gt_i32 vcc, -8, v54
s_nop 1
v_cndmask_b32 v47, v13, 0, vcc
v_subrev_u32 v54, 2, v2
v_cmp_gt_u32 vcc, 8, v54
s_nop 1
v_cndmask_b32 v52, v13, 0, vcc
v_cmp_gt_i32 vcc, -8, v54
s_nop 1
v_cndmask_b32 v48, v13, 0, vcc
v_subrev_u32 v54, 3, v2
v_cmp_gt_u32 vcc, 8, v54
s_nop 1
v_cndmask_b32 v53, v13, 0, vcc
v_cmp_gt_i32 vcc, -8, v54
s_nop 1
v_cndmask_b32 v49, v13, 0, vcc
s_cmp_lt_u32 s8, 2
s_cselect_b64 vcc, -1, 0
v_cndmask_b32 v54, v46, v13, vcc
v_cndmask_b32 v55, v47, v13, vcc
v_cndmask_b32 v56, v48, v13, vcc
v_cndmask_b32 v57, v49, v13, vcc
v_mov_b64 v[60:61], 0
v_mov_b64 v[62:63], 0
v_mov_b64 v[64:65], 0
v_mov_b64 v[66:67], 0
v_mov_b64 v[68:69], 0
v_mov_b64 v[70:71], 0
v_mov_b64 v[72:73], 0
v_mov_b64 v[74:75], 0
v_mov_b64 v[76:77], 0
v_mov_b64 v[78:79], 0
v_mov_b64 v[80:81], 0
v_mov_b64 v[82:83], 0
v_mov_b64 v[84:85], 0
v_mov_b64 v[86:87], 0
v_mov_b64 v[88:89], 0
v_mov_b64 v[90:91], 0
v_mov_b64 v[92:93], 0
v_mov_b64 v[94:95], 0
v_mov_b64 v[96:97], 0
v_mov_b64 v[98:99], 0
v_mov_b64 v[100:101], 0
v_mov_b64 v[102:103], 0
v_mov_b64 v[104:105], 0
v_mov_b64 v[106:107], 0
v_mov_b64 v[108:109], 0
v_mov_b64 v[110:111], 0
v_mov_b64 v[112:113], 0
v_mov_b64 v[114:115], 0
v_mov_b64 v[116:117], 0
v_mov_b64 v[118:119], 0
v_mov_b64 v[120:121], 0
v_mov_b64 v[122:123], 0
v_mov_b64 v[124:125], 0
v_mov_b64 v[126:127], 0
v_mov_b64 v[128:129], 0
v_mov_b64 v[130:131], 0
v_mov_b64 v[132:133], 0
v_mov_b64 v[134:135], 0
v_mov_b64 v[136:137], 0
v_mov_b64 v[138:139], 0
v_mov_b64 v[140:141], 0
v_mov_b64 v[142:143], 0
v_mov_b64 v[144:145], 0
v_mov_b64 v[146:147], 0
v_mov_b64 v[148:149], 0
v_mov_b64 v[150:151], 0
v_mov_b64 v[152:153], 0
v_mov_b64 v[154:155], 0
v_mov_b64 v[156:157], 0
v_mov_b64 v[158:159], 0
v_mov_b64 v[160:161], 0
v_mov_b64 v[162:163], 0
v_mov_b64 v[164:165], 0
v_mov_b64 v[166:167], 0
v_mov_b64 v[168:169], 0
v_mov_b64 v[170:171], 0
v_mov_b64 v[172:173], 0
v_mov_b64 v[174:175], 0
s_mov_b32 s75, 62914560
v_and_b32 v10, 15, v1
v_lshlrev_b32 v12, 2, v10
v_lshlrev_b32 v10, 4, v10
v_add_u32 v10, 152576, v10
v_lshrrev_b32 v11, 4, v1
v_lshlrev_b32 v11, 4, v11
s_lshl_b32 s62, s49, 7
s_add_u32 s62, s62, 158720
v_add_u32 v12, s62, v12
v_add_u32 v13, s62, v11
v_add_u32 v11, 156672, v11
s_lshl_b32 s62, s3, 11
s_add_u32 s62, s62, 143360
v_lshl_add_u32 v8, v1, 4, s62
v_xor_b32 v9, 2048, v8
v_mov_b32 v248, 0x3f803f80
v_mov_b32 v249, 0x3f803f80
v_mov_b32 v250, 0x3f803f80
v_mov_b32 v251, 0x3f803f80
v_and_b32 v7, 31, v1
v_lshrrev_b32 v2, 5, v1
v_lshl_add_u32 v7, v7, 1, v2
v_and_b32 v2, 0xc0, v0
v_add_u32 v7, v7, v2
v_lshlrev_b32 v17, 2, v7
v_add_u32 v17, 156672, v17
v_lshlrev_b32 v7, 4, v7
v_add_u32 v7, 152576, v7
s_lshl_b32 s74, s9, 1
s_add_u32 s74, s74, s49
s_lshl_b32 s74, s74, 17
s_add_u32 s74, s74, s85
s_lshl_b32 s63, s48, 12
s_add_u32 s74, s74, s63
s_add_u32 s74, s74, 37748736
s_mov_b32 s62, 0
v_lshl_add_u32 v4, v1, 4, s62
v_lshrrev_b32 v2, 3, v1
v_cmp_eq_u32 vcc, 3, v2
v_add_u32 v2, 67108480, v4
s_nop 0
v_cndmask_b32 v4, v4, v2, vcc
ds_read_b128 v[28:31], v13
ds_read_b128 v[32:35], v13 offset:64
ds_read_b128 v[36:39], v13 offset:256
ds_read_b128 v[40:43], v13 offset:320
ds_read_b32 v44, v12 offset:512
ds_read_b32 v45, v12 offset:576
s_waitcnt lgkmcnt(0)
s_cmp_lg_u32 s3, 1
s_cbranch_scc1 .Lnopoll53
s_mov_b64 exec, 3
s_mov_b32 s15, 0
.Lpoll52:
v_mov_b32 v255, 0
buffer_atomic_add v255, v253, s[16:19], 0 offen sc0
s_waitcnt vmcnt(1)
v_cmp_gt_u32 vcc, 16, v254
s_add_u32 s15, s15, 1
s_cbranch_vccz .Lnopoll53r
v_mov_b32 v254, 0
buffer_atomic_add v254, v253, s[16:19], 0 offen sc0
s_waitcnt vmcnt(1)
v_cmp_gt_u32 vcc, 16, v255
s_add_u32 s15, s15, 1
s_cbranch_vccz .Lnopoll53r
s_cmp_le_u32 s15, 100000
s_cbranch_scc1 .Lpoll52
s_branch .Lnopoll53r
.Lnopoll53:
s_mov_b64 exec, 0
s_cmp_eq_u32 s3, 2
s_cbranch_scc1 .Lpad23
s_cmp_eq_u32 s3, 3
s_cbranch_scc1 .Lpad24
s_branch .Lpad25
.Lnopoll53r:
s_mov_b64 exec, -1
s_barrier
s_cmp_eq_u32 s48, 1
s_cbranch_scc1 .Lqkv55
s_add_u32 m0, s55, 36864
s_nop 0
buffer_load_dwordx4 v21, s[16:19], s52 offen sc1 lds
buffer_load_dwordx4 v21, s[16:19], s52 offen offset:1024 sc1 lds
buffer_load_dword v22, s[16:19], s52 offen offset:2048 sc1 lds
s_add_u32 s52, s52, 131072
s_add_u32 m0, s55, 46080
s_nop 0
buffer_load_dwordx4 v21, s[16:19], s52 offen sc1 lds
buffer_load_dwordx4 v21, s[16:19], s52 offen offset:1024 sc1 lds
buffer_load_dword v22, s[16:19], s52 offen offset:2048 sc1 lds
s_add_u32 s52, s52, 131072
s_add_u32 m0, s55, 0
s_nop 0
buffer_load_dwordx4 v21, s[16:19], s52 offen sc1 lds
buffer_load_dwordx4 v21, s[16:19], s52 offen offset:1024 sc1 lds
buffer_load_dword v22, s[16:19], s52 offen offset:2048 sc1 lds
s_add_u32 s52, s52, 131072
s_add_u32 m0, s55, 9216
s_nop 0
buffer_load_dwordx4 v21, s[16:19], s52 offen sc1 lds
buffer_load_dwordx4 v21, s[16:19], s52 offen offset:1024 sc1 lds
buffer_load_dword v22, s[16:19], s52 offen offset:2048 sc1 lds
s_add_u32 s52, s52, 131072
s_add_u32 m0, s55, 18432
s_nop 0
buffer_load_dwordx4 v21, s[16:19], s52 offen sc1 lds
buffer_load_dwordx4 v21, s[16:19], s52 offen offset:1024 sc1 lds
buffer_load_dword v22, s[16:19], s52 offen offset:2048 sc1 lds
s_add_u32 s52, s52, 131072
s_add_u32 m0, s55, 27648
s_nop 0
buffer_load_dwordx4 v21, s[16:19], s52 offen sc1 lds
buffer_load_dwordx4 v21, s[16:19], s52 offen offset:1024 sc1 lds
buffer_load_dword v22, s[16:19], s52 offen offset:2048 sc1 lds
s_add_u32 s52, s52, 131072
s_waitcnt vmcnt(12)
s_barrier
RD 0,23,36864
RD 4,23,37888
RD 8,23,39168
RD 12,23,40192
RD 16,24,38912
RD 20,23,46080
RD 24,23,47104
RD 28,23,48384
RD 32,23,49408
RD 36,24,48128
s_waitcnt lgkmcnt(0)
s_mov_b32 s15, -2
.p2align 6
.Lk57:
s_waitcnt vmcnt(9) lgkmcnt(8)
s_barrier
MAA 60,80,0
TR 104,25,49696
s_add_u32 m0, s56, 104832
MAA 60,84,20
buffer_load_dwordx4 v18, s[20:23], s54 offen lds
MAA 64,84,24
TR 106,25,50208
v_add_f32 v164, v164, v168
MAA 64,80,4
TR 108,25,62112
MAA 68,80,8
TR 110,25,62624
MAA 68,84,28
buffer_load_dwordx4 v19, s[20:23], s54 offen offset:1024 lds
MAA 72,84,32
TR 112,25,50720
v_add_f32 v165, v165, v169
MAA 72,80,12
TR 114,25,51232
s_waitcnt lgkmcnt(6)
MAA 156,88,16
TR 116,25,63136
MAA 156,92,36
buffer_load_dwordx4 v20, s[20:23], s54 offen offset:2048 lds
MAA 104,92,32
s_add_u32 s54, s54, 196608
s_add_u32 m0, s55, 36864
MAA 104,88,12
buffer_load_dwordx4 v21, s[16:19], s52 offen sc1 lds
MAA 100,88,8
TR 118,25,63648
MAA 100,92,28
TR 120,25,51744
v_add_f32 v166, v166, v170
MAA 96,92,24
TR 122,25,52256
MAA 96,88,4
buffer_load_dwordx4 v21, s[16:19], s52 offen offset:1024 sc1 lds
MAA 92,88,0
TR 124,25,64160
MAA 92,92,20
TR 126,25,64672
v_add_f32 v167, v167, v171
MAA 124,20,100
ds_read_b128 a[40:43], v23
MAA 124,0,96
buffer_load_dword v22, s[16:19], s52 offen offset:2048 sc1 lds
MAA 128,4,96
RD 44,23,1024
s_add_u32 s52, s52, 131072
MAA 128,24,100
buffer_load_dword v27, v14, s[20:23], s44 offen
MAA 132,28,100
RD 48,23,2304
s_add_u32 s44, s44, 1572864
MAA 132,8,96
RD 52,23,3328
MAA 136,12,96
RD 56,24,2048
MAA 136,32,100
s_waitcnt vmcnt(13) lgkmcnt(5)
s_barrier
MAA 76,104,0
RD 60,23,9216
s_add_u32 m0, s56, 117248
MAA 76,108,20
buffer_load_dwordx4 v18, s[20:23], s54 offen lds
MAA 80,108,24
RD 64,23,10240
MAA 80,104,4
RD 68,23,11520
MAA 84,104,8
RD 72,23,12544
MAA 84,108,28
buffer_load_dwordx4 v19, s[20:23], s54 offen offset:1024 lds
MAA 88,108,32
RD 76,24,11264
MAA 88,104,12
buffer_load_dwordx4 v20, s[20:23], s54 offen offset:2048 lds
MAA 160,112,16
ds_read_b64_tr_b16 a[80:81], v25
s_add_u32 s54, s54, 196608
MAA 160,116,36
TR 82,25,512
MAA 120,116,32
TR 84,25,12416
s_add_u32 m0, s55, 46080
MAA 120,112,12
buffer_load_dwordx4 v21, s[16:19], s52 offen sc1 lds
MAA 116,112,8
TR 86,25,12928
MAA 116,116,28
TR 88,25,1024
MAA 112,116,24
TR 90,25,1536
MAA 112,112,4
buffer_load_dwordx4 v21, s[16:19], s52 offen offset:1024 sc1 lds
MAA 108,112,0
TR 92,25,13440
MAA 108,116,20
TR 94,25,13952
MAA 140,20,124
TR 96,25,2048
MAA 140,0,120
buffer_load_dword v22, s[16:19], s52 offen offset:2048 sc1 lds
MAA 144,4,120
TR 98,25,2560
s_add_u32 s52, s52, 131072
MAA 144,24,124
buffer_load_dwordx4 v[168:171], v26, s[16:19], s75 offen sc1
MAA 148,28,124
TR 100,25,14464
MAA 148,8,120
TR 102,25,14976
MAA 152,12,120
MAA 152,32,124
s_waitcnt vmcnt(17) lgkmcnt(8)
s_barrier
MAA 60,80,40
TR 104,25,32
s_add_u32 m0, s56, 129664
MAA 60,84,60
buffer_load_dwordx4 v18, s[20:23], s54 offen lds
MAA 64,84,64
TR 106,25,544
v_add_f32 v164, v164, v172
MAA 64,80,44
TR 108,25,12448
MAA 68,80,48
TR 110,25,12960
MAA 68,84,68
buffer_load_dwordx4 v19, s[20:23], s54 offen offset:1024 lds
MAA 72,84,72
TR 112,25,1056
MAA 72,80,52
TR 114,25,1568
s_waitcnt lgkmcnt(6)
MAA 156,88,56
TR 116,25,13472
v_add_f32 v165, v165, v173
MAA 156,92,76
buffer_load_dwordx4 v20, s[20:23], s54 offen offset:2048 lds
MAA 104,92,72
TR 118,25,13984
s_add_u32 s54, s54, 196608
MAA 104,88,52
TR 120,25,2080
MAA 100,88,48
s_add_u32 m0, s55, 0
MAA 100,92,68
buffer_load_dwordx4 v21, s[16:19], s52 offen sc1 lds
MAA 96,92,64
TR 122,25,2592
v_add_f32 v166, v166, v174
MAA 96,88,44
TR 124,25,14496
MAA 92,88,40
TR 126,25,15008
MAA 92,92,60
buffer_load_dwordx4 v21, s[16:19], s52 offen offset:1024 sc1 lds
MAA 124,60,100
RD 0,23,18432
MAA 124,40,96
RD 4,23,19456
v_add_f32 v167, v167, v175
MAA 128,44,96
RD 8,23,20736
MAA 128,64,100
buffer_load_dword v22, s[16:19], s52 offen offset:2048 sc1 lds
MAA 132,68,100
RD 12,23,21760
s_add_u32 s52, s52, 131072
MAA 132,48,96
RD 16,24,20480
MAA 136,52,96
MAA 136,72,100
s_waitcnt vmcnt(17) lgkmcnt(5)
s_barrier
MAA 76,104,40
RD 20,23,27648
s_add_u32 m0, s56, 67584
MAA 76,108,60
buffer_load_dwordx4 v18, s[20:23], s54 offen lds
MAA 80,108,64
RD 24,23,28672
MAA 80,104,44
RD 28,23,29952
MAA 84,104,48
RD 32,23,30976
MAA 84,108,68
buffer_load_dwordx4 v19, s[20:23], s54 offen offset:1024 lds
MAA 88,108,72
RD 36,24,29696
MAA 88,104,52
buffer_load_dwordx4 v20, s[20:23], s54 offen offset:2048 lds
MAA 160,112,56
TR 80,25,24832
s_add_u32 s54, s54, 196608
MAA 160,116,76
TR 82,25,25344
MAA 120,116,72
TR 84,25,37248
s_add_u32 m0, s55, 9216
MAA 120,112,52
buffer_load_dwordx4 v21, s[16:19], s52 offen sc1 lds
MAA 116,112,48
TR 86,25,37760
MAA 116,116,68
TR 88,25,25856
MAA 112,116,64
TR 90,25,26368
MAA 112,112,44
buffer_load_dwordx4 v21, s[16:19], s52 offen offset:1024 sc1 lds
MAA 108,112,40
TR 92,25,38272
MAA 108,116,60
TR 94,25,38784
MAA 140,60,124
TR 96,25,26880
MAA 140,40,120
buffer_load_dword v22, s[16:19], s52 offen offset:2048 sc1 lds
MAA 144,44,120
TR 98,25,27392
s_add_u32 s52, s52, 131072
MAA 144,64,124
buffer_load_dwordx4 v[172:175], v26, s[16:19], s75 offen offset:1024 sc1
MAA 148,68,124
TR 100,25,39296
s_add_u32 s75, s75, 2048
MAA 148,48,120
TR 102,25,39808
MAA 152,52,120
MAA 152,72,124
s_waitcnt vmcnt(21) lgkmcnt(8)
s_barrier
MAA 60,80,0
TR 104,25,24864
s_add_u32 m0, s56, 80000
MAA 60,84,20
buffer_load_dwordx4 v18, s[20:23], s54 offen lds
MAA 64,84,24
TR 106,25,25376
MAA 64,80,4
TR 108,25,37280
MAA 68,80,8
TR 110,25,37792
MAA 68,84,28
buffer_load_dwordx4 v19, s[20:23], s54 offen offset:1024 lds
MAA 72,84,32
TR 112,25,25888
MAA 72,80,12
TR 114,25,26400
s_waitcnt lgkmcnt(6)
MAA 156,88,16
TR 116,25,38304
MAA 156,92,36
buffer_load_dwordx4 v20, s[20:23], s54 offen offset:2048 lds
MAA 104,92,32
TR 118,25,38816
s_add_u32 s54, s54, 196608
MAA 104,88,12
TR 120,25,26912
MAA 100,88,8
s_add_u32 m0, s55, 18432
MAA 100,92,28
.Lpad23:
s_cbranch_execz .Lpad26
buffer_load_dwordx4 v21, s[16:19], s52 offen sc1 lds
MAA 96,92,24
TR 122,25,27424
MAA 96,88,4
TR 124,25,39328
MAA 92,88,0
TR 126,25,39840
MAA 92,92,20
buffer_load_dwordx4 v21, s[16:19], s52 offen offset:1024 sc1 lds
MAA 124,20,100
RD 40,23,36864
MAA 124,0,96
RD 44,23,37888
MAA 128,4,96
RD 48,23,39168
MAA 128,24,100
buffer_load_dword v22, s[16:19], s52 offen offset:2048 sc1 lds
MAA 132,28,100
RD 52,23,40192
s_add_u32 s52, s52, 131072
MAA 132,8,96
RD 56,24,38912
MAA 136,12,96
MAA 136,32,100
s_waitcnt vmcnt(16) lgkmcnt(5)
s_barrier
MAA 76,104,0
RD 60,23,46080
s_add_u32 m0, s56, 92416
MAA 76,108,20
buffer_load_dwordx4 v18, s[20:23], s54 offen lds
MAA 80,108,24
RD 64,23,47104
MAA 80,104,4
RD 68,23,48384
MAA 84,104,8
RD 72,23,49408
MAA 84,108,28
buffer_load_dwordx4 v19, s[20:23], s54 offen offset:1024 lds
MAA 88,108,32
RD 76,24,48128
MAA 88,104,12
TR 80,25,49664
MAA 160,112,16
TR 82,25,50176
MAA 160,116,36
buffer_load_dwordx4 v20, s[20:23], s54 offen offset:2048 lds
MAA 120,116,32
TR 84,25,62080
s_add_u32 s54, s54, 196608
MAA 120,112,12
TR 86,25,62592
MAA 116,112,8
s_add_u32 m0, s55, 27648
MAA 116,116,28
buffer_load_dwordx4 v21, s[16:19], s52 offen sc1 lds
MAA 112,116,24
TR 88,25,50688
MAA 112,112,4
TR 90,25,51200
MAA 108,112,0
TR 92,25,63104
MAA 108,116,20
buffer_load_dwordx4 v21, s[16:19], s52 offen offset:1024 sc1 lds
MAA 140,20,124
TR 94,25,63616
MAA 140,0,120
TR 96,25,51712
MAA 144,4,120
TR 98,25,52224
MAA 144,24,124
buffer_load_dword v22, s[16:19], s52 offen offset:2048 sc1 lds
MAA 148,28,124
TR 100,25,64128
s_add_u32 s52, s52, 131072
MAA 148,8,120
TR 102,25,64640
MAA 152,12,120
MAA 152,32,124
s_waitcnt vmcnt(19) lgkmcnt(8)
s_barrier
MAA 60,80,40
TR 104,25,49696
s_add_u32 m0, s56, 104832
MAA 60,84,60
buffer_load_dwordx4 v18, s[20:23], s54 offen lds
MAA 64,84,64
TR 106,25,50208
v_add_f32 v164, v164, v168
MAA 64,80,44
TR 108,25,62112
MAA 68,80,48
TR 110,25,62624
MAA 68,84,68
buffer_load_dwordx4 v19, s[20:23], s54 offen offset:1024 lds
MAA 72,84,72
TR 112,25,50720
v_add_f32 v165, v165, v169
MAA 72,80,52
TR 114,25,51232
s_waitcnt lgkmcnt(6)
MAA 156,88,56
TR 116,25,63136
MAA 156,92,76
buffer_load_dwordx4 v20, s[20:23], s54 offen offset:2048 lds
MAA 104,92,72
s_add_u32 s54, s54, 196608
s_add_u32 m0, s55, 36864
MAA 104,88,52
buffer_load_dwordx4 v21, s[16:19], s52 offen sc1 lds
MAA 100,88,48
TR 118,25,63648
MAA 100,92,68
TR 120,25,51744
v_add_f32 v166, v166, v170
MAA 96,92,64
TR 122,25,52256
MAA 96,88,44
buffer_load_dwordx4 v21, s[16:19], s52 offen offset:1024 sc1 lds
MAA 92,88,40
TR 124,25,64160
MAA 92,92,60
TR 126,25,64672
v_add_f32 v167, v167, v171
MAA 124,60,100
ds_read_b128 a[0:3], v23
MAA 124,40,96
buffer_load_dword v22, s[16:19], s52 offen offset:2048 sc1 lds
MAA 128,44,96
RD 4,23,1024
s_add_u32 s52, s52, 131072
MAA 128,64,100
buffer_load_dword v27, v14, s[20:23], s44 offen
MAA 132,68,100
RD 8,23,2304
s_add_u32 s44, s44, 1572864
MAA 132,48,96
RD 12,23,3328
MAA 136,52,96
RD 16,24,2048
MAA 136,72,100
s_waitcnt vmcnt(16) lgkmcnt(5)
s_barrier
MAA 76,104,40
RD 20,23,9216
s_add_u32 m0, s56, 117248
MAA 76,108,60
buffer_load_dwordx4 v18, s[20:23], s54 offen lds
MAA 80,108,64
RD 24,23,10240
MAA 80,104,44
RD 28,23,11520
MAA 84,104,48
RD 32,23,12544
MAA 84,108,68
buffer_load_dwordx4 v19, s[20:23], s54 offen offset:1024 lds
MAA 88,108,72
RD 36,24,11264
MAA 88,104,52
buffer_load_dwordx4 v20, s[20:23], s54 offen offset:2048 lds
MAA 160,112,56
ds_read_b64_tr_b16 a[80:81], v25
s_add_u32 s54, s54, 196608
MAA 160,116,76
TR 82,25,512
MAA 120,116,72
TR 84,25,12416
s_add_u32 m0, s55, 46080
MAA 120,112,52
buffer_load_dwordx4 v21, s[16:19], s52 offen sc1 lds
MAA 116,112,48
TR 86,25,12928
MAA 116,116,68
TR 88,25,1024
MAA 112,116,64
TR 90,25,1536
MAA 112,112,44
buffer_load_dwordx4 v21, s[16:19], s52 offen offset:1024 sc1 lds
MAA 108,112,40
TR 92,25,13440
MAA 108,116,60
TR 94,25,13952
MAA 140,60,124
TR 96,25,2048
MAA 140,40,120
buffer_load_dword v22, s[16:19], s52 offen offset:2048 sc1 lds
MAA 144,44,120
TR 98,25,2560
s_add_u32 s52, s52, 131072
MAA 144,64,124
buffer_load_dwordx4 v[168:171], v26, s[16:19], s75 offen sc1
MAA 148,68,124
TR 100,25,14464
MAA 148,48,120
TR 102,25,14976
MAA 152,52,120
MAA 152,72,124
s_waitcnt vmcnt(20) lgkmcnt(8)
s_barrier
MAA 60,80,0
TR 104,25,32
s_add_u32 m0, s56, 129664
MAA 60,84,20
buffer_load_dwordx4 v18, s[20:23], s54 offen lds
MAA 64,84,24
TR 106,25,544
v_add_f32 v164, v164, v172
MAA 64,80,4
TR 108,25,12448
MAA 68,80,8
TR 110,25,12960
MAA 68,84,28
buffer_load_dwordx4 v19, s[20:23], s54 offen offset:1024 lds
MAA 72,84,32
TR 112,25,1056
MAA 72,80,12
TR 114,25,1568
s_waitcnt lgkmcnt(6)
MAA 156,88,16
TR 116,25,13472
v_add_f32 v165, v165, v173
MAA 156,92,36
buffer_load_dwordx4 v20, s[20:23], s54 offen offset:2048 lds
MAA 104,92,32
TR 118,25,13984
s_add_u32 s54, s54, 196608
MAA 104,88,12
TR 120,25,2080
MAA 100,88,8
s_add_u32 m0, s55, 0
MAA 100,92,28
buffer_load_dwordx4 v21, s[16:19], s52 offen sc1 lds
MAA 96,92,24
TR 122,25,2592
v_add_f32 v166, v166, v174
MAA 96,88,4
TR 124,25,14496
MAA 92,88,0
TR 126,25,15008
MAA 92,92,20
buffer_load_dwordx4 v21, s[16:19], s52 offen offset:1024 sc1 lds
MAA 124,20,100
RD 40,23,18432
MAA 124,0,96
RD 44,23,19456
v_add_f32 v167, v167, v175
MAA 128,4,96
RD 48,23,20736
MAA 128,24,100
buffer_load_dword v22, s[16:19], s52 offen offset:2048 sc1 lds
MAA 132,28,100
RD 52,23,21760
s_add_u32 s52, s52, 131072
MAA 132,8,96
RD 56,24,20480
MAA 136,12,96
MAA 136,32,100
s_waitcnt vmcnt(17) lgkmcnt(5)
s_barrier
MAA 76,104,0
RD 60,23,27648
s_add_u32 m0, s56, 67584
MAA 76,108,20
buffer_load_dwordx4 v18, s[20:23], s54 offen lds
MAA 80,108,24
RD 64,23,28672
MAA 80,104,4
RD 68,23,29952
MAA 84,104,8
RD 72,23,30976
MAA 84,108,28
buffer_load_dwordx4 v19, s[20:23], s54 offen offset:1024 lds
MAA 88,108,32
RD 76,24,29696
MAA 88,104,12
buffer_load_dwordx4 v20, s[20:23], s54 offen offset:2048 lds
MAA 160,112,16
TR 80,25,24832
s_add_u32 s54, s54, 196608
MAA 160,116,36
TR 82,25,25344
MAA 120,116,32
TR 84,25,37248
s_add_u32 m0, s55, 9216
MAA 120,112,12
buffer_load_dwordx4 v21, s[16:19], s52 offen sc1 lds
MAA 116,112,8
TR 86,25,37760
MAA 116,116,28
TR 88,25,25856
MAA 112,116,24
TR 90,25,26368
MAA 112,112,4
buffer_load_dwordx4 v21, s[16:19], s52 offen offset:1024 sc1 lds
MAA 108,112,0
TR 92,25,38272
MAA 108,116,20
TR 94,25,38784
MAA 140,20,124
TR 96,25,26880
MAA 140,0,120
buffer_load_dword v22, s[16:19], s52 offen offset:2048 sc1 lds
MAA 144,4,120
TR 98,25,27392
s_add_u32 s52, s52, 131072
MAA 144,24,124
buffer_load_dwordx4 v[172:175], v26, s[16:19], s75 offen offset:1024 sc1
MAA 148,28,124
TR 100,25,39296
s_add_u32 s75, s75, 2048
MAA 148,8,120
TR 102,25,39808
MAA 152,12,120
MAA 152,32,124
s_waitcnt vmcnt(21) lgkmcnt(8)
s_barrier
MAA 60,80,40
TR 104,25,24864
s_add_u32 m0, s56, 80000
MAA 60,84,60
buffer_load_dwordx4 v18, s[20:23], s54 offen lds
MAA 64,84,64
TR 106,25,25376
MAA 64,80,44
TR 108,25,37280
MAA 68,80,48
TR 110,25,37792
MAA 68,84,68
buffer_load_dwordx4 v19, s[20:23], s54 offen offset:1024 lds
MAA 72,84,72
TR 112,25,25888
MAA 72,80,52
TR 114,25,26400
s_waitcnt lgkmcnt(6)
MAA 156,88,56
TR 116,25,38304
MAA 156,92,76
buffer_load_dwordx4 v20, s[20:23], s54 offen offset:2048 lds
MAA 104,92,72
TR 118,25,38816
s_add_u32 s54, s54, 196608
MAA 104,88,52
TR 120,25,26912
MAA 100,88,48
s_add_u32 m0, s55, 18432
MAA 100,92,68
buffer_load_dwordx4 v21, s[16:19], s52 offen sc1 lds
MAA 96,92,64
TR 122,25,27424
MAA 96,88,44
TR 124,25,39328
MAA 92,88,40
TR 126,25,39840
MAA 92,92,60
buffer_load_dwordx4 v21, s[16:19], s52 offen offset:1024 sc1 lds
MAA 124,60,100
RD 0,23,36864
MAA 124,40,96
RD 4,23,37888
MAA 128,44,96
RD 8,23,39168
MAA 128,64,100
buffer_load_dword v22, s[16:19], s52 offen offset:2048 sc1 lds
MAA 132,68,100
RD 12,23,40192
s_add_u32 s52, s52, 131072
MAA 132,48,96
RD 16,24,38912
MAA 136,52,96
MAA 136,72,100
s_waitcnt vmcnt(16) lgkmcnt(5)
s_barrier
MAA 76,104,40
RD 20,23,46080
s_add_u32 m0, s56, 92416
MAA 76,108,60
buffer_load_dwordx4 v18, s[20:23], s54 offen lds
MAA 80,108,64
RD 24,23,47104
MAA 80,104,44
RD 28,23,48384
MAA 84,104,48
RD 32,23,49408
MAA 84,108,68
buffer_load_dwordx4 v19, s[20:23], s54 offen offset:1024 lds
MAA 88,108,72
RD 36,24,48128
MAA 88,104,52
TR 80,25,49664
MAA 160,112,56
TR 82,25,50176
MAA 160,116,76
buffer_load_dwordx4 v20, s[20:23], s54 offen offset:2048 lds
MAA 120,116,72
TR 84,25,62080
s_add_u32 s54, s54, 196608
MAA 120,112,52
TR 86,25,62592
MAA 116,112,48
s_add_u32 m0, s55, 27648
MAA 116,116,68
buffer_load_dwordx4 v21, s[16:19], s52 offen sc1 lds
MAA 112,116,64
TR 88,25,50688
MAA 112,112,44
TR 90,25,51200
MAA 108,112,40
TR 92,25,63104
MAA 108,116,60
buffer_load_dwordx4 v21, s[16:19], s52 offen offset:1024 sc1 lds
MAA 140,60,124
TR 94,25,63616
MAA 140,40,120
TR 96,25,51712
MAA 144,44,120
TR 98,25,52224
MAA 144,64,124
buffer_load_dword v22, s[16:19], s52 offen offset:2048 sc1 lds
MAA 148,68,124
TR 100,25,64128
s_add_u32 s52, s52, 131072
MAA 148,48,120
TR 102,25,64640
MAA 152,52,120
s_add_u32 s15, s15, 1
MAA 152,72,124
s_cbranch_scc0 .Lk57
s_waitcnt vmcnt(19) lgkmcnt(8)
s_barrier
MAA 60,80,0
TR 104,25,49696
s_add_u32 m0, s56, 104832
MAA 60,84,20
buffer_load_dwordx4 v18, s[20:23], s54 offen lds
MAA 64,84,24
TR 106,25,50208
v_add_f32 v164, v164, v168
MAA 64,80,4
TR 108,25,62112
v_add_f32 v165, v165, v169
MAA 68,80,8
TR 110,25,62624
v_add_f32 v166, v166, v170
MAA 68,84,28
buffer_load_dwordx4 v19, s[20:23], s54 offen offset:1024 lds
MAA 72,84,32
TR 112,25,50720
v_add_f32 v167, v167, v171
MAA 72,80,12
TR 114,25,51232
s_waitcnt lgkmcnt(6)
MAA 156,88,16
TR 116,25,63136
MAA 156,92,36
buffer_load_dwordx4 v20, s[20:23], s54 offen offset:2048 lds
MAA 104,92,32
TR 118,25,63648
s_add_u32 s54, s54, 196608
MAA 104,88,12
TR 120,25,51744
s_add_u32 m0, s55, 36864
MAA 100,88,8
TR 122,25,52256
MAA 100,92,28
buffer_load_dwordx4 v21, s[16:19], s52 offen sc1 lds
MAA 96,92,24
TR 124,25,64160
MAA 96,88,4
TR 126,25,64672
MAA 92,88,0
ds_read_b128 a[40:43], v23
MAA 92,92,20
buffer_load_dwordx4 v21, s[16:19], s52 offen offset:1024 sc1 lds
MAA 124,20,100
RD 44,23,1024
MAA 124,0,96
RD 48,23,2304
MAA 128,4,96
RD 52,23,3328
MAA 128,24,100
buffer_load_dword v22, s[16:19], s52 offen offset:2048 sc1 lds
MAA 132,28,100
RD 56,24,2048
s_add_u32 s52, s52, 131072
MAA 132,8,96
MAA 136,12,96
MAA 136,32,100
s_waitcnt vmcnt(15) lgkmcnt(5)
s_barrier
MAA 76,104,0
RD 60,23,9216
s_add_u32 m0, s56, 117248
MAA 76,108,20
buffer_load_dwordx4 v18, s[20:23], s54 offen lds
MAA 80,108,24
RD 64,23,10240
v_add_f32 v164, v164, v172
MAA 80,104,4
RD 68,23,11520
v_add_f32 v165, v165, v173
MAA 84,104,8
RD 72,23,12544
v_add_f32 v166, v166, v174
MAA 84,108,28
buffer_load_dwordx4 v19, s[20:23], s54 offen offset:1024 lds
MAA 88,108,32
RD 76,24,11264
v_add_f32 v167, v167, v175
MAA 88,104,12
ds_read_b64_tr_b16 a[80:81], v25
MAA 160,112,16
TR 82,25,512
MAA 160,116,36
buffer_load_dwordx4 v20, s[20:23], s54 offen offset:2048 lds
MAA 120,116,32
TR 84,25,12416
s_add_u32 s54, s54, 196608
MAA 120,112,12
TR 86,25,12928
s_add_u32 m0, s55, 46080
MAA 116,112,8
TR 88,25,1024
MAA 116,116,28
buffer_load_dwordx4 v21, s[16:19], s52 offen sc1 lds
MAA 112,116,24
TR 90,25,1536
MAA 112,112,4
TR 92,25,13440
MAA 108,112,0
TR 94,25,13952
MAA 108,116,20
buffer_load_dwordx4 v21, s[16:19], s52 offen offset:1024 sc1 lds
.Lpad24:
s_cbranch_execz .Lpad27
MAA 140,20,124
TR 96,25,2048
MAA 140,0,120
TR 98,25,2560
MAA 144,4,120
TR 100,25,14464
MAA 144,24,124
buffer_load_dword v22, s[16:19], s52 offen offset:2048 sc1 lds
MAA 148,28,124
TR 102,25,14976
s_add_u32 s52, s52, 131072
MAA 148,8,120
v_permlane32_swap_b32 v164, v166
MAA 152,12,120
v_permlane32_swap_b32 v165, v167
MAA 152,32,124
s_waitcnt vmcnt(18) lgkmcnt(8)
s_barrier
MAA 60,80,40
TR 104,25,32
s_add_u32 m0, s56, 129664
MAA 60,84,60
buffer_load_dwordx4 v18, s[20:23], s54 offen lds
MAA 64,84,64
TR 106,25,544
v_add_f32 v164, v164, v166
MAA 64,80,44
TR 108,25,12448
v_add_f32 v165, v165, v167
MAA 68,80,48
buffer_load_dwordx4 v19, s[20:23], s54 offen offset:1024 lds
MAA 68,84,68
TR 110,25,12960
v_mul_f32 v164, 0xba800000, v164
MAA 72,84,72
TR 112,25,1056
v_mul_f32 v165, 0x3a800000, v165
MAA 72,80,52
buffer_load_dwordx4 v20, s[20:23], s54 offen offset:2048 lds
s_waitcnt lgkmcnt(5)
MAA 156,88,56
TR 114,25,1568
s_add_u32 s54, s54, 196608
MAA 156,92,76
TR 116,25,13472
s_add_u32 m0, s59, 58240
MAA 104,92,72
TR 118,25,13984
s_xor_b32 s58, s87, 1966080
MAA 104,88,52
buffer_load_dwordx4 v5, s[24:27], s58 offen lds
MAA 100,88,48
TR 120,25,2080
v_fma_f32 v165, -v164, v164, v165
MAA 100,92,68
TR 122,25,2592
v_max_f32 v165, 0, v165
MAA 96,92,64
buffer_load_dwordx4 v6, s[24:27], s58 offen offset:1024 lds
MAA 96,88,44
TR 124,25,14496
s_add_u32 m0, s59, 0
MAA 92,88,40
TR 126,25,15008
s_xor_b32 s58, s87, 1048576
MAA 92,92,60
buffer_load_dwordx4 v5, s[24:27], s58 offen lds
MAA 124,60,100
RD 0,23,18432
v_add_f32 v165, 0x3727c5ac, v165
MAA 124,40,96
RD 4,23,19456
MAA 128,44,96
buffer_load_dwordx4 v6, s[24:27], s58 offen offset:1024 lds
MAA 128,64,100
RD 8,23,20736
MAA 132,68,100
RD 12,23,21760
MAA 132,48,96
RD 16,24,20480
MAA 136,52,96
v_rsq_f32 v166, v165
MAA 136,72,100
v_mov_b32 v165, v166
v_mul_f32 v166, 0x3e8293ee, v166
ds_write_b128 v7, v[164:167]
s_waitcnt vmcnt(16) lgkmcnt(6)
s_barrier
MAA 76,104,40
ds_write_b32 v17, v164
s_add_u32 m0, s59, 8320
MAA 76,108,60
ds_write_b32 v17, v165 offset:1024
s_xor_b32 s58, s87, 1179648
MAA 80,108,64
buffer_load_dwordx4 v5, s[24:27], s58 offen lds
MAA 80,104,44
RD 20,23,27648
MAA 84,104,48
RD 24,23,28672
MAA 84,108,68
RD 28,23,29952
MAA 88,108,72
buffer_load_dwordx4 v6, s[24:27], s58 offen offset:1024 lds
MAA 88,104,52
RD 32,23,30976
s_add_u32 m0, s59, 66560
MAA 160,112,56
RD 36,24,29696
s_xor_b32 s58, s87, 0
MAA 160,116,76
TR 80,25,24832
MAA 120,116,72
buffer_load_dwordx4 v5, s[24:27], s58 offen lds
MAA 120,112,52
TR 82,25,25344
MAA 116,112,48
TR 84,25,37248
MAA 116,116,68
TR 86,25,37760
MAA 112,116,64
buffer_load_dwordx4 v6, s[24:27], s58 offen offset:1024 lds
MAA 112,112,44
TR 88,25,25856
s_add_u32 m0, s59, 74880
MAA 108,112,40
TR 90,25,26368
s_xor_b32 s58, s87, 131072
MAA 108,116,60
TR 92,25,38272
MAA 140,60,124
buffer_load_dwordx4 v5, s[24:27], s58 offen lds
MAA 140,40,120
TR 94,25,38784
MAA 144,44,120
TR 96,25,26880
MAA 144,64,124
TR 98,25,27392
MAA 148,68,124
buffer_load_dwordx4 v6, s[24:27], s58 offen offset:1024 lds
MAA 148,48,120
TR 100,25,39296
MAA 152,52,120
TR 102,25,39808
MAA 152,72,124
s_waitcnt vmcnt(10) lgkmcnt(0)
s_barrier
MAA 156,88,16
TR 112,25,25888
s_add_u32 m0, s59, 83200
MAA 156,92,36
TR 114,25,26400
s_xor_b32 s58, s87, 262144
MAA 104,92,32
buffer_load_dwordx4 v5, s[24:27], s58 offen lds
MAA 104,88,12
TR 116,25,38304
MAA 100,88,8
TR 118,25,38816
MAA 100,92,28
TR 120,25,26912
MAA 96,92,24
buffer_load_dwordx4 v6, s[24:27], s58 offen offset:1024 lds
MAA 96,88,4
TR 122,25,27424
s_add_u32 m0, s59, 16640
MAA 92,88,0
TR 124,25,39328
s_xor_b32 s58, s87, 1310720
MAA 92,92,20
TR 126,25,39840
MAA 136,32,100
buffer_load_dwordx4 v5, s[24:27], s58 offen lds
MAA 136,12,96
TR 104,25,24864
MAA 72,80,12
TR 106,25,25376
MAA 72,84,32
TR 108,25,37280
MAA 68,84,28
buffer_load_dwordx4 v6, s[24:27], s58 offen offset:1024 lds
MAA 68,80,8
TR 110,25,37792
s_add_u32 m0, s59, 24960
MAA 64,80,4
RD 40,23,36864
s_xor_b32 s58, s87, 1441792
MAA 64,84,24
RD 44,23,37888
MAA 60,84,20
buffer_load_dwordx4 v5, s[24:27], s58 offen lds
MAA 60,80,0
RD 48,23,39168
s_waitcnt lgkmcnt(13)
MAA 160,112,16
RD 52,23,40192
s_waitcnt lgkmcnt(12)
MAA 160,116,36
RD 56,24,38912
MAA 120,116,32
buffer_load_dwordx4 v6, s[24:27], s58 offen offset:1024 lds
MAA 120,112,12
s_waitcnt lgkmcnt(5)
s_barrier
RD 60,23,46080
MAA 116,112,8
RD 64,23,47104
s_add_u32 m0, s59, 91520
MAA 116,116,28
RD 68,23,48384
s_xor_b32 s58, s87, 393216
MAA 112,116,24
RD 72,23,49408
MAA 112,112,4
RD 76,24,48128
MAA 108,112,0
TR 144,25,50688
MAA 108,116,20
TR 146,25,51200
MAA 152,32,124
TR 148,25,63104
MAA 152,12,120
TR 150,25,63616
MAA 88,104,12
TR 152,25,50720
MAA 88,108,32
TR 154,25,51232
MAA 84,108,28
TR 156,25,63136
MAA 84,104,8
TR 158,25,63648
MAA 80,104,4
TR 160,25,51712
MAA 80,108,24
TR 162,25,52224
MAA 76,108,20
TR 164,25,64128
MAA 76,104,0
TR 166,25,64640
s_waitcnt lgkmcnt(10)
MAA 156,144,56
TR 168,25,51744
s_waitcnt lgkmcnt(9)
MAA 156,148,76
TR 170,25,52256
MAA 104,148,72
TR 172,25,64160
MAA 104,144,52
TR 174,25,64672
MAA 100,144,48
TR 128,25,49664
MAA 100,148,68
TR 130,25,50176
MAA 96,148,64
TR 132,25,62080
MAA 96,144,44
TR 134,25,62592
MAA 92,144,40
TR 136,25,49696
MAA 92,148,60
TR 138,25,50208
s_waitcnt lgkmcnt(14)
MAA 160,156,76
TR 140,25,62112
MAA 160,152,56
TR 142,25,62624
MAA 120,152,52
ds_read_b128 v[232:235], v10 offset:768
MAA 120,156,72
ds_read_b128 v[236:239], v10 offset:2816
MAA 116,156,68
ds_read_b128 v[228:231], v10 offset:512
MAA 116,152,48
ds_read_b128 v[224:227], v10 offset:256
MAA 112,152,44
ds_read_b128 v[220:223], v10
MAA 112,156,64
buffer_load_dwordx4 v5, s[24:27], s58 offen lds
MAA 108,156,60
ds_read_b128 v[240:243], v11 offset:192
MAA 108,152,40
s_waitcnt lgkmcnt(6)
s_barrier
ds_read_b128 v[244:247], v11 offset:1216
MAA 136,52,160
ds_read_b128 v[18:21], v11 offset:128
MAA 136,72,164
buffer_load_dwordx4 v6, s[24:27], s58 offen offset:1024 lds
MAA 152,72,172
ds_read_b128 v[22:25], v11 offset:1152
s_add_u32 m0, s59, 99840
MAA 152,52,168
s_xor_b32 s58, s87, 524288
MAA 72,128,52
MAA 72,132,72
buffer_load_dwordx4 v5, s[24:27], s58 offen lds
MAA 68,132,68
MAA 68,128,48
MAA 64,128,44
MAA 64,132,64
buffer_load_dwordx4 v6, s[24:27], s58 offen offset:1024 lds
MAA 60,132,60
s_add_u32 m0, s59, 108160
s_xor_b32 s58, s87, 655360
MAA 60,128,40
MAA 88,136,52
MAA 88,140,72
buffer_load_dwordx4 v5, s[24:27], s58 offen lds
MAA 84,140,68
MAA 84,136,48
MAA 80,136,44
MAA 80,140,64
buffer_load_dwordx4 v6, s[24:27], s58 offen offset:1024 lds
MAA 76,140,60
s_add_u32 m0, s59, 33280
s_xor_b32 s58, s87, 1572864
MAA 76,136,40
s_waitcnt lgkmcnt(8)
v_pk_fma_f32 v[104:105], v[36:37], v[232:233], v[104:105] op_sel_hi:[1,0,1]
v_pk_mul_f32 v[104:105], v[104:105], v[232:233] op_sel:[0,1] op_sel_hi:[1,1]
v_cvt_pk_bf16_f32 v196, v104, v105
v_pk_fma_f32 v[106:107], v[38:39], v[232:233], v[106:107] op_sel_hi:[1,0,1]
v_pk_mul_f32 v[106:107], v[106:107], v[232:233] op_sel:[0,1] op_sel_hi:[1,1]
v_cvt_pk_bf16_f32 v197, v106, v107
v_pk_fma_f32 v[120:121], v[40:41], v[232:233], v[120:121] op_sel_hi:[1,0,1]
v_pk_mul_f32 v[120:121], v[120:121], v[232:233] op_sel:[0,1] op_sel_hi:[1,1]
v_cvt_pk_bf16_f32 v198, v120, v121
v_pk_fma_f32 v[122:123], v[42:43], v[232:233], v[122:123] op_sel_hi:[1,0,1]
v_pk_mul_f32 v[122:123], v[122:123], v[232:233] op_sel:[0,1] op_sel_hi:[1,1]
v_cvt_pk_bf16_f32 v199, v122, v123
s_waitcnt lgkmcnt(3)
v_pk_fma_f32 v[136:137], v[240:241], v[44:45], v[136:137] op_sel_hi:[1,0,1]
s_waitcnt lgkmcnt(2)
v_pk_mul_f32 v[136:137], v[136:137], v[244:245]
v_cvt_pk_bf16_f32 v208, v136, v137
v_pk_fma_f32 v[138:139], v[242:243], v[44:45], v[138:139] op_sel_hi:[1,0,1]
v_pk_mul_f32 v[138:139], v[138:139], v[246:247]
v_cvt_pk_bf16_f32 v209, v138, v139
v_pk_fma_f32 v[152:153], v[240:241], v[44:45], v[152:153] op_sel:[0,1,0] op_sel_hi:[1,1,1]
v_pk_mul_f32 v[152:153], v[152:153], v[244:245]
v_cvt_pk_bf16_f32 v218, v152, v153
v_pk_fma_f32 v[154:155], v[242:243], v[44:45], v[154:155] op_sel:[0,1,0] op_sel_hi:[1,1,1]
v_pk_mul_f32 v[154:155], v[154:155], v[246:247]
v_cvt_pk_bf16_f32 v219, v154, v155
ds_write_b128 v8, v[196:199]
ds_write_b64 v8, v[208:209] offset:1024
ds_write_b64 v8, v[218:219] offset:1032
v_pk_fma_f32 v[156:157], v[36:37], v[236:237], v[156:157] op_sel_hi:[1,0,1]
v_pk_mul_f32 v[156:157], v[156:157], v[236:237] op_sel:[0,1] op_sel_hi:[1,1]
v_cvt_pk_bf16_f32 v180, v156, v157
v_pk_fma_f32 v[158:159], v[38:39], v[236:237], v[158:159] op_sel_hi:[1,0,1]
v_pk_mul_f32 v[158:159], v[158:159], v[236:237] op_sel:[0,1] op_sel_hi:[1,1]
v_cvt_pk_bf16_f32 v181, v158, v159
v_pk_fma_f32 v[160:161], v[40:41], v[236:237], v[160:161] op_sel_hi:[1,0,1]
v_pk_mul_f32 v[160:161], v[160:161], v[236:237] op_sel:[0,1] op_sel_hi:[1,1]
v_cvt_pk_bf16_f32 v182, v160, v161
v_pk_fma_f32 v[162:163], v[42:43], v[236:237], v[162:163] op_sel_hi:[1,0,1]
v_pk_mul_f32 v[162:163], v[162:163], v[236:237] op_sel:[0,1] op_sel_hi:[1,1]
v_cvt_pk_bf16_f32 v183, v162, v163
v_pk_fma_f32 v[100:101], v[36:37], v[228:229], v[100:101] op_sel_hi:[1,0,1]
v_pk_mul_f32 v[100:101], v[100:101], v[228:229] op_sel:[0,1] op_sel_hi:[1,1]
v_cvt_pk_bf16_f32 v192, v100, v101
v_pk_fma_f32 v[102:103], v[38:39], v[228:229], v[102:103] op_sel_hi:[1,0,1]
v_pk_mul_f32 v[102:103], v[102:103], v[228:229] op_sel:[0,1] op_sel_hi:[1,1]
v_cvt_pk_bf16_f32 v193, v102, v103
v_pk_fma_f32 v[116:117], v[40:41], v[228:229], v[116:117] op_sel_hi:[1,0,1]
v_pk_mul_f32 v[116:117], v[116:117], v[228:229] op_sel:[0,1] op_sel_hi:[1,1]
v_cvt_pk_bf16_f32 v194, v116, v117
v_pk_fma_f32 v[118:119], v[42:43], v[228:229], v[118:119] op_sel_hi:[1,0,1]
v_pk_mul_f32 v[118:119], v[118:119], v[228:229] op_sel:[0,1] op_sel_hi:[1,1]
s_waitcnt lgkmcnt(0)
s_barrier
v_cvt_pk_bf16_f32 v195, v118, v119
v_pk_fma_f32 v[96:97], v[36:37], v[224:225], v[96:97] op_sel_hi:[1,0,1]
v_pk_mul_f32 v[96:97], v[96:97], v[224:225] op_sel:[0,1] op_sel_hi:[1,1]
v_cvt_pk_bf16_f32 v188, v96, v97
v_pk_fma_f32 v[98:99], v[38:39], v[224:225], v[98:99] op_sel_hi:[1,0,1]
v_pk_mul_f32 v[98:99], v[98:99], v[224:225] op_sel:[0,1] op_sel_hi:[1,1]
v_cvt_pk_bf16_f32 v189, v98, v99
v_pk_fma_f32 v[112:113], v[40:41], v[224:225], v[112:113] op_sel_hi:[1,0,1]
v_pk_mul_f32 v[112:113], v[112:113], v[224:225] op_sel:[0,1] op_sel_hi:[1,1]
v_cvt_pk_bf16_f32 v190, v112, v113
v_pk_fma_f32 v[114:115], v[42:43], v[224:225], v[114:115] op_sel_hi:[1,0,1]
v_pk_mul_f32 v[114:115], v[114:115], v[224:225] op_sel:[0,1] op_sel_hi:[1,1]
v_cvt_pk_bf16_f32 v191, v114, v115
v_pk_fma_f32 v[92:93], v[36:37], v[220:221], v[92:93] op_sel_hi:[1,0,1]
v_pk_mul_f32 v[92:93], v[92:93], v[220:221] op_sel:[0,1] op_sel_hi:[1,1]
v_cvt_pk_bf16_f32 v184, v92, v93
v_pk_fma_f32 v[94:95], v[38:39], v[220:221], v[94:95] op_sel_hi:[1,0,1]
v_pk_mul_f32 v[94:95], v[94:95], v[220:221] op_sel:[0,1] op_sel_hi:[1,1]
v_cvt_pk_bf16_f32 v185, v94, v95
v_pk_fma_f32 v[108:109], v[40:41], v[220:221], v[108:109] op_sel_hi:[1,0,1]
v_pk_mul_f32 v[108:109], v[108:109], v[220:221] op_sel:[0,1] op_sel_hi:[1,1]
v_cvt_pk_bf16_f32 v186, v108, v109
v_pk_fma_f32 v[110:111], v[42:43], v[220:221], v[110:111] op_sel_hi:[1,0,1]
v_pk_mul_f32 v[110:111], v[110:111], v[220:221] op_sel:[0,1] op_sel_hi:[1,1]
v_cvt_pk_bf16_f32 v187, v110, v111
v_pk_fma_f32 v[72:73], v[28:29], v[232:233], v[72:73] op_sel_hi:[1,0,1]
v_cvt_pk_bf16_f32 v176, v72, v73
v_pk_fma_f32 v[74:75], v[30:31], v[232:233], v[74:75] op_sel_hi:[1,0,1]
v_cvt_pk_bf16_f32 v177, v74, v75
v_pk_fma_f32 v[88:89], v[32:33], v[232:233], v[88:89] op_sel_hi:[1,0,1]
v_cvt_pk_bf16_f32 v178, v88, v89
v_pk_fma_f32 v[90:91], v[34:35], v[232:233], v[90:91] op_sel_hi:[1,0,1]
v_cvt_pk_bf16_f32 v179, v90, v91
v_pk_fma_f32 v[68:69], v[28:29], v[228:229], v[68:69] op_sel_hi:[1,0,1]
v_cvt_pk_bf16_f32 v172, v68, v69
v_pk_fma_f32 v[70:71], v[30:31], v[228:229], v[70:71] op_sel_hi:[1,0,1]
v_cvt_pk_bf16_f32 v173, v70, v71
v_pk_fma_f32 v[84:85], v[32:33], v[228:229], v[84:85] op_sel_hi:[1,0,1]
v_cvt_pk_bf16_f32 v174, v84, v85
v_pk_fma_f32 v[86:87], v[34:35], v[228:229], v[86:87] op_sel_hi:[1,0,1]
v_cvt_pk_bf16_f32 v175, v86, v87
v_pk_fma_f32 v[64:65], v[28:29], v[224:225], v[64:65] op_sel_hi:[1,0,1]
v_cvt_pk_bf16_f32 v168, v64, v65
v_pk_fma_f32 v[66:67], v[30:31], v[224:225], v[66:67] op_sel_hi:[1,0,1]
v_cvt_pk_bf16_f32 v169, v66, v67
v_pk_fma_f32 v[80:81], v[32:33], v[224:225], v[80:81] op_sel_hi:[1,0,1]
v_cvt_pk_bf16_f32 v170, v80, v81
v_pk_fma_f32 v[82:83], v[34:35], v[224:225], v[82:83] op_sel_hi:[1,0,1]
v_cvt_pk_bf16_f32 v171, v82, v83
v_pk_fma_f32 v[60:61], v[28:29], v[220:221], v[60:61] op_sel_hi:[1,0,1]
v_cvt_pk_bf16_f32 v164, v60, v61
v_pk_fma_f32 v[62:63], v[30:31], v[220:221], v[62:63] op_sel_hi:[1,0,1]
v_cvt_pk_bf16_f32 v165, v62, v63
v_pk_fma_f32 v[76:77], v[32:33], v[220:221], v[76:77] op_sel_hi:[1,0,1]
v_cvt_pk_bf16_f32 v166, v76, v77
v_pk_fma_f32 v[78:79], v[34:35], v[220:221], v[78:79] op_sel_hi:[1,0,1]
v_cvt_pk_bf16_f32 v167, v78, v79
s_nop 0
v_mfma_f32_16x16x32_bf16 v[120:123], v[196:199], v[176:179], v[50:53]
buffer_load_dwordx4 v5, s[24:27], s58 offen lds
v_mfma_f32_16x16x32_bf16 v[104:107], v[192:195], v[176:179], v[46:49]
ds_read_b64 v[200:201], v9 offset:1024
v_mfma_f32_16x16x32_bf16 v[116:119], v[192:195], v[172:175], v[50:53]
ds_read_b64 v[210:211], v9 offset:1032
v_mfma_f32_16x16x32_bf16 v[100:103], v[188:191], v[172:175], v[46:49]
ds_read_b128 v[240:243], v11 offset:64
v_mfma_f32_16x16x32_bf16 v[112:115], v[188:191], v[168:171], v[50:53]
buffer_load_dwordx4 v6, s[24:27], s58 offen offset:1024 lds
v_mfma_f32_16x16x32_bf16 v[96:99], v[184:187], v[168:171], v[46:49]
ds_read_b128 v[244:247], v11 offset:1088
s_add_u32 m0, s59, 41600
v_mfma_f32_16x16x32_bf16 v[108:111], v[184:187], v[164:167], v[50:53]
ds_read_b128 v[28:31], v11
s_xor_b32 s58, s87, 1703936
v_mfma_f32_16x16x32_bf16 v[92:95], v[180:183], v[164:167], v[54:57]
ds_read_b128 v[32:35], v11 offset:1024
v_max3_f32 v88, v104, v105, v106
MAA 132,8,96
buffer_load_dwordx4 v5, s[24:27], s58 offen lds
MAA 132,28,100
v_max3_f32 v89, v107, v120, v121
v_max3_f32 v88, v88, v122, v123
MAA 132,48,160
v_max_f32 v90, v88, v89
v_max_f32 v89, v88, v89
MAA 132,68,164
s_nop 0
v_permlane16_swap_b32 v90, v89
MAA 148,68,172
buffer_load_dwordx4 v6, s[24:27], s58 offen offset:1024 lds
MAA 148,48,168
s_add_u32 m0, s59, 49920
s_xor_b32 s58, s87, 1835008
v_max_f32 v88, v90, v89
MAA 148,28,124
v_max_f32 v89, v90, v89
v_max3_f32 v84, v100, v101, v102
MAA 148,8,120
v_permlane32_swap_b32 v88, v89
v_max3_f32 v85, v103, v116, v117
v_max_f32 v88, v88, v89
v_mul_f32 v88, v88, v234
v_max3_f32 v84, v84, v118, v119
v_max_f32 v86, v84, v85
v_max_f32 v85, v84, v85
v_max3_f32 v80, v96, v97, v98
v_max3_f32 v81, v99, v112, v113
v_permlane16_swap_b32 v86, v85
v_max3_f32 v80, v80, v114, v115
v_max_f32 v84, v86, v85
v_max_f32 v85, v86, v85
v_max_f32 v82, v80, v81
v_max_f32 v81, v80, v81
v_permlane32_swap_b32 v84, v85
v_max3_f32 v76, v92, v93, v94
v_max_f32 v84, v84, v85
v_mul_f32 v84, v84, v230
v_permlane16_swap_b32 v82, v81
v_max3_f32 v77, v95, v108, v109
v_max_f32 v80, v82, v81
v_max_f32 v81, v82, v81
v_max3_f32 v76, v76, v110, v111
v_max_f32 v78, v76, v77
v_permlane32_swap_b32 v80, v81
v_max_f32 v77, v76, v77
v_max_f32 v80, v80, v81
v_mul_f32 v80, v80, v226
v_permlane16_swap_b32 v78, v77
v_pk_fma_f32 v[104:105], v[104:105], v[234:235], v[88:89] op_sel_hi:[1,0,0] neg_lo:[0,0,1] neg_hi:[0,0,1]
v_max_f32 v76, v78, v77
v_max_f32 v77, v78, v77
v_pk_fma_f32 v[106:107], v[106:107], v[234:235], v[88:89] op_sel_hi:[1,0,0] neg_lo:[0,0,1] neg_hi:[0,0,1]
v_pk_fma_f32 v[120:121], v[120:121], v[234:235], v[88:89] op_sel_hi:[1,0,0] neg_lo:[0,0,1] neg_hi:[0,0,1]
v_permlane32_swap_b32 v76, v77
v_pk_fma_f32 v[122:123], v[122:123], v[234:235], v[88:89] op_sel_hi:[1,0,0] neg_lo:[0,0,1] neg_hi:[0,0,1]
v_max_f32 v76, v76, v77
v_mul_f32 v76, v76, v222
v_pk_fma_f32 v[100:101], v[100:101], v[230:231], v[84:85] op_sel_hi:[1,0,0] neg_lo:[0,0,1] neg_hi:[0,0,1]
v_pk_fma_f32 v[102:103], v[102:103], v[230:231], v[84:85] op_sel_hi:[1,0,0] neg_lo:[0,0,1] neg_hi:[0,0,1]
v_pk_fma_f32 v[116:117], v[116:117], v[230:231], v[84:85] op_sel_hi:[1,0,0] neg_lo:[0,0,1] neg_hi:[0,0,1]
v_pk_fma_f32 v[118:119], v[118:119], v[230:231], v[84:85] op_sel_hi:[1,0,0] neg_lo:[0,0,1] neg_hi:[0,0,1]
v_pk_fma_f32 v[96:97], v[96:97], v[226:227], v[80:81] op_sel_hi:[1,0,0] neg_lo:[0,0,1] neg_hi:[0,0,1]
v_pk_fma_f32 v[98:99], v[98:99], v[226:227], v[80:81] op_sel_hi:[1,0,0] neg_lo:[0,0,1] neg_hi:[0,0,1]
v_pk_fma_f32 v[112:113], v[112:113], v[226:227], v[80:81] op_sel_hi:[1,0,0] neg_lo:[0,0,1] neg_hi:[0,0,1]
v_pk_fma_f32 v[114:115], v[114:115], v[226:227], v[80:81] op_sel_hi:[1,0,0] neg_lo:[0,0,1] neg_hi:[0,0,1]
v_pk_fma_f32 v[92:93], v[92:93], v[222:223], v[76:77] op_sel_hi:[1,0,0] neg_lo:[0,0,1] neg_hi:[0,0,1]
v_pk_fma_f32 v[94:95], v[94:95], v[222:223], v[76:77] op_sel_hi:[1,0,0] neg_lo:[0,0,1] neg_hi:[0,0,1]
v_pk_fma_f32 v[108:109], v[108:109], v[222:223], v[76:77] op_sel_hi:[1,0,0] neg_lo:[0,0,1] neg_hi:[0,0,1]
v_pk_fma_f32 v[110:111], v[110:111], v[222:223], v[76:77] op_sel_hi:[1,0,0] neg_lo:[0,0,1] neg_hi:[0,0,1]
v_pk_fma_f32 v[132:133], v[18:19], v[44:45], v[132:133] op_sel_hi:[1,0,1]
v_pk_mul_f32 v[132:133], v[132:133], v[22:23]
v_pk_fma_f32 v[134:135], v[20:21], v[44:45], v[134:135] op_sel_hi:[1,0,1]
v_pk_mul_f32 v[134:135], v[134:135], v[24:25]
v_pk_fma_f32 v[148:149], v[18:19], v[44:45], v[148:149] op_sel:[0,1,0] op_sel_hi:[1,1,1]
v_pk_mul_f32 v[148:149], v[148:149], v[22:23]
v_pk_fma_f32 v[150:151], v[20:21], v[44:45], v[150:151] op_sel:[0,1,0] op_sel_hi:[1,1,1]
v_pk_mul_f32 v[150:151], v[150:151], v[24:25]
v_exp_f32 v104, v104
s_nop 0
MAA 128,4,96
buffer_load_dwordx4 v5, s[24:27], s58 offen lds
MAA 128,24,100
v_exp_f32 v105, v105
MAA 128,44,160
v_exp_f32 v106, v106
MAA 128,64,164
v_exp_f32 v107, v107
MAA 144,64,172
buffer_load_dwordx4 v6, s[24:27], s58 offen offset:1024 lds
MAA 144,44,168
s_add_u32 m0, s59, 116480
s_xor_b32 s58, s87, 786432
v_exp_f32 v120, v120
MAA 144,24,124
v_exp_f32 v121, v121
.Lpad25:
s_cbranch_execz .Lpad28
MAA 144,4,120
v_exp_f32 v122, v122
MAA 124,0,96
buffer_load_dwordx4 v5, s[24:27], s58 offen lds
MAA 124,20,100
v_exp_f32 v123, v123
MAA 124,40,160
v_exp_f32 v100, v100
MAA 124,60,164
v_exp_f32 v101, v101
MAA 140,60,172
buffer_load_dwordx4 v6, s[24:27], s58 offen offset:1024 lds
MAA 140,40,168
s_add_u32 m0, s59, 124800
s_xor_b32 s58, s87, 917504
v_exp_f32 v102, v102
MAA 140,20,124
v_exp_f32 v103, v103
MAA 140,0,120
v_cvt_pk_bf16_f32 v72, v104, v105
v_cvt_pk_bf16_f32 v73, v106, v107
v_cvt_pk_bf16_f32 v74, v120, v121
v_cvt_pk_bf16_f32 v75, v122, v123
v_exp_f32 v116, v116
v_exp_f32 v117, v117
v_exp_f32 v118, v118
v_exp_f32 v119, v119
v_cvt_pk_bf16_f32 v68, v100, v101
v_cvt_pk_bf16_f32 v69, v102, v103
v_cvt_pk_bf16_f32 v70, v116, v117
v_cvt_pk_bf16_f32 v71, v118, v119
v_exp_f32 v96, v96
v_exp_f32 v97, v97
v_exp_f32 v98, v98
v_exp_f32 v99, v99
v_exp_f32 v112, v112
v_exp_f32 v113, v113
v_exp_f32 v114, v114
v_exp_f32 v115, v115
v_cvt_pk_bf16_f32 v64, v96, v97
v_cvt_pk_bf16_f32 v65, v98, v99
v_cvt_pk_bf16_f32 v66, v112, v113
v_cvt_pk_bf16_f32 v67, v114, v115
v_cvt_pk_bf16_f32 v206, v132, v133
v_cvt_pk_bf16_f32 v207, v134, v135
v_cvt_pk_bf16_f32 v216, v148, v149
v_cvt_pk_bf16_f32 v217, v150, v151
s_waitcnt lgkmcnt(3)
v_pk_fma_f32 v[128:129], v[240:241], v[44:45], v[128:129] op_sel_hi:[1,0,1]
s_waitcnt lgkmcnt(2)
v_pk_mul_f32 v[128:129], v[128:129], v[244:245]
v_cvt_pk_bf16_f32 v204, v128, v129
v_pk_fma_f32 v[130:131], v[242:243], v[44:45], v[130:131] op_sel_hi:[1,0,1]
v_pk_mul_f32 v[130:131], v[130:131], v[246:247]
v_cvt_pk_bf16_f32 v205, v130, v131
v_pk_fma_f32 v[144:145], v[240:241], v[44:45], v[144:145] op_sel:[0,1,0] op_sel_hi:[1,1,1]
v_pk_mul_f32 v[144:145], v[144:145], v[244:245]
v_cvt_pk_bf16_f32 v214, v144, v145
v_pk_fma_f32 v[146:147], v[242:243], v[44:45], v[146:147] op_sel:[0,1,0] op_sel_hi:[1,1,1]
v_pk_mul_f32 v[146:147], v[146:147], v[246:247]
v_cvt_pk_bf16_f32 v215, v146, v147
s_waitcnt lgkmcnt(1)
v_pk_fma_f32 v[124:125], v[28:29], v[44:45], v[124:125] op_sel_hi:[1,0,1]
s_waitcnt lgkmcnt(0)
v_pk_mul_f32 v[124:125], v[124:125], v[32:33]
v_cvt_pk_bf16_f32 v202, v124, v125
v_pk_fma_f32 v[126:127], v[30:31], v[44:45], v[126:127] op_sel_hi:[1,0,1]
v_pk_mul_f32 v[126:127], v[126:127], v[34:35]
v_cvt_pk_bf16_f32 v203, v126, v127
v_pk_fma_f32 v[140:141], v[28:29], v[44:45], v[140:141] op_sel:[0,1,0] op_sel_hi:[1,1,1]
v_pk_mul_f32 v[140:141], v[140:141], v[32:33]
v_cvt_pk_bf16_f32 v212, v140, v141
v_pk_fma_f32 v[142:143], v[30:31], v[44:45], v[142:143] op_sel:[0,1,0] op_sel_hi:[1,1,1]
v_pk_mul_f32 v[142:143], v[142:143], v[34:35]
v_cvt_pk_bf16_f32 v213, v142, v143
s_nop 0
v_mfma_f32_16x16x32_bf16 v[88:91], v[248:251], v[72:75], 0
buffer_load_dwordx4 v5, s[24:27], s58 offen lds
v_mfma_f32_16x16x32_bf16 v[104:107], v[206:209], v[72:75], 0
v_exp_f32 v92, v92
v_mfma_f32_16x16x32_bf16 v[120:123], v[216:219], v[72:75], 0
v_exp_f32 v93, v93
v_mfma_f32_16x16x32_bf16 v[84:87], v[248:251], v[68:71], 0
v_exp_f32 v94, v94
v_mfma_f32_16x16x32_bf16 v[100:103], v[204:207], v[68:71], 0
buffer_load_dwordx4 v6, s[24:27], s58 offen offset:1024 lds
v_mfma_f32_16x16x32_bf16 v[116:119], v[214:217], v[68:71], 0
v_exp_f32 v95, v95
v_mfma_f32_16x16x32_bf16 v[80:83], v[248:251], v[64:67], 0
v_exp_f32 v108, v108
v_mfma_f32_16x16x32_bf16 v[96:99], v[202:205], v[64:67], 0
v_exp_f32 v109, v109
v_mfma_f32_16x16x32_bf16 v[112:115], v[212:215], v[64:67], 0
v_exp_f32 v110, v110
v_cvt_pk_bf16_f32 v60, v92, v93
v_cvt_pk_bf16_f32 v61, v94, v95
v_cvt_pk_bf16_f32 v62, v108, v109
v_rcp_f32 v88, v88
v_rcp_f32 v84, v84
v_rcp_f32 v80, v80
v_pk_mul_f32 v[104:105], v[104:105], v[88:89] op_sel_hi:[1,0]
v_pk_mul_f32 v[106:107], v[106:107], v[88:89] op_sel_hi:[1,0]
v_pk_mul_f32 v[120:121], v[120:121], v[88:89] op_sel_hi:[1,0]
v_pk_mul_f32 v[122:123], v[122:123], v[88:89] op_sel_hi:[1,0]
v_cvt_pk_bf16_f32 v176, v104, v105
v_cvt_pk_bf16_f32 v177, v106, v107
v_cvt_pk_bf16_f32 v178, v120, v121
v_cvt_pk_bf16_f32 v179, v122, v123
buffer_store_dwordx4 v[176:179], v4, s[16:19], s74 offen offset:3072 sc1
v_pk_mul_f32 v[100:101], v[100:101], v[84:85] op_sel_hi:[1,0]
v_pk_mul_f32 v[102:103], v[102:103], v[84:85] op_sel_hi:[1,0]
v_pk_mul_f32 v[116:117], v[116:117], v[84:85] op_sel_hi:[1,0]
v_pk_mul_f32 v[118:119], v[118:119], v[84:85] op_sel_hi:[1,0]
v_cvt_pk_bf16_f32 v172, v100, v101
v_cvt_pk_bf16_f32 v173, v102, v103
v_cvt_pk_bf16_f32 v174, v116, v117
v_cvt_pk_bf16_f32 v175, v118, v119
buffer_store_dwordx4 v[172:175], v4, s[16:19], s74 offen offset:2048 sc1
v_pk_mul_f32 v[96:97], v[96:97], v[80:81] op_sel_hi:[1,0]
v_pk_mul_f32 v[98:99], v[98:99], v[80:81] op_sel_hi:[1,0]
v_pk_mul_f32 v[112:113], v[112:113], v[80:81] op_sel_hi:[1,0]
v_pk_mul_f32 v[114:115], v[114:115], v[80:81] op_sel_hi:[1,0]
v_cvt_pk_bf16_f32 v168, v96, v97
v_cvt_pk_bf16_f32 v169, v98, v99
v_cvt_pk_bf16_f32 v170, v112, v113
v_cvt_pk_bf16_f32 v171, v114, v115
buffer_store_dwordx4 v[168:171], v4, s[16:19], s74 offen offset:1024 sc1
v_exp_f32 v111, v111
s_nop 0
v_cvt_pk_bf16_f32 v63, v110, v111
s_nop 1
v_mfma_f32_16x16x32_bf16 v[76:79], v[248:251], v[60:63], 0
v_mfma_f32_16x16x32_bf16 v[92:95], v[200:203], v[60:63], 0
v_mfma_f32_16x16x32_bf16 v[108:111], v[210:213], v[60:63], 0
s_nop 5
v_rcp_f32 v76, v76
s_nop 0
v_pk_mul_f32 v[92:93], v[92:93], v[76:77] op_sel_hi:[1,0]
v_cvt_pk_bf16_f32 v164, v92, v93
v_pk_mul_f32 v[94:95], v[94:95], v[76:77] op_sel_hi:[1,0]
v_cvt_pk_bf16_f32 v165, v94, v95
v_pk_mul_f32 v[108:109], v[108:109], v[76:77] op_sel_hi:[1,0]
v_cvt_pk_bf16_f32 v166, v108, v109
v_pk_mul_f32 v[110:111], v[110:111], v[76:77] op_sel_hi:[1,0]
v_cvt_pk_bf16_f32 v167, v110, v111
buffer_store_dwordx4 v[164:167], v4, s[16:19], s74 offen sc1
s_nop 1
s_branch .Lqkve56
.Lsp50:
s_mov_b32 s15, 0
.Lsp50l:
v_mov_b32 v25, 0
buffer_atomic_add v25, v22, s[16:19], s73 offen sc0
s_add_u32 s15, s15, 1
s_cmp_gt_u32 s15, 100000
s_waitcnt vmcnt(0)
s_cbranch_scc1 .Lsp50b
v_cmp_gt_u32 vcc, v23, v25
s_nop 0
s_cbranch_vccnz .Lsp50l
s_branch .Lsp50b
.p2align 12
.Lqkv55:
.Lpad26:
s_cbranch_execz .Lpad29
s_add_u32 m0, s55, 36864
s_nop 0
buffer_load_dwordx4 v21, s[16:19], s52 offen sc1 lds
buffer_load_dwordx4 v21, s[16:19], s52 offen offset:1024 sc1 lds
buffer_load_dword v22, s[16:19], s52 offen offset:2048 sc1 lds
s_add_u32 s52, s52, 131072
s_add_u32 m0, s55, 46080
s_nop 0
buffer_load_dwordx4 v21, s[16:19], s52 offen sc1 lds
buffer_load_dwordx4 v21, s[16:19], s52 offen offset:1024 sc1 lds
buffer_load_dword v22, s[16:19], s52 offen offset:2048 sc1 lds
s_add_u32 s52, s52, 131072
s_add_u32 m0, s55, 0
s_nop 0
buffer_load_dwordx4 v21, s[16:19], s52 offen sc1 lds
buffer_load_dwordx4 v21, s[16:19], s52 offen offset:1024 sc1 lds
buffer_load_dword v22, s[16:19], s52 offen offset:2048 sc1 lds
s_add_u32 s52, s52, 131072
s_add_u32 m0, s55, 9216
s_nop 0
buffer_load_dwordx4 v21, s[16:19], s52 offen sc1 lds
buffer_load_dwordx4 v21, s[16:19], s52 offen offset:1024 sc1 lds
buffer_load_dword v22, s[16:19], s52 offen offset:2048 sc1 lds
s_add_u32 s52, s52, 131072
s_add_u32 m0, s55, 18432
s_nop 0
buffer_load_dwordx4 v21, s[16:19], s52 offen sc1 lds
buffer_load_dwordx4 v21, s[16:19], s52 offen offset:1024 sc1 lds
buffer_load_dword v22, s[16:19], s52 offen offset:2048 sc1 lds
s_add_u32 s52, s52, 131072
s_add_u32 m0, s55, 27648
s_nop 0
buffer_load_dwordx4 v21, s[16:19], s52 offen sc1 lds
buffer_load_dwordx4 v21, s[16:19], s52 offen offset:1024 sc1 lds
buffer_load_dword v22, s[16:19], s52 offen offset:2048 sc1 lds
s_add_u32 s52, s52, 131072
s_waitcnt vmcnt(12)
s_barrier
RD 0,23,36864
RD 4,23,37888
RD 8,23,39168
RD 12,23,40192
RD 16,24,38912
RD 20,23,46080
RD 24,23,47104
RD 28,23,48384
RD 32,23,49408
RD 36,24,48128
s_waitcnt lgkmcnt(0)
s_mov_b32 s15, -2
.p2align 6
.Lk58:
s_waitcnt vmcnt(9) lgkmcnt(8)
s_barrier
MAA 60,80,0
TR 104,25,49696
s_add_u32 m0, s56, 104832
MAA 60,84,20
buffer_load_dwordx4 v18, s[20:23], s54 offen lds
MAA 64,84,24
TR 106,25,50208
v_add_f32 v164, v164, v168
MAA 64,80,4
TR 108,25,62112
MAA 68,80,8
TR 110,25,62624
MAA 68,84,28
buffer_load_dwordx4 v19, s[20:23], s54 offen offset:1024 lds
MAA 72,84,32
TR 112,25,50720
v_add_f32 v165, v165, v169
MAA 72,80,12
TR 114,25,51232
s_waitcnt lgkmcnt(6)
MAA 104,88,12
TR 116,25,63136
MAA 104,92,32
buffer_load_dwordx4 v20, s[20:23], s54 offen offset:2048 lds
MAA 100,92,28
s_add_u32 s54, s54, 196608
s_add_u32 m0, s55, 36864
MAA 100,88,8
buffer_load_dwordx4 v21, s[16:19], s52 offen sc1 lds
MAA 96,88,4
TR 118,25,63648
MAA 96,92,24
TR 120,25,51744
v_add_f32 v166, v166, v170
MAA 92,92,20
TR 122,25,52256
MAA 92,88,0
buffer_load_dwordx4 v21, s[16:19], s52 offen offset:1024 sc1 lds
MAA 124,0,96
TR 124,25,64160
MAA 124,20,100
TR 126,25,64672
v_add_f32 v167, v167, v171
MAA 128,24,100
ds_read_b128 a[40:43], v23
MAA 128,4,96
buffer_load_dword v22, s[16:19], s52 offen offset:2048 sc1 lds
MAA 132,8,96
RD 44,23,1024
s_add_u32 s52, s52, 131072
MAA 132,28,100
buffer_load_dword v27, v14, s[20:23], s44 offen
MAA 136,32,100
RD 48,23,2304
s_add_u32 s44, s44, 1572864
MAA 136,12,96
RD 52,23,3328
MAA 156,16,96
RD 56,24,2048
MAA 156,36,100
s_waitcnt vmcnt(13) lgkmcnt(5)
s_barrier
MAA 76,104,0
RD 60,23,9216
s_add_u32 m0, s56, 117248
MAA 76,108,20
buffer_load_dwordx4 v18, s[20:23], s54 offen lds
MAA 80,108,24
RD 64,23,10240
MAA 80,104,4
RD 68,23,11520
MAA 84,104,8
RD 72,23,12544
MAA 84,108,28
buffer_load_dwordx4 v19, s[20:23], s54 offen offset:1024 lds
MAA 88,108,32
RD 76,24,11264
MAA 88,104,12
buffer_load_dwordx4 v20, s[20:23], s54 offen offset:2048 lds
MAA 120,112,12
ds_read_b64_tr_b16 a[80:81], v25
s_add_u32 s54, s54, 196608
MAA 120,116,32
TR 82,25,512
MAA 116,116,28
TR 84,25,12416
s_add_u32 m0, s55, 46080
MAA 116,112,8
buffer_load_dwordx4 v21, s[16:19], s52 offen sc1 lds
MAA 112,112,4
TR 86,25,12928
MAA 112,116,24
TR 88,25,1024
MAA 108,116,20
TR 90,25,1536
MAA 108,112,0
buffer_load_dwordx4 v21, s[16:19], s52 offen offset:1024 sc1 lds
MAA 140,0,120
TR 92,25,13440
MAA 140,20,124
TR 94,25,13952
MAA 144,24,124
TR 96,25,2048
MAA 144,4,120
buffer_load_dword v22, s[16:19], s52 offen offset:2048 sc1 lds
MAA 148,8,120
TR 98,25,2560
s_add_u32 s52, s52, 131072
MAA 148,28,124
buffer_load_dwordx4 v[168:171], v26, s[16:19], s75 offen sc1
MAA 152,32,124
TR 100,25,14464
MAA 152,12,120
TR 102,25,14976
MAA 160,16,120
MAA 160,36,124
s_waitcnt vmcnt(17) lgkmcnt(8)
s_barrier
MAA 60,80,40
TR 104,25,32
v_add_f32 v164, v164, v172
MAA 60,84,60
TR 106,25,544
MAA 64,84,64
TR 108,25,12448
s_add_u32 m0, s56, 129664
MAA 64,80,44
buffer_load_dwordx4 v18, s[20:23], s54 offen lds
MAA 68,80,48
TR 110,25,12960
MAA 68,84,68
TR 112,25,1056
MAA 72,84,72
TR 114,25,1568
v_add_f32 v165, v165, v173
MAA 72,80,52
TR 116,25,13472
s_waitcnt lgkmcnt(7)
MAA 104,88,52
TR 118,25,13984
MAA 104,92,72
buffer_load_dwordx4 v19, s[20:23], s54 offen offset:1024 lds
MAA 100,92,68
TR 120,25,2080
MAA 100,88,48
buffer_load_dwordx4 v20, s[20:23], s54 offen offset:2048 lds
MAA 96,88,44
s_add_u32 s54, s54, 196608
MAA 96,92,64
TR 122,25,2592
v_add_f32 v166, v166, v174
MAA 92,92,60
TR 124,25,14496
s_add_u32 m0, s55, 0
MAA 92,88,40
buffer_load_dwordx4 v21, s[16:19], s52 offen sc1 lds
MAA 124,40,96
TR 126,25,15008
MAA 124,60,100
RD 0,23,18432
MAA 128,64,100
RD 4,23,19456
MAA 128,44,96
buffer_load_dwordx4 v21, s[16:19], s52 offen offset:1024 sc1 lds
MAA 132,48,96
RD 8,23,20736
v_add_f32 v167, v167, v175
MAA 132,68,100
RD 12,23,21760
MAA 136,72,100
RD 16,24,20480
MAA 136,52,96
buffer_load_dword v22, s[16:19], s52 offen offset:2048 sc1 lds
MAA 156,56,96
s_add_u32 s52, s52, 131072
MAA 156,76,100
s_waitcnt vmcnt(17) lgkmcnt(5)
s_barrier
MAA 76,104,40
RD 20,23,27648
s_add_u32 m0, s56, 67584
MAA 76,108,60
buffer_load_dwordx4 v18, s[20:23], s54 offen lds
MAA 80,108,64
RD 24,23,28672
MAA 80,104,44
RD 28,23,29952
MAA 84,104,48
RD 32,23,30976
MAA 84,108,68
buffer_load_dwordx4 v19, s[20:23], s54 offen offset:1024 lds
MAA 88,108,72
RD 36,24,29696
MAA 88,104,52
buffer_load_dwordx4 v20, s[20:23], s54 offen offset:2048 lds
MAA 120,112,52
TR 80,25,24832
s_add_u32 s54, s54, 196608
MAA 120,116,72
TR 82,25,25344
MAA 116,116,68
TR 84,25,37248
s_add_u32 m0, s55, 9216
MAA 116,112,48
buffer_load_dwordx4 v21, s[16:19], s52 offen sc1 lds
MAA 112,112,44
TR 86,25,37760
MAA 112,116,64
TR 88,25,25856
MAA 108,116,60
TR 90,25,26368
MAA 108,112,40
buffer_load_dwordx4 v21, s[16:19], s52 offen offset:1024 sc1 lds
MAA 140,40,120
TR 92,25,38272
MAA 140,60,124
TR 94,25,38784
MAA 144,64,124
TR 96,25,26880
MAA 144,44,120
buffer_load_dword v22, s[16:19], s52 offen offset:2048 sc1 lds
MAA 148,48,120
TR 98,25,27392
s_add_u32 s52, s52, 131072
MAA 148,68,124
buffer_load_dwordx4 v[172:175], v26, s[16:19], s75 offen offset:1024 sc1
MAA 152,72,124
TR 100,25,39296
s_add_u32 s75, s75, 2048
MAA 152,52,120
TR 102,25,39808
MAA 160,56,120
MAA 160,76,124
s_waitcnt vmcnt(21) lgkmcnt(8)
s_barrier
MAA 60,80,0
TR 104,25,24864
MAA 60,84,20
TR 106,25,25376
MAA 64,84,24
TR 108,25,37280
s_add_u32 m0, s56, 80000
MAA 64,80,4
buffer_load_dwordx4 v18, s[20:23], s54 offen lds
MAA 68,80,8
TR 110,25,37792
MAA 68,84,28
TR 112,25,25888
MAA 72,84,32
TR 114,25,26400
MAA 72,80,12
TR 116,25,38304
s_waitcnt lgkmcnt(7)
MAA 104,88,12
TR 118,25,38816
MAA 104,92,32
buffer_load_dwordx4 v19, s[20:23], s54 offen offset:1024 lds
MAA 100,92,28
TR 120,25,26912
MAA 100,88,8
buffer_load_dwordx4 v20, s[20:23], s54 offen offset:2048 lds
MAA 96,88,4
s_add_u32 s54, s54, 196608
MAA 96,92,24
TR 122,25,27424
MAA 92,92,20
TR 124,25,39328
s_add_u32 m0, s55, 18432
MAA 92,88,0
buffer_load_dwordx4 v21, s[16:19], s52 offen sc1 lds
MAA 124,0,96
TR 126,25,39840
MAA 124,20,100
RD 40,23,36864
MAA 128,24,100
RD 44,23,37888
MAA 128,4,96
buffer_load_dwordx4 v21, s[16:19], s52 offen offset:1024 sc1 lds
MAA 132,8,96
RD 48,23,39168
MAA 132,28,100
RD 52,23,40192
MAA 136,32,100
RD 56,24,38912
MAA 136,12,96
buffer_load_dword v22, s[16:19], s52 offen offset:2048 sc1 lds
MAA 156,16,96
s_add_u32 s52, s52, 131072
MAA 156,36,100
s_waitcnt vmcnt(16) lgkmcnt(5)
s_barrier
MAA 76,104,0
RD 60,23,46080
MAA 76,108,20
RD 64,23,47104
MAA 80,108,24
RD 68,23,48384
s_add_u32 m0, s56, 92416
MAA 80,104,4
buffer_load_dwordx4 v18, s[20:23], s54 offen lds
MAA 84,104,8
RD 72,23,49408
MAA 84,108,28
RD 76,24,48128
MAA 88,108,32
TR 80,25,49664
MAA 88,104,12
buffer_load_dwordx4 v19, s[20:23], s54 offen offset:1024 lds
MAA 120,112,12
TR 82,25,50176
MAA 120,116,32
TR 84,25,62080
MAA 116,116,28
TR 86,25,62592
MAA 116,112,8
buffer_load_dwordx4 v20, s[20:23], s54 offen offset:2048 lds
MAA 112,112,4
s_add_u32 s54, s54, 196608
MAA 112,116,24
TR 88,25,50688
MAA 108,116,20
TR 90,25,51200
s_add_u32 m0, s55, 27648
MAA 108,112,0
buffer_load_dwordx4 v21, s[16:19], s52 offen sc1 lds
MAA 140,0,120
TR 92,25,63104
MAA 140,20,124
TR 94,25,63616
MAA 144,24,124
TR 96,25,51712
MAA 144,4,120
buffer_load_dwordx4 v21, s[16:19], s52 offen offset:1024 sc1 lds
MAA 148,8,120
TR 98,25,52224
MAA 148,28,124
TR 100,25,64128
MAA 152,32,124
TR 102,25,64640
MAA 152,12,120
buffer_load_dword v22, s[16:19], s52 offen offset:2048 sc1 lds
MAA 160,16,120
s_add_u32 s52, s52, 131072
MAA 160,36,124
s_waitcnt vmcnt(19) lgkmcnt(8)
s_barrier
MAA 60,80,40
TR 104,25,49696
s_add_u32 m0, s56, 104832
MAA 60,84,60
buffer_load_dwordx4 v18, s[20:23], s54 offen lds
MAA 64,84,64
TR 106,25,50208
v_add_f32 v164, v164, v168
MAA 64,80,44
TR 108,25,62112
MAA 68,80,48
TR 110,25,62624
MAA 68,84,68
buffer_load_dwordx4 v19, s[20:23], s54 offen offset:1024 lds
MAA 72,84,72
TR 112,25,50720
v_add_f32 v165, v165, v169
MAA 72,80,52
TR 114,25,51232
s_waitcnt lgkmcnt(6)
MAA 104,88,52
TR 116,25,63136
MAA 104,92,72
buffer_load_dwordx4 v20, s[20:23], s54 offen offset:2048 lds
MAA 100,92,68
s_add_u32 s54, s54, 196608
s_add_u32 m0, s55, 36864
MAA 100,88,48
buffer_load_dwordx4 v21, s[16:19], s52 offen sc1 lds
MAA 96,88,44
TR 118,25,63648
MAA 96,92,64
TR 120,25,51744
v_add_f32 v166, v166, v170
MAA 92,92,60
TR 122,25,52256
MAA 92,88,40
buffer_load_dwordx4 v21, s[16:19], s52 offen offset:1024 sc1 lds
MAA 124,40,96
TR 124,25,64160
MAA 124,60,100
TR 126,25,64672
v_add_f32 v167, v167, v171
MAA 128,64,100
ds_read_b128 a[0:3], v23
MAA 128,44,96
buffer_load_dword v22, s[16:19], s52 offen offset:2048 sc1 lds
MAA 132,48,96
RD 4,23,1024
s_add_u32 s52, s52, 131072
MAA 132,68,100
buffer_load_dword v27, v14, s[20:23], s44 offen
MAA 136,72,100
RD 8,23,2304
s_add_u32 s44, s44, 1572864
MAA 136,52,96
RD 12,23,3328
MAA 156,56,96
RD 16,24,2048
MAA 156,76,100
s_waitcnt vmcnt(16) lgkmcnt(5)
s_barrier
MAA 76,104,40
RD 20,23,9216
s_add_u32 m0, s56, 117248
MAA 76,108,60
buffer_load_dwordx4 v18, s[20:23], s54 offen lds
MAA 80,108,64
RD 24,23,10240
MAA 80,104,44
RD 28,23,11520
MAA 84,104,48
RD 32,23,12544
MAA 84,108,68
buffer_load_dwordx4 v19, s[20:23], s54 offen offset:1024 lds
MAA 88,108,72
RD 36,24,11264
MAA 88,104,52
buffer_load_dwordx4 v20, s[20:23], s54 offen offset:2048 lds
MAA 120,112,52
ds_read_b64_tr_b16 a[80:81], v25
s_add_u32 s54, s54, 196608
MAA 120,116,72
TR 82,25,512
MAA 116,116,68
TR 84,25,12416
s_add_u32 m0, s55, 46080
MAA 116,112,48
buffer_load_dwordx4 v21, s[16:19], s52 offen sc1 lds
MAA 112,112,44
TR 86,25,12928
MAA 112,116,64
TR 88,25,1024
MAA 108,116,60
TR 90,25,1536
MAA 108,112,40
buffer_load_dwordx4 v21, s[16:19], s52 offen offset:1024 sc1 lds
MAA 140,40,120
TR 92,25,13440
MAA 140,60,124
TR 94,25,13952
MAA 144,64,124
TR 96,25,2048
MAA 144,44,120
buffer_load_dword v22, s[16:19], s52 offen offset:2048 sc1 lds
MAA 148,48,120
TR 98,25,2560
s_add_u32 s52, s52, 131072
MAA 148,68,124
buffer_load_dwordx4 v[168:171], v26, s[16:19], s75 offen sc1
MAA 152,72,124
TR 100,25,14464
MAA 152,52,120
TR 102,25,14976
MAA 160,56,120
MAA 160,76,124
s_waitcnt vmcnt(20) lgkmcnt(8)
s_barrier
MAA 60,80,0
TR 104,25,32
v_add_f32 v164, v164, v172
MAA 60,84,20
TR 106,25,544
MAA 64,84,24
TR 108,25,12448
s_add_u32 m0, s56, 129664
MAA 64,80,4
buffer_load_dwordx4 v18, s[20:23], s54 offen lds
MAA 68,80,8
TR 110,25,12960
MAA 68,84,28
TR 112,25,1056
MAA 72,84,32
TR 114,25,1568
.Lpad27:
s_cbranch_execz .Lnopoll53r
v_add_f32 v165, v165, v173
MAA 72,80,12
TR 116,25,13472
s_waitcnt lgkmcnt(7)
MAA 104,88,12
TR 118,25,13984
MAA 104,92,32
buffer_load_dwordx4 v19, s[20:23], s54 offen offset:1024 lds
MAA 100,92,28
TR 120,25,2080
MAA 100,88,8
buffer_load_dwordx4 v20, s[20:23], s54 offen offset:2048 lds
MAA 96,88,4
s_add_u32 s54, s54, 196608
MAA 96,92,24
TR 122,25,2592
v_add_f32 v166, v166, v174
MAA 92,92,20
TR 124,25,14496
s_add_u32 m0, s55, 0
MAA 92,88,0
buffer_load_dwordx4 v21, s[16:19], s52 offen sc1 lds
MAA 124,0,96
TR 126,25,15008
MAA 124,20,100
RD 40,23,18432
MAA 128,24,100
RD 44,23,19456
MAA 128,4,96
buffer_load_dwordx4 v21, s[16:19], s52 offen offset:1024 sc1 lds
MAA 132,8,96
RD 48,23,20736
v_add_f32 v167, v167, v175
MAA 132,28,100
RD 52,23,21760
MAA 136,32,100
RD 56,24,20480
MAA 136,12,96
buffer_load_dword v22, s[16:19], s52 offen offset:2048 sc1 lds
MAA 156,16,96
s_add_u32 s52, s52, 131072
MAA 156,36,100
s_waitcnt vmcnt(17) lgkmcnt(5)
s_barrier
MAA 76,104,0
RD 60,23,27648
s_add_u32 m0, s56, 67584
MAA 76,108,20
buffer_load_dwordx4 v18, s[20:23], s54 offen lds
MAA 80,108,24
RD 64,23,28672
MAA 80,104,4
RD 68,23,29952
MAA 84,104,8
RD 72,23,30976
MAA 84,108,28
buffer_load_dwordx4 v19, s[20:23], s54 offen offset:1024 lds
MAA 88,108,32
RD 76,24,29696
MAA 88,104,12
buffer_load_dwordx4 v20, s[20:23], s54 offen offset:2048 lds
MAA 120,112,12
TR 80,25,24832
s_add_u32 s54, s54, 196608
MAA 120,116,32
TR 82,25,25344
MAA 116,116,28
TR 84,25,37248
s_add_u32 m0, s55, 9216
MAA 116,112,8
buffer_load_dwordx4 v21, s[16:19], s52 offen sc1 lds
MAA 112,112,4
TR 86,25,37760
MAA 112,116,24
TR 88,25,25856
MAA 108,116,20
TR 90,25,26368
MAA 108,112,0
buffer_load_dwordx4 v21, s[16:19], s52 offen offset:1024 sc1 lds
MAA 140,0,120
TR 92,25,38272
MAA 140,20,124
TR 94,25,38784
MAA 144,24,124
TR 96,25,26880
MAA 144,4,120
buffer_load_dword v22, s[16:19], s52 offen offset:2048 sc1 lds
MAA 148,8,120
TR 98,25,27392
s_add_u32 s52, s52, 131072
MAA 148,28,124
buffer_load_dwordx4 v[172:175], v26, s[16:19], s75 offen offset:1024 sc1
MAA 152,32,124
TR 100,25,39296
s_add_u32 s75, s75, 2048
MAA 152,12,120
TR 102,25,39808
MAA 160,16,120
MAA 160,36,124
s_waitcnt vmcnt(21) lgkmcnt(8)
s_barrier
MAA 60,80,40
TR 104,25,24864
MAA 60,84,60
TR 106,25,25376
MAA 64,84,64
TR 108,25,37280
s_add_u32 m0, s56, 80000
MAA 64,80,44
buffer_load_dwordx4 v18, s[20:23], s54 offen lds
MAA 68,80,48
TR 110,25,37792
MAA 68,84,68
TR 112,25,25888
MAA 72,84,72
TR 114,25,26400
MAA 72,80,52
TR 116,25,38304
s_waitcnt lgkmcnt(7)
MAA 104,88,52
TR 118,25,38816
MAA 104,92,72
buffer_load_dwordx4 v19, s[20:23], s54 offen offset:1024 lds
MAA 100,92,68
TR 120,25,26912
MAA 100,88,48
buffer_load_dwordx4 v20, s[20:23], s54 offen offset:2048 lds
MAA 96,88,44
s_add_u32 s54, s54, 196608
MAA 96,92,64
TR 122,25,27424
MAA 92,92,60
TR 124,25,39328
s_add_u32 m0, s55, 18432
MAA 92,88,40
buffer_load_dwordx4 v21, s[16:19], s52 offen sc1 lds
MAA 124,40,96
TR 126,25,39840
MAA 124,60,100
RD 0,23,36864
MAA 128,64,100
RD 4,23,37888
MAA 128,44,96
buffer_load_dwordx4 v21, s[16:19], s52 offen offset:1024 sc1 lds
MAA 132,48,96
RD 8,23,39168
MAA 132,68,100
RD 12,23,40192
MAA 136,72,100
RD 16,24,38912
MAA 136,52,96
buffer_load_dword v22, s[16:19], s52 offen offset:2048 sc1 lds
MAA 156,56,96
s_add_u32 s52, s52, 131072
MAA 156,76,100
s_waitcnt vmcnt(16) lgkmcnt(5)
s_barrier
MAA 76,104,40
RD 20,23,46080
MAA 76,108,60
RD 24,23,47104
MAA 80,108,64
RD 28,23,48384
s_add_u32 m0, s56, 92416
MAA 80,104,44
buffer_load_dwordx4 v18, s[20:23], s54 offen lds
MAA 84,104,48
RD 32,23,49408
MAA 84,108,68
RD 36,24,48128
MAA 88,108,72
TR 80,25,49664
MAA 88,104,52
buffer_load_dwordx4 v19, s[20:23], s54 offen offset:1024 lds
MAA 120,112,52
TR 82,25,50176
MAA 120,116,72
TR 84,25,62080
MAA 116,116,68
TR 86,25,62592
MAA 116,112,48
buffer_load_dwordx4 v20, s[20:23], s54 offen offset:2048 lds
MAA 112,112,44
s_add_u32 s54, s54, 196608
MAA 112,116,64
TR 88,25,50688
MAA 108,116,60
TR 90,25,51200
s_add_u32 m0, s55, 27648
MAA 108,112,40
buffer_load_dwordx4 v21, s[16:19], s52 offen sc1 lds
MAA 140,40,120
TR 92,25,63104
MAA 140,60,124
TR 94,25,63616
MAA 144,64,124
TR 96,25,51712
MAA 144,44,120
buffer_load_dwordx4 v21, s[16:19], s52 offen offset:1024 sc1 lds
MAA 148,48,120
TR 98,25,52224
MAA 148,68,124
TR 100,25,64128
MAA 152,72,124
TR 102,25,64640
MAA 152,52,120
buffer_load_dword v22, s[16:19], s52 offen offset:2048 sc1 lds
MAA 160,56,120
s_add_u32 s52, s52, 131072
s_add_u32 s15, s15, 1
MAA 160,76,124
s_cbranch_scc0 .Lk58
s_waitcnt vmcnt(19) lgkmcnt(8)
s_barrier
MAA 60,80,0
TR 104,25,49696
v_add_f32 v164, v164, v168
MAA 60,84,20
TR 106,25,50208
s_add_u32 m0, s56, 104832
MAA 64,84,24
buffer_load_dwordx4 v18, s[20:23], s54 offen lds
MAA 64,80,4
TR 108,25,62112
v_add_f32 v165, v165, v169
MAA 68,80,8
TR 110,25,62624
v_add_f32 v166, v166, v170
MAA 68,84,28
TR 112,25,50720
v_add_f32 v167, v167, v171
MAA 72,84,32
buffer_load_dwordx4 v19, s[20:23], s54 offen offset:1024 lds
MAA 72,80,12
TR 114,25,51232
s_waitcnt lgkmcnt(6)
MAA 104,88,12
TR 116,25,63136
MAA 104,92,32
TR 118,25,63648
MAA 100,92,28
buffer_load_dwordx4 v20, s[20:23], s54 offen offset:2048 lds
MAA 100,88,8
TR 120,25,51744
s_add_u32 s54, s54, 196608
MAA 96,88,4
TR 122,25,52256
s_add_u32 m0, s55, 36864
MAA 96,92,24
TR 124,25,64160
MAA 92,92,20
buffer_load_dwordx4 v21, s[16:19], s52 offen sc1 lds
MAA 92,88,0
TR 126,25,64672
MAA 124,0,96
ds_read_b128 a[40:43], v23
MAA 124,20,100
RD 44,23,1024
MAA 128,24,100
buffer_load_dwordx4 v21, s[16:19], s52 offen offset:1024 sc1 lds
MAA 128,4,96
RD 48,23,2304
MAA 132,8,96
RD 52,23,3328
MAA 132,28,100
RD 56,24,2048
MAA 136,32,100
buffer_load_dword v22, s[16:19], s52 offen offset:2048 sc1 lds
MAA 136,12,96
s_add_u32 s52, s52, 131072
MAA 156,16,96
MAA 156,36,100
s_waitcnt vmcnt(15) lgkmcnt(5)
s_barrier
MAA 76,104,0
RD 60,23,9216
v_add_f32 v164, v164, v172
MAA 76,108,20
RD 64,23,10240
s_add_u32 m0, s56, 117248
MAA 80,108,24
buffer_load_dwordx4 v18, s[20:23], s54 offen lds
MAA 80,104,4
RD 68,23,11520
v_add_f32 v165, v165, v173
MAA 84,104,8
RD 72,23,12544
v_add_f32 v166, v166, v174
MAA 84,108,28
RD 76,24,11264
v_add_f32 v167, v167, v175
MAA 88,108,32
buffer_load_dwordx4 v19, s[20:23], s54 offen offset:1024 lds
MAA 88,104,12
ds_read_b64_tr_b16 a[80:81], v25
MAA 120,112,12
TR 82,25,512
MAA 120,116,32
TR 84,25,12416
MAA 116,116,28
buffer_load_dwordx4 v20, s[20:23], s54 offen offset:2048 lds
MAA 116,112,8
TR 86,25,12928
s_add_u32 s54, s54, 196608
MAA 112,112,4
TR 88,25,1024
s_add_u32 m0, s55, 46080
MAA 112,116,24
TR 90,25,1536
MAA 108,116,20
buffer_load_dwordx4 v21, s[16:19], s52 offen sc1 lds
MAA 108,112,0
TR 92,25,13440
MAA 140,0,120
TR 94,25,13952
MAA 140,20,124
TR 96,25,2048
MAA 144,24,124
buffer_load_dwordx4 v21, s[16:19], s52 offen offset:1024 sc1 lds
MAA 144,4,120
TR 98,25,2560
MAA 148,8,120
TR 100,25,14464
MAA 148,28,124
TR 102,25,14976
MAA 152,32,124
buffer_load_dword v22, s[16:19], s52 offen offset:2048 sc1 lds
MAA 152,12,120
s_add_u32 s52, s52, 131072
v_permlane32_swap_b32 v164, v166
MAA 160,16,120
v_permlane32_swap_b32 v165, v167
MAA 160,36,124
s_waitcnt vmcnt(18) lgkmcnt(8)
s_barrier
MAA 60,80,40
TR 104,25,32
v_add_f32 v164, v164, v166
MAA 60,84,60
TR 106,25,544
s_add_u32 m0, s56, 129664
MAA 64,84,64
buffer_load_dwordx4 v18, s[20:23], s54 offen lds
MAA 64,80,44
TR 108,25,12448
v_add_f32 v165, v165, v167
MAA 68,80,48
TR 110,25,12960
v_mul_f32 v164, 0xba800000, v164
MAA 68,84,68
buffer_load_dwordx4 v19, s[20:23], s54 offen offset:1024 lds
MAA 72,84,72
TR 112,25,1056
v_mul_f32 v165, 0x3a800000, v165
MAA 72,80,52
TR 114,25,1568
v_fma_f32 v165, -v164, v164, v165
s_waitcnt lgkmcnt(6)
MAA 104,88,52
buffer_load_dwordx4 v20, s[20:23], s54 offen offset:2048 lds
MAA 104,92,72
TR 116,25,13472
s_add_u32 s54, s54, 196608
MAA 100,92,68
TR 118,25,13984
s_add_u32 m0, s59, 58240
MAA 100,88,48
TR 120,25,2080
s_xor_b32 s58, s87, 1966080
MAA 96,88,44
buffer_load_dwordx4 v5, s[24:27], s58 offen lds
MAA 96,92,64
TR 122,25,2592
v_max_f32 v165, 0, v165
MAA 92,92,60
TR 124,25,14496
v_add_f32 v165, 0x3727c5ac, v165
MAA 92,88,40
buffer_load_dwordx4 v6, s[24:27], s58 offen offset:1024 lds
MAA 124,40,96
TR 126,25,15008
s_add_u32 m0, s59, 0
MAA 124,60,100
RD 0,23,18432
s_xor_b32 s58, s87, 1048576
MAA 128,64,100
buffer_load_dwordx4 v5, s[24:27], s58 offen lds
MAA 128,44,96
RD 4,23,19456
MAA 132,48,96
RD 8,23,20736
MAA 132,68,100
buffer_load_dwordx4 v6, s[24:27], s58 offen offset:1024 lds
MAA 136,72,100
RD 12,23,21760
MAA 136,52,96
RD 16,24,20480
MAA 156,56,96
v_rsq_f32 v166, v165
MAA 156,76,100
v_mov_b32 v165, v166
v_mul_f32 v166, 0x3e8293ee, v166
ds_write_b128 v7, v[164:167]
s_waitcnt vmcnt(16) lgkmcnt(6)
s_barrier
MAA 76,104,40
ds_write_b32 v17, v164
MAA 76,108,60
ds_write_b32 v17, v165 offset:1024
s_add_u32 m0, s59, 8320
MAA 80,108,64
RD 20,23,27648
s_xor_b32 s58, s87, 1179648
MAA 80,104,44
buffer_load_dwordx4 v5, s[24:27], s58 offen lds
MAA 84,104,48
RD 24,23,28672
MAA 84,108,68
RD 28,23,29952
MAA 88,108,72
RD 32,23,30976
MAA 88,104,52
buffer_load_dwordx4 v6, s[24:27], s58 offen offset:1024 lds
MAA 120,112,52
RD 36,24,29696
s_add_u32 m0, s59, 66560
MAA 120,116,72
TR 80,25,24832
s_xor_b32 s58, s87, 0
MAA 116,116,68
TR 82,25,25344
MAA 116,112,48
buffer_load_dwordx4 v5, s[24:27], s58 offen lds
MAA 112,112,44
TR 84,25,37248
MAA 112,116,64
TR 86,25,37760
MAA 108,116,60
TR 88,25,25856
MAA 108,112,40
buffer_load_dwordx4 v6, s[24:27], s58 offen offset:1024 lds
MAA 140,40,120
TR 90,25,26368
s_add_u32 m0, s59, 74880
MAA 140,60,124
TR 92,25,38272
s_xor_b32 s58, s87, 131072
MAA 144,64,124
TR 94,25,38784
MAA 144,44,120
buffer_load_dwordx4 v5, s[24:27], s58 offen lds
MAA 148,48,120
TR 96,25,26880
MAA 148,68,124
TR 98,25,27392
MAA 152,72,124
TR 100,25,39296
MAA 152,52,120
buffer_load_dwordx4 v6, s[24:27], s58 offen offset:1024 lds
MAA 160,56,120
TR 102,25,39808
MAA 160,76,124
s_waitcnt vmcnt(10) lgkmcnt(0)
s_barrier
MAA 104,88,12
TR 112,25,25888
s_add_u32 m0, s59, 83200
MAA 104,92,32
TR 114,25,26400
s_xor_b32 s58, s87, 262144
MAA 100,92,28
buffer_load_dwordx4 v5, s[24:27], s58 offen lds
MAA 100,88,8
TR 116,25,38304
MAA 96,88,4
TR 118,25,38816
MAA 96,92,24
TR 120,25,26912
MAA 92,92,20
buffer_load_dwordx4 v6, s[24:27], s58 offen offset:1024 lds
MAA 92,88,0
TR 122,25,27424
s_add_u32 m0, s59, 16640
MAA 156,16,96
TR 124,25,39328
s_xor_b32 s58, s87, 1310720
MAA 156,36,100
TR 126,25,39840
MAA 72,84,32
buffer_load_dwordx4 v5, s[24:27], s58 offen lds
MAA 72,80,12
TR 104,25,24864
MAA 68,80,8
TR 106,25,25376
MAA 68,84,28
TR 108,25,37280
MAA 64,84,24
buffer_load_dwordx4 v6, s[24:27], s58 offen offset:1024 lds
MAA 64,80,4
TR 110,25,37792
s_add_u32 m0, s59, 24960
MAA 60,80,0
RD 40,23,36864
s_xor_b32 s58, s87, 1441792
MAA 60,84,20
RD 44,23,37888
s_waitcnt lgkmcnt(12)
MAA 120,112,12
buffer_load_dwordx4 v5, s[24:27], s58 offen lds
s_waitcnt lgkmcnt(10)
MAA 120,116,32
RD 48,23,39168
MAA 116,116,28
RD 52,23,40192
MAA 116,112,8
RD 56,24,38912
MAA 112,112,4
buffer_load_dwordx4 v6, s[24:27], s58 offen offset:1024 lds
MAA 112,116,24
s_waitcnt lgkmcnt(5)
s_barrier
RD 60,23,46080
MAA 108,116,20
RD 64,23,47104
s_add_u32 m0, s59, 91520
MAA 108,112,0
RD 68,23,48384
s_xor_b32 s58, s87, 393216
MAA 160,16,120
RD 72,23,49408
MAA 160,36,124
RD 76,24,48128
MAA 88,108,32
TR 144,25,50688
MAA 88,104,12
.Lpad28:
s_cbranch_execz .Lnopoll53r
TR 146,25,51200
MAA 84,104,8
TR 148,25,63104
MAA 84,108,28
TR 150,25,63616
MAA 80,108,24
TR 152,25,50720
MAA 80,104,4
TR 154,25,51232
MAA 76,104,0
TR 156,25,63136
MAA 76,108,20
TR 158,25,63648
TR 160,25,51712
TR 162,25,52224
TR 164,25,64128
s_waitcnt lgkmcnt(9)
MAA 104,144,52
TR 166,25,64640
TR 168,25,51744
TR 170,25,52256
s_waitcnt lgkmcnt(10)
MAA 104,148,72
TR 172,25,64160
MAA 100,148,68
TR 174,25,64672
MAA 100,144,48
TR 136,25,49696
MAA 96,144,44
TR 138,25,50208
MAA 96,148,64
TR 140,25,62112
MAA 92,148,60
TR 142,25,62624
MAA 92,144,40
TR 128,25,49664
s_waitcnt lgkmcnt(15)
MAA 120,152,52
TR 130,25,50176
s_waitcnt lgkmcnt(14)
MAA 120,156,72
TR 132,25,62080
MAA 116,156,68
TR 134,25,62592
MAA 116,152,48
ds_read_b128 v[232:235], v10 offset:1792
MAA 112,152,44
ds_read_b128 v[228:231], v10 offset:1536
MAA 112,156,64
ds_read_b128 v[224:227], v10 offset:1280
MAA 108,156,60
ds_read_b128 v[220:223], v10 offset:1024
MAA 108,152,40
buffer_load_dwordx4 v5, s[24:27], s58 offen lds
s_waitcnt lgkmcnt(15)
MAA 156,56,160
ds_read_b128 v[240:243], v11 offset:704
MAA 156,76,164
ds_read_b128 v[244:247], v11 offset:1728
s_waitcnt lgkmcnt(14)
MAA 160,76,172
s_waitcnt lgkmcnt(6)
s_barrier
ds_read_b128 v[18:21], v11 offset:448
MAA 160,56,168
buffer_load_dwordx4 v6, s[24:27], s58 offen offset:1024 lds
MAA 88,136,52
ds_read_b128 v[22:25], v11 offset:1472
s_add_u32 m0, s59, 99840
MAA 88,140,72
s_xor_b32 s58, s87, 524288
MAA 84,140,68
MAA 84,136,48
buffer_load_dwordx4 v5, s[24:27], s58 offen lds
MAA 80,136,44
MAA 80,140,64
MAA 76,140,60
MAA 76,136,40
buffer_load_dwordx4 v6, s[24:27], s58 offen offset:1024 lds
MAA 72,128,52
s_add_u32 m0, s59, 108160
s_xor_b32 s58, s87, 655360
MAA 72,132,72
MAA 68,132,68
MAA 68,128,48
buffer_load_dwordx4 v5, s[24:27], s58 offen lds
MAA 64,128,44
MAA 64,132,64
MAA 60,132,60
MAA 60,128,40
buffer_load_dwordx4 v6, s[24:27], s58 offen offset:1024 lds
s_waitcnt lgkmcnt(3)
v_pk_fma_f32 v[156:157], v[240:241], v[44:45], v[156:157] op_sel_hi:[1,0,1]
s_waitcnt lgkmcnt(2)
v_pk_mul_f32 v[156:157], v[156:157], v[244:245]
v_cvt_pk_bf16_f32 v236, v156, v157
v_pk_fma_f32 v[158:159], v[242:243], v[44:45], v[158:159] op_sel_hi:[1,0,1]
v_pk_mul_f32 v[158:159], v[158:159], v[246:247]
v_cvt_pk_bf16_f32 v237, v158, v159
v_pk_fma_f32 v[160:161], v[240:241], v[44:45], v[160:161] op_sel:[0,1,0] op_sel_hi:[1,1,1]
v_pk_mul_f32 v[160:161], v[160:161], v[244:245]
v_cvt_pk_bf16_f32 v238, v160, v161
v_pk_fma_f32 v[162:163], v[242:243], v[44:45], v[162:163] op_sel:[0,1,0] op_sel_hi:[1,1,1]
v_pk_mul_f32 v[162:163], v[162:163], v[246:247]
v_cvt_pk_bf16_f32 v239, v162, v163
ds_write_b128 v8, v[236:239] offset:1024
v_pk_fma_f32 v[104:105], v[36:37], v[232:233], v[104:105] op_sel_hi:[1,0,1]
v_pk_mul_f32 v[104:105], v[104:105], v[232:233] op_sel:[0,1] op_sel_hi:[1,1]
v_cvt_pk_bf16_f32 v196, v104, v105
v_pk_fma_f32 v[106:107], v[38:39], v[232:233], v[106:107] op_sel_hi:[1,0,1]
v_pk_mul_f32 v[106:107], v[106:107], v[232:233] op_sel:[0,1] op_sel_hi:[1,1]
v_cvt_pk_bf16_f32 v197, v106, v107
v_pk_fma_f32 v[120:121], v[40:41], v[232:233], v[120:121] op_sel_hi:[1,0,1]
v_pk_mul_f32 v[120:121], v[120:121], v[232:233] op_sel:[0,1] op_sel_hi:[1,1]
v_cvt_pk_bf16_f32 v198, v120, v121
v_pk_fma_f32 v[122:123], v[42:43], v[232:233], v[122:123] op_sel_hi:[1,0,1]
v_pk_mul_f32 v[122:123], v[122:123], v[232:233] op_sel:[0,1] op_sel_hi:[1,1]
v_cvt_pk_bf16_f32 v199, v122, v123
v_pk_fma_f32 v[100:101], v[36:37], v[228:229], v[100:101] op_sel_hi:[1,0,1]
v_pk_mul_f32 v[100:101], v[100:101], v[228:229] op_sel:[0,1] op_sel_hi:[1,1]
v_cvt_pk_bf16_f32 v192, v100, v101
v_pk_fma_f32 v[102:103], v[38:39], v[228:229], v[102:103] op_sel_hi:[1,0,1]
v_pk_mul_f32 v[102:103], v[102:103], v[228:229] op_sel:[0,1] op_sel_hi:[1,1]
v_cvt_pk_bf16_f32 v193, v102, v103
v_pk_fma_f32 v[116:117], v[40:41], v[228:229], v[116:117] op_sel_hi:[1,0,1]
v_pk_mul_f32 v[116:117], v[116:117], v[228:229] op_sel:[0,1] op_sel_hi:[1,1]
v_cvt_pk_bf16_f32 v194, v116, v117
v_pk_fma_f32 v[118:119], v[42:43], v[228:229], v[118:119] op_sel_hi:[1,0,1]
v_pk_mul_f32 v[118:119], v[118:119], v[228:229] op_sel:[0,1] op_sel_hi:[1,1]
v_cvt_pk_bf16_f32 v195, v118, v119
v_pk_fma_f32 v[96:97], v[36:37], v[224:225], v[96:97] op_sel_hi:[1,0,1]
v_pk_mul_f32 v[96:97], v[96:97], v[224:225] op_sel:[0,1] op_sel_hi:[1,1]
v_cvt_pk_bf16_f32 v188, v96, v97
v_pk_fma_f32 v[98:99], v[38:39], v[224:225], v[98:99] op_sel_hi:[1,0,1]
v_pk_mul_f32 v[98:99], v[98:99], v[224:225] op_sel:[0,1] op_sel_hi:[1,1]
v_cvt_pk_bf16_f32 v189, v98, v99
v_pk_fma_f32 v[112:113], v[40:41], v[224:225], v[112:113] op_sel_hi:[1,0,1]
v_pk_mul_f32 v[112:113], v[112:113], v[224:225] op_sel:[0,1] op_sel_hi:[1,1]
v_cvt_pk_bf16_f32 v190, v112, v113
v_pk_fma_f32 v[114:115], v[42:43], v[224:225], v[114:115] op_sel_hi:[1,0,1]
v_pk_mul_f32 v[114:115], v[114:115], v[224:225] op_sel:[0,1] op_sel_hi:[1,1]
v_cvt_pk_bf16_f32 v191, v114, v115
v_pk_fma_f32 v[92:93], v[36:37], v[220:221], v[92:93] op_sel_hi:[1,0,1]
v_pk_mul_f32 v[92:93], v[92:93], v[220:221] op_sel:[0,1] op_sel_hi:[1,1]
v_cvt_pk_bf16_f32 v184, v92, v93
v_pk_fma_f32 v[94:95], v[38:39], v[220:221], v[94:95] op_sel_hi:[1,0,1]
v_pk_mul_f32 v[94:95], v[94:95], v[220:221] op_sel:[0,1] op_sel_hi:[1,1]
v_cvt_pk_bf16_f32 v185, v94, v95
v_pk_fma_f32 v[108:109], v[40:41], v[220:221], v[108:109] op_sel_hi:[1,0,1]
v_pk_mul_f32 v[108:109], v[108:109], v[220:221] op_sel:[0,1] op_sel_hi:[1,1]
v_cvt_pk_bf16_f32 v186, v108, v109
v_pk_fma_f32 v[110:111], v[42:43], v[220:221], v[110:111] op_sel_hi:[1,0,1]
v_pk_mul_f32 v[110:111], v[110:111], v[220:221] op_sel:[0,1] op_sel_hi:[1,1]
v_cvt_pk_bf16_f32 v187, v110, v111
v_pk_fma_f32 v[72:73], v[28:29], v[232:233], v[72:73] op_sel_hi:[1,0,1]
v_cvt_pk_bf16_f32 v176, v72, v73
v_pk_fma_f32 v[74:75], v[30:31], v[232:233], v[74:75] op_sel_hi:[1,0,1]
v_cvt_pk_bf16_f32 v177, v74, v75
v_pk_fma_f32 v[88:89], v[32:33], v[232:233], v[88:89] op_sel_hi:[1,0,1]
v_cvt_pk_bf16_f32 v178, v88, v89
v_pk_fma_f32 v[90:91], v[34:35], v[232:233], v[90:91] op_sel_hi:[1,0,1]
v_cvt_pk_bf16_f32 v179, v90, v91
v_pk_fma_f32 v[68:69], v[28:29], v[228:229], v[68:69] op_sel_hi:[1,0,1]
v_cvt_pk_bf16_f32 v172, v68, v69
v_pk_fma_f32 v[70:71], v[30:31], v[228:229], v[70:71] op_sel_hi:[1,0,1]
v_cvt_pk_bf16_f32 v173, v70, v71
v_pk_fma_f32 v[84:85], v[32:33], v[228:229], v[84:85] op_sel_hi:[1,0,1]
v_cvt_pk_bf16_f32 v174, v84, v85
v_pk_fma_f32 v[86:87], v[34:35], v[228:229], v[86:87] op_sel_hi:[1,0,1]
v_cvt_pk_bf16_f32 v175, v86, v87
v_pk_fma_f32 v[64:65], v[28:29], v[224:225], v[64:65] op_sel_hi:[1,0,1]
v_cvt_pk_bf16_f32 v168, v64, v65
v_pk_fma_f32 v[66:67], v[30:31], v[224:225], v[66:67] op_sel_hi:[1,0,1]
v_cvt_pk_bf16_f32 v169, v66, v67
v_pk_fma_f32 v[80:81], v[32:33], v[224:225], v[80:81] op_sel_hi:[1,0,1]
v_cvt_pk_bf16_f32 v170, v80, v81
v_pk_fma_f32 v[82:83], v[34:35], v[224:225], v[82:83] op_sel_hi:[1,0,1]
v_cvt_pk_bf16_f32 v171, v82, v83
v_pk_fma_f32 v[60:61], v[28:29], v[220:221], v[60:61] op_sel_hi:[1,0,1]
v_cvt_pk_bf16_f32 v164, v60, v61
v_pk_fma_f32 v[62:63], v[30:31], v[220:221], v[62:63] op_sel_hi:[1,0,1]
v_cvt_pk_bf16_f32 v165, v62, v63
v_pk_fma_f32 v[76:77], v[32:33], v[220:221], v[76:77] op_sel_hi:[1,0,1]
v_cvt_pk_bf16_f32 v166, v76, v77
v_pk_fma_f32 v[78:79], v[34:35], v[220:221], v[78:79] op_sel_hi:[1,0,1]
s_waitcnt lgkmcnt(0)
s_barrier
v_cvt_pk_bf16_f32 v167, v78, v79
v_mfma_f32_16x16x32_bf16 v[120:123], v[196:199], v[176:179], v[50:53]
ds_read_b128 v[180:183], v9
s_add_u32 m0, s59, 33280
v_mfma_f32_16x16x32_bf16 v[104:107], v[192:195], v[176:179], v[46:49]
ds_read_b64 v[200:201], v9 offset:1024
s_xor_b32 s58, s87, 1572864
v_mfma_f32_16x16x32_bf16 v[116:119], v[192:195], v[172:175], v[50:53]
buffer_load_dwordx4 v5, s[24:27], s58 offen lds
v_mfma_f32_16x16x32_bf16 v[100:103], v[188:191], v[172:175], v[46:49]
ds_read_b64 v[210:211], v9 offset:1032
v_mfma_f32_16x16x32_bf16 v[112:115], v[188:191], v[168:171], v[50:53]
ds_read_b128 v[240:243], v11 offset:384
v_max3_f32 v88, v104, v105, v106
v_mfma_f32_16x16x32_bf16 v[96:99], v[184:187], v[168:171], v[46:49]
ds_read_b128 v[244:247], v11 offset:1408
v_max3_f32 v89, v107, v120, v121
v_mfma_f32_16x16x32_bf16 v[108:111], v[184:187], v[164:167], v[50:53]
buffer_load_dwordx4 v6, s[24:27], s58 offen offset:1024 lds
v_max3_f32 v88, v88, v122, v123
v_max_f32 v90, v88, v89
v_max_f32 v89, v88, v89
v_max3_f32 v84, v100, v101, v102
v_max3_f32 v85, v103, v116, v117
s_waitcnt lgkmcnt(4)
v_mfma_f32_16x16x32_bf16 v[92:95], v[180:183], v[164:167], v[46:49]
ds_read_b128 v[28:31], v11 offset:320
s_add_u32 m0, s59, 41600
MAA 136,12,96
ds_read_b128 v[32:35], v11 offset:1344
s_xor_b32 s58, s87, 1703936
MAA 136,32,100
buffer_load_dwordx4 v5, s[24:27], s58 offen lds
MAA 136,52,160
ds_read_b128 v[36:39], v11 offset:256
v_permlane16_swap_b32 v90, v89
MAA 136,72,164
ds_read_b128 v[40:43], v11 offset:1280
v_max_f32 v88, v90, v89
MAA 152,72,172
v_max_f32 v89, v90, v89
v_max3_f32 v84, v84, v118, v119
MAA 152,52,168
buffer_load_dwordx4 v6, s[24:27], s58 offen offset:1024 lds
MAA 152,32,124
s_add_u32 m0, s59, 49920
s_xor_b32 s58, s87, 1835008
v_permlane32_swap_b32 v88, v89
MAA 152,12,120
v_max_f32 v88, v88, v89
v_mul_f32 v88, v88, v234
v_max_f32 v86, v84, v85
v_max_f32 v85, v84, v85
v_max3_f32 v80, v96, v97, v98
v_max3_f32 v81, v99, v112, v113
v_permlane16_swap_b32 v86, v85
v_max3_f32 v80, v80, v114, v115
v_max_f32 v84, v86, v85
v_max_f32 v85, v86, v85
v_max_f32 v82, v80, v81
v_max_f32 v81, v80, v81
v_permlane32_swap_b32 v84, v85
v_max3_f32 v76, v92, v93, v94
v_max_f32 v84, v84, v85
v_mul_f32 v84, v84, v230
v_permlane16_swap_b32 v82, v81
v_max3_f32 v77, v95, v108, v109
v_max_f32 v80, v82, v81
v_max_f32 v81, v82, v81
v_max3_f32 v76, v76, v110, v111
v_max_f32 v78, v76, v77
v_permlane32_swap_b32 v80, v81
v_max_f32 v77, v76, v77
v_max_f32 v80, v80, v81
v_mul_f32 v80, v80, v226
v_permlane16_swap_b32 v78, v77
v_pk_fma_f32 v[104:105], v[104:105], v[234:235], v[88:89] op_sel_hi:[1,0,0] neg_lo:[0,0,1] neg_hi:[0,0,1]
v_max_f32 v76, v78, v77
v_max_f32 v77, v78, v77
v_pk_fma_f32 v[106:107], v[106:107], v[234:235], v[88:89] op_sel_hi:[1,0,0] neg_lo:[0,0,1] neg_hi:[0,0,1]
v_pk_fma_f32 v[120:121], v[120:121], v[234:235], v[88:89] op_sel_hi:[1,0,0] neg_lo:[0,0,1] neg_hi:[0,0,1]
v_permlane32_swap_b32 v76, v77
v_pk_fma_f32 v[122:123], v[122:123], v[234:235], v[88:89] op_sel_hi:[1,0,0] neg_lo:[0,0,1] neg_hi:[0,0,1]
v_max_f32 v76, v76, v77
v_mul_f32 v76, v76, v222
v_pk_fma_f32 v[100:101], v[100:101], v[230:231], v[84:85] op_sel_hi:[1,0,0] neg_lo:[0,0,1] neg_hi:[0,0,1]
v_pk_fma_f32 v[102:103], v[102:103], v[230:231], v[84:85] op_sel_hi:[1,0,0] neg_lo:[0,0,1] neg_hi:[0,0,1]
v_pk_fma_f32 v[116:117], v[116:117], v[230:231], v[84:85] op_sel_hi:[1,0,0] neg_lo:[0,0,1] neg_hi:[0,0,1]
v_pk_fma_f32 v[118:119], v[118:119], v[230:231], v[84:85] op_sel_hi:[1,0,0] neg_lo:[0,0,1] neg_hi:[0,0,1]
v_pk_fma_f32 v[96:97], v[96:97], v[226:227], v[80:81] op_sel_hi:[1,0,0] neg_lo:[0,0,1] neg_hi:[0,0,1]
v_pk_fma_f32 v[98:99], v[98:99], v[226:227], v[80:81] op_sel_hi:[1,0,0] neg_lo:[0,0,1] neg_hi:[0,0,1]
v_pk_fma_f32 v[112:113], v[112:113], v[226:227], v[80:81] op_sel_hi:[1,0,0] neg_lo:[0,0,1] neg_hi:[0,0,1]
v_pk_fma_f32 v[114:115], v[114:115], v[226:227], v[80:81] op_sel_hi:[1,0,0] neg_lo:[0,0,1] neg_hi:[0,0,1]
v_pk_fma_f32 v[92:93], v[92:93], v[222:223], v[76:77] op_sel_hi:[1,0,0] neg_lo:[0,0,1] neg_hi:[0,0,1]
v_pk_fma_f32 v[94:95], v[94:95], v[222:223], v[76:77] op_sel_hi:[1,0,0] neg_lo:[0,0,1] neg_hi:[0,0,1]
v_pk_fma_f32 v[108:109], v[108:109], v[222:223], v[76:77] op_sel_hi:[1,0,0] neg_lo:[0,0,1] neg_hi:[0,0,1]
v_pk_fma_f32 v[110:111], v[110:111], v[222:223], v[76:77] op_sel_hi:[1,0,0] neg_lo:[0,0,1] neg_hi:[0,0,1]
v_pk_fma_f32 v[136:137], v[18:19], v[44:45], v[136:137] op_sel_hi:[1,0,1]
v_pk_mul_f32 v[136:137], v[136:137], v[22:23]
v_pk_fma_f32 v[138:139], v[20:21], v[44:45], v[138:139] op_sel_hi:[1,0,1]
v_pk_mul_f32 v[138:139], v[138:139], v[24:25]
v_pk_fma_f32 v[152:153], v[18:19], v[44:45], v[152:153] op_sel:[0,1,0] op_sel_hi:[1,1,1]
v_pk_mul_f32 v[152:153], v[152:153], v[22:23]
v_pk_fma_f32 v[154:155], v[20:21], v[44:45], v[154:155] op_sel:[0,1,0] op_sel_hi:[1,1,1]
v_pk_mul_f32 v[154:155], v[154:155], v[24:25]
v_exp_f32 v104, v104
s_nop 0
MAA 132,8,96
buffer_load_dwordx4 v5, s[24:27], s58 offen lds
MAA 132,28,100
v_exp_f32 v105, v105
MAA 132,48,160
v_exp_f32 v106, v106
MAA 132,68,164
v_exp_f32 v107, v107
MAA 148,68,172
buffer_load_dwordx4 v6, s[24:27], s58 offen offset:1024 lds
MAA 148,48,168
s_add_u32 m0, s59, 116480
s_xor_b32 s58, s87, 786432
v_exp_f32 v120, v120
MAA 148,28,124
v_exp_f32 v121, v121
MAA 148,8,120
v_exp_f32 v122, v122
MAA 128,4,96
buffer_load_dwordx4 v5, s[24:27], s58 offen lds
MAA 128,24,100
v_exp_f32 v123, v123
MAA 128,44,160
v_exp_f32 v100, v100
MAA 128,64,164
v_exp_f32 v101, v101
MAA 144,64,172
buffer_load_dwordx4 v6, s[24:27], s58 offen offset:1024 lds
MAA 144,44,168
s_add_u32 m0, s59, 124800
s_xor_b32 s58, s87, 917504
v_exp_f32 v102, v102
MAA 144,24,124
v_exp_f32 v103, v103
MAA 144,4,120
v_exp_f32 v116, v116
MAA 124,0,96
buffer_load_dwordx4 v5, s[24:27], s58 offen lds
MAA 124,20,100
v_exp_f32 v117, v117
MAA 124,40,160
v_exp_f32 v118, v118
MAA 124,60,164
v_exp_f32 v119, v119
MAA 140,60,172
buffer_load_dwordx4 v6, s[24:27], s58 offen offset:1024 lds
MAA 140,40,168
v_exp_f32 v96, v96
MAA 140,20,124
v_exp_f32 v97, v97
MAA 140,0,120
v_cvt_pk_bf16_f32 v72, v104, v105
v_cvt_pk_bf16_f32 v73, v106, v107
v_cvt_pk_bf16_f32 v74, v120, v121
v_cvt_pk_bf16_f32 v75, v122, v123
v_cvt_pk_bf16_f32 v68, v100, v101
v_cvt_pk_bf16_f32 v69, v102, v103
v_cvt_pk_bf16_f32 v70, v116, v117
v_cvt_pk_bf16_f32 v71, v118, v119
v_exp_f32 v98, v98
v_exp_f32 v99, v99
v_exp_f32 v112, v112
v_exp_f32 v113, v113
v_exp_f32 v114, v114
v_exp_f32 v115, v115
v_cvt_pk_bf16_f32 v64, v96, v97
v_cvt_pk_bf16_f32 v65, v98, v99
v_cvt_pk_bf16_f32 v66, v112, v113
v_cvt_pk_bf16_f32 v67, v114, v115
v_cvt_pk_bf16_f32 v208, v136, v137
v_cvt_pk_bf16_f32 v209, v138, v139
v_cvt_pk_bf16_f32 v218, v152, v153
v_cvt_pk_bf16_f32 v219, v154, v155
s_waitcnt lgkmcnt(5)
v_pk_fma_f32 v[132:133], v[240:241], v[44:45], v[132:133] op_sel_hi:[1,0,1]
s_waitcnt lgkmcnt(4)
v_pk_mul_f32 v[132:133], v[132:133], v[244:245]
v_cvt_pk_bf16_f32 v206, v132, v133
v_pk_fma_f32 v[134:135], v[242:243], v[44:45], v[134:135] op_sel_hi:[1,0,1]
v_pk_mul_f32 v[134:135], v[134:135], v[246:247]
v_cvt_pk_bf16_f32 v207, v134, v135
v_pk_fma_f32 v[148:149], v[240:241], v[44:45], v[148:149] op_sel:[0,1,0] op_sel_hi:[1,1,1]
v_pk_mul_f32 v[148:149], v[148:149], v[244:245]
v_cvt_pk_bf16_f32 v216, v148, v149
v_pk_fma_f32 v[150:151], v[242:243], v[44:45], v[150:151] op_sel:[0,1,0] op_sel_hi:[1,1,1]
v_pk_mul_f32 v[150:151], v[150:151], v[246:247]
v_cvt_pk_bf16_f32 v217, v150, v151
s_waitcnt lgkmcnt(3)
v_pk_fma_f32 v[128:129], v[28:29], v[44:45], v[128:129] op_sel_hi:[1,0,1]
s_waitcnt lgkmcnt(2)
v_pk_mul_f32 v[128:129], v[128:129], v[32:33]
v_cvt_pk_bf16_f32 v204, v128, v129
v_pk_fma_f32 v[130:131], v[30:31], v[44:45], v[130:131] op_sel_hi:[1,0,1]
v_pk_mul_f32 v[130:131], v[130:131], v[34:35]
v_cvt_pk_bf16_f32 v205, v130, v131
v_pk_fma_f32 v[144:145], v[28:29], v[44:45], v[144:145] op_sel:[0,1,0] op_sel_hi:[1,1,1]
v_pk_mul_f32 v[144:145], v[144:145], v[32:33]
v_cvt_pk_bf16_f32 v214, v144, v145
v_pk_fma_f32 v[146:147], v[30:31], v[44:45], v[146:147] op_sel:[0,1,0] op_sel_hi:[1,1,1]
v_pk_mul_f32 v[146:147], v[146:147], v[34:35]
v_cvt_pk_bf16_f32 v215, v146, v147
s_waitcnt lgkmcnt(1)
v_pk_fma_f32 v[124:125], v[36:37], v[44:45], v[124:125] op_sel_hi:[1,0,1]
s_waitcnt lgkmcnt(0)
v_pk_mul_f32 v[124:125], v[124:125], v[40:41]
v_cvt_pk_bf16_f32 v202, v124, v125
v_pk_fma_f32 v[126:127], v[38:39], v[44:45], v[126:127] op_sel_hi:[1,0,1]
v_pk_mul_f32 v[126:127], v[126:127], v[42:43]
v_cvt_pk_bf16_f32 v203, v126, v127
v_pk_fma_f32 v[140:141], v[36:37], v[44:45], v[140:141] op_sel:[0,1,0] op_sel_hi:[1,1,1]
v_pk_mul_f32 v[140:141], v[140:141], v[40:41]
v_cvt_pk_bf16_f32 v212, v140, v141
v_pk_fma_f32 v[142:143], v[38:39], v[44:45], v[142:143] op_sel:[0,1,0] op_sel_hi:[1,1,1]
v_pk_mul_f32 v[142:143], v[142:143], v[42:43]
v_cvt_pk_bf16_f32 v213, v142, v143
s_nop 0
v_mfma_f32_16x16x32_bf16 v[88:91], v[248:251], v[72:75], 0
v_exp_f32 v92, v92
v_mfma_f32_16x16x32_bf16 v[104:107], v[206:209], v[72:75], 0
v_exp_f32 v93, v93
v_mfma_f32_16x16x32_bf16 v[120:123], v[216:219], v[72:75], 0
v_exp_f32 v94, v94
v_mfma_f32_16x16x32_bf16 v[84:87], v[248:251], v[68:71], 0
v_exp_f32 v95, v95
v_mfma_f32_16x16x32_bf16 v[100:103], v[204:207], v[68:71], 0
v_exp_f32 v108, v108
v_mfma_f32_16x16x32_bf16 v[116:119], v[214:217], v[68:71], 0
v_exp_f32 v109, v109
v_mfma_f32_16x16x32_bf16 v[80:83], v[248:251], v[64:67], 0
v_exp_f32 v110, v110
v_mfma_f32_16x16x32_bf16 v[96:99], v[202:205], v[64:67], 0
v_exp_f32 v111, v111
v_mfma_f32_16x16x32_bf16 v[112:115], v[212:215], v[64:67], 0
v_cvt_pk_bf16_f32 v60, v92, v93
v_cvt_pk_bf16_f32 v61, v94, v95
v_cvt_pk_bf16_f32 v62, v108, v109
v_cvt_pk_bf16_f32 v63, v110, v111
v_rcp_f32 v88, v88
v_rcp_f32 v84, v84
v_mfma_f32_16x16x32_bf16 v[76:79], v[248:251], v[60:63], 0
v_rcp_f32 v80, v80
v_mfma_f32_16x16x32_bf16 v[92:95], v[200:203], v[60:63], 0
v_mfma_f32_16x16x32_bf16 v[108:111], v[210:213], v[60:63], 0
s_nop 4
v_rcp_f32 v76, v76
v_pk_mul_f32 v[104:105], v[104:105], v[88:89] op_sel_hi:[1,0]
v_pk_mul_f32 v[106:107], v[106:107], v[88:89] op_sel_hi:[1,0]
v_pk_mul_f32 v[120:121], v[120:121], v[88:89] op_sel_hi:[1,0]
v_pk_mul_f32 v[122:123], v[122:123], v[88:89] op_sel_hi:[1,0]
v_cvt_pk_bf16_f32 v176, v104, v105
v_cvt_pk_bf16_f32 v177, v106, v107
v_cvt_pk_bf16_f32 v178, v120, v121
v_cvt_pk_bf16_f32 v179, v122, v123
buffer_store_dwordx4 v[176:179], v4, s[16:19], s74 offen offset:3072 sc1
v_pk_mul_f32 v[100:101], v[100:101], v[84:85] op_sel_hi:[1,0]
v_pk_mul_f32 v[102:103], v[102:103], v[84:85] op_sel_hi:[1,0]
v_pk_mul_f32 v[116:117], v[116:117], v[84:85] op_sel_hi:[1,0]
v_pk_mul_f32 v[118:119], v[118:119], v[84:85] op_sel_hi:[1,0]
v_cvt_pk_bf16_f32 v172, v100, v101
v_cvt_pk_bf16_f32 v173, v102, v103
v_cvt_pk_bf16_f32 v174, v116, v117
v_cvt_pk_bf16_f32 v175, v118, v119
buffer_store_dwordx4 v[172:175], v4, s[16:19], s74 offen offset:2048 sc1
v_pk_mul_f32 v[96:97], v[96:97], v[80:81] op_sel_hi:[1,0]
v_pk_mul_f32 v[98:99], v[98:99], v[80:81] op_sel_hi:[1,0]
v_pk_mul_f32 v[112:113], v[112:113], v[80:81] op_sel_hi:[1,0]
v_pk_mul_f32 v[114:115], v[114:115], v[80:81] op_sel_hi:[1,0]
v_cvt_pk_bf16_f32 v168, v96, v97
v_cvt_pk_bf16_f32 v169, v98, v99
v_cvt_pk_bf16_f32 v170, v112, v113
v_cvt_pk_bf16_f32 v171, v114, v115
buffer_store_dwordx4 v[168:171], v4, s[16:19], s74 offen offset:1024 sc1
v_pk_mul_f32 v[92:93], v[92:93], v[76:77] op_sel_hi:[1,0]
v_pk_mul_f32 v[94:95], v[94:95], v[76:77] op_sel_hi:[1,0]
v_pk_mul_f32 v[108:109], v[108:109], v[76:77] op_sel_hi:[1,0]
v_pk_mul_f32 v[110:111], v[110:111], v[76:77] op_sel_hi:[1,0]
v_cvt_pk_bf16_f32 v164, v92, v93
v_cvt_pk_bf16_f32 v165, v94, v95
v_cvt_pk_bf16_f32 v166, v108, v109
v_cvt_pk_bf16_f32 v167, v110, v111
buffer_store_dwordx4 v[164:167], v4, s[16:19], s74 offen sc1
s_nop 1
.Lqkve56:
s_lshl_b32 s62, s3, 11
s_add_u32 s62, s62, s84
v_lshl_add_u32 v4, v1, 4, s62
v_lshrrev_b32 v2, 3, v1
v_cmp_eq_u32 vcc, 3, v2
v_add_u32 v2, 67108480, v4
s_nop 0
v_cndmask_b32 v4, v4, v2, vcc
v_bfe_u32 v5, v1, 3, 1
v_lshrrev_b32 v2, 4, v1
v_lshl_add_u32 v5, v2, 3, v5
s_lshl_b32 s62, s3, 1
v_add_u32 v5, s62, v5
v_mul_u32_u24 v5, 2048, v5
v_and_b32 v2, 7, v1
v_lshl_add_u32 v5, v2, 4, v5
s_lshl_b32 s62, s7, 7
v_add_u32 v5, s62, v5
v_add_u32 v6, 64512, v5
v_bfe_u32 v8, v1, 3, 2
v_mul_u32_u24 v8, 2080, v8
v_bfe_u32 v2, v1, 2, 1
v_lshl_add_u32 v8, v2, 7, v8
v_bfe_u32 v2, v1, 5, 1
v_lshl_add_u32 v8, v2, 8, v8
v_and_b32 v2, 3, v1
v_lshl_add_u32 v8, v2, 3, v8
s_mov_b32 s57, 66560
v_add_u32 v7, s57, v8
s_lshr_b32 s54, s87, 17
s_lshl_b32 s54, s54, 18
s_add_u32 s54, s54, 37748736
s_mov_b32 s52, s54
s_add_u32 s53, s54, 131072
v_accvgpr_read_b32 v32, a224
v_accvgpr_read_b32 v33, a225
v_accvgpr_read_b32 v34, a226
v_accvgpr_read_b32 v35, a227
v_accvgpr_read_b32 v36, a228
v_accvgpr_read_b32 v37, a229
v_accvgpr_read_b32 v38, a230
v_accvgpr_read_b32 v39, a231
v_accvgpr_read_b32 v40, a232
v_accvgpr_read_b32 v41, a233
v_accvgpr_read_b32 v42, a234
v_accvgpr_read_b32 v43, a235
v_accvgpr_read_b32 v44, a236
v_accvgpr_read_b32 v45, a237
v_accvgpr_read_b32 v46, a238
v_accvgpr_read_b32 v47, a239
v_accvgpr_read_b32 v48, a240
v_accvgpr_read_b32 v49, a241
v_accvgpr_read_b32 v50, a242
v_accvgpr_read_b32 v51, a243
v_accvgpr_read_b32 v52, a244
v_accvgpr_read_b32 v53, a245
v_accvgpr_read_b32 v54, a246
v_accvgpr_read_b32 v55, a247
v_accvgpr_read_b32 v56, a248
v_accvgpr_read_b32 v57, a249
v_accvgpr_read_b32 v58, a250
v_accvgpr_read_b32 v59, a251
v_accvgpr_read_b32 v60, a252
v_accvgpr_read_b32 v61, a253
v_accvgpr_read_b32 v62, a254
v_accvgpr_read_b32 v63, a255
s_lshl_b32 s62, s49, 3
s_add_u32 s62, s62, s48
s_mul_i32 s62, s62, 28672
s_add_u32 s62, s62, s51
v_lshrrev_b32 v12, 4, v1
v_mul_u32_u24 v12, 57344, v12
v_and_b32 v2, 15, v1
v_lshl_add_u32 v12, v2, 4, v12
v_add_u32 v12, s62, v12
v_add_u32 v13, 6112, v12
v_add_u32 v14, 12224, v12
v_add_u32 v15, 18336, v12
s_mul_i32 s59, s3, 4224
s_mov_b32 s58, 0
s_lshl_b32 s62, s8, 10
s_add_u32 s62, s62, 30490624
s_lshl_b32 s64, s6, 10
s_add_u32 s64, s64, 30490624
s_lshr_b32 s67, s5, 2
s_and_b32 s67, s67, 3
s_lshl_b32 s67, s67, 7
s_add_u32 s64, s64, s67
v_lshl_add_u32 v252, v1, 7, s62
v_mov_b32 v253, s64
v_mov_b32 v255, 1
s_waitcnt vmcnt(0) lgkmcnt(0)
s_cmp_lg_u32 s3, 1
s_barrier
s_cbranch_scc1 .Lfirst61
s_mov_b64 exec, 15
buffer_atomic_add v255, v252, s[16:19], 0 offen
s_mov_b64 exec, 1
v_mov_b32 v254, 0
buffer_atomic_add v254, v253, s[16:19], 0 offen sc0
s_mov_b64 exec, -1
.Lfirst61:
.Lpad29:
s_cbranch_execz .Lnopoll53r
ds_read_b64_tr_b16 a[0:1], v7
TR 2,7,512
TR 16,7,1024
TR 18,7,1536
TR 4,7,32
TR 6,7,544
TR 20,7,1056
TR 22,7,1568
TR 8,7,64
TR 10,7,576
TR 24,7,1088
TR 26,7,1600
TR 12,7,96
TR 14,7,608
TR 28,7,1120
TR 30,7,1632
s_waitcnt lgkmcnt(0)
s_cmp_lg_u32 s3, 1
s_cbranch_scc1 .Lnopoll60
s_mov_b64 exec, 1
s_mov_b32 s15, 0
.Lpoll59:
v_mov_b32 v255, 0
buffer_atomic_add v255, v253, s[16:19], 0 offen sc0
s_waitcnt vmcnt(1)
v_cmp_gt_u32 vcc, 16, v254
s_add_u32 s15, s15, 1
s_cbranch_vccz .Lnopoll60r
v_mov_b32 v254, 0
buffer_atomic_add v254, v253, s[16:19], 0 offen sc0
s_waitcnt vmcnt(1)
v_cmp_gt_u32 vcc, 16, v255
s_add_u32 s15, s15, 1
s_cbranch_vccz .Lnopoll60r
s_cmp_le_u32 s15, 100000
s_cbranch_scc1 .Lpoll59
s_branch .Lnopoll60r
.Lnopoll60:
s_mov_b64 exec, 0
s_cmp_eq_u32 s3, 2
s_cbranch_scc1 .Lpad30
s_cmp_eq_u32 s3, 3
s_cbranch_scc1 .Lpad31
s_branch .Lpad32
.Lnopoll60r:
s_mov_b64 exec, -1
s_barrier
buffer_load_dwordx4 v[64:67], v4, s[16:19], s52 offen sc1
buffer_load_dwordx4 v[68:71], v4, s[16:19], s52 offen offset:1024 sc1
s_xor_b32 s52, s54, 262144
buffer_load_dwordx4 v[72:75], v4, s[16:19], s53 offen sc1
buffer_load_dwordx4 v[76:79], v4, s[16:19], s53 offen offset:1024 sc1
s_xor_b32 s53, s54, 393216
buffer_load_dwordx4 v[80:83], v4, s[16:19], s52 offen sc1
buffer_load_dwordx4 v[84:87], v4, s[16:19], s52 offen offset:1024 sc1
s_xor_b32 s52, s54, 524288
buffer_load_dwordx4 v[88:91], v4, s[16:19], s53 offen sc1
buffer_load_dwordx4 v[92:95], v4, s[16:19], s53 offen offset:1024 sc1
s_xor_b32 s53, s54, 655360
buffer_load_dwordx4 v[96:99], v4, s[16:19], s52 offen sc1
buffer_load_dwordx4 v[100:103], v4, s[16:19], s52 offen offset:1024 sc1
s_xor_b32 s52, s54, 786432
buffer_load_dwordx4 v[104:107], v4, s[16:19], s53 offen sc1
buffer_load_dwordx4 v[108:111], v4, s[16:19], s53 offen offset:1024 sc1
s_xor_b32 s53, s54, 917504
s_waitcnt vmcnt(8)
MAV 32,0,64
TR 32,7,8320
MAV 32,16,72
buffer_load_dwordx4 v[112:115], v4, s[16:19], s52 offen sc1
MAV 48,16,76
TR 34,7,8832
MAV 48,0,68
TR 48,7,9344
TR 50,7,9856
MAV 52,4,68
TR 36,7,8352
MAV 52,20,76
buffer_load_dwordx4 v[116:119], v4, s[16:19], s52 offen offset:1024 sc1
MAV 36,20,72
TR 38,7,8864
s_xor_b32 s52, s54, 1048576
MAV 36,4,64
TR 52,7,9376
TR 54,7,9888
MAV 40,8,64
TR 40,7,8384
MAV 40,24,72
buffer_load_dwordx4 v[120:123], v4, s[16:19], s53 offen sc1
MAV 56,24,76
TR 42,7,8896
MAV 56,8,68
TR 56,7,9408
TR 58,7,9920
MAV 60,12,68
TR 44,7,8416
MAV 60,28,76
buffer_load_dwordx4 v[124:127], v4, s[16:19], s53 offen offset:1024 sc1
MAV 44,28,72
TR 46,7,8928
s_xor_b32 s53, s54, 1179648
MAV 44,12,64
TR 60,7,9440
TR 62,7,9952
s_waitcnt vmcnt(8) lgkmcnt(8)
MAV 32,32,80
TR 0,7,16640
MAV 32,48,88
buffer_load_dwordx4 v[64:67], v4, s[16:19], s52 offen sc1
MAV 48,48,92
TR 2,7,17152
MAV 48,32,84
TR 16,7,17664
TR 18,7,18176
MAV 52,36,84
TR 4,7,16672
MAV 52,52,92
buffer_load_dwordx4 v[68:71], v4, s[16:19], s52 offen offset:1024 sc1
MAV 36,52,88
TR 6,7,17184
s_xor_b32 s52, s54, 1310720
MAV 36,36,80
TR 20,7,17696
TR 22,7,18208
s_waitcnt lgkmcnt(8)
MAV 40,40,80
TR 8,7,16704
MAV 40,56,88
buffer_load_dwordx4 v[72:75], v4, s[16:19], s53 offen sc1
MAV 56,56,92
TR 10,7,17216
MAV 56,40,84
TR 24,7,17728
TR 26,7,18240
MAV 60,44,84
TR 12,7,16736
MAV 60,60,92
buffer_load_dwordx4 v[76:79], v4, s[16:19], s53 offen offset:1024 sc1
MAV 44,60,88
TR 14,7,17248
s_xor_b32 s53, s54, 1441792
MAV 44,44,80
TR 28,7,17760
TR 30,7,18272
s_waitcnt vmcnt(8) lgkmcnt(8)
MAV 32,0,96
TR 32,7,24960
MAV 32,16,104
buffer_load_dwordx4 v[80:83], v4, s[16:19], s52 offen sc1
MAV 48,16,108
TR 34,7,25472
MAV 48,0,100
TR 48,7,25984
TR 50,7,26496
MAV 52,4,100
TR 36,7,24992
MAV 52,20,108
buffer_load_dwordx4 v[84:87], v4, s[16:19], s52 offen offset:1024 sc1
MAV 36,20,104
TR 38,7,25504
s_xor_b32 s52, s54, 1572864
MAV 36,4,96
TR 52,7,26016
TR 54,7,26528
s_waitcnt lgkmcnt(8)
MAV 40,8,96
TR 40,7,25024
MAV 40,24,104
buffer_load_dwordx4 v[88:91], v4, s[16:19], s53 offen sc1
MAV 56,24,108
TR 42,7,25536
MAV 56,8,100
TR 56,7,26048
TR 58,7,26560
MAV 60,12,100
TR 44,7,25056
MAV 60,28,108
buffer_load_dwordx4 v[92:95], v4, s[16:19], s53 offen offset:1024 sc1
MAV 44,28,104
TR 46,7,25568
s_xor_b32 s53, s54, 1703936
MAV 44,12,96
TR 60,7,26080
TR 62,7,26592
s_waitcnt vmcnt(8) lgkmcnt(8)
MAV 32,32,112
TR 0,7,33280
MAV 32,48,120
buffer_load_dwordx4 v[96:99], v4, s[16:19], s52 offen sc1
MAV 48,48,124
TR 2,7,33792
MAV 48,32,116
TR 16,7,34304
TR 18,7,34816
MAV 52,36,116
TR 4,7,33312
MAV 52,52,124
buffer_load_dwordx4 v[100:103], v4, s[16:19], s52 offen offset:1024 sc1
MAV 36,52,120
TR 6,7,33824
s_xor_b32 s52, s54, 1835008
MAV 36,36,112
TR 20,7,34336
TR 22,7,34848
s_waitcnt lgkmcnt(8)
MAV 40,40,112
TR 8,7,33344
MAV 40,56,120
buffer_load_dwordx4 v[104:107], v4, s[16:19], s53 offen sc1
MAV 56,56,124
TR 10,7,33856
MAV 56,40,116
TR 24,7,34368
TR 26,7,34880
MAV 60,44,116
TR 12,7,33376
MAV 60,60,124
buffer_load_dwordx4 v[108:111], v4, s[16:19], s53 offen offset:1024 sc1
MAV 44,60,120
TR 14,7,33888
s_xor_b32 s53, s54, 1966080
MAV 44,44,112
TR 28,7,34400
TR 30,7,34912
s_waitcnt vmcnt(8) lgkmcnt(8)
MAV 32,0,64
TR 32,7,41600
MAV 32,16,72
buffer_load_dwordx4 v[112:115], v4, s[16:19], s52 offen sc1
MAV 48,16,76
TR 34,7,42112
MAV 48,0,68
TR 48,7,42624
TR 50,7,43136
MAV 52,4,68
TR 36,7,41632
MAV 52,20,76
buffer_load_dwordx4 v[116:119], v4, s[16:19], s52 offen offset:1024 sc1
MAV 36,20,72
TR 38,7,42144
s_xor_b32 s52, s54, 2097152
MAV 36,4,64
TR 52,7,42656
TR 54,7,43168
s_waitcnt lgkmcnt(8)
MAV 40,8,64
TR 40,7,41664
MAV 40,24,72
buffer_load_dwordx4 v[120:123], v4, s[16:19], s53 offen sc1
MAV 56,24,76
TR 42,7,42176
MAV 56,8,68
TR 56,7,42688
TR 58,7,43200
MAV 60,12,68
TR 44,7,41696
MAV 60,28,76
buffer_load_dwordx4 v[124:127], v4, s[16:19], s53 offen offset:1024 sc1
MAV 44,28,72
TR 46,7,42208
s_xor_b32 s53, s54, 2228224
MAV 44,12,64
TR 60,7,42720
TR 62,7,43232
s_waitcnt vmcnt(8) lgkmcnt(8)
MAV 32,32,80
TR 0,7,49920
MAV 32,48,88
buffer_load_dwordx4 v[64:67], v4, s[16:19], s52 offen sc1
MAV 48,48,92
TR 2,7,50432
MAV 48,32,84
TR 16,7,50944
TR 18,7,51456
MAV 52,36,84
TR 4,7,49952
MAV 52,52,92
buffer_load_dwordx4 v[68:71], v4, s[16:19], s52 offen offset:1024 sc1
MAV 36,52,88
TR 6,7,50464
s_xor_b32 s52, s54, 2359296
MAV 36,36,80
TR 20,7,50976
TR 22,7,51488
s_waitcnt lgkmcnt(8)
MAV 40,40,80
TR 8,7,49984
MAV 40,56,88
buffer_load_dwordx4 v[72:75], v4, s[16:19], s53 offen sc1
MAV 56,56,92
TR 10,7,50496
MAV 56,40,84
TR 24,7,51008
TR 26,7,51520
MAV 60,44,84
TR 12,7,50016
MAV 60,60,92
buffer_load_dwordx4 v[76:79], v4, s[16:19], s53 offen offset:1024 sc1
MAV 44,60,88
TR 14,7,50528
s_xor_b32 s53, s54, 2490368
MAV 44,44,80
TR 28,7,51040
TR 30,7,51552
s_waitcnt vmcnt(8) lgkmcnt(8)
MAV 32,0,96
TR 32,7,58240
MAV 32,16,104
buffer_load_dwordx4 v[80:83], v4, s[16:19], s52 offen sc1
MAV 48,16,108
TR 34,7,58752
MAV 48,0,100
TR 48,7,59264
TR 50,7,59776
MAV 52,4,100
TR 36,7,58272
MAV 52,20,108
buffer_load_dwordx4 v[84:87], v4, s[16:19], s52 offen offset:1024 sc1
MAV 36,20,104
TR 38,7,58784
s_xor_b32 s52, s54, 2621440
MAV 36,4,96
TR 52,7,59296
TR 54,7,59808
s_waitcnt lgkmcnt(8)
MAV 40,8,96
TR 40,7,58304
MAV 40,24,104
buffer_load_dwordx4 v[88:91], v4, s[16:19], s53 offen sc1
MAV 56,24,108
TR 42,7,58816
MAV 56,8,100
TR 56,7,59328
TR 58,7,59840
MAV 60,12,100
TR 44,7,58336
MAV 60,28,108
buffer_load_dwordx4 v[92:95], v4, s[16:19], s53 offen offset:1024 sc1
MAV 44,28,104
TR 46,7,58848
s_xor_b32 s53, s54, 2752512
MAV 44,12,96
TR 60,7,59360
TR 62,7,59872
s_xor_b32 s57, s57, 66560
v_add_u32 v7, s57, v8
s_waitcnt vmcnt(8) lgkmcnt(8)
MAV 32,32,112
ds_read_b64_tr_b16 a[0:1], v7
MAV 32,48,120
buffer_load_dwordx4 v[96:99], v4, s[16:19], s52 offen sc1
MAV 48,48,124
TR 2,7,512
MAV 48,32,116
TR 16,7,1024
TR 18,7,1536
MAV 52,36,116
TR 4,7,32
MAV 52,52,124
buffer_load_dwordx4 v[100:103], v4, s[16:19], s52 offen offset:1024 sc1
MAV 36,52,120
TR 6,7,544
s_xor_b32 s52, s54, 2883584
MAV 36,36,112
TR 20,7,1056
TR 22,7,1568
s_waitcnt lgkmcnt(8)
MAV 40,40,112
TR 8,7,64
MAV 40,56,120
buffer_load_dwordx4 v[104:107], v4, s[16:19], s53 offen sc1
MAV 56,56,124
TR 10,7,576
MAV 56,40,116
TR 24,7,1088
TR 26,7,1600
MAV 60,44,116
TR 12,7,96
MAV 60,60,124
buffer_load_dwordx4 v[108:111], v4, s[16:19], s53 offen offset:1024 sc1
MAV 44,60,120
TR 14,7,608
s_xor_b32 s53, s54, 3014656
MAV 44,44,112
TR 28,7,1120
TR 30,7,1632
s_waitcnt vmcnt(8) lgkmcnt(8)
MAV 32,0,64
TR 32,7,8320
MAV 32,16,72
buffer_load_dwordx4 v[112:115], v4, s[16:19], s52 offen sc1
MAV 48,16,76
TR 34,7,8832
MAV 48,0,68
TR 48,7,9344
TR 50,7,9856
MAV 52,4,68
TR 36,7,8352
MAV 52,20,76
buffer_load_dwordx4 v[116:119], v4, s[16:19], s52 offen offset:1024 sc1
MAV 36,20,72
TR 38,7,8864
s_xor_b32 s52, s54, 3145728
MAV 36,4,64
TR 52,7,9376
TR 54,7,9888
s_waitcnt lgkmcnt(8)
MAV 40,8,64
TR 40,7,8384
MAV 40,24,72
buffer_load_dwordx4 v[120:123], v4, s[16:19], s53 offen sc1
MAV 56,24,76
TR 42,7,8896
MAV 56,8,68
TR 56,7,9408
TR 58,7,9920
MAV 60,12,68
TR 44,7,8416
MAV 60,28,76
buffer_load_dwordx4 v[124:127], v4, s[16:19], s53 offen offset:1024 sc1
MAV 44,28,72
TR 46,7,8928
s_xor_b32 s53, s54, 3276800
MAV 44,12,64
TR 60,7,9440
TR 62,7,9952
s_waitcnt vmcnt(8) lgkmcnt(8)
MAV 32,32,80
TR 0,7,16640
MAV 32,48,88
buffer_load_dwordx4 v[64:67], v4, s[16:19], s52 offen sc1
MAV 48,48,92
TR 2,7,17152
MAV 48,32,84
TR 16,7,17664
TR 18,7,18176
MAV 52,36,84
TR 4,7,16672
MAV 52,52,92
buffer_load_dwordx4 v[68:71], v4, s[16:19], s52 offen offset:1024 sc1
MAV 36,52,88
TR 6,7,17184
s_xor_b32 s52, s54, 3407872
MAV 36,36,80
TR 20,7,17696
TR 22,7,18208
s_waitcnt lgkmcnt(8)
MAV 40,40,80
TR 8,7,16704
MAV 40,56,88
buffer_load_dwordx4 v[72:75], v4, s[16:19], s53 offen sc1
MAV 56,56,92
TR 10,7,17216
MAV 56,40,84
TR 24,7,17728
TR 26,7,18240
MAV 60,44,84
TR 12,7,16736
MAV 60,60,92
buffer_load_dwordx4 v[76:79], v4, s[16:19], s53 offen offset:1024 sc1
MAV 44,60,88
TR 14,7,17248
s_xor_b32 s53, s54, 3538944
MAV 44,44,80
TR 28,7,17760
TR 30,7,18272
s_waitcnt vmcnt(8) lgkmcnt(8)
MAV 32,0,96
TR 32,7,24960
MAV 32,16,104
buffer_load_dwordx4 v[80:83], v4, s[16:19], s52 offen sc1
MAV 48,16,108
TR 34,7,25472
MAV 48,0,100
TR 48,7,25984
TR 50,7,26496
MAV 52,4,100
TR 36,7,24992
MAV 52,20,108
buffer_load_dwordx4 v[84:87], v4, s[16:19], s52 offen offset:1024 sc1
MAV 36,20,104
TR 38,7,25504
s_xor_b32 s52, s54, 3670016
MAV 36,4,96
TR 52,7,26016
TR 54,7,26528
s_waitcnt lgkmcnt(8)
MAV 40,8,96
TR 40,7,25024
MAV 40,24,104
buffer_load_dwordx4 v[88:91], v4, s[16:19], s53 offen sc1
MAV 56,24,108
TR 42,7,25536
MAV 56,8,100
TR 56,7,26048
TR 58,7,26560
MAV 60,12,100
TR 44,7,25056
MAV 60,28,108
buffer_load_dwordx4 v[92:95], v4, s[16:19], s53 offen offset:1024 sc1
MAV 44,28,104
TR 46,7,25568
s_xor_b32 s53, s54, 3801088
MAV 44,12,96
TR 60,7,26080
TR 62,7,26592
s_waitcnt vmcnt(8) lgkmcnt(8)
MAV 32,32,112
TR 0,7,33280
MAV 32,48,120
buffer_load_dwordx4 v[96:99], v4, s[16:19], s52 offen sc1
MAV 48,48,124
TR 2,7,33792
MAV 48,32,116
TR 16,7,34304
TR 18,7,34816
MAV 52,36,116
TR 4,7,33312
MAV 52,52,124
buffer_load_dwordx4 v[100:103], v4, s[16:19], s52 offen offset:1024 sc1
MAV 36,52,120
TR 6,7,33824
s_xor_b32 s52, s54, 3932160
MAV 36,36,112
TR 20,7,34336
TR 22,7,34848
s_waitcnt lgkmcnt(8)
MAV 40,40,112
TR 8,7,33344
MAV 40,56,120
buffer_load_dwordx4 v[104:107], v4, s[16:19], s53 offen sc1
MAV 56,56,124
TR 10,7,33856
MAV 56,40,116
TR 24,7,34368
TR 26,7,34880
MAV 60,44,116
TR 12,7,33376
MAV 60,60,124
.Lpad30:
s_cbranch_execz .Lpad33
buffer_load_dwordx4 v[108:111], v4, s[16:19], s53 offen offset:1024 sc1
MAV 44,60,120
TR 14,7,33888
s_xor_b32 s53, s54, 4063232
MAV 44,44,112
TR 28,7,34400
TR 30,7,34912
s_waitcnt vmcnt(8) lgkmcnt(8)
MAV 32,0,64
TR 32,7,41600
MAV 32,16,72
buffer_load_dwordx4 v[112:115], v4, s[16:19], s52 offen sc1
MAV 48,16,76
TR 34,7,42112
MAV 48,0,68
TR 48,7,42624
TR 50,7,43136
MAV 52,4,68
TR 36,7,41632
MAV 52,20,76
buffer_load_dwordx4 v[116:119], v4, s[16:19], s52 offen offset:1024 sc1
MAV 36,20,72
TR 38,7,42144
MAV 36,4,64
TR 52,7,42656
TR 54,7,43168
s_waitcnt lgkmcnt(8)
MAV 40,8,64
TR 40,7,41664
MAV 40,24,72
buffer_load_dwordx4 v[120:123], v4, s[16:19], s53 offen sc1
MAV 56,24,76
TR 42,7,42176
MAV 56,8,68
TR 56,7,42688
TR 58,7,43200
MAV 60,12,68
TR 44,7,41696
MAV 60,28,76
buffer_load_dwordx4 v[124:127], v4, s[16:19], s53 offen offset:1024 sc1
MAV 44,28,72
TR 46,7,42208
MAV 44,12,64
TR 60,7,42720
TR 62,7,43232
s_barrier
s_waitcnt vmcnt(8) lgkmcnt(8)
MAV 32,32,80
TR 0,7,49920
s_add_u32 m0, s59, 84480
MAV 32,48,88
buffer_load_dwordx4 v12, s[32:35], s58 offen   lds
MAV 48,48,92
TR 2,7,50432
MAV 48,32,84
TR 16,7,50944
TR 18,7,51456
MAV 52,36,84
TR 4,7,49952
MAV 52,52,92
buffer_load_dwordx4 v13, s[32:35], s58 offen offset:1056   lds
MAV 36,52,88
TR 6,7,50464
MAV 36,36,80
TR 20,7,50976
TR 22,7,51488
s_waitcnt lgkmcnt(8)
MAV 40,40,80
TR 8,7,49984
MAV 40,56,88
buffer_load_dwordx4 v14, s[32:35], s58 offen offset:2112   lds
MAV 56,56,92
TR 10,7,50496
MAV 56,40,84
TR 24,7,51008
TR 26,7,51520
MAV 60,44,84
TR 12,7,50016
MAV 60,60,92
buffer_load_dwordx4 v15, s[32:35], s58 offen offset:3168   lds
MAV 44,60,88
TR 14,7,50528
MAV 44,44,80
TR 28,7,51040
TR 30,7,51552
s_waitcnt vmcnt(8) lgkmcnt(8)
MAV 32,0,96
TR 32,7,58240
s_add_u32 m0, s59, 101376
MAV 32,16,104
buffer_load_dwordx4 v12, s[80:83], s58 offen   lds
MAV 48,16,108
TR 34,7,58752
MAV 48,0,100
TR 48,7,59264
TR 50,7,59776
MAV 52,4,100
TR 36,7,58272
MAV 52,20,108
buffer_load_dwordx4 v13, s[80:83], s58 offen offset:1056   lds
MAV 36,20,104
TR 38,7,58784
MAV 36,4,96
TR 52,7,59296
TR 54,7,59808
s_waitcnt lgkmcnt(8)
MAV 40,8,96
TR 40,7,58304
MAV 40,24,104
buffer_load_dwordx4 v14, s[80:83], s58 offen offset:2112   lds
MAV 56,24,108
TR 42,7,58816
MAV 56,8,100
TR 56,7,59328
TR 58,7,59840
MAV 60,12,100
TR 44,7,58336
MAV 60,28,108
buffer_load_dwordx4 v15, s[80:83], s58 offen offset:3168   lds
MAV 44,28,104
TR 46,7,58848
s_add_u32 s58, s58, 458752
MAV 44,12,96
TR 60,7,59360
TR 62,7,59872
s_waitcnt vmcnt(11) lgkmcnt(14)
MAV 32,32,112
s_add_u32 m0, s59, 118272
s_lshl_b32 s64, s6, 14
s_lshl_b32 s65, s49, 13
s_waitcnt vmcnt(9) lgkmcnt(12)
MAV 32,48,120
buffer_load_dwordx4 v12, s[32:35], s58 offen   lds
s_waitcnt vmcnt(9)
MAV 48,48,124
s_add_u32 s64, s64, s65
s_lshl_b32 s65, s7, 9
s_add_u32 s64, s64, s65
MAV 48,32,116
s_lshl_b32 s65, s48, 8
s_add_u32 s64, s64, s65
s_add_u32 s64, s64, 63176704
s_waitcnt lgkmcnt(10)
MAV 52,36,116
s_lshl_b32 s62, s7, 18
v_and_b32 v152, 31, v1
v_lshlrev_b32 v152, 3, v152
s_waitcnt lgkmcnt(8)
MAV 52,52,124
buffer_load_dwordx4 v13, s[32:35], s58 offen offset:1056   lds
MAV 36,52,120
s_add_u32 s62, s62, 41943040
v_lshrrev_b32 v153, 5, v1
v_lshl_add_u32 v152, v153, 28, v152
MAV 36,36,112
s_add_u32 s63, s62, 131072
v_cvt_pk_bf16_f32 v128, v32, v33
v_cvt_pk_bf16_f32 v129, v34, v35
s_waitcnt lgkmcnt(6)
MAV 40,40,112
v_cvt_pk_bf16_f32 v136, v48, v49
v_cvt_pk_bf16_f32 v137, v50, v51
s_waitcnt lgkmcnt(4)
MAV 40,56,120
buffer_load_dwordx4 v14, s[32:35], s58 offen offset:2112   lds
MAV 56,56,124
v_cvt_pk_bf16_f32 v130, v36, v37
v_cvt_pk_bf16_f32 v131, v38, v39
MAV 56,40,116
v_cvt_pk_bf16_f32 v138, v52, v53
v_cvt_pk_bf16_f32 v139, v54, v55
s_waitcnt lgkmcnt(2)
MAV 60,44,116
v_cvt_pk_bf16_f32 v132, v40, v41
v_cvt_pk_bf16_f32 v133, v42, v43
s_waitcnt lgkmcnt(0)
MAV 60,60,124
buffer_load_dwordx4 v15, s[32:35], s58 offen offset:3168   lds
MAV 44,60,120
v_cvt_pk_bf16_f32 v140, v56, v57
v_cvt_pk_bf16_f32 v141, v58, v59
MAV 44,44,112
s_nop 2
v_cvt_pk_bf16_f32 v142, v60, v61
v_cvt_pk_bf16_f32 v143, v62, v63
v_pk_mul_f32 v[146:147], v[32:33], v[32:33]
buffer_store_dwordx4 v[128:131], v4, s[16:19], s62 offen sc1
v_pk_mul_f32 v[150:151], v[48:49], v[48:49]
v_pk_fma_f32 v[146:147], v[34:35], v[34:35], v[146:147]
v_pk_add_f32 v[144:145], v[32:33], v[34:35]
v_pk_fma_f32 v[150:151], v[50:51], v[50:51], v[150:151]
v_cvt_pk_bf16_f32 v134, v44, v45
v_cvt_pk_bf16_f32 v135, v46, v47
v_pk_add_f32 v[148:149], v[48:49], v[50:51]
v_pk_fma_f32 v[146:147], v[36:37], v[36:37], v[146:147]
v_pk_add_f32 v[144:145], v[144:145], v[36:37]
v_pk_fma_f32 v[150:151], v[52:53], v[52:53], v[150:151]
v_pk_add_f32 v[148:149], v[148:149], v[52:53]
v_pk_fma_f32 v[146:147], v[38:39], v[38:39], v[146:147]
v_pk_add_f32 v[144:145], v[144:145], v[38:39]
buffer_store_dwordx4 v[132:135], v4, s[16:19], s63 offen sc1
v_pk_fma_f32 v[150:151], v[54:55], v[54:55], v[150:151]
v_pk_add_f32 v[148:149], v[148:149], v[54:55]
v_pk_fma_f32 v[146:147], v[40:41], v[40:41], v[146:147]
v_pk_add_f32 v[144:145], v[144:145], v[40:41]
v_pk_fma_f32 v[150:151], v[56:57], v[56:57], v[150:151]
v_pk_add_f32 v[148:149], v[148:149], v[56:57]
v_pk_fma_f32 v[146:147], v[42:43], v[42:43], v[146:147]
v_pk_add_f32 v[144:145], v[144:145], v[42:43]
v_pk_fma_f32 v[150:151], v[58:59], v[58:59], v[150:151]
v_pk_add_f32 v[148:149], v[148:149], v[58:59]
v_pk_fma_f32 v[146:147], v[44:45], v[44:45], v[146:147]
v_pk_add_f32 v[144:145], v[144:145], v[44:45]
v_pk_fma_f32 v[150:151], v[60:61], v[60:61], v[150:151]
buffer_store_dwordx4 v[136:139], v4, s[16:19], s62 offen offset:1024 sc1
v_pk_add_f32 v[148:149], v[148:149], v[60:61]
v_pk_fma_f32 v[146:147], v[46:47], v[46:47], v[146:147]
v_pk_add_f32 v[144:145], v[144:145], v[46:47]
v_pk_fma_f32 v[150:151], v[62:63], v[62:63], v[150:151]
v_pk_add_f32 v[148:149], v[148:149], v[62:63]
v_add_f32 v144, v144, v145
v_add_f32 v146, v146, v147
v_add_f32 v148, v148, v149
v_add_f32 v150, v150, v151
s_nop 0
v_permlane16_swap_b32 v144, v148
buffer_store_dwordx4 v[140:143], v4, s[16:19], s63 offen offset:1024 sc1
v_permlane16_swap_b32 v146, v150
v_add_f32 v144, v144, v148
v_add_f32 v146, v146, v150
s_nop 1
v_permlane32_swap_b32 v144, v146
v_add_f32 v144, v144, v146
s_nop 1
v_permlane32_swap_b32 v144, v145
buffer_store_dwordx2 v[144:145], v152, s[16:19], s64 offen sc1
s_nop 1
v_accvgpr_write_b32 a224, v32
v_accvgpr_write_b32 a225, v33
v_accvgpr_write_b32 a226, v34
v_accvgpr_write_b32 a227, v35
v_accvgpr_write_b32 a228, v36
v_accvgpr_write_b32 a229, v37
v_accvgpr_write_b32 a230, v38
v_accvgpr_write_b32 a231, v39
v_accvgpr_write_b32 a232, v40
v_accvgpr_write_b32 a233, v41
v_accvgpr_write_b32 a234, v42
v_accvgpr_write_b32 a235, v43
v_accvgpr_write_b32 a236, v44
v_accvgpr_write_b32 a237, v45
v_accvgpr_write_b32 a238, v46
v_accvgpr_write_b32 a239, v47
v_accvgpr_write_b32 a240, v48
v_accvgpr_write_b32 a241, v49
v_accvgpr_write_b32 a242, v50
v_accvgpr_write_b32 a243, v51
v_accvgpr_write_b32 a244, v52
v_accvgpr_write_b32 a245, v53
v_accvgpr_write_b32 a246, v54
v_accvgpr_write_b32 a247, v55
v_accvgpr_write_b32 a248, v56
v_accvgpr_write_b32 a249, v57
v_accvgpr_write_b32 a250, v58
v_accvgpr_write_b32 a251, v59
v_accvgpr_write_b32 a252, v60
v_accvgpr_write_b32 a253, v61
v_accvgpr_write_b32 a254, v62
v_accvgpr_write_b32 a255, v63
s_lshl_b32 s62, s10, 14
s_lshl_b32 s63, s3, 12
s_add_u32 s62, s62, s63
s_lshl_b32 s63, s12, 11
s_add_u32 s62, s62, s63
v_lshl_add_u32 v10, v1, 4, s62
v_lshrrev_b32 v2, 3, v1
v_cmp_eq_u32 vcc, 3, v2
v_add_u32 v2, 67108480, v10
s_nop 0
v_cndmask_b32 v10, v10, v2, vcc
v_xor_b32 v11, 2048, v10
v_bfe_u32 v16, v1, 2, 3
v_mul_u32_u24 v16, 1056, v16
v_bfe_u32 v2, v1, 5, 1
v_lshl_add_u32 v16, v2, 8, v16
v_and_b32 v2, 3, v1
v_lshl_add_u32 v16, v2, 3, v16
s_lshl_b32 s62, s12, 6
s_add_u32 s62, s62, 84480
s_xor_b32 s63, s12, 1
s_mul_i32 s63, s63, 192
s_add_u32 s63, s63, 84480
v_add_u32 v17, s63, v16
v_add_u32 v16, s62, v16
s_mov_b32 s52, 41943040
s_mov_b32 s53, 41943040
s_mov_b32 s54, s58
s_mov_b32 s55, s59
s_mul_i32 s59, s3, 2112
s_and_b32 s62, s7, 1
s_mul_i32 s62, s62, 3670016
s_lshr_b32 s63, s7, 1
s_lshl_b32 s63, s63, 8
s_add_u32 s62, s62, s63
s_lshl_b32 s63, s3, 12
s_add_u32 s62, s62, s63
v_lshrrev_b32 v5, 4, v1
v_lshlrev_b32 v5, 14, v5
v_and_b32 v2, 15, v1
v_lshl_add_u32 v5, v2, 4, v5
v_add_u32 v5, s62, v5
v_add_u32 v6, 992, v5
s_lshl_b32 s62, s10, 15
s_lshl_b32 s63, s3, 13
s_add_u32 s62, s62, s63
v_lshl_add_u32 v4, v1, 4, s62
s_lshl_b32 s62, s6, 10
s_add_u32 s62, s62, 30507008
s_lshl_b32 s64, s10, 1
s_lshl_b32 s64, s64, 10
s_add_u32 s64, s64, 30507008
s_lshr_b32 s67, s5, 2
s_and_b32 s67, s67, 3
s_lshl_b32 s67, s67, 7
s_add_u32 s64, s64, s67
s_add_u32 s65, s64, 1024
v_lshl_add_u32 v252, v1, 7, s62
v_mov_b32 v253, s64
v_mov_b32 v255, 1
v_writelane_b32 v253, s65, 1
s_waitcnt vmcnt(0) lgkmcnt(0)
s_cmp_lg_u32 s3, 1
s_barrier
s_cbranch_scc1 .Lfirst64
s_mov_b64 exec, 15
buffer_atomic_add v255, v252, s[16:19], 0 offen
s_mov_b64 exec, 3
v_mov_b32 v254, 0
buffer_atomic_add v254, v253, s[16:19], 0 offen sc0
s_mov_b64 exec, -1
.Lfirst64:
ds_read_b64_tr_b16 a[0:1], v16
TR 2,16,512
TR 4,16,8448
TR 6,16,8960
TR 8,16,32
TR 10,16,544
TR 12,16,8480
TR 14,16,8992
TR 16,16,64
TR 18,16,576
TR 20,16,8512
TR 22,16,9024
TR 24,16,96
TR 26,16,608
TR 28,16,8544
TR 30,16,9056
TR 32,16,128
TR 34,16,640
TR 36,16,8576
TR 38,16,9088
TR 40,16,160
TR 42,16,672
TR 44,16,8608
TR 46,16,9120
ds_read_b64_tr_b16 a[48:49], v17
TR 50,17,512
TR 52,17,8448
TR 54,17,8960
TR 56,17,32
TR 58,17,544
TR 60,17,8480
TR 62,17,8992
s_waitcnt lgkmcnt(0)
s_cmp_lg_u32 s3, 1
s_cbranch_scc1 .Lnopoll63
s_mov_b64 exec, 3
s_mov_b32 s15, 0
.Lpoll62:
v_mov_b32 v255, 0
buffer_atomic_add v255, v253, s[16:19], 0 offen sc0
s_waitcnt vmcnt(1)
v_cmp_gt_u32 vcc, 16, v254
s_add_u32 s15, s15, 1
s_cbranch_vccz .Lnopoll63r
v_mov_b32 v254, 0
buffer_atomic_add v254, v253, s[16:19], 0 offen sc0
s_waitcnt vmcnt(1)
v_cmp_gt_u32 vcc, 16, v255
s_add_u32 s15, s15, 1
s_cbranch_vccz .Lnopoll63r
s_cmp_le_u32 s15, 100000
s_cbranch_scc1 .Lpoll62
s_branch .Lnopoll63r
.Lnopoll63:
s_mov_b64 exec, 0
s_cmp_eq_u32 s3, 2
s_cbranch_scc1 .Lpad35
s_cmp_eq_u32 s3, 3
s_cbranch_scc1 .Lpad36
s_branch .Lpad37
.Lnopoll63r:
s_mov_b64 exec, -1
s_barrier
buffer_load_dwordx4 a[128:131], v10, s[16:19], s52 offen sc1
buffer_load_dwordx4 a[132:135], v10, s[16:19], s52 offen offset:1024 sc1
s_add_u32 s52, s52, 131072
buffer_load_dwordx4 a[144:147], v10, s[16:19], s52 offen sc1
buffer_load_dwordx4 a[148:151], v10, s[16:19], s52 offen offset:1024 sc1
s_add_u32 s52, s52, 131072
buffer_load_dwordx4 a[136:139], v11, s[16:19], s53 offen sc1
buffer_load_dwordx4 a[140:143], v11, s[16:19], s53 offen offset:1024 sc1
s_add_u32 s53, s53, 131072
buffer_load_dwordx4 a[152:155], v11, s[16:19], s53 offen sc1
buffer_load_dwordx4 a[156:159], v11, s[16:19], s53 offen offset:1024 sc1
s_add_u32 s53, s53, 131072
s_add_u32 m0, s55, 135168
s_nop 0
buffer_load_dwordx4 v12, s[80:83], s54 offen   lds
buffer_load_dwordx4 v13, s[80:83], s54 offen offset:1056   lds
buffer_load_dwordx4 v14, s[80:83], s54 offen offset:2112   lds
buffer_load_dwordx4 v15, s[80:83], s54 offen offset:3168   lds
s_add_u32 s54, s54, 458752
s_lshl_b32 s57, s3, 13
s_add_u32 s57, s57, 49920
v_lshl_add_u32 v2, v1, 4, s57
s_waitcnt vmcnt(11)
v_mfma_f32_16x16x32_bf16 v[32:35], a[0:3], a[128:131], 0
buffer_load_dwordx4 a[160:163], v10, s[16:19], s52 offen sc1
s_waitcnt vmcnt(10)
MAA 32,4,144
TR 64,16,16896
v_mfma_f32_16x16x32_bf16 v[36:39], a[0:3], a[132:135], 0
TR 66,16,17408
s_waitcnt vmcnt(9)
MAA 36,4,148
TR 68,16,25344
v_mfma_f32_16x16x32_bf16 v[52:55], a[8:11], a[132:135], 0
buffer_load_dwordx4 a[164:167], v10, s[16:19], s52 offen offset:1024 sc1
MAA 52,12,148
TR 70,16,25856
s_add_u32 s52, s52, 131072
v_mfma_f32_16x16x32_bf16 v[48:51], a[8:11], a[128:131], 0
TR 72,16,16928
MAA 48,12,144
TR 74,16,17440
v_mfma_f32_16x16x32_bf16 v[96:99], a[16:19], a[128:131], 0
buffer_load_dwordx4 a[176:179], v10, s[16:19], s52 offen sc1
MAA 96,20,144
TR 76,16,25376
v_mfma_f32_16x16x32_bf16 v[100:103], a[16:19], a[132:135], 0
TR 78,16,25888
MAA 100,20,148
TR 80,16,16960
v_mfma_f32_16x16x32_bf16 v[116:119], a[24:27], a[132:135], 0
buffer_load_dwordx4 a[180:183], v10, s[16:19], s52 offen offset:1024 sc1
MAA 116,28,148
TR 82,16,17472
s_add_u32 s52, s52, 131072
v_mfma_f32_16x16x32_bf16 v[112:115], a[24:27], a[128:131], 0
TR 84,16,25408
MAA 112,28,144
TR 86,16,25920
v_mfma_f32_16x16x32_bf16 v[160:163], a[32:35], a[128:131], 0
buffer_load_dwordx4 a[168:171], v11, s[16:19], s53 offen sc1
MAA 160,36,144
TR 88,16,16992
v_mfma_f32_16x16x32_bf16 v[164:167], a[32:35], a[132:135], 0
TR 90,16,17504
MAA 164,36,148
TR 92,16,25440
v_mfma_f32_16x16x32_bf16 v[180:183], a[40:43], a[132:135], 0
buffer_load_dwordx4 a[172:175], v11, s[16:19], s53 offen offset:1024 sc1
MAA 180,44,148
TR 94,16,25952
s_add_u32 s53, s53, 131072
v_mfma_f32_16x16x32_bf16 v[176:179], a[40:43], a[128:131], 0
TR 96,16,17024
MAA 176,44,144
TR 98,16,17536
v_mfma_f32_16x16x32_bf16 v[224:227], a[48:51], a[128:131], 0
buffer_load_dwordx4 a[184:187], v11, s[16:19], s53 offen sc1
MAA 224,52,144
TR 100,16,25472
v_mfma_f32_16x16x32_bf16 v[228:231], a[48:51], a[132:135], 0
TR 102,16,25984
MAA 228,52,148
TR 104,16,17056
v_mfma_f32_16x16x32_bf16 v[236:239], a[56:59], a[132:135], 0
buffer_load_dwordx4 a[188:191], v11, s[16:19], s53 offen offset:1024 sc1
MAA 236,60,148
TR 106,16,17568
s_add_u32 s53, s53, 131072
v_mfma_f32_16x16x32_bf16 v[232:235], a[56:59], a[128:131], 0
TR 108,16,25504
s_add_u32 m0, s55, 84480
MAA 232,60,144
TR 110,16,26016
s_waitcnt vmcnt(12)
v_mfma_f32_16x16x32_bf16 v[188:191], a[40:43], a[140:143], 0
buffer_load_dwordx4 v12, s[32:35], s54 offen   lds
MAA 188,44,156
TR 112,17,16896
v_mfma_f32_16x16x32_bf16 v[184:187], a[40:43], a[136:139], 0
TR 114,17,17408
MAA 184,44,152
TR 116,17,25344
v_mfma_f32_16x16x32_bf16 v[168:171], a[32:35], a[136:139], 0
buffer_load_dwordx4 v13, s[32:35], s54 offen offset:1056   lds
MAA 168,36,152
TR 118,17,25856
v_mfma_f32_16x16x32_bf16 v[172:175], a[32:35], a[140:143], 0
TR 120,17,16928
MAA 172,36,156
TR 122,17,17440
v_mfma_f32_16x16x32_bf16 v[124:127], a[24:27], a[140:143], 0
buffer_load_dwordx4 v14, s[32:35], s54 offen offset:2112   lds
MAA 124,28,156
TR 124,17,25376
v_mfma_f32_16x16x32_bf16 v[120:123], a[24:27], a[136:139], 0
TR 126,17,25888
MAA 120,28,152
v_mfma_f32_16x16x32_bf16 v[104:107], a[16:19], a[136:139], 0
buffer_load_dwordx4 v15, s[32:35], s54 offen offset:3168   lds
MAA 104,20,152
v_mfma_f32_16x16x32_bf16 v[108:111], a[16:19], a[140:143], 0
MAA 108,20,156
v_mfma_f32_16x16x32_bf16 v[60:63], a[8:11], a[140:143], 0
MAA 60,12,156
v_mfma_f32_16x16x32_bf16 v[56:59], a[8:11], a[136:139], 0
MAA 56,12,152
v_mfma_f32_16x16x32_bf16 v[40:43], a[0:3], a[136:139], 0
MAA 40,4,152
v_mfma_f32_16x16x32_bf16 v[44:47], a[0:3], a[140:143], 0
MAA 44,4,156
s_waitcnt lgkmcnt(0)
s_barrier
v_mfma_f32_16x16x32_bf16 v[64:67], a[64:67], a[128:131], 0
TR 0,16,33792
s_add_u32 m0, s55, 101376
MAA 64,68,144
buffer_load_dwordx4 v12, s[80:83], s54 offen   lds
v_mfma_f32_16x16x32_bf16 v[68:71], a[64:67], a[132:135], 0
TR 2,16,34304
s_mul_i32 s66, s13, 114688
MAA 68,68,148
TR 4,16,42240
s_mul_i32 s65, s10, 1818624
v_mfma_f32_16x16x32_bf16 v[84:87], a[72:75], a[132:135], 0
TR 6,16,42752
s_add_u32 s66, s66, s65
MAA 84,76,148
TR 8,16,33824
s_add_u32 s66, s66, 46137344
v_mfma_f32_16x16x32_bf16 v[80:83], a[72:75], a[128:131], 0
buffer_load_dwordx4 v13, s[80:83], s54 offen offset:1056   lds
MAA 80,76,144
TR 10,16,34336
s_add_u32 s65, s66, 49152
v_mfma_f32_16x16x32_bf16 v[128:131], a[80:83], a[128:131], 0
TR 12,16,42272
s_lshl_b32 s62, s12, 16
MAA 128,84,144
TR 14,16,42784
s_add_u32 s62, s62, s66
v_mfma_f32_16x16x32_bf16 v[132:135], a[80:83], a[132:135], 0
TR 16,16,33856
s_add_u32 s63, s62, 16384
MAA 132,84,148
buffer_load_dwordx4 v14, s[80:83], s54 offen offset:2112   lds
v_mfma_f32_16x16x32_bf16 v[148:151], a[88:91], a[132:135], 0
TR 18,16,34368
s_add_u32 s64, s62, 32768
MAA 148,92,148
TR 20,16,42304
s_lshl_b32 s72, s10, 1
v_mfma_f32_16x16x32_bf16 v[144:147], a[88:91], a[128:131], 0
TR 22,16,42816
s_lshr_b32 s74, s11, 4
.Lpad31:
s_cbranch_execz .Lpad34
MAA 144,92,144
TR 24,16,33888
s_add_u32 s72, s72, s74
v_mfma_f32_16x16x32_bf16 v[192:195], a[96:99], a[128:131], 0
buffer_load_dwordx4 v15, s[80:83], s54 offen offset:3168   lds
MAA 192,100,144
TR 26,16,34400
s_add_u32 s54, s54, 458752
v_mfma_f32_16x16x32_bf16 v[196:199], a[96:99], a[132:135], 0
TR 28,16,42336
s_add_u32 m0, s57, 0
MAA 196,100,148
TR 30,16,42848
s_mov_b32 s58, 63176704
v_mfma_f32_16x16x32_bf16 v[212:215], a[104:107], a[132:135], 0
TR 32,16,33920
s_lshl_b32 s72, s72, 10
MAA 212,108,148
buffer_load_dwordx4 v4, s[16:19], s58 offen sc1 lds
v_mfma_f32_16x16x32_bf16 v[208:211], a[104:107], a[128:131], 0
TR 34,16,34432
s_add_u32 s72, s72, 30523392
MAA 208,108,144
TR 36,16,42368
s_and_b32 s73, s6, 14
v_mfma_f32_16x16x32_bf16 v[240:243], a[112:115], a[128:131], 0
TR 38,16,42880
s_and_b32 s74, s7, 1
MAA 240,116,144
TR 40,16,33952
s_add_u32 s73, s73, s74
v_mfma_f32_16x16x32_bf16 v[244:247], a[112:115], a[132:135], 0
buffer_load_dwordx4 v4, s[16:19], s58 offen offset:1024 sc1 lds
MAA 244,116,148
TR 42,16,34464
s_lshl_b32 s73, s73, 10
v_mfma_f32_16x16x32_bf16 v[252:255], a[120:123], a[132:135], 0
TR 44,16,42400
s_add_u32 s73, s73, 30523392
MAA 252,124,148
TR 46,16,42912
s_lshr_b32 s67, s5, 2
v_mfma_f32_16x16x32_bf16 v[248:251], a[120:123], a[128:131], 0
TR 48,17,33792
s_and_b32 s67, s67, 3
MAA 248,124,144
buffer_load_dwordx4 a[128:131], v10, s[16:19], s52 offen sc1
v_mfma_f32_16x16x32_bf16 v[220:223], a[104:107], a[140:143], 0
TR 50,17,34304
s_lshl_b32 s67, s67, 7
MAA 220,108,156
TR 52,17,42240
s_add_u32 s73, s73, s67
v_mfma_f32_16x16x32_bf16 v[216:219], a[104:107], a[136:139], 0
TR 54,17,42752
MAA 216,108,152
TR 56,17,33824
v_mfma_f32_16x16x32_bf16 v[200:203], a[96:99], a[136:139], 0
buffer_load_dwordx4 a[132:135], v10, s[16:19], s52 offen offset:1024 sc1
MAA 200,100,152
TR 58,17,34336
s_add_u32 s52, s52, 131072
v_mfma_f32_16x16x32_bf16 v[204:207], a[96:99], a[140:143], 0
TR 60,17,42272
MAA 204,100,156
TR 62,17,42784
v_mfma_f32_16x16x32_bf16 v[156:159], a[88:91], a[140:143], 0
MAA 156,92,156
buffer_load_dwordx4 a[144:147], v10, s[16:19], s52 offen sc1
v_mfma_f32_16x16x32_bf16 v[152:155], a[88:91], a[136:139], 0
MAA 152,92,152
v_mfma_f32_16x16x32_bf16 v[136:139], a[80:83], a[136:139], 0
MAA 136,84,152
v_mfma_f32_16x16x32_bf16 v[140:143], a[80:83], a[140:143], 0
buffer_load_dwordx4 a[148:151], v10, s[16:19], s52 offen offset:1024 sc1
MAA 140,84,156
s_add_u32 s52, s52, 131072
v_mfma_f32_16x16x32_bf16 v[92:95], a[72:75], a[140:143], 0
MAA 92,76,156
v_mfma_f32_16x16x32_bf16 v[88:91], a[72:75], a[136:139], 0
MAA 88,76,152
v_mfma_f32_16x16x32_bf16 v[72:75], a[64:67], a[136:139], 0
MAA 72,68,152
v_mfma_f32_16x16x32_bf16 v[76:79], a[64:67], a[140:143], 0
MAA 76,68,156
s_waitcnt vmcnt(18) lgkmcnt(0)
s_barrier
MAA 32,0,160
buffer_load_dwordx4 a[136:139], v11, s[16:19], s53 offen sc1
MAA 32,4,176
TR 64,16,50688
s_and_b32 s74, s7, 1
MAA 36,4,180
TR 66,16,51200
s_mul_i32 s87, s74, 917504
MAA 36,0,164
TR 68,16,59136
s_lshr_b32 s75, s6, 1
MAA 52,8,164
TR 70,16,59648
s_mul_i32 s75, s75, 1818624
MAA 52,12,180
buffer_load_dwordx4 a[140:143], v11, s[16:19], s53 offen offset:1024 sc1
MAA 48,12,176
TR 72,16,50720
s_add_u32 s53, s53, 131072
MAA 48,8,160
TR 74,16,51232
s_add_u32 s87, s87, s75
MAA 96,16,160
TR 76,16,59168
s_add_u32 s87, s87, 46137344
MAA 96,20,176
TR 78,16,59680
s_and_b32 s74, s6, 3
MAA 100,20,180
buffer_load_dwordx4 a[152:155], v11, s[16:19], s53 offen sc1
MAA 100,16,164
TR 80,16,50752
s_xor_b32 s75, s74, 0
MAA 116,24,164
TR 82,16,51264
s_sub_u32 s75, s75, 0
MAA 116,28,180
TR 84,16,59200
s_mul_i32 s98, s75, 458752
MAA 112,28,176
TR 86,16,59712
s_mul_i32 s75, s75, 114688
MAA 112,24,160
buffer_load_dwordx4 a[156:159], v11, s[16:19], s53 offen offset:1024 sc1
MAA 160,32,160
TR 88,16,50784
s_add_u32 s53, s53, 131072
MAA 160,36,176
TR 90,16,51296
s_add_u32 m0, s55, 118272
MAA 164,36,180
TR 92,16,59232
s_add_u32 s76, s87, s75
MAA 164,32,164
TR 94,16,59744
s_xor_b32 s75, s74, 1
MAA 180,40,164
buffer_load_dwordx4 v12, s[32:35], s54 offen   lds
MAA 180,44,180
TR 96,16,50816
s_sub_u32 s75, s75, 1
MAA 176,44,176
TR 98,16,51328
s_mul_i32 s99, s75, 458752
MAA 176,40,160
TR 100,16,59264
s_mul_i32 s75, s75, 114688
MAA 224,48,160
TR 102,16,59776
s_add_u32 s77, s87, s75
MAA 224,52,176
buffer_load_dwordx4 v13, s[32:35], s54 offen offset:1056   lds
MAA 228,52,180
TR 104,16,50848
s_xor_b32 s75, s74, 2
MAA 228,48,164
TR 106,16,51360
s_sub_u32 s75, s75, 2
MAA 236,56,164
TR 108,16,59296
s_mul_i32 s100, s75, 458752
MAA 236,60,180
TR 110,16,59808
s_mul_i32 s75, s75, 114688
MAA 232,60,176
buffer_load_dwordx4 v14, s[32:35], s54 offen offset:2112   lds
MAA 232,56,160
TR 112,17,50688
s_add_u32 s78, s87, s75
s_waitcnt vmcnt(21)
MAA 188,40,172
TR 114,17,51200
s_xor_b32 s75, s74, 3
MAA 188,44,188
TR 116,17,59136
MAA 184,44,184
TR 118,17,59648
MAA 184,40,168
buffer_load_dwordx4 v15, s[32:35], s54 offen offset:3168   lds
MAA 168,32,168
TR 120,17,50720
s_add_u32 m0, s57, 2048
MAA 168,36,184
TR 122,17,51232
s_mov_b32 s58, 63178752
MAA 172,36,188
TR 124,17,59168
MAA 172,32,172
TR 126,17,59680
MAA 124,24,172
buffer_load_dwordx4 v4, s[16:19], s58 offen sc1 lds
MAA 124,28,188
MAA 120,28,184
MAA 120,24,168
MAA 104,16,168
MAA 104,20,184
buffer_load_dwordx4 v4, s[16:19], s58 offen offset:1024 sc1 lds
MAA 108,20,188
MAA 108,16,172
MAA 60,8,172
MAA 60,12,188
MAA 56,12,184
MAA 56,8,168
MAA 40,0,168
MAA 40,4,184
MAA 44,4,188
MAA 44,0,172
s_waitcnt vmcnt(20) lgkmcnt(0)
s_barrier
MAA 64,64,160
ds_read_b64_tr_b16 a[0:1], v16
s_add_u32 m0, s55, 135168
MAA 64,68,176
buffer_load_dwordx4 v12, s[80:83], s54 offen   lds
MAA 68,68,180
TR 2,16,512
s_sub_u32 s75, s75, 3
MAA 68,64,164
TR 4,16,8448
s_mul_i32 s101, s75, 458752
MAA 84,72,164
TR 6,16,8960
s_mul_i32 s75, s75, 114688
MAA 84,76,180
TR 8,16,32
s_add_u32 s79, s87, s75
MAA 80,76,176
buffer_load_dwordx4 v13, s[80:83], s54 offen offset:1056   lds
MAA 80,72,160
TR 10,16,544
s_and_b32 s87, s6, 3
MAA 128,80,160
TR 12,16,8480
s_mov_b32 s46, 0
MAA 128,84,176
TR 14,16,8992
s_lshl_b32 s74, s3, 10
MAA 132,84,180
TR 16,16,64
s_lshl_b32 s75, s12, 9
MAA 132,80,164
buffer_load_dwordx4 v14, s[80:83], s54 offen offset:2112   lds
MAA 148,88,164
TR 18,16,576
s_add_u32 s74, s74, s75
MAA 148,92,180
TR 20,16,8512
s_add_u32 s74, s74, 152576
MAA 144,92,176
TR 22,16,9024
v_and_b32 v18, 15, v1
MAA 144,88,160
TR 24,16,96
v_lshl_add_u32 v18, v18, 4, s74
MAA 192,96,160
buffer_load_dwordx4 v15, s[80:83], s54 offen offset:3168   lds
MAA 192,100,176
TR 26,16,608
s_add_u32 s54, s54, 458752
MAA 196,100,180
TR 28,16,8544
s_add_u32 m0, s57, 4096
MAA 196,96,164
TR 30,16,9056
s_mov_b32 s58, 63180800
MAA 212,104,164
TR 32,16,128
v_xor_b32 v19, 512, v18
MAA 212,108,180
buffer_load_dwordx4 v4, s[16:19], s58 offen sc1 lds
MAA 208,108,176
TR 34,16,640
s_lshl_b32 s74, s12, 7
MAA 208,104,160
TR 36,16,8576
s_add_u32 s74, s74, 161536
MAA 240,112,160
TR 38,16,9088
s_xor_b32 s75, s12, 1
MAA 240,116,176
TR 40,16,160
s_mul_i32 s75, s75, 384
MAA 244,116,180
buffer_load_dwordx4 v4, s[16:19], s58 offen offset:1024 sc1 lds
MAA 244,112,164
TR 42,16,672
s_add_u32 s75, s75, 161536
MAA 252,120,164
TR 44,16,8608
v_lshrrev_b32 v9, 4, v1
MAA 252,124,180
TR 46,16,9120
v_lshlrev_b32 v9, 4, v9
MAA 248,124,176
ds_read_b64_tr_b16 a[48:49], v17
v_add_u32 v8, s75, v9
MAA 248,120,160
buffer_load_dwordx4 a[160:163], v10, s[16:19], s52 offen sc1
MAA 220,104,172
TR 50,17,512
v_add_u32 v9, s74, v9
MAA 220,108,188
TR 52,17,8448
MAA 216,108,184
TR 54,17,8960
MAA 216,104,168
TR 56,17,32
MAA 200,96,168
buffer_load_dwordx4 a[164:167], v10, s[16:19], s52 offen offset:1024 sc1
MAA 200,100,184
TR 58,17,544
s_add_u32 s52, s52, 131072
MAA 204,100,188
TR 60,17,8480
MAA 204,96,172
TR 62,17,8992
MAA 156,88,172
MAA 156,92,188
buffer_load_dwordx4 a[176:179], v10, s[16:19], s52 offen sc1
MAA 152,92,184
MAA 152,88,168
MAA 136,80,168
MAA 136,84,184
MAA 140,84,188
buffer_load_dwordx4 a[180:183], v10, s[16:19], s52 offen offset:1024 sc1
MAA 140,80,172
s_add_u32 s52, s52, 131072
MAA 92,72,172
MAA 92,76,188
MAA 88,76,184
MAA 88,72,168
MAA 72,64,168
MAA 72,68,184
MAA 76,68,188
MAA 76,64,172
s_waitcnt vmcnt(20) lgkmcnt(0)
s_barrier
MAA 32,0,128
buffer_load_dwordx4 a[168:171], v11, s[16:19], s53 offen sc1
MAA 32,4,144
ds_read_b128 v[20:23], v2
MAA 36,4,148
ds_read_b128 v[28:31], v2 offset:1024
MAA 36,0,132
s_waitcnt vmcnt(11)
ds_read_b128 v[24:27], v2 offset:2048
MAA 52,8,132
TR 64,16,16896
MAA 52,12,148
buffer_load_dwordx4 a[172:175], v11, s[16:19], s53 offen offset:1024 sc1
MAA 48,12,144
TR 66,16,17408
s_add_u32 s53, s53, 131072
MAA 48,8,128
TR 68,16,25344
MAA 96,16,128
TR 70,16,25856
MAA 96,20,144
TR 72,16,16928
MAA 100,20,148
buffer_load_dwordx4 a[184:187], v11, s[16:19], s53 offen sc1
MAA 100,16,132
TR 74,16,17440
s_waitcnt lgkmcnt(7)
v_add_f32 v20, v20, v28
MAA 116,24,132
TR 76,16,25376
v_add_f32 v21, v21, v29
MAA 116,28,148
TR 78,16,25888
v_add_f32 v22, v22, v30
MAA 112,28,144
TR 80,16,16960
v_add_f32 v23, v23, v31
MAA 112,24,128
buffer_load_dwordx4 a[188:191], v11, s[16:19], s53 offen offset:1024 sc1
MAA 160,32,128
ds_read_b128 v[28:31], v2 offset:3072
s_add_u32 s53, s53, 131072
MAA 160,36,144
TR 82,16,17472
s_add_u32 m0, s55, 84480
MAA 164,36,148
TR 84,16,25408
s_waitcnt lgkmcnt(12)
v_add_f32 v20, v20, v24
MAA 164,32,132
TR 86,16,25920
v_add_f32 v21, v21, v25
MAA 180,40,132
buffer_load_dwordx4 v12, s[32:35], s54 offen   lds
MAA 180,44,148
TR 88,16,16992
v_add_f32 v22, v22, v26
MAA 176,44,144
TR 90,16,17504
v_add_f32 v23, v23, v27
MAA 176,40,128
TR 92,16,25440
MAA 224,48,128
TR 94,16,25952
MAA 224,52,144
buffer_load_dwordx4 v13, s[32:35], s54 offen offset:1056   lds
MAA 228,52,148
TR 96,16,17024
MAA 228,48,132
TR 98,16,17536
MAA 236,56,132
TR 100,16,25472
MAA 236,60,148
TR 102,16,25984
MAA 232,60,144
buffer_load_dwordx4 v14, s[32:35], s54 offen offset:2112   lds
MAA 232,56,128
TR 104,16,17056
MAA 188,40,140
TR 106,16,17568
MAA 188,44,156
TR 108,16,25504
MAA 184,44,152
TR 110,16,26016
MAA 184,40,136
buffer_load_dwordx4 v15, s[32:35], s54 offen offset:3168   lds
MAA 168,32,136
TR 112,17,16896
s_add_u32 m0, s57, 6144
MAA 168,36,152
TR 114,17,17408
s_mov_b32 s58, 63182848
MAA 172,36,156
TR 116,17,25344
MAA 172,32,140
TR 118,17,25856
MAA 124,24,140
buffer_load_dwordx4 v4, s[16:19], s58 offen sc1 lds
MAA 124,28,156
TR 120,17,16928
MAA 120,28,152
TR 122,17,17440
MAA 120,24,136
TR 124,17,25376
MAA 104,16,136
TR 126,17,25888
MAA 104,20,152
buffer_load_dwordx4 v4, s[16:19], s58 offen offset:1024 sc1 lds
MAA 108,20,156
MAA 108,16,140
MAA 60,8,140
MAA 60,12,156
MAA 56,12,152
MAA 56,8,136
MAA 40,0,136
MAA 40,4,152
MAA 44,4,156
MAA 44,0,140
s_waitcnt lgkmcnt(0)
s_barrier
MAA 64,64,128
s_waitcnt vmcnt(14)
ds_read_b128 v[24:27], v2 offset:4096
s_add_u32 m0, s55, 101376
MAA 64,68,144
buffer_load_dwordx4 v12, s[80:83], s54 offen   lds
MAA 68,68,148
TR 0,16,33792
v_add_f32 v20, v20, v28
MAA 68,64,132
TR 2,16,34304
v_add_f32 v21, v21, v29
MAA 84,72,132
TR 4,16,42240
v_add_f32 v22, v22, v30
MAA 84,76,148
TR 6,16,42752
v_add_f32 v23, v23, v31
MAA 80,76,144
ds_read_b128 v[28:31], v2 offset:5120
MAA 80,72,128
TR 8,16,33824
MAA 128,80,128
buffer_load_dwordx4 v13, s[80:83], s54 offen offset:1056   lds
MAA 128,84,144
TR 10,16,34336
s_waitcnt lgkmcnt(7)
v_add_f32 v20, v20, v24
MAA 132,84,148
TR 12,16,42272
v_add_f32 v21, v21, v25
MAA 132,80,132
TR 14,16,42784
v_add_f32 v22, v22, v26
MAA 148,88,132
TR 16,16,33856
v_add_f32 v23, v23, v27
MAA 148,92,148
TR 18,16,34368
MAA 144,92,144
TR 20,16,42304
MAA 144,88,128
buffer_load_dwordx4 v14, s[80:83], s54 offen offset:2112   lds
MAA 192,96,128
TR 22,16,42816
MAA 192,100,144
TR 24,16,33888
MAA 196,100,148
TR 26,16,34400
MAA 196,96,132
TR 28,16,42336
MAA 212,104,132
TR 30,16,42848
MAA 212,108,148
TR 32,16,33920
MAA 208,108,144
buffer_load_dwordx4 v15, s[80:83], s54 offen offset:3168   lds
MAA 208,104,128
TR 34,16,34432
s_add_u32 s54, s54, 458752
MAA 240,112,128
TR 36,16,42368
MAA 240,116,144
TR 38,16,42880
MAA 244,116,148
TR 40,16,33952
MAA 244,112,132
TR 42,16,34464
MAA 252,120,132
TR 44,16,42400
MAA 252,124,148
TR 46,16,42912
MAA 248,124,144
TR 48,17,33792
MAA 248,120,128
buffer_load_dwordx4 a[128:131], v10, s[16:19], s52 offen sc1
MAA 220,104,140
TR 50,17,34304
MAA 220,108,156
TR 52,17,42240
MAA 216,108,152
TR 54,17,42752
.Lpad32:
s_cbranch_execz .Lnopoll60r
MAA 216,104,136
TR 56,17,33824
MAA 200,96,136
TR 58,17,34336
MAA 200,100,152
TR 60,17,42272
MAA 204,100,156
buffer_load_dwordx4 a[132:135], v10, s[16:19], s52 offen offset:1024 sc1
MAA 204,96,140
TR 62,17,42784
s_add_u32 s52, s52, 131072
MAA 156,88,140
MAA 156,92,156
MAA 152,92,152
MAA 152,88,136
MAA 136,80,136
MAA 136,84,152
buffer_load_dwordx4 a[144:147], v10, s[16:19], s52 offen sc1
MAA 140,84,156
MAA 140,80,140
MAA 92,72,140
MAA 92,76,156
MAA 88,76,152
MAA 88,72,136
MAA 72,64,136
buffer_load_dwordx4 a[148:151], v10, s[16:19], s52 offen offset:1024 sc1
MAA 72,68,152
s_add_u32 s52, s52, 131072
MAA 76,68,156
MAA 76,64,140
s_waitcnt vmcnt(18) lgkmcnt(0)
s_barrier
MAA 32,0,160
buffer_load_dwordx4 a[136:139], v11, s[16:19], s53 offen sc1
MAA 32,4,176
s_waitcnt vmcnt(9)
ds_read_b128 v[24:27], v2 offset:6144
v_add_f32 v20, v20, v28
MAA 36,4,180
TR 64,16,50688
v_add_f32 v21, v21, v29
MAA 36,0,164
TR 66,16,51200
v_add_f32 v22, v22, v30
MAA 52,8,164
TR 68,16,59136
v_add_f32 v23, v23, v31
MAA 52,12,180
ds_read_b128 v[28:31], v2 offset:7168
MAA 48,12,176
TR 70,16,59648
MAA 48,8,160
buffer_load_dwordx4 a[140:143], v11, s[16:19], s53 offen offset:1024 sc1
MAA 96,16,160
TR 72,16,50720
s_add_u32 s53, s53, 131072
MAA 96,20,176
TR 74,16,51232
s_waitcnt lgkmcnt(7)
v_add_f32 v20, v20, v24
MAA 100,20,180
TR 76,16,59168
v_add_f32 v21, v21, v25
MAA 100,16,164
TR 78,16,59680
v_add_f32 v22, v22, v26
MAA 116,24,164
TR 80,16,50752
v_add_f32 v23, v23, v27
MAA 116,28,180
TR 82,16,51264
s_waitcnt lgkmcnt(7)
v_add_f32 v20, v20, v28
MAA 112,28,176
buffer_load_dwordx4 a[152:155], v11, s[16:19], s53 offen sc1
MAA 112,24,160
TR 84,16,59200
v_add_f32 v21, v21, v29
MAA 160,32,160
TR 86,16,59712
v_add_f32 v22, v22, v30
MAA 160,36,176
TR 88,16,50784
v_add_f32 v23, v23, v31
MAA 164,36,180
TR 90,16,51296
MAA 164,32,164
TR 92,16,59232
MAA 180,40,164
TR 94,16,59744
MAA 180,44,180
buffer_load_dwordx4 a[156:159], v11, s[16:19], s53 offen offset:1024 sc1
MAA 176,44,176
TR 96,16,50816
s_add_u32 s53, s53, 131072
MAA 176,40,160
TR 98,16,51328
s_add_u32 m0, s55, 118272
MAA 224,48,160
TR 100,16,59264
MAA 224,52,176
TR 102,16,59776
MAA 228,52,180
TR 104,16,50848
MAA 228,48,164
TR 106,16,51360
MAA 236,56,164
buffer_load_dwordx4 v12, s[32:35], s54 offen   lds
MAA 236,60,180
TR 108,16,59296
MAA 232,60,176
TR 110,16,59808
MAA 232,56,160
TR 112,17,50688
MAA 188,40,172
TR 114,17,51200
MAA 188,44,188
TR 116,17,59136
MAA 184,44,184
TR 118,17,59648
MAA 184,40,168
buffer_load_dwordx4 v13, s[32:35], s54 offen offset:1056   lds
MAA 168,32,168
TR 120,17,50720
MAA 168,36,184
TR 122,17,51232
MAA 172,36,188
TR 124,17,59168
MAA 172,32,172
TR 126,17,59680
MAA 124,24,172
MAA 124,28,188
MAA 120,28,184
buffer_load_dwordx4 v14, s[32:35], s54 offen offset:2112   lds
MAA 120,24,168
MAA 104,16,168
MAA 104,20,184
MAA 108,20,188
MAA 108,16,172
MAA 60,8,172
MAA 60,12,188
buffer_load_dwordx4 v15, s[32:35], s54 offen offset:3168   lds
MAA 56,12,184
MAA 56,8,168
MAA 40,0,168
MAA 40,4,184
MAA 44,4,188
MAA 44,0,172
s_waitcnt lgkmcnt(0)
s_barrier
MAA 64,64,160
ds_read_b64_tr_b16 a[0:1], v16
s_add_u32 m0, s55, 135168
MAA 64,68,176
buffer_load_dwordx4 v12, s[80:83], s54 offen   lds
MAA 68,68,180
TR 2,16,512
v_permlane32_swap_b32 v20, v22
MAA 68,64,164
TR 4,16,8448
v_permlane32_swap_b32 v21, v23
MAA 84,72,164
TR 6,16,8960
v_add_f32 v20, v20, v22
MAA 84,76,180
TR 8,16,32
v_add_f32 v21, v21, v23
MAA 80,76,176
TR 10,16,544
v_mul_f32 v20, 0xba800000, v20
MAA 80,72,160
buffer_load_dwordx4 v13, s[80:83], s54 offen offset:1056   lds
MAA 128,80,160
TR 12,16,8480
v_mul_f32 v21, 0x3a800000, v21
MAA 128,84,176
TR 14,16,8992
v_fma_f32 v21, -v20, v20, v21
MAA 132,84,180
TR 16,16,64
v_max_f32 v21, 0, v21
MAA 132,80,164
TR 18,16,576
v_add_f32 v21, 0x3727c5ac, v21
MAA 148,88,164
TR 20,16,8512
v_rsq_f32 v22, v21
MAA 148,92,180
buffer_load_dwordx4 v14, s[80:83], s54 offen offset:2112   lds
MAA 144,92,176
TR 22,16,9024
v_and_b32 v24, 31, v1
MAA 144,88,160
TR 24,16,96
v_lshrrev_b32 v25, 5, v1
MAA 192,96,160
TR 26,16,608
v_lshl_add_u32 v24, v24, 1, v25
MAA 192,100,176
TR 28,16,8544
v_and_b32 v25, 0xc0, v0
MAA 196,100,180
TR 30,16,9056
v_add_u32 v24, v24, v25
MAA 196,96,164
TR 32,16,128
v_lshlrev_b32 v24, 4, v24
MAA 212,104,164
buffer_load_dwordx4 v15, s[80:83], s54 offen offset:3168   lds
MAA 212,108,180
TR 34,16,640
s_add_u32 s54, s54, 458752
MAA 208,108,176
TR 36,16,8576
v_add_u32 v24, 152576, v24
MAA 208,104,160
TR 38,16,9088
v_mul_f32 v22, 0xbfb8aa3b, v22
MAA 240,112,160
ds_write_b128 v24, v[20:23]
s_mov_b32 s58, s98
MAA 240,116,176
ds_read_b64 v[20:21], v18
s_mov_b32 s67, s59
MAA 244,116,180
ds_read_b64 v[22:23], v18 offset:256
MAA 244,112,164
ds_read_b64 v[24:25], v19
MAA 252,120,164
ds_read_b64 v[26:27], v19 offset:256
MAA 252,124,180
ds_read_b32 a192, v18 offset:8
MAA 248,124,176
ds_read_b32 a193, v18 offset:264
v_mov_b32 v18, v5
MAA 248,120,160
buffer_load_dwordx4 a[160:163], v10, s[16:19], s52 offen sc1
MAA 220,104,172
ds_read_b32 a194, v19 offset:8
MAA 220,108,188
ds_read_b32 a195, v19 offset:264
v_add_u32 v19, 992, v5
MAA 216,108,184
TR 40,16,160
MAA 216,104,168
TR 42,16,672
MAA 200,96,168
TR 44,16,8608
MAA 200,100,184
TR 46,16,9120
MAA 204,100,188
buffer_load_dwordx4 a[164:167], v10, s[16:19], s52 offen offset:1024 sc1
MAA 204,96,172
ds_read_b64_tr_b16 a[48:49], v17
s_add_u32 s52, s52, 131072
MAA 156,88,172
TR 50,17,512
MAA 156,92,188
TR 52,17,8448
MAA 152,92,184
TR 54,17,8960
MAA 152,88,168
TR 56,17,32
MAA 136,80,168
TR 58,17,544
MAA 136,84,184
buffer_load_dwordx4 a[176:179], v10, s[16:19], s52 offen sc1
MAA 140,84,188
TR 60,17,8480
MAA 140,80,172
TR 62,17,8992
MAA 92,72,172
MAA 92,76,188
MAA 88,76,184
MAA 88,72,168
MAA 72,64,168
buffer_load_dwordx4 a[180:183], v10, s[16:19], s52 offen offset:1024 sc1
MAA 72,68,184
s_add_u32 s52, s52, 131072
MAA 76,68,188
MAA 76,64,172
s_waitcnt vmcnt(16) lgkmcnt(0)
s_barrier
MAA 32,0,128
ds_read_b128 v[28:31], v9 offset:512
MAA 32,4,144
ds_read_b128 v[4:7], v9 offset:576
MAA 36,4,148
buffer_load_dwordx4 a[168:171], v11, s[16:19], s53 offen sc1
MAA 36,0,132
TR 64,16,16896
MAA 52,8,132
TR 66,16,17408
MAA 52,12,148
TR 68,16,25344
MAA 48,12,144
TR 70,16,25856
MAA 48,8,128
TR 72,16,16928
MAA 96,16,128
buffer_load_dwordx4 a[172:175], v11, s[16:19], s53 offen offset:1024 sc1
MAA 96,20,144
TR 74,16,17440
s_add_u32 s53, s53, 131072
MAA 100,20,148
TR 76,16,25376
s_waitcnt lgkmcnt(8)
v_fmac_f32 v64, v28, v20
MAA 100,16,132
TR 78,16,25888
v_fmac_f32 v65, v29, v20
MAA 116,24,132
TR 80,16,16960
v_fmac_f32 v66, v30, v20
MAA 116,28,148
TR 82,16,17472
v_fmac_f32 v67, v31, v20
MAA 112,28,144
buffer_load_dwordx4 a[184:187], v11, s[16:19], s53 offen sc1
MAA 112,24,128
TR 84,16,25408
v_fmac_f32 v68, v28, v22
MAA 160,32,128
TR 86,16,25920
v_fmac_f32 v69, v29, v22
MAA 160,36,144
TR 88,16,16992
v_fmac_f32 v70, v30, v22
MAA 164,36,148
TR 90,16,17504
v_fmac_f32 v71, v31, v22
MAA 164,32,132
TR 92,16,25440
v_fmac_f32 v72, v28, v24
MAA 180,40,132
buffer_load_dwordx4 a[188:191], v11, s[16:19], s53 offen offset:1024 sc1
MAA 180,44,148
TR 94,16,25952
s_add_u32 s53, s53, 131072
MAA 176,44,144
TR 96,16,17024
s_add_u32 m0, s55, 84480
MAA 176,40,128
TR 98,16,17536
v_fmac_f32 v73, v29, v24
MAA 224,48,128
TR 100,16,25472
v_fmac_f32 v74, v30, v24
MAA 224,52,144
TR 102,16,25984
v_fmac_f32 v75, v31, v24
MAA 228,52,148
buffer_load_dwordx4 v12, s[32:35], s54 offen   lds
MAA 228,48,132
TR 104,16,17056
v_fmac_f32 v76, v28, v26
MAA 236,56,132
TR 106,16,17568
v_fmac_f32 v77, v29, v26
MAA 236,60,148
TR 108,16,25504
v_fmac_f32 v78, v30, v26
MAA 232,60,144
TR 110,16,26016
v_fmac_f32 v79, v31, v26
MAA 232,56,128
ds_read_b128 v[28:31], v9 offset:640
s_waitcnt lgkmcnt(15)
v_fmac_f32 v80, v4, v20
s_waitcnt vmcnt(17)
MAA 188,40,140
buffer_load_dwordx4 v13, s[32:35], s54 offen offset:1056   lds
MAA 188,44,156
TR 112,17,16896
v_fmac_f32 v81, v5, v20
MAA 184,44,152
TR 114,17,17408
v_fmac_f32 v82, v6, v20
MAA 184,40,136
TR 116,17,25344
v_fmac_f32 v83, v7, v20
MAA 168,32,136
TR 118,17,25856
v_fmac_f32 v84, v4, v22
MAA 168,36,152
TR 120,17,16928
v_fmac_f32 v85, v5, v22
MAA 172,36,156
buffer_load_dwordx4 v14, s[32:35], s54 offen offset:2112   lds
MAA 172,32,140
TR 122,17,17440
v_fmac_f32 v86, v6, v22
MAA 124,24,140
TR 124,17,25376
v_fmac_f32 v87, v7, v22
MAA 124,28,156
TR 126,17,25888
v_fmac_f32 v88, v4, v24
MAA 120,28,152
v_fmac_f32 v89, v5, v24
v_fmac_f32 v90, v6, v24
MAA 120,24,136
v_fmac_f32 v91, v7, v24
v_fmac_f32 v92, v4, v26
MAA 104,16,136
buffer_load_dwordx4 v15, s[32:35], s54 offen offset:3168   lds
MAA 104,20,152
s_mov_b32 m0, s67
v_fmac_f32 v93, v5, v26
v_fmac_f32 v94, v6, v26
MAA 108,20,156
v_fmac_f32 v95, v7, v26
s_waitcnt lgkmcnt(8)
v_fmac_f32 v128, v28, v20
MAA 108,16,140
ds_read_b128 v[4:7], v8 offset:512
v_fmac_f32 v129, v29, v20
MAA 60,8,140
v_fmac_f32 v130, v30, v20
v_fmac_f32 v131, v31, v20
MAA 60,12,156
v_fmac_f32 v132, v28, v22
v_fmac_f32 v133, v29, v22
MAA 56,12,152
buffer_load_dwordx4 v18, s[28:31], s58 offen lds
MAA 56,8,136
v_fmac_f32 v134, v30, v22
v_fmac_f32 v135, v31, v22
MAA 40,0,136
v_fmac_f32 v136, v28, v24
v_fmac_f32 v137, v29, v24
MAA 40,4,152
v_fmac_f32 v138, v30, v24
v_fmac_f32 v139, v31, v24
MAA 44,4,156
v_fmac_f32 v140, v28, v26
v_fmac_f32 v141, v29, v26
MAA 44,0,140
v_fmac_f32 v142, v30, v26
v_fmac_f32 v143, v31, v26
s_waitcnt lgkmcnt(0)
v_fmac_f32 v240, v4, v20
v_fmac_f32 v241, v5, v20
v_fmac_f32 v242, v6, v20
v_fmac_f32 v243, v7, v20
v_fmac_f32 v244, v4, v22
v_fmac_f32 v245, v5, v22
v_fmac_f32 v246, v6, v22
v_fmac_f32 v247, v7, v22
s_waitcnt vmcnt(17) lgkmcnt(0)
s_barrier
MAA 64,64,128
ds_read_b128 v[28:31], v9
s_add_u32 m0, s55, 101376
MAA 64,68,144
ds_read_b128 v[4:7], v9 offset:64
MAA 68,68,148
buffer_load_dwordx4 v12, s[80:83], s54 offen   lds
MAA 68,64,132
TR 0,16,33792
MAA 84,72,132
TR 2,16,34304
MAA 84,76,148
TR 4,16,42240
MAA 80,76,144
TR 6,16,42752
MAA 80,72,128
TR 8,16,33824
MAA 128,80,128
buffer_load_dwordx4 v13, s[80:83], s54 offen offset:1056   lds
MAA 128,84,144
TR 10,16,34336
s_waitcnt lgkmcnt(7)
v_fmac_f32 v32, v28, v20
MAA 132,84,148
TR 12,16,42272
v_fmac_f32 v33, v29, v20
MAA 132,80,132
TR 14,16,42784
v_fmac_f32 v34, v30, v20
MAA 148,88,132
TR 16,16,33856
v_fmac_f32 v35, v31, v20
MAA 148,92,148
TR 18,16,34368
v_fmac_f32 v36, v28, v22
MAA 144,92,144
buffer_load_dwordx4 v14, s[80:83], s54 offen offset:2112   lds
MAA 144,88,128
TR 20,16,42304
v_fmac_f32 v37, v29, v22
MAA 192,96,128
TR 22,16,42816
v_fmac_f32 v38, v30, v22
MAA 192,100,144
TR 24,16,33888
v_fmac_f32 v39, v31, v22
MAA 196,100,148
TR 26,16,34400
v_fmac_f32 v40, v28, v24
MAA 196,96,132
TR 28,16,42336
v_fmac_f32 v41, v29, v24
MAA 212,104,132
buffer_load_dwordx4 v15, s[80:83], s54 offen offset:3168   lds
MAA 212,108,148
TR 30,16,42848
s_add_u32 s54, s54, 458752
MAA 208,108,144
TR 32,16,33920
s_mov_b32 m0, s67
MAA 208,104,128
TR 34,16,34432
v_fmac_f32 v42, v30, v24
MAA 240,112,128
TR 36,16,42368
v_fmac_f32 v43, v31, v24
MAA 240,116,144
TR 38,16,42880
v_fmac_f32 v44, v28, v26
MAA 244,116,148
buffer_load_dwordx4 v19, s[28:31], s58 offen offset:1056 lds
MAA 244,112,132
TR 40,16,33952
s_add_u32 s67, s67, 8448
MAA 252,120,132
TR 42,16,34464
s_add_u32 s58, s58, 0x40000
MAA 252,124,148
TR 44,16,42400
v_fmac_f32 v45, v29, v26
MAA 248,124,144
TR 46,16,42912
v_fmac_f32 v46, v30, v26
MAA 248,120,128
TR 48,17,33792
v_fmac_f32 v47, v31, v26
MAA 220,104,140
ds_read_b128 v[28:31], v9 offset:128
s_waitcnt lgkmcnt(15)
v_fmac_f32 v48, v4, v20
MAA 220,108,156
buffer_load_dwordx4 a[128:131], v10, s[16:19], s52 offen sc1
MAA 216,108,152
TR 50,17,34304
v_fmac_f32 v49, v5, v20
MAA 216,104,136
TR 52,17,42240
v_fmac_f32 v50, v6, v20
MAA 200,96,136
TR 54,17,42752
v_fmac_f32 v51, v7, v20
MAA 200,100,152
TR 56,17,33824
v_fmac_f32 v52, v4, v22
MAA 204,100,156
TR 58,17,34336
v_fmac_f32 v53, v5, v22
MAA 204,96,140
buffer_load_dwordx4 a[132:135], v10, s[16:19], s52 offen offset:1024 sc1
MAA 156,88,140
TR 60,17,42272
s_add_u32 s52, s52, 131072
MAA 156,92,156
TR 62,17,42784
v_fmac_f32 v54, v6, v22
MAA 152,92,152
v_fmac_f32 v55, v7, v22
v_fmac_f32 v56, v4, v24
MAA 152,88,136
v_fmac_f32 v57, v5, v24
v_fmac_f32 v58, v6, v24
MAA 136,80,136
v_fmac_f32 v59, v7, v24
v_fmac_f32 v60, v4, v26
MAA 136,84,152
buffer_load_dwordx4 a[144:147], v10, s[16:19], s52 offen sc1
.Lpad33:
s_cbranch_execz .Lnopoll60r
MAA 140,84,156
v_fmac_f32 v61, v5, v26
v_fmac_f32 v62, v6, v26
MAA 140,80,140
v_fmac_f32 v63, v7, v26
s_waitcnt lgkmcnt(7)
v_fmac_f32 v96, v28, v20
MAA 92,72,140
ds_read_b128 v[4:7], v8
v_fmac_f32 v97, v29, v20
MAA 92,76,156
v_fmac_f32 v98, v30, v20
v_fmac_f32 v99, v31, v20
MAA 88,76,152
v_fmac_f32 v100, v28, v22
v_fmac_f32 v101, v29, v22
MAA 88,72,136
buffer_load_dwordx4 a[148:151], v10, s[16:19], s52 offen offset:1024 sc1
MAA 72,64,136
s_add_u32 s52, s52, 131072
v_fmac_f32 v102, v30, v22
v_fmac_f32 v103, v31, v22
MAA 72,68,152
v_fmac_f32 v104, v28, v24
v_fmac_f32 v105, v29, v24
MAA 76,68,156
v_fmac_f32 v106, v30, v24
v_fmac_f32 v107, v31, v24
MAA 76,64,140
v_fmac_f32 v108, v28, v26
v_fmac_f32 v109, v29, v26
v_fmac_f32 v110, v30, v26
v_fmac_f32 v111, v31, v26
s_waitcnt lgkmcnt(0)
v_fmac_f32 v224, v4, v20
v_fmac_f32 v225, v5, v20
v_fmac_f32 v226, v6, v20
v_fmac_f32 v227, v7, v20
v_fmac_f32 v228, v4, v22
v_fmac_f32 v229, v5, v22
v_fmac_f32 v230, v6, v22
v_fmac_f32 v231, v7, v22
s_waitcnt vmcnt(18) lgkmcnt(0)
s_barrier
MAA 32,0,160
ds_read_b128 v[28:31], v9 offset:704
MAA 32,4,176
ds_read_b128 v[4:7], v9 offset:768
MAA 36,4,180
buffer_load_dwordx4 a[136:139], v11, s[16:19], s53 offen sc1
MAA 36,0,164
TR 64,16,50688
MAA 52,8,164
TR 66,16,51200
MAA 52,12,180
TR 68,16,59136
MAA 48,12,176
TR 70,16,59648
MAA 48,8,160
TR 72,16,50720
MAA 96,16,160
buffer_load_dwordx4 a[140:143], v11, s[16:19], s53 offen offset:1024 sc1
MAA 96,20,176
TR 74,16,51232
s_add_u32 s53, s53, 131072
MAA 100,20,180
TR 76,16,59168
s_waitcnt lgkmcnt(8)
v_fmac_f32 v144, v28, v20
MAA 100,16,164
TR 78,16,59680
v_fmac_f32 v145, v29, v20
MAA 116,24,164
TR 80,16,50752
v_fmac_f32 v146, v30, v20
MAA 116,28,180
TR 82,16,51264
v_fmac_f32 v147, v31, v20
MAA 112,28,176
buffer_load_dwordx4 a[152:155], v11, s[16:19], s53 offen sc1
MAA 112,24,160
TR 84,16,59200
v_fmac_f32 v148, v28, v22
MAA 160,32,160
TR 86,16,59712
v_fmac_f32 v149, v29, v22
MAA 160,36,176
TR 88,16,50784
v_fmac_f32 v150, v30, v22
MAA 164,36,180
TR 90,16,51296
v_fmac_f32 v151, v31, v22
MAA 164,32,164
TR 92,16,59232
v_fmac_f32 v152, v28, v24
MAA 180,40,164
buffer_load_dwordx4 a[156:159], v11, s[16:19], s53 offen offset:1024 sc1
MAA 180,44,180
TR 94,16,59744
s_add_u32 s53, s53, 131072
MAA 176,44,176
TR 96,16,50816
s_add_u32 m0, s55, 118272
MAA 176,40,160
TR 98,16,51328
v_fmac_f32 v153, v29, v24
MAA 224,48,160
TR 100,16,59264
v_fmac_f32 v154, v30, v24
MAA 224,52,176
TR 102,16,59776
v_fmac_f32 v155, v31, v24
MAA 228,52,180
buffer_load_dwordx4 v12, s[32:35], s54 offen   lds
MAA 228,48,164
TR 104,16,50848
v_fmac_f32 v156, v28, v26
MAA 236,56,164
TR 106,16,51360
v_fmac_f32 v157, v29, v26
MAA 236,60,180
TR 108,16,59296
v_fmac_f32 v158, v30, v26
MAA 232,60,176
TR 110,16,59808
v_fmac_f32 v159, v31, v26
MAA 232,56,160
ds_read_b128 v[28:31], v9 offset:832
s_waitcnt lgkmcnt(15)
v_fmac_f32 v192, v4, v20
s_waitcnt vmcnt(19)
MAA 188,40,172
buffer_load_dwordx4 v13, s[32:35], s54 offen offset:1056   lds
MAA 188,44,188
TR 112,17,50688
v_fmac_f32 v193, v5, v20
MAA 184,44,184
TR 114,17,51200
v_fmac_f32 v194, v6, v20
MAA 184,40,168
TR 116,17,59136
v_fmac_f32 v195, v7, v20
MAA 168,32,168
TR 118,17,59648
v_fmac_f32 v196, v4, v22
MAA 168,36,184
TR 120,17,50720
v_fmac_f32 v197, v5, v22
MAA 172,36,188
buffer_load_dwordx4 v14, s[32:35], s54 offen offset:2112   lds
MAA 172,32,172
TR 122,17,51232
v_fmac_f32 v198, v6, v22
MAA 124,24,172
TR 124,17,59168
v_fmac_f32 v199, v7, v22
MAA 124,28,188
TR 126,17,59680
v_fmac_f32 v200, v4, v24
MAA 120,28,184
v_fmac_f32 v201, v5, v24
v_fmac_f32 v202, v6, v24
MAA 120,24,168
v_fmac_f32 v203, v7, v24
v_fmac_f32 v204, v4, v26
MAA 104,16,168
buffer_load_dwordx4 v15, s[32:35], s54 offen offset:3168   lds
MAA 104,20,184
s_mov_b32 m0, s67
v_fmac_f32 v205, v5, v26
v_fmac_f32 v206, v6, v26
MAA 108,20,188
v_fmac_f32 v207, v7, v26
s_waitcnt lgkmcnt(8)
v_fmac_f32 v208, v28, v20
MAA 108,16,172
ds_read_b128 v[4:7], v8 offset:576
v_fmac_f32 v209, v29, v20
MAA 60,8,172
v_fmac_f32 v210, v30, v20
v_fmac_f32 v211, v31, v20
MAA 60,12,188
v_fmac_f32 v212, v28, v22
v_fmac_f32 v213, v29, v22
MAA 56,12,184
buffer_load_dwordx4 v18, s[28:31], s58 offen lds
MAA 56,8,168
v_fmac_f32 v214, v30, v22
v_fmac_f32 v215, v31, v22
MAA 40,0,168
v_fmac_f32 v216, v28, v24
v_fmac_f32 v217, v29, v24
MAA 40,4,184
v_fmac_f32 v218, v30, v24
v_fmac_f32 v219, v31, v24
MAA 44,4,188
v_fmac_f32 v220, v28, v26
v_fmac_f32 v221, v29, v26
MAA 44,0,172
v_fmac_f32 v222, v30, v26
v_fmac_f32 v223, v31, v26
s_waitcnt lgkmcnt(0)
v_fmac_f32 v248, v4, v20
v_fmac_f32 v249, v5, v20
v_fmac_f32 v250, v6, v20
v_fmac_f32 v251, v7, v20
v_fmac_f32 v252, v4, v22
v_fmac_f32 v253, v5, v22
v_fmac_f32 v254, v6, v22
v_fmac_f32 v255, v7, v22
s_waitcnt vmcnt(19) lgkmcnt(0)
s_barrier
MAA 64,64,160
ds_read_b128 v[28:31], v9 offset:192
s_add_u32 m0, s55, 135168
MAA 64,68,176
ds_read_b128 v[4:7], v9 offset:256
MAA 68,68,180
buffer_load_dwordx4 v12, s[80:83], s54 offen   lds
MAA 68,64,164
ds_read_b64_tr_b16 a[0:1], v16
MAA 84,72,164
TR 2,16,512
MAA 84,76,180
TR 4,16,8448
MAA 80,76,176
TR 6,16,8960
MAA 80,72,160
TR 8,16,32
MAA 128,80,160
buffer_load_dwordx4 v13, s[80:83], s54 offen offset:1056   lds
MAA 128,84,176
TR 10,16,544
s_waitcnt lgkmcnt(7)
v_fmac_f32 v112, v28, v20
MAA 132,84,180
TR 12,16,8480
v_fmac_f32 v113, v29, v20
MAA 132,80,164
TR 14,16,8992
v_fmac_f32 v114, v30, v20
MAA 148,88,164
TR 16,16,64
v_fmac_f32 v115, v31, v20
MAA 148,92,180
TR 18,16,576
v_fmac_f32 v116, v28, v22
MAA 144,92,176
buffer_load_dwordx4 v14, s[80:83], s54 offen offset:2112   lds
MAA 144,88,160
TR 20,16,8512
v_fmac_f32 v117, v29, v22
MAA 192,96,160
TR 22,16,9024
v_fmac_f32 v118, v30, v22
MAA 192,100,176
TR 24,16,96
v_fmac_f32 v119, v31, v22
MAA 196,100,180
TR 26,16,608
v_fmac_f32 v120, v28, v24
MAA 196,96,164
TR 28,16,8544
v_fmac_f32 v121, v29, v24
MAA 212,104,164
buffer_load_dwordx4 v15, s[80:83], s54 offen offset:3168   lds
MAA 212,108,180
TR 30,16,9056
s_add_u32 s54, s54, 458752
MAA 208,108,176
TR 32,16,128
s_mov_b32 m0, s67
MAA 208,104,160
TR 34,16,640
v_fmac_f32 v122, v30, v24
MAA 240,112,160
TR 36,16,8576
v_fmac_f32 v123, v31, v24
MAA 240,116,176
TR 38,16,9088
v_fmac_f32 v124, v28, v26
MAA 244,116,180
buffer_load_dwordx4 v19, s[28:31], s58 offen offset:1056 lds
MAA 244,112,164
TR 40,16,160
s_add_u32 s67, s67, 8448
MAA 252,120,164
TR 42,16,672
s_add_u32 s46, s46, 1
MAA 252,124,180
TR 44,16,8608
s_xor_b32 s58, s46, s87
MAA 248,124,176
TR 46,16,9120
s_mul_i32 s58, s58, 458752
MAA 248,120,160
ds_read_b64_tr_b16 a[48:49], v17
v_fmac_f32 v125, v29, v26
MAA 220,104,172
buffer_load_dwordx4 a[160:163], v10, s[16:19], s52 offen sc1
MAA 220,108,188
TR 50,17,512
v_fmac_f32 v126, v30, v26
MAA 216,108,184
TR 52,17,8448
v_fmac_f32 v127, v31, v26
MAA 216,104,168
ds_read_b128 v[28:31], v9 offset:320
s_waitcnt lgkmcnt(15)
v_fmac_f32 v160, v4, v20
MAA 200,96,168
TR 54,17,8960
v_fmac_f32 v161, v5, v20
MAA 200,100,184
TR 56,17,32
v_fmac_f32 v162, v6, v20
MAA 204,100,188
buffer_load_dwordx4 a[164:167], v10, s[16:19], s52 offen offset:1024 sc1
MAA 204,96,172
TR 58,17,544
s_add_u32 s52, s52, 131072
MAA 156,88,172
TR 60,17,8480
v_fmac_f32 v163, v7, v20
MAA 156,92,188
TR 62,17,8992
v_fmac_f32 v164, v4, v22
MAA 152,92,184
v_fmac_f32 v165, v5, v22
v_fmac_f32 v166, v6, v22
MAA 152,88,168
v_fmac_f32 v167, v7, v22
v_fmac_f32 v168, v4, v24
MAA 136,80,168
buffer_load_dwordx4 a[176:179], v10, s[16:19], s52 offen sc1
MAA 136,84,184
v_fmac_f32 v169, v5, v24
v_fmac_f32 v170, v6, v24
MAA 140,84,188
v_fmac_f32 v171, v7, v24
v_fmac_f32 v172, v4, v26
MAA 140,80,172
v_fmac_f32 v173, v5, v26
v_fmac_f32 v174, v6, v26
MAA 92,72,172
v_fmac_f32 v175, v7, v26
s_waitcnt lgkmcnt(5)
v_fmac_f32 v176, v28, v20
MAA 92,76,188
ds_read_b128 v[4:7], v8 offset:64
v_fmac_f32 v177, v29, v20
MAA 88,76,184
buffer_load_dwordx4 a[180:183], v10, s[16:19], s52 offen offset:1024 sc1
MAA 88,72,168
s_add_u32 s52, s52, 131072
v_fmac_f32 v178, v30, v20
v_fmac_f32 v179, v31, v20
MAA 72,64,168
v_fmac_f32 v180, v28, v22
v_fmac_f32 v181, v29, v22
MAA 72,68,184
v_fmac_f32 v182, v30, v22
v_fmac_f32 v183, v31, v22
MAA 76,68,188
v_fmac_f32 v184, v28, v24
v_fmac_f32 v185, v29, v24
MAA 76,64,172
v_fmac_f32 v186, v30, v24
v_fmac_f32 v187, v31, v24
v_fmac_f32 v188, v28, v26
v_fmac_f32 v189, v29, v26
v_fmac_f32 v190, v30, v26
v_fmac_f32 v191, v31, v26
v_accvgpr_read_b32 v28, a192
s_waitcnt lgkmcnt(0)
v_fmac_f32 v232, v4, v20
v_fmac_f32 v233, v5, v20
v_fmac_f32 v234, v6, v20
v_fmac_f32 v235, v7, v20
v_fmac_f32 v236, v4, v22
v_fmac_f32 v237, v5, v22
v_fmac_f32 v238, v6, v22
v_fmac_f32 v239, v7, v22
v_accvgpr_read_b32 v29, a193
v_accvgpr_read_b32 v30, a194
v_accvgpr_read_b32 v31, a195
s_mov_b32 s15, -4
.p2align 6
.Lk65:
s_waitcnt vmcnt(18) lgkmcnt(0)
s_barrier
MAA 32,0,128
TR 64,16,16896
MAA 32,4,144
buffer_load_dwordx4 a[168:171], v11, s[16:19], s53 offen sc1
MAA 36,4,148
TR 66,16,17408
MAA 36,0,132
TR 68,16,25344
MAA 52,8,132
TR 70,16,25856
MAA 52,12,148
MAA 48,12,144
TR 72,16,16928
MAA 48,8,128
buffer_load_dwordx4 a[172:175], v11, s[16:19], s53 offen offset:1024 sc1
MAA 96,16,128
TR 74,16,17440
s_add_u32 s53, s53, 131072
MAA 96,20,144
TR 76,16,25376
MAA 100,20,148
MAA 100,16,132
TR 78,16,25888
MAA 116,24,132
TR 80,16,16960
MAA 116,28,148
buffer_load_dwordx4 a[184:187], v11, s[16:19], s53 offen sc1
MAA 112,28,144
TR 82,16,17472
MAA 112,24,128
MAA 160,32,128
TR 84,16,25408
MAA 160,36,144
TR 86,16,25920
MAA 164,36,148
TR 88,16,16992
MAA 164,32,132
buffer_load_dwordx4 a[188:191], v11, s[16:19], s53 offen offset:1024 sc1
MAA 180,40,132
s_add_u32 s53, s53, 131072
MAA 180,44,148
TR 90,16,17504
MAA 176,44,144
TR 92,16,25440
MAA 176,40,128
TR 94,16,25952
MAA 224,48,128
s_add_u32 m0, s55, 84480
MAA 224,52,144
buffer_load_dwordx4 v12, s[32:35], s54 offen   lds
MAA 228,52,148
TR 96,16,17024
MAA 228,48,132
TR 98,16,17536
MAA 236,56,132
TR 100,16,25472
MAA 236,60,148
TR 102,16,25984
MAA 232,60,144
MAA 232,56,128
TR 104,16,17056
s_waitcnt vmcnt(19)
MAA 188,40,140
TR 106,16,17568
MAA 188,44,156
buffer_load_dwordx4 v13, s[32:35], s54 offen offset:1056   lds
MAA 184,44,152
TR 108,16,25504
MAA 184,40,136
MAA 168,32,136
TR 110,16,26016
MAA 168,36,152
buffer_load_dwordx4 v14, s[32:35], s54 offen offset:2112   lds
MAA 172,36,156
TR 112,17,16896
MAA 172,32,140
TR 114,17,17408
MAA 124,24,140
MAA 124,28,156
TR 116,17,25344
MAA 120,28,152
TR 118,17,25856
MAA 120,24,136
buffer_load_dwordx4 v15, s[32:35], s54 offen offset:3168   lds
MAA 104,16,136
TR 120,17,16928
MAA 104,20,152
MAA 108,20,156
TR 122,17,17440
MAA 108,16,140
TR 124,17,25376
MAA 60,8,140
TR 126,17,25888
s_mov_b32 m0, s67
MAA 60,12,156
buffer_load_dwordx4 v18, s[28:31], s58 offen lds
MAA 56,12,152
MAA 56,8,136
MAA 40,0,136
MAA 40,4,152
MAA 44,4,156
MAA 44,0,140
s_waitcnt vmcnt(19) lgkmcnt(0)
s_barrier
MAA 64,64,128
TR 0,16,33792
s_add_u32 m0, s55, 101376
MAA 64,68,144
buffer_load_dwordx4 v12, s[80:83], s54 offen   lds
MAA 68,68,148
TR 2,16,34304
MAA 68,64,132
TR 4,16,42240
MAA 84,72,132
TR 6,16,42752
MAA 84,76,148
MAA 80,76,144
TR 8,16,33824
MAA 80,72,128
buffer_load_dwordx4 v13, s[80:83], s54 offen offset:1056   lds
MAA 128,80,128
TR 10,16,34336
MAA 128,84,144
TR 12,16,42272
MAA 132,84,148
TR 14,16,42784
MAA 132,80,132
MAA 148,88,132
TR 16,16,33856
MAA 148,92,148
buffer_load_dwordx4 v14, s[80:83], s54 offen offset:2112   lds
MAA 144,92,144
TR 18,16,34368
MAA 144,88,128
TR 20,16,42304
MAA 192,96,128
MAA 192,100,144
TR 22,16,42816
MAA 196,100,148
TR 24,16,33888
MAA 196,96,132
buffer_load_dwordx4 v15, s[80:83], s54 offen offset:3168   lds
MAA 212,104,132
TR 26,16,34400
s_add_u32 s54, s54, 458752
MAA 212,108,148
TR 28,16,42336
MAA 208,108,144
MAA 208,104,128
TR 30,16,42848
MAA 240,112,128
TR 32,16,33920
s_mov_b32 m0, s67
MAA 240,116,144
buffer_load_dwordx4 v19, s[28:31], s58 offen offset:1056 lds
MAA 244,116,148
s_add_u32 s67, s67, 8448
s_add_u32 s58, s58, 0x40000
MAA 244,112,132
TR 34,16,34432
MAA 252,120,132
MAA 252,124,148
TR 36,16,42368
MAA 248,124,144
TR 38,16,42880
MAA 248,120,128
buffer_load_dwordx4 a[128:131], v10, s[16:19], s52 offen sc1
MAA 220,104,140
TR 40,16,33952
MAA 220,108,156
TR 42,16,34464
MAA 216,108,152
MAA 216,104,136
TR 44,16,42400
MAA 200,96,136
TR 46,16,42912
MAA 200,100,152
buffer_load_dwordx4 a[132:135], v10, s[16:19], s52 offen offset:1024 sc1
MAA 204,100,156
TR 48,17,33792
s_add_u32 s52, s52, 131072
MAA 204,96,140
MAA 156,88,140
TR 50,17,34304
MAA 156,92,156
TR 52,17,42240
MAA 152,92,152
TR 54,17,42752
MAA 152,88,136
buffer_load_dwordx4 a[144:147], v10, s[16:19], s52 offen sc1
MAA 136,80,136
TR 56,17,33824
MAA 136,84,152
MAA 140,84,156
TR 58,17,34336
MAA 140,80,140
TR 60,17,42272
MAA 92,72,140
TR 62,17,42784
MAA 92,76,156
buffer_load_dwordx4 a[148:151], v10, s[16:19], s52 offen offset:1024 sc1
MAA 88,76,152
.Lpad34:
s_cbranch_execz .Lnopoll60r
s_add_u32 s52, s52, 131072
MAA 88,72,136
MAA 72,64,136
MAA 72,68,152
MAA 76,68,156
MAA 76,64,140
s_waitcnt vmcnt(18) lgkmcnt(0)
s_barrier
MAA 32,0,160
TR 64,16,50688
MAA 32,4,176
buffer_load_dwordx4 a[136:139], v11, s[16:19], s53 offen sc1
MAA 36,4,180
TR 66,16,51200
MAA 36,0,164
TR 68,16,59136
MAA 52,8,164
TR 70,16,59648
MAA 52,12,180
MAA 48,12,176
TR 72,16,50720
MAA 48,8,160
buffer_load_dwordx4 a[140:143], v11, s[16:19], s53 offen offset:1024 sc1
MAA 96,16,160
TR 74,16,51232
s_add_u32 s53, s53, 131072
MAA 96,20,176
TR 76,16,59168
MAA 100,20,180
MAA 100,16,164
TR 78,16,59680
MAA 116,24,164
TR 80,16,50752
MAA 116,28,180
buffer_load_dwordx4 a[152:155], v11, s[16:19], s53 offen sc1
MAA 112,28,176
TR 82,16,51264
MAA 112,24,160
MAA 160,32,160
TR 84,16,59200
MAA 160,36,176
TR 86,16,59712
MAA 164,36,180
TR 88,16,50784
MAA 164,32,164
buffer_load_dwordx4 a[156:159], v11, s[16:19], s53 offen offset:1024 sc1
MAA 180,40,164
s_add_u32 s53, s53, 131072
MAA 180,44,180
TR 90,16,51296
MAA 176,44,176
TR 92,16,59232
MAA 176,40,160
TR 94,16,59744
MAA 224,48,160
s_add_u32 m0, s55, 118272
MAA 224,52,176
buffer_load_dwordx4 v12, s[32:35], s54 offen   lds
MAA 228,52,180
TR 96,16,50816
MAA 228,48,164
TR 98,16,51328
MAA 236,56,164
TR 100,16,59264
MAA 236,60,180
TR 102,16,59776
MAA 232,60,176
MAA 232,56,160
TR 104,16,50848
s_waitcnt vmcnt(19)
MAA 188,40,172
TR 106,16,51360
MAA 188,44,188
buffer_load_dwordx4 v13, s[32:35], s54 offen offset:1056   lds
MAA 184,44,184
TR 108,16,59296
MAA 184,40,168
MAA 168,32,168
TR 110,16,59808
MAA 168,36,184
buffer_load_dwordx4 v14, s[32:35], s54 offen offset:2112   lds
MAA 172,36,188
TR 112,17,50688
MAA 172,32,172
TR 114,17,51200
MAA 124,24,172
MAA 124,28,188
TR 116,17,59136
MAA 120,28,184
TR 118,17,59648
MAA 120,24,168
buffer_load_dwordx4 v15, s[32:35], s54 offen offset:3168   lds
MAA 104,16,168
TR 120,17,50720
MAA 104,20,184
MAA 108,20,188
TR 122,17,51232
MAA 108,16,172
TR 124,17,59168
MAA 60,8,172
TR 126,17,59680
s_mov_b32 m0, s67
MAA 60,12,188
buffer_load_dwordx4 v18, s[28:31], s58 offen lds
MAA 56,12,184
MAA 56,8,168
MAA 40,0,168
MAA 40,4,184
MAA 44,4,188
MAA 44,0,172
s_waitcnt vmcnt(19) lgkmcnt(0)
s_barrier
MAA 64,64,160
ds_read_b64_tr_b16 a[0:1], v16
s_add_u32 m0, s55, 135168
MAA 64,68,176
buffer_load_dwordx4 v12, s[80:83], s54 offen   lds
MAA 68,68,180
TR 2,16,512
MAA 68,64,164
TR 4,16,8448
MAA 84,72,164
TR 6,16,8960
MAA 84,76,180
MAA 80,76,176
TR 8,16,32
MAA 80,72,160
buffer_load_dwordx4 v13, s[80:83], s54 offen offset:1056   lds
MAA 128,80,160
TR 10,16,544
MAA 128,84,176
TR 12,16,8480
MAA 132,84,180
TR 14,16,8992
MAA 132,80,164
MAA 148,88,164
TR 16,16,64
MAA 148,92,180
buffer_load_dwordx4 v14, s[80:83], s54 offen offset:2112   lds
MAA 144,92,176
TR 18,16,576
MAA 144,88,160
TR 20,16,8512
MAA 192,96,160
MAA 192,100,176
TR 22,16,9024
MAA 196,100,180
TR 24,16,96
MAA 196,96,164
buffer_load_dwordx4 v15, s[80:83], s54 offen offset:3168   lds
MAA 212,104,164
TR 26,16,608
s_add_u32 s54, s54, 458752
MAA 212,108,180
TR 28,16,8544
MAA 208,108,176
MAA 208,104,160
TR 30,16,9056
MAA 240,112,160
TR 32,16,128
s_mov_b32 m0, s67
MAA 240,116,176
buffer_load_dwordx4 v19, s[28:31], s58 offen offset:1056 lds
MAA 244,116,180
s_add_u32 s67, s67, 8448
s_add_u32 s46, s46, 1
s_xor_b32 s58, s46, s87
s_mul_i32 s58, s58, 458752
MAA 244,112,164
TR 34,16,640
MAA 252,120,164
MAA 252,124,180
TR 36,16,8576
MAA 248,124,176
TR 38,16,9088
MAA 248,120,160
buffer_load_dwordx4 a[160:163], v10, s[16:19], s52 offen sc1
MAA 220,104,172
TR 40,16,160
MAA 220,108,188
TR 42,16,672
MAA 216,108,184
MAA 216,104,168
TR 44,16,8608
MAA 200,96,168
TR 46,16,9120
MAA 200,100,184
buffer_load_dwordx4 a[164:167], v10, s[16:19], s52 offen offset:1024 sc1
MAA 204,100,188
ds_read_b64_tr_b16 a[48:49], v17
s_add_u32 s52, s52, 131072
MAA 204,96,172
MAA 156,88,172
TR 50,17,512
MAA 156,92,188
TR 52,17,8448
MAA 152,92,184
TR 54,17,8960
MAA 152,88,168
buffer_load_dwordx4 a[176:179], v10, s[16:19], s52 offen sc1
MAA 136,80,168
TR 56,17,32
MAA 136,84,184
MAA 140,84,188
TR 58,17,544
MAA 140,80,172
TR 60,17,8480
MAA 92,72,172
TR 62,17,8992
MAA 92,76,188
buffer_load_dwordx4 a[180:183], v10, s[16:19], s52 offen offset:1024 sc1
MAA 88,76,184
s_add_u32 s52, s52, 131072
MAA 88,72,168
MAA 72,64,168
MAA 72,68,184
MAA 76,68,188
s_add_u32 s15, s15, 1
MAA 76,64,172
s_cbranch_scc0 .Lk65
s_waitcnt vmcnt(10) lgkmcnt(0)
s_barrier
MAA 32,0,128
buffer_load_dwordx4 a[168:171], v11, s[16:19], s53 offen sc1
MAA 32,4,144
TR 64,16,16896
s_add_u32 s58, s99, 2293760
MAA 48,12,144
TR 66,16,17408
s_lshl_b32 s74, s3, 11
MAA 48,8,128
TR 68,16,25344
s_add_u32 s74, s74, s84
MAA 36,0,132
buffer_load_dwordx4 a[172:175], v11, s[16:19], s53 offen offset:1024 sc1
MAA 36,4,148
TR 70,16,25856
s_add_u32 s53, s53, 131072
MAA 52,12,148
TR 72,16,16928
v_lshl_add_u32 v4, v1, 4, s74
MAA 52,8,132
TR 74,16,17440
v_lshrrev_b32 v2, 3, v1
MAA 40,0,136
buffer_load_dwordx4 a[184:187], v11, s[16:19], s53 offen sc1
MAA 40,4,152
TR 76,16,25376
v_cmp_eq_u32 vcc, 3, v2
MAA 56,12,152
TR 78,16,25888
v_add_u32 v2, 67108480, v4
MAA 56,8,136
TR 80,16,33792
v_cndmask_b32 v4, v4, v2, vcc
MAA 44,0,140
buffer_load_dwordx4 a[188:191], v11, s[16:19], s53 offen offset:1024 sc1
MAA 44,4,156
TR 82,16,34304
s_add_u32 s53, s53, 131072
MAA 60,12,156
TR 84,16,42240
s_and_b32 s74, s7, 1
MAA 60,8,140
TR 86,16,42752
s_add_u32 s54, s98, 65536
MAA 96,16,128
TR 88,16,33824
v_bfe_u32 v7, v1, 2, 3
MAA 96,20,144
TR 90,16,34336
v_mul_u32_u24 v7, 1056, v7
MAA 112,28,144
TR 92,16,42272
s_waitcnt vmcnt(9)
s_barrier
MAA 112,24,128
TR 94,16,42784
v_bfe_u32 v2, v1, 5, 1
MAA 100,16,132
TR 96,16,50688
v_lshl_add_u32 v7, v2, 8, v7
MAA 100,20,148
TR 98,16,51200
v_and_b32 v2, 3, v1
MAA 116,28,148
TR 100,16,59136
v_lshl_add_u32 v7, v2, 3, v7
MAA 116,24,132
TR 102,16,59648
s_lshl_b32 s74, s74, 7
MAA 104,16,136
TR 104,16,50720
s_xor_b32 s75, s74, 128
MAA 104,20,152
TR 106,16,51232
v_add_u32 v6, s75, v7
MAA 120,28,152
TR 108,16,59168
v_add_u32 v7, s74, v7
MAA 120,24,136
TR 110,16,59680
s_mul_i32 s55, s3, 2112
MAA 108,16,140
TR 112,16,16960
s_mov_b32 s57, 67584
MAA 108,20,156
TR 114,16,17472
MAA 124,28,156
TR 116,16,25408
MAA 124,24,140
TR 118,16,25920
MAA 160,32,128
TR 120,16,16992
MAA 160,36,144
TR 122,16,17504
MAA 176,44,144
TR 124,16,25440
MAA 176,40,128
TR 126,16,25952
MAA 164,32,132
TR 192,16,33856
MAA 164,36,148
TR 194,16,34368
MAA 180,44,148
TR 196,16,42304
MAA 180,40,132
TR 198,16,42816
MAA 168,32,136
TR 200,16,33888
MAA 168,36,152
TR 202,16,34400
MAA 184,44,152
TR 204,16,42336
MAA 184,40,136
TR 206,16,42848
MAA 172,32,140
TR 208,16,50752
MAA 172,36,156
TR 210,16,51264
MAA 188,44,156
TR 212,16,59200
MAA 188,40,140
TR 214,16,59712
MAA 224,48,128
TR 216,16,50784
MAA 224,52,144
TR 218,16,51296
MAA 232,60,144
TR 220,16,59232
MAA 232,56,128
TR 222,16,59744
MAA 228,48,132
TR 0,16,17024
MAA 228,52,148
TR 2,16,17536
MAA 236,60,148
TR 4,16,25472
MAA 236,56,132
TR 6,16,25984
s_waitcnt lgkmcnt(15)
MAA 64,64,128
TR 8,16,17056
MAA 64,68,144
TR 10,16,17568
s_waitcnt vmcnt(7)
MAA 64,96,160
TR 12,16,25504
s_waitcnt vmcnt(5)
MAA 64,100,176
TR 14,16,26016
MAA 80,108,176
TR 16,16,33920
MAA 80,104,160
TR 18,16,34432
MAA 80,76,144
TR 20,16,42368
MAA 80,72,128
TR 22,16,42880
MAA 32,80,160
TR 24,16,33952
MAA 32,84,176
TR 26,16,34464
MAA 48,92,176
TR 28,16,42400
MAA 48,88,160
TR 30,16,42912
s_nop 2
v_pk_mul_f32 v[64:65], v[64:65], v[32:33]
TR 32,16,50816
TR 34,16,51328
v_pk_mul_f32 v[32:33], v[32:33], v[28:29] op_sel_hi:[1,0]
v_pk_mul_f32 v[66:67], v[66:67], v[34:35]
v_pk_mul_f32 v[34:35], v[34:35], v[28:29] op_sel_hi:[1,0]
v_exp_f32 v32, v32
v_pk_mul_f32 v[80:81], v[80:81], v[48:49]
v_pk_mul_f32 v[48:49], v[48:49], v[28:29] op_sel_hi:[1,0]
v_pk_mul_f32 v[82:83], v[82:83], v[50:51]
v_pk_mul_f32 v[50:51], v[50:51], v[28:29] op_sel_hi:[1,0]
v_exp_f32 v33, v33
v_exp_f32 v34, v34
MAA 68,64,132
TR 36,16,59264
v_exp_f32 v35, v35
MAA 68,68,148
TR 38,16,59776
v_exp_f32 v48, v48
MAA 68,96,164
TR 40,16,50848
v_exp_f32 v49, v49
s_waitcnt vmcnt(4)
MAA 68,100,180
TR 42,16,51360
v_exp_f32 v50, v50
MAA 84,108,180
TR 44,16,59296
v_exp_f32 v51, v51
MAA 84,104,164
TR 46,16,59808
MAA 84,76,148
TR 48,17,16896
MAA 84,72,132
TR 50,17,17408
MAA 36,80,164
TR 52,17,25344
MAA 36,84,180
TR 54,17,25856
MAA 52,92,180
TR 56,17,16928
MAA 52,88,164
TR 58,17,17440
s_nop 2
v_pk_mul_f32 v[68:69], v[68:69], v[36:37]
v_pk_fma_f32 v[32:33], v[32:33], v[20:21], v[20:21] op_sel:[0,1,1] op_sel_hi:[1,1,1]
v_pk_fma_f32 v[34:35], v[34:35], v[20:21], v[20:21] op_sel:[0,1,1] op_sel_hi:[1,1,1]
v_pk_mul_f32 v[36:37], v[36:37], v[28:29] op_sel:[0,1] op_sel_hi:[1,1]
v_pk_mul_f32 v[70:71], v[70:71], v[38:39]
v_pk_mul_f32 v[38:39], v[38:39], v[28:29] op_sel:[0,1] op_sel_hi:[1,1]
v_pk_fma_f32 v[48:49], v[48:49], v[20:21], v[20:21] op_sel:[0,1,1] op_sel_hi:[1,1,1]
v_pk_mul_f32 v[84:85], v[84:85], v[52:53]
v_pk_mul_f32 v[52:53], v[52:53], v[28:29] op_sel:[0,1] op_sel_hi:[1,1]
v_pk_mul_f32 v[86:87], v[86:87], v[54:55]
v_pk_mul_f32 v[54:55], v[54:55], v[28:29] op_sel:[0,1] op_sel_hi:[1,1]
v_pk_fma_f32 v[50:51], v[50:51], v[20:21], v[20:21] op_sel:[0,1,1] op_sel_hi:[1,1,1]
v_rcp_f32 v32, v32
v_rcp_f32 v33, v33
MAA 72,64,136
TR 60,17,25376
v_rcp_f32 v34, v34
MAA 72,68,152
TR 62,17,25888
v_rcp_f32 v35, v35
s_waitcnt vmcnt(3)
MAA 72,96,168
v_rcp_f32 v48, v48
s_waitcnt vmcnt(1)
MAA 72,100,184
v_rcp_f32 v49, v49
MAA 88,108,184
v_rcp_f32 v50, v50
MAA 88,104,168
v_rcp_f32 v51, v51
MAA 88,76,152
v_exp_f32 v36, v36
MAA 88,72,136
v_exp_f32 v37, v37
MAA 40,80,168
v_exp_f32 v38, v38
MAA 40,84,184
v_exp_f32 v39, v39
MAA 56,92,184
v_exp_f32 v52, v52
MAA 56,88,168
v_exp_f32 v53, v53
v_exp_f32 v54, v54
v_exp_f32 v55, v55
v_pk_mul_f32 v[64:65], v[64:65], v[32:33]
v_pk_mul_f32 v[66:67], v[66:67], v[34:35]
v_pk_mul_f32 v[80:81], v[80:81], v[48:49]
v_pk_mul_f32 v[82:83], v[82:83], v[50:51]
v_pk_mul_f32 v[72:73], v[72:73], v[40:41]
v_pk_mul_f32 v[40:41], v[40:41], v[30:31] op_sel_hi:[1,0]
v_pk_mul_f32 v[74:75], v[74:75], v[42:43]
v_pk_mul_f32 v[42:43], v[42:43], v[30:31] op_sel_hi:[1,0]
v_pk_mul_f32 v[88:89], v[88:89], v[56:57]
v_pk_mul_f32 v[56:57], v[56:57], v[30:31] op_sel_hi:[1,0]
v_pk_mul_f32 v[90:91], v[90:91], v[58:59]
v_pk_mul_f32 v[58:59], v[58:59], v[30:31] op_sel_hi:[1,0]
v_pk_fma_f32 v[36:37], v[36:37], v[22:23], v[22:23] op_sel:[0,1,1] op_sel_hi:[1,1,1]
v_pk_fma_f32 v[38:39], v[38:39], v[22:23], v[22:23] op_sel:[0,1,1] op_sel_hi:[1,1,1]
v_pk_fma_f32 v[52:53], v[52:53], v[22:23], v[22:23] op_sel:[0,1,1] op_sel_hi:[1,1,1]
v_pk_fma_f32 v[54:55], v[54:55], v[22:23], v[22:23] op_sel:[0,1,1] op_sel_hi:[1,1,1]
v_cvt_pk_bf16_f32 v32, v64, v65
v_cvt_pk_bf16_f32 v33, v66, v67
v_cvt_pk_bf16_f32 v34, v80, v81
v_cvt_pk_bf16_f32 v35, v82, v83
MAA 76,64,140
buffer_store_dwordx4 v[32:35], v10, s[16:19], s62 offen sc1
MAA 76,68,156
TR 64,17,33792
v_rcp_f32 v36, v36
MAA 76,96,172
TR 66,17,34304
v_rcp_f32 v37, v37
s_waitcnt vmcnt(1)
MAA 76,100,188
TR 68,17,42240
v_rcp_f32 v38, v38
MAA 92,108,188
TR 70,17,42752
v_rcp_f32 v39, v39
MAA 92,104,172
v_rcp_f32 v52, v52
MAA 92,76,156
TR 76,17,42272
v_rcp_f32 v53, v53
MAA 92,72,140
TR 72,17,33824
v_rcp_f32 v54, v54
MAA 44,80,172
TR 74,17,34336
v_rcp_f32 v55, v55
MAA 44,84,188
TR 78,17,42784
v_exp_f32 v40, v40
MAA 60,92,188
TR 80,17,50688
v_exp_f32 v41, v41
MAA 60,88,172
TR 82,17,51200
v_exp_f32 v42, v42
v_exp_f32 v43, v43
v_exp_f32 v56, v56
v_exp_f32 v57, v57
v_exp_f32 v58, v58
v_exp_f32 v59, v59
v_pk_mul_f32 v[68:69], v[68:69], v[36:37]
v_pk_mul_f32 v[70:71], v[70:71], v[38:39]
v_pk_mul_f32 v[84:85], v[84:85], v[52:53]
v_pk_mul_f32 v[86:87], v[86:87], v[54:55]
v_pk_mul_f32 v[76:77], v[76:77], v[44:45]
v_pk_mul_f32 v[44:45], v[44:45], v[30:31] op_sel:[0,1] op_sel_hi:[1,1]
v_pk_mul_f32 v[78:79], v[78:79], v[46:47]
v_pk_mul_f32 v[46:47], v[46:47], v[30:31] op_sel:[0,1] op_sel_hi:[1,1]
v_pk_mul_f32 v[92:93], v[92:93], v[60:61]
v_pk_mul_f32 v[60:61], v[60:61], v[30:31] op_sel:[0,1] op_sel_hi:[1,1]
v_pk_mul_f32 v[94:95], v[94:95], v[62:63]
v_pk_mul_f32 v[62:63], v[62:63], v[30:31] op_sel:[0,1] op_sel_hi:[1,1]
.Lpad35:
s_cbranch_execz .Lpad38
v_pk_fma_f32 v[40:41], v[40:41], v[24:25], v[24:25] op_sel:[0,1,1] op_sel_hi:[1,1,1]
v_pk_fma_f32 v[42:43], v[42:43], v[24:25], v[24:25] op_sel:[0,1,1] op_sel_hi:[1,1,1]
v_pk_fma_f32 v[56:57], v[56:57], v[24:25], v[24:25] op_sel:[0,1,1] op_sel_hi:[1,1,1]
v_pk_fma_f32 v[58:59], v[58:59], v[24:25], v[24:25] op_sel:[0,1,1] op_sel_hi:[1,1,1]
v_cvt_pk_bf16_f32 v36, v68, v69
v_cvt_pk_bf16_f32 v37, v70, v71
v_cvt_pk_bf16_f32 v38, v84, v85
v_cvt_pk_bf16_f32 v39, v86, v87
MAA 128,112,128
buffer_store_dwordx4 v[36:39], v10, s[16:19], s62 offen offset:1024 sc1
MAA 128,116,144
TR 84,17,59136
v_rcp_f32 v40, v40
s_waitcnt lgkmcnt(15)
MAA 128,208,160
TR 86,17,59648
v_rcp_f32 v41, v41
MAA 128,212,176
TR 88,17,50720
v_rcp_f32 v42, v42
MAA 144,220,176
TR 90,17,51232
v_rcp_f32 v43, v43
MAA 144,216,160
TR 92,17,59168
v_rcp_f32 v56, v56
MAA 144,124,144
TR 94,17,59680
v_rcp_f32 v57, v57
MAA 144,120,128
v_rcp_f32 v58, v58
MAA 96,192,160
v_rcp_f32 v59, v59
MAA 96,196,176
v_exp_f32 v44, v44
MAA 112,204,176
v_exp_f32 v45, v45
MAA 112,200,160
v_lshrrev_b32 v69, 2, v0
v_min_u32 v69, 1, v69
v_lshlrev_b32 v69, 28, v69
v_lshl_add_u32 v68, v0, 7, v69
v_xor_b32 v69, 64, v0
v_min_u32 v69, 1, v69
v_lshlrev_b32 v70, 4, v69
v_sub_u32 v70, 16, v70
v_lshlrev_b32 v69, 28, v69
v_mov_b32 v71, 1
s_waitcnt lgkmcnt(0)
s_barrier
v_mov_b32 v84, 0
v_mov_b32 v85, 0
v_mov_b32 v86, 0
v_exp_f32 v46, v46
v_exp_f32 v47, v47
v_exp_f32 v60, v60
v_exp_f32 v61, v61
v_exp_f32 v62, v62
v_exp_f32 v63, v63
v_pk_mul_f32 v[72:73], v[72:73], v[40:41]
v_pk_mul_f32 v[74:75], v[74:75], v[42:43]
v_pk_mul_f32 v[88:89], v[88:89], v[56:57]
v_pk_mul_f32 v[90:91], v[90:91], v[58:59]
v_pk_mul_f32 v[128:129], v[128:129], v[96:97]
v_pk_mul_f32 v[96:97], v[96:97], v[28:29] op_sel_hi:[1,0]
v_pk_mul_f32 v[130:131], v[130:131], v[98:99]
v_pk_mul_f32 v[98:99], v[98:99], v[28:29] op_sel_hi:[1,0]
v_pk_mul_f32 v[144:145], v[144:145], v[112:113]
v_pk_mul_f32 v[112:113], v[112:113], v[28:29] op_sel_hi:[1,0]
v_pk_mul_f32 v[146:147], v[146:147], v[114:115]
v_pk_mul_f32 v[114:115], v[114:115], v[28:29] op_sel_hi:[1,0]
v_pk_fma_f32 v[44:45], v[44:45], v[26:27], v[26:27] op_sel:[0,1,1] op_sel_hi:[1,1,1]
v_pk_fma_f32 v[46:47], v[46:47], v[26:27], v[26:27] op_sel:[0,1,1] op_sel_hi:[1,1,1]
v_pk_fma_f32 v[60:61], v[60:61], v[26:27], v[26:27] op_sel:[0,1,1] op_sel_hi:[1,1,1]
v_pk_fma_f32 v[62:63], v[62:63], v[26:27], v[26:27] op_sel:[0,1,1] op_sel_hi:[1,1,1]
v_cvt_pk_bf16_f32 v40, v72, v73
v_cvt_pk_bf16_f32 v41, v74, v75
v_cvt_pk_bf16_f32 v42, v88, v89
v_cvt_pk_bf16_f32 v43, v90, v91
MAA 132,112,132
buffer_store_dwordx4 v[40:43], v11, s[16:19], s62 offen sc1
MAA 132,116,148
s_add_u32 m0, s59, 84480
v_rcp_f32 v44, v44
MAA 132,208,164
v_rcp_f32 v45, v45
MAA 132,212,180
v_rcp_f32 v46, v46
MAA 148,220,180
buffer_load_dwordx4 v18, s[28:31], s58 offen lds
MAA 148,216,164
v_rcp_f32 v47, v47
MAA 148,124,148
v_rcp_f32 v60, v60
MAA 148,120,132
v_rcp_f32 v61, v61
MAA 100,192,164
buffer_load_dwordx4 v19, s[28:31], s58 offen offset:1056 lds
MAA 100,196,180
s_add_u32 m0, s59, 92928
s_add_u32 s58, s99, 2555904
v_rcp_f32 v62, v62
MAA 116,204,180
v_rcp_f32 v63, v63
MAA 116,200,164
v_exp_f32 v96, v96
v_exp_f32 v97, v97
v_exp_f32 v98, v98
v_exp_f32 v99, v99
v_exp_f32 v112, v112
v_exp_f32 v113, v113
v_exp_f32 v114, v114
v_exp_f32 v115, v115
v_pk_mul_f32 v[76:77], v[76:77], v[44:45]
v_pk_mul_f32 v[78:79], v[78:79], v[46:47]
v_pk_mul_f32 v[92:93], v[92:93], v[60:61]
v_pk_mul_f32 v[94:95], v[94:95], v[62:63]
v_pk_mul_f32 v[132:133], v[132:133], v[100:101]
v_pk_mul_f32 v[100:101], v[100:101], v[28:29] op_sel:[0,1] op_sel_hi:[1,1]
v_pk_mul_f32 v[134:135], v[134:135], v[102:103]
v_pk_mul_f32 v[102:103], v[102:103], v[28:29] op_sel:[0,1] op_sel_hi:[1,1]
v_pk_mul_f32 v[148:149], v[148:149], v[116:117]
v_pk_mul_f32 v[116:117], v[116:117], v[28:29] op_sel:[0,1] op_sel_hi:[1,1]
v_pk_mul_f32 v[150:151], v[150:151], v[118:119]
v_pk_mul_f32 v[118:119], v[118:119], v[28:29] op_sel:[0,1] op_sel_hi:[1,1]
v_pk_fma_f32 v[96:97], v[96:97], v[20:21], v[20:21] op_sel:[0,1,1] op_sel_hi:[1,1,1]
v_pk_fma_f32 v[98:99], v[98:99], v[20:21], v[20:21] op_sel:[0,1,1] op_sel_hi:[1,1,1]
v_pk_fma_f32 v[112:113], v[112:113], v[20:21], v[20:21] op_sel:[0,1,1] op_sel_hi:[1,1,1]
v_pk_fma_f32 v[114:115], v[114:115], v[20:21], v[20:21] op_sel:[0,1,1] op_sel_hi:[1,1,1]
v_cvt_pk_bf16_f32 v44, v76, v77
v_cvt_pk_bf16_f32 v45, v78, v79
v_cvt_pk_bf16_f32 v46, v92, v93
v_cvt_pk_bf16_f32 v47, v94, v95
MAA 136,112,136
buffer_store_dwordx4 v[44:47], v11, s[16:19], s62 offen offset:1024 sc1
MAA 136,116,152
v_rcp_f32 v96, v96
MAA 136,208,168
v_rcp_f32 v97, v97
MAA 136,212,184
v_rcp_f32 v98, v98
MAA 152,220,184
buffer_load_dwordx4 v18, s[28:31], s58 offen lds
MAA 152,216,168
v_rcp_f32 v99, v99
MAA 152,124,152
v_rcp_f32 v112, v112
MAA 152,120,136
v_rcp_f32 v113, v113
MAA 104,192,168
buffer_load_dwordx4 v19, s[28:31], s58 offen offset:1056 lds
MAA 104,196,184
s_add_u32 m0, s59, 101376
s_add_u32 s58, s100, 2752512
v_rcp_f32 v114, v114
MAA 120,204,184
v_rcp_f32 v115, v115
MAA 120,200,168
v_exp_f32 v100, v100
v_exp_f32 v101, v101
v_exp_f32 v102, v102
v_exp_f32 v103, v103
v_exp_f32 v116, v116
v_exp_f32 v117, v117
v_exp_f32 v118, v118
v_exp_f32 v119, v119
v_pk_mul_f32 v[128:129], v[128:129], v[96:97]
v_pk_mul_f32 v[130:131], v[130:131], v[98:99]
v_pk_mul_f32 v[144:145], v[144:145], v[112:113]
v_pk_mul_f32 v[146:147], v[146:147], v[114:115]
v_pk_mul_f32 v[136:137], v[136:137], v[104:105]
v_pk_mul_f32 v[104:105], v[104:105], v[30:31] op_sel_hi:[1,0]
v_pk_mul_f32 v[138:139], v[138:139], v[106:107]
v_pk_mul_f32 v[106:107], v[106:107], v[30:31] op_sel_hi:[1,0]
v_pk_mul_f32 v[152:153], v[152:153], v[120:121]
v_pk_mul_f32 v[120:121], v[120:121], v[30:31] op_sel_hi:[1,0]
v_pk_mul_f32 v[154:155], v[154:155], v[122:123]
v_pk_mul_f32 v[122:123], v[122:123], v[30:31] op_sel_hi:[1,0]
v_pk_fma_f32 v[100:101], v[100:101], v[22:23], v[22:23] op_sel:[0,1,1] op_sel_hi:[1,1,1]
v_pk_fma_f32 v[102:103], v[102:103], v[22:23], v[22:23] op_sel:[0,1,1] op_sel_hi:[1,1,1]
v_pk_fma_f32 v[116:117], v[116:117], v[22:23], v[22:23] op_sel:[0,1,1] op_sel_hi:[1,1,1]
v_pk_fma_f32 v[118:119], v[118:119], v[22:23], v[22:23] op_sel:[0,1,1] op_sel_hi:[1,1,1]
v_cvt_pk_bf16_f32 v96, v128, v129
v_cvt_pk_bf16_f32 v97, v130, v131
v_cvt_pk_bf16_f32 v98, v144, v145
v_cvt_pk_bf16_f32 v99, v146, v147
MAA 140,112,140
buffer_store_dwordx4 v[96:99], v10, s[16:19], s63 offen sc1
MAA 140,116,156
v_rcp_f32 v100, v100
MAA 140,208,172
v_rcp_f32 v101, v101
MAA 140,212,188
v_rcp_f32 v102, v102
MAA 156,220,188
buffer_load_dwordx4 v18, s[28:31], s58 offen lds
MAA 156,216,172
v_rcp_f32 v103, v103
MAA 156,124,156
v_rcp_f32 v116, v116
MAA 156,120,140
v_rcp_f32 v117, v117
MAA 108,192,172
buffer_load_dwordx4 v19, s[28:31], s58 offen offset:1056 lds
MAA 108,196,188
s_add_u32 m0, s59, 109824
s_add_u32 s58, s100, 3014656
v_rcp_f32 v118, v118
MAA 124,204,188
v_rcp_f32 v119, v119
MAA 124,200,172
v_exp_f32 v104, v104
v_exp_f32 v105, v105
v_exp_f32 v106, v106
v_exp_f32 v107, v107
v_exp_f32 v120, v120
v_exp_f32 v121, v121
v_exp_f32 v122, v122
v_exp_f32 v123, v123
v_pk_mul_f32 v[132:133], v[132:133], v[100:101]
v_pk_mul_f32 v[134:135], v[134:135], v[102:103]
v_pk_mul_f32 v[148:149], v[148:149], v[116:117]
v_pk_mul_f32 v[150:151], v[150:151], v[118:119]
v_pk_mul_f32 v[140:141], v[140:141], v[108:109]
v_pk_mul_f32 v[108:109], v[108:109], v[30:31] op_sel:[0,1] op_sel_hi:[1,1]
v_pk_mul_f32 v[142:143], v[142:143], v[110:111]
v_pk_mul_f32 v[110:111], v[110:111], v[30:31] op_sel:[0,1] op_sel_hi:[1,1]
v_pk_mul_f32 v[156:157], v[156:157], v[124:125]
v_pk_mul_f32 v[124:125], v[124:125], v[30:31] op_sel:[0,1] op_sel_hi:[1,1]
v_pk_mul_f32 v[158:159], v[158:159], v[126:127]
v_pk_mul_f32 v[126:127], v[126:127], v[30:31] op_sel:[0,1] op_sel_hi:[1,1]
v_pk_fma_f32 v[104:105], v[104:105], v[24:25], v[24:25] op_sel:[0,1,1] op_sel_hi:[1,1,1]
v_pk_fma_f32 v[106:107], v[106:107], v[24:25], v[24:25] op_sel:[0,1,1] op_sel_hi:[1,1,1]
v_pk_fma_f32 v[120:121], v[120:121], v[24:25], v[24:25] op_sel:[0,1,1] op_sel_hi:[1,1,1]
v_pk_fma_f32 v[122:123], v[122:123], v[24:25], v[24:25] op_sel:[0,1,1] op_sel_hi:[1,1,1]
v_cvt_pk_bf16_f32 v100, v132, v133
v_cvt_pk_bf16_f32 v101, v134, v135
v_cvt_pk_bf16_f32 v102, v148, v149
v_cvt_pk_bf16_f32 v103, v150, v151
MAA 192,0,128
buffer_store_dwordx4 v[100:103], v10, s[16:19], s63 offen offset:1024 sc1
MAA 192,4,144
v_rcp_f32 v104, v104
MAA 192,32,160
s_waitcnt vmcnt(6)
s_barrier
v_rcp_f32 v105, v105
MAA 192,36,176
v_rcp_f32 v106, v106
MAA 208,44,176
buffer_atomic_add v71, v68, s[16:19], s72 offen offset:512
MAA 208,40,160
v_rcp_f32 v107, v107
MAA 208,12,144
v_rcp_f32 v120, v120
MAA 208,8,128
v_rcp_f32 v121, v121
MAA 160,16,160
buffer_load_dwordx4 v18, s[28:31], s58 offen lds
MAA 160,20,176
v_rcp_f32 v122, v122
MAA 176,28,176
v_rcp_f32 v123, v123
MAA 176,24,160
v_exp_f32 v108, v108
v_exp_f32 v109, v109
v_exp_f32 v110, v110
v_exp_f32 v111, v111
v_exp_f32 v124, v124
v_exp_f32 v125, v125
v_exp_f32 v126, v126
v_exp_f32 v127, v127
v_pk_mul_f32 v[136:137], v[136:137], v[104:105]
v_pk_mul_f32 v[138:139], v[138:139], v[106:107]
v_pk_mul_f32 v[152:153], v[152:153], v[120:121]
v_pk_mul_f32 v[154:155], v[154:155], v[122:123]
v_pk_mul_f32 v[192:193], v[192:193], v[160:161]
v_pk_mul_f32 v[160:161], v[160:161], v[28:29] op_sel_hi:[1,0]
v_pk_mul_f32 v[194:195], v[194:195], v[162:163]
v_pk_mul_f32 v[162:163], v[162:163], v[28:29] op_sel_hi:[1,0]
v_pk_mul_f32 v[208:209], v[208:209], v[176:177]
v_pk_mul_f32 v[176:177], v[176:177], v[28:29] op_sel_hi:[1,0]
v_pk_mul_f32 v[210:211], v[210:211], v[178:179]
v_pk_mul_f32 v[178:179], v[178:179], v[28:29] op_sel_hi:[1,0]
v_pk_fma_f32 v[108:109], v[108:109], v[26:27], v[26:27] op_sel:[0,1,1] op_sel_hi:[1,1,1]
v_pk_fma_f32 v[110:111], v[110:111], v[26:27], v[26:27] op_sel:[0,1,1] op_sel_hi:[1,1,1]
v_pk_fma_f32 v[124:125], v[124:125], v[26:27], v[26:27] op_sel:[0,1,1] op_sel_hi:[1,1,1]
v_pk_fma_f32 v[126:127], v[126:127], v[26:27], v[26:27] op_sel:[0,1,1] op_sel_hi:[1,1,1]
v_cvt_pk_bf16_f32 v104, v136, v137
v_cvt_pk_bf16_f32 v105, v138, v139
v_cvt_pk_bf16_f32 v106, v152, v153
v_cvt_pk_bf16_f32 v107, v154, v155
MAA 196,0,132
buffer_store_dwordx4 v[104:107], v11, s[16:19], s63 offen sc1
MAA 196,4,148
v_rcp_f32 v108, v108
MAA 196,32,164
v_rcp_f32 v109, v109
MAA 196,36,180
v_rcp_f32 v110, v110
MAA 212,44,180
buffer_load_dwordx4 v19, s[28:31], s58 offen offset:1056 lds
MAA 212,40,164
s_add_u32 m0, s59, 118272
s_add_u32 s58, s101, 3211264
v_rcp_f32 v111, v111
MAA 212,12,148
v_rcp_f32 v124, v124
MAA 212,8,132
v_rcp_f32 v125, v125
MAA 164,16,164
buffer_load_dwordx4 v18, s[28:31], s58 offen lds
MAA 164,20,180
v_rcp_f32 v126, v126
MAA 180,28,180
v_rcp_f32 v127, v127
MAA 180,24,164
v_exp_f32 v160, v160
v_exp_f32 v161, v161
v_exp_f32 v162, v162
v_exp_f32 v163, v163
v_exp_f32 v176, v176
v_exp_f32 v177, v177
v_exp_f32 v178, v178
v_exp_f32 v179, v179
v_pk_mul_f32 v[140:141], v[140:141], v[108:109]
v_pk_mul_f32 v[142:143], v[142:143], v[110:111]
v_pk_mul_f32 v[156:157], v[156:157], v[124:125]
v_pk_mul_f32 v[158:159], v[158:159], v[126:127]
v_pk_mul_f32 v[196:197], v[196:197], v[164:165]
v_pk_mul_f32 v[164:165], v[164:165], v[28:29] op_sel:[0,1] op_sel_hi:[1,1]
v_pk_mul_f32 v[198:199], v[198:199], v[166:167]
v_pk_mul_f32 v[166:167], v[166:167], v[28:29] op_sel:[0,1] op_sel_hi:[1,1]
v_pk_mul_f32 v[212:213], v[212:213], v[180:181]
v_pk_mul_f32 v[180:181], v[180:181], v[28:29] op_sel:[0,1] op_sel_hi:[1,1]
v_pk_mul_f32 v[214:215], v[214:215], v[182:183]
v_pk_mul_f32 v[182:183], v[182:183], v[28:29] op_sel:[0,1] op_sel_hi:[1,1]
v_pk_fma_f32 v[160:161], v[160:161], v[20:21], v[20:21] op_sel:[0,1,1] op_sel_hi:[1,1,1]
v_pk_fma_f32 v[162:163], v[162:163], v[20:21], v[20:21] op_sel:[0,1,1] op_sel_hi:[1,1,1]
v_pk_fma_f32 v[176:177], v[176:177], v[20:21], v[20:21] op_sel:[0,1,1] op_sel_hi:[1,1,1]
v_pk_fma_f32 v[178:179], v[178:179], v[20:21], v[20:21] op_sel:[0,1,1] op_sel_hi:[1,1,1]
v_cvt_pk_bf16_f32 v108, v140, v141
v_cvt_pk_bf16_f32 v109, v142, v143
v_cvt_pk_bf16_f32 v110, v156, v157
v_cvt_pk_bf16_f32 v111, v158, v159
MAA 200,0,136
buffer_store_dwordx4 v[108:111], v11, s[16:19], s63 offen offset:1024 sc1
MAA 200,4,152
v_rcp_f32 v160, v160
MAA 200,32,168
v_rcp_f32 v161, v161
MAA 200,36,184
v_rcp_f32 v162, v162
MAA 216,44,184
buffer_load_dwordx4 v19, s[28:31], s58 offen offset:1056 lds
MAA 216,40,168
s_add_u32 m0, s59, 126720
s_add_u32 s58, s101, 3473408
v_rcp_f32 v163, v163
MAA 216,12,152
v_rcp_f32 v176, v176
MAA 216,8,136
v_rcp_f32 v177, v177
MAA 168,16,168
buffer_load_dwordx4 v18, s[28:31], s58 offen lds
MAA 168,20,184
v_rcp_f32 v178, v178
MAA 184,28,184
v_rcp_f32 v179, v179
MAA 184,24,168
v_exp_f32 v164, v164
v_exp_f32 v165, v165
v_exp_f32 v166, v166
v_exp_f32 v167, v167
v_exp_f32 v180, v180
v_exp_f32 v181, v181
v_exp_f32 v182, v182
v_exp_f32 v183, v183
v_pk_mul_f32 v[192:193], v[192:193], v[160:161]
v_pk_mul_f32 v[194:195], v[194:195], v[162:163]
v_pk_mul_f32 v[208:209], v[208:209], v[176:177]
v_pk_mul_f32 v[210:211], v[210:211], v[178:179]
v_pk_mul_f32 v[200:201], v[200:201], v[168:169]
v_pk_mul_f32 v[168:169], v[168:169], v[30:31] op_sel_hi:[1,0]
v_pk_mul_f32 v[202:203], v[202:203], v[170:171]
v_pk_mul_f32 v[170:171], v[170:171], v[30:31] op_sel_hi:[1,0]
v_pk_mul_f32 v[216:217], v[216:217], v[184:185]
v_pk_mul_f32 v[184:185], v[184:185], v[30:31] op_sel_hi:[1,0]
v_pk_mul_f32 v[218:219], v[218:219], v[186:187]
v_pk_mul_f32 v[186:187], v[186:187], v[30:31] op_sel_hi:[1,0]
v_pk_fma_f32 v[164:165], v[164:165], v[22:23], v[22:23] op_sel:[0,1,1] op_sel_hi:[1,1,1]
v_pk_fma_f32 v[166:167], v[166:167], v[22:23], v[22:23] op_sel:[0,1,1] op_sel_hi:[1,1,1]
v_pk_fma_f32 v[180:181], v[180:181], v[22:23], v[22:23] op_sel:[0,1,1] op_sel_hi:[1,1,1]
v_pk_fma_f32 v[182:183], v[182:183], v[22:23], v[22:23] op_sel:[0,1,1] op_sel_hi:[1,1,1]
v_cvt_pk_bf16_f32 v160, v192, v193
v_cvt_pk_bf16_f32 v161, v194, v195
v_cvt_pk_bf16_f32 v162, v208, v209
v_cvt_pk_bf16_f32 v163, v210, v211
MAA 204,0,140
buffer_store_dwordx4 v[160:163], v10, s[16:19], s64 offen sc1
MAA 204,4,156
v_rcp_f32 v164, v164
MAA 204,32,172
v_rcp_f32 v165, v165
MAA 204,36,188
v_rcp_f32 v166, v166
MAA 220,44,188
buffer_atomic_add v84, v69, s[16:19], s73 offen offset:512 sc0
MAA 220,40,172
v_rcp_f32 v167, v167
MAA 220,12,156
v_rcp_f32 v180, v180
MAA 220,8,140
v_rcp_f32 v181, v181
MAA 172,16,172
buffer_load_dwordx4 v19, s[28:31], s58 offen offset:1056 lds
MAA 172,20,188
v_rcp_f32 v182, v182
MAA 188,28,188
v_rcp_f32 v183, v183
MAA 188,24,172
v_exp_f32 v168, v168
v_exp_f32 v169, v169
v_exp_f32 v170, v170
v_exp_f32 v171, v171
v_exp_f32 v184, v184
v_exp_f32 v185, v185
v_exp_f32 v186, v186
v_exp_f32 v187, v187
v_pk_mul_f32 v[196:197], v[196:197], v[164:165]
v_pk_mul_f32 v[198:199], v[198:199], v[166:167]
v_pk_mul_f32 v[212:213], v[212:213], v[180:181]
v_pk_mul_f32 v[214:215], v[214:215], v[182:183]
v_pk_mul_f32 v[204:205], v[204:205], v[172:173]
v_pk_mul_f32 v[172:173], v[172:173], v[30:31] op_sel:[0,1] op_sel_hi:[1,1]
v_pk_mul_f32 v[206:207], v[206:207], v[174:175]
v_pk_mul_f32 v[174:175], v[174:175], v[30:31] op_sel:[0,1] op_sel_hi:[1,1]
v_pk_mul_f32 v[220:221], v[220:221], v[188:189]
v_pk_mul_f32 v[188:189], v[188:189], v[30:31] op_sel:[0,1] op_sel_hi:[1,1]
v_pk_mul_f32 v[222:223], v[222:223], v[190:191]
v_pk_mul_f32 v[190:191], v[190:191], v[30:31] op_sel:[0,1] op_sel_hi:[1,1]
v_pk_fma_f32 v[168:169], v[168:169], v[24:25], v[24:25] op_sel:[0,1,1] op_sel_hi:[1,1,1]
v_pk_fma_f32 v[170:171], v[170:171], v[24:25], v[24:25] op_sel:[0,1,1] op_sel_hi:[1,1,1]
v_pk_fma_f32 v[184:185], v[184:185], v[24:25], v[24:25] op_sel:[0,1,1] op_sel_hi:[1,1,1]
v_pk_fma_f32 v[186:187], v[186:187], v[24:25], v[24:25] op_sel:[0,1,1] op_sel_hi:[1,1,1]
v_cvt_pk_bf16_f32 v164, v196, v197
v_cvt_pk_bf16_f32 v165, v198, v199
v_cvt_pk_bf16_f32 v166, v212, v213
v_cvt_pk_bf16_f32 v167, v214, v215
MAA 240,48,128
buffer_store_dwordx4 v[164:167], v10, s[16:19], s64 offen offset:1024 sc1
MAA 240,52,144
v_rcp_f32 v168, v168
MAA 240,80,160
v_rcp_f32 v169, v169
MAA 240,84,176
v_rcp_f32 v170, v170
MAA 248,92,176
buffer_atomic_add v85, v69, s[16:19], s73 offen offset:512 sc0
MAA 248,88,160
v_rcp_f32 v171, v171
MAA 248,60,144
v_rcp_f32 v184, v184
MAA 248,56,128
v_rcp_f32 v185, v185
MAA 224,64,160
v_rcp_f32 v186, v186
MAA 224,68,176
v_rcp_f32 v187, v187
MAA 232,76,176
v_exp_f32 v172, v172
MAA 232,72,160
v_exp_f32 v173, v173
v_exp_f32 v174, v174
v_exp_f32 v175, v175
v_exp_f32 v188, v188
v_exp_f32 v189, v189
v_exp_f32 v190, v190
v_exp_f32 v191, v191
v_pk_mul_f32 v[200:201], v[200:201], v[168:169]
v_pk_mul_f32 v[202:203], v[202:203], v[170:171]
v_pk_mul_f32 v[216:217], v[216:217], v[184:185]
v_pk_mul_f32 v[218:219], v[218:219], v[186:187]
v_pk_mul_f32 v[240:241], v[240:241], v[224:225]
v_pk_mul_f32 v[224:225], v[224:225], v[28:29] op_sel_hi:[1,0]
v_pk_mul_f32 v[242:243], v[242:243], v[226:227]
v_pk_mul_f32 v[226:227], v[226:227], v[28:29] op_sel_hi:[1,0]
v_pk_mul_f32 v[248:249], v[248:249], v[232:233]
v_pk_mul_f32 v[232:233], v[232:233], v[28:29] op_sel_hi:[1,0]
v_pk_mul_f32 v[250:251], v[250:251], v[234:235]
v_pk_mul_f32 v[234:235], v[234:235], v[28:29] op_sel_hi:[1,0]
v_pk_fma_f32 v[172:173], v[172:173], v[26:27], v[26:27] op_sel:[0,1,1] op_sel_hi:[1,1,1]
v_pk_fma_f32 v[174:175], v[174:175], v[26:27], v[26:27] op_sel:[0,1,1] op_sel_hi:[1,1,1]
v_pk_fma_f32 v[188:189], v[188:189], v[26:27], v[26:27] op_sel:[0,1,1] op_sel_hi:[1,1,1]
v_pk_fma_f32 v[190:191], v[190:191], v[26:27], v[26:27] op_sel:[0,1,1] op_sel_hi:[1,1,1]
v_cvt_pk_bf16_f32 v168, v200, v201
v_cvt_pk_bf16_f32 v169, v202, v203
v_cvt_pk_bf16_f32 v170, v216, v217
v_cvt_pk_bf16_f32 v171, v218, v219
buffer_store_dwordx4 v[168:171], v11, s[16:19], s64 offen sc1
buffer_atomic_add v86, v69, s[16:19], s73 offen offset:512 sc0
s_waitcnt vmcnt(5)
v_cmp_gt_u32 vcc, v70, v84
s_nop 0
s_cbranch_vccz .Lok66
s_waitcnt vmcnt(2)
v_cmp_gt_u32 vcc, v70, v85
s_nop 0
s_cbranch_vccz .Lok66
s_waitcnt vmcnt(0)
v_cmp_gt_u32 vcc, v70, v86
s_nop 0
s_cbranch_vccz .Lok66
s_mov_b32 s15, 0
.Lok66l:
v_mov_b32 v84, 0
buffer_atomic_add v84, v69, s[16:19], s73 offen offset:512 sc0
s_add_u32 s15, s15, 1
s_cmp_gt_u32 s15, 100000
s_waitcnt vmcnt(0)
s_cbranch_scc1 .Lok66
v_cmp_gt_u32 vcc, v70, v84
s_nop 0
s_cbranch_vccnz .Lok66l
.Lok66:
s_waitcnt vmcnt(4)
s_barrier
MAA 244,48,132
ds_read_b64_tr_b16 a[0:1], v7
s_add_u32 s52, s76, 0
MAA 244,52,148
buffer_load_dwordx4 v[96:99], v4, s[16:19], s52 offen sc1
MAA 244,80,164
TR 2,7,512
v_rcp_f32 v172, v172
MAA 244,84,180
TR 4,7,32
v_rcp_f32 v173, v173
MAA 252,92,180
TR 6,7,544
v_rcp_f32 v174, v174
MAA 252,88,164
buffer_load_dwordx4 v[100:103], v4, s[16:19], s52 offen offset:1024 sc1
MAA 252,60,148
TR 8,7,64
s_add_u32 s52, s76, 65536
MAA 252,56,132
TR 10,7,576
v_rcp_f32 v175, v175
MAA 228,64,164
TR 12,7,96
v_rcp_f32 v188, v188
MAA 228,68,180
buffer_load_dwordx4 v[104:107], v4, s[16:19], s52 offen sc1
MAA 236,76,180
TR 14,7,608
v_rcp_f32 v189, v189
MAA 236,72,164
TR 16,7,8448
v_rcp_f32 v190, v190
v_rcp_f32 v191, v191
v_exp_f32 v224, v224
v_exp_f32 v225, v225
v_exp_f32 v226, v226
v_exp_f32 v227, v227
v_exp_f32 v232, v232
v_exp_f32 v233, v233
v_exp_f32 v234, v234
v_exp_f32 v235, v235
v_pk_mul_f32 v[204:205], v[204:205], v[172:173]
buffer_load_dwordx4 v[108:111], v4, s[16:19], s52 offen offset:1024 sc1
s_add_u32 s52, s77, 114688
v_pk_mul_f32 v[206:207], v[206:207], v[174:175]
v_pk_mul_f32 v[220:221], v[220:221], v[188:189]
v_pk_mul_f32 v[222:223], v[222:223], v[190:191]
v_pk_mul_f32 v[244:245], v[244:245], v[228:229]
v_pk_mul_f32 v[228:229], v[228:229], v[28:29] op_sel:[0,1] op_sel_hi:[1,1]
v_pk_mul_f32 v[246:247], v[246:247], v[230:231]
v_pk_mul_f32 v[230:231], v[230:231], v[28:29] op_sel:[0,1] op_sel_hi:[1,1]
v_pk_mul_f32 v[252:253], v[252:253], v[236:237]
v_pk_mul_f32 v[236:237], v[236:237], v[28:29] op_sel:[0,1] op_sel_hi:[1,1]
v_pk_mul_f32 v[254:255], v[254:255], v[238:239]
v_pk_mul_f32 v[238:239], v[238:239], v[28:29] op_sel:[0,1] op_sel_hi:[1,1]
v_pk_fma_f32 v[224:225], v[224:225], v[20:21], v[20:21] op_sel:[0,1,1] op_sel_hi:[1,1,1]
buffer_load_dwordx4 v[112:115], v4, s[16:19], s52 offen sc1
v_pk_fma_f32 v[226:227], v[226:227], v[20:21], v[20:21] op_sel:[0,1,1] op_sel_hi:[1,1,1]
v_pk_fma_f32 v[232:233], v[232:233], v[20:21], v[20:21] op_sel:[0,1,1] op_sel_hi:[1,1,1]
v_pk_fma_f32 v[234:235], v[234:235], v[20:21], v[20:21] op_sel:[0,1,1] op_sel_hi:[1,1,1]
v_cvt_pk_bf16_f32 v172, v204, v205
v_cvt_pk_bf16_f32 v173, v206, v207
v_cvt_pk_bf16_f32 v174, v220, v221
v_cvt_pk_bf16_f32 v175, v222, v223
TR 18,7,8960
TR 20,7,8480
TR 22,7,8992
buffer_store_dwordx4 v[172:175], v11, s[16:19], s64 offen offset:1024 sc1
TR 24,7,8512
TR 26,7,9024
TR 28,7,8544
TR 30,7,9056
v_rcp_f32 v224, v224
v_rcp_f32 v225, v225
v_rcp_f32 v226, v226
v_rcp_f32 v227, v227
v_rcp_f32 v232, v232
v_rcp_f32 v233, v233
v_rcp_f32 v234, v234
v_rcp_f32 v235, v235
v_exp_f32 v228, v228
v_exp_f32 v229, v229
v_exp_f32 v230, v230
v_exp_f32 v231, v231
v_exp_f32 v236, v236
v_exp_f32 v237, v237
v_exp_f32 v238, v238
v_exp_f32 v239, v239
v_pk_mul_f32 v[240:241], v[240:241], v[224:225]
buffer_load_dwordx4 v[116:119], v4, s[16:19], s52 offen offset:1024 sc1
s_add_u32 s52, s77, 180224
v_pk_mul_f32 v[242:243], v[242:243], v[226:227]
v_pk_mul_f32 v[248:249], v[248:249], v[232:233]
v_pk_mul_f32 v[250:251], v[250:251], v[234:235]
.Lpad36:
s_cbranch_execz .Lpad39
v_pk_fma_f32 v[228:229], v[228:229], v[22:23], v[22:23] op_sel:[0,1,1] op_sel_hi:[1,1,1]
v_pk_fma_f32 v[230:231], v[230:231], v[22:23], v[22:23] op_sel:[0,1,1] op_sel_hi:[1,1,1]
v_pk_fma_f32 v[236:237], v[236:237], v[22:23], v[22:23] op_sel:[0,1,1] op_sel_hi:[1,1,1]
v_pk_fma_f32 v[238:239], v[238:239], v[22:23], v[22:23] op_sel:[0,1,1] op_sel_hi:[1,1,1]
v_cvt_pk_bf16_f32 v224, v240, v241
v_cvt_pk_bf16_f32 v225, v242, v243
v_cvt_pk_bf16_f32 v226, v248, v249
v_cvt_pk_bf16_f32 v227, v250, v251
v_rcp_f32 v228, v228
v_rcp_f32 v229, v229
v_rcp_f32 v230, v230
v_rcp_f32 v231, v231
v_rcp_f32 v236, v236
v_rcp_f32 v237, v237
v_rcp_f32 v238, v238
v_rcp_f32 v239, v239
v_pk_mul_f32 v[244:245], v[244:245], v[228:229]
buffer_store_dwordx4 v[224:227], v10, s[16:19], s65 offen sc1
v_pk_mul_f32 v[246:247], v[246:247], v[230:231]
v_pk_mul_f32 v[252:253], v[252:253], v[236:237]
v_pk_mul_f32 v[254:255], v[254:255], v[238:239]
v_cvt_pk_bf16_f32 v228, v244, v245
v_cvt_pk_bf16_f32 v229, v246, v247
v_cvt_pk_bf16_f32 v230, v252, v253
v_cvt_pk_bf16_f32 v231, v254, v255
buffer_store_dwordx4 v[228:231], v10, s[16:19], s65 offen offset:1024 sc1
buffer_load_dwordx4 v[120:123], v4, s[16:19], s52 offen sc1
buffer_load_dwordx4 v[124:127], v4, s[16:19], s52 offen offset:1024 sc1
v_mov_b32 v21, v68
v_mov_b32 v22, v69
v_mov_b32 v23, v70
v_mov_b32 v24, v71
v_mov_b32 v25, 0
s_waitcnt vmcnt(7) lgkmcnt(0)
s_barrier
v_mfma_f32_16x16x32_bf16 v[32:35], a[0:3], v[96:99], 0
ds_read_b64_tr_b16 a[32:33], v6
s_add_u32 s52, s78, 229376
MAV 32,16,104
buffer_load_dwordx4 v[128:131], v4, s[16:19], s52 offen sc1
v_mfma_f32_16x16x32_bf16 v[48:51], a[0:3], v[100:103], 0
TR 34,6,512
MAV 48,16,108
TR 36,6,32
TR 38,6,544
v_mfma_f32_16x16x32_bf16 v[52:55], a[4:7], v[100:103], 0
TR 48,6,8448
MAV 52,20,108
buffer_load_dwordx4 v[132:135], v4, s[16:19], s52 offen offset:1024 sc1
v_mfma_f32_16x16x32_bf16 v[36:39], a[4:7], v[96:99], 0
TR 50,6,8960
MAV 36,20,104
TR 52,6,8480
TR 54,6,8992
v_mfma_f32_16x16x32_bf16 v[40:43], a[8:11], v[96:99], 0
TR 40,6,64
s_add_u32 s52, s78, 294912
MAV 40,24,104
buffer_load_dwordx4 v[136:139], v4, s[16:19], s52 offen sc1
v_mfma_f32_16x16x32_bf16 v[56:59], a[8:11], v[100:103], 0
TR 42,6,576
MAV 56,24,108
TR 44,6,96
TR 46,6,608
v_mfma_f32_16x16x32_bf16 v[60:63], a[12:15], v[100:103], 0
TR 56,6,8512
MAV 60,28,108
buffer_load_dwordx4 v[140:143], v4, s[16:19], s52 offen offset:1024 sc1
v_mfma_f32_16x16x32_bf16 v[44:47], a[12:15], v[96:99], 0
TR 58,6,9024
MAV 44,28,104
TR 60,6,8544
TR 62,6,9056
s_waitcnt lgkmcnt(8)
v_mfma_f32_16x16x32_bf16 v[64:67], a[32:35], v[96:99], 0
TR 0,7,16896
s_add_u32 s52, s79, 344064
MAV 64,48,104
buffer_load_dwordx4 v[144:147], v4, s[16:19], s52 offen sc1
v_mfma_f32_16x16x32_bf16 v[80:83], a[32:35], v[100:103], 0
TR 2,7,17408
MAV 80,48,108
TR 4,7,16928
TR 6,7,17440
v_mfma_f32_16x16x32_bf16 v[84:87], a[36:39], v[100:103], 0
TR 16,7,25344
MAV 84,52,108
buffer_load_dwordx4 v[148:151], v4, s[16:19], s52 offen offset:1024 sc1
v_mfma_f32_16x16x32_bf16 v[68:71], a[36:39], v[96:99], 0
TR 18,7,25856
MAV 68,52,104
TR 20,7,25376
TR 22,7,25888
s_waitcnt lgkmcnt(8)
v_mfma_f32_16x16x32_bf16 v[72:75], a[40:43], v[96:99], 0
TR 8,7,16960
s_add_u32 s52, s79, 409600
MAV 72,56,104
buffer_load_dwordx4 v[152:155], v4, s[16:19], s52 offen sc1
v_mfma_f32_16x16x32_bf16 v[88:91], a[40:43], v[100:103], 0
TR 10,7,17472
MAV 88,56,108
TR 12,7,16992
TR 14,7,17504
v_mfma_f32_16x16x32_bf16 v[92:95], a[44:47], v[100:103], 0
TR 24,7,25408
MAV 92,60,108
buffer_load_dwordx4 v[156:159], v4, s[16:19], s52 offen offset:1024 sc1
v_mfma_f32_16x16x32_bf16 v[76:79], a[44:47], v[96:99], 0
TR 26,7,25920
MAV 76,60,104
TR 28,7,25440
TR 30,7,25952
s_waitcnt vmcnt(8) lgkmcnt(8)
s_barrier
MAV 32,0,112
TR 32,6,16896
s_add_u32 m0, s55, 0
MAV 32,16,120
buffer_load_dwordx4 v18, s[28:31], s54 offen lds
MAV 48,16,124
TR 34,6,17408
MAV 48,0,116
TR 36,6,16928
TR 38,6,17440
MAV 52,4,116
TR 48,6,25344
s_add_u32 s52, s76, 458752
MAV 52,20,124
buffer_load_dwordx4 v[96:99], v4, s[16:19], s52 offen sc1
MAV 36,20,120
TR 50,6,25856
MAV 36,4,112
TR 52,6,25376
TR 54,6,25888
s_waitcnt lgkmcnt(8)
MAV 40,8,112
TR 40,6,16960
MAV 40,24,120
buffer_load_dwordx4 v19, s[28:31], s54 offen offset:1056 lds
MAV 56,24,124
TR 42,6,17472
s_add_u32 s54, s98, 327680
MAV 56,8,116
TR 44,6,16992
TR 46,6,17504
MAV 60,12,116
TR 56,6,25408
MAV 60,28,124
buffer_load_dwordx4 v[100:103], v4, s[16:19], s52 offen offset:1024 sc1
MAV 44,28,120
TR 58,6,25920
MAV 44,12,112
TR 60,6,25440
TR 62,6,25952
s_waitcnt lgkmcnt(8)
MAV 64,32,112
TR 0,7,33792
s_add_u32 m0, s55, 8448
MAV 64,48,120
buffer_load_dwordx4 v18, s[28:31], s54 offen lds
MAV 80,48,124
TR 2,7,34304
MAV 80,32,116
TR 4,7,33824
TR 6,7,34336
MAV 84,36,116
TR 16,7,42240
s_add_u32 s52, s76, 524288
MAV 84,52,124
buffer_load_dwordx4 v[104:107], v4, s[16:19], s52 offen sc1
MAV 68,52,120
TR 18,7,42752
MAV 68,36,112
TR 20,7,42272
TR 22,7,42784
s_waitcnt lgkmcnt(8)
MAV 72,40,112
TR 8,7,33856
MAV 72,56,120
buffer_load_dwordx4 v19, s[28:31], s54 offen offset:1056 lds
MAV 88,56,124
TR 10,7,34368
s_add_u32 s54, s99, 524288
MAV 88,40,116
TR 12,7,33888
TR 14,7,34400
MAV 92,44,116
TR 24,7,42304
MAV 92,60,124
buffer_load_dwordx4 v[108:111], v4, s[16:19], s52 offen offset:1024 sc1
MAV 76,60,120
TR 26,7,42816
MAV 76,44,112
TR 28,7,42336
TR 30,7,42848
s_waitcnt vmcnt(12) lgkmcnt(8)
s_barrier
MAV 32,0,128
TR 32,6,33792
MAV 32,16,136
buffer_atomic_add v24, v21, s[16:19], s72 offen
MAV 48,16,140
TR 34,6,34304
MAV 48,0,132
TR 36,6,33824
TR 38,6,34336
TR 48,6,42240
MAV 52,4,132
TR 50,6,42752
s_add_u32 m0, s55, 16896
MAV 52,20,140
buffer_load_dwordx4 v18, s[28:31], s54 offen lds
MAV 36,20,136
TR 52,6,42272
MAV 36,4,128
TR 54,6,42784
TR 40,6,33856
s_waitcnt lgkmcnt(9)
MAV 40,8,128
TR 42,6,34368
s_add_u32 s52, s77, 573440
MAV 40,24,136
buffer_load_dwordx4 v[112:115], v4, s[16:19], s52 offen sc1
MAV 56,24,140
TR 44,6,33888
MAV 56,8,132
buffer_load_dwordx4 v19, s[28:31], s54 offen offset:1056 lds
MAV 60,12,132
TR 46,6,34400
s_add_u32 s54, s99, 786432
MAV 60,28,140
buffer_load_dwordx4 v[116:119], v4, s[16:19], s52 offen offset:1024 sc1
MAV 44,28,136
TR 56,6,42304
MAV 44,12,128
TR 58,6,42816
TR 60,6,42336
TR 62,6,42848
s_waitcnt lgkmcnt(8)
MAV 64,32,128
TR 0,7,50688
s_add_u32 m0, s55, 25344
MAV 64,48,136
buffer_load_dwordx4 v18, s[28:31], s54 offen lds
MAV 80,48,140
TR 2,7,51200
MAV 80,32,132
TR 4,7,50720
TR 6,7,51232
MAV 84,36,132
TR 16,7,59136
s_add_u32 s52, s77, 638976
MAV 84,52,140
buffer_load_dwordx4 v[120:123], v4, s[16:19], s52 offen sc1
MAV 68,52,136
TR 18,7,59648
MAV 68,36,128
TR 20,7,59168
TR 22,7,59680
s_waitcnt lgkmcnt(8)
MAV 72,40,128
TR 8,7,50752
MAV 72,56,136
buffer_load_dwordx4 v19, s[28:31], s54 offen offset:1056 lds
MAV 88,56,140
TR 10,7,51264
s_add_u32 s54, s100, 983040
MAV 88,40,132
TR 12,7,50784
TR 14,7,51296
MAV 92,44,132
TR 24,7,59200
MAV 92,60,140
buffer_load_dwordx4 v[124:127], v4, s[16:19], s52 offen offset:1024 sc1
MAV 76,60,136
TR 26,7,59712
MAV 76,44,128
TR 28,7,59232
TR 30,7,59744
s_waitcnt vmcnt(17) lgkmcnt(8)
s_barrier
MAV 32,0,144
TR 32,6,50688
s_add_u32 m0, s55, 33792
MAV 32,16,152
buffer_load_dwordx4 v18, s[28:31], s54 offen lds
MAV 48,16,156
TR 34,6,51200
MAV 48,0,148
TR 36,6,50720
TR 38,6,51232
MAV 52,4,148
TR 48,6,59136
s_add_u32 s52, s78, 688128
MAV 52,20,156
buffer_load_dwordx4 v[128:131], v4, s[16:19], s52 offen sc1
MAV 36,20,152
TR 50,6,59648
MAV 36,4,144
TR 52,6,59168
TR 54,6,59680
s_waitcnt lgkmcnt(8)
MAV 40,8,144
TR 40,6,50752
MAV 40,24,152
buffer_load_dwordx4 v19, s[28:31], s54 offen offset:1056 lds
MAV 56,24,156
TR 42,6,51264
s_add_u32 s54, s100, 1245184
MAV 56,8,148
TR 44,6,50784
TR 46,6,51296
MAV 60,12,148
TR 56,6,59200
MAV 60,28,156
buffer_load_dwordx4 v[132:135], v4, s[16:19], s52 offen offset:1024 sc1
MAV 44,28,152
TR 58,6,59712
MAV 44,12,144
TR 60,6,59232
TR 62,6,59744
v_add_u32 v7, s57, v7
v_add_u32 v6, s57, v6
s_sub_u32 s57, 0, s57
s_waitcnt lgkmcnt(8)
MAV 64,32,144
ds_read_b64_tr_b16 a[0:1], v7
s_add_u32 m0, s55, 42240
MAV 64,48,152
buffer_load_dwordx4 v18, s[28:31], s54 offen lds
MAV 80,48,156
TR 2,7,512
MAV 80,32,148
TR 4,7,32
TR 6,7,544
TR 16,7,8448
MAV 84,36,148
TR 18,7,8960
s_add_u32 s52, s78, 753664
MAV 84,52,156
buffer_load_dwordx4 v[136:139], v4, s[16:19], s52 offen sc1
MAV 68,52,152
TR 20,7,8480
MAV 68,36,144
TR 22,7,8992
TR 8,7,64
s_waitcnt lgkmcnt(9)
MAV 72,40,144
TR 10,7,576
MAV 72,56,152
buffer_load_dwordx4 v19, s[28:31], s54 offen offset:1056 lds
MAV 88,56,156
TR 12,7,96
s_add_u32 s54, s101, 1441792
MAV 88,40,148
buffer_load_dwordx4 v[140:143], v4, s[16:19], s52 offen offset:1024 sc1
MAV 92,44,148
TR 14,7,608
MAV 92,60,156
buffer_atomic_add v25, v22, s[16:19], s73 offen sc0
MAV 76,60,152
TR 24,7,8512
MAV 76,44,144
TR 26,7,9024
TR 28,7,8544
TR 30,7,9056
s_waitcnt vmcnt(18) lgkmcnt(8)
s_barrier
MAV 32,0,96
ds_read_b64_tr_b16 a[32:33], v6
s_add_u32 m0, s55, 50688
MAV 32,16,104
buffer_load_dwordx4 v18, s[28:31], s54 offen lds
MAV 48,16,108
TR 34,6,512
MAV 48,0,100
TR 36,6,32
TR 38,6,544
MAV 52,4,100
TR 48,6,8448
s_add_u32 s52, s79, 802816
MAV 52,20,108
buffer_load_dwordx4 v[144:147], v4, s[16:19], s52 offen sc1
MAV 36,20,104
TR 50,6,8960
MAV 36,4,96
TR 52,6,8480
TR 54,6,8992
s_waitcnt lgkmcnt(8)
MAV 40,8,96
TR 40,6,64
MAV 40,24,104
buffer_load_dwordx4 v19, s[28:31], s54 offen offset:1056 lds
MAV 56,24,108
TR 42,6,576
s_add_u32 s54, s101, 1703936
MAV 56,8,100
TR 44,6,96
TR 46,6,608
MAV 60,12,100
TR 56,6,8512
MAV 60,28,108
buffer_load_dwordx4 v[148:151], v4, s[16:19], s52 offen offset:1024 sc1
MAV 44,28,104
TR 58,6,9024
MAV 44,12,96
TR 60,6,8544
TR 62,6,9056
s_waitcnt lgkmcnt(8)
MAV 64,32,96
TR 0,7,16896
s_add_u32 m0, s55, 59136
MAV 64,48,104
buffer_load_dwordx4 v18, s[28:31], s54 offen lds
MAV 80,48,108
TR 2,7,17408
MAV 80,32,100
TR 4,7,16928
TR 6,7,17440
MAV 84,36,100
TR 16,7,25344
s_add_u32 s52, s79, 868352
MAV 84,52,108
buffer_load_dwordx4 v[152:155], v4, s[16:19], s52 offen sc1
MAV 68,52,104
TR 18,7,25856
MAV 68,36,96
TR 20,7,25376
TR 22,7,25888
s_waitcnt lgkmcnt(8)
MAV 72,40,96
TR 8,7,16960
MAV 72,56,104
buffer_load_dwordx4 v19, s[28:31], s54 offen offset:1056 lds
MAV 88,56,108
TR 10,7,17472
s_add_u32 s54, s98, 1900544
MAV 88,40,100
TR 12,7,16992
TR 14,7,17504
MAV 92,44,100
TR 24,7,25408
MAV 92,60,108
buffer_load_dwordx4 v[156:159], v4, s[16:19], s52 offen offset:1024 sc1
MAV 76,60,104
TR 26,7,25920
MAV 76,44,96
TR 28,7,25440
TR 30,7,25952
s_waitcnt vmcnt(8)
v_cmp_gt_u32 vcc, v23, v25
s_nop 0
s_cbranch_vccnz .Lsp67
.Lsp67b:
s_waitcnt lgkmcnt(8)
s_barrier
MAV 32,0,112
TR 32,6,16896
s_add_u32 m0, s55, 67584
MAV 32,16,120
buffer_load_dwordx4 v18, s[28:31], s54 offen lds
MAV 48,16,124
TR 34,6,17408
MAV 48,0,116
TR 36,6,16928
TR 38,6,17440
MAV 52,4,116
TR 48,6,25344
s_add_u32 s52, s76, 16384
MAV 52,20,124
buffer_load_dwordx4 v[96:99], v4, s[16:19], s52 offen sc1
MAV 36,20,120
TR 50,6,25856
MAV 36,4,112
TR 52,6,25376
TR 54,6,25888
s_waitcnt lgkmcnt(8)
MAV 40,8,112
TR 40,6,16960
MAV 40,24,120
buffer_load_dwordx4 v19, s[28:31], s54 offen offset:1056 lds
MAV 56,24,124
TR 42,6,17472
s_add_u32 s54, s98, 2162688
MAV 56,8,116
TR 44,6,16992
TR 46,6,17504
MAV 60,12,116
TR 56,6,25408
MAV 60,28,124
buffer_load_dwordx4 v[100:103], v4, s[16:19], s52 offen offset:1024 sc1
MAV 44,28,120
TR 58,6,25920
MAV 44,12,112
TR 60,6,25440
TR 62,6,25952
s_waitcnt lgkmcnt(8)
MAV 64,32,112
TR 0,7,33792
s_add_u32 m0, s55, 76032
MAV 64,48,120
buffer_load_dwordx4 v18, s[28:31], s54 offen lds
MAV 80,48,124
TR 2,7,34304
MAV 80,32,116
TR 4,7,33824
TR 6,7,34336
MAV 84,36,116
TR 16,7,42240
s_add_u32 s52, s76, 81920
MAV 84,52,124
buffer_load_dwordx4 v[104:107], v4, s[16:19], s52 offen sc1
MAV 68,52,120
TR 18,7,42752
MAV 68,36,112
TR 20,7,42272
TR 22,7,42784
s_waitcnt lgkmcnt(8)
MAV 72,40,112
TR 8,7,33856
MAV 72,56,120
buffer_load_dwordx4 v19, s[28:31], s54 offen offset:1056 lds
MAV 88,56,124
TR 10,7,34368
s_add_u32 s54, s99, 2359296
MAV 88,40,116
TR 12,7,33888
TR 14,7,34400
MAV 92,44,116
TR 24,7,42304
MAV 92,60,124
buffer_load_dwordx4 v[108:111], v4, s[16:19], s52 offen offset:1024 sc1
MAV 76,60,120
TR 26,7,42816
MAV 76,44,112
TR 28,7,42336
.Lpad37:
s_cbranch_execz .Lpad40
TR 30,7,42848
s_waitcnt lgkmcnt(8)
s_barrier
MAV 32,0,128
TR 32,6,33792
s_add_u32 m0, s55, 84480
MAV 32,16,136
buffer_load_dwordx4 v18, s[28:31], s54 offen lds
MAV 48,16,140
TR 34,6,34304
MAV 48,0,132
TR 36,6,33824
TR 38,6,34336
MAV 52,4,132
TR 48,6,42240
s_add_u32 s52, s77, 131072
MAV 52,20,140
buffer_load_dwordx4 v[112:115], v4, s[16:19], s52 offen sc1
MAV 36,20,136
TR 50,6,42752
MAV 36,4,128
TR 52,6,42272
TR 54,6,42784
s_waitcnt lgkmcnt(8)
MAV 40,8,128
TR 40,6,33856
MAV 40,24,136
buffer_load_dwordx4 v19, s[28:31], s54 offen offset:1056 lds
MAV 56,24,140
TR 42,6,34368
s_add_u32 s54, s99, 2621440
MAV 56,8,132
TR 44,6,33888
TR 46,6,34400
MAV 60,12,132
TR 56,6,42304
MAV 60,28,140
buffer_load_dwordx4 v[116:119], v4, s[16:19], s52 offen offset:1024 sc1
MAV 44,28,136
TR 58,6,42816
MAV 44,12,128
TR 60,6,42336
TR 62,6,42848
s_waitcnt lgkmcnt(8)
MAV 64,32,128
TR 0,7,50688
s_add_u32 m0, s55, 92928
MAV 64,48,136
buffer_load_dwordx4 v18, s[28:31], s54 offen lds
MAV 80,48,140
TR 2,7,51200
MAV 80,32,132
TR 4,7,50720
TR 6,7,51232
MAV 84,36,132
TR 16,7,59136
s_add_u32 s52, s77, 196608
MAV 84,52,140
buffer_load_dwordx4 v[120:123], v4, s[16:19], s52 offen sc1
MAV 68,52,136
TR 18,7,59648
MAV 68,36,128
TR 20,7,59168
TR 22,7,59680
s_waitcnt lgkmcnt(8)
MAV 72,40,128
TR 8,7,50752
MAV 72,56,136
buffer_load_dwordx4 v19, s[28:31], s54 offen offset:1056 lds
MAV 88,56,140
TR 10,7,51264
s_add_u32 s54, s100, 2818048
MAV 88,40,132
TR 12,7,50784
TR 14,7,51296
MAV 92,44,132
TR 24,7,59200
MAV 92,60,140
buffer_load_dwordx4 v[124:127], v4, s[16:19], s52 offen offset:1024 sc1
MAV 76,60,136
TR 26,7,59712
MAV 76,44,128
TR 28,7,59232
TR 30,7,59744
s_waitcnt vmcnt(16) lgkmcnt(8)
s_barrier
MAV 32,0,144
TR 32,6,50688
s_add_u32 m0, s55, 101376
MAV 32,16,152
buffer_load_dwordx4 v18, s[28:31], s54 offen lds
MAV 48,16,156
TR 34,6,51200
MAV 48,0,148
TR 36,6,50720
TR 38,6,51232
MAV 52,4,148
TR 48,6,59136
s_add_u32 s52, s78, 245760
MAV 52,20,156
buffer_load_dwordx4 v[128:131], v4, s[16:19], s52 offen sc1
MAV 36,20,152
TR 50,6,59648
MAV 36,4,144
TR 52,6,59168
TR 54,6,59680
s_waitcnt lgkmcnt(8)
MAV 40,8,144
TR 40,6,50752
MAV 40,24,152
buffer_load_dwordx4 v19, s[28:31], s54 offen offset:1056 lds
MAV 56,24,156
TR 42,6,51264
s_add_u32 s54, s100, 3080192
MAV 56,8,148
TR 44,6,50784
TR 46,6,51296
MAV 60,12,148
TR 56,6,59200
MAV 60,28,156
buffer_load_dwordx4 v[132:135], v4, s[16:19], s52 offen offset:1024 sc1
MAV 44,28,152
TR 58,6,59712
MAV 44,12,144
TR 60,6,59232
TR 62,6,59744
v_add_u32 v7, s57, v7
v_add_u32 v6, s57, v6
s_sub_u32 s57, 0, s57
s_waitcnt lgkmcnt(8)
MAV 64,32,144
ds_read_b64_tr_b16 a[0:1], v7
s_add_u32 m0, s55, 109824
MAV 64,48,152
buffer_load_dwordx4 v18, s[28:31], s54 offen lds
MAV 80,48,156
TR 2,7,512
MAV 80,32,148
TR 4,7,32
TR 6,7,544
MAV 84,36,148
TR 16,7,8448
s_add_u32 s52, s78, 311296
MAV 84,52,156
buffer_load_dwordx4 v[136:139], v4, s[16:19], s52 offen sc1
MAV 68,52,152
TR 18,7,8960
MAV 68,36,144
TR 20,7,8480
TR 22,7,8992
s_waitcnt lgkmcnt(8)
MAV 72,40,144
TR 8,7,64
MAV 72,56,152
buffer_load_dwordx4 v19, s[28:31], s54 offen offset:1056 lds
MAV 88,56,156
TR 10,7,576
s_add_u32 s54, s101, 3276800
MAV 88,40,148
TR 12,7,96
TR 14,7,608
MAV 92,44,148
TR 24,7,8512
MAV 92,60,156
buffer_load_dwordx4 v[140:143], v4, s[16:19], s52 offen offset:1024 sc1
MAV 76,60,152
TR 26,7,9024
MAV 76,44,144
TR 28,7,8544
TR 30,7,9056
s_waitcnt vmcnt(16) lgkmcnt(8)
s_barrier
MAV 32,0,96
ds_read_b64_tr_b16 a[32:33], v6
s_add_u32 m0, s55, 118272
MAV 32,16,104
buffer_load_dwordx4 v18, s[28:31], s54 offen lds
MAV 48,16,108
TR 34,6,512
MAV 48,0,100
TR 36,6,32
TR 38,6,544
MAV 52,4,100
TR 48,6,8448
s_add_u32 s52, s79, 360448
MAV 52,20,108
buffer_load_dwordx4 v[144:147], v4, s[16:19], s52 offen sc1
MAV 36,20,104
TR 50,6,8960
MAV 36,4,96
TR 52,6,8480
TR 54,6,8992
s_waitcnt lgkmcnt(8)
MAV 40,8,96
TR 40,6,64
MAV 40,24,104
buffer_load_dwordx4 v19, s[28:31], s54 offen offset:1056 lds
MAV 56,24,108
TR 42,6,576
s_add_u32 s54, s101, 3538944
MAV 56,8,100
TR 44,6,96
TR 46,6,608
MAV 60,12,100
TR 56,6,8512
MAV 60,28,108
buffer_load_dwordx4 v[148:151], v4, s[16:19], s52 offen offset:1024 sc1
MAV 44,28,104
TR 58,6,9024
MAV 44,12,96
TR 60,6,8544
TR 62,6,9056
s_waitcnt lgkmcnt(8)
MAV 64,32,96
TR 0,7,16896
s_add_u32 m0, s55, 126720
MAV 64,48,104
buffer_load_dwordx4 v18, s[28:31], s54 offen lds
MAV 80,48,108
TR 2,7,17408
MAV 80,32,100
TR 4,7,16928
TR 6,7,17440
MAV 84,36,100
TR 16,7,25344
s_add_u32 s52, s79, 425984
MAV 84,52,108
buffer_load_dwordx4 v[152:155], v4, s[16:19], s52 offen sc1
MAV 68,52,104
TR 18,7,25856
MAV 68,36,96
TR 20,7,25376
TR 22,7,25888
s_waitcnt lgkmcnt(8)
MAV 72,40,96
TR 8,7,16960
MAV 72,56,104
buffer_load_dwordx4 v19, s[28:31], s54 offen offset:1056 lds
MAV 88,56,108
TR 10,7,17472
s_add_u32 s54, s98, 131072
MAV 88,40,100
TR 12,7,16992
TR 14,7,17504
MAV 92,44,100
TR 24,7,25408
MAV 92,60,108
buffer_load_dwordx4 v[156:159], v4, s[16:19], s52 offen offset:1024 sc1
MAV 76,60,104
TR 26,7,25920
MAV 76,44,96
TR 28,7,25440
TR 30,7,25952
s_waitcnt vmcnt(16) lgkmcnt(8)
s_barrier
MAV 32,0,112
TR 32,6,16896
s_add_u32 m0, s55, 0
MAV 32,16,120
buffer_load_dwordx4 v18, s[28:31], s54 offen lds
MAV 48,16,124
TR 34,6,17408
MAV 48,0,116
TR 36,6,16928
TR 38,6,17440
MAV 52,4,116
TR 48,6,25344
s_add_u32 s52, s76, 475136
MAV 52,20,124
buffer_load_dwordx4 v[96:99], v4, s[16:19], s52 offen sc1
MAV 36,20,120
TR 50,6,25856
MAV 36,4,112
TR 52,6,25376
TR 54,6,25888
s_waitcnt lgkmcnt(8)
MAV 40,8,112
TR 40,6,16960
MAV 40,24,120
buffer_load_dwordx4 v19, s[28:31], s54 offen offset:1056 lds
MAV 56,24,124
TR 42,6,17472
s_add_u32 s54, s98, 393216
MAV 56,8,116
TR 44,6,16992
TR 46,6,17504
MAV 60,12,116
TR 56,6,25408
MAV 60,28,124
buffer_load_dwordx4 v[100:103], v4, s[16:19], s52 offen offset:1024 sc1
MAV 44,28,120
TR 58,6,25920
MAV 44,12,112
TR 60,6,25440
TR 62,6,25952
s_waitcnt lgkmcnt(8)
MAV 64,32,112
TR 0,7,33792
s_add_u32 m0, s55, 8448
MAV 64,48,120
buffer_load_dwordx4 v18, s[28:31], s54 offen lds
MAV 80,48,124
TR 2,7,34304
MAV 80,32,116
TR 4,7,33824
TR 6,7,34336
MAV 84,36,116
TR 16,7,42240
s_add_u32 s52, s76, 540672
MAV 84,52,124
buffer_load_dwordx4 v[104:107], v4, s[16:19], s52 offen sc1
MAV 68,52,120
TR 18,7,42752
MAV 68,36,112
TR 20,7,42272
TR 22,7,42784
s_waitcnt lgkmcnt(8)
MAV 72,40,112
TR 8,7,33856
MAV 72,56,120
buffer_load_dwordx4 v19, s[28:31], s54 offen offset:1056 lds
MAV 88,56,124
TR 10,7,34368
s_add_u32 s54, s99, 589824
MAV 88,40,116
TR 12,7,33888
TR 14,7,34400
MAV 92,44,116
TR 24,7,42304
MAV 92,60,124
buffer_load_dwordx4 v[108:111], v4, s[16:19], s52 offen offset:1024 sc1
MAV 76,60,120
TR 26,7,42816
MAV 76,44,112
TR 28,7,42336
TR 30,7,42848
s_waitcnt vmcnt(16) lgkmcnt(8)
s_barrier
MAV 32,0,128
TR 32,6,33792
s_add_u32 m0, s55, 16896
MAV 32,16,136
buffer_load_dwordx4 v18, s[28:31], s54 offen lds
MAV 48,16,140
TR 34,6,34304
MAV 48,0,132
TR 36,6,33824
TR 38,6,34336
MAV 52,4,132
TR 48,6,42240
s_add_u32 s52, s77, 589824
MAV 52,20,140
buffer_load_dwordx4 v[112:115], v4, s[16:19], s52 offen sc1
MAV 36,20,136
TR 50,6,42752
MAV 36,4,128
TR 52,6,42272
TR 54,6,42784
s_waitcnt lgkmcnt(8)
MAV 40,8,128
TR 40,6,33856
MAV 40,24,136
buffer_load_dwordx4 v19, s[28:31], s54 offen offset:1056 lds
MAV 56,24,140
TR 42,6,34368
s_add_u32 s54, s99, 851968
MAV 56,8,132
TR 44,6,33888
TR 46,6,34400
MAV 60,12,132
TR 56,6,42304
MAV 60,28,140
buffer_load_dwordx4 v[116:119], v4, s[16:19], s52 offen offset:1024 sc1
MAV 44,28,136
TR 58,6,42816
MAV 44,12,128
TR 60,6,42336
TR 62,6,42848
s_waitcnt lgkmcnt(8)
MAV 64,32,128
TR 0,7,50688
s_add_u32 m0, s55, 25344
MAV 64,48,136
buffer_load_dwordx4 v18, s[28:31], s54 offen lds
MAV 80,48,140
TR 2,7,51200
MAV 80,32,132
TR 4,7,50720
TR 6,7,51232
MAV 84,36,132
TR 16,7,59136
s_add_u32 s52, s77, 655360
MAV 84,52,140
buffer_load_dwordx4 v[120:123], v4, s[16:19], s52 offen sc1
MAV 68,52,136
TR 18,7,59648
MAV 68,36,128
TR 20,7,59168
TR 22,7,59680
s_waitcnt lgkmcnt(8)
MAV 72,40,128
TR 8,7,50752
MAV 72,56,136
buffer_load_dwordx4 v19, s[28:31], s54 offen offset:1056 lds
MAV 88,56,140
TR 10,7,51264
s_add_u32 s54, s100, 1048576
MAV 88,40,132
TR 12,7,50784
TR 14,7,51296
MAV 92,44,132
TR 24,7,59200
MAV 92,60,140
buffer_load_dwordx4 v[124:127], v4, s[16:19], s52 offen offset:1024 sc1
MAV 76,60,136
TR 26,7,59712
MAV 76,44,128
TR 28,7,59232
TR 30,7,59744
s_waitcnt vmcnt(16) lgkmcnt(8)
s_barrier
MAV 32,0,144
TR 32,6,50688
s_add_u32 m0, s55, 33792
MAV 32,16,152
buffer_load_dwordx4 v18, s[28:31], s54 offen lds
MAV 48,16,156
TR 34,6,51200
MAV 48,0,148
TR 36,6,50720
TR 38,6,51232
MAV 52,4,148
TR 48,6,59136
s_add_u32 s52, s78, 704512
MAV 52,20,156
buffer_load_dwordx4 v[128:131], v4, s[16:19], s52 offen sc1
MAV 36,20,152
TR 50,6,59648
MAV 36,4,144
TR 52,6,59168
TR 54,6,59680
s_waitcnt lgkmcnt(8)
MAV 40,8,144
TR 40,6,50752
MAV 40,24,152
buffer_load_dwordx4 v19, s[28:31], s54 offen offset:1056 lds
MAV 56,24,156
TR 42,6,51264
s_add_u32 s54, s100, 1310720
MAV 56,8,148
TR 44,6,50784
TR 46,6,51296
MAV 60,12,148
TR 56,6,59200
MAV 60,28,156
buffer_load_dwordx4 v[132:135], v4, s[16:19], s52 offen offset:1024 sc1
MAV 44,28,152
TR 58,6,59712
MAV 44,12,144
TR 60,6,59232
TR 62,6,59744
v_add_u32 v7, s57, v7
v_add_u32 v6, s57, v6
s_sub_u32 s57, 0, s57
s_waitcnt lgkmcnt(8)
MAV 64,32,144
ds_read_b64_tr_b16 a[0:1], v7
s_add_u32 m0, s55, 42240
MAV 64,48,152
buffer_load_dwordx4 v18, s[28:31], s54 offen lds
MAV 80,48,156
TR 2,7,512
MAV 80,32,148
TR 4,7,32
TR 6,7,544
MAV 84,36,148
TR 16,7,8448
s_add_u32 s52, s78, 770048
MAV 84,52,156
buffer_load_dwordx4 v[136:139], v4, s[16:19], s52 offen sc1
MAV 68,52,152
TR 18,7,8960
MAV 68,36,144
TR 20,7,8480
TR 22,7,8992
s_waitcnt lgkmcnt(8)
MAV 72,40,144
TR 8,7,64
MAV 72,56,152
buffer_load_dwordx4 v19, s[28:31], s54 offen offset:1056 lds
MAV 88,56,156
TR 10,7,576
s_add_u32 s54, s101, 1507328
MAV 88,40,148
TR 12,7,96
TR 14,7,608
MAV 92,44,148
TR 24,7,8512
MAV 92,60,156
buffer_load_dwordx4 v[140:143], v4, s[16:19], s52 offen offset:1024 sc1
MAV 76,60,152
TR 26,7,9024
MAV 76,44,144
TR 28,7,8544
TR 30,7,9056
s_waitcnt vmcnt(16) lgkmcnt(8)
s_barrier
MAV 32,0,96
ds_read_b64_tr_b16 a[32:33], v6
s_add_u32 m0, s55, 50688
MAV 32,16,104
buffer_load_dwordx4 v18, s[28:31], s54 offen lds
MAV 48,16,108
TR 34,6,512
MAV 48,0,100
TR 36,6,32
TR 38,6,544
MAV 52,4,100
TR 48,6,8448
s_add_u32 s52, s79, 819200
MAV 52,20,108
buffer_load_dwordx4 v[144:147], v4, s[16:19], s52 offen sc1
MAV 36,20,104
TR 50,6,8960
MAV 36,4,96
TR 52,6,8480
TR 54,6,8992
s_waitcnt lgkmcnt(8)
MAV 40,8,96
TR 40,6,64
MAV 40,24,104
buffer_load_dwordx4 v19, s[28:31], s54 offen offset:1056 lds
.Lpad38:
s_cbranch_execz .Lnopoll63r
MAV 56,24,108
TR 42,6,576
s_add_u32 s54, s101, 1769472
MAV 56,8,100
TR 44,6,96
TR 46,6,608
MAV 60,12,100
TR 56,6,8512
MAV 60,28,108
buffer_load_dwordx4 v[148:151], v4, s[16:19], s52 offen offset:1024 sc1
MAV 44,28,104
TR 58,6,9024
MAV 44,12,96
TR 60,6,8544
TR 62,6,9056
s_waitcnt lgkmcnt(8)
MAV 64,32,96
TR 0,7,16896
s_add_u32 m0, s55, 59136
MAV 64,48,104
buffer_load_dwordx4 v18, s[28:31], s54 offen lds
MAV 80,48,108
TR 2,7,17408
MAV 80,32,100
TR 4,7,16928
TR 6,7,17440
MAV 84,36,100
TR 16,7,25344
s_add_u32 s52, s79, 884736
MAV 84,52,108
buffer_load_dwordx4 v[152:155], v4, s[16:19], s52 offen sc1
MAV 68,52,104
TR 18,7,25856
MAV 68,36,96
TR 20,7,25376
TR 22,7,25888
s_waitcnt lgkmcnt(8)
MAV 72,40,96
TR 8,7,16960
MAV 72,56,104
buffer_load_dwordx4 v19, s[28:31], s54 offen offset:1056 lds
MAV 88,56,108
TR 10,7,17472
s_add_u32 s54, s98, 1966080
MAV 88,40,100
TR 12,7,16992
TR 14,7,17504
MAV 92,44,100
TR 24,7,25408
MAV 92,60,108
buffer_load_dwordx4 v[156:159], v4, s[16:19], s52 offen offset:1024 sc1
MAV 76,60,104
TR 26,7,25920
MAV 76,44,96
TR 28,7,25440
TR 30,7,25952
s_waitcnt vmcnt(16) lgkmcnt(8)
s_barrier
MAV 32,0,112
TR 32,6,16896
s_add_u32 m0, s55, 67584
MAV 32,16,120
buffer_load_dwordx4 v18, s[28:31], s54 offen lds
MAV 48,16,124
TR 34,6,17408
MAV 48,0,116
TR 36,6,16928
TR 38,6,17440
MAV 52,4,116
TR 48,6,25344
s_add_u32 s52, s76, 32768
MAV 52,20,124
buffer_load_dwordx4 v[96:99], v4, s[16:19], s52 offen sc1
MAV 36,20,120
TR 50,6,25856
MAV 36,4,112
TR 52,6,25376
TR 54,6,25888
s_waitcnt lgkmcnt(8)
MAV 40,8,112
TR 40,6,16960
MAV 40,24,120
buffer_load_dwordx4 v19, s[28:31], s54 offen offset:1056 lds
MAV 56,24,124
TR 42,6,17472
s_add_u32 s54, s98, 2228224
MAV 56,8,116
TR 44,6,16992
TR 46,6,17504
MAV 60,12,116
TR 56,6,25408
MAV 60,28,124
buffer_load_dwordx4 v[100:103], v4, s[16:19], s52 offen offset:1024 sc1
MAV 44,28,120
TR 58,6,25920
MAV 44,12,112
TR 60,6,25440
TR 62,6,25952
s_waitcnt lgkmcnt(8)
MAV 64,32,112
TR 0,7,33792
s_add_u32 m0, s55, 76032
MAV 64,48,120
buffer_load_dwordx4 v18, s[28:31], s54 offen lds
MAV 80,48,124
TR 2,7,34304
MAV 80,32,116
TR 4,7,33824
TR 6,7,34336
MAV 84,36,116
TR 16,7,42240
s_add_u32 s52, s76, 98304
MAV 84,52,124
buffer_load_dwordx4 v[104:107], v4, s[16:19], s52 offen sc1
MAV 68,52,120
TR 18,7,42752
MAV 68,36,112
TR 20,7,42272
TR 22,7,42784
s_waitcnt lgkmcnt(8)
MAV 72,40,112
TR 8,7,33856
MAV 72,56,120
buffer_load_dwordx4 v19, s[28:31], s54 offen offset:1056 lds
MAV 88,56,124
TR 10,7,34368
s_add_u32 s54, s99, 2424832
MAV 88,40,116
TR 12,7,33888
TR 14,7,34400
MAV 92,44,116
TR 24,7,42304
MAV 92,60,124
buffer_load_dwordx4 v[108:111], v4, s[16:19], s52 offen offset:1024 sc1
MAV 76,60,120
TR 26,7,42816
MAV 76,44,112
TR 28,7,42336
TR 30,7,42848
s_waitcnt vmcnt(16) lgkmcnt(8)
s_barrier
MAV 32,0,128
TR 32,6,33792
s_add_u32 m0, s55, 84480
MAV 32,16,136
buffer_load_dwordx4 v18, s[28:31], s54 offen lds
MAV 48,16,140
TR 34,6,34304
MAV 48,0,132
TR 36,6,33824
TR 38,6,34336
MAV 52,4,132
TR 48,6,42240
s_add_u32 s52, s77, 147456
MAV 52,20,140
buffer_load_dwordx4 v[112:115], v4, s[16:19], s52 offen sc1
MAV 36,20,136
TR 50,6,42752
MAV 36,4,128
TR 52,6,42272
TR 54,6,42784
s_waitcnt lgkmcnt(8)
MAV 40,8,128
TR 40,6,33856
MAV 40,24,136
buffer_load_dwordx4 v19, s[28:31], s54 offen offset:1056 lds
MAV 56,24,140
TR 42,6,34368
s_add_u32 s54, s99, 2686976
MAV 56,8,132
TR 44,6,33888
TR 46,6,34400
MAV 60,12,132
TR 56,6,42304
MAV 60,28,140
buffer_load_dwordx4 v[116:119], v4, s[16:19], s52 offen offset:1024 sc1
MAV 44,28,136
TR 58,6,42816
MAV 44,12,128
TR 60,6,42336
TR 62,6,42848
s_waitcnt lgkmcnt(8)
MAV 64,32,128
TR 0,7,50688
s_add_u32 m0, s55, 92928
MAV 64,48,136
buffer_load_dwordx4 v18, s[28:31], s54 offen lds
MAV 80,48,140
TR 2,7,51200
MAV 80,32,132
TR 4,7,50720
TR 6,7,51232
MAV 84,36,132
TR 16,7,59136
s_add_u32 s52, s77, 212992
MAV 84,52,140
buffer_load_dwordx4 v[120:123], v4, s[16:19], s52 offen sc1
MAV 68,52,136
TR 18,7,59648
MAV 68,36,128
TR 20,7,59168
TR 22,7,59680
s_waitcnt lgkmcnt(8)
MAV 72,40,128
TR 8,7,50752
MAV 72,56,136
buffer_load_dwordx4 v19, s[28:31], s54 offen offset:1056 lds
MAV 88,56,140
TR 10,7,51264
s_add_u32 s54, s100, 2883584
MAV 88,40,132
TR 12,7,50784
TR 14,7,51296
MAV 92,44,132
TR 24,7,59200
MAV 92,60,140
buffer_load_dwordx4 v[124:127], v4, s[16:19], s52 offen offset:1024 sc1
MAV 76,60,136
TR 26,7,59712
MAV 76,44,128
TR 28,7,59232
TR 30,7,59744
s_waitcnt vmcnt(16) lgkmcnt(8)
s_barrier
MAV 32,0,144
TR 32,6,50688
s_add_u32 m0, s55, 101376
MAV 32,16,152
buffer_load_dwordx4 v18, s[28:31], s54 offen lds
MAV 48,16,156
TR 34,6,51200
MAV 48,0,148
TR 36,6,50720
TR 38,6,51232
MAV 52,4,148
TR 48,6,59136
s_add_u32 s52, s78, 262144
MAV 52,20,156
buffer_load_dwordx4 v[128:131], v4, s[16:19], s52 offen sc1
MAV 36,20,152
TR 50,6,59648
MAV 36,4,144
TR 52,6,59168
TR 54,6,59680
s_waitcnt lgkmcnt(8)
MAV 40,8,144
TR 40,6,50752
MAV 40,24,152
buffer_load_dwordx4 v19, s[28:31], s54 offen offset:1056 lds
MAV 56,24,156
TR 42,6,51264
s_add_u32 s54, s100, 3145728
MAV 56,8,148
TR 44,6,50784
TR 46,6,51296
MAV 60,12,148
TR 56,6,59200
MAV 60,28,156
buffer_load_dwordx4 v[132:135], v4, s[16:19], s52 offen offset:1024 sc1
MAV 44,28,152
TR 58,6,59712
MAV 44,12,144
TR 60,6,59232
TR 62,6,59744
v_add_u32 v7, s57, v7
v_add_u32 v6, s57, v6
s_sub_u32 s57, 0, s57
s_waitcnt lgkmcnt(8)
MAV 64,32,144
ds_read_b64_tr_b16 a[0:1], v7
s_add_u32 m0, s55, 109824
MAV 64,48,152
buffer_load_dwordx4 v18, s[28:31], s54 offen lds
MAV 80,48,156
TR 2,7,512
MAV 80,32,148
TR 4,7,32
TR 6,7,544
MAV 84,36,148
TR 16,7,8448
s_add_u32 s52, s78, 327680
MAV 84,52,156
buffer_load_dwordx4 v[136:139], v4, s[16:19], s52 offen sc1
MAV 68,52,152
TR 18,7,8960
MAV 68,36,144
TR 20,7,8480
TR 22,7,8992
s_waitcnt lgkmcnt(8)
MAV 72,40,144
TR 8,7,64
MAV 72,56,152
buffer_load_dwordx4 v19, s[28:31], s54 offen offset:1056 lds
MAV 88,56,156
TR 10,7,576
s_add_u32 s54, s101, 3342336
MAV 88,40,148
TR 12,7,96
TR 14,7,608
MAV 92,44,148
TR 24,7,8512
MAV 92,60,156
buffer_load_dwordx4 v[140:143], v4, s[16:19], s52 offen offset:1024 sc1
MAV 76,60,152
TR 26,7,9024
MAV 76,44,144
TR 28,7,8544
TR 30,7,9056
s_waitcnt vmcnt(16) lgkmcnt(8)
s_barrier
MAV 32,0,96
ds_read_b64_tr_b16 a[32:33], v6
s_add_u32 m0, s55, 118272
MAV 32,16,104
buffer_load_dwordx4 v18, s[28:31], s54 offen lds
MAV 48,16,108
TR 34,6,512
MAV 48,0,100
TR 36,6,32
TR 38,6,544
MAV 52,4,100
TR 48,6,8448
s_add_u32 s52, s79, 376832
MAV 52,20,108
buffer_load_dwordx4 v[144:147], v4, s[16:19], s52 offen sc1
MAV 36,20,104
TR 50,6,8960
MAV 36,4,96
TR 52,6,8480
TR 54,6,8992
s_waitcnt lgkmcnt(8)
MAV 40,8,96
TR 40,6,64
MAV 40,24,104
buffer_load_dwordx4 v19, s[28:31], s54 offen offset:1056 lds
MAV 56,24,108
TR 42,6,576
s_add_u32 s54, s101, 3604480
MAV 56,8,100
TR 44,6,96
TR 46,6,608
MAV 60,12,100
TR 56,6,8512
MAV 60,28,108
buffer_load_dwordx4 v[148:151], v4, s[16:19], s52 offen offset:1024 sc1
MAV 44,28,104
TR 58,6,9024
MAV 44,12,96
TR 60,6,8544
TR 62,6,9056
s_waitcnt lgkmcnt(8)
MAV 64,32,96
TR 0,7,16896
s_add_u32 m0, s55, 126720
MAV 64,48,104
buffer_load_dwordx4 v18, s[28:31], s54 offen lds
MAV 80,48,108
TR 2,7,17408
MAV 80,32,100
TR 4,7,16928
TR 6,7,17440
MAV 84,36,100
TR 16,7,25344
s_add_u32 s52, s79, 442368
MAV 84,52,108
buffer_load_dwordx4 v[152:155], v4, s[16:19], s52 offen sc1
MAV 68,52,104
TR 18,7,25856
MAV 68,36,96
TR 20,7,25376
TR 22,7,25888
s_waitcnt lgkmcnt(8)
MAV 72,40,96
TR 8,7,16960
MAV 72,56,104
buffer_load_dwordx4 v19, s[28:31], s54 offen offset:1056 lds
MAV 88,56,108
TR 10,7,17472
s_add_u32 s54, s98, 196608
MAV 88,40,100
TR 12,7,16992
TR 14,7,17504
MAV 92,44,100
TR 24,7,25408
MAV 92,60,108
buffer_load_dwordx4 v[156:159], v4, s[16:19], s52 offen offset:1024 sc1
MAV 76,60,104
TR 26,7,25920
MAV 76,44,96
TR 28,7,25440
TR 30,7,25952
s_waitcnt vmcnt(16) lgkmcnt(8)
s_barrier
MAV 32,0,112
TR 32,6,16896
s_add_u32 m0, s55, 0
MAV 32,16,120
buffer_load_dwordx4 v18, s[28:31], s54 offen lds
MAV 48,16,124
TR 34,6,17408
MAV 48,0,116
TR 36,6,16928
TR 38,6,17440
MAV 52,4,116
TR 48,6,25344
s_add_u32 s52, s76, 491520
MAV 52,20,124
buffer_load_dwordx4 v[96:99], v4, s[16:19], s52 offen sc1
MAV 36,20,120
TR 50,6,25856
MAV 36,4,112
TR 52,6,25376
TR 54,6,25888
s_waitcnt lgkmcnt(8)
MAV 40,8,112
TR 40,6,16960
MAV 40,24,120
buffer_load_dwordx4 v19, s[28:31], s54 offen offset:1056 lds
MAV 56,24,124
TR 42,6,17472
s_add_u32 s54, s99, 655360
MAV 56,8,116
TR 44,6,16992
TR 46,6,17504
MAV 60,12,116
TR 56,6,25408
MAV 60,28,124
buffer_load_dwordx4 v[100:103], v4, s[16:19], s52 offen offset:1024 sc1
MAV 44,28,120
TR 58,6,25920
MAV 44,12,112
TR 60,6,25440
TR 62,6,25952
s_waitcnt lgkmcnt(8)
MAV 64,32,112
TR 0,7,33792
s_add_u32 m0, s55, 8448
MAV 64,48,120
buffer_load_dwordx4 v18, s[28:31], s54 offen lds
MAV 80,48,124
TR 2,7,34304
MAV 80,32,116
TR 4,7,33824
TR 6,7,34336
MAV 84,36,116
TR 16,7,42240
s_add_u32 s52, s76, 557056
MAV 84,52,124
buffer_load_dwordx4 v[104:107], v4, s[16:19], s52 offen sc1
MAV 68,52,120
TR 18,7,42752
MAV 68,36,112
TR 20,7,42272
TR 22,7,42784
s_waitcnt lgkmcnt(8)
MAV 72,40,112
TR 8,7,33856
MAV 72,56,120
buffer_load_dwordx4 v19, s[28:31], s54 offen offset:1056 lds
MAV 88,56,124
TR 10,7,34368
s_add_u32 s54, s100, 1114112
MAV 88,40,116
TR 12,7,33888
TR 14,7,34400
MAV 92,44,116
TR 24,7,42304
MAV 92,60,124
buffer_load_dwordx4 v[108:111], v4, s[16:19], s52 offen offset:1024 sc1
MAV 76,60,120
TR 26,7,42816
MAV 76,44,112
TR 28,7,42336
TR 30,7,42848
s_waitcnt vmcnt(16) lgkmcnt(8)
s_barrier
MAV 32,0,128
TR 32,6,33792
s_add_u32 m0, s55, 16896
MAV 32,16,136
buffer_load_dwordx4 v18, s[28:31], s54 offen lds
MAV 48,16,140
TR 34,6,34304
MAV 48,0,132
TR 36,6,33824
TR 38,6,34336
MAV 52,4,132
TR 48,6,42240
s_add_u32 s52, s77, 606208
MAV 52,20,140
buffer_load_dwordx4 v[112:115], v4, s[16:19], s52 offen sc1
MAV 36,20,136
TR 50,6,42752
MAV 36,4,128
TR 52,6,42272
TR 54,6,42784
s_waitcnt lgkmcnt(8)
MAV 40,8,128
TR 40,6,33856
MAV 40,24,136
buffer_load_dwordx4 v19, s[28:31], s54 offen offset:1056 lds
MAV 56,24,140
TR 42,6,34368
s_add_u32 s54, s101, 1572864
MAV 56,8,132
TR 44,6,33888
TR 46,6,34400
MAV 60,12,132
TR 56,6,42304
MAV 60,28,140
buffer_load_dwordx4 v[116:119], v4, s[16:19], s52 offen offset:1024 sc1
MAV 44,28,136
TR 58,6,42816
MAV 44,12,128
TR 60,6,42336
TR 62,6,42848
s_waitcnt lgkmcnt(8)
MAV 64,32,128
TR 0,7,50688
s_add_u32 m0, s55, 25344
MAV 64,48,136
buffer_load_dwordx4 v18, s[28:31], s54 offen lds
MAV 80,48,140
TR 2,7,51200
MAV 80,32,132
TR 4,7,50720
TR 6,7,51232
MAV 84,36,132
TR 16,7,59136
.Lpad39:
s_cbranch_execz .Lnopoll63r
s_add_u32 s52, s77, 671744
MAV 84,52,140
buffer_load_dwordx4 v[120:123], v4, s[16:19], s52 offen sc1
MAV 68,52,136
TR 18,7,59648
MAV 68,36,128
TR 20,7,59168
TR 22,7,59680
s_waitcnt lgkmcnt(8)
MAV 72,40,128
TR 8,7,50752
MAV 72,56,136
buffer_load_dwordx4 v19, s[28:31], s54 offen offset:1056 lds
MAV 88,56,140
TR 10,7,51264
s_add_u32 s54, s98, 2031616
MAV 88,40,132
TR 12,7,50784
TR 14,7,51296
MAV 92,44,132
TR 24,7,59200
MAV 92,60,140
buffer_load_dwordx4 v[124:127], v4, s[16:19], s52 offen offset:1024 sc1
MAV 76,60,136
TR 26,7,59712
MAV 76,44,128
TR 28,7,59232
TR 30,7,59744
s_waitcnt vmcnt(16) lgkmcnt(8)
s_barrier
MAV 32,0,144
TR 32,6,50688
s_add_u32 m0, s55, 33792
MAV 32,16,152
buffer_load_dwordx4 v18, s[28:31], s54 offen lds
MAV 48,16,156
TR 34,6,51200
MAV 48,0,148
TR 36,6,50720
TR 38,6,51232
MAV 52,4,148
TR 48,6,59136
s_add_u32 s52, s78, 720896
MAV 52,20,156
buffer_load_dwordx4 v[128:131], v4, s[16:19], s52 offen sc1
MAV 36,20,152
TR 50,6,59648
MAV 36,4,144
TR 52,6,59168
TR 54,6,59680
s_waitcnt lgkmcnt(8)
MAV 40,8,144
TR 40,6,50752
MAV 40,24,152
buffer_load_dwordx4 v19, s[28:31], s54 offen offset:1056 lds
MAV 56,24,156
TR 42,6,51264
s_add_u32 s54, s99, 2490368
MAV 56,8,148
TR 44,6,50784
TR 46,6,51296
MAV 60,12,148
TR 56,6,59200
MAV 60,28,156
buffer_load_dwordx4 v[132:135], v4, s[16:19], s52 offen offset:1024 sc1
MAV 44,28,152
TR 58,6,59712
MAV 44,12,144
TR 60,6,59232
TR 62,6,59744
v_add_u32 v7, s57, v7
v_add_u32 v6, s57, v6
s_sub_u32 s57, 0, s57
s_waitcnt lgkmcnt(8)
MAV 64,32,144
ds_read_b64_tr_b16 a[0:1], v6
s_add_u32 m0, s55, 42240
MAV 64,48,152
buffer_load_dwordx4 v18, s[28:31], s54 offen lds
MAV 80,48,156
TR 2,6,512
MAV 80,32,148
TR 4,6,32
TR 6,6,544
MAV 84,36,148
TR 16,6,8448
s_add_u32 s52, s78, 786432
MAV 84,52,156
buffer_load_dwordx4 v[136:139], v4, s[16:19], s52 offen sc1
MAV 68,52,152
TR 18,6,8960
MAV 68,36,144
TR 20,6,8480
TR 22,6,8992
s_waitcnt lgkmcnt(8)
MAV 72,40,144
TR 8,6,64
MAV 72,56,152
buffer_load_dwordx4 v19, s[28:31], s54 offen offset:1056 lds
MAV 88,56,156
TR 10,6,576
s_add_u32 s54, s100, 2949120
MAV 88,40,148
TR 12,6,96
TR 14,6,608
MAV 92,44,148
TR 24,6,8512
MAV 92,60,156
buffer_load_dwordx4 v[140:143], v4, s[16:19], s52 offen offset:1024 sc1
MAV 76,60,152
TR 26,6,9024
MAV 76,44,144
TR 28,6,8544
TR 30,6,9056
s_waitcnt vmcnt(16) lgkmcnt(8)
s_barrier
MAV 64,0,96
TR 32,6,16896
TR 34,6,17408
s_add_u32 m0, s55, 50688
MAV 64,16,104
TR 36,6,16928
buffer_load_dwordx4 v18, s[28:31], s54 offen lds
MAV 80,16,108
TR 38,6,17440
MAV 80,0,100
TR 48,6,25344
buffer_load_dwordx4 v19, s[28:31], s54 offen offset:1056 lds
MAV 84,4,100
TR 50,6,25856
s_add_u32 s54, s101, 3407872
s_add_u32 s52, s79, 835584
MAV 84,20,108
buffer_load_dwordx4 v[144:147], v4, s[16:19], s52 offen sc1
MAV 68,20,104
TR 52,6,25376
TR 54,6,25888
MAV 68,4,96
TR 40,6,16960
s_waitcnt lgkmcnt(9)
MAV 72,8,96
TR 42,6,17472
MAV 72,24,104
TR 44,6,16992
buffer_load_dwordx4 v[148:151], v4, s[16:19], s52 offen offset:1024 sc1
MAV 88,24,108
TR 46,6,17504
s_add_u32 m0, s55, 59136
MAV 88,8,100
TR 56,6,25408
buffer_load_dwordx4 v18, s[28:31], s54 offen lds
MAV 92,12,100
TR 58,6,25920
MAV 92,28,108
TR 60,6,25440
buffer_load_dwordx4 v19, s[28:31], s54 offen offset:1056 lds
MAV 76,28,104
TR 62,6,25952
s_add_u32 s52, s79, 901120
MAV 76,12,96
buffer_load_dwordx4 v[152:155], v4, s[16:19], s52 offen sc1
buffer_load_dwordx4 v[156:159], v4, s[16:19], s52 offen offset:1024 sc1
s_waitcnt vmcnt(16) lgkmcnt(8)
MAV 64,32,112
TR 0,6,33792
s_add_u32 s52, s76, 49152
s_lshl_b32 s70, s2, 10
s_lshl_b32 s62, s3, 7
MAV 64,48,120
buffer_load_dwordx4 v[160:163], v4, s[16:19], s52 offen sc1
s_add_u32 s70, s70, s62
MAV 80,48,124
TR 2,6,34304
s_add_u32 s70, s70, 31457280
MAV 80,32,116
TR 4,6,33824
TR 6,6,34336
s_xor_b32 s71, s70, 1024
MAV 84,36,116
TR 16,6,42240
v_min_u32 v26, 1, v1
MAV 84,52,124
buffer_load_dwordx4 v[164:167], v4, s[16:19], s52 offen offset:1024 sc1
v_lshlrev_b32 v26, 28, v26
MAV 68,52,120
TR 18,6,42752
v_mov_b32 v30, 1
MAV 68,36,112
TR 20,6,42272
TR 22,6,42784
v_mov_b32 v31, 0
s_waitcnt lgkmcnt(8)
MAV 72,40,112
TR 8,6,33856
s_add_u32 s52, s77, 163840
s_lshl_b32 s68, s7, 18
MAV 72,56,120
buffer_load_dwordx4 v[168:171], v4, s[16:19], s52 offen sc1
s_add_u32 s68, s68, 142606336
MAV 88,56,124
TR 10,6,34368
s_xor_b32 s69, s68, 262144
MAV 88,40,116
TR 12,6,33888
TR 14,6,34400
v_and_b32 v2, 1, v1
MAV 92,44,116
TR 24,6,42304
v_lshlrev_b32 v2, 4, v2
MAV 92,60,124
buffer_load_dwordx4 v[172:175], v4, s[16:19], s52 offen offset:1024 sc1
v_mov_b32 v224, 0x3f80
MAV 76,60,120
TR 26,6,42816
v_lshlrev_b32 v2, v2, v224
v_bfe_u32 v224, v1, 2, 2
MAV 76,44,112
TR 28,6,42336
TR 30,6,42848
s_waitcnt vmcnt(12) lgkmcnt(8)
MAV 64,0,128
TR 32,6,50688
s_add_u32 s52, s78, 278528
v_lshrrev_b32 v225, 4, v1
v_cmp_eq_u32 vcc, v224, v225
MAV 64,16,136
buffer_load_dwordx4 v[176:179], v4, s[16:19], s52 offen sc1
v_cndmask_b32 v2, 0, v2, vcc
MAV 80,16,140
TR 34,6,51200
v_and_b32 v224, 2, v1
MAV 80,0,132
TR 36,6,50720
TR 38,6,51232
v_cmp_eq_u32 vcc, 0, v224
MAV 84,4,132
TR 48,6,59136
v_cndmask_b32 v226, 0, v2, vcc
MAV 84,20,140
buffer_load_dwordx4 v[180:183], v4, s[16:19], s52 offen offset:1024 sc1
v_cndmask_b32 v227, v2, 0, vcc
MAV 68,20,136
TR 50,6,59648
v_mov_b32 v224, 0
MAV 68,4,128
TR 52,6,59168
TR 54,6,59680
v_mov_b32 v225, 0
s_waitcnt lgkmcnt(8)
MAV 72,8,128
TR 40,6,50752
s_add_u32 s52, s79, 393216
v_mov_b32 v228, 0
MAV 72,24,136
buffer_load_dwordx4 v[184:187], v4, s[16:19], s52 offen sc1
v_mov_b32 v229, 0
MAV 88,24,140
TR 42,6,51264
s_lshr_b32 s62, s6, 1
MAV 88,8,132
TR 44,6,50784
TR 46,6,51296
s_lshl_b32 s62, s62, 8
MAV 92,12,132
TR 56,6,59200
s_and_b32 s67, s6, 1
MAV 92,28,140
buffer_load_dwordx4 v[188:191], v4, s[16:19], s52 offen offset:1024 sc1
s_add_u32 s62, s62, s67
MAV 76,28,136
TR 58,6,59712
s_lshl_b32 s62, s62, 11
s_lshl_b32 s63, s3, 17
MAV 76,12,128
TR 60,6,59232
TR 62,6,59744
s_waitcnt vmcnt(8) lgkmcnt(8)
s_barrier
v_add_u32 v6, s57, v6
MAV 64,32,144
ds_read_b64_tr_b16 a[0:1], v6
s_add_u32 s52, s76, 507904
s_add_u32 s62, s62, s63
s_lshl_b32 s63, s7, 7
MAV 64,48,152
buffer_load_dwordx4 v[192:195], v4, s[16:19], s52 offen sc1
s_add_u32 s62, s62, s63
MAV 80,48,156
TR 2,6,512
s_mov_b32 s64, 0x8000
MAV 80,32,148
TR 4,6,32
TR 6,6,544
v_lshrrev_b32 v21, 3, v1
MAV 84,36,148
TR 16,6,8448
v_and_b32 v2, 7, v1
MAV 84,52,156
buffer_load_dwordx4 v[196:199], v4, s[16:19], s52 offen offset:1024 sc1
v_lshlrev_b32 v2, 4, v2
MAV 68,52,152
TR 18,6,8960
v_lshl_add_u32 v16, v21, 12, v2
MAV 68,36,144
TR 20,6,8480
TR 22,6,8992
v_add_u32 v16, s62, v16
s_waitcnt lgkmcnt(8)
MAV 72,40,144
TR 8,6,64
s_add_u32 s52, s77, 622592
v_add_u32 v17, 0x10000, v16
MAV 72,56,152
buffer_load_dwordx4 v[200:203], v4, s[16:19], s52 offen sc1
s_mul_i32 s62, s3, 4608
MAV 88,56,156
TR 10,6,576
s_add_u32 s62, s62, 135168
MAV 88,40,148
TR 12,6,96
TR 14,6,608
v_mul_u32_u24 v21, 144, v21
MAV 92,44,148
TR 24,6,8512
v_add3_u32 v21, v21, v2, s62
MAV 92,60,156
buffer_load_dwordx4 v[204:207], v4, s[16:19], s52 offen offset:1024 sc1
v_and_b32 v20, 15, v1
MAV 76,60,152
TR 26,6,9024
v_mul_u32_u24 v20, 144, v20
v_lshrrev_b32 v2, 4, v1
MAV 76,44,144
TR 28,6,8544
TR 30,6,9056
s_waitcnt vmcnt(8) lgkmcnt(8)
MAV 64,0,160
TR 32,6,16896
s_add_u32 s52, s78, 737280
v_lshlrev_b32 v2, 3, v2
v_add3_u32 v20, v20, v2, s62
MAV 64,16,168
buffer_load_dwordx4 v[208:211], v4, s[16:19], s52 offen sc1
v_accvgpr_read_b32 v28, a224
MAV 80,16,172
TR 34,6,17408
v_add_f32 v32, v32, v28
MAV 80,0,164
TR 36,6,16928
TR 38,6,17440
v_accvgpr_read_b32 v29, a225
MAV 84,4,164
TR 48,6,25344
v_add_f32 v33, v33, v29
MAV 84,20,172
buffer_load_dwordx4 v[212:215], v4, s[16:19], s52 offen offset:1024 sc1
v_accvgpr_read_b32 v28, a226
MAV 68,20,168
TR 50,6,25856
v_add_f32 v34, v34, v28
MAV 68,4,160
TR 52,6,25376
TR 54,6,25888
v_accvgpr_read_b32 v29, a227
s_waitcnt lgkmcnt(8)
MAV 72,8,160
TR 40,6,16960
s_add_u32 s52, s79, 851968
v_add_f32 v35, v35, v29
MAV 72,24,168
buffer_load_dwordx4 v[216:219], v4, s[16:19], s52 offen sc1
v_accvgpr_read_b32 v28, a228
MAV 88,24,172
TR 42,6,17472
v_add_f32 v36, v36, v28
MAV 88,8,164
TR 44,6,16992
TR 46,6,17504
v_accvgpr_read_b32 v29, a229
MAV 92,12,164
TR 56,6,25408
v_add_f32 v37, v37, v29
MAV 92,28,172
buffer_load_dwordx4 v[220:223], v4, s[16:19], s52 offen offset:1024 sc1
v_accvgpr_read_b32 v28, a230
MAV 76,28,168
TR 58,6,25920
v_add_f32 v38, v38, v28
v_accvgpr_read_b32 v29, a231
MAV 76,12,160
TR 60,6,25440
TR 62,6,25952
s_waitcnt vmcnt(8) lgkmcnt(8)
MAV 64,32,176
TR 0,6,33792
v_add_f32 v39, v39, v29
MAV 64,48,184
TR 2,6,34304
v_accvgpr_read_b32 v28, a232
v_add_f32 v40, v40, v28
MAV 80,48,188
TR 4,6,33824
MAV 80,32,180
TR 6,6,34336
v_accvgpr_read_b32 v29, a233
v_add_f32 v41, v41, v29
MAV 84,36,180
TR 16,6,42240
v_accvgpr_read_b32 v28, a234
MAV 84,52,188
TR 18,6,42752
v_add_f32 v42, v42, v28
MAV 68,52,184
TR 20,6,42272
v_accvgpr_read_b32 v29, a235
MAV 68,36,176
TR 22,6,42784
v_add_f32 v43, v43, v29
s_waitcnt lgkmcnt(8)
MAV 72,40,176
TR 8,6,33856
MAV 72,56,184
TR 10,6,34368
v_accvgpr_read_b32 v28, a236
v_add_f32 v44, v44, v28
MAV 88,56,188
TR 12,6,33888
v_accvgpr_read_b32 v29, a237
MAV 88,40,180
TR 14,6,34400
v_add_f32 v45, v45, v29
MAV 92,44,180
TR 24,6,42304
v_accvgpr_read_b32 v28, a238
MAV 92,60,188
TR 26,6,42816
v_add_f32 v46, v46, v28
MAV 76,60,184
TR 28,6,42336
v_accvgpr_read_b32 v29, a239
MAV 76,44,176
TR 30,6,42848
v_add_f32 v47, v47, v29
s_waitcnt vmcnt(4) lgkmcnt(8)
MAV 64,0,192
TR 32,6,50688
v_accvgpr_read_b32 v28, a240
MAV 64,16,200
TR 34,6,51200
v_add_f32 v48, v48, v28
v_accvgpr_read_b32 v29, a241
MAV 80,16,204
TR 36,6,50720
MAV 80,0,196
TR 38,6,51232
v_add_f32 v49, v49, v29
v_accvgpr_read_b32 v28, a242
MAV 84,4,196
TR 48,6,59136
v_add_f32 v50, v50, v28
MAV 84,20,204
TR 50,6,59648
v_accvgpr_read_b32 v29, a243
MAV 68,20,200
TR 52,6,59168
v_add_f32 v51, v51, v29
MAV 68,4,192
TR 54,6,59680
v_accvgpr_read_b32 v28, a244
s_waitcnt lgkmcnt(8)
MAV 72,8,192
TR 40,6,50752
MAV 72,24,200
TR 42,6,51264
v_add_f32 v52, v52, v28
v_accvgpr_read_b32 v29, a245
MAV 88,24,204
TR 44,6,50784
v_add_f32 v53, v53, v29
MAV 88,8,196
TR 46,6,51296
v_accvgpr_read_b32 v28, a246
MAV 92,12,196
TR 56,6,59200
v_add_f32 v54, v54, v28
MAV 92,28,204
TR 58,6,59712
v_accvgpr_read_b32 v29, a247
MAV 76,28,200
TR 60,6,59232
v_add_f32 v55, v55, v29
MAV 76,12,192
TR 62,6,59744
v_accvgpr_read_b32 v28, a248
s_waitcnt vmcnt(0) lgkmcnt(8)
MAV 64,32,208
ds_read_b64_tr_b16 a[0:1], v7
v_add_f32 v56, v56, v28
MAV 64,48,216
TR 2,7,512
v_accvgpr_read_b32 v29, a249
MAV 80,48,220
TR 4,7,32
v_add_f32 v57, v57, v29
MAV 80,32,212
TR 6,7,544
v_accvgpr_read_b32 v28, a250
MAV 84,36,212
TR 16,7,8448
v_add_f32 v58, v58, v28
MAV 84,52,220
TR 18,7,8960
v_accvgpr_read_b32 v29, a251
MAV 68,52,216
TR 20,7,8480
v_add_f32 v59, v59, v29
MAV 68,36,208
TR 22,7,8992
s_waitcnt lgkmcnt(8)
MAV 72,40,208
TR 8,7,64
v_accvgpr_read_b32 v28, a252
MAV 72,56,216
TR 10,7,576
v_add_f32 v60, v60, v28
MAV 88,56,220
TR 12,7,96
v_accvgpr_read_b32 v29, a253
MAV 88,40,212
TR 14,7,608
v_add_f32 v61, v61, v29
MAV 92,44,212
TR 24,7,8512
v_accvgpr_read_b32 v28, a254
MAV 92,60,220
TR 26,7,9024
v_add_f32 v62, v62, v28
MAV 76,60,216
TR 28,7,8544
v_accvgpr_read_b32 v29, a255
MAV 76,44,208
TR 30,7,9056
v_add_f32 v63, v63, v29
s_waitcnt lgkmcnt(8)
MAV 32,0,96
TR 32,7,16896
v_cvt_pk_bf16_f32 v232, v64, v65
MAV 32,16,104
TR 34,7,17408
v_cvt_pk_bf16_f32 v233, v66, v67
v_cvt_pk_bf16_f32 v234, v68, v69
MAV 48,16,108
TR 36,7,16928
v_cvt_pk_bf16_f32 v235, v70, v71
MAV 48,0,100
TR 38,7,17440
buffer_store_dwordx4 v[232:235], v4, s[16:19], s69 offen sc1
s_add_u32 s69, s69, 131072
MAV 52,4,100
TR 48,7,25344
.Lpad40:
s_cbranch_execz .Lnopoll63r
v_cvt_pk_bf16_f32 v236, v72, v73
MAV 52,20,108
TR 50,7,25856
v_cvt_pk_bf16_f32 v237, v74, v75
v_cvt_pk_bf16_f32 v238, v76, v77
MAV 36,20,104
TR 52,7,25376
v_cvt_pk_bf16_f32 v239, v78, v79
MAV 36,4,96
TR 54,7,25888
buffer_store_dwordx4 v[236:239], v4, s[16:19], s69 offen sc1
s_waitcnt lgkmcnt(8)
MAV 40,8,96
TR 40,7,16960
s_add_u32 s69, s69, -130048
MAV 40,24,104
TR 42,7,17472
v_cvt_pk_bf16_f32 v240, v80, v81
v_cvt_pk_bf16_f32 v241, v82, v83
MAV 56,24,108
TR 44,7,16992
v_cvt_pk_bf16_f32 v242, v84, v85
MAV 56,8,100
TR 46,7,17504
v_cvt_pk_bf16_f32 v243, v86, v87
buffer_store_dwordx4 v[240:243], v4, s[16:19], s69 offen sc1
MAV 60,12,100
TR 56,7,25408
s_add_u32 s69, s69, 131072
MAV 60,28,108
TR 58,7,25920
v_cvt_pk_bf16_f32 v244, v88, v89
v_cvt_pk_bf16_f32 v245, v90, v91
MAV 44,28,104
TR 60,7,25440
v_cvt_pk_bf16_f32 v246, v92, v93
MAV 44,12,96
TR 62,7,25952
v_cvt_pk_bf16_f32 v247, v94, v95
buffer_store_dwordx4 v[244:247], v4, s[16:19], s69 offen sc1
s_waitcnt lgkmcnt(8)
MAV 32,32,112
TR 0,7,33792
MAV 32,48,120
TR 2,7,34304
MAV 48,48,124
TR 4,7,33824
MAV 48,32,116
TR 6,7,34336
MAV 52,36,116
TR 16,7,42240
MAV 52,52,124
TR 18,7,42752
MAV 36,52,120
TR 20,7,42272
MAV 36,36,112
TR 22,7,42784
s_waitcnt lgkmcnt(8)
MAV 40,40,112
TR 8,7,33856
MAV 40,56,120
TR 10,7,34368
MAV 56,56,124
TR 12,7,33888
MAV 56,40,116
TR 14,7,34400
MAV 60,44,116
TR 24,7,42304
MAV 60,60,124
TR 26,7,42816
MAV 44,60,120
TR 28,7,42336
MAV 44,44,112
TR 30,7,42848
s_waitcnt lgkmcnt(8)
MAV 32,0,128
TR 32,7,50688
MAV 32,16,136
TR 34,7,51200
MAV 48,16,140
TR 36,7,50720
MAV 48,0,132
TR 38,7,51232
MAV 52,4,132
TR 48,7,59136
MAV 52,20,140
TR 50,7,59648
MAV 36,20,136
TR 52,7,59168
MAV 36,4,128
TR 54,7,59680
s_waitcnt lgkmcnt(8)
MAV 40,8,128
TR 40,7,50752
MAV 40,24,136
TR 42,7,51264
MAV 56,24,140
TR 44,7,50784
MAV 56,8,132
TR 46,7,51296
MAV 60,12,132
TR 56,7,59200
MAV 60,28,140
TR 58,7,59712
MAV 44,28,136
TR 60,7,59232
MAV 44,12,128
TR 62,7,59744
v_add_u32 v7, s57, v7
s_waitcnt lgkmcnt(8)
MAV 32,32,144
ds_read_b64_tr_b16 a[0:1], v7
MAV 32,48,152
s_waitcnt vmcnt(0)
buffer_atomic_add v30, v26, s[16:19], s71 offen
MAV 48,48,156
TR 2,7,512
MAV 48,32,148
TR 4,7,32
TR 6,7,544
MAV 52,36,148
MAV 52,52,156
TR 16,7,8448
TR 18,7,8960
MAV 36,52,152
TR 20,7,8480
MAV 36,36,144
s_waitcnt lgkmcnt(7)
MAV 40,40,144
TR 22,7,8992
MAV 40,56,152
TR 8,7,64
TR 10,7,576
MAV 56,56,156
MAV 56,40,148
TR 12,7,96
TR 14,7,608
MAV 60,44,148
TR 24,7,8512
MAV 60,60,156
TR 26,7,9024
MAV 44,60,152
TR 28,7,8544
MAV 44,44,144
TR 30,7,9056
s_waitcnt lgkmcnt(8)
MAV 32,0,160
TR 32,7,16896
MAV 32,16,168
buffer_atomic_add v31, v26, s[16:19], s70 offen sc0
MAV 48,16,172
TR 34,7,17408
MAV 48,0,164
TR 36,7,16928
TR 38,7,17440
MAV 52,4,164
MAV 52,20,172
TR 48,7,25344
TR 50,7,25856
MAV 36,20,168
TR 52,7,25376
MAV 36,4,160
s_waitcnt lgkmcnt(7)
MAV 40,8,160
TR 54,7,25888
MAV 40,24,168
TR 40,7,16960
TR 42,7,17472
MAV 56,24,172
MAV 56,8,164
TR 44,7,16992
TR 46,7,17504
MAV 60,12,164
TR 56,7,25408
MAV 60,28,172
TR 58,7,25920
MAV 44,28,168
TR 60,7,25440
MAV 44,12,160
TR 62,7,25952
s_waitcnt lgkmcnt(8)
MAV 32,32,176
TR 0,7,33792
MAV 32,48,184
TR 2,7,34304
MAV 48,48,188
TR 4,7,33824
MAV 48,32,180
TR 6,7,34336
MAV 52,36,180
TR 16,7,42240
MAV 52,52,188
TR 18,7,42752
MAV 36,52,184
TR 20,7,42272
MAV 36,36,176
TR 22,7,42784
s_waitcnt lgkmcnt(8)
MAV 40,40,176
TR 8,7,33856
MAV 40,56,184
TR 10,7,34368
MAV 56,56,188
TR 12,7,33888
MAV 56,40,180
TR 14,7,34400
MAV 60,44,180
TR 24,7,42304
MAV 60,60,188
TR 26,7,42816
MAV 44,60,184
TR 28,7,42336
MAV 44,44,176
TR 30,7,42848
s_waitcnt vmcnt(0)
v_cmp_le_u32 vcc, 2, v31
s_nop 0
s_cbranch_vccnz .Lxs68
s_mov_b32 s15, 0
.Lxs68l:
v_mov_b32 v31, 0
buffer_atomic_add v31, v26, s[16:19], s70 offen sc0
s_add_u32 s15, s15, 1
s_cmp_gt_u32 s15, 100000
s_waitcnt vmcnt(0)
s_cbranch_scc1 .Lxs68
v_cmp_le_u32 vcc, 2, v31
s_nop 0
s_cbranch_vccz .Lxs68l
.Lxs68:
s_waitcnt lgkmcnt(8)
MAV 32,0,192
TR 32,7,50688
MAV 32,16,200
buffer_load_dwordx4 v[232:235], v4, s[16:19], s68 offen sc1
MAV 48,16,204
TR 34,7,51200
s_add_u32 s68, s68, 131072
MAV 48,0,196
TR 36,7,50720
TR 38,7,51232
MAV 52,4,196
TR 48,7,59136
MAV 52,20,204
buffer_load_dwordx4 v[236:239], v4, s[16:19], s68 offen sc1
MAV 36,20,200
TR 50,7,59648
s_add_u32 s68, s68, -130048
MAV 36,4,192
TR 52,7,59168
TR 54,7,59680
s_waitcnt lgkmcnt(8)
MAV 40,8,192
TR 40,7,50752
MAV 40,24,200
buffer_load_dwordx4 v[240:243], v4, s[16:19], s68 offen sc1
MAV 56,24,204
TR 42,7,51264
s_add_u32 s68, s68, 131072
MAV 56,8,196
TR 44,7,50784
TR 46,7,51296
MAV 60,12,196
TR 56,7,59200
MAV 60,28,204
buffer_load_dwordx4 v[244:247], v4, s[16:19], s68 offen sc1
MAV 44,28,200
TR 58,7,59712
MAV 44,12,192
TR 60,7,59232
TR 62,7,59744
s_waitcnt lgkmcnt(8)
MAV 32,32,208
MAV 32,48,216
MAV 48,48,220
MAV 48,32,212
MAV 52,36,212
MAV 52,52,220
MAV 36,52,216
MAV 36,36,208
s_waitcnt lgkmcnt(0)
MAV 40,40,208
MAV 40,56,216
MAV 56,56,220
MAV 56,40,212
MAV 60,44,212
MAV 60,60,220
MAV 44,60,216
MAV 44,44,208
s_waitcnt vmcnt(3)
v_mfma_f32_16x16x32_bf16 v[32:35], v[226:229], v[232:235], v[32:35]
v_mfma_f32_16x16x32_bf16 v[36:39], v[224:227], v[232:235], v[36:39]
s_waitcnt vmcnt(2)
v_mfma_f32_16x16x32_bf16 v[40:43], v[226:229], v[236:239], v[40:43]
v_mfma_f32_16x16x32_bf16 v[44:47], v[224:227], v[236:239], v[44:47]
s_waitcnt vmcnt(1)
v_mfma_f32_16x16x32_bf16 v[48:51], v[226:229], v[240:243], v[48:51]
v_mfma_f32_16x16x32_bf16 v[52:55], v[224:227], v[240:243], v[52:55]
s_waitcnt vmcnt(0)
v_mfma_f32_16x16x32_bf16 v[56:59], v[226:229], v[244:247], v[56:59]
v_cvt_pk_bf16_f32 v128, v32, v33
v_mfma_f32_16x16x32_bf16 v[60:63], v[224:227], v[244:247], v[60:63]
v_cvt_pk_bf16_f32 v129, v34, v35
ds_write_b64 v20, v[128:129]
v_cvt_pk_bf16_f32 v130, v36, v37
v_cvt_pk_bf16_f32 v131, v38, v39
ds_write_b64 v20, v[130:131] offset:32
v_cvt_pk_bf16_f32 v132, v40, v41
v_cvt_pk_bf16_f32 v133, v42, v43
ds_write_b64 v20, v[132:133] offset:64
v_cvt_pk_bf16_f32 v134, v44, v45
v_cvt_pk_bf16_f32 v135, v46, v47
ds_write_b64 v20, v[134:135] offset:96
ds_read_b128 v[144:147], v21
ds_read_b128 v[148:151], v21 offset:1152
v_cvt_pk_bf16_f32 v136, v48, v49
v_cvt_pk_bf16_f32 v137, v50, v51
ds_write_b64 v20, v[136:137] offset:2304
v_cvt_pk_bf16_f32 v138, v52, v53
v_cvt_pk_bf16_f32 v139, v54, v55
ds_write_b64 v20, v[138:139] offset:2336
v_cvt_pk_bf16_f32 v140, v56, v57
v_cvt_pk_bf16_f32 v141, v58, v59
ds_write_b64 v20, v[140:141] offset:2368
v_cvt_pk_bf16_f32 v142, v60, v61
v_cvt_pk_bf16_f32 v143, v62, v63
ds_write_b64 v20, v[142:143] offset:2400
ds_read_b128 v[152:155], v21 offset:2304
ds_read_b128 v[156:159], v21 offset:3456
s_waitcnt lgkmcnt(7)
buffer_store_dwordx4 v[144:147], v16, s[36:39], 0 offen sc1
s_waitcnt lgkmcnt(6)
buffer_store_dwordx4 v[148:151], v16, s[36:39], s64 offen sc1
s_waitcnt lgkmcnt(1)
buffer_store_dwordx4 v[152:155], v17, s[36:39], 0 offen sc1
s_waitcnt lgkmcnt(0)
buffer_store_dwordx4 v[156:159], v17, s[36:39], s64 offen sc1
s_nop 1
.Lend:
s_endpgm
.Lsp67:
s_mov_b32 s15, 0
.Lsp67l:
v_mov_b32 v25, 0
buffer_atomic_add v25, v22, s[16:19], s73 offen sc0
s_add_u32 s15, s15, 1
s_cmp_gt_u32 s15, 100000
s_waitcnt vmcnt(0)
s_cbranch_scc1 .Lsp67b
v_cmp_gt_u32 vcc, v23, v25
s_nop 0
s_cbranch_vccnz .Lsp67l
s_branch .Lsp67b
.section .rodata,"a"
.p2align 6
.amdhsa_kernel interleave_layers__sliding_local_dilated__swiglu_ffn__prompt_kernel
  .amdhsa_next_free_vgpr 512
  .amdhsa_next_free_sgpr 102
  .amdhsa_accum_offset 256
  .amdhsa_group_segment_fixed_size 0
  .amdhsa_kernarg_size 80
  .amdhsa_user_sgpr_count 2
  .amdhsa_user_sgpr_kernarg_segment_ptr 1
  .amdhsa_system_sgpr_workgroup_id_x 1
  .amdhsa_float_denorm_mode_32 3
.end_amdhsa_kernel
```

```asm
; @launch grid=(256,1,1) block=(256,1,1) lds=162560
.amdgcn_target "amdgcn-amd-amdhsa--gfx950"
.macro MAA d,a,b
v_mfma_f32_16x16x32_bf16 v[\d:\d+3], a[\a:\a+3], a[\b:\b+3], v[\d:\d+3]
.endm
.macro MAV d,a,b
v_mfma_f32_16x16x32_bf16 v[\d:\d+3], a[\a:\a+3], v[\b:\b+3], v[\d:\d+3]
.endm
.macro TR d,v,o
ds_read_b64_tr_b16 a[\d:\d+1], v\v offset:\o
.endm
.macro RD d,v,o
ds_read_b128 a[\d:\d+3], v\v offset:\o
.endm
.text
.globl interleave_layers__sliding_local_dilated__swiglu_ffn__prompt_kernel
.p2align 8
.type interleave_layers__sliding_local_dilated__swiglu_ffn__prompt_kernel,@function
interleave_layers__sliding_local_dilated__swiglu_ffn__prompt_kernel:
s_load_dwordx4 s[68:71], s[0:1], 0
s_load_dwordx2 s[72:73], s[0:1], 16
s_load_dwordx8 s[76:83], s[0:1], 32
s_load_dwordx4 s[84:87], s[0:1], 64
s_cmp_lt_u32 s2, 256
s_cbranch_scc1 .Lgo
s_endpgm
.p2align 12
.Lgo:
v_lshrrev_b32 v2, 6, v0
v_and_b32 v1, 63, v0
v_readfirstlane_b32 s3, v2
s_and_b32 s4, s2, 7
s_lshr_b32 s5, s2, 3
s_lshr_b32 s8, s4, 2
s_lshl_b32 s8, s8, 3
s_and_b32 s62, s5, 7
s_add_u32 s8, s8, s62
s_and_b32 s9, s4, 3
s_lshl_b32 s9, s9, 2
s_lshr_b32 s62, s5, 3
s_add_u32 s9, s9, s62
s_and_b32 s48, s3, 1
s_lshr_b32 s49, s3, 1
s_lshl_b32 s50, s8, 3
s_sub_u32 s50, s50, 9
s_cmp_lt_u32 s8, 2
s_cselect_b32 s50, 7, s50
s_lshr_b32 s6, s4, 1
s_lshl_b32 s6, s6, 2
s_and_b32 s62, s5, 3
s_add_u32 s6, s6, s62
s_and_b32 s7, s4, 1
s_lshr_b32 s62, s5, 2
s_lshl_b32 s62, s62, 1
s_add_u32 s7, s7, s62
s_lshr_b32 s62, s6, 1
s_lshl_b32 s62, s62, 8
s_and_b32 s63, s6, 1
s_add_u32 s62, s62, s63
s_lshl_b32 s63, s3, 6
s_add_u32 s62, s62, s63
s_lshl_b32 s62, s62, 11
s_lshl_b32 s63, s7, 7
s_add_u32 s62, s62, s63
v_and_b32 v228, 15, v1
v_lshlrev_b32 v228, 12, v228
v_bfe_u32 v2, v1, 4, 1
v_lshl_add_u32 v228, v2, 5, v228
v_bfe_u32 v2, v1, 5, 1
v_lshl_add_u32 v228, v2, 4, v228
v_add_u32 v228, s62, v228
v_add_u32 v229, 0x10000, v228
s_sub_u32 s64, s3, 1
s_max_i32 s64, s64, 0
s_lshl_b32 s64, s64, 11
s_lshl_b32 s66, s9, 7
s_add_u32 s66, s66, s64
s_cmp_eq_u32 s3, 1
s_cselect_b32 s66, 8388608, s66
s_mul_i32 s65, s8, 122880
s_add_u32 s65, s65, s66
v_lshrrev_b32 v9, 1, v1
v_min_u32 v9, 19, v9
v_mul_u32_u24 v9, 6144, v9
s_xor_b32 s14, s3, 3
s_lshl_b32 s14, s14, 8
s_add_u32 s14, s14, s2
v_lshlrev_b32 v230, 4, v1
v_mov_b64 v[224:225], 0
v_mov_b64 v[226:227], 0
s_waitcnt lgkmcnt(0)
s_mov_b32 s16, s86
s_mov_b32 s17, s87
s_mov_b32 s18, 268435456
s_mov_b32 s19, 0x20000
s_mov_b32 s36, s68
s_mov_b32 s37, s69
s_mov_b32 s38, 4194304
s_mov_b32 s39, 0x20000
s_cmp_ge_u32 s14, 16
s_cbranch_scc1 .Lz3
s_lshl_b32 s62, s2, 13
s_add_u32 s62, s62, 30408704
s_add_u32 s63, s62, 4096
buffer_store_dwordx4 v[224:227], v230, s[16:19], s62 offen sc1
buffer_store_dwordx4 v[224:227], v230, s[16:19], s62 offen offset:1024 sc1
buffer_store_dwordx4 v[224:227], v230, s[16:19], s62 offen offset:2048 sc1
buffer_store_dwordx4 v[224:227], v230, s[16:19], s62 offen offset:3072 sc1
buffer_store_dwordx4 v[224:227], v230, s[16:19], s63 offen sc1
buffer_store_dwordx4 v[224:227], v230, s[16:19], s63 offen offset:1024 sc1
buffer_store_dwordx4 v[224:227], v230, s[16:19], s63 offen offset:2048 sc1
buffer_store_dwordx4 v[224:227], v230, s[16:19], s63 offen offset:3072 sc1
.Lz3:
buffer_load_dwordx4 v[164:167], v228, s[36:39], 0 offen
buffer_load_dwordx4 v[168:171], v228, s[36:39], 0 offen offset:64
buffer_load_dwordx4 v[172:175], v229, s[36:39], 0 offen
buffer_load_dwordx4 v[176:179], v229, s[36:39], 0 offen offset:64
s_mov_b32 s20, s70
s_mov_b32 s21, s71
s_mov_b32 s22, 6291456
s_mov_b32 s23, 0x20000
buffer_load_dword v58, v9, s[20:23], s65 offen
s_mov_b32 s40, s84
s_mov_b32 s41, s85
s_mov_b32 s42, 256
s_mov_b32 s43, 0x20000
s_getpc_b64 s[62:63]
.Lpc:
s_lshl_b32 s64, s5, 12
v_lshrrev_b32 v59, 3, v0
v_lshl_add_u32 v59, v59, 7, s64
v_add_u32 v2, 0x20000, v59
v_min_u32 v2, .Lend-.Lpc, v2
v_min_u32 v59, .Lend-.Lpc, v59
global_load_dword v59, v59, s[62:63]
global_load_dword v58, v2, s[62:63]
s_mov_b32 s24, s72
s_mov_b32 s25, s73
s_mov_b32 s26, 2097152
s_mov_b32 s27, 0x20000
s_mov_b32 s28, s80
s_mov_b32 s29, s81
s_mov_b32 s30, 7340032
s_mov_b32 s31, 0x20000
s_mov_b32 s0, s82
s_mov_b32 s1, s83
s_mov_b32 s32, s76
s_mov_b32 s33, s77
s_mov_b32 s34, 7340032
s_mov_b32 s35, 0x20000
s_mov_b32 s80, s78
s_mov_b32 s81, s79
s_mov_b32 s82, 7340032
s_mov_b32 s83, 0x20000
s_lshr_b32 s10, s4, 2
s_lshl_b32 s10, s10, 2
s_and_b32 s62, s5, 3
s_add_u32 s10, s10, s62
s_and_b32 s11, s4, 3
s_lshl_b32 s11, s11, 3
s_lshr_b32 s62, s5, 2
s_add_u32 s11, s11, s62
s_and_b32 s12, s11, 1
s_lshr_b32 s13, s11, 1
s_mul_i32 s51, s13, 448
s_mul_i32 s62, s12, 192
s_add_u32 s51, s51, s62
s_lshl_b32 s62, s6, 3
s_lshr_b32 s84, s62, 4
s_lshl_b32 s84, s84, 14
s_and_b32 s62, s62, 15
s_lshl_b32 s62, s62, 10
s_add_u32 s84, s84, s62
s_lshl_b32 s62, s8, 3
s_lshr_b32 s85, s62, 4
s_lshl_b32 s85, s85, 14
s_and_b32 s62, s62, 15
s_lshl_b32 s62, s62, 10
s_add_u32 s85, s85, s62
s_lshl_b32 s62, s50, 0
s_lshr_b32 s86, s62, 4
s_lshl_b32 s86, s86, 14
s_and_b32 s62, s62, 15
s_lshl_b32 s62, s62, 10
s_add_u32 s86, s86, s62
s_mul_i32 s62, s8, 393216
s_add_u32 s62, s62, s66
v_mul_u32_u24 v14, 6144, v1
v_add_u32 v14, s62, v14
s_lshl_b32 s62, s8, 4
s_add_u32 s62, s62, s9
s_lshl_b32 s62, s62, 2
s_add_u32 s62, s62, s3
s_mul_i32 s62, s62, 6656
v_min_u32 v15, 51, v1
v_lshl_add_u32 v15, v15, 7, s62
s_sub_u32 s63, s8, 4
s_lshl_b32 s64, s8, 1
s_add_u32 s64, s64, 1
s_cmp_lt_u32 s8, 5
s_cselect_b64 vcc, -1, 0
s_cselect_b32 s46, s64, s63
v_cndmask_b32 v14, v14, v15, vcc
s_lshl_b32 s62, s2, 1
s_add_u32 s62, s62, s48
s_mul_i32 s62, s62, 5376
v_min_u32 v16, 41, v1
v_lshl_add_u32 v16, v16, 7, s62
s_cmp_lt_u32 s46, 6
s_cselect_b64 vcc, -1, 0
v_cndmask_b32 v15, v14, v16, vcc
v_cndmask_b32 v14, v16, v14, vcc
s_cmp_lt_u32 s3, 2
s_cselect_b32 s65, s32, s80
s_cselect_b32 s66, s33, s81
s_cselect_b32 s67, s34, s82
s_cmp_lt_u32 s8, 5
s_cselect_b32 s62, s24, s20
s_cselect_b32 s63, s25, s21
s_cselect_b32 s64, s26, s22
s_sub_u32 s47, s46, 6
s_cmp_lt_u32 s46, 6
s_cselect_b32 s47, s46, s47
s_cselect_b32 s76, s62, s65
s_cselect_b32 s98, s65, s62
s_cselect_b32 s77, s63, s66
s_cselect_b32 s99, s66, s63
s_cselect_b32 s78, s64, s67
s_cselect_b32 s100, s67, s64
s_mov_b32 s79, 0x20000
v_bfe_u32 v18, v1, 3, 1
v_bfe_u32 v2, v1, 5, 1
v_lshl_add_u32 v18, v2, 2, v18
v_and_b32 v2, 16, v1
v_add_u32 v18, v18, v2
s_lshl_b32 s62, s49, 2
s_add_u32 s62, s62, s48
s_lshl_b32 s62, s62, 1
v_add_u32 v18, s62, v18
v_mul_u32_u24 v18, 6144, v18
v_and_b32 v2, 7, v1
v_lshl_add_u32 v18, v2, 4, v18
s_lshl_b32 s62, s9, 7
v_add_u32 v18, s62, v18
v_add_u32 v19, 1024, v18
v_add_u32 v20, 2048, v18
s_mul_i32 s59, s3, 3104
s_mov_b32 s58, 0
s_lshr_b32 s62, s8, 1
s_lshl_b32 s62, s62, 8
s_and_b32 s67, s8, 1
s_add_u32 s62, s62, s67
s_lshl_b32 s62, s62, 11
s_lshl_b32 s63, s3, 17
s_add_u32 s62, s62, s63
v_lshrrev_b32 v2, 4, v1
v_xor_b32 v2, v2, v1
v_and_b32 v2, 7, v2
v_lshlrev_b32 v2, 4, v2
v_lshrrev_b32 v21, 3, v1
v_lshl_add_u32 v21, v21, 12, v2
v_add_u32 v21, s62, v21
v_xor_b32 v28, 64, v21
v_add_u32 v28, 31744, v28
s_lshr_b32 s63, s50, 3
s_lshr_b32 s62, s63, 1
s_lshl_b32 s62, s62, 8
s_and_b32 s67, s63, 1
s_add_u32 s62, s62, s67
s_lshl_b32 s62, s62, 11
s_lshl_b32 s63, s3, 14
s_add_u32 s62, s62, s63
s_add_u32 s62, s62, 456704
s_lshl_b32 s63, s3, 5
v_and_b32 v2, 31, v1
v_lshlrev_b32 v2, 2, v2
v_xor_b32 v2, s63, v2
v_lshrrev_b32 v22, 5, v1
v_lshl_add_u32 v22, v22, 12, v2
v_add_u32 v22, s62, v22
v_xor_b32 v29, 16, v22
v_add_u32 v29, -57344, v29
s_mov_b32 s52, 0
s_mov_b32 s53, 65536
s_mul_i32 s55, s3, 4608
s_mov_b32 s54, 0
s_mul_i32 s56, s3, 3104
v_bfe_u32 v24, v1, 1, 3
v_lshrrev_b32 v2, 4, v1
v_xor_b32 v2, v2, v24
v_lshlrev_b32 v2, 4, v2
v_and_b32 v23, 15, v1
v_lshl_add_u32 v23, v23, 7, v2
s_mul_i32 s62, s48, 9216
v_add_u32 v23, s62, v23
v_xor_b32 v30, 64, v23
v_mul_u32_u24 v24, 2304, v24
v_add_u32 v24, v24, v2
v_and_b32 v2, 1, v1
v_lshl_add_u32 v24, v2, 7, v24
v_add_u32 v24, 2048, v24
v_xor_b32 v31, 64, v24
v_and_b32 v2, 15, v1
v_cmp_eq_u32 vcc, 0, v2
v_mov_b32 v2, 18432
s_nop 0
v_cndmask_b32 v24, v24, v2, vcc
v_cndmask_b32 v31, v31, v2, vcc
v_bfe_u32 v25, v1, 3, 2
v_mul_u32_u24 v25, 3104, v25
v_bfe_u32 v2, v1, 2, 1
v_lshl_add_u32 v25, v2, 7, v25
v_bfe_u32 v2, v1, 5, 1
v_lshl_add_u32 v25, v2, 8, v25
v_and_b32 v2, 3, v1
v_lshl_add_u32 v25, v2, 3, v25
s_lshl_b32 s62, s49, 6
s_add_u32 s62, s62, 73984
v_add_u32 v25, s62, v25
s_lshl_b32 s62, s8, 1
s_add_u32 s62, s62, s3
s_lshr_b32 s63, s50, 2
s_cmp_lt_u32 s3, 2
s_cselect_b32 s62, s62, s63
s_lshl_b32 s62, s62, 13
s_cmp_eq_u32 s3, 3
s_cselect_b32 s62, 268435456, s62
v_lshl_add_u32 v26, v1, 4, s62
s_mul_i32 s59, s3, 2080
s_and_b32 s87, s6, 3
s_lshl_b32 s87, s87, 17
v_bfe_u32 v5, v1, 3, 1
v_lshrrev_b32 v2, 4, v1
v_lshl_add_u32 v5, v2, 3, v5
s_lshl_b32 s62, s3, 1
v_add_u32 v5, s62, v5
v_mul_u32_u24 v5, 2048, v5
v_and_b32 v2, 7, v1
v_lshl_add_u32 v5, v2, 4, v5
s_lshl_b32 s62, s7, 7
v_add_u32 v5, s62, v5
v_add_u32 v6, 64512, v5
s_lshl_b32 s62, s6, 10
s_add_u32 s62, s62, 30408704
s_lshl_b32 s64, s8, 10
s_add_u32 s64, s64, 30408704
s_lshr_b32 s67, s9, 1
s_and_b32 s67, s67, 3
s_lshl_b32 s67, s67, 7
s_add_u32 s64, s64, s67
s_lshr_b32 s65, s50, 3
s_lshl_b32 s65, s65, 10
s_add_u32 s65, s65, 30408704
s_lshr_b32 s67, s9, 1
s_and_b32 s67, s67, 3
s_lshl_b32 s67, s67, 7
s_add_u32 s65, s65, s67
v_mov_b32 v2, 268435456
v_cmp_eq_u32 vcc, 65, v0
v_mov_b32 v33, s65
s_nop 0
v_cndmask_b32 v33, v2, v33, vcc
v_cndmask_b32 v36, 0, 16, vcc
v_cmp_eq_u32 vcc, 64, v0
v_mov_b32 v32, s64
s_nop 0
v_cndmask_b32 v33, v33, v32, vcc
v_lshl_add_u32 v32, v1, 7, s62
v_cndmask_b32 v34, v2, 0, vcc
v_cndmask_b32 v35, 0, 16, vcc
v_cndmask_b32 v36, v36, 16, vcc
v_lshrrev_b32 v37, 3, v0
v_cmp_eq_u32 vcc, 8, v37
s_nop 1
v_cndmask_b32 v32, v2, v32, vcc
v_mov_b32 v38, 1
v_lshrrev_b32 v2, 4, v1
v_lshlrev_b32 v2, 2, v2
v_and_b32 v13, 15, v1
v_sub_u32 v2, v13, v2
v_mov_b32 v13, 0xff61b1e6
v_subrev_u32 v54, 0, v2
v_cmp_gt_u32 vcc, 8, v54
s_nop 1
v_cndmask_b32 v50, v13, 0, vcc
v_cmp_gt_i32 vcc, -8, v54
s_nop 1
v_cndmask_b32 v46, v13, 0, vcc
v_subrev_u32 v54, 1, v2
v_cmp_gt_u32 vcc, 8, v54
s_nop 1
v_cndmask_b32 v51, v13, 0, vcc
v_cmp_gt_i32 vcc, -8, v54
s_nop 1
v_cndmask_b32 v47, v13, 0, vcc
v_subrev_u32 v54, 2, v2
v_cmp_gt_u32 vcc, 8, v54
s_nop 1
v_cndmask_b32 v52, v13, 0, vcc
v_cmp_gt_i32 vcc, -8, v54
s_nop 1
v_cndmask_b32 v48, v13, 0, vcc
v_subrev_u32 v54, 3, v2
v_cmp_gt_u32 vcc, 8, v54
s_nop 1
v_cndmask_b32 v53, v13, 0, vcc
v_cmp_gt_i32 vcc, -8, v54
s_nop 1
v_cndmask_b32 v49, v13, 0, vcc
s_cmp_lt_u32 s8, 2
s_cselect_b64 vcc, -1, 0
v_cndmask_b32 v54, v46, v13, vcc
v_cndmask_b32 v55, v47, v13, vcc
v_cndmask_b32 v56, v48, v13, vcc
v_cndmask_b32 v57, v49, v13, vcc
s_mov_b32 s75, 29360128
v_and_b32 v10, 15, v1
v_lshlrev_b32 v12, 2, v10
v_lshlrev_b32 v10, 4, v10
v_add_u32 v10, 152576, v10
v_lshrrev_b32 v11, 4, v1
v_lshlrev_b32 v11, 4, v11
s_lshl_b32 s62, s49, 7
s_add_u32 s62, s62, 158720
v_add_u32 v12, s62, v12
v_add_u32 v13, s62, v11
v_add_u32 v11, 156672, v11
s_lshl_b32 s62, s3, 11
s_add_u32 s62, s62, 143360
v_lshl_add_u32 v8, v1, 4, s62
v_xor_b32 v9, 2048, v8
v_mov_b32 v248, 0x3f803f80
v_mov_b32 v249, 0x3f803f80
v_mov_b32 v250, 0x3f803f80
v_mov_b32 v251, 0x3f803f80
s_mul_i32 s62, s3, 18496
s_add_u32 s62, s62, 18432
v_mov_b32 v2, s62
ds_write_b128 v2, v[248:251]
v_and_b32 v7, 31, v1
v_lshrrev_b32 v2, 5, v1
v_lshl_add_u32 v7, v7, 1, v2
v_and_b32 v2, 0xc0, v0
v_add_u32 v7, v7, v2
v_lshlrev_b32 v17, 2, v7
v_add_u32 v17, 156672, v17
v_lshlrev_b32 v7, 4, v7
v_add_u32 v7, 152576, v7
s_lshl_b32 s74, s9, 1
s_add_u32 s74, s74, s49
s_lshl_b32 s74, s74, 17
s_add_u32 s74, s74, s85
s_lshl_b32 s63, s48, 12
s_add_u32 s74, s74, s63
s_add_u32 s74, s74, 4194304
s_mov_b32 s62, 0
v_lshl_add_u32 v4, v1, 4, s62
v_lshrrev_b32 v2, 3, v1
v_cmp_eq_u32 vcc, 3, v2
v_add_u32 v2, 67108480, v4
s_nop 0
v_cndmask_b32 v4, v4, v2, vcc
s_mov_b64 exec, 0
s_cmp_eq_u32 s3, 2
s_cbranch_scc1 .Lpad1
s_cmp_eq_u32 s3, 3
s_cbranch_scc1 .Lpad2
s_cmp_eq_u32 s3, 1
s_cbranch_scc1 .Lpad4
s_branch .Lpad3
.Lt0r:
s_mov_b64 exec, -1
s_add_u32 m0, s55, 0
s_nop 0
buffer_load_dwordx4 v21, s[36:39], s52 offen lds
buffer_load_dwordx4 v28, s[36:39], s52 offen offset:1024 lds
buffer_load_dword v22, s[36:39], s52 offen offset:2048 lds
s_add_u32 s52, s52, 128
s_add_u32 m0, s55, 2304
s_nop 0
buffer_load_dwordx4 v21, s[36:39], s53 offen lds
buffer_load_dwordx4 v28, s[36:39], s53 offen offset:1024 lds
buffer_load_dword v29, s[36:39], s53 offen offset:2048 lds
s_add_u32 s53, s53, 128
s_add_u32 m0, s56, 123648
s_nop 0
buffer_load_dwordx4 v18, s[20:23], s54 offen lds
buffer_load_dwordx4 v19, s[20:23], s54 offen offset:1024 lds
buffer_load_dwordx4 v20, s[20:23], s54 offen offset:2048 lds
s_add_u32 s54, s54, 196608
s_add_u32 m0, s56, 136064
s_nop 0
buffer_load_dwordx4 v18, s[20:23], s54 offen lds
buffer_load_dwordx4 v19, s[20:23], s54 offen offset:1024 lds
buffer_load_dwordx4 v20, s[20:23], s54 offen offset:2048 lds
s_add_u32 s54, s54, 196608
s_cmp_eq_u32 s48, 1
s_cbranch_scc1 .Lqkv1
s_cmp_lt_u32 s14, 16
s_cselect_b32 s62, 0, 4096
v_mov_b32 v231, 1
v_lshlrev_b32 v232, 8, v1
s_waitcnt vmcnt(18)
v_permlane16_swap_b32 v164, v166
v_permlane16_swap_b32 v165, v167
s_waitcnt vmcnt(17)
v_permlane16_swap_b32 v168, v170
v_permlane16_swap_b32 v169, v171
s_waitcnt vmcnt(16)
v_permlane16_swap_b32 v172, v174
v_permlane16_swap_b32 v173, v175
s_waitcnt vmcnt(15)
v_permlane16_swap_b32 v176, v178
v_permlane16_swap_b32 v177, v179
buffer_atomic_add v231, v232, s[40:43], s62 offen
v_lshlrev_b32 v192, 16, v164
v_and_b32 v193, 0xffff0000, v164
v_lshlrev_b32 v194, 16, v165
v_and_b32 v195, 0xffff0000, v165
v_lshlrev_b32 v196, 16, v166
v_and_b32 v197, 0xffff0000, v166
v_lshlrev_b32 v198, 16, v167
v_and_b32 v199, 0xffff0000, v167
v_lshlrev_b32 v200, 16, v168
v_and_b32 v201, 0xffff0000, v168
v_lshlrev_b32 v202, 16, v169
v_and_b32 v203, 0xffff0000, v169
v_lshlrev_b32 v204, 16, v170
v_and_b32 v205, 0xffff0000, v170
v_lshlrev_b32 v206, 16, v171
v_and_b32 v207, 0xffff0000, v171
v_lshlrev_b32 v208, 16, v172
v_and_b32 v209, 0xffff0000, v172
v_lshlrev_b32 v210, 16, v173
v_and_b32 v211, 0xffff0000, v173
v_lshlrev_b32 v212, 16, v174
v_and_b32 v213, 0xffff0000, v174
v_lshlrev_b32 v214, 16, v175
v_and_b32 v215, 0xffff0000, v175
v_lshlrev_b32 v216, 16, v176
v_and_b32 v217, 0xffff0000, v176
v_lshlrev_b32 v218, 16, v177
v_and_b32 v219, 0xffff0000, v177
v_lshlrev_b32 v220, 16, v178
v_and_b32 v221, 0xffff0000, v178
v_lshlrev_b32 v222, 16, v179
v_and_b32 v223, 0xffff0000, v179
s_lshl_b32 s64, s6, 14
s_lshl_b32 s65, s49, 13
s_add_u32 s64, s64, s65
s_lshl_b32 s65, s7, 9
s_add_u32 s64, s64, s65
s_lshl_b32 s65, s48, 8
s_add_u32 s64, s64, s65
s_add_u32 s64, s64, 29360128
v_and_b32 v188, 31, v1
v_lshlrev_b32 v188, 3, v188
v_lshrrev_b32 v189, 5, v1
v_lshl_add_u32 v188, v189, 28, v188
s_lshl_b32 s62, s7, 18
s_add_u32 s62, s62, 0
s_add_u32 s63, s62, 131072
v_pk_mul_f32 v[182:183], v[192:193], v[192:193]
v_pk_mul_f32 v[186:187], v[208:209], v[208:209]
v_pk_fma_f32 v[182:183], v[194:195], v[194:195], v[182:183]
v_pk_add_f32 v[180:181], v[192:193], v[194:195]
v_pk_fma_f32 v[186:187], v[210:211], v[210:211], v[186:187]
v_pk_add_f32 v[184:185], v[208:209], v[210:211]
v_pk_fma_f32 v[182:183], v[196:197], v[196:197], v[182:183]
v_pk_add_f32 v[180:181], v[180:181], v[196:197]
v_pk_fma_f32 v[186:187], v[212:213], v[212:213], v[186:187]
v_pk_add_f32 v[184:185], v[184:185], v[212:213]
v_pk_fma_f32 v[182:183], v[198:199], v[198:199], v[182:183]
v_pk_add_f32 v[180:181], v[180:181], v[198:199]
v_pk_fma_f32 v[186:187], v[214:215], v[214:215], v[186:187]
v_pk_add_f32 v[184:185], v[184:185], v[214:215]
v_pk_fma_f32 v[182:183], v[200:201], v[200:201], v[182:183]
v_pk_add_f32 v[180:181], v[180:181], v[200:201]
v_pk_fma_f32 v[186:187], v[216:217], v[216:217], v[186:187]
v_pk_add_f32 v[184:185], v[184:185], v[216:217]
v_pk_fma_f32 v[182:183], v[202:203], v[202:203], v[182:183]
v_pk_add_f32 v[180:181], v[180:181], v[202:203]
v_pk_fma_f32 v[186:187], v[218:219], v[218:219], v[186:187]
v_pk_add_f32 v[184:185], v[184:185], v[218:219]
v_pk_fma_f32 v[182:183], v[204:205], v[204:205], v[182:183]
v_pk_add_f32 v[180:181], v[180:181], v[204:205]
v_pk_fma_f32 v[186:187], v[220:221], v[220:221], v[186:187]
v_pk_add_f32 v[184:185], v[184:185], v[220:221]
v_pk_fma_f32 v[182:183], v[206:207], v[206:207], v[182:183]
v_pk_add_f32 v[180:181], v[180:181], v[206:207]
v_pk_fma_f32 v[186:187], v[222:223], v[222:223], v[186:187]
v_pk_add_f32 v[184:185], v[184:185], v[222:223]
v_add_f32 v180, v180, v181
v_add_f32 v182, v182, v183
v_add_f32 v184, v184, v185
v_add_f32 v186, v186, v187
s_nop 0
v_permlane16_swap_b32 v180, v184
v_permlane16_swap_b32 v182, v186
v_add_f32 v180, v180, v184
v_add_f32 v182, v182, v186
s_nop 1
v_permlane32_swap_b32 v180, v182
v_add_f32 v180, v180, v182
s_nop 1
v_permlane32_swap_b32 v180, v181
buffer_store_dwordx2 v[180:181], v188, s[16:19], s64 offen sc1
s_lshl_b32 s62, s2, 10
s_add_u32 s62, s62, 31457280
s_cmp_eq_u32 s3, 0
s_cselect_b32 s62, s62, 268435456
buffer_store_dwordx4 v[224:227], v230, s[16:19], s62 offen sc1
v_accvgpr_write_b32 a224, v192
v_accvgpr_write_b32 a225, v193
v_accvgpr_write_b32 a226, v194
v_accvgpr_write_b32 a227, v195
v_accvgpr_write_b32 a228, v196
v_accvgpr_write_b32 a229, v197
v_accvgpr_write_b32 a230, v198
v_accvgpr_write_b32 a231, v199
v_accvgpr_write_b32 a232, v200
v_accvgpr_write_b32 a233, v201
v_accvgpr_write_b32 a234, v202
v_accvgpr_write_b32 a235, v203
v_accvgpr_write_b32 a236, v204
v_accvgpr_write_b32 a237, v205
v_accvgpr_write_b32 a238, v206
v_accvgpr_write_b32 a239, v207
v_accvgpr_write_b32 a240, v208
v_accvgpr_write_b32 a241, v209
v_accvgpr_write_b32 a242, v210
v_accvgpr_write_b32 a243, v211
v_accvgpr_write_b32 a244, v212
v_accvgpr_write_b32 a245, v213
v_accvgpr_write_b32 a246, v214
v_accvgpr_write_b32 a247, v215
v_accvgpr_write_b32 a248, v216
v_accvgpr_write_b32 a249, v217
v_accvgpr_write_b32 a250, v218
v_accvgpr_write_b32 a251, v219
v_accvgpr_write_b32 a252, v220
v_accvgpr_write_b32 a253, v221
v_accvgpr_write_b32 a254, v222
v_accvgpr_write_b32 a255, v223
s_add_u32 m0, s55, 18496
s_nop 0
buffer_load_dwordx4 v21, s[36:39], s52 offen lds
buffer_load_dwordx4 v28, s[36:39], s52 offen offset:1024 lds
buffer_load_dword v22, s[36:39], s52 offen offset:2048 lds
s_add_u32 s52, s52, 128
s_add_u32 m0, s55, 20800
s_nop 0
buffer_load_dwordx4 v21, s[36:39], s53 offen lds
buffer_load_dwordx4 v28, s[36:39], s53 offen offset:1024 lds
buffer_load_dword v29, s[36:39], s53 offen offset:2048 lds
s_add_u32 s53, s53, 128
s_add_u32 m0, s56, 73984
s_nop 0
buffer_load_dwordx4 v18, s[20:23], s54 offen lds
buffer_load_dwordx4 v19, s[20:23], s54 offen offset:1024 lds
buffer_load_dwordx4 v20, s[20:23], s54 offen offset:2048 lds
s_add_u32 s54, s54, 196608
s_waitcnt vmcnt(12) lgkmcnt(0)
s_barrier
ds_read_b128 a[0:3], v23
RD 4,23,2304
RD 8,23,4608
RD 12,23,6912
ds_read_b128 a[16:19], v24
ds_read_b128 a[20:23], v30
RD 24,30,2304
RD 28,30,4608
RD 32,30,6912
ds_read_b128 a[36:39], v31
TR 80,25,49664
TR 82,25,50176
TR 84,25,62080
TR 86,25,62592
TR 88,25,50688
TR 90,25,51200
TR 92,25,63104
TR 94,25,63616
TR 96,25,51712
TR 98,25,52224
TR 100,25,64128
TR 102,25,64640
s_waitcnt vmcnt(3) lgkmcnt(0)
s_barrier
v_mfma_f32_16x16x32_bf16 v[60:63], a[80:83], a[0:3], 0
TR 104,25,49696
s_add_u32 m0, s56, 86400
MAA 60,84,20
buffer_load_dwordx4 v18, s[20:23], s54 offen lds
v_mfma_f32_16x16x32_bf16 v[64:67], a[80:83], a[4:7], 0
s_sub_u32 s47, s47, 1
s_cbranch_scc1 .Lx4
.Lx4b:
MAA 64,84,24
buffer_load_dwordx4 v19, s[20:23], s54 offen offset:1024 lds
v_mfma_f32_16x16x32_bf16 v[68:71], a[80:83], a[8:11], 0
TR 106,25,50208
MAA 68,84,28
TR 108,25,62112
TR 110,25,62624
v_mfma_f32_16x16x32_bf16 v[72:75], a[80:83], a[12:15], 0
TR 112,25,50720
MAA 72,84,32
TR 114,25,51232
v_mfma_f32_16x16x32_bf16 v[244:247], a[80:83], a[16:19], 0
TR 116,25,63136
MAA 244,84,36
buffer_load_dwordx4 v20, s[20:23], s54 offen offset:2048 lds
v_mfma_f32_16x16x32_bf16 v[156:159], a[88:91], a[16:19], 0
s_add_u32 s54, s54, 196608
s_add_u32 m0, s55, 36992
MAA 156,92,36
buffer_load_dwordx4 v21, s[36:39], s52 offen lds
v_mfma_f32_16x16x32_bf16 v[104:107], a[88:91], a[12:15], 0
TR 118,25,63648
MAA 104,92,32
buffer_load_dwordx4 v28, s[36:39], s52 offen offset:1024 lds
v_mfma_f32_16x16x32_bf16 v[100:103], a[88:91], a[8:11], 0
TR 120,25,51744
MAA 100,92,28
buffer_load_dword v22, s[36:39], s52 offen offset:2048 lds
v_mfma_f32_16x16x32_bf16 v[96:99], a[88:91], a[4:7], 0
s_add_u32 s52, s52, 128
MAA 96,92,24
TR 122,25,52256
TR 124,25,64160
v_mfma_f32_16x16x32_bf16 v[92:95], a[88:91], a[0:3], 0
TR 126,25,64672
s_add_u32 m0, s55, 39296
MAA 92,92,20
buffer_load_dwordx4 v21, s[36:39], s53 offen lds
v_mfma_f32_16x16x32_bf16 v[124:127], a[0:3], a[96:99], 0
.Lpad1:
s_cbranch_execz .Lpad5
RD 40,23,18496
MAA 124,20,100
buffer_load_dwordx4 v28, s[36:39], s53 offen offset:1024 lds
v_mfma_f32_16x16x32_bf16 v[128:131], a[4:7], a[96:99], 0
RD 44,23,20800
MAA 128,24,100
RD 48,23,23104
RD 52,23,25408
v_mfma_f32_16x16x32_bf16 v[132:135], a[8:11], a[96:99], 0
RD 56,24,18496
MAA 132,28,100
buffer_load_dword v29, s[36:39], s53 offen offset:2048 lds
v_mfma_f32_16x16x32_bf16 v[136:139], a[12:15], a[96:99], 0
s_add_u32 s53, s53, 128
MAA 136,32,100
s_waitcnt vmcnt(6) lgkmcnt(5)
s_barrier
v_mfma_f32_16x16x32_bf16 v[76:79], a[104:107], a[0:3], 0
RD 60,30,18496
s_add_u32 m0, s56, 98816
MAA 76,108,20
buffer_load_dwordx4 v18, s[20:23], s54 offen lds
v_mfma_f32_16x16x32_bf16 v[80:83], a[104:107], a[4:7], 0
RD 64,30,20800
MAA 80,108,24
buffer_load_dwordx4 v19, s[20:23], s54 offen offset:1024 lds
v_mfma_f32_16x16x32_bf16 v[84:87], a[104:107], a[8:11], 0
RD 68,30,23104
MAA 84,108,28
RD 72,30,25408
RD 76,31,18496
v_mfma_f32_16x16x32_bf16 v[88:91], a[104:107], a[12:15], 0
ds_read_b64_tr_b16 a[80:81], v25
MAA 88,108,32
buffer_load_dwordx4 v20, s[20:23], s54 offen offset:2048 lds
v_mfma_f32_16x16x32_bf16 v[160:163], a[112:115], a[16:19], 0
s_add_u32 s54, s54, 196608
s_add_u32 m0, s56, 111232
MAA 160,116,36
buffer_load_dwordx4 v18, s[20:23], s54 offen lds
v_mfma_f32_16x16x32_bf16 v[120:123], a[112:115], a[12:15], 0
TR 82,25,512
MAA 120,116,32
buffer_load_dwordx4 v19, s[20:23], s54 offen offset:1024 lds
v_mfma_f32_16x16x32_bf16 v[116:119], a[112:115], a[8:11], 0
TR 84,25,12416
MAA 116,116,28
TR 86,25,12928
TR 88,25,1024
v_mfma_f32_16x16x32_bf16 v[112:115], a[112:115], a[4:7], 0
TR 90,25,1536
MAA 112,116,24
buffer_load_dwordx4 v20, s[20:23], s54 offen offset:2048 lds
v_mfma_f32_16x16x32_bf16 v[108:111], a[112:115], a[0:3], 0
s_add_u32 s54, s54, 196608
s_add_u32 m0, s55, 55488
MAA 108,116,20
buffer_load_dwordx4 v21, s[36:39], s52 offen lds
v_mfma_f32_16x16x32_bf16 v[140:143], a[0:3], a[120:123], 0
TR 92,25,13440
MAA 140,20,124
buffer_load_dwordx4 v28, s[36:39], s52 offen offset:1024 lds
v_mfma_f32_16x16x32_bf16 v[144:147], a[4:7], a[120:123], 0
TR 94,25,13952
MAA 144,24,124
TR 96,25,2048
TR 98,25,2560
v_mfma_f32_16x16x32_bf16 v[148:151], a[8:11], a[120:123], 0
TR 100,25,14464
MAA 148,28,124
buffer_load_dword v22, s[36:39], s52 offen offset:2048 lds
v_mfma_f32_16x16x32_bf16 v[152:155], a[12:15], a[120:123], 0
TR 102,25,14976
s_add_u32 s52, s52, 128
MAA 152,32,124
s_waitcnt vmcnt(9) lgkmcnt(8)
s_barrier
MAA 60,80,40
TR 104,25,32
s_add_u32 m0, s55, 57792
MAA 60,84,60
buffer_load_dwordx4 v21, s[36:39], s53 offen lds
MAA 64,84,64
s_sub_u32 s47, s47, 1
s_cbranch_scc1 .Lx5
.Lx5b:
MAA 64,80,44
buffer_load_dwordx4 v28, s[36:39], s53 offen offset:1024 lds
MAA 68,80,48
TR 106,25,544
MAA 68,84,68
TR 108,25,12448
TR 110,25,12960
MAA 72,84,72
TR 112,25,1056
MAA 72,80,52
TR 114,25,1568
s_waitcnt lgkmcnt(6)
MAA 244,80,56
TR 116,25,13472
MAA 244,84,76
buffer_load_dword v29, s[36:39], s53 offen offset:2048 lds
MAA 156,92,76
s_add_u32 s53, s53, 128
s_add_u32 m0, s56, 123648
MAA 156,88,56
buffer_load_dwordx4 v18, s[20:23], s54 offen lds
MAA 104,88,52
TR 118,25,13984
MAA 104,92,72
buffer_load_dwordx4 v19, s[20:23], s54 offen offset:1024 lds
MAA 100,92,68
TR 120,25,2080
MAA 100,88,48
buffer_load_dwordx4 v20, s[20:23], s54 offen offset:2048 lds
MAA 96,88,44
s_add_u32 s54, s54, 196608
MAA 96,92,64
TR 122,25,2592
TR 124,25,14496
MAA 92,92,60
TR 126,25,15008
s_add_u32 m0, s56, 136064
MAA 92,88,40
buffer_load_dwordx4 v18, s[20:23], s54 offen lds
MAA 124,40,96
RD 0,23,36992
MAA 124,60,100
buffer_load_dwordx4 v19, s[20:23], s54 offen offset:1024 lds
MAA 128,64,100
RD 4,23,39296
MAA 128,44,96
RD 8,23,41600
RD 12,23,43904
MAA 132,48,96
RD 16,24,36992
MAA 132,68,100
buffer_load_dwordx4 v20, s[20:23], s54 offen offset:2048 lds
MAA 136,72,100
s_add_u32 s54, s54, 196608
MAA 136,52,96
s_waitcnt vmcnt(12) lgkmcnt(5)
s_barrier
MAA 76,104,40
RD 20,30,36992
s_add_u32 m0, s55, 0
MAA 76,108,60
buffer_load_dwordx4 v21, s[36:39], s52 offen lds
MAA 80,108,64
RD 24,30,39296
MAA 80,104,44
buffer_load_dwordx4 v28, s[36:39], s52 offen offset:1024 lds
MAA 84,104,48
RD 28,30,41600
MAA 84,108,68
buffer_load_dword v22, s[36:39], s52 offen offset:2048 lds
MAA 88,108,72
RD 32,30,43904
s_add_u32 s52, s52, 128
MAA 88,104,52
RD 36,31,36992
TR 80,25,24832
TR 82,25,25344
MAA 160,112,56
TR 84,25,37248
s_add_u32 m0, s55, 2304
MAA 160,116,76
buffer_load_dwordx4 v21, s[36:39], s53 offen lds
MAA 120,116,72
TR 86,25,37760
MAA 120,112,52
buffer_load_dwordx4 v28, s[36:39], s53 offen offset:1024 lds
MAA 116,112,48
TR 88,25,25856
MAA 116,116,68
buffer_load_dword v29, s[36:39], s53 offen offset:2048 lds
MAA 112,116,64
s_add_u32 s53, s53, 128
s_add_u32 m0, s56, 73984
MAA 112,112,44
buffer_load_dwordx4 v18, s[20:23], s54 offen lds
MAA 108,112,40
TR 90,25,26368
MAA 108,116,60
buffer_load_dwordx4 v19, s[20:23], s54 offen offset:1024 lds
MAA 140,60,124
TR 92,25,38272
MAA 140,40,120
TR 94,25,38784
TR 96,25,26880
TR 98,25,27392
MAA 144,44,120
TR 100,25,39296
MAA 144,64,124
buffer_load_dwordx4 v20, s[20:23], s54 offen offset:2048 lds
MAA 148,68,124
TR 102,25,39808
s_add_u32 s54, s54, 196608
MAA 148,48,120
buffer_load_dword v37, v34, s[40:43], 0 offen sc1
MAA 152,52,120
MAA 152,72,124
s_waitcnt vmcnt(16) lgkmcnt(8)
s_barrier
MAA 60,80,0
TR 104,25,24864
s_add_u32 m0, s56, 86400
MAA 60,84,20
buffer_load_dwordx4 v18, s[20:23], s54 offen lds
MAA 64,84,24
s_sub_u32 s47, s47, 1
s_cbranch_scc1 .Lx6
.Lx6b:
MAA 64,80,4
buffer_load_dwordx4 v19, s[20:23], s54 offen offset:1024 lds
MAA 68,80,8
TR 106,25,25376
MAA 68,84,28
TR 108,25,37280
TR 110,25,37792
MAA 72,84,32
TR 112,25,25888
MAA 72,80,12
TR 114,25,26400
s_waitcnt lgkmcnt(6)
MAA 244,80,16
TR 116,25,38304
MAA 244,84,36
buffer_load_dwordx4 v20, s[20:23], s54 offen offset:2048 lds
MAA 156,92,36
s_add_u32 s54, s54, 196608
s_add_u32 m0, s55, 18496
MAA 156,88,16
buffer_load_dwordx4 v21, s[36:39], s52 offen lds
MAA 104,88,12
TR 118,25,38816
MAA 104,92,32
buffer_load_dwordx4 v28, s[36:39], s52 offen offset:1024 lds
MAA 100,92,28
TR 120,25,26912
MAA 100,88,8
buffer_load_dword v22, s[36:39], s52 offen offset:2048 lds
MAA 96,88,4
s_add_u32 s52, s52, 128
MAA 96,92,24
TR 122,25,27424
TR 124,25,39328
MAA 92,92,20
TR 126,25,39840
s_add_u32 m0, s55, 20800
MAA 92,88,0
buffer_load_dwordx4 v21, s[36:39], s53 offen lds
MAA 124,0,96
RD 40,23,55488
MAA 124,20,100
buffer_load_dwordx4 v28, s[36:39], s53 offen offset:1024 lds
MAA 128,24,100
RD 44,23,57792
MAA 128,4,96
RD 48,23,60096
RD 52,23,62400
MAA 132,8,96
RD 56,24,55488
MAA 132,28,100
buffer_load_dword v29, s[36:39], s53 offen offset:2048 lds
MAA 136,32,100
s_add_u32 s53, s53, 128
MAA 136,12,96
s_waitcnt vmcnt(19) lgkmcnt(5)
s_barrier
MAA 76,104,0
RD 60,30,55488
s_add_u32 m0, s56, 98816
MAA 76,108,20
buffer_load_dwordx4 v18, s[20:23], s54 offen lds
MAA 80,108,24
RD 64,30,57792
MAA 80,104,4
buffer_load_dwordx4 v19, s[20:23], s54 offen offset:1024 lds
MAA 84,104,8
RD 68,30,60096
MAA 84,108,28
RD 72,30,62400
RD 76,31,55488
MAA 88,108,32
TR 80,25,49664
MAA 88,104,12
buffer_load_dwordx4 v20, s[20:23], s54 offen offset:2048 lds
MAA 160,112,16
s_add_u32 s54, s54, 196608
s_add_u32 m0, s55, 36992
MAA 160,116,36
buffer_load_dwordx4 v21, s[36:39], s52 offen lds
MAA 120,116,32
TR 82,25,50176
MAA 120,112,12
buffer_load_dwordx4 v28, s[36:39], s52 offen offset:1024 lds
MAA 116,112,8
TR 84,25,62080
MAA 116,116,28
TR 86,25,62592
TR 88,25,50688
MAA 112,116,24
TR 90,25,51200
MAA 112,112,4
buffer_load_dword v22, s[36:39], s52 offen offset:2048 lds
MAA 108,112,0
s_add_u32 s52, s52, 128
s_add_u32 m0, s55, 39296
MAA 108,116,20
buffer_load_dwordx4 v21, s[36:39], s53 offen lds
MAA 140,20,124
TR 92,25,63104
MAA 140,0,120
buffer_load_dwordx4 v28, s[36:39], s53 offen offset:1024 lds
MAA 144,4,120
TR 94,25,63616
MAA 144,24,124
TR 96,25,51712
TR 98,25,52224
MAA 148,28,124
TR 100,25,64128
MAA 148,8,120
buffer_load_dword v29, s[36:39], s53 offen offset:2048 lds
MAA 152,12,120
TR 102,25,64640
s_add_u32 s53, s53, 128
MAA 152,32,124
s_waitcnt vmcnt(22) lgkmcnt(8)
s_barrier
MAA 60,80,40
TR 104,25,49696
s_add_u32 m0, s56, 111232
MAA 60,84,60
buffer_load_dwordx4 v18, s[20:23], s54 offen lds
MAA 64,84,64
s_sub_u32 s47, s47, 1
s_cbranch_scc1 .Lx7
.Lx7b:
MAA 64,80,44
TR 106,25,50208
MAA 68,80,48
TR 108,25,62112
MAA 68,84,68
buffer_load_dwordx4 v19, s[20:23], s54 offen offset:1024 lds
MAA 72,84,72
TR 110,25,62624
MAA 72,80,52
TR 112,25,50720
s_waitcnt lgkmcnt(5)
MAA 244,80,56
TR 114,25,51232
MAA 244,84,76
buffer_load_dwordx4 v20, s[20:23], s54 offen offset:2048 lds
MAA 156,92,76
s_add_u32 s54, s54, 196608
MAA 156,88,56
TR 116,25,63136
MAA 104,88,52
TR 118,25,63648
MAA 104,92,72
TR 120,25,51744
MAA 100,92,68
TR 122,25,52256
s_add_u32 m0, s55, 55488
MAA 100,88,48
buffer_load_dwordx4 v21, s[36:39], s52 offen lds
MAA 96,88,44
TR 124,25,64160
MAA 96,92,64
TR 126,25,64672
MAA 92,92,60
MAA 92,88,40
buffer_load_dwordx4 v28, s[36:39], s52 offen offset:1024 lds
MAA 124,40,96
ds_read_b128 a[0:3], v23
MAA 124,60,100
RD 4,23,2304
MAA 128,64,100
RD 8,23,4608
MAA 128,44,96
buffer_load_dword v22, s[36:39], s52 offen offset:2048 lds
MAA 132,48,96
RD 12,23,6912
s_add_u32 s52, s52, 128
MAA 132,68,100
ds_read_b128 a[16:19], v24
MAA 136,72,100
MAA 136,52,96
s_waitcnt vmcnt(21) lgkmcnt(5)
s_barrier
v_cmp_gt_u32 vcc, v35, v37
s_nop 0
s_cbranch_vccnz .Lsp8
.Lsp8b:
v_mov_b32 v37, 0
MAA 76,104,40
ds_read_b128 a[20:23], v30
MAA 76,108,60
buffer_atomic_add v38, v32, s[16:19], 0 offen
MAA 80,108,64
RD 24,30,2304
MAA 80,104,44
RD 28,30,4608
MAA 84,104,48
RD 32,30,6912
s_add_u32 m0, s56, 123648
MAA 84,108,68
buffer_load_dwordx4 v18, s[20:23], s54 offen lds
MAA 88,108,72
ds_read_b128 a[36:39], v31
MAA 88,104,52
buffer_load_dwordx4 v19, s[20:23], s54 offen offset:1024 lds
MAA 160,112,56
ds_read_b64_tr_b16 a[80:81], v25
MAA 160,116,76
TR 82,25,512
MAA 120,116,72
TR 84,25,12416
MAA 120,112,52
buffer_load_dwordx4 v20, s[20:23], s54 offen offset:2048 lds
MAA 116,112,48
TR 86,25,12928
s_add_u32 s54, s54, 196608
MAA 116,116,68
TR 88,25,1024
MAA 112,116,64
TR 90,25,1536
s_add_u32 m0, s55, 57792
MAA 112,112,44
buffer_load_dwordx4 v21, s[36:39], s53 offen lds
MAA 108,112,40
TR 92,25,13440
MAA 108,116,60
TR 94,25,13952
MAA 140,60,124
TR 96,25,2048
MAA 140,40,120
buffer_load_dwordx4 v28, s[36:39], s53 offen offset:1024 lds
MAA 144,44,120
TR 98,25,2560
MAA 144,64,124
buffer_load_dword v29, s[36:39], s53 offen offset:2048 lds
MAA 148,68,124
TR 100,25,14464
s_add_u32 s53, s53, 128
MAA 148,48,120
TR 102,25,14976
MAA 152,52,120
MAA 152,72,124
s_waitcnt vmcnt(22) lgkmcnt(8)
s_barrier
MAA 60,80,0
TR 104,25,32
s_add_u32 m0, s56, 136064
MAA 60,84,20
buffer_load_dwordx4 v18, s[20:23], s54 offen lds
MAA 64,84,24
s_sub_u32 s47, s47, 1
s_cbranch_scc1 .Lx9
.Lx9b:
MAA 64,80,4
TR 106,25,544
MAA 68,80,8
TR 108,25,12448
MAA 68,84,28
buffer_load_dwordx4 v19, s[20:23], s54 offen offset:1024 lds
MAA 72,84,32
TR 110,25,12960
MAA 72,80,12
TR 112,25,1056
s_waitcnt lgkmcnt(5)
MAA 244,80,16
TR 114,25,1568
MAA 244,84,36
buffer_load_dwordx4 v20, s[20:23], s54 offen offset:2048 lds
MAA 156,92,36
s_add_u32 s54, s54, 196608
MAA 156,88,16
TR 116,25,13472
MAA 104,88,12
TR 118,25,13984
MAA 104,92,32
TR 120,25,2080
MAA 100,92,28
TR 122,25,2592
s_add_u32 m0, s55, 0
MAA 100,88,8
buffer_load_dwordx4 v21, s[36:39], s52 offen lds
MAA 96,88,4
TR 124,25,14496
MAA 96,92,24
TR 126,25,15008
MAA 92,92,20
MAA 92,88,0
buffer_load_dwordx4 v28, s[36:39], s52 offen offset:1024 lds
MAA 124,0,96
RD 40,23,18496
MAA 124,20,100
RD 44,23,20800
MAA 128,24,100
RD 48,23,23104
MAA 128,4,96
buffer_load_dword v22, s[36:39], s52 offen offset:2048 lds
MAA 132,8,96
RD 52,23,25408
s_add_u32 s52, s52, 128
MAA 132,28,100
RD 56,24,18496
MAA 136,32,100
MAA 136,12,96
s_waitcnt vmcnt(16) lgkmcnt(5)
s_barrier
MAA 76,104,0
RD 60,30,18496
s_add_u32 m0, s56, 73984
MAA 76,108,20
buffer_load_dwordx4 v18, s[20:23], s54 offen lds
MAA 80,108,24
RD 64,30,20800
MAA 80,104,4
RD 68,30,23104
MAA 84,104,8
RD 72,30,25408
MAA 84,108,28
buffer_load_dwordx4 v19, s[20:23], s54 offen offset:1024 lds
MAA 88,108,32
RD 76,31,18496
MAA 88,104,12
TR 80,25,24832
MAA 160,112,16
TR 82,25,25344
MAA 160,116,36
buffer_load_dwordx4 v20, s[20:23], s54 offen offset:2048 lds
.Lpad2:
s_cbranch_execz .Lpad6
MAA 120,116,32
TR 84,25,37248
s_add_u32 s54, s54, 196608
MAA 120,112,12
TR 86,25,37760
MAA 116,112,8
s_add_u32 m0, s55, 2304
MAA 116,116,28
buffer_load_dwordx4 v21, s[36:39], s53 offen lds
MAA 112,116,24
TR 88,25,25856
MAA 112,112,4
TR 90,25,26368
MAA 108,112,0
TR 92,25,38272
MAA 108,116,20
buffer_load_dwordx4 v28, s[36:39], s53 offen offset:1024 lds
MAA 140,20,124
TR 94,25,38784
MAA 140,0,120
TR 96,25,26880
MAA 144,4,120
TR 98,25,27392
MAA 144,24,124
buffer_load_dword v29, s[36:39], s53 offen offset:2048 lds
MAA 148,28,124
TR 100,25,39296
s_add_u32 s53, s53, 128
MAA 148,8,120
TR 102,25,39808
MAA 152,12,120
MAA 152,32,124
s_waitcnt lgkmcnt(8)
s_barrier
MAA 60,80,40
TR 104,25,24864
s_add_u32 m0, s56, 86400
MAA 60,84,60
buffer_load_dwordx4 v18, s[20:23], s54 offen lds
MAA 64,84,64
s_sub_u32 s47, s47, 1
s_cbranch_scc1 .Lx10
.Lx10b:
MAA 64,80,44
TR 106,25,25376
MAA 68,80,48
TR 108,25,37280
MAA 68,84,68
buffer_load_dwordx4 v19, s[20:23], s54 offen offset:1024 lds
MAA 72,84,72
TR 110,25,37792
MAA 72,80,52
TR 112,25,25888
s_waitcnt lgkmcnt(5)
MAA 244,80,56
TR 114,25,26400
MAA 244,84,76
buffer_load_dwordx4 v20, s[20:23], s54 offen offset:2048 lds
MAA 156,92,76
s_add_u32 s54, s54, 196608
MAA 156,88,56
TR 116,25,38304
MAA 104,88,52
TR 118,25,38816
MAA 104,92,72
TR 120,25,26912
MAA 100,92,68
TR 122,25,27424
s_add_u32 m0, s55, 18496
MAA 100,88,48
buffer_load_dwordx4 v21, s[36:39], s52 offen lds
MAA 96,88,44
TR 124,25,39328
MAA 96,92,64
TR 126,25,39840
MAA 92,92,60
MAA 92,88,40
buffer_load_dwordx4 v28, s[36:39], s52 offen offset:1024 lds
MAA 124,40,96
RD 0,23,36992
MAA 124,60,100
RD 4,23,39296
MAA 128,64,100
RD 8,23,41600
MAA 128,44,96
buffer_load_dword v22, s[36:39], s52 offen offset:2048 lds
MAA 132,48,96
RD 12,23,43904
s_add_u32 s52, s52, 128
MAA 132,68,100
RD 16,24,36992
MAA 136,72,100
MAA 136,52,96
s_waitcnt vmcnt(15) lgkmcnt(5)
s_barrier
MAA 76,104,40
RD 20,30,36992
s_add_u32 m0, s56, 98816
MAA 76,108,60
buffer_load_dwordx4 v18, s[20:23], s54 offen lds
MAA 80,108,64
RD 24,30,39296
MAA 80,104,44
RD 28,30,41600
MAA 84,104,48
RD 32,30,43904
MAA 84,108,68
buffer_load_dwordx4 v19, s[20:23], s54 offen offset:1024 lds
MAA 88,108,72
RD 36,31,36992
MAA 88,104,52
buffer_load_dwordx4 v20, s[20:23], s54 offen offset:2048 lds
MAA 160,112,56
TR 80,25,49664
s_add_u32 s54, s54, 196608
MAA 160,116,76
TR 82,25,50176
MAA 120,116,72
TR 84,25,62080
s_add_u32 m0, s55, 20800
MAA 120,112,52
buffer_load_dwordx4 v21, s[36:39], s53 offen lds
MAA 116,112,48
TR 86,25,62592
MAA 116,116,68
TR 88,25,50688
MAA 112,116,64
TR 90,25,51200
MAA 112,112,44
buffer_load_dwordx4 v28, s[36:39], s53 offen offset:1024 lds
MAA 108,112,40
TR 92,25,63104
MAA 108,116,60
TR 94,25,63616
MAA 140,60,124
TR 96,25,51712
MAA 140,40,120
buffer_load_dword v29, s[36:39], s53 offen offset:2048 lds
MAA 144,44,120
TR 98,25,52224
s_add_u32 s53, s53, 128
MAA 144,64,124
buffer_atomic_add v37, v33, s[16:19], 0 offen sc0
MAA 148,68,124
TR 100,25,64128
MAA 148,48,120
TR 102,25,64640
MAA 152,52,120
MAA 152,72,124
s_waitcnt lgkmcnt(8)
s_barrier
MAA 60,80,0
TR 104,25,49696
s_add_u32 m0, s56, 111232
MAA 60,84,20
buffer_load_dwordx4 v18, s[20:23], s54 offen lds
MAA 64,84,24
s_sub_u32 s47, s47, 1
s_cbranch_scc1 .Lx11
.Lx11b:
MAA 64,80,4
TR 106,25,50208
MAA 68,80,8
TR 108,25,62112
MAA 68,84,28
buffer_load_dwordx4 v19, s[20:23], s54 offen offset:1024 lds
MAA 72,84,32
TR 110,25,62624
MAA 72,80,12
TR 112,25,50720
s_waitcnt lgkmcnt(5)
MAA 244,80,16
TR 114,25,51232
MAA 244,84,36
buffer_load_dwordx4 v20, s[20:23], s54 offen offset:2048 lds
MAA 156,92,36
s_add_u32 s54, s54, 196608
MAA 156,88,16
TR 116,25,63136
MAA 104,88,12
TR 118,25,63648
MAA 104,92,32
TR 120,25,51744
MAA 100,92,28
TR 122,25,52256
s_add_u32 m0, s55, 36992
MAA 100,88,8
buffer_load_dwordx4 v21, s[36:39], s52 offen lds
MAA 96,88,4
TR 124,25,64160
MAA 96,92,24
TR 126,25,64672
MAA 92,92,20
MAA 92,88,0
buffer_load_dwordx4 v28, s[36:39], s52 offen offset:1024 lds
MAA 124,0,96
RD 40,23,55488
MAA 124,20,100
RD 44,23,57792
MAA 128,24,100
RD 48,23,60096
MAA 128,4,96
buffer_load_dword v22, s[36:39], s52 offen offset:2048 lds
MAA 132,8,96
RD 52,23,62400
s_add_u32 s52, s52, 128
MAA 132,28,100
RD 56,24,55488
MAA 136,32,100
MAA 136,12,96
s_waitcnt vmcnt(16) lgkmcnt(5)
s_barrier
MAA 76,104,0
RD 60,30,55488
s_add_u32 m0, s56, 123648
MAA 76,108,20
buffer_load_dwordx4 v18, s[20:23], s54 offen lds
MAA 80,108,24
RD 64,30,57792
MAA 80,104,4
RD 68,30,60096
MAA 84,104,8
RD 72,30,62400
MAA 84,108,28
buffer_load_dwordx4 v19, s[20:23], s54 offen offset:1024 lds
MAA 88,108,32
RD 76,31,55488
MAA 88,104,12
ds_read_b64_tr_b16 a[80:81], v25
MAA 160,112,16
TR 82,25,512
MAA 160,116,36
buffer_load_dwordx4 v20, s[20:23], s54 offen offset:2048 lds
MAA 120,116,32
TR 84,25,12416
s_add_u32 s54, s54, 196608
MAA 120,112,12
TR 86,25,12928
MAA 116,112,8
s_add_u32 m0, s55, 39296
MAA 116,116,28
buffer_load_dwordx4 v21, s[36:39], s53 offen lds
MAA 112,116,24
TR 88,25,1024
MAA 112,112,4
TR 90,25,1536
MAA 108,112,0
TR 92,25,13440
MAA 108,116,20
buffer_load_dwordx4 v28, s[36:39], s53 offen offset:1024 lds
MAA 140,20,124
TR 94,25,13952
MAA 140,0,120
TR 96,25,2048
MAA 144,4,120
TR 98,25,2560
MAA 144,24,124
buffer_load_dword v29, s[36:39], s53 offen offset:2048 lds
MAA 148,28,124
TR 100,25,14464
s_add_u32 s53, s53, 128
MAA 148,8,120
TR 102,25,14976
MAA 152,12,120
MAA 152,32,124
s_waitcnt lgkmcnt(8)
s_barrier
MAA 60,80,40
TR 104,25,32
s_add_u32 m0, s56, 136064
MAA 60,84,60
buffer_load_dwordx4 v18, s[20:23], s54 offen lds
MAA 64,84,64
s_sub_u32 s47, s47, 1
s_cbranch_scc1 .Lx12
.Lx12b:
MAA 64,80,44
TR 106,25,544
MAA 68,80,48
TR 108,25,12448
MAA 68,84,68
buffer_load_dwordx4 v19, s[20:23], s54 offen offset:1024 lds
MAA 72,84,72
TR 110,25,12960
MAA 72,80,52
TR 112,25,1056
s_waitcnt lgkmcnt(5)
MAA 244,80,56
TR 114,25,1568
MAA 244,84,76
buffer_load_dwordx4 v20, s[20:23], s54 offen offset:2048 lds
MAA 156,92,76
s_add_u32 s54, s54, 196608
MAA 156,88,56
TR 116,25,13472
MAA 104,88,52
TR 118,25,13984
MAA 104,92,72
TR 120,25,2080
MAA 100,92,68
TR 122,25,2592
s_add_u32 m0, s55, 55488
MAA 100,88,48
buffer_load_dwordx4 v21, s[36:39], s52 offen lds
MAA 96,88,44
TR 124,25,14496
MAA 96,92,64
TR 126,25,15008
MAA 92,92,60
MAA 92,88,40
buffer_load_dwordx4 v28, s[36:39], s52 offen offset:1024 lds
MAA 124,40,96
ds_read_b128 a[0:3], v23
MAA 124,60,100
RD 4,23,2304
MAA 128,64,100
RD 8,23,4608
MAA 128,44,96
buffer_load_dword v22, s[36:39], s52 offen offset:2048 lds
MAA 132,48,96
RD 12,23,6912
s_add_u32 s52, s52, 128
MAA 132,68,100
ds_read_b128 a[16:19], v24
MAA 136,72,100
MAA 136,52,96
s_waitcnt vmcnt(18)
v_cmp_gt_u32 vcc, v36, v37
s_nop 0
s_cbranch_vccnz .Lsp13
.Lsp13b:
s_waitcnt vmcnt(15) lgkmcnt(5)
s_barrier
MAA 76,104,40
ds_read_b128 a[20:23], v30
s_add_u32 m0, s56, 73984
MAA 76,108,60
buffer_load_dwordx4 v18, s[20:23], s54 offen lds
MAA 80,108,64
RD 24,30,2304
MAA 80,104,44
RD 28,30,4608
MAA 84,104,48
RD 32,30,6912
MAA 84,108,68
buffer_load_dwordx4 v19, s[20:23], s54 offen offset:1024 lds
MAA 88,108,72
ds_read_b128 a[36:39], v31
MAA 88,104,52
buffer_load_dwordx4 v20, s[20:23], s54 offen offset:2048 lds
MAA 160,112,56
TR 80,25,24832
s_add_u32 s54, s54, 196608
MAA 160,116,76
TR 82,25,25344
MAA 120,116,72
TR 84,25,37248
s_add_u32 m0, s55, 57792
MAA 120,112,52
buffer_load_dwordx4 v21, s[36:39], s53 offen lds
MAA 116,112,48
TR 86,25,37760
MAA 116,116,68
TR 88,25,25856
MAA 112,116,64
TR 90,25,26368
MAA 112,112,44
buffer_load_dwordx4 v28, s[36:39], s53 offen offset:1024 lds
MAA 108,112,40
TR 92,25,38272
MAA 108,116,60
TR 94,25,38784
MAA 140,60,124
TR 96,25,26880
MAA 140,40,120
buffer_load_dword v29, s[36:39], s53 offen offset:2048 lds
MAA 144,44,120
TR 98,25,27392
s_add_u32 s53, s53, 128
MAA 144,64,124
buffer_load_dwordx4 v[164:167], v26, s[16:19], s75 offen sc1
MAA 148,68,124
TR 100,25,39296
MAA 148,48,120
TR 102,25,39808
MAA 152,52,120
MAA 152,72,124
s_waitcnt lgkmcnt(8)
s_barrier
MAA 60,80,0
TR 104,25,24864
s_add_u32 m0, s56, 86400
MAA 60,84,20
buffer_load_dwordx4 v18, s[20:23], s54 offen lds
MAA 64,84,24
s_sub_u32 s47, s47, 1
s_cbranch_scc1 .Lx14
.Lx14b:
MAA 64,80,4
TR 106,25,25376
MAA 68,80,8
TR 108,25,37280
MAA 68,84,28
buffer_load_dwordx4 v19, s[20:23], s54 offen offset:1024 lds
MAA 72,84,32
TR 110,25,37792
MAA 72,80,12
TR 112,25,25888
s_waitcnt lgkmcnt(5)
MAA 244,80,16
TR 114,25,26400
MAA 244,84,36
buffer_load_dwordx4 v20, s[20:23], s54 offen offset:2048 lds
MAA 156,92,36
TR 116,25,38304
s_add_u32 s54, s54, 196608
MAA 156,88,16
TR 118,25,38816
MAA 104,88,12
TR 120,25,26912
s_add_u32 m0, s55, 0
MAA 104,92,32
buffer_load_dwordx4 v21, s[36:39], s52 offen lds
MAA 100,92,28
MAA 100,88,8
buffer_load_dwordx4 v28, s[36:39], s52 offen offset:1024 lds
MAA 96,88,4
TR 122,25,27424
MAA 96,92,24
TR 124,25,39328
MAA 92,92,20
TR 126,25,39840
MAA 92,88,0
buffer_load_dword v22, s[36:39], s52 offen offset:2048 lds
MAA 124,0,96
RD 40,23,18496
s_add_u32 s52, s52, 128
MAA 124,20,100
RD 44,23,20800
MAA 128,24,100
RD 48,23,23104
MAA 128,4,96
buffer_load_dwordx4 v[168:171], v26, s[16:19], s75 offen offset:1024 sc1
MAA 132,8,96
RD 52,23,25408
MAA 132,28,100
RD 56,24,18496
MAA 136,32,100
MAA 136,12,96
s_waitcnt vmcnt(17) lgkmcnt(5)
s_barrier
MAA 76,104,0
RD 60,30,18496
s_add_u32 m0, s56, 98816
MAA 76,108,20
buffer_load_dwordx4 v18, s[20:23], s54 offen lds
MAA 80,108,24
RD 64,30,20800
MAA 80,104,4
RD 68,30,23104
MAA 84,104,8
RD 72,30,25408
MAA 84,108,28
buffer_load_dwordx4 v19, s[20:23], s54 offen offset:1024 lds
MAA 88,108,32
RD 76,31,18496
MAA 88,104,12
buffer_load_dwordx4 v20, s[20:23], s54 offen offset:2048 lds
MAA 160,112,16
TR 80,25,49664
s_add_u32 s54, s54, 196608
MAA 160,116,36
TR 82,25,50176
MAA 120,116,32
TR 84,25,62080
s_add_u32 m0, s55, 2304
MAA 120,112,12
buffer_load_dwordx4 v21, s[36:39], s53 offen lds
MAA 116,112,8
TR 86,25,62592
MAA 116,116,28
TR 88,25,50688
MAA 112,116,24
TR 90,25,51200
MAA 112,112,4
buffer_load_dwordx4 v28, s[36:39], s53 offen offset:1024 lds
MAA 108,112,0
TR 92,25,63104
MAA 108,116,20
TR 94,25,63616
MAA 140,20,124
TR 96,25,51712
MAA 140,0,120
buffer_load_dword v29, s[36:39], s53 offen offset:2048 lds
MAA 144,4,120
TR 98,25,52224
s_add_u32 s53, s53, 128
MAA 144,24,124
buffer_load_dwordx4 v[172:175], v26, s[16:19], s75 offen offset:2048 sc1
MAA 148,28,124
TR 100,25,64128
MAA 148,8,120
TR 102,25,64640
MAA 152,12,120
MAA 152,32,124
s_waitcnt lgkmcnt(8)
s_barrier
MAA 60,80,40
TR 104,25,49696
s_add_u32 m0, s56, 111232
MAA 60,84,60
buffer_load_dwordx4 v18, s[20:23], s54 offen lds
MAA 64,84,64
s_sub_u32 s47, s47, 1
s_cbranch_scc1 .Lx15
.Lx15b:
MAA 64,80,44
TR 106,25,50208
MAA 68,80,48
TR 108,25,62112
MAA 68,84,68
buffer_load_dwordx4 v19, s[20:23], s54 offen offset:1024 lds
MAA 72,84,72
TR 110,25,62624
MAA 72,80,52
TR 112,25,50720
s_waitcnt lgkmcnt(5)
MAA 244,80,56
TR 114,25,51232
MAA 244,84,76
buffer_load_dwordx4 v20, s[20:23], s54 offen offset:2048 lds
MAA 156,92,76
TR 116,25,63136
s_add_u32 s54, s54, 196608
MAA 156,88,56
TR 118,25,63648
MAA 104,88,52
.Lpad3:
s_cbranch_execz .Lpad7
TR 120,25,51744
s_add_u32 m0, s55, 18496
MAA 104,92,72
buffer_load_dwordx4 v21, s[36:39], s52 offen lds
MAA 100,92,68
MAA 100,88,48
buffer_load_dwordx4 v28, s[36:39], s52 offen offset:1024 lds
MAA 96,88,44
TR 122,25,52256
MAA 96,92,64
TR 124,25,64160
MAA 92,92,60
TR 126,25,64672
MAA 92,88,40
buffer_load_dword v22, s[36:39], s52 offen offset:2048 lds
MAA 124,40,96
RD 0,23,36992
s_add_u32 s52, s52, 128
MAA 124,60,100
RD 4,23,39296
MAA 128,64,100
RD 8,23,41600
MAA 128,44,96
buffer_load_dwordx4 v[176:179], v26, s[16:19], s75 offen offset:3072 sc1
MAA 132,48,96
RD 12,23,43904
s_add_u32 s75, s75, 4096
MAA 132,68,100
RD 16,24,36992
MAA 136,72,100
MAA 136,52,96
s_waitcnt vmcnt(18) lgkmcnt(5)
s_barrier
MAA 76,104,40
RD 20,30,36992
s_add_u32 m0, s56, 123648
MAA 76,108,60
buffer_load_dwordx4 v18, s[20:23], s54 offen lds
MAA 80,108,64
RD 24,30,39296
s_waitcnt vmcnt(15)
v_add_f32 v164, v164, v168
MAA 80,104,44
RD 28,30,41600
MAA 84,104,48
RD 32,30,43904
MAA 84,108,68
buffer_load_dwordx4 v19, s[20:23], s54 offen offset:1024 lds
MAA 88,108,72
RD 36,31,36992
v_add_f32 v165, v165, v169
MAA 88,104,52
buffer_load_dwordx4 v20, s[20:23], s54 offen offset:2048 lds
MAA 160,112,56
ds_read_b64_tr_b16 a[80:81], v25
s_add_u32 s54, s54, 196608
MAA 160,116,76
TR 82,25,512
MAA 120,116,72
TR 84,25,12416
s_add_u32 m0, s55, 20800
MAA 120,112,52
buffer_load_dwordx4 v21, s[36:39], s53 offen lds
MAA 116,112,48
TR 86,25,12928
MAA 116,116,68
TR 88,25,1024
MAA 112,116,64
TR 90,25,1536
v_add_f32 v166, v166, v170
MAA 112,112,44
buffer_load_dwordx4 v28, s[36:39], s53 offen offset:1024 lds
MAA 108,112,40
TR 92,25,13440
MAA 108,116,60
TR 94,25,13952
MAA 140,60,124
TR 96,25,2048
MAA 140,40,120
buffer_load_dword v29, s[36:39], s53 offen offset:2048 lds
MAA 144,44,120
TR 98,25,2560
s_add_u32 s53, s53, 128
MAA 144,64,124
buffer_load_dwordx4 v[180:183], v26, s[16:19], s75 offen sc1
MAA 148,68,124
TR 100,25,14464
v_add_f32 v167, v167, v171
MAA 148,48,120
TR 102,25,14976
MAA 152,52,120
MAA 152,72,124
s_waitcnt lgkmcnt(8)
s_barrier
MAA 60,80,0
TR 104,25,32
s_add_u32 m0, s56, 136064
MAA 60,84,20
buffer_load_dwordx4 v18, s[20:23], s54 offen lds
MAA 64,84,24
s_sub_u32 s47, s47, 1
s_cbranch_scc1 .Lx16
.Lx16b:
MAA 64,80,4
TR 106,25,544
s_waitcnt vmcnt(15)
v_add_f32 v164, v164, v172
MAA 68,80,8
TR 108,25,12448
MAA 68,84,28
buffer_load_dwordx4 v19, s[20:23], s54 offen offset:1024 lds
MAA 72,84,32
TR 110,25,12960
MAA 72,80,12
TR 112,25,1056
s_waitcnt lgkmcnt(5)
MAA 244,80,16
TR 114,25,1568
MAA 244,84,36
buffer_load_dwordx4 v20, s[20:23], s54 offen offset:2048 lds
MAA 156,92,36
TR 116,25,13472
s_add_u32 s54, s54, 196608
MAA 156,88,16
TR 118,25,13984
v_add_f32 v165, v165, v173
MAA 104,88,12
TR 120,25,2080
s_add_u32 m0, s55, 36992
MAA 104,92,32
buffer_load_dwordx4 v21, s[36:39], s52 offen lds
MAA 100,92,28
MAA 100,88,8
buffer_load_dwordx4 v28, s[36:39], s52 offen offset:1024 lds
MAA 96,88,4
TR 122,25,2592
MAA 96,92,24
TR 124,25,14496
v_add_f32 v166, v166, v174
MAA 92,92,20
TR 126,25,15008
MAA 92,88,0
buffer_load_dword v22, s[36:39], s52 offen offset:2048 lds
MAA 124,0,96
RD 40,23,55488
s_add_u32 s52, s52, 128
MAA 124,20,100
RD 44,23,57792
MAA 128,24,100
RD 48,23,60096
MAA 128,4,96
buffer_load_dwordx4 v[184:187], v26, s[16:19], s75 offen offset:1024 sc1
MAA 132,8,96
RD 52,23,62400
v_add_f32 v167, v167, v175
MAA 132,28,100
RD 56,24,55488
MAA 136,32,100
MAA 136,12,96
s_waitcnt vmcnt(18) lgkmcnt(5)
s_barrier
MAA 76,104,0
RD 60,30,55488
s_add_u32 m0, s56, 73984
MAA 76,108,20
buffer_load_dwordx4 v18, s[20:23], s54 offen lds
MAA 80,108,24
RD 64,30,57792
s_waitcnt vmcnt(15)
v_add_f32 v164, v164, v176
MAA 80,104,4
RD 68,30,60096
v_add_f32 v165, v165, v177
MAA 84,104,8
buffer_load_dwordx4 v19, s[20:23], s54 offen offset:1024 lds
MAA 84,108,28
RD 72,30,62400
v_add_f32 v166, v166, v178
MAA 88,108,32
RD 76,31,55488
v_add_f32 v167, v167, v179
MAA 88,104,12
buffer_load_dwordx4 v20, s[20:23], s54 offen offset:2048 lds
MAA 160,112,16
TR 80,25,24832
s_add_u32 s54, s54, 196608
MAA 160,116,36
TR 82,25,25344
s_add_u32 m0, s55, 39296
MAA 120,116,32
buffer_load_dwordx4 v21, s[36:39], s53 offen lds
MAA 120,112,12
TR 84,25,37248
MAA 116,112,8
TR 86,25,37760
MAA 116,116,28
buffer_load_dwordx4 v28, s[36:39], s53 offen offset:1024 lds
MAA 112,116,24
TR 88,25,25856
MAA 112,112,4
TR 90,25,26368
MAA 108,112,0
buffer_load_dword v29, s[36:39], s53 offen offset:2048 lds
MAA 108,116,20
TR 92,25,38272
s_add_u32 s53, s53, 128
MAA 140,20,124
TR 94,25,38784
MAA 140,0,120
buffer_load_dwordx4 v[188:191], v26, s[16:19], s75 offen offset:2048 sc1
MAA 144,4,120
TR 96,25,26880
MAA 144,24,124
TR 98,25,27392
MAA 148,28,124
TR 100,25,39296
MAA 148,8,120
TR 102,25,39808
MAA 152,12,120
MAA 152,32,124
s_waitcnt lgkmcnt(8)
s_barrier
MAA 60,80,40
TR 104,25,24864
s_add_u32 m0, s56, 86400
MAA 60,84,60
buffer_load_dwordx4 v18, s[20:23], s54 offen lds
MAA 64,84,64
s_sub_u32 s47, s47, 1
s_cbranch_scc1 .Lx17
.Lx17b:
MAA 64,80,44
TR 106,25,25376
s_waitcnt vmcnt(15)
v_add_f32 v164, v164, v180
MAA 68,80,48
TR 108,25,37280
MAA 68,84,68
buffer_load_dwordx4 v19, s[20:23], s54 offen offset:1024 lds
MAA 72,84,72
TR 110,25,37792
MAA 72,80,52
TR 112,25,25888
s_waitcnt lgkmcnt(5)
MAA 244,80,56
TR 114,25,26400
MAA 244,84,76
buffer_load_dwordx4 v20, s[20:23], s54 offen offset:2048 lds
MAA 156,92,76
TR 116,25,38304
s_add_u32 s54, s54, 196608
MAA 156,88,56
TR 118,25,38816
v_add_f32 v165, v165, v181
MAA 104,88,52
TR 120,25,26912
s_add_u32 m0, s55, 55488
MAA 104,92,72
buffer_load_dwordx4 v21, s[36:39], s52 offen lds
MAA 100,92,68
MAA 100,88,48
buffer_load_dwordx4 v28, s[36:39], s52 offen offset:1024 lds
MAA 96,88,44
TR 122,25,27424
MAA 96,92,64
TR 124,25,39328
v_add_f32 v166, v166, v182
MAA 92,92,60
TR 126,25,39840
MAA 92,88,40
buffer_load_dword v22, s[36:39], s52 offen offset:2048 lds
MAA 124,40,96
ds_read_b128 a[0:3], v23
s_add_u32 s52, s52, 128
MAA 124,60,100
RD 4,23,2304
MAA 128,64,100
RD 8,23,4608
MAA 128,44,96
buffer_load_dwordx4 v[192:195], v26, s[16:19], s75 offen offset:3072 sc1
MAA 132,48,96
RD 12,23,6912
v_add_f32 v167, v167, v183
MAA 132,68,100
ds_read_b128 a[16:19], v24
MAA 136,72,100
MAA 136,52,96
s_waitcnt vmcnt(18) lgkmcnt(5)
s_barrier
MAA 76,104,40
ds_read_b128 a[20:23], v30
s_add_u32 m0, s56, 98816
MAA 76,108,60
buffer_load_dwordx4 v18, s[20:23], s54 offen lds
MAA 80,108,64
RD 24,30,2304
s_waitcnt vmcnt(15)
v_add_f32 v164, v164, v184
MAA 80,104,44
RD 28,30,4608
v_add_f32 v165, v165, v185
MAA 84,104,48
RD 32,30,6912
v_add_f32 v166, v166, v186
MAA 84,108,68
buffer_load_dwordx4 v19, s[20:23], s54 offen offset:1024 lds
MAA 88,108,72
ds_read_b128 a[36:39], v31
v_add_f32 v167, v167, v187
MAA 88,104,52
TR 80,25,49664
MAA 160,112,56
TR 82,25,50176
MAA 160,116,76
buffer_load_dwordx4 v20, s[20:23], s54 offen offset:2048 lds
MAA 120,116,72
TR 84,25,62080
s_add_u32 s54, s54, 196608
MAA 120,112,52
TR 86,25,62592
s_add_u32 m0, s55, 57792
MAA 116,112,48
TR 88,25,50688
MAA 116,116,68
buffer_load_dwordx4 v21, s[36:39], s53 offen lds
MAA 112,116,64
TR 90,25,51200
MAA 112,112,44
TR 92,25,63104
MAA 108,112,40
TR 94,25,63616
MAA 108,116,60
buffer_load_dwordx4 v28, s[36:39], s53 offen offset:1024 lds
MAA 140,60,124
TR 96,25,51712
MAA 140,40,120
TR 98,25,52224
MAA 144,44,120
TR 100,25,64128
MAA 144,64,124
buffer_load_dword v29, s[36:39], s53 offen offset:2048 lds
MAA 148,68,124
TR 102,25,64640
s_add_u32 s53, s53, 128
MAA 148,48,120
MAA 152,52,120
MAA 152,72,124
s_waitcnt lgkmcnt(8)
s_barrier
MAA 60,80,0
TR 104,25,49696
s_add_u32 m0, s56, 111232
MAA 60,84,20
buffer_load_dwordx4 v18, s[20:23], s54 offen lds
MAA 64,84,24
TR 106,25,50208
s_waitcnt vmcnt(14)
v_add_f32 v164, v164, v188
MAA 64,80,4
TR 108,25,62112
v_add_f32 v165, v165, v189
MAA 68,80,8
buffer_load_dwordx4 v19, s[20:23], s54 offen offset:1024 lds
MAA 68,84,28
TR 110,25,62624
v_add_f32 v166, v166, v190
MAA 72,84,32
TR 112,25,50720
v_add_f32 v167, v167, v191
MAA 72,80,12
buffer_load_dwordx4 v20, s[20:23], s54 offen offset:2048 lds
s_waitcnt lgkmcnt(5)
MAA 244,80,16
TR 114,25,51232
s_add_u32 s54, s54, 196608
MAA 244,84,36
TR 116,25,63136
s_add_u32 m0, s59, 0
MAA 156,92,36
TR 118,25,63648
s_xor_b32 s58, s87, 1048576
MAA 156,88,16
buffer_load_dwordx4 v5, s[24:27], s58 offen lds
MAA 104,88,12
TR 120,25,51744
MAA 104,92,32
TR 122,25,52256
MAA 100,92,28
buffer_load_dwordx4 v6, s[24:27], s58 offen offset:1024 lds
MAA 100,88,8
TR 124,25,64160
s_add_u32 m0, s59, 8320
MAA 96,88,4
TR 126,25,64672
s_xor_b32 s58, s87, 1179648
MAA 96,92,24
buffer_load_dwordx4 v5, s[24:27], s58 offen lds
MAA 92,92,20
RD 40,23,18496
MAA 92,88,0
RD 44,23,20800
MAA 124,0,96
buffer_load_dwordx4 v6, s[24:27], s58 offen offset:1024 lds
MAA 124,20,100
RD 48,23,23104
MAA 128,24,100
RD 52,23,25408
MAA 128,4,96
RD 56,24,18496
MAA 132,8,96
MAA 132,28,100
MAA 136,32,100
MAA 136,12,96
s_waitcnt vmcnt(17) lgkmcnt(5)
s_barrier
MAA 76,104,0
RD 60,30,18496
s_add_u32 m0, s56, 123648
MAA 76,108,20
buffer_load_dwordx4 v18, s[20:23], s54 offen lds
MAA 80,108,24
RD 64,30,20800
s_waitcnt vmcnt(14)
v_add_f32 v164, v164, v192
MAA 80,104,4
RD 68,30,23104
v_add_f32 v165, v165, v193
MAA 84,104,8
RD 72,30,25408
v_add_f32 v166, v166, v194
MAA 84,108,28
RD 76,31,18496
v_add_f32 v167, v167, v195
MAA 88,108,32
ds_read_b64_tr_b16 a[80:81], v25
MAA 88,104,12
TR 82,25,512
MAA 160,112,16
TR 84,25,12416
MAA 160,116,36
buffer_load_dwordx4 v19, s[20:23], s54 offen offset:1024 lds
MAA 120,116,32
TR 86,25,12928
MAA 120,112,12
TR 88,25,1024
MAA 116,112,8
TR 90,25,1536
MAA 116,116,28
TR 92,25,13440
MAA 112,116,24
TR 94,25,13952
MAA 112,112,4
TR 96,25,2048
MAA 108,112,0
TR 98,25,2560
MAA 108,116,20
buffer_load_dwordx4 v20, s[20:23], s54 offen offset:2048 lds
MAA 140,20,124
TR 100,25,14464
s_add_u32 s54, s54, 196608
MAA 140,0,120
TR 102,25,14976
MAA 144,4,120
MAA 144,24,124
MAA 148,28,124
MAA 148,8,120
MAA 152,12,120
MAA 152,32,124
s_waitcnt lgkmcnt(8)
s_barrier
MAA 60,80,40
TR 104,25,32
s_add_u32 m0, s56, 136064
MAA 60,84,60
buffer_load_dwordx4 v18, s[20:23], s54 offen lds
MAA 64,84,64
TR 106,25,544
MAA 64,80,44
TR 108,25,12448
MAA 68,80,48
buffer_load_dwordx4 v19, s[20:23], s54 offen offset:1024 lds
MAA 68,84,68
TR 110,25,12960
MAA 72,84,72
TR 112,25,1056
MAA 72,80,52
buffer_load_dwordx4 v20, s[20:23], s54 offen offset:2048 lds
s_waitcnt lgkmcnt(5)
MAA 244,80,56
TR 114,25,1568
s_add_u32 s54, s54, 196608
MAA 244,84,76
TR 116,25,13472
s_add_u32 m0, s59, 16640
MAA 156,92,76
TR 118,25,13984
s_xor_b32 s58, s87, 1310720
MAA 156,88,56
buffer_load_dwordx4 v5, s[24:27], s58 offen lds
MAA 104,88,52
TR 120,25,2080
MAA 104,92,72
TR 122,25,2592
MAA 100,92,68
buffer_load_dwordx4 v6, s[24:27], s58 offen offset:1024 lds
MAA 100,88,48
TR 124,25,14496
s_add_u32 m0, s59, 24960
MAA 96,88,44
TR 126,25,15008
s_xor_b32 s58, s87, 1441792
MAA 96,92,64
buffer_load_dwordx4 v5, s[24:27], s58 offen lds
MAA 92,92,60
RD 0,23,36992
MAA 92,88,40
RD 4,23,39296
MAA 124,40,96
buffer_load_dwordx4 v6, s[24:27], s58 offen offset:1024 lds
MAA 124,60,100
RD 8,23,41600
MAA 128,64,100
RD 12,23,43904
MAA 128,44,96
RD 16,24,36992
MAA 132,48,96
v_permlane32_swap_b32 v164, v166
MAA 132,68,100
v_permlane32_swap_b32 v165, v167
MAA 136,72,100
v_add_f32 v164, v164, v166
v_add_f32 v165, v165, v167
MAA 136,52,96
v_mul_f32 v164, 0xba800000, v164
v_mul_f32 v165, 0x3a800000, v165
v_fma_f32 v165, -v164, v164, v165
v_max_f32 v165, 0, v165
v_add_f32 v165, 0x3727c5ac, v165
v_rsq_f32 v166, v165
s_nop 0
v_mov_b32 v165, v166
v_mul_f32 v166, 0x3e8293ee, v166
s_waitcnt vmcnt(14) lgkmcnt(5)
s_barrier
MAA 76,104,40
ds_write_b128 v7, v[164:167]
s_add_u32 m0, s59, 74880
MAA 76,108,60
.Lpad4:
s_cbranch_execz .Lpad8
ds_write_b32 v17, v164
s_xor_b32 s58, s87, 131072
MAA 80,108,64
ds_write_b32 v17, v165 offset:1024
MAA 80,104,44
buffer_load_dwordx4 v5, s[24:27], s58 offen lds
MAA 84,104,48
RD 20,30,36992
MAA 84,108,68
RD 24,30,39296
MAA 88,108,72
RD 28,30,41600
MAA 88,104,52
RD 32,30,43904
MAA 160,112,56
RD 36,31,36992
MAA 160,116,76
buffer_load_dwordx4 v6, s[24:27], s58 offen offset:1024 lds
MAA 120,116,72
TR 80,25,24832
s_add_u32 m0, s59, 83200
MAA 120,112,52
TR 82,25,25344
s_xor_b32 s58, s87, 262144
MAA 116,112,48
TR 84,25,37248
MAA 116,116,68
TR 86,25,37760
MAA 112,116,64
TR 88,25,25856
MAA 112,112,44
buffer_load_dwordx4 v5, s[24:27], s58 offen lds
MAA 108,112,40
TR 90,25,26368
MAA 108,116,60
TR 92,25,38272
MAA 140,60,124
TR 94,25,38784
MAA 140,40,120
TR 96,25,26880
MAA 144,44,120
TR 98,25,27392
MAA 144,64,124
buffer_load_dwordx4 v6, s[24:27], s58 offen offset:1024 lds
MAA 148,68,124
TR 100,25,39296
MAA 148,48,120
TR 102,25,39808
MAA 152,52,120
MAA 152,72,124
s_waitcnt vmcnt(8) lgkmcnt(0)
s_barrier
MAA 156,88,16
TR 112,25,25888
s_add_u32 m0, s59, 33280
MAA 156,92,36
TR 114,25,26400
s_xor_b32 s58, s87, 1572864
MAA 104,92,32
buffer_load_dwordx4 v5, s[24:27], s58 offen lds
MAA 104,88,12
TR 116,25,38304
MAA 100,88,8
TR 118,25,38816
MAA 100,92,28
TR 120,25,26912
MAA 96,92,24
buffer_load_dwordx4 v6, s[24:27], s58 offen offset:1024 lds
MAA 96,88,4
TR 122,25,27424
s_add_u32 m0, s59, 41600
MAA 92,88,0
TR 124,25,39328
s_xor_b32 s58, s87, 1703936
MAA 92,92,20
TR 126,25,39840
MAA 136,32,100
buffer_load_dwordx4 v5, s[24:27], s58 offen lds
MAA 136,12,96
TR 104,25,24864
MAA 244,80,16
TR 106,25,25376
MAA 244,84,36
TR 108,25,37280
MAA 72,84,32
buffer_load_dwordx4 v6, s[24:27], s58 offen offset:1024 lds
MAA 72,80,12
TR 110,25,37792
MAA 68,80,8
RD 40,23,55488
MAA 68,84,28
RD 44,23,57792
MAA 64,84,24
RD 48,23,60096
MAA 64,80,4
RD 52,23,62400
MAA 60,80,0
RD 56,24,55488
MAA 60,84,20
RD 60,30,55488
s_waitcnt lgkmcnt(15)
MAA 160,112,16
RD 64,30,57792
s_waitcnt lgkmcnt(15)
MAA 160,116,36
s_waitcnt lgkmcnt(7)
s_barrier
RD 68,30,60096
MAA 120,116,32
RD 72,30,62400
s_add_u32 m0, s59, 91520
MAA 120,112,12
RD 76,31,55488
s_xor_b32 s58, s87, 393216
MAA 116,112,8
TR 144,25,50688
MAA 116,116,28
TR 146,25,51200
MAA 112,116,24
TR 148,25,63104
MAA 112,112,4
TR 150,25,63616
MAA 108,112,0
TR 152,25,50720
MAA 108,116,20
TR 154,25,51232
MAA 152,32,124
TR 156,25,63136
MAA 152,12,120
TR 158,25,63648
MAA 88,104,12
TR 160,25,51712
MAA 88,108,32
TR 162,25,52224
MAA 84,108,28
TR 164,25,64128
MAA 84,104,8
TR 166,25,64640
MAA 80,104,4
TR 168,25,51744
MAA 80,108,24
TR 170,25,52256
MAA 76,108,20
TR 172,25,64160
MAA 76,104,0
TR 174,25,64672
s_waitcnt lgkmcnt(14)
MAA 156,144,56
TR 128,25,49664
s_waitcnt lgkmcnt(13)
MAA 156,148,76
TR 130,25,50176
MAA 104,148,72
TR 132,25,62080
MAA 104,144,52
TR 134,25,62592
MAA 100,144,48
TR 136,25,49696
MAA 100,148,68
TR 138,25,50208
MAA 96,148,64
TR 140,25,62112
MAA 96,144,44
TR 142,25,62624
MAA 92,144,40
ds_read_b128 v[232:235], v10 offset:768
MAA 92,148,60
ds_read_b128 v[236:239], v10 offset:2816
s_waitcnt lgkmcnt(15)
MAA 160,156,76
ds_read_b128 v[228:231], v10 offset:512
MAA 160,152,56
ds_read_b128 v[224:227], v10 offset:256
MAA 120,152,52
ds_read_b128 v[220:223], v10
MAA 120,156,72
buffer_load_dwordx4 v5, s[24:27], s58 offen lds
MAA 116,156,68
MAA 116,152,48
MAA 112,152,44
MAA 112,156,64
buffer_load_dwordx4 v6, s[24:27], s58 offen offset:1024 lds
MAA 108,156,60
s_add_u32 m0, s59, 99840
s_xor_b32 s58, s87, 524288
MAA 108,152,40
MAA 136,52,160
s_waitcnt lgkmcnt(15)
MAA 136,72,164
buffer_load_dwordx4 v5, s[24:27], s58 offen lds
s_waitcnt lgkmcnt(13)
MAA 152,72,172
MAA 152,52,168
s_waitcnt lgkmcnt(11)
MAA 244,128,56
s_waitcnt lgkmcnt(9)
MAA 244,132,76
buffer_load_dwordx4 v6, s[24:27], s58 offen offset:1024 lds
MAA 72,132,72
s_add_u32 m0, s59, 108160
s_xor_b32 s58, s87, 655360
MAA 72,128,52
MAA 68,128,48
MAA 68,132,68
buffer_load_dwordx4 v5, s[24:27], s58 offen lds
buffer_load_dwordx4 v6, s[24:27], s58 offen offset:1024 lds
s_mov_b32 exec_lo, 0x10001
s_mov_b32 exec_hi, 0x10001
ds_write_b128 v13, v[244:247]
ds_write_b128 v13, v[156:159] offset:256
ds_write_b128 v13, v[160:163] offset:320
s_mov_b64 exec, -1
MAA 64,128,44
MAA 64,132,64
MAA 60,132,60
MAA 60,128,40
s_waitcnt lgkmcnt(10)
MAA 88,136,52
s_waitcnt lgkmcnt(8)
MAA 88,140,72
s_waitcnt lgkmcnt(0)
s_barrier
MAA 84,136,48
ds_read_b128 v[28:31], v13
MAA 84,140,68
ds_read_b128 v[32:35], v13 offset:64
MAA 80,140,64
ds_read_b128 v[36:39], v13 offset:256
MAA 80,136,44
ds_read_b128 v[40:43], v13 offset:320
MAA 76,136,40
ds_read_b32 v44, v12 offset:512
MAA 76,140,60
ds_read_b32 v45, v12 offset:576
ds_read_b128 v[240:243], v11 offset:192
ds_read_b128 v[244:247], v11 offset:1216
ds_read_b128 v[18:21], v11 offset:128
ds_read_b128 v[22:25], v11 offset:1152
s_waitcnt lgkmcnt(9)
v_pk_fma_f32 v[72:73], v[28:29], v[232:233], v[72:73] op_sel_hi:[1,0,1]
v_cvt_pk_bf16_f32 v176, v72, v73
v_pk_fma_f32 v[74:75], v[30:31], v[232:233], v[74:75] op_sel_hi:[1,0,1]
v_cvt_pk_bf16_f32 v177, v74, v75
s_waitcnt lgkmcnt(8)
v_pk_fma_f32 v[88:89], v[32:33], v[232:233], v[88:89] op_sel_hi:[1,0,1]
v_cvt_pk_bf16_f32 v178, v88, v89
v_pk_fma_f32 v[90:91], v[34:35], v[232:233], v[90:91] op_sel_hi:[1,0,1]
v_cvt_pk_bf16_f32 v179, v90, v91
s_waitcnt lgkmcnt(7)
v_pk_fma_f32 v[104:105], v[36:37], v[232:233], v[104:105] op_sel_hi:[1,0,1]
v_pk_mul_f32 v[104:105], v[104:105], v[232:233] op_sel:[0,1] op_sel_hi:[1,1]
v_cvt_pk_bf16_f32 v196, v104, v105
v_pk_fma_f32 v[106:107], v[38:39], v[232:233], v[106:107] op_sel_hi:[1,0,1]
v_pk_mul_f32 v[106:107], v[106:107], v[232:233] op_sel:[0,1] op_sel_hi:[1,1]
v_cvt_pk_bf16_f32 v197, v106, v107
s_waitcnt lgkmcnt(6)
v_pk_fma_f32 v[120:121], v[40:41], v[232:233], v[120:121] op_sel_hi:[1,0,1]
v_pk_mul_f32 v[120:121], v[120:121], v[232:233] op_sel:[0,1] op_sel_hi:[1,1]
v_cvt_pk_bf16_f32 v198, v120, v121
v_pk_fma_f32 v[122:123], v[42:43], v[232:233], v[122:123] op_sel_hi:[1,0,1]
v_pk_mul_f32 v[122:123], v[122:123], v[232:233] op_sel:[0,1] op_sel_hi:[1,1]
v_cvt_pk_bf16_f32 v199, v122, v123
ds_write_b128 v8, v[196:199]
s_waitcnt lgkmcnt(4)
v_pk_fma_f32 v[136:137], v[240:241], v[44:45], v[136:137] op_sel_hi:[1,0,1]
v_pk_fma_f32 v[138:139], v[242:243], v[44:45], v[138:139] op_sel_hi:[1,0,1]
s_waitcnt lgkmcnt(3)
v_pk_mul_f32 v[136:137], v[136:137], v[244:245]
v_cvt_pk_bf16_f32 v208, v136, v137
v_pk_mul_f32 v[138:139], v[138:139], v[246:247]
v_cvt_pk_bf16_f32 v209, v138, v139
v_pk_fma_f32 v[152:153], v[240:241], v[44:45], v[152:153] op_sel:[0,1,0] op_sel_hi:[1,1,1]
v_pk_mul_f32 v[152:153], v[152:153], v[244:245]
v_cvt_pk_bf16_f32 v218, v152, v153
v_pk_fma_f32 v[154:155], v[242:243], v[44:45], v[154:155] op_sel:[0,1,0] op_sel_hi:[1,1,1]
v_pk_mul_f32 v[154:155], v[154:155], v[246:247]
v_cvt_pk_bf16_f32 v219, v154, v155
ds_write_b64 v8, v[208:209] offset:1024
ds_write_b64 v8, v[218:219] offset:1032
v_pk_fma_f32 v[156:157], v[36:37], v[236:237], v[156:157] op_sel_hi:[1,0,1]
v_pk_mul_f32 v[156:157], v[156:157], v[236:237] op_sel:[0,1] op_sel_hi:[1,1]
v_cvt_pk_bf16_f32 v180, v156, v157
v_pk_fma_f32 v[158:159], v[38:39], v[236:237], v[158:159] op_sel_hi:[1,0,1]
v_pk_mul_f32 v[158:159], v[158:159], v[236:237] op_sel:[0,1] op_sel_hi:[1,1]
v_cvt_pk_bf16_f32 v181, v158, v159
v_pk_fma_f32 v[160:161], v[40:41], v[236:237], v[160:161] op_sel_hi:[1,0,1]
v_pk_mul_f32 v[160:161], v[160:161], v[236:237] op_sel:[0,1] op_sel_hi:[1,1]
v_cvt_pk_bf16_f32 v182, v160, v161
v_pk_fma_f32 v[162:163], v[42:43], v[236:237], v[162:163] op_sel_hi:[1,0,1]
v_pk_mul_f32 v[162:163], v[162:163], v[236:237] op_sel:[0,1] op_sel_hi:[1,1]
v_cvt_pk_bf16_f32 v183, v162, v163
v_pk_fma_f32 v[100:101], v[36:37], v[228:229], v[100:101] op_sel_hi:[1,0,1]
v_pk_mul_f32 v[100:101], v[100:101], v[228:229] op_sel:[0,1] op_sel_hi:[1,1]
v_cvt_pk_bf16_f32 v192, v100, v101
v_pk_fma_f32 v[102:103], v[38:39], v[228:229], v[102:103] op_sel_hi:[1,0,1]
v_pk_mul_f32 v[102:103], v[102:103], v[228:229] op_sel:[0,1] op_sel_hi:[1,1]
v_cvt_pk_bf16_f32 v193, v102, v103
v_pk_fma_f32 v[116:117], v[40:41], v[228:229], v[116:117] op_sel_hi:[1,0,1]
v_pk_mul_f32 v[116:117], v[116:117], v[228:229] op_sel:[0,1] op_sel_hi:[1,1]
v_cvt_pk_bf16_f32 v194, v116, v117
v_pk_fma_f32 v[118:119], v[42:43], v[228:229], v[118:119] op_sel_hi:[1,0,1]
v_pk_mul_f32 v[118:119], v[118:119], v[228:229] op_sel:[0,1] op_sel_hi:[1,1]
s_waitcnt lgkmcnt(0)
s_barrier
v_cvt_pk_bf16_f32 v195, v118, v119
v_pk_fma_f32 v[96:97], v[36:37], v[224:225], v[96:97] op_sel_hi:[1,0,1]
v_pk_mul_f32 v[96:97], v[96:97], v[224:225] op_sel:[0,1] op_sel_hi:[1,1]
v_cvt_pk_bf16_f32 v188, v96, v97
v_pk_fma_f32 v[98:99], v[38:39], v[224:225], v[98:99] op_sel_hi:[1,0,1]
v_pk_mul_f32 v[98:99], v[98:99], v[224:225] op_sel:[0,1] op_sel_hi:[1,1]
v_cvt_pk_bf16_f32 v189, v98, v99
v_pk_fma_f32 v[112:113], v[40:41], v[224:225], v[112:113] op_sel_hi:[1,0,1]
v_pk_mul_f32 v[112:113], v[112:113], v[224:225] op_sel:[0,1] op_sel_hi:[1,1]
v_cvt_pk_bf16_f32 v190, v112, v113
v_pk_fma_f32 v[114:115], v[42:43], v[224:225], v[114:115] op_sel_hi:[1,0,1]
v_pk_mul_f32 v[114:115], v[114:115], v[224:225] op_sel:[0,1] op_sel_hi:[1,1]
v_cvt_pk_bf16_f32 v191, v114, v115
v_pk_fma_f32 v[92:93], v[36:37], v[220:221], v[92:93] op_sel_hi:[1,0,1]
v_pk_mul_f32 v[92:93], v[92:93], v[220:221] op_sel:[0,1] op_sel_hi:[1,1]
v_cvt_pk_bf16_f32 v184, v92, v93
v_pk_fma_f32 v[94:95], v[38:39], v[220:221], v[94:95] op_sel_hi:[1,0,1]
v_pk_mul_f32 v[94:95], v[94:95], v[220:221] op_sel:[0,1] op_sel_hi:[1,1]
v_cvt_pk_bf16_f32 v185, v94, v95
v_pk_fma_f32 v[108:109], v[40:41], v[220:221], v[108:109] op_sel_hi:[1,0,1]
v_pk_mul_f32 v[108:109], v[108:109], v[220:221] op_sel:[0,1] op_sel_hi:[1,1]
v_cvt_pk_bf16_f32 v186, v108, v109
v_pk_fma_f32 v[110:111], v[42:43], v[220:221], v[110:111] op_sel_hi:[1,0,1]
v_pk_mul_f32 v[110:111], v[110:111], v[220:221] op_sel:[0,1] op_sel_hi:[1,1]
v_cvt_pk_bf16_f32 v187, v110, v111
v_pk_fma_f32 v[68:69], v[28:29], v[228:229], v[68:69] op_sel_hi:[1,0,1]
v_cvt_pk_bf16_f32 v172, v68, v69
v_pk_fma_f32 v[70:71], v[30:31], v[228:229], v[70:71] op_sel_hi:[1,0,1]
v_cvt_pk_bf16_f32 v173, v70, v71
v_pk_fma_f32 v[84:85], v[32:33], v[228:229], v[84:85] op_sel_hi:[1,0,1]
v_cvt_pk_bf16_f32 v174, v84, v85
v_pk_fma_f32 v[86:87], v[34:35], v[228:229], v[86:87] op_sel_hi:[1,0,1]
v_cvt_pk_bf16_f32 v175, v86, v87
v_pk_fma_f32 v[64:65], v[28:29], v[224:225], v[64:65] op_sel_hi:[1,0,1]
v_cvt_pk_bf16_f32 v168, v64, v65
v_pk_fma_f32 v[66:67], v[30:31], v[224:225], v[66:67] op_sel_hi:[1,0,1]
v_cvt_pk_bf16_f32 v169, v66, v67
v_pk_fma_f32 v[80:81], v[32:33], v[224:225], v[80:81] op_sel_hi:[1,0,1]
v_cvt_pk_bf16_f32 v170, v80, v81
v_pk_fma_f32 v[82:83], v[34:35], v[224:225], v[82:83] op_sel_hi:[1,0,1]
v_cvt_pk_bf16_f32 v171, v82, v83
v_pk_fma_f32 v[60:61], v[28:29], v[220:221], v[60:61] op_sel_hi:[1,0,1]
v_cvt_pk_bf16_f32 v164, v60, v61
v_pk_fma_f32 v[62:63], v[30:31], v[220:221], v[62:63] op_sel_hi:[1,0,1]
v_cvt_pk_bf16_f32 v165, v62, v63
v_pk_fma_f32 v[76:77], v[32:33], v[220:221], v[76:77] op_sel_hi:[1,0,1]
v_cvt_pk_bf16_f32 v166, v76, v77
v_pk_fma_f32 v[78:79], v[34:35], v[220:221], v[78:79] op_sel_hi:[1,0,1]
v_cvt_pk_bf16_f32 v167, v78, v79
s_nop 0
v_mfma_f32_16x16x32_bf16 v[120:123], v[196:199], v[176:179], v[50:53]
ds_read_b64 v[200:201], v9 offset:1024
v_mfma_f32_16x16x32_bf16 v[104:107], v[192:195], v[176:179], v[46:49]
ds_read_b64 v[210:211], v9 offset:1032
v_mfma_f32_16x16x32_bf16 v[116:119], v[192:195], v[172:175], v[50:53]
ds_read_b128 v[240:243], v11 offset:64
v_mfma_f32_16x16x32_bf16 v[100:103], v[188:191], v[172:175], v[46:49]
ds_read_b128 v[244:247], v11 offset:1088
v_mfma_f32_16x16x32_bf16 v[112:115], v[188:191], v[168:171], v[50:53]
ds_read_b128 v[28:31], v11
v_mfma_f32_16x16x32_bf16 v[96:99], v[184:187], v[168:171], v[46:49]
ds_read_b128 v[32:35], v11 offset:1024
v_max3_f32 v88, v104, v105, v106
v_mfma_f32_16x16x32_bf16 v[108:111], v[184:187], v[164:167], v[50:53]
v_max3_f32 v89, v107, v120, v121
v_max3_f32 v88, v88, v122, v123
v_mfma_f32_16x16x32_bf16 v[92:95], v[180:183], v[164:167], v[54:57]
v_max_f32 v90, v88, v89
v_max_f32 v89, v88, v89
MAA 132,8,96
s_nop 0
v_permlane16_swap_b32 v90, v89
MAA 132,28,100
v_max_f32 v88, v90, v89
v_max_f32 v89, v90, v89
MAA 132,48,160
s_nop 0
v_permlane32_swap_b32 v88, v89
MAA 132,68,164
v_max_f32 v88, v88, v89
v_mul_f32 v88, v88, v234
MAA 148,68,172
v_max3_f32 v84, v100, v101, v102
v_max3_f32 v85, v103, v116, v117
MAA 148,48,168
v_max3_f32 v84, v84, v118, v119
v_max_f32 v86, v84, v85
MAA 148,28,124
v_max_f32 v85, v84, v85
v_max3_f32 v80, v96, v97, v98
MAA 148,8,120
v_permlane16_swap_b32 v86, v85
v_max3_f32 v81, v99, v112, v113
v_max_f32 v84, v86, v85
v_max_f32 v85, v86, v85
v_max3_f32 v80, v80, v114, v115
v_max_f32 v82, v80, v81
v_permlane32_swap_b32 v84, v85
v_max_f32 v81, v80, v81
v_max_f32 v84, v84, v85
v_mul_f32 v84, v84, v230
v_permlane16_swap_b32 v82, v81
v_max3_f32 v76, v92, v93, v94
v_max_f32 v80, v82, v81
v_max_f32 v81, v82, v81
v_max3_f32 v77, v95, v108, v109
v_max3_f32 v76, v76, v110, v111
v_permlane32_swap_b32 v80, v81
v_max_f32 v78, v76, v77
v_max_f32 v80, v80, v81
v_mul_f32 v80, v80, v226
v_max_f32 v77, v76, v77
v_pk_fma_f32 v[104:105], v[104:105], v[234:235], v[88:89] op_sel_hi:[1,0,0] neg_lo:[0,0,1] neg_hi:[0,0,1]
v_pk_fma_f32 v[106:107], v[106:107], v[234:235], v[88:89] op_sel_hi:[1,0,0] neg_lo:[0,0,1] neg_hi:[0,0,1]
v_permlane16_swap_b32 v78, v77
v_pk_fma_f32 v[120:121], v[120:121], v[234:235], v[88:89] op_sel_hi:[1,0,0] neg_lo:[0,0,1] neg_hi:[0,0,1]
v_max_f32 v76, v78, v77
v_max_f32 v77, v78, v77
v_pk_fma_f32 v[122:123], v[122:123], v[234:235], v[88:89] op_sel_hi:[1,0,0] neg_lo:[0,0,1] neg_hi:[0,0,1]
v_pk_fma_f32 v[100:101], v[100:101], v[230:231], v[84:85] op_sel_hi:[1,0,0] neg_lo:[0,0,1] neg_hi:[0,0,1]
v_permlane32_swap_b32 v76, v77
v_pk_fma_f32 v[102:103], v[102:103], v[230:231], v[84:85] op_sel_hi:[1,0,0] neg_lo:[0,0,1] neg_hi:[0,0,1]
v_max_f32 v76, v76, v77
v_mul_f32 v76, v76, v222
v_pk_fma_f32 v[116:117], v[116:117], v[230:231], v[84:85] op_sel_hi:[1,0,0] neg_lo:[0,0,1] neg_hi:[0,0,1]
v_pk_fma_f32 v[118:119], v[118:119], v[230:231], v[84:85] op_sel_hi:[1,0,0] neg_lo:[0,0,1] neg_hi:[0,0,1]
v_pk_fma_f32 v[96:97], v[96:97], v[226:227], v[80:81] op_sel_hi:[1,0,0] neg_lo:[0,0,1] neg_hi:[0,0,1]
v_pk_fma_f32 v[98:99], v[98:99], v[226:227], v[80:81] op_sel_hi:[1,0,0] neg_lo:[0,0,1] neg_hi:[0,0,1]
v_pk_fma_f32 v[112:113], v[112:113], v[226:227], v[80:81] op_sel_hi:[1,0,0] neg_lo:[0,0,1] neg_hi:[0,0,1]
v_pk_fma_f32 v[114:115], v[114:115], v[226:227], v[80:81] op_sel_hi:[1,0,0] neg_lo:[0,0,1] neg_hi:[0,0,1]
v_pk_fma_f32 v[92:93], v[92:93], v[222:223], v[76:77] op_sel_hi:[1,0,0] neg_lo:[0,0,1] neg_hi:[0,0,1]
v_pk_fma_f32 v[94:95], v[94:95], v[222:223], v[76:77] op_sel_hi:[1,0,0] neg_lo:[0,0,1] neg_hi:[0,0,1]
v_pk_fma_f32 v[108:109], v[108:109], v[222:223], v[76:77] op_sel_hi:[1,0,0] neg_lo:[0,0,1] neg_hi:[0,0,1]
v_pk_fma_f32 v[110:111], v[110:111], v[222:223], v[76:77] op_sel_hi:[1,0,0] neg_lo:[0,0,1] neg_hi:[0,0,1]
v_pk_fma_f32 v[132:133], v[18:19], v[44:45], v[132:133] op_sel_hi:[1,0,1]
v_pk_mul_f32 v[132:133], v[132:133], v[22:23]
v_pk_fma_f32 v[134:135], v[20:21], v[44:45], v[134:135] op_sel_hi:[1,0,1]
v_pk_mul_f32 v[134:135], v[134:135], v[24:25]
v_pk_fma_f32 v[148:149], v[18:19], v[44:45], v[148:149] op_sel:[0,1,0] op_sel_hi:[1,1,1]
v_pk_mul_f32 v[148:149], v[148:149], v[22:23]
v_pk_fma_f32 v[150:151], v[20:21], v[44:45], v[150:151] op_sel:[0,1,0] op_sel_hi:[1,1,1]
v_pk_mul_f32 v[150:151], v[150:151], v[24:25]
v_exp_f32 v104, v104
s_nop 0
MAA 128,4,96
v_exp_f32 v105, v105
MAA 128,24,100
v_exp_f32 v106, v106
MAA 128,44,160
v_exp_f32 v107, v107
MAA 128,64,164
v_exp_f32 v120, v120
MAA 144,64,172
v_exp_f32 v121, v121
MAA 144,44,168
v_exp_f32 v122, v122
MAA 144,24,124
v_exp_f32 v123, v123
MAA 144,4,120
v_exp_f32 v100, v100
MAA 124,0,96
v_exp_f32 v101, v101
MAA 124,20,100
v_exp_f32 v102, v102
MAA 124,40,160
v_exp_f32 v103, v103
MAA 124,60,164
v_exp_f32 v116, v116
MAA 140,60,172
v_exp_f32 v117, v117
MAA 140,40,168
v_exp_f32 v118, v118
MAA 140,20,124
v_exp_f32 v119, v119
MAA 140,0,120
v_cvt_pk_bf16_f32 v72, v104, v105
v_cvt_pk_bf16_f32 v73, v106, v107
v_cvt_pk_bf16_f32 v74, v120, v121
v_cvt_pk_bf16_f32 v75, v122, v123
v_cvt_pk_bf16_f32 v68, v100, v101
v_cvt_pk_bf16_f32 v69, v102, v103
v_cvt_pk_bf16_f32 v70, v116, v117
v_cvt_pk_bf16_f32 v71, v118, v119
v_exp_f32 v96, v96
v_exp_f32 v97, v97
v_exp_f32 v98, v98
v_exp_f32 v99, v99
v_exp_f32 v112, v112
v_exp_f32 v113, v113
v_exp_f32 v114, v114
v_exp_f32 v115, v115
v_cvt_pk_bf16_f32 v64, v96, v97
v_cvt_pk_bf16_f32 v65, v98, v99
v_cvt_pk_bf16_f32 v66, v112, v113
v_cvt_pk_bf16_f32 v67, v114, v115
v_cvt_pk_bf16_f32 v206, v132, v133
v_cvt_pk_bf16_f32 v207, v134, v135
v_cvt_pk_bf16_f32 v216, v148, v149
v_cvt_pk_bf16_f32 v217, v150, v151
s_waitcnt lgkmcnt(3)
v_pk_fma_f32 v[128:129], v[240:241], v[44:45], v[128:129] op_sel_hi:[1,0,1]
s_waitcnt lgkmcnt(2)
v_pk_mul_f32 v[128:129], v[128:129], v[244:245]
v_cvt_pk_bf16_f32 v204, v128, v129
v_pk_fma_f32 v[130:131], v[242:243], v[44:45], v[130:131] op_sel_hi:[1,0,1]
v_pk_mul_f32 v[130:131], v[130:131], v[246:247]
v_cvt_pk_bf16_f32 v205, v130, v131
v_pk_fma_f32 v[144:145], v[240:241], v[44:45], v[144:145] op_sel:[0,1,0] op_sel_hi:[1,1,1]
v_pk_mul_f32 v[144:145], v[144:145], v[244:245]
v_cvt_pk_bf16_f32 v214, v144, v145
v_pk_fma_f32 v[146:147], v[242:243], v[44:45], v[146:147] op_sel:[0,1,0] op_sel_hi:[1,1,1]
v_pk_mul_f32 v[146:147], v[146:147], v[246:247]
v_cvt_pk_bf16_f32 v215, v146, v147
s_waitcnt lgkmcnt(1)
v_pk_fma_f32 v[124:125], v[28:29], v[44:45], v[124:125] op_sel_hi:[1,0,1]
s_waitcnt lgkmcnt(0)
v_pk_mul_f32 v[124:125], v[124:125], v[32:33]
v_cvt_pk_bf16_f32 v202, v124, v125
v_pk_fma_f32 v[126:127], v[30:31], v[44:45], v[126:127] op_sel_hi:[1,0,1]
v_pk_mul_f32 v[126:127], v[126:127], v[34:35]
v_cvt_pk_bf16_f32 v203, v126, v127
v_pk_fma_f32 v[140:141], v[28:29], v[44:45], v[140:141] op_sel:[0,1,0] op_sel_hi:[1,1,1]
v_pk_mul_f32 v[140:141], v[140:141], v[32:33]
v_cvt_pk_bf16_f32 v212, v140, v141
v_pk_fma_f32 v[142:143], v[30:31], v[44:45], v[142:143] op_sel:[0,1,0] op_sel_hi:[1,1,1]
v_pk_mul_f32 v[142:143], v[142:143], v[34:35]
v_cvt_pk_bf16_f32 v213, v142, v143
s_nop 0
v_mfma_f32_16x16x32_bf16 v[88:91], v[248:251], v[72:75], 0
v_exp_f32 v92, v92
v_mfma_f32_16x16x32_bf16 v[104:107], v[206:209], v[72:75], 0
v_exp_f32 v93, v93
v_mfma_f32_16x16x32_bf16 v[120:123], v[216:219], v[72:75], 0
v_exp_f32 v94, v94
v_mfma_f32_16x16x32_bf16 v[84:87], v[248:251], v[68:71], 0
v_exp_f32 v95, v95
v_mfma_f32_16x16x32_bf16 v[100:103], v[204:207], v[68:71], 0
v_exp_f32 v108, v108
v_mfma_f32_16x16x32_bf16 v[116:119], v[214:217], v[68:71], 0
v_exp_f32 v109, v109
v_mfma_f32_16x16x32_bf16 v[80:83], v[248:251], v[64:67], 0
v_exp_f32 v110, v110
v_mfma_f32_16x16x32_bf16 v[96:99], v[202:205], v[64:67], 0
v_exp_f32 v111, v111
v_mfma_f32_16x16x32_bf16 v[112:115], v[212:215], v[64:67], 0
v_cvt_pk_bf16_f32 v60, v92, v93
v_cvt_pk_bf16_f32 v61, v94, v95
v_cvt_pk_bf16_f32 v62, v108, v109
v_cvt_pk_bf16_f32 v63, v110, v111
v_rcp_f32 v88, v88
v_rcp_f32 v84, v84
v_mfma_f32_16x16x32_bf16 v[76:79], v[248:251], v[60:63], 0
v_rcp_f32 v80, v80
v_mfma_f32_16x16x32_bf16 v[92:95], v[200:203], v[60:63], 0
v_mfma_f32_16x16x32_bf16 v[108:111], v[210:213], v[60:63], 0
s_nop 4
v_rcp_f32 v76, v76
v_pk_mul_f32 v[104:105], v[104:105], v[88:89] op_sel_hi:[1,0]
v_pk_mul_f32 v[106:107], v[106:107], v[88:89] op_sel_hi:[1,0]
v_pk_mul_f32 v[120:121], v[120:121], v[88:89] op_sel_hi:[1,0]
.Lpad5:
s_cbranch_execz .Lpad9
v_pk_mul_f32 v[122:123], v[122:123], v[88:89] op_sel_hi:[1,0]
v_cvt_pk_bf16_f32 v176, v104, v105
v_cvt_pk_bf16_f32 v177, v106, v107
v_cvt_pk_bf16_f32 v178, v120, v121
v_cvt_pk_bf16_f32 v179, v122, v123
buffer_store_dwordx4 v[176:179], v4, s[16:19], s74 offen offset:3072 sc1
v_pk_mul_f32 v[100:101], v[100:101], v[84:85] op_sel_hi:[1,0]
v_pk_mul_f32 v[102:103], v[102:103], v[84:85] op_sel_hi:[1,0]
v_pk_mul_f32 v[116:117], v[116:117], v[84:85] op_sel_hi:[1,0]
v_pk_mul_f32 v[118:119], v[118:119], v[84:85] op_sel_hi:[1,0]
v_cvt_pk_bf16_f32 v172, v100, v101
v_cvt_pk_bf16_f32 v173, v102, v103
v_cvt_pk_bf16_f32 v174, v116, v117
v_cvt_pk_bf16_f32 v175, v118, v119
buffer_store_dwordx4 v[172:175], v4, s[16:19], s74 offen offset:2048 sc1
v_pk_mul_f32 v[96:97], v[96:97], v[80:81] op_sel_hi:[1,0]
v_pk_mul_f32 v[98:99], v[98:99], v[80:81] op_sel_hi:[1,0]
v_pk_mul_f32 v[112:113], v[112:113], v[80:81] op_sel_hi:[1,0]
v_pk_mul_f32 v[114:115], v[114:115], v[80:81] op_sel_hi:[1,0]
v_cvt_pk_bf16_f32 v168, v96, v97
v_cvt_pk_bf16_f32 v169, v98, v99
v_cvt_pk_bf16_f32 v170, v112, v113
v_cvt_pk_bf16_f32 v171, v114, v115
buffer_store_dwordx4 v[168:171], v4, s[16:19], s74 offen offset:1024 sc1
v_pk_mul_f32 v[92:93], v[92:93], v[76:77] op_sel_hi:[1,0]
v_pk_mul_f32 v[94:95], v[94:95], v[76:77] op_sel_hi:[1,0]
v_pk_mul_f32 v[108:109], v[108:109], v[76:77] op_sel_hi:[1,0]
v_pk_mul_f32 v[110:111], v[110:111], v[76:77] op_sel_hi:[1,0]
v_cvt_pk_bf16_f32 v164, v92, v93
v_cvt_pk_bf16_f32 v165, v94, v95
v_cvt_pk_bf16_f32 v166, v108, v109
v_cvt_pk_bf16_f32 v167, v110, v111
buffer_store_dwordx4 v[164:167], v4, s[16:19], s74 offen sc1
s_nop 1
s_branch .Lqkve2
.Lx4:
buffer_load_dword v27, v14, s[76:79], 0 offen
s_mov_b32 s76, s98
s_mov_b32 s77, s99
s_mov_b32 s78, s100
v_mov_b32 v14, v15
s_mov_b32 s47, 5
s_branch .Lx4b
.Lx5:
buffer_load_dword v27, v14, s[76:79], 0 offen
s_mov_b32 s76, s98
s_mov_b32 s77, s99
s_mov_b32 s78, s100
v_mov_b32 v14, v15
s_mov_b32 s47, 5
s_branch .Lx5b
.Lx6:
buffer_load_dword v27, v14, s[76:79], 0 offen
s_mov_b32 s76, s98
s_mov_b32 s77, s99
s_mov_b32 s78, s100
v_mov_b32 v14, v15
s_mov_b32 s47, 5
s_branch .Lx6b
.Lx7:
buffer_load_dword v27, v14, s[76:79], 0 offen
s_mov_b32 s76, s98
s_mov_b32 s77, s99
s_mov_b32 s78, s100
v_mov_b32 v14, v15
s_mov_b32 s47, 5
s_branch .Lx7b
.Lsp8:
s_mov_b32 s15, 0
.Lsp8l:
v_mov_b32 v37, 0
buffer_atomic_add v37, v34, s[40:43], 0 offen sc0
s_add_u32 s15, s15, 1
s_cmp_gt_u32 s15, 100000
s_waitcnt vmcnt(0)
s_cbranch_scc1 .Lsp8b
v_cmp_gt_u32 vcc, v35, v37
s_nop 0
s_cbranch_vccnz .Lsp8l
s_branch .Lsp8b
.Lx9:
buffer_load_dword v27, v14, s[76:79], 0 offen
s_mov_b32 s76, s98
s_mov_b32 s77, s99
s_mov_b32 s78, s100
v_mov_b32 v14, v15
s_mov_b32 s47, 5
s_branch .Lx9b
.Lx10:
buffer_load_dword v27, v14, s[76:79], 0 offen
s_mov_b32 s76, s98
s_mov_b32 s77, s99
s_mov_b32 s78, s100
v_mov_b32 v14, v15
s_mov_b32 s47, 5
s_branch .Lx10b
.Lx11:
buffer_load_dword v27, v14, s[76:79], 0 offen
s_mov_b32 s76, s98
s_mov_b32 s77, s99
s_mov_b32 s78, s100
v_mov_b32 v14, v15
s_mov_b32 s47, 5
s_branch .Lx11b
.Lx12:
buffer_load_dword v27, v14, s[76:79], 0 offen
s_mov_b32 s76, s98
s_mov_b32 s77, s99
s_mov_b32 s78, s100
v_mov_b32 v14, v15
s_mov_b32 s47, 5
s_branch .Lx12b
.Lsp13:
s_mov_b32 s15, 0
.Lsp13l:
v_mov_b32 v37, 0
buffer_atomic_add v37, v33, s[16:19], 0 offen sc0
s_add_u32 s15, s15, 1
s_cmp_gt_u32 s15, 100000
s_waitcnt vmcnt(0)
s_cbranch_scc1 .Lsp13b
v_cmp_gt_u32 vcc, v36, v37
s_nop 0
s_cbranch_vccnz .Lsp13l
s_branch .Lsp13b
.Lx14:
buffer_load_dword v27, v14, s[76:79], 0 offen
s_mov_b32 s76, s98
s_mov_b32 s77, s99
s_mov_b32 s78, s100
v_mov_b32 v14, v15
s_mov_b32 s47, 5
s_branch .Lx14b
.Lx15:
buffer_load_dword v27, v14, s[76:79], 0 offen
s_mov_b32 s76, s98
s_mov_b32 s77, s99
s_mov_b32 s78, s100
v_mov_b32 v14, v15
s_mov_b32 s47, 5
s_branch .Lx15b
.Lx16:
buffer_load_dword v27, v14, s[76:79], 0 offen
s_mov_b32 s76, s98
s_mov_b32 s77, s99
s_mov_b32 s78, s100
v_mov_b32 v14, v15
s_mov_b32 s47, 5
s_branch .Lx16b
.Lx17:
buffer_load_dword v27, v14, s[76:79], 0 offen
s_mov_b32 s76, s98
s_mov_b32 s77, s99
s_mov_b32 s78, s100
v_mov_b32 v14, v15
s_mov_b32 s47, 5
s_branch .Lx17b
.Lx19:
buffer_load_dword v27, v14, s[76:79], 0 offen
s_mov_b32 s76, s98
s_mov_b32 s77, s99
s_mov_b32 s78, s100
v_mov_b32 v14, v15
s_mov_b32 s47, 5
s_branch .Lx19b
.Lx20:
buffer_load_dword v27, v14, s[76:79], 0 offen
s_mov_b32 s76, s98
s_mov_b32 s77, s99
s_mov_b32 s78, s100
v_mov_b32 v14, v15
s_mov_b32 s47, 5
s_branch .Lx20b
.Lx21:
buffer_load_dword v27, v14, s[76:79], 0 offen
s_mov_b32 s76, s98
s_mov_b32 s77, s99
s_mov_b32 s78, s100
v_mov_b32 v14, v15
s_mov_b32 s47, 5
s_branch .Lx21b
.Lx22:
buffer_load_dword v27, v14, s[76:79], 0 offen
s_mov_b32 s76, s98
s_mov_b32 s77, s99
s_mov_b32 s78, s100
v_mov_b32 v14, v15
s_mov_b32 s47, 5
s_branch .Lx22b
.Lsp23:
s_mov_b32 s15, 0
.Lsp23l:
v_mov_b32 v37, 0
buffer_atomic_add v37, v34, s[40:43], 0 offen sc0
s_add_u32 s15, s15, 1
s_cmp_gt_u32 s15, 100000
s_waitcnt vmcnt(0)
s_cbranch_scc1 .Lsp23b
v_cmp_gt_u32 vcc, v35, v37
s_nop 0
s_cbranch_vccnz .Lsp23l
s_branch .Lsp23b
.Lx24:
buffer_load_dword v27, v14, s[76:79], 0 offen
s_mov_b32 s76, s98
s_mov_b32 s77, s99
s_mov_b32 s78, s100
v_mov_b32 v14, v15
s_mov_b32 s47, 5
s_branch .Lx24b
.Lx25:
buffer_load_dword v27, v14, s[76:79], 0 offen
s_mov_b32 s76, s98
s_mov_b32 s77, s99
s_mov_b32 s78, s100
v_mov_b32 v14, v15
s_mov_b32 s47, 5
s_branch .Lx25b
.Lx26:
buffer_load_dword v27, v14, s[76:79], 0 offen
s_mov_b32 s76, s98
s_mov_b32 s77, s99
s_mov_b32 s78, s100
v_mov_b32 v14, v15
s_mov_b32 s47, 5
s_branch .Lx26b
.Lx27:
buffer_load_dword v27, v14, s[76:79], 0 offen
s_mov_b32 s76, s98
s_mov_b32 s77, s99
s_mov_b32 s78, s100
v_mov_b32 v14, v15
s_mov_b32 s47, 5
s_branch .Lx27b
.Lsp28:
s_mov_b32 s15, 0
.Lsp28l:
v_mov_b32 v37, 0
buffer_atomic_add v37, v33, s[16:19], 0 offen sc0
s_add_u32 s15, s15, 1
s_cmp_gt_u32 s15, 100000
s_waitcnt vmcnt(0)
s_cbranch_scc1 .Lsp28b
v_cmp_gt_u32 vcc, v36, v37
s_nop 0
s_cbranch_vccnz .Lsp28l
s_branch .Lsp28b
.Lx29:
buffer_load_dword v27, v14, s[76:79], 0 offen
s_mov_b32 s76, s98
s_mov_b32 s77, s99
s_mov_b32 s78, s100
v_mov_b32 v14, v15
s_mov_b32 s47, 5
s_branch .Lx29b
.Lx30:
buffer_load_dword v27, v14, s[76:79], 0 offen
s_mov_b32 s76, s98
s_mov_b32 s77, s99
s_mov_b32 s78, s100
v_mov_b32 v14, v15
s_mov_b32 s47, 5
s_branch .Lx30b
.Lx31:
buffer_load_dword v27, v14, s[76:79], 0 offen
s_mov_b32 s76, s98
s_mov_b32 s77, s99
s_mov_b32 s78, s100
v_mov_b32 v14, v15
s_mov_b32 s47, 5
s_branch .Lx31b
.Lx32:
buffer_load_dword v27, v14, s[76:79], 0 offen
s_mov_b32 s76, s98
s_mov_b32 s77, s99
s_mov_b32 s78, s100
v_mov_b32 v14, v15
s_mov_b32 s47, 5
s_branch .Lx32b
.p2align 12
.Lqkv1:
.Lpad6:
s_cbranch_execz .Lpad10
s_cmp_lt_u32 s14, 16
s_cselect_b32 s62, 0, 4096
v_mov_b32 v231, 1
v_lshlrev_b32 v232, 8, v1
s_waitcnt vmcnt(18)
v_permlane16_swap_b32 v164, v166
v_permlane16_swap_b32 v165, v167
s_waitcnt vmcnt(17)
v_permlane16_swap_b32 v168, v170
v_permlane16_swap_b32 v169, v171
s_waitcnt vmcnt(16)
v_permlane16_swap_b32 v172, v174
v_permlane16_swap_b32 v173, v175
s_waitcnt vmcnt(15)
v_permlane16_swap_b32 v176, v178
v_permlane16_swap_b32 v177, v179
buffer_atomic_add v231, v232, s[40:43], s62 offen
v_lshlrev_b32 v192, 16, v164
v_and_b32 v193, 0xffff0000, v164
v_lshlrev_b32 v194, 16, v165
v_and_b32 v195, 0xffff0000, v165
v_lshlrev_b32 v196, 16, v166
v_and_b32 v197, 0xffff0000, v166
v_lshlrev_b32 v198, 16, v167
v_and_b32 v199, 0xffff0000, v167
v_lshlrev_b32 v200, 16, v168
v_and_b32 v201, 0xffff0000, v168
v_lshlrev_b32 v202, 16, v169
v_and_b32 v203, 0xffff0000, v169
v_lshlrev_b32 v204, 16, v170
v_and_b32 v205, 0xffff0000, v170
v_lshlrev_b32 v206, 16, v171
v_and_b32 v207, 0xffff0000, v171
v_lshlrev_b32 v208, 16, v172
v_and_b32 v209, 0xffff0000, v172
v_lshlrev_b32 v210, 16, v173
v_and_b32 v211, 0xffff0000, v173
v_lshlrev_b32 v212, 16, v174
v_and_b32 v213, 0xffff0000, v174
v_lshlrev_b32 v214, 16, v175
v_and_b32 v215, 0xffff0000, v175
v_lshlrev_b32 v216, 16, v176
v_and_b32 v217, 0xffff0000, v176
v_lshlrev_b32 v218, 16, v177
v_and_b32 v219, 0xffff0000, v177
v_lshlrev_b32 v220, 16, v178
v_and_b32 v221, 0xffff0000, v178
v_lshlrev_b32 v222, 16, v179
v_and_b32 v223, 0xffff0000, v179
s_lshl_b32 s64, s6, 14
s_lshl_b32 s65, s49, 13
s_add_u32 s64, s64, s65
s_lshl_b32 s65, s7, 9
s_add_u32 s64, s64, s65
s_lshl_b32 s65, s48, 8
s_add_u32 s64, s64, s65
s_add_u32 s64, s64, 29360128
v_and_b32 v188, 31, v1
v_lshlrev_b32 v188, 3, v188
v_lshrrev_b32 v189, 5, v1
v_lshl_add_u32 v188, v189, 28, v188
s_lshl_b32 s62, s7, 18
s_add_u32 s62, s62, 0
s_add_u32 s63, s62, 131072
v_pk_mul_f32 v[182:183], v[192:193], v[192:193]
v_pk_mul_f32 v[186:187], v[208:209], v[208:209]
v_pk_fma_f32 v[182:183], v[194:195], v[194:195], v[182:183]
v_pk_add_f32 v[180:181], v[192:193], v[194:195]
v_pk_fma_f32 v[186:187], v[210:211], v[210:211], v[186:187]
v_pk_add_f32 v[184:185], v[208:209], v[210:211]
v_pk_fma_f32 v[182:183], v[196:197], v[196:197], v[182:183]
v_pk_add_f32 v[180:181], v[180:181], v[196:197]
v_pk_fma_f32 v[186:187], v[212:213], v[212:213], v[186:187]
v_pk_add_f32 v[184:185], v[184:185], v[212:213]
v_pk_fma_f32 v[182:183], v[198:199], v[198:199], v[182:183]
v_pk_add_f32 v[180:181], v[180:181], v[198:199]
v_pk_fma_f32 v[186:187], v[214:215], v[214:215], v[186:187]
v_pk_add_f32 v[184:185], v[184:185], v[214:215]
v_pk_fma_f32 v[182:183], v[200:201], v[200:201], v[182:183]
v_pk_add_f32 v[180:181], v[180:181], v[200:201]
v_pk_fma_f32 v[186:187], v[216:217], v[216:217], v[186:187]
v_pk_add_f32 v[184:185], v[184:185], v[216:217]
v_pk_fma_f32 v[182:183], v[202:203], v[202:203], v[182:183]
v_pk_add_f32 v[180:181], v[180:181], v[202:203]
v_pk_fma_f32 v[186:187], v[218:219], v[218:219], v[186:187]
v_pk_add_f32 v[184:185], v[184:185], v[218:219]
v_pk_fma_f32 v[182:183], v[204:205], v[204:205], v[182:183]
v_pk_add_f32 v[180:181], v[180:181], v[204:205]
v_pk_fma_f32 v[186:187], v[220:221], v[220:221], v[186:187]
v_pk_add_f32 v[184:185], v[184:185], v[220:221]
v_pk_fma_f32 v[182:183], v[206:207], v[206:207], v[182:183]
v_pk_add_f32 v[180:181], v[180:181], v[206:207]
v_pk_fma_f32 v[186:187], v[222:223], v[222:223], v[186:187]
v_pk_add_f32 v[184:185], v[184:185], v[222:223]
v_add_f32 v180, v180, v181
v_add_f32 v182, v182, v183
v_add_f32 v184, v184, v185
v_add_f32 v186, v186, v187
s_nop 0
v_permlane16_swap_b32 v180, v184
v_permlane16_swap_b32 v182, v186
v_add_f32 v180, v180, v184
v_add_f32 v182, v182, v186
s_nop 1
v_permlane32_swap_b32 v180, v182
v_add_f32 v180, v180, v182
s_nop 1
v_permlane32_swap_b32 v180, v181
buffer_store_dwordx2 v[180:181], v188, s[16:19], s64 offen sc1
s_lshl_b32 s62, s2, 10
s_add_u32 s62, s62, 31457280
s_cmp_eq_u32 s3, 0
s_cselect_b32 s62, s62, 268435456
buffer_store_dwordx4 v[224:227], v230, s[16:19], s62 offen sc1
v_accvgpr_write_b32 a224, v192
v_accvgpr_write_b32 a225, v193
v_accvgpr_write_b32 a226, v194
v_accvgpr_write_b32 a227, v195
v_accvgpr_write_b32 a228, v196
v_accvgpr_write_b32 a229, v197
v_accvgpr_write_b32 a230, v198
v_accvgpr_write_b32 a231, v199
v_accvgpr_write_b32 a232, v200
v_accvgpr_write_b32 a233, v201
v_accvgpr_write_b32 a234, v202
v_accvgpr_write_b32 a235, v203
v_accvgpr_write_b32 a236, v204
v_accvgpr_write_b32 a237, v205
v_accvgpr_write_b32 a238, v206
v_accvgpr_write_b32 a239, v207
v_accvgpr_write_b32 a240, v208
v_accvgpr_write_b32 a241, v209
v_accvgpr_write_b32 a242, v210
v_accvgpr_write_b32 a243, v211
v_accvgpr_write_b32 a244, v212
v_accvgpr_write_b32 a245, v213
v_accvgpr_write_b32 a246, v214
v_accvgpr_write_b32 a247, v215
v_accvgpr_write_b32 a248, v216
v_accvgpr_write_b32 a249, v217
v_accvgpr_write_b32 a250, v218
v_accvgpr_write_b32 a251, v219
v_accvgpr_write_b32 a252, v220
v_accvgpr_write_b32 a253, v221
v_accvgpr_write_b32 a254, v222
v_accvgpr_write_b32 a255, v223
s_add_u32 m0, s55, 18496
s_nop 0
buffer_load_dwordx4 v21, s[36:39], s52 offen lds
buffer_load_dwordx4 v28, s[36:39], s52 offen offset:1024 lds
buffer_load_dword v22, s[36:39], s52 offen offset:2048 lds
s_add_u32 s52, s52, 128
s_add_u32 m0, s55, 20800
s_nop 0
buffer_load_dwordx4 v21, s[36:39], s53 offen lds
buffer_load_dwordx4 v28, s[36:39], s53 offen offset:1024 lds
buffer_load_dword v29, s[36:39], s53 offen offset:2048 lds
s_add_u32 s53, s53, 128
s_add_u32 m0, s56, 73984
s_nop 0
buffer_load_dwordx4 v18, s[20:23], s54 offen lds
buffer_load_dwordx4 v19, s[20:23], s54 offen offset:1024 lds
buffer_load_dwordx4 v20, s[20:23], s54 offen offset:2048 lds
s_add_u32 s54, s54, 196608
s_waitcnt vmcnt(12) lgkmcnt(0)
s_barrier
ds_read_b128 a[0:3], v23
RD 4,23,2304
RD 8,23,4608
RD 12,23,6912
ds_read_b128 a[16:19], v24
ds_read_b128 a[20:23], v30
RD 24,30,2304
RD 28,30,4608
RD 32,30,6912
ds_read_b128 a[36:39], v31
TR 80,25,49664
TR 82,25,50176
TR 84,25,62080
TR 86,25,62592
TR 88,25,50688
TR 90,25,51200
TR 92,25,63104
TR 94,25,63616
TR 96,25,51712
TR 98,25,52224
TR 100,25,64128
TR 102,25,64640
s_waitcnt vmcnt(3) lgkmcnt(0)
s_barrier
v_mfma_f32_16x16x32_bf16 v[60:63], a[80:83], a[0:3], 0
TR 104,25,49696
s_add_u32 m0, s56, 86400
MAA 60,84,20
buffer_load_dwordx4 v18, s[20:23], s54 offen lds
v_mfma_f32_16x16x32_bf16 v[64:67], a[80:83], a[4:7], 0
s_sub_u32 s47, s47, 1
s_cbranch_scc1 .Lx19
.Lx19b:
MAA 64,84,24
buffer_load_dwordx4 v19, s[20:23], s54 offen offset:1024 lds
v_mfma_f32_16x16x32_bf16 v[68:71], a[80:83], a[8:11], 0
TR 106,25,50208
MAA 68,84,28
TR 108,25,62112
TR 110,25,62624
TR 112,25,50720
v_mfma_f32_16x16x32_bf16 v[72:75], a[80:83], a[12:15], 0
TR 114,25,51232
MAA 72,84,32
TR 116,25,63136
TR 118,25,63648
v_mfma_f32_16x16x32_bf16 v[104:107], a[88:91], a[12:15], 0
TR 120,25,51744
MAA 104,92,32
buffer_load_dwordx4 v20, s[20:23], s54 offen offset:2048 lds
v_mfma_f32_16x16x32_bf16 v[100:103], a[88:91], a[8:11], 0
s_add_u32 s54, s54, 196608
s_add_u32 m0, s55, 36992
MAA 100,92,28
buffer_load_dwordx4 v21, s[36:39], s52 offen lds
v_mfma_f32_16x16x32_bf16 v[96:99], a[88:91], a[4:7], 0
TR 122,25,52256
MAA 96,92,24
buffer_load_dwordx4 v28, s[36:39], s52 offen offset:1024 lds
v_mfma_f32_16x16x32_bf16 v[92:95], a[88:91], a[0:3], 0
TR 124,25,64160
MAA 92,92,20
buffer_load_dword v22, s[36:39], s52 offen offset:2048 lds
v_mfma_f32_16x16x32_bf16 v[124:127], a[0:3], a[96:99], 0
s_add_u32 s52, s52, 128
s_add_u32 m0, s55, 39296
MAA 124,20,100
buffer_load_dwordx4 v21, s[36:39], s53 offen lds
v_mfma_f32_16x16x32_bf16 v[128:131], a[4:7], a[96:99], 0
TR 126,25,64672
MAA 128,24,100
buffer_load_dwordx4 v28, s[36:39], s53 offen offset:1024 lds
v_mfma_f32_16x16x32_bf16 v[132:135], a[8:11], a[96:99], 0
RD 40,23,18496
MAA 132,28,100
RD 44,23,20800
RD 48,23,23104
RD 52,23,25408
v_mfma_f32_16x16x32_bf16 v[136:139], a[12:15], a[96:99], 0
RD 56,24,18496
MAA 136,32,100
buffer_load_dword v29, s[36:39], s53 offen offset:2048 lds
v_mfma_f32_16x16x32_bf16 v[156:159], a[16:19], a[96:99], 0
s_add_u32 s53, s53, 128
MAA 156,36,100
s_waitcnt vmcnt(6) lgkmcnt(5)
s_barrier
v_mfma_f32_16x16x32_bf16 v[76:79], a[104:107], a[0:3], 0
RD 60,30,18496
s_add_u32 m0, s56, 98816
MAA 76,108,20
buffer_load_dwordx4 v18, s[20:23], s54 offen lds
v_mfma_f32_16x16x32_bf16 v[80:83], a[104:107], a[4:7], 0
RD 64,30,20800
MAA 80,108,24
buffer_load_dwordx4 v19, s[20:23], s54 offen offset:1024 lds
v_mfma_f32_16x16x32_bf16 v[84:87], a[104:107], a[8:11], 0
RD 68,30,23104
MAA 84,108,28
RD 72,30,25408
v_mfma_f32_16x16x32_bf16 v[88:91], a[104:107], a[12:15], 0
RD 76,31,18496
MAA 88,108,32
buffer_load_dwordx4 v20, s[20:23], s54 offen offset:2048 lds
v_mfma_f32_16x16x32_bf16 v[244:247], a[104:107], a[16:19], 0
s_add_u32 s54, s54, 196608
s_add_u32 m0, s56, 111232
MAA 244,108,36
buffer_load_dwordx4 v18, s[20:23], s54 offen lds
v_mfma_f32_16x16x32_bf16 v[120:123], a[112:115], a[12:15], 0
ds_read_b64_tr_b16 a[80:81], v25
MAA 120,116,32
TR 82,25,512
v_mfma_f32_16x16x32_bf16 v[116:119], a[112:115], a[8:11], 0
TR 84,25,12416
MAA 116,116,28
buffer_load_dwordx4 v19, s[20:23], s54 offen offset:1024 lds
v_mfma_f32_16x16x32_bf16 v[112:115], a[112:115], a[4:7], 0
TR 86,25,12928
MAA 112,116,24
buffer_load_dwordx4 v20, s[20:23], s54 offen offset:2048 lds
v_mfma_f32_16x16x32_bf16 v[108:111], a[112:115], a[0:3], 0
TR 88,25,1024
s_add_u32 s54, s54, 196608
MAA 108,116,20
TR 90,25,1536
v_mfma_f32_16x16x32_bf16 v[140:143], a[0:3], a[120:123], 0
TR 92,25,13440
s_add_u32 m0, s55, 55488
MAA 140,20,124
buffer_load_dwordx4 v21, s[36:39], s52 offen lds
v_mfma_f32_16x16x32_bf16 v[144:147], a[4:7], a[120:123], 0
TR 94,25,13952
MAA 144,24,124
buffer_load_dwordx4 v28, s[36:39], s52 offen offset:1024 lds
v_mfma_f32_16x16x32_bf16 v[148:151], a[8:11], a[120:123], 0
TR 96,25,2048
MAA 148,28,124
TR 98,25,2560
v_mfma_f32_16x16x32_bf16 v[152:155], a[12:15], a[120:123], 0
TR 100,25,14464
MAA 152,32,124
buffer_load_dword v22, s[36:39], s52 offen offset:2048 lds
v_mfma_f32_16x16x32_bf16 v[160:163], a[16:19], a[120:123], 0
TR 102,25,14976
s_add_u32 s52, s52, 128
MAA 160,36,124
s_waitcnt vmcnt(9) lgkmcnt(8)
s_barrier
MAA 60,80,40
TR 104,25,32
s_add_u32 m0, s55, 57792
MAA 60,84,60
buffer_load_dwordx4 v21, s[36:39], s53 offen lds
MAA 64,84,64
s_sub_u32 s47, s47, 1
s_cbranch_scc1 .Lx20
.Lx20b:
MAA 64,80,44
buffer_load_dwordx4 v28, s[36:39], s53 offen offset:1024 lds
MAA 68,80,48
TR 106,25,544
MAA 68,84,68
TR 108,25,12448
TR 110,25,12960
TR 112,25,1056
MAA 72,84,72
TR 114,25,1568
MAA 72,80,52
TR 116,25,13472
TR 118,25,13984
s_waitcnt lgkmcnt(8)
MAA 104,88,52
TR 120,25,2080
MAA 104,92,72
buffer_load_dword v29, s[36:39], s53 offen offset:2048 lds
MAA 100,92,68
s_add_u32 s53, s53, 128
s_add_u32 m0, s56, 123648
MAA 100,88,48
buffer_load_dwordx4 v18, s[20:23], s54 offen lds
MAA 96,88,44
TR 122,25,2592
MAA 96,92,64
buffer_load_dwordx4 v19, s[20:23], s54 offen offset:1024 lds
MAA 92,92,60
TR 124,25,14496
MAA 92,88,40
buffer_load_dwordx4 v20, s[20:23], s54 offen offset:2048 lds
MAA 124,40,96
s_add_u32 s54, s54, 196608
s_add_u32 m0, s56, 136064
MAA 124,60,100
buffer_load_dwordx4 v18, s[20:23], s54 offen lds
MAA 128,64,100
TR 126,25,15008
MAA 128,44,96
buffer_load_dwordx4 v19, s[20:23], s54 offen offset:1024 lds
MAA 132,48,96
RD 0,23,36992
MAA 132,68,100
RD 4,23,39296
RD 8,23,41600
RD 12,23,43904
MAA 136,72,100
RD 16,24,36992
MAA 136,52,96
buffer_load_dwordx4 v20, s[20:23], s54 offen offset:2048 lds
MAA 156,56,96
s_add_u32 s54, s54, 196608
MAA 156,76,100
s_waitcnt vmcnt(12) lgkmcnt(5)
s_barrier
MAA 76,104,40
RD 20,30,36992
s_add_u32 m0, s55, 0
MAA 76,108,60
buffer_load_dwordx4 v21, s[36:39], s52 offen lds
MAA 80,108,64
RD 24,30,39296
MAA 80,104,44
buffer_load_dwordx4 v28, s[36:39], s52 offen offset:1024 lds
MAA 84,104,48
RD 28,30,41600
MAA 84,108,68
RD 32,30,43904
RD 36,31,36992
MAA 88,108,72
TR 80,25,24832
MAA 88,104,52
buffer_load_dword v22, s[36:39], s52 offen offset:2048 lds
MAA 244,104,56
s_add_u32 s52, s52, 128
s_add_u32 m0, s55, 2304
MAA 244,108,76
buffer_load_dwordx4 v21, s[36:39], s53 offen lds
MAA 120,116,72
TR 82,25,25344
MAA 120,112,52
buffer_load_dwordx4 v28, s[36:39], s53 offen offset:1024 lds
MAA 116,112,48
TR 84,25,37248
MAA 116,116,68
TR 86,25,37760
TR 88,25,25856
MAA 112,116,64
TR 90,25,26368
MAA 112,112,44
buffer_load_dword v29, s[36:39], s53 offen offset:2048 lds
MAA 108,112,40
s_add_u32 s53, s53, 128
s_add_u32 m0, s56, 73984
MAA 108,116,60
buffer_load_dwordx4 v18, s[20:23], s54 offen lds
MAA 140,60,124
TR 92,25,38272
MAA 140,40,120
buffer_load_dwordx4 v19, s[20:23], s54 offen offset:1024 lds
MAA 144,44,120
TR 94,25,38784
MAA 144,64,124
buffer_load_dwordx4 v20, s[20:23], s54 offen offset:2048 lds
MAA 148,68,124
TR 96,25,26880
s_add_u32 s54, s54, 196608
MAA 148,48,120
TR 98,25,27392
TR 100,25,39296
MAA 152,52,120
TR 102,25,39808
MAA 152,72,124
buffer_load_dword v37, v34, s[40:43], 0 offen sc1
MAA 160,76,124
MAA 160,56,120
s_waitcnt vmcnt(16) lgkmcnt(8)
s_barrier
MAA 60,80,0
TR 104,25,24864
s_add_u32 m0, s56, 86400
MAA 60,84,20
buffer_load_dwordx4 v18, s[20:23], s54 offen lds
MAA 64,84,24
s_sub_u32 s47, s47, 1
s_cbranch_scc1 .Lx21
.Lx21b:
MAA 64,80,4
buffer_load_dwordx4 v19, s[20:23], s54 offen offset:1024 lds
MAA 68,80,8
TR 106,25,25376
MAA 68,84,28
TR 108,25,37280
TR 110,25,37792
TR 112,25,25888
MAA 72,84,32
TR 114,25,26400
MAA 72,80,12
TR 116,25,38304
TR 118,25,38816
s_waitcnt lgkmcnt(8)
MAA 104,88,12
TR 120,25,26912
MAA 104,92,32
buffer_load_dwordx4 v20, s[20:23], s54 offen offset:2048 lds
MAA 100,92,28
s_add_u32 s54, s54, 196608
s_add_u32 m0, s55, 18496
MAA 100,88,8
buffer_load_dwordx4 v21, s[36:39], s52 offen lds
MAA 96,88,4
TR 122,25,27424
MAA 96,92,24
buffer_load_dwordx4 v28, s[36:39], s52 offen offset:1024 lds
MAA 92,92,20
TR 124,25,39328
MAA 92,88,0
buffer_load_dword v22, s[36:39], s52 offen offset:2048 lds
MAA 124,0,96
s_add_u32 s52, s52, 128
s_add_u32 m0, s55, 20800
MAA 124,20,100
buffer_load_dwordx4 v21, s[36:39], s53 offen lds
MAA 128,24,100
TR 126,25,39840
MAA 128,4,96
buffer_load_dwordx4 v28, s[36:39], s53 offen offset:1024 lds
MAA 132,8,96
RD 40,23,55488
MAA 132,28,100
RD 44,23,57792
RD 48,23,60096
RD 52,23,62400
MAA 136,32,100
RD 56,24,55488
MAA 136,12,96
buffer_load_dword v29, s[36:39], s53 offen offset:2048 lds
MAA 156,16,96
s_add_u32 s53, s53, 128
MAA 156,36,100
s_waitcnt vmcnt(19) lgkmcnt(5)
s_barrier
MAA 76,104,0
RD 60,30,55488
s_add_u32 m0, s56, 98816
MAA 76,108,20
buffer_load_dwordx4 v18, s[20:23], s54 offen lds
MAA 80,108,24
RD 64,30,57792
MAA 80,104,4
buffer_load_dwordx4 v19, s[20:23], s54 offen offset:1024 lds
MAA 84,104,8
RD 68,30,60096
MAA 84,108,28
RD 72,30,62400
MAA 88,108,32
RD 76,31,55488
MAA 88,104,12
buffer_load_dwordx4 v20, s[20:23], s54 offen offset:2048 lds
MAA 244,104,16
s_add_u32 s54, s54, 196608
s_add_u32 m0, s55, 36992
MAA 244,108,36
buffer_load_dwordx4 v21, s[36:39], s52 offen lds
MAA 120,116,32
TR 80,25,49664
MAA 120,112,12
TR 82,25,50176
MAA 116,112,8
TR 84,25,62080
MAA 116,116,28
buffer_load_dwordx4 v28, s[36:39], s52 offen offset:1024 lds
MAA 112,116,24
TR 86,25,62592
MAA 112,112,4
buffer_load_dword v22, s[36:39], s52 offen offset:2048 lds
MAA 108,112,0
TR 88,25,50688
s_add_u32 s52, s52, 128
MAA 108,116,20
TR 90,25,51200
MAA 140,20,124
TR 92,25,63104
s_add_u32 m0, s55, 39296
MAA 140,0,120
buffer_load_dwordx4 v21, s[36:39], s53 offen lds
MAA 144,4,120
TR 94,25,63616
MAA 144,24,124
buffer_load_dwordx4 v28, s[36:39], s53 offen offset:1024 lds
MAA 148,28,124
TR 96,25,51712
MAA 148,8,120
.Lpad7:
s_cbranch_execz .Lt0r
TR 98,25,52224
MAA 152,12,120
TR 100,25,64128
MAA 152,32,124
buffer_load_dword v29, s[36:39], s53 offen offset:2048 lds
MAA 160,36,124
TR 102,25,64640
s_add_u32 s53, s53, 128
MAA 160,16,120
s_waitcnt vmcnt(22) lgkmcnt(8)
s_barrier
MAA 60,80,40
TR 104,25,49696
MAA 60,84,60
TR 106,25,50208
MAA 64,84,64
TR 108,25,62112
s_add_u32 m0, s56, 111232
MAA 64,80,44
buffer_load_dwordx4 v18, s[20:23], s54 offen lds
MAA 68,80,48
s_sub_u32 s47, s47, 1
s_cbranch_scc1 .Lx22
.Lx22b:
MAA 68,84,68
TR 110,25,62624
MAA 72,84,72
TR 112,25,50720
MAA 72,80,52
TR 114,25,51232
s_waitcnt lgkmcnt(6)
MAA 104,88,52
TR 116,25,63136
MAA 104,92,72
buffer_load_dwordx4 v19, s[20:23], s54 offen offset:1024 lds
MAA 100,92,68
TR 118,25,63648
MAA 100,88,48
buffer_load_dwordx4 v20, s[20:23], s54 offen offset:2048 lds
MAA 96,88,44
TR 120,25,51744
s_add_u32 s54, s54, 196608
MAA 96,92,64
TR 122,25,52256
MAA 92,92,60
TR 124,25,64160
s_add_u32 m0, s55, 55488
MAA 92,88,40
buffer_load_dwordx4 v21, s[36:39], s52 offen lds
MAA 124,40,96
TR 126,25,64672
MAA 124,60,100
ds_read_b128 a[0:3], v23
MAA 128,64,100
RD 4,23,2304
MAA 128,44,96
buffer_load_dwordx4 v28, s[36:39], s52 offen offset:1024 lds
MAA 132,48,96
RD 8,23,4608
MAA 132,68,100
RD 12,23,6912
MAA 136,72,100
ds_read_b128 a[16:19], v24
MAA 136,52,96
buffer_load_dword v22, s[36:39], s52 offen offset:2048 lds
MAA 156,56,96
s_add_u32 s52, s52, 128
MAA 156,76,100
s_waitcnt vmcnt(21) lgkmcnt(5)
s_barrier
v_cmp_gt_u32 vcc, v35, v37
s_nop 0
s_cbranch_vccnz .Lsp23
.Lsp23b:
v_mov_b32 v37, 0
MAA 76,104,40
ds_read_b128 a[20:23], v30
MAA 76,108,60
buffer_atomic_add v38, v32, s[16:19], 0 offen
MAA 80,108,64
RD 24,30,2304
MAA 80,104,44
RD 28,30,4608
MAA 84,104,48
RD 32,30,6912
s_add_u32 m0, s56, 123648
MAA 84,108,68
buffer_load_dwordx4 v18, s[20:23], s54 offen lds
MAA 88,108,72
ds_read_b128 a[36:39], v31
MAA 88,104,52
ds_read_b64_tr_b16 a[80:81], v25
MAA 244,104,56
TR 82,25,512
MAA 244,108,76
buffer_load_dwordx4 v19, s[20:23], s54 offen offset:1024 lds
MAA 120,116,72
TR 84,25,12416
MAA 120,112,52
TR 86,25,12928
MAA 116,112,48
MAA 116,116,68
buffer_load_dwordx4 v20, s[20:23], s54 offen offset:2048 lds
MAA 112,116,64
s_add_u32 s54, s54, 196608
s_add_u32 m0, s55, 57792
MAA 112,112,44
buffer_load_dwordx4 v21, s[36:39], s53 offen lds
MAA 108,112,40
TR 88,25,1024
MAA 108,116,60
TR 90,25,1536
MAA 140,60,124
TR 92,25,13440
MAA 140,40,120
buffer_load_dwordx4 v28, s[36:39], s53 offen offset:1024 lds
MAA 144,44,120
TR 94,25,13952
MAA 144,64,124
TR 96,25,2048
MAA 148,68,124
TR 98,25,2560
MAA 148,48,120
buffer_load_dword v29, s[36:39], s53 offen offset:2048 lds
MAA 152,52,120
TR 100,25,14464
s_add_u32 s53, s53, 128
MAA 152,72,124
TR 102,25,14976
MAA 160,76,124
MAA 160,56,120
s_waitcnt vmcnt(22) lgkmcnt(8)
s_barrier
MAA 60,80,0
TR 104,25,32
MAA 60,84,20
TR 106,25,544
MAA 64,84,24
TR 108,25,12448
s_add_u32 m0, s56, 136064
MAA 64,80,4
buffer_load_dwordx4 v18, s[20:23], s54 offen lds
MAA 68,80,8
s_sub_u32 s47, s47, 1
s_cbranch_scc1 .Lx24
.Lx24b:
MAA 68,84,28
TR 110,25,12960
MAA 72,84,32
TR 112,25,1056
MAA 72,80,12
TR 114,25,1568
s_waitcnt lgkmcnt(6)
MAA 104,88,12
TR 116,25,13472
MAA 104,92,32
buffer_load_dwordx4 v19, s[20:23], s54 offen offset:1024 lds
MAA 100,92,28
TR 118,25,13984
MAA 100,88,8
buffer_load_dwordx4 v20, s[20:23], s54 offen offset:2048 lds
MAA 96,88,4
TR 120,25,2080
s_add_u32 s54, s54, 196608
MAA 96,92,24
TR 122,25,2592
MAA 92,92,20
TR 124,25,14496
s_add_u32 m0, s55, 0
MAA 92,88,0
buffer_load_dwordx4 v21, s[36:39], s52 offen lds
MAA 124,0,96
TR 126,25,15008
MAA 124,20,100
RD 40,23,18496
MAA 128,24,100
RD 44,23,20800
MAA 128,4,96
buffer_load_dwordx4 v28, s[36:39], s52 offen offset:1024 lds
MAA 132,8,96
RD 48,23,23104
MAA 132,28,100
RD 52,23,25408
MAA 136,32,100
RD 56,24,18496
MAA 136,12,96
buffer_load_dword v22, s[36:39], s52 offen offset:2048 lds
MAA 156,16,96
s_add_u32 s52, s52, 128
MAA 156,36,100
s_waitcnt vmcnt(16) lgkmcnt(5)
s_barrier
MAA 76,104,0
RD 60,30,18496
MAA 76,108,20
RD 64,30,20800
MAA 80,108,24
RD 68,30,23104
s_add_u32 m0, s56, 73984
MAA 80,104,4
buffer_load_dwordx4 v18, s[20:23], s54 offen lds
MAA 84,104,8
RD 72,30,25408
MAA 84,108,28
RD 76,31,18496
MAA 88,108,32
MAA 88,104,12
buffer_load_dwordx4 v19, s[20:23], s54 offen offset:1024 lds
MAA 244,104,16
TR 80,25,24832
MAA 244,108,36
TR 82,25,25344
MAA 120,116,32
TR 84,25,37248
MAA 120,112,12
buffer_load_dwordx4 v20, s[20:23], s54 offen offset:2048 lds
MAA 116,112,8
TR 86,25,37760
s_add_u32 s54, s54, 196608
MAA 116,116,28
MAA 112,116,24
TR 88,25,25856
MAA 112,112,4
TR 90,25,26368
MAA 108,112,0
TR 92,25,38272
s_add_u32 m0, s55, 2304
MAA 108,116,20
buffer_load_dwordx4 v21, s[36:39], s53 offen lds
MAA 140,20,124
TR 94,25,38784
MAA 140,0,120
MAA 144,4,120
TR 96,25,26880
MAA 144,24,124
buffer_load_dwordx4 v28, s[36:39], s53 offen offset:1024 lds
MAA 148,28,124
TR 98,25,27392
MAA 148,8,120
TR 100,25,39296
MAA 152,12,120
TR 102,25,39808
MAA 152,32,124
buffer_load_dword v29, s[36:39], s53 offen offset:2048 lds
MAA 160,36,124
s_add_u32 s53, s53, 128
MAA 160,16,120
s_waitcnt lgkmcnt(8)
s_barrier
MAA 60,80,40
TR 104,25,24864
MAA 60,84,60
TR 106,25,25376
MAA 64,84,64
TR 108,25,37280
s_add_u32 m0, s56, 86400
MAA 64,80,44
buffer_load_dwordx4 v18, s[20:23], s54 offen lds
MAA 68,80,48
s_sub_u32 s47, s47, 1
s_cbranch_scc1 .Lx25
.Lx25b:
MAA 68,84,68
TR 110,25,37792
MAA 72,84,72
TR 112,25,25888
MAA 72,80,52
TR 114,25,26400
s_waitcnt lgkmcnt(6)
MAA 104,88,52
TR 116,25,38304
MAA 104,92,72
buffer_load_dwordx4 v19, s[20:23], s54 offen offset:1024 lds
MAA 100,92,68
TR 118,25,38816
MAA 100,88,48
buffer_load_dwordx4 v20, s[20:23], s54 offen offset:2048 lds
MAA 96,88,44
TR 120,25,26912
s_add_u32 s54, s54, 196608
MAA 96,92,64
TR 122,25,27424
MAA 92,92,60
TR 124,25,39328
s_add_u32 m0, s55, 18496
MAA 92,88,40
buffer_load_dwordx4 v21, s[36:39], s52 offen lds
MAA 124,40,96
TR 126,25,39840
MAA 124,60,100
RD 0,23,36992
MAA 128,64,100
RD 4,23,39296
MAA 128,44,96
buffer_load_dwordx4 v28, s[36:39], s52 offen offset:1024 lds
MAA 132,48,96
RD 8,23,41600
MAA 132,68,100
RD 12,23,43904
MAA 136,72,100
RD 16,24,36992
MAA 136,52,96
buffer_load_dword v22, s[36:39], s52 offen offset:2048 lds
MAA 156,56,96
s_add_u32 s52, s52, 128
MAA 156,76,100
s_waitcnt vmcnt(15) lgkmcnt(5)
s_barrier
MAA 76,104,40
RD 20,30,36992
s_add_u32 m0, s56, 98816
MAA 76,108,60
buffer_load_dwordx4 v18, s[20:23], s54 offen lds
MAA 80,108,64
RD 24,30,39296
MAA 80,104,44
RD 28,30,41600
MAA 84,104,48
RD 32,30,43904
MAA 84,108,68
buffer_load_dwordx4 v19, s[20:23], s54 offen offset:1024 lds
MAA 88,108,72
RD 36,31,36992
MAA 88,104,52
TR 80,25,49664
MAA 244,104,56
MAA 244,108,76
buffer_load_dwordx4 v20, s[20:23], s54 offen offset:2048 lds
MAA 120,116,72
TR 82,25,50176
s_add_u32 s54, s54, 196608
MAA 120,112,52
TR 84,25,62080
MAA 116,112,48
TR 86,25,62592
s_add_u32 m0, s55, 20800
MAA 116,116,68
buffer_load_dwordx4 v21, s[36:39], s53 offen lds
MAA 112,116,64
TR 88,25,50688
MAA 112,112,44
buffer_load_dwordx4 v28, s[36:39], s53 offen offset:1024 lds
MAA 108,112,40
TR 90,25,51200
MAA 108,116,60
TR 92,25,63104
MAA 140,60,124
MAA 140,40,120
buffer_load_dword v29, s[36:39], s53 offen offset:2048 lds
MAA 144,44,120
TR 94,25,63616
s_add_u32 s53, s53, 128
MAA 144,64,124
TR 96,25,51712
MAA 148,68,124
TR 98,25,52224
MAA 148,48,120
buffer_atomic_add v37, v33, s[16:19], 0 offen sc0
MAA 152,52,120
TR 100,25,64128
MAA 152,72,124
TR 102,25,64640
MAA 160,76,124
MAA 160,56,120
s_waitcnt lgkmcnt(8)
s_barrier
MAA 60,80,0
TR 104,25,49696
MAA 60,84,20
TR 106,25,50208
MAA 64,84,24
TR 108,25,62112
s_add_u32 m0, s56, 111232
MAA 64,80,4
buffer_load_dwordx4 v18, s[20:23], s54 offen lds
MAA 68,80,8
s_sub_u32 s47, s47, 1
s_cbranch_scc1 .Lx26
.Lx26b:
MAA 68,84,28
TR 110,25,62624
MAA 72,84,32
TR 112,25,50720
MAA 72,80,12
TR 114,25,51232
s_waitcnt lgkmcnt(6)
MAA 104,88,12
TR 116,25,63136
MAA 104,92,32
buffer_load_dwordx4 v19, s[20:23], s54 offen offset:1024 lds
MAA 100,92,28
TR 118,25,63648
MAA 100,88,8
buffer_load_dwordx4 v20, s[20:23], s54 offen offset:2048 lds
MAA 96,88,4
TR 120,25,51744
s_add_u32 s54, s54, 196608
MAA 96,92,24
TR 122,25,52256
MAA 92,92,20
TR 124,25,64160
s_add_u32 m0, s55, 36992
MAA 92,88,0
buffer_load_dwordx4 v21, s[36:39], s52 offen lds
MAA 124,0,96
TR 126,25,64672
MAA 124,20,100
RD 40,23,55488
MAA 128,24,100
RD 44,23,57792
MAA 128,4,96
buffer_load_dwordx4 v28, s[36:39], s52 offen offset:1024 lds
MAA 132,8,96
RD 48,23,60096
MAA 132,28,100
RD 52,23,62400
MAA 136,32,100
RD 56,24,55488
MAA 136,12,96
buffer_load_dword v22, s[36:39], s52 offen offset:2048 lds
MAA 156,16,96
s_add_u32 s52, s52, 128
MAA 156,36,100
s_waitcnt vmcnt(16) lgkmcnt(5)
s_barrier
MAA 76,104,0
RD 60,30,55488
MAA 76,108,20
RD 64,30,57792
MAA 80,108,24
RD 68,30,60096
s_add_u32 m0, s56, 123648
MAA 80,104,4
buffer_load_dwordx4 v18, s[20:23], s54 offen lds
MAA 84,104,8
RD 72,30,62400
MAA 84,108,28
RD 76,31,55488
MAA 88,108,32
MAA 88,104,12
buffer_load_dwordx4 v19, s[20:23], s54 offen offset:1024 lds
MAA 244,104,16
ds_read_b64_tr_b16 a[80:81], v25
MAA 244,108,36
TR 82,25,512
MAA 120,116,32
TR 84,25,12416
MAA 120,112,12
buffer_load_dwordx4 v20, s[20:23], s54 offen offset:2048 lds
MAA 116,112,8
TR 86,25,12928
s_add_u32 s54, s54, 196608
MAA 116,116,28
MAA 112,116,24
TR 88,25,1024
MAA 112,112,4
TR 90,25,1536
MAA 108,112,0
TR 92,25,13440
s_add_u32 m0, s55, 39296
MAA 108,116,20
buffer_load_dwordx4 v21, s[36:39], s53 offen lds
MAA 140,20,124
TR 94,25,13952
MAA 140,0,120
MAA 144,4,120
TR 96,25,2048
MAA 144,24,124
buffer_load_dwordx4 v28, s[36:39], s53 offen offset:1024 lds
MAA 148,28,124
TR 98,25,2560
MAA 148,8,120
TR 100,25,14464
MAA 152,12,120
TR 102,25,14976
MAA 152,32,124
buffer_load_dword v29, s[36:39], s53 offen offset:2048 lds
MAA 160,36,124
s_add_u32 s53, s53, 128
MAA 160,16,120
s_waitcnt lgkmcnt(8)
s_barrier
MAA 60,80,40
TR 104,25,32
MAA 60,84,60
TR 106,25,544
MAA 64,84,64
TR 108,25,12448
s_add_u32 m0, s56, 136064
MAA 64,80,44
buffer_load_dwordx4 v18, s[20:23], s54 offen lds
MAA 68,80,48
s_sub_u32 s47, s47, 1
s_cbranch_scc1 .Lx27
.Lx27b:
MAA 68,84,68
TR 110,25,12960
MAA 72,84,72
TR 112,25,1056
MAA 72,80,52
TR 114,25,1568
s_waitcnt lgkmcnt(6)
MAA 104,88,52
TR 116,25,13472
MAA 104,92,72
buffer_load_dwordx4 v19, s[20:23], s54 offen offset:1024 lds
MAA 100,92,68
TR 118,25,13984
MAA 100,88,48
buffer_load_dwordx4 v20, s[20:23], s54 offen offset:2048 lds
MAA 96,88,44
TR 120,25,2080
s_add_u32 s54, s54, 196608
MAA 96,92,64
TR 122,25,2592
MAA 92,92,60
TR 124,25,14496
s_add_u32 m0, s55, 55488
MAA 92,88,40
buffer_load_dwordx4 v21, s[36:39], s52 offen lds
MAA 124,40,96
TR 126,25,15008
MAA 124,60,100
ds_read_b128 a[0:3], v23
MAA 128,64,100
RD 4,23,2304
MAA 128,44,96
buffer_load_dwordx4 v28, s[36:39], s52 offen offset:1024 lds
MAA 132,48,96
RD 8,23,4608
MAA 132,68,100
RD 12,23,6912
MAA 136,72,100
ds_read_b128 a[16:19], v24
MAA 136,52,96
buffer_load_dword v22, s[36:39], s52 offen offset:2048 lds
MAA 156,56,96
.Lpad8:
s_cbranch_execz .Lt0r
s_add_u32 s52, s52, 128
MAA 156,76,100
s_waitcnt vmcnt(18)
v_cmp_gt_u32 vcc, v36, v37
s_nop 0
s_cbranch_vccnz .Lsp28
.Lsp28b:
s_waitcnt vmcnt(15) lgkmcnt(5)
s_barrier
MAA 76,104,40
ds_read_b128 a[20:23], v30
s_add_u32 m0, s56, 73984
MAA 76,108,60
buffer_load_dwordx4 v18, s[20:23], s54 offen lds
MAA 80,108,64
RD 24,30,2304
MAA 80,104,44
RD 28,30,4608
MAA 84,104,48
RD 32,30,6912
MAA 84,108,68
buffer_load_dwordx4 v19, s[20:23], s54 offen offset:1024 lds
MAA 88,108,72
ds_read_b128 a[36:39], v31
MAA 88,104,52
TR 80,25,24832
MAA 244,104,56
MAA 244,108,76
buffer_load_dwordx4 v20, s[20:23], s54 offen offset:2048 lds
MAA 120,116,72
TR 82,25,25344
s_add_u32 s54, s54, 196608
MAA 120,112,52
TR 84,25,37248
MAA 116,112,48
TR 86,25,37760
s_add_u32 m0, s55, 57792
MAA 116,116,68
buffer_load_dwordx4 v21, s[36:39], s53 offen lds
MAA 112,116,64
TR 88,25,25856
MAA 112,112,44
buffer_load_dwordx4 v28, s[36:39], s53 offen offset:1024 lds
MAA 108,112,40
TR 90,25,26368
MAA 108,116,60
TR 92,25,38272
MAA 140,60,124
MAA 140,40,120
buffer_load_dword v29, s[36:39], s53 offen offset:2048 lds
MAA 144,44,120
TR 94,25,38784
s_add_u32 s53, s53, 128
MAA 144,64,124
TR 96,25,26880
MAA 148,68,124
TR 98,25,27392
MAA 148,48,120
buffer_load_dwordx4 v[164:167], v26, s[16:19], s75 offen sc1
MAA 152,52,120
TR 100,25,39296
MAA 152,72,124
TR 102,25,39808
MAA 160,76,124
MAA 160,56,120
s_waitcnt lgkmcnt(8)
s_barrier
MAA 60,80,0
TR 104,25,24864
s_add_u32 m0, s56, 86400
MAA 60,84,20
buffer_load_dwordx4 v18, s[20:23], s54 offen lds
MAA 64,84,24
s_sub_u32 s47, s47, 1
s_cbranch_scc1 .Lx29
.Lx29b:
MAA 64,80,4
TR 106,25,25376
TR 108,25,37280
MAA 68,80,8
TR 110,25,37792
MAA 68,84,28
buffer_load_dwordx4 v19, s[20:23], s54 offen offset:1024 lds
MAA 72,84,32
TR 112,25,25888
MAA 72,80,12
TR 114,25,26400
s_waitcnt lgkmcnt(6)
MAA 104,88,12
MAA 104,92,32
buffer_load_dwordx4 v20, s[20:23], s54 offen offset:2048 lds
MAA 100,92,28
s_add_u32 s54, s54, 196608
s_add_u32 m0, s55, 0
MAA 100,88,8
buffer_load_dwordx4 v21, s[36:39], s52 offen lds
MAA 96,88,4
TR 116,25,38304
MAA 96,92,24
TR 118,25,38816
TR 120,25,26912
MAA 92,92,20
TR 122,25,27424
MAA 92,88,0
buffer_load_dwordx4 v28, s[36:39], s52 offen offset:1024 lds
MAA 124,0,96
TR 124,25,39328
MAA 124,20,100
TR 126,25,39840
MAA 128,24,100
RD 40,23,18496
MAA 128,4,96
buffer_load_dword v22, s[36:39], s52 offen offset:2048 lds
MAA 132,8,96
RD 44,23,20800
s_add_u32 s52, s52, 128
MAA 132,28,100
buffer_load_dwordx4 v[168:171], v26, s[16:19], s75 offen offset:1024 sc1
MAA 136,32,100
RD 48,23,23104
MAA 136,12,96
RD 52,23,25408
RD 56,24,18496
MAA 156,16,96
MAA 156,36,100
s_waitcnt vmcnt(17) lgkmcnt(5)
s_barrier
MAA 76,104,0
RD 60,30,18496
s_add_u32 m0, s56, 98816
MAA 76,108,20
buffer_load_dwordx4 v18, s[20:23], s54 offen lds
MAA 80,108,24
RD 64,30,20800
MAA 80,104,4
RD 68,30,23104
MAA 84,104,8
RD 72,30,25408
MAA 84,108,28
buffer_load_dwordx4 v19, s[20:23], s54 offen offset:1024 lds
MAA 88,108,32
RD 76,31,18496
MAA 88,104,12
TR 80,25,49664
MAA 244,104,16
MAA 244,108,36
buffer_load_dwordx4 v20, s[20:23], s54 offen offset:2048 lds
MAA 120,116,32
TR 82,25,50176
s_add_u32 s54, s54, 196608
MAA 120,112,12
TR 84,25,62080
MAA 116,112,8
TR 86,25,62592
s_add_u32 m0, s55, 2304
MAA 116,116,28
buffer_load_dwordx4 v21, s[36:39], s53 offen lds
MAA 112,116,24
TR 88,25,50688
MAA 112,112,4
buffer_load_dwordx4 v28, s[36:39], s53 offen offset:1024 lds
MAA 108,112,0
TR 90,25,51200
MAA 108,116,20
TR 92,25,63104
MAA 140,20,124
MAA 140,0,120
buffer_load_dword v29, s[36:39], s53 offen offset:2048 lds
MAA 144,4,120
TR 94,25,63616
s_add_u32 s53, s53, 128
MAA 144,24,124
TR 96,25,51712
MAA 148,28,124
TR 98,25,52224
MAA 148,8,120
buffer_load_dwordx4 v[172:175], v26, s[16:19], s75 offen offset:2048 sc1
MAA 152,12,120
TR 100,25,64128
MAA 152,32,124
TR 102,25,64640
MAA 160,36,124
MAA 160,16,120
s_waitcnt lgkmcnt(8)
s_barrier
MAA 60,80,40
TR 104,25,49696
s_add_u32 m0, s56, 111232
MAA 60,84,60
buffer_load_dwordx4 v18, s[20:23], s54 offen lds
MAA 64,84,64
s_sub_u32 s47, s47, 1
s_cbranch_scc1 .Lx30
.Lx30b:
MAA 64,80,44
TR 106,25,50208
TR 108,25,62112
MAA 68,80,48
TR 110,25,62624
MAA 68,84,68
buffer_load_dwordx4 v19, s[20:23], s54 offen offset:1024 lds
MAA 72,84,72
TR 112,25,50720
MAA 72,80,52
TR 114,25,51232
s_waitcnt lgkmcnt(6)
MAA 104,88,52
MAA 104,92,72
buffer_load_dwordx4 v20, s[20:23], s54 offen offset:2048 lds
MAA 100,92,68
s_add_u32 s54, s54, 196608
s_add_u32 m0, s55, 18496
MAA 100,88,48
buffer_load_dwordx4 v21, s[36:39], s52 offen lds
MAA 96,88,44
TR 116,25,63136
MAA 96,92,64
TR 118,25,63648
TR 120,25,51744
MAA 92,92,60
TR 122,25,52256
MAA 92,88,40
buffer_load_dwordx4 v28, s[36:39], s52 offen offset:1024 lds
MAA 124,40,96
TR 124,25,64160
MAA 124,60,100
TR 126,25,64672
MAA 128,64,100
RD 0,23,36992
MAA 128,44,96
buffer_load_dword v22, s[36:39], s52 offen offset:2048 lds
MAA 132,48,96
RD 4,23,39296
s_add_u32 s52, s52, 128
MAA 132,68,100
buffer_load_dwordx4 v[176:179], v26, s[16:19], s75 offen offset:3072 sc1
MAA 136,72,100
RD 8,23,41600
s_add_u32 s75, s75, 4096
MAA 136,52,96
RD 12,23,43904
RD 16,24,36992
MAA 156,56,96
MAA 156,76,100
s_waitcnt vmcnt(18) lgkmcnt(5)
s_barrier
MAA 76,104,40
RD 20,30,36992
s_add_u32 m0, s56, 123648
MAA 76,108,60
buffer_load_dwordx4 v18, s[20:23], s54 offen lds
MAA 80,108,64
RD 24,30,39296
s_waitcnt vmcnt(15)
v_add_f32 v164, v164, v168
MAA 80,104,44
RD 28,30,41600
MAA 84,104,48
RD 32,30,43904
MAA 84,108,68
buffer_load_dwordx4 v19, s[20:23], s54 offen offset:1024 lds
MAA 88,108,72
RD 36,31,36992
MAA 88,104,52
ds_read_b64_tr_b16 a[80:81], v25
v_add_f32 v165, v165, v169
MAA 244,104,56
MAA 244,108,76
buffer_load_dwordx4 v20, s[20:23], s54 offen offset:2048 lds
MAA 120,116,72
TR 82,25,512
s_add_u32 s54, s54, 196608
MAA 120,112,52
TR 84,25,12416
MAA 116,112,48
TR 86,25,12928
s_add_u32 m0, s55, 20800
MAA 116,116,68
buffer_load_dwordx4 v21, s[36:39], s53 offen lds
MAA 112,116,64
TR 88,25,1024
MAA 112,112,44
buffer_load_dwordx4 v28, s[36:39], s53 offen offset:1024 lds
MAA 108,112,40
TR 90,25,1536
v_add_f32 v166, v166, v170
MAA 108,116,60
TR 92,25,13440
MAA 140,60,124
MAA 140,40,120
buffer_load_dword v29, s[36:39], s53 offen offset:2048 lds
MAA 144,44,120
TR 94,25,13952
s_add_u32 s53, s53, 128
MAA 144,64,124
TR 96,25,2048
MAA 148,68,124
TR 98,25,2560
v_add_f32 v167, v167, v171
MAA 148,48,120
buffer_load_dwordx4 v[180:183], v26, s[16:19], s75 offen sc1
MAA 152,52,120
TR 100,25,14464
MAA 152,72,124
TR 102,25,14976
MAA 160,76,124
MAA 160,56,120
s_waitcnt lgkmcnt(8)
s_barrier
MAA 60,80,0
TR 104,25,32
s_add_u32 m0, s56, 136064
MAA 60,84,20
buffer_load_dwordx4 v18, s[20:23], s54 offen lds
MAA 64,84,24
s_sub_u32 s47, s47, 1
s_cbranch_scc1 .Lx31
.Lx31b:
MAA 64,80,4
TR 106,25,544
TR 108,25,12448
MAA 68,80,8
TR 110,25,12960
s_waitcnt vmcnt(15)
v_add_f32 v164, v164, v172
MAA 68,84,28
buffer_load_dwordx4 v19, s[20:23], s54 offen offset:1024 lds
MAA 72,84,32
TR 112,25,1056
MAA 72,80,12
TR 114,25,1568
s_waitcnt lgkmcnt(6)
MAA 104,88,12
v_add_f32 v165, v165, v173
MAA 104,92,32
buffer_load_dwordx4 v20, s[20:23], s54 offen offset:2048 lds
MAA 100,92,28
s_add_u32 s54, s54, 196608
s_add_u32 m0, s55, 36992
MAA 100,88,8
buffer_load_dwordx4 v21, s[36:39], s52 offen lds
MAA 96,88,4
TR 116,25,13472
MAA 96,92,24
TR 118,25,13984
TR 120,25,2080
MAA 92,92,20
TR 122,25,2592
v_add_f32 v166, v166, v174
MAA 92,88,0
buffer_load_dwordx4 v28, s[36:39], s52 offen offset:1024 lds
MAA 124,0,96
TR 124,25,14496
MAA 124,20,100
TR 126,25,15008
MAA 128,24,100
RD 40,23,55488
v_add_f32 v167, v167, v175
MAA 128,4,96
buffer_load_dword v22, s[36:39], s52 offen offset:2048 lds
MAA 132,8,96
RD 44,23,57792
s_add_u32 s52, s52, 128
MAA 132,28,100
buffer_load_dwordx4 v[184:187], v26, s[16:19], s75 offen offset:1024 sc1
MAA 136,32,100
RD 48,23,60096
MAA 136,12,96
RD 52,23,62400
RD 56,24,55488
MAA 156,16,96
MAA 156,36,100
s_waitcnt vmcnt(18) lgkmcnt(5)
s_barrier
MAA 76,104,0
RD 60,30,55488
s_waitcnt vmcnt(14)
v_add_f32 v164, v164, v176
MAA 76,108,20
RD 64,30,57792
s_add_u32 m0, s56, 73984
MAA 80,108,24
buffer_load_dwordx4 v18, s[20:23], s54 offen lds
MAA 80,104,4
RD 68,30,60096
v_add_f32 v165, v165, v177
MAA 84,104,8
RD 72,30,62400
v_add_f32 v166, v166, v178
MAA 84,108,28
buffer_load_dwordx4 v19, s[20:23], s54 offen offset:1024 lds
MAA 88,108,32
RD 76,31,55488
v_add_f32 v167, v167, v179
MAA 88,104,12
TR 80,25,24832
MAA 244,104,16
buffer_load_dwordx4 v20, s[20:23], s54 offen offset:2048 lds
MAA 244,108,36
TR 82,25,25344
s_add_u32 s54, s54, 196608
MAA 120,116,32
TR 84,25,37248
s_add_u32 m0, s55, 39296
MAA 120,112,12
buffer_load_dwordx4 v21, s[36:39], s53 offen lds
MAA 116,112,8
TR 86,25,37760
MAA 116,116,28
TR 88,25,25856
MAA 112,116,24
buffer_load_dwordx4 v28, s[36:39], s53 offen offset:1024 lds
MAA 112,112,4
TR 90,25,26368
MAA 108,112,0
TR 92,25,38272
MAA 108,116,20
buffer_load_dword v29, s[36:39], s53 offen offset:2048 lds
MAA 140,20,124
TR 94,25,38784
s_add_u32 s53, s53, 128
MAA 140,0,120
TR 96,25,26880
MAA 144,4,120
buffer_load_dwordx4 v[188:191], v26, s[16:19], s75 offen offset:2048 sc1
MAA 144,24,124
TR 98,25,27392
MAA 148,28,124
TR 100,25,39296
MAA 148,8,120
TR 102,25,39808
MAA 152,12,120
MAA 152,32,124
MAA 160,36,124
MAA 160,16,120
s_waitcnt lgkmcnt(8)
s_barrier
MAA 60,80,40
TR 104,25,24864
s_add_u32 m0, s56, 86400
MAA 60,84,60
buffer_load_dwordx4 v18, s[20:23], s54 offen lds
MAA 64,84,64
s_sub_u32 s47, s47, 1
s_cbranch_scc1 .Lx32
.Lx32b:
MAA 64,80,44
TR 106,25,25376
TR 108,25,37280
MAA 68,80,48
TR 110,25,37792
s_waitcnt vmcnt(15)
v_add_f32 v164, v164, v180
MAA 68,84,68
buffer_load_dwordx4 v19, s[20:23], s54 offen offset:1024 lds
MAA 72,84,72
TR 112,25,25888
MAA 72,80,52
TR 114,25,26400
s_waitcnt lgkmcnt(6)
MAA 104,88,52
v_add_f32 v165, v165, v181
MAA 104,92,72
buffer_load_dwordx4 v20, s[20:23], s54 offen offset:2048 lds
MAA 100,92,68
s_add_u32 s54, s54, 196608
s_add_u32 m0, s55, 55488
MAA 100,88,48
buffer_load_dwordx4 v21, s[36:39], s52 offen lds
MAA 96,88,44
TR 116,25,38304
MAA 96,92,64
TR 118,25,38816
TR 120,25,26912
MAA 92,92,60
TR 122,25,27424
v_add_f32 v166, v166, v182
MAA 92,88,40
buffer_load_dwordx4 v28, s[36:39], s52 offen offset:1024 lds
MAA 124,40,96
TR 124,25,39328
MAA 124,60,100
TR 126,25,39840
MAA 128,64,100
ds_read_b128 a[0:3], v23
v_add_f32 v167, v167, v183
MAA 128,44,96
buffer_load_dword v22, s[36:39], s52 offen offset:2048 lds
MAA 132,48,96
RD 4,23,2304
s_add_u32 s52, s52, 128
MAA 132,68,100
buffer_load_dwordx4 v[192:195], v26, s[16:19], s75 offen offset:3072 sc1
MAA 136,72,100
RD 8,23,4608
MAA 136,52,96
RD 12,23,6912
ds_read_b128 a[16:19], v24
MAA 156,56,96
MAA 156,76,100
s_waitcnt vmcnt(18) lgkmcnt(5)
s_barrier
MAA 76,104,40
ds_read_b128 a[20:23], v30
s_waitcnt vmcnt(14)
v_add_f32 v164, v164, v184
MAA 76,108,60
RD 24,30,2304
s_add_u32 m0, s56, 98816
MAA 80,108,64
buffer_load_dwordx4 v18, s[20:23], s54 offen lds
MAA 80,104,44
RD 28,30,4608
v_add_f32 v165, v165, v185
MAA 84,104,48
RD 32,30,6912
v_add_f32 v166, v166, v186
MAA 84,108,68
ds_read_b128 a[36:39], v31
v_add_f32 v167, v167, v187
MAA 88,108,72
buffer_load_dwordx4 v19, s[20:23], s54 offen offset:1024 lds
MAA 88,104,52
TR 80,25,49664
MAA 244,104,56
TR 82,25,50176
MAA 244,108,76
TR 84,25,62080
MAA 120,116,72
buffer_load_dwordx4 v20, s[20:23], s54 offen offset:2048 lds
MAA 120,112,52
TR 86,25,62592
s_add_u32 s54, s54, 196608
MAA 116,112,48
TR 88,25,50688
s_add_u32 m0, s55, 57792
MAA 116,116,68
TR 90,25,51200
MAA 112,116,64
buffer_load_dwordx4 v21, s[36:39], s53 offen lds
MAA 112,112,44
TR 92,25,63104
MAA 108,112,40
TR 94,25,63616
MAA 108,116,60
TR 96,25,51712
.Lpad9:
s_cbranch_execz .Lt0r
MAA 140,60,124
buffer_load_dwordx4 v28, s[36:39], s53 offen offset:1024 lds
MAA 140,40,120
TR 98,25,52224
MAA 144,44,120
TR 100,25,64128
MAA 144,64,124
TR 102,25,64640
MAA 148,68,124
buffer_load_dword v29, s[36:39], s53 offen offset:2048 lds
MAA 148,48,120
s_add_u32 s53, s53, 128
MAA 152,52,120
MAA 152,72,124
MAA 160,76,124
MAA 160,56,120
s_waitcnt lgkmcnt(8)
s_barrier
MAA 60,80,0
TR 104,25,49696
s_waitcnt vmcnt(13)
v_add_f32 v164, v164, v188
MAA 60,84,20
TR 106,25,50208
s_add_u32 m0, s56, 111232
MAA 64,84,24
buffer_load_dwordx4 v18, s[20:23], s54 offen lds
MAA 64,80,4
TR 108,25,62112
v_add_f32 v165, v165, v189
MAA 68,80,8
TR 110,25,62624
v_add_f32 v166, v166, v190
MAA 68,84,28
buffer_load_dwordx4 v19, s[20:23], s54 offen offset:1024 lds
MAA 72,84,32
TR 112,25,50720
v_add_f32 v167, v167, v191
MAA 72,80,12
TR 114,25,51232
s_waitcnt lgkmcnt(6)
MAA 104,88,12
buffer_load_dwordx4 v20, s[20:23], s54 offen offset:2048 lds
MAA 104,92,32
TR 116,25,63136
s_add_u32 s54, s54, 196608
MAA 100,92,28
TR 118,25,63648
s_add_u32 m0, s59, 0
MAA 100,88,8
TR 120,25,51744
s_xor_b32 s58, s87, 1048576
MAA 96,88,4
buffer_load_dwordx4 v5, s[24:27], s58 offen lds
MAA 96,92,24
TR 122,25,52256
MAA 92,92,20
TR 124,25,64160
MAA 92,88,0
buffer_load_dwordx4 v6, s[24:27], s58 offen offset:1024 lds
MAA 124,0,96
TR 126,25,64672
s_add_u32 m0, s59, 8320
MAA 124,20,100
RD 40,23,18496
s_xor_b32 s58, s87, 1179648
MAA 128,24,100
buffer_load_dwordx4 v5, s[24:27], s58 offen lds
MAA 128,4,96
RD 44,23,20800
MAA 132,8,96
RD 48,23,23104
MAA 132,28,100
buffer_load_dwordx4 v6, s[24:27], s58 offen offset:1024 lds
MAA 136,32,100
RD 52,23,25408
MAA 136,12,96
RD 56,24,18496
MAA 156,16,96
MAA 156,36,100
s_waitcnt vmcnt(17) lgkmcnt(5)
s_barrier
MAA 76,104,0
RD 60,30,18496
s_waitcnt vmcnt(13)
v_add_f32 v164, v164, v192
MAA 76,108,20
RD 64,30,20800
s_add_u32 m0, s56, 123648
MAA 80,108,24
buffer_load_dwordx4 v18, s[20:23], s54 offen lds
MAA 80,104,4
RD 68,30,23104
v_add_f32 v165, v165, v193
MAA 84,104,8
RD 72,30,25408
v_add_f32 v166, v166, v194
MAA 84,108,28
RD 76,31,18496
v_add_f32 v167, v167, v195
MAA 88,108,32
ds_read_b64_tr_b16 a[80:81], v25
MAA 88,104,12
TR 82,25,512
MAA 244,104,16
TR 84,25,12416
MAA 244,108,36
TR 86,25,12928
MAA 120,116,32
buffer_load_dwordx4 v19, s[20:23], s54 offen offset:1024 lds
MAA 120,112,12
TR 88,25,1024
MAA 116,112,8
TR 90,25,1536
MAA 116,116,28
TR 92,25,13440
MAA 112,116,24
TR 94,25,13952
MAA 112,112,4
TR 96,25,2048
MAA 108,112,0
TR 98,25,2560
MAA 108,116,20
TR 100,25,14464
MAA 140,20,124
buffer_load_dwordx4 v20, s[20:23], s54 offen offset:2048 lds
MAA 140,0,120
TR 102,25,14976
s_add_u32 s54, s54, 196608
MAA 144,4,120
MAA 144,24,124
MAA 148,28,124
MAA 148,8,120
MAA 152,12,120
MAA 152,32,124
MAA 160,36,124
MAA 160,16,120
s_waitcnt lgkmcnt(8)
s_barrier
MAA 60,80,40
TR 104,25,32
MAA 60,84,60
TR 106,25,544
s_add_u32 m0, s56, 136064
MAA 64,84,64
buffer_load_dwordx4 v18, s[20:23], s54 offen lds
MAA 64,80,44
TR 108,25,12448
MAA 68,80,48
TR 110,25,12960
MAA 68,84,68
buffer_load_dwordx4 v19, s[20:23], s54 offen offset:1024 lds
MAA 72,84,72
TR 112,25,1056
MAA 72,80,52
TR 114,25,1568
s_waitcnt lgkmcnt(6)
MAA 104,88,52
buffer_load_dwordx4 v20, s[20:23], s54 offen offset:2048 lds
MAA 104,92,72
TR 116,25,13472
s_add_u32 s54, s54, 196608
MAA 100,92,68
TR 118,25,13984
s_add_u32 m0, s59, 16640
MAA 100,88,48
TR 120,25,2080
s_xor_b32 s58, s87, 1310720
MAA 96,88,44
buffer_load_dwordx4 v5, s[24:27], s58 offen lds
MAA 96,92,64
TR 122,25,2592
MAA 92,92,60
TR 124,25,14496
MAA 92,88,40
buffer_load_dwordx4 v6, s[24:27], s58 offen offset:1024 lds
MAA 124,40,96
TR 126,25,15008
s_add_u32 m0, s59, 24960
MAA 124,60,100
RD 0,23,36992
s_xor_b32 s58, s87, 1441792
MAA 128,64,100
buffer_load_dwordx4 v5, s[24:27], s58 offen lds
MAA 128,44,96
RD 4,23,39296
MAA 132,48,96
RD 8,23,41600
MAA 132,68,100
buffer_load_dwordx4 v6, s[24:27], s58 offen offset:1024 lds
MAA 136,72,100
RD 12,23,43904
MAA 136,52,96
RD 16,24,36992
MAA 156,56,96
v_permlane32_swap_b32 v164, v166
MAA 156,76,100
v_permlane32_swap_b32 v165, v167
v_add_f32 v164, v164, v166
v_add_f32 v165, v165, v167
v_mul_f32 v164, 0xba800000, v164
v_mul_f32 v165, 0x3a800000, v165
v_fma_f32 v165, -v164, v164, v165
v_max_f32 v165, 0, v165
v_add_f32 v165, 0x3727c5ac, v165
v_rsq_f32 v166, v165
s_nop 0
v_mov_b32 v165, v166
v_mul_f32 v166, 0x3e8293ee, v166
s_waitcnt vmcnt(14) lgkmcnt(5)
s_barrier
MAA 76,104,40
ds_write_b128 v7, v[164:167]
MAA 76,108,60
ds_write_b32 v17, v164
s_add_u32 m0, s59, 74880
MAA 80,108,64
ds_write_b32 v17, v165 offset:1024
s_xor_b32 s58, s87, 131072
MAA 80,104,44
buffer_load_dwordx4 v5, s[24:27], s58 offen lds
MAA 84,104,48
RD 20,30,36992
MAA 84,108,68
RD 24,30,39296
MAA 88,108,72
RD 28,30,41600
MAA 88,104,52
RD 32,30,43904
MAA 244,104,56
RD 36,31,36992
MAA 244,108,76
buffer_load_dwordx4 v6, s[24:27], s58 offen offset:1024 lds
MAA 120,116,72
TR 80,25,24832
s_add_u32 m0, s59, 83200
MAA 120,112,52
TR 82,25,25344
s_xor_b32 s58, s87, 262144
MAA 116,112,48
TR 84,25,37248
MAA 116,116,68
TR 86,25,37760
MAA 112,116,64
TR 88,25,25856
MAA 112,112,44
buffer_load_dwordx4 v5, s[24:27], s58 offen lds
MAA 108,112,40
TR 90,25,26368
MAA 108,116,60
TR 92,25,38272
MAA 140,60,124
TR 94,25,38784
MAA 140,40,120
TR 96,25,26880
MAA 144,44,120
TR 98,25,27392
MAA 144,64,124
buffer_load_dwordx4 v6, s[24:27], s58 offen offset:1024 lds
MAA 148,68,124
TR 100,25,39296
MAA 148,48,120
TR 102,25,39808
MAA 152,52,120
MAA 152,72,124
MAA 160,76,124
MAA 160,56,120
s_waitcnt vmcnt(8) lgkmcnt(0)
s_barrier
MAA 104,88,12
TR 112,25,25888
s_add_u32 m0, s59, 33280
MAA 104,92,32
TR 114,25,26400
s_xor_b32 s58, s87, 1572864
MAA 100,92,28
buffer_load_dwordx4 v5, s[24:27], s58 offen lds
MAA 100,88,8
TR 116,25,38304
MAA 96,88,4
TR 118,25,38816
MAA 96,92,24
TR 120,25,26912
MAA 92,92,20
buffer_load_dwordx4 v6, s[24:27], s58 offen offset:1024 lds
MAA 92,88,0
TR 122,25,27424
s_add_u32 m0, s59, 41600
MAA 156,16,96
TR 124,25,39328
s_xor_b32 s58, s87, 1703936
MAA 156,36,100
TR 126,25,39840
MAA 72,84,32
buffer_load_dwordx4 v5, s[24:27], s58 offen lds
MAA 72,80,12
TR 104,25,24864
MAA 68,80,8
TR 106,25,25376
MAA 68,84,28
TR 108,25,37280
MAA 64,84,24
buffer_load_dwordx4 v6, s[24:27], s58 offen offset:1024 lds
MAA 64,80,4
TR 110,25,37792
MAA 60,80,0
RD 40,23,55488
MAA 60,84,20
RD 44,23,57792
s_waitcnt lgkmcnt(12)
MAA 120,112,12
RD 48,23,60096
s_waitcnt lgkmcnt(11)
MAA 120,116,32
RD 52,23,62400
MAA 116,116,28
RD 56,24,55488
MAA 116,112,8
RD 60,30,55488
MAA 112,112,4
RD 64,30,57792
MAA 112,116,24
s_waitcnt lgkmcnt(7)
s_barrier
RD 68,30,60096
MAA 108,116,20
RD 72,30,62400
s_add_u32 m0, s59, 91520
MAA 108,112,0
RD 76,31,55488
s_xor_b32 s58, s87, 393216
MAA 160,16,120
TR 144,25,50688
MAA 160,36,124
TR 146,25,51200
MAA 244,108,36
TR 148,25,63104
MAA 244,104,16
TR 150,25,63616
MAA 88,104,12
TR 152,25,50720
MAA 88,108,32
TR 154,25,51232
MAA 84,108,28
TR 156,25,63136
MAA 84,104,8
TR 158,25,63648
MAA 80,104,4
TR 160,25,51712
MAA 80,108,24
TR 162,25,52224
MAA 76,108,20
TR 164,25,64128
MAA 76,104,0
TR 166,25,64640
s_waitcnt lgkmcnt(10)
MAA 104,144,52
TR 168,25,51744
s_waitcnt lgkmcnt(9)
MAA 104,148,72
TR 170,25,52256
MAA 100,148,68
TR 172,25,64160
MAA 100,144,48
TR 174,25,64672
MAA 96,144,44
TR 136,25,49696
MAA 96,148,64
TR 138,25,50208
MAA 92,148,60
TR 140,25,62112
MAA 92,144,40
TR 142,25,62624
s_waitcnt lgkmcnt(14)
MAA 120,152,52
TR 128,25,49664
s_waitcnt lgkmcnt(13)
MAA 120,156,72
TR 130,25,50176
MAA 116,156,68
TR 132,25,62080
MAA 116,152,48
TR 134,25,62592
MAA 112,152,44
ds_read_b128 v[232:235], v10 offset:1792
MAA 112,156,64
ds_read_b128 v[228:231], v10 offset:1536
MAA 108,156,60
ds_read_b128 v[224:227], v10 offset:1280
MAA 108,152,40
ds_read_b128 v[220:223], v10 offset:1024
s_waitcnt lgkmcnt(15)
MAA 156,56,160
buffer_load_dwordx4 v5, s[24:27], s58 offen lds
MAA 156,76,164
s_waitcnt lgkmcnt(12)
MAA 160,76,172
MAA 160,56,168
s_waitcnt lgkmcnt(10)
MAA 244,136,56
buffer_load_dwordx4 v6, s[24:27], s58 offen offset:1024 lds
s_waitcnt lgkmcnt(8)
MAA 244,140,76
s_add_u32 m0, s59, 99840
s_xor_b32 s58, s87, 524288
MAA 88,140,72
MAA 88,136,52
MAA 84,136,48
buffer_load_dwordx4 v5, s[24:27], s58 offen lds
MAA 84,140,68
buffer_load_dwordx4 v6, s[24:27], s58 offen offset:1024 lds
s_add_u32 m0, s59, 108160
s_xor_b32 s58, s87, 655360
buffer_load_dwordx4 v5, s[24:27], s58 offen lds
buffer_load_dwordx4 v6, s[24:27], s58 offen offset:1024 lds
s_mov_b32 exec_lo, 0x10001
s_mov_b32 exec_hi, 0x10001
ds_write_b128 v13, v[244:247] offset:64
s_mov_b64 exec, 0xffff
ds_write_b32 v12, v156 offset:512
ds_write_b32 v12, v160 offset:576
s_mov_b64 exec, -1
MAA 80,136,44
MAA 80,140,64
MAA 76,140,60
MAA 76,136,40
s_waitcnt lgkmcnt(9)
MAA 72,128,52
s_waitcnt lgkmcnt(7)
MAA 72,132,72
s_waitcnt lgkmcnt(0)
s_barrier
MAA 68,128,48
ds_read_b128 v[28:31], v13
MAA 68,132,68
ds_read_b128 v[32:35], v13 offset:64
MAA 64,132,64
ds_read_b128 v[36:39], v13 offset:256
MAA 64,128,44
ds_read_b128 v[40:43], v13 offset:320
MAA 60,128,40
ds_read_b32 v44, v12 offset:512
MAA 60,132,60
ds_read_b32 v45, v12 offset:576
ds_read_b128 v[240:243], v11 offset:704
ds_read_b128 v[244:247], v11 offset:1728
ds_read_b128 v[18:21], v11 offset:448
ds_read_b128 v[22:25], v11 offset:1472
s_waitcnt lgkmcnt(9)
v_pk_fma_f32 v[72:73], v[28:29], v[232:233], v[72:73] op_sel_hi:[1,0,1]
v_cvt_pk_bf16_f32 v176, v72, v73
v_pk_fma_f32 v[74:75], v[30:31], v[232:233], v[74:75] op_sel_hi:[1,0,1]
v_cvt_pk_bf16_f32 v177, v74, v75
s_waitcnt lgkmcnt(8)
v_pk_fma_f32 v[88:89], v[32:33], v[232:233], v[88:89] op_sel_hi:[1,0,1]
v_cvt_pk_bf16_f32 v178, v88, v89
v_pk_fma_f32 v[90:91], v[34:35], v[232:233], v[90:91] op_sel_hi:[1,0,1]
v_cvt_pk_bf16_f32 v179, v90, v91
s_waitcnt lgkmcnt(7)
v_pk_fma_f32 v[104:105], v[36:37], v[232:233], v[104:105] op_sel_hi:[1,0,1]
v_pk_mul_f32 v[104:105], v[104:105], v[232:233] op_sel:[0,1] op_sel_hi:[1,1]
v_cvt_pk_bf16_f32 v196, v104, v105
v_pk_fma_f32 v[106:107], v[38:39], v[232:233], v[106:107] op_sel_hi:[1,0,1]
v_pk_mul_f32 v[106:107], v[106:107], v[232:233] op_sel:[0,1] op_sel_hi:[1,1]
v_cvt_pk_bf16_f32 v197, v106, v107
s_waitcnt lgkmcnt(6)
v_pk_fma_f32 v[120:121], v[40:41], v[232:233], v[120:121] op_sel_hi:[1,0,1]
v_pk_mul_f32 v[120:121], v[120:121], v[232:233] op_sel:[0,1] op_sel_hi:[1,1]
v_cvt_pk_bf16_f32 v198, v120, v121
v_pk_fma_f32 v[122:123], v[42:43], v[232:233], v[122:123] op_sel_hi:[1,0,1]
v_pk_mul_f32 v[122:123], v[122:123], v[232:233] op_sel:[0,1] op_sel_hi:[1,1]
v_cvt_pk_bf16_f32 v199, v122, v123
v_pk_fma_f32 v[100:101], v[36:37], v[228:229], v[100:101] op_sel_hi:[1,0,1]
v_pk_mul_f32 v[100:101], v[100:101], v[228:229] op_sel:[0,1] op_sel_hi:[1,1]
s_waitcnt lgkmcnt(3)
v_pk_fma_f32 v[156:157], v[240:241], v[44:45], v[156:157] op_sel_hi:[1,0,1]
v_pk_fma_f32 v[158:159], v[242:243], v[44:45], v[158:159] op_sel_hi:[1,0,1]
s_waitcnt lgkmcnt(2)
v_pk_mul_f32 v[156:157], v[156:157], v[244:245]
v_cvt_pk_bf16_f32 v236, v156, v157
v_pk_mul_f32 v[158:159], v[158:159], v[246:247]
v_cvt_pk_bf16_f32 v237, v158, v159
v_pk_fma_f32 v[160:161], v[240:241], v[44:45], v[160:161] op_sel:[0,1,0] op_sel_hi:[1,1,1]
v_pk_mul_f32 v[160:161], v[160:161], v[244:245]
v_cvt_pk_bf16_f32 v238, v160, v161
v_pk_fma_f32 v[162:163], v[242:243], v[44:45], v[162:163] op_sel:[0,1,0] op_sel_hi:[1,1,1]
v_pk_mul_f32 v[162:163], v[162:163], v[246:247]
v_cvt_pk_bf16_f32 v239, v162, v163
ds_write_b128 v8, v[236:239] offset:1024
v_cvt_pk_bf16_f32 v192, v100, v101
v_pk_fma_f32 v[102:103], v[38:39], v[228:229], v[102:103] op_sel_hi:[1,0,1]
v_pk_mul_f32 v[102:103], v[102:103], v[228:229] op_sel:[0,1] op_sel_hi:[1,1]
v_cvt_pk_bf16_f32 v193, v102, v103
v_pk_fma_f32 v[116:117], v[40:41], v[228:229], v[116:117] op_sel_hi:[1,0,1]
v_pk_mul_f32 v[116:117], v[116:117], v[228:229] op_sel:[0,1] op_sel_hi:[1,1]
v_cvt_pk_bf16_f32 v194, v116, v117
v_pk_fma_f32 v[118:119], v[42:43], v[228:229], v[118:119] op_sel_hi:[1,0,1]
v_pk_mul_f32 v[118:119], v[118:119], v[228:229] op_sel:[0,1] op_sel_hi:[1,1]
v_cvt_pk_bf16_f32 v195, v118, v119
v_pk_fma_f32 v[96:97], v[36:37], v[224:225], v[96:97] op_sel_hi:[1,0,1]
v_pk_mul_f32 v[96:97], v[96:97], v[224:225] op_sel:[0,1] op_sel_hi:[1,1]
v_cvt_pk_bf16_f32 v188, v96, v97
v_pk_fma_f32 v[98:99], v[38:39], v[224:225], v[98:99] op_sel_hi:[1,0,1]
v_pk_mul_f32 v[98:99], v[98:99], v[224:225] op_sel:[0,1] op_sel_hi:[1,1]
v_cvt_pk_bf16_f32 v189, v98, v99
v_pk_fma_f32 v[112:113], v[40:41], v[224:225], v[112:113] op_sel_hi:[1,0,1]
v_pk_mul_f32 v[112:113], v[112:113], v[224:225] op_sel:[0,1] op_sel_hi:[1,1]
v_cvt_pk_bf16_f32 v190, v112, v113
v_pk_fma_f32 v[114:115], v[42:43], v[224:225], v[114:115] op_sel_hi:[1,0,1]
v_pk_mul_f32 v[114:115], v[114:115], v[224:225] op_sel:[0,1] op_sel_hi:[1,1]
v_cvt_pk_bf16_f32 v191, v114, v115
v_pk_fma_f32 v[92:93], v[36:37], v[220:221], v[92:93] op_sel_hi:[1,0,1]
v_pk_mul_f32 v[92:93], v[92:93], v[220:221] op_sel:[0,1] op_sel_hi:[1,1]
v_cvt_pk_bf16_f32 v184, v92, v93
v_pk_fma_f32 v[94:95], v[38:39], v[220:221], v[94:95] op_sel_hi:[1,0,1]
v_pk_mul_f32 v[94:95], v[94:95], v[220:221] op_sel:[0,1] op_sel_hi:[1,1]
v_cvt_pk_bf16_f32 v185, v94, v95
v_pk_fma_f32 v[108:109], v[40:41], v[220:221], v[108:109] op_sel_hi:[1,0,1]
v_pk_mul_f32 v[108:109], v[108:109], v[220:221] op_sel:[0,1] op_sel_hi:[1,1]
v_cvt_pk_bf16_f32 v186, v108, v109
v_pk_fma_f32 v[110:111], v[42:43], v[220:221], v[110:111] op_sel_hi:[1,0,1]
v_pk_mul_f32 v[110:111], v[110:111], v[220:221] op_sel:[0,1] op_sel_hi:[1,1]
v_cvt_pk_bf16_f32 v187, v110, v111
v_pk_fma_f32 v[68:69], v[28:29], v[228:229], v[68:69] op_sel_hi:[1,0,1]
v_cvt_pk_bf16_f32 v172, v68, v69
v_pk_fma_f32 v[70:71], v[30:31], v[228:229], v[70:71] op_sel_hi:[1,0,1]
v_cvt_pk_bf16_f32 v173, v70, v71
v_pk_fma_f32 v[84:85], v[32:33], v[228:229], v[84:85] op_sel_hi:[1,0,1]
v_cvt_pk_bf16_f32 v174, v84, v85
v_pk_fma_f32 v[86:87], v[34:35], v[228:229], v[86:87] op_sel_hi:[1,0,1]
v_cvt_pk_bf16_f32 v175, v86, v87
v_pk_fma_f32 v[64:65], v[28:29], v[224:225], v[64:65] op_sel_hi:[1,0,1]
v_cvt_pk_bf16_f32 v168, v64, v65
v_pk_fma_f32 v[66:67], v[30:31], v[224:225], v[66:67] op_sel_hi:[1,0,1]
v_cvt_pk_bf16_f32 v169, v66, v67
v_pk_fma_f32 v[80:81], v[32:33], v[224:225], v[80:81] op_sel_hi:[1,0,1]
v_cvt_pk_bf16_f32 v170, v80, v81
v_pk_fma_f32 v[82:83], v[34:35], v[224:225], v[82:83] op_sel_hi:[1,0,1]
v_cvt_pk_bf16_f32 v171, v82, v83
.Lpad10:
s_cbranch_execz .Lt0r
v_pk_fma_f32 v[60:61], v[28:29], v[220:221], v[60:61] op_sel_hi:[1,0,1]
v_cvt_pk_bf16_f32 v164, v60, v61
v_pk_fma_f32 v[62:63], v[30:31], v[220:221], v[62:63] op_sel_hi:[1,0,1]
v_cvt_pk_bf16_f32 v165, v62, v63
v_pk_fma_f32 v[76:77], v[32:33], v[220:221], v[76:77] op_sel_hi:[1,0,1]
v_cvt_pk_bf16_f32 v166, v76, v77
v_pk_fma_f32 v[78:79], v[34:35], v[220:221], v[78:79] op_sel_hi:[1,0,1]
s_waitcnt lgkmcnt(0)
s_barrier
v_cvt_pk_bf16_f32 v167, v78, v79
v_mfma_f32_16x16x32_bf16 v[120:123], v[196:199], v[176:179], v[50:53]
ds_read_b128 v[180:183], v9
v_mfma_f32_16x16x32_bf16 v[104:107], v[192:195], v[176:179], v[46:49]
ds_read_b64 v[200:201], v9 offset:1024
v_mfma_f32_16x16x32_bf16 v[116:119], v[192:195], v[172:175], v[50:53]
ds_read_b64 v[210:211], v9 offset:1032
v_mfma_f32_16x16x32_bf16 v[100:103], v[188:191], v[172:175], v[46:49]
ds_read_b128 v[240:243], v11 offset:384
v_mfma_f32_16x16x32_bf16 v[112:115], v[188:191], v[168:171], v[50:53]
ds_read_b128 v[244:247], v11 offset:1408
v_mfma_f32_16x16x32_bf16 v[96:99], v[184:187], v[168:171], v[46:49]
ds_read_b128 v[28:31], v11 offset:320
v_max3_f32 v88, v104, v105, v106
v_mfma_f32_16x16x32_bf16 v[108:111], v[184:187], v[164:167], v[50:53]
ds_read_b128 v[32:35], v11 offset:1344
v_max3_f32 v89, v107, v120, v121
v_max3_f32 v88, v88, v122, v123
v_max_f32 v90, v88, v89
v_max_f32 v89, v88, v89
v_max3_f32 v84, v100, v101, v102
v_max3_f32 v85, v103, v116, v117
s_waitcnt lgkmcnt(6)
v_mfma_f32_16x16x32_bf16 v[92:95], v[180:183], v[164:167], v[46:49]
ds_read_b128 v[36:39], v11 offset:256
v_permlane16_swap_b32 v90, v89
MAA 136,12,96
ds_read_b128 v[40:43], v11 offset:1280
v_max_f32 v88, v90, v89
MAA 136,32,100
v_max_f32 v89, v90, v89
v_max3_f32 v84, v84, v118, v119
MAA 136,52,160
v_permlane32_swap_b32 v88, v89
MAA 136,72,164
v_max_f32 v88, v88, v89
v_mul_f32 v88, v88, v234
MAA 152,72,172
v_max_f32 v86, v84, v85
v_max_f32 v85, v84, v85
MAA 152,52,168
s_nop 0
v_permlane16_swap_b32 v86, v85
MAA 152,32,124
v_max_f32 v84, v86, v85
v_max_f32 v85, v86, v85
MAA 152,12,120
s_nop 0
v_permlane32_swap_b32 v84, v85
v_max3_f32 v80, v96, v97, v98
v_max_f32 v84, v84, v85
v_mul_f32 v84, v84, v230
v_max3_f32 v81, v99, v112, v113
v_max3_f32 v80, v80, v114, v115
v_max_f32 v82, v80, v81
v_max_f32 v81, v80, v81
v_max3_f32 v76, v92, v93, v94
v_max3_f32 v77, v95, v108, v109
v_permlane16_swap_b32 v82, v81
v_max3_f32 v76, v76, v110, v111
v_max_f32 v80, v82, v81
v_max_f32 v81, v82, v81
v_max_f32 v78, v76, v77
v_max_f32 v77, v76, v77
v_permlane32_swap_b32 v80, v81
v_pk_fma_f32 v[104:105], v[104:105], v[234:235], v[88:89] op_sel_hi:[1,0,0] neg_lo:[0,0,1] neg_hi:[0,0,1]
v_max_f32 v80, v80, v81
v_mul_f32 v80, v80, v226
v_permlane16_swap_b32 v78, v77
v_pk_fma_f32 v[106:107], v[106:107], v[234:235], v[88:89] op_sel_hi:[1,0,0] neg_lo:[0,0,1] neg_hi:[0,0,1]
v_max_f32 v76, v78, v77
v_max_f32 v77, v78, v77
v_pk_fma_f32 v[120:121], v[120:121], v[234:235], v[88:89] op_sel_hi:[1,0,0] neg_lo:[0,0,1] neg_hi:[0,0,1]
v_pk_fma_f32 v[122:123], v[122:123], v[234:235], v[88:89] op_sel_hi:[1,0,0] neg_lo:[0,0,1] neg_hi:[0,0,1]
v_permlane32_swap_b32 v76, v77
v_pk_fma_f32 v[100:101], v[100:101], v[230:231], v[84:85] op_sel_hi:[1,0,0] neg_lo:[0,0,1] neg_hi:[0,0,1]
v_max_f32 v76, v76, v77
v_mul_f32 v76, v76, v222
v_pk_fma_f32 v[102:103], v[102:103], v[230:231], v[84:85] op_sel_hi:[1,0,0] neg_lo:[0,0,1] neg_hi:[0,0,1]
v_pk_fma_f32 v[116:117], v[116:117], v[230:231], v[84:85] op_sel_hi:[1,0,0] neg_lo:[0,0,1] neg_hi:[0,0,1]
v_pk_fma_f32 v[118:119], v[118:119], v[230:231], v[84:85] op_sel_hi:[1,0,0] neg_lo:[0,0,1] neg_hi:[0,0,1]
v_pk_fma_f32 v[96:97], v[96:97], v[226:227], v[80:81] op_sel_hi:[1,0,0] neg_lo:[0,0,1] neg_hi:[0,0,1]
v_pk_fma_f32 v[98:99], v[98:99], v[226:227], v[80:81] op_sel_hi:[1,0,0] neg_lo:[0,0,1] neg_hi:[0,0,1]
v_pk_fma_f32 v[112:113], v[112:113], v[226:227], v[80:81] op_sel_hi:[1,0,0] neg_lo:[0,0,1] neg_hi:[0,0,1]
v_pk_fma_f32 v[114:115], v[114:115], v[226:227], v[80:81] op_sel_hi:[1,0,0] neg_lo:[0,0,1] neg_hi:[0,0,1]
v_pk_fma_f32 v[92:93], v[92:93], v[222:223], v[76:77] op_sel_hi:[1,0,0] neg_lo:[0,0,1] neg_hi:[0,0,1]
v_pk_fma_f32 v[94:95], v[94:95], v[222:223], v[76:77] op_sel_hi:[1,0,0] neg_lo:[0,0,1] neg_hi:[0,0,1]
v_pk_fma_f32 v[108:109], v[108:109], v[222:223], v[76:77] op_sel_hi:[1,0,0] neg_lo:[0,0,1] neg_hi:[0,0,1]
v_pk_fma_f32 v[110:111], v[110:111], v[222:223], v[76:77] op_sel_hi:[1,0,0] neg_lo:[0,0,1] neg_hi:[0,0,1]
v_pk_fma_f32 v[136:137], v[18:19], v[44:45], v[136:137] op_sel_hi:[1,0,1]
v_pk_mul_f32 v[136:137], v[136:137], v[22:23]
v_pk_fma_f32 v[138:139], v[20:21], v[44:45], v[138:139] op_sel_hi:[1,0,1]
v_pk_mul_f32 v[138:139], v[138:139], v[24:25]
v_pk_fma_f32 v[152:153], v[18:19], v[44:45], v[152:153] op_sel:[0,1,0] op_sel_hi:[1,1,1]
v_pk_mul_f32 v[152:153], v[152:153], v[22:23]
v_pk_fma_f32 v[154:155], v[20:21], v[44:45], v[154:155] op_sel:[0,1,0] op_sel_hi:[1,1,1]
v_pk_mul_f32 v[154:155], v[154:155], v[24:25]
v_exp_f32 v104, v104
s_nop 0
MAA 132,8,96
v_exp_f32 v105, v105
MAA 132,28,100
v_exp_f32 v106, v106
MAA 132,48,160
v_exp_f32 v107, v107
MAA 132,68,164
v_exp_f32 v120, v120
MAA 148,68,172
v_exp_f32 v121, v121
MAA 148,48,168
v_exp_f32 v122, v122
MAA 148,28,124
v_exp_f32 v123, v123
MAA 148,8,120
v_exp_f32 v100, v100
MAA 128,4,96
v_exp_f32 v101, v101
MAA 128,24,100
v_exp_f32 v102, v102
MAA 128,44,160
v_exp_f32 v103, v103
MAA 128,64,164
v_exp_f32 v116, v116
MAA 144,64,172
v_exp_f32 v117, v117
MAA 144,44,168
v_exp_f32 v118, v118
MAA 144,24,124
v_exp_f32 v119, v119
MAA 144,4,120
v_exp_f32 v96, v96
MAA 124,0,96
v_exp_f32 v97, v97
MAA 124,20,100
v_exp_f32 v98, v98
MAA 124,40,160
v_exp_f32 v99, v99
MAA 124,60,164
v_exp_f32 v112, v112
MAA 140,60,172
v_exp_f32 v113, v113
MAA 140,40,168
v_exp_f32 v114, v114
MAA 140,20,124
v_exp_f32 v115, v115
MAA 140,0,120
v_cvt_pk_bf16_f32 v72, v104, v105
v_cvt_pk_bf16_f32 v73, v106, v107
v_cvt_pk_bf16_f32 v74, v120, v121
v_cvt_pk_bf16_f32 v75, v122, v123
v_cvt_pk_bf16_f32 v68, v100, v101
v_cvt_pk_bf16_f32 v69, v102, v103
v_cvt_pk_bf16_f32 v70, v116, v117
v_cvt_pk_bf16_f32 v71, v118, v119
v_cvt_pk_bf16_f32 v64, v96, v97
v_cvt_pk_bf16_f32 v65, v98, v99
v_cvt_pk_bf16_f32 v66, v112, v113
v_cvt_pk_bf16_f32 v67, v114, v115
v_cvt_pk_bf16_f32 v208, v136, v137
v_cvt_pk_bf16_f32 v209, v138, v139
v_cvt_pk_bf16_f32 v218, v152, v153
v_cvt_pk_bf16_f32 v219, v154, v155
s_waitcnt lgkmcnt(5)
v_pk_fma_f32 v[132:133], v[240:241], v[44:45], v[132:133] op_sel_hi:[1,0,1]
s_waitcnt lgkmcnt(4)
v_pk_mul_f32 v[132:133], v[132:133], v[244:245]
v_cvt_pk_bf16_f32 v206, v132, v133
v_pk_fma_f32 v[134:135], v[242:243], v[44:45], v[134:135] op_sel_hi:[1,0,1]
v_pk_mul_f32 v[134:135], v[134:135], v[246:247]
v_cvt_pk_bf16_f32 v207, v134, v135
v_pk_fma_f32 v[148:149], v[240:241], v[44:45], v[148:149] op_sel:[0,1,0] op_sel_hi:[1,1,1]
v_pk_mul_f32 v[148:149], v[148:149], v[244:245]
v_cvt_pk_bf16_f32 v216, v148, v149
v_pk_fma_f32 v[150:151], v[242:243], v[44:45], v[150:151] op_sel:[0,1,0] op_sel_hi:[1,1,1]
v_pk_mul_f32 v[150:151], v[150:151], v[246:247]
v_cvt_pk_bf16_f32 v217, v150, v151
s_waitcnt lgkmcnt(3)
v_pk_fma_f32 v[128:129], v[28:29], v[44:45], v[128:129] op_sel_hi:[1,0,1]
s_waitcnt lgkmcnt(2)
v_pk_mul_f32 v[128:129], v[128:129], v[32:33]
v_cvt_pk_bf16_f32 v204, v128, v129
v_pk_fma_f32 v[130:131], v[30:31], v[44:45], v[130:131] op_sel_hi:[1,0,1]
v_pk_mul_f32 v[130:131], v[130:131], v[34:35]
v_cvt_pk_bf16_f32 v205, v130, v131
v_pk_fma_f32 v[144:145], v[28:29], v[44:45], v[144:145] op_sel:[0,1,0] op_sel_hi:[1,1,1]
v_pk_mul_f32 v[144:145], v[144:145], v[32:33]
v_cvt_pk_bf16_f32 v214, v144, v145
v_pk_fma_f32 v[146:147], v[30:31], v[44:45], v[146:147] op_sel:[0,1,0] op_sel_hi:[1,1,1]
v_pk_mul_f32 v[146:147], v[146:147], v[34:35]
v_cvt_pk_bf16_f32 v215, v146, v147
s_waitcnt lgkmcnt(1)
v_pk_fma_f32 v[124:125], v[36:37], v[44:45], v[124:125] op_sel_hi:[1,0,1]
s_waitcnt lgkmcnt(0)
v_pk_mul_f32 v[124:125], v[124:125], v[40:41]
v_cvt_pk_bf16_f32 v202, v124, v125
v_pk_fma_f32 v[126:127], v[38:39], v[44:45], v[126:127] op_sel_hi:[1,0,1]
v_pk_mul_f32 v[126:127], v[126:127], v[42:43]
v_cvt_pk_bf16_f32 v203, v126, v127
v_pk_fma_f32 v[140:141], v[36:37], v[44:45], v[140:141] op_sel:[0,1,0] op_sel_hi:[1,1,1]
v_pk_mul_f32 v[140:141], v[140:141], v[40:41]
v_cvt_pk_bf16_f32 v212, v140, v141
v_pk_fma_f32 v[142:143], v[38:39], v[44:45], v[142:143] op_sel:[0,1,0] op_sel_hi:[1,1,1]
v_pk_mul_f32 v[142:143], v[142:143], v[42:43]
v_cvt_pk_bf16_f32 v213, v142, v143
s_nop 0
v_mfma_f32_16x16x32_bf16 v[88:91], v[248:251], v[72:75], 0
v_exp_f32 v92, v92
v_mfma_f32_16x16x32_bf16 v[104:107], v[206:209], v[72:75], 0
v_exp_f32 v93, v93
v_mfma_f32_16x16x32_bf16 v[120:123], v[216:219], v[72:75], 0
v_exp_f32 v94, v94
v_mfma_f32_16x16x32_bf16 v[84:87], v[248:251], v[68:71], 0
v_exp_f32 v95, v95
v_mfma_f32_16x16x32_bf16 v[100:103], v[204:207], v[68:71], 0
v_exp_f32 v108, v108
v_mfma_f32_16x16x32_bf16 v[116:119], v[214:217], v[68:71], 0
v_exp_f32 v109, v109
v_mfma_f32_16x16x32_bf16 v[80:83], v[248:251], v[64:67], 0
v_exp_f32 v110, v110
v_mfma_f32_16x16x32_bf16 v[96:99], v[202:205], v[64:67], 0
v_exp_f32 v111, v111
v_mfma_f32_16x16x32_bf16 v[112:115], v[212:215], v[64:67], 0
v_cvt_pk_bf16_f32 v60, v92, v93
v_cvt_pk_bf16_f32 v61, v94, v95
v_cvt_pk_bf16_f32 v62, v108, v109
v_cvt_pk_bf16_f32 v63, v110, v111
v_rcp_f32 v88, v88
v_rcp_f32 v84, v84
v_mfma_f32_16x16x32_bf16 v[76:79], v[248:251], v[60:63], 0
v_rcp_f32 v80, v80
v_mfma_f32_16x16x32_bf16 v[92:95], v[200:203], v[60:63], 0
v_mfma_f32_16x16x32_bf16 v[108:111], v[210:213], v[60:63], 0
s_nop 4
v_rcp_f32 v76, v76
v_pk_mul_f32 v[104:105], v[104:105], v[88:89] op_sel_hi:[1,0]
v_pk_mul_f32 v[106:107], v[106:107], v[88:89] op_sel_hi:[1,0]
v_pk_mul_f32 v[120:121], v[120:121], v[88:89] op_sel_hi:[1,0]
v_pk_mul_f32 v[122:123], v[122:123], v[88:89] op_sel_hi:[1,0]
v_cvt_pk_bf16_f32 v176, v104, v105
v_cvt_pk_bf16_f32 v177, v106, v107
v_cvt_pk_bf16_f32 v178, v120, v121
v_cvt_pk_bf16_f32 v179, v122, v123
buffer_store_dwordx4 v[176:179], v4, s[16:19], s74 offen offset:3072 sc1
v_pk_mul_f32 v[100:101], v[100:101], v[84:85] op_sel_hi:[1,0]
v_pk_mul_f32 v[102:103], v[102:103], v[84:85] op_sel_hi:[1,0]
v_pk_mul_f32 v[116:117], v[116:117], v[84:85] op_sel_hi:[1,0]
v_pk_mul_f32 v[118:119], v[118:119], v[84:85] op_sel_hi:[1,0]
v_cvt_pk_bf16_f32 v172, v100, v101
v_cvt_pk_bf16_f32 v173, v102, v103
v_cvt_pk_bf16_f32 v174, v116, v117
v_cvt_pk_bf16_f32 v175, v118, v119
buffer_store_dwordx4 v[172:175], v4, s[16:19], s74 offen offset:2048 sc1
v_pk_mul_f32 v[96:97], v[96:97], v[80:81] op_sel_hi:[1,0]
v_pk_mul_f32 v[98:99], v[98:99], v[80:81] op_sel_hi:[1,0]
v_pk_mul_f32 v[112:113], v[112:113], v[80:81] op_sel_hi:[1,0]
v_pk_mul_f32 v[114:115], v[114:115], v[80:81] op_sel_hi:[1,0]
v_cvt_pk_bf16_f32 v168, v96, v97
v_cvt_pk_bf16_f32 v169, v98, v99
v_cvt_pk_bf16_f32 v170, v112, v113
v_cvt_pk_bf16_f32 v171, v114, v115
buffer_store_dwordx4 v[168:171], v4, s[16:19], s74 offen offset:1024 sc1
v_pk_mul_f32 v[92:93], v[92:93], v[76:77] op_sel_hi:[1,0]
v_pk_mul_f32 v[94:95], v[94:95], v[76:77] op_sel_hi:[1,0]
v_pk_mul_f32 v[108:109], v[108:109], v[76:77] op_sel_hi:[1,0]
v_pk_mul_f32 v[110:111], v[110:111], v[76:77] op_sel_hi:[1,0]
v_cvt_pk_bf16_f32 v164, v92, v93
v_cvt_pk_bf16_f32 v165, v94, v95
v_cvt_pk_bf16_f32 v166, v108, v109
v_cvt_pk_bf16_f32 v167, v110, v111
buffer_store_dwordx4 v[164:167], v4, s[16:19], s74 offen sc1
s_nop 1
.Lqkve2:
s_mov_b32 s36, s0
s_mov_b32 s37, s1
s_lshl_b32 s62, s3, 11
s_add_u32 s62, s62, s84
v_lshl_add_u32 v4, v1, 4, s62
v_lshrrev_b32 v2, 3, v1
v_cmp_eq_u32 vcc, 3, v2
v_add_u32 v2, 67108480, v4
s_nop 0
v_cndmask_b32 v4, v4, v2, vcc
v_bfe_u32 v8, v1, 3, 2
v_mul_u32_u24 v8, 2080, v8
v_bfe_u32 v2, v1, 2, 1
v_lshl_add_u32 v8, v2, 7, v8
v_bfe_u32 v2, v1, 5, 1
v_lshl_add_u32 v8, v2, 8, v8
v_and_b32 v2, 3, v1
v_lshl_add_u32 v8, v2, 3, v8
s_mov_b32 s57, 66560
v_add_u32 v7, s57, v8
s_lshr_b32 s54, s87, 17
s_lshl_b32 s54, s54, 18
s_add_u32 s54, s54, 4194304
s_mov_b32 s52, s54
s_add_u32 s53, s54, 131072
v_accvgpr_read_b32 v32, a224
v_accvgpr_read_b32 v33, a225
v_accvgpr_read_b32 v34, a226
v_accvgpr_read_b32 v35, a227
v_accvgpr_read_b32 v36, a228
v_accvgpr_read_b32 v37, a229
v_accvgpr_read_b32 v38, a230
v_accvgpr_read_b32 v39, a231
v_accvgpr_read_b32 v40, a232
v_accvgpr_read_b32 v41, a233
v_accvgpr_read_b32 v42, a234
v_accvgpr_read_b32 v43, a235
v_accvgpr_read_b32 v44, a236
v_accvgpr_read_b32 v45, a237
v_accvgpr_read_b32 v46, a238
v_accvgpr_read_b32 v47, a239
v_accvgpr_read_b32 v48, a240
v_accvgpr_read_b32 v49, a241
v_accvgpr_read_b32 v50, a242
v_accvgpr_read_b32 v51, a243
v_accvgpr_read_b32 v52, a244
v_accvgpr_read_b32 v53, a245
v_accvgpr_read_b32 v54, a246
v_accvgpr_read_b32 v55, a247
v_accvgpr_read_b32 v56, a248
v_accvgpr_read_b32 v57, a249
v_accvgpr_read_b32 v58, a250
v_accvgpr_read_b32 v59, a251
v_accvgpr_read_b32 v60, a252
v_accvgpr_read_b32 v61, a253
v_accvgpr_read_b32 v62, a254
v_accvgpr_read_b32 v63, a255
s_lshl_b32 s62, s8, 10
s_add_u32 s62, s62, 30425088
s_lshl_b32 s64, s6, 10
s_add_u32 s64, s64, 30425088
s_lshr_b32 s67, s5, 2
s_and_b32 s67, s67, 3
s_lshl_b32 s67, s67, 7
s_add_u32 s64, s64, s67
s_waitcnt lgkmcnt(0)
s_mov_b32 s0, 0
s_mov_b32 s1, 16
s_mov_b32 s67, 1
s_waitcnt vmcnt(0) lgkmcnt(0)
s_cmp_lg_u32 s3, 1
s_barrier
s_cbranch_scc1 .Lnopoll34
s_atomic_add s67, s[16:17], s62 offset:0x0
s_atomic_add s67, s[16:17], s62 offset:0x80
s_atomic_add s67, s[16:17], s62 offset:0x100
s_atomic_add s67, s[16:17], s62 offset:0x180
s_atomic_umax s0, s[16:17], s64 glc
s_add_u32 m0, s59, 66560
s_xor_b32 s58, s87, 0
buffer_load_dwordx4 v5, s[24:27], s58 offen lds
buffer_load_dwordx4 v6, s[24:27], s58 offen offset:1024 lds
s_add_u32 m0, s59, 116480
s_xor_b32 s58, s87, 786432
buffer_load_dwordx4 v5, s[24:27], s58 offen lds
buffer_load_dwordx4 v6, s[24:27], s58 offen offset:1024 lds
s_add_u32 m0, s59, 124800
s_xor_b32 s58, s87, 917504
buffer_load_dwordx4 v5, s[24:27], s58 offen lds
buffer_load_dwordx4 v6, s[24:27], s58 offen offset:1024 lds
s_add_u32 m0, s59, 49920
s_xor_b32 s58, s87, 1835008
buffer_load_dwordx4 v5, s[24:27], s58 offen lds
buffer_load_dwordx4 v6, s[24:27], s58 offen offset:1024 lds
s_add_u32 m0, s59, 58240
s_xor_b32 s58, s87, 1966080
buffer_load_dwordx4 v5, s[24:27], s58 offen lds
buffer_load_dwordx4 v6, s[24:27], s58 offen offset:1024 lds
s_mov_b32 s15, 0
.Lpoll33:
s_min_u32 s66, s0, s1
s_cmp_ge_u32 s66, 16
s_cbranch_scc1 .Lnopoll34r
s_atomic_umax s0, s[16:17], s64 glc
s_add_u32 s15, s15, 1
s_cmp_le_u32 s15, 100000
s_waitcnt lgkmcnt(1)
s_cbranch_scc1 .Lpoll33
s_branch .Lnopoll34r
.Lnopoll34:
s_add_u32 m0, s59, 66560
s_xor_b32 s58, s87, 0
buffer_load_dwordx4 v5, s[24:27], s58 offen lds
buffer_load_dwordx4 v6, s[24:27], s58 offen offset:1024 lds
s_add_u32 m0, s59, 116480
s_xor_b32 s58, s87, 786432
buffer_load_dwordx4 v5, s[24:27], s58 offen lds
buffer_load_dwordx4 v6, s[24:27], s58 offen offset:1024 lds
s_add_u32 m0, s59, 124800
s_xor_b32 s58, s87, 917504
buffer_load_dwordx4 v5, s[24:27], s58 offen lds
buffer_load_dwordx4 v6, s[24:27], s58 offen offset:1024 lds
s_add_u32 m0, s59, 49920
s_xor_b32 s58, s87, 1835008
buffer_load_dwordx4 v5, s[24:27], s58 offen lds
buffer_load_dwordx4 v6, s[24:27], s58 offen offset:1024 lds
s_add_u32 m0, s59, 58240
s_xor_b32 s58, s87, 1966080
buffer_load_dwordx4 v5, s[24:27], s58 offen lds
buffer_load_dwordx4 v6, s[24:27], s58 offen offset:1024 lds
s_mov_b64 exec, 0
s_cmp_eq_u32 s3, 2
s_cbranch_scc1 .Lpad11
s_cmp_eq_u32 s3, 3
s_cbranch_scc1 .Lpad12
s_branch .Lpad13
.Lnopoll34r:
s_mov_b64 exec, -1
s_waitcnt vmcnt(8)
s_barrier
buffer_load_dwordx4 v[64:67], v4, s[16:19], s52 offen sc1
buffer_load_dwordx4 v[68:71], v4, s[16:19], s52 offen offset:1024 sc1
s_xor_b32 s52, s54, 262144
buffer_load_dwordx4 v[72:75], v4, s[16:19], s53 offen sc1
buffer_load_dwordx4 v[76:79], v4, s[16:19], s53 offen offset:1024 sc1
s_xor_b32 s53, s54, 393216
buffer_load_dwordx4 v[80:83], v4, s[16:19], s52 offen sc1
buffer_load_dwordx4 v[84:87], v4, s[16:19], s52 offen offset:1024 sc1
s_xor_b32 s52, s54, 524288
buffer_load_dwordx4 v[88:91], v4, s[16:19], s53 offen sc1
buffer_load_dwordx4 v[92:95], v4, s[16:19], s53 offen offset:1024 sc1
s_xor_b32 s53, s54, 655360
buffer_load_dwordx4 v[96:99], v4, s[16:19], s52 offen sc1
buffer_load_dwordx4 v[100:103], v4, s[16:19], s52 offen offset:1024 sc1
s_xor_b32 s52, s54, 786432
buffer_load_dwordx4 v[104:107], v4, s[16:19], s53 offen sc1
buffer_load_dwordx4 v[108:111], v4, s[16:19], s53 offen offset:1024 sc1
s_xor_b32 s53, s54, 917504
ds_read_b64_tr_b16 a[0:1], v7
TR 2,7,512
TR 16,7,1024
TR 18,7,1536
TR 4,7,32
TR 6,7,544
TR 20,7,1056
TR 22,7,1568
TR 8,7,64
TR 10,7,576
TR 24,7,1088
TR 26,7,1600
TR 12,7,96
TR 14,7,608
TR 28,7,1120
TR 30,7,1632
s_lshl_b32 s62, s49, 3
s_add_u32 s62, s62, s48
s_mul_i32 s62, s62, 28672
s_add_u32 s62, s62, s51
v_lshrrev_b32 v12, 4, v1
v_mul_u32_u24 v12, 57344, v12
v_and_b32 v2, 15, v1
v_lshl_add_u32 v12, v2, 4, v12
v_add_u32 v12, s62, v12
v_add_u32 v13, 6112, v12
v_add_u32 v14, 12224, v12
v_add_u32 v15, 18336, v12
s_mul_i32 s59, s3, 4224
s_mov_b32 s58, 0
s_waitcnt vmcnt(8) lgkmcnt(14)
MAV 32,0,64
TR 32,7,8320
s_waitcnt lgkmcnt(13)
MAV 32,16,72
buffer_load_dwordx4 v[112:115], v4, s[16:19], s52 offen sc1
MAV 48,16,76
TR 34,7,8832
MAV 48,0,68
TR 48,7,9344
TR 50,7,9856
s_waitcnt lgkmcnt(14)
MAV 52,4,68
TR 36,7,8352
s_waitcnt lgkmcnt(13)
MAV 52,20,76
buffer_load_dwordx4 v[116:119], v4, s[16:19], s52 offen offset:1024 sc1
MAV 36,20,72
TR 38,7,8864
s_xor_b32 s52, s54, 1048576
MAV 36,4,64
TR 52,7,9376
TR 54,7,9888
s_waitcnt lgkmcnt(14)
MAV 40,8,64
TR 40,7,8384
s_waitcnt lgkmcnt(13)
MAV 40,24,72
buffer_load_dwordx4 v[120:123], v4, s[16:19], s53 offen sc1
MAV 56,24,76
TR 42,7,8896
MAV 56,8,68
TR 56,7,9408
TR 58,7,9920
s_waitcnt lgkmcnt(14)
MAV 60,12,68
TR 44,7,8416
s_waitcnt lgkmcnt(13)
MAV 60,28,76
buffer_load_dwordx4 v[124:127], v4, s[16:19], s53 offen offset:1024 sc1
MAV 44,28,72
TR 46,7,8928
s_xor_b32 s53, s54, 1179648
MAV 44,12,64
TR 60,7,9440
TR 62,7,9952
s_waitcnt vmcnt(8) lgkmcnt(8)
MAV 32,32,80
TR 0,7,16640
MAV 32,48,88
buffer_load_dwordx4 v[64:67], v4, s[16:19], s52 offen sc1
MAV 48,48,92
TR 2,7,17152
MAV 48,32,84
TR 16,7,17664
TR 18,7,18176
MAV 52,36,84
TR 4,7,16672
MAV 52,52,92
buffer_load_dwordx4 v[68:71], v4, s[16:19], s52 offen offset:1024 sc1
MAV 36,52,88
TR 6,7,17184
s_xor_b32 s52, s54, 1310720
MAV 36,36,80
TR 20,7,17696
TR 22,7,18208
s_waitcnt lgkmcnt(8)
MAV 40,40,80
TR 8,7,16704
MAV 40,56,88
buffer_load_dwordx4 v[72:75], v4, s[16:19], s53 offen sc1
MAV 56,56,92
TR 10,7,17216
MAV 56,40,84
TR 24,7,17728
TR 26,7,18240
MAV 60,44,84
TR 12,7,16736
MAV 60,60,92
buffer_load_dwordx4 v[76:79], v4, s[16:19], s53 offen offset:1024 sc1
MAV 44,60,88
TR 14,7,17248
s_xor_b32 s53, s54, 1441792
MAV 44,44,80
TR 28,7,17760
TR 30,7,18272
s_waitcnt vmcnt(8) lgkmcnt(8)
MAV 32,0,96
TR 32,7,24960
MAV 32,16,104
buffer_load_dwordx4 v[80:83], v4, s[16:19], s52 offen sc1
MAV 48,16,108
TR 34,7,25472
MAV 48,0,100
TR 48,7,25984
TR 50,7,26496
MAV 52,4,100
TR 36,7,24992
MAV 52,20,108
buffer_load_dwordx4 v[84:87], v4, s[16:19], s52 offen offset:1024 sc1
MAV 36,20,104
TR 38,7,25504
s_xor_b32 s52, s54, 1572864
MAV 36,4,96
TR 52,7,26016
TR 54,7,26528
s_waitcnt lgkmcnt(8)
MAV 40,8,96
TR 40,7,25024
MAV 40,24,104
buffer_load_dwordx4 v[88:91], v4, s[16:19], s53 offen sc1
MAV 56,24,108
TR 42,7,25536
MAV 56,8,100
TR 56,7,26048
TR 58,7,26560
MAV 60,12,100
TR 44,7,25056
MAV 60,28,108
buffer_load_dwordx4 v[92:95], v4, s[16:19], s53 offen offset:1024 sc1
.Lpad11:
s_cbranch_execz .Lpad14
MAV 44,28,104
TR 46,7,25568
s_xor_b32 s53, s54, 1703936
MAV 44,12,96
TR 60,7,26080
TR 62,7,26592
s_barrier
s_waitcnt vmcnt(8) lgkmcnt(8)
MAV 32,32,112
TR 0,7,33280
MAV 32,48,120
buffer_load_dwordx4 v[96:99], v4, s[16:19], s52 offen sc1
MAV 48,48,124
TR 2,7,33792
MAV 48,32,116
TR 16,7,34304
TR 18,7,34816
MAV 52,36,116
TR 4,7,33312
MAV 52,52,124
buffer_load_dwordx4 v[100:103], v4, s[16:19], s52 offen offset:1024 sc1
MAV 36,52,120
TR 6,7,33824
s_xor_b32 s52, s54, 1835008
MAV 36,36,112
TR 20,7,34336
TR 22,7,34848
s_waitcnt lgkmcnt(8)
MAV 40,40,112
TR 8,7,33344
MAV 40,56,120
buffer_load_dwordx4 v[104:107], v4, s[16:19], s53 offen sc1
MAV 56,56,124
TR 10,7,33856
MAV 56,40,116
TR 24,7,34368
TR 26,7,34880
MAV 60,44,116
TR 12,7,33376
MAV 60,60,124
buffer_load_dwordx4 v[108:111], v4, s[16:19], s53 offen offset:1024 sc1
MAV 44,60,120
TR 14,7,33888
s_xor_b32 s53, s54, 1966080
MAV 44,44,112
TR 28,7,34400
TR 30,7,34912
s_waitcnt vmcnt(8) lgkmcnt(8)
MAV 32,0,64
TR 32,7,41600
MAV 32,16,72
buffer_load_dwordx4 v[112:115], v4, s[16:19], s52 offen sc1
MAV 48,16,76
TR 34,7,42112
MAV 48,0,68
TR 48,7,42624
TR 50,7,43136
MAV 52,4,68
TR 36,7,41632
MAV 52,20,76
buffer_load_dwordx4 v[116:119], v4, s[16:19], s52 offen offset:1024 sc1
MAV 36,20,72
TR 38,7,42144
s_xor_b32 s52, s54, 2097152
MAV 36,4,64
TR 52,7,42656
TR 54,7,43168
s_waitcnt lgkmcnt(8)
MAV 40,8,64
TR 40,7,41664
MAV 40,24,72
buffer_load_dwordx4 v[120:123], v4, s[16:19], s53 offen sc1
MAV 56,24,76
TR 42,7,42176
MAV 56,8,68
TR 56,7,42688
TR 58,7,43200
MAV 60,12,68
TR 44,7,41696
MAV 60,28,76
buffer_load_dwordx4 v[124:127], v4, s[16:19], s53 offen offset:1024 sc1
MAV 44,28,72
TR 46,7,42208
s_xor_b32 s53, s54, 2228224
MAV 44,12,64
TR 60,7,42720
TR 62,7,43232
s_waitcnt vmcnt(8) lgkmcnt(8)
MAV 32,32,80
TR 0,7,49920
MAV 32,48,88
buffer_load_dwordx4 v[64:67], v4, s[16:19], s52 offen sc1
MAV 48,48,92
TR 2,7,50432
MAV 48,32,84
TR 16,7,50944
TR 18,7,51456
MAV 52,36,84
TR 4,7,49952
MAV 52,52,92
buffer_load_dwordx4 v[68:71], v4, s[16:19], s52 offen offset:1024 sc1
MAV 36,52,88
TR 6,7,50464
s_xor_b32 s52, s54, 2359296
MAV 36,36,80
TR 20,7,50976
TR 22,7,51488
s_waitcnt lgkmcnt(8)
MAV 40,40,80
TR 8,7,49984
MAV 40,56,88
buffer_load_dwordx4 v[72:75], v4, s[16:19], s53 offen sc1
MAV 56,56,92
TR 10,7,50496
MAV 56,40,84
TR 24,7,51008
TR 26,7,51520
MAV 60,44,84
TR 12,7,50016
MAV 60,60,92
buffer_load_dwordx4 v[76:79], v4, s[16:19], s53 offen offset:1024 sc1
MAV 44,60,88
TR 14,7,50528
s_xor_b32 s53, s54, 2490368
MAV 44,44,80
TR 28,7,51040
TR 30,7,51552
s_waitcnt vmcnt(8) lgkmcnt(8)
MAV 32,0,96
TR 32,7,58240
MAV 32,16,104
buffer_load_dwordx4 v[80:83], v4, s[16:19], s52 offen sc1
MAV 48,16,108
TR 34,7,58752
MAV 48,0,100
TR 48,7,59264
TR 50,7,59776
MAV 52,4,100
TR 36,7,58272
MAV 52,20,108
buffer_load_dwordx4 v[84:87], v4, s[16:19], s52 offen offset:1024 sc1
MAV 36,20,104
TR 38,7,58784
s_xor_b32 s52, s54, 2621440
MAV 36,4,96
TR 52,7,59296
TR 54,7,59808
s_waitcnt lgkmcnt(8)
MAV 40,8,96
TR 40,7,58304
MAV 40,24,104
buffer_load_dwordx4 v[88:91], v4, s[16:19], s53 offen sc1
MAV 56,24,108
TR 42,7,58816
MAV 56,8,100
TR 56,7,59328
TR 58,7,59840
MAV 60,12,100
TR 44,7,58336
MAV 60,28,108
buffer_load_dwordx4 v[92:95], v4, s[16:19], s53 offen offset:1024 sc1
MAV 44,28,104
TR 46,7,58848
s_xor_b32 s53, s54, 2752512
MAV 44,12,96
TR 60,7,59360
TR 62,7,59872
s_xor_b32 s57, s57, 66560
v_add_u32 v7, s57, v8
s_waitcnt vmcnt(8) lgkmcnt(8)
MAV 32,32,112
ds_read_b64_tr_b16 a[0:1], v7
MAV 32,48,120
buffer_load_dwordx4 v[96:99], v4, s[16:19], s52 offen sc1
MAV 48,48,124
TR 2,7,512
MAV 48,32,116
TR 16,7,1024
TR 18,7,1536
MAV 52,36,116
TR 4,7,32
MAV 52,52,124
buffer_load_dwordx4 v[100:103], v4, s[16:19], s52 offen offset:1024 sc1
MAV 36,52,120
TR 6,7,544
s_xor_b32 s52, s54, 2883584
MAV 36,36,112
TR 20,7,1056
TR 22,7,1568
s_waitcnt lgkmcnt(8)
MAV 40,40,112
TR 8,7,64
MAV 40,56,120
buffer_load_dwordx4 v[104:107], v4, s[16:19], s53 offen sc1
MAV 56,56,124
TR 10,7,576
MAV 56,40,116
TR 24,7,1088
TR 26,7,1600
MAV 60,44,116
TR 12,7,96
MAV 60,60,124
buffer_load_dwordx4 v[108:111], v4, s[16:19], s53 offen offset:1024 sc1
MAV 44,60,120
TR 14,7,608
s_xor_b32 s53, s54, 3014656
MAV 44,44,112
TR 28,7,1120
TR 30,7,1632
s_waitcnt vmcnt(8) lgkmcnt(8)
MAV 32,0,64
TR 32,7,8320
MAV 32,16,72
buffer_load_dwordx4 v[112:115], v4, s[16:19], s52 offen sc1
MAV 48,16,76
TR 34,7,8832
MAV 48,0,68
TR 48,7,9344
TR 50,7,9856
MAV 52,4,68
TR 36,7,8352
MAV 52,20,76
buffer_load_dwordx4 v[116:119], v4, s[16:19], s52 offen offset:1024 sc1
MAV 36,20,72
TR 38,7,8864
s_xor_b32 s52, s54, 3145728
MAV 36,4,64
TR 52,7,9376
TR 54,7,9888
s_waitcnt lgkmcnt(8)
MAV 40,8,64
TR 40,7,8384
MAV 40,24,72
buffer_load_dwordx4 v[120:123], v4, s[16:19], s53 offen sc1
MAV 56,24,76
TR 42,7,8896
MAV 56,8,68
TR 56,7,9408
TR 58,7,9920
MAV 60,12,68
TR 44,7,8416
MAV 60,28,76
buffer_load_dwordx4 v[124:127], v4, s[16:19], s53 offen offset:1024 sc1
MAV 44,28,72
TR 46,7,8928
s_xor_b32 s53, s54, 3276800
MAV 44,12,64
TR 60,7,9440
TR 62,7,9952
s_waitcnt vmcnt(8) lgkmcnt(8)
MAV 32,32,80
TR 0,7,16640
MAV 32,48,88
buffer_load_dwordx4 v[64:67], v4, s[16:19], s52 offen sc1
MAV 48,48,92
TR 2,7,17152
MAV 48,32,84
TR 16,7,17664
TR 18,7,18176
MAV 52,36,84
TR 4,7,16672
MAV 52,52,92
buffer_load_dwordx4 v[68:71], v4, s[16:19], s52 offen offset:1024 sc1
MAV 36,52,88
TR 6,7,17184
s_xor_b32 s52, s54, 3407872
MAV 36,36,80
TR 20,7,17696
TR 22,7,18208
s_waitcnt lgkmcnt(8)
MAV 40,40,80
TR 8,7,16704
MAV 40,56,88
buffer_load_dwordx4 v[72:75], v4, s[16:19], s53 offen sc1
MAV 56,56,92
TR 10,7,17216
MAV 56,40,84
TR 24,7,17728
TR 26,7,18240
MAV 60,44,84
TR 12,7,16736
MAV 60,60,92
buffer_load_dwordx4 v[76:79], v4, s[16:19], s53 offen offset:1024 sc1
MAV 44,60,88
TR 14,7,17248
s_xor_b32 s53, s54, 3538944
MAV 44,44,80
TR 28,7,17760
TR 30,7,18272
s_waitcnt vmcnt(8) lgkmcnt(8)
MAV 32,0,96
TR 32,7,24960
MAV 32,16,104
buffer_load_dwordx4 v[80:83], v4, s[16:19], s52 offen sc1
MAV 48,16,108
TR 34,7,25472
MAV 48,0,100
TR 48,7,25984
TR 50,7,26496
MAV 52,4,100
TR 36,7,24992
MAV 52,20,108
buffer_load_dwordx4 v[84:87], v4, s[16:19], s52 offen offset:1024 sc1
MAV 36,20,104
TR 38,7,25504
s_xor_b32 s52, s54, 3670016
MAV 36,4,96
TR 52,7,26016
TR 54,7,26528
s_waitcnt lgkmcnt(8)
MAV 40,8,96
TR 40,7,25024
MAV 40,24,104
buffer_load_dwordx4 v[88:91], v4, s[16:19], s53 offen sc1
MAV 56,24,108
TR 42,7,25536
MAV 56,8,100
TR 56,7,26048
TR 58,7,26560
MAV 60,12,100
TR 44,7,25056
MAV 60,28,108
buffer_load_dwordx4 v[92:95], v4, s[16:19], s53 offen offset:1024 sc1
MAV 44,28,104
TR 46,7,25568
s_xor_b32 s53, s54, 3801088
MAV 44,12,96
TR 60,7,26080
TR 62,7,26592
s_waitcnt vmcnt(8) lgkmcnt(8)
MAV 32,32,112
TR 0,7,33280
MAV 32,48,120
buffer_load_dwordx4 v[96:99], v4, s[16:19], s52 offen sc1
MAV 48,48,124
TR 2,7,33792
MAV 48,32,116
TR 16,7,34304
TR 18,7,34816
MAV 52,36,116
TR 4,7,33312
MAV 52,52,124
buffer_load_dwordx4 v[100:103], v4, s[16:19], s52 offen offset:1024 sc1
MAV 36,52,120
TR 6,7,33824
s_xor_b32 s52, s54, 3932160
MAV 36,36,112
TR 20,7,34336
TR 22,7,34848
s_waitcnt lgkmcnt(8)
MAV 40,40,112
TR 8,7,33344
MAV 40,56,120
buffer_load_dwordx4 v[104:107], v4, s[16:19], s53 offen sc1
MAV 56,56,124
TR 10,7,33856
MAV 56,40,116
TR 24,7,34368
TR 26,7,34880
MAV 60,44,116
TR 12,7,33376
MAV 60,60,124
buffer_load_dwordx4 v[108:111], v4, s[16:19], s53 offen offset:1024 sc1
MAV 44,60,120
TR 14,7,33888
s_xor_b32 s53, s54, 4063232
MAV 44,44,112
TR 28,7,34400
TR 30,7,34912
s_waitcnt vmcnt(8) lgkmcnt(8)
MAV 32,0,64
TR 32,7,41600
MAV 32,16,72
buffer_load_dwordx4 v[112:115], v4, s[16:19], s52 offen sc1
MAV 48,16,76
TR 34,7,42112
MAV 48,0,68
TR 48,7,42624
TR 50,7,43136
MAV 52,4,68
TR 36,7,41632
MAV 52,20,76
buffer_load_dwordx4 v[116:119], v4, s[16:19], s52 offen offset:1024 sc1
MAV 36,20,72
TR 38,7,42144
MAV 36,4,64
TR 52,7,42656
TR 54,7,43168
s_waitcnt lgkmcnt(8)
MAV 40,8,64
TR 40,7,41664
MAV 40,24,72
buffer_load_dwordx4 v[120:123], v4, s[16:19], s53 offen sc1
MAV 56,24,76
TR 42,7,42176
MAV 56,8,68
TR 56,7,42688
TR 58,7,43200
MAV 60,12,68
TR 44,7,41696
MAV 60,28,76
buffer_load_dwordx4 v[124:127], v4, s[16:19], s53 offen offset:1024 sc1
MAV 44,28,72
TR 46,7,42208
MAV 44,12,64
TR 60,7,42720
TR 62,7,43232
s_barrier
s_waitcnt vmcnt(8) lgkmcnt(8)
MAV 32,32,80
TR 0,7,49920
s_add_u32 m0, s59, 84480
MAV 32,48,88
buffer_load_dwordx4 v12, s[32:35], s58 offen lds
MAV 48,48,92
TR 2,7,50432
MAV 48,32,84
TR 16,7,50944
TR 18,7,51456
MAV 52,36,84
TR 4,7,49952
MAV 52,52,92
TR 6,7,50464
TR 20,7,50976
MAV 36,52,88
TR 22,7,51488
MAV 36,36,80
TR 8,7,49984
s_waitcnt lgkmcnt(9)
MAV 40,40,80
TR 10,7,50496
MAV 40,56,88
buffer_load_dwordx4 v13, s[32:35], s58 offen offset:1056 lds
MAV 56,56,92
TR 24,7,51008
MAV 56,40,84
buffer_load_dwordx4 v14, s[32:35], s58 offen offset:2112 lds
MAV 60,44,84
TR 26,7,51520
MAV 60,60,92
TR 12,7,50016
TR 14,7,50528
MAV 44,60,88
TR 28,7,51040
MAV 44,44,80
TR 30,7,51552
s_waitcnt vmcnt(7) lgkmcnt(8)
MAV 32,0,96
TR 32,7,58240
MAV 32,16,104
buffer_load_dwordx4 v15, s[32:35], s58 offen offset:3168 lds
MAV 48,16,108
TR 34,7,58752
MAV 48,0,100
TR 48,7,59264
TR 50,7,59776
MAV 52,4,100
TR 36,7,58272
MAV 52,20,108
TR 38,7,58784
TR 52,7,59296
MAV 36,20,104
TR 54,7,59808
MAV 36,4,96
TR 40,7,58304
s_waitcnt lgkmcnt(9)
MAV 40,8,96
TR 42,7,58816
s_add_u32 m0, s59, 101376
MAV 40,24,104
buffer_load_dwordx4 v12, s[80:83], s58 offen lds
MAV 56,24,108
TR 56,7,59328
MAV 56,8,100
buffer_load_dwordx4 v13, s[80:83], s58 offen offset:1056 lds
MAV 60,12,100
TR 58,7,59840
MAV 60,28,108
TR 44,7,58336
TR 46,7,58848
MAV 44,28,104
TR 60,7,59360
MAV 44,12,96
TR 62,7,59872
s_waitcnt vmcnt(9) lgkmcnt(14)
MAV 32,32,112
buffer_load_dwordx4 v14, s[80:83], s58 offen offset:2112 lds
s_waitcnt vmcnt(8) lgkmcnt(12)
MAV 32,48,120
s_lshl_b32 s64, s6, 14
s_lshl_b32 s65, s49, 13
s_add_u32 s64, s64, s65
s_waitcnt vmcnt(7)
MAV 48,48,124
s_lshl_b32 s65, s7, 9
s_add_u32 s64, s64, s65
s_lshl_b32 s65, s48, 8
MAV 48,32,116
s_add_u32 s64, s64, s65
s_add_u32 s64, s64, 29622272
v_and_b32 v152, 31, v1
s_waitcnt lgkmcnt(10)
MAV 52,36,116
buffer_load_dwordx4 v15, s[80:83], s58 offen offset:3168 lds
s_waitcnt lgkmcnt(8)
MAV 52,52,124
s_add_u32 s58, s58, 458752
v_lshlrev_b32 v152, 3, v152
v_lshrrev_b32 v153, 5, v1
MAV 36,52,120
s_lshl_b32 s62, s7, 18
v_lshl_add_u32 v152, v153, 28, v152
s_add_u32 s62, s62, 8388608
MAV 36,36,112
s_add_u32 s63, s62, 131072
v_cvt_pk_bf16_f32 v128, v32, v33
v_cvt_pk_bf16_f32 v129, v34, v35
s_waitcnt lgkmcnt(6)
MAV 40,40,112
v_cvt_pk_bf16_f32 v136, v48, v49
v_cvt_pk_bf16_f32 v137, v50, v51
s_waitcnt lgkmcnt(4)
MAV 40,56,120
v_cvt_pk_bf16_f32 v130, v36, v37
v_cvt_pk_bf16_f32 v131, v38, v39
MAV 56,56,124
buffer_store_dwordx4 v[128:131], v4, s[16:19], s62 offen sc1
MAV 56,40,116
v_cvt_pk_bf16_f32 v138, v52, v53
v_cvt_pk_bf16_f32 v139, v54, v55
s_waitcnt lgkmcnt(2)
MAV 60,44,116
v_cvt_pk_bf16_f32 v132, v40, v41
v_cvt_pk_bf16_f32 v133, v42, v43
s_waitcnt lgkmcnt(0)
.Lpad12:
s_cbranch_execz .Lpad15
MAV 60,60,124
v_cvt_pk_bf16_f32 v140, v56, v57
MAV 44,60,120
buffer_store_dwordx4 v[136:139], v4, s[16:19], s62 offen offset:1024 sc1
MAV 44,44,112
v_cvt_pk_bf16_f32 v141, v58, v59
s_nop 2
v_cvt_pk_bf16_f32 v142, v60, v61
v_pk_mul_f32 v[146:147], v[32:33], v[32:33]
v_pk_mul_f32 v[150:151], v[48:49], v[48:49]
v_cvt_pk_bf16_f32 v143, v62, v63
v_pk_fma_f32 v[146:147], v[34:35], v[34:35], v[146:147]
v_pk_add_f32 v[144:145], v[32:33], v[34:35]
v_pk_fma_f32 v[150:151], v[50:51], v[50:51], v[150:151]
v_cvt_pk_bf16_f32 v134, v44, v45
v_cvt_pk_bf16_f32 v135, v46, v47
buffer_store_dwordx4 v[132:135], v4, s[16:19], s63 offen sc1
v_pk_add_f32 v[148:149], v[48:49], v[50:51]
v_pk_fma_f32 v[146:147], v[36:37], v[36:37], v[146:147]
v_pk_add_f32 v[144:145], v[144:145], v[36:37]
v_pk_fma_f32 v[150:151], v[52:53], v[52:53], v[150:151]
v_pk_add_f32 v[148:149], v[148:149], v[52:53]
v_pk_fma_f32 v[146:147], v[38:39], v[38:39], v[146:147]
v_pk_add_f32 v[144:145], v[144:145], v[38:39]
v_pk_fma_f32 v[150:151], v[54:55], v[54:55], v[150:151]
v_pk_add_f32 v[148:149], v[148:149], v[54:55]
v_pk_fma_f32 v[146:147], v[40:41], v[40:41], v[146:147]
v_pk_add_f32 v[144:145], v[144:145], v[40:41]
v_pk_fma_f32 v[150:151], v[56:57], v[56:57], v[150:151]
v_pk_add_f32 v[148:149], v[148:149], v[56:57]
buffer_store_dwordx4 v[140:143], v4, s[16:19], s63 offen offset:1024 sc1
v_pk_fma_f32 v[146:147], v[42:43], v[42:43], v[146:147]
v_pk_add_f32 v[144:145], v[144:145], v[42:43]
v_pk_fma_f32 v[150:151], v[58:59], v[58:59], v[150:151]
v_pk_add_f32 v[148:149], v[148:149], v[58:59]
v_pk_fma_f32 v[146:147], v[44:45], v[44:45], v[146:147]
v_pk_add_f32 v[144:145], v[144:145], v[44:45]
v_pk_fma_f32 v[150:151], v[60:61], v[60:61], v[150:151]
v_pk_add_f32 v[148:149], v[148:149], v[60:61]
v_pk_fma_f32 v[146:147], v[46:47], v[46:47], v[146:147]
v_pk_add_f32 v[144:145], v[144:145], v[46:47]
v_pk_fma_f32 v[150:151], v[62:63], v[62:63], v[150:151]
v_pk_add_f32 v[148:149], v[148:149], v[62:63]
v_add_f32 v144, v144, v145
v_add_f32 v146, v146, v147
v_add_f32 v148, v148, v149
v_add_f32 v150, v150, v151
s_nop 0
v_permlane16_swap_b32 v144, v148
v_permlane16_swap_b32 v146, v150
v_add_f32 v144, v144, v148
v_add_f32 v146, v146, v150
s_nop 1
v_permlane32_swap_b32 v144, v146
v_add_f32 v144, v144, v146
s_nop 1
v_permlane32_swap_b32 v144, v145
buffer_store_dwordx2 v[144:145], v152, s[16:19], s64 offen sc1
s_nop 1
s_mov_b32 s54, s58
s_mov_b32 s55, s59
v_accvgpr_write_b32 a224, v32
v_accvgpr_write_b32 a225, v33
v_accvgpr_write_b32 a226, v34
v_accvgpr_write_b32 a227, v35
v_accvgpr_write_b32 a228, v36
v_accvgpr_write_b32 a229, v37
v_accvgpr_write_b32 a230, v38
v_accvgpr_write_b32 a231, v39
v_accvgpr_write_b32 a232, v40
v_accvgpr_write_b32 a233, v41
v_accvgpr_write_b32 a234, v42
v_accvgpr_write_b32 a235, v43
v_accvgpr_write_b32 a236, v44
v_accvgpr_write_b32 a237, v45
v_accvgpr_write_b32 a238, v46
v_accvgpr_write_b32 a239, v47
v_accvgpr_write_b32 a240, v48
v_accvgpr_write_b32 a241, v49
v_accvgpr_write_b32 a242, v50
v_accvgpr_write_b32 a243, v51
v_accvgpr_write_b32 a244, v52
v_accvgpr_write_b32 a245, v53
v_accvgpr_write_b32 a246, v54
v_accvgpr_write_b32 a247, v55
v_accvgpr_write_b32 a248, v56
v_accvgpr_write_b32 a249, v57
v_accvgpr_write_b32 a250, v58
v_accvgpr_write_b32 a251, v59
v_accvgpr_write_b32 a252, v60
v_accvgpr_write_b32 a253, v61
v_accvgpr_write_b32 a254, v62
v_accvgpr_write_b32 a255, v63
s_lshl_b32 s62, s10, 14
s_lshl_b32 s63, s3, 12
s_add_u32 s62, s62, s63
s_lshl_b32 s63, s12, 11
s_add_u32 s62, s62, s63
v_lshl_add_u32 v10, v1, 4, s62
v_lshrrev_b32 v2, 3, v1
v_cmp_eq_u32 vcc, 3, v2
v_add_u32 v2, 67108480, v10
s_nop 0
v_cndmask_b32 v10, v10, v2, vcc
v_xor_b32 v11, 2048, v10
v_bfe_u32 v16, v1, 2, 3
v_mul_u32_u24 v16, 1056, v16
v_bfe_u32 v2, v1, 5, 1
v_lshl_add_u32 v16, v2, 8, v16
v_and_b32 v2, 3, v1
v_lshl_add_u32 v16, v2, 3, v16
s_lshl_b32 s62, s12, 6
s_add_u32 s62, s62, 84480
s_xor_b32 s63, s12, 1
s_mul_i32 s63, s63, 192
s_add_u32 s63, s63, 84480
v_add_u32 v17, s63, v16
v_add_u32 v16, s62, v16
s_mov_b32 s52, 8388608
s_mov_b32 s53, 8388608
s_mul_i32 s59, s3, 2112
s_and_b32 s62, s7, 1
s_mul_i32 s62, s62, 3670016
s_lshr_b32 s63, s7, 1
s_lshl_b32 s63, s63, 8
s_add_u32 s62, s62, s63
s_lshl_b32 s63, s3, 12
s_add_u32 s62, s62, s63
v_lshrrev_b32 v5, 4, v1
v_lshlrev_b32 v5, 14, v5
v_and_b32 v2, 15, v1
v_lshl_add_u32 v5, v2, 4, v5
v_add_u32 v5, s62, v5
v_add_u32 v6, 992, v5
s_lshl_b32 s62, s10, 15
s_lshl_b32 s63, s3, 13
s_add_u32 s62, s62, s63
v_lshl_add_u32 v4, v1, 4, s62
s_and_b32 s47, s5, 3
s_lshr_b32 s63, s5, 2
s_lshl_b32 s63, s63, 3
s_add_u32 s63, s63, s4
s_lshl_b32 s62, s63, 1
s_add_u32 s62, s62, s48
s_mul_i32 s62, s62, 1792
v_lshrrev_b32 v7, 1, v1
v_min_u32 v8, 13, v7
v_lshl_add_u32 v8, v8, 7, s62
s_lshl_b32 s62, s63, 2
s_add_u32 s62, s62, s3
s_mul_i32 s62, s62, 640
v_and_b32 v7, 15, v7
v_min_u32 v7, 4, v7
v_lshl_add_u32 v7, v7, 7, s62
v_lshrrev_b32 v2, 5, v1
v_mul_u32_u24 v2, 3670016, v2
v_add_u32 v7, v7, v2
s_mul_i32 s44, s47, 163840
s_add_u32 s45, s47, 12
s_mul_i32 s45, s45, 229376
v_and_b32 v6, 3, v1
v_cmp_eq_u32 vcc, 3, v6
v_mov_b32 v2, 0x3f80
v_mov_b32 v20, 1.0
v_cndmask_b32 v2, v2, v20, vcc
v_cndmask_b32 v6, v6, 0, vcc
v_or_b32 v6, 12, v6
v_mul_u32_u24 v6, 0x1111, v6
v_lshl_or_b32 v6, v6, 16, v6
v_bfe_u32 v22, v1, 2, 2
v_cmp_eq_u32 vcc, 0, v22
s_nop 1
v_cndmask_b32 v20, 0, v2, vcc
v_cmp_eq_u32 vcc, 1, v22
s_nop 1
v_cndmask_b32 v21, 0, v2, vcc
v_accvgpr_write_b32 a208, v20
v_accvgpr_write_b32 a209, v21
v_accvgpr_write_b32 a210, v20
v_accvgpr_write_b32 a211, v21
v_accvgpr_write_b32 a212, 0
v_accvgpr_write_b32 a213, 0
v_accvgpr_write_b32 a214, 0
v_accvgpr_write_b32 a215, 0
v_accvgpr_write_b32 a216, 0
v_accvgpr_write_b32 a217, 0
v_accvgpr_write_b32 a218, 0
v_accvgpr_write_b32 a219, 0
s_cmp_lt_u32 s3, 2
s_cselect_b32 s40, s32, s80
s_cselect_b32 s41, s33, s81
s_cselect_b32 s42, s34, s82
s_add_u32 s62, s55, 84480
v_lshl_add_u32 v9, v1, 4, s62
s_lshl_b32 s62, s6, 10
s_add_u32 s62, s62, 30441472
s_lshl_b32 s64, s10, 1
s_lshl_b32 s64, s64, 10
s_add_u32 s64, s64, 30441472
s_lshr_b32 s67, s5, 2
s_and_b32 s67, s67, 3
s_lshl_b32 s67, s67, 7
s_add_u32 s64, s64, s67
s_add_u32 s65, s64, 1024
s_waitcnt lgkmcnt(0)
s_mov_b32 s0, 0
s_mov_b32 s1, 0
s_mov_b32 s67, 1
s_waitcnt vmcnt(0) lgkmcnt(0)
s_cmp_lg_u32 s3, 1
s_barrier
s_cbranch_scc1 .Lnopoll37
s_atomic_add s67, s[16:17], s62 offset:0x0
s_atomic_add s67, s[16:17], s62 offset:0x80
s_atomic_add s67, s[16:17], s62 offset:0x100
s_atomic_add s67, s[16:17], s62 offset:0x180
s_atomic_umax s0, s[16:17], s64 glc
s_atomic_umax s1, s[16:17], s65 glc
s_add_u32 m0, s55, 118272
s_nop 0
buffer_load_dwordx4 v12, s[32:35], s54 offen lds
buffer_load_dwordx4 v13, s[32:35], s54 offen offset:1056 lds
buffer_load_dwordx4 v14, s[32:35], s54 offen offset:2112 lds
buffer_load_dwordx4 v15, s[32:35], s54 offen offset:3168 lds
s_add_u32 m0, s55, 135168
s_nop 0
buffer_load_dwordx4 v12, s[80:83], s54 offen lds
buffer_load_dwordx4 v13, s[80:83], s54 offen offset:1056 lds
buffer_load_dwordx4 v14, s[80:83], s54 offen offset:2112 lds
buffer_load_dwordx4 v15, s[80:83], s54 offen offset:3168 lds
s_add_u32 s54, s54, 458752
s_mov_b32 s15, 0
.Lpoll36:
s_min_u32 s66, s0, s1
s_cmp_ge_u32 s66, 16
s_cbranch_scc1 .Lnopoll37r
s_atomic_umax s0, s[16:17], s64 glc
s_atomic_umax s1, s[16:17], s65 glc
s_add_u32 s15, s15, 1
s_cmp_le_u32 s15, 100000
s_waitcnt lgkmcnt(2)
s_cbranch_scc1 .Lpoll36
s_branch .Lnopoll37r
.Lnopoll37:
s_add_u32 m0, s55, 118272
s_nop 0
buffer_load_dwordx4 v12, s[32:35], s54 offen lds
buffer_load_dwordx4 v13, s[32:35], s54 offen offset:1056 lds
buffer_load_dwordx4 v14, s[32:35], s54 offen offset:2112 lds
buffer_load_dwordx4 v15, s[32:35], s54 offen offset:3168 lds
s_add_u32 m0, s55, 135168
s_nop 0
buffer_load_dwordx4 v12, s[80:83], s54 offen lds
buffer_load_dwordx4 v13, s[80:83], s54 offen offset:1056 lds
buffer_load_dwordx4 v14, s[80:83], s54 offen offset:2112 lds
buffer_load_dwordx4 v15, s[80:83], s54 offen offset:3168 lds
s_add_u32 s54, s54, 458752
s_mov_b64 exec, 0
s_cmp_eq_u32 s3, 2
s_cbranch_scc1 .Lpad17
s_cmp_eq_u32 s3, 3
s_cbranch_scc1 .Lpad18
s_branch .Lpad19
.Lnopoll37r:
s_mov_b64 exec, -1
s_waitcnt vmcnt(8)
s_barrier
buffer_load_dwordx4 a[128:131], v10, s[16:19], s52 offen sc1
buffer_load_dwordx4 a[132:135], v10, s[16:19], s52 offen offset:1024 sc1
s_add_u32 s52, s52, 131072
buffer_load_dwordx4 a[144:147], v10, s[16:19], s52 offen sc1
buffer_load_dwordx4 a[148:151], v10, s[16:19], s52 offen offset:1024 sc1
s_add_u32 s52, s52, 131072
buffer_load_dwordx4 a[136:139], v11, s[16:19], s53 offen sc1
buffer_load_dwordx4 a[140:143], v11, s[16:19], s53 offen offset:1024 sc1
s_add_u32 s53, s53, 131072
buffer_load_dwordx4 a[152:155], v11, s[16:19], s53 offen sc1
buffer_load_dwordx4 a[156:159], v11, s[16:19], s53 offen offset:1024 sc1
s_add_u32 s53, s53, 131072
ds_read_b64_tr_b16 a[0:1], v16
TR 2,16,512
TR 4,16,8448
TR 6,16,8960
TR 8,16,32
TR 10,16,544
TR 12,16,8480
TR 14,16,8992
TR 16,16,64
TR 18,16,576
TR 20,16,8512
TR 22,16,9024
TR 24,16,96
TR 26,16,608
TR 28,16,8544
TR 30,16,9056
TR 32,16,128
TR 34,16,640
TR 36,16,8576
TR 38,16,9088
TR 40,16,160
TR 42,16,672
TR 44,16,8608
TR 46,16,9120
ds_read_b64_tr_b16 a[48:49], v17
TR 50,17,512
TR 52,17,8448
TR 54,17,8960
TR 56,17,32
TR 58,17,544
TR 60,17,8480
TR 62,17,8992
ds_read_b128 a[192:195], v9
RD 196,9,1056
RD 200,9,2112
RD 204,9,3168
s_lshl_b32 s57, s3, 13
s_add_u32 s57, s57, 49920
v_lshl_add_u32 v2, v1, 4, s57
s_waitcnt lgkmcnt(0)
s_barrier
s_waitcnt vmcnt(7)
v_mfma_f32_16x16x32_bf16 v[32:35], a[0:3], a[128:131], 0
buffer_load_dwordx4 a[160:163], v10, s[16:19], s52 offen sc1
s_waitcnt vmcnt(6)
MAA 32,4,144
TR 64,16,16896
v_smfmac_f32_16x16x64_bf16 a[212:215], a[208:211], a[192:199], v6
TR 66,16,17408
v_smfmac_f32_16x16x64_bf16 a[212:215], a[208:211], a[200:207], v6
TR 68,16,25344
v_mfma_f32_16x16x32_bf16 v[36:39], a[0:3], a[132:135], 0
TR 70,16,25856
s_waitcnt vmcnt(5)
MAA 36,4,148
buffer_load_dwordx4 a[164:167], v10, s[16:19], s52 offen offset:1024 sc1
v_mfma_f32_16x16x32_bf16 v[52:55], a[8:11], a[132:135], 0
TR 72,16,16928
s_add_u32 s52, s52, 131072
MAA 52,12,148
TR 74,16,17440
v_mfma_f32_16x16x32_bf16 v[48:51], a[8:11], a[128:131], 0
TR 76,16,25376
MAA 48,12,144
TR 78,16,25888
v_mfma_f32_16x16x32_bf16 v[96:99], a[16:19], a[128:131], 0
buffer_load_dwordx4 a[176:179], v10, s[16:19], s52 offen sc1
MAA 96,20,144
TR 80,16,16960
v_mfma_f32_16x16x32_bf16 v[100:103], a[16:19], a[132:135], 0
TR 82,16,17472
MAA 100,20,148
TR 84,16,25408
v_mfma_f32_16x16x32_bf16 v[116:119], a[24:27], a[132:135], 0
TR 86,16,25920
MAA 116,28,148
buffer_load_dwordx4 a[180:183], v10, s[16:19], s52 offen offset:1024 sc1
v_mfma_f32_16x16x32_bf16 v[112:115], a[24:27], a[128:131], 0
TR 88,16,16992
s_add_u32 s52, s52, 131072
MAA 112,28,144
TR 90,16,17504
v_mfma_f32_16x16x32_bf16 v[160:163], a[32:35], a[128:131], 0
TR 92,16,25440
MAA 160,36,144
TR 94,16,25952
v_mfma_f32_16x16x32_bf16 v[164:167], a[32:35], a[132:135], 0
buffer_load_dwordx4 a[168:171], v11, s[16:19], s53 offen sc1
MAA 164,36,148
TR 96,16,17024
v_mfma_f32_16x16x32_bf16 v[180:183], a[40:43], a[132:135], 0
TR 98,16,17536
MAA 180,44,148
TR 100,16,25472
v_mfma_f32_16x16x32_bf16 v[176:179], a[40:43], a[128:131], 0
TR 102,16,25984
MAA 176,44,144
buffer_load_dwordx4 a[172:175], v11, s[16:19], s53 offen offset:1024 sc1
v_mfma_f32_16x16x32_bf16 v[224:227], a[48:51], a[128:131], 0
TR 104,16,17056
s_add_u32 s53, s53, 131072
MAA 224,52,144
TR 106,16,17568
v_mfma_f32_16x16x32_bf16 v[228:231], a[48:51], a[132:135], 0
TR 108,16,25504
MAA 228,52,148
TR 110,16,26016
v_mfma_f32_16x16x32_bf16 v[236:239], a[56:59], a[132:135], 0
buffer_load_dwordx4 a[184:187], v11, s[16:19], s53 offen sc1
MAA 236,60,148
TR 112,17,16896
v_mfma_f32_16x16x32_bf16 v[232:235], a[56:59], a[128:131], 0
TR 114,17,17408
MAA 232,60,144
TR 116,17,25344
s_waitcnt vmcnt(7)
v_mfma_f32_16x16x32_bf16 v[188:191], a[40:43], a[140:143], 0
TR 118,17,25856
MAA 188,44,156
buffer_load_dwordx4 a[188:191], v11, s[16:19], s53 offen offset:1024 sc1
v_mfma_f32_16x16x32_bf16 v[184:187], a[40:43], a[136:139], 0
TR 120,17,16928
s_add_u32 s53, s53, 131072
MAA 184,44,152
TR 122,17,17440
s_add_u32 m0, s55, 84480
v_mfma_f32_16x16x32_bf16 v[168:171], a[32:35], a[136:139], 0
TR 124,17,25376
MAA 168,36,152
TR 126,17,25888
v_mfma_f32_16x16x32_bf16 v[172:175], a[32:35], a[140:143], 0
buffer_load_dwordx4 v12, s[32:35], s54 offen lds
MAA 172,36,156
RD 192,9,16896
v_mfma_f32_16x16x32_bf16 v[124:127], a[24:27], a[140:143], 0
RD 196,9,17952
MAA 124,28,156
RD 200,9,19008
v_mfma_f32_16x16x32_bf16 v[120:123], a[24:27], a[136:139], 0
RD 204,9,20064
MAA 120,28,152
buffer_load_dwordx4 v13, s[32:35], s54 offen offset:1056 lds
v_mfma_f32_16x16x32_bf16 v[104:107], a[16:19], a[136:139], 0
MAA 104,20,152
v_mfma_f32_16x16x32_bf16 v[108:111], a[16:19], a[140:143], 0
MAA 108,20,156
v_mfma_f32_16x16x32_bf16 v[60:63], a[8:11], a[140:143], 0
buffer_load_dwordx4 v14, s[32:35], s54 offen offset:2112 lds
MAA 60,12,156
v_mfma_f32_16x16x32_bf16 v[56:59], a[8:11], a[136:139], 0
MAA 56,12,152
v_mfma_f32_16x16x32_bf16 v[40:43], a[0:3], a[136:139], 0
MAA 40,4,152
buffer_load_dwordx4 v15, s[32:35], s54 offen offset:3168 lds
v_mfma_f32_16x16x32_bf16 v[44:47], a[0:3], a[140:143], 0
MAA 44,4,156
s_waitcnt lgkmcnt(0)
s_barrier
v_mfma_f32_16x16x32_bf16 v[64:67], a[64:67], a[128:131], 0
TR 0,16,33792
s_add_u32 m0, s55, 101376
MAA 64,68,144
buffer_load_dwordx4 v12, s[80:83], s54 offen lds
v_smfmac_f32_16x16x64_bf16 a[216:219], a[208:211], a[192:199], v6
TR 2,16,34304
s_mul_i32 s66, s13, 114688
v_smfmac_f32_16x16x64_bf16 a[216:219], a[208:211], a[200:207], v6
TR 4,16,42240
s_mul_i32 s65, s10, 1818624
v_mfma_f32_16x16x32_bf16 v[68:71], a[64:67], a[132:135], 0
TR 6,16,42752
s_add_u32 s66, s66, s65
MAA 68,68,148
TR 8,16,33824
s_add_u32 s66, s66, 12582912
v_mfma_f32_16x16x32_bf16 v[84:87], a[72:75], a[132:135], 0
buffer_load_dwordx4 v13, s[80:83], s54 offen offset:1056 lds
MAA 84,76,148
TR 10,16,34336
s_add_u32 s65, s66, 49152
v_mfma_f32_16x16x32_bf16 v[80:83], a[72:75], a[128:131], 0
TR 12,16,42272
s_lshl_b32 s62, s12, 16
MAA 80,76,144
TR 14,16,42784
s_add_u32 s62, s62, s66
v_mfma_f32_16x16x32_bf16 v[128:131], a[80:83], a[128:131], 0
TR 16,16,33856
s_add_u32 s63, s62, 16384
MAA 128,84,144
buffer_load_dwordx4 v14, s[80:83], s54 offen offset:2112 lds
v_mfma_f32_16x16x32_bf16 v[132:135], a[80:83], a[132:135], 0
TR 18,16,34368
s_add_u32 s64, s62, 32768
MAA 132,84,148
TR 20,16,42304
s_lshl_b32 s72, s10, 1
v_mfma_f32_16x16x32_bf16 v[148:151], a[88:91], a[132:135], 0
TR 22,16,42816
s_lshr_b32 s74, s11, 4
MAA 148,92,148
TR 24,16,33888
s_add_u32 s72, s72, s74
v_mfma_f32_16x16x32_bf16 v[144:147], a[88:91], a[128:131], 0
buffer_load_dwordx4 v15, s[80:83], s54 offen offset:3168 lds
MAA 144,92,144
TR 26,16,34400
s_add_u32 s54, s54, 458752
v_mfma_f32_16x16x32_bf16 v[192:195], a[96:99], a[128:131], 0
TR 28,16,42336
s_add_u32 m0, s57, 0
MAA 192,100,144
TR 30,16,42848
s_mov_b32 s58, 29622272
v_mfma_f32_16x16x32_bf16 v[196:199], a[96:99], a[132:135], 0
TR 32,16,33920
s_lshl_b32 s72, s72, 10
MAA 196,100,148
buffer_load_dwordx4 v4, s[16:19], s58 offen sc1 lds
v_mfma_f32_16x16x32_bf16 v[212:215], a[104:107], a[132:135], 0
TR 34,16,34432
s_add_u32 s72, s72, 30457856
MAA 212,108,148
TR 36,16,42368
s_and_b32 s73, s6, 14
v_mfma_f32_16x16x32_bf16 v[208:211], a[104:107], a[128:131], 0
TR 38,16,42880
s_and_b32 s74, s7, 1
MAA 208,108,144
TR 40,16,33952
s_add_u32 s73, s73, s74
v_mfma_f32_16x16x32_bf16 v[240:243], a[112:115], a[128:131], 0
buffer_load_dwordx4 v4, s[16:19], s58 offen offset:1024 sc1 lds
MAA 240,116,144
TR 42,16,34464
s_lshl_b32 s73, s73, 10
v_mfma_f32_16x16x32_bf16 v[244:247], a[112:115], a[132:135], 0
TR 44,16,42400
s_add_u32 s73, s73, 30457856
MAA 244,116,148
TR 46,16,42912
s_lshr_b32 s67, s5, 2
v_mfma_f32_16x16x32_bf16 v[252:255], a[120:123], a[132:135], 0
TR 48,17,33792
MAA 252,124,148
TR 50,17,34304
v_mfma_f32_16x16x32_bf16 v[248:251], a[120:123], a[128:131], 0
buffer_load_dwordx4 a[128:131], v10, s[16:19], s52 offen sc1
MAA 248,124,144
TR 52,17,42240
v_mfma_f32_16x16x32_bf16 v[220:223], a[104:107], a[140:143], 0
TR 54,17,42752
MAA 220,108,156
TR 56,17,33824
v_mfma_f32_16x16x32_bf16 v[216:219], a[104:107], a[136:139], 0
TR 58,17,34336
MAA 216,108,152
buffer_load_dwordx4 a[132:135], v10, s[16:19], s52 offen offset:1024 sc1
v_mfma_f32_16x16x32_bf16 v[200:203], a[96:99], a[136:139], 0
TR 60,17,42272
s_add_u32 s52, s52, 131072
MAA 200,100,152
TR 62,17,42784
v_mfma_f32_16x16x32_bf16 v[204:207], a[96:99], a[140:143], 0
RD 192,9,33792
MAA 204,100,156
RD 196,9,34848
v_mfma_f32_16x16x32_bf16 v[156:159], a[88:91], a[140:143], 0
buffer_load_dwordx4 a[144:147], v10, s[16:19], s52 offen sc1
MAA 156,92,156
RD 200,9,35904
v_mfma_f32_16x16x32_bf16 v[152:155], a[88:91], a[136:139], 0
RD 204,9,36960
MAA 152,92,152
v_mfma_f32_16x16x32_bf16 v[136:139], a[80:83], a[136:139], 0
MAA 136,84,152
buffer_load_dwordx4 a[148:151], v10, s[16:19], s52 offen offset:1024 sc1
v_mfma_f32_16x16x32_bf16 v[140:143], a[80:83], a[140:143], 0
s_add_u32 s52, s52, 131072
MAA 140,84,156
v_mfma_f32_16x16x32_bf16 v[92:95], a[72:75], a[140:143], 0
MAA 92,76,156
v_mfma_f32_16x16x32_bf16 v[88:91], a[72:75], a[136:139], 0
MAA 88,76,152
v_mfma_f32_16x16x32_bf16 v[72:75], a[64:67], a[136:139], 0
MAA 72,68,152
v_mfma_f32_16x16x32_bf16 v[76:79], a[64:67], a[140:143], 0
MAA 76,68,156
s_waitcnt vmcnt(18) lgkmcnt(0)
s_barrier
MAA 32,0,160
buffer_load_dwordx4 a[136:139], v11, s[16:19], s53 offen sc1
MAA 32,4,176
TR 64,16,50688
s_and_b32 s67, s67, 3
v_smfmac_f32_16x16x64_bf16 a[212:215], a[208:211], a[192:199], v6
TR 66,16,51200
s_lshl_b32 s67, s67, 7
v_smfmac_f32_16x16x64_bf16 a[212:215], a[208:211], a[200:207], v6
TR 68,16,59136
s_add_u32 s73, s73, s67
MAA 36,4,180
TR 70,16,59648
s_and_b32 s74, s7, 1
MAA 36,0,164
.Lpad13:
s_cbranch_execz .Lpad16
buffer_load_dwordx4 a[140:143], v11, s[16:19], s53 offen offset:1024 sc1
MAA 52,8,164
TR 72,16,50720
s_add_u32 s53, s53, 131072
MAA 52,12,180
TR 74,16,51232
s_mul_i32 s87, s74, 917504
MAA 48,12,176
TR 76,16,59168
s_lshr_b32 s75, s6, 1
MAA 48,8,160
TR 78,16,59680
s_mul_i32 s75, s75, 1818624
MAA 96,16,160
buffer_load_dwordx4 a[152:155], v11, s[16:19], s53 offen sc1
MAA 96,20,176
TR 80,16,50752
s_add_u32 s87, s87, s75
MAA 100,20,180
TR 82,16,51264
s_add_u32 s87, s87, 12582912
MAA 100,16,164
TR 84,16,59200
s_and_b32 s74, s6, 3
MAA 116,24,164
TR 86,16,59712
s_xor_b32 s75, s74, 0
MAA 116,28,180
buffer_load_dwordx4 a[156:159], v11, s[16:19], s53 offen offset:1024 sc1
MAA 112,28,176
TR 88,16,50784
s_add_u32 s53, s53, 131072
MAA 112,24,160
TR 90,16,51296
s_add_u32 m0, s55, 118272
MAA 160,32,160
TR 92,16,59232
s_sub_u32 s75, s75, 0
MAA 160,36,176
TR 94,16,59744
s_mul_i32 s98, s75, 458752
MAA 164,36,180
buffer_load_dwordx4 v12, s[32:35], s54 offen lds
MAA 164,32,164
TR 96,16,50816
s_mul_i32 s75, s75, 114688
MAA 180,40,164
TR 98,16,51328
s_add_u32 s76, s87, s75
MAA 180,44,180
TR 100,16,59264
s_xor_b32 s75, s74, 1
MAA 176,44,176
TR 102,16,59776
s_sub_u32 s75, s75, 1
MAA 176,40,160
buffer_load_dwordx4 v13, s[32:35], s54 offen offset:1056 lds
MAA 224,48,160
TR 104,16,50848
s_mul_i32 s99, s75, 458752
MAA 224,52,176
TR 106,16,51360
s_mul_i32 s75, s75, 114688
MAA 228,52,180
TR 108,16,59296
s_add_u32 s77, s87, s75
MAA 228,48,164
TR 110,16,59808
MAA 236,56,164
buffer_load_dwordx4 v14, s[32:35], s54 offen offset:2112 lds
MAA 236,60,180
TR 112,17,50688
MAA 232,60,176
TR 114,17,51200
MAA 232,56,160
TR 116,17,59136
s_waitcnt vmcnt(21)
MAA 188,40,172
TR 118,17,59648
MAA 188,44,188
buffer_load_dwordx4 v15, s[32:35], s54 offen offset:3168 lds
MAA 184,44,184
TR 120,17,50720
s_add_u32 m0, s57, 2048
MAA 184,40,168
TR 122,17,51232
s_mov_b32 s58, 29624320
MAA 168,32,168
TR 124,17,59168
MAA 168,36,184
TR 126,17,59680
MAA 172,36,188
buffer_load_dwordx4 v4, s[16:19], s58 offen sc1 lds
MAA 172,32,172
RD 192,9,50688
MAA 124,24,172
RD 196,9,51744
MAA 124,28,188
RD 200,9,52800
MAA 120,28,184
RD 204,9,53856
MAA 120,24,168
buffer_load_dwordx4 v4, s[16:19], s58 offen offset:1024 sc1 lds
MAA 104,16,168
MAA 104,20,184
MAA 108,20,188
MAA 108,16,172
MAA 60,8,172
MAA 60,12,188
MAA 56,12,184
MAA 56,8,168
MAA 40,0,168
MAA 40,4,184
MAA 44,4,188
MAA 44,0,172
s_waitcnt vmcnt(20) lgkmcnt(0)
s_barrier
MAA 64,64,160
ds_read_b64_tr_b16 a[0:1], v16
s_add_u32 m0, s55, 135168
MAA 64,68,176
buffer_load_dwordx4 v12, s[80:83], s54 offen lds
v_smfmac_f32_16x16x64_bf16 a[216:219], a[208:211], a[192:199], v6
TR 2,16,512
s_xor_b32 s75, s74, 2
v_smfmac_f32_16x16x64_bf16 a[216:219], a[208:211], a[200:207], v6
TR 4,16,8448
s_sub_u32 s75, s75, 2
MAA 68,68,180
TR 6,16,8960
s_mul_i32 s100, s75, 458752
MAA 68,64,164
TR 8,16,32
s_mul_i32 s75, s75, 114688
MAA 84,72,164
buffer_load_dwordx4 v13, s[80:83], s54 offen offset:1056 lds
MAA 84,76,180
TR 10,16,544
s_add_u32 s78, s87, s75
MAA 80,76,176
TR 12,16,8480
s_xor_b32 s75, s74, 3
MAA 80,72,160
TR 14,16,8992
s_sub_u32 s75, s75, 3
MAA 128,80,160
TR 16,16,64
s_mul_i32 s101, s75, 458752
MAA 128,84,176
buffer_load_dwordx4 v14, s[80:83], s54 offen offset:2112 lds
MAA 132,84,180
TR 18,16,576
s_mul_i32 s75, s75, 114688
MAA 132,80,164
TR 20,16,8512
s_add_u32 s79, s87, s75
MAA 148,88,164
TR 22,16,9024
s_and_b32 s87, s6, 3
MAA 148,92,180
TR 24,16,96
s_mov_b32 s46, 0
MAA 144,92,176
buffer_load_dwordx4 v15, s[80:83], s54 offen offset:3168 lds
MAA 144,88,160
TR 26,16,608
s_add_u32 s54, s54, 458752
MAA 192,96,160
TR 28,16,8544
s_add_u32 m0, s57, 4096
MAA 192,100,176
TR 30,16,9056
s_mov_b32 s58, 29626368
MAA 196,100,180
TR 32,16,128
s_lshl_b32 s74, s3, 10
MAA 196,96,164
buffer_load_dwordx4 v4, s[16:19], s58 offen sc1 lds
MAA 212,104,164
TR 34,16,640
s_lshl_b32 s75, s12, 9
MAA 212,108,180
TR 36,16,8576
s_add_u32 s74, s74, s75
MAA 208,108,176
TR 38,16,9088
s_add_u32 s74, s74, 152576
MAA 208,104,160
TR 40,16,160
v_and_b32 v18, 15, v1
MAA 240,112,160
buffer_load_dwordx4 v4, s[16:19], s58 offen offset:1024 sc1 lds
MAA 240,116,176
TR 42,16,672
v_lshl_add_u32 v18, v18, 4, s74
MAA 244,116,180
TR 44,16,8608
v_xor_b32 v19, 512, v18
MAA 244,112,164
TR 46,16,9120
MAA 252,120,164
ds_read_b64_tr_b16 a[48:49], v17
MAA 252,124,180
TR 50,17,512
MAA 248,124,176
TR 52,17,8448
MAA 248,120,160
buffer_load_dwordx4 a[160:163], v10, s[16:19], s52 offen sc1
MAA 220,104,172
TR 54,17,8960
MAA 220,108,188
TR 56,17,32
MAA 216,108,184
TR 58,17,544
MAA 216,104,168
TR 60,17,8480
MAA 200,96,168
buffer_load_dwordx4 a[164:167], v10, s[16:19], s52 offen offset:1024 sc1
MAA 200,100,184
TR 62,17,8992
s_add_u32 s52, s52, 131072
MAA 204,100,188
ds_read_b128 a[192:195], v9
MAA 204,96,172
RD 196,9,1056
MAA 156,88,172
RD 200,9,2112
MAA 156,92,188
buffer_load_dwordx4 a[176:179], v10, s[16:19], s52 offen sc1
MAA 152,92,184
RD 204,9,3168
MAA 152,88,168
MAA 136,80,168
MAA 136,84,184
MAA 140,84,188
buffer_load_dwordx4 a[180:183], v10, s[16:19], s52 offen offset:1024 sc1
MAA 140,80,172
s_add_u32 s52, s52, 131072
MAA 92,72,172
MAA 92,76,188
MAA 88,76,184
MAA 88,72,168
MAA 72,64,168
MAA 72,68,184
MAA 76,68,188
MAA 76,64,172
s_waitcnt vmcnt(20) lgkmcnt(0)
s_barrier
MAA 32,0,128
buffer_load_dwordx4 a[168:171], v11, s[16:19], s53 offen sc1
MAA 32,4,144
ds_read_b128 v[20:23], v2
v_smfmac_f32_16x16x64_bf16 a[212:215], a[208:211], a[192:199], v6
ds_read_b128 v[28:31], v2 offset:1024
v_smfmac_f32_16x16x64_bf16 a[212:215], a[208:211], a[200:207], v6
s_waitcnt vmcnt(11)
ds_read_b128 v[24:27], v2 offset:2048
MAA 36,4,148
TR 64,16,16896
MAA 36,0,132
buffer_load_dwordx4 a[172:175], v11, s[16:19], s53 offen offset:1024 sc1
MAA 52,8,132
TR 66,16,17408
s_add_u32 s53, s53, 131072
MAA 52,12,148
TR 68,16,25344
MAA 48,12,144
TR 70,16,25856
MAA 48,8,128
TR 72,16,16928
MAA 96,16,128
buffer_load_dwordx4 a[184:187], v11, s[16:19], s53 offen sc1
MAA 96,20,144
TR 74,16,17440
s_waitcnt lgkmcnt(7)
v_add_f32 v20, v20, v28
MAA 100,20,148
TR 76,16,25376
v_add_f32 v21, v21, v29
MAA 100,16,132
TR 78,16,25888
v_add_f32 v22, v22, v30
MAA 116,24,132
TR 80,16,16960
v_add_f32 v23, v23, v31
MAA 116,28,148
buffer_load_dwordx4 a[188:191], v11, s[16:19], s53 offen offset:1024 sc1
MAA 112,28,144
ds_read_b128 v[28:31], v2 offset:3072
s_add_u32 s53, s53, 131072
MAA 112,24,128
TR 82,16,17472
s_add_u32 m0, s55, 84480
MAA 160,32,128
TR 84,16,25408
s_waitcnt lgkmcnt(12)
v_add_f32 v20, v20, v24
MAA 160,36,144
TR 86,16,25920
v_add_f32 v21, v21, v25
MAA 164,36,148
buffer_load_dwordx4 v12, s[32:35], s54 offen lds
MAA 164,32,132
TR 88,16,16992
v_add_f32 v22, v22, v26
MAA 180,40,132
TR 90,16,17504
v_add_f32 v23, v23, v27
MAA 180,44,148
TR 92,16,25440
MAA 176,44,144
TR 94,16,25952
MAA 176,40,128
buffer_load_dwordx4 v13, s[32:35], s54 offen offset:1056 lds
MAA 224,48,128
TR 96,16,17024
MAA 224,52,144
TR 98,16,17536
MAA 228,52,148
TR 100,16,25472
MAA 228,48,132
TR 102,16,25984
MAA 236,56,132
buffer_load_dwordx4 v14, s[32:35], s54 offen offset:2112 lds
MAA 236,60,148
TR 104,16,17056
MAA 232,60,144
TR 106,16,17568
MAA 232,56,128
TR 108,16,25504
MAA 188,40,140
TR 110,16,26016
MAA 188,44,156
buffer_load_dwordx4 v15, s[32:35], s54 offen offset:3168 lds
MAA 184,44,152
TR 112,17,16896
s_add_u32 m0, s57, 6144
MAA 184,40,136
TR 114,17,17408
s_mov_b32 s58, 29628416
MAA 168,32,136
TR 116,17,25344
MAA 168,36,152
TR 118,17,25856
MAA 172,36,156
buffer_load_dwordx4 v4, s[16:19], s58 offen sc1 lds
MAA 172,32,140
TR 120,17,16928
MAA 124,24,140
TR 122,17,17440
MAA 124,28,156
TR 124,17,25376
MAA 120,28,152
TR 126,17,25888
MAA 120,24,136
buffer_load_dwordx4 v4, s[16:19], s58 offen offset:1024 sc1 lds
MAA 104,16,136
RD 192,9,16896
MAA 104,20,152
RD 196,9,17952
MAA 108,20,156
RD 200,9,19008
MAA 108,16,140
RD 204,9,20064
MAA 60,8,140
MAA 60,12,156
MAA 56,12,152
MAA 56,8,136
MAA 40,0,136
MAA 40,4,152
MAA 44,4,156
s_sub_u32 s47, s47, 1
s_cbranch_scc1 .Lx39
.Lx39b:
MAA 44,0,140
s_waitcnt lgkmcnt(0)
s_barrier
MAA 64,64,128
s_waitcnt vmcnt(14)
ds_read_b128 v[24:27], v2 offset:4096
s_add_u32 m0, s55, 101376
MAA 64,68,144
buffer_load_dwordx4 v12, s[80:83], s54 offen lds
v_smfmac_f32_16x16x64_bf16 a[216:219], a[208:211], a[192:199], v6
TR 0,16,33792
v_add_f32 v20, v20, v28
v_smfmac_f32_16x16x64_bf16 a[216:219], a[208:211], a[200:207], v6
TR 2,16,34304
v_add_f32 v21, v21, v29
MAA 68,68,148
TR 4,16,42240
v_add_f32 v22, v22, v30
MAA 68,64,132
TR 6,16,42752
v_add_f32 v23, v23, v31
MAA 84,72,132
ds_read_b128 v[28:31], v2 offset:5120
MAA 84,76,148
TR 8,16,33824
MAA 80,76,144
buffer_load_dwordx4 v13, s[80:83], s54 offen offset:1056 lds
MAA 80,72,128
TR 10,16,34336
s_waitcnt lgkmcnt(7)
v_add_f32 v20, v20, v24
MAA 128,80,128
TR 12,16,42272
v_add_f32 v21, v21, v25
MAA 128,84,144
TR 14,16,42784
v_add_f32 v22, v22, v26
MAA 132,84,148
TR 16,16,33856
v_add_f32 v23, v23, v27
MAA 132,80,132
TR 18,16,34368
MAA 148,88,132
TR 20,16,42304
MAA 148,92,148
buffer_load_dwordx4 v14, s[80:83], s54 offen offset:2112 lds
MAA 144,92,144
TR 22,16,42816
MAA 144,88,128
TR 24,16,33888
MAA 192,96,128
TR 26,16,34400
MAA 192,100,144
TR 28,16,42336
MAA 196,100,148
TR 30,16,42848
MAA 196,96,132
TR 32,16,33920
MAA 212,104,132
buffer_load_dwordx4 v15, s[80:83], s54 offen offset:3168 lds
MAA 212,108,148
TR 34,16,34432
s_add_u32 s54, s54, 458752
MAA 208,108,144
TR 36,16,42368
MAA 208,104,128
TR 38,16,42880
MAA 240,112,128
TR 40,16,33952
MAA 240,116,144
TR 42,16,34464
MAA 244,116,148
TR 44,16,42400
MAA 244,112,132
TR 46,16,42912
MAA 252,120,132
TR 48,17,33792
MAA 252,124,148
TR 50,17,34304
MAA 248,124,144
TR 52,17,42240
MAA 248,120,128
buffer_load_dwordx4 a[128:131], v10, s[16:19], s52 offen sc1
MAA 220,104,140
TR 54,17,42752
MAA 220,108,156
TR 56,17,33824
MAA 216,108,152
TR 58,17,34336
MAA 216,104,136
TR 60,17,42272
MAA 200,96,136
TR 62,17,42784
MAA 200,100,152
RD 192,9,33792
MAA 204,100,156
buffer_load_dwordx4 a[132:135], v10, s[16:19], s52 offen offset:1024 sc1
MAA 204,96,140
RD 196,9,34848
s_add_u32 s52, s52, 131072
MAA 156,88,140
RD 200,9,35904
MAA 156,92,156
RD 204,9,36960
MAA 152,92,152
MAA 152,88,136
MAA 136,80,136
MAA 136,84,152
buffer_load_dwordx4 a[144:147], v10, s[16:19], s52 offen sc1
MAA 140,84,156
MAA 140,80,140
MAA 92,72,140
MAA 92,76,156
MAA 88,76,152
MAA 88,72,136
MAA 72,64,136
buffer_load_dwordx4 a[148:151], v10, s[16:19], s52 offen offset:1024 sc1
MAA 72,68,152
s_add_u32 s52, s52, 131072
MAA 76,68,156
s_sub_u32 s47, s47, 1
s_cbranch_scc1 .Lx40
.Lx40b:
MAA 76,64,140
s_waitcnt vmcnt(18) lgkmcnt(0)
s_barrier
MAA 32,0,160
buffer_load_dwordx4 a[136:139], v11, s[16:19], s53 offen sc1
MAA 32,4,176
s_waitcnt vmcnt(9)
ds_read_b128 v[24:27], v2 offset:6144
v_add_f32 v20, v20, v28
v_smfmac_f32_16x16x64_bf16 a[212:215], a[208:211], a[192:199], v6
TR 64,16,50688
v_add_f32 v21, v21, v29
v_smfmac_f32_16x16x64_bf16 a[212:215], a[208:211], a[200:207], v6
TR 66,16,51200
v_add_f32 v22, v22, v30
MAA 36,4,180
TR 68,16,59136
v_add_f32 v23, v23, v31
MAA 36,0,164
ds_read_b128 v[28:31], v2 offset:7168
MAA 52,8,164
TR 70,16,59648
MAA 52,12,180
buffer_load_dwordx4 a[140:143], v11, s[16:19], s53 offen offset:1024 sc1
MAA 48,12,176
TR 72,16,50720
s_add_u32 s53, s53, 131072
MAA 48,8,160
TR 74,16,51232
s_waitcnt lgkmcnt(7)
v_add_f32 v20, v20, v24
MAA 96,16,160
TR 76,16,59168
v_add_f32 v21, v21, v25
MAA 96,20,176
TR 78,16,59680
v_add_f32 v22, v22, v26
MAA 100,20,180
TR 80,16,50752
v_add_f32 v23, v23, v27
MAA 100,16,164
TR 82,16,51264
s_waitcnt lgkmcnt(7)
v_add_f32 v20, v20, v28
MAA 116,24,164
buffer_load_dwordx4 a[152:155], v11, s[16:19], s53 offen sc1
MAA 116,28,180
TR 84,16,59200
v_add_f32 v21, v21, v29
MAA 112,28,176
TR 86,16,59712
.Lpad14:
s_cbranch_execz .Lnopoll34r
v_add_f32 v22, v22, v30
MAA 112,24,160
TR 88,16,50784
v_add_f32 v23, v23, v31
MAA 160,32,160
TR 90,16,51296
MAA 160,36,176
TR 92,16,59232
MAA 164,36,180
TR 94,16,59744
MAA 164,32,164
buffer_load_dwordx4 a[156:159], v11, s[16:19], s53 offen offset:1024 sc1
MAA 180,40,164
TR 96,16,50816
s_add_u32 s53, s53, 131072
MAA 180,44,180
TR 98,16,51328
s_add_u32 m0, s55, 118272
MAA 176,44,176
TR 100,16,59264
MAA 176,40,160
TR 102,16,59776
MAA 224,48,160
TR 104,16,50848
MAA 224,52,176
TR 106,16,51360
MAA 228,52,180
buffer_load_dwordx4 v12, s[32:35], s54 offen lds
MAA 228,48,164
TR 108,16,59296
MAA 236,56,164
TR 110,16,59808
MAA 236,60,180
TR 112,17,50688
MAA 232,60,176
TR 114,17,51200
MAA 232,56,160
TR 116,17,59136
MAA 188,40,172
TR 118,17,59648
MAA 188,44,188
buffer_load_dwordx4 v13, s[32:35], s54 offen offset:1056 lds
MAA 184,44,184
TR 120,17,50720
MAA 184,40,168
TR 122,17,51232
MAA 168,32,168
TR 124,17,59168
MAA 168,36,184
TR 126,17,59680
MAA 172,36,188
RD 192,9,50688
MAA 172,32,172
RD 196,9,51744
MAA 124,24,172
buffer_load_dwordx4 v14, s[32:35], s54 offen offset:2112 lds
MAA 124,28,188
RD 200,9,52800
MAA 120,28,184
RD 204,9,53856
MAA 120,24,168
MAA 104,16,168
MAA 104,20,184
MAA 108,20,188
MAA 108,16,172
buffer_load_dwordx4 v15, s[32:35], s54 offen offset:3168 lds
MAA 60,8,172
MAA 60,12,188
MAA 56,12,184
MAA 56,8,168
MAA 40,0,168
MAA 40,4,184
MAA 44,4,188
s_sub_u32 s47, s47, 1
s_cbranch_scc1 .Lx41
.Lx41b:
MAA 44,0,172
s_waitcnt lgkmcnt(0)
s_barrier
MAA 64,64,160
ds_read_b64_tr_b16 a[0:1], v16
s_add_u32 m0, s55, 135168
MAA 64,68,176
buffer_load_dwordx4 v12, s[80:83], s54 offen lds
v_smfmac_f32_16x16x64_bf16 a[216:219], a[208:211], a[192:199], v6
TR 2,16,512
v_permlane32_swap_b32 v20, v22
v_smfmac_f32_16x16x64_bf16 a[216:219], a[208:211], a[200:207], v6
TR 4,16,8448
v_permlane32_swap_b32 v21, v23
MAA 68,68,180
TR 6,16,8960
v_add_f32 v20, v20, v22
MAA 68,64,164
TR 8,16,32
v_add_f32 v21, v21, v23
MAA 84,72,164
TR 10,16,544
v_mul_f32 v20, 0xba800000, v20
MAA 84,76,180
buffer_load_dwordx4 v13, s[80:83], s54 offen offset:1056 lds
MAA 80,76,176
TR 12,16,8480
v_mul_f32 v21, 0x3a800000, v21
MAA 80,72,160
TR 14,16,8992
v_fma_f32 v21, -v20, v20, v21
MAA 128,80,160
TR 16,16,64
v_max_f32 v21, 0, v21
MAA 128,84,176
TR 18,16,576
v_add_f32 v21, 0x3727c5ac, v21
MAA 132,84,180
TR 20,16,8512
v_rsq_f32 v22, v21
MAA 132,80,164
TR 22,16,9024
v_and_b32 v24, 31, v1
MAA 148,88,164
buffer_load_dwordx4 v14, s[80:83], s54 offen offset:2112 lds
MAA 148,92,180
TR 24,16,96
v_lshrrev_b32 v25, 5, v1
MAA 144,92,176
TR 26,16,608
v_lshl_add_u32 v24, v24, 1, v25
MAA 144,88,160
TR 28,16,8544
v_and_b32 v25, 0xc0, v0
MAA 192,96,160
TR 30,16,9056
v_add_u32 v24, v24, v25
MAA 192,100,176
TR 32,16,128
v_lshlrev_b32 v24, 4, v24
MAA 196,100,180
TR 34,16,640
v_add_u32 v24, 152576, v24
MAA 196,96,164
buffer_load_dwordx4 v15, s[80:83], s54 offen offset:3168 lds
MAA 212,104,164
TR 36,16,8576
s_add_u32 s54, s54, 458752
MAA 212,108,180
TR 38,16,9088
v_mul_f32 v22, 0xbfb8aa3b, v22
MAA 208,108,176
ds_write_b128 v24, v[20:23]
s_mov_b32 s58, s98
MAA 208,104,160
ds_read_b64 v[20:21], v18
s_mov_b32 s67, s59
MAA 240,112,160
ds_read_b64 v[22:23], v18 offset:256
MAA 240,116,176
ds_read_b64 v[24:25], v19
MAA 244,116,180
ds_read_b64 v[26:27], v19 offset:256
MAA 244,112,164
ds_read_b32 v28, v18 offset:8
MAA 252,120,164
ds_read_b32 v29, v18 offset:264
v_mov_b32 v18, v5
MAA 252,124,180
ds_read_b32 v30, v19 offset:8
MAA 248,124,176
ds_read_b32 v31, v19 offset:264
v_add_u32 v19, 992, v5
MAA 248,120,160
buffer_load_dwordx4 a[160:163], v10, s[16:19], s52 offen sc1
MAA 220,104,172
TR 40,16,160
MAA 220,108,188
TR 42,16,672
MAA 216,108,184
TR 44,16,8608
MAA 216,104,168
TR 46,16,9120
MAA 200,96,168
ds_read_b64_tr_b16 a[48:49], v17
MAA 200,100,184
TR 50,17,512
MAA 204,100,188
buffer_load_dwordx4 a[164:167], v10, s[16:19], s52 offen offset:1024 sc1
MAA 204,96,172
TR 52,17,8448
s_add_u32 s52, s52, 131072
MAA 156,88,172
TR 54,17,8960
MAA 156,92,188
TR 56,17,32
MAA 152,92,184
TR 58,17,544
MAA 152,88,168
TR 60,17,8480
MAA 136,80,168
TR 62,17,8992
MAA 136,84,184
buffer_load_dwordx4 a[176:179], v10, s[16:19], s52 offen sc1
MAA 140,84,188
ds_read_b128 a[192:195], v9
MAA 140,80,172
RD 196,9,1056
MAA 92,72,172
RD 200,9,2112
MAA 92,76,188
RD 204,9,3168
MAA 88,76,184
MAA 88,72,168
MAA 72,64,168
buffer_load_dwordx4 a[180:183], v10, s[16:19], s52 offen offset:1024 sc1
MAA 72,68,184
s_add_u32 s52, s52, 131072
MAA 76,68,188
s_sub_u32 s47, s47, 1
s_cbranch_scc1 .Lx42
.Lx42b:
MAA 76,64,172
s_mov_b32 s15, -5
.p2align 6
.Lk43:
s_waitcnt vmcnt(16) lgkmcnt(0)
s_barrier
MAA 32,0,128
TR 64,16,16896
MAA 32,4,144
buffer_load_dwordx4 a[168:171], v11, s[16:19], s53 offen sc1
v_smfmac_f32_16x16x64_bf16 a[212:215], a[208:211], a[192:199], v6
s_sub_u32 s47, s47, 1
s_cbranch_scc1 .Lx44
.Lx44b:
v_smfmac_f32_16x16x64_bf16 a[212:215], a[208:211], a[200:207], v6
TR 66,16,17408
MAA 36,4,148
TR 68,16,25344
MAA 36,0,132
TR 70,16,25856
MAA 52,8,132
TR 72,16,16928
MAA 52,12,148
buffer_load_dwordx4 a[172:175], v11, s[16:19], s53 offen offset:1024 sc1
MAA 48,12,144
TR 74,16,17440
s_add_u32 s53, s53, 131072
MAA 48,8,128
MAA 96,16,128
TR 76,16,25376
MAA 96,20,144
TR 78,16,25888
MAA 100,20,148
TR 80,16,16960
MAA 100,16,132
buffer_load_dwordx4 a[184:187], v11, s[16:19], s53 offen sc1
MAA 116,24,132
TR 82,16,17472
MAA 116,28,148
TR 84,16,25408
MAA 112,28,144
MAA 112,24,128
TR 86,16,25920
MAA 160,32,128
TR 88,16,16992
MAA 160,36,144
buffer_load_dwordx4 a[188:191], v11, s[16:19], s53 offen offset:1024 sc1
MAA 164,36,148
TR 90,16,17504
s_add_u32 s53, s53, 131072
MAA 164,32,132
TR 92,16,25440
MAA 180,40,132
TR 94,16,25952
MAA 180,44,148
MAA 176,44,144
TR 96,16,17024
s_add_u32 m0, s55, 84480
MAA 176,40,128
buffer_load_dwordx4 v12, s[32:35], s54 offen lds
MAA 224,48,128
TR 98,16,17536
MAA 224,52,144
TR 100,16,25472
MAA 228,52,148
TR 102,16,25984
MAA 228,48,132
TR 104,16,17056
MAA 236,56,132
MAA 236,60,148
TR 106,16,17568
MAA 232,60,144
TR 108,16,25504
MAA 232,56,128
TR 110,16,26016
s_waitcnt vmcnt(17)
MAA 188,40,140
TR 112,17,16896
MAA 188,44,156
buffer_load_dwordx4 v13, s[32:35], s54 offen offset:1056 lds
MAA 184,44,152
TR 114,17,17408
MAA 184,40,136
MAA 168,32,136
TR 116,17,25344
MAA 168,36,152
buffer_load_dwordx4 v14, s[32:35], s54 offen offset:2112 lds
MAA 172,36,156
TR 118,17,25856
MAA 172,32,140
TR 120,17,16928
MAA 124,24,140
TR 122,17,17440
MAA 124,28,156
TR 124,17,25376
MAA 120,28,152
MAA 120,24,136
buffer_load_dwordx4 v15, s[32:35], s54 offen offset:3168 lds
MAA 104,16,136
TR 126,17,25888
MAA 104,20,152
RD 192,9,16896
MAA 108,20,156
RD 196,9,17952
MAA 108,16,140
RD 200,9,19008
MAA 60,8,140
RD 204,9,20064
s_mov_b32 m0, s67
MAA 60,12,156
buffer_load_dwordx4 v18, s[28:31], s58 offen lds
MAA 56,12,152
MAA 56,8,136
MAA 40,0,136
MAA 40,4,152
MAA 44,4,156
MAA 44,0,140
s_waitcnt vmcnt(17) lgkmcnt(0)
s_barrier
MAA 64,64,128
TR 0,16,33792
s_add_u32 m0, s55, 101376
MAA 64,68,144
buffer_load_dwordx4 v12, s[80:83], s54 offen lds
v_smfmac_f32_16x16x64_bf16 a[216:219], a[208:211], a[192:199], v6
s_sub_u32 s47, s47, 1
s_cbranch_scc1 .Lx45
.Lx45b:
v_smfmac_f32_16x16x64_bf16 a[216:219], a[208:211], a[200:207], v6
TR 2,16,34304
MAA 68,68,148
TR 4,16,42240
MAA 68,64,132
TR 6,16,42752
MAA 84,72,132
TR 8,16,33824
MAA 84,76,148
buffer_load_dwordx4 v13, s[80:83], s54 offen offset:1056 lds
MAA 80,76,144
TR 10,16,34336
MAA 80,72,128
MAA 128,80,128
TR 12,16,42272
MAA 128,84,144
TR 14,16,42784
MAA 132,84,148
TR 16,16,33856
MAA 132,80,132
buffer_load_dwordx4 v14, s[80:83], s54 offen offset:2112 lds
MAA 148,88,132
TR 18,16,34368
MAA 148,92,148
TR 20,16,42304
MAA 144,92,144
TR 22,16,42816
MAA 144,88,128
MAA 192,96,128
TR 24,16,33888
MAA 192,100,144
buffer_load_dwordx4 v15, s[80:83], s54 offen offset:3168 lds
MAA 196,100,148
TR 26,16,34400
s_add_u32 s54, s54, 458752
MAA 196,96,132
TR 28,16,42336
MAA 212,104,132
TR 30,16,42848
MAA 212,108,148
TR 32,16,33920
MAA 208,108,144
TR 34,16,34432
s_mov_b32 m0, s67
MAA 208,104,128
buffer_load_dwordx4 v19, s[28:31], s58 offen offset:1056 lds
MAA 240,112,128
s_add_u32 s67, s67, 8448
s_add_u32 s58, s58, 0x40000
MAA 240,116,144
MAA 244,116,148
TR 36,16,42368
MAA 244,112,132
TR 38,16,42880
MAA 252,120,132
TR 40,16,33952
MAA 252,124,148
TR 42,16,34464
MAA 248,124,144
TR 44,16,42400
MAA 248,120,128
buffer_load_dwordx4 a[128:131], v10, s[16:19], s52 offen sc1
MAA 220,104,140
TR 46,16,42912
MAA 220,108,156
MAA 216,108,152
TR 48,17,33792
MAA 216,104,136
TR 50,17,34304
MAA 200,96,136
TR 52,17,42240
MAA 200,100,152
buffer_load_dwordx4 a[132:135], v10, s[16:19], s52 offen offset:1024 sc1
MAA 204,100,156
TR 54,17,42752
s_add_u32 s52, s52, 131072
MAA 204,96,140
TR 56,17,33824
MAA 156,88,140
TR 58,17,34336
MAA 156,92,156
MAA 152,92,152
TR 60,17,42272
MAA 152,88,136
buffer_load_dwordx4 a[144:147], v10, s[16:19], s52 offen sc1
MAA 136,80,136
TR 62,17,42784
MAA 136,84,152
RD 192,9,33792
MAA 140,84,156
RD 196,9,34848
MAA 140,80,140
RD 200,9,35904
MAA 92,72,140
RD 204,9,36960
MAA 92,76,156
buffer_load_dwordx4 a[148:151], v10, s[16:19], s52 offen offset:1024 sc1
MAA 88,76,152
s_add_u32 s52, s52, 131072
MAA 88,72,136
MAA 72,64,136
MAA 72,68,152
MAA 76,68,156
MAA 76,64,140
s_waitcnt vmcnt(18) lgkmcnt(0)
s_barrier
MAA 32,0,160
TR 64,16,50688
MAA 32,4,176
buffer_load_dwordx4 a[136:139], v11, s[16:19], s53 offen sc1
v_smfmac_f32_16x16x64_bf16 a[212:215], a[208:211], a[192:199], v6
s_sub_u32 s47, s47, 1
s_cbranch_scc1 .Lx46
.Lx46b:
v_smfmac_f32_16x16x64_bf16 a[212:215], a[208:211], a[200:207], v6
TR 66,16,51200
MAA 36,4,180
TR 68,16,59136
MAA 36,0,164
TR 70,16,59648
MAA 52,8,164
TR 72,16,50720
MAA 52,12,180
buffer_load_dwordx4 a[140:143], v11, s[16:19], s53 offen offset:1024 sc1
MAA 48,12,176
TR 74,16,51232
s_add_u32 s53, s53, 131072
MAA 48,8,160
MAA 96,16,160
TR 76,16,59168
MAA 96,20,176
TR 78,16,59680
MAA 100,20,180
TR 80,16,50752
MAA 100,16,164
buffer_load_dwordx4 a[152:155], v11, s[16:19], s53 offen sc1
MAA 116,24,164
TR 82,16,51264
MAA 116,28,180
TR 84,16,59200
MAA 112,28,176
MAA 112,24,160
TR 86,16,59712
MAA 160,32,160
TR 88,16,50784
MAA 160,36,176
buffer_load_dwordx4 a[156:159], v11, s[16:19], s53 offen offset:1024 sc1
MAA 164,36,180
TR 90,16,51296
s_add_u32 s53, s53, 131072
MAA 164,32,164
TR 92,16,59232
MAA 180,40,164
TR 94,16,59744
MAA 180,44,180
MAA 176,44,176
TR 96,16,50816
s_add_u32 m0, s55, 118272
MAA 176,40,160
buffer_load_dwordx4 v12, s[32:35], s54 offen lds
MAA 224,48,160
TR 98,16,51328
MAA 224,52,176
TR 100,16,59264
MAA 228,52,180
TR 102,16,59776
MAA 228,48,164
TR 104,16,50848
MAA 236,56,164
MAA 236,60,180
TR 106,16,51360
MAA 232,60,176
TR 108,16,59296
MAA 232,56,160
TR 110,16,59808
s_waitcnt vmcnt(19)
MAA 188,40,172
TR 112,17,50688
MAA 188,44,188
buffer_load_dwordx4 v13, s[32:35], s54 offen offset:1056 lds
MAA 184,44,184
TR 114,17,51200
MAA 184,40,168
MAA 168,32,168
TR 116,17,59136
MAA 168,36,184
buffer_load_dwordx4 v14, s[32:35], s54 offen offset:2112 lds
MAA 172,36,188
TR 118,17,59648
MAA 172,32,172
TR 120,17,50720
.Lpad15:
s_cbranch_execz .Lnopoll34r
MAA 124,24,172
TR 122,17,51232
MAA 124,28,188
TR 124,17,59168
MAA 120,28,184
MAA 120,24,168
buffer_load_dwordx4 v15, s[32:35], s54 offen offset:3168 lds
MAA 104,16,168
TR 126,17,59680
MAA 104,20,184
RD 192,9,50688
MAA 108,20,188
RD 196,9,51744
MAA 108,16,172
RD 200,9,52800
MAA 60,8,172
RD 204,9,53856
s_mov_b32 m0, s67
MAA 60,12,188
buffer_load_dwordx4 v18, s[28:31], s58 offen lds
MAA 56,12,184
MAA 56,8,168
MAA 40,0,168
MAA 40,4,184
MAA 44,4,188
MAA 44,0,172
s_waitcnt vmcnt(19) lgkmcnt(0)
s_barrier
MAA 64,64,160
ds_read_b64_tr_b16 a[0:1], v16
s_add_u32 m0, s55, 135168
MAA 64,68,176
buffer_load_dwordx4 v12, s[80:83], s54 offen lds
v_smfmac_f32_16x16x64_bf16 a[216:219], a[208:211], a[192:199], v6
s_sub_u32 s47, s47, 1
s_cbranch_scc1 .Lx47
.Lx47b:
v_smfmac_f32_16x16x64_bf16 a[216:219], a[208:211], a[200:207], v6
TR 2,16,512
MAA 68,68,180
TR 4,16,8448
MAA 68,64,164
TR 6,16,8960
MAA 84,72,164
TR 8,16,32
MAA 84,76,180
buffer_load_dwordx4 v13, s[80:83], s54 offen offset:1056 lds
MAA 80,76,176
TR 10,16,544
MAA 80,72,160
MAA 128,80,160
TR 12,16,8480
MAA 128,84,176
TR 14,16,8992
MAA 132,84,180
TR 16,16,64
MAA 132,80,164
buffer_load_dwordx4 v14, s[80:83], s54 offen offset:2112 lds
MAA 148,88,164
TR 18,16,576
MAA 148,92,180
TR 20,16,8512
MAA 144,92,176
TR 22,16,9024
MAA 144,88,160
MAA 192,96,160
TR 24,16,96
MAA 192,100,176
buffer_load_dwordx4 v15, s[80:83], s54 offen offset:3168 lds
MAA 196,100,180
TR 26,16,608
s_add_u32 s54, s54, 458752
MAA 196,96,164
TR 28,16,8544
MAA 212,104,164
TR 30,16,9056
MAA 212,108,180
TR 32,16,128
MAA 208,108,176
TR 34,16,640
s_mov_b32 m0, s67
MAA 208,104,160
buffer_load_dwordx4 v19, s[28:31], s58 offen offset:1056 lds
MAA 240,112,160
s_add_u32 s67, s67, 8448
s_add_u32 s46, s46, 1
s_xor_b32 s58, s46, s87
s_mul_i32 s58, s58, 458752
MAA 240,116,176
MAA 244,116,180
TR 36,16,8576
MAA 244,112,164
TR 38,16,9088
MAA 252,120,164
TR 40,16,160
MAA 252,124,180
TR 42,16,672
MAA 248,124,176
TR 44,16,8608
MAA 248,120,160
buffer_load_dwordx4 a[160:163], v10, s[16:19], s52 offen sc1
MAA 220,104,172
TR 46,16,9120
MAA 220,108,188
MAA 216,108,184
ds_read_b64_tr_b16 a[48:49], v17
MAA 216,104,168
TR 50,17,512
MAA 200,96,168
TR 52,17,8448
MAA 200,100,184
buffer_load_dwordx4 a[164:167], v10, s[16:19], s52 offen offset:1024 sc1
MAA 204,100,188
TR 54,17,8960
s_add_u32 s52, s52, 131072
MAA 204,96,172
TR 56,17,32
MAA 156,88,172
TR 58,17,544
MAA 156,92,188
MAA 152,92,184
TR 60,17,8480
MAA 152,88,168
buffer_load_dwordx4 a[176:179], v10, s[16:19], s52 offen sc1
MAA 136,80,168
TR 62,17,8992
MAA 136,84,184
ds_read_b128 a[192:195], v9
MAA 140,84,188
RD 196,9,1056
MAA 140,80,172
RD 200,9,2112
MAA 92,72,172
RD 204,9,3168
MAA 92,76,188
buffer_load_dwordx4 a[180:183], v10, s[16:19], s52 offen offset:1024 sc1
MAA 88,76,184
s_add_u32 s52, s52, 131072
MAA 88,72,168
MAA 72,64,168
MAA 72,68,184
MAA 76,68,188
s_add_u32 s15, s15, 1
MAA 76,64,172
s_cbranch_scc0 .Lk43
s_branch .Lj48
.Lx39:
buffer_load_dword a220, v8, s[40:43], s45 offen
buffer_load_dword a220, v7, s[28:31], s44 offen
s_add_u32 s44, s44, 655360
s_add_u32 s45, s45, 917504
s_mov_b32 s47, 3
s_branch .Lx39b
.Lx40:
buffer_load_dword a220, v8, s[40:43], s45 offen
buffer_load_dword a220, v7, s[28:31], s44 offen
s_add_u32 s44, s44, 655360
s_add_u32 s45, s45, 917504
s_mov_b32 s47, 3
s_branch .Lx40b
.Lx41:
buffer_load_dword a220, v8, s[40:43], s45 offen
buffer_load_dword a220, v7, s[28:31], s44 offen
s_add_u32 s44, s44, 655360
s_add_u32 s45, s45, 917504
s_mov_b32 s47, 3
s_branch .Lx41b
.Lx42:
buffer_load_dword a220, v8, s[40:43], s45 offen
buffer_load_dword a220, v7, s[28:31], s44 offen
s_add_u32 s44, s44, 655360
s_add_u32 s45, s45, 917504
s_mov_b32 s47, 3
s_branch .Lx42b
.Lx44:
buffer_load_dword a220, v8, s[40:43], s45 offen
buffer_load_dword a220, v7, s[28:31], s44 offen
s_add_u32 s44, s44, 655360
s_add_u32 s45, s45, 917504
s_mov_b32 s47, 3
s_branch .Lx44b
.Lx45:
buffer_load_dword a220, v8, s[40:43], s45 offen
buffer_load_dword a220, v7, s[28:31], s44 offen
s_add_u32 s44, s44, 655360
s_add_u32 s45, s45, 917504
s_mov_b32 s47, 3
s_branch .Lx45b
.Lx46:
buffer_load_dword a220, v8, s[40:43], s45 offen
buffer_load_dword a220, v7, s[28:31], s44 offen
s_add_u32 s44, s44, 655360
s_add_u32 s45, s45, 917504
s_mov_b32 s47, 3
s_branch .Lx46b
.Lx47:
buffer_load_dword a220, v8, s[40:43], s45 offen
buffer_load_dword a220, v7, s[28:31], s44 offen
s_add_u32 s44, s44, 655360
s_add_u32 s45, s45, 917504
s_mov_b32 s47, 3
s_branch .Lx47b
.Lj48:
s_waitcnt vmcnt(10) lgkmcnt(0)
s_barrier
v_smfmac_f32_16x16x64_bf16 a[212:215], a[208:211], a[192:199], v6
RD 112,9,16896
s_lshl_b32 s74, s3, 10
v_smfmac_f32_16x16x64_bf16 a[212:215], a[208:211], a[200:207], v6
RD 116,9,17952
s_add_u32 s74, s74, 152576
MAA 32,0,128
RD 120,9,19008
s_sub_u32 s75, 156672, s74
MAA 32,4,144
RD 124,9,20064
v_and_b32 v7, 15, v1
MAA 48,12,144
RD 192,9,33792
v_lshl_add_u32 v7, v7, 5, s74
MAA 48,8,128
RD 196,9,34848
v_bfe_u32 v2, v1, 4, 1
MAA 36,0,132
RD 200,9,35904
v_lshl_add_u32 v7, v2, 4, v7
MAA 36,4,148
RD 204,9,36960
v_bfe_u32 v2, v1, 5, 1
MAA 52,12,148
buffer_load_dwordx4 a[168:171], v11, s[16:19], s53 offen sc1
MAA 52,8,132
TR 64,16,16896
v_mul_u32_u24 v2, s75, v2
s_waitcnt lgkmcnt(7)
v_smfmac_f32_16x16x64_bf16 a[216:219], a[208:211], a[112:119], v6
TR 66,16,17408
v_add_u32 v7, v7, v2
MAA 40,0,136
TR 68,16,25344
v_lshlrev_b32 v2, 4, v1
s_waitcnt lgkmcnt(7)
v_smfmac_f32_16x16x64_bf16 a[216:219], a[208:211], a[120:127], v6
buffer_load_dwordx4 a[172:175], v11, s[16:19], s53 offen offset:1024 sc1
MAA 40,4,152
TR 70,16,25856
s_add_u32 s53, s53, 131072
s_waitcnt lgkmcnt(6)
v_smfmac_f32_16x16x64_bf16 a[212:215], a[208:211], a[192:199], v6
TR 72,16,16928
v_add_u32 v2, 152576, v2
MAA 56,12,152
TR 74,16,17440
s_lshl_b32 s74, s12, 7
s_waitcnt lgkmcnt(6)
v_smfmac_f32_16x16x64_bf16 a[212:215], a[208:211], a[200:207], v6
buffer_load_dwordx4 a[184:187], v11, s[16:19], s53 offen sc1
MAA 56,8,136
TR 76,16,25376
s_add_u32 s74, s74, 161536
MAA 44,0,140
TR 78,16,25888
s_waitcnt vmcnt(8)
s_barrier
MAA 44,4,156
RD 112,9,50688
s_xor_b32 s75, s12, 1
MAA 60,12,156
RD 116,9,51744
s_mul_i32 s75, s75, 384
MAA 60,8,140
RD 120,9,52800
s_add_u32 s75, s75, 161536
MAA 96,16,128
RD 124,9,53856
v_lshrrev_b32 v9, 4, v1
MAA 96,20,144
ds_write_b128 v7, a[212:215]
v_lshlrev_b32 v9, 4, v9
MAA 112,28,144
buffer_load_dwordx4 a[188:191], v11, s[16:19], s53 offen offset:1024 sc1
MAA 112,24,128
TR 80,16,33792
s_add_u32 s53, s53, 131072
MAA 100,16,132
TR 82,16,34304
v_add_u32 v8, s75, v9
MAA 100,20,148
TR 84,16,42240
v_add_u32 v9, s74, v9
MAA 116,28,148
TR 86,16,42752
s_add_u32 s58, s99, 2293760
s_waitcnt lgkmcnt(7)
v_smfmac_f32_16x16x64_bf16 a[216:219], a[208:211], a[112:119], v6
TR 88,16,33824
s_lshl_b32 s74, s3, 11
MAA 116,24,132
TR 90,16,34336
s_add_u32 s74, s74, s84
s_waitcnt lgkmcnt(7)
v_smfmac_f32_16x16x64_bf16 a[216:219], a[208:211], a[120:127], v6
TR 92,16,42272
s_add_u32 s54, s98, 65536
MAA 104,16,136
TR 94,16,42784
s_mul_i32 s55, s3, 2112
MAA 104,20,152
TR 96,16,50688
s_mov_b32 s57, 67584
MAA 120,28,152
ds_write_b128 v7, a[216:219] offset:512
MAA 120,24,136
TR 98,16,51200
MAA 108,16,140
TR 100,16,59136
MAA 108,20,156
TR 102,16,59648
MAA 124,28,156
TR 104,16,50720
MAA 124,24,140
TR 106,16,51232
MAA 160,32,128
TR 108,16,59168
MAA 160,36,144
TR 110,16,59680
MAA 176,44,144
s_waitcnt lgkmcnt(7)
s_barrier
ds_read_b128 v[12:15], v2
MAA 176,40,128
ds_read_b128 v[4:7], v2 offset:1024
MAA 164,32,132
TR 192,16,16960
MAA 164,36,148
TR 194,16,17472
MAA 180,44,148
TR 196,16,25408
MAA 180,40,132
TR 198,16,25920
MAA 168,32,136
TR 200,16,16992
MAA 168,36,152
TR 202,16,17504
MAA 184,44,152
TR 204,16,25440
MAA 184,40,136
TR 206,16,25952
s_waitcnt lgkmcnt(8)
v_add_f32 v12, v12, v4
MAA 172,32,140
TR 112,16,33856
v_add_f32 v13, v13, v5
MAA 172,36,156
TR 114,16,34368
v_add_f32 v14, v14, v6
MAA 188,44,156
TR 116,16,42304
v_add_f32 v15, v15, v7
MAA 188,40,140
ds_read_b128 v[4:7], v2 offset:2048
MAA 224,48,128
TR 118,16,42816
MAA 224,52,144
TR 120,16,33888
MAA 232,60,144
TR 122,16,34400
MAA 232,56,128
TR 124,16,42336
MAA 228,48,132
TR 126,16,42848
MAA 228,52,148
TR 0,16,50752
MAA 236,60,148
TR 2,16,51264
MAA 236,56,132
TR 4,16,59200
s_waitcnt lgkmcnt(8)
v_add_f32 v12, v12, v4
MAA 64,64,128
TR 6,16,59712
v_add_f32 v13, v13, v5
MAA 64,68,144
TR 8,16,50784
v_add_f32 v14, v14, v6
s_waitcnt vmcnt(7)
MAA 64,96,160
TR 10,16,51296
v_add_f32 v15, v15, v7
s_waitcnt vmcnt(5)
MAA 64,100,176
ds_read_b128 v[4:7], v2 offset:3072
MAA 80,108,176
TR 12,16,59232
MAA 80,104,160
TR 14,16,59744
MAA 80,76,144
TR 16,16,17024
MAA 80,72,128
TR 18,16,17536
MAA 32,80,160
TR 20,16,25472
MAA 32,84,176
TR 22,16,25984
MAA 48,92,176
TR 24,16,17056
MAA 48,88,160
TR 26,16,17568
s_waitcnt lgkmcnt(8)
v_add_f32 v12, v12, v4
v_add_f32 v13, v13, v5
v_add_f32 v14, v14, v6
v_add_f32 v15, v15, v7
ds_write_b128 v2, v[12:15] offset:8960
ds_read_b128 v[12:15], v9
ds_read_b128 v[4:7], v9 offset:64
v_lshrrev_b32 v2, 3, v1
v_cmp_eq_u32 vcc, 3, v2
TR 28,16,25504
TR 30,16,26016
TR 32,16,33920
TR 34,16,34432
TR 36,16,42368
TR 38,16,42880
TR 40,16,33952
TR 42,16,34464
TR 44,16,42400
TR 46,16,42912
TR 48,16,50816
TR 50,16,51328
TR 52,16,59264
s_waitcnt lgkmcnt(14)
v_pk_fma_f32 v[32:33], v[12:13], v[20:21], v[32:33] op_sel_hi:[1,0,1]
v_pk_fma_f32 v[34:35], v[14:15], v[20:21], v[34:35] op_sel_hi:[1,0,1]
v_pk_fma_f32 v[36:37], v[12:13], v[22:23], v[36:37] op_sel_hi:[1,0,1]
v_pk_fma_f32 v[38:39], v[14:15], v[22:23], v[38:39] op_sel_hi:[1,0,1]
v_pk_fma_f32 v[40:41], v[12:13], v[24:25], v[40:41] op_sel_hi:[1,0,1]
v_pk_fma_f32 v[42:43], v[14:15], v[24:25], v[42:43] op_sel_hi:[1,0,1]
v_pk_fma_f32 v[44:45], v[12:13], v[26:27], v[44:45] op_sel_hi:[1,0,1]
v_pk_fma_f32 v[46:47], v[14:15], v[26:27], v[46:47] op_sel_hi:[1,0,1]
ds_read_b128 v[12:15], v9 offset:512
s_waitcnt lgkmcnt(14)
v_pk_fma_f32 v[48:49], v[4:5], v[20:21], v[48:49] op_sel_hi:[1,0,1]
v_pk_fma_f32 v[50:51], v[6:7], v[20:21], v[50:51] op_sel_hi:[1,0,1]
v_pk_fma_f32 v[52:53], v[4:5], v[22:23], v[52:53] op_sel_hi:[1,0,1]
v_pk_fma_f32 v[54:55], v[6:7], v[22:23], v[54:55] op_sel_hi:[1,0,1]
v_pk_fma_f32 v[56:57], v[4:5], v[24:25], v[56:57] op_sel_hi:[1,0,1]
v_pk_fma_f32 v[58:59], v[6:7], v[24:25], v[58:59] op_sel_hi:[1,0,1]
v_pk_fma_f32 v[60:61], v[4:5], v[26:27], v[60:61] op_sel_hi:[1,0,1]
v_pk_fma_f32 v[62:63], v[6:7], v[26:27], v[62:63] op_sel_hi:[1,0,1]
ds_read_b128 v[4:7], v9 offset:576
TR 54,16,59776
TR 56,16,50848
TR 58,16,51360
TR 60,16,59296
TR 62,16,59808
s_waitcnt lgkmcnt(6)
v_pk_fma_f32 v[64:65], v[12:13], v[20:21], v[64:65] op_sel_hi:[1,0,1]
v_pk_fma_f32 v[66:67], v[14:15], v[20:21], v[66:67] op_sel_hi:[1,0,1]
v_pk_fma_f32 v[68:69], v[12:13], v[22:23], v[68:69] op_sel_hi:[1,0,1]
v_pk_fma_f32 v[70:71], v[14:15], v[22:23], v[70:71] op_sel_hi:[1,0,1]
v_pk_fma_f32 v[72:73], v[12:13], v[24:25], v[72:73] op_sel_hi:[1,0,1]
v_pk_fma_f32 v[74:75], v[14:15], v[24:25], v[74:75] op_sel_hi:[1,0,1]
v_pk_fma_f32 v[76:77], v[12:13], v[26:27], v[76:77] op_sel_hi:[1,0,1]
v_pk_fma_f32 v[78:79], v[14:15], v[26:27], v[78:79] op_sel_hi:[1,0,1]
ds_read_b128 v[12:15], v9 offset:832
s_waitcnt lgkmcnt(6)
v_pk_fma_f32 v[80:81], v[4:5], v[20:21], v[80:81] op_sel_hi:[1,0,1]
v_pk_fma_f32 v[82:83], v[6:7], v[20:21], v[82:83] op_sel_hi:[1,0,1]
v_pk_fma_f32 v[84:85], v[4:5], v[22:23], v[84:85] op_sel_hi:[1,0,1]
v_pk_fma_f32 v[86:87], v[6:7], v[22:23], v[86:87] op_sel_hi:[1,0,1]
v_pk_fma_f32 v[88:89], v[4:5], v[24:25], v[88:89] op_sel_hi:[1,0,1]
v_pk_fma_f32 v[90:91], v[6:7], v[24:25], v[90:91] op_sel_hi:[1,0,1]
v_pk_fma_f32 v[92:93], v[4:5], v[26:27], v[92:93] op_sel_hi:[1,0,1]
v_pk_fma_f32 v[94:95], v[6:7], v[26:27], v[94:95] op_sel_hi:[1,0,1]
ds_read_b128 v[4:7], v9 offset:704
v_pk_mul_f32 v[64:65], v[64:65], v[32:33]
v_pk_mul_f32 v[32:33], v[32:33], v[28:29] op_sel_hi:[1,0]
v_pk_mul_f32 v[66:67], v[66:67], v[34:35]
v_pk_mul_f32 v[34:35], v[34:35], v[28:29] op_sel_hi:[1,0]
v_pk_mul_f32 v[80:81], v[80:81], v[48:49]
v_pk_mul_f32 v[48:49], v[48:49], v[28:29] op_sel_hi:[1,0]
v_pk_mul_f32 v[82:83], v[82:83], v[50:51]
v_pk_mul_f32 v[50:51], v[50:51], v[28:29] op_sel_hi:[1,0]
v_exp_f32 v32, v32
v_exp_f32 v33, v33
MAA 68,64,132
v_exp_f32 v34, v34
MAA 68,68,148
v_exp_f32 v35, v35
MAA 68,96,164
v_exp_f32 v48, v48
s_waitcnt vmcnt(4)
MAA 68,100,180
v_exp_f32 v49, v49
MAA 84,108,180
v_exp_f32 v50, v50
MAA 84,104,164
v_exp_f32 v51, v51
MAA 84,76,148
MAA 84,72,132
MAA 36,80,164
MAA 36,84,180
MAA 52,92,180
MAA 52,88,164
s_nop 5
v_pk_mul_f32 v[68:69], v[68:69], v[36:37]
v_pk_fma_f32 v[32:33], v[32:33], v[20:21], v[20:21] op_sel:[0,1,1] op_sel_hi:[1,1,1]
v_pk_fma_f32 v[34:35], v[34:35], v[20:21], v[20:21] op_sel:[0,1,1] op_sel_hi:[1,1,1]
v_pk_fma_f32 v[48:49], v[48:49], v[20:21], v[20:21] op_sel:[0,1,1] op_sel_hi:[1,1,1]
v_pk_fma_f32 v[50:51], v[50:51], v[20:21], v[20:21] op_sel:[0,1,1] op_sel_hi:[1,1,1]
v_rcp_f32 v32, v32
v_pk_mul_f32 v[36:37], v[36:37], v[28:29] op_sel:[0,1] op_sel_hi:[1,1]
v_pk_mul_f32 v[70:71], v[70:71], v[38:39]
v_pk_mul_f32 v[38:39], v[38:39], v[28:29] op_sel:[0,1] op_sel_hi:[1,1]
v_pk_mul_f32 v[84:85], v[84:85], v[52:53]
v_pk_mul_f32 v[52:53], v[52:53], v[28:29] op_sel:[0,1] op_sel_hi:[1,1]
v_pk_mul_f32 v[86:87], v[86:87], v[54:55]
v_pk_mul_f32 v[54:55], v[54:55], v[28:29] op_sel:[0,1] op_sel_hi:[1,1]
v_rcp_f32 v33, v33
v_rcp_f32 v34, v34
MAA 72,64,136
v_rcp_f32 v35, v35
MAA 72,68,152
v_rcp_f32 v48, v48
s_waitcnt vmcnt(3)
MAA 72,96,168
v_rcp_f32 v49, v49
s_waitcnt vmcnt(1)
MAA 72,100,184
v_rcp_f32 v50, v50
MAA 88,108,184
v_rcp_f32 v51, v51
MAA 88,104,168
v_exp_f32 v36, v36
MAA 88,76,152
v_exp_f32 v37, v37
MAA 88,72,136
v_exp_f32 v38, v38
MAA 40,80,168
v_exp_f32 v39, v39
MAA 40,84,184
v_exp_f32 v52, v52
MAA 56,92,184
v_exp_f32 v53, v53
MAA 56,88,168
v_exp_f32 v54, v54
v_exp_f32 v55, v55
v_pk_mul_f32 v[64:65], v[64:65], v[32:33]
v_pk_mul_f32 v[66:67], v[66:67], v[34:35]
v_pk_mul_f32 v[80:81], v[80:81], v[48:49]
v_pk_mul_f32 v[82:83], v[82:83], v[50:51]
ds_read_b128 v[48:51], v9 offset:128
v_pk_mul_f32 v[72:73], v[72:73], v[40:41]
v_pk_mul_f32 v[40:41], v[40:41], v[30:31] op_sel_hi:[1,0]
v_pk_mul_f32 v[74:75], v[74:75], v[42:43]
v_pk_mul_f32 v[42:43], v[42:43], v[30:31] op_sel_hi:[1,0]
v_pk_mul_f32 v[88:89], v[88:89], v[56:57]
v_pk_mul_f32 v[56:57], v[56:57], v[30:31] op_sel_hi:[1,0]
v_pk_mul_f32 v[90:91], v[90:91], v[58:59]
v_pk_mul_f32 v[58:59], v[58:59], v[30:31] op_sel_hi:[1,0]
v_pk_fma_f32 v[36:37], v[36:37], v[22:23], v[22:23] op_sel:[0,1,1] op_sel_hi:[1,1,1]
v_pk_fma_f32 v[38:39], v[38:39], v[22:23], v[22:23] op_sel:[0,1,1] op_sel_hi:[1,1,1]
v_pk_fma_f32 v[52:53], v[52:53], v[22:23], v[22:23] op_sel:[0,1,1] op_sel_hi:[1,1,1]
v_pk_fma_f32 v[54:55], v[54:55], v[22:23], v[22:23] op_sel:[0,1,1] op_sel_hi:[1,1,1]
v_cvt_pk_bf16_f32 v32, v64, v65
v_cvt_pk_bf16_f32 v33, v66, v67
ds_read_b128 v[64:67], v9 offset:192
v_cvt_pk_bf16_f32 v34, v80, v81
v_cvt_pk_bf16_f32 v35, v82, v83
MAA 76,64,140
buffer_store_dwordx4 v[32:35], v10, s[16:19], s62 offen sc1
MAA 76,68,156
.Lpad16:
s_cbranch_execz .Lnopoll34r
ds_read_b128 v[80:83], v9 offset:640
v_rcp_f32 v36, v36
MAA 76,96,172
TR 64,17,16896
v_rcp_f32 v37, v37
s_waitcnt vmcnt(1)
MAA 76,100,188
TR 66,17,17408
v_rcp_f32 v38, v38
MAA 92,108,188
TR 68,17,25344
v_rcp_f32 v39, v39
MAA 92,104,172
TR 70,17,25856
v_rcp_f32 v52, v52
MAA 92,76,156
TR 76,17,25376
v_rcp_f32 v53, v53
MAA 92,72,140
TR 72,17,16928
v_rcp_f32 v54, v54
MAA 44,80,172
TR 74,17,17440
v_rcp_f32 v55, v55
MAA 44,84,188
TR 78,17,25888
v_exp_f32 v40, v40
MAA 60,92,188
TR 80,17,33792
v_exp_f32 v41, v41
MAA 60,88,172
TR 82,17,34304
v_exp_f32 v42, v42
v_exp_f32 v43, v43
v_exp_f32 v56, v56
v_exp_f32 v57, v57
v_exp_f32 v58, v58
v_exp_f32 v59, v59
v_pk_mul_f32 v[68:69], v[68:69], v[36:37]
v_pk_mul_f32 v[70:71], v[70:71], v[38:39]
v_pk_mul_f32 v[84:85], v[84:85], v[52:53]
v_pk_mul_f32 v[86:87], v[86:87], v[54:55]
ds_read_b128 v[52:55], v8 offset:576
v_pk_mul_f32 v[76:77], v[76:77], v[44:45]
v_pk_mul_f32 v[44:45], v[44:45], v[30:31] op_sel:[0,1] op_sel_hi:[1,1]
v_pk_mul_f32 v[78:79], v[78:79], v[46:47]
v_pk_mul_f32 v[46:47], v[46:47], v[30:31] op_sel:[0,1] op_sel_hi:[1,1]
v_pk_mul_f32 v[92:93], v[92:93], v[60:61]
v_pk_mul_f32 v[60:61], v[60:61], v[30:31] op_sel:[0,1] op_sel_hi:[1,1]
v_pk_mul_f32 v[94:95], v[94:95], v[62:63]
v_pk_mul_f32 v[62:63], v[62:63], v[30:31] op_sel:[0,1] op_sel_hi:[1,1]
v_pk_fma_f32 v[40:41], v[40:41], v[24:25], v[24:25] op_sel:[0,1,1] op_sel_hi:[1,1,1]
v_pk_fma_f32 v[42:43], v[42:43], v[24:25], v[24:25] op_sel:[0,1,1] op_sel_hi:[1,1,1]
v_pk_fma_f32 v[56:57], v[56:57], v[24:25], v[24:25] op_sel:[0,1,1] op_sel_hi:[1,1,1]
v_pk_fma_f32 v[58:59], v[58:59], v[24:25], v[24:25] op_sel:[0,1,1] op_sel_hi:[1,1,1]
v_cvt_pk_bf16_f32 v36, v68, v69
v_cvt_pk_bf16_f32 v37, v70, v71
v_cvt_pk_bf16_f32 v38, v84, v85
v_cvt_pk_bf16_f32 v39, v86, v87
MAA 128,192,128
buffer_store_dwordx4 v[36:39], v10, s[16:19], s62 offen offset:1024 sc1
MAA 128,196,144
TR 84,17,42240
v_rcp_f32 v40, v40
MAA 128,0,160
TR 86,17,42752
v_rcp_f32 v41, v41
MAA 128,4,176
TR 88,17,33824
v_rcp_f32 v42, v42
MAA 144,12,176
TR 90,17,34336
v_rcp_f32 v43, v43
MAA 144,8,160
TR 92,17,42272
v_rcp_f32 v56, v56
MAA 144,204,144
TR 94,17,42784
v_rcp_f32 v57, v57
MAA 144,200,128
TR 96,17,50688
v_rcp_f32 v58, v58
MAA 96,112,160
TR 98,17,51200
v_rcp_f32 v59, v59
MAA 96,116,176
TR 100,17,59136
v_exp_f32 v44, v44
MAA 112,124,176
TR 102,17,59648
v_exp_f32 v45, v45
MAA 112,120,160
TR 104,17,50720
v_lshrrev_b32 v69, 2, v0
v_min_u32 v69, 1, v69
v_lshlrev_b32 v69, 28, v69
v_lshl_add_u32 v68, v0, 7, v69
v_xor_b32 v69, 64, v0
v_min_u32 v69, 1, v69
v_lshlrev_b32 v70, 4, v69
v_sub_u32 v70, 16, v70
v_lshlrev_b32 v69, 28, v69
v_mov_b32 v71, 1
v_mov_b32 v84, 0
v_mov_b32 v85, 0
v_mov_b32 v86, 0
v_exp_f32 v46, v46
v_exp_f32 v47, v47
v_exp_f32 v60, v60
v_exp_f32 v61, v61
v_exp_f32 v62, v62
v_exp_f32 v63, v63
v_pk_mul_f32 v[72:73], v[72:73], v[40:41]
v_pk_mul_f32 v[74:75], v[74:75], v[42:43]
v_pk_mul_f32 v[88:89], v[88:89], v[56:57]
v_pk_mul_f32 v[90:91], v[90:91], v[58:59]
s_waitcnt lgkmcnt(15)
v_pk_fma_f32 v[96:97], v[48:49], v[20:21], v[96:97] op_sel_hi:[1,0,1]
v_pk_fma_f32 v[98:99], v[50:51], v[20:21], v[98:99] op_sel_hi:[1,0,1]
v_pk_fma_f32 v[112:113], v[64:65], v[20:21], v[112:113] op_sel_hi:[1,0,1]
v_pk_fma_f32 v[114:115], v[66:67], v[20:21], v[114:115] op_sel_hi:[1,0,1]
v_pk_fma_f32 v[128:129], v[80:81], v[20:21], v[128:129] op_sel_hi:[1,0,1]
v_pk_fma_f32 v[130:131], v[82:83], v[20:21], v[130:131] op_sel_hi:[1,0,1]
v_pk_fma_f32 v[144:145], v[4:5], v[20:21], v[144:145] op_sel_hi:[1,0,1]
v_pk_fma_f32 v[146:147], v[6:7], v[20:21], v[146:147] op_sel_hi:[1,0,1]
v_pk_mul_f32 v[128:129], v[128:129], v[96:97]
v_pk_mul_f32 v[96:97], v[96:97], v[28:29] op_sel_hi:[1,0]
v_pk_mul_f32 v[130:131], v[130:131], v[98:99]
v_pk_mul_f32 v[98:99], v[98:99], v[28:29] op_sel_hi:[1,0]
v_pk_mul_f32 v[144:145], v[144:145], v[112:113]
v_pk_mul_f32 v[112:113], v[112:113], v[28:29] op_sel_hi:[1,0]
v_pk_mul_f32 v[146:147], v[146:147], v[114:115]
v_pk_mul_f32 v[114:115], v[114:115], v[28:29] op_sel_hi:[1,0]
v_pk_fma_f32 v[44:45], v[44:45], v[26:27], v[26:27] op_sel:[0,1,1] op_sel_hi:[1,1,1]
v_pk_fma_f32 v[46:47], v[46:47], v[26:27], v[26:27] op_sel:[0,1,1] op_sel_hi:[1,1,1]
v_pk_fma_f32 v[60:61], v[60:61], v[26:27], v[26:27] op_sel:[0,1,1] op_sel_hi:[1,1,1]
v_pk_fma_f32 v[62:63], v[62:63], v[26:27], v[26:27] op_sel:[0,1,1] op_sel_hi:[1,1,1]
v_cvt_pk_bf16_f32 v40, v72, v73
v_cvt_pk_bf16_f32 v41, v74, v75
v_cvt_pk_bf16_f32 v42, v88, v89
v_cvt_pk_bf16_f32 v43, v90, v91
MAA 132,192,132
buffer_store_dwordx4 v[40:43], v11, s[16:19], s62 offen sc1
MAA 132,196,148
TR 106,17,51232
v_rcp_f32 v44, v44
MAA 132,0,164
TR 108,17,59168
v_rcp_f32 v45, v45
MAA 132,4,180
TR 110,17,59680
v_rcp_f32 v46, v46
MAA 148,12,180
v_rcp_f32 v47, v47
MAA 148,8,164
v_rcp_f32 v60, v60
MAA 148,204,148
v_rcp_f32 v61, v61
MAA 148,200,132
v_rcp_f32 v62, v62
MAA 100,112,164
v_rcp_f32 v63, v63
MAA 100,116,180
v_exp_f32 v96, v96
MAA 116,124,180
v_exp_f32 v97, v97
MAA 116,120,164
s_waitcnt lgkmcnt(0)
s_barrier
s_add_u32 m0, s59, 84480
v_exp_f32 v98, v98
v_exp_f32 v99, v99
v_exp_f32 v112, v112
v_exp_f32 v113, v113
v_exp_f32 v114, v114
v_exp_f32 v115, v115
v_pk_mul_f32 v[76:77], v[76:77], v[44:45]
v_pk_mul_f32 v[78:79], v[78:79], v[46:47]
v_pk_mul_f32 v[92:93], v[92:93], v[60:61]
v_pk_mul_f32 v[94:95], v[94:95], v[62:63]
v_pk_fma_f32 v[100:101], v[48:49], v[22:23], v[100:101] op_sel_hi:[1,0,1]
v_pk_fma_f32 v[102:103], v[50:51], v[22:23], v[102:103] op_sel_hi:[1,0,1]
v_pk_fma_f32 v[116:117], v[64:65], v[22:23], v[116:117] op_sel_hi:[1,0,1]
v_pk_fma_f32 v[118:119], v[66:67], v[22:23], v[118:119] op_sel_hi:[1,0,1]
v_pk_fma_f32 v[132:133], v[80:81], v[22:23], v[132:133] op_sel_hi:[1,0,1]
v_pk_fma_f32 v[134:135], v[82:83], v[22:23], v[134:135] op_sel_hi:[1,0,1]
v_pk_fma_f32 v[148:149], v[4:5], v[22:23], v[148:149] op_sel_hi:[1,0,1]
v_pk_fma_f32 v[150:151], v[6:7], v[22:23], v[150:151] op_sel_hi:[1,0,1]
v_pk_mul_f32 v[132:133], v[132:133], v[100:101]
v_pk_mul_f32 v[100:101], v[100:101], v[28:29] op_sel:[0,1] op_sel_hi:[1,1]
v_pk_mul_f32 v[134:135], v[134:135], v[102:103]
v_pk_mul_f32 v[102:103], v[102:103], v[28:29] op_sel:[0,1] op_sel_hi:[1,1]
v_pk_mul_f32 v[148:149], v[148:149], v[116:117]
v_pk_mul_f32 v[116:117], v[116:117], v[28:29] op_sel:[0,1] op_sel_hi:[1,1]
v_pk_mul_f32 v[150:151], v[150:151], v[118:119]
v_pk_mul_f32 v[118:119], v[118:119], v[28:29] op_sel:[0,1] op_sel_hi:[1,1]
v_pk_fma_f32 v[96:97], v[96:97], v[20:21], v[20:21] op_sel:[0,1,1] op_sel_hi:[1,1,1]
v_pk_fma_f32 v[98:99], v[98:99], v[20:21], v[20:21] op_sel:[0,1,1] op_sel_hi:[1,1,1]
v_pk_fma_f32 v[112:113], v[112:113], v[20:21], v[20:21] op_sel:[0,1,1] op_sel_hi:[1,1,1]
v_pk_fma_f32 v[114:115], v[114:115], v[20:21], v[20:21] op_sel:[0,1,1] op_sel_hi:[1,1,1]
v_cvt_pk_bf16_f32 v44, v76, v77
v_cvt_pk_bf16_f32 v45, v78, v79
v_cvt_pk_bf16_f32 v46, v92, v93
v_cvt_pk_bf16_f32 v47, v94, v95
MAA 136,192,136
buffer_store_dwordx4 v[44:47], v11, s[16:19], s62 offen offset:1024 sc1
MAA 136,196,152
v_rcp_f32 v96, v96
MAA 136,0,168
v_rcp_f32 v97, v97
MAA 136,4,184
v_rcp_f32 v98, v98
MAA 152,12,184
buffer_load_dwordx4 v18, s[28:31], s58 offen lds
MAA 152,8,168
v_rcp_f32 v99, v99
MAA 152,204,152
v_rcp_f32 v112, v112
MAA 152,200,136
v_rcp_f32 v113, v113
MAA 104,112,168
buffer_load_dwordx4 v19, s[28:31], s58 offen offset:1056 lds
MAA 104,116,184
s_add_u32 m0, s59, 92928
s_add_u32 s58, s99, 2555904
v_rcp_f32 v114, v114
MAA 120,124,184
v_rcp_f32 v115, v115
MAA 120,120,168
v_exp_f32 v100, v100
v_exp_f32 v101, v101
v_exp_f32 v102, v102
v_exp_f32 v103, v103
v_exp_f32 v116, v116
v_exp_f32 v117, v117
v_exp_f32 v118, v118
v_exp_f32 v119, v119
v_pk_mul_f32 v[128:129], v[128:129], v[96:97]
v_pk_mul_f32 v[130:131], v[130:131], v[98:99]
v_pk_mul_f32 v[144:145], v[144:145], v[112:113]
v_pk_mul_f32 v[146:147], v[146:147], v[114:115]
ds_read_b128 v[112:115], v9 offset:256
v_pk_fma_f32 v[104:105], v[48:49], v[24:25], v[104:105] op_sel_hi:[1,0,1]
v_pk_fma_f32 v[106:107], v[50:51], v[24:25], v[106:107] op_sel_hi:[1,0,1]
v_pk_fma_f32 v[120:121], v[64:65], v[24:25], v[120:121] op_sel_hi:[1,0,1]
v_pk_fma_f32 v[122:123], v[66:67], v[24:25], v[122:123] op_sel_hi:[1,0,1]
v_pk_fma_f32 v[136:137], v[80:81], v[24:25], v[136:137] op_sel_hi:[1,0,1]
v_pk_fma_f32 v[138:139], v[82:83], v[24:25], v[138:139] op_sel_hi:[1,0,1]
v_pk_fma_f32 v[152:153], v[4:5], v[24:25], v[152:153] op_sel_hi:[1,0,1]
v_pk_fma_f32 v[154:155], v[6:7], v[24:25], v[154:155] op_sel_hi:[1,0,1]
v_pk_mul_f32 v[136:137], v[136:137], v[104:105]
v_pk_mul_f32 v[104:105], v[104:105], v[30:31] op_sel_hi:[1,0]
v_pk_mul_f32 v[138:139], v[138:139], v[106:107]
v_pk_mul_f32 v[106:107], v[106:107], v[30:31] op_sel_hi:[1,0]
v_pk_mul_f32 v[152:153], v[152:153], v[120:121]
v_pk_mul_f32 v[120:121], v[120:121], v[30:31] op_sel_hi:[1,0]
v_pk_mul_f32 v[154:155], v[154:155], v[122:123]
v_pk_mul_f32 v[122:123], v[122:123], v[30:31] op_sel_hi:[1,0]
v_pk_fma_f32 v[100:101], v[100:101], v[22:23], v[22:23] op_sel:[0,1,1] op_sel_hi:[1,1,1]
v_pk_fma_f32 v[102:103], v[102:103], v[22:23], v[22:23] op_sel:[0,1,1] op_sel_hi:[1,1,1]
v_pk_fma_f32 v[116:117], v[116:117], v[22:23], v[22:23] op_sel:[0,1,1] op_sel_hi:[1,1,1]
v_pk_fma_f32 v[118:119], v[118:119], v[22:23], v[22:23] op_sel:[0,1,1] op_sel_hi:[1,1,1]
v_cvt_pk_bf16_f32 v96, v128, v129
v_cvt_pk_bf16_f32 v97, v130, v131
ds_read_b128 v[128:131], v9 offset:320
v_cvt_pk_bf16_f32 v98, v144, v145
v_cvt_pk_bf16_f32 v99, v146, v147
MAA 140,192,140
buffer_store_dwordx4 v[96:99], v10, s[16:19], s63 offen sc1
MAA 140,196,156
ds_read_b128 v[144:147], v9 offset:768
v_rcp_f32 v100, v100
MAA 140,0,172
v_rcp_f32 v101, v101
MAA 140,4,188
v_rcp_f32 v102, v102
MAA 156,12,188
buffer_load_dwordx4 v18, s[28:31], s58 offen lds
MAA 156,8,172
v_rcp_f32 v103, v103
MAA 156,204,156
v_rcp_f32 v116, v116
MAA 156,200,140
v_rcp_f32 v117, v117
MAA 108,112,172
buffer_load_dwordx4 v19, s[28:31], s58 offen offset:1056 lds
MAA 108,116,188
s_add_u32 m0, s59, 101376
s_add_u32 s58, s100, 2752512
v_rcp_f32 v118, v118
MAA 124,124,188
v_rcp_f32 v119, v119
MAA 124,120,172
v_exp_f32 v104, v104
v_exp_f32 v105, v105
v_exp_f32 v106, v106
v_exp_f32 v107, v107
v_exp_f32 v120, v120
v_exp_f32 v121, v121
v_exp_f32 v122, v122
v_exp_f32 v123, v123
v_pk_mul_f32 v[132:133], v[132:133], v[100:101]
v_pk_mul_f32 v[134:135], v[134:135], v[102:103]
v_pk_mul_f32 v[148:149], v[148:149], v[116:117]
v_pk_mul_f32 v[150:151], v[150:151], v[118:119]
v_pk_fma_f32 v[108:109], v[48:49], v[26:27], v[108:109] op_sel_hi:[1,0,1]
v_pk_fma_f32 v[110:111], v[50:51], v[26:27], v[110:111] op_sel_hi:[1,0,1]
v_pk_fma_f32 v[124:125], v[64:65], v[26:27], v[124:125] op_sel_hi:[1,0,1]
v_pk_fma_f32 v[126:127], v[66:67], v[26:27], v[126:127] op_sel_hi:[1,0,1]
v_pk_fma_f32 v[140:141], v[80:81], v[26:27], v[140:141] op_sel_hi:[1,0,1]
v_pk_fma_f32 v[142:143], v[82:83], v[26:27], v[142:143] op_sel_hi:[1,0,1]
v_pk_fma_f32 v[156:157], v[4:5], v[26:27], v[156:157] op_sel_hi:[1,0,1]
v_pk_fma_f32 v[158:159], v[6:7], v[26:27], v[158:159] op_sel_hi:[1,0,1]
v_pk_mul_f32 v[140:141], v[140:141], v[108:109]
v_pk_mul_f32 v[108:109], v[108:109], v[30:31] op_sel:[0,1] op_sel_hi:[1,1]
v_pk_mul_f32 v[142:143], v[142:143], v[110:111]
v_pk_mul_f32 v[110:111], v[110:111], v[30:31] op_sel:[0,1] op_sel_hi:[1,1]
v_pk_mul_f32 v[156:157], v[156:157], v[124:125]
s_waitcnt vmcnt(5)
s_barrier
buffer_atomic_add v71, v68, s[16:19], s72 offen offset:512
v_pk_mul_f32 v[124:125], v[124:125], v[30:31] op_sel:[0,1] op_sel_hi:[1,1]
v_pk_mul_f32 v[158:159], v[158:159], v[126:127]
v_pk_mul_f32 v[126:127], v[126:127], v[30:31] op_sel:[0,1] op_sel_hi:[1,1]
v_pk_fma_f32 v[104:105], v[104:105], v[24:25], v[24:25] op_sel:[0,1,1] op_sel_hi:[1,1,1]
v_pk_fma_f32 v[106:107], v[106:107], v[24:25], v[24:25] op_sel:[0,1,1] op_sel_hi:[1,1,1]
v_pk_fma_f32 v[120:121], v[120:121], v[24:25], v[24:25] op_sel:[0,1,1] op_sel_hi:[1,1,1]
v_pk_fma_f32 v[122:123], v[122:123], v[24:25], v[24:25] op_sel:[0,1,1] op_sel_hi:[1,1,1]
v_cvt_pk_bf16_f32 v100, v132, v133
v_cvt_pk_bf16_f32 v101, v134, v135
v_cvt_pk_bf16_f32 v102, v148, v149
v_cvt_pk_bf16_f32 v103, v150, v151
MAA 192,16,128
v_rcp_f32 v104, v104
MAA 192,20,144
buffer_store_dwordx4 v[100:103], v10, s[16:19], s63 offen offset:1024 sc1
MAA 192,48,160
v_rcp_f32 v105, v105
MAA 192,52,176
v_rcp_f32 v106, v106
MAA 208,60,176
v_rcp_f32 v107, v107
MAA 208,56,160
buffer_load_dwordx4 v18, s[28:31], s58 offen lds
MAA 208,28,144
v_rcp_f32 v120, v120
MAA 208,24,128
v_rcp_f32 v121, v121
MAA 160,32,160
v_rcp_f32 v122, v122
MAA 160,36,176
buffer_load_dwordx4 v19, s[28:31], s58 offen offset:1056 lds
MAA 176,44,176
s_add_u32 m0, s59, 109824
s_add_u32 s58, s100, 3014656
v_rcp_f32 v123, v123
MAA 176,40,160
v_exp_f32 v108, v108
v_exp_f32 v109, v109
v_exp_f32 v110, v110
v_exp_f32 v111, v111
v_exp_f32 v124, v124
v_exp_f32 v125, v125
v_exp_f32 v126, v126
v_exp_f32 v127, v127
v_pk_mul_f32 v[136:137], v[136:137], v[104:105]
v_pk_mul_f32 v[138:139], v[138:139], v[106:107]
v_pk_mul_f32 v[152:153], v[152:153], v[120:121]
v_pk_mul_f32 v[154:155], v[154:155], v[122:123]
s_waitcnt lgkmcnt(2)
v_pk_fma_f32 v[160:161], v[112:113], v[20:21], v[160:161] op_sel_hi:[1,0,1]
v_pk_fma_f32 v[162:163], v[114:115], v[20:21], v[162:163] op_sel_hi:[1,0,1]
s_waitcnt lgkmcnt(1)
v_pk_fma_f32 v[176:177], v[128:129], v[20:21], v[176:177] op_sel_hi:[1,0,1]
v_pk_fma_f32 v[178:179], v[130:131], v[20:21], v[178:179] op_sel_hi:[1,0,1]
s_waitcnt lgkmcnt(0)
v_pk_fma_f32 v[192:193], v[144:145], v[20:21], v[192:193] op_sel_hi:[1,0,1]
v_pk_fma_f32 v[194:195], v[146:147], v[20:21], v[194:195] op_sel_hi:[1,0,1]
v_pk_fma_f32 v[208:209], v[12:13], v[20:21], v[208:209] op_sel_hi:[1,0,1]
v_pk_fma_f32 v[210:211], v[14:15], v[20:21], v[210:211] op_sel_hi:[1,0,1]
v_pk_mul_f32 v[192:193], v[192:193], v[160:161]
v_pk_mul_f32 v[160:161], v[160:161], v[28:29] op_sel_hi:[1,0]
v_pk_mul_f32 v[194:195], v[194:195], v[162:163]
v_pk_mul_f32 v[162:163], v[162:163], v[28:29] op_sel_hi:[1,0]
v_pk_mul_f32 v[208:209], v[208:209], v[176:177]
v_pk_mul_f32 v[176:177], v[176:177], v[28:29] op_sel_hi:[1,0]
v_pk_mul_f32 v[210:211], v[210:211], v[178:179]
v_pk_mul_f32 v[178:179], v[178:179], v[28:29] op_sel_hi:[1,0]
v_pk_fma_f32 v[108:109], v[108:109], v[26:27], v[26:27] op_sel:[0,1,1] op_sel_hi:[1,1,1]
v_pk_fma_f32 v[110:111], v[110:111], v[26:27], v[26:27] op_sel:[0,1,1] op_sel_hi:[1,1,1]
v_pk_fma_f32 v[124:125], v[124:125], v[26:27], v[26:27] op_sel:[0,1,1] op_sel_hi:[1,1,1]
v_pk_fma_f32 v[126:127], v[126:127], v[26:27], v[26:27] op_sel:[0,1,1] op_sel_hi:[1,1,1]
v_cvt_pk_bf16_f32 v104, v136, v137
v_cvt_pk_bf16_f32 v105, v138, v139
v_cvt_pk_bf16_f32 v106, v152, v153
v_cvt_pk_bf16_f32 v107, v154, v155
MAA 196,16,132
buffer_store_dwordx4 v[104:107], v11, s[16:19], s63 offen sc1
MAA 196,20,148
v_rcp_f32 v108, v108
MAA 196,48,164
v_rcp_f32 v109, v109
MAA 196,52,180
v_rcp_f32 v110, v110
MAA 212,60,180
buffer_load_dwordx4 v18, s[28:31], s58 offen lds
MAA 212,56,164
v_rcp_f32 v111, v111
MAA 212,28,148
v_rcp_f32 v124, v124
MAA 212,24,132
v_rcp_f32 v125, v125
MAA 164,32,164
buffer_load_dwordx4 v19, s[28:31], s58 offen offset:1056 lds
MAA 164,36,180
s_add_u32 m0, s59, 118272
s_add_u32 s58, s101, 3211264
v_rcp_f32 v126, v126
MAA 180,44,180
v_rcp_f32 v127, v127
MAA 180,40,164
v_lshl_add_u32 v4, v1, 4, s74
v_add_u32 v2, 67108480, v4
v_cndmask_b32 v4, v4, v2, vcc
s_and_b32 s74, s7, 1
v_bfe_u32 v7, v1, 2, 3
v_mul_u32_u24 v7, 1056, v7
v_bfe_u32 v2, v1, 5, 1
v_lshl_add_u32 v7, v2, 8, v7
v_and_b32 v2, 3, v1
v_lshl_add_u32 v7, v2, 3, v7
s_lshl_b32 s74, s74, 7
s_xor_b32 s75, s74, 128
v_add_u32 v6, s75, v7
v_add_u32 v7, s74, v7
v_exp_f32 v160, v160
v_exp_f32 v161, v161
v_exp_f32 v162, v162
v_exp_f32 v163, v163
v_exp_f32 v176, v176
v_exp_f32 v177, v177
v_exp_f32 v178, v178
v_exp_f32 v179, v179
v_pk_mul_f32 v[140:141], v[140:141], v[108:109]
v_pk_mul_f32 v[142:143], v[142:143], v[110:111]
v_pk_mul_f32 v[156:157], v[156:157], v[124:125]
v_pk_mul_f32 v[158:159], v[158:159], v[126:127]
v_pk_fma_f32 v[164:165], v[112:113], v[22:23], v[164:165] op_sel_hi:[1,0,1]
v_pk_fma_f32 v[166:167], v[114:115], v[22:23], v[166:167] op_sel_hi:[1,0,1]
v_pk_fma_f32 v[180:181], v[128:129], v[22:23], v[180:181] op_sel_hi:[1,0,1]
v_pk_fma_f32 v[182:183], v[130:131], v[22:23], v[182:183] op_sel_hi:[1,0,1]
v_pk_fma_f32 v[196:197], v[144:145], v[22:23], v[196:197] op_sel_hi:[1,0,1]
v_pk_fma_f32 v[198:199], v[146:147], v[22:23], v[198:199] op_sel_hi:[1,0,1]
v_pk_fma_f32 v[212:213], v[12:13], v[22:23], v[212:213] op_sel_hi:[1,0,1]
v_pk_fma_f32 v[214:215], v[14:15], v[22:23], v[214:215] op_sel_hi:[1,0,1]
v_pk_mul_f32 v[196:197], v[196:197], v[164:165]
v_pk_mul_f32 v[164:165], v[164:165], v[28:29] op_sel:[0,1] op_sel_hi:[1,1]
v_pk_mul_f32 v[198:199], v[198:199], v[166:167]
v_pk_mul_f32 v[166:167], v[166:167], v[28:29] op_sel:[0,1] op_sel_hi:[1,1]
v_pk_mul_f32 v[212:213], v[212:213], v[180:181]
v_pk_mul_f32 v[180:181], v[180:181], v[28:29] op_sel:[0,1] op_sel_hi:[1,1]
v_pk_mul_f32 v[214:215], v[214:215], v[182:183]
v_pk_mul_f32 v[182:183], v[182:183], v[28:29] op_sel:[0,1] op_sel_hi:[1,1]
v_pk_fma_f32 v[160:161], v[160:161], v[20:21], v[20:21] op_sel:[0,1,1] op_sel_hi:[1,1,1]
v_pk_fma_f32 v[162:163], v[162:163], v[20:21], v[20:21] op_sel:[0,1,1] op_sel_hi:[1,1,1]
v_pk_fma_f32 v[176:177], v[176:177], v[20:21], v[20:21] op_sel:[0,1,1] op_sel_hi:[1,1,1]
v_pk_fma_f32 v[178:179], v[178:179], v[20:21], v[20:21] op_sel:[0,1,1] op_sel_hi:[1,1,1]
v_cvt_pk_bf16_f32 v108, v140, v141
v_cvt_pk_bf16_f32 v109, v142, v143
v_cvt_pk_bf16_f32 v110, v156, v157
v_cvt_pk_bf16_f32 v111, v158, v159
MAA 200,16,136
buffer_store_dwordx4 v[108:111], v11, s[16:19], s63 offen offset:1024 sc1
MAA 200,20,152
v_rcp_f32 v160, v160
MAA 200,48,168
v_rcp_f32 v161, v161
MAA 200,52,184
v_rcp_f32 v162, v162
MAA 216,60,184
buffer_load_dwordx4 v18, s[28:31], s58 offen lds
MAA 216,56,168
v_rcp_f32 v163, v163
MAA 216,28,152
v_rcp_f32 v176, v176
MAA 216,24,136
v_rcp_f32 v177, v177
MAA 168,32,168
buffer_load_dwordx4 v19, s[28:31], s58 offen offset:1056 lds
MAA 168,36,184
s_add_u32 m0, s59, 126720
s_add_u32 s58, s101, 3473408
v_rcp_f32 v178, v178
MAA 184,44,184
v_rcp_f32 v179, v179
MAA 184,40,168
v_exp_f32 v164, v164
v_exp_f32 v165, v165
v_exp_f32 v166, v166
v_exp_f32 v167, v167
v_exp_f32 v180, v180
v_exp_f32 v181, v181
v_exp_f32 v182, v182
v_exp_f32 v183, v183
v_pk_mul_f32 v[192:193], v[192:193], v[160:161]
v_pk_mul_f32 v[194:195], v[194:195], v[162:163]
v_pk_mul_f32 v[208:209], v[208:209], v[176:177]
v_pk_mul_f32 v[210:211], v[210:211], v[178:179]
ds_read_b128 v[176:179], v8
v_pk_fma_f32 v[168:169], v[112:113], v[24:25], v[168:169] op_sel_hi:[1,0,1]
v_pk_fma_f32 v[170:171], v[114:115], v[24:25], v[170:171] op_sel_hi:[1,0,1]
v_pk_fma_f32 v[184:185], v[128:129], v[24:25], v[184:185] op_sel_hi:[1,0,1]
v_pk_fma_f32 v[186:187], v[130:131], v[24:25], v[186:187] op_sel_hi:[1,0,1]
v_pk_fma_f32 v[200:201], v[144:145], v[24:25], v[200:201] op_sel_hi:[1,0,1]
v_pk_fma_f32 v[202:203], v[146:147], v[24:25], v[202:203] op_sel_hi:[1,0,1]
v_pk_fma_f32 v[216:217], v[12:13], v[24:25], v[216:217] op_sel_hi:[1,0,1]
v_pk_fma_f32 v[218:219], v[14:15], v[24:25], v[218:219] op_sel_hi:[1,0,1]
v_pk_mul_f32 v[200:201], v[200:201], v[168:169]
v_pk_mul_f32 v[168:169], v[168:169], v[30:31] op_sel_hi:[1,0]
v_pk_mul_f32 v[202:203], v[202:203], v[170:171]
v_pk_mul_f32 v[170:171], v[170:171], v[30:31] op_sel_hi:[1,0]
v_pk_mul_f32 v[216:217], v[216:217], v[184:185]
v_pk_mul_f32 v[184:185], v[184:185], v[30:31] op_sel_hi:[1,0]
v_pk_mul_f32 v[218:219], v[218:219], v[186:187]
v_pk_mul_f32 v[186:187], v[186:187], v[30:31] op_sel_hi:[1,0]
v_pk_fma_f32 v[164:165], v[164:165], v[22:23], v[22:23] op_sel:[0,1,1] op_sel_hi:[1,1,1]
v_pk_fma_f32 v[166:167], v[166:167], v[22:23], v[22:23] op_sel:[0,1,1] op_sel_hi:[1,1,1]
v_pk_fma_f32 v[180:181], v[180:181], v[22:23], v[22:23] op_sel:[0,1,1] op_sel_hi:[1,1,1]
v_pk_fma_f32 v[182:183], v[182:183], v[22:23], v[22:23] op_sel:[0,1,1] op_sel_hi:[1,1,1]
v_cvt_pk_bf16_f32 v160, v192, v193
v_cvt_pk_bf16_f32 v161, v194, v195
ds_read_b128 v[192:195], v8 offset:64
v_cvt_pk_bf16_f32 v162, v208, v209
v_cvt_pk_bf16_f32 v163, v210, v211
MAA 204,16,140
buffer_store_dwordx4 v[160:163], v10, s[16:19], s64 offen sc1
MAA 204,20,156
ds_read_b128 v[208:211], v8 offset:512
v_rcp_f32 v164, v164
MAA 204,48,172
v_rcp_f32 v165, v165
MAA 204,52,188
v_rcp_f32 v166, v166
MAA 220,60,188
buffer_atomic_add v84, v69, s[16:19], s73 offen offset:512 sc0
MAA 220,56,172
v_rcp_f32 v167, v167
MAA 220,28,156
v_rcp_f32 v180, v180
MAA 220,24,140
v_rcp_f32 v181, v181
MAA 172,32,172
buffer_load_dwordx4 v18, s[28:31], s58 offen lds
MAA 172,36,188
v_rcp_f32 v182, v182
MAA 188,44,188
v_rcp_f32 v183, v183
MAA 188,40,172
v_exp_f32 v168, v168
v_exp_f32 v169, v169
v_exp_f32 v170, v170
v_exp_f32 v171, v171
v_exp_f32 v184, v184
v_exp_f32 v185, v185
v_exp_f32 v186, v186
v_exp_f32 v187, v187
v_pk_mul_f32 v[196:197], v[196:197], v[164:165]
v_pk_mul_f32 v[198:199], v[198:199], v[166:167]
v_pk_mul_f32 v[212:213], v[212:213], v[180:181]
v_pk_mul_f32 v[214:215], v[214:215], v[182:183]
v_pk_fma_f32 v[172:173], v[112:113], v[26:27], v[172:173] op_sel_hi:[1,0,1]
v_pk_fma_f32 v[174:175], v[114:115], v[26:27], v[174:175] op_sel_hi:[1,0,1]
v_pk_fma_f32 v[188:189], v[128:129], v[26:27], v[188:189] op_sel_hi:[1,0,1]
v_pk_fma_f32 v[190:191], v[130:131], v[26:27], v[190:191] op_sel_hi:[1,0,1]
v_pk_fma_f32 v[204:205], v[144:145], v[26:27], v[204:205] op_sel_hi:[1,0,1]
v_pk_fma_f32 v[206:207], v[146:147], v[26:27], v[206:207] op_sel_hi:[1,0,1]
v_pk_fma_f32 v[220:221], v[12:13], v[26:27], v[220:221] op_sel_hi:[1,0,1]
v_pk_fma_f32 v[222:223], v[14:15], v[26:27], v[222:223] op_sel_hi:[1,0,1]
v_pk_mul_f32 v[204:205], v[204:205], v[172:173]
v_pk_mul_f32 v[172:173], v[172:173], v[30:31] op_sel:[0,1] op_sel_hi:[1,1]
v_pk_mul_f32 v[206:207], v[206:207], v[174:175]
v_pk_mul_f32 v[174:175], v[174:175], v[30:31] op_sel:[0,1] op_sel_hi:[1,1]
v_pk_mul_f32 v[220:221], v[220:221], v[188:189]
v_pk_mul_f32 v[188:189], v[188:189], v[30:31] op_sel:[0,1] op_sel_hi:[1,1]
v_pk_mul_f32 v[222:223], v[222:223], v[190:191]
v_pk_mul_f32 v[190:191], v[190:191], v[30:31] op_sel:[0,1] op_sel_hi:[1,1]
v_pk_fma_f32 v[168:169], v[168:169], v[24:25], v[24:25] op_sel:[0,1,1] op_sel_hi:[1,1,1]
v_pk_fma_f32 v[170:171], v[170:171], v[24:25], v[24:25] op_sel:[0,1,1] op_sel_hi:[1,1,1]
v_pk_fma_f32 v[184:185], v[184:185], v[24:25], v[24:25] op_sel:[0,1,1] op_sel_hi:[1,1,1]
v_pk_fma_f32 v[186:187], v[186:187], v[24:25], v[24:25] op_sel:[0,1,1] op_sel_hi:[1,1,1]
v_cvt_pk_bf16_f32 v164, v196, v197
v_cvt_pk_bf16_f32 v165, v198, v199
v_cvt_pk_bf16_f32 v166, v212, v213
v_cvt_pk_bf16_f32 v167, v214, v215
MAA 240,64,128
buffer_store_dwordx4 v[164:167], v10, s[16:19], s64 offen offset:1024 sc1
MAA 240,68,144
.Lpad17:
s_cbranch_execz .Lpad20
v_rcp_f32 v168, v168
MAA 240,96,160
v_rcp_f32 v169, v169
MAA 240,100,176
v_rcp_f32 v170, v170
MAA 248,108,176
buffer_atomic_add v85, v69, s[16:19], s73 offen offset:512 sc0
MAA 248,104,160
v_rcp_f32 v171, v171
MAA 248,76,144
v_rcp_f32 v184, v184
MAA 248,72,128
v_rcp_f32 v185, v185
MAA 224,80,160
buffer_load_dwordx4 v19, s[28:31], s58 offen offset:1056 lds
MAA 224,84,176
v_rcp_f32 v186, v186
MAA 232,92,176
v_rcp_f32 v187, v187
MAA 232,88,160
v_exp_f32 v172, v172
v_exp_f32 v173, v173
v_exp_f32 v174, v174
v_exp_f32 v175, v175
v_exp_f32 v188, v188
v_exp_f32 v189, v189
v_exp_f32 v190, v190
v_exp_f32 v191, v191
v_pk_mul_f32 v[200:201], v[200:201], v[168:169]
v_pk_mul_f32 v[202:203], v[202:203], v[170:171]
v_pk_mul_f32 v[216:217], v[216:217], v[184:185]
v_pk_mul_f32 v[218:219], v[218:219], v[186:187]
s_waitcnt lgkmcnt(2)
v_pk_fma_f32 v[224:225], v[176:177], v[20:21], v[224:225] op_sel_hi:[1,0,1]
v_pk_fma_f32 v[226:227], v[178:179], v[20:21], v[226:227] op_sel_hi:[1,0,1]
s_waitcnt lgkmcnt(1)
v_pk_fma_f32 v[232:233], v[192:193], v[20:21], v[232:233] op_sel_hi:[1,0,1]
v_pk_fma_f32 v[234:235], v[194:195], v[20:21], v[234:235] op_sel_hi:[1,0,1]
s_waitcnt lgkmcnt(0)
v_pk_fma_f32 v[240:241], v[208:209], v[20:21], v[240:241] op_sel_hi:[1,0,1]
v_pk_fma_f32 v[242:243], v[210:211], v[20:21], v[242:243] op_sel_hi:[1,0,1]
v_pk_fma_f32 v[248:249], v[52:53], v[20:21], v[248:249] op_sel_hi:[1,0,1]
v_pk_fma_f32 v[250:251], v[54:55], v[20:21], v[250:251] op_sel_hi:[1,0,1]
v_pk_mul_f32 v[240:241], v[240:241], v[224:225]
v_pk_mul_f32 v[224:225], v[224:225], v[28:29] op_sel_hi:[1,0]
v_pk_mul_f32 v[242:243], v[242:243], v[226:227]
v_pk_mul_f32 v[226:227], v[226:227], v[28:29] op_sel_hi:[1,0]
v_pk_mul_f32 v[248:249], v[248:249], v[232:233]
v_pk_mul_f32 v[232:233], v[232:233], v[28:29] op_sel_hi:[1,0]
v_pk_mul_f32 v[250:251], v[250:251], v[234:235]
v_pk_mul_f32 v[234:235], v[234:235], v[28:29] op_sel_hi:[1,0]
v_pk_fma_f32 v[172:173], v[172:173], v[26:27], v[26:27] op_sel:[0,1,1] op_sel_hi:[1,1,1]
v_pk_fma_f32 v[174:175], v[174:175], v[26:27], v[26:27] op_sel:[0,1,1] op_sel_hi:[1,1,1]
v_pk_fma_f32 v[188:189], v[188:189], v[26:27], v[26:27] op_sel:[0,1,1] op_sel_hi:[1,1,1]
v_pk_fma_f32 v[190:191], v[190:191], v[26:27], v[26:27] op_sel:[0,1,1] op_sel_hi:[1,1,1]
v_cvt_pk_bf16_f32 v168, v200, v201
v_cvt_pk_bf16_f32 v169, v202, v203
v_cvt_pk_bf16_f32 v170, v216, v217
v_cvt_pk_bf16_f32 v171, v218, v219
buffer_store_dwordx4 v[168:171], v11, s[16:19], s64 offen sc1
buffer_atomic_add v86, v69, s[16:19], s73 offen offset:512 sc0
s_waitcnt vmcnt(6)
v_cmp_gt_u32 vcc, v70, v84
s_nop 0
s_cbranch_vccz .Lok49
s_waitcnt vmcnt(3)
v_cmp_gt_u32 vcc, v70, v85
s_nop 0
s_cbranch_vccz .Lok49
s_waitcnt vmcnt(0)
v_cmp_gt_u32 vcc, v70, v86
s_nop 0
s_cbranch_vccz .Lok49
s_mov_b32 s15, 0
.Lok49l:
v_mov_b32 v84, 0
buffer_atomic_add v84, v69, s[16:19], s73 offen offset:512 sc0
s_add_u32 s15, s15, 1
s_cmp_gt_u32 s15, 100000
s_waitcnt vmcnt(0)
s_cbranch_scc1 .Lok49
v_cmp_gt_u32 vcc, v70, v84
s_nop 0
s_cbranch_vccnz .Lok49l
.Lok49:
s_waitcnt vmcnt(2)
s_barrier
MAA 244,64,132
ds_read_b64_tr_b16 a[0:1], v7
s_add_u32 s52, s76, 0
MAA 244,68,148
buffer_load_dwordx4 v[96:99], v4, s[16:19], s52 offen sc1
MAA 244,96,164
TR 2,7,512
v_rcp_f32 v172, v172
MAA 244,100,180
TR 4,7,32
v_rcp_f32 v173, v173
MAA 252,108,180
TR 6,7,544
v_rcp_f32 v174, v174
MAA 252,104,164
buffer_load_dwordx4 v[100:103], v4, s[16:19], s52 offen offset:1024 sc1
MAA 252,76,148
TR 8,7,64
s_add_u32 s52, s76, 65536
MAA 252,72,132
TR 10,7,576
v_rcp_f32 v175, v175
MAA 228,80,164
TR 12,7,96
v_rcp_f32 v188, v188
MAA 228,84,180
buffer_load_dwordx4 v[104:107], v4, s[16:19], s52 offen sc1
MAA 236,92,180
TR 14,7,608
v_rcp_f32 v189, v189
MAA 236,88,164
TR 16,7,8448
v_rcp_f32 v190, v190
v_rcp_f32 v191, v191
v_exp_f32 v224, v224
v_exp_f32 v225, v225
v_exp_f32 v226, v226
v_exp_f32 v227, v227
v_exp_f32 v232, v232
v_exp_f32 v233, v233
v_exp_f32 v234, v234
v_exp_f32 v235, v235
v_pk_mul_f32 v[204:205], v[204:205], v[172:173]
buffer_load_dwordx4 v[108:111], v4, s[16:19], s52 offen offset:1024 sc1
s_add_u32 s52, s77, 114688
v_pk_mul_f32 v[206:207], v[206:207], v[174:175]
v_pk_mul_f32 v[220:221], v[220:221], v[188:189]
v_pk_mul_f32 v[222:223], v[222:223], v[190:191]
v_pk_fma_f32 v[228:229], v[176:177], v[22:23], v[228:229] op_sel_hi:[1,0,1]
v_pk_fma_f32 v[230:231], v[178:179], v[22:23], v[230:231] op_sel_hi:[1,0,1]
v_pk_fma_f32 v[236:237], v[192:193], v[22:23], v[236:237] op_sel_hi:[1,0,1]
v_pk_fma_f32 v[238:239], v[194:195], v[22:23], v[238:239] op_sel_hi:[1,0,1]
v_pk_fma_f32 v[244:245], v[208:209], v[22:23], v[244:245] op_sel_hi:[1,0,1]
v_pk_fma_f32 v[246:247], v[210:211], v[22:23], v[246:247] op_sel_hi:[1,0,1]
v_pk_fma_f32 v[252:253], v[52:53], v[22:23], v[252:253] op_sel_hi:[1,0,1]
v_pk_fma_f32 v[254:255], v[54:55], v[22:23], v[254:255] op_sel_hi:[1,0,1]
v_pk_mul_f32 v[244:245], v[244:245], v[228:229]
buffer_load_dwordx4 v[112:115], v4, s[16:19], s52 offen sc1
v_pk_mul_f32 v[228:229], v[228:229], v[28:29] op_sel:[0,1] op_sel_hi:[1,1]
v_pk_mul_f32 v[246:247], v[246:247], v[230:231]
v_pk_mul_f32 v[230:231], v[230:231], v[28:29] op_sel:[0,1] op_sel_hi:[1,1]
v_pk_mul_f32 v[252:253], v[252:253], v[236:237]
v_pk_mul_f32 v[236:237], v[236:237], v[28:29] op_sel:[0,1] op_sel_hi:[1,1]
v_pk_mul_f32 v[254:255], v[254:255], v[238:239]
v_pk_mul_f32 v[238:239], v[238:239], v[28:29] op_sel:[0,1] op_sel_hi:[1,1]
v_pk_fma_f32 v[224:225], v[224:225], v[20:21], v[20:21] op_sel:[0,1,1] op_sel_hi:[1,1,1]
v_pk_fma_f32 v[226:227], v[226:227], v[20:21], v[20:21] op_sel:[0,1,1] op_sel_hi:[1,1,1]
v_pk_fma_f32 v[232:233], v[232:233], v[20:21], v[20:21] op_sel:[0,1,1] op_sel_hi:[1,1,1]
v_pk_fma_f32 v[234:235], v[234:235], v[20:21], v[20:21] op_sel:[0,1,1] op_sel_hi:[1,1,1]
v_cvt_pk_bf16_f32 v172, v204, v205
v_cvt_pk_bf16_f32 v173, v206, v207
buffer_load_dwordx4 v[116:119], v4, s[16:19], s52 offen offset:1024 sc1
s_add_u32 s52, s77, 180224
v_cvt_pk_bf16_f32 v174, v220, v221
v_cvt_pk_bf16_f32 v175, v222, v223
TR 18,7,8960
TR 20,7,8480
TR 22,7,8992
TR 24,7,8512
TR 26,7,9024
buffer_store_dwordx4 v[172:175], v11, s[16:19], s64 offen offset:1024 sc1
TR 28,7,8544
TR 30,7,9056
v_rcp_f32 v224, v224
v_rcp_f32 v225, v225
v_rcp_f32 v226, v226
v_rcp_f32 v227, v227
v_rcp_f32 v232, v232
v_rcp_f32 v233, v233
v_rcp_f32 v234, v234
v_rcp_f32 v235, v235
v_exp_f32 v228, v228
v_exp_f32 v229, v229
v_exp_f32 v230, v230
v_exp_f32 v231, v231
v_exp_f32 v236, v236
v_exp_f32 v237, v237
v_exp_f32 v238, v238
v_exp_f32 v239, v239
v_pk_mul_f32 v[240:241], v[240:241], v[224:225]
buffer_load_dwordx4 v[120:123], v4, s[16:19], s52 offen sc1
v_pk_mul_f32 v[242:243], v[242:243], v[226:227]
v_pk_mul_f32 v[248:249], v[248:249], v[232:233]
v_pk_mul_f32 v[250:251], v[250:251], v[234:235]
v_pk_fma_f32 v[228:229], v[228:229], v[22:23], v[22:23] op_sel:[0,1,1] op_sel_hi:[1,1,1]
v_pk_fma_f32 v[230:231], v[230:231], v[22:23], v[22:23] op_sel:[0,1,1] op_sel_hi:[1,1,1]
v_pk_fma_f32 v[236:237], v[236:237], v[22:23], v[22:23] op_sel:[0,1,1] op_sel_hi:[1,1,1]
v_pk_fma_f32 v[238:239], v[238:239], v[22:23], v[22:23] op_sel:[0,1,1] op_sel_hi:[1,1,1]
v_cvt_pk_bf16_f32 v224, v240, v241
v_cvt_pk_bf16_f32 v225, v242, v243
v_cvt_pk_bf16_f32 v226, v248, v249
v_cvt_pk_bf16_f32 v227, v250, v251
v_rcp_f32 v228, v228
v_rcp_f32 v229, v229
v_rcp_f32 v230, v230
v_rcp_f32 v231, v231
v_rcp_f32 v236, v236
v_rcp_f32 v237, v237
v_rcp_f32 v238, v238
v_rcp_f32 v239, v239
v_pk_mul_f32 v[244:245], v[244:245], v[228:229]
buffer_store_dwordx4 v[224:227], v10, s[16:19], s65 offen sc1
v_pk_mul_f32 v[246:247], v[246:247], v[230:231]
v_pk_mul_f32 v[252:253], v[252:253], v[236:237]
v_pk_mul_f32 v[254:255], v[254:255], v[238:239]
v_cvt_pk_bf16_f32 v228, v244, v245
v_cvt_pk_bf16_f32 v229, v246, v247
v_cvt_pk_bf16_f32 v230, v252, v253
v_cvt_pk_bf16_f32 v231, v254, v255
buffer_store_dwordx4 v[228:231], v10, s[16:19], s65 offen offset:1024 sc1
buffer_load_dwordx4 v[124:127], v4, s[16:19], s52 offen offset:1024 sc1
v_mov_b32 v21, v68
v_mov_b32 v22, v69
v_mov_b32 v23, v70
v_mov_b32 v24, v71
v_mov_b32 v25, 0
s_waitcnt vmcnt(7) lgkmcnt(0)
s_barrier
v_mfma_f32_16x16x32_bf16 v[32:35], a[0:3], v[96:99], 0
ds_read_b64_tr_b16 a[32:33], v6
s_add_u32 s52, s78, 229376
MAV 32,16,104
buffer_load_dwordx4 v[128:131], v4, s[16:19], s52 offen sc1
v_mfma_f32_16x16x32_bf16 v[48:51], a[0:3], v[100:103], 0
TR 34,6,512
MAV 48,16,108
TR 36,6,32
TR 38,6,544
v_mfma_f32_16x16x32_bf16 v[52:55], a[4:7], v[100:103], 0
TR 48,6,8448
MAV 52,20,108
buffer_load_dwordx4 v[132:135], v4, s[16:19], s52 offen offset:1024 sc1
v_mfma_f32_16x16x32_bf16 v[36:39], a[4:7], v[96:99], 0
TR 50,6,8960
MAV 36,20,104
TR 52,6,8480
TR 54,6,8992
v_mfma_f32_16x16x32_bf16 v[40:43], a[8:11], v[96:99], 0
TR 40,6,64
s_add_u32 s52, s78, 294912
MAV 40,24,104
buffer_load_dwordx4 v[136:139], v4, s[16:19], s52 offen sc1
v_mfma_f32_16x16x32_bf16 v[56:59], a[8:11], v[100:103], 0
TR 42,6,576
MAV 56,24,108
TR 44,6,96
TR 46,6,608
v_mfma_f32_16x16x32_bf16 v[60:63], a[12:15], v[100:103], 0
TR 56,6,8512
MAV 60,28,108
buffer_load_dwordx4 v[140:143], v4, s[16:19], s52 offen offset:1024 sc1
v_mfma_f32_16x16x32_bf16 v[44:47], a[12:15], v[96:99], 0
TR 58,6,9024
MAV 44,28,104
TR 60,6,8544
TR 62,6,9056
s_waitcnt lgkmcnt(8)
v_mfma_f32_16x16x32_bf16 v[64:67], a[32:35], v[96:99], 0
TR 0,7,16896
s_add_u32 s52, s79, 344064
MAV 64,48,104
buffer_load_dwordx4 v[144:147], v4, s[16:19], s52 offen sc1
v_mfma_f32_16x16x32_bf16 v[80:83], a[32:35], v[100:103], 0
TR 2,7,17408
MAV 80,48,108
TR 4,7,16928
TR 6,7,17440
v_mfma_f32_16x16x32_bf16 v[84:87], a[36:39], v[100:103], 0
TR 16,7,25344
MAV 84,52,108
buffer_load_dwordx4 v[148:151], v4, s[16:19], s52 offen offset:1024 sc1
v_mfma_f32_16x16x32_bf16 v[68:71], a[36:39], v[96:99], 0
TR 18,7,25856
MAV 68,52,104
TR 20,7,25376
TR 22,7,25888
s_waitcnt lgkmcnt(8)
v_mfma_f32_16x16x32_bf16 v[72:75], a[40:43], v[96:99], 0
TR 8,7,16960
s_add_u32 s52, s79, 409600
MAV 72,56,104
buffer_load_dwordx4 v[152:155], v4, s[16:19], s52 offen sc1
v_mfma_f32_16x16x32_bf16 v[88:91], a[40:43], v[100:103], 0
TR 10,7,17472
MAV 88,56,108
TR 12,7,16992
TR 14,7,17504
v_mfma_f32_16x16x32_bf16 v[92:95], a[44:47], v[100:103], 0
TR 24,7,25408
MAV 92,60,108
buffer_load_dwordx4 v[156:159], v4, s[16:19], s52 offen offset:1024 sc1
v_mfma_f32_16x16x32_bf16 v[76:79], a[44:47], v[96:99], 0
TR 26,7,25920
MAV 76,60,104
TR 28,7,25440
TR 30,7,25952
s_waitcnt vmcnt(8) lgkmcnt(8)
s_barrier
MAV 32,0,112
TR 32,6,16896
s_add_u32 m0, s55, 0
MAV 32,16,120
buffer_load_dwordx4 v18, s[28:31], s54 offen lds
MAV 48,16,124
TR 34,6,17408
MAV 48,0,116
TR 36,6,16928
TR 38,6,17440
MAV 52,4,116
TR 48,6,25344
s_add_u32 s52, s76, 458752
MAV 52,20,124
buffer_load_dwordx4 v[96:99], v4, s[16:19], s52 offen sc1
MAV 36,20,120
TR 50,6,25856
MAV 36,4,112
TR 52,6,25376
TR 54,6,25888
s_waitcnt lgkmcnt(8)
MAV 40,8,112
TR 40,6,16960
MAV 40,24,120
buffer_load_dwordx4 v19, s[28:31], s54 offen offset:1056 lds
MAV 56,24,124
TR 42,6,17472
s_add_u32 s54, s98, 327680
MAV 56,8,116
TR 44,6,16992
TR 46,6,17504
MAV 60,12,116
TR 56,6,25408
MAV 60,28,124
buffer_load_dwordx4 v[100:103], v4, s[16:19], s52 offen offset:1024 sc1
MAV 44,28,120
TR 58,6,25920
MAV 44,12,112
TR 60,6,25440
TR 62,6,25952
s_waitcnt lgkmcnt(8)
MAV 64,32,112
TR 0,7,33792
s_add_u32 m0, s55, 8448
MAV 64,48,120
buffer_load_dwordx4 v18, s[28:31], s54 offen lds
MAV 80,48,124
TR 2,7,34304
MAV 80,32,116
TR 4,7,33824
TR 6,7,34336
MAV 84,36,116
TR 16,7,42240
s_add_u32 s52, s76, 524288
MAV 84,52,124
buffer_load_dwordx4 v[104:107], v4, s[16:19], s52 offen sc1
MAV 68,52,120
TR 18,7,42752
MAV 68,36,112
TR 20,7,42272
TR 22,7,42784
s_waitcnt lgkmcnt(8)
MAV 72,40,112
TR 8,7,33856
MAV 72,56,120
buffer_load_dwordx4 v19, s[28:31], s54 offen offset:1056 lds
MAV 88,56,124
TR 10,7,34368
s_add_u32 s54, s99, 524288
MAV 88,40,116
TR 12,7,33888
TR 14,7,34400
MAV 92,44,116
TR 24,7,42304
MAV 92,60,124
buffer_load_dwordx4 v[108:111], v4, s[16:19], s52 offen offset:1024 sc1
MAV 76,60,120
TR 26,7,42816
MAV 76,44,112
TR 28,7,42336
TR 30,7,42848
s_waitcnt vmcnt(12) lgkmcnt(8)
s_barrier
MAV 32,0,128
TR 32,6,33792
MAV 32,16,136
buffer_atomic_add v24, v21, s[16:19], s72 offen
MAV 48,16,140
TR 34,6,34304
MAV 48,0,132
TR 36,6,33824
TR 38,6,34336
TR 48,6,42240
MAV 52,4,132
TR 50,6,42752
s_add_u32 m0, s55, 16896
MAV 52,20,140
buffer_load_dwordx4 v18, s[28:31], s54 offen lds
MAV 36,20,136
TR 52,6,42272
MAV 36,4,128
TR 54,6,42784
TR 40,6,33856
s_waitcnt lgkmcnt(9)
MAV 40,8,128
TR 42,6,34368
s_add_u32 s52, s77, 573440
MAV 40,24,136
buffer_load_dwordx4 v[112:115], v4, s[16:19], s52 offen sc1
MAV 56,24,140
TR 44,6,33888
MAV 56,8,132
buffer_load_dwordx4 v19, s[28:31], s54 offen offset:1056 lds
MAV 60,12,132
TR 46,6,34400
s_add_u32 s54, s99, 786432
MAV 60,28,140
buffer_load_dwordx4 v[116:119], v4, s[16:19], s52 offen offset:1024 sc1
MAV 44,28,136
TR 56,6,42304
MAV 44,12,128
TR 58,6,42816
TR 60,6,42336
TR 62,6,42848
s_waitcnt lgkmcnt(8)
MAV 64,32,128
TR 0,7,50688
s_add_u32 m0, s55, 25344
MAV 64,48,136
buffer_load_dwordx4 v18, s[28:31], s54 offen lds
MAV 80,48,140
TR 2,7,51200
MAV 80,32,132
TR 4,7,50720
TR 6,7,51232
MAV 84,36,132
TR 16,7,59136
s_add_u32 s52, s77, 638976
MAV 84,52,140
buffer_load_dwordx4 v[120:123], v4, s[16:19], s52 offen sc1
MAV 68,52,136
TR 18,7,59648
MAV 68,36,128
TR 20,7,59168
TR 22,7,59680
s_waitcnt lgkmcnt(8)
MAV 72,40,128
TR 8,7,50752
MAV 72,56,136
buffer_load_dwordx4 v19, s[28:31], s54 offen offset:1056 lds
MAV 88,56,140
TR 10,7,51264
s_add_u32 s54, s100, 983040
MAV 88,40,132
TR 12,7,50784
TR 14,7,51296
MAV 92,44,132
TR 24,7,59200
MAV 92,60,140
buffer_load_dwordx4 v[124:127], v4, s[16:19], s52 offen offset:1024 sc1
MAV 76,60,136
TR 26,7,59712
MAV 76,44,128
TR 28,7,59232
TR 30,7,59744
s_waitcnt vmcnt(17) lgkmcnt(8)
s_barrier
MAV 32,0,144
TR 32,6,50688
s_add_u32 m0, s55, 33792
MAV 32,16,152
buffer_load_dwordx4 v18, s[28:31], s54 offen lds
MAV 48,16,156
TR 34,6,51200
MAV 48,0,148
TR 36,6,50720
TR 38,6,51232
MAV 52,4,148
TR 48,6,59136
s_add_u32 s52, s78, 688128
MAV 52,20,156
buffer_load_dwordx4 v[128:131], v4, s[16:19], s52 offen sc1
MAV 36,20,152
TR 50,6,59648
MAV 36,4,144
TR 52,6,59168
TR 54,6,59680
s_waitcnt lgkmcnt(8)
MAV 40,8,144
TR 40,6,50752
MAV 40,24,152
buffer_load_dwordx4 v19, s[28:31], s54 offen offset:1056 lds
MAV 56,24,156
TR 42,6,51264
s_add_u32 s54, s100, 1245184
MAV 56,8,148
TR 44,6,50784
TR 46,6,51296
MAV 60,12,148
TR 56,6,59200
MAV 60,28,156
buffer_load_dwordx4 v[132:135], v4, s[16:19], s52 offen offset:1024 sc1
MAV 44,28,152
TR 58,6,59712
MAV 44,12,144
TR 60,6,59232
TR 62,6,59744
v_add_u32 v7, s57, v7
v_add_u32 v6, s57, v6
s_sub_u32 s57, 0, s57
s_waitcnt lgkmcnt(8)
MAV 64,32,144
ds_read_b64_tr_b16 a[0:1], v7
s_add_u32 m0, s55, 42240
MAV 64,48,152
buffer_load_dwordx4 v18, s[28:31], s54 offen lds
MAV 80,48,156
TR 2,7,512
MAV 80,32,148
TR 4,7,32
TR 6,7,544
TR 16,7,8448
MAV 84,36,148
TR 18,7,8960
s_add_u32 s52, s78, 753664
MAV 84,52,156
buffer_load_dwordx4 v[136:139], v4, s[16:19], s52 offen sc1
MAV 68,52,152
TR 20,7,8480
MAV 68,36,144
TR 22,7,8992
TR 8,7,64
s_waitcnt lgkmcnt(9)
MAV 72,40,144
TR 10,7,576
MAV 72,56,152
buffer_load_dwordx4 v19, s[28:31], s54 offen offset:1056 lds
MAV 88,56,156
TR 12,7,96
s_add_u32 s54, s101, 1441792
MAV 88,40,148
buffer_load_dwordx4 v[140:143], v4, s[16:19], s52 offen offset:1024 sc1
MAV 92,44,148
TR 14,7,608
MAV 92,60,156
buffer_atomic_add v25, v22, s[16:19], s73 offen sc0
MAV 76,60,152
TR 24,7,8512
MAV 76,44,144
TR 26,7,9024
TR 28,7,8544
TR 30,7,9056
s_waitcnt vmcnt(18) lgkmcnt(8)
s_barrier
MAV 32,0,96
ds_read_b64_tr_b16 a[32:33], v6
s_add_u32 m0, s55, 50688
MAV 32,16,104
buffer_load_dwordx4 v18, s[28:31], s54 offen lds
MAV 48,16,108
TR 34,6,512
MAV 48,0,100
TR 36,6,32
TR 38,6,544
MAV 52,4,100
.Lpad18:
s_cbranch_execz .Lpad21
TR 48,6,8448
s_add_u32 s52, s79, 802816
MAV 52,20,108
buffer_load_dwordx4 v[144:147], v4, s[16:19], s52 offen sc1
MAV 36,20,104
TR 50,6,8960
MAV 36,4,96
TR 52,6,8480
TR 54,6,8992
s_waitcnt lgkmcnt(8)
MAV 40,8,96
TR 40,6,64
MAV 40,24,104
buffer_load_dwordx4 v19, s[28:31], s54 offen offset:1056 lds
MAV 56,24,108
TR 42,6,576
s_add_u32 s54, s101, 1703936
MAV 56,8,100
TR 44,6,96
TR 46,6,608
MAV 60,12,100
TR 56,6,8512
MAV 60,28,108
buffer_load_dwordx4 v[148:151], v4, s[16:19], s52 offen offset:1024 sc1
MAV 44,28,104
TR 58,6,9024
MAV 44,12,96
TR 60,6,8544
TR 62,6,9056
s_waitcnt lgkmcnt(8)
MAV 64,32,96
TR 0,7,16896
s_add_u32 m0, s55, 59136
MAV 64,48,104
buffer_load_dwordx4 v18, s[28:31], s54 offen lds
MAV 80,48,108
TR 2,7,17408
MAV 80,32,100
TR 4,7,16928
TR 6,7,17440
MAV 84,36,100
TR 16,7,25344
s_add_u32 s52, s79, 868352
MAV 84,52,108
buffer_load_dwordx4 v[152:155], v4, s[16:19], s52 offen sc1
MAV 68,52,104
TR 18,7,25856
MAV 68,36,96
TR 20,7,25376
TR 22,7,25888
s_waitcnt lgkmcnt(8)
MAV 72,40,96
TR 8,7,16960
MAV 72,56,104
buffer_load_dwordx4 v19, s[28:31], s54 offen offset:1056 lds
MAV 88,56,108
TR 10,7,17472
s_add_u32 s54, s98, 1900544
MAV 88,40,100
TR 12,7,16992
TR 14,7,17504
MAV 92,44,100
TR 24,7,25408
MAV 92,60,108
buffer_load_dwordx4 v[156:159], v4, s[16:19], s52 offen offset:1024 sc1
MAV 76,60,104
TR 26,7,25920
MAV 76,44,96
TR 28,7,25440
TR 30,7,25952
s_waitcnt vmcnt(8)
v_cmp_gt_u32 vcc, v23, v25
s_nop 0
s_cbranch_vccnz .Lsp50
.Lsp50b:
s_waitcnt lgkmcnt(8)
s_barrier
MAV 32,0,112
TR 32,6,16896
s_add_u32 m0, s55, 67584
MAV 32,16,120
buffer_load_dwordx4 v18, s[28:31], s54 offen lds
MAV 48,16,124
TR 34,6,17408
MAV 48,0,116
TR 36,6,16928
TR 38,6,17440
MAV 52,4,116
TR 48,6,25344
s_add_u32 s52, s76, 16384
MAV 52,20,124
buffer_load_dwordx4 v[96:99], v4, s[16:19], s52 offen sc1
MAV 36,20,120
TR 50,6,25856
MAV 36,4,112
TR 52,6,25376
TR 54,6,25888
s_waitcnt lgkmcnt(8)
MAV 40,8,112
TR 40,6,16960
MAV 40,24,120
buffer_load_dwordx4 v19, s[28:31], s54 offen offset:1056 lds
MAV 56,24,124
TR 42,6,17472
s_add_u32 s54, s98, 2162688
MAV 56,8,116
TR 44,6,16992
TR 46,6,17504
MAV 60,12,116
TR 56,6,25408
MAV 60,28,124
buffer_load_dwordx4 v[100:103], v4, s[16:19], s52 offen offset:1024 sc1
MAV 44,28,120
TR 58,6,25920
MAV 44,12,112
TR 60,6,25440
TR 62,6,25952
s_waitcnt lgkmcnt(8)
MAV 64,32,112
TR 0,7,33792
s_add_u32 m0, s55, 76032
MAV 64,48,120
buffer_load_dwordx4 v18, s[28:31], s54 offen lds
MAV 80,48,124
TR 2,7,34304
MAV 80,32,116
TR 4,7,33824
TR 6,7,34336
MAV 84,36,116
TR 16,7,42240
s_add_u32 s52, s76, 81920
MAV 84,52,124
buffer_load_dwordx4 v[104:107], v4, s[16:19], s52 offen sc1
MAV 68,52,120
TR 18,7,42752
MAV 68,36,112
TR 20,7,42272
TR 22,7,42784
s_waitcnt lgkmcnt(8)
MAV 72,40,112
TR 8,7,33856
MAV 72,56,120
buffer_load_dwordx4 v19, s[28:31], s54 offen offset:1056 lds
MAV 88,56,124
TR 10,7,34368
s_add_u32 s54, s99, 2359296
MAV 88,40,116
TR 12,7,33888
TR 14,7,34400
MAV 92,44,116
TR 24,7,42304
MAV 92,60,124
buffer_load_dwordx4 v[108:111], v4, s[16:19], s52 offen offset:1024 sc1
MAV 76,60,120
TR 26,7,42816
MAV 76,44,112
TR 28,7,42336
TR 30,7,42848
s_waitcnt lgkmcnt(8)
s_barrier
MAV 32,0,128
TR 32,6,33792
s_add_u32 m0, s55, 84480
MAV 32,16,136
buffer_load_dwordx4 v18, s[28:31], s54 offen lds
MAV 48,16,140
TR 34,6,34304
MAV 48,0,132
TR 36,6,33824
TR 38,6,34336
MAV 52,4,132
TR 48,6,42240
s_add_u32 s52, s77, 131072
MAV 52,20,140
buffer_load_dwordx4 v[112:115], v4, s[16:19], s52 offen sc1
MAV 36,20,136
TR 50,6,42752
MAV 36,4,128
TR 52,6,42272
TR 54,6,42784
s_waitcnt lgkmcnt(8)
MAV 40,8,128
TR 40,6,33856
MAV 40,24,136
buffer_load_dwordx4 v19, s[28:31], s54 offen offset:1056 lds
MAV 56,24,140
TR 42,6,34368
s_add_u32 s54, s99, 2621440
MAV 56,8,132
TR 44,6,33888
TR 46,6,34400
MAV 60,12,132
TR 56,6,42304
MAV 60,28,140
buffer_load_dwordx4 v[116:119], v4, s[16:19], s52 offen offset:1024 sc1
MAV 44,28,136
TR 58,6,42816
MAV 44,12,128
TR 60,6,42336
TR 62,6,42848
s_waitcnt lgkmcnt(8)
MAV 64,32,128
TR 0,7,50688
s_add_u32 m0, s55, 92928
MAV 64,48,136
buffer_load_dwordx4 v18, s[28:31], s54 offen lds
MAV 80,48,140
TR 2,7,51200
MAV 80,32,132
TR 4,7,50720
TR 6,7,51232
MAV 84,36,132
TR 16,7,59136
s_add_u32 s52, s77, 196608
MAV 84,52,140
buffer_load_dwordx4 v[120:123], v4, s[16:19], s52 offen sc1
MAV 68,52,136
TR 18,7,59648
MAV 68,36,128
TR 20,7,59168
TR 22,7,59680
s_waitcnt lgkmcnt(8)
MAV 72,40,128
TR 8,7,50752
MAV 72,56,136
buffer_load_dwordx4 v19, s[28:31], s54 offen offset:1056 lds
MAV 88,56,140
TR 10,7,51264
s_add_u32 s54, s100, 2818048
MAV 88,40,132
TR 12,7,50784
TR 14,7,51296
MAV 92,44,132
TR 24,7,59200
MAV 92,60,140
buffer_load_dwordx4 v[124:127], v4, s[16:19], s52 offen offset:1024 sc1
MAV 76,60,136
TR 26,7,59712
MAV 76,44,128
TR 28,7,59232
TR 30,7,59744
s_waitcnt vmcnt(16) lgkmcnt(8)
s_barrier
MAV 32,0,144
TR 32,6,50688
s_add_u32 m0, s55, 101376
MAV 32,16,152
buffer_load_dwordx4 v18, s[28:31], s54 offen lds
MAV 48,16,156
TR 34,6,51200
MAV 48,0,148
TR 36,6,50720
TR 38,6,51232
MAV 52,4,148
TR 48,6,59136
s_add_u32 s52, s78, 245760
MAV 52,20,156
buffer_load_dwordx4 v[128:131], v4, s[16:19], s52 offen sc1
MAV 36,20,152
TR 50,6,59648
MAV 36,4,144
TR 52,6,59168
TR 54,6,59680
s_waitcnt lgkmcnt(8)
MAV 40,8,144
TR 40,6,50752
MAV 40,24,152
buffer_load_dwordx4 v19, s[28:31], s54 offen offset:1056 lds
MAV 56,24,156
TR 42,6,51264
s_add_u32 s54, s100, 3080192
MAV 56,8,148
TR 44,6,50784
TR 46,6,51296
MAV 60,12,148
TR 56,6,59200
MAV 60,28,156
buffer_load_dwordx4 v[132:135], v4, s[16:19], s52 offen offset:1024 sc1
MAV 44,28,152
TR 58,6,59712
MAV 44,12,144
TR 60,6,59232
TR 62,6,59744
v_add_u32 v7, s57, v7
v_add_u32 v6, s57, v6
s_sub_u32 s57, 0, s57
s_waitcnt lgkmcnt(8)
MAV 64,32,144
ds_read_b64_tr_b16 a[0:1], v7
s_add_u32 m0, s55, 109824
MAV 64,48,152
buffer_load_dwordx4 v18, s[28:31], s54 offen lds
MAV 80,48,156
TR 2,7,512
MAV 80,32,148
TR 4,7,32
TR 6,7,544
MAV 84,36,148
TR 16,7,8448
s_add_u32 s52, s78, 311296
MAV 84,52,156
buffer_load_dwordx4 v[136:139], v4, s[16:19], s52 offen sc1
MAV 68,52,152
TR 18,7,8960
MAV 68,36,144
TR 20,7,8480
TR 22,7,8992
s_waitcnt lgkmcnt(8)
MAV 72,40,144
TR 8,7,64
MAV 72,56,152
buffer_load_dwordx4 v19, s[28:31], s54 offen offset:1056 lds
MAV 88,56,156
TR 10,7,576
s_add_u32 s54, s101, 3276800
MAV 88,40,148
TR 12,7,96
TR 14,7,608
MAV 92,44,148
TR 24,7,8512
MAV 92,60,156
buffer_load_dwordx4 v[140:143], v4, s[16:19], s52 offen offset:1024 sc1
MAV 76,60,152
TR 26,7,9024
MAV 76,44,144
TR 28,7,8544
TR 30,7,9056
s_waitcnt vmcnt(16) lgkmcnt(8)
s_barrier
MAV 32,0,96
ds_read_b64_tr_b16 a[32:33], v6
s_add_u32 m0, s55, 118272
MAV 32,16,104
buffer_load_dwordx4 v18, s[28:31], s54 offen lds
MAV 48,16,108
TR 34,6,512
MAV 48,0,100
TR 36,6,32
TR 38,6,544
MAV 52,4,100
TR 48,6,8448
s_add_u32 s52, s79, 360448
MAV 52,20,108
buffer_load_dwordx4 v[144:147], v4, s[16:19], s52 offen sc1
MAV 36,20,104
TR 50,6,8960
MAV 36,4,96
TR 52,6,8480
TR 54,6,8992
s_waitcnt lgkmcnt(8)
MAV 40,8,96
TR 40,6,64
MAV 40,24,104
buffer_load_dwordx4 v19, s[28:31], s54 offen offset:1056 lds
MAV 56,24,108
TR 42,6,576
s_add_u32 s54, s101, 3538944
MAV 56,8,100
TR 44,6,96
TR 46,6,608
MAV 60,12,100
TR 56,6,8512
MAV 60,28,108
buffer_load_dwordx4 v[148:151], v4, s[16:19], s52 offen offset:1024 sc1
MAV 44,28,104
TR 58,6,9024
MAV 44,12,96
TR 60,6,8544
TR 62,6,9056
s_waitcnt lgkmcnt(8)
MAV 64,32,96
TR 0,7,16896
s_add_u32 m0, s55, 126720
MAV 64,48,104
buffer_load_dwordx4 v18, s[28:31], s54 offen lds
MAV 80,48,108
TR 2,7,17408
MAV 80,32,100
TR 4,7,16928
TR 6,7,17440
MAV 84,36,100
TR 16,7,25344
s_add_u32 s52, s79, 425984
MAV 84,52,108
buffer_load_dwordx4 v[152:155], v4, s[16:19], s52 offen sc1
MAV 68,52,104
TR 18,7,25856
MAV 68,36,96
TR 20,7,25376
TR 22,7,25888
s_waitcnt lgkmcnt(8)
MAV 72,40,96
TR 8,7,16960
MAV 72,56,104
buffer_load_dwordx4 v19, s[28:31], s54 offen offset:1056 lds
MAV 88,56,108
TR 10,7,17472
s_add_u32 s54, s98, 131072
MAV 88,40,100
TR 12,7,16992
TR 14,7,17504
MAV 92,44,100
TR 24,7,25408
MAV 92,60,108
buffer_load_dwordx4 v[156:159], v4, s[16:19], s52 offen offset:1024 sc1
MAV 76,60,104
TR 26,7,25920
MAV 76,44,96
TR 28,7,25440
TR 30,7,25952
s_waitcnt vmcnt(16) lgkmcnt(8)
s_barrier
MAV 32,0,112
TR 32,6,16896
s_add_u32 m0, s55, 0
MAV 32,16,120
buffer_load_dwordx4 v18, s[28:31], s54 offen lds
MAV 48,16,124
TR 34,6,17408
MAV 48,0,116
TR 36,6,16928
TR 38,6,17440
MAV 52,4,116
TR 48,6,25344
s_add_u32 s52, s76, 475136
MAV 52,20,124
buffer_load_dwordx4 v[96:99], v4, s[16:19], s52 offen sc1
MAV 36,20,120
TR 50,6,25856
MAV 36,4,112
TR 52,6,25376
TR 54,6,25888
s_waitcnt lgkmcnt(8)
MAV 40,8,112
TR 40,6,16960
MAV 40,24,120
buffer_load_dwordx4 v19, s[28:31], s54 offen offset:1056 lds
MAV 56,24,124
TR 42,6,17472
s_add_u32 s54, s98, 393216
MAV 56,8,116
TR 44,6,16992
TR 46,6,17504
MAV 60,12,116
TR 56,6,25408
MAV 60,28,124
buffer_load_dwordx4 v[100:103], v4, s[16:19], s52 offen offset:1024 sc1
MAV 44,28,120
TR 58,6,25920
MAV 44,12,112
TR 60,6,25440
TR 62,6,25952
s_waitcnt lgkmcnt(8)
MAV 64,32,112
TR 0,7,33792
s_add_u32 m0, s55, 8448
MAV 64,48,120
buffer_load_dwordx4 v18, s[28:31], s54 offen lds
MAV 80,48,124
TR 2,7,34304
MAV 80,32,116
TR 4,7,33824
TR 6,7,34336
MAV 84,36,116
TR 16,7,42240
s_add_u32 s52, s76, 540672
MAV 84,52,124
buffer_load_dwordx4 v[104:107], v4, s[16:19], s52 offen sc1
MAV 68,52,120
TR 18,7,42752
MAV 68,36,112
TR 20,7,42272
TR 22,7,42784
s_waitcnt lgkmcnt(8)
MAV 72,40,112
TR 8,7,33856
MAV 72,56,120
buffer_load_dwordx4 v19, s[28:31], s54 offen offset:1056 lds
MAV 88,56,124
TR 10,7,34368
s_add_u32 s54, s99, 589824
MAV 88,40,116
TR 12,7,33888
TR 14,7,34400
MAV 92,44,116
TR 24,7,42304
MAV 92,60,124
buffer_load_dwordx4 v[108:111], v4, s[16:19], s52 offen offset:1024 sc1
MAV 76,60,120
TR 26,7,42816
MAV 76,44,112
TR 28,7,42336
TR 30,7,42848
s_waitcnt vmcnt(16) lgkmcnt(8)
s_barrier
MAV 32,0,128
TR 32,6,33792
s_add_u32 m0, s55, 16896
MAV 32,16,136
buffer_load_dwordx4 v18, s[28:31], s54 offen lds
MAV 48,16,140
TR 34,6,34304
MAV 48,0,132
TR 36,6,33824
TR 38,6,34336
MAV 52,4,132
TR 48,6,42240
s_add_u32 s52, s77, 589824
MAV 52,20,140
buffer_load_dwordx4 v[112:115], v4, s[16:19], s52 offen sc1
MAV 36,20,136
TR 50,6,42752
MAV 36,4,128
TR 52,6,42272
TR 54,6,42784
s_waitcnt lgkmcnt(8)
MAV 40,8,128
TR 40,6,33856
MAV 40,24,136
buffer_load_dwordx4 v19, s[28:31], s54 offen offset:1056 lds
MAV 56,24,140
TR 42,6,34368
s_add_u32 s54, s99, 851968
MAV 56,8,132
TR 44,6,33888
TR 46,6,34400
MAV 60,12,132
TR 56,6,42304
MAV 60,28,140
buffer_load_dwordx4 v[116:119], v4, s[16:19], s52 offen offset:1024 sc1
MAV 44,28,136
TR 58,6,42816
.Lpad19:
s_cbranch_execz .Lpad22
MAV 44,12,128
TR 60,6,42336
TR 62,6,42848
s_waitcnt lgkmcnt(8)
MAV 64,32,128
TR 0,7,50688
s_add_u32 m0, s55, 25344
MAV 64,48,136
buffer_load_dwordx4 v18, s[28:31], s54 offen lds
MAV 80,48,140
TR 2,7,51200
MAV 80,32,132
TR 4,7,50720
TR 6,7,51232
MAV 84,36,132
TR 16,7,59136
s_add_u32 s52, s77, 655360
MAV 84,52,140
buffer_load_dwordx4 v[120:123], v4, s[16:19], s52 offen sc1
MAV 68,52,136
TR 18,7,59648
MAV 68,36,128
TR 20,7,59168
TR 22,7,59680
s_waitcnt lgkmcnt(8)
MAV 72,40,128
TR 8,7,50752
MAV 72,56,136
buffer_load_dwordx4 v19, s[28:31], s54 offen offset:1056 lds
MAV 88,56,140
TR 10,7,51264
s_add_u32 s54, s100, 1048576
MAV 88,40,132
TR 12,7,50784
TR 14,7,51296
MAV 92,44,132
TR 24,7,59200
MAV 92,60,140
buffer_load_dwordx4 v[124:127], v4, s[16:19], s52 offen offset:1024 sc1
MAV 76,60,136
TR 26,7,59712
MAV 76,44,128
TR 28,7,59232
TR 30,7,59744
s_waitcnt vmcnt(16) lgkmcnt(8)
s_barrier
MAV 32,0,144
TR 32,6,50688
s_add_u32 m0, s55, 33792
MAV 32,16,152
buffer_load_dwordx4 v18, s[28:31], s54 offen lds
MAV 48,16,156
TR 34,6,51200
MAV 48,0,148
TR 36,6,50720
TR 38,6,51232
MAV 52,4,148
TR 48,6,59136
s_add_u32 s52, s78, 704512
MAV 52,20,156
buffer_load_dwordx4 v[128:131], v4, s[16:19], s52 offen sc1
MAV 36,20,152
TR 50,6,59648
MAV 36,4,144
TR 52,6,59168
TR 54,6,59680
s_waitcnt lgkmcnt(8)
MAV 40,8,144
TR 40,6,50752
MAV 40,24,152
buffer_load_dwordx4 v19, s[28:31], s54 offen offset:1056 lds
MAV 56,24,156
TR 42,6,51264
s_add_u32 s54, s100, 1310720
MAV 56,8,148
TR 44,6,50784
TR 46,6,51296
MAV 60,12,148
TR 56,6,59200
MAV 60,28,156
buffer_load_dwordx4 v[132:135], v4, s[16:19], s52 offen offset:1024 sc1
MAV 44,28,152
TR 58,6,59712
MAV 44,12,144
TR 60,6,59232
TR 62,6,59744
v_add_u32 v7, s57, v7
v_add_u32 v6, s57, v6
s_sub_u32 s57, 0, s57
s_waitcnt lgkmcnt(8)
MAV 64,32,144
ds_read_b64_tr_b16 a[0:1], v7
s_add_u32 m0, s55, 42240
MAV 64,48,152
buffer_load_dwordx4 v18, s[28:31], s54 offen lds
MAV 80,48,156
TR 2,7,512
MAV 80,32,148
TR 4,7,32
TR 6,7,544
MAV 84,36,148
TR 16,7,8448
s_add_u32 s52, s78, 770048
MAV 84,52,156
buffer_load_dwordx4 v[136:139], v4, s[16:19], s52 offen sc1
MAV 68,52,152
TR 18,7,8960
MAV 68,36,144
TR 20,7,8480
TR 22,7,8992
s_waitcnt lgkmcnt(8)
MAV 72,40,144
TR 8,7,64
MAV 72,56,152
buffer_load_dwordx4 v19, s[28:31], s54 offen offset:1056 lds
MAV 88,56,156
TR 10,7,576
s_add_u32 s54, s101, 1507328
MAV 88,40,148
TR 12,7,96
TR 14,7,608
MAV 92,44,148
TR 24,7,8512
MAV 92,60,156
buffer_load_dwordx4 v[140:143], v4, s[16:19], s52 offen offset:1024 sc1
MAV 76,60,152
TR 26,7,9024
MAV 76,44,144
TR 28,7,8544
TR 30,7,9056
s_waitcnt vmcnt(16) lgkmcnt(8)
s_barrier
MAV 32,0,96
ds_read_b64_tr_b16 a[32:33], v6
s_add_u32 m0, s55, 50688
MAV 32,16,104
buffer_load_dwordx4 v18, s[28:31], s54 offen lds
MAV 48,16,108
TR 34,6,512
MAV 48,0,100
TR 36,6,32
TR 38,6,544
MAV 52,4,100
TR 48,6,8448
s_add_u32 s52, s79, 819200
MAV 52,20,108
buffer_load_dwordx4 v[144:147], v4, s[16:19], s52 offen sc1
MAV 36,20,104
TR 50,6,8960
MAV 36,4,96
TR 52,6,8480
TR 54,6,8992
s_waitcnt lgkmcnt(8)
MAV 40,8,96
TR 40,6,64
MAV 40,24,104
buffer_load_dwordx4 v19, s[28:31], s54 offen offset:1056 lds
MAV 56,24,108
TR 42,6,576
s_add_u32 s54, s101, 1769472
MAV 56,8,100
TR 44,6,96
TR 46,6,608
MAV 60,12,100
TR 56,6,8512
MAV 60,28,108
buffer_load_dwordx4 v[148:151], v4, s[16:19], s52 offen offset:1024 sc1
MAV 44,28,104
TR 58,6,9024
MAV 44,12,96
TR 60,6,8544
TR 62,6,9056
s_waitcnt lgkmcnt(8)
MAV 64,32,96
TR 0,7,16896
s_add_u32 m0, s55, 59136
MAV 64,48,104
buffer_load_dwordx4 v18, s[28:31], s54 offen lds
MAV 80,48,108
TR 2,7,17408
MAV 80,32,100
TR 4,7,16928
TR 6,7,17440
MAV 84,36,100
TR 16,7,25344
s_add_u32 s52, s79, 884736
MAV 84,52,108
buffer_load_dwordx4 v[152:155], v4, s[16:19], s52 offen sc1
MAV 68,52,104
TR 18,7,25856
MAV 68,36,96
TR 20,7,25376
TR 22,7,25888
s_waitcnt lgkmcnt(8)
MAV 72,40,96
TR 8,7,16960
MAV 72,56,104
buffer_load_dwordx4 v19, s[28:31], s54 offen offset:1056 lds
MAV 88,56,108
TR 10,7,17472
s_add_u32 s54, s98, 1966080
MAV 88,40,100
TR 12,7,16992
TR 14,7,17504
MAV 92,44,100
TR 24,7,25408
MAV 92,60,108
buffer_load_dwordx4 v[156:159], v4, s[16:19], s52 offen offset:1024 sc1
MAV 76,60,104
TR 26,7,25920
MAV 76,44,96
TR 28,7,25440
TR 30,7,25952
s_waitcnt vmcnt(16) lgkmcnt(8)
s_barrier
MAV 32,0,112
TR 32,6,16896
s_add_u32 m0, s55, 67584
MAV 32,16,120
buffer_load_dwordx4 v18, s[28:31], s54 offen lds
MAV 48,16,124
TR 34,6,17408
MAV 48,0,116
TR 36,6,16928
TR 38,6,17440
MAV 52,4,116
TR 48,6,25344
s_add_u32 s52, s76, 32768
MAV 52,20,124
buffer_load_dwordx4 v[96:99], v4, s[16:19], s52 offen sc1
MAV 36,20,120
TR 50,6,25856
MAV 36,4,112
TR 52,6,25376
TR 54,6,25888
s_waitcnt lgkmcnt(8)
MAV 40,8,112
TR 40,6,16960
MAV 40,24,120
buffer_load_dwordx4 v19, s[28:31], s54 offen offset:1056 lds
MAV 56,24,124
TR 42,6,17472
s_add_u32 s54, s98, 2228224
MAV 56,8,116
TR 44,6,16992
TR 46,6,17504
MAV 60,12,116
TR 56,6,25408
MAV 60,28,124
buffer_load_dwordx4 v[100:103], v4, s[16:19], s52 offen offset:1024 sc1
MAV 44,28,120
TR 58,6,25920
MAV 44,12,112
TR 60,6,25440
TR 62,6,25952
s_waitcnt lgkmcnt(8)
MAV 64,32,112
TR 0,7,33792
s_add_u32 m0, s55, 76032
MAV 64,48,120
buffer_load_dwordx4 v18, s[28:31], s54 offen lds
MAV 80,48,124
TR 2,7,34304
MAV 80,32,116
TR 4,7,33824
TR 6,7,34336
MAV 84,36,116
TR 16,7,42240
s_add_u32 s52, s76, 98304
MAV 84,52,124
buffer_load_dwordx4 v[104:107], v4, s[16:19], s52 offen sc1
MAV 68,52,120
TR 18,7,42752
MAV 68,36,112
TR 20,7,42272
TR 22,7,42784
s_waitcnt lgkmcnt(8)
MAV 72,40,112
TR 8,7,33856
MAV 72,56,120
buffer_load_dwordx4 v19, s[28:31], s54 offen offset:1056 lds
MAV 88,56,124
TR 10,7,34368
s_add_u32 s54, s99, 2424832
MAV 88,40,116
TR 12,7,33888
TR 14,7,34400
MAV 92,44,116
TR 24,7,42304
MAV 92,60,124
buffer_load_dwordx4 v[108:111], v4, s[16:19], s52 offen offset:1024 sc1
MAV 76,60,120
TR 26,7,42816
MAV 76,44,112
TR 28,7,42336
TR 30,7,42848
s_waitcnt vmcnt(16) lgkmcnt(8)
s_barrier
MAV 32,0,128
TR 32,6,33792
s_add_u32 m0, s55, 84480
MAV 32,16,136
buffer_load_dwordx4 v18, s[28:31], s54 offen lds
MAV 48,16,140
TR 34,6,34304
MAV 48,0,132
TR 36,6,33824
TR 38,6,34336
MAV 52,4,132
TR 48,6,42240
s_add_u32 s52, s77, 147456
MAV 52,20,140
buffer_load_dwordx4 v[112:115], v4, s[16:19], s52 offen sc1
MAV 36,20,136
TR 50,6,42752
MAV 36,4,128
TR 52,6,42272
TR 54,6,42784
s_waitcnt lgkmcnt(8)
MAV 40,8,128
TR 40,6,33856
MAV 40,24,136
buffer_load_dwordx4 v19, s[28:31], s54 offen offset:1056 lds
MAV 56,24,140
TR 42,6,34368
s_add_u32 s54, s99, 2686976
MAV 56,8,132
TR 44,6,33888
TR 46,6,34400
MAV 60,12,132
TR 56,6,42304
MAV 60,28,140
buffer_load_dwordx4 v[116:119], v4, s[16:19], s52 offen offset:1024 sc1
MAV 44,28,136
TR 58,6,42816
MAV 44,12,128
TR 60,6,42336
TR 62,6,42848
s_waitcnt lgkmcnt(8)
MAV 64,32,128
TR 0,7,50688
s_add_u32 m0, s55, 92928
MAV 64,48,136
buffer_load_dwordx4 v18, s[28:31], s54 offen lds
MAV 80,48,140
TR 2,7,51200
MAV 80,32,132
TR 4,7,50720
TR 6,7,51232
MAV 84,36,132
TR 16,7,59136
s_add_u32 s52, s77, 212992
MAV 84,52,140
buffer_load_dwordx4 v[120:123], v4, s[16:19], s52 offen sc1
MAV 68,52,136
TR 18,7,59648
MAV 68,36,128
TR 20,7,59168
TR 22,7,59680
s_waitcnt lgkmcnt(8)
MAV 72,40,128
TR 8,7,50752
MAV 72,56,136
buffer_load_dwordx4 v19, s[28:31], s54 offen offset:1056 lds
MAV 88,56,140
TR 10,7,51264
s_add_u32 s54, s100, 2883584
MAV 88,40,132
TR 12,7,50784
TR 14,7,51296
MAV 92,44,132
TR 24,7,59200
MAV 92,60,140
buffer_load_dwordx4 v[124:127], v4, s[16:19], s52 offen offset:1024 sc1
MAV 76,60,136
TR 26,7,59712
MAV 76,44,128
TR 28,7,59232
TR 30,7,59744
s_waitcnt vmcnt(16) lgkmcnt(8)
s_barrier
MAV 32,0,144
TR 32,6,50688
s_add_u32 m0, s55, 101376
MAV 32,16,152
buffer_load_dwordx4 v18, s[28:31], s54 offen lds
MAV 48,16,156
TR 34,6,51200
MAV 48,0,148
TR 36,6,50720
TR 38,6,51232
MAV 52,4,148
TR 48,6,59136
s_add_u32 s52, s78, 262144
MAV 52,20,156
buffer_load_dwordx4 v[128:131], v4, s[16:19], s52 offen sc1
MAV 36,20,152
TR 50,6,59648
MAV 36,4,144
TR 52,6,59168
TR 54,6,59680
s_waitcnt lgkmcnt(8)
MAV 40,8,144
TR 40,6,50752
MAV 40,24,152
buffer_load_dwordx4 v19, s[28:31], s54 offen offset:1056 lds
MAV 56,24,156
TR 42,6,51264
s_add_u32 s54, s100, 3145728
MAV 56,8,148
TR 44,6,50784
TR 46,6,51296
MAV 60,12,148
TR 56,6,59200
MAV 60,28,156
buffer_load_dwordx4 v[132:135], v4, s[16:19], s52 offen offset:1024 sc1
MAV 44,28,152
TR 58,6,59712
MAV 44,12,144
TR 60,6,59232
TR 62,6,59744
v_add_u32 v7, s57, v7
v_add_u32 v6, s57, v6
s_sub_u32 s57, 0, s57
s_waitcnt lgkmcnt(8)
MAV 64,32,144
ds_read_b64_tr_b16 a[0:1], v7
s_add_u32 m0, s55, 109824
MAV 64,48,152
buffer_load_dwordx4 v18, s[28:31], s54 offen lds
MAV 80,48,156
TR 2,7,512
MAV 80,32,148
TR 4,7,32
TR 6,7,544
MAV 84,36,148
TR 16,7,8448
s_add_u32 s52, s78, 327680
MAV 84,52,156
buffer_load_dwordx4 v[136:139], v4, s[16:19], s52 offen sc1
MAV 68,52,152
TR 18,7,8960
MAV 68,36,144
TR 20,7,8480
TR 22,7,8992
s_waitcnt lgkmcnt(8)
MAV 72,40,144
TR 8,7,64
MAV 72,56,152
buffer_load_dwordx4 v19, s[28:31], s54 offen offset:1056 lds
MAV 88,56,156
TR 10,7,576
s_add_u32 s54, s101, 3342336
MAV 88,40,148
TR 12,7,96
TR 14,7,608
MAV 92,44,148
TR 24,7,8512
MAV 92,60,156
buffer_load_dwordx4 v[140:143], v4, s[16:19], s52 offen offset:1024 sc1
MAV 76,60,152
TR 26,7,9024
MAV 76,44,144
TR 28,7,8544
TR 30,7,9056
s_waitcnt vmcnt(16) lgkmcnt(8)
s_barrier
MAV 32,0,96
ds_read_b64_tr_b16 a[32:33], v6
s_add_u32 m0, s55, 118272
MAV 32,16,104
buffer_load_dwordx4 v18, s[28:31], s54 offen lds
MAV 48,16,108
TR 34,6,512
MAV 48,0,100
TR 36,6,32
TR 38,6,544
MAV 52,4,100
TR 48,6,8448
s_add_u32 s52, s79, 376832
MAV 52,20,108
buffer_load_dwordx4 v[144:147], v4, s[16:19], s52 offen sc1
MAV 36,20,104
TR 50,6,8960
MAV 36,4,96
TR 52,6,8480
TR 54,6,8992
s_waitcnt lgkmcnt(8)
MAV 40,8,96
TR 40,6,64
MAV 40,24,104
buffer_load_dwordx4 v19, s[28:31], s54 offen offset:1056 lds
MAV 56,24,108
TR 42,6,576
s_add_u32 s54, s101, 3604480
MAV 56,8,100
TR 44,6,96
TR 46,6,608
MAV 60,12,100
TR 56,6,8512
MAV 60,28,108
buffer_load_dwordx4 v[148:151], v4, s[16:19], s52 offen offset:1024 sc1
MAV 44,28,104
TR 58,6,9024
MAV 44,12,96
TR 60,6,8544
TR 62,6,9056
s_waitcnt lgkmcnt(8)
MAV 64,32,96
TR 0,7,16896
s_add_u32 m0, s55, 126720
MAV 64,48,104
buffer_load_dwordx4 v18, s[28:31], s54 offen lds
MAV 80,48,108
TR 2,7,17408
MAV 80,32,100
TR 4,7,16928
TR 6,7,17440
MAV 84,36,100
TR 16,7,25344
s_add_u32 s52, s79, 442368
MAV 84,52,108
buffer_load_dwordx4 v[152:155], v4, s[16:19], s52 offen sc1
MAV 68,52,104
TR 18,7,25856
MAV 68,36,96
TR 20,7,25376
TR 22,7,25888
s_waitcnt lgkmcnt(8)
MAV 72,40,96
.Lpad20:
s_cbranch_execz .Lnopoll37r
TR 8,7,16960
MAV 72,56,104
buffer_load_dwordx4 v19, s[28:31], s54 offen offset:1056 lds
MAV 88,56,108
TR 10,7,17472
s_add_u32 s54, s98, 196608
MAV 88,40,100
TR 12,7,16992
TR 14,7,17504
MAV 92,44,100
TR 24,7,25408
MAV 92,60,108
buffer_load_dwordx4 v[156:159], v4, s[16:19], s52 offen offset:1024 sc1
MAV 76,60,104
TR 26,7,25920
MAV 76,44,96
TR 28,7,25440
TR 30,7,25952
s_waitcnt vmcnt(16) lgkmcnt(8)
s_barrier
MAV 32,0,112
TR 32,6,16896
s_add_u32 m0, s55, 0
MAV 32,16,120
buffer_load_dwordx4 v18, s[28:31], s54 offen lds
MAV 48,16,124
TR 34,6,17408
MAV 48,0,116
TR 36,6,16928
TR 38,6,17440
MAV 52,4,116
TR 48,6,25344
s_add_u32 s52, s76, 491520
MAV 52,20,124
buffer_load_dwordx4 v[96:99], v4, s[16:19], s52 offen sc1
MAV 36,20,120
TR 50,6,25856
MAV 36,4,112
TR 52,6,25376
TR 54,6,25888
s_waitcnt lgkmcnt(8)
MAV 40,8,112
TR 40,6,16960
MAV 40,24,120
buffer_load_dwordx4 v19, s[28:31], s54 offen offset:1056 lds
MAV 56,24,124
TR 42,6,17472
s_add_u32 s54, s99, 655360
MAV 56,8,116
TR 44,6,16992
TR 46,6,17504
MAV 60,12,116
TR 56,6,25408
MAV 60,28,124
buffer_load_dwordx4 v[100:103], v4, s[16:19], s52 offen offset:1024 sc1
MAV 44,28,120
TR 58,6,25920
MAV 44,12,112
TR 60,6,25440
TR 62,6,25952
s_waitcnt lgkmcnt(8)
MAV 64,32,112
TR 0,7,33792
s_add_u32 m0, s55, 8448
MAV 64,48,120
buffer_load_dwordx4 v18, s[28:31], s54 offen lds
MAV 80,48,124
TR 2,7,34304
MAV 80,32,116
TR 4,7,33824
TR 6,7,34336
MAV 84,36,116
TR 16,7,42240
s_add_u32 s52, s76, 557056
MAV 84,52,124
buffer_load_dwordx4 v[104:107], v4, s[16:19], s52 offen sc1
MAV 68,52,120
TR 18,7,42752
MAV 68,36,112
TR 20,7,42272
TR 22,7,42784
s_waitcnt lgkmcnt(8)
MAV 72,40,112
TR 8,7,33856
MAV 72,56,120
buffer_load_dwordx4 v19, s[28:31], s54 offen offset:1056 lds
MAV 88,56,124
TR 10,7,34368
s_add_u32 s54, s100, 1114112
MAV 88,40,116
TR 12,7,33888
TR 14,7,34400
MAV 92,44,116
TR 24,7,42304
MAV 92,60,124
buffer_load_dwordx4 v[108:111], v4, s[16:19], s52 offen offset:1024 sc1
MAV 76,60,120
TR 26,7,42816
MAV 76,44,112
TR 28,7,42336
TR 30,7,42848
s_waitcnt vmcnt(16) lgkmcnt(8)
s_barrier
MAV 32,0,128
TR 32,6,33792
s_add_u32 m0, s55, 16896
MAV 32,16,136
buffer_load_dwordx4 v18, s[28:31], s54 offen lds
MAV 48,16,140
TR 34,6,34304
MAV 48,0,132
TR 36,6,33824
TR 38,6,34336
MAV 52,4,132
TR 48,6,42240
s_add_u32 s52, s77, 606208
MAV 52,20,140
buffer_load_dwordx4 v[112:115], v4, s[16:19], s52 offen sc1
MAV 36,20,136
TR 50,6,42752
MAV 36,4,128
TR 52,6,42272
TR 54,6,42784
s_waitcnt lgkmcnt(8)
MAV 40,8,128
TR 40,6,33856
MAV 40,24,136
buffer_load_dwordx4 v19, s[28:31], s54 offen offset:1056 lds
MAV 56,24,140
TR 42,6,34368
s_add_u32 s54, s101, 1572864
MAV 56,8,132
TR 44,6,33888
TR 46,6,34400
MAV 60,12,132
TR 56,6,42304
MAV 60,28,140
buffer_load_dwordx4 v[116:119], v4, s[16:19], s52 offen offset:1024 sc1
MAV 44,28,136
TR 58,6,42816
MAV 44,12,128
TR 60,6,42336
TR 62,6,42848
s_waitcnt lgkmcnt(8)
MAV 64,32,128
TR 0,7,50688
s_add_u32 m0, s55, 25344
MAV 64,48,136
buffer_load_dwordx4 v18, s[28:31], s54 offen lds
MAV 80,48,140
TR 2,7,51200
MAV 80,32,132
TR 4,7,50720
TR 6,7,51232
MAV 84,36,132
TR 16,7,59136
s_add_u32 s52, s77, 671744
MAV 84,52,140
buffer_load_dwordx4 v[120:123], v4, s[16:19], s52 offen sc1
MAV 68,52,136
TR 18,7,59648
MAV 68,36,128
TR 20,7,59168
TR 22,7,59680
s_waitcnt lgkmcnt(8)
MAV 72,40,128
TR 8,7,50752
MAV 72,56,136
buffer_load_dwordx4 v19, s[28:31], s54 offen offset:1056 lds
MAV 88,56,140
TR 10,7,51264
s_add_u32 s54, s98, 2031616
MAV 88,40,132
TR 12,7,50784
TR 14,7,51296
MAV 92,44,132
TR 24,7,59200
MAV 92,60,140
buffer_load_dwordx4 v[124:127], v4, s[16:19], s52 offen offset:1024 sc1
MAV 76,60,136
TR 26,7,59712
MAV 76,44,128
TR 28,7,59232
TR 30,7,59744
s_waitcnt vmcnt(16) lgkmcnt(8)
s_barrier
MAV 32,0,144
TR 32,6,50688
s_add_u32 m0, s55, 33792
MAV 32,16,152
buffer_load_dwordx4 v18, s[28:31], s54 offen lds
MAV 48,16,156
TR 34,6,51200
MAV 48,0,148
TR 36,6,50720
TR 38,6,51232
MAV 52,4,148
TR 48,6,59136
s_add_u32 s52, s78, 720896
MAV 52,20,156
buffer_load_dwordx4 v[128:131], v4, s[16:19], s52 offen sc1
MAV 36,20,152
TR 50,6,59648
MAV 36,4,144
TR 52,6,59168
TR 54,6,59680
s_waitcnt lgkmcnt(8)
MAV 40,8,144
TR 40,6,50752
MAV 40,24,152
buffer_load_dwordx4 v19, s[28:31], s54 offen offset:1056 lds
MAV 56,24,156
TR 42,6,51264
s_add_u32 s54, s99, 2490368
MAV 56,8,148
TR 44,6,50784
TR 46,6,51296
MAV 60,12,148
TR 56,6,59200
MAV 60,28,156
buffer_load_dwordx4 v[132:135], v4, s[16:19], s52 offen offset:1024 sc1
MAV 44,28,152
TR 58,6,59712
MAV 44,12,144
TR 60,6,59232
TR 62,6,59744
v_add_u32 v7, s57, v7
v_add_u32 v6, s57, v6
s_sub_u32 s57, 0, s57
s_waitcnt lgkmcnt(8)
MAV 64,32,144
ds_read_b64_tr_b16 a[0:1], v6
s_add_u32 m0, s55, 42240
MAV 64,48,152
buffer_load_dwordx4 v18, s[28:31], s54 offen lds
MAV 80,48,156
TR 2,6,512
MAV 80,32,148
TR 4,6,32
TR 6,6,544
MAV 84,36,148
TR 16,6,8448
s_add_u32 s52, s78, 786432
MAV 84,52,156
buffer_load_dwordx4 v[136:139], v4, s[16:19], s52 offen sc1
MAV 68,52,152
TR 18,6,8960
MAV 68,36,144
TR 20,6,8480
TR 22,6,8992
s_waitcnt lgkmcnt(8)
MAV 72,40,144
TR 8,6,64
MAV 72,56,152
buffer_load_dwordx4 v19, s[28:31], s54 offen offset:1056 lds
MAV 88,56,156
TR 10,6,576
s_add_u32 s54, s100, 2949120
MAV 88,40,148
TR 12,6,96
TR 14,6,608
MAV 92,44,148
TR 24,6,8512
MAV 92,60,156
buffer_load_dwordx4 v[140:143], v4, s[16:19], s52 offen offset:1024 sc1
MAV 76,60,152
TR 26,6,9024
MAV 76,44,144
TR 28,6,8544
TR 30,6,9056
s_waitcnt vmcnt(16) lgkmcnt(8)
s_barrier
MAV 64,0,96
TR 32,6,16896
TR 34,6,17408
s_add_u32 m0, s55, 50688
MAV 64,16,104
TR 36,6,16928
buffer_load_dwordx4 v18, s[28:31], s54 offen lds
MAV 80,16,108
TR 38,6,17440
MAV 80,0,100
TR 48,6,25344
buffer_load_dwordx4 v19, s[28:31], s54 offen offset:1056 lds
MAV 84,4,100
TR 50,6,25856
s_add_u32 s54, s101, 3407872
s_add_u32 s52, s79, 835584
MAV 84,20,108
buffer_load_dwordx4 v[144:147], v4, s[16:19], s52 offen sc1
MAV 68,20,104
TR 52,6,25376
TR 54,6,25888
MAV 68,4,96
TR 40,6,16960
s_waitcnt lgkmcnt(9)
MAV 72,8,96
TR 42,6,17472
MAV 72,24,104
TR 44,6,16992
buffer_load_dwordx4 v[148:151], v4, s[16:19], s52 offen offset:1024 sc1
MAV 88,24,108
TR 46,6,17504
s_add_u32 m0, s55, 59136
MAV 88,8,100
TR 56,6,25408
buffer_load_dwordx4 v18, s[28:31], s54 offen lds
MAV 92,12,100
TR 58,6,25920
MAV 92,28,108
TR 60,6,25440
buffer_load_dwordx4 v19, s[28:31], s54 offen offset:1056 lds
MAV 76,28,104
TR 62,6,25952
s_add_u32 s52, s79, 901120
MAV 76,12,96
buffer_load_dwordx4 v[152:155], v4, s[16:19], s52 offen sc1
buffer_load_dwordx4 v[156:159], v4, s[16:19], s52 offen offset:1024 sc1
s_waitcnt vmcnt(16) lgkmcnt(8)
MAV 64,32,112
TR 0,6,33792
s_add_u32 s52, s76, 49152
s_lshl_b32 s70, s2, 10
MAV 64,48,120
buffer_load_dwordx4 v[160:163], v4, s[16:19], s52 offen sc1
s_lshl_b32 s62, s3, 7
MAV 80,48,124
TR 2,6,34304
s_add_u32 s70, s70, s62
s_add_u32 s70, s70, 31457280
MAV 80,32,116
TR 4,6,33824
TR 6,6,34336
MAV 84,36,116
TR 16,6,42240
s_xor_b32 s71, s70, 1024
v_min_u32 v26, 1, v1
MAV 84,52,124
buffer_load_dwordx4 v[164:167], v4, s[16:19], s52 offen offset:1024 sc1
v_lshlrev_b32 v26, 28, v26
MAV 68,52,120
TR 18,6,42752
v_mov_b32 v30, 1
MAV 68,36,112
TR 20,6,42272
TR 22,6,42784
s_waitcnt lgkmcnt(8)
MAV 72,40,112
TR 8,6,33856
s_add_u32 s52, s77, 163840
v_mov_b32 v31, 0
MAV 72,56,120
buffer_load_dwordx4 v[168:171], v4, s[16:19], s52 offen sc1
s_lshl_b32 s68, s7, 18
MAV 88,56,124
TR 10,6,34368
s_add_u32 s68, s68, 33554432
s_xor_b32 s69, s68, 262144
MAV 88,40,116
TR 12,6,33888
TR 14,6,34400
MAV 92,44,116
TR 24,6,42304
v_and_b32 v2, 1, v1
v_lshlrev_b32 v2, 4, v2
MAV 92,60,124
buffer_load_dwordx4 v[172:175], v4, s[16:19], s52 offen offset:1024 sc1
v_mov_b32 v224, 0x3f80
MAV 76,60,120
TR 26,6,42816
v_lshlrev_b32 v2, v2, v224
MAV 76,44,112
TR 28,6,42336
TR 30,6,42848
s_waitcnt vmcnt(12) lgkmcnt(8)
MAV 64,0,128
TR 32,6,50688
s_add_u32 s52, s78, 278528
v_bfe_u32 v224, v1, 2, 2
MAV 64,16,136
buffer_load_dwordx4 v[176:179], v4, s[16:19], s52 offen sc1
v_lshrrev_b32 v225, 4, v1
MAV 80,16,140
TR 34,6,51200
v_cmp_eq_u32 vcc, v224, v225
s_nop 1
v_cndmask_b32 v2, 0, v2, vcc
MAV 80,0,132
TR 36,6,50720
TR 38,6,51232
MAV 84,4,132
TR 48,6,59136
v_and_b32 v224, 2, v1
v_cmp_eq_u32 vcc, 0, v224
MAV 84,20,140
buffer_load_dwordx4 v[180:183], v4, s[16:19], s52 offen offset:1024 sc1
v_cndmask_b32 v226, 0, v2, vcc
MAV 68,20,136
TR 50,6,59648
v_cndmask_b32 v227, v2, 0, vcc
MAV 68,4,128
TR 52,6,59168
TR 54,6,59680
s_waitcnt lgkmcnt(8)
MAV 72,8,128
TR 40,6,50752
s_add_u32 s52, s79, 393216
v_mov_b32 v224, 0
MAV 72,24,136
buffer_load_dwordx4 v[184:187], v4, s[16:19], s52 offen sc1
v_mov_b32 v225, 0
MAV 88,24,140
TR 42,6,51264
v_mov_b32 v228, 0
v_mov_b32 v229, 0
MAV 88,8,132
TR 44,6,50784
TR 46,6,51296
MAV 92,12,132
TR 56,6,59200
v_bfe_u32 v18, v1, 3, 1
v_lshrrev_b32 v2, 4, v1
MAV 92,28,140
buffer_load_dwordx4 v[188:191], v4, s[16:19], s52 offen offset:1024 sc1
v_lshl_add_u32 v18, v2, 3, v18
MAV 76,28,136
TR 58,6,59712
s_lshl_b32 s62, s3, 1
MAV 76,12,128
TR 60,6,59232
TR 62,6,59744
s_waitcnt vmcnt(8) lgkmcnt(8)
s_barrier
v_add_u32 v6, s57, v6
MAV 64,32,144
ds_read_b64_tr_b16 a[0:1], v6
s_add_u32 s52, s76, 507904
v_add_u32 v18, s62, v18
MAV 64,48,152
buffer_load_dwordx4 v[192:195], v4, s[16:19], s52 offen sc1
v_mul_u32_u24 v18, 6144, v18
MAV 80,48,156
TR 2,6,512
v_and_b32 v2, 7, v1
v_lshl_add_u32 v18, v2, 4, v18
MAV 80,32,148
TR 4,6,32
TR 6,6,544
MAV 84,36,148
TR 16,6,8448
s_lshl_b32 s62, s9, 7
v_add_u32 v18, s62, v18
MAV 84,52,156
buffer_load_dwordx4 v[196:199], v4, s[16:19], s52 offen offset:1024 sc1
v_add_u32 v19, 1024, v18
MAV 68,52,152
TR 18,6,8960
v_add_u32 v20, 2048, v18
MAV 68,36,144
TR 20,6,8480
TR 22,6,8992
s_waitcnt lgkmcnt(8)
MAV 72,40,144
TR 8,6,64
s_add_u32 s52, s77, 622592
s_mul_i32 s59, s3, 3104
MAV 72,56,152
buffer_load_dwordx4 v[200:203], v4, s[16:19], s52 offen sc1
s_mov_b32 s58, 0
MAV 88,56,156
TR 10,6,576
v_accvgpr_read_b32 v28, a224
v_add_f32 v32, v32, v28
MAV 88,40,148
TR 12,6,96
TR 14,6,608
MAV 92,44,148
TR 24,6,8512
v_accvgpr_read_b32 v29, a225
v_add_f32 v33, v33, v29
MAV 92,60,156
buffer_load_dwordx4 v[204:207], v4, s[16:19], s52 offen offset:1024 sc1
v_accvgpr_read_b32 v28, a226
MAV 76,60,152
TR 26,6,9024
v_add_f32 v34, v34, v28
MAV 76,44,144
TR 28,6,8544
TR 30,6,9056
s_waitcnt vmcnt(8) lgkmcnt(8)
MAV 64,0,160
TR 32,6,16896
s_add_u32 s52, s78, 737280
v_accvgpr_read_b32 v29, a227
MAV 64,16,168
buffer_load_dwordx4 v[208:211], v4, s[16:19], s52 offen sc1
v_add_f32 v35, v35, v29
MAV 80,16,172
TR 34,6,17408
v_accvgpr_read_b32 v28, a228
v_add_f32 v36, v36, v28
MAV 80,0,164
TR 36,6,16928
TR 38,6,17440
MAV 84,4,164
TR 48,6,25344
v_accvgpr_read_b32 v29, a229
v_add_f32 v37, v37, v29
MAV 84,20,172
buffer_load_dwordx4 v[212:215], v4, s[16:19], s52 offen offset:1024 sc1
v_accvgpr_read_b32 v28, a230
MAV 68,20,168
TR 50,6,25856
v_add_f32 v38, v38, v28
MAV 68,4,160
TR 52,6,25376
TR 54,6,25888
s_waitcnt lgkmcnt(8)
MAV 72,8,160
TR 40,6,16960
s_add_u32 s52, s79, 851968
v_accvgpr_read_b32 v29, a231
MAV 72,24,168
buffer_load_dwordx4 v[216:219], v4, s[16:19], s52 offen sc1
v_add_f32 v39, v39, v29
MAV 88,24,172
TR 42,6,17472
v_accvgpr_read_b32 v28, a232
v_add_f32 v40, v40, v28
MAV 88,8,164
TR 44,6,16992
TR 46,6,17504
MAV 92,12,164
TR 56,6,25408
v_accvgpr_read_b32 v29, a233
v_add_f32 v41, v41, v29
MAV 92,28,172
buffer_load_dwordx4 v[220:223], v4, s[16:19], s52 offen offset:1024 sc1
v_accvgpr_read_b32 v28, a234
MAV 76,28,168
TR 58,6,25920
v_add_f32 v42, v42, v28
MAV 76,12,160
TR 60,6,25440
TR 62,6,25952
s_waitcnt vmcnt(8) lgkmcnt(8)
MAV 64,32,176
TR 0,6,33792
.Lpad21:
s_cbranch_execz .Lnopoll37r
v_accvgpr_read_b32 v29, a235
MAV 64,48,184
TR 2,6,34304
v_add_f32 v43, v43, v29
v_accvgpr_read_b32 v28, a236
MAV 80,48,188
TR 4,6,33824
MAV 80,32,180
TR 6,6,34336
v_add_f32 v44, v44, v28
v_accvgpr_read_b32 v29, a237
MAV 84,36,180
TR 16,6,42240
MAV 84,52,188
TR 18,6,42752
v_add_f32 v45, v45, v29
v_accvgpr_read_b32 v28, a238
MAV 68,52,184
TR 20,6,42272
MAV 68,36,176
TR 22,6,42784
v_add_f32 v46, v46, v28
s_waitcnt lgkmcnt(8)
MAV 72,40,176
TR 8,6,33856
v_accvgpr_read_b32 v29, a239
MAV 72,56,184
TR 10,6,34368
v_add_f32 v47, v47, v29
MAV 88,56,188
TR 12,6,33888
v_accvgpr_read_b32 v28, a240
MAV 88,40,180
TR 14,6,34400
v_add_f32 v48, v48, v28
MAV 92,44,180
TR 24,6,42304
v_accvgpr_read_b32 v29, a241
MAV 92,60,188
TR 26,6,42816
v_add_f32 v49, v49, v29
MAV 76,60,184
TR 28,6,42336
v_accvgpr_read_b32 v28, a242
MAV 76,44,176
TR 30,6,42848
v_add_f32 v50, v50, v28
s_waitcnt vmcnt(4) lgkmcnt(8)
MAV 64,0,192
TR 32,6,50688
v_accvgpr_read_b32 v29, a243
MAV 64,16,200
TR 34,6,51200
v_add_f32 v51, v51, v29
v_accvgpr_read_b32 v28, a244
MAV 80,16,204
TR 36,6,50720
MAV 80,0,196
TR 38,6,51232
v_add_f32 v52, v52, v28
v_accvgpr_read_b32 v29, a245
MAV 84,4,196
TR 48,6,59136
MAV 84,20,204
TR 50,6,59648
v_add_f32 v53, v53, v29
v_accvgpr_read_b32 v28, a246
MAV 68,20,200
TR 52,6,59168
MAV 68,4,192
TR 54,6,59680
v_add_f32 v54, v54, v28
s_waitcnt lgkmcnt(8)
MAV 72,8,192
TR 40,6,50752
v_accvgpr_read_b32 v29, a247
MAV 72,24,200
TR 42,6,51264
v_add_f32 v55, v55, v29
MAV 88,24,204
TR 44,6,50784
v_accvgpr_read_b32 v28, a248
MAV 88,8,196
TR 46,6,51296
v_add_f32 v56, v56, v28
MAV 92,12,196
TR 56,6,59200
v_accvgpr_read_b32 v29, a249
MAV 92,28,204
TR 58,6,59712
v_add_f32 v57, v57, v29
MAV 76,28,200
TR 60,6,59232
v_accvgpr_read_b32 v28, a250
MAV 76,12,192
TR 62,6,59744
v_add_f32 v58, v58, v28
s_waitcnt vmcnt(0) lgkmcnt(8)
MAV 64,32,208
ds_read_b64_tr_b16 a[0:1], v7
v_accvgpr_read_b32 v29, a251
MAV 64,48,216
TR 2,7,512
v_add_f32 v59, v59, v29
MAV 80,48,220
TR 4,7,32
MAV 80,32,212
TR 6,7,544
v_accvgpr_read_b32 v28, a252
MAV 84,36,212
TR 16,7,8448
v_add_f32 v60, v60, v28
MAV 84,52,220
TR 18,7,8960
MAV 68,52,216
TR 20,7,8480
v_accvgpr_read_b32 v29, a253
MAV 68,36,208
TR 22,7,8992
s_waitcnt lgkmcnt(8)
MAV 72,40,208
TR 8,7,64
v_add_f32 v61, v61, v29
MAV 72,56,216
TR 10,7,576
MAV 88,56,220
TR 12,7,96
v_accvgpr_read_b32 v28, a254
MAV 88,40,212
TR 14,7,608
v_add_f32 v62, v62, v28
MAV 92,44,212
TR 24,7,8512
MAV 92,60,220
TR 26,7,9024
v_accvgpr_read_b32 v29, a255
MAV 76,60,216
TR 28,7,8544
v_add_f32 v63, v63, v29
MAV 76,44,208
TR 30,7,9056
s_waitcnt lgkmcnt(8)
MAV 32,0,96
TR 32,7,16896
v_cvt_pk_bf16_f32 v232, v64, v65
MAV 32,16,104
TR 34,7,17408
v_cvt_pk_bf16_f32 v233, v66, v67
v_cvt_pk_bf16_f32 v234, v68, v69
MAV 48,16,108
TR 36,7,16928
v_cvt_pk_bf16_f32 v235, v70, v71
MAV 48,0,100
TR 38,7,17440
buffer_store_dwordx4 v[232:235], v4, s[16:19], s69 offen sc1
s_add_u32 s69, s69, 131072
MAV 52,4,100
TR 48,7,25344
v_cvt_pk_bf16_f32 v236, v72, v73
MAV 52,20,108
TR 50,7,25856
v_cvt_pk_bf16_f32 v237, v74, v75
v_cvt_pk_bf16_f32 v238, v76, v77
MAV 36,20,104
TR 52,7,25376
v_cvt_pk_bf16_f32 v239, v78, v79
MAV 36,4,96
TR 54,7,25888
buffer_store_dwordx4 v[236:239], v4, s[16:19], s69 offen sc1
s_waitcnt lgkmcnt(8)
MAV 40,8,96
TR 40,7,16960
s_add_u32 s69, s69, -130048
MAV 40,24,104
TR 42,7,17472
v_cvt_pk_bf16_f32 v240, v80, v81
v_cvt_pk_bf16_f32 v241, v82, v83
MAV 56,24,108
TR 44,7,16992
v_cvt_pk_bf16_f32 v242, v84, v85
MAV 56,8,100
TR 46,7,17504
v_cvt_pk_bf16_f32 v243, v86, v87
buffer_store_dwordx4 v[240:243], v4, s[16:19], s69 offen sc1
MAV 60,12,100
TR 56,7,25408
s_add_u32 s69, s69, 131072
MAV 60,28,108
TR 58,7,25920
v_cvt_pk_bf16_f32 v244, v88, v89
v_cvt_pk_bf16_f32 v245, v90, v91
MAV 44,28,104
TR 60,7,25440
v_cvt_pk_bf16_f32 v246, v92, v93
MAV 44,12,96
TR 62,7,25952
v_cvt_pk_bf16_f32 v247, v94, v95
buffer_store_dwordx4 v[244:247], v4, s[16:19], s69 offen sc1
s_waitcnt lgkmcnt(8)
MAV 32,32,112
TR 0,7,33792
MAV 32,48,120
TR 2,7,34304
MAV 48,48,124
TR 4,7,33824
MAV 48,32,116
TR 6,7,34336
MAV 52,36,116
TR 16,7,42240
MAV 52,52,124
TR 18,7,42752
MAV 36,52,120
TR 20,7,42272
MAV 36,36,112
TR 22,7,42784
s_waitcnt lgkmcnt(8)
MAV 40,40,112
TR 8,7,33856
MAV 40,56,120
TR 10,7,34368
MAV 56,56,124
TR 12,7,33888
MAV 56,40,116
TR 14,7,34400
MAV 60,44,116
TR 24,7,42304
MAV 60,60,124
TR 26,7,42816
MAV 44,60,120
TR 28,7,42336
MAV 44,44,112
TR 30,7,42848
s_waitcnt lgkmcnt(8)
MAV 32,0,128
TR 32,7,50688
MAV 32,16,136
TR 34,7,51200
MAV 48,16,140
TR 36,7,50720
MAV 48,0,132
TR 38,7,51232
MAV 52,4,132
TR 48,7,59136
MAV 52,20,140
TR 50,7,59648
MAV 36,20,136
TR 52,7,59168
MAV 36,4,128
TR 54,7,59680
s_waitcnt lgkmcnt(8)
MAV 40,8,128
TR 40,7,50752
MAV 40,24,136
TR 42,7,51264
MAV 56,24,140
TR 44,7,50784
MAV 56,8,132
TR 46,7,51296
MAV 60,12,132
TR 56,7,59200
MAV 60,28,140
TR 58,7,59712
MAV 44,28,136
TR 60,7,59232
MAV 44,12,128
TR 62,7,59744
v_add_u32 v7, s57, v7
s_waitcnt lgkmcnt(8)
MAV 32,32,144
ds_read_b64_tr_b16 a[0:1], v7
MAV 32,48,152
s_waitcnt vmcnt(0)
buffer_atomic_add v30, v26, s[16:19], s71 offen
MAV 48,48,156
TR 2,7,512
MAV 48,32,148
TR 4,7,32
TR 6,7,544
MAV 52,36,148
MAV 52,52,156
TR 16,7,8448
TR 18,7,8960
MAV 36,52,152
TR 20,7,8480
MAV 36,36,144
s_waitcnt lgkmcnt(7)
MAV 40,40,144
TR 22,7,8992
MAV 40,56,152
TR 8,7,64
TR 10,7,576
MAV 56,56,156
MAV 56,40,148
TR 12,7,96
TR 14,7,608
MAV 60,44,148
TR 24,7,8512
MAV 60,60,156
TR 26,7,9024
MAV 44,60,152
TR 28,7,8544
MAV 44,44,144
TR 30,7,9056
s_waitcnt lgkmcnt(8)
s_barrier
MAV 32,0,160
TR 32,7,16896
MAV 32,16,168
buffer_atomic_add v31, v26, s[16:19], s70 offen sc0
MAV 48,16,172
TR 34,7,17408
MAV 48,0,164
TR 36,7,16928
TR 38,7,17440
MAV 52,4,164
MAV 52,20,172
TR 48,7,25344
TR 50,7,25856
MAV 36,20,168
TR 52,7,25376
MAV 36,4,160
s_waitcnt lgkmcnt(7)
MAV 40,8,160
TR 54,7,25888
MAV 40,24,168
TR 40,7,16960
TR 42,7,17472
MAV 56,24,172
MAV 56,8,164
TR 44,7,16992
TR 46,7,17504
MAV 60,12,164
TR 56,7,25408
MAV 60,28,172
TR 58,7,25920
MAV 44,28,168
TR 60,7,25440
MAV 44,12,160
TR 62,7,25952
s_waitcnt lgkmcnt(8)
MAV 32,32,176
TR 0,7,33792
MAV 32,48,184
TR 2,7,34304
MAV 48,48,188
TR 4,7,33824
MAV 48,32,180
TR 6,7,34336
MAV 52,36,180
TR 16,7,42240
MAV 52,52,188
TR 18,7,42752
MAV 36,52,184
TR 20,7,42272
MAV 36,36,176
TR 22,7,42784
s_waitcnt lgkmcnt(8)
MAV 40,40,176
TR 8,7,33856
MAV 40,56,184
TR 10,7,34368
MAV 56,56,188
TR 12,7,33888
MAV 56,40,180
TR 14,7,34400
MAV 60,44,180
TR 24,7,42304
MAV 60,60,188
TR 26,7,42816
MAV 44,60,184
TR 28,7,42336
MAV 44,44,176
TR 30,7,42848
s_waitcnt vmcnt(0)
v_cmp_le_u32 vcc, 1, v31
s_nop 0
s_cbranch_vccnz .Lxs51
s_mov_b32 s15, 0
.Lxs51l:
v_mov_b32 v31, 0
buffer_atomic_add v31, v26, s[16:19], s70 offen sc0
s_add_u32 s15, s15, 1
s_cmp_gt_u32 s15, 100000
s_waitcnt vmcnt(0)
s_cbranch_scc1 .Lxs51
v_cmp_le_u32 vcc, 1, v31
s_nop 0
s_cbranch_vccz .Lxs51l
.Lxs51:
s_waitcnt lgkmcnt(8)
MAV 32,0,192
TR 32,7,50688
MAV 32,16,200
buffer_load_dwordx4 v[232:235], v4, s[16:19], s68 offen sc1
MAV 48,16,204
TR 34,7,51200
s_add_u32 s68, s68, 131072
MAV 48,0,196
TR 36,7,50720
TR 38,7,51232
MAV 52,4,196
TR 48,7,59136
MAV 52,20,204
buffer_load_dwordx4 v[236:239], v4, s[16:19], s68 offen sc1
MAV 36,20,200
TR 50,7,59648
s_add_u32 s68, s68, -130048
MAV 36,4,192
TR 52,7,59168
TR 54,7,59680
s_waitcnt lgkmcnt(8)
MAV 40,8,192
TR 40,7,50752
MAV 40,24,200
buffer_load_dwordx4 v[240:243], v4, s[16:19], s68 offen sc1
MAV 56,24,204
TR 42,7,51264
s_add_u32 s68, s68, 131072
MAV 56,8,196
TR 44,7,50784
TR 46,7,51296
MAV 60,12,196
TR 56,7,59200
MAV 60,28,204
buffer_load_dwordx4 v[244:247], v4, s[16:19], s68 offen sc1
MAV 44,28,200
TR 58,7,59712
MAV 44,12,192
TR 60,7,59232
TR 62,7,59744
s_waitcnt lgkmcnt(8)
MAV 32,32,208
MAV 32,48,216
MAV 48,48,220
MAV 48,32,212
MAV 52,36,212
MAV 52,52,220
MAV 36,52,216
MAV 36,36,208
s_waitcnt lgkmcnt(0)
MAV 40,40,208
MAV 40,56,216
MAV 56,56,220
MAV 56,40,212
MAV 60,44,212
MAV 60,60,220
MAV 44,60,216
MAV 44,44,208
s_waitcnt vmcnt(3)
v_mfma_f32_16x16x32_bf16 v[32:35], v[226:229], v[232:235], v[32:35]
s_lshl_b32 s64, s6, 14
s_lshl_b32 s65, s49, 13
s_add_u32 s64, s64, s65
v_mfma_f32_16x16x32_bf16 v[36:39], v[224:227], v[232:235], v[36:39]
s_lshl_b32 s65, s7, 9
s_add_u32 s64, s64, s65
s_lshl_b32 s65, s48, 8
s_waitcnt vmcnt(2)
v_mfma_f32_16x16x32_bf16 v[40:43], v[226:229], v[236:239], v[40:43]
s_add_u32 s64, s64, s65
s_add_u32 s64, s64, 62914560
v_and_b32 v152, 31, v1
v_mfma_f32_16x16x32_bf16 v[44:47], v[224:227], v[236:239], v[44:47]
s_lshl_b32 s62, s7, 18
v_lshlrev_b32 v152, 3, v152
v_lshrrev_b32 v153, 5, v1
s_waitcnt vmcnt(1)
v_mfma_f32_16x16x32_bf16 v[48:51], v[226:229], v[240:243], v[48:51]
s_add_u32 s62, s62, 33554432
v_lshl_add_u32 v152, v153, 28, v152
s_add_u32 s63, s62, 131072
v_mfma_f32_16x16x32_bf16 v[52:55], v[224:227], v[240:243], v[52:55]
v_cvt_pk_bf16_f32 v128, v32, v33
v_cvt_pk_bf16_f32 v129, v34, v35
s_waitcnt vmcnt(0)
v_mfma_f32_16x16x32_bf16 v[56:59], v[226:229], v[244:247], v[56:59]
v_cvt_pk_bf16_f32 v130, v36, v37
v_cvt_pk_bf16_f32 v131, v38, v39
v_mfma_f32_16x16x32_bf16 v[60:63], v[224:227], v[244:247], v[60:63]
buffer_store_dwordx4 v[128:131], v4, s[16:19], s62 offen sc1
v_cvt_pk_bf16_f32 v132, v40, v41
v_cvt_pk_bf16_f32 v133, v42, v43
v_cvt_pk_bf16_f32 v134, v44, v45
v_cvt_pk_bf16_f32 v135, v46, v47
v_cvt_pk_bf16_f32 v136, v48, v49
v_cvt_pk_bf16_f32 v137, v50, v51
v_cvt_pk_bf16_f32 v138, v52, v53
v_cvt_pk_bf16_f32 v139, v54, v55
v_cvt_pk_bf16_f32 v140, v56, v57
v_cvt_pk_bf16_f32 v141, v58, v59
v_cvt_pk_bf16_f32 v142, v60, v61
v_cvt_pk_bf16_f32 v143, v62, v63
v_pk_mul_f32 v[146:147], v[32:33], v[32:33]
buffer_store_dwordx4 v[132:135], v4, s[16:19], s63 offen sc1
v_pk_mul_f32 v[150:151], v[48:49], v[48:49]
v_pk_fma_f32 v[146:147], v[34:35], v[34:35], v[146:147]
v_pk_add_f32 v[144:145], v[32:33], v[34:35]
v_pk_fma_f32 v[150:151], v[50:51], v[50:51], v[150:151]
v_pk_add_f32 v[148:149], v[48:49], v[50:51]
v_pk_fma_f32 v[146:147], v[36:37], v[36:37], v[146:147]
v_pk_add_f32 v[144:145], v[144:145], v[36:37]
v_pk_fma_f32 v[150:151], v[52:53], v[52:53], v[150:151]
v_pk_add_f32 v[148:149], v[148:149], v[52:53]
v_pk_fma_f32 v[146:147], v[38:39], v[38:39], v[146:147]
v_pk_add_f32 v[144:145], v[144:145], v[38:39]
v_pk_fma_f32 v[150:151], v[54:55], v[54:55], v[150:151]
v_pk_add_f32 v[148:149], v[148:149], v[54:55]
buffer_store_dwordx4 v[136:139], v4, s[16:19], s62 offen offset:1024 sc1
v_pk_fma_f32 v[146:147], v[40:41], v[40:41], v[146:147]
v_pk_add_f32 v[144:145], v[144:145], v[40:41]
v_pk_fma_f32 v[150:151], v[56:57], v[56:57], v[150:151]
v_pk_add_f32 v[148:149], v[148:149], v[56:57]
v_pk_fma_f32 v[146:147], v[42:43], v[42:43], v[146:147]
v_pk_add_f32 v[144:145], v[144:145], v[42:43]
v_pk_fma_f32 v[150:151], v[58:59], v[58:59], v[150:151]
v_pk_add_f32 v[148:149], v[148:149], v[58:59]
v_pk_fma_f32 v[146:147], v[44:45], v[44:45], v[146:147]
v_pk_add_f32 v[144:145], v[144:145], v[44:45]
v_pk_fma_f32 v[150:151], v[60:61], v[60:61], v[150:151]
v_pk_add_f32 v[148:149], v[148:149], v[60:61]
v_pk_fma_f32 v[146:147], v[46:47], v[46:47], v[146:147]
buffer_store_dwordx4 v[140:143], v4, s[16:19], s63 offen offset:1024 sc1
v_pk_add_f32 v[144:145], v[144:145], v[46:47]
v_pk_fma_f32 v[150:151], v[62:63], v[62:63], v[150:151]
v_pk_add_f32 v[148:149], v[148:149], v[62:63]
v_add_f32 v144, v144, v145
v_add_f32 v146, v146, v147
v_add_f32 v148, v148, v149
v_add_f32 v150, v150, v151
s_nop 0
v_permlane16_swap_b32 v144, v148
v_permlane16_swap_b32 v146, v150
v_add_f32 v144, v144, v148
v_add_f32 v146, v146, v150
s_nop 1
v_permlane32_swap_b32 v144, v146
v_add_f32 v144, v144, v146
s_nop 1
v_permlane32_swap_b32 v144, v145
buffer_store_dwordx2 v[144:145], v152, s[16:19], s64 offen sc1
s_nop 1
s_mov_b32 s54, s58
s_mov_b32 s56, s59
v_accvgpr_write_b32 a224, v32
v_accvgpr_write_b32 a225, v33
v_accvgpr_write_b32 a226, v34
v_accvgpr_write_b32 a227, v35
v_accvgpr_write_b32 a228, v36
v_accvgpr_write_b32 a229, v37
v_accvgpr_write_b32 a230, v38
v_accvgpr_write_b32 a231, v39
v_accvgpr_write_b32 a232, v40
v_accvgpr_write_b32 a233, v41
v_accvgpr_write_b32 a234, v42
v_accvgpr_write_b32 a235, v43
v_accvgpr_write_b32 a236, v44
v_accvgpr_write_b32 a237, v45
v_accvgpr_write_b32 a238, v46
.Lpad22:
s_cbranch_execz .Lnopoll37r
v_accvgpr_write_b32 a239, v47
v_accvgpr_write_b32 a240, v48
v_accvgpr_write_b32 a241, v49
v_accvgpr_write_b32 a242, v50
v_accvgpr_write_b32 a243, v51
v_accvgpr_write_b32 a244, v52
v_accvgpr_write_b32 a245, v53
v_accvgpr_write_b32 a246, v54
v_accvgpr_write_b32 a247, v55
v_accvgpr_write_b32 a248, v56
v_accvgpr_write_b32 a249, v57
v_accvgpr_write_b32 a250, v58
v_accvgpr_write_b32 a251, v59
v_accvgpr_write_b32 a252, v60
v_accvgpr_write_b32 a253, v61
v_accvgpr_write_b32 a254, v62
v_accvgpr_write_b32 a255, v63
s_lshl_b32 s62, s3, 11
s_add_u32 s62, s62, s85
v_lshl_add_u32 v21, v1, 4, s62
v_lshrrev_b32 v2, 3, v1
v_cmp_eq_u32 vcc, 3, v2
v_add_u32 v2, 67108480, v21
s_nop 0
v_cndmask_b32 v21, v21, v2, vcc
s_sub_u32 s62, s86, 2048
v_lshl_add_u32 v22, v0, 2, s62
v_lshrrev_b32 v2, 5, v0
v_cmp_eq_u32 vcc, 3, v2
v_add_u32 v2, 67108480, v22
s_nop 0
v_cndmask_b32 v22, v22, v2, vcc
s_mul_i32 s62, s48, 4608
v_lshl_add_u32 v23, v1, 4, s62
v_lshrrev_b32 v24, 4, v1
v_mul_u32_u24 v24, 2304, v24
v_and_b32 v2, 15, v1
v_lshl_add_u32 v24, v2, 4, v24
s_mov_b32 s52, 33554432
s_mul_i32 s55, s3, 2304
v_bfe_u32 v25, v1, 3, 2
v_mul_u32_u24 v25, 3104, v25
v_bfe_u32 v2, v1, 2, 1
v_lshl_add_u32 v25, v2, 7, v25
v_bfe_u32 v2, v1, 5, 1
v_lshl_add_u32 v25, v2, 8, v25
v_and_b32 v2, 3, v1
v_lshl_add_u32 v25, v2, 3, v25
s_lshl_b32 s62, s49, 6
s_add_u32 s62, s62, 67584
v_add_u32 v25, s62, v25
s_lshl_b32 s62, s8, 1
s_add_u32 s62, s62, s3
s_lshr_b32 s63, s50, 2
s_cmp_lt_u32 s3, 2
s_cselect_b32 s62, s62, s63
s_lshl_b32 s62, s62, 13
s_cmp_eq_u32 s3, 3
s_cselect_b32 s62, 268435456, s62
v_lshl_add_u32 v26, v1, 4, s62
s_lshr_b32 s63, s20, 7
s_sub_u32 s63, 3, s63
s_and_b32 s63, s63, 7
s_and_b32 s62, s9, 8
s_add_u32 s63, s63, s62
s_lshl_b32 s62, s5, 2
s_add_u32 s62, s62, s3
s_mul_i32 s62, s62, 12288
s_lshl_b32 s64, s63, 7
s_add_u32 s62, s62, s64
s_xor_b32 s63, s63, s9
s_cmp_lt_u32 s63, 4
s_cselect_b32 s62, s62, 16777216
v_lshrrev_b32 v14, 3, v1
v_min_u32 v14, 5, v14
v_lshl_add_u32 v14, v14, 11, s62
s_mov_b32 s44, 983040
buffer_load_dword v27, v14, s[20:23], s44 offen
s_mov_b32 s44, 2555904
s_mul_i32 s59, s3, 2080
s_and_b32 s87, s6, 3
s_lshl_b32 s87, s87, 17
v_bfe_u32 v5, v1, 3, 1
v_lshrrev_b32 v2, 4, v1
v_lshl_add_u32 v5, v2, 3, v5
s_lshl_b32 s62, s3, 1
v_add_u32 v5, s62, v5
v_mul_u32_u24 v5, 2048, v5
v_and_b32 v2, 7, v1
v_lshl_add_u32 v5, v2, 4, v5
s_lshl_b32 s62, s7, 7
v_add_u32 v5, s62, v5
v_add_u32 v6, 64512, v5
s_lshl_b32 s62, s6, 10
s_add_u32 s62, s62, 30474240
s_lshl_b32 s64, s8, 10
s_add_u32 s64, s64, 30474240
s_lshr_b32 s67, s9, 1
s_and_b32 s67, s67, 3
s_lshl_b32 s67, s67, 7
s_add_u32 s64, s64, s67
s_lshr_b32 s65, s50, 3
s_lshl_b32 s65, s65, 10
s_add_u32 s65, s65, 30474240
s_lshr_b32 s67, s9, 1
s_and_b32 s67, s67, 3
s_lshl_b32 s67, s67, 7
s_add_u32 s65, s65, s67
s_waitcnt lgkmcnt(0)
s_mov_b32 s0, 0
s_mov_b32 s1, 0
s_mov_b32 s67, 1
s_waitcnt vmcnt(1) lgkmcnt(0)
s_cmp_lg_u32 s3, 1
s_barrier
s_cbranch_scc1 .Lnopoll53
s_atomic_add s67, s[16:17], s62 offset:0x0
s_atomic_add s67, s[16:17], s62 offset:0x80
s_atomic_add s67, s[16:17], s62 offset:0x100
s_atomic_add s67, s[16:17], s62 offset:0x180
s_atomic_umax s0, s[16:17], s64 glc
s_atomic_umax s1, s[16:17], s65 glc
s_add_u32 m0, s56, 117248
s_nop 0
buffer_load_dwordx4 v18, s[20:23], s54 offen lds
v_lshrrev_b32 v2, 4, v1
v_lshlrev_b32 v2, 2, v2
v_and_b32 v13, 15, v1
v_sub_u32 v2, v13, v2
v_mov_b32 v13, 0xff61b1e6
v_subrev_u32 v54, 0, v2
v_cmp_gt_u32 vcc, 8, v54
s_nop 1
v_cndmask_b32 v50, v13, 0, vcc
buffer_load_dwordx4 v19, s[20:23], s54 offen offset:1024 lds
v_cmp_gt_i32 vcc, -8, v54
s_nop 1
v_cndmask_b32 v46, v13, 0, vcc
v_subrev_u32 v54, 1, v2
v_cmp_gt_u32 vcc, 8, v54
s_nop 1
v_cndmask_b32 v51, v13, 0, vcc
v_cmp_gt_i32 vcc, -8, v54
s_nop 1
v_cndmask_b32 v47, v13, 0, vcc
v_subrev_u32 v54, 2, v2
buffer_load_dwordx4 v20, s[20:23], s54 offen offset:2048 lds
s_add_u32 s54, s54, 196608
v_cmp_gt_u32 vcc, 8, v54
s_nop 1
v_cndmask_b32 v52, v13, 0, vcc
v_cmp_gt_i32 vcc, -8, v54
s_nop 1
v_cndmask_b32 v48, v13, 0, vcc
v_subrev_u32 v54, 3, v2
v_cmp_gt_u32 vcc, 8, v54
s_nop 1
v_cndmask_b32 v53, v13, 0, vcc
v_cmp_gt_i32 vcc, -8, v54
s_add_u32 m0, s56, 129664
s_nop 0
buffer_load_dwordx4 v18, s[20:23], s54 offen lds
v_cndmask_b32 v49, v13, 0, vcc
s_cmp_lt_u32 s8, 2
s_cselect_b64 vcc, -1, 0
v_cndmask_b32 v54, v46, v13, vcc
v_cndmask_b32 v55, v47, v13, vcc
v_cndmask_b32 v56, v48, v13, vcc
v_cndmask_b32 v57, v49, v13, vcc
v_mov_b64 v[60:61], 0
buffer_load_dwordx4 v19, s[20:23], s54 offen offset:1024 lds
v_mov_b64 v[62:63], 0
v_mov_b64 v[64:65], 0
v_mov_b64 v[66:67], 0
v_mov_b64 v[68:69], 0
v_mov_b64 v[70:71], 0
v_mov_b64 v[72:73], 0
v_mov_b64 v[74:75], 0
v_mov_b64 v[76:77], 0
buffer_load_dwordx4 v20, s[20:23], s54 offen offset:2048 lds
s_add_u32 s54, s54, 196608
v_mov_b64 v[78:79], 0
v_mov_b64 v[80:81], 0
v_mov_b64 v[82:83], 0
v_mov_b64 v[84:85], 0
v_mov_b64 v[86:87], 0
v_mov_b64 v[88:89], 0
v_mov_b64 v[90:91], 0
v_mov_b64 v[92:93], 0
s_add_u32 m0, s56, 67584
s_nop 0
buffer_load_dwordx4 v18, s[20:23], s54 offen lds
v_mov_b64 v[94:95], 0
v_mov_b64 v[96:97], 0
v_mov_b64 v[98:99], 0
v_mov_b64 v[100:101], 0
v_mov_b64 v[102:103], 0
v_mov_b64 v[104:105], 0
v_mov_b64 v[106:107], 0
v_mov_b64 v[108:109], 0
buffer_load_dwordx4 v19, s[20:23], s54 offen offset:1024 lds
v_mov_b64 v[110:111], 0
v_mov_b64 v[112:113], 0
v_mov_b64 v[114:115], 0
v_mov_b64 v[116:117], 0
v_mov_b64 v[118:119], 0
v_mov_b64 v[120:121], 0
v_mov_b64 v[122:123], 0
v_mov_b64 v[124:125], 0
buffer_load_dwordx4 v20, s[20:23], s54 offen offset:2048 lds
s_add_u32 s54, s54, 196608
v_mov_b64 v[126:127], 0
v_mov_b64 v[128:129], 0
v_mov_b64 v[130:131], 0
v_mov_b64 v[132:133], 0
v_mov_b64 v[134:135], 0
v_mov_b64 v[136:137], 0
v_mov_b64 v[138:139], 0
v_mov_b64 v[140:141], 0
s_add_u32 m0, s56, 80000
s_nop 0
buffer_load_dwordx4 v18, s[20:23], s54 offen lds
v_mov_b64 v[142:143], 0
v_mov_b64 v[144:145], 0
v_mov_b64 v[146:147], 0
v_mov_b64 v[148:149], 0
v_mov_b64 v[150:151], 0
v_mov_b64 v[152:153], 0
v_mov_b64 v[154:155], 0
v_mov_b64 v[156:157], 0
buffer_load_dwordx4 v19, s[20:23], s54 offen offset:1024 lds
v_mov_b64 v[158:159], 0
v_mov_b64 v[160:161], 0
v_mov_b64 v[162:163], 0
v_mov_b64 v[164:165], 0
v_mov_b64 v[166:167], 0
v_mov_b64 v[168:169], 0
v_mov_b64 v[170:171], 0
v_mov_b64 v[172:173], 0
buffer_load_dwordx4 v20, s[20:23], s54 offen offset:2048 lds
s_add_u32 s54, s54, 196608
v_mov_b64 v[174:175], 0
s_mov_b32 s75, 62914560
v_and_b32 v10, 15, v1
v_lshlrev_b32 v12, 2, v10
v_lshlrev_b32 v10, 4, v10
v_add_u32 v10, 152576, v10
v_lshrrev_b32 v11, 4, v1
v_lshlrev_b32 v11, 4, v11
s_add_u32 m0, s56, 92416
s_nop 0
buffer_load_dwordx4 v18, s[20:23], s54 offen lds
s_lshl_b32 s62, s49, 7
s_add_u32 s62, s62, 158720
v_add_u32 v12, s62, v12
v_add_u32 v13, s62, v11
v_add_u32 v11, 156672, v11
s_lshl_b32 s62, s3, 11
s_add_u32 s62, s62, 143360
v_lshl_add_u32 v8, v1, 4, s62
buffer_load_dwordx4 v19, s[20:23], s54 offen offset:1024 lds
v_xor_b32 v9, 2048, v8
v_mov_b32 v248, 0x3f803f80
v_mov_b32 v249, 0x3f803f80
v_mov_b32 v250, 0x3f803f80
v_mov_b32 v251, 0x3f803f80
v_and_b32 v7, 31, v1
v_lshrrev_b32 v2, 5, v1
v_lshl_add_u32 v7, v7, 1, v2
buffer_load_dwordx4 v20, s[20:23], s54 offen offset:2048 lds
s_add_u32 s54, s54, 196608
v_and_b32 v2, 0xc0, v0
v_add_u32 v7, v7, v2
v_lshlrev_b32 v17, 2, v7
v_add_u32 v17, 156672, v17
v_lshlrev_b32 v7, 4, v7
v_add_u32 v7, 152576, v7
s_lshl_b32 s74, s9, 1
s_add_u32 s74, s74, s49
s_lshl_b32 s74, s74, 17
s_add_u32 s74, s74, s85
s_lshl_b32 s63, s48, 12
s_add_u32 s74, s74, s63
s_add_u32 s74, s74, 37748736
s_mov_b32 s62, 0
v_lshl_add_u32 v4, v1, 4, s62
v_lshrrev_b32 v2, 3, v1
v_cmp_eq_u32 vcc, 3, v2
v_add_u32 v2, 67108480, v4
s_nop 0
v_cndmask_b32 v4, v4, v2, vcc
s_mov_b32 s15, 0
.Lpoll52:
s_min_u32 s66, s0, s1
s_cmp_ge_u32 s66, 16
s_cbranch_scc1 .Lnopoll53r
s_atomic_umax s0, s[16:17], s64 glc
s_atomic_umax s1, s[16:17], s65 glc
s_add_u32 s15, s15, 1
s_cmp_le_u32 s15, 100000
s_waitcnt lgkmcnt(2)
s_cbranch_scc1 .Lpoll52
s_branch .Lnopoll53r
.Lnopoll53:
s_add_u32 m0, s56, 117248
s_nop 0
buffer_load_dwordx4 v18, s[20:23], s54 offen lds
v_lshrrev_b32 v2, 4, v1
v_lshlrev_b32 v2, 2, v2
v_and_b32 v13, 15, v1
v_sub_u32 v2, v13, v2
v_mov_b32 v13, 0xff61b1e6
v_subrev_u32 v54, 0, v2
v_cmp_gt_u32 vcc, 8, v54
s_nop 1
v_cndmask_b32 v50, v13, 0, vcc
buffer_load_dwordx4 v19, s[20:23], s54 offen offset:1024 lds
v_cmp_gt_i32 vcc, -8, v54
s_nop 1
v_cndmask_b32 v46, v13, 0, vcc
v_subrev_u32 v54, 1, v2
v_cmp_gt_u32 vcc, 8, v54
s_nop 1
v_cndmask_b32 v51, v13, 0, vcc
v_cmp_gt_i32 vcc, -8, v54
s_nop 1
v_cndmask_b32 v47, v13, 0, vcc
v_subrev_u32 v54, 2, v2
buffer_load_dwordx4 v20, s[20:23], s54 offen offset:2048 lds
s_add_u32 s54, s54, 196608
v_cmp_gt_u32 vcc, 8, v54
s_nop 1
v_cndmask_b32 v52, v13, 0, vcc
v_cmp_gt_i32 vcc, -8, v54
s_nop 1
v_cndmask_b32 v48, v13, 0, vcc
v_subrev_u32 v54, 3, v2
v_cmp_gt_u32 vcc, 8, v54
s_nop 1
v_cndmask_b32 v53, v13, 0, vcc
v_cmp_gt_i32 vcc, -8, v54
s_add_u32 m0, s56, 129664
s_nop 0
buffer_load_dwordx4 v18, s[20:23], s54 offen lds
v_cndmask_b32 v49, v13, 0, vcc
s_cmp_lt_u32 s8, 2
s_cselect_b64 vcc, -1, 0
v_cndmask_b32 v54, v46, v13, vcc
v_cndmask_b32 v55, v47, v13, vcc
v_cndmask_b32 v56, v48, v13, vcc
v_cndmask_b32 v57, v49, v13, vcc
v_mov_b64 v[60:61], 0
buffer_load_dwordx4 v19, s[20:23], s54 offen offset:1024 lds
v_mov_b64 v[62:63], 0
v_mov_b64 v[64:65], 0
v_mov_b64 v[66:67], 0
v_mov_b64 v[68:69], 0
v_mov_b64 v[70:71], 0
v_mov_b64 v[72:73], 0
v_mov_b64 v[74:75], 0
v_mov_b64 v[76:77], 0
buffer_load_dwordx4 v20, s[20:23], s54 offen offset:2048 lds
s_add_u32 s54, s54, 196608
v_mov_b64 v[78:79], 0
v_mov_b64 v[80:81], 0
v_mov_b64 v[82:83], 0
v_mov_b64 v[84:85], 0
v_mov_b64 v[86:87], 0
v_mov_b64 v[88:89], 0
v_mov_b64 v[90:91], 0
v_mov_b64 v[92:93], 0
s_add_u32 m0, s56, 67584
s_nop 0
buffer_load_dwordx4 v18, s[20:23], s54 offen lds
v_mov_b64 v[94:95], 0
v_mov_b64 v[96:97], 0
v_mov_b64 v[98:99], 0
v_mov_b64 v[100:101], 0
v_mov_b64 v[102:103], 0
v_mov_b64 v[104:105], 0
v_mov_b64 v[106:107], 0
v_mov_b64 v[108:109], 0
buffer_load_dwordx4 v19, s[20:23], s54 offen offset:1024 lds
v_mov_b64 v[110:111], 0
v_mov_b64 v[112:113], 0
v_mov_b64 v[114:115], 0
v_mov_b64 v[116:117], 0
v_mov_b64 v[118:119], 0
v_mov_b64 v[120:121], 0
v_mov_b64 v[122:123], 0
v_mov_b64 v[124:125], 0
buffer_load_dwordx4 v20, s[20:23], s54 offen offset:2048 lds
s_add_u32 s54, s54, 196608
v_mov_b64 v[126:127], 0
v_mov_b64 v[128:129], 0
v_mov_b64 v[130:131], 0
v_mov_b64 v[132:133], 0
v_mov_b64 v[134:135], 0
v_mov_b64 v[136:137], 0
v_mov_b64 v[138:139], 0
v_mov_b64 v[140:141], 0
s_add_u32 m0, s56, 80000
s_nop 0
buffer_load_dwordx4 v18, s[20:23], s54 offen lds
v_mov_b64 v[142:143], 0
v_mov_b64 v[144:145], 0
v_mov_b64 v[146:147], 0
v_mov_b64 v[148:149], 0
v_mov_b64 v[150:151], 0
v_mov_b64 v[152:153], 0
v_mov_b64 v[154:155], 0
v_mov_b64 v[156:157], 0
buffer_load_dwordx4 v19, s[20:23], s54 offen offset:1024 lds
v_mov_b64 v[158:159], 0
v_mov_b64 v[160:161], 0
v_mov_b64 v[162:163], 0
v_mov_b64 v[164:165], 0
v_mov_b64 v[166:167], 0
v_mov_b64 v[168:169], 0
v_mov_b64 v[170:171], 0
v_mov_b64 v[172:173], 0
buffer_load_dwordx4 v20, s[20:23], s54 offen offset:2048 lds
s_add_u32 s54, s54, 196608
v_mov_b64 v[174:175], 0
s_mov_b32 s75, 62914560
v_and_b32 v10, 15, v1
v_lshlrev_b32 v12, 2, v10
v_lshlrev_b32 v10, 4, v10
v_add_u32 v10, 152576, v10
v_lshrrev_b32 v11, 4, v1
v_lshlrev_b32 v11, 4, v11
s_add_u32 m0, s56, 92416
s_nop 0
buffer_load_dwordx4 v18, s[20:23], s54 offen lds
s_lshl_b32 s62, s49, 7
s_add_u32 s62, s62, 158720
v_add_u32 v12, s62, v12
v_add_u32 v13, s62, v11
v_add_u32 v11, 156672, v11
s_lshl_b32 s62, s3, 11
s_add_u32 s62, s62, 143360
v_lshl_add_u32 v8, v1, 4, s62
buffer_load_dwordx4 v19, s[20:23], s54 offen offset:1024 lds
v_xor_b32 v9, 2048, v8
v_mov_b32 v248, 0x3f803f80
v_mov_b32 v249, 0x3f803f80
v_mov_b32 v250, 0x3f803f80
v_mov_b32 v251, 0x3f803f80
v_and_b32 v7, 31, v1
v_lshrrev_b32 v2, 5, v1
v_lshl_add_u32 v7, v7, 1, v2
buffer_load_dwordx4 v20, s[20:23], s54 offen offset:2048 lds
s_add_u32 s54, s54, 196608
v_and_b32 v2, 0xc0, v0
v_add_u32 v7, v7, v2
v_lshlrev_b32 v17, 2, v7
v_add_u32 v17, 156672, v17
v_lshlrev_b32 v7, 4, v7
v_add_u32 v7, 152576, v7
s_lshl_b32 s74, s9, 1
s_add_u32 s74, s74, s49
s_lshl_b32 s74, s74, 17
s_add_u32 s74, s74, s85
s_lshl_b32 s63, s48, 12
s_add_u32 s74, s74, s63
s_add_u32 s74, s74, 37748736
s_mov_b32 s62, 0
v_lshl_add_u32 v4, v1, 4, s62
v_lshrrev_b32 v2, 3, v1
v_cmp_eq_u32 vcc, 3, v2
v_add_u32 v2, 67108480, v4
s_nop 0
v_cndmask_b32 v4, v4, v2, vcc
s_mov_b64 exec, 0
s_cmp_eq_u32 s3, 2
s_cbranch_scc1 .Lpad23
s_cmp_eq_u32 s3, 3
s_cbranch_scc1 .Lpad24
s_branch .Lpad25
.Lnopoll53r:
s_mov_b64 exec, -1
s_waitcnt vmcnt(9)
s_barrier
s_cmp_eq_u32 s48, 1
s_cbranch_scc1 .Lqkv55
s_add_u32 m0, s55, 36864
s_nop 0
buffer_load_dwordx4 v21, s[16:19], s52 offen sc1 lds
buffer_load_dwordx4 v21, s[16:19], s52 offen offset:1024 sc1 lds
buffer_load_dword v22, s[16:19], s52 offen offset:2048 sc1 lds
s_add_u32 s52, s52, 131072
TR 80,25,49664
TR 82,25,50176
TR 84,25,62080
s_add_u32 m0, s55, 46080
s_nop 0
buffer_load_dwordx4 v21, s[16:19], s52 offen sc1 lds
buffer_load_dwordx4 v21, s[16:19], s52 offen offset:1024 sc1 lds
buffer_load_dword v22, s[16:19], s52 offen offset:2048 sc1 lds
s_add_u32 s52, s52, 131072
TR 86,25,62592
TR 88,25,50688
TR 90,25,51200
s_add_u32 m0, s55, 0
s_nop 0
buffer_load_dwordx4 v21, s[16:19], s52 offen sc1 lds
buffer_load_dwordx4 v21, s[16:19], s52 offen offset:1024 sc1 lds
buffer_load_dword v22, s[16:19], s52 offen offset:2048 sc1 lds
s_add_u32 s52, s52, 131072
TR 92,25,63104
TR 94,25,63616
TR 96,25,51712
s_add_u32 m0, s55, 9216
s_nop 0
buffer_load_dwordx4 v21, s[16:19], s52 offen sc1 lds
buffer_load_dwordx4 v21, s[16:19], s52 offen offset:1024 sc1 lds
buffer_load_dword v22, s[16:19], s52 offen offset:2048 sc1 lds
s_add_u32 s52, s52, 131072
TR 98,25,52224
TR 100,25,64128
TR 102,25,64640
s_add_u32 m0, s55, 18432
s_nop 0
buffer_load_dwordx4 v21, s[16:19], s52 offen sc1 lds
buffer_load_dwordx4 v21, s[16:19], s52 offen offset:1024 sc1 lds
buffer_load_dword v22, s[16:19], s52 offen offset:2048 sc1 lds
s_add_u32 s52, s52, 131072
ds_read_b128 v[28:31], v13
ds_read_b128 v[32:35], v13 offset:64
ds_read_b128 v[36:39], v13 offset:256
s_add_u32 m0, s55, 27648
s_nop 0
buffer_load_dwordx4 v21, s[16:19], s52 offen sc1 lds
buffer_load_dwordx4 v21, s[16:19], s52 offen offset:1024 sc1 lds
buffer_load_dword v22, s[16:19], s52 offen offset:2048 sc1 lds
s_add_u32 s52, s52, 131072
ds_read_b128 v[40:43], v13 offset:320
ds_read_b32 v44, v12 offset:512
ds_read_b32 v45, v12 offset:576
s_waitcnt vmcnt(12)
s_barrier
RD 0,23,36864
RD 4,23,37888
RD 8,23,39168
RD 12,23,40192
RD 16,24,38912
RD 20,23,46080
RD 24,23,47104
RD 28,23,48384
RD 32,23,49408
RD 36,24,48128
s_waitcnt lgkmcnt(0)
s_mov_b32 s15, -2
.p2align 6
.Lk57:
s_waitcnt vmcnt(9) lgkmcnt(8)
s_barrier
MAA 60,80,0
TR 104,25,49696
s_add_u32 m0, s56, 104832
MAA 60,84,20
buffer_load_dwordx4 v18, s[20:23], s54 offen lds
MAA 64,84,24
TR 106,25,50208
v_add_f32 v164, v164, v168
MAA 64,80,4
TR 108,25,62112
MAA 68,80,8
TR 110,25,62624
MAA 68,84,28
buffer_load_dwordx4 v19, s[20:23], s54 offen offset:1024 lds
MAA 72,84,32
TR 112,25,50720
v_add_f32 v165, v165, v169
MAA 72,80,12
TR 114,25,51232
s_waitcnt lgkmcnt(6)
MAA 156,88,16
TR 116,25,63136
MAA 156,92,36
buffer_load_dwordx4 v20, s[20:23], s54 offen offset:2048 lds
MAA 104,92,32
s_add_u32 s54, s54, 196608
s_add_u32 m0, s55, 36864
MAA 104,88,12
buffer_load_dwordx4 v21, s[16:19], s52 offen sc1 lds
MAA 100,88,8
TR 118,25,63648
MAA 100,92,28
TR 120,25,51744
v_add_f32 v166, v166, v170
MAA 96,92,24
TR 122,25,52256
MAA 96,88,4
buffer_load_dwordx4 v21, s[16:19], s52 offen offset:1024 sc1 lds
MAA 92,88,0
TR 124,25,64160
MAA 92,92,20
TR 126,25,64672
v_add_f32 v167, v167, v171
MAA 124,20,100
ds_read_b128 a[40:43], v23
MAA 124,0,96
buffer_load_dword v22, s[16:19], s52 offen offset:2048 sc1 lds
MAA 128,4,96
RD 44,23,1024
s_add_u32 s52, s52, 131072
MAA 128,24,100
buffer_load_dword v27, v14, s[20:23], s44 offen
MAA 132,28,100
RD 48,23,2304
s_add_u32 s44, s44, 1572864
MAA 132,8,96
RD 52,23,3328
MAA 136,12,96
RD 56,24,2048
MAA 136,32,100
s_waitcnt vmcnt(13) lgkmcnt(5)
s_barrier
MAA 76,104,0
RD 60,23,9216
s_add_u32 m0, s56, 117248
MAA 76,108,20
buffer_load_dwordx4 v18, s[20:23], s54 offen lds
MAA 80,108,24
RD 64,23,10240
MAA 80,104,4
RD 68,23,11520
MAA 84,104,8
RD 72,23,12544
MAA 84,108,28
buffer_load_dwordx4 v19, s[20:23], s54 offen offset:1024 lds
MAA 88,108,32
RD 76,24,11264
MAA 88,104,12
buffer_load_dwordx4 v20, s[20:23], s54 offen offset:2048 lds
MAA 160,112,16
ds_read_b64_tr_b16 a[80:81], v25
s_add_u32 s54, s54, 196608
MAA 160,116,36
TR 82,25,512
MAA 120,116,32
TR 84,25,12416
s_add_u32 m0, s55, 46080
MAA 120,112,12
buffer_load_dwordx4 v21, s[16:19], s52 offen sc1 lds
MAA 116,112,8
TR 86,25,12928
MAA 116,116,28
TR 88,25,1024
MAA 112,116,24
TR 90,25,1536
MAA 112,112,4
buffer_load_dwordx4 v21, s[16:19], s52 offen offset:1024 sc1 lds
MAA 108,112,0
TR 92,25,13440
MAA 108,116,20
TR 94,25,13952
MAA 140,20,124
TR 96,25,2048
MAA 140,0,120
buffer_load_dword v22, s[16:19], s52 offen offset:2048 sc1 lds
MAA 144,4,120
TR 98,25,2560
s_add_u32 s52, s52, 131072
MAA 144,24,124
buffer_load_dwordx4 v[168:171], v26, s[16:19], s75 offen sc1
MAA 148,28,124
TR 100,25,14464
MAA 148,8,120
TR 102,25,14976
MAA 152,12,120
MAA 152,32,124
s_waitcnt vmcnt(17) lgkmcnt(8)
s_barrier
MAA 60,80,40
TR 104,25,32
s_add_u32 m0, s56, 129664
MAA 60,84,60
buffer_load_dwordx4 v18, s[20:23], s54 offen lds
MAA 64,84,64
.Lpad23:
s_cbranch_execz .Lpad26
TR 106,25,544
v_add_f32 v164, v164, v172
MAA 64,80,44
TR 108,25,12448
MAA 68,80,48
TR 110,25,12960
MAA 68,84,68
buffer_load_dwordx4 v19, s[20:23], s54 offen offset:1024 lds
MAA 72,84,72
TR 112,25,1056
MAA 72,80,52
TR 114,25,1568
s_waitcnt lgkmcnt(6)
MAA 156,88,56
TR 116,25,13472
v_add_f32 v165, v165, v173
MAA 156,92,76
buffer_load_dwordx4 v20, s[20:23], s54 offen offset:2048 lds
MAA 104,92,72
TR 118,25,13984
s_add_u32 s54, s54, 196608
MAA 104,88,52
TR 120,25,2080
MAA 100,88,48
s_add_u32 m0, s55, 0
MAA 100,92,68
buffer_load_dwordx4 v21, s[16:19], s52 offen sc1 lds
MAA 96,92,64
TR 122,25,2592
v_add_f32 v166, v166, v174
MAA 96,88,44
TR 124,25,14496
MAA 92,88,40
TR 126,25,15008
MAA 92,92,60
buffer_load_dwordx4 v21, s[16:19], s52 offen offset:1024 sc1 lds
MAA 124,60,100
RD 0,23,18432
MAA 124,40,96
RD 4,23,19456
v_add_f32 v167, v167, v175
MAA 128,44,96
RD 8,23,20736
MAA 128,64,100
buffer_load_dword v22, s[16:19], s52 offen offset:2048 sc1 lds
MAA 132,68,100
RD 12,23,21760
s_add_u32 s52, s52, 131072
MAA 132,48,96
RD 16,24,20480
MAA 136,52,96
MAA 136,72,100
s_waitcnt vmcnt(17) lgkmcnt(5)
s_barrier
MAA 76,104,40
RD 20,23,27648
s_add_u32 m0, s56, 67584
MAA 76,108,60
buffer_load_dwordx4 v18, s[20:23], s54 offen lds
MAA 80,108,64
RD 24,23,28672
MAA 80,104,44
RD 28,23,29952
MAA 84,104,48
RD 32,23,30976
MAA 84,108,68
buffer_load_dwordx4 v19, s[20:23], s54 offen offset:1024 lds
MAA 88,108,72
RD 36,24,29696
MAA 88,104,52
buffer_load_dwordx4 v20, s[20:23], s54 offen offset:2048 lds
MAA 160,112,56
TR 80,25,24832
s_add_u32 s54, s54, 196608
MAA 160,116,76
TR 82,25,25344
MAA 120,116,72
TR 84,25,37248
s_add_u32 m0, s55, 9216
MAA 120,112,52
buffer_load_dwordx4 v21, s[16:19], s52 offen sc1 lds
MAA 116,112,48
TR 86,25,37760
MAA 116,116,68
TR 88,25,25856
MAA 112,116,64
TR 90,25,26368
MAA 112,112,44
buffer_load_dwordx4 v21, s[16:19], s52 offen offset:1024 sc1 lds
MAA 108,112,40
TR 92,25,38272
MAA 108,116,60
TR 94,25,38784
MAA 140,60,124
TR 96,25,26880
MAA 140,40,120
buffer_load_dword v22, s[16:19], s52 offen offset:2048 sc1 lds
MAA 144,44,120
TR 98,25,27392
s_add_u32 s52, s52, 131072
MAA 144,64,124
buffer_load_dwordx4 v[172:175], v26, s[16:19], s75 offen offset:1024 sc1
MAA 148,68,124
TR 100,25,39296
s_add_u32 s75, s75, 2048
MAA 148,48,120
TR 102,25,39808
MAA 152,52,120
MAA 152,72,124
s_waitcnt vmcnt(21) lgkmcnt(8)
s_barrier
MAA 60,80,0
TR 104,25,24864
s_add_u32 m0, s56, 80000
MAA 60,84,20
buffer_load_dwordx4 v18, s[20:23], s54 offen lds
MAA 64,84,24
TR 106,25,25376
MAA 64,80,4
TR 108,25,37280
MAA 68,80,8
TR 110,25,37792
MAA 68,84,28
buffer_load_dwordx4 v19, s[20:23], s54 offen offset:1024 lds
MAA 72,84,32
TR 112,25,25888
MAA 72,80,12
TR 114,25,26400
s_waitcnt lgkmcnt(6)
MAA 156,88,16
TR 116,25,38304
MAA 156,92,36
buffer_load_dwordx4 v20, s[20:23], s54 offen offset:2048 lds
MAA 104,92,32
TR 118,25,38816
s_add_u32 s54, s54, 196608
MAA 104,88,12
TR 120,25,26912
MAA 100,88,8
s_add_u32 m0, s55, 18432
MAA 100,92,28
buffer_load_dwordx4 v21, s[16:19], s52 offen sc1 lds
MAA 96,92,24
TR 122,25,27424
MAA 96,88,4
TR 124,25,39328
MAA 92,88,0
TR 126,25,39840
MAA 92,92,20
buffer_load_dwordx4 v21, s[16:19], s52 offen offset:1024 sc1 lds
MAA 124,20,100
RD 40,23,36864
MAA 124,0,96
RD 44,23,37888
MAA 128,4,96
RD 48,23,39168
MAA 128,24,100
buffer_load_dword v22, s[16:19], s52 offen offset:2048 sc1 lds
MAA 132,28,100
RD 52,23,40192
s_add_u32 s52, s52, 131072
MAA 132,8,96
RD 56,24,38912
MAA 136,12,96
MAA 136,32,100
s_waitcnt vmcnt(16) lgkmcnt(5)
s_barrier
MAA 76,104,0
RD 60,23,46080
s_add_u32 m0, s56, 92416
MAA 76,108,20
buffer_load_dwordx4 v18, s[20:23], s54 offen lds
MAA 80,108,24
RD 64,23,47104
MAA 80,104,4
RD 68,23,48384
MAA 84,104,8
RD 72,23,49408
MAA 84,108,28
buffer_load_dwordx4 v19, s[20:23], s54 offen offset:1024 lds
MAA 88,108,32
RD 76,24,48128
MAA 88,104,12
TR 80,25,49664
MAA 160,112,16
TR 82,25,50176
MAA 160,116,36
buffer_load_dwordx4 v20, s[20:23], s54 offen offset:2048 lds
MAA 120,116,32
TR 84,25,62080
s_add_u32 s54, s54, 196608
MAA 120,112,12
TR 86,25,62592
MAA 116,112,8
s_add_u32 m0, s55, 27648
MAA 116,116,28
buffer_load_dwordx4 v21, s[16:19], s52 offen sc1 lds
MAA 112,116,24
TR 88,25,50688
MAA 112,112,4
TR 90,25,51200
MAA 108,112,0
TR 92,25,63104
MAA 108,116,20
buffer_load_dwordx4 v21, s[16:19], s52 offen offset:1024 sc1 lds
MAA 140,20,124
TR 94,25,63616
MAA 140,0,120
TR 96,25,51712
MAA 144,4,120
TR 98,25,52224
MAA 144,24,124
buffer_load_dword v22, s[16:19], s52 offen offset:2048 sc1 lds
MAA 148,28,124
TR 100,25,64128
s_add_u32 s52, s52, 131072
MAA 148,8,120
TR 102,25,64640
MAA 152,12,120
MAA 152,32,124
s_waitcnt vmcnt(19) lgkmcnt(8)
s_barrier
MAA 60,80,40
TR 104,25,49696
s_add_u32 m0, s56, 104832
MAA 60,84,60
buffer_load_dwordx4 v18, s[20:23], s54 offen lds
MAA 64,84,64
TR 106,25,50208
v_add_f32 v164, v164, v168
MAA 64,80,44
TR 108,25,62112
MAA 68,80,48
TR 110,25,62624
MAA 68,84,68
buffer_load_dwordx4 v19, s[20:23], s54 offen offset:1024 lds
MAA 72,84,72
TR 112,25,50720
v_add_f32 v165, v165, v169
MAA 72,80,52
TR 114,25,51232
s_waitcnt lgkmcnt(6)
MAA 156,88,56
TR 116,25,63136
MAA 156,92,76
buffer_load_dwordx4 v20, s[20:23], s54 offen offset:2048 lds
MAA 104,92,72
s_add_u32 s54, s54, 196608
s_add_u32 m0, s55, 36864
MAA 104,88,52
buffer_load_dwordx4 v21, s[16:19], s52 offen sc1 lds
MAA 100,88,48
TR 118,25,63648
MAA 100,92,68
TR 120,25,51744
v_add_f32 v166, v166, v170
MAA 96,92,64
TR 122,25,52256
MAA 96,88,44
buffer_load_dwordx4 v21, s[16:19], s52 offen offset:1024 sc1 lds
MAA 92,88,40
TR 124,25,64160
MAA 92,92,60
TR 126,25,64672
v_add_f32 v167, v167, v171
MAA 124,60,100
ds_read_b128 a[0:3], v23
MAA 124,40,96
buffer_load_dword v22, s[16:19], s52 offen offset:2048 sc1 lds
MAA 128,44,96
RD 4,23,1024
s_add_u32 s52, s52, 131072
MAA 128,64,100
buffer_load_dword v27, v14, s[20:23], s44 offen
MAA 132,68,100
RD 8,23,2304
s_add_u32 s44, s44, 1572864
MAA 132,48,96
RD 12,23,3328
MAA 136,52,96
RD 16,24,2048
MAA 136,72,100
s_waitcnt vmcnt(16) lgkmcnt(5)
s_barrier
MAA 76,104,40
RD 20,23,9216
s_add_u32 m0, s56, 117248
MAA 76,108,60
buffer_load_dwordx4 v18, s[20:23], s54 offen lds
MAA 80,108,64
RD 24,23,10240
MAA 80,104,44
RD 28,23,11520
MAA 84,104,48
RD 32,23,12544
MAA 84,108,68
buffer_load_dwordx4 v19, s[20:23], s54 offen offset:1024 lds
MAA 88,108,72
RD 36,24,11264
MAA 88,104,52
buffer_load_dwordx4 v20, s[20:23], s54 offen offset:2048 lds
MAA 160,112,56
ds_read_b64_tr_b16 a[80:81], v25
s_add_u32 s54, s54, 196608
MAA 160,116,76
TR 82,25,512
MAA 120,116,72
TR 84,25,12416
s_add_u32 m0, s55, 46080
MAA 120,112,52
buffer_load_dwordx4 v21, s[16:19], s52 offen sc1 lds
MAA 116,112,48
TR 86,25,12928
MAA 116,116,68
TR 88,25,1024
MAA 112,116,64
TR 90,25,1536
MAA 112,112,44
buffer_load_dwordx4 v21, s[16:19], s52 offen offset:1024 sc1 lds
MAA 108,112,40
TR 92,25,13440
MAA 108,116,60
TR 94,25,13952
MAA 140,60,124
TR 96,25,2048
MAA 140,40,120
buffer_load_dword v22, s[16:19], s52 offen offset:2048 sc1 lds
MAA 144,44,120
TR 98,25,2560
s_add_u32 s52, s52, 131072
MAA 144,64,124
buffer_load_dwordx4 v[168:171], v26, s[16:19], s75 offen sc1
MAA 148,68,124
TR 100,25,14464
MAA 148,48,120
TR 102,25,14976
MAA 152,52,120
MAA 152,72,124
s_waitcnt vmcnt(20) lgkmcnt(8)
s_barrier
MAA 60,80,0
TR 104,25,32
s_add_u32 m0, s56, 129664
MAA 60,84,20
buffer_load_dwordx4 v18, s[20:23], s54 offen lds
MAA 64,84,24
TR 106,25,544
v_add_f32 v164, v164, v172
MAA 64,80,4
TR 108,25,12448
MAA 68,80,8
TR 110,25,12960
MAA 68,84,28
buffer_load_dwordx4 v19, s[20:23], s54 offen offset:1024 lds
MAA 72,84,32
TR 112,25,1056
MAA 72,80,12
TR 114,25,1568
s_waitcnt lgkmcnt(6)
MAA 156,88,16
TR 116,25,13472
v_add_f32 v165, v165, v173
MAA 156,92,36
buffer_load_dwordx4 v20, s[20:23], s54 offen offset:2048 lds
MAA 104,92,32
TR 118,25,13984
s_add_u32 s54, s54, 196608
MAA 104,88,12
TR 120,25,2080
MAA 100,88,8
s_add_u32 m0, s55, 0
MAA 100,92,28
buffer_load_dwordx4 v21, s[16:19], s52 offen sc1 lds
MAA 96,92,24
TR 122,25,2592
v_add_f32 v166, v166, v174
MAA 96,88,4
TR 124,25,14496
MAA 92,88,0
TR 126,25,15008
MAA 92,92,20
buffer_load_dwordx4 v21, s[16:19], s52 offen offset:1024 sc1 lds
MAA 124,20,100
RD 40,23,18432
MAA 124,0,96
RD 44,23,19456
v_add_f32 v167, v167, v175
MAA 128,4,96
RD 48,23,20736
MAA 128,24,100
buffer_load_dword v22, s[16:19], s52 offen offset:2048 sc1 lds
MAA 132,28,100
RD 52,23,21760
s_add_u32 s52, s52, 131072
MAA 132,8,96
RD 56,24,20480
MAA 136,12,96
MAA 136,32,100
s_waitcnt vmcnt(17) lgkmcnt(5)
s_barrier
MAA 76,104,0
RD 60,23,27648
s_add_u32 m0, s56, 67584
MAA 76,108,20
buffer_load_dwordx4 v18, s[20:23], s54 offen lds
MAA 80,108,24
RD 64,23,28672
MAA 80,104,4
RD 68,23,29952
MAA 84,104,8
RD 72,23,30976
MAA 84,108,28
buffer_load_dwordx4 v19, s[20:23], s54 offen offset:1024 lds
MAA 88,108,32
RD 76,24,29696
MAA 88,104,12
buffer_load_dwordx4 v20, s[20:23], s54 offen offset:2048 lds
MAA 160,112,16
TR 80,25,24832
s_add_u32 s54, s54, 196608
MAA 160,116,36
TR 82,25,25344
MAA 120,116,32
TR 84,25,37248
s_add_u32 m0, s55, 9216
MAA 120,112,12
buffer_load_dwordx4 v21, s[16:19], s52 offen sc1 lds
MAA 116,112,8
TR 86,25,37760
MAA 116,116,28
TR 88,25,25856
MAA 112,116,24
TR 90,25,26368
MAA 112,112,4
buffer_load_dwordx4 v21, s[16:19], s52 offen offset:1024 sc1 lds
MAA 108,112,0
TR 92,25,38272
MAA 108,116,20
TR 94,25,38784
MAA 140,20,124
TR 96,25,26880
MAA 140,0,120
buffer_load_dword v22, s[16:19], s52 offen offset:2048 sc1 lds
MAA 144,4,120
TR 98,25,27392
s_add_u32 s52, s52, 131072
MAA 144,24,124
buffer_load_dwordx4 v[172:175], v26, s[16:19], s75 offen offset:1024 sc1
MAA 148,28,124
TR 100,25,39296
s_add_u32 s75, s75, 2048
MAA 148,8,120
TR 102,25,39808
MAA 152,12,120
MAA 152,32,124
s_waitcnt vmcnt(21) lgkmcnt(8)
s_barrier
MAA 60,80,40
TR 104,25,24864
s_add_u32 m0, s56, 80000
MAA 60,84,60
buffer_load_dwordx4 v18, s[20:23], s54 offen lds
MAA 64,84,64
TR 106,25,25376
MAA 64,80,44
TR 108,25,37280
MAA 68,80,48
TR 110,25,37792
MAA 68,84,68
buffer_load_dwordx4 v19, s[20:23], s54 offen offset:1024 lds
MAA 72,84,72
TR 112,25,25888
MAA 72,80,52
TR 114,25,26400
s_waitcnt lgkmcnt(6)
MAA 156,88,56
TR 116,25,38304
MAA 156,92,76
buffer_load_dwordx4 v20, s[20:23], s54 offen offset:2048 lds
MAA 104,92,72
TR 118,25,38816
s_add_u32 s54, s54, 196608
MAA 104,88,52
TR 120,25,26912
MAA 100,88,48
s_add_u32 m0, s55, 18432
MAA 100,92,68
buffer_load_dwordx4 v21, s[16:19], s52 offen sc1 lds
MAA 96,92,64
TR 122,25,27424
MAA 96,88,44
TR 124,25,39328
MAA 92,88,40
TR 126,25,39840
MAA 92,92,60
buffer_load_dwordx4 v21, s[16:19], s52 offen offset:1024 sc1 lds
MAA 124,60,100
RD 0,23,36864
MAA 124,40,96
RD 4,23,37888
MAA 128,44,96
RD 8,23,39168
MAA 128,64,100
buffer_load_dword v22, s[16:19], s52 offen offset:2048 sc1 lds
MAA 132,68,100
RD 12,23,40192
s_add_u32 s52, s52, 131072
MAA 132,48,96
RD 16,24,38912
MAA 136,52,96
MAA 136,72,100
s_waitcnt vmcnt(16) lgkmcnt(5)
s_barrier
MAA 76,104,40
RD 20,23,46080
s_add_u32 m0, s56, 92416
MAA 76,108,60
buffer_load_dwordx4 v18, s[20:23], s54 offen lds
MAA 80,108,64
RD 24,23,47104
MAA 80,104,44
RD 28,23,48384
MAA 84,104,48
RD 32,23,49408
MAA 84,108,68
buffer_load_dwordx4 v19, s[20:23], s54 offen offset:1024 lds
MAA 88,108,72
RD 36,24,48128
MAA 88,104,52
TR 80,25,49664
.Lpad24:
s_cbranch_execz .Lpad27
MAA 160,112,56
TR 82,25,50176
MAA 160,116,76
buffer_load_dwordx4 v20, s[20:23], s54 offen offset:2048 lds
MAA 120,116,72
TR 84,25,62080
s_add_u32 s54, s54, 196608
MAA 120,112,52
TR 86,25,62592
MAA 116,112,48
s_add_u32 m0, s55, 27648
MAA 116,116,68
buffer_load_dwordx4 v21, s[16:19], s52 offen sc1 lds
MAA 112,116,64
TR 88,25,50688
MAA 112,112,44
TR 90,25,51200
MAA 108,112,40
TR 92,25,63104
MAA 108,116,60
buffer_load_dwordx4 v21, s[16:19], s52 offen offset:1024 sc1 lds
MAA 140,60,124
TR 94,25,63616
MAA 140,40,120
TR 96,25,51712
MAA 144,44,120
TR 98,25,52224
MAA 144,64,124
buffer_load_dword v22, s[16:19], s52 offen offset:2048 sc1 lds
MAA 148,68,124
TR 100,25,64128
s_add_u32 s52, s52, 131072
MAA 148,48,120
TR 102,25,64640
MAA 152,52,120
s_add_u32 s15, s15, 1
MAA 152,72,124
s_cbranch_scc0 .Lk57
s_waitcnt vmcnt(19) lgkmcnt(8)
s_barrier
MAA 60,80,0
TR 104,25,49696
s_add_u32 m0, s56, 104832
MAA 60,84,20
buffer_load_dwordx4 v18, s[20:23], s54 offen lds
MAA 64,84,24
TR 106,25,50208
v_add_f32 v164, v164, v168
MAA 64,80,4
TR 108,25,62112
v_add_f32 v165, v165, v169
MAA 68,80,8
TR 110,25,62624
v_add_f32 v166, v166, v170
MAA 68,84,28
buffer_load_dwordx4 v19, s[20:23], s54 offen offset:1024 lds
MAA 72,84,32
TR 112,25,50720
v_add_f32 v167, v167, v171
MAA 72,80,12
TR 114,25,51232
s_waitcnt lgkmcnt(6)
MAA 156,88,16
TR 116,25,63136
MAA 156,92,36
buffer_load_dwordx4 v20, s[20:23], s54 offen offset:2048 lds
MAA 104,92,32
TR 118,25,63648
s_add_u32 s54, s54, 196608
MAA 104,88,12
TR 120,25,51744
s_add_u32 m0, s55, 36864
MAA 100,88,8
TR 122,25,52256
MAA 100,92,28
buffer_load_dwordx4 v21, s[16:19], s52 offen sc1 lds
MAA 96,92,24
TR 124,25,64160
MAA 96,88,4
TR 126,25,64672
MAA 92,88,0
ds_read_b128 a[40:43], v23
MAA 92,92,20
buffer_load_dwordx4 v21, s[16:19], s52 offen offset:1024 sc1 lds
MAA 124,20,100
RD 44,23,1024
MAA 124,0,96
RD 48,23,2304
MAA 128,4,96
RD 52,23,3328
MAA 128,24,100
buffer_load_dword v22, s[16:19], s52 offen offset:2048 sc1 lds
MAA 132,28,100
RD 56,24,2048
s_add_u32 s52, s52, 131072
MAA 132,8,96
MAA 136,12,96
MAA 136,32,100
s_waitcnt vmcnt(15) lgkmcnt(5)
s_barrier
MAA 76,104,0
RD 60,23,9216
s_add_u32 m0, s56, 117248
MAA 76,108,20
buffer_load_dwordx4 v18, s[20:23], s54 offen lds
MAA 80,108,24
RD 64,23,10240
v_add_f32 v164, v164, v172
MAA 80,104,4
RD 68,23,11520
v_add_f32 v165, v165, v173
MAA 84,104,8
RD 72,23,12544
v_add_f32 v166, v166, v174
MAA 84,108,28
buffer_load_dwordx4 v19, s[20:23], s54 offen offset:1024 lds
MAA 88,108,32
RD 76,24,11264
v_add_f32 v167, v167, v175
MAA 88,104,12
ds_read_b64_tr_b16 a[80:81], v25
MAA 160,112,16
TR 82,25,512
MAA 160,116,36
buffer_load_dwordx4 v20, s[20:23], s54 offen offset:2048 lds
MAA 120,116,32
TR 84,25,12416
s_add_u32 s54, s54, 196608
MAA 120,112,12
TR 86,25,12928
s_add_u32 m0, s55, 46080
MAA 116,112,8
TR 88,25,1024
MAA 116,116,28
buffer_load_dwordx4 v21, s[16:19], s52 offen sc1 lds
MAA 112,116,24
TR 90,25,1536
MAA 112,112,4
TR 92,25,13440
MAA 108,112,0
TR 94,25,13952
MAA 108,116,20
buffer_load_dwordx4 v21, s[16:19], s52 offen offset:1024 sc1 lds
MAA 140,20,124
TR 96,25,2048
MAA 140,0,120
TR 98,25,2560
MAA 144,4,120
TR 100,25,14464
MAA 144,24,124
buffer_load_dword v22, s[16:19], s52 offen offset:2048 sc1 lds
MAA 148,28,124
TR 102,25,14976
s_add_u32 s52, s52, 131072
MAA 148,8,120
v_permlane32_swap_b32 v164, v166
MAA 152,12,120
v_permlane32_swap_b32 v165, v167
MAA 152,32,124
s_waitcnt vmcnt(18) lgkmcnt(8)
s_barrier
MAA 60,80,40
TR 104,25,32
s_add_u32 m0, s56, 129664
MAA 60,84,60
buffer_load_dwordx4 v18, s[20:23], s54 offen lds
MAA 64,84,64
TR 106,25,544
v_add_f32 v164, v164, v166
MAA 64,80,44
TR 108,25,12448
v_add_f32 v165, v165, v167
MAA 68,80,48
buffer_load_dwordx4 v19, s[20:23], s54 offen offset:1024 lds
MAA 68,84,68
TR 110,25,12960
v_mul_f32 v164, 0xba800000, v164
MAA 72,84,72
TR 112,25,1056
v_mul_f32 v165, 0x3a800000, v165
MAA 72,80,52
buffer_load_dwordx4 v20, s[20:23], s54 offen offset:2048 lds
s_waitcnt lgkmcnt(5)
MAA 156,88,56
TR 114,25,1568
s_add_u32 s54, s54, 196608
MAA 156,92,76
TR 116,25,13472
s_add_u32 m0, s59, 58240
MAA 104,92,72
TR 118,25,13984
s_xor_b32 s58, s87, 1966080
MAA 104,88,52
buffer_load_dwordx4 v5, s[24:27], s58 offen lds
MAA 100,88,48
TR 120,25,2080
v_fma_f32 v165, -v164, v164, v165
MAA 100,92,68
TR 122,25,2592
v_max_f32 v165, 0, v165
MAA 96,92,64
buffer_load_dwordx4 v6, s[24:27], s58 offen offset:1024 lds
MAA 96,88,44
TR 124,25,14496
s_add_u32 m0, s59, 0
MAA 92,88,40
TR 126,25,15008
s_xor_b32 s58, s87, 1048576
MAA 92,92,60
buffer_load_dwordx4 v5, s[24:27], s58 offen lds
MAA 124,60,100
RD 0,23,18432
v_add_f32 v165, 0x3727c5ac, v165
MAA 124,40,96
RD 4,23,19456
MAA 128,44,96
buffer_load_dwordx4 v6, s[24:27], s58 offen offset:1024 lds
MAA 128,64,100
RD 8,23,20736
MAA 132,68,100
RD 12,23,21760
MAA 132,48,96
RD 16,24,20480
MAA 136,52,96
v_rsq_f32 v166, v165
MAA 136,72,100
v_mov_b32 v165, v166
v_mul_f32 v166, 0x3e8293ee, v166
ds_write_b128 v7, v[164:167]
s_waitcnt vmcnt(16) lgkmcnt(6)
s_barrier
MAA 76,104,40
ds_write_b32 v17, v164
s_add_u32 m0, s59, 8320
MAA 76,108,60
ds_write_b32 v17, v165 offset:1024
s_xor_b32 s58, s87, 1179648
MAA 80,108,64
buffer_load_dwordx4 v5, s[24:27], s58 offen lds
MAA 80,104,44
RD 20,23,27648
MAA 84,104,48
RD 24,23,28672
MAA 84,108,68
RD 28,23,29952
MAA 88,108,72
buffer_load_dwordx4 v6, s[24:27], s58 offen offset:1024 lds
MAA 88,104,52
RD 32,23,30976
s_add_u32 m0, s59, 66560
MAA 160,112,56
RD 36,24,29696
s_xor_b32 s58, s87, 0
MAA 160,116,76
TR 80,25,24832
MAA 120,116,72
buffer_load_dwordx4 v5, s[24:27], s58 offen lds
MAA 120,112,52
TR 82,25,25344
MAA 116,112,48
TR 84,25,37248
MAA 116,116,68
TR 86,25,37760
MAA 112,116,64
buffer_load_dwordx4 v6, s[24:27], s58 offen offset:1024 lds
MAA 112,112,44
TR 88,25,25856
s_add_u32 m0, s59, 74880
MAA 108,112,40
TR 90,25,26368
s_xor_b32 s58, s87, 131072
MAA 108,116,60
TR 92,25,38272
MAA 140,60,124
buffer_load_dwordx4 v5, s[24:27], s58 offen lds
MAA 140,40,120
TR 94,25,38784
MAA 144,44,120
TR 96,25,26880
MAA 144,64,124
TR 98,25,27392
MAA 148,68,124
buffer_load_dwordx4 v6, s[24:27], s58 offen offset:1024 lds
MAA 148,48,120
TR 100,25,39296
MAA 152,52,120
TR 102,25,39808
MAA 152,72,124
s_waitcnt vmcnt(10) lgkmcnt(0)
s_barrier
MAA 156,88,16
TR 112,25,25888
s_add_u32 m0, s59, 83200
MAA 156,92,36
TR 114,25,26400
s_xor_b32 s58, s87, 262144
MAA 104,92,32
buffer_load_dwordx4 v5, s[24:27], s58 offen lds
MAA 104,88,12
TR 116,25,38304
MAA 100,88,8
TR 118,25,38816
MAA 100,92,28
TR 120,25,26912
MAA 96,92,24
buffer_load_dwordx4 v6, s[24:27], s58 offen offset:1024 lds
MAA 96,88,4
TR 122,25,27424
s_add_u32 m0, s59, 16640
MAA 92,88,0
TR 124,25,39328
s_xor_b32 s58, s87, 1310720
MAA 92,92,20
TR 126,25,39840
MAA 136,32,100
buffer_load_dwordx4 v5, s[24:27], s58 offen lds
MAA 136,12,96
TR 104,25,24864
MAA 72,80,12
TR 106,25,25376
MAA 72,84,32
TR 108,25,37280
MAA 68,84,28
buffer_load_dwordx4 v6, s[24:27], s58 offen offset:1024 lds
MAA 68,80,8
TR 110,25,37792
s_add_u32 m0, s59, 24960
MAA 64,80,4
RD 40,23,36864
s_xor_b32 s58, s87, 1441792
MAA 64,84,24
RD 44,23,37888
MAA 60,84,20
buffer_load_dwordx4 v5, s[24:27], s58 offen lds
MAA 60,80,0
RD 48,23,39168
s_waitcnt lgkmcnt(13)
MAA 160,112,16
RD 52,23,40192
s_waitcnt lgkmcnt(12)
MAA 160,116,36
RD 56,24,38912
MAA 120,116,32
buffer_load_dwordx4 v6, s[24:27], s58 offen offset:1024 lds
MAA 120,112,12
s_waitcnt lgkmcnt(5)
s_barrier
RD 60,23,46080
MAA 116,112,8
RD 64,23,47104
s_add_u32 m0, s59, 91520
MAA 116,116,28
RD 68,23,48384
s_xor_b32 s58, s87, 393216
MAA 112,116,24
RD 72,23,49408
MAA 112,112,4
RD 76,24,48128
MAA 108,112,0
TR 144,25,50688
MAA 108,116,20
TR 146,25,51200
MAA 152,32,124
TR 148,25,63104
MAA 152,12,120
TR 150,25,63616
MAA 88,104,12
TR 152,25,50720
MAA 88,108,32
TR 154,25,51232
MAA 84,108,28
TR 156,25,63136
MAA 84,104,8
TR 158,25,63648
MAA 80,104,4
TR 160,25,51712
MAA 80,108,24
TR 162,25,52224
MAA 76,108,20
TR 164,25,64128
MAA 76,104,0
TR 166,25,64640
s_waitcnt lgkmcnt(10)
MAA 156,144,56
TR 168,25,51744
s_waitcnt lgkmcnt(9)
MAA 156,148,76
TR 170,25,52256
MAA 104,148,72
TR 172,25,64160
MAA 104,144,52
TR 174,25,64672
MAA 100,144,48
TR 128,25,49664
MAA 100,148,68
TR 130,25,50176
MAA 96,148,64
TR 132,25,62080
MAA 96,144,44
TR 134,25,62592
MAA 92,144,40
TR 136,25,49696
MAA 92,148,60
TR 138,25,50208
s_waitcnt lgkmcnt(14)
MAA 160,156,76
TR 140,25,62112
MAA 160,152,56
TR 142,25,62624
MAA 120,152,52
ds_read_b128 v[232:235], v10 offset:768
MAA 120,156,72
ds_read_b128 v[236:239], v10 offset:2816
MAA 116,156,68
ds_read_b128 v[228:231], v10 offset:512
MAA 116,152,48
ds_read_b128 v[224:227], v10 offset:256
MAA 112,152,44
ds_read_b128 v[220:223], v10
MAA 112,156,64
buffer_load_dwordx4 v5, s[24:27], s58 offen lds
MAA 108,156,60
ds_read_b128 v[240:243], v11 offset:192
MAA 108,152,40
ds_read_b128 v[244:247], v11 offset:1216
s_waitcnt lgkmcnt(15)
MAA 136,52,160
ds_read_b128 v[18:21], v11 offset:128
MAA 136,72,164
buffer_load_dwordx4 v6, s[24:27], s58 offen offset:1024 lds
MAA 152,72,172
ds_read_b128 v[22:25], v11 offset:1152
s_add_u32 m0, s59, 99840
MAA 152,52,168
s_xor_b32 s58, s87, 524288
s_waitcnt lgkmcnt(15)
MAA 72,128,52
s_waitcnt lgkmcnt(13)
MAA 72,132,72
buffer_load_dwordx4 v5, s[24:27], s58 offen lds
MAA 68,132,68
MAA 68,128,48
MAA 64,128,44
MAA 64,132,64
buffer_load_dwordx4 v6, s[24:27], s58 offen offset:1024 lds
MAA 60,132,60
s_add_u32 m0, s59, 108160
s_xor_b32 s58, s87, 655360
MAA 60,128,40
s_waitcnt lgkmcnt(11)
MAA 88,136,52
s_waitcnt lgkmcnt(9)
MAA 88,140,72
buffer_load_dwordx4 v5, s[24:27], s58 offen lds
MAA 84,140,68
MAA 84,136,48
MAA 80,136,44
MAA 80,140,64
buffer_load_dwordx4 v6, s[24:27], s58 offen offset:1024 lds
MAA 76,140,60
MAA 76,136,40
s_waitcnt lgkmcnt(8)
v_pk_fma_f32 v[104:105], v[36:37], v[232:233], v[104:105] op_sel_hi:[1,0,1]
v_pk_mul_f32 v[104:105], v[104:105], v[232:233] op_sel:[0,1] op_sel_hi:[1,1]
v_cvt_pk_bf16_f32 v196, v104, v105
v_pk_fma_f32 v[106:107], v[38:39], v[232:233], v[106:107] op_sel_hi:[1,0,1]
v_pk_mul_f32 v[106:107], v[106:107], v[232:233] op_sel:[0,1] op_sel_hi:[1,1]
v_cvt_pk_bf16_f32 v197, v106, v107
v_pk_fma_f32 v[120:121], v[40:41], v[232:233], v[120:121] op_sel_hi:[1,0,1]
v_pk_mul_f32 v[120:121], v[120:121], v[232:233] op_sel:[0,1] op_sel_hi:[1,1]
v_cvt_pk_bf16_f32 v198, v120, v121
v_pk_fma_f32 v[122:123], v[42:43], v[232:233], v[122:123] op_sel_hi:[1,0,1]
v_pk_mul_f32 v[122:123], v[122:123], v[232:233] op_sel:[0,1] op_sel_hi:[1,1]
v_cvt_pk_bf16_f32 v199, v122, v123
s_waitcnt lgkmcnt(3)
v_pk_fma_f32 v[136:137], v[240:241], v[44:45], v[136:137] op_sel_hi:[1,0,1]
s_waitcnt lgkmcnt(2)
v_pk_mul_f32 v[136:137], v[136:137], v[244:245]
v_cvt_pk_bf16_f32 v208, v136, v137
v_pk_fma_f32 v[138:139], v[242:243], v[44:45], v[138:139] op_sel_hi:[1,0,1]
v_pk_mul_f32 v[138:139], v[138:139], v[246:247]
v_cvt_pk_bf16_f32 v209, v138, v139
v_pk_fma_f32 v[152:153], v[240:241], v[44:45], v[152:153] op_sel:[0,1,0] op_sel_hi:[1,1,1]
v_pk_mul_f32 v[152:153], v[152:153], v[244:245]
v_cvt_pk_bf16_f32 v218, v152, v153
v_pk_fma_f32 v[154:155], v[242:243], v[44:45], v[154:155] op_sel:[0,1,0] op_sel_hi:[1,1,1]
v_pk_mul_f32 v[154:155], v[154:155], v[246:247]
v_cvt_pk_bf16_f32 v219, v154, v155
ds_write_b128 v8, v[196:199]
ds_write_b64 v8, v[208:209] offset:1024
ds_write_b64 v8, v[218:219] offset:1032
v_pk_fma_f32 v[156:157], v[36:37], v[236:237], v[156:157] op_sel_hi:[1,0,1]
v_pk_mul_f32 v[156:157], v[156:157], v[236:237] op_sel:[0,1] op_sel_hi:[1,1]
v_cvt_pk_bf16_f32 v180, v156, v157
v_pk_fma_f32 v[158:159], v[38:39], v[236:237], v[158:159] op_sel_hi:[1,0,1]
v_pk_mul_f32 v[158:159], v[158:159], v[236:237] op_sel:[0,1] op_sel_hi:[1,1]
v_cvt_pk_bf16_f32 v181, v158, v159
v_pk_fma_f32 v[160:161], v[40:41], v[236:237], v[160:161] op_sel_hi:[1,0,1]
v_pk_mul_f32 v[160:161], v[160:161], v[236:237] op_sel:[0,1] op_sel_hi:[1,1]
v_cvt_pk_bf16_f32 v182, v160, v161
v_pk_fma_f32 v[162:163], v[42:43], v[236:237], v[162:163] op_sel_hi:[1,0,1]
v_pk_mul_f32 v[162:163], v[162:163], v[236:237] op_sel:[0,1] op_sel_hi:[1,1]
v_cvt_pk_bf16_f32 v183, v162, v163
v_pk_fma_f32 v[100:101], v[36:37], v[228:229], v[100:101] op_sel_hi:[1,0,1]
v_pk_mul_f32 v[100:101], v[100:101], v[228:229] op_sel:[0,1] op_sel_hi:[1,1]
v_cvt_pk_bf16_f32 v192, v100, v101
v_pk_fma_f32 v[102:103], v[38:39], v[228:229], v[102:103] op_sel_hi:[1,0,1]
v_pk_mul_f32 v[102:103], v[102:103], v[228:229] op_sel:[0,1] op_sel_hi:[1,1]
v_cvt_pk_bf16_f32 v193, v102, v103
v_pk_fma_f32 v[116:117], v[40:41], v[228:229], v[116:117] op_sel_hi:[1,0,1]
v_pk_mul_f32 v[116:117], v[116:117], v[228:229] op_sel:[0,1] op_sel_hi:[1,1]
v_cvt_pk_bf16_f32 v194, v116, v117
v_pk_fma_f32 v[118:119], v[42:43], v[228:229], v[118:119] op_sel_hi:[1,0,1]
v_pk_mul_f32 v[118:119], v[118:119], v[228:229] op_sel:[0,1] op_sel_hi:[1,1]
s_waitcnt lgkmcnt(0)
s_barrier
v_cvt_pk_bf16_f32 v195, v118, v119
v_pk_fma_f32 v[96:97], v[36:37], v[224:225], v[96:97] op_sel_hi:[1,0,1]
v_pk_mul_f32 v[96:97], v[96:97], v[224:225] op_sel:[0,1] op_sel_hi:[1,1]
v_cvt_pk_bf16_f32 v188, v96, v97
v_pk_fma_f32 v[98:99], v[38:39], v[224:225], v[98:99] op_sel_hi:[1,0,1]
v_pk_mul_f32 v[98:99], v[98:99], v[224:225] op_sel:[0,1] op_sel_hi:[1,1]
v_cvt_pk_bf16_f32 v189, v98, v99
v_pk_fma_f32 v[112:113], v[40:41], v[224:225], v[112:113] op_sel_hi:[1,0,1]
v_pk_mul_f32 v[112:113], v[112:113], v[224:225] op_sel:[0,1] op_sel_hi:[1,1]
v_cvt_pk_bf16_f32 v190, v112, v113
v_pk_fma_f32 v[114:115], v[42:43], v[224:225], v[114:115] op_sel_hi:[1,0,1]
v_pk_mul_f32 v[114:115], v[114:115], v[224:225] op_sel:[0,1] op_sel_hi:[1,1]
v_cvt_pk_bf16_f32 v191, v114, v115
v_pk_fma_f32 v[92:93], v[36:37], v[220:221], v[92:93] op_sel_hi:[1,0,1]
v_pk_mul_f32 v[92:93], v[92:93], v[220:221] op_sel:[0,1] op_sel_hi:[1,1]
v_cvt_pk_bf16_f32 v184, v92, v93
v_pk_fma_f32 v[94:95], v[38:39], v[220:221], v[94:95] op_sel_hi:[1,0,1]
v_pk_mul_f32 v[94:95], v[94:95], v[220:221] op_sel:[0,1] op_sel_hi:[1,1]
v_cvt_pk_bf16_f32 v185, v94, v95
.Lpad25:
s_cbranch_execz .Lpad28
v_pk_fma_f32 v[108:109], v[40:41], v[220:221], v[108:109] op_sel_hi:[1,0,1]
v_pk_mul_f32 v[108:109], v[108:109], v[220:221] op_sel:[0,1] op_sel_hi:[1,1]
v_cvt_pk_bf16_f32 v186, v108, v109
v_pk_fma_f32 v[110:111], v[42:43], v[220:221], v[110:111] op_sel_hi:[1,0,1]
v_pk_mul_f32 v[110:111], v[110:111], v[220:221] op_sel:[0,1] op_sel_hi:[1,1]
v_cvt_pk_bf16_f32 v187, v110, v111
v_pk_fma_f32 v[72:73], v[28:29], v[232:233], v[72:73] op_sel_hi:[1,0,1]
v_cvt_pk_bf16_f32 v176, v72, v73
v_pk_fma_f32 v[74:75], v[30:31], v[232:233], v[74:75] op_sel_hi:[1,0,1]
v_cvt_pk_bf16_f32 v177, v74, v75
v_pk_fma_f32 v[88:89], v[32:33], v[232:233], v[88:89] op_sel_hi:[1,0,1]
v_cvt_pk_bf16_f32 v178, v88, v89
v_pk_fma_f32 v[90:91], v[34:35], v[232:233], v[90:91] op_sel_hi:[1,0,1]
v_cvt_pk_bf16_f32 v179, v90, v91
v_pk_fma_f32 v[68:69], v[28:29], v[228:229], v[68:69] op_sel_hi:[1,0,1]
v_cvt_pk_bf16_f32 v172, v68, v69
v_pk_fma_f32 v[70:71], v[30:31], v[228:229], v[70:71] op_sel_hi:[1,0,1]
v_cvt_pk_bf16_f32 v173, v70, v71
v_pk_fma_f32 v[84:85], v[32:33], v[228:229], v[84:85] op_sel_hi:[1,0,1]
v_cvt_pk_bf16_f32 v174, v84, v85
v_pk_fma_f32 v[86:87], v[34:35], v[228:229], v[86:87] op_sel_hi:[1,0,1]
v_cvt_pk_bf16_f32 v175, v86, v87
v_pk_fma_f32 v[64:65], v[28:29], v[224:225], v[64:65] op_sel_hi:[1,0,1]
v_cvt_pk_bf16_f32 v168, v64, v65
v_pk_fma_f32 v[66:67], v[30:31], v[224:225], v[66:67] op_sel_hi:[1,0,1]
v_cvt_pk_bf16_f32 v169, v66, v67
v_pk_fma_f32 v[80:81], v[32:33], v[224:225], v[80:81] op_sel_hi:[1,0,1]
v_cvt_pk_bf16_f32 v170, v80, v81
v_pk_fma_f32 v[82:83], v[34:35], v[224:225], v[82:83] op_sel_hi:[1,0,1]
v_cvt_pk_bf16_f32 v171, v82, v83
v_pk_fma_f32 v[60:61], v[28:29], v[220:221], v[60:61] op_sel_hi:[1,0,1]
v_cvt_pk_bf16_f32 v164, v60, v61
v_pk_fma_f32 v[62:63], v[30:31], v[220:221], v[62:63] op_sel_hi:[1,0,1]
v_cvt_pk_bf16_f32 v165, v62, v63
v_pk_fma_f32 v[76:77], v[32:33], v[220:221], v[76:77] op_sel_hi:[1,0,1]
v_cvt_pk_bf16_f32 v166, v76, v77
v_pk_fma_f32 v[78:79], v[34:35], v[220:221], v[78:79] op_sel_hi:[1,0,1]
v_cvt_pk_bf16_f32 v167, v78, v79
s_nop 0
v_mfma_f32_16x16x32_bf16 v[120:123], v[196:199], v[176:179], v[50:53]
ds_read_b64 v[200:201], v9 offset:1024
v_mfma_f32_16x16x32_bf16 v[104:107], v[192:195], v[176:179], v[46:49]
ds_read_b64 v[210:211], v9 offset:1032
v_mfma_f32_16x16x32_bf16 v[116:119], v[192:195], v[172:175], v[50:53]
ds_read_b128 v[240:243], v11 offset:64
v_mfma_f32_16x16x32_bf16 v[100:103], v[188:191], v[172:175], v[46:49]
ds_read_b128 v[244:247], v11 offset:1088
v_mfma_f32_16x16x32_bf16 v[112:115], v[188:191], v[168:171], v[50:53]
ds_read_b128 v[28:31], v11
v_mfma_f32_16x16x32_bf16 v[96:99], v[184:187], v[168:171], v[46:49]
ds_read_b128 v[32:35], v11 offset:1024
v_max3_f32 v88, v104, v105, v106
v_mfma_f32_16x16x32_bf16 v[108:111], v[184:187], v[164:167], v[50:53]
v_max3_f32 v89, v107, v120, v121
v_max3_f32 v88, v88, v122, v123
v_mfma_f32_16x16x32_bf16 v[92:95], v[180:183], v[164:167], v[54:57]
v_max_f32 v90, v88, v89
v_max_f32 v89, v88, v89
MAA 132,8,96
s_nop 0
v_permlane16_swap_b32 v90, v89
MAA 132,28,100
v_max_f32 v88, v90, v89
v_max_f32 v89, v90, v89
MAA 132,48,160
s_nop 0
v_permlane32_swap_b32 v88, v89
MAA 132,68,164
v_max_f32 v88, v88, v89
v_mul_f32 v88, v88, v234
MAA 148,68,172
v_max3_f32 v84, v100, v101, v102
v_max3_f32 v85, v103, v116, v117
MAA 148,48,168
v_max3_f32 v84, v84, v118, v119
v_max_f32 v86, v84, v85
MAA 148,28,124
v_max_f32 v85, v84, v85
v_max3_f32 v80, v96, v97, v98
MAA 148,8,120
v_permlane16_swap_b32 v86, v85
v_max3_f32 v81, v99, v112, v113
v_max_f32 v84, v86, v85
v_max_f32 v85, v86, v85
v_max3_f32 v80, v80, v114, v115
v_max_f32 v82, v80, v81
v_permlane32_swap_b32 v84, v85
v_max_f32 v81, v80, v81
v_max_f32 v84, v84, v85
v_mul_f32 v84, v84, v230
v_permlane16_swap_b32 v82, v81
v_max3_f32 v76, v92, v93, v94
v_max_f32 v80, v82, v81
v_max_f32 v81, v82, v81
v_max3_f32 v77, v95, v108, v109
v_max3_f32 v76, v76, v110, v111
v_permlane32_swap_b32 v80, v81
v_max_f32 v78, v76, v77
v_max_f32 v80, v80, v81
v_mul_f32 v80, v80, v226
v_max_f32 v77, v76, v77
v_pk_fma_f32 v[104:105], v[104:105], v[234:235], v[88:89] op_sel_hi:[1,0,0] neg_lo:[0,0,1] neg_hi:[0,0,1]
v_pk_fma_f32 v[106:107], v[106:107], v[234:235], v[88:89] op_sel_hi:[1,0,0] neg_lo:[0,0,1] neg_hi:[0,0,1]
v_permlane16_swap_b32 v78, v77
v_pk_fma_f32 v[120:121], v[120:121], v[234:235], v[88:89] op_sel_hi:[1,0,0] neg_lo:[0,0,1] neg_hi:[0,0,1]
v_max_f32 v76, v78, v77
v_max_f32 v77, v78, v77
v_pk_fma_f32 v[122:123], v[122:123], v[234:235], v[88:89] op_sel_hi:[1,0,0] neg_lo:[0,0,1] neg_hi:[0,0,1]
v_pk_fma_f32 v[100:101], v[100:101], v[230:231], v[84:85] op_sel_hi:[1,0,0] neg_lo:[0,0,1] neg_hi:[0,0,1]
v_permlane32_swap_b32 v76, v77
v_pk_fma_f32 v[102:103], v[102:103], v[230:231], v[84:85] op_sel_hi:[1,0,0] neg_lo:[0,0,1] neg_hi:[0,0,1]
v_max_f32 v76, v76, v77
v_mul_f32 v76, v76, v222
v_pk_fma_f32 v[116:117], v[116:117], v[230:231], v[84:85] op_sel_hi:[1,0,0] neg_lo:[0,0,1] neg_hi:[0,0,1]
v_pk_fma_f32 v[118:119], v[118:119], v[230:231], v[84:85] op_sel_hi:[1,0,0] neg_lo:[0,0,1] neg_hi:[0,0,1]
v_pk_fma_f32 v[96:97], v[96:97], v[226:227], v[80:81] op_sel_hi:[1,0,0] neg_lo:[0,0,1] neg_hi:[0,0,1]
v_pk_fma_f32 v[98:99], v[98:99], v[226:227], v[80:81] op_sel_hi:[1,0,0] neg_lo:[0,0,1] neg_hi:[0,0,1]
v_pk_fma_f32 v[112:113], v[112:113], v[226:227], v[80:81] op_sel_hi:[1,0,0] neg_lo:[0,0,1] neg_hi:[0,0,1]
v_pk_fma_f32 v[114:115], v[114:115], v[226:227], v[80:81] op_sel_hi:[1,0,0] neg_lo:[0,0,1] neg_hi:[0,0,1]
v_pk_fma_f32 v[92:93], v[92:93], v[222:223], v[76:77] op_sel_hi:[1,0,0] neg_lo:[0,0,1] neg_hi:[0,0,1]
v_pk_fma_f32 v[94:95], v[94:95], v[222:223], v[76:77] op_sel_hi:[1,0,0] neg_lo:[0,0,1] neg_hi:[0,0,1]
v_pk_fma_f32 v[108:109], v[108:109], v[222:223], v[76:77] op_sel_hi:[1,0,0] neg_lo:[0,0,1] neg_hi:[0,0,1]
v_pk_fma_f32 v[110:111], v[110:111], v[222:223], v[76:77] op_sel_hi:[1,0,0] neg_lo:[0,0,1] neg_hi:[0,0,1]
v_pk_fma_f32 v[132:133], v[18:19], v[44:45], v[132:133] op_sel_hi:[1,0,1]
v_pk_mul_f32 v[132:133], v[132:133], v[22:23]
v_pk_fma_f32 v[134:135], v[20:21], v[44:45], v[134:135] op_sel_hi:[1,0,1]
v_pk_mul_f32 v[134:135], v[134:135], v[24:25]
v_pk_fma_f32 v[148:149], v[18:19], v[44:45], v[148:149] op_sel:[0,1,0] op_sel_hi:[1,1,1]
v_pk_mul_f32 v[148:149], v[148:149], v[22:23]
v_pk_fma_f32 v[150:151], v[20:21], v[44:45], v[150:151] op_sel:[0,1,0] op_sel_hi:[1,1,1]
v_pk_mul_f32 v[150:151], v[150:151], v[24:25]
v_exp_f32 v104, v104
s_nop 0
MAA 128,4,96
v_exp_f32 v105, v105
MAA 128,24,100
v_exp_f32 v106, v106
MAA 128,44,160
v_exp_f32 v107, v107
MAA 128,64,164
v_exp_f32 v120, v120
MAA 144,64,172
v_exp_f32 v121, v121
MAA 144,44,168
v_exp_f32 v122, v122
MAA 144,24,124
v_exp_f32 v123, v123
MAA 144,4,120
v_exp_f32 v100, v100
MAA 124,0,96
v_exp_f32 v101, v101
MAA 124,20,100
v_exp_f32 v102, v102
MAA 124,40,160
v_exp_f32 v103, v103
MAA 124,60,164
v_exp_f32 v116, v116
MAA 140,60,172
v_exp_f32 v117, v117
MAA 140,40,168
v_exp_f32 v118, v118
MAA 140,20,124
v_exp_f32 v119, v119
MAA 140,0,120
v_cvt_pk_bf16_f32 v72, v104, v105
v_cvt_pk_bf16_f32 v73, v106, v107
v_cvt_pk_bf16_f32 v74, v120, v121
v_cvt_pk_bf16_f32 v75, v122, v123
v_cvt_pk_bf16_f32 v68, v100, v101
v_cvt_pk_bf16_f32 v69, v102, v103
v_cvt_pk_bf16_f32 v70, v116, v117
v_cvt_pk_bf16_f32 v71, v118, v119
v_exp_f32 v96, v96
v_exp_f32 v97, v97
v_exp_f32 v98, v98
v_exp_f32 v99, v99
v_exp_f32 v112, v112
v_exp_f32 v113, v113
v_exp_f32 v114, v114
v_exp_f32 v115, v115
v_cvt_pk_bf16_f32 v64, v96, v97
v_cvt_pk_bf16_f32 v65, v98, v99
v_cvt_pk_bf16_f32 v66, v112, v113
v_cvt_pk_bf16_f32 v67, v114, v115
v_cvt_pk_bf16_f32 v206, v132, v133
v_cvt_pk_bf16_f32 v207, v134, v135
v_cvt_pk_bf16_f32 v216, v148, v149
v_cvt_pk_bf16_f32 v217, v150, v151
s_waitcnt lgkmcnt(3)
v_pk_fma_f32 v[128:129], v[240:241], v[44:45], v[128:129] op_sel_hi:[1,0,1]
s_waitcnt lgkmcnt(2)
v_pk_mul_f32 v[128:129], v[128:129], v[244:245]
v_cvt_pk_bf16_f32 v204, v128, v129
v_pk_fma_f32 v[130:131], v[242:243], v[44:45], v[130:131] op_sel_hi:[1,0,1]
v_pk_mul_f32 v[130:131], v[130:131], v[246:247]
v_cvt_pk_bf16_f32 v205, v130, v131
v_pk_fma_f32 v[144:145], v[240:241], v[44:45], v[144:145] op_sel:[0,1,0] op_sel_hi:[1,1,1]
v_pk_mul_f32 v[144:145], v[144:145], v[244:245]
v_cvt_pk_bf16_f32 v214, v144, v145
v_pk_fma_f32 v[146:147], v[242:243], v[44:45], v[146:147] op_sel:[0,1,0] op_sel_hi:[1,1,1]
v_pk_mul_f32 v[146:147], v[146:147], v[246:247]
v_cvt_pk_bf16_f32 v215, v146, v147
s_waitcnt lgkmcnt(1)
v_pk_fma_f32 v[124:125], v[28:29], v[44:45], v[124:125] op_sel_hi:[1,0,1]
s_waitcnt lgkmcnt(0)
v_pk_mul_f32 v[124:125], v[124:125], v[32:33]
v_cvt_pk_bf16_f32 v202, v124, v125
v_pk_fma_f32 v[126:127], v[30:31], v[44:45], v[126:127] op_sel_hi:[1,0,1]
v_pk_mul_f32 v[126:127], v[126:127], v[34:35]
v_cvt_pk_bf16_f32 v203, v126, v127
v_pk_fma_f32 v[140:141], v[28:29], v[44:45], v[140:141] op_sel:[0,1,0] op_sel_hi:[1,1,1]
v_pk_mul_f32 v[140:141], v[140:141], v[32:33]
v_cvt_pk_bf16_f32 v212, v140, v141
v_pk_fma_f32 v[142:143], v[30:31], v[44:45], v[142:143] op_sel:[0,1,0] op_sel_hi:[1,1,1]
v_pk_mul_f32 v[142:143], v[142:143], v[34:35]
v_cvt_pk_bf16_f32 v213, v142, v143
s_nop 0
v_mfma_f32_16x16x32_bf16 v[88:91], v[248:251], v[72:75], 0
v_exp_f32 v92, v92
v_mfma_f32_16x16x32_bf16 v[104:107], v[206:209], v[72:75], 0
v_exp_f32 v93, v93
v_mfma_f32_16x16x32_bf16 v[120:123], v[216:219], v[72:75], 0
v_exp_f32 v94, v94
v_mfma_f32_16x16x32_bf16 v[84:87], v[248:251], v[68:71], 0
v_exp_f32 v95, v95
v_mfma_f32_16x16x32_bf16 v[100:103], v[204:207], v[68:71], 0
v_exp_f32 v108, v108
v_mfma_f32_16x16x32_bf16 v[116:119], v[214:217], v[68:71], 0
v_exp_f32 v109, v109
v_mfma_f32_16x16x32_bf16 v[80:83], v[248:251], v[64:67], 0
v_exp_f32 v110, v110
v_mfma_f32_16x16x32_bf16 v[96:99], v[202:205], v[64:67], 0
v_exp_f32 v111, v111
v_mfma_f32_16x16x32_bf16 v[112:115], v[212:215], v[64:67], 0
v_cvt_pk_bf16_f32 v60, v92, v93
v_cvt_pk_bf16_f32 v61, v94, v95
v_cvt_pk_bf16_f32 v62, v108, v109
v_cvt_pk_bf16_f32 v63, v110, v111
v_rcp_f32 v88, v88
v_rcp_f32 v84, v84
v_mfma_f32_16x16x32_bf16 v[76:79], v[248:251], v[60:63], 0
v_rcp_f32 v80, v80
v_mfma_f32_16x16x32_bf16 v[92:95], v[200:203], v[60:63], 0
v_mfma_f32_16x16x32_bf16 v[108:111], v[210:213], v[60:63], 0
s_nop 4
v_rcp_f32 v76, v76
v_pk_mul_f32 v[104:105], v[104:105], v[88:89] op_sel_hi:[1,0]
v_pk_mul_f32 v[106:107], v[106:107], v[88:89] op_sel_hi:[1,0]
v_pk_mul_f32 v[120:121], v[120:121], v[88:89] op_sel_hi:[1,0]
v_pk_mul_f32 v[122:123], v[122:123], v[88:89] op_sel_hi:[1,0]
v_cvt_pk_bf16_f32 v176, v104, v105
v_cvt_pk_bf16_f32 v177, v106, v107
v_cvt_pk_bf16_f32 v178, v120, v121
v_cvt_pk_bf16_f32 v179, v122, v123
buffer_store_dwordx4 v[176:179], v4, s[16:19], s74 offen offset:3072 sc1
v_pk_mul_f32 v[100:101], v[100:101], v[84:85] op_sel_hi:[1,0]
v_pk_mul_f32 v[102:103], v[102:103], v[84:85] op_sel_hi:[1,0]
v_pk_mul_f32 v[116:117], v[116:117], v[84:85] op_sel_hi:[1,0]
v_pk_mul_f32 v[118:119], v[118:119], v[84:85] op_sel_hi:[1,0]
v_cvt_pk_bf16_f32 v172, v100, v101
v_cvt_pk_bf16_f32 v173, v102, v103
v_cvt_pk_bf16_f32 v174, v116, v117
v_cvt_pk_bf16_f32 v175, v118, v119
buffer_store_dwordx4 v[172:175], v4, s[16:19], s74 offen offset:2048 sc1
v_pk_mul_f32 v[96:97], v[96:97], v[80:81] op_sel_hi:[1,0]
v_pk_mul_f32 v[98:99], v[98:99], v[80:81] op_sel_hi:[1,0]
v_pk_mul_f32 v[112:113], v[112:113], v[80:81] op_sel_hi:[1,0]
v_pk_mul_f32 v[114:115], v[114:115], v[80:81] op_sel_hi:[1,0]
v_cvt_pk_bf16_f32 v168, v96, v97
v_cvt_pk_bf16_f32 v169, v98, v99
v_cvt_pk_bf16_f32 v170, v112, v113
v_cvt_pk_bf16_f32 v171, v114, v115
buffer_store_dwordx4 v[168:171], v4, s[16:19], s74 offen offset:1024 sc1
v_pk_mul_f32 v[92:93], v[92:93], v[76:77] op_sel_hi:[1,0]
v_pk_mul_f32 v[94:95], v[94:95], v[76:77] op_sel_hi:[1,0]
v_pk_mul_f32 v[108:109], v[108:109], v[76:77] op_sel_hi:[1,0]
v_pk_mul_f32 v[110:111], v[110:111], v[76:77] op_sel_hi:[1,0]
v_cvt_pk_bf16_f32 v164, v92, v93
v_cvt_pk_bf16_f32 v165, v94, v95
v_cvt_pk_bf16_f32 v166, v108, v109
v_cvt_pk_bf16_f32 v167, v110, v111
buffer_store_dwordx4 v[164:167], v4, s[16:19], s74 offen sc1
s_nop 1
s_branch .Lqkve56
.Lsp50:
s_mov_b32 s15, 0
.Lsp50l:
v_mov_b32 v25, 0
buffer_atomic_add v25, v22, s[16:19], s73 offen sc0
s_add_u32 s15, s15, 1
s_cmp_gt_u32 s15, 100000
s_waitcnt vmcnt(0)
s_cbranch_scc1 .Lsp50b
v_cmp_gt_u32 vcc, v23, v25
s_nop 0
s_cbranch_vccnz .Lsp50l
s_branch .Lsp50b
.p2align 12
.Lqkv55:
.Lpad26:
s_cbranch_execz .Lpad29
s_add_u32 m0, s55, 36864
s_nop 0
buffer_load_dwordx4 v21, s[16:19], s52 offen sc1 lds
buffer_load_dwordx4 v21, s[16:19], s52 offen offset:1024 sc1 lds
buffer_load_dword v22, s[16:19], s52 offen offset:2048 sc1 lds
s_add_u32 s52, s52, 131072
TR 80,25,49664
TR 82,25,50176
TR 84,25,62080
s_add_u32 m0, s55, 46080
s_nop 0
buffer_load_dwordx4 v21, s[16:19], s52 offen sc1 lds
buffer_load_dwordx4 v21, s[16:19], s52 offen offset:1024 sc1 lds
buffer_load_dword v22, s[16:19], s52 offen offset:2048 sc1 lds
s_add_u32 s52, s52, 131072
TR 86,25,62592
TR 88,25,50688
TR 90,25,51200
s_add_u32 m0, s55, 0
s_nop 0
buffer_load_dwordx4 v21, s[16:19], s52 offen sc1 lds
buffer_load_dwordx4 v21, s[16:19], s52 offen offset:1024 sc1 lds
buffer_load_dword v22, s[16:19], s52 offen offset:2048 sc1 lds
s_add_u32 s52, s52, 131072
TR 92,25,63104
TR 94,25,63616
TR 96,25,51712
s_add_u32 m0, s55, 9216
s_nop 0
buffer_load_dwordx4 v21, s[16:19], s52 offen sc1 lds
buffer_load_dwordx4 v21, s[16:19], s52 offen offset:1024 sc1 lds
buffer_load_dword v22, s[16:19], s52 offen offset:2048 sc1 lds
s_add_u32 s52, s52, 131072
TR 98,25,52224
TR 100,25,64128
TR 102,25,64640
s_add_u32 m0, s55, 18432
s_nop 0
buffer_load_dwordx4 v21, s[16:19], s52 offen sc1 lds
buffer_load_dwordx4 v21, s[16:19], s52 offen offset:1024 sc1 lds
buffer_load_dword v22, s[16:19], s52 offen offset:2048 sc1 lds
s_add_u32 s52, s52, 131072
ds_read_b128 v[28:31], v13
ds_read_b128 v[32:35], v13 offset:64
ds_read_b128 v[36:39], v13 offset:256
s_add_u32 m0, s55, 27648
s_nop 0
buffer_load_dwordx4 v21, s[16:19], s52 offen sc1 lds
buffer_load_dwordx4 v21, s[16:19], s52 offen offset:1024 sc1 lds
buffer_load_dword v22, s[16:19], s52 offen offset:2048 sc1 lds
s_add_u32 s52, s52, 131072
ds_read_b128 v[40:43], v13 offset:320
ds_read_b32 v44, v12 offset:512
ds_read_b32 v45, v12 offset:576
s_waitcnt vmcnt(12)
s_barrier
RD 0,23,36864
RD 4,23,37888
RD 8,23,39168
RD 12,23,40192
RD 16,24,38912
RD 20,23,46080
RD 24,23,47104
RD 28,23,48384
RD 32,23,49408
RD 36,24,48128
s_waitcnt lgkmcnt(0)
s_mov_b32 s15, -2
.p2align 6
.Lk58:
s_waitcnt vmcnt(9) lgkmcnt(8)
s_barrier
MAA 60,80,0
TR 104,25,49696
s_add_u32 m0, s56, 104832
MAA 60,84,20
buffer_load_dwordx4 v18, s[20:23], s54 offen lds
MAA 64,84,24
TR 106,25,50208
v_add_f32 v164, v164, v168
MAA 64,80,4
TR 108,25,62112
MAA 68,80,8
TR 110,25,62624
MAA 68,84,28
buffer_load_dwordx4 v19, s[20:23], s54 offen offset:1024 lds
MAA 72,84,32
TR 112,25,50720
v_add_f32 v165, v165, v169
MAA 72,80,12
TR 114,25,51232
s_waitcnt lgkmcnt(6)
MAA 104,88,12
TR 116,25,63136
MAA 104,92,32
buffer_load_dwordx4 v20, s[20:23], s54 offen offset:2048 lds
MAA 100,92,28
s_add_u32 s54, s54, 196608
s_add_u32 m0, s55, 36864
MAA 100,88,8
buffer_load_dwordx4 v21, s[16:19], s52 offen sc1 lds
MAA 96,88,4
TR 118,25,63648
MAA 96,92,24
TR 120,25,51744
v_add_f32 v166, v166, v170
MAA 92,92,20
TR 122,25,52256
MAA 92,88,0
buffer_load_dwordx4 v21, s[16:19], s52 offen offset:1024 sc1 lds
MAA 124,0,96
TR 124,25,64160
MAA 124,20,100
TR 126,25,64672
v_add_f32 v167, v167, v171
MAA 128,24,100
ds_read_b128 a[40:43], v23
MAA 128,4,96
buffer_load_dword v22, s[16:19], s52 offen offset:2048 sc1 lds
MAA 132,8,96
RD 44,23,1024
s_add_u32 s52, s52, 131072
MAA 132,28,100
buffer_load_dword v27, v14, s[20:23], s44 offen
MAA 136,32,100
RD 48,23,2304
s_add_u32 s44, s44, 1572864
MAA 136,12,96
RD 52,23,3328
MAA 156,16,96
RD 56,24,2048
MAA 156,36,100
s_waitcnt vmcnt(13) lgkmcnt(5)
s_barrier
MAA 76,104,0
RD 60,23,9216
s_add_u32 m0, s56, 117248
MAA 76,108,20
buffer_load_dwordx4 v18, s[20:23], s54 offen lds
MAA 80,108,24
RD 64,23,10240
MAA 80,104,4
RD 68,23,11520
MAA 84,104,8
RD 72,23,12544
MAA 84,108,28
buffer_load_dwordx4 v19, s[20:23], s54 offen offset:1024 lds
MAA 88,108,32
RD 76,24,11264
MAA 88,104,12
buffer_load_dwordx4 v20, s[20:23], s54 offen offset:2048 lds
MAA 120,112,12
ds_read_b64_tr_b16 a[80:81], v25
s_add_u32 s54, s54, 196608
MAA 120,116,32
TR 82,25,512
MAA 116,116,28
TR 84,25,12416
s_add_u32 m0, s55, 46080
MAA 116,112,8
buffer_load_dwordx4 v21, s[16:19], s52 offen sc1 lds
MAA 112,112,4
TR 86,25,12928
MAA 112,116,24
TR 88,25,1024
MAA 108,116,20
TR 90,25,1536
MAA 108,112,0
buffer_load_dwordx4 v21, s[16:19], s52 offen offset:1024 sc1 lds
MAA 140,0,120
TR 92,25,13440
MAA 140,20,124
TR 94,25,13952
MAA 144,24,124
TR 96,25,2048
MAA 144,4,120
buffer_load_dword v22, s[16:19], s52 offen offset:2048 sc1 lds
MAA 148,8,120
TR 98,25,2560
s_add_u32 s52, s52, 131072
MAA 148,28,124
buffer_load_dwordx4 v[168:171], v26, s[16:19], s75 offen sc1
MAA 152,32,124
TR 100,25,14464
MAA 152,12,120
TR 102,25,14976
MAA 160,16,120
MAA 160,36,124
s_waitcnt vmcnt(17) lgkmcnt(8)
s_barrier
MAA 60,80,40
TR 104,25,32
v_add_f32 v164, v164, v172
MAA 60,84,60
TR 106,25,544
MAA 64,84,64
TR 108,25,12448
s_add_u32 m0, s56, 129664
MAA 64,80,44
buffer_load_dwordx4 v18, s[20:23], s54 offen lds
MAA 68,80,48
TR 110,25,12960
MAA 68,84,68
TR 112,25,1056
MAA 72,84,72
TR 114,25,1568
v_add_f32 v165, v165, v173
MAA 72,80,52
TR 116,25,13472
s_waitcnt lgkmcnt(7)
MAA 104,88,52
TR 118,25,13984
MAA 104,92,72
buffer_load_dwordx4 v19, s[20:23], s54 offen offset:1024 lds
MAA 100,92,68
TR 120,25,2080
MAA 100,88,48
buffer_load_dwordx4 v20, s[20:23], s54 offen offset:2048 lds
MAA 96,88,44
s_add_u32 s54, s54, 196608
MAA 96,92,64
TR 122,25,2592
v_add_f32 v166, v166, v174
MAA 92,92,60
TR 124,25,14496
s_add_u32 m0, s55, 0
MAA 92,88,40
buffer_load_dwordx4 v21, s[16:19], s52 offen sc1 lds
MAA 124,40,96
TR 126,25,15008
MAA 124,60,100
RD 0,23,18432
MAA 128,64,100
RD 4,23,19456
MAA 128,44,96
buffer_load_dwordx4 v21, s[16:19], s52 offen offset:1024 sc1 lds
MAA 132,48,96
RD 8,23,20736
v_add_f32 v167, v167, v175
MAA 132,68,100
RD 12,23,21760
MAA 136,72,100
RD 16,24,20480
MAA 136,52,96
buffer_load_dword v22, s[16:19], s52 offen offset:2048 sc1 lds
MAA 156,56,96
s_add_u32 s52, s52, 131072
MAA 156,76,100
s_waitcnt vmcnt(17) lgkmcnt(5)
s_barrier
MAA 76,104,40
RD 20,23,27648
s_add_u32 m0, s56, 67584
MAA 76,108,60
buffer_load_dwordx4 v18, s[20:23], s54 offen lds
MAA 80,108,64
RD 24,23,28672
MAA 80,104,44
RD 28,23,29952
MAA 84,104,48
RD 32,23,30976
MAA 84,108,68
buffer_load_dwordx4 v19, s[20:23], s54 offen offset:1024 lds
MAA 88,108,72
RD 36,24,29696
MAA 88,104,52
buffer_load_dwordx4 v20, s[20:23], s54 offen offset:2048 lds
MAA 120,112,52
TR 80,25,24832
s_add_u32 s54, s54, 196608
MAA 120,116,72
TR 82,25,25344
MAA 116,116,68
TR 84,25,37248
s_add_u32 m0, s55, 9216
MAA 116,112,48
buffer_load_dwordx4 v21, s[16:19], s52 offen sc1 lds
MAA 112,112,44
TR 86,25,37760
MAA 112,116,64
TR 88,25,25856
MAA 108,116,60
TR 90,25,26368
MAA 108,112,40
buffer_load_dwordx4 v21, s[16:19], s52 offen offset:1024 sc1 lds
MAA 140,40,120
TR 92,25,38272
MAA 140,60,124
TR 94,25,38784
MAA 144,64,124
TR 96,25,26880
MAA 144,44,120
buffer_load_dword v22, s[16:19], s52 offen offset:2048 sc1 lds
MAA 148,48,120
TR 98,25,27392
s_add_u32 s52, s52, 131072
MAA 148,68,124
buffer_load_dwordx4 v[172:175], v26, s[16:19], s75 offen offset:1024 sc1
MAA 152,72,124
TR 100,25,39296
s_add_u32 s75, s75, 2048
MAA 152,52,120
TR 102,25,39808
MAA 160,56,120
MAA 160,76,124
s_waitcnt vmcnt(21) lgkmcnt(8)
s_barrier
MAA 60,80,0
TR 104,25,24864
MAA 60,84,20
TR 106,25,25376
MAA 64,84,24
TR 108,25,37280
s_add_u32 m0, s56, 80000
MAA 64,80,4
buffer_load_dwordx4 v18, s[20:23], s54 offen lds
MAA 68,80,8
TR 110,25,37792
MAA 68,84,28
TR 112,25,25888
MAA 72,84,32
TR 114,25,26400
MAA 72,80,12
TR 116,25,38304
s_waitcnt lgkmcnt(7)
MAA 104,88,12
TR 118,25,38816
MAA 104,92,32
buffer_load_dwordx4 v19, s[20:23], s54 offen offset:1024 lds
MAA 100,92,28
TR 120,25,26912
MAA 100,88,8
buffer_load_dwordx4 v20, s[20:23], s54 offen offset:2048 lds
MAA 96,88,4
s_add_u32 s54, s54, 196608
MAA 96,92,24
TR 122,25,27424
MAA 92,92,20
TR 124,25,39328
s_add_u32 m0, s55, 18432
MAA 92,88,0
buffer_load_dwordx4 v21, s[16:19], s52 offen sc1 lds
MAA 124,0,96
TR 126,25,39840
MAA 124,20,100
RD 40,23,36864
MAA 128,24,100
RD 44,23,37888
MAA 128,4,96
buffer_load_dwordx4 v21, s[16:19], s52 offen offset:1024 sc1 lds
MAA 132,8,96
RD 48,23,39168
MAA 132,28,100
RD 52,23,40192
MAA 136,32,100
RD 56,24,38912
MAA 136,12,96
buffer_load_dword v22, s[16:19], s52 offen offset:2048 sc1 lds
MAA 156,16,96
s_add_u32 s52, s52, 131072
MAA 156,36,100
s_waitcnt vmcnt(16) lgkmcnt(5)
s_barrier
MAA 76,104,0
RD 60,23,46080
MAA 76,108,20
RD 64,23,47104
MAA 80,108,24
RD 68,23,48384
s_add_u32 m0, s56, 92416
MAA 80,104,4
buffer_load_dwordx4 v18, s[20:23], s54 offen lds
MAA 84,104,8
RD 72,23,49408
MAA 84,108,28
RD 76,24,48128
MAA 88,108,32
TR 80,25,49664
MAA 88,104,12
buffer_load_dwordx4 v19, s[20:23], s54 offen offset:1024 lds
MAA 120,112,12
TR 82,25,50176
MAA 120,116,32
TR 84,25,62080
MAA 116,116,28
TR 86,25,62592
MAA 116,112,8
buffer_load_dwordx4 v20, s[20:23], s54 offen offset:2048 lds
MAA 112,112,4
s_add_u32 s54, s54, 196608
MAA 112,116,24
TR 88,25,50688
MAA 108,116,20
TR 90,25,51200
s_add_u32 m0, s55, 27648
MAA 108,112,0
buffer_load_dwordx4 v21, s[16:19], s52 offen sc1 lds
MAA 140,0,120
TR 92,25,63104
MAA 140,20,124
TR 94,25,63616
MAA 144,24,124
TR 96,25,51712
MAA 144,4,120
buffer_load_dwordx4 v21, s[16:19], s52 offen offset:1024 sc1 lds
MAA 148,8,120
TR 98,25,52224
MAA 148,28,124
TR 100,25,64128
MAA 152,32,124
TR 102,25,64640
MAA 152,12,120
buffer_load_dword v22, s[16:19], s52 offen offset:2048 sc1 lds
MAA 160,16,120
s_add_u32 s52, s52, 131072
MAA 160,36,124
s_waitcnt vmcnt(19) lgkmcnt(8)
s_barrier
MAA 60,80,40
TR 104,25,49696
s_add_u32 m0, s56, 104832
MAA 60,84,60
buffer_load_dwordx4 v18, s[20:23], s54 offen lds
MAA 64,84,64
TR 106,25,50208
v_add_f32 v164, v164, v168
MAA 64,80,44
TR 108,25,62112
MAA 68,80,48
TR 110,25,62624
MAA 68,84,68
buffer_load_dwordx4 v19, s[20:23], s54 offen offset:1024 lds
MAA 72,84,72
TR 112,25,50720
v_add_f32 v165, v165, v169
MAA 72,80,52
TR 114,25,51232
s_waitcnt lgkmcnt(6)
MAA 104,88,52
TR 116,25,63136
MAA 104,92,72
buffer_load_dwordx4 v20, s[20:23], s54 offen offset:2048 lds
MAA 100,92,68
s_add_u32 s54, s54, 196608
s_add_u32 m0, s55, 36864
MAA 100,88,48
buffer_load_dwordx4 v21, s[16:19], s52 offen sc1 lds
MAA 96,88,44
TR 118,25,63648
MAA 96,92,64
TR 120,25,51744
v_add_f32 v166, v166, v170
MAA 92,92,60
TR 122,25,52256
MAA 92,88,40
buffer_load_dwordx4 v21, s[16:19], s52 offen offset:1024 sc1 lds
MAA 124,40,96
TR 124,25,64160
MAA 124,60,100
TR 126,25,64672
v_add_f32 v167, v167, v171
MAA 128,64,100
ds_read_b128 a[0:3], v23
MAA 128,44,96
buffer_load_dword v22, s[16:19], s52 offen offset:2048 sc1 lds
MAA 132,48,96
RD 4,23,1024
s_add_u32 s52, s52, 131072
MAA 132,68,100
buffer_load_dword v27, v14, s[20:23], s44 offen
MAA 136,72,100
RD 8,23,2304
s_add_u32 s44, s44, 1572864
MAA 136,52,96
RD 12,23,3328
MAA 156,56,96
RD 16,24,2048
MAA 156,76,100
s_waitcnt vmcnt(16) lgkmcnt(5)
s_barrier
MAA 76,104,40
RD 20,23,9216
s_add_u32 m0, s56, 117248
MAA 76,108,60
buffer_load_dwordx4 v18, s[20:23], s54 offen lds
MAA 80,108,64
RD 24,23,10240
MAA 80,104,44
RD 28,23,11520
MAA 84,104,48
RD 32,23,12544
MAA 84,108,68
buffer_load_dwordx4 v19, s[20:23], s54 offen offset:1024 lds
MAA 88,108,72
RD 36,24,11264
MAA 88,104,52
buffer_load_dwordx4 v20, s[20:23], s54 offen offset:2048 lds
MAA 120,112,52
ds_read_b64_tr_b16 a[80:81], v25
s_add_u32 s54, s54, 196608
MAA 120,116,72
TR 82,25,512
MAA 116,116,68
TR 84,25,12416
s_add_u32 m0, s55, 46080
MAA 116,112,48
buffer_load_dwordx4 v21, s[16:19], s52 offen sc1 lds
MAA 112,112,44
TR 86,25,12928
MAA 112,116,64
TR 88,25,1024
MAA 108,116,60
TR 90,25,1536
MAA 108,112,40
buffer_load_dwordx4 v21, s[16:19], s52 offen offset:1024 sc1 lds
MAA 140,40,120
TR 92,25,13440
MAA 140,60,124
TR 94,25,13952
MAA 144,64,124
TR 96,25,2048
MAA 144,44,120
buffer_load_dword v22, s[16:19], s52 offen offset:2048 sc1 lds
MAA 148,48,120
TR 98,25,2560
s_add_u32 s52, s52, 131072
MAA 148,68,124
buffer_load_dwordx4 v[168:171], v26, s[16:19], s75 offen sc1
MAA 152,72,124
TR 100,25,14464
MAA 152,52,120
TR 102,25,14976
MAA 160,56,120
MAA 160,76,124
s_waitcnt vmcnt(20) lgkmcnt(8)
.Lpad27:
s_cbranch_execz .Lnopoll53r
s_barrier
MAA 60,80,0
TR 104,25,32
v_add_f32 v164, v164, v172
MAA 60,84,20
TR 106,25,544
MAA 64,84,24
TR 108,25,12448
s_add_u32 m0, s56, 129664
MAA 64,80,4
buffer_load_dwordx4 v18, s[20:23], s54 offen lds
MAA 68,80,8
TR 110,25,12960
MAA 68,84,28
TR 112,25,1056
MAA 72,84,32
TR 114,25,1568
v_add_f32 v165, v165, v173
MAA 72,80,12
TR 116,25,13472
s_waitcnt lgkmcnt(7)
MAA 104,88,12
TR 118,25,13984
MAA 104,92,32
buffer_load_dwordx4 v19, s[20:23], s54 offen offset:1024 lds
MAA 100,92,28
TR 120,25,2080
MAA 100,88,8
buffer_load_dwordx4 v20, s[20:23], s54 offen offset:2048 lds
MAA 96,88,4
s_add_u32 s54, s54, 196608
MAA 96,92,24
TR 122,25,2592
v_add_f32 v166, v166, v174
MAA 92,92,20
TR 124,25,14496
s_add_u32 m0, s55, 0
MAA 92,88,0
buffer_load_dwordx4 v21, s[16:19], s52 offen sc1 lds
MAA 124,0,96
TR 126,25,15008
MAA 124,20,100
RD 40,23,18432
MAA 128,24,100
RD 44,23,19456
MAA 128,4,96
buffer_load_dwordx4 v21, s[16:19], s52 offen offset:1024 sc1 lds
MAA 132,8,96
RD 48,23,20736
v_add_f32 v167, v167, v175
MAA 132,28,100
RD 52,23,21760
MAA 136,32,100
RD 56,24,20480
MAA 136,12,96
buffer_load_dword v22, s[16:19], s52 offen offset:2048 sc1 lds
MAA 156,16,96
s_add_u32 s52, s52, 131072
MAA 156,36,100
s_waitcnt vmcnt(17) lgkmcnt(5)
s_barrier
MAA 76,104,0
RD 60,23,27648
s_add_u32 m0, s56, 67584
MAA 76,108,20
buffer_load_dwordx4 v18, s[20:23], s54 offen lds
MAA 80,108,24
RD 64,23,28672
MAA 80,104,4
RD 68,23,29952
MAA 84,104,8
RD 72,23,30976
MAA 84,108,28
buffer_load_dwordx4 v19, s[20:23], s54 offen offset:1024 lds
MAA 88,108,32
RD 76,24,29696
MAA 88,104,12
buffer_load_dwordx4 v20, s[20:23], s54 offen offset:2048 lds
MAA 120,112,12
TR 80,25,24832
s_add_u32 s54, s54, 196608
MAA 120,116,32
TR 82,25,25344
MAA 116,116,28
TR 84,25,37248
s_add_u32 m0, s55, 9216
MAA 116,112,8
buffer_load_dwordx4 v21, s[16:19], s52 offen sc1 lds
MAA 112,112,4
TR 86,25,37760
MAA 112,116,24
TR 88,25,25856
MAA 108,116,20
TR 90,25,26368
MAA 108,112,0
buffer_load_dwordx4 v21, s[16:19], s52 offen offset:1024 sc1 lds
MAA 140,0,120
TR 92,25,38272
MAA 140,20,124
TR 94,25,38784
MAA 144,24,124
TR 96,25,26880
MAA 144,4,120
buffer_load_dword v22, s[16:19], s52 offen offset:2048 sc1 lds
MAA 148,8,120
TR 98,25,27392
s_add_u32 s52, s52, 131072
MAA 148,28,124
buffer_load_dwordx4 v[172:175], v26, s[16:19], s75 offen offset:1024 sc1
MAA 152,32,124
TR 100,25,39296
s_add_u32 s75, s75, 2048
MAA 152,12,120
TR 102,25,39808
MAA 160,16,120
MAA 160,36,124
s_waitcnt vmcnt(21) lgkmcnt(8)
s_barrier
MAA 60,80,40
TR 104,25,24864
MAA 60,84,60
TR 106,25,25376
MAA 64,84,64
TR 108,25,37280
s_add_u32 m0, s56, 80000
MAA 64,80,44
buffer_load_dwordx4 v18, s[20:23], s54 offen lds
MAA 68,80,48
TR 110,25,37792
MAA 68,84,68
TR 112,25,25888
MAA 72,84,72
TR 114,25,26400
MAA 72,80,52
TR 116,25,38304
s_waitcnt lgkmcnt(7)
MAA 104,88,52
TR 118,25,38816
MAA 104,92,72
buffer_load_dwordx4 v19, s[20:23], s54 offen offset:1024 lds
MAA 100,92,68
TR 120,25,26912
MAA 100,88,48
buffer_load_dwordx4 v20, s[20:23], s54 offen offset:2048 lds
MAA 96,88,44
s_add_u32 s54, s54, 196608
MAA 96,92,64
TR 122,25,27424
MAA 92,92,60
TR 124,25,39328
s_add_u32 m0, s55, 18432
MAA 92,88,40
buffer_load_dwordx4 v21, s[16:19], s52 offen sc1 lds
MAA 124,40,96
TR 126,25,39840
MAA 124,60,100
RD 0,23,36864
MAA 128,64,100
RD 4,23,37888
MAA 128,44,96
buffer_load_dwordx4 v21, s[16:19], s52 offen offset:1024 sc1 lds
MAA 132,48,96
RD 8,23,39168
MAA 132,68,100
RD 12,23,40192
MAA 136,72,100
RD 16,24,38912
MAA 136,52,96
buffer_load_dword v22, s[16:19], s52 offen offset:2048 sc1 lds
MAA 156,56,96
s_add_u32 s52, s52, 131072
MAA 156,76,100
s_waitcnt vmcnt(16) lgkmcnt(5)
s_barrier
MAA 76,104,40
RD 20,23,46080
MAA 76,108,60
RD 24,23,47104
MAA 80,108,64
RD 28,23,48384
s_add_u32 m0, s56, 92416
MAA 80,104,44
buffer_load_dwordx4 v18, s[20:23], s54 offen lds
MAA 84,104,48
RD 32,23,49408
MAA 84,108,68
RD 36,24,48128
MAA 88,108,72
TR 80,25,49664
MAA 88,104,52
buffer_load_dwordx4 v19, s[20:23], s54 offen offset:1024 lds
MAA 120,112,52
TR 82,25,50176
MAA 120,116,72
TR 84,25,62080
MAA 116,116,68
TR 86,25,62592
MAA 116,112,48
buffer_load_dwordx4 v20, s[20:23], s54 offen offset:2048 lds
MAA 112,112,44
s_add_u32 s54, s54, 196608
MAA 112,116,64
TR 88,25,50688
MAA 108,116,60
TR 90,25,51200
s_add_u32 m0, s55, 27648
MAA 108,112,40
buffer_load_dwordx4 v21, s[16:19], s52 offen sc1 lds
MAA 140,40,120
TR 92,25,63104
MAA 140,60,124
TR 94,25,63616
MAA 144,64,124
TR 96,25,51712
MAA 144,44,120
buffer_load_dwordx4 v21, s[16:19], s52 offen offset:1024 sc1 lds
MAA 148,48,120
TR 98,25,52224
MAA 148,68,124
TR 100,25,64128
MAA 152,72,124
TR 102,25,64640
MAA 152,52,120
buffer_load_dword v22, s[16:19], s52 offen offset:2048 sc1 lds
MAA 160,56,120
s_add_u32 s52, s52, 131072
s_add_u32 s15, s15, 1
MAA 160,76,124
s_cbranch_scc0 .Lk58
s_waitcnt vmcnt(19) lgkmcnt(8)
s_barrier
MAA 60,80,0
TR 104,25,49696
v_add_f32 v164, v164, v168
MAA 60,84,20
TR 106,25,50208
s_add_u32 m0, s56, 104832
MAA 64,84,24
buffer_load_dwordx4 v18, s[20:23], s54 offen lds
MAA 64,80,4
TR 108,25,62112
v_add_f32 v165, v165, v169
MAA 68,80,8
TR 110,25,62624
v_add_f32 v166, v166, v170
MAA 68,84,28
TR 112,25,50720
v_add_f32 v167, v167, v171
MAA 72,84,32
buffer_load_dwordx4 v19, s[20:23], s54 offen offset:1024 lds
MAA 72,80,12
TR 114,25,51232
s_waitcnt lgkmcnt(6)
MAA 104,88,12
TR 116,25,63136
MAA 104,92,32
TR 118,25,63648
MAA 100,92,28
buffer_load_dwordx4 v20, s[20:23], s54 offen offset:2048 lds
MAA 100,88,8
TR 120,25,51744
s_add_u32 s54, s54, 196608
MAA 96,88,4
TR 122,25,52256
s_add_u32 m0, s55, 36864
MAA 96,92,24
TR 124,25,64160
MAA 92,92,20
buffer_load_dwordx4 v21, s[16:19], s52 offen sc1 lds
MAA 92,88,0
TR 126,25,64672
MAA 124,0,96
ds_read_b128 a[40:43], v23
MAA 124,20,100
RD 44,23,1024
MAA 128,24,100
buffer_load_dwordx4 v21, s[16:19], s52 offen offset:1024 sc1 lds
MAA 128,4,96
RD 48,23,2304
MAA 132,8,96
RD 52,23,3328
MAA 132,28,100
RD 56,24,2048
MAA 136,32,100
buffer_load_dword v22, s[16:19], s52 offen offset:2048 sc1 lds
MAA 136,12,96
s_add_u32 s52, s52, 131072
MAA 156,16,96
MAA 156,36,100
s_waitcnt vmcnt(15) lgkmcnt(5)
s_barrier
MAA 76,104,0
RD 60,23,9216
v_add_f32 v164, v164, v172
MAA 76,108,20
RD 64,23,10240
s_add_u32 m0, s56, 117248
MAA 80,108,24
buffer_load_dwordx4 v18, s[20:23], s54 offen lds
MAA 80,104,4
RD 68,23,11520
v_add_f32 v165, v165, v173
MAA 84,104,8
RD 72,23,12544
v_add_f32 v166, v166, v174
MAA 84,108,28
RD 76,24,11264
v_add_f32 v167, v167, v175
MAA 88,108,32
buffer_load_dwordx4 v19, s[20:23], s54 offen offset:1024 lds
MAA 88,104,12
ds_read_b64_tr_b16 a[80:81], v25
MAA 120,112,12
TR 82,25,512
MAA 120,116,32
TR 84,25,12416
MAA 116,116,28
buffer_load_dwordx4 v20, s[20:23], s54 offen offset:2048 lds
MAA 116,112,8
TR 86,25,12928
s_add_u32 s54, s54, 196608
MAA 112,112,4
TR 88,25,1024
s_add_u32 m0, s55, 46080
MAA 112,116,24
TR 90,25,1536
MAA 108,116,20
buffer_load_dwordx4 v21, s[16:19], s52 offen sc1 lds
MAA 108,112,0
TR 92,25,13440
MAA 140,0,120
TR 94,25,13952
MAA 140,20,124
TR 96,25,2048
MAA 144,24,124
buffer_load_dwordx4 v21, s[16:19], s52 offen offset:1024 sc1 lds
MAA 144,4,120
TR 98,25,2560
MAA 148,8,120
TR 100,25,14464
MAA 148,28,124
TR 102,25,14976
MAA 152,32,124
buffer_load_dword v22, s[16:19], s52 offen offset:2048 sc1 lds
MAA 152,12,120
s_add_u32 s52, s52, 131072
v_permlane32_swap_b32 v164, v166
MAA 160,16,120
v_permlane32_swap_b32 v165, v167
MAA 160,36,124
s_waitcnt vmcnt(18) lgkmcnt(8)
s_barrier
MAA 60,80,40
TR 104,25,32
v_add_f32 v164, v164, v166
MAA 60,84,60
TR 106,25,544
s_add_u32 m0, s56, 129664
MAA 64,84,64
buffer_load_dwordx4 v18, s[20:23], s54 offen lds
MAA 64,80,44
TR 108,25,12448
v_add_f32 v165, v165, v167
MAA 68,80,48
TR 110,25,12960
v_mul_f32 v164, 0xba800000, v164
MAA 68,84,68
buffer_load_dwordx4 v19, s[20:23], s54 offen offset:1024 lds
MAA 72,84,72
TR 112,25,1056
v_mul_f32 v165, 0x3a800000, v165
MAA 72,80,52
TR 114,25,1568
v_fma_f32 v165, -v164, v164, v165
s_waitcnt lgkmcnt(6)
MAA 104,88,52
buffer_load_dwordx4 v20, s[20:23], s54 offen offset:2048 lds
MAA 104,92,72
TR 116,25,13472
s_add_u32 s54, s54, 196608
MAA 100,92,68
TR 118,25,13984
s_add_u32 m0, s59, 58240
MAA 100,88,48
TR 120,25,2080
s_xor_b32 s58, s87, 1966080
MAA 96,88,44
buffer_load_dwordx4 v5, s[24:27], s58 offen lds
MAA 96,92,64
TR 122,25,2592
v_max_f32 v165, 0, v165
MAA 92,92,60
TR 124,25,14496
v_add_f32 v165, 0x3727c5ac, v165
MAA 92,88,40
buffer_load_dwordx4 v6, s[24:27], s58 offen offset:1024 lds
MAA 124,40,96
TR 126,25,15008
s_add_u32 m0, s59, 0
MAA 124,60,100
RD 0,23,18432
s_xor_b32 s58, s87, 1048576
MAA 128,64,100
buffer_load_dwordx4 v5, s[24:27], s58 offen lds
MAA 128,44,96
RD 4,23,19456
MAA 132,48,96
RD 8,23,20736
MAA 132,68,100
buffer_load_dwordx4 v6, s[24:27], s58 offen offset:1024 lds
MAA 136,72,100
RD 12,23,21760
MAA 136,52,96
RD 16,24,20480
MAA 156,56,96
v_rsq_f32 v166, v165
MAA 156,76,100
v_mov_b32 v165, v166
v_mul_f32 v166, 0x3e8293ee, v166
ds_write_b128 v7, v[164:167]
s_waitcnt vmcnt(16) lgkmcnt(6)
s_barrier
MAA 76,104,40
ds_write_b32 v17, v164
MAA 76,108,60
ds_write_b32 v17, v165 offset:1024
s_add_u32 m0, s59, 8320
MAA 80,108,64
RD 20,23,27648
s_xor_b32 s58, s87, 1179648
MAA 80,104,44
buffer_load_dwordx4 v5, s[24:27], s58 offen lds
MAA 84,104,48
RD 24,23,28672
MAA 84,108,68
RD 28,23,29952
MAA 88,108,72
RD 32,23,30976
MAA 88,104,52
buffer_load_dwordx4 v6, s[24:27], s58 offen offset:1024 lds
MAA 120,112,52
RD 36,24,29696
s_add_u32 m0, s59, 66560
MAA 120,116,72
TR 80,25,24832
s_xor_b32 s58, s87, 0
MAA 116,116,68
TR 82,25,25344
MAA 116,112,48
buffer_load_dwordx4 v5, s[24:27], s58 offen lds
MAA 112,112,44
TR 84,25,37248
MAA 112,116,64
TR 86,25,37760
MAA 108,116,60
TR 88,25,25856
MAA 108,112,40
buffer_load_dwordx4 v6, s[24:27], s58 offen offset:1024 lds
MAA 140,40,120
TR 90,25,26368
s_add_u32 m0, s59, 74880
MAA 140,60,124
TR 92,25,38272
s_xor_b32 s58, s87, 131072
MAA 144,64,124
TR 94,25,38784
MAA 144,44,120
buffer_load_dwordx4 v5, s[24:27], s58 offen lds
MAA 148,48,120
TR 96,25,26880
MAA 148,68,124
TR 98,25,27392
MAA 152,72,124
TR 100,25,39296
MAA 152,52,120
buffer_load_dwordx4 v6, s[24:27], s58 offen offset:1024 lds
MAA 160,56,120
TR 102,25,39808
MAA 160,76,124
s_waitcnt vmcnt(10) lgkmcnt(0)
s_barrier
MAA 104,88,12
TR 112,25,25888
s_add_u32 m0, s59, 83200
MAA 104,92,32
TR 114,25,26400
s_xor_b32 s58, s87, 262144
MAA 100,92,28
buffer_load_dwordx4 v5, s[24:27], s58 offen lds
MAA 100,88,8
TR 116,25,38304
MAA 96,88,4
TR 118,25,38816
MAA 96,92,24
TR 120,25,26912
MAA 92,92,20
buffer_load_dwordx4 v6, s[24:27], s58 offen offset:1024 lds
MAA 92,88,0
TR 122,25,27424
s_add_u32 m0, s59, 16640
MAA 156,16,96
TR 124,25,39328
s_xor_b32 s58, s87, 1310720
MAA 156,36,100
TR 126,25,39840
MAA 72,84,32
buffer_load_dwordx4 v5, s[24:27], s58 offen lds
MAA 72,80,12
TR 104,25,24864
MAA 68,80,8
TR 106,25,25376
MAA 68,84,28
TR 108,25,37280
MAA 64,84,24
buffer_load_dwordx4 v6, s[24:27], s58 offen offset:1024 lds
MAA 64,80,4
TR 110,25,37792
s_add_u32 m0, s59, 24960
MAA 60,80,0
RD 40,23,36864
s_xor_b32 s58, s87, 1441792
MAA 60,84,20
RD 44,23,37888
s_waitcnt lgkmcnt(12)
MAA 120,112,12
buffer_load_dwordx4 v5, s[24:27], s58 offen lds
s_waitcnt lgkmcnt(10)
MAA 120,116,32
RD 48,23,39168
MAA 116,116,28
RD 52,23,40192
MAA 116,112,8
RD 56,24,38912
MAA 112,112,4
buffer_load_dwordx4 v6, s[24:27], s58 offen offset:1024 lds
.Lpad28:
s_cbranch_execz .Lnopoll53r
MAA 112,116,24
s_waitcnt lgkmcnt(5)
s_barrier
RD 60,23,46080
MAA 108,116,20
RD 64,23,47104
s_add_u32 m0, s59, 91520
MAA 108,112,0
RD 68,23,48384
s_xor_b32 s58, s87, 393216
MAA 160,16,120
RD 72,23,49408
MAA 160,36,124
RD 76,24,48128
MAA 88,108,32
TR 144,25,50688
MAA 88,104,12
TR 146,25,51200
MAA 84,104,8
TR 148,25,63104
MAA 84,108,28
TR 150,25,63616
MAA 80,108,24
TR 152,25,50720
MAA 80,104,4
TR 154,25,51232
MAA 76,104,0
TR 156,25,63136
MAA 76,108,20
TR 158,25,63648
TR 160,25,51712
TR 162,25,52224
TR 164,25,64128
s_waitcnt lgkmcnt(9)
MAA 104,144,52
TR 166,25,64640
TR 168,25,51744
TR 170,25,52256
s_waitcnt lgkmcnt(10)
MAA 104,148,72
TR 172,25,64160
MAA 100,148,68
TR 174,25,64672
MAA 100,144,48
TR 136,25,49696
MAA 96,144,44
TR 138,25,50208
MAA 96,148,64
TR 140,25,62112
MAA 92,148,60
TR 142,25,62624
MAA 92,144,40
TR 128,25,49664
s_waitcnt lgkmcnt(15)
MAA 120,152,52
TR 130,25,50176
s_waitcnt lgkmcnt(14)
MAA 120,156,72
TR 132,25,62080
MAA 116,156,68
TR 134,25,62592
MAA 116,152,48
ds_read_b128 v[232:235], v10 offset:1792
MAA 112,152,44
ds_read_b128 v[228:231], v10 offset:1536
MAA 112,156,64
ds_read_b128 v[224:227], v10 offset:1280
MAA 108,156,60
ds_read_b128 v[220:223], v10 offset:1024
MAA 108,152,40
buffer_load_dwordx4 v5, s[24:27], s58 offen lds
s_waitcnt lgkmcnt(15)
MAA 156,56,160
ds_read_b128 v[240:243], v11 offset:704
MAA 156,76,164
ds_read_b128 v[244:247], v11 offset:1728
s_waitcnt lgkmcnt(14)
MAA 160,76,172
ds_read_b128 v[18:21], v11 offset:448
MAA 160,56,168
buffer_load_dwordx4 v6, s[24:27], s58 offen offset:1024 lds
s_waitcnt lgkmcnt(13)
MAA 88,136,52
ds_read_b128 v[22:25], v11 offset:1472
s_add_u32 m0, s59, 99840
s_waitcnt lgkmcnt(12)
MAA 88,140,72
s_xor_b32 s58, s87, 524288
MAA 84,140,68
MAA 84,136,48
buffer_load_dwordx4 v5, s[24:27], s58 offen lds
MAA 80,136,44
MAA 80,140,64
MAA 76,140,60
MAA 76,136,40
buffer_load_dwordx4 v6, s[24:27], s58 offen offset:1024 lds
s_waitcnt lgkmcnt(10)
MAA 72,128,52
s_add_u32 m0, s59, 108160
s_xor_b32 s58, s87, 655360
s_waitcnt lgkmcnt(8)
MAA 72,132,72
MAA 68,132,68
MAA 68,128,48
buffer_load_dwordx4 v5, s[24:27], s58 offen lds
MAA 64,128,44
MAA 64,132,64
MAA 60,132,60
MAA 60,128,40
buffer_load_dwordx4 v6, s[24:27], s58 offen offset:1024 lds
s_waitcnt lgkmcnt(3)
v_pk_fma_f32 v[156:157], v[240:241], v[44:45], v[156:157] op_sel_hi:[1,0,1]
s_waitcnt lgkmcnt(2)
v_pk_mul_f32 v[156:157], v[156:157], v[244:245]
v_cvt_pk_bf16_f32 v236, v156, v157
v_pk_fma_f32 v[158:159], v[242:243], v[44:45], v[158:159] op_sel_hi:[1,0,1]
v_pk_mul_f32 v[158:159], v[158:159], v[246:247]
v_cvt_pk_bf16_f32 v237, v158, v159
v_pk_fma_f32 v[160:161], v[240:241], v[44:45], v[160:161] op_sel:[0,1,0] op_sel_hi:[1,1,1]
v_pk_mul_f32 v[160:161], v[160:161], v[244:245]
v_cvt_pk_bf16_f32 v238, v160, v161
v_pk_fma_f32 v[162:163], v[242:243], v[44:45], v[162:163] op_sel:[0,1,0] op_sel_hi:[1,1,1]
v_pk_mul_f32 v[162:163], v[162:163], v[246:247]
v_cvt_pk_bf16_f32 v239, v162, v163
ds_write_b128 v8, v[236:239] offset:1024
v_pk_fma_f32 v[104:105], v[36:37], v[232:233], v[104:105] op_sel_hi:[1,0,1]
v_pk_mul_f32 v[104:105], v[104:105], v[232:233] op_sel:[0,1] op_sel_hi:[1,1]
v_cvt_pk_bf16_f32 v196, v104, v105
v_pk_fma_f32 v[106:107], v[38:39], v[232:233], v[106:107] op_sel_hi:[1,0,1]
v_pk_mul_f32 v[106:107], v[106:107], v[232:233] op_sel:[0,1] op_sel_hi:[1,1]
v_cvt_pk_bf16_f32 v197, v106, v107
v_pk_fma_f32 v[120:121], v[40:41], v[232:233], v[120:121] op_sel_hi:[1,0,1]
v_pk_mul_f32 v[120:121], v[120:121], v[232:233] op_sel:[0,1] op_sel_hi:[1,1]
v_cvt_pk_bf16_f32 v198, v120, v121
v_pk_fma_f32 v[122:123], v[42:43], v[232:233], v[122:123] op_sel_hi:[1,0,1]
v_pk_mul_f32 v[122:123], v[122:123], v[232:233] op_sel:[0,1] op_sel_hi:[1,1]
v_cvt_pk_bf16_f32 v199, v122, v123
v_pk_fma_f32 v[100:101], v[36:37], v[228:229], v[100:101] op_sel_hi:[1,0,1]
v_pk_mul_f32 v[100:101], v[100:101], v[228:229] op_sel:[0,1] op_sel_hi:[1,1]
v_cvt_pk_bf16_f32 v192, v100, v101
v_pk_fma_f32 v[102:103], v[38:39], v[228:229], v[102:103] op_sel_hi:[1,0,1]
v_pk_mul_f32 v[102:103], v[102:103], v[228:229] op_sel:[0,1] op_sel_hi:[1,1]
v_cvt_pk_bf16_f32 v193, v102, v103
v_pk_fma_f32 v[116:117], v[40:41], v[228:229], v[116:117] op_sel_hi:[1,0,1]
v_pk_mul_f32 v[116:117], v[116:117], v[228:229] op_sel:[0,1] op_sel_hi:[1,1]
v_cvt_pk_bf16_f32 v194, v116, v117
v_pk_fma_f32 v[118:119], v[42:43], v[228:229], v[118:119] op_sel_hi:[1,0,1]
v_pk_mul_f32 v[118:119], v[118:119], v[228:229] op_sel:[0,1] op_sel_hi:[1,1]
v_cvt_pk_bf16_f32 v195, v118, v119
v_pk_fma_f32 v[96:97], v[36:37], v[224:225], v[96:97] op_sel_hi:[1,0,1]
v_pk_mul_f32 v[96:97], v[96:97], v[224:225] op_sel:[0,1] op_sel_hi:[1,1]
v_cvt_pk_bf16_f32 v188, v96, v97
v_pk_fma_f32 v[98:99], v[38:39], v[224:225], v[98:99] op_sel_hi:[1,0,1]
v_pk_mul_f32 v[98:99], v[98:99], v[224:225] op_sel:[0,1] op_sel_hi:[1,1]
v_cvt_pk_bf16_f32 v189, v98, v99
v_pk_fma_f32 v[112:113], v[40:41], v[224:225], v[112:113] op_sel_hi:[1,0,1]
v_pk_mul_f32 v[112:113], v[112:113], v[224:225] op_sel:[0,1] op_sel_hi:[1,1]
v_cvt_pk_bf16_f32 v190, v112, v113
v_pk_fma_f32 v[114:115], v[42:43], v[224:225], v[114:115] op_sel_hi:[1,0,1]
v_pk_mul_f32 v[114:115], v[114:115], v[224:225] op_sel:[0,1] op_sel_hi:[1,1]
v_cvt_pk_bf16_f32 v191, v114, v115
v_pk_fma_f32 v[92:93], v[36:37], v[220:221], v[92:93] op_sel_hi:[1,0,1]
v_pk_mul_f32 v[92:93], v[92:93], v[220:221] op_sel:[0,1] op_sel_hi:[1,1]
v_cvt_pk_bf16_f32 v184, v92, v93
v_pk_fma_f32 v[94:95], v[38:39], v[220:221], v[94:95] op_sel_hi:[1,0,1]
v_pk_mul_f32 v[94:95], v[94:95], v[220:221] op_sel:[0,1] op_sel_hi:[1,1]
v_cvt_pk_bf16_f32 v185, v94, v95
v_pk_fma_f32 v[108:109], v[40:41], v[220:221], v[108:109] op_sel_hi:[1,0,1]
v_pk_mul_f32 v[108:109], v[108:109], v[220:221] op_sel:[0,1] op_sel_hi:[1,1]
v_cvt_pk_bf16_f32 v186, v108, v109
v_pk_fma_f32 v[110:111], v[42:43], v[220:221], v[110:111] op_sel_hi:[1,0,1]
v_pk_mul_f32 v[110:111], v[110:111], v[220:221] op_sel:[0,1] op_sel_hi:[1,1]
v_cvt_pk_bf16_f32 v187, v110, v111
v_pk_fma_f32 v[72:73], v[28:29], v[232:233], v[72:73] op_sel_hi:[1,0,1]
v_cvt_pk_bf16_f32 v176, v72, v73
v_pk_fma_f32 v[74:75], v[30:31], v[232:233], v[74:75] op_sel_hi:[1,0,1]
v_cvt_pk_bf16_f32 v177, v74, v75
v_pk_fma_f32 v[88:89], v[32:33], v[232:233], v[88:89] op_sel_hi:[1,0,1]
v_cvt_pk_bf16_f32 v178, v88, v89
v_pk_fma_f32 v[90:91], v[34:35], v[232:233], v[90:91] op_sel_hi:[1,0,1]
v_cvt_pk_bf16_f32 v179, v90, v91
v_pk_fma_f32 v[68:69], v[28:29], v[228:229], v[68:69] op_sel_hi:[1,0,1]
v_cvt_pk_bf16_f32 v172, v68, v69
v_pk_fma_f32 v[70:71], v[30:31], v[228:229], v[70:71] op_sel_hi:[1,0,1]
v_cvt_pk_bf16_f32 v173, v70, v71
v_pk_fma_f32 v[84:85], v[32:33], v[228:229], v[84:85] op_sel_hi:[1,0,1]
v_cvt_pk_bf16_f32 v174, v84, v85
v_pk_fma_f32 v[86:87], v[34:35], v[228:229], v[86:87] op_sel_hi:[1,0,1]
v_cvt_pk_bf16_f32 v175, v86, v87
v_pk_fma_f32 v[64:65], v[28:29], v[224:225], v[64:65] op_sel_hi:[1,0,1]
v_cvt_pk_bf16_f32 v168, v64, v65
v_pk_fma_f32 v[66:67], v[30:31], v[224:225], v[66:67] op_sel_hi:[1,0,1]
v_cvt_pk_bf16_f32 v169, v66, v67
v_pk_fma_f32 v[80:81], v[32:33], v[224:225], v[80:81] op_sel_hi:[1,0,1]
v_cvt_pk_bf16_f32 v170, v80, v81
v_pk_fma_f32 v[82:83], v[34:35], v[224:225], v[82:83] op_sel_hi:[1,0,1]
v_cvt_pk_bf16_f32 v171, v82, v83
v_pk_fma_f32 v[60:61], v[28:29], v[220:221], v[60:61] op_sel_hi:[1,0,1]
v_cvt_pk_bf16_f32 v164, v60, v61
v_pk_fma_f32 v[62:63], v[30:31], v[220:221], v[62:63] op_sel_hi:[1,0,1]
v_cvt_pk_bf16_f32 v165, v62, v63
v_pk_fma_f32 v[76:77], v[32:33], v[220:221], v[76:77] op_sel_hi:[1,0,1]
v_cvt_pk_bf16_f32 v166, v76, v77
v_pk_fma_f32 v[78:79], v[34:35], v[220:221], v[78:79] op_sel_hi:[1,0,1]
s_waitcnt lgkmcnt(0)
s_barrier
v_cvt_pk_bf16_f32 v167, v78, v79
v_mfma_f32_16x16x32_bf16 v[120:123], v[196:199], v[176:179], v[50:53]
ds_read_b128 v[180:183], v9
v_mfma_f32_16x16x32_bf16 v[104:107], v[192:195], v[176:179], v[46:49]
ds_read_b64 v[200:201], v9 offset:1024
v_mfma_f32_16x16x32_bf16 v[116:119], v[192:195], v[172:175], v[50:53]
ds_read_b64 v[210:211], v9 offset:1032
v_mfma_f32_16x16x32_bf16 v[100:103], v[188:191], v[172:175], v[46:49]
ds_read_b128 v[240:243], v11 offset:384
v_mfma_f32_16x16x32_bf16 v[112:115], v[188:191], v[168:171], v[50:53]
ds_read_b128 v[244:247], v11 offset:1408
v_mfma_f32_16x16x32_bf16 v[96:99], v[184:187], v[168:171], v[46:49]
ds_read_b128 v[28:31], v11 offset:320
v_max3_f32 v88, v104, v105, v106
v_mfma_f32_16x16x32_bf16 v[108:111], v[184:187], v[164:167], v[50:53]
ds_read_b128 v[32:35], v11 offset:1344
v_max3_f32 v89, v107, v120, v121
v_max3_f32 v88, v88, v122, v123
v_max_f32 v90, v88, v89
v_max_f32 v89, v88, v89
v_max3_f32 v84, v100, v101, v102
v_max3_f32 v85, v103, v116, v117
s_waitcnt lgkmcnt(6)
v_mfma_f32_16x16x32_bf16 v[92:95], v[180:183], v[164:167], v[46:49]
ds_read_b128 v[36:39], v11 offset:256
v_permlane16_swap_b32 v90, v89
MAA 136,12,96
ds_read_b128 v[40:43], v11 offset:1280
v_max_f32 v88, v90, v89
MAA 136,32,100
v_max_f32 v89, v90, v89
v_max3_f32 v84, v84, v118, v119
MAA 136,52,160
v_permlane32_swap_b32 v88, v89
MAA 136,72,164
v_max_f32 v88, v88, v89
v_mul_f32 v88, v88, v234
MAA 152,72,172
v_max_f32 v86, v84, v85
v_max_f32 v85, v84, v85
MAA 152,52,168
s_nop 0
v_permlane16_swap_b32 v86, v85
MAA 152,32,124
v_max_f32 v84, v86, v85
v_max_f32 v85, v86, v85
MAA 152,12,120
s_nop 0
v_permlane32_swap_b32 v84, v85
v_max3_f32 v80, v96, v97, v98
v_max_f32 v84, v84, v85
v_mul_f32 v84, v84, v230
v_max3_f32 v81, v99, v112, v113
v_max3_f32 v80, v80, v114, v115
v_max_f32 v82, v80, v81
v_max_f32 v81, v80, v81
v_max3_f32 v76, v92, v93, v94
v_max3_f32 v77, v95, v108, v109
v_permlane16_swap_b32 v82, v81
v_max3_f32 v76, v76, v110, v111
v_max_f32 v80, v82, v81
v_max_f32 v81, v82, v81
v_max_f32 v78, v76, v77
v_max_f32 v77, v76, v77
v_permlane32_swap_b32 v80, v81
v_pk_fma_f32 v[104:105], v[104:105], v[234:235], v[88:89] op_sel_hi:[1,0,0] neg_lo:[0,0,1] neg_hi:[0,0,1]
v_max_f32 v80, v80, v81
v_mul_f32 v80, v80, v226
v_permlane16_swap_b32 v78, v77
v_pk_fma_f32 v[106:107], v[106:107], v[234:235], v[88:89] op_sel_hi:[1,0,0] neg_lo:[0,0,1] neg_hi:[0,0,1]
v_max_f32 v76, v78, v77
v_max_f32 v77, v78, v77
v_pk_fma_f32 v[120:121], v[120:121], v[234:235], v[88:89] op_sel_hi:[1,0,0] neg_lo:[0,0,1] neg_hi:[0,0,1]
v_pk_fma_f32 v[122:123], v[122:123], v[234:235], v[88:89] op_sel_hi:[1,0,0] neg_lo:[0,0,1] neg_hi:[0,0,1]
v_permlane32_swap_b32 v76, v77
v_pk_fma_f32 v[100:101], v[100:101], v[230:231], v[84:85] op_sel_hi:[1,0,0] neg_lo:[0,0,1] neg_hi:[0,0,1]
v_max_f32 v76, v76, v77
v_mul_f32 v76, v76, v222
v_pk_fma_f32 v[102:103], v[102:103], v[230:231], v[84:85] op_sel_hi:[1,0,0] neg_lo:[0,0,1] neg_hi:[0,0,1]
v_pk_fma_f32 v[116:117], v[116:117], v[230:231], v[84:85] op_sel_hi:[1,0,0] neg_lo:[0,0,1] neg_hi:[0,0,1]
v_pk_fma_f32 v[118:119], v[118:119], v[230:231], v[84:85] op_sel_hi:[1,0,0] neg_lo:[0,0,1] neg_hi:[0,0,1]
v_pk_fma_f32 v[96:97], v[96:97], v[226:227], v[80:81] op_sel_hi:[1,0,0] neg_lo:[0,0,1] neg_hi:[0,0,1]
v_pk_fma_f32 v[98:99], v[98:99], v[226:227], v[80:81] op_sel_hi:[1,0,0] neg_lo:[0,0,1] neg_hi:[0,0,1]
v_pk_fma_f32 v[112:113], v[112:113], v[226:227], v[80:81] op_sel_hi:[1,0,0] neg_lo:[0,0,1] neg_hi:[0,0,1]
v_pk_fma_f32 v[114:115], v[114:115], v[226:227], v[80:81] op_sel_hi:[1,0,0] neg_lo:[0,0,1] neg_hi:[0,0,1]
v_pk_fma_f32 v[92:93], v[92:93], v[222:223], v[76:77] op_sel_hi:[1,0,0] neg_lo:[0,0,1] neg_hi:[0,0,1]
v_pk_fma_f32 v[94:95], v[94:95], v[222:223], v[76:77] op_sel_hi:[1,0,0] neg_lo:[0,0,1] neg_hi:[0,0,1]
v_pk_fma_f32 v[108:109], v[108:109], v[222:223], v[76:77] op_sel_hi:[1,0,0] neg_lo:[0,0,1] neg_hi:[0,0,1]
v_pk_fma_f32 v[110:111], v[110:111], v[222:223], v[76:77] op_sel_hi:[1,0,0] neg_lo:[0,0,1] neg_hi:[0,0,1]
v_pk_fma_f32 v[136:137], v[18:19], v[44:45], v[136:137] op_sel_hi:[1,0,1]
v_pk_mul_f32 v[136:137], v[136:137], v[22:23]
v_pk_fma_f32 v[138:139], v[20:21], v[44:45], v[138:139] op_sel_hi:[1,0,1]
v_pk_mul_f32 v[138:139], v[138:139], v[24:25]
v_pk_fma_f32 v[152:153], v[18:19], v[44:45], v[152:153] op_sel:[0,1,0] op_sel_hi:[1,1,1]
v_pk_mul_f32 v[152:153], v[152:153], v[22:23]
v_pk_fma_f32 v[154:155], v[20:21], v[44:45], v[154:155] op_sel:[0,1,0] op_sel_hi:[1,1,1]
v_pk_mul_f32 v[154:155], v[154:155], v[24:25]
v_exp_f32 v104, v104
s_nop 0
MAA 132,8,96
v_exp_f32 v105, v105
MAA 132,28,100
v_exp_f32 v106, v106
MAA 132,48,160
v_exp_f32 v107, v107
MAA 132,68,164
v_exp_f32 v120, v120
MAA 148,68,172
v_exp_f32 v121, v121
MAA 148,48,168
v_exp_f32 v122, v122
MAA 148,28,124
v_exp_f32 v123, v123
MAA 148,8,120
v_exp_f32 v100, v100
MAA 128,4,96
v_exp_f32 v101, v101
MAA 128,24,100
v_exp_f32 v102, v102
MAA 128,44,160
v_exp_f32 v103, v103
MAA 128,64,164
v_exp_f32 v116, v116
MAA 144,64,172
v_exp_f32 v117, v117
MAA 144,44,168
v_exp_f32 v118, v118
MAA 144,24,124
v_exp_f32 v119, v119
MAA 144,4,120
v_exp_f32 v96, v96
MAA 124,0,96
v_exp_f32 v97, v97
MAA 124,20,100
v_exp_f32 v98, v98
MAA 124,40,160
v_exp_f32 v99, v99
MAA 124,60,164
v_exp_f32 v112, v112
MAA 140,60,172
v_exp_f32 v113, v113
MAA 140,40,168
v_exp_f32 v114, v114
MAA 140,20,124
v_exp_f32 v115, v115
MAA 140,0,120
v_cvt_pk_bf16_f32 v72, v104, v105
v_cvt_pk_bf16_f32 v73, v106, v107
v_cvt_pk_bf16_f32 v74, v120, v121
v_cvt_pk_bf16_f32 v75, v122, v123
v_cvt_pk_bf16_f32 v68, v100, v101
v_cvt_pk_bf16_f32 v69, v102, v103
v_cvt_pk_bf16_f32 v70, v116, v117
v_cvt_pk_bf16_f32 v71, v118, v119
v_cvt_pk_bf16_f32 v64, v96, v97
v_cvt_pk_bf16_f32 v65, v98, v99
v_cvt_pk_bf16_f32 v66, v112, v113
v_cvt_pk_bf16_f32 v67, v114, v115
v_cvt_pk_bf16_f32 v208, v136, v137
v_cvt_pk_bf16_f32 v209, v138, v139
v_cvt_pk_bf16_f32 v218, v152, v153
v_cvt_pk_bf16_f32 v219, v154, v155
s_waitcnt lgkmcnt(5)
v_pk_fma_f32 v[132:133], v[240:241], v[44:45], v[132:133] op_sel_hi:[1,0,1]
s_waitcnt lgkmcnt(4)
v_pk_mul_f32 v[132:133], v[132:133], v[244:245]
v_cvt_pk_bf16_f32 v206, v132, v133
v_pk_fma_f32 v[134:135], v[242:243], v[44:45], v[134:135] op_sel_hi:[1,0,1]
v_pk_mul_f32 v[134:135], v[134:135], v[246:247]
v_cvt_pk_bf16_f32 v207, v134, v135
v_pk_fma_f32 v[148:149], v[240:241], v[44:45], v[148:149] op_sel:[0,1,0] op_sel_hi:[1,1,1]
v_pk_mul_f32 v[148:149], v[148:149], v[244:245]
v_cvt_pk_bf16_f32 v216, v148, v149
v_pk_fma_f32 v[150:151], v[242:243], v[44:45], v[150:151] op_sel:[0,1,0] op_sel_hi:[1,1,1]
v_pk_mul_f32 v[150:151], v[150:151], v[246:247]
v_cvt_pk_bf16_f32 v217, v150, v151
s_waitcnt lgkmcnt(3)
v_pk_fma_f32 v[128:129], v[28:29], v[44:45], v[128:129] op_sel_hi:[1,0,1]
s_waitcnt lgkmcnt(2)
v_pk_mul_f32 v[128:129], v[128:129], v[32:33]
v_cvt_pk_bf16_f32 v204, v128, v129
v_pk_fma_f32 v[130:131], v[30:31], v[44:45], v[130:131] op_sel_hi:[1,0,1]
v_pk_mul_f32 v[130:131], v[130:131], v[34:35]
v_cvt_pk_bf16_f32 v205, v130, v131
v_pk_fma_f32 v[144:145], v[28:29], v[44:45], v[144:145] op_sel:[0,1,0] op_sel_hi:[1,1,1]
v_pk_mul_f32 v[144:145], v[144:145], v[32:33]
v_cvt_pk_bf16_f32 v214, v144, v145
v_pk_fma_f32 v[146:147], v[30:31], v[44:45], v[146:147] op_sel:[0,1,0] op_sel_hi:[1,1,1]
v_pk_mul_f32 v[146:147], v[146:147], v[34:35]
v_cvt_pk_bf16_f32 v215, v146, v147
s_waitcnt lgkmcnt(1)
v_pk_fma_f32 v[124:125], v[36:37], v[44:45], v[124:125] op_sel_hi:[1,0,1]
s_waitcnt lgkmcnt(0)
v_pk_mul_f32 v[124:125], v[124:125], v[40:41]
v_cvt_pk_bf16_f32 v202, v124, v125
v_pk_fma_f32 v[126:127], v[38:39], v[44:45], v[126:127] op_sel_hi:[1,0,1]
v_pk_mul_f32 v[126:127], v[126:127], v[42:43]
v_cvt_pk_bf16_f32 v203, v126, v127
v_pk_fma_f32 v[140:141], v[36:37], v[44:45], v[140:141] op_sel:[0,1,0] op_sel_hi:[1,1,1]
v_pk_mul_f32 v[140:141], v[140:141], v[40:41]
v_cvt_pk_bf16_f32 v212, v140, v141
v_pk_fma_f32 v[142:143], v[38:39], v[44:45], v[142:143] op_sel:[0,1,0] op_sel_hi:[1,1,1]
v_pk_mul_f32 v[142:143], v[142:143], v[42:43]
v_cvt_pk_bf16_f32 v213, v142, v143
s_nop 0
v_mfma_f32_16x16x32_bf16 v[88:91], v[248:251], v[72:75], 0
v_exp_f32 v92, v92
v_mfma_f32_16x16x32_bf16 v[104:107], v[206:209], v[72:75], 0
v_exp_f32 v93, v93
v_mfma_f32_16x16x32_bf16 v[120:123], v[216:219], v[72:75], 0
v_exp_f32 v94, v94
v_mfma_f32_16x16x32_bf16 v[84:87], v[248:251], v[68:71], 0
v_exp_f32 v95, v95
v_mfma_f32_16x16x32_bf16 v[100:103], v[204:207], v[68:71], 0
v_exp_f32 v108, v108
v_mfma_f32_16x16x32_bf16 v[116:119], v[214:217], v[68:71], 0
v_exp_f32 v109, v109
v_mfma_f32_16x16x32_bf16 v[80:83], v[248:251], v[64:67], 0
v_exp_f32 v110, v110
v_mfma_f32_16x16x32_bf16 v[96:99], v[202:205], v[64:67], 0
v_exp_f32 v111, v111
v_mfma_f32_16x16x32_bf16 v[112:115], v[212:215], v[64:67], 0
v_cvt_pk_bf16_f32 v60, v92, v93
v_cvt_pk_bf16_f32 v61, v94, v95
v_cvt_pk_bf16_f32 v62, v108, v109
v_cvt_pk_bf16_f32 v63, v110, v111
v_rcp_f32 v88, v88
v_rcp_f32 v84, v84
v_mfma_f32_16x16x32_bf16 v[76:79], v[248:251], v[60:63], 0
v_rcp_f32 v80, v80
v_mfma_f32_16x16x32_bf16 v[92:95], v[200:203], v[60:63], 0
v_mfma_f32_16x16x32_bf16 v[108:111], v[210:213], v[60:63], 0
s_nop 4
v_rcp_f32 v76, v76
v_pk_mul_f32 v[104:105], v[104:105], v[88:89] op_sel_hi:[1,0]
v_pk_mul_f32 v[106:107], v[106:107], v[88:89] op_sel_hi:[1,0]
v_pk_mul_f32 v[120:121], v[120:121], v[88:89] op_sel_hi:[1,0]
v_pk_mul_f32 v[122:123], v[122:123], v[88:89] op_sel_hi:[1,0]
v_cvt_pk_bf16_f32 v176, v104, v105
v_cvt_pk_bf16_f32 v177, v106, v107
v_cvt_pk_bf16_f32 v178, v120, v121
v_cvt_pk_bf16_f32 v179, v122, v123
buffer_store_dwordx4 v[176:179], v4, s[16:19], s74 offen offset:3072 sc1
v_pk_mul_f32 v[100:101], v[100:101], v[84:85] op_sel_hi:[1,0]
v_pk_mul_f32 v[102:103], v[102:103], v[84:85] op_sel_hi:[1,0]
v_pk_mul_f32 v[116:117], v[116:117], v[84:85] op_sel_hi:[1,0]
v_pk_mul_f32 v[118:119], v[118:119], v[84:85] op_sel_hi:[1,0]
v_cvt_pk_bf16_f32 v172, v100, v101
v_cvt_pk_bf16_f32 v173, v102, v103
v_cvt_pk_bf16_f32 v174, v116, v117
v_cvt_pk_bf16_f32 v175, v118, v119
buffer_store_dwordx4 v[172:175], v4, s[16:19], s74 offen offset:2048 sc1
v_pk_mul_f32 v[96:97], v[96:97], v[80:81] op_sel_hi:[1,0]
v_pk_mul_f32 v[98:99], v[98:99], v[80:81] op_sel_hi:[1,0]
v_pk_mul_f32 v[112:113], v[112:113], v[80:81] op_sel_hi:[1,0]
v_pk_mul_f32 v[114:115], v[114:115], v[80:81] op_sel_hi:[1,0]
v_cvt_pk_bf16_f32 v168, v96, v97
v_cvt_pk_bf16_f32 v169, v98, v99
v_cvt_pk_bf16_f32 v170, v112, v113
v_cvt_pk_bf16_f32 v171, v114, v115
buffer_store_dwordx4 v[168:171], v4, s[16:19], s74 offen offset:1024 sc1
v_pk_mul_f32 v[92:93], v[92:93], v[76:77] op_sel_hi:[1,0]
v_pk_mul_f32 v[94:95], v[94:95], v[76:77] op_sel_hi:[1,0]
v_pk_mul_f32 v[108:109], v[108:109], v[76:77] op_sel_hi:[1,0]
v_pk_mul_f32 v[110:111], v[110:111], v[76:77] op_sel_hi:[1,0]
v_cvt_pk_bf16_f32 v164, v92, v93
v_cvt_pk_bf16_f32 v165, v94, v95
v_cvt_pk_bf16_f32 v166, v108, v109
v_cvt_pk_bf16_f32 v167, v110, v111
buffer_store_dwordx4 v[164:167], v4, s[16:19], s74 offen sc1
s_nop 1
.Lqkve56:
s_lshl_b32 s62, s3, 11
s_add_u32 s62, s62, s84
v_lshl_add_u32 v4, v1, 4, s62
v_lshrrev_b32 v2, 3, v1
v_cmp_eq_u32 vcc, 3, v2
v_add_u32 v2, 67108480, v4
s_nop 0
v_cndmask_b32 v4, v4, v2, vcc
v_bfe_u32 v8, v1, 3, 2
v_mul_u32_u24 v8, 2080, v8
v_bfe_u32 v2, v1, 2, 1
v_lshl_add_u32 v8, v2, 7, v8
v_bfe_u32 v2, v1, 5, 1
v_lshl_add_u32 v8, v2, 8, v8
v_and_b32 v2, 3, v1
v_lshl_add_u32 v8, v2, 3, v8
s_mov_b32 s57, 66560
v_add_u32 v7, s57, v8
s_lshr_b32 s54, s87, 17
s_lshl_b32 s54, s54, 18
s_add_u32 s54, s54, 37748736
s_mov_b32 s52, s54
s_add_u32 s53, s54, 131072
v_accvgpr_read_b32 v32, a224
v_accvgpr_read_b32 v33, a225
v_accvgpr_read_b32 v34, a226
v_accvgpr_read_b32 v35, a227
v_accvgpr_read_b32 v36, a228
v_accvgpr_read_b32 v37, a229
v_accvgpr_read_b32 v38, a230
v_accvgpr_read_b32 v39, a231
v_accvgpr_read_b32 v40, a232
v_accvgpr_read_b32 v41, a233
v_accvgpr_read_b32 v42, a234
v_accvgpr_read_b32 v43, a235
v_accvgpr_read_b32 v44, a236
v_accvgpr_read_b32 v45, a237
v_accvgpr_read_b32 v46, a238
v_accvgpr_read_b32 v47, a239
v_accvgpr_read_b32 v48, a240
v_accvgpr_read_b32 v49, a241
v_accvgpr_read_b32 v50, a242
v_accvgpr_read_b32 v51, a243
v_accvgpr_read_b32 v52, a244
v_accvgpr_read_b32 v53, a245
v_accvgpr_read_b32 v54, a246
v_accvgpr_read_b32 v55, a247
v_accvgpr_read_b32 v56, a248
v_accvgpr_read_b32 v57, a249
v_accvgpr_read_b32 v58, a250
v_accvgpr_read_b32 v59, a251
v_accvgpr_read_b32 v60, a252
v_accvgpr_read_b32 v61, a253
v_accvgpr_read_b32 v62, a254
v_accvgpr_read_b32 v63, a255
s_lshl_b32 s62, s8, 10
s_add_u32 s62, s62, 30490624
s_lshl_b32 s64, s6, 10
s_add_u32 s64, s64, 30490624
s_lshr_b32 s67, s5, 2
s_and_b32 s67, s67, 3
s_lshl_b32 s67, s67, 7
s_add_u32 s64, s64, s67
s_waitcnt lgkmcnt(0)
s_mov_b32 s0, 0
s_mov_b32 s1, 16
s_mov_b32 s67, 1
s_waitcnt vmcnt(0) lgkmcnt(0)
s_cmp_lg_u32 s3, 1
s_barrier
s_cbranch_scc1 .Lnopoll60
s_atomic_add s67, s[16:17], s62 offset:0x0
s_atomic_add s67, s[16:17], s62 offset:0x80
s_atomic_add s67, s[16:17], s62 offset:0x100
s_atomic_add s67, s[16:17], s62 offset:0x180
s_atomic_umax s0, s[16:17], s64 glc
s_add_u32 m0, s59, 116480
s_xor_b32 s58, s87, 786432
buffer_load_dwordx4 v5, s[24:27], s58 offen lds
buffer_load_dwordx4 v6, s[24:27], s58 offen offset:1024 lds
s_add_u32 m0, s59, 124800
s_xor_b32 s58, s87, 917504
buffer_load_dwordx4 v5, s[24:27], s58 offen lds
buffer_load_dwordx4 v6, s[24:27], s58 offen offset:1024 lds
s_add_u32 m0, s59, 33280
s_xor_b32 s58, s87, 1572864
buffer_load_dwordx4 v5, s[24:27], s58 offen lds
buffer_load_dwordx4 v6, s[24:27], s58 offen offset:1024 lds
s_add_u32 m0, s59, 41600
s_xor_b32 s58, s87, 1703936
buffer_load_dwordx4 v5, s[24:27], s58 offen lds
buffer_load_dwordx4 v6, s[24:27], s58 offen offset:1024 lds
s_add_u32 m0, s59, 49920
s_xor_b32 s58, s87, 1835008
buffer_load_dwordx4 v5, s[24:27], s58 offen lds
buffer_load_dwordx4 v6, s[24:27], s58 offen offset:1024 lds
.Lpad29:
s_cbranch_execz .Lnopoll53r
s_mov_b32 s15, 0
.Lpoll59:
s_min_u32 s66, s0, s1
s_cmp_ge_u32 s66, 16
s_cbranch_scc1 .Lnopoll60r
s_atomic_umax s0, s[16:17], s64 glc
s_add_u32 s15, s15, 1
s_cmp_le_u32 s15, 100000
s_waitcnt lgkmcnt(1)
s_cbranch_scc1 .Lpoll59
s_branch .Lnopoll60r
.Lnopoll60:
s_add_u32 m0, s59, 116480
s_xor_b32 s58, s87, 786432
buffer_load_dwordx4 v5, s[24:27], s58 offen lds
buffer_load_dwordx4 v6, s[24:27], s58 offen offset:1024 lds
s_add_u32 m0, s59, 124800
s_xor_b32 s58, s87, 917504
buffer_load_dwordx4 v5, s[24:27], s58 offen lds
buffer_load_dwordx4 v6, s[24:27], s58 offen offset:1024 lds
s_add_u32 m0, s59, 33280
s_xor_b32 s58, s87, 1572864
buffer_load_dwordx4 v5, s[24:27], s58 offen lds
buffer_load_dwordx4 v6, s[24:27], s58 offen offset:1024 lds
s_add_u32 m0, s59, 41600
s_xor_b32 s58, s87, 1703936
buffer_load_dwordx4 v5, s[24:27], s58 offen lds
buffer_load_dwordx4 v6, s[24:27], s58 offen offset:1024 lds
s_add_u32 m0, s59, 49920
s_xor_b32 s58, s87, 1835008
buffer_load_dwordx4 v5, s[24:27], s58 offen lds
buffer_load_dwordx4 v6, s[24:27], s58 offen offset:1024 lds
s_mov_b64 exec, 0
s_cmp_eq_u32 s3, 2
s_cbranch_scc1 .Lpad30
s_cmp_eq_u32 s3, 3
s_cbranch_scc1 .Lpad31
s_branch .Lpad32
.Lnopoll60r:
s_mov_b64 exec, -1
s_waitcnt vmcnt(10)
s_barrier
buffer_load_dwordx4 v[64:67], v4, s[16:19], s52 offen sc1
buffer_load_dwordx4 v[68:71], v4, s[16:19], s52 offen offset:1024 sc1
s_xor_b32 s52, s54, 262144
buffer_load_dwordx4 v[72:75], v4, s[16:19], s53 offen sc1
buffer_load_dwordx4 v[76:79], v4, s[16:19], s53 offen offset:1024 sc1
s_xor_b32 s53, s54, 393216
buffer_load_dwordx4 v[80:83], v4, s[16:19], s52 offen sc1
buffer_load_dwordx4 v[84:87], v4, s[16:19], s52 offen offset:1024 sc1
s_xor_b32 s52, s54, 524288
buffer_load_dwordx4 v[88:91], v4, s[16:19], s53 offen sc1
buffer_load_dwordx4 v[92:95], v4, s[16:19], s53 offen offset:1024 sc1
s_xor_b32 s53, s54, 655360
buffer_load_dwordx4 v[96:99], v4, s[16:19], s52 offen sc1
buffer_load_dwordx4 v[100:103], v4, s[16:19], s52 offen offset:1024 sc1
s_xor_b32 s52, s54, 786432
buffer_load_dwordx4 v[104:107], v4, s[16:19], s53 offen sc1
buffer_load_dwordx4 v[108:111], v4, s[16:19], s53 offen offset:1024 sc1
s_xor_b32 s53, s54, 917504
ds_read_b64_tr_b16 a[0:1], v7
TR 2,7,512
TR 16,7,1024
TR 18,7,1536
TR 4,7,32
TR 6,7,544
TR 20,7,1056
TR 22,7,1568
TR 8,7,64
TR 10,7,576
TR 24,7,1088
TR 26,7,1600
TR 12,7,96
TR 14,7,608
TR 28,7,1120
TR 30,7,1632
s_lshl_b32 s62, s49, 3
s_add_u32 s62, s62, s48
s_mul_i32 s62, s62, 28672
s_add_u32 s62, s62, s51
v_lshrrev_b32 v12, 4, v1
v_mul_u32_u24 v12, 57344, v12
v_and_b32 v2, 15, v1
v_lshl_add_u32 v12, v2, 4, v12
v_add_u32 v12, s62, v12
v_add_u32 v13, 6112, v12
v_add_u32 v14, 12224, v12
v_add_u32 v15, 18336, v12
s_mul_i32 s59, s3, 4224
s_mov_b32 s58, 0
s_waitcnt vmcnt(8) lgkmcnt(14)
MAV 32,0,64
TR 32,7,8320
s_waitcnt lgkmcnt(13)
MAV 32,16,72
buffer_load_dwordx4 v[112:115], v4, s[16:19], s52 offen sc1
MAV 48,16,76
TR 34,7,8832
MAV 48,0,68
TR 48,7,9344
TR 50,7,9856
s_waitcnt lgkmcnt(14)
MAV 52,4,68
TR 36,7,8352
s_waitcnt lgkmcnt(13)
MAV 52,20,76
buffer_load_dwordx4 v[116:119], v4, s[16:19], s52 offen offset:1024 sc1
MAV 36,20,72
TR 38,7,8864
s_xor_b32 s52, s54, 1048576
MAV 36,4,64
TR 52,7,9376
TR 54,7,9888
s_waitcnt lgkmcnt(14)
MAV 40,8,64
TR 40,7,8384
s_waitcnt lgkmcnt(13)
MAV 40,24,72
buffer_load_dwordx4 v[120:123], v4, s[16:19], s53 offen sc1
MAV 56,24,76
TR 42,7,8896
MAV 56,8,68
TR 56,7,9408
TR 58,7,9920
s_waitcnt lgkmcnt(14)
MAV 60,12,68
TR 44,7,8416
s_waitcnt lgkmcnt(13)
MAV 60,28,76
buffer_load_dwordx4 v[124:127], v4, s[16:19], s53 offen offset:1024 sc1
MAV 44,28,72
TR 46,7,8928
s_xor_b32 s53, s54, 1179648
MAV 44,12,64
TR 60,7,9440
TR 62,7,9952
s_waitcnt vmcnt(8) lgkmcnt(8)
MAV 32,32,80
TR 0,7,16640
MAV 32,48,88
buffer_load_dwordx4 v[64:67], v4, s[16:19], s52 offen sc1
MAV 48,48,92
TR 2,7,17152
MAV 48,32,84
TR 16,7,17664
TR 18,7,18176
MAV 52,36,84
TR 4,7,16672
MAV 52,52,92
buffer_load_dwordx4 v[68:71], v4, s[16:19], s52 offen offset:1024 sc1
MAV 36,52,88
TR 6,7,17184
s_xor_b32 s52, s54, 1310720
MAV 36,36,80
TR 20,7,17696
TR 22,7,18208
s_waitcnt lgkmcnt(8)
MAV 40,40,80
TR 8,7,16704
MAV 40,56,88
buffer_load_dwordx4 v[72:75], v4, s[16:19], s53 offen sc1
MAV 56,56,92
TR 10,7,17216
MAV 56,40,84
TR 24,7,17728
TR 26,7,18240
MAV 60,44,84
TR 12,7,16736
MAV 60,60,92
buffer_load_dwordx4 v[76:79], v4, s[16:19], s53 offen offset:1024 sc1
MAV 44,60,88
TR 14,7,17248
s_xor_b32 s53, s54, 1441792
MAV 44,44,80
TR 28,7,17760
TR 30,7,18272
s_waitcnt vmcnt(8) lgkmcnt(8)
MAV 32,0,96
TR 32,7,24960
MAV 32,16,104
buffer_load_dwordx4 v[80:83], v4, s[16:19], s52 offen sc1
MAV 48,16,108
TR 34,7,25472
MAV 48,0,100
TR 48,7,25984
TR 50,7,26496
MAV 52,4,100
TR 36,7,24992
MAV 52,20,108
buffer_load_dwordx4 v[84:87], v4, s[16:19], s52 offen offset:1024 sc1
MAV 36,20,104
TR 38,7,25504
s_xor_b32 s52, s54, 1572864
MAV 36,4,96
TR 52,7,26016
TR 54,7,26528
s_waitcnt lgkmcnt(8)
MAV 40,8,96
TR 40,7,25024
MAV 40,24,104
buffer_load_dwordx4 v[88:91], v4, s[16:19], s53 offen sc1
MAV 56,24,108
TR 42,7,25536
MAV 56,8,100
TR 56,7,26048
TR 58,7,26560
MAV 60,12,100
TR 44,7,25056
MAV 60,28,108
buffer_load_dwordx4 v[92:95], v4, s[16:19], s53 offen offset:1024 sc1
MAV 44,28,104
TR 46,7,25568
s_xor_b32 s53, s54, 1703936
MAV 44,12,96
TR 60,7,26080
TR 62,7,26592
s_barrier
s_waitcnt vmcnt(8) lgkmcnt(8)
MAV 32,32,112
TR 0,7,33280
MAV 32,48,120
buffer_load_dwordx4 v[96:99], v4, s[16:19], s52 offen sc1
MAV 48,48,124
TR 2,7,33792
MAV 48,32,116
TR 16,7,34304
TR 18,7,34816
MAV 52,36,116
TR 4,7,33312
MAV 52,52,124
buffer_load_dwordx4 v[100:103], v4, s[16:19], s52 offen offset:1024 sc1
MAV 36,52,120
TR 6,7,33824
s_xor_b32 s52, s54, 1835008
MAV 36,36,112
TR 20,7,34336
TR 22,7,34848
s_waitcnt lgkmcnt(8)
MAV 40,40,112
TR 8,7,33344
MAV 40,56,120
buffer_load_dwordx4 v[104:107], v4, s[16:19], s53 offen sc1
MAV 56,56,124
TR 10,7,33856
MAV 56,40,116
TR 24,7,34368
TR 26,7,34880
MAV 60,44,116
TR 12,7,33376
MAV 60,60,124
buffer_load_dwordx4 v[108:111], v4, s[16:19], s53 offen offset:1024 sc1
MAV 44,60,120
TR 14,7,33888
s_xor_b32 s53, s54, 1966080
MAV 44,44,112
TR 28,7,34400
TR 30,7,34912
s_waitcnt vmcnt(8) lgkmcnt(8)
MAV 32,0,64
TR 32,7,41600
MAV 32,16,72
buffer_load_dwordx4 v[112:115], v4, s[16:19], s52 offen sc1
MAV 48,16,76
TR 34,7,42112
MAV 48,0,68
TR 48,7,42624
TR 50,7,43136
MAV 52,4,68
TR 36,7,41632
MAV 52,20,76
buffer_load_dwordx4 v[116:119], v4, s[16:19], s52 offen offset:1024 sc1
MAV 36,20,72
TR 38,7,42144
s_xor_b32 s52, s54, 2097152
MAV 36,4,64
TR 52,7,42656
TR 54,7,43168
s_waitcnt lgkmcnt(8)
MAV 40,8,64
TR 40,7,41664
MAV 40,24,72
buffer_load_dwordx4 v[120:123], v4, s[16:19], s53 offen sc1
MAV 56,24,76
TR 42,7,42176
MAV 56,8,68
TR 56,7,42688
TR 58,7,43200
MAV 60,12,68
TR 44,7,41696
MAV 60,28,76
buffer_load_dwordx4 v[124:127], v4, s[16:19], s53 offen offset:1024 sc1
MAV 44,28,72
TR 46,7,42208
s_xor_b32 s53, s54, 2228224
MAV 44,12,64
TR 60,7,42720
TR 62,7,43232
s_waitcnt vmcnt(8) lgkmcnt(8)
MAV 32,32,80
TR 0,7,49920
MAV 32,48,88
buffer_load_dwordx4 v[64:67], v4, s[16:19], s52 offen sc1
MAV 48,48,92
TR 2,7,50432
MAV 48,32,84
TR 16,7,50944
TR 18,7,51456
MAV 52,36,84
TR 4,7,49952
MAV 52,52,92
buffer_load_dwordx4 v[68:71], v4, s[16:19], s52 offen offset:1024 sc1
MAV 36,52,88
TR 6,7,50464
s_xor_b32 s52, s54, 2359296
MAV 36,36,80
TR 20,7,50976
TR 22,7,51488
s_waitcnt lgkmcnt(8)
MAV 40,40,80
TR 8,7,49984
MAV 40,56,88
buffer_load_dwordx4 v[72:75], v4, s[16:19], s53 offen sc1
MAV 56,56,92
TR 10,7,50496
MAV 56,40,84
TR 24,7,51008
TR 26,7,51520
MAV 60,44,84
TR 12,7,50016
MAV 60,60,92
buffer_load_dwordx4 v[76:79], v4, s[16:19], s53 offen offset:1024 sc1
MAV 44,60,88
TR 14,7,50528
s_xor_b32 s53, s54, 2490368
MAV 44,44,80
TR 28,7,51040
TR 30,7,51552
s_waitcnt vmcnt(8) lgkmcnt(8)
MAV 32,0,96
TR 32,7,58240
MAV 32,16,104
buffer_load_dwordx4 v[80:83], v4, s[16:19], s52 offen sc1
MAV 48,16,108
TR 34,7,58752
MAV 48,0,100
TR 48,7,59264
TR 50,7,59776
MAV 52,4,100
TR 36,7,58272
MAV 52,20,108
buffer_load_dwordx4 v[84:87], v4, s[16:19], s52 offen offset:1024 sc1
MAV 36,20,104
TR 38,7,58784
s_xor_b32 s52, s54, 2621440
MAV 36,4,96
TR 52,7,59296
TR 54,7,59808
s_waitcnt lgkmcnt(8)
MAV 40,8,96
TR 40,7,58304
MAV 40,24,104
buffer_load_dwordx4 v[88:91], v4, s[16:19], s53 offen sc1
MAV 56,24,108
TR 42,7,58816
MAV 56,8,100
TR 56,7,59328
TR 58,7,59840
MAV 60,12,100
TR 44,7,58336
MAV 60,28,108
buffer_load_dwordx4 v[92:95], v4, s[16:19], s53 offen offset:1024 sc1
MAV 44,28,104
TR 46,7,58848
s_xor_b32 s53, s54, 2752512
MAV 44,12,96
TR 60,7,59360
TR 62,7,59872
s_xor_b32 s57, s57, 66560
v_add_u32 v7, s57, v8
s_waitcnt vmcnt(8) lgkmcnt(8)
MAV 32,32,112
ds_read_b64_tr_b16 a[0:1], v7
MAV 32,48,120
buffer_load_dwordx4 v[96:99], v4, s[16:19], s52 offen sc1
MAV 48,48,124
TR 2,7,512
MAV 48,32,116
TR 16,7,1024
TR 18,7,1536
MAV 52,36,116
TR 4,7,32
MAV 52,52,124
buffer_load_dwordx4 v[100:103], v4, s[16:19], s52 offen offset:1024 sc1
MAV 36,52,120
TR 6,7,544
s_xor_b32 s52, s54, 2883584
MAV 36,36,112
TR 20,7,1056
TR 22,7,1568
s_waitcnt lgkmcnt(8)
MAV 40,40,112
TR 8,7,64
MAV 40,56,120
buffer_load_dwordx4 v[104:107], v4, s[16:19], s53 offen sc1
MAV 56,56,124
TR 10,7,576
MAV 56,40,116
TR 24,7,1088
TR 26,7,1600
MAV 60,44,116
TR 12,7,96
MAV 60,60,124
buffer_load_dwordx4 v[108:111], v4, s[16:19], s53 offen offset:1024 sc1
MAV 44,60,120
TR 14,7,608
s_xor_b32 s53, s54, 3014656
MAV 44,44,112
TR 28,7,1120
TR 30,7,1632
s_waitcnt vmcnt(8) lgkmcnt(8)
MAV 32,0,64
TR 32,7,8320
MAV 32,16,72
buffer_load_dwordx4 v[112:115], v4, s[16:19], s52 offen sc1
MAV 48,16,76
TR 34,7,8832
MAV 48,0,68
TR 48,7,9344
TR 50,7,9856
MAV 52,4,68
TR 36,7,8352
MAV 52,20,76
buffer_load_dwordx4 v[116:119], v4, s[16:19], s52 offen offset:1024 sc1
MAV 36,20,72
TR 38,7,8864
s_xor_b32 s52, s54, 3145728
MAV 36,4,64
TR 52,7,9376
TR 54,7,9888
s_waitcnt lgkmcnt(8)
MAV 40,8,64
TR 40,7,8384
MAV 40,24,72
buffer_load_dwordx4 v[120:123], v4, s[16:19], s53 offen sc1
MAV 56,24,76
TR 42,7,8896
MAV 56,8,68
TR 56,7,9408
TR 58,7,9920
MAV 60,12,68
TR 44,7,8416
MAV 60,28,76
buffer_load_dwordx4 v[124:127], v4, s[16:19], s53 offen offset:1024 sc1
MAV 44,28,72
TR 46,7,8928
s_xor_b32 s53, s54, 3276800
MAV 44,12,64
TR 60,7,9440
TR 62,7,9952
s_waitcnt vmcnt(8) lgkmcnt(8)
MAV 32,32,80
TR 0,7,16640
MAV 32,48,88
buffer_load_dwordx4 v[64:67], v4, s[16:19], s52 offen sc1
MAV 48,48,92
TR 2,7,17152
MAV 48,32,84
TR 16,7,17664
TR 18,7,18176
MAV 52,36,84
TR 4,7,16672
MAV 52,52,92
buffer_load_dwordx4 v[68:71], v4, s[16:19], s52 offen offset:1024 sc1
MAV 36,52,88
TR 6,7,17184
s_xor_b32 s52, s54, 3407872
MAV 36,36,80
TR 20,7,17696
TR 22,7,18208
s_waitcnt lgkmcnt(8)
MAV 40,40,80
TR 8,7,16704
MAV 40,56,88
buffer_load_dwordx4 v[72:75], v4, s[16:19], s53 offen sc1
MAV 56,56,92
TR 10,7,17216
MAV 56,40,84
TR 24,7,17728
TR 26,7,18240
MAV 60,44,84
TR 12,7,16736
MAV 60,60,92
buffer_load_dwordx4 v[76:79], v4, s[16:19], s53 offen offset:1024 sc1
MAV 44,60,88
TR 14,7,17248
s_xor_b32 s53, s54, 3538944
MAV 44,44,80
TR 28,7,17760
TR 30,7,18272
s_waitcnt vmcnt(8) lgkmcnt(8)
MAV 32,0,96
TR 32,7,24960
MAV 32,16,104
buffer_load_dwordx4 v[80:83], v4, s[16:19], s52 offen sc1
MAV 48,16,108
TR 34,7,25472
MAV 48,0,100
TR 48,7,25984
TR 50,7,26496
MAV 52,4,100
TR 36,7,24992
MAV 52,20,108
buffer_load_dwordx4 v[84:87], v4, s[16:19], s52 offen offset:1024 sc1
MAV 36,20,104
TR 38,7,25504
s_xor_b32 s52, s54, 3670016
MAV 36,4,96
TR 52,7,26016
TR 54,7,26528
s_waitcnt lgkmcnt(8)
MAV 40,8,96
TR 40,7,25024
MAV 40,24,104
buffer_load_dwordx4 v[88:91], v4, s[16:19], s53 offen sc1
MAV 56,24,108
TR 42,7,25536
MAV 56,8,100
TR 56,7,26048
TR 58,7,26560
MAV 60,12,100
TR 44,7,25056
MAV 60,28,108
buffer_load_dwordx4 v[92:95], v4, s[16:19], s53 offen offset:1024 sc1
MAV 44,28,104
TR 46,7,25568
s_xor_b32 s53, s54, 3801088
MAV 44,12,96
TR 60,7,26080
TR 62,7,26592
s_waitcnt vmcnt(8) lgkmcnt(8)
MAV 32,32,112
TR 0,7,33280
.Lpad30:
s_cbranch_execz .Lpad33
MAV 32,48,120
buffer_load_dwordx4 v[96:99], v4, s[16:19], s52 offen sc1
MAV 48,48,124
TR 2,7,33792
MAV 48,32,116
TR 16,7,34304
TR 18,7,34816
MAV 52,36,116
TR 4,7,33312
MAV 52,52,124
buffer_load_dwordx4 v[100:103], v4, s[16:19], s52 offen offset:1024 sc1
MAV 36,52,120
TR 6,7,33824
s_xor_b32 s52, s54, 3932160
MAV 36,36,112
TR 20,7,34336
TR 22,7,34848
s_waitcnt lgkmcnt(8)
MAV 40,40,112
TR 8,7,33344
MAV 40,56,120
buffer_load_dwordx4 v[104:107], v4, s[16:19], s53 offen sc1
MAV 56,56,124
TR 10,7,33856
MAV 56,40,116
TR 24,7,34368
TR 26,7,34880
MAV 60,44,116
TR 12,7,33376
MAV 60,60,124
buffer_load_dwordx4 v[108:111], v4, s[16:19], s53 offen offset:1024 sc1
MAV 44,60,120
TR 14,7,33888
s_xor_b32 s53, s54, 4063232
MAV 44,44,112
TR 28,7,34400
TR 30,7,34912
s_waitcnt vmcnt(8) lgkmcnt(8)
MAV 32,0,64
TR 32,7,41600
MAV 32,16,72
buffer_load_dwordx4 v[112:115], v4, s[16:19], s52 offen sc1
MAV 48,16,76
TR 34,7,42112
MAV 48,0,68
TR 48,7,42624
TR 50,7,43136
MAV 52,4,68
TR 36,7,41632
MAV 52,20,76
buffer_load_dwordx4 v[116:119], v4, s[16:19], s52 offen offset:1024 sc1
MAV 36,20,72
TR 38,7,42144
MAV 36,4,64
TR 52,7,42656
TR 54,7,43168
s_waitcnt lgkmcnt(8)
MAV 40,8,64
TR 40,7,41664
MAV 40,24,72
buffer_load_dwordx4 v[120:123], v4, s[16:19], s53 offen sc1
MAV 56,24,76
TR 42,7,42176
MAV 56,8,68
TR 56,7,42688
TR 58,7,43200
MAV 60,12,68
TR 44,7,41696
MAV 60,28,76
buffer_load_dwordx4 v[124:127], v4, s[16:19], s53 offen offset:1024 sc1
MAV 44,28,72
TR 46,7,42208
MAV 44,12,64
TR 60,7,42720
TR 62,7,43232
s_barrier
s_waitcnt vmcnt(8) lgkmcnt(8)
MAV 32,32,80
TR 0,7,49920
s_add_u32 m0, s59, 84480
MAV 32,48,88
buffer_load_dwordx4 v12, s[32:35], s58 offen lds
MAV 48,48,92
TR 2,7,50432
MAV 48,32,84
TR 16,7,50944
TR 18,7,51456
MAV 52,36,84
TR 4,7,49952
MAV 52,52,92
TR 6,7,50464
TR 20,7,50976
MAV 36,52,88
TR 22,7,51488
MAV 36,36,80
TR 8,7,49984
s_waitcnt lgkmcnt(9)
MAV 40,40,80
TR 10,7,50496
MAV 40,56,88
buffer_load_dwordx4 v13, s[32:35], s58 offen offset:1056 lds
MAV 56,56,92
TR 24,7,51008
MAV 56,40,84
buffer_load_dwordx4 v14, s[32:35], s58 offen offset:2112 lds
MAV 60,44,84
TR 26,7,51520
MAV 60,60,92
TR 12,7,50016
TR 14,7,50528
MAV 44,60,88
TR 28,7,51040
MAV 44,44,80
TR 30,7,51552
s_waitcnt vmcnt(7) lgkmcnt(8)
MAV 32,0,96
TR 32,7,58240
MAV 32,16,104
buffer_load_dwordx4 v15, s[32:35], s58 offen offset:3168 lds
MAV 48,16,108
TR 34,7,58752
MAV 48,0,100
TR 48,7,59264
TR 50,7,59776
MAV 52,4,100
TR 36,7,58272
MAV 52,20,108
TR 38,7,58784
TR 52,7,59296
MAV 36,20,104
TR 54,7,59808
MAV 36,4,96
TR 40,7,58304
s_waitcnt lgkmcnt(9)
MAV 40,8,96
TR 42,7,58816
s_add_u32 m0, s59, 101376
MAV 40,24,104
buffer_load_dwordx4 v12, s[80:83], s58 offen lds
MAV 56,24,108
TR 56,7,59328
MAV 56,8,100
buffer_load_dwordx4 v13, s[80:83], s58 offen offset:1056 lds
MAV 60,12,100
TR 58,7,59840
MAV 60,28,108
TR 44,7,58336
TR 46,7,58848
MAV 44,28,104
TR 60,7,59360
MAV 44,12,96
TR 62,7,59872
s_waitcnt vmcnt(9) lgkmcnt(14)
MAV 32,32,112
buffer_load_dwordx4 v14, s[80:83], s58 offen offset:2112 lds
s_waitcnt vmcnt(8) lgkmcnt(12)
MAV 32,48,120
s_lshl_b32 s64, s6, 14
s_lshl_b32 s65, s49, 13
s_add_u32 s64, s64, s65
s_waitcnt vmcnt(7)
MAV 48,48,124
s_lshl_b32 s65, s7, 9
s_add_u32 s64, s64, s65
s_lshl_b32 s65, s48, 8
MAV 48,32,116
s_add_u32 s64, s64, s65
s_add_u32 s64, s64, 63176704
v_and_b32 v152, 31, v1
s_waitcnt lgkmcnt(10)
MAV 52,36,116
buffer_load_dwordx4 v15, s[80:83], s58 offen offset:3168 lds
s_waitcnt lgkmcnt(8)
MAV 52,52,124
s_add_u32 s58, s58, 458752
v_lshlrev_b32 v152, 3, v152
v_lshrrev_b32 v153, 5, v1
MAV 36,52,120
s_lshl_b32 s62, s7, 18
v_lshl_add_u32 v152, v153, 28, v152
s_add_u32 s62, s62, 41943040
MAV 36,36,112
s_add_u32 s63, s62, 131072
v_cvt_pk_bf16_f32 v128, v32, v33
v_cvt_pk_bf16_f32 v129, v34, v35
s_waitcnt lgkmcnt(6)
MAV 40,40,112
v_cvt_pk_bf16_f32 v136, v48, v49
v_cvt_pk_bf16_f32 v137, v50, v51
s_waitcnt lgkmcnt(4)
MAV 40,56,120
v_cvt_pk_bf16_f32 v130, v36, v37
v_cvt_pk_bf16_f32 v131, v38, v39
MAV 56,56,124
buffer_store_dwordx4 v[128:131], v4, s[16:19], s62 offen sc1
MAV 56,40,116
v_cvt_pk_bf16_f32 v138, v52, v53
v_cvt_pk_bf16_f32 v139, v54, v55
s_waitcnt lgkmcnt(2)
MAV 60,44,116
v_cvt_pk_bf16_f32 v132, v40, v41
v_cvt_pk_bf16_f32 v133, v42, v43
s_waitcnt lgkmcnt(0)
MAV 60,60,124
v_cvt_pk_bf16_f32 v140, v56, v57
MAV 44,60,120
buffer_store_dwordx4 v[136:139], v4, s[16:19], s62 offen offset:1024 sc1
MAV 44,44,112
v_cvt_pk_bf16_f32 v141, v58, v59
s_nop 2
v_cvt_pk_bf16_f32 v142, v60, v61
v_pk_mul_f32 v[146:147], v[32:33], v[32:33]
v_pk_mul_f32 v[150:151], v[48:49], v[48:49]
v_cvt_pk_bf16_f32 v143, v62, v63
v_pk_fma_f32 v[146:147], v[34:35], v[34:35], v[146:147]
v_pk_add_f32 v[144:145], v[32:33], v[34:35]
v_pk_fma_f32 v[150:151], v[50:51], v[50:51], v[150:151]
v_cvt_pk_bf16_f32 v134, v44, v45
v_cvt_pk_bf16_f32 v135, v46, v47
buffer_store_dwordx4 v[132:135], v4, s[16:19], s63 offen sc1
v_pk_add_f32 v[148:149], v[48:49], v[50:51]
v_pk_fma_f32 v[146:147], v[36:37], v[36:37], v[146:147]
v_pk_add_f32 v[144:145], v[144:145], v[36:37]
v_pk_fma_f32 v[150:151], v[52:53], v[52:53], v[150:151]
v_pk_add_f32 v[148:149], v[148:149], v[52:53]
v_pk_fma_f32 v[146:147], v[38:39], v[38:39], v[146:147]
v_pk_add_f32 v[144:145], v[144:145], v[38:39]
v_pk_fma_f32 v[150:151], v[54:55], v[54:55], v[150:151]
v_pk_add_f32 v[148:149], v[148:149], v[54:55]
v_pk_fma_f32 v[146:147], v[40:41], v[40:41], v[146:147]
v_pk_add_f32 v[144:145], v[144:145], v[40:41]
v_pk_fma_f32 v[150:151], v[56:57], v[56:57], v[150:151]
v_pk_add_f32 v[148:149], v[148:149], v[56:57]
buffer_store_dwordx4 v[140:143], v4, s[16:19], s63 offen offset:1024 sc1
v_pk_fma_f32 v[146:147], v[42:43], v[42:43], v[146:147]
v_pk_add_f32 v[144:145], v[144:145], v[42:43]
v_pk_fma_f32 v[150:151], v[58:59], v[58:59], v[150:151]
v_pk_add_f32 v[148:149], v[148:149], v[58:59]
v_pk_fma_f32 v[146:147], v[44:45], v[44:45], v[146:147]
v_pk_add_f32 v[144:145], v[144:145], v[44:45]
v_pk_fma_f32 v[150:151], v[60:61], v[60:61], v[150:151]
v_pk_add_f32 v[148:149], v[148:149], v[60:61]
v_pk_fma_f32 v[146:147], v[46:47], v[46:47], v[146:147]
v_pk_add_f32 v[144:145], v[144:145], v[46:47]
v_pk_fma_f32 v[150:151], v[62:63], v[62:63], v[150:151]
v_pk_add_f32 v[148:149], v[148:149], v[62:63]
v_add_f32 v144, v144, v145
v_add_f32 v146, v146, v147
v_add_f32 v148, v148, v149
v_add_f32 v150, v150, v151
s_nop 0
v_permlane16_swap_b32 v144, v148
v_permlane16_swap_b32 v146, v150
v_add_f32 v144, v144, v148
v_add_f32 v146, v146, v150
s_nop 1
v_permlane32_swap_b32 v144, v146
v_add_f32 v144, v144, v146
s_nop 1
v_permlane32_swap_b32 v144, v145
buffer_store_dwordx2 v[144:145], v152, s[16:19], s64 offen sc1
s_nop 1
s_mov_b32 s54, s58
s_mov_b32 s55, s59
v_accvgpr_write_b32 a224, v32
v_accvgpr_write_b32 a225, v33
v_accvgpr_write_b32 a226, v34
v_accvgpr_write_b32 a227, v35
v_accvgpr_write_b32 a228, v36
v_accvgpr_write_b32 a229, v37
v_accvgpr_write_b32 a230, v38
v_accvgpr_write_b32 a231, v39
v_accvgpr_write_b32 a232, v40
v_accvgpr_write_b32 a233, v41
v_accvgpr_write_b32 a234, v42
v_accvgpr_write_b32 a235, v43
v_accvgpr_write_b32 a236, v44
v_accvgpr_write_b32 a237, v45
v_accvgpr_write_b32 a238, v46
v_accvgpr_write_b32 a239, v47
v_accvgpr_write_b32 a240, v48
v_accvgpr_write_b32 a241, v49
v_accvgpr_write_b32 a242, v50
v_accvgpr_write_b32 a243, v51
v_accvgpr_write_b32 a244, v52
v_accvgpr_write_b32 a245, v53
v_accvgpr_write_b32 a246, v54
v_accvgpr_write_b32 a247, v55
v_accvgpr_write_b32 a248, v56
v_accvgpr_write_b32 a249, v57
v_accvgpr_write_b32 a250, v58
v_accvgpr_write_b32 a251, v59
v_accvgpr_write_b32 a252, v60
v_accvgpr_write_b32 a253, v61
v_accvgpr_write_b32 a254, v62
v_accvgpr_write_b32 a255, v63
s_lshl_b32 s62, s10, 14
s_lshl_b32 s63, s3, 12
s_add_u32 s62, s62, s63
s_lshl_b32 s63, s12, 11
s_add_u32 s62, s62, s63
v_lshl_add_u32 v10, v1, 4, s62
v_lshrrev_b32 v2, 3, v1
v_cmp_eq_u32 vcc, 3, v2
v_add_u32 v2, 67108480, v10
s_nop 0
v_cndmask_b32 v10, v10, v2, vcc
v_xor_b32 v11, 2048, v10
v_bfe_u32 v16, v1, 2, 3
v_mul_u32_u24 v16, 1056, v16
v_bfe_u32 v2, v1, 5, 1
v_lshl_add_u32 v16, v2, 8, v16
v_and_b32 v2, 3, v1
v_lshl_add_u32 v16, v2, 3, v16
s_lshl_b32 s62, s12, 6
s_add_u32 s62, s62, 84480
s_xor_b32 s63, s12, 1
s_mul_i32 s63, s63, 192
s_add_u32 s63, s63, 84480
v_add_u32 v17, s63, v16
v_add_u32 v16, s62, v16
s_mov_b32 s52, 41943040
s_mov_b32 s53, 41943040
s_mul_i32 s59, s3, 2112
s_and_b32 s62, s7, 1
s_mul_i32 s62, s62, 3670016
s_lshr_b32 s63, s7, 1
s_lshl_b32 s63, s63, 8
s_add_u32 s62, s62, s63
s_lshl_b32 s63, s3, 12
s_add_u32 s62, s62, s63
v_lshrrev_b32 v5, 4, v1
v_lshlrev_b32 v5, 14, v5
v_and_b32 v2, 15, v1
v_lshl_add_u32 v5, v2, 4, v5
v_add_u32 v5, s62, v5
v_add_u32 v6, 992, v5
s_lshl_b32 s62, s10, 15
s_lshl_b32 s63, s3, 13
s_add_u32 s62, s62, s63
v_lshl_add_u32 v4, v1, 4, s62
s_lshl_b32 s62, s6, 10
s_add_u32 s62, s62, 30507008
s_lshl_b32 s64, s10, 1
s_lshl_b32 s64, s64, 10
s_add_u32 s64, s64, 30507008
s_lshr_b32 s67, s5, 2
s_and_b32 s67, s67, 3
s_lshl_b32 s67, s67, 7
s_add_u32 s64, s64, s67
s_add_u32 s65, s64, 1024
s_waitcnt lgkmcnt(0)
s_mov_b32 s0, 0
s_mov_b32 s1, 0
s_mov_b32 s67, 1
s_waitcnt vmcnt(0) lgkmcnt(0)
s_cmp_lg_u32 s3, 1
s_barrier
s_cbranch_scc1 .Lnopoll63
s_atomic_add s67, s[16:17], s62 offset:0x0
s_atomic_add s67, s[16:17], s62 offset:0x80
s_atomic_add s67, s[16:17], s62 offset:0x100
s_atomic_add s67, s[16:17], s62 offset:0x180
s_atomic_umax s0, s[16:17], s64 glc
s_atomic_umax s1, s[16:17], s65 glc
s_add_u32 m0, s55, 118272
s_nop 0
buffer_load_dwordx4 v12, s[32:35], s54 offen lds
buffer_load_dwordx4 v13, s[32:35], s54 offen offset:1056 lds
buffer_load_dwordx4 v14, s[32:35], s54 offen offset:2112 lds
buffer_load_dwordx4 v15, s[32:35], s54 offen offset:3168 lds
s_add_u32 m0, s55, 135168
s_nop 0
buffer_load_dwordx4 v12, s[80:83], s54 offen lds
buffer_load_dwordx4 v13, s[80:83], s54 offen offset:1056 lds
buffer_load_dwordx4 v14, s[80:83], s54 offen offset:2112 lds
buffer_load_dwordx4 v15, s[80:83], s54 offen offset:3168 lds
s_add_u32 s54, s54, 458752
s_mov_b32 s15, 0
.Lpoll62:
s_min_u32 s66, s0, s1
s_cmp_ge_u32 s66, 16
s_cbranch_scc1 .Lnopoll63r
s_atomic_umax s0, s[16:17], s64 glc
s_atomic_umax s1, s[16:17], s65 glc
s_add_u32 s15, s15, 1
s_cmp_le_u32 s15, 100000
s_waitcnt lgkmcnt(2)
s_cbranch_scc1 .Lpoll62
s_branch .Lnopoll63r
.Lnopoll63:
s_add_u32 m0, s55, 118272
s_nop 0
buffer_load_dwordx4 v12, s[32:35], s54 offen lds
buffer_load_dwordx4 v13, s[32:35], s54 offen offset:1056 lds
buffer_load_dwordx4 v14, s[32:35], s54 offen offset:2112 lds
buffer_load_dwordx4 v15, s[32:35], s54 offen offset:3168 lds
s_add_u32 m0, s55, 135168
s_nop 0
buffer_load_dwordx4 v12, s[80:83], s54 offen lds
buffer_load_dwordx4 v13, s[80:83], s54 offen offset:1056 lds
buffer_load_dwordx4 v14, s[80:83], s54 offen offset:2112 lds
buffer_load_dwordx4 v15, s[80:83], s54 offen offset:3168 lds
s_add_u32 s54, s54, 458752
s_mov_b64 exec, 0
s_cmp_eq_u32 s3, 2
s_cbranch_scc1 .Lpad35
s_cmp_eq_u32 s3, 3
s_cbranch_scc1 .Lpad36
s_branch .Lpad37
.Lnopoll63r:
s_mov_b64 exec, -1
s_waitcnt vmcnt(8)
s_barrier
buffer_load_dwordx4 a[128:131], v10, s[16:19], s52 offen sc1
buffer_load_dwordx4 a[132:135], v10, s[16:19], s52 offen offset:1024 sc1
s_add_u32 s52, s52, 131072
buffer_load_dwordx4 a[144:147], v10, s[16:19], s52 offen sc1
buffer_load_dwordx4 a[148:151], v10, s[16:19], s52 offen offset:1024 sc1
s_add_u32 s52, s52, 131072
buffer_load_dwordx4 a[136:139], v11, s[16:19], s53 offen sc1
buffer_load_dwordx4 a[140:143], v11, s[16:19], s53 offen offset:1024 sc1
s_add_u32 s53, s53, 131072
buffer_load_dwordx4 a[152:155], v11, s[16:19], s53 offen sc1
buffer_load_dwordx4 a[156:159], v11, s[16:19], s53 offen offset:1024 sc1
s_add_u32 s53, s53, 131072
ds_read_b64_tr_b16 a[0:1], v16
TR 2,16,512
TR 4,16,8448
TR 6,16,8960
TR 8,16,32
TR 10,16,544
TR 12,16,8480
TR 14,16,8992
TR 16,16,64
TR 18,16,576
TR 20,16,8512
TR 22,16,9024
TR 24,16,96
TR 26,16,608
TR 28,16,8544
TR 30,16,9056
TR 32,16,128
TR 34,16,640
TR 36,16,8576
TR 38,16,9088
TR 40,16,160
TR 42,16,672
TR 44,16,8608
TR 46,16,9120
ds_read_b64_tr_b16 a[48:49], v17
TR 50,17,512
TR 52,17,8448
TR 54,17,8960
TR 56,17,32
TR 58,17,544
TR 60,17,8480
TR 62,17,8992
s_lshl_b32 s57, s3, 13
s_add_u32 s57, s57, 49920
v_lshl_add_u32 v2, v1, 4, s57
s_waitcnt lgkmcnt(0)
s_barrier
s_waitcnt vmcnt(7)
v_mfma_f32_16x16x32_bf16 v[32:35], a[0:3], a[128:131], 0
buffer_load_dwordx4 a[160:163], v10, s[16:19], s52 offen sc1
s_waitcnt vmcnt(6)
MAA 32,4,144
TR 64,16,16896
v_mfma_f32_16x16x32_bf16 v[36:39], a[0:3], a[132:135], 0
TR 66,16,17408
s_waitcnt vmcnt(5)
MAA 36,4,148
TR 68,16,25344
v_mfma_f32_16x16x32_bf16 v[52:55], a[8:11], a[132:135], 0
buffer_load_dwordx4 a[164:167], v10, s[16:19], s52 offen offset:1024 sc1
MAA 52,12,148
TR 70,16,25856
s_add_u32 s52, s52, 131072
v_mfma_f32_16x16x32_bf16 v[48:51], a[8:11], a[128:131], 0
TR 72,16,16928
MAA 48,12,144
TR 74,16,17440
v_mfma_f32_16x16x32_bf16 v[96:99], a[16:19], a[128:131], 0
buffer_load_dwordx4 a[176:179], v10, s[16:19], s52 offen sc1
MAA 96,20,144
TR 76,16,25376
v_mfma_f32_16x16x32_bf16 v[100:103], a[16:19], a[132:135], 0
TR 78,16,25888
MAA 100,20,148
TR 80,16,16960
v_mfma_f32_16x16x32_bf16 v[116:119], a[24:27], a[132:135], 0
buffer_load_dwordx4 a[180:183], v10, s[16:19], s52 offen offset:1024 sc1
MAA 116,28,148
TR 82,16,17472
s_add_u32 s52, s52, 131072
v_mfma_f32_16x16x32_bf16 v[112:115], a[24:27], a[128:131], 0
TR 84,16,25408
MAA 112,28,144
TR 86,16,25920
v_mfma_f32_16x16x32_bf16 v[160:163], a[32:35], a[128:131], 0
buffer_load_dwordx4 a[168:171], v11, s[16:19], s53 offen sc1
MAA 160,36,144
TR 88,16,16992
v_mfma_f32_16x16x32_bf16 v[164:167], a[32:35], a[132:135], 0
TR 90,16,17504
MAA 164,36,148
TR 92,16,25440
v_mfma_f32_16x16x32_bf16 v[180:183], a[40:43], a[132:135], 0
buffer_load_dwordx4 a[172:175], v11, s[16:19], s53 offen offset:1024 sc1
MAA 180,44,148
TR 94,16,25952
s_add_u32 s53, s53, 131072
v_mfma_f32_16x16x32_bf16 v[176:179], a[40:43], a[128:131], 0
TR 96,16,17024
MAA 176,44,144
TR 98,16,17536
v_mfma_f32_16x16x32_bf16 v[224:227], a[48:51], a[128:131], 0
buffer_load_dwordx4 a[184:187], v11, s[16:19], s53 offen sc1
MAA 224,52,144
TR 100,16,25472
v_mfma_f32_16x16x32_bf16 v[228:231], a[48:51], a[132:135], 0
TR 102,16,25984
MAA 228,52,148
TR 104,16,17056
v_mfma_f32_16x16x32_bf16 v[236:239], a[56:59], a[132:135], 0
buffer_load_dwordx4 a[188:191], v11, s[16:19], s53 offen offset:1024 sc1
MAA 236,60,148
TR 106,16,17568
s_add_u32 s53, s53, 131072
v_mfma_f32_16x16x32_bf16 v[232:235], a[56:59], a[128:131], 0
TR 108,16,25504
s_add_u32 m0, s55, 84480
MAA 232,60,144
TR 110,16,26016
s_waitcnt vmcnt(8)
v_mfma_f32_16x16x32_bf16 v[188:191], a[40:43], a[140:143], 0
buffer_load_dwordx4 v12, s[32:35], s54 offen lds
MAA 188,44,156
TR 112,17,16896
v_mfma_f32_16x16x32_bf16 v[184:187], a[40:43], a[136:139], 0
TR 114,17,17408
MAA 184,44,152
TR 116,17,25344
v_mfma_f32_16x16x32_bf16 v[168:171], a[32:35], a[136:139], 0
buffer_load_dwordx4 v13, s[32:35], s54 offen offset:1056 lds
MAA 168,36,152
TR 118,17,25856
v_mfma_f32_16x16x32_bf16 v[172:175], a[32:35], a[140:143], 0
TR 120,17,16928
MAA 172,36,156
TR 122,17,17440
v_mfma_f32_16x16x32_bf16 v[124:127], a[24:27], a[140:143], 0
buffer_load_dwordx4 v14, s[32:35], s54 offen offset:2112 lds
MAA 124,28,156
TR 124,17,25376
v_mfma_f32_16x16x32_bf16 v[120:123], a[24:27], a[136:139], 0
TR 126,17,25888
MAA 120,28,152
v_mfma_f32_16x16x32_bf16 v[104:107], a[16:19], a[136:139], 0
buffer_load_dwordx4 v15, s[32:35], s54 offen offset:3168 lds
MAA 104,20,152
v_mfma_f32_16x16x32_bf16 v[108:111], a[16:19], a[140:143], 0
MAA 108,20,156
v_mfma_f32_16x16x32_bf16 v[60:63], a[8:11], a[140:143], 0
MAA 60,12,156
v_mfma_f32_16x16x32_bf16 v[56:59], a[8:11], a[136:139], 0
MAA 56,12,152
v_mfma_f32_16x16x32_bf16 v[40:43], a[0:3], a[136:139], 0
MAA 40,4,152
v_mfma_f32_16x16x32_bf16 v[44:47], a[0:3], a[140:143], 0
MAA 44,4,156
.Lpad31:
s_cbranch_execz .Lpad34
s_waitcnt lgkmcnt(0)
s_barrier
v_mfma_f32_16x16x32_bf16 v[64:67], a[64:67], a[128:131], 0
TR 0,16,33792
s_add_u32 m0, s55, 101376
MAA 64,68,144
buffer_load_dwordx4 v12, s[80:83], s54 offen lds
v_mfma_f32_16x16x32_bf16 v[68:71], a[64:67], a[132:135], 0
TR 2,16,34304
s_mul_i32 s66, s13, 114688
MAA 68,68,148
TR 4,16,42240
s_mul_i32 s65, s10, 1818624
v_mfma_f32_16x16x32_bf16 v[84:87], a[72:75], a[132:135], 0
TR 6,16,42752
s_add_u32 s66, s66, s65
MAA 84,76,148
TR 8,16,33824
s_add_u32 s66, s66, 46137344
v_mfma_f32_16x16x32_bf16 v[80:83], a[72:75], a[128:131], 0
buffer_load_dwordx4 v13, s[80:83], s54 offen offset:1056 lds
MAA 80,76,144
TR 10,16,34336
s_add_u32 s65, s66, 49152
v_mfma_f32_16x16x32_bf16 v[128:131], a[80:83], a[128:131], 0
TR 12,16,42272
s_lshl_b32 s62, s12, 16
MAA 128,84,144
TR 14,16,42784
s_add_u32 s62, s62, s66
v_mfma_f32_16x16x32_bf16 v[132:135], a[80:83], a[132:135], 0
TR 16,16,33856
s_add_u32 s63, s62, 16384
MAA 132,84,148
buffer_load_dwordx4 v14, s[80:83], s54 offen offset:2112 lds
v_mfma_f32_16x16x32_bf16 v[148:151], a[88:91], a[132:135], 0
TR 18,16,34368
s_add_u32 s64, s62, 32768
MAA 148,92,148
TR 20,16,42304
s_lshl_b32 s72, s10, 1
v_mfma_f32_16x16x32_bf16 v[144:147], a[88:91], a[128:131], 0
TR 22,16,42816
s_lshr_b32 s74, s11, 4
MAA 144,92,144
TR 24,16,33888
s_add_u32 s72, s72, s74
v_mfma_f32_16x16x32_bf16 v[192:195], a[96:99], a[128:131], 0
buffer_load_dwordx4 v15, s[80:83], s54 offen offset:3168 lds
MAA 192,100,144
TR 26,16,34400
s_add_u32 s54, s54, 458752
v_mfma_f32_16x16x32_bf16 v[196:199], a[96:99], a[132:135], 0
TR 28,16,42336
s_add_u32 m0, s57, 0
MAA 196,100,148
TR 30,16,42848
s_mov_b32 s58, 63176704
v_mfma_f32_16x16x32_bf16 v[212:215], a[104:107], a[132:135], 0
TR 32,16,33920
s_lshl_b32 s72, s72, 10
MAA 212,108,148
buffer_load_dwordx4 v4, s[16:19], s58 offen sc1 lds
v_mfma_f32_16x16x32_bf16 v[208:211], a[104:107], a[128:131], 0
TR 34,16,34432
s_add_u32 s72, s72, 30523392
MAA 208,108,144
TR 36,16,42368
s_and_b32 s73, s6, 14
v_mfma_f32_16x16x32_bf16 v[240:243], a[112:115], a[128:131], 0
TR 38,16,42880
s_and_b32 s74, s7, 1
MAA 240,116,144
TR 40,16,33952
s_add_u32 s73, s73, s74
v_mfma_f32_16x16x32_bf16 v[244:247], a[112:115], a[132:135], 0
buffer_load_dwordx4 v4, s[16:19], s58 offen offset:1024 sc1 lds
MAA 244,116,148
TR 42,16,34464
s_lshl_b32 s73, s73, 10
v_mfma_f32_16x16x32_bf16 v[252:255], a[120:123], a[132:135], 0
TR 44,16,42400
s_add_u32 s73, s73, 30523392
MAA 252,124,148
TR 46,16,42912
s_lshr_b32 s67, s5, 2
v_mfma_f32_16x16x32_bf16 v[248:251], a[120:123], a[128:131], 0
TR 48,17,33792
s_and_b32 s67, s67, 3
MAA 248,124,144
buffer_load_dwordx4 a[128:131], v10, s[16:19], s52 offen sc1
v_mfma_f32_16x16x32_bf16 v[220:223], a[104:107], a[140:143], 0
TR 50,17,34304
s_lshl_b32 s67, s67, 7
MAA 220,108,156
TR 52,17,42240
s_add_u32 s73, s73, s67
v_mfma_f32_16x16x32_bf16 v[216:219], a[104:107], a[136:139], 0
TR 54,17,42752
MAA 216,108,152
TR 56,17,33824
v_mfma_f32_16x16x32_bf16 v[200:203], a[96:99], a[136:139], 0
buffer_load_dwordx4 a[132:135], v10, s[16:19], s52 offen offset:1024 sc1
MAA 200,100,152
TR 58,17,34336
s_add_u32 s52, s52, 131072
v_mfma_f32_16x16x32_bf16 v[204:207], a[96:99], a[140:143], 0
TR 60,17,42272
MAA 204,100,156
TR 62,17,42784
v_mfma_f32_16x16x32_bf16 v[156:159], a[88:91], a[140:143], 0
MAA 156,92,156
buffer_load_dwordx4 a[144:147], v10, s[16:19], s52 offen sc1
v_mfma_f32_16x16x32_bf16 v[152:155], a[88:91], a[136:139], 0
MAA 152,92,152
v_mfma_f32_16x16x32_bf16 v[136:139], a[80:83], a[136:139], 0
MAA 136,84,152
v_mfma_f32_16x16x32_bf16 v[140:143], a[80:83], a[140:143], 0
buffer_load_dwordx4 a[148:151], v10, s[16:19], s52 offen offset:1024 sc1
MAA 140,84,156
s_add_u32 s52, s52, 131072
v_mfma_f32_16x16x32_bf16 v[92:95], a[72:75], a[140:143], 0
MAA 92,76,156
v_mfma_f32_16x16x32_bf16 v[88:91], a[72:75], a[136:139], 0
MAA 88,76,152
v_mfma_f32_16x16x32_bf16 v[72:75], a[64:67], a[136:139], 0
MAA 72,68,152
v_mfma_f32_16x16x32_bf16 v[76:79], a[64:67], a[140:143], 0
MAA 76,68,156
s_waitcnt vmcnt(18) lgkmcnt(0)
s_barrier
MAA 32,0,160
buffer_load_dwordx4 a[136:139], v11, s[16:19], s53 offen sc1
MAA 32,4,176
TR 64,16,50688
s_and_b32 s74, s7, 1
MAA 36,4,180
TR 66,16,51200
s_mul_i32 s87, s74, 917504
MAA 36,0,164
TR 68,16,59136
s_lshr_b32 s75, s6, 1
MAA 52,8,164
TR 70,16,59648
s_mul_i32 s75, s75, 1818624
MAA 52,12,180
buffer_load_dwordx4 a[140:143], v11, s[16:19], s53 offen offset:1024 sc1
MAA 48,12,176
TR 72,16,50720
s_add_u32 s53, s53, 131072
MAA 48,8,160
TR 74,16,51232
s_add_u32 s87, s87, s75
MAA 96,16,160
TR 76,16,59168
s_add_u32 s87, s87, 46137344
MAA 96,20,176
TR 78,16,59680
s_and_b32 s74, s6, 3
MAA 100,20,180
buffer_load_dwordx4 a[152:155], v11, s[16:19], s53 offen sc1
MAA 100,16,164
TR 80,16,50752
s_xor_b32 s75, s74, 0
MAA 116,24,164
TR 82,16,51264
s_sub_u32 s75, s75, 0
MAA 116,28,180
TR 84,16,59200
s_mul_i32 s98, s75, 458752
MAA 112,28,176
TR 86,16,59712
s_mul_i32 s75, s75, 114688
MAA 112,24,160
buffer_load_dwordx4 a[156:159], v11, s[16:19], s53 offen offset:1024 sc1
MAA 160,32,160
TR 88,16,50784
s_add_u32 s53, s53, 131072
MAA 160,36,176
TR 90,16,51296
s_add_u32 m0, s55, 118272
MAA 164,36,180
TR 92,16,59232
s_add_u32 s76, s87, s75
MAA 164,32,164
TR 94,16,59744
s_xor_b32 s75, s74, 1
MAA 180,40,164
buffer_load_dwordx4 v12, s[32:35], s54 offen lds
MAA 180,44,180
TR 96,16,50816
s_sub_u32 s75, s75, 1
MAA 176,44,176
TR 98,16,51328
s_mul_i32 s99, s75, 458752
MAA 176,40,160
TR 100,16,59264
s_mul_i32 s75, s75, 114688
MAA 224,48,160
TR 102,16,59776
s_add_u32 s77, s87, s75
MAA 224,52,176
buffer_load_dwordx4 v13, s[32:35], s54 offen offset:1056 lds
MAA 228,52,180
TR 104,16,50848
s_xor_b32 s75, s74, 2
MAA 228,48,164
TR 106,16,51360
s_sub_u32 s75, s75, 2
MAA 236,56,164
TR 108,16,59296
s_mul_i32 s100, s75, 458752
MAA 236,60,180
TR 110,16,59808
s_mul_i32 s75, s75, 114688
MAA 232,60,176
buffer_load_dwordx4 v14, s[32:35], s54 offen offset:2112 lds
MAA 232,56,160
TR 112,17,50688
s_add_u32 s78, s87, s75
s_waitcnt vmcnt(21)
MAA 188,40,172
TR 114,17,51200
s_xor_b32 s75, s74, 3
MAA 188,44,188
TR 116,17,59136
MAA 184,44,184
TR 118,17,59648
MAA 184,40,168
buffer_load_dwordx4 v15, s[32:35], s54 offen offset:3168 lds
MAA 168,32,168
TR 120,17,50720
s_add_u32 m0, s57, 2048
MAA 168,36,184
TR 122,17,51232
s_mov_b32 s58, 63178752
MAA 172,36,188
TR 124,17,59168
MAA 172,32,172
TR 126,17,59680
MAA 124,24,172
buffer_load_dwordx4 v4, s[16:19], s58 offen sc1 lds
MAA 124,28,188
MAA 120,28,184
MAA 120,24,168
MAA 104,16,168
MAA 104,20,184
buffer_load_dwordx4 v4, s[16:19], s58 offen offset:1024 sc1 lds
MAA 108,20,188
MAA 108,16,172
MAA 60,8,172
MAA 60,12,188
MAA 56,12,184
MAA 56,8,168
MAA 40,0,168
MAA 40,4,184
MAA 44,4,188
MAA 44,0,172
s_waitcnt vmcnt(20) lgkmcnt(0)
s_barrier
MAA 64,64,160
ds_read_b64_tr_b16 a[0:1], v16
s_add_u32 m0, s55, 135168
MAA 64,68,176
buffer_load_dwordx4 v12, s[80:83], s54 offen lds
MAA 68,68,180
TR 2,16,512
s_sub_u32 s75, s75, 3
MAA 68,64,164
TR 4,16,8448
s_mul_i32 s101, s75, 458752
MAA 84,72,164
TR 6,16,8960
s_mul_i32 s75, s75, 114688
MAA 84,76,180
TR 8,16,32
s_add_u32 s79, s87, s75
MAA 80,76,176
buffer_load_dwordx4 v13, s[80:83], s54 offen offset:1056 lds
MAA 80,72,160
TR 10,16,544
s_and_b32 s87, s6, 3
MAA 128,80,160
TR 12,16,8480
s_mov_b32 s46, 0
MAA 128,84,176
TR 14,16,8992
s_lshl_b32 s74, s3, 10
MAA 132,84,180
TR 16,16,64
s_lshl_b32 s75, s12, 9
MAA 132,80,164
buffer_load_dwordx4 v14, s[80:83], s54 offen offset:2112 lds
MAA 148,88,164
TR 18,16,576
s_add_u32 s74, s74, s75
MAA 148,92,180
TR 20,16,8512
s_add_u32 s74, s74, 152576
MAA 144,92,176
TR 22,16,9024
v_and_b32 v18, 15, v1
MAA 144,88,160
TR 24,16,96
v_lshl_add_u32 v18, v18, 4, s74
MAA 192,96,160
buffer_load_dwordx4 v15, s[80:83], s54 offen offset:3168 lds
MAA 192,100,176
TR 26,16,608
s_add_u32 s54, s54, 458752
MAA 196,100,180
TR 28,16,8544
s_add_u32 m0, s57, 4096
MAA 196,96,164
TR 30,16,9056
s_mov_b32 s58, 63180800
MAA 212,104,164
TR 32,16,128
v_xor_b32 v19, 512, v18
MAA 212,108,180
buffer_load_dwordx4 v4, s[16:19], s58 offen sc1 lds
MAA 208,108,176
TR 34,16,640
s_lshl_b32 s74, s12, 7
MAA 208,104,160
TR 36,16,8576
s_add_u32 s74, s74, 161536
MAA 240,112,160
TR 38,16,9088
s_xor_b32 s75, s12, 1
MAA 240,116,176
TR 40,16,160
s_mul_i32 s75, s75, 384
MAA 244,116,180
buffer_load_dwordx4 v4, s[16:19], s58 offen offset:1024 sc1 lds
MAA 244,112,164
TR 42,16,672
s_add_u32 s75, s75, 161536
MAA 252,120,164
TR 44,16,8608
v_lshrrev_b32 v9, 4, v1
MAA 252,124,180
TR 46,16,9120
v_lshlrev_b32 v9, 4, v9
MAA 248,124,176
ds_read_b64_tr_b16 a[48:49], v17
v_add_u32 v8, s75, v9
MAA 248,120,160
buffer_load_dwordx4 a[160:163], v10, s[16:19], s52 offen sc1
MAA 220,104,172
TR 50,17,512
v_add_u32 v9, s74, v9
MAA 220,108,188
TR 52,17,8448
MAA 216,108,184
TR 54,17,8960
MAA 216,104,168
TR 56,17,32
MAA 200,96,168
buffer_load_dwordx4 a[164:167], v10, s[16:19], s52 offen offset:1024 sc1
MAA 200,100,184
TR 58,17,544
s_add_u32 s52, s52, 131072
MAA 204,100,188
TR 60,17,8480
MAA 204,96,172
TR 62,17,8992
MAA 156,88,172
MAA 156,92,188
buffer_load_dwordx4 a[176:179], v10, s[16:19], s52 offen sc1
MAA 152,92,184
MAA 152,88,168
MAA 136,80,168
MAA 136,84,184
MAA 140,84,188
buffer_load_dwordx4 a[180:183], v10, s[16:19], s52 offen offset:1024 sc1
MAA 140,80,172
s_add_u32 s52, s52, 131072
MAA 92,72,172
MAA 92,76,188
MAA 88,76,184
MAA 88,72,168
MAA 72,64,168
MAA 72,68,184
MAA 76,68,188
MAA 76,64,172
s_waitcnt vmcnt(20) lgkmcnt(0)
s_barrier
MAA 32,0,128
buffer_load_dwordx4 a[168:171], v11, s[16:19], s53 offen sc1
MAA 32,4,144
ds_read_b128 v[20:23], v2
MAA 36,4,148
ds_read_b128 v[28:31], v2 offset:1024
MAA 36,0,132
s_waitcnt vmcnt(11)
ds_read_b128 v[24:27], v2 offset:2048
MAA 52,8,132
TR 64,16,16896
MAA 52,12,148
buffer_load_dwordx4 a[172:175], v11, s[16:19], s53 offen offset:1024 sc1
MAA 48,12,144
TR 66,16,17408
s_add_u32 s53, s53, 131072
MAA 48,8,128
TR 68,16,25344
MAA 96,16,128
TR 70,16,25856
MAA 96,20,144
TR 72,16,16928
MAA 100,20,148
buffer_load_dwordx4 a[184:187], v11, s[16:19], s53 offen sc1
MAA 100,16,132
TR 74,16,17440
s_waitcnt lgkmcnt(7)
v_add_f32 v20, v20, v28
MAA 116,24,132
TR 76,16,25376
v_add_f32 v21, v21, v29
MAA 116,28,148
TR 78,16,25888
v_add_f32 v22, v22, v30
MAA 112,28,144
TR 80,16,16960
v_add_f32 v23, v23, v31
MAA 112,24,128
buffer_load_dwordx4 a[188:191], v11, s[16:19], s53 offen offset:1024 sc1
MAA 160,32,128
ds_read_b128 v[28:31], v2 offset:3072
s_add_u32 s53, s53, 131072
MAA 160,36,144
TR 82,16,17472
s_add_u32 m0, s55, 84480
MAA 164,36,148
TR 84,16,25408
s_waitcnt lgkmcnt(12)
v_add_f32 v20, v20, v24
MAA 164,32,132
TR 86,16,25920
v_add_f32 v21, v21, v25
MAA 180,40,132
buffer_load_dwordx4 v12, s[32:35], s54 offen lds
MAA 180,44,148
TR 88,16,16992
v_add_f32 v22, v22, v26
MAA 176,44,144
TR 90,16,17504
v_add_f32 v23, v23, v27
MAA 176,40,128
TR 92,16,25440
MAA 224,48,128
TR 94,16,25952
MAA 224,52,144
buffer_load_dwordx4 v13, s[32:35], s54 offen offset:1056 lds
MAA 228,52,148
TR 96,16,17024
MAA 228,48,132
TR 98,16,17536
MAA 236,56,132
TR 100,16,25472
MAA 236,60,148
TR 102,16,25984
MAA 232,60,144
buffer_load_dwordx4 v14, s[32:35], s54 offen offset:2112 lds
MAA 232,56,128
TR 104,16,17056
MAA 188,40,140
TR 106,16,17568
MAA 188,44,156
TR 108,16,25504
MAA 184,44,152
TR 110,16,26016
MAA 184,40,136
buffer_load_dwordx4 v15, s[32:35], s54 offen offset:3168 lds
MAA 168,32,136
TR 112,17,16896
s_add_u32 m0, s57, 6144
MAA 168,36,152
TR 114,17,17408
s_mov_b32 s58, 63182848
MAA 172,36,156
TR 116,17,25344
MAA 172,32,140
TR 118,17,25856
MAA 124,24,140
buffer_load_dwordx4 v4, s[16:19], s58 offen sc1 lds
MAA 124,28,156
TR 120,17,16928
MAA 120,28,152
TR 122,17,17440
MAA 120,24,136
TR 124,17,25376
MAA 104,16,136
TR 126,17,25888
MAA 104,20,152
buffer_load_dwordx4 v4, s[16:19], s58 offen offset:1024 sc1 lds
MAA 108,20,156
MAA 108,16,140
MAA 60,8,140
MAA 60,12,156
MAA 56,12,152
MAA 56,8,136
MAA 40,0,136
MAA 40,4,152
MAA 44,4,156
MAA 44,0,140
s_waitcnt lgkmcnt(0)
s_barrier
MAA 64,64,128
s_waitcnt vmcnt(14)
ds_read_b128 v[24:27], v2 offset:4096
s_add_u32 m0, s55, 101376
MAA 64,68,144
buffer_load_dwordx4 v12, s[80:83], s54 offen lds
MAA 68,68,148
TR 0,16,33792
v_add_f32 v20, v20, v28
MAA 68,64,132
TR 2,16,34304
v_add_f32 v21, v21, v29
MAA 84,72,132
TR 4,16,42240
v_add_f32 v22, v22, v30
MAA 84,76,148
TR 6,16,42752
v_add_f32 v23, v23, v31
MAA 80,76,144
ds_read_b128 v[28:31], v2 offset:5120
MAA 80,72,128
TR 8,16,33824
MAA 128,80,128
buffer_load_dwordx4 v13, s[80:83], s54 offen offset:1056 lds
MAA 128,84,144
TR 10,16,34336
s_waitcnt lgkmcnt(7)
v_add_f32 v20, v20, v24
MAA 132,84,148
TR 12,16,42272
v_add_f32 v21, v21, v25
MAA 132,80,132
TR 14,16,42784
v_add_f32 v22, v22, v26
MAA 148,88,132
TR 16,16,33856
v_add_f32 v23, v23, v27
MAA 148,92,148
TR 18,16,34368
MAA 144,92,144
TR 20,16,42304
MAA 144,88,128
.Lpad32:
s_cbranch_execz .Lnopoll60r
buffer_load_dwordx4 v14, s[80:83], s54 offen offset:2112 lds
MAA 192,96,128
TR 22,16,42816
MAA 192,100,144
TR 24,16,33888
MAA 196,100,148
TR 26,16,34400
MAA 196,96,132
TR 28,16,42336
MAA 212,104,132
TR 30,16,42848
MAA 212,108,148
TR 32,16,33920
MAA 208,108,144
buffer_load_dwordx4 v15, s[80:83], s54 offen offset:3168 lds
MAA 208,104,128
TR 34,16,34432
s_add_u32 s54, s54, 458752
MAA 240,112,128
TR 36,16,42368
MAA 240,116,144
TR 38,16,42880
MAA 244,116,148
TR 40,16,33952
MAA 244,112,132
TR 42,16,34464
MAA 252,120,132
TR 44,16,42400
MAA 252,124,148
TR 46,16,42912
MAA 248,124,144
TR 48,17,33792
MAA 248,120,128
buffer_load_dwordx4 a[128:131], v10, s[16:19], s52 offen sc1
MAA 220,104,140
TR 50,17,34304
MAA 220,108,156
TR 52,17,42240
MAA 216,108,152
TR 54,17,42752
MAA 216,104,136
TR 56,17,33824
MAA 200,96,136
TR 58,17,34336
MAA 200,100,152
TR 60,17,42272
MAA 204,100,156
buffer_load_dwordx4 a[132:135], v10, s[16:19], s52 offen offset:1024 sc1
MAA 204,96,140
TR 62,17,42784
s_add_u32 s52, s52, 131072
MAA 156,88,140
MAA 156,92,156
MAA 152,92,152
MAA 152,88,136
MAA 136,80,136
MAA 136,84,152
buffer_load_dwordx4 a[144:147], v10, s[16:19], s52 offen sc1
MAA 140,84,156
MAA 140,80,140
MAA 92,72,140
MAA 92,76,156
MAA 88,76,152
MAA 88,72,136
MAA 72,64,136
buffer_load_dwordx4 a[148:151], v10, s[16:19], s52 offen offset:1024 sc1
MAA 72,68,152
s_add_u32 s52, s52, 131072
MAA 76,68,156
MAA 76,64,140
s_waitcnt vmcnt(18) lgkmcnt(0)
s_barrier
MAA 32,0,160
buffer_load_dwordx4 a[136:139], v11, s[16:19], s53 offen sc1
MAA 32,4,176
s_waitcnt vmcnt(9)
ds_read_b128 v[24:27], v2 offset:6144
v_add_f32 v20, v20, v28
MAA 36,4,180
TR 64,16,50688
v_add_f32 v21, v21, v29
MAA 36,0,164
TR 66,16,51200
v_add_f32 v22, v22, v30
MAA 52,8,164
TR 68,16,59136
v_add_f32 v23, v23, v31
MAA 52,12,180
ds_read_b128 v[28:31], v2 offset:7168
MAA 48,12,176
TR 70,16,59648
MAA 48,8,160
buffer_load_dwordx4 a[140:143], v11, s[16:19], s53 offen offset:1024 sc1
MAA 96,16,160
TR 72,16,50720
s_add_u32 s53, s53, 131072
MAA 96,20,176
TR 74,16,51232
s_waitcnt lgkmcnt(7)
v_add_f32 v20, v20, v24
MAA 100,20,180
TR 76,16,59168
v_add_f32 v21, v21, v25
MAA 100,16,164
TR 78,16,59680
v_add_f32 v22, v22, v26
MAA 116,24,164
TR 80,16,50752
v_add_f32 v23, v23, v27
MAA 116,28,180
TR 82,16,51264
s_waitcnt lgkmcnt(7)
v_add_f32 v20, v20, v28
MAA 112,28,176
buffer_load_dwordx4 a[152:155], v11, s[16:19], s53 offen sc1
MAA 112,24,160
TR 84,16,59200
v_add_f32 v21, v21, v29
MAA 160,32,160
TR 86,16,59712
v_add_f32 v22, v22, v30
MAA 160,36,176
TR 88,16,50784
v_add_f32 v23, v23, v31
MAA 164,36,180
TR 90,16,51296
MAA 164,32,164
TR 92,16,59232
MAA 180,40,164
TR 94,16,59744
MAA 180,44,180
buffer_load_dwordx4 a[156:159], v11, s[16:19], s53 offen offset:1024 sc1
MAA 176,44,176
TR 96,16,50816
s_add_u32 s53, s53, 131072
MAA 176,40,160
TR 98,16,51328
s_add_u32 m0, s55, 118272
MAA 224,48,160
TR 100,16,59264
MAA 224,52,176
TR 102,16,59776
MAA 228,52,180
TR 104,16,50848
MAA 228,48,164
TR 106,16,51360
MAA 236,56,164
buffer_load_dwordx4 v12, s[32:35], s54 offen lds
MAA 236,60,180
TR 108,16,59296
MAA 232,60,176
TR 110,16,59808
MAA 232,56,160
TR 112,17,50688
MAA 188,40,172
TR 114,17,51200
MAA 188,44,188
TR 116,17,59136
MAA 184,44,184
TR 118,17,59648
MAA 184,40,168
buffer_load_dwordx4 v13, s[32:35], s54 offen offset:1056 lds
MAA 168,32,168
TR 120,17,50720
MAA 168,36,184
TR 122,17,51232
MAA 172,36,188
TR 124,17,59168
MAA 172,32,172
TR 126,17,59680
MAA 124,24,172
MAA 124,28,188
MAA 120,28,184
buffer_load_dwordx4 v14, s[32:35], s54 offen offset:2112 lds
MAA 120,24,168
MAA 104,16,168
MAA 104,20,184
MAA 108,20,188
MAA 108,16,172
MAA 60,8,172
MAA 60,12,188
buffer_load_dwordx4 v15, s[32:35], s54 offen offset:3168 lds
MAA 56,12,184
MAA 56,8,168
MAA 40,0,168
MAA 40,4,184
MAA 44,4,188
MAA 44,0,172
s_waitcnt lgkmcnt(0)
s_barrier
MAA 64,64,160
ds_read_b64_tr_b16 a[0:1], v16
s_add_u32 m0, s55, 135168
MAA 64,68,176
buffer_load_dwordx4 v12, s[80:83], s54 offen lds
MAA 68,68,180
TR 2,16,512
v_permlane32_swap_b32 v20, v22
MAA 68,64,164
TR 4,16,8448
v_permlane32_swap_b32 v21, v23
MAA 84,72,164
TR 6,16,8960
v_add_f32 v20, v20, v22
MAA 84,76,180
TR 8,16,32
v_add_f32 v21, v21, v23
MAA 80,76,176
TR 10,16,544
v_mul_f32 v20, 0xba800000, v20
MAA 80,72,160
buffer_load_dwordx4 v13, s[80:83], s54 offen offset:1056 lds
MAA 128,80,160
TR 12,16,8480
v_mul_f32 v21, 0x3a800000, v21
MAA 128,84,176
TR 14,16,8992
v_fma_f32 v21, -v20, v20, v21
MAA 132,84,180
TR 16,16,64
v_max_f32 v21, 0, v21
MAA 132,80,164
TR 18,16,576
v_add_f32 v21, 0x3727c5ac, v21
MAA 148,88,164
TR 20,16,8512
v_rsq_f32 v22, v21
MAA 148,92,180
buffer_load_dwordx4 v14, s[80:83], s54 offen offset:2112 lds
MAA 144,92,176
TR 22,16,9024
v_and_b32 v24, 31, v1
MAA 144,88,160
TR 24,16,96
v_lshrrev_b32 v25, 5, v1
MAA 192,96,160
TR 26,16,608
v_lshl_add_u32 v24, v24, 1, v25
MAA 192,100,176
TR 28,16,8544
v_and_b32 v25, 0xc0, v0
MAA 196,100,180
TR 30,16,9056
v_add_u32 v24, v24, v25
MAA 196,96,164
TR 32,16,128
v_lshlrev_b32 v24, 4, v24
MAA 212,104,164
buffer_load_dwordx4 v15, s[80:83], s54 offen offset:3168 lds
MAA 212,108,180
TR 34,16,640
s_add_u32 s54, s54, 458752
MAA 208,108,176
TR 36,16,8576
v_add_u32 v24, 152576, v24
MAA 208,104,160
TR 38,16,9088
v_mul_f32 v22, 0xbfb8aa3b, v22
MAA 240,112,160
ds_write_b128 v24, v[20:23]
s_mov_b32 s58, s98
MAA 240,116,176
ds_read_b64 v[20:21], v18
s_mov_b32 s67, s59
MAA 244,116,180
ds_read_b64 v[22:23], v18 offset:256
MAA 244,112,164
ds_read_b64 v[24:25], v19
MAA 252,120,164
ds_read_b64 v[26:27], v19 offset:256
MAA 252,124,180
ds_read_b32 a192, v18 offset:8
MAA 248,124,176
ds_read_b32 a193, v18 offset:264
v_mov_b32 v18, v5
MAA 248,120,160
buffer_load_dwordx4 a[160:163], v10, s[16:19], s52 offen sc1
MAA 220,104,172
ds_read_b32 a194, v19 offset:8
MAA 220,108,188
ds_read_b32 a195, v19 offset:264
v_add_u32 v19, 992, v5
MAA 216,108,184
TR 40,16,160
MAA 216,104,168
TR 42,16,672
MAA 200,96,168
TR 44,16,8608
MAA 200,100,184
TR 46,16,9120
MAA 204,100,188
buffer_load_dwordx4 a[164:167], v10, s[16:19], s52 offen offset:1024 sc1
MAA 204,96,172
ds_read_b64_tr_b16 a[48:49], v17
s_add_u32 s52, s52, 131072
MAA 156,88,172
TR 50,17,512
MAA 156,92,188
TR 52,17,8448
MAA 152,92,184
TR 54,17,8960
MAA 152,88,168
TR 56,17,32
MAA 136,80,168
TR 58,17,544
MAA 136,84,184
buffer_load_dwordx4 a[176:179], v10, s[16:19], s52 offen sc1
MAA 140,84,188
TR 60,17,8480
MAA 140,80,172
TR 62,17,8992
MAA 92,72,172
MAA 92,76,188
MAA 88,76,184
MAA 88,72,168
MAA 72,64,168
buffer_load_dwordx4 a[180:183], v10, s[16:19], s52 offen offset:1024 sc1
MAA 72,68,184
s_add_u32 s52, s52, 131072
MAA 76,68,188
MAA 76,64,172
s_waitcnt vmcnt(16) lgkmcnt(0)
s_barrier
MAA 32,0,128
ds_read_b128 v[28:31], v9 offset:512
MAA 32,4,144
ds_read_b128 v[4:7], v9 offset:576
MAA 36,4,148
buffer_load_dwordx4 a[168:171], v11, s[16:19], s53 offen sc1
MAA 36,0,132
TR 64,16,16896
MAA 52,8,132
TR 66,16,17408
MAA 52,12,148
TR 68,16,25344
MAA 48,12,144
TR 70,16,25856
MAA 48,8,128
TR 72,16,16928
MAA 96,16,128
buffer_load_dwordx4 a[172:175], v11, s[16:19], s53 offen offset:1024 sc1
MAA 96,20,144
TR 74,16,17440
s_add_u32 s53, s53, 131072
MAA 100,20,148
TR 76,16,25376
s_waitcnt lgkmcnt(8)
v_fmac_f32 v64, v28, v20
MAA 100,16,132
TR 78,16,25888
v_fmac_f32 v65, v29, v20
MAA 116,24,132
TR 80,16,16960
v_fmac_f32 v66, v30, v20
MAA 116,28,148
TR 82,16,17472
v_fmac_f32 v67, v31, v20
MAA 112,28,144
buffer_load_dwordx4 a[184:187], v11, s[16:19], s53 offen sc1
MAA 112,24,128
TR 84,16,25408
v_fmac_f32 v68, v28, v22
MAA 160,32,128
TR 86,16,25920
v_fmac_f32 v69, v29, v22
MAA 160,36,144
TR 88,16,16992
v_fmac_f32 v70, v30, v22
MAA 164,36,148
TR 90,16,17504
v_fmac_f32 v71, v31, v22
MAA 164,32,132
TR 92,16,25440
v_fmac_f32 v72, v28, v24
MAA 180,40,132
buffer_load_dwordx4 a[188:191], v11, s[16:19], s53 offen offset:1024 sc1
MAA 180,44,148
TR 94,16,25952
s_add_u32 s53, s53, 131072
MAA 176,44,144
TR 96,16,17024
s_add_u32 m0, s55, 84480
MAA 176,40,128
TR 98,16,17536
v_fmac_f32 v73, v29, v24
MAA 224,48,128
TR 100,16,25472
v_fmac_f32 v74, v30, v24
MAA 224,52,144
TR 102,16,25984
v_fmac_f32 v75, v31, v24
MAA 228,52,148
buffer_load_dwordx4 v12, s[32:35], s54 offen lds
MAA 228,48,132
TR 104,16,17056
v_fmac_f32 v76, v28, v26
MAA 236,56,132
TR 106,16,17568
v_fmac_f32 v77, v29, v26
MAA 236,60,148
TR 108,16,25504
v_fmac_f32 v78, v30, v26
MAA 232,60,144
TR 110,16,26016
v_fmac_f32 v79, v31, v26
MAA 232,56,128
ds_read_b128 v[28:31], v9 offset:640
s_waitcnt lgkmcnt(15)
v_fmac_f32 v80, v4, v20
s_waitcnt vmcnt(17)
MAA 188,40,140
buffer_load_dwordx4 v13, s[32:35], s54 offen offset:1056 lds
MAA 188,44,156
TR 112,17,16896
v_fmac_f32 v81, v5, v20
MAA 184,44,152
TR 114,17,17408
v_fmac_f32 v82, v6, v20
MAA 184,40,136
TR 116,17,25344
v_fmac_f32 v83, v7, v20
MAA 168,32,136
TR 118,17,25856
v_fmac_f32 v84, v4, v22
MAA 168,36,152
TR 120,17,16928
v_fmac_f32 v85, v5, v22
MAA 172,36,156
buffer_load_dwordx4 v14, s[32:35], s54 offen offset:2112 lds
MAA 172,32,140
TR 122,17,17440
v_fmac_f32 v86, v6, v22
MAA 124,24,140
TR 124,17,25376
v_fmac_f32 v87, v7, v22
MAA 124,28,156
TR 126,17,25888
v_fmac_f32 v88, v4, v24
MAA 120,28,152
v_fmac_f32 v89, v5, v24
v_fmac_f32 v90, v6, v24
MAA 120,24,136
v_fmac_f32 v91, v7, v24
v_fmac_f32 v92, v4, v26
MAA 104,16,136
buffer_load_dwordx4 v15, s[32:35], s54 offen offset:3168 lds
MAA 104,20,152
s_mov_b32 m0, s67
v_fmac_f32 v93, v5, v26
v_fmac_f32 v94, v6, v26
MAA 108,20,156
v_fmac_f32 v95, v7, v26
s_waitcnt lgkmcnt(8)
v_fmac_f32 v128, v28, v20
MAA 108,16,140
ds_read_b128 v[4:7], v8 offset:512
v_fmac_f32 v129, v29, v20
MAA 60,8,140
v_fmac_f32 v130, v30, v20
v_fmac_f32 v131, v31, v20
MAA 60,12,156
v_fmac_f32 v132, v28, v22
v_fmac_f32 v133, v29, v22
MAA 56,12,152
buffer_load_dwordx4 v18, s[28:31], s58 offen lds
MAA 56,8,136
v_fmac_f32 v134, v30, v22
v_fmac_f32 v135, v31, v22
MAA 40,0,136
v_fmac_f32 v136, v28, v24
v_fmac_f32 v137, v29, v24
MAA 40,4,152
v_fmac_f32 v138, v30, v24
v_fmac_f32 v139, v31, v24
MAA 44,4,156
v_fmac_f32 v140, v28, v26
v_fmac_f32 v141, v29, v26
MAA 44,0,140
v_fmac_f32 v142, v30, v26
v_fmac_f32 v143, v31, v26
s_waitcnt lgkmcnt(0)
v_fmac_f32 v240, v4, v20
v_fmac_f32 v241, v5, v20
v_fmac_f32 v242, v6, v20
v_fmac_f32 v243, v7, v20
v_fmac_f32 v244, v4, v22
v_fmac_f32 v245, v5, v22
v_fmac_f32 v246, v6, v22
v_fmac_f32 v247, v7, v22
s_waitcnt vmcnt(17) lgkmcnt(0)
s_barrier
MAA 64,64,128
ds_read_b128 v[28:31], v9
s_add_u32 m0, s55, 101376
MAA 64,68,144
ds_read_b128 v[4:7], v9 offset:64
MAA 68,68,148
buffer_load_dwordx4 v12, s[80:83], s54 offen lds
MAA 68,64,132
TR 0,16,33792
MAA 84,72,132
TR 2,16,34304
MAA 84,76,148
TR 4,16,42240
MAA 80,76,144
TR 6,16,42752
MAA 80,72,128
TR 8,16,33824
MAA 128,80,128
buffer_load_dwordx4 v13, s[80:83], s54 offen offset:1056 lds
MAA 128,84,144
TR 10,16,34336
s_waitcnt lgkmcnt(7)
v_fmac_f32 v32, v28, v20
MAA 132,84,148
TR 12,16,42272
v_fmac_f32 v33, v29, v20
MAA 132,80,132
TR 14,16,42784
v_fmac_f32 v34, v30, v20
MAA 148,88,132
TR 16,16,33856
v_fmac_f32 v35, v31, v20
MAA 148,92,148
TR 18,16,34368
v_fmac_f32 v36, v28, v22
MAA 144,92,144
buffer_load_dwordx4 v14, s[80:83], s54 offen offset:2112 lds
MAA 144,88,128
TR 20,16,42304
v_fmac_f32 v37, v29, v22
MAA 192,96,128
TR 22,16,42816
v_fmac_f32 v38, v30, v22
MAA 192,100,144
TR 24,16,33888
v_fmac_f32 v39, v31, v22
MAA 196,100,148
TR 26,16,34400
v_fmac_f32 v40, v28, v24
MAA 196,96,132
TR 28,16,42336
v_fmac_f32 v41, v29, v24
MAA 212,104,132
buffer_load_dwordx4 v15, s[80:83], s54 offen offset:3168 lds
MAA 212,108,148
TR 30,16,42848
s_add_u32 s54, s54, 458752
MAA 208,108,144
TR 32,16,33920
s_mov_b32 m0, s67
MAA 208,104,128
TR 34,16,34432
v_fmac_f32 v42, v30, v24
MAA 240,112,128
TR 36,16,42368
v_fmac_f32 v43, v31, v24
MAA 240,116,144
TR 38,16,42880
v_fmac_f32 v44, v28, v26
MAA 244,116,148
buffer_load_dwordx4 v19, s[28:31], s58 offen offset:1056 lds
MAA 244,112,132
TR 40,16,33952
s_add_u32 s67, s67, 8448
MAA 252,120,132
TR 42,16,34464
s_add_u32 s58, s58, 0x40000
.Lpad33:
s_cbranch_execz .Lnopoll60r
MAA 252,124,148
TR 44,16,42400
v_fmac_f32 v45, v29, v26
MAA 248,124,144
TR 46,16,42912
v_fmac_f32 v46, v30, v26
MAA 248,120,128
TR 48,17,33792
v_fmac_f32 v47, v31, v26
MAA 220,104,140
ds_read_b128 v[28:31], v9 offset:128
s_waitcnt lgkmcnt(15)
v_fmac_f32 v48, v4, v20
MAA 220,108,156
buffer_load_dwordx4 a[128:131], v10, s[16:19], s52 offen sc1
MAA 216,108,152
TR 50,17,34304
v_fmac_f32 v49, v5, v20
MAA 216,104,136
TR 52,17,42240
v_fmac_f32 v50, v6, v20
MAA 200,96,136
TR 54,17,42752
v_fmac_f32 v51, v7, v20
MAA 200,100,152
TR 56,17,33824
v_fmac_f32 v52, v4, v22
MAA 204,100,156
TR 58,17,34336
v_fmac_f32 v53, v5, v22
MAA 204,96,140
buffer_load_dwordx4 a[132:135], v10, s[16:19], s52 offen offset:1024 sc1
MAA 156,88,140
TR 60,17,42272
s_add_u32 s52, s52, 131072
MAA 156,92,156
TR 62,17,42784
v_fmac_f32 v54, v6, v22
MAA 152,92,152
v_fmac_f32 v55, v7, v22
v_fmac_f32 v56, v4, v24
MAA 152,88,136
v_fmac_f32 v57, v5, v24
v_fmac_f32 v58, v6, v24
MAA 136,80,136
v_fmac_f32 v59, v7, v24
v_fmac_f32 v60, v4, v26
MAA 136,84,152
buffer_load_dwordx4 a[144:147], v10, s[16:19], s52 offen sc1
MAA 140,84,156
v_fmac_f32 v61, v5, v26
v_fmac_f32 v62, v6, v26
MAA 140,80,140
v_fmac_f32 v63, v7, v26
s_waitcnt lgkmcnt(7)
v_fmac_f32 v96, v28, v20
MAA 92,72,140
ds_read_b128 v[4:7], v8
v_fmac_f32 v97, v29, v20
MAA 92,76,156
v_fmac_f32 v98, v30, v20
v_fmac_f32 v99, v31, v20
MAA 88,76,152
v_fmac_f32 v100, v28, v22
v_fmac_f32 v101, v29, v22
MAA 88,72,136
buffer_load_dwordx4 a[148:151], v10, s[16:19], s52 offen offset:1024 sc1
MAA 72,64,136
s_add_u32 s52, s52, 131072
v_fmac_f32 v102, v30, v22
v_fmac_f32 v103, v31, v22
MAA 72,68,152
v_fmac_f32 v104, v28, v24
v_fmac_f32 v105, v29, v24
MAA 76,68,156
v_fmac_f32 v106, v30, v24
v_fmac_f32 v107, v31, v24
MAA 76,64,140
v_fmac_f32 v108, v28, v26
v_fmac_f32 v109, v29, v26
v_fmac_f32 v110, v30, v26
v_fmac_f32 v111, v31, v26
s_waitcnt lgkmcnt(0)
v_fmac_f32 v224, v4, v20
v_fmac_f32 v225, v5, v20
v_fmac_f32 v226, v6, v20
v_fmac_f32 v227, v7, v20
v_fmac_f32 v228, v4, v22
v_fmac_f32 v229, v5, v22
v_fmac_f32 v230, v6, v22
v_fmac_f32 v231, v7, v22
s_waitcnt vmcnt(18) lgkmcnt(0)
s_barrier
MAA 32,0,160
ds_read_b128 v[28:31], v9 offset:704
MAA 32,4,176
ds_read_b128 v[4:7], v9 offset:768
MAA 36,4,180
buffer_load_dwordx4 a[136:139], v11, s[16:19], s53 offen sc1
MAA 36,0,164
TR 64,16,50688
MAA 52,8,164
TR 66,16,51200
MAA 52,12,180
TR 68,16,59136
MAA 48,12,176
TR 70,16,59648
MAA 48,8,160
TR 72,16,50720
MAA 96,16,160
buffer_load_dwordx4 a[140:143], v11, s[16:19], s53 offen offset:1024 sc1
MAA 96,20,176
TR 74,16,51232
s_add_u32 s53, s53, 131072
MAA 100,20,180
TR 76,16,59168
s_waitcnt lgkmcnt(8)
v_fmac_f32 v144, v28, v20
MAA 100,16,164
TR 78,16,59680
v_fmac_f32 v145, v29, v20
MAA 116,24,164
TR 80,16,50752
v_fmac_f32 v146, v30, v20
MAA 116,28,180
TR 82,16,51264
v_fmac_f32 v147, v31, v20
MAA 112,28,176
buffer_load_dwordx4 a[152:155], v11, s[16:19], s53 offen sc1
MAA 112,24,160
TR 84,16,59200
v_fmac_f32 v148, v28, v22
MAA 160,32,160
TR 86,16,59712
v_fmac_f32 v149, v29, v22
MAA 160,36,176
TR 88,16,50784
v_fmac_f32 v150, v30, v22
MAA 164,36,180
TR 90,16,51296
v_fmac_f32 v151, v31, v22
MAA 164,32,164
TR 92,16,59232
v_fmac_f32 v152, v28, v24
MAA 180,40,164
buffer_load_dwordx4 a[156:159], v11, s[16:19], s53 offen offset:1024 sc1
MAA 180,44,180
TR 94,16,59744
s_add_u32 s53, s53, 131072
MAA 176,44,176
TR 96,16,50816
s_add_u32 m0, s55, 118272
MAA 176,40,160
TR 98,16,51328
v_fmac_f32 v153, v29, v24
MAA 224,48,160
TR 100,16,59264
v_fmac_f32 v154, v30, v24
MAA 224,52,176
TR 102,16,59776
v_fmac_f32 v155, v31, v24
MAA 228,52,180
buffer_load_dwordx4 v12, s[32:35], s54 offen lds
MAA 228,48,164
TR 104,16,50848
v_fmac_f32 v156, v28, v26
MAA 236,56,164
TR 106,16,51360
v_fmac_f32 v157, v29, v26
MAA 236,60,180
TR 108,16,59296
v_fmac_f32 v158, v30, v26
MAA 232,60,176
TR 110,16,59808
v_fmac_f32 v159, v31, v26
MAA 232,56,160
ds_read_b128 v[28:31], v9 offset:832
s_waitcnt lgkmcnt(15)
v_fmac_f32 v192, v4, v20
s_waitcnt vmcnt(19)
MAA 188,40,172
buffer_load_dwordx4 v13, s[32:35], s54 offen offset:1056 lds
MAA 188,44,188
TR 112,17,50688
v_fmac_f32 v193, v5, v20
MAA 184,44,184
TR 114,17,51200
v_fmac_f32 v194, v6, v20
MAA 184,40,168
TR 116,17,59136
v_fmac_f32 v195, v7, v20
MAA 168,32,168
TR 118,17,59648
v_fmac_f32 v196, v4, v22
MAA 168,36,184
TR 120,17,50720
v_fmac_f32 v197, v5, v22
MAA 172,36,188
buffer_load_dwordx4 v14, s[32:35], s54 offen offset:2112 lds
MAA 172,32,172
TR 122,17,51232
v_fmac_f32 v198, v6, v22
MAA 124,24,172
TR 124,17,59168
v_fmac_f32 v199, v7, v22
MAA 124,28,188
TR 126,17,59680
v_fmac_f32 v200, v4, v24
MAA 120,28,184
v_fmac_f32 v201, v5, v24
v_fmac_f32 v202, v6, v24
MAA 120,24,168
v_fmac_f32 v203, v7, v24
v_fmac_f32 v204, v4, v26
MAA 104,16,168
buffer_load_dwordx4 v15, s[32:35], s54 offen offset:3168 lds
MAA 104,20,184
s_mov_b32 m0, s67
v_fmac_f32 v205, v5, v26
v_fmac_f32 v206, v6, v26
MAA 108,20,188
v_fmac_f32 v207, v7, v26
s_waitcnt lgkmcnt(8)
v_fmac_f32 v208, v28, v20
MAA 108,16,172
ds_read_b128 v[4:7], v8 offset:576
v_fmac_f32 v209, v29, v20
MAA 60,8,172
v_fmac_f32 v210, v30, v20
v_fmac_f32 v211, v31, v20
MAA 60,12,188
v_fmac_f32 v212, v28, v22
v_fmac_f32 v213, v29, v22
MAA 56,12,184
buffer_load_dwordx4 v18, s[28:31], s58 offen lds
MAA 56,8,168
v_fmac_f32 v214, v30, v22
v_fmac_f32 v215, v31, v22
MAA 40,0,168
v_fmac_f32 v216, v28, v24
v_fmac_f32 v217, v29, v24
MAA 40,4,184
v_fmac_f32 v218, v30, v24
v_fmac_f32 v219, v31, v24
MAA 44,4,188
v_fmac_f32 v220, v28, v26
v_fmac_f32 v221, v29, v26
MAA 44,0,172
v_fmac_f32 v222, v30, v26
v_fmac_f32 v223, v31, v26
s_waitcnt lgkmcnt(0)
v_fmac_f32 v248, v4, v20
v_fmac_f32 v249, v5, v20
v_fmac_f32 v250, v6, v20
v_fmac_f32 v251, v7, v20
v_fmac_f32 v252, v4, v22
v_fmac_f32 v253, v5, v22
v_fmac_f32 v254, v6, v22
v_fmac_f32 v255, v7, v22
s_waitcnt vmcnt(19) lgkmcnt(0)
s_barrier
MAA 64,64,160
ds_read_b128 v[28:31], v9 offset:192
s_add_u32 m0, s55, 135168
MAA 64,68,176
ds_read_b128 v[4:7], v9 offset:256
MAA 68,68,180
buffer_load_dwordx4 v12, s[80:83], s54 offen lds
MAA 68,64,164
ds_read_b64_tr_b16 a[0:1], v16
MAA 84,72,164
TR 2,16,512
MAA 84,76,180
TR 4,16,8448
MAA 80,76,176
TR 6,16,8960
MAA 80,72,160
TR 8,16,32
MAA 128,80,160
buffer_load_dwordx4 v13, s[80:83], s54 offen offset:1056 lds
MAA 128,84,176
TR 10,16,544
s_waitcnt lgkmcnt(7)
v_fmac_f32 v112, v28, v20
MAA 132,84,180
TR 12,16,8480
v_fmac_f32 v113, v29, v20
MAA 132,80,164
TR 14,16,8992
v_fmac_f32 v114, v30, v20
MAA 148,88,164
TR 16,16,64
v_fmac_f32 v115, v31, v20
MAA 148,92,180
TR 18,16,576
v_fmac_f32 v116, v28, v22
MAA 144,92,176
buffer_load_dwordx4 v14, s[80:83], s54 offen offset:2112 lds
MAA 144,88,160
TR 20,16,8512
v_fmac_f32 v117, v29, v22
MAA 192,96,160
TR 22,16,9024
v_fmac_f32 v118, v30, v22
MAA 192,100,176
TR 24,16,96
v_fmac_f32 v119, v31, v22
MAA 196,100,180
TR 26,16,608
v_fmac_f32 v120, v28, v24
MAA 196,96,164
TR 28,16,8544
v_fmac_f32 v121, v29, v24
MAA 212,104,164
buffer_load_dwordx4 v15, s[80:83], s54 offen offset:3168 lds
MAA 212,108,180
TR 30,16,9056
s_add_u32 s54, s54, 458752
MAA 208,108,176
TR 32,16,128
s_mov_b32 m0, s67
MAA 208,104,160
TR 34,16,640
v_fmac_f32 v122, v30, v24
MAA 240,112,160
TR 36,16,8576
v_fmac_f32 v123, v31, v24
MAA 240,116,176
TR 38,16,9088
v_fmac_f32 v124, v28, v26
MAA 244,116,180
buffer_load_dwordx4 v19, s[28:31], s58 offen offset:1056 lds
MAA 244,112,164
TR 40,16,160
s_add_u32 s67, s67, 8448
MAA 252,120,164
TR 42,16,672
s_add_u32 s46, s46, 1
MAA 252,124,180
TR 44,16,8608
s_xor_b32 s58, s46, s87
MAA 248,124,176
TR 46,16,9120
s_mul_i32 s58, s58, 458752
MAA 248,120,160
ds_read_b64_tr_b16 a[48:49], v17
v_fmac_f32 v125, v29, v26
MAA 220,104,172
buffer_load_dwordx4 a[160:163], v10, s[16:19], s52 offen sc1
MAA 220,108,188
TR 50,17,512
v_fmac_f32 v126, v30, v26
MAA 216,108,184
TR 52,17,8448
v_fmac_f32 v127, v31, v26
MAA 216,104,168
ds_read_b128 v[28:31], v9 offset:320
s_waitcnt lgkmcnt(15)
v_fmac_f32 v160, v4, v20
MAA 200,96,168
TR 54,17,8960
v_fmac_f32 v161, v5, v20
MAA 200,100,184
TR 56,17,32
v_fmac_f32 v162, v6, v20
MAA 204,100,188
buffer_load_dwordx4 a[164:167], v10, s[16:19], s52 offen offset:1024 sc1
MAA 204,96,172
TR 58,17,544
s_add_u32 s52, s52, 131072
MAA 156,88,172
TR 60,17,8480
v_fmac_f32 v163, v7, v20
MAA 156,92,188
TR 62,17,8992
v_fmac_f32 v164, v4, v22
MAA 152,92,184
v_fmac_f32 v165, v5, v22
v_fmac_f32 v166, v6, v22
MAA 152,88,168
v_fmac_f32 v167, v7, v22
v_fmac_f32 v168, v4, v24
MAA 136,80,168
buffer_load_dwordx4 a[176:179], v10, s[16:19], s52 offen sc1
MAA 136,84,184
v_fmac_f32 v169, v5, v24
v_fmac_f32 v170, v6, v24
MAA 140,84,188
v_fmac_f32 v171, v7, v24
v_fmac_f32 v172, v4, v26
MAA 140,80,172
v_fmac_f32 v173, v5, v26
v_fmac_f32 v174, v6, v26
MAA 92,72,172
v_fmac_f32 v175, v7, v26
s_waitcnt lgkmcnt(5)
v_fmac_f32 v176, v28, v20
MAA 92,76,188
ds_read_b128 v[4:7], v8 offset:64
v_fmac_f32 v177, v29, v20
MAA 88,76,184
buffer_load_dwordx4 a[180:183], v10, s[16:19], s52 offen offset:1024 sc1
MAA 88,72,168
s_add_u32 s52, s52, 131072
v_fmac_f32 v178, v30, v20
v_fmac_f32 v179, v31, v20
MAA 72,64,168
v_fmac_f32 v180, v28, v22
v_fmac_f32 v181, v29, v22
MAA 72,68,184
v_fmac_f32 v182, v30, v22
v_fmac_f32 v183, v31, v22
MAA 76,68,188
v_fmac_f32 v184, v28, v24
v_fmac_f32 v185, v29, v24
MAA 76,64,172
v_fmac_f32 v186, v30, v24
v_fmac_f32 v187, v31, v24
v_fmac_f32 v188, v28, v26
v_fmac_f32 v189, v29, v26
v_fmac_f32 v190, v30, v26
v_fmac_f32 v191, v31, v26
v_accvgpr_read_b32 v28, a192
s_waitcnt lgkmcnt(0)
v_fmac_f32 v232, v4, v20
v_fmac_f32 v233, v5, v20
v_fmac_f32 v234, v6, v20
v_fmac_f32 v235, v7, v20
v_fmac_f32 v236, v4, v22
v_fmac_f32 v237, v5, v22
v_fmac_f32 v238, v6, v22
v_fmac_f32 v239, v7, v22
v_accvgpr_read_b32 v29, a193
v_accvgpr_read_b32 v30, a194
v_accvgpr_read_b32 v31, a195
s_mov_b32 s15, -4
.p2align 6
.Lk65:
s_waitcnt vmcnt(18) lgkmcnt(0)
s_barrier
MAA 32,0,128
TR 64,16,16896
MAA 32,4,144
buffer_load_dwordx4 a[168:171], v11, s[16:19], s53 offen sc1
MAA 36,4,148
TR 66,16,17408
MAA 36,0,132
TR 68,16,25344
MAA 52,8,132
TR 70,16,25856
MAA 52,12,148
MAA 48,12,144
TR 72,16,16928
MAA 48,8,128
buffer_load_dwordx4 a[172:175], v11, s[16:19], s53 offen offset:1024 sc1
MAA 96,16,128
TR 74,16,17440
s_add_u32 s53, s53, 131072
MAA 96,20,144
TR 76,16,25376
MAA 100,20,148
MAA 100,16,132
TR 78,16,25888
MAA 116,24,132
TR 80,16,16960
MAA 116,28,148
buffer_load_dwordx4 a[184:187], v11, s[16:19], s53 offen sc1
MAA 112,28,144
TR 82,16,17472
MAA 112,24,128
MAA 160,32,128
TR 84,16,25408
MAA 160,36,144
TR 86,16,25920
MAA 164,36,148
TR 88,16,16992
MAA 164,32,132
buffer_load_dwordx4 a[188:191], v11, s[16:19], s53 offen offset:1024 sc1
MAA 180,40,132
s_add_u32 s53, s53, 131072
MAA 180,44,148
TR 90,16,17504
MAA 176,44,144
TR 92,16,25440
MAA 176,40,128
TR 94,16,25952
MAA 224,48,128
s_add_u32 m0, s55, 84480
MAA 224,52,144
buffer_load_dwordx4 v12, s[32:35], s54 offen lds
MAA 228,52,148
TR 96,16,17024
MAA 228,48,132
TR 98,16,17536
MAA 236,56,132
TR 100,16,25472
MAA 236,60,148
TR 102,16,25984
MAA 232,60,144
MAA 232,56,128
TR 104,16,17056
s_waitcnt vmcnt(19)
MAA 188,40,140
TR 106,16,17568
MAA 188,44,156
buffer_load_dwordx4 v13, s[32:35], s54 offen offset:1056 lds
MAA 184,44,152
TR 108,16,25504
MAA 184,40,136
MAA 168,32,136
TR 110,16,26016
MAA 168,36,152
buffer_load_dwordx4 v14, s[32:35], s54 offen offset:2112 lds
MAA 172,36,156
TR 112,17,16896
MAA 172,32,140
TR 114,17,17408
MAA 124,24,140
MAA 124,28,156
TR 116,17,25344
MAA 120,28,152
TR 118,17,25856
MAA 120,24,136
buffer_load_dwordx4 v15, s[32:35], s54 offen offset:3168 lds
MAA 104,16,136
TR 120,17,16928
MAA 104,20,152
MAA 108,20,156
TR 122,17,17440
MAA 108,16,140
TR 124,17,25376
MAA 60,8,140
TR 126,17,25888
s_mov_b32 m0, s67
MAA 60,12,156
buffer_load_dwordx4 v18, s[28:31], s58 offen lds
MAA 56,12,152
MAA 56,8,136
MAA 40,0,136
MAA 40,4,152
MAA 44,4,156
MAA 44,0,140
s_waitcnt vmcnt(19) lgkmcnt(0)
s_barrier
MAA 64,64,128
TR 0,16,33792
s_add_u32 m0, s55, 101376
MAA 64,68,144
buffer_load_dwordx4 v12, s[80:83], s54 offen lds
MAA 68,68,148
TR 2,16,34304
MAA 68,64,132
TR 4,16,42240
MAA 84,72,132
TR 6,16,42752
MAA 84,76,148
MAA 80,76,144
TR 8,16,33824
MAA 80,72,128
buffer_load_dwordx4 v13, s[80:83], s54 offen offset:1056 lds
MAA 128,80,128
TR 10,16,34336
MAA 128,84,144
TR 12,16,42272
MAA 132,84,148
TR 14,16,42784
MAA 132,80,132
MAA 148,88,132
TR 16,16,33856
MAA 148,92,148
buffer_load_dwordx4 v14, s[80:83], s54 offen offset:2112 lds
MAA 144,92,144
TR 18,16,34368
MAA 144,88,128
TR 20,16,42304
MAA 192,96,128
MAA 192,100,144
TR 22,16,42816
MAA 196,100,148
TR 24,16,33888
MAA 196,96,132
buffer_load_dwordx4 v15, s[80:83], s54 offen offset:3168 lds
MAA 212,104,132
TR 26,16,34400
s_add_u32 s54, s54, 458752
MAA 212,108,148
TR 28,16,42336
MAA 208,108,144
MAA 208,104,128
TR 30,16,42848
MAA 240,112,128
TR 32,16,33920
s_mov_b32 m0, s67
MAA 240,116,144
buffer_load_dwordx4 v19, s[28:31], s58 offen offset:1056 lds
MAA 244,116,148
s_add_u32 s67, s67, 8448
s_add_u32 s58, s58, 0x40000
MAA 244,112,132
TR 34,16,34432
MAA 252,120,132
MAA 252,124,148
.Lpad34:
s_cbranch_execz .Lnopoll60r
TR 36,16,42368
MAA 248,124,144
TR 38,16,42880
MAA 248,120,128
buffer_load_dwordx4 a[128:131], v10, s[16:19], s52 offen sc1
MAA 220,104,140
TR 40,16,33952
MAA 220,108,156
TR 42,16,34464
MAA 216,108,152
MAA 216,104,136
TR 44,16,42400
MAA 200,96,136
TR 46,16,42912
MAA 200,100,152
buffer_load_dwordx4 a[132:135], v10, s[16:19], s52 offen offset:1024 sc1
MAA 204,100,156
TR 48,17,33792
s_add_u32 s52, s52, 131072
MAA 204,96,140
MAA 156,88,140
TR 50,17,34304
MAA 156,92,156
TR 52,17,42240
MAA 152,92,152
TR 54,17,42752
MAA 152,88,136
buffer_load_dwordx4 a[144:147], v10, s[16:19], s52 offen sc1
MAA 136,80,136
TR 56,17,33824
MAA 136,84,152
MAA 140,84,156
TR 58,17,34336
MAA 140,80,140
TR 60,17,42272
MAA 92,72,140
TR 62,17,42784
MAA 92,76,156
buffer_load_dwordx4 a[148:151], v10, s[16:19], s52 offen offset:1024 sc1
MAA 88,76,152
s_add_u32 s52, s52, 131072
MAA 88,72,136
MAA 72,64,136
MAA 72,68,152
MAA 76,68,156
MAA 76,64,140
s_waitcnt vmcnt(18) lgkmcnt(0)
s_barrier
MAA 32,0,160
TR 64,16,50688
MAA 32,4,176
buffer_load_dwordx4 a[136:139], v11, s[16:19], s53 offen sc1
MAA 36,4,180
TR 66,16,51200
MAA 36,0,164
TR 68,16,59136
MAA 52,8,164
TR 70,16,59648
MAA 52,12,180
MAA 48,12,176
TR 72,16,50720
MAA 48,8,160
buffer_load_dwordx4 a[140:143], v11, s[16:19], s53 offen offset:1024 sc1
MAA 96,16,160
TR 74,16,51232
s_add_u32 s53, s53, 131072
MAA 96,20,176
TR 76,16,59168
MAA 100,20,180
MAA 100,16,164
TR 78,16,59680
MAA 116,24,164
TR 80,16,50752
MAA 116,28,180
buffer_load_dwordx4 a[152:155], v11, s[16:19], s53 offen sc1
MAA 112,28,176
TR 82,16,51264
MAA 112,24,160
MAA 160,32,160
TR 84,16,59200
MAA 160,36,176
TR 86,16,59712
MAA 164,36,180
TR 88,16,50784
MAA 164,32,164
buffer_load_dwordx4 a[156:159], v11, s[16:19], s53 offen offset:1024 sc1
MAA 180,40,164
s_add_u32 s53, s53, 131072
MAA 180,44,180
TR 90,16,51296
MAA 176,44,176
TR 92,16,59232
MAA 176,40,160
TR 94,16,59744
MAA 224,48,160
s_add_u32 m0, s55, 118272
MAA 224,52,176
buffer_load_dwordx4 v12, s[32:35], s54 offen lds
MAA 228,52,180
TR 96,16,50816
MAA 228,48,164
TR 98,16,51328
MAA 236,56,164
TR 100,16,59264
MAA 236,60,180
TR 102,16,59776
MAA 232,60,176
MAA 232,56,160
TR 104,16,50848
s_waitcnt vmcnt(19)
MAA 188,40,172
TR 106,16,51360
MAA 188,44,188
buffer_load_dwordx4 v13, s[32:35], s54 offen offset:1056 lds
MAA 184,44,184
TR 108,16,59296
MAA 184,40,168
MAA 168,32,168
TR 110,16,59808
MAA 168,36,184
buffer_load_dwordx4 v14, s[32:35], s54 offen offset:2112 lds
MAA 172,36,188
TR 112,17,50688
MAA 172,32,172
TR 114,17,51200
MAA 124,24,172
MAA 124,28,188
TR 116,17,59136
MAA 120,28,184
TR 118,17,59648
MAA 120,24,168
buffer_load_dwordx4 v15, s[32:35], s54 offen offset:3168 lds
MAA 104,16,168
TR 120,17,50720
MAA 104,20,184
MAA 108,20,188
TR 122,17,51232
MAA 108,16,172
TR 124,17,59168
MAA 60,8,172
TR 126,17,59680
s_mov_b32 m0, s67
MAA 60,12,188
buffer_load_dwordx4 v18, s[28:31], s58 offen lds
MAA 56,12,184
MAA 56,8,168
MAA 40,0,168
MAA 40,4,184
MAA 44,4,188
MAA 44,0,172
s_waitcnt vmcnt(19) lgkmcnt(0)
s_barrier
MAA 64,64,160
ds_read_b64_tr_b16 a[0:1], v16
s_add_u32 m0, s55, 135168
MAA 64,68,176
buffer_load_dwordx4 v12, s[80:83], s54 offen lds
MAA 68,68,180
TR 2,16,512
MAA 68,64,164
TR 4,16,8448
MAA 84,72,164
TR 6,16,8960
MAA 84,76,180
MAA 80,76,176
TR 8,16,32
MAA 80,72,160
buffer_load_dwordx4 v13, s[80:83], s54 offen offset:1056 lds
MAA 128,80,160
TR 10,16,544
MAA 128,84,176
TR 12,16,8480
MAA 132,84,180
TR 14,16,8992
MAA 132,80,164
MAA 148,88,164
TR 16,16,64
MAA 148,92,180
buffer_load_dwordx4 v14, s[80:83], s54 offen offset:2112 lds
MAA 144,92,176
TR 18,16,576
MAA 144,88,160
TR 20,16,8512
MAA 192,96,160
MAA 192,100,176
TR 22,16,9024
MAA 196,100,180
TR 24,16,96
MAA 196,96,164
buffer_load_dwordx4 v15, s[80:83], s54 offen offset:3168 lds
MAA 212,104,164
TR 26,16,608
s_add_u32 s54, s54, 458752
MAA 212,108,180
TR 28,16,8544
MAA 208,108,176
MAA 208,104,160
TR 30,16,9056
MAA 240,112,160
TR 32,16,128
s_mov_b32 m0, s67
MAA 240,116,176
buffer_load_dwordx4 v19, s[28:31], s58 offen offset:1056 lds
MAA 244,116,180
s_add_u32 s67, s67, 8448
s_add_u32 s46, s46, 1
s_xor_b32 s58, s46, s87
s_mul_i32 s58, s58, 458752
MAA 244,112,164
TR 34,16,640
MAA 252,120,164
MAA 252,124,180
TR 36,16,8576
MAA 248,124,176
TR 38,16,9088
MAA 248,120,160
buffer_load_dwordx4 a[160:163], v10, s[16:19], s52 offen sc1
MAA 220,104,172
TR 40,16,160
MAA 220,108,188
TR 42,16,672
MAA 216,108,184
MAA 216,104,168
TR 44,16,8608
MAA 200,96,168
TR 46,16,9120
MAA 200,100,184
buffer_load_dwordx4 a[164:167], v10, s[16:19], s52 offen offset:1024 sc1
MAA 204,100,188
ds_read_b64_tr_b16 a[48:49], v17
s_add_u32 s52, s52, 131072
MAA 204,96,172
MAA 156,88,172
TR 50,17,512
MAA 156,92,188
TR 52,17,8448
MAA 152,92,184
TR 54,17,8960
MAA 152,88,168
buffer_load_dwordx4 a[176:179], v10, s[16:19], s52 offen sc1
MAA 136,80,168
TR 56,17,32
MAA 136,84,184
MAA 140,84,188
TR 58,17,544
MAA 140,80,172
TR 60,17,8480
MAA 92,72,172
TR 62,17,8992
MAA 92,76,188
buffer_load_dwordx4 a[180:183], v10, s[16:19], s52 offen offset:1024 sc1
MAA 88,76,184
s_add_u32 s52, s52, 131072
MAA 88,72,168
MAA 72,64,168
MAA 72,68,184
MAA 76,68,188
s_add_u32 s15, s15, 1
MAA 76,64,172
s_cbranch_scc0 .Lk65
s_waitcnt vmcnt(10) lgkmcnt(0)
s_barrier
MAA 32,0,128
buffer_load_dwordx4 a[168:171], v11, s[16:19], s53 offen sc1
MAA 32,4,144
TR 64,16,16896
s_add_u32 s58, s99, 2293760
MAA 48,12,144
TR 66,16,17408
s_lshl_b32 s74, s3, 11
MAA 48,8,128
TR 68,16,25344
s_add_u32 s74, s74, s84
MAA 36,0,132
buffer_load_dwordx4 a[172:175], v11, s[16:19], s53 offen offset:1024 sc1
MAA 36,4,148
TR 70,16,25856
s_add_u32 s53, s53, 131072
MAA 52,12,148
TR 72,16,16928
v_lshl_add_u32 v4, v1, 4, s74
MAA 52,8,132
TR 74,16,17440
v_lshrrev_b32 v2, 3, v1
MAA 40,0,136
buffer_load_dwordx4 a[184:187], v11, s[16:19], s53 offen sc1
MAA 40,4,152
TR 76,16,25376
v_cmp_eq_u32 vcc, 3, v2
MAA 56,12,152
TR 78,16,25888
v_add_u32 v2, 67108480, v4
MAA 56,8,136
TR 80,16,33792
v_cndmask_b32 v4, v4, v2, vcc
MAA 44,0,140
buffer_load_dwordx4 a[188:191], v11, s[16:19], s53 offen offset:1024 sc1
MAA 44,4,156
TR 82,16,34304
s_add_u32 s53, s53, 131072
MAA 60,12,156
TR 84,16,42240
s_and_b32 s74, s7, 1
MAA 60,8,140
TR 86,16,42752
s_add_u32 s54, s98, 65536
MAA 96,16,128
TR 88,16,33824
v_bfe_u32 v7, v1, 2, 3
MAA 96,20,144
TR 90,16,34336
v_mul_u32_u24 v7, 1056, v7
MAA 112,28,144
TR 92,16,42272
s_waitcnt vmcnt(9)
s_barrier
MAA 112,24,128
TR 94,16,42784
v_bfe_u32 v2, v1, 5, 1
MAA 100,16,132
TR 96,16,50688
v_lshl_add_u32 v7, v2, 8, v7
MAA 100,20,148
TR 98,16,51200
v_and_b32 v2, 3, v1
MAA 116,28,148
TR 100,16,59136
v_lshl_add_u32 v7, v2, 3, v7
MAA 116,24,132
TR 102,16,59648
s_lshl_b32 s74, s74, 7
MAA 104,16,136
TR 104,16,50720
s_xor_b32 s75, s74, 128
MAA 104,20,152
TR 106,16,51232
v_add_u32 v6, s75, v7
MAA 120,28,152
TR 108,16,59168
v_add_u32 v7, s74, v7
MAA 120,24,136
TR 110,16,59680
s_mul_i32 s55, s3, 2112
MAA 108,16,140
TR 112,16,16960
s_mov_b32 s57, 67584
MAA 108,20,156
TR 114,16,17472
MAA 124,28,156
TR 116,16,25408
MAA 124,24,140
TR 118,16,25920
MAA 160,32,128
TR 120,16,16992
MAA 160,36,144
TR 122,16,17504
MAA 176,44,144
TR 124,16,25440
MAA 176,40,128
TR 126,16,25952
MAA 164,32,132
TR 192,16,33856
MAA 164,36,148
TR 194,16,34368
MAA 180,44,148
TR 196,16,42304
MAA 180,40,132
TR 198,16,42816
MAA 168,32,136
TR 200,16,33888
MAA 168,36,152
TR 202,16,34400
MAA 184,44,152
TR 204,16,42336
MAA 184,40,136
TR 206,16,42848
MAA 172,32,140
TR 208,16,50752
MAA 172,36,156
TR 210,16,51264
MAA 188,44,156
TR 212,16,59200
MAA 188,40,140
TR 214,16,59712
MAA 224,48,128
TR 216,16,50784
MAA 224,52,144
TR 218,16,51296
MAA 232,60,144
TR 220,16,59232
MAA 232,56,128
TR 222,16,59744
MAA 228,48,132
TR 0,16,17024
MAA 228,52,148
TR 2,16,17536
MAA 236,60,148
TR 4,16,25472
MAA 236,56,132
TR 6,16,25984
s_waitcnt lgkmcnt(15)
MAA 64,64,128
TR 8,16,17056
MAA 64,68,144
TR 10,16,17568
s_waitcnt vmcnt(7)
MAA 64,96,160
TR 12,16,25504
s_waitcnt vmcnt(5)
MAA 64,100,176
TR 14,16,26016
MAA 80,108,176
TR 16,16,33920
MAA 80,104,160
TR 18,16,34432
MAA 80,76,144
TR 20,16,42368
MAA 80,72,128
TR 22,16,42880
MAA 32,80,160
TR 24,16,33952
MAA 32,84,176
TR 26,16,34464
MAA 48,92,176
TR 28,16,42400
MAA 48,88,160
TR 30,16,42912
s_nop 2
v_pk_mul_f32 v[64:65], v[64:65], v[32:33]
TR 32,16,50816
TR 34,16,51328
v_pk_mul_f32 v[32:33], v[32:33], v[28:29] op_sel_hi:[1,0]
v_pk_mul_f32 v[66:67], v[66:67], v[34:35]
v_pk_mul_f32 v[34:35], v[34:35], v[28:29] op_sel_hi:[1,0]
v_exp_f32 v32, v32
v_pk_mul_f32 v[80:81], v[80:81], v[48:49]
v_pk_mul_f32 v[48:49], v[48:49], v[28:29] op_sel_hi:[1,0]
v_pk_mul_f32 v[82:83], v[82:83], v[50:51]
v_pk_mul_f32 v[50:51], v[50:51], v[28:29] op_sel_hi:[1,0]
v_exp_f32 v33, v33
v_exp_f32 v34, v34
MAA 68,64,132
TR 36,16,59264
v_exp_f32 v35, v35
MAA 68,68,148
TR 38,16,59776
v_exp_f32 v48, v48
MAA 68,96,164
TR 40,16,50848
v_exp_f32 v49, v49
s_waitcnt vmcnt(4)
MAA 68,100,180
TR 42,16,51360
v_exp_f32 v50, v50
MAA 84,108,180
TR 44,16,59296
v_exp_f32 v51, v51
MAA 84,104,164
TR 46,16,59808
MAA 84,76,148
TR 48,17,16896
MAA 84,72,132
TR 50,17,17408
MAA 36,80,164
TR 52,17,25344
MAA 36,84,180
TR 54,17,25856
MAA 52,92,180
TR 56,17,16928
MAA 52,88,164
TR 58,17,17440
s_nop 2
v_pk_mul_f32 v[68:69], v[68:69], v[36:37]
v_pk_fma_f32 v[32:33], v[32:33], v[20:21], v[20:21] op_sel:[0,1,1] op_sel_hi:[1,1,1]
v_pk_fma_f32 v[34:35], v[34:35], v[20:21], v[20:21] op_sel:[0,1,1] op_sel_hi:[1,1,1]
v_pk_mul_f32 v[36:37], v[36:37], v[28:29] op_sel:[0,1] op_sel_hi:[1,1]
v_pk_mul_f32 v[70:71], v[70:71], v[38:39]
v_pk_mul_f32 v[38:39], v[38:39], v[28:29] op_sel:[0,1] op_sel_hi:[1,1]
v_pk_fma_f32 v[48:49], v[48:49], v[20:21], v[20:21] op_sel:[0,1,1] op_sel_hi:[1,1,1]
v_pk_mul_f32 v[84:85], v[84:85], v[52:53]
v_pk_mul_f32 v[52:53], v[52:53], v[28:29] op_sel:[0,1] op_sel_hi:[1,1]
v_pk_mul_f32 v[86:87], v[86:87], v[54:55]
v_pk_mul_f32 v[54:55], v[54:55], v[28:29] op_sel:[0,1] op_sel_hi:[1,1]
v_pk_fma_f32 v[50:51], v[50:51], v[20:21], v[20:21] op_sel:[0,1,1] op_sel_hi:[1,1,1]
v_rcp_f32 v32, v32
v_rcp_f32 v33, v33
MAA 72,64,136
TR 60,17,25376
v_rcp_f32 v34, v34
MAA 72,68,152
TR 62,17,25888
v_rcp_f32 v35, v35
s_waitcnt vmcnt(3)
MAA 72,96,168
v_rcp_f32 v48, v48
s_waitcnt vmcnt(1)
MAA 72,100,184
v_rcp_f32 v49, v49
MAA 88,108,184
v_rcp_f32 v50, v50
MAA 88,104,168
v_rcp_f32 v51, v51
MAA 88,76,152
v_exp_f32 v36, v36
MAA 88,72,136
v_exp_f32 v37, v37
MAA 40,80,168
v_exp_f32 v38, v38
MAA 40,84,184
v_exp_f32 v39, v39
MAA 56,92,184
v_exp_f32 v52, v52
MAA 56,88,168
v_exp_f32 v53, v53
v_exp_f32 v54, v54
v_exp_f32 v55, v55
v_pk_mul_f32 v[64:65], v[64:65], v[32:33]
v_pk_mul_f32 v[66:67], v[66:67], v[34:35]
v_pk_mul_f32 v[80:81], v[80:81], v[48:49]
v_pk_mul_f32 v[82:83], v[82:83], v[50:51]
v_pk_mul_f32 v[72:73], v[72:73], v[40:41]
v_pk_mul_f32 v[40:41], v[40:41], v[30:31] op_sel_hi:[1,0]
v_pk_mul_f32 v[74:75], v[74:75], v[42:43]
v_pk_mul_f32 v[42:43], v[42:43], v[30:31] op_sel_hi:[1,0]
v_pk_mul_f32 v[88:89], v[88:89], v[56:57]
v_pk_mul_f32 v[56:57], v[56:57], v[30:31] op_sel_hi:[1,0]
v_pk_mul_f32 v[90:91], v[90:91], v[58:59]
v_pk_mul_f32 v[58:59], v[58:59], v[30:31] op_sel_hi:[1,0]
v_pk_fma_f32 v[36:37], v[36:37], v[22:23], v[22:23] op_sel:[0,1,1] op_sel_hi:[1,1,1]
v_pk_fma_f32 v[38:39], v[38:39], v[22:23], v[22:23] op_sel:[0,1,1] op_sel_hi:[1,1,1]
v_pk_fma_f32 v[52:53], v[52:53], v[22:23], v[22:23] op_sel:[0,1,1] op_sel_hi:[1,1,1]
v_pk_fma_f32 v[54:55], v[54:55], v[22:23], v[22:23] op_sel:[0,1,1] op_sel_hi:[1,1,1]
v_cvt_pk_bf16_f32 v32, v64, v65
v_cvt_pk_bf16_f32 v33, v66, v67
v_cvt_pk_bf16_f32 v34, v80, v81
v_cvt_pk_bf16_f32 v35, v82, v83
MAA 76,64,140
buffer_store_dwordx4 v[32:35], v10, s[16:19], s62 offen sc1
MAA 76,68,156
TR 64,17,33792
.Lpad35:
s_cbranch_execz .Lpad38
v_rcp_f32 v36, v36
MAA 76,96,172
TR 66,17,34304
v_rcp_f32 v37, v37
s_waitcnt vmcnt(1)
MAA 76,100,188
TR 68,17,42240
v_rcp_f32 v38, v38
MAA 92,108,188
TR 70,17,42752
v_rcp_f32 v39, v39
MAA 92,104,172
v_rcp_f32 v52, v52
MAA 92,76,156
TR 76,17,42272
v_rcp_f32 v53, v53
MAA 92,72,140
TR 72,17,33824
v_rcp_f32 v54, v54
MAA 44,80,172
TR 74,17,34336
v_rcp_f32 v55, v55
MAA 44,84,188
TR 78,17,42784
v_exp_f32 v40, v40
MAA 60,92,188
TR 80,17,50688
v_exp_f32 v41, v41
MAA 60,88,172
TR 82,17,51200
v_exp_f32 v42, v42
v_exp_f32 v43, v43
v_exp_f32 v56, v56
v_exp_f32 v57, v57
v_exp_f32 v58, v58
v_exp_f32 v59, v59
v_pk_mul_f32 v[68:69], v[68:69], v[36:37]
v_pk_mul_f32 v[70:71], v[70:71], v[38:39]
v_pk_mul_f32 v[84:85], v[84:85], v[52:53]
v_pk_mul_f32 v[86:87], v[86:87], v[54:55]
v_pk_mul_f32 v[76:77], v[76:77], v[44:45]
v_pk_mul_f32 v[44:45], v[44:45], v[30:31] op_sel:[0,1] op_sel_hi:[1,1]
v_pk_mul_f32 v[78:79], v[78:79], v[46:47]
v_pk_mul_f32 v[46:47], v[46:47], v[30:31] op_sel:[0,1] op_sel_hi:[1,1]
v_pk_mul_f32 v[92:93], v[92:93], v[60:61]
v_pk_mul_f32 v[60:61], v[60:61], v[30:31] op_sel:[0,1] op_sel_hi:[1,1]
v_pk_mul_f32 v[94:95], v[94:95], v[62:63]
v_pk_mul_f32 v[62:63], v[62:63], v[30:31] op_sel:[0,1] op_sel_hi:[1,1]
v_pk_fma_f32 v[40:41], v[40:41], v[24:25], v[24:25] op_sel:[0,1,1] op_sel_hi:[1,1,1]
v_pk_fma_f32 v[42:43], v[42:43], v[24:25], v[24:25] op_sel:[0,1,1] op_sel_hi:[1,1,1]
v_pk_fma_f32 v[56:57], v[56:57], v[24:25], v[24:25] op_sel:[0,1,1] op_sel_hi:[1,1,1]
v_pk_fma_f32 v[58:59], v[58:59], v[24:25], v[24:25] op_sel:[0,1,1] op_sel_hi:[1,1,1]
v_cvt_pk_bf16_f32 v36, v68, v69
v_cvt_pk_bf16_f32 v37, v70, v71
v_cvt_pk_bf16_f32 v38, v84, v85
v_cvt_pk_bf16_f32 v39, v86, v87
MAA 128,112,128
buffer_store_dwordx4 v[36:39], v10, s[16:19], s62 offen offset:1024 sc1
MAA 128,116,144
TR 84,17,59136
v_rcp_f32 v40, v40
s_waitcnt lgkmcnt(15)
MAA 128,208,160
TR 86,17,59648
v_rcp_f32 v41, v41
MAA 128,212,176
TR 88,17,50720
v_rcp_f32 v42, v42
MAA 144,220,176
TR 90,17,51232
v_rcp_f32 v43, v43
MAA 144,216,160
TR 92,17,59168
v_rcp_f32 v56, v56
MAA 144,124,144
TR 94,17,59680
v_rcp_f32 v57, v57
MAA 144,120,128
v_rcp_f32 v58, v58
MAA 96,192,160
v_rcp_f32 v59, v59
MAA 96,196,176
v_exp_f32 v44, v44
MAA 112,204,176
v_exp_f32 v45, v45
MAA 112,200,160
v_lshrrev_b32 v69, 2, v0
v_min_u32 v69, 1, v69
v_lshlrev_b32 v69, 28, v69
v_lshl_add_u32 v68, v0, 7, v69
v_xor_b32 v69, 64, v0
v_min_u32 v69, 1, v69
v_lshlrev_b32 v70, 4, v69
v_sub_u32 v70, 16, v70
v_lshlrev_b32 v69, 28, v69
v_mov_b32 v71, 1
s_waitcnt lgkmcnt(0)
s_barrier
v_mov_b32 v84, 0
v_mov_b32 v85, 0
v_mov_b32 v86, 0
v_exp_f32 v46, v46
v_exp_f32 v47, v47
v_exp_f32 v60, v60
v_exp_f32 v61, v61
v_exp_f32 v62, v62
v_exp_f32 v63, v63
v_pk_mul_f32 v[72:73], v[72:73], v[40:41]
v_pk_mul_f32 v[74:75], v[74:75], v[42:43]
v_pk_mul_f32 v[88:89], v[88:89], v[56:57]
v_pk_mul_f32 v[90:91], v[90:91], v[58:59]
v_pk_mul_f32 v[128:129], v[128:129], v[96:97]
v_pk_mul_f32 v[96:97], v[96:97], v[28:29] op_sel_hi:[1,0]
v_pk_mul_f32 v[130:131], v[130:131], v[98:99]
v_pk_mul_f32 v[98:99], v[98:99], v[28:29] op_sel_hi:[1,0]
v_pk_mul_f32 v[144:145], v[144:145], v[112:113]
v_pk_mul_f32 v[112:113], v[112:113], v[28:29] op_sel_hi:[1,0]
v_pk_mul_f32 v[146:147], v[146:147], v[114:115]
v_pk_mul_f32 v[114:115], v[114:115], v[28:29] op_sel_hi:[1,0]
v_pk_fma_f32 v[44:45], v[44:45], v[26:27], v[26:27] op_sel:[0,1,1] op_sel_hi:[1,1,1]
v_pk_fma_f32 v[46:47], v[46:47], v[26:27], v[26:27] op_sel:[0,1,1] op_sel_hi:[1,1,1]
v_pk_fma_f32 v[60:61], v[60:61], v[26:27], v[26:27] op_sel:[0,1,1] op_sel_hi:[1,1,1]
v_pk_fma_f32 v[62:63], v[62:63], v[26:27], v[26:27] op_sel:[0,1,1] op_sel_hi:[1,1,1]
v_cvt_pk_bf16_f32 v40, v72, v73
v_cvt_pk_bf16_f32 v41, v74, v75
v_cvt_pk_bf16_f32 v42, v88, v89
v_cvt_pk_bf16_f32 v43, v90, v91
MAA 132,112,132
buffer_store_dwordx4 v[40:43], v11, s[16:19], s62 offen sc1
MAA 132,116,148
s_add_u32 m0, s59, 84480
v_rcp_f32 v44, v44
MAA 132,208,164
v_rcp_f32 v45, v45
MAA 132,212,180
v_rcp_f32 v46, v46
MAA 148,220,180
buffer_load_dwordx4 v18, s[28:31], s58 offen lds
MAA 148,216,164
v_rcp_f32 v47, v47
MAA 148,124,148
v_rcp_f32 v60, v60
MAA 148,120,132
v_rcp_f32 v61, v61
MAA 100,192,164
buffer_load_dwordx4 v19, s[28:31], s58 offen offset:1056 lds
MAA 100,196,180
s_add_u32 m0, s59, 92928
s_add_u32 s58, s99, 2555904
v_rcp_f32 v62, v62
MAA 116,204,180
v_rcp_f32 v63, v63
MAA 116,200,164
v_exp_f32 v96, v96
v_exp_f32 v97, v97
v_exp_f32 v98, v98
v_exp_f32 v99, v99
v_exp_f32 v112, v112
v_exp_f32 v113, v113
v_exp_f32 v114, v114
v_exp_f32 v115, v115
v_pk_mul_f32 v[76:77], v[76:77], v[44:45]
v_pk_mul_f32 v[78:79], v[78:79], v[46:47]
v_pk_mul_f32 v[92:93], v[92:93], v[60:61]
v_pk_mul_f32 v[94:95], v[94:95], v[62:63]
v_pk_mul_f32 v[132:133], v[132:133], v[100:101]
v_pk_mul_f32 v[100:101], v[100:101], v[28:29] op_sel:[0,1] op_sel_hi:[1,1]
v_pk_mul_f32 v[134:135], v[134:135], v[102:103]
v_pk_mul_f32 v[102:103], v[102:103], v[28:29] op_sel:[0,1] op_sel_hi:[1,1]
v_pk_mul_f32 v[148:149], v[148:149], v[116:117]
v_pk_mul_f32 v[116:117], v[116:117], v[28:29] op_sel:[0,1] op_sel_hi:[1,1]
v_pk_mul_f32 v[150:151], v[150:151], v[118:119]
v_pk_mul_f32 v[118:119], v[118:119], v[28:29] op_sel:[0,1] op_sel_hi:[1,1]
v_pk_fma_f32 v[96:97], v[96:97], v[20:21], v[20:21] op_sel:[0,1,1] op_sel_hi:[1,1,1]
v_pk_fma_f32 v[98:99], v[98:99], v[20:21], v[20:21] op_sel:[0,1,1] op_sel_hi:[1,1,1]
v_pk_fma_f32 v[112:113], v[112:113], v[20:21], v[20:21] op_sel:[0,1,1] op_sel_hi:[1,1,1]
v_pk_fma_f32 v[114:115], v[114:115], v[20:21], v[20:21] op_sel:[0,1,1] op_sel_hi:[1,1,1]
v_cvt_pk_bf16_f32 v44, v76, v77
v_cvt_pk_bf16_f32 v45, v78, v79
v_cvt_pk_bf16_f32 v46, v92, v93
v_cvt_pk_bf16_f32 v47, v94, v95
MAA 136,112,136
buffer_store_dwordx4 v[44:47], v11, s[16:19], s62 offen offset:1024 sc1
MAA 136,116,152
v_rcp_f32 v96, v96
MAA 136,208,168
v_rcp_f32 v97, v97
MAA 136,212,184
v_rcp_f32 v98, v98
MAA 152,220,184
buffer_load_dwordx4 v18, s[28:31], s58 offen lds
MAA 152,216,168
v_rcp_f32 v99, v99
MAA 152,124,152
v_rcp_f32 v112, v112
MAA 152,120,136
v_rcp_f32 v113, v113
MAA 104,192,168
buffer_load_dwordx4 v19, s[28:31], s58 offen offset:1056 lds
MAA 104,196,184
s_add_u32 m0, s59, 101376
s_add_u32 s58, s100, 2752512
v_rcp_f32 v114, v114
MAA 120,204,184
v_rcp_f32 v115, v115
MAA 120,200,168
v_exp_f32 v100, v100
v_exp_f32 v101, v101
v_exp_f32 v102, v102
v_exp_f32 v103, v103
v_exp_f32 v116, v116
v_exp_f32 v117, v117
v_exp_f32 v118, v118
v_exp_f32 v119, v119
v_pk_mul_f32 v[128:129], v[128:129], v[96:97]
v_pk_mul_f32 v[130:131], v[130:131], v[98:99]
v_pk_mul_f32 v[144:145], v[144:145], v[112:113]
v_pk_mul_f32 v[146:147], v[146:147], v[114:115]
v_pk_mul_f32 v[136:137], v[136:137], v[104:105]
v_pk_mul_f32 v[104:105], v[104:105], v[30:31] op_sel_hi:[1,0]
v_pk_mul_f32 v[138:139], v[138:139], v[106:107]
v_pk_mul_f32 v[106:107], v[106:107], v[30:31] op_sel_hi:[1,0]
v_pk_mul_f32 v[152:153], v[152:153], v[120:121]
v_pk_mul_f32 v[120:121], v[120:121], v[30:31] op_sel_hi:[1,0]
v_pk_mul_f32 v[154:155], v[154:155], v[122:123]
v_pk_mul_f32 v[122:123], v[122:123], v[30:31] op_sel_hi:[1,0]
v_pk_fma_f32 v[100:101], v[100:101], v[22:23], v[22:23] op_sel:[0,1,1] op_sel_hi:[1,1,1]
v_pk_fma_f32 v[102:103], v[102:103], v[22:23], v[22:23] op_sel:[0,1,1] op_sel_hi:[1,1,1]
v_pk_fma_f32 v[116:117], v[116:117], v[22:23], v[22:23] op_sel:[0,1,1] op_sel_hi:[1,1,1]
v_pk_fma_f32 v[118:119], v[118:119], v[22:23], v[22:23] op_sel:[0,1,1] op_sel_hi:[1,1,1]
v_cvt_pk_bf16_f32 v96, v128, v129
v_cvt_pk_bf16_f32 v97, v130, v131
v_cvt_pk_bf16_f32 v98, v144, v145
v_cvt_pk_bf16_f32 v99, v146, v147
MAA 140,112,140
buffer_store_dwordx4 v[96:99], v10, s[16:19], s63 offen sc1
MAA 140,116,156
v_rcp_f32 v100, v100
MAA 140,208,172
v_rcp_f32 v101, v101
MAA 140,212,188
v_rcp_f32 v102, v102
MAA 156,220,188
buffer_load_dwordx4 v18, s[28:31], s58 offen lds
MAA 156,216,172
v_rcp_f32 v103, v103
MAA 156,124,156
v_rcp_f32 v116, v116
MAA 156,120,140
v_rcp_f32 v117, v117
MAA 108,192,172
buffer_load_dwordx4 v19, s[28:31], s58 offen offset:1056 lds
MAA 108,196,188
s_add_u32 m0, s59, 109824
s_add_u32 s58, s100, 3014656
v_rcp_f32 v118, v118
MAA 124,204,188
v_rcp_f32 v119, v119
MAA 124,200,172
v_exp_f32 v104, v104
v_exp_f32 v105, v105
v_exp_f32 v106, v106
v_exp_f32 v107, v107
v_exp_f32 v120, v120
v_exp_f32 v121, v121
v_exp_f32 v122, v122
v_exp_f32 v123, v123
v_pk_mul_f32 v[132:133], v[132:133], v[100:101]
v_pk_mul_f32 v[134:135], v[134:135], v[102:103]
v_pk_mul_f32 v[148:149], v[148:149], v[116:117]
v_pk_mul_f32 v[150:151], v[150:151], v[118:119]
v_pk_mul_f32 v[140:141], v[140:141], v[108:109]
v_pk_mul_f32 v[108:109], v[108:109], v[30:31] op_sel:[0,1] op_sel_hi:[1,1]
v_pk_mul_f32 v[142:143], v[142:143], v[110:111]
v_pk_mul_f32 v[110:111], v[110:111], v[30:31] op_sel:[0,1] op_sel_hi:[1,1]
v_pk_mul_f32 v[156:157], v[156:157], v[124:125]
v_pk_mul_f32 v[124:125], v[124:125], v[30:31] op_sel:[0,1] op_sel_hi:[1,1]
v_pk_mul_f32 v[158:159], v[158:159], v[126:127]
v_pk_mul_f32 v[126:127], v[126:127], v[30:31] op_sel:[0,1] op_sel_hi:[1,1]
v_pk_fma_f32 v[104:105], v[104:105], v[24:25], v[24:25] op_sel:[0,1,1] op_sel_hi:[1,1,1]
v_pk_fma_f32 v[106:107], v[106:107], v[24:25], v[24:25] op_sel:[0,1,1] op_sel_hi:[1,1,1]
v_pk_fma_f32 v[120:121], v[120:121], v[24:25], v[24:25] op_sel:[0,1,1] op_sel_hi:[1,1,1]
v_pk_fma_f32 v[122:123], v[122:123], v[24:25], v[24:25] op_sel:[0,1,1] op_sel_hi:[1,1,1]
v_cvt_pk_bf16_f32 v100, v132, v133
v_cvt_pk_bf16_f32 v101, v134, v135
v_cvt_pk_bf16_f32 v102, v148, v149
v_cvt_pk_bf16_f32 v103, v150, v151
MAA 192,0,128
buffer_store_dwordx4 v[100:103], v10, s[16:19], s63 offen offset:1024 sc1
MAA 192,4,144
v_rcp_f32 v104, v104
MAA 192,32,160
s_waitcnt vmcnt(6)
s_barrier
v_rcp_f32 v105, v105
MAA 192,36,176
v_rcp_f32 v106, v106
MAA 208,44,176
buffer_atomic_add v71, v68, s[16:19], s72 offen offset:512
MAA 208,40,160
v_rcp_f32 v107, v107
MAA 208,12,144
v_rcp_f32 v120, v120
MAA 208,8,128
v_rcp_f32 v121, v121
MAA 160,16,160
buffer_load_dwordx4 v18, s[28:31], s58 offen lds
MAA 160,20,176
v_rcp_f32 v122, v122
MAA 176,28,176
v_rcp_f32 v123, v123
MAA 176,24,160
v_exp_f32 v108, v108
v_exp_f32 v109, v109
v_exp_f32 v110, v110
v_exp_f32 v111, v111
v_exp_f32 v124, v124
v_exp_f32 v125, v125
v_exp_f32 v126, v126
v_exp_f32 v127, v127
v_pk_mul_f32 v[136:137], v[136:137], v[104:105]
v_pk_mul_f32 v[138:139], v[138:139], v[106:107]
v_pk_mul_f32 v[152:153], v[152:153], v[120:121]
v_pk_mul_f32 v[154:155], v[154:155], v[122:123]
v_pk_mul_f32 v[192:193], v[192:193], v[160:161]
v_pk_mul_f32 v[160:161], v[160:161], v[28:29] op_sel_hi:[1,0]
v_pk_mul_f32 v[194:195], v[194:195], v[162:163]
v_pk_mul_f32 v[162:163], v[162:163], v[28:29] op_sel_hi:[1,0]
v_pk_mul_f32 v[208:209], v[208:209], v[176:177]
v_pk_mul_f32 v[176:177], v[176:177], v[28:29] op_sel_hi:[1,0]
v_pk_mul_f32 v[210:211], v[210:211], v[178:179]
v_pk_mul_f32 v[178:179], v[178:179], v[28:29] op_sel_hi:[1,0]
v_pk_fma_f32 v[108:109], v[108:109], v[26:27], v[26:27] op_sel:[0,1,1] op_sel_hi:[1,1,1]
v_pk_fma_f32 v[110:111], v[110:111], v[26:27], v[26:27] op_sel:[0,1,1] op_sel_hi:[1,1,1]
v_pk_fma_f32 v[124:125], v[124:125], v[26:27], v[26:27] op_sel:[0,1,1] op_sel_hi:[1,1,1]
v_pk_fma_f32 v[126:127], v[126:127], v[26:27], v[26:27] op_sel:[0,1,1] op_sel_hi:[1,1,1]
v_cvt_pk_bf16_f32 v104, v136, v137
v_cvt_pk_bf16_f32 v105, v138, v139
v_cvt_pk_bf16_f32 v106, v152, v153
v_cvt_pk_bf16_f32 v107, v154, v155
MAA 196,0,132
buffer_store_dwordx4 v[104:107], v11, s[16:19], s63 offen sc1
MAA 196,4,148
v_rcp_f32 v108, v108
MAA 196,32,164
v_rcp_f32 v109, v109
MAA 196,36,180
v_rcp_f32 v110, v110
MAA 212,44,180
buffer_load_dwordx4 v19, s[28:31], s58 offen offset:1056 lds
MAA 212,40,164
s_add_u32 m0, s59, 118272
s_add_u32 s58, s101, 3211264
v_rcp_f32 v111, v111
MAA 212,12,148
v_rcp_f32 v124, v124
MAA 212,8,132
v_rcp_f32 v125, v125
MAA 164,16,164
buffer_load_dwordx4 v18, s[28:31], s58 offen lds
MAA 164,20,180
v_rcp_f32 v126, v126
MAA 180,28,180
v_rcp_f32 v127, v127
MAA 180,24,164
v_exp_f32 v160, v160
v_exp_f32 v161, v161
v_exp_f32 v162, v162
v_exp_f32 v163, v163
v_exp_f32 v176, v176
v_exp_f32 v177, v177
v_exp_f32 v178, v178
v_exp_f32 v179, v179
v_pk_mul_f32 v[140:141], v[140:141], v[108:109]
v_pk_mul_f32 v[142:143], v[142:143], v[110:111]
v_pk_mul_f32 v[156:157], v[156:157], v[124:125]
v_pk_mul_f32 v[158:159], v[158:159], v[126:127]
v_pk_mul_f32 v[196:197], v[196:197], v[164:165]
v_pk_mul_f32 v[164:165], v[164:165], v[28:29] op_sel:[0,1] op_sel_hi:[1,1]
v_pk_mul_f32 v[198:199], v[198:199], v[166:167]
v_pk_mul_f32 v[166:167], v[166:167], v[28:29] op_sel:[0,1] op_sel_hi:[1,1]
v_pk_mul_f32 v[212:213], v[212:213], v[180:181]
v_pk_mul_f32 v[180:181], v[180:181], v[28:29] op_sel:[0,1] op_sel_hi:[1,1]
v_pk_mul_f32 v[214:215], v[214:215], v[182:183]
v_pk_mul_f32 v[182:183], v[182:183], v[28:29] op_sel:[0,1] op_sel_hi:[1,1]
v_pk_fma_f32 v[160:161], v[160:161], v[20:21], v[20:21] op_sel:[0,1,1] op_sel_hi:[1,1,1]
v_pk_fma_f32 v[162:163], v[162:163], v[20:21], v[20:21] op_sel:[0,1,1] op_sel_hi:[1,1,1]
v_pk_fma_f32 v[176:177], v[176:177], v[20:21], v[20:21] op_sel:[0,1,1] op_sel_hi:[1,1,1]
v_pk_fma_f32 v[178:179], v[178:179], v[20:21], v[20:21] op_sel:[0,1,1] op_sel_hi:[1,1,1]
v_cvt_pk_bf16_f32 v108, v140, v141
v_cvt_pk_bf16_f32 v109, v142, v143
v_cvt_pk_bf16_f32 v110, v156, v157
v_cvt_pk_bf16_f32 v111, v158, v159
MAA 200,0,136
buffer_store_dwordx4 v[108:111], v11, s[16:19], s63 offen offset:1024 sc1
MAA 200,4,152
v_rcp_f32 v160, v160
MAA 200,32,168
v_rcp_f32 v161, v161
MAA 200,36,184
v_rcp_f32 v162, v162
MAA 216,44,184
buffer_load_dwordx4 v19, s[28:31], s58 offen offset:1056 lds
MAA 216,40,168
s_add_u32 m0, s59, 126720
s_add_u32 s58, s101, 3473408
v_rcp_f32 v163, v163
MAA 216,12,152
v_rcp_f32 v176, v176
MAA 216,8,136
v_rcp_f32 v177, v177
MAA 168,16,168
buffer_load_dwordx4 v18, s[28:31], s58 offen lds
MAA 168,20,184
v_rcp_f32 v178, v178
MAA 184,28,184
v_rcp_f32 v179, v179
MAA 184,24,168
v_exp_f32 v164, v164
v_exp_f32 v165, v165
v_exp_f32 v166, v166
v_exp_f32 v167, v167
v_exp_f32 v180, v180
v_exp_f32 v181, v181
v_exp_f32 v182, v182
v_exp_f32 v183, v183
v_pk_mul_f32 v[192:193], v[192:193], v[160:161]
v_pk_mul_f32 v[194:195], v[194:195], v[162:163]
v_pk_mul_f32 v[208:209], v[208:209], v[176:177]
v_pk_mul_f32 v[210:211], v[210:211], v[178:179]
v_pk_mul_f32 v[200:201], v[200:201], v[168:169]
v_pk_mul_f32 v[168:169], v[168:169], v[30:31] op_sel_hi:[1,0]
v_pk_mul_f32 v[202:203], v[202:203], v[170:171]
v_pk_mul_f32 v[170:171], v[170:171], v[30:31] op_sel_hi:[1,0]
v_pk_mul_f32 v[216:217], v[216:217], v[184:185]
v_pk_mul_f32 v[184:185], v[184:185], v[30:31] op_sel_hi:[1,0]
v_pk_mul_f32 v[218:219], v[218:219], v[186:187]
v_pk_mul_f32 v[186:187], v[186:187], v[30:31] op_sel_hi:[1,0]
v_pk_fma_f32 v[164:165], v[164:165], v[22:23], v[22:23] op_sel:[0,1,1] op_sel_hi:[1,1,1]
v_pk_fma_f32 v[166:167], v[166:167], v[22:23], v[22:23] op_sel:[0,1,1] op_sel_hi:[1,1,1]
v_pk_fma_f32 v[180:181], v[180:181], v[22:23], v[22:23] op_sel:[0,1,1] op_sel_hi:[1,1,1]
v_pk_fma_f32 v[182:183], v[182:183], v[22:23], v[22:23] op_sel:[0,1,1] op_sel_hi:[1,1,1]
v_cvt_pk_bf16_f32 v160, v192, v193
v_cvt_pk_bf16_f32 v161, v194, v195
v_cvt_pk_bf16_f32 v162, v208, v209
v_cvt_pk_bf16_f32 v163, v210, v211
MAA 204,0,140
buffer_store_dwordx4 v[160:163], v10, s[16:19], s64 offen sc1
MAA 204,4,156
v_rcp_f32 v164, v164
MAA 204,32,172
v_rcp_f32 v165, v165
MAA 204,36,188
v_rcp_f32 v166, v166
MAA 220,44,188
buffer_atomic_add v84, v69, s[16:19], s73 offen offset:512 sc0
MAA 220,40,172
v_rcp_f32 v167, v167
MAA 220,12,156
v_rcp_f32 v180, v180
MAA 220,8,140
v_rcp_f32 v181, v181
MAA 172,16,172
buffer_load_dwordx4 v19, s[28:31], s58 offen offset:1056 lds
MAA 172,20,188
v_rcp_f32 v182, v182
MAA 188,28,188
v_rcp_f32 v183, v183
MAA 188,24,172
v_exp_f32 v168, v168
v_exp_f32 v169, v169
v_exp_f32 v170, v170
v_exp_f32 v171, v171
v_exp_f32 v184, v184
v_exp_f32 v185, v185
v_exp_f32 v186, v186
v_exp_f32 v187, v187
v_pk_mul_f32 v[196:197], v[196:197], v[164:165]
v_pk_mul_f32 v[198:199], v[198:199], v[166:167]
v_pk_mul_f32 v[212:213], v[212:213], v[180:181]
v_pk_mul_f32 v[214:215], v[214:215], v[182:183]
v_pk_mul_f32 v[204:205], v[204:205], v[172:173]
v_pk_mul_f32 v[172:173], v[172:173], v[30:31] op_sel:[0,1] op_sel_hi:[1,1]
v_pk_mul_f32 v[206:207], v[206:207], v[174:175]
v_pk_mul_f32 v[174:175], v[174:175], v[30:31] op_sel:[0,1] op_sel_hi:[1,1]
v_pk_mul_f32 v[220:221], v[220:221], v[188:189]
v_pk_mul_f32 v[188:189], v[188:189], v[30:31] op_sel:[0,1] op_sel_hi:[1,1]
v_pk_mul_f32 v[222:223], v[222:223], v[190:191]
v_pk_mul_f32 v[190:191], v[190:191], v[30:31] op_sel:[0,1] op_sel_hi:[1,1]
v_pk_fma_f32 v[168:169], v[168:169], v[24:25], v[24:25] op_sel:[0,1,1] op_sel_hi:[1,1,1]
v_pk_fma_f32 v[170:171], v[170:171], v[24:25], v[24:25] op_sel:[0,1,1] op_sel_hi:[1,1,1]
v_pk_fma_f32 v[184:185], v[184:185], v[24:25], v[24:25] op_sel:[0,1,1] op_sel_hi:[1,1,1]
v_pk_fma_f32 v[186:187], v[186:187], v[24:25], v[24:25] op_sel:[0,1,1] op_sel_hi:[1,1,1]
v_cvt_pk_bf16_f32 v164, v196, v197
v_cvt_pk_bf16_f32 v165, v198, v199
v_cvt_pk_bf16_f32 v166, v212, v213
v_cvt_pk_bf16_f32 v167, v214, v215
MAA 240,48,128
buffer_store_dwordx4 v[164:167], v10, s[16:19], s64 offen offset:1024 sc1
MAA 240,52,144
v_rcp_f32 v168, v168
MAA 240,80,160
v_rcp_f32 v169, v169
MAA 240,84,176
v_rcp_f32 v170, v170
MAA 248,92,176
buffer_atomic_add v85, v69, s[16:19], s73 offen offset:512 sc0
MAA 248,88,160
v_rcp_f32 v171, v171
MAA 248,60,144
v_rcp_f32 v184, v184
MAA 248,56,128
v_rcp_f32 v185, v185
MAA 224,64,160
v_rcp_f32 v186, v186
MAA 224,68,176
v_rcp_f32 v187, v187
MAA 232,76,176
v_exp_f32 v172, v172
MAA 232,72,160
v_exp_f32 v173, v173
v_exp_f32 v174, v174
v_exp_f32 v175, v175
v_exp_f32 v188, v188
v_exp_f32 v189, v189
v_exp_f32 v190, v190
v_exp_f32 v191, v191
v_pk_mul_f32 v[200:201], v[200:201], v[168:169]
v_pk_mul_f32 v[202:203], v[202:203], v[170:171]
v_pk_mul_f32 v[216:217], v[216:217], v[184:185]
v_pk_mul_f32 v[218:219], v[218:219], v[186:187]
v_pk_mul_f32 v[240:241], v[240:241], v[224:225]
v_pk_mul_f32 v[224:225], v[224:225], v[28:29] op_sel_hi:[1,0]
v_pk_mul_f32 v[242:243], v[242:243], v[226:227]
v_pk_mul_f32 v[226:227], v[226:227], v[28:29] op_sel_hi:[1,0]
v_pk_mul_f32 v[248:249], v[248:249], v[232:233]
v_pk_mul_f32 v[232:233], v[232:233], v[28:29] op_sel_hi:[1,0]
v_pk_mul_f32 v[250:251], v[250:251], v[234:235]
v_pk_mul_f32 v[234:235], v[234:235], v[28:29] op_sel_hi:[1,0]
v_pk_fma_f32 v[172:173], v[172:173], v[26:27], v[26:27] op_sel:[0,1,1] op_sel_hi:[1,1,1]
v_pk_fma_f32 v[174:175], v[174:175], v[26:27], v[26:27] op_sel:[0,1,1] op_sel_hi:[1,1,1]
v_pk_fma_f32 v[188:189], v[188:189], v[26:27], v[26:27] op_sel:[0,1,1] op_sel_hi:[1,1,1]
v_pk_fma_f32 v[190:191], v[190:191], v[26:27], v[26:27] op_sel:[0,1,1] op_sel_hi:[1,1,1]
v_cvt_pk_bf16_f32 v168, v200, v201
v_cvt_pk_bf16_f32 v169, v202, v203
v_cvt_pk_bf16_f32 v170, v216, v217
v_cvt_pk_bf16_f32 v171, v218, v219
buffer_store_dwordx4 v[168:171], v11, s[16:19], s64 offen sc1
buffer_atomic_add v86, v69, s[16:19], s73 offen offset:512 sc0
s_waitcnt vmcnt(5)
v_cmp_gt_u32 vcc, v70, v84
s_nop 0
s_cbranch_vccz .Lok66
s_waitcnt vmcnt(2)
v_cmp_gt_u32 vcc, v70, v85
s_nop 0
s_cbranch_vccz .Lok66
s_waitcnt vmcnt(0)
v_cmp_gt_u32 vcc, v70, v86
s_nop 0
s_cbranch_vccz .Lok66
s_mov_b32 s15, 0
.Lok66l:
v_mov_b32 v84, 0
buffer_atomic_add v84, v69, s[16:19], s73 offen offset:512 sc0
s_add_u32 s15, s15, 1
s_cmp_gt_u32 s15, 100000
s_waitcnt vmcnt(0)
s_cbranch_scc1 .Lok66
v_cmp_gt_u32 vcc, v70, v84
s_nop 0
s_cbranch_vccnz .Lok66l
.Lok66:
s_waitcnt vmcnt(4)
s_barrier
MAA 244,48,132
ds_read_b64_tr_b16 a[0:1], v7
s_add_u32 s52, s76, 0
MAA 244,52,148
buffer_load_dwordx4 v[96:99], v4, s[16:19], s52 offen sc1
MAA 244,80,164
TR 2,7,512
v_rcp_f32 v172, v172
MAA 244,84,180
TR 4,7,32
v_rcp_f32 v173, v173
MAA 252,92,180
TR 6,7,544
v_rcp_f32 v174, v174
MAA 252,88,164
buffer_load_dwordx4 v[100:103], v4, s[16:19], s52 offen offset:1024 sc1
MAA 252,60,148
TR 8,7,64
s_add_u32 s52, s76, 65536
MAA 252,56,132
TR 10,7,576
v_rcp_f32 v175, v175
MAA 228,64,164
TR 12,7,96
v_rcp_f32 v188, v188
MAA 228,68,180
buffer_load_dwordx4 v[104:107], v4, s[16:19], s52 offen sc1
MAA 236,76,180
TR 14,7,608
v_rcp_f32 v189, v189
MAA 236,72,164
TR 16,7,8448
v_rcp_f32 v190, v190
v_rcp_f32 v191, v191
v_exp_f32 v224, v224
v_exp_f32 v225, v225
v_exp_f32 v226, v226
v_exp_f32 v227, v227
v_exp_f32 v232, v232
v_exp_f32 v233, v233
v_exp_f32 v234, v234
v_exp_f32 v235, v235
v_pk_mul_f32 v[204:205], v[204:205], v[172:173]
buffer_load_dwordx4 v[108:111], v4, s[16:19], s52 offen offset:1024 sc1
s_add_u32 s52, s77, 114688
v_pk_mul_f32 v[206:207], v[206:207], v[174:175]
v_pk_mul_f32 v[220:221], v[220:221], v[188:189]
.Lpad36:
s_cbranch_execz .Lpad39
v_pk_mul_f32 v[222:223], v[222:223], v[190:191]
v_pk_mul_f32 v[244:245], v[244:245], v[228:229]
v_pk_mul_f32 v[228:229], v[228:229], v[28:29] op_sel:[0,1] op_sel_hi:[1,1]
v_pk_mul_f32 v[246:247], v[246:247], v[230:231]
v_pk_mul_f32 v[230:231], v[230:231], v[28:29] op_sel:[0,1] op_sel_hi:[1,1]
v_pk_mul_f32 v[252:253], v[252:253], v[236:237]
v_pk_mul_f32 v[236:237], v[236:237], v[28:29] op_sel:[0,1] op_sel_hi:[1,1]
v_pk_mul_f32 v[254:255], v[254:255], v[238:239]
v_pk_mul_f32 v[238:239], v[238:239], v[28:29] op_sel:[0,1] op_sel_hi:[1,1]
v_pk_fma_f32 v[224:225], v[224:225], v[20:21], v[20:21] op_sel:[0,1,1] op_sel_hi:[1,1,1]
buffer_load_dwordx4 v[112:115], v4, s[16:19], s52 offen sc1
v_pk_fma_f32 v[226:227], v[226:227], v[20:21], v[20:21] op_sel:[0,1,1] op_sel_hi:[1,1,1]
v_pk_fma_f32 v[232:233], v[232:233], v[20:21], v[20:21] op_sel:[0,1,1] op_sel_hi:[1,1,1]
v_pk_fma_f32 v[234:235], v[234:235], v[20:21], v[20:21] op_sel:[0,1,1] op_sel_hi:[1,1,1]
v_cvt_pk_bf16_f32 v172, v204, v205
v_cvt_pk_bf16_f32 v173, v206, v207
v_cvt_pk_bf16_f32 v174, v220, v221
v_cvt_pk_bf16_f32 v175, v222, v223
TR 18,7,8960
TR 20,7,8480
TR 22,7,8992
buffer_store_dwordx4 v[172:175], v11, s[16:19], s64 offen offset:1024 sc1
TR 24,7,8512
TR 26,7,9024
TR 28,7,8544
TR 30,7,9056
v_rcp_f32 v224, v224
v_rcp_f32 v225, v225
v_rcp_f32 v226, v226
v_rcp_f32 v227, v227
v_rcp_f32 v232, v232
v_rcp_f32 v233, v233
v_rcp_f32 v234, v234
v_rcp_f32 v235, v235
v_exp_f32 v228, v228
v_exp_f32 v229, v229
v_exp_f32 v230, v230
v_exp_f32 v231, v231
v_exp_f32 v236, v236
v_exp_f32 v237, v237
v_exp_f32 v238, v238
v_exp_f32 v239, v239
v_pk_mul_f32 v[240:241], v[240:241], v[224:225]
buffer_load_dwordx4 v[116:119], v4, s[16:19], s52 offen offset:1024 sc1
s_add_u32 s52, s77, 180224
v_pk_mul_f32 v[242:243], v[242:243], v[226:227]
v_pk_mul_f32 v[248:249], v[248:249], v[232:233]
v_pk_mul_f32 v[250:251], v[250:251], v[234:235]
v_pk_fma_f32 v[228:229], v[228:229], v[22:23], v[22:23] op_sel:[0,1,1] op_sel_hi:[1,1,1]
v_pk_fma_f32 v[230:231], v[230:231], v[22:23], v[22:23] op_sel:[0,1,1] op_sel_hi:[1,1,1]
v_pk_fma_f32 v[236:237], v[236:237], v[22:23], v[22:23] op_sel:[0,1,1] op_sel_hi:[1,1,1]
v_pk_fma_f32 v[238:239], v[238:239], v[22:23], v[22:23] op_sel:[0,1,1] op_sel_hi:[1,1,1]
v_cvt_pk_bf16_f32 v224, v240, v241
v_cvt_pk_bf16_f32 v225, v242, v243
v_cvt_pk_bf16_f32 v226, v248, v249
v_cvt_pk_bf16_f32 v227, v250, v251
v_rcp_f32 v228, v228
v_rcp_f32 v229, v229
v_rcp_f32 v230, v230
v_rcp_f32 v231, v231
v_rcp_f32 v236, v236
v_rcp_f32 v237, v237
v_rcp_f32 v238, v238
v_rcp_f32 v239, v239
v_pk_mul_f32 v[244:245], v[244:245], v[228:229]
buffer_store_dwordx4 v[224:227], v10, s[16:19], s65 offen sc1
v_pk_mul_f32 v[246:247], v[246:247], v[230:231]
v_pk_mul_f32 v[252:253], v[252:253], v[236:237]
v_pk_mul_f32 v[254:255], v[254:255], v[238:239]
v_cvt_pk_bf16_f32 v228, v244, v245
v_cvt_pk_bf16_f32 v229, v246, v247
v_cvt_pk_bf16_f32 v230, v252, v253
v_cvt_pk_bf16_f32 v231, v254, v255
buffer_store_dwordx4 v[228:231], v10, s[16:19], s65 offen offset:1024 sc1
buffer_load_dwordx4 v[120:123], v4, s[16:19], s52 offen sc1
buffer_load_dwordx4 v[124:127], v4, s[16:19], s52 offen offset:1024 sc1
v_mov_b32 v21, v68
v_mov_b32 v22, v69
v_mov_b32 v23, v70
v_mov_b32 v24, v71
v_mov_b32 v25, 0
s_waitcnt vmcnt(7) lgkmcnt(0)
s_barrier
v_mfma_f32_16x16x32_bf16 v[32:35], a[0:3], v[96:99], 0
ds_read_b64_tr_b16 a[32:33], v6
s_add_u32 s52, s78, 229376
MAV 32,16,104
buffer_load_dwordx4 v[128:131], v4, s[16:19], s52 offen sc1
v_mfma_f32_16x16x32_bf16 v[48:51], a[0:3], v[100:103], 0
TR 34,6,512
MAV 48,16,108
TR 36,6,32
TR 38,6,544
v_mfma_f32_16x16x32_bf16 v[52:55], a[4:7], v[100:103], 0
TR 48,6,8448
MAV 52,20,108
buffer_load_dwordx4 v[132:135], v4, s[16:19], s52 offen offset:1024 sc1
v_mfma_f32_16x16x32_bf16 v[36:39], a[4:7], v[96:99], 0
TR 50,6,8960
MAV 36,20,104
TR 52,6,8480
TR 54,6,8992
v_mfma_f32_16x16x32_bf16 v[40:43], a[8:11], v[96:99], 0
TR 40,6,64
s_add_u32 s52, s78, 294912
MAV 40,24,104
buffer_load_dwordx4 v[136:139], v4, s[16:19], s52 offen sc1
v_mfma_f32_16x16x32_bf16 v[56:59], a[8:11], v[100:103], 0
TR 42,6,576
MAV 56,24,108
TR 44,6,96
TR 46,6,608
v_mfma_f32_16x16x32_bf16 v[60:63], a[12:15], v[100:103], 0
TR 56,6,8512
MAV 60,28,108
buffer_load_dwordx4 v[140:143], v4, s[16:19], s52 offen offset:1024 sc1
v_mfma_f32_16x16x32_bf16 v[44:47], a[12:15], v[96:99], 0
TR 58,6,9024
MAV 44,28,104
TR 60,6,8544
TR 62,6,9056
s_waitcnt lgkmcnt(8)
v_mfma_f32_16x16x32_bf16 v[64:67], a[32:35], v[96:99], 0
TR 0,7,16896
s_add_u32 s52, s79, 344064
MAV 64,48,104
buffer_load_dwordx4 v[144:147], v4, s[16:19], s52 offen sc1
v_mfma_f32_16x16x32_bf16 v[80:83], a[32:35], v[100:103], 0
TR 2,7,17408
MAV 80,48,108
TR 4,7,16928
TR 6,7,17440
v_mfma_f32_16x16x32_bf16 v[84:87], a[36:39], v[100:103], 0
TR 16,7,25344
MAV 84,52,108
buffer_load_dwordx4 v[148:151], v4, s[16:19], s52 offen offset:1024 sc1
v_mfma_f32_16x16x32_bf16 v[68:71], a[36:39], v[96:99], 0
TR 18,7,25856
MAV 68,52,104
TR 20,7,25376
TR 22,7,25888
s_waitcnt lgkmcnt(8)
v_mfma_f32_16x16x32_bf16 v[72:75], a[40:43], v[96:99], 0
TR 8,7,16960
s_add_u32 s52, s79, 409600
MAV 72,56,104
buffer_load_dwordx4 v[152:155], v4, s[16:19], s52 offen sc1
v_mfma_f32_16x16x32_bf16 v[88:91], a[40:43], v[100:103], 0
TR 10,7,17472
MAV 88,56,108
TR 12,7,16992
TR 14,7,17504
v_mfma_f32_16x16x32_bf16 v[92:95], a[44:47], v[100:103], 0
TR 24,7,25408
MAV 92,60,108
buffer_load_dwordx4 v[156:159], v4, s[16:19], s52 offen offset:1024 sc1
v_mfma_f32_16x16x32_bf16 v[76:79], a[44:47], v[96:99], 0
TR 26,7,25920
MAV 76,60,104
TR 28,7,25440
TR 30,7,25952
s_waitcnt vmcnt(8) lgkmcnt(8)
s_barrier
MAV 32,0,112
TR 32,6,16896
s_add_u32 m0, s55, 0
MAV 32,16,120
buffer_load_dwordx4 v18, s[28:31], s54 offen lds
MAV 48,16,124
TR 34,6,17408
MAV 48,0,116
TR 36,6,16928
TR 38,6,17440
MAV 52,4,116
TR 48,6,25344
s_add_u32 s52, s76, 458752
MAV 52,20,124
buffer_load_dwordx4 v[96:99], v4, s[16:19], s52 offen sc1
MAV 36,20,120
TR 50,6,25856
MAV 36,4,112
TR 52,6,25376
TR 54,6,25888
s_waitcnt lgkmcnt(8)
MAV 40,8,112
TR 40,6,16960
MAV 40,24,120
buffer_load_dwordx4 v19, s[28:31], s54 offen offset:1056 lds
MAV 56,24,124
TR 42,6,17472
s_add_u32 s54, s98, 327680
MAV 56,8,116
TR 44,6,16992
TR 46,6,17504
MAV 60,12,116
TR 56,6,25408
MAV 60,28,124
buffer_load_dwordx4 v[100:103], v4, s[16:19], s52 offen offset:1024 sc1
MAV 44,28,120
TR 58,6,25920
MAV 44,12,112
TR 60,6,25440
TR 62,6,25952
s_waitcnt lgkmcnt(8)
MAV 64,32,112
TR 0,7,33792
s_add_u32 m0, s55, 8448
MAV 64,48,120
buffer_load_dwordx4 v18, s[28:31], s54 offen lds
MAV 80,48,124
TR 2,7,34304
MAV 80,32,116
TR 4,7,33824
TR 6,7,34336
MAV 84,36,116
TR 16,7,42240
s_add_u32 s52, s76, 524288
MAV 84,52,124
buffer_load_dwordx4 v[104:107], v4, s[16:19], s52 offen sc1
MAV 68,52,120
TR 18,7,42752
MAV 68,36,112
TR 20,7,42272
TR 22,7,42784
s_waitcnt lgkmcnt(8)
MAV 72,40,112
TR 8,7,33856
MAV 72,56,120
buffer_load_dwordx4 v19, s[28:31], s54 offen offset:1056 lds
MAV 88,56,124
TR 10,7,34368
s_add_u32 s54, s99, 524288
MAV 88,40,116
TR 12,7,33888
TR 14,7,34400
MAV 92,44,116
TR 24,7,42304
MAV 92,60,124
buffer_load_dwordx4 v[108:111], v4, s[16:19], s52 offen offset:1024 sc1
MAV 76,60,120
TR 26,7,42816
MAV 76,44,112
TR 28,7,42336
TR 30,7,42848
s_waitcnt vmcnt(12) lgkmcnt(8)
s_barrier
MAV 32,0,128
TR 32,6,33792
MAV 32,16,136
buffer_atomic_add v24, v21, s[16:19], s72 offen
MAV 48,16,140
TR 34,6,34304
MAV 48,0,132
TR 36,6,33824
TR 38,6,34336
TR 48,6,42240
MAV 52,4,132
TR 50,6,42752
s_add_u32 m0, s55, 16896
MAV 52,20,140
buffer_load_dwordx4 v18, s[28:31], s54 offen lds
MAV 36,20,136
TR 52,6,42272
MAV 36,4,128
TR 54,6,42784
TR 40,6,33856
s_waitcnt lgkmcnt(9)
MAV 40,8,128
TR 42,6,34368
s_add_u32 s52, s77, 573440
MAV 40,24,136
buffer_load_dwordx4 v[112:115], v4, s[16:19], s52 offen sc1
MAV 56,24,140
TR 44,6,33888
MAV 56,8,132
buffer_load_dwordx4 v19, s[28:31], s54 offen offset:1056 lds
MAV 60,12,132
TR 46,6,34400
s_add_u32 s54, s99, 786432
MAV 60,28,140
buffer_load_dwordx4 v[116:119], v4, s[16:19], s52 offen offset:1024 sc1
MAV 44,28,136
TR 56,6,42304
MAV 44,12,128
TR 58,6,42816
TR 60,6,42336
TR 62,6,42848
s_waitcnt lgkmcnt(8)
MAV 64,32,128
TR 0,7,50688
s_add_u32 m0, s55, 25344
MAV 64,48,136
buffer_load_dwordx4 v18, s[28:31], s54 offen lds
MAV 80,48,140
TR 2,7,51200
MAV 80,32,132
TR 4,7,50720
TR 6,7,51232
MAV 84,36,132
TR 16,7,59136
s_add_u32 s52, s77, 638976
MAV 84,52,140
buffer_load_dwordx4 v[120:123], v4, s[16:19], s52 offen sc1
MAV 68,52,136
TR 18,7,59648
MAV 68,36,128
TR 20,7,59168
TR 22,7,59680
s_waitcnt lgkmcnt(8)
MAV 72,40,128
TR 8,7,50752
MAV 72,56,136
buffer_load_dwordx4 v19, s[28:31], s54 offen offset:1056 lds
MAV 88,56,140
TR 10,7,51264
s_add_u32 s54, s100, 983040
MAV 88,40,132
TR 12,7,50784
TR 14,7,51296
MAV 92,44,132
TR 24,7,59200
MAV 92,60,140
buffer_load_dwordx4 v[124:127], v4, s[16:19], s52 offen offset:1024 sc1
MAV 76,60,136
TR 26,7,59712
MAV 76,44,128
TR 28,7,59232
TR 30,7,59744
s_waitcnt vmcnt(17) lgkmcnt(8)
s_barrier
MAV 32,0,144
TR 32,6,50688
s_add_u32 m0, s55, 33792
MAV 32,16,152
buffer_load_dwordx4 v18, s[28:31], s54 offen lds
MAV 48,16,156
TR 34,6,51200
MAV 48,0,148
TR 36,6,50720
TR 38,6,51232
MAV 52,4,148
TR 48,6,59136
s_add_u32 s52, s78, 688128
MAV 52,20,156
buffer_load_dwordx4 v[128:131], v4, s[16:19], s52 offen sc1
MAV 36,20,152
TR 50,6,59648
MAV 36,4,144
TR 52,6,59168
TR 54,6,59680
s_waitcnt lgkmcnt(8)
MAV 40,8,144
TR 40,6,50752
MAV 40,24,152
buffer_load_dwordx4 v19, s[28:31], s54 offen offset:1056 lds
MAV 56,24,156
TR 42,6,51264
s_add_u32 s54, s100, 1245184
MAV 56,8,148
TR 44,6,50784
TR 46,6,51296
MAV 60,12,148
TR 56,6,59200
MAV 60,28,156
buffer_load_dwordx4 v[132:135], v4, s[16:19], s52 offen offset:1024 sc1
MAV 44,28,152
TR 58,6,59712
MAV 44,12,144
TR 60,6,59232
TR 62,6,59744
v_add_u32 v7, s57, v7
v_add_u32 v6, s57, v6
s_sub_u32 s57, 0, s57
s_waitcnt lgkmcnt(8)
MAV 64,32,144
ds_read_b64_tr_b16 a[0:1], v7
s_add_u32 m0, s55, 42240
MAV 64,48,152
buffer_load_dwordx4 v18, s[28:31], s54 offen lds
MAV 80,48,156
TR 2,7,512
MAV 80,32,148
TR 4,7,32
TR 6,7,544
TR 16,7,8448
MAV 84,36,148
TR 18,7,8960
s_add_u32 s52, s78, 753664
MAV 84,52,156
buffer_load_dwordx4 v[136:139], v4, s[16:19], s52 offen sc1
MAV 68,52,152
TR 20,7,8480
MAV 68,36,144
TR 22,7,8992
TR 8,7,64
s_waitcnt lgkmcnt(9)
MAV 72,40,144
TR 10,7,576
MAV 72,56,152
buffer_load_dwordx4 v19, s[28:31], s54 offen offset:1056 lds
MAV 88,56,156
TR 12,7,96
s_add_u32 s54, s101, 1441792
MAV 88,40,148
buffer_load_dwordx4 v[140:143], v4, s[16:19], s52 offen offset:1024 sc1
MAV 92,44,148
TR 14,7,608
MAV 92,60,156
buffer_atomic_add v25, v22, s[16:19], s73 offen sc0
MAV 76,60,152
TR 24,7,8512
MAV 76,44,144
TR 26,7,9024
TR 28,7,8544
TR 30,7,9056
s_waitcnt vmcnt(18) lgkmcnt(8)
s_barrier
MAV 32,0,96
ds_read_b64_tr_b16 a[32:33], v6
s_add_u32 m0, s55, 50688
MAV 32,16,104
buffer_load_dwordx4 v18, s[28:31], s54 offen lds
MAV 48,16,108
TR 34,6,512
MAV 48,0,100
TR 36,6,32
TR 38,6,544
MAV 52,4,100
TR 48,6,8448
s_add_u32 s52, s79, 802816
MAV 52,20,108
buffer_load_dwordx4 v[144:147], v4, s[16:19], s52 offen sc1
MAV 36,20,104
TR 50,6,8960
MAV 36,4,96
TR 52,6,8480
TR 54,6,8992
s_waitcnt lgkmcnt(8)
MAV 40,8,96
TR 40,6,64
MAV 40,24,104
buffer_load_dwordx4 v19, s[28:31], s54 offen offset:1056 lds
MAV 56,24,108
TR 42,6,576
s_add_u32 s54, s101, 1703936
MAV 56,8,100
TR 44,6,96
TR 46,6,608
MAV 60,12,100
TR 56,6,8512
MAV 60,28,108
buffer_load_dwordx4 v[148:151], v4, s[16:19], s52 offen offset:1024 sc1
MAV 44,28,104
TR 58,6,9024
MAV 44,12,96
TR 60,6,8544
TR 62,6,9056
s_waitcnt lgkmcnt(8)
MAV 64,32,96
TR 0,7,16896
s_add_u32 m0, s55, 59136
MAV 64,48,104
buffer_load_dwordx4 v18, s[28:31], s54 offen lds
MAV 80,48,108
TR 2,7,17408
MAV 80,32,100
TR 4,7,16928
TR 6,7,17440
MAV 84,36,100
TR 16,7,25344
s_add_u32 s52, s79, 868352
MAV 84,52,108
buffer_load_dwordx4 v[152:155], v4, s[16:19], s52 offen sc1
MAV 68,52,104
TR 18,7,25856
MAV 68,36,96
TR 20,7,25376
TR 22,7,25888
s_waitcnt lgkmcnt(8)
MAV 72,40,96
TR 8,7,16960
MAV 72,56,104
buffer_load_dwordx4 v19, s[28:31], s54 offen offset:1056 lds
MAV 88,56,108
TR 10,7,17472
s_add_u32 s54, s98, 1900544
MAV 88,40,100
TR 12,7,16992
TR 14,7,17504
MAV 92,44,100
TR 24,7,25408
MAV 92,60,108
buffer_load_dwordx4 v[156:159], v4, s[16:19], s52 offen offset:1024 sc1
MAV 76,60,104
TR 26,7,25920
MAV 76,44,96
TR 28,7,25440
TR 30,7,25952
s_waitcnt vmcnt(8)
v_cmp_gt_u32 vcc, v23, v25
s_nop 0
s_cbranch_vccnz .Lsp67
.Lsp67b:
s_waitcnt lgkmcnt(8)
s_barrier
MAV 32,0,112
TR 32,6,16896
s_add_u32 m0, s55, 67584
MAV 32,16,120
buffer_load_dwordx4 v18, s[28:31], s54 offen lds
MAV 48,16,124
TR 34,6,17408
MAV 48,0,116
TR 36,6,16928
TR 38,6,17440
MAV 52,4,116
TR 48,6,25344
s_add_u32 s52, s76, 16384
MAV 52,20,124
buffer_load_dwordx4 v[96:99], v4, s[16:19], s52 offen sc1
MAV 36,20,120
TR 50,6,25856
MAV 36,4,112
TR 52,6,25376
TR 54,6,25888
s_waitcnt lgkmcnt(8)
MAV 40,8,112
TR 40,6,16960
MAV 40,24,120
buffer_load_dwordx4 v19, s[28:31], s54 offen offset:1056 lds
MAV 56,24,124
TR 42,6,17472
s_add_u32 s54, s98, 2162688
MAV 56,8,116
TR 44,6,16992
TR 46,6,17504
MAV 60,12,116
TR 56,6,25408
MAV 60,28,124
buffer_load_dwordx4 v[100:103], v4, s[16:19], s52 offen offset:1024 sc1
MAV 44,28,120
TR 58,6,25920
MAV 44,12,112
TR 60,6,25440
.Lpad37:
s_cbranch_execz .Lpad40
TR 62,6,25952
s_waitcnt lgkmcnt(8)
MAV 64,32,112
TR 0,7,33792
s_add_u32 m0, s55, 76032
MAV 64,48,120
buffer_load_dwordx4 v18, s[28:31], s54 offen lds
MAV 80,48,124
TR 2,7,34304
MAV 80,32,116
TR 4,7,33824
TR 6,7,34336
MAV 84,36,116
TR 16,7,42240
s_add_u32 s52, s76, 81920
MAV 84,52,124
buffer_load_dwordx4 v[104:107], v4, s[16:19], s52 offen sc1
MAV 68,52,120
TR 18,7,42752
MAV 68,36,112
TR 20,7,42272
TR 22,7,42784
s_waitcnt lgkmcnt(8)
MAV 72,40,112
TR 8,7,33856
MAV 72,56,120
buffer_load_dwordx4 v19, s[28:31], s54 offen offset:1056 lds
MAV 88,56,124
TR 10,7,34368
s_add_u32 s54, s99, 2359296
MAV 88,40,116
TR 12,7,33888
TR 14,7,34400
MAV 92,44,116
TR 24,7,42304
MAV 92,60,124
buffer_load_dwordx4 v[108:111], v4, s[16:19], s52 offen offset:1024 sc1
MAV 76,60,120
TR 26,7,42816
MAV 76,44,112
TR 28,7,42336
TR 30,7,42848
s_waitcnt lgkmcnt(8)
s_barrier
MAV 32,0,128
TR 32,6,33792
s_add_u32 m0, s55, 84480
MAV 32,16,136
buffer_load_dwordx4 v18, s[28:31], s54 offen lds
MAV 48,16,140
TR 34,6,34304
MAV 48,0,132
TR 36,6,33824
TR 38,6,34336
MAV 52,4,132
TR 48,6,42240
s_add_u32 s52, s77, 131072
MAV 52,20,140
buffer_load_dwordx4 v[112:115], v4, s[16:19], s52 offen sc1
MAV 36,20,136
TR 50,6,42752
MAV 36,4,128
TR 52,6,42272
TR 54,6,42784
s_waitcnt lgkmcnt(8)
MAV 40,8,128
TR 40,6,33856
MAV 40,24,136
buffer_load_dwordx4 v19, s[28:31], s54 offen offset:1056 lds
MAV 56,24,140
TR 42,6,34368
s_add_u32 s54, s99, 2621440
MAV 56,8,132
TR 44,6,33888
TR 46,6,34400
MAV 60,12,132
TR 56,6,42304
MAV 60,28,140
buffer_load_dwordx4 v[116:119], v4, s[16:19], s52 offen offset:1024 sc1
MAV 44,28,136
TR 58,6,42816
MAV 44,12,128
TR 60,6,42336
TR 62,6,42848
s_waitcnt lgkmcnt(8)
MAV 64,32,128
TR 0,7,50688
s_add_u32 m0, s55, 92928
MAV 64,48,136
buffer_load_dwordx4 v18, s[28:31], s54 offen lds
MAV 80,48,140
TR 2,7,51200
MAV 80,32,132
TR 4,7,50720
TR 6,7,51232
MAV 84,36,132
TR 16,7,59136
s_add_u32 s52, s77, 196608
MAV 84,52,140
buffer_load_dwordx4 v[120:123], v4, s[16:19], s52 offen sc1
MAV 68,52,136
TR 18,7,59648
MAV 68,36,128
TR 20,7,59168
TR 22,7,59680
s_waitcnt lgkmcnt(8)
MAV 72,40,128
TR 8,7,50752
MAV 72,56,136
buffer_load_dwordx4 v19, s[28:31], s54 offen offset:1056 lds
MAV 88,56,140
TR 10,7,51264
s_add_u32 s54, s100, 2818048
MAV 88,40,132
TR 12,7,50784
TR 14,7,51296
MAV 92,44,132
TR 24,7,59200
MAV 92,60,140
buffer_load_dwordx4 v[124:127], v4, s[16:19], s52 offen offset:1024 sc1
MAV 76,60,136
TR 26,7,59712
MAV 76,44,128
TR 28,7,59232
TR 30,7,59744
s_waitcnt vmcnt(16) lgkmcnt(8)
s_barrier
MAV 32,0,144
TR 32,6,50688
s_add_u32 m0, s55, 101376
MAV 32,16,152
buffer_load_dwordx4 v18, s[28:31], s54 offen lds
MAV 48,16,156
TR 34,6,51200
MAV 48,0,148
TR 36,6,50720
TR 38,6,51232
MAV 52,4,148
TR 48,6,59136
s_add_u32 s52, s78, 245760
MAV 52,20,156
buffer_load_dwordx4 v[128:131], v4, s[16:19], s52 offen sc1
MAV 36,20,152
TR 50,6,59648
MAV 36,4,144
TR 52,6,59168
TR 54,6,59680
s_waitcnt lgkmcnt(8)
MAV 40,8,144
TR 40,6,50752
MAV 40,24,152
buffer_load_dwordx4 v19, s[28:31], s54 offen offset:1056 lds
MAV 56,24,156
TR 42,6,51264
s_add_u32 s54, s100, 3080192
MAV 56,8,148
TR 44,6,50784
TR 46,6,51296
MAV 60,12,148
TR 56,6,59200
MAV 60,28,156
buffer_load_dwordx4 v[132:135], v4, s[16:19], s52 offen offset:1024 sc1
MAV 44,28,152
TR 58,6,59712
MAV 44,12,144
TR 60,6,59232
TR 62,6,59744
v_add_u32 v7, s57, v7
v_add_u32 v6, s57, v6
s_sub_u32 s57, 0, s57
s_waitcnt lgkmcnt(8)
MAV 64,32,144
ds_read_b64_tr_b16 a[0:1], v7
s_add_u32 m0, s55, 109824
MAV 64,48,152
buffer_load_dwordx4 v18, s[28:31], s54 offen lds
MAV 80,48,156
TR 2,7,512
MAV 80,32,148
TR 4,7,32
TR 6,7,544
MAV 84,36,148
TR 16,7,8448
s_add_u32 s52, s78, 311296
MAV 84,52,156
buffer_load_dwordx4 v[136:139], v4, s[16:19], s52 offen sc1
MAV 68,52,152
TR 18,7,8960
MAV 68,36,144
TR 20,7,8480
TR 22,7,8992
s_waitcnt lgkmcnt(8)
MAV 72,40,144
TR 8,7,64
MAV 72,56,152
buffer_load_dwordx4 v19, s[28:31], s54 offen offset:1056 lds
MAV 88,56,156
TR 10,7,576
s_add_u32 s54, s101, 3276800
MAV 88,40,148
TR 12,7,96
TR 14,7,608
MAV 92,44,148
TR 24,7,8512
MAV 92,60,156
buffer_load_dwordx4 v[140:143], v4, s[16:19], s52 offen offset:1024 sc1
MAV 76,60,152
TR 26,7,9024
MAV 76,44,144
TR 28,7,8544
TR 30,7,9056
s_waitcnt vmcnt(16) lgkmcnt(8)
s_barrier
MAV 32,0,96
ds_read_b64_tr_b16 a[32:33], v6
s_add_u32 m0, s55, 118272
MAV 32,16,104
buffer_load_dwordx4 v18, s[28:31], s54 offen lds
MAV 48,16,108
TR 34,6,512
MAV 48,0,100
TR 36,6,32
TR 38,6,544
MAV 52,4,100
TR 48,6,8448
s_add_u32 s52, s79, 360448
MAV 52,20,108
buffer_load_dwordx4 v[144:147], v4, s[16:19], s52 offen sc1
MAV 36,20,104
TR 50,6,8960
MAV 36,4,96
TR 52,6,8480
TR 54,6,8992
s_waitcnt lgkmcnt(8)
MAV 40,8,96
TR 40,6,64
MAV 40,24,104
buffer_load_dwordx4 v19, s[28:31], s54 offen offset:1056 lds
MAV 56,24,108
TR 42,6,576
s_add_u32 s54, s101, 3538944
MAV 56,8,100
TR 44,6,96
TR 46,6,608
MAV 60,12,100
TR 56,6,8512
MAV 60,28,108
buffer_load_dwordx4 v[148:151], v4, s[16:19], s52 offen offset:1024 sc1
MAV 44,28,104
TR 58,6,9024
MAV 44,12,96
TR 60,6,8544
TR 62,6,9056
s_waitcnt lgkmcnt(8)
MAV 64,32,96
TR 0,7,16896
s_add_u32 m0, s55, 126720
MAV 64,48,104
buffer_load_dwordx4 v18, s[28:31], s54 offen lds
MAV 80,48,108
TR 2,7,17408
MAV 80,32,100
TR 4,7,16928
TR 6,7,17440
MAV 84,36,100
TR 16,7,25344
s_add_u32 s52, s79, 425984
MAV 84,52,108
buffer_load_dwordx4 v[152:155], v4, s[16:19], s52 offen sc1
MAV 68,52,104
TR 18,7,25856
MAV 68,36,96
TR 20,7,25376
TR 22,7,25888
s_waitcnt lgkmcnt(8)
MAV 72,40,96
TR 8,7,16960
MAV 72,56,104
buffer_load_dwordx4 v19, s[28:31], s54 offen offset:1056 lds
MAV 88,56,108
TR 10,7,17472
s_add_u32 s54, s98, 131072
MAV 88,40,100
TR 12,7,16992
TR 14,7,17504
MAV 92,44,100
TR 24,7,25408
MAV 92,60,108
buffer_load_dwordx4 v[156:159], v4, s[16:19], s52 offen offset:1024 sc1
MAV 76,60,104
TR 26,7,25920
MAV 76,44,96
TR 28,7,25440
TR 30,7,25952
s_waitcnt vmcnt(16) lgkmcnt(8)
s_barrier
MAV 32,0,112
TR 32,6,16896
s_add_u32 m0, s55, 0
MAV 32,16,120
buffer_load_dwordx4 v18, s[28:31], s54 offen lds
MAV 48,16,124
TR 34,6,17408
MAV 48,0,116
TR 36,6,16928
TR 38,6,17440
MAV 52,4,116
TR 48,6,25344
s_add_u32 s52, s76, 475136
MAV 52,20,124
buffer_load_dwordx4 v[96:99], v4, s[16:19], s52 offen sc1
MAV 36,20,120
TR 50,6,25856
MAV 36,4,112
TR 52,6,25376
TR 54,6,25888
s_waitcnt lgkmcnt(8)
MAV 40,8,112
TR 40,6,16960
MAV 40,24,120
buffer_load_dwordx4 v19, s[28:31], s54 offen offset:1056 lds
MAV 56,24,124
TR 42,6,17472
s_add_u32 s54, s98, 393216
MAV 56,8,116
TR 44,6,16992
TR 46,6,17504
MAV 60,12,116
TR 56,6,25408
MAV 60,28,124
buffer_load_dwordx4 v[100:103], v4, s[16:19], s52 offen offset:1024 sc1
MAV 44,28,120
TR 58,6,25920
MAV 44,12,112
TR 60,6,25440
TR 62,6,25952
s_waitcnt lgkmcnt(8)
MAV 64,32,112
TR 0,7,33792
s_add_u32 m0, s55, 8448
MAV 64,48,120
buffer_load_dwordx4 v18, s[28:31], s54 offen lds
MAV 80,48,124
TR 2,7,34304
MAV 80,32,116
TR 4,7,33824
TR 6,7,34336
MAV 84,36,116
TR 16,7,42240
s_add_u32 s52, s76, 540672
MAV 84,52,124
buffer_load_dwordx4 v[104:107], v4, s[16:19], s52 offen sc1
MAV 68,52,120
TR 18,7,42752
MAV 68,36,112
TR 20,7,42272
TR 22,7,42784
s_waitcnt lgkmcnt(8)
MAV 72,40,112
TR 8,7,33856
MAV 72,56,120
buffer_load_dwordx4 v19, s[28:31], s54 offen offset:1056 lds
MAV 88,56,124
TR 10,7,34368
s_add_u32 s54, s99, 589824
MAV 88,40,116
TR 12,7,33888
TR 14,7,34400
MAV 92,44,116
TR 24,7,42304
MAV 92,60,124
buffer_load_dwordx4 v[108:111], v4, s[16:19], s52 offen offset:1024 sc1
MAV 76,60,120
TR 26,7,42816
MAV 76,44,112
TR 28,7,42336
TR 30,7,42848
s_waitcnt vmcnt(16) lgkmcnt(8)
s_barrier
MAV 32,0,128
TR 32,6,33792
s_add_u32 m0, s55, 16896
MAV 32,16,136
buffer_load_dwordx4 v18, s[28:31], s54 offen lds
MAV 48,16,140
TR 34,6,34304
MAV 48,0,132
TR 36,6,33824
TR 38,6,34336
MAV 52,4,132
TR 48,6,42240
s_add_u32 s52, s77, 589824
MAV 52,20,140
buffer_load_dwordx4 v[112:115], v4, s[16:19], s52 offen sc1
MAV 36,20,136
TR 50,6,42752
MAV 36,4,128
TR 52,6,42272
TR 54,6,42784
s_waitcnt lgkmcnt(8)
MAV 40,8,128
TR 40,6,33856
MAV 40,24,136
buffer_load_dwordx4 v19, s[28:31], s54 offen offset:1056 lds
MAV 56,24,140
TR 42,6,34368
s_add_u32 s54, s99, 851968
MAV 56,8,132
TR 44,6,33888
TR 46,6,34400
MAV 60,12,132
TR 56,6,42304
MAV 60,28,140
buffer_load_dwordx4 v[116:119], v4, s[16:19], s52 offen offset:1024 sc1
MAV 44,28,136
TR 58,6,42816
MAV 44,12,128
TR 60,6,42336
TR 62,6,42848
s_waitcnt lgkmcnt(8)
MAV 64,32,128
TR 0,7,50688
s_add_u32 m0, s55, 25344
MAV 64,48,136
buffer_load_dwordx4 v18, s[28:31], s54 offen lds
MAV 80,48,140
TR 2,7,51200
MAV 80,32,132
TR 4,7,50720
TR 6,7,51232
MAV 84,36,132
TR 16,7,59136
s_add_u32 s52, s77, 655360
MAV 84,52,140
buffer_load_dwordx4 v[120:123], v4, s[16:19], s52 offen sc1
MAV 68,52,136
TR 18,7,59648
MAV 68,36,128
TR 20,7,59168
TR 22,7,59680
s_waitcnt lgkmcnt(8)
MAV 72,40,128
TR 8,7,50752
MAV 72,56,136
buffer_load_dwordx4 v19, s[28:31], s54 offen offset:1056 lds
MAV 88,56,140
TR 10,7,51264
s_add_u32 s54, s100, 1048576
MAV 88,40,132
TR 12,7,50784
TR 14,7,51296
MAV 92,44,132
TR 24,7,59200
MAV 92,60,140
buffer_load_dwordx4 v[124:127], v4, s[16:19], s52 offen offset:1024 sc1
MAV 76,60,136
TR 26,7,59712
MAV 76,44,128
TR 28,7,59232
TR 30,7,59744
s_waitcnt vmcnt(16) lgkmcnt(8)
s_barrier
MAV 32,0,144
TR 32,6,50688
s_add_u32 m0, s55, 33792
MAV 32,16,152
buffer_load_dwordx4 v18, s[28:31], s54 offen lds
MAV 48,16,156
TR 34,6,51200
MAV 48,0,148
TR 36,6,50720
TR 38,6,51232
MAV 52,4,148
TR 48,6,59136
s_add_u32 s52, s78, 704512
MAV 52,20,156
buffer_load_dwordx4 v[128:131], v4, s[16:19], s52 offen sc1
MAV 36,20,152
TR 50,6,59648
MAV 36,4,144
TR 52,6,59168
TR 54,6,59680
s_waitcnt lgkmcnt(8)
MAV 40,8,144
TR 40,6,50752
MAV 40,24,152
buffer_load_dwordx4 v19, s[28:31], s54 offen offset:1056 lds
MAV 56,24,156
TR 42,6,51264
s_add_u32 s54, s100, 1310720
MAV 56,8,148
TR 44,6,50784
TR 46,6,51296
MAV 60,12,148
TR 56,6,59200
MAV 60,28,156
buffer_load_dwordx4 v[132:135], v4, s[16:19], s52 offen offset:1024 sc1
MAV 44,28,152
TR 58,6,59712
MAV 44,12,144
TR 60,6,59232
TR 62,6,59744
v_add_u32 v7, s57, v7
v_add_u32 v6, s57, v6
s_sub_u32 s57, 0, s57
s_waitcnt lgkmcnt(8)
MAV 64,32,144
ds_read_b64_tr_b16 a[0:1], v7
s_add_u32 m0, s55, 42240
MAV 64,48,152
buffer_load_dwordx4 v18, s[28:31], s54 offen lds
MAV 80,48,156
TR 2,7,512
MAV 80,32,148
TR 4,7,32
TR 6,7,544
MAV 84,36,148
TR 16,7,8448
s_add_u32 s52, s78, 770048
MAV 84,52,156
buffer_load_dwordx4 v[136:139], v4, s[16:19], s52 offen sc1
MAV 68,52,152
TR 18,7,8960
MAV 68,36,144
TR 20,7,8480
TR 22,7,8992
s_waitcnt lgkmcnt(8)
MAV 72,40,144
TR 8,7,64
MAV 72,56,152
buffer_load_dwordx4 v19, s[28:31], s54 offen offset:1056 lds
.Lpad38:
s_cbranch_execz .Lnopoll63r
MAV 88,56,156
TR 10,7,576
s_add_u32 s54, s101, 1507328
MAV 88,40,148
TR 12,7,96
TR 14,7,608
MAV 92,44,148
TR 24,7,8512
MAV 92,60,156
buffer_load_dwordx4 v[140:143], v4, s[16:19], s52 offen offset:1024 sc1
MAV 76,60,152
TR 26,7,9024
MAV 76,44,144
TR 28,7,8544
TR 30,7,9056
s_waitcnt vmcnt(16) lgkmcnt(8)
s_barrier
MAV 32,0,96
ds_read_b64_tr_b16 a[32:33], v6
s_add_u32 m0, s55, 50688
MAV 32,16,104
buffer_load_dwordx4 v18, s[28:31], s54 offen lds
MAV 48,16,108
TR 34,6,512
MAV 48,0,100
TR 36,6,32
TR 38,6,544
MAV 52,4,100
TR 48,6,8448
s_add_u32 s52, s79, 819200
MAV 52,20,108
buffer_load_dwordx4 v[144:147], v4, s[16:19], s52 offen sc1
MAV 36,20,104
TR 50,6,8960
MAV 36,4,96
TR 52,6,8480
TR 54,6,8992
s_waitcnt lgkmcnt(8)
MAV 40,8,96
TR 40,6,64
MAV 40,24,104
buffer_load_dwordx4 v19, s[28:31], s54 offen offset:1056 lds
MAV 56,24,108
TR 42,6,576
s_add_u32 s54, s101, 1769472
MAV 56,8,100
TR 44,6,96
TR 46,6,608
MAV 60,12,100
TR 56,6,8512
MAV 60,28,108
buffer_load_dwordx4 v[148:151], v4, s[16:19], s52 offen offset:1024 sc1
MAV 44,28,104
TR 58,6,9024
MAV 44,12,96
TR 60,6,8544
TR 62,6,9056
s_waitcnt lgkmcnt(8)
MAV 64,32,96
TR 0,7,16896
s_add_u32 m0, s55, 59136
MAV 64,48,104
buffer_load_dwordx4 v18, s[28:31], s54 offen lds
MAV 80,48,108
TR 2,7,17408
MAV 80,32,100
TR 4,7,16928
TR 6,7,17440
MAV 84,36,100
TR 16,7,25344
s_add_u32 s52, s79, 884736
MAV 84,52,108
buffer_load_dwordx4 v[152:155], v4, s[16:19], s52 offen sc1
MAV 68,52,104
TR 18,7,25856
MAV 68,36,96
TR 20,7,25376
TR 22,7,25888
s_waitcnt lgkmcnt(8)
MAV 72,40,96
TR 8,7,16960
MAV 72,56,104
buffer_load_dwordx4 v19, s[28:31], s54 offen offset:1056 lds
MAV 88,56,108
TR 10,7,17472
s_add_u32 s54, s98, 1966080
MAV 88,40,100
TR 12,7,16992
TR 14,7,17504
MAV 92,44,100
TR 24,7,25408
MAV 92,60,108
buffer_load_dwordx4 v[156:159], v4, s[16:19], s52 offen offset:1024 sc1
MAV 76,60,104
TR 26,7,25920
MAV 76,44,96
TR 28,7,25440
TR 30,7,25952
s_waitcnt vmcnt(16) lgkmcnt(8)
s_barrier
MAV 32,0,112
TR 32,6,16896
s_add_u32 m0, s55, 67584
MAV 32,16,120
buffer_load_dwordx4 v18, s[28:31], s54 offen lds
MAV 48,16,124
TR 34,6,17408
MAV 48,0,116
TR 36,6,16928
TR 38,6,17440
MAV 52,4,116
TR 48,6,25344
s_add_u32 s52, s76, 32768
MAV 52,20,124
buffer_load_dwordx4 v[96:99], v4, s[16:19], s52 offen sc1
MAV 36,20,120
TR 50,6,25856
MAV 36,4,112
TR 52,6,25376
TR 54,6,25888
s_waitcnt lgkmcnt(8)
MAV 40,8,112
TR 40,6,16960
MAV 40,24,120
buffer_load_dwordx4 v19, s[28:31], s54 offen offset:1056 lds
MAV 56,24,124
TR 42,6,17472
s_add_u32 s54, s98, 2228224
MAV 56,8,116
TR 44,6,16992
TR 46,6,17504
MAV 60,12,116
TR 56,6,25408
MAV 60,28,124
buffer_load_dwordx4 v[100:103], v4, s[16:19], s52 offen offset:1024 sc1
MAV 44,28,120
TR 58,6,25920
MAV 44,12,112
TR 60,6,25440
TR 62,6,25952
s_waitcnt lgkmcnt(8)
MAV 64,32,112
TR 0,7,33792
s_add_u32 m0, s55, 76032
MAV 64,48,120
buffer_load_dwordx4 v18, s[28:31], s54 offen lds
MAV 80,48,124
TR 2,7,34304
MAV 80,32,116
TR 4,7,33824
TR 6,7,34336
MAV 84,36,116
TR 16,7,42240
s_add_u32 s52, s76, 98304
MAV 84,52,124
buffer_load_dwordx4 v[104:107], v4, s[16:19], s52 offen sc1
MAV 68,52,120
TR 18,7,42752
MAV 68,36,112
TR 20,7,42272
TR 22,7,42784
s_waitcnt lgkmcnt(8)
MAV 72,40,112
TR 8,7,33856
MAV 72,56,120
buffer_load_dwordx4 v19, s[28:31], s54 offen offset:1056 lds
MAV 88,56,124
TR 10,7,34368
s_add_u32 s54, s99, 2424832
MAV 88,40,116
TR 12,7,33888
TR 14,7,34400
MAV 92,44,116
TR 24,7,42304
MAV 92,60,124
buffer_load_dwordx4 v[108:111], v4, s[16:19], s52 offen offset:1024 sc1
MAV 76,60,120
TR 26,7,42816
MAV 76,44,112
TR 28,7,42336
TR 30,7,42848
s_waitcnt vmcnt(16) lgkmcnt(8)
s_barrier
MAV 32,0,128
TR 32,6,33792
s_add_u32 m0, s55, 84480
MAV 32,16,136
buffer_load_dwordx4 v18, s[28:31], s54 offen lds
MAV 48,16,140
TR 34,6,34304
MAV 48,0,132
TR 36,6,33824
TR 38,6,34336
MAV 52,4,132
TR 48,6,42240
s_add_u32 s52, s77, 147456
MAV 52,20,140
buffer_load_dwordx4 v[112:115], v4, s[16:19], s52 offen sc1
MAV 36,20,136
TR 50,6,42752
MAV 36,4,128
TR 52,6,42272
TR 54,6,42784
s_waitcnt lgkmcnt(8)
MAV 40,8,128
TR 40,6,33856
MAV 40,24,136
buffer_load_dwordx4 v19, s[28:31], s54 offen offset:1056 lds
MAV 56,24,140
TR 42,6,34368
s_add_u32 s54, s99, 2686976
MAV 56,8,132
TR 44,6,33888
TR 46,6,34400
MAV 60,12,132
TR 56,6,42304
MAV 60,28,140
buffer_load_dwordx4 v[116:119], v4, s[16:19], s52 offen offset:1024 sc1
MAV 44,28,136
TR 58,6,42816
MAV 44,12,128
TR 60,6,42336
TR 62,6,42848
s_waitcnt lgkmcnt(8)
MAV 64,32,128
TR 0,7,50688
s_add_u32 m0, s55, 92928
MAV 64,48,136
buffer_load_dwordx4 v18, s[28:31], s54 offen lds
MAV 80,48,140
TR 2,7,51200
MAV 80,32,132
TR 4,7,50720
TR 6,7,51232
MAV 84,36,132
TR 16,7,59136
s_add_u32 s52, s77, 212992
MAV 84,52,140
buffer_load_dwordx4 v[120:123], v4, s[16:19], s52 offen sc1
MAV 68,52,136
TR 18,7,59648
MAV 68,36,128
TR 20,7,59168
TR 22,7,59680
s_waitcnt lgkmcnt(8)
MAV 72,40,128
TR 8,7,50752
MAV 72,56,136
buffer_load_dwordx4 v19, s[28:31], s54 offen offset:1056 lds
MAV 88,56,140
TR 10,7,51264
s_add_u32 s54, s100, 2883584
MAV 88,40,132
TR 12,7,50784
TR 14,7,51296
MAV 92,44,132
TR 24,7,59200
MAV 92,60,140
buffer_load_dwordx4 v[124:127], v4, s[16:19], s52 offen offset:1024 sc1
MAV 76,60,136
TR 26,7,59712
MAV 76,44,128
TR 28,7,59232
TR 30,7,59744
s_waitcnt vmcnt(16) lgkmcnt(8)
s_barrier
MAV 32,0,144
TR 32,6,50688
s_add_u32 m0, s55, 101376
MAV 32,16,152
buffer_load_dwordx4 v18, s[28:31], s54 offen lds
MAV 48,16,156
TR 34,6,51200
MAV 48,0,148
TR 36,6,50720
TR 38,6,51232
MAV 52,4,148
TR 48,6,59136
s_add_u32 s52, s78, 262144
MAV 52,20,156
buffer_load_dwordx4 v[128:131], v4, s[16:19], s52 offen sc1
MAV 36,20,152
TR 50,6,59648
MAV 36,4,144
TR 52,6,59168
TR 54,6,59680
s_waitcnt lgkmcnt(8)
MAV 40,8,144
TR 40,6,50752
MAV 40,24,152
buffer_load_dwordx4 v19, s[28:31], s54 offen offset:1056 lds
MAV 56,24,156
TR 42,6,51264
s_add_u32 s54, s100, 3145728
MAV 56,8,148
TR 44,6,50784
TR 46,6,51296
MAV 60,12,148
TR 56,6,59200
MAV 60,28,156
buffer_load_dwordx4 v[132:135], v4, s[16:19], s52 offen offset:1024 sc1
MAV 44,28,152
TR 58,6,59712
MAV 44,12,144
TR 60,6,59232
TR 62,6,59744
v_add_u32 v7, s57, v7
v_add_u32 v6, s57, v6
s_sub_u32 s57, 0, s57
s_waitcnt lgkmcnt(8)
MAV 64,32,144
ds_read_b64_tr_b16 a[0:1], v7
s_add_u32 m0, s55, 109824
MAV 64,48,152
buffer_load_dwordx4 v18, s[28:31], s54 offen lds
MAV 80,48,156
TR 2,7,512
MAV 80,32,148
TR 4,7,32
TR 6,7,544
MAV 84,36,148
TR 16,7,8448
s_add_u32 s52, s78, 327680
MAV 84,52,156
buffer_load_dwordx4 v[136:139], v4, s[16:19], s52 offen sc1
MAV 68,52,152
TR 18,7,8960
MAV 68,36,144
TR 20,7,8480
TR 22,7,8992
s_waitcnt lgkmcnt(8)
MAV 72,40,144
TR 8,7,64
MAV 72,56,152
buffer_load_dwordx4 v19, s[28:31], s54 offen offset:1056 lds
MAV 88,56,156
TR 10,7,576
s_add_u32 s54, s101, 3342336
MAV 88,40,148
TR 12,7,96
TR 14,7,608
MAV 92,44,148
TR 24,7,8512
MAV 92,60,156
buffer_load_dwordx4 v[140:143], v4, s[16:19], s52 offen offset:1024 sc1
MAV 76,60,152
TR 26,7,9024
MAV 76,44,144
TR 28,7,8544
TR 30,7,9056
s_waitcnt vmcnt(16) lgkmcnt(8)
s_barrier
MAV 32,0,96
ds_read_b64_tr_b16 a[32:33], v6
s_add_u32 m0, s55, 118272
MAV 32,16,104
buffer_load_dwordx4 v18, s[28:31], s54 offen lds
MAV 48,16,108
TR 34,6,512
MAV 48,0,100
TR 36,6,32
TR 38,6,544
MAV 52,4,100
TR 48,6,8448
s_add_u32 s52, s79, 376832
MAV 52,20,108
buffer_load_dwordx4 v[144:147], v4, s[16:19], s52 offen sc1
MAV 36,20,104
TR 50,6,8960
MAV 36,4,96
TR 52,6,8480
TR 54,6,8992
s_waitcnt lgkmcnt(8)
MAV 40,8,96
TR 40,6,64
MAV 40,24,104
buffer_load_dwordx4 v19, s[28:31], s54 offen offset:1056 lds
MAV 56,24,108
TR 42,6,576
s_add_u32 s54, s101, 3604480
MAV 56,8,100
TR 44,6,96
TR 46,6,608
MAV 60,12,100
TR 56,6,8512
MAV 60,28,108
buffer_load_dwordx4 v[148:151], v4, s[16:19], s52 offen offset:1024 sc1
MAV 44,28,104
TR 58,6,9024
MAV 44,12,96
TR 60,6,8544
TR 62,6,9056
s_waitcnt lgkmcnt(8)
MAV 64,32,96
TR 0,7,16896
s_add_u32 m0, s55, 126720
MAV 64,48,104
buffer_load_dwordx4 v18, s[28:31], s54 offen lds
MAV 80,48,108
TR 2,7,17408
MAV 80,32,100
TR 4,7,16928
TR 6,7,17440
MAV 84,36,100
TR 16,7,25344
s_add_u32 s52, s79, 442368
MAV 84,52,108
buffer_load_dwordx4 v[152:155], v4, s[16:19], s52 offen sc1
MAV 68,52,104
TR 18,7,25856
MAV 68,36,96
TR 20,7,25376
TR 22,7,25888
s_waitcnt lgkmcnt(8)
MAV 72,40,96
TR 8,7,16960
MAV 72,56,104
buffer_load_dwordx4 v19, s[28:31], s54 offen offset:1056 lds
MAV 88,56,108
TR 10,7,17472
s_add_u32 s54, s98, 196608
MAV 88,40,100
TR 12,7,16992
TR 14,7,17504
MAV 92,44,100
TR 24,7,25408
MAV 92,60,108
buffer_load_dwordx4 v[156:159], v4, s[16:19], s52 offen offset:1024 sc1
MAV 76,60,104
TR 26,7,25920
MAV 76,44,96
TR 28,7,25440
TR 30,7,25952
s_waitcnt vmcnt(16) lgkmcnt(8)
s_barrier
MAV 32,0,112
TR 32,6,16896
s_add_u32 m0, s55, 0
MAV 32,16,120
buffer_load_dwordx4 v18, s[28:31], s54 offen lds
MAV 48,16,124
TR 34,6,17408
MAV 48,0,116
TR 36,6,16928
TR 38,6,17440
MAV 52,4,116
TR 48,6,25344
s_add_u32 s52, s76, 491520
MAV 52,20,124
buffer_load_dwordx4 v[96:99], v4, s[16:19], s52 offen sc1
MAV 36,20,120
TR 50,6,25856
MAV 36,4,112
TR 52,6,25376
TR 54,6,25888
s_waitcnt lgkmcnt(8)
MAV 40,8,112
TR 40,6,16960
MAV 40,24,120
buffer_load_dwordx4 v19, s[28:31], s54 offen offset:1056 lds
MAV 56,24,124
TR 42,6,17472
s_add_u32 s54, s99, 655360
MAV 56,8,116
TR 44,6,16992
TR 46,6,17504
MAV 60,12,116
TR 56,6,25408
MAV 60,28,124
buffer_load_dwordx4 v[100:103], v4, s[16:19], s52 offen offset:1024 sc1
MAV 44,28,120
TR 58,6,25920
MAV 44,12,112
TR 60,6,25440
TR 62,6,25952
s_waitcnt lgkmcnt(8)
MAV 64,32,112
TR 0,7,33792
s_add_u32 m0, s55, 8448
MAV 64,48,120
buffer_load_dwordx4 v18, s[28:31], s54 offen lds
MAV 80,48,124
TR 2,7,34304
MAV 80,32,116
TR 4,7,33824
TR 6,7,34336
MAV 84,36,116
TR 16,7,42240
s_add_u32 s52, s76, 557056
MAV 84,52,124
buffer_load_dwordx4 v[104:107], v4, s[16:19], s52 offen sc1
MAV 68,52,120
TR 18,7,42752
MAV 68,36,112
TR 20,7,42272
TR 22,7,42784
s_waitcnt lgkmcnt(8)
MAV 72,40,112
TR 8,7,33856
MAV 72,56,120
buffer_load_dwordx4 v19, s[28:31], s54 offen offset:1056 lds
MAV 88,56,124
TR 10,7,34368
s_add_u32 s54, s100, 1114112
MAV 88,40,116
TR 12,7,33888
TR 14,7,34400
MAV 92,44,116
TR 24,7,42304
MAV 92,60,124
buffer_load_dwordx4 v[108:111], v4, s[16:19], s52 offen offset:1024 sc1
MAV 76,60,120
TR 26,7,42816
MAV 76,44,112
TR 28,7,42336
TR 30,7,42848
s_waitcnt vmcnt(16) lgkmcnt(8)
s_barrier
MAV 32,0,128
TR 32,6,33792
s_add_u32 m0, s55, 16896
MAV 32,16,136
buffer_load_dwordx4 v18, s[28:31], s54 offen lds
MAV 48,16,140
TR 34,6,34304
MAV 48,0,132
TR 36,6,33824
TR 38,6,34336
MAV 52,4,132
TR 48,6,42240
.Lpad39:
s_cbranch_execz .Lnopoll63r
s_add_u32 s52, s77, 606208
MAV 52,20,140
buffer_load_dwordx4 v[112:115], v4, s[16:19], s52 offen sc1
MAV 36,20,136
TR 50,6,42752
MAV 36,4,128
TR 52,6,42272
TR 54,6,42784
s_waitcnt lgkmcnt(8)
MAV 40,8,128
TR 40,6,33856
MAV 40,24,136
buffer_load_dwordx4 v19, s[28:31], s54 offen offset:1056 lds
MAV 56,24,140
TR 42,6,34368
s_add_u32 s54, s101, 1572864
MAV 56,8,132
TR 44,6,33888
TR 46,6,34400
MAV 60,12,132
TR 56,6,42304
MAV 60,28,140
buffer_load_dwordx4 v[116:119], v4, s[16:19], s52 offen offset:1024 sc1
MAV 44,28,136
TR 58,6,42816
MAV 44,12,128
TR 60,6,42336
TR 62,6,42848
s_waitcnt lgkmcnt(8)
MAV 64,32,128
TR 0,7,50688
s_add_u32 m0, s55, 25344
MAV 64,48,136
buffer_load_dwordx4 v18, s[28:31], s54 offen lds
MAV 80,48,140
TR 2,7,51200
MAV 80,32,132
TR 4,7,50720
TR 6,7,51232
MAV 84,36,132
TR 16,7,59136
s_add_u32 s52, s77, 671744
MAV 84,52,140
buffer_load_dwordx4 v[120:123], v4, s[16:19], s52 offen sc1
MAV 68,52,136
TR 18,7,59648
MAV 68,36,128
TR 20,7,59168
TR 22,7,59680
s_waitcnt lgkmcnt(8)
MAV 72,40,128
TR 8,7,50752
MAV 72,56,136
buffer_load_dwordx4 v19, s[28:31], s54 offen offset:1056 lds
MAV 88,56,140
TR 10,7,51264
s_add_u32 s54, s98, 2031616
MAV 88,40,132
TR 12,7,50784
TR 14,7,51296
MAV 92,44,132
TR 24,7,59200
MAV 92,60,140
buffer_load_dwordx4 v[124:127], v4, s[16:19], s52 offen offset:1024 sc1
MAV 76,60,136
TR 26,7,59712
MAV 76,44,128
TR 28,7,59232
TR 30,7,59744
s_waitcnt vmcnt(16) lgkmcnt(8)
s_barrier
MAV 32,0,144
TR 32,6,50688
s_add_u32 m0, s55, 33792
MAV 32,16,152
buffer_load_dwordx4 v18, s[28:31], s54 offen lds
MAV 48,16,156
TR 34,6,51200
MAV 48,0,148
TR 36,6,50720
TR 38,6,51232
MAV 52,4,148
TR 48,6,59136
s_add_u32 s52, s78, 720896
MAV 52,20,156
buffer_load_dwordx4 v[128:131], v4, s[16:19], s52 offen sc1
MAV 36,20,152
TR 50,6,59648
MAV 36,4,144
TR 52,6,59168
TR 54,6,59680
s_waitcnt lgkmcnt(8)
MAV 40,8,144
TR 40,6,50752
MAV 40,24,152
buffer_load_dwordx4 v19, s[28:31], s54 offen offset:1056 lds
MAV 56,24,156
TR 42,6,51264
s_add_u32 s54, s99, 2490368
MAV 56,8,148
TR 44,6,50784
TR 46,6,51296
MAV 60,12,148
TR 56,6,59200
MAV 60,28,156
buffer_load_dwordx4 v[132:135], v4, s[16:19], s52 offen offset:1024 sc1
MAV 44,28,152
TR 58,6,59712
MAV 44,12,144
TR 60,6,59232
TR 62,6,59744
v_add_u32 v7, s57, v7
v_add_u32 v6, s57, v6
s_sub_u32 s57, 0, s57
s_waitcnt lgkmcnt(8)
MAV 64,32,144
ds_read_b64_tr_b16 a[0:1], v6
s_add_u32 m0, s55, 42240
MAV 64,48,152
buffer_load_dwordx4 v18, s[28:31], s54 offen lds
MAV 80,48,156
TR 2,6,512
MAV 80,32,148
TR 4,6,32
TR 6,6,544
MAV 84,36,148
TR 16,6,8448
s_add_u32 s52, s78, 786432
MAV 84,52,156
buffer_load_dwordx4 v[136:139], v4, s[16:19], s52 offen sc1
MAV 68,52,152
TR 18,6,8960
MAV 68,36,144
TR 20,6,8480
TR 22,6,8992
s_waitcnt lgkmcnt(8)
MAV 72,40,144
TR 8,6,64
MAV 72,56,152
buffer_load_dwordx4 v19, s[28:31], s54 offen offset:1056 lds
MAV 88,56,156
TR 10,6,576
s_add_u32 s54, s100, 2949120
MAV 88,40,148
TR 12,6,96
TR 14,6,608
MAV 92,44,148
TR 24,6,8512
MAV 92,60,156
buffer_load_dwordx4 v[140:143], v4, s[16:19], s52 offen offset:1024 sc1
MAV 76,60,152
TR 26,6,9024
MAV 76,44,144
TR 28,6,8544
TR 30,6,9056
s_waitcnt vmcnt(16) lgkmcnt(8)
s_barrier
MAV 64,0,96
TR 32,6,16896
TR 34,6,17408
s_add_u32 m0, s55, 50688
MAV 64,16,104
TR 36,6,16928
buffer_load_dwordx4 v18, s[28:31], s54 offen lds
MAV 80,16,108
TR 38,6,17440
MAV 80,0,100
TR 48,6,25344
buffer_load_dwordx4 v19, s[28:31], s54 offen offset:1056 lds
MAV 84,4,100
TR 50,6,25856
s_add_u32 s54, s101, 3407872
s_add_u32 s52, s79, 835584
MAV 84,20,108
buffer_load_dwordx4 v[144:147], v4, s[16:19], s52 offen sc1
MAV 68,20,104
TR 52,6,25376
TR 54,6,25888
MAV 68,4,96
TR 40,6,16960
s_waitcnt lgkmcnt(9)
MAV 72,8,96
TR 42,6,17472
MAV 72,24,104
TR 44,6,16992
buffer_load_dwordx4 v[148:151], v4, s[16:19], s52 offen offset:1024 sc1
MAV 88,24,108
TR 46,6,17504
s_add_u32 m0, s55, 59136
MAV 88,8,100
TR 56,6,25408
buffer_load_dwordx4 v18, s[28:31], s54 offen lds
MAV 92,12,100
TR 58,6,25920
MAV 92,28,108
TR 60,6,25440
buffer_load_dwordx4 v19, s[28:31], s54 offen offset:1056 lds
MAV 76,28,104
TR 62,6,25952
s_add_u32 s52, s79, 901120
MAV 76,12,96
buffer_load_dwordx4 v[152:155], v4, s[16:19], s52 offen sc1
buffer_load_dwordx4 v[156:159], v4, s[16:19], s52 offen offset:1024 sc1
s_waitcnt vmcnt(16) lgkmcnt(8)
MAV 64,32,112
TR 0,6,33792
s_add_u32 s52, s76, 49152
s_lshl_b32 s70, s2, 10
s_lshl_b32 s62, s3, 7
MAV 64,48,120
buffer_load_dwordx4 v[160:163], v4, s[16:19], s52 offen sc1
s_add_u32 s70, s70, s62
MAV 80,48,124
TR 2,6,34304
s_add_u32 s70, s70, 31457280
MAV 80,32,116
TR 4,6,33824
TR 6,6,34336
s_xor_b32 s71, s70, 1024
MAV 84,36,116
TR 16,6,42240
v_min_u32 v26, 1, v1
MAV 84,52,124
buffer_load_dwordx4 v[164:167], v4, s[16:19], s52 offen offset:1024 sc1
v_lshlrev_b32 v26, 28, v26
MAV 68,52,120
TR 18,6,42752
v_mov_b32 v30, 1
MAV 68,36,112
TR 20,6,42272
TR 22,6,42784
v_mov_b32 v31, 0
s_waitcnt lgkmcnt(8)
MAV 72,40,112
TR 8,6,33856
s_add_u32 s52, s77, 163840
s_lshl_b32 s68, s7, 18
MAV 72,56,120
buffer_load_dwordx4 v[168:171], v4, s[16:19], s52 offen sc1
s_add_u32 s68, s68, 142606336
MAV 88,56,124
TR 10,6,34368
s_xor_b32 s69, s68, 262144
MAV 88,40,116
TR 12,6,33888
TR 14,6,34400
v_and_b32 v2, 1, v1
MAV 92,44,116
TR 24,6,42304
v_lshlrev_b32 v2, 4, v2
MAV 92,60,124
buffer_load_dwordx4 v[172:175], v4, s[16:19], s52 offen offset:1024 sc1
v_mov_b32 v224, 0x3f80
MAV 76,60,120
TR 26,6,42816
v_lshlrev_b32 v2, v2, v224
v_bfe_u32 v224, v1, 2, 2
MAV 76,44,112
TR 28,6,42336
TR 30,6,42848
s_waitcnt vmcnt(12) lgkmcnt(8)
MAV 64,0,128
TR 32,6,50688
s_add_u32 s52, s78, 278528
v_lshrrev_b32 v225, 4, v1
v_cmp_eq_u32 vcc, v224, v225
MAV 64,16,136
buffer_load_dwordx4 v[176:179], v4, s[16:19], s52 offen sc1
v_cndmask_b32 v2, 0, v2, vcc
MAV 80,16,140
TR 34,6,51200
v_and_b32 v224, 2, v1
MAV 80,0,132
TR 36,6,50720
TR 38,6,51232
v_cmp_eq_u32 vcc, 0, v224
MAV 84,4,132
TR 48,6,59136
v_cndmask_b32 v226, 0, v2, vcc
MAV 84,20,140
buffer_load_dwordx4 v[180:183], v4, s[16:19], s52 offen offset:1024 sc1
v_cndmask_b32 v227, v2, 0, vcc
MAV 68,20,136
TR 50,6,59648
v_mov_b32 v224, 0
MAV 68,4,128
TR 52,6,59168
TR 54,6,59680
v_mov_b32 v225, 0
s_waitcnt lgkmcnt(8)
MAV 72,8,128
TR 40,6,50752
s_add_u32 s52, s79, 393216
v_mov_b32 v228, 0
MAV 72,24,136
buffer_load_dwordx4 v[184:187], v4, s[16:19], s52 offen sc1
v_mov_b32 v229, 0
MAV 88,24,140
TR 42,6,51264
s_lshr_b32 s62, s6, 1
MAV 88,8,132
TR 44,6,50784
TR 46,6,51296
s_lshl_b32 s62, s62, 8
MAV 92,12,132
TR 56,6,59200
s_and_b32 s67, s6, 1
MAV 92,28,140
buffer_load_dwordx4 v[188:191], v4, s[16:19], s52 offen offset:1024 sc1
s_add_u32 s62, s62, s67
MAV 76,28,136
TR 58,6,59712
s_lshl_b32 s62, s62, 11
s_lshl_b32 s63, s3, 17
MAV 76,12,128
TR 60,6,59232
TR 62,6,59744
s_waitcnt vmcnt(8) lgkmcnt(8)
s_barrier
v_add_u32 v6, s57, v6
MAV 64,32,144
ds_read_b64_tr_b16 a[0:1], v6
s_add_u32 s52, s76, 507904
s_add_u32 s62, s62, s63
s_lshl_b32 s63, s7, 7
MAV 64,48,152
buffer_load_dwordx4 v[192:195], v4, s[16:19], s52 offen sc1
s_add_u32 s62, s62, s63
MAV 80,48,156
TR 2,6,512
s_mov_b32 s64, 0x8000
MAV 80,32,148
TR 4,6,32
TR 6,6,544
v_lshrrev_b32 v21, 3, v1
MAV 84,36,148
TR 16,6,8448
v_and_b32 v2, 7, v1
MAV 84,52,156
buffer_load_dwordx4 v[196:199], v4, s[16:19], s52 offen offset:1024 sc1
v_lshlrev_b32 v2, 4, v2
MAV 68,52,152
TR 18,6,8960
v_lshl_add_u32 v16, v21, 12, v2
MAV 68,36,144
TR 20,6,8480
TR 22,6,8992
v_add_u32 v16, s62, v16
s_waitcnt lgkmcnt(8)
MAV 72,40,144
TR 8,6,64
s_add_u32 s52, s77, 622592
v_add_u32 v17, 0x10000, v16
MAV 72,56,152
buffer_load_dwordx4 v[200:203], v4, s[16:19], s52 offen sc1
s_mul_i32 s62, s3, 4608
MAV 88,56,156
TR 10,6,576
s_add_u32 s62, s62, 135168
MAV 88,40,148
TR 12,6,96
TR 14,6,608
v_mul_u32_u24 v21, 144, v21
MAV 92,44,148
TR 24,6,8512
v_add3_u32 v21, v21, v2, s62
MAV 92,60,156
buffer_load_dwordx4 v[204:207], v4, s[16:19], s52 offen offset:1024 sc1
v_and_b32 v20, 15, v1
MAV 76,60,152
TR 26,6,9024
v_mul_u32_u24 v20, 144, v20
v_lshrrev_b32 v2, 4, v1
MAV 76,44,144
TR 28,6,8544
TR 30,6,9056
s_waitcnt vmcnt(8) lgkmcnt(8)
MAV 64,0,160
TR 32,6,16896
s_add_u32 s52, s78, 737280
v_lshlrev_b32 v2, 3, v2
v_add3_u32 v20, v20, v2, s62
MAV 64,16,168
buffer_load_dwordx4 v[208:211], v4, s[16:19], s52 offen sc1
v_accvgpr_read_b32 v28, a224
MAV 80,16,172
TR 34,6,17408
v_add_f32 v32, v32, v28
MAV 80,0,164
TR 36,6,16928
TR 38,6,17440
v_accvgpr_read_b32 v29, a225
MAV 84,4,164
TR 48,6,25344
v_add_f32 v33, v33, v29
MAV 84,20,172
buffer_load_dwordx4 v[212:215], v4, s[16:19], s52 offen offset:1024 sc1
v_accvgpr_read_b32 v28, a226
MAV 68,20,168
TR 50,6,25856
v_add_f32 v34, v34, v28
MAV 68,4,160
TR 52,6,25376
TR 54,6,25888
v_accvgpr_read_b32 v29, a227
s_waitcnt lgkmcnt(8)
MAV 72,8,160
TR 40,6,16960
s_add_u32 s52, s79, 851968
v_add_f32 v35, v35, v29
MAV 72,24,168
buffer_load_dwordx4 v[216:219], v4, s[16:19], s52 offen sc1
v_accvgpr_read_b32 v28, a228
MAV 88,24,172
TR 42,6,17472
v_add_f32 v36, v36, v28
MAV 88,8,164
TR 44,6,16992
TR 46,6,17504
v_accvgpr_read_b32 v29, a229
MAV 92,12,164
TR 56,6,25408
v_add_f32 v37, v37, v29
MAV 92,28,172
buffer_load_dwordx4 v[220:223], v4, s[16:19], s52 offen offset:1024 sc1
v_accvgpr_read_b32 v28, a230
MAV 76,28,168
TR 58,6,25920
v_add_f32 v38, v38, v28
v_accvgpr_read_b32 v29, a231
MAV 76,12,160
TR 60,6,25440
TR 62,6,25952
s_waitcnt vmcnt(8) lgkmcnt(8)
MAV 64,32,176
TR 0,6,33792
v_add_f32 v39, v39, v29
MAV 64,48,184
TR 2,6,34304
v_accvgpr_read_b32 v28, a232
v_add_f32 v40, v40, v28
MAV 80,48,188
TR 4,6,33824
MAV 80,32,180
TR 6,6,34336
v_accvgpr_read_b32 v29, a233
v_add_f32 v41, v41, v29
MAV 84,36,180
TR 16,6,42240
v_accvgpr_read_b32 v28, a234
MAV 84,52,188
TR 18,6,42752
v_add_f32 v42, v42, v28
MAV 68,52,184
TR 20,6,42272
v_accvgpr_read_b32 v29, a235
MAV 68,36,176
TR 22,6,42784
v_add_f32 v43, v43, v29
s_waitcnt lgkmcnt(8)
MAV 72,40,176
TR 8,6,33856
MAV 72,56,184
TR 10,6,34368
v_accvgpr_read_b32 v28, a236
v_add_f32 v44, v44, v28
MAV 88,56,188
TR 12,6,33888
v_accvgpr_read_b32 v29, a237
MAV 88,40,180
TR 14,6,34400
v_add_f32 v45, v45, v29
MAV 92,44,180
TR 24,6,42304
v_accvgpr_read_b32 v28, a238
MAV 92,60,188
TR 26,6,42816
v_add_f32 v46, v46, v28
MAV 76,60,184
TR 28,6,42336
v_accvgpr_read_b32 v29, a239
MAV 76,44,176
TR 30,6,42848
v_add_f32 v47, v47, v29
s_waitcnt vmcnt(4) lgkmcnt(8)
MAV 64,0,192
TR 32,6,50688
v_accvgpr_read_b32 v28, a240
MAV 64,16,200
TR 34,6,51200
v_add_f32 v48, v48, v28
v_accvgpr_read_b32 v29, a241
MAV 80,16,204
TR 36,6,50720
MAV 80,0,196
TR 38,6,51232
v_add_f32 v49, v49, v29
v_accvgpr_read_b32 v28, a242
MAV 84,4,196
TR 48,6,59136
v_add_f32 v50, v50, v28
MAV 84,20,204
TR 50,6,59648
v_accvgpr_read_b32 v29, a243
MAV 68,20,200
TR 52,6,59168
v_add_f32 v51, v51, v29
MAV 68,4,192
TR 54,6,59680
v_accvgpr_read_b32 v28, a244
s_waitcnt lgkmcnt(8)
MAV 72,8,192
TR 40,6,50752
MAV 72,24,200
TR 42,6,51264
v_add_f32 v52, v52, v28
v_accvgpr_read_b32 v29, a245
MAV 88,24,204
TR 44,6,50784
v_add_f32 v53, v53, v29
MAV 88,8,196
TR 46,6,51296
v_accvgpr_read_b32 v28, a246
MAV 92,12,196
TR 56,6,59200
v_add_f32 v54, v54, v28
MAV 92,28,204
TR 58,6,59712
v_accvgpr_read_b32 v29, a247
MAV 76,28,200
TR 60,6,59232
v_add_f32 v55, v55, v29
MAV 76,12,192
TR 62,6,59744
v_accvgpr_read_b32 v28, a248
s_waitcnt vmcnt(0) lgkmcnt(8)
MAV 64,32,208
ds_read_b64_tr_b16 a[0:1], v7
v_add_f32 v56, v56, v28
MAV 64,48,216
TR 2,7,512
v_accvgpr_read_b32 v29, a249
MAV 80,48,220
TR 4,7,32
v_add_f32 v57, v57, v29
MAV 80,32,212
TR 6,7,544
v_accvgpr_read_b32 v28, a250
MAV 84,36,212
TR 16,7,8448
v_add_f32 v58, v58, v28
MAV 84,52,220
TR 18,7,8960
v_accvgpr_read_b32 v29, a251
MAV 68,52,216
TR 20,7,8480
v_add_f32 v59, v59, v29
MAV 68,36,208
.Lpad40:
s_cbranch_execz .Lnopoll63r
TR 22,7,8992
s_waitcnt lgkmcnt(8)
MAV 72,40,208
TR 8,7,64
v_accvgpr_read_b32 v28, a252
MAV 72,56,216
TR 10,7,576
v_add_f32 v60, v60, v28
MAV 88,56,220
TR 12,7,96
v_accvgpr_read_b32 v29, a253
MAV 88,40,212
TR 14,7,608
v_add_f32 v61, v61, v29
MAV 92,44,212
TR 24,7,8512
v_accvgpr_read_b32 v28, a254
MAV 92,60,220
TR 26,7,9024
v_add_f32 v62, v62, v28
MAV 76,60,216
TR 28,7,8544
v_accvgpr_read_b32 v29, a255
MAV 76,44,208
TR 30,7,9056
v_add_f32 v63, v63, v29
s_waitcnt lgkmcnt(8)
MAV 32,0,96
TR 32,7,16896
v_cvt_pk_bf16_f32 v232, v64, v65
MAV 32,16,104
TR 34,7,17408
v_cvt_pk_bf16_f32 v233, v66, v67
v_cvt_pk_bf16_f32 v234, v68, v69
MAV 48,16,108
TR 36,7,16928
v_cvt_pk_bf16_f32 v235, v70, v71
MAV 48,0,100
TR 38,7,17440
buffer_store_dwordx4 v[232:235], v4, s[16:19], s69 offen sc1
s_add_u32 s69, s69, 131072
MAV 52,4,100
TR 48,7,25344
v_cvt_pk_bf16_f32 v236, v72, v73
MAV 52,20,108
TR 50,7,25856
v_cvt_pk_bf16_f32 v237, v74, v75
v_cvt_pk_bf16_f32 v238, v76, v77
MAV 36,20,104
TR 52,7,25376
v_cvt_pk_bf16_f32 v239, v78, v79
MAV 36,4,96
TR 54,7,25888
buffer_store_dwordx4 v[236:239], v4, s[16:19], s69 offen sc1
s_waitcnt lgkmcnt(8)
MAV 40,8,96
TR 40,7,16960
s_add_u32 s69, s69, -130048
MAV 40,24,104
TR 42,7,17472
v_cvt_pk_bf16_f32 v240, v80, v81
v_cvt_pk_bf16_f32 v241, v82, v83
MAV 56,24,108
TR 44,7,16992
v_cvt_pk_bf16_f32 v242, v84, v85
MAV 56,8,100
TR 46,7,17504
v_cvt_pk_bf16_f32 v243, v86, v87
buffer_store_dwordx4 v[240:243], v4, s[16:19], s69 offen sc1
MAV 60,12,100
TR 56,7,25408
s_add_u32 s69, s69, 131072
MAV 60,28,108
TR 58,7,25920
v_cvt_pk_bf16_f32 v244, v88, v89
v_cvt_pk_bf16_f32 v245, v90, v91
MAV 44,28,104
TR 60,7,25440
v_cvt_pk_bf16_f32 v246, v92, v93
MAV 44,12,96
TR 62,7,25952
v_cvt_pk_bf16_f32 v247, v94, v95
buffer_store_dwordx4 v[244:247], v4, s[16:19], s69 offen sc1
s_waitcnt lgkmcnt(8)
MAV 32,32,112
TR 0,7,33792
MAV 32,48,120
TR 2,7,34304
MAV 48,48,124
TR 4,7,33824
MAV 48,32,116
TR 6,7,34336
MAV 52,36,116
TR 16,7,42240
MAV 52,52,124
TR 18,7,42752
MAV 36,52,120
TR 20,7,42272
MAV 36,36,112
TR 22,7,42784
s_waitcnt lgkmcnt(8)
MAV 40,40,112
TR 8,7,33856
MAV 40,56,120
TR 10,7,34368
MAV 56,56,124
TR 12,7,33888
MAV 56,40,116
TR 14,7,34400
MAV 60,44,116
TR 24,7,42304
MAV 60,60,124
TR 26,7,42816
MAV 44,60,120
TR 28,7,42336
MAV 44,44,112
TR 30,7,42848
s_waitcnt lgkmcnt(8)
MAV 32,0,128
TR 32,7,50688
MAV 32,16,136
TR 34,7,51200
MAV 48,16,140
TR 36,7,50720
MAV 48,0,132
TR 38,7,51232
MAV 52,4,132
TR 48,7,59136
MAV 52,20,140
TR 50,7,59648
MAV 36,20,136
TR 52,7,59168
MAV 36,4,128
TR 54,7,59680
s_waitcnt lgkmcnt(8)
MAV 40,8,128
TR 40,7,50752
MAV 40,24,136
TR 42,7,51264
MAV 56,24,140
TR 44,7,50784
MAV 56,8,132
TR 46,7,51296
MAV 60,12,132
TR 56,7,59200
MAV 60,28,140
TR 58,7,59712
MAV 44,28,136
TR 60,7,59232
MAV 44,12,128
TR 62,7,59744
v_add_u32 v7, s57, v7
s_waitcnt lgkmcnt(8)
MAV 32,32,144
ds_read_b64_tr_b16 a[0:1], v7
MAV 32,48,152
s_waitcnt vmcnt(0)
buffer_atomic_add v30, v26, s[16:19], s71 offen
MAV 48,48,156
TR 2,7,512
MAV 48,32,148
TR 4,7,32
TR 6,7,544
MAV 52,36,148
MAV 52,52,156
TR 16,7,8448
TR 18,7,8960
MAV 36,52,152
TR 20,7,8480
MAV 36,36,144
s_waitcnt lgkmcnt(7)
MAV 40,40,144
TR 22,7,8992
MAV 40,56,152
TR 8,7,64
TR 10,7,576
MAV 56,56,156
MAV 56,40,148
TR 12,7,96
TR 14,7,608
MAV 60,44,148
TR 24,7,8512
MAV 60,60,156
TR 26,7,9024
MAV 44,60,152
TR 28,7,8544
MAV 44,44,144
TR 30,7,9056
s_waitcnt lgkmcnt(8)
MAV 32,0,160
TR 32,7,16896
MAV 32,16,168
buffer_atomic_add v31, v26, s[16:19], s70 offen sc0
MAV 48,16,172
TR 34,7,17408
MAV 48,0,164
TR 36,7,16928
TR 38,7,17440
MAV 52,4,164
MAV 52,20,172
TR 48,7,25344
TR 50,7,25856
MAV 36,20,168
TR 52,7,25376
MAV 36,4,160
s_waitcnt lgkmcnt(7)
MAV 40,8,160
TR 54,7,25888
MAV 40,24,168
TR 40,7,16960
TR 42,7,17472
MAV 56,24,172
MAV 56,8,164
TR 44,7,16992
TR 46,7,17504
MAV 60,12,164
TR 56,7,25408
MAV 60,28,172
TR 58,7,25920
MAV 44,28,168
TR 60,7,25440
MAV 44,12,160
TR 62,7,25952
s_waitcnt lgkmcnt(8)
MAV 32,32,176
TR 0,7,33792
MAV 32,48,184
TR 2,7,34304
MAV 48,48,188
TR 4,7,33824
MAV 48,32,180
TR 6,7,34336
MAV 52,36,180
TR 16,7,42240
MAV 52,52,188
TR 18,7,42752
MAV 36,52,184
TR 20,7,42272
MAV 36,36,176
TR 22,7,42784
s_waitcnt lgkmcnt(8)
MAV 40,40,176
TR 8,7,33856
MAV 40,56,184
TR 10,7,34368
MAV 56,56,188
TR 12,7,33888
MAV 56,40,180
TR 14,7,34400
MAV 60,44,180
TR 24,7,42304
MAV 60,60,188
TR 26,7,42816
MAV 44,60,184
TR 28,7,42336
MAV 44,44,176
TR 30,7,42848
s_waitcnt vmcnt(0)
v_cmp_le_u32 vcc, 2, v31
s_nop 0
s_cbranch_vccnz .Lxs68
s_mov_b32 s15, 0
.Lxs68l:
v_mov_b32 v31, 0
buffer_atomic_add v31, v26, s[16:19], s70 offen sc0
s_add_u32 s15, s15, 1
s_cmp_gt_u32 s15, 100000
s_waitcnt vmcnt(0)
s_cbranch_scc1 .Lxs68
v_cmp_le_u32 vcc, 2, v31
s_nop 0
s_cbranch_vccz .Lxs68l
.Lxs68:
s_waitcnt lgkmcnt(8)
MAV 32,0,192
TR 32,7,50688
MAV 32,16,200
buffer_load_dwordx4 v[232:235], v4, s[16:19], s68 offen sc1
MAV 48,16,204
TR 34,7,51200
s_add_u32 s68, s68, 131072
MAV 48,0,196
TR 36,7,50720
TR 38,7,51232
MAV 52,4,196
TR 48,7,59136
MAV 52,20,204
buffer_load_dwordx4 v[236:239], v4, s[16:19], s68 offen sc1
MAV 36,20,200
TR 50,7,59648
s_add_u32 s68, s68, -130048
MAV 36,4,192
TR 52,7,59168
TR 54,7,59680
s_waitcnt lgkmcnt(8)
MAV 40,8,192
TR 40,7,50752
MAV 40,24,200
buffer_load_dwordx4 v[240:243], v4, s[16:19], s68 offen sc1
MAV 56,24,204
TR 42,7,51264
s_add_u32 s68, s68, 131072
MAV 56,8,196
TR 44,7,50784
TR 46,7,51296
MAV 60,12,196
TR 56,7,59200
MAV 60,28,204
buffer_load_dwordx4 v[244:247], v4, s[16:19], s68 offen sc1
MAV 44,28,200
TR 58,7,59712
MAV 44,12,192
TR 60,7,59232
TR 62,7,59744
s_waitcnt lgkmcnt(8)
MAV 32,32,208
MAV 32,48,216
MAV 48,48,220
MAV 48,32,212
MAV 52,36,212
MAV 52,52,220
MAV 36,52,216
MAV 36,36,208
s_waitcnt lgkmcnt(0)
MAV 40,40,208
MAV 40,56,216
MAV 56,56,220
MAV 56,40,212
MAV 60,44,212
MAV 60,60,220
MAV 44,60,216
MAV 44,44,208
s_waitcnt vmcnt(3)
v_mfma_f32_16x16x32_bf16 v[32:35], v[226:229], v[232:235], v[32:35]
v_mfma_f32_16x16x32_bf16 v[36:39], v[224:227], v[232:235], v[36:39]
s_waitcnt vmcnt(2)
v_mfma_f32_16x16x32_bf16 v[40:43], v[226:229], v[236:239], v[40:43]
v_mfma_f32_16x16x32_bf16 v[44:47], v[224:227], v[236:239], v[44:47]
s_waitcnt vmcnt(1)
v_mfma_f32_16x16x32_bf16 v[48:51], v[226:229], v[240:243], v[48:51]
v_mfma_f32_16x16x32_bf16 v[52:55], v[224:227], v[240:243], v[52:55]
s_waitcnt vmcnt(0)
v_mfma_f32_16x16x32_bf16 v[56:59], v[226:229], v[244:247], v[56:59]
v_cvt_pk_bf16_f32 v128, v32, v33
v_mfma_f32_16x16x32_bf16 v[60:63], v[224:227], v[244:247], v[60:63]
v_cvt_pk_bf16_f32 v129, v34, v35
ds_write_b64 v20, v[128:129]
v_cvt_pk_bf16_f32 v130, v36, v37
v_cvt_pk_bf16_f32 v131, v38, v39
ds_write_b64 v20, v[130:131] offset:32
v_cvt_pk_bf16_f32 v132, v40, v41
v_cvt_pk_bf16_f32 v133, v42, v43
ds_write_b64 v20, v[132:133] offset:64
v_cvt_pk_bf16_f32 v134, v44, v45
v_cvt_pk_bf16_f32 v135, v46, v47
ds_write_b64 v20, v[134:135] offset:96
ds_read_b128 v[144:147], v21
ds_read_b128 v[148:151], v21 offset:1152
v_cvt_pk_bf16_f32 v136, v48, v49
v_cvt_pk_bf16_f32 v137, v50, v51
ds_write_b64 v20, v[136:137] offset:2304
v_cvt_pk_bf16_f32 v138, v52, v53
v_cvt_pk_bf16_f32 v139, v54, v55
ds_write_b64 v20, v[138:139] offset:2336
v_cvt_pk_bf16_f32 v140, v56, v57
v_cvt_pk_bf16_f32 v141, v58, v59
ds_write_b64 v20, v[140:141] offset:2368
v_cvt_pk_bf16_f32 v142, v60, v61
v_cvt_pk_bf16_f32 v143, v62, v63
ds_write_b64 v20, v[142:143] offset:2400
ds_read_b128 v[152:155], v21 offset:2304
ds_read_b128 v[156:159], v21 offset:3456
s_waitcnt lgkmcnt(7)
buffer_store_dwordx4 v[144:147], v16, s[36:39], 0 offen sc1
s_waitcnt lgkmcnt(6)
buffer_store_dwordx4 v[148:151], v16, s[36:39], s64 offen sc1
s_waitcnt lgkmcnt(1)
buffer_store_dwordx4 v[152:155], v17, s[36:39], 0 offen sc1
s_waitcnt lgkmcnt(0)
buffer_store_dwordx4 v[156:159], v17, s[36:39], s64 offen sc1
s_nop 1
.Lend:
s_endpgm
.Lsp67:
s_mov_b32 s15, 0
.Lsp67l:
v_mov_b32 v25, 0
buffer_atomic_add v25, v22, s[16:19], s73 offen sc0
s_add_u32 s15, s15, 1
s_cmp_gt_u32 s15, 100000
s_waitcnt vmcnt(0)
s_cbranch_scc1 .Lsp67b
v_cmp_gt_u32 vcc, v23, v25
s_nop 0
s_cbranch_vccnz .Lsp67l
s_branch .Lsp67b
.section .rodata,"a"
.p2align 6
.amdhsa_kernel interleave_layers__sliding_local_dilated__swiglu_ffn__prompt_kernel
  .amdhsa_next_free_vgpr 512
  .amdhsa_next_free_sgpr 102
  .amdhsa_accum_offset 256
  .amdhsa_group_segment_fixed_size 0
  .amdhsa_kernarg_size 80
  .amdhsa_user_sgpr_count 2
  .amdhsa_user_sgpr_kernarg_segment_ptr 1
  .amdhsa_system_sgpr_workgroup_id_x 1
  .amdhsa_float_denorm_mode_32 3
.end_amdhsa_kernel
```

```asm
; @launch grid=(256,1,1) block=(256,1,1) lds=162560
.amdgcn_target "amdgcn-amd-amdhsa--gfx950"
.macro MAA d,a,b
v_mfma_f32_16x16x32_bf16 v[\d:\d+3], a[\a:\a+3], a[\b:\b+3], v[\d:\d+3]
.endm
.macro MAV d,a,b
v_mfma_f32_16x16x32_bf16 v[\d:\d+3], a[\a:\a+3], v[\b:\b+3], v[\d:\d+3]
.endm
.macro TR d,v,o
ds_read_b64_tr_b16 a[\d:\d+1], v\v offset:\o
.endm
.macro RD d,v,o
ds_read_b128 a[\d:\d+3], v\v offset:\o
.endm
.text
.globl interleave_layers__sliding_local_dilated__swiglu_ffn__prompt_kernel
.p2align 8
.type interleave_layers__sliding_local_dilated__swiglu_ffn__prompt_kernel,@function
interleave_layers__sliding_local_dilated__swiglu_ffn__prompt_kernel:
s_load_dwordx4 s[68:71], s[0:1], 0
s_load_dwordx2 s[72:73], s[0:1], 16
s_load_dwordx8 s[76:83], s[0:1], 32
s_load_dwordx4 s[84:87], s[0:1], 64
s_cmp_lt_u32 s2, 256
s_cbranch_scc1 .Lgo
s_endpgm
.p2align 12
.Lgo:
v_lshrrev_b32 v2, 6, v0
v_and_b32 v1, 63, v0
v_readfirstlane_b32 s3, v2
s_and_b32 s4, s2, 7
s_lshr_b32 s5, s2, 3
s_lshr_b32 s8, s4, 2
s_lshl_b32 s8, s8, 3
s_and_b32 s62, s5, 7
s_add_u32 s8, s8, s62
s_and_b32 s9, s4, 3
s_lshl_b32 s9, s9, 2
s_lshr_b32 s62, s5, 3
s_add_u32 s9, s9, s62
s_and_b32 s48, s3, 1
s_lshr_b32 s49, s3, 1
s_lshl_b32 s50, s8, 3
s_sub_u32 s50, s50, 9
s_cmp_lt_u32 s8, 2
s_cselect_b32 s50, 7, s50
s_lshr_b32 s6, s4, 1
s_lshl_b32 s6, s6, 2
s_and_b32 s62, s5, 3
s_add_u32 s6, s6, s62
s_and_b32 s7, s4, 1
s_lshr_b32 s62, s5, 2
s_lshl_b32 s62, s62, 1
s_add_u32 s7, s7, s62
s_lshr_b32 s62, s6, 1
s_lshl_b32 s62, s62, 8
s_and_b32 s63, s6, 1
s_add_u32 s62, s62, s63
s_lshl_b32 s63, s3, 6
s_add_u32 s62, s62, s63
s_lshl_b32 s62, s62, 11
s_lshl_b32 s63, s7, 7
s_add_u32 s62, s62, s63
v_and_b32 v228, 15, v1
v_lshlrev_b32 v228, 12, v228
v_bfe_u32 v2, v1, 4, 1
v_lshl_add_u32 v228, v2, 5, v228
v_bfe_u32 v2, v1, 5, 1
v_lshl_add_u32 v228, v2, 4, v228
v_add_u32 v228, s62, v228
v_add_u32 v229, 0x10000, v228
s_sub_u32 s64, s3, 1
s_max_i32 s64, s64, 0
s_lshl_b32 s64, s64, 11
s_lshl_b32 s66, s9, 7
s_add_u32 s66, s66, s64
s_cmp_eq_u32 s3, 1
s_cselect_b32 s66, 8388608, s66
s_mul_i32 s65, s8, 122880
s_add_u32 s65, s65, s66
v_lshrrev_b32 v9, 1, v1
v_min_u32 v9, 19, v9
v_mul_u32_u24 v9, 6144, v9
s_xor_b32 s14, s3, 3
s_lshl_b32 s14, s14, 8
s_add_u32 s14, s14, s2
v_lshlrev_b32 v230, 4, v1
v_mov_b64 v[224:225], 0
v_mov_b64 v[226:227], 0
s_waitcnt lgkmcnt(0)
s_mov_b32 s16, s86
s_mov_b32 s17, s87
s_mov_b32 s18, 268435456
s_mov_b32 s19, 0x20000
s_mov_b32 s36, s68
s_mov_b32 s37, s69
s_mov_b32 s38, 4194304
s_mov_b32 s39, 0x20000
s_cmp_ge_u32 s14, 16
s_cbranch_scc1 .Lz3
s_lshl_b32 s62, s2, 13
s_add_u32 s62, s62, 30408704
s_add_u32 s63, s62, 4096
buffer_store_dwordx4 v[224:227], v230, s[16:19], s62 offen sc1
buffer_store_dwordx4 v[224:227], v230, s[16:19], s62 offen offset:1024 sc1
buffer_store_dwordx4 v[224:227], v230, s[16:19], s62 offen offset:2048 sc1
buffer_store_dwordx4 v[224:227], v230, s[16:19], s62 offen offset:3072 sc1
buffer_store_dwordx4 v[224:227], v230, s[16:19], s63 offen sc1
buffer_store_dwordx4 v[224:227], v230, s[16:19], s63 offen offset:1024 sc1
buffer_store_dwordx4 v[224:227], v230, s[16:19], s63 offen offset:2048 sc1
buffer_store_dwordx4 v[224:227], v230, s[16:19], s63 offen offset:3072 sc1
.Lz3:
buffer_load_dwordx4 v[164:167], v228, s[36:39], 0 offen
buffer_load_dwordx4 v[168:171], v228, s[36:39], 0 offen offset:64
buffer_load_dwordx4 v[172:175], v229, s[36:39], 0 offen
buffer_load_dwordx4 v[176:179], v229, s[36:39], 0 offen offset:64
s_mov_b32 s20, s70
s_mov_b32 s21, s71
s_mov_b32 s22, 6291456
s_mov_b32 s23, 0x20000
buffer_load_dword v58, v9, s[20:23], s65 offen
s_mov_b32 s40, s84
s_mov_b32 s41, s85
s_mov_b32 s42, 256
s_mov_b32 s43, 0x20000
s_getpc_b64 s[62:63]
.Lpc:
s_lshl_b32 s64, s5, 12
v_lshrrev_b32 v59, 3, v0
v_lshl_add_u32 v59, v59, 7, s64
v_add_u32 v2, 0x20000, v59
v_min_u32 v2, .Lend-.Lpc, v2
v_min_u32 v59, .Lend-.Lpc, v59
global_load_dword v59, v59, s[62:63]
global_load_dword v58, v2, s[62:63]
s_mov_b32 s24, s72
s_mov_b32 s25, s73
s_mov_b32 s26, 2097152
s_mov_b32 s27, 0x20000
s_mov_b32 s28, s80
s_mov_b32 s29, s81
s_mov_b32 s30, 7340032
s_mov_b32 s31, 0x20000
s_mov_b32 s0, s82
s_mov_b32 s1, s83
s_mov_b32 s32, s76
s_mov_b32 s33, s77
s_mov_b32 s34, 7340032
s_mov_b32 s35, 0x20000
s_mov_b32 s80, s78
s_mov_b32 s81, s79
s_mov_b32 s82, 7340032
s_mov_b32 s83, 0x20000
s_lshr_b32 s10, s4, 2
s_lshl_b32 s10, s10, 2
s_and_b32 s62, s5, 3
s_add_u32 s10, s10, s62
s_and_b32 s11, s4, 3
s_lshl_b32 s11, s11, 3
s_lshr_b32 s62, s5, 2
s_add_u32 s11, s11, s62
s_and_b32 s12, s11, 1
s_lshr_b32 s13, s11, 1
s_mul_i32 s51, s13, 448
s_mul_i32 s62, s12, 192
s_add_u32 s51, s51, s62
s_lshl_b32 s62, s6, 3
s_lshr_b32 s84, s62, 4
s_lshl_b32 s84, s84, 14
s_and_b32 s62, s62, 15
s_lshl_b32 s62, s62, 10
s_add_u32 s84, s84, s62
s_lshl_b32 s62, s8, 3
s_lshr_b32 s85, s62, 4
s_lshl_b32 s85, s85, 14
s_and_b32 s62, s62, 15
s_lshl_b32 s62, s62, 10
s_add_u32 s85, s85, s62
s_lshl_b32 s62, s50, 0
s_lshr_b32 s86, s62, 4
s_lshl_b32 s86, s86, 14
s_and_b32 s62, s62, 15
s_lshl_b32 s62, s62, 10
s_add_u32 s86, s86, s62
s_mul_i32 s62, s8, 393216
s_add_u32 s62, s62, s66
v_mul_u32_u24 v14, 6144, v1
v_add_u32 v14, s62, v14
s_lshl_b32 s62, s8, 4
s_add_u32 s62, s62, s9
s_lshl_b32 s62, s62, 2
s_add_u32 s62, s62, s3
s_mul_i32 s62, s62, 6656
v_min_u32 v15, 51, v1
v_lshl_add_u32 v15, v15, 7, s62
s_sub_u32 s63, s8, 4
s_lshl_b32 s64, s8, 1
s_add_u32 s64, s64, 1
s_cmp_lt_u32 s8, 5
s_cselect_b64 vcc, -1, 0
s_cselect_b32 s46, s64, s63
v_cndmask_b32 v14, v14, v15, vcc
s_lshl_b32 s62, s2, 1
s_add_u32 s62, s62, s48
s_mul_i32 s62, s62, 5376
v_min_u32 v16, 41, v1
v_lshl_add_u32 v16, v16, 7, s62
s_cmp_lt_u32 s46, 6
s_cselect_b64 vcc, -1, 0
v_cndmask_b32 v15, v14, v16, vcc
v_cndmask_b32 v14, v16, v14, vcc
s_cmp_lt_u32 s3, 2
s_cselect_b32 s65, s32, s80
s_cselect_b32 s66, s33, s81
s_cselect_b32 s67, s34, s82
s_cmp_lt_u32 s8, 5
s_cselect_b32 s62, s24, s20
s_cselect_b32 s63, s25, s21
s_cselect_b32 s64, s26, s22
s_sub_u32 s47, s46, 6
s_cmp_lt_u32 s46, 6
s_cselect_b32 s47, s46, s47
s_cselect_b32 s76, s62, s65
s_cselect_b32 s98, s65, s62
s_cselect_b32 s77, s63, s66
s_cselect_b32 s99, s66, s63
s_cselect_b32 s78, s64, s67
s_cselect_b32 s100, s67, s64
s_mov_b32 s79, 0x20000
v_bfe_u32 v18, v1, 3, 1
v_bfe_u32 v2, v1, 5, 1
v_lshl_add_u32 v18, v2, 2, v18
v_and_b32 v2, 16, v1
v_add_u32 v18, v18, v2
s_lshl_b32 s62, s49, 2
s_add_u32 s62, s62, s48
s_lshl_b32 s62, s62, 1
v_add_u32 v18, s62, v18
v_mul_u32_u24 v18, 6144, v18
v_and_b32 v2, 7, v1
v_lshl_add_u32 v18, v2, 4, v18
s_lshl_b32 s62, s9, 7
v_add_u32 v18, s62, v18
v_add_u32 v19, 1024, v18
v_add_u32 v20, 2048, v18
s_mul_i32 s59, s3, 3104
s_mov_b32 s58, 0
s_lshr_b32 s62, s8, 1
s_lshl_b32 s62, s62, 8
s_and_b32 s67, s8, 1
s_add_u32 s62, s62, s67
s_lshl_b32 s62, s62, 11
s_lshl_b32 s63, s3, 17
s_add_u32 s62, s62, s63
v_lshrrev_b32 v2, 4, v1
v_xor_b32 v2, v2, v1
v_and_b32 v2, 7, v2
v_lshlrev_b32 v2, 4, v2
v_lshrrev_b32 v21, 3, v1
v_lshl_add_u32 v21, v21, 12, v2
v_add_u32 v21, s62, v21
v_xor_b32 v28, 64, v21
v_add_u32 v28, 31744, v28
s_lshr_b32 s63, s50, 3
s_lshr_b32 s62, s63, 1
s_lshl_b32 s62, s62, 8
s_and_b32 s67, s63, 1
s_add_u32 s62, s62, s67
s_lshl_b32 s62, s62, 11
s_lshl_b32 s63, s3, 14
s_add_u32 s62, s62, s63
s_add_u32 s62, s62, 456704
s_lshl_b32 s63, s3, 5
v_and_b32 v2, 31, v1
v_lshlrev_b32 v2, 2, v2
v_xor_b32 v2, s63, v2
v_lshrrev_b32 v22, 5, v1
v_lshl_add_u32 v22, v22, 12, v2
v_add_u32 v22, s62, v22
v_xor_b32 v29, 16, v22
v_add_u32 v29, -57344, v29
s_mov_b32 s52, 0
s_mov_b32 s53, 65536
s_mul_i32 s55, s3, 4608
s_mov_b32 s54, 0
s_mul_i32 s56, s3, 3104
v_bfe_u32 v24, v1, 1, 3
v_lshrrev_b32 v2, 4, v1
v_xor_b32 v2, v2, v24
v_lshlrev_b32 v2, 4, v2
v_and_b32 v23, 15, v1
v_lshl_add_u32 v23, v23, 7, v2
s_mul_i32 s62, s48, 9216
v_add_u32 v23, s62, v23
v_xor_b32 v30, 64, v23
v_mul_u32_u24 v24, 2304, v24
v_add_u32 v24, v24, v2
v_and_b32 v2, 1, v1
v_lshl_add_u32 v24, v2, 7, v24
v_add_u32 v24, 2048, v24
v_xor_b32 v31, 64, v24
v_and_b32 v2, 15, v1
v_cmp_eq_u32 vcc, 0, v2
v_mov_b32 v2, 18432
s_nop 0
v_cndmask_b32 v24, v24, v2, vcc
v_cndmask_b32 v31, v31, v2, vcc
v_bfe_u32 v25, v1, 3, 2
v_mul_u32_u24 v25, 3104, v25
v_bfe_u32 v2, v1, 2, 1
v_lshl_add_u32 v25, v2, 7, v25
v_bfe_u32 v2, v1, 5, 1
v_lshl_add_u32 v25, v2, 8, v25
v_and_b32 v2, 3, v1
v_lshl_add_u32 v25, v2, 3, v25
s_lshl_b32 s62, s49, 6
s_add_u32 s62, s62, 73984
v_add_u32 v25, s62, v25
s_lshl_b32 s62, s8, 1
s_add_u32 s62, s62, s3
s_lshr_b32 s63, s50, 2
s_cmp_lt_u32 s3, 2
s_cselect_b32 s62, s62, s63
s_lshl_b32 s62, s62, 13
s_cmp_eq_u32 s3, 3
s_cselect_b32 s62, 268435456, s62
v_lshl_add_u32 v26, v1, 4, s62
s_mul_i32 s59, s3, 2080
s_and_b32 s87, s6, 3
s_lshl_b32 s87, s87, 17
v_bfe_u32 v5, v1, 3, 1
v_lshrrev_b32 v2, 4, v1
v_lshl_add_u32 v5, v2, 3, v5
s_lshl_b32 s62, s3, 1
v_add_u32 v5, s62, v5
v_mul_u32_u24 v5, 2048, v5
v_and_b32 v2, 7, v1
v_lshl_add_u32 v5, v2, 4, v5
s_lshl_b32 s62, s7, 7
v_add_u32 v5, s62, v5
v_add_u32 v6, 64512, v5
s_lshl_b32 s62, s6, 10
s_add_u32 s62, s62, 30408704
s_lshl_b32 s64, s8, 10
s_add_u32 s64, s64, 30408704
s_lshr_b32 s67, s9, 1
s_and_b32 s67, s67, 3
s_lshl_b32 s67, s67, 7
s_add_u32 s64, s64, s67
s_lshr_b32 s65, s50, 3
s_lshl_b32 s65, s65, 10
s_add_u32 s65, s65, 30408704
s_lshr_b32 s67, s9, 1
s_and_b32 s67, s67, 3
s_lshl_b32 s67, s67, 7
s_add_u32 s65, s65, s67
v_mov_b32 v2, 268435456
v_cmp_eq_u32 vcc, 65, v0
v_mov_b32 v33, s65
s_nop 0
v_cndmask_b32 v33, v2, v33, vcc
v_cndmask_b32 v36, 0, 16, vcc
v_cmp_eq_u32 vcc, 64, v0
v_mov_b32 v32, s64
s_nop 0
v_cndmask_b32 v33, v33, v32, vcc
v_lshl_add_u32 v32, v1, 7, s62
v_cndmask_b32 v34, v2, 0, vcc
v_cndmask_b32 v35, 0, 16, vcc
v_cndmask_b32 v36, v36, 16, vcc
v_lshrrev_b32 v37, 3, v0
v_cmp_eq_u32 vcc, 8, v37
s_nop 1
v_cndmask_b32 v32, v2, v32, vcc
v_mov_b32 v38, 1
v_lshrrev_b32 v2, 4, v1
v_lshlrev_b32 v2, 2, v2
v_and_b32 v13, 15, v1
v_sub_u32 v2, v13, v2
v_mov_b32 v13, 0xff61b1e6
v_subrev_u32 v54, 0, v2
v_cmp_gt_u32 vcc, 8, v54
s_nop 1
v_cndmask_b32 v50, v13, 0, vcc
v_cmp_gt_i32 vcc, -8, v54
s_nop 1
v_cndmask_b32 v46, v13, 0, vcc
v_subrev_u32 v54, 1, v2
v_cmp_gt_u32 vcc, 8, v54
s_nop 1
v_cndmask_b32 v51, v13, 0, vcc
v_cmp_gt_i32 vcc, -8, v54
s_nop 1
v_cndmask_b32 v47, v13, 0, vcc
v_subrev_u32 v54, 2, v2
v_cmp_gt_u32 vcc, 8, v54
s_nop 1
v_cndmask_b32 v52, v13, 0, vcc
v_cmp_gt_i32 vcc, -8, v54
s_nop 1
v_cndmask_b32 v48, v13, 0, vcc
v_subrev_u32 v54, 3, v2
v_cmp_gt_u32 vcc, 8, v54
s_nop 1
v_cndmask_b32 v53, v13, 0, vcc
v_cmp_gt_i32 vcc, -8, v54
s_nop 1
v_cndmask_b32 v49, v13, 0, vcc
s_cmp_lt_u32 s8, 2
s_cselect_b64 vcc, -1, 0
v_cndmask_b32 v54, v46, v13, vcc
v_cndmask_b32 v55, v47, v13, vcc
v_cndmask_b32 v56, v48, v13, vcc
v_cndmask_b32 v57, v49, v13, vcc
s_mov_b32 s75, 29360128
v_and_b32 v10, 15, v1
v_lshlrev_b32 v12, 2, v10
v_lshlrev_b32 v10, 4, v10
v_add_u32 v10, 152576, v10
v_lshrrev_b32 v11, 4, v1
v_lshlrev_b32 v11, 4, v11
s_lshl_b32 s62, s49, 7
s_add_u32 s62, s62, 158720
v_add_u32 v12, s62, v12
v_add_u32 v13, s62, v11
v_add_u32 v11, 156672, v11
s_lshl_b32 s62, s3, 11
s_add_u32 s62, s62, 143360
v_lshl_add_u32 v8, v1, 4, s62
v_xor_b32 v9, 2048, v8
v_mov_b32 v248, 0x3f803f80
v_mov_b32 v249, 0x3f803f80
v_mov_b32 v250, 0x3f803f80
v_mov_b32 v251, 0x3f803f80
s_mul_i32 s62, s3, 18496
s_add_u32 s62, s62, 18432
v_mov_b32 v2, s62
ds_write_b128 v2, v[248:251]
v_and_b32 v7, 31, v1
v_lshrrev_b32 v2, 5, v1
v_lshl_add_u32 v7, v7, 1, v2
v_and_b32 v2, 0xc0, v0
v_add_u32 v7, v7, v2
v_lshlrev_b32 v17, 2, v7
v_add_u32 v17, 156672, v17
v_lshlrev_b32 v7, 4, v7
v_add_u32 v7, 152576, v7
s_lshl_b32 s74, s9, 1
s_add_u32 s74, s74, s49
s_lshl_b32 s74, s74, 17
s_add_u32 s74, s74, s85
s_lshl_b32 s63, s48, 12
s_add_u32 s74, s74, s63
s_add_u32 s74, s74, 4194304
s_mov_b32 s62, 0
v_lshl_add_u32 v4, v1, 4, s62
v_lshrrev_b32 v2, 3, v1
v_cmp_eq_u32 vcc, 3, v2
v_add_u32 v2, 67108480, v4
s_nop 0
v_cndmask_b32 v4, v4, v2, vcc
s_mov_b64 exec, 0
s_cmp_eq_u32 s3, 2
s_cbranch_scc1 .Lpad1
s_cmp_eq_u32 s3, 3
s_cbranch_scc1 .Lpad2
s_cmp_eq_u32 s3, 1
s_cbranch_scc1 .Lpad4
s_branch .Lpad3
.Lt0r:
s_mov_b64 exec, -1
s_add_u32 m0, s55, 0
s_nop 0
buffer_load_dwordx4 v21, s[36:39], s52 offen lds
buffer_load_dwordx4 v28, s[36:39], s52 offen offset:1024 lds
buffer_load_dword v22, s[36:39], s52 offen offset:2048 lds
s_add_u32 s52, s52, 128
s_add_u32 m0, s55, 2304
s_nop 0
buffer_load_dwordx4 v21, s[36:39], s53 offen lds
buffer_load_dwordx4 v28, s[36:39], s53 offen offset:1024 lds
buffer_load_dword v29, s[36:39], s53 offen offset:2048 lds
s_add_u32 s53, s53, 128
s_add_u32 m0, s56, 123648
s_nop 0
buffer_load_dwordx4 v18, s[20:23], s54 offen lds
buffer_load_dwordx4 v19, s[20:23], s54 offen offset:1024 lds
buffer_load_dwordx4 v20, s[20:23], s54 offen offset:2048 lds
s_add_u32 s54, s54, 196608
s_add_u32 m0, s56, 136064
s_nop 0
buffer_load_dwordx4 v18, s[20:23], s54 offen lds
buffer_load_dwordx4 v19, s[20:23], s54 offen offset:1024 lds
buffer_load_dwordx4 v20, s[20:23], s54 offen offset:2048 lds
s_add_u32 s54, s54, 196608
s_cmp_eq_u32 s48, 1
s_cbranch_scc1 .Lqkv1
s_cmp_lt_u32 s14, 16
s_cselect_b32 s62, 0, 4096
v_mov_b32 v231, 1
v_lshlrev_b32 v232, 8, v1
s_waitcnt vmcnt(18)
v_permlane16_swap_b32 v164, v166
v_permlane16_swap_b32 v165, v167
s_waitcnt vmcnt(17)
v_permlane16_swap_b32 v168, v170
v_permlane16_swap_b32 v169, v171
s_waitcnt vmcnt(16)
v_permlane16_swap_b32 v172, v174
v_permlane16_swap_b32 v173, v175
s_waitcnt vmcnt(15)
v_permlane16_swap_b32 v176, v178
v_permlane16_swap_b32 v177, v179
buffer_atomic_add v231, v232, s[40:43], s62 offen
v_lshlrev_b32 v192, 16, v164
v_and_b32 v193, 0xffff0000, v164
v_lshlrev_b32 v194, 16, v165
v_and_b32 v195, 0xffff0000, v165
v_lshlrev_b32 v196, 16, v166
v_and_b32 v197, 0xffff0000, v166
v_lshlrev_b32 v198, 16, v167
v_and_b32 v199, 0xffff0000, v167
v_lshlrev_b32 v200, 16, v168
v_and_b32 v201, 0xffff0000, v168
v_lshlrev_b32 v202, 16, v169
v_and_b32 v203, 0xffff0000, v169
v_lshlrev_b32 v204, 16, v170
v_and_b32 v205, 0xffff0000, v170
v_lshlrev_b32 v206, 16, v171
v_and_b32 v207, 0xffff0000, v171
v_lshlrev_b32 v208, 16, v172
v_and_b32 v209, 0xffff0000, v172
v_lshlrev_b32 v210, 16, v173
v_and_b32 v211, 0xffff0000, v173
v_lshlrev_b32 v212, 16, v174
v_and_b32 v213, 0xffff0000, v174
v_lshlrev_b32 v214, 16, v175
v_and_b32 v215, 0xffff0000, v175
v_lshlrev_b32 v216, 16, v176
v_and_b32 v217, 0xffff0000, v176
v_lshlrev_b32 v218, 16, v177
v_and_b32 v219, 0xffff0000, v177
v_lshlrev_b32 v220, 16, v178
v_and_b32 v221, 0xffff0000, v178
v_lshlrev_b32 v222, 16, v179
v_and_b32 v223, 0xffff0000, v179
s_lshl_b32 s64, s6, 14
s_lshl_b32 s65, s49, 13
s_add_u32 s64, s64, s65
s_lshl_b32 s65, s7, 9
s_add_u32 s64, s64, s65
s_lshl_b32 s65, s48, 8
s_add_u32 s64, s64, s65
s_add_u32 s64, s64, 29360128
v_and_b32 v188, 31, v1
v_lshlrev_b32 v188, 3, v188
v_lshrrev_b32 v189, 5, v1
v_lshl_add_u32 v188, v189, 28, v188
s_lshl_b32 s62, s7, 18
s_add_u32 s62, s62, 0
s_add_u32 s63, s62, 131072
v_pk_mul_f32 v[182:183], v[192:193], v[192:193]
v_pk_mul_f32 v[186:187], v[208:209], v[208:209]
v_pk_fma_f32 v[182:183], v[194:195], v[194:195], v[182:183]
v_pk_add_f32 v[180:181], v[192:193], v[194:195]
v_pk_fma_f32 v[186:187], v[210:211], v[210:211], v[186:187]
v_pk_add_f32 v[184:185], v[208:209], v[210:211]
v_pk_fma_f32 v[182:183], v[196:197], v[196:197], v[182:183]
v_pk_add_f32 v[180:181], v[180:181], v[196:197]
v_pk_fma_f32 v[186:187], v[212:213], v[212:213], v[186:187]
v_pk_add_f32 v[184:185], v[184:185], v[212:213]
v_pk_fma_f32 v[182:183], v[198:199], v[198:199], v[182:183]
v_pk_add_f32 v[180:181], v[180:181], v[198:199]
v_pk_fma_f32 v[186:187], v[214:215], v[214:215], v[186:187]
v_pk_add_f32 v[184:185], v[184:185], v[214:215]
v_pk_fma_f32 v[182:183], v[200:201], v[200:201], v[182:183]
v_pk_add_f32 v[180:181], v[180:181], v[200:201]
v_pk_fma_f32 v[186:187], v[216:217], v[216:217], v[186:187]
v_pk_add_f32 v[184:185], v[184:185], v[216:217]
v_pk_fma_f32 v[182:183], v[202:203], v[202:203], v[182:183]
v_pk_add_f32 v[180:181], v[180:181], v[202:203]
v_pk_fma_f32 v[186:187], v[218:219], v[218:219], v[186:187]
v_pk_add_f32 v[184:185], v[184:185], v[218:219]
v_pk_fma_f32 v[182:183], v[204:205], v[204:205], v[182:183]
v_pk_add_f32 v[180:181], v[180:181], v[204:205]
v_pk_fma_f32 v[186:187], v[220:221], v[220:221], v[186:187]
v_pk_add_f32 v[184:185], v[184:185], v[220:221]
v_pk_fma_f32 v[182:183], v[206:207], v[206:207], v[182:183]
v_pk_add_f32 v[180:181], v[180:181], v[206:207]
v_pk_fma_f32 v[186:187], v[222:223], v[222:223], v[186:187]
v_pk_add_f32 v[184:185], v[184:185], v[222:223]
v_add_f32 v180, v180, v181
v_add_f32 v182, v182, v183
v_add_f32 v184, v184, v185
v_add_f32 v186, v186, v187
s_nop 0
v_permlane16_swap_b32 v180, v184
v_permlane16_swap_b32 v182, v186
v_add_f32 v180, v180, v184
v_add_f32 v182, v182, v186
s_nop 1
v_permlane32_swap_b32 v180, v182
v_add_f32 v180, v180, v182
s_nop 1
v_permlane32_swap_b32 v180, v181
buffer_store_dwordx2 v[180:181], v188, s[16:19], s64 offen sc1
s_lshl_b32 s62, s2, 10
s_add_u32 s62, s62, 31457280
s_cmp_eq_u32 s3, 0
s_cselect_b32 s62, s62, 268435456
buffer_store_dwordx4 v[224:227], v230, s[16:19], s62 offen sc1
v_accvgpr_write_b32 a224, v192
v_accvgpr_write_b32 a225, v193
v_accvgpr_write_b32 a226, v194
v_accvgpr_write_b32 a227, v195
v_accvgpr_write_b32 a228, v196
v_accvgpr_write_b32 a229, v197
v_accvgpr_write_b32 a230, v198
v_accvgpr_write_b32 a231, v199
v_accvgpr_write_b32 a232, v200
v_accvgpr_write_b32 a233, v201
v_accvgpr_write_b32 a234, v202
v_accvgpr_write_b32 a235, v203
v_accvgpr_write_b32 a236, v204
v_accvgpr_write_b32 a237, v205
v_accvgpr_write_b32 a238, v206
v_accvgpr_write_b32 a239, v207
v_accvgpr_write_b32 a240, v208
v_accvgpr_write_b32 a241, v209
v_accvgpr_write_b32 a242, v210
v_accvgpr_write_b32 a243, v211
v_accvgpr_write_b32 a244, v212
v_accvgpr_write_b32 a245, v213
v_accvgpr_write_b32 a246, v214
v_accvgpr_write_b32 a247, v215
v_accvgpr_write_b32 a248, v216
v_accvgpr_write_b32 a249, v217
v_accvgpr_write_b32 a250, v218
v_accvgpr_write_b32 a251, v219
v_accvgpr_write_b32 a252, v220
v_accvgpr_write_b32 a253, v221
v_accvgpr_write_b32 a254, v222
v_accvgpr_write_b32 a255, v223
s_add_u32 m0, s55, 18496
s_nop 0
buffer_load_dwordx4 v21, s[36:39], s52 offen lds
buffer_load_dwordx4 v28, s[36:39], s52 offen offset:1024 lds
buffer_load_dword v22, s[36:39], s52 offen offset:2048 lds
s_add_u32 s52, s52, 128
s_add_u32 m0, s55, 20800
s_nop 0
buffer_load_dwordx4 v21, s[36:39], s53 offen lds
buffer_load_dwordx4 v28, s[36:39], s53 offen offset:1024 lds
buffer_load_dword v29, s[36:39], s53 offen offset:2048 lds
s_add_u32 s53, s53, 128
s_add_u32 m0, s56, 73984
s_nop 0
buffer_load_dwordx4 v18, s[20:23], s54 offen lds
buffer_load_dwordx4 v19, s[20:23], s54 offen offset:1024 lds
buffer_load_dwordx4 v20, s[20:23], s54 offen offset:2048 lds
s_add_u32 s54, s54, 196608
s_waitcnt vmcnt(12) lgkmcnt(0)
s_barrier
ds_read_b128 a[0:3], v23
RD 4,23,2304
RD 8,23,4608
RD 12,23,6912
ds_read_b128 a[16:19], v24
ds_read_b128 a[20:23], v30
RD 24,30,2304
RD 28,30,4608
RD 32,30,6912
ds_read_b128 a[36:39], v31
TR 80,25,49664
TR 82,25,50176
TR 84,25,62080
TR 86,25,62592
TR 88,25,50688
TR 90,25,51200
TR 92,25,63104
TR 94,25,63616
TR 96,25,51712
TR 98,25,52224
TR 100,25,64128
TR 102,25,64640
s_waitcnt vmcnt(3) lgkmcnt(0)
s_barrier
v_mfma_f32_16x16x32_bf16 v[60:63], a[80:83], a[0:3], 0
TR 104,25,49696
s_add_u32 m0, s56, 86400
MAA 60,84,20
buffer_load_dwordx4 v18, s[20:23], s54 offen lds
v_mfma_f32_16x16x32_bf16 v[64:67], a[80:83], a[4:7], 0
s_sub_u32 s47, s47, 1
s_cbranch_scc1 .Lx4
.Lx4b:
MAA 64,84,24
buffer_load_dwordx4 v19, s[20:23], s54 offen offset:1024 lds
v_mfma_f32_16x16x32_bf16 v[68:71], a[80:83], a[8:11], 0
TR 106,25,50208
MAA 68,84,28
TR 108,25,62112
TR 110,25,62624
v_mfma_f32_16x16x32_bf16 v[72:75], a[80:83], a[12:15], 0
TR 112,25,50720
MAA 72,84,32
TR 114,25,51232
v_mfma_f32_16x16x32_bf16 v[244:247], a[80:83], a[16:19], 0
TR 116,25,63136
MAA 244,84,36
buffer_load_dwordx4 v20, s[20:23], s54 offen offset:2048 lds
v_mfma_f32_16x16x32_bf16 v[156:159], a[88:91], a[16:19], 0
s_add_u32 s54, s54, 196608
s_add_u32 m0, s55, 36992
MAA 156,92,36
buffer_load_dwordx4 v21, s[36:39], s52 offen lds
v_mfma_f32_16x16x32_bf16 v[104:107], a[88:91], a[12:15], 0
TR 118,25,63648
MAA 104,92,32
buffer_load_dwordx4 v28, s[36:39], s52 offen offset:1024 lds
v_mfma_f32_16x16x32_bf16 v[100:103], a[88:91], a[8:11], 0
TR 120,25,51744
MAA 100,92,28
buffer_load_dword v22, s[36:39], s52 offen offset:2048 lds
v_mfma_f32_16x16x32_bf16 v[96:99], a[88:91], a[4:7], 0
s_add_u32 s52, s52, 128
MAA 96,92,24
TR 122,25,52256
TR 124,25,64160
v_mfma_f32_16x16x32_bf16 v[92:95], a[88:91], a[0:3], 0
TR 126,25,64672
s_add_u32 m0, s55, 39296
MAA 92,92,20
buffer_load_dwordx4 v21, s[36:39], s53 offen lds
v_mfma_f32_16x16x32_bf16 v[124:127], a[0:3], a[96:99], 0
.Lpad1:
s_cbranch_execz .Lpad5
RD 40,23,18496
MAA 124,20,100
buffer_load_dwordx4 v28, s[36:39], s53 offen offset:1024 lds
v_mfma_f32_16x16x32_bf16 v[128:131], a[4:7], a[96:99], 0
RD 44,23,20800
MAA 128,24,100
RD 48,23,23104
RD 52,23,25408
v_mfma_f32_16x16x32_bf16 v[132:135], a[8:11], a[96:99], 0
RD 56,24,18496
MAA 132,28,100
buffer_load_dword v29, s[36:39], s53 offen offset:2048 lds
v_mfma_f32_16x16x32_bf16 v[136:139], a[12:15], a[96:99], 0
s_add_u32 s53, s53, 128
MAA 136,32,100
s_waitcnt vmcnt(6) lgkmcnt(5)
s_barrier
v_mfma_f32_16x16x32_bf16 v[76:79], a[104:107], a[0:3], 0
RD 60,30,18496
s_add_u32 m0, s56, 98816
MAA 76,108,20
buffer_load_dwordx4 v18, s[20:23], s54 offen lds
v_mfma_f32_16x16x32_bf16 v[80:83], a[104:107], a[4:7], 0
RD 64,30,20800
MAA 80,108,24
buffer_load_dwordx4 v19, s[20:23], s54 offen offset:1024 lds
v_mfma_f32_16x16x32_bf16 v[84:87], a[104:107], a[8:11], 0
RD 68,30,23104
MAA 84,108,28
RD 72,30,25408
RD 76,31,18496
v_mfma_f32_16x16x32_bf16 v[88:91], a[104:107], a[12:15], 0
ds_read_b64_tr_b16 a[80:81], v25
MAA 88,108,32
buffer_load_dwordx4 v20, s[20:23], s54 offen offset:2048 lds
v_mfma_f32_16x16x32_bf16 v[160:163], a[112:115], a[16:19], 0
s_add_u32 s54, s54, 196608
s_add_u32 m0, s56, 111232
MAA 160,116,36
buffer_load_dwordx4 v18, s[20:23], s54 offen lds
v_mfma_f32_16x16x32_bf16 v[120:123], a[112:115], a[12:15], 0
TR 82,25,512
MAA 120,116,32
buffer_load_dwordx4 v19, s[20:23], s54 offen offset:1024 lds
v_mfma_f32_16x16x32_bf16 v[116:119], a[112:115], a[8:11], 0
TR 84,25,12416
MAA 116,116,28
TR 86,25,12928
TR 88,25,1024
v_mfma_f32_16x16x32_bf16 v[112:115], a[112:115], a[4:7], 0
TR 90,25,1536
MAA 112,116,24
buffer_load_dwordx4 v20, s[20:23], s54 offen offset:2048 lds
v_mfma_f32_16x16x32_bf16 v[108:111], a[112:115], a[0:3], 0
s_add_u32 s54, s54, 196608
s_add_u32 m0, s55, 55488
MAA 108,116,20
buffer_load_dwordx4 v21, s[36:39], s52 offen lds
v_mfma_f32_16x16x32_bf16 v[140:143], a[0:3], a[120:123], 0
TR 92,25,13440
MAA 140,20,124
buffer_load_dwordx4 v28, s[36:39], s52 offen offset:1024 lds
v_mfma_f32_16x16x32_bf16 v[144:147], a[4:7], a[120:123], 0
TR 94,25,13952
MAA 144,24,124
TR 96,25,2048
TR 98,25,2560
v_mfma_f32_16x16x32_bf16 v[148:151], a[8:11], a[120:123], 0
TR 100,25,14464
MAA 148,28,124
buffer_load_dword v22, s[36:39], s52 offen offset:2048 lds
v_mfma_f32_16x16x32_bf16 v[152:155], a[12:15], a[120:123], 0
TR 102,25,14976
s_add_u32 s52, s52, 128
MAA 152,32,124
s_waitcnt vmcnt(9) lgkmcnt(8)
s_barrier
MAA 60,80,40
TR 104,25,32
s_add_u32 m0, s55, 57792
MAA 60,84,60
buffer_load_dwordx4 v21, s[36:39], s53 offen lds
MAA 64,84,64
s_sub_u32 s47, s47, 1
s_cbranch_scc1 .Lx5
.Lx5b:
MAA 64,80,44
buffer_load_dwordx4 v28, s[36:39], s53 offen offset:1024 lds
MAA 68,80,48
TR 106,25,544
MAA 68,84,68
TR 108,25,12448
TR 110,25,12960
MAA 72,84,72
TR 112,25,1056
MAA 72,80,52
TR 114,25,1568
s_waitcnt lgkmcnt(6)
MAA 244,80,56
TR 116,25,13472
MAA 244,84,76
buffer_load_dword v29, s[36:39], s53 offen offset:2048 lds
MAA 156,92,76
s_add_u32 s53, s53, 128
s_add_u32 m0, s56, 123648
MAA 156,88,56
buffer_load_dwordx4 v18, s[20:23], s54 offen lds
MAA 104,88,52
TR 118,25,13984
MAA 104,92,72
buffer_load_dwordx4 v19, s[20:23], s54 offen offset:1024 lds
MAA 100,92,68
TR 120,25,2080
MAA 100,88,48
buffer_load_dwordx4 v20, s[20:23], s54 offen offset:2048 lds
MAA 96,88,44
s_add_u32 s54, s54, 196608
MAA 96,92,64
TR 122,25,2592
TR 124,25,14496
MAA 92,92,60
TR 126,25,15008
s_add_u32 m0, s56, 136064
MAA 92,88,40
buffer_load_dwordx4 v18, s[20:23], s54 offen lds
MAA 124,40,96
RD 0,23,36992
MAA 124,60,100
buffer_load_dwordx4 v19, s[20:23], s54 offen offset:1024 lds
MAA 128,64,100
RD 4,23,39296
MAA 128,44,96
RD 8,23,41600
RD 12,23,43904
MAA 132,48,96
RD 16,24,36992
MAA 132,68,100
buffer_load_dwordx4 v20, s[20:23], s54 offen offset:2048 lds
MAA 136,72,100
s_add_u32 s54, s54, 196608
MAA 136,52,96
s_waitcnt vmcnt(12) lgkmcnt(5)
s_barrier
MAA 76,104,40
RD 20,30,36992
s_add_u32 m0, s55, 0
MAA 76,108,60
buffer_load_dwordx4 v21, s[36:39], s52 offen lds
MAA 80,108,64
RD 24,30,39296
MAA 80,104,44
buffer_load_dwordx4 v28, s[36:39], s52 offen offset:1024 lds
MAA 84,104,48
RD 28,30,41600
MAA 84,108,68
buffer_load_dword v22, s[36:39], s52 offen offset:2048 lds
MAA 88,108,72
RD 32,30,43904
s_add_u32 s52, s52, 128
MAA 88,104,52
RD 36,31,36992
TR 80,25,24832
TR 82,25,25344
MAA 160,112,56
TR 84,25,37248
s_add_u32 m0, s55, 2304
MAA 160,116,76
buffer_load_dwordx4 v21, s[36:39], s53 offen lds
MAA 120,116,72
TR 86,25,37760
MAA 120,112,52
buffer_load_dwordx4 v28, s[36:39], s53 offen offset:1024 lds
MAA 116,112,48
TR 88,25,25856
MAA 116,116,68
buffer_load_dword v29, s[36:39], s53 offen offset:2048 lds
MAA 112,116,64
s_add_u32 s53, s53, 128
s_add_u32 m0, s56, 73984
MAA 112,112,44
buffer_load_dwordx4 v18, s[20:23], s54 offen lds
MAA 108,112,40
TR 90,25,26368
MAA 108,116,60
buffer_load_dwordx4 v19, s[20:23], s54 offen offset:1024 lds
MAA 140,60,124
TR 92,25,38272
MAA 140,40,120
TR 94,25,38784
TR 96,25,26880
TR 98,25,27392
MAA 144,44,120
TR 100,25,39296
MAA 144,64,124
buffer_load_dwordx4 v20, s[20:23], s54 offen offset:2048 lds
MAA 148,68,124
TR 102,25,39808
s_add_u32 s54, s54, 196608
MAA 148,48,120
buffer_load_dword v37, v34, s[40:43], 0 offen sc1
MAA 152,52,120
MAA 152,72,124
s_waitcnt vmcnt(16) lgkmcnt(8)
s_barrier
MAA 60,80,0
TR 104,25,24864
s_add_u32 m0, s56, 86400
MAA 60,84,20
buffer_load_dwordx4 v18, s[20:23], s54 offen lds
MAA 64,84,24
s_sub_u32 s47, s47, 1
s_cbranch_scc1 .Lx6
.Lx6b:
MAA 64,80,4
buffer_load_dwordx4 v19, s[20:23], s54 offen offset:1024 lds
MAA 68,80,8
TR 106,25,25376
MAA 68,84,28
TR 108,25,37280
TR 110,25,37792
MAA 72,84,32
TR 112,25,25888
MAA 72,80,12
TR 114,25,26400
s_waitcnt lgkmcnt(6)
MAA 244,80,16
TR 116,25,38304
MAA 244,84,36
buffer_load_dwordx4 v20, s[20:23], s54 offen offset:2048 lds
MAA 156,92,36
s_add_u32 s54, s54, 196608
s_add_u32 m0, s55, 18496
MAA 156,88,16
buffer_load_dwordx4 v21, s[36:39], s52 offen lds
MAA 104,88,12
TR 118,25,38816
MAA 104,92,32
buffer_load_dwordx4 v28, s[36:39], s52 offen offset:1024 lds
MAA 100,92,28
TR 120,25,26912
MAA 100,88,8
buffer_load_dword v22, s[36:39], s52 offen offset:2048 lds
MAA 96,88,4
s_add_u32 s52, s52, 128
MAA 96,92,24
TR 122,25,27424
TR 124,25,39328
MAA 92,92,20
TR 126,25,39840
s_add_u32 m0, s55, 20800
MAA 92,88,0
buffer_load_dwordx4 v21, s[36:39], s53 offen lds
MAA 124,0,96
RD 40,23,55488
MAA 124,20,100
buffer_load_dwordx4 v28, s[36:39], s53 offen offset:1024 lds
MAA 128,24,100
RD 44,23,57792
MAA 128,4,96
RD 48,23,60096
RD 52,23,62400
MAA 132,8,96
RD 56,24,55488
MAA 132,28,100
buffer_load_dword v29, s[36:39], s53 offen offset:2048 lds
MAA 136,32,100
s_add_u32 s53, s53, 128
MAA 136,12,96
s_waitcnt vmcnt(19) lgkmcnt(5)
s_barrier
MAA 76,104,0
RD 60,30,55488
s_add_u32 m0, s56, 98816
MAA 76,108,20
buffer_load_dwordx4 v18, s[20:23], s54 offen lds
MAA 80,108,24
RD 64,30,57792
MAA 80,104,4
buffer_load_dwordx4 v19, s[20:23], s54 offen offset:1024 lds
MAA 84,104,8
RD 68,30,60096
MAA 84,108,28
RD 72,30,62400
RD 76,31,55488
MAA 88,108,32
TR 80,25,49664
MAA 88,104,12
buffer_load_dwordx4 v20, s[20:23], s54 offen offset:2048 lds
MAA 160,112,16
s_add_u32 s54, s54, 196608
s_add_u32 m0, s55, 36992
MAA 160,116,36
buffer_load_dwordx4 v21, s[36:39], s52 offen lds
MAA 120,116,32
TR 82,25,50176
MAA 120,112,12
buffer_load_dwordx4 v28, s[36:39], s52 offen offset:1024 lds
MAA 116,112,8
TR 84,25,62080
MAA 116,116,28
TR 86,25,62592
TR 88,25,50688
MAA 112,116,24
TR 90,25,51200
MAA 112,112,4
buffer_load_dword v22, s[36:39], s52 offen offset:2048 lds
MAA 108,112,0
s_add_u32 s52, s52, 128
s_add_u32 m0, s55, 39296
MAA 108,116,20
buffer_load_dwordx4 v21, s[36:39], s53 offen lds
MAA 140,20,124
TR 92,25,63104
MAA 140,0,120
buffer_load_dwordx4 v28, s[36:39], s53 offen offset:1024 lds
MAA 144,4,120
TR 94,25,63616
MAA 144,24,124
TR 96,25,51712
TR 98,25,52224
MAA 148,28,124
TR 100,25,64128
MAA 148,8,120
buffer_load_dword v29, s[36:39], s53 offen offset:2048 lds
MAA 152,12,120
TR 102,25,64640
s_add_u32 s53, s53, 128
MAA 152,32,124
s_waitcnt vmcnt(22) lgkmcnt(8)
s_barrier
MAA 60,80,40
TR 104,25,49696
s_add_u32 m0, s56, 111232
MAA 60,84,60
buffer_load_dwordx4 v18, s[20:23], s54 offen lds
MAA 64,84,64
s_sub_u32 s47, s47, 1
s_cbranch_scc1 .Lx7
.Lx7b:
MAA 64,80,44
TR 106,25,50208
MAA 68,80,48
TR 108,25,62112
MAA 68,84,68
buffer_load_dwordx4 v19, s[20:23], s54 offen offset:1024 lds
MAA 72,84,72
TR 110,25,62624
MAA 72,80,52
TR 112,25,50720
s_waitcnt lgkmcnt(5)
MAA 244,80,56
TR 114,25,51232
MAA 244,84,76
buffer_load_dwordx4 v20, s[20:23], s54 offen offset:2048 lds
MAA 156,92,76
s_add_u32 s54, s54, 196608
MAA 156,88,56
TR 116,25,63136
MAA 104,88,52
TR 118,25,63648
MAA 104,92,72
TR 120,25,51744
MAA 100,92,68
TR 122,25,52256
s_add_u32 m0, s55, 55488
MAA 100,88,48
buffer_load_dwordx4 v21, s[36:39], s52 offen lds
MAA 96,88,44
TR 124,25,64160
MAA 96,92,64
TR 126,25,64672
MAA 92,92,60
MAA 92,88,40
buffer_load_dwordx4 v28, s[36:39], s52 offen offset:1024 lds
MAA 124,40,96
ds_read_b128 a[0:3], v23
MAA 124,60,100
RD 4,23,2304
MAA 128,64,100
RD 8,23,4608
MAA 128,44,96
buffer_load_dword v22, s[36:39], s52 offen offset:2048 lds
MAA 132,48,96
RD 12,23,6912
s_add_u32 s52, s52, 128
MAA 132,68,100
ds_read_b128 a[16:19], v24
MAA 136,72,100
MAA 136,52,96
s_waitcnt vmcnt(21) lgkmcnt(5)
s_barrier
v_cmp_gt_u32 vcc, v35, v37
s_nop 0
s_cbranch_vccnz .Lsp8
.Lsp8b:
v_mov_b32 v37, 0
MAA 76,104,40
ds_read_b128 a[20:23], v30
MAA 76,108,60
buffer_atomic_add v38, v32, s[16:19], 0 offen
MAA 80,108,64
RD 24,30,2304
MAA 80,104,44
RD 28,30,4608
MAA 84,104,48
RD 32,30,6912
s_add_u32 m0, s56, 123648
MAA 84,108,68
buffer_load_dwordx4 v18, s[20:23], s54 offen lds
MAA 88,108,72
ds_read_b128 a[36:39], v31
MAA 88,104,52
buffer_load_dwordx4 v19, s[20:23], s54 offen offset:1024 lds
MAA 160,112,56
ds_read_b64_tr_b16 a[80:81], v25
MAA 160,116,76
TR 82,25,512
MAA 120,116,72
TR 84,25,12416
MAA 120,112,52
buffer_load_dwordx4 v20, s[20:23], s54 offen offset:2048 lds
MAA 116,112,48
TR 86,25,12928
s_add_u32 s54, s54, 196608
MAA 116,116,68
TR 88,25,1024
MAA 112,116,64
TR 90,25,1536
s_add_u32 m0, s55, 57792
MAA 112,112,44
buffer_load_dwordx4 v21, s[36:39], s53 offen lds
MAA 108,112,40
TR 92,25,13440
MAA 108,116,60
TR 94,25,13952
MAA 140,60,124
TR 96,25,2048
MAA 140,40,120
buffer_load_dwordx4 v28, s[36:39], s53 offen offset:1024 lds
MAA 144,44,120
TR 98,25,2560
MAA 144,64,124
buffer_load_dword v29, s[36:39], s53 offen offset:2048 lds
MAA 148,68,124
TR 100,25,14464
s_add_u32 s53, s53, 128
MAA 148,48,120
TR 102,25,14976
MAA 152,52,120
MAA 152,72,124
s_waitcnt vmcnt(22) lgkmcnt(8)
s_barrier
MAA 60,80,0
TR 104,25,32
s_add_u32 m0, s56, 136064
MAA 60,84,20
buffer_load_dwordx4 v18, s[20:23], s54 offen lds
MAA 64,84,24
s_sub_u32 s47, s47, 1
s_cbranch_scc1 .Lx9
.Lx9b:
MAA 64,80,4
TR 106,25,544
MAA 68,80,8
TR 108,25,12448
MAA 68,84,28
buffer_load_dwordx4 v19, s[20:23], s54 offen offset:1024 lds
MAA 72,84,32
TR 110,25,12960
MAA 72,80,12
TR 112,25,1056
s_waitcnt lgkmcnt(5)
MAA 244,80,16
TR 114,25,1568
MAA 244,84,36
buffer_load_dwordx4 v20, s[20:23], s54 offen offset:2048 lds
MAA 156,92,36
s_add_u32 s54, s54, 196608
MAA 156,88,16
TR 116,25,13472
MAA 104,88,12
TR 118,25,13984
MAA 104,92,32
TR 120,25,2080
MAA 100,92,28
TR 122,25,2592
s_add_u32 m0, s55, 0
MAA 100,88,8
buffer_load_dwordx4 v21, s[36:39], s52 offen lds
MAA 96,88,4
TR 124,25,14496
MAA 96,92,24
TR 126,25,15008
MAA 92,92,20
MAA 92,88,0
buffer_load_dwordx4 v28, s[36:39], s52 offen offset:1024 lds
MAA 124,0,96
RD 40,23,18496
MAA 124,20,100
RD 44,23,20800
MAA 128,24,100
RD 48,23,23104
MAA 128,4,96
buffer_load_dword v22, s[36:39], s52 offen offset:2048 lds
MAA 132,8,96
RD 52,23,25408
s_add_u32 s52, s52, 128
MAA 132,28,100
RD 56,24,18496
MAA 136,32,100
MAA 136,12,96
s_waitcnt vmcnt(16) lgkmcnt(5)
s_barrier
MAA 76,104,0
RD 60,30,18496
s_add_u32 m0, s56, 73984
MAA 76,108,20
buffer_load_dwordx4 v18, s[20:23], s54 offen lds
MAA 80,108,24
RD 64,30,20800
MAA 80,104,4
RD 68,30,23104
MAA 84,104,8
RD 72,30,25408
MAA 84,108,28
buffer_load_dwordx4 v19, s[20:23], s54 offen offset:1024 lds
MAA 88,108,32
RD 76,31,18496
MAA 88,104,12
TR 80,25,24832
MAA 160,112,16
TR 82,25,25344
MAA 160,116,36
buffer_load_dwordx4 v20, s[20:23], s54 offen offset:2048 lds
.Lpad2:
s_cbranch_execz .Lpad6
MAA 120,116,32
TR 84,25,37248
s_add_u32 s54, s54, 196608
MAA 120,112,12
TR 86,25,37760
MAA 116,112,8
s_add_u32 m0, s55, 2304
MAA 116,116,28
buffer_load_dwordx4 v21, s[36:39], s53 offen lds
MAA 112,116,24
TR 88,25,25856
MAA 112,112,4
TR 90,25,26368
MAA 108,112,0
TR 92,25,38272
MAA 108,116,20
buffer_load_dwordx4 v28, s[36:39], s53 offen offset:1024 lds
MAA 140,20,124
TR 94,25,38784
MAA 140,0,120
TR 96,25,26880
MAA 144,4,120
TR 98,25,27392
MAA 144,24,124
buffer_load_dword v29, s[36:39], s53 offen offset:2048 lds
MAA 148,28,124
TR 100,25,39296
s_add_u32 s53, s53, 128
MAA 148,8,120
TR 102,25,39808
MAA 152,12,120
MAA 152,32,124
s_waitcnt lgkmcnt(8)
s_barrier
MAA 60,80,40
TR 104,25,24864
s_add_u32 m0, s56, 86400
MAA 60,84,60
buffer_load_dwordx4 v18, s[20:23], s54 offen lds
MAA 64,84,64
s_sub_u32 s47, s47, 1
s_cbranch_scc1 .Lx10
.Lx10b:
MAA 64,80,44
TR 106,25,25376
MAA 68,80,48
TR 108,25,37280
MAA 68,84,68
buffer_load_dwordx4 v19, s[20:23], s54 offen offset:1024 lds
MAA 72,84,72
TR 110,25,37792
MAA 72,80,52
TR 112,25,25888
s_waitcnt lgkmcnt(5)
MAA 244,80,56
TR 114,25,26400
MAA 244,84,76
buffer_load_dwordx4 v20, s[20:23], s54 offen offset:2048 lds
MAA 156,92,76
s_add_u32 s54, s54, 196608
MAA 156,88,56
TR 116,25,38304
MAA 104,88,52
TR 118,25,38816
MAA 104,92,72
TR 120,25,26912
MAA 100,92,68
TR 122,25,27424
s_add_u32 m0, s55, 18496
MAA 100,88,48
buffer_load_dwordx4 v21, s[36:39], s52 offen lds
MAA 96,88,44
TR 124,25,39328
MAA 96,92,64
TR 126,25,39840
MAA 92,92,60
MAA 92,88,40
buffer_load_dwordx4 v28, s[36:39], s52 offen offset:1024 lds
MAA 124,40,96
RD 0,23,36992
MAA 124,60,100
RD 4,23,39296
MAA 128,64,100
RD 8,23,41600
MAA 128,44,96
buffer_load_dword v22, s[36:39], s52 offen offset:2048 lds
MAA 132,48,96
RD 12,23,43904
s_add_u32 s52, s52, 128
MAA 132,68,100
RD 16,24,36992
MAA 136,72,100
MAA 136,52,96
s_waitcnt vmcnt(15) lgkmcnt(5)
s_barrier
MAA 76,104,40
RD 20,30,36992
s_add_u32 m0, s56, 98816
MAA 76,108,60
buffer_load_dwordx4 v18, s[20:23], s54 offen lds
MAA 80,108,64
RD 24,30,39296
MAA 80,104,44
RD 28,30,41600
MAA 84,104,48
RD 32,30,43904
MAA 84,108,68
buffer_load_dwordx4 v19, s[20:23], s54 offen offset:1024 lds
MAA 88,108,72
RD 36,31,36992
MAA 88,104,52
buffer_load_dwordx4 v20, s[20:23], s54 offen offset:2048 lds
MAA 160,112,56
TR 80,25,49664
s_add_u32 s54, s54, 196608
MAA 160,116,76
TR 82,25,50176
MAA 120,116,72
TR 84,25,62080
s_add_u32 m0, s55, 20800
MAA 120,112,52
buffer_load_dwordx4 v21, s[36:39], s53 offen lds
MAA 116,112,48
TR 86,25,62592
MAA 116,116,68
TR 88,25,50688
MAA 112,116,64
TR 90,25,51200
MAA 112,112,44
buffer_load_dwordx4 v28, s[36:39], s53 offen offset:1024 lds
MAA 108,112,40
TR 92,25,63104
MAA 108,116,60
TR 94,25,63616
MAA 140,60,124
TR 96,25,51712
MAA 140,40,120
buffer_load_dword v29, s[36:39], s53 offen offset:2048 lds
MAA 144,44,120
TR 98,25,52224
s_add_u32 s53, s53, 128
MAA 144,64,124
buffer_atomic_add v37, v33, s[16:19], 0 offen sc0
MAA 148,68,124
TR 100,25,64128
MAA 148,48,120
TR 102,25,64640
MAA 152,52,120
MAA 152,72,124
s_waitcnt lgkmcnt(8)
s_barrier
MAA 60,80,0
TR 104,25,49696
s_add_u32 m0, s56, 111232
MAA 60,84,20
buffer_load_dwordx4 v18, s[20:23], s54 offen lds
MAA 64,84,24
s_sub_u32 s47, s47, 1
s_cbranch_scc1 .Lx11
.Lx11b:
MAA 64,80,4
TR 106,25,50208
MAA 68,80,8
TR 108,25,62112
MAA 68,84,28
buffer_load_dwordx4 v19, s[20:23], s54 offen offset:1024 lds
MAA 72,84,32
TR 110,25,62624
MAA 72,80,12
TR 112,25,50720
s_waitcnt lgkmcnt(5)
MAA 244,80,16
TR 114,25,51232
MAA 244,84,36
buffer_load_dwordx4 v20, s[20:23], s54 offen offset:2048 lds
MAA 156,92,36
s_add_u32 s54, s54, 196608
MAA 156,88,16
TR 116,25,63136
MAA 104,88,12
TR 118,25,63648
MAA 104,92,32
TR 120,25,51744
MAA 100,92,28
TR 122,25,52256
s_add_u32 m0, s55, 36992
MAA 100,88,8
buffer_load_dwordx4 v21, s[36:39], s52 offen lds
MAA 96,88,4
TR 124,25,64160
MAA 96,92,24
TR 126,25,64672
MAA 92,92,20
MAA 92,88,0
buffer_load_dwordx4 v28, s[36:39], s52 offen offset:1024 lds
MAA 124,0,96
RD 40,23,55488
MAA 124,20,100
RD 44,23,57792
MAA 128,24,100
RD 48,23,60096
MAA 128,4,96
buffer_load_dword v22, s[36:39], s52 offen offset:2048 lds
MAA 132,8,96
RD 52,23,62400
s_add_u32 s52, s52, 128
MAA 132,28,100
RD 56,24,55488
MAA 136,32,100
MAA 136,12,96
s_waitcnt vmcnt(16) lgkmcnt(5)
s_barrier
MAA 76,104,0
RD 60,30,55488
s_add_u32 m0, s56, 123648
MAA 76,108,20
buffer_load_dwordx4 v18, s[20:23], s54 offen lds
MAA 80,108,24
RD 64,30,57792
MAA 80,104,4
RD 68,30,60096
MAA 84,104,8
RD 72,30,62400
MAA 84,108,28
buffer_load_dwordx4 v19, s[20:23], s54 offen offset:1024 lds
MAA 88,108,32
RD 76,31,55488
MAA 88,104,12
ds_read_b64_tr_b16 a[80:81], v25
MAA 160,112,16
TR 82,25,512
MAA 160,116,36
buffer_load_dwordx4 v20, s[20:23], s54 offen offset:2048 lds
MAA 120,116,32
TR 84,25,12416
s_add_u32 s54, s54, 196608
MAA 120,112,12
TR 86,25,12928
MAA 116,112,8
s_add_u32 m0, s55, 39296
MAA 116,116,28
buffer_load_dwordx4 v21, s[36:39], s53 offen lds
MAA 112,116,24
TR 88,25,1024
MAA 112,112,4
TR 90,25,1536
MAA 108,112,0
TR 92,25,13440
MAA 108,116,20
buffer_load_dwordx4 v28, s[36:39], s53 offen offset:1024 lds
MAA 140,20,124
TR 94,25,13952
MAA 140,0,120
TR 96,25,2048
MAA 144,4,120
TR 98,25,2560
MAA 144,24,124
buffer_load_dword v29, s[36:39], s53 offen offset:2048 lds
MAA 148,28,124
TR 100,25,14464
s_add_u32 s53, s53, 128
MAA 148,8,120
TR 102,25,14976
MAA 152,12,120
MAA 152,32,124
s_waitcnt lgkmcnt(8)
s_barrier
MAA 60,80,40
TR 104,25,32
s_add_u32 m0, s56, 136064
MAA 60,84,60
buffer_load_dwordx4 v18, s[20:23], s54 offen lds
MAA 64,84,64
s_sub_u32 s47, s47, 1
s_cbranch_scc1 .Lx12
.Lx12b:
MAA 64,80,44
TR 106,25,544
MAA 68,80,48
TR 108,25,12448
MAA 68,84,68
buffer_load_dwordx4 v19, s[20:23], s54 offen offset:1024 lds
MAA 72,84,72
TR 110,25,12960
MAA 72,80,52
TR 112,25,1056
s_waitcnt lgkmcnt(5)
MAA 244,80,56
TR 114,25,1568
MAA 244,84,76
buffer_load_dwordx4 v20, s[20:23], s54 offen offset:2048 lds
MAA 156,92,76
s_add_u32 s54, s54, 196608
MAA 156,88,56
TR 116,25,13472
MAA 104,88,52
TR 118,25,13984
MAA 104,92,72
TR 120,25,2080
MAA 100,92,68
TR 122,25,2592
s_add_u32 m0, s55, 55488
MAA 100,88,48
buffer_load_dwordx4 v21, s[36:39], s52 offen lds
MAA 96,88,44
TR 124,25,14496
MAA 96,92,64
TR 126,25,15008
MAA 92,92,60
MAA 92,88,40
buffer_load_dwordx4 v28, s[36:39], s52 offen offset:1024 lds
MAA 124,40,96
ds_read_b128 a[0:3], v23
MAA 124,60,100
RD 4,23,2304
MAA 128,64,100
RD 8,23,4608
MAA 128,44,96
buffer_load_dword v22, s[36:39], s52 offen offset:2048 lds
MAA 132,48,96
RD 12,23,6912
s_add_u32 s52, s52, 128
MAA 132,68,100
ds_read_b128 a[16:19], v24
MAA 136,72,100
MAA 136,52,96
s_waitcnt vmcnt(18)
v_cmp_gt_u32 vcc, v36, v37
s_nop 0
s_cbranch_vccnz .Lsp13
.Lsp13b:
s_waitcnt vmcnt(15) lgkmcnt(5)
s_barrier
MAA 76,104,40
ds_read_b128 a[20:23], v30
s_add_u32 m0, s56, 73984
MAA 76,108,60
buffer_load_dwordx4 v18, s[20:23], s54 offen lds
MAA 80,108,64
RD 24,30,2304
MAA 80,104,44
RD 28,30,4608
MAA 84,104,48
RD 32,30,6912
MAA 84,108,68
buffer_load_dwordx4 v19, s[20:23], s54 offen offset:1024 lds
MAA 88,108,72
ds_read_b128 a[36:39], v31
MAA 88,104,52
buffer_load_dwordx4 v20, s[20:23], s54 offen offset:2048 lds
MAA 160,112,56
TR 80,25,24832
s_add_u32 s54, s54, 196608
MAA 160,116,76
TR 82,25,25344
MAA 120,116,72
TR 84,25,37248
s_add_u32 m0, s55, 57792
MAA 120,112,52
buffer_load_dwordx4 v21, s[36:39], s53 offen lds
MAA 116,112,48
TR 86,25,37760
MAA 116,116,68
TR 88,25,25856
MAA 112,116,64
TR 90,25,26368
MAA 112,112,44
buffer_load_dwordx4 v28, s[36:39], s53 offen offset:1024 lds
MAA 108,112,40
TR 92,25,38272
MAA 108,116,60
TR 94,25,38784
MAA 140,60,124
TR 96,25,26880
MAA 140,40,120
buffer_load_dword v29, s[36:39], s53 offen offset:2048 lds
MAA 144,44,120
TR 98,25,27392
s_add_u32 s53, s53, 128
MAA 144,64,124
buffer_load_dwordx4 v[164:167], v26, s[16:19], s75 offen sc1
MAA 148,68,124
TR 100,25,39296
MAA 148,48,120
TR 102,25,39808
MAA 152,52,120
MAA 152,72,124
s_waitcnt lgkmcnt(8)
s_barrier
MAA 60,80,0
TR 104,25,24864
s_add_u32 m0, s56, 86400
MAA 60,84,20
buffer_load_dwordx4 v18, s[20:23], s54 offen lds
MAA 64,84,24
s_sub_u32 s47, s47, 1
s_cbranch_scc1 .Lx14
.Lx14b:
MAA 64,80,4
TR 106,25,25376
MAA 68,80,8
TR 108,25,37280
MAA 68,84,28
buffer_load_dwordx4 v19, s[20:23], s54 offen offset:1024 lds
MAA 72,84,32
TR 110,25,37792
MAA 72,80,12
TR 112,25,25888
s_waitcnt lgkmcnt(5)
MAA 244,80,16
TR 114,25,26400
MAA 244,84,36
buffer_load_dwordx4 v20, s[20:23], s54 offen offset:2048 lds
MAA 156,92,36
TR 116,25,38304
s_add_u32 s54, s54, 196608
MAA 156,88,16
TR 118,25,38816
MAA 104,88,12
TR 120,25,26912
s_add_u32 m0, s55, 0
MAA 104,92,32
buffer_load_dwordx4 v21, s[36:39], s52 offen lds
MAA 100,92,28
MAA 100,88,8
buffer_load_dwordx4 v28, s[36:39], s52 offen offset:1024 lds
MAA 96,88,4
TR 122,25,27424
MAA 96,92,24
TR 124,25,39328
MAA 92,92,20
TR 126,25,39840
MAA 92,88,0
buffer_load_dword v22, s[36:39], s52 offen offset:2048 lds
MAA 124,0,96
RD 40,23,18496
s_add_u32 s52, s52, 128
MAA 124,20,100
RD 44,23,20800
MAA 128,24,100
RD 48,23,23104
MAA 128,4,96
buffer_load_dwordx4 v[168:171], v26, s[16:19], s75 offen offset:1024 sc1
MAA 132,8,96
RD 52,23,25408
MAA 132,28,100
RD 56,24,18496
MAA 136,32,100
MAA 136,12,96
s_waitcnt vmcnt(17) lgkmcnt(5)
s_barrier
MAA 76,104,0
RD 60,30,18496
s_add_u32 m0, s56, 98816
MAA 76,108,20
buffer_load_dwordx4 v18, s[20:23], s54 offen lds
MAA 80,108,24
RD 64,30,20800
MAA 80,104,4
RD 68,30,23104
MAA 84,104,8
RD 72,30,25408
MAA 84,108,28
buffer_load_dwordx4 v19, s[20:23], s54 offen offset:1024 lds
MAA 88,108,32
RD 76,31,18496
MAA 88,104,12
buffer_load_dwordx4 v20, s[20:23], s54 offen offset:2048 lds
MAA 160,112,16
TR 80,25,49664
s_add_u32 s54, s54, 196608
MAA 160,116,36
TR 82,25,50176
MAA 120,116,32
TR 84,25,62080
s_add_u32 m0, s55, 2304
MAA 120,112,12
buffer_load_dwordx4 v21, s[36:39], s53 offen lds
MAA 116,112,8
TR 86,25,62592
MAA 116,116,28
TR 88,25,50688
MAA 112,116,24
TR 90,25,51200
MAA 112,112,4
buffer_load_dwordx4 v28, s[36:39], s53 offen offset:1024 lds
MAA 108,112,0
TR 92,25,63104
MAA 108,116,20
TR 94,25,63616
MAA 140,20,124
TR 96,25,51712
MAA 140,0,120
buffer_load_dword v29, s[36:39], s53 offen offset:2048 lds
MAA 144,4,120
TR 98,25,52224
s_add_u32 s53, s53, 128
MAA 144,24,124
buffer_load_dwordx4 v[172:175], v26, s[16:19], s75 offen offset:2048 sc1
MAA 148,28,124
TR 100,25,64128
MAA 148,8,120
TR 102,25,64640
MAA 152,12,120
MAA 152,32,124
s_waitcnt lgkmcnt(8)
s_barrier
MAA 60,80,40
TR 104,25,49696
s_add_u32 m0, s56, 111232
MAA 60,84,60
buffer_load_dwordx4 v18, s[20:23], s54 offen lds
MAA 64,84,64
s_sub_u32 s47, s47, 1
s_cbranch_scc1 .Lx15
.Lx15b:
MAA 64,80,44
TR 106,25,50208
MAA 68,80,48
TR 108,25,62112
MAA 68,84,68
buffer_load_dwordx4 v19, s[20:23], s54 offen offset:1024 lds
MAA 72,84,72
TR 110,25,62624
MAA 72,80,52
TR 112,25,50720
s_waitcnt lgkmcnt(5)
MAA 244,80,56
TR 114,25,51232
MAA 244,84,76
buffer_load_dwordx4 v20, s[20:23], s54 offen offset:2048 lds
MAA 156,92,76
TR 116,25,63136
s_add_u32 s54, s54, 196608
MAA 156,88,56
TR 118,25,63648
MAA 104,88,52
.Lpad3:
s_cbranch_execz .Lpad7
TR 120,25,51744
s_add_u32 m0, s55, 18496
MAA 104,92,72
buffer_load_dwordx4 v21, s[36:39], s52 offen lds
MAA 100,92,68
MAA 100,88,48
buffer_load_dwordx4 v28, s[36:39], s52 offen offset:1024 lds
MAA 96,88,44
TR 122,25,52256
MAA 96,92,64
TR 124,25,64160
MAA 92,92,60
TR 126,25,64672
MAA 92,88,40
buffer_load_dword v22, s[36:39], s52 offen offset:2048 lds
MAA 124,40,96
RD 0,23,36992
s_add_u32 s52, s52, 128
MAA 124,60,100
RD 4,23,39296
MAA 128,64,100
RD 8,23,41600
MAA 128,44,96
buffer_load_dwordx4 v[176:179], v26, s[16:19], s75 offen offset:3072 sc1
MAA 132,48,96
RD 12,23,43904
s_add_u32 s75, s75, 4096
MAA 132,68,100
RD 16,24,36992
MAA 136,72,100
MAA 136,52,96
s_waitcnt vmcnt(18) lgkmcnt(5)
s_barrier
MAA 76,104,40
RD 20,30,36992
s_add_u32 m0, s56, 123648
MAA 76,108,60
buffer_load_dwordx4 v18, s[20:23], s54 offen lds
MAA 80,108,64
RD 24,30,39296
s_waitcnt vmcnt(15)
v_add_f32 v164, v164, v168
MAA 80,104,44
RD 28,30,41600
MAA 84,104,48
RD 32,30,43904
MAA 84,108,68
buffer_load_dwordx4 v19, s[20:23], s54 offen offset:1024 lds
MAA 88,108,72
RD 36,31,36992
v_add_f32 v165, v165, v169
MAA 88,104,52
buffer_load_dwordx4 v20, s[20:23], s54 offen offset:2048 lds
MAA 160,112,56
ds_read_b64_tr_b16 a[80:81], v25
s_add_u32 s54, s54, 196608
MAA 160,116,76
TR 82,25,512
MAA 120,116,72
TR 84,25,12416
s_add_u32 m0, s55, 20800
MAA 120,112,52
buffer_load_dwordx4 v21, s[36:39], s53 offen lds
MAA 116,112,48
TR 86,25,12928
MAA 116,116,68
TR 88,25,1024
MAA 112,116,64
TR 90,25,1536
v_add_f32 v166, v166, v170
MAA 112,112,44
buffer_load_dwordx4 v28, s[36:39], s53 offen offset:1024 lds
MAA 108,112,40
TR 92,25,13440
MAA 108,116,60
TR 94,25,13952
MAA 140,60,124
TR 96,25,2048
MAA 140,40,120
buffer_load_dword v29, s[36:39], s53 offen offset:2048 lds
MAA 144,44,120
TR 98,25,2560
s_add_u32 s53, s53, 128
MAA 144,64,124
buffer_load_dwordx4 v[180:183], v26, s[16:19], s75 offen sc1
MAA 148,68,124
TR 100,25,14464
v_add_f32 v167, v167, v171
MAA 148,48,120
TR 102,25,14976
MAA 152,52,120
MAA 152,72,124
s_waitcnt lgkmcnt(8)
s_barrier
MAA 60,80,0
TR 104,25,32
s_add_u32 m0, s56, 136064
MAA 60,84,20
buffer_load_dwordx4 v18, s[20:23], s54 offen lds
MAA 64,84,24
s_sub_u32 s47, s47, 1
s_cbranch_scc1 .Lx16
.Lx16b:
MAA 64,80,4
TR 106,25,544
s_waitcnt vmcnt(15)
v_add_f32 v164, v164, v172
MAA 68,80,8
TR 108,25,12448
MAA 68,84,28
buffer_load_dwordx4 v19, s[20:23], s54 offen offset:1024 lds
MAA 72,84,32
TR 110,25,12960
MAA 72,80,12
TR 112,25,1056
s_waitcnt lgkmcnt(5)
MAA 244,80,16
TR 114,25,1568
MAA 244,84,36
buffer_load_dwordx4 v20, s[20:23], s54 offen offset:2048 lds
MAA 156,92,36
TR 116,25,13472
s_add_u32 s54, s54, 196608
MAA 156,88,16
TR 118,25,13984
v_add_f32 v165, v165, v173
MAA 104,88,12
TR 120,25,2080
s_add_u32 m0, s55, 36992
MAA 104,92,32
buffer_load_dwordx4 v21, s[36:39], s52 offen lds
MAA 100,92,28
MAA 100,88,8
buffer_load_dwordx4 v28, s[36:39], s52 offen offset:1024 lds
MAA 96,88,4
TR 122,25,2592
MAA 96,92,24
TR 124,25,14496
v_add_f32 v166, v166, v174
MAA 92,92,20
TR 126,25,15008
MAA 92,88,0
buffer_load_dword v22, s[36:39], s52 offen offset:2048 lds
MAA 124,0,96
RD 40,23,55488
s_add_u32 s52, s52, 128
MAA 124,20,100
RD 44,23,57792
MAA 128,24,100
RD 48,23,60096
MAA 128,4,96
buffer_load_dwordx4 v[184:187], v26, s[16:19], s75 offen offset:1024 sc1
MAA 132,8,96
RD 52,23,62400
v_add_f32 v167, v167, v175
MAA 132,28,100
RD 56,24,55488
MAA 136,32,100
MAA 136,12,96
s_waitcnt vmcnt(18) lgkmcnt(5)
s_barrier
MAA 76,104,0
RD 60,30,55488
s_add_u32 m0, s56, 73984
MAA 76,108,20
buffer_load_dwordx4 v18, s[20:23], s54 offen lds
MAA 80,108,24
RD 64,30,57792
s_waitcnt vmcnt(15)
v_add_f32 v164, v164, v176
MAA 80,104,4
RD 68,30,60096
v_add_f32 v165, v165, v177
MAA 84,104,8
buffer_load_dwordx4 v19, s[20:23], s54 offen offset:1024 lds
MAA 84,108,28
RD 72,30,62400
v_add_f32 v166, v166, v178
MAA 88,108,32
RD 76,31,55488
v_add_f32 v167, v167, v179
MAA 88,104,12
buffer_load_dwordx4 v20, s[20:23], s54 offen offset:2048 lds
MAA 160,112,16
TR 80,25,24832
s_add_u32 s54, s54, 196608
MAA 160,116,36
TR 82,25,25344
s_add_u32 m0, s55, 39296
MAA 120,116,32
buffer_load_dwordx4 v21, s[36:39], s53 offen lds
MAA 120,112,12
TR 84,25,37248
MAA 116,112,8
TR 86,25,37760
MAA 116,116,28
buffer_load_dwordx4 v28, s[36:39], s53 offen offset:1024 lds
MAA 112,116,24
TR 88,25,25856
MAA 112,112,4
TR 90,25,26368
MAA 108,112,0
buffer_load_dword v29, s[36:39], s53 offen offset:2048 lds
MAA 108,116,20
TR 92,25,38272
s_add_u32 s53, s53, 128
MAA 140,20,124
TR 94,25,38784
MAA 140,0,120
buffer_load_dwordx4 v[188:191], v26, s[16:19], s75 offen offset:2048 sc1
MAA 144,4,120
TR 96,25,26880
MAA 144,24,124
TR 98,25,27392
MAA 148,28,124
TR 100,25,39296
MAA 148,8,120
TR 102,25,39808
MAA 152,12,120
MAA 152,32,124
s_waitcnt lgkmcnt(8)
s_barrier
MAA 60,80,40
TR 104,25,24864
s_add_u32 m0, s56, 86400
MAA 60,84,60
buffer_load_dwordx4 v18, s[20:23], s54 offen lds
MAA 64,84,64
s_sub_u32 s47, s47, 1
s_cbranch_scc1 .Lx17
.Lx17b:
MAA 64,80,44
TR 106,25,25376
s_waitcnt vmcnt(15)
v_add_f32 v164, v164, v180
MAA 68,80,48
TR 108,25,37280
MAA 68,84,68
buffer_load_dwordx4 v19, s[20:23], s54 offen offset:1024 lds
MAA 72,84,72
TR 110,25,37792
MAA 72,80,52
TR 112,25,25888
s_waitcnt lgkmcnt(5)
MAA 244,80,56
TR 114,25,26400
MAA 244,84,76
buffer_load_dwordx4 v20, s[20:23], s54 offen offset:2048 lds
MAA 156,92,76
TR 116,25,38304
s_add_u32 s54, s54, 196608
MAA 156,88,56
TR 118,25,38816
v_add_f32 v165, v165, v181
MAA 104,88,52
TR 120,25,26912
s_add_u32 m0, s55, 55488
MAA 104,92,72
buffer_load_dwordx4 v21, s[36:39], s52 offen lds
MAA 100,92,68
MAA 100,88,48
buffer_load_dwordx4 v28, s[36:39], s52 offen offset:1024 lds
MAA 96,88,44
TR 122,25,27424
MAA 96,92,64
TR 124,25,39328
v_add_f32 v166, v166, v182
MAA 92,92,60
TR 126,25,39840
MAA 92,88,40
buffer_load_dword v22, s[36:39], s52 offen offset:2048 lds
MAA 124,40,96
ds_read_b128 a[0:3], v23
s_add_u32 s52, s52, 128
MAA 124,60,100
RD 4,23,2304
MAA 128,64,100
RD 8,23,4608
MAA 128,44,96
buffer_load_dwordx4 v[192:195], v26, s[16:19], s75 offen offset:3072 sc1
MAA 132,48,96
RD 12,23,6912
v_add_f32 v167, v167, v183
MAA 132,68,100
ds_read_b128 a[16:19], v24
MAA 136,72,100
MAA 136,52,96
s_waitcnt vmcnt(18) lgkmcnt(5)
s_barrier
MAA 76,104,40
ds_read_b128 a[20:23], v30
s_add_u32 m0, s56, 98816
MAA 76,108,60
buffer_load_dwordx4 v18, s[20:23], s54 offen lds
MAA 80,108,64
RD 24,30,2304
s_waitcnt vmcnt(15)
v_add_f32 v164, v164, v184
MAA 80,104,44
RD 28,30,4608
v_add_f32 v165, v165, v185
MAA 84,104,48
RD 32,30,6912
v_add_f32 v166, v166, v186
MAA 84,108,68
buffer_load_dwordx4 v19, s[20:23], s54 offen offset:1024 lds
MAA 88,108,72
ds_read_b128 a[36:39], v31
v_add_f32 v167, v167, v187
MAA 88,104,52
TR 80,25,49664
MAA 160,112,56
TR 82,25,50176
MAA 160,116,76
buffer_load_dwordx4 v20, s[20:23], s54 offen offset:2048 lds
MAA 120,116,72
TR 84,25,62080
s_add_u32 s54, s54, 196608
MAA 120,112,52
TR 86,25,62592
s_add_u32 m0, s55, 57792
MAA 116,112,48
TR 88,25,50688
MAA 116,116,68
buffer_load_dwordx4 v21, s[36:39], s53 offen lds
MAA 112,116,64
TR 90,25,51200
MAA 112,112,44
TR 92,25,63104
MAA 108,112,40
TR 94,25,63616
MAA 108,116,60
buffer_load_dwordx4 v28, s[36:39], s53 offen offset:1024 lds
MAA 140,60,124
TR 96,25,51712
MAA 140,40,120
TR 98,25,52224
MAA 144,44,120
TR 100,25,64128
MAA 144,64,124
buffer_load_dword v29, s[36:39], s53 offen offset:2048 lds
MAA 148,68,124
TR 102,25,64640
s_add_u32 s53, s53, 128
MAA 148,48,120
MAA 152,52,120
MAA 152,72,124
s_waitcnt lgkmcnt(8)
s_barrier
MAA 60,80,0
TR 104,25,49696
s_add_u32 m0, s56, 111232
MAA 60,84,20
buffer_load_dwordx4 v18, s[20:23], s54 offen lds
MAA 64,84,24
TR 106,25,50208
s_waitcnt vmcnt(14)
v_add_f32 v164, v164, v188
MAA 64,80,4
TR 108,25,62112
v_add_f32 v165, v165, v189
MAA 68,80,8
buffer_load_dwordx4 v19, s[20:23], s54 offen offset:1024 lds
MAA 68,84,28
TR 110,25,62624
v_add_f32 v166, v166, v190
MAA 72,84,32
TR 112,25,50720
v_add_f32 v167, v167, v191
MAA 72,80,12
buffer_load_dwordx4 v20, s[20:23], s54 offen offset:2048 lds
s_waitcnt lgkmcnt(5)
MAA 244,80,16
TR 114,25,51232
s_add_u32 s54, s54, 196608
MAA 244,84,36
TR 116,25,63136
s_add_u32 m0, s59, 0
MAA 156,92,36
TR 118,25,63648
s_xor_b32 s58, s87, 1048576
MAA 156,88,16
buffer_load_dwordx4 v5, s[24:27], s58 offen lds
MAA 104,88,12
TR 120,25,51744
MAA 104,92,32
TR 122,25,52256
MAA 100,92,28
buffer_load_dwordx4 v6, s[24:27], s58 offen offset:1024 lds
MAA 100,88,8
TR 124,25,64160
s_add_u32 m0, s59, 8320
MAA 96,88,4
TR 126,25,64672
s_xor_b32 s58, s87, 1179648
MAA 96,92,24
buffer_load_dwordx4 v5, s[24:27], s58 offen lds
MAA 92,92,20
RD 40,23,18496
MAA 92,88,0
RD 44,23,20800
MAA 124,0,96
buffer_load_dwordx4 v6, s[24:27], s58 offen offset:1024 lds
MAA 124,20,100
RD 48,23,23104
MAA 128,24,100
RD 52,23,25408
MAA 128,4,96
RD 56,24,18496
MAA 132,8,96
MAA 132,28,100
MAA 136,32,100
MAA 136,12,96
s_waitcnt vmcnt(17) lgkmcnt(5)
s_barrier
MAA 76,104,0
RD 60,30,18496
s_add_u32 m0, s56, 123648
MAA 76,108,20
buffer_load_dwordx4 v18, s[20:23], s54 offen lds
MAA 80,108,24
RD 64,30,20800
s_waitcnt vmcnt(14)
v_add_f32 v164, v164, v192
MAA 80,104,4
RD 68,30,23104
v_add_f32 v165, v165, v193
MAA 84,104,8
RD 72,30,25408
v_add_f32 v166, v166, v194
MAA 84,108,28
RD 76,31,18496
v_add_f32 v167, v167, v195
MAA 88,108,32
ds_read_b64_tr_b16 a[80:81], v25
MAA 88,104,12
TR 82,25,512
MAA 160,112,16
TR 84,25,12416
MAA 160,116,36
buffer_load_dwordx4 v19, s[20:23], s54 offen offset:1024 lds
MAA 120,116,32
TR 86,25,12928
MAA 120,112,12
TR 88,25,1024
MAA 116,112,8
TR 90,25,1536
MAA 116,116,28
TR 92,25,13440
MAA 112,116,24
TR 94,25,13952
MAA 112,112,4
TR 96,25,2048
MAA 108,112,0
TR 98,25,2560
MAA 108,116,20
buffer_load_dwordx4 v20, s[20:23], s54 offen offset:2048 lds
MAA 140,20,124
TR 100,25,14464
s_add_u32 s54, s54, 196608
MAA 140,0,120
TR 102,25,14976
MAA 144,4,120
MAA 144,24,124
MAA 148,28,124
MAA 148,8,120
MAA 152,12,120
MAA 152,32,124
s_waitcnt lgkmcnt(8)
s_barrier
MAA 60,80,40
TR 104,25,32
s_add_u32 m0, s56, 136064
MAA 60,84,60
buffer_load_dwordx4 v18, s[20:23], s54 offen lds
MAA 64,84,64
TR 106,25,544
MAA 64,80,44
TR 108,25,12448
MAA 68,80,48
buffer_load_dwordx4 v19, s[20:23], s54 offen offset:1024 lds
MAA 68,84,68
TR 110,25,12960
MAA 72,84,72
TR 112,25,1056
MAA 72,80,52
buffer_load_dwordx4 v20, s[20:23], s54 offen offset:2048 lds
s_waitcnt lgkmcnt(5)
MAA 244,80,56
TR 114,25,1568
s_add_u32 s54, s54, 196608
MAA 244,84,76
TR 116,25,13472
s_add_u32 m0, s59, 16640
MAA 156,92,76
TR 118,25,13984
s_xor_b32 s58, s87, 1310720
MAA 156,88,56
buffer_load_dwordx4 v5, s[24:27], s58 offen lds
MAA 104,88,52
TR 120,25,2080
MAA 104,92,72
TR 122,25,2592
MAA 100,92,68
buffer_load_dwordx4 v6, s[24:27], s58 offen offset:1024 lds
MAA 100,88,48
TR 124,25,14496
s_add_u32 m0, s59, 24960
MAA 96,88,44
TR 126,25,15008
s_xor_b32 s58, s87, 1441792
MAA 96,92,64
buffer_load_dwordx4 v5, s[24:27], s58 offen lds
MAA 92,92,60
RD 0,23,36992
MAA 92,88,40
RD 4,23,39296
MAA 124,40,96
buffer_load_dwordx4 v6, s[24:27], s58 offen offset:1024 lds
MAA 124,60,100
RD 8,23,41600
MAA 128,64,100
RD 12,23,43904
MAA 128,44,96
RD 16,24,36992
MAA 132,48,96
v_permlane32_swap_b32 v164, v166
MAA 132,68,100
v_permlane32_swap_b32 v165, v167
MAA 136,72,100
v_add_f32 v164, v164, v166
v_add_f32 v165, v165, v167
MAA 136,52,96
v_mul_f32 v164, 0xba800000, v164
v_mul_f32 v165, 0x3a800000, v165
v_fma_f32 v165, -v164, v164, v165
v_max_f32 v165, 0, v165
v_add_f32 v165, 0x3727c5ac, v165
v_rsq_f32 v166, v165
s_nop 0
v_mov_b32 v165, v166
v_mul_f32 v166, 0x3e8293ee, v166
s_waitcnt vmcnt(14) lgkmcnt(5)
s_barrier
MAA 76,104,40
ds_write_b128 v7, v[164:167]
s_add_u32 m0, s59, 74880
MAA 76,108,60
.Lpad4:
s_cbranch_execz .Lpad8
ds_write_b32 v17, v164
s_xor_b32 s58, s87, 131072
MAA 80,108,64
ds_write_b32 v17, v165 offset:1024
MAA 80,104,44
buffer_load_dwordx4 v5, s[24:27], s58 offen lds
MAA 84,104,48
RD 20,30,36992
MAA 84,108,68
RD 24,30,39296
MAA 88,108,72
RD 28,30,41600
MAA 88,104,52
RD 32,30,43904
MAA 160,112,56
RD 36,31,36992
MAA 160,116,76
buffer_load_dwordx4 v6, s[24:27], s58 offen offset:1024 lds
MAA 120,116,72
TR 80,25,24832
s_add_u32 m0, s59, 83200
MAA 120,112,52
TR 82,25,25344
s_xor_b32 s58, s87, 262144
MAA 116,112,48
TR 84,25,37248
MAA 116,116,68
TR 86,25,37760
MAA 112,116,64
TR 88,25,25856
MAA 112,112,44
buffer_load_dwordx4 v5, s[24:27], s58 offen lds
MAA 108,112,40
TR 90,25,26368
MAA 108,116,60
TR 92,25,38272
MAA 140,60,124
TR 94,25,38784
MAA 140,40,120
TR 96,25,26880
MAA 144,44,120
TR 98,25,27392
MAA 144,64,124
buffer_load_dwordx4 v6, s[24:27], s58 offen offset:1024 lds
MAA 148,68,124
TR 100,25,39296
MAA 148,48,120
TR 102,25,39808
MAA 152,52,120
MAA 152,72,124
s_waitcnt vmcnt(8) lgkmcnt(0)
s_barrier
MAA 156,88,16
TR 112,25,25888
s_add_u32 m0, s59, 33280
MAA 156,92,36
TR 114,25,26400
s_xor_b32 s58, s87, 1572864
MAA 104,92,32
buffer_load_dwordx4 v5, s[24:27], s58 offen lds
MAA 104,88,12
TR 116,25,38304
MAA 100,88,8
TR 118,25,38816
MAA 100,92,28
TR 120,25,26912
MAA 96,92,24
buffer_load_dwordx4 v6, s[24:27], s58 offen offset:1024 lds
MAA 96,88,4
TR 122,25,27424
s_add_u32 m0, s59, 41600
MAA 92,88,0
TR 124,25,39328
s_xor_b32 s58, s87, 1703936
MAA 92,92,20
TR 126,25,39840
MAA 136,32,100
buffer_load_dwordx4 v5, s[24:27], s58 offen lds
MAA 136,12,96
TR 104,25,24864
MAA 244,80,16
TR 106,25,25376
MAA 244,84,36
TR 108,25,37280
MAA 72,84,32
buffer_load_dwordx4 v6, s[24:27], s58 offen offset:1024 lds
MAA 72,80,12
TR 110,25,37792
MAA 68,80,8
RD 40,23,55488
MAA 68,84,28
RD 44,23,57792
MAA 64,84,24
RD 48,23,60096
MAA 64,80,4
RD 52,23,62400
MAA 60,80,0
RD 56,24,55488
MAA 60,84,20
RD 60,30,55488
s_waitcnt lgkmcnt(15)
MAA 160,112,16
RD 64,30,57792
s_waitcnt lgkmcnt(15)
MAA 160,116,36
s_waitcnt lgkmcnt(7)
s_barrier
RD 68,30,60096
MAA 120,116,32
RD 72,30,62400
s_add_u32 m0, s59, 91520
MAA 120,112,12
RD 76,31,55488
s_xor_b32 s58, s87, 393216
MAA 116,112,8
TR 144,25,50688
MAA 116,116,28
TR 146,25,51200
MAA 112,116,24
TR 148,25,63104
MAA 112,112,4
TR 150,25,63616
MAA 108,112,0
TR 152,25,50720
MAA 108,116,20
TR 154,25,51232
MAA 152,32,124
TR 156,25,63136
MAA 152,12,120
TR 158,25,63648
MAA 88,104,12
TR 160,25,51712
MAA 88,108,32
TR 162,25,52224
MAA 84,108,28
TR 164,25,64128
MAA 84,104,8
TR 166,25,64640
MAA 80,104,4
TR 168,25,51744
MAA 80,108,24
TR 170,25,52256
MAA 76,108,20
TR 172,25,64160
MAA 76,104,0
TR 174,25,64672
s_waitcnt lgkmcnt(14)
MAA 156,144,56
TR 128,25,49664
s_waitcnt lgkmcnt(13)
MAA 156,148,76
TR 130,25,50176
MAA 104,148,72
TR 132,25,62080
MAA 104,144,52
TR 134,25,62592
MAA 100,144,48
TR 136,25,49696
MAA 100,148,68
TR 138,25,50208
MAA 96,148,64
TR 140,25,62112
MAA 96,144,44
TR 142,25,62624
MAA 92,144,40
ds_read_b128 v[232:235], v10 offset:768
MAA 92,148,60
ds_read_b128 v[236:239], v10 offset:2816
s_waitcnt lgkmcnt(15)
MAA 160,156,76
ds_read_b128 v[228:231], v10 offset:512
MAA 160,152,56
ds_read_b128 v[224:227], v10 offset:256
MAA 120,152,52
ds_read_b128 v[220:223], v10
MAA 120,156,72
buffer_load_dwordx4 v5, s[24:27], s58 offen lds
MAA 116,156,68
MAA 116,152,48
MAA 112,152,44
MAA 112,156,64
buffer_load_dwordx4 v6, s[24:27], s58 offen offset:1024 lds
MAA 108,156,60
s_add_u32 m0, s59, 99840
s_xor_b32 s58, s87, 524288
MAA 108,152,40
MAA 136,52,160
s_waitcnt lgkmcnt(15)
MAA 136,72,164
buffer_load_dwordx4 v5, s[24:27], s58 offen lds
s_waitcnt lgkmcnt(13)
MAA 152,72,172
MAA 152,52,168
s_waitcnt lgkmcnt(11)
MAA 244,128,56
s_waitcnt lgkmcnt(9)
MAA 244,132,76
buffer_load_dwordx4 v6, s[24:27], s58 offen offset:1024 lds
MAA 72,132,72
s_add_u32 m0, s59, 108160
s_xor_b32 s58, s87, 655360
MAA 72,128,52
MAA 68,128,48
MAA 68,132,68
buffer_load_dwordx4 v5, s[24:27], s58 offen lds
buffer_load_dwordx4 v6, s[24:27], s58 offen offset:1024 lds
s_mov_b32 exec_lo, 0x10001
s_mov_b32 exec_hi, 0x10001
ds_write_b128 v13, v[244:247]
ds_write_b128 v13, v[156:159] offset:256
ds_write_b128 v13, v[160:163] offset:320
s_mov_b64 exec, -1
MAA 64,128,44
MAA 64,132,64
MAA 60,132,60
MAA 60,128,40
s_waitcnt lgkmcnt(10)
MAA 88,136,52
s_waitcnt lgkmcnt(8)
MAA 88,140,72
s_waitcnt lgkmcnt(0)
s_barrier
MAA 84,136,48
ds_read_b128 v[28:31], v13
MAA 84,140,68
ds_read_b128 v[32:35], v13 offset:64
MAA 80,140,64
ds_read_b128 v[36:39], v13 offset:256
MAA 80,136,44
ds_read_b128 v[40:43], v13 offset:320
MAA 76,136,40
ds_read_b32 v44, v12 offset:512
MAA 76,140,60
ds_read_b32 v45, v12 offset:576
ds_read_b128 v[240:243], v11 offset:192
ds_read_b128 v[244:247], v11 offset:1216
ds_read_b128 v[18:21], v11 offset:128
ds_read_b128 v[22:25], v11 offset:1152
s_waitcnt lgkmcnt(9)
v_pk_fma_f32 v[72:73], v[28:29], v[232:233], v[72:73] op_sel_hi:[1,0,1]
v_cvt_pk_bf16_f32 v176, v72, v73
v_pk_fma_f32 v[74:75], v[30:31], v[232:233], v[74:75] op_sel_hi:[1,0,1]
v_cvt_pk_bf16_f32 v177, v74, v75
s_waitcnt lgkmcnt(8)
v_pk_fma_f32 v[88:89], v[32:33], v[232:233], v[88:89] op_sel_hi:[1,0,1]
v_cvt_pk_bf16_f32 v178, v88, v89
v_pk_fma_f32 v[90:91], v[34:35], v[232:233], v[90:91] op_sel_hi:[1,0,1]
v_cvt_pk_bf16_f32 v179, v90, v91
s_waitcnt lgkmcnt(7)
v_pk_fma_f32 v[104:105], v[36:37], v[232:233], v[104:105] op_sel_hi:[1,0,1]
v_pk_mul_f32 v[104:105], v[104:105], v[232:233] op_sel:[0,1] op_sel_hi:[1,1]
v_cvt_pk_bf16_f32 v196, v104, v105
v_pk_fma_f32 v[106:107], v[38:39], v[232:233], v[106:107] op_sel_hi:[1,0,1]
v_pk_mul_f32 v[106:107], v[106:107], v[232:233] op_sel:[0,1] op_sel_hi:[1,1]
v_cvt_pk_bf16_f32 v197, v106, v107
s_waitcnt lgkmcnt(6)
v_pk_fma_f32 v[120:121], v[40:41], v[232:233], v[120:121] op_sel_hi:[1,0,1]
v_pk_mul_f32 v[120:121], v[120:121], v[232:233] op_sel:[0,1] op_sel_hi:[1,1]
v_cvt_pk_bf16_f32 v198, v120, v121
v_pk_fma_f32 v[122:123], v[42:43], v[232:233], v[122:123] op_sel_hi:[1,0,1]
v_pk_mul_f32 v[122:123], v[122:123], v[232:233] op_sel:[0,1] op_sel_hi:[1,1]
v_cvt_pk_bf16_f32 v199, v122, v123
ds_write_b128 v8, v[196:199]
s_waitcnt lgkmcnt(4)
v_pk_fma_f32 v[136:137], v[240:241], v[44:45], v[136:137] op_sel_hi:[1,0,1]
v_pk_fma_f32 v[138:139], v[242:243], v[44:45], v[138:139] op_sel_hi:[1,0,1]
s_waitcnt lgkmcnt(3)
v_pk_mul_f32 v[136:137], v[136:137], v[244:245]
v_cvt_pk_bf16_f32 v208, v136, v137
v_pk_mul_f32 v[138:139], v[138:139], v[246:247]
v_cvt_pk_bf16_f32 v209, v138, v139
v_pk_fma_f32 v[152:153], v[240:241], v[44:45], v[152:153] op_sel:[0,1,0] op_sel_hi:[1,1,1]
v_pk_mul_f32 v[152:153], v[152:153], v[244:245]
v_cvt_pk_bf16_f32 v218, v152, v153
v_pk_fma_f32 v[154:155], v[242:243], v[44:45], v[154:155] op_sel:[0,1,0] op_sel_hi:[1,1,1]
v_pk_mul_f32 v[154:155], v[154:155], v[246:247]
v_cvt_pk_bf16_f32 v219, v154, v155
ds_write_b64 v8, v[208:209] offset:1024
ds_write_b64 v8, v[218:219] offset:1032
v_pk_fma_f32 v[156:157], v[36:37], v[236:237], v[156:157] op_sel_hi:[1,0,1]
v_pk_mul_f32 v[156:157], v[156:157], v[236:237] op_sel:[0,1] op_sel_hi:[1,1]
v_cvt_pk_bf16_f32 v180, v156, v157
v_pk_fma_f32 v[158:159], v[38:39], v[236:237], v[158:159] op_sel_hi:[1,0,1]
v_pk_mul_f32 v[158:159], v[158:159], v[236:237] op_sel:[0,1] op_sel_hi:[1,1]
v_cvt_pk_bf16_f32 v181, v158, v159
v_pk_fma_f32 v[160:161], v[40:41], v[236:237], v[160:161] op_sel_hi:[1,0,1]
v_pk_mul_f32 v[160:161], v[160:161], v[236:237] op_sel:[0,1] op_sel_hi:[1,1]
v_cvt_pk_bf16_f32 v182, v160, v161
v_pk_fma_f32 v[162:163], v[42:43], v[236:237], v[162:163] op_sel_hi:[1,0,1]
v_pk_mul_f32 v[162:163], v[162:163], v[236:237] op_sel:[0,1] op_sel_hi:[1,1]
v_cvt_pk_bf16_f32 v183, v162, v163
v_pk_fma_f32 v[100:101], v[36:37], v[228:229], v[100:101] op_sel_hi:[1,0,1]
v_pk_mul_f32 v[100:101], v[100:101], v[228:229] op_sel:[0,1] op_sel_hi:[1,1]
v_cvt_pk_bf16_f32 v192, v100, v101
v_pk_fma_f32 v[102:103], v[38:39], v[228:229], v[102:103] op_sel_hi:[1,0,1]
v_pk_mul_f32 v[102:103], v[102:103], v[228:229] op_sel:[0,1] op_sel_hi:[1,1]
v_cvt_pk_bf16_f32 v193, v102, v103
v_pk_fma_f32 v[116:117], v[40:41], v[228:229], v[116:117] op_sel_hi:[1,0,1]
v_pk_mul_f32 v[116:117], v[116:117], v[228:229] op_sel:[0,1] op_sel_hi:[1,1]
v_cvt_pk_bf16_f32 v194, v116, v117
v_pk_fma_f32 v[118:119], v[42:43], v[228:229], v[118:119] op_sel_hi:[1,0,1]
v_pk_mul_f32 v[118:119], v[118:119], v[228:229] op_sel:[0,1] op_sel_hi:[1,1]
s_waitcnt lgkmcnt(0)
s_barrier
v_cvt_pk_bf16_f32 v195, v118, v119
v_pk_fma_f32 v[96:97], v[36:37], v[224:225], v[96:97] op_sel_hi:[1,0,1]
v_pk_mul_f32 v[96:97], v[96:97], v[224:225] op_sel:[0,1] op_sel_hi:[1,1]
v_cvt_pk_bf16_f32 v188, v96, v97
v_pk_fma_f32 v[98:99], v[38:39], v[224:225], v[98:99] op_sel_hi:[1,0,1]
v_pk_mul_f32 v[98:99], v[98:99], v[224:225] op_sel:[0,1] op_sel_hi:[1,1]
v_cvt_pk_bf16_f32 v189, v98, v99
v_pk_fma_f32 v[112:113], v[40:41], v[224:225], v[112:113] op_sel_hi:[1,0,1]
v_pk_mul_f32 v[112:113], v[112:113], v[224:225] op_sel:[0,1] op_sel_hi:[1,1]
v_cvt_pk_bf16_f32 v190, v112, v113
v_pk_fma_f32 v[114:115], v[42:43], v[224:225], v[114:115] op_sel_hi:[1,0,1]
v_pk_mul_f32 v[114:115], v[114:115], v[224:225] op_sel:[0,1] op_sel_hi:[1,1]
v_cvt_pk_bf16_f32 v191, v114, v115
v_pk_fma_f32 v[92:93], v[36:37], v[220:221], v[92:93] op_sel_hi:[1,0,1]
v_pk_mul_f32 v[92:93], v[92:93], v[220:221] op_sel:[0,1] op_sel_hi:[1,1]
v_cvt_pk_bf16_f32 v184, v92, v93
v_pk_fma_f32 v[94:95], v[38:39], v[220:221], v[94:95] op_sel_hi:[1,0,1]
v_pk_mul_f32 v[94:95], v[94:95], v[220:221] op_sel:[0,1] op_sel_hi:[1,1]
v_cvt_pk_bf16_f32 v185, v94, v95
v_pk_fma_f32 v[108:109], v[40:41], v[220:221], v[108:109] op_sel_hi:[1,0,1]
v_pk_mul_f32 v[108:109], v[108:109], v[220:221] op_sel:[0,1] op_sel_hi:[1,1]
v_cvt_pk_bf16_f32 v186, v108, v109
v_pk_fma_f32 v[110:111], v[42:43], v[220:221], v[110:111] op_sel_hi:[1,0,1]
v_pk_mul_f32 v[110:111], v[110:111], v[220:221] op_sel:[0,1] op_sel_hi:[1,1]
v_cvt_pk_bf16_f32 v187, v110, v111
v_pk_fma_f32 v[68:69], v[28:29], v[228:229], v[68:69] op_sel_hi:[1,0,1]
v_cvt_pk_bf16_f32 v172, v68, v69
v_pk_fma_f32 v[70:71], v[30:31], v[228:229], v[70:71] op_sel_hi:[1,0,1]
v_cvt_pk_bf16_f32 v173, v70, v71
v_pk_fma_f32 v[84:85], v[32:33], v[228:229], v[84:85] op_sel_hi:[1,0,1]
v_cvt_pk_bf16_f32 v174, v84, v85
v_pk_fma_f32 v[86:87], v[34:35], v[228:229], v[86:87] op_sel_hi:[1,0,1]
v_cvt_pk_bf16_f32 v175, v86, v87
v_pk_fma_f32 v[64:65], v[28:29], v[224:225], v[64:65] op_sel_hi:[1,0,1]
v_cvt_pk_bf16_f32 v168, v64, v65
v_pk_fma_f32 v[66:67], v[30:31], v[224:225], v[66:67] op_sel_hi:[1,0,1]
v_cvt_pk_bf16_f32 v169, v66, v67
v_pk_fma_f32 v[80:81], v[32:33], v[224:225], v[80:81] op_sel_hi:[1,0,1]
v_cvt_pk_bf16_f32 v170, v80, v81
v_pk_fma_f32 v[82:83], v[34:35], v[224:225], v[82:83] op_sel_hi:[1,0,1]
v_cvt_pk_bf16_f32 v171, v82, v83
v_pk_fma_f32 v[60:61], v[28:29], v[220:221], v[60:61] op_sel_hi:[1,0,1]
v_cvt_pk_bf16_f32 v164, v60, v61
v_pk_fma_f32 v[62:63], v[30:31], v[220:221], v[62:63] op_sel_hi:[1,0,1]
v_cvt_pk_bf16_f32 v165, v62, v63
v_pk_fma_f32 v[76:77], v[32:33], v[220:221], v[76:77] op_sel_hi:[1,0,1]
v_cvt_pk_bf16_f32 v166, v76, v77
v_pk_fma_f32 v[78:79], v[34:35], v[220:221], v[78:79] op_sel_hi:[1,0,1]
v_cvt_pk_bf16_f32 v167, v78, v79
s_nop 0
v_mfma_f32_16x16x32_bf16 v[120:123], v[196:199], v[176:179], v[50:53]
ds_read_b64 v[200:201], v9 offset:1024
v_mfma_f32_16x16x32_bf16 v[104:107], v[192:195], v[176:179], v[46:49]
ds_read_b64 v[210:211], v9 offset:1032
v_mfma_f32_16x16x32_bf16 v[116:119], v[192:195], v[172:175], v[50:53]
ds_read_b128 v[240:243], v11 offset:64
v_mfma_f32_16x16x32_bf16 v[100:103], v[188:191], v[172:175], v[46:49]
ds_read_b128 v[244:247], v11 offset:1088
v_mfma_f32_16x16x32_bf16 v[112:115], v[188:191], v[168:171], v[50:53]
ds_read_b128 v[28:31], v11
v_mfma_f32_16x16x32_bf16 v[96:99], v[184:187], v[168:171], v[46:49]
ds_read_b128 v[32:35], v11 offset:1024
v_max3_f32 v88, v104, v105, v106
v_mfma_f32_16x16x32_bf16 v[108:111], v[184:187], v[164:167], v[50:53]
v_max3_f32 v89, v107, v120, v121
v_max3_f32 v88, v88, v122, v123
v_mfma_f32_16x16x32_bf16 v[92:95], v[180:183], v[164:167], v[54:57]
v_max_f32 v90, v88, v89
v_max_f32 v89, v88, v89
MAA 132,8,96
s_nop 0
v_permlane16_swap_b32 v90, v89
MAA 132,28,100
v_max_f32 v88, v90, v89
v_max_f32 v89, v90, v89
MAA 132,48,160
s_nop 0
v_permlane32_swap_b32 v88, v89
MAA 132,68,164
v_max_f32 v88, v88, v89
v_mul_f32 v88, v88, v234
MAA 148,68,172
v_max3_f32 v84, v100, v101, v102
v_max3_f32 v85, v103, v116, v117
MAA 148,48,168
v_max3_f32 v84, v84, v118, v119
v_max_f32 v86, v84, v85
MAA 148,28,124
v_max_f32 v85, v84, v85
v_max3_f32 v80, v96, v97, v98
MAA 148,8,120
v_permlane16_swap_b32 v86, v85
v_max3_f32 v81, v99, v112, v113
v_max_f32 v84, v86, v85
v_max_f32 v85, v86, v85
v_max3_f32 v80, v80, v114, v115
v_max_f32 v82, v80, v81
v_permlane32_swap_b32 v84, v85
v_max_f32 v81, v80, v81
v_max_f32 v84, v84, v85
v_mul_f32 v84, v84, v230
v_permlane16_swap_b32 v82, v81
v_max3_f32 v76, v92, v93, v94
v_max_f32 v80, v82, v81
v_max_f32 v81, v82, v81
v_max3_f32 v77, v95, v108, v109
v_max3_f32 v76, v76, v110, v111
v_permlane32_swap_b32 v80, v81
v_max_f32 v78, v76, v77
v_max_f32 v80, v80, v81
v_mul_f32 v80, v80, v226
v_max_f32 v77, v76, v77
v_pk_fma_f32 v[104:105], v[104:105], v[234:235], v[88:89] op_sel_hi:[1,0,0] neg_lo:[0,0,1] neg_hi:[0,0,1]
v_pk_fma_f32 v[106:107], v[106:107], v[234:235], v[88:89] op_sel_hi:[1,0,0] neg_lo:[0,0,1] neg_hi:[0,0,1]
v_permlane16_swap_b32 v78, v77
v_pk_fma_f32 v[120:121], v[120:121], v[234:235], v[88:89] op_sel_hi:[1,0,0] neg_lo:[0,0,1] neg_hi:[0,0,1]
v_max_f32 v76, v78, v77
v_max_f32 v77, v78, v77
v_pk_fma_f32 v[122:123], v[122:123], v[234:235], v[88:89] op_sel_hi:[1,0,0] neg_lo:[0,0,1] neg_hi:[0,0,1]
v_pk_fma_f32 v[100:101], v[100:101], v[230:231], v[84:85] op_sel_hi:[1,0,0] neg_lo:[0,0,1] neg_hi:[0,0,1]
v_permlane32_swap_b32 v76, v77
v_pk_fma_f32 v[102:103], v[102:103], v[230:231], v[84:85] op_sel_hi:[1,0,0] neg_lo:[0,0,1] neg_hi:[0,0,1]
v_max_f32 v76, v76, v77
v_mul_f32 v76, v76, v222
v_pk_fma_f32 v[116:117], v[116:117], v[230:231], v[84:85] op_sel_hi:[1,0,0] neg_lo:[0,0,1] neg_hi:[0,0,1]
v_pk_fma_f32 v[118:119], v[118:119], v[230:231], v[84:85] op_sel_hi:[1,0,0] neg_lo:[0,0,1] neg_hi:[0,0,1]
v_pk_fma_f32 v[96:97], v[96:97], v[226:227], v[80:81] op_sel_hi:[1,0,0] neg_lo:[0,0,1] neg_hi:[0,0,1]
v_pk_fma_f32 v[98:99], v[98:99], v[226:227], v[80:81] op_sel_hi:[1,0,0] neg_lo:[0,0,1] neg_hi:[0,0,1]
v_pk_fma_f32 v[112:113], v[112:113], v[226:227], v[80:81] op_sel_hi:[1,0,0] neg_lo:[0,0,1] neg_hi:[0,0,1]
v_pk_fma_f32 v[114:115], v[114:115], v[226:227], v[80:81] op_sel_hi:[1,0,0] neg_lo:[0,0,1] neg_hi:[0,0,1]
v_pk_fma_f32 v[92:93], v[92:93], v[222:223], v[76:77] op_sel_hi:[1,0,0] neg_lo:[0,0,1] neg_hi:[0,0,1]
v_pk_fma_f32 v[94:95], v[94:95], v[222:223], v[76:77] op_sel_hi:[1,0,0] neg_lo:[0,0,1] neg_hi:[0,0,1]
v_pk_fma_f32 v[108:109], v[108:109], v[222:223], v[76:77] op_sel_hi:[1,0,0] neg_lo:[0,0,1] neg_hi:[0,0,1]
v_pk_fma_f32 v[110:111], v[110:111], v[222:223], v[76:77] op_sel_hi:[1,0,0] neg_lo:[0,0,1] neg_hi:[0,0,1]
v_pk_fma_f32 v[132:133], v[18:19], v[44:45], v[132:133] op_sel_hi:[1,0,1]
v_pk_mul_f32 v[132:133], v[132:133], v[22:23]
v_pk_fma_f32 v[134:135], v[20:21], v[44:45], v[134:135] op_sel_hi:[1,0,1]
v_pk_mul_f32 v[134:135], v[134:135], v[24:25]
v_pk_fma_f32 v[148:149], v[18:19], v[44:45], v[148:149] op_sel:[0,1,0] op_sel_hi:[1,1,1]
v_pk_mul_f32 v[148:149], v[148:149], v[22:23]
v_pk_fma_f32 v[150:151], v[20:21], v[44:45], v[150:151] op_sel:[0,1,0] op_sel_hi:[1,1,1]
v_pk_mul_f32 v[150:151], v[150:151], v[24:25]
v_exp_f32 v104, v104
s_nop 0
MAA 128,4,96
v_exp_f32 v105, v105
MAA 128,24,100
v_exp_f32 v106, v106
MAA 128,44,160
v_exp_f32 v107, v107
MAA 128,64,164
v_exp_f32 v120, v120
MAA 144,64,172
v_exp_f32 v121, v121
MAA 144,44,168
v_exp_f32 v122, v122
MAA 144,24,124
v_exp_f32 v123, v123
MAA 144,4,120
v_exp_f32 v100, v100
MAA 124,0,96
v_exp_f32 v101, v101
MAA 124,20,100
v_exp_f32 v102, v102
MAA 124,40,160
v_exp_f32 v103, v103
MAA 124,60,164
v_exp_f32 v116, v116
MAA 140,60,172
v_exp_f32 v117, v117
MAA 140,40,168
v_exp_f32 v118, v118
MAA 140,20,124
v_exp_f32 v119, v119
MAA 140,0,120
v_cvt_pk_bf16_f32 v72, v104, v105
v_cvt_pk_bf16_f32 v73, v106, v107
v_cvt_pk_bf16_f32 v74, v120, v121
v_cvt_pk_bf16_f32 v75, v122, v123
v_cvt_pk_bf16_f32 v68, v100, v101
v_cvt_pk_bf16_f32 v69, v102, v103
v_cvt_pk_bf16_f32 v70, v116, v117
v_cvt_pk_bf16_f32 v71, v118, v119
v_exp_f32 v96, v96
v_exp_f32 v97, v97
v_exp_f32 v98, v98
v_exp_f32 v99, v99
v_exp_f32 v112, v112
v_exp_f32 v113, v113
v_exp_f32 v114, v114
v_exp_f32 v115, v115
v_cvt_pk_bf16_f32 v64, v96, v97
v_cvt_pk_bf16_f32 v65, v98, v99
v_cvt_pk_bf16_f32 v66, v112, v113
v_cvt_pk_bf16_f32 v67, v114, v115
v_cvt_pk_bf16_f32 v206, v132, v133
v_cvt_pk_bf16_f32 v207, v134, v135
v_cvt_pk_bf16_f32 v216, v148, v149
v_cvt_pk_bf16_f32 v217, v150, v151
s_waitcnt lgkmcnt(3)
v_pk_fma_f32 v[128:129], v[240:241], v[44:45], v[128:129] op_sel_hi:[1,0,1]
s_waitcnt lgkmcnt(2)
v_pk_mul_f32 v[128:129], v[128:129], v[244:245]
v_cvt_pk_bf16_f32 v204, v128, v129
v_pk_fma_f32 v[130:131], v[242:243], v[44:45], v[130:131] op_sel_hi:[1,0,1]
v_pk_mul_f32 v[130:131], v[130:131], v[246:247]
v_cvt_pk_bf16_f32 v205, v130, v131
v_pk_fma_f32 v[144:145], v[240:241], v[44:45], v[144:145] op_sel:[0,1,0] op_sel_hi:[1,1,1]
v_pk_mul_f32 v[144:145], v[144:145], v[244:245]
v_cvt_pk_bf16_f32 v214, v144, v145
v_pk_fma_f32 v[146:147], v[242:243], v[44:45], v[146:147] op_sel:[0,1,0] op_sel_hi:[1,1,1]
v_pk_mul_f32 v[146:147], v[146:147], v[246:247]
v_cvt_pk_bf16_f32 v215, v146, v147
s_waitcnt lgkmcnt(1)
v_pk_fma_f32 v[124:125], v[28:29], v[44:45], v[124:125] op_sel_hi:[1,0,1]
s_waitcnt lgkmcnt(0)
v_pk_mul_f32 v[124:125], v[124:125], v[32:33]
v_cvt_pk_bf16_f32 v202, v124, v125
v_pk_fma_f32 v[126:127], v[30:31], v[44:45], v[126:127] op_sel_hi:[1,0,1]
v_pk_mul_f32 v[126:127], v[126:127], v[34:35]
v_cvt_pk_bf16_f32 v203, v126, v127
v_pk_fma_f32 v[140:141], v[28:29], v[44:45], v[140:141] op_sel:[0,1,0] op_sel_hi:[1,1,1]
v_pk_mul_f32 v[140:141], v[140:141], v[32:33]
v_cvt_pk_bf16_f32 v212, v140, v141
v_pk_fma_f32 v[142:143], v[30:31], v[44:45], v[142:143] op_sel:[0,1,0] op_sel_hi:[1,1,1]
v_pk_mul_f32 v[142:143], v[142:143], v[34:35]
v_cvt_pk_bf16_f32 v213, v142, v143
s_nop 0
v_mfma_f32_16x16x32_bf16 v[88:91], v[248:251], v[72:75], 0
v_exp_f32 v92, v92
v_mfma_f32_16x16x32_bf16 v[104:107], v[206:209], v[72:75], 0
v_exp_f32 v93, v93
v_mfma_f32_16x16x32_bf16 v[120:123], v[216:219], v[72:75], 0
v_exp_f32 v94, v94
v_mfma_f32_16x16x32_bf16 v[84:87], v[248:251], v[68:71], 0
v_exp_f32 v95, v95
v_mfma_f32_16x16x32_bf16 v[100:103], v[204:207], v[68:71], 0
v_exp_f32 v108, v108
v_mfma_f32_16x16x32_bf16 v[116:119], v[214:217], v[68:71], 0
v_exp_f32 v109, v109
v_mfma_f32_16x16x32_bf16 v[80:83], v[248:251], v[64:67], 0
v_exp_f32 v110, v110
v_mfma_f32_16x16x32_bf16 v[96:99], v[202:205], v[64:67], 0
v_exp_f32 v111, v111
v_mfma_f32_16x16x32_bf16 v[112:115], v[212:215], v[64:67], 0
v_cvt_pk_bf16_f32 v60, v92, v93
v_cvt_pk_bf16_f32 v61, v94, v95
v_cvt_pk_bf16_f32 v62, v108, v109
v_cvt_pk_bf16_f32 v63, v110, v111
v_rcp_f32 v88, v88
v_rcp_f32 v84, v84
v_mfma_f32_16x16x32_bf16 v[76:79], v[248:251], v[60:63], 0
v_rcp_f32 v80, v80
v_mfma_f32_16x16x32_bf16 v[92:95], v[200:203], v[60:63], 0
v_mfma_f32_16x16x32_bf16 v[108:111], v[210:213], v[60:63], 0
s_nop 4
v_rcp_f32 v76, v76
v_pk_mul_f32 v[104:105], v[104:105], v[88:89] op_sel_hi:[1,0]
v_pk_mul_f32 v[106:107], v[106:107], v[88:89] op_sel_hi:[1,0]
v_pk_mul_f32 v[120:121], v[120:121], v[88:89] op_sel_hi:[1,0]
.Lpad5:
s_cbranch_execz .Lpad9
v_pk_mul_f32 v[122:123], v[122:123], v[88:89] op_sel_hi:[1,0]
v_cvt_pk_bf16_f32 v176, v104, v105
v_cvt_pk_bf16_f32 v177, v106, v107
v_cvt_pk_bf16_f32 v178, v120, v121
v_cvt_pk_bf16_f32 v179, v122, v123
buffer_store_dwordx4 v[176:179], v4, s[16:19], s74 offen offset:3072 sc1
v_pk_mul_f32 v[100:101], v[100:101], v[84:85] op_sel_hi:[1,0]
v_pk_mul_f32 v[102:103], v[102:103], v[84:85] op_sel_hi:[1,0]
v_pk_mul_f32 v[116:117], v[116:117], v[84:85] op_sel_hi:[1,0]
v_pk_mul_f32 v[118:119], v[118:119], v[84:85] op_sel_hi:[1,0]
v_cvt_pk_bf16_f32 v172, v100, v101
v_cvt_pk_bf16_f32 v173, v102, v103
v_cvt_pk_bf16_f32 v174, v116, v117
v_cvt_pk_bf16_f32 v175, v118, v119
buffer_store_dwordx4 v[172:175], v4, s[16:19], s74 offen offset:2048 sc1
v_pk_mul_f32 v[96:97], v[96:97], v[80:81] op_sel_hi:[1,0]
v_pk_mul_f32 v[98:99], v[98:99], v[80:81] op_sel_hi:[1,0]
v_pk_mul_f32 v[112:113], v[112:113], v[80:81] op_sel_hi:[1,0]
v_pk_mul_f32 v[114:115], v[114:115], v[80:81] op_sel_hi:[1,0]
v_cvt_pk_bf16_f32 v168, v96, v97
v_cvt_pk_bf16_f32 v169, v98, v99
v_cvt_pk_bf16_f32 v170, v112, v113
v_cvt_pk_bf16_f32 v171, v114, v115
buffer_store_dwordx4 v[168:171], v4, s[16:19], s74 offen offset:1024 sc1
v_pk_mul_f32 v[92:93], v[92:93], v[76:77] op_sel_hi:[1,0]
v_pk_mul_f32 v[94:95], v[94:95], v[76:77] op_sel_hi:[1,0]
v_pk_mul_f32 v[108:109], v[108:109], v[76:77] op_sel_hi:[1,0]
v_pk_mul_f32 v[110:111], v[110:111], v[76:77] op_sel_hi:[1,0]
v_cvt_pk_bf16_f32 v164, v92, v93
v_cvt_pk_bf16_f32 v165, v94, v95
v_cvt_pk_bf16_f32 v166, v108, v109
v_cvt_pk_bf16_f32 v167, v110, v111
buffer_store_dwordx4 v[164:167], v4, s[16:19], s74 offen sc1
s_nop 1
s_branch .Lqkve2
.Lx4:
buffer_load_dword v27, v14, s[76:79], 0 offen
s_mov_b32 s76, s98
s_mov_b32 s77, s99
s_mov_b32 s78, s100
v_mov_b32 v14, v15
s_mov_b32 s47, 5
s_branch .Lx4b
.Lx5:
buffer_load_dword v27, v14, s[76:79], 0 offen
s_mov_b32 s76, s98
s_mov_b32 s77, s99
s_mov_b32 s78, s100
v_mov_b32 v14, v15
s_mov_b32 s47, 5
s_branch .Lx5b
.Lx6:
buffer_load_dword v27, v14, s[76:79], 0 offen
s_mov_b32 s76, s98
s_mov_b32 s77, s99
s_mov_b32 s78, s100
v_mov_b32 v14, v15
s_mov_b32 s47, 5
s_branch .Lx6b
.Lx7:
buffer_load_dword v27, v14, s[76:79], 0 offen
s_mov_b32 s76, s98
s_mov_b32 s77, s99
s_mov_b32 s78, s100
v_mov_b32 v14, v15
s_mov_b32 s47, 5
s_branch .Lx7b
.Lsp8:
s_mov_b32 s15, 0
.Lsp8l:
v_mov_b32 v37, 0
buffer_atomic_add v37, v34, s[40:43], 0 offen sc0
s_add_u32 s15, s15, 1
s_cmp_gt_u32 s15, 100000
s_waitcnt vmcnt(0)
s_cbranch_scc1 .Lsp8b
v_cmp_gt_u32 vcc, v35, v37
s_nop 0
s_cbranch_vccnz .Lsp8l
s_branch .Lsp8b
.Lx9:
buffer_load_dword v27, v14, s[76:79], 0 offen
s_mov_b32 s76, s98
s_mov_b32 s77, s99
s_mov_b32 s78, s100
v_mov_b32 v14, v15
s_mov_b32 s47, 5
s_branch .Lx9b
.Lx10:
buffer_load_dword v27, v14, s[76:79], 0 offen
s_mov_b32 s76, s98
s_mov_b32 s77, s99
s_mov_b32 s78, s100
v_mov_b32 v14, v15
s_mov_b32 s47, 5
s_branch .Lx10b
.Lx11:
buffer_load_dword v27, v14, s[76:79], 0 offen
s_mov_b32 s76, s98
s_mov_b32 s77, s99
s_mov_b32 s78, s100
v_mov_b32 v14, v15
s_mov_b32 s47, 5
s_branch .Lx11b
.Lx12:
buffer_load_dword v27, v14, s[76:79], 0 offen
s_mov_b32 s76, s98
s_mov_b32 s77, s99
s_mov_b32 s78, s100
v_mov_b32 v14, v15
s_mov_b32 s47, 5
s_branch .Lx12b
.Lsp13:
s_mov_b32 s15, 0
.Lsp13l:
v_mov_b32 v37, 0
buffer_atomic_add v37, v33, s[16:19], 0 offen sc0
s_add_u32 s15, s15, 1
s_cmp_gt_u32 s15, 100000
s_waitcnt vmcnt(0)
s_cbranch_scc1 .Lsp13b
v_cmp_gt_u32 vcc, v36, v37
s_nop 0
s_cbranch_vccnz .Lsp13l
s_branch .Lsp13b
.Lx14:
buffer_load_dword v27, v14, s[76:79], 0 offen
s_mov_b32 s76, s98
s_mov_b32 s77, s99
s_mov_b32 s78, s100
v_mov_b32 v14, v15
s_mov_b32 s47, 5
s_branch .Lx14b
.Lx15:
buffer_load_dword v27, v14, s[76:79], 0 offen
s_mov_b32 s76, s98
s_mov_b32 s77, s99
s_mov_b32 s78, s100
v_mov_b32 v14, v15
s_mov_b32 s47, 5
s_branch .Lx15b
.Lx16:
buffer_load_dword v27, v14, s[76:79], 0 offen
s_mov_b32 s76, s98
s_mov_b32 s77, s99
s_mov_b32 s78, s100
v_mov_b32 v14, v15
s_mov_b32 s47, 5
s_branch .Lx16b
.Lx17:
buffer_load_dword v27, v14, s[76:79], 0 offen
s_mov_b32 s76, s98
s_mov_b32 s77, s99
s_mov_b32 s78, s100
v_mov_b32 v14, v15
s_mov_b32 s47, 5
s_branch .Lx17b
.Lx19:
buffer_load_dword v27, v14, s[76:79], 0 offen
s_mov_b32 s76, s98
s_mov_b32 s77, s99
s_mov_b32 s78, s100
v_mov_b32 v14, v15
s_mov_b32 s47, 5
s_branch .Lx19b
.Lx20:
buffer_load_dword v27, v14, s[76:79], 0 offen
s_mov_b32 s76, s98
s_mov_b32 s77, s99
s_mov_b32 s78, s100
v_mov_b32 v14, v15
s_mov_b32 s47, 5
s_branch .Lx20b
.Lx21:
buffer_load_dword v27, v14, s[76:79], 0 offen
s_mov_b32 s76, s98
s_mov_b32 s77, s99
s_mov_b32 s78, s100
v_mov_b32 v14, v15
s_mov_b32 s47, 5
s_branch .Lx21b
.Lx22:
buffer_load_dword v27, v14, s[76:79], 0 offen
s_mov_b32 s76, s98
s_mov_b32 s77, s99
s_mov_b32 s78, s100
v_mov_b32 v14, v15
s_mov_b32 s47, 5
s_branch .Lx22b
.Lsp23:
s_mov_b32 s15, 0
.Lsp23l:
v_mov_b32 v37, 0
buffer_atomic_add v37, v34, s[40:43], 0 offen sc0
s_add_u32 s15, s15, 1
s_cmp_gt_u32 s15, 100000
s_waitcnt vmcnt(0)
s_cbranch_scc1 .Lsp23b
v_cmp_gt_u32 vcc, v35, v37
s_nop 0
s_cbranch_vccnz .Lsp23l
s_branch .Lsp23b
.Lx24:
buffer_load_dword v27, v14, s[76:79], 0 offen
s_mov_b32 s76, s98
s_mov_b32 s77, s99
s_mov_b32 s78, s100
v_mov_b32 v14, v15
s_mov_b32 s47, 5
s_branch .Lx24b
.Lx25:
buffer_load_dword v27, v14, s[76:79], 0 offen
s_mov_b32 s76, s98
s_mov_b32 s77, s99
s_mov_b32 s78, s100
v_mov_b32 v14, v15
s_mov_b32 s47, 5
s_branch .Lx25b
.Lx26:
buffer_load_dword v27, v14, s[76:79], 0 offen
s_mov_b32 s76, s98
s_mov_b32 s77, s99
s_mov_b32 s78, s100
v_mov_b32 v14, v15
s_mov_b32 s47, 5
s_branch .Lx26b
.Lx27:
buffer_load_dword v27, v14, s[76:79], 0 offen
s_mov_b32 s76, s98
s_mov_b32 s77, s99
s_mov_b32 s78, s100
v_mov_b32 v14, v15
s_mov_b32 s47, 5
s_branch .Lx27b
.Lsp28:
s_mov_b32 s15, 0
.Lsp28l:
v_mov_b32 v37, 0
buffer_atomic_add v37, v33, s[16:19], 0 offen sc0
s_add_u32 s15, s15, 1
s_cmp_gt_u32 s15, 100000
s_waitcnt vmcnt(0)
s_cbranch_scc1 .Lsp28b
v_cmp_gt_u32 vcc, v36, v37
s_nop 0
s_cbranch_vccnz .Lsp28l
s_branch .Lsp28b
.Lx29:
buffer_load_dword v27, v14, s[76:79], 0 offen
s_mov_b32 s76, s98
s_mov_b32 s77, s99
s_mov_b32 s78, s100
v_mov_b32 v14, v15
s_mov_b32 s47, 5
s_branch .Lx29b
.Lx30:
buffer_load_dword v27, v14, s[76:79], 0 offen
s_mov_b32 s76, s98
s_mov_b32 s77, s99
s_mov_b32 s78, s100
v_mov_b32 v14, v15
s_mov_b32 s47, 5
s_branch .Lx30b
.Lx31:
buffer_load_dword v27, v14, s[76:79], 0 offen
s_mov_b32 s76, s98
s_mov_b32 s77, s99
s_mov_b32 s78, s100
v_mov_b32 v14, v15
s_mov_b32 s47, 5
s_branch .Lx31b
.Lx32:
buffer_load_dword v27, v14, s[76:79], 0 offen
s_mov_b32 s76, s98
s_mov_b32 s77, s99
s_mov_b32 s78, s100
v_mov_b32 v14, v15
s_mov_b32 s47, 5
s_branch .Lx32b
.p2align 12
.Lqkv1:
.Lpad6:
s_cbranch_execz .Lpad10
s_cmp_lt_u32 s14, 16
s_cselect_b32 s62, 0, 4096
v_mov_b32 v231, 1
v_lshlrev_b32 v232, 8, v1
s_waitcnt vmcnt(18)
v_permlane16_swap_b32 v164, v166
v_permlane16_swap_b32 v165, v167
s_waitcnt vmcnt(17)
v_permlane16_swap_b32 v168, v170
v_permlane16_swap_b32 v169, v171
s_waitcnt vmcnt(16)
v_permlane16_swap_b32 v172, v174
v_permlane16_swap_b32 v173, v175
s_waitcnt vmcnt(15)
v_permlane16_swap_b32 v176, v178
v_permlane16_swap_b32 v177, v179
buffer_atomic_add v231, v232, s[40:43], s62 offen
v_lshlrev_b32 v192, 16, v164
v_and_b32 v193, 0xffff0000, v164
v_lshlrev_b32 v194, 16, v165
v_and_b32 v195, 0xffff0000, v165
v_lshlrev_b32 v196, 16, v166
v_and_b32 v197, 0xffff0000, v166
v_lshlrev_b32 v198, 16, v167
v_and_b32 v199, 0xffff0000, v167
v_lshlrev_b32 v200, 16, v168
v_and_b32 v201, 0xffff0000, v168
v_lshlrev_b32 v202, 16, v169
v_and_b32 v203, 0xffff0000, v169
v_lshlrev_b32 v204, 16, v170
v_and_b32 v205, 0xffff0000, v170
v_lshlrev_b32 v206, 16, v171
v_and_b32 v207, 0xffff0000, v171
v_lshlrev_b32 v208, 16, v172
v_and_b32 v209, 0xffff0000, v172
v_lshlrev_b32 v210, 16, v173
v_and_b32 v211, 0xffff0000, v173
v_lshlrev_b32 v212, 16, v174
v_and_b32 v213, 0xffff0000, v174
v_lshlrev_b32 v214, 16, v175
v_and_b32 v215, 0xffff0000, v175
v_lshlrev_b32 v216, 16, v176
v_and_b32 v217, 0xffff0000, v176
v_lshlrev_b32 v218, 16, v177
v_and_b32 v219, 0xffff0000, v177
v_lshlrev_b32 v220, 16, v178
v_and_b32 v221, 0xffff0000, v178
v_lshlrev_b32 v222, 16, v179
v_and_b32 v223, 0xffff0000, v179
s_lshl_b32 s64, s6, 14
s_lshl_b32 s65, s49, 13
s_add_u32 s64, s64, s65
s_lshl_b32 s65, s7, 9
s_add_u32 s64, s64, s65
s_lshl_b32 s65, s48, 8
s_add_u32 s64, s64, s65
s_add_u32 s64, s64, 29360128
v_and_b32 v188, 31, v1
v_lshlrev_b32 v188, 3, v188
v_lshrrev_b32 v189, 5, v1
v_lshl_add_u32 v188, v189, 28, v188
s_lshl_b32 s62, s7, 18
s_add_u32 s62, s62, 0
s_add_u32 s63, s62, 131072
v_pk_mul_f32 v[182:183], v[192:193], v[192:193]
v_pk_mul_f32 v[186:187], v[208:209], v[208:209]
v_pk_fma_f32 v[182:183], v[194:195], v[194:195], v[182:183]
v_pk_add_f32 v[180:181], v[192:193], v[194:195]
v_pk_fma_f32 v[186:187], v[210:211], v[210:211], v[186:187]
v_pk_add_f32 v[184:185], v[208:209], v[210:211]
v_pk_fma_f32 v[182:183], v[196:197], v[196:197], v[182:183]
v_pk_add_f32 v[180:181], v[180:181], v[196:197]
v_pk_fma_f32 v[186:187], v[212:213], v[212:213], v[186:187]
v_pk_add_f32 v[184:185], v[184:185], v[212:213]
v_pk_fma_f32 v[182:183], v[198:199], v[198:199], v[182:183]
v_pk_add_f32 v[180:181], v[180:181], v[198:199]
v_pk_fma_f32 v[186:187], v[214:215], v[214:215], v[186:187]
v_pk_add_f32 v[184:185], v[184:185], v[214:215]
v_pk_fma_f32 v[182:183], v[200:201], v[200:201], v[182:183]
v_pk_add_f32 v[180:181], v[180:181], v[200:201]
v_pk_fma_f32 v[186:187], v[216:217], v[216:217], v[186:187]
v_pk_add_f32 v[184:185], v[184:185], v[216:217]
v_pk_fma_f32 v[182:183], v[202:203], v[202:203], v[182:183]
v_pk_add_f32 v[180:181], v[180:181], v[202:203]
v_pk_fma_f32 v[186:187], v[218:219], v[218:219], v[186:187]
v_pk_add_f32 v[184:185], v[184:185], v[218:219]
v_pk_fma_f32 v[182:183], v[204:205], v[204:205], v[182:183]
v_pk_add_f32 v[180:181], v[180:181], v[204:205]
v_pk_fma_f32 v[186:187], v[220:221], v[220:221], v[186:187]
v_pk_add_f32 v[184:185], v[184:185], v[220:221]
v_pk_fma_f32 v[182:183], v[206:207], v[206:207], v[182:183]
v_pk_add_f32 v[180:181], v[180:181], v[206:207]
v_pk_fma_f32 v[186:187], v[222:223], v[222:223], v[186:187]
v_pk_add_f32 v[184:185], v[184:185], v[222:223]
v_add_f32 v180, v180, v181
v_add_f32 v182, v182, v183
v_add_f32 v184, v184, v185
v_add_f32 v186, v186, v187
s_nop 0
v_permlane16_swap_b32 v180, v184
v_permlane16_swap_b32 v182, v186
v_add_f32 v180, v180, v184
v_add_f32 v182, v182, v186
s_nop 1
v_permlane32_swap_b32 v180, v182
v_add_f32 v180, v180, v182
s_nop 1
v_permlane32_swap_b32 v180, v181
buffer_store_dwordx2 v[180:181], v188, s[16:19], s64 offen sc1
s_lshl_b32 s62, s2, 10
s_add_u32 s62, s62, 31457280
s_cmp_eq_u32 s3, 0
s_cselect_b32 s62, s62, 268435456
buffer_store_dwordx4 v[224:227], v230, s[16:19], s62 offen sc1
v_accvgpr_write_b32 a224, v192
v_accvgpr_write_b32 a225, v193
v_accvgpr_write_b32 a226, v194
v_accvgpr_write_b32 a227, v195
v_accvgpr_write_b32 a228, v196
v_accvgpr_write_b32 a229, v197
v_accvgpr_write_b32 a230, v198
v_accvgpr_write_b32 a231, v199
v_accvgpr_write_b32 a232, v200
v_accvgpr_write_b32 a233, v201
v_accvgpr_write_b32 a234, v202
v_accvgpr_write_b32 a235, v203
v_accvgpr_write_b32 a236, v204
v_accvgpr_write_b32 a237, v205
v_accvgpr_write_b32 a238, v206
v_accvgpr_write_b32 a239, v207
v_accvgpr_write_b32 a240, v208
v_accvgpr_write_b32 a241, v209
v_accvgpr_write_b32 a242, v210
v_accvgpr_write_b32 a243, v211
v_accvgpr_write_b32 a244, v212
v_accvgpr_write_b32 a245, v213
v_accvgpr_write_b32 a246, v214
v_accvgpr_write_b32 a247, v215
v_accvgpr_write_b32 a248, v216
v_accvgpr_write_b32 a249, v217
v_accvgpr_write_b32 a250, v218
v_accvgpr_write_b32 a251, v219
v_accvgpr_write_b32 a252, v220
v_accvgpr_write_b32 a253, v221
v_accvgpr_write_b32 a254, v222
v_accvgpr_write_b32 a255, v223
s_add_u32 m0, s55, 18496
s_nop 0
buffer_load_dwordx4 v21, s[36:39], s52 offen lds
buffer_load_dwordx4 v28, s[36:39], s52 offen offset:1024 lds
buffer_load_dword v22, s[36:39], s52 offen offset:2048 lds
s_add_u32 s52, s52, 128
s_add_u32 m0, s55, 20800
s_nop 0
buffer_load_dwordx4 v21, s[36:39], s53 offen lds
buffer_load_dwordx4 v28, s[36:39], s53 offen offset:1024 lds
buffer_load_dword v29, s[36:39], s53 offen offset:2048 lds
s_add_u32 s53, s53, 128
s_add_u32 m0, s56, 73984
s_nop 0
buffer_load_dwordx4 v18, s[20:23], s54 offen lds
buffer_load_dwordx4 v19, s[20:23], s54 offen offset:1024 lds
buffer_load_dwordx4 v20, s[20:23], s54 offen offset:2048 lds
s_add_u32 s54, s54, 196608
s_waitcnt vmcnt(12) lgkmcnt(0)
s_barrier
ds_read_b128 a[0:3], v23
RD 4,23,2304
RD 8,23,4608
RD 12,23,6912
ds_read_b128 a[16:19], v24
ds_read_b128 a[20:23], v30
RD 24,30,2304
RD 28,30,4608
RD 32,30,6912
ds_read_b128 a[36:39], v31
TR 80,25,49664
TR 82,25,50176
TR 84,25,62080
TR 86,25,62592
TR 88,25,50688
TR 90,25,51200
TR 92,25,63104
TR 94,25,63616
TR 96,25,51712
TR 98,25,52224
TR 100,25,64128
TR 102,25,64640
s_waitcnt vmcnt(3) lgkmcnt(0)
s_barrier
v_mfma_f32_16x16x32_bf16 v[60:63], a[80:83], a[0:3], 0
TR 104,25,49696
s_add_u32 m0, s56, 86400
MAA 60,84,20
buffer_load_dwordx4 v18, s[20:23], s54 offen lds
v_mfma_f32_16x16x32_bf16 v[64:67], a[80:83], a[4:7], 0
s_sub_u32 s47, s47, 1
s_cbranch_scc1 .Lx19
.Lx19b:
MAA 64,84,24
buffer_load_dwordx4 v19, s[20:23], s54 offen offset:1024 lds
v_mfma_f32_16x16x32_bf16 v[68:71], a[80:83], a[8:11], 0
TR 106,25,50208
MAA 68,84,28
TR 108,25,62112
TR 110,25,62624
TR 112,25,50720
v_mfma_f32_16x16x32_bf16 v[72:75], a[80:83], a[12:15], 0
TR 114,25,51232
MAA 72,84,32
TR 116,25,63136
TR 118,25,63648
v_mfma_f32_16x16x32_bf16 v[104:107], a[88:91], a[12:15], 0
TR 120,25,51744
MAA 104,92,32
buffer_load_dwordx4 v20, s[20:23], s54 offen offset:2048 lds
v_mfma_f32_16x16x32_bf16 v[100:103], a[88:91], a[8:11], 0
s_add_u32 s54, s54, 196608
s_add_u32 m0, s55, 36992
MAA 100,92,28
buffer_load_dwordx4 v21, s[36:39], s52 offen lds
v_mfma_f32_16x16x32_bf16 v[96:99], a[88:91], a[4:7], 0
TR 122,25,52256
MAA 96,92,24
buffer_load_dwordx4 v28, s[36:39], s52 offen offset:1024 lds
v_mfma_f32_16x16x32_bf16 v[92:95], a[88:91], a[0:3], 0
TR 124,25,64160
MAA 92,92,20
buffer_load_dword v22, s[36:39], s52 offen offset:2048 lds
v_mfma_f32_16x16x32_bf16 v[124:127], a[0:3], a[96:99], 0
s_add_u32 s52, s52, 128
s_add_u32 m0, s55, 39296
MAA 124,20,100
buffer_load_dwordx4 v21, s[36:39], s53 offen lds
v_mfma_f32_16x16x32_bf16 v[128:131], a[4:7], a[96:99], 0
TR 126,25,64672
MAA 128,24,100
buffer_load_dwordx4 v28, s[36:39], s53 offen offset:1024 lds
v_mfma_f32_16x16x32_bf16 v[132:135], a[8:11], a[96:99], 0
RD 40,23,18496
MAA 132,28,100
RD 44,23,20800
RD 48,23,23104
RD 52,23,25408
v_mfma_f32_16x16x32_bf16 v[136:139], a[12:15], a[96:99], 0
RD 56,24,18496
MAA 136,32,100
buffer_load_dword v29, s[36:39], s53 offen offset:2048 lds
v_mfma_f32_16x16x32_bf16 v[156:159], a[16:19], a[96:99], 0
s_add_u32 s53, s53, 128
MAA 156,36,100
s_waitcnt vmcnt(6) lgkmcnt(5)
s_barrier
v_mfma_f32_16x16x32_bf16 v[76:79], a[104:107], a[0:3], 0
RD 60,30,18496
s_add_u32 m0, s56, 98816
MAA 76,108,20
buffer_load_dwordx4 v18, s[20:23], s54 offen lds
v_mfma_f32_16x16x32_bf16 v[80:83], a[104:107], a[4:7], 0
RD 64,30,20800
MAA 80,108,24
buffer_load_dwordx4 v19, s[20:23], s54 offen offset:1024 lds
v_mfma_f32_16x16x32_bf16 v[84:87], a[104:107], a[8:11], 0
RD 68,30,23104
MAA 84,108,28
RD 72,30,25408
v_mfma_f32_16x16x32_bf16 v[88:91], a[104:107], a[12:15], 0
RD 76,31,18496
MAA 88,108,32
buffer_load_dwordx4 v20, s[20:23], s54 offen offset:2048 lds
v_mfma_f32_16x16x32_bf16 v[244:247], a[104:107], a[16:19], 0
s_add_u32 s54, s54, 196608
s_add_u32 m0, s56, 111232
MAA 244,108,36
buffer_load_dwordx4 v18, s[20:23], s54 offen lds
v_mfma_f32_16x16x32_bf16 v[120:123], a[112:115], a[12:15], 0
ds_read_b64_tr_b16 a[80:81], v25
MAA 120,116,32
TR 82,25,512
v_mfma_f32_16x16x32_bf16 v[116:119], a[112:115], a[8:11], 0
TR 84,25,12416
MAA 116,116,28
buffer_load_dwordx4 v19, s[20:23], s54 offen offset:1024 lds
v_mfma_f32_16x16x32_bf16 v[112:115], a[112:115], a[4:7], 0
TR 86,25,12928
MAA 112,116,24
buffer_load_dwordx4 v20, s[20:23], s54 offen offset:2048 lds
v_mfma_f32_16x16x32_bf16 v[108:111], a[112:115], a[0:3], 0
TR 88,25,1024
s_add_u32 s54, s54, 196608
MAA 108,116,20
TR 90,25,1536
v_mfma_f32_16x16x32_bf16 v[140:143], a[0:3], a[120:123], 0
TR 92,25,13440
s_add_u32 m0, s55, 55488
MAA 140,20,124
buffer_load_dwordx4 v21, s[36:39], s52 offen lds
v_mfma_f32_16x16x32_bf16 v[144:147], a[4:7], a[120:123], 0
TR 94,25,13952
MAA 144,24,124
buffer_load_dwordx4 v28, s[36:39], s52 offen offset:1024 lds
v_mfma_f32_16x16x32_bf16 v[148:151], a[8:11], a[120:123], 0
TR 96,25,2048
MAA 148,28,124
TR 98,25,2560
v_mfma_f32_16x16x32_bf16 v[152:155], a[12:15], a[120:123], 0
TR 100,25,14464
MAA 152,32,124
buffer_load_dword v22, s[36:39], s52 offen offset:2048 lds
v_mfma_f32_16x16x32_bf16 v[160:163], a[16:19], a[120:123], 0
TR 102,25,14976
s_add_u32 s52, s52, 128
MAA 160,36,124
s_waitcnt vmcnt(9) lgkmcnt(8)
s_barrier
MAA 60,80,40
TR 104,25,32
s_add_u32 m0, s55, 57792
MAA 60,84,60
buffer_load_dwordx4 v21, s[36:39], s53 offen lds
MAA 64,84,64
s_sub_u32 s47, s47, 1
s_cbranch_scc1 .Lx20
.Lx20b:
MAA 64,80,44
buffer_load_dwordx4 v28, s[36:39], s53 offen offset:1024 lds
MAA 68,80,48
TR 106,25,544
MAA 68,84,68
TR 108,25,12448
TR 110,25,12960
TR 112,25,1056
MAA 72,84,72
TR 114,25,1568
MAA 72,80,52
TR 116,25,13472
TR 118,25,13984
s_waitcnt lgkmcnt(8)
MAA 104,88,52
TR 120,25,2080
MAA 104,92,72
buffer_load_dword v29, s[36:39], s53 offen offset:2048 lds
MAA 100,92,68
s_add_u32 s53, s53, 128
s_add_u32 m0, s56, 123648
MAA 100,88,48
buffer_load_dwordx4 v18, s[20:23], s54 offen lds
MAA 96,88,44
TR 122,25,2592
MAA 96,92,64
buffer_load_dwordx4 v19, s[20:23], s54 offen offset:1024 lds
MAA 92,92,60
TR 124,25,14496
MAA 92,88,40
buffer_load_dwordx4 v20, s[20:23], s54 offen offset:2048 lds
MAA 124,40,96
s_add_u32 s54, s54, 196608
s_add_u32 m0, s56, 136064
MAA 124,60,100
buffer_load_dwordx4 v18, s[20:23], s54 offen lds
MAA 128,64,100
TR 126,25,15008
MAA 128,44,96
buffer_load_dwordx4 v19, s[20:23], s54 offen offset:1024 lds
MAA 132,48,96
RD 0,23,36992
MAA 132,68,100
RD 4,23,39296
RD 8,23,41600
RD 12,23,43904
MAA 136,72,100
RD 16,24,36992
MAA 136,52,96
buffer_load_dwordx4 v20, s[20:23], s54 offen offset:2048 lds
MAA 156,56,96
s_add_u32 s54, s54, 196608
MAA 156,76,100
s_waitcnt vmcnt(12) lgkmcnt(5)
s_barrier
MAA 76,104,40
RD 20,30,36992
s_add_u32 m0, s55, 0
MAA 76,108,60
buffer_load_dwordx4 v21, s[36:39], s52 offen lds
MAA 80,108,64
RD 24,30,39296
MAA 80,104,44
buffer_load_dwordx4 v28, s[36:39], s52 offen offset:1024 lds
MAA 84,104,48
RD 28,30,41600
MAA 84,108,68
RD 32,30,43904
RD 36,31,36992
MAA 88,108,72
TR 80,25,24832
MAA 88,104,52
buffer_load_dword v22, s[36:39], s52 offen offset:2048 lds
MAA 244,104,56
s_add_u32 s52, s52, 128
s_add_u32 m0, s55, 2304
MAA 244,108,76
buffer_load_dwordx4 v21, s[36:39], s53 offen lds
MAA 120,116,72
TR 82,25,25344
MAA 120,112,52
buffer_load_dwordx4 v28, s[36:39], s53 offen offset:1024 lds
MAA 116,112,48
TR 84,25,37248
MAA 116,116,68
TR 86,25,37760
TR 88,25,25856
MAA 112,116,64
TR 90,25,26368
MAA 112,112,44
buffer_load_dword v29, s[36:39], s53 offen offset:2048 lds
MAA 108,112,40
s_add_u32 s53, s53, 128
s_add_u32 m0, s56, 73984
MAA 108,116,60
buffer_load_dwordx4 v18, s[20:23], s54 offen lds
MAA 140,60,124
TR 92,25,38272
MAA 140,40,120
buffer_load_dwordx4 v19, s[20:23], s54 offen offset:1024 lds
MAA 144,44,120
TR 94,25,38784
MAA 144,64,124
buffer_load_dwordx4 v20, s[20:23], s54 offen offset:2048 lds
MAA 148,68,124
TR 96,25,26880
s_add_u32 s54, s54, 196608
MAA 148,48,120
TR 98,25,27392
TR 100,25,39296
MAA 152,52,120
TR 102,25,39808
MAA 152,72,124
buffer_load_dword v37, v34, s[40:43], 0 offen sc1
MAA 160,76,124
MAA 160,56,120
s_waitcnt vmcnt(16) lgkmcnt(8)
s_barrier
MAA 60,80,0
TR 104,25,24864
s_add_u32 m0, s56, 86400
MAA 60,84,20
buffer_load_dwordx4 v18, s[20:23], s54 offen lds
MAA 64,84,24
s_sub_u32 s47, s47, 1
s_cbranch_scc1 .Lx21
.Lx21b:
MAA 64,80,4
buffer_load_dwordx4 v19, s[20:23], s54 offen offset:1024 lds
MAA 68,80,8
TR 106,25,25376
MAA 68,84,28
TR 108,25,37280
TR 110,25,37792
TR 112,25,25888
MAA 72,84,32
TR 114,25,26400
MAA 72,80,12
TR 116,25,38304
TR 118,25,38816
s_waitcnt lgkmcnt(8)
MAA 104,88,12
TR 120,25,26912
MAA 104,92,32
buffer_load_dwordx4 v20, s[20:23], s54 offen offset:2048 lds
MAA 100,92,28
s_add_u32 s54, s54, 196608
s_add_u32 m0, s55, 18496
MAA 100,88,8
buffer_load_dwordx4 v21, s[36:39], s52 offen lds
MAA 96,88,4
TR 122,25,27424
MAA 96,92,24
buffer_load_dwordx4 v28, s[36:39], s52 offen offset:1024 lds
MAA 92,92,20
TR 124,25,39328
MAA 92,88,0
buffer_load_dword v22, s[36:39], s52 offen offset:2048 lds
MAA 124,0,96
s_add_u32 s52, s52, 128
s_add_u32 m0, s55, 20800
MAA 124,20,100
buffer_load_dwordx4 v21, s[36:39], s53 offen lds
MAA 128,24,100
TR 126,25,39840
MAA 128,4,96
buffer_load_dwordx4 v28, s[36:39], s53 offen offset:1024 lds
MAA 132,8,96
RD 40,23,55488
MAA 132,28,100
RD 44,23,57792
RD 48,23,60096
RD 52,23,62400
MAA 136,32,100
RD 56,24,55488
MAA 136,12,96
buffer_load_dword v29, s[36:39], s53 offen offset:2048 lds
MAA 156,16,96
s_add_u32 s53, s53, 128
MAA 156,36,100
s_waitcnt vmcnt(19) lgkmcnt(5)
s_barrier
MAA 76,104,0
RD 60,30,55488
s_add_u32 m0, s56, 98816
MAA 76,108,20
buffer_load_dwordx4 v18, s[20:23], s54 offen lds
MAA 80,108,24
RD 64,30,57792
MAA 80,104,4
buffer_load_dwordx4 v19, s[20:23], s54 offen offset:1024 lds
MAA 84,104,8
RD 68,30,60096
MAA 84,108,28
RD 72,30,62400
MAA 88,108,32
RD 76,31,55488
MAA 88,104,12
buffer_load_dwordx4 v20, s[20:23], s54 offen offset:2048 lds
MAA 244,104,16
s_add_u32 s54, s54, 196608
s_add_u32 m0, s55, 36992
MAA 244,108,36
buffer_load_dwordx4 v21, s[36:39], s52 offen lds
MAA 120,116,32
TR 80,25,49664
MAA 120,112,12
TR 82,25,50176
MAA 116,112,8
TR 84,25,62080
MAA 116,116,28
buffer_load_dwordx4 v28, s[36:39], s52 offen offset:1024 lds
MAA 112,116,24
TR 86,25,62592
MAA 112,112,4
buffer_load_dword v22, s[36:39], s52 offen offset:2048 lds
MAA 108,112,0
TR 88,25,50688
s_add_u32 s52, s52, 128
MAA 108,116,20
TR 90,25,51200
MAA 140,20,124
TR 92,25,63104
s_add_u32 m0, s55, 39296
MAA 140,0,120
buffer_load_dwordx4 v21, s[36:39], s53 offen lds
MAA 144,4,120
TR 94,25,63616
MAA 144,24,124
buffer_load_dwordx4 v28, s[36:39], s53 offen offset:1024 lds
MAA 148,28,124
TR 96,25,51712
MAA 148,8,120
.Lpad7:
s_cbranch_execz .Lt0r
TR 98,25,52224
MAA 152,12,120
TR 100,25,64128
MAA 152,32,124
buffer_load_dword v29, s[36:39], s53 offen offset:2048 lds
MAA 160,36,124
TR 102,25,64640
s_add_u32 s53, s53, 128
MAA 160,16,120
s_waitcnt vmcnt(22) lgkmcnt(8)
s_barrier
MAA 60,80,40
TR 104,25,49696
MAA 60,84,60
TR 106,25,50208
MAA 64,84,64
TR 108,25,62112
s_add_u32 m0, s56, 111232
MAA 64,80,44
buffer_load_dwordx4 v18, s[20:23], s54 offen lds
MAA 68,80,48
s_sub_u32 s47, s47, 1
s_cbranch_scc1 .Lx22
.Lx22b:
MAA 68,84,68
TR 110,25,62624
MAA 72,84,72
TR 112,25,50720
MAA 72,80,52
TR 114,25,51232
s_waitcnt lgkmcnt(6)
MAA 104,88,52
TR 116,25,63136
MAA 104,92,72
buffer_load_dwordx4 v19, s[20:23], s54 offen offset:1024 lds
MAA 100,92,68
TR 118,25,63648
MAA 100,88,48
buffer_load_dwordx4 v20, s[20:23], s54 offen offset:2048 lds
MAA 96,88,44
TR 120,25,51744
s_add_u32 s54, s54, 196608
MAA 96,92,64
TR 122,25,52256
MAA 92,92,60
TR 124,25,64160
s_add_u32 m0, s55, 55488
MAA 92,88,40
buffer_load_dwordx4 v21, s[36:39], s52 offen lds
MAA 124,40,96
TR 126,25,64672
MAA 124,60,100
ds_read_b128 a[0:3], v23
MAA 128,64,100
RD 4,23,2304
MAA 128,44,96
buffer_load_dwordx4 v28, s[36:39], s52 offen offset:1024 lds
MAA 132,48,96
RD 8,23,4608
MAA 132,68,100
RD 12,23,6912
MAA 136,72,100
ds_read_b128 a[16:19], v24
MAA 136,52,96
buffer_load_dword v22, s[36:39], s52 offen offset:2048 lds
MAA 156,56,96
s_add_u32 s52, s52, 128
MAA 156,76,100
s_waitcnt vmcnt(21) lgkmcnt(5)
s_barrier
v_cmp_gt_u32 vcc, v35, v37
s_nop 0
s_cbranch_vccnz .Lsp23
.Lsp23b:
v_mov_b32 v37, 0
MAA 76,104,40
ds_read_b128 a[20:23], v30
MAA 76,108,60
buffer_atomic_add v38, v32, s[16:19], 0 offen
MAA 80,108,64
RD 24,30,2304
MAA 80,104,44
RD 28,30,4608
MAA 84,104,48
RD 32,30,6912
s_add_u32 m0, s56, 123648
MAA 84,108,68
buffer_load_dwordx4 v18, s[20:23], s54 offen lds
MAA 88,108,72
ds_read_b128 a[36:39], v31
MAA 88,104,52
ds_read_b64_tr_b16 a[80:81], v25
MAA 244,104,56
TR 82,25,512
MAA 244,108,76
buffer_load_dwordx4 v19, s[20:23], s54 offen offset:1024 lds
MAA 120,116,72
TR 84,25,12416
MAA 120,112,52
TR 86,25,12928
MAA 116,112,48
MAA 116,116,68
buffer_load_dwordx4 v20, s[20:23], s54 offen offset:2048 lds
MAA 112,116,64
s_add_u32 s54, s54, 196608
s_add_u32 m0, s55, 57792
MAA 112,112,44
buffer_load_dwordx4 v21, s[36:39], s53 offen lds
MAA 108,112,40
TR 88,25,1024
MAA 108,116,60
TR 90,25,1536
MAA 140,60,124
TR 92,25,13440
MAA 140,40,120
buffer_load_dwordx4 v28, s[36:39], s53 offen offset:1024 lds
MAA 144,44,120
TR 94,25,13952
MAA 144,64,124
TR 96,25,2048
MAA 148,68,124
TR 98,25,2560
MAA 148,48,120
buffer_load_dword v29, s[36:39], s53 offen offset:2048 lds
MAA 152,52,120
TR 100,25,14464
s_add_u32 s53, s53, 128
MAA 152,72,124
TR 102,25,14976
MAA 160,76,124
MAA 160,56,120
s_waitcnt vmcnt(22) lgkmcnt(8)
s_barrier
MAA 60,80,0
TR 104,25,32
MAA 60,84,20
TR 106,25,544
MAA 64,84,24
TR 108,25,12448
s_add_u32 m0, s56, 136064
MAA 64,80,4
buffer_load_dwordx4 v18, s[20:23], s54 offen lds
MAA 68,80,8
s_sub_u32 s47, s47, 1
s_cbranch_scc1 .Lx24
.Lx24b:
MAA 68,84,28
TR 110,25,12960
MAA 72,84,32
TR 112,25,1056
MAA 72,80,12
TR 114,25,1568
s_waitcnt lgkmcnt(6)
MAA 104,88,12
TR 116,25,13472
MAA 104,92,32
buffer_load_dwordx4 v19, s[20:23], s54 offen offset:1024 lds
MAA 100,92,28
TR 118,25,13984
MAA 100,88,8
buffer_load_dwordx4 v20, s[20:23], s54 offen offset:2048 lds
MAA 96,88,4
TR 120,25,2080
s_add_u32 s54, s54, 196608
MAA 96,92,24
TR 122,25,2592
MAA 92,92,20
TR 124,25,14496
s_add_u32 m0, s55, 0
MAA 92,88,0
buffer_load_dwordx4 v21, s[36:39], s52 offen lds
MAA 124,0,96
TR 126,25,15008
MAA 124,20,100
RD 40,23,18496
MAA 128,24,100
RD 44,23,20800
MAA 128,4,96
buffer_load_dwordx4 v28, s[36:39], s52 offen offset:1024 lds
MAA 132,8,96
RD 48,23,23104
MAA 132,28,100
RD 52,23,25408
MAA 136,32,100
RD 56,24,18496
MAA 136,12,96
buffer_load_dword v22, s[36:39], s52 offen offset:2048 lds
MAA 156,16,96
s_add_u32 s52, s52, 128
MAA 156,36,100
s_waitcnt vmcnt(16) lgkmcnt(5)
s_barrier
MAA 76,104,0
RD 60,30,18496
MAA 76,108,20
RD 64,30,20800
MAA 80,108,24
RD 68,30,23104
s_add_u32 m0, s56, 73984
MAA 80,104,4
buffer_load_dwordx4 v18, s[20:23], s54 offen lds
MAA 84,104,8
RD 72,30,25408
MAA 84,108,28
RD 76,31,18496
MAA 88,108,32
MAA 88,104,12
buffer_load_dwordx4 v19, s[20:23], s54 offen offset:1024 lds
MAA 244,104,16
TR 80,25,24832
MAA 244,108,36
TR 82,25,25344
MAA 120,116,32
TR 84,25,37248
MAA 120,112,12
buffer_load_dwordx4 v20, s[20:23], s54 offen offset:2048 lds
MAA 116,112,8
TR 86,25,37760
s_add_u32 s54, s54, 196608
MAA 116,116,28
MAA 112,116,24
TR 88,25,25856
MAA 112,112,4
TR 90,25,26368
MAA 108,112,0
TR 92,25,38272
s_add_u32 m0, s55, 2304
MAA 108,116,20
buffer_load_dwordx4 v21, s[36:39], s53 offen lds
MAA 140,20,124
TR 94,25,38784
MAA 140,0,120
MAA 144,4,120
TR 96,25,26880
MAA 144,24,124
buffer_load_dwordx4 v28, s[36:39], s53 offen offset:1024 lds
MAA 148,28,124
TR 98,25,27392
MAA 148,8,120
TR 100,25,39296
MAA 152,12,120
TR 102,25,39808
MAA 152,32,124
buffer_load_dword v29, s[36:39], s53 offen offset:2048 lds
MAA 160,36,124
s_add_u32 s53, s53, 128
MAA 160,16,120
s_waitcnt lgkmcnt(8)
s_barrier
MAA 60,80,40
TR 104,25,24864
MAA 60,84,60
TR 106,25,25376
MAA 64,84,64
TR 108,25,37280
s_add_u32 m0, s56, 86400
MAA 64,80,44
buffer_load_dwordx4 v18, s[20:23], s54 offen lds
MAA 68,80,48
s_sub_u32 s47, s47, 1
s_cbranch_scc1 .Lx25
.Lx25b:
MAA 68,84,68
TR 110,25,37792
MAA 72,84,72
TR 112,25,25888
MAA 72,80,52
TR 114,25,26400
s_waitcnt lgkmcnt(6)
MAA 104,88,52
TR 116,25,38304
MAA 104,92,72
buffer_load_dwordx4 v19, s[20:23], s54 offen offset:1024 lds
MAA 100,92,68
TR 118,25,38816
MAA 100,88,48
buffer_load_dwordx4 v20, s[20:23], s54 offen offset:2048 lds
MAA 96,88,44
TR 120,25,26912
s_add_u32 s54, s54, 196608
MAA 96,92,64
TR 122,25,27424
MAA 92,92,60
TR 124,25,39328
s_add_u32 m0, s55, 18496
MAA 92,88,40
buffer_load_dwordx4 v21, s[36:39], s52 offen lds
MAA 124,40,96
TR 126,25,39840
MAA 124,60,100
RD 0,23,36992
MAA 128,64,100
RD 4,23,39296
MAA 128,44,96
buffer_load_dwordx4 v28, s[36:39], s52 offen offset:1024 lds
MAA 132,48,96
RD 8,23,41600
MAA 132,68,100
RD 12,23,43904
MAA 136,72,100
RD 16,24,36992
MAA 136,52,96
buffer_load_dword v22, s[36:39], s52 offen offset:2048 lds
MAA 156,56,96
s_add_u32 s52, s52, 128
MAA 156,76,100
s_waitcnt vmcnt(15) lgkmcnt(5)
s_barrier
MAA 76,104,40
RD 20,30,36992
s_add_u32 m0, s56, 98816
MAA 76,108,60
buffer_load_dwordx4 v18, s[20:23], s54 offen lds
MAA 80,108,64
RD 24,30,39296
MAA 80,104,44
RD 28,30,41600
MAA 84,104,48
RD 32,30,43904
MAA 84,108,68
buffer_load_dwordx4 v19, s[20:23], s54 offen offset:1024 lds
MAA 88,108,72
RD 36,31,36992
MAA 88,104,52
TR 80,25,49664
MAA 244,104,56
MAA 244,108,76
buffer_load_dwordx4 v20, s[20:23], s54 offen offset:2048 lds
MAA 120,116,72
TR 82,25,50176
s_add_u32 s54, s54, 196608
MAA 120,112,52
TR 84,25,62080
MAA 116,112,48
TR 86,25,62592
s_add_u32 m0, s55, 20800
MAA 116,116,68
buffer_load_dwordx4 v21, s[36:39], s53 offen lds
MAA 112,116,64
TR 88,25,50688
MAA 112,112,44
buffer_load_dwordx4 v28, s[36:39], s53 offen offset:1024 lds
MAA 108,112,40
TR 90,25,51200
MAA 108,116,60
TR 92,25,63104
MAA 140,60,124
MAA 140,40,120
buffer_load_dword v29, s[36:39], s53 offen offset:2048 lds
MAA 144,44,120
TR 94,25,63616
s_add_u32 s53, s53, 128
MAA 144,64,124
TR 96,25,51712
MAA 148,68,124
TR 98,25,52224
MAA 148,48,120
buffer_atomic_add v37, v33, s[16:19], 0 offen sc0
MAA 152,52,120
TR 100,25,64128
MAA 152,72,124
TR 102,25,64640
MAA 160,76,124
MAA 160,56,120
s_waitcnt lgkmcnt(8)
s_barrier
MAA 60,80,0
TR 104,25,49696
MAA 60,84,20
TR 106,25,50208
MAA 64,84,24
TR 108,25,62112
s_add_u32 m0, s56, 111232
MAA 64,80,4
buffer_load_dwordx4 v18, s[20:23], s54 offen lds
MAA 68,80,8
s_sub_u32 s47, s47, 1
s_cbranch_scc1 .Lx26
.Lx26b:
MAA 68,84,28
TR 110,25,62624
MAA 72,84,32
TR 112,25,50720
MAA 72,80,12
TR 114,25,51232
s_waitcnt lgkmcnt(6)
MAA 104,88,12
TR 116,25,63136
MAA 104,92,32
buffer_load_dwordx4 v19, s[20:23], s54 offen offset:1024 lds
MAA 100,92,28
TR 118,25,63648
MAA 100,88,8
buffer_load_dwordx4 v20, s[20:23], s54 offen offset:2048 lds
MAA 96,88,4
TR 120,25,51744
s_add_u32 s54, s54, 196608
MAA 96,92,24
TR 122,25,52256
MAA 92,92,20
TR 124,25,64160
s_add_u32 m0, s55, 36992
MAA 92,88,0
buffer_load_dwordx4 v21, s[36:39], s52 offen lds
MAA 124,0,96
TR 126,25,64672
MAA 124,20,100
RD 40,23,55488
MAA 128,24,100
RD 44,23,57792
MAA 128,4,96
buffer_load_dwordx4 v28, s[36:39], s52 offen offset:1024 lds
MAA 132,8,96
RD 48,23,60096
MAA 132,28,100
RD 52,23,62400
MAA 136,32,100
RD 56,24,55488
MAA 136,12,96
buffer_load_dword v22, s[36:39], s52 offen offset:2048 lds
MAA 156,16,96
s_add_u32 s52, s52, 128
MAA 156,36,100
s_waitcnt vmcnt(16) lgkmcnt(5)
s_barrier
MAA 76,104,0
RD 60,30,55488
MAA 76,108,20
RD 64,30,57792
MAA 80,108,24
RD 68,30,60096
s_add_u32 m0, s56, 123648
MAA 80,104,4
buffer_load_dwordx4 v18, s[20:23], s54 offen lds
MAA 84,104,8
RD 72,30,62400
MAA 84,108,28
RD 76,31,55488
MAA 88,108,32
MAA 88,104,12
buffer_load_dwordx4 v19, s[20:23], s54 offen offset:1024 lds
MAA 244,104,16
ds_read_b64_tr_b16 a[80:81], v25
MAA 244,108,36
TR 82,25,512
MAA 120,116,32
TR 84,25,12416
MAA 120,112,12
buffer_load_dwordx4 v20, s[20:23], s54 offen offset:2048 lds
MAA 116,112,8
TR 86,25,12928
s_add_u32 s54, s54, 196608
MAA 116,116,28
MAA 112,116,24
TR 88,25,1024
MAA 112,112,4
TR 90,25,1536
MAA 108,112,0
TR 92,25,13440
s_add_u32 m0, s55, 39296
MAA 108,116,20
buffer_load_dwordx4 v21, s[36:39], s53 offen lds
MAA 140,20,124
TR 94,25,13952
MAA 140,0,120
MAA 144,4,120
TR 96,25,2048
MAA 144,24,124
buffer_load_dwordx4 v28, s[36:39], s53 offen offset:1024 lds
MAA 148,28,124
TR 98,25,2560
MAA 148,8,120
TR 100,25,14464
MAA 152,12,120
TR 102,25,14976
MAA 152,32,124
buffer_load_dword v29, s[36:39], s53 offen offset:2048 lds
MAA 160,36,124
s_add_u32 s53, s53, 128
MAA 160,16,120
s_waitcnt lgkmcnt(8)
s_barrier
MAA 60,80,40
TR 104,25,32
MAA 60,84,60
TR 106,25,544
MAA 64,84,64
TR 108,25,12448
s_add_u32 m0, s56, 136064
MAA 64,80,44
buffer_load_dwordx4 v18, s[20:23], s54 offen lds
MAA 68,80,48
s_sub_u32 s47, s47, 1
s_cbranch_scc1 .Lx27
.Lx27b:
MAA 68,84,68
TR 110,25,12960
MAA 72,84,72
TR 112,25,1056
MAA 72,80,52
TR 114,25,1568
s_waitcnt lgkmcnt(6)
MAA 104,88,52
TR 116,25,13472
MAA 104,92,72
buffer_load_dwordx4 v19, s[20:23], s54 offen offset:1024 lds
MAA 100,92,68
TR 118,25,13984
MAA 100,88,48
buffer_load_dwordx4 v20, s[20:23], s54 offen offset:2048 lds
MAA 96,88,44
TR 120,25,2080
s_add_u32 s54, s54, 196608
MAA 96,92,64
TR 122,25,2592
MAA 92,92,60
TR 124,25,14496
s_add_u32 m0, s55, 55488
MAA 92,88,40
buffer_load_dwordx4 v21, s[36:39], s52 offen lds
MAA 124,40,96
TR 126,25,15008
MAA 124,60,100
ds_read_b128 a[0:3], v23
MAA 128,64,100
RD 4,23,2304
MAA 128,44,96
buffer_load_dwordx4 v28, s[36:39], s52 offen offset:1024 lds
MAA 132,48,96
RD 8,23,4608
MAA 132,68,100
RD 12,23,6912
MAA 136,72,100
ds_read_b128 a[16:19], v24
MAA 136,52,96
buffer_load_dword v22, s[36:39], s52 offen offset:2048 lds
MAA 156,56,96
.Lpad8:
s_cbranch_execz .Lt0r
s_add_u32 s52, s52, 128
MAA 156,76,100
s_waitcnt vmcnt(18)
v_cmp_gt_u32 vcc, v36, v37
s_nop 0
s_cbranch_vccnz .Lsp28
.Lsp28b:
s_waitcnt vmcnt(15) lgkmcnt(5)
s_barrier
MAA 76,104,40
ds_read_b128 a[20:23], v30
s_add_u32 m0, s56, 73984
MAA 76,108,60
buffer_load_dwordx4 v18, s[20:23], s54 offen lds
MAA 80,108,64
RD 24,30,2304
MAA 80,104,44
RD 28,30,4608
MAA 84,104,48
RD 32,30,6912
MAA 84,108,68
buffer_load_dwordx4 v19, s[20:23], s54 offen offset:1024 lds
MAA 88,108,72
ds_read_b128 a[36:39], v31
MAA 88,104,52
TR 80,25,24832
MAA 244,104,56
MAA 244,108,76
buffer_load_dwordx4 v20, s[20:23], s54 offen offset:2048 lds
MAA 120,116,72
TR 82,25,25344
s_add_u32 s54, s54, 196608
MAA 120,112,52
TR 84,25,37248
MAA 116,112,48
TR 86,25,37760
s_add_u32 m0, s55, 57792
MAA 116,116,68
buffer_load_dwordx4 v21, s[36:39], s53 offen lds
MAA 112,116,64
TR 88,25,25856
MAA 112,112,44
buffer_load_dwordx4 v28, s[36:39], s53 offen offset:1024 lds
MAA 108,112,40
TR 90,25,26368
MAA 108,116,60
TR 92,25,38272
MAA 140,60,124
MAA 140,40,120
buffer_load_dword v29, s[36:39], s53 offen offset:2048 lds
MAA 144,44,120
TR 94,25,38784
s_add_u32 s53, s53, 128
MAA 144,64,124
TR 96,25,26880
MAA 148,68,124
TR 98,25,27392
MAA 148,48,120
buffer_load_dwordx4 v[164:167], v26, s[16:19], s75 offen sc1
MAA 152,52,120
TR 100,25,39296
MAA 152,72,124
TR 102,25,39808
MAA 160,76,124
MAA 160,56,120
s_waitcnt lgkmcnt(8)
s_barrier
MAA 60,80,0
TR 104,25,24864
s_add_u32 m0, s56, 86400
MAA 60,84,20
buffer_load_dwordx4 v18, s[20:23], s54 offen lds
MAA 64,84,24
s_sub_u32 s47, s47, 1
s_cbranch_scc1 .Lx29
.Lx29b:
MAA 64,80,4
TR 106,25,25376
TR 108,25,37280
MAA 68,80,8
TR 110,25,37792
MAA 68,84,28
buffer_load_dwordx4 v19, s[20:23], s54 offen offset:1024 lds
MAA 72,84,32
TR 112,25,25888
MAA 72,80,12
TR 114,25,26400
s_waitcnt lgkmcnt(6)
MAA 104,88,12
MAA 104,92,32
buffer_load_dwordx4 v20, s[20:23], s54 offen offset:2048 lds
MAA 100,92,28
s_add_u32 s54, s54, 196608
s_add_u32 m0, s55, 0
MAA 100,88,8
buffer_load_dwordx4 v21, s[36:39], s52 offen lds
MAA 96,88,4
TR 116,25,38304
MAA 96,92,24
TR 118,25,38816
TR 120,25,26912
MAA 92,92,20
TR 122,25,27424
MAA 92,88,0
buffer_load_dwordx4 v28, s[36:39], s52 offen offset:1024 lds
MAA 124,0,96
TR 124,25,39328
MAA 124,20,100
TR 126,25,39840
MAA 128,24,100
RD 40,23,18496
MAA 128,4,96
buffer_load_dword v22, s[36:39], s52 offen offset:2048 lds
MAA 132,8,96
RD 44,23,20800
s_add_u32 s52, s52, 128
MAA 132,28,100
buffer_load_dwordx4 v[168:171], v26, s[16:19], s75 offen offset:1024 sc1
MAA 136,32,100
RD 48,23,23104
MAA 136,12,96
RD 52,23,25408
RD 56,24,18496
MAA 156,16,96
MAA 156,36,100
s_waitcnt vmcnt(17) lgkmcnt(5)
s_barrier
MAA 76,104,0
RD 60,30,18496
s_add_u32 m0, s56, 98816
MAA 76,108,20
buffer_load_dwordx4 v18, s[20:23], s54 offen lds
MAA 80,108,24
RD 64,30,20800
MAA 80,104,4
RD 68,30,23104
MAA 84,104,8
RD 72,30,25408
MAA 84,108,28
buffer_load_dwordx4 v19, s[20:23], s54 offen offset:1024 lds
MAA 88,108,32
RD 76,31,18496
MAA 88,104,12
TR 80,25,49664
MAA 244,104,16
MAA 244,108,36
buffer_load_dwordx4 v20, s[20:23], s54 offen offset:2048 lds
MAA 120,116,32
TR 82,25,50176
s_add_u32 s54, s54, 196608
MAA 120,112,12
TR 84,25,62080
MAA 116,112,8
TR 86,25,62592
s_add_u32 m0, s55, 2304
MAA 116,116,28
buffer_load_dwordx4 v21, s[36:39], s53 offen lds
MAA 112,116,24
TR 88,25,50688
MAA 112,112,4
buffer_load_dwordx4 v28, s[36:39], s53 offen offset:1024 lds
MAA 108,112,0
TR 90,25,51200
MAA 108,116,20
TR 92,25,63104
MAA 140,20,124
MAA 140,0,120
buffer_load_dword v29, s[36:39], s53 offen offset:2048 lds
MAA 144,4,120
TR 94,25,63616
s_add_u32 s53, s53, 128
MAA 144,24,124
TR 96,25,51712
MAA 148,28,124
TR 98,25,52224
MAA 148,8,120
buffer_load_dwordx4 v[172:175], v26, s[16:19], s75 offen offset:2048 sc1
MAA 152,12,120
TR 100,25,64128
MAA 152,32,124
TR 102,25,64640
MAA 160,36,124
MAA 160,16,120
s_waitcnt lgkmcnt(8)
s_barrier
MAA 60,80,40
TR 104,25,49696
s_add_u32 m0, s56, 111232
MAA 60,84,60
buffer_load_dwordx4 v18, s[20:23], s54 offen lds
MAA 64,84,64
s_sub_u32 s47, s47, 1
s_cbranch_scc1 .Lx30
.Lx30b:
MAA 64,80,44
TR 106,25,50208
TR 108,25,62112
MAA 68,80,48
TR 110,25,62624
MAA 68,84,68
buffer_load_dwordx4 v19, s[20:23], s54 offen offset:1024 lds
MAA 72,84,72
TR 112,25,50720
MAA 72,80,52
TR 114,25,51232
s_waitcnt lgkmcnt(6)
MAA 104,88,52
MAA 104,92,72
buffer_load_dwordx4 v20, s[20:23], s54 offen offset:2048 lds
MAA 100,92,68
s_add_u32 s54, s54, 196608
s_add_u32 m0, s55, 18496
MAA 100,88,48
buffer_load_dwordx4 v21, s[36:39], s52 offen lds
MAA 96,88,44
TR 116,25,63136
MAA 96,92,64
TR 118,25,63648
TR 120,25,51744
MAA 92,92,60
TR 122,25,52256
MAA 92,88,40
buffer_load_dwordx4 v28, s[36:39], s52 offen offset:1024 lds
MAA 124,40,96
TR 124,25,64160
MAA 124,60,100
TR 126,25,64672
MAA 128,64,100
RD 0,23,36992
MAA 128,44,96
buffer_load_dword v22, s[36:39], s52 offen offset:2048 lds
MAA 132,48,96
RD 4,23,39296
s_add_u32 s52, s52, 128
MAA 132,68,100
buffer_load_dwordx4 v[176:179], v26, s[16:19], s75 offen offset:3072 sc1
MAA 136,72,100
RD 8,23,41600
s_add_u32 s75, s75, 4096
MAA 136,52,96
RD 12,23,43904
RD 16,24,36992
MAA 156,56,96
MAA 156,76,100
s_waitcnt vmcnt(18) lgkmcnt(5)
s_barrier
MAA 76,104,40
RD 20,30,36992
s_add_u32 m0, s56, 123648
MAA 76,108,60
buffer_load_dwordx4 v18, s[20:23], s54 offen lds
MAA 80,108,64
RD 24,30,39296
s_waitcnt vmcnt(15)
v_add_f32 v164, v164, v168
MAA 80,104,44
RD 28,30,41600
MAA 84,104,48
RD 32,30,43904
MAA 84,108,68
buffer_load_dwordx4 v19, s[20:23], s54 offen offset:1024 lds
MAA 88,108,72
RD 36,31,36992
MAA 88,104,52
ds_read_b64_tr_b16 a[80:81], v25
v_add_f32 v165, v165, v169
MAA 244,104,56
MAA 244,108,76
buffer_load_dwordx4 v20, s[20:23], s54 offen offset:2048 lds
MAA 120,116,72
TR 82,25,512
s_add_u32 s54, s54, 196608
MAA 120,112,52
TR 84,25,12416
MAA 116,112,48
TR 86,25,12928
s_add_u32 m0, s55, 20800
MAA 116,116,68
buffer_load_dwordx4 v21, s[36:39], s53 offen lds
MAA 112,116,64
TR 88,25,1024
MAA 112,112,44
buffer_load_dwordx4 v28, s[36:39], s53 offen offset:1024 lds
MAA 108,112,40
TR 90,25,1536
v_add_f32 v166, v166, v170
MAA 108,116,60
TR 92,25,13440
MAA 140,60,124
MAA 140,40,120
buffer_load_dword v29, s[36:39], s53 offen offset:2048 lds
MAA 144,44,120
TR 94,25,13952
s_add_u32 s53, s53, 128
MAA 144,64,124
TR 96,25,2048
MAA 148,68,124
TR 98,25,2560
v_add_f32 v167, v167, v171
MAA 148,48,120
buffer_load_dwordx4 v[180:183], v26, s[16:19], s75 offen sc1
MAA 152,52,120
TR 100,25,14464
MAA 152,72,124
TR 102,25,14976
MAA 160,76,124
MAA 160,56,120
s_waitcnt lgkmcnt(8)
s_barrier
MAA 60,80,0
TR 104,25,32
s_add_u32 m0, s56, 136064
MAA 60,84,20
buffer_load_dwordx4 v18, s[20:23], s54 offen lds
MAA 64,84,24
s_sub_u32 s47, s47, 1
s_cbranch_scc1 .Lx31
.Lx31b:
MAA 64,80,4
TR 106,25,544
TR 108,25,12448
MAA 68,80,8
TR 110,25,12960
s_waitcnt vmcnt(15)
v_add_f32 v164, v164, v172
MAA 68,84,28
buffer_load_dwordx4 v19, s[20:23], s54 offen offset:1024 lds
MAA 72,84,32
TR 112,25,1056
MAA 72,80,12
TR 114,25,1568
s_waitcnt lgkmcnt(6)
MAA 104,88,12
v_add_f32 v165, v165, v173
MAA 104,92,32
buffer_load_dwordx4 v20, s[20:23], s54 offen offset:2048 lds
MAA 100,92,28
s_add_u32 s54, s54, 196608
s_add_u32 m0, s55, 36992
MAA 100,88,8
buffer_load_dwordx4 v21, s[36:39], s52 offen lds
MAA 96,88,4
TR 116,25,13472
MAA 96,92,24
TR 118,25,13984
TR 120,25,2080
MAA 92,92,20
TR 122,25,2592
v_add_f32 v166, v166, v174
MAA 92,88,0
buffer_load_dwordx4 v28, s[36:39], s52 offen offset:1024 lds
MAA 124,0,96
TR 124,25,14496
MAA 124,20,100
TR 126,25,15008
MAA 128,24,100
RD 40,23,55488
v_add_f32 v167, v167, v175
MAA 128,4,96
buffer_load_dword v22, s[36:39], s52 offen offset:2048 lds
MAA 132,8,96
RD 44,23,57792
s_add_u32 s52, s52, 128
MAA 132,28,100
buffer_load_dwordx4 v[184:187], v26, s[16:19], s75 offen offset:1024 sc1
MAA 136,32,100
RD 48,23,60096
MAA 136,12,96
RD 52,23,62400
RD 56,24,55488
MAA 156,16,96
MAA 156,36,100
s_waitcnt vmcnt(18) lgkmcnt(5)
s_barrier
MAA 76,104,0
RD 60,30,55488
s_waitcnt vmcnt(14)
v_add_f32 v164, v164, v176
MAA 76,108,20
RD 64,30,57792
s_add_u32 m0, s56, 73984
MAA 80,108,24
buffer_load_dwordx4 v18, s[20:23], s54 offen lds
MAA 80,104,4
RD 68,30,60096
v_add_f32 v165, v165, v177
MAA 84,104,8
RD 72,30,62400
v_add_f32 v166, v166, v178
MAA 84,108,28
buffer_load_dwordx4 v19, s[20:23], s54 offen offset:1024 lds
MAA 88,108,32
RD 76,31,55488
v_add_f32 v167, v167, v179
MAA 88,104,12
TR 80,25,24832
MAA 244,104,16
buffer_load_dwordx4 v20, s[20:23], s54 offen offset:2048 lds
MAA 244,108,36
TR 82,25,25344
s_add_u32 s54, s54, 196608
MAA 120,116,32
TR 84,25,37248
s_add_u32 m0, s55, 39296
MAA 120,112,12
buffer_load_dwordx4 v21, s[36:39], s53 offen lds
MAA 116,112,8
TR 86,25,37760
MAA 116,116,28
TR 88,25,25856
MAA 112,116,24
buffer_load_dwordx4 v28, s[36:39], s53 offen offset:1024 lds
MAA 112,112,4
TR 90,25,26368
MAA 108,112,0
TR 92,25,38272
MAA 108,116,20
buffer_load_dword v29, s[36:39], s53 offen offset:2048 lds
MAA 140,20,124
TR 94,25,38784
s_add_u32 s53, s53, 128
MAA 140,0,120
TR 96,25,26880
MAA 144,4,120
buffer_load_dwordx4 v[188:191], v26, s[16:19], s75 offen offset:2048 sc1
MAA 144,24,124
TR 98,25,27392
MAA 148,28,124
TR 100,25,39296
MAA 148,8,120
TR 102,25,39808
MAA 152,12,120
MAA 152,32,124
MAA 160,36,124
MAA 160,16,120
s_waitcnt lgkmcnt(8)
s_barrier
MAA 60,80,40
TR 104,25,24864
s_add_u32 m0, s56, 86400
MAA 60,84,60
buffer_load_dwordx4 v18, s[20:23], s54 offen lds
MAA 64,84,64
s_sub_u32 s47, s47, 1
s_cbranch_scc1 .Lx32
.Lx32b:
MAA 64,80,44
TR 106,25,25376
TR 108,25,37280
MAA 68,80,48
TR 110,25,37792
s_waitcnt vmcnt(15)
v_add_f32 v164, v164, v180
MAA 68,84,68
buffer_load_dwordx4 v19, s[20:23], s54 offen offset:1024 lds
MAA 72,84,72
TR 112,25,25888
MAA 72,80,52
TR 114,25,26400
s_waitcnt lgkmcnt(6)
MAA 104,88,52
v_add_f32 v165, v165, v181
MAA 104,92,72
buffer_load_dwordx4 v20, s[20:23], s54 offen offset:2048 lds
MAA 100,92,68
s_add_u32 s54, s54, 196608
s_add_u32 m0, s55, 55488
MAA 100,88,48
buffer_load_dwordx4 v21, s[36:39], s52 offen lds
MAA 96,88,44
TR 116,25,38304
MAA 96,92,64
TR 118,25,38816
TR 120,25,26912
MAA 92,92,60
TR 122,25,27424
v_add_f32 v166, v166, v182
MAA 92,88,40
buffer_load_dwordx4 v28, s[36:39], s52 offen offset:1024 lds
MAA 124,40,96
TR 124,25,39328
MAA 124,60,100
TR 126,25,39840
MAA 128,64,100
ds_read_b128 a[0:3], v23
v_add_f32 v167, v167, v183
MAA 128,44,96
buffer_load_dword v22, s[36:39], s52 offen offset:2048 lds
MAA 132,48,96
RD 4,23,2304
s_add_u32 s52, s52, 128
MAA 132,68,100
buffer_load_dwordx4 v[192:195], v26, s[16:19], s75 offen offset:3072 sc1
MAA 136,72,100
RD 8,23,4608
MAA 136,52,96
RD 12,23,6912
ds_read_b128 a[16:19], v24
MAA 156,56,96
MAA 156,76,100
s_waitcnt vmcnt(18) lgkmcnt(5)
s_barrier
MAA 76,104,40
ds_read_b128 a[20:23], v30
s_waitcnt vmcnt(14)
v_add_f32 v164, v164, v184
MAA 76,108,60
RD 24,30,2304
s_add_u32 m0, s56, 98816
MAA 80,108,64
buffer_load_dwordx4 v18, s[20:23], s54 offen lds
MAA 80,104,44
RD 28,30,4608
v_add_f32 v165, v165, v185
MAA 84,104,48
RD 32,30,6912
v_add_f32 v166, v166, v186
MAA 84,108,68
ds_read_b128 a[36:39], v31
v_add_f32 v167, v167, v187
MAA 88,108,72
buffer_load_dwordx4 v19, s[20:23], s54 offen offset:1024 lds
MAA 88,104,52
TR 80,25,49664
MAA 244,104,56
TR 82,25,50176
MAA 244,108,76
TR 84,25,62080
MAA 120,116,72
buffer_load_dwordx4 v20, s[20:23], s54 offen offset:2048 lds
MAA 120,112,52
TR 86,25,62592
s_add_u32 s54, s54, 196608
MAA 116,112,48
TR 88,25,50688
s_add_u32 m0, s55, 57792
MAA 116,116,68
TR 90,25,51200
MAA 112,116,64
buffer_load_dwordx4 v21, s[36:39], s53 offen lds
MAA 112,112,44
TR 92,25,63104
MAA 108,112,40
TR 94,25,63616
MAA 108,116,60
TR 96,25,51712
.Lpad9:
s_cbranch_execz .Lt0r
MAA 140,60,124
buffer_load_dwordx4 v28, s[36:39], s53 offen offset:1024 lds
MAA 140,40,120
TR 98,25,52224
MAA 144,44,120
TR 100,25,64128
MAA 144,64,124
TR 102,25,64640
MAA 148,68,124
buffer_load_dword v29, s[36:39], s53 offen offset:2048 lds
MAA 148,48,120
s_add_u32 s53, s53, 128
MAA 152,52,120
MAA 152,72,124
MAA 160,76,124
MAA 160,56,120
s_waitcnt lgkmcnt(8)
s_barrier
MAA 60,80,0
TR 104,25,49696
s_waitcnt vmcnt(13)
v_add_f32 v164, v164, v188
MAA 60,84,20
TR 106,25,50208
s_add_u32 m0, s56, 111232
MAA 64,84,24
buffer_load_dwordx4 v18, s[20:23], s54 offen lds
MAA 64,80,4
TR 108,25,62112
v_add_f32 v165, v165, v189
MAA 68,80,8
TR 110,25,62624
v_add_f32 v166, v166, v190
MAA 68,84,28
buffer_load_dwordx4 v19, s[20:23], s54 offen offset:1024 lds
MAA 72,84,32
TR 112,25,50720
v_add_f32 v167, v167, v191
MAA 72,80,12
TR 114,25,51232
s_waitcnt lgkmcnt(6)
MAA 104,88,12
buffer_load_dwordx4 v20, s[20:23], s54 offen offset:2048 lds
MAA 104,92,32
TR 116,25,63136
s_add_u32 s54, s54, 196608
MAA 100,92,28
TR 118,25,63648
s_add_u32 m0, s59, 0
MAA 100,88,8
TR 120,25,51744
s_xor_b32 s58, s87, 1048576
MAA 96,88,4
buffer_load_dwordx4 v5, s[24:27], s58 offen lds
MAA 96,92,24
TR 122,25,52256
MAA 92,92,20
TR 124,25,64160
MAA 92,88,0
buffer_load_dwordx4 v6, s[24:27], s58 offen offset:1024 lds
MAA 124,0,96
TR 126,25,64672
s_add_u32 m0, s59, 8320
MAA 124,20,100
RD 40,23,18496
s_xor_b32 s58, s87, 1179648
MAA 128,24,100
buffer_load_dwordx4 v5, s[24:27], s58 offen lds
MAA 128,4,96
RD 44,23,20800
MAA 132,8,96
RD 48,23,23104
MAA 132,28,100
buffer_load_dwordx4 v6, s[24:27], s58 offen offset:1024 lds
MAA 136,32,100
RD 52,23,25408
MAA 136,12,96
RD 56,24,18496
MAA 156,16,96
MAA 156,36,100
s_waitcnt vmcnt(17) lgkmcnt(5)
s_barrier
MAA 76,104,0
RD 60,30,18496
s_waitcnt vmcnt(13)
v_add_f32 v164, v164, v192
MAA 76,108,20
RD 64,30,20800
s_add_u32 m0, s56, 123648
MAA 80,108,24
buffer_load_dwordx4 v18, s[20:23], s54 offen lds
MAA 80,104,4
RD 68,30,23104
v_add_f32 v165, v165, v193
MAA 84,104,8
RD 72,30,25408
v_add_f32 v166, v166, v194
MAA 84,108,28
RD 76,31,18496
v_add_f32 v167, v167, v195
MAA 88,108,32
ds_read_b64_tr_b16 a[80:81], v25
MAA 88,104,12
TR 82,25,512
MAA 244,104,16
TR 84,25,12416
MAA 244,108,36
TR 86,25,12928
MAA 120,116,32
buffer_load_dwordx4 v19, s[20:23], s54 offen offset:1024 lds
MAA 120,112,12
TR 88,25,1024
MAA 116,112,8
TR 90,25,1536
MAA 116,116,28
TR 92,25,13440
MAA 112,116,24
TR 94,25,13952
MAA 112,112,4
TR 96,25,2048
MAA 108,112,0
TR 98,25,2560
MAA 108,116,20
TR 100,25,14464
MAA 140,20,124
buffer_load_dwordx4 v20, s[20:23], s54 offen offset:2048 lds
MAA 140,0,120
TR 102,25,14976
s_add_u32 s54, s54, 196608
MAA 144,4,120
MAA 144,24,124
MAA 148,28,124
MAA 148,8,120
MAA 152,12,120
MAA 152,32,124
MAA 160,36,124
MAA 160,16,120
s_waitcnt lgkmcnt(8)
s_barrier
MAA 60,80,40
TR 104,25,32
MAA 60,84,60
TR 106,25,544
s_add_u32 m0, s56, 136064
MAA 64,84,64
buffer_load_dwordx4 v18, s[20:23], s54 offen lds
MAA 64,80,44
TR 108,25,12448
MAA 68,80,48
TR 110,25,12960
MAA 68,84,68
buffer_load_dwordx4 v19, s[20:23], s54 offen offset:1024 lds
MAA 72,84,72
TR 112,25,1056
MAA 72,80,52
TR 114,25,1568
s_waitcnt lgkmcnt(6)
MAA 104,88,52
buffer_load_dwordx4 v20, s[20:23], s54 offen offset:2048 lds
MAA 104,92,72
TR 116,25,13472
s_add_u32 s54, s54, 196608
MAA 100,92,68
TR 118,25,13984
s_add_u32 m0, s59, 16640
MAA 100,88,48
TR 120,25,2080
s_xor_b32 s58, s87, 1310720
MAA 96,88,44
buffer_load_dwordx4 v5, s[24:27], s58 offen lds
MAA 96,92,64
TR 122,25,2592
MAA 92,92,60
TR 124,25,14496
MAA 92,88,40
buffer_load_dwordx4 v6, s[24:27], s58 offen offset:1024 lds
MAA 124,40,96
TR 126,25,15008
s_add_u32 m0, s59, 24960
MAA 124,60,100
RD 0,23,36992
s_xor_b32 s58, s87, 1441792
MAA 128,64,100
buffer_load_dwordx4 v5, s[24:27], s58 offen lds
MAA 128,44,96
RD 4,23,39296
MAA 132,48,96
RD 8,23,41600
MAA 132,68,100
buffer_load_dwordx4 v6, s[24:27], s58 offen offset:1024 lds
MAA 136,72,100
RD 12,23,43904
MAA 136,52,96
RD 16,24,36992
MAA 156,56,96
v_permlane32_swap_b32 v164, v166
MAA 156,76,100
v_permlane32_swap_b32 v165, v167
v_add_f32 v164, v164, v166
v_add_f32 v165, v165, v167
v_mul_f32 v164, 0xba800000, v164
v_mul_f32 v165, 0x3a800000, v165
v_fma_f32 v165, -v164, v164, v165
v_max_f32 v165, 0, v165
v_add_f32 v165, 0x3727c5ac, v165
v_rsq_f32 v166, v165
s_nop 0
v_mov_b32 v165, v166
v_mul_f32 v166, 0x3e8293ee, v166
s_waitcnt vmcnt(14) lgkmcnt(5)
s_barrier
MAA 76,104,40
ds_write_b128 v7, v[164:167]
MAA 76,108,60
ds_write_b32 v17, v164
s_add_u32 m0, s59, 74880
MAA 80,108,64
ds_write_b32 v17, v165 offset:1024
s_xor_b32 s58, s87, 131072
MAA 80,104,44
buffer_load_dwordx4 v5, s[24:27], s58 offen lds
MAA 84,104,48
RD 20,30,36992
MAA 84,108,68
RD 24,30,39296
MAA 88,108,72
RD 28,30,41600
MAA 88,104,52
RD 32,30,43904
MAA 244,104,56
RD 36,31,36992
MAA 244,108,76
buffer_load_dwordx4 v6, s[24:27], s58 offen offset:1024 lds
MAA 120,116,72
TR 80,25,24832
s_add_u32 m0, s59, 83200
MAA 120,112,52
TR 82,25,25344
s_xor_b32 s58, s87, 262144
MAA 116,112,48
TR 84,25,37248
MAA 116,116,68
TR 86,25,37760
MAA 112,116,64
TR 88,25,25856
MAA 112,112,44
buffer_load_dwordx4 v5, s[24:27], s58 offen lds
MAA 108,112,40
TR 90,25,26368
MAA 108,116,60
TR 92,25,38272
MAA 140,60,124
TR 94,25,38784
MAA 140,40,120
TR 96,25,26880
MAA 144,44,120
TR 98,25,27392
MAA 144,64,124
buffer_load_dwordx4 v6, s[24:27], s58 offen offset:1024 lds
MAA 148,68,124
TR 100,25,39296
MAA 148,48,120
TR 102,25,39808
MAA 152,52,120
MAA 152,72,124
MAA 160,76,124
MAA 160,56,120
s_waitcnt vmcnt(8) lgkmcnt(0)
s_barrier
MAA 104,88,12
TR 112,25,25888
s_add_u32 m0, s59, 33280
MAA 104,92,32
TR 114,25,26400
s_xor_b32 s58, s87, 1572864
MAA 100,92,28
buffer_load_dwordx4 v5, s[24:27], s58 offen lds
MAA 100,88,8
TR 116,25,38304
MAA 96,88,4
TR 118,25,38816
MAA 96,92,24
TR 120,25,26912
MAA 92,92,20
buffer_load_dwordx4 v6, s[24:27], s58 offen offset:1024 lds
MAA 92,88,0
TR 122,25,27424
s_add_u32 m0, s59, 41600
MAA 156,16,96
TR 124,25,39328
s_xor_b32 s58, s87, 1703936
MAA 156,36,100
TR 126,25,39840
MAA 72,84,32
buffer_load_dwordx4 v5, s[24:27], s58 offen lds
MAA 72,80,12
TR 104,25,24864
MAA 68,80,8
TR 106,25,25376
MAA 68,84,28
TR 108,25,37280
MAA 64,84,24
buffer_load_dwordx4 v6, s[24:27], s58 offen offset:1024 lds
MAA 64,80,4
TR 110,25,37792
MAA 60,80,0
RD 40,23,55488
MAA 60,84,20
RD 44,23,57792
s_waitcnt lgkmcnt(12)
MAA 120,112,12
RD 48,23,60096
s_waitcnt lgkmcnt(11)
MAA 120,116,32
RD 52,23,62400
MAA 116,116,28
RD 56,24,55488
MAA 116,112,8
RD 60,30,55488
MAA 112,112,4
RD 64,30,57792
MAA 112,116,24
s_waitcnt lgkmcnt(7)
s_barrier
RD 68,30,60096
MAA 108,116,20
RD 72,30,62400
s_add_u32 m0, s59, 91520
MAA 108,112,0
RD 76,31,55488
s_xor_b32 s58, s87, 393216
MAA 160,16,120
TR 144,25,50688
MAA 160,36,124
TR 146,25,51200
MAA 244,108,36
TR 148,25,63104
MAA 244,104,16
TR 150,25,63616
MAA 88,104,12
TR 152,25,50720
MAA 88,108,32
TR 154,25,51232
MAA 84,108,28
TR 156,25,63136
MAA 84,104,8
TR 158,25,63648
MAA 80,104,4
TR 160,25,51712
MAA 80,108,24
TR 162,25,52224
MAA 76,108,20
TR 164,25,64128
MAA 76,104,0
TR 166,25,64640
s_waitcnt lgkmcnt(10)
MAA 104,144,52
TR 168,25,51744
s_waitcnt lgkmcnt(9)
MAA 104,148,72
TR 170,25,52256
MAA 100,148,68
TR 172,25,64160
MAA 100,144,48
TR 174,25,64672
MAA 96,144,44
TR 136,25,49696
MAA 96,148,64
TR 138,25,50208
MAA 92,148,60
TR 140,25,62112
MAA 92,144,40
TR 142,25,62624
s_waitcnt lgkmcnt(14)
MAA 120,152,52
TR 128,25,49664
s_waitcnt lgkmcnt(13)
MAA 120,156,72
TR 130,25,50176
MAA 116,156,68
TR 132,25,62080
MAA 116,152,48
TR 134,25,62592
MAA 112,152,44
ds_read_b128 v[232:235], v10 offset:1792
MAA 112,156,64
ds_read_b128 v[228:231], v10 offset:1536
MAA 108,156,60
ds_read_b128 v[224:227], v10 offset:1280
MAA 108,152,40
ds_read_b128 v[220:223], v10 offset:1024
s_waitcnt lgkmcnt(15)
MAA 156,56,160
buffer_load_dwordx4 v5, s[24:27], s58 offen lds
MAA 156,76,164
s_waitcnt lgkmcnt(12)
MAA 160,76,172
MAA 160,56,168
s_waitcnt lgkmcnt(10)
MAA 244,136,56
buffer_load_dwordx4 v6, s[24:27], s58 offen offset:1024 lds
s_waitcnt lgkmcnt(8)
MAA 244,140,76
s_add_u32 m0, s59, 99840
s_xor_b32 s58, s87, 524288
MAA 88,140,72
MAA 88,136,52
MAA 84,136,48
buffer_load_dwordx4 v5, s[24:27], s58 offen lds
MAA 84,140,68
buffer_load_dwordx4 v6, s[24:27], s58 offen offset:1024 lds
s_add_u32 m0, s59, 108160
s_xor_b32 s58, s87, 655360
buffer_load_dwordx4 v5, s[24:27], s58 offen lds
buffer_load_dwordx4 v6, s[24:27], s58 offen offset:1024 lds
s_mov_b32 exec_lo, 0x10001
s_mov_b32 exec_hi, 0x10001
ds_write_b128 v13, v[244:247] offset:64
s_mov_b64 exec, 0xffff
ds_write_b32 v12, v156 offset:512
ds_write_b32 v12, v160 offset:576
s_mov_b64 exec, -1
MAA 80,136,44
MAA 80,140,64
MAA 76,140,60
MAA 76,136,40
s_waitcnt lgkmcnt(9)
MAA 72,128,52
s_waitcnt lgkmcnt(7)
MAA 72,132,72
s_waitcnt lgkmcnt(0)
s_barrier
MAA 68,128,48
ds_read_b128 v[28:31], v13
MAA 68,132,68
ds_read_b128 v[32:35], v13 offset:64
MAA 64,132,64
ds_read_b128 v[36:39], v13 offset:256
MAA 64,128,44
ds_read_b128 v[40:43], v13 offset:320
MAA 60,128,40
ds_read_b32 v44, v12 offset:512
MAA 60,132,60
ds_read_b32 v45, v12 offset:576
ds_read_b128 v[240:243], v11 offset:704
ds_read_b128 v[244:247], v11 offset:1728
ds_read_b128 v[18:21], v11 offset:448
ds_read_b128 v[22:25], v11 offset:1472
s_waitcnt lgkmcnt(9)
v_pk_fma_f32 v[72:73], v[28:29], v[232:233], v[72:73] op_sel_hi:[1,0,1]
v_cvt_pk_bf16_f32 v176, v72, v73
v_pk_fma_f32 v[74:75], v[30:31], v[232:233], v[74:75] op_sel_hi:[1,0,1]
v_cvt_pk_bf16_f32 v177, v74, v75
s_waitcnt lgkmcnt(8)
v_pk_fma_f32 v[88:89], v[32:33], v[232:233], v[88:89] op_sel_hi:[1,0,1]
v_cvt_pk_bf16_f32 v178, v88, v89
v_pk_fma_f32 v[90:91], v[34:35], v[232:233], v[90:91] op_sel_hi:[1,0,1]
v_cvt_pk_bf16_f32 v179, v90, v91
s_waitcnt lgkmcnt(7)
v_pk_fma_f32 v[104:105], v[36:37], v[232:233], v[104:105] op_sel_hi:[1,0,1]
v_pk_mul_f32 v[104:105], v[104:105], v[232:233] op_sel:[0,1] op_sel_hi:[1,1]
v_cvt_pk_bf16_f32 v196, v104, v105
v_pk_fma_f32 v[106:107], v[38:39], v[232:233], v[106:107] op_sel_hi:[1,0,1]
v_pk_mul_f32 v[106:107], v[106:107], v[232:233] op_sel:[0,1] op_sel_hi:[1,1]
v_cvt_pk_bf16_f32 v197, v106, v107
s_waitcnt lgkmcnt(6)
v_pk_fma_f32 v[120:121], v[40:41], v[232:233], v[120:121] op_sel_hi:[1,0,1]
v_pk_mul_f32 v[120:121], v[120:121], v[232:233] op_sel:[0,1] op_sel_hi:[1,1]
v_cvt_pk_bf16_f32 v198, v120, v121
v_pk_fma_f32 v[122:123], v[42:43], v[232:233], v[122:123] op_sel_hi:[1,0,1]
v_pk_mul_f32 v[122:123], v[122:123], v[232:233] op_sel:[0,1] op_sel_hi:[1,1]
v_cvt_pk_bf16_f32 v199, v122, v123
v_pk_fma_f32 v[100:101], v[36:37], v[228:229], v[100:101] op_sel_hi:[1,0,1]
v_pk_mul_f32 v[100:101], v[100:101], v[228:229] op_sel:[0,1] op_sel_hi:[1,1]
s_waitcnt lgkmcnt(3)
v_pk_fma_f32 v[156:157], v[240:241], v[44:45], v[156:157] op_sel_hi:[1,0,1]
v_pk_fma_f32 v[158:159], v[242:243], v[44:45], v[158:159] op_sel_hi:[1,0,1]
s_waitcnt lgkmcnt(2)
v_pk_mul_f32 v[156:157], v[156:157], v[244:245]
v_cvt_pk_bf16_f32 v236, v156, v157
v_pk_mul_f32 v[158:159], v[158:159], v[246:247]
v_cvt_pk_bf16_f32 v237, v158, v159
v_pk_fma_f32 v[160:161], v[240:241], v[44:45], v[160:161] op_sel:[0,1,0] op_sel_hi:[1,1,1]
v_pk_mul_f32 v[160:161], v[160:161], v[244:245]
v_cvt_pk_bf16_f32 v238, v160, v161
v_pk_fma_f32 v[162:163], v[242:243], v[44:45], v[162:163] op_sel:[0,1,0] op_sel_hi:[1,1,1]
v_pk_mul_f32 v[162:163], v[162:163], v[246:247]
v_cvt_pk_bf16_f32 v239, v162, v163
ds_write_b128 v8, v[236:239] offset:1024
v_cvt_pk_bf16_f32 v192, v100, v101
v_pk_fma_f32 v[102:103], v[38:39], v[228:229], v[102:103] op_sel_hi:[1,0,1]
v_pk_mul_f32 v[102:103], v[102:103], v[228:229] op_sel:[0,1] op_sel_hi:[1,1]
v_cvt_pk_bf16_f32 v193, v102, v103
v_pk_fma_f32 v[116:117], v[40:41], v[228:229], v[116:117] op_sel_hi:[1,0,1]
v_pk_mul_f32 v[116:117], v[116:117], v[228:229] op_sel:[0,1] op_sel_hi:[1,1]
v_cvt_pk_bf16_f32 v194, v116, v117
v_pk_fma_f32 v[118:119], v[42:43], v[228:229], v[118:119] op_sel_hi:[1,0,1]
v_pk_mul_f32 v[118:119], v[118:119], v[228:229] op_sel:[0,1] op_sel_hi:[1,1]
v_cvt_pk_bf16_f32 v195, v118, v119
v_pk_fma_f32 v[96:97], v[36:37], v[224:225], v[96:97] op_sel_hi:[1,0,1]
v_pk_mul_f32 v[96:97], v[96:97], v[224:225] op_sel:[0,1] op_sel_hi:[1,1]
v_cvt_pk_bf16_f32 v188, v96, v97
v_pk_fma_f32 v[98:99], v[38:39], v[224:225], v[98:99] op_sel_hi:[1,0,1]
v_pk_mul_f32 v[98:99], v[98:99], v[224:225] op_sel:[0,1] op_sel_hi:[1,1]
v_cvt_pk_bf16_f32 v189, v98, v99
v_pk_fma_f32 v[112:113], v[40:41], v[224:225], v[112:113] op_sel_hi:[1,0,1]
v_pk_mul_f32 v[112:113], v[112:113], v[224:225] op_sel:[0,1] op_sel_hi:[1,1]
v_cvt_pk_bf16_f32 v190, v112, v113
v_pk_fma_f32 v[114:115], v[42:43], v[224:225], v[114:115] op_sel_hi:[1,0,1]
v_pk_mul_f32 v[114:115], v[114:115], v[224:225] op_sel:[0,1] op_sel_hi:[1,1]
v_cvt_pk_bf16_f32 v191, v114, v115
v_pk_fma_f32 v[92:93], v[36:37], v[220:221], v[92:93] op_sel_hi:[1,0,1]
v_pk_mul_f32 v[92:93], v[92:93], v[220:221] op_sel:[0,1] op_sel_hi:[1,1]
v_cvt_pk_bf16_f32 v184, v92, v93
v_pk_fma_f32 v[94:95], v[38:39], v[220:221], v[94:95] op_sel_hi:[1,0,1]
v_pk_mul_f32 v[94:95], v[94:95], v[220:221] op_sel:[0,1] op_sel_hi:[1,1]
v_cvt_pk_bf16_f32 v185, v94, v95
v_pk_fma_f32 v[108:109], v[40:41], v[220:221], v[108:109] op_sel_hi:[1,0,1]
v_pk_mul_f32 v[108:109], v[108:109], v[220:221] op_sel:[0,1] op_sel_hi:[1,1]
v_cvt_pk_bf16_f32 v186, v108, v109
v_pk_fma_f32 v[110:111], v[42:43], v[220:221], v[110:111] op_sel_hi:[1,0,1]
v_pk_mul_f32 v[110:111], v[110:111], v[220:221] op_sel:[0,1] op_sel_hi:[1,1]
v_cvt_pk_bf16_f32 v187, v110, v111
v_pk_fma_f32 v[68:69], v[28:29], v[228:229], v[68:69] op_sel_hi:[1,0,1]
v_cvt_pk_bf16_f32 v172, v68, v69
v_pk_fma_f32 v[70:71], v[30:31], v[228:229], v[70:71] op_sel_hi:[1,0,1]
v_cvt_pk_bf16_f32 v173, v70, v71
v_pk_fma_f32 v[84:85], v[32:33], v[228:229], v[84:85] op_sel_hi:[1,0,1]
v_cvt_pk_bf16_f32 v174, v84, v85
v_pk_fma_f32 v[86:87], v[34:35], v[228:229], v[86:87] op_sel_hi:[1,0,1]
v_cvt_pk_bf16_f32 v175, v86, v87
v_pk_fma_f32 v[64:65], v[28:29], v[224:225], v[64:65] op_sel_hi:[1,0,1]
v_cvt_pk_bf16_f32 v168, v64, v65
v_pk_fma_f32 v[66:67], v[30:31], v[224:225], v[66:67] op_sel_hi:[1,0,1]
v_cvt_pk_bf16_f32 v169, v66, v67
v_pk_fma_f32 v[80:81], v[32:33], v[224:225], v[80:81] op_sel_hi:[1,0,1]
v_cvt_pk_bf16_f32 v170, v80, v81
v_pk_fma_f32 v[82:83], v[34:35], v[224:225], v[82:83] op_sel_hi:[1,0,1]
v_cvt_pk_bf16_f32 v171, v82, v83
.Lpad10:
s_cbranch_execz .Lt0r
v_pk_fma_f32 v[60:61], v[28:29], v[220:221], v[60:61] op_sel_hi:[1,0,1]
v_cvt_pk_bf16_f32 v164, v60, v61
v_pk_fma_f32 v[62:63], v[30:31], v[220:221], v[62:63] op_sel_hi:[1,0,1]
v_cvt_pk_bf16_f32 v165, v62, v63
v_pk_fma_f32 v[76:77], v[32:33], v[220:221], v[76:77] op_sel_hi:[1,0,1]
v_cvt_pk_bf16_f32 v166, v76, v77
v_pk_fma_f32 v[78:79], v[34:35], v[220:221], v[78:79] op_sel_hi:[1,0,1]
s_waitcnt lgkmcnt(0)
s_barrier
v_cvt_pk_bf16_f32 v167, v78, v79
v_mfma_f32_16x16x32_bf16 v[120:123], v[196:199], v[176:179], v[50:53]
ds_read_b128 v[180:183], v9
v_mfma_f32_16x16x32_bf16 v[104:107], v[192:195], v[176:179], v[46:49]
ds_read_b64 v[200:201], v9 offset:1024
v_mfma_f32_16x16x32_bf16 v[116:119], v[192:195], v[172:175], v[50:53]
ds_read_b64 v[210:211], v9 offset:1032
v_mfma_f32_16x16x32_bf16 v[100:103], v[188:191], v[172:175], v[46:49]
ds_read_b128 v[240:243], v11 offset:384
v_mfma_f32_16x16x32_bf16 v[112:115], v[188:191], v[168:171], v[50:53]
ds_read_b128 v[244:247], v11 offset:1408
v_mfma_f32_16x16x32_bf16 v[96:99], v[184:187], v[168:171], v[46:49]
ds_read_b128 v[28:31], v11 offset:320
v_max3_f32 v88, v104, v105, v106
v_mfma_f32_16x16x32_bf16 v[108:111], v[184:187], v[164:167], v[50:53]
ds_read_b128 v[32:35], v11 offset:1344
v_max3_f32 v89, v107, v120, v121
v_max3_f32 v88, v88, v122, v123
v_max_f32 v90, v88, v89
v_max_f32 v89, v88, v89
v_max3_f32 v84, v100, v101, v102
v_max3_f32 v85, v103, v116, v117
s_waitcnt lgkmcnt(6)
v_mfma_f32_16x16x32_bf16 v[92:95], v[180:183], v[164:167], v[46:49]
ds_read_b128 v[36:39], v11 offset:256
v_permlane16_swap_b32 v90, v89
MAA 136,12,96
ds_read_b128 v[40:43], v11 offset:1280
v_max_f32 v88, v90, v89
MAA 136,32,100
v_max_f32 v89, v90, v89
v_max3_f32 v84, v84, v118, v119
MAA 136,52,160
v_permlane32_swap_b32 v88, v89
MAA 136,72,164
v_max_f32 v88, v88, v89
v_mul_f32 v88, v88, v234
MAA 152,72,172
v_max_f32 v86, v84, v85
v_max_f32 v85, v84, v85
MAA 152,52,168
s_nop 0
v_permlane16_swap_b32 v86, v85
MAA 152,32,124
v_max_f32 v84, v86, v85
v_max_f32 v85, v86, v85
MAA 152,12,120
s_nop 0
v_permlane32_swap_b32 v84, v85
v_max3_f32 v80, v96, v97, v98
v_max_f32 v84, v84, v85
v_mul_f32 v84, v84, v230
v_max3_f32 v81, v99, v112, v113
v_max3_f32 v80, v80, v114, v115
v_max_f32 v82, v80, v81
v_max_f32 v81, v80, v81
v_max3_f32 v76, v92, v93, v94
v_max3_f32 v77, v95, v108, v109
v_permlane16_swap_b32 v82, v81
v_max3_f32 v76, v76, v110, v111
v_max_f32 v80, v82, v81
v_max_f32 v81, v82, v81
v_max_f32 v78, v76, v77
v_max_f32 v77, v76, v77
v_permlane32_swap_b32 v80, v81
v_pk_fma_f32 v[104:105], v[104:105], v[234:235], v[88:89] op_sel_hi:[1,0,0] neg_lo:[0,0,1] neg_hi:[0,0,1]
v_max_f32 v80, v80, v81
v_mul_f32 v80, v80, v226
v_permlane16_swap_b32 v78, v77
v_pk_fma_f32 v[106:107], v[106:107], v[234:235], v[88:89] op_sel_hi:[1,0,0] neg_lo:[0,0,1] neg_hi:[0,0,1]
v_max_f32 v76, v78, v77
v_max_f32 v77, v78, v77
v_pk_fma_f32 v[120:121], v[120:121], v[234:235], v[88:89] op_sel_hi:[1,0,0] neg_lo:[0,0,1] neg_hi:[0,0,1]
v_pk_fma_f32 v[122:123], v[122:123], v[234:235], v[88:89] op_sel_hi:[1,0,0] neg_lo:[0,0,1] neg_hi:[0,0,1]
v_permlane32_swap_b32 v76, v77
v_pk_fma_f32 v[100:101], v[100:101], v[230:231], v[84:85] op_sel_hi:[1,0,0] neg_lo:[0,0,1] neg_hi:[0,0,1]
v_max_f32 v76, v76, v77
v_mul_f32 v76, v76, v222
v_pk_fma_f32 v[102:103], v[102:103], v[230:231], v[84:85] op_sel_hi:[1,0,0] neg_lo:[0,0,1] neg_hi:[0,0,1]
v_pk_fma_f32 v[116:117], v[116:117], v[230:231], v[84:85] op_sel_hi:[1,0,0] neg_lo:[0,0,1] neg_hi:[0,0,1]
v_pk_fma_f32 v[118:119], v[118:119], v[230:231], v[84:85] op_sel_hi:[1,0,0] neg_lo:[0,0,1] neg_hi:[0,0,1]
v_pk_fma_f32 v[96:97], v[96:97], v[226:227], v[80:81] op_sel_hi:[1,0,0] neg_lo:[0,0,1] neg_hi:[0,0,1]
v_pk_fma_f32 v[98:99], v[98:99], v[226:227], v[80:81] op_sel_hi:[1,0,0] neg_lo:[0,0,1] neg_hi:[0,0,1]
v_pk_fma_f32 v[112:113], v[112:113], v[226:227], v[80:81] op_sel_hi:[1,0,0] neg_lo:[0,0,1] neg_hi:[0,0,1]
v_pk_fma_f32 v[114:115], v[114:115], v[226:227], v[80:81] op_sel_hi:[1,0,0] neg_lo:[0,0,1] neg_hi:[0,0,1]
v_pk_fma_f32 v[92:93], v[92:93], v[222:223], v[76:77] op_sel_hi:[1,0,0] neg_lo:[0,0,1] neg_hi:[0,0,1]
v_pk_fma_f32 v[94:95], v[94:95], v[222:223], v[76:77] op_sel_hi:[1,0,0] neg_lo:[0,0,1] neg_hi:[0,0,1]
v_pk_fma_f32 v[108:109], v[108:109], v[222:223], v[76:77] op_sel_hi:[1,0,0] neg_lo:[0,0,1] neg_hi:[0,0,1]
v_pk_fma_f32 v[110:111], v[110:111], v[222:223], v[76:77] op_sel_hi:[1,0,0] neg_lo:[0,0,1] neg_hi:[0,0,1]
v_pk_fma_f32 v[136:137], v[18:19], v[44:45], v[136:137] op_sel_hi:[1,0,1]
v_pk_mul_f32 v[136:137], v[136:137], v[22:23]
v_pk_fma_f32 v[138:139], v[20:21], v[44:45], v[138:139] op_sel_hi:[1,0,1]
v_pk_mul_f32 v[138:139], v[138:139], v[24:25]
v_pk_fma_f32 v[152:153], v[18:19], v[44:45], v[152:153] op_sel:[0,1,0] op_sel_hi:[1,1,1]
v_pk_mul_f32 v[152:153], v[152:153], v[22:23]
v_pk_fma_f32 v[154:155], v[20:21], v[44:45], v[154:155] op_sel:[0,1,0] op_sel_hi:[1,1,1]
v_pk_mul_f32 v[154:155], v[154:155], v[24:25]
v_exp_f32 v104, v104
s_nop 0
MAA 132,8,96
v_exp_f32 v105, v105
MAA 132,28,100
v_exp_f32 v106, v106
MAA 132,48,160
v_exp_f32 v107, v107
MAA 132,68,164
v_exp_f32 v120, v120
MAA 148,68,172
v_exp_f32 v121, v121
MAA 148,48,168
v_exp_f32 v122, v122
MAA 148,28,124
v_exp_f32 v123, v123
MAA 148,8,120
v_exp_f32 v100, v100
MAA 128,4,96
v_exp_f32 v101, v101
MAA 128,24,100
v_exp_f32 v102, v102
MAA 128,44,160
v_exp_f32 v103, v103
MAA 128,64,164
v_exp_f32 v116, v116
MAA 144,64,172
v_exp_f32 v117, v117
MAA 144,44,168
v_exp_f32 v118, v118
MAA 144,24,124
v_exp_f32 v119, v119
MAA 144,4,120
v_exp_f32 v96, v96
MAA 124,0,96
v_exp_f32 v97, v97
MAA 124,20,100
v_exp_f32 v98, v98
MAA 124,40,160
v_exp_f32 v99, v99
MAA 124,60,164
v_exp_f32 v112, v112
MAA 140,60,172
v_exp_f32 v113, v113
MAA 140,40,168
v_exp_f32 v114, v114
MAA 140,20,124
v_exp_f32 v115, v115
MAA 140,0,120
v_cvt_pk_bf16_f32 v72, v104, v105
v_cvt_pk_bf16_f32 v73, v106, v107
v_cvt_pk_bf16_f32 v74, v120, v121
v_cvt_pk_bf16_f32 v75, v122, v123
v_cvt_pk_bf16_f32 v68, v100, v101
v_cvt_pk_bf16_f32 v69, v102, v103
v_cvt_pk_bf16_f32 v70, v116, v117
v_cvt_pk_bf16_f32 v71, v118, v119
v_cvt_pk_bf16_f32 v64, v96, v97
v_cvt_pk_bf16_f32 v65, v98, v99
v_cvt_pk_bf16_f32 v66, v112, v113
v_cvt_pk_bf16_f32 v67, v114, v115
v_cvt_pk_bf16_f32 v208, v136, v137
v_cvt_pk_bf16_f32 v209, v138, v139
v_cvt_pk_bf16_f32 v218, v152, v153
v_cvt_pk_bf16_f32 v219, v154, v155
s_waitcnt lgkmcnt(5)
v_pk_fma_f32 v[132:133], v[240:241], v[44:45], v[132:133] op_sel_hi:[1,0,1]
s_waitcnt lgkmcnt(4)
v_pk_mul_f32 v[132:133], v[132:133], v[244:245]
v_cvt_pk_bf16_f32 v206, v132, v133
v_pk_fma_f32 v[134:135], v[242:243], v[44:45], v[134:135] op_sel_hi:[1,0,1]
v_pk_mul_f32 v[134:135], v[134:135], v[246:247]
v_cvt_pk_bf16_f32 v207, v134, v135
v_pk_fma_f32 v[148:149], v[240:241], v[44:45], v[148:149] op_sel:[0,1,0] op_sel_hi:[1,1,1]
v_pk_mul_f32 v[148:149], v[148:149], v[244:245]
v_cvt_pk_bf16_f32 v216, v148, v149
v_pk_fma_f32 v[150:151], v[242:243], v[44:45], v[150:151] op_sel:[0,1,0] op_sel_hi:[1,1,1]
v_pk_mul_f32 v[150:151], v[150:151], v[246:247]
v_cvt_pk_bf16_f32 v217, v150, v151
s_waitcnt lgkmcnt(3)
v_pk_fma_f32 v[128:129], v[28:29], v[44:45], v[128:129] op_sel_hi:[1,0,1]
s_waitcnt lgkmcnt(2)
v_pk_mul_f32 v[128:129], v[128:129], v[32:33]
v_cvt_pk_bf16_f32 v204, v128, v129
v_pk_fma_f32 v[130:131], v[30:31], v[44:45], v[130:131] op_sel_hi:[1,0,1]
v_pk_mul_f32 v[130:131], v[130:131], v[34:35]
v_cvt_pk_bf16_f32 v205, v130, v131
v_pk_fma_f32 v[144:145], v[28:29], v[44:45], v[144:145] op_sel:[0,1,0] op_sel_hi:[1,1,1]
v_pk_mul_f32 v[144:145], v[144:145], v[32:33]
v_cvt_pk_bf16_f32 v214, v144, v145
v_pk_fma_f32 v[146:147], v[30:31], v[44:45], v[146:147] op_sel:[0,1,0] op_sel_hi:[1,1,1]
v_pk_mul_f32 v[146:147], v[146:147], v[34:35]
v_cvt_pk_bf16_f32 v215, v146, v147
s_waitcnt lgkmcnt(1)
v_pk_fma_f32 v[124:125], v[36:37], v[44:45], v[124:125] op_sel_hi:[1,0,1]
s_waitcnt lgkmcnt(0)
v_pk_mul_f32 v[124:125], v[124:125], v[40:41]
v_cvt_pk_bf16_f32 v202, v124, v125
v_pk_fma_f32 v[126:127], v[38:39], v[44:45], v[126:127] op_sel_hi:[1,0,1]
v_pk_mul_f32 v[126:127], v[126:127], v[42:43]
v_cvt_pk_bf16_f32 v203, v126, v127
v_pk_fma_f32 v[140:141], v[36:37], v[44:45], v[140:141] op_sel:[0,1,0] op_sel_hi:[1,1,1]
v_pk_mul_f32 v[140:141], v[140:141], v[40:41]
v_cvt_pk_bf16_f32 v212, v140, v141
v_pk_fma_f32 v[142:143], v[38:39], v[44:45], v[142:143] op_sel:[0,1,0] op_sel_hi:[1,1,1]
v_pk_mul_f32 v[142:143], v[142:143], v[42:43]
v_cvt_pk_bf16_f32 v213, v142, v143
s_nop 0
v_mfma_f32_16x16x32_bf16 v[88:91], v[248:251], v[72:75], 0
v_exp_f32 v92, v92
v_mfma_f32_16x16x32_bf16 v[104:107], v[206:209], v[72:75], 0
v_exp_f32 v93, v93
v_mfma_f32_16x16x32_bf16 v[120:123], v[216:219], v[72:75], 0
v_exp_f32 v94, v94
v_mfma_f32_16x16x32_bf16 v[84:87], v[248:251], v[68:71], 0
v_exp_f32 v95, v95
v_mfma_f32_16x16x32_bf16 v[100:103], v[204:207], v[68:71], 0
v_exp_f32 v108, v108
v_mfma_f32_16x16x32_bf16 v[116:119], v[214:217], v[68:71], 0
v_exp_f32 v109, v109
v_mfma_f32_16x16x32_bf16 v[80:83], v[248:251], v[64:67], 0
v_exp_f32 v110, v110
v_mfma_f32_16x16x32_bf16 v[96:99], v[202:205], v[64:67], 0
v_exp_f32 v111, v111
v_mfma_f32_16x16x32_bf16 v[112:115], v[212:215], v[64:67], 0
v_cvt_pk_bf16_f32 v60, v92, v93
v_cvt_pk_bf16_f32 v61, v94, v95
v_cvt_pk_bf16_f32 v62, v108, v109
v_cvt_pk_bf16_f32 v63, v110, v111
v_rcp_f32 v88, v88
v_rcp_f32 v84, v84
v_mfma_f32_16x16x32_bf16 v[76:79], v[248:251], v[60:63], 0
v_rcp_f32 v80, v80
v_mfma_f32_16x16x32_bf16 v[92:95], v[200:203], v[60:63], 0
v_mfma_f32_16x16x32_bf16 v[108:111], v[210:213], v[60:63], 0
s_nop 4
v_rcp_f32 v76, v76
v_pk_mul_f32 v[104:105], v[104:105], v[88:89] op_sel_hi:[1,0]
v_pk_mul_f32 v[106:107], v[106:107], v[88:89] op_sel_hi:[1,0]
v_pk_mul_f32 v[120:121], v[120:121], v[88:89] op_sel_hi:[1,0]
v_pk_mul_f32 v[122:123], v[122:123], v[88:89] op_sel_hi:[1,0]
v_cvt_pk_bf16_f32 v176, v104, v105
v_cvt_pk_bf16_f32 v177, v106, v107
v_cvt_pk_bf16_f32 v178, v120, v121
v_cvt_pk_bf16_f32 v179, v122, v123
buffer_store_dwordx4 v[176:179], v4, s[16:19], s74 offen offset:3072 sc1
v_pk_mul_f32 v[100:101], v[100:101], v[84:85] op_sel_hi:[1,0]
v_pk_mul_f32 v[102:103], v[102:103], v[84:85] op_sel_hi:[1,0]
v_pk_mul_f32 v[116:117], v[116:117], v[84:85] op_sel_hi:[1,0]
v_pk_mul_f32 v[118:119], v[118:119], v[84:85] op_sel_hi:[1,0]
v_cvt_pk_bf16_f32 v172, v100, v101
v_cvt_pk_bf16_f32 v173, v102, v103
v_cvt_pk_bf16_f32 v174, v116, v117
v_cvt_pk_bf16_f32 v175, v118, v119
buffer_store_dwordx4 v[172:175], v4, s[16:19], s74 offen offset:2048 sc1
v_pk_mul_f32 v[96:97], v[96:97], v[80:81] op_sel_hi:[1,0]
v_pk_mul_f32 v[98:99], v[98:99], v[80:81] op_sel_hi:[1,0]
v_pk_mul_f32 v[112:113], v[112:113], v[80:81] op_sel_hi:[1,0]
v_pk_mul_f32 v[114:115], v[114:115], v[80:81] op_sel_hi:[1,0]
v_cvt_pk_bf16_f32 v168, v96, v97
v_cvt_pk_bf16_f32 v169, v98, v99
v_cvt_pk_bf16_f32 v170, v112, v113
v_cvt_pk_bf16_f32 v171, v114, v115
buffer_store_dwordx4 v[168:171], v4, s[16:19], s74 offen offset:1024 sc1
v_pk_mul_f32 v[92:93], v[92:93], v[76:77] op_sel_hi:[1,0]
v_pk_mul_f32 v[94:95], v[94:95], v[76:77] op_sel_hi:[1,0]
v_pk_mul_f32 v[108:109], v[108:109], v[76:77] op_sel_hi:[1,0]
v_pk_mul_f32 v[110:111], v[110:111], v[76:77] op_sel_hi:[1,0]
v_cvt_pk_bf16_f32 v164, v92, v93
v_cvt_pk_bf16_f32 v165, v94, v95
v_cvt_pk_bf16_f32 v166, v108, v109
v_cvt_pk_bf16_f32 v167, v110, v111
buffer_store_dwordx4 v[164:167], v4, s[16:19], s74 offen sc1
s_nop 1
.Lqkve2:
s_mov_b32 s36, s0
s_mov_b32 s37, s1
s_lshl_b32 s62, s3, 11
s_add_u32 s62, s62, s84
v_lshl_add_u32 v4, v1, 4, s62
v_lshrrev_b32 v2, 3, v1
v_cmp_eq_u32 vcc, 3, v2
v_add_u32 v2, 67108480, v4
s_nop 0
v_cndmask_b32 v4, v4, v2, vcc
v_bfe_u32 v8, v1, 3, 2
v_mul_u32_u24 v8, 2080, v8
v_bfe_u32 v2, v1, 2, 1
v_lshl_add_u32 v8, v2, 7, v8
v_bfe_u32 v2, v1, 5, 1
v_lshl_add_u32 v8, v2, 8, v8
v_and_b32 v2, 3, v1
v_lshl_add_u32 v8, v2, 3, v8
s_mov_b32 s57, 66560
v_add_u32 v7, s57, v8
s_lshr_b32 s54, s87, 17
s_lshl_b32 s54, s54, 18
s_add_u32 s54, s54, 4194304
s_mov_b32 s52, s54
s_add_u32 s53, s54, 131072
v_accvgpr_read_b32 v32, a224
v_accvgpr_read_b32 v33, a225
v_accvgpr_read_b32 v34, a226
v_accvgpr_read_b32 v35, a227
v_accvgpr_read_b32 v36, a228
v_accvgpr_read_b32 v37, a229
v_accvgpr_read_b32 v38, a230
v_accvgpr_read_b32 v39, a231
v_accvgpr_read_b32 v40, a232
v_accvgpr_read_b32 v41, a233
v_accvgpr_read_b32 v42, a234
v_accvgpr_read_b32 v43, a235
v_accvgpr_read_b32 v44, a236
v_accvgpr_read_b32 v45, a237
v_accvgpr_read_b32 v46, a238
v_accvgpr_read_b32 v47, a239
v_accvgpr_read_b32 v48, a240
v_accvgpr_read_b32 v49, a241
v_accvgpr_read_b32 v50, a242
v_accvgpr_read_b32 v51, a243
v_accvgpr_read_b32 v52, a244
v_accvgpr_read_b32 v53, a245
v_accvgpr_read_b32 v54, a246
v_accvgpr_read_b32 v55, a247
v_accvgpr_read_b32 v56, a248
v_accvgpr_read_b32 v57, a249
v_accvgpr_read_b32 v58, a250
v_accvgpr_read_b32 v59, a251
v_accvgpr_read_b32 v60, a252
v_accvgpr_read_b32 v61, a253
v_accvgpr_read_b32 v62, a254
v_accvgpr_read_b32 v63, a255
s_lshl_b32 s62, s8, 10
s_add_u32 s62, s62, 30425088
s_lshl_b32 s64, s6, 10
s_add_u32 s64, s64, 30425088
s_lshr_b32 s67, s5, 2
s_and_b32 s67, s67, 3
s_lshl_b32 s67, s67, 7
s_add_u32 s64, s64, s67
v_lshl_add_u32 v252, v1, 7, s62
v_mov_b32 v253, s64
v_mov_b32 v255, 1
s_waitcnt vmcnt(0) lgkmcnt(0)
s_cmp_lg_u32 s3, 1
s_barrier
s_cbranch_scc1 .Lfirst35
s_mov_b64 exec, 15
buffer_atomic_add v255, v252, s[16:19], 0 offen
s_mov_b64 exec, 1
v_mov_b32 v254, 0
buffer_atomic_add v254, v253, s[16:19], 0 offen sc0
s_mov_b64 exec, -1
.Lfirst35:
s_add_u32 m0, s59, 66560
s_xor_b32 s58, s87, 0
buffer_load_dwordx4 v5, s[24:27], s58 offen lds
buffer_load_dwordx4 v6, s[24:27], s58 offen offset:1024 lds
s_add_u32 m0, s59, 116480
s_xor_b32 s58, s87, 786432
buffer_load_dwordx4 v5, s[24:27], s58 offen lds
buffer_load_dwordx4 v6, s[24:27], s58 offen offset:1024 lds
s_add_u32 m0, s59, 124800
s_xor_b32 s58, s87, 917504
buffer_load_dwordx4 v5, s[24:27], s58 offen lds
buffer_load_dwordx4 v6, s[24:27], s58 offen offset:1024 lds
s_add_u32 m0, s59, 49920
s_xor_b32 s58, s87, 1835008
buffer_load_dwordx4 v5, s[24:27], s58 offen lds
buffer_load_dwordx4 v6, s[24:27], s58 offen offset:1024 lds
s_add_u32 m0, s59, 58240
s_xor_b32 s58, s87, 1966080
buffer_load_dwordx4 v5, s[24:27], s58 offen lds
buffer_load_dwordx4 v6, s[24:27], s58 offen offset:1024 lds
s_cmp_lg_u32 s3, 1
s_cbranch_scc1 .Lnopoll34
s_mov_b64 exec, 1
s_mov_b32 s15, 0
v_mov_b32 v255, 0
buffer_atomic_add v255, v253, s[16:19], 0 offen sc0
s_waitcnt vmcnt(11)
v_cmp_gt_u32 vcc, 16, v254
s_nop 0
s_cbranch_vccz .Lnopoll34r
.Lpoll33:
s_waitcnt vmcnt(0)
v_cmp_gt_u32 vcc, 16, v255
s_add_u32 s15, s15, 1
s_cbranch_vccz .Lnopoll34r
v_mov_b32 v255, 0
buffer_atomic_add v255, v253, s[16:19], 0 offen sc0
s_cmp_le_u32 s15, 100000
s_cbranch_scc1 .Lpoll33
s_branch .Lnopoll34r
.Lnopoll34:
s_mov_b64 exec, 0
s_cmp_eq_u32 s3, 2
s_cbranch_scc1 .Lpad11
s_cmp_eq_u32 s3, 3
s_cbranch_scc1 .Lpad12
s_branch .Lpad13
.Lnopoll34r:
s_mov_b64 exec, -1
s_waitcnt vmcnt(8)
s_barrier
buffer_load_dwordx4 v[64:67], v4, s[16:19], s52 offen sc1
buffer_load_dwordx4 v[68:71], v4, s[16:19], s52 offen offset:1024 sc1
s_xor_b32 s52, s54, 262144
buffer_load_dwordx4 v[72:75], v4, s[16:19], s53 offen sc1
buffer_load_dwordx4 v[76:79], v4, s[16:19], s53 offen offset:1024 sc1
s_xor_b32 s53, s54, 393216
buffer_load_dwordx4 v[80:83], v4, s[16:19], s52 offen sc1
buffer_load_dwordx4 v[84:87], v4, s[16:19], s52 offen offset:1024 sc1
s_xor_b32 s52, s54, 524288
buffer_load_dwordx4 v[88:91], v4, s[16:19], s53 offen sc1
buffer_load_dwordx4 v[92:95], v4, s[16:19], s53 offen offset:1024 sc1
s_xor_b32 s53, s54, 655360
buffer_load_dwordx4 v[96:99], v4, s[16:19], s52 offen sc1
buffer_load_dwordx4 v[100:103], v4, s[16:19], s52 offen offset:1024 sc1
s_xor_b32 s52, s54, 786432
buffer_load_dwordx4 v[104:107], v4, s[16:19], s53 offen sc1
buffer_load_dwordx4 v[108:111], v4, s[16:19], s53 offen offset:1024 sc1
s_xor_b32 s53, s54, 917504
ds_read_b64_tr_b16 a[0:1], v7
TR 2,7,512
TR 16,7,1024
TR 18,7,1536
TR 4,7,32
TR 6,7,544
TR 20,7,1056
TR 22,7,1568
TR 8,7,64
TR 10,7,576
TR 24,7,1088
TR 26,7,1600
TR 12,7,96
TR 14,7,608
TR 28,7,1120
TR 30,7,1632
s_lshl_b32 s62, s49, 3
s_add_u32 s62, s62, s48
s_mul_i32 s62, s62, 28672
s_add_u32 s62, s62, s51
v_lshrrev_b32 v12, 4, v1
v_mul_u32_u24 v12, 57344, v12
v_and_b32 v2, 15, v1
v_lshl_add_u32 v12, v2, 4, v12
v_add_u32 v12, s62, v12
v_add_u32 v13, 6112, v12
v_add_u32 v14, 12224, v12
v_add_u32 v15, 18336, v12
s_mul_i32 s59, s3, 4224
s_mov_b32 s58, 0
s_waitcnt vmcnt(8) lgkmcnt(14)
MAV 32,0,64
TR 32,7,8320
s_waitcnt lgkmcnt(13)
MAV 32,16,72
buffer_load_dwordx4 v[112:115], v4, s[16:19], s52 offen sc1
MAV 48,16,76
TR 34,7,8832
MAV 48,0,68
TR 48,7,9344
TR 50,7,9856
s_waitcnt lgkmcnt(14)
MAV 52,4,68
TR 36,7,8352
s_waitcnt lgkmcnt(13)
MAV 52,20,76
buffer_load_dwordx4 v[116:119], v4, s[16:19], s52 offen offset:1024 sc1
MAV 36,20,72
TR 38,7,8864
s_xor_b32 s52, s54, 1048576
MAV 36,4,64
TR 52,7,9376
TR 54,7,9888
s_waitcnt lgkmcnt(14)
MAV 40,8,64
TR 40,7,8384
s_waitcnt lgkmcnt(13)
MAV 40,24,72
buffer_load_dwordx4 v[120:123], v4, s[16:19], s53 offen sc1
MAV 56,24,76
TR 42,7,8896
MAV 56,8,68
TR 56,7,9408
TR 58,7,9920
s_waitcnt lgkmcnt(14)
MAV 60,12,68
TR 44,7,8416
s_waitcnt lgkmcnt(13)
MAV 60,28,76
buffer_load_dwordx4 v[124:127], v4, s[16:19], s53 offen offset:1024 sc1
MAV 44,28,72
TR 46,7,8928
s_xor_b32 s53, s54, 1179648
MAV 44,12,64
TR 60,7,9440
TR 62,7,9952
s_waitcnt vmcnt(8) lgkmcnt(8)
MAV 32,32,80
TR 0,7,16640
MAV 32,48,88
buffer_load_dwordx4 v[64:67], v4, s[16:19], s52 offen sc1
MAV 48,48,92
TR 2,7,17152
MAV 48,32,84
TR 16,7,17664
TR 18,7,18176
MAV 52,36,84
TR 4,7,16672
MAV 52,52,92
buffer_load_dwordx4 v[68:71], v4, s[16:19], s52 offen offset:1024 sc1
MAV 36,52,88
TR 6,7,17184
s_xor_b32 s52, s54, 1310720
MAV 36,36,80
TR 20,7,17696
TR 22,7,18208
s_waitcnt lgkmcnt(8)
MAV 40,40,80
TR 8,7,16704
MAV 40,56,88
buffer_load_dwordx4 v[72:75], v4, s[16:19], s53 offen sc1
MAV 56,56,92
TR 10,7,17216
MAV 56,40,84
TR 24,7,17728
TR 26,7,18240
MAV 60,44,84
TR 12,7,16736
MAV 60,60,92
buffer_load_dwordx4 v[76:79], v4, s[16:19], s53 offen offset:1024 sc1
MAV 44,60,88
TR 14,7,17248
s_xor_b32 s53, s54, 1441792
MAV 44,44,80
TR 28,7,17760
TR 30,7,18272
s_waitcnt vmcnt(8) lgkmcnt(8)
MAV 32,0,96
TR 32,7,24960
MAV 32,16,104
buffer_load_dwordx4 v[80:83], v4, s[16:19], s52 offen sc1
MAV 48,16,108
TR 34,7,25472
MAV 48,0,100
TR 48,7,25984
TR 50,7,26496
MAV 52,4,100
TR 36,7,24992
MAV 52,20,108
buffer_load_dwordx4 v[84:87], v4, s[16:19], s52 offen offset:1024 sc1
MAV 36,20,104
TR 38,7,25504
s_xor_b32 s52, s54, 1572864
MAV 36,4,96
TR 52,7,26016
TR 54,7,26528
s_waitcnt lgkmcnt(8)
MAV 40,8,96
TR 40,7,25024
MAV 40,24,104
buffer_load_dwordx4 v[88:91], v4, s[16:19], s53 offen sc1
MAV 56,24,108
TR 42,7,25536
MAV 56,8,100
TR 56,7,26048
TR 58,7,26560
MAV 60,12,100
TR 44,7,25056
MAV 60,28,108
buffer_load_dwordx4 v[92:95], v4, s[16:19], s53 offen offset:1024 sc1
MAV 44,28,104
TR 46,7,25568
s_xor_b32 s53, s54, 1703936
MAV 44,12,96
TR 60,7,26080
TR 62,7,26592
s_barrier
s_waitcnt vmcnt(8) lgkmcnt(8)
MAV 32,32,112
TR 0,7,33280
MAV 32,48,120
buffer_load_dwordx4 v[96:99], v4, s[16:19], s52 offen sc1
MAV 48,48,124
TR 2,7,33792
MAV 48,32,116
TR 16,7,34304
TR 18,7,34816
.Lpad11:
s_cbranch_execz .Lpad14
MAV 52,36,116
TR 4,7,33312
MAV 52,52,124
buffer_load_dwordx4 v[100:103], v4, s[16:19], s52 offen offset:1024 sc1
MAV 36,52,120
TR 6,7,33824
s_xor_b32 s52, s54, 1835008
MAV 36,36,112
TR 20,7,34336
TR 22,7,34848
s_waitcnt lgkmcnt(8)
MAV 40,40,112
TR 8,7,33344
MAV 40,56,120
buffer_load_dwordx4 v[104:107], v4, s[16:19], s53 offen sc1
MAV 56,56,124
TR 10,7,33856
MAV 56,40,116
TR 24,7,34368
TR 26,7,34880
MAV 60,44,116
TR 12,7,33376
MAV 60,60,124
buffer_load_dwordx4 v[108:111], v4, s[16:19], s53 offen offset:1024 sc1
MAV 44,60,120
TR 14,7,33888
s_xor_b32 s53, s54, 1966080
MAV 44,44,112
TR 28,7,34400
TR 30,7,34912
s_waitcnt vmcnt(8) lgkmcnt(8)
MAV 32,0,64
TR 32,7,41600
MAV 32,16,72
buffer_load_dwordx4 v[112:115], v4, s[16:19], s52 offen sc1
MAV 48,16,76
TR 34,7,42112
MAV 48,0,68
TR 48,7,42624
TR 50,7,43136
MAV 52,4,68
TR 36,7,41632
MAV 52,20,76
buffer_load_dwordx4 v[116:119], v4, s[16:19], s52 offen offset:1024 sc1
MAV 36,20,72
TR 38,7,42144
s_xor_b32 s52, s54, 2097152
MAV 36,4,64
TR 52,7,42656
TR 54,7,43168
s_waitcnt lgkmcnt(8)
MAV 40,8,64
TR 40,7,41664
MAV 40,24,72
buffer_load_dwordx4 v[120:123], v4, s[16:19], s53 offen sc1
MAV 56,24,76
TR 42,7,42176
MAV 56,8,68
TR 56,7,42688
TR 58,7,43200
MAV 60,12,68
TR 44,7,41696
MAV 60,28,76
buffer_load_dwordx4 v[124:127], v4, s[16:19], s53 offen offset:1024 sc1
MAV 44,28,72
TR 46,7,42208
s_xor_b32 s53, s54, 2228224
MAV 44,12,64
TR 60,7,42720
TR 62,7,43232
s_waitcnt vmcnt(8) lgkmcnt(8)
MAV 32,32,80
TR 0,7,49920
MAV 32,48,88
buffer_load_dwordx4 v[64:67], v4, s[16:19], s52 offen sc1
MAV 48,48,92
TR 2,7,50432
MAV 48,32,84
TR 16,7,50944
TR 18,7,51456
MAV 52,36,84
TR 4,7,49952
MAV 52,52,92
buffer_load_dwordx4 v[68:71], v4, s[16:19], s52 offen offset:1024 sc1
MAV 36,52,88
TR 6,7,50464
s_xor_b32 s52, s54, 2359296
MAV 36,36,80
TR 20,7,50976
TR 22,7,51488
s_waitcnt lgkmcnt(8)
MAV 40,40,80
TR 8,7,49984
MAV 40,56,88
buffer_load_dwordx4 v[72:75], v4, s[16:19], s53 offen sc1
MAV 56,56,92
TR 10,7,50496
MAV 56,40,84
TR 24,7,51008
TR 26,7,51520
MAV 60,44,84
TR 12,7,50016
MAV 60,60,92
buffer_load_dwordx4 v[76:79], v4, s[16:19], s53 offen offset:1024 sc1
MAV 44,60,88
TR 14,7,50528
s_xor_b32 s53, s54, 2490368
MAV 44,44,80
TR 28,7,51040
TR 30,7,51552
s_waitcnt vmcnt(8) lgkmcnt(8)
MAV 32,0,96
TR 32,7,58240
MAV 32,16,104
buffer_load_dwordx4 v[80:83], v4, s[16:19], s52 offen sc1
MAV 48,16,108
TR 34,7,58752
MAV 48,0,100
TR 48,7,59264
TR 50,7,59776
MAV 52,4,100
TR 36,7,58272
MAV 52,20,108
buffer_load_dwordx4 v[84:87], v4, s[16:19], s52 offen offset:1024 sc1
MAV 36,20,104
TR 38,7,58784
s_xor_b32 s52, s54, 2621440
MAV 36,4,96
TR 52,7,59296
TR 54,7,59808
s_waitcnt lgkmcnt(8)
MAV 40,8,96
TR 40,7,58304
MAV 40,24,104
buffer_load_dwordx4 v[88:91], v4, s[16:19], s53 offen sc1
MAV 56,24,108
TR 42,7,58816
MAV 56,8,100
TR 56,7,59328
TR 58,7,59840
MAV 60,12,100
TR 44,7,58336
MAV 60,28,108
buffer_load_dwordx4 v[92:95], v4, s[16:19], s53 offen offset:1024 sc1
MAV 44,28,104
TR 46,7,58848
s_xor_b32 s53, s54, 2752512
MAV 44,12,96
TR 60,7,59360
TR 62,7,59872
s_xor_b32 s57, s57, 66560
v_add_u32 v7, s57, v8
s_waitcnt vmcnt(8) lgkmcnt(8)
MAV 32,32,112
ds_read_b64_tr_b16 a[0:1], v7
MAV 32,48,120
buffer_load_dwordx4 v[96:99], v4, s[16:19], s52 offen sc1
MAV 48,48,124
TR 2,7,512
MAV 48,32,116
TR 16,7,1024
TR 18,7,1536
MAV 52,36,116
TR 4,7,32
MAV 52,52,124
buffer_load_dwordx4 v[100:103], v4, s[16:19], s52 offen offset:1024 sc1
MAV 36,52,120
TR 6,7,544
s_xor_b32 s52, s54, 2883584
MAV 36,36,112
TR 20,7,1056
TR 22,7,1568
s_waitcnt lgkmcnt(8)
MAV 40,40,112
TR 8,7,64
MAV 40,56,120
buffer_load_dwordx4 v[104:107], v4, s[16:19], s53 offen sc1
MAV 56,56,124
TR 10,7,576
MAV 56,40,116
TR 24,7,1088
TR 26,7,1600
MAV 60,44,116
TR 12,7,96
MAV 60,60,124
buffer_load_dwordx4 v[108:111], v4, s[16:19], s53 offen offset:1024 sc1
MAV 44,60,120
TR 14,7,608
s_xor_b32 s53, s54, 3014656
MAV 44,44,112
TR 28,7,1120
TR 30,7,1632
s_waitcnt vmcnt(8) lgkmcnt(8)
MAV 32,0,64
TR 32,7,8320
MAV 32,16,72
buffer_load_dwordx4 v[112:115], v4, s[16:19], s52 offen sc1
MAV 48,16,76
TR 34,7,8832
MAV 48,0,68
TR 48,7,9344
TR 50,7,9856
MAV 52,4,68
TR 36,7,8352
MAV 52,20,76
buffer_load_dwordx4 v[116:119], v4, s[16:19], s52 offen offset:1024 sc1
MAV 36,20,72
TR 38,7,8864
s_xor_b32 s52, s54, 3145728
MAV 36,4,64
TR 52,7,9376
TR 54,7,9888
s_waitcnt lgkmcnt(8)
MAV 40,8,64
TR 40,7,8384
MAV 40,24,72
buffer_load_dwordx4 v[120:123], v4, s[16:19], s53 offen sc1
MAV 56,24,76
TR 42,7,8896
MAV 56,8,68
TR 56,7,9408
TR 58,7,9920
MAV 60,12,68
TR 44,7,8416
MAV 60,28,76
buffer_load_dwordx4 v[124:127], v4, s[16:19], s53 offen offset:1024 sc1
MAV 44,28,72
TR 46,7,8928
s_xor_b32 s53, s54, 3276800
MAV 44,12,64
TR 60,7,9440
TR 62,7,9952
s_waitcnt vmcnt(8) lgkmcnt(8)
MAV 32,32,80
TR 0,7,16640
MAV 32,48,88
buffer_load_dwordx4 v[64:67], v4, s[16:19], s52 offen sc1
MAV 48,48,92
TR 2,7,17152
MAV 48,32,84
TR 16,7,17664
TR 18,7,18176
MAV 52,36,84
TR 4,7,16672
MAV 52,52,92
buffer_load_dwordx4 v[68:71], v4, s[16:19], s52 offen offset:1024 sc1
MAV 36,52,88
TR 6,7,17184
s_xor_b32 s52, s54, 3407872
MAV 36,36,80
TR 20,7,17696
TR 22,7,18208
s_waitcnt lgkmcnt(8)
MAV 40,40,80
TR 8,7,16704
MAV 40,56,88
buffer_load_dwordx4 v[72:75], v4, s[16:19], s53 offen sc1
MAV 56,56,92
TR 10,7,17216
MAV 56,40,84
TR 24,7,17728
TR 26,7,18240
MAV 60,44,84
TR 12,7,16736
MAV 60,60,92
buffer_load_dwordx4 v[76:79], v4, s[16:19], s53 offen offset:1024 sc1
MAV 44,60,88
TR 14,7,17248
s_xor_b32 s53, s54, 3538944
MAV 44,44,80
TR 28,7,17760
TR 30,7,18272
s_waitcnt vmcnt(8) lgkmcnt(8)
MAV 32,0,96
TR 32,7,24960
MAV 32,16,104
buffer_load_dwordx4 v[80:83], v4, s[16:19], s52 offen sc1
MAV 48,16,108
TR 34,7,25472
MAV 48,0,100
TR 48,7,25984
TR 50,7,26496
MAV 52,4,100
TR 36,7,24992
MAV 52,20,108
buffer_load_dwordx4 v[84:87], v4, s[16:19], s52 offen offset:1024 sc1
MAV 36,20,104
TR 38,7,25504
s_xor_b32 s52, s54, 3670016
MAV 36,4,96
TR 52,7,26016
TR 54,7,26528
s_waitcnt lgkmcnt(8)
MAV 40,8,96
TR 40,7,25024
MAV 40,24,104
buffer_load_dwordx4 v[88:91], v4, s[16:19], s53 offen sc1
MAV 56,24,108
TR 42,7,25536
MAV 56,8,100
TR 56,7,26048
TR 58,7,26560
MAV 60,12,100
TR 44,7,25056
MAV 60,28,108
buffer_load_dwordx4 v[92:95], v4, s[16:19], s53 offen offset:1024 sc1
MAV 44,28,104
TR 46,7,25568
s_xor_b32 s53, s54, 3801088
MAV 44,12,96
TR 60,7,26080
TR 62,7,26592
s_waitcnt vmcnt(8) lgkmcnt(8)
MAV 32,32,112
TR 0,7,33280
MAV 32,48,120
buffer_load_dwordx4 v[96:99], v4, s[16:19], s52 offen sc1
MAV 48,48,124
TR 2,7,33792
MAV 48,32,116
TR 16,7,34304
TR 18,7,34816
MAV 52,36,116
TR 4,7,33312
MAV 52,52,124
buffer_load_dwordx4 v[100:103], v4, s[16:19], s52 offen offset:1024 sc1
MAV 36,52,120
TR 6,7,33824
s_xor_b32 s52, s54, 3932160
MAV 36,36,112
TR 20,7,34336
TR 22,7,34848
s_waitcnt lgkmcnt(8)
MAV 40,40,112
TR 8,7,33344
MAV 40,56,120
buffer_load_dwordx4 v[104:107], v4, s[16:19], s53 offen sc1
MAV 56,56,124
TR 10,7,33856
MAV 56,40,116
TR 24,7,34368
TR 26,7,34880
MAV 60,44,116
TR 12,7,33376
MAV 60,60,124
buffer_load_dwordx4 v[108:111], v4, s[16:19], s53 offen offset:1024 sc1
MAV 44,60,120
TR 14,7,33888
s_xor_b32 s53, s54, 4063232
MAV 44,44,112
TR 28,7,34400
TR 30,7,34912
s_waitcnt vmcnt(8) lgkmcnt(8)
MAV 32,0,64
TR 32,7,41600
MAV 32,16,72
buffer_load_dwordx4 v[112:115], v4, s[16:19], s52 offen sc1
MAV 48,16,76
TR 34,7,42112
MAV 48,0,68
TR 48,7,42624
TR 50,7,43136
MAV 52,4,68
TR 36,7,41632
MAV 52,20,76
buffer_load_dwordx4 v[116:119], v4, s[16:19], s52 offen offset:1024 sc1
MAV 36,20,72
TR 38,7,42144
MAV 36,4,64
TR 52,7,42656
TR 54,7,43168
s_waitcnt lgkmcnt(8)
MAV 40,8,64
TR 40,7,41664
MAV 40,24,72
buffer_load_dwordx4 v[120:123], v4, s[16:19], s53 offen sc1
MAV 56,24,76
TR 42,7,42176
MAV 56,8,68
TR 56,7,42688
TR 58,7,43200
MAV 60,12,68
TR 44,7,41696
MAV 60,28,76
buffer_load_dwordx4 v[124:127], v4, s[16:19], s53 offen offset:1024 sc1
MAV 44,28,72
TR 46,7,42208
MAV 44,12,64
TR 60,7,42720
TR 62,7,43232
s_barrier
s_waitcnt vmcnt(8) lgkmcnt(8)
MAV 32,32,80
TR 0,7,49920
s_add_u32 m0, s59, 84480
MAV 32,48,88
buffer_load_dwordx4 v12, s[32:35], s58 offen lds
MAV 48,48,92
TR 2,7,50432
MAV 48,32,84
TR 16,7,50944
TR 18,7,51456
MAV 52,36,84
TR 4,7,49952
MAV 52,52,92
TR 6,7,50464
TR 20,7,50976
MAV 36,52,88
TR 22,7,51488
MAV 36,36,80
TR 8,7,49984
s_waitcnt lgkmcnt(9)
MAV 40,40,80
TR 10,7,50496
MAV 40,56,88
buffer_load_dwordx4 v13, s[32:35], s58 offen offset:1056 lds
MAV 56,56,92
TR 24,7,51008
MAV 56,40,84
buffer_load_dwordx4 v14, s[32:35], s58 offen offset:2112 lds
MAV 60,44,84
TR 26,7,51520
MAV 60,60,92
TR 12,7,50016
TR 14,7,50528
MAV 44,60,88
TR 28,7,51040
MAV 44,44,80
TR 30,7,51552
s_waitcnt vmcnt(7) lgkmcnt(8)
MAV 32,0,96
TR 32,7,58240
MAV 32,16,104
buffer_load_dwordx4 v15, s[32:35], s58 offen offset:3168 lds
MAV 48,16,108
TR 34,7,58752
MAV 48,0,100
TR 48,7,59264
TR 50,7,59776
MAV 52,4,100
TR 36,7,58272
MAV 52,20,108
TR 38,7,58784
TR 52,7,59296
MAV 36,20,104
TR 54,7,59808
MAV 36,4,96
TR 40,7,58304
s_waitcnt lgkmcnt(9)
MAV 40,8,96
TR 42,7,58816
s_add_u32 m0, s59, 101376
MAV 40,24,104
buffer_load_dwordx4 v12, s[80:83], s58 offen lds
MAV 56,24,108
TR 56,7,59328
MAV 56,8,100
buffer_load_dwordx4 v13, s[80:83], s58 offen offset:1056 lds
MAV 60,12,100
TR 58,7,59840
MAV 60,28,108
TR 44,7,58336
TR 46,7,58848
MAV 44,28,104
TR 60,7,59360
MAV 44,12,96
TR 62,7,59872
s_waitcnt vmcnt(9) lgkmcnt(14)
MAV 32,32,112
buffer_load_dwordx4 v14, s[80:83], s58 offen offset:2112 lds
s_waitcnt vmcnt(8) lgkmcnt(12)
MAV 32,48,120
s_lshl_b32 s64, s6, 14
s_lshl_b32 s65, s49, 13
s_add_u32 s64, s64, s65
s_waitcnt vmcnt(7)
MAV 48,48,124
s_lshl_b32 s65, s7, 9
s_add_u32 s64, s64, s65
s_lshl_b32 s65, s48, 8
MAV 48,32,116
s_add_u32 s64, s64, s65
s_add_u32 s64, s64, 29622272
v_and_b32 v152, 31, v1
s_waitcnt lgkmcnt(10)
MAV 52,36,116
buffer_load_dwordx4 v15, s[80:83], s58 offen offset:3168 lds
s_waitcnt lgkmcnt(8)
MAV 52,52,124
s_add_u32 s58, s58, 458752
v_lshlrev_b32 v152, 3, v152
v_lshrrev_b32 v153, 5, v1
MAV 36,52,120
s_lshl_b32 s62, s7, 18
v_lshl_add_u32 v152, v153, 28, v152
s_add_u32 s62, s62, 8388608
MAV 36,36,112
s_add_u32 s63, s62, 131072
v_cvt_pk_bf16_f32 v128, v32, v33
v_cvt_pk_bf16_f32 v129, v34, v35
s_waitcnt lgkmcnt(6)
MAV 40,40,112
v_cvt_pk_bf16_f32 v136, v48, v49
v_cvt_pk_bf16_f32 v137, v50, v51
s_waitcnt lgkmcnt(4)
MAV 40,56,120
v_cvt_pk_bf16_f32 v130, v36, v37
v_cvt_pk_bf16_f32 v131, v38, v39
MAV 56,56,124
buffer_store_dwordx4 v[128:131], v4, s[16:19], s62 offen sc1
MAV 56,40,116
v_cvt_pk_bf16_f32 v138, v52, v53
v_cvt_pk_bf16_f32 v139, v54, v55
s_waitcnt lgkmcnt(2)
MAV 60,44,116
v_cvt_pk_bf16_f32 v132, v40, v41
v_cvt_pk_bf16_f32 v133, v42, v43
s_waitcnt lgkmcnt(0)
MAV 60,60,124
v_cvt_pk_bf16_f32 v140, v56, v57
MAV 44,60,120
buffer_store_dwordx4 v[136:139], v4, s[16:19], s62 offen offset:1024 sc1
MAV 44,44,112
v_cvt_pk_bf16_f32 v141, v58, v59
s_nop 2
v_cvt_pk_bf16_f32 v142, v60, v61
v_pk_mul_f32 v[146:147], v[32:33], v[32:33]
v_pk_mul_f32 v[150:151], v[48:49], v[48:49]
v_cvt_pk_bf16_f32 v143, v62, v63
v_pk_fma_f32 v[146:147], v[34:35], v[34:35], v[146:147]
v_pk_add_f32 v[144:145], v[32:33], v[34:35]
v_pk_fma_f32 v[150:151], v[50:51], v[50:51], v[150:151]
v_cvt_pk_bf16_f32 v134, v44, v45
v_cvt_pk_bf16_f32 v135, v46, v47
.Lpad12:
s_cbranch_execz .Lpad15
buffer_store_dwordx4 v[132:135], v4, s[16:19], s63 offen sc1
v_pk_add_f32 v[148:149], v[48:49], v[50:51]
v_pk_fma_f32 v[146:147], v[36:37], v[36:37], v[146:147]
v_pk_add_f32 v[144:145], v[144:145], v[36:37]
v_pk_fma_f32 v[150:151], v[52:53], v[52:53], v[150:151]
v_pk_add_f32 v[148:149], v[148:149], v[52:53]
v_pk_fma_f32 v[146:147], v[38:39], v[38:39], v[146:147]
v_pk_add_f32 v[144:145], v[144:145], v[38:39]
v_pk_fma_f32 v[150:151], v[54:55], v[54:55], v[150:151]
v_pk_add_f32 v[148:149], v[148:149], v[54:55]
v_pk_fma_f32 v[146:147], v[40:41], v[40:41], v[146:147]
v_pk_add_f32 v[144:145], v[144:145], v[40:41]
v_pk_fma_f32 v[150:151], v[56:57], v[56:57], v[150:151]
v_pk_add_f32 v[148:149], v[148:149], v[56:57]
buffer_store_dwordx4 v[140:143], v4, s[16:19], s63 offen offset:1024 sc1
v_pk_fma_f32 v[146:147], v[42:43], v[42:43], v[146:147]
v_pk_add_f32 v[144:145], v[144:145], v[42:43]
v_pk_fma_f32 v[150:151], v[58:59], v[58:59], v[150:151]
v_pk_add_f32 v[148:149], v[148:149], v[58:59]
v_pk_fma_f32 v[146:147], v[44:45], v[44:45], v[146:147]
v_pk_add_f32 v[144:145], v[144:145], v[44:45]
v_pk_fma_f32 v[150:151], v[60:61], v[60:61], v[150:151]
v_pk_add_f32 v[148:149], v[148:149], v[60:61]
v_pk_fma_f32 v[146:147], v[46:47], v[46:47], v[146:147]
v_pk_add_f32 v[144:145], v[144:145], v[46:47]
v_pk_fma_f32 v[150:151], v[62:63], v[62:63], v[150:151]
v_pk_add_f32 v[148:149], v[148:149], v[62:63]
v_add_f32 v144, v144, v145
v_add_f32 v146, v146, v147
v_add_f32 v148, v148, v149
v_add_f32 v150, v150, v151
s_nop 0
v_permlane16_swap_b32 v144, v148
v_permlane16_swap_b32 v146, v150
v_add_f32 v144, v144, v148
v_add_f32 v146, v146, v150
s_nop 1
v_permlane32_swap_b32 v144, v146
v_add_f32 v144, v144, v146
s_nop 1
v_permlane32_swap_b32 v144, v145
buffer_store_dwordx2 v[144:145], v152, s[16:19], s64 offen sc1
s_nop 1
s_mov_b32 s54, s58
s_mov_b32 s55, s59
v_accvgpr_write_b32 a224, v32
v_accvgpr_write_b32 a225, v33
v_accvgpr_write_b32 a226, v34
v_accvgpr_write_b32 a227, v35
v_accvgpr_write_b32 a228, v36
v_accvgpr_write_b32 a229, v37
v_accvgpr_write_b32 a230, v38
v_accvgpr_write_b32 a231, v39
v_accvgpr_write_b32 a232, v40
v_accvgpr_write_b32 a233, v41
v_accvgpr_write_b32 a234, v42
v_accvgpr_write_b32 a235, v43
v_accvgpr_write_b32 a236, v44
v_accvgpr_write_b32 a237, v45
v_accvgpr_write_b32 a238, v46
v_accvgpr_write_b32 a239, v47
v_accvgpr_write_b32 a240, v48
v_accvgpr_write_b32 a241, v49
v_accvgpr_write_b32 a242, v50
v_accvgpr_write_b32 a243, v51
v_accvgpr_write_b32 a244, v52
v_accvgpr_write_b32 a245, v53
v_accvgpr_write_b32 a246, v54
v_accvgpr_write_b32 a247, v55
v_accvgpr_write_b32 a248, v56
v_accvgpr_write_b32 a249, v57
v_accvgpr_write_b32 a250, v58
v_accvgpr_write_b32 a251, v59
v_accvgpr_write_b32 a252, v60
v_accvgpr_write_b32 a253, v61
v_accvgpr_write_b32 a254, v62
v_accvgpr_write_b32 a255, v63
s_lshl_b32 s62, s10, 14
s_lshl_b32 s63, s3, 12
s_add_u32 s62, s62, s63
s_lshl_b32 s63, s12, 11
s_add_u32 s62, s62, s63
v_lshl_add_u32 v10, v1, 4, s62
v_lshrrev_b32 v2, 3, v1
v_cmp_eq_u32 vcc, 3, v2
v_add_u32 v2, 67108480, v10
s_nop 0
v_cndmask_b32 v10, v10, v2, vcc
v_xor_b32 v11, 2048, v10
v_bfe_u32 v16, v1, 2, 3
v_mul_u32_u24 v16, 1056, v16
v_bfe_u32 v2, v1, 5, 1
v_lshl_add_u32 v16, v2, 8, v16
v_and_b32 v2, 3, v1
v_lshl_add_u32 v16, v2, 3, v16
s_lshl_b32 s62, s12, 6
s_add_u32 s62, s62, 84480
s_xor_b32 s63, s12, 1
s_mul_i32 s63, s63, 192
s_add_u32 s63, s63, 84480
v_add_u32 v17, s63, v16
v_add_u32 v16, s62, v16
s_mov_b32 s52, 8388608
s_mov_b32 s53, 8388608
s_mul_i32 s59, s3, 2112
s_and_b32 s62, s7, 1
s_mul_i32 s62, s62, 3670016
s_lshr_b32 s63, s7, 1
s_lshl_b32 s63, s63, 8
s_add_u32 s62, s62, s63
s_lshl_b32 s63, s3, 12
s_add_u32 s62, s62, s63
v_lshrrev_b32 v5, 4, v1
v_lshlrev_b32 v5, 14, v5
v_and_b32 v2, 15, v1
v_lshl_add_u32 v5, v2, 4, v5
v_add_u32 v5, s62, v5
v_add_u32 v6, 992, v5
s_lshl_b32 s62, s10, 15
s_lshl_b32 s63, s3, 13
s_add_u32 s62, s62, s63
v_lshl_add_u32 v4, v1, 4, s62
s_and_b32 s47, s5, 3
s_lshr_b32 s63, s5, 2
s_lshl_b32 s63, s63, 3
s_add_u32 s63, s63, s4
s_lshl_b32 s62, s63, 1
s_add_u32 s62, s62, s48
s_mul_i32 s62, s62, 1792
v_lshrrev_b32 v7, 1, v1
v_min_u32 v8, 13, v7
v_lshl_add_u32 v8, v8, 7, s62
s_lshl_b32 s62, s63, 2
s_add_u32 s62, s62, s3
s_mul_i32 s62, s62, 640
v_and_b32 v7, 15, v7
v_min_u32 v7, 4, v7
v_lshl_add_u32 v7, v7, 7, s62
v_lshrrev_b32 v2, 5, v1
v_mul_u32_u24 v2, 3670016, v2
v_add_u32 v7, v7, v2
s_mul_i32 s44, s47, 163840
s_add_u32 s45, s47, 12
s_mul_i32 s45, s45, 229376
v_and_b32 v6, 3, v1
v_cmp_eq_u32 vcc, 3, v6
v_mov_b32 v2, 0x3f80
v_mov_b32 v20, 1.0
v_cndmask_b32 v2, v2, v20, vcc
v_cndmask_b32 v6, v6, 0, vcc
v_or_b32 v6, 12, v6
v_mul_u32_u24 v6, 0x1111, v6
v_lshl_or_b32 v6, v6, 16, v6
v_bfe_u32 v22, v1, 2, 2
v_cmp_eq_u32 vcc, 0, v22
s_nop 1
v_cndmask_b32 v20, 0, v2, vcc
v_cmp_eq_u32 vcc, 1, v22
s_nop 1
v_cndmask_b32 v21, 0, v2, vcc
v_accvgpr_write_b32 a208, v20
v_accvgpr_write_b32 a209, v21
v_accvgpr_write_b32 a210, v20
v_accvgpr_write_b32 a211, v21
v_accvgpr_write_b32 a212, 0
v_accvgpr_write_b32 a213, 0
v_accvgpr_write_b32 a214, 0
v_accvgpr_write_b32 a215, 0
v_accvgpr_write_b32 a216, 0
v_accvgpr_write_b32 a217, 0
v_accvgpr_write_b32 a218, 0
v_accvgpr_write_b32 a219, 0
s_cmp_lt_u32 s3, 2
s_cselect_b32 s40, s32, s80
s_cselect_b32 s41, s33, s81
s_cselect_b32 s42, s34, s82
s_add_u32 s62, s55, 84480
v_lshl_add_u32 v9, v1, 4, s62
s_lshl_b32 s62, s6, 10
s_add_u32 s62, s62, 30441472
s_lshl_b32 s64, s10, 1
s_lshl_b32 s64, s64, 10
s_add_u32 s64, s64, 30441472
s_lshr_b32 s67, s5, 2
s_and_b32 s67, s67, 3
s_lshl_b32 s67, s67, 7
s_add_u32 s64, s64, s67
s_add_u32 s65, s64, 1024
v_lshl_add_u32 v252, v1, 7, s62
v_mov_b32 v253, s64
v_mov_b32 v255, 1
v_writelane_b32 v253, s65, 1
s_waitcnt vmcnt(0) lgkmcnt(0)
s_cmp_lg_u32 s3, 1
s_barrier
s_cbranch_scc1 .Lfirst38
s_mov_b64 exec, 15
buffer_atomic_add v255, v252, s[16:19], 0 offen
s_mov_b64 exec, 3
v_mov_b32 v254, 0
buffer_atomic_add v254, v253, s[16:19], 0 offen sc0
s_mov_b64 exec, -1
.Lfirst38:
s_add_u32 m0, s55, 118272
s_nop 0
buffer_load_dwordx4 v12, s[32:35], s54 offen lds
buffer_load_dwordx4 v13, s[32:35], s54 offen offset:1056 lds
buffer_load_dwordx4 v14, s[32:35], s54 offen offset:2112 lds
buffer_load_dwordx4 v15, s[32:35], s54 offen offset:3168 lds
s_add_u32 m0, s55, 135168
s_nop 0
buffer_load_dwordx4 v12, s[80:83], s54 offen lds
buffer_load_dwordx4 v13, s[80:83], s54 offen offset:1056 lds
buffer_load_dwordx4 v14, s[80:83], s54 offen offset:2112 lds
buffer_load_dwordx4 v15, s[80:83], s54 offen offset:3168 lds
s_add_u32 s54, s54, 458752
s_cmp_lg_u32 s3, 1
s_cbranch_scc1 .Lnopoll37
s_mov_b64 exec, 3
s_mov_b32 s15, 0
v_mov_b32 v255, 0
buffer_atomic_add v255, v253, s[16:19], 0 offen sc0
s_waitcnt vmcnt(9)
v_cmp_gt_u32 vcc, 16, v254
s_nop 0
s_cbranch_vccz .Lnopoll37r
.Lpoll36:
s_waitcnt vmcnt(0)
v_cmp_gt_u32 vcc, 16, v255
s_add_u32 s15, s15, 1
s_cbranch_vccz .Lnopoll37r
v_mov_b32 v255, 0
buffer_atomic_add v255, v253, s[16:19], 0 offen sc0
s_cmp_le_u32 s15, 100000
s_cbranch_scc1 .Lpoll36
s_branch .Lnopoll37r
.Lnopoll37:
s_mov_b64 exec, 0
s_cmp_eq_u32 s3, 2
s_cbranch_scc1 .Lpad17
s_cmp_eq_u32 s3, 3
s_cbranch_scc1 .Lpad18
s_branch .Lpad19
.Lnopoll37r:
s_mov_b64 exec, -1
s_waitcnt vmcnt(9)
s_barrier
buffer_load_dwordx4 a[128:131], v10, s[16:19], s52 offen sc1
buffer_load_dwordx4 a[132:135], v10, s[16:19], s52 offen offset:1024 sc1
s_add_u32 s52, s52, 131072
buffer_load_dwordx4 a[144:147], v10, s[16:19], s52 offen sc1
buffer_load_dwordx4 a[148:151], v10, s[16:19], s52 offen offset:1024 sc1
s_add_u32 s52, s52, 131072
buffer_load_dwordx4 a[136:139], v11, s[16:19], s53 offen sc1
buffer_load_dwordx4 a[140:143], v11, s[16:19], s53 offen offset:1024 sc1
s_add_u32 s53, s53, 131072
buffer_load_dwordx4 a[152:155], v11, s[16:19], s53 offen sc1
buffer_load_dwordx4 a[156:159], v11, s[16:19], s53 offen offset:1024 sc1
s_add_u32 s53, s53, 131072
ds_read_b64_tr_b16 a[0:1], v16
TR 2,16,512
TR 4,16,8448
TR 6,16,8960
TR 8,16,32
TR 10,16,544
TR 12,16,8480
TR 14,16,8992
TR 16,16,64
TR 18,16,576
TR 20,16,8512
TR 22,16,9024
TR 24,16,96
TR 26,16,608
TR 28,16,8544
TR 30,16,9056
TR 32,16,128
TR 34,16,640
TR 36,16,8576
TR 38,16,9088
TR 40,16,160
TR 42,16,672
TR 44,16,8608
TR 46,16,9120
ds_read_b64_tr_b16 a[48:49], v17
TR 50,17,512
TR 52,17,8448
TR 54,17,8960
TR 56,17,32
TR 58,17,544
TR 60,17,8480
TR 62,17,8992
ds_read_b128 a[192:195], v9
RD 196,9,1056
RD 200,9,2112
RD 204,9,3168
s_lshl_b32 s57, s3, 13
s_add_u32 s57, s57, 49920
v_lshl_add_u32 v2, v1, 4, s57
s_waitcnt lgkmcnt(0)
s_barrier
s_waitcnt vmcnt(7)
v_mfma_f32_16x16x32_bf16 v[32:35], a[0:3], a[128:131], 0
buffer_load_dwordx4 a[160:163], v10, s[16:19], s52 offen sc1
s_waitcnt vmcnt(6)
MAA 32,4,144
TR 64,16,16896
v_smfmac_f32_16x16x64_bf16 a[212:215], a[208:211], a[192:199], v6
TR 66,16,17408
v_smfmac_f32_16x16x64_bf16 a[212:215], a[208:211], a[200:207], v6
TR 68,16,25344
v_mfma_f32_16x16x32_bf16 v[36:39], a[0:3], a[132:135], 0
TR 70,16,25856
s_waitcnt vmcnt(5)
MAA 36,4,148
buffer_load_dwordx4 a[164:167], v10, s[16:19], s52 offen offset:1024 sc1
v_mfma_f32_16x16x32_bf16 v[52:55], a[8:11], a[132:135], 0
TR 72,16,16928
s_add_u32 s52, s52, 131072
MAA 52,12,148
TR 74,16,17440
v_mfma_f32_16x16x32_bf16 v[48:51], a[8:11], a[128:131], 0
TR 76,16,25376
MAA 48,12,144
TR 78,16,25888
v_mfma_f32_16x16x32_bf16 v[96:99], a[16:19], a[128:131], 0
buffer_load_dwordx4 a[176:179], v10, s[16:19], s52 offen sc1
MAA 96,20,144
TR 80,16,16960
v_mfma_f32_16x16x32_bf16 v[100:103], a[16:19], a[132:135], 0
TR 82,16,17472
MAA 100,20,148
TR 84,16,25408
v_mfma_f32_16x16x32_bf16 v[116:119], a[24:27], a[132:135], 0
TR 86,16,25920
MAA 116,28,148
buffer_load_dwordx4 a[180:183], v10, s[16:19], s52 offen offset:1024 sc1
v_mfma_f32_16x16x32_bf16 v[112:115], a[24:27], a[128:131], 0
TR 88,16,16992
s_add_u32 s52, s52, 131072
MAA 112,28,144
TR 90,16,17504
v_mfma_f32_16x16x32_bf16 v[160:163], a[32:35], a[128:131], 0
TR 92,16,25440
MAA 160,36,144
TR 94,16,25952
v_mfma_f32_16x16x32_bf16 v[164:167], a[32:35], a[132:135], 0
buffer_load_dwordx4 a[168:171], v11, s[16:19], s53 offen sc1
MAA 164,36,148
TR 96,16,17024
v_mfma_f32_16x16x32_bf16 v[180:183], a[40:43], a[132:135], 0
TR 98,16,17536
MAA 180,44,148
TR 100,16,25472
v_mfma_f32_16x16x32_bf16 v[176:179], a[40:43], a[128:131], 0
TR 102,16,25984
MAA 176,44,144
buffer_load_dwordx4 a[172:175], v11, s[16:19], s53 offen offset:1024 sc1
v_mfma_f32_16x16x32_bf16 v[224:227], a[48:51], a[128:131], 0
TR 104,16,17056
s_add_u32 s53, s53, 131072
MAA 224,52,144
TR 106,16,17568
v_mfma_f32_16x16x32_bf16 v[228:231], a[48:51], a[132:135], 0
TR 108,16,25504
MAA 228,52,148
TR 110,16,26016
v_mfma_f32_16x16x32_bf16 v[236:239], a[56:59], a[132:135], 0
buffer_load_dwordx4 a[184:187], v11, s[16:19], s53 offen sc1
MAA 236,60,148
TR 112,17,16896
v_mfma_f32_16x16x32_bf16 v[232:235], a[56:59], a[128:131], 0
TR 114,17,17408
MAA 232,60,144
TR 116,17,25344
s_waitcnt vmcnt(7)
v_mfma_f32_16x16x32_bf16 v[188:191], a[40:43], a[140:143], 0
TR 118,17,25856
MAA 188,44,156
buffer_load_dwordx4 a[188:191], v11, s[16:19], s53 offen offset:1024 sc1
v_mfma_f32_16x16x32_bf16 v[184:187], a[40:43], a[136:139], 0
TR 120,17,16928
s_add_u32 s53, s53, 131072
MAA 184,44,152
TR 122,17,17440
s_add_u32 m0, s55, 84480
v_mfma_f32_16x16x32_bf16 v[168:171], a[32:35], a[136:139], 0
TR 124,17,25376
MAA 168,36,152
TR 126,17,25888
v_mfma_f32_16x16x32_bf16 v[172:175], a[32:35], a[140:143], 0
buffer_load_dwordx4 v12, s[32:35], s54 offen lds
MAA 172,36,156
RD 192,9,16896
v_mfma_f32_16x16x32_bf16 v[124:127], a[24:27], a[140:143], 0
RD 196,9,17952
MAA 124,28,156
RD 200,9,19008
v_mfma_f32_16x16x32_bf16 v[120:123], a[24:27], a[136:139], 0
RD 204,9,20064
MAA 120,28,152
buffer_load_dwordx4 v13, s[32:35], s54 offen offset:1056 lds
v_mfma_f32_16x16x32_bf16 v[104:107], a[16:19], a[136:139], 0
MAA 104,20,152
v_mfma_f32_16x16x32_bf16 v[108:111], a[16:19], a[140:143], 0
MAA 108,20,156
v_mfma_f32_16x16x32_bf16 v[60:63], a[8:11], a[140:143], 0
buffer_load_dwordx4 v14, s[32:35], s54 offen offset:2112 lds
MAA 60,12,156
v_mfma_f32_16x16x32_bf16 v[56:59], a[8:11], a[136:139], 0
MAA 56,12,152
v_mfma_f32_16x16x32_bf16 v[40:43], a[0:3], a[136:139], 0
MAA 40,4,152
buffer_load_dwordx4 v15, s[32:35], s54 offen offset:3168 lds
v_mfma_f32_16x16x32_bf16 v[44:47], a[0:3], a[140:143], 0
MAA 44,4,156
s_waitcnt lgkmcnt(0)
s_barrier
v_mfma_f32_16x16x32_bf16 v[64:67], a[64:67], a[128:131], 0
TR 0,16,33792
s_add_u32 m0, s55, 101376
MAA 64,68,144
buffer_load_dwordx4 v12, s[80:83], s54 offen lds
v_smfmac_f32_16x16x64_bf16 a[216:219], a[208:211], a[192:199], v6
TR 2,16,34304
s_mul_i32 s66, s13, 114688
v_smfmac_f32_16x16x64_bf16 a[216:219], a[208:211], a[200:207], v6
TR 4,16,42240
s_mul_i32 s65, s10, 1818624
v_mfma_f32_16x16x32_bf16 v[68:71], a[64:67], a[132:135], 0
TR 6,16,42752
s_add_u32 s66, s66, s65
MAA 68,68,148
TR 8,16,33824
s_add_u32 s66, s66, 12582912
v_mfma_f32_16x16x32_bf16 v[84:87], a[72:75], a[132:135], 0
buffer_load_dwordx4 v13, s[80:83], s54 offen offset:1056 lds
MAA 84,76,148
TR 10,16,34336
s_add_u32 s65, s66, 49152
v_mfma_f32_16x16x32_bf16 v[80:83], a[72:75], a[128:131], 0
TR 12,16,42272
s_lshl_b32 s62, s12, 16
MAA 80,76,144
TR 14,16,42784
s_add_u32 s62, s62, s66
v_mfma_f32_16x16x32_bf16 v[128:131], a[80:83], a[128:131], 0
TR 16,16,33856
s_add_u32 s63, s62, 16384
MAA 128,84,144
buffer_load_dwordx4 v14, s[80:83], s54 offen offset:2112 lds
v_mfma_f32_16x16x32_bf16 v[132:135], a[80:83], a[132:135], 0
TR 18,16,34368
s_add_u32 s64, s62, 32768
MAA 132,84,148
TR 20,16,42304
s_lshl_b32 s72, s10, 1
v_mfma_f32_16x16x32_bf16 v[148:151], a[88:91], a[132:135], 0
TR 22,16,42816
s_lshr_b32 s74, s11, 4
MAA 148,92,148
TR 24,16,33888
s_add_u32 s72, s72, s74
v_mfma_f32_16x16x32_bf16 v[144:147], a[88:91], a[128:131], 0
buffer_load_dwordx4 v15, s[80:83], s54 offen offset:3168 lds
MAA 144,92,144
TR 26,16,34400
s_add_u32 s54, s54, 458752
v_mfma_f32_16x16x32_bf16 v[192:195], a[96:99], a[128:131], 0
TR 28,16,42336
s_add_u32 m0, s57, 0
MAA 192,100,144
TR 30,16,42848
s_mov_b32 s58, 29622272
v_mfma_f32_16x16x32_bf16 v[196:199], a[96:99], a[132:135], 0
TR 32,16,33920
s_lshl_b32 s72, s72, 10
MAA 196,100,148
buffer_load_dwordx4 v4, s[16:19], s58 offen sc1 lds
v_mfma_f32_16x16x32_bf16 v[212:215], a[104:107], a[132:135], 0
TR 34,16,34432
s_add_u32 s72, s72, 30457856
MAA 212,108,148
TR 36,16,42368
s_and_b32 s73, s6, 14
v_mfma_f32_16x16x32_bf16 v[208:211], a[104:107], a[128:131], 0
TR 38,16,42880
s_and_b32 s74, s7, 1
MAA 208,108,144
TR 40,16,33952
s_add_u32 s73, s73, s74
v_mfma_f32_16x16x32_bf16 v[240:243], a[112:115], a[128:131], 0
buffer_load_dwordx4 v4, s[16:19], s58 offen offset:1024 sc1 lds
MAA 240,116,144
TR 42,16,34464
s_lshl_b32 s73, s73, 10
v_mfma_f32_16x16x32_bf16 v[244:247], a[112:115], a[132:135], 0
TR 44,16,42400
s_add_u32 s73, s73, 30457856
MAA 244,116,148
TR 46,16,42912
s_lshr_b32 s67, s5, 2
v_mfma_f32_16x16x32_bf16 v[252:255], a[120:123], a[132:135], 0
TR 48,17,33792
MAA 252,124,148
TR 50,17,34304
v_mfma_f32_16x16x32_bf16 v[248:251], a[120:123], a[128:131], 0
buffer_load_dwordx4 a[128:131], v10, s[16:19], s52 offen sc1
MAA 248,124,144
TR 52,17,42240
v_mfma_f32_16x16x32_bf16 v[220:223], a[104:107], a[140:143], 0
TR 54,17,42752
MAA 220,108,156
TR 56,17,33824
v_mfma_f32_16x16x32_bf16 v[216:219], a[104:107], a[136:139], 0
TR 58,17,34336
MAA 216,108,152
buffer_load_dwordx4 a[132:135], v10, s[16:19], s52 offen offset:1024 sc1
v_mfma_f32_16x16x32_bf16 v[200:203], a[96:99], a[136:139], 0
TR 60,17,42272
s_add_u32 s52, s52, 131072
MAA 200,100,152
TR 62,17,42784
v_mfma_f32_16x16x32_bf16 v[204:207], a[96:99], a[140:143], 0
RD 192,9,33792
MAA 204,100,156
RD 196,9,34848
v_mfma_f32_16x16x32_bf16 v[156:159], a[88:91], a[140:143], 0
buffer_load_dwordx4 a[144:147], v10, s[16:19], s52 offen sc1
MAA 156,92,156
RD 200,9,35904
v_mfma_f32_16x16x32_bf16 v[152:155], a[88:91], a[136:139], 0
RD 204,9,36960
MAA 152,92,152
v_mfma_f32_16x16x32_bf16 v[136:139], a[80:83], a[136:139], 0
MAA 136,84,152
buffer_load_dwordx4 a[148:151], v10, s[16:19], s52 offen offset:1024 sc1
v_mfma_f32_16x16x32_bf16 v[140:143], a[80:83], a[140:143], 0
s_add_u32 s52, s52, 131072
MAA 140,84,156
v_mfma_f32_16x16x32_bf16 v[92:95], a[72:75], a[140:143], 0
MAA 92,76,156
v_mfma_f32_16x16x32_bf16 v[88:91], a[72:75], a[136:139], 0
MAA 88,76,152
v_mfma_f32_16x16x32_bf16 v[72:75], a[64:67], a[136:139], 0
MAA 72,68,152
v_mfma_f32_16x16x32_bf16 v[76:79], a[64:67], a[140:143], 0
MAA 76,68,156
s_waitcnt vmcnt(18) lgkmcnt(0)
s_barrier
MAA 32,0,160
buffer_load_dwordx4 a[136:139], v11, s[16:19], s53 offen sc1
MAA 32,4,176
TR 64,16,50688
s_and_b32 s67, s67, 3
v_smfmac_f32_16x16x64_bf16 a[212:215], a[208:211], a[192:199], v6
TR 66,16,51200
s_lshl_b32 s67, s67, 7
v_smfmac_f32_16x16x64_bf16 a[212:215], a[208:211], a[200:207], v6
TR 68,16,59136
s_add_u32 s73, s73, s67
MAA 36,4,180
TR 70,16,59648
s_and_b32 s74, s7, 1
MAA 36,0,164
buffer_load_dwordx4 a[140:143], v11, s[16:19], s53 offen offset:1024 sc1
MAA 52,8,164
TR 72,16,50720
s_add_u32 s53, s53, 131072
MAA 52,12,180
TR 74,16,51232
s_mul_i32 s87, s74, 917504
MAA 48,12,176
TR 76,16,59168
s_lshr_b32 s75, s6, 1
MAA 48,8,160
TR 78,16,59680
s_mul_i32 s75, s75, 1818624
MAA 96,16,160
buffer_load_dwordx4 a[152:155], v11, s[16:19], s53 offen sc1
MAA 96,20,176
TR 80,16,50752
s_add_u32 s87, s87, s75
MAA 100,20,180
TR 82,16,51264
s_add_u32 s87, s87, 12582912
MAA 100,16,164
TR 84,16,59200
s_and_b32 s74, s6, 3
MAA 116,24,164
TR 86,16,59712
.Lpad13:
s_cbranch_execz .Lpad16
s_xor_b32 s75, s74, 0
MAA 116,28,180
buffer_load_dwordx4 a[156:159], v11, s[16:19], s53 offen offset:1024 sc1
MAA 112,28,176
TR 88,16,50784
s_add_u32 s53, s53, 131072
MAA 112,24,160
TR 90,16,51296
s_add_u32 m0, s55, 118272
MAA 160,32,160
TR 92,16,59232
s_sub_u32 s75, s75, 0
MAA 160,36,176
TR 94,16,59744
s_mul_i32 s98, s75, 458752
MAA 164,36,180
buffer_load_dwordx4 v12, s[32:35], s54 offen lds
MAA 164,32,164
TR 96,16,50816
s_mul_i32 s75, s75, 114688
MAA 180,40,164
TR 98,16,51328
s_add_u32 s76, s87, s75
MAA 180,44,180
TR 100,16,59264
s_xor_b32 s75, s74, 1
MAA 176,44,176
TR 102,16,59776
s_sub_u32 s75, s75, 1
MAA 176,40,160
buffer_load_dwordx4 v13, s[32:35], s54 offen offset:1056 lds
MAA 224,48,160
TR 104,16,50848
s_mul_i32 s99, s75, 458752
MAA 224,52,176
TR 106,16,51360
s_mul_i32 s75, s75, 114688
MAA 228,52,180
TR 108,16,59296
s_add_u32 s77, s87, s75
MAA 228,48,164
TR 110,16,59808
MAA 236,56,164
buffer_load_dwordx4 v14, s[32:35], s54 offen offset:2112 lds
MAA 236,60,180
TR 112,17,50688
MAA 232,60,176
TR 114,17,51200
MAA 232,56,160
TR 116,17,59136
s_waitcnt vmcnt(21)
MAA 188,40,172
TR 118,17,59648
MAA 188,44,188
buffer_load_dwordx4 v15, s[32:35], s54 offen offset:3168 lds
MAA 184,44,184
TR 120,17,50720
s_add_u32 m0, s57, 2048
MAA 184,40,168
TR 122,17,51232
s_mov_b32 s58, 29624320
MAA 168,32,168
TR 124,17,59168
MAA 168,36,184
TR 126,17,59680
MAA 172,36,188
buffer_load_dwordx4 v4, s[16:19], s58 offen sc1 lds
MAA 172,32,172
RD 192,9,50688
MAA 124,24,172
RD 196,9,51744
MAA 124,28,188
RD 200,9,52800
MAA 120,28,184
RD 204,9,53856
MAA 120,24,168
buffer_load_dwordx4 v4, s[16:19], s58 offen offset:1024 sc1 lds
MAA 104,16,168
MAA 104,20,184
MAA 108,20,188
MAA 108,16,172
MAA 60,8,172
MAA 60,12,188
MAA 56,12,184
MAA 56,8,168
MAA 40,0,168
MAA 40,4,184
MAA 44,4,188
MAA 44,0,172
s_waitcnt vmcnt(20) lgkmcnt(0)
s_barrier
MAA 64,64,160
ds_read_b64_tr_b16 a[0:1], v16
s_add_u32 m0, s55, 135168
MAA 64,68,176
buffer_load_dwordx4 v12, s[80:83], s54 offen lds
v_smfmac_f32_16x16x64_bf16 a[216:219], a[208:211], a[192:199], v6
TR 2,16,512
s_xor_b32 s75, s74, 2
v_smfmac_f32_16x16x64_bf16 a[216:219], a[208:211], a[200:207], v6
TR 4,16,8448
s_sub_u32 s75, s75, 2
MAA 68,68,180
TR 6,16,8960
s_mul_i32 s100, s75, 458752
MAA 68,64,164
TR 8,16,32
s_mul_i32 s75, s75, 114688
MAA 84,72,164
buffer_load_dwordx4 v13, s[80:83], s54 offen offset:1056 lds
MAA 84,76,180
TR 10,16,544
s_add_u32 s78, s87, s75
MAA 80,76,176
TR 12,16,8480
s_xor_b32 s75, s74, 3
MAA 80,72,160
TR 14,16,8992
s_sub_u32 s75, s75, 3
MAA 128,80,160
TR 16,16,64
s_mul_i32 s101, s75, 458752
MAA 128,84,176
buffer_load_dwordx4 v14, s[80:83], s54 offen offset:2112 lds
MAA 132,84,180
TR 18,16,576
s_mul_i32 s75, s75, 114688
MAA 132,80,164
TR 20,16,8512
s_add_u32 s79, s87, s75
MAA 148,88,164
TR 22,16,9024
s_and_b32 s87, s6, 3
MAA 148,92,180
TR 24,16,96
s_mov_b32 s46, 0
MAA 144,92,176
buffer_load_dwordx4 v15, s[80:83], s54 offen offset:3168 lds
MAA 144,88,160
TR 26,16,608
s_add_u32 s54, s54, 458752
MAA 192,96,160
TR 28,16,8544
s_add_u32 m0, s57, 4096
MAA 192,100,176
TR 30,16,9056
s_mov_b32 s58, 29626368
MAA 196,100,180
TR 32,16,128
s_lshl_b32 s74, s3, 10
MAA 196,96,164
buffer_load_dwordx4 v4, s[16:19], s58 offen sc1 lds
MAA 212,104,164
TR 34,16,640
s_lshl_b32 s75, s12, 9
MAA 212,108,180
TR 36,16,8576
s_add_u32 s74, s74, s75
MAA 208,108,176
TR 38,16,9088
s_add_u32 s74, s74, 152576
MAA 208,104,160
TR 40,16,160
v_and_b32 v18, 15, v1
MAA 240,112,160
buffer_load_dwordx4 v4, s[16:19], s58 offen offset:1024 sc1 lds
MAA 240,116,176
TR 42,16,672
v_lshl_add_u32 v18, v18, 4, s74
MAA 244,116,180
TR 44,16,8608
v_xor_b32 v19, 512, v18
MAA 244,112,164
TR 46,16,9120
MAA 252,120,164
ds_read_b64_tr_b16 a[48:49], v17
MAA 252,124,180
TR 50,17,512
MAA 248,124,176
TR 52,17,8448
MAA 248,120,160
buffer_load_dwordx4 a[160:163], v10, s[16:19], s52 offen sc1
MAA 220,104,172
TR 54,17,8960
MAA 220,108,188
TR 56,17,32
MAA 216,108,184
TR 58,17,544
MAA 216,104,168
TR 60,17,8480
MAA 200,96,168
buffer_load_dwordx4 a[164:167], v10, s[16:19], s52 offen offset:1024 sc1
MAA 200,100,184
TR 62,17,8992
s_add_u32 s52, s52, 131072
MAA 204,100,188
ds_read_b128 a[192:195], v9
MAA 204,96,172
RD 196,9,1056
MAA 156,88,172
RD 200,9,2112
MAA 156,92,188
buffer_load_dwordx4 a[176:179], v10, s[16:19], s52 offen sc1
MAA 152,92,184
RD 204,9,3168
MAA 152,88,168
MAA 136,80,168
MAA 136,84,184
MAA 140,84,188
buffer_load_dwordx4 a[180:183], v10, s[16:19], s52 offen offset:1024 sc1
MAA 140,80,172
s_add_u32 s52, s52, 131072
MAA 92,72,172
MAA 92,76,188
MAA 88,76,184
MAA 88,72,168
MAA 72,64,168
MAA 72,68,184
MAA 76,68,188
MAA 76,64,172
s_waitcnt vmcnt(20) lgkmcnt(0)
s_barrier
MAA 32,0,128
buffer_load_dwordx4 a[168:171], v11, s[16:19], s53 offen sc1
MAA 32,4,144
ds_read_b128 v[20:23], v2
v_smfmac_f32_16x16x64_bf16 a[212:215], a[208:211], a[192:199], v6
ds_read_b128 v[28:31], v2 offset:1024
v_smfmac_f32_16x16x64_bf16 a[212:215], a[208:211], a[200:207], v6
s_waitcnt vmcnt(11)
ds_read_b128 v[24:27], v2 offset:2048
MAA 36,4,148
TR 64,16,16896
MAA 36,0,132
buffer_load_dwordx4 a[172:175], v11, s[16:19], s53 offen offset:1024 sc1
MAA 52,8,132
TR 66,16,17408
s_add_u32 s53, s53, 131072
MAA 52,12,148
TR 68,16,25344
MAA 48,12,144
TR 70,16,25856
MAA 48,8,128
TR 72,16,16928
MAA 96,16,128
buffer_load_dwordx4 a[184:187], v11, s[16:19], s53 offen sc1
MAA 96,20,144
TR 74,16,17440
s_waitcnt lgkmcnt(7)
v_add_f32 v20, v20, v28
MAA 100,20,148
TR 76,16,25376
v_add_f32 v21, v21, v29
MAA 100,16,132
TR 78,16,25888
v_add_f32 v22, v22, v30
MAA 116,24,132
TR 80,16,16960
v_add_f32 v23, v23, v31
MAA 116,28,148
buffer_load_dwordx4 a[188:191], v11, s[16:19], s53 offen offset:1024 sc1
MAA 112,28,144
ds_read_b128 v[28:31], v2 offset:3072
s_add_u32 s53, s53, 131072
MAA 112,24,128
TR 82,16,17472
s_add_u32 m0, s55, 84480
MAA 160,32,128
TR 84,16,25408
s_waitcnt lgkmcnt(12)
v_add_f32 v20, v20, v24
MAA 160,36,144
TR 86,16,25920
v_add_f32 v21, v21, v25
MAA 164,36,148
buffer_load_dwordx4 v12, s[32:35], s54 offen lds
MAA 164,32,132
TR 88,16,16992
v_add_f32 v22, v22, v26
MAA 180,40,132
TR 90,16,17504
v_add_f32 v23, v23, v27
MAA 180,44,148
TR 92,16,25440
MAA 176,44,144
TR 94,16,25952
MAA 176,40,128
buffer_load_dwordx4 v13, s[32:35], s54 offen offset:1056 lds
MAA 224,48,128
TR 96,16,17024
MAA 224,52,144
TR 98,16,17536
MAA 228,52,148
TR 100,16,25472
MAA 228,48,132
TR 102,16,25984
MAA 236,56,132
buffer_load_dwordx4 v14, s[32:35], s54 offen offset:2112 lds
MAA 236,60,148
TR 104,16,17056
MAA 232,60,144
TR 106,16,17568
MAA 232,56,128
TR 108,16,25504
MAA 188,40,140
TR 110,16,26016
MAA 188,44,156
buffer_load_dwordx4 v15, s[32:35], s54 offen offset:3168 lds
MAA 184,44,152
TR 112,17,16896
s_add_u32 m0, s57, 6144
MAA 184,40,136
TR 114,17,17408
s_mov_b32 s58, 29628416
MAA 168,32,136
TR 116,17,25344
MAA 168,36,152
TR 118,17,25856
MAA 172,36,156
buffer_load_dwordx4 v4, s[16:19], s58 offen sc1 lds
MAA 172,32,140
TR 120,17,16928
MAA 124,24,140
TR 122,17,17440
MAA 124,28,156
TR 124,17,25376
MAA 120,28,152
TR 126,17,25888
MAA 120,24,136
buffer_load_dwordx4 v4, s[16:19], s58 offen offset:1024 sc1 lds
MAA 104,16,136
RD 192,9,16896
MAA 104,20,152
RD 196,9,17952
MAA 108,20,156
RD 200,9,19008
MAA 108,16,140
RD 204,9,20064
MAA 60,8,140
MAA 60,12,156
MAA 56,12,152
MAA 56,8,136
MAA 40,0,136
MAA 40,4,152
MAA 44,4,156
s_sub_u32 s47, s47, 1
s_cbranch_scc1 .Lx39
.Lx39b:
MAA 44,0,140
s_waitcnt lgkmcnt(0)
s_barrier
MAA 64,64,128
s_waitcnt vmcnt(14)
ds_read_b128 v[24:27], v2 offset:4096
s_add_u32 m0, s55, 101376
MAA 64,68,144
buffer_load_dwordx4 v12, s[80:83], s54 offen lds
v_smfmac_f32_16x16x64_bf16 a[216:219], a[208:211], a[192:199], v6
TR 0,16,33792
v_add_f32 v20, v20, v28
v_smfmac_f32_16x16x64_bf16 a[216:219], a[208:211], a[200:207], v6
TR 2,16,34304
v_add_f32 v21, v21, v29
MAA 68,68,148
TR 4,16,42240
v_add_f32 v22, v22, v30
MAA 68,64,132
TR 6,16,42752
v_add_f32 v23, v23, v31
MAA 84,72,132
ds_read_b128 v[28:31], v2 offset:5120
MAA 84,76,148
TR 8,16,33824
MAA 80,76,144
buffer_load_dwordx4 v13, s[80:83], s54 offen offset:1056 lds
MAA 80,72,128
TR 10,16,34336
s_waitcnt lgkmcnt(7)
v_add_f32 v20, v20, v24
MAA 128,80,128
TR 12,16,42272
v_add_f32 v21, v21, v25
MAA 128,84,144
TR 14,16,42784
v_add_f32 v22, v22, v26
MAA 132,84,148
TR 16,16,33856
v_add_f32 v23, v23, v27
MAA 132,80,132
TR 18,16,34368
MAA 148,88,132
TR 20,16,42304
MAA 148,92,148
buffer_load_dwordx4 v14, s[80:83], s54 offen offset:2112 lds
MAA 144,92,144
TR 22,16,42816
MAA 144,88,128
TR 24,16,33888
MAA 192,96,128
TR 26,16,34400
MAA 192,100,144
TR 28,16,42336
MAA 196,100,148
TR 30,16,42848
MAA 196,96,132
TR 32,16,33920
MAA 212,104,132
buffer_load_dwordx4 v15, s[80:83], s54 offen offset:3168 lds
MAA 212,108,148
TR 34,16,34432
s_add_u32 s54, s54, 458752
MAA 208,108,144
TR 36,16,42368
MAA 208,104,128
TR 38,16,42880
MAA 240,112,128
TR 40,16,33952
MAA 240,116,144
TR 42,16,34464
MAA 244,116,148
TR 44,16,42400
MAA 244,112,132
TR 46,16,42912
MAA 252,120,132
TR 48,17,33792
MAA 252,124,148
TR 50,17,34304
MAA 248,124,144
TR 52,17,42240
MAA 248,120,128
buffer_load_dwordx4 a[128:131], v10, s[16:19], s52 offen sc1
MAA 220,104,140
TR 54,17,42752
MAA 220,108,156
TR 56,17,33824
MAA 216,108,152
TR 58,17,34336
MAA 216,104,136
TR 60,17,42272
MAA 200,96,136
TR 62,17,42784
MAA 200,100,152
RD 192,9,33792
MAA 204,100,156
buffer_load_dwordx4 a[132:135], v10, s[16:19], s52 offen offset:1024 sc1
MAA 204,96,140
RD 196,9,34848
s_add_u32 s52, s52, 131072
MAA 156,88,140
RD 200,9,35904
MAA 156,92,156
RD 204,9,36960
MAA 152,92,152
MAA 152,88,136
MAA 136,80,136
MAA 136,84,152
buffer_load_dwordx4 a[144:147], v10, s[16:19], s52 offen sc1
MAA 140,84,156
MAA 140,80,140
MAA 92,72,140
MAA 92,76,156
MAA 88,76,152
MAA 88,72,136
MAA 72,64,136
buffer_load_dwordx4 a[148:151], v10, s[16:19], s52 offen offset:1024 sc1
MAA 72,68,152
s_add_u32 s52, s52, 131072
MAA 76,68,156
s_sub_u32 s47, s47, 1
s_cbranch_scc1 .Lx40
.Lx40b:
MAA 76,64,140
s_waitcnt vmcnt(18) lgkmcnt(0)
s_barrier
MAA 32,0,160
buffer_load_dwordx4 a[136:139], v11, s[16:19], s53 offen sc1
MAA 32,4,176
s_waitcnt vmcnt(9)
ds_read_b128 v[24:27], v2 offset:6144
v_add_f32 v20, v20, v28
v_smfmac_f32_16x16x64_bf16 a[212:215], a[208:211], a[192:199], v6
TR 64,16,50688
v_add_f32 v21, v21, v29
v_smfmac_f32_16x16x64_bf16 a[212:215], a[208:211], a[200:207], v6
TR 66,16,51200
v_add_f32 v22, v22, v30
MAA 36,4,180
TR 68,16,59136
v_add_f32 v23, v23, v31
MAA 36,0,164
ds_read_b128 v[28:31], v2 offset:7168
MAA 52,8,164
TR 70,16,59648
MAA 52,12,180
buffer_load_dwordx4 a[140:143], v11, s[16:19], s53 offen offset:1024 sc1
MAA 48,12,176
TR 72,16,50720
s_add_u32 s53, s53, 131072
MAA 48,8,160
TR 74,16,51232
s_waitcnt lgkmcnt(7)
v_add_f32 v20, v20, v24
MAA 96,16,160
TR 76,16,59168
v_add_f32 v21, v21, v25
MAA 96,20,176
TR 78,16,59680
v_add_f32 v22, v22, v26
MAA 100,20,180
TR 80,16,50752
v_add_f32 v23, v23, v27
MAA 100,16,164
TR 82,16,51264
s_waitcnt lgkmcnt(7)
v_add_f32 v20, v20, v28
MAA 116,24,164
buffer_load_dwordx4 a[152:155], v11, s[16:19], s53 offen sc1
MAA 116,28,180
TR 84,16,59200
v_add_f32 v21, v21, v29
MAA 112,28,176
TR 86,16,59712
v_add_f32 v22, v22, v30
MAA 112,24,160
TR 88,16,50784
v_add_f32 v23, v23, v31
MAA 160,32,160
TR 90,16,51296
MAA 160,36,176
TR 92,16,59232
MAA 164,36,180
TR 94,16,59744
MAA 164,32,164
buffer_load_dwordx4 a[156:159], v11, s[16:19], s53 offen offset:1024 sc1
MAA 180,40,164
TR 96,16,50816
s_add_u32 s53, s53, 131072
MAA 180,44,180
TR 98,16,51328
s_add_u32 m0, s55, 118272
MAA 176,44,176
TR 100,16,59264
MAA 176,40,160
TR 102,16,59776
MAA 224,48,160
TR 104,16,50848
MAA 224,52,176
.Lpad14:
s_cbranch_execz .Lnopoll34r
TR 106,16,51360
MAA 228,52,180
buffer_load_dwordx4 v12, s[32:35], s54 offen lds
MAA 228,48,164
TR 108,16,59296
MAA 236,56,164
TR 110,16,59808
MAA 236,60,180
TR 112,17,50688
MAA 232,60,176
TR 114,17,51200
MAA 232,56,160
TR 116,17,59136
MAA 188,40,172
TR 118,17,59648
MAA 188,44,188
buffer_load_dwordx4 v13, s[32:35], s54 offen offset:1056 lds
MAA 184,44,184
TR 120,17,50720
MAA 184,40,168
TR 122,17,51232
MAA 168,32,168
TR 124,17,59168
MAA 168,36,184
TR 126,17,59680
MAA 172,36,188
RD 192,9,50688
MAA 172,32,172
RD 196,9,51744
MAA 124,24,172
buffer_load_dwordx4 v14, s[32:35], s54 offen offset:2112 lds
MAA 124,28,188
RD 200,9,52800
MAA 120,28,184
RD 204,9,53856
MAA 120,24,168
MAA 104,16,168
MAA 104,20,184
MAA 108,20,188
MAA 108,16,172
buffer_load_dwordx4 v15, s[32:35], s54 offen offset:3168 lds
MAA 60,8,172
MAA 60,12,188
MAA 56,12,184
MAA 56,8,168
MAA 40,0,168
MAA 40,4,184
MAA 44,4,188
s_sub_u32 s47, s47, 1
s_cbranch_scc1 .Lx41
.Lx41b:
MAA 44,0,172
s_waitcnt lgkmcnt(0)
s_barrier
MAA 64,64,160
ds_read_b64_tr_b16 a[0:1], v16
s_add_u32 m0, s55, 135168
MAA 64,68,176
buffer_load_dwordx4 v12, s[80:83], s54 offen lds
v_smfmac_f32_16x16x64_bf16 a[216:219], a[208:211], a[192:199], v6
TR 2,16,512
v_permlane32_swap_b32 v20, v22
v_smfmac_f32_16x16x64_bf16 a[216:219], a[208:211], a[200:207], v6
TR 4,16,8448
v_permlane32_swap_b32 v21, v23
MAA 68,68,180
TR 6,16,8960
v_add_f32 v20, v20, v22
MAA 68,64,164
TR 8,16,32
v_add_f32 v21, v21, v23
MAA 84,72,164
TR 10,16,544
v_mul_f32 v20, 0xba800000, v20
MAA 84,76,180
buffer_load_dwordx4 v13, s[80:83], s54 offen offset:1056 lds
MAA 80,76,176
TR 12,16,8480
v_mul_f32 v21, 0x3a800000, v21
MAA 80,72,160
TR 14,16,8992
v_fma_f32 v21, -v20, v20, v21
MAA 128,80,160
TR 16,16,64
v_max_f32 v21, 0, v21
MAA 128,84,176
TR 18,16,576
v_add_f32 v21, 0x3727c5ac, v21
MAA 132,84,180
TR 20,16,8512
v_rsq_f32 v22, v21
MAA 132,80,164
TR 22,16,9024
v_and_b32 v24, 31, v1
MAA 148,88,164
buffer_load_dwordx4 v14, s[80:83], s54 offen offset:2112 lds
MAA 148,92,180
TR 24,16,96
v_lshrrev_b32 v25, 5, v1
MAA 144,92,176
TR 26,16,608
v_lshl_add_u32 v24, v24, 1, v25
MAA 144,88,160
TR 28,16,8544
v_and_b32 v25, 0xc0, v0
MAA 192,96,160
TR 30,16,9056
v_add_u32 v24, v24, v25
MAA 192,100,176
TR 32,16,128
v_lshlrev_b32 v24, 4, v24
MAA 196,100,180
TR 34,16,640
v_add_u32 v24, 152576, v24
MAA 196,96,164
buffer_load_dwordx4 v15, s[80:83], s54 offen offset:3168 lds
MAA 212,104,164
TR 36,16,8576
s_add_u32 s54, s54, 458752
MAA 212,108,180
TR 38,16,9088
v_mul_f32 v22, 0xbfb8aa3b, v22
MAA 208,108,176
ds_write_b128 v24, v[20:23]
s_mov_b32 s58, s98
MAA 208,104,160
ds_read_b64 v[20:21], v18
s_mov_b32 s67, s59
MAA 240,112,160
ds_read_b64 v[22:23], v18 offset:256
MAA 240,116,176
ds_read_b64 v[24:25], v19
MAA 244,116,180
ds_read_b64 v[26:27], v19 offset:256
MAA 244,112,164
ds_read_b32 v28, v18 offset:8
MAA 252,120,164
ds_read_b32 v29, v18 offset:264
v_mov_b32 v18, v5
MAA 252,124,180
ds_read_b32 v30, v19 offset:8
MAA 248,124,176
ds_read_b32 v31, v19 offset:264
v_add_u32 v19, 992, v5
MAA 248,120,160
buffer_load_dwordx4 a[160:163], v10, s[16:19], s52 offen sc1
MAA 220,104,172
TR 40,16,160
MAA 220,108,188
TR 42,16,672
MAA 216,108,184
TR 44,16,8608
MAA 216,104,168
TR 46,16,9120
MAA 200,96,168
ds_read_b64_tr_b16 a[48:49], v17
MAA 200,100,184
TR 50,17,512
MAA 204,100,188
buffer_load_dwordx4 a[164:167], v10, s[16:19], s52 offen offset:1024 sc1
MAA 204,96,172
TR 52,17,8448
s_add_u32 s52, s52, 131072
MAA 156,88,172
TR 54,17,8960
MAA 156,92,188
TR 56,17,32
MAA 152,92,184
TR 58,17,544
MAA 152,88,168
TR 60,17,8480
MAA 136,80,168
TR 62,17,8992
MAA 136,84,184
buffer_load_dwordx4 a[176:179], v10, s[16:19], s52 offen sc1
MAA 140,84,188
ds_read_b128 a[192:195], v9
MAA 140,80,172
RD 196,9,1056
MAA 92,72,172
RD 200,9,2112
MAA 92,76,188
RD 204,9,3168
MAA 88,76,184
MAA 88,72,168
MAA 72,64,168
buffer_load_dwordx4 a[180:183], v10, s[16:19], s52 offen offset:1024 sc1
MAA 72,68,184
s_add_u32 s52, s52, 131072
MAA 76,68,188
s_sub_u32 s47, s47, 1
s_cbranch_scc1 .Lx42
.Lx42b:
MAA 76,64,172
s_mov_b32 s15, -5
.p2align 6
.Lk43:
s_waitcnt vmcnt(16) lgkmcnt(0)
s_barrier
MAA 32,0,128
TR 64,16,16896
MAA 32,4,144
buffer_load_dwordx4 a[168:171], v11, s[16:19], s53 offen sc1
v_smfmac_f32_16x16x64_bf16 a[212:215], a[208:211], a[192:199], v6
s_sub_u32 s47, s47, 1
s_cbranch_scc1 .Lx44
.Lx44b:
v_smfmac_f32_16x16x64_bf16 a[212:215], a[208:211], a[200:207], v6
TR 66,16,17408
MAA 36,4,148
TR 68,16,25344
MAA 36,0,132
TR 70,16,25856
MAA 52,8,132
TR 72,16,16928
MAA 52,12,148
buffer_load_dwordx4 a[172:175], v11, s[16:19], s53 offen offset:1024 sc1
MAA 48,12,144
TR 74,16,17440
s_add_u32 s53, s53, 131072
MAA 48,8,128
MAA 96,16,128
TR 76,16,25376
MAA 96,20,144
TR 78,16,25888
MAA 100,20,148
TR 80,16,16960
MAA 100,16,132
buffer_load_dwordx4 a[184:187], v11, s[16:19], s53 offen sc1
MAA 116,24,132
TR 82,16,17472
MAA 116,28,148
TR 84,16,25408
MAA 112,28,144
MAA 112,24,128
TR 86,16,25920
MAA 160,32,128
TR 88,16,16992
MAA 160,36,144
buffer_load_dwordx4 a[188:191], v11, s[16:19], s53 offen offset:1024 sc1
MAA 164,36,148
TR 90,16,17504
s_add_u32 s53, s53, 131072
MAA 164,32,132
TR 92,16,25440
MAA 180,40,132
TR 94,16,25952
MAA 180,44,148
MAA 176,44,144
TR 96,16,17024
s_add_u32 m0, s55, 84480
MAA 176,40,128
buffer_load_dwordx4 v12, s[32:35], s54 offen lds
MAA 224,48,128
TR 98,16,17536
MAA 224,52,144
TR 100,16,25472
MAA 228,52,148
TR 102,16,25984
MAA 228,48,132
TR 104,16,17056
MAA 236,56,132
MAA 236,60,148
TR 106,16,17568
MAA 232,60,144
TR 108,16,25504
MAA 232,56,128
TR 110,16,26016
s_waitcnt vmcnt(17)
MAA 188,40,140
TR 112,17,16896
MAA 188,44,156
buffer_load_dwordx4 v13, s[32:35], s54 offen offset:1056 lds
MAA 184,44,152
TR 114,17,17408
MAA 184,40,136
MAA 168,32,136
TR 116,17,25344
MAA 168,36,152
buffer_load_dwordx4 v14, s[32:35], s54 offen offset:2112 lds
MAA 172,36,156
TR 118,17,25856
MAA 172,32,140
TR 120,17,16928
MAA 124,24,140
TR 122,17,17440
MAA 124,28,156
TR 124,17,25376
MAA 120,28,152
MAA 120,24,136
buffer_load_dwordx4 v15, s[32:35], s54 offen offset:3168 lds
MAA 104,16,136
TR 126,17,25888
MAA 104,20,152
RD 192,9,16896
MAA 108,20,156
RD 196,9,17952
MAA 108,16,140
RD 200,9,19008
MAA 60,8,140
RD 204,9,20064
s_mov_b32 m0, s67
MAA 60,12,156
buffer_load_dwordx4 v18, s[28:31], s58 offen lds
MAA 56,12,152
MAA 56,8,136
MAA 40,0,136
MAA 40,4,152
MAA 44,4,156
MAA 44,0,140
s_waitcnt vmcnt(17) lgkmcnt(0)
s_barrier
MAA 64,64,128
TR 0,16,33792
s_add_u32 m0, s55, 101376
MAA 64,68,144
buffer_load_dwordx4 v12, s[80:83], s54 offen lds
v_smfmac_f32_16x16x64_bf16 a[216:219], a[208:211], a[192:199], v6
s_sub_u32 s47, s47, 1
s_cbranch_scc1 .Lx45
.Lx45b:
v_smfmac_f32_16x16x64_bf16 a[216:219], a[208:211], a[200:207], v6
TR 2,16,34304
MAA 68,68,148
TR 4,16,42240
MAA 68,64,132
TR 6,16,42752
MAA 84,72,132
TR 8,16,33824
MAA 84,76,148
buffer_load_dwordx4 v13, s[80:83], s54 offen offset:1056 lds
MAA 80,76,144
TR 10,16,34336
MAA 80,72,128
MAA 128,80,128
TR 12,16,42272
MAA 128,84,144
TR 14,16,42784
MAA 132,84,148
TR 16,16,33856
MAA 132,80,132
buffer_load_dwordx4 v14, s[80:83], s54 offen offset:2112 lds
MAA 148,88,132
TR 18,16,34368
MAA 148,92,148
TR 20,16,42304
MAA 144,92,144
TR 22,16,42816
MAA 144,88,128
MAA 192,96,128
TR 24,16,33888
MAA 192,100,144
buffer_load_dwordx4 v15, s[80:83], s54 offen offset:3168 lds
MAA 196,100,148
TR 26,16,34400
s_add_u32 s54, s54, 458752
MAA 196,96,132
TR 28,16,42336
MAA 212,104,132
TR 30,16,42848
MAA 212,108,148
TR 32,16,33920
MAA 208,108,144
TR 34,16,34432
s_mov_b32 m0, s67
MAA 208,104,128
buffer_load_dwordx4 v19, s[28:31], s58 offen offset:1056 lds
MAA 240,112,128
s_add_u32 s67, s67, 8448
s_add_u32 s58, s58, 0x40000
MAA 240,116,144
MAA 244,116,148
TR 36,16,42368
MAA 244,112,132
TR 38,16,42880
MAA 252,120,132
TR 40,16,33952
MAA 252,124,148
TR 42,16,34464
MAA 248,124,144
TR 44,16,42400
MAA 248,120,128
buffer_load_dwordx4 a[128:131], v10, s[16:19], s52 offen sc1
MAA 220,104,140
TR 46,16,42912
MAA 220,108,156
MAA 216,108,152
TR 48,17,33792
MAA 216,104,136
TR 50,17,34304
MAA 200,96,136
TR 52,17,42240
MAA 200,100,152
buffer_load_dwordx4 a[132:135], v10, s[16:19], s52 offen offset:1024 sc1
MAA 204,100,156
TR 54,17,42752
s_add_u32 s52, s52, 131072
MAA 204,96,140
TR 56,17,33824
MAA 156,88,140
TR 58,17,34336
MAA 156,92,156
MAA 152,92,152
TR 60,17,42272
MAA 152,88,136
buffer_load_dwordx4 a[144:147], v10, s[16:19], s52 offen sc1
MAA 136,80,136
TR 62,17,42784
MAA 136,84,152
RD 192,9,33792
MAA 140,84,156
RD 196,9,34848
MAA 140,80,140
RD 200,9,35904
MAA 92,72,140
RD 204,9,36960
MAA 92,76,156
buffer_load_dwordx4 a[148:151], v10, s[16:19], s52 offen offset:1024 sc1
MAA 88,76,152
s_add_u32 s52, s52, 131072
MAA 88,72,136
MAA 72,64,136
MAA 72,68,152
MAA 76,68,156
MAA 76,64,140
s_waitcnt vmcnt(18) lgkmcnt(0)
s_barrier
MAA 32,0,160
TR 64,16,50688
MAA 32,4,176
buffer_load_dwordx4 a[136:139], v11, s[16:19], s53 offen sc1
v_smfmac_f32_16x16x64_bf16 a[212:215], a[208:211], a[192:199], v6
s_sub_u32 s47, s47, 1
s_cbranch_scc1 .Lx46
.Lx46b:
v_smfmac_f32_16x16x64_bf16 a[212:215], a[208:211], a[200:207], v6
TR 66,16,51200
MAA 36,4,180
TR 68,16,59136
MAA 36,0,164
TR 70,16,59648
MAA 52,8,164
TR 72,16,50720
MAA 52,12,180
buffer_load_dwordx4 a[140:143], v11, s[16:19], s53 offen offset:1024 sc1
MAA 48,12,176
TR 74,16,51232
s_add_u32 s53, s53, 131072
MAA 48,8,160
MAA 96,16,160
TR 76,16,59168
MAA 96,20,176
TR 78,16,59680
MAA 100,20,180
TR 80,16,50752
MAA 100,16,164
buffer_load_dwordx4 a[152:155], v11, s[16:19], s53 offen sc1
MAA 116,24,164
TR 82,16,51264
MAA 116,28,180
TR 84,16,59200
MAA 112,28,176
MAA 112,24,160
TR 86,16,59712
MAA 160,32,160
TR 88,16,50784
MAA 160,36,176
buffer_load_dwordx4 a[156:159], v11, s[16:19], s53 offen offset:1024 sc1
MAA 164,36,180
TR 90,16,51296
s_add_u32 s53, s53, 131072
MAA 164,32,164
TR 92,16,59232
MAA 180,40,164
TR 94,16,59744
MAA 180,44,180
MAA 176,44,176
TR 96,16,50816
s_add_u32 m0, s55, 118272
MAA 176,40,160
buffer_load_dwordx4 v12, s[32:35], s54 offen lds
MAA 224,48,160
TR 98,16,51328
MAA 224,52,176
TR 100,16,59264
MAA 228,52,180
TR 102,16,59776
MAA 228,48,164
TR 104,16,50848
MAA 236,56,164
MAA 236,60,180
TR 106,16,51360
MAA 232,60,176
TR 108,16,59296
MAA 232,56,160
TR 110,16,59808
s_waitcnt vmcnt(19)
MAA 188,40,172
TR 112,17,50688
MAA 188,44,188
buffer_load_dwordx4 v13, s[32:35], s54 offen offset:1056 lds
MAA 184,44,184
TR 114,17,51200
MAA 184,40,168
MAA 168,32,168
TR 116,17,59136
MAA 168,36,184
buffer_load_dwordx4 v14, s[32:35], s54 offen offset:2112 lds
MAA 172,36,188
TR 118,17,59648
MAA 172,32,172
TR 120,17,50720
MAA 124,24,172
TR 122,17,51232
MAA 124,28,188
TR 124,17,59168
MAA 120,28,184
MAA 120,24,168
buffer_load_dwordx4 v15, s[32:35], s54 offen offset:3168 lds
MAA 104,16,168
TR 126,17,59680
MAA 104,20,184
RD 192,9,50688
MAA 108,20,188
RD 196,9,51744
MAA 108,16,172
RD 200,9,52800
MAA 60,8,172
RD 204,9,53856
s_mov_b32 m0, s67
MAA 60,12,188
buffer_load_dwordx4 v18, s[28:31], s58 offen lds
MAA 56,12,184
MAA 56,8,168
MAA 40,0,168
MAA 40,4,184
MAA 44,4,188
.Lpad15:
s_cbranch_execz .Lnopoll34r
MAA 44,0,172
s_waitcnt vmcnt(19) lgkmcnt(0)
s_barrier
MAA 64,64,160
ds_read_b64_tr_b16 a[0:1], v16
s_add_u32 m0, s55, 135168
MAA 64,68,176
buffer_load_dwordx4 v12, s[80:83], s54 offen lds
v_smfmac_f32_16x16x64_bf16 a[216:219], a[208:211], a[192:199], v6
s_sub_u32 s47, s47, 1
s_cbranch_scc1 .Lx47
.Lx47b:
v_smfmac_f32_16x16x64_bf16 a[216:219], a[208:211], a[200:207], v6
TR 2,16,512
MAA 68,68,180
TR 4,16,8448
MAA 68,64,164
TR 6,16,8960
MAA 84,72,164
TR 8,16,32
MAA 84,76,180
buffer_load_dwordx4 v13, s[80:83], s54 offen offset:1056 lds
MAA 80,76,176
TR 10,16,544
MAA 80,72,160
MAA 128,80,160
TR 12,16,8480
MAA 128,84,176
TR 14,16,8992
MAA 132,84,180
TR 16,16,64
MAA 132,80,164
buffer_load_dwordx4 v14, s[80:83], s54 offen offset:2112 lds
MAA 148,88,164
TR 18,16,576
MAA 148,92,180
TR 20,16,8512
MAA 144,92,176
TR 22,16,9024
MAA 144,88,160
MAA 192,96,160
TR 24,16,96
MAA 192,100,176
buffer_load_dwordx4 v15, s[80:83], s54 offen offset:3168 lds
MAA 196,100,180
TR 26,16,608
s_add_u32 s54, s54, 458752
MAA 196,96,164
TR 28,16,8544
MAA 212,104,164
TR 30,16,9056
MAA 212,108,180
TR 32,16,128
MAA 208,108,176
TR 34,16,640
s_mov_b32 m0, s67
MAA 208,104,160
buffer_load_dwordx4 v19, s[28:31], s58 offen offset:1056 lds
MAA 240,112,160
s_add_u32 s67, s67, 8448
s_add_u32 s46, s46, 1
s_xor_b32 s58, s46, s87
s_mul_i32 s58, s58, 458752
MAA 240,116,176
MAA 244,116,180
TR 36,16,8576
MAA 244,112,164
TR 38,16,9088
MAA 252,120,164
TR 40,16,160
MAA 252,124,180
TR 42,16,672
MAA 248,124,176
TR 44,16,8608
MAA 248,120,160
buffer_load_dwordx4 a[160:163], v10, s[16:19], s52 offen sc1
MAA 220,104,172
TR 46,16,9120
MAA 220,108,188
MAA 216,108,184
ds_read_b64_tr_b16 a[48:49], v17
MAA 216,104,168
TR 50,17,512
MAA 200,96,168
TR 52,17,8448
MAA 200,100,184
buffer_load_dwordx4 a[164:167], v10, s[16:19], s52 offen offset:1024 sc1
MAA 204,100,188
TR 54,17,8960
s_add_u32 s52, s52, 131072
MAA 204,96,172
TR 56,17,32
MAA 156,88,172
TR 58,17,544
MAA 156,92,188
MAA 152,92,184
TR 60,17,8480
MAA 152,88,168
buffer_load_dwordx4 a[176:179], v10, s[16:19], s52 offen sc1
MAA 136,80,168
TR 62,17,8992
MAA 136,84,184
ds_read_b128 a[192:195], v9
MAA 140,84,188
RD 196,9,1056
MAA 140,80,172
RD 200,9,2112
MAA 92,72,172
RD 204,9,3168
MAA 92,76,188
buffer_load_dwordx4 a[180:183], v10, s[16:19], s52 offen offset:1024 sc1
MAA 88,76,184
s_add_u32 s52, s52, 131072
MAA 88,72,168
MAA 72,64,168
MAA 72,68,184
MAA 76,68,188
s_add_u32 s15, s15, 1
MAA 76,64,172
s_cbranch_scc0 .Lk43
s_branch .Lj48
.Lx39:
buffer_load_dword a220, v8, s[40:43], s45 offen
buffer_load_dword a220, v7, s[28:31], s44 offen
s_add_u32 s44, s44, 655360
s_add_u32 s45, s45, 917504
s_mov_b32 s47, 3
s_branch .Lx39b
.Lx40:
buffer_load_dword a220, v8, s[40:43], s45 offen
buffer_load_dword a220, v7, s[28:31], s44 offen
s_add_u32 s44, s44, 655360
s_add_u32 s45, s45, 917504
s_mov_b32 s47, 3
s_branch .Lx40b
.Lx41:
buffer_load_dword a220, v8, s[40:43], s45 offen
buffer_load_dword a220, v7, s[28:31], s44 offen
s_add_u32 s44, s44, 655360
s_add_u32 s45, s45, 917504
s_mov_b32 s47, 3
s_branch .Lx41b
.Lx42:
buffer_load_dword a220, v8, s[40:43], s45 offen
buffer_load_dword a220, v7, s[28:31], s44 offen
s_add_u32 s44, s44, 655360
s_add_u32 s45, s45, 917504
s_mov_b32 s47, 3
s_branch .Lx42b
.Lx44:
buffer_load_dword a220, v8, s[40:43], s45 offen
buffer_load_dword a220, v7, s[28:31], s44 offen
s_add_u32 s44, s44, 655360
s_add_u32 s45, s45, 917504
s_mov_b32 s47, 3
s_branch .Lx44b
.Lx45:
buffer_load_dword a220, v8, s[40:43], s45 offen
buffer_load_dword a220, v7, s[28:31], s44 offen
s_add_u32 s44, s44, 655360
s_add_u32 s45, s45, 917504
s_mov_b32 s47, 3
s_branch .Lx45b
.Lx46:
buffer_load_dword a220, v8, s[40:43], s45 offen
buffer_load_dword a220, v7, s[28:31], s44 offen
s_add_u32 s44, s44, 655360
s_add_u32 s45, s45, 917504
s_mov_b32 s47, 3
s_branch .Lx46b
.Lx47:
buffer_load_dword a220, v8, s[40:43], s45 offen
buffer_load_dword a220, v7, s[28:31], s44 offen
s_add_u32 s44, s44, 655360
s_add_u32 s45, s45, 917504
s_mov_b32 s47, 3
s_branch .Lx47b
.Lj48:
s_waitcnt vmcnt(10) lgkmcnt(0)
s_barrier
v_smfmac_f32_16x16x64_bf16 a[212:215], a[208:211], a[192:199], v6
RD 112,9,16896
s_lshl_b32 s74, s3, 10
v_smfmac_f32_16x16x64_bf16 a[212:215], a[208:211], a[200:207], v6
RD 116,9,17952
s_add_u32 s74, s74, 152576
MAA 32,0,128
RD 120,9,19008
s_sub_u32 s75, 156672, s74
MAA 32,4,144
RD 124,9,20064
v_and_b32 v7, 15, v1
MAA 48,12,144
RD 192,9,33792
v_lshl_add_u32 v7, v7, 5, s74
MAA 48,8,128
RD 196,9,34848
v_bfe_u32 v2, v1, 4, 1
MAA 36,0,132
RD 200,9,35904
v_lshl_add_u32 v7, v2, 4, v7
MAA 36,4,148
RD 204,9,36960
v_bfe_u32 v2, v1, 5, 1
MAA 52,12,148
buffer_load_dwordx4 a[168:171], v11, s[16:19], s53 offen sc1
MAA 52,8,132
TR 64,16,16896
v_mul_u32_u24 v2, s75, v2
s_waitcnt lgkmcnt(7)
v_smfmac_f32_16x16x64_bf16 a[216:219], a[208:211], a[112:119], v6
TR 66,16,17408
v_add_u32 v7, v7, v2
MAA 40,0,136
TR 68,16,25344
v_lshlrev_b32 v2, 4, v1
s_waitcnt lgkmcnt(7)
v_smfmac_f32_16x16x64_bf16 a[216:219], a[208:211], a[120:127], v6
buffer_load_dwordx4 a[172:175], v11, s[16:19], s53 offen offset:1024 sc1
MAA 40,4,152
TR 70,16,25856
s_add_u32 s53, s53, 131072
s_waitcnt lgkmcnt(6)
v_smfmac_f32_16x16x64_bf16 a[212:215], a[208:211], a[192:199], v6
TR 72,16,16928
v_add_u32 v2, 152576, v2
MAA 56,12,152
TR 74,16,17440
s_lshl_b32 s74, s12, 7
s_waitcnt lgkmcnt(6)
v_smfmac_f32_16x16x64_bf16 a[212:215], a[208:211], a[200:207], v6
buffer_load_dwordx4 a[184:187], v11, s[16:19], s53 offen sc1
MAA 56,8,136
TR 76,16,25376
s_add_u32 s74, s74, 161536
MAA 44,0,140
TR 78,16,25888
s_waitcnt vmcnt(8)
s_barrier
MAA 44,4,156
RD 112,9,50688
s_xor_b32 s75, s12, 1
MAA 60,12,156
RD 116,9,51744
s_mul_i32 s75, s75, 384
MAA 60,8,140
RD 120,9,52800
s_add_u32 s75, s75, 161536
MAA 96,16,128
RD 124,9,53856
v_lshrrev_b32 v9, 4, v1
MAA 96,20,144
ds_write_b128 v7, a[212:215]
v_lshlrev_b32 v9, 4, v9
MAA 112,28,144
buffer_load_dwordx4 a[188:191], v11, s[16:19], s53 offen offset:1024 sc1
MAA 112,24,128
TR 80,16,33792
s_add_u32 s53, s53, 131072
MAA 100,16,132
TR 82,16,34304
v_add_u32 v8, s75, v9
MAA 100,20,148
TR 84,16,42240
v_add_u32 v9, s74, v9
MAA 116,28,148
TR 86,16,42752
s_add_u32 s58, s99, 2293760
s_waitcnt lgkmcnt(7)
v_smfmac_f32_16x16x64_bf16 a[216:219], a[208:211], a[112:119], v6
TR 88,16,33824
s_lshl_b32 s74, s3, 11
MAA 116,24,132
TR 90,16,34336
s_add_u32 s74, s74, s84
s_waitcnt lgkmcnt(7)
v_smfmac_f32_16x16x64_bf16 a[216:219], a[208:211], a[120:127], v6
TR 92,16,42272
s_add_u32 s54, s98, 65536
MAA 104,16,136
TR 94,16,42784
s_mul_i32 s55, s3, 2112
MAA 104,20,152
TR 96,16,50688
s_mov_b32 s57, 67584
MAA 120,28,152
ds_write_b128 v7, a[216:219] offset:512
MAA 120,24,136
TR 98,16,51200
MAA 108,16,140
TR 100,16,59136
MAA 108,20,156
TR 102,16,59648
MAA 124,28,156
TR 104,16,50720
MAA 124,24,140
TR 106,16,51232
MAA 160,32,128
TR 108,16,59168
MAA 160,36,144
TR 110,16,59680
MAA 176,44,144
s_waitcnt lgkmcnt(7)
s_barrier
ds_read_b128 v[12:15], v2
MAA 176,40,128
ds_read_b128 v[4:7], v2 offset:1024
MAA 164,32,132
TR 192,16,16960
MAA 164,36,148
TR 194,16,17472
MAA 180,44,148
TR 196,16,25408
MAA 180,40,132
TR 198,16,25920
MAA 168,32,136
TR 200,16,16992
MAA 168,36,152
TR 202,16,17504
MAA 184,44,152
TR 204,16,25440
MAA 184,40,136
TR 206,16,25952
s_waitcnt lgkmcnt(8)
v_add_f32 v12, v12, v4
MAA 172,32,140
TR 112,16,33856
v_add_f32 v13, v13, v5
MAA 172,36,156
TR 114,16,34368
v_add_f32 v14, v14, v6
MAA 188,44,156
TR 116,16,42304
v_add_f32 v15, v15, v7
MAA 188,40,140
ds_read_b128 v[4:7], v2 offset:2048
MAA 224,48,128
TR 118,16,42816
MAA 224,52,144
TR 120,16,33888
MAA 232,60,144
TR 122,16,34400
MAA 232,56,128
TR 124,16,42336
MAA 228,48,132
TR 126,16,42848
MAA 228,52,148
TR 0,16,50752
MAA 236,60,148
TR 2,16,51264
MAA 236,56,132
TR 4,16,59200
s_waitcnt lgkmcnt(8)
v_add_f32 v12, v12, v4
MAA 64,64,128
TR 6,16,59712
v_add_f32 v13, v13, v5
MAA 64,68,144
TR 8,16,50784
v_add_f32 v14, v14, v6
s_waitcnt vmcnt(7)
MAA 64,96,160
TR 10,16,51296
v_add_f32 v15, v15, v7
s_waitcnt vmcnt(5)
MAA 64,100,176
ds_read_b128 v[4:7], v2 offset:3072
MAA 80,108,176
TR 12,16,59232
MAA 80,104,160
TR 14,16,59744
MAA 80,76,144
TR 16,16,17024
MAA 80,72,128
TR 18,16,17536
MAA 32,80,160
TR 20,16,25472
MAA 32,84,176
TR 22,16,25984
MAA 48,92,176
TR 24,16,17056
MAA 48,88,160
TR 26,16,17568
s_waitcnt lgkmcnt(8)
v_add_f32 v12, v12, v4
v_add_f32 v13, v13, v5
v_add_f32 v14, v14, v6
v_add_f32 v15, v15, v7
ds_write_b128 v2, v[12:15] offset:8960
ds_read_b128 v[12:15], v9
ds_read_b128 v[4:7], v9 offset:64
v_lshrrev_b32 v2, 3, v1
v_cmp_eq_u32 vcc, 3, v2
TR 28,16,25504
TR 30,16,26016
TR 32,16,33920
TR 34,16,34432
TR 36,16,42368
TR 38,16,42880
TR 40,16,33952
TR 42,16,34464
TR 44,16,42400
TR 46,16,42912
TR 48,16,50816
TR 50,16,51328
TR 52,16,59264
s_waitcnt lgkmcnt(14)
v_pk_fma_f32 v[32:33], v[12:13], v[20:21], v[32:33] op_sel_hi:[1,0,1]
v_pk_fma_f32 v[34:35], v[14:15], v[20:21], v[34:35] op_sel_hi:[1,0,1]
v_pk_fma_f32 v[36:37], v[12:13], v[22:23], v[36:37] op_sel_hi:[1,0,1]
v_pk_fma_f32 v[38:39], v[14:15], v[22:23], v[38:39] op_sel_hi:[1,0,1]
v_pk_fma_f32 v[40:41], v[12:13], v[24:25], v[40:41] op_sel_hi:[1,0,1]
v_pk_fma_f32 v[42:43], v[14:15], v[24:25], v[42:43] op_sel_hi:[1,0,1]
v_pk_fma_f32 v[44:45], v[12:13], v[26:27], v[44:45] op_sel_hi:[1,0,1]
v_pk_fma_f32 v[46:47], v[14:15], v[26:27], v[46:47] op_sel_hi:[1,0,1]
ds_read_b128 v[12:15], v9 offset:512
s_waitcnt lgkmcnt(14)
v_pk_fma_f32 v[48:49], v[4:5], v[20:21], v[48:49] op_sel_hi:[1,0,1]
v_pk_fma_f32 v[50:51], v[6:7], v[20:21], v[50:51] op_sel_hi:[1,0,1]
v_pk_fma_f32 v[52:53], v[4:5], v[22:23], v[52:53] op_sel_hi:[1,0,1]
v_pk_fma_f32 v[54:55], v[6:7], v[22:23], v[54:55] op_sel_hi:[1,0,1]
v_pk_fma_f32 v[56:57], v[4:5], v[24:25], v[56:57] op_sel_hi:[1,0,1]
v_pk_fma_f32 v[58:59], v[6:7], v[24:25], v[58:59] op_sel_hi:[1,0,1]
v_pk_fma_f32 v[60:61], v[4:5], v[26:27], v[60:61] op_sel_hi:[1,0,1]
v_pk_fma_f32 v[62:63], v[6:7], v[26:27], v[62:63] op_sel_hi:[1,0,1]
ds_read_b128 v[4:7], v9 offset:576
TR 54,16,59776
TR 56,16,50848
TR 58,16,51360
TR 60,16,59296
TR 62,16,59808
s_waitcnt lgkmcnt(6)
v_pk_fma_f32 v[64:65], v[12:13], v[20:21], v[64:65] op_sel_hi:[1,0,1]
v_pk_fma_f32 v[66:67], v[14:15], v[20:21], v[66:67] op_sel_hi:[1,0,1]
v_pk_fma_f32 v[68:69], v[12:13], v[22:23], v[68:69] op_sel_hi:[1,0,1]
v_pk_fma_f32 v[70:71], v[14:15], v[22:23], v[70:71] op_sel_hi:[1,0,1]
v_pk_fma_f32 v[72:73], v[12:13], v[24:25], v[72:73] op_sel_hi:[1,0,1]
v_pk_fma_f32 v[74:75], v[14:15], v[24:25], v[74:75] op_sel_hi:[1,0,1]
v_pk_fma_f32 v[76:77], v[12:13], v[26:27], v[76:77] op_sel_hi:[1,0,1]
v_pk_fma_f32 v[78:79], v[14:15], v[26:27], v[78:79] op_sel_hi:[1,0,1]
ds_read_b128 v[12:15], v9 offset:832
s_waitcnt lgkmcnt(6)
v_pk_fma_f32 v[80:81], v[4:5], v[20:21], v[80:81] op_sel_hi:[1,0,1]
v_pk_fma_f32 v[82:83], v[6:7], v[20:21], v[82:83] op_sel_hi:[1,0,1]
v_pk_fma_f32 v[84:85], v[4:5], v[22:23], v[84:85] op_sel_hi:[1,0,1]
v_pk_fma_f32 v[86:87], v[6:7], v[22:23], v[86:87] op_sel_hi:[1,0,1]
v_pk_fma_f32 v[88:89], v[4:5], v[24:25], v[88:89] op_sel_hi:[1,0,1]
v_pk_fma_f32 v[90:91], v[6:7], v[24:25], v[90:91] op_sel_hi:[1,0,1]
v_pk_fma_f32 v[92:93], v[4:5], v[26:27], v[92:93] op_sel_hi:[1,0,1]
v_pk_fma_f32 v[94:95], v[6:7], v[26:27], v[94:95] op_sel_hi:[1,0,1]
ds_read_b128 v[4:7], v9 offset:704
v_pk_mul_f32 v[64:65], v[64:65], v[32:33]
v_pk_mul_f32 v[32:33], v[32:33], v[28:29] op_sel_hi:[1,0]
v_pk_mul_f32 v[66:67], v[66:67], v[34:35]
v_pk_mul_f32 v[34:35], v[34:35], v[28:29] op_sel_hi:[1,0]
v_pk_mul_f32 v[80:81], v[80:81], v[48:49]
v_pk_mul_f32 v[48:49], v[48:49], v[28:29] op_sel_hi:[1,0]
v_pk_mul_f32 v[82:83], v[82:83], v[50:51]
v_pk_mul_f32 v[50:51], v[50:51], v[28:29] op_sel_hi:[1,0]
v_exp_f32 v32, v32
v_exp_f32 v33, v33
MAA 68,64,132
v_exp_f32 v34, v34
MAA 68,68,148
v_exp_f32 v35, v35
MAA 68,96,164
v_exp_f32 v48, v48
s_waitcnt vmcnt(4)
MAA 68,100,180
v_exp_f32 v49, v49
MAA 84,108,180
v_exp_f32 v50, v50
MAA 84,104,164
v_exp_f32 v51, v51
MAA 84,76,148
MAA 84,72,132
MAA 36,80,164
MAA 36,84,180
MAA 52,92,180
MAA 52,88,164
s_nop 5
v_pk_mul_f32 v[68:69], v[68:69], v[36:37]
v_pk_fma_f32 v[32:33], v[32:33], v[20:21], v[20:21] op_sel:[0,1,1] op_sel_hi:[1,1,1]
v_pk_fma_f32 v[34:35], v[34:35], v[20:21], v[20:21] op_sel:[0,1,1] op_sel_hi:[1,1,1]
v_pk_fma_f32 v[48:49], v[48:49], v[20:21], v[20:21] op_sel:[0,1,1] op_sel_hi:[1,1,1]
v_pk_fma_f32 v[50:51], v[50:51], v[20:21], v[20:21] op_sel:[0,1,1] op_sel_hi:[1,1,1]
v_rcp_f32 v32, v32
v_pk_mul_f32 v[36:37], v[36:37], v[28:29] op_sel:[0,1] op_sel_hi:[1,1]
v_pk_mul_f32 v[70:71], v[70:71], v[38:39]
v_pk_mul_f32 v[38:39], v[38:39], v[28:29] op_sel:[0,1] op_sel_hi:[1,1]
v_pk_mul_f32 v[84:85], v[84:85], v[52:53]
v_pk_mul_f32 v[52:53], v[52:53], v[28:29] op_sel:[0,1] op_sel_hi:[1,1]
v_pk_mul_f32 v[86:87], v[86:87], v[54:55]
v_pk_mul_f32 v[54:55], v[54:55], v[28:29] op_sel:[0,1] op_sel_hi:[1,1]
v_rcp_f32 v33, v33
v_rcp_f32 v34, v34
MAA 72,64,136
v_rcp_f32 v35, v35
MAA 72,68,152
v_rcp_f32 v48, v48
s_waitcnt vmcnt(3)
MAA 72,96,168
v_rcp_f32 v49, v49
s_waitcnt vmcnt(1)
MAA 72,100,184
v_rcp_f32 v50, v50
MAA 88,108,184
v_rcp_f32 v51, v51
MAA 88,104,168
v_exp_f32 v36, v36
MAA 88,76,152
v_exp_f32 v37, v37
MAA 88,72,136
v_exp_f32 v38, v38
MAA 40,80,168
v_exp_f32 v39, v39
MAA 40,84,184
v_exp_f32 v52, v52
MAA 56,92,184
v_exp_f32 v53, v53
MAA 56,88,168
v_exp_f32 v54, v54
v_exp_f32 v55, v55
v_pk_mul_f32 v[64:65], v[64:65], v[32:33]
v_pk_mul_f32 v[66:67], v[66:67], v[34:35]
v_pk_mul_f32 v[80:81], v[80:81], v[48:49]
v_pk_mul_f32 v[82:83], v[82:83], v[50:51]
ds_read_b128 v[48:51], v9 offset:128
v_pk_mul_f32 v[72:73], v[72:73], v[40:41]
v_pk_mul_f32 v[40:41], v[40:41], v[30:31] op_sel_hi:[1,0]
v_pk_mul_f32 v[74:75], v[74:75], v[42:43]
v_pk_mul_f32 v[42:43], v[42:43], v[30:31] op_sel_hi:[1,0]
v_pk_mul_f32 v[88:89], v[88:89], v[56:57]
v_pk_mul_f32 v[56:57], v[56:57], v[30:31] op_sel_hi:[1,0]
v_pk_mul_f32 v[90:91], v[90:91], v[58:59]
v_pk_mul_f32 v[58:59], v[58:59], v[30:31] op_sel_hi:[1,0]
v_pk_fma_f32 v[36:37], v[36:37], v[22:23], v[22:23] op_sel:[0,1,1] op_sel_hi:[1,1,1]
v_pk_fma_f32 v[38:39], v[38:39], v[22:23], v[22:23] op_sel:[0,1,1] op_sel_hi:[1,1,1]
v_pk_fma_f32 v[52:53], v[52:53], v[22:23], v[22:23] op_sel:[0,1,1] op_sel_hi:[1,1,1]
v_pk_fma_f32 v[54:55], v[54:55], v[22:23], v[22:23] op_sel:[0,1,1] op_sel_hi:[1,1,1]
v_cvt_pk_bf16_f32 v32, v64, v65
v_cvt_pk_bf16_f32 v33, v66, v67
ds_read_b128 v[64:67], v9 offset:192
v_cvt_pk_bf16_f32 v34, v80, v81
v_cvt_pk_bf16_f32 v35, v82, v83
MAA 76,64,140
buffer_store_dwordx4 v[32:35], v10, s[16:19], s62 offen sc1
MAA 76,68,156
ds_read_b128 v[80:83], v9 offset:640
v_rcp_f32 v36, v36
MAA 76,96,172
TR 64,17,16896
v_rcp_f32 v37, v37
s_waitcnt vmcnt(1)
MAA 76,100,188
TR 66,17,17408
v_rcp_f32 v38, v38
MAA 92,108,188
TR 68,17,25344
v_rcp_f32 v39, v39
MAA 92,104,172
TR 70,17,25856
v_rcp_f32 v52, v52
MAA 92,76,156
TR 76,17,25376
v_rcp_f32 v53, v53
MAA 92,72,140
TR 72,17,16928
v_rcp_f32 v54, v54
MAA 44,80,172
TR 74,17,17440
v_rcp_f32 v55, v55
MAA 44,84,188
TR 78,17,25888
v_exp_f32 v40, v40
MAA 60,92,188
TR 80,17,33792
.Lpad16:
s_cbranch_execz .Lnopoll34r
v_exp_f32 v41, v41
MAA 60,88,172
TR 82,17,34304
v_exp_f32 v42, v42
v_exp_f32 v43, v43
v_exp_f32 v56, v56
v_exp_f32 v57, v57
v_exp_f32 v58, v58
v_exp_f32 v59, v59
v_pk_mul_f32 v[68:69], v[68:69], v[36:37]
v_pk_mul_f32 v[70:71], v[70:71], v[38:39]
v_pk_mul_f32 v[84:85], v[84:85], v[52:53]
v_pk_mul_f32 v[86:87], v[86:87], v[54:55]
ds_read_b128 v[52:55], v8 offset:576
v_pk_mul_f32 v[76:77], v[76:77], v[44:45]
v_pk_mul_f32 v[44:45], v[44:45], v[30:31] op_sel:[0,1] op_sel_hi:[1,1]
v_pk_mul_f32 v[78:79], v[78:79], v[46:47]
v_pk_mul_f32 v[46:47], v[46:47], v[30:31] op_sel:[0,1] op_sel_hi:[1,1]
v_pk_mul_f32 v[92:93], v[92:93], v[60:61]
v_pk_mul_f32 v[60:61], v[60:61], v[30:31] op_sel:[0,1] op_sel_hi:[1,1]
v_pk_mul_f32 v[94:95], v[94:95], v[62:63]
v_pk_mul_f32 v[62:63], v[62:63], v[30:31] op_sel:[0,1] op_sel_hi:[1,1]
v_pk_fma_f32 v[40:41], v[40:41], v[24:25], v[24:25] op_sel:[0,1,1] op_sel_hi:[1,1,1]
v_pk_fma_f32 v[42:43], v[42:43], v[24:25], v[24:25] op_sel:[0,1,1] op_sel_hi:[1,1,1]
v_pk_fma_f32 v[56:57], v[56:57], v[24:25], v[24:25] op_sel:[0,1,1] op_sel_hi:[1,1,1]
v_pk_fma_f32 v[58:59], v[58:59], v[24:25], v[24:25] op_sel:[0,1,1] op_sel_hi:[1,1,1]
v_cvt_pk_bf16_f32 v36, v68, v69
v_cvt_pk_bf16_f32 v37, v70, v71
v_cvt_pk_bf16_f32 v38, v84, v85
v_cvt_pk_bf16_f32 v39, v86, v87
MAA 128,192,128
buffer_store_dwordx4 v[36:39], v10, s[16:19], s62 offen offset:1024 sc1
MAA 128,196,144
TR 84,17,42240
v_rcp_f32 v40, v40
MAA 128,0,160
TR 86,17,42752
v_rcp_f32 v41, v41
MAA 128,4,176
TR 88,17,33824
v_rcp_f32 v42, v42
MAA 144,12,176
TR 90,17,34336
v_rcp_f32 v43, v43
MAA 144,8,160
TR 92,17,42272
v_rcp_f32 v56, v56
MAA 144,204,144
TR 94,17,42784
v_rcp_f32 v57, v57
MAA 144,200,128
TR 96,17,50688
v_rcp_f32 v58, v58
MAA 96,112,160
TR 98,17,51200
v_rcp_f32 v59, v59
MAA 96,116,176
TR 100,17,59136
v_exp_f32 v44, v44
MAA 112,124,176
TR 102,17,59648
v_exp_f32 v45, v45
MAA 112,120,160
TR 104,17,50720
v_lshrrev_b32 v69, 2, v0
v_min_u32 v69, 1, v69
v_lshlrev_b32 v69, 28, v69
v_lshl_add_u32 v68, v0, 7, v69
v_xor_b32 v69, 64, v0
v_min_u32 v69, 1, v69
v_lshlrev_b32 v70, 4, v69
v_sub_u32 v70, 16, v70
v_lshlrev_b32 v69, 28, v69
v_mov_b32 v71, 1
v_mov_b32 v84, 0
v_mov_b32 v85, 0
v_mov_b32 v86, 0
v_exp_f32 v46, v46
v_exp_f32 v47, v47
v_exp_f32 v60, v60
v_exp_f32 v61, v61
v_exp_f32 v62, v62
v_exp_f32 v63, v63
v_pk_mul_f32 v[72:73], v[72:73], v[40:41]
v_pk_mul_f32 v[74:75], v[74:75], v[42:43]
v_pk_mul_f32 v[88:89], v[88:89], v[56:57]
v_pk_mul_f32 v[90:91], v[90:91], v[58:59]
s_waitcnt lgkmcnt(15)
v_pk_fma_f32 v[96:97], v[48:49], v[20:21], v[96:97] op_sel_hi:[1,0,1]
v_pk_fma_f32 v[98:99], v[50:51], v[20:21], v[98:99] op_sel_hi:[1,0,1]
v_pk_fma_f32 v[112:113], v[64:65], v[20:21], v[112:113] op_sel_hi:[1,0,1]
v_pk_fma_f32 v[114:115], v[66:67], v[20:21], v[114:115] op_sel_hi:[1,0,1]
v_pk_fma_f32 v[128:129], v[80:81], v[20:21], v[128:129] op_sel_hi:[1,0,1]
v_pk_fma_f32 v[130:131], v[82:83], v[20:21], v[130:131] op_sel_hi:[1,0,1]
v_pk_fma_f32 v[144:145], v[4:5], v[20:21], v[144:145] op_sel_hi:[1,0,1]
v_pk_fma_f32 v[146:147], v[6:7], v[20:21], v[146:147] op_sel_hi:[1,0,1]
v_pk_mul_f32 v[128:129], v[128:129], v[96:97]
v_pk_mul_f32 v[96:97], v[96:97], v[28:29] op_sel_hi:[1,0]
v_pk_mul_f32 v[130:131], v[130:131], v[98:99]
v_pk_mul_f32 v[98:99], v[98:99], v[28:29] op_sel_hi:[1,0]
v_pk_mul_f32 v[144:145], v[144:145], v[112:113]
v_pk_mul_f32 v[112:113], v[112:113], v[28:29] op_sel_hi:[1,0]
v_pk_mul_f32 v[146:147], v[146:147], v[114:115]
v_pk_mul_f32 v[114:115], v[114:115], v[28:29] op_sel_hi:[1,0]
v_pk_fma_f32 v[44:45], v[44:45], v[26:27], v[26:27] op_sel:[0,1,1] op_sel_hi:[1,1,1]
v_pk_fma_f32 v[46:47], v[46:47], v[26:27], v[26:27] op_sel:[0,1,1] op_sel_hi:[1,1,1]
v_pk_fma_f32 v[60:61], v[60:61], v[26:27], v[26:27] op_sel:[0,1,1] op_sel_hi:[1,1,1]
v_pk_fma_f32 v[62:63], v[62:63], v[26:27], v[26:27] op_sel:[0,1,1] op_sel_hi:[1,1,1]
v_cvt_pk_bf16_f32 v40, v72, v73
v_cvt_pk_bf16_f32 v41, v74, v75
v_cvt_pk_bf16_f32 v42, v88, v89
v_cvt_pk_bf16_f32 v43, v90, v91
MAA 132,192,132
buffer_store_dwordx4 v[40:43], v11, s[16:19], s62 offen sc1
MAA 132,196,148
TR 106,17,51232
v_rcp_f32 v44, v44
MAA 132,0,164
TR 108,17,59168
v_rcp_f32 v45, v45
MAA 132,4,180
TR 110,17,59680
v_rcp_f32 v46, v46
MAA 148,12,180
v_rcp_f32 v47, v47
MAA 148,8,164
v_rcp_f32 v60, v60
MAA 148,204,148
v_rcp_f32 v61, v61
MAA 148,200,132
v_rcp_f32 v62, v62
MAA 100,112,164
v_rcp_f32 v63, v63
MAA 100,116,180
v_exp_f32 v96, v96
MAA 116,124,180
v_exp_f32 v97, v97
MAA 116,120,164
s_waitcnt lgkmcnt(0)
s_barrier
s_add_u32 m0, s59, 84480
v_exp_f32 v98, v98
v_exp_f32 v99, v99
v_exp_f32 v112, v112
v_exp_f32 v113, v113
v_exp_f32 v114, v114
v_exp_f32 v115, v115
v_pk_mul_f32 v[76:77], v[76:77], v[44:45]
v_pk_mul_f32 v[78:79], v[78:79], v[46:47]
v_pk_mul_f32 v[92:93], v[92:93], v[60:61]
v_pk_mul_f32 v[94:95], v[94:95], v[62:63]
v_pk_fma_f32 v[100:101], v[48:49], v[22:23], v[100:101] op_sel_hi:[1,0,1]
v_pk_fma_f32 v[102:103], v[50:51], v[22:23], v[102:103] op_sel_hi:[1,0,1]
v_pk_fma_f32 v[116:117], v[64:65], v[22:23], v[116:117] op_sel_hi:[1,0,1]
v_pk_fma_f32 v[118:119], v[66:67], v[22:23], v[118:119] op_sel_hi:[1,0,1]
v_pk_fma_f32 v[132:133], v[80:81], v[22:23], v[132:133] op_sel_hi:[1,0,1]
v_pk_fma_f32 v[134:135], v[82:83], v[22:23], v[134:135] op_sel_hi:[1,0,1]
v_pk_fma_f32 v[148:149], v[4:5], v[22:23], v[148:149] op_sel_hi:[1,0,1]
v_pk_fma_f32 v[150:151], v[6:7], v[22:23], v[150:151] op_sel_hi:[1,0,1]
v_pk_mul_f32 v[132:133], v[132:133], v[100:101]
v_pk_mul_f32 v[100:101], v[100:101], v[28:29] op_sel:[0,1] op_sel_hi:[1,1]
v_pk_mul_f32 v[134:135], v[134:135], v[102:103]
v_pk_mul_f32 v[102:103], v[102:103], v[28:29] op_sel:[0,1] op_sel_hi:[1,1]
v_pk_mul_f32 v[148:149], v[148:149], v[116:117]
v_pk_mul_f32 v[116:117], v[116:117], v[28:29] op_sel:[0,1] op_sel_hi:[1,1]
v_pk_mul_f32 v[150:151], v[150:151], v[118:119]
v_pk_mul_f32 v[118:119], v[118:119], v[28:29] op_sel:[0,1] op_sel_hi:[1,1]
v_pk_fma_f32 v[96:97], v[96:97], v[20:21], v[20:21] op_sel:[0,1,1] op_sel_hi:[1,1,1]
v_pk_fma_f32 v[98:99], v[98:99], v[20:21], v[20:21] op_sel:[0,1,1] op_sel_hi:[1,1,1]
v_pk_fma_f32 v[112:113], v[112:113], v[20:21], v[20:21] op_sel:[0,1,1] op_sel_hi:[1,1,1]
v_pk_fma_f32 v[114:115], v[114:115], v[20:21], v[20:21] op_sel:[0,1,1] op_sel_hi:[1,1,1]
v_cvt_pk_bf16_f32 v44, v76, v77
v_cvt_pk_bf16_f32 v45, v78, v79
v_cvt_pk_bf16_f32 v46, v92, v93
v_cvt_pk_bf16_f32 v47, v94, v95
MAA 136,192,136
buffer_store_dwordx4 v[44:47], v11, s[16:19], s62 offen offset:1024 sc1
MAA 136,196,152
v_rcp_f32 v96, v96
MAA 136,0,168
v_rcp_f32 v97, v97
MAA 136,4,184
v_rcp_f32 v98, v98
MAA 152,12,184
buffer_load_dwordx4 v18, s[28:31], s58 offen lds
MAA 152,8,168
v_rcp_f32 v99, v99
MAA 152,204,152
v_rcp_f32 v112, v112
MAA 152,200,136
v_rcp_f32 v113, v113
MAA 104,112,168
buffer_load_dwordx4 v19, s[28:31], s58 offen offset:1056 lds
MAA 104,116,184
s_add_u32 m0, s59, 92928
s_add_u32 s58, s99, 2555904
v_rcp_f32 v114, v114
MAA 120,124,184
v_rcp_f32 v115, v115
MAA 120,120,168
v_exp_f32 v100, v100
v_exp_f32 v101, v101
v_exp_f32 v102, v102
v_exp_f32 v103, v103
v_exp_f32 v116, v116
v_exp_f32 v117, v117
v_exp_f32 v118, v118
v_exp_f32 v119, v119
v_pk_mul_f32 v[128:129], v[128:129], v[96:97]
v_pk_mul_f32 v[130:131], v[130:131], v[98:99]
v_pk_mul_f32 v[144:145], v[144:145], v[112:113]
v_pk_mul_f32 v[146:147], v[146:147], v[114:115]
ds_read_b128 v[112:115], v9 offset:256
v_pk_fma_f32 v[104:105], v[48:49], v[24:25], v[104:105] op_sel_hi:[1,0,1]
v_pk_fma_f32 v[106:107], v[50:51], v[24:25], v[106:107] op_sel_hi:[1,0,1]
v_pk_fma_f32 v[120:121], v[64:65], v[24:25], v[120:121] op_sel_hi:[1,0,1]
v_pk_fma_f32 v[122:123], v[66:67], v[24:25], v[122:123] op_sel_hi:[1,0,1]
v_pk_fma_f32 v[136:137], v[80:81], v[24:25], v[136:137] op_sel_hi:[1,0,1]
v_pk_fma_f32 v[138:139], v[82:83], v[24:25], v[138:139] op_sel_hi:[1,0,1]
v_pk_fma_f32 v[152:153], v[4:5], v[24:25], v[152:153] op_sel_hi:[1,0,1]
v_pk_fma_f32 v[154:155], v[6:7], v[24:25], v[154:155] op_sel_hi:[1,0,1]
v_pk_mul_f32 v[136:137], v[136:137], v[104:105]
v_pk_mul_f32 v[104:105], v[104:105], v[30:31] op_sel_hi:[1,0]
v_pk_mul_f32 v[138:139], v[138:139], v[106:107]
v_pk_mul_f32 v[106:107], v[106:107], v[30:31] op_sel_hi:[1,0]
v_pk_mul_f32 v[152:153], v[152:153], v[120:121]
v_pk_mul_f32 v[120:121], v[120:121], v[30:31] op_sel_hi:[1,0]
v_pk_mul_f32 v[154:155], v[154:155], v[122:123]
v_pk_mul_f32 v[122:123], v[122:123], v[30:31] op_sel_hi:[1,0]
v_pk_fma_f32 v[100:101], v[100:101], v[22:23], v[22:23] op_sel:[0,1,1] op_sel_hi:[1,1,1]
v_pk_fma_f32 v[102:103], v[102:103], v[22:23], v[22:23] op_sel:[0,1,1] op_sel_hi:[1,1,1]
v_pk_fma_f32 v[116:117], v[116:117], v[22:23], v[22:23] op_sel:[0,1,1] op_sel_hi:[1,1,1]
v_pk_fma_f32 v[118:119], v[118:119], v[22:23], v[22:23] op_sel:[0,1,1] op_sel_hi:[1,1,1]
v_cvt_pk_bf16_f32 v96, v128, v129
v_cvt_pk_bf16_f32 v97, v130, v131
ds_read_b128 v[128:131], v9 offset:320
v_cvt_pk_bf16_f32 v98, v144, v145
v_cvt_pk_bf16_f32 v99, v146, v147
MAA 140,192,140
buffer_store_dwordx4 v[96:99], v10, s[16:19], s63 offen sc1
MAA 140,196,156
ds_read_b128 v[144:147], v9 offset:768
v_rcp_f32 v100, v100
MAA 140,0,172
v_rcp_f32 v101, v101
MAA 140,4,188
v_rcp_f32 v102, v102
MAA 156,12,188
buffer_load_dwordx4 v18, s[28:31], s58 offen lds
MAA 156,8,172
v_rcp_f32 v103, v103
MAA 156,204,156
v_rcp_f32 v116, v116
MAA 156,200,140
v_rcp_f32 v117, v117
MAA 108,112,172
buffer_load_dwordx4 v19, s[28:31], s58 offen offset:1056 lds
MAA 108,116,188
s_add_u32 m0, s59, 101376
s_add_u32 s58, s100, 2752512
v_rcp_f32 v118, v118
MAA 124,124,188
v_rcp_f32 v119, v119
MAA 124,120,172
v_exp_f32 v104, v104
v_exp_f32 v105, v105
v_exp_f32 v106, v106
v_exp_f32 v107, v107
v_exp_f32 v120, v120
v_exp_f32 v121, v121
v_exp_f32 v122, v122
v_exp_f32 v123, v123
v_pk_mul_f32 v[132:133], v[132:133], v[100:101]
v_pk_mul_f32 v[134:135], v[134:135], v[102:103]
v_pk_mul_f32 v[148:149], v[148:149], v[116:117]
v_pk_mul_f32 v[150:151], v[150:151], v[118:119]
v_pk_fma_f32 v[108:109], v[48:49], v[26:27], v[108:109] op_sel_hi:[1,0,1]
v_pk_fma_f32 v[110:111], v[50:51], v[26:27], v[110:111] op_sel_hi:[1,0,1]
v_pk_fma_f32 v[124:125], v[64:65], v[26:27], v[124:125] op_sel_hi:[1,0,1]
v_pk_fma_f32 v[126:127], v[66:67], v[26:27], v[126:127] op_sel_hi:[1,0,1]
v_pk_fma_f32 v[140:141], v[80:81], v[26:27], v[140:141] op_sel_hi:[1,0,1]
v_pk_fma_f32 v[142:143], v[82:83], v[26:27], v[142:143] op_sel_hi:[1,0,1]
v_pk_fma_f32 v[156:157], v[4:5], v[26:27], v[156:157] op_sel_hi:[1,0,1]
v_pk_fma_f32 v[158:159], v[6:7], v[26:27], v[158:159] op_sel_hi:[1,0,1]
v_pk_mul_f32 v[140:141], v[140:141], v[108:109]
v_pk_mul_f32 v[108:109], v[108:109], v[30:31] op_sel:[0,1] op_sel_hi:[1,1]
v_pk_mul_f32 v[142:143], v[142:143], v[110:111]
v_pk_mul_f32 v[110:111], v[110:111], v[30:31] op_sel:[0,1] op_sel_hi:[1,1]
v_pk_mul_f32 v[156:157], v[156:157], v[124:125]
s_waitcnt vmcnt(5)
s_barrier
buffer_atomic_add v71, v68, s[16:19], s72 offen offset:512
v_pk_mul_f32 v[124:125], v[124:125], v[30:31] op_sel:[0,1] op_sel_hi:[1,1]
v_pk_mul_f32 v[158:159], v[158:159], v[126:127]
v_pk_mul_f32 v[126:127], v[126:127], v[30:31] op_sel:[0,1] op_sel_hi:[1,1]
v_pk_fma_f32 v[104:105], v[104:105], v[24:25], v[24:25] op_sel:[0,1,1] op_sel_hi:[1,1,1]
v_pk_fma_f32 v[106:107], v[106:107], v[24:25], v[24:25] op_sel:[0,1,1] op_sel_hi:[1,1,1]
v_pk_fma_f32 v[120:121], v[120:121], v[24:25], v[24:25] op_sel:[0,1,1] op_sel_hi:[1,1,1]
v_pk_fma_f32 v[122:123], v[122:123], v[24:25], v[24:25] op_sel:[0,1,1] op_sel_hi:[1,1,1]
v_cvt_pk_bf16_f32 v100, v132, v133
v_cvt_pk_bf16_f32 v101, v134, v135
v_cvt_pk_bf16_f32 v102, v148, v149
v_cvt_pk_bf16_f32 v103, v150, v151
MAA 192,16,128
v_rcp_f32 v104, v104
MAA 192,20,144
buffer_store_dwordx4 v[100:103], v10, s[16:19], s63 offen offset:1024 sc1
MAA 192,48,160
v_rcp_f32 v105, v105
MAA 192,52,176
v_rcp_f32 v106, v106
MAA 208,60,176
v_rcp_f32 v107, v107
MAA 208,56,160
buffer_load_dwordx4 v18, s[28:31], s58 offen lds
MAA 208,28,144
v_rcp_f32 v120, v120
MAA 208,24,128
v_rcp_f32 v121, v121
MAA 160,32,160
v_rcp_f32 v122, v122
MAA 160,36,176
buffer_load_dwordx4 v19, s[28:31], s58 offen offset:1056 lds
MAA 176,44,176
s_add_u32 m0, s59, 109824
s_add_u32 s58, s100, 3014656
v_rcp_f32 v123, v123
MAA 176,40,160
v_exp_f32 v108, v108
v_exp_f32 v109, v109
v_exp_f32 v110, v110
v_exp_f32 v111, v111
v_exp_f32 v124, v124
v_exp_f32 v125, v125
v_exp_f32 v126, v126
v_exp_f32 v127, v127
v_pk_mul_f32 v[136:137], v[136:137], v[104:105]
v_pk_mul_f32 v[138:139], v[138:139], v[106:107]
v_pk_mul_f32 v[152:153], v[152:153], v[120:121]
v_pk_mul_f32 v[154:155], v[154:155], v[122:123]
s_waitcnt lgkmcnt(2)
v_pk_fma_f32 v[160:161], v[112:113], v[20:21], v[160:161] op_sel_hi:[1,0,1]
v_pk_fma_f32 v[162:163], v[114:115], v[20:21], v[162:163] op_sel_hi:[1,0,1]
s_waitcnt lgkmcnt(1)
v_pk_fma_f32 v[176:177], v[128:129], v[20:21], v[176:177] op_sel_hi:[1,0,1]
v_pk_fma_f32 v[178:179], v[130:131], v[20:21], v[178:179] op_sel_hi:[1,0,1]
s_waitcnt lgkmcnt(0)
v_pk_fma_f32 v[192:193], v[144:145], v[20:21], v[192:193] op_sel_hi:[1,0,1]
v_pk_fma_f32 v[194:195], v[146:147], v[20:21], v[194:195] op_sel_hi:[1,0,1]
v_pk_fma_f32 v[208:209], v[12:13], v[20:21], v[208:209] op_sel_hi:[1,0,1]
v_pk_fma_f32 v[210:211], v[14:15], v[20:21], v[210:211] op_sel_hi:[1,0,1]
v_pk_mul_f32 v[192:193], v[192:193], v[160:161]
v_pk_mul_f32 v[160:161], v[160:161], v[28:29] op_sel_hi:[1,0]
v_pk_mul_f32 v[194:195], v[194:195], v[162:163]
v_pk_mul_f32 v[162:163], v[162:163], v[28:29] op_sel_hi:[1,0]
v_pk_mul_f32 v[208:209], v[208:209], v[176:177]
v_pk_mul_f32 v[176:177], v[176:177], v[28:29] op_sel_hi:[1,0]
v_pk_mul_f32 v[210:211], v[210:211], v[178:179]
v_pk_mul_f32 v[178:179], v[178:179], v[28:29] op_sel_hi:[1,0]
v_pk_fma_f32 v[108:109], v[108:109], v[26:27], v[26:27] op_sel:[0,1,1] op_sel_hi:[1,1,1]
v_pk_fma_f32 v[110:111], v[110:111], v[26:27], v[26:27] op_sel:[0,1,1] op_sel_hi:[1,1,1]
v_pk_fma_f32 v[124:125], v[124:125], v[26:27], v[26:27] op_sel:[0,1,1] op_sel_hi:[1,1,1]
v_pk_fma_f32 v[126:127], v[126:127], v[26:27], v[26:27] op_sel:[0,1,1] op_sel_hi:[1,1,1]
v_cvt_pk_bf16_f32 v104, v136, v137
v_cvt_pk_bf16_f32 v105, v138, v139
v_cvt_pk_bf16_f32 v106, v152, v153
v_cvt_pk_bf16_f32 v107, v154, v155
MAA 196,16,132
buffer_store_dwordx4 v[104:107], v11, s[16:19], s63 offen sc1
MAA 196,20,148
v_rcp_f32 v108, v108
MAA 196,48,164
v_rcp_f32 v109, v109
MAA 196,52,180
v_rcp_f32 v110, v110
MAA 212,60,180
buffer_load_dwordx4 v18, s[28:31], s58 offen lds
MAA 212,56,164
v_rcp_f32 v111, v111
MAA 212,28,148
v_rcp_f32 v124, v124
MAA 212,24,132
v_rcp_f32 v125, v125
MAA 164,32,164
buffer_load_dwordx4 v19, s[28:31], s58 offen offset:1056 lds
MAA 164,36,180
s_add_u32 m0, s59, 118272
s_add_u32 s58, s101, 3211264
v_rcp_f32 v126, v126
MAA 180,44,180
v_rcp_f32 v127, v127
MAA 180,40,164
v_lshl_add_u32 v4, v1, 4, s74
v_add_u32 v2, 67108480, v4
v_cndmask_b32 v4, v4, v2, vcc
s_and_b32 s74, s7, 1
v_bfe_u32 v7, v1, 2, 3
v_mul_u32_u24 v7, 1056, v7
v_bfe_u32 v2, v1, 5, 1
v_lshl_add_u32 v7, v2, 8, v7
v_and_b32 v2, 3, v1
v_lshl_add_u32 v7, v2, 3, v7
s_lshl_b32 s74, s74, 7
s_xor_b32 s75, s74, 128
v_add_u32 v6, s75, v7
v_add_u32 v7, s74, v7
v_exp_f32 v160, v160
v_exp_f32 v161, v161
v_exp_f32 v162, v162
v_exp_f32 v163, v163
v_exp_f32 v176, v176
v_exp_f32 v177, v177
v_exp_f32 v178, v178
v_exp_f32 v179, v179
v_pk_mul_f32 v[140:141], v[140:141], v[108:109]
v_pk_mul_f32 v[142:143], v[142:143], v[110:111]
v_pk_mul_f32 v[156:157], v[156:157], v[124:125]
v_pk_mul_f32 v[158:159], v[158:159], v[126:127]
v_pk_fma_f32 v[164:165], v[112:113], v[22:23], v[164:165] op_sel_hi:[1,0,1]
v_pk_fma_f32 v[166:167], v[114:115], v[22:23], v[166:167] op_sel_hi:[1,0,1]
v_pk_fma_f32 v[180:181], v[128:129], v[22:23], v[180:181] op_sel_hi:[1,0,1]
v_pk_fma_f32 v[182:183], v[130:131], v[22:23], v[182:183] op_sel_hi:[1,0,1]
v_pk_fma_f32 v[196:197], v[144:145], v[22:23], v[196:197] op_sel_hi:[1,0,1]
v_pk_fma_f32 v[198:199], v[146:147], v[22:23], v[198:199] op_sel_hi:[1,0,1]
v_pk_fma_f32 v[212:213], v[12:13], v[22:23], v[212:213] op_sel_hi:[1,0,1]
v_pk_fma_f32 v[214:215], v[14:15], v[22:23], v[214:215] op_sel_hi:[1,0,1]
v_pk_mul_f32 v[196:197], v[196:197], v[164:165]
v_pk_mul_f32 v[164:165], v[164:165], v[28:29] op_sel:[0,1] op_sel_hi:[1,1]
v_pk_mul_f32 v[198:199], v[198:199], v[166:167]
v_pk_mul_f32 v[166:167], v[166:167], v[28:29] op_sel:[0,1] op_sel_hi:[1,1]
v_pk_mul_f32 v[212:213], v[212:213], v[180:181]
v_pk_mul_f32 v[180:181], v[180:181], v[28:29] op_sel:[0,1] op_sel_hi:[1,1]
v_pk_mul_f32 v[214:215], v[214:215], v[182:183]
v_pk_mul_f32 v[182:183], v[182:183], v[28:29] op_sel:[0,1] op_sel_hi:[1,1]
v_pk_fma_f32 v[160:161], v[160:161], v[20:21], v[20:21] op_sel:[0,1,1] op_sel_hi:[1,1,1]
v_pk_fma_f32 v[162:163], v[162:163], v[20:21], v[20:21] op_sel:[0,1,1] op_sel_hi:[1,1,1]
v_pk_fma_f32 v[176:177], v[176:177], v[20:21], v[20:21] op_sel:[0,1,1] op_sel_hi:[1,1,1]
v_pk_fma_f32 v[178:179], v[178:179], v[20:21], v[20:21] op_sel:[0,1,1] op_sel_hi:[1,1,1]
v_cvt_pk_bf16_f32 v108, v140, v141
v_cvt_pk_bf16_f32 v109, v142, v143
v_cvt_pk_bf16_f32 v110, v156, v157
v_cvt_pk_bf16_f32 v111, v158, v159
MAA 200,16,136
buffer_store_dwordx4 v[108:111], v11, s[16:19], s63 offen offset:1024 sc1
MAA 200,20,152
v_rcp_f32 v160, v160
MAA 200,48,168
v_rcp_f32 v161, v161
MAA 200,52,184
v_rcp_f32 v162, v162
MAA 216,60,184
buffer_load_dwordx4 v18, s[28:31], s58 offen lds
MAA 216,56,168
v_rcp_f32 v163, v163
MAA 216,28,152
v_rcp_f32 v176, v176
MAA 216,24,136
v_rcp_f32 v177, v177
MAA 168,32,168
buffer_load_dwordx4 v19, s[28:31], s58 offen offset:1056 lds
MAA 168,36,184
s_add_u32 m0, s59, 126720
s_add_u32 s58, s101, 3473408
v_rcp_f32 v178, v178
MAA 184,44,184
v_rcp_f32 v179, v179
MAA 184,40,168
v_exp_f32 v164, v164
v_exp_f32 v165, v165
v_exp_f32 v166, v166
v_exp_f32 v167, v167
v_exp_f32 v180, v180
v_exp_f32 v181, v181
v_exp_f32 v182, v182
v_exp_f32 v183, v183
v_pk_mul_f32 v[192:193], v[192:193], v[160:161]
v_pk_mul_f32 v[194:195], v[194:195], v[162:163]
v_pk_mul_f32 v[208:209], v[208:209], v[176:177]
v_pk_mul_f32 v[210:211], v[210:211], v[178:179]
ds_read_b128 v[176:179], v8
v_pk_fma_f32 v[168:169], v[112:113], v[24:25], v[168:169] op_sel_hi:[1,0,1]
v_pk_fma_f32 v[170:171], v[114:115], v[24:25], v[170:171] op_sel_hi:[1,0,1]
v_pk_fma_f32 v[184:185], v[128:129], v[24:25], v[184:185] op_sel_hi:[1,0,1]
v_pk_fma_f32 v[186:187], v[130:131], v[24:25], v[186:187] op_sel_hi:[1,0,1]
v_pk_fma_f32 v[200:201], v[144:145], v[24:25], v[200:201] op_sel_hi:[1,0,1]
v_pk_fma_f32 v[202:203], v[146:147], v[24:25], v[202:203] op_sel_hi:[1,0,1]
v_pk_fma_f32 v[216:217], v[12:13], v[24:25], v[216:217] op_sel_hi:[1,0,1]
v_pk_fma_f32 v[218:219], v[14:15], v[24:25], v[218:219] op_sel_hi:[1,0,1]
v_pk_mul_f32 v[200:201], v[200:201], v[168:169]
v_pk_mul_f32 v[168:169], v[168:169], v[30:31] op_sel_hi:[1,0]
v_pk_mul_f32 v[202:203], v[202:203], v[170:171]
v_pk_mul_f32 v[170:171], v[170:171], v[30:31] op_sel_hi:[1,0]
v_pk_mul_f32 v[216:217], v[216:217], v[184:185]
v_pk_mul_f32 v[184:185], v[184:185], v[30:31] op_sel_hi:[1,0]
v_pk_mul_f32 v[218:219], v[218:219], v[186:187]
v_pk_mul_f32 v[186:187], v[186:187], v[30:31] op_sel_hi:[1,0]
v_pk_fma_f32 v[164:165], v[164:165], v[22:23], v[22:23] op_sel:[0,1,1] op_sel_hi:[1,1,1]
v_pk_fma_f32 v[166:167], v[166:167], v[22:23], v[22:23] op_sel:[0,1,1] op_sel_hi:[1,1,1]
v_pk_fma_f32 v[180:181], v[180:181], v[22:23], v[22:23] op_sel:[0,1,1] op_sel_hi:[1,1,1]
v_pk_fma_f32 v[182:183], v[182:183], v[22:23], v[22:23] op_sel:[0,1,1] op_sel_hi:[1,1,1]
v_cvt_pk_bf16_f32 v160, v192, v193
v_cvt_pk_bf16_f32 v161, v194, v195
ds_read_b128 v[192:195], v8 offset:64
v_cvt_pk_bf16_f32 v162, v208, v209
v_cvt_pk_bf16_f32 v163, v210, v211
MAA 204,16,140
buffer_store_dwordx4 v[160:163], v10, s[16:19], s64 offen sc1
MAA 204,20,156
ds_read_b128 v[208:211], v8 offset:512
v_rcp_f32 v164, v164
MAA 204,48,172
v_rcp_f32 v165, v165
MAA 204,52,188
v_rcp_f32 v166, v166
MAA 220,60,188
buffer_atomic_add v84, v69, s[16:19], s73 offen offset:512 sc0
MAA 220,56,172
v_rcp_f32 v167, v167
MAA 220,28,156
v_rcp_f32 v180, v180
MAA 220,24,140
v_rcp_f32 v181, v181
MAA 172,32,172
buffer_load_dwordx4 v18, s[28:31], s58 offen lds
MAA 172,36,188
v_rcp_f32 v182, v182
MAA 188,44,188
v_rcp_f32 v183, v183
MAA 188,40,172
v_exp_f32 v168, v168
v_exp_f32 v169, v169
v_exp_f32 v170, v170
v_exp_f32 v171, v171
v_exp_f32 v184, v184
v_exp_f32 v185, v185
v_exp_f32 v186, v186
v_exp_f32 v187, v187
v_pk_mul_f32 v[196:197], v[196:197], v[164:165]
v_pk_mul_f32 v[198:199], v[198:199], v[166:167]
v_pk_mul_f32 v[212:213], v[212:213], v[180:181]
v_pk_mul_f32 v[214:215], v[214:215], v[182:183]
v_pk_fma_f32 v[172:173], v[112:113], v[26:27], v[172:173] op_sel_hi:[1,0,1]
v_pk_fma_f32 v[174:175], v[114:115], v[26:27], v[174:175] op_sel_hi:[1,0,1]
v_pk_fma_f32 v[188:189], v[128:129], v[26:27], v[188:189] op_sel_hi:[1,0,1]
v_pk_fma_f32 v[190:191], v[130:131], v[26:27], v[190:191] op_sel_hi:[1,0,1]
v_pk_fma_f32 v[204:205], v[144:145], v[26:27], v[204:205] op_sel_hi:[1,0,1]
v_pk_fma_f32 v[206:207], v[146:147], v[26:27], v[206:207] op_sel_hi:[1,0,1]
v_pk_fma_f32 v[220:221], v[12:13], v[26:27], v[220:221] op_sel_hi:[1,0,1]
v_pk_fma_f32 v[222:223], v[14:15], v[26:27], v[222:223] op_sel_hi:[1,0,1]
v_pk_mul_f32 v[204:205], v[204:205], v[172:173]
v_pk_mul_f32 v[172:173], v[172:173], v[30:31] op_sel:[0,1] op_sel_hi:[1,1]
v_pk_mul_f32 v[206:207], v[206:207], v[174:175]
v_pk_mul_f32 v[174:175], v[174:175], v[30:31] op_sel:[0,1] op_sel_hi:[1,1]
v_pk_mul_f32 v[220:221], v[220:221], v[188:189]
v_pk_mul_f32 v[188:189], v[188:189], v[30:31] op_sel:[0,1] op_sel_hi:[1,1]
v_pk_mul_f32 v[222:223], v[222:223], v[190:191]
v_pk_mul_f32 v[190:191], v[190:191], v[30:31] op_sel:[0,1] op_sel_hi:[1,1]
v_pk_fma_f32 v[168:169], v[168:169], v[24:25], v[24:25] op_sel:[0,1,1] op_sel_hi:[1,1,1]
v_pk_fma_f32 v[170:171], v[170:171], v[24:25], v[24:25] op_sel:[0,1,1] op_sel_hi:[1,1,1]
v_pk_fma_f32 v[184:185], v[184:185], v[24:25], v[24:25] op_sel:[0,1,1] op_sel_hi:[1,1,1]
v_pk_fma_f32 v[186:187], v[186:187], v[24:25], v[24:25] op_sel:[0,1,1] op_sel_hi:[1,1,1]
v_cvt_pk_bf16_f32 v164, v196, v197
v_cvt_pk_bf16_f32 v165, v198, v199
v_cvt_pk_bf16_f32 v166, v212, v213
v_cvt_pk_bf16_f32 v167, v214, v215
MAA 240,64,128
buffer_store_dwordx4 v[164:167], v10, s[16:19], s64 offen offset:1024 sc1
MAA 240,68,144
v_rcp_f32 v168, v168
MAA 240,96,160
v_rcp_f32 v169, v169
MAA 240,100,176
v_rcp_f32 v170, v170
MAA 248,108,176
buffer_atomic_add v85, v69, s[16:19], s73 offen offset:512 sc0
MAA 248,104,160
v_rcp_f32 v171, v171
MAA 248,76,144
v_rcp_f32 v184, v184
MAA 248,72,128
v_rcp_f32 v185, v185
MAA 224,80,160
buffer_load_dwordx4 v19, s[28:31], s58 offen offset:1056 lds
MAA 224,84,176
v_rcp_f32 v186, v186
MAA 232,92,176
v_rcp_f32 v187, v187
MAA 232,88,160
v_exp_f32 v172, v172
v_exp_f32 v173, v173
v_exp_f32 v174, v174
v_exp_f32 v175, v175
v_exp_f32 v188, v188
v_exp_f32 v189, v189
v_exp_f32 v190, v190
v_exp_f32 v191, v191
v_pk_mul_f32 v[200:201], v[200:201], v[168:169]
v_pk_mul_f32 v[202:203], v[202:203], v[170:171]
v_pk_mul_f32 v[216:217], v[216:217], v[184:185]
v_pk_mul_f32 v[218:219], v[218:219], v[186:187]
.Lpad17:
s_cbranch_execz .Lpad20
s_waitcnt lgkmcnt(2)
v_pk_fma_f32 v[224:225], v[176:177], v[20:21], v[224:225] op_sel_hi:[1,0,1]
v_pk_fma_f32 v[226:227], v[178:179], v[20:21], v[226:227] op_sel_hi:[1,0,1]
s_waitcnt lgkmcnt(1)
v_pk_fma_f32 v[232:233], v[192:193], v[20:21], v[232:233] op_sel_hi:[1,0,1]
v_pk_fma_f32 v[234:235], v[194:195], v[20:21], v[234:235] op_sel_hi:[1,0,1]
s_waitcnt lgkmcnt(0)
v_pk_fma_f32 v[240:241], v[208:209], v[20:21], v[240:241] op_sel_hi:[1,0,1]
v_pk_fma_f32 v[242:243], v[210:211], v[20:21], v[242:243] op_sel_hi:[1,0,1]
v_pk_fma_f32 v[248:249], v[52:53], v[20:21], v[248:249] op_sel_hi:[1,0,1]
v_pk_fma_f32 v[250:251], v[54:55], v[20:21], v[250:251] op_sel_hi:[1,0,1]
v_pk_mul_f32 v[240:241], v[240:241], v[224:225]
v_pk_mul_f32 v[224:225], v[224:225], v[28:29] op_sel_hi:[1,0]
v_pk_mul_f32 v[242:243], v[242:243], v[226:227]
v_pk_mul_f32 v[226:227], v[226:227], v[28:29] op_sel_hi:[1,0]
v_pk_mul_f32 v[248:249], v[248:249], v[232:233]
v_pk_mul_f32 v[232:233], v[232:233], v[28:29] op_sel_hi:[1,0]
v_pk_mul_f32 v[250:251], v[250:251], v[234:235]
v_pk_mul_f32 v[234:235], v[234:235], v[28:29] op_sel_hi:[1,0]
v_pk_fma_f32 v[172:173], v[172:173], v[26:27], v[26:27] op_sel:[0,1,1] op_sel_hi:[1,1,1]
v_pk_fma_f32 v[174:175], v[174:175], v[26:27], v[26:27] op_sel:[0,1,1] op_sel_hi:[1,1,1]
v_pk_fma_f32 v[188:189], v[188:189], v[26:27], v[26:27] op_sel:[0,1,1] op_sel_hi:[1,1,1]
v_pk_fma_f32 v[190:191], v[190:191], v[26:27], v[26:27] op_sel:[0,1,1] op_sel_hi:[1,1,1]
v_cvt_pk_bf16_f32 v168, v200, v201
v_cvt_pk_bf16_f32 v169, v202, v203
v_cvt_pk_bf16_f32 v170, v216, v217
v_cvt_pk_bf16_f32 v171, v218, v219
buffer_store_dwordx4 v[168:171], v11, s[16:19], s64 offen sc1
buffer_atomic_add v86, v69, s[16:19], s73 offen offset:512 sc0
s_waitcnt vmcnt(6)
v_cmp_gt_u32 vcc, v70, v84
s_nop 0
s_cbranch_vccz .Lok49
s_waitcnt vmcnt(3)
v_cmp_gt_u32 vcc, v70, v85
s_nop 0
s_cbranch_vccz .Lok49
s_waitcnt vmcnt(0)
v_cmp_gt_u32 vcc, v70, v86
s_nop 0
s_cbranch_vccz .Lok49
s_mov_b32 s15, 0
.Lok49l:
v_mov_b32 v84, 0
buffer_atomic_add v84, v69, s[16:19], s73 offen offset:512 sc0
s_add_u32 s15, s15, 1
s_cmp_gt_u32 s15, 100000
s_waitcnt vmcnt(0)
s_cbranch_scc1 .Lok49
v_cmp_gt_u32 vcc, v70, v84
s_nop 0
s_cbranch_vccnz .Lok49l
.Lok49:
s_waitcnt vmcnt(2)
s_barrier
MAA 244,64,132
ds_read_b64_tr_b16 a[0:1], v7
s_add_u32 s52, s76, 0
MAA 244,68,148
buffer_load_dwordx4 v[96:99], v4, s[16:19], s52 offen sc1
MAA 244,96,164
TR 2,7,512
v_rcp_f32 v172, v172
MAA 244,100,180
TR 4,7,32
v_rcp_f32 v173, v173
MAA 252,108,180
TR 6,7,544
v_rcp_f32 v174, v174
MAA 252,104,164
buffer_load_dwordx4 v[100:103], v4, s[16:19], s52 offen offset:1024 sc1
MAA 252,76,148
TR 8,7,64
s_add_u32 s52, s76, 65536
MAA 252,72,132
TR 10,7,576
v_rcp_f32 v175, v175
MAA 228,80,164
TR 12,7,96
v_rcp_f32 v188, v188
MAA 228,84,180
buffer_load_dwordx4 v[104:107], v4, s[16:19], s52 offen sc1
MAA 236,92,180
TR 14,7,608
v_rcp_f32 v189, v189
MAA 236,88,164
TR 16,7,8448
v_rcp_f32 v190, v190
v_rcp_f32 v191, v191
v_exp_f32 v224, v224
v_exp_f32 v225, v225
v_exp_f32 v226, v226
v_exp_f32 v227, v227
v_exp_f32 v232, v232
v_exp_f32 v233, v233
v_exp_f32 v234, v234
v_exp_f32 v235, v235
v_pk_mul_f32 v[204:205], v[204:205], v[172:173]
buffer_load_dwordx4 v[108:111], v4, s[16:19], s52 offen offset:1024 sc1
s_add_u32 s52, s77, 114688
v_pk_mul_f32 v[206:207], v[206:207], v[174:175]
v_pk_mul_f32 v[220:221], v[220:221], v[188:189]
v_pk_mul_f32 v[222:223], v[222:223], v[190:191]
v_pk_fma_f32 v[228:229], v[176:177], v[22:23], v[228:229] op_sel_hi:[1,0,1]
v_pk_fma_f32 v[230:231], v[178:179], v[22:23], v[230:231] op_sel_hi:[1,0,1]
v_pk_fma_f32 v[236:237], v[192:193], v[22:23], v[236:237] op_sel_hi:[1,0,1]
v_pk_fma_f32 v[238:239], v[194:195], v[22:23], v[238:239] op_sel_hi:[1,0,1]
v_pk_fma_f32 v[244:245], v[208:209], v[22:23], v[244:245] op_sel_hi:[1,0,1]
v_pk_fma_f32 v[246:247], v[210:211], v[22:23], v[246:247] op_sel_hi:[1,0,1]
v_pk_fma_f32 v[252:253], v[52:53], v[22:23], v[252:253] op_sel_hi:[1,0,1]
v_pk_fma_f32 v[254:255], v[54:55], v[22:23], v[254:255] op_sel_hi:[1,0,1]
v_pk_mul_f32 v[244:245], v[244:245], v[228:229]
buffer_load_dwordx4 v[112:115], v4, s[16:19], s52 offen sc1
v_pk_mul_f32 v[228:229], v[228:229], v[28:29] op_sel:[0,1] op_sel_hi:[1,1]
v_pk_mul_f32 v[246:247], v[246:247], v[230:231]
v_pk_mul_f32 v[230:231], v[230:231], v[28:29] op_sel:[0,1] op_sel_hi:[1,1]
v_pk_mul_f32 v[252:253], v[252:253], v[236:237]
v_pk_mul_f32 v[236:237], v[236:237], v[28:29] op_sel:[0,1] op_sel_hi:[1,1]
v_pk_mul_f32 v[254:255], v[254:255], v[238:239]
v_pk_mul_f32 v[238:239], v[238:239], v[28:29] op_sel:[0,1] op_sel_hi:[1,1]
v_pk_fma_f32 v[224:225], v[224:225], v[20:21], v[20:21] op_sel:[0,1,1] op_sel_hi:[1,1,1]
v_pk_fma_f32 v[226:227], v[226:227], v[20:21], v[20:21] op_sel:[0,1,1] op_sel_hi:[1,1,1]
v_pk_fma_f32 v[232:233], v[232:233], v[20:21], v[20:21] op_sel:[0,1,1] op_sel_hi:[1,1,1]
v_pk_fma_f32 v[234:235], v[234:235], v[20:21], v[20:21] op_sel:[0,1,1] op_sel_hi:[1,1,1]
v_cvt_pk_bf16_f32 v172, v204, v205
v_cvt_pk_bf16_f32 v173, v206, v207
buffer_load_dwordx4 v[116:119], v4, s[16:19], s52 offen offset:1024 sc1
s_add_u32 s52, s77, 180224
v_cvt_pk_bf16_f32 v174, v220, v221
v_cvt_pk_bf16_f32 v175, v222, v223
TR 18,7,8960
TR 20,7,8480
TR 22,7,8992
TR 24,7,8512
TR 26,7,9024
buffer_store_dwordx4 v[172:175], v11, s[16:19], s64 offen offset:1024 sc1
TR 28,7,8544
TR 30,7,9056
v_rcp_f32 v224, v224
v_rcp_f32 v225, v225
v_rcp_f32 v226, v226
v_rcp_f32 v227, v227
v_rcp_f32 v232, v232
v_rcp_f32 v233, v233
v_rcp_f32 v234, v234
v_rcp_f32 v235, v235
v_exp_f32 v228, v228
v_exp_f32 v229, v229
v_exp_f32 v230, v230
v_exp_f32 v231, v231
v_exp_f32 v236, v236
v_exp_f32 v237, v237
v_exp_f32 v238, v238
v_exp_f32 v239, v239
v_pk_mul_f32 v[240:241], v[240:241], v[224:225]
buffer_load_dwordx4 v[120:123], v4, s[16:19], s52 offen sc1
v_pk_mul_f32 v[242:243], v[242:243], v[226:227]
v_pk_mul_f32 v[248:249], v[248:249], v[232:233]
v_pk_mul_f32 v[250:251], v[250:251], v[234:235]
v_pk_fma_f32 v[228:229], v[228:229], v[22:23], v[22:23] op_sel:[0,1,1] op_sel_hi:[1,1,1]
v_pk_fma_f32 v[230:231], v[230:231], v[22:23], v[22:23] op_sel:[0,1,1] op_sel_hi:[1,1,1]
v_pk_fma_f32 v[236:237], v[236:237], v[22:23], v[22:23] op_sel:[0,1,1] op_sel_hi:[1,1,1]
v_pk_fma_f32 v[238:239], v[238:239], v[22:23], v[22:23] op_sel:[0,1,1] op_sel_hi:[1,1,1]
v_cvt_pk_bf16_f32 v224, v240, v241
v_cvt_pk_bf16_f32 v225, v242, v243
v_cvt_pk_bf16_f32 v226, v248, v249
v_cvt_pk_bf16_f32 v227, v250, v251
v_rcp_f32 v228, v228
v_rcp_f32 v229, v229
v_rcp_f32 v230, v230
v_rcp_f32 v231, v231
v_rcp_f32 v236, v236
v_rcp_f32 v237, v237
v_rcp_f32 v238, v238
v_rcp_f32 v239, v239
v_pk_mul_f32 v[244:245], v[244:245], v[228:229]
buffer_store_dwordx4 v[224:227], v10, s[16:19], s65 offen sc1
v_pk_mul_f32 v[246:247], v[246:247], v[230:231]
v_pk_mul_f32 v[252:253], v[252:253], v[236:237]
v_pk_mul_f32 v[254:255], v[254:255], v[238:239]
v_cvt_pk_bf16_f32 v228, v244, v245
v_cvt_pk_bf16_f32 v229, v246, v247
v_cvt_pk_bf16_f32 v230, v252, v253
v_cvt_pk_bf16_f32 v231, v254, v255
buffer_store_dwordx4 v[228:231], v10, s[16:19], s65 offen offset:1024 sc1
buffer_load_dwordx4 v[124:127], v4, s[16:19], s52 offen offset:1024 sc1
v_mov_b32 v21, v68
v_mov_b32 v22, v69
v_mov_b32 v23, v70
v_mov_b32 v24, v71
v_mov_b32 v25, 0
s_waitcnt vmcnt(7) lgkmcnt(0)
s_barrier
v_mfma_f32_16x16x32_bf16 v[32:35], a[0:3], v[96:99], 0
ds_read_b64_tr_b16 a[32:33], v6
s_add_u32 s52, s78, 229376
MAV 32,16,104
buffer_load_dwordx4 v[128:131], v4, s[16:19], s52 offen sc1
v_mfma_f32_16x16x32_bf16 v[48:51], a[0:3], v[100:103], 0
TR 34,6,512
MAV 48,16,108
TR 36,6,32
TR 38,6,544
v_mfma_f32_16x16x32_bf16 v[52:55], a[4:7], v[100:103], 0
TR 48,6,8448
MAV 52,20,108
buffer_load_dwordx4 v[132:135], v4, s[16:19], s52 offen offset:1024 sc1
v_mfma_f32_16x16x32_bf16 v[36:39], a[4:7], v[96:99], 0
TR 50,6,8960
MAV 36,20,104
TR 52,6,8480
TR 54,6,8992
v_mfma_f32_16x16x32_bf16 v[40:43], a[8:11], v[96:99], 0
TR 40,6,64
s_add_u32 s52, s78, 294912
MAV 40,24,104
buffer_load_dwordx4 v[136:139], v4, s[16:19], s52 offen sc1
v_mfma_f32_16x16x32_bf16 v[56:59], a[8:11], v[100:103], 0
TR 42,6,576
MAV 56,24,108
TR 44,6,96
TR 46,6,608
v_mfma_f32_16x16x32_bf16 v[60:63], a[12:15], v[100:103], 0
TR 56,6,8512
MAV 60,28,108
buffer_load_dwordx4 v[140:143], v4, s[16:19], s52 offen offset:1024 sc1
v_mfma_f32_16x16x32_bf16 v[44:47], a[12:15], v[96:99], 0
TR 58,6,9024
MAV 44,28,104
TR 60,6,8544
TR 62,6,9056
s_waitcnt lgkmcnt(8)
v_mfma_f32_16x16x32_bf16 v[64:67], a[32:35], v[96:99], 0
TR 0,7,16896
s_add_u32 s52, s79, 344064
MAV 64,48,104
buffer_load_dwordx4 v[144:147], v4, s[16:19], s52 offen sc1
v_mfma_f32_16x16x32_bf16 v[80:83], a[32:35], v[100:103], 0
TR 2,7,17408
MAV 80,48,108
TR 4,7,16928
TR 6,7,17440
v_mfma_f32_16x16x32_bf16 v[84:87], a[36:39], v[100:103], 0
TR 16,7,25344
MAV 84,52,108
buffer_load_dwordx4 v[148:151], v4, s[16:19], s52 offen offset:1024 sc1
v_mfma_f32_16x16x32_bf16 v[68:71], a[36:39], v[96:99], 0
TR 18,7,25856
MAV 68,52,104
TR 20,7,25376
TR 22,7,25888
s_waitcnt lgkmcnt(8)
v_mfma_f32_16x16x32_bf16 v[72:75], a[40:43], v[96:99], 0
TR 8,7,16960
s_add_u32 s52, s79, 409600
MAV 72,56,104
buffer_load_dwordx4 v[152:155], v4, s[16:19], s52 offen sc1
v_mfma_f32_16x16x32_bf16 v[88:91], a[40:43], v[100:103], 0
TR 10,7,17472
MAV 88,56,108
TR 12,7,16992
TR 14,7,17504
v_mfma_f32_16x16x32_bf16 v[92:95], a[44:47], v[100:103], 0
TR 24,7,25408
MAV 92,60,108
buffer_load_dwordx4 v[156:159], v4, s[16:19], s52 offen offset:1024 sc1
v_mfma_f32_16x16x32_bf16 v[76:79], a[44:47], v[96:99], 0
TR 26,7,25920
MAV 76,60,104
TR 28,7,25440
TR 30,7,25952
s_waitcnt vmcnt(8) lgkmcnt(8)
s_barrier
MAV 32,0,112
TR 32,6,16896
s_add_u32 m0, s55, 0
MAV 32,16,120
buffer_load_dwordx4 v18, s[28:31], s54 offen lds
MAV 48,16,124
TR 34,6,17408
MAV 48,0,116
TR 36,6,16928
TR 38,6,17440
MAV 52,4,116
TR 48,6,25344
s_add_u32 s52, s76, 458752
MAV 52,20,124
buffer_load_dwordx4 v[96:99], v4, s[16:19], s52 offen sc1
MAV 36,20,120
TR 50,6,25856
MAV 36,4,112
TR 52,6,25376
TR 54,6,25888
s_waitcnt lgkmcnt(8)
MAV 40,8,112
TR 40,6,16960
MAV 40,24,120
buffer_load_dwordx4 v19, s[28:31], s54 offen offset:1056 lds
MAV 56,24,124
TR 42,6,17472
s_add_u32 s54, s98, 327680
MAV 56,8,116
TR 44,6,16992
TR 46,6,17504
MAV 60,12,116
TR 56,6,25408
MAV 60,28,124
buffer_load_dwordx4 v[100:103], v4, s[16:19], s52 offen offset:1024 sc1
MAV 44,28,120
TR 58,6,25920
MAV 44,12,112
TR 60,6,25440
TR 62,6,25952
s_waitcnt lgkmcnt(8)
MAV 64,32,112
TR 0,7,33792
s_add_u32 m0, s55, 8448
MAV 64,48,120
buffer_load_dwordx4 v18, s[28:31], s54 offen lds
MAV 80,48,124
TR 2,7,34304
MAV 80,32,116
TR 4,7,33824
TR 6,7,34336
MAV 84,36,116
TR 16,7,42240
s_add_u32 s52, s76, 524288
MAV 84,52,124
buffer_load_dwordx4 v[104:107], v4, s[16:19], s52 offen sc1
MAV 68,52,120
TR 18,7,42752
MAV 68,36,112
TR 20,7,42272
TR 22,7,42784
s_waitcnt lgkmcnt(8)
MAV 72,40,112
TR 8,7,33856
MAV 72,56,120
buffer_load_dwordx4 v19, s[28:31], s54 offen offset:1056 lds
MAV 88,56,124
TR 10,7,34368
s_add_u32 s54, s99, 524288
MAV 88,40,116
TR 12,7,33888
TR 14,7,34400
MAV 92,44,116
TR 24,7,42304
MAV 92,60,124
buffer_load_dwordx4 v[108:111], v4, s[16:19], s52 offen offset:1024 sc1
MAV 76,60,120
TR 26,7,42816
MAV 76,44,112
TR 28,7,42336
TR 30,7,42848
s_waitcnt vmcnt(12) lgkmcnt(8)
s_barrier
MAV 32,0,128
TR 32,6,33792
MAV 32,16,136
buffer_atomic_add v24, v21, s[16:19], s72 offen
MAV 48,16,140
TR 34,6,34304
MAV 48,0,132
TR 36,6,33824
TR 38,6,34336
TR 48,6,42240
MAV 52,4,132
TR 50,6,42752
s_add_u32 m0, s55, 16896
MAV 52,20,140
buffer_load_dwordx4 v18, s[28:31], s54 offen lds
MAV 36,20,136
TR 52,6,42272
MAV 36,4,128
TR 54,6,42784
TR 40,6,33856
s_waitcnt lgkmcnt(9)
MAV 40,8,128
TR 42,6,34368
s_add_u32 s52, s77, 573440
MAV 40,24,136
buffer_load_dwordx4 v[112:115], v4, s[16:19], s52 offen sc1
MAV 56,24,140
TR 44,6,33888
MAV 56,8,132
buffer_load_dwordx4 v19, s[28:31], s54 offen offset:1056 lds
MAV 60,12,132
TR 46,6,34400
s_add_u32 s54, s99, 786432
MAV 60,28,140
buffer_load_dwordx4 v[116:119], v4, s[16:19], s52 offen offset:1024 sc1
MAV 44,28,136
TR 56,6,42304
MAV 44,12,128
TR 58,6,42816
TR 60,6,42336
TR 62,6,42848
s_waitcnt lgkmcnt(8)
MAV 64,32,128
TR 0,7,50688
s_add_u32 m0, s55, 25344
MAV 64,48,136
buffer_load_dwordx4 v18, s[28:31], s54 offen lds
MAV 80,48,140
TR 2,7,51200
MAV 80,32,132
TR 4,7,50720
TR 6,7,51232
MAV 84,36,132
TR 16,7,59136
s_add_u32 s52, s77, 638976
MAV 84,52,140
buffer_load_dwordx4 v[120:123], v4, s[16:19], s52 offen sc1
MAV 68,52,136
TR 18,7,59648
MAV 68,36,128
TR 20,7,59168
TR 22,7,59680
s_waitcnt lgkmcnt(8)
MAV 72,40,128
TR 8,7,50752
MAV 72,56,136
buffer_load_dwordx4 v19, s[28:31], s54 offen offset:1056 lds
MAV 88,56,140
TR 10,7,51264
s_add_u32 s54, s100, 983040
MAV 88,40,132
TR 12,7,50784
TR 14,7,51296
MAV 92,44,132
TR 24,7,59200
MAV 92,60,140
buffer_load_dwordx4 v[124:127], v4, s[16:19], s52 offen offset:1024 sc1
MAV 76,60,136
TR 26,7,59712
MAV 76,44,128
TR 28,7,59232
TR 30,7,59744
s_waitcnt vmcnt(17) lgkmcnt(8)
s_barrier
MAV 32,0,144
TR 32,6,50688
s_add_u32 m0, s55, 33792
MAV 32,16,152
buffer_load_dwordx4 v18, s[28:31], s54 offen lds
MAV 48,16,156
TR 34,6,51200
MAV 48,0,148
TR 36,6,50720
TR 38,6,51232
MAV 52,4,148
TR 48,6,59136
s_add_u32 s52, s78, 688128
MAV 52,20,156
buffer_load_dwordx4 v[128:131], v4, s[16:19], s52 offen sc1
MAV 36,20,152
TR 50,6,59648
MAV 36,4,144
TR 52,6,59168
TR 54,6,59680
s_waitcnt lgkmcnt(8)
MAV 40,8,144
TR 40,6,50752
MAV 40,24,152
buffer_load_dwordx4 v19, s[28:31], s54 offen offset:1056 lds
MAV 56,24,156
TR 42,6,51264
s_add_u32 s54, s100, 1245184
MAV 56,8,148
TR 44,6,50784
TR 46,6,51296
MAV 60,12,148
TR 56,6,59200
MAV 60,28,156
buffer_load_dwordx4 v[132:135], v4, s[16:19], s52 offen offset:1024 sc1
MAV 44,28,152
TR 58,6,59712
MAV 44,12,144
TR 60,6,59232
TR 62,6,59744
v_add_u32 v7, s57, v7
v_add_u32 v6, s57, v6
s_sub_u32 s57, 0, s57
s_waitcnt lgkmcnt(8)
MAV 64,32,144
ds_read_b64_tr_b16 a[0:1], v7
s_add_u32 m0, s55, 42240
MAV 64,48,152
buffer_load_dwordx4 v18, s[28:31], s54 offen lds
MAV 80,48,156
TR 2,7,512
MAV 80,32,148
TR 4,7,32
TR 6,7,544
TR 16,7,8448
MAV 84,36,148
TR 18,7,8960
s_add_u32 s52, s78, 753664
MAV 84,52,156
buffer_load_dwordx4 v[136:139], v4, s[16:19], s52 offen sc1
MAV 68,52,152
TR 20,7,8480
MAV 68,36,144
TR 22,7,8992
TR 8,7,64
s_waitcnt lgkmcnt(9)
MAV 72,40,144
TR 10,7,576
MAV 72,56,152
buffer_load_dwordx4 v19, s[28:31], s54 offen offset:1056 lds
MAV 88,56,156
TR 12,7,96
s_add_u32 s54, s101, 1441792
MAV 88,40,148
buffer_load_dwordx4 v[140:143], v4, s[16:19], s52 offen offset:1024 sc1
MAV 92,44,148
TR 14,7,608
MAV 92,60,156
buffer_atomic_add v25, v22, s[16:19], s73 offen sc0
MAV 76,60,152
TR 24,7,8512
MAV 76,44,144
TR 26,7,9024
TR 28,7,8544
TR 30,7,9056
s_waitcnt vmcnt(18) lgkmcnt(8)
s_barrier
MAV 32,0,96
ds_read_b64_tr_b16 a[32:33], v6
s_add_u32 m0, s55, 50688
MAV 32,16,104
buffer_load_dwordx4 v18, s[28:31], s54 offen lds
MAV 48,16,108
TR 34,6,512
MAV 48,0,100
TR 36,6,32
TR 38,6,544
MAV 52,4,100
TR 48,6,8448
s_add_u32 s52, s79, 802816
MAV 52,20,108
buffer_load_dwordx4 v[144:147], v4, s[16:19], s52 offen sc1
MAV 36,20,104
TR 50,6,8960
MAV 36,4,96
TR 52,6,8480
TR 54,6,8992
s_waitcnt lgkmcnt(8)
MAV 40,8,96
TR 40,6,64
MAV 40,24,104
buffer_load_dwordx4 v19, s[28:31], s54 offen offset:1056 lds
MAV 56,24,108
TR 42,6,576
s_add_u32 s54, s101, 1703936
MAV 56,8,100
TR 44,6,96
TR 46,6,608
MAV 60,12,100
TR 56,6,8512
MAV 60,28,108
buffer_load_dwordx4 v[148:151], v4, s[16:19], s52 offen offset:1024 sc1
.Lpad18:
s_cbranch_execz .Lpad21
MAV 44,28,104
TR 58,6,9024
MAV 44,12,96
TR 60,6,8544
TR 62,6,9056
s_waitcnt lgkmcnt(8)
MAV 64,32,96
TR 0,7,16896
s_add_u32 m0, s55, 59136
MAV 64,48,104
buffer_load_dwordx4 v18, s[28:31], s54 offen lds
MAV 80,48,108
TR 2,7,17408
MAV 80,32,100
TR 4,7,16928
TR 6,7,17440
MAV 84,36,100
TR 16,7,25344
s_add_u32 s52, s79, 868352
MAV 84,52,108
buffer_load_dwordx4 v[152:155], v4, s[16:19], s52 offen sc1
MAV 68,52,104
TR 18,7,25856
MAV 68,36,96
TR 20,7,25376
TR 22,7,25888
s_waitcnt lgkmcnt(8)
MAV 72,40,96
TR 8,7,16960
MAV 72,56,104
buffer_load_dwordx4 v19, s[28:31], s54 offen offset:1056 lds
MAV 88,56,108
TR 10,7,17472
s_add_u32 s54, s98, 1900544
MAV 88,40,100
TR 12,7,16992
TR 14,7,17504
MAV 92,44,100
TR 24,7,25408
MAV 92,60,108
buffer_load_dwordx4 v[156:159], v4, s[16:19], s52 offen offset:1024 sc1
MAV 76,60,104
TR 26,7,25920
MAV 76,44,96
TR 28,7,25440
TR 30,7,25952
s_waitcnt vmcnt(8)
v_cmp_gt_u32 vcc, v23, v25
s_nop 0
s_cbranch_vccnz .Lsp50
.Lsp50b:
s_waitcnt lgkmcnt(8)
s_barrier
MAV 32,0,112
TR 32,6,16896
s_add_u32 m0, s55, 67584
MAV 32,16,120
buffer_load_dwordx4 v18, s[28:31], s54 offen lds
MAV 48,16,124
TR 34,6,17408
MAV 48,0,116
TR 36,6,16928
TR 38,6,17440
MAV 52,4,116
TR 48,6,25344
s_add_u32 s52, s76, 16384
MAV 52,20,124
buffer_load_dwordx4 v[96:99], v4, s[16:19], s52 offen sc1
MAV 36,20,120
TR 50,6,25856
MAV 36,4,112
TR 52,6,25376
TR 54,6,25888
s_waitcnt lgkmcnt(8)
MAV 40,8,112
TR 40,6,16960
MAV 40,24,120
buffer_load_dwordx4 v19, s[28:31], s54 offen offset:1056 lds
MAV 56,24,124
TR 42,6,17472
s_add_u32 s54, s98, 2162688
MAV 56,8,116
TR 44,6,16992
TR 46,6,17504
MAV 60,12,116
TR 56,6,25408
MAV 60,28,124
buffer_load_dwordx4 v[100:103], v4, s[16:19], s52 offen offset:1024 sc1
MAV 44,28,120
TR 58,6,25920
MAV 44,12,112
TR 60,6,25440
TR 62,6,25952
s_waitcnt lgkmcnt(8)
MAV 64,32,112
TR 0,7,33792
s_add_u32 m0, s55, 76032
MAV 64,48,120
buffer_load_dwordx4 v18, s[28:31], s54 offen lds
MAV 80,48,124
TR 2,7,34304
MAV 80,32,116
TR 4,7,33824
TR 6,7,34336
MAV 84,36,116
TR 16,7,42240
s_add_u32 s52, s76, 81920
MAV 84,52,124
buffer_load_dwordx4 v[104:107], v4, s[16:19], s52 offen sc1
MAV 68,52,120
TR 18,7,42752
MAV 68,36,112
TR 20,7,42272
TR 22,7,42784
s_waitcnt lgkmcnt(8)
MAV 72,40,112
TR 8,7,33856
MAV 72,56,120
buffer_load_dwordx4 v19, s[28:31], s54 offen offset:1056 lds
MAV 88,56,124
TR 10,7,34368
s_add_u32 s54, s99, 2359296
MAV 88,40,116
TR 12,7,33888
TR 14,7,34400
MAV 92,44,116
TR 24,7,42304
MAV 92,60,124
buffer_load_dwordx4 v[108:111], v4, s[16:19], s52 offen offset:1024 sc1
MAV 76,60,120
TR 26,7,42816
MAV 76,44,112
TR 28,7,42336
TR 30,7,42848
s_waitcnt lgkmcnt(8)
s_barrier
MAV 32,0,128
TR 32,6,33792
s_add_u32 m0, s55, 84480
MAV 32,16,136
buffer_load_dwordx4 v18, s[28:31], s54 offen lds
MAV 48,16,140
TR 34,6,34304
MAV 48,0,132
TR 36,6,33824
TR 38,6,34336
MAV 52,4,132
TR 48,6,42240
s_add_u32 s52, s77, 131072
MAV 52,20,140
buffer_load_dwordx4 v[112:115], v4, s[16:19], s52 offen sc1
MAV 36,20,136
TR 50,6,42752
MAV 36,4,128
TR 52,6,42272
TR 54,6,42784
s_waitcnt lgkmcnt(8)
MAV 40,8,128
TR 40,6,33856
MAV 40,24,136
buffer_load_dwordx4 v19, s[28:31], s54 offen offset:1056 lds
MAV 56,24,140
TR 42,6,34368
s_add_u32 s54, s99, 2621440
MAV 56,8,132
TR 44,6,33888
TR 46,6,34400
MAV 60,12,132
TR 56,6,42304
MAV 60,28,140
buffer_load_dwordx4 v[116:119], v4, s[16:19], s52 offen offset:1024 sc1
MAV 44,28,136
TR 58,6,42816
MAV 44,12,128
TR 60,6,42336
TR 62,6,42848
s_waitcnt lgkmcnt(8)
MAV 64,32,128
TR 0,7,50688
s_add_u32 m0, s55, 92928
MAV 64,48,136
buffer_load_dwordx4 v18, s[28:31], s54 offen lds
MAV 80,48,140
TR 2,7,51200
MAV 80,32,132
TR 4,7,50720
TR 6,7,51232
MAV 84,36,132
TR 16,7,59136
s_add_u32 s52, s77, 196608
MAV 84,52,140
buffer_load_dwordx4 v[120:123], v4, s[16:19], s52 offen sc1
MAV 68,52,136
TR 18,7,59648
MAV 68,36,128
TR 20,7,59168
TR 22,7,59680
s_waitcnt lgkmcnt(8)
MAV 72,40,128
TR 8,7,50752
MAV 72,56,136
buffer_load_dwordx4 v19, s[28:31], s54 offen offset:1056 lds
MAV 88,56,140
TR 10,7,51264
s_add_u32 s54, s100, 2818048
MAV 88,40,132
TR 12,7,50784
TR 14,7,51296
MAV 92,44,132
TR 24,7,59200
MAV 92,60,140
buffer_load_dwordx4 v[124:127], v4, s[16:19], s52 offen offset:1024 sc1
MAV 76,60,136
TR 26,7,59712
MAV 76,44,128
TR 28,7,59232
TR 30,7,59744
s_waitcnt vmcnt(16) lgkmcnt(8)
s_barrier
MAV 32,0,144
TR 32,6,50688
s_add_u32 m0, s55, 101376
MAV 32,16,152
buffer_load_dwordx4 v18, s[28:31], s54 offen lds
MAV 48,16,156
TR 34,6,51200
MAV 48,0,148
TR 36,6,50720
TR 38,6,51232
MAV 52,4,148
TR 48,6,59136
s_add_u32 s52, s78, 245760
MAV 52,20,156
buffer_load_dwordx4 v[128:131], v4, s[16:19], s52 offen sc1
MAV 36,20,152
TR 50,6,59648
MAV 36,4,144
TR 52,6,59168
TR 54,6,59680
s_waitcnt lgkmcnt(8)
MAV 40,8,144
TR 40,6,50752
MAV 40,24,152
buffer_load_dwordx4 v19, s[28:31], s54 offen offset:1056 lds
MAV 56,24,156
TR 42,6,51264
s_add_u32 s54, s100, 3080192
MAV 56,8,148
TR 44,6,50784
TR 46,6,51296
MAV 60,12,148
TR 56,6,59200
MAV 60,28,156
buffer_load_dwordx4 v[132:135], v4, s[16:19], s52 offen offset:1024 sc1
MAV 44,28,152
TR 58,6,59712
MAV 44,12,144
TR 60,6,59232
TR 62,6,59744
v_add_u32 v7, s57, v7
v_add_u32 v6, s57, v6
s_sub_u32 s57, 0, s57
s_waitcnt lgkmcnt(8)
MAV 64,32,144
ds_read_b64_tr_b16 a[0:1], v7
s_add_u32 m0, s55, 109824
MAV 64,48,152
buffer_load_dwordx4 v18, s[28:31], s54 offen lds
MAV 80,48,156
TR 2,7,512
MAV 80,32,148
TR 4,7,32
TR 6,7,544
MAV 84,36,148
TR 16,7,8448
s_add_u32 s52, s78, 311296
MAV 84,52,156
buffer_load_dwordx4 v[136:139], v4, s[16:19], s52 offen sc1
MAV 68,52,152
TR 18,7,8960
MAV 68,36,144
TR 20,7,8480
TR 22,7,8992
s_waitcnt lgkmcnt(8)
MAV 72,40,144
TR 8,7,64
MAV 72,56,152
buffer_load_dwordx4 v19, s[28:31], s54 offen offset:1056 lds
MAV 88,56,156
TR 10,7,576
s_add_u32 s54, s101, 3276800
MAV 88,40,148
TR 12,7,96
TR 14,7,608
MAV 92,44,148
TR 24,7,8512
MAV 92,60,156
buffer_load_dwordx4 v[140:143], v4, s[16:19], s52 offen offset:1024 sc1
MAV 76,60,152
TR 26,7,9024
MAV 76,44,144
TR 28,7,8544
TR 30,7,9056
s_waitcnt vmcnt(16) lgkmcnt(8)
s_barrier
MAV 32,0,96
ds_read_b64_tr_b16 a[32:33], v6
s_add_u32 m0, s55, 118272
MAV 32,16,104
buffer_load_dwordx4 v18, s[28:31], s54 offen lds
MAV 48,16,108
TR 34,6,512
MAV 48,0,100
TR 36,6,32
TR 38,6,544
MAV 52,4,100
TR 48,6,8448
s_add_u32 s52, s79, 360448
MAV 52,20,108
buffer_load_dwordx4 v[144:147], v4, s[16:19], s52 offen sc1
MAV 36,20,104
TR 50,6,8960
MAV 36,4,96
TR 52,6,8480
TR 54,6,8992
s_waitcnt lgkmcnt(8)
MAV 40,8,96
TR 40,6,64
MAV 40,24,104
buffer_load_dwordx4 v19, s[28:31], s54 offen offset:1056 lds
MAV 56,24,108
TR 42,6,576
s_add_u32 s54, s101, 3538944
MAV 56,8,100
TR 44,6,96
TR 46,6,608
MAV 60,12,100
TR 56,6,8512
MAV 60,28,108
buffer_load_dwordx4 v[148:151], v4, s[16:19], s52 offen offset:1024 sc1
MAV 44,28,104
TR 58,6,9024
MAV 44,12,96
TR 60,6,8544
TR 62,6,9056
s_waitcnt lgkmcnt(8)
MAV 64,32,96
TR 0,7,16896
s_add_u32 m0, s55, 126720
MAV 64,48,104
buffer_load_dwordx4 v18, s[28:31], s54 offen lds
MAV 80,48,108
TR 2,7,17408
MAV 80,32,100
TR 4,7,16928
TR 6,7,17440
MAV 84,36,100
TR 16,7,25344
s_add_u32 s52, s79, 425984
MAV 84,52,108
buffer_load_dwordx4 v[152:155], v4, s[16:19], s52 offen sc1
MAV 68,52,104
TR 18,7,25856
MAV 68,36,96
TR 20,7,25376
TR 22,7,25888
s_waitcnt lgkmcnt(8)
MAV 72,40,96
TR 8,7,16960
MAV 72,56,104
buffer_load_dwordx4 v19, s[28:31], s54 offen offset:1056 lds
MAV 88,56,108
TR 10,7,17472
s_add_u32 s54, s98, 131072
MAV 88,40,100
TR 12,7,16992
TR 14,7,17504
MAV 92,44,100
TR 24,7,25408
MAV 92,60,108
buffer_load_dwordx4 v[156:159], v4, s[16:19], s52 offen offset:1024 sc1
MAV 76,60,104
TR 26,7,25920
MAV 76,44,96
TR 28,7,25440
TR 30,7,25952
s_waitcnt vmcnt(16) lgkmcnt(8)
s_barrier
MAV 32,0,112
TR 32,6,16896
s_add_u32 m0, s55, 0
MAV 32,16,120
buffer_load_dwordx4 v18, s[28:31], s54 offen lds
MAV 48,16,124
TR 34,6,17408
MAV 48,0,116
TR 36,6,16928
TR 38,6,17440
MAV 52,4,116
TR 48,6,25344
s_add_u32 s52, s76, 475136
MAV 52,20,124
buffer_load_dwordx4 v[96:99], v4, s[16:19], s52 offen sc1
MAV 36,20,120
TR 50,6,25856
MAV 36,4,112
TR 52,6,25376
TR 54,6,25888
s_waitcnt lgkmcnt(8)
MAV 40,8,112
TR 40,6,16960
MAV 40,24,120
buffer_load_dwordx4 v19, s[28:31], s54 offen offset:1056 lds
MAV 56,24,124
TR 42,6,17472
s_add_u32 s54, s98, 393216
MAV 56,8,116
TR 44,6,16992
TR 46,6,17504
MAV 60,12,116
TR 56,6,25408
MAV 60,28,124
buffer_load_dwordx4 v[100:103], v4, s[16:19], s52 offen offset:1024 sc1
MAV 44,28,120
TR 58,6,25920
MAV 44,12,112
TR 60,6,25440
TR 62,6,25952
s_waitcnt lgkmcnt(8)
MAV 64,32,112
TR 0,7,33792
s_add_u32 m0, s55, 8448
MAV 64,48,120
buffer_load_dwordx4 v18, s[28:31], s54 offen lds
MAV 80,48,124
TR 2,7,34304
MAV 80,32,116
TR 4,7,33824
TR 6,7,34336
MAV 84,36,116
TR 16,7,42240
s_add_u32 s52, s76, 540672
MAV 84,52,124
buffer_load_dwordx4 v[104:107], v4, s[16:19], s52 offen sc1
MAV 68,52,120
TR 18,7,42752
MAV 68,36,112
TR 20,7,42272
TR 22,7,42784
s_waitcnt lgkmcnt(8)
MAV 72,40,112
TR 8,7,33856
MAV 72,56,120
buffer_load_dwordx4 v19, s[28:31], s54 offen offset:1056 lds
MAV 88,56,124
TR 10,7,34368
s_add_u32 s54, s99, 589824
MAV 88,40,116
TR 12,7,33888
TR 14,7,34400
MAV 92,44,116
TR 24,7,42304
MAV 92,60,124
buffer_load_dwordx4 v[108:111], v4, s[16:19], s52 offen offset:1024 sc1
MAV 76,60,120
TR 26,7,42816
MAV 76,44,112
TR 28,7,42336
TR 30,7,42848
s_waitcnt vmcnt(16) lgkmcnt(8)
s_barrier
MAV 32,0,128
TR 32,6,33792
s_add_u32 m0, s55, 16896
MAV 32,16,136
buffer_load_dwordx4 v18, s[28:31], s54 offen lds
MAV 48,16,140
TR 34,6,34304
MAV 48,0,132
TR 36,6,33824
TR 38,6,34336
MAV 52,4,132
TR 48,6,42240
s_add_u32 s52, s77, 589824
MAV 52,20,140
buffer_load_dwordx4 v[112:115], v4, s[16:19], s52 offen sc1
MAV 36,20,136
TR 50,6,42752
MAV 36,4,128
TR 52,6,42272
TR 54,6,42784
s_waitcnt lgkmcnt(8)
MAV 40,8,128
TR 40,6,33856
MAV 40,24,136
buffer_load_dwordx4 v19, s[28:31], s54 offen offset:1056 lds
MAV 56,24,140
TR 42,6,34368
s_add_u32 s54, s99, 851968
MAV 56,8,132
TR 44,6,33888
TR 46,6,34400
MAV 60,12,132
TR 56,6,42304
MAV 60,28,140
buffer_load_dwordx4 v[116:119], v4, s[16:19], s52 offen offset:1024 sc1
MAV 44,28,136
TR 58,6,42816
MAV 44,12,128
TR 60,6,42336
TR 62,6,42848
s_waitcnt lgkmcnt(8)
MAV 64,32,128
TR 0,7,50688
s_add_u32 m0, s55, 25344
MAV 64,48,136
buffer_load_dwordx4 v18, s[28:31], s54 offen lds
MAV 80,48,140
TR 2,7,51200
MAV 80,32,132
TR 4,7,50720
TR 6,7,51232
MAV 84,36,132
TR 16,7,59136
s_add_u32 s52, s77, 655360
MAV 84,52,140
buffer_load_dwordx4 v[120:123], v4, s[16:19], s52 offen sc1
MAV 68,52,136
TR 18,7,59648
MAV 68,36,128
TR 20,7,59168
TR 22,7,59680
.Lpad19:
s_cbranch_execz .Lpad22
s_waitcnt lgkmcnt(8)
MAV 72,40,128
TR 8,7,50752
MAV 72,56,136
buffer_load_dwordx4 v19, s[28:31], s54 offen offset:1056 lds
MAV 88,56,140
TR 10,7,51264
s_add_u32 s54, s100, 1048576
MAV 88,40,132
TR 12,7,50784
TR 14,7,51296
MAV 92,44,132
TR 24,7,59200
MAV 92,60,140
buffer_load_dwordx4 v[124:127], v4, s[16:19], s52 offen offset:1024 sc1
MAV 76,60,136
TR 26,7,59712
MAV 76,44,128
TR 28,7,59232
TR 30,7,59744
s_waitcnt vmcnt(16) lgkmcnt(8)
s_barrier
MAV 32,0,144
TR 32,6,50688
s_add_u32 m0, s55, 33792
MAV 32,16,152
buffer_load_dwordx4 v18, s[28:31], s54 offen lds
MAV 48,16,156
TR 34,6,51200
MAV 48,0,148
TR 36,6,50720
TR 38,6,51232
MAV 52,4,148
TR 48,6,59136
s_add_u32 s52, s78, 704512
MAV 52,20,156
buffer_load_dwordx4 v[128:131], v4, s[16:19], s52 offen sc1
MAV 36,20,152
TR 50,6,59648
MAV 36,4,144
TR 52,6,59168
TR 54,6,59680
s_waitcnt lgkmcnt(8)
MAV 40,8,144
TR 40,6,50752
MAV 40,24,152
buffer_load_dwordx4 v19, s[28:31], s54 offen offset:1056 lds
MAV 56,24,156
TR 42,6,51264
s_add_u32 s54, s100, 1310720
MAV 56,8,148
TR 44,6,50784
TR 46,6,51296
MAV 60,12,148
TR 56,6,59200
MAV 60,28,156
buffer_load_dwordx4 v[132:135], v4, s[16:19], s52 offen offset:1024 sc1
MAV 44,28,152
TR 58,6,59712
MAV 44,12,144
TR 60,6,59232
TR 62,6,59744
v_add_u32 v7, s57, v7
v_add_u32 v6, s57, v6
s_sub_u32 s57, 0, s57
s_waitcnt lgkmcnt(8)
MAV 64,32,144
ds_read_b64_tr_b16 a[0:1], v7
s_add_u32 m0, s55, 42240
MAV 64,48,152
buffer_load_dwordx4 v18, s[28:31], s54 offen lds
MAV 80,48,156
TR 2,7,512
MAV 80,32,148
TR 4,7,32
TR 6,7,544
MAV 84,36,148
TR 16,7,8448
s_add_u32 s52, s78, 770048
MAV 84,52,156
buffer_load_dwordx4 v[136:139], v4, s[16:19], s52 offen sc1
MAV 68,52,152
TR 18,7,8960
MAV 68,36,144
TR 20,7,8480
TR 22,7,8992
s_waitcnt lgkmcnt(8)
MAV 72,40,144
TR 8,7,64
MAV 72,56,152
buffer_load_dwordx4 v19, s[28:31], s54 offen offset:1056 lds
MAV 88,56,156
TR 10,7,576
s_add_u32 s54, s101, 1507328
MAV 88,40,148
TR 12,7,96
TR 14,7,608
MAV 92,44,148
TR 24,7,8512
MAV 92,60,156
buffer_load_dwordx4 v[140:143], v4, s[16:19], s52 offen offset:1024 sc1
MAV 76,60,152
TR 26,7,9024
MAV 76,44,144
TR 28,7,8544
TR 30,7,9056
s_waitcnt vmcnt(16) lgkmcnt(8)
s_barrier
MAV 32,0,96
ds_read_b64_tr_b16 a[32:33], v6
s_add_u32 m0, s55, 50688
MAV 32,16,104
buffer_load_dwordx4 v18, s[28:31], s54 offen lds
MAV 48,16,108
TR 34,6,512
MAV 48,0,100
TR 36,6,32
TR 38,6,544
MAV 52,4,100
TR 48,6,8448
s_add_u32 s52, s79, 819200
MAV 52,20,108
buffer_load_dwordx4 v[144:147], v4, s[16:19], s52 offen sc1
MAV 36,20,104
TR 50,6,8960
MAV 36,4,96
TR 52,6,8480
TR 54,6,8992
s_waitcnt lgkmcnt(8)
MAV 40,8,96
TR 40,6,64
MAV 40,24,104
buffer_load_dwordx4 v19, s[28:31], s54 offen offset:1056 lds
MAV 56,24,108
TR 42,6,576
s_add_u32 s54, s101, 1769472
MAV 56,8,100
TR 44,6,96
TR 46,6,608
MAV 60,12,100
TR 56,6,8512
MAV 60,28,108
buffer_load_dwordx4 v[148:151], v4, s[16:19], s52 offen offset:1024 sc1
MAV 44,28,104
TR 58,6,9024
MAV 44,12,96
TR 60,6,8544
TR 62,6,9056
s_waitcnt lgkmcnt(8)
MAV 64,32,96
TR 0,7,16896
s_add_u32 m0, s55, 59136
MAV 64,48,104
buffer_load_dwordx4 v18, s[28:31], s54 offen lds
MAV 80,48,108
TR 2,7,17408
MAV 80,32,100
TR 4,7,16928
TR 6,7,17440
MAV 84,36,100
TR 16,7,25344
s_add_u32 s52, s79, 884736
MAV 84,52,108
buffer_load_dwordx4 v[152:155], v4, s[16:19], s52 offen sc1
MAV 68,52,104
TR 18,7,25856
MAV 68,36,96
TR 20,7,25376
TR 22,7,25888
s_waitcnt lgkmcnt(8)
MAV 72,40,96
TR 8,7,16960
MAV 72,56,104
buffer_load_dwordx4 v19, s[28:31], s54 offen offset:1056 lds
MAV 88,56,108
TR 10,7,17472
s_add_u32 s54, s98, 1966080
MAV 88,40,100
TR 12,7,16992
TR 14,7,17504
MAV 92,44,100
TR 24,7,25408
MAV 92,60,108
buffer_load_dwordx4 v[156:159], v4, s[16:19], s52 offen offset:1024 sc1
MAV 76,60,104
TR 26,7,25920
MAV 76,44,96
TR 28,7,25440
TR 30,7,25952
s_waitcnt vmcnt(16) lgkmcnt(8)
s_barrier
MAV 32,0,112
TR 32,6,16896
s_add_u32 m0, s55, 67584
MAV 32,16,120
buffer_load_dwordx4 v18, s[28:31], s54 offen lds
MAV 48,16,124
TR 34,6,17408
MAV 48,0,116
TR 36,6,16928
TR 38,6,17440
MAV 52,4,116
TR 48,6,25344
s_add_u32 s52, s76, 32768
MAV 52,20,124
buffer_load_dwordx4 v[96:99], v4, s[16:19], s52 offen sc1
MAV 36,20,120
TR 50,6,25856
MAV 36,4,112
TR 52,6,25376
TR 54,6,25888
s_waitcnt lgkmcnt(8)
MAV 40,8,112
TR 40,6,16960
MAV 40,24,120
buffer_load_dwordx4 v19, s[28:31], s54 offen offset:1056 lds
MAV 56,24,124
TR 42,6,17472
s_add_u32 s54, s98, 2228224
MAV 56,8,116
TR 44,6,16992
TR 46,6,17504
MAV 60,12,116
TR 56,6,25408
MAV 60,28,124
buffer_load_dwordx4 v[100:103], v4, s[16:19], s52 offen offset:1024 sc1
MAV 44,28,120
TR 58,6,25920
MAV 44,12,112
TR 60,6,25440
TR 62,6,25952
s_waitcnt lgkmcnt(8)
MAV 64,32,112
TR 0,7,33792
s_add_u32 m0, s55, 76032
MAV 64,48,120
buffer_load_dwordx4 v18, s[28:31], s54 offen lds
MAV 80,48,124
TR 2,7,34304
MAV 80,32,116
TR 4,7,33824
TR 6,7,34336
MAV 84,36,116
TR 16,7,42240
s_add_u32 s52, s76, 98304
MAV 84,52,124
buffer_load_dwordx4 v[104:107], v4, s[16:19], s52 offen sc1
MAV 68,52,120
TR 18,7,42752
MAV 68,36,112
TR 20,7,42272
TR 22,7,42784
s_waitcnt lgkmcnt(8)
MAV 72,40,112
TR 8,7,33856
MAV 72,56,120
buffer_load_dwordx4 v19, s[28:31], s54 offen offset:1056 lds
MAV 88,56,124
TR 10,7,34368
s_add_u32 s54, s99, 2424832
MAV 88,40,116
TR 12,7,33888
TR 14,7,34400
MAV 92,44,116
TR 24,7,42304
MAV 92,60,124
buffer_load_dwordx4 v[108:111], v4, s[16:19], s52 offen offset:1024 sc1
MAV 76,60,120
TR 26,7,42816
MAV 76,44,112
TR 28,7,42336
TR 30,7,42848
s_waitcnt vmcnt(16) lgkmcnt(8)
s_barrier
MAV 32,0,128
TR 32,6,33792
s_add_u32 m0, s55, 84480
MAV 32,16,136
buffer_load_dwordx4 v18, s[28:31], s54 offen lds
MAV 48,16,140
TR 34,6,34304
MAV 48,0,132
TR 36,6,33824
TR 38,6,34336
MAV 52,4,132
TR 48,6,42240
s_add_u32 s52, s77, 147456
MAV 52,20,140
buffer_load_dwordx4 v[112:115], v4, s[16:19], s52 offen sc1
MAV 36,20,136
TR 50,6,42752
MAV 36,4,128
TR 52,6,42272
TR 54,6,42784
s_waitcnt lgkmcnt(8)
MAV 40,8,128
TR 40,6,33856
MAV 40,24,136
buffer_load_dwordx4 v19, s[28:31], s54 offen offset:1056 lds
MAV 56,24,140
TR 42,6,34368
s_add_u32 s54, s99, 2686976
MAV 56,8,132
TR 44,6,33888
TR 46,6,34400
MAV 60,12,132
TR 56,6,42304
MAV 60,28,140
buffer_load_dwordx4 v[116:119], v4, s[16:19], s52 offen offset:1024 sc1
MAV 44,28,136
TR 58,6,42816
MAV 44,12,128
TR 60,6,42336
TR 62,6,42848
s_waitcnt lgkmcnt(8)
MAV 64,32,128
TR 0,7,50688
s_add_u32 m0, s55, 92928
MAV 64,48,136
buffer_load_dwordx4 v18, s[28:31], s54 offen lds
MAV 80,48,140
TR 2,7,51200
MAV 80,32,132
TR 4,7,50720
TR 6,7,51232
MAV 84,36,132
TR 16,7,59136
s_add_u32 s52, s77, 212992
MAV 84,52,140
buffer_load_dwordx4 v[120:123], v4, s[16:19], s52 offen sc1
MAV 68,52,136
TR 18,7,59648
MAV 68,36,128
TR 20,7,59168
TR 22,7,59680
s_waitcnt lgkmcnt(8)
MAV 72,40,128
TR 8,7,50752
MAV 72,56,136
buffer_load_dwordx4 v19, s[28:31], s54 offen offset:1056 lds
MAV 88,56,140
TR 10,7,51264
s_add_u32 s54, s100, 2883584
MAV 88,40,132
TR 12,7,50784
TR 14,7,51296
MAV 92,44,132
TR 24,7,59200
MAV 92,60,140
buffer_load_dwordx4 v[124:127], v4, s[16:19], s52 offen offset:1024 sc1
MAV 76,60,136
TR 26,7,59712
MAV 76,44,128
TR 28,7,59232
TR 30,7,59744
s_waitcnt vmcnt(16) lgkmcnt(8)
s_barrier
MAV 32,0,144
TR 32,6,50688
s_add_u32 m0, s55, 101376
MAV 32,16,152
buffer_load_dwordx4 v18, s[28:31], s54 offen lds
MAV 48,16,156
TR 34,6,51200
MAV 48,0,148
TR 36,6,50720
TR 38,6,51232
MAV 52,4,148
TR 48,6,59136
s_add_u32 s52, s78, 262144
MAV 52,20,156
buffer_load_dwordx4 v[128:131], v4, s[16:19], s52 offen sc1
MAV 36,20,152
TR 50,6,59648
MAV 36,4,144
TR 52,6,59168
TR 54,6,59680
s_waitcnt lgkmcnt(8)
MAV 40,8,144
TR 40,6,50752
MAV 40,24,152
buffer_load_dwordx4 v19, s[28:31], s54 offen offset:1056 lds
MAV 56,24,156
TR 42,6,51264
s_add_u32 s54, s100, 3145728
MAV 56,8,148
TR 44,6,50784
TR 46,6,51296
MAV 60,12,148
TR 56,6,59200
MAV 60,28,156
buffer_load_dwordx4 v[132:135], v4, s[16:19], s52 offen offset:1024 sc1
MAV 44,28,152
TR 58,6,59712
MAV 44,12,144
TR 60,6,59232
TR 62,6,59744
v_add_u32 v7, s57, v7
v_add_u32 v6, s57, v6
s_sub_u32 s57, 0, s57
s_waitcnt lgkmcnt(8)
MAV 64,32,144
ds_read_b64_tr_b16 a[0:1], v7
s_add_u32 m0, s55, 109824
MAV 64,48,152
buffer_load_dwordx4 v18, s[28:31], s54 offen lds
MAV 80,48,156
TR 2,7,512
MAV 80,32,148
TR 4,7,32
TR 6,7,544
MAV 84,36,148
TR 16,7,8448
s_add_u32 s52, s78, 327680
MAV 84,52,156
buffer_load_dwordx4 v[136:139], v4, s[16:19], s52 offen sc1
MAV 68,52,152
TR 18,7,8960
MAV 68,36,144
TR 20,7,8480
TR 22,7,8992
s_waitcnt lgkmcnt(8)
MAV 72,40,144
TR 8,7,64
MAV 72,56,152
buffer_load_dwordx4 v19, s[28:31], s54 offen offset:1056 lds
MAV 88,56,156
TR 10,7,576
s_add_u32 s54, s101, 3342336
MAV 88,40,148
TR 12,7,96
TR 14,7,608
MAV 92,44,148
TR 24,7,8512
MAV 92,60,156
buffer_load_dwordx4 v[140:143], v4, s[16:19], s52 offen offset:1024 sc1
MAV 76,60,152
TR 26,7,9024
MAV 76,44,144
TR 28,7,8544
TR 30,7,9056
s_waitcnt vmcnt(16) lgkmcnt(8)
s_barrier
MAV 32,0,96
ds_read_b64_tr_b16 a[32:33], v6
s_add_u32 m0, s55, 118272
MAV 32,16,104
buffer_load_dwordx4 v18, s[28:31], s54 offen lds
MAV 48,16,108
TR 34,6,512
MAV 48,0,100
TR 36,6,32
TR 38,6,544
MAV 52,4,100
TR 48,6,8448
s_add_u32 s52, s79, 376832
MAV 52,20,108
buffer_load_dwordx4 v[144:147], v4, s[16:19], s52 offen sc1
MAV 36,20,104
TR 50,6,8960
MAV 36,4,96
TR 52,6,8480
TR 54,6,8992
s_waitcnt lgkmcnt(8)
MAV 40,8,96
TR 40,6,64
MAV 40,24,104
buffer_load_dwordx4 v19, s[28:31], s54 offen offset:1056 lds
MAV 56,24,108
TR 42,6,576
s_add_u32 s54, s101, 3604480
MAV 56,8,100
TR 44,6,96
TR 46,6,608
MAV 60,12,100
TR 56,6,8512
MAV 60,28,108
buffer_load_dwordx4 v[148:151], v4, s[16:19], s52 offen offset:1024 sc1
MAV 44,28,104
TR 58,6,9024
MAV 44,12,96
TR 60,6,8544
TR 62,6,9056
s_waitcnt lgkmcnt(8)
MAV 64,32,96
TR 0,7,16896
s_add_u32 m0, s55, 126720
MAV 64,48,104
buffer_load_dwordx4 v18, s[28:31], s54 offen lds
MAV 80,48,108
TR 2,7,17408
MAV 80,32,100
TR 4,7,16928
TR 6,7,17440
MAV 84,36,100
TR 16,7,25344
s_add_u32 s52, s79, 442368
MAV 84,52,108
buffer_load_dwordx4 v[152:155], v4, s[16:19], s52 offen sc1
MAV 68,52,104
TR 18,7,25856
MAV 68,36,96
TR 20,7,25376
TR 22,7,25888
s_waitcnt lgkmcnt(8)
MAV 72,40,96
TR 8,7,16960
MAV 72,56,104
buffer_load_dwordx4 v19, s[28:31], s54 offen offset:1056 lds
MAV 88,56,108
TR 10,7,17472
s_add_u32 s54, s98, 196608
MAV 88,40,100
TR 12,7,16992
TR 14,7,17504
MAV 92,44,100
TR 24,7,25408
MAV 92,60,108
buffer_load_dwordx4 v[156:159], v4, s[16:19], s52 offen offset:1024 sc1
MAV 76,60,104
TR 26,7,25920
MAV 76,44,96
TR 28,7,25440
TR 30,7,25952
s_waitcnt vmcnt(16) lgkmcnt(8)
s_barrier
MAV 32,0,112
TR 32,6,16896
s_add_u32 m0, s55, 0
MAV 32,16,120
buffer_load_dwordx4 v18, s[28:31], s54 offen lds
MAV 48,16,124
.Lpad20:
s_cbranch_execz .Lnopoll37r
TR 34,6,17408
MAV 48,0,116
TR 36,6,16928
TR 38,6,17440
MAV 52,4,116
TR 48,6,25344
s_add_u32 s52, s76, 491520
MAV 52,20,124
buffer_load_dwordx4 v[96:99], v4, s[16:19], s52 offen sc1
MAV 36,20,120
TR 50,6,25856
MAV 36,4,112
TR 52,6,25376
TR 54,6,25888
s_waitcnt lgkmcnt(8)
MAV 40,8,112
TR 40,6,16960
MAV 40,24,120
buffer_load_dwordx4 v19, s[28:31], s54 offen offset:1056 lds
MAV 56,24,124
TR 42,6,17472
s_add_u32 s54, s99, 655360
MAV 56,8,116
TR 44,6,16992
TR 46,6,17504
MAV 60,12,116
TR 56,6,25408
MAV 60,28,124
buffer_load_dwordx4 v[100:103], v4, s[16:19], s52 offen offset:1024 sc1
MAV 44,28,120
TR 58,6,25920
MAV 44,12,112
TR 60,6,25440
TR 62,6,25952
s_waitcnt lgkmcnt(8)
MAV 64,32,112
TR 0,7,33792
s_add_u32 m0, s55, 8448
MAV 64,48,120
buffer_load_dwordx4 v18, s[28:31], s54 offen lds
MAV 80,48,124
TR 2,7,34304
MAV 80,32,116
TR 4,7,33824
TR 6,7,34336
MAV 84,36,116
TR 16,7,42240
s_add_u32 s52, s76, 557056
MAV 84,52,124
buffer_load_dwordx4 v[104:107], v4, s[16:19], s52 offen sc1
MAV 68,52,120
TR 18,7,42752
MAV 68,36,112
TR 20,7,42272
TR 22,7,42784
s_waitcnt lgkmcnt(8)
MAV 72,40,112
TR 8,7,33856
MAV 72,56,120
buffer_load_dwordx4 v19, s[28:31], s54 offen offset:1056 lds
MAV 88,56,124
TR 10,7,34368
s_add_u32 s54, s100, 1114112
MAV 88,40,116
TR 12,7,33888
TR 14,7,34400
MAV 92,44,116
TR 24,7,42304
MAV 92,60,124
buffer_load_dwordx4 v[108:111], v4, s[16:19], s52 offen offset:1024 sc1
MAV 76,60,120
TR 26,7,42816
MAV 76,44,112
TR 28,7,42336
TR 30,7,42848
s_waitcnt vmcnt(16) lgkmcnt(8)
s_barrier
MAV 32,0,128
TR 32,6,33792
s_add_u32 m0, s55, 16896
MAV 32,16,136
buffer_load_dwordx4 v18, s[28:31], s54 offen lds
MAV 48,16,140
TR 34,6,34304
MAV 48,0,132
TR 36,6,33824
TR 38,6,34336
MAV 52,4,132
TR 48,6,42240
s_add_u32 s52, s77, 606208
MAV 52,20,140
buffer_load_dwordx4 v[112:115], v4, s[16:19], s52 offen sc1
MAV 36,20,136
TR 50,6,42752
MAV 36,4,128
TR 52,6,42272
TR 54,6,42784
s_waitcnt lgkmcnt(8)
MAV 40,8,128
TR 40,6,33856
MAV 40,24,136
buffer_load_dwordx4 v19, s[28:31], s54 offen offset:1056 lds
MAV 56,24,140
TR 42,6,34368
s_add_u32 s54, s101, 1572864
MAV 56,8,132
TR 44,6,33888
TR 46,6,34400
MAV 60,12,132
TR 56,6,42304
MAV 60,28,140
buffer_load_dwordx4 v[116:119], v4, s[16:19], s52 offen offset:1024 sc1
MAV 44,28,136
TR 58,6,42816
MAV 44,12,128
TR 60,6,42336
TR 62,6,42848
s_waitcnt lgkmcnt(8)
MAV 64,32,128
TR 0,7,50688
s_add_u32 m0, s55, 25344
MAV 64,48,136
buffer_load_dwordx4 v18, s[28:31], s54 offen lds
MAV 80,48,140
TR 2,7,51200
MAV 80,32,132
TR 4,7,50720
TR 6,7,51232
MAV 84,36,132
TR 16,7,59136
s_add_u32 s52, s77, 671744
MAV 84,52,140
buffer_load_dwordx4 v[120:123], v4, s[16:19], s52 offen sc1
MAV 68,52,136
TR 18,7,59648
MAV 68,36,128
TR 20,7,59168
TR 22,7,59680
s_waitcnt lgkmcnt(8)
MAV 72,40,128
TR 8,7,50752
MAV 72,56,136
buffer_load_dwordx4 v19, s[28:31], s54 offen offset:1056 lds
MAV 88,56,140
TR 10,7,51264
s_add_u32 s54, s98, 2031616
MAV 88,40,132
TR 12,7,50784
TR 14,7,51296
MAV 92,44,132
TR 24,7,59200
MAV 92,60,140
buffer_load_dwordx4 v[124:127], v4, s[16:19], s52 offen offset:1024 sc1
MAV 76,60,136
TR 26,7,59712
MAV 76,44,128
TR 28,7,59232
TR 30,7,59744
s_waitcnt vmcnt(16) lgkmcnt(8)
s_barrier
MAV 32,0,144
TR 32,6,50688
s_add_u32 m0, s55, 33792
MAV 32,16,152
buffer_load_dwordx4 v18, s[28:31], s54 offen lds
MAV 48,16,156
TR 34,6,51200
MAV 48,0,148
TR 36,6,50720
TR 38,6,51232
MAV 52,4,148
TR 48,6,59136
s_add_u32 s52, s78, 720896
MAV 52,20,156
buffer_load_dwordx4 v[128:131], v4, s[16:19], s52 offen sc1
MAV 36,20,152
TR 50,6,59648
MAV 36,4,144
TR 52,6,59168
TR 54,6,59680
s_waitcnt lgkmcnt(8)
MAV 40,8,144
TR 40,6,50752
MAV 40,24,152
buffer_load_dwordx4 v19, s[28:31], s54 offen offset:1056 lds
MAV 56,24,156
TR 42,6,51264
s_add_u32 s54, s99, 2490368
MAV 56,8,148
TR 44,6,50784
TR 46,6,51296
MAV 60,12,148
TR 56,6,59200
MAV 60,28,156
buffer_load_dwordx4 v[132:135], v4, s[16:19], s52 offen offset:1024 sc1
MAV 44,28,152
TR 58,6,59712
MAV 44,12,144
TR 60,6,59232
TR 62,6,59744
v_add_u32 v7, s57, v7
v_add_u32 v6, s57, v6
s_sub_u32 s57, 0, s57
s_waitcnt lgkmcnt(8)
MAV 64,32,144
ds_read_b64_tr_b16 a[0:1], v6
s_add_u32 m0, s55, 42240
MAV 64,48,152
buffer_load_dwordx4 v18, s[28:31], s54 offen lds
MAV 80,48,156
TR 2,6,512
MAV 80,32,148
TR 4,6,32
TR 6,6,544
MAV 84,36,148
TR 16,6,8448
s_add_u32 s52, s78, 786432
MAV 84,52,156
buffer_load_dwordx4 v[136:139], v4, s[16:19], s52 offen sc1
MAV 68,52,152
TR 18,6,8960
MAV 68,36,144
TR 20,6,8480
TR 22,6,8992
s_waitcnt lgkmcnt(8)
MAV 72,40,144
TR 8,6,64
MAV 72,56,152
buffer_load_dwordx4 v19, s[28:31], s54 offen offset:1056 lds
MAV 88,56,156
TR 10,6,576
s_add_u32 s54, s100, 2949120
MAV 88,40,148
TR 12,6,96
TR 14,6,608
MAV 92,44,148
TR 24,6,8512
MAV 92,60,156
buffer_load_dwordx4 v[140:143], v4, s[16:19], s52 offen offset:1024 sc1
MAV 76,60,152
TR 26,6,9024
MAV 76,44,144
TR 28,6,8544
TR 30,6,9056
s_waitcnt vmcnt(16) lgkmcnt(8)
s_barrier
MAV 64,0,96
TR 32,6,16896
TR 34,6,17408
s_add_u32 m0, s55, 50688
MAV 64,16,104
TR 36,6,16928
buffer_load_dwordx4 v18, s[28:31], s54 offen lds
MAV 80,16,108
TR 38,6,17440
MAV 80,0,100
TR 48,6,25344
buffer_load_dwordx4 v19, s[28:31], s54 offen offset:1056 lds
MAV 84,4,100
TR 50,6,25856
s_add_u32 s54, s101, 3407872
s_add_u32 s52, s79, 835584
MAV 84,20,108
buffer_load_dwordx4 v[144:147], v4, s[16:19], s52 offen sc1
MAV 68,20,104
TR 52,6,25376
TR 54,6,25888
MAV 68,4,96
TR 40,6,16960
s_waitcnt lgkmcnt(9)
MAV 72,8,96
TR 42,6,17472
MAV 72,24,104
TR 44,6,16992
buffer_load_dwordx4 v[148:151], v4, s[16:19], s52 offen offset:1024 sc1
MAV 88,24,108
TR 46,6,17504
s_add_u32 m0, s55, 59136
MAV 88,8,100
TR 56,6,25408
buffer_load_dwordx4 v18, s[28:31], s54 offen lds
MAV 92,12,100
TR 58,6,25920
MAV 92,28,108
TR 60,6,25440
buffer_load_dwordx4 v19, s[28:31], s54 offen offset:1056 lds
MAV 76,28,104
TR 62,6,25952
s_add_u32 s52, s79, 901120
MAV 76,12,96
buffer_load_dwordx4 v[152:155], v4, s[16:19], s52 offen sc1
buffer_load_dwordx4 v[156:159], v4, s[16:19], s52 offen offset:1024 sc1
s_waitcnt vmcnt(16) lgkmcnt(8)
MAV 64,32,112
TR 0,6,33792
s_add_u32 s52, s76, 49152
s_lshl_b32 s70, s2, 10
MAV 64,48,120
buffer_load_dwordx4 v[160:163], v4, s[16:19], s52 offen sc1
s_lshl_b32 s62, s3, 7
MAV 80,48,124
TR 2,6,34304
s_add_u32 s70, s70, s62
s_add_u32 s70, s70, 31457280
MAV 80,32,116
TR 4,6,33824
TR 6,6,34336
MAV 84,36,116
TR 16,6,42240
s_xor_b32 s71, s70, 1024
v_min_u32 v26, 1, v1
MAV 84,52,124
buffer_load_dwordx4 v[164:167], v4, s[16:19], s52 offen offset:1024 sc1
v_lshlrev_b32 v26, 28, v26
MAV 68,52,120
TR 18,6,42752
v_mov_b32 v30, 1
MAV 68,36,112
TR 20,6,42272
TR 22,6,42784
s_waitcnt lgkmcnt(8)
MAV 72,40,112
TR 8,6,33856
s_add_u32 s52, s77, 163840
v_mov_b32 v31, 0
MAV 72,56,120
buffer_load_dwordx4 v[168:171], v4, s[16:19], s52 offen sc1
s_lshl_b32 s68, s7, 18
MAV 88,56,124
TR 10,6,34368
s_add_u32 s68, s68, 33554432
s_xor_b32 s69, s68, 262144
MAV 88,40,116
TR 12,6,33888
TR 14,6,34400
MAV 92,44,116
TR 24,6,42304
v_and_b32 v2, 1, v1
v_lshlrev_b32 v2, 4, v2
MAV 92,60,124
buffer_load_dwordx4 v[172:175], v4, s[16:19], s52 offen offset:1024 sc1
v_mov_b32 v224, 0x3f80
MAV 76,60,120
TR 26,6,42816
v_lshlrev_b32 v2, v2, v224
MAV 76,44,112
TR 28,6,42336
TR 30,6,42848
s_waitcnt vmcnt(12) lgkmcnt(8)
MAV 64,0,128
TR 32,6,50688
s_add_u32 s52, s78, 278528
v_bfe_u32 v224, v1, 2, 2
MAV 64,16,136
buffer_load_dwordx4 v[176:179], v4, s[16:19], s52 offen sc1
v_lshrrev_b32 v225, 4, v1
MAV 80,16,140
TR 34,6,51200
v_cmp_eq_u32 vcc, v224, v225
s_nop 1
v_cndmask_b32 v2, 0, v2, vcc
MAV 80,0,132
TR 36,6,50720
TR 38,6,51232
MAV 84,4,132
TR 48,6,59136
v_and_b32 v224, 2, v1
v_cmp_eq_u32 vcc, 0, v224
MAV 84,20,140
buffer_load_dwordx4 v[180:183], v4, s[16:19], s52 offen offset:1024 sc1
v_cndmask_b32 v226, 0, v2, vcc
MAV 68,20,136
TR 50,6,59648
v_cndmask_b32 v227, v2, 0, vcc
MAV 68,4,128
TR 52,6,59168
TR 54,6,59680
s_waitcnt lgkmcnt(8)
MAV 72,8,128
TR 40,6,50752
s_add_u32 s52, s79, 393216
v_mov_b32 v224, 0
MAV 72,24,136
buffer_load_dwordx4 v[184:187], v4, s[16:19], s52 offen sc1
v_mov_b32 v225, 0
MAV 88,24,140
TR 42,6,51264
v_mov_b32 v228, 0
v_mov_b32 v229, 0
MAV 88,8,132
TR 44,6,50784
TR 46,6,51296
MAV 92,12,132
TR 56,6,59200
v_bfe_u32 v18, v1, 3, 1
v_lshrrev_b32 v2, 4, v1
MAV 92,28,140
buffer_load_dwordx4 v[188:191], v4, s[16:19], s52 offen offset:1024 sc1
v_lshl_add_u32 v18, v2, 3, v18
MAV 76,28,136
TR 58,6,59712
s_lshl_b32 s62, s3, 1
MAV 76,12,128
TR 60,6,59232
TR 62,6,59744
s_waitcnt vmcnt(8) lgkmcnt(8)
s_barrier
v_add_u32 v6, s57, v6
MAV 64,32,144
ds_read_b64_tr_b16 a[0:1], v6
s_add_u32 s52, s76, 507904
v_add_u32 v18, s62, v18
MAV 64,48,152
buffer_load_dwordx4 v[192:195], v4, s[16:19], s52 offen sc1
v_mul_u32_u24 v18, 6144, v18
MAV 80,48,156
TR 2,6,512
v_and_b32 v2, 7, v1
v_lshl_add_u32 v18, v2, 4, v18
MAV 80,32,148
TR 4,6,32
TR 6,6,544
MAV 84,36,148
TR 16,6,8448
s_lshl_b32 s62, s9, 7
v_add_u32 v18, s62, v18
MAV 84,52,156
buffer_load_dwordx4 v[196:199], v4, s[16:19], s52 offen offset:1024 sc1
v_add_u32 v19, 1024, v18
MAV 68,52,152
TR 18,6,8960
v_add_u32 v20, 2048, v18
MAV 68,36,144
TR 20,6,8480
TR 22,6,8992
s_waitcnt lgkmcnt(8)
MAV 72,40,144
TR 8,6,64
s_add_u32 s52, s77, 622592
s_mul_i32 s59, s3, 3104
MAV 72,56,152
buffer_load_dwordx4 v[200:203], v4, s[16:19], s52 offen sc1
s_mov_b32 s58, 0
MAV 88,56,156
TR 10,6,576
v_accvgpr_read_b32 v28, a224
v_add_f32 v32, v32, v28
MAV 88,40,148
TR 12,6,96
TR 14,6,608
MAV 92,44,148
TR 24,6,8512
v_accvgpr_read_b32 v29, a225
v_add_f32 v33, v33, v29
MAV 92,60,156
buffer_load_dwordx4 v[204:207], v4, s[16:19], s52 offen offset:1024 sc1
v_accvgpr_read_b32 v28, a226
MAV 76,60,152
TR 26,6,9024
v_add_f32 v34, v34, v28
MAV 76,44,144
TR 28,6,8544
TR 30,6,9056
s_waitcnt vmcnt(8) lgkmcnt(8)
MAV 64,0,160
TR 32,6,16896
s_add_u32 s52, s78, 737280
v_accvgpr_read_b32 v29, a227
MAV 64,16,168
buffer_load_dwordx4 v[208:211], v4, s[16:19], s52 offen sc1
v_add_f32 v35, v35, v29
MAV 80,16,172
TR 34,6,17408
v_accvgpr_read_b32 v28, a228
v_add_f32 v36, v36, v28
MAV 80,0,164
TR 36,6,16928
TR 38,6,17440
MAV 84,4,164
TR 48,6,25344
v_accvgpr_read_b32 v29, a229
v_add_f32 v37, v37, v29
MAV 84,20,172
buffer_load_dwordx4 v[212:215], v4, s[16:19], s52 offen offset:1024 sc1
v_accvgpr_read_b32 v28, a230
MAV 68,20,168
TR 50,6,25856
v_add_f32 v38, v38, v28
MAV 68,4,160
TR 52,6,25376
TR 54,6,25888
s_waitcnt lgkmcnt(8)
MAV 72,8,160
TR 40,6,16960
s_add_u32 s52, s79, 851968
v_accvgpr_read_b32 v29, a231
MAV 72,24,168
buffer_load_dwordx4 v[216:219], v4, s[16:19], s52 offen sc1
v_add_f32 v39, v39, v29
MAV 88,24,172
TR 42,6,17472
v_accvgpr_read_b32 v28, a232
v_add_f32 v40, v40, v28
MAV 88,8,164
TR 44,6,16992
TR 46,6,17504
MAV 92,12,164
TR 56,6,25408
v_accvgpr_read_b32 v29, a233
v_add_f32 v41, v41, v29
MAV 92,28,172
buffer_load_dwordx4 v[220:223], v4, s[16:19], s52 offen offset:1024 sc1
v_accvgpr_read_b32 v28, a234
MAV 76,28,168
TR 58,6,25920
v_add_f32 v42, v42, v28
MAV 76,12,160
TR 60,6,25440
TR 62,6,25952
s_waitcnt vmcnt(8) lgkmcnt(8)
MAV 64,32,176
TR 0,6,33792
v_accvgpr_read_b32 v29, a235
MAV 64,48,184
TR 2,6,34304
v_add_f32 v43, v43, v29
v_accvgpr_read_b32 v28, a236
MAV 80,48,188
TR 4,6,33824
MAV 80,32,180
TR 6,6,34336
v_add_f32 v44, v44, v28
v_accvgpr_read_b32 v29, a237
MAV 84,36,180
TR 16,6,42240
MAV 84,52,188
TR 18,6,42752
v_add_f32 v45, v45, v29
v_accvgpr_read_b32 v28, a238
MAV 68,52,184
TR 20,6,42272
MAV 68,36,176
TR 22,6,42784
v_add_f32 v46, v46, v28
s_waitcnt lgkmcnt(8)
MAV 72,40,176
TR 8,6,33856
v_accvgpr_read_b32 v29, a239
MAV 72,56,184
.Lpad21:
s_cbranch_execz .Lnopoll37r
TR 10,6,34368
v_add_f32 v47, v47, v29
MAV 88,56,188
TR 12,6,33888
v_accvgpr_read_b32 v28, a240
MAV 88,40,180
TR 14,6,34400
v_add_f32 v48, v48, v28
MAV 92,44,180
TR 24,6,42304
v_accvgpr_read_b32 v29, a241
MAV 92,60,188
TR 26,6,42816
v_add_f32 v49, v49, v29
MAV 76,60,184
TR 28,6,42336
v_accvgpr_read_b32 v28, a242
MAV 76,44,176
TR 30,6,42848
v_add_f32 v50, v50, v28
s_waitcnt vmcnt(4) lgkmcnt(8)
MAV 64,0,192
TR 32,6,50688
v_accvgpr_read_b32 v29, a243
MAV 64,16,200
TR 34,6,51200
v_add_f32 v51, v51, v29
v_accvgpr_read_b32 v28, a244
MAV 80,16,204
TR 36,6,50720
MAV 80,0,196
TR 38,6,51232
v_add_f32 v52, v52, v28
v_accvgpr_read_b32 v29, a245
MAV 84,4,196
TR 48,6,59136
MAV 84,20,204
TR 50,6,59648
v_add_f32 v53, v53, v29
v_accvgpr_read_b32 v28, a246
MAV 68,20,200
TR 52,6,59168
MAV 68,4,192
TR 54,6,59680
v_add_f32 v54, v54, v28
s_waitcnt lgkmcnt(8)
MAV 72,8,192
TR 40,6,50752
v_accvgpr_read_b32 v29, a247
MAV 72,24,200
TR 42,6,51264
v_add_f32 v55, v55, v29
MAV 88,24,204
TR 44,6,50784
v_accvgpr_read_b32 v28, a248
MAV 88,8,196
TR 46,6,51296
v_add_f32 v56, v56, v28
MAV 92,12,196
TR 56,6,59200
v_accvgpr_read_b32 v29, a249
MAV 92,28,204
TR 58,6,59712
v_add_f32 v57, v57, v29
MAV 76,28,200
TR 60,6,59232
v_accvgpr_read_b32 v28, a250
MAV 76,12,192
TR 62,6,59744
v_add_f32 v58, v58, v28
s_waitcnt vmcnt(0) lgkmcnt(8)
MAV 64,32,208
ds_read_b64_tr_b16 a[0:1], v7
v_accvgpr_read_b32 v29, a251
MAV 64,48,216
TR 2,7,512
v_add_f32 v59, v59, v29
MAV 80,48,220
TR 4,7,32
MAV 80,32,212
TR 6,7,544
v_accvgpr_read_b32 v28, a252
MAV 84,36,212
TR 16,7,8448
v_add_f32 v60, v60, v28
MAV 84,52,220
TR 18,7,8960
MAV 68,52,216
TR 20,7,8480
v_accvgpr_read_b32 v29, a253
MAV 68,36,208
TR 22,7,8992
s_waitcnt lgkmcnt(8)
MAV 72,40,208
TR 8,7,64
v_add_f32 v61, v61, v29
MAV 72,56,216
TR 10,7,576
MAV 88,56,220
TR 12,7,96
v_accvgpr_read_b32 v28, a254
MAV 88,40,212
TR 14,7,608
v_add_f32 v62, v62, v28
MAV 92,44,212
TR 24,7,8512
MAV 92,60,220
TR 26,7,9024
v_accvgpr_read_b32 v29, a255
MAV 76,60,216
TR 28,7,8544
v_add_f32 v63, v63, v29
MAV 76,44,208
TR 30,7,9056
s_waitcnt lgkmcnt(8)
MAV 32,0,96
TR 32,7,16896
v_cvt_pk_bf16_f32 v232, v64, v65
MAV 32,16,104
TR 34,7,17408
v_cvt_pk_bf16_f32 v233, v66, v67
v_cvt_pk_bf16_f32 v234, v68, v69
MAV 48,16,108
TR 36,7,16928
v_cvt_pk_bf16_f32 v235, v70, v71
MAV 48,0,100
TR 38,7,17440
buffer_store_dwordx4 v[232:235], v4, s[16:19], s69 offen sc1
s_add_u32 s69, s69, 131072
MAV 52,4,100
TR 48,7,25344
v_cvt_pk_bf16_f32 v236, v72, v73
MAV 52,20,108
TR 50,7,25856
v_cvt_pk_bf16_f32 v237, v74, v75
v_cvt_pk_bf16_f32 v238, v76, v77
MAV 36,20,104
TR 52,7,25376
v_cvt_pk_bf16_f32 v239, v78, v79
MAV 36,4,96
TR 54,7,25888
buffer_store_dwordx4 v[236:239], v4, s[16:19], s69 offen sc1
s_waitcnt lgkmcnt(8)
MAV 40,8,96
TR 40,7,16960
s_add_u32 s69, s69, -130048
MAV 40,24,104
TR 42,7,17472
v_cvt_pk_bf16_f32 v240, v80, v81
v_cvt_pk_bf16_f32 v241, v82, v83
MAV 56,24,108
TR 44,7,16992
v_cvt_pk_bf16_f32 v242, v84, v85
MAV 56,8,100
TR 46,7,17504
v_cvt_pk_bf16_f32 v243, v86, v87
buffer_store_dwordx4 v[240:243], v4, s[16:19], s69 offen sc1
MAV 60,12,100
TR 56,7,25408
s_add_u32 s69, s69, 131072
MAV 60,28,108
TR 58,7,25920
v_cvt_pk_bf16_f32 v244, v88, v89
v_cvt_pk_bf16_f32 v245, v90, v91
MAV 44,28,104
TR 60,7,25440
v_cvt_pk_bf16_f32 v246, v92, v93
MAV 44,12,96
TR 62,7,25952
v_cvt_pk_bf16_f32 v247, v94, v95
buffer_store_dwordx4 v[244:247], v4, s[16:19], s69 offen sc1
s_waitcnt lgkmcnt(8)
MAV 32,32,112
TR 0,7,33792
MAV 32,48,120
TR 2,7,34304
MAV 48,48,124
TR 4,7,33824
MAV 48,32,116
TR 6,7,34336
MAV 52,36,116
TR 16,7,42240
MAV 52,52,124
TR 18,7,42752
MAV 36,52,120
TR 20,7,42272
MAV 36,36,112
TR 22,7,42784
s_waitcnt lgkmcnt(8)
MAV 40,40,112
TR 8,7,33856
MAV 40,56,120
TR 10,7,34368
MAV 56,56,124
TR 12,7,33888
MAV 56,40,116
TR 14,7,34400
MAV 60,44,116
TR 24,7,42304
MAV 60,60,124
TR 26,7,42816
MAV 44,60,120
TR 28,7,42336
MAV 44,44,112
TR 30,7,42848
s_waitcnt lgkmcnt(8)
MAV 32,0,128
TR 32,7,50688
MAV 32,16,136
TR 34,7,51200
MAV 48,16,140
TR 36,7,50720
MAV 48,0,132
TR 38,7,51232
MAV 52,4,132
TR 48,7,59136
MAV 52,20,140
TR 50,7,59648
MAV 36,20,136
TR 52,7,59168
MAV 36,4,128
TR 54,7,59680
s_waitcnt lgkmcnt(8)
MAV 40,8,128
TR 40,7,50752
MAV 40,24,136
TR 42,7,51264
MAV 56,24,140
TR 44,7,50784
MAV 56,8,132
TR 46,7,51296
MAV 60,12,132
TR 56,7,59200
MAV 60,28,140
TR 58,7,59712
MAV 44,28,136
TR 60,7,59232
MAV 44,12,128
TR 62,7,59744
v_add_u32 v7, s57, v7
s_waitcnt lgkmcnt(8)
MAV 32,32,144
ds_read_b64_tr_b16 a[0:1], v7
MAV 32,48,152
s_waitcnt vmcnt(0)
buffer_atomic_add v30, v26, s[16:19], s71 offen
MAV 48,48,156
TR 2,7,512
MAV 48,32,148
TR 4,7,32
TR 6,7,544
MAV 52,36,148
MAV 52,52,156
TR 16,7,8448
TR 18,7,8960
MAV 36,52,152
TR 20,7,8480
MAV 36,36,144
s_waitcnt lgkmcnt(7)
MAV 40,40,144
TR 22,7,8992
MAV 40,56,152
TR 8,7,64
TR 10,7,576
MAV 56,56,156
MAV 56,40,148
TR 12,7,96
TR 14,7,608
MAV 60,44,148
TR 24,7,8512
MAV 60,60,156
TR 26,7,9024
MAV 44,60,152
TR 28,7,8544
MAV 44,44,144
TR 30,7,9056
s_waitcnt lgkmcnt(8)
s_barrier
MAV 32,0,160
TR 32,7,16896
MAV 32,16,168
buffer_atomic_add v31, v26, s[16:19], s70 offen sc0
MAV 48,16,172
TR 34,7,17408
MAV 48,0,164
TR 36,7,16928
TR 38,7,17440
MAV 52,4,164
MAV 52,20,172
TR 48,7,25344
TR 50,7,25856
MAV 36,20,168
TR 52,7,25376
MAV 36,4,160
s_waitcnt lgkmcnt(7)
MAV 40,8,160
TR 54,7,25888
MAV 40,24,168
TR 40,7,16960
TR 42,7,17472
MAV 56,24,172
MAV 56,8,164
TR 44,7,16992
TR 46,7,17504
MAV 60,12,164
TR 56,7,25408
MAV 60,28,172
TR 58,7,25920
MAV 44,28,168
TR 60,7,25440
MAV 44,12,160
TR 62,7,25952
s_waitcnt lgkmcnt(8)
MAV 32,32,176
TR 0,7,33792
MAV 32,48,184
TR 2,7,34304
MAV 48,48,188
TR 4,7,33824
MAV 48,32,180
TR 6,7,34336
MAV 52,36,180
TR 16,7,42240
MAV 52,52,188
TR 18,7,42752
MAV 36,52,184
TR 20,7,42272
MAV 36,36,176
TR 22,7,42784
s_waitcnt lgkmcnt(8)
MAV 40,40,176
TR 8,7,33856
MAV 40,56,184
TR 10,7,34368
MAV 56,56,188
TR 12,7,33888
MAV 56,40,180
TR 14,7,34400
MAV 60,44,180
TR 24,7,42304
MAV 60,60,188
TR 26,7,42816
MAV 44,60,184
TR 28,7,42336
MAV 44,44,176
TR 30,7,42848
s_waitcnt vmcnt(0)
v_cmp_le_u32 vcc, 1, v31
s_nop 0
s_cbranch_vccnz .Lxs51
s_mov_b32 s15, 0
.Lxs51l:
v_mov_b32 v31, 0
buffer_atomic_add v31, v26, s[16:19], s70 offen sc0
s_add_u32 s15, s15, 1
s_cmp_gt_u32 s15, 100000
s_waitcnt vmcnt(0)
s_cbranch_scc1 .Lxs51
v_cmp_le_u32 vcc, 1, v31
s_nop 0
s_cbranch_vccz .Lxs51l
.Lxs51:
s_waitcnt lgkmcnt(8)
MAV 32,0,192
TR 32,7,50688
MAV 32,16,200
buffer_load_dwordx4 v[232:235], v4, s[16:19], s68 offen sc1
MAV 48,16,204
TR 34,7,51200
s_add_u32 s68, s68, 131072
MAV 48,0,196
TR 36,7,50720
TR 38,7,51232
MAV 52,4,196
TR 48,7,59136
MAV 52,20,204
buffer_load_dwordx4 v[236:239], v4, s[16:19], s68 offen sc1
MAV 36,20,200
TR 50,7,59648
s_add_u32 s68, s68, -130048
MAV 36,4,192
TR 52,7,59168
TR 54,7,59680
s_waitcnt lgkmcnt(8)
MAV 40,8,192
TR 40,7,50752
MAV 40,24,200
buffer_load_dwordx4 v[240:243], v4, s[16:19], s68 offen sc1
MAV 56,24,204
TR 42,7,51264
s_add_u32 s68, s68, 131072
MAV 56,8,196
TR 44,7,50784
TR 46,7,51296
MAV 60,12,196
TR 56,7,59200
MAV 60,28,204
buffer_load_dwordx4 v[244:247], v4, s[16:19], s68 offen sc1
MAV 44,28,200
TR 58,7,59712
MAV 44,12,192
TR 60,7,59232
TR 62,7,59744
s_waitcnt lgkmcnt(8)
MAV 32,32,208
MAV 32,48,216
MAV 48,48,220
MAV 48,32,212
MAV 52,36,212
MAV 52,52,220
MAV 36,52,216
MAV 36,36,208
s_waitcnt lgkmcnt(0)
MAV 40,40,208
MAV 40,56,216
MAV 56,56,220
MAV 56,40,212
MAV 60,44,212
MAV 60,60,220
MAV 44,60,216
MAV 44,44,208
s_waitcnt vmcnt(3)
v_mfma_f32_16x16x32_bf16 v[32:35], v[226:229], v[232:235], v[32:35]
s_lshl_b32 s64, s6, 14
s_lshl_b32 s65, s49, 13
s_add_u32 s64, s64, s65
v_mfma_f32_16x16x32_bf16 v[36:39], v[224:227], v[232:235], v[36:39]
s_lshl_b32 s65, s7, 9
s_add_u32 s64, s64, s65
s_lshl_b32 s65, s48, 8
s_waitcnt vmcnt(2)
v_mfma_f32_16x16x32_bf16 v[40:43], v[226:229], v[236:239], v[40:43]
s_add_u32 s64, s64, s65
s_add_u32 s64, s64, 62914560
v_and_b32 v152, 31, v1
v_mfma_f32_16x16x32_bf16 v[44:47], v[224:227], v[236:239], v[44:47]
s_lshl_b32 s62, s7, 18
v_lshlrev_b32 v152, 3, v152
v_lshrrev_b32 v153, 5, v1
s_waitcnt vmcnt(1)
v_mfma_f32_16x16x32_bf16 v[48:51], v[226:229], v[240:243], v[48:51]
s_add_u32 s62, s62, 33554432
v_lshl_add_u32 v152, v153, 28, v152
s_add_u32 s63, s62, 131072
v_mfma_f32_16x16x32_bf16 v[52:55], v[224:227], v[240:243], v[52:55]
v_cvt_pk_bf16_f32 v128, v32, v33
v_cvt_pk_bf16_f32 v129, v34, v35
s_waitcnt vmcnt(0)
v_mfma_f32_16x16x32_bf16 v[56:59], v[226:229], v[244:247], v[56:59]
v_cvt_pk_bf16_f32 v130, v36, v37
v_cvt_pk_bf16_f32 v131, v38, v39
v_mfma_f32_16x16x32_bf16 v[60:63], v[224:227], v[244:247], v[60:63]
buffer_store_dwordx4 v[128:131], v4, s[16:19], s62 offen sc1
v_cvt_pk_bf16_f32 v132, v40, v41
v_cvt_pk_bf16_f32 v133, v42, v43
v_cvt_pk_bf16_f32 v134, v44, v45
v_cvt_pk_bf16_f32 v135, v46, v47
v_cvt_pk_bf16_f32 v136, v48, v49
v_cvt_pk_bf16_f32 v137, v50, v51
v_cvt_pk_bf16_f32 v138, v52, v53
v_cvt_pk_bf16_f32 v139, v54, v55
v_cvt_pk_bf16_f32 v140, v56, v57
v_cvt_pk_bf16_f32 v141, v58, v59
v_cvt_pk_bf16_f32 v142, v60, v61
v_cvt_pk_bf16_f32 v143, v62, v63
v_pk_mul_f32 v[146:147], v[32:33], v[32:33]
buffer_store_dwordx4 v[132:135], v4, s[16:19], s63 offen sc1
v_pk_mul_f32 v[150:151], v[48:49], v[48:49]
v_pk_fma_f32 v[146:147], v[34:35], v[34:35], v[146:147]
v_pk_add_f32 v[144:145], v[32:33], v[34:35]
v_pk_fma_f32 v[150:151], v[50:51], v[50:51], v[150:151]
v_pk_add_f32 v[148:149], v[48:49], v[50:51]
v_pk_fma_f32 v[146:147], v[36:37], v[36:37], v[146:147]
v_pk_add_f32 v[144:145], v[144:145], v[36:37]
v_pk_fma_f32 v[150:151], v[52:53], v[52:53], v[150:151]
v_pk_add_f32 v[148:149], v[148:149], v[52:53]
v_pk_fma_f32 v[146:147], v[38:39], v[38:39], v[146:147]
v_pk_add_f32 v[144:145], v[144:145], v[38:39]
v_pk_fma_f32 v[150:151], v[54:55], v[54:55], v[150:151]
v_pk_add_f32 v[148:149], v[148:149], v[54:55]
buffer_store_dwordx4 v[136:139], v4, s[16:19], s62 offen offset:1024 sc1
v_pk_fma_f32 v[146:147], v[40:41], v[40:41], v[146:147]
v_pk_add_f32 v[144:145], v[144:145], v[40:41]
v_pk_fma_f32 v[150:151], v[56:57], v[56:57], v[150:151]
v_pk_add_f32 v[148:149], v[148:149], v[56:57]
v_pk_fma_f32 v[146:147], v[42:43], v[42:43], v[146:147]
v_pk_add_f32 v[144:145], v[144:145], v[42:43]
v_pk_fma_f32 v[150:151], v[58:59], v[58:59], v[150:151]
v_pk_add_f32 v[148:149], v[148:149], v[58:59]
v_pk_fma_f32 v[146:147], v[44:45], v[44:45], v[146:147]
v_pk_add_f32 v[144:145], v[144:145], v[44:45]
v_pk_fma_f32 v[150:151], v[60:61], v[60:61], v[150:151]
v_pk_add_f32 v[148:149], v[148:149], v[60:61]
v_pk_fma_f32 v[146:147], v[46:47], v[46:47], v[146:147]
buffer_store_dwordx4 v[140:143], v4, s[16:19], s63 offen offset:1024 sc1
v_pk_add_f32 v[144:145], v[144:145], v[46:47]
v_pk_fma_f32 v[150:151], v[62:63], v[62:63], v[150:151]
v_pk_add_f32 v[148:149], v[148:149], v[62:63]
v_add_f32 v144, v144, v145
v_add_f32 v146, v146, v147
v_add_f32 v148, v148, v149
v_add_f32 v150, v150, v151
s_nop 0
v_permlane16_swap_b32 v144, v148
v_permlane16_swap_b32 v146, v150
v_add_f32 v144, v144, v148
v_add_f32 v146, v146, v150
s_nop 1
v_permlane32_swap_b32 v144, v146
v_add_f32 v144, v144, v146
s_nop 1
v_permlane32_swap_b32 v144, v145
buffer_store_dwordx2 v[144:145], v152, s[16:19], s64 offen sc1
s_nop 1
s_mov_b32 s54, s58
s_mov_b32 s56, s59
v_accvgpr_write_b32 a224, v32
v_accvgpr_write_b32 a225, v33
v_accvgpr_write_b32 a226, v34
v_accvgpr_write_b32 a227, v35
v_accvgpr_write_b32 a228, v36
v_accvgpr_write_b32 a229, v37
v_accvgpr_write_b32 a230, v38
v_accvgpr_write_b32 a231, v39
v_accvgpr_write_b32 a232, v40
v_accvgpr_write_b32 a233, v41
v_accvgpr_write_b32 a234, v42
v_accvgpr_write_b32 a235, v43
v_accvgpr_write_b32 a236, v44
v_accvgpr_write_b32 a237, v45
v_accvgpr_write_b32 a238, v46
v_accvgpr_write_b32 a239, v47
v_accvgpr_write_b32 a240, v48
v_accvgpr_write_b32 a241, v49
v_accvgpr_write_b32 a242, v50
v_accvgpr_write_b32 a243, v51
v_accvgpr_write_b32 a244, v52
v_accvgpr_write_b32 a245, v53
v_accvgpr_write_b32 a246, v54
v_accvgpr_write_b32 a247, v55
v_accvgpr_write_b32 a248, v56
v_accvgpr_write_b32 a249, v57
v_accvgpr_write_b32 a250, v58
v_accvgpr_write_b32 a251, v59
v_accvgpr_write_b32 a252, v60
v_accvgpr_write_b32 a253, v61
v_accvgpr_write_b32 a254, v62
v_accvgpr_write_b32 a255, v63
s_lshl_b32 s62, s3, 11
s_add_u32 s62, s62, s85
v_lshl_add_u32 v21, v1, 4, s62
v_lshrrev_b32 v2, 3, v1
v_cmp_eq_u32 vcc, 3, v2
v_add_u32 v2, 67108480, v21
s_nop 0
v_cndmask_b32 v21, v21, v2, vcc
s_sub_u32 s62, s86, 2048
v_lshl_add_u32 v22, v0, 2, s62
.Lpad22:
s_cbranch_execz .Lnopoll37r
v_lshrrev_b32 v2, 5, v0
v_cmp_eq_u32 vcc, 3, v2
v_add_u32 v2, 67108480, v22
s_nop 0
v_cndmask_b32 v22, v22, v2, vcc
s_mul_i32 s62, s48, 4608
v_lshl_add_u32 v23, v1, 4, s62
v_lshrrev_b32 v24, 4, v1
v_mul_u32_u24 v24, 2304, v24
v_and_b32 v2, 15, v1
v_lshl_add_u32 v24, v2, 4, v24
s_mov_b32 s52, 33554432
s_mul_i32 s55, s3, 2304
v_bfe_u32 v25, v1, 3, 2
v_mul_u32_u24 v25, 3104, v25
v_bfe_u32 v2, v1, 2, 1
v_lshl_add_u32 v25, v2, 7, v25
v_bfe_u32 v2, v1, 5, 1
v_lshl_add_u32 v25, v2, 8, v25
v_and_b32 v2, 3, v1
v_lshl_add_u32 v25, v2, 3, v25
s_lshl_b32 s62, s49, 6
s_add_u32 s62, s62, 67584
v_add_u32 v25, s62, v25
s_lshl_b32 s62, s8, 1
s_add_u32 s62, s62, s3
s_lshr_b32 s63, s50, 2
s_cmp_lt_u32 s3, 2
s_cselect_b32 s62, s62, s63
s_lshl_b32 s62, s62, 13
s_cmp_eq_u32 s3, 3
s_cselect_b32 s62, 268435456, s62
v_lshl_add_u32 v26, v1, 4, s62
s_lshr_b32 s63, s20, 7
s_sub_u32 s63, 3, s63
s_and_b32 s63, s63, 7
s_and_b32 s62, s9, 8
s_add_u32 s63, s63, s62
s_lshl_b32 s62, s5, 2
s_add_u32 s62, s62, s3
s_mul_i32 s62, s62, 12288
s_lshl_b32 s64, s63, 7
s_add_u32 s62, s62, s64
s_xor_b32 s63, s63, s9
s_cmp_lt_u32 s63, 4
s_cselect_b32 s62, s62, 16777216
v_lshrrev_b32 v14, 3, v1
v_min_u32 v14, 5, v14
v_lshl_add_u32 v14, v14, 11, s62
s_mov_b32 s44, 983040
buffer_load_dword v27, v14, s[20:23], s44 offen
s_mov_b32 s44, 2555904
s_mul_i32 s59, s3, 2080
s_and_b32 s87, s6, 3
s_lshl_b32 s87, s87, 17
v_bfe_u32 v5, v1, 3, 1
v_lshrrev_b32 v2, 4, v1
v_lshl_add_u32 v5, v2, 3, v5
s_lshl_b32 s62, s3, 1
v_add_u32 v5, s62, v5
v_mul_u32_u24 v5, 2048, v5
v_and_b32 v2, 7, v1
v_lshl_add_u32 v5, v2, 4, v5
s_lshl_b32 s62, s7, 7
v_add_u32 v5, s62, v5
v_add_u32 v6, 64512, v5
s_lshl_b32 s62, s6, 10
s_add_u32 s62, s62, 30474240
s_lshl_b32 s64, s8, 10
s_add_u32 s64, s64, 30474240
s_lshr_b32 s67, s9, 1
s_and_b32 s67, s67, 3
s_lshl_b32 s67, s67, 7
s_add_u32 s64, s64, s67
s_lshr_b32 s65, s50, 3
s_lshl_b32 s65, s65, 10
s_add_u32 s65, s65, 30474240
s_lshr_b32 s67, s9, 1
s_and_b32 s67, s67, 3
s_lshl_b32 s67, s67, 7
s_add_u32 s65, s65, s67
v_lshl_add_u32 v252, v1, 7, s62
v_mov_b32 v253, s64
v_mov_b32 v255, 1
v_writelane_b32 v253, s65, 1
s_waitcnt vmcnt(1) lgkmcnt(0)
s_cmp_lg_u32 s3, 1
s_barrier
s_cbranch_scc1 .Lfirst54
s_mov_b64 exec, 15
buffer_atomic_add v255, v252, s[16:19], 0 offen
s_mov_b64 exec, 3
v_mov_b32 v254, 0
buffer_atomic_add v254, v253, s[16:19], 0 offen sc0
s_mov_b64 exec, -1
.Lfirst54:
s_add_u32 m0, s56, 117248
s_nop 0
buffer_load_dwordx4 v18, s[20:23], s54 offen lds
v_lshrrev_b32 v2, 4, v1
v_lshlrev_b32 v2, 2, v2
v_and_b32 v13, 15, v1
v_sub_u32 v2, v13, v2
v_mov_b32 v13, 0xff61b1e6
v_subrev_u32 v54, 0, v2
v_cmp_gt_u32 vcc, 8, v54
s_nop 1
v_cndmask_b32 v50, v13, 0, vcc
buffer_load_dwordx4 v19, s[20:23], s54 offen offset:1024 lds
v_cmp_gt_i32 vcc, -8, v54
s_nop 1
v_cndmask_b32 v46, v13, 0, vcc
v_subrev_u32 v54, 1, v2
v_cmp_gt_u32 vcc, 8, v54
s_nop 1
v_cndmask_b32 v51, v13, 0, vcc
v_cmp_gt_i32 vcc, -8, v54
s_nop 1
v_cndmask_b32 v47, v13, 0, vcc
v_subrev_u32 v54, 2, v2
buffer_load_dwordx4 v20, s[20:23], s54 offen offset:2048 lds
s_add_u32 s54, s54, 196608
v_cmp_gt_u32 vcc, 8, v54
s_nop 1
v_cndmask_b32 v52, v13, 0, vcc
v_cmp_gt_i32 vcc, -8, v54
s_nop 1
v_cndmask_b32 v48, v13, 0, vcc
v_subrev_u32 v54, 3, v2
v_cmp_gt_u32 vcc, 8, v54
s_nop 1
v_cndmask_b32 v53, v13, 0, vcc
v_cmp_gt_i32 vcc, -8, v54
s_add_u32 m0, s56, 129664
s_nop 0
buffer_load_dwordx4 v18, s[20:23], s54 offen lds
v_cndmask_b32 v49, v13, 0, vcc
s_cmp_lt_u32 s8, 2
s_cselect_b64 vcc, -1, 0
v_cndmask_b32 v54, v46, v13, vcc
v_cndmask_b32 v55, v47, v13, vcc
v_cndmask_b32 v56, v48, v13, vcc
v_cndmask_b32 v57, v49, v13, vcc
v_mov_b64 v[60:61], 0
buffer_load_dwordx4 v19, s[20:23], s54 offen offset:1024 lds
v_mov_b64 v[62:63], 0
v_mov_b64 v[64:65], 0
v_mov_b64 v[66:67], 0
v_mov_b64 v[68:69], 0
v_mov_b64 v[70:71], 0
v_mov_b64 v[72:73], 0
v_mov_b64 v[74:75], 0
v_mov_b64 v[76:77], 0
buffer_load_dwordx4 v20, s[20:23], s54 offen offset:2048 lds
s_add_u32 s54, s54, 196608
v_mov_b64 v[78:79], 0
v_mov_b64 v[80:81], 0
v_mov_b64 v[82:83], 0
v_mov_b64 v[84:85], 0
v_mov_b64 v[86:87], 0
v_mov_b64 v[88:89], 0
v_mov_b64 v[90:91], 0
v_mov_b64 v[92:93], 0
s_add_u32 m0, s56, 67584
s_nop 0
buffer_load_dwordx4 v18, s[20:23], s54 offen lds
v_mov_b64 v[94:95], 0
v_mov_b64 v[96:97], 0
v_mov_b64 v[98:99], 0
v_mov_b64 v[100:101], 0
v_mov_b64 v[102:103], 0
v_mov_b64 v[104:105], 0
v_mov_b64 v[106:107], 0
v_mov_b64 v[108:109], 0
buffer_load_dwordx4 v19, s[20:23], s54 offen offset:1024 lds
v_mov_b64 v[110:111], 0
v_mov_b64 v[112:113], 0
v_mov_b64 v[114:115], 0
v_mov_b64 v[116:117], 0
v_mov_b64 v[118:119], 0
v_mov_b64 v[120:121], 0
v_mov_b64 v[122:123], 0
v_mov_b64 v[124:125], 0
buffer_load_dwordx4 v20, s[20:23], s54 offen offset:2048 lds
s_add_u32 s54, s54, 196608
v_mov_b64 v[126:127], 0
v_mov_b64 v[128:129], 0
v_mov_b64 v[130:131], 0
v_mov_b64 v[132:133], 0
v_mov_b64 v[134:135], 0
v_mov_b64 v[136:137], 0
v_mov_b64 v[138:139], 0
v_mov_b64 v[140:141], 0
s_add_u32 m0, s56, 80000
s_nop 0
buffer_load_dwordx4 v18, s[20:23], s54 offen lds
v_mov_b64 v[142:143], 0
v_mov_b64 v[144:145], 0
v_mov_b64 v[146:147], 0
v_mov_b64 v[148:149], 0
v_mov_b64 v[150:151], 0
v_mov_b64 v[152:153], 0
v_mov_b64 v[154:155], 0
v_mov_b64 v[156:157], 0
buffer_load_dwordx4 v19, s[20:23], s54 offen offset:1024 lds
v_mov_b64 v[158:159], 0
v_mov_b64 v[160:161], 0
v_mov_b64 v[162:163], 0
v_mov_b64 v[164:165], 0
v_mov_b64 v[166:167], 0
v_mov_b64 v[168:169], 0
v_mov_b64 v[170:171], 0
v_mov_b64 v[172:173], 0
buffer_load_dwordx4 v20, s[20:23], s54 offen offset:2048 lds
s_add_u32 s54, s54, 196608
v_mov_b64 v[174:175], 0
s_mov_b32 s75, 62914560
v_and_b32 v10, 15, v1
v_lshlrev_b32 v12, 2, v10
v_lshlrev_b32 v10, 4, v10
v_add_u32 v10, 152576, v10
v_lshrrev_b32 v11, 4, v1
v_lshlrev_b32 v11, 4, v11
s_add_u32 m0, s56, 92416
s_nop 0
buffer_load_dwordx4 v18, s[20:23], s54 offen lds
s_lshl_b32 s62, s49, 7
s_add_u32 s62, s62, 158720
v_add_u32 v12, s62, v12
v_add_u32 v13, s62, v11
v_add_u32 v11, 156672, v11
s_lshl_b32 s62, s3, 11
s_add_u32 s62, s62, 143360
v_lshl_add_u32 v8, v1, 4, s62
buffer_load_dwordx4 v19, s[20:23], s54 offen offset:1024 lds
v_xor_b32 v9, 2048, v8
v_mov_b32 v248, 0x3f803f80
v_mov_b32 v249, 0x3f803f80
v_mov_b32 v250, 0x3f803f80
v_mov_b32 v251, 0x3f803f80
v_and_b32 v7, 31, v1
v_lshrrev_b32 v2, 5, v1
v_lshl_add_u32 v7, v7, 1, v2
buffer_load_dwordx4 v20, s[20:23], s54 offen offset:2048 lds
s_add_u32 s54, s54, 196608
v_and_b32 v2, 0xc0, v0
v_add_u32 v7, v7, v2
v_lshlrev_b32 v17, 2, v7
v_add_u32 v17, 156672, v17
v_lshlrev_b32 v7, 4, v7
v_add_u32 v7, 152576, v7
s_lshl_b32 s74, s9, 1
s_add_u32 s74, s74, s49
s_lshl_b32 s74, s74, 17
s_add_u32 s74, s74, s85
s_lshl_b32 s63, s48, 12
s_add_u32 s74, s74, s63
s_add_u32 s74, s74, 37748736
s_mov_b32 s62, 0
v_lshl_add_u32 v4, v1, 4, s62
v_lshrrev_b32 v2, 3, v1
v_cmp_eq_u32 vcc, 3, v2
v_add_u32 v2, 67108480, v4
s_nop 0
v_cndmask_b32 v4, v4, v2, vcc
s_cmp_lg_u32 s3, 1
s_cbranch_scc1 .Lnopoll53
s_mov_b64 exec, 3
s_mov_b32 s15, 0
v_mov_b32 v255, 0
buffer_atomic_add v255, v253, s[16:19], 0 offen sc0
s_waitcnt vmcnt(16)
v_cmp_gt_u32 vcc, 16, v254
s_nop 0
s_cbranch_vccz .Lnopoll53r
.Lpoll52:
s_waitcnt vmcnt(0)
v_cmp_gt_u32 vcc, 16, v255
s_add_u32 s15, s15, 1
s_cbranch_vccz .Lnopoll53r
v_mov_b32 v255, 0
buffer_atomic_add v255, v253, s[16:19], 0 offen sc0
s_cmp_le_u32 s15, 100000
s_cbranch_scc1 .Lpoll52
s_branch .Lnopoll53r
.Lnopoll53:
s_mov_b64 exec, 0
s_cmp_eq_u32 s3, 2
s_cbranch_scc1 .Lpad23
s_cmp_eq_u32 s3, 3
s_cbranch_scc1 .Lpad24
s_branch .Lpad25
.Lnopoll53r:
s_mov_b64 exec, -1
s_waitcnt vmcnt(9)
s_barrier
s_cmp_eq_u32 s48, 1
s_cbranch_scc1 .Lqkv55
s_add_u32 m0, s55, 36864
s_nop 0
buffer_load_dwordx4 v21, s[16:19], s52 offen sc1 lds
buffer_load_dwordx4 v21, s[16:19], s52 offen offset:1024 sc1 lds
buffer_load_dword v22, s[16:19], s52 offen offset:2048 sc1 lds
s_add_u32 s52, s52, 131072
TR 80,25,49664
TR 82,25,50176
TR 84,25,62080
s_add_u32 m0, s55, 46080
s_nop 0
buffer_load_dwordx4 v21, s[16:19], s52 offen sc1 lds
buffer_load_dwordx4 v21, s[16:19], s52 offen offset:1024 sc1 lds
buffer_load_dword v22, s[16:19], s52 offen offset:2048 sc1 lds
s_add_u32 s52, s52, 131072
TR 86,25,62592
TR 88,25,50688
TR 90,25,51200
s_add_u32 m0, s55, 0
s_nop 0
buffer_load_dwordx4 v21, s[16:19], s52 offen sc1 lds
buffer_load_dwordx4 v21, s[16:19], s52 offen offset:1024 sc1 lds
buffer_load_dword v22, s[16:19], s52 offen offset:2048 sc1 lds
s_add_u32 s52, s52, 131072
TR 92,25,63104
TR 94,25,63616
TR 96,25,51712
s_add_u32 m0, s55, 9216
s_nop 0
buffer_load_dwordx4 v21, s[16:19], s52 offen sc1 lds
buffer_load_dwordx4 v21, s[16:19], s52 offen offset:1024 sc1 lds
buffer_load_dword v22, s[16:19], s52 offen offset:2048 sc1 lds
s_add_u32 s52, s52, 131072
TR 98,25,52224
TR 100,25,64128
TR 102,25,64640
s_add_u32 m0, s55, 18432
s_nop 0
buffer_load_dwordx4 v21, s[16:19], s52 offen sc1 lds
buffer_load_dwordx4 v21, s[16:19], s52 offen offset:1024 sc1 lds
buffer_load_dword v22, s[16:19], s52 offen offset:2048 sc1 lds
s_add_u32 s52, s52, 131072
ds_read_b128 v[28:31], v13
ds_read_b128 v[32:35], v13 offset:64
ds_read_b128 v[36:39], v13 offset:256
s_add_u32 m0, s55, 27648
s_nop 0
buffer_load_dwordx4 v21, s[16:19], s52 offen sc1 lds
buffer_load_dwordx4 v21, s[16:19], s52 offen offset:1024 sc1 lds
buffer_load_dword v22, s[16:19], s52 offen offset:2048 sc1 lds
s_add_u32 s52, s52, 131072
ds_read_b128 v[40:43], v13 offset:320
ds_read_b32 v44, v12 offset:512
ds_read_b32 v45, v12 offset:576
s_waitcnt vmcnt(12)
s_barrier
RD 0,23,36864
RD 4,23,37888
RD 8,23,39168
RD 12,23,40192
RD 16,24,38912
RD 20,23,46080
RD 24,23,47104
RD 28,23,48384
RD 32,23,49408
RD 36,24,48128
s_waitcnt lgkmcnt(0)
s_mov_b32 s15, -2
.p2align 6
.Lk57:
s_waitcnt vmcnt(9) lgkmcnt(8)
s_barrier
MAA 60,80,0
TR 104,25,49696
s_add_u32 m0, s56, 104832
MAA 60,84,20
buffer_load_dwordx4 v18, s[20:23], s54 offen lds
MAA 64,84,24
TR 106,25,50208
v_add_f32 v164, v164, v168
MAA 64,80,4
TR 108,25,62112
MAA 68,80,8
TR 110,25,62624
MAA 68,84,28
buffer_load_dwordx4 v19, s[20:23], s54 offen offset:1024 lds
MAA 72,84,32
TR 112,25,50720
v_add_f32 v165, v165, v169
MAA 72,80,12
TR 114,25,51232
s_waitcnt lgkmcnt(6)
MAA 156,88,16
TR 116,25,63136
MAA 156,92,36
buffer_load_dwordx4 v20, s[20:23], s54 offen offset:2048 lds
MAA 104,92,32
s_add_u32 s54, s54, 196608
s_add_u32 m0, s55, 36864
MAA 104,88,12
buffer_load_dwordx4 v21, s[16:19], s52 offen sc1 lds
MAA 100,88,8
TR 118,25,63648
MAA 100,92,28
TR 120,25,51744
v_add_f32 v166, v166, v170
MAA 96,92,24
TR 122,25,52256
MAA 96,88,4
buffer_load_dwordx4 v21, s[16:19], s52 offen offset:1024 sc1 lds
MAA 92,88,0
TR 124,25,64160
MAA 92,92,20
TR 126,25,64672
v_add_f32 v167, v167, v171
MAA 124,20,100
ds_read_b128 a[40:43], v23
MAA 124,0,96
buffer_load_dword v22, s[16:19], s52 offen offset:2048 sc1 lds
MAA 128,4,96
RD 44,23,1024
s_add_u32 s52, s52, 131072
MAA 128,24,100
buffer_load_dword v27, v14, s[20:23], s44 offen
MAA 132,28,100
RD 48,23,2304
s_add_u32 s44, s44, 1572864
MAA 132,8,96
RD 52,23,3328
MAA 136,12,96
RD 56,24,2048
MAA 136,32,100
s_waitcnt vmcnt(13) lgkmcnt(5)
s_barrier
MAA 76,104,0
RD 60,23,9216
s_add_u32 m0, s56, 117248
MAA 76,108,20
buffer_load_dwordx4 v18, s[20:23], s54 offen lds
MAA 80,108,24
RD 64,23,10240
MAA 80,104,4
RD 68,23,11520
MAA 84,104,8
RD 72,23,12544
MAA 84,108,28
buffer_load_dwordx4 v19, s[20:23], s54 offen offset:1024 lds
MAA 88,108,32
RD 76,24,11264
MAA 88,104,12
buffer_load_dwordx4 v20, s[20:23], s54 offen offset:2048 lds
MAA 160,112,16
ds_read_b64_tr_b16 a[80:81], v25
s_add_u32 s54, s54, 196608
MAA 160,116,36
TR 82,25,512
MAA 120,116,32
TR 84,25,12416
s_add_u32 m0, s55, 46080
MAA 120,112,12
buffer_load_dwordx4 v21, s[16:19], s52 offen sc1 lds
MAA 116,112,8
TR 86,25,12928
MAA 116,116,28
TR 88,25,1024
MAA 112,116,24
TR 90,25,1536
MAA 112,112,4
buffer_load_dwordx4 v21, s[16:19], s52 offen offset:1024 sc1 lds
MAA 108,112,0
TR 92,25,13440
MAA 108,116,20
TR 94,25,13952
MAA 140,20,124
TR 96,25,2048
MAA 140,0,120
buffer_load_dword v22, s[16:19], s52 offen offset:2048 sc1 lds
MAA 144,4,120
TR 98,25,2560
s_add_u32 s52, s52, 131072
MAA 144,24,124
buffer_load_dwordx4 v[168:171], v26, s[16:19], s75 offen sc1
MAA 148,28,124
TR 100,25,14464
MAA 148,8,120
TR 102,25,14976
MAA 152,12,120
MAA 152,32,124
s_waitcnt vmcnt(17) lgkmcnt(8)
s_barrier
MAA 60,80,40
TR 104,25,32
s_add_u32 m0, s56, 129664
MAA 60,84,60
buffer_load_dwordx4 v18, s[20:23], s54 offen lds
MAA 64,84,64
TR 106,25,544
v_add_f32 v164, v164, v172
MAA 64,80,44
TR 108,25,12448
MAA 68,80,48
TR 110,25,12960
MAA 68,84,68
buffer_load_dwordx4 v19, s[20:23], s54 offen offset:1024 lds
MAA 72,84,72
TR 112,25,1056
MAA 72,80,52
TR 114,25,1568
s_waitcnt lgkmcnt(6)
MAA 156,88,56
TR 116,25,13472
v_add_f32 v165, v165, v173
MAA 156,92,76
buffer_load_dwordx4 v20, s[20:23], s54 offen offset:2048 lds
MAA 104,92,72
TR 118,25,13984
s_add_u32 s54, s54, 196608
MAA 104,88,52
TR 120,25,2080
MAA 100,88,48
s_add_u32 m0, s55, 0
MAA 100,92,68
buffer_load_dwordx4 v21, s[16:19], s52 offen sc1 lds
MAA 96,92,64
TR 122,25,2592
v_add_f32 v166, v166, v174
MAA 96,88,44
TR 124,25,14496
MAA 92,88,40
TR 126,25,15008
MAA 92,92,60
buffer_load_dwordx4 v21, s[16:19], s52 offen offset:1024 sc1 lds
MAA 124,60,100
RD 0,23,18432
MAA 124,40,96
RD 4,23,19456
v_add_f32 v167, v167, v175
MAA 128,44,96
RD 8,23,20736
MAA 128,64,100
buffer_load_dword v22, s[16:19], s52 offen offset:2048 sc1 lds
MAA 132,68,100
RD 12,23,21760
s_add_u32 s52, s52, 131072
MAA 132,48,96
RD 16,24,20480
MAA 136,52,96
MAA 136,72,100
s_waitcnt vmcnt(17) lgkmcnt(5)
s_barrier
MAA 76,104,40
RD 20,23,27648
s_add_u32 m0, s56, 67584
MAA 76,108,60
buffer_load_dwordx4 v18, s[20:23], s54 offen lds
MAA 80,108,64
RD 24,23,28672
MAA 80,104,44
RD 28,23,29952
MAA 84,104,48
RD 32,23,30976
MAA 84,108,68
buffer_load_dwordx4 v19, s[20:23], s54 offen offset:1024 lds
MAA 88,108,72
RD 36,24,29696
MAA 88,104,52
buffer_load_dwordx4 v20, s[20:23], s54 offen offset:2048 lds
MAA 160,112,56
TR 80,25,24832
s_add_u32 s54, s54, 196608
MAA 160,116,76
TR 82,25,25344
MAA 120,116,72
TR 84,25,37248
s_add_u32 m0, s55, 9216
MAA 120,112,52
buffer_load_dwordx4 v21, s[16:19], s52 offen sc1 lds
MAA 116,112,48
TR 86,25,37760
MAA 116,116,68
TR 88,25,25856
MAA 112,116,64
TR 90,25,26368
MAA 112,112,44
buffer_load_dwordx4 v21, s[16:19], s52 offen offset:1024 sc1 lds
MAA 108,112,40
TR 92,25,38272
MAA 108,116,60
TR 94,25,38784
MAA 140,60,124
TR 96,25,26880
MAA 140,40,120
buffer_load_dword v22, s[16:19], s52 offen offset:2048 sc1 lds
MAA 144,44,120
TR 98,25,27392
s_add_u32 s52, s52, 131072
MAA 144,64,124
buffer_load_dwordx4 v[172:175], v26, s[16:19], s75 offen offset:1024 sc1
MAA 148,68,124
TR 100,25,39296
s_add_u32 s75, s75, 2048
MAA 148,48,120
TR 102,25,39808
MAA 152,52,120
MAA 152,72,124
s_waitcnt vmcnt(21) lgkmcnt(8)
s_barrier
MAA 60,80,0
TR 104,25,24864
s_add_u32 m0, s56, 80000
MAA 60,84,20
buffer_load_dwordx4 v18, s[20:23], s54 offen lds
MAA 64,84,24
TR 106,25,25376
MAA 64,80,4
TR 108,25,37280
MAA 68,80,8
TR 110,25,37792
MAA 68,84,28
buffer_load_dwordx4 v19, s[20:23], s54 offen offset:1024 lds
MAA 72,84,32
TR 112,25,25888
MAA 72,80,12
TR 114,25,26400
s_waitcnt lgkmcnt(6)
MAA 156,88,16
TR 116,25,38304
MAA 156,92,36
buffer_load_dwordx4 v20, s[20:23], s54 offen offset:2048 lds
MAA 104,92,32
TR 118,25,38816
s_add_u32 s54, s54, 196608
MAA 104,88,12
TR 120,25,26912
MAA 100,88,8
s_add_u32 m0, s55, 18432
MAA 100,92,28
.Lpad23:
s_cbranch_execz .Lpad26
buffer_load_dwordx4 v21, s[16:19], s52 offen sc1 lds
MAA 96,92,24
TR 122,25,27424
MAA 96,88,4
TR 124,25,39328
MAA 92,88,0
TR 126,25,39840
MAA 92,92,20
buffer_load_dwordx4 v21, s[16:19], s52 offen offset:1024 sc1 lds
MAA 124,20,100
RD 40,23,36864
MAA 124,0,96
RD 44,23,37888
MAA 128,4,96
RD 48,23,39168
MAA 128,24,100
buffer_load_dword v22, s[16:19], s52 offen offset:2048 sc1 lds
MAA 132,28,100
RD 52,23,40192
s_add_u32 s52, s52, 131072
MAA 132,8,96
RD 56,24,38912
MAA 136,12,96
MAA 136,32,100
s_waitcnt vmcnt(16) lgkmcnt(5)
s_barrier
MAA 76,104,0
RD 60,23,46080
s_add_u32 m0, s56, 92416
MAA 76,108,20
buffer_load_dwordx4 v18, s[20:23], s54 offen lds
MAA 80,108,24
RD 64,23,47104
MAA 80,104,4
RD 68,23,48384
MAA 84,104,8
RD 72,23,49408
MAA 84,108,28
buffer_load_dwordx4 v19, s[20:23], s54 offen offset:1024 lds
MAA 88,108,32
RD 76,24,48128
MAA 88,104,12
TR 80,25,49664
MAA 160,112,16
TR 82,25,50176
MAA 160,116,36
buffer_load_dwordx4 v20, s[20:23], s54 offen offset:2048 lds
MAA 120,116,32
TR 84,25,62080
s_add_u32 s54, s54, 196608
MAA 120,112,12
TR 86,25,62592
MAA 116,112,8
s_add_u32 m0, s55, 27648
MAA 116,116,28
buffer_load_dwordx4 v21, s[16:19], s52 offen sc1 lds
MAA 112,116,24
TR 88,25,50688
MAA 112,112,4
TR 90,25,51200
MAA 108,112,0
TR 92,25,63104
MAA 108,116,20
buffer_load_dwordx4 v21, s[16:19], s52 offen offset:1024 sc1 lds
MAA 140,20,124
TR 94,25,63616
MAA 140,0,120
TR 96,25,51712
MAA 144,4,120
TR 98,25,52224
MAA 144,24,124
buffer_load_dword v22, s[16:19], s52 offen offset:2048 sc1 lds
MAA 148,28,124
TR 100,25,64128
s_add_u32 s52, s52, 131072
MAA 148,8,120
TR 102,25,64640
MAA 152,12,120
MAA 152,32,124
s_waitcnt vmcnt(19) lgkmcnt(8)
s_barrier
MAA 60,80,40
TR 104,25,49696
s_add_u32 m0, s56, 104832
MAA 60,84,60
buffer_load_dwordx4 v18, s[20:23], s54 offen lds
MAA 64,84,64
TR 106,25,50208
v_add_f32 v164, v164, v168
MAA 64,80,44
TR 108,25,62112
MAA 68,80,48
TR 110,25,62624
MAA 68,84,68
buffer_load_dwordx4 v19, s[20:23], s54 offen offset:1024 lds
MAA 72,84,72
TR 112,25,50720
v_add_f32 v165, v165, v169
MAA 72,80,52
TR 114,25,51232
s_waitcnt lgkmcnt(6)
MAA 156,88,56
TR 116,25,63136
MAA 156,92,76
buffer_load_dwordx4 v20, s[20:23], s54 offen offset:2048 lds
MAA 104,92,72
s_add_u32 s54, s54, 196608
s_add_u32 m0, s55, 36864
MAA 104,88,52
buffer_load_dwordx4 v21, s[16:19], s52 offen sc1 lds
MAA 100,88,48
TR 118,25,63648
MAA 100,92,68
TR 120,25,51744
v_add_f32 v166, v166, v170
MAA 96,92,64
TR 122,25,52256
MAA 96,88,44
buffer_load_dwordx4 v21, s[16:19], s52 offen offset:1024 sc1 lds
MAA 92,88,40
TR 124,25,64160
MAA 92,92,60
TR 126,25,64672
v_add_f32 v167, v167, v171
MAA 124,60,100
ds_read_b128 a[0:3], v23
MAA 124,40,96
buffer_load_dword v22, s[16:19], s52 offen offset:2048 sc1 lds
MAA 128,44,96
RD 4,23,1024
s_add_u32 s52, s52, 131072
MAA 128,64,100
buffer_load_dword v27, v14, s[20:23], s44 offen
MAA 132,68,100
RD 8,23,2304
s_add_u32 s44, s44, 1572864
MAA 132,48,96
RD 12,23,3328
MAA 136,52,96
RD 16,24,2048
MAA 136,72,100
s_waitcnt vmcnt(16) lgkmcnt(5)
s_barrier
MAA 76,104,40
RD 20,23,9216
s_add_u32 m0, s56, 117248
MAA 76,108,60
buffer_load_dwordx4 v18, s[20:23], s54 offen lds
MAA 80,108,64
RD 24,23,10240
MAA 80,104,44
RD 28,23,11520
MAA 84,104,48
RD 32,23,12544
MAA 84,108,68
buffer_load_dwordx4 v19, s[20:23], s54 offen offset:1024 lds
MAA 88,108,72
RD 36,24,11264
MAA 88,104,52
buffer_load_dwordx4 v20, s[20:23], s54 offen offset:2048 lds
MAA 160,112,56
ds_read_b64_tr_b16 a[80:81], v25
s_add_u32 s54, s54, 196608
MAA 160,116,76
TR 82,25,512
MAA 120,116,72
TR 84,25,12416
s_add_u32 m0, s55, 46080
MAA 120,112,52
buffer_load_dwordx4 v21, s[16:19], s52 offen sc1 lds
MAA 116,112,48
TR 86,25,12928
MAA 116,116,68
TR 88,25,1024
MAA 112,116,64
TR 90,25,1536
MAA 112,112,44
buffer_load_dwordx4 v21, s[16:19], s52 offen offset:1024 sc1 lds
MAA 108,112,40
TR 92,25,13440
MAA 108,116,60
TR 94,25,13952
MAA 140,60,124
TR 96,25,2048
MAA 140,40,120
buffer_load_dword v22, s[16:19], s52 offen offset:2048 sc1 lds
MAA 144,44,120
TR 98,25,2560
s_add_u32 s52, s52, 131072
MAA 144,64,124
buffer_load_dwordx4 v[168:171], v26, s[16:19], s75 offen sc1
MAA 148,68,124
TR 100,25,14464
MAA 148,48,120
TR 102,25,14976
MAA 152,52,120
MAA 152,72,124
s_waitcnt vmcnt(20) lgkmcnt(8)
s_barrier
MAA 60,80,0
TR 104,25,32
s_add_u32 m0, s56, 129664
MAA 60,84,20
buffer_load_dwordx4 v18, s[20:23], s54 offen lds
MAA 64,84,24
TR 106,25,544
v_add_f32 v164, v164, v172
MAA 64,80,4
TR 108,25,12448
MAA 68,80,8
TR 110,25,12960
MAA 68,84,28
buffer_load_dwordx4 v19, s[20:23], s54 offen offset:1024 lds
MAA 72,84,32
TR 112,25,1056
MAA 72,80,12
TR 114,25,1568
s_waitcnt lgkmcnt(6)
MAA 156,88,16
TR 116,25,13472
v_add_f32 v165, v165, v173
MAA 156,92,36
buffer_load_dwordx4 v20, s[20:23], s54 offen offset:2048 lds
MAA 104,92,32
TR 118,25,13984
s_add_u32 s54, s54, 196608
MAA 104,88,12
TR 120,25,2080
MAA 100,88,8
s_add_u32 m0, s55, 0
MAA 100,92,28
buffer_load_dwordx4 v21, s[16:19], s52 offen sc1 lds
MAA 96,92,24
TR 122,25,2592
v_add_f32 v166, v166, v174
MAA 96,88,4
TR 124,25,14496
MAA 92,88,0
TR 126,25,15008
MAA 92,92,20
buffer_load_dwordx4 v21, s[16:19], s52 offen offset:1024 sc1 lds
MAA 124,20,100
RD 40,23,18432
MAA 124,0,96
RD 44,23,19456
v_add_f32 v167, v167, v175
MAA 128,4,96
RD 48,23,20736
MAA 128,24,100
buffer_load_dword v22, s[16:19], s52 offen offset:2048 sc1 lds
MAA 132,28,100
RD 52,23,21760
s_add_u32 s52, s52, 131072
MAA 132,8,96
RD 56,24,20480
MAA 136,12,96
MAA 136,32,100
s_waitcnt vmcnt(17) lgkmcnt(5)
s_barrier
MAA 76,104,0
RD 60,23,27648
s_add_u32 m0, s56, 67584
MAA 76,108,20
buffer_load_dwordx4 v18, s[20:23], s54 offen lds
MAA 80,108,24
RD 64,23,28672
MAA 80,104,4
RD 68,23,29952
MAA 84,104,8
RD 72,23,30976
MAA 84,108,28
buffer_load_dwordx4 v19, s[20:23], s54 offen offset:1024 lds
MAA 88,108,32
RD 76,24,29696
MAA 88,104,12
buffer_load_dwordx4 v20, s[20:23], s54 offen offset:2048 lds
MAA 160,112,16
TR 80,25,24832
s_add_u32 s54, s54, 196608
MAA 160,116,36
TR 82,25,25344
MAA 120,116,32
TR 84,25,37248
s_add_u32 m0, s55, 9216
MAA 120,112,12
buffer_load_dwordx4 v21, s[16:19], s52 offen sc1 lds
MAA 116,112,8
TR 86,25,37760
MAA 116,116,28
TR 88,25,25856
MAA 112,116,24
TR 90,25,26368
MAA 112,112,4
buffer_load_dwordx4 v21, s[16:19], s52 offen offset:1024 sc1 lds
MAA 108,112,0
TR 92,25,38272
MAA 108,116,20
TR 94,25,38784
MAA 140,20,124
TR 96,25,26880
MAA 140,0,120
buffer_load_dword v22, s[16:19], s52 offen offset:2048 sc1 lds
MAA 144,4,120
TR 98,25,27392
s_add_u32 s52, s52, 131072
MAA 144,24,124
buffer_load_dwordx4 v[172:175], v26, s[16:19], s75 offen offset:1024 sc1
MAA 148,28,124
TR 100,25,39296
s_add_u32 s75, s75, 2048
MAA 148,8,120
TR 102,25,39808
MAA 152,12,120
MAA 152,32,124
s_waitcnt vmcnt(21) lgkmcnt(8)
s_barrier
MAA 60,80,40
TR 104,25,24864
s_add_u32 m0, s56, 80000
MAA 60,84,60
buffer_load_dwordx4 v18, s[20:23], s54 offen lds
MAA 64,84,64
TR 106,25,25376
MAA 64,80,44
TR 108,25,37280
MAA 68,80,48
TR 110,25,37792
MAA 68,84,68
buffer_load_dwordx4 v19, s[20:23], s54 offen offset:1024 lds
MAA 72,84,72
TR 112,25,25888
MAA 72,80,52
TR 114,25,26400
s_waitcnt lgkmcnt(6)
MAA 156,88,56
TR 116,25,38304
MAA 156,92,76
buffer_load_dwordx4 v20, s[20:23], s54 offen offset:2048 lds
MAA 104,92,72
TR 118,25,38816
s_add_u32 s54, s54, 196608
MAA 104,88,52
TR 120,25,26912
MAA 100,88,48
s_add_u32 m0, s55, 18432
MAA 100,92,68
buffer_load_dwordx4 v21, s[16:19], s52 offen sc1 lds
MAA 96,92,64
TR 122,25,27424
MAA 96,88,44
TR 124,25,39328
MAA 92,88,40
TR 126,25,39840
MAA 92,92,60
buffer_load_dwordx4 v21, s[16:19], s52 offen offset:1024 sc1 lds
MAA 124,60,100
RD 0,23,36864
MAA 124,40,96
RD 4,23,37888
MAA 128,44,96
RD 8,23,39168
MAA 128,64,100
buffer_load_dword v22, s[16:19], s52 offen offset:2048 sc1 lds
MAA 132,68,100
RD 12,23,40192
s_add_u32 s52, s52, 131072
MAA 132,48,96
RD 16,24,38912
MAA 136,52,96
MAA 136,72,100
s_waitcnt vmcnt(16) lgkmcnt(5)
s_barrier
MAA 76,104,40
RD 20,23,46080
s_add_u32 m0, s56, 92416
MAA 76,108,60
buffer_load_dwordx4 v18, s[20:23], s54 offen lds
MAA 80,108,64
RD 24,23,47104
MAA 80,104,44
RD 28,23,48384
MAA 84,104,48
RD 32,23,49408
MAA 84,108,68
buffer_load_dwordx4 v19, s[20:23], s54 offen offset:1024 lds
MAA 88,108,72
RD 36,24,48128
MAA 88,104,52
TR 80,25,49664
MAA 160,112,56
TR 82,25,50176
MAA 160,116,76
buffer_load_dwordx4 v20, s[20:23], s54 offen offset:2048 lds
MAA 120,116,72
TR 84,25,62080
s_add_u32 s54, s54, 196608
MAA 120,112,52
TR 86,25,62592
MAA 116,112,48
s_add_u32 m0, s55, 27648
MAA 116,116,68
buffer_load_dwordx4 v21, s[16:19], s52 offen sc1 lds
MAA 112,116,64
TR 88,25,50688
MAA 112,112,44
TR 90,25,51200
MAA 108,112,40
TR 92,25,63104
MAA 108,116,60
buffer_load_dwordx4 v21, s[16:19], s52 offen offset:1024 sc1 lds
MAA 140,60,124
TR 94,25,63616
MAA 140,40,120
TR 96,25,51712
MAA 144,44,120
TR 98,25,52224
MAA 144,64,124
buffer_load_dword v22, s[16:19], s52 offen offset:2048 sc1 lds
MAA 148,68,124
TR 100,25,64128
s_add_u32 s52, s52, 131072
MAA 148,48,120
TR 102,25,64640
MAA 152,52,120
s_add_u32 s15, s15, 1
MAA 152,72,124
s_cbranch_scc0 .Lk57
s_waitcnt vmcnt(19) lgkmcnt(8)
s_barrier
MAA 60,80,0
TR 104,25,49696
s_add_u32 m0, s56, 104832
MAA 60,84,20
buffer_load_dwordx4 v18, s[20:23], s54 offen lds
MAA 64,84,24
TR 106,25,50208
v_add_f32 v164, v164, v168
MAA 64,80,4
TR 108,25,62112
v_add_f32 v165, v165, v169
MAA 68,80,8
TR 110,25,62624
v_add_f32 v166, v166, v170
MAA 68,84,28
buffer_load_dwordx4 v19, s[20:23], s54 offen offset:1024 lds
MAA 72,84,32
TR 112,25,50720
v_add_f32 v167, v167, v171
MAA 72,80,12
TR 114,25,51232
s_waitcnt lgkmcnt(6)
MAA 156,88,16
TR 116,25,63136
MAA 156,92,36
buffer_load_dwordx4 v20, s[20:23], s54 offen offset:2048 lds
MAA 104,92,32
TR 118,25,63648
s_add_u32 s54, s54, 196608
MAA 104,88,12
TR 120,25,51744
s_add_u32 m0, s55, 36864
MAA 100,88,8
TR 122,25,52256
MAA 100,92,28
buffer_load_dwordx4 v21, s[16:19], s52 offen sc1 lds
MAA 96,92,24
TR 124,25,64160
MAA 96,88,4
TR 126,25,64672
MAA 92,88,0
ds_read_b128 a[40:43], v23
MAA 92,92,20
buffer_load_dwordx4 v21, s[16:19], s52 offen offset:1024 sc1 lds
MAA 124,20,100
RD 44,23,1024
MAA 124,0,96
RD 48,23,2304
MAA 128,4,96
RD 52,23,3328
MAA 128,24,100
buffer_load_dword v22, s[16:19], s52 offen offset:2048 sc1 lds
MAA 132,28,100
RD 56,24,2048
s_add_u32 s52, s52, 131072
MAA 132,8,96
MAA 136,12,96
MAA 136,32,100
s_waitcnt vmcnt(15) lgkmcnt(5)
s_barrier
MAA 76,104,0
RD 60,23,9216
s_add_u32 m0, s56, 117248
MAA 76,108,20
buffer_load_dwordx4 v18, s[20:23], s54 offen lds
MAA 80,108,24
RD 64,23,10240
v_add_f32 v164, v164, v172
MAA 80,104,4
RD 68,23,11520
v_add_f32 v165, v165, v173
MAA 84,104,8
RD 72,23,12544
v_add_f32 v166, v166, v174
MAA 84,108,28
buffer_load_dwordx4 v19, s[20:23], s54 offen offset:1024 lds
MAA 88,108,32
RD 76,24,11264
v_add_f32 v167, v167, v175
MAA 88,104,12
ds_read_b64_tr_b16 a[80:81], v25
MAA 160,112,16
TR 82,25,512
MAA 160,116,36
buffer_load_dwordx4 v20, s[20:23], s54 offen offset:2048 lds
MAA 120,116,32
TR 84,25,12416
s_add_u32 s54, s54, 196608
MAA 120,112,12
TR 86,25,12928
s_add_u32 m0, s55, 46080
MAA 116,112,8
TR 88,25,1024
MAA 116,116,28
buffer_load_dwordx4 v21, s[16:19], s52 offen sc1 lds
MAA 112,116,24
TR 90,25,1536
MAA 112,112,4
TR 92,25,13440
MAA 108,112,0
TR 94,25,13952
MAA 108,116,20
buffer_load_dwordx4 v21, s[16:19], s52 offen offset:1024 sc1 lds
.Lpad24:
s_cbranch_execz .Lpad27
MAA 140,20,124
TR 96,25,2048
MAA 140,0,120
TR 98,25,2560
MAA 144,4,120
TR 100,25,14464
MAA 144,24,124
buffer_load_dword v22, s[16:19], s52 offen offset:2048 sc1 lds
MAA 148,28,124
TR 102,25,14976
s_add_u32 s52, s52, 131072
MAA 148,8,120
v_permlane32_swap_b32 v164, v166
MAA 152,12,120
v_permlane32_swap_b32 v165, v167
MAA 152,32,124
s_waitcnt vmcnt(18) lgkmcnt(8)
s_barrier
MAA 60,80,40
TR 104,25,32
s_add_u32 m0, s56, 129664
MAA 60,84,60
buffer_load_dwordx4 v18, s[20:23], s54 offen lds
MAA 64,84,64
TR 106,25,544
v_add_f32 v164, v164, v166
MAA 64,80,44
TR 108,25,12448
v_add_f32 v165, v165, v167
MAA 68,80,48
buffer_load_dwordx4 v19, s[20:23], s54 offen offset:1024 lds
MAA 68,84,68
TR 110,25,12960
v_mul_f32 v164, 0xba800000, v164
MAA 72,84,72
TR 112,25,1056
v_mul_f32 v165, 0x3a800000, v165
MAA 72,80,52
buffer_load_dwordx4 v20, s[20:23], s54 offen offset:2048 lds
s_waitcnt lgkmcnt(5)
MAA 156,88,56
TR 114,25,1568
s_add_u32 s54, s54, 196608
MAA 156,92,76
TR 116,25,13472
s_add_u32 m0, s59, 58240
MAA 104,92,72
TR 118,25,13984
s_xor_b32 s58, s87, 1966080
MAA 104,88,52
buffer_load_dwordx4 v5, s[24:27], s58 offen lds
MAA 100,88,48
TR 120,25,2080
v_fma_f32 v165, -v164, v164, v165
MAA 100,92,68
TR 122,25,2592
v_max_f32 v165, 0, v165
MAA 96,92,64
buffer_load_dwordx4 v6, s[24:27], s58 offen offset:1024 lds
MAA 96,88,44
TR 124,25,14496
s_add_u32 m0, s59, 0
MAA 92,88,40
TR 126,25,15008
s_xor_b32 s58, s87, 1048576
MAA 92,92,60
buffer_load_dwordx4 v5, s[24:27], s58 offen lds
MAA 124,60,100
RD 0,23,18432
v_add_f32 v165, 0x3727c5ac, v165
MAA 124,40,96
RD 4,23,19456
MAA 128,44,96
buffer_load_dwordx4 v6, s[24:27], s58 offen offset:1024 lds
MAA 128,64,100
RD 8,23,20736
MAA 132,68,100
RD 12,23,21760
MAA 132,48,96
RD 16,24,20480
MAA 136,52,96
v_rsq_f32 v166, v165
MAA 136,72,100
v_mov_b32 v165, v166
v_mul_f32 v166, 0x3e8293ee, v166
ds_write_b128 v7, v[164:167]
s_waitcnt vmcnt(16) lgkmcnt(6)
s_barrier
MAA 76,104,40
ds_write_b32 v17, v164
s_add_u32 m0, s59, 8320
MAA 76,108,60
ds_write_b32 v17, v165 offset:1024
s_xor_b32 s58, s87, 1179648
MAA 80,108,64
buffer_load_dwordx4 v5, s[24:27], s58 offen lds
MAA 80,104,44
RD 20,23,27648
MAA 84,104,48
RD 24,23,28672
MAA 84,108,68
RD 28,23,29952
MAA 88,108,72
buffer_load_dwordx4 v6, s[24:27], s58 offen offset:1024 lds
MAA 88,104,52
RD 32,23,30976
s_add_u32 m0, s59, 66560
MAA 160,112,56
RD 36,24,29696
s_xor_b32 s58, s87, 0
MAA 160,116,76
TR 80,25,24832
MAA 120,116,72
buffer_load_dwordx4 v5, s[24:27], s58 offen lds
MAA 120,112,52
TR 82,25,25344
MAA 116,112,48
TR 84,25,37248
MAA 116,116,68
TR 86,25,37760
MAA 112,116,64
buffer_load_dwordx4 v6, s[24:27], s58 offen offset:1024 lds
MAA 112,112,44
TR 88,25,25856
s_add_u32 m0, s59, 74880
MAA 108,112,40
TR 90,25,26368
s_xor_b32 s58, s87, 131072
MAA 108,116,60
TR 92,25,38272
MAA 140,60,124
buffer_load_dwordx4 v5, s[24:27], s58 offen lds
MAA 140,40,120
TR 94,25,38784
MAA 144,44,120
TR 96,25,26880
MAA 144,64,124
TR 98,25,27392
MAA 148,68,124
buffer_load_dwordx4 v6, s[24:27], s58 offen offset:1024 lds
MAA 148,48,120
TR 100,25,39296
MAA 152,52,120
TR 102,25,39808
MAA 152,72,124
s_waitcnt vmcnt(10) lgkmcnt(0)
s_barrier
MAA 156,88,16
TR 112,25,25888
s_add_u32 m0, s59, 83200
MAA 156,92,36
TR 114,25,26400
s_xor_b32 s58, s87, 262144
MAA 104,92,32
buffer_load_dwordx4 v5, s[24:27], s58 offen lds
MAA 104,88,12
TR 116,25,38304
MAA 100,88,8
TR 118,25,38816
MAA 100,92,28
TR 120,25,26912
MAA 96,92,24
buffer_load_dwordx4 v6, s[24:27], s58 offen offset:1024 lds
MAA 96,88,4
TR 122,25,27424
s_add_u32 m0, s59, 16640
MAA 92,88,0
TR 124,25,39328
s_xor_b32 s58, s87, 1310720
MAA 92,92,20
TR 126,25,39840
MAA 136,32,100
buffer_load_dwordx4 v5, s[24:27], s58 offen lds
MAA 136,12,96
TR 104,25,24864
MAA 72,80,12
TR 106,25,25376
MAA 72,84,32
TR 108,25,37280
MAA 68,84,28
buffer_load_dwordx4 v6, s[24:27], s58 offen offset:1024 lds
MAA 68,80,8
TR 110,25,37792
s_add_u32 m0, s59, 24960
MAA 64,80,4
RD 40,23,36864
s_xor_b32 s58, s87, 1441792
MAA 64,84,24
RD 44,23,37888
MAA 60,84,20
buffer_load_dwordx4 v5, s[24:27], s58 offen lds
MAA 60,80,0
RD 48,23,39168
s_waitcnt lgkmcnt(13)
MAA 160,112,16
RD 52,23,40192
s_waitcnt lgkmcnt(12)
MAA 160,116,36
RD 56,24,38912
MAA 120,116,32
buffer_load_dwordx4 v6, s[24:27], s58 offen offset:1024 lds
MAA 120,112,12
s_waitcnt lgkmcnt(5)
s_barrier
RD 60,23,46080
MAA 116,112,8
RD 64,23,47104
s_add_u32 m0, s59, 91520
MAA 116,116,28
RD 68,23,48384
s_xor_b32 s58, s87, 393216
MAA 112,116,24
RD 72,23,49408
MAA 112,112,4
RD 76,24,48128
MAA 108,112,0
TR 144,25,50688
MAA 108,116,20
TR 146,25,51200
MAA 152,32,124
TR 148,25,63104
MAA 152,12,120
TR 150,25,63616
MAA 88,104,12
TR 152,25,50720
MAA 88,108,32
TR 154,25,51232
MAA 84,108,28
TR 156,25,63136
MAA 84,104,8
TR 158,25,63648
MAA 80,104,4
TR 160,25,51712
MAA 80,108,24
TR 162,25,52224
MAA 76,108,20
TR 164,25,64128
MAA 76,104,0
TR 166,25,64640
s_waitcnt lgkmcnt(10)
MAA 156,144,56
TR 168,25,51744
s_waitcnt lgkmcnt(9)
MAA 156,148,76
TR 170,25,52256
MAA 104,148,72
TR 172,25,64160
MAA 104,144,52
TR 174,25,64672
MAA 100,144,48
TR 128,25,49664
MAA 100,148,68
TR 130,25,50176
MAA 96,148,64
TR 132,25,62080
MAA 96,144,44
TR 134,25,62592
MAA 92,144,40
TR 136,25,49696
MAA 92,148,60
TR 138,25,50208
s_waitcnt lgkmcnt(14)
MAA 160,156,76
TR 140,25,62112
MAA 160,152,56
TR 142,25,62624
MAA 120,152,52
ds_read_b128 v[232:235], v10 offset:768
MAA 120,156,72
ds_read_b128 v[236:239], v10 offset:2816
MAA 116,156,68
ds_read_b128 v[228:231], v10 offset:512
MAA 116,152,48
ds_read_b128 v[224:227], v10 offset:256
MAA 112,152,44
ds_read_b128 v[220:223], v10
MAA 112,156,64
buffer_load_dwordx4 v5, s[24:27], s58 offen lds
MAA 108,156,60
ds_read_b128 v[240:243], v11 offset:192
MAA 108,152,40
ds_read_b128 v[244:247], v11 offset:1216
s_waitcnt lgkmcnt(15)
MAA 136,52,160
ds_read_b128 v[18:21], v11 offset:128
MAA 136,72,164
buffer_load_dwordx4 v6, s[24:27], s58 offen offset:1024 lds
MAA 152,72,172
ds_read_b128 v[22:25], v11 offset:1152
s_add_u32 m0, s59, 99840
MAA 152,52,168
s_xor_b32 s58, s87, 524288
s_waitcnt lgkmcnt(15)
MAA 72,128,52
s_waitcnt lgkmcnt(13)
MAA 72,132,72
buffer_load_dwordx4 v5, s[24:27], s58 offen lds
MAA 68,132,68
MAA 68,128,48
MAA 64,128,44
MAA 64,132,64
buffer_load_dwordx4 v6, s[24:27], s58 offen offset:1024 lds
MAA 60,132,60
s_add_u32 m0, s59, 108160
s_xor_b32 s58, s87, 655360
MAA 60,128,40
s_waitcnt lgkmcnt(11)
MAA 88,136,52
s_waitcnt lgkmcnt(9)
MAA 88,140,72
buffer_load_dwordx4 v5, s[24:27], s58 offen lds
MAA 84,140,68
MAA 84,136,48
MAA 80,136,44
MAA 80,140,64
buffer_load_dwordx4 v6, s[24:27], s58 offen offset:1024 lds
MAA 76,140,60
MAA 76,136,40
s_waitcnt lgkmcnt(8)
v_pk_fma_f32 v[104:105], v[36:37], v[232:233], v[104:105] op_sel_hi:[1,0,1]
v_pk_mul_f32 v[104:105], v[104:105], v[232:233] op_sel:[0,1] op_sel_hi:[1,1]
v_cvt_pk_bf16_f32 v196, v104, v105
v_pk_fma_f32 v[106:107], v[38:39], v[232:233], v[106:107] op_sel_hi:[1,0,1]
v_pk_mul_f32 v[106:107], v[106:107], v[232:233] op_sel:[0,1] op_sel_hi:[1,1]
v_cvt_pk_bf16_f32 v197, v106, v107
v_pk_fma_f32 v[120:121], v[40:41], v[232:233], v[120:121] op_sel_hi:[1,0,1]
v_pk_mul_f32 v[120:121], v[120:121], v[232:233] op_sel:[0,1] op_sel_hi:[1,1]
v_cvt_pk_bf16_f32 v198, v120, v121
v_pk_fma_f32 v[122:123], v[42:43], v[232:233], v[122:123] op_sel_hi:[1,0,1]
v_pk_mul_f32 v[122:123], v[122:123], v[232:233] op_sel:[0,1] op_sel_hi:[1,1]
v_cvt_pk_bf16_f32 v199, v122, v123
s_waitcnt lgkmcnt(3)
v_pk_fma_f32 v[136:137], v[240:241], v[44:45], v[136:137] op_sel_hi:[1,0,1]
s_waitcnt lgkmcnt(2)
v_pk_mul_f32 v[136:137], v[136:137], v[244:245]
v_cvt_pk_bf16_f32 v208, v136, v137
v_pk_fma_f32 v[138:139], v[242:243], v[44:45], v[138:139] op_sel_hi:[1,0,1]
v_pk_mul_f32 v[138:139], v[138:139], v[246:247]
v_cvt_pk_bf16_f32 v209, v138, v139
v_pk_fma_f32 v[152:153], v[240:241], v[44:45], v[152:153] op_sel:[0,1,0] op_sel_hi:[1,1,1]
v_pk_mul_f32 v[152:153], v[152:153], v[244:245]
v_cvt_pk_bf16_f32 v218, v152, v153
v_pk_fma_f32 v[154:155], v[242:243], v[44:45], v[154:155] op_sel:[0,1,0] op_sel_hi:[1,1,1]
v_pk_mul_f32 v[154:155], v[154:155], v[246:247]
v_cvt_pk_bf16_f32 v219, v154, v155
ds_write_b128 v8, v[196:199]
ds_write_b64 v8, v[208:209] offset:1024
ds_write_b64 v8, v[218:219] offset:1032
v_pk_fma_f32 v[156:157], v[36:37], v[236:237], v[156:157] op_sel_hi:[1,0,1]
v_pk_mul_f32 v[156:157], v[156:157], v[236:237] op_sel:[0,1] op_sel_hi:[1,1]
v_cvt_pk_bf16_f32 v180, v156, v157
v_pk_fma_f32 v[158:159], v[38:39], v[236:237], v[158:159] op_sel_hi:[1,0,1]
v_pk_mul_f32 v[158:159], v[158:159], v[236:237] op_sel:[0,1] op_sel_hi:[1,1]
v_cvt_pk_bf16_f32 v181, v158, v159
v_pk_fma_f32 v[160:161], v[40:41], v[236:237], v[160:161] op_sel_hi:[1,0,1]
v_pk_mul_f32 v[160:161], v[160:161], v[236:237] op_sel:[0,1] op_sel_hi:[1,1]
v_cvt_pk_bf16_f32 v182, v160, v161
v_pk_fma_f32 v[162:163], v[42:43], v[236:237], v[162:163] op_sel_hi:[1,0,1]
v_pk_mul_f32 v[162:163], v[162:163], v[236:237] op_sel:[0,1] op_sel_hi:[1,1]
v_cvt_pk_bf16_f32 v183, v162, v163
v_pk_fma_f32 v[100:101], v[36:37], v[228:229], v[100:101] op_sel_hi:[1,0,1]
v_pk_mul_f32 v[100:101], v[100:101], v[228:229] op_sel:[0,1] op_sel_hi:[1,1]
v_cvt_pk_bf16_f32 v192, v100, v101
v_pk_fma_f32 v[102:103], v[38:39], v[228:229], v[102:103] op_sel_hi:[1,0,1]
v_pk_mul_f32 v[102:103], v[102:103], v[228:229] op_sel:[0,1] op_sel_hi:[1,1]
v_cvt_pk_bf16_f32 v193, v102, v103
v_pk_fma_f32 v[116:117], v[40:41], v[228:229], v[116:117] op_sel_hi:[1,0,1]
v_pk_mul_f32 v[116:117], v[116:117], v[228:229] op_sel:[0,1] op_sel_hi:[1,1]
v_cvt_pk_bf16_f32 v194, v116, v117
v_pk_fma_f32 v[118:119], v[42:43], v[228:229], v[118:119] op_sel_hi:[1,0,1]
v_pk_mul_f32 v[118:119], v[118:119], v[228:229] op_sel:[0,1] op_sel_hi:[1,1]
s_waitcnt lgkmcnt(0)
s_barrier
v_cvt_pk_bf16_f32 v195, v118, v119
v_pk_fma_f32 v[96:97], v[36:37], v[224:225], v[96:97] op_sel_hi:[1,0,1]
v_pk_mul_f32 v[96:97], v[96:97], v[224:225] op_sel:[0,1] op_sel_hi:[1,1]
v_cvt_pk_bf16_f32 v188, v96, v97
v_pk_fma_f32 v[98:99], v[38:39], v[224:225], v[98:99] op_sel_hi:[1,0,1]
v_pk_mul_f32 v[98:99], v[98:99], v[224:225] op_sel:[0,1] op_sel_hi:[1,1]
v_cvt_pk_bf16_f32 v189, v98, v99
v_pk_fma_f32 v[112:113], v[40:41], v[224:225], v[112:113] op_sel_hi:[1,0,1]
v_pk_mul_f32 v[112:113], v[112:113], v[224:225] op_sel:[0,1] op_sel_hi:[1,1]
v_cvt_pk_bf16_f32 v190, v112, v113
v_pk_fma_f32 v[114:115], v[42:43], v[224:225], v[114:115] op_sel_hi:[1,0,1]
v_pk_mul_f32 v[114:115], v[114:115], v[224:225] op_sel:[0,1] op_sel_hi:[1,1]
v_cvt_pk_bf16_f32 v191, v114, v115
v_pk_fma_f32 v[92:93], v[36:37], v[220:221], v[92:93] op_sel_hi:[1,0,1]
v_pk_mul_f32 v[92:93], v[92:93], v[220:221] op_sel:[0,1] op_sel_hi:[1,1]
v_cvt_pk_bf16_f32 v184, v92, v93
v_pk_fma_f32 v[94:95], v[38:39], v[220:221], v[94:95] op_sel_hi:[1,0,1]
v_pk_mul_f32 v[94:95], v[94:95], v[220:221] op_sel:[0,1] op_sel_hi:[1,1]
v_cvt_pk_bf16_f32 v185, v94, v95
v_pk_fma_f32 v[108:109], v[40:41], v[220:221], v[108:109] op_sel_hi:[1,0,1]
v_pk_mul_f32 v[108:109], v[108:109], v[220:221] op_sel:[0,1] op_sel_hi:[1,1]
v_cvt_pk_bf16_f32 v186, v108, v109
v_pk_fma_f32 v[110:111], v[42:43], v[220:221], v[110:111] op_sel_hi:[1,0,1]
v_pk_mul_f32 v[110:111], v[110:111], v[220:221] op_sel:[0,1] op_sel_hi:[1,1]
v_cvt_pk_bf16_f32 v187, v110, v111
v_pk_fma_f32 v[72:73], v[28:29], v[232:233], v[72:73] op_sel_hi:[1,0,1]
v_cvt_pk_bf16_f32 v176, v72, v73
v_pk_fma_f32 v[74:75], v[30:31], v[232:233], v[74:75] op_sel_hi:[1,0,1]
v_cvt_pk_bf16_f32 v177, v74, v75
v_pk_fma_f32 v[88:89], v[32:33], v[232:233], v[88:89] op_sel_hi:[1,0,1]
v_cvt_pk_bf16_f32 v178, v88, v89
v_pk_fma_f32 v[90:91], v[34:35], v[232:233], v[90:91] op_sel_hi:[1,0,1]
v_cvt_pk_bf16_f32 v179, v90, v91
v_pk_fma_f32 v[68:69], v[28:29], v[228:229], v[68:69] op_sel_hi:[1,0,1]
v_cvt_pk_bf16_f32 v172, v68, v69
v_pk_fma_f32 v[70:71], v[30:31], v[228:229], v[70:71] op_sel_hi:[1,0,1]
v_cvt_pk_bf16_f32 v173, v70, v71
v_pk_fma_f32 v[84:85], v[32:33], v[228:229], v[84:85] op_sel_hi:[1,0,1]
v_cvt_pk_bf16_f32 v174, v84, v85
v_pk_fma_f32 v[86:87], v[34:35], v[228:229], v[86:87] op_sel_hi:[1,0,1]
v_cvt_pk_bf16_f32 v175, v86, v87
v_pk_fma_f32 v[64:65], v[28:29], v[224:225], v[64:65] op_sel_hi:[1,0,1]
v_cvt_pk_bf16_f32 v168, v64, v65
v_pk_fma_f32 v[66:67], v[30:31], v[224:225], v[66:67] op_sel_hi:[1,0,1]
v_cvt_pk_bf16_f32 v169, v66, v67
v_pk_fma_f32 v[80:81], v[32:33], v[224:225], v[80:81] op_sel_hi:[1,0,1]
v_cvt_pk_bf16_f32 v170, v80, v81
v_pk_fma_f32 v[82:83], v[34:35], v[224:225], v[82:83] op_sel_hi:[1,0,1]
v_cvt_pk_bf16_f32 v171, v82, v83
v_pk_fma_f32 v[60:61], v[28:29], v[220:221], v[60:61] op_sel_hi:[1,0,1]
v_cvt_pk_bf16_f32 v164, v60, v61
v_pk_fma_f32 v[62:63], v[30:31], v[220:221], v[62:63] op_sel_hi:[1,0,1]
v_cvt_pk_bf16_f32 v165, v62, v63
v_pk_fma_f32 v[76:77], v[32:33], v[220:221], v[76:77] op_sel_hi:[1,0,1]
v_cvt_pk_bf16_f32 v166, v76, v77
v_pk_fma_f32 v[78:79], v[34:35], v[220:221], v[78:79] op_sel_hi:[1,0,1]
v_cvt_pk_bf16_f32 v167, v78, v79
s_nop 0
v_mfma_f32_16x16x32_bf16 v[120:123], v[196:199], v[176:179], v[50:53]
ds_read_b64 v[200:201], v9 offset:1024
v_mfma_f32_16x16x32_bf16 v[104:107], v[192:195], v[176:179], v[46:49]
ds_read_b64 v[210:211], v9 offset:1032
v_mfma_f32_16x16x32_bf16 v[116:119], v[192:195], v[172:175], v[50:53]
ds_read_b128 v[240:243], v11 offset:64
v_mfma_f32_16x16x32_bf16 v[100:103], v[188:191], v[172:175], v[46:49]
ds_read_b128 v[244:247], v11 offset:1088
v_mfma_f32_16x16x32_bf16 v[112:115], v[188:191], v[168:171], v[50:53]
ds_read_b128 v[28:31], v11
v_mfma_f32_16x16x32_bf16 v[96:99], v[184:187], v[168:171], v[46:49]
ds_read_b128 v[32:35], v11 offset:1024
v_max3_f32 v88, v104, v105, v106
v_mfma_f32_16x16x32_bf16 v[108:111], v[184:187], v[164:167], v[50:53]
v_max3_f32 v89, v107, v120, v121
v_max3_f32 v88, v88, v122, v123
v_mfma_f32_16x16x32_bf16 v[92:95], v[180:183], v[164:167], v[54:57]
v_max_f32 v90, v88, v89
v_max_f32 v89, v88, v89
MAA 132,8,96
s_nop 0
v_permlane16_swap_b32 v90, v89
MAA 132,28,100
v_max_f32 v88, v90, v89
v_max_f32 v89, v90, v89
MAA 132,48,160
s_nop 0
v_permlane32_swap_b32 v88, v89
MAA 132,68,164
v_max_f32 v88, v88, v89
v_mul_f32 v88, v88, v234
MAA 148,68,172
v_max3_f32 v84, v100, v101, v102
v_max3_f32 v85, v103, v116, v117
MAA 148,48,168
v_max3_f32 v84, v84, v118, v119
v_max_f32 v86, v84, v85
MAA 148,28,124
v_max_f32 v85, v84, v85
v_max3_f32 v80, v96, v97, v98
MAA 148,8,120
v_permlane16_swap_b32 v86, v85
v_max3_f32 v81, v99, v112, v113
v_max_f32 v84, v86, v85
v_max_f32 v85, v86, v85
v_max3_f32 v80, v80, v114, v115
v_max_f32 v82, v80, v81
v_permlane32_swap_b32 v84, v85
v_max_f32 v81, v80, v81
v_max_f32 v84, v84, v85
v_mul_f32 v84, v84, v230
v_permlane16_swap_b32 v82, v81
v_max3_f32 v76, v92, v93, v94
v_max_f32 v80, v82, v81
v_max_f32 v81, v82, v81
v_max3_f32 v77, v95, v108, v109
v_max3_f32 v76, v76, v110, v111
v_permlane32_swap_b32 v80, v81
v_max_f32 v78, v76, v77
v_max_f32 v80, v80, v81
v_mul_f32 v80, v80, v226
v_max_f32 v77, v76, v77
v_pk_fma_f32 v[104:105], v[104:105], v[234:235], v[88:89] op_sel_hi:[1,0,0] neg_lo:[0,0,1] neg_hi:[0,0,1]
v_pk_fma_f32 v[106:107], v[106:107], v[234:235], v[88:89] op_sel_hi:[1,0,0] neg_lo:[0,0,1] neg_hi:[0,0,1]
v_permlane16_swap_b32 v78, v77
v_pk_fma_f32 v[120:121], v[120:121], v[234:235], v[88:89] op_sel_hi:[1,0,0] neg_lo:[0,0,1] neg_hi:[0,0,1]
v_max_f32 v76, v78, v77
v_max_f32 v77, v78, v77
v_pk_fma_f32 v[122:123], v[122:123], v[234:235], v[88:89] op_sel_hi:[1,0,0] neg_lo:[0,0,1] neg_hi:[0,0,1]
v_pk_fma_f32 v[100:101], v[100:101], v[230:231], v[84:85] op_sel_hi:[1,0,0] neg_lo:[0,0,1] neg_hi:[0,0,1]
v_permlane32_swap_b32 v76, v77
v_pk_fma_f32 v[102:103], v[102:103], v[230:231], v[84:85] op_sel_hi:[1,0,0] neg_lo:[0,0,1] neg_hi:[0,0,1]
v_max_f32 v76, v76, v77
v_mul_f32 v76, v76, v222
v_pk_fma_f32 v[116:117], v[116:117], v[230:231], v[84:85] op_sel_hi:[1,0,0] neg_lo:[0,0,1] neg_hi:[0,0,1]
v_pk_fma_f32 v[118:119], v[118:119], v[230:231], v[84:85] op_sel_hi:[1,0,0] neg_lo:[0,0,1] neg_hi:[0,0,1]
v_pk_fma_f32 v[96:97], v[96:97], v[226:227], v[80:81] op_sel_hi:[1,0,0] neg_lo:[0,0,1] neg_hi:[0,0,1]
v_pk_fma_f32 v[98:99], v[98:99], v[226:227], v[80:81] op_sel_hi:[1,0,0] neg_lo:[0,0,1] neg_hi:[0,0,1]
v_pk_fma_f32 v[112:113], v[112:113], v[226:227], v[80:81] op_sel_hi:[1,0,0] neg_lo:[0,0,1] neg_hi:[0,0,1]
v_pk_fma_f32 v[114:115], v[114:115], v[226:227], v[80:81] op_sel_hi:[1,0,0] neg_lo:[0,0,1] neg_hi:[0,0,1]
v_pk_fma_f32 v[92:93], v[92:93], v[222:223], v[76:77] op_sel_hi:[1,0,0] neg_lo:[0,0,1] neg_hi:[0,0,1]
v_pk_fma_f32 v[94:95], v[94:95], v[222:223], v[76:77] op_sel_hi:[1,0,0] neg_lo:[0,0,1] neg_hi:[0,0,1]
v_pk_fma_f32 v[108:109], v[108:109], v[222:223], v[76:77] op_sel_hi:[1,0,0] neg_lo:[0,0,1] neg_hi:[0,0,1]
v_pk_fma_f32 v[110:111], v[110:111], v[222:223], v[76:77] op_sel_hi:[1,0,0] neg_lo:[0,0,1] neg_hi:[0,0,1]
v_pk_fma_f32 v[132:133], v[18:19], v[44:45], v[132:133] op_sel_hi:[1,0,1]
v_pk_mul_f32 v[132:133], v[132:133], v[22:23]
v_pk_fma_f32 v[134:135], v[20:21], v[44:45], v[134:135] op_sel_hi:[1,0,1]
v_pk_mul_f32 v[134:135], v[134:135], v[24:25]
v_pk_fma_f32 v[148:149], v[18:19], v[44:45], v[148:149] op_sel:[0,1,0] op_sel_hi:[1,1,1]
v_pk_mul_f32 v[148:149], v[148:149], v[22:23]
v_pk_fma_f32 v[150:151], v[20:21], v[44:45], v[150:151] op_sel:[0,1,0] op_sel_hi:[1,1,1]
v_pk_mul_f32 v[150:151], v[150:151], v[24:25]
v_exp_f32 v104, v104
s_nop 0
MAA 128,4,96
v_exp_f32 v105, v105
MAA 128,24,100
v_exp_f32 v106, v106
MAA 128,44,160
v_exp_f32 v107, v107
MAA 128,64,164
v_exp_f32 v120, v120
MAA 144,64,172
v_exp_f32 v121, v121
MAA 144,44,168
v_exp_f32 v122, v122
MAA 144,24,124
v_exp_f32 v123, v123
MAA 144,4,120
v_exp_f32 v100, v100
MAA 124,0,96
v_exp_f32 v101, v101
MAA 124,20,100
v_exp_f32 v102, v102
MAA 124,40,160
v_exp_f32 v103, v103
MAA 124,60,164
v_exp_f32 v116, v116
MAA 140,60,172
v_exp_f32 v117, v117
MAA 140,40,168
v_exp_f32 v118, v118
MAA 140,20,124
.Lpad25:
s_cbranch_execz .Lpad28
v_exp_f32 v119, v119
MAA 140,0,120
v_cvt_pk_bf16_f32 v72, v104, v105
v_cvt_pk_bf16_f32 v73, v106, v107
v_cvt_pk_bf16_f32 v74, v120, v121
v_cvt_pk_bf16_f32 v75, v122, v123
v_cvt_pk_bf16_f32 v68, v100, v101
v_cvt_pk_bf16_f32 v69, v102, v103
v_cvt_pk_bf16_f32 v70, v116, v117
v_cvt_pk_bf16_f32 v71, v118, v119
v_exp_f32 v96, v96
v_exp_f32 v97, v97
v_exp_f32 v98, v98
v_exp_f32 v99, v99
v_exp_f32 v112, v112
v_exp_f32 v113, v113
v_exp_f32 v114, v114
v_exp_f32 v115, v115
v_cvt_pk_bf16_f32 v64, v96, v97
v_cvt_pk_bf16_f32 v65, v98, v99
v_cvt_pk_bf16_f32 v66, v112, v113
v_cvt_pk_bf16_f32 v67, v114, v115
v_cvt_pk_bf16_f32 v206, v132, v133
v_cvt_pk_bf16_f32 v207, v134, v135
v_cvt_pk_bf16_f32 v216, v148, v149
v_cvt_pk_bf16_f32 v217, v150, v151
s_waitcnt lgkmcnt(3)
v_pk_fma_f32 v[128:129], v[240:241], v[44:45], v[128:129] op_sel_hi:[1,0,1]
s_waitcnt lgkmcnt(2)
v_pk_mul_f32 v[128:129], v[128:129], v[244:245]
v_cvt_pk_bf16_f32 v204, v128, v129
v_pk_fma_f32 v[130:131], v[242:243], v[44:45], v[130:131] op_sel_hi:[1,0,1]
v_pk_mul_f32 v[130:131], v[130:131], v[246:247]
v_cvt_pk_bf16_f32 v205, v130, v131
v_pk_fma_f32 v[144:145], v[240:241], v[44:45], v[144:145] op_sel:[0,1,0] op_sel_hi:[1,1,1]
v_pk_mul_f32 v[144:145], v[144:145], v[244:245]
v_cvt_pk_bf16_f32 v214, v144, v145
v_pk_fma_f32 v[146:147], v[242:243], v[44:45], v[146:147] op_sel:[0,1,0] op_sel_hi:[1,1,1]
v_pk_mul_f32 v[146:147], v[146:147], v[246:247]
v_cvt_pk_bf16_f32 v215, v146, v147
s_waitcnt lgkmcnt(1)
v_pk_fma_f32 v[124:125], v[28:29], v[44:45], v[124:125] op_sel_hi:[1,0,1]
s_waitcnt lgkmcnt(0)
v_pk_mul_f32 v[124:125], v[124:125], v[32:33]
v_cvt_pk_bf16_f32 v202, v124, v125
v_pk_fma_f32 v[126:127], v[30:31], v[44:45], v[126:127] op_sel_hi:[1,0,1]
v_pk_mul_f32 v[126:127], v[126:127], v[34:35]
v_cvt_pk_bf16_f32 v203, v126, v127
v_pk_fma_f32 v[140:141], v[28:29], v[44:45], v[140:141] op_sel:[0,1,0] op_sel_hi:[1,1,1]
v_pk_mul_f32 v[140:141], v[140:141], v[32:33]
v_cvt_pk_bf16_f32 v212, v140, v141
v_pk_fma_f32 v[142:143], v[30:31], v[44:45], v[142:143] op_sel:[0,1,0] op_sel_hi:[1,1,1]
v_pk_mul_f32 v[142:143], v[142:143], v[34:35]
v_cvt_pk_bf16_f32 v213, v142, v143
s_nop 0
v_mfma_f32_16x16x32_bf16 v[88:91], v[248:251], v[72:75], 0
v_exp_f32 v92, v92
v_mfma_f32_16x16x32_bf16 v[104:107], v[206:209], v[72:75], 0
v_exp_f32 v93, v93
v_mfma_f32_16x16x32_bf16 v[120:123], v[216:219], v[72:75], 0
v_exp_f32 v94, v94
v_mfma_f32_16x16x32_bf16 v[84:87], v[248:251], v[68:71], 0
v_exp_f32 v95, v95
v_mfma_f32_16x16x32_bf16 v[100:103], v[204:207], v[68:71], 0
v_exp_f32 v108, v108
v_mfma_f32_16x16x32_bf16 v[116:119], v[214:217], v[68:71], 0
v_exp_f32 v109, v109
v_mfma_f32_16x16x32_bf16 v[80:83], v[248:251], v[64:67], 0
v_exp_f32 v110, v110
v_mfma_f32_16x16x32_bf16 v[96:99], v[202:205], v[64:67], 0
v_exp_f32 v111, v111
v_mfma_f32_16x16x32_bf16 v[112:115], v[212:215], v[64:67], 0
v_cvt_pk_bf16_f32 v60, v92, v93
v_cvt_pk_bf16_f32 v61, v94, v95
v_cvt_pk_bf16_f32 v62, v108, v109
v_cvt_pk_bf16_f32 v63, v110, v111
v_rcp_f32 v88, v88
v_rcp_f32 v84, v84
v_mfma_f32_16x16x32_bf16 v[76:79], v[248:251], v[60:63], 0
v_rcp_f32 v80, v80
v_mfma_f32_16x16x32_bf16 v[92:95], v[200:203], v[60:63], 0
v_mfma_f32_16x16x32_bf16 v[108:111], v[210:213], v[60:63], 0
s_nop 4
v_rcp_f32 v76, v76
v_pk_mul_f32 v[104:105], v[104:105], v[88:89] op_sel_hi:[1,0]
v_pk_mul_f32 v[106:107], v[106:107], v[88:89] op_sel_hi:[1,0]
v_pk_mul_f32 v[120:121], v[120:121], v[88:89] op_sel_hi:[1,0]
v_pk_mul_f32 v[122:123], v[122:123], v[88:89] op_sel_hi:[1,0]
v_cvt_pk_bf16_f32 v176, v104, v105
v_cvt_pk_bf16_f32 v177, v106, v107
v_cvt_pk_bf16_f32 v178, v120, v121
v_cvt_pk_bf16_f32 v179, v122, v123
buffer_store_dwordx4 v[176:179], v4, s[16:19], s74 offen offset:3072 sc1
v_pk_mul_f32 v[100:101], v[100:101], v[84:85] op_sel_hi:[1,0]
v_pk_mul_f32 v[102:103], v[102:103], v[84:85] op_sel_hi:[1,0]
v_pk_mul_f32 v[116:117], v[116:117], v[84:85] op_sel_hi:[1,0]
v_pk_mul_f32 v[118:119], v[118:119], v[84:85] op_sel_hi:[1,0]
v_cvt_pk_bf16_f32 v172, v100, v101
v_cvt_pk_bf16_f32 v173, v102, v103
v_cvt_pk_bf16_f32 v174, v116, v117
v_cvt_pk_bf16_f32 v175, v118, v119
buffer_store_dwordx4 v[172:175], v4, s[16:19], s74 offen offset:2048 sc1
v_pk_mul_f32 v[96:97], v[96:97], v[80:81] op_sel_hi:[1,0]
v_pk_mul_f32 v[98:99], v[98:99], v[80:81] op_sel_hi:[1,0]
v_pk_mul_f32 v[112:113], v[112:113], v[80:81] op_sel_hi:[1,0]
v_pk_mul_f32 v[114:115], v[114:115], v[80:81] op_sel_hi:[1,0]
v_cvt_pk_bf16_f32 v168, v96, v97
v_cvt_pk_bf16_f32 v169, v98, v99
v_cvt_pk_bf16_f32 v170, v112, v113
v_cvt_pk_bf16_f32 v171, v114, v115
buffer_store_dwordx4 v[168:171], v4, s[16:19], s74 offen offset:1024 sc1
v_pk_mul_f32 v[92:93], v[92:93], v[76:77] op_sel_hi:[1,0]
v_pk_mul_f32 v[94:95], v[94:95], v[76:77] op_sel_hi:[1,0]
v_pk_mul_f32 v[108:109], v[108:109], v[76:77] op_sel_hi:[1,0]
v_pk_mul_f32 v[110:111], v[110:111], v[76:77] op_sel_hi:[1,0]
v_cvt_pk_bf16_f32 v164, v92, v93
v_cvt_pk_bf16_f32 v165, v94, v95
v_cvt_pk_bf16_f32 v166, v108, v109
v_cvt_pk_bf16_f32 v167, v110, v111
buffer_store_dwordx4 v[164:167], v4, s[16:19], s74 offen sc1
s_nop 1
s_branch .Lqkve56
.Lsp50:
s_mov_b32 s15, 0
.Lsp50l:
v_mov_b32 v25, 0
buffer_atomic_add v25, v22, s[16:19], s73 offen sc0
s_add_u32 s15, s15, 1
s_cmp_gt_u32 s15, 100000
s_waitcnt vmcnt(0)
s_cbranch_scc1 .Lsp50b
v_cmp_gt_u32 vcc, v23, v25
s_nop 0
s_cbranch_vccnz .Lsp50l
s_branch .Lsp50b
.p2align 12
.Lqkv55:
.Lpad26:
s_cbranch_execz .Lpad29
s_add_u32 m0, s55, 36864
s_nop 0
buffer_load_dwordx4 v21, s[16:19], s52 offen sc1 lds
buffer_load_dwordx4 v21, s[16:19], s52 offen offset:1024 sc1 lds
buffer_load_dword v22, s[16:19], s52 offen offset:2048 sc1 lds
s_add_u32 s52, s52, 131072
TR 80,25,49664
TR 82,25,50176
TR 84,25,62080
s_add_u32 m0, s55, 46080
s_nop 0
buffer_load_dwordx4 v21, s[16:19], s52 offen sc1 lds
buffer_load_dwordx4 v21, s[16:19], s52 offen offset:1024 sc1 lds
buffer_load_dword v22, s[16:19], s52 offen offset:2048 sc1 lds
s_add_u32 s52, s52, 131072
TR 86,25,62592
TR 88,25,50688
TR 90,25,51200
s_add_u32 m0, s55, 0
s_nop 0
buffer_load_dwordx4 v21, s[16:19], s52 offen sc1 lds
buffer_load_dwordx4 v21, s[16:19], s52 offen offset:1024 sc1 lds
buffer_load_dword v22, s[16:19], s52 offen offset:2048 sc1 lds
s_add_u32 s52, s52, 131072
TR 92,25,63104
TR 94,25,63616
TR 96,25,51712
s_add_u32 m0, s55, 9216
s_nop 0
buffer_load_dwordx4 v21, s[16:19], s52 offen sc1 lds
buffer_load_dwordx4 v21, s[16:19], s52 offen offset:1024 sc1 lds
buffer_load_dword v22, s[16:19], s52 offen offset:2048 sc1 lds
s_add_u32 s52, s52, 131072
TR 98,25,52224
TR 100,25,64128
TR 102,25,64640
s_add_u32 m0, s55, 18432
s_nop 0
buffer_load_dwordx4 v21, s[16:19], s52 offen sc1 lds
buffer_load_dwordx4 v21, s[16:19], s52 offen offset:1024 sc1 lds
buffer_load_dword v22, s[16:19], s52 offen offset:2048 sc1 lds
s_add_u32 s52, s52, 131072
ds_read_b128 v[28:31], v13
ds_read_b128 v[32:35], v13 offset:64
ds_read_b128 v[36:39], v13 offset:256
s_add_u32 m0, s55, 27648
s_nop 0
buffer_load_dwordx4 v21, s[16:19], s52 offen sc1 lds
buffer_load_dwordx4 v21, s[16:19], s52 offen offset:1024 sc1 lds
buffer_load_dword v22, s[16:19], s52 offen offset:2048 sc1 lds
s_add_u32 s52, s52, 131072
ds_read_b128 v[40:43], v13 offset:320
ds_read_b32 v44, v12 offset:512
ds_read_b32 v45, v12 offset:576
s_waitcnt vmcnt(12)
s_barrier
RD 0,23,36864
RD 4,23,37888
RD 8,23,39168
RD 12,23,40192
RD 16,24,38912
RD 20,23,46080
RD 24,23,47104
RD 28,23,48384
RD 32,23,49408
RD 36,24,48128
s_waitcnt lgkmcnt(0)
s_mov_b32 s15, -2
.p2align 6
.Lk58:
s_waitcnt vmcnt(9) lgkmcnt(8)
s_barrier
MAA 60,80,0
TR 104,25,49696
s_add_u32 m0, s56, 104832
MAA 60,84,20
buffer_load_dwordx4 v18, s[20:23], s54 offen lds
MAA 64,84,24
TR 106,25,50208
v_add_f32 v164, v164, v168
MAA 64,80,4
TR 108,25,62112
MAA 68,80,8
TR 110,25,62624
MAA 68,84,28
buffer_load_dwordx4 v19, s[20:23], s54 offen offset:1024 lds
MAA 72,84,32
TR 112,25,50720
v_add_f32 v165, v165, v169
MAA 72,80,12
TR 114,25,51232
s_waitcnt lgkmcnt(6)
MAA 104,88,12
TR 116,25,63136
MAA 104,92,32
buffer_load_dwordx4 v20, s[20:23], s54 offen offset:2048 lds
MAA 100,92,28
s_add_u32 s54, s54, 196608
s_add_u32 m0, s55, 36864
MAA 100,88,8
buffer_load_dwordx4 v21, s[16:19], s52 offen sc1 lds
MAA 96,88,4
TR 118,25,63648
MAA 96,92,24
TR 120,25,51744
v_add_f32 v166, v166, v170
MAA 92,92,20
TR 122,25,52256
MAA 92,88,0
buffer_load_dwordx4 v21, s[16:19], s52 offen offset:1024 sc1 lds
MAA 124,0,96
TR 124,25,64160
MAA 124,20,100
TR 126,25,64672
v_add_f32 v167, v167, v171
MAA 128,24,100
ds_read_b128 a[40:43], v23
MAA 128,4,96
buffer_load_dword v22, s[16:19], s52 offen offset:2048 sc1 lds
MAA 132,8,96
RD 44,23,1024
s_add_u32 s52, s52, 131072
MAA 132,28,100
buffer_load_dword v27, v14, s[20:23], s44 offen
MAA 136,32,100
RD 48,23,2304
s_add_u32 s44, s44, 1572864
MAA 136,12,96
RD 52,23,3328
MAA 156,16,96
RD 56,24,2048
MAA 156,36,100
s_waitcnt vmcnt(13) lgkmcnt(5)
s_barrier
MAA 76,104,0
RD 60,23,9216
s_add_u32 m0, s56, 117248
MAA 76,108,20
buffer_load_dwordx4 v18, s[20:23], s54 offen lds
MAA 80,108,24
RD 64,23,10240
MAA 80,104,4
RD 68,23,11520
MAA 84,104,8
RD 72,23,12544
MAA 84,108,28
buffer_load_dwordx4 v19, s[20:23], s54 offen offset:1024 lds
MAA 88,108,32
RD 76,24,11264
MAA 88,104,12
buffer_load_dwordx4 v20, s[20:23], s54 offen offset:2048 lds
MAA 120,112,12
ds_read_b64_tr_b16 a[80:81], v25
s_add_u32 s54, s54, 196608
MAA 120,116,32
TR 82,25,512
MAA 116,116,28
TR 84,25,12416
s_add_u32 m0, s55, 46080
MAA 116,112,8
buffer_load_dwordx4 v21, s[16:19], s52 offen sc1 lds
MAA 112,112,4
TR 86,25,12928
MAA 112,116,24
TR 88,25,1024
MAA 108,116,20
TR 90,25,1536
MAA 108,112,0
buffer_load_dwordx4 v21, s[16:19], s52 offen offset:1024 sc1 lds
MAA 140,0,120
TR 92,25,13440
MAA 140,20,124
TR 94,25,13952
MAA 144,24,124
TR 96,25,2048
MAA 144,4,120
buffer_load_dword v22, s[16:19], s52 offen offset:2048 sc1 lds
MAA 148,8,120
TR 98,25,2560
s_add_u32 s52, s52, 131072
MAA 148,28,124
buffer_load_dwordx4 v[168:171], v26, s[16:19], s75 offen sc1
MAA 152,32,124
TR 100,25,14464
MAA 152,12,120
TR 102,25,14976
MAA 160,16,120
MAA 160,36,124
s_waitcnt vmcnt(17) lgkmcnt(8)
s_barrier
MAA 60,80,40
TR 104,25,32
v_add_f32 v164, v164, v172
MAA 60,84,60
TR 106,25,544
MAA 64,84,64
TR 108,25,12448
s_add_u32 m0, s56, 129664
MAA 64,80,44
buffer_load_dwordx4 v18, s[20:23], s54 offen lds
MAA 68,80,48
TR 110,25,12960
MAA 68,84,68
TR 112,25,1056
MAA 72,84,72
TR 114,25,1568
v_add_f32 v165, v165, v173
MAA 72,80,52
TR 116,25,13472
s_waitcnt lgkmcnt(7)
MAA 104,88,52
TR 118,25,13984
MAA 104,92,72
buffer_load_dwordx4 v19, s[20:23], s54 offen offset:1024 lds
MAA 100,92,68
TR 120,25,2080
MAA 100,88,48
buffer_load_dwordx4 v20, s[20:23], s54 offen offset:2048 lds
MAA 96,88,44
s_add_u32 s54, s54, 196608
MAA 96,92,64
TR 122,25,2592
v_add_f32 v166, v166, v174
MAA 92,92,60
TR 124,25,14496
s_add_u32 m0, s55, 0
MAA 92,88,40
buffer_load_dwordx4 v21, s[16:19], s52 offen sc1 lds
MAA 124,40,96
TR 126,25,15008
MAA 124,60,100
RD 0,23,18432
MAA 128,64,100
RD 4,23,19456
MAA 128,44,96
buffer_load_dwordx4 v21, s[16:19], s52 offen offset:1024 sc1 lds
MAA 132,48,96
RD 8,23,20736
v_add_f32 v167, v167, v175
MAA 132,68,100
RD 12,23,21760
MAA 136,72,100
RD 16,24,20480
MAA 136,52,96
buffer_load_dword v22, s[16:19], s52 offen offset:2048 sc1 lds
MAA 156,56,96
s_add_u32 s52, s52, 131072
MAA 156,76,100
s_waitcnt vmcnt(17) lgkmcnt(5)
s_barrier
MAA 76,104,40
RD 20,23,27648
s_add_u32 m0, s56, 67584
MAA 76,108,60
buffer_load_dwordx4 v18, s[20:23], s54 offen lds
MAA 80,108,64
RD 24,23,28672
MAA 80,104,44
RD 28,23,29952
MAA 84,104,48
RD 32,23,30976
MAA 84,108,68
buffer_load_dwordx4 v19, s[20:23], s54 offen offset:1024 lds
MAA 88,108,72
RD 36,24,29696
MAA 88,104,52
buffer_load_dwordx4 v20, s[20:23], s54 offen offset:2048 lds
MAA 120,112,52
TR 80,25,24832
s_add_u32 s54, s54, 196608
MAA 120,116,72
TR 82,25,25344
MAA 116,116,68
TR 84,25,37248
s_add_u32 m0, s55, 9216
MAA 116,112,48
buffer_load_dwordx4 v21, s[16:19], s52 offen sc1 lds
MAA 112,112,44
TR 86,25,37760
MAA 112,116,64
TR 88,25,25856
MAA 108,116,60
TR 90,25,26368
MAA 108,112,40
buffer_load_dwordx4 v21, s[16:19], s52 offen offset:1024 sc1 lds
MAA 140,40,120
TR 92,25,38272
MAA 140,60,124
TR 94,25,38784
MAA 144,64,124
TR 96,25,26880
MAA 144,44,120
buffer_load_dword v22, s[16:19], s52 offen offset:2048 sc1 lds
MAA 148,48,120
TR 98,25,27392
s_add_u32 s52, s52, 131072
MAA 148,68,124
buffer_load_dwordx4 v[172:175], v26, s[16:19], s75 offen offset:1024 sc1
MAA 152,72,124
TR 100,25,39296
s_add_u32 s75, s75, 2048
MAA 152,52,120
TR 102,25,39808
MAA 160,56,120
MAA 160,76,124
s_waitcnt vmcnt(21) lgkmcnt(8)
s_barrier
MAA 60,80,0
TR 104,25,24864
MAA 60,84,20
TR 106,25,25376
MAA 64,84,24
TR 108,25,37280
s_add_u32 m0, s56, 80000
MAA 64,80,4
buffer_load_dwordx4 v18, s[20:23], s54 offen lds
MAA 68,80,8
TR 110,25,37792
MAA 68,84,28
TR 112,25,25888
MAA 72,84,32
TR 114,25,26400
MAA 72,80,12
TR 116,25,38304
s_waitcnt lgkmcnt(7)
MAA 104,88,12
TR 118,25,38816
MAA 104,92,32
buffer_load_dwordx4 v19, s[20:23], s54 offen offset:1024 lds
MAA 100,92,28
TR 120,25,26912
MAA 100,88,8
buffer_load_dwordx4 v20, s[20:23], s54 offen offset:2048 lds
MAA 96,88,4
s_add_u32 s54, s54, 196608
MAA 96,92,24
TR 122,25,27424
MAA 92,92,20
TR 124,25,39328
s_add_u32 m0, s55, 18432
MAA 92,88,0
buffer_load_dwordx4 v21, s[16:19], s52 offen sc1 lds
MAA 124,0,96
TR 126,25,39840
MAA 124,20,100
RD 40,23,36864
MAA 128,24,100
RD 44,23,37888
MAA 128,4,96
buffer_load_dwordx4 v21, s[16:19], s52 offen offset:1024 sc1 lds
MAA 132,8,96
RD 48,23,39168
MAA 132,28,100
RD 52,23,40192
MAA 136,32,100
RD 56,24,38912
MAA 136,12,96
buffer_load_dword v22, s[16:19], s52 offen offset:2048 sc1 lds
MAA 156,16,96
s_add_u32 s52, s52, 131072
MAA 156,36,100
s_waitcnt vmcnt(16) lgkmcnt(5)
s_barrier
MAA 76,104,0
RD 60,23,46080
MAA 76,108,20
RD 64,23,47104
MAA 80,108,24
RD 68,23,48384
s_add_u32 m0, s56, 92416
MAA 80,104,4
buffer_load_dwordx4 v18, s[20:23], s54 offen lds
MAA 84,104,8
RD 72,23,49408
MAA 84,108,28
RD 76,24,48128
MAA 88,108,32
TR 80,25,49664
MAA 88,104,12
buffer_load_dwordx4 v19, s[20:23], s54 offen offset:1024 lds
MAA 120,112,12
TR 82,25,50176
MAA 120,116,32
TR 84,25,62080
MAA 116,116,28
TR 86,25,62592
MAA 116,112,8
buffer_load_dwordx4 v20, s[20:23], s54 offen offset:2048 lds
MAA 112,112,4
s_add_u32 s54, s54, 196608
MAA 112,116,24
TR 88,25,50688
MAA 108,116,20
TR 90,25,51200
s_add_u32 m0, s55, 27648
MAA 108,112,0
buffer_load_dwordx4 v21, s[16:19], s52 offen sc1 lds
MAA 140,0,120
TR 92,25,63104
MAA 140,20,124
TR 94,25,63616
MAA 144,24,124
TR 96,25,51712
MAA 144,4,120
buffer_load_dwordx4 v21, s[16:19], s52 offen offset:1024 sc1 lds
MAA 148,8,120
TR 98,25,52224
MAA 148,28,124
TR 100,25,64128
MAA 152,32,124
TR 102,25,64640
MAA 152,12,120
buffer_load_dword v22, s[16:19], s52 offen offset:2048 sc1 lds
MAA 160,16,120
s_add_u32 s52, s52, 131072
MAA 160,36,124
s_waitcnt vmcnt(19) lgkmcnt(8)
s_barrier
MAA 60,80,40
TR 104,25,49696
s_add_u32 m0, s56, 104832
MAA 60,84,60
buffer_load_dwordx4 v18, s[20:23], s54 offen lds
MAA 64,84,64
TR 106,25,50208
v_add_f32 v164, v164, v168
MAA 64,80,44
TR 108,25,62112
MAA 68,80,48
TR 110,25,62624
MAA 68,84,68
buffer_load_dwordx4 v19, s[20:23], s54 offen offset:1024 lds
MAA 72,84,72
TR 112,25,50720
v_add_f32 v165, v165, v169
MAA 72,80,52
TR 114,25,51232
s_waitcnt lgkmcnt(6)
MAA 104,88,52
TR 116,25,63136
MAA 104,92,72
buffer_load_dwordx4 v20, s[20:23], s54 offen offset:2048 lds
MAA 100,92,68
s_add_u32 s54, s54, 196608
s_add_u32 m0, s55, 36864
MAA 100,88,48
buffer_load_dwordx4 v21, s[16:19], s52 offen sc1 lds
MAA 96,88,44
TR 118,25,63648
MAA 96,92,64
TR 120,25,51744
v_add_f32 v166, v166, v170
MAA 92,92,60
TR 122,25,52256
MAA 92,88,40
buffer_load_dwordx4 v21, s[16:19], s52 offen offset:1024 sc1 lds
MAA 124,40,96
TR 124,25,64160
MAA 124,60,100
TR 126,25,64672
v_add_f32 v167, v167, v171
MAA 128,64,100
ds_read_b128 a[0:3], v23
MAA 128,44,96
buffer_load_dword v22, s[16:19], s52 offen offset:2048 sc1 lds
MAA 132,48,96
RD 4,23,1024
s_add_u32 s52, s52, 131072
MAA 132,68,100
buffer_load_dword v27, v14, s[20:23], s44 offen
MAA 136,72,100
RD 8,23,2304
s_add_u32 s44, s44, 1572864
MAA 136,52,96
RD 12,23,3328
MAA 156,56,96
RD 16,24,2048
MAA 156,76,100
s_waitcnt vmcnt(16) lgkmcnt(5)
s_barrier
MAA 76,104,40
RD 20,23,9216
s_add_u32 m0, s56, 117248
MAA 76,108,60
buffer_load_dwordx4 v18, s[20:23], s54 offen lds
MAA 80,108,64
RD 24,23,10240
MAA 80,104,44
RD 28,23,11520
MAA 84,104,48
RD 32,23,12544
MAA 84,108,68
buffer_load_dwordx4 v19, s[20:23], s54 offen offset:1024 lds
MAA 88,108,72
RD 36,24,11264
MAA 88,104,52
buffer_load_dwordx4 v20, s[20:23], s54 offen offset:2048 lds
MAA 120,112,52
ds_read_b64_tr_b16 a[80:81], v25
s_add_u32 s54, s54, 196608
MAA 120,116,72
TR 82,25,512
MAA 116,116,68
TR 84,25,12416
s_add_u32 m0, s55, 46080
MAA 116,112,48
buffer_load_dwordx4 v21, s[16:19], s52 offen sc1 lds
MAA 112,112,44
TR 86,25,12928
MAA 112,116,64
TR 88,25,1024
MAA 108,116,60
TR 90,25,1536
MAA 108,112,40
buffer_load_dwordx4 v21, s[16:19], s52 offen offset:1024 sc1 lds
MAA 140,40,120
TR 92,25,13440
MAA 140,60,124
TR 94,25,13952
MAA 144,64,124
TR 96,25,2048
MAA 144,44,120
buffer_load_dword v22, s[16:19], s52 offen offset:2048 sc1 lds
MAA 148,48,120
TR 98,25,2560
s_add_u32 s52, s52, 131072
MAA 148,68,124
buffer_load_dwordx4 v[168:171], v26, s[16:19], s75 offen sc1
MAA 152,72,124
TR 100,25,14464
MAA 152,52,120
TR 102,25,14976
MAA 160,56,120
MAA 160,76,124
s_waitcnt vmcnt(20) lgkmcnt(8)
.Lpad27:
s_cbranch_execz .Lnopoll53r
s_barrier
MAA 60,80,0
TR 104,25,32
v_add_f32 v164, v164, v172
MAA 60,84,20
TR 106,25,544
MAA 64,84,24
TR 108,25,12448
s_add_u32 m0, s56, 129664
MAA 64,80,4
buffer_load_dwordx4 v18, s[20:23], s54 offen lds
MAA 68,80,8
TR 110,25,12960
MAA 68,84,28
TR 112,25,1056
MAA 72,84,32
TR 114,25,1568
v_add_f32 v165, v165, v173
MAA 72,80,12
TR 116,25,13472
s_waitcnt lgkmcnt(7)
MAA 104,88,12
TR 118,25,13984
MAA 104,92,32
buffer_load_dwordx4 v19, s[20:23], s54 offen offset:1024 lds
MAA 100,92,28
TR 120,25,2080
MAA 100,88,8
buffer_load_dwordx4 v20, s[20:23], s54 offen offset:2048 lds
MAA 96,88,4
s_add_u32 s54, s54, 196608
MAA 96,92,24
TR 122,25,2592
v_add_f32 v166, v166, v174
MAA 92,92,20
TR 124,25,14496
s_add_u32 m0, s55, 0
MAA 92,88,0
buffer_load_dwordx4 v21, s[16:19], s52 offen sc1 lds
MAA 124,0,96
TR 126,25,15008
MAA 124,20,100
RD 40,23,18432
MAA 128,24,100
RD 44,23,19456
MAA 128,4,96
buffer_load_dwordx4 v21, s[16:19], s52 offen offset:1024 sc1 lds
MAA 132,8,96
RD 48,23,20736
v_add_f32 v167, v167, v175
MAA 132,28,100
RD 52,23,21760
MAA 136,32,100
RD 56,24,20480
MAA 136,12,96
buffer_load_dword v22, s[16:19], s52 offen offset:2048 sc1 lds
MAA 156,16,96
s_add_u32 s52, s52, 131072
MAA 156,36,100
s_waitcnt vmcnt(17) lgkmcnt(5)
s_barrier
MAA 76,104,0
RD 60,23,27648
s_add_u32 m0, s56, 67584
MAA 76,108,20
buffer_load_dwordx4 v18, s[20:23], s54 offen lds
MAA 80,108,24
RD 64,23,28672
MAA 80,104,4
RD 68,23,29952
MAA 84,104,8
RD 72,23,30976
MAA 84,108,28
buffer_load_dwordx4 v19, s[20:23], s54 offen offset:1024 lds
MAA 88,108,32
RD 76,24,29696
MAA 88,104,12
buffer_load_dwordx4 v20, s[20:23], s54 offen offset:2048 lds
MAA 120,112,12
TR 80,25,24832
s_add_u32 s54, s54, 196608
MAA 120,116,32
TR 82,25,25344
MAA 116,116,28
TR 84,25,37248
s_add_u32 m0, s55, 9216
MAA 116,112,8
buffer_load_dwordx4 v21, s[16:19], s52 offen sc1 lds
MAA 112,112,4
TR 86,25,37760
MAA 112,116,24
TR 88,25,25856
MAA 108,116,20
TR 90,25,26368
MAA 108,112,0
buffer_load_dwordx4 v21, s[16:19], s52 offen offset:1024 sc1 lds
MAA 140,0,120
TR 92,25,38272
MAA 140,20,124
TR 94,25,38784
MAA 144,24,124
TR 96,25,26880
MAA 144,4,120
buffer_load_dword v22, s[16:19], s52 offen offset:2048 sc1 lds
MAA 148,8,120
TR 98,25,27392
s_add_u32 s52, s52, 131072
MAA 148,28,124
buffer_load_dwordx4 v[172:175], v26, s[16:19], s75 offen offset:1024 sc1
MAA 152,32,124
TR 100,25,39296
s_add_u32 s75, s75, 2048
MAA 152,12,120
TR 102,25,39808
MAA 160,16,120
MAA 160,36,124
s_waitcnt vmcnt(21) lgkmcnt(8)
s_barrier
MAA 60,80,40
TR 104,25,24864
MAA 60,84,60
TR 106,25,25376
MAA 64,84,64
TR 108,25,37280
s_add_u32 m0, s56, 80000
MAA 64,80,44
buffer_load_dwordx4 v18, s[20:23], s54 offen lds
MAA 68,80,48
TR 110,25,37792
MAA 68,84,68
TR 112,25,25888
MAA 72,84,72
TR 114,25,26400
MAA 72,80,52
TR 116,25,38304
s_waitcnt lgkmcnt(7)
MAA 104,88,52
TR 118,25,38816
MAA 104,92,72
buffer_load_dwordx4 v19, s[20:23], s54 offen offset:1024 lds
MAA 100,92,68
TR 120,25,26912
MAA 100,88,48
buffer_load_dwordx4 v20, s[20:23], s54 offen offset:2048 lds
MAA 96,88,44
s_add_u32 s54, s54, 196608
MAA 96,92,64
TR 122,25,27424
MAA 92,92,60
TR 124,25,39328
s_add_u32 m0, s55, 18432
MAA 92,88,40
buffer_load_dwordx4 v21, s[16:19], s52 offen sc1 lds
MAA 124,40,96
TR 126,25,39840
MAA 124,60,100
RD 0,23,36864
MAA 128,64,100
RD 4,23,37888
MAA 128,44,96
buffer_load_dwordx4 v21, s[16:19], s52 offen offset:1024 sc1 lds
MAA 132,48,96
RD 8,23,39168
MAA 132,68,100
RD 12,23,40192
MAA 136,72,100
RD 16,24,38912
MAA 136,52,96
buffer_load_dword v22, s[16:19], s52 offen offset:2048 sc1 lds
MAA 156,56,96
s_add_u32 s52, s52, 131072
MAA 156,76,100
s_waitcnt vmcnt(16) lgkmcnt(5)
s_barrier
MAA 76,104,40
RD 20,23,46080
MAA 76,108,60
RD 24,23,47104
MAA 80,108,64
RD 28,23,48384
s_add_u32 m0, s56, 92416
MAA 80,104,44
buffer_load_dwordx4 v18, s[20:23], s54 offen lds
MAA 84,104,48
RD 32,23,49408
MAA 84,108,68
RD 36,24,48128
MAA 88,108,72
TR 80,25,49664
MAA 88,104,52
buffer_load_dwordx4 v19, s[20:23], s54 offen offset:1024 lds
MAA 120,112,52
TR 82,25,50176
MAA 120,116,72
TR 84,25,62080
MAA 116,116,68
TR 86,25,62592
MAA 116,112,48
buffer_load_dwordx4 v20, s[20:23], s54 offen offset:2048 lds
MAA 112,112,44
s_add_u32 s54, s54, 196608
MAA 112,116,64
TR 88,25,50688
MAA 108,116,60
TR 90,25,51200
s_add_u32 m0, s55, 27648
MAA 108,112,40
buffer_load_dwordx4 v21, s[16:19], s52 offen sc1 lds
MAA 140,40,120
TR 92,25,63104
MAA 140,60,124
TR 94,25,63616
MAA 144,64,124
TR 96,25,51712
MAA 144,44,120
buffer_load_dwordx4 v21, s[16:19], s52 offen offset:1024 sc1 lds
MAA 148,48,120
TR 98,25,52224
MAA 148,68,124
TR 100,25,64128
MAA 152,72,124
TR 102,25,64640
MAA 152,52,120
buffer_load_dword v22, s[16:19], s52 offen offset:2048 sc1 lds
MAA 160,56,120
s_add_u32 s52, s52, 131072
s_add_u32 s15, s15, 1
MAA 160,76,124
s_cbranch_scc0 .Lk58
s_waitcnt vmcnt(19) lgkmcnt(8)
s_barrier
MAA 60,80,0
TR 104,25,49696
v_add_f32 v164, v164, v168
MAA 60,84,20
TR 106,25,50208
s_add_u32 m0, s56, 104832
MAA 64,84,24
buffer_load_dwordx4 v18, s[20:23], s54 offen lds
MAA 64,80,4
TR 108,25,62112
v_add_f32 v165, v165, v169
MAA 68,80,8
TR 110,25,62624
v_add_f32 v166, v166, v170
MAA 68,84,28
TR 112,25,50720
v_add_f32 v167, v167, v171
MAA 72,84,32
buffer_load_dwordx4 v19, s[20:23], s54 offen offset:1024 lds
MAA 72,80,12
TR 114,25,51232
s_waitcnt lgkmcnt(6)
MAA 104,88,12
TR 116,25,63136
MAA 104,92,32
TR 118,25,63648
MAA 100,92,28
buffer_load_dwordx4 v20, s[20:23], s54 offen offset:2048 lds
MAA 100,88,8
TR 120,25,51744
s_add_u32 s54, s54, 196608
MAA 96,88,4
TR 122,25,52256
s_add_u32 m0, s55, 36864
MAA 96,92,24
TR 124,25,64160
MAA 92,92,20
buffer_load_dwordx4 v21, s[16:19], s52 offen sc1 lds
MAA 92,88,0
TR 126,25,64672
MAA 124,0,96
ds_read_b128 a[40:43], v23
MAA 124,20,100
RD 44,23,1024
MAA 128,24,100
buffer_load_dwordx4 v21, s[16:19], s52 offen offset:1024 sc1 lds
MAA 128,4,96
RD 48,23,2304
MAA 132,8,96
RD 52,23,3328
MAA 132,28,100
RD 56,24,2048
MAA 136,32,100
buffer_load_dword v22, s[16:19], s52 offen offset:2048 sc1 lds
MAA 136,12,96
s_add_u32 s52, s52, 131072
MAA 156,16,96
MAA 156,36,100
s_waitcnt vmcnt(15) lgkmcnt(5)
s_barrier
MAA 76,104,0
RD 60,23,9216
v_add_f32 v164, v164, v172
MAA 76,108,20
RD 64,23,10240
s_add_u32 m0, s56, 117248
MAA 80,108,24
buffer_load_dwordx4 v18, s[20:23], s54 offen lds
MAA 80,104,4
RD 68,23,11520
v_add_f32 v165, v165, v173
MAA 84,104,8
RD 72,23,12544
v_add_f32 v166, v166, v174
MAA 84,108,28
RD 76,24,11264
v_add_f32 v167, v167, v175
MAA 88,108,32
buffer_load_dwordx4 v19, s[20:23], s54 offen offset:1024 lds
MAA 88,104,12
ds_read_b64_tr_b16 a[80:81], v25
MAA 120,112,12
TR 82,25,512
MAA 120,116,32
TR 84,25,12416
MAA 116,116,28
buffer_load_dwordx4 v20, s[20:23], s54 offen offset:2048 lds
MAA 116,112,8
TR 86,25,12928
s_add_u32 s54, s54, 196608
MAA 112,112,4
TR 88,25,1024
s_add_u32 m0, s55, 46080
MAA 112,116,24
TR 90,25,1536
MAA 108,116,20
buffer_load_dwordx4 v21, s[16:19], s52 offen sc1 lds
MAA 108,112,0
TR 92,25,13440
MAA 140,0,120
TR 94,25,13952
MAA 140,20,124
TR 96,25,2048
MAA 144,24,124
buffer_load_dwordx4 v21, s[16:19], s52 offen offset:1024 sc1 lds
MAA 144,4,120
TR 98,25,2560
MAA 148,8,120
TR 100,25,14464
MAA 148,28,124
TR 102,25,14976
MAA 152,32,124
buffer_load_dword v22, s[16:19], s52 offen offset:2048 sc1 lds
MAA 152,12,120
s_add_u32 s52, s52, 131072
v_permlane32_swap_b32 v164, v166
MAA 160,16,120
v_permlane32_swap_b32 v165, v167
MAA 160,36,124
s_waitcnt vmcnt(18) lgkmcnt(8)
s_barrier
MAA 60,80,40
TR 104,25,32
v_add_f32 v164, v164, v166
MAA 60,84,60
TR 106,25,544
s_add_u32 m0, s56, 129664
MAA 64,84,64
buffer_load_dwordx4 v18, s[20:23], s54 offen lds
MAA 64,80,44
TR 108,25,12448
v_add_f32 v165, v165, v167
MAA 68,80,48
TR 110,25,12960
v_mul_f32 v164, 0xba800000, v164
MAA 68,84,68
buffer_load_dwordx4 v19, s[20:23], s54 offen offset:1024 lds
MAA 72,84,72
TR 112,25,1056
v_mul_f32 v165, 0x3a800000, v165
MAA 72,80,52
TR 114,25,1568
v_fma_f32 v165, -v164, v164, v165
s_waitcnt lgkmcnt(6)
MAA 104,88,52
buffer_load_dwordx4 v20, s[20:23], s54 offen offset:2048 lds
MAA 104,92,72
TR 116,25,13472
s_add_u32 s54, s54, 196608
MAA 100,92,68
TR 118,25,13984
s_add_u32 m0, s59, 58240
MAA 100,88,48
TR 120,25,2080
s_xor_b32 s58, s87, 1966080
MAA 96,88,44
buffer_load_dwordx4 v5, s[24:27], s58 offen lds
MAA 96,92,64
TR 122,25,2592
v_max_f32 v165, 0, v165
MAA 92,92,60
TR 124,25,14496
v_add_f32 v165, 0x3727c5ac, v165
MAA 92,88,40
buffer_load_dwordx4 v6, s[24:27], s58 offen offset:1024 lds
MAA 124,40,96
TR 126,25,15008
s_add_u32 m0, s59, 0
MAA 124,60,100
RD 0,23,18432
s_xor_b32 s58, s87, 1048576
MAA 128,64,100
buffer_load_dwordx4 v5, s[24:27], s58 offen lds
MAA 128,44,96
RD 4,23,19456
MAA 132,48,96
RD 8,23,20736
MAA 132,68,100
buffer_load_dwordx4 v6, s[24:27], s58 offen offset:1024 lds
MAA 136,72,100
RD 12,23,21760
MAA 136,52,96
RD 16,24,20480
MAA 156,56,96
v_rsq_f32 v166, v165
MAA 156,76,100
v_mov_b32 v165, v166
v_mul_f32 v166, 0x3e8293ee, v166
ds_write_b128 v7, v[164:167]
s_waitcnt vmcnt(16) lgkmcnt(6)
s_barrier
MAA 76,104,40
ds_write_b32 v17, v164
MAA 76,108,60
ds_write_b32 v17, v165 offset:1024
s_add_u32 m0, s59, 8320
MAA 80,108,64
RD 20,23,27648
s_xor_b32 s58, s87, 1179648
MAA 80,104,44
buffer_load_dwordx4 v5, s[24:27], s58 offen lds
MAA 84,104,48
RD 24,23,28672
MAA 84,108,68
RD 28,23,29952
MAA 88,108,72
RD 32,23,30976
MAA 88,104,52
buffer_load_dwordx4 v6, s[24:27], s58 offen offset:1024 lds
MAA 120,112,52
RD 36,24,29696
s_add_u32 m0, s59, 66560
MAA 120,116,72
TR 80,25,24832
s_xor_b32 s58, s87, 0
MAA 116,116,68
TR 82,25,25344
MAA 116,112,48
buffer_load_dwordx4 v5, s[24:27], s58 offen lds
MAA 112,112,44
TR 84,25,37248
MAA 112,116,64
TR 86,25,37760
MAA 108,116,60
TR 88,25,25856
MAA 108,112,40
buffer_load_dwordx4 v6, s[24:27], s58 offen offset:1024 lds
MAA 140,40,120
TR 90,25,26368
s_add_u32 m0, s59, 74880
MAA 140,60,124
TR 92,25,38272
s_xor_b32 s58, s87, 131072
MAA 144,64,124
TR 94,25,38784
MAA 144,44,120
buffer_load_dwordx4 v5, s[24:27], s58 offen lds
MAA 148,48,120
TR 96,25,26880
MAA 148,68,124
TR 98,25,27392
MAA 152,72,124
TR 100,25,39296
MAA 152,52,120
buffer_load_dwordx4 v6, s[24:27], s58 offen offset:1024 lds
MAA 160,56,120
TR 102,25,39808
MAA 160,76,124
s_waitcnt vmcnt(10) lgkmcnt(0)
s_barrier
MAA 104,88,12
TR 112,25,25888
s_add_u32 m0, s59, 83200
MAA 104,92,32
TR 114,25,26400
s_xor_b32 s58, s87, 262144
MAA 100,92,28
buffer_load_dwordx4 v5, s[24:27], s58 offen lds
MAA 100,88,8
TR 116,25,38304
MAA 96,88,4
TR 118,25,38816
MAA 96,92,24
TR 120,25,26912
MAA 92,92,20
buffer_load_dwordx4 v6, s[24:27], s58 offen offset:1024 lds
MAA 92,88,0
TR 122,25,27424
s_add_u32 m0, s59, 16640
MAA 156,16,96
TR 124,25,39328
s_xor_b32 s58, s87, 1310720
MAA 156,36,100
TR 126,25,39840
MAA 72,84,32
buffer_load_dwordx4 v5, s[24:27], s58 offen lds
MAA 72,80,12
TR 104,25,24864
MAA 68,80,8
TR 106,25,25376
MAA 68,84,28
TR 108,25,37280
MAA 64,84,24
buffer_load_dwordx4 v6, s[24:27], s58 offen offset:1024 lds
MAA 64,80,4
TR 110,25,37792
s_add_u32 m0, s59, 24960
MAA 60,80,0
RD 40,23,36864
s_xor_b32 s58, s87, 1441792
MAA 60,84,20
RD 44,23,37888
s_waitcnt lgkmcnt(12)
MAA 120,112,12
buffer_load_dwordx4 v5, s[24:27], s58 offen lds
s_waitcnt lgkmcnt(10)
MAA 120,116,32
RD 48,23,39168
MAA 116,116,28
RD 52,23,40192
MAA 116,112,8
RD 56,24,38912
MAA 112,112,4
buffer_load_dwordx4 v6, s[24:27], s58 offen offset:1024 lds
.Lpad28:
s_cbranch_execz .Lnopoll53r
MAA 112,116,24
s_waitcnt lgkmcnt(5)
s_barrier
RD 60,23,46080
MAA 108,116,20
RD 64,23,47104
s_add_u32 m0, s59, 91520
MAA 108,112,0
RD 68,23,48384
s_xor_b32 s58, s87, 393216
MAA 160,16,120
RD 72,23,49408
MAA 160,36,124
RD 76,24,48128
MAA 88,108,32
TR 144,25,50688
MAA 88,104,12
TR 146,25,51200
MAA 84,104,8
TR 148,25,63104
MAA 84,108,28
TR 150,25,63616
MAA 80,108,24
TR 152,25,50720
MAA 80,104,4
TR 154,25,51232
MAA 76,104,0
TR 156,25,63136
MAA 76,108,20
TR 158,25,63648
TR 160,25,51712
TR 162,25,52224
TR 164,25,64128
s_waitcnt lgkmcnt(9)
MAA 104,144,52
TR 166,25,64640
TR 168,25,51744
TR 170,25,52256
s_waitcnt lgkmcnt(10)
MAA 104,148,72
TR 172,25,64160
MAA 100,148,68
TR 174,25,64672
MAA 100,144,48
TR 136,25,49696
MAA 96,144,44
TR 138,25,50208
MAA 96,148,64
TR 140,25,62112
MAA 92,148,60
TR 142,25,62624
MAA 92,144,40
TR 128,25,49664
s_waitcnt lgkmcnt(15)
MAA 120,152,52
TR 130,25,50176
s_waitcnt lgkmcnt(14)
MAA 120,156,72
TR 132,25,62080
MAA 116,156,68
TR 134,25,62592
MAA 116,152,48
ds_read_b128 v[232:235], v10 offset:1792
MAA 112,152,44
ds_read_b128 v[228:231], v10 offset:1536
MAA 112,156,64
ds_read_b128 v[224:227], v10 offset:1280
MAA 108,156,60
ds_read_b128 v[220:223], v10 offset:1024
MAA 108,152,40
buffer_load_dwordx4 v5, s[24:27], s58 offen lds
s_waitcnt lgkmcnt(15)
MAA 156,56,160
ds_read_b128 v[240:243], v11 offset:704
MAA 156,76,164
ds_read_b128 v[244:247], v11 offset:1728
s_waitcnt lgkmcnt(14)
MAA 160,76,172
ds_read_b128 v[18:21], v11 offset:448
MAA 160,56,168
buffer_load_dwordx4 v6, s[24:27], s58 offen offset:1024 lds
s_waitcnt lgkmcnt(13)
MAA 88,136,52
ds_read_b128 v[22:25], v11 offset:1472
s_add_u32 m0, s59, 99840
s_waitcnt lgkmcnt(12)
MAA 88,140,72
s_xor_b32 s58, s87, 524288
MAA 84,140,68
MAA 84,136,48
buffer_load_dwordx4 v5, s[24:27], s58 offen lds
MAA 80,136,44
MAA 80,140,64
MAA 76,140,60
MAA 76,136,40
buffer_load_dwordx4 v6, s[24:27], s58 offen offset:1024 lds
s_waitcnt lgkmcnt(10)
MAA 72,128,52
s_add_u32 m0, s59, 108160
s_xor_b32 s58, s87, 655360
s_waitcnt lgkmcnt(8)
MAA 72,132,72
MAA 68,132,68
MAA 68,128,48
buffer_load_dwordx4 v5, s[24:27], s58 offen lds
MAA 64,128,44
MAA 64,132,64
MAA 60,132,60
MAA 60,128,40
buffer_load_dwordx4 v6, s[24:27], s58 offen offset:1024 lds
s_waitcnt lgkmcnt(3)
v_pk_fma_f32 v[156:157], v[240:241], v[44:45], v[156:157] op_sel_hi:[1,0,1]
s_waitcnt lgkmcnt(2)
v_pk_mul_f32 v[156:157], v[156:157], v[244:245]
v_cvt_pk_bf16_f32 v236, v156, v157
v_pk_fma_f32 v[158:159], v[242:243], v[44:45], v[158:159] op_sel_hi:[1,0,1]
v_pk_mul_f32 v[158:159], v[158:159], v[246:247]
v_cvt_pk_bf16_f32 v237, v158, v159
v_pk_fma_f32 v[160:161], v[240:241], v[44:45], v[160:161] op_sel:[0,1,0] op_sel_hi:[1,1,1]
v_pk_mul_f32 v[160:161], v[160:161], v[244:245]
v_cvt_pk_bf16_f32 v238, v160, v161
v_pk_fma_f32 v[162:163], v[242:243], v[44:45], v[162:163] op_sel:[0,1,0] op_sel_hi:[1,1,1]
v_pk_mul_f32 v[162:163], v[162:163], v[246:247]
v_cvt_pk_bf16_f32 v239, v162, v163
ds_write_b128 v8, v[236:239] offset:1024
v_pk_fma_f32 v[104:105], v[36:37], v[232:233], v[104:105] op_sel_hi:[1,0,1]
v_pk_mul_f32 v[104:105], v[104:105], v[232:233] op_sel:[0,1] op_sel_hi:[1,1]
v_cvt_pk_bf16_f32 v196, v104, v105
v_pk_fma_f32 v[106:107], v[38:39], v[232:233], v[106:107] op_sel_hi:[1,0,1]
v_pk_mul_f32 v[106:107], v[106:107], v[232:233] op_sel:[0,1] op_sel_hi:[1,1]
v_cvt_pk_bf16_f32 v197, v106, v107
v_pk_fma_f32 v[120:121], v[40:41], v[232:233], v[120:121] op_sel_hi:[1,0,1]
v_pk_mul_f32 v[120:121], v[120:121], v[232:233] op_sel:[0,1] op_sel_hi:[1,1]
v_cvt_pk_bf16_f32 v198, v120, v121
v_pk_fma_f32 v[122:123], v[42:43], v[232:233], v[122:123] op_sel_hi:[1,0,1]
v_pk_mul_f32 v[122:123], v[122:123], v[232:233] op_sel:[0,1] op_sel_hi:[1,1]
v_cvt_pk_bf16_f32 v199, v122, v123
v_pk_fma_f32 v[100:101], v[36:37], v[228:229], v[100:101] op_sel_hi:[1,0,1]
v_pk_mul_f32 v[100:101], v[100:101], v[228:229] op_sel:[0,1] op_sel_hi:[1,1]
v_cvt_pk_bf16_f32 v192, v100, v101
v_pk_fma_f32 v[102:103], v[38:39], v[228:229], v[102:103] op_sel_hi:[1,0,1]
v_pk_mul_f32 v[102:103], v[102:103], v[228:229] op_sel:[0,1] op_sel_hi:[1,1]
v_cvt_pk_bf16_f32 v193, v102, v103
v_pk_fma_f32 v[116:117], v[40:41], v[228:229], v[116:117] op_sel_hi:[1,0,1]
v_pk_mul_f32 v[116:117], v[116:117], v[228:229] op_sel:[0,1] op_sel_hi:[1,1]
v_cvt_pk_bf16_f32 v194, v116, v117
v_pk_fma_f32 v[118:119], v[42:43], v[228:229], v[118:119] op_sel_hi:[1,0,1]
v_pk_mul_f32 v[118:119], v[118:119], v[228:229] op_sel:[0,1] op_sel_hi:[1,1]
v_cvt_pk_bf16_f32 v195, v118, v119
v_pk_fma_f32 v[96:97], v[36:37], v[224:225], v[96:97] op_sel_hi:[1,0,1]
v_pk_mul_f32 v[96:97], v[96:97], v[224:225] op_sel:[0,1] op_sel_hi:[1,1]
v_cvt_pk_bf16_f32 v188, v96, v97
v_pk_fma_f32 v[98:99], v[38:39], v[224:225], v[98:99] op_sel_hi:[1,0,1]
v_pk_mul_f32 v[98:99], v[98:99], v[224:225] op_sel:[0,1] op_sel_hi:[1,1]
v_cvt_pk_bf16_f32 v189, v98, v99
v_pk_fma_f32 v[112:113], v[40:41], v[224:225], v[112:113] op_sel_hi:[1,0,1]
v_pk_mul_f32 v[112:113], v[112:113], v[224:225] op_sel:[0,1] op_sel_hi:[1,1]
v_cvt_pk_bf16_f32 v190, v112, v113
v_pk_fma_f32 v[114:115], v[42:43], v[224:225], v[114:115] op_sel_hi:[1,0,1]
v_pk_mul_f32 v[114:115], v[114:115], v[224:225] op_sel:[0,1] op_sel_hi:[1,1]
v_cvt_pk_bf16_f32 v191, v114, v115
v_pk_fma_f32 v[92:93], v[36:37], v[220:221], v[92:93] op_sel_hi:[1,0,1]
v_pk_mul_f32 v[92:93], v[92:93], v[220:221] op_sel:[0,1] op_sel_hi:[1,1]
v_cvt_pk_bf16_f32 v184, v92, v93
v_pk_fma_f32 v[94:95], v[38:39], v[220:221], v[94:95] op_sel_hi:[1,0,1]
v_pk_mul_f32 v[94:95], v[94:95], v[220:221] op_sel:[0,1] op_sel_hi:[1,1]
v_cvt_pk_bf16_f32 v185, v94, v95
v_pk_fma_f32 v[108:109], v[40:41], v[220:221], v[108:109] op_sel_hi:[1,0,1]
v_pk_mul_f32 v[108:109], v[108:109], v[220:221] op_sel:[0,1] op_sel_hi:[1,1]
v_cvt_pk_bf16_f32 v186, v108, v109
v_pk_fma_f32 v[110:111], v[42:43], v[220:221], v[110:111] op_sel_hi:[1,0,1]
v_pk_mul_f32 v[110:111], v[110:111], v[220:221] op_sel:[0,1] op_sel_hi:[1,1]
v_cvt_pk_bf16_f32 v187, v110, v111
v_pk_fma_f32 v[72:73], v[28:29], v[232:233], v[72:73] op_sel_hi:[1,0,1]
v_cvt_pk_bf16_f32 v176, v72, v73
v_pk_fma_f32 v[74:75], v[30:31], v[232:233], v[74:75] op_sel_hi:[1,0,1]
v_cvt_pk_bf16_f32 v177, v74, v75
v_pk_fma_f32 v[88:89], v[32:33], v[232:233], v[88:89] op_sel_hi:[1,0,1]
v_cvt_pk_bf16_f32 v178, v88, v89
v_pk_fma_f32 v[90:91], v[34:35], v[232:233], v[90:91] op_sel_hi:[1,0,1]
v_cvt_pk_bf16_f32 v179, v90, v91
v_pk_fma_f32 v[68:69], v[28:29], v[228:229], v[68:69] op_sel_hi:[1,0,1]
v_cvt_pk_bf16_f32 v172, v68, v69
v_pk_fma_f32 v[70:71], v[30:31], v[228:229], v[70:71] op_sel_hi:[1,0,1]
v_cvt_pk_bf16_f32 v173, v70, v71
v_pk_fma_f32 v[84:85], v[32:33], v[228:229], v[84:85] op_sel_hi:[1,0,1]
v_cvt_pk_bf16_f32 v174, v84, v85
v_pk_fma_f32 v[86:87], v[34:35], v[228:229], v[86:87] op_sel_hi:[1,0,1]
v_cvt_pk_bf16_f32 v175, v86, v87
v_pk_fma_f32 v[64:65], v[28:29], v[224:225], v[64:65] op_sel_hi:[1,0,1]
v_cvt_pk_bf16_f32 v168, v64, v65
v_pk_fma_f32 v[66:67], v[30:31], v[224:225], v[66:67] op_sel_hi:[1,0,1]
v_cvt_pk_bf16_f32 v169, v66, v67
v_pk_fma_f32 v[80:81], v[32:33], v[224:225], v[80:81] op_sel_hi:[1,0,1]
v_cvt_pk_bf16_f32 v170, v80, v81
v_pk_fma_f32 v[82:83], v[34:35], v[224:225], v[82:83] op_sel_hi:[1,0,1]
v_cvt_pk_bf16_f32 v171, v82, v83
v_pk_fma_f32 v[60:61], v[28:29], v[220:221], v[60:61] op_sel_hi:[1,0,1]
v_cvt_pk_bf16_f32 v164, v60, v61
v_pk_fma_f32 v[62:63], v[30:31], v[220:221], v[62:63] op_sel_hi:[1,0,1]
v_cvt_pk_bf16_f32 v165, v62, v63
v_pk_fma_f32 v[76:77], v[32:33], v[220:221], v[76:77] op_sel_hi:[1,0,1]
v_cvt_pk_bf16_f32 v166, v76, v77
v_pk_fma_f32 v[78:79], v[34:35], v[220:221], v[78:79] op_sel_hi:[1,0,1]
s_waitcnt lgkmcnt(0)
s_barrier
v_cvt_pk_bf16_f32 v167, v78, v79
v_mfma_f32_16x16x32_bf16 v[120:123], v[196:199], v[176:179], v[50:53]
ds_read_b128 v[180:183], v9
v_mfma_f32_16x16x32_bf16 v[104:107], v[192:195], v[176:179], v[46:49]
ds_read_b64 v[200:201], v9 offset:1024
v_mfma_f32_16x16x32_bf16 v[116:119], v[192:195], v[172:175], v[50:53]
ds_read_b64 v[210:211], v9 offset:1032
v_mfma_f32_16x16x32_bf16 v[100:103], v[188:191], v[172:175], v[46:49]
ds_read_b128 v[240:243], v11 offset:384
v_mfma_f32_16x16x32_bf16 v[112:115], v[188:191], v[168:171], v[50:53]
ds_read_b128 v[244:247], v11 offset:1408
v_mfma_f32_16x16x32_bf16 v[96:99], v[184:187], v[168:171], v[46:49]
ds_read_b128 v[28:31], v11 offset:320
v_max3_f32 v88, v104, v105, v106
v_mfma_f32_16x16x32_bf16 v[108:111], v[184:187], v[164:167], v[50:53]
ds_read_b128 v[32:35], v11 offset:1344
v_max3_f32 v89, v107, v120, v121
v_max3_f32 v88, v88, v122, v123
v_max_f32 v90, v88, v89
v_max_f32 v89, v88, v89
v_max3_f32 v84, v100, v101, v102
v_max3_f32 v85, v103, v116, v117
s_waitcnt lgkmcnt(6)
v_mfma_f32_16x16x32_bf16 v[92:95], v[180:183], v[164:167], v[46:49]
ds_read_b128 v[36:39], v11 offset:256
v_permlane16_swap_b32 v90, v89
MAA 136,12,96
ds_read_b128 v[40:43], v11 offset:1280
v_max_f32 v88, v90, v89
MAA 136,32,100
v_max_f32 v89, v90, v89
v_max3_f32 v84, v84, v118, v119
MAA 136,52,160
v_permlane32_swap_b32 v88, v89
MAA 136,72,164
v_max_f32 v88, v88, v89
v_mul_f32 v88, v88, v234
MAA 152,72,172
v_max_f32 v86, v84, v85
v_max_f32 v85, v84, v85
MAA 152,52,168
s_nop 0
v_permlane16_swap_b32 v86, v85
MAA 152,32,124
v_max_f32 v84, v86, v85
v_max_f32 v85, v86, v85
MAA 152,12,120
s_nop 0
v_permlane32_swap_b32 v84, v85
v_max3_f32 v80, v96, v97, v98
v_max_f32 v84, v84, v85
v_mul_f32 v84, v84, v230
v_max3_f32 v81, v99, v112, v113
v_max3_f32 v80, v80, v114, v115
v_max_f32 v82, v80, v81
v_max_f32 v81, v80, v81
v_max3_f32 v76, v92, v93, v94
v_max3_f32 v77, v95, v108, v109
v_permlane16_swap_b32 v82, v81
v_max3_f32 v76, v76, v110, v111
v_max_f32 v80, v82, v81
v_max_f32 v81, v82, v81
v_max_f32 v78, v76, v77
v_max_f32 v77, v76, v77
v_permlane32_swap_b32 v80, v81
v_pk_fma_f32 v[104:105], v[104:105], v[234:235], v[88:89] op_sel_hi:[1,0,0] neg_lo:[0,0,1] neg_hi:[0,0,1]
v_max_f32 v80, v80, v81
v_mul_f32 v80, v80, v226
v_permlane16_swap_b32 v78, v77
v_pk_fma_f32 v[106:107], v[106:107], v[234:235], v[88:89] op_sel_hi:[1,0,0] neg_lo:[0,0,1] neg_hi:[0,0,1]
v_max_f32 v76, v78, v77
v_max_f32 v77, v78, v77
v_pk_fma_f32 v[120:121], v[120:121], v[234:235], v[88:89] op_sel_hi:[1,0,0] neg_lo:[0,0,1] neg_hi:[0,0,1]
v_pk_fma_f32 v[122:123], v[122:123], v[234:235], v[88:89] op_sel_hi:[1,0,0] neg_lo:[0,0,1] neg_hi:[0,0,1]
v_permlane32_swap_b32 v76, v77
v_pk_fma_f32 v[100:101], v[100:101], v[230:231], v[84:85] op_sel_hi:[1,0,0] neg_lo:[0,0,1] neg_hi:[0,0,1]
v_max_f32 v76, v76, v77
v_mul_f32 v76, v76, v222
v_pk_fma_f32 v[102:103], v[102:103], v[230:231], v[84:85] op_sel_hi:[1,0,0] neg_lo:[0,0,1] neg_hi:[0,0,1]
v_pk_fma_f32 v[116:117], v[116:117], v[230:231], v[84:85] op_sel_hi:[1,0,0] neg_lo:[0,0,1] neg_hi:[0,0,1]
v_pk_fma_f32 v[118:119], v[118:119], v[230:231], v[84:85] op_sel_hi:[1,0,0] neg_lo:[0,0,1] neg_hi:[0,0,1]
v_pk_fma_f32 v[96:97], v[96:97], v[226:227], v[80:81] op_sel_hi:[1,0,0] neg_lo:[0,0,1] neg_hi:[0,0,1]
v_pk_fma_f32 v[98:99], v[98:99], v[226:227], v[80:81] op_sel_hi:[1,0,0] neg_lo:[0,0,1] neg_hi:[0,0,1]
v_pk_fma_f32 v[112:113], v[112:113], v[226:227], v[80:81] op_sel_hi:[1,0,0] neg_lo:[0,0,1] neg_hi:[0,0,1]
v_pk_fma_f32 v[114:115], v[114:115], v[226:227], v[80:81] op_sel_hi:[1,0,0] neg_lo:[0,0,1] neg_hi:[0,0,1]
v_pk_fma_f32 v[92:93], v[92:93], v[222:223], v[76:77] op_sel_hi:[1,0,0] neg_lo:[0,0,1] neg_hi:[0,0,1]
v_pk_fma_f32 v[94:95], v[94:95], v[222:223], v[76:77] op_sel_hi:[1,0,0] neg_lo:[0,0,1] neg_hi:[0,0,1]
v_pk_fma_f32 v[108:109], v[108:109], v[222:223], v[76:77] op_sel_hi:[1,0,0] neg_lo:[0,0,1] neg_hi:[0,0,1]
v_pk_fma_f32 v[110:111], v[110:111], v[222:223], v[76:77] op_sel_hi:[1,0,0] neg_lo:[0,0,1] neg_hi:[0,0,1]
v_pk_fma_f32 v[136:137], v[18:19], v[44:45], v[136:137] op_sel_hi:[1,0,1]
v_pk_mul_f32 v[136:137], v[136:137], v[22:23]
v_pk_fma_f32 v[138:139], v[20:21], v[44:45], v[138:139] op_sel_hi:[1,0,1]
v_pk_mul_f32 v[138:139], v[138:139], v[24:25]
v_pk_fma_f32 v[152:153], v[18:19], v[44:45], v[152:153] op_sel:[0,1,0] op_sel_hi:[1,1,1]
v_pk_mul_f32 v[152:153], v[152:153], v[22:23]
v_pk_fma_f32 v[154:155], v[20:21], v[44:45], v[154:155] op_sel:[0,1,0] op_sel_hi:[1,1,1]
v_pk_mul_f32 v[154:155], v[154:155], v[24:25]
v_exp_f32 v104, v104
s_nop 0
MAA 132,8,96
v_exp_f32 v105, v105
MAA 132,28,100
v_exp_f32 v106, v106
MAA 132,48,160
v_exp_f32 v107, v107
MAA 132,68,164
v_exp_f32 v120, v120
MAA 148,68,172
v_exp_f32 v121, v121
MAA 148,48,168
v_exp_f32 v122, v122
MAA 148,28,124
v_exp_f32 v123, v123
MAA 148,8,120
v_exp_f32 v100, v100
MAA 128,4,96
v_exp_f32 v101, v101
MAA 128,24,100
v_exp_f32 v102, v102
MAA 128,44,160
v_exp_f32 v103, v103
MAA 128,64,164
v_exp_f32 v116, v116
MAA 144,64,172
v_exp_f32 v117, v117
MAA 144,44,168
v_exp_f32 v118, v118
MAA 144,24,124
v_exp_f32 v119, v119
MAA 144,4,120
v_exp_f32 v96, v96
MAA 124,0,96
v_exp_f32 v97, v97
MAA 124,20,100
v_exp_f32 v98, v98
MAA 124,40,160
v_exp_f32 v99, v99
MAA 124,60,164
v_exp_f32 v112, v112
MAA 140,60,172
v_exp_f32 v113, v113
MAA 140,40,168
v_exp_f32 v114, v114
MAA 140,20,124
v_exp_f32 v115, v115
MAA 140,0,120
v_cvt_pk_bf16_f32 v72, v104, v105
v_cvt_pk_bf16_f32 v73, v106, v107
v_cvt_pk_bf16_f32 v74, v120, v121
v_cvt_pk_bf16_f32 v75, v122, v123
v_cvt_pk_bf16_f32 v68, v100, v101
v_cvt_pk_bf16_f32 v69, v102, v103
v_cvt_pk_bf16_f32 v70, v116, v117
v_cvt_pk_bf16_f32 v71, v118, v119
v_cvt_pk_bf16_f32 v64, v96, v97
v_cvt_pk_bf16_f32 v65, v98, v99
v_cvt_pk_bf16_f32 v66, v112, v113
v_cvt_pk_bf16_f32 v67, v114, v115
v_cvt_pk_bf16_f32 v208, v136, v137
v_cvt_pk_bf16_f32 v209, v138, v139
v_cvt_pk_bf16_f32 v218, v152, v153
v_cvt_pk_bf16_f32 v219, v154, v155
s_waitcnt lgkmcnt(5)
v_pk_fma_f32 v[132:133], v[240:241], v[44:45], v[132:133] op_sel_hi:[1,0,1]
s_waitcnt lgkmcnt(4)
v_pk_mul_f32 v[132:133], v[132:133], v[244:245]
v_cvt_pk_bf16_f32 v206, v132, v133
v_pk_fma_f32 v[134:135], v[242:243], v[44:45], v[134:135] op_sel_hi:[1,0,1]
v_pk_mul_f32 v[134:135], v[134:135], v[246:247]
v_cvt_pk_bf16_f32 v207, v134, v135
v_pk_fma_f32 v[148:149], v[240:241], v[44:45], v[148:149] op_sel:[0,1,0] op_sel_hi:[1,1,1]
v_pk_mul_f32 v[148:149], v[148:149], v[244:245]
v_cvt_pk_bf16_f32 v216, v148, v149
v_pk_fma_f32 v[150:151], v[242:243], v[44:45], v[150:151] op_sel:[0,1,0] op_sel_hi:[1,1,1]
v_pk_mul_f32 v[150:151], v[150:151], v[246:247]
v_cvt_pk_bf16_f32 v217, v150, v151
s_waitcnt lgkmcnt(3)
v_pk_fma_f32 v[128:129], v[28:29], v[44:45], v[128:129] op_sel_hi:[1,0,1]
s_waitcnt lgkmcnt(2)
v_pk_mul_f32 v[128:129], v[128:129], v[32:33]
v_cvt_pk_bf16_f32 v204, v128, v129
v_pk_fma_f32 v[130:131], v[30:31], v[44:45], v[130:131] op_sel_hi:[1,0,1]
v_pk_mul_f32 v[130:131], v[130:131], v[34:35]
v_cvt_pk_bf16_f32 v205, v130, v131
v_pk_fma_f32 v[144:145], v[28:29], v[44:45], v[144:145] op_sel:[0,1,0] op_sel_hi:[1,1,1]
v_pk_mul_f32 v[144:145], v[144:145], v[32:33]
v_cvt_pk_bf16_f32 v214, v144, v145
v_pk_fma_f32 v[146:147], v[30:31], v[44:45], v[146:147] op_sel:[0,1,0] op_sel_hi:[1,1,1]
v_pk_mul_f32 v[146:147], v[146:147], v[34:35]
v_cvt_pk_bf16_f32 v215, v146, v147
s_waitcnt lgkmcnt(1)
v_pk_fma_f32 v[124:125], v[36:37], v[44:45], v[124:125] op_sel_hi:[1,0,1]
s_waitcnt lgkmcnt(0)
v_pk_mul_f32 v[124:125], v[124:125], v[40:41]
v_cvt_pk_bf16_f32 v202, v124, v125
v_pk_fma_f32 v[126:127], v[38:39], v[44:45], v[126:127] op_sel_hi:[1,0,1]
v_pk_mul_f32 v[126:127], v[126:127], v[42:43]
v_cvt_pk_bf16_f32 v203, v126, v127
v_pk_fma_f32 v[140:141], v[36:37], v[44:45], v[140:141] op_sel:[0,1,0] op_sel_hi:[1,1,1]
v_pk_mul_f32 v[140:141], v[140:141], v[40:41]
v_cvt_pk_bf16_f32 v212, v140, v141
v_pk_fma_f32 v[142:143], v[38:39], v[44:45], v[142:143] op_sel:[0,1,0] op_sel_hi:[1,1,1]
v_pk_mul_f32 v[142:143], v[142:143], v[42:43]
v_cvt_pk_bf16_f32 v213, v142, v143
s_nop 0
v_mfma_f32_16x16x32_bf16 v[88:91], v[248:251], v[72:75], 0
v_exp_f32 v92, v92
v_mfma_f32_16x16x32_bf16 v[104:107], v[206:209], v[72:75], 0
v_exp_f32 v93, v93
v_mfma_f32_16x16x32_bf16 v[120:123], v[216:219], v[72:75], 0
v_exp_f32 v94, v94
v_mfma_f32_16x16x32_bf16 v[84:87], v[248:251], v[68:71], 0
v_exp_f32 v95, v95
v_mfma_f32_16x16x32_bf16 v[100:103], v[204:207], v[68:71], 0
v_exp_f32 v108, v108
v_mfma_f32_16x16x32_bf16 v[116:119], v[214:217], v[68:71], 0
v_exp_f32 v109, v109
v_mfma_f32_16x16x32_bf16 v[80:83], v[248:251], v[64:67], 0
v_exp_f32 v110, v110
v_mfma_f32_16x16x32_bf16 v[96:99], v[202:205], v[64:67], 0
v_exp_f32 v111, v111
v_mfma_f32_16x16x32_bf16 v[112:115], v[212:215], v[64:67], 0
v_cvt_pk_bf16_f32 v60, v92, v93
v_cvt_pk_bf16_f32 v61, v94, v95
v_cvt_pk_bf16_f32 v62, v108, v109
v_cvt_pk_bf16_f32 v63, v110, v111
v_rcp_f32 v88, v88
v_rcp_f32 v84, v84
v_mfma_f32_16x16x32_bf16 v[76:79], v[248:251], v[60:63], 0
v_rcp_f32 v80, v80
v_mfma_f32_16x16x32_bf16 v[92:95], v[200:203], v[60:63], 0
v_mfma_f32_16x16x32_bf16 v[108:111], v[210:213], v[60:63], 0
s_nop 4
v_rcp_f32 v76, v76
v_pk_mul_f32 v[104:105], v[104:105], v[88:89] op_sel_hi:[1,0]
v_pk_mul_f32 v[106:107], v[106:107], v[88:89] op_sel_hi:[1,0]
v_pk_mul_f32 v[120:121], v[120:121], v[88:89] op_sel_hi:[1,0]
v_pk_mul_f32 v[122:123], v[122:123], v[88:89] op_sel_hi:[1,0]
v_cvt_pk_bf16_f32 v176, v104, v105
v_cvt_pk_bf16_f32 v177, v106, v107
v_cvt_pk_bf16_f32 v178, v120, v121
v_cvt_pk_bf16_f32 v179, v122, v123
buffer_store_dwordx4 v[176:179], v4, s[16:19], s74 offen offset:3072 sc1
v_pk_mul_f32 v[100:101], v[100:101], v[84:85] op_sel_hi:[1,0]
v_pk_mul_f32 v[102:103], v[102:103], v[84:85] op_sel_hi:[1,0]
v_pk_mul_f32 v[116:117], v[116:117], v[84:85] op_sel_hi:[1,0]
v_pk_mul_f32 v[118:119], v[118:119], v[84:85] op_sel_hi:[1,0]
v_cvt_pk_bf16_f32 v172, v100, v101
v_cvt_pk_bf16_f32 v173, v102, v103
v_cvt_pk_bf16_f32 v174, v116, v117
v_cvt_pk_bf16_f32 v175, v118, v119
buffer_store_dwordx4 v[172:175], v4, s[16:19], s74 offen offset:2048 sc1
v_pk_mul_f32 v[96:97], v[96:97], v[80:81] op_sel_hi:[1,0]
v_pk_mul_f32 v[98:99], v[98:99], v[80:81] op_sel_hi:[1,0]
v_pk_mul_f32 v[112:113], v[112:113], v[80:81] op_sel_hi:[1,0]
v_pk_mul_f32 v[114:115], v[114:115], v[80:81] op_sel_hi:[1,0]
v_cvt_pk_bf16_f32 v168, v96, v97
v_cvt_pk_bf16_f32 v169, v98, v99
v_cvt_pk_bf16_f32 v170, v112, v113
v_cvt_pk_bf16_f32 v171, v114, v115
buffer_store_dwordx4 v[168:171], v4, s[16:19], s74 offen offset:1024 sc1
v_pk_mul_f32 v[92:93], v[92:93], v[76:77] op_sel_hi:[1,0]
v_pk_mul_f32 v[94:95], v[94:95], v[76:77] op_sel_hi:[1,0]
v_pk_mul_f32 v[108:109], v[108:109], v[76:77] op_sel_hi:[1,0]
v_pk_mul_f32 v[110:111], v[110:111], v[76:77] op_sel_hi:[1,0]
v_cvt_pk_bf16_f32 v164, v92, v93
v_cvt_pk_bf16_f32 v165, v94, v95
v_cvt_pk_bf16_f32 v166, v108, v109
v_cvt_pk_bf16_f32 v167, v110, v111
buffer_store_dwordx4 v[164:167], v4, s[16:19], s74 offen sc1
s_nop 1
.Lqkve56:
s_lshl_b32 s62, s3, 11
s_add_u32 s62, s62, s84
v_lshl_add_u32 v4, v1, 4, s62
v_lshrrev_b32 v2, 3, v1
v_cmp_eq_u32 vcc, 3, v2
v_add_u32 v2, 67108480, v4
s_nop 0
v_cndmask_b32 v4, v4, v2, vcc
v_bfe_u32 v8, v1, 3, 2
v_mul_u32_u24 v8, 2080, v8
v_bfe_u32 v2, v1, 2, 1
v_lshl_add_u32 v8, v2, 7, v8
v_bfe_u32 v2, v1, 5, 1
v_lshl_add_u32 v8, v2, 8, v8
v_and_b32 v2, 3, v1
v_lshl_add_u32 v8, v2, 3, v8
s_mov_b32 s57, 66560
v_add_u32 v7, s57, v8
s_lshr_b32 s54, s87, 17
s_lshl_b32 s54, s54, 18
s_add_u32 s54, s54, 37748736
s_mov_b32 s52, s54
s_add_u32 s53, s54, 131072
v_accvgpr_read_b32 v32, a224
v_accvgpr_read_b32 v33, a225
v_accvgpr_read_b32 v34, a226
v_accvgpr_read_b32 v35, a227
v_accvgpr_read_b32 v36, a228
v_accvgpr_read_b32 v37, a229
v_accvgpr_read_b32 v38, a230
v_accvgpr_read_b32 v39, a231
v_accvgpr_read_b32 v40, a232
v_accvgpr_read_b32 v41, a233
v_accvgpr_read_b32 v42, a234
v_accvgpr_read_b32 v43, a235
v_accvgpr_read_b32 v44, a236
v_accvgpr_read_b32 v45, a237
v_accvgpr_read_b32 v46, a238
v_accvgpr_read_b32 v47, a239
v_accvgpr_read_b32 v48, a240
v_accvgpr_read_b32 v49, a241
v_accvgpr_read_b32 v50, a242
v_accvgpr_read_b32 v51, a243
v_accvgpr_read_b32 v52, a244
v_accvgpr_read_b32 v53, a245
v_accvgpr_read_b32 v54, a246
v_accvgpr_read_b32 v55, a247
v_accvgpr_read_b32 v56, a248
v_accvgpr_read_b32 v57, a249
v_accvgpr_read_b32 v58, a250
v_accvgpr_read_b32 v59, a251
v_accvgpr_read_b32 v60, a252
v_accvgpr_read_b32 v61, a253
v_accvgpr_read_b32 v62, a254
v_accvgpr_read_b32 v63, a255
s_lshl_b32 s62, s8, 10
s_add_u32 s62, s62, 30490624
s_lshl_b32 s64, s6, 10
s_add_u32 s64, s64, 30490624
s_lshr_b32 s67, s5, 2
s_and_b32 s67, s67, 3
s_lshl_b32 s67, s67, 7
s_add_u32 s64, s64, s67
v_lshl_add_u32 v252, v1, 7, s62
v_mov_b32 v253, s64
v_mov_b32 v255, 1
s_waitcnt vmcnt(0) lgkmcnt(0)
s_cmp_lg_u32 s3, 1
s_barrier
s_cbranch_scc1 .Lfirst61
s_mov_b64 exec, 15
buffer_atomic_add v255, v252, s[16:19], 0 offen
s_mov_b64 exec, 1
v_mov_b32 v254, 0
buffer_atomic_add v254, v253, s[16:19], 0 offen sc0
s_mov_b64 exec, -1
.Lfirst61:
s_add_u32 m0, s59, 116480
s_xor_b32 s58, s87, 786432
buffer_load_dwordx4 v5, s[24:27], s58 offen lds
buffer_load_dwordx4 v6, s[24:27], s58 offen offset:1024 lds
s_add_u32 m0, s59, 124800
s_xor_b32 s58, s87, 917504
buffer_load_dwordx4 v5, s[24:27], s58 offen lds
buffer_load_dwordx4 v6, s[24:27], s58 offen offset:1024 lds
s_add_u32 m0, s59, 33280
s_xor_b32 s58, s87, 1572864
buffer_load_dwordx4 v5, s[24:27], s58 offen lds
buffer_load_dwordx4 v6, s[24:27], s58 offen offset:1024 lds
s_add_u32 m0, s59, 41600
s_xor_b32 s58, s87, 1703936
buffer_load_dwordx4 v5, s[24:27], s58 offen lds
buffer_load_dwordx4 v6, s[24:27], s58 offen offset:1024 lds
s_add_u32 m0, s59, 49920
s_xor_b32 s58, s87, 1835008
buffer_load_dwordx4 v5, s[24:27], s58 offen lds
buffer_load_dwordx4 v6, s[24:27], s58 offen offset:1024 lds
s_cmp_lg_u32 s3, 1
.Lpad29:
s_cbranch_execz .Lnopoll53r
s_cbranch_scc1 .Lnopoll60
s_mov_b64 exec, 1
s_mov_b32 s15, 0
v_mov_b32 v255, 0
buffer_atomic_add v255, v253, s[16:19], 0 offen sc0
s_waitcnt vmcnt(11)
v_cmp_gt_u32 vcc, 16, v254
s_nop 0
s_cbranch_vccz .Lnopoll60r
.Lpoll59:
s_waitcnt vmcnt(0)
v_cmp_gt_u32 vcc, 16, v255
s_add_u32 s15, s15, 1
s_cbranch_vccz .Lnopoll60r
v_mov_b32 v255, 0
buffer_atomic_add v255, v253, s[16:19], 0 offen sc0
s_cmp_le_u32 s15, 100000
s_cbranch_scc1 .Lpoll59
s_branch .Lnopoll60r
.Lnopoll60:
s_mov_b64 exec, 0
s_cmp_eq_u32 s3, 2
s_cbranch_scc1 .Lpad30
s_cmp_eq_u32 s3, 3
s_cbranch_scc1 .Lpad31
s_branch .Lpad32
.Lnopoll60r:
s_mov_b64 exec, -1
s_waitcnt vmcnt(11)
s_barrier
buffer_load_dwordx4 v[64:67], v4, s[16:19], s52 offen sc1
buffer_load_dwordx4 v[68:71], v4, s[16:19], s52 offen offset:1024 sc1
s_xor_b32 s52, s54, 262144
buffer_load_dwordx4 v[72:75], v4, s[16:19], s53 offen sc1
buffer_load_dwordx4 v[76:79], v4, s[16:19], s53 offen offset:1024 sc1
s_xor_b32 s53, s54, 393216
buffer_load_dwordx4 v[80:83], v4, s[16:19], s52 offen sc1
buffer_load_dwordx4 v[84:87], v4, s[16:19], s52 offen offset:1024 sc1
s_xor_b32 s52, s54, 524288
buffer_load_dwordx4 v[88:91], v4, s[16:19], s53 offen sc1
buffer_load_dwordx4 v[92:95], v4, s[16:19], s53 offen offset:1024 sc1
s_xor_b32 s53, s54, 655360
buffer_load_dwordx4 v[96:99], v4, s[16:19], s52 offen sc1
buffer_load_dwordx4 v[100:103], v4, s[16:19], s52 offen offset:1024 sc1
s_xor_b32 s52, s54, 786432
buffer_load_dwordx4 v[104:107], v4, s[16:19], s53 offen sc1
buffer_load_dwordx4 v[108:111], v4, s[16:19], s53 offen offset:1024 sc1
s_xor_b32 s53, s54, 917504
ds_read_b64_tr_b16 a[0:1], v7
TR 2,7,512
TR 16,7,1024
TR 18,7,1536
TR 4,7,32
TR 6,7,544
TR 20,7,1056
TR 22,7,1568
TR 8,7,64
TR 10,7,576
TR 24,7,1088
TR 26,7,1600
TR 12,7,96
TR 14,7,608
TR 28,7,1120
TR 30,7,1632
s_lshl_b32 s62, s49, 3
s_add_u32 s62, s62, s48
s_mul_i32 s62, s62, 28672
s_add_u32 s62, s62, s51
v_lshrrev_b32 v12, 4, v1
v_mul_u32_u24 v12, 57344, v12
v_and_b32 v2, 15, v1
v_lshl_add_u32 v12, v2, 4, v12
v_add_u32 v12, s62, v12
v_add_u32 v13, 6112, v12
v_add_u32 v14, 12224, v12
v_add_u32 v15, 18336, v12
s_mul_i32 s59, s3, 4224
s_mov_b32 s58, 0
s_waitcnt vmcnt(8) lgkmcnt(14)
MAV 32,0,64
TR 32,7,8320
s_waitcnt lgkmcnt(13)
MAV 32,16,72
buffer_load_dwordx4 v[112:115], v4, s[16:19], s52 offen sc1
MAV 48,16,76
TR 34,7,8832
MAV 48,0,68
TR 48,7,9344
TR 50,7,9856
s_waitcnt lgkmcnt(14)
MAV 52,4,68
TR 36,7,8352
s_waitcnt lgkmcnt(13)
MAV 52,20,76
buffer_load_dwordx4 v[116:119], v4, s[16:19], s52 offen offset:1024 sc1
MAV 36,20,72
TR 38,7,8864
s_xor_b32 s52, s54, 1048576
MAV 36,4,64
TR 52,7,9376
TR 54,7,9888
s_waitcnt lgkmcnt(14)
MAV 40,8,64
TR 40,7,8384
s_waitcnt lgkmcnt(13)
MAV 40,24,72
buffer_load_dwordx4 v[120:123], v4, s[16:19], s53 offen sc1
MAV 56,24,76
TR 42,7,8896
MAV 56,8,68
TR 56,7,9408
TR 58,7,9920
s_waitcnt lgkmcnt(14)
MAV 60,12,68
TR 44,7,8416
s_waitcnt lgkmcnt(13)
MAV 60,28,76
buffer_load_dwordx4 v[124:127], v4, s[16:19], s53 offen offset:1024 sc1
MAV 44,28,72
TR 46,7,8928
s_xor_b32 s53, s54, 1179648
MAV 44,12,64
TR 60,7,9440
TR 62,7,9952
s_waitcnt vmcnt(8) lgkmcnt(8)
MAV 32,32,80
TR 0,7,16640
MAV 32,48,88
buffer_load_dwordx4 v[64:67], v4, s[16:19], s52 offen sc1
MAV 48,48,92
TR 2,7,17152
MAV 48,32,84
TR 16,7,17664
TR 18,7,18176
MAV 52,36,84
TR 4,7,16672
MAV 52,52,92
buffer_load_dwordx4 v[68:71], v4, s[16:19], s52 offen offset:1024 sc1
MAV 36,52,88
TR 6,7,17184
s_xor_b32 s52, s54, 1310720
MAV 36,36,80
TR 20,7,17696
TR 22,7,18208
s_waitcnt lgkmcnt(8)
MAV 40,40,80
TR 8,7,16704
MAV 40,56,88
buffer_load_dwordx4 v[72:75], v4, s[16:19], s53 offen sc1
MAV 56,56,92
TR 10,7,17216
MAV 56,40,84
TR 24,7,17728
TR 26,7,18240
MAV 60,44,84
TR 12,7,16736
MAV 60,60,92
buffer_load_dwordx4 v[76:79], v4, s[16:19], s53 offen offset:1024 sc1
MAV 44,60,88
TR 14,7,17248
s_xor_b32 s53, s54, 1441792
MAV 44,44,80
TR 28,7,17760
TR 30,7,18272
s_waitcnt vmcnt(8) lgkmcnt(8)
MAV 32,0,96
TR 32,7,24960
MAV 32,16,104
buffer_load_dwordx4 v[80:83], v4, s[16:19], s52 offen sc1
MAV 48,16,108
TR 34,7,25472
MAV 48,0,100
TR 48,7,25984
TR 50,7,26496
MAV 52,4,100
TR 36,7,24992
MAV 52,20,108
buffer_load_dwordx4 v[84:87], v4, s[16:19], s52 offen offset:1024 sc1
MAV 36,20,104
TR 38,7,25504
s_xor_b32 s52, s54, 1572864
MAV 36,4,96
TR 52,7,26016
TR 54,7,26528
s_waitcnt lgkmcnt(8)
MAV 40,8,96
TR 40,7,25024
MAV 40,24,104
buffer_load_dwordx4 v[88:91], v4, s[16:19], s53 offen sc1
MAV 56,24,108
TR 42,7,25536
MAV 56,8,100
TR 56,7,26048
TR 58,7,26560
MAV 60,12,100
TR 44,7,25056
MAV 60,28,108
buffer_load_dwordx4 v[92:95], v4, s[16:19], s53 offen offset:1024 sc1
MAV 44,28,104
TR 46,7,25568
s_xor_b32 s53, s54, 1703936
MAV 44,12,96
TR 60,7,26080
TR 62,7,26592
s_barrier
s_waitcnt vmcnt(8) lgkmcnt(8)
MAV 32,32,112
TR 0,7,33280
MAV 32,48,120
buffer_load_dwordx4 v[96:99], v4, s[16:19], s52 offen sc1
MAV 48,48,124
TR 2,7,33792
MAV 48,32,116
TR 16,7,34304
TR 18,7,34816
MAV 52,36,116
TR 4,7,33312
MAV 52,52,124
buffer_load_dwordx4 v[100:103], v4, s[16:19], s52 offen offset:1024 sc1
MAV 36,52,120
TR 6,7,33824
s_xor_b32 s52, s54, 1835008
MAV 36,36,112
TR 20,7,34336
TR 22,7,34848
s_waitcnt lgkmcnt(8)
MAV 40,40,112
TR 8,7,33344
MAV 40,56,120
buffer_load_dwordx4 v[104:107], v4, s[16:19], s53 offen sc1
MAV 56,56,124
TR 10,7,33856
MAV 56,40,116
TR 24,7,34368
TR 26,7,34880
MAV 60,44,116
TR 12,7,33376
MAV 60,60,124
buffer_load_dwordx4 v[108:111], v4, s[16:19], s53 offen offset:1024 sc1
MAV 44,60,120
TR 14,7,33888
s_xor_b32 s53, s54, 1966080
MAV 44,44,112
TR 28,7,34400
TR 30,7,34912
s_waitcnt vmcnt(8) lgkmcnt(8)
MAV 32,0,64
TR 32,7,41600
MAV 32,16,72
buffer_load_dwordx4 v[112:115], v4, s[16:19], s52 offen sc1
MAV 48,16,76
TR 34,7,42112
MAV 48,0,68
TR 48,7,42624
TR 50,7,43136
MAV 52,4,68
TR 36,7,41632
MAV 52,20,76
buffer_load_dwordx4 v[116:119], v4, s[16:19], s52 offen offset:1024 sc1
MAV 36,20,72
TR 38,7,42144
s_xor_b32 s52, s54, 2097152
MAV 36,4,64
TR 52,7,42656
TR 54,7,43168
s_waitcnt lgkmcnt(8)
MAV 40,8,64
TR 40,7,41664
MAV 40,24,72
buffer_load_dwordx4 v[120:123], v4, s[16:19], s53 offen sc1
MAV 56,24,76
TR 42,7,42176
MAV 56,8,68
TR 56,7,42688
TR 58,7,43200
MAV 60,12,68
TR 44,7,41696
MAV 60,28,76
buffer_load_dwordx4 v[124:127], v4, s[16:19], s53 offen offset:1024 sc1
MAV 44,28,72
TR 46,7,42208
s_xor_b32 s53, s54, 2228224
MAV 44,12,64
TR 60,7,42720
TR 62,7,43232
s_waitcnt vmcnt(8) lgkmcnt(8)
MAV 32,32,80
TR 0,7,49920
MAV 32,48,88
buffer_load_dwordx4 v[64:67], v4, s[16:19], s52 offen sc1
MAV 48,48,92
TR 2,7,50432
MAV 48,32,84
TR 16,7,50944
TR 18,7,51456
MAV 52,36,84
TR 4,7,49952
MAV 52,52,92
buffer_load_dwordx4 v[68:71], v4, s[16:19], s52 offen offset:1024 sc1
MAV 36,52,88
TR 6,7,50464
s_xor_b32 s52, s54, 2359296
MAV 36,36,80
TR 20,7,50976
TR 22,7,51488
s_waitcnt lgkmcnt(8)
MAV 40,40,80
TR 8,7,49984
MAV 40,56,88
buffer_load_dwordx4 v[72:75], v4, s[16:19], s53 offen sc1
MAV 56,56,92
TR 10,7,50496
MAV 56,40,84
TR 24,7,51008
TR 26,7,51520
MAV 60,44,84
TR 12,7,50016
MAV 60,60,92
buffer_load_dwordx4 v[76:79], v4, s[16:19], s53 offen offset:1024 sc1
MAV 44,60,88
TR 14,7,50528
s_xor_b32 s53, s54, 2490368
MAV 44,44,80
TR 28,7,51040
TR 30,7,51552
s_waitcnt vmcnt(8) lgkmcnt(8)
MAV 32,0,96
TR 32,7,58240
MAV 32,16,104
buffer_load_dwordx4 v[80:83], v4, s[16:19], s52 offen sc1
MAV 48,16,108
TR 34,7,58752
MAV 48,0,100
TR 48,7,59264
TR 50,7,59776
MAV 52,4,100
TR 36,7,58272
MAV 52,20,108
buffer_load_dwordx4 v[84:87], v4, s[16:19], s52 offen offset:1024 sc1
MAV 36,20,104
TR 38,7,58784
s_xor_b32 s52, s54, 2621440
MAV 36,4,96
TR 52,7,59296
TR 54,7,59808
s_waitcnt lgkmcnt(8)
MAV 40,8,96
TR 40,7,58304
MAV 40,24,104
buffer_load_dwordx4 v[88:91], v4, s[16:19], s53 offen sc1
MAV 56,24,108
TR 42,7,58816
MAV 56,8,100
TR 56,7,59328
TR 58,7,59840
MAV 60,12,100
TR 44,7,58336
MAV 60,28,108
buffer_load_dwordx4 v[92:95], v4, s[16:19], s53 offen offset:1024 sc1
MAV 44,28,104
TR 46,7,58848
s_xor_b32 s53, s54, 2752512
MAV 44,12,96
TR 60,7,59360
TR 62,7,59872
s_xor_b32 s57, s57, 66560
v_add_u32 v7, s57, v8
s_waitcnt vmcnt(8) lgkmcnt(8)
MAV 32,32,112
ds_read_b64_tr_b16 a[0:1], v7
MAV 32,48,120
buffer_load_dwordx4 v[96:99], v4, s[16:19], s52 offen sc1
MAV 48,48,124
TR 2,7,512
MAV 48,32,116
TR 16,7,1024
TR 18,7,1536
MAV 52,36,116
TR 4,7,32
MAV 52,52,124
buffer_load_dwordx4 v[100:103], v4, s[16:19], s52 offen offset:1024 sc1
MAV 36,52,120
TR 6,7,544
s_xor_b32 s52, s54, 2883584
MAV 36,36,112
TR 20,7,1056
TR 22,7,1568
s_waitcnt lgkmcnt(8)
MAV 40,40,112
TR 8,7,64
MAV 40,56,120
buffer_load_dwordx4 v[104:107], v4, s[16:19], s53 offen sc1
MAV 56,56,124
TR 10,7,576
MAV 56,40,116
TR 24,7,1088
TR 26,7,1600
MAV 60,44,116
TR 12,7,96
MAV 60,60,124
buffer_load_dwordx4 v[108:111], v4, s[16:19], s53 offen offset:1024 sc1
MAV 44,60,120
TR 14,7,608
s_xor_b32 s53, s54, 3014656
MAV 44,44,112
TR 28,7,1120
TR 30,7,1632
s_waitcnt vmcnt(8) lgkmcnt(8)
MAV 32,0,64
TR 32,7,8320
MAV 32,16,72
buffer_load_dwordx4 v[112:115], v4, s[16:19], s52 offen sc1
MAV 48,16,76
TR 34,7,8832
MAV 48,0,68
TR 48,7,9344
TR 50,7,9856
MAV 52,4,68
TR 36,7,8352
MAV 52,20,76
buffer_load_dwordx4 v[116:119], v4, s[16:19], s52 offen offset:1024 sc1
MAV 36,20,72
TR 38,7,8864
s_xor_b32 s52, s54, 3145728
MAV 36,4,64
TR 52,7,9376
TR 54,7,9888
s_waitcnt lgkmcnt(8)
MAV 40,8,64
TR 40,7,8384
MAV 40,24,72
buffer_load_dwordx4 v[120:123], v4, s[16:19], s53 offen sc1
MAV 56,24,76
TR 42,7,8896
MAV 56,8,68
TR 56,7,9408
TR 58,7,9920
MAV 60,12,68
TR 44,7,8416
MAV 60,28,76
buffer_load_dwordx4 v[124:127], v4, s[16:19], s53 offen offset:1024 sc1
MAV 44,28,72
TR 46,7,8928
s_xor_b32 s53, s54, 3276800
MAV 44,12,64
TR 60,7,9440
TR 62,7,9952
s_waitcnt vmcnt(8) lgkmcnt(8)
MAV 32,32,80
TR 0,7,16640
MAV 32,48,88
buffer_load_dwordx4 v[64:67], v4, s[16:19], s52 offen sc1
MAV 48,48,92
TR 2,7,17152
MAV 48,32,84
TR 16,7,17664
TR 18,7,18176
MAV 52,36,84
TR 4,7,16672
MAV 52,52,92
buffer_load_dwordx4 v[68:71], v4, s[16:19], s52 offen offset:1024 sc1
MAV 36,52,88
TR 6,7,17184
s_xor_b32 s52, s54, 3407872
MAV 36,36,80
TR 20,7,17696
TR 22,7,18208
s_waitcnt lgkmcnt(8)
MAV 40,40,80
TR 8,7,16704
MAV 40,56,88
buffer_load_dwordx4 v[72:75], v4, s[16:19], s53 offen sc1
MAV 56,56,92
TR 10,7,17216
MAV 56,40,84
TR 24,7,17728
TR 26,7,18240
MAV 60,44,84
TR 12,7,16736
MAV 60,60,92
buffer_load_dwordx4 v[76:79], v4, s[16:19], s53 offen offset:1024 sc1
MAV 44,60,88
TR 14,7,17248
s_xor_b32 s53, s54, 3538944
MAV 44,44,80
TR 28,7,17760
TR 30,7,18272
s_waitcnt vmcnt(8) lgkmcnt(8)
MAV 32,0,96
TR 32,7,24960
MAV 32,16,104
buffer_load_dwordx4 v[80:83], v4, s[16:19], s52 offen sc1
MAV 48,16,108
TR 34,7,25472
MAV 48,0,100
TR 48,7,25984
TR 50,7,26496
MAV 52,4,100
TR 36,7,24992
MAV 52,20,108
buffer_load_dwordx4 v[84:87], v4, s[16:19], s52 offen offset:1024 sc1
MAV 36,20,104
TR 38,7,25504
s_xor_b32 s52, s54, 3670016
MAV 36,4,96
TR 52,7,26016
TR 54,7,26528
s_waitcnt lgkmcnt(8)
MAV 40,8,96
TR 40,7,25024
MAV 40,24,104
buffer_load_dwordx4 v[88:91], v4, s[16:19], s53 offen sc1
MAV 56,24,108
TR 42,7,25536
MAV 56,8,100
TR 56,7,26048
TR 58,7,26560
MAV 60,12,100
TR 44,7,25056
MAV 60,28,108
buffer_load_dwordx4 v[92:95], v4, s[16:19], s53 offen offset:1024 sc1
MAV 44,28,104
TR 46,7,25568
s_xor_b32 s53, s54, 3801088
MAV 44,12,96
TR 60,7,26080
TR 62,7,26592
s_waitcnt vmcnt(8) lgkmcnt(8)
MAV 32,32,112
TR 0,7,33280
MAV 32,48,120
buffer_load_dwordx4 v[96:99], v4, s[16:19], s52 offen sc1
MAV 48,48,124
TR 2,7,33792
MAV 48,32,116
TR 16,7,34304
TR 18,7,34816
MAV 52,36,116
TR 4,7,33312
MAV 52,52,124
buffer_load_dwordx4 v[100:103], v4, s[16:19], s52 offen offset:1024 sc1
MAV 36,52,120
TR 6,7,33824
s_xor_b32 s52, s54, 3932160
MAV 36,36,112
TR 20,7,34336
.Lpad30:
s_cbranch_execz .Lpad33
TR 22,7,34848
s_waitcnt lgkmcnt(8)
MAV 40,40,112
TR 8,7,33344
MAV 40,56,120
buffer_load_dwordx4 v[104:107], v4, s[16:19], s53 offen sc1
MAV 56,56,124
TR 10,7,33856
MAV 56,40,116
TR 24,7,34368
TR 26,7,34880
MAV 60,44,116
TR 12,7,33376
MAV 60,60,124
buffer_load_dwordx4 v[108:111], v4, s[16:19], s53 offen offset:1024 sc1
MAV 44,60,120
TR 14,7,33888
s_xor_b32 s53, s54, 4063232
MAV 44,44,112
TR 28,7,34400
TR 30,7,34912
s_waitcnt vmcnt(8) lgkmcnt(8)
MAV 32,0,64
TR 32,7,41600
MAV 32,16,72
buffer_load_dwordx4 v[112:115], v4, s[16:19], s52 offen sc1
MAV 48,16,76
TR 34,7,42112
MAV 48,0,68
TR 48,7,42624
TR 50,7,43136
MAV 52,4,68
TR 36,7,41632
MAV 52,20,76
buffer_load_dwordx4 v[116:119], v4, s[16:19], s52 offen offset:1024 sc1
MAV 36,20,72
TR 38,7,42144
MAV 36,4,64
TR 52,7,42656
TR 54,7,43168
s_waitcnt lgkmcnt(8)
MAV 40,8,64
TR 40,7,41664
MAV 40,24,72
buffer_load_dwordx4 v[120:123], v4, s[16:19], s53 offen sc1
MAV 56,24,76
TR 42,7,42176
MAV 56,8,68
TR 56,7,42688
TR 58,7,43200
MAV 60,12,68
TR 44,7,41696
MAV 60,28,76
buffer_load_dwordx4 v[124:127], v4, s[16:19], s53 offen offset:1024 sc1
MAV 44,28,72
TR 46,7,42208
MAV 44,12,64
TR 60,7,42720
TR 62,7,43232
s_barrier
s_waitcnt vmcnt(8) lgkmcnt(8)
MAV 32,32,80
TR 0,7,49920
s_add_u32 m0, s59, 84480
MAV 32,48,88
buffer_load_dwordx4 v12, s[32:35], s58 offen lds
MAV 48,48,92
TR 2,7,50432
MAV 48,32,84
TR 16,7,50944
TR 18,7,51456
MAV 52,36,84
TR 4,7,49952
MAV 52,52,92
TR 6,7,50464
TR 20,7,50976
MAV 36,52,88
TR 22,7,51488
MAV 36,36,80
TR 8,7,49984
s_waitcnt lgkmcnt(9)
MAV 40,40,80
TR 10,7,50496
MAV 40,56,88
buffer_load_dwordx4 v13, s[32:35], s58 offen offset:1056 lds
MAV 56,56,92
TR 24,7,51008
MAV 56,40,84
buffer_load_dwordx4 v14, s[32:35], s58 offen offset:2112 lds
MAV 60,44,84
TR 26,7,51520
MAV 60,60,92
TR 12,7,50016
TR 14,7,50528
MAV 44,60,88
TR 28,7,51040
MAV 44,44,80
TR 30,7,51552
s_waitcnt vmcnt(7) lgkmcnt(8)
MAV 32,0,96
TR 32,7,58240
MAV 32,16,104
buffer_load_dwordx4 v15, s[32:35], s58 offen offset:3168 lds
MAV 48,16,108
TR 34,7,58752
MAV 48,0,100
TR 48,7,59264
TR 50,7,59776
MAV 52,4,100
TR 36,7,58272
MAV 52,20,108
TR 38,7,58784
TR 52,7,59296
MAV 36,20,104
TR 54,7,59808
MAV 36,4,96
TR 40,7,58304
s_waitcnt lgkmcnt(9)
MAV 40,8,96
TR 42,7,58816
s_add_u32 m0, s59, 101376
MAV 40,24,104
buffer_load_dwordx4 v12, s[80:83], s58 offen lds
MAV 56,24,108
TR 56,7,59328
MAV 56,8,100
buffer_load_dwordx4 v13, s[80:83], s58 offen offset:1056 lds
MAV 60,12,100
TR 58,7,59840
MAV 60,28,108
TR 44,7,58336
TR 46,7,58848
MAV 44,28,104
TR 60,7,59360
MAV 44,12,96
TR 62,7,59872
s_waitcnt vmcnt(9) lgkmcnt(14)
MAV 32,32,112
buffer_load_dwordx4 v14, s[80:83], s58 offen offset:2112 lds
s_waitcnt vmcnt(8) lgkmcnt(12)
MAV 32,48,120
s_lshl_b32 s64, s6, 14
s_lshl_b32 s65, s49, 13
s_add_u32 s64, s64, s65
s_waitcnt vmcnt(7)
MAV 48,48,124
s_lshl_b32 s65, s7, 9
s_add_u32 s64, s64, s65
s_lshl_b32 s65, s48, 8
MAV 48,32,116
s_add_u32 s64, s64, s65
s_add_u32 s64, s64, 63176704
v_and_b32 v152, 31, v1
s_waitcnt lgkmcnt(10)
MAV 52,36,116
buffer_load_dwordx4 v15, s[80:83], s58 offen offset:3168 lds
s_waitcnt lgkmcnt(8)
MAV 52,52,124
s_add_u32 s58, s58, 458752
v_lshlrev_b32 v152, 3, v152
v_lshrrev_b32 v153, 5, v1
MAV 36,52,120
s_lshl_b32 s62, s7, 18
v_lshl_add_u32 v152, v153, 28, v152
s_add_u32 s62, s62, 41943040
MAV 36,36,112
s_add_u32 s63, s62, 131072
v_cvt_pk_bf16_f32 v128, v32, v33
v_cvt_pk_bf16_f32 v129, v34, v35
s_waitcnt lgkmcnt(6)
MAV 40,40,112
v_cvt_pk_bf16_f32 v136, v48, v49
v_cvt_pk_bf16_f32 v137, v50, v51
s_waitcnt lgkmcnt(4)
MAV 40,56,120
v_cvt_pk_bf16_f32 v130, v36, v37
v_cvt_pk_bf16_f32 v131, v38, v39
MAV 56,56,124
buffer_store_dwordx4 v[128:131], v4, s[16:19], s62 offen sc1
MAV 56,40,116
v_cvt_pk_bf16_f32 v138, v52, v53
v_cvt_pk_bf16_f32 v139, v54, v55
s_waitcnt lgkmcnt(2)
MAV 60,44,116
v_cvt_pk_bf16_f32 v132, v40, v41
v_cvt_pk_bf16_f32 v133, v42, v43
s_waitcnt lgkmcnt(0)
MAV 60,60,124
v_cvt_pk_bf16_f32 v140, v56, v57
MAV 44,60,120
buffer_store_dwordx4 v[136:139], v4, s[16:19], s62 offen offset:1024 sc1
MAV 44,44,112
v_cvt_pk_bf16_f32 v141, v58, v59
s_nop 2
v_cvt_pk_bf16_f32 v142, v60, v61
v_pk_mul_f32 v[146:147], v[32:33], v[32:33]
v_pk_mul_f32 v[150:151], v[48:49], v[48:49]
v_cvt_pk_bf16_f32 v143, v62, v63
v_pk_fma_f32 v[146:147], v[34:35], v[34:35], v[146:147]
v_pk_add_f32 v[144:145], v[32:33], v[34:35]
v_pk_fma_f32 v[150:151], v[50:51], v[50:51], v[150:151]
v_cvt_pk_bf16_f32 v134, v44, v45
v_cvt_pk_bf16_f32 v135, v46, v47
buffer_store_dwordx4 v[132:135], v4, s[16:19], s63 offen sc1
v_pk_add_f32 v[148:149], v[48:49], v[50:51]
v_pk_fma_f32 v[146:147], v[36:37], v[36:37], v[146:147]
v_pk_add_f32 v[144:145], v[144:145], v[36:37]
v_pk_fma_f32 v[150:151], v[52:53], v[52:53], v[150:151]
v_pk_add_f32 v[148:149], v[148:149], v[52:53]
v_pk_fma_f32 v[146:147], v[38:39], v[38:39], v[146:147]
v_pk_add_f32 v[144:145], v[144:145], v[38:39]
v_pk_fma_f32 v[150:151], v[54:55], v[54:55], v[150:151]
v_pk_add_f32 v[148:149], v[148:149], v[54:55]
v_pk_fma_f32 v[146:147], v[40:41], v[40:41], v[146:147]
v_pk_add_f32 v[144:145], v[144:145], v[40:41]
v_pk_fma_f32 v[150:151], v[56:57], v[56:57], v[150:151]
v_pk_add_f32 v[148:149], v[148:149], v[56:57]
buffer_store_dwordx4 v[140:143], v4, s[16:19], s63 offen offset:1024 sc1
v_pk_fma_f32 v[146:147], v[42:43], v[42:43], v[146:147]
v_pk_add_f32 v[144:145], v[144:145], v[42:43]
v_pk_fma_f32 v[150:151], v[58:59], v[58:59], v[150:151]
v_pk_add_f32 v[148:149], v[148:149], v[58:59]
v_pk_fma_f32 v[146:147], v[44:45], v[44:45], v[146:147]
v_pk_add_f32 v[144:145], v[144:145], v[44:45]
v_pk_fma_f32 v[150:151], v[60:61], v[60:61], v[150:151]
v_pk_add_f32 v[148:149], v[148:149], v[60:61]
v_pk_fma_f32 v[146:147], v[46:47], v[46:47], v[146:147]
v_pk_add_f32 v[144:145], v[144:145], v[46:47]
v_pk_fma_f32 v[150:151], v[62:63], v[62:63], v[150:151]
v_pk_add_f32 v[148:149], v[148:149], v[62:63]
v_add_f32 v144, v144, v145
v_add_f32 v146, v146, v147
v_add_f32 v148, v148, v149
v_add_f32 v150, v150, v151
s_nop 0
v_permlane16_swap_b32 v144, v148
v_permlane16_swap_b32 v146, v150
v_add_f32 v144, v144, v148
v_add_f32 v146, v146, v150
s_nop 1
v_permlane32_swap_b32 v144, v146
v_add_f32 v144, v144, v146
s_nop 1
v_permlane32_swap_b32 v144, v145
buffer_store_dwordx2 v[144:145], v152, s[16:19], s64 offen sc1
s_nop 1
s_mov_b32 s54, s58
s_mov_b32 s55, s59
v_accvgpr_write_b32 a224, v32
v_accvgpr_write_b32 a225, v33
v_accvgpr_write_b32 a226, v34
v_accvgpr_write_b32 a227, v35
v_accvgpr_write_b32 a228, v36
v_accvgpr_write_b32 a229, v37
v_accvgpr_write_b32 a230, v38
v_accvgpr_write_b32 a231, v39
v_accvgpr_write_b32 a232, v40
v_accvgpr_write_b32 a233, v41
v_accvgpr_write_b32 a234, v42
v_accvgpr_write_b32 a235, v43
v_accvgpr_write_b32 a236, v44
v_accvgpr_write_b32 a237, v45
v_accvgpr_write_b32 a238, v46
v_accvgpr_write_b32 a239, v47
v_accvgpr_write_b32 a240, v48
v_accvgpr_write_b32 a241, v49
v_accvgpr_write_b32 a242, v50
v_accvgpr_write_b32 a243, v51
v_accvgpr_write_b32 a244, v52
v_accvgpr_write_b32 a245, v53
v_accvgpr_write_b32 a246, v54
v_accvgpr_write_b32 a247, v55
v_accvgpr_write_b32 a248, v56
v_accvgpr_write_b32 a249, v57
v_accvgpr_write_b32 a250, v58
v_accvgpr_write_b32 a251, v59
v_accvgpr_write_b32 a252, v60
v_accvgpr_write_b32 a253, v61
v_accvgpr_write_b32 a254, v62
v_accvgpr_write_b32 a255, v63
s_lshl_b32 s62, s10, 14
s_lshl_b32 s63, s3, 12
s_add_u32 s62, s62, s63
s_lshl_b32 s63, s12, 11
s_add_u32 s62, s62, s63
v_lshl_add_u32 v10, v1, 4, s62
v_lshrrev_b32 v2, 3, v1
v_cmp_eq_u32 vcc, 3, v2
v_add_u32 v2, 67108480, v10
s_nop 0
v_cndmask_b32 v10, v10, v2, vcc
v_xor_b32 v11, 2048, v10
v_bfe_u32 v16, v1, 2, 3
v_mul_u32_u24 v16, 1056, v16
v_bfe_u32 v2, v1, 5, 1
v_lshl_add_u32 v16, v2, 8, v16
v_and_b32 v2, 3, v1
v_lshl_add_u32 v16, v2, 3, v16
s_lshl_b32 s62, s12, 6
s_add_u32 s62, s62, 84480
s_xor_b32 s63, s12, 1
s_mul_i32 s63, s63, 192
s_add_u32 s63, s63, 84480
v_add_u32 v17, s63, v16
v_add_u32 v16, s62, v16
s_mov_b32 s52, 41943040
s_mov_b32 s53, 41943040
s_mul_i32 s59, s3, 2112
s_and_b32 s62, s7, 1
s_mul_i32 s62, s62, 3670016
s_lshr_b32 s63, s7, 1
s_lshl_b32 s63, s63, 8
s_add_u32 s62, s62, s63
s_lshl_b32 s63, s3, 12
s_add_u32 s62, s62, s63
v_lshrrev_b32 v5, 4, v1
v_lshlrev_b32 v5, 14, v5
v_and_b32 v2, 15, v1
v_lshl_add_u32 v5, v2, 4, v5
v_add_u32 v5, s62, v5
v_add_u32 v6, 992, v5
s_lshl_b32 s62, s10, 15
s_lshl_b32 s63, s3, 13
s_add_u32 s62, s62, s63
v_lshl_add_u32 v4, v1, 4, s62
s_lshl_b32 s62, s6, 10
s_add_u32 s62, s62, 30507008
s_lshl_b32 s64, s10, 1
s_lshl_b32 s64, s64, 10
s_add_u32 s64, s64, 30507008
s_lshr_b32 s67, s5, 2
s_and_b32 s67, s67, 3
s_lshl_b32 s67, s67, 7
s_add_u32 s64, s64, s67
s_add_u32 s65, s64, 1024
v_lshl_add_u32 v252, v1, 7, s62
v_mov_b32 v253, s64
v_mov_b32 v255, 1
v_writelane_b32 v253, s65, 1
s_waitcnt vmcnt(0) lgkmcnt(0)
s_cmp_lg_u32 s3, 1
s_barrier
s_cbranch_scc1 .Lfirst64
s_mov_b64 exec, 15
buffer_atomic_add v255, v252, s[16:19], 0 offen
s_mov_b64 exec, 3
v_mov_b32 v254, 0
buffer_atomic_add v254, v253, s[16:19], 0 offen sc0
s_mov_b64 exec, -1
.Lfirst64:
s_add_u32 m0, s55, 118272
s_nop 0
buffer_load_dwordx4 v12, s[32:35], s54 offen lds
buffer_load_dwordx4 v13, s[32:35], s54 offen offset:1056 lds
buffer_load_dwordx4 v14, s[32:35], s54 offen offset:2112 lds
buffer_load_dwordx4 v15, s[32:35], s54 offen offset:3168 lds
s_add_u32 m0, s55, 135168
s_nop 0
buffer_load_dwordx4 v12, s[80:83], s54 offen lds
buffer_load_dwordx4 v13, s[80:83], s54 offen offset:1056 lds
buffer_load_dwordx4 v14, s[80:83], s54 offen offset:2112 lds
buffer_load_dwordx4 v15, s[80:83], s54 offen offset:3168 lds
s_add_u32 s54, s54, 458752
s_cmp_lg_u32 s3, 1
s_cbranch_scc1 .Lnopoll63
s_mov_b64 exec, 3
s_mov_b32 s15, 0
v_mov_b32 v255, 0
buffer_atomic_add v255, v253, s[16:19], 0 offen sc0
s_waitcnt vmcnt(9)
v_cmp_gt_u32 vcc, 16, v254
s_nop 0
s_cbranch_vccz .Lnopoll63r
.Lpoll62:
s_waitcnt vmcnt(0)
v_cmp_gt_u32 vcc, 16, v255
s_add_u32 s15, s15, 1
s_cbranch_vccz .Lnopoll63r
v_mov_b32 v255, 0
buffer_atomic_add v255, v253, s[16:19], 0 offen sc0
s_cmp_le_u32 s15, 100000
s_cbranch_scc1 .Lpoll62
s_branch .Lnopoll63r
.Lnopoll63:
s_mov_b64 exec, 0
s_cmp_eq_u32 s3, 2
s_cbranch_scc1 .Lpad35
s_cmp_eq_u32 s3, 3
s_cbranch_scc1 .Lpad36
s_branch .Lpad37
.Lnopoll63r:
s_mov_b64 exec, -1
s_waitcnt vmcnt(9)
s_barrier
buffer_load_dwordx4 a[128:131], v10, s[16:19], s52 offen sc1
buffer_load_dwordx4 a[132:135], v10, s[16:19], s52 offen offset:1024 sc1
s_add_u32 s52, s52, 131072
buffer_load_dwordx4 a[144:147], v10, s[16:19], s52 offen sc1
buffer_load_dwordx4 a[148:151], v10, s[16:19], s52 offen offset:1024 sc1
s_add_u32 s52, s52, 131072
buffer_load_dwordx4 a[136:139], v11, s[16:19], s53 offen sc1
buffer_load_dwordx4 a[140:143], v11, s[16:19], s53 offen offset:1024 sc1
s_add_u32 s53, s53, 131072
buffer_load_dwordx4 a[152:155], v11, s[16:19], s53 offen sc1
buffer_load_dwordx4 a[156:159], v11, s[16:19], s53 offen offset:1024 sc1
s_add_u32 s53, s53, 131072
ds_read_b64_tr_b16 a[0:1], v16
TR 2,16,512
TR 4,16,8448
TR 6,16,8960
TR 8,16,32
TR 10,16,544
TR 12,16,8480
TR 14,16,8992
TR 16,16,64
TR 18,16,576
TR 20,16,8512
TR 22,16,9024
TR 24,16,96
TR 26,16,608
TR 28,16,8544
TR 30,16,9056
TR 32,16,128
TR 34,16,640
TR 36,16,8576
TR 38,16,9088
TR 40,16,160
TR 42,16,672
TR 44,16,8608
TR 46,16,9120
ds_read_b64_tr_b16 a[48:49], v17
TR 50,17,512
TR 52,17,8448
TR 54,17,8960
TR 56,17,32
TR 58,17,544
TR 60,17,8480
TR 62,17,8992
s_lshl_b32 s57, s3, 13
s_add_u32 s57, s57, 49920
v_lshl_add_u32 v2, v1, 4, s57
s_waitcnt lgkmcnt(0)
s_barrier
s_waitcnt vmcnt(7)
v_mfma_f32_16x16x32_bf16 v[32:35], a[0:3], a[128:131], 0
buffer_load_dwordx4 a[160:163], v10, s[16:19], s52 offen sc1
s_waitcnt vmcnt(6)
MAA 32,4,144
TR 64,16,16896
v_mfma_f32_16x16x32_bf16 v[36:39], a[0:3], a[132:135], 0
TR 66,16,17408
s_waitcnt vmcnt(5)
MAA 36,4,148
TR 68,16,25344
v_mfma_f32_16x16x32_bf16 v[52:55], a[8:11], a[132:135], 0
buffer_load_dwordx4 a[164:167], v10, s[16:19], s52 offen offset:1024 sc1
MAA 52,12,148
TR 70,16,25856
s_add_u32 s52, s52, 131072
v_mfma_f32_16x16x32_bf16 v[48:51], a[8:11], a[128:131], 0
TR 72,16,16928
MAA 48,12,144
TR 74,16,17440
v_mfma_f32_16x16x32_bf16 v[96:99], a[16:19], a[128:131], 0
buffer_load_dwordx4 a[176:179], v10, s[16:19], s52 offen sc1
MAA 96,20,144
TR 76,16,25376
v_mfma_f32_16x16x32_bf16 v[100:103], a[16:19], a[132:135], 0
TR 78,16,25888
MAA 100,20,148
TR 80,16,16960
v_mfma_f32_16x16x32_bf16 v[116:119], a[24:27], a[132:135], 0
buffer_load_dwordx4 a[180:183], v10, s[16:19], s52 offen offset:1024 sc1
MAA 116,28,148
TR 82,16,17472
s_add_u32 s52, s52, 131072
v_mfma_f32_16x16x32_bf16 v[112:115], a[24:27], a[128:131], 0
TR 84,16,25408
MAA 112,28,144
TR 86,16,25920
v_mfma_f32_16x16x32_bf16 v[160:163], a[32:35], a[128:131], 0
buffer_load_dwordx4 a[168:171], v11, s[16:19], s53 offen sc1
MAA 160,36,144
TR 88,16,16992
v_mfma_f32_16x16x32_bf16 v[164:167], a[32:35], a[132:135], 0
TR 90,16,17504
MAA 164,36,148
TR 92,16,25440
v_mfma_f32_16x16x32_bf16 v[180:183], a[40:43], a[132:135], 0
buffer_load_dwordx4 a[172:175], v11, s[16:19], s53 offen offset:1024 sc1
MAA 180,44,148
TR 94,16,25952
s_add_u32 s53, s53, 131072
v_mfma_f32_16x16x32_bf16 v[176:179], a[40:43], a[128:131], 0
TR 96,16,17024
MAA 176,44,144
TR 98,16,17536
v_mfma_f32_16x16x32_bf16 v[224:227], a[48:51], a[128:131], 0
buffer_load_dwordx4 a[184:187], v11, s[16:19], s53 offen sc1
MAA 224,52,144
TR 100,16,25472
v_mfma_f32_16x16x32_bf16 v[228:231], a[48:51], a[132:135], 0
TR 102,16,25984
MAA 228,52,148
TR 104,16,17056
v_mfma_f32_16x16x32_bf16 v[236:239], a[56:59], a[132:135], 0
buffer_load_dwordx4 a[188:191], v11, s[16:19], s53 offen offset:1024 sc1
MAA 236,60,148
TR 106,16,17568
s_add_u32 s53, s53, 131072
v_mfma_f32_16x16x32_bf16 v[232:235], a[56:59], a[128:131], 0
TR 108,16,25504
s_add_u32 m0, s55, 84480
MAA 232,60,144
TR 110,16,26016
s_waitcnt vmcnt(8)
v_mfma_f32_16x16x32_bf16 v[188:191], a[40:43], a[140:143], 0
buffer_load_dwordx4 v12, s[32:35], s54 offen lds
MAA 188,44,156
TR 112,17,16896
v_mfma_f32_16x16x32_bf16 v[184:187], a[40:43], a[136:139], 0
TR 114,17,17408
MAA 184,44,152
TR 116,17,25344
v_mfma_f32_16x16x32_bf16 v[168:171], a[32:35], a[136:139], 0
buffer_load_dwordx4 v13, s[32:35], s54 offen offset:1056 lds
MAA 168,36,152
TR 118,17,25856
v_mfma_f32_16x16x32_bf16 v[172:175], a[32:35], a[140:143], 0
TR 120,17,16928
MAA 172,36,156
TR 122,17,17440
v_mfma_f32_16x16x32_bf16 v[124:127], a[24:27], a[140:143], 0
buffer_load_dwordx4 v14, s[32:35], s54 offen offset:2112 lds
MAA 124,28,156
TR 124,17,25376
v_mfma_f32_16x16x32_bf16 v[120:123], a[24:27], a[136:139], 0
TR 126,17,25888
MAA 120,28,152
v_mfma_f32_16x16x32_bf16 v[104:107], a[16:19], a[136:139], 0
buffer_load_dwordx4 v15, s[32:35], s54 offen offset:3168 lds
MAA 104,20,152
v_mfma_f32_16x16x32_bf16 v[108:111], a[16:19], a[140:143], 0
MAA 108,20,156
v_mfma_f32_16x16x32_bf16 v[60:63], a[8:11], a[140:143], 0
MAA 60,12,156
v_mfma_f32_16x16x32_bf16 v[56:59], a[8:11], a[136:139], 0
MAA 56,12,152
v_mfma_f32_16x16x32_bf16 v[40:43], a[0:3], a[136:139], 0
MAA 40,4,152
v_mfma_f32_16x16x32_bf16 v[44:47], a[0:3], a[140:143], 0
MAA 44,4,156
s_waitcnt lgkmcnt(0)
s_barrier
v_mfma_f32_16x16x32_bf16 v[64:67], a[64:67], a[128:131], 0
TR 0,16,33792
s_add_u32 m0, s55, 101376
MAA 64,68,144
buffer_load_dwordx4 v12, s[80:83], s54 offen lds
v_mfma_f32_16x16x32_bf16 v[68:71], a[64:67], a[132:135], 0
TR 2,16,34304
s_mul_i32 s66, s13, 114688
MAA 68,68,148
TR 4,16,42240
s_mul_i32 s65, s10, 1818624
v_mfma_f32_16x16x32_bf16 v[84:87], a[72:75], a[132:135], 0
TR 6,16,42752
s_add_u32 s66, s66, s65
MAA 84,76,148
TR 8,16,33824
s_add_u32 s66, s66, 46137344
v_mfma_f32_16x16x32_bf16 v[80:83], a[72:75], a[128:131], 0
buffer_load_dwordx4 v13, s[80:83], s54 offen offset:1056 lds
MAA 80,76,144
TR 10,16,34336
s_add_u32 s65, s66, 49152
v_mfma_f32_16x16x32_bf16 v[128:131], a[80:83], a[128:131], 0
TR 12,16,42272
s_lshl_b32 s62, s12, 16
.Lpad31:
s_cbranch_execz .Lpad34
MAA 128,84,144
TR 14,16,42784
s_add_u32 s62, s62, s66
v_mfma_f32_16x16x32_bf16 v[132:135], a[80:83], a[132:135], 0
TR 16,16,33856
s_add_u32 s63, s62, 16384
MAA 132,84,148
buffer_load_dwordx4 v14, s[80:83], s54 offen offset:2112 lds
v_mfma_f32_16x16x32_bf16 v[148:151], a[88:91], a[132:135], 0
TR 18,16,34368
s_add_u32 s64, s62, 32768
MAA 148,92,148
TR 20,16,42304
s_lshl_b32 s72, s10, 1
v_mfma_f32_16x16x32_bf16 v[144:147], a[88:91], a[128:131], 0
TR 22,16,42816
s_lshr_b32 s74, s11, 4
MAA 144,92,144
TR 24,16,33888
s_add_u32 s72, s72, s74
v_mfma_f32_16x16x32_bf16 v[192:195], a[96:99], a[128:131], 0
buffer_load_dwordx4 v15, s[80:83], s54 offen offset:3168 lds
MAA 192,100,144
TR 26,16,34400
s_add_u32 s54, s54, 458752
v_mfma_f32_16x16x32_bf16 v[196:199], a[96:99], a[132:135], 0
TR 28,16,42336
s_add_u32 m0, s57, 0
MAA 196,100,148
TR 30,16,42848
s_mov_b32 s58, 63176704
v_mfma_f32_16x16x32_bf16 v[212:215], a[104:107], a[132:135], 0
TR 32,16,33920
s_lshl_b32 s72, s72, 10
MAA 212,108,148
buffer_load_dwordx4 v4, s[16:19], s58 offen sc1 lds
v_mfma_f32_16x16x32_bf16 v[208:211], a[104:107], a[128:131], 0
TR 34,16,34432
s_add_u32 s72, s72, 30523392
MAA 208,108,144
TR 36,16,42368
s_and_b32 s73, s6, 14
v_mfma_f32_16x16x32_bf16 v[240:243], a[112:115], a[128:131], 0
TR 38,16,42880
s_and_b32 s74, s7, 1
MAA 240,116,144
TR 40,16,33952
s_add_u32 s73, s73, s74
v_mfma_f32_16x16x32_bf16 v[244:247], a[112:115], a[132:135], 0
buffer_load_dwordx4 v4, s[16:19], s58 offen offset:1024 sc1 lds
MAA 244,116,148
TR 42,16,34464
s_lshl_b32 s73, s73, 10
v_mfma_f32_16x16x32_bf16 v[252:255], a[120:123], a[132:135], 0
TR 44,16,42400
s_add_u32 s73, s73, 30523392
MAA 252,124,148
TR 46,16,42912
s_lshr_b32 s67, s5, 2
v_mfma_f32_16x16x32_bf16 v[248:251], a[120:123], a[128:131], 0
TR 48,17,33792
s_and_b32 s67, s67, 3
MAA 248,124,144
buffer_load_dwordx4 a[128:131], v10, s[16:19], s52 offen sc1
v_mfma_f32_16x16x32_bf16 v[220:223], a[104:107], a[140:143], 0
TR 50,17,34304
s_lshl_b32 s67, s67, 7
MAA 220,108,156
TR 52,17,42240
s_add_u32 s73, s73, s67
v_mfma_f32_16x16x32_bf16 v[216:219], a[104:107], a[136:139], 0
TR 54,17,42752
MAA 216,108,152
TR 56,17,33824
v_mfma_f32_16x16x32_bf16 v[200:203], a[96:99], a[136:139], 0
buffer_load_dwordx4 a[132:135], v10, s[16:19], s52 offen offset:1024 sc1
MAA 200,100,152
TR 58,17,34336
s_add_u32 s52, s52, 131072
v_mfma_f32_16x16x32_bf16 v[204:207], a[96:99], a[140:143], 0
TR 60,17,42272
MAA 204,100,156
TR 62,17,42784
v_mfma_f32_16x16x32_bf16 v[156:159], a[88:91], a[140:143], 0
MAA 156,92,156
buffer_load_dwordx4 a[144:147], v10, s[16:19], s52 offen sc1
v_mfma_f32_16x16x32_bf16 v[152:155], a[88:91], a[136:139], 0
MAA 152,92,152
v_mfma_f32_16x16x32_bf16 v[136:139], a[80:83], a[136:139], 0
MAA 136,84,152
v_mfma_f32_16x16x32_bf16 v[140:143], a[80:83], a[140:143], 0
buffer_load_dwordx4 a[148:151], v10, s[16:19], s52 offen offset:1024 sc1
MAA 140,84,156
s_add_u32 s52, s52, 131072
v_mfma_f32_16x16x32_bf16 v[92:95], a[72:75], a[140:143], 0
MAA 92,76,156
v_mfma_f32_16x16x32_bf16 v[88:91], a[72:75], a[136:139], 0
MAA 88,76,152
v_mfma_f32_16x16x32_bf16 v[72:75], a[64:67], a[136:139], 0
MAA 72,68,152
v_mfma_f32_16x16x32_bf16 v[76:79], a[64:67], a[140:143], 0
MAA 76,68,156
s_waitcnt vmcnt(18) lgkmcnt(0)
s_barrier
MAA 32,0,160
buffer_load_dwordx4 a[136:139], v11, s[16:19], s53 offen sc1
MAA 32,4,176
TR 64,16,50688
s_and_b32 s74, s7, 1
MAA 36,4,180
TR 66,16,51200
s_mul_i32 s87, s74, 917504
MAA 36,0,164
TR 68,16,59136
s_lshr_b32 s75, s6, 1
MAA 52,8,164
TR 70,16,59648
s_mul_i32 s75, s75, 1818624
MAA 52,12,180
buffer_load_dwordx4 a[140:143], v11, s[16:19], s53 offen offset:1024 sc1
MAA 48,12,176
TR 72,16,50720
s_add_u32 s53, s53, 131072
MAA 48,8,160
TR 74,16,51232
s_add_u32 s87, s87, s75
MAA 96,16,160
TR 76,16,59168
s_add_u32 s87, s87, 46137344
MAA 96,20,176
TR 78,16,59680
s_and_b32 s74, s6, 3
MAA 100,20,180
buffer_load_dwordx4 a[152:155], v11, s[16:19], s53 offen sc1
MAA 100,16,164
TR 80,16,50752
s_xor_b32 s75, s74, 0
MAA 116,24,164
TR 82,16,51264
s_sub_u32 s75, s75, 0
MAA 116,28,180
TR 84,16,59200
s_mul_i32 s98, s75, 458752
MAA 112,28,176
TR 86,16,59712
s_mul_i32 s75, s75, 114688
MAA 112,24,160
buffer_load_dwordx4 a[156:159], v11, s[16:19], s53 offen offset:1024 sc1
MAA 160,32,160
TR 88,16,50784
s_add_u32 s53, s53, 131072
MAA 160,36,176
TR 90,16,51296
s_add_u32 m0, s55, 118272
MAA 164,36,180
TR 92,16,59232
s_add_u32 s76, s87, s75
MAA 164,32,164
TR 94,16,59744
s_xor_b32 s75, s74, 1
MAA 180,40,164
buffer_load_dwordx4 v12, s[32:35], s54 offen lds
MAA 180,44,180
TR 96,16,50816
s_sub_u32 s75, s75, 1
MAA 176,44,176
TR 98,16,51328
s_mul_i32 s99, s75, 458752
MAA 176,40,160
TR 100,16,59264
s_mul_i32 s75, s75, 114688
MAA 224,48,160
TR 102,16,59776
s_add_u32 s77, s87, s75
MAA 224,52,176
buffer_load_dwordx4 v13, s[32:35], s54 offen offset:1056 lds
MAA 228,52,180
TR 104,16,50848
s_xor_b32 s75, s74, 2
MAA 228,48,164
TR 106,16,51360
s_sub_u32 s75, s75, 2
MAA 236,56,164
TR 108,16,59296
s_mul_i32 s100, s75, 458752
MAA 236,60,180
TR 110,16,59808
s_mul_i32 s75, s75, 114688
MAA 232,60,176
buffer_load_dwordx4 v14, s[32:35], s54 offen offset:2112 lds
MAA 232,56,160
TR 112,17,50688
s_add_u32 s78, s87, s75
s_waitcnt vmcnt(21)
MAA 188,40,172
TR 114,17,51200
s_xor_b32 s75, s74, 3
MAA 188,44,188
TR 116,17,59136
MAA 184,44,184
TR 118,17,59648
MAA 184,40,168
buffer_load_dwordx4 v15, s[32:35], s54 offen offset:3168 lds
MAA 168,32,168
TR 120,17,50720
s_add_u32 m0, s57, 2048
MAA 168,36,184
TR 122,17,51232
s_mov_b32 s58, 63178752
MAA 172,36,188
TR 124,17,59168
MAA 172,32,172
TR 126,17,59680
MAA 124,24,172
buffer_load_dwordx4 v4, s[16:19], s58 offen sc1 lds
MAA 124,28,188
MAA 120,28,184
MAA 120,24,168
MAA 104,16,168
MAA 104,20,184
buffer_load_dwordx4 v4, s[16:19], s58 offen offset:1024 sc1 lds
MAA 108,20,188
MAA 108,16,172
MAA 60,8,172
MAA 60,12,188
MAA 56,12,184
MAA 56,8,168
MAA 40,0,168
MAA 40,4,184
MAA 44,4,188
MAA 44,0,172
s_waitcnt vmcnt(20) lgkmcnt(0)
s_barrier
MAA 64,64,160
ds_read_b64_tr_b16 a[0:1], v16
s_add_u32 m0, s55, 135168
MAA 64,68,176
buffer_load_dwordx4 v12, s[80:83], s54 offen lds
MAA 68,68,180
TR 2,16,512
s_sub_u32 s75, s75, 3
MAA 68,64,164
TR 4,16,8448
s_mul_i32 s101, s75, 458752
MAA 84,72,164
TR 6,16,8960
s_mul_i32 s75, s75, 114688
MAA 84,76,180
TR 8,16,32
s_add_u32 s79, s87, s75
MAA 80,76,176
buffer_load_dwordx4 v13, s[80:83], s54 offen offset:1056 lds
MAA 80,72,160
TR 10,16,544
s_and_b32 s87, s6, 3
MAA 128,80,160
TR 12,16,8480
s_mov_b32 s46, 0
MAA 128,84,176
TR 14,16,8992
s_lshl_b32 s74, s3, 10
MAA 132,84,180
TR 16,16,64
s_lshl_b32 s75, s12, 9
MAA 132,80,164
buffer_load_dwordx4 v14, s[80:83], s54 offen offset:2112 lds
MAA 148,88,164
TR 18,16,576
s_add_u32 s74, s74, s75
MAA 148,92,180
TR 20,16,8512
s_add_u32 s74, s74, 152576
MAA 144,92,176
TR 22,16,9024
v_and_b32 v18, 15, v1
MAA 144,88,160
TR 24,16,96
v_lshl_add_u32 v18, v18, 4, s74
MAA 192,96,160
buffer_load_dwordx4 v15, s[80:83], s54 offen offset:3168 lds
MAA 192,100,176
TR 26,16,608
s_add_u32 s54, s54, 458752
MAA 196,100,180
TR 28,16,8544
s_add_u32 m0, s57, 4096
MAA 196,96,164
TR 30,16,9056
s_mov_b32 s58, 63180800
MAA 212,104,164
TR 32,16,128
v_xor_b32 v19, 512, v18
MAA 212,108,180
buffer_load_dwordx4 v4, s[16:19], s58 offen sc1 lds
MAA 208,108,176
TR 34,16,640
s_lshl_b32 s74, s12, 7
MAA 208,104,160
TR 36,16,8576
s_add_u32 s74, s74, 161536
MAA 240,112,160
TR 38,16,9088
s_xor_b32 s75, s12, 1
MAA 240,116,176
TR 40,16,160
s_mul_i32 s75, s75, 384
MAA 244,116,180
buffer_load_dwordx4 v4, s[16:19], s58 offen offset:1024 sc1 lds
MAA 244,112,164
TR 42,16,672
s_add_u32 s75, s75, 161536
MAA 252,120,164
TR 44,16,8608
v_lshrrev_b32 v9, 4, v1
MAA 252,124,180
TR 46,16,9120
v_lshlrev_b32 v9, 4, v9
MAA 248,124,176
ds_read_b64_tr_b16 a[48:49], v17
v_add_u32 v8, s75, v9
MAA 248,120,160
buffer_load_dwordx4 a[160:163], v10, s[16:19], s52 offen sc1
MAA 220,104,172
TR 50,17,512
v_add_u32 v9, s74, v9
MAA 220,108,188
TR 52,17,8448
MAA 216,108,184
TR 54,17,8960
MAA 216,104,168
TR 56,17,32
MAA 200,96,168
buffer_load_dwordx4 a[164:167], v10, s[16:19], s52 offen offset:1024 sc1
MAA 200,100,184
TR 58,17,544
s_add_u32 s52, s52, 131072
MAA 204,100,188
TR 60,17,8480
MAA 204,96,172
TR 62,17,8992
MAA 156,88,172
MAA 156,92,188
buffer_load_dwordx4 a[176:179], v10, s[16:19], s52 offen sc1
MAA 152,92,184
MAA 152,88,168
MAA 136,80,168
MAA 136,84,184
MAA 140,84,188
buffer_load_dwordx4 a[180:183], v10, s[16:19], s52 offen offset:1024 sc1
MAA 140,80,172
s_add_u32 s52, s52, 131072
MAA 92,72,172
MAA 92,76,188
MAA 88,76,184
MAA 88,72,168
MAA 72,64,168
MAA 72,68,184
MAA 76,68,188
MAA 76,64,172
s_waitcnt vmcnt(20) lgkmcnt(0)
s_barrier
MAA 32,0,128
buffer_load_dwordx4 a[168:171], v11, s[16:19], s53 offen sc1
MAA 32,4,144
ds_read_b128 v[20:23], v2
MAA 36,4,148
ds_read_b128 v[28:31], v2 offset:1024
MAA 36,0,132
s_waitcnt vmcnt(11)
ds_read_b128 v[24:27], v2 offset:2048
MAA 52,8,132
TR 64,16,16896
MAA 52,12,148
buffer_load_dwordx4 a[172:175], v11, s[16:19], s53 offen offset:1024 sc1
MAA 48,12,144
TR 66,16,17408
s_add_u32 s53, s53, 131072
MAA 48,8,128
TR 68,16,25344
MAA 96,16,128
TR 70,16,25856
MAA 96,20,144
TR 72,16,16928
MAA 100,20,148
buffer_load_dwordx4 a[184:187], v11, s[16:19], s53 offen sc1
MAA 100,16,132
TR 74,16,17440
s_waitcnt lgkmcnt(7)
v_add_f32 v20, v20, v28
MAA 116,24,132
TR 76,16,25376
v_add_f32 v21, v21, v29
MAA 116,28,148
TR 78,16,25888
v_add_f32 v22, v22, v30
MAA 112,28,144
TR 80,16,16960
v_add_f32 v23, v23, v31
MAA 112,24,128
buffer_load_dwordx4 a[188:191], v11, s[16:19], s53 offen offset:1024 sc1
MAA 160,32,128
ds_read_b128 v[28:31], v2 offset:3072
s_add_u32 s53, s53, 131072
MAA 160,36,144
TR 82,16,17472
s_add_u32 m0, s55, 84480
MAA 164,36,148
TR 84,16,25408
s_waitcnt lgkmcnt(12)
v_add_f32 v20, v20, v24
MAA 164,32,132
TR 86,16,25920
v_add_f32 v21, v21, v25
MAA 180,40,132
buffer_load_dwordx4 v12, s[32:35], s54 offen lds
MAA 180,44,148
TR 88,16,16992
v_add_f32 v22, v22, v26
MAA 176,44,144
TR 90,16,17504
v_add_f32 v23, v23, v27
MAA 176,40,128
TR 92,16,25440
MAA 224,48,128
TR 94,16,25952
MAA 224,52,144
buffer_load_dwordx4 v13, s[32:35], s54 offen offset:1056 lds
MAA 228,52,148
TR 96,16,17024
MAA 228,48,132
TR 98,16,17536
MAA 236,56,132
TR 100,16,25472
MAA 236,60,148
TR 102,16,25984
MAA 232,60,144
buffer_load_dwordx4 v14, s[32:35], s54 offen offset:2112 lds
MAA 232,56,128
TR 104,16,17056
MAA 188,40,140
TR 106,16,17568
MAA 188,44,156
TR 108,16,25504
MAA 184,44,152
TR 110,16,26016
MAA 184,40,136
buffer_load_dwordx4 v15, s[32:35], s54 offen offset:3168 lds
MAA 168,32,136
TR 112,17,16896
s_add_u32 m0, s57, 6144
MAA 168,36,152
TR 114,17,17408
s_mov_b32 s58, 63182848
MAA 172,36,156
TR 116,17,25344
MAA 172,32,140
TR 118,17,25856
MAA 124,24,140
buffer_load_dwordx4 v4, s[16:19], s58 offen sc1 lds
MAA 124,28,156
TR 120,17,16928
MAA 120,28,152
TR 122,17,17440
MAA 120,24,136
TR 124,17,25376
MAA 104,16,136
TR 126,17,25888
MAA 104,20,152
buffer_load_dwordx4 v4, s[16:19], s58 offen offset:1024 sc1 lds
MAA 108,20,156
MAA 108,16,140
MAA 60,8,140
MAA 60,12,156
MAA 56,12,152
MAA 56,8,136
MAA 40,0,136
MAA 40,4,152
MAA 44,4,156
MAA 44,0,140
s_waitcnt lgkmcnt(0)
s_barrier
MAA 64,64,128
s_waitcnt vmcnt(14)
ds_read_b128 v[24:27], v2 offset:4096
s_add_u32 m0, s55, 101376
MAA 64,68,144
buffer_load_dwordx4 v12, s[80:83], s54 offen lds
MAA 68,68,148
TR 0,16,33792
v_add_f32 v20, v20, v28
MAA 68,64,132
TR 2,16,34304
v_add_f32 v21, v21, v29
MAA 84,72,132
TR 4,16,42240
v_add_f32 v22, v22, v30
MAA 84,76,148
TR 6,16,42752
v_add_f32 v23, v23, v31
MAA 80,76,144
ds_read_b128 v[28:31], v2 offset:5120
MAA 80,72,128
TR 8,16,33824
MAA 128,80,128
buffer_load_dwordx4 v13, s[80:83], s54 offen offset:1056 lds
MAA 128,84,144
TR 10,16,34336
s_waitcnt lgkmcnt(7)
v_add_f32 v20, v20, v24
MAA 132,84,148
TR 12,16,42272
v_add_f32 v21, v21, v25
MAA 132,80,132
TR 14,16,42784
v_add_f32 v22, v22, v26
MAA 148,88,132
TR 16,16,33856
v_add_f32 v23, v23, v27
MAA 148,92,148
TR 18,16,34368
MAA 144,92,144
TR 20,16,42304
MAA 144,88,128
buffer_load_dwordx4 v14, s[80:83], s54 offen offset:2112 lds
MAA 192,96,128
TR 22,16,42816
MAA 192,100,144
TR 24,16,33888
MAA 196,100,148
TR 26,16,34400
MAA 196,96,132
TR 28,16,42336
MAA 212,104,132
TR 30,16,42848
MAA 212,108,148
TR 32,16,33920
MAA 208,108,144
buffer_load_dwordx4 v15, s[80:83], s54 offen offset:3168 lds
MAA 208,104,128
TR 34,16,34432
s_add_u32 s54, s54, 458752
MAA 240,112,128
TR 36,16,42368
MAA 240,116,144
TR 38,16,42880
MAA 244,116,148
TR 40,16,33952
MAA 244,112,132
.Lpad32:
s_cbranch_execz .Lnopoll60r
TR 42,16,34464
MAA 252,120,132
TR 44,16,42400
MAA 252,124,148
TR 46,16,42912
MAA 248,124,144
TR 48,17,33792
MAA 248,120,128
buffer_load_dwordx4 a[128:131], v10, s[16:19], s52 offen sc1
MAA 220,104,140
TR 50,17,34304
MAA 220,108,156
TR 52,17,42240
MAA 216,108,152
TR 54,17,42752
MAA 216,104,136
TR 56,17,33824
MAA 200,96,136
TR 58,17,34336
MAA 200,100,152
TR 60,17,42272
MAA 204,100,156
buffer_load_dwordx4 a[132:135], v10, s[16:19], s52 offen offset:1024 sc1
MAA 204,96,140
TR 62,17,42784
s_add_u32 s52, s52, 131072
MAA 156,88,140
MAA 156,92,156
MAA 152,92,152
MAA 152,88,136
MAA 136,80,136
MAA 136,84,152
buffer_load_dwordx4 a[144:147], v10, s[16:19], s52 offen sc1
MAA 140,84,156
MAA 140,80,140
MAA 92,72,140
MAA 92,76,156
MAA 88,76,152
MAA 88,72,136
MAA 72,64,136
buffer_load_dwordx4 a[148:151], v10, s[16:19], s52 offen offset:1024 sc1
MAA 72,68,152
s_add_u32 s52, s52, 131072
MAA 76,68,156
MAA 76,64,140
s_waitcnt vmcnt(18) lgkmcnt(0)
s_barrier
MAA 32,0,160
buffer_load_dwordx4 a[136:139], v11, s[16:19], s53 offen sc1
MAA 32,4,176
s_waitcnt vmcnt(9)
ds_read_b128 v[24:27], v2 offset:6144
v_add_f32 v20, v20, v28
MAA 36,4,180
TR 64,16,50688
v_add_f32 v21, v21, v29
MAA 36,0,164
TR 66,16,51200
v_add_f32 v22, v22, v30
MAA 52,8,164
TR 68,16,59136
v_add_f32 v23, v23, v31
MAA 52,12,180
ds_read_b128 v[28:31], v2 offset:7168
MAA 48,12,176
TR 70,16,59648
MAA 48,8,160
buffer_load_dwordx4 a[140:143], v11, s[16:19], s53 offen offset:1024 sc1
MAA 96,16,160
TR 72,16,50720
s_add_u32 s53, s53, 131072
MAA 96,20,176
TR 74,16,51232
s_waitcnt lgkmcnt(7)
v_add_f32 v20, v20, v24
MAA 100,20,180
TR 76,16,59168
v_add_f32 v21, v21, v25
MAA 100,16,164
TR 78,16,59680
v_add_f32 v22, v22, v26
MAA 116,24,164
TR 80,16,50752
v_add_f32 v23, v23, v27
MAA 116,28,180
TR 82,16,51264
s_waitcnt lgkmcnt(7)
v_add_f32 v20, v20, v28
MAA 112,28,176
buffer_load_dwordx4 a[152:155], v11, s[16:19], s53 offen sc1
MAA 112,24,160
TR 84,16,59200
v_add_f32 v21, v21, v29
MAA 160,32,160
TR 86,16,59712
v_add_f32 v22, v22, v30
MAA 160,36,176
TR 88,16,50784
v_add_f32 v23, v23, v31
MAA 164,36,180
TR 90,16,51296
MAA 164,32,164
TR 92,16,59232
MAA 180,40,164
TR 94,16,59744
MAA 180,44,180
buffer_load_dwordx4 a[156:159], v11, s[16:19], s53 offen offset:1024 sc1
MAA 176,44,176
TR 96,16,50816
s_add_u32 s53, s53, 131072
MAA 176,40,160
TR 98,16,51328
s_add_u32 m0, s55, 118272
MAA 224,48,160
TR 100,16,59264
MAA 224,52,176
TR 102,16,59776
MAA 228,52,180
TR 104,16,50848
MAA 228,48,164
TR 106,16,51360
MAA 236,56,164
buffer_load_dwordx4 v12, s[32:35], s54 offen lds
MAA 236,60,180
TR 108,16,59296
MAA 232,60,176
TR 110,16,59808
MAA 232,56,160
TR 112,17,50688
MAA 188,40,172
TR 114,17,51200
MAA 188,44,188
TR 116,17,59136
MAA 184,44,184
TR 118,17,59648
MAA 184,40,168
buffer_load_dwordx4 v13, s[32:35], s54 offen offset:1056 lds
MAA 168,32,168
TR 120,17,50720
MAA 168,36,184
TR 122,17,51232
MAA 172,36,188
TR 124,17,59168
MAA 172,32,172
TR 126,17,59680
MAA 124,24,172
MAA 124,28,188
MAA 120,28,184
buffer_load_dwordx4 v14, s[32:35], s54 offen offset:2112 lds
MAA 120,24,168
MAA 104,16,168
MAA 104,20,184
MAA 108,20,188
MAA 108,16,172
MAA 60,8,172
MAA 60,12,188
buffer_load_dwordx4 v15, s[32:35], s54 offen offset:3168 lds
MAA 56,12,184
MAA 56,8,168
MAA 40,0,168
MAA 40,4,184
MAA 44,4,188
MAA 44,0,172
s_waitcnt lgkmcnt(0)
s_barrier
MAA 64,64,160
ds_read_b64_tr_b16 a[0:1], v16
s_add_u32 m0, s55, 135168
MAA 64,68,176
buffer_load_dwordx4 v12, s[80:83], s54 offen lds
MAA 68,68,180
TR 2,16,512
v_permlane32_swap_b32 v20, v22
MAA 68,64,164
TR 4,16,8448
v_permlane32_swap_b32 v21, v23
MAA 84,72,164
TR 6,16,8960
v_add_f32 v20, v20, v22
MAA 84,76,180
TR 8,16,32
v_add_f32 v21, v21, v23
MAA 80,76,176
TR 10,16,544
v_mul_f32 v20, 0xba800000, v20
MAA 80,72,160
buffer_load_dwordx4 v13, s[80:83], s54 offen offset:1056 lds
MAA 128,80,160
TR 12,16,8480
v_mul_f32 v21, 0x3a800000, v21
MAA 128,84,176
TR 14,16,8992
v_fma_f32 v21, -v20, v20, v21
MAA 132,84,180
TR 16,16,64
v_max_f32 v21, 0, v21
MAA 132,80,164
TR 18,16,576
v_add_f32 v21, 0x3727c5ac, v21
MAA 148,88,164
TR 20,16,8512
v_rsq_f32 v22, v21
MAA 148,92,180
buffer_load_dwordx4 v14, s[80:83], s54 offen offset:2112 lds
MAA 144,92,176
TR 22,16,9024
v_and_b32 v24, 31, v1
MAA 144,88,160
TR 24,16,96
v_lshrrev_b32 v25, 5, v1
MAA 192,96,160
TR 26,16,608
v_lshl_add_u32 v24, v24, 1, v25
MAA 192,100,176
TR 28,16,8544
v_and_b32 v25, 0xc0, v0
MAA 196,100,180
TR 30,16,9056
v_add_u32 v24, v24, v25
MAA 196,96,164
TR 32,16,128
v_lshlrev_b32 v24, 4, v24
MAA 212,104,164
buffer_load_dwordx4 v15, s[80:83], s54 offen offset:3168 lds
MAA 212,108,180
TR 34,16,640
s_add_u32 s54, s54, 458752
MAA 208,108,176
TR 36,16,8576
v_add_u32 v24, 152576, v24
MAA 208,104,160
TR 38,16,9088
v_mul_f32 v22, 0xbfb8aa3b, v22
MAA 240,112,160
ds_write_b128 v24, v[20:23]
s_mov_b32 s58, s98
MAA 240,116,176
ds_read_b64 v[20:21], v18
s_mov_b32 s67, s59
MAA 244,116,180
ds_read_b64 v[22:23], v18 offset:256
MAA 244,112,164
ds_read_b64 v[24:25], v19
MAA 252,120,164
ds_read_b64 v[26:27], v19 offset:256
MAA 252,124,180
ds_read_b32 a192, v18 offset:8
MAA 248,124,176
ds_read_b32 a193, v18 offset:264
v_mov_b32 v18, v5
MAA 248,120,160
buffer_load_dwordx4 a[160:163], v10, s[16:19], s52 offen sc1
MAA 220,104,172
ds_read_b32 a194, v19 offset:8
MAA 220,108,188
ds_read_b32 a195, v19 offset:264
v_add_u32 v19, 992, v5
MAA 216,108,184
TR 40,16,160
MAA 216,104,168
TR 42,16,672
MAA 200,96,168
TR 44,16,8608
MAA 200,100,184
TR 46,16,9120
MAA 204,100,188
buffer_load_dwordx4 a[164:167], v10, s[16:19], s52 offen offset:1024 sc1
MAA 204,96,172
ds_read_b64_tr_b16 a[48:49], v17
s_add_u32 s52, s52, 131072
MAA 156,88,172
TR 50,17,512
MAA 156,92,188
TR 52,17,8448
MAA 152,92,184
TR 54,17,8960
MAA 152,88,168
TR 56,17,32
MAA 136,80,168
TR 58,17,544
MAA 136,84,184
buffer_load_dwordx4 a[176:179], v10, s[16:19], s52 offen sc1
MAA 140,84,188
TR 60,17,8480
MAA 140,80,172
TR 62,17,8992
MAA 92,72,172
MAA 92,76,188
MAA 88,76,184
MAA 88,72,168
MAA 72,64,168
buffer_load_dwordx4 a[180:183], v10, s[16:19], s52 offen offset:1024 sc1
MAA 72,68,184
s_add_u32 s52, s52, 131072
MAA 76,68,188
MAA 76,64,172
s_waitcnt vmcnt(16) lgkmcnt(0)
s_barrier
MAA 32,0,128
ds_read_b128 v[28:31], v9 offset:512
MAA 32,4,144
ds_read_b128 v[4:7], v9 offset:576
MAA 36,4,148
buffer_load_dwordx4 a[168:171], v11, s[16:19], s53 offen sc1
MAA 36,0,132
TR 64,16,16896
MAA 52,8,132
TR 66,16,17408
MAA 52,12,148
TR 68,16,25344
MAA 48,12,144
TR 70,16,25856
MAA 48,8,128
TR 72,16,16928
MAA 96,16,128
buffer_load_dwordx4 a[172:175], v11, s[16:19], s53 offen offset:1024 sc1
MAA 96,20,144
TR 74,16,17440
s_add_u32 s53, s53, 131072
MAA 100,20,148
TR 76,16,25376
s_waitcnt lgkmcnt(8)
v_fmac_f32 v64, v28, v20
MAA 100,16,132
TR 78,16,25888
v_fmac_f32 v65, v29, v20
MAA 116,24,132
TR 80,16,16960
v_fmac_f32 v66, v30, v20
MAA 116,28,148
TR 82,16,17472
v_fmac_f32 v67, v31, v20
MAA 112,28,144
buffer_load_dwordx4 a[184:187], v11, s[16:19], s53 offen sc1
MAA 112,24,128
TR 84,16,25408
v_fmac_f32 v68, v28, v22
MAA 160,32,128
TR 86,16,25920
v_fmac_f32 v69, v29, v22
MAA 160,36,144
TR 88,16,16992
v_fmac_f32 v70, v30, v22
MAA 164,36,148
TR 90,16,17504
v_fmac_f32 v71, v31, v22
MAA 164,32,132
TR 92,16,25440
v_fmac_f32 v72, v28, v24
MAA 180,40,132
buffer_load_dwordx4 a[188:191], v11, s[16:19], s53 offen offset:1024 sc1
MAA 180,44,148
TR 94,16,25952
s_add_u32 s53, s53, 131072
MAA 176,44,144
TR 96,16,17024
s_add_u32 m0, s55, 84480
MAA 176,40,128
TR 98,16,17536
v_fmac_f32 v73, v29, v24
MAA 224,48,128
TR 100,16,25472
v_fmac_f32 v74, v30, v24
MAA 224,52,144
TR 102,16,25984
v_fmac_f32 v75, v31, v24
MAA 228,52,148
buffer_load_dwordx4 v12, s[32:35], s54 offen lds
MAA 228,48,132
TR 104,16,17056
v_fmac_f32 v76, v28, v26
MAA 236,56,132
TR 106,16,17568
v_fmac_f32 v77, v29, v26
MAA 236,60,148
TR 108,16,25504
v_fmac_f32 v78, v30, v26
MAA 232,60,144
TR 110,16,26016
v_fmac_f32 v79, v31, v26
MAA 232,56,128
ds_read_b128 v[28:31], v9 offset:640
s_waitcnt lgkmcnt(15)
v_fmac_f32 v80, v4, v20
s_waitcnt vmcnt(17)
MAA 188,40,140
buffer_load_dwordx4 v13, s[32:35], s54 offen offset:1056 lds
MAA 188,44,156
TR 112,17,16896
v_fmac_f32 v81, v5, v20
MAA 184,44,152
TR 114,17,17408
v_fmac_f32 v82, v6, v20
MAA 184,40,136
TR 116,17,25344
v_fmac_f32 v83, v7, v20
MAA 168,32,136
TR 118,17,25856
v_fmac_f32 v84, v4, v22
MAA 168,36,152
TR 120,17,16928
v_fmac_f32 v85, v5, v22
MAA 172,36,156
buffer_load_dwordx4 v14, s[32:35], s54 offen offset:2112 lds
MAA 172,32,140
TR 122,17,17440
v_fmac_f32 v86, v6, v22
MAA 124,24,140
TR 124,17,25376
v_fmac_f32 v87, v7, v22
MAA 124,28,156
TR 126,17,25888
v_fmac_f32 v88, v4, v24
MAA 120,28,152
v_fmac_f32 v89, v5, v24
v_fmac_f32 v90, v6, v24
MAA 120,24,136
v_fmac_f32 v91, v7, v24
v_fmac_f32 v92, v4, v26
MAA 104,16,136
buffer_load_dwordx4 v15, s[32:35], s54 offen offset:3168 lds
MAA 104,20,152
s_mov_b32 m0, s67
v_fmac_f32 v93, v5, v26
v_fmac_f32 v94, v6, v26
MAA 108,20,156
v_fmac_f32 v95, v7, v26
s_waitcnt lgkmcnt(8)
v_fmac_f32 v128, v28, v20
MAA 108,16,140
ds_read_b128 v[4:7], v8 offset:512
v_fmac_f32 v129, v29, v20
MAA 60,8,140
v_fmac_f32 v130, v30, v20
v_fmac_f32 v131, v31, v20
MAA 60,12,156
v_fmac_f32 v132, v28, v22
v_fmac_f32 v133, v29, v22
MAA 56,12,152
buffer_load_dwordx4 v18, s[28:31], s58 offen lds
MAA 56,8,136
v_fmac_f32 v134, v30, v22
v_fmac_f32 v135, v31, v22
MAA 40,0,136
v_fmac_f32 v136, v28, v24
v_fmac_f32 v137, v29, v24
MAA 40,4,152
v_fmac_f32 v138, v30, v24
v_fmac_f32 v139, v31, v24
MAA 44,4,156
v_fmac_f32 v140, v28, v26
v_fmac_f32 v141, v29, v26
MAA 44,0,140
v_fmac_f32 v142, v30, v26
v_fmac_f32 v143, v31, v26
s_waitcnt lgkmcnt(0)
v_fmac_f32 v240, v4, v20
v_fmac_f32 v241, v5, v20
v_fmac_f32 v242, v6, v20
v_fmac_f32 v243, v7, v20
v_fmac_f32 v244, v4, v22
v_fmac_f32 v245, v5, v22
v_fmac_f32 v246, v6, v22
v_fmac_f32 v247, v7, v22
s_waitcnt vmcnt(17) lgkmcnt(0)
s_barrier
MAA 64,64,128
ds_read_b128 v[28:31], v9
s_add_u32 m0, s55, 101376
MAA 64,68,144
ds_read_b128 v[4:7], v9 offset:64
MAA 68,68,148
buffer_load_dwordx4 v12, s[80:83], s54 offen lds
MAA 68,64,132
TR 0,16,33792
MAA 84,72,132
TR 2,16,34304
MAA 84,76,148
TR 4,16,42240
MAA 80,76,144
TR 6,16,42752
MAA 80,72,128
TR 8,16,33824
MAA 128,80,128
buffer_load_dwordx4 v13, s[80:83], s54 offen offset:1056 lds
MAA 128,84,144
TR 10,16,34336
s_waitcnt lgkmcnt(7)
v_fmac_f32 v32, v28, v20
MAA 132,84,148
TR 12,16,42272
v_fmac_f32 v33, v29, v20
MAA 132,80,132
TR 14,16,42784
v_fmac_f32 v34, v30, v20
MAA 148,88,132
TR 16,16,33856
v_fmac_f32 v35, v31, v20
MAA 148,92,148
TR 18,16,34368
v_fmac_f32 v36, v28, v22
MAA 144,92,144
buffer_load_dwordx4 v14, s[80:83], s54 offen offset:2112 lds
MAA 144,88,128
TR 20,16,42304
v_fmac_f32 v37, v29, v22
MAA 192,96,128
TR 22,16,42816
v_fmac_f32 v38, v30, v22
MAA 192,100,144
TR 24,16,33888
v_fmac_f32 v39, v31, v22
MAA 196,100,148
TR 26,16,34400
v_fmac_f32 v40, v28, v24
MAA 196,96,132
TR 28,16,42336
v_fmac_f32 v41, v29, v24
MAA 212,104,132
buffer_load_dwordx4 v15, s[80:83], s54 offen offset:3168 lds
MAA 212,108,148
TR 30,16,42848
s_add_u32 s54, s54, 458752
MAA 208,108,144
TR 32,16,33920
s_mov_b32 m0, s67
MAA 208,104,128
TR 34,16,34432
v_fmac_f32 v42, v30, v24
MAA 240,112,128
TR 36,16,42368
v_fmac_f32 v43, v31, v24
MAA 240,116,144
TR 38,16,42880
v_fmac_f32 v44, v28, v26
MAA 244,116,148
buffer_load_dwordx4 v19, s[28:31], s58 offen offset:1056 lds
MAA 244,112,132
TR 40,16,33952
s_add_u32 s67, s67, 8448
MAA 252,120,132
TR 42,16,34464
s_add_u32 s58, s58, 0x40000
MAA 252,124,148
TR 44,16,42400
v_fmac_f32 v45, v29, v26
MAA 248,124,144
TR 46,16,42912
v_fmac_f32 v46, v30, v26
MAA 248,120,128
TR 48,17,33792
v_fmac_f32 v47, v31, v26
MAA 220,104,140
ds_read_b128 v[28:31], v9 offset:128
s_waitcnt lgkmcnt(15)
v_fmac_f32 v48, v4, v20
MAA 220,108,156
buffer_load_dwordx4 a[128:131], v10, s[16:19], s52 offen sc1
MAA 216,108,152
TR 50,17,34304
v_fmac_f32 v49, v5, v20
MAA 216,104,136
TR 52,17,42240
v_fmac_f32 v50, v6, v20
MAA 200,96,136
TR 54,17,42752
v_fmac_f32 v51, v7, v20
MAA 200,100,152
TR 56,17,33824
v_fmac_f32 v52, v4, v22
MAA 204,100,156
TR 58,17,34336
.Lpad33:
s_cbranch_execz .Lnopoll60r
v_fmac_f32 v53, v5, v22
MAA 204,96,140
buffer_load_dwordx4 a[132:135], v10, s[16:19], s52 offen offset:1024 sc1
MAA 156,88,140
TR 60,17,42272
s_add_u32 s52, s52, 131072
MAA 156,92,156
TR 62,17,42784
v_fmac_f32 v54, v6, v22
MAA 152,92,152
v_fmac_f32 v55, v7, v22
v_fmac_f32 v56, v4, v24
MAA 152,88,136
v_fmac_f32 v57, v5, v24
v_fmac_f32 v58, v6, v24
MAA 136,80,136
v_fmac_f32 v59, v7, v24
v_fmac_f32 v60, v4, v26
MAA 136,84,152
buffer_load_dwordx4 a[144:147], v10, s[16:19], s52 offen sc1
MAA 140,84,156
v_fmac_f32 v61, v5, v26
v_fmac_f32 v62, v6, v26
MAA 140,80,140
v_fmac_f32 v63, v7, v26
s_waitcnt lgkmcnt(7)
v_fmac_f32 v96, v28, v20
MAA 92,72,140
ds_read_b128 v[4:7], v8
v_fmac_f32 v97, v29, v20
MAA 92,76,156
v_fmac_f32 v98, v30, v20
v_fmac_f32 v99, v31, v20
MAA 88,76,152
v_fmac_f32 v100, v28, v22
v_fmac_f32 v101, v29, v22
MAA 88,72,136
buffer_load_dwordx4 a[148:151], v10, s[16:19], s52 offen offset:1024 sc1
MAA 72,64,136
s_add_u32 s52, s52, 131072
v_fmac_f32 v102, v30, v22
v_fmac_f32 v103, v31, v22
MAA 72,68,152
v_fmac_f32 v104, v28, v24
v_fmac_f32 v105, v29, v24
MAA 76,68,156
v_fmac_f32 v106, v30, v24
v_fmac_f32 v107, v31, v24
MAA 76,64,140
v_fmac_f32 v108, v28, v26
v_fmac_f32 v109, v29, v26
v_fmac_f32 v110, v30, v26
v_fmac_f32 v111, v31, v26
s_waitcnt lgkmcnt(0)
v_fmac_f32 v224, v4, v20
v_fmac_f32 v225, v5, v20
v_fmac_f32 v226, v6, v20
v_fmac_f32 v227, v7, v20
v_fmac_f32 v228, v4, v22
v_fmac_f32 v229, v5, v22
v_fmac_f32 v230, v6, v22
v_fmac_f32 v231, v7, v22
s_waitcnt vmcnt(18) lgkmcnt(0)
s_barrier
MAA 32,0,160
ds_read_b128 v[28:31], v9 offset:704
MAA 32,4,176
ds_read_b128 v[4:7], v9 offset:768
MAA 36,4,180
buffer_load_dwordx4 a[136:139], v11, s[16:19], s53 offen sc1
MAA 36,0,164
TR 64,16,50688
MAA 52,8,164
TR 66,16,51200
MAA 52,12,180
TR 68,16,59136
MAA 48,12,176
TR 70,16,59648
MAA 48,8,160
TR 72,16,50720
MAA 96,16,160
buffer_load_dwordx4 a[140:143], v11, s[16:19], s53 offen offset:1024 sc1
MAA 96,20,176
TR 74,16,51232
s_add_u32 s53, s53, 131072
MAA 100,20,180
TR 76,16,59168
s_waitcnt lgkmcnt(8)
v_fmac_f32 v144, v28, v20
MAA 100,16,164
TR 78,16,59680
v_fmac_f32 v145, v29, v20
MAA 116,24,164
TR 80,16,50752
v_fmac_f32 v146, v30, v20
MAA 116,28,180
TR 82,16,51264
v_fmac_f32 v147, v31, v20
MAA 112,28,176
buffer_load_dwordx4 a[152:155], v11, s[16:19], s53 offen sc1
MAA 112,24,160
TR 84,16,59200
v_fmac_f32 v148, v28, v22
MAA 160,32,160
TR 86,16,59712
v_fmac_f32 v149, v29, v22
MAA 160,36,176
TR 88,16,50784
v_fmac_f32 v150, v30, v22
MAA 164,36,180
TR 90,16,51296
v_fmac_f32 v151, v31, v22
MAA 164,32,164
TR 92,16,59232
v_fmac_f32 v152, v28, v24
MAA 180,40,164
buffer_load_dwordx4 a[156:159], v11, s[16:19], s53 offen offset:1024 sc1
MAA 180,44,180
TR 94,16,59744
s_add_u32 s53, s53, 131072
MAA 176,44,176
TR 96,16,50816
s_add_u32 m0, s55, 118272
MAA 176,40,160
TR 98,16,51328
v_fmac_f32 v153, v29, v24
MAA 224,48,160
TR 100,16,59264
v_fmac_f32 v154, v30, v24
MAA 224,52,176
TR 102,16,59776
v_fmac_f32 v155, v31, v24
MAA 228,52,180
buffer_load_dwordx4 v12, s[32:35], s54 offen lds
MAA 228,48,164
TR 104,16,50848
v_fmac_f32 v156, v28, v26
MAA 236,56,164
TR 106,16,51360
v_fmac_f32 v157, v29, v26
MAA 236,60,180
TR 108,16,59296
v_fmac_f32 v158, v30, v26
MAA 232,60,176
TR 110,16,59808
v_fmac_f32 v159, v31, v26
MAA 232,56,160
ds_read_b128 v[28:31], v9 offset:832
s_waitcnt lgkmcnt(15)
v_fmac_f32 v192, v4, v20
s_waitcnt vmcnt(19)
MAA 188,40,172
buffer_load_dwordx4 v13, s[32:35], s54 offen offset:1056 lds
MAA 188,44,188
TR 112,17,50688
v_fmac_f32 v193, v5, v20
MAA 184,44,184
TR 114,17,51200
v_fmac_f32 v194, v6, v20
MAA 184,40,168
TR 116,17,59136
v_fmac_f32 v195, v7, v20
MAA 168,32,168
TR 118,17,59648
v_fmac_f32 v196, v4, v22
MAA 168,36,184
TR 120,17,50720
v_fmac_f32 v197, v5, v22
MAA 172,36,188
buffer_load_dwordx4 v14, s[32:35], s54 offen offset:2112 lds
MAA 172,32,172
TR 122,17,51232
v_fmac_f32 v198, v6, v22
MAA 124,24,172
TR 124,17,59168
v_fmac_f32 v199, v7, v22
MAA 124,28,188
TR 126,17,59680
v_fmac_f32 v200, v4, v24
MAA 120,28,184
v_fmac_f32 v201, v5, v24
v_fmac_f32 v202, v6, v24
MAA 120,24,168
v_fmac_f32 v203, v7, v24
v_fmac_f32 v204, v4, v26
MAA 104,16,168
buffer_load_dwordx4 v15, s[32:35], s54 offen offset:3168 lds
MAA 104,20,184
s_mov_b32 m0, s67
v_fmac_f32 v205, v5, v26
v_fmac_f32 v206, v6, v26
MAA 108,20,188
v_fmac_f32 v207, v7, v26
s_waitcnt lgkmcnt(8)
v_fmac_f32 v208, v28, v20
MAA 108,16,172
ds_read_b128 v[4:7], v8 offset:576
v_fmac_f32 v209, v29, v20
MAA 60,8,172
v_fmac_f32 v210, v30, v20
v_fmac_f32 v211, v31, v20
MAA 60,12,188
v_fmac_f32 v212, v28, v22
v_fmac_f32 v213, v29, v22
MAA 56,12,184
buffer_load_dwordx4 v18, s[28:31], s58 offen lds
MAA 56,8,168
v_fmac_f32 v214, v30, v22
v_fmac_f32 v215, v31, v22
MAA 40,0,168
v_fmac_f32 v216, v28, v24
v_fmac_f32 v217, v29, v24
MAA 40,4,184
v_fmac_f32 v218, v30, v24
v_fmac_f32 v219, v31, v24
MAA 44,4,188
v_fmac_f32 v220, v28, v26
v_fmac_f32 v221, v29, v26
MAA 44,0,172
v_fmac_f32 v222, v30, v26
v_fmac_f32 v223, v31, v26
s_waitcnt lgkmcnt(0)
v_fmac_f32 v248, v4, v20
v_fmac_f32 v249, v5, v20
v_fmac_f32 v250, v6, v20
v_fmac_f32 v251, v7, v20
v_fmac_f32 v252, v4, v22
v_fmac_f32 v253, v5, v22
v_fmac_f32 v254, v6, v22
v_fmac_f32 v255, v7, v22
s_waitcnt vmcnt(19) lgkmcnt(0)
s_barrier
MAA 64,64,160
ds_read_b128 v[28:31], v9 offset:192
s_add_u32 m0, s55, 135168
MAA 64,68,176
ds_read_b128 v[4:7], v9 offset:256
MAA 68,68,180
buffer_load_dwordx4 v12, s[80:83], s54 offen lds
MAA 68,64,164
ds_read_b64_tr_b16 a[0:1], v16
MAA 84,72,164
TR 2,16,512
MAA 84,76,180
TR 4,16,8448
MAA 80,76,176
TR 6,16,8960
MAA 80,72,160
TR 8,16,32
MAA 128,80,160
buffer_load_dwordx4 v13, s[80:83], s54 offen offset:1056 lds
MAA 128,84,176
TR 10,16,544
s_waitcnt lgkmcnt(7)
v_fmac_f32 v112, v28, v20
MAA 132,84,180
TR 12,16,8480
v_fmac_f32 v113, v29, v20
MAA 132,80,164
TR 14,16,8992
v_fmac_f32 v114, v30, v20
MAA 148,88,164
TR 16,16,64
v_fmac_f32 v115, v31, v20
MAA 148,92,180
TR 18,16,576
v_fmac_f32 v116, v28, v22
MAA 144,92,176
buffer_load_dwordx4 v14, s[80:83], s54 offen offset:2112 lds
MAA 144,88,160
TR 20,16,8512
v_fmac_f32 v117, v29, v22
MAA 192,96,160
TR 22,16,9024
v_fmac_f32 v118, v30, v22
MAA 192,100,176
TR 24,16,96
v_fmac_f32 v119, v31, v22
MAA 196,100,180
TR 26,16,608
v_fmac_f32 v120, v28, v24
MAA 196,96,164
TR 28,16,8544
v_fmac_f32 v121, v29, v24
MAA 212,104,164
buffer_load_dwordx4 v15, s[80:83], s54 offen offset:3168 lds
MAA 212,108,180
TR 30,16,9056
s_add_u32 s54, s54, 458752
MAA 208,108,176
TR 32,16,128
s_mov_b32 m0, s67
MAA 208,104,160
TR 34,16,640
v_fmac_f32 v122, v30, v24
MAA 240,112,160
TR 36,16,8576
v_fmac_f32 v123, v31, v24
MAA 240,116,176
TR 38,16,9088
v_fmac_f32 v124, v28, v26
MAA 244,116,180
buffer_load_dwordx4 v19, s[28:31], s58 offen offset:1056 lds
MAA 244,112,164
TR 40,16,160
s_add_u32 s67, s67, 8448
MAA 252,120,164
TR 42,16,672
s_add_u32 s46, s46, 1
MAA 252,124,180
TR 44,16,8608
s_xor_b32 s58, s46, s87
MAA 248,124,176
TR 46,16,9120
s_mul_i32 s58, s58, 458752
MAA 248,120,160
ds_read_b64_tr_b16 a[48:49], v17
v_fmac_f32 v125, v29, v26
MAA 220,104,172
buffer_load_dwordx4 a[160:163], v10, s[16:19], s52 offen sc1
MAA 220,108,188
TR 50,17,512
v_fmac_f32 v126, v30, v26
MAA 216,108,184
TR 52,17,8448
v_fmac_f32 v127, v31, v26
MAA 216,104,168
ds_read_b128 v[28:31], v9 offset:320
s_waitcnt lgkmcnt(15)
v_fmac_f32 v160, v4, v20
MAA 200,96,168
TR 54,17,8960
v_fmac_f32 v161, v5, v20
MAA 200,100,184
TR 56,17,32
v_fmac_f32 v162, v6, v20
MAA 204,100,188
buffer_load_dwordx4 a[164:167], v10, s[16:19], s52 offen offset:1024 sc1
MAA 204,96,172
TR 58,17,544
s_add_u32 s52, s52, 131072
MAA 156,88,172
TR 60,17,8480
v_fmac_f32 v163, v7, v20
MAA 156,92,188
TR 62,17,8992
v_fmac_f32 v164, v4, v22
MAA 152,92,184
v_fmac_f32 v165, v5, v22
v_fmac_f32 v166, v6, v22
MAA 152,88,168
v_fmac_f32 v167, v7, v22
v_fmac_f32 v168, v4, v24
MAA 136,80,168
buffer_load_dwordx4 a[176:179], v10, s[16:19], s52 offen sc1
MAA 136,84,184
v_fmac_f32 v169, v5, v24
v_fmac_f32 v170, v6, v24
MAA 140,84,188
v_fmac_f32 v171, v7, v24
v_fmac_f32 v172, v4, v26
MAA 140,80,172
v_fmac_f32 v173, v5, v26
v_fmac_f32 v174, v6, v26
MAA 92,72,172
v_fmac_f32 v175, v7, v26
s_waitcnt lgkmcnt(5)
v_fmac_f32 v176, v28, v20
MAA 92,76,188
ds_read_b128 v[4:7], v8 offset:64
v_fmac_f32 v177, v29, v20
MAA 88,76,184
buffer_load_dwordx4 a[180:183], v10, s[16:19], s52 offen offset:1024 sc1
MAA 88,72,168
s_add_u32 s52, s52, 131072
v_fmac_f32 v178, v30, v20
v_fmac_f32 v179, v31, v20
MAA 72,64,168
v_fmac_f32 v180, v28, v22
v_fmac_f32 v181, v29, v22
MAA 72,68,184
v_fmac_f32 v182, v30, v22
v_fmac_f32 v183, v31, v22
MAA 76,68,188
v_fmac_f32 v184, v28, v24
v_fmac_f32 v185, v29, v24
MAA 76,64,172
v_fmac_f32 v186, v30, v24
v_fmac_f32 v187, v31, v24
v_fmac_f32 v188, v28, v26
v_fmac_f32 v189, v29, v26
v_fmac_f32 v190, v30, v26
v_fmac_f32 v191, v31, v26
v_accvgpr_read_b32 v28, a192
s_waitcnt lgkmcnt(0)
v_fmac_f32 v232, v4, v20
v_fmac_f32 v233, v5, v20
v_fmac_f32 v234, v6, v20
v_fmac_f32 v235, v7, v20
v_fmac_f32 v236, v4, v22
v_fmac_f32 v237, v5, v22
v_fmac_f32 v238, v6, v22
v_fmac_f32 v239, v7, v22
v_accvgpr_read_b32 v29, a193
v_accvgpr_read_b32 v30, a194
v_accvgpr_read_b32 v31, a195
s_mov_b32 s15, -4
.p2align 6
.Lk65:
s_waitcnt vmcnt(18) lgkmcnt(0)
s_barrier
MAA 32,0,128
TR 64,16,16896
MAA 32,4,144
buffer_load_dwordx4 a[168:171], v11, s[16:19], s53 offen sc1
MAA 36,4,148
TR 66,16,17408
MAA 36,0,132
TR 68,16,25344
MAA 52,8,132
TR 70,16,25856
MAA 52,12,148
MAA 48,12,144
TR 72,16,16928
MAA 48,8,128
buffer_load_dwordx4 a[172:175], v11, s[16:19], s53 offen offset:1024 sc1
MAA 96,16,128
TR 74,16,17440
s_add_u32 s53, s53, 131072
MAA 96,20,144
TR 76,16,25376
MAA 100,20,148
MAA 100,16,132
TR 78,16,25888
MAA 116,24,132
TR 80,16,16960
MAA 116,28,148
buffer_load_dwordx4 a[184:187], v11, s[16:19], s53 offen sc1
MAA 112,28,144
TR 82,16,17472
MAA 112,24,128
MAA 160,32,128
TR 84,16,25408
MAA 160,36,144
TR 86,16,25920
MAA 164,36,148
TR 88,16,16992
MAA 164,32,132
buffer_load_dwordx4 a[188:191], v11, s[16:19], s53 offen offset:1024 sc1
MAA 180,40,132
s_add_u32 s53, s53, 131072
MAA 180,44,148
TR 90,16,17504
MAA 176,44,144
TR 92,16,25440
MAA 176,40,128
TR 94,16,25952
MAA 224,48,128
s_add_u32 m0, s55, 84480
MAA 224,52,144
buffer_load_dwordx4 v12, s[32:35], s54 offen lds
MAA 228,52,148
TR 96,16,17024
MAA 228,48,132
TR 98,16,17536
MAA 236,56,132
TR 100,16,25472
MAA 236,60,148
TR 102,16,25984
MAA 232,60,144
MAA 232,56,128
TR 104,16,17056
s_waitcnt vmcnt(19)
MAA 188,40,140
TR 106,16,17568
MAA 188,44,156
buffer_load_dwordx4 v13, s[32:35], s54 offen offset:1056 lds
MAA 184,44,152
TR 108,16,25504
MAA 184,40,136
MAA 168,32,136
TR 110,16,26016
MAA 168,36,152
buffer_load_dwordx4 v14, s[32:35], s54 offen offset:2112 lds
MAA 172,36,156
TR 112,17,16896
MAA 172,32,140
TR 114,17,17408
MAA 124,24,140
MAA 124,28,156
TR 116,17,25344
MAA 120,28,152
TR 118,17,25856
MAA 120,24,136
buffer_load_dwordx4 v15, s[32:35], s54 offen offset:3168 lds
MAA 104,16,136
TR 120,17,16928
MAA 104,20,152
MAA 108,20,156
TR 122,17,17440
MAA 108,16,140
TR 124,17,25376
MAA 60,8,140
TR 126,17,25888
s_mov_b32 m0, s67
MAA 60,12,156
buffer_load_dwordx4 v18, s[28:31], s58 offen lds
MAA 56,12,152
MAA 56,8,136
MAA 40,0,136
MAA 40,4,152
MAA 44,4,156
MAA 44,0,140
s_waitcnt vmcnt(19) lgkmcnt(0)
s_barrier
MAA 64,64,128
TR 0,16,33792
s_add_u32 m0, s55, 101376
MAA 64,68,144
buffer_load_dwordx4 v12, s[80:83], s54 offen lds
MAA 68,68,148
TR 2,16,34304
MAA 68,64,132
TR 4,16,42240
MAA 84,72,132
TR 6,16,42752
MAA 84,76,148
MAA 80,76,144
TR 8,16,33824
MAA 80,72,128
buffer_load_dwordx4 v13, s[80:83], s54 offen offset:1056 lds
MAA 128,80,128
TR 10,16,34336
MAA 128,84,144
TR 12,16,42272
MAA 132,84,148
TR 14,16,42784
MAA 132,80,132
MAA 148,88,132
TR 16,16,33856
MAA 148,92,148
buffer_load_dwordx4 v14, s[80:83], s54 offen offset:2112 lds
MAA 144,92,144
TR 18,16,34368
MAA 144,88,128
TR 20,16,42304
MAA 192,96,128
MAA 192,100,144
TR 22,16,42816
MAA 196,100,148
TR 24,16,33888
MAA 196,96,132
buffer_load_dwordx4 v15, s[80:83], s54 offen offset:3168 lds
MAA 212,104,132
TR 26,16,34400
s_add_u32 s54, s54, 458752
MAA 212,108,148
TR 28,16,42336
MAA 208,108,144
MAA 208,104,128
TR 30,16,42848
MAA 240,112,128
TR 32,16,33920
s_mov_b32 m0, s67
MAA 240,116,144
buffer_load_dwordx4 v19, s[28:31], s58 offen offset:1056 lds
MAA 244,116,148
s_add_u32 s67, s67, 8448
s_add_u32 s58, s58, 0x40000
MAA 244,112,132
TR 34,16,34432
MAA 252,120,132
MAA 252,124,148
TR 36,16,42368
MAA 248,124,144
TR 38,16,42880
MAA 248,120,128
buffer_load_dwordx4 a[128:131], v10, s[16:19], s52 offen sc1
MAA 220,104,140
TR 40,16,33952
MAA 220,108,156
TR 42,16,34464
MAA 216,108,152
MAA 216,104,136
TR 44,16,42400
MAA 200,96,136
TR 46,16,42912
MAA 200,100,152
buffer_load_dwordx4 a[132:135], v10, s[16:19], s52 offen offset:1024 sc1
MAA 204,100,156
TR 48,17,33792
s_add_u32 s52, s52, 131072
MAA 204,96,140
MAA 156,88,140
TR 50,17,34304
MAA 156,92,156
TR 52,17,42240
.Lpad34:
s_cbranch_execz .Lnopoll60r
MAA 152,92,152
TR 54,17,42752
MAA 152,88,136
buffer_load_dwordx4 a[144:147], v10, s[16:19], s52 offen sc1
MAA 136,80,136
TR 56,17,33824
MAA 136,84,152
MAA 140,84,156
TR 58,17,34336
MAA 140,80,140
TR 60,17,42272
MAA 92,72,140
TR 62,17,42784
MAA 92,76,156
buffer_load_dwordx4 a[148:151], v10, s[16:19], s52 offen offset:1024 sc1
MAA 88,76,152
s_add_u32 s52, s52, 131072
MAA 88,72,136
MAA 72,64,136
MAA 72,68,152
MAA 76,68,156
MAA 76,64,140
s_waitcnt vmcnt(18) lgkmcnt(0)
s_barrier
MAA 32,0,160
TR 64,16,50688
MAA 32,4,176
buffer_load_dwordx4 a[136:139], v11, s[16:19], s53 offen sc1
MAA 36,4,180
TR 66,16,51200
MAA 36,0,164
TR 68,16,59136
MAA 52,8,164
TR 70,16,59648
MAA 52,12,180
MAA 48,12,176
TR 72,16,50720
MAA 48,8,160
buffer_load_dwordx4 a[140:143], v11, s[16:19], s53 offen offset:1024 sc1
MAA 96,16,160
TR 74,16,51232
s_add_u32 s53, s53, 131072
MAA 96,20,176
TR 76,16,59168
MAA 100,20,180
MAA 100,16,164
TR 78,16,59680
MAA 116,24,164
TR 80,16,50752
MAA 116,28,180
buffer_load_dwordx4 a[152:155], v11, s[16:19], s53 offen sc1
MAA 112,28,176
TR 82,16,51264
MAA 112,24,160
MAA 160,32,160
TR 84,16,59200
MAA 160,36,176
TR 86,16,59712
MAA 164,36,180
TR 88,16,50784
MAA 164,32,164
buffer_load_dwordx4 a[156:159], v11, s[16:19], s53 offen offset:1024 sc1
MAA 180,40,164
s_add_u32 s53, s53, 131072
MAA 180,44,180
TR 90,16,51296
MAA 176,44,176
TR 92,16,59232
MAA 176,40,160
TR 94,16,59744
MAA 224,48,160
s_add_u32 m0, s55, 118272
MAA 224,52,176
buffer_load_dwordx4 v12, s[32:35], s54 offen lds
MAA 228,52,180
TR 96,16,50816
MAA 228,48,164
TR 98,16,51328
MAA 236,56,164
TR 100,16,59264
MAA 236,60,180
TR 102,16,59776
MAA 232,60,176
MAA 232,56,160
TR 104,16,50848
s_waitcnt vmcnt(19)
MAA 188,40,172
TR 106,16,51360
MAA 188,44,188
buffer_load_dwordx4 v13, s[32:35], s54 offen offset:1056 lds
MAA 184,44,184
TR 108,16,59296
MAA 184,40,168
MAA 168,32,168
TR 110,16,59808
MAA 168,36,184
buffer_load_dwordx4 v14, s[32:35], s54 offen offset:2112 lds
MAA 172,36,188
TR 112,17,50688
MAA 172,32,172
TR 114,17,51200
MAA 124,24,172
MAA 124,28,188
TR 116,17,59136
MAA 120,28,184
TR 118,17,59648
MAA 120,24,168
buffer_load_dwordx4 v15, s[32:35], s54 offen offset:3168 lds
MAA 104,16,168
TR 120,17,50720
MAA 104,20,184
MAA 108,20,188
TR 122,17,51232
MAA 108,16,172
TR 124,17,59168
MAA 60,8,172
TR 126,17,59680
s_mov_b32 m0, s67
MAA 60,12,188
buffer_load_dwordx4 v18, s[28:31], s58 offen lds
MAA 56,12,184
MAA 56,8,168
MAA 40,0,168
MAA 40,4,184
MAA 44,4,188
MAA 44,0,172
s_waitcnt vmcnt(19) lgkmcnt(0)
s_barrier
MAA 64,64,160
ds_read_b64_tr_b16 a[0:1], v16
s_add_u32 m0, s55, 135168
MAA 64,68,176
buffer_load_dwordx4 v12, s[80:83], s54 offen lds
MAA 68,68,180
TR 2,16,512
MAA 68,64,164
TR 4,16,8448
MAA 84,72,164
TR 6,16,8960
MAA 84,76,180
MAA 80,76,176
TR 8,16,32
MAA 80,72,160
buffer_load_dwordx4 v13, s[80:83], s54 offen offset:1056 lds
MAA 128,80,160
TR 10,16,544
MAA 128,84,176
TR 12,16,8480
MAA 132,84,180
TR 14,16,8992
MAA 132,80,164
MAA 148,88,164
TR 16,16,64
MAA 148,92,180
buffer_load_dwordx4 v14, s[80:83], s54 offen offset:2112 lds
MAA 144,92,176
TR 18,16,576
MAA 144,88,160
TR 20,16,8512
MAA 192,96,160
MAA 192,100,176
TR 22,16,9024
MAA 196,100,180
TR 24,16,96
MAA 196,96,164
buffer_load_dwordx4 v15, s[80:83], s54 offen offset:3168 lds
MAA 212,104,164
TR 26,16,608
s_add_u32 s54, s54, 458752
MAA 212,108,180
TR 28,16,8544
MAA 208,108,176
MAA 208,104,160
TR 30,16,9056
MAA 240,112,160
TR 32,16,128
s_mov_b32 m0, s67
MAA 240,116,176
buffer_load_dwordx4 v19, s[28:31], s58 offen offset:1056 lds
MAA 244,116,180
s_add_u32 s67, s67, 8448
s_add_u32 s46, s46, 1
s_xor_b32 s58, s46, s87
s_mul_i32 s58, s58, 458752
MAA 244,112,164
TR 34,16,640
MAA 252,120,164
MAA 252,124,180
TR 36,16,8576
MAA 248,124,176
TR 38,16,9088
MAA 248,120,160
buffer_load_dwordx4 a[160:163], v10, s[16:19], s52 offen sc1
MAA 220,104,172
TR 40,16,160
MAA 220,108,188
TR 42,16,672
MAA 216,108,184
MAA 216,104,168
TR 44,16,8608
MAA 200,96,168
TR 46,16,9120
MAA 200,100,184
buffer_load_dwordx4 a[164:167], v10, s[16:19], s52 offen offset:1024 sc1
MAA 204,100,188
ds_read_b64_tr_b16 a[48:49], v17
s_add_u32 s52, s52, 131072
MAA 204,96,172
MAA 156,88,172
TR 50,17,512
MAA 156,92,188
TR 52,17,8448
MAA 152,92,184
TR 54,17,8960
MAA 152,88,168
buffer_load_dwordx4 a[176:179], v10, s[16:19], s52 offen sc1
MAA 136,80,168
TR 56,17,32
MAA 136,84,184
MAA 140,84,188
TR 58,17,544
MAA 140,80,172
TR 60,17,8480
MAA 92,72,172
TR 62,17,8992
MAA 92,76,188
buffer_load_dwordx4 a[180:183], v10, s[16:19], s52 offen offset:1024 sc1
MAA 88,76,184
s_add_u32 s52, s52, 131072
MAA 88,72,168
MAA 72,64,168
MAA 72,68,184
MAA 76,68,188
s_add_u32 s15, s15, 1
MAA 76,64,172
s_cbranch_scc0 .Lk65
s_waitcnt vmcnt(10) lgkmcnt(0)
s_barrier
MAA 32,0,128
buffer_load_dwordx4 a[168:171], v11, s[16:19], s53 offen sc1
MAA 32,4,144
TR 64,16,16896
s_add_u32 s58, s99, 2293760
MAA 48,12,144
TR 66,16,17408
s_lshl_b32 s74, s3, 11
MAA 48,8,128
TR 68,16,25344
s_add_u32 s74, s74, s84
MAA 36,0,132
buffer_load_dwordx4 a[172:175], v11, s[16:19], s53 offen offset:1024 sc1
MAA 36,4,148
TR 70,16,25856
s_add_u32 s53, s53, 131072
MAA 52,12,148
TR 72,16,16928
v_lshl_add_u32 v4, v1, 4, s74
MAA 52,8,132
TR 74,16,17440
v_lshrrev_b32 v2, 3, v1
MAA 40,0,136
buffer_load_dwordx4 a[184:187], v11, s[16:19], s53 offen sc1
MAA 40,4,152
TR 76,16,25376
v_cmp_eq_u32 vcc, 3, v2
MAA 56,12,152
TR 78,16,25888
v_add_u32 v2, 67108480, v4
MAA 56,8,136
TR 80,16,33792
v_cndmask_b32 v4, v4, v2, vcc
MAA 44,0,140
buffer_load_dwordx4 a[188:191], v11, s[16:19], s53 offen offset:1024 sc1
MAA 44,4,156
TR 82,16,34304
s_add_u32 s53, s53, 131072
MAA 60,12,156
TR 84,16,42240
s_and_b32 s74, s7, 1
MAA 60,8,140
TR 86,16,42752
s_add_u32 s54, s98, 65536
MAA 96,16,128
TR 88,16,33824
v_bfe_u32 v7, v1, 2, 3
MAA 96,20,144
TR 90,16,34336
v_mul_u32_u24 v7, 1056, v7
MAA 112,28,144
TR 92,16,42272
s_waitcnt vmcnt(9)
s_barrier
MAA 112,24,128
TR 94,16,42784
v_bfe_u32 v2, v1, 5, 1
MAA 100,16,132
TR 96,16,50688
v_lshl_add_u32 v7, v2, 8, v7
MAA 100,20,148
TR 98,16,51200
v_and_b32 v2, 3, v1
MAA 116,28,148
TR 100,16,59136
v_lshl_add_u32 v7, v2, 3, v7
MAA 116,24,132
TR 102,16,59648
s_lshl_b32 s74, s74, 7
MAA 104,16,136
TR 104,16,50720
s_xor_b32 s75, s74, 128
MAA 104,20,152
TR 106,16,51232
v_add_u32 v6, s75, v7
MAA 120,28,152
TR 108,16,59168
v_add_u32 v7, s74, v7
MAA 120,24,136
TR 110,16,59680
s_mul_i32 s55, s3, 2112
MAA 108,16,140
TR 112,16,16960
s_mov_b32 s57, 67584
MAA 108,20,156
TR 114,16,17472
MAA 124,28,156
TR 116,16,25408
MAA 124,24,140
TR 118,16,25920
MAA 160,32,128
TR 120,16,16992
MAA 160,36,144
TR 122,16,17504
MAA 176,44,144
TR 124,16,25440
MAA 176,40,128
TR 126,16,25952
MAA 164,32,132
TR 192,16,33856
MAA 164,36,148
TR 194,16,34368
MAA 180,44,148
TR 196,16,42304
MAA 180,40,132
TR 198,16,42816
MAA 168,32,136
TR 200,16,33888
MAA 168,36,152
TR 202,16,34400
MAA 184,44,152
TR 204,16,42336
MAA 184,40,136
TR 206,16,42848
MAA 172,32,140
TR 208,16,50752
MAA 172,36,156
TR 210,16,51264
MAA 188,44,156
TR 212,16,59200
MAA 188,40,140
TR 214,16,59712
MAA 224,48,128
TR 216,16,50784
MAA 224,52,144
TR 218,16,51296
MAA 232,60,144
TR 220,16,59232
MAA 232,56,128
TR 222,16,59744
MAA 228,48,132
TR 0,16,17024
MAA 228,52,148
TR 2,16,17536
MAA 236,60,148
TR 4,16,25472
MAA 236,56,132
TR 6,16,25984
s_waitcnt lgkmcnt(15)
MAA 64,64,128
TR 8,16,17056
MAA 64,68,144
TR 10,16,17568
s_waitcnt vmcnt(7)
MAA 64,96,160
TR 12,16,25504
s_waitcnt vmcnt(5)
MAA 64,100,176
TR 14,16,26016
MAA 80,108,176
TR 16,16,33920
MAA 80,104,160
TR 18,16,34432
MAA 80,76,144
TR 20,16,42368
MAA 80,72,128
TR 22,16,42880
MAA 32,80,160
TR 24,16,33952
MAA 32,84,176
TR 26,16,34464
MAA 48,92,176
TR 28,16,42400
MAA 48,88,160
TR 30,16,42912
s_nop 2
v_pk_mul_f32 v[64:65], v[64:65], v[32:33]
TR 32,16,50816
TR 34,16,51328
v_pk_mul_f32 v[32:33], v[32:33], v[28:29] op_sel_hi:[1,0]
v_pk_mul_f32 v[66:67], v[66:67], v[34:35]
v_pk_mul_f32 v[34:35], v[34:35], v[28:29] op_sel_hi:[1,0]
v_exp_f32 v32, v32
v_pk_mul_f32 v[80:81], v[80:81], v[48:49]
v_pk_mul_f32 v[48:49], v[48:49], v[28:29] op_sel_hi:[1,0]
v_pk_mul_f32 v[82:83], v[82:83], v[50:51]
v_pk_mul_f32 v[50:51], v[50:51], v[28:29] op_sel_hi:[1,0]
v_exp_f32 v33, v33
v_exp_f32 v34, v34
MAA 68,64,132
TR 36,16,59264
v_exp_f32 v35, v35
MAA 68,68,148
TR 38,16,59776
v_exp_f32 v48, v48
MAA 68,96,164
TR 40,16,50848
v_exp_f32 v49, v49
s_waitcnt vmcnt(4)
MAA 68,100,180
TR 42,16,51360
v_exp_f32 v50, v50
MAA 84,108,180
TR 44,16,59296
v_exp_f32 v51, v51
MAA 84,104,164
TR 46,16,59808
MAA 84,76,148
TR 48,17,16896
MAA 84,72,132
TR 50,17,17408
MAA 36,80,164
TR 52,17,25344
MAA 36,84,180
TR 54,17,25856
MAA 52,92,180
TR 56,17,16928
MAA 52,88,164
TR 58,17,17440
s_nop 2
v_pk_mul_f32 v[68:69], v[68:69], v[36:37]
v_pk_fma_f32 v[32:33], v[32:33], v[20:21], v[20:21] op_sel:[0,1,1] op_sel_hi:[1,1,1]
v_pk_fma_f32 v[34:35], v[34:35], v[20:21], v[20:21] op_sel:[0,1,1] op_sel_hi:[1,1,1]
v_pk_mul_f32 v[36:37], v[36:37], v[28:29] op_sel:[0,1] op_sel_hi:[1,1]
v_pk_mul_f32 v[70:71], v[70:71], v[38:39]
v_pk_mul_f32 v[38:39], v[38:39], v[28:29] op_sel:[0,1] op_sel_hi:[1,1]
v_pk_fma_f32 v[48:49], v[48:49], v[20:21], v[20:21] op_sel:[0,1,1] op_sel_hi:[1,1,1]
v_pk_mul_f32 v[84:85], v[84:85], v[52:53]
v_pk_mul_f32 v[52:53], v[52:53], v[28:29] op_sel:[0,1] op_sel_hi:[1,1]
v_pk_mul_f32 v[86:87], v[86:87], v[54:55]
v_pk_mul_f32 v[54:55], v[54:55], v[28:29] op_sel:[0,1] op_sel_hi:[1,1]
v_pk_fma_f32 v[50:51], v[50:51], v[20:21], v[20:21] op_sel:[0,1,1] op_sel_hi:[1,1,1]
v_rcp_f32 v32, v32
v_rcp_f32 v33, v33
MAA 72,64,136
TR 60,17,25376
v_rcp_f32 v34, v34
MAA 72,68,152
TR 62,17,25888
v_rcp_f32 v35, v35
s_waitcnt vmcnt(3)
MAA 72,96,168
v_rcp_f32 v48, v48
s_waitcnt vmcnt(1)
MAA 72,100,184
v_rcp_f32 v49, v49
MAA 88,108,184
v_rcp_f32 v50, v50
MAA 88,104,168
v_rcp_f32 v51, v51
MAA 88,76,152
v_exp_f32 v36, v36
MAA 88,72,136
v_exp_f32 v37, v37
MAA 40,80,168
v_exp_f32 v38, v38
MAA 40,84,184
v_exp_f32 v39, v39
MAA 56,92,184
v_exp_f32 v52, v52
MAA 56,88,168
v_exp_f32 v53, v53
v_exp_f32 v54, v54
v_exp_f32 v55, v55
v_pk_mul_f32 v[64:65], v[64:65], v[32:33]
v_pk_mul_f32 v[66:67], v[66:67], v[34:35]
v_pk_mul_f32 v[80:81], v[80:81], v[48:49]
v_pk_mul_f32 v[82:83], v[82:83], v[50:51]
v_pk_mul_f32 v[72:73], v[72:73], v[40:41]
v_pk_mul_f32 v[40:41], v[40:41], v[30:31] op_sel_hi:[1,0]
v_pk_mul_f32 v[74:75], v[74:75], v[42:43]
v_pk_mul_f32 v[42:43], v[42:43], v[30:31] op_sel_hi:[1,0]
v_pk_mul_f32 v[88:89], v[88:89], v[56:57]
v_pk_mul_f32 v[56:57], v[56:57], v[30:31] op_sel_hi:[1,0]
v_pk_mul_f32 v[90:91], v[90:91], v[58:59]
v_pk_mul_f32 v[58:59], v[58:59], v[30:31] op_sel_hi:[1,0]
v_pk_fma_f32 v[36:37], v[36:37], v[22:23], v[22:23] op_sel:[0,1,1] op_sel_hi:[1,1,1]
v_pk_fma_f32 v[38:39], v[38:39], v[22:23], v[22:23] op_sel:[0,1,1] op_sel_hi:[1,1,1]
v_pk_fma_f32 v[52:53], v[52:53], v[22:23], v[22:23] op_sel:[0,1,1] op_sel_hi:[1,1,1]
v_pk_fma_f32 v[54:55], v[54:55], v[22:23], v[22:23] op_sel:[0,1,1] op_sel_hi:[1,1,1]
v_cvt_pk_bf16_f32 v32, v64, v65
v_cvt_pk_bf16_f32 v33, v66, v67
v_cvt_pk_bf16_f32 v34, v80, v81
v_cvt_pk_bf16_f32 v35, v82, v83
MAA 76,64,140
buffer_store_dwordx4 v[32:35], v10, s[16:19], s62 offen sc1
MAA 76,68,156
TR 64,17,33792
v_rcp_f32 v36, v36
MAA 76,96,172
TR 66,17,34304
v_rcp_f32 v37, v37
s_waitcnt vmcnt(1)
MAA 76,100,188
TR 68,17,42240
v_rcp_f32 v38, v38
MAA 92,108,188
TR 70,17,42752
v_rcp_f32 v39, v39
MAA 92,104,172
v_rcp_f32 v52, v52
MAA 92,76,156
TR 76,17,42272
v_rcp_f32 v53, v53
MAA 92,72,140
TR 72,17,33824
v_rcp_f32 v54, v54
MAA 44,80,172
TR 74,17,34336
v_rcp_f32 v55, v55
MAA 44,84,188
TR 78,17,42784
v_exp_f32 v40, v40
MAA 60,92,188
TR 80,17,50688
v_exp_f32 v41, v41
MAA 60,88,172
.Lpad35:
s_cbranch_execz .Lpad38
TR 82,17,51200
v_exp_f32 v42, v42
v_exp_f32 v43, v43
v_exp_f32 v56, v56
v_exp_f32 v57, v57
v_exp_f32 v58, v58
v_exp_f32 v59, v59
v_pk_mul_f32 v[68:69], v[68:69], v[36:37]
v_pk_mul_f32 v[70:71], v[70:71], v[38:39]
v_pk_mul_f32 v[84:85], v[84:85], v[52:53]
v_pk_mul_f32 v[86:87], v[86:87], v[54:55]
v_pk_mul_f32 v[76:77], v[76:77], v[44:45]
v_pk_mul_f32 v[44:45], v[44:45], v[30:31] op_sel:[0,1] op_sel_hi:[1,1]
v_pk_mul_f32 v[78:79], v[78:79], v[46:47]
v_pk_mul_f32 v[46:47], v[46:47], v[30:31] op_sel:[0,1] op_sel_hi:[1,1]
v_pk_mul_f32 v[92:93], v[92:93], v[60:61]
v_pk_mul_f32 v[60:61], v[60:61], v[30:31] op_sel:[0,1] op_sel_hi:[1,1]
v_pk_mul_f32 v[94:95], v[94:95], v[62:63]
v_pk_mul_f32 v[62:63], v[62:63], v[30:31] op_sel:[0,1] op_sel_hi:[1,1]
v_pk_fma_f32 v[40:41], v[40:41], v[24:25], v[24:25] op_sel:[0,1,1] op_sel_hi:[1,1,1]
v_pk_fma_f32 v[42:43], v[42:43], v[24:25], v[24:25] op_sel:[0,1,1] op_sel_hi:[1,1,1]
v_pk_fma_f32 v[56:57], v[56:57], v[24:25], v[24:25] op_sel:[0,1,1] op_sel_hi:[1,1,1]
v_pk_fma_f32 v[58:59], v[58:59], v[24:25], v[24:25] op_sel:[0,1,1] op_sel_hi:[1,1,1]
v_cvt_pk_bf16_f32 v36, v68, v69
v_cvt_pk_bf16_f32 v37, v70, v71
v_cvt_pk_bf16_f32 v38, v84, v85
v_cvt_pk_bf16_f32 v39, v86, v87
MAA 128,112,128
buffer_store_dwordx4 v[36:39], v10, s[16:19], s62 offen offset:1024 sc1
MAA 128,116,144
TR 84,17,59136
v_rcp_f32 v40, v40
s_waitcnt lgkmcnt(15)
MAA 128,208,160
TR 86,17,59648
v_rcp_f32 v41, v41
MAA 128,212,176
TR 88,17,50720
v_rcp_f32 v42, v42
MAA 144,220,176
TR 90,17,51232
v_rcp_f32 v43, v43
MAA 144,216,160
TR 92,17,59168
v_rcp_f32 v56, v56
MAA 144,124,144
TR 94,17,59680
v_rcp_f32 v57, v57
MAA 144,120,128
v_rcp_f32 v58, v58
MAA 96,192,160
v_rcp_f32 v59, v59
MAA 96,196,176
v_exp_f32 v44, v44
MAA 112,204,176
v_exp_f32 v45, v45
MAA 112,200,160
v_lshrrev_b32 v69, 2, v0
v_min_u32 v69, 1, v69
v_lshlrev_b32 v69, 28, v69
v_lshl_add_u32 v68, v0, 7, v69
v_xor_b32 v69, 64, v0
v_min_u32 v69, 1, v69
v_lshlrev_b32 v70, 4, v69
v_sub_u32 v70, 16, v70
v_lshlrev_b32 v69, 28, v69
v_mov_b32 v71, 1
s_waitcnt lgkmcnt(0)
s_barrier
v_mov_b32 v84, 0
v_mov_b32 v85, 0
v_mov_b32 v86, 0
v_exp_f32 v46, v46
v_exp_f32 v47, v47
v_exp_f32 v60, v60
v_exp_f32 v61, v61
v_exp_f32 v62, v62
v_exp_f32 v63, v63
v_pk_mul_f32 v[72:73], v[72:73], v[40:41]
v_pk_mul_f32 v[74:75], v[74:75], v[42:43]
v_pk_mul_f32 v[88:89], v[88:89], v[56:57]
v_pk_mul_f32 v[90:91], v[90:91], v[58:59]
v_pk_mul_f32 v[128:129], v[128:129], v[96:97]
v_pk_mul_f32 v[96:97], v[96:97], v[28:29] op_sel_hi:[1,0]
v_pk_mul_f32 v[130:131], v[130:131], v[98:99]
v_pk_mul_f32 v[98:99], v[98:99], v[28:29] op_sel_hi:[1,0]
v_pk_mul_f32 v[144:145], v[144:145], v[112:113]
v_pk_mul_f32 v[112:113], v[112:113], v[28:29] op_sel_hi:[1,0]
v_pk_mul_f32 v[146:147], v[146:147], v[114:115]
v_pk_mul_f32 v[114:115], v[114:115], v[28:29] op_sel_hi:[1,0]
v_pk_fma_f32 v[44:45], v[44:45], v[26:27], v[26:27] op_sel:[0,1,1] op_sel_hi:[1,1,1]
v_pk_fma_f32 v[46:47], v[46:47], v[26:27], v[26:27] op_sel:[0,1,1] op_sel_hi:[1,1,1]
v_pk_fma_f32 v[60:61], v[60:61], v[26:27], v[26:27] op_sel:[0,1,1] op_sel_hi:[1,1,1]
v_pk_fma_f32 v[62:63], v[62:63], v[26:27], v[26:27] op_sel:[0,1,1] op_sel_hi:[1,1,1]
v_cvt_pk_bf16_f32 v40, v72, v73
v_cvt_pk_bf16_f32 v41, v74, v75
v_cvt_pk_bf16_f32 v42, v88, v89
v_cvt_pk_bf16_f32 v43, v90, v91
MAA 132,112,132
buffer_store_dwordx4 v[40:43], v11, s[16:19], s62 offen sc1
MAA 132,116,148
s_add_u32 m0, s59, 84480
v_rcp_f32 v44, v44
MAA 132,208,164
v_rcp_f32 v45, v45
MAA 132,212,180
v_rcp_f32 v46, v46
MAA 148,220,180
buffer_load_dwordx4 v18, s[28:31], s58 offen lds
MAA 148,216,164
v_rcp_f32 v47, v47
MAA 148,124,148
v_rcp_f32 v60, v60
MAA 148,120,132
v_rcp_f32 v61, v61
MAA 100,192,164
buffer_load_dwordx4 v19, s[28:31], s58 offen offset:1056 lds
MAA 100,196,180
s_add_u32 m0, s59, 92928
s_add_u32 s58, s99, 2555904
v_rcp_f32 v62, v62
MAA 116,204,180
v_rcp_f32 v63, v63
MAA 116,200,164
v_exp_f32 v96, v96
v_exp_f32 v97, v97
v_exp_f32 v98, v98
v_exp_f32 v99, v99
v_exp_f32 v112, v112
v_exp_f32 v113, v113
v_exp_f32 v114, v114
v_exp_f32 v115, v115
v_pk_mul_f32 v[76:77], v[76:77], v[44:45]
v_pk_mul_f32 v[78:79], v[78:79], v[46:47]
v_pk_mul_f32 v[92:93], v[92:93], v[60:61]
v_pk_mul_f32 v[94:95], v[94:95], v[62:63]
v_pk_mul_f32 v[132:133], v[132:133], v[100:101]
v_pk_mul_f32 v[100:101], v[100:101], v[28:29] op_sel:[0,1] op_sel_hi:[1,1]
v_pk_mul_f32 v[134:135], v[134:135], v[102:103]
v_pk_mul_f32 v[102:103], v[102:103], v[28:29] op_sel:[0,1] op_sel_hi:[1,1]
v_pk_mul_f32 v[148:149], v[148:149], v[116:117]
v_pk_mul_f32 v[116:117], v[116:117], v[28:29] op_sel:[0,1] op_sel_hi:[1,1]
v_pk_mul_f32 v[150:151], v[150:151], v[118:119]
v_pk_mul_f32 v[118:119], v[118:119], v[28:29] op_sel:[0,1] op_sel_hi:[1,1]
v_pk_fma_f32 v[96:97], v[96:97], v[20:21], v[20:21] op_sel:[0,1,1] op_sel_hi:[1,1,1]
v_pk_fma_f32 v[98:99], v[98:99], v[20:21], v[20:21] op_sel:[0,1,1] op_sel_hi:[1,1,1]
v_pk_fma_f32 v[112:113], v[112:113], v[20:21], v[20:21] op_sel:[0,1,1] op_sel_hi:[1,1,1]
v_pk_fma_f32 v[114:115], v[114:115], v[20:21], v[20:21] op_sel:[0,1,1] op_sel_hi:[1,1,1]
v_cvt_pk_bf16_f32 v44, v76, v77
v_cvt_pk_bf16_f32 v45, v78, v79
v_cvt_pk_bf16_f32 v46, v92, v93
v_cvt_pk_bf16_f32 v47, v94, v95
MAA 136,112,136
buffer_store_dwordx4 v[44:47], v11, s[16:19], s62 offen offset:1024 sc1
MAA 136,116,152
v_rcp_f32 v96, v96
MAA 136,208,168
v_rcp_f32 v97, v97
MAA 136,212,184
v_rcp_f32 v98, v98
MAA 152,220,184
buffer_load_dwordx4 v18, s[28:31], s58 offen lds
MAA 152,216,168
v_rcp_f32 v99, v99
MAA 152,124,152
v_rcp_f32 v112, v112
MAA 152,120,136
v_rcp_f32 v113, v113
MAA 104,192,168
buffer_load_dwordx4 v19, s[28:31], s58 offen offset:1056 lds
MAA 104,196,184
s_add_u32 m0, s59, 101376
s_add_u32 s58, s100, 2752512
v_rcp_f32 v114, v114
MAA 120,204,184
v_rcp_f32 v115, v115
MAA 120,200,168
v_exp_f32 v100, v100
v_exp_f32 v101, v101
v_exp_f32 v102, v102
v_exp_f32 v103, v103
v_exp_f32 v116, v116
v_exp_f32 v117, v117
v_exp_f32 v118, v118
v_exp_f32 v119, v119
v_pk_mul_f32 v[128:129], v[128:129], v[96:97]
v_pk_mul_f32 v[130:131], v[130:131], v[98:99]
v_pk_mul_f32 v[144:145], v[144:145], v[112:113]
v_pk_mul_f32 v[146:147], v[146:147], v[114:115]
v_pk_mul_f32 v[136:137], v[136:137], v[104:105]
v_pk_mul_f32 v[104:105], v[104:105], v[30:31] op_sel_hi:[1,0]
v_pk_mul_f32 v[138:139], v[138:139], v[106:107]
v_pk_mul_f32 v[106:107], v[106:107], v[30:31] op_sel_hi:[1,0]
v_pk_mul_f32 v[152:153], v[152:153], v[120:121]
v_pk_mul_f32 v[120:121], v[120:121], v[30:31] op_sel_hi:[1,0]
v_pk_mul_f32 v[154:155], v[154:155], v[122:123]
v_pk_mul_f32 v[122:123], v[122:123], v[30:31] op_sel_hi:[1,0]
v_pk_fma_f32 v[100:101], v[100:101], v[22:23], v[22:23] op_sel:[0,1,1] op_sel_hi:[1,1,1]
v_pk_fma_f32 v[102:103], v[102:103], v[22:23], v[22:23] op_sel:[0,1,1] op_sel_hi:[1,1,1]
v_pk_fma_f32 v[116:117], v[116:117], v[22:23], v[22:23] op_sel:[0,1,1] op_sel_hi:[1,1,1]
v_pk_fma_f32 v[118:119], v[118:119], v[22:23], v[22:23] op_sel:[0,1,1] op_sel_hi:[1,1,1]
v_cvt_pk_bf16_f32 v96, v128, v129
v_cvt_pk_bf16_f32 v97, v130, v131
v_cvt_pk_bf16_f32 v98, v144, v145
v_cvt_pk_bf16_f32 v99, v146, v147
MAA 140,112,140
buffer_store_dwordx4 v[96:99], v10, s[16:19], s63 offen sc1
MAA 140,116,156
v_rcp_f32 v100, v100
MAA 140,208,172
v_rcp_f32 v101, v101
MAA 140,212,188
v_rcp_f32 v102, v102
MAA 156,220,188
buffer_load_dwordx4 v18, s[28:31], s58 offen lds
MAA 156,216,172
v_rcp_f32 v103, v103
MAA 156,124,156
v_rcp_f32 v116, v116
MAA 156,120,140
v_rcp_f32 v117, v117
MAA 108,192,172
buffer_load_dwordx4 v19, s[28:31], s58 offen offset:1056 lds
MAA 108,196,188
s_add_u32 m0, s59, 109824
s_add_u32 s58, s100, 3014656
v_rcp_f32 v118, v118
MAA 124,204,188
v_rcp_f32 v119, v119
MAA 124,200,172
v_exp_f32 v104, v104
v_exp_f32 v105, v105
v_exp_f32 v106, v106
v_exp_f32 v107, v107
v_exp_f32 v120, v120
v_exp_f32 v121, v121
v_exp_f32 v122, v122
v_exp_f32 v123, v123
v_pk_mul_f32 v[132:133], v[132:133], v[100:101]
v_pk_mul_f32 v[134:135], v[134:135], v[102:103]
v_pk_mul_f32 v[148:149], v[148:149], v[116:117]
v_pk_mul_f32 v[150:151], v[150:151], v[118:119]
v_pk_mul_f32 v[140:141], v[140:141], v[108:109]
v_pk_mul_f32 v[108:109], v[108:109], v[30:31] op_sel:[0,1] op_sel_hi:[1,1]
v_pk_mul_f32 v[142:143], v[142:143], v[110:111]
v_pk_mul_f32 v[110:111], v[110:111], v[30:31] op_sel:[0,1] op_sel_hi:[1,1]
v_pk_mul_f32 v[156:157], v[156:157], v[124:125]
v_pk_mul_f32 v[124:125], v[124:125], v[30:31] op_sel:[0,1] op_sel_hi:[1,1]
v_pk_mul_f32 v[158:159], v[158:159], v[126:127]
v_pk_mul_f32 v[126:127], v[126:127], v[30:31] op_sel:[0,1] op_sel_hi:[1,1]
v_pk_fma_f32 v[104:105], v[104:105], v[24:25], v[24:25] op_sel:[0,1,1] op_sel_hi:[1,1,1]
v_pk_fma_f32 v[106:107], v[106:107], v[24:25], v[24:25] op_sel:[0,1,1] op_sel_hi:[1,1,1]
v_pk_fma_f32 v[120:121], v[120:121], v[24:25], v[24:25] op_sel:[0,1,1] op_sel_hi:[1,1,1]
v_pk_fma_f32 v[122:123], v[122:123], v[24:25], v[24:25] op_sel:[0,1,1] op_sel_hi:[1,1,1]
v_cvt_pk_bf16_f32 v100, v132, v133
v_cvt_pk_bf16_f32 v101, v134, v135
v_cvt_pk_bf16_f32 v102, v148, v149
v_cvt_pk_bf16_f32 v103, v150, v151
MAA 192,0,128
buffer_store_dwordx4 v[100:103], v10, s[16:19], s63 offen offset:1024 sc1
MAA 192,4,144
v_rcp_f32 v104, v104
MAA 192,32,160
s_waitcnt vmcnt(6)
s_barrier
v_rcp_f32 v105, v105
MAA 192,36,176
v_rcp_f32 v106, v106
MAA 208,44,176
buffer_atomic_add v71, v68, s[16:19], s72 offen offset:512
MAA 208,40,160
v_rcp_f32 v107, v107
MAA 208,12,144
v_rcp_f32 v120, v120
MAA 208,8,128
v_rcp_f32 v121, v121
MAA 160,16,160
buffer_load_dwordx4 v18, s[28:31], s58 offen lds
MAA 160,20,176
v_rcp_f32 v122, v122
MAA 176,28,176
v_rcp_f32 v123, v123
MAA 176,24,160
v_exp_f32 v108, v108
v_exp_f32 v109, v109
v_exp_f32 v110, v110
v_exp_f32 v111, v111
v_exp_f32 v124, v124
v_exp_f32 v125, v125
v_exp_f32 v126, v126
v_exp_f32 v127, v127
v_pk_mul_f32 v[136:137], v[136:137], v[104:105]
v_pk_mul_f32 v[138:139], v[138:139], v[106:107]
v_pk_mul_f32 v[152:153], v[152:153], v[120:121]
v_pk_mul_f32 v[154:155], v[154:155], v[122:123]
v_pk_mul_f32 v[192:193], v[192:193], v[160:161]
v_pk_mul_f32 v[160:161], v[160:161], v[28:29] op_sel_hi:[1,0]
v_pk_mul_f32 v[194:195], v[194:195], v[162:163]
v_pk_mul_f32 v[162:163], v[162:163], v[28:29] op_sel_hi:[1,0]
v_pk_mul_f32 v[208:209], v[208:209], v[176:177]
v_pk_mul_f32 v[176:177], v[176:177], v[28:29] op_sel_hi:[1,0]
v_pk_mul_f32 v[210:211], v[210:211], v[178:179]
v_pk_mul_f32 v[178:179], v[178:179], v[28:29] op_sel_hi:[1,0]
v_pk_fma_f32 v[108:109], v[108:109], v[26:27], v[26:27] op_sel:[0,1,1] op_sel_hi:[1,1,1]
v_pk_fma_f32 v[110:111], v[110:111], v[26:27], v[26:27] op_sel:[0,1,1] op_sel_hi:[1,1,1]
v_pk_fma_f32 v[124:125], v[124:125], v[26:27], v[26:27] op_sel:[0,1,1] op_sel_hi:[1,1,1]
v_pk_fma_f32 v[126:127], v[126:127], v[26:27], v[26:27] op_sel:[0,1,1] op_sel_hi:[1,1,1]
v_cvt_pk_bf16_f32 v104, v136, v137
v_cvt_pk_bf16_f32 v105, v138, v139
v_cvt_pk_bf16_f32 v106, v152, v153
v_cvt_pk_bf16_f32 v107, v154, v155
MAA 196,0,132
buffer_store_dwordx4 v[104:107], v11, s[16:19], s63 offen sc1
MAA 196,4,148
v_rcp_f32 v108, v108
MAA 196,32,164
v_rcp_f32 v109, v109
MAA 196,36,180
v_rcp_f32 v110, v110
MAA 212,44,180
buffer_load_dwordx4 v19, s[28:31], s58 offen offset:1056 lds
MAA 212,40,164
s_add_u32 m0, s59, 118272
s_add_u32 s58, s101, 3211264
v_rcp_f32 v111, v111
MAA 212,12,148
v_rcp_f32 v124, v124
MAA 212,8,132
v_rcp_f32 v125, v125
MAA 164,16,164
buffer_load_dwordx4 v18, s[28:31], s58 offen lds
MAA 164,20,180
v_rcp_f32 v126, v126
MAA 180,28,180
v_rcp_f32 v127, v127
MAA 180,24,164
v_exp_f32 v160, v160
v_exp_f32 v161, v161
v_exp_f32 v162, v162
v_exp_f32 v163, v163
v_exp_f32 v176, v176
v_exp_f32 v177, v177
v_exp_f32 v178, v178
v_exp_f32 v179, v179
v_pk_mul_f32 v[140:141], v[140:141], v[108:109]
v_pk_mul_f32 v[142:143], v[142:143], v[110:111]
v_pk_mul_f32 v[156:157], v[156:157], v[124:125]
v_pk_mul_f32 v[158:159], v[158:159], v[126:127]
v_pk_mul_f32 v[196:197], v[196:197], v[164:165]
v_pk_mul_f32 v[164:165], v[164:165], v[28:29] op_sel:[0,1] op_sel_hi:[1,1]
v_pk_mul_f32 v[198:199], v[198:199], v[166:167]
v_pk_mul_f32 v[166:167], v[166:167], v[28:29] op_sel:[0,1] op_sel_hi:[1,1]
v_pk_mul_f32 v[212:213], v[212:213], v[180:181]
v_pk_mul_f32 v[180:181], v[180:181], v[28:29] op_sel:[0,1] op_sel_hi:[1,1]
v_pk_mul_f32 v[214:215], v[214:215], v[182:183]
v_pk_mul_f32 v[182:183], v[182:183], v[28:29] op_sel:[0,1] op_sel_hi:[1,1]
v_pk_fma_f32 v[160:161], v[160:161], v[20:21], v[20:21] op_sel:[0,1,1] op_sel_hi:[1,1,1]
v_pk_fma_f32 v[162:163], v[162:163], v[20:21], v[20:21] op_sel:[0,1,1] op_sel_hi:[1,1,1]
v_pk_fma_f32 v[176:177], v[176:177], v[20:21], v[20:21] op_sel:[0,1,1] op_sel_hi:[1,1,1]
v_pk_fma_f32 v[178:179], v[178:179], v[20:21], v[20:21] op_sel:[0,1,1] op_sel_hi:[1,1,1]
v_cvt_pk_bf16_f32 v108, v140, v141
v_cvt_pk_bf16_f32 v109, v142, v143
v_cvt_pk_bf16_f32 v110, v156, v157
v_cvt_pk_bf16_f32 v111, v158, v159
MAA 200,0,136
buffer_store_dwordx4 v[108:111], v11, s[16:19], s63 offen offset:1024 sc1
MAA 200,4,152
v_rcp_f32 v160, v160
MAA 200,32,168
v_rcp_f32 v161, v161
MAA 200,36,184
v_rcp_f32 v162, v162
MAA 216,44,184
buffer_load_dwordx4 v19, s[28:31], s58 offen offset:1056 lds
MAA 216,40,168
s_add_u32 m0, s59, 126720
s_add_u32 s58, s101, 3473408
v_rcp_f32 v163, v163
MAA 216,12,152
v_rcp_f32 v176, v176
MAA 216,8,136
v_rcp_f32 v177, v177
MAA 168,16,168
buffer_load_dwordx4 v18, s[28:31], s58 offen lds
MAA 168,20,184
v_rcp_f32 v178, v178
MAA 184,28,184
v_rcp_f32 v179, v179
MAA 184,24,168
v_exp_f32 v164, v164
v_exp_f32 v165, v165
v_exp_f32 v166, v166
v_exp_f32 v167, v167
v_exp_f32 v180, v180
v_exp_f32 v181, v181
v_exp_f32 v182, v182
v_exp_f32 v183, v183
v_pk_mul_f32 v[192:193], v[192:193], v[160:161]
v_pk_mul_f32 v[194:195], v[194:195], v[162:163]
v_pk_mul_f32 v[208:209], v[208:209], v[176:177]
v_pk_mul_f32 v[210:211], v[210:211], v[178:179]
v_pk_mul_f32 v[200:201], v[200:201], v[168:169]
v_pk_mul_f32 v[168:169], v[168:169], v[30:31] op_sel_hi:[1,0]
v_pk_mul_f32 v[202:203], v[202:203], v[170:171]
v_pk_mul_f32 v[170:171], v[170:171], v[30:31] op_sel_hi:[1,0]
v_pk_mul_f32 v[216:217], v[216:217], v[184:185]
v_pk_mul_f32 v[184:185], v[184:185], v[30:31] op_sel_hi:[1,0]
v_pk_mul_f32 v[218:219], v[218:219], v[186:187]
v_pk_mul_f32 v[186:187], v[186:187], v[30:31] op_sel_hi:[1,0]
v_pk_fma_f32 v[164:165], v[164:165], v[22:23], v[22:23] op_sel:[0,1,1] op_sel_hi:[1,1,1]
v_pk_fma_f32 v[166:167], v[166:167], v[22:23], v[22:23] op_sel:[0,1,1] op_sel_hi:[1,1,1]
v_pk_fma_f32 v[180:181], v[180:181], v[22:23], v[22:23] op_sel:[0,1,1] op_sel_hi:[1,1,1]
v_pk_fma_f32 v[182:183], v[182:183], v[22:23], v[22:23] op_sel:[0,1,1] op_sel_hi:[1,1,1]
v_cvt_pk_bf16_f32 v160, v192, v193
v_cvt_pk_bf16_f32 v161, v194, v195
v_cvt_pk_bf16_f32 v162, v208, v209
v_cvt_pk_bf16_f32 v163, v210, v211
MAA 204,0,140
buffer_store_dwordx4 v[160:163], v10, s[16:19], s64 offen sc1
MAA 204,4,156
v_rcp_f32 v164, v164
MAA 204,32,172
v_rcp_f32 v165, v165
MAA 204,36,188
v_rcp_f32 v166, v166
MAA 220,44,188
buffer_atomic_add v84, v69, s[16:19], s73 offen offset:512 sc0
MAA 220,40,172
v_rcp_f32 v167, v167
MAA 220,12,156
v_rcp_f32 v180, v180
MAA 220,8,140
v_rcp_f32 v181, v181
MAA 172,16,172
buffer_load_dwordx4 v19, s[28:31], s58 offen offset:1056 lds
MAA 172,20,188
v_rcp_f32 v182, v182
MAA 188,28,188
v_rcp_f32 v183, v183
MAA 188,24,172
v_exp_f32 v168, v168
v_exp_f32 v169, v169
v_exp_f32 v170, v170
v_exp_f32 v171, v171
v_exp_f32 v184, v184
v_exp_f32 v185, v185
v_exp_f32 v186, v186
v_exp_f32 v187, v187
v_pk_mul_f32 v[196:197], v[196:197], v[164:165]
v_pk_mul_f32 v[198:199], v[198:199], v[166:167]
v_pk_mul_f32 v[212:213], v[212:213], v[180:181]
v_pk_mul_f32 v[214:215], v[214:215], v[182:183]
v_pk_mul_f32 v[204:205], v[204:205], v[172:173]
v_pk_mul_f32 v[172:173], v[172:173], v[30:31] op_sel:[0,1] op_sel_hi:[1,1]
v_pk_mul_f32 v[206:207], v[206:207], v[174:175]
v_pk_mul_f32 v[174:175], v[174:175], v[30:31] op_sel:[0,1] op_sel_hi:[1,1]
v_pk_mul_f32 v[220:221], v[220:221], v[188:189]
v_pk_mul_f32 v[188:189], v[188:189], v[30:31] op_sel:[0,1] op_sel_hi:[1,1]
v_pk_mul_f32 v[222:223], v[222:223], v[190:191]
v_pk_mul_f32 v[190:191], v[190:191], v[30:31] op_sel:[0,1] op_sel_hi:[1,1]
v_pk_fma_f32 v[168:169], v[168:169], v[24:25], v[24:25] op_sel:[0,1,1] op_sel_hi:[1,1,1]
v_pk_fma_f32 v[170:171], v[170:171], v[24:25], v[24:25] op_sel:[0,1,1] op_sel_hi:[1,1,1]
v_pk_fma_f32 v[184:185], v[184:185], v[24:25], v[24:25] op_sel:[0,1,1] op_sel_hi:[1,1,1]
v_pk_fma_f32 v[186:187], v[186:187], v[24:25], v[24:25] op_sel:[0,1,1] op_sel_hi:[1,1,1]
v_cvt_pk_bf16_f32 v164, v196, v197
v_cvt_pk_bf16_f32 v165, v198, v199
v_cvt_pk_bf16_f32 v166, v212, v213
v_cvt_pk_bf16_f32 v167, v214, v215
MAA 240,48,128
buffer_store_dwordx4 v[164:167], v10, s[16:19], s64 offen offset:1024 sc1
MAA 240,52,144
v_rcp_f32 v168, v168
MAA 240,80,160
v_rcp_f32 v169, v169
MAA 240,84,176
v_rcp_f32 v170, v170
MAA 248,92,176
buffer_atomic_add v85, v69, s[16:19], s73 offen offset:512 sc0
MAA 248,88,160
v_rcp_f32 v171, v171
MAA 248,60,144
v_rcp_f32 v184, v184
MAA 248,56,128
v_rcp_f32 v185, v185
MAA 224,64,160
v_rcp_f32 v186, v186
MAA 224,68,176
v_rcp_f32 v187, v187
MAA 232,76,176
v_exp_f32 v172, v172
MAA 232,72,160
v_exp_f32 v173, v173
v_exp_f32 v174, v174
v_exp_f32 v175, v175
v_exp_f32 v188, v188
v_exp_f32 v189, v189
v_exp_f32 v190, v190
v_exp_f32 v191, v191
v_pk_mul_f32 v[200:201], v[200:201], v[168:169]
v_pk_mul_f32 v[202:203], v[202:203], v[170:171]
v_pk_mul_f32 v[216:217], v[216:217], v[184:185]
v_pk_mul_f32 v[218:219], v[218:219], v[186:187]
v_pk_mul_f32 v[240:241], v[240:241], v[224:225]
v_pk_mul_f32 v[224:225], v[224:225], v[28:29] op_sel_hi:[1,0]
v_pk_mul_f32 v[242:243], v[242:243], v[226:227]
v_pk_mul_f32 v[226:227], v[226:227], v[28:29] op_sel_hi:[1,0]
v_pk_mul_f32 v[248:249], v[248:249], v[232:233]
v_pk_mul_f32 v[232:233], v[232:233], v[28:29] op_sel_hi:[1,0]
v_pk_mul_f32 v[250:251], v[250:251], v[234:235]
v_pk_mul_f32 v[234:235], v[234:235], v[28:29] op_sel_hi:[1,0]
v_pk_fma_f32 v[172:173], v[172:173], v[26:27], v[26:27] op_sel:[0,1,1] op_sel_hi:[1,1,1]
v_pk_fma_f32 v[174:175], v[174:175], v[26:27], v[26:27] op_sel:[0,1,1] op_sel_hi:[1,1,1]
v_pk_fma_f32 v[188:189], v[188:189], v[26:27], v[26:27] op_sel:[0,1,1] op_sel_hi:[1,1,1]
v_pk_fma_f32 v[190:191], v[190:191], v[26:27], v[26:27] op_sel:[0,1,1] op_sel_hi:[1,1,1]
v_cvt_pk_bf16_f32 v168, v200, v201
v_cvt_pk_bf16_f32 v169, v202, v203
v_cvt_pk_bf16_f32 v170, v216, v217
v_cvt_pk_bf16_f32 v171, v218, v219
buffer_store_dwordx4 v[168:171], v11, s[16:19], s64 offen sc1
buffer_atomic_add v86, v69, s[16:19], s73 offen offset:512 sc0
s_waitcnt vmcnt(5)
v_cmp_gt_u32 vcc, v70, v84
s_nop 0
s_cbranch_vccz .Lok66
s_waitcnt vmcnt(2)
v_cmp_gt_u32 vcc, v70, v85
s_nop 0
s_cbranch_vccz .Lok66
s_waitcnt vmcnt(0)
v_cmp_gt_u32 vcc, v70, v86
s_nop 0
s_cbranch_vccz .Lok66
s_mov_b32 s15, 0
.Lok66l:
v_mov_b32 v84, 0
buffer_atomic_add v84, v69, s[16:19], s73 offen offset:512 sc0
s_add_u32 s15, s15, 1
s_cmp_gt_u32 s15, 100000
s_waitcnt vmcnt(0)
s_cbranch_scc1 .Lok66
v_cmp_gt_u32 vcc, v70, v84
s_nop 0
s_cbranch_vccnz .Lok66l
.Lok66:
s_waitcnt vmcnt(4)
s_barrier
MAA 244,48,132
ds_read_b64_tr_b16 a[0:1], v7
s_add_u32 s52, s76, 0
MAA 244,52,148
buffer_load_dwordx4 v[96:99], v4, s[16:19], s52 offen sc1
MAA 244,80,164
TR 2,7,512
v_rcp_f32 v172, v172
MAA 244,84,180
TR 4,7,32
v_rcp_f32 v173, v173
MAA 252,92,180
TR 6,7,544
v_rcp_f32 v174, v174
MAA 252,88,164
buffer_load_dwordx4 v[100:103], v4, s[16:19], s52 offen offset:1024 sc1
MAA 252,60,148
TR 8,7,64
s_add_u32 s52, s76, 65536
MAA 252,56,132
TR 10,7,576
v_rcp_f32 v175, v175
MAA 228,64,164
TR 12,7,96
v_rcp_f32 v188, v188
MAA 228,68,180
buffer_load_dwordx4 v[104:107], v4, s[16:19], s52 offen sc1
MAA 236,76,180
TR 14,7,608
v_rcp_f32 v189, v189
MAA 236,72,164
TR 16,7,8448
v_rcp_f32 v190, v190
v_rcp_f32 v191, v191
v_exp_f32 v224, v224
v_exp_f32 v225, v225
v_exp_f32 v226, v226
v_exp_f32 v227, v227
v_exp_f32 v232, v232
v_exp_f32 v233, v233
v_exp_f32 v234, v234
v_exp_f32 v235, v235
v_pk_mul_f32 v[204:205], v[204:205], v[172:173]
buffer_load_dwordx4 v[108:111], v4, s[16:19], s52 offen offset:1024 sc1
s_add_u32 s52, s77, 114688
v_pk_mul_f32 v[206:207], v[206:207], v[174:175]
v_pk_mul_f32 v[220:221], v[220:221], v[188:189]
v_pk_mul_f32 v[222:223], v[222:223], v[190:191]
v_pk_mul_f32 v[244:245], v[244:245], v[228:229]
v_pk_mul_f32 v[228:229], v[228:229], v[28:29] op_sel:[0,1] op_sel_hi:[1,1]
v_pk_mul_f32 v[246:247], v[246:247], v[230:231]
v_pk_mul_f32 v[230:231], v[230:231], v[28:29] op_sel:[0,1] op_sel_hi:[1,1]
v_pk_mul_f32 v[252:253], v[252:253], v[236:237]
v_pk_mul_f32 v[236:237], v[236:237], v[28:29] op_sel:[0,1] op_sel_hi:[1,1]
v_pk_mul_f32 v[254:255], v[254:255], v[238:239]
v_pk_mul_f32 v[238:239], v[238:239], v[28:29] op_sel:[0,1] op_sel_hi:[1,1]
v_pk_fma_f32 v[224:225], v[224:225], v[20:21], v[20:21] op_sel:[0,1,1] op_sel_hi:[1,1,1]
buffer_load_dwordx4 v[112:115], v4, s[16:19], s52 offen sc1
v_pk_fma_f32 v[226:227], v[226:227], v[20:21], v[20:21] op_sel:[0,1,1] op_sel_hi:[1,1,1]
v_pk_fma_f32 v[232:233], v[232:233], v[20:21], v[20:21] op_sel:[0,1,1] op_sel_hi:[1,1,1]
v_pk_fma_f32 v[234:235], v[234:235], v[20:21], v[20:21] op_sel:[0,1,1] op_sel_hi:[1,1,1]
v_cvt_pk_bf16_f32 v172, v204, v205
v_cvt_pk_bf16_f32 v173, v206, v207
v_cvt_pk_bf16_f32 v174, v220, v221
v_cvt_pk_bf16_f32 v175, v222, v223
TR 18,7,8960
TR 20,7,8480
TR 22,7,8992
buffer_store_dwordx4 v[172:175], v11, s[16:19], s64 offen offset:1024 sc1
TR 24,7,8512
TR 26,7,9024
.Lpad36:
s_cbranch_execz .Lpad39
TR 28,7,8544
TR 30,7,9056
v_rcp_f32 v224, v224
v_rcp_f32 v225, v225
v_rcp_f32 v226, v226
v_rcp_f32 v227, v227
v_rcp_f32 v232, v232
v_rcp_f32 v233, v233
v_rcp_f32 v234, v234
v_rcp_f32 v235, v235
v_exp_f32 v228, v228
v_exp_f32 v229, v229
v_exp_f32 v230, v230
v_exp_f32 v231, v231
v_exp_f32 v236, v236
v_exp_f32 v237, v237
v_exp_f32 v238, v238
v_exp_f32 v239, v239
v_pk_mul_f32 v[240:241], v[240:241], v[224:225]
buffer_load_dwordx4 v[116:119], v4, s[16:19], s52 offen offset:1024 sc1
s_add_u32 s52, s77, 180224
v_pk_mul_f32 v[242:243], v[242:243], v[226:227]
v_pk_mul_f32 v[248:249], v[248:249], v[232:233]
v_pk_mul_f32 v[250:251], v[250:251], v[234:235]
v_pk_fma_f32 v[228:229], v[228:229], v[22:23], v[22:23] op_sel:[0,1,1] op_sel_hi:[1,1,1]
v_pk_fma_f32 v[230:231], v[230:231], v[22:23], v[22:23] op_sel:[0,1,1] op_sel_hi:[1,1,1]
v_pk_fma_f32 v[236:237], v[236:237], v[22:23], v[22:23] op_sel:[0,1,1] op_sel_hi:[1,1,1]
v_pk_fma_f32 v[238:239], v[238:239], v[22:23], v[22:23] op_sel:[0,1,1] op_sel_hi:[1,1,1]
v_cvt_pk_bf16_f32 v224, v240, v241
v_cvt_pk_bf16_f32 v225, v242, v243
v_cvt_pk_bf16_f32 v226, v248, v249
v_cvt_pk_bf16_f32 v227, v250, v251
v_rcp_f32 v228, v228
v_rcp_f32 v229, v229
v_rcp_f32 v230, v230
v_rcp_f32 v231, v231
v_rcp_f32 v236, v236
v_rcp_f32 v237, v237
v_rcp_f32 v238, v238
v_rcp_f32 v239, v239
v_pk_mul_f32 v[244:245], v[244:245], v[228:229]
buffer_store_dwordx4 v[224:227], v10, s[16:19], s65 offen sc1
v_pk_mul_f32 v[246:247], v[246:247], v[230:231]
v_pk_mul_f32 v[252:253], v[252:253], v[236:237]
v_pk_mul_f32 v[254:255], v[254:255], v[238:239]
v_cvt_pk_bf16_f32 v228, v244, v245
v_cvt_pk_bf16_f32 v229, v246, v247
v_cvt_pk_bf16_f32 v230, v252, v253
v_cvt_pk_bf16_f32 v231, v254, v255
buffer_store_dwordx4 v[228:231], v10, s[16:19], s65 offen offset:1024 sc1
buffer_load_dwordx4 v[120:123], v4, s[16:19], s52 offen sc1
buffer_load_dwordx4 v[124:127], v4, s[16:19], s52 offen offset:1024 sc1
v_mov_b32 v21, v68
v_mov_b32 v22, v69
v_mov_b32 v23, v70
v_mov_b32 v24, v71
v_mov_b32 v25, 0
s_waitcnt vmcnt(7) lgkmcnt(0)
s_barrier
v_mfma_f32_16x16x32_bf16 v[32:35], a[0:3], v[96:99], 0
ds_read_b64_tr_b16 a[32:33], v6
s_add_u32 s52, s78, 229376
MAV 32,16,104
buffer_load_dwordx4 v[128:131], v4, s[16:19], s52 offen sc1
v_mfma_f32_16x16x32_bf16 v[48:51], a[0:3], v[100:103], 0
TR 34,6,512
MAV 48,16,108
TR 36,6,32
TR 38,6,544
v_mfma_f32_16x16x32_bf16 v[52:55], a[4:7], v[100:103], 0
TR 48,6,8448
MAV 52,20,108
buffer_load_dwordx4 v[132:135], v4, s[16:19], s52 offen offset:1024 sc1
v_mfma_f32_16x16x32_bf16 v[36:39], a[4:7], v[96:99], 0
TR 50,6,8960
MAV 36,20,104
TR 52,6,8480
TR 54,6,8992
v_mfma_f32_16x16x32_bf16 v[40:43], a[8:11], v[96:99], 0
TR 40,6,64
s_add_u32 s52, s78, 294912
MAV 40,24,104
buffer_load_dwordx4 v[136:139], v4, s[16:19], s52 offen sc1
v_mfma_f32_16x16x32_bf16 v[56:59], a[8:11], v[100:103], 0
TR 42,6,576
MAV 56,24,108
TR 44,6,96
TR 46,6,608
v_mfma_f32_16x16x32_bf16 v[60:63], a[12:15], v[100:103], 0
TR 56,6,8512
MAV 60,28,108
buffer_load_dwordx4 v[140:143], v4, s[16:19], s52 offen offset:1024 sc1
v_mfma_f32_16x16x32_bf16 v[44:47], a[12:15], v[96:99], 0
TR 58,6,9024
MAV 44,28,104
TR 60,6,8544
TR 62,6,9056
s_waitcnt lgkmcnt(8)
v_mfma_f32_16x16x32_bf16 v[64:67], a[32:35], v[96:99], 0
TR 0,7,16896
s_add_u32 s52, s79, 344064
MAV 64,48,104
buffer_load_dwordx4 v[144:147], v4, s[16:19], s52 offen sc1
v_mfma_f32_16x16x32_bf16 v[80:83], a[32:35], v[100:103], 0
TR 2,7,17408
MAV 80,48,108
TR 4,7,16928
TR 6,7,17440
v_mfma_f32_16x16x32_bf16 v[84:87], a[36:39], v[100:103], 0
TR 16,7,25344
MAV 84,52,108
buffer_load_dwordx4 v[148:151], v4, s[16:19], s52 offen offset:1024 sc1
v_mfma_f32_16x16x32_bf16 v[68:71], a[36:39], v[96:99], 0
TR 18,7,25856
MAV 68,52,104
TR 20,7,25376
TR 22,7,25888
s_waitcnt lgkmcnt(8)
v_mfma_f32_16x16x32_bf16 v[72:75], a[40:43], v[96:99], 0
TR 8,7,16960
s_add_u32 s52, s79, 409600
MAV 72,56,104
buffer_load_dwordx4 v[152:155], v4, s[16:19], s52 offen sc1
v_mfma_f32_16x16x32_bf16 v[88:91], a[40:43], v[100:103], 0
TR 10,7,17472
MAV 88,56,108
TR 12,7,16992
TR 14,7,17504
v_mfma_f32_16x16x32_bf16 v[92:95], a[44:47], v[100:103], 0
TR 24,7,25408
MAV 92,60,108
buffer_load_dwordx4 v[156:159], v4, s[16:19], s52 offen offset:1024 sc1
v_mfma_f32_16x16x32_bf16 v[76:79], a[44:47], v[96:99], 0
TR 26,7,25920
MAV 76,60,104
TR 28,7,25440
TR 30,7,25952
s_waitcnt vmcnt(8) lgkmcnt(8)
s_barrier
MAV 32,0,112
TR 32,6,16896
s_add_u32 m0, s55, 0
MAV 32,16,120
buffer_load_dwordx4 v18, s[28:31], s54 offen lds
MAV 48,16,124
TR 34,6,17408
MAV 48,0,116
TR 36,6,16928
TR 38,6,17440
MAV 52,4,116
TR 48,6,25344
s_add_u32 s52, s76, 458752
MAV 52,20,124
buffer_load_dwordx4 v[96:99], v4, s[16:19], s52 offen sc1
MAV 36,20,120
TR 50,6,25856
MAV 36,4,112
TR 52,6,25376
TR 54,6,25888
s_waitcnt lgkmcnt(8)
MAV 40,8,112
TR 40,6,16960
MAV 40,24,120
buffer_load_dwordx4 v19, s[28:31], s54 offen offset:1056 lds
MAV 56,24,124
TR 42,6,17472
s_add_u32 s54, s98, 327680
MAV 56,8,116
TR 44,6,16992
TR 46,6,17504
MAV 60,12,116
TR 56,6,25408
MAV 60,28,124
buffer_load_dwordx4 v[100:103], v4, s[16:19], s52 offen offset:1024 sc1
MAV 44,28,120
TR 58,6,25920
MAV 44,12,112
TR 60,6,25440
TR 62,6,25952
s_waitcnt lgkmcnt(8)
MAV 64,32,112
TR 0,7,33792
s_add_u32 m0, s55, 8448
MAV 64,48,120
buffer_load_dwordx4 v18, s[28:31], s54 offen lds
MAV 80,48,124
TR 2,7,34304
MAV 80,32,116
TR 4,7,33824
TR 6,7,34336
MAV 84,36,116
TR 16,7,42240
s_add_u32 s52, s76, 524288
MAV 84,52,124
buffer_load_dwordx4 v[104:107], v4, s[16:19], s52 offen sc1
MAV 68,52,120
TR 18,7,42752
MAV 68,36,112
TR 20,7,42272
TR 22,7,42784
s_waitcnt lgkmcnt(8)
MAV 72,40,112
TR 8,7,33856
MAV 72,56,120
buffer_load_dwordx4 v19, s[28:31], s54 offen offset:1056 lds
MAV 88,56,124
TR 10,7,34368
s_add_u32 s54, s99, 524288
MAV 88,40,116
TR 12,7,33888
TR 14,7,34400
MAV 92,44,116
TR 24,7,42304
MAV 92,60,124
buffer_load_dwordx4 v[108:111], v4, s[16:19], s52 offen offset:1024 sc1
MAV 76,60,120
TR 26,7,42816
MAV 76,44,112
TR 28,7,42336
TR 30,7,42848
s_waitcnt vmcnt(12) lgkmcnt(8)
s_barrier
MAV 32,0,128
TR 32,6,33792
MAV 32,16,136
buffer_atomic_add v24, v21, s[16:19], s72 offen
MAV 48,16,140
TR 34,6,34304
MAV 48,0,132
TR 36,6,33824
TR 38,6,34336
TR 48,6,42240
MAV 52,4,132
TR 50,6,42752
s_add_u32 m0, s55, 16896
MAV 52,20,140
buffer_load_dwordx4 v18, s[28:31], s54 offen lds
MAV 36,20,136
TR 52,6,42272
MAV 36,4,128
TR 54,6,42784
TR 40,6,33856
s_waitcnt lgkmcnt(9)
MAV 40,8,128
TR 42,6,34368
s_add_u32 s52, s77, 573440
MAV 40,24,136
buffer_load_dwordx4 v[112:115], v4, s[16:19], s52 offen sc1
MAV 56,24,140
TR 44,6,33888
MAV 56,8,132
buffer_load_dwordx4 v19, s[28:31], s54 offen offset:1056 lds
MAV 60,12,132
TR 46,6,34400
s_add_u32 s54, s99, 786432
MAV 60,28,140
buffer_load_dwordx4 v[116:119], v4, s[16:19], s52 offen offset:1024 sc1
MAV 44,28,136
TR 56,6,42304
MAV 44,12,128
TR 58,6,42816
TR 60,6,42336
TR 62,6,42848
s_waitcnt lgkmcnt(8)
MAV 64,32,128
TR 0,7,50688
s_add_u32 m0, s55, 25344
MAV 64,48,136
buffer_load_dwordx4 v18, s[28:31], s54 offen lds
MAV 80,48,140
TR 2,7,51200
MAV 80,32,132
TR 4,7,50720
TR 6,7,51232
MAV 84,36,132
TR 16,7,59136
s_add_u32 s52, s77, 638976
MAV 84,52,140
buffer_load_dwordx4 v[120:123], v4, s[16:19], s52 offen sc1
MAV 68,52,136
TR 18,7,59648
MAV 68,36,128
TR 20,7,59168
TR 22,7,59680
s_waitcnt lgkmcnt(8)
MAV 72,40,128
TR 8,7,50752
MAV 72,56,136
buffer_load_dwordx4 v19, s[28:31], s54 offen offset:1056 lds
MAV 88,56,140
TR 10,7,51264
s_add_u32 s54, s100, 983040
MAV 88,40,132
TR 12,7,50784
TR 14,7,51296
MAV 92,44,132
TR 24,7,59200
MAV 92,60,140
buffer_load_dwordx4 v[124:127], v4, s[16:19], s52 offen offset:1024 sc1
MAV 76,60,136
TR 26,7,59712
MAV 76,44,128
TR 28,7,59232
TR 30,7,59744
s_waitcnt vmcnt(17) lgkmcnt(8)
s_barrier
MAV 32,0,144
TR 32,6,50688
s_add_u32 m0, s55, 33792
MAV 32,16,152
buffer_load_dwordx4 v18, s[28:31], s54 offen lds
MAV 48,16,156
TR 34,6,51200
MAV 48,0,148
TR 36,6,50720
TR 38,6,51232
MAV 52,4,148
TR 48,6,59136
s_add_u32 s52, s78, 688128
MAV 52,20,156
buffer_load_dwordx4 v[128:131], v4, s[16:19], s52 offen sc1
MAV 36,20,152
TR 50,6,59648
MAV 36,4,144
TR 52,6,59168
TR 54,6,59680
s_waitcnt lgkmcnt(8)
MAV 40,8,144
TR 40,6,50752
MAV 40,24,152
buffer_load_dwordx4 v19, s[28:31], s54 offen offset:1056 lds
MAV 56,24,156
TR 42,6,51264
s_add_u32 s54, s100, 1245184
MAV 56,8,148
TR 44,6,50784
TR 46,6,51296
MAV 60,12,148
TR 56,6,59200
MAV 60,28,156
buffer_load_dwordx4 v[132:135], v4, s[16:19], s52 offen offset:1024 sc1
MAV 44,28,152
TR 58,6,59712
MAV 44,12,144
TR 60,6,59232
TR 62,6,59744
v_add_u32 v7, s57, v7
v_add_u32 v6, s57, v6
s_sub_u32 s57, 0, s57
s_waitcnt lgkmcnt(8)
MAV 64,32,144
ds_read_b64_tr_b16 a[0:1], v7
s_add_u32 m0, s55, 42240
MAV 64,48,152
buffer_load_dwordx4 v18, s[28:31], s54 offen lds
MAV 80,48,156
TR 2,7,512
MAV 80,32,148
TR 4,7,32
TR 6,7,544
TR 16,7,8448
MAV 84,36,148
TR 18,7,8960
s_add_u32 s52, s78, 753664
MAV 84,52,156
buffer_load_dwordx4 v[136:139], v4, s[16:19], s52 offen sc1
MAV 68,52,152
TR 20,7,8480
MAV 68,36,144
TR 22,7,8992
TR 8,7,64
s_waitcnt lgkmcnt(9)
MAV 72,40,144
TR 10,7,576
MAV 72,56,152
buffer_load_dwordx4 v19, s[28:31], s54 offen offset:1056 lds
MAV 88,56,156
TR 12,7,96
s_add_u32 s54, s101, 1441792
MAV 88,40,148
buffer_load_dwordx4 v[140:143], v4, s[16:19], s52 offen offset:1024 sc1
MAV 92,44,148
TR 14,7,608
MAV 92,60,156
buffer_atomic_add v25, v22, s[16:19], s73 offen sc0
MAV 76,60,152
TR 24,7,8512
MAV 76,44,144
TR 26,7,9024
TR 28,7,8544
TR 30,7,9056
s_waitcnt vmcnt(18) lgkmcnt(8)
s_barrier
MAV 32,0,96
ds_read_b64_tr_b16 a[32:33], v6
s_add_u32 m0, s55, 50688
MAV 32,16,104
buffer_load_dwordx4 v18, s[28:31], s54 offen lds
MAV 48,16,108
TR 34,6,512
MAV 48,0,100
TR 36,6,32
TR 38,6,544
MAV 52,4,100
TR 48,6,8448
s_add_u32 s52, s79, 802816
MAV 52,20,108
buffer_load_dwordx4 v[144:147], v4, s[16:19], s52 offen sc1
MAV 36,20,104
TR 50,6,8960
MAV 36,4,96
TR 52,6,8480
TR 54,6,8992
s_waitcnt lgkmcnt(8)
MAV 40,8,96
TR 40,6,64
MAV 40,24,104
buffer_load_dwordx4 v19, s[28:31], s54 offen offset:1056 lds
MAV 56,24,108
TR 42,6,576
s_add_u32 s54, s101, 1703936
MAV 56,8,100
TR 44,6,96
TR 46,6,608
MAV 60,12,100
TR 56,6,8512
MAV 60,28,108
buffer_load_dwordx4 v[148:151], v4, s[16:19], s52 offen offset:1024 sc1
MAV 44,28,104
TR 58,6,9024
MAV 44,12,96
TR 60,6,8544
TR 62,6,9056
s_waitcnt lgkmcnt(8)
MAV 64,32,96
TR 0,7,16896
s_add_u32 m0, s55, 59136
MAV 64,48,104
buffer_load_dwordx4 v18, s[28:31], s54 offen lds
MAV 80,48,108
TR 2,7,17408
MAV 80,32,100
TR 4,7,16928
TR 6,7,17440
MAV 84,36,100
TR 16,7,25344
s_add_u32 s52, s79, 868352
MAV 84,52,108
buffer_load_dwordx4 v[152:155], v4, s[16:19], s52 offen sc1
MAV 68,52,104
TR 18,7,25856
MAV 68,36,96
TR 20,7,25376
TR 22,7,25888
s_waitcnt lgkmcnt(8)
MAV 72,40,96
TR 8,7,16960
MAV 72,56,104
buffer_load_dwordx4 v19, s[28:31], s54 offen offset:1056 lds
MAV 88,56,108
TR 10,7,17472
s_add_u32 s54, s98, 1900544
MAV 88,40,100
TR 12,7,16992
TR 14,7,17504
MAV 92,44,100
TR 24,7,25408
MAV 92,60,108
buffer_load_dwordx4 v[156:159], v4, s[16:19], s52 offen offset:1024 sc1
MAV 76,60,104
TR 26,7,25920
MAV 76,44,96
TR 28,7,25440
TR 30,7,25952
s_waitcnt vmcnt(8)
v_cmp_gt_u32 vcc, v23, v25
s_nop 0
s_cbranch_vccnz .Lsp67
.Lsp67b:
s_waitcnt lgkmcnt(8)
s_barrier
MAV 32,0,112
TR 32,6,16896
s_add_u32 m0, s55, 67584
MAV 32,16,120
buffer_load_dwordx4 v18, s[28:31], s54 offen lds
MAV 48,16,124
TR 34,6,17408
MAV 48,0,116
TR 36,6,16928
TR 38,6,17440
MAV 52,4,116
TR 48,6,25344
s_add_u32 s52, s76, 16384
MAV 52,20,124
buffer_load_dwordx4 v[96:99], v4, s[16:19], s52 offen sc1
MAV 36,20,120
TR 50,6,25856
MAV 36,4,112
TR 52,6,25376
TR 54,6,25888
s_waitcnt lgkmcnt(8)
MAV 40,8,112
TR 40,6,16960
MAV 40,24,120
buffer_load_dwordx4 v19, s[28:31], s54 offen offset:1056 lds
MAV 56,24,124
TR 42,6,17472
s_add_u32 s54, s98, 2162688
MAV 56,8,116
TR 44,6,16992
TR 46,6,17504
MAV 60,12,116
TR 56,6,25408
MAV 60,28,124
buffer_load_dwordx4 v[100:103], v4, s[16:19], s52 offen offset:1024 sc1
MAV 44,28,120
TR 58,6,25920
MAV 44,12,112
TR 60,6,25440
TR 62,6,25952
s_waitcnt lgkmcnt(8)
MAV 64,32,112
TR 0,7,33792
s_add_u32 m0, s55, 76032
MAV 64,48,120
buffer_load_dwordx4 v18, s[28:31], s54 offen lds
MAV 80,48,124
TR 2,7,34304
MAV 80,32,116
TR 4,7,33824
TR 6,7,34336
MAV 84,36,116
TR 16,7,42240
s_add_u32 s52, s76, 81920
MAV 84,52,124
buffer_load_dwordx4 v[104:107], v4, s[16:19], s52 offen sc1
MAV 68,52,120
TR 18,7,42752
MAV 68,36,112
TR 20,7,42272
TR 22,7,42784
s_waitcnt lgkmcnt(8)
MAV 72,40,112
TR 8,7,33856
.Lpad37:
s_cbranch_execz .Lpad40
MAV 72,56,120
buffer_load_dwordx4 v19, s[28:31], s54 offen offset:1056 lds
MAV 88,56,124
TR 10,7,34368
s_add_u32 s54, s99, 2359296
MAV 88,40,116
TR 12,7,33888
TR 14,7,34400
MAV 92,44,116
TR 24,7,42304
MAV 92,60,124
buffer_load_dwordx4 v[108:111], v4, s[16:19], s52 offen offset:1024 sc1
MAV 76,60,120
TR 26,7,42816
MAV 76,44,112
TR 28,7,42336
TR 30,7,42848
s_waitcnt lgkmcnt(8)
s_barrier
MAV 32,0,128
TR 32,6,33792
s_add_u32 m0, s55, 84480
MAV 32,16,136
buffer_load_dwordx4 v18, s[28:31], s54 offen lds
MAV 48,16,140
TR 34,6,34304
MAV 48,0,132
TR 36,6,33824
TR 38,6,34336
MAV 52,4,132
TR 48,6,42240
s_add_u32 s52, s77, 131072
MAV 52,20,140
buffer_load_dwordx4 v[112:115], v4, s[16:19], s52 offen sc1
MAV 36,20,136
TR 50,6,42752
MAV 36,4,128
TR 52,6,42272
TR 54,6,42784
s_waitcnt lgkmcnt(8)
MAV 40,8,128
TR 40,6,33856
MAV 40,24,136
buffer_load_dwordx4 v19, s[28:31], s54 offen offset:1056 lds
MAV 56,24,140
TR 42,6,34368
s_add_u32 s54, s99, 2621440
MAV 56,8,132
TR 44,6,33888
TR 46,6,34400
MAV 60,12,132
TR 56,6,42304
MAV 60,28,140
buffer_load_dwordx4 v[116:119], v4, s[16:19], s52 offen offset:1024 sc1
MAV 44,28,136
TR 58,6,42816
MAV 44,12,128
TR 60,6,42336
TR 62,6,42848
s_waitcnt lgkmcnt(8)
MAV 64,32,128
TR 0,7,50688
s_add_u32 m0, s55, 92928
MAV 64,48,136
buffer_load_dwordx4 v18, s[28:31], s54 offen lds
MAV 80,48,140
TR 2,7,51200
MAV 80,32,132
TR 4,7,50720
TR 6,7,51232
MAV 84,36,132
TR 16,7,59136
s_add_u32 s52, s77, 196608
MAV 84,52,140
buffer_load_dwordx4 v[120:123], v4, s[16:19], s52 offen sc1
MAV 68,52,136
TR 18,7,59648
MAV 68,36,128
TR 20,7,59168
TR 22,7,59680
s_waitcnt lgkmcnt(8)
MAV 72,40,128
TR 8,7,50752
MAV 72,56,136
buffer_load_dwordx4 v19, s[28:31], s54 offen offset:1056 lds
MAV 88,56,140
TR 10,7,51264
s_add_u32 s54, s100, 2818048
MAV 88,40,132
TR 12,7,50784
TR 14,7,51296
MAV 92,44,132
TR 24,7,59200
MAV 92,60,140
buffer_load_dwordx4 v[124:127], v4, s[16:19], s52 offen offset:1024 sc1
MAV 76,60,136
TR 26,7,59712
MAV 76,44,128
TR 28,7,59232
TR 30,7,59744
s_waitcnt vmcnt(16) lgkmcnt(8)
s_barrier
MAV 32,0,144
TR 32,6,50688
s_add_u32 m0, s55, 101376
MAV 32,16,152
buffer_load_dwordx4 v18, s[28:31], s54 offen lds
MAV 48,16,156
TR 34,6,51200
MAV 48,0,148
TR 36,6,50720
TR 38,6,51232
MAV 52,4,148
TR 48,6,59136
s_add_u32 s52, s78, 245760
MAV 52,20,156
buffer_load_dwordx4 v[128:131], v4, s[16:19], s52 offen sc1
MAV 36,20,152
TR 50,6,59648
MAV 36,4,144
TR 52,6,59168
TR 54,6,59680
s_waitcnt lgkmcnt(8)
MAV 40,8,144
TR 40,6,50752
MAV 40,24,152
buffer_load_dwordx4 v19, s[28:31], s54 offen offset:1056 lds
MAV 56,24,156
TR 42,6,51264
s_add_u32 s54, s100, 3080192
MAV 56,8,148
TR 44,6,50784
TR 46,6,51296
MAV 60,12,148
TR 56,6,59200
MAV 60,28,156
buffer_load_dwordx4 v[132:135], v4, s[16:19], s52 offen offset:1024 sc1
MAV 44,28,152
TR 58,6,59712
MAV 44,12,144
TR 60,6,59232
TR 62,6,59744
v_add_u32 v7, s57, v7
v_add_u32 v6, s57, v6
s_sub_u32 s57, 0, s57
s_waitcnt lgkmcnt(8)
MAV 64,32,144
ds_read_b64_tr_b16 a[0:1], v7
s_add_u32 m0, s55, 109824
MAV 64,48,152
buffer_load_dwordx4 v18, s[28:31], s54 offen lds
MAV 80,48,156
TR 2,7,512
MAV 80,32,148
TR 4,7,32
TR 6,7,544
MAV 84,36,148
TR 16,7,8448
s_add_u32 s52, s78, 311296
MAV 84,52,156
buffer_load_dwordx4 v[136:139], v4, s[16:19], s52 offen sc1
MAV 68,52,152
TR 18,7,8960
MAV 68,36,144
TR 20,7,8480
TR 22,7,8992
s_waitcnt lgkmcnt(8)
MAV 72,40,144
TR 8,7,64
MAV 72,56,152
buffer_load_dwordx4 v19, s[28:31], s54 offen offset:1056 lds
MAV 88,56,156
TR 10,7,576
s_add_u32 s54, s101, 3276800
MAV 88,40,148
TR 12,7,96
TR 14,7,608
MAV 92,44,148
TR 24,7,8512
MAV 92,60,156
buffer_load_dwordx4 v[140:143], v4, s[16:19], s52 offen offset:1024 sc1
MAV 76,60,152
TR 26,7,9024
MAV 76,44,144
TR 28,7,8544
TR 30,7,9056
s_waitcnt vmcnt(16) lgkmcnt(8)
s_barrier
MAV 32,0,96
ds_read_b64_tr_b16 a[32:33], v6
s_add_u32 m0, s55, 118272
MAV 32,16,104
buffer_load_dwordx4 v18, s[28:31], s54 offen lds
MAV 48,16,108
TR 34,6,512
MAV 48,0,100
TR 36,6,32
TR 38,6,544
MAV 52,4,100
TR 48,6,8448
s_add_u32 s52, s79, 360448
MAV 52,20,108
buffer_load_dwordx4 v[144:147], v4, s[16:19], s52 offen sc1
MAV 36,20,104
TR 50,6,8960
MAV 36,4,96
TR 52,6,8480
TR 54,6,8992
s_waitcnt lgkmcnt(8)
MAV 40,8,96
TR 40,6,64
MAV 40,24,104
buffer_load_dwordx4 v19, s[28:31], s54 offen offset:1056 lds
MAV 56,24,108
TR 42,6,576
s_add_u32 s54, s101, 3538944
MAV 56,8,100
TR 44,6,96
TR 46,6,608
MAV 60,12,100
TR 56,6,8512
MAV 60,28,108
buffer_load_dwordx4 v[148:151], v4, s[16:19], s52 offen offset:1024 sc1
MAV 44,28,104
TR 58,6,9024
MAV 44,12,96
TR 60,6,8544
TR 62,6,9056
s_waitcnt lgkmcnt(8)
MAV 64,32,96
TR 0,7,16896
s_add_u32 m0, s55, 126720
MAV 64,48,104
buffer_load_dwordx4 v18, s[28:31], s54 offen lds
MAV 80,48,108
TR 2,7,17408
MAV 80,32,100
TR 4,7,16928
TR 6,7,17440
MAV 84,36,100
TR 16,7,25344
s_add_u32 s52, s79, 425984
MAV 84,52,108
buffer_load_dwordx4 v[152:155], v4, s[16:19], s52 offen sc1
MAV 68,52,104
TR 18,7,25856
MAV 68,36,96
TR 20,7,25376
TR 22,7,25888
s_waitcnt lgkmcnt(8)
MAV 72,40,96
TR 8,7,16960
MAV 72,56,104
buffer_load_dwordx4 v19, s[28:31], s54 offen offset:1056 lds
MAV 88,56,108
TR 10,7,17472
s_add_u32 s54, s98, 131072
MAV 88,40,100
TR 12,7,16992
TR 14,7,17504
MAV 92,44,100
TR 24,7,25408
MAV 92,60,108
buffer_load_dwordx4 v[156:159], v4, s[16:19], s52 offen offset:1024 sc1
MAV 76,60,104
TR 26,7,25920
MAV 76,44,96
TR 28,7,25440
TR 30,7,25952
s_waitcnt vmcnt(16) lgkmcnt(8)
s_barrier
MAV 32,0,112
TR 32,6,16896
s_add_u32 m0, s55, 0
MAV 32,16,120
buffer_load_dwordx4 v18, s[28:31], s54 offen lds
MAV 48,16,124
TR 34,6,17408
MAV 48,0,116
TR 36,6,16928
TR 38,6,17440
MAV 52,4,116
TR 48,6,25344
s_add_u32 s52, s76, 475136
MAV 52,20,124
buffer_load_dwordx4 v[96:99], v4, s[16:19], s52 offen sc1
MAV 36,20,120
TR 50,6,25856
MAV 36,4,112
TR 52,6,25376
TR 54,6,25888
s_waitcnt lgkmcnt(8)
MAV 40,8,112
TR 40,6,16960
MAV 40,24,120
buffer_load_dwordx4 v19, s[28:31], s54 offen offset:1056 lds
MAV 56,24,124
TR 42,6,17472
s_add_u32 s54, s98, 393216
MAV 56,8,116
TR 44,6,16992
TR 46,6,17504
MAV 60,12,116
TR 56,6,25408
MAV 60,28,124
buffer_load_dwordx4 v[100:103], v4, s[16:19], s52 offen offset:1024 sc1
MAV 44,28,120
TR 58,6,25920
MAV 44,12,112
TR 60,6,25440
TR 62,6,25952
s_waitcnt lgkmcnt(8)
MAV 64,32,112
TR 0,7,33792
s_add_u32 m0, s55, 8448
MAV 64,48,120
buffer_load_dwordx4 v18, s[28:31], s54 offen lds
MAV 80,48,124
TR 2,7,34304
MAV 80,32,116
TR 4,7,33824
TR 6,7,34336
MAV 84,36,116
TR 16,7,42240
s_add_u32 s52, s76, 540672
MAV 84,52,124
buffer_load_dwordx4 v[104:107], v4, s[16:19], s52 offen sc1
MAV 68,52,120
TR 18,7,42752
MAV 68,36,112
TR 20,7,42272
TR 22,7,42784
s_waitcnt lgkmcnt(8)
MAV 72,40,112
TR 8,7,33856
MAV 72,56,120
buffer_load_dwordx4 v19, s[28:31], s54 offen offset:1056 lds
MAV 88,56,124
TR 10,7,34368
s_add_u32 s54, s99, 589824
MAV 88,40,116
TR 12,7,33888
TR 14,7,34400
MAV 92,44,116
TR 24,7,42304
MAV 92,60,124
buffer_load_dwordx4 v[108:111], v4, s[16:19], s52 offen offset:1024 sc1
MAV 76,60,120
TR 26,7,42816
MAV 76,44,112
TR 28,7,42336
TR 30,7,42848
s_waitcnt vmcnt(16) lgkmcnt(8)
s_barrier
MAV 32,0,128
TR 32,6,33792
s_add_u32 m0, s55, 16896
MAV 32,16,136
buffer_load_dwordx4 v18, s[28:31], s54 offen lds
MAV 48,16,140
TR 34,6,34304
MAV 48,0,132
TR 36,6,33824
TR 38,6,34336
MAV 52,4,132
TR 48,6,42240
s_add_u32 s52, s77, 589824
MAV 52,20,140
buffer_load_dwordx4 v[112:115], v4, s[16:19], s52 offen sc1
MAV 36,20,136
TR 50,6,42752
MAV 36,4,128
TR 52,6,42272
TR 54,6,42784
s_waitcnt lgkmcnt(8)
MAV 40,8,128
TR 40,6,33856
MAV 40,24,136
buffer_load_dwordx4 v19, s[28:31], s54 offen offset:1056 lds
MAV 56,24,140
TR 42,6,34368
s_add_u32 s54, s99, 851968
MAV 56,8,132
TR 44,6,33888
TR 46,6,34400
MAV 60,12,132
TR 56,6,42304
MAV 60,28,140
buffer_load_dwordx4 v[116:119], v4, s[16:19], s52 offen offset:1024 sc1
MAV 44,28,136
TR 58,6,42816
MAV 44,12,128
TR 60,6,42336
TR 62,6,42848
s_waitcnt lgkmcnt(8)
MAV 64,32,128
TR 0,7,50688
s_add_u32 m0, s55, 25344
MAV 64,48,136
buffer_load_dwordx4 v18, s[28:31], s54 offen lds
MAV 80,48,140
TR 2,7,51200
MAV 80,32,132
TR 4,7,50720
TR 6,7,51232
MAV 84,36,132
TR 16,7,59136
s_add_u32 s52, s77, 655360
MAV 84,52,140
buffer_load_dwordx4 v[120:123], v4, s[16:19], s52 offen sc1
MAV 68,52,136
TR 18,7,59648
MAV 68,36,128
TR 20,7,59168
TR 22,7,59680
s_waitcnt lgkmcnt(8)
MAV 72,40,128
TR 8,7,50752
MAV 72,56,136
buffer_load_dwordx4 v19, s[28:31], s54 offen offset:1056 lds
MAV 88,56,140
TR 10,7,51264
s_add_u32 s54, s100, 1048576
MAV 88,40,132
TR 12,7,50784
TR 14,7,51296
MAV 92,44,132
TR 24,7,59200
MAV 92,60,140
buffer_load_dwordx4 v[124:127], v4, s[16:19], s52 offen offset:1024 sc1
MAV 76,60,136
TR 26,7,59712
MAV 76,44,128
TR 28,7,59232
TR 30,7,59744
s_waitcnt vmcnt(16) lgkmcnt(8)
s_barrier
MAV 32,0,144
TR 32,6,50688
s_add_u32 m0, s55, 33792
MAV 32,16,152
buffer_load_dwordx4 v18, s[28:31], s54 offen lds
MAV 48,16,156
TR 34,6,51200
MAV 48,0,148
TR 36,6,50720
TR 38,6,51232
MAV 52,4,148
TR 48,6,59136
s_add_u32 s52, s78, 704512
MAV 52,20,156
buffer_load_dwordx4 v[128:131], v4, s[16:19], s52 offen sc1
MAV 36,20,152
TR 50,6,59648
MAV 36,4,144
TR 52,6,59168
TR 54,6,59680
s_waitcnt lgkmcnt(8)
MAV 40,8,144
TR 40,6,50752
MAV 40,24,152
buffer_load_dwordx4 v19, s[28:31], s54 offen offset:1056 lds
MAV 56,24,156
TR 42,6,51264
s_add_u32 s54, s100, 1310720
MAV 56,8,148
TR 44,6,50784
TR 46,6,51296
MAV 60,12,148
TR 56,6,59200
MAV 60,28,156
buffer_load_dwordx4 v[132:135], v4, s[16:19], s52 offen offset:1024 sc1
MAV 44,28,152
TR 58,6,59712
MAV 44,12,144
TR 60,6,59232
TR 62,6,59744
v_add_u32 v7, s57, v7
v_add_u32 v6, s57, v6
s_sub_u32 s57, 0, s57
s_waitcnt lgkmcnt(8)
MAV 64,32,144
ds_read_b64_tr_b16 a[0:1], v7
s_add_u32 m0, s55, 42240
MAV 64,48,152
buffer_load_dwordx4 v18, s[28:31], s54 offen lds
MAV 80,48,156
TR 2,7,512
MAV 80,32,148
TR 4,7,32
TR 6,7,544
MAV 84,36,148
TR 16,7,8448
s_add_u32 s52, s78, 770048
MAV 84,52,156
buffer_load_dwordx4 v[136:139], v4, s[16:19], s52 offen sc1
MAV 68,52,152
TR 18,7,8960
MAV 68,36,144
TR 20,7,8480
TR 22,7,8992
s_waitcnt lgkmcnt(8)
MAV 72,40,144
TR 8,7,64
MAV 72,56,152
buffer_load_dwordx4 v19, s[28:31], s54 offen offset:1056 lds
MAV 88,56,156
TR 10,7,576
s_add_u32 s54, s101, 1507328
MAV 88,40,148
TR 12,7,96
TR 14,7,608
MAV 92,44,148
TR 24,7,8512
MAV 92,60,156
buffer_load_dwordx4 v[140:143], v4, s[16:19], s52 offen offset:1024 sc1
MAV 76,60,152
TR 26,7,9024
MAV 76,44,144
TR 28,7,8544
TR 30,7,9056
s_waitcnt vmcnt(16) lgkmcnt(8)
s_barrier
MAV 32,0,96
ds_read_b64_tr_b16 a[32:33], v6
s_add_u32 m0, s55, 50688
MAV 32,16,104
buffer_load_dwordx4 v18, s[28:31], s54 offen lds
MAV 48,16,108
TR 34,6,512
MAV 48,0,100
.Lpad38:
s_cbranch_execz .Lnopoll63r
TR 36,6,32
TR 38,6,544
MAV 52,4,100
TR 48,6,8448
s_add_u32 s52, s79, 819200
MAV 52,20,108
buffer_load_dwordx4 v[144:147], v4, s[16:19], s52 offen sc1
MAV 36,20,104
TR 50,6,8960
MAV 36,4,96
TR 52,6,8480
TR 54,6,8992
s_waitcnt lgkmcnt(8)
MAV 40,8,96
TR 40,6,64
MAV 40,24,104
buffer_load_dwordx4 v19, s[28:31], s54 offen offset:1056 lds
MAV 56,24,108
TR 42,6,576
s_add_u32 s54, s101, 1769472
MAV 56,8,100
TR 44,6,96
TR 46,6,608
MAV 60,12,100
TR 56,6,8512
MAV 60,28,108
buffer_load_dwordx4 v[148:151], v4, s[16:19], s52 offen offset:1024 sc1
MAV 44,28,104
TR 58,6,9024
MAV 44,12,96
TR 60,6,8544
TR 62,6,9056
s_waitcnt lgkmcnt(8)
MAV 64,32,96
TR 0,7,16896
s_add_u32 m0, s55, 59136
MAV 64,48,104
buffer_load_dwordx4 v18, s[28:31], s54 offen lds
MAV 80,48,108
TR 2,7,17408
MAV 80,32,100
TR 4,7,16928
TR 6,7,17440
MAV 84,36,100
TR 16,7,25344
s_add_u32 s52, s79, 884736
MAV 84,52,108
buffer_load_dwordx4 v[152:155], v4, s[16:19], s52 offen sc1
MAV 68,52,104
TR 18,7,25856
MAV 68,36,96
TR 20,7,25376
TR 22,7,25888
s_waitcnt lgkmcnt(8)
MAV 72,40,96
TR 8,7,16960
MAV 72,56,104
buffer_load_dwordx4 v19, s[28:31], s54 offen offset:1056 lds
MAV 88,56,108
TR 10,7,17472
s_add_u32 s54, s98, 1966080
MAV 88,40,100
TR 12,7,16992
TR 14,7,17504
MAV 92,44,100
TR 24,7,25408
MAV 92,60,108
buffer_load_dwordx4 v[156:159], v4, s[16:19], s52 offen offset:1024 sc1
MAV 76,60,104
TR 26,7,25920
MAV 76,44,96
TR 28,7,25440
TR 30,7,25952
s_waitcnt vmcnt(16) lgkmcnt(8)
s_barrier
MAV 32,0,112
TR 32,6,16896
s_add_u32 m0, s55, 67584
MAV 32,16,120
buffer_load_dwordx4 v18, s[28:31], s54 offen lds
MAV 48,16,124
TR 34,6,17408
MAV 48,0,116
TR 36,6,16928
TR 38,6,17440
MAV 52,4,116
TR 48,6,25344
s_add_u32 s52, s76, 32768
MAV 52,20,124
buffer_load_dwordx4 v[96:99], v4, s[16:19], s52 offen sc1
MAV 36,20,120
TR 50,6,25856
MAV 36,4,112
TR 52,6,25376
TR 54,6,25888
s_waitcnt lgkmcnt(8)
MAV 40,8,112
TR 40,6,16960
MAV 40,24,120
buffer_load_dwordx4 v19, s[28:31], s54 offen offset:1056 lds
MAV 56,24,124
TR 42,6,17472
s_add_u32 s54, s98, 2228224
MAV 56,8,116
TR 44,6,16992
TR 46,6,17504
MAV 60,12,116
TR 56,6,25408
MAV 60,28,124
buffer_load_dwordx4 v[100:103], v4, s[16:19], s52 offen offset:1024 sc1
MAV 44,28,120
TR 58,6,25920
MAV 44,12,112
TR 60,6,25440
TR 62,6,25952
s_waitcnt lgkmcnt(8)
MAV 64,32,112
TR 0,7,33792
s_add_u32 m0, s55, 76032
MAV 64,48,120
buffer_load_dwordx4 v18, s[28:31], s54 offen lds
MAV 80,48,124
TR 2,7,34304
MAV 80,32,116
TR 4,7,33824
TR 6,7,34336
MAV 84,36,116
TR 16,7,42240
s_add_u32 s52, s76, 98304
MAV 84,52,124
buffer_load_dwordx4 v[104:107], v4, s[16:19], s52 offen sc1
MAV 68,52,120
TR 18,7,42752
MAV 68,36,112
TR 20,7,42272
TR 22,7,42784
s_waitcnt lgkmcnt(8)
MAV 72,40,112
TR 8,7,33856
MAV 72,56,120
buffer_load_dwordx4 v19, s[28:31], s54 offen offset:1056 lds
MAV 88,56,124
TR 10,7,34368
s_add_u32 s54, s99, 2424832
MAV 88,40,116
TR 12,7,33888
TR 14,7,34400
MAV 92,44,116
TR 24,7,42304
MAV 92,60,124
buffer_load_dwordx4 v[108:111], v4, s[16:19], s52 offen offset:1024 sc1
MAV 76,60,120
TR 26,7,42816
MAV 76,44,112
TR 28,7,42336
TR 30,7,42848
s_waitcnt vmcnt(16) lgkmcnt(8)
s_barrier
MAV 32,0,128
TR 32,6,33792
s_add_u32 m0, s55, 84480
MAV 32,16,136
buffer_load_dwordx4 v18, s[28:31], s54 offen lds
MAV 48,16,140
TR 34,6,34304
MAV 48,0,132
TR 36,6,33824
TR 38,6,34336
MAV 52,4,132
TR 48,6,42240
s_add_u32 s52, s77, 147456
MAV 52,20,140
buffer_load_dwordx4 v[112:115], v4, s[16:19], s52 offen sc1
MAV 36,20,136
TR 50,6,42752
MAV 36,4,128
TR 52,6,42272
TR 54,6,42784
s_waitcnt lgkmcnt(8)
MAV 40,8,128
TR 40,6,33856
MAV 40,24,136
buffer_load_dwordx4 v19, s[28:31], s54 offen offset:1056 lds
MAV 56,24,140
TR 42,6,34368
s_add_u32 s54, s99, 2686976
MAV 56,8,132
TR 44,6,33888
TR 46,6,34400
MAV 60,12,132
TR 56,6,42304
MAV 60,28,140
buffer_load_dwordx4 v[116:119], v4, s[16:19], s52 offen offset:1024 sc1
MAV 44,28,136
TR 58,6,42816
MAV 44,12,128
TR 60,6,42336
TR 62,6,42848
s_waitcnt lgkmcnt(8)
MAV 64,32,128
TR 0,7,50688
s_add_u32 m0, s55, 92928
MAV 64,48,136
buffer_load_dwordx4 v18, s[28:31], s54 offen lds
MAV 80,48,140
TR 2,7,51200
MAV 80,32,132
TR 4,7,50720
TR 6,7,51232
MAV 84,36,132
TR 16,7,59136
s_add_u32 s52, s77, 212992
MAV 84,52,140
buffer_load_dwordx4 v[120:123], v4, s[16:19], s52 offen sc1
MAV 68,52,136
TR 18,7,59648
MAV 68,36,128
TR 20,7,59168
TR 22,7,59680
s_waitcnt lgkmcnt(8)
MAV 72,40,128
TR 8,7,50752
MAV 72,56,136
buffer_load_dwordx4 v19, s[28:31], s54 offen offset:1056 lds
MAV 88,56,140
TR 10,7,51264
s_add_u32 s54, s100, 2883584
MAV 88,40,132
TR 12,7,50784
TR 14,7,51296
MAV 92,44,132
TR 24,7,59200
MAV 92,60,140
buffer_load_dwordx4 v[124:127], v4, s[16:19], s52 offen offset:1024 sc1
MAV 76,60,136
TR 26,7,59712
MAV 76,44,128
TR 28,7,59232
TR 30,7,59744
s_waitcnt vmcnt(16) lgkmcnt(8)
s_barrier
MAV 32,0,144
TR 32,6,50688
s_add_u32 m0, s55, 101376
MAV 32,16,152
buffer_load_dwordx4 v18, s[28:31], s54 offen lds
MAV 48,16,156
TR 34,6,51200
MAV 48,0,148
TR 36,6,50720
TR 38,6,51232
MAV 52,4,148
TR 48,6,59136
s_add_u32 s52, s78, 262144
MAV 52,20,156
buffer_load_dwordx4 v[128:131], v4, s[16:19], s52 offen sc1
MAV 36,20,152
TR 50,6,59648
MAV 36,4,144
TR 52,6,59168
TR 54,6,59680
s_waitcnt lgkmcnt(8)
MAV 40,8,144
TR 40,6,50752
MAV 40,24,152
buffer_load_dwordx4 v19, s[28:31], s54 offen offset:1056 lds
MAV 56,24,156
TR 42,6,51264
s_add_u32 s54, s100, 3145728
MAV 56,8,148
TR 44,6,50784
TR 46,6,51296
MAV 60,12,148
TR 56,6,59200
MAV 60,28,156
buffer_load_dwordx4 v[132:135], v4, s[16:19], s52 offen offset:1024 sc1
MAV 44,28,152
TR 58,6,59712
MAV 44,12,144
TR 60,6,59232
TR 62,6,59744
v_add_u32 v7, s57, v7
v_add_u32 v6, s57, v6
s_sub_u32 s57, 0, s57
s_waitcnt lgkmcnt(8)
MAV 64,32,144
ds_read_b64_tr_b16 a[0:1], v7
s_add_u32 m0, s55, 109824
MAV 64,48,152
buffer_load_dwordx4 v18, s[28:31], s54 offen lds
MAV 80,48,156
TR 2,7,512
MAV 80,32,148
TR 4,7,32
TR 6,7,544
MAV 84,36,148
TR 16,7,8448
s_add_u32 s52, s78, 327680
MAV 84,52,156
buffer_load_dwordx4 v[136:139], v4, s[16:19], s52 offen sc1
MAV 68,52,152
TR 18,7,8960
MAV 68,36,144
TR 20,7,8480
TR 22,7,8992
s_waitcnt lgkmcnt(8)
MAV 72,40,144
TR 8,7,64
MAV 72,56,152
buffer_load_dwordx4 v19, s[28:31], s54 offen offset:1056 lds
MAV 88,56,156
TR 10,7,576
s_add_u32 s54, s101, 3342336
MAV 88,40,148
TR 12,7,96
TR 14,7,608
MAV 92,44,148
TR 24,7,8512
MAV 92,60,156
buffer_load_dwordx4 v[140:143], v4, s[16:19], s52 offen offset:1024 sc1
MAV 76,60,152
TR 26,7,9024
MAV 76,44,144
TR 28,7,8544
TR 30,7,9056
s_waitcnt vmcnt(16) lgkmcnt(8)
s_barrier
MAV 32,0,96
ds_read_b64_tr_b16 a[32:33], v6
s_add_u32 m0, s55, 118272
MAV 32,16,104
buffer_load_dwordx4 v18, s[28:31], s54 offen lds
MAV 48,16,108
TR 34,6,512
MAV 48,0,100
TR 36,6,32
TR 38,6,544
MAV 52,4,100
TR 48,6,8448
s_add_u32 s52, s79, 376832
MAV 52,20,108
buffer_load_dwordx4 v[144:147], v4, s[16:19], s52 offen sc1
MAV 36,20,104
TR 50,6,8960
MAV 36,4,96
TR 52,6,8480
TR 54,6,8992
s_waitcnt lgkmcnt(8)
MAV 40,8,96
TR 40,6,64
MAV 40,24,104
buffer_load_dwordx4 v19, s[28:31], s54 offen offset:1056 lds
MAV 56,24,108
TR 42,6,576
s_add_u32 s54, s101, 3604480
MAV 56,8,100
TR 44,6,96
TR 46,6,608
MAV 60,12,100
TR 56,6,8512
MAV 60,28,108
buffer_load_dwordx4 v[148:151], v4, s[16:19], s52 offen offset:1024 sc1
MAV 44,28,104
TR 58,6,9024
MAV 44,12,96
TR 60,6,8544
TR 62,6,9056
s_waitcnt lgkmcnt(8)
MAV 64,32,96
TR 0,7,16896
s_add_u32 m0, s55, 126720
MAV 64,48,104
buffer_load_dwordx4 v18, s[28:31], s54 offen lds
MAV 80,48,108
TR 2,7,17408
MAV 80,32,100
TR 4,7,16928
TR 6,7,17440
MAV 84,36,100
TR 16,7,25344
s_add_u32 s52, s79, 442368
MAV 84,52,108
buffer_load_dwordx4 v[152:155], v4, s[16:19], s52 offen sc1
MAV 68,52,104
TR 18,7,25856
MAV 68,36,96
TR 20,7,25376
TR 22,7,25888
s_waitcnt lgkmcnt(8)
MAV 72,40,96
TR 8,7,16960
MAV 72,56,104
buffer_load_dwordx4 v19, s[28:31], s54 offen offset:1056 lds
MAV 88,56,108
TR 10,7,17472
s_add_u32 s54, s98, 196608
MAV 88,40,100
TR 12,7,16992
TR 14,7,17504
MAV 92,44,100
TR 24,7,25408
MAV 92,60,108
buffer_load_dwordx4 v[156:159], v4, s[16:19], s52 offen offset:1024 sc1
MAV 76,60,104
TR 26,7,25920
MAV 76,44,96
TR 28,7,25440
TR 30,7,25952
s_waitcnt vmcnt(16) lgkmcnt(8)
s_barrier
MAV 32,0,112
TR 32,6,16896
s_add_u32 m0, s55, 0
MAV 32,16,120
buffer_load_dwordx4 v18, s[28:31], s54 offen lds
MAV 48,16,124
TR 34,6,17408
MAV 48,0,116
TR 36,6,16928
TR 38,6,17440
MAV 52,4,116
TR 48,6,25344
s_add_u32 s52, s76, 491520
MAV 52,20,124
buffer_load_dwordx4 v[96:99], v4, s[16:19], s52 offen sc1
MAV 36,20,120
TR 50,6,25856
MAV 36,4,112
TR 52,6,25376
TR 54,6,25888
s_waitcnt lgkmcnt(8)
MAV 40,8,112
TR 40,6,16960
MAV 40,24,120
buffer_load_dwordx4 v19, s[28:31], s54 offen offset:1056 lds
MAV 56,24,124
TR 42,6,17472
s_add_u32 s54, s99, 655360
MAV 56,8,116
TR 44,6,16992
TR 46,6,17504
MAV 60,12,116
TR 56,6,25408
MAV 60,28,124
buffer_load_dwordx4 v[100:103], v4, s[16:19], s52 offen offset:1024 sc1
MAV 44,28,120
TR 58,6,25920
MAV 44,12,112
TR 60,6,25440
TR 62,6,25952
s_waitcnt lgkmcnt(8)
MAV 64,32,112
TR 0,7,33792
s_add_u32 m0, s55, 8448
MAV 64,48,120
buffer_load_dwordx4 v18, s[28:31], s54 offen lds
MAV 80,48,124
TR 2,7,34304
MAV 80,32,116
TR 4,7,33824
TR 6,7,34336
MAV 84,36,116
TR 16,7,42240
s_add_u32 s52, s76, 557056
MAV 84,52,124
buffer_load_dwordx4 v[104:107], v4, s[16:19], s52 offen sc1
MAV 68,52,120
TR 18,7,42752
MAV 68,36,112
TR 20,7,42272
TR 22,7,42784
s_waitcnt lgkmcnt(8)
MAV 72,40,112
TR 8,7,33856
MAV 72,56,120
buffer_load_dwordx4 v19, s[28:31], s54 offen offset:1056 lds
MAV 88,56,124
TR 10,7,34368
s_add_u32 s54, s100, 1114112
MAV 88,40,116
TR 12,7,33888
TR 14,7,34400
MAV 92,44,116
TR 24,7,42304
MAV 92,60,124
buffer_load_dwordx4 v[108:111], v4, s[16:19], s52 offen offset:1024 sc1
MAV 76,60,120
TR 26,7,42816
MAV 76,44,112
TR 28,7,42336
TR 30,7,42848
s_waitcnt vmcnt(16) lgkmcnt(8)
s_barrier
MAV 32,0,128
TR 32,6,33792
s_add_u32 m0, s55, 16896
MAV 32,16,136
buffer_load_dwordx4 v18, s[28:31], s54 offen lds
MAV 48,16,140
TR 34,6,34304
MAV 48,0,132
TR 36,6,33824
TR 38,6,34336
MAV 52,4,132
TR 48,6,42240
s_add_u32 s52, s77, 606208
MAV 52,20,140
buffer_load_dwordx4 v[112:115], v4, s[16:19], s52 offen sc1
MAV 36,20,136
TR 50,6,42752
MAV 36,4,128
TR 52,6,42272
TR 54,6,42784
s_waitcnt lgkmcnt(8)
MAV 40,8,128
TR 40,6,33856
MAV 40,24,136
buffer_load_dwordx4 v19, s[28:31], s54 offen offset:1056 lds
MAV 56,24,140
TR 42,6,34368
s_add_u32 s54, s101, 1572864
MAV 56,8,132
TR 44,6,33888
TR 46,6,34400
MAV 60,12,132
TR 56,6,42304
MAV 60,28,140
buffer_load_dwordx4 v[116:119], v4, s[16:19], s52 offen offset:1024 sc1
MAV 44,28,136
.Lpad39:
s_cbranch_execz .Lnopoll63r
TR 58,6,42816
MAV 44,12,128
TR 60,6,42336
TR 62,6,42848
s_waitcnt lgkmcnt(8)
MAV 64,32,128
TR 0,7,50688
s_add_u32 m0, s55, 25344
MAV 64,48,136
buffer_load_dwordx4 v18, s[28:31], s54 offen lds
MAV 80,48,140
TR 2,7,51200
MAV 80,32,132
TR 4,7,50720
TR 6,7,51232
MAV 84,36,132
TR 16,7,59136
s_add_u32 s52, s77, 671744
MAV 84,52,140
buffer_load_dwordx4 v[120:123], v4, s[16:19], s52 offen sc1
MAV 68,52,136
TR 18,7,59648
MAV 68,36,128
TR 20,7,59168
TR 22,7,59680
s_waitcnt lgkmcnt(8)
MAV 72,40,128
TR 8,7,50752
MAV 72,56,136
buffer_load_dwordx4 v19, s[28:31], s54 offen offset:1056 lds
MAV 88,56,140
TR 10,7,51264
s_add_u32 s54, s98, 2031616
MAV 88,40,132
TR 12,7,50784
TR 14,7,51296
MAV 92,44,132
TR 24,7,59200
MAV 92,60,140
buffer_load_dwordx4 v[124:127], v4, s[16:19], s52 offen offset:1024 sc1
MAV 76,60,136
TR 26,7,59712
MAV 76,44,128
TR 28,7,59232
TR 30,7,59744
s_waitcnt vmcnt(16) lgkmcnt(8)
s_barrier
MAV 32,0,144
TR 32,6,50688
s_add_u32 m0, s55, 33792
MAV 32,16,152
buffer_load_dwordx4 v18, s[28:31], s54 offen lds
MAV 48,16,156
TR 34,6,51200
MAV 48,0,148
TR 36,6,50720
TR 38,6,51232
MAV 52,4,148
TR 48,6,59136
s_add_u32 s52, s78, 720896
MAV 52,20,156
buffer_load_dwordx4 v[128:131], v4, s[16:19], s52 offen sc1
MAV 36,20,152
TR 50,6,59648
MAV 36,4,144
TR 52,6,59168
TR 54,6,59680
s_waitcnt lgkmcnt(8)
MAV 40,8,144
TR 40,6,50752
MAV 40,24,152
buffer_load_dwordx4 v19, s[28:31], s54 offen offset:1056 lds
MAV 56,24,156
TR 42,6,51264
s_add_u32 s54, s99, 2490368
MAV 56,8,148
TR 44,6,50784
TR 46,6,51296
MAV 60,12,148
TR 56,6,59200
MAV 60,28,156
buffer_load_dwordx4 v[132:135], v4, s[16:19], s52 offen offset:1024 sc1
MAV 44,28,152
TR 58,6,59712
MAV 44,12,144
TR 60,6,59232
TR 62,6,59744
v_add_u32 v7, s57, v7
v_add_u32 v6, s57, v6
s_sub_u32 s57, 0, s57
s_waitcnt lgkmcnt(8)
MAV 64,32,144
ds_read_b64_tr_b16 a[0:1], v6
s_add_u32 m0, s55, 42240
MAV 64,48,152
buffer_load_dwordx4 v18, s[28:31], s54 offen lds
MAV 80,48,156
TR 2,6,512
MAV 80,32,148
TR 4,6,32
TR 6,6,544
MAV 84,36,148
TR 16,6,8448
s_add_u32 s52, s78, 786432
MAV 84,52,156
buffer_load_dwordx4 v[136:139], v4, s[16:19], s52 offen sc1
MAV 68,52,152
TR 18,6,8960
MAV 68,36,144
TR 20,6,8480
TR 22,6,8992
s_waitcnt lgkmcnt(8)
MAV 72,40,144
TR 8,6,64
MAV 72,56,152
buffer_load_dwordx4 v19, s[28:31], s54 offen offset:1056 lds
MAV 88,56,156
TR 10,6,576
s_add_u32 s54, s100, 2949120
MAV 88,40,148
TR 12,6,96
TR 14,6,608
MAV 92,44,148
TR 24,6,8512
MAV 92,60,156
buffer_load_dwordx4 v[140:143], v4, s[16:19], s52 offen offset:1024 sc1
MAV 76,60,152
TR 26,6,9024
MAV 76,44,144
TR 28,6,8544
TR 30,6,9056
s_waitcnt vmcnt(16) lgkmcnt(8)
s_barrier
MAV 64,0,96
TR 32,6,16896
TR 34,6,17408
s_add_u32 m0, s55, 50688
MAV 64,16,104
TR 36,6,16928
buffer_load_dwordx4 v18, s[28:31], s54 offen lds
MAV 80,16,108
TR 38,6,17440
MAV 80,0,100
TR 48,6,25344
buffer_load_dwordx4 v19, s[28:31], s54 offen offset:1056 lds
MAV 84,4,100
TR 50,6,25856
s_add_u32 s54, s101, 3407872
s_add_u32 s52, s79, 835584
MAV 84,20,108
buffer_load_dwordx4 v[144:147], v4, s[16:19], s52 offen sc1
MAV 68,20,104
TR 52,6,25376
TR 54,6,25888
MAV 68,4,96
TR 40,6,16960
s_waitcnt lgkmcnt(9)
MAV 72,8,96
TR 42,6,17472
MAV 72,24,104
TR 44,6,16992
buffer_load_dwordx4 v[148:151], v4, s[16:19], s52 offen offset:1024 sc1
MAV 88,24,108
TR 46,6,17504
s_add_u32 m0, s55, 59136
MAV 88,8,100
TR 56,6,25408
buffer_load_dwordx4 v18, s[28:31], s54 offen lds
MAV 92,12,100
TR 58,6,25920
MAV 92,28,108
TR 60,6,25440
buffer_load_dwordx4 v19, s[28:31], s54 offen offset:1056 lds
MAV 76,28,104
TR 62,6,25952
s_add_u32 s52, s79, 901120
MAV 76,12,96
buffer_load_dwordx4 v[152:155], v4, s[16:19], s52 offen sc1
buffer_load_dwordx4 v[156:159], v4, s[16:19], s52 offen offset:1024 sc1
s_waitcnt vmcnt(16) lgkmcnt(8)
MAV 64,32,112
TR 0,6,33792
s_add_u32 s52, s76, 49152
s_lshl_b32 s70, s2, 10
s_lshl_b32 s62, s3, 7
MAV 64,48,120
buffer_load_dwordx4 v[160:163], v4, s[16:19], s52 offen sc1
s_add_u32 s70, s70, s62
MAV 80,48,124
TR 2,6,34304
s_add_u32 s70, s70, 31457280
MAV 80,32,116
TR 4,6,33824
TR 6,6,34336
s_xor_b32 s71, s70, 1024
MAV 84,36,116
TR 16,6,42240
v_min_u32 v26, 1, v1
MAV 84,52,124
buffer_load_dwordx4 v[164:167], v4, s[16:19], s52 offen offset:1024 sc1
v_lshlrev_b32 v26, 28, v26
MAV 68,52,120
TR 18,6,42752
v_mov_b32 v30, 1
MAV 68,36,112
TR 20,6,42272
TR 22,6,42784
v_mov_b32 v31, 0
s_waitcnt lgkmcnt(8)
MAV 72,40,112
TR 8,6,33856
s_add_u32 s52, s77, 163840
s_lshl_b32 s68, s7, 18
MAV 72,56,120
buffer_load_dwordx4 v[168:171], v4, s[16:19], s52 offen sc1
s_add_u32 s68, s68, 142606336
MAV 88,56,124
TR 10,6,34368
s_xor_b32 s69, s68, 262144
MAV 88,40,116
TR 12,6,33888
TR 14,6,34400
v_and_b32 v2, 1, v1
MAV 92,44,116
TR 24,6,42304
v_lshlrev_b32 v2, 4, v2
MAV 92,60,124
buffer_load_dwordx4 v[172:175], v4, s[16:19], s52 offen offset:1024 sc1
v_mov_b32 v224, 0x3f80
MAV 76,60,120
TR 26,6,42816
v_lshlrev_b32 v2, v2, v224
v_bfe_u32 v224, v1, 2, 2
MAV 76,44,112
TR 28,6,42336
TR 30,6,42848
s_waitcnt vmcnt(12) lgkmcnt(8)
MAV 64,0,128
TR 32,6,50688
s_add_u32 s52, s78, 278528
v_lshrrev_b32 v225, 4, v1
v_cmp_eq_u32 vcc, v224, v225
MAV 64,16,136
buffer_load_dwordx4 v[176:179], v4, s[16:19], s52 offen sc1
v_cndmask_b32 v2, 0, v2, vcc
MAV 80,16,140
TR 34,6,51200
v_and_b32 v224, 2, v1
MAV 80,0,132
TR 36,6,50720
TR 38,6,51232
v_cmp_eq_u32 vcc, 0, v224
MAV 84,4,132
TR 48,6,59136
v_cndmask_b32 v226, 0, v2, vcc
MAV 84,20,140
buffer_load_dwordx4 v[180:183], v4, s[16:19], s52 offen offset:1024 sc1
v_cndmask_b32 v227, v2, 0, vcc
MAV 68,20,136
TR 50,6,59648
v_mov_b32 v224, 0
MAV 68,4,128
TR 52,6,59168
TR 54,6,59680
v_mov_b32 v225, 0
s_waitcnt lgkmcnt(8)
MAV 72,8,128
TR 40,6,50752
s_add_u32 s52, s79, 393216
v_mov_b32 v228, 0
MAV 72,24,136
buffer_load_dwordx4 v[184:187], v4, s[16:19], s52 offen sc1
v_mov_b32 v229, 0
MAV 88,24,140
TR 42,6,51264
s_lshr_b32 s62, s6, 1
MAV 88,8,132
TR 44,6,50784
TR 46,6,51296
s_lshl_b32 s62, s62, 8
MAV 92,12,132
TR 56,6,59200
s_and_b32 s67, s6, 1
MAV 92,28,140
buffer_load_dwordx4 v[188:191], v4, s[16:19], s52 offen offset:1024 sc1
s_add_u32 s62, s62, s67
MAV 76,28,136
TR 58,6,59712
s_lshl_b32 s62, s62, 11
s_lshl_b32 s63, s3, 17
MAV 76,12,128
TR 60,6,59232
TR 62,6,59744
s_waitcnt vmcnt(8) lgkmcnt(8)
s_barrier
v_add_u32 v6, s57, v6
MAV 64,32,144
ds_read_b64_tr_b16 a[0:1], v6
s_add_u32 s52, s76, 507904
s_add_u32 s62, s62, s63
s_lshl_b32 s63, s7, 7
MAV 64,48,152
buffer_load_dwordx4 v[192:195], v4, s[16:19], s52 offen sc1
s_add_u32 s62, s62, s63
MAV 80,48,156
TR 2,6,512
s_mov_b32 s64, 0x8000
MAV 80,32,148
TR 4,6,32
TR 6,6,544
v_lshrrev_b32 v21, 3, v1
MAV 84,36,148
TR 16,6,8448
v_and_b32 v2, 7, v1
MAV 84,52,156
buffer_load_dwordx4 v[196:199], v4, s[16:19], s52 offen offset:1024 sc1
v_lshlrev_b32 v2, 4, v2
MAV 68,52,152
TR 18,6,8960
v_lshl_add_u32 v16, v21, 12, v2
MAV 68,36,144
TR 20,6,8480
TR 22,6,8992
v_add_u32 v16, s62, v16
s_waitcnt lgkmcnt(8)
MAV 72,40,144
TR 8,6,64
s_add_u32 s52, s77, 622592
v_add_u32 v17, 0x10000, v16
MAV 72,56,152
buffer_load_dwordx4 v[200:203], v4, s[16:19], s52 offen sc1
s_mul_i32 s62, s3, 4608
MAV 88,56,156
TR 10,6,576
s_add_u32 s62, s62, 135168
MAV 88,40,148
TR 12,6,96
TR 14,6,608
v_mul_u32_u24 v21, 144, v21
MAV 92,44,148
TR 24,6,8512
v_add3_u32 v21, v21, v2, s62
MAV 92,60,156
buffer_load_dwordx4 v[204:207], v4, s[16:19], s52 offen offset:1024 sc1
v_and_b32 v20, 15, v1
MAV 76,60,152
TR 26,6,9024
v_mul_u32_u24 v20, 144, v20
v_lshrrev_b32 v2, 4, v1
MAV 76,44,144
TR 28,6,8544
TR 30,6,9056
s_waitcnt vmcnt(8) lgkmcnt(8)
MAV 64,0,160
TR 32,6,16896
s_add_u32 s52, s78, 737280
v_lshlrev_b32 v2, 3, v2
v_add3_u32 v20, v20, v2, s62
MAV 64,16,168
buffer_load_dwordx4 v[208:211], v4, s[16:19], s52 offen sc1
v_accvgpr_read_b32 v28, a224
MAV 80,16,172
TR 34,6,17408
v_add_f32 v32, v32, v28
MAV 80,0,164
TR 36,6,16928
TR 38,6,17440
v_accvgpr_read_b32 v29, a225
MAV 84,4,164
TR 48,6,25344
v_add_f32 v33, v33, v29
MAV 84,20,172
buffer_load_dwordx4 v[212:215], v4, s[16:19], s52 offen offset:1024 sc1
v_accvgpr_read_b32 v28, a226
MAV 68,20,168
TR 50,6,25856
v_add_f32 v34, v34, v28
MAV 68,4,160
TR 52,6,25376
TR 54,6,25888
v_accvgpr_read_b32 v29, a227
s_waitcnt lgkmcnt(8)
MAV 72,8,160
TR 40,6,16960
s_add_u32 s52, s79, 851968
v_add_f32 v35, v35, v29
MAV 72,24,168
buffer_load_dwordx4 v[216:219], v4, s[16:19], s52 offen sc1
v_accvgpr_read_b32 v28, a228
MAV 88,24,172
TR 42,6,17472
v_add_f32 v36, v36, v28
MAV 88,8,164
TR 44,6,16992
TR 46,6,17504
v_accvgpr_read_b32 v29, a229
MAV 92,12,164
TR 56,6,25408
v_add_f32 v37, v37, v29
MAV 92,28,172
buffer_load_dwordx4 v[220:223], v4, s[16:19], s52 offen offset:1024 sc1
v_accvgpr_read_b32 v28, a230
MAV 76,28,168
TR 58,6,25920
v_add_f32 v38, v38, v28
v_accvgpr_read_b32 v29, a231
MAV 76,12,160
TR 60,6,25440
TR 62,6,25952
s_waitcnt vmcnt(8) lgkmcnt(8)
MAV 64,32,176
TR 0,6,33792
v_add_f32 v39, v39, v29
MAV 64,48,184
TR 2,6,34304
v_accvgpr_read_b32 v28, a232
v_add_f32 v40, v40, v28
MAV 80,48,188
TR 4,6,33824
MAV 80,32,180
TR 6,6,34336
v_accvgpr_read_b32 v29, a233
v_add_f32 v41, v41, v29
MAV 84,36,180
TR 16,6,42240
v_accvgpr_read_b32 v28, a234
MAV 84,52,188
TR 18,6,42752
v_add_f32 v42, v42, v28
MAV 68,52,184
TR 20,6,42272
v_accvgpr_read_b32 v29, a235
MAV 68,36,176
TR 22,6,42784
v_add_f32 v43, v43, v29
s_waitcnt lgkmcnt(8)
MAV 72,40,176
TR 8,6,33856
MAV 72,56,184
TR 10,6,34368
v_accvgpr_read_b32 v28, a236
v_add_f32 v44, v44, v28
MAV 88,56,188
TR 12,6,33888
v_accvgpr_read_b32 v29, a237
MAV 88,40,180
TR 14,6,34400
v_add_f32 v45, v45, v29
MAV 92,44,180
TR 24,6,42304
v_accvgpr_read_b32 v28, a238
MAV 92,60,188
TR 26,6,42816
v_add_f32 v46, v46, v28
MAV 76,60,184
TR 28,6,42336
v_accvgpr_read_b32 v29, a239
MAV 76,44,176
TR 30,6,42848
v_add_f32 v47, v47, v29
s_waitcnt vmcnt(4) lgkmcnt(8)
MAV 64,0,192
TR 32,6,50688
v_accvgpr_read_b32 v28, a240
MAV 64,16,200
TR 34,6,51200
v_add_f32 v48, v48, v28
v_accvgpr_read_b32 v29, a241
MAV 80,16,204
TR 36,6,50720
MAV 80,0,196
TR 38,6,51232
v_add_f32 v49, v49, v29
v_accvgpr_read_b32 v28, a242
MAV 84,4,196
TR 48,6,59136
v_add_f32 v50, v50, v28
MAV 84,20,204
TR 50,6,59648
v_accvgpr_read_b32 v29, a243
MAV 68,20,200
TR 52,6,59168
v_add_f32 v51, v51, v29
MAV 68,4,192
TR 54,6,59680
v_accvgpr_read_b32 v28, a244
s_waitcnt lgkmcnt(8)
MAV 72,8,192
TR 40,6,50752
MAV 72,24,200
TR 42,6,51264
v_add_f32 v52, v52, v28
v_accvgpr_read_b32 v29, a245
MAV 88,24,204
TR 44,6,50784
v_add_f32 v53, v53, v29
MAV 88,8,196
TR 46,6,51296
v_accvgpr_read_b32 v28, a246
MAV 92,12,196
TR 56,6,59200
v_add_f32 v54, v54, v28
MAV 92,28,204
TR 58,6,59712
v_accvgpr_read_b32 v29, a247
MAV 76,28,200
TR 60,6,59232
v_add_f32 v55, v55, v29
MAV 76,12,192
TR 62,6,59744
v_accvgpr_read_b32 v28, a248
s_waitcnt vmcnt(0) lgkmcnt(8)
MAV 64,32,208
ds_read_b64_tr_b16 a[0:1], v7
v_add_f32 v56, v56, v28
MAV 64,48,216
TR 2,7,512
v_accvgpr_read_b32 v29, a249
MAV 80,48,220
TR 4,7,32
v_add_f32 v57, v57, v29
MAV 80,32,212
TR 6,7,544
v_accvgpr_read_b32 v28, a250
MAV 84,36,212
TR 16,7,8448
v_add_f32 v58, v58, v28
MAV 84,52,220
TR 18,7,8960
v_accvgpr_read_b32 v29, a251
MAV 68,52,216
TR 20,7,8480
v_add_f32 v59, v59, v29
MAV 68,36,208
TR 22,7,8992
s_waitcnt lgkmcnt(8)
MAV 72,40,208
TR 8,7,64
v_accvgpr_read_b32 v28, a252
MAV 72,56,216
TR 10,7,576
v_add_f32 v60, v60, v28
MAV 88,56,220
TR 12,7,96
v_accvgpr_read_b32 v29, a253
MAV 88,40,212
TR 14,7,608
v_add_f32 v61, v61, v29
MAV 92,44,212
TR 24,7,8512
v_accvgpr_read_b32 v28, a254
MAV 92,60,220
TR 26,7,9024
v_add_f32 v62, v62, v28
MAV 76,60,216
TR 28,7,8544
v_accvgpr_read_b32 v29, a255
MAV 76,44,208
TR 30,7,9056
v_add_f32 v63, v63, v29
s_waitcnt lgkmcnt(8)
.Lpad40:
s_cbranch_execz .Lnopoll63r
MAV 32,0,96
TR 32,7,16896
v_cvt_pk_bf16_f32 v232, v64, v65
MAV 32,16,104
TR 34,7,17408
v_cvt_pk_bf16_f32 v233, v66, v67
v_cvt_pk_bf16_f32 v234, v68, v69
MAV 48,16,108
TR 36,7,16928
v_cvt_pk_bf16_f32 v235, v70, v71
MAV 48,0,100
TR 38,7,17440
buffer_store_dwordx4 v[232:235], v4, s[16:19], s69 offen sc1
s_add_u32 s69, s69, 131072
MAV 52,4,100
TR 48,7,25344
v_cvt_pk_bf16_f32 v236, v72, v73
MAV 52,20,108
TR 50,7,25856
v_cvt_pk_bf16_f32 v237, v74, v75
v_cvt_pk_bf16_f32 v238, v76, v77
MAV 36,20,104
TR 52,7,25376
v_cvt_pk_bf16_f32 v239, v78, v79
MAV 36,4,96
TR 54,7,25888
buffer_store_dwordx4 v[236:239], v4, s[16:19], s69 offen sc1
s_waitcnt lgkmcnt(8)
MAV 40,8,96
TR 40,7,16960
s_add_u32 s69, s69, -130048
MAV 40,24,104
TR 42,7,17472
v_cvt_pk_bf16_f32 v240, v80, v81
v_cvt_pk_bf16_f32 v241, v82, v83
MAV 56,24,108
TR 44,7,16992
v_cvt_pk_bf16_f32 v242, v84, v85
MAV 56,8,100
TR 46,7,17504
v_cvt_pk_bf16_f32 v243, v86, v87
buffer_store_dwordx4 v[240:243], v4, s[16:19], s69 offen sc1
MAV 60,12,100
TR 56,7,25408
s_add_u32 s69, s69, 131072
MAV 60,28,108
TR 58,7,25920
v_cvt_pk_bf16_f32 v244, v88, v89
v_cvt_pk_bf16_f32 v245, v90, v91
MAV 44,28,104
TR 60,7,25440
v_cvt_pk_bf16_f32 v246, v92, v93
MAV 44,12,96
TR 62,7,25952
v_cvt_pk_bf16_f32 v247, v94, v95
buffer_store_dwordx4 v[244:247], v4, s[16:19], s69 offen sc1
s_waitcnt lgkmcnt(8)
MAV 32,32,112
TR 0,7,33792
MAV 32,48,120
TR 2,7,34304
MAV 48,48,124
TR 4,7,33824
MAV 48,32,116
TR 6,7,34336
MAV 52,36,116
TR 16,7,42240
MAV 52,52,124
TR 18,7,42752
MAV 36,52,120
TR 20,7,42272
MAV 36,36,112
TR 22,7,42784
s_waitcnt lgkmcnt(8)
MAV 40,40,112
TR 8,7,33856
MAV 40,56,120
TR 10,7,34368
MAV 56,56,124
TR 12,7,33888
MAV 56,40,116
TR 14,7,34400
MAV 60,44,116
TR 24,7,42304
MAV 60,60,124
TR 26,7,42816
MAV 44,60,120
TR 28,7,42336
MAV 44,44,112
TR 30,7,42848
s_waitcnt lgkmcnt(8)
MAV 32,0,128
TR 32,7,50688
MAV 32,16,136
TR 34,7,51200
MAV 48,16,140
TR 36,7,50720
MAV 48,0,132
TR 38,7,51232
MAV 52,4,132
TR 48,7,59136
MAV 52,20,140
TR 50,7,59648
MAV 36,20,136
TR 52,7,59168
MAV 36,4,128
TR 54,7,59680
s_waitcnt lgkmcnt(8)
MAV 40,8,128
TR 40,7,50752
MAV 40,24,136
TR 42,7,51264
MAV 56,24,140
TR 44,7,50784
MAV 56,8,132
TR 46,7,51296
MAV 60,12,132
TR 56,7,59200
MAV 60,28,140
TR 58,7,59712
MAV 44,28,136
TR 60,7,59232
MAV 44,12,128
TR 62,7,59744
v_add_u32 v7, s57, v7
s_waitcnt lgkmcnt(8)
MAV 32,32,144
ds_read_b64_tr_b16 a[0:1], v7
MAV 32,48,152
s_waitcnt vmcnt(0)
buffer_atomic_add v30, v26, s[16:19], s71 offen
MAV 48,48,156
TR 2,7,512
MAV 48,32,148
TR 4,7,32
TR 6,7,544
MAV 52,36,148
MAV 52,52,156
TR 16,7,8448
TR 18,7,8960
MAV 36,52,152
TR 20,7,8480
MAV 36,36,144
s_waitcnt lgkmcnt(7)
MAV 40,40,144
TR 22,7,8992
MAV 40,56,152
TR 8,7,64
TR 10,7,576
MAV 56,56,156
MAV 56,40,148
TR 12,7,96
TR 14,7,608
MAV 60,44,148
TR 24,7,8512
MAV 60,60,156
TR 26,7,9024
MAV 44,60,152
TR 28,7,8544
MAV 44,44,144
TR 30,7,9056
s_waitcnt lgkmcnt(8)
MAV 32,0,160
TR 32,7,16896
MAV 32,16,168
buffer_atomic_add v31, v26, s[16:19], s70 offen sc0
MAV 48,16,172
TR 34,7,17408
MAV 48,0,164
TR 36,7,16928
TR 38,7,17440
MAV 52,4,164
MAV 52,20,172
TR 48,7,25344
TR 50,7,25856
MAV 36,20,168
TR 52,7,25376
MAV 36,4,160
s_waitcnt lgkmcnt(7)
MAV 40,8,160
TR 54,7,25888
MAV 40,24,168
TR 40,7,16960
TR 42,7,17472
MAV 56,24,172
MAV 56,8,164
TR 44,7,16992
TR 46,7,17504
MAV 60,12,164
TR 56,7,25408
MAV 60,28,172
TR 58,7,25920
MAV 44,28,168
TR 60,7,25440
MAV 44,12,160
TR 62,7,25952
s_waitcnt lgkmcnt(8)
MAV 32,32,176
TR 0,7,33792
MAV 32,48,184
TR 2,7,34304
MAV 48,48,188
TR 4,7,33824
MAV 48,32,180
TR 6,7,34336
MAV 52,36,180
TR 16,7,42240
MAV 52,52,188
TR 18,7,42752
MAV 36,52,184
TR 20,7,42272
MAV 36,36,176
TR 22,7,42784
s_waitcnt lgkmcnt(8)
MAV 40,40,176
TR 8,7,33856
MAV 40,56,184
TR 10,7,34368
MAV 56,56,188
TR 12,7,33888
MAV 56,40,180
TR 14,7,34400
MAV 60,44,180
TR 24,7,42304
MAV 60,60,188
TR 26,7,42816
MAV 44,60,184
TR 28,7,42336
MAV 44,44,176
TR 30,7,42848
s_waitcnt vmcnt(0)
v_cmp_le_u32 vcc, 2, v31
s_nop 0
s_cbranch_vccnz .Lxs68
s_mov_b32 s15, 0
.Lxs68l:
v_mov_b32 v31, 0
buffer_atomic_add v31, v26, s[16:19], s70 offen sc0
s_add_u32 s15, s15, 1
s_cmp_gt_u32 s15, 100000
s_waitcnt vmcnt(0)
s_cbranch_scc1 .Lxs68
v_cmp_le_u32 vcc, 2, v31
s_nop 0
s_cbranch_vccz .Lxs68l
.Lxs68:
s_waitcnt lgkmcnt(8)
MAV 32,0,192
TR 32,7,50688
MAV 32,16,200
buffer_load_dwordx4 v[232:235], v4, s[16:19], s68 offen sc1
MAV 48,16,204
TR 34,7,51200
s_add_u32 s68, s68, 131072
MAV 48,0,196
TR 36,7,50720
TR 38,7,51232
MAV 52,4,196
TR 48,7,59136
MAV 52,20,204
buffer_load_dwordx4 v[236:239], v4, s[16:19], s68 offen sc1
MAV 36,20,200
TR 50,7,59648
s_add_u32 s68, s68, -130048
MAV 36,4,192
TR 52,7,59168
TR 54,7,59680
s_waitcnt lgkmcnt(8)
MAV 40,8,192
TR 40,7,50752
MAV 40,24,200
buffer_load_dwordx4 v[240:243], v4, s[16:19], s68 offen sc1
MAV 56,24,204
TR 42,7,51264
s_add_u32 s68, s68, 131072
MAV 56,8,196
TR 44,7,50784
TR 46,7,51296
MAV 60,12,196
TR 56,7,59200
MAV 60,28,204
buffer_load_dwordx4 v[244:247], v4, s[16:19], s68 offen sc1
MAV 44,28,200
TR 58,7,59712
MAV 44,12,192
TR 60,7,59232
TR 62,7,59744
s_waitcnt lgkmcnt(8)
MAV 32,32,208
MAV 32,48,216
MAV 48,48,220
MAV 48,32,212
MAV 52,36,212
MAV 52,52,220
MAV 36,52,216
MAV 36,36,208
s_waitcnt lgkmcnt(0)
MAV 40,40,208
MAV 40,56,216
MAV 56,56,220
MAV 56,40,212
MAV 60,44,212
MAV 60,60,220
MAV 44,60,216
MAV 44,44,208
s_waitcnt vmcnt(3)
v_mfma_f32_16x16x32_bf16 v[32:35], v[226:229], v[232:235], v[32:35]
v_mfma_f32_16x16x32_bf16 v[36:39], v[224:227], v[232:235], v[36:39]
s_waitcnt vmcnt(2)
v_mfma_f32_16x16x32_bf16 v[40:43], v[226:229], v[236:239], v[40:43]
v_mfma_f32_16x16x32_bf16 v[44:47], v[224:227], v[236:239], v[44:47]
s_waitcnt vmcnt(1)
v_mfma_f32_16x16x32_bf16 v[48:51], v[226:229], v[240:243], v[48:51]
v_mfma_f32_16x16x32_bf16 v[52:55], v[224:227], v[240:243], v[52:55]
s_waitcnt vmcnt(0)
v_mfma_f32_16x16x32_bf16 v[56:59], v[226:229], v[244:247], v[56:59]
v_cvt_pk_bf16_f32 v128, v32, v33
v_mfma_f32_16x16x32_bf16 v[60:63], v[224:227], v[244:247], v[60:63]
v_cvt_pk_bf16_f32 v129, v34, v35
ds_write_b64 v20, v[128:129]
v_cvt_pk_bf16_f32 v130, v36, v37
v_cvt_pk_bf16_f32 v131, v38, v39
ds_write_b64 v20, v[130:131] offset:32
v_cvt_pk_bf16_f32 v132, v40, v41
v_cvt_pk_bf16_f32 v133, v42, v43
ds_write_b64 v20, v[132:133] offset:64
v_cvt_pk_bf16_f32 v134, v44, v45
v_cvt_pk_bf16_f32 v135, v46, v47
ds_write_b64 v20, v[134:135] offset:96
ds_read_b128 v[144:147], v21
ds_read_b128 v[148:151], v21 offset:1152
v_cvt_pk_bf16_f32 v136, v48, v49
v_cvt_pk_bf16_f32 v137, v50, v51
ds_write_b64 v20, v[136:137] offset:2304
v_cvt_pk_bf16_f32 v138, v52, v53
v_cvt_pk_bf16_f32 v139, v54, v55
ds_write_b64 v20, v[138:139] offset:2336
v_cvt_pk_bf16_f32 v140, v56, v57
v_cvt_pk_bf16_f32 v141, v58, v59
ds_write_b64 v20, v[140:141] offset:2368
v_cvt_pk_bf16_f32 v142, v60, v61
v_cvt_pk_bf16_f32 v143, v62, v63
ds_write_b64 v20, v[142:143] offset:2400
ds_read_b128 v[152:155], v21 offset:2304
ds_read_b128 v[156:159], v21 offset:3456
s_waitcnt lgkmcnt(7)
buffer_store_dwordx4 v[144:147], v16, s[36:39], 0 offen sc1
s_waitcnt lgkmcnt(6)
buffer_store_dwordx4 v[148:151], v16, s[36:39], s64 offen sc1
s_waitcnt lgkmcnt(1)
buffer_store_dwordx4 v[152:155], v17, s[36:39], 0 offen sc1
s_waitcnt lgkmcnt(0)
buffer_store_dwordx4 v[156:159], v17, s[36:39], s64 offen sc1
s_nop 1
.Lend:
s_endpgm
.Lsp67:
s_mov_b32 s15, 0
.Lsp67l:
v_mov_b32 v25, 0
buffer_atomic_add v25, v22, s[16:19], s73 offen sc0
s_add_u32 s15, s15, 1
s_cmp_gt_u32 s15, 100000
s_waitcnt vmcnt(0)
s_cbranch_scc1 .Lsp67b
v_cmp_gt_u32 vcc, v23, v25
s_nop 0
s_cbranch_vccnz .Lsp67l
s_branch .Lsp67b
.section .rodata,"a"
.p2align 6
.amdhsa_kernel interleave_layers__sliding_local_dilated__swiglu_ffn__prompt_kernel
  .amdhsa_next_free_vgpr 512
  .amdhsa_next_free_sgpr 102
  .amdhsa_accum_offset 256
  .amdhsa_group_segment_fixed_size 0
  .amdhsa_kernarg_size 80
  .amdhsa_user_sgpr_count 2
  .amdhsa_user_sgpr_kernarg_segment_ptr 1
  .amdhsa_system_sgpr_workgroup_id_x 1
  .amdhsa_float_denorm_mode_32 3
.end_amdhsa_kernel
```

```asm
; @launch grid=(256,1,1) block=(256,1,1) lds=162560
.amdgcn_target "amdgcn-amd-amdhsa--gfx950"
.macro MAA d,a,b
v_mfma_f32_16x16x32_bf16 v[\d:\d+3], a[\a:\a+3], a[\b:\b+3], v[\d:\d+3]
.endm
.macro MAV d,a,b
v_mfma_f32_16x16x32_bf16 v[\d:\d+3], a[\a:\a+3], v[\b:\b+3], v[\d:\d+3]
.endm
.macro TR d,v,o
ds_read_b64_tr_b16 a[\d:\d+1], v\v offset:\o
.endm
.macro RD d,v,o
ds_read_b128 a[\d:\d+3], v\v offset:\o
.endm
.text
.globl interleave_layers__sliding_local_dilated__swiglu_ffn__prompt_kernel
.p2align 8
.type interleave_layers__sliding_local_dilated__swiglu_ffn__prompt_kernel,@function
interleave_layers__sliding_local_dilated__swiglu_ffn__prompt_kernel:
s_load_dwordx4 s[68:71], s[0:1], 0
s_load_dwordx2 s[72:73], s[0:1], 16
s_load_dwordx8 s[76:83], s[0:1], 32
s_load_dwordx4 s[84:87], s[0:1], 64
s_cmp_ge_u32 s2, 256
s_cbranch_scc1 .Lout
v_lshrrev_b32 v2, 6, v0
v_and_b32 v1, 63, v0
v_readfirstlane_b32 s3, v2
s_and_b32 s4, s2, 7
s_lshr_b32 s5, s2, 3
s_getpc_b64 s[62:63]
.Lpc:
s_lshl_b32 s64, s5, 12
v_lshrrev_b32 v59, 3, v0
v_lshl_add_u32 v59, v59, 7, s64
v_add_u32 v2, 0x20000, v59
v_min_u32 v2, .Lend-.Lpc, v2
v_min_u32 v59, .Lend-.Lpc, v59
global_load_dword v59, v59, s[62:63]
global_load_dword v58, v2, s[62:63]
s_lshr_b32 s8, s4, 2
s_lshl_b32 s8, s8, 3
s_and_b32 s62, s5, 7
s_add_u32 s8, s8, s62
s_and_b32 s9, s4, 3
s_lshl_b32 s9, s9, 2
s_lshr_b32 s62, s5, 3
s_add_u32 s9, s9, s62
s_and_b32 s48, s3, 1
s_lshr_b32 s49, s3, 1
s_lshl_b32 s50, s8, 3
s_sub_u32 s50, s50, 9
s_cmp_lt_u32 s8, 2
s_cselect_b32 s50, 7, s50
s_lshr_b32 s6, s4, 1
s_lshl_b32 s6, s6, 2
s_and_b32 s62, s5, 3
s_add_u32 s6, s6, s62
s_and_b32 s7, s4, 1
s_lshr_b32 s62, s5, 2
s_lshl_b32 s62, s62, 1
s_add_u32 s7, s7, s62
s_lshr_b32 s62, s6, 1
s_lshl_b32 s62, s62, 8
s_and_b32 s63, s6, 1
s_add_u32 s62, s62, s63
s_lshl_b32 s63, s3, 6
s_add_u32 s62, s62, s63
s_lshl_b32 s62, s62, 11
s_lshl_b32 s63, s7, 7
s_add_u32 s62, s62, s63
v_and_b32 v228, 15, v1
v_lshlrev_b32 v228, 12, v228
v_bfe_u32 v2, v1, 4, 1
v_lshl_add_u32 v228, v2, 5, v228
v_bfe_u32 v2, v1, 5, 1
v_lshl_add_u32 v228, v2, 4, v228
v_add_u32 v228, s62, v228
v_add_u32 v229, 0x10000, v228
s_sub_u32 s64, s3, 1
s_max_i32 s64, s64, 0
s_lshl_b32 s64, s64, 11
s_lshl_b32 s66, s9, 7
s_add_u32 s66, s66, s64
s_cmp_eq_u32 s3, 1
s_cselect_b32 s66, 8388608, s66
s_mul_i32 s65, s8, 122880
s_add_u32 s65, s65, s66
v_lshrrev_b32 v9, 1, v1
v_min_u32 v9, 19, v9
v_mul_u32_u24 v9, 6144, v9
s_xor_b32 s14, s3, 3
s_lshl_b32 s14, s14, 8
s_add_u32 s14, s14, s2
v_lshlrev_b32 v230, 4, v1
v_mov_b64 v[224:225], 0
v_mov_b64 v[226:227], 0
s_waitcnt lgkmcnt(0)
s_mov_b32 s16, s86
s_mov_b32 s17, s87
s_mov_b32 s18, 268435456
s_mov_b32 s19, 0x20000
s_mov_b32 s36, s68
s_mov_b32 s37, s69
s_mov_b32 s38, 4194304
s_mov_b32 s39, 0x20000
s_cmp_ge_u32 s14, 16
s_cbranch_scc1 .Lz3
s_lshl_b32 s62, s2, 13
s_add_u32 s62, s62, 30408704
s_add_u32 s63, s62, 4096
buffer_store_dwordx4 v[224:227], v230, s[16:19], s62 offen sc1
buffer_store_dwordx4 v[224:227], v230, s[16:19], s62 offen offset:1024 sc1
buffer_store_dwordx4 v[224:227], v230, s[16:19], s62 offen offset:2048 sc1
buffer_store_dwordx4 v[224:227], v230, s[16:19], s62 offen offset:3072 sc1
buffer_store_dwordx4 v[224:227], v230, s[16:19], s63 offen sc1
buffer_store_dwordx4 v[224:227], v230, s[16:19], s63 offen offset:1024 sc1
buffer_store_dwordx4 v[224:227], v230, s[16:19], s63 offen offset:2048 sc1
buffer_store_dwordx4 v[224:227], v230, s[16:19], s63 offen offset:3072 sc1
.Lz3:
buffer_load_dwordx4 v[164:167], v228, s[36:39], 0 offen
buffer_load_dwordx4 v[168:171], v228, s[36:39], 0 offen offset:64
buffer_load_dwordx4 v[172:175], v229, s[36:39], 0 offen
buffer_load_dwordx4 v[176:179], v229, s[36:39], 0 offen offset:64
s_mov_b32 s20, s70
s_mov_b32 s21, s71
s_mov_b32 s22, 6291456
s_mov_b32 s23, 0x20000
buffer_load_dword v58, v9, s[20:23], s65 offen
s_mov_b32 s40, s84
s_mov_b32 s41, s85
s_mov_b32 s42, 256
s_mov_b32 s43, 0x20000
s_mov_b32 s24, s72
s_mov_b32 s25, s73
s_mov_b32 s26, 2097152
s_mov_b32 s27, 0x20000
s_mov_b32 s28, s80
s_mov_b32 s29, s81
s_mov_b32 s30, 7340032
s_mov_b32 s31, 0x20000
s_mov_b32 s0, s82
s_mov_b32 s1, s83
s_mov_b32 s32, s76
s_mov_b32 s33, s77
s_mov_b32 s34, 7340032
s_mov_b32 s35, 0x20000
s_mov_b32 s80, s78
s_mov_b32 s81, s79
s_mov_b32 s82, 7340032
s_mov_b32 s83, 0x20000
s_lshr_b32 s10, s4, 2
s_lshl_b32 s10, s10, 2
s_and_b32 s62, s5, 3
s_add_u32 s10, s10, s62
s_and_b32 s11, s4, 3
s_lshl_b32 s11, s11, 3
s_lshr_b32 s62, s5, 2
s_add_u32 s11, s11, s62
s_and_b32 s12, s11, 1
s_lshr_b32 s13, s11, 1
s_mul_i32 s51, s13, 448
s_mul_i32 s62, s12, 192
s_add_u32 s51, s51, s62
s_lshl_b32 s62, s6, 3
s_lshr_b32 s84, s62, 4
s_lshl_b32 s84, s84, 14
s_and_b32 s62, s62, 15
s_lshl_b32 s62, s62, 10
s_add_u32 s84, s84, s62
s_lshl_b32 s62, s8, 3
s_lshr_b32 s85, s62, 4
s_lshl_b32 s85, s85, 14
s_and_b32 s62, s62, 15
s_lshl_b32 s62, s62, 10
s_add_u32 s85, s85, s62
s_lshl_b32 s62, s50, 0
s_lshr_b32 s86, s62, 4
s_lshl_b32 s86, s86, 14
s_and_b32 s62, s62, 15
s_lshl_b32 s62, s62, 10
s_add_u32 s86, s86, s62
s_mul_i32 s62, s8, 393216
s_add_u32 s62, s62, s66
v_mul_u32_u24 v14, 6144, v1
v_add_u32 v14, s62, v14
s_lshl_b32 s62, s8, 4
s_add_u32 s62, s62, s9
s_lshl_b32 s62, s62, 2
s_add_u32 s62, s62, s3
s_mul_i32 s62, s62, 6656
v_min_u32 v15, 51, v1
v_lshl_add_u32 v15, v15, 7, s62
s_sub_u32 s63, s8, 4
s_lshl_b32 s64, s8, 1
s_add_u32 s64, s64, 1
s_cmp_lt_u32 s8, 5
s_cselect_b64 vcc, -1, 0
s_cselect_b32 s46, s64, s63
v_cndmask_b32 v14, v14, v15, vcc
s_lshl_b32 s62, s2, 1
s_add_u32 s62, s62, s48
s_mul_i32 s62, s62, 5376
v_min_u32 v16, 41, v1
v_lshl_add_u32 v16, v16, 7, s62
s_cmp_lt_u32 s46, 6
s_cselect_b64 vcc, -1, 0
v_cndmask_b32 v15, v14, v16, vcc
v_cndmask_b32 v14, v16, v14, vcc
s_cmp_lt_u32 s3, 2
s_cselect_b32 s65, s32, s80
s_cselect_b32 s66, s33, s81
s_cselect_b32 s67, s34, s82
s_cmp_lt_u32 s8, 5
s_cselect_b32 s62, s24, s20
s_cselect_b32 s63, s25, s21
s_cselect_b32 s64, s26, s22
s_sub_u32 s47, s46, 6
s_cmp_lt_u32 s46, 6
s_cselect_b32 s47, s46, s47
s_cselect_b32 s76, s62, s65
s_cselect_b32 s98, s65, s62
s_cselect_b32 s77, s63, s66
s_cselect_b32 s99, s66, s63
s_cselect_b32 s78, s64, s67
s_cselect_b32 s100, s67, s64
s_mov_b32 s79, 0x20000
v_bfe_u32 v18, v1, 3, 1
v_bfe_u32 v2, v1, 5, 1
v_lshl_add_u32 v18, v2, 2, v18
v_and_b32 v2, 16, v1
v_add_u32 v18, v18, v2
s_lshl_b32 s62, s49, 2
s_add_u32 s62, s62, s48
s_lshl_b32 s62, s62, 1
v_add_u32 v18, s62, v18
v_mul_u32_u24 v18, 6144, v18
v_and_b32 v2, 7, v1
v_lshl_add_u32 v18, v2, 4, v18
s_lshl_b32 s62, s9, 7
v_add_u32 v18, s62, v18
v_add_u32 v19, 1024, v18
v_add_u32 v20, 2048, v18
s_mul_i32 s59, s3, 3104
s_mov_b32 s58, 0
s_lshr_b32 s62, s8, 1
s_lshl_b32 s62, s62, 8
s_and_b32 s67, s8, 1
s_add_u32 s62, s62, s67
s_lshl_b32 s62, s62, 11
s_lshl_b32 s63, s3, 17
s_add_u32 s62, s62, s63
v_lshrrev_b32 v2, 4, v1
v_xor_b32 v2, v2, v1
v_and_b32 v2, 7, v2
v_lshlrev_b32 v2, 4, v2
v_lshrrev_b32 v21, 3, v1
v_lshl_add_u32 v21, v21, 12, v2
v_add_u32 v21, s62, v21
v_xor_b32 v28, 64, v21
v_add_u32 v28, 31744, v28
s_lshr_b32 s63, s50, 3
s_lshr_b32 s62, s63, 1
s_lshl_b32 s62, s62, 8
s_and_b32 s67, s63, 1
s_add_u32 s62, s62, s67
s_lshl_b32 s62, s62, 11
s_lshl_b32 s63, s3, 14
s_add_u32 s62, s62, s63
s_add_u32 s62, s62, 456704
s_lshl_b32 s63, s3, 5
v_and_b32 v2, 31, v1
v_lshlrev_b32 v2, 2, v2
v_xor_b32 v2, s63, v2
v_lshrrev_b32 v22, 5, v1
v_lshl_add_u32 v22, v22, 12, v2
v_add_u32 v22, s62, v22
v_xor_b32 v29, 16, v22
v_add_u32 v29, -57344, v29
s_mov_b32 s52, 0
s_mov_b32 s53, 65536
s_mul_i32 s55, s3, 4608
s_mov_b32 s54, 0
s_mul_i32 s56, s3, 3104
v_bfe_u32 v24, v1, 1, 3
v_lshrrev_b32 v2, 4, v1
v_xor_b32 v2, v2, v24
v_lshlrev_b32 v2, 4, v2
v_and_b32 v23, 15, v1
v_lshl_add_u32 v23, v23, 7, v2
s_mul_i32 s62, s48, 9216
v_add_u32 v23, s62, v23
v_xor_b32 v30, 64, v23
v_mul_u32_u24 v24, 2304, v24
v_add_u32 v24, v24, v2
v_and_b32 v2, 1, v1
v_lshl_add_u32 v24, v2, 7, v24
v_add_u32 v24, 2048, v24
v_xor_b32 v31, 64, v24
v_and_b32 v2, 15, v1
v_cmp_eq_u32 vcc, 0, v2
v_mov_b32 v2, 18432
s_nop 0
v_cndmask_b32 v24, v24, v2, vcc
v_cndmask_b32 v31, v31, v2, vcc
v_bfe_u32 v25, v1, 3, 2
v_mul_u32_u24 v25, 3104, v25
v_bfe_u32 v2, v1, 2, 1
v_lshl_add_u32 v25, v2, 7, v25
v_bfe_u32 v2, v1, 5, 1
v_lshl_add_u32 v25, v2, 8, v25
v_and_b32 v2, 3, v1
v_lshl_add_u32 v25, v2, 3, v25
s_lshl_b32 s62, s49, 6
s_add_u32 s62, s62, 73984
v_add_u32 v25, s62, v25
s_lshl_b32 s62, s8, 1
s_add_u32 s62, s62, s3
s_lshr_b32 s63, s50, 2
s_cmp_lt_u32 s3, 2
s_cselect_b32 s62, s62, s63
s_lshl_b32 s62, s62, 13
s_cmp_eq_u32 s3, 3
s_cselect_b32 s62, 268435456, s62
v_lshl_add_u32 v26, v1, 4, s62
s_mul_i32 s59, s3, 2080
s_and_b32 s87, s6, 3
s_lshl_b32 s87, s87, 17
v_bfe_u32 v5, v1, 3, 1
v_lshrrev_b32 v2, 4, v1
v_lshl_add_u32 v5, v2, 3, v5
s_lshl_b32 s62, s3, 1
v_add_u32 v5, s62, v5
v_mul_u32_u24 v5, 2048, v5
v_and_b32 v2, 7, v1
v_lshl_add_u32 v5, v2, 4, v5
s_lshl_b32 s62, s7, 7
v_add_u32 v5, s62, v5
v_add_u32 v6, 64512, v5
s_lshl_b32 s62, s6, 10
s_add_u32 s62, s62, 30408704
s_lshl_b32 s64, s8, 10
s_add_u32 s64, s64, 30408704
s_lshr_b32 s67, s9, 1
s_and_b32 s67, s67, 3
s_lshl_b32 s67, s67, 7
s_add_u32 s64, s64, s67
s_lshr_b32 s65, s50, 3
s_lshl_b32 s65, s65, 10
s_add_u32 s65, s65, 30408704
s_lshr_b32 s67, s9, 1
s_and_b32 s67, s67, 3
s_lshl_b32 s67, s67, 7
s_add_u32 s65, s65, s67
v_mov_b32 v2, 268435456
v_cmp_eq_u32 vcc, 65, v0
v_mov_b32 v33, s65
s_nop 0
v_cndmask_b32 v33, v2, v33, vcc
v_cndmask_b32 v36, 0, 16, vcc
v_cmp_eq_u32 vcc, 64, v0
v_mov_b32 v32, s64
s_nop 0
v_cndmask_b32 v33, v33, v32, vcc
v_lshl_add_u32 v32, v1, 7, s62
v_cndmask_b32 v34, v2, 0, vcc
v_cndmask_b32 v35, 0, 16, vcc
v_cndmask_b32 v36, v36, 16, vcc
v_lshrrev_b32 v37, 3, v0
v_cmp_eq_u32 vcc, 8, v37
s_nop 1
v_cndmask_b32 v32, v2, v32, vcc
v_mov_b32 v38, 1
v_lshrrev_b32 v2, 4, v1
v_lshlrev_b32 v2, 2, v2
v_and_b32 v13, 15, v1
v_sub_u32 v2, v13, v2
v_mov_b32 v13, 0xff61b1e6
v_subrev_u32 v54, 0, v2
v_cmp_gt_u32 vcc, 8, v54
s_nop 1
v_cndmask_b32 v50, v13, 0, vcc
v_cmp_gt_i32 vcc, -8, v54
s_nop 1
v_cndmask_b32 v46, v13, 0, vcc
v_subrev_u32 v54, 1, v2
v_cmp_gt_u32 vcc, 8, v54
s_nop 1
v_cndmask_b32 v51, v13, 0, vcc
v_cmp_gt_i32 vcc, -8, v54
s_nop 1
v_cndmask_b32 v47, v13, 0, vcc
v_subrev_u32 v54, 2, v2
v_cmp_gt_u32 vcc, 8, v54
s_nop 1
v_cndmask_b32 v52, v13, 0, vcc
v_cmp_gt_i32 vcc, -8, v54
s_nop 1
v_cndmask_b32 v48, v13, 0, vcc
v_subrev_u32 v54, 3, v2
v_cmp_gt_u32 vcc, 8, v54
s_nop 1
v_cndmask_b32 v53, v13, 0, vcc
v_cmp_gt_i32 vcc, -8, v54
s_nop 1
v_cndmask_b32 v49, v13, 0, vcc
s_cmp_lt_u32 s8, 2
s_cselect_b64 vcc, -1, 0
v_cndmask_b32 v54, v46, v13, vcc
v_cndmask_b32 v55, v47, v13, vcc
v_cndmask_b32 v56, v48, v13, vcc
v_cndmask_b32 v57, v49, v13, vcc
s_mov_b32 s75, 29360128
v_and_b32 v10, 15, v1
v_lshlrev_b32 v12, 2, v10
v_lshlrev_b32 v10, 4, v10
v_add_u32 v10, 152576, v10
v_lshrrev_b32 v11, 4, v1
v_lshlrev_b32 v11, 4, v11
s_lshl_b32 s62, s49, 7
s_add_u32 s62, s62, 158720
v_add_u32 v12, s62, v12
v_add_u32 v13, s62, v11
v_add_u32 v11, 156672, v11
s_lshl_b32 s62, s3, 11
s_add_u32 s62, s62, 143360
v_lshl_add_u32 v8, v1, 4, s62
v_xor_b32 v9, 2048, v8
v_mov_b32 v248, 0x3f803f80
v_mov_b32 v249, 0x3f803f80
v_mov_b32 v250, 0x3f803f80
v_mov_b32 v251, 0x3f803f80
s_mul_i32 s62, s3, 18496
s_add_u32 s62, s62, 18432
v_mov_b32 v2, s62
ds_write_b128 v2, v[248:251]
v_and_b32 v7, 31, v1
v_lshrrev_b32 v2, 5, v1
v_lshl_add_u32 v7, v7, 1, v2
v_and_b32 v2, 0xc0, v0
v_add_u32 v7, v7, v2
v_lshlrev_b32 v17, 2, v7
v_add_u32 v17, 156672, v17
v_lshlrev_b32 v7, 4, v7
v_add_u32 v7, 152576, v7
s_lshl_b32 s74, s9, 1
s_add_u32 s74, s74, s49
s_lshl_b32 s74, s74, 17
s_add_u32 s74, s74, s85
s_lshl_b32 s63, s48, 12
s_add_u32 s74, s74, s63
s_add_u32 s74, s74, 4194304
s_mov_b32 s62, 0
v_lshl_add_u32 v4, v1, 4, s62
v_lshrrev_b32 v2, 3, v1
v_cmp_eq_u32 vcc, 3, v2
v_add_u32 v2, 67108480, v4
s_nop 0
v_cndmask_b32 v4, v4, v2, vcc
s_add_u32 m0, s55, 0
s_nop 0
buffer_load_dwordx4 v21, s[36:39], s52 offen lds
buffer_load_dwordx4 v28, s[36:39], s52 offen offset:1024 lds
buffer_load_dword v22, s[36:39], s52 offen offset:2048 lds
s_add_u32 s52, s52, 128
s_add_u32 m0, s55, 2304
s_nop 0
buffer_load_dwordx4 v21, s[36:39], s53 offen lds
buffer_load_dwordx4 v28, s[36:39], s53 offen offset:1024 lds
buffer_load_dword v29, s[36:39], s53 offen offset:2048 lds
s_add_u32 s53, s53, 128
s_add_u32 m0, s56, 123648
s_nop 0
buffer_load_dwordx4 v18, s[20:23], s54 offen lds
buffer_load_dwordx4 v19, s[20:23], s54 offen offset:1024 lds
buffer_load_dwordx4 v20, s[20:23], s54 offen offset:2048 lds
s_add_u32 s54, s54, 196608
s_add_u32 m0, s56, 136064
s_nop 0
buffer_load_dwordx4 v18, s[20:23], s54 offen lds
buffer_load_dwordx4 v19, s[20:23], s54 offen offset:1024 lds
buffer_load_dwordx4 v20, s[20:23], s54 offen offset:2048 lds
s_add_u32 s54, s54, 196608
s_mov_b64 exec, 0
s_cmp_eq_u32 s3, 2
s_cbranch_scc1 .Lpad1
s_cmp_eq_u32 s3, 3
s_cbranch_scc1 .Lpad2
s_cmp_eq_u32 s3, 1
s_cbranch_scc1 .Lpad4
s_branch .Lpad3
.Lout:
s_endpgm
.p2align 12
.Lt0r:
s_mov_b64 exec, -1
s_cmp_eq_u32 s48, 1
s_cbranch_scc1 .Lqkv1
s_cmp_lt_u32 s14, 16
s_cselect_b32 s62, 0, 4096
v_mov_b32 v231, 1
v_lshlrev_b32 v232, 8, v1
s_waitcnt vmcnt(16)
v_permlane16_swap_b32 v164, v166
v_permlane16_swap_b32 v165, v167
s_waitcnt vmcnt(15)
v_permlane16_swap_b32 v168, v170
v_permlane16_swap_b32 v169, v171
s_waitcnt vmcnt(14)
v_permlane16_swap_b32 v172, v174
v_permlane16_swap_b32 v173, v175
s_waitcnt vmcnt(13)
v_permlane16_swap_b32 v176, v178
v_permlane16_swap_b32 v177, v179
buffer_atomic_add v231, v232, s[40:43], s62 offen
s_add_u32 m0, s55, 18496
s_nop 0
buffer_load_dwordx4 v21, s[36:39], s52 offen lds
v_lshlrev_b32 v192, 16, v164
v_and_b32 v193, 0xffff0000, v164
v_lshlrev_b32 v194, 16, v165
v_and_b32 v195, 0xffff0000, v165
v_lshlrev_b32 v196, 16, v166
v_and_b32 v197, 0xffff0000, v166
v_lshlrev_b32 v198, 16, v167
buffer_load_dwordx4 v28, s[36:39], s52 offen offset:1024 lds
v_and_b32 v199, 0xffff0000, v167
v_lshlrev_b32 v200, 16, v168
v_and_b32 v201, 0xffff0000, v168
v_lshlrev_b32 v202, 16, v169
v_and_b32 v203, 0xffff0000, v169
v_lshlrev_b32 v204, 16, v170
v_and_b32 v205, 0xffff0000, v170
buffer_load_dword v22, s[36:39], s52 offen offset:2048 lds
s_add_u32 s52, s52, 128
v_lshlrev_b32 v206, 16, v171
v_and_b32 v207, 0xffff0000, v171
v_lshlrev_b32 v208, 16, v172
v_and_b32 v209, 0xffff0000, v172
v_lshlrev_b32 v210, 16, v173
v_and_b32 v211, 0xffff0000, v173
v_lshlrev_b32 v212, 16, v174
s_add_u32 m0, s55, 20800
s_nop 0
buffer_load_dwordx4 v21, s[36:39], s53 offen lds
v_and_b32 v213, 0xffff0000, v174
v_lshlrev_b32 v214, 16, v175
v_and_b32 v215, 0xffff0000, v175
v_lshlrev_b32 v216, 16, v176
v_and_b32 v217, 0xffff0000, v176
v_lshlrev_b32 v218, 16, v177
v_and_b32 v219, 0xffff0000, v177
buffer_load_dwordx4 v28, s[36:39], s53 offen offset:1024 lds
v_lshlrev_b32 v220, 16, v178
v_and_b32 v221, 0xffff0000, v178
v_lshlrev_b32 v222, 16, v179
v_and_b32 v223, 0xffff0000, v179
s_lshl_b32 s64, s6, 14
s_lshl_b32 s65, s49, 13
s_add_u32 s64, s64, s65
buffer_load_dword v29, s[36:39], s53 offen offset:2048 lds
s_add_u32 s53, s53, 128
s_lshl_b32 s65, s7, 9
s_add_u32 s64, s64, s65
s_lshl_b32 s65, s48, 8
s_add_u32 s64, s64, s65
s_add_u32 s64, s64, 29360128
v_and_b32 v188, 31, v1
v_lshlrev_b32 v188, 3, v188
s_add_u32 m0, s56, 73984
s_nop 0
buffer_load_dwordx4 v18, s[20:23], s54 offen lds
v_lshrrev_b32 v189, 5, v1
v_lshl_add_u32 v188, v189, 28, v188
s_lshl_b32 s62, s7, 18
s_add_u32 s62, s62, 0
s_add_u32 s63, s62, 131072
v_pk_mul_f32 v[182:183], v[192:193], v[192:193]
v_pk_mul_f32 v[186:187], v[208:209], v[208:209]
buffer_load_dwordx4 v19, s[20:23], s54 offen offset:1024 lds
v_pk_fma_f32 v[182:183], v[194:195], v[194:195], v[182:183]
v_pk_add_f32 v[180:181], v[192:193], v[194:195]
v_pk_fma_f32 v[186:187], v[210:211], v[210:211], v[186:187]
v_pk_add_f32 v[184:185], v[208:209], v[210:211]
v_pk_fma_f32 v[182:183], v[196:197], v[196:197], v[182:183]
v_pk_add_f32 v[180:181], v[180:181], v[196:197]
v_pk_fma_f32 v[186:187], v[212:213], v[212:213], v[186:187]
buffer_load_dwordx4 v20, s[20:23], s54 offen offset:2048 lds
s_add_u32 s54, s54, 196608
v_pk_add_f32 v[184:185], v[184:185], v[212:213]
v_pk_fma_f32 v[182:183], v[198:199], v[198:199], v[182:183]
v_pk_add_f32 v[180:181], v[180:181], v[198:199]
v_pk_fma_f32 v[186:187], v[214:215], v[214:215], v[186:187]
v_pk_add_f32 v[184:185], v[184:185], v[214:215]
v_pk_fma_f32 v[182:183], v[200:201], v[200:201], v[182:183]
v_pk_add_f32 v[180:181], v[180:181], v[200:201]
s_add_u32 m0, s56, 86400
s_nop 0
buffer_load_dwordx4 v18, s[20:23], s54 offen lds
v_pk_fma_f32 v[186:187], v[216:217], v[216:217], v[186:187]
v_pk_add_f32 v[184:185], v[184:185], v[216:217]
v_pk_fma_f32 v[182:183], v[202:203], v[202:203], v[182:183]
v_pk_add_f32 v[180:181], v[180:181], v[202:203]
v_pk_fma_f32 v[186:187], v[218:219], v[218:219], v[186:187]
v_pk_add_f32 v[184:185], v[184:185], v[218:219]
v_pk_fma_f32 v[182:183], v[204:205], v[204:205], v[182:183]
buffer_load_dwordx4 v19, s[20:23], s54 offen offset:1024 lds
v_pk_add_f32 v[180:181], v[180:181], v[204:205]
v_pk_fma_f32 v[186:187], v[220:221], v[220:221], v[186:187]
v_pk_add_f32 v[184:185], v[184:185], v[220:221]
v_pk_fma_f32 v[182:183], v[206:207], v[206:207], v[182:183]
v_pk_add_f32 v[180:181], v[180:181], v[206:207]
v_pk_fma_f32 v[186:187], v[222:223], v[222:223], v[186:187]
v_pk_add_f32 v[184:185], v[184:185], v[222:223]
buffer_load_dwordx4 v20, s[20:23], s54 offen offset:2048 lds
s_add_u32 s54, s54, 196608
v_add_f32 v180, v180, v181
v_add_f32 v182, v182, v183
v_add_f32 v184, v184, v185
v_add_f32 v186, v186, v187
s_nop 0
v_permlane16_swap_b32 v180, v184
v_permlane16_swap_b32 v182, v186
v_add_f32 v180, v180, v184
v_add_f32 v182, v182, v186
s_nop 1
v_permlane32_swap_b32 v180, v182
v_add_f32 v180, v180, v182
s_nop 1
v_permlane32_swap_b32 v180, v181
buffer_store_dwordx2 v[180:181], v188, s[16:19], s64 offen sc1
s_lshl_b32 s62, s2, 10
s_add_u32 s62, s62, 31457280
s_cmp_eq_u32 s3, 0
s_cselect_b32 s62, s62, 268435456
buffer_store_dwordx4 v[224:227], v230, s[16:19], s62 offen sc1
s_waitcnt vmcnt(15) lgkmcnt(0)
s_barrier
ds_read_b128 a[0:3], v23
RD 4,23,2304
RD 8,23,4608
RD 12,23,6912
ds_read_b128 a[16:19], v24
ds_read_b128 a[20:23], v30
RD 24,30,2304
RD 28,30,4608
RD 32,30,6912
ds_read_b128 a[36:39], v31
TR 80,25,49664
TR 82,25,50176
TR 84,25,62080
TR 86,25,62592
TR 88,25,50688
TR 90,25,51200
TR 92,25,63104
TR 94,25,63616
TR 96,25,51712
TR 98,25,52224
TR 100,25,64128
TR 102,25,64640
s_waitcnt vmcnt(8) lgkmcnt(0)
s_barrier
v_mfma_f32_16x16x32_bf16 v[60:63], a[80:83], a[0:3], 0
TR 104,25,49696
s_add_u32 m0, s55, 36992
MAA 60,84,20
buffer_load_dwordx4 v21, s[36:39], s52 offen lds
v_mfma_f32_16x16x32_bf16 v[64:67], a[80:83], a[4:7], 0
s_sub_u32 s47, s47, 1
s_cbranch_scc1 .Lx4
.Lx4b:
MAA 64,84,24
buffer_load_dwordx4 v28, s[36:39], s52 offen offset:1024 lds
v_mfma_f32_16x16x32_bf16 v[68:71], a[80:83], a[8:11], 0
TR 106,25,50208
MAA 68,84,28
TR 108,25,62112
TR 110,25,62624
v_mfma_f32_16x16x32_bf16 v[72:75], a[80:83], a[12:15], 0
TR 112,25,50720
MAA 72,84,32
TR 114,25,51232
v_mfma_f32_16x16x32_bf16 v[244:247], a[80:83], a[16:19], 0
TR 116,25,63136
MAA 244,84,36
buffer_load_dword v22, s[36:39], s52 offen offset:2048 lds
v_mfma_f32_16x16x32_bf16 v[156:159], a[88:91], a[16:19], 0
s_add_u32 s52, s52, 128
s_add_u32 m0, s55, 39296
MAA 156,92,36
buffer_load_dwordx4 v21, s[36:39], s53 offen lds
v_mfma_f32_16x16x32_bf16 v[104:107], a[88:91], a[12:15], 0
TR 118,25,63648
MAA 104,92,32
buffer_load_dwordx4 v28, s[36:39], s53 offen offset:1024 lds
v_mfma_f32_16x16x32_bf16 v[100:103], a[88:91], a[8:11], 0
TR 120,25,51744
MAA 100,92,28
buffer_load_dword v29, s[36:39], s53 offen offset:2048 lds
v_mfma_f32_16x16x32_bf16 v[96:99], a[88:91], a[4:7], 0
s_add_u32 s53, s53, 128
MAA 96,92,24
TR 122,25,52256
TR 124,25,64160
v_mfma_f32_16x16x32_bf16 v[92:95], a[88:91], a[0:3], 0
TR 126,25,64672
s_add_u32 m0, s56, 98816
MAA 92,92,20
buffer_load_dwordx4 v18, s[20:23], s54 offen lds
v_mfma_f32_16x16x32_bf16 v[124:127], a[0:3], a[96:99], 0
RD 40,23,18496
MAA 124,20,100
buffer_load_dwordx4 v19, s[20:23], s54 offen offset:1024 lds
v_mfma_f32_16x16x32_bf16 v[128:131], a[4:7], a[96:99], 0
RD 44,23,20800
MAA 128,24,100
RD 48,23,23104
RD 52,23,25408
v_mfma_f32_16x16x32_bf16 v[132:135], a[8:11], a[96:99], 0
RD 56,24,18496
MAA 132,28,100
buffer_load_dwordx4 v20, s[20:23], s54 offen offset:2048 lds
v_mfma_f32_16x16x32_bf16 v[136:139], a[12:15], a[96:99], 0
s_add_u32 s54, s54, 196608
MAA 136,32,100
s_waitcnt vmcnt(11) lgkmcnt(5)
s_barrier
v_mfma_f32_16x16x32_bf16 v[76:79], a[104:107], a[0:3], 0
RD 60,30,18496
s_add_u32 m0, s56, 111232
MAA 76,108,20
buffer_load_dwordx4 v18, s[20:23], s54 offen lds
v_mfma_f32_16x16x32_bf16 v[80:83], a[104:107], a[4:7], 0
RD 64,30,20800
MAA 80,108,24
buffer_load_dwordx4 v19, s[20:23], s54 offen offset:1024 lds
v_mfma_f32_16x16x32_bf16 v[84:87], a[104:107], a[8:11], 0
RD 68,30,23104
MAA 84,108,28
RD 72,30,25408
RD 76,31,18496
v_mfma_f32_16x16x32_bf16 v[88:91], a[104:107], a[12:15], 0
ds_read_b64_tr_b16 a[80:81], v25
MAA 88,108,32
buffer_load_dwordx4 v20, s[20:23], s54 offen offset:2048 lds
v_mfma_f32_16x16x32_bf16 v[160:163], a[112:115], a[16:19], 0
s_add_u32 s54, s54, 196608
s_add_u32 m0, s55, 55488
MAA 160,116,36
buffer_load_dwordx4 v21, s[36:39], s52 offen lds
v_mfma_f32_16x16x32_bf16 v[120:123], a[112:115], a[12:15], 0
TR 82,25,512
MAA 120,116,32
buffer_load_dwordx4 v28, s[36:39], s52 offen offset:1024 lds
v_mfma_f32_16x16x32_bf16 v[116:119], a[112:115], a[8:11], 0
TR 84,25,12416
MAA 116,116,28
TR 86,25,12928
TR 88,25,1024
v_mfma_f32_16x16x32_bf16 v[112:115], a[112:115], a[4:7], 0
TR 90,25,1536
MAA 112,116,24
buffer_load_dword v22, s[36:39], s52 offen offset:2048 lds
v_mfma_f32_16x16x32_bf16 v[108:111], a[112:115], a[0:3], 0
s_add_u32 s52, s52, 128
s_add_u32 m0, s55, 57792
MAA 108,116,20
buffer_load_dwordx4 v21, s[36:39], s53 offen lds
v_mfma_f32_16x16x32_bf16 v[140:143], a[0:3], a[120:123], 0
TR 92,25,13440
MAA 140,20,124
buffer_load_dwordx4 v28, s[36:39], s53 offen offset:1024 lds
v_mfma_f32_16x16x32_bf16 v[144:147], a[4:7], a[120:123], 0
TR 94,25,13952
MAA 144,24,124
TR 96,25,2048
TR 98,25,2560
v_mfma_f32_16x16x32_bf16 v[148:151], a[8:11], a[120:123], 0
TR 100,25,14464
MAA 148,28,124
buffer_load_dword v29, s[36:39], s53 offen offset:2048 lds
v_mfma_f32_16x16x32_bf16 v[152:155], a[12:15], a[120:123], 0
TR 102,25,14976
s_add_u32 s53, s53, 128
MAA 152,32,124
s_waitcnt vmcnt(12) lgkmcnt(8)
s_barrier
MAA 60,80,40
TR 104,25,32
s_add_u32 m0, s56, 123648
MAA 60,84,60
buffer_load_dwordx4 v18, s[20:23], s54 offen lds
MAA 64,84,64
s_sub_u32 s47, s47, 1
s_cbranch_scc1 .Lx5
.Lx5b:
MAA 64,80,44
buffer_load_dwordx4 v19, s[20:23], s54 offen offset:1024 lds
MAA 68,80,48
TR 106,25,544
MAA 68,84,68
TR 108,25,12448
TR 110,25,12960
MAA 72,84,72
TR 112,25,1056
MAA 72,80,52
TR 114,25,1568
s_waitcnt lgkmcnt(6)
MAA 244,80,56
TR 116,25,13472
MAA 244,84,76
buffer_load_dwordx4 v20, s[20:23], s54 offen offset:2048 lds
MAA 156,92,76
s_add_u32 s54, s54, 196608
s_add_u32 m0, s56, 136064
MAA 156,88,56
buffer_load_dwordx4 v18, s[20:23], s54 offen lds
MAA 104,88,52
TR 118,25,13984
MAA 104,92,72
buffer_load_dwordx4 v19, s[20:23], s54 offen offset:1024 lds
MAA 100,92,68
TR 120,25,2080
MAA 100,88,48
buffer_load_dwordx4 v20, s[20:23], s54 offen offset:2048 lds
MAA 96,88,44
s_add_u32 s54, s54, 196608
MAA 96,92,64
TR 122,25,2592
TR 124,25,14496
MAA 92,92,60
TR 126,25,15008
s_add_u32 m0, s55, 0
MAA 92,88,40
buffer_load_dwordx4 v21, s[36:39], s52 offen lds
MAA 124,40,96
RD 0,23,36992
MAA 124,60,100
buffer_load_dwordx4 v28, s[36:39], s52 offen offset:1024 lds
MAA 128,64,100
RD 4,23,39296
MAA 128,44,96
RD 8,23,41600
RD 12,23,43904
MAA 132,48,96
RD 16,24,36992
MAA 132,68,100
buffer_load_dword v22, s[36:39], s52 offen offset:2048 lds
MAA 136,72,100
s_add_u32 s52, s52, 128
MAA 136,52,96
s_waitcnt vmcnt(15) lgkmcnt(5)
s_barrier
MAA 76,104,40
RD 20,30,36992
s_add_u32 m0, s55, 2304
MAA 76,108,60
buffer_load_dwordx4 v21, s[36:39], s53 offen lds
MAA 80,108,64
RD 24,30,39296
MAA 80,104,44
buffer_load_dwordx4 v28, s[36:39], s53 offen offset:1024 lds
MAA 84,104,48
RD 28,30,41600
MAA 84,108,68
buffer_load_dword v29, s[36:39], s53 offen offset:2048 lds
MAA 88,108,72
RD 32,30,43904
s_add_u32 s53, s53, 128
MAA 88,104,52
RD 36,31,36992
TR 80,25,24832
TR 82,25,25344
MAA 160,112,56
TR 84,25,37248
s_add_u32 m0, s56, 73984
MAA 160,116,76
buffer_load_dwordx4 v18, s[20:23], s54 offen lds
MAA 120,116,72
TR 86,25,37760
MAA 120,112,52
buffer_load_dwordx4 v19, s[20:23], s54 offen offset:1024 lds
MAA 116,112,48
TR 88,25,25856
MAA 116,116,68
buffer_load_dwordx4 v20, s[20:23], s54 offen offset:2048 lds
MAA 112,116,64
s_add_u32 s54, s54, 196608
s_add_u32 m0, s55, 18496
MAA 112,112,44
buffer_load_dwordx4 v21, s[36:39], s52 offen lds
MAA 108,112,40
TR 90,25,26368
MAA 108,116,60
buffer_load_dwordx4 v28, s[36:39], s52 offen offset:1024 lds
MAA 140,60,124
TR 92,25,38272
MAA 140,40,120
TR 94,25,38784
TR 96,25,26880
TR 98,25,27392
MAA 144,44,120
TR 100,25,39296
MAA 144,64,124
buffer_load_dword v22, s[36:39], s52 offen offset:2048 lds
MAA 148,68,124
TR 102,25,39808
s_add_u32 s52, s52, 128
MAA 148,48,120
buffer_load_dword v37, v34, s[40:43], 0 offen sc1
MAA 152,52,120
MAA 152,72,124
s_waitcnt vmcnt(19) lgkmcnt(8)
s_barrier
MAA 60,80,0
TR 104,25,24864
s_add_u32 m0, s56, 86400
MAA 60,84,20
buffer_load_dwordx4 v18, s[20:23], s54 offen lds
MAA 64,84,24
s_sub_u32 s47, s47, 1
s_cbranch_scc1 .Lx6
.Lx6b:
MAA 64,80,4
buffer_load_dwordx4 v19, s[20:23], s54 offen offset:1024 lds
MAA 68,80,8
TR 106,25,25376
MAA 68,84,28
TR 108,25,37280
TR 110,25,37792
MAA 72,84,32
TR 112,25,25888
MAA 72,80,12
TR 114,25,26400
s_waitcnt lgkmcnt(6)
MAA 244,80,16
TR 116,25,38304
MAA 244,84,36
buffer_load_dwordx4 v20, s[20:23], s54 offen offset:2048 lds
MAA 156,92,36
s_add_u32 s54, s54, 196608
s_add_u32 m0, s55, 20800
MAA 156,88,16
buffer_load_dwordx4 v21, s[36:39], s53 offen lds
MAA 104,88,12
TR 118,25,38816
MAA 104,92,32
buffer_load_dwordx4 v28, s[36:39], s53 offen offset:1024 lds
MAA 100,92,28
TR 120,25,26912
MAA 100,88,8
buffer_load_dword v29, s[36:39], s53 offen offset:2048 lds
MAA 96,88,4
s_add_u32 s53, s53, 128
MAA 96,92,24
TR 122,25,27424
TR 124,25,39328
MAA 92,92,20
TR 126,25,39840
s_add_u32 m0, s55, 36992
MAA 92,88,0
buffer_load_dwordx4 v21, s[36:39], s52 offen lds
MAA 124,0,96
RD 40,23,55488
MAA 124,20,100
buffer_load_dwordx4 v28, s[36:39], s52 offen offset:1024 lds
MAA 128,24,100
RD 44,23,57792
MAA 128,4,96
RD 48,23,60096
RD 52,23,62400
MAA 132,8,96
RD 56,24,55488
MAA 132,28,100
buffer_load_dword v22, s[36:39], s52 offen offset:2048 lds
MAA 136,32,100
s_add_u32 s52, s52, 128
MAA 136,12,96
s_waitcnt vmcnt(22) lgkmcnt(5)
s_barrier
MAA 76,104,0
RD 60,30,55488
s_add_u32 m0, s56, 98816
MAA 76,108,20
buffer_load_dwordx4 v18, s[20:23], s54 offen lds
MAA 80,108,24
RD 64,30,57792
MAA 80,104,4
RD 68,30,60096
MAA 84,104,8
RD 72,30,62400
MAA 84,108,28
buffer_load_dwordx4 v19, s[20:23], s54 offen offset:1024 lds
MAA 88,108,32
RD 76,31,55488
MAA 88,104,12
TR 80,25,49664
MAA 160,112,16
TR 82,25,50176
MAA 160,116,36
buffer_load_dwordx4 v20, s[20:23], s54 offen offset:2048 lds
MAA 120,116,32
TR 84,25,62080
s_add_u32 s54, s54, 196608
MAA 120,112,12
TR 86,25,62592
MAA 116,112,8
s_add_u32 m0, s55, 39296
MAA 116,116,28
buffer_load_dwordx4 v21, s[36:39], s53 offen lds
MAA 112,116,24
TR 88,25,50688
MAA 112,112,4
TR 90,25,51200
MAA 108,112,0
TR 92,25,63104
MAA 108,116,20
buffer_load_dwordx4 v28, s[36:39], s53 offen offset:1024 lds
MAA 140,20,124
TR 94,25,63616
MAA 140,0,120
TR 96,25,51712
MAA 144,4,120
TR 98,25,52224
MAA 144,24,124
buffer_load_dword v29, s[36:39], s53 offen offset:2048 lds
MAA 148,28,124
TR 100,25,64128
s_add_u32 s53, s53, 128
MAA 148,8,120
TR 102,25,64640
MAA 152,12,120
MAA 152,32,124
s_waitcnt vmcnt(22) lgkmcnt(8)
s_barrier
MAA 60,80,40
TR 104,25,49696
s_add_u32 m0, s56, 111232
MAA 60,84,60
buffer_load_dwordx4 v18, s[20:23], s54 offen lds
MAA 64,84,64
s_sub_u32 s47, s47, 1
s_cbranch_scc1 .Lx7
.Lx7b:
MAA 64,80,44
TR 106,25,50208
MAA 68,80,48
TR 108,25,62112
MAA 68,84,68
buffer_load_dwordx4 v19, s[20:23], s54 offen offset:1024 lds
MAA 72,84,72
TR 110,25,62624
MAA 72,80,52
TR 112,25,50720
s_waitcnt lgkmcnt(5)
MAA 244,80,56
TR 114,25,51232
MAA 244,84,76
.Lpad1:
s_cbranch_execz .Lpad5
buffer_load_dwordx4 v20, s[20:23], s54 offen offset:2048 lds
MAA 156,92,76
s_add_u32 s54, s54, 196608
MAA 156,88,56
TR 116,25,63136
MAA 104,88,52
TR 118,25,63648
MAA 104,92,72
TR 120,25,51744
MAA 100,92,68
TR 122,25,52256
s_add_u32 m0, s55, 55488
MAA 100,88,48
buffer_load_dwordx4 v21, s[36:39], s52 offen lds
MAA 96,88,44
TR 124,25,64160
MAA 96,92,64
TR 126,25,64672
MAA 92,92,60
MAA 92,88,40
buffer_load_dwordx4 v28, s[36:39], s52 offen offset:1024 lds
MAA 124,40,96
ds_read_b128 a[0:3], v23
MAA 124,60,100
RD 4,23,2304
MAA 128,64,100
RD 8,23,4608
MAA 128,44,96
buffer_load_dword v22, s[36:39], s52 offen offset:2048 lds
MAA 132,48,96
RD 12,23,6912
s_add_u32 s52, s52, 128
MAA 132,68,100
ds_read_b128 a[16:19], v24
MAA 136,72,100
MAA 136,52,96
s_waitcnt vmcnt(18) lgkmcnt(5)
s_barrier
v_cmp_gt_u32 vcc, v35, v37
s_nop 0
s_cbranch_vccnz .Lsp8
.Lsp8b:
v_mov_b32 v37, 0
MAA 76,104,40
ds_read_b128 a[20:23], v30
MAA 76,108,60
buffer_atomic_add v38, v32, s[16:19], 0 offen
MAA 80,108,64
RD 24,30,2304
MAA 80,104,44
RD 28,30,4608
MAA 84,104,48
RD 32,30,6912
s_add_u32 m0, s56, 123648
MAA 84,108,68
buffer_load_dwordx4 v18, s[20:23], s54 offen lds
MAA 88,108,72
ds_read_b128 a[36:39], v31
MAA 88,104,52
buffer_load_dwordx4 v19, s[20:23], s54 offen offset:1024 lds
MAA 160,112,56
ds_read_b64_tr_b16 a[80:81], v25
MAA 160,116,76
TR 82,25,512
MAA 120,116,72
TR 84,25,12416
MAA 120,112,52
buffer_load_dwordx4 v20, s[20:23], s54 offen offset:2048 lds
MAA 116,112,48
TR 86,25,12928
s_add_u32 s54, s54, 196608
MAA 116,116,68
TR 88,25,1024
MAA 112,116,64
TR 90,25,1536
s_add_u32 m0, s55, 57792
MAA 112,112,44
buffer_load_dwordx4 v21, s[36:39], s53 offen lds
MAA 108,112,40
TR 92,25,13440
MAA 108,116,60
TR 94,25,13952
MAA 140,60,124
TR 96,25,2048
MAA 140,40,120
buffer_load_dwordx4 v28, s[36:39], s53 offen offset:1024 lds
MAA 144,44,120
TR 98,25,2560
MAA 144,64,124
buffer_load_dword v29, s[36:39], s53 offen offset:2048 lds
MAA 148,68,124
TR 100,25,14464
s_add_u32 s53, s53, 128
MAA 148,48,120
TR 102,25,14976
MAA 152,52,120
MAA 152,72,124
s_waitcnt vmcnt(22) lgkmcnt(8)
s_barrier
MAA 60,80,0
TR 104,25,32
s_add_u32 m0, s56, 136064
MAA 60,84,20
buffer_load_dwordx4 v18, s[20:23], s54 offen lds
MAA 64,84,24
s_sub_u32 s47, s47, 1
s_cbranch_scc1 .Lx9
.Lx9b:
MAA 64,80,4
TR 106,25,544
v_accvgpr_write_b32 a224, v192
MAA 68,80,8
TR 108,25,12448
MAA 68,84,28
buffer_load_dwordx4 v19, s[20:23], s54 offen offset:1024 lds
MAA 72,84,32
TR 110,25,12960
v_accvgpr_write_b32 a225, v193
MAA 72,80,12
TR 112,25,1056
s_waitcnt lgkmcnt(5)
MAA 244,80,16
TR 114,25,1568
MAA 244,84,36
buffer_load_dwordx4 v20, s[20:23], s54 offen offset:2048 lds
MAA 156,92,36
s_add_u32 s54, s54, 196608
v_accvgpr_write_b32 a226, v194
MAA 156,88,16
TR 116,25,13472
MAA 104,88,12
TR 118,25,13984
v_accvgpr_write_b32 a227, v195
MAA 104,92,32
TR 120,25,2080
MAA 100,92,28
TR 122,25,2592
s_add_u32 m0, s55, 0
MAA 100,88,8
buffer_load_dwordx4 v21, s[36:39], s52 offen lds
MAA 96,88,4
TR 124,25,14496
v_accvgpr_write_b32 a228, v196
MAA 96,92,24
TR 126,25,15008
MAA 92,92,20
v_accvgpr_write_b32 a229, v197
MAA 92,88,0
buffer_load_dwordx4 v28, s[36:39], s52 offen offset:1024 lds
MAA 124,0,96
RD 40,23,18496
MAA 124,20,100
RD 44,23,20800
v_accvgpr_write_b32 a230, v198
MAA 128,24,100
RD 48,23,23104
MAA 128,4,96
buffer_load_dword v22, s[36:39], s52 offen offset:2048 lds
MAA 132,8,96
RD 52,23,25408
s_add_u32 s52, s52, 128
MAA 132,28,100
RD 56,24,18496
v_accvgpr_write_b32 a231, v199
MAA 136,32,100
MAA 136,12,96
s_waitcnt vmcnt(16) lgkmcnt(5)
s_barrier
MAA 76,104,0
RD 60,30,18496
s_add_u32 m0, s56, 73984
MAA 76,108,20
buffer_load_dwordx4 v18, s[20:23], s54 offen lds
MAA 80,108,24
RD 64,30,20800
v_accvgpr_write_b32 a232, v200
MAA 80,104,4
RD 68,30,23104
MAA 84,104,8
RD 72,30,25408
v_accvgpr_write_b32 a233, v201
MAA 84,108,28
buffer_load_dwordx4 v19, s[20:23], s54 offen offset:1024 lds
MAA 88,108,32
RD 76,31,18496
MAA 88,104,12
TR 80,25,24832
v_accvgpr_write_b32 a234, v202
MAA 160,112,16
TR 82,25,25344
MAA 160,116,36
buffer_load_dwordx4 v20, s[20:23], s54 offen offset:2048 lds
MAA 120,116,32
TR 84,25,37248
s_add_u32 s54, s54, 196608
MAA 120,112,12
TR 86,25,37760
v_accvgpr_write_b32 a235, v203
MAA 116,112,8
s_add_u32 m0, s55, 2304
MAA 116,116,28
buffer_load_dwordx4 v21, s[36:39], s53 offen lds
MAA 112,116,24
TR 88,25,25856
v_accvgpr_write_b32 a236, v204
MAA 112,112,4
TR 90,25,26368
MAA 108,112,0
TR 92,25,38272
v_accvgpr_write_b32 a237, v205
MAA 108,116,20
buffer_load_dwordx4 v28, s[36:39], s53 offen offset:1024 lds
MAA 140,20,124
TR 94,25,38784
MAA 140,0,120
TR 96,25,26880
v_accvgpr_write_b32 a238, v206
MAA 144,4,120
TR 98,25,27392
MAA 144,24,124
buffer_load_dword v29, s[36:39], s53 offen offset:2048 lds
MAA 148,28,124
TR 100,25,39296
s_add_u32 s53, s53, 128
MAA 148,8,120
TR 102,25,39808
v_accvgpr_write_b32 a239, v207
MAA 152,12,120
MAA 152,32,124
s_waitcnt lgkmcnt(8)
s_barrier
MAA 60,80,40
TR 104,25,24864
s_add_u32 m0, s56, 86400
MAA 60,84,60
buffer_load_dwordx4 v18, s[20:23], s54 offen lds
MAA 64,84,64
s_sub_u32 s47, s47, 1
s_cbranch_scc1 .Lx10
.Lx10b:
MAA 64,80,44
TR 106,25,25376
v_accvgpr_write_b32 a240, v208
MAA 68,80,48
TR 108,25,37280
MAA 68,84,68
buffer_load_dwordx4 v19, s[20:23], s54 offen offset:1024 lds
MAA 72,84,72
TR 110,25,37792
v_accvgpr_write_b32 a241, v209
MAA 72,80,52
TR 112,25,25888
s_waitcnt lgkmcnt(5)
MAA 244,80,56
TR 114,25,26400
MAA 244,84,76
buffer_load_dwordx4 v20, s[20:23], s54 offen offset:2048 lds
MAA 156,92,76
s_add_u32 s54, s54, 196608
v_accvgpr_write_b32 a242, v210
MAA 156,88,56
TR 116,25,38304
MAA 104,88,52
TR 118,25,38816
v_accvgpr_write_b32 a243, v211
MAA 104,92,72
TR 120,25,26912
MAA 100,92,68
TR 122,25,27424
s_add_u32 m0, s55, 18496
MAA 100,88,48
buffer_load_dwordx4 v21, s[36:39], s52 offen lds
MAA 96,88,44
TR 124,25,39328
v_accvgpr_write_b32 a244, v212
MAA 96,92,64
TR 126,25,39840
MAA 92,92,60
v_accvgpr_write_b32 a245, v213
MAA 92,88,40
buffer_load_dwordx4 v28, s[36:39], s52 offen offset:1024 lds
MAA 124,40,96
RD 0,23,36992
MAA 124,60,100
RD 4,23,39296
v_accvgpr_write_b32 a246, v214
MAA 128,64,100
RD 8,23,41600
MAA 128,44,96
buffer_load_dword v22, s[36:39], s52 offen offset:2048 lds
MAA 132,48,96
RD 12,23,43904
s_add_u32 s52, s52, 128
MAA 132,68,100
RD 16,24,36992
v_accvgpr_write_b32 a247, v215
MAA 136,72,100
MAA 136,52,96
s_waitcnt vmcnt(15) lgkmcnt(5)
s_barrier
MAA 76,104,40
RD 20,30,36992
s_add_u32 m0, s56, 98816
MAA 76,108,60
buffer_load_dwordx4 v18, s[20:23], s54 offen lds
MAA 80,108,64
RD 24,30,39296
v_accvgpr_write_b32 a248, v216
MAA 80,104,44
RD 28,30,41600
v_accvgpr_write_b32 a249, v217
MAA 84,104,48
RD 32,30,43904
MAA 84,108,68
buffer_load_dwordx4 v19, s[20:23], s54 offen offset:1024 lds
MAA 88,108,72
RD 36,31,36992
v_accvgpr_write_b32 a250, v218
MAA 88,104,52
buffer_load_dwordx4 v20, s[20:23], s54 offen offset:2048 lds
MAA 160,112,56
TR 80,25,49664
s_add_u32 s54, s54, 196608
MAA 160,116,76
TR 82,25,50176
MAA 120,116,72
TR 84,25,62080
s_add_u32 m0, s55, 20800
MAA 120,112,52
buffer_load_dwordx4 v21, s[36:39], s53 offen lds
MAA 116,112,48
TR 86,25,62592
v_accvgpr_write_b32 a251, v219
MAA 116,116,68
TR 88,25,50688
MAA 112,116,64
TR 90,25,51200
v_accvgpr_write_b32 a252, v220
MAA 112,112,44
buffer_load_dwordx4 v28, s[36:39], s53 offen offset:1024 lds
MAA 108,112,40
TR 92,25,63104
MAA 108,116,60
TR 94,25,63616
v_accvgpr_write_b32 a253, v221
MAA 140,60,124
TR 96,25,51712
MAA 140,40,120
buffer_load_dword v29, s[36:39], s53 offen offset:2048 lds
MAA 144,44,120
TR 98,25,52224
s_add_u32 s53, s53, 128
MAA 144,64,124
buffer_atomic_add v37, v33, s[16:19], 0 offen sc0
MAA 148,68,124
TR 100,25,64128
v_accvgpr_write_b32 a254, v222
MAA 148,48,120
TR 102,25,64640
MAA 152,52,120
v_accvgpr_write_b32 a255, v223
MAA 152,72,124
s_waitcnt lgkmcnt(8)
s_barrier
MAA 60,80,0
TR 104,25,49696
s_add_u32 m0, s56, 111232
MAA 60,84,20
buffer_load_dwordx4 v18, s[20:23], s54 offen lds
MAA 64,84,24
s_sub_u32 s47, s47, 1
s_cbranch_scc1 .Lx11
.Lx11b:
MAA 64,80,4
TR 106,25,50208
MAA 68,80,8
TR 108,25,62112
MAA 68,84,28
buffer_load_dwordx4 v19, s[20:23], s54 offen offset:1024 lds
MAA 72,84,32
TR 110,25,62624
MAA 72,80,12
TR 112,25,50720
s_waitcnt lgkmcnt(5)
MAA 244,80,16
TR 114,25,51232
MAA 244,84,36
buffer_load_dwordx4 v20, s[20:23], s54 offen offset:2048 lds
MAA 156,92,36
s_add_u32 s54, s54, 196608
MAA 156,88,16
TR 116,25,63136
MAA 104,88,12
TR 118,25,63648
MAA 104,92,32
TR 120,25,51744
MAA 100,92,28
TR 122,25,52256
s_add_u32 m0, s55, 36992
MAA 100,88,8
buffer_load_dwordx4 v21, s[36:39], s52 offen lds
MAA 96,88,4
TR 124,25,64160
MAA 96,92,24
TR 126,25,64672
MAA 92,92,20
MAA 92,88,0
buffer_load_dwordx4 v28, s[36:39], s52 offen offset:1024 lds
MAA 124,0,96
RD 40,23,55488
MAA 124,20,100
RD 44,23,57792
MAA 128,24,100
RD 48,23,60096
MAA 128,4,96
buffer_load_dword v22, s[36:39], s52 offen offset:2048 lds
MAA 132,8,96
RD 52,23,62400
s_add_u32 s52, s52, 128
MAA 132,28,100
RD 56,24,55488
MAA 136,32,100
MAA 136,12,96
s_waitcnt vmcnt(16) lgkmcnt(5)
s_barrier
MAA 76,104,0
RD 60,30,55488
s_add_u32 m0, s56, 123648
MAA 76,108,20
buffer_load_dwordx4 v18, s[20:23], s54 offen lds
MAA 80,108,24
RD 64,30,57792
MAA 80,104,4
RD 68,30,60096
MAA 84,104,8
RD 72,30,62400
MAA 84,108,28
buffer_load_dwordx4 v19, s[20:23], s54 offen offset:1024 lds
MAA 88,108,32
RD 76,31,55488
MAA 88,104,12
ds_read_b64_tr_b16 a[80:81], v25
MAA 160,112,16
TR 82,25,512
MAA 160,116,36
buffer_load_dwordx4 v20, s[20:23], s54 offen offset:2048 lds
MAA 120,116,32
TR 84,25,12416
s_add_u32 s54, s54, 196608
MAA 120,112,12
TR 86,25,12928
MAA 116,112,8
s_add_u32 m0, s55, 39296
MAA 116,116,28
buffer_load_dwordx4 v21, s[36:39], s53 offen lds
MAA 112,116,24
TR 88,25,1024
MAA 112,112,4
TR 90,25,1536
MAA 108,112,0
TR 92,25,13440
MAA 108,116,20
buffer_load_dwordx4 v28, s[36:39], s53 offen offset:1024 lds
MAA 140,20,124
TR 94,25,13952
MAA 140,0,120
TR 96,25,2048
MAA 144,4,120
TR 98,25,2560
MAA 144,24,124
buffer_load_dword v29, s[36:39], s53 offen offset:2048 lds
MAA 148,28,124
TR 100,25,14464
s_add_u32 s53, s53, 128
MAA 148,8,120
TR 102,25,14976
MAA 152,12,120
MAA 152,32,124
s_waitcnt lgkmcnt(8)
s_barrier
MAA 60,80,40
TR 104,25,32
s_add_u32 m0, s56, 136064
MAA 60,84,60
buffer_load_dwordx4 v18, s[20:23], s54 offen lds
MAA 64,84,64
s_sub_u32 s47, s47, 1
s_cbranch_scc1 .Lx12
.Lx12b:
MAA 64,80,44
TR 106,25,544
MAA 68,80,48
TR 108,25,12448
MAA 68,84,68
buffer_load_dwordx4 v19, s[20:23], s54 offen offset:1024 lds
MAA 72,84,72
TR 110,25,12960
MAA 72,80,52
TR 112,25,1056
s_waitcnt lgkmcnt(5)
MAA 244,80,56
TR 114,25,1568
MAA 244,84,76
buffer_load_dwordx4 v20, s[20:23], s54 offen offset:2048 lds
MAA 156,92,76
s_add_u32 s54, s54, 196608
MAA 156,88,56
TR 116,25,13472
MAA 104,88,52
TR 118,25,13984
MAA 104,92,72
TR 120,25,2080
MAA 100,92,68
TR 122,25,2592
s_add_u32 m0, s55, 55488
MAA 100,88,48
buffer_load_dwordx4 v21, s[36:39], s52 offen lds
MAA 96,88,44
TR 124,25,14496
MAA 96,92,64
TR 126,25,15008
MAA 92,92,60
MAA 92,88,40
buffer_load_dwordx4 v28, s[36:39], s52 offen offset:1024 lds
MAA 124,40,96
ds_read_b128 a[0:3], v23
MAA 124,60,100
RD 4,23,2304
MAA 128,64,100
RD 8,23,4608
MAA 128,44,96
buffer_load_dword v22, s[36:39], s52 offen offset:2048 lds
MAA 132,48,96
.Lpad2:
s_cbranch_execz .Lpad6
RD 12,23,6912
s_add_u32 s52, s52, 128
MAA 132,68,100
ds_read_b128 a[16:19], v24
MAA 136,72,100
MAA 136,52,96
s_waitcnt vmcnt(18)
v_cmp_gt_u32 vcc, v36, v37
s_nop 0
s_cbranch_vccnz .Lsp13
.Lsp13b:
s_waitcnt vmcnt(15) lgkmcnt(5)
s_barrier
MAA 76,104,40
ds_read_b128 a[20:23], v30
s_add_u32 m0, s56, 73984
MAA 76,108,60
buffer_load_dwordx4 v18, s[20:23], s54 offen lds
MAA 80,108,64
RD 24,30,2304
MAA 80,104,44
RD 28,30,4608
MAA 84,104,48
RD 32,30,6912
MAA 84,108,68
buffer_load_dwordx4 v19, s[20:23], s54 offen offset:1024 lds
MAA 88,108,72
ds_read_b128 a[36:39], v31
MAA 88,104,52
buffer_load_dwordx4 v20, s[20:23], s54 offen offset:2048 lds
MAA 160,112,56
TR 80,25,24832
s_add_u32 s54, s54, 196608
MAA 160,116,76
TR 82,25,25344
MAA 120,116,72
TR 84,25,37248
s_add_u32 m0, s55, 57792
MAA 120,112,52
buffer_load_dwordx4 v21, s[36:39], s53 offen lds
MAA 116,112,48
TR 86,25,37760
MAA 116,116,68
TR 88,25,25856
MAA 112,116,64
TR 90,25,26368
MAA 112,112,44
buffer_load_dwordx4 v28, s[36:39], s53 offen offset:1024 lds
MAA 108,112,40
TR 92,25,38272
MAA 108,116,60
TR 94,25,38784
MAA 140,60,124
TR 96,25,26880
MAA 140,40,120
buffer_load_dword v29, s[36:39], s53 offen offset:2048 lds
MAA 144,44,120
TR 98,25,27392
s_add_u32 s53, s53, 128
MAA 144,64,124
buffer_load_dwordx4 v[164:167], v26, s[16:19], s75 offen sc1
MAA 148,68,124
TR 100,25,39296
MAA 148,48,120
TR 102,25,39808
MAA 152,52,120
MAA 152,72,124
s_waitcnt lgkmcnt(8)
s_barrier
MAA 60,80,0
TR 104,25,24864
s_add_u32 m0, s56, 86400
MAA 60,84,20
buffer_load_dwordx4 v18, s[20:23], s54 offen lds
MAA 64,84,24
s_sub_u32 s47, s47, 1
s_cbranch_scc1 .Lx14
.Lx14b:
MAA 64,80,4
TR 106,25,25376
MAA 68,80,8
TR 108,25,37280
MAA 68,84,28
buffer_load_dwordx4 v19, s[20:23], s54 offen offset:1024 lds
MAA 72,84,32
TR 110,25,37792
MAA 72,80,12
TR 112,25,25888
s_waitcnt lgkmcnt(5)
MAA 244,80,16
TR 114,25,26400
MAA 244,84,36
buffer_load_dwordx4 v20, s[20:23], s54 offen offset:2048 lds
MAA 156,92,36
TR 116,25,38304
s_add_u32 s54, s54, 196608
MAA 156,88,16
TR 118,25,38816
MAA 104,88,12
TR 120,25,26912
s_add_u32 m0, s55, 0
MAA 104,92,32
buffer_load_dwordx4 v21, s[36:39], s52 offen lds
MAA 100,92,28
MAA 100,88,8
buffer_load_dwordx4 v28, s[36:39], s52 offen offset:1024 lds
MAA 96,88,4
TR 122,25,27424
MAA 96,92,24
TR 124,25,39328
MAA 92,92,20
TR 126,25,39840
MAA 92,88,0
buffer_load_dword v22, s[36:39], s52 offen offset:2048 lds
MAA 124,0,96
RD 40,23,18496
s_add_u32 s52, s52, 128
MAA 124,20,100
RD 44,23,20800
MAA 128,24,100
RD 48,23,23104
MAA 128,4,96
buffer_load_dwordx4 v[168:171], v26, s[16:19], s75 offen offset:1024 sc1
MAA 132,8,96
RD 52,23,25408
MAA 132,28,100
RD 56,24,18496
MAA 136,32,100
MAA 136,12,96
s_waitcnt vmcnt(17) lgkmcnt(5)
s_barrier
MAA 76,104,0
RD 60,30,18496
s_add_u32 m0, s56, 98816
MAA 76,108,20
buffer_load_dwordx4 v18, s[20:23], s54 offen lds
MAA 80,108,24
RD 64,30,20800
MAA 80,104,4
RD 68,30,23104
MAA 84,104,8
RD 72,30,25408
MAA 84,108,28
buffer_load_dwordx4 v19, s[20:23], s54 offen offset:1024 lds
MAA 88,108,32
RD 76,31,18496
MAA 88,104,12
buffer_load_dwordx4 v20, s[20:23], s54 offen offset:2048 lds
MAA 160,112,16
TR 80,25,49664
s_add_u32 s54, s54, 196608
MAA 160,116,36
TR 82,25,50176
MAA 120,116,32
TR 84,25,62080
s_add_u32 m0, s55, 2304
MAA 120,112,12
buffer_load_dwordx4 v21, s[36:39], s53 offen lds
MAA 116,112,8
TR 86,25,62592
MAA 116,116,28
TR 88,25,50688
MAA 112,116,24
TR 90,25,51200
MAA 112,112,4
buffer_load_dwordx4 v28, s[36:39], s53 offen offset:1024 lds
MAA 108,112,0
TR 92,25,63104
MAA 108,116,20
TR 94,25,63616
MAA 140,20,124
TR 96,25,51712
MAA 140,0,120
buffer_load_dword v29, s[36:39], s53 offen offset:2048 lds
MAA 144,4,120
TR 98,25,52224
s_add_u32 s53, s53, 128
MAA 144,24,124
buffer_load_dwordx4 v[172:175], v26, s[16:19], s75 offen offset:2048 sc1
MAA 148,28,124
TR 100,25,64128
MAA 148,8,120
TR 102,25,64640
MAA 152,12,120
MAA 152,32,124
s_waitcnt lgkmcnt(8)
s_barrier
MAA 60,80,40
TR 104,25,49696
s_add_u32 m0, s56, 111232
MAA 60,84,60
buffer_load_dwordx4 v18, s[20:23], s54 offen lds
MAA 64,84,64
s_sub_u32 s47, s47, 1
s_cbranch_scc1 .Lx15
.Lx15b:
MAA 64,80,44
TR 106,25,50208
MAA 68,80,48
TR 108,25,62112
MAA 68,84,68
buffer_load_dwordx4 v19, s[20:23], s54 offen offset:1024 lds
MAA 72,84,72
TR 110,25,62624
MAA 72,80,52
TR 112,25,50720
s_waitcnt lgkmcnt(5)
MAA 244,80,56
TR 114,25,51232
MAA 244,84,76
buffer_load_dwordx4 v20, s[20:23], s54 offen offset:2048 lds
MAA 156,92,76
TR 116,25,63136
s_add_u32 s54, s54, 196608
MAA 156,88,56
TR 118,25,63648
MAA 104,88,52
TR 120,25,51744
s_add_u32 m0, s55, 18496
MAA 104,92,72
buffer_load_dwordx4 v21, s[36:39], s52 offen lds
MAA 100,92,68
MAA 100,88,48
buffer_load_dwordx4 v28, s[36:39], s52 offen offset:1024 lds
MAA 96,88,44
TR 122,25,52256
MAA 96,92,64
TR 124,25,64160
MAA 92,92,60
TR 126,25,64672
MAA 92,88,40
buffer_load_dword v22, s[36:39], s52 offen offset:2048 lds
MAA 124,40,96
RD 0,23,36992
s_add_u32 s52, s52, 128
MAA 124,60,100
RD 4,23,39296
MAA 128,64,100
RD 8,23,41600
MAA 128,44,96
buffer_load_dwordx4 v[176:179], v26, s[16:19], s75 offen offset:3072 sc1
MAA 132,48,96
RD 12,23,43904
s_add_u32 s75, s75, 4096
MAA 132,68,100
RD 16,24,36992
MAA 136,72,100
MAA 136,52,96
s_waitcnt vmcnt(18) lgkmcnt(5)
s_barrier
MAA 76,104,40
RD 20,30,36992
s_add_u32 m0, s56, 123648
MAA 76,108,60
buffer_load_dwordx4 v18, s[20:23], s54 offen lds
MAA 80,108,64
RD 24,30,39296
s_waitcnt vmcnt(15)
v_add_f32 v164, v164, v168
MAA 80,104,44
RD 28,30,41600
MAA 84,104,48
RD 32,30,43904
MAA 84,108,68
buffer_load_dwordx4 v19, s[20:23], s54 offen offset:1024 lds
MAA 88,108,72
RD 36,31,36992
v_add_f32 v165, v165, v169
MAA 88,104,52
buffer_load_dwordx4 v20, s[20:23], s54 offen offset:2048 lds
MAA 160,112,56
ds_read_b64_tr_b16 a[80:81], v25
s_add_u32 s54, s54, 196608
MAA 160,116,76
TR 82,25,512
MAA 120,116,72
TR 84,25,12416
s_add_u32 m0, s55, 20800
MAA 120,112,52
buffer_load_dwordx4 v21, s[36:39], s53 offen lds
MAA 116,112,48
TR 86,25,12928
MAA 116,116,68
TR 88,25,1024
MAA 112,116,64
TR 90,25,1536
v_add_f32 v166, v166, v170
MAA 112,112,44
buffer_load_dwordx4 v28, s[36:39], s53 offen offset:1024 lds
MAA 108,112,40
TR 92,25,13440
MAA 108,116,60
TR 94,25,13952
MAA 140,60,124
TR 96,25,2048
MAA 140,40,120
buffer_load_dword v29, s[36:39], s53 offen offset:2048 lds
MAA 144,44,120
TR 98,25,2560
s_add_u32 s53, s53, 128
MAA 144,64,124
buffer_load_dwordx4 v[180:183], v26, s[16:19], s75 offen sc1
MAA 148,68,124
TR 100,25,14464
v_add_f32 v167, v167, v171
MAA 148,48,120
TR 102,25,14976
MAA 152,52,120
MAA 152,72,124
s_waitcnt lgkmcnt(8)
s_barrier
MAA 60,80,0
TR 104,25,32
s_add_u32 m0, s56, 136064
MAA 60,84,20
buffer_load_dwordx4 v18, s[20:23], s54 offen lds
MAA 64,84,24
s_sub_u32 s47, s47, 1
s_cbranch_scc1 .Lx16
.Lx16b:
MAA 64,80,4
TR 106,25,544
s_waitcnt vmcnt(15)
v_add_f32 v164, v164, v172
MAA 68,80,8
TR 108,25,12448
MAA 68,84,28
buffer_load_dwordx4 v19, s[20:23], s54 offen offset:1024 lds
MAA 72,84,32
TR 110,25,12960
MAA 72,80,12
TR 112,25,1056
s_waitcnt lgkmcnt(5)
MAA 244,80,16
TR 114,25,1568
MAA 244,84,36
buffer_load_dwordx4 v20, s[20:23], s54 offen offset:2048 lds
MAA 156,92,36
TR 116,25,13472
s_add_u32 s54, s54, 196608
MAA 156,88,16
TR 118,25,13984
v_add_f32 v165, v165, v173
MAA 104,88,12
TR 120,25,2080
s_add_u32 m0, s55, 36992
MAA 104,92,32
buffer_load_dwordx4 v21, s[36:39], s52 offen lds
MAA 100,92,28
MAA 100,88,8
buffer_load_dwordx4 v28, s[36:39], s52 offen offset:1024 lds
MAA 96,88,4
TR 122,25,2592
MAA 96,92,24
TR 124,25,14496
v_add_f32 v166, v166, v174
MAA 92,92,20
TR 126,25,15008
MAA 92,88,0
buffer_load_dword v22, s[36:39], s52 offen offset:2048 lds
MAA 124,0,96
RD 40,23,55488
s_add_u32 s52, s52, 128
MAA 124,20,100
RD 44,23,57792
MAA 128,24,100
RD 48,23,60096
MAA 128,4,96
buffer_load_dwordx4 v[184:187], v26, s[16:19], s75 offen offset:1024 sc1
MAA 132,8,96
RD 52,23,62400
v_add_f32 v167, v167, v175
MAA 132,28,100
RD 56,24,55488
MAA 136,32,100
MAA 136,12,96
s_waitcnt vmcnt(18) lgkmcnt(5)
s_barrier
MAA 76,104,0
RD 60,30,55488
s_add_u32 m0, s56, 73984
MAA 76,108,20
buffer_load_dwordx4 v18, s[20:23], s54 offen lds
MAA 80,108,24
RD 64,30,57792
s_waitcnt vmcnt(15)
v_add_f32 v164, v164, v176
MAA 80,104,4
RD 68,30,60096
v_add_f32 v165, v165, v177
MAA 84,104,8
buffer_load_dwordx4 v19, s[20:23], s54 offen offset:1024 lds
MAA 84,108,28
RD 72,30,62400
v_add_f32 v166, v166, v178
MAA 88,108,32
RD 76,31,55488
v_add_f32 v167, v167, v179
MAA 88,104,12
buffer_load_dwordx4 v20, s[20:23], s54 offen offset:2048 lds
MAA 160,112,16
TR 80,25,24832
s_add_u32 s54, s54, 196608
MAA 160,116,36
TR 82,25,25344
s_add_u32 m0, s55, 39296
MAA 120,116,32
buffer_load_dwordx4 v21, s[36:39], s53 offen lds
MAA 120,112,12
TR 84,25,37248
MAA 116,112,8
TR 86,25,37760
MAA 116,116,28
buffer_load_dwordx4 v28, s[36:39], s53 offen offset:1024 lds
MAA 112,116,24
TR 88,25,25856
MAA 112,112,4
TR 90,25,26368
MAA 108,112,0
buffer_load_dword v29, s[36:39], s53 offen offset:2048 lds
MAA 108,116,20
TR 92,25,38272
s_add_u32 s53, s53, 128
MAA 140,20,124
TR 94,25,38784
MAA 140,0,120
buffer_load_dwordx4 v[188:191], v26, s[16:19], s75 offen offset:2048 sc1
MAA 144,4,120
TR 96,25,26880
MAA 144,24,124
TR 98,25,27392
MAA 148,28,124
TR 100,25,39296
MAA 148,8,120
TR 102,25,39808
MAA 152,12,120
MAA 152,32,124
s_waitcnt lgkmcnt(8)
s_barrier
MAA 60,80,40
TR 104,25,24864
s_add_u32 m0, s56, 86400
MAA 60,84,60
buffer_load_dwordx4 v18, s[20:23], s54 offen lds
MAA 64,84,64
s_sub_u32 s47, s47, 1
s_cbranch_scc1 .Lx17
.Lx17b:
MAA 64,80,44
TR 106,25,25376
s_waitcnt vmcnt(15)
v_add_f32 v164, v164, v180
MAA 68,80,48
TR 108,25,37280
MAA 68,84,68
buffer_load_dwordx4 v19, s[20:23], s54 offen offset:1024 lds
MAA 72,84,72
TR 110,25,37792
MAA 72,80,52
TR 112,25,25888
s_waitcnt lgkmcnt(5)
MAA 244,80,56
TR 114,25,26400
MAA 244,84,76
buffer_load_dwordx4 v20, s[20:23], s54 offen offset:2048 lds
MAA 156,92,76
TR 116,25,38304
s_add_u32 s54, s54, 196608
MAA 156,88,56
TR 118,25,38816
v_add_f32 v165, v165, v181
MAA 104,88,52
TR 120,25,26912
s_add_u32 m0, s55, 55488
MAA 104,92,72
buffer_load_dwordx4 v21, s[36:39], s52 offen lds
MAA 100,92,68
MAA 100,88,48
buffer_load_dwordx4 v28, s[36:39], s52 offen offset:1024 lds
MAA 96,88,44
TR 122,25,27424
MAA 96,92,64
TR 124,25,39328
v_add_f32 v166, v166, v182
MAA 92,92,60
TR 126,25,39840
MAA 92,88,40
buffer_load_dword v22, s[36:39], s52 offen offset:2048 lds
MAA 124,40,96
ds_read_b128 a[0:3], v23
s_add_u32 s52, s52, 128
MAA 124,60,100
RD 4,23,2304
MAA 128,64,100
RD 8,23,4608
MAA 128,44,96
buffer_load_dwordx4 v[192:195], v26, s[16:19], s75 offen offset:3072 sc1
MAA 132,48,96
RD 12,23,6912
v_add_f32 v167, v167, v183
MAA 132,68,100
ds_read_b128 a[16:19], v24
MAA 136,72,100
MAA 136,52,96
s_waitcnt vmcnt(18) lgkmcnt(5)
s_barrier
MAA 76,104,40
ds_read_b128 a[20:23], v30
s_add_u32 m0, s56, 98816
MAA 76,108,60
buffer_load_dwordx4 v18, s[20:23], s54 offen lds
MAA 80,108,64
RD 24,30,2304
s_waitcnt vmcnt(15)
v_add_f32 v164, v164, v184
MAA 80,104,44
RD 28,30,4608
v_add_f32 v165, v165, v185
MAA 84,104,48
RD 32,30,6912
v_add_f32 v166, v166, v186
MAA 84,108,68
buffer_load_dwordx4 v19, s[20:23], s54 offen offset:1024 lds
MAA 88,108,72
ds_read_b128 a[36:39], v31
v_add_f32 v167, v167, v187
MAA 88,104,52
TR 80,25,49664
MAA 160,112,56
TR 82,25,50176
MAA 160,116,76
buffer_load_dwordx4 v20, s[20:23], s54 offen offset:2048 lds
MAA 120,116,72
TR 84,25,62080
s_add_u32 s54, s54, 196608
MAA 120,112,52
TR 86,25,62592
s_add_u32 m0, s55, 57792
MAA 116,112,48
TR 88,25,50688
MAA 116,116,68
buffer_load_dwordx4 v21, s[36:39], s53 offen lds
MAA 112,116,64
TR 90,25,51200
MAA 112,112,44
TR 92,25,63104
MAA 108,112,40
.Lpad3:
s_cbranch_execz .Lpad7
TR 94,25,63616
MAA 108,116,60
buffer_load_dwordx4 v28, s[36:39], s53 offen offset:1024 lds
MAA 140,60,124
TR 96,25,51712
MAA 140,40,120
TR 98,25,52224
MAA 144,44,120
TR 100,25,64128
MAA 144,64,124
buffer_load_dword v29, s[36:39], s53 offen offset:2048 lds
MAA 148,68,124
TR 102,25,64640
s_add_u32 s53, s53, 128
MAA 148,48,120
MAA 152,52,120
MAA 152,72,124
s_waitcnt lgkmcnt(8)
s_barrier
MAA 60,80,0
TR 104,25,49696
s_add_u32 m0, s56, 111232
MAA 60,84,20
buffer_load_dwordx4 v18, s[20:23], s54 offen lds
MAA 64,84,24
TR 106,25,50208
s_waitcnt vmcnt(14)
v_add_f32 v164, v164, v188
MAA 64,80,4
TR 108,25,62112
v_add_f32 v165, v165, v189
MAA 68,80,8
buffer_load_dwordx4 v19, s[20:23], s54 offen offset:1024 lds
MAA 68,84,28
TR 110,25,62624
v_add_f32 v166, v166, v190
MAA 72,84,32
TR 112,25,50720
v_add_f32 v167, v167, v191
MAA 72,80,12
buffer_load_dwordx4 v20, s[20:23], s54 offen offset:2048 lds
s_waitcnt lgkmcnt(5)
MAA 244,80,16
TR 114,25,51232
s_add_u32 s54, s54, 196608
MAA 244,84,36
TR 116,25,63136
s_add_u32 m0, s59, 0
MAA 156,92,36
TR 118,25,63648
s_xor_b32 s58, s87, 1048576
MAA 156,88,16
buffer_load_dwordx4 v5, s[24:27], s58 offen lds
MAA 104,88,12
TR 120,25,51744
MAA 104,92,32
TR 122,25,52256
MAA 100,92,28
buffer_load_dwordx4 v6, s[24:27], s58 offen offset:1024 lds
MAA 100,88,8
TR 124,25,64160
s_add_u32 m0, s59, 8320
MAA 96,88,4
TR 126,25,64672
s_xor_b32 s58, s87, 1179648
MAA 96,92,24
buffer_load_dwordx4 v5, s[24:27], s58 offen lds
MAA 92,92,20
RD 40,23,18496
MAA 92,88,0
RD 44,23,20800
MAA 124,0,96
buffer_load_dwordx4 v6, s[24:27], s58 offen offset:1024 lds
MAA 124,20,100
RD 48,23,23104
MAA 128,24,100
RD 52,23,25408
MAA 128,4,96
RD 56,24,18496
MAA 132,8,96
MAA 132,28,100
MAA 136,32,100
MAA 136,12,96
s_waitcnt vmcnt(17) lgkmcnt(5)
s_barrier
MAA 76,104,0
RD 60,30,18496
s_add_u32 m0, s56, 123648
MAA 76,108,20
buffer_load_dwordx4 v18, s[20:23], s54 offen lds
MAA 80,108,24
RD 64,30,20800
s_waitcnt vmcnt(14)
v_add_f32 v164, v164, v192
MAA 80,104,4
RD 68,30,23104
v_add_f32 v165, v165, v193
MAA 84,104,8
RD 72,30,25408
v_add_f32 v166, v166, v194
MAA 84,108,28
RD 76,31,18496
v_add_f32 v167, v167, v195
MAA 88,108,32
ds_read_b64_tr_b16 a[80:81], v25
MAA 88,104,12
TR 82,25,512
MAA 160,112,16
TR 84,25,12416
MAA 160,116,36
buffer_load_dwordx4 v19, s[20:23], s54 offen offset:1024 lds
MAA 120,116,32
TR 86,25,12928
MAA 120,112,12
TR 88,25,1024
MAA 116,112,8
TR 90,25,1536
MAA 116,116,28
TR 92,25,13440
MAA 112,116,24
TR 94,25,13952
MAA 112,112,4
TR 96,25,2048
MAA 108,112,0
TR 98,25,2560
MAA 108,116,20
buffer_load_dwordx4 v20, s[20:23], s54 offen offset:2048 lds
MAA 140,20,124
TR 100,25,14464
s_add_u32 s54, s54, 196608
MAA 140,0,120
TR 102,25,14976
MAA 144,4,120
MAA 144,24,124
MAA 148,28,124
MAA 148,8,120
MAA 152,12,120
MAA 152,32,124
s_waitcnt lgkmcnt(8)
s_barrier
MAA 60,80,40
TR 104,25,32
s_add_u32 m0, s56, 136064
MAA 60,84,60
buffer_load_dwordx4 v18, s[20:23], s54 offen lds
MAA 64,84,64
TR 106,25,544
MAA 64,80,44
TR 108,25,12448
MAA 68,80,48
buffer_load_dwordx4 v19, s[20:23], s54 offen offset:1024 lds
MAA 68,84,68
TR 110,25,12960
MAA 72,84,72
TR 112,25,1056
MAA 72,80,52
buffer_load_dwordx4 v20, s[20:23], s54 offen offset:2048 lds
s_waitcnt lgkmcnt(5)
MAA 244,80,56
TR 114,25,1568
s_add_u32 s54, s54, 196608
MAA 244,84,76
TR 116,25,13472
s_add_u32 m0, s59, 16640
MAA 156,92,76
TR 118,25,13984
s_xor_b32 s58, s87, 1310720
MAA 156,88,56
buffer_load_dwordx4 v5, s[24:27], s58 offen lds
MAA 104,88,52
TR 120,25,2080
MAA 104,92,72
TR 122,25,2592
MAA 100,92,68
buffer_load_dwordx4 v6, s[24:27], s58 offen offset:1024 lds
MAA 100,88,48
TR 124,25,14496
s_add_u32 m0, s59, 24960
MAA 96,88,44
TR 126,25,15008
s_xor_b32 s58, s87, 1441792
MAA 96,92,64
buffer_load_dwordx4 v5, s[24:27], s58 offen lds
MAA 92,92,60
RD 0,23,36992
MAA 92,88,40
RD 4,23,39296
MAA 124,40,96
buffer_load_dwordx4 v6, s[24:27], s58 offen offset:1024 lds
MAA 124,60,100
RD 8,23,41600
MAA 128,64,100
RD 12,23,43904
MAA 128,44,96
RD 16,24,36992
MAA 132,48,96
v_permlane32_swap_b32 v164, v166
MAA 132,68,100
v_permlane32_swap_b32 v165, v167
MAA 136,72,100
v_add_f32 v164, v164, v166
v_add_f32 v165, v165, v167
MAA 136,52,96
v_mul_f32 v164, 0xba800000, v164
v_mul_f32 v165, 0x3a800000, v165
v_fma_f32 v165, -v164, v164, v165
v_max_f32 v165, 0, v165
v_add_f32 v165, 0x3727c5ac, v165
v_rsq_f32 v166, v165
s_nop 0
v_mov_b32 v165, v166
v_mul_f32 v166, 0x3e8293ee, v166
s_waitcnt vmcnt(14) lgkmcnt(5)
s_barrier
MAA 76,104,40
ds_write_b128 v7, v[164:167]
s_add_u32 m0, s59, 74880
MAA 76,108,60
ds_write_b32 v17, v164
s_xor_b32 s58, s87, 131072
MAA 80,108,64
ds_write_b32 v17, v165 offset:1024
MAA 80,104,44
buffer_load_dwordx4 v5, s[24:27], s58 offen lds
MAA 84,104,48
RD 20,30,36992
MAA 84,108,68
RD 24,30,39296
MAA 88,108,72
RD 28,30,41600
MAA 88,104,52
RD 32,30,43904
MAA 160,112,56
RD 36,31,36992
MAA 160,116,76
buffer_load_dwordx4 v6, s[24:27], s58 offen offset:1024 lds
MAA 120,116,72
TR 80,25,24832
s_add_u32 m0, s59, 83200
MAA 120,112,52
TR 82,25,25344
s_xor_b32 s58, s87, 262144
MAA 116,112,48
TR 84,25,37248
MAA 116,116,68
TR 86,25,37760
MAA 112,116,64
TR 88,25,25856
MAA 112,112,44
buffer_load_dwordx4 v5, s[24:27], s58 offen lds
MAA 108,112,40
TR 90,25,26368
MAA 108,116,60
TR 92,25,38272
MAA 140,60,124
TR 94,25,38784
MAA 140,40,120
TR 96,25,26880
MAA 144,44,120
TR 98,25,27392
MAA 144,64,124
buffer_load_dwordx4 v6, s[24:27], s58 offen offset:1024 lds
MAA 148,68,124
TR 100,25,39296
MAA 148,48,120
TR 102,25,39808
MAA 152,52,120
MAA 152,72,124
s_waitcnt vmcnt(8) lgkmcnt(0)
s_barrier
MAA 156,88,16
TR 112,25,25888
s_add_u32 m0, s59, 33280
MAA 156,92,36
TR 114,25,26400
s_xor_b32 s58, s87, 1572864
MAA 104,92,32
buffer_load_dwordx4 v5, s[24:27], s58 offen lds
MAA 104,88,12
TR 116,25,38304
MAA 100,88,8
TR 118,25,38816
MAA 100,92,28
TR 120,25,26912
MAA 96,92,24
buffer_load_dwordx4 v6, s[24:27], s58 offen offset:1024 lds
MAA 96,88,4
TR 122,25,27424
s_add_u32 m0, s59, 41600
MAA 92,88,0
TR 124,25,39328
s_xor_b32 s58, s87, 1703936
MAA 92,92,20
TR 126,25,39840
MAA 136,32,100
buffer_load_dwordx4 v5, s[24:27], s58 offen lds
MAA 136,12,96
TR 104,25,24864
MAA 244,80,16
TR 106,25,25376
MAA 244,84,36
TR 108,25,37280
MAA 72,84,32
buffer_load_dwordx4 v6, s[24:27], s58 offen offset:1024 lds
MAA 72,80,12
TR 110,25,37792
MAA 68,80,8
RD 40,23,55488
MAA 68,84,28
RD 44,23,57792
MAA 64,84,24
RD 48,23,60096
MAA 64,80,4
RD 52,23,62400
MAA 60,80,0
RD 56,24,55488
MAA 60,84,20
RD 60,30,55488
s_waitcnt lgkmcnt(15)
MAA 160,112,16
RD 64,30,57792
s_waitcnt lgkmcnt(15)
MAA 160,116,36
s_waitcnt lgkmcnt(7)
s_barrier
RD 68,30,60096
MAA 120,116,32
RD 72,30,62400
s_add_u32 m0, s59, 91520
MAA 120,112,12
RD 76,31,55488
s_xor_b32 s58, s87, 393216
MAA 116,112,8
TR 144,25,50688
MAA 116,116,28
TR 146,25,51200
MAA 112,116,24
TR 148,25,63104
MAA 112,112,4
TR 150,25,63616
MAA 108,112,0
TR 152,25,50720
MAA 108,116,20
TR 154,25,51232
MAA 152,32,124
TR 156,25,63136
MAA 152,12,120
TR 158,25,63648
MAA 88,104,12
TR 160,25,51712
MAA 88,108,32
TR 162,25,52224
MAA 84,108,28
TR 164,25,64128
MAA 84,104,8
TR 166,25,64640
MAA 80,104,4
TR 168,25,51744
MAA 80,108,24
TR 170,25,52256
MAA 76,108,20
TR 172,25,64160
MAA 76,104,0
TR 174,25,64672
s_waitcnt lgkmcnt(14)
MAA 156,144,56
TR 128,25,49664
s_waitcnt lgkmcnt(13)
MAA 156,148,76
TR 130,25,50176
MAA 104,148,72
TR 132,25,62080
MAA 104,144,52
TR 134,25,62592
MAA 100,144,48
TR 136,25,49696
MAA 100,148,68
TR 138,25,50208
MAA 96,148,64
TR 140,25,62112
MAA 96,144,44
TR 142,25,62624
MAA 92,144,40
ds_read_b128 v[232:235], v10 offset:768
MAA 92,148,60
ds_read_b128 v[236:239], v10 offset:2816
s_waitcnt lgkmcnt(15)
MAA 160,156,76
ds_read_b128 v[228:231], v10 offset:512
MAA 160,152,56
ds_read_b128 v[224:227], v10 offset:256
MAA 120,152,52
ds_read_b128 v[220:223], v10
MAA 120,156,72
buffer_load_dwordx4 v5, s[24:27], s58 offen lds
MAA 116,156,68
MAA 116,152,48
MAA 112,152,44
MAA 112,156,64
buffer_load_dwordx4 v6, s[24:27], s58 offen offset:1024 lds
MAA 108,156,60
s_add_u32 m0, s59, 99840
s_xor_b32 s58, s87, 524288
MAA 108,152,40
MAA 136,52,160
s_waitcnt lgkmcnt(15)
MAA 136,72,164
buffer_load_dwordx4 v5, s[24:27], s58 offen lds
s_waitcnt lgkmcnt(13)
MAA 152,72,172
MAA 152,52,168
s_waitcnt lgkmcnt(11)
MAA 244,128,56
s_waitcnt lgkmcnt(9)
MAA 244,132,76
buffer_load_dwordx4 v6, s[24:27], s58 offen offset:1024 lds
MAA 72,132,72
s_add_u32 m0, s59, 108160
s_xor_b32 s58, s87, 655360
MAA 72,128,52
MAA 68,128,48
MAA 68,132,68
buffer_load_dwordx4 v5, s[24:27], s58 offen lds
buffer_load_dwordx4 v6, s[24:27], s58 offen offset:1024 lds
s_mov_b32 exec_lo, 0x10001
s_mov_b32 exec_hi, 0x10001
ds_write_b128 v13, v[244:247]
ds_write_b128 v13, v[156:159] offset:256
ds_write_b128 v13, v[160:163] offset:320
s_mov_b64 exec, -1
MAA 64,128,44
MAA 64,132,64
MAA 60,132,60
MAA 60,128,40
s_waitcnt lgkmcnt(10)
MAA 88,136,52
s_waitcnt lgkmcnt(8)
MAA 88,140,72
s_waitcnt lgkmcnt(0)
s_barrier
MAA 84,136,48
ds_read_b128 v[28:31], v13
MAA 84,140,68
ds_read_b128 v[32:35], v13 offset:64
MAA 80,140,64
ds_read_b128 v[36:39], v13 offset:256
MAA 80,136,44
ds_read_b128 v[40:43], v13 offset:320
MAA 76,136,40
ds_read_b32 v44, v12 offset:512
MAA 76,140,60
ds_read_b32 v45, v12 offset:576
ds_read_b128 v[240:243], v11 offset:192
ds_read_b128 v[244:247], v11 offset:1216
ds_read_b128 v[18:21], v11 offset:128
ds_read_b128 v[22:25], v11 offset:1152
s_waitcnt lgkmcnt(9)
v_pk_fma_f32 v[72:73], v[28:29], v[232:233], v[72:73] op_sel_hi:[1,0,1]
v_cvt_pk_bf16_f32 v176, v72, v73
v_pk_fma_f32 v[74:75], v[30:31], v[232:233], v[74:75] op_sel_hi:[1,0,1]
v_cvt_pk_bf16_f32 v177, v74, v75
s_waitcnt lgkmcnt(8)
v_pk_fma_f32 v[88:89], v[32:33], v[232:233], v[88:89] op_sel_hi:[1,0,1]
v_cvt_pk_bf16_f32 v178, v88, v89
v_pk_fma_f32 v[90:91], v[34:35], v[232:233], v[90:91] op_sel_hi:[1,0,1]
v_cvt_pk_bf16_f32 v179, v90, v91
s_waitcnt lgkmcnt(7)
v_pk_fma_f32 v[104:105], v[36:37], v[232:233], v[104:105] op_sel_hi:[1,0,1]
v_pk_mul_f32 v[104:105], v[104:105], v[232:233] op_sel:[0,1] op_sel_hi:[1,1]
v_cvt_pk_bf16_f32 v196, v104, v105
v_pk_fma_f32 v[106:107], v[38:39], v[232:233], v[106:107] op_sel_hi:[1,0,1]
v_pk_mul_f32 v[106:107], v[106:107], v[232:233] op_sel:[0,1] op_sel_hi:[1,1]
v_cvt_pk_bf16_f32 v197, v106, v107
s_waitcnt lgkmcnt(6)
v_pk_fma_f32 v[120:121], v[40:41], v[232:233], v[120:121] op_sel_hi:[1,0,1]
v_pk_mul_f32 v[120:121], v[120:121], v[232:233] op_sel:[0,1] op_sel_hi:[1,1]
v_cvt_pk_bf16_f32 v198, v120, v121
v_pk_fma_f32 v[122:123], v[42:43], v[232:233], v[122:123] op_sel_hi:[1,0,1]
v_pk_mul_f32 v[122:123], v[122:123], v[232:233] op_sel:[0,1] op_sel_hi:[1,1]
v_cvt_pk_bf16_f32 v199, v122, v123
ds_write_b128 v8, v[196:199]
s_waitcnt lgkmcnt(4)
v_pk_fma_f32 v[136:137], v[240:241], v[44:45], v[136:137] op_sel_hi:[1,0,1]
v_pk_fma_f32 v[138:139], v[242:243], v[44:45], v[138:139] op_sel_hi:[1,0,1]
s_waitcnt lgkmcnt(3)
v_pk_mul_f32 v[136:137], v[136:137], v[244:245]
v_cvt_pk_bf16_f32 v208, v136, v137
v_pk_mul_f32 v[138:139], v[138:139], v[246:247]
v_cvt_pk_bf16_f32 v209, v138, v139
v_pk_fma_f32 v[152:153], v[240:241], v[44:45], v[152:153] op_sel:[0,1,0] op_sel_hi:[1,1,1]
v_pk_mul_f32 v[152:153], v[152:153], v[244:245]
v_cvt_pk_bf16_f32 v218, v152, v153
v_pk_fma_f32 v[154:155], v[242:243], v[44:45], v[154:155] op_sel:[0,1,0] op_sel_hi:[1,1,1]
v_pk_mul_f32 v[154:155], v[154:155], v[246:247]
v_cvt_pk_bf16_f32 v219, v154, v155
ds_write_b64 v8, v[208:209] offset:1024
ds_write_b64 v8, v[218:219] offset:1032
v_pk_fma_f32 v[156:157], v[36:37], v[236:237], v[156:157] op_sel_hi:[1,0,1]
v_pk_mul_f32 v[156:157], v[156:157], v[236:237] op_sel:[0,1] op_sel_hi:[1,1]
v_cvt_pk_bf16_f32 v180, v156, v157
v_pk_fma_f32 v[158:159], v[38:39], v[236:237], v[158:159] op_sel_hi:[1,0,1]
v_pk_mul_f32 v[158:159], v[158:159], v[236:237] op_sel:[0,1] op_sel_hi:[1,1]
v_cvt_pk_bf16_f32 v181, v158, v159
v_pk_fma_f32 v[160:161], v[40:41], v[236:237], v[160:161] op_sel_hi:[1,0,1]
v_pk_mul_f32 v[160:161], v[160:161], v[236:237] op_sel:[0,1] op_sel_hi:[1,1]
v_cvt_pk_bf16_f32 v182, v160, v161
v_pk_fma_f32 v[162:163], v[42:43], v[236:237], v[162:163] op_sel_hi:[1,0,1]
v_pk_mul_f32 v[162:163], v[162:163], v[236:237] op_sel:[0,1] op_sel_hi:[1,1]
v_cvt_pk_bf16_f32 v183, v162, v163
v_pk_fma_f32 v[100:101], v[36:37], v[228:229], v[100:101] op_sel_hi:[1,0,1]
v_pk_mul_f32 v[100:101], v[100:101], v[228:229] op_sel:[0,1] op_sel_hi:[1,1]
v_cvt_pk_bf16_f32 v192, v100, v101
v_pk_fma_f32 v[102:103], v[38:39], v[228:229], v[102:103] op_sel_hi:[1,0,1]
v_pk_mul_f32 v[102:103], v[102:103], v[228:229] op_sel:[0,1] op_sel_hi:[1,1]
v_cvt_pk_bf16_f32 v193, v102, v103
v_pk_fma_f32 v[116:117], v[40:41], v[228:229], v[116:117] op_sel_hi:[1,0,1]
v_pk_mul_f32 v[116:117], v[116:117], v[228:229] op_sel:[0,1] op_sel_hi:[1,1]
v_cvt_pk_bf16_f32 v194, v116, v117
v_pk_fma_f32 v[118:119], v[42:43], v[228:229], v[118:119] op_sel_hi:[1,0,1]
v_pk_mul_f32 v[118:119], v[118:119], v[228:229] op_sel:[0,1] op_sel_hi:[1,1]
s_waitcnt lgkmcnt(0)
s_barrier
v_cvt_pk_bf16_f32 v195, v118, v119
v_pk_fma_f32 v[96:97], v[36:37], v[224:225], v[96:97] op_sel_hi:[1,0,1]
v_pk_mul_f32 v[96:97], v[96:97], v[224:225] op_sel:[0,1] op_sel_hi:[1,1]
v_cvt_pk_bf16_f32 v188, v96, v97
v_pk_fma_f32 v[98:99], v[38:39], v[224:225], v[98:99] op_sel_hi:[1,0,1]
v_pk_mul_f32 v[98:99], v[98:99], v[224:225] op_sel:[0,1] op_sel_hi:[1,1]
v_cvt_pk_bf16_f32 v189, v98, v99
v_pk_fma_f32 v[112:113], v[40:41], v[224:225], v[112:113] op_sel_hi:[1,0,1]
v_pk_mul_f32 v[112:113], v[112:113], v[224:225] op_sel:[0,1] op_sel_hi:[1,1]
v_cvt_pk_bf16_f32 v190, v112, v113
v_pk_fma_f32 v[114:115], v[42:43], v[224:225], v[114:115] op_sel_hi:[1,0,1]
v_pk_mul_f32 v[114:115], v[114:115], v[224:225] op_sel:[0,1] op_sel_hi:[1,1]
v_cvt_pk_bf16_f32 v191, v114, v115
v_pk_fma_f32 v[92:93], v[36:37], v[220:221], v[92:93] op_sel_hi:[1,0,1]
v_pk_mul_f32 v[92:93], v[92:93], v[220:221] op_sel:[0,1] op_sel_hi:[1,1]
v_cvt_pk_bf16_f32 v184, v92, v93
v_pk_fma_f32 v[94:95], v[38:39], v[220:221], v[94:95] op_sel_hi:[1,0,1]
.Lpad4:
s_cbranch_execz .Lpad8
v_pk_mul_f32 v[94:95], v[94:95], v[220:221] op_sel:[0,1] op_sel_hi:[1,1]
v_cvt_pk_bf16_f32 v185, v94, v95
v_pk_fma_f32 v[108:109], v[40:41], v[220:221], v[108:109] op_sel_hi:[1,0,1]
v_pk_mul_f32 v[108:109], v[108:109], v[220:221] op_sel:[0,1] op_sel_hi:[1,1]
v_cvt_pk_bf16_f32 v186, v108, v109
v_pk_fma_f32 v[110:111], v[42:43], v[220:221], v[110:111] op_sel_hi:[1,0,1]
v_pk_mul_f32 v[110:111], v[110:111], v[220:221] op_sel:[0,1] op_sel_hi:[1,1]
v_cvt_pk_bf16_f32 v187, v110, v111
v_pk_fma_f32 v[68:69], v[28:29], v[228:229], v[68:69] op_sel_hi:[1,0,1]
v_cvt_pk_bf16_f32 v172, v68, v69
v_pk_fma_f32 v[70:71], v[30:31], v[228:229], v[70:71] op_sel_hi:[1,0,1]
v_cvt_pk_bf16_f32 v173, v70, v71
v_pk_fma_f32 v[84:85], v[32:33], v[228:229], v[84:85] op_sel_hi:[1,0,1]
v_cvt_pk_bf16_f32 v174, v84, v85
v_pk_fma_f32 v[86:87], v[34:35], v[228:229], v[86:87] op_sel_hi:[1,0,1]
v_cvt_pk_bf16_f32 v175, v86, v87
v_pk_fma_f32 v[64:65], v[28:29], v[224:225], v[64:65] op_sel_hi:[1,0,1]
v_cvt_pk_bf16_f32 v168, v64, v65
v_pk_fma_f32 v[66:67], v[30:31], v[224:225], v[66:67] op_sel_hi:[1,0,1]
v_cvt_pk_bf16_f32 v169, v66, v67
v_pk_fma_f32 v[80:81], v[32:33], v[224:225], v[80:81] op_sel_hi:[1,0,1]
v_cvt_pk_bf16_f32 v170, v80, v81
v_pk_fma_f32 v[82:83], v[34:35], v[224:225], v[82:83] op_sel_hi:[1,0,1]
v_cvt_pk_bf16_f32 v171, v82, v83
v_pk_fma_f32 v[60:61], v[28:29], v[220:221], v[60:61] op_sel_hi:[1,0,1]
v_cvt_pk_bf16_f32 v164, v60, v61
v_pk_fma_f32 v[62:63], v[30:31], v[220:221], v[62:63] op_sel_hi:[1,0,1]
v_cvt_pk_bf16_f32 v165, v62, v63
v_pk_fma_f32 v[76:77], v[32:33], v[220:221], v[76:77] op_sel_hi:[1,0,1]
v_cvt_pk_bf16_f32 v166, v76, v77
v_pk_fma_f32 v[78:79], v[34:35], v[220:221], v[78:79] op_sel_hi:[1,0,1]
v_cvt_pk_bf16_f32 v167, v78, v79
s_nop 0
v_mfma_f32_16x16x32_bf16 v[120:123], v[196:199], v[176:179], v[50:53]
ds_read_b64 v[200:201], v9 offset:1024
v_mfma_f32_16x16x32_bf16 v[104:107], v[192:195], v[176:179], v[46:49]
ds_read_b64 v[210:211], v9 offset:1032
v_mfma_f32_16x16x32_bf16 v[116:119], v[192:195], v[172:175], v[50:53]
ds_read_b128 v[240:243], v11 offset:64
v_mfma_f32_16x16x32_bf16 v[100:103], v[188:191], v[172:175], v[46:49]
ds_read_b128 v[244:247], v11 offset:1088
v_mfma_f32_16x16x32_bf16 v[112:115], v[188:191], v[168:171], v[50:53]
ds_read_b128 v[28:31], v11
v_mfma_f32_16x16x32_bf16 v[96:99], v[184:187], v[168:171], v[46:49]
ds_read_b128 v[32:35], v11 offset:1024
v_max3_f32 v88, v104, v105, v106
v_mfma_f32_16x16x32_bf16 v[108:111], v[184:187], v[164:167], v[50:53]
v_max3_f32 v89, v107, v120, v121
v_max3_f32 v88, v88, v122, v123
v_mfma_f32_16x16x32_bf16 v[92:95], v[180:183], v[164:167], v[54:57]
v_max_f32 v90, v88, v89
v_max_f32 v89, v88, v89
MAA 132,8,96
s_nop 0
v_permlane16_swap_b32 v90, v89
MAA 132,28,100
v_max_f32 v88, v90, v89
v_max_f32 v89, v90, v89
MAA 132,48,160
s_nop 0
v_permlane32_swap_b32 v88, v89
MAA 132,68,164
v_max_f32 v88, v88, v89
v_mul_f32 v88, v88, v234
MAA 148,68,172
v_max3_f32 v84, v100, v101, v102
v_max3_f32 v85, v103, v116, v117
MAA 148,48,168
v_max3_f32 v84, v84, v118, v119
v_max_f32 v86, v84, v85
MAA 148,28,124
v_max_f32 v85, v84, v85
v_max3_f32 v80, v96, v97, v98
MAA 148,8,120
v_permlane16_swap_b32 v86, v85
v_max3_f32 v81, v99, v112, v113
v_max_f32 v84, v86, v85
v_max_f32 v85, v86, v85
v_max3_f32 v80, v80, v114, v115
v_max_f32 v82, v80, v81
v_permlane32_swap_b32 v84, v85
v_max_f32 v81, v80, v81
v_max_f32 v84, v84, v85
v_mul_f32 v84, v84, v230
v_permlane16_swap_b32 v82, v81
v_max3_f32 v76, v92, v93, v94
v_max_f32 v80, v82, v81
v_max_f32 v81, v82, v81
v_max3_f32 v77, v95, v108, v109
v_max3_f32 v76, v76, v110, v111
v_permlane32_swap_b32 v80, v81
v_max_f32 v78, v76, v77
v_max_f32 v80, v80, v81
v_mul_f32 v80, v80, v226
v_max_f32 v77, v76, v77
v_pk_fma_f32 v[104:105], v[104:105], v[234:235], v[88:89] op_sel_hi:[1,0,0] neg_lo:[0,0,1] neg_hi:[0,0,1]
v_pk_fma_f32 v[106:107], v[106:107], v[234:235], v[88:89] op_sel_hi:[1,0,0] neg_lo:[0,0,1] neg_hi:[0,0,1]
v_permlane16_swap_b32 v78, v77
v_pk_fma_f32 v[120:121], v[120:121], v[234:235], v[88:89] op_sel_hi:[1,0,0] neg_lo:[0,0,1] neg_hi:[0,0,1]
v_max_f32 v76, v78, v77
v_max_f32 v77, v78, v77
v_pk_fma_f32 v[122:123], v[122:123], v[234:235], v[88:89] op_sel_hi:[1,0,0] neg_lo:[0,0,1] neg_hi:[0,0,1]
v_pk_fma_f32 v[100:101], v[100:101], v[230:231], v[84:85] op_sel_hi:[1,0,0] neg_lo:[0,0,1] neg_hi:[0,0,1]
v_permlane32_swap_b32 v76, v77
v_pk_fma_f32 v[102:103], v[102:103], v[230:231], v[84:85] op_sel_hi:[1,0,0] neg_lo:[0,0,1] neg_hi:[0,0,1]
v_max_f32 v76, v76, v77
v_mul_f32 v76, v76, v222
v_pk_fma_f32 v[116:117], v[116:117], v[230:231], v[84:85] op_sel_hi:[1,0,0] neg_lo:[0,0,1] neg_hi:[0,0,1]
v_pk_fma_f32 v[118:119], v[118:119], v[230:231], v[84:85] op_sel_hi:[1,0,0] neg_lo:[0,0,1] neg_hi:[0,0,1]
v_pk_fma_f32 v[96:97], v[96:97], v[226:227], v[80:81] op_sel_hi:[1,0,0] neg_lo:[0,0,1] neg_hi:[0,0,1]
v_pk_fma_f32 v[98:99], v[98:99], v[226:227], v[80:81] op_sel_hi:[1,0,0] neg_lo:[0,0,1] neg_hi:[0,0,1]
v_pk_fma_f32 v[112:113], v[112:113], v[226:227], v[80:81] op_sel_hi:[1,0,0] neg_lo:[0,0,1] neg_hi:[0,0,1]
v_pk_fma_f32 v[114:115], v[114:115], v[226:227], v[80:81] op_sel_hi:[1,0,0] neg_lo:[0,0,1] neg_hi:[0,0,1]
v_pk_fma_f32 v[92:93], v[92:93], v[222:223], v[76:77] op_sel_hi:[1,0,0] neg_lo:[0,0,1] neg_hi:[0,0,1]
v_pk_fma_f32 v[94:95], v[94:95], v[222:223], v[76:77] op_sel_hi:[1,0,0] neg_lo:[0,0,1] neg_hi:[0,0,1]
v_pk_fma_f32 v[108:109], v[108:109], v[222:223], v[76:77] op_sel_hi:[1,0,0] neg_lo:[0,0,1] neg_hi:[0,0,1]
v_pk_fma_f32 v[110:111], v[110:111], v[222:223], v[76:77] op_sel_hi:[1,0,0] neg_lo:[0,0,1] neg_hi:[0,0,1]
v_pk_fma_f32 v[132:133], v[18:19], v[44:45], v[132:133] op_sel_hi:[1,0,1]
v_pk_mul_f32 v[132:133], v[132:133], v[22:23]
v_pk_fma_f32 v[134:135], v[20:21], v[44:45], v[134:135] op_sel_hi:[1,0,1]
v_pk_mul_f32 v[134:135], v[134:135], v[24:25]
v_pk_fma_f32 v[148:149], v[18:19], v[44:45], v[148:149] op_sel:[0,1,0] op_sel_hi:[1,1,1]
v_pk_mul_f32 v[148:149], v[148:149], v[22:23]
v_pk_fma_f32 v[150:151], v[20:21], v[44:45], v[150:151] op_sel:[0,1,0] op_sel_hi:[1,1,1]
v_pk_mul_f32 v[150:151], v[150:151], v[24:25]
v_exp_f32 v104, v104
s_nop 0
MAA 128,4,96
v_exp_f32 v105, v105
MAA 128,24,100
v_exp_f32 v106, v106
MAA 128,44,160
v_exp_f32 v107, v107
MAA 128,64,164
v_exp_f32 v120, v120
MAA 144,64,172
v_exp_f32 v121, v121
MAA 144,44,168
v_exp_f32 v122, v122
MAA 144,24,124
v_exp_f32 v123, v123
MAA 144,4,120
v_exp_f32 v100, v100
MAA 124,0,96
v_exp_f32 v101, v101
MAA 124,20,100
v_exp_f32 v102, v102
MAA 124,40,160
v_exp_f32 v103, v103
MAA 124,60,164
v_exp_f32 v116, v116
MAA 140,60,172
v_exp_f32 v117, v117
MAA 140,40,168
v_exp_f32 v118, v118
MAA 140,20,124
v_exp_f32 v119, v119
MAA 140,0,120
v_cvt_pk_bf16_f32 v72, v104, v105
v_cvt_pk_bf16_f32 v73, v106, v107
v_cvt_pk_bf16_f32 v74, v120, v121
v_cvt_pk_bf16_f32 v75, v122, v123
v_cvt_pk_bf16_f32 v68, v100, v101
v_cvt_pk_bf16_f32 v69, v102, v103
v_cvt_pk_bf16_f32 v70, v116, v117
v_cvt_pk_bf16_f32 v71, v118, v119
v_exp_f32 v96, v96
v_exp_f32 v97, v97
v_exp_f32 v98, v98
v_exp_f32 v99, v99
v_exp_f32 v112, v112
v_exp_f32 v113, v113
v_exp_f32 v114, v114
v_exp_f32 v115, v115
v_cvt_pk_bf16_f32 v64, v96, v97
v_cvt_pk_bf16_f32 v65, v98, v99
v_cvt_pk_bf16_f32 v66, v112, v113
v_cvt_pk_bf16_f32 v67, v114, v115
v_cvt_pk_bf16_f32 v206, v132, v133
v_cvt_pk_bf16_f32 v207, v134, v135
v_cvt_pk_bf16_f32 v216, v148, v149
v_cvt_pk_bf16_f32 v217, v150, v151
s_waitcnt lgkmcnt(3)
v_pk_fma_f32 v[128:129], v[240:241], v[44:45], v[128:129] op_sel_hi:[1,0,1]
s_waitcnt lgkmcnt(2)
v_pk_mul_f32 v[128:129], v[128:129], v[244:245]
v_cvt_pk_bf16_f32 v204, v128, v129
v_pk_fma_f32 v[130:131], v[242:243], v[44:45], v[130:131] op_sel_hi:[1,0,1]
v_pk_mul_f32 v[130:131], v[130:131], v[246:247]
v_cvt_pk_bf16_f32 v205, v130, v131
v_pk_fma_f32 v[144:145], v[240:241], v[44:45], v[144:145] op_sel:[0,1,0] op_sel_hi:[1,1,1]
v_pk_mul_f32 v[144:145], v[144:145], v[244:245]
v_cvt_pk_bf16_f32 v214, v144, v145
v_pk_fma_f32 v[146:147], v[242:243], v[44:45], v[146:147] op_sel:[0,1,0] op_sel_hi:[1,1,1]
v_pk_mul_f32 v[146:147], v[146:147], v[246:247]
v_cvt_pk_bf16_f32 v215, v146, v147
s_waitcnt lgkmcnt(1)
v_pk_fma_f32 v[124:125], v[28:29], v[44:45], v[124:125] op_sel_hi:[1,0,1]
s_waitcnt lgkmcnt(0)
v_pk_mul_f32 v[124:125], v[124:125], v[32:33]
v_cvt_pk_bf16_f32 v202, v124, v125
v_pk_fma_f32 v[126:127], v[30:31], v[44:45], v[126:127] op_sel_hi:[1,0,1]
v_pk_mul_f32 v[126:127], v[126:127], v[34:35]
v_cvt_pk_bf16_f32 v203, v126, v127
v_pk_fma_f32 v[140:141], v[28:29], v[44:45], v[140:141] op_sel:[0,1,0] op_sel_hi:[1,1,1]
v_pk_mul_f32 v[140:141], v[140:141], v[32:33]
v_cvt_pk_bf16_f32 v212, v140, v141
v_pk_fma_f32 v[142:143], v[30:31], v[44:45], v[142:143] op_sel:[0,1,0] op_sel_hi:[1,1,1]
v_pk_mul_f32 v[142:143], v[142:143], v[34:35]
v_cvt_pk_bf16_f32 v213, v142, v143
s_nop 0
v_mfma_f32_16x16x32_bf16 v[88:91], v[248:251], v[72:75], 0
v_exp_f32 v92, v92
v_mfma_f32_16x16x32_bf16 v[104:107], v[206:209], v[72:75], 0
v_exp_f32 v93, v93
v_mfma_f32_16x16x32_bf16 v[120:123], v[216:219], v[72:75], 0
v_exp_f32 v94, v94
v_mfma_f32_16x16x32_bf16 v[84:87], v[248:251], v[68:71], 0
v_exp_f32 v95, v95
v_mfma_f32_16x16x32_bf16 v[100:103], v[204:207], v[68:71], 0
v_exp_f32 v108, v108
v_mfma_f32_16x16x32_bf16 v[116:119], v[214:217], v[68:71], 0
v_exp_f32 v109, v109
v_mfma_f32_16x16x32_bf16 v[80:83], v[248:251], v[64:67], 0
v_exp_f32 v110, v110
v_mfma_f32_16x16x32_bf16 v[96:99], v[202:205], v[64:67], 0
v_exp_f32 v111, v111
v_mfma_f32_16x16x32_bf16 v[112:115], v[212:215], v[64:67], 0
v_cvt_pk_bf16_f32 v60, v92, v93
v_cvt_pk_bf16_f32 v61, v94, v95
v_cvt_pk_bf16_f32 v62, v108, v109
v_cvt_pk_bf16_f32 v63, v110, v111
v_rcp_f32 v88, v88
v_rcp_f32 v84, v84
v_mfma_f32_16x16x32_bf16 v[76:79], v[248:251], v[60:63], 0
v_rcp_f32 v80, v80
v_mfma_f32_16x16x32_bf16 v[92:95], v[200:203], v[60:63], 0
v_mfma_f32_16x16x32_bf16 v[108:111], v[210:213], v[60:63], 0
s_nop 4
v_rcp_f32 v76, v76
v_pk_mul_f32 v[104:105], v[104:105], v[88:89] op_sel_hi:[1,0]
v_pk_mul_f32 v[106:107], v[106:107], v[88:89] op_sel_hi:[1,0]
v_pk_mul_f32 v[120:121], v[120:121], v[88:89] op_sel_hi:[1,0]
v_pk_mul_f32 v[122:123], v[122:123], v[88:89] op_sel_hi:[1,0]
v_cvt_pk_bf16_f32 v176, v104, v105
v_cvt_pk_bf16_f32 v177, v106, v107
v_cvt_pk_bf16_f32 v178, v120, v121
v_cvt_pk_bf16_f32 v179, v122, v123
buffer_store_dwordx4 v[176:179], v4, s[16:19], s74 offen offset:3072 sc1
v_pk_mul_f32 v[100:101], v[100:101], v[84:85] op_sel_hi:[1,0]
v_pk_mul_f32 v[102:103], v[102:103], v[84:85] op_sel_hi:[1,0]
v_pk_mul_f32 v[116:117], v[116:117], v[84:85] op_sel_hi:[1,0]
v_pk_mul_f32 v[118:119], v[118:119], v[84:85] op_sel_hi:[1,0]
v_cvt_pk_bf16_f32 v172, v100, v101
v_cvt_pk_bf16_f32 v173, v102, v103
v_cvt_pk_bf16_f32 v174, v116, v117
v_cvt_pk_bf16_f32 v175, v118, v119
buffer_store_dwordx4 v[172:175], v4, s[16:19], s74 offen offset:2048 sc1
v_pk_mul_f32 v[96:97], v[96:97], v[80:81] op_sel_hi:[1,0]
v_pk_mul_f32 v[98:99], v[98:99], v[80:81] op_sel_hi:[1,0]
v_pk_mul_f32 v[112:113], v[112:113], v[80:81] op_sel_hi:[1,0]
v_pk_mul_f32 v[114:115], v[114:115], v[80:81] op_sel_hi:[1,0]
v_cvt_pk_bf16_f32 v168, v96, v97
v_cvt_pk_bf16_f32 v169, v98, v99
v_cvt_pk_bf16_f32 v170, v112, v113
v_cvt_pk_bf16_f32 v171, v114, v115
buffer_store_dwordx4 v[168:171], v4, s[16:19], s74 offen offset:1024 sc1
v_pk_mul_f32 v[92:93], v[92:93], v[76:77] op_sel_hi:[1,0]
v_pk_mul_f32 v[94:95], v[94:95], v[76:77] op_sel_hi:[1,0]
v_pk_mul_f32 v[108:109], v[108:109], v[76:77] op_sel_hi:[1,0]
v_pk_mul_f32 v[110:111], v[110:111], v[76:77] op_sel_hi:[1,0]
v_cvt_pk_bf16_f32 v164, v92, v93
v_cvt_pk_bf16_f32 v165, v94, v95
v_cvt_pk_bf16_f32 v166, v108, v109
v_cvt_pk_bf16_f32 v167, v110, v111
buffer_store_dwordx4 v[164:167], v4, s[16:19], s74 offen sc1
s_nop 1
s_branch .Lqkve2
.Lx4:
buffer_load_dword v27, v14, s[76:79], 0 offen
s_mov_b32 s76, s98
s_mov_b32 s77, s99
s_mov_b32 s78, s100
v_mov_b32 v14, v15
s_mov_b32 s47, 5
s_branch .Lx4b
.Lx5:
buffer_load_dword v27, v14, s[76:79], 0 offen
s_mov_b32 s76, s98
s_mov_b32 s77, s99
s_mov_b32 s78, s100
v_mov_b32 v14, v15
s_mov_b32 s47, 5
s_branch .Lx5b
.Lx6:
buffer_load_dword v27, v14, s[76:79], 0 offen
s_mov_b32 s76, s98
s_mov_b32 s77, s99
s_mov_b32 s78, s100
v_mov_b32 v14, v15
s_mov_b32 s47, 5
s_branch .Lx6b
.Lx7:
buffer_load_dword v27, v14, s[76:79], 0 offen
s_mov_b32 s76, s98
s_mov_b32 s77, s99
s_mov_b32 s78, s100
v_mov_b32 v14, v15
s_mov_b32 s47, 5
s_branch .Lx7b
.Lsp8:
s_mov_b32 s15, 0
.Lsp8l:
v_mov_b32 v37, 0
buffer_atomic_add v37, v34, s[40:43], 0 offen sc0
s_add_u32 s15, s15, 1
s_cmp_gt_u32 s15, 100000
s_waitcnt vmcnt(0)
s_cbranch_scc1 .Lsp8b
v_cmp_gt_u32 vcc, v35, v37
s_nop 0
s_cbranch_vccnz .Lsp8l
s_branch .Lsp8b
.Lx9:
buffer_load_dword v27, v14, s[76:79], 0 offen
s_mov_b32 s76, s98
s_mov_b32 s77, s99
s_mov_b32 s78, s100
v_mov_b32 v14, v15
s_mov_b32 s47, 5
s_branch .Lx9b
.Lx10:
buffer_load_dword v27, v14, s[76:79], 0 offen
s_mov_b32 s76, s98
s_mov_b32 s77, s99
s_mov_b32 s78, s100
v_mov_b32 v14, v15
s_mov_b32 s47, 5
s_branch .Lx10b
.Lx11:
buffer_load_dword v27, v14, s[76:79], 0 offen
s_mov_b32 s76, s98
s_mov_b32 s77, s99
s_mov_b32 s78, s100
v_mov_b32 v14, v15
s_mov_b32 s47, 5
s_branch .Lx11b
.Lx12:
buffer_load_dword v27, v14, s[76:79], 0 offen
s_mov_b32 s76, s98
s_mov_b32 s77, s99
s_mov_b32 s78, s100
v_mov_b32 v14, v15
s_mov_b32 s47, 5
s_branch .Lx12b
.Lsp13:
s_mov_b32 s15, 0
.Lsp13l:
v_mov_b32 v37, 0
buffer_atomic_add v37, v33, s[16:19], 0 offen sc0
s_add_u32 s15, s15, 1
s_cmp_gt_u32 s15, 100000
s_waitcnt vmcnt(0)
s_cbranch_scc1 .Lsp13b
v_cmp_gt_u32 vcc, v36, v37
s_nop 0
s_cbranch_vccnz .Lsp13l
s_branch .Lsp13b
.Lx14:
buffer_load_dword v27, v14, s[76:79], 0 offen
s_mov_b32 s76, s98
s_mov_b32 s77, s99
s_mov_b32 s78, s100
v_mov_b32 v14, v15
s_mov_b32 s47, 5
s_branch .Lx14b
.Lx15:
buffer_load_dword v27, v14, s[76:79], 0 offen
s_mov_b32 s76, s98
s_mov_b32 s77, s99
s_mov_b32 s78, s100
v_mov_b32 v14, v15
s_mov_b32 s47, 5
s_branch .Lx15b
.Lx16:
buffer_load_dword v27, v14, s[76:79], 0 offen
s_mov_b32 s76, s98
s_mov_b32 s77, s99
s_mov_b32 s78, s100
v_mov_b32 v14, v15
s_mov_b32 s47, 5
s_branch .Lx16b
.Lx17:
buffer_load_dword v27, v14, s[76:79], 0 offen
s_mov_b32 s76, s98
s_mov_b32 s77, s99
s_mov_b32 s78, s100
v_mov_b32 v14, v15
s_mov_b32 s47, 5
s_branch .Lx17b
.Lx19:
buffer_load_dword v27, v14, s[76:79], 0 offen
s_mov_b32 s76, s98
s_mov_b32 s77, s99
s_mov_b32 s78, s100
v_mov_b32 v14, v15
s_mov_b32 s47, 5
s_branch .Lx19b
.Lx20:
buffer_load_dword v27, v14, s[76:79], 0 offen
s_mov_b32 s76, s98
s_mov_b32 s77, s99
s_mov_b32 s78, s100
v_mov_b32 v14, v15
s_mov_b32 s47, 5
s_branch .Lx20b
.Lx21:
buffer_load_dword v27, v14, s[76:79], 0 offen
s_mov_b32 s76, s98
s_mov_b32 s77, s99
s_mov_b32 s78, s100
v_mov_b32 v14, v15
s_mov_b32 s47, 5
s_branch .Lx21b
.Lx22:
buffer_load_dword v27, v14, s[76:79], 0 offen
s_mov_b32 s76, s98
s_mov_b32 s77, s99
s_mov_b32 s78, s100
v_mov_b32 v14, v15
s_mov_b32 s47, 5
s_branch .Lx22b
.Lsp23:
s_mov_b32 s15, 0
.Lsp23l:
v_mov_b32 v37, 0
buffer_atomic_add v37, v34, s[40:43], 0 offen sc0
s_add_u32 s15, s15, 1
s_cmp_gt_u32 s15, 100000
s_waitcnt vmcnt(0)
s_cbranch_scc1 .Lsp23b
v_cmp_gt_u32 vcc, v35, v37
s_nop 0
s_cbranch_vccnz .Lsp23l
s_branch .Lsp23b
.Lx24:
buffer_load_dword v27, v14, s[76:79], 0 offen
s_mov_b32 s76, s98
s_mov_b32 s77, s99
s_mov_b32 s78, s100
v_mov_b32 v14, v15
s_mov_b32 s47, 5
s_branch .Lx24b
.Lx25:
buffer_load_dword v27, v14, s[76:79], 0 offen
s_mov_b32 s76, s98
s_mov_b32 s77, s99
s_mov_b32 s78, s100
v_mov_b32 v14, v15
s_mov_b32 s47, 5
s_branch .Lx25b
.Lx26:
buffer_load_dword v27, v14, s[76:79], 0 offen
s_mov_b32 s76, s98
s_mov_b32 s77, s99
s_mov_b32 s78, s100
v_mov_b32 v14, v15
s_mov_b32 s47, 5
s_branch .Lx26b
.Lx27:
buffer_load_dword v27, v14, s[76:79], 0 offen
s_mov_b32 s76, s98
s_mov_b32 s77, s99
s_mov_b32 s78, s100
v_mov_b32 v14, v15
s_mov_b32 s47, 5
s_branch .Lx27b
.Lsp28:
s_mov_b32 s15, 0
.Lsp28l:
v_mov_b32 v37, 0
buffer_atomic_add v37, v33, s[16:19], 0 offen sc0
s_add_u32 s15, s15, 1
s_cmp_gt_u32 s15, 100000
s_waitcnt vmcnt(0)
s_cbranch_scc1 .Lsp28b
v_cmp_gt_u32 vcc, v36, v37
s_nop 0
s_cbranch_vccnz .Lsp28l
s_branch .Lsp28b
.Lx29:
buffer_load_dword v27, v14, s[76:79], 0 offen
s_mov_b32 s76, s98
s_mov_b32 s77, s99
s_mov_b32 s78, s100
v_mov_b32 v14, v15
s_mov_b32 s47, 5
s_branch .Lx29b
.Lx30:
buffer_load_dword v27, v14, s[76:79], 0 offen
s_mov_b32 s76, s98
s_mov_b32 s77, s99
s_mov_b32 s78, s100
v_mov_b32 v14, v15
s_mov_b32 s47, 5
s_branch .Lx30b
.Lx31:
buffer_load_dword v27, v14, s[76:79], 0 offen
s_mov_b32 s76, s98
s_mov_b32 s77, s99
s_mov_b32 s78, s100
v_mov_b32 v14, v15
s_mov_b32 s47, 5
s_branch .Lx31b
.Lx32:
buffer_load_dword v27, v14, s[76:79], 0 offen
s_mov_b32 s76, s98
s_mov_b32 s77, s99
s_mov_b32 s78, s100
v_mov_b32 v14, v15
s_mov_b32 s47, 5
s_branch .Lx32b
.p2align 12
.Lqkv1:
.Lpad5:
s_cbranch_execz .Lpad9
s_cmp_lt_u32 s14, 16
s_cselect_b32 s62, 0, 4096
v_mov_b32 v231, 1
v_lshlrev_b32 v232, 8, v1
s_waitcnt vmcnt(16)
v_permlane16_swap_b32 v164, v166
v_permlane16_swap_b32 v165, v167
s_waitcnt vmcnt(15)
v_permlane16_swap_b32 v168, v170
v_permlane16_swap_b32 v169, v171
s_waitcnt vmcnt(14)
v_permlane16_swap_b32 v172, v174
v_permlane16_swap_b32 v173, v175
s_waitcnt vmcnt(13)
v_permlane16_swap_b32 v176, v178
v_permlane16_swap_b32 v177, v179
buffer_atomic_add v231, v232, s[40:43], s62 offen
s_add_u32 m0, s55, 18496
s_nop 0
buffer_load_dwordx4 v21, s[36:39], s52 offen lds
v_lshlrev_b32 v192, 16, v164
v_and_b32 v193, 0xffff0000, v164
v_lshlrev_b32 v194, 16, v165
v_and_b32 v195, 0xffff0000, v165
v_lshlrev_b32 v196, 16, v166
v_and_b32 v197, 0xffff0000, v166
v_lshlrev_b32 v198, 16, v167
buffer_load_dwordx4 v28, s[36:39], s52 offen offset:1024 lds
v_and_b32 v199, 0xffff0000, v167
v_lshlrev_b32 v200, 16, v168
v_and_b32 v201, 0xffff0000, v168
v_lshlrev_b32 v202, 16, v169
v_and_b32 v203, 0xffff0000, v169
v_lshlrev_b32 v204, 16, v170
v_and_b32 v205, 0xffff0000, v170
buffer_load_dword v22, s[36:39], s52 offen offset:2048 lds
s_add_u32 s52, s52, 128
v_lshlrev_b32 v206, 16, v171
v_and_b32 v207, 0xffff0000, v171
v_lshlrev_b32 v208, 16, v172
v_and_b32 v209, 0xffff0000, v172
v_lshlrev_b32 v210, 16, v173
v_and_b32 v211, 0xffff0000, v173
v_lshlrev_b32 v212, 16, v174
s_add_u32 m0, s55, 20800
s_nop 0
buffer_load_dwordx4 v21, s[36:39], s53 offen lds
v_and_b32 v213, 0xffff0000, v174
v_lshlrev_b32 v214, 16, v175
v_and_b32 v215, 0xffff0000, v175
v_lshlrev_b32 v216, 16, v176
v_and_b32 v217, 0xffff0000, v176
v_lshlrev_b32 v218, 16, v177
v_and_b32 v219, 0xffff0000, v177
buffer_load_dwordx4 v28, s[36:39], s53 offen offset:1024 lds
v_lshlrev_b32 v220, 16, v178
v_and_b32 v221, 0xffff0000, v178
v_lshlrev_b32 v222, 16, v179
v_and_b32 v223, 0xffff0000, v179
s_lshl_b32 s64, s6, 14
s_lshl_b32 s65, s49, 13
s_add_u32 s64, s64, s65
buffer_load_dword v29, s[36:39], s53 offen offset:2048 lds
s_add_u32 s53, s53, 128
s_lshl_b32 s65, s7, 9
s_add_u32 s64, s64, s65
s_lshl_b32 s65, s48, 8
s_add_u32 s64, s64, s65
s_add_u32 s64, s64, 29360128
v_and_b32 v188, 31, v1
v_lshlrev_b32 v188, 3, v188
s_add_u32 m0, s56, 73984
s_nop 0
buffer_load_dwordx4 v18, s[20:23], s54 offen lds
v_lshrrev_b32 v189, 5, v1
v_lshl_add_u32 v188, v189, 28, v188
s_lshl_b32 s62, s7, 18
s_add_u32 s62, s62, 0
s_add_u32 s63, s62, 131072
v_pk_mul_f32 v[182:183], v[192:193], v[192:193]
v_pk_mul_f32 v[186:187], v[208:209], v[208:209]
buffer_load_dwordx4 v19, s[20:23], s54 offen offset:1024 lds
v_pk_fma_f32 v[182:183], v[194:195], v[194:195], v[182:183]
v_pk_add_f32 v[180:181], v[192:193], v[194:195]
v_pk_fma_f32 v[186:187], v[210:211], v[210:211], v[186:187]
v_pk_add_f32 v[184:185], v[208:209], v[210:211]
v_pk_fma_f32 v[182:183], v[196:197], v[196:197], v[182:183]
v_pk_add_f32 v[180:181], v[180:181], v[196:197]
v_pk_fma_f32 v[186:187], v[212:213], v[212:213], v[186:187]
buffer_load_dwordx4 v20, s[20:23], s54 offen offset:2048 lds
s_add_u32 s54, s54, 196608
v_pk_add_f32 v[184:185], v[184:185], v[212:213]
v_pk_fma_f32 v[182:183], v[198:199], v[198:199], v[182:183]
v_pk_add_f32 v[180:181], v[180:181], v[198:199]
v_pk_fma_f32 v[186:187], v[214:215], v[214:215], v[186:187]
v_pk_add_f32 v[184:185], v[184:185], v[214:215]
v_pk_fma_f32 v[182:183], v[200:201], v[200:201], v[182:183]
v_pk_add_f32 v[180:181], v[180:181], v[200:201]
s_add_u32 m0, s56, 86400
s_nop 0
buffer_load_dwordx4 v18, s[20:23], s54 offen lds
v_pk_fma_f32 v[186:187], v[216:217], v[216:217], v[186:187]
v_pk_add_f32 v[184:185], v[184:185], v[216:217]
v_pk_fma_f32 v[182:183], v[202:203], v[202:203], v[182:183]
v_pk_add_f32 v[180:181], v[180:181], v[202:203]
v_pk_fma_f32 v[186:187], v[218:219], v[218:219], v[186:187]
v_pk_add_f32 v[184:185], v[184:185], v[218:219]
v_pk_fma_f32 v[182:183], v[204:205], v[204:205], v[182:183]
buffer_load_dwordx4 v19, s[20:23], s54 offen offset:1024 lds
v_pk_add_f32 v[180:181], v[180:181], v[204:205]
v_pk_fma_f32 v[186:187], v[220:221], v[220:221], v[186:187]
v_pk_add_f32 v[184:185], v[184:185], v[220:221]
v_pk_fma_f32 v[182:183], v[206:207], v[206:207], v[182:183]
v_pk_add_f32 v[180:181], v[180:181], v[206:207]
v_pk_fma_f32 v[186:187], v[222:223], v[222:223], v[186:187]
v_pk_add_f32 v[184:185], v[184:185], v[222:223]
buffer_load_dwordx4 v20, s[20:23], s54 offen offset:2048 lds
s_add_u32 s54, s54, 196608
v_add_f32 v180, v180, v181
v_add_f32 v182, v182, v183
v_add_f32 v184, v184, v185
v_add_f32 v186, v186, v187
s_nop 0
v_permlane16_swap_b32 v180, v184
v_permlane16_swap_b32 v182, v186
v_add_f32 v180, v180, v184
v_add_f32 v182, v182, v186
s_nop 1
v_permlane32_swap_b32 v180, v182
v_add_f32 v180, v180, v182
s_nop 1
v_permlane32_swap_b32 v180, v181
buffer_store_dwordx2 v[180:181], v188, s[16:19], s64 offen sc1
s_lshl_b32 s62, s2, 10
s_add_u32 s62, s62, 31457280
s_cmp_eq_u32 s3, 0
s_cselect_b32 s62, s62, 268435456
buffer_store_dwordx4 v[224:227], v230, s[16:19], s62 offen sc1
s_waitcnt vmcnt(15) lgkmcnt(0)
s_barrier
ds_read_b128 a[0:3], v23
RD 4,23,2304
RD 8,23,4608
RD 12,23,6912
ds_read_b128 a[16:19], v24
ds_read_b128 a[20:23], v30
RD 24,30,2304
RD 28,30,4608
RD 32,30,6912
ds_read_b128 a[36:39], v31
TR 80,25,49664
TR 82,25,50176
TR 84,25,62080
TR 86,25,62592
TR 88,25,50688
TR 90,25,51200
TR 92,25,63104
TR 94,25,63616
TR 96,25,51712
TR 98,25,52224
TR 100,25,64128
TR 102,25,64640
s_waitcnt vmcnt(8) lgkmcnt(0)
s_barrier
v_mfma_f32_16x16x32_bf16 v[60:63], a[80:83], a[0:3], 0
TR 104,25,49696
s_add_u32 m0, s55, 36992
MAA 60,84,20
buffer_load_dwordx4 v21, s[36:39], s52 offen lds
v_mfma_f32_16x16x32_bf16 v[64:67], a[80:83], a[4:7], 0
s_sub_u32 s47, s47, 1
s_cbranch_scc1 .Lx19
.Lx19b:
MAA 64,84,24
buffer_load_dwordx4 v28, s[36:39], s52 offen offset:1024 lds
v_mfma_f32_16x16x32_bf16 v[68:71], a[80:83], a[8:11], 0
TR 106,25,50208
MAA 68,84,28
TR 108,25,62112
TR 110,25,62624
TR 112,25,50720
v_mfma_f32_16x16x32_bf16 v[72:75], a[80:83], a[12:15], 0
TR 114,25,51232
MAA 72,84,32
TR 116,25,63136
TR 118,25,63648
v_mfma_f32_16x16x32_bf16 v[104:107], a[88:91], a[12:15], 0
TR 120,25,51744
MAA 104,92,32
buffer_load_dword v22, s[36:39], s52 offen offset:2048 lds
v_mfma_f32_16x16x32_bf16 v[100:103], a[88:91], a[8:11], 0
s_add_u32 s52, s52, 128
s_add_u32 m0, s55, 39296
MAA 100,92,28
buffer_load_dwordx4 v21, s[36:39], s53 offen lds
v_mfma_f32_16x16x32_bf16 v[96:99], a[88:91], a[4:7], 0
TR 122,25,52256
MAA 96,92,24
buffer_load_dwordx4 v28, s[36:39], s53 offen offset:1024 lds
v_mfma_f32_16x16x32_bf16 v[92:95], a[88:91], a[0:3], 0
TR 124,25,64160
MAA 92,92,20
buffer_load_dword v29, s[36:39], s53 offen offset:2048 lds
v_mfma_f32_16x16x32_bf16 v[124:127], a[0:3], a[96:99], 0
s_add_u32 s53, s53, 128
s_add_u32 m0, s56, 98816
MAA 124,20,100
buffer_load_dwordx4 v18, s[20:23], s54 offen lds
v_mfma_f32_16x16x32_bf16 v[128:131], a[4:7], a[96:99], 0
TR 126,25,64672
MAA 128,24,100
buffer_load_dwordx4 v19, s[20:23], s54 offen offset:1024 lds
v_mfma_f32_16x16x32_bf16 v[132:135], a[8:11], a[96:99], 0
RD 40,23,18496
MAA 132,28,100
RD 44,23,20800
RD 48,23,23104
RD 52,23,25408
v_mfma_f32_16x16x32_bf16 v[136:139], a[12:15], a[96:99], 0
RD 56,24,18496
MAA 136,32,100
buffer_load_dwordx4 v20, s[20:23], s54 offen offset:2048 lds
v_mfma_f32_16x16x32_bf16 v[156:159], a[16:19], a[96:99], 0
s_add_u32 s54, s54, 196608
MAA 156,36,100
s_waitcnt vmcnt(11) lgkmcnt(5)
s_barrier
v_mfma_f32_16x16x32_bf16 v[76:79], a[104:107], a[0:3], 0
RD 60,30,18496
s_add_u32 m0, s56, 111232
MAA 76,108,20
buffer_load_dwordx4 v18, s[20:23], s54 offen lds
v_mfma_f32_16x16x32_bf16 v[80:83], a[104:107], a[4:7], 0
RD 64,30,20800
MAA 80,108,24
buffer_load_dwordx4 v19, s[20:23], s54 offen offset:1024 lds
v_mfma_f32_16x16x32_bf16 v[84:87], a[104:107], a[8:11], 0
RD 68,30,23104
MAA 84,108,28
RD 72,30,25408
v_mfma_f32_16x16x32_bf16 v[88:91], a[104:107], a[12:15], 0
RD 76,31,18496
MAA 88,108,32
buffer_load_dwordx4 v20, s[20:23], s54 offen offset:2048 lds
v_mfma_f32_16x16x32_bf16 v[244:247], a[104:107], a[16:19], 0
s_add_u32 s54, s54, 196608
s_add_u32 m0, s55, 55488
MAA 244,108,36
buffer_load_dwordx4 v21, s[36:39], s52 offen lds
v_mfma_f32_16x16x32_bf16 v[120:123], a[112:115], a[12:15], 0
ds_read_b64_tr_b16 a[80:81], v25
MAA 120,116,32
TR 82,25,512
v_mfma_f32_16x16x32_bf16 v[116:119], a[112:115], a[8:11], 0
TR 84,25,12416
MAA 116,116,28
buffer_load_dwordx4 v28, s[36:39], s52 offen offset:1024 lds
v_mfma_f32_16x16x32_bf16 v[112:115], a[112:115], a[4:7], 0
TR 86,25,12928
MAA 112,116,24
buffer_load_dword v22, s[36:39], s52 offen offset:2048 lds
v_mfma_f32_16x16x32_bf16 v[108:111], a[112:115], a[0:3], 0
TR 88,25,1024
s_add_u32 s52, s52, 128
MAA 108,116,20
TR 90,25,1536
v_mfma_f32_16x16x32_bf16 v[140:143], a[0:3], a[120:123], 0
TR 92,25,13440
s_add_u32 m0, s55, 57792
MAA 140,20,124
buffer_load_dwordx4 v21, s[36:39], s53 offen lds
v_mfma_f32_16x16x32_bf16 v[144:147], a[4:7], a[120:123], 0
TR 94,25,13952
MAA 144,24,124
buffer_load_dwordx4 v28, s[36:39], s53 offen offset:1024 lds
v_mfma_f32_16x16x32_bf16 v[148:151], a[8:11], a[120:123], 0
TR 96,25,2048
MAA 148,28,124
TR 98,25,2560
v_mfma_f32_16x16x32_bf16 v[152:155], a[12:15], a[120:123], 0
TR 100,25,14464
MAA 152,32,124
buffer_load_dword v29, s[36:39], s53 offen offset:2048 lds
v_mfma_f32_16x16x32_bf16 v[160:163], a[16:19], a[120:123], 0
TR 102,25,14976
s_add_u32 s53, s53, 128
MAA 160,36,124
s_waitcnt vmcnt(12) lgkmcnt(8)
s_barrier
MAA 60,80,40
TR 104,25,32
s_add_u32 m0, s56, 123648
MAA 60,84,60
buffer_load_dwordx4 v18, s[20:23], s54 offen lds
MAA 64,84,64
s_sub_u32 s47, s47, 1
s_cbranch_scc1 .Lx20
.Lx20b:
MAA 64,80,44
buffer_load_dwordx4 v19, s[20:23], s54 offen offset:1024 lds
MAA 68,80,48
TR 106,25,544
MAA 68,84,68
TR 108,25,12448
TR 110,25,12960
TR 112,25,1056
MAA 72,84,72
TR 114,25,1568
MAA 72,80,52
TR 116,25,13472
TR 118,25,13984
s_waitcnt lgkmcnt(8)
MAA 104,88,52
TR 120,25,2080
MAA 104,92,72
buffer_load_dwordx4 v20, s[20:23], s54 offen offset:2048 lds
MAA 100,92,68
s_add_u32 s54, s54, 196608
s_add_u32 m0, s56, 136064
MAA 100,88,48
buffer_load_dwordx4 v18, s[20:23], s54 offen lds
MAA 96,88,44
TR 122,25,2592
MAA 96,92,64
buffer_load_dwordx4 v19, s[20:23], s54 offen offset:1024 lds
MAA 92,92,60
TR 124,25,14496
MAA 92,88,40
buffer_load_dwordx4 v20, s[20:23], s54 offen offset:2048 lds
MAA 124,40,96
s_add_u32 s54, s54, 196608
s_add_u32 m0, s55, 0
MAA 124,60,100
buffer_load_dwordx4 v21, s[36:39], s52 offen lds
MAA 128,64,100
TR 126,25,15008
MAA 128,44,96
buffer_load_dwordx4 v28, s[36:39], s52 offen offset:1024 lds
MAA 132,48,96
RD 0,23,36992
MAA 132,68,100
RD 4,23,39296
RD 8,23,41600
RD 12,23,43904
MAA 136,72,100
RD 16,24,36992
MAA 136,52,96
buffer_load_dword v22, s[36:39], s52 offen offset:2048 lds
MAA 156,56,96
s_add_u32 s52, s52, 128
MAA 156,76,100
s_waitcnt vmcnt(15) lgkmcnt(5)
s_barrier
MAA 76,104,40
RD 20,30,36992
s_add_u32 m0, s55, 2304
MAA 76,108,60
buffer_load_dwordx4 v21, s[36:39], s53 offen lds
MAA 80,108,64
RD 24,30,39296
MAA 80,104,44
buffer_load_dwordx4 v28, s[36:39], s53 offen offset:1024 lds
MAA 84,104,48
RD 28,30,41600
MAA 84,108,68
RD 32,30,43904
RD 36,31,36992
MAA 88,108,72
TR 80,25,24832
MAA 88,104,52
buffer_load_dword v29, s[36:39], s53 offen offset:2048 lds
MAA 244,104,56
s_add_u32 s53, s53, 128
s_add_u32 m0, s56, 73984
MAA 244,108,76
buffer_load_dwordx4 v18, s[20:23], s54 offen lds
MAA 120,116,72
TR 82,25,25344
MAA 120,112,52
buffer_load_dwordx4 v19, s[20:23], s54 offen offset:1024 lds
MAA 116,112,48
TR 84,25,37248
MAA 116,116,68
TR 86,25,37760
TR 88,25,25856
MAA 112,116,64
TR 90,25,26368
MAA 112,112,44
buffer_load_dwordx4 v20, s[20:23], s54 offen offset:2048 lds
MAA 108,112,40
s_add_u32 s54, s54, 196608
s_add_u32 m0, s55, 18496
MAA 108,116,60
buffer_load_dwordx4 v21, s[36:39], s52 offen lds
MAA 140,60,124
TR 92,25,38272
MAA 140,40,120
buffer_load_dwordx4 v28, s[36:39], s52 offen offset:1024 lds
MAA 144,44,120
TR 94,25,38784
MAA 144,64,124
buffer_load_dword v22, s[36:39], s52 offen offset:2048 lds
MAA 148,68,124
TR 96,25,26880
s_add_u32 s52, s52, 128
MAA 148,48,120
TR 98,25,27392
TR 100,25,39296
MAA 152,52,120
TR 102,25,39808
MAA 152,72,124
buffer_load_dword v37, v34, s[40:43], 0 offen sc1
MAA 160,76,124
MAA 160,56,120
s_waitcnt vmcnt(19) lgkmcnt(8)
s_barrier
MAA 60,80,0
TR 104,25,24864
s_add_u32 m0, s56, 86400
MAA 60,84,20
buffer_load_dwordx4 v18, s[20:23], s54 offen lds
MAA 64,84,24
s_sub_u32 s47, s47, 1
s_cbranch_scc1 .Lx21
.Lx21b:
MAA 64,80,4
buffer_load_dwordx4 v19, s[20:23], s54 offen offset:1024 lds
MAA 68,80,8
TR 106,25,25376
MAA 68,84,28
TR 108,25,37280
TR 110,25,37792
TR 112,25,25888
MAA 72,84,32
TR 114,25,26400
MAA 72,80,12
TR 116,25,38304
TR 118,25,38816
s_waitcnt lgkmcnt(8)
MAA 104,88,12
TR 120,25,26912
MAA 104,92,32
buffer_load_dwordx4 v20, s[20:23], s54 offen offset:2048 lds
MAA 100,92,28
s_add_u32 s54, s54, 196608
s_add_u32 m0, s55, 20800
MAA 100,88,8
buffer_load_dwordx4 v21, s[36:39], s53 offen lds
MAA 96,88,4
TR 122,25,27424
MAA 96,92,24
buffer_load_dwordx4 v28, s[36:39], s53 offen offset:1024 lds
MAA 92,92,20
TR 124,25,39328
MAA 92,88,0
buffer_load_dword v29, s[36:39], s53 offen offset:2048 lds
MAA 124,0,96
s_add_u32 s53, s53, 128
s_add_u32 m0, s55, 36992
MAA 124,20,100
buffer_load_dwordx4 v21, s[36:39], s52 offen lds
MAA 128,24,100
TR 126,25,39840
MAA 128,4,96
buffer_load_dwordx4 v28, s[36:39], s52 offen offset:1024 lds
MAA 132,8,96
RD 40,23,55488
MAA 132,28,100
RD 44,23,57792
RD 48,23,60096
RD 52,23,62400
MAA 136,32,100
RD 56,24,55488
MAA 136,12,96
buffer_load_dword v22, s[36:39], s52 offen offset:2048 lds
MAA 156,16,96
s_add_u32 s52, s52, 128
MAA 156,36,100
s_waitcnt vmcnt(22) lgkmcnt(5)
s_barrier
MAA 76,104,0
RD 60,30,55488
MAA 76,108,20
RD 64,30,57792
MAA 80,108,24
RD 68,30,60096
s_add_u32 m0, s56, 98816
MAA 80,104,4
buffer_load_dwordx4 v18, s[20:23], s54 offen lds
MAA 84,104,8
RD 72,30,62400
MAA 84,108,28
RD 76,31,55488
MAA 88,108,32
MAA 88,104,12
buffer_load_dwordx4 v19, s[20:23], s54 offen offset:1024 lds
MAA 244,104,16
TR 80,25,49664
MAA 244,108,36
TR 82,25,50176
MAA 120,116,32
TR 84,25,62080
MAA 120,112,12
buffer_load_dwordx4 v20, s[20:23], s54 offen offset:2048 lds
MAA 116,112,8
TR 86,25,62592
s_add_u32 s54, s54, 196608
MAA 116,116,28
MAA 112,116,24
TR 88,25,50688
MAA 112,112,4
TR 90,25,51200
MAA 108,112,0
TR 92,25,63104
s_add_u32 m0, s55, 39296
MAA 108,116,20
buffer_load_dwordx4 v21, s[36:39], s53 offen lds
MAA 140,20,124
TR 94,25,63616
MAA 140,0,120
MAA 144,4,120
TR 96,25,51712
MAA 144,24,124
buffer_load_dwordx4 v28, s[36:39], s53 offen offset:1024 lds
MAA 148,28,124
TR 98,25,52224
MAA 148,8,120
TR 100,25,64128
MAA 152,12,120
TR 102,25,64640
MAA 152,32,124
buffer_load_dword v29, s[36:39], s53 offen offset:2048 lds
MAA 160,36,124
s_add_u32 s53, s53, 128
MAA 160,16,120
s_waitcnt vmcnt(22) lgkmcnt(8)
s_barrier
MAA 60,80,40
TR 104,25,49696
MAA 60,84,60
TR 106,25,50208
MAA 64,84,64
TR 108,25,62112
s_add_u32 m0, s56, 111232
MAA 64,80,44
buffer_load_dwordx4 v18, s[20:23], s54 offen lds
MAA 68,80,48
s_sub_u32 s47, s47, 1
s_cbranch_scc1 .Lx22
.Lx22b:
MAA 68,84,68
TR 110,25,62624
MAA 72,84,72
TR 112,25,50720
MAA 72,80,52
TR 114,25,51232
s_waitcnt lgkmcnt(6)
MAA 104,88,52
TR 116,25,63136
MAA 104,92,72
buffer_load_dwordx4 v19, s[20:23], s54 offen offset:1024 lds
.Lpad6:
s_cbranch_execz .Lt0r
MAA 100,92,68
TR 118,25,63648
MAA 100,88,48
buffer_load_dwordx4 v20, s[20:23], s54 offen offset:2048 lds
MAA 96,88,44
TR 120,25,51744
s_add_u32 s54, s54, 196608
MAA 96,92,64
TR 122,25,52256
MAA 92,92,60
TR 124,25,64160
s_add_u32 m0, s55, 55488
MAA 92,88,40
buffer_load_dwordx4 v21, s[36:39], s52 offen lds
MAA 124,40,96
TR 126,25,64672
MAA 124,60,100
ds_read_b128 a[0:3], v23
MAA 128,64,100
RD 4,23,2304
MAA 128,44,96
buffer_load_dwordx4 v28, s[36:39], s52 offen offset:1024 lds
MAA 132,48,96
RD 8,23,4608
MAA 132,68,100
RD 12,23,6912
MAA 136,72,100
ds_read_b128 a[16:19], v24
MAA 136,52,96
buffer_load_dword v22, s[36:39], s52 offen offset:2048 lds
MAA 156,56,96
s_add_u32 s52, s52, 128
MAA 156,76,100
s_waitcnt vmcnt(18) lgkmcnt(5)
s_barrier
v_cmp_gt_u32 vcc, v35, v37
s_nop 0
s_cbranch_vccnz .Lsp23
.Lsp23b:
v_mov_b32 v37, 0
MAA 76,104,40
ds_read_b128 a[20:23], v30
MAA 76,108,60
buffer_atomic_add v38, v32, s[16:19], 0 offen
MAA 80,108,64
RD 24,30,2304
MAA 80,104,44
RD 28,30,4608
MAA 84,104,48
RD 32,30,6912
s_add_u32 m0, s56, 123648
MAA 84,108,68
buffer_load_dwordx4 v18, s[20:23], s54 offen lds
MAA 88,108,72
ds_read_b128 a[36:39], v31
MAA 88,104,52
ds_read_b64_tr_b16 a[80:81], v25
MAA 244,104,56
TR 82,25,512
MAA 244,108,76
buffer_load_dwordx4 v19, s[20:23], s54 offen offset:1024 lds
MAA 120,116,72
TR 84,25,12416
MAA 120,112,52
TR 86,25,12928
MAA 116,112,48
MAA 116,116,68
buffer_load_dwordx4 v20, s[20:23], s54 offen offset:2048 lds
MAA 112,116,64
s_add_u32 s54, s54, 196608
s_add_u32 m0, s55, 57792
MAA 112,112,44
buffer_load_dwordx4 v21, s[36:39], s53 offen lds
MAA 108,112,40
TR 88,25,1024
MAA 108,116,60
TR 90,25,1536
MAA 140,60,124
TR 92,25,13440
MAA 140,40,120
buffer_load_dwordx4 v28, s[36:39], s53 offen offset:1024 lds
MAA 144,44,120
TR 94,25,13952
MAA 144,64,124
TR 96,25,2048
MAA 148,68,124
TR 98,25,2560
MAA 148,48,120
buffer_load_dword v29, s[36:39], s53 offen offset:2048 lds
MAA 152,52,120
TR 100,25,14464
s_add_u32 s53, s53, 128
MAA 152,72,124
TR 102,25,14976
MAA 160,76,124
MAA 160,56,120
s_waitcnt vmcnt(22) lgkmcnt(8)
s_barrier
MAA 60,80,0
TR 104,25,32
v_accvgpr_write_b32 a224, v192
MAA 60,84,20
TR 106,25,544
v_accvgpr_write_b32 a225, v193
MAA 64,84,24
TR 108,25,12448
s_add_u32 m0, s56, 136064
MAA 64,80,4
buffer_load_dwordx4 v18, s[20:23], s54 offen lds
MAA 68,80,8
s_sub_u32 s47, s47, 1
s_cbranch_scc1 .Lx24
.Lx24b:
MAA 68,84,28
TR 110,25,12960
MAA 72,84,32
TR 112,25,1056
v_accvgpr_write_b32 a226, v194
MAA 72,80,12
TR 114,25,1568
s_waitcnt lgkmcnt(6)
MAA 104,88,12
TR 116,25,13472
MAA 104,92,32
buffer_load_dwordx4 v19, s[20:23], s54 offen offset:1024 lds
MAA 100,92,28
TR 118,25,13984
v_accvgpr_write_b32 a227, v195
MAA 100,88,8
buffer_load_dwordx4 v20, s[20:23], s54 offen offset:2048 lds
MAA 96,88,4
TR 120,25,2080
s_add_u32 s54, s54, 196608
MAA 96,92,24
TR 122,25,2592
MAA 92,92,20
TR 124,25,14496
s_add_u32 m0, s55, 0
MAA 92,88,0
buffer_load_dwordx4 v21, s[36:39], s52 offen lds
MAA 124,0,96
TR 126,25,15008
v_accvgpr_write_b32 a228, v196
MAA 124,20,100
RD 40,23,18496
MAA 128,24,100
RD 44,23,20800
v_accvgpr_write_b32 a229, v197
MAA 128,4,96
buffer_load_dwordx4 v28, s[36:39], s52 offen offset:1024 lds
MAA 132,8,96
RD 48,23,23104
MAA 132,28,100
RD 52,23,25408
v_accvgpr_write_b32 a230, v198
MAA 136,32,100
RD 56,24,18496
MAA 136,12,96
buffer_load_dword v22, s[36:39], s52 offen offset:2048 lds
MAA 156,16,96
s_add_u32 s52, s52, 128
v_accvgpr_write_b32 a231, v199
MAA 156,36,100
s_waitcnt vmcnt(16) lgkmcnt(5)
s_barrier
MAA 76,104,0
RD 60,30,18496
v_accvgpr_write_b32 a232, v200
MAA 76,108,20
RD 64,30,20800
MAA 80,108,24
RD 68,30,23104
s_add_u32 m0, s56, 73984
MAA 80,104,4
buffer_load_dwordx4 v18, s[20:23], s54 offen lds
MAA 84,104,8
RD 72,30,25408
v_accvgpr_write_b32 a233, v201
MAA 84,108,28
RD 76,31,18496
MAA 88,108,32
v_accvgpr_write_b32 a234, v202
MAA 88,104,12
buffer_load_dwordx4 v19, s[20:23], s54 offen offset:1024 lds
MAA 244,104,16
TR 80,25,24832
MAA 244,108,36
TR 82,25,25344
MAA 120,116,32
TR 84,25,37248
v_accvgpr_write_b32 a235, v203
MAA 120,112,12
buffer_load_dwordx4 v20, s[20:23], s54 offen offset:2048 lds
MAA 116,112,8
TR 86,25,37760
s_add_u32 s54, s54, 196608
MAA 116,116,28
MAA 112,116,24
TR 88,25,25856
v_accvgpr_write_b32 a236, v204
MAA 112,112,4
TR 90,25,26368
MAA 108,112,0
TR 92,25,38272
s_add_u32 m0, s55, 2304
MAA 108,116,20
buffer_load_dwordx4 v21, s[36:39], s53 offen lds
MAA 140,20,124
TR 94,25,38784
v_accvgpr_write_b32 a237, v205
MAA 140,0,120
MAA 144,4,120
TR 96,25,26880
v_accvgpr_write_b32 a238, v206
MAA 144,24,124
buffer_load_dwordx4 v28, s[36:39], s53 offen offset:1024 lds
MAA 148,28,124
TR 98,25,27392
MAA 148,8,120
TR 100,25,39296
MAA 152,12,120
TR 102,25,39808
v_accvgpr_write_b32 a239, v207
MAA 152,32,124
buffer_load_dword v29, s[36:39], s53 offen offset:2048 lds
MAA 160,36,124
s_add_u32 s53, s53, 128
MAA 160,16,120
s_waitcnt lgkmcnt(8)
s_barrier
MAA 60,80,40
TR 104,25,24864
v_accvgpr_write_b32 a240, v208
MAA 60,84,60
TR 106,25,25376
v_accvgpr_write_b32 a241, v209
MAA 64,84,64
TR 108,25,37280
s_add_u32 m0, s56, 86400
MAA 64,80,44
buffer_load_dwordx4 v18, s[20:23], s54 offen lds
MAA 68,80,48
s_sub_u32 s47, s47, 1
s_cbranch_scc1 .Lx25
.Lx25b:
MAA 68,84,68
TR 110,25,37792
MAA 72,84,72
TR 112,25,25888
v_accvgpr_write_b32 a242, v210
MAA 72,80,52
TR 114,25,26400
s_waitcnt lgkmcnt(6)
MAA 104,88,52
TR 116,25,38304
MAA 104,92,72
buffer_load_dwordx4 v19, s[20:23], s54 offen offset:1024 lds
MAA 100,92,68
TR 118,25,38816
v_accvgpr_write_b32 a243, v211
MAA 100,88,48
buffer_load_dwordx4 v20, s[20:23], s54 offen offset:2048 lds
MAA 96,88,44
TR 120,25,26912
s_add_u32 s54, s54, 196608
MAA 96,92,64
TR 122,25,27424
MAA 92,92,60
TR 124,25,39328
s_add_u32 m0, s55, 18496
MAA 92,88,40
buffer_load_dwordx4 v21, s[36:39], s52 offen lds
MAA 124,40,96
TR 126,25,39840
v_accvgpr_write_b32 a244, v212
MAA 124,60,100
RD 0,23,36992
MAA 128,64,100
RD 4,23,39296
v_accvgpr_write_b32 a245, v213
MAA 128,44,96
buffer_load_dwordx4 v28, s[36:39], s52 offen offset:1024 lds
MAA 132,48,96
RD 8,23,41600
MAA 132,68,100
RD 12,23,43904
v_accvgpr_write_b32 a246, v214
MAA 136,72,100
RD 16,24,36992
MAA 136,52,96
buffer_load_dword v22, s[36:39], s52 offen offset:2048 lds
MAA 156,56,96
s_add_u32 s52, s52, 128
v_accvgpr_write_b32 a247, v215
MAA 156,76,100
s_waitcnt vmcnt(15) lgkmcnt(5)
s_barrier
MAA 76,104,40
RD 20,30,36992
s_add_u32 m0, s56, 98816
MAA 76,108,60
buffer_load_dwordx4 v18, s[20:23], s54 offen lds
MAA 80,108,64
RD 24,30,39296
v_accvgpr_write_b32 a248, v216
MAA 80,104,44
RD 28,30,41600
MAA 84,104,48
RD 32,30,43904
v_accvgpr_write_b32 a249, v217
MAA 84,108,68
buffer_load_dwordx4 v19, s[20:23], s54 offen offset:1024 lds
MAA 88,108,72
RD 36,31,36992
MAA 88,104,52
TR 80,25,49664
v_accvgpr_write_b32 a250, v218
MAA 244,104,56
MAA 244,108,76
buffer_load_dwordx4 v20, s[20:23], s54 offen offset:2048 lds
MAA 120,116,72
TR 82,25,50176
s_add_u32 s54, s54, 196608
MAA 120,112,52
TR 84,25,62080
v_accvgpr_write_b32 a251, v219
MAA 116,112,48
TR 86,25,62592
s_add_u32 m0, s55, 20800
MAA 116,116,68
buffer_load_dwordx4 v21, s[36:39], s53 offen lds
MAA 112,116,64
TR 88,25,50688
MAA 112,112,44
buffer_load_dwordx4 v28, s[36:39], s53 offen offset:1024 lds
MAA 108,112,40
TR 90,25,51200
v_accvgpr_write_b32 a252, v220
MAA 108,116,60
TR 92,25,63104
MAA 140,60,124
v_accvgpr_write_b32 a253, v221
MAA 140,40,120
buffer_load_dword v29, s[36:39], s53 offen offset:2048 lds
MAA 144,44,120
TR 94,25,63616
s_add_u32 s53, s53, 128
MAA 144,64,124
TR 96,25,51712
MAA 148,68,124
TR 98,25,52224
v_accvgpr_write_b32 a254, v222
MAA 148,48,120
buffer_atomic_add v37, v33, s[16:19], 0 offen sc0
MAA 152,52,120
TR 100,25,64128
MAA 152,72,124
TR 102,25,64640
v_accvgpr_write_b32 a255, v223
MAA 160,76,124
MAA 160,56,120
s_waitcnt lgkmcnt(8)
s_barrier
MAA 60,80,0
TR 104,25,49696
MAA 60,84,20
TR 106,25,50208
MAA 64,84,24
TR 108,25,62112
s_add_u32 m0, s56, 111232
MAA 64,80,4
buffer_load_dwordx4 v18, s[20:23], s54 offen lds
MAA 68,80,8
s_sub_u32 s47, s47, 1
s_cbranch_scc1 .Lx26
.Lx26b:
MAA 68,84,28
TR 110,25,62624
MAA 72,84,32
TR 112,25,50720
MAA 72,80,12
TR 114,25,51232
s_waitcnt lgkmcnt(6)
MAA 104,88,12
TR 116,25,63136
MAA 104,92,32
buffer_load_dwordx4 v19, s[20:23], s54 offen offset:1024 lds
MAA 100,92,28
TR 118,25,63648
MAA 100,88,8
buffer_load_dwordx4 v20, s[20:23], s54 offen offset:2048 lds
MAA 96,88,4
TR 120,25,51744
s_add_u32 s54, s54, 196608
MAA 96,92,24
TR 122,25,52256
MAA 92,92,20
TR 124,25,64160
s_add_u32 m0, s55, 36992
MAA 92,88,0
buffer_load_dwordx4 v21, s[36:39], s52 offen lds
MAA 124,0,96
TR 126,25,64672
MAA 124,20,100
RD 40,23,55488
MAA 128,24,100
RD 44,23,57792
MAA 128,4,96
buffer_load_dwordx4 v28, s[36:39], s52 offen offset:1024 lds
MAA 132,8,96
RD 48,23,60096
MAA 132,28,100
RD 52,23,62400
MAA 136,32,100
RD 56,24,55488
MAA 136,12,96
buffer_load_dword v22, s[36:39], s52 offen offset:2048 lds
MAA 156,16,96
s_add_u32 s52, s52, 128
MAA 156,36,100
s_waitcnt vmcnt(16) lgkmcnt(5)
s_barrier
MAA 76,104,0
RD 60,30,55488
MAA 76,108,20
RD 64,30,57792
MAA 80,108,24
RD 68,30,60096
s_add_u32 m0, s56, 123648
MAA 80,104,4
buffer_load_dwordx4 v18, s[20:23], s54 offen lds
MAA 84,104,8
RD 72,30,62400
MAA 84,108,28
RD 76,31,55488
MAA 88,108,32
MAA 88,104,12
buffer_load_dwordx4 v19, s[20:23], s54 offen offset:1024 lds
MAA 244,104,16
ds_read_b64_tr_b16 a[80:81], v25
MAA 244,108,36
TR 82,25,512
MAA 120,116,32
TR 84,25,12416
MAA 120,112,12
buffer_load_dwordx4 v20, s[20:23], s54 offen offset:2048 lds
MAA 116,112,8
TR 86,25,12928
s_add_u32 s54, s54, 196608
MAA 116,116,28
MAA 112,116,24
TR 88,25,1024
MAA 112,112,4
TR 90,25,1536
MAA 108,112,0
TR 92,25,13440
s_add_u32 m0, s55, 39296
MAA 108,116,20
buffer_load_dwordx4 v21, s[36:39], s53 offen lds
MAA 140,20,124
TR 94,25,13952
MAA 140,0,120
MAA 144,4,120
TR 96,25,2048
MAA 144,24,124
buffer_load_dwordx4 v28, s[36:39], s53 offen offset:1024 lds
MAA 148,28,124
TR 98,25,2560
MAA 148,8,120
TR 100,25,14464
MAA 152,12,120
TR 102,25,14976
MAA 152,32,124
buffer_load_dword v29, s[36:39], s53 offen offset:2048 lds
MAA 160,36,124
s_add_u32 s53, s53, 128
MAA 160,16,120
s_waitcnt lgkmcnt(8)
s_barrier
MAA 60,80,40
TR 104,25,32
MAA 60,84,60
TR 106,25,544
MAA 64,84,64
TR 108,25,12448
s_add_u32 m0, s56, 136064
MAA 64,80,44
buffer_load_dwordx4 v18, s[20:23], s54 offen lds
MAA 68,80,48
s_sub_u32 s47, s47, 1
s_cbranch_scc1 .Lx27
.Lx27b:
MAA 68,84,68
TR 110,25,12960
MAA 72,84,72
TR 112,25,1056
MAA 72,80,52
TR 114,25,1568
s_waitcnt lgkmcnt(6)
MAA 104,88,52
TR 116,25,13472
MAA 104,92,72
buffer_load_dwordx4 v19, s[20:23], s54 offen offset:1024 lds
MAA 100,92,68
TR 118,25,13984
MAA 100,88,48
buffer_load_dwordx4 v20, s[20:23], s54 offen offset:2048 lds
MAA 96,88,44
TR 120,25,2080
s_add_u32 s54, s54, 196608
MAA 96,92,64
TR 122,25,2592
MAA 92,92,60
TR 124,25,14496
s_add_u32 m0, s55, 55488
MAA 92,88,40
buffer_load_dwordx4 v21, s[36:39], s52 offen lds
MAA 124,40,96
TR 126,25,15008
MAA 124,60,100
ds_read_b128 a[0:3], v23
MAA 128,64,100
RD 4,23,2304
MAA 128,44,96
buffer_load_dwordx4 v28, s[36:39], s52 offen offset:1024 lds
MAA 132,48,96
RD 8,23,4608
MAA 132,68,100
RD 12,23,6912
MAA 136,72,100
ds_read_b128 a[16:19], v24
MAA 136,52,96
buffer_load_dword v22, s[36:39], s52 offen offset:2048 lds
.Lpad7:
s_cbranch_execz .Lt0r
MAA 156,56,96
s_add_u32 s52, s52, 128
MAA 156,76,100
s_waitcnt vmcnt(18)
v_cmp_gt_u32 vcc, v36, v37
s_nop 0
s_cbranch_vccnz .Lsp28
.Lsp28b:
s_waitcnt vmcnt(15) lgkmcnt(5)
s_barrier
MAA 76,104,40
ds_read_b128 a[20:23], v30
s_add_u32 m0, s56, 73984
MAA 76,108,60
buffer_load_dwordx4 v18, s[20:23], s54 offen lds
MAA 80,108,64
RD 24,30,2304
MAA 80,104,44
RD 28,30,4608
MAA 84,104,48
RD 32,30,6912
MAA 84,108,68
buffer_load_dwordx4 v19, s[20:23], s54 offen offset:1024 lds
MAA 88,108,72
ds_read_b128 a[36:39], v31
MAA 88,104,52
TR 80,25,24832
MAA 244,104,56
MAA 244,108,76
buffer_load_dwordx4 v20, s[20:23], s54 offen offset:2048 lds
MAA 120,116,72
TR 82,25,25344
s_add_u32 s54, s54, 196608
MAA 120,112,52
TR 84,25,37248
MAA 116,112,48
TR 86,25,37760
s_add_u32 m0, s55, 57792
MAA 116,116,68
buffer_load_dwordx4 v21, s[36:39], s53 offen lds
MAA 112,116,64
TR 88,25,25856
MAA 112,112,44
buffer_load_dwordx4 v28, s[36:39], s53 offen offset:1024 lds
MAA 108,112,40
TR 90,25,26368
MAA 108,116,60
TR 92,25,38272
MAA 140,60,124
MAA 140,40,120
buffer_load_dword v29, s[36:39], s53 offen offset:2048 lds
MAA 144,44,120
TR 94,25,38784
s_add_u32 s53, s53, 128
MAA 144,64,124
TR 96,25,26880
MAA 148,68,124
TR 98,25,27392
MAA 148,48,120
buffer_load_dwordx4 v[164:167], v26, s[16:19], s75 offen sc1
MAA 152,52,120
TR 100,25,39296
MAA 152,72,124
TR 102,25,39808
MAA 160,76,124
MAA 160,56,120
s_waitcnt lgkmcnt(8)
s_barrier
MAA 60,80,0
TR 104,25,24864
s_add_u32 m0, s56, 86400
MAA 60,84,20
buffer_load_dwordx4 v18, s[20:23], s54 offen lds
MAA 64,84,24
s_sub_u32 s47, s47, 1
s_cbranch_scc1 .Lx29
.Lx29b:
MAA 64,80,4
TR 106,25,25376
TR 108,25,37280
MAA 68,80,8
TR 110,25,37792
MAA 68,84,28
buffer_load_dwordx4 v19, s[20:23], s54 offen offset:1024 lds
MAA 72,84,32
TR 112,25,25888
MAA 72,80,12
TR 114,25,26400
s_waitcnt lgkmcnt(6)
MAA 104,88,12
MAA 104,92,32
buffer_load_dwordx4 v20, s[20:23], s54 offen offset:2048 lds
MAA 100,92,28
s_add_u32 s54, s54, 196608
s_add_u32 m0, s55, 0
MAA 100,88,8
buffer_load_dwordx4 v21, s[36:39], s52 offen lds
MAA 96,88,4
TR 116,25,38304
MAA 96,92,24
TR 118,25,38816
TR 120,25,26912
MAA 92,92,20
TR 122,25,27424
MAA 92,88,0
buffer_load_dwordx4 v28, s[36:39], s52 offen offset:1024 lds
MAA 124,0,96
TR 124,25,39328
MAA 124,20,100
TR 126,25,39840
MAA 128,24,100
RD 40,23,18496
MAA 128,4,96
buffer_load_dword v22, s[36:39], s52 offen offset:2048 lds
MAA 132,8,96
RD 44,23,20800
s_add_u32 s52, s52, 128
MAA 132,28,100
buffer_load_dwordx4 v[168:171], v26, s[16:19], s75 offen offset:1024 sc1
MAA 136,32,100
RD 48,23,23104
MAA 136,12,96
RD 52,23,25408
RD 56,24,18496
MAA 156,16,96
MAA 156,36,100
s_waitcnt vmcnt(17) lgkmcnt(5)
s_barrier
MAA 76,104,0
RD 60,30,18496
s_add_u32 m0, s56, 98816
MAA 76,108,20
buffer_load_dwordx4 v18, s[20:23], s54 offen lds
MAA 80,108,24
RD 64,30,20800
MAA 80,104,4
RD 68,30,23104
MAA 84,104,8
RD 72,30,25408
MAA 84,108,28
buffer_load_dwordx4 v19, s[20:23], s54 offen offset:1024 lds
MAA 88,108,32
RD 76,31,18496
MAA 88,104,12
TR 80,25,49664
MAA 244,104,16
MAA 244,108,36
buffer_load_dwordx4 v20, s[20:23], s54 offen offset:2048 lds
MAA 120,116,32
TR 82,25,50176
s_add_u32 s54, s54, 196608
MAA 120,112,12
TR 84,25,62080
MAA 116,112,8
TR 86,25,62592
s_add_u32 m0, s55, 2304
MAA 116,116,28
buffer_load_dwordx4 v21, s[36:39], s53 offen lds
MAA 112,116,24
TR 88,25,50688
MAA 112,112,4
buffer_load_dwordx4 v28, s[36:39], s53 offen offset:1024 lds
MAA 108,112,0
TR 90,25,51200
MAA 108,116,20
TR 92,25,63104
MAA 140,20,124
MAA 140,0,120
buffer_load_dword v29, s[36:39], s53 offen offset:2048 lds
MAA 144,4,120
TR 94,25,63616
s_add_u32 s53, s53, 128
MAA 144,24,124
TR 96,25,51712
MAA 148,28,124
TR 98,25,52224
MAA 148,8,120
buffer_load_dwordx4 v[172:175], v26, s[16:19], s75 offen offset:2048 sc1
MAA 152,12,120
TR 100,25,64128
MAA 152,32,124
TR 102,25,64640
MAA 160,36,124
MAA 160,16,120
s_waitcnt lgkmcnt(8)
s_barrier
MAA 60,80,40
TR 104,25,49696
s_add_u32 m0, s56, 111232
MAA 60,84,60
buffer_load_dwordx4 v18, s[20:23], s54 offen lds
MAA 64,84,64
s_sub_u32 s47, s47, 1
s_cbranch_scc1 .Lx30
.Lx30b:
MAA 64,80,44
TR 106,25,50208
TR 108,25,62112
MAA 68,80,48
TR 110,25,62624
MAA 68,84,68
buffer_load_dwordx4 v19, s[20:23], s54 offen offset:1024 lds
MAA 72,84,72
TR 112,25,50720
MAA 72,80,52
TR 114,25,51232
s_waitcnt lgkmcnt(6)
MAA 104,88,52
MAA 104,92,72
buffer_load_dwordx4 v20, s[20:23], s54 offen offset:2048 lds
MAA 100,92,68
s_add_u32 s54, s54, 196608
s_add_u32 m0, s55, 18496
MAA 100,88,48
buffer_load_dwordx4 v21, s[36:39], s52 offen lds
MAA 96,88,44
TR 116,25,63136
MAA 96,92,64
TR 118,25,63648
TR 120,25,51744
MAA 92,92,60
TR 122,25,52256
MAA 92,88,40
buffer_load_dwordx4 v28, s[36:39], s52 offen offset:1024 lds
MAA 124,40,96
TR 124,25,64160
MAA 124,60,100
TR 126,25,64672
MAA 128,64,100
RD 0,23,36992
MAA 128,44,96
buffer_load_dword v22, s[36:39], s52 offen offset:2048 lds
MAA 132,48,96
RD 4,23,39296
s_add_u32 s52, s52, 128
MAA 132,68,100
buffer_load_dwordx4 v[176:179], v26, s[16:19], s75 offen offset:3072 sc1
MAA 136,72,100
RD 8,23,41600
s_add_u32 s75, s75, 4096
MAA 136,52,96
RD 12,23,43904
RD 16,24,36992
MAA 156,56,96
MAA 156,76,100
s_waitcnt vmcnt(18) lgkmcnt(5)
s_barrier
MAA 76,104,40
RD 20,30,36992
s_add_u32 m0, s56, 123648
MAA 76,108,60
buffer_load_dwordx4 v18, s[20:23], s54 offen lds
MAA 80,108,64
RD 24,30,39296
s_waitcnt vmcnt(15)
v_add_f32 v164, v164, v168
MAA 80,104,44
RD 28,30,41600
MAA 84,104,48
RD 32,30,43904
MAA 84,108,68
buffer_load_dwordx4 v19, s[20:23], s54 offen offset:1024 lds
MAA 88,108,72
RD 36,31,36992
MAA 88,104,52
ds_read_b64_tr_b16 a[80:81], v25
v_add_f32 v165, v165, v169
MAA 244,104,56
MAA 244,108,76
buffer_load_dwordx4 v20, s[20:23], s54 offen offset:2048 lds
MAA 120,116,72
TR 82,25,512
s_add_u32 s54, s54, 196608
MAA 120,112,52
TR 84,25,12416
MAA 116,112,48
TR 86,25,12928
s_add_u32 m0, s55, 20800
MAA 116,116,68
buffer_load_dwordx4 v21, s[36:39], s53 offen lds
MAA 112,116,64
TR 88,25,1024
MAA 112,112,44
buffer_load_dwordx4 v28, s[36:39], s53 offen offset:1024 lds
MAA 108,112,40
TR 90,25,1536
v_add_f32 v166, v166, v170
MAA 108,116,60
TR 92,25,13440
MAA 140,60,124
MAA 140,40,120
buffer_load_dword v29, s[36:39], s53 offen offset:2048 lds
MAA 144,44,120
TR 94,25,13952
s_add_u32 s53, s53, 128
MAA 144,64,124
TR 96,25,2048
MAA 148,68,124
TR 98,25,2560
v_add_f32 v167, v167, v171
MAA 148,48,120
buffer_load_dwordx4 v[180:183], v26, s[16:19], s75 offen sc1
MAA 152,52,120
TR 100,25,14464
MAA 152,72,124
TR 102,25,14976
MAA 160,76,124
MAA 160,56,120
s_waitcnt lgkmcnt(8)
s_barrier
MAA 60,80,0
TR 104,25,32
s_add_u32 m0, s56, 136064
MAA 60,84,20
buffer_load_dwordx4 v18, s[20:23], s54 offen lds
MAA 64,84,24
s_sub_u32 s47, s47, 1
s_cbranch_scc1 .Lx31
.Lx31b:
MAA 64,80,4
TR 106,25,544
TR 108,25,12448
MAA 68,80,8
TR 110,25,12960
s_waitcnt vmcnt(15)
v_add_f32 v164, v164, v172
MAA 68,84,28
buffer_load_dwordx4 v19, s[20:23], s54 offen offset:1024 lds
MAA 72,84,32
TR 112,25,1056
MAA 72,80,12
TR 114,25,1568
s_waitcnt lgkmcnt(6)
MAA 104,88,12
v_add_f32 v165, v165, v173
MAA 104,92,32
buffer_load_dwordx4 v20, s[20:23], s54 offen offset:2048 lds
MAA 100,92,28
s_add_u32 s54, s54, 196608
s_add_u32 m0, s55, 36992
MAA 100,88,8
buffer_load_dwordx4 v21, s[36:39], s52 offen lds
MAA 96,88,4
TR 116,25,13472
MAA 96,92,24
TR 118,25,13984
TR 120,25,2080
MAA 92,92,20
TR 122,25,2592
v_add_f32 v166, v166, v174
MAA 92,88,0
buffer_load_dwordx4 v28, s[36:39], s52 offen offset:1024 lds
MAA 124,0,96
TR 124,25,14496
MAA 124,20,100
TR 126,25,15008
MAA 128,24,100
RD 40,23,55488
v_add_f32 v167, v167, v175
MAA 128,4,96
buffer_load_dword v22, s[36:39], s52 offen offset:2048 lds
MAA 132,8,96
RD 44,23,57792
s_add_u32 s52, s52, 128
MAA 132,28,100
buffer_load_dwordx4 v[184:187], v26, s[16:19], s75 offen offset:1024 sc1
MAA 136,32,100
RD 48,23,60096
MAA 136,12,96
RD 52,23,62400
RD 56,24,55488
MAA 156,16,96
MAA 156,36,100
s_waitcnt vmcnt(18) lgkmcnt(5)
s_barrier
MAA 76,104,0
RD 60,30,55488
s_waitcnt vmcnt(14)
v_add_f32 v164, v164, v176
MAA 76,108,20
RD 64,30,57792
s_add_u32 m0, s56, 73984
MAA 80,108,24
buffer_load_dwordx4 v18, s[20:23], s54 offen lds
MAA 80,104,4
RD 68,30,60096
v_add_f32 v165, v165, v177
MAA 84,104,8
RD 72,30,62400
v_add_f32 v166, v166, v178
MAA 84,108,28
buffer_load_dwordx4 v19, s[20:23], s54 offen offset:1024 lds
MAA 88,108,32
RD 76,31,55488
v_add_f32 v167, v167, v179
MAA 88,104,12
TR 80,25,24832
MAA 244,104,16
buffer_load_dwordx4 v20, s[20:23], s54 offen offset:2048 lds
MAA 244,108,36
TR 82,25,25344
s_add_u32 s54, s54, 196608
MAA 120,116,32
TR 84,25,37248
s_add_u32 m0, s55, 39296
MAA 120,112,12
buffer_load_dwordx4 v21, s[36:39], s53 offen lds
MAA 116,112,8
TR 86,25,37760
MAA 116,116,28
TR 88,25,25856
MAA 112,116,24
buffer_load_dwordx4 v28, s[36:39], s53 offen offset:1024 lds
MAA 112,112,4
TR 90,25,26368
MAA 108,112,0
TR 92,25,38272
MAA 108,116,20
buffer_load_dword v29, s[36:39], s53 offen offset:2048 lds
MAA 140,20,124
TR 94,25,38784
s_add_u32 s53, s53, 128
MAA 140,0,120
TR 96,25,26880
MAA 144,4,120
buffer_load_dwordx4 v[188:191], v26, s[16:19], s75 offen offset:2048 sc1
MAA 144,24,124
TR 98,25,27392
MAA 148,28,124
TR 100,25,39296
MAA 148,8,120
TR 102,25,39808
MAA 152,12,120
MAA 152,32,124
MAA 160,36,124
MAA 160,16,120
s_waitcnt lgkmcnt(8)
s_barrier
MAA 60,80,40
TR 104,25,24864
s_add_u32 m0, s56, 86400
MAA 60,84,60
buffer_load_dwordx4 v18, s[20:23], s54 offen lds
MAA 64,84,64
s_sub_u32 s47, s47, 1
s_cbranch_scc1 .Lx32
.Lx32b:
MAA 64,80,44
TR 106,25,25376
TR 108,25,37280
MAA 68,80,48
TR 110,25,37792
s_waitcnt vmcnt(15)
v_add_f32 v164, v164, v180
MAA 68,84,68
buffer_load_dwordx4 v19, s[20:23], s54 offen offset:1024 lds
MAA 72,84,72
TR 112,25,25888
MAA 72,80,52
TR 114,25,26400
s_waitcnt lgkmcnt(6)
MAA 104,88,52
v_add_f32 v165, v165, v181
MAA 104,92,72
buffer_load_dwordx4 v20, s[20:23], s54 offen offset:2048 lds
MAA 100,92,68
s_add_u32 s54, s54, 196608
s_add_u32 m0, s55, 55488
MAA 100,88,48
buffer_load_dwordx4 v21, s[36:39], s52 offen lds
MAA 96,88,44
TR 116,25,38304
MAA 96,92,64
TR 118,25,38816
TR 120,25,26912
MAA 92,92,60
TR 122,25,27424
v_add_f32 v166, v166, v182
MAA 92,88,40
buffer_load_dwordx4 v28, s[36:39], s52 offen offset:1024 lds
MAA 124,40,96
TR 124,25,39328
MAA 124,60,100
TR 126,25,39840
MAA 128,64,100
ds_read_b128 a[0:3], v23
v_add_f32 v167, v167, v183
MAA 128,44,96
buffer_load_dword v22, s[36:39], s52 offen offset:2048 lds
MAA 132,48,96
RD 4,23,2304
s_add_u32 s52, s52, 128
MAA 132,68,100
buffer_load_dwordx4 v[192:195], v26, s[16:19], s75 offen offset:3072 sc1
MAA 136,72,100
RD 8,23,4608
MAA 136,52,96
RD 12,23,6912
ds_read_b128 a[16:19], v24
MAA 156,56,96
MAA 156,76,100
s_waitcnt vmcnt(18) lgkmcnt(5)
s_barrier
MAA 76,104,40
ds_read_b128 a[20:23], v30
s_waitcnt vmcnt(14)
v_add_f32 v164, v164, v184
MAA 76,108,60
RD 24,30,2304
s_add_u32 m0, s56, 98816
MAA 80,108,64
buffer_load_dwordx4 v18, s[20:23], s54 offen lds
MAA 80,104,44
RD 28,30,4608
v_add_f32 v165, v165, v185
MAA 84,104,48
RD 32,30,6912
v_add_f32 v166, v166, v186
MAA 84,108,68
ds_read_b128 a[36:39], v31
v_add_f32 v167, v167, v187
MAA 88,108,72
buffer_load_dwordx4 v19, s[20:23], s54 offen offset:1024 lds
MAA 88,104,52
TR 80,25,49664
MAA 244,104,56
TR 82,25,50176
MAA 244,108,76
TR 84,25,62080
MAA 120,116,72
buffer_load_dwordx4 v20, s[20:23], s54 offen offset:2048 lds
MAA 120,112,52
TR 86,25,62592
s_add_u32 s54, s54, 196608
MAA 116,112,48
TR 88,25,50688
s_add_u32 m0, s55, 57792
MAA 116,116,68
TR 90,25,51200
MAA 112,116,64
buffer_load_dwordx4 v21, s[36:39], s53 offen lds
MAA 112,112,44
TR 92,25,63104
MAA 108,112,40
TR 94,25,63616
MAA 108,116,60
TR 96,25,51712
.Lpad8:
s_cbranch_execz .Lt0r
MAA 140,60,124
buffer_load_dwordx4 v28, s[36:39], s53 offen offset:1024 lds
MAA 140,40,120
TR 98,25,52224
MAA 144,44,120
TR 100,25,64128
MAA 144,64,124
TR 102,25,64640
MAA 148,68,124
buffer_load_dword v29, s[36:39], s53 offen offset:2048 lds
MAA 148,48,120
s_add_u32 s53, s53, 128
MAA 152,52,120
MAA 152,72,124
MAA 160,76,124
MAA 160,56,120
s_waitcnt lgkmcnt(8)
s_barrier
MAA 60,80,0
TR 104,25,49696
s_waitcnt vmcnt(13)
v_add_f32 v164, v164, v188
MAA 60,84,20
TR 106,25,50208
s_add_u32 m0, s56, 111232
MAA 64,84,24
buffer_load_dwordx4 v18, s[20:23], s54 offen lds
MAA 64,80,4
TR 108,25,62112
v_add_f32 v165, v165, v189
MAA 68,80,8
TR 110,25,62624
v_add_f32 v166, v166, v190
MAA 68,84,28
buffer_load_dwordx4 v19, s[20:23], s54 offen offset:1024 lds
MAA 72,84,32
TR 112,25,50720
v_add_f32 v167, v167, v191
MAA 72,80,12
TR 114,25,51232
s_waitcnt lgkmcnt(6)
MAA 104,88,12
buffer_load_dwordx4 v20, s[20:23], s54 offen offset:2048 lds
MAA 104,92,32
TR 116,25,63136
s_add_u32 s54, s54, 196608
MAA 100,92,28
TR 118,25,63648
s_add_u32 m0, s59, 0
MAA 100,88,8
TR 120,25,51744
s_xor_b32 s58, s87, 1048576
MAA 96,88,4
buffer_load_dwordx4 v5, s[24:27], s58 offen lds
MAA 96,92,24
TR 122,25,52256
MAA 92,92,20
TR 124,25,64160
MAA 92,88,0
buffer_load_dwordx4 v6, s[24:27], s58 offen offset:1024 lds
MAA 124,0,96
TR 126,25,64672
s_add_u32 m0, s59, 8320
MAA 124,20,100
RD 40,23,18496
s_xor_b32 s58, s87, 1179648
MAA 128,24,100
buffer_load_dwordx4 v5, s[24:27], s58 offen lds
MAA 128,4,96
RD 44,23,20800
MAA 132,8,96
RD 48,23,23104
MAA 132,28,100
buffer_load_dwordx4 v6, s[24:27], s58 offen offset:1024 lds
MAA 136,32,100
RD 52,23,25408
MAA 136,12,96
RD 56,24,18496
MAA 156,16,96
MAA 156,36,100
s_waitcnt vmcnt(17) lgkmcnt(5)
s_barrier
MAA 76,104,0
RD 60,30,18496
s_waitcnt vmcnt(13)
v_add_f32 v164, v164, v192
MAA 76,108,20
RD 64,30,20800
s_add_u32 m0, s56, 123648
MAA 80,108,24
buffer_load_dwordx4 v18, s[20:23], s54 offen lds
MAA 80,104,4
RD 68,30,23104
v_add_f32 v165, v165, v193
MAA 84,104,8
RD 72,30,25408
v_add_f32 v166, v166, v194
MAA 84,108,28
RD 76,31,18496
v_add_f32 v167, v167, v195
MAA 88,108,32
ds_read_b64_tr_b16 a[80:81], v25
MAA 88,104,12
TR 82,25,512
MAA 244,104,16
TR 84,25,12416
MAA 244,108,36
TR 86,25,12928
MAA 120,116,32
buffer_load_dwordx4 v19, s[20:23], s54 offen offset:1024 lds
MAA 120,112,12
TR 88,25,1024
MAA 116,112,8
TR 90,25,1536
MAA 116,116,28
TR 92,25,13440
MAA 112,116,24
TR 94,25,13952
MAA 112,112,4
TR 96,25,2048
MAA 108,112,0
TR 98,25,2560
MAA 108,116,20
TR 100,25,14464
MAA 140,20,124
buffer_load_dwordx4 v20, s[20:23], s54 offen offset:2048 lds
MAA 140,0,120
TR 102,25,14976
s_add_u32 s54, s54, 196608
MAA 144,4,120
MAA 144,24,124
MAA 148,28,124
MAA 148,8,120
MAA 152,12,120
MAA 152,32,124
MAA 160,36,124
MAA 160,16,120
s_waitcnt lgkmcnt(8)
s_barrier
MAA 60,80,40
TR 104,25,32
MAA 60,84,60
TR 106,25,544
s_add_u32 m0, s56, 136064
MAA 64,84,64
buffer_load_dwordx4 v18, s[20:23], s54 offen lds
MAA 64,80,44
TR 108,25,12448
MAA 68,80,48
TR 110,25,12960
MAA 68,84,68
buffer_load_dwordx4 v19, s[20:23], s54 offen offset:1024 lds
MAA 72,84,72
TR 112,25,1056
MAA 72,80,52
TR 114,25,1568
s_waitcnt lgkmcnt(6)
MAA 104,88,52
buffer_load_dwordx4 v20, s[20:23], s54 offen offset:2048 lds
MAA 104,92,72
TR 116,25,13472
s_add_u32 s54, s54, 196608
MAA 100,92,68
TR 118,25,13984
s_add_u32 m0, s59, 16640
MAA 100,88,48
TR 120,25,2080
s_xor_b32 s58, s87, 1310720
MAA 96,88,44
buffer_load_dwordx4 v5, s[24:27], s58 offen lds
MAA 96,92,64
TR 122,25,2592
MAA 92,92,60
TR 124,25,14496
MAA 92,88,40
buffer_load_dwordx4 v6, s[24:27], s58 offen offset:1024 lds
MAA 124,40,96
TR 126,25,15008
s_add_u32 m0, s59, 24960
MAA 124,60,100
RD 0,23,36992
s_xor_b32 s58, s87, 1441792
MAA 128,64,100
buffer_load_dwordx4 v5, s[24:27], s58 offen lds
MAA 128,44,96
RD 4,23,39296
MAA 132,48,96
RD 8,23,41600
MAA 132,68,100
buffer_load_dwordx4 v6, s[24:27], s58 offen offset:1024 lds
MAA 136,72,100
RD 12,23,43904
MAA 136,52,96
RD 16,24,36992
MAA 156,56,96
v_permlane32_swap_b32 v164, v166
MAA 156,76,100
v_permlane32_swap_b32 v165, v167
v_add_f32 v164, v164, v166
v_add_f32 v165, v165, v167
v_mul_f32 v164, 0xba800000, v164
v_mul_f32 v165, 0x3a800000, v165
v_fma_f32 v165, -v164, v164, v165
v_max_f32 v165, 0, v165
v_add_f32 v165, 0x3727c5ac, v165
v_rsq_f32 v166, v165
s_nop 0
v_mov_b32 v165, v166
v_mul_f32 v166, 0x3e8293ee, v166
s_waitcnt vmcnt(14) lgkmcnt(5)
s_barrier
MAA 76,104,40
ds_write_b128 v7, v[164:167]
MAA 76,108,60
ds_write_b32 v17, v164
s_add_u32 m0, s59, 74880
MAA 80,108,64
ds_write_b32 v17, v165 offset:1024
s_xor_b32 s58, s87, 131072
MAA 80,104,44
buffer_load_dwordx4 v5, s[24:27], s58 offen lds
MAA 84,104,48
RD 20,30,36992
MAA 84,108,68
RD 24,30,39296
MAA 88,108,72
RD 28,30,41600
MAA 88,104,52
RD 32,30,43904
MAA 244,104,56
RD 36,31,36992
MAA 244,108,76
buffer_load_dwordx4 v6, s[24:27], s58 offen offset:1024 lds
MAA 120,116,72
TR 80,25,24832
s_add_u32 m0, s59, 83200
MAA 120,112,52
TR 82,25,25344
s_xor_b32 s58, s87, 262144
MAA 116,112,48
TR 84,25,37248
MAA 116,116,68
TR 86,25,37760
MAA 112,116,64
TR 88,25,25856
MAA 112,112,44
buffer_load_dwordx4 v5, s[24:27], s58 offen lds
MAA 108,112,40
TR 90,25,26368
MAA 108,116,60
TR 92,25,38272
MAA 140,60,124
TR 94,25,38784
MAA 140,40,120
TR 96,25,26880
MAA 144,44,120
TR 98,25,27392
MAA 144,64,124
buffer_load_dwordx4 v6, s[24:27], s58 offen offset:1024 lds
MAA 148,68,124
TR 100,25,39296
MAA 148,48,120
TR 102,25,39808
MAA 152,52,120
MAA 152,72,124
MAA 160,76,124
MAA 160,56,120
s_waitcnt vmcnt(8) lgkmcnt(0)
s_barrier
MAA 104,88,12
TR 112,25,25888
s_add_u32 m0, s59, 33280
MAA 104,92,32
TR 114,25,26400
s_xor_b32 s58, s87, 1572864
MAA 100,92,28
buffer_load_dwordx4 v5, s[24:27], s58 offen lds
MAA 100,88,8
TR 116,25,38304
MAA 96,88,4
TR 118,25,38816
MAA 96,92,24
TR 120,25,26912
MAA 92,92,20
buffer_load_dwordx4 v6, s[24:27], s58 offen offset:1024 lds
MAA 92,88,0
TR 122,25,27424
s_add_u32 m0, s59, 41600
MAA 156,16,96
TR 124,25,39328
s_xor_b32 s58, s87, 1703936
MAA 156,36,100
TR 126,25,39840
MAA 72,84,32
buffer_load_dwordx4 v5, s[24:27], s58 offen lds
MAA 72,80,12
TR 104,25,24864
MAA 68,80,8
TR 106,25,25376
MAA 68,84,28
TR 108,25,37280
MAA 64,84,24
buffer_load_dwordx4 v6, s[24:27], s58 offen offset:1024 lds
MAA 64,80,4
TR 110,25,37792
MAA 60,80,0
RD 40,23,55488
MAA 60,84,20
RD 44,23,57792
s_waitcnt lgkmcnt(12)
MAA 120,112,12
RD 48,23,60096
s_waitcnt lgkmcnt(11)
MAA 120,116,32
RD 52,23,62400
MAA 116,116,28
RD 56,24,55488
MAA 116,112,8
RD 60,30,55488
MAA 112,112,4
RD 64,30,57792
MAA 112,116,24
s_waitcnt lgkmcnt(7)
s_barrier
RD 68,30,60096
MAA 108,116,20
RD 72,30,62400
s_add_u32 m0, s59, 91520
MAA 108,112,0
RD 76,31,55488
s_xor_b32 s58, s87, 393216
MAA 160,16,120
TR 144,25,50688
MAA 160,36,124
TR 146,25,51200
MAA 244,108,36
TR 148,25,63104
MAA 244,104,16
TR 150,25,63616
MAA 88,104,12
TR 152,25,50720
MAA 88,108,32
TR 154,25,51232
MAA 84,108,28
TR 156,25,63136
MAA 84,104,8
TR 158,25,63648
MAA 80,104,4
TR 160,25,51712
MAA 80,108,24
TR 162,25,52224
MAA 76,108,20
TR 164,25,64128
MAA 76,104,0
TR 166,25,64640
s_waitcnt lgkmcnt(10)
MAA 104,144,52
TR 168,25,51744
s_waitcnt lgkmcnt(9)
MAA 104,148,72
TR 170,25,52256
MAA 100,148,68
TR 172,25,64160
MAA 100,144,48
TR 174,25,64672
MAA 96,144,44
TR 136,25,49696
MAA 96,148,64
TR 138,25,50208
MAA 92,148,60
TR 140,25,62112
MAA 92,144,40
TR 142,25,62624
s_waitcnt lgkmcnt(14)
MAA 120,152,52
TR 128,25,49664
s_waitcnt lgkmcnt(13)
MAA 120,156,72
TR 130,25,50176
MAA 116,156,68
TR 132,25,62080
MAA 116,152,48
TR 134,25,62592
MAA 112,152,44
ds_read_b128 v[232:235], v10 offset:1792
MAA 112,156,64
ds_read_b128 v[228:231], v10 offset:1536
MAA 108,156,60
ds_read_b128 v[224:227], v10 offset:1280
MAA 108,152,40
ds_read_b128 v[220:223], v10 offset:1024
s_waitcnt lgkmcnt(15)
MAA 156,56,160
buffer_load_dwordx4 v5, s[24:27], s58 offen lds
MAA 156,76,164
s_waitcnt lgkmcnt(12)
MAA 160,76,172
MAA 160,56,168
s_waitcnt lgkmcnt(10)
MAA 244,136,56
buffer_load_dwordx4 v6, s[24:27], s58 offen offset:1024 lds
s_waitcnt lgkmcnt(8)
MAA 244,140,76
s_add_u32 m0, s59, 99840
s_xor_b32 s58, s87, 524288
MAA 88,140,72
MAA 88,136,52
MAA 84,136,48
buffer_load_dwordx4 v5, s[24:27], s58 offen lds
MAA 84,140,68
buffer_load_dwordx4 v6, s[24:27], s58 offen offset:1024 lds
s_add_u32 m0, s59, 108160
s_xor_b32 s58, s87, 655360
buffer_load_dwordx4 v5, s[24:27], s58 offen lds
buffer_load_dwordx4 v6, s[24:27], s58 offen offset:1024 lds
s_mov_b32 exec_lo, 0x10001
s_mov_b32 exec_hi, 0x10001
ds_write_b128 v13, v[244:247] offset:64
s_mov_b64 exec, 0xffff
ds_write_b32 v12, v156 offset:512
ds_write_b32 v12, v160 offset:576
s_mov_b64 exec, -1
MAA 80,136,44
MAA 80,140,64
MAA 76,140,60
MAA 76,136,40
s_waitcnt lgkmcnt(9)
MAA 72,128,52
s_waitcnt lgkmcnt(7)
MAA 72,132,72
s_waitcnt lgkmcnt(0)
s_barrier
MAA 68,128,48
ds_read_b128 v[28:31], v13
MAA 68,132,68
ds_read_b128 v[32:35], v13 offset:64
MAA 64,132,64
ds_read_b128 v[36:39], v13 offset:256
MAA 64,128,44
ds_read_b128 v[40:43], v13 offset:320
MAA 60,128,40
ds_read_b32 v44, v12 offset:512
MAA 60,132,60
ds_read_b32 v45, v12 offset:576
ds_read_b128 v[240:243], v11 offset:704
ds_read_b128 v[244:247], v11 offset:1728
ds_read_b128 v[18:21], v11 offset:448
ds_read_b128 v[22:25], v11 offset:1472
s_waitcnt lgkmcnt(9)
v_pk_fma_f32 v[72:73], v[28:29], v[232:233], v[72:73] op_sel_hi:[1,0,1]
v_cvt_pk_bf16_f32 v176, v72, v73
v_pk_fma_f32 v[74:75], v[30:31], v[232:233], v[74:75] op_sel_hi:[1,0,1]
v_cvt_pk_bf16_f32 v177, v74, v75
s_waitcnt lgkmcnt(8)
v_pk_fma_f32 v[88:89], v[32:33], v[232:233], v[88:89] op_sel_hi:[1,0,1]
v_cvt_pk_bf16_f32 v178, v88, v89
v_pk_fma_f32 v[90:91], v[34:35], v[232:233], v[90:91] op_sel_hi:[1,0,1]
v_cvt_pk_bf16_f32 v179, v90, v91
s_waitcnt lgkmcnt(7)
v_pk_fma_f32 v[104:105], v[36:37], v[232:233], v[104:105] op_sel_hi:[1,0,1]
v_pk_mul_f32 v[104:105], v[104:105], v[232:233] op_sel:[0,1] op_sel_hi:[1,1]
v_cvt_pk_bf16_f32 v196, v104, v105
v_pk_fma_f32 v[106:107], v[38:39], v[232:233], v[106:107] op_sel_hi:[1,0,1]
v_pk_mul_f32 v[106:107], v[106:107], v[232:233] op_sel:[0,1] op_sel_hi:[1,1]
v_cvt_pk_bf16_f32 v197, v106, v107
s_waitcnt lgkmcnt(6)
v_pk_fma_f32 v[120:121], v[40:41], v[232:233], v[120:121] op_sel_hi:[1,0,1]
v_pk_mul_f32 v[120:121], v[120:121], v[232:233] op_sel:[0,1] op_sel_hi:[1,1]
v_cvt_pk_bf16_f32 v198, v120, v121
v_pk_fma_f32 v[122:123], v[42:43], v[232:233], v[122:123] op_sel_hi:[1,0,1]
v_pk_mul_f32 v[122:123], v[122:123], v[232:233] op_sel:[0,1] op_sel_hi:[1,1]
v_cvt_pk_bf16_f32 v199, v122, v123
v_pk_fma_f32 v[100:101], v[36:37], v[228:229], v[100:101] op_sel_hi:[1,0,1]
v_pk_mul_f32 v[100:101], v[100:101], v[228:229] op_sel:[0,1] op_sel_hi:[1,1]
s_waitcnt lgkmcnt(3)
v_pk_fma_f32 v[156:157], v[240:241], v[44:45], v[156:157] op_sel_hi:[1,0,1]
v_pk_fma_f32 v[158:159], v[242:243], v[44:45], v[158:159] op_sel_hi:[1,0,1]
s_waitcnt lgkmcnt(2)
v_pk_mul_f32 v[156:157], v[156:157], v[244:245]
v_cvt_pk_bf16_f32 v236, v156, v157
v_pk_mul_f32 v[158:159], v[158:159], v[246:247]
v_cvt_pk_bf16_f32 v237, v158, v159
v_pk_fma_f32 v[160:161], v[240:241], v[44:45], v[160:161] op_sel:[0,1,0] op_sel_hi:[1,1,1]
v_pk_mul_f32 v[160:161], v[160:161], v[244:245]
v_cvt_pk_bf16_f32 v238, v160, v161
v_pk_fma_f32 v[162:163], v[242:243], v[44:45], v[162:163] op_sel:[0,1,0] op_sel_hi:[1,1,1]
v_pk_mul_f32 v[162:163], v[162:163], v[246:247]
v_cvt_pk_bf16_f32 v239, v162, v163
ds_write_b128 v8, v[236:239] offset:1024
v_cvt_pk_bf16_f32 v192, v100, v101
v_pk_fma_f32 v[102:103], v[38:39], v[228:229], v[102:103] op_sel_hi:[1,0,1]
v_pk_mul_f32 v[102:103], v[102:103], v[228:229] op_sel:[0,1] op_sel_hi:[1,1]
v_cvt_pk_bf16_f32 v193, v102, v103
v_pk_fma_f32 v[116:117], v[40:41], v[228:229], v[116:117] op_sel_hi:[1,0,1]
v_pk_mul_f32 v[116:117], v[116:117], v[228:229] op_sel:[0,1] op_sel_hi:[1,1]
v_cvt_pk_bf16_f32 v194, v116, v117
v_pk_fma_f32 v[118:119], v[42:43], v[228:229], v[118:119] op_sel_hi:[1,0,1]
v_pk_mul_f32 v[118:119], v[118:119], v[228:229] op_sel:[0,1] op_sel_hi:[1,1]
v_cvt_pk_bf16_f32 v195, v118, v119
v_pk_fma_f32 v[96:97], v[36:37], v[224:225], v[96:97] op_sel_hi:[1,0,1]
v_pk_mul_f32 v[96:97], v[96:97], v[224:225] op_sel:[0,1] op_sel_hi:[1,1]
v_cvt_pk_bf16_f32 v188, v96, v97
v_pk_fma_f32 v[98:99], v[38:39], v[224:225], v[98:99] op_sel_hi:[1,0,1]
v_pk_mul_f32 v[98:99], v[98:99], v[224:225] op_sel:[0,1] op_sel_hi:[1,1]
v_cvt_pk_bf16_f32 v189, v98, v99
v_pk_fma_f32 v[112:113], v[40:41], v[224:225], v[112:113] op_sel_hi:[1,0,1]
v_pk_mul_f32 v[112:113], v[112:113], v[224:225] op_sel:[0,1] op_sel_hi:[1,1]
v_cvt_pk_bf16_f32 v190, v112, v113
v_pk_fma_f32 v[114:115], v[42:43], v[224:225], v[114:115] op_sel_hi:[1,0,1]
v_pk_mul_f32 v[114:115], v[114:115], v[224:225] op_sel:[0,1] op_sel_hi:[1,1]
v_cvt_pk_bf16_f32 v191, v114, v115
v_pk_fma_f32 v[92:93], v[36:37], v[220:221], v[92:93] op_sel_hi:[1,0,1]
v_pk_mul_f32 v[92:93], v[92:93], v[220:221] op_sel:[0,1] op_sel_hi:[1,1]
v_cvt_pk_bf16_f32 v184, v92, v93
v_pk_fma_f32 v[94:95], v[38:39], v[220:221], v[94:95] op_sel_hi:[1,0,1]
v_pk_mul_f32 v[94:95], v[94:95], v[220:221] op_sel:[0,1] op_sel_hi:[1,1]
v_cvt_pk_bf16_f32 v185, v94, v95
v_pk_fma_f32 v[108:109], v[40:41], v[220:221], v[108:109] op_sel_hi:[1,0,1]
v_pk_mul_f32 v[108:109], v[108:109], v[220:221] op_sel:[0,1] op_sel_hi:[1,1]
v_cvt_pk_bf16_f32 v186, v108, v109
v_pk_fma_f32 v[110:111], v[42:43], v[220:221], v[110:111] op_sel_hi:[1,0,1]
v_pk_mul_f32 v[110:111], v[110:111], v[220:221] op_sel:[0,1] op_sel_hi:[1,1]
v_cvt_pk_bf16_f32 v187, v110, v111
v_pk_fma_f32 v[68:69], v[28:29], v[228:229], v[68:69] op_sel_hi:[1,0,1]
v_cvt_pk_bf16_f32 v172, v68, v69
v_pk_fma_f32 v[70:71], v[30:31], v[228:229], v[70:71] op_sel_hi:[1,0,1]
v_cvt_pk_bf16_f32 v173, v70, v71
v_pk_fma_f32 v[84:85], v[32:33], v[228:229], v[84:85] op_sel_hi:[1,0,1]
v_cvt_pk_bf16_f32 v174, v84, v85
v_pk_fma_f32 v[86:87], v[34:35], v[228:229], v[86:87] op_sel_hi:[1,0,1]
v_cvt_pk_bf16_f32 v175, v86, v87
v_pk_fma_f32 v[64:65], v[28:29], v[224:225], v[64:65] op_sel_hi:[1,0,1]
v_cvt_pk_bf16_f32 v168, v64, v65
v_pk_fma_f32 v[66:67], v[30:31], v[224:225], v[66:67] op_sel_hi:[1,0,1]
v_cvt_pk_bf16_f32 v169, v66, v67
v_pk_fma_f32 v[80:81], v[32:33], v[224:225], v[80:81] op_sel_hi:[1,0,1]
v_cvt_pk_bf16_f32 v170, v80, v81
v_pk_fma_f32 v[82:83], v[34:35], v[224:225], v[82:83] op_sel_hi:[1,0,1]
.Lpad9:
s_cbranch_execz .Lt0r
v_cvt_pk_bf16_f32 v171, v82, v83
v_pk_fma_f32 v[60:61], v[28:29], v[220:221], v[60:61] op_sel_hi:[1,0,1]
v_cvt_pk_bf16_f32 v164, v60, v61
v_pk_fma_f32 v[62:63], v[30:31], v[220:221], v[62:63] op_sel_hi:[1,0,1]
v_cvt_pk_bf16_f32 v165, v62, v63
v_pk_fma_f32 v[76:77], v[32:33], v[220:221], v[76:77] op_sel_hi:[1,0,1]
v_cvt_pk_bf16_f32 v166, v76, v77
v_pk_fma_f32 v[78:79], v[34:35], v[220:221], v[78:79] op_sel_hi:[1,0,1]
s_waitcnt lgkmcnt(0)
s_barrier
v_cvt_pk_bf16_f32 v167, v78, v79
v_mfma_f32_16x16x32_bf16 v[120:123], v[196:199], v[176:179], v[50:53]
ds_read_b128 v[180:183], v9
v_mfma_f32_16x16x32_bf16 v[104:107], v[192:195], v[176:179], v[46:49]
ds_read_b64 v[200:201], v9 offset:1024
v_mfma_f32_16x16x32_bf16 v[116:119], v[192:195], v[172:175], v[50:53]
ds_read_b64 v[210:211], v9 offset:1032
v_mfma_f32_16x16x32_bf16 v[100:103], v[188:191], v[172:175], v[46:49]
ds_read_b128 v[240:243], v11 offset:384
v_mfma_f32_16x16x32_bf16 v[112:115], v[188:191], v[168:171], v[50:53]
ds_read_b128 v[244:247], v11 offset:1408
v_mfma_f32_16x16x32_bf16 v[96:99], v[184:187], v[168:171], v[46:49]
ds_read_b128 v[28:31], v11 offset:320
v_max3_f32 v88, v104, v105, v106
v_mfma_f32_16x16x32_bf16 v[108:111], v[184:187], v[164:167], v[50:53]
ds_read_b128 v[32:35], v11 offset:1344
v_max3_f32 v89, v107, v120, v121
v_max3_f32 v88, v88, v122, v123
v_max_f32 v90, v88, v89
v_max_f32 v89, v88, v89
v_max3_f32 v84, v100, v101, v102
v_max3_f32 v85, v103, v116, v117
s_waitcnt lgkmcnt(6)
v_mfma_f32_16x16x32_bf16 v[92:95], v[180:183], v[164:167], v[46:49]
ds_read_b128 v[36:39], v11 offset:256
v_permlane16_swap_b32 v90, v89
MAA 136,12,96
ds_read_b128 v[40:43], v11 offset:1280
v_max_f32 v88, v90, v89
MAA 136,32,100
v_max_f32 v89, v90, v89
v_max3_f32 v84, v84, v118, v119
MAA 136,52,160
v_permlane32_swap_b32 v88, v89
MAA 136,72,164
v_max_f32 v88, v88, v89
v_mul_f32 v88, v88, v234
MAA 152,72,172
v_max_f32 v86, v84, v85
v_max_f32 v85, v84, v85
MAA 152,52,168
s_nop 0
v_permlane16_swap_b32 v86, v85
MAA 152,32,124
v_max_f32 v84, v86, v85
v_max_f32 v85, v86, v85
MAA 152,12,120
s_nop 0
v_permlane32_swap_b32 v84, v85
v_max3_f32 v80, v96, v97, v98
v_max_f32 v84, v84, v85
v_mul_f32 v84, v84, v230
v_max3_f32 v81, v99, v112, v113
v_max3_f32 v80, v80, v114, v115
v_max_f32 v82, v80, v81
v_max_f32 v81, v80, v81
v_max3_f32 v76, v92, v93, v94
v_max3_f32 v77, v95, v108, v109
v_permlane16_swap_b32 v82, v81
v_max3_f32 v76, v76, v110, v111
v_max_f32 v80, v82, v81
v_max_f32 v81, v82, v81
v_max_f32 v78, v76, v77
v_max_f32 v77, v76, v77
v_permlane32_swap_b32 v80, v81
v_pk_fma_f32 v[104:105], v[104:105], v[234:235], v[88:89] op_sel_hi:[1,0,0] neg_lo:[0,0,1] neg_hi:[0,0,1]
v_max_f32 v80, v80, v81
v_mul_f32 v80, v80, v226
v_permlane16_swap_b32 v78, v77
v_pk_fma_f32 v[106:107], v[106:107], v[234:235], v[88:89] op_sel_hi:[1,0,0] neg_lo:[0,0,1] neg_hi:[0,0,1]
v_max_f32 v76, v78, v77
v_max_f32 v77, v78, v77
v_pk_fma_f32 v[120:121], v[120:121], v[234:235], v[88:89] op_sel_hi:[1,0,0] neg_lo:[0,0,1] neg_hi:[0,0,1]
v_pk_fma_f32 v[122:123], v[122:123], v[234:235], v[88:89] op_sel_hi:[1,0,0] neg_lo:[0,0,1] neg_hi:[0,0,1]
v_permlane32_swap_b32 v76, v77
v_pk_fma_f32 v[100:101], v[100:101], v[230:231], v[84:85] op_sel_hi:[1,0,0] neg_lo:[0,0,1] neg_hi:[0,0,1]
v_max_f32 v76, v76, v77
v_mul_f32 v76, v76, v222
v_pk_fma_f32 v[102:103], v[102:103], v[230:231], v[84:85] op_sel_hi:[1,0,0] neg_lo:[0,0,1] neg_hi:[0,0,1]
v_pk_fma_f32 v[116:117], v[116:117], v[230:231], v[84:85] op_sel_hi:[1,0,0] neg_lo:[0,0,1] neg_hi:[0,0,1]
v_pk_fma_f32 v[118:119], v[118:119], v[230:231], v[84:85] op_sel_hi:[1,0,0] neg_lo:[0,0,1] neg_hi:[0,0,1]
v_pk_fma_f32 v[96:97], v[96:97], v[226:227], v[80:81] op_sel_hi:[1,0,0] neg_lo:[0,0,1] neg_hi:[0,0,1]
v_pk_fma_f32 v[98:99], v[98:99], v[226:227], v[80:81] op_sel_hi:[1,0,0] neg_lo:[0,0,1] neg_hi:[0,0,1]
v_pk_fma_f32 v[112:113], v[112:113], v[226:227], v[80:81] op_sel_hi:[1,0,0] neg_lo:[0,0,1] neg_hi:[0,0,1]
v_pk_fma_f32 v[114:115], v[114:115], v[226:227], v[80:81] op_sel_hi:[1,0,0] neg_lo:[0,0,1] neg_hi:[0,0,1]
v_pk_fma_f32 v[92:93], v[92:93], v[222:223], v[76:77] op_sel_hi:[1,0,0] neg_lo:[0,0,1] neg_hi:[0,0,1]
v_pk_fma_f32 v[94:95], v[94:95], v[222:223], v[76:77] op_sel_hi:[1,0,0] neg_lo:[0,0,1] neg_hi:[0,0,1]
v_pk_fma_f32 v[108:109], v[108:109], v[222:223], v[76:77] op_sel_hi:[1,0,0] neg_lo:[0,0,1] neg_hi:[0,0,1]
v_pk_fma_f32 v[110:111], v[110:111], v[222:223], v[76:77] op_sel_hi:[1,0,0] neg_lo:[0,0,1] neg_hi:[0,0,1]
v_pk_fma_f32 v[136:137], v[18:19], v[44:45], v[136:137] op_sel_hi:[1,0,1]
v_pk_mul_f32 v[136:137], v[136:137], v[22:23]
v_pk_fma_f32 v[138:139], v[20:21], v[44:45], v[138:139] op_sel_hi:[1,0,1]
v_pk_mul_f32 v[138:139], v[138:139], v[24:25]
v_pk_fma_f32 v[152:153], v[18:19], v[44:45], v[152:153] op_sel:[0,1,0] op_sel_hi:[1,1,1]
v_pk_mul_f32 v[152:153], v[152:153], v[22:23]
v_pk_fma_f32 v[154:155], v[20:21], v[44:45], v[154:155] op_sel:[0,1,0] op_sel_hi:[1,1,1]
v_pk_mul_f32 v[154:155], v[154:155], v[24:25]
v_exp_f32 v104, v104
s_nop 0
MAA 132,8,96
v_exp_f32 v105, v105
MAA 132,28,100
v_exp_f32 v106, v106
MAA 132,48,160
v_exp_f32 v107, v107
MAA 132,68,164
v_exp_f32 v120, v120
MAA 148,68,172
v_exp_f32 v121, v121
MAA 148,48,168
v_exp_f32 v122, v122
MAA 148,28,124
v_exp_f32 v123, v123
MAA 148,8,120
v_exp_f32 v100, v100
MAA 128,4,96
v_exp_f32 v101, v101
MAA 128,24,100
v_exp_f32 v102, v102
MAA 128,44,160
v_exp_f32 v103, v103
MAA 128,64,164
v_exp_f32 v116, v116
MAA 144,64,172
v_exp_f32 v117, v117
MAA 144,44,168
v_exp_f32 v118, v118
MAA 144,24,124
v_exp_f32 v119, v119
MAA 144,4,120
v_exp_f32 v96, v96
MAA 124,0,96
v_exp_f32 v97, v97
MAA 124,20,100
v_exp_f32 v98, v98
MAA 124,40,160
v_exp_f32 v99, v99
MAA 124,60,164
v_exp_f32 v112, v112
MAA 140,60,172
v_exp_f32 v113, v113
MAA 140,40,168
v_exp_f32 v114, v114
MAA 140,20,124
v_exp_f32 v115, v115
MAA 140,0,120
v_cvt_pk_bf16_f32 v72, v104, v105
v_cvt_pk_bf16_f32 v73, v106, v107
v_cvt_pk_bf16_f32 v74, v120, v121
v_cvt_pk_bf16_f32 v75, v122, v123
v_cvt_pk_bf16_f32 v68, v100, v101
v_cvt_pk_bf16_f32 v69, v102, v103
v_cvt_pk_bf16_f32 v70, v116, v117
v_cvt_pk_bf16_f32 v71, v118, v119
v_cvt_pk_bf16_f32 v64, v96, v97
v_cvt_pk_bf16_f32 v65, v98, v99
v_cvt_pk_bf16_f32 v66, v112, v113
v_cvt_pk_bf16_f32 v67, v114, v115
v_cvt_pk_bf16_f32 v208, v136, v137
v_cvt_pk_bf16_f32 v209, v138, v139
v_cvt_pk_bf16_f32 v218, v152, v153
v_cvt_pk_bf16_f32 v219, v154, v155
s_waitcnt lgkmcnt(5)
v_pk_fma_f32 v[132:133], v[240:241], v[44:45], v[132:133] op_sel_hi:[1,0,1]
s_waitcnt lgkmcnt(4)
v_pk_mul_f32 v[132:133], v[132:133], v[244:245]
v_cvt_pk_bf16_f32 v206, v132, v133
v_pk_fma_f32 v[134:135], v[242:243], v[44:45], v[134:135] op_sel_hi:[1,0,1]
v_pk_mul_f32 v[134:135], v[134:135], v[246:247]
v_cvt_pk_bf16_f32 v207, v134, v135
v_pk_fma_f32 v[148:149], v[240:241], v[44:45], v[148:149] op_sel:[0,1,0] op_sel_hi:[1,1,1]
v_pk_mul_f32 v[148:149], v[148:149], v[244:245]
v_cvt_pk_bf16_f32 v216, v148, v149
v_pk_fma_f32 v[150:151], v[242:243], v[44:45], v[150:151] op_sel:[0,1,0] op_sel_hi:[1,1,1]
v_pk_mul_f32 v[150:151], v[150:151], v[246:247]
v_cvt_pk_bf16_f32 v217, v150, v151
s_waitcnt lgkmcnt(3)
v_pk_fma_f32 v[128:129], v[28:29], v[44:45], v[128:129] op_sel_hi:[1,0,1]
s_waitcnt lgkmcnt(2)
v_pk_mul_f32 v[128:129], v[128:129], v[32:33]
v_cvt_pk_bf16_f32 v204, v128, v129
v_pk_fma_f32 v[130:131], v[30:31], v[44:45], v[130:131] op_sel_hi:[1,0,1]
v_pk_mul_f32 v[130:131], v[130:131], v[34:35]
v_cvt_pk_bf16_f32 v205, v130, v131
v_pk_fma_f32 v[144:145], v[28:29], v[44:45], v[144:145] op_sel:[0,1,0] op_sel_hi:[1,1,1]
v_pk_mul_f32 v[144:145], v[144:145], v[32:33]
v_cvt_pk_bf16_f32 v214, v144, v145
v_pk_fma_f32 v[146:147], v[30:31], v[44:45], v[146:147] op_sel:[0,1,0] op_sel_hi:[1,1,1]
v_pk_mul_f32 v[146:147], v[146:147], v[34:35]
v_cvt_pk_bf16_f32 v215, v146, v147
s_waitcnt lgkmcnt(1)
v_pk_fma_f32 v[124:125], v[36:37], v[44:45], v[124:125] op_sel_hi:[1,0,1]
s_waitcnt lgkmcnt(0)
v_pk_mul_f32 v[124:125], v[124:125], v[40:41]
v_cvt_pk_bf16_f32 v202, v124, v125
v_pk_fma_f32 v[126:127], v[38:39], v[44:45], v[126:127] op_sel_hi:[1,0,1]
v_pk_mul_f32 v[126:127], v[126:127], v[42:43]
v_cvt_pk_bf16_f32 v203, v126, v127
v_pk_fma_f32 v[140:141], v[36:37], v[44:45], v[140:141] op_sel:[0,1,0] op_sel_hi:[1,1,1]
v_pk_mul_f32 v[140:141], v[140:141], v[40:41]
v_cvt_pk_bf16_f32 v212, v140, v141
v_pk_fma_f32 v[142:143], v[38:39], v[44:45], v[142:143] op_sel:[0,1,0] op_sel_hi:[1,1,1]
v_pk_mul_f32 v[142:143], v[142:143], v[42:43]
v_cvt_pk_bf16_f32 v213, v142, v143
s_nop 0
v_mfma_f32_16x16x32_bf16 v[88:91], v[248:251], v[72:75], 0
v_exp_f32 v92, v92
v_mfma_f32_16x16x32_bf16 v[104:107], v[206:209], v[72:75], 0
v_exp_f32 v93, v93
v_mfma_f32_16x16x32_bf16 v[120:123], v[216:219], v[72:75], 0
v_exp_f32 v94, v94
v_mfma_f32_16x16x32_bf16 v[84:87], v[248:251], v[68:71], 0
v_exp_f32 v95, v95
v_mfma_f32_16x16x32_bf16 v[100:103], v[204:207], v[68:71], 0
v_exp_f32 v108, v108
v_mfma_f32_16x16x32_bf16 v[116:119], v[214:217], v[68:71], 0
v_exp_f32 v109, v109
v_mfma_f32_16x16x32_bf16 v[80:83], v[248:251], v[64:67], 0
v_exp_f32 v110, v110
v_mfma_f32_16x16x32_bf16 v[96:99], v[202:205], v[64:67], 0
v_exp_f32 v111, v111
v_mfma_f32_16x16x32_bf16 v[112:115], v[212:215], v[64:67], 0
v_cvt_pk_bf16_f32 v60, v92, v93
v_cvt_pk_bf16_f32 v61, v94, v95
v_cvt_pk_bf16_f32 v62, v108, v109
v_cvt_pk_bf16_f32 v63, v110, v111
v_rcp_f32 v88, v88
v_rcp_f32 v84, v84
v_mfma_f32_16x16x32_bf16 v[76:79], v[248:251], v[60:63], 0
v_rcp_f32 v80, v80
v_mfma_f32_16x16x32_bf16 v[92:95], v[200:203], v[60:63], 0
v_mfma_f32_16x16x32_bf16 v[108:111], v[210:213], v[60:63], 0
s_nop 4
v_rcp_f32 v76, v76
v_pk_mul_f32 v[104:105], v[104:105], v[88:89] op_sel_hi:[1,0]
v_pk_mul_f32 v[106:107], v[106:107], v[88:89] op_sel_hi:[1,0]
v_pk_mul_f32 v[120:121], v[120:121], v[88:89] op_sel_hi:[1,0]
v_pk_mul_f32 v[122:123], v[122:123], v[88:89] op_sel_hi:[1,0]
v_cvt_pk_bf16_f32 v176, v104, v105
v_cvt_pk_bf16_f32 v177, v106, v107
v_cvt_pk_bf16_f32 v178, v120, v121
v_cvt_pk_bf16_f32 v179, v122, v123
buffer_store_dwordx4 v[176:179], v4, s[16:19], s74 offen offset:3072 sc1
v_pk_mul_f32 v[100:101], v[100:101], v[84:85] op_sel_hi:[1,0]
v_pk_mul_f32 v[102:103], v[102:103], v[84:85] op_sel_hi:[1,0]
v_pk_mul_f32 v[116:117], v[116:117], v[84:85] op_sel_hi:[1,0]
v_pk_mul_f32 v[118:119], v[118:119], v[84:85] op_sel_hi:[1,0]
v_cvt_pk_bf16_f32 v172, v100, v101
v_cvt_pk_bf16_f32 v173, v102, v103
v_cvt_pk_bf16_f32 v174, v116, v117
v_cvt_pk_bf16_f32 v175, v118, v119
buffer_store_dwordx4 v[172:175], v4, s[16:19], s74 offen offset:2048 sc1
v_pk_mul_f32 v[96:97], v[96:97], v[80:81] op_sel_hi:[1,0]
v_pk_mul_f32 v[98:99], v[98:99], v[80:81] op_sel_hi:[1,0]
v_pk_mul_f32 v[112:113], v[112:113], v[80:81] op_sel_hi:[1,0]
v_pk_mul_f32 v[114:115], v[114:115], v[80:81] op_sel_hi:[1,0]
v_cvt_pk_bf16_f32 v168, v96, v97
v_cvt_pk_bf16_f32 v169, v98, v99
v_cvt_pk_bf16_f32 v170, v112, v113
v_cvt_pk_bf16_f32 v171, v114, v115
buffer_store_dwordx4 v[168:171], v4, s[16:19], s74 offen offset:1024 sc1
v_pk_mul_f32 v[92:93], v[92:93], v[76:77] op_sel_hi:[1,0]
v_pk_mul_f32 v[94:95], v[94:95], v[76:77] op_sel_hi:[1,0]
v_pk_mul_f32 v[108:109], v[108:109], v[76:77] op_sel_hi:[1,0]
v_pk_mul_f32 v[110:111], v[110:111], v[76:77] op_sel_hi:[1,0]
v_cvt_pk_bf16_f32 v164, v92, v93
v_cvt_pk_bf16_f32 v165, v94, v95
v_cvt_pk_bf16_f32 v166, v108, v109
v_cvt_pk_bf16_f32 v167, v110, v111
buffer_store_dwordx4 v[164:167], v4, s[16:19], s74 offen sc1
s_nop 1
.Lqkve2:
s_mov_b32 s36, s0
s_mov_b32 s37, s1
s_lshl_b32 s62, s3, 11
s_add_u32 s62, s62, s84
v_lshl_add_u32 v4, v1, 4, s62
v_lshrrev_b32 v2, 3, v1
v_cmp_eq_u32 vcc, 3, v2
v_add_u32 v2, 67108480, v4
s_nop 0
v_cndmask_b32 v4, v4, v2, vcc
v_bfe_u32 v8, v1, 3, 2
v_mul_u32_u24 v8, 2080, v8
v_bfe_u32 v2, v1, 2, 1
v_lshl_add_u32 v8, v2, 7, v8
v_bfe_u32 v2, v1, 5, 1
v_lshl_add_u32 v8, v2, 8, v8
v_and_b32 v2, 3, v1
v_lshl_add_u32 v8, v2, 3, v8
s_mov_b32 s57, 66560
v_add_u32 v7, s57, v8
s_lshr_b32 s54, s87, 17
s_lshl_b32 s54, s54, 18
s_add_u32 s54, s54, 4194304
s_mov_b32 s52, s54
s_add_u32 s53, s54, 131072
v_accvgpr_read_b32 v32, a224
v_accvgpr_read_b32 v33, a225
v_accvgpr_read_b32 v34, a226
v_accvgpr_read_b32 v35, a227
v_accvgpr_read_b32 v36, a228
v_accvgpr_read_b32 v37, a229
v_accvgpr_read_b32 v38, a230
v_accvgpr_read_b32 v39, a231
v_accvgpr_read_b32 v40, a232
v_accvgpr_read_b32 v41, a233
v_accvgpr_read_b32 v42, a234
v_accvgpr_read_b32 v43, a235
v_accvgpr_read_b32 v44, a236
v_accvgpr_read_b32 v45, a237
v_accvgpr_read_b32 v46, a238
v_accvgpr_read_b32 v47, a239
v_accvgpr_read_b32 v48, a240
v_accvgpr_read_b32 v49, a241
v_accvgpr_read_b32 v50, a242
v_accvgpr_read_b32 v51, a243
v_accvgpr_read_b32 v52, a244
v_accvgpr_read_b32 v53, a245
v_accvgpr_read_b32 v54, a246
v_accvgpr_read_b32 v55, a247
v_accvgpr_read_b32 v56, a248
v_accvgpr_read_b32 v57, a249
v_accvgpr_read_b32 v58, a250
v_accvgpr_read_b32 v59, a251
v_accvgpr_read_b32 v60, a252
v_accvgpr_read_b32 v61, a253
v_accvgpr_read_b32 v62, a254
v_accvgpr_read_b32 v63, a255
s_lshl_b32 s62, s8, 10
s_add_u32 s62, s62, 30425088
s_lshl_b32 s64, s6, 10
s_add_u32 s64, s64, 30425088
s_lshr_b32 s67, s5, 2
s_and_b32 s67, s67, 3
s_lshl_b32 s67, s67, 7
s_add_u32 s64, s64, s67
v_lshl_add_u32 v252, v1, 7, s62
v_mov_b32 v253, s64
v_mov_b32 v255, 1
s_waitcnt vmcnt(0) lgkmcnt(0)
s_cmp_lg_u32 s3, 1
s_barrier
s_cbranch_scc1 .Lfirst35
s_mov_b64 exec, 15
buffer_atomic_add v255, v252, s[16:19], 0 offen
s_mov_b64 exec, 1
v_mov_b32 v254, 0
buffer_atomic_add v254, v253, s[16:19], 0 offen sc0
s_mov_b64 exec, -1
.Lfirst35:
s_add_u32 m0, s59, 66560
s_xor_b32 s58, s87, 0
buffer_load_dwordx4 v5, s[24:27], s58 offen lds
buffer_load_dwordx4 v6, s[24:27], s58 offen offset:1024 lds
s_add_u32 m0, s59, 116480
s_xor_b32 s58, s87, 786432
buffer_load_dwordx4 v5, s[24:27], s58 offen lds
buffer_load_dwordx4 v6, s[24:27], s58 offen offset:1024 lds
s_add_u32 m0, s59, 124800
s_xor_b32 s58, s87, 917504
buffer_load_dwordx4 v5, s[24:27], s58 offen lds
buffer_load_dwordx4 v6, s[24:27], s58 offen offset:1024 lds
s_add_u32 m0, s59, 49920
s_xor_b32 s58, s87, 1835008
buffer_load_dwordx4 v5, s[24:27], s58 offen lds
buffer_load_dwordx4 v6, s[24:27], s58 offen offset:1024 lds
s_add_u32 m0, s59, 58240
s_xor_b32 s58, s87, 1966080
buffer_load_dwordx4 v5, s[24:27], s58 offen lds
buffer_load_dwordx4 v6, s[24:27], s58 offen offset:1024 lds
s_cmp_lg_u32 s3, 1
s_cbranch_scc1 .Lnopoll34
s_mov_b64 exec, 1
s_mov_b32 s15, 0
v_mov_b32 v255, 0
buffer_atomic_add v255, v253, s[16:19], 0 offen sc0
s_waitcnt vmcnt(11)
v_cmp_gt_u32 vcc, 16, v254
s_nop 0
s_cbranch_vccz .Lnopoll34r
.Lpoll33:
s_waitcnt vmcnt(0)
v_cmp_gt_u32 vcc, 16, v255
s_add_u32 s15, s15, 1
s_cbranch_vccz .Lnopoll34r
v_mov_b32 v255, 0
buffer_atomic_add v255, v253, s[16:19], 0 offen sc0
s_cmp_le_u32 s15, 100000
s_cbranch_scc1 .Lpoll33
s_branch .Lnopoll34r
.Lnopoll34:
s_mov_b64 exec, 0
s_cmp_eq_u32 s3, 2
s_cbranch_scc1 .Lpad10
s_cmp_eq_u32 s3, 3
s_cbranch_scc1 .Lpad11
s_branch .Lpad12
.Lnopoll34r:
s_mov_b64 exec, -1
s_waitcnt vmcnt(8)
s_barrier
buffer_load_dwordx4 v[64:67], v4, s[16:19], s52 offen sc1
buffer_load_dwordx4 v[68:71], v4, s[16:19], s52 offen offset:1024 sc1
s_xor_b32 s52, s54, 262144
buffer_load_dwordx4 v[72:75], v4, s[16:19], s53 offen sc1
buffer_load_dwordx4 v[76:79], v4, s[16:19], s53 offen offset:1024 sc1
s_xor_b32 s53, s54, 393216
buffer_load_dwordx4 v[80:83], v4, s[16:19], s52 offen sc1
buffer_load_dwordx4 v[84:87], v4, s[16:19], s52 offen offset:1024 sc1
s_xor_b32 s52, s54, 524288
buffer_load_dwordx4 v[88:91], v4, s[16:19], s53 offen sc1
buffer_load_dwordx4 v[92:95], v4, s[16:19], s53 offen offset:1024 sc1
s_xor_b32 s53, s54, 655360
buffer_load_dwordx4 v[96:99], v4, s[16:19], s52 offen sc1
buffer_load_dwordx4 v[100:103], v4, s[16:19], s52 offen offset:1024 sc1
s_xor_b32 s52, s54, 786432
buffer_load_dwordx4 v[104:107], v4, s[16:19], s53 offen sc1
buffer_load_dwordx4 v[108:111], v4, s[16:19], s53 offen offset:1024 sc1
s_xor_b32 s53, s54, 917504
ds_read_b64_tr_b16 a[0:1], v7
TR 2,7,512
TR 16,7,1024
TR 18,7,1536
TR 4,7,32
TR 6,7,544
TR 20,7,1056
TR 22,7,1568
TR 8,7,64
TR 10,7,576
TR 24,7,1088
TR 26,7,1600
TR 12,7,96
TR 14,7,608
TR 28,7,1120
TR 30,7,1632
s_lshl_b32 s62, s49, 3
s_add_u32 s62, s62, s48
s_mul_i32 s62, s62, 28672
s_add_u32 s62, s62, s51
v_lshrrev_b32 v12, 4, v1
v_mul_u32_u24 v12, 57344, v12
v_and_b32 v2, 15, v1
v_lshl_add_u32 v12, v2, 4, v12
v_add_u32 v12, s62, v12
v_add_u32 v13, 6112, v12
v_add_u32 v14, 12224, v12
v_add_u32 v15, 18336, v12
s_mul_i32 s59, s3, 4224
s_mov_b32 s58, 0
s_waitcnt vmcnt(8) lgkmcnt(14)
MAV 32,0,64
TR 32,7,8320
s_waitcnt lgkmcnt(13)
MAV 32,16,72
buffer_load_dwordx4 v[112:115], v4, s[16:19], s52 offen sc1
MAV 48,16,76
TR 34,7,8832
MAV 48,0,68
TR 48,7,9344
TR 50,7,9856
s_waitcnt lgkmcnt(14)
MAV 52,4,68
TR 36,7,8352
s_waitcnt lgkmcnt(13)
MAV 52,20,76
buffer_load_dwordx4 v[116:119], v4, s[16:19], s52 offen offset:1024 sc1
MAV 36,20,72
TR 38,7,8864
s_xor_b32 s52, s54, 1048576
MAV 36,4,64
TR 52,7,9376
TR 54,7,9888
s_waitcnt lgkmcnt(14)
MAV 40,8,64
TR 40,7,8384
s_waitcnt lgkmcnt(13)
MAV 40,24,72
buffer_load_dwordx4 v[120:123], v4, s[16:19], s53 offen sc1
MAV 56,24,76
TR 42,7,8896
MAV 56,8,68
TR 56,7,9408
TR 58,7,9920
s_waitcnt lgkmcnt(14)
MAV 60,12,68
TR 44,7,8416
s_waitcnt lgkmcnt(13)
MAV 60,28,76
buffer_load_dwordx4 v[124:127], v4, s[16:19], s53 offen offset:1024 sc1
MAV 44,28,72
TR 46,7,8928
s_xor_b32 s53, s54, 1179648
MAV 44,12,64
TR 60,7,9440
TR 62,7,9952
s_waitcnt vmcnt(8) lgkmcnt(8)
MAV 32,32,80
TR 0,7,16640
MAV 32,48,88
buffer_load_dwordx4 v[64:67], v4, s[16:19], s52 offen sc1
MAV 48,48,92
TR 2,7,17152
MAV 48,32,84
TR 16,7,17664
TR 18,7,18176
MAV 52,36,84
TR 4,7,16672
MAV 52,52,92
buffer_load_dwordx4 v[68:71], v4, s[16:19], s52 offen offset:1024 sc1
MAV 36,52,88
TR 6,7,17184
s_xor_b32 s52, s54, 1310720
MAV 36,36,80
TR 20,7,17696
TR 22,7,18208
s_waitcnt lgkmcnt(8)
MAV 40,40,80
TR 8,7,16704
MAV 40,56,88
buffer_load_dwordx4 v[72:75], v4, s[16:19], s53 offen sc1
MAV 56,56,92
TR 10,7,17216
MAV 56,40,84
TR 24,7,17728
TR 26,7,18240
MAV 60,44,84
TR 12,7,16736
MAV 60,60,92
buffer_load_dwordx4 v[76:79], v4, s[16:19], s53 offen offset:1024 sc1
MAV 44,60,88
TR 14,7,17248
s_xor_b32 s53, s54, 1441792
MAV 44,44,80
TR 28,7,17760
TR 30,7,18272
s_waitcnt vmcnt(8) lgkmcnt(8)
MAV 32,0,96
TR 32,7,24960
MAV 32,16,104
buffer_load_dwordx4 v[80:83], v4, s[16:19], s52 offen sc1
MAV 48,16,108
TR 34,7,25472
MAV 48,0,100
TR 48,7,25984
TR 50,7,26496
MAV 52,4,100
TR 36,7,24992
MAV 52,20,108
buffer_load_dwordx4 v[84:87], v4, s[16:19], s52 offen offset:1024 sc1
MAV 36,20,104
TR 38,7,25504
s_xor_b32 s52, s54, 1572864
MAV 36,4,96
TR 52,7,26016
TR 54,7,26528
s_waitcnt lgkmcnt(8)
MAV 40,8,96
TR 40,7,25024
MAV 40,24,104
buffer_load_dwordx4 v[88:91], v4, s[16:19], s53 offen sc1
MAV 56,24,108
TR 42,7,25536
MAV 56,8,100
TR 56,7,26048
TR 58,7,26560
MAV 60,12,100
TR 44,7,25056
MAV 60,28,108
buffer_load_dwordx4 v[92:95], v4, s[16:19], s53 offen offset:1024 sc1
MAV 44,28,104
TR 46,7,25568
s_xor_b32 s53, s54, 1703936
MAV 44,12,96
TR 60,7,26080
TR 62,7,26592
s_barrier
s_waitcnt vmcnt(8) lgkmcnt(8)
MAV 32,32,112
TR 0,7,33280
MAV 32,48,120
buffer_load_dwordx4 v[96:99], v4, s[16:19], s52 offen sc1
MAV 48,48,124
TR 2,7,33792
MAV 48,32,116
TR 16,7,34304
.Lpad10:
s_cbranch_execz .Lpad13
TR 18,7,34816
MAV 52,36,116
TR 4,7,33312
MAV 52,52,124
buffer_load_dwordx4 v[100:103], v4, s[16:19], s52 offen offset:1024 sc1
MAV 36,52,120
TR 6,7,33824
s_xor_b32 s52, s54, 1835008
MAV 36,36,112
TR 20,7,34336
TR 22,7,34848
s_waitcnt lgkmcnt(8)
MAV 40,40,112
TR 8,7,33344
MAV 40,56,120
buffer_load_dwordx4 v[104:107], v4, s[16:19], s53 offen sc1
MAV 56,56,124
TR 10,7,33856
MAV 56,40,116
TR 24,7,34368
TR 26,7,34880
MAV 60,44,116
TR 12,7,33376
MAV 60,60,124
buffer_load_dwordx4 v[108:111], v4, s[16:19], s53 offen offset:1024 sc1
MAV 44,60,120
TR 14,7,33888
s_xor_b32 s53, s54, 1966080
MAV 44,44,112
TR 28,7,34400
TR 30,7,34912
s_waitcnt vmcnt(8) lgkmcnt(8)
MAV 32,0,64
TR 32,7,41600
MAV 32,16,72
buffer_load_dwordx4 v[112:115], v4, s[16:19], s52 offen sc1
MAV 48,16,76
TR 34,7,42112
MAV 48,0,68
TR 48,7,42624
TR 50,7,43136
MAV 52,4,68
TR 36,7,41632
MAV 52,20,76
buffer_load_dwordx4 v[116:119], v4, s[16:19], s52 offen offset:1024 sc1
MAV 36,20,72
TR 38,7,42144
s_xor_b32 s52, s54, 2097152
MAV 36,4,64
TR 52,7,42656
TR 54,7,43168
s_waitcnt lgkmcnt(8)
MAV 40,8,64
TR 40,7,41664
MAV 40,24,72
buffer_load_dwordx4 v[120:123], v4, s[16:19], s53 offen sc1
MAV 56,24,76
TR 42,7,42176
MAV 56,8,68
TR 56,7,42688
TR 58,7,43200
MAV 60,12,68
TR 44,7,41696
MAV 60,28,76
buffer_load_dwordx4 v[124:127], v4, s[16:19], s53 offen offset:1024 sc1
MAV 44,28,72
TR 46,7,42208
s_xor_b32 s53, s54, 2228224
MAV 44,12,64
TR 60,7,42720
TR 62,7,43232
s_waitcnt vmcnt(8) lgkmcnt(8)
MAV 32,32,80
TR 0,7,49920
MAV 32,48,88
buffer_load_dwordx4 v[64:67], v4, s[16:19], s52 offen sc1
MAV 48,48,92
TR 2,7,50432
MAV 48,32,84
TR 16,7,50944
TR 18,7,51456
MAV 52,36,84
TR 4,7,49952
MAV 52,52,92
buffer_load_dwordx4 v[68:71], v4, s[16:19], s52 offen offset:1024 sc1
MAV 36,52,88
TR 6,7,50464
s_xor_b32 s52, s54, 2359296
MAV 36,36,80
TR 20,7,50976
TR 22,7,51488
s_waitcnt lgkmcnt(8)
MAV 40,40,80
TR 8,7,49984
MAV 40,56,88
buffer_load_dwordx4 v[72:75], v4, s[16:19], s53 offen sc1
MAV 56,56,92
TR 10,7,50496
MAV 56,40,84
TR 24,7,51008
TR 26,7,51520
MAV 60,44,84
TR 12,7,50016
MAV 60,60,92
buffer_load_dwordx4 v[76:79], v4, s[16:19], s53 offen offset:1024 sc1
MAV 44,60,88
TR 14,7,50528
s_xor_b32 s53, s54, 2490368
MAV 44,44,80
TR 28,7,51040
TR 30,7,51552
s_waitcnt vmcnt(8) lgkmcnt(8)
MAV 32,0,96
TR 32,7,58240
MAV 32,16,104
buffer_load_dwordx4 v[80:83], v4, s[16:19], s52 offen sc1
MAV 48,16,108
TR 34,7,58752
MAV 48,0,100
TR 48,7,59264
TR 50,7,59776
MAV 52,4,100
TR 36,7,58272
MAV 52,20,108
buffer_load_dwordx4 v[84:87], v4, s[16:19], s52 offen offset:1024 sc1
MAV 36,20,104
TR 38,7,58784
s_xor_b32 s52, s54, 2621440
MAV 36,4,96
TR 52,7,59296
TR 54,7,59808
s_waitcnt lgkmcnt(8)
MAV 40,8,96
TR 40,7,58304
MAV 40,24,104
buffer_load_dwordx4 v[88:91], v4, s[16:19], s53 offen sc1
MAV 56,24,108
TR 42,7,58816
MAV 56,8,100
TR 56,7,59328
TR 58,7,59840
MAV 60,12,100
TR 44,7,58336
MAV 60,28,108
buffer_load_dwordx4 v[92:95], v4, s[16:19], s53 offen offset:1024 sc1
MAV 44,28,104
TR 46,7,58848
s_xor_b32 s53, s54, 2752512
MAV 44,12,96
TR 60,7,59360
TR 62,7,59872
s_xor_b32 s57, s57, 66560
v_add_u32 v7, s57, v8
s_waitcnt vmcnt(8) lgkmcnt(8)
MAV 32,32,112
ds_read_b64_tr_b16 a[0:1], v7
MAV 32,48,120
buffer_load_dwordx4 v[96:99], v4, s[16:19], s52 offen sc1
MAV 48,48,124
TR 2,7,512
MAV 48,32,116
TR 16,7,1024
TR 18,7,1536
MAV 52,36,116
TR 4,7,32
MAV 52,52,124
buffer_load_dwordx4 v[100:103], v4, s[16:19], s52 offen offset:1024 sc1
MAV 36,52,120
TR 6,7,544
s_xor_b32 s52, s54, 2883584
MAV 36,36,112
TR 20,7,1056
TR 22,7,1568
s_waitcnt lgkmcnt(8)
MAV 40,40,112
TR 8,7,64
MAV 40,56,120
buffer_load_dwordx4 v[104:107], v4, s[16:19], s53 offen sc1
MAV 56,56,124
TR 10,7,576
MAV 56,40,116
TR 24,7,1088
TR 26,7,1600
MAV 60,44,116
TR 12,7,96
MAV 60,60,124
buffer_load_dwordx4 v[108:111], v4, s[16:19], s53 offen offset:1024 sc1
MAV 44,60,120
TR 14,7,608
s_xor_b32 s53, s54, 3014656
MAV 44,44,112
TR 28,7,1120
TR 30,7,1632
s_waitcnt vmcnt(8) lgkmcnt(8)
MAV 32,0,64
TR 32,7,8320
MAV 32,16,72
buffer_load_dwordx4 v[112:115], v4, s[16:19], s52 offen sc1
MAV 48,16,76
TR 34,7,8832
MAV 48,0,68
TR 48,7,9344
TR 50,7,9856
MAV 52,4,68
TR 36,7,8352
MAV 52,20,76
buffer_load_dwordx4 v[116:119], v4, s[16:19], s52 offen offset:1024 sc1
MAV 36,20,72
TR 38,7,8864
s_xor_b32 s52, s54, 3145728
MAV 36,4,64
TR 52,7,9376
TR 54,7,9888
s_waitcnt lgkmcnt(8)
MAV 40,8,64
TR 40,7,8384
MAV 40,24,72
buffer_load_dwordx4 v[120:123], v4, s[16:19], s53 offen sc1
MAV 56,24,76
TR 42,7,8896
MAV 56,8,68
TR 56,7,9408
TR 58,7,9920
MAV 60,12,68
TR 44,7,8416
MAV 60,28,76
buffer_load_dwordx4 v[124:127], v4, s[16:19], s53 offen offset:1024 sc1
MAV 44,28,72
TR 46,7,8928
s_xor_b32 s53, s54, 3276800
MAV 44,12,64
TR 60,7,9440
TR 62,7,9952
s_waitcnt vmcnt(8) lgkmcnt(8)
MAV 32,32,80
TR 0,7,16640
MAV 32,48,88
buffer_load_dwordx4 v[64:67], v4, s[16:19], s52 offen sc1
MAV 48,48,92
TR 2,7,17152
MAV 48,32,84
TR 16,7,17664
TR 18,7,18176
MAV 52,36,84
TR 4,7,16672
MAV 52,52,92
buffer_load_dwordx4 v[68:71], v4, s[16:19], s52 offen offset:1024 sc1
MAV 36,52,88
TR 6,7,17184
s_xor_b32 s52, s54, 3407872
MAV 36,36,80
TR 20,7,17696
TR 22,7,18208
s_waitcnt lgkmcnt(8)
MAV 40,40,80
TR 8,7,16704
MAV 40,56,88
buffer_load_dwordx4 v[72:75], v4, s[16:19], s53 offen sc1
MAV 56,56,92
TR 10,7,17216
MAV 56,40,84
TR 24,7,17728
TR 26,7,18240
MAV 60,44,84
TR 12,7,16736
MAV 60,60,92
buffer_load_dwordx4 v[76:79], v4, s[16:19], s53 offen offset:1024 sc1
MAV 44,60,88
TR 14,7,17248
s_xor_b32 s53, s54, 3538944
MAV 44,44,80
TR 28,7,17760
TR 30,7,18272
s_waitcnt vmcnt(8) lgkmcnt(8)
MAV 32,0,96
TR 32,7,24960
MAV 32,16,104
buffer_load_dwordx4 v[80:83], v4, s[16:19], s52 offen sc1
MAV 48,16,108
TR 34,7,25472
MAV 48,0,100
TR 48,7,25984
TR 50,7,26496
MAV 52,4,100
TR 36,7,24992
MAV 52,20,108
buffer_load_dwordx4 v[84:87], v4, s[16:19], s52 offen offset:1024 sc1
MAV 36,20,104
TR 38,7,25504
s_xor_b32 s52, s54, 3670016
MAV 36,4,96
TR 52,7,26016
TR 54,7,26528
s_waitcnt lgkmcnt(8)
MAV 40,8,96
TR 40,7,25024
MAV 40,24,104
buffer_load_dwordx4 v[88:91], v4, s[16:19], s53 offen sc1
MAV 56,24,108
TR 42,7,25536
MAV 56,8,100
TR 56,7,26048
TR 58,7,26560
MAV 60,12,100
TR 44,7,25056
MAV 60,28,108
buffer_load_dwordx4 v[92:95], v4, s[16:19], s53 offen offset:1024 sc1
MAV 44,28,104
TR 46,7,25568
s_xor_b32 s53, s54, 3801088
MAV 44,12,96
TR 60,7,26080
TR 62,7,26592
s_waitcnt vmcnt(8) lgkmcnt(8)
MAV 32,32,112
TR 0,7,33280
MAV 32,48,120
buffer_load_dwordx4 v[96:99], v4, s[16:19], s52 offen sc1
MAV 48,48,124
TR 2,7,33792
MAV 48,32,116
TR 16,7,34304
TR 18,7,34816
MAV 52,36,116
TR 4,7,33312
MAV 52,52,124
buffer_load_dwordx4 v[100:103], v4, s[16:19], s52 offen offset:1024 sc1
MAV 36,52,120
TR 6,7,33824
s_xor_b32 s52, s54, 3932160
MAV 36,36,112
TR 20,7,34336
TR 22,7,34848
s_waitcnt lgkmcnt(8)
MAV 40,40,112
TR 8,7,33344
MAV 40,56,120
buffer_load_dwordx4 v[104:107], v4, s[16:19], s53 offen sc1
MAV 56,56,124
TR 10,7,33856
MAV 56,40,116
TR 24,7,34368
TR 26,7,34880
MAV 60,44,116
TR 12,7,33376
MAV 60,60,124
buffer_load_dwordx4 v[108:111], v4, s[16:19], s53 offen offset:1024 sc1
MAV 44,60,120
TR 14,7,33888
s_xor_b32 s53, s54, 4063232
MAV 44,44,112
TR 28,7,34400
TR 30,7,34912
s_waitcnt vmcnt(8) lgkmcnt(8)
MAV 32,0,64
TR 32,7,41600
MAV 32,16,72
buffer_load_dwordx4 v[112:115], v4, s[16:19], s52 offen sc1
MAV 48,16,76
TR 34,7,42112
MAV 48,0,68
TR 48,7,42624
TR 50,7,43136
MAV 52,4,68
TR 36,7,41632
MAV 52,20,76
buffer_load_dwordx4 v[116:119], v4, s[16:19], s52 offen offset:1024 sc1
MAV 36,20,72
TR 38,7,42144
MAV 36,4,64
TR 52,7,42656
TR 54,7,43168
s_waitcnt lgkmcnt(8)
MAV 40,8,64
TR 40,7,41664
MAV 40,24,72
buffer_load_dwordx4 v[120:123], v4, s[16:19], s53 offen sc1
MAV 56,24,76
TR 42,7,42176
MAV 56,8,68
TR 56,7,42688
TR 58,7,43200
MAV 60,12,68
TR 44,7,41696
MAV 60,28,76
buffer_load_dwordx4 v[124:127], v4, s[16:19], s53 offen offset:1024 sc1
MAV 44,28,72
TR 46,7,42208
MAV 44,12,64
TR 60,7,42720
TR 62,7,43232
s_barrier
s_waitcnt vmcnt(8) lgkmcnt(8)
MAV 32,32,80
TR 0,7,49920
s_add_u32 m0, s59, 84480
MAV 32,48,88
buffer_load_dwordx4 v12, s[32:35], s58 offen lds
MAV 48,48,92
TR 2,7,50432
MAV 48,32,84
TR 16,7,50944
TR 18,7,51456
MAV 52,36,84
TR 4,7,49952
MAV 52,52,92
TR 6,7,50464
TR 20,7,50976
MAV 36,52,88
TR 22,7,51488
MAV 36,36,80
TR 8,7,49984
s_waitcnt lgkmcnt(9)
MAV 40,40,80
TR 10,7,50496
MAV 40,56,88
buffer_load_dwordx4 v13, s[32:35], s58 offen offset:1056 lds
MAV 56,56,92
TR 24,7,51008
MAV 56,40,84
buffer_load_dwordx4 v14, s[32:35], s58 offen offset:2112 lds
MAV 60,44,84
TR 26,7,51520
MAV 60,60,92
TR 12,7,50016
TR 14,7,50528
MAV 44,60,88
TR 28,7,51040
MAV 44,44,80
TR 30,7,51552
s_waitcnt vmcnt(7) lgkmcnt(8)
MAV 32,0,96
TR 32,7,58240
MAV 32,16,104
buffer_load_dwordx4 v15, s[32:35], s58 offen offset:3168 lds
MAV 48,16,108
TR 34,7,58752
MAV 48,0,100
TR 48,7,59264
TR 50,7,59776
MAV 52,4,100
TR 36,7,58272
MAV 52,20,108
TR 38,7,58784
TR 52,7,59296
MAV 36,20,104
TR 54,7,59808
MAV 36,4,96
TR 40,7,58304
s_waitcnt lgkmcnt(9)
MAV 40,8,96
TR 42,7,58816
s_add_u32 m0, s59, 101376
MAV 40,24,104
buffer_load_dwordx4 v12, s[80:83], s58 offen lds
MAV 56,24,108
TR 56,7,59328
MAV 56,8,100
buffer_load_dwordx4 v13, s[80:83], s58 offen offset:1056 lds
MAV 60,12,100
TR 58,7,59840
MAV 60,28,108
TR 44,7,58336
TR 46,7,58848
MAV 44,28,104
TR 60,7,59360
MAV 44,12,96
TR 62,7,59872
s_waitcnt vmcnt(9) lgkmcnt(14)
MAV 32,32,112
buffer_load_dwordx4 v14, s[80:83], s58 offen offset:2112 lds
s_waitcnt vmcnt(8) lgkmcnt(12)
MAV 32,48,120
s_lshl_b32 s64, s6, 14
s_lshl_b32 s65, s49, 13
s_add_u32 s64, s64, s65
s_waitcnt vmcnt(7)
MAV 48,48,124
s_lshl_b32 s65, s7, 9
s_add_u32 s64, s64, s65
s_lshl_b32 s65, s48, 8
MAV 48,32,116
s_add_u32 s64, s64, s65
s_add_u32 s64, s64, 29622272
v_and_b32 v152, 31, v1
s_waitcnt lgkmcnt(10)
MAV 52,36,116
buffer_load_dwordx4 v15, s[80:83], s58 offen offset:3168 lds
s_waitcnt lgkmcnt(8)
MAV 52,52,124
s_add_u32 s58, s58, 458752
v_lshlrev_b32 v152, 3, v152
v_lshrrev_b32 v153, 5, v1
MAV 36,52,120
s_lshl_b32 s62, s7, 18
v_lshl_add_u32 v152, v153, 28, v152
s_add_u32 s62, s62, 8388608
MAV 36,36,112
s_add_u32 s63, s62, 131072
v_cvt_pk_bf16_f32 v128, v32, v33
v_cvt_pk_bf16_f32 v129, v34, v35
s_waitcnt lgkmcnt(6)
MAV 40,40,112
v_cvt_pk_bf16_f32 v136, v48, v49
v_cvt_pk_bf16_f32 v137, v50, v51
s_waitcnt lgkmcnt(4)
MAV 40,56,120
v_cvt_pk_bf16_f32 v130, v36, v37
v_cvt_pk_bf16_f32 v131, v38, v39
MAV 56,56,124
buffer_store_dwordx4 v[128:131], v4, s[16:19], s62 offen sc1
MAV 56,40,116
v_cvt_pk_bf16_f32 v138, v52, v53
v_cvt_pk_bf16_f32 v139, v54, v55
s_waitcnt lgkmcnt(2)
MAV 60,44,116
v_cvt_pk_bf16_f32 v132, v40, v41
v_cvt_pk_bf16_f32 v133, v42, v43
s_waitcnt lgkmcnt(0)
MAV 60,60,124
v_cvt_pk_bf16_f32 v140, v56, v57
MAV 44,60,120
buffer_store_dwordx4 v[136:139], v4, s[16:19], s62 offen offset:1024 sc1
MAV 44,44,112
v_cvt_pk_bf16_f32 v141, v58, v59
s_nop 2
v_cvt_pk_bf16_f32 v142, v60, v61
v_pk_mul_f32 v[146:147], v[32:33], v[32:33]
v_pk_mul_f32 v[150:151], v[48:49], v[48:49]
v_cvt_pk_bf16_f32 v143, v62, v63
v_pk_fma_f32 v[146:147], v[34:35], v[34:35], v[146:147]
v_pk_add_f32 v[144:145], v[32:33], v[34:35]
v_pk_fma_f32 v[150:151], v[50:51], v[50:51], v[150:151]
v_cvt_pk_bf16_f32 v134, v44, v45
v_cvt_pk_bf16_f32 v135, v46, v47
.Lpad11:
s_cbranch_execz .Lpad14
buffer_store_dwordx4 v[132:135], v4, s[16:19], s63 offen sc1
v_pk_add_f32 v[148:149], v[48:49], v[50:51]
v_pk_fma_f32 v[146:147], v[36:37], v[36:37], v[146:147]
v_pk_add_f32 v[144:145], v[144:145], v[36:37]
v_pk_fma_f32 v[150:151], v[52:53], v[52:53], v[150:151]
v_pk_add_f32 v[148:149], v[148:149], v[52:53]
v_pk_fma_f32 v[146:147], v[38:39], v[38:39], v[146:147]
v_pk_add_f32 v[144:145], v[144:145], v[38:39]
v_pk_fma_f32 v[150:151], v[54:55], v[54:55], v[150:151]
v_pk_add_f32 v[148:149], v[148:149], v[54:55]
v_pk_fma_f32 v[146:147], v[40:41], v[40:41], v[146:147]
v_pk_add_f32 v[144:145], v[144:145], v[40:41]
v_pk_fma_f32 v[150:151], v[56:57], v[56:57], v[150:151]
v_pk_add_f32 v[148:149], v[148:149], v[56:57]
buffer_store_dwordx4 v[140:143], v4, s[16:19], s63 offen offset:1024 sc1
v_pk_fma_f32 v[146:147], v[42:43], v[42:43], v[146:147]
v_pk_add_f32 v[144:145], v[144:145], v[42:43]
v_pk_fma_f32 v[150:151], v[58:59], v[58:59], v[150:151]
v_pk_add_f32 v[148:149], v[148:149], v[58:59]
v_pk_fma_f32 v[146:147], v[44:45], v[44:45], v[146:147]
v_pk_add_f32 v[144:145], v[144:145], v[44:45]
v_pk_fma_f32 v[150:151], v[60:61], v[60:61], v[150:151]
v_pk_add_f32 v[148:149], v[148:149], v[60:61]
v_pk_fma_f32 v[146:147], v[46:47], v[46:47], v[146:147]
v_pk_add_f32 v[144:145], v[144:145], v[46:47]
v_pk_fma_f32 v[150:151], v[62:63], v[62:63], v[150:151]
v_pk_add_f32 v[148:149], v[148:149], v[62:63]
v_add_f32 v144, v144, v145
v_add_f32 v146, v146, v147
v_add_f32 v148, v148, v149
v_add_f32 v150, v150, v151
s_nop 0
v_permlane16_swap_b32 v144, v148
v_permlane16_swap_b32 v146, v150
v_add_f32 v144, v144, v148
v_add_f32 v146, v146, v150
s_nop 1
v_permlane32_swap_b32 v144, v146
v_add_f32 v144, v144, v146
s_nop 1
v_permlane32_swap_b32 v144, v145
buffer_store_dwordx2 v[144:145], v152, s[16:19], s64 offen sc1
s_nop 1
s_mov_b32 s54, s58
s_mov_b32 s55, s59
v_accvgpr_write_b32 a224, v32
v_accvgpr_write_b32 a225, v33
v_accvgpr_write_b32 a226, v34
v_accvgpr_write_b32 a227, v35
v_accvgpr_write_b32 a228, v36
v_accvgpr_write_b32 a229, v37
v_accvgpr_write_b32 a230, v38
v_accvgpr_write_b32 a231, v39
v_accvgpr_write_b32 a232, v40
v_accvgpr_write_b32 a233, v41
v_accvgpr_write_b32 a234, v42
v_accvgpr_write_b32 a235, v43
v_accvgpr_write_b32 a236, v44
v_accvgpr_write_b32 a237, v45
v_accvgpr_write_b32 a238, v46
v_accvgpr_write_b32 a239, v47
v_accvgpr_write_b32 a240, v48
v_accvgpr_write_b32 a241, v49
v_accvgpr_write_b32 a242, v50
v_accvgpr_write_b32 a243, v51
v_accvgpr_write_b32 a244, v52
v_accvgpr_write_b32 a245, v53
v_accvgpr_write_b32 a246, v54
v_accvgpr_write_b32 a247, v55
v_accvgpr_write_b32 a248, v56
v_accvgpr_write_b32 a249, v57
v_accvgpr_write_b32 a250, v58
v_accvgpr_write_b32 a251, v59
v_accvgpr_write_b32 a252, v60
v_accvgpr_write_b32 a253, v61
v_accvgpr_write_b32 a254, v62
v_accvgpr_write_b32 a255, v63
s_lshl_b32 s62, s10, 14
s_lshl_b32 s63, s3, 12
s_add_u32 s62, s62, s63
s_lshl_b32 s63, s12, 11
s_add_u32 s62, s62, s63
v_lshl_add_u32 v10, v1, 4, s62
v_lshrrev_b32 v2, 3, v1
v_cmp_eq_u32 vcc, 3, v2
v_add_u32 v2, 67108480, v10
s_nop 0
v_cndmask_b32 v10, v10, v2, vcc
v_xor_b32 v11, 2048, v10
v_bfe_u32 v16, v1, 2, 3
v_mul_u32_u24 v16, 1056, v16
v_bfe_u32 v2, v1, 5, 1
v_lshl_add_u32 v16, v2, 8, v16
v_and_b32 v2, 3, v1
v_lshl_add_u32 v16, v2, 3, v16
s_lshl_b32 s62, s12, 6
s_add_u32 s62, s62, 84480
s_xor_b32 s63, s12, 1
s_mul_i32 s63, s63, 192
s_add_u32 s63, s63, 84480
v_add_u32 v17, s63, v16
v_add_u32 v16, s62, v16
s_mov_b32 s52, 8388608
s_mov_b32 s53, 8388608
s_mul_i32 s59, s3, 2112
s_and_b32 s62, s7, 1
s_mul_i32 s62, s62, 3670016
s_lshr_b32 s63, s7, 1
s_lshl_b32 s63, s63, 8
s_add_u32 s62, s62, s63
s_lshl_b32 s63, s3, 12
s_add_u32 s62, s62, s63
v_lshrrev_b32 v5, 4, v1
v_lshlrev_b32 v5, 14, v5
v_and_b32 v2, 15, v1
v_lshl_add_u32 v5, v2, 4, v5
v_add_u32 v5, s62, v5
v_add_u32 v6, 992, v5
s_lshl_b32 s62, s10, 15
s_lshl_b32 s63, s3, 13
s_add_u32 s62, s62, s63
v_lshl_add_u32 v4, v1, 4, s62
s_and_b32 s47, s5, 3
s_lshr_b32 s63, s5, 2
s_lshl_b32 s63, s63, 3
s_add_u32 s63, s63, s4
s_lshl_b32 s62, s63, 1
s_add_u32 s62, s62, s48
s_mul_i32 s62, s62, 1792
v_lshrrev_b32 v7, 1, v1
v_min_u32 v8, 13, v7
v_lshl_add_u32 v8, v8, 7, s62
s_lshl_b32 s62, s63, 2
s_add_u32 s62, s62, s3
s_mul_i32 s62, s62, 640
v_and_b32 v7, 15, v7
v_min_u32 v7, 4, v7
v_lshl_add_u32 v7, v7, 7, s62
v_lshrrev_b32 v2, 5, v1
v_mul_u32_u24 v2, 3670016, v2
v_add_u32 v7, v7, v2
s_mul_i32 s44, s47, 163840
s_add_u32 s45, s47, 12
s_mul_i32 s45, s45, 229376
v_and_b32 v6, 3, v1
v_cmp_eq_u32 vcc, 3, v6
v_mov_b32 v2, 0x3f80
v_mov_b32 v20, 1.0
v_cndmask_b32 v2, v2, v20, vcc
v_cndmask_b32 v6, v6, 0, vcc
v_or_b32 v6, 12, v6
v_mul_u32_u24 v6, 0x1111, v6
v_lshl_or_b32 v6, v6, 16, v6
v_bfe_u32 v22, v1, 2, 2
v_cmp_eq_u32 vcc, 0, v22
s_nop 1
v_cndmask_b32 v20, 0, v2, vcc
v_cmp_eq_u32 vcc, 1, v22
s_nop 1
v_cndmask_b32 v21, 0, v2, vcc
v_accvgpr_write_b32 a208, v20
v_accvgpr_write_b32 a209, v21
v_accvgpr_write_b32 a210, v20
v_accvgpr_write_b32 a211, v21
v_accvgpr_write_b32 a212, 0
v_accvgpr_write_b32 a213, 0
v_accvgpr_write_b32 a214, 0
v_accvgpr_write_b32 a215, 0
v_accvgpr_write_b32 a216, 0
v_accvgpr_write_b32 a217, 0
v_accvgpr_write_b32 a218, 0
v_accvgpr_write_b32 a219, 0
s_cmp_lt_u32 s3, 2
s_cselect_b32 s40, s32, s80
s_cselect_b32 s41, s33, s81
s_cselect_b32 s42, s34, s82
s_add_u32 s62, s55, 84480
v_lshl_add_u32 v9, v1, 4, s62
s_lshl_b32 s62, s6, 10
s_add_u32 s62, s62, 30441472
s_lshl_b32 s64, s10, 1
s_lshl_b32 s64, s64, 10
s_add_u32 s64, s64, 30441472
s_lshr_b32 s67, s5, 2
s_and_b32 s67, s67, 3
s_lshl_b32 s67, s67, 7
s_add_u32 s64, s64, s67
s_add_u32 s65, s64, 1024
v_lshl_add_u32 v252, v1, 7, s62
v_mov_b32 v253, s64
v_mov_b32 v255, 1
v_writelane_b32 v253, s65, 1
s_waitcnt vmcnt(0) lgkmcnt(0)
s_cmp_lg_u32 s3, 1
s_barrier
s_cbranch_scc1 .Lfirst38
s_mov_b64 exec, 15
buffer_atomic_add v255, v252, s[16:19], 0 offen
s_mov_b64 exec, 3
v_mov_b32 v254, 0
buffer_atomic_add v254, v253, s[16:19], 0 offen sc0
s_mov_b64 exec, -1
.Lfirst38:
s_add_u32 m0, s55, 118272
s_nop 0
buffer_load_dwordx4 v12, s[32:35], s54 offen lds
buffer_load_dwordx4 v13, s[32:35], s54 offen offset:1056 lds
buffer_load_dwordx4 v14, s[32:35], s54 offen offset:2112 lds
buffer_load_dwordx4 v15, s[32:35], s54 offen offset:3168 lds
s_add_u32 m0, s55, 135168
s_nop 0
buffer_load_dwordx4 v12, s[80:83], s54 offen lds
buffer_load_dwordx4 v13, s[80:83], s54 offen offset:1056 lds
buffer_load_dwordx4 v14, s[80:83], s54 offen offset:2112 lds
buffer_load_dwordx4 v15, s[80:83], s54 offen offset:3168 lds
s_add_u32 s54, s54, 458752
s_cmp_lg_u32 s3, 1
s_cbranch_scc1 .Lnopoll37
s_mov_b64 exec, 3
s_mov_b32 s15, 0
v_mov_b32 v255, 0
buffer_atomic_add v255, v253, s[16:19], 0 offen sc0
s_waitcnt vmcnt(9)
v_cmp_gt_u32 vcc, 16, v254
s_nop 0
s_cbranch_vccz .Lnopoll37r
.Lpoll36:
s_waitcnt vmcnt(0)
v_cmp_gt_u32 vcc, 16, v255
s_add_u32 s15, s15, 1
s_cbranch_vccz .Lnopoll37r
v_mov_b32 v255, 0
buffer_atomic_add v255, v253, s[16:19], 0 offen sc0
s_cmp_le_u32 s15, 100000
s_cbranch_scc1 .Lpoll36
s_branch .Lnopoll37r
.Lnopoll37:
s_mov_b64 exec, 0
s_cmp_eq_u32 s3, 2
s_cbranch_scc1 .Lpad16
s_cmp_eq_u32 s3, 3
s_cbranch_scc1 .Lpad17
s_branch .Lpad18
.Lnopoll37r:
s_mov_b64 exec, -1
s_waitcnt vmcnt(9)
s_barrier
buffer_load_dwordx4 a[128:131], v10, s[16:19], s52 offen sc1
buffer_load_dwordx4 a[132:135], v10, s[16:19], s52 offen offset:1024 sc1
s_add_u32 s52, s52, 131072
buffer_load_dwordx4 a[144:147], v10, s[16:19], s52 offen sc1
buffer_load_dwordx4 a[148:151], v10, s[16:19], s52 offen offset:1024 sc1
s_add_u32 s52, s52, 131072
buffer_load_dwordx4 a[136:139], v11, s[16:19], s53 offen sc1
buffer_load_dwordx4 a[140:143], v11, s[16:19], s53 offen offset:1024 sc1
s_add_u32 s53, s53, 131072
buffer_load_dwordx4 a[152:155], v11, s[16:19], s53 offen sc1
buffer_load_dwordx4 a[156:159], v11, s[16:19], s53 offen offset:1024 sc1
s_add_u32 s53, s53, 131072
ds_read_b64_tr_b16 a[0:1], v16
TR 2,16,512
TR 4,16,8448
TR 6,16,8960
TR 8,16,32
TR 10,16,544
TR 12,16,8480
TR 14,16,8992
TR 16,16,64
TR 18,16,576
TR 20,16,8512
TR 22,16,9024
TR 24,16,96
TR 26,16,608
TR 28,16,8544
TR 30,16,9056
TR 32,16,128
TR 34,16,640
TR 36,16,8576
TR 38,16,9088
TR 40,16,160
TR 42,16,672
TR 44,16,8608
TR 46,16,9120
ds_read_b64_tr_b16 a[48:49], v17
TR 50,17,512
TR 52,17,8448
TR 54,17,8960
TR 56,17,32
TR 58,17,544
TR 60,17,8480
TR 62,17,8992
ds_read_b128 a[192:195], v9
RD 196,9,1056
RD 200,9,2112
RD 204,9,3168
s_lshl_b32 s57, s3, 13
s_add_u32 s57, s57, 49920
v_lshl_add_u32 v2, v1, 4, s57
s_waitcnt lgkmcnt(0)
s_barrier
s_waitcnt vmcnt(7)
v_mfma_f32_16x16x32_bf16 v[32:35], a[0:3], a[128:131], 0
buffer_load_dwordx4 a[160:163], v10, s[16:19], s52 offen sc1
s_waitcnt vmcnt(6)
MAA 32,4,144
TR 64,16,16896
v_smfmac_f32_16x16x64_bf16 a[212:215], a[208:211], a[192:199], v6
TR 66,16,17408
v_smfmac_f32_16x16x64_bf16 a[212:215], a[208:211], a[200:207], v6
TR 68,16,25344
v_mfma_f32_16x16x32_bf16 v[36:39], a[0:3], a[132:135], 0
TR 70,16,25856
s_waitcnt vmcnt(5)
MAA 36,4,148
buffer_load_dwordx4 a[164:167], v10, s[16:19], s52 offen offset:1024 sc1
v_mfma_f32_16x16x32_bf16 v[52:55], a[8:11], a[132:135], 0
TR 72,16,16928
s_add_u32 s52, s52, 131072
MAA 52,12,148
TR 74,16,17440
v_mfma_f32_16x16x32_bf16 v[48:51], a[8:11], a[128:131], 0
TR 76,16,25376
MAA 48,12,144
TR 78,16,25888
v_mfma_f32_16x16x32_bf16 v[96:99], a[16:19], a[128:131], 0
buffer_load_dwordx4 a[176:179], v10, s[16:19], s52 offen sc1
MAA 96,20,144
TR 80,16,16960
v_mfma_f32_16x16x32_bf16 v[100:103], a[16:19], a[132:135], 0
TR 82,16,17472
MAA 100,20,148
TR 84,16,25408
v_mfma_f32_16x16x32_bf16 v[116:119], a[24:27], a[132:135], 0
TR 86,16,25920
MAA 116,28,148
buffer_load_dwordx4 a[180:183], v10, s[16:19], s52 offen offset:1024 sc1
v_mfma_f32_16x16x32_bf16 v[112:115], a[24:27], a[128:131], 0
TR 88,16,16992
s_add_u32 s52, s52, 131072
MAA 112,28,144
TR 90,16,17504
v_mfma_f32_16x16x32_bf16 v[160:163], a[32:35], a[128:131], 0
TR 92,16,25440
MAA 160,36,144
TR 94,16,25952
v_mfma_f32_16x16x32_bf16 v[164:167], a[32:35], a[132:135], 0
buffer_load_dwordx4 a[168:171], v11, s[16:19], s53 offen sc1
MAA 164,36,148
TR 96,16,17024
v_mfma_f32_16x16x32_bf16 v[180:183], a[40:43], a[132:135], 0
TR 98,16,17536
MAA 180,44,148
TR 100,16,25472
v_mfma_f32_16x16x32_bf16 v[176:179], a[40:43], a[128:131], 0
TR 102,16,25984
MAA 176,44,144
buffer_load_dwordx4 a[172:175], v11, s[16:19], s53 offen offset:1024 sc1
v_mfma_f32_16x16x32_bf16 v[224:227], a[48:51], a[128:131], 0
TR 104,16,17056
s_add_u32 s53, s53, 131072
MAA 224,52,144
TR 106,16,17568
v_mfma_f32_16x16x32_bf16 v[228:231], a[48:51], a[132:135], 0
TR 108,16,25504
MAA 228,52,148
TR 110,16,26016
v_mfma_f32_16x16x32_bf16 v[236:239], a[56:59], a[132:135], 0
buffer_load_dwordx4 a[184:187], v11, s[16:19], s53 offen sc1
MAA 236,60,148
TR 112,17,16896
v_mfma_f32_16x16x32_bf16 v[232:235], a[56:59], a[128:131], 0
TR 114,17,17408
MAA 232,60,144
TR 116,17,25344
s_waitcnt vmcnt(7)
v_mfma_f32_16x16x32_bf16 v[188:191], a[40:43], a[140:143], 0
TR 118,17,25856
MAA 188,44,156
buffer_load_dwordx4 a[188:191], v11, s[16:19], s53 offen offset:1024 sc1
v_mfma_f32_16x16x32_bf16 v[184:187], a[40:43], a[136:139], 0
TR 120,17,16928
s_add_u32 s53, s53, 131072
MAA 184,44,152
TR 122,17,17440
s_add_u32 m0, s55, 84480
v_mfma_f32_16x16x32_bf16 v[168:171], a[32:35], a[136:139], 0
TR 124,17,25376
MAA 168,36,152
TR 126,17,25888
v_mfma_f32_16x16x32_bf16 v[172:175], a[32:35], a[140:143], 0
buffer_load_dwordx4 v12, s[32:35], s54 offen lds
MAA 172,36,156
RD 192,9,16896
v_mfma_f32_16x16x32_bf16 v[124:127], a[24:27], a[140:143], 0
RD 196,9,17952
MAA 124,28,156
RD 200,9,19008
v_mfma_f32_16x16x32_bf16 v[120:123], a[24:27], a[136:139], 0
RD 204,9,20064
MAA 120,28,152
buffer_load_dwordx4 v13, s[32:35], s54 offen offset:1056 lds
v_mfma_f32_16x16x32_bf16 v[104:107], a[16:19], a[136:139], 0
MAA 104,20,152
v_mfma_f32_16x16x32_bf16 v[108:111], a[16:19], a[140:143], 0
MAA 108,20,156
v_mfma_f32_16x16x32_bf16 v[60:63], a[8:11], a[140:143], 0
buffer_load_dwordx4 v14, s[32:35], s54 offen offset:2112 lds
MAA 60,12,156
v_mfma_f32_16x16x32_bf16 v[56:59], a[8:11], a[136:139], 0
MAA 56,12,152
v_mfma_f32_16x16x32_bf16 v[40:43], a[0:3], a[136:139], 0
MAA 40,4,152
buffer_load_dwordx4 v15, s[32:35], s54 offen offset:3168 lds
v_mfma_f32_16x16x32_bf16 v[44:47], a[0:3], a[140:143], 0
MAA 44,4,156
s_waitcnt lgkmcnt(0)
s_barrier
v_mfma_f32_16x16x32_bf16 v[64:67], a[64:67], a[128:131], 0
TR 0,16,33792
s_add_u32 m0, s55, 101376
MAA 64,68,144
buffer_load_dwordx4 v12, s[80:83], s54 offen lds
v_smfmac_f32_16x16x64_bf16 a[216:219], a[208:211], a[192:199], v6
TR 2,16,34304
s_mul_i32 s66, s13, 114688
v_smfmac_f32_16x16x64_bf16 a[216:219], a[208:211], a[200:207], v6
TR 4,16,42240
s_mul_i32 s65, s10, 1818624
v_mfma_f32_16x16x32_bf16 v[68:71], a[64:67], a[132:135], 0
TR 6,16,42752
s_add_u32 s66, s66, s65
MAA 68,68,148
TR 8,16,33824
s_add_u32 s66, s66, 12582912
v_mfma_f32_16x16x32_bf16 v[84:87], a[72:75], a[132:135], 0
buffer_load_dwordx4 v13, s[80:83], s54 offen offset:1056 lds
MAA 84,76,148
TR 10,16,34336
s_add_u32 s65, s66, 49152
v_mfma_f32_16x16x32_bf16 v[80:83], a[72:75], a[128:131], 0
TR 12,16,42272
s_lshl_b32 s62, s12, 16
MAA 80,76,144
TR 14,16,42784
s_add_u32 s62, s62, s66
v_mfma_f32_16x16x32_bf16 v[128:131], a[80:83], a[128:131], 0
TR 16,16,33856
s_add_u32 s63, s62, 16384
MAA 128,84,144
buffer_load_dwordx4 v14, s[80:83], s54 offen offset:2112 lds
v_mfma_f32_16x16x32_bf16 v[132:135], a[80:83], a[132:135], 0
TR 18,16,34368
s_add_u32 s64, s62, 32768
MAA 132,84,148
TR 20,16,42304
s_lshl_b32 s72, s10, 1
v_mfma_f32_16x16x32_bf16 v[148:151], a[88:91], a[132:135], 0
TR 22,16,42816
s_lshr_b32 s74, s11, 4
MAA 148,92,148
TR 24,16,33888
s_add_u32 s72, s72, s74
v_mfma_f32_16x16x32_bf16 v[144:147], a[88:91], a[128:131], 0
buffer_load_dwordx4 v15, s[80:83], s54 offen offset:3168 lds
MAA 144,92,144
TR 26,16,34400
s_add_u32 s54, s54, 458752
v_mfma_f32_16x16x32_bf16 v[192:195], a[96:99], a[128:131], 0
TR 28,16,42336
s_add_u32 m0, s57, 0
MAA 192,100,144
TR 30,16,42848
s_mov_b32 s58, 29622272
v_mfma_f32_16x16x32_bf16 v[196:199], a[96:99], a[132:135], 0
TR 32,16,33920
s_lshl_b32 s72, s72, 10
MAA 196,100,148
buffer_load_dwordx4 v4, s[16:19], s58 offen sc1 lds
v_mfma_f32_16x16x32_bf16 v[212:215], a[104:107], a[132:135], 0
TR 34,16,34432
s_add_u32 s72, s72, 30457856
MAA 212,108,148
TR 36,16,42368
s_and_b32 s73, s6, 14
v_mfma_f32_16x16x32_bf16 v[208:211], a[104:107], a[128:131], 0
TR 38,16,42880
s_and_b32 s74, s7, 1
MAA 208,108,144
TR 40,16,33952
s_add_u32 s73, s73, s74
v_mfma_f32_16x16x32_bf16 v[240:243], a[112:115], a[128:131], 0
buffer_load_dwordx4 v4, s[16:19], s58 offen offset:1024 sc1 lds
MAA 240,116,144
TR 42,16,34464
s_lshl_b32 s73, s73, 10
v_mfma_f32_16x16x32_bf16 v[244:247], a[112:115], a[132:135], 0
TR 44,16,42400
s_add_u32 s73, s73, 30457856
MAA 244,116,148
TR 46,16,42912
s_lshr_b32 s67, s5, 2
v_mfma_f32_16x16x32_bf16 v[252:255], a[120:123], a[132:135], 0
TR 48,17,33792
MAA 252,124,148
TR 50,17,34304
v_mfma_f32_16x16x32_bf16 v[248:251], a[120:123], a[128:131], 0
buffer_load_dwordx4 a[128:131], v10, s[16:19], s52 offen sc1
MAA 248,124,144
TR 52,17,42240
v_mfma_f32_16x16x32_bf16 v[220:223], a[104:107], a[140:143], 0
TR 54,17,42752
MAA 220,108,156
TR 56,17,33824
v_mfma_f32_16x16x32_bf16 v[216:219], a[104:107], a[136:139], 0
TR 58,17,34336
MAA 216,108,152
buffer_load_dwordx4 a[132:135], v10, s[16:19], s52 offen offset:1024 sc1
v_mfma_f32_16x16x32_bf16 v[200:203], a[96:99], a[136:139], 0
TR 60,17,42272
s_add_u32 s52, s52, 131072
MAA 200,100,152
TR 62,17,42784
v_mfma_f32_16x16x32_bf16 v[204:207], a[96:99], a[140:143], 0
RD 192,9,33792
MAA 204,100,156
RD 196,9,34848
v_mfma_f32_16x16x32_bf16 v[156:159], a[88:91], a[140:143], 0
buffer_load_dwordx4 a[144:147], v10, s[16:19], s52 offen sc1
MAA 156,92,156
RD 200,9,35904
v_mfma_f32_16x16x32_bf16 v[152:155], a[88:91], a[136:139], 0
RD 204,9,36960
MAA 152,92,152
v_mfma_f32_16x16x32_bf16 v[136:139], a[80:83], a[136:139], 0
MAA 136,84,152
buffer_load_dwordx4 a[148:151], v10, s[16:19], s52 offen offset:1024 sc1
v_mfma_f32_16x16x32_bf16 v[140:143], a[80:83], a[140:143], 0
s_add_u32 s52, s52, 131072
MAA 140,84,156
v_mfma_f32_16x16x32_bf16 v[92:95], a[72:75], a[140:143], 0
MAA 92,76,156
v_mfma_f32_16x16x32_bf16 v[88:91], a[72:75], a[136:139], 0
MAA 88,76,152
v_mfma_f32_16x16x32_bf16 v[72:75], a[64:67], a[136:139], 0
MAA 72,68,152
v_mfma_f32_16x16x32_bf16 v[76:79], a[64:67], a[140:143], 0
MAA 76,68,156
s_waitcnt vmcnt(18) lgkmcnt(0)
s_barrier
MAA 32,0,160
buffer_load_dwordx4 a[136:139], v11, s[16:19], s53 offen sc1
MAA 32,4,176
TR 64,16,50688
s_and_b32 s67, s67, 3
v_smfmac_f32_16x16x64_bf16 a[212:215], a[208:211], a[192:199], v6
TR 66,16,51200
s_lshl_b32 s67, s67, 7
v_smfmac_f32_16x16x64_bf16 a[212:215], a[208:211], a[200:207], v6
TR 68,16,59136
s_add_u32 s73, s73, s67
MAA 36,4,180
TR 70,16,59648
s_and_b32 s74, s7, 1
MAA 36,0,164
buffer_load_dwordx4 a[140:143], v11, s[16:19], s53 offen offset:1024 sc1
MAA 52,8,164
TR 72,16,50720
s_add_u32 s53, s53, 131072
MAA 52,12,180
TR 74,16,51232
s_mul_i32 s87, s74, 917504
MAA 48,12,176
TR 76,16,59168
s_lshr_b32 s75, s6, 1
MAA 48,8,160
TR 78,16,59680
s_mul_i32 s75, s75, 1818624
MAA 96,16,160
buffer_load_dwordx4 a[152:155], v11, s[16:19], s53 offen sc1
MAA 96,20,176
TR 80,16,50752
s_add_u32 s87, s87, s75
MAA 100,20,180
TR 82,16,51264
s_add_u32 s87, s87, 12582912
MAA 100,16,164
TR 84,16,59200
s_and_b32 s74, s6, 3
MAA 116,24,164
TR 86,16,59712
.Lpad12:
s_cbranch_execz .Lpad15
s_xor_b32 s75, s74, 0
MAA 116,28,180
buffer_load_dwordx4 a[156:159], v11, s[16:19], s53 offen offset:1024 sc1
MAA 112,28,176
TR 88,16,50784
s_add_u32 s53, s53, 131072
MAA 112,24,160
TR 90,16,51296
s_add_u32 m0, s55, 118272
MAA 160,32,160
TR 92,16,59232
s_sub_u32 s75, s75, 0
MAA 160,36,176
TR 94,16,59744
s_mul_i32 s98, s75, 458752
MAA 164,36,180
buffer_load_dwordx4 v12, s[32:35], s54 offen lds
MAA 164,32,164
TR 96,16,50816
s_mul_i32 s75, s75, 114688
MAA 180,40,164
TR 98,16,51328
s_add_u32 s76, s87, s75
MAA 180,44,180
TR 100,16,59264
s_xor_b32 s75, s74, 1
MAA 176,44,176
TR 102,16,59776
s_sub_u32 s75, s75, 1
MAA 176,40,160
buffer_load_dwordx4 v13, s[32:35], s54 offen offset:1056 lds
MAA 224,48,160
TR 104,16,50848
s_mul_i32 s99, s75, 458752
MAA 224,52,176
TR 106,16,51360
s_mul_i32 s75, s75, 114688
MAA 228,52,180
TR 108,16,59296
s_add_u32 s77, s87, s75
MAA 228,48,164
TR 110,16,59808
MAA 236,56,164
buffer_load_dwordx4 v14, s[32:35], s54 offen offset:2112 lds
MAA 236,60,180
TR 112,17,50688
MAA 232,60,176
TR 114,17,51200
MAA 232,56,160
TR 116,17,59136
s_waitcnt vmcnt(21)
MAA 188,40,172
TR 118,17,59648
MAA 188,44,188
buffer_load_dwordx4 v15, s[32:35], s54 offen offset:3168 lds
MAA 184,44,184
TR 120,17,50720
s_add_u32 m0, s57, 2048
MAA 184,40,168
TR 122,17,51232
s_mov_b32 s58, 29624320
MAA 168,32,168
TR 124,17,59168
MAA 168,36,184
TR 126,17,59680
MAA 172,36,188
buffer_load_dwordx4 v4, s[16:19], s58 offen sc1 lds
MAA 172,32,172
RD 192,9,50688
MAA 124,24,172
RD 196,9,51744
MAA 124,28,188
RD 200,9,52800
MAA 120,28,184
RD 204,9,53856
MAA 120,24,168
buffer_load_dwordx4 v4, s[16:19], s58 offen offset:1024 sc1 lds
MAA 104,16,168
MAA 104,20,184
MAA 108,20,188
MAA 108,16,172
MAA 60,8,172
MAA 60,12,188
MAA 56,12,184
MAA 56,8,168
MAA 40,0,168
MAA 40,4,184
MAA 44,4,188
MAA 44,0,172
s_waitcnt vmcnt(20) lgkmcnt(0)
s_barrier
MAA 64,64,160
ds_read_b64_tr_b16 a[0:1], v16
s_add_u32 m0, s55, 135168
MAA 64,68,176
buffer_load_dwordx4 v12, s[80:83], s54 offen lds
v_smfmac_f32_16x16x64_bf16 a[216:219], a[208:211], a[192:199], v6
TR 2,16,512
s_xor_b32 s75, s74, 2
v_smfmac_f32_16x16x64_bf16 a[216:219], a[208:211], a[200:207], v6
TR 4,16,8448
s_sub_u32 s75, s75, 2
MAA 68,68,180
TR 6,16,8960
s_mul_i32 s100, s75, 458752
MAA 68,64,164
TR 8,16,32
s_mul_i32 s75, s75, 114688
MAA 84,72,164
buffer_load_dwordx4 v13, s[80:83], s54 offen offset:1056 lds
MAA 84,76,180
TR 10,16,544
s_add_u32 s78, s87, s75
MAA 80,76,176
TR 12,16,8480
s_xor_b32 s75, s74, 3
MAA 80,72,160
TR 14,16,8992
s_sub_u32 s75, s75, 3
MAA 128,80,160
TR 16,16,64
s_mul_i32 s101, s75, 458752
MAA 128,84,176
buffer_load_dwordx4 v14, s[80:83], s54 offen offset:2112 lds
MAA 132,84,180
TR 18,16,576
s_mul_i32 s75, s75, 114688
MAA 132,80,164
TR 20,16,8512
s_add_u32 s79, s87, s75
MAA 148,88,164
TR 22,16,9024
s_and_b32 s87, s6, 3
MAA 148,92,180
TR 24,16,96
s_mov_b32 s46, 0
MAA 144,92,176
buffer_load_dwordx4 v15, s[80:83], s54 offen offset:3168 lds
MAA 144,88,160
TR 26,16,608
s_add_u32 s54, s54, 458752
MAA 192,96,160
TR 28,16,8544
s_add_u32 m0, s57, 4096
MAA 192,100,176
TR 30,16,9056
s_mov_b32 s58, 29626368
MAA 196,100,180
TR 32,16,128
s_lshl_b32 s74, s3, 10
MAA 196,96,164
buffer_load_dwordx4 v4, s[16:19], s58 offen sc1 lds
MAA 212,104,164
TR 34,16,640
s_lshl_b32 s75, s12, 9
MAA 212,108,180
TR 36,16,8576
s_add_u32 s74, s74, s75
MAA 208,108,176
TR 38,16,9088
s_add_u32 s74, s74, 152576
MAA 208,104,160
TR 40,16,160
v_and_b32 v18, 15, v1
MAA 240,112,160
buffer_load_dwordx4 v4, s[16:19], s58 offen offset:1024 sc1 lds
MAA 240,116,176
TR 42,16,672
v_lshl_add_u32 v18, v18, 4, s74
MAA 244,116,180
TR 44,16,8608
v_xor_b32 v19, 512, v18
MAA 244,112,164
TR 46,16,9120
MAA 252,120,164
ds_read_b64_tr_b16 a[48:49], v17
MAA 252,124,180
TR 50,17,512
MAA 248,124,176
TR 52,17,8448
MAA 248,120,160
buffer_load_dwordx4 a[160:163], v10, s[16:19], s52 offen sc1
MAA 220,104,172
TR 54,17,8960
MAA 220,108,188
TR 56,17,32
MAA 216,108,184
TR 58,17,544
MAA 216,104,168
TR 60,17,8480
MAA 200,96,168
buffer_load_dwordx4 a[164:167], v10, s[16:19], s52 offen offset:1024 sc1
MAA 200,100,184
TR 62,17,8992
s_add_u32 s52, s52, 131072
MAA 204,100,188
ds_read_b128 a[192:195], v9
MAA 204,96,172
RD 196,9,1056
MAA 156,88,172
RD 200,9,2112
MAA 156,92,188
buffer_load_dwordx4 a[176:179], v10, s[16:19], s52 offen sc1
MAA 152,92,184
RD 204,9,3168
MAA 152,88,168
MAA 136,80,168
MAA 136,84,184
MAA 140,84,188
buffer_load_dwordx4 a[180:183], v10, s[16:19], s52 offen offset:1024 sc1
MAA 140,80,172
s_add_u32 s52, s52, 131072
MAA 92,72,172
MAA 92,76,188
MAA 88,76,184
MAA 88,72,168
MAA 72,64,168
MAA 72,68,184
MAA 76,68,188
MAA 76,64,172
s_waitcnt vmcnt(20) lgkmcnt(0)
s_barrier
MAA 32,0,128
buffer_load_dwordx4 a[168:171], v11, s[16:19], s53 offen sc1
MAA 32,4,144
ds_read_b128 v[20:23], v2
v_smfmac_f32_16x16x64_bf16 a[212:215], a[208:211], a[192:199], v6
ds_read_b128 v[28:31], v2 offset:1024
v_smfmac_f32_16x16x64_bf16 a[212:215], a[208:211], a[200:207], v6
s_waitcnt vmcnt(11)
ds_read_b128 v[24:27], v2 offset:2048
MAA 36,4,148
TR 64,16,16896
MAA 36,0,132
buffer_load_dwordx4 a[172:175], v11, s[16:19], s53 offen offset:1024 sc1
MAA 52,8,132
TR 66,16,17408
s_add_u32 s53, s53, 131072
MAA 52,12,148
TR 68,16,25344
MAA 48,12,144
TR 70,16,25856
MAA 48,8,128
TR 72,16,16928
MAA 96,16,128
buffer_load_dwordx4 a[184:187], v11, s[16:19], s53 offen sc1
MAA 96,20,144
TR 74,16,17440
s_waitcnt lgkmcnt(7)
v_add_f32 v20, v20, v28
MAA 100,20,148
TR 76,16,25376
v_add_f32 v21, v21, v29
MAA 100,16,132
TR 78,16,25888
v_add_f32 v22, v22, v30
MAA 116,24,132
TR 80,16,16960
v_add_f32 v23, v23, v31
MAA 116,28,148
buffer_load_dwordx4 a[188:191], v11, s[16:19], s53 offen offset:1024 sc1
MAA 112,28,144
ds_read_b128 v[28:31], v2 offset:3072
s_add_u32 s53, s53, 131072
MAA 112,24,128
TR 82,16,17472
s_add_u32 m0, s55, 84480
MAA 160,32,128
TR 84,16,25408
s_waitcnt lgkmcnt(12)
v_add_f32 v20, v20, v24
MAA 160,36,144
TR 86,16,25920
v_add_f32 v21, v21, v25
MAA 164,36,148
buffer_load_dwordx4 v12, s[32:35], s54 offen lds
MAA 164,32,132
TR 88,16,16992
v_add_f32 v22, v22, v26
MAA 180,40,132
TR 90,16,17504
v_add_f32 v23, v23, v27
MAA 180,44,148
TR 92,16,25440
MAA 176,44,144
TR 94,16,25952
MAA 176,40,128
buffer_load_dwordx4 v13, s[32:35], s54 offen offset:1056 lds
MAA 224,48,128
TR 96,16,17024
MAA 224,52,144
TR 98,16,17536
MAA 228,52,148
TR 100,16,25472
MAA 228,48,132
TR 102,16,25984
MAA 236,56,132
buffer_load_dwordx4 v14, s[32:35], s54 offen offset:2112 lds
MAA 236,60,148
TR 104,16,17056
MAA 232,60,144
TR 106,16,17568
MAA 232,56,128
TR 108,16,25504
MAA 188,40,140
TR 110,16,26016
MAA 188,44,156
buffer_load_dwordx4 v15, s[32:35], s54 offen offset:3168 lds
MAA 184,44,152
TR 112,17,16896
s_add_u32 m0, s57, 6144
MAA 184,40,136
TR 114,17,17408
s_mov_b32 s58, 29628416
MAA 168,32,136
TR 116,17,25344
MAA 168,36,152
TR 118,17,25856
MAA 172,36,156
buffer_load_dwordx4 v4, s[16:19], s58 offen sc1 lds
MAA 172,32,140
TR 120,17,16928
MAA 124,24,140
TR 122,17,17440
MAA 124,28,156
TR 124,17,25376
MAA 120,28,152
TR 126,17,25888
MAA 120,24,136
buffer_load_dwordx4 v4, s[16:19], s58 offen offset:1024 sc1 lds
MAA 104,16,136
RD 192,9,16896
MAA 104,20,152
RD 196,9,17952
MAA 108,20,156
RD 200,9,19008
MAA 108,16,140
RD 204,9,20064
MAA 60,8,140
MAA 60,12,156
MAA 56,12,152
MAA 56,8,136
MAA 40,0,136
MAA 40,4,152
MAA 44,4,156
s_sub_u32 s47, s47, 1
s_cbranch_scc1 .Lx39
.Lx39b:
MAA 44,0,140
s_waitcnt lgkmcnt(0)
s_barrier
MAA 64,64,128
s_waitcnt vmcnt(14)
ds_read_b128 v[24:27], v2 offset:4096
s_add_u32 m0, s55, 101376
MAA 64,68,144
buffer_load_dwordx4 v12, s[80:83], s54 offen lds
v_smfmac_f32_16x16x64_bf16 a[216:219], a[208:211], a[192:199], v6
TR 0,16,33792
v_add_f32 v20, v20, v28
v_smfmac_f32_16x16x64_bf16 a[216:219], a[208:211], a[200:207], v6
TR 2,16,34304
v_add_f32 v21, v21, v29
MAA 68,68,148
TR 4,16,42240
v_add_f32 v22, v22, v30
MAA 68,64,132
TR 6,16,42752
v_add_f32 v23, v23, v31
MAA 84,72,132
ds_read_b128 v[28:31], v2 offset:5120
MAA 84,76,148
TR 8,16,33824
MAA 80,76,144
buffer_load_dwordx4 v13, s[80:83], s54 offen offset:1056 lds
MAA 80,72,128
TR 10,16,34336
s_waitcnt lgkmcnt(7)
v_add_f32 v20, v20, v24
MAA 128,80,128
TR 12,16,42272
v_add_f32 v21, v21, v25
MAA 128,84,144
TR 14,16,42784
v_add_f32 v22, v22, v26
MAA 132,84,148
TR 16,16,33856
v_add_f32 v23, v23, v27
MAA 132,80,132
TR 18,16,34368
MAA 148,88,132
TR 20,16,42304
MAA 148,92,148
buffer_load_dwordx4 v14, s[80:83], s54 offen offset:2112 lds
MAA 144,92,144
TR 22,16,42816
MAA 144,88,128
TR 24,16,33888
MAA 192,96,128
TR 26,16,34400
MAA 192,100,144
TR 28,16,42336
MAA 196,100,148
TR 30,16,42848
MAA 196,96,132
TR 32,16,33920
MAA 212,104,132
buffer_load_dwordx4 v15, s[80:83], s54 offen offset:3168 lds
MAA 212,108,148
TR 34,16,34432
s_add_u32 s54, s54, 458752
MAA 208,108,144
TR 36,16,42368
MAA 208,104,128
TR 38,16,42880
MAA 240,112,128
TR 40,16,33952
MAA 240,116,144
TR 42,16,34464
MAA 244,116,148
TR 44,16,42400
MAA 244,112,132
TR 46,16,42912
MAA 252,120,132
TR 48,17,33792
MAA 252,124,148
TR 50,17,34304
MAA 248,124,144
TR 52,17,42240
MAA 248,120,128
buffer_load_dwordx4 a[128:131], v10, s[16:19], s52 offen sc1
MAA 220,104,140
TR 54,17,42752
MAA 220,108,156
TR 56,17,33824
MAA 216,108,152
TR 58,17,34336
MAA 216,104,136
TR 60,17,42272
MAA 200,96,136
TR 62,17,42784
MAA 200,100,152
RD 192,9,33792
MAA 204,100,156
buffer_load_dwordx4 a[132:135], v10, s[16:19], s52 offen offset:1024 sc1
MAA 204,96,140
RD 196,9,34848
s_add_u32 s52, s52, 131072
MAA 156,88,140
RD 200,9,35904
MAA 156,92,156
RD 204,9,36960
MAA 152,92,152
MAA 152,88,136
MAA 136,80,136
MAA 136,84,152
buffer_load_dwordx4 a[144:147], v10, s[16:19], s52 offen sc1
MAA 140,84,156
MAA 140,80,140
MAA 92,72,140
MAA 92,76,156
MAA 88,76,152
MAA 88,72,136
MAA 72,64,136
buffer_load_dwordx4 a[148:151], v10, s[16:19], s52 offen offset:1024 sc1
MAA 72,68,152
s_add_u32 s52, s52, 131072
MAA 76,68,156
s_sub_u32 s47, s47, 1
s_cbranch_scc1 .Lx40
.Lx40b:
MAA 76,64,140
s_waitcnt vmcnt(18) lgkmcnt(0)
s_barrier
MAA 32,0,160
buffer_load_dwordx4 a[136:139], v11, s[16:19], s53 offen sc1
MAA 32,4,176
s_waitcnt vmcnt(9)
ds_read_b128 v[24:27], v2 offset:6144
v_add_f32 v20, v20, v28
v_smfmac_f32_16x16x64_bf16 a[212:215], a[208:211], a[192:199], v6
TR 64,16,50688
v_add_f32 v21, v21, v29
v_smfmac_f32_16x16x64_bf16 a[212:215], a[208:211], a[200:207], v6
TR 66,16,51200
v_add_f32 v22, v22, v30
MAA 36,4,180
TR 68,16,59136
v_add_f32 v23, v23, v31
MAA 36,0,164
ds_read_b128 v[28:31], v2 offset:7168
MAA 52,8,164
TR 70,16,59648
MAA 52,12,180
buffer_load_dwordx4 a[140:143], v11, s[16:19], s53 offen offset:1024 sc1
MAA 48,12,176
TR 72,16,50720
s_add_u32 s53, s53, 131072
MAA 48,8,160
TR 74,16,51232
s_waitcnt lgkmcnt(7)
v_add_f32 v20, v20, v24
MAA 96,16,160
TR 76,16,59168
v_add_f32 v21, v21, v25
MAA 96,20,176
TR 78,16,59680
v_add_f32 v22, v22, v26
MAA 100,20,180
TR 80,16,50752
v_add_f32 v23, v23, v27
MAA 100,16,164
TR 82,16,51264
s_waitcnt lgkmcnt(7)
v_add_f32 v20, v20, v28
MAA 116,24,164
buffer_load_dwordx4 a[152:155], v11, s[16:19], s53 offen sc1
MAA 116,28,180
TR 84,16,59200
v_add_f32 v21, v21, v29
MAA 112,28,176
TR 86,16,59712
v_add_f32 v22, v22, v30
MAA 112,24,160
TR 88,16,50784
v_add_f32 v23, v23, v31
MAA 160,32,160
TR 90,16,51296
MAA 160,36,176
TR 92,16,59232
MAA 164,36,180
TR 94,16,59744
MAA 164,32,164
buffer_load_dwordx4 a[156:159], v11, s[16:19], s53 offen offset:1024 sc1
MAA 180,40,164
TR 96,16,50816
s_add_u32 s53, s53, 131072
MAA 180,44,180
TR 98,16,51328
s_add_u32 m0, s55, 118272
MAA 176,44,176
TR 100,16,59264
MAA 176,40,160
TR 102,16,59776
MAA 224,48,160
TR 104,16,50848
MAA 224,52,176
.Lpad13:
s_cbranch_execz .Lnopoll34r
TR 106,16,51360
MAA 228,52,180
buffer_load_dwordx4 v12, s[32:35], s54 offen lds
MAA 228,48,164
TR 108,16,59296
MAA 236,56,164
TR 110,16,59808
MAA 236,60,180
TR 112,17,50688
MAA 232,60,176
TR 114,17,51200
MAA 232,56,160
TR 116,17,59136
MAA 188,40,172
TR 118,17,59648
MAA 188,44,188
buffer_load_dwordx4 v13, s[32:35], s54 offen offset:1056 lds
MAA 184,44,184
TR 120,17,50720
MAA 184,40,168
TR 122,17,51232
MAA 168,32,168
TR 124,17,59168
MAA 168,36,184
TR 126,17,59680
MAA 172,36,188
RD 192,9,50688
MAA 172,32,172
RD 196,9,51744
MAA 124,24,172
buffer_load_dwordx4 v14, s[32:35], s54 offen offset:2112 lds
MAA 124,28,188
RD 200,9,52800
MAA 120,28,184
RD 204,9,53856
MAA 120,24,168
MAA 104,16,168
MAA 104,20,184
MAA 108,20,188
MAA 108,16,172
buffer_load_dwordx4 v15, s[32:35], s54 offen offset:3168 lds
MAA 60,8,172
MAA 60,12,188
MAA 56,12,184
MAA 56,8,168
MAA 40,0,168
MAA 40,4,184
MAA 44,4,188
s_sub_u32 s47, s47, 1
s_cbranch_scc1 .Lx41
.Lx41b:
MAA 44,0,172
s_waitcnt lgkmcnt(0)
s_barrier
MAA 64,64,160
ds_read_b64_tr_b16 a[0:1], v16
s_add_u32 m0, s55, 135168
MAA 64,68,176
buffer_load_dwordx4 v12, s[80:83], s54 offen lds
v_smfmac_f32_16x16x64_bf16 a[216:219], a[208:211], a[192:199], v6
TR 2,16,512
v_permlane32_swap_b32 v20, v22
v_smfmac_f32_16x16x64_bf16 a[216:219], a[208:211], a[200:207], v6
TR 4,16,8448
v_permlane32_swap_b32 v21, v23
MAA 68,68,180
TR 6,16,8960
v_add_f32 v20, v20, v22
MAA 68,64,164
TR 8,16,32
v_add_f32 v21, v21, v23
MAA 84,72,164
TR 10,16,544
v_mul_f32 v20, 0xba800000, v20
MAA 84,76,180
buffer_load_dwordx4 v13, s[80:83], s54 offen offset:1056 lds
MAA 80,76,176
TR 12,16,8480
v_mul_f32 v21, 0x3a800000, v21
MAA 80,72,160
TR 14,16,8992
v_fma_f32 v21, -v20, v20, v21
MAA 128,80,160
TR 16,16,64
v_max_f32 v21, 0, v21
MAA 128,84,176
TR 18,16,576
v_add_f32 v21, 0x3727c5ac, v21
MAA 132,84,180
TR 20,16,8512
v_rsq_f32 v22, v21
MAA 132,80,164
TR 22,16,9024
v_and_b32 v24, 31, v1
MAA 148,88,164
buffer_load_dwordx4 v14, s[80:83], s54 offen offset:2112 lds
MAA 148,92,180
TR 24,16,96
v_lshrrev_b32 v25, 5, v1
MAA 144,92,176
TR 26,16,608
v_lshl_add_u32 v24, v24, 1, v25
MAA 144,88,160
TR 28,16,8544
v_and_b32 v25, 0xc0, v0
MAA 192,96,160
TR 30,16,9056
v_add_u32 v24, v24, v25
MAA 192,100,176
TR 32,16,128
v_lshlrev_b32 v24, 4, v24
MAA 196,100,180
TR 34,16,640
v_add_u32 v24, 152576, v24
MAA 196,96,164
buffer_load_dwordx4 v15, s[80:83], s54 offen offset:3168 lds
MAA 212,104,164
TR 36,16,8576
s_add_u32 s54, s54, 458752
MAA 212,108,180
TR 38,16,9088
v_mul_f32 v22, 0xbfb8aa3b, v22
MAA 208,108,176
ds_write_b128 v24, v[20:23]
s_mov_b32 s58, s98
MAA 208,104,160
ds_read_b64 v[20:21], v18
s_mov_b32 s67, s59
MAA 240,112,160
ds_read_b64 v[22:23], v18 offset:256
MAA 240,116,176
ds_read_b64 v[24:25], v19
MAA 244,116,180
ds_read_b64 v[26:27], v19 offset:256
MAA 244,112,164
ds_read_b32 v28, v18 offset:8
MAA 252,120,164
ds_read_b32 v29, v18 offset:264
v_mov_b32 v18, v5
MAA 252,124,180
ds_read_b32 v30, v19 offset:8
MAA 248,124,176
ds_read_b32 v31, v19 offset:264
v_add_u32 v19, 992, v5
MAA 248,120,160
buffer_load_dwordx4 a[160:163], v10, s[16:19], s52 offen sc1
MAA 220,104,172
TR 40,16,160
MAA 220,108,188
TR 42,16,672
MAA 216,108,184
TR 44,16,8608
MAA 216,104,168
TR 46,16,9120
MAA 200,96,168
ds_read_b64_tr_b16 a[48:49], v17
MAA 200,100,184
TR 50,17,512
MAA 204,100,188
buffer_load_dwordx4 a[164:167], v10, s[16:19], s52 offen offset:1024 sc1
MAA 204,96,172
TR 52,17,8448
s_add_u32 s52, s52, 131072
MAA 156,88,172
TR 54,17,8960
MAA 156,92,188
TR 56,17,32
MAA 152,92,184
TR 58,17,544
MAA 152,88,168
TR 60,17,8480
MAA 136,80,168
TR 62,17,8992
MAA 136,84,184
buffer_load_dwordx4 a[176:179], v10, s[16:19], s52 offen sc1
MAA 140,84,188
ds_read_b128 a[192:195], v9
MAA 140,80,172
RD 196,9,1056
MAA 92,72,172
RD 200,9,2112
MAA 92,76,188
RD 204,9,3168
MAA 88,76,184
MAA 88,72,168
MAA 72,64,168
buffer_load_dwordx4 a[180:183], v10, s[16:19], s52 offen offset:1024 sc1
MAA 72,68,184
s_add_u32 s52, s52, 131072
MAA 76,68,188
s_sub_u32 s47, s47, 1
s_cbranch_scc1 .Lx42
.Lx42b:
MAA 76,64,172
s_mov_b32 s15, -5
.p2align 6
.Lk43:
s_waitcnt vmcnt(16) lgkmcnt(0)
s_barrier
MAA 32,0,128
TR 64,16,16896
MAA 32,4,144
buffer_load_dwordx4 a[168:171], v11, s[16:19], s53 offen sc1
v_smfmac_f32_16x16x64_bf16 a[212:215], a[208:211], a[192:199], v6
s_sub_u32 s47, s47, 1
s_cbranch_scc1 .Lx44
.Lx44b:
v_smfmac_f32_16x16x64_bf16 a[212:215], a[208:211], a[200:207], v6
TR 66,16,17408
MAA 36,4,148
TR 68,16,25344
MAA 36,0,132
TR 70,16,25856
MAA 52,8,132
TR 72,16,16928
MAA 52,12,148
buffer_load_dwordx4 a[172:175], v11, s[16:19], s53 offen offset:1024 sc1
MAA 48,12,144
TR 74,16,17440
s_add_u32 s53, s53, 131072
MAA 48,8,128
MAA 96,16,128
TR 76,16,25376
MAA 96,20,144
TR 78,16,25888
MAA 100,20,148
TR 80,16,16960
MAA 100,16,132
buffer_load_dwordx4 a[184:187], v11, s[16:19], s53 offen sc1
MAA 116,24,132
TR 82,16,17472
MAA 116,28,148
TR 84,16,25408
MAA 112,28,144
MAA 112,24,128
TR 86,16,25920
MAA 160,32,128
TR 88,16,16992
MAA 160,36,144
buffer_load_dwordx4 a[188:191], v11, s[16:19], s53 offen offset:1024 sc1
MAA 164,36,148
TR 90,16,17504
s_add_u32 s53, s53, 131072
MAA 164,32,132
TR 92,16,25440
MAA 180,40,132
TR 94,16,25952
MAA 180,44,148
MAA 176,44,144
TR 96,16,17024
s_add_u32 m0, s55, 84480
MAA 176,40,128
buffer_load_dwordx4 v12, s[32:35], s54 offen lds
MAA 224,48,128
TR 98,16,17536
MAA 224,52,144
TR 100,16,25472
MAA 228,52,148
TR 102,16,25984
MAA 228,48,132
TR 104,16,17056
MAA 236,56,132
MAA 236,60,148
TR 106,16,17568
MAA 232,60,144
TR 108,16,25504
MAA 232,56,128
TR 110,16,26016
s_waitcnt vmcnt(17)
MAA 188,40,140
TR 112,17,16896
MAA 188,44,156
buffer_load_dwordx4 v13, s[32:35], s54 offen offset:1056 lds
MAA 184,44,152
TR 114,17,17408
MAA 184,40,136
MAA 168,32,136
TR 116,17,25344
MAA 168,36,152
buffer_load_dwordx4 v14, s[32:35], s54 offen offset:2112 lds
MAA 172,36,156
TR 118,17,25856
MAA 172,32,140
TR 120,17,16928
MAA 124,24,140
TR 122,17,17440
MAA 124,28,156
TR 124,17,25376
MAA 120,28,152
MAA 120,24,136
buffer_load_dwordx4 v15, s[32:35], s54 offen offset:3168 lds
MAA 104,16,136
TR 126,17,25888
MAA 104,20,152
RD 192,9,16896
MAA 108,20,156
RD 196,9,17952
MAA 108,16,140
RD 200,9,19008
MAA 60,8,140
RD 204,9,20064
s_mov_b32 m0, s67
MAA 60,12,156
buffer_load_dwordx4 v18, s[28:31], s58 offen lds
MAA 56,12,152
MAA 56,8,136
MAA 40,0,136
MAA 40,4,152
MAA 44,4,156
MAA 44,0,140
s_waitcnt vmcnt(17) lgkmcnt(0)
s_barrier
MAA 64,64,128
TR 0,16,33792
s_add_u32 m0, s55, 101376
MAA 64,68,144
buffer_load_dwordx4 v12, s[80:83], s54 offen lds
v_smfmac_f32_16x16x64_bf16 a[216:219], a[208:211], a[192:199], v6
s_sub_u32 s47, s47, 1
s_cbranch_scc1 .Lx45
.Lx45b:
v_smfmac_f32_16x16x64_bf16 a[216:219], a[208:211], a[200:207], v6
TR 2,16,34304
MAA 68,68,148
TR 4,16,42240
MAA 68,64,132
TR 6,16,42752
MAA 84,72,132
TR 8,16,33824
MAA 84,76,148
buffer_load_dwordx4 v13, s[80:83], s54 offen offset:1056 lds
MAA 80,76,144
TR 10,16,34336
MAA 80,72,128
MAA 128,80,128
TR 12,16,42272
MAA 128,84,144
TR 14,16,42784
MAA 132,84,148
TR 16,16,33856
MAA 132,80,132
buffer_load_dwordx4 v14, s[80:83], s54 offen offset:2112 lds
MAA 148,88,132
TR 18,16,34368
MAA 148,92,148
TR 20,16,42304
MAA 144,92,144
TR 22,16,42816
MAA 144,88,128
MAA 192,96,128
TR 24,16,33888
MAA 192,100,144
buffer_load_dwordx4 v15, s[80:83], s54 offen offset:3168 lds
MAA 196,100,148
TR 26,16,34400
s_add_u32 s54, s54, 458752
MAA 196,96,132
TR 28,16,42336
MAA 212,104,132
TR 30,16,42848
MAA 212,108,148
TR 32,16,33920
MAA 208,108,144
TR 34,16,34432
s_mov_b32 m0, s67
MAA 208,104,128
buffer_load_dwordx4 v19, s[28:31], s58 offen offset:1056 lds
MAA 240,112,128
s_add_u32 s67, s67, 8448
s_add_u32 s58, s58, 0x40000
MAA 240,116,144
MAA 244,116,148
TR 36,16,42368
MAA 244,112,132
TR 38,16,42880
MAA 252,120,132
TR 40,16,33952
MAA 252,124,148
TR 42,16,34464
MAA 248,124,144
TR 44,16,42400
MAA 248,120,128
buffer_load_dwordx4 a[128:131], v10, s[16:19], s52 offen sc1
MAA 220,104,140
TR 46,16,42912
MAA 220,108,156
MAA 216,108,152
TR 48,17,33792
MAA 216,104,136
TR 50,17,34304
MAA 200,96,136
TR 52,17,42240
MAA 200,100,152
buffer_load_dwordx4 a[132:135], v10, s[16:19], s52 offen offset:1024 sc1
MAA 204,100,156
TR 54,17,42752
s_add_u32 s52, s52, 131072
MAA 204,96,140
TR 56,17,33824
MAA 156,88,140
TR 58,17,34336
MAA 156,92,156
MAA 152,92,152
TR 60,17,42272
MAA 152,88,136
buffer_load_dwordx4 a[144:147], v10, s[16:19], s52 offen sc1
MAA 136,80,136
TR 62,17,42784
MAA 136,84,152
RD 192,9,33792
MAA 140,84,156
RD 196,9,34848
MAA 140,80,140
RD 200,9,35904
MAA 92,72,140
RD 204,9,36960
MAA 92,76,156
buffer_load_dwordx4 a[148:151], v10, s[16:19], s52 offen offset:1024 sc1
MAA 88,76,152
s_add_u32 s52, s52, 131072
MAA 88,72,136
MAA 72,64,136
MAA 72,68,152
MAA 76,68,156
MAA 76,64,140
s_waitcnt vmcnt(18) lgkmcnt(0)
s_barrier
MAA 32,0,160
TR 64,16,50688
MAA 32,4,176
buffer_load_dwordx4 a[136:139], v11, s[16:19], s53 offen sc1
v_smfmac_f32_16x16x64_bf16 a[212:215], a[208:211], a[192:199], v6
s_sub_u32 s47, s47, 1
s_cbranch_scc1 .Lx46
.Lx46b:
v_smfmac_f32_16x16x64_bf16 a[212:215], a[208:211], a[200:207], v6
TR 66,16,51200
MAA 36,4,180
TR 68,16,59136
MAA 36,0,164
TR 70,16,59648
MAA 52,8,164
TR 72,16,50720
MAA 52,12,180
buffer_load_dwordx4 a[140:143], v11, s[16:19], s53 offen offset:1024 sc1
MAA 48,12,176
TR 74,16,51232
s_add_u32 s53, s53, 131072
MAA 48,8,160
MAA 96,16,160
TR 76,16,59168
MAA 96,20,176
TR 78,16,59680
MAA 100,20,180
TR 80,16,50752
MAA 100,16,164
buffer_load_dwordx4 a[152:155], v11, s[16:19], s53 offen sc1
MAA 116,24,164
TR 82,16,51264
MAA 116,28,180
TR 84,16,59200
MAA 112,28,176
MAA 112,24,160
TR 86,16,59712
MAA 160,32,160
TR 88,16,50784
MAA 160,36,176
buffer_load_dwordx4 a[156:159], v11, s[16:19], s53 offen offset:1024 sc1
MAA 164,36,180
TR 90,16,51296
s_add_u32 s53, s53, 131072
MAA 164,32,164
TR 92,16,59232
MAA 180,40,164
TR 94,16,59744
MAA 180,44,180
MAA 176,44,176
TR 96,16,50816
s_add_u32 m0, s55, 118272
MAA 176,40,160
buffer_load_dwordx4 v12, s[32:35], s54 offen lds
MAA 224,48,160
TR 98,16,51328
MAA 224,52,176
TR 100,16,59264
MAA 228,52,180
TR 102,16,59776
MAA 228,48,164
TR 104,16,50848
MAA 236,56,164
MAA 236,60,180
TR 106,16,51360
MAA 232,60,176
TR 108,16,59296
MAA 232,56,160
TR 110,16,59808
s_waitcnt vmcnt(19)
MAA 188,40,172
TR 112,17,50688
MAA 188,44,188
buffer_load_dwordx4 v13, s[32:35], s54 offen offset:1056 lds
MAA 184,44,184
TR 114,17,51200
MAA 184,40,168
MAA 168,32,168
TR 116,17,59136
MAA 168,36,184
buffer_load_dwordx4 v14, s[32:35], s54 offen offset:2112 lds
MAA 172,36,188
TR 118,17,59648
MAA 172,32,172
TR 120,17,50720
MAA 124,24,172
TR 122,17,51232
MAA 124,28,188
TR 124,17,59168
MAA 120,28,184
MAA 120,24,168
buffer_load_dwordx4 v15, s[32:35], s54 offen offset:3168 lds
MAA 104,16,168
TR 126,17,59680
MAA 104,20,184
RD 192,9,50688
MAA 108,20,188
RD 196,9,51744
MAA 108,16,172
RD 200,9,52800
MAA 60,8,172
RD 204,9,53856
s_mov_b32 m0, s67
MAA 60,12,188
buffer_load_dwordx4 v18, s[28:31], s58 offen lds
MAA 56,12,184
MAA 56,8,168
MAA 40,0,168
MAA 40,4,184
MAA 44,4,188
.Lpad14:
s_cbranch_execz .Lnopoll34r
MAA 44,0,172
s_waitcnt vmcnt(19) lgkmcnt(0)
s_barrier
MAA 64,64,160
ds_read_b64_tr_b16 a[0:1], v16
s_add_u32 m0, s55, 135168
MAA 64,68,176
buffer_load_dwordx4 v12, s[80:83], s54 offen lds
v_smfmac_f32_16x16x64_bf16 a[216:219], a[208:211], a[192:199], v6
s_sub_u32 s47, s47, 1
s_cbranch_scc1 .Lx47
.Lx47b:
v_smfmac_f32_16x16x64_bf16 a[216:219], a[208:211], a[200:207], v6
TR 2,16,512
MAA 68,68,180
TR 4,16,8448
MAA 68,64,164
TR 6,16,8960
MAA 84,72,164
TR 8,16,32
MAA 84,76,180
buffer_load_dwordx4 v13, s[80:83], s54 offen offset:1056 lds
MAA 80,76,176
TR 10,16,544
MAA 80,72,160
MAA 128,80,160
TR 12,16,8480
MAA 128,84,176
TR 14,16,8992
MAA 132,84,180
TR 16,16,64
MAA 132,80,164
buffer_load_dwordx4 v14, s[80:83], s54 offen offset:2112 lds
MAA 148,88,164
TR 18,16,576
MAA 148,92,180
TR 20,16,8512
MAA 144,92,176
TR 22,16,9024
MAA 144,88,160
MAA 192,96,160
TR 24,16,96
MAA 192,100,176
buffer_load_dwordx4 v15, s[80:83], s54 offen offset:3168 lds
MAA 196,100,180
TR 26,16,608
s_add_u32 s54, s54, 458752
MAA 196,96,164
TR 28,16,8544
MAA 212,104,164
TR 30,16,9056
MAA 212,108,180
TR 32,16,128
MAA 208,108,176
TR 34,16,640
s_mov_b32 m0, s67
MAA 208,104,160
buffer_load_dwordx4 v19, s[28:31], s58 offen offset:1056 lds
MAA 240,112,160
s_add_u32 s67, s67, 8448
s_add_u32 s46, s46, 1
s_xor_b32 s58, s46, s87
s_mul_i32 s58, s58, 458752
MAA 240,116,176
MAA 244,116,180
TR 36,16,8576
MAA 244,112,164
TR 38,16,9088
MAA 252,120,164
TR 40,16,160
MAA 252,124,180
TR 42,16,672
MAA 248,124,176
TR 44,16,8608
MAA 248,120,160
buffer_load_dwordx4 a[160:163], v10, s[16:19], s52 offen sc1
MAA 220,104,172
TR 46,16,9120
MAA 220,108,188
MAA 216,108,184
ds_read_b64_tr_b16 a[48:49], v17
MAA 216,104,168
TR 50,17,512
MAA 200,96,168
TR 52,17,8448
MAA 200,100,184
buffer_load_dwordx4 a[164:167], v10, s[16:19], s52 offen offset:1024 sc1
MAA 204,100,188
TR 54,17,8960
s_add_u32 s52, s52, 131072
MAA 204,96,172
TR 56,17,32
MAA 156,88,172
TR 58,17,544
MAA 156,92,188
MAA 152,92,184
TR 60,17,8480
MAA 152,88,168
buffer_load_dwordx4 a[176:179], v10, s[16:19], s52 offen sc1
MAA 136,80,168
TR 62,17,8992
MAA 136,84,184
ds_read_b128 a[192:195], v9
MAA 140,84,188
RD 196,9,1056
MAA 140,80,172
RD 200,9,2112
MAA 92,72,172
RD 204,9,3168
MAA 92,76,188
buffer_load_dwordx4 a[180:183], v10, s[16:19], s52 offen offset:1024 sc1
MAA 88,76,184
s_add_u32 s52, s52, 131072
MAA 88,72,168
MAA 72,64,168
MAA 72,68,184
MAA 76,68,188
s_add_u32 s15, s15, 1
MAA 76,64,172
s_cbranch_scc0 .Lk43
s_branch .Lj48
.Lx39:
buffer_load_dword a220, v8, s[40:43], s45 offen
buffer_load_dword a220, v7, s[28:31], s44 offen
s_add_u32 s44, s44, 655360
s_add_u32 s45, s45, 917504
s_mov_b32 s47, 3
s_branch .Lx39b
.Lx40:
buffer_load_dword a220, v8, s[40:43], s45 offen
buffer_load_dword a220, v7, s[28:31], s44 offen
s_add_u32 s44, s44, 655360
s_add_u32 s45, s45, 917504
s_mov_b32 s47, 3
s_branch .Lx40b
.Lx41:
buffer_load_dword a220, v8, s[40:43], s45 offen
buffer_load_dword a220, v7, s[28:31], s44 offen
s_add_u32 s44, s44, 655360
s_add_u32 s45, s45, 917504
s_mov_b32 s47, 3
s_branch .Lx41b
.Lx42:
buffer_load_dword a220, v8, s[40:43], s45 offen
buffer_load_dword a220, v7, s[28:31], s44 offen
s_add_u32 s44, s44, 655360
s_add_u32 s45, s45, 917504
s_mov_b32 s47, 3
s_branch .Lx42b
.Lx44:
buffer_load_dword a220, v8, s[40:43], s45 offen
buffer_load_dword a220, v7, s[28:31], s44 offen
s_add_u32 s44, s44, 655360
s_add_u32 s45, s45, 917504
s_mov_b32 s47, 3
s_branch .Lx44b
.Lx45:
buffer_load_dword a220, v8, s[40:43], s45 offen
buffer_load_dword a220, v7, s[28:31], s44 offen
s_add_u32 s44, s44, 655360
s_add_u32 s45, s45, 917504
s_mov_b32 s47, 3
s_branch .Lx45b
.Lx46:
buffer_load_dword a220, v8, s[40:43], s45 offen
buffer_load_dword a220, v7, s[28:31], s44 offen
s_add_u32 s44, s44, 655360
s_add_u32 s45, s45, 917504
s_mov_b32 s47, 3
s_branch .Lx46b
.Lx47:
buffer_load_dword a220, v8, s[40:43], s45 offen
buffer_load_dword a220, v7, s[28:31], s44 offen
s_add_u32 s44, s44, 655360
s_add_u32 s45, s45, 917504
s_mov_b32 s47, 3
s_branch .Lx47b
.Lj48:
s_waitcnt vmcnt(10) lgkmcnt(0)
s_barrier
v_smfmac_f32_16x16x64_bf16 a[212:215], a[208:211], a[192:199], v6
RD 112,9,16896
s_lshl_b32 s74, s3, 10
v_smfmac_f32_16x16x64_bf16 a[212:215], a[208:211], a[200:207], v6
RD 116,9,17952
s_add_u32 s74, s74, 152576
MAA 32,0,128
RD 120,9,19008
s_sub_u32 s75, 156672, s74
MAA 32,4,144
RD 124,9,20064
v_and_b32 v7, 15, v1
MAA 48,12,144
RD 192,9,33792
v_lshl_add_u32 v7, v7, 5, s74
MAA 48,8,128
RD 196,9,34848
v_bfe_u32 v2, v1, 4, 1
MAA 36,0,132
RD 200,9,35904
v_lshl_add_u32 v7, v2, 4, v7
MAA 36,4,148
RD 204,9,36960
v_bfe_u32 v2, v1, 5, 1
MAA 52,12,148
buffer_load_dwordx4 a[168:171], v11, s[16:19], s53 offen sc1
MAA 52,8,132
TR 64,16,16896
v_mul_u32_u24 v2, s75, v2
s_waitcnt lgkmcnt(7)
v_smfmac_f32_16x16x64_bf16 a[216:219], a[208:211], a[112:119], v6
TR 66,16,17408
v_add_u32 v7, v7, v2
MAA 40,0,136
TR 68,16,25344
v_lshlrev_b32 v2, 4, v1
s_waitcnt lgkmcnt(7)
v_smfmac_f32_16x16x64_bf16 a[216:219], a[208:211], a[120:127], v6
buffer_load_dwordx4 a[172:175], v11, s[16:19], s53 offen offset:1024 sc1
MAA 40,4,152
TR 70,16,25856
s_add_u32 s53, s53, 131072
s_waitcnt lgkmcnt(6)
v_smfmac_f32_16x16x64_bf16 a[212:215], a[208:211], a[192:199], v6
TR 72,16,16928
v_add_u32 v2, 152576, v2
MAA 56,12,152
TR 74,16,17440
s_lshl_b32 s74, s12, 7
s_waitcnt lgkmcnt(6)
v_smfmac_f32_16x16x64_bf16 a[212:215], a[208:211], a[200:207], v6
buffer_load_dwordx4 a[184:187], v11, s[16:19], s53 offen sc1
MAA 56,8,136
TR 76,16,25376
s_add_u32 s74, s74, 161536
MAA 44,0,140
TR 78,16,25888
s_waitcnt vmcnt(8)
s_barrier
MAA 44,4,156
RD 112,9,50688
s_xor_b32 s75, s12, 1
MAA 60,12,156
RD 116,9,51744
s_mul_i32 s75, s75, 384
MAA 60,8,140
RD 120,9,52800
s_add_u32 s75, s75, 161536
MAA 96,16,128
RD 124,9,53856
v_lshrrev_b32 v9, 4, v1
MAA 96,20,144
ds_write_b128 v7, a[212:215]
v_lshlrev_b32 v9, 4, v9
MAA 112,28,144
buffer_load_dwordx4 a[188:191], v11, s[16:19], s53 offen offset:1024 sc1
MAA 112,24,128
TR 80,16,33792
s_add_u32 s53, s53, 131072
MAA 100,16,132
TR 82,16,34304
v_add_u32 v8, s75, v9
MAA 100,20,148
TR 84,16,42240
v_add_u32 v9, s74, v9
MAA 116,28,148
TR 86,16,42752
s_add_u32 s58, s99, 2293760
s_waitcnt lgkmcnt(7)
v_smfmac_f32_16x16x64_bf16 a[216:219], a[208:211], a[112:119], v6
TR 88,16,33824
s_lshl_b32 s74, s3, 11
MAA 116,24,132
TR 90,16,34336
s_add_u32 s74, s74, s84
s_waitcnt lgkmcnt(7)
v_smfmac_f32_16x16x64_bf16 a[216:219], a[208:211], a[120:127], v6
TR 92,16,42272
s_add_u32 s54, s98, 65536
MAA 104,16,136
TR 94,16,42784
s_mul_i32 s55, s3, 2112
MAA 104,20,152
TR 96,16,50688
s_mov_b32 s57, 67584
MAA 120,28,152
ds_write_b128 v7, a[216:219] offset:512
MAA 120,24,136
TR 98,16,51200
MAA 108,16,140
TR 100,16,59136
MAA 108,20,156
TR 102,16,59648
MAA 124,28,156
TR 104,16,50720
MAA 124,24,140
TR 106,16,51232
MAA 160,32,128
TR 108,16,59168
MAA 160,36,144
TR 110,16,59680
MAA 176,44,144
s_waitcnt lgkmcnt(7)
s_barrier
ds_read_b128 v[12:15], v2
MAA 176,40,128
ds_read_b128 v[4:7], v2 offset:1024
MAA 164,32,132
TR 192,16,16960
MAA 164,36,148
TR 194,16,17472
MAA 180,44,148
TR 196,16,25408
MAA 180,40,132
TR 198,16,25920
MAA 168,32,136
TR 200,16,16992
MAA 168,36,152
TR 202,16,17504
MAA 184,44,152
TR 204,16,25440
MAA 184,40,136
TR 206,16,25952
s_waitcnt lgkmcnt(8)
v_add_f32 v12, v12, v4
MAA 172,32,140
TR 112,16,33856
v_add_f32 v13, v13, v5
MAA 172,36,156
TR 114,16,34368
v_add_f32 v14, v14, v6
MAA 188,44,156
TR 116,16,42304
v_add_f32 v15, v15, v7
MAA 188,40,140
ds_read_b128 v[4:7], v2 offset:2048
MAA 224,48,128
TR 118,16,42816
MAA 224,52,144
TR 120,16,33888
MAA 232,60,144
TR 122,16,34400
MAA 232,56,128
TR 124,16,42336
MAA 228,48,132
TR 126,16,42848
MAA 228,52,148
TR 0,16,50752
MAA 236,60,148
TR 2,16,51264
MAA 236,56,132
TR 4,16,59200
s_waitcnt lgkmcnt(8)
v_add_f32 v12, v12, v4
MAA 64,64,128
TR 6,16,59712
v_add_f32 v13, v13, v5
MAA 64,68,144
TR 8,16,50784
v_add_f32 v14, v14, v6
s_waitcnt vmcnt(7)
MAA 64,96,160
TR 10,16,51296
v_add_f32 v15, v15, v7
s_waitcnt vmcnt(5)
MAA 64,100,176
ds_read_b128 v[4:7], v2 offset:3072
MAA 80,108,176
TR 12,16,59232
MAA 80,104,160
TR 14,16,59744
MAA 80,76,144
TR 16,16,17024
MAA 80,72,128
TR 18,16,17536
MAA 32,80,160
TR 20,16,25472
MAA 32,84,176
TR 22,16,25984
MAA 48,92,176
TR 24,16,17056
MAA 48,88,160
TR 26,16,17568
s_waitcnt lgkmcnt(8)
v_add_f32 v12, v12, v4
v_add_f32 v13, v13, v5
v_add_f32 v14, v14, v6
v_add_f32 v15, v15, v7
ds_write_b128 v2, v[12:15] offset:8960
ds_read_b128 v[12:15], v9
ds_read_b128 v[4:7], v9 offset:64
v_lshrrev_b32 v2, 3, v1
v_cmp_eq_u32 vcc, 3, v2
TR 28,16,25504
TR 30,16,26016
TR 32,16,33920
TR 34,16,34432
TR 36,16,42368
TR 38,16,42880
TR 40,16,33952
TR 42,16,34464
TR 44,16,42400
TR 46,16,42912
TR 48,16,50816
TR 50,16,51328
TR 52,16,59264
s_waitcnt lgkmcnt(14)
v_pk_fma_f32 v[32:33], v[12:13], v[20:21], v[32:33] op_sel_hi:[1,0,1]
v_pk_fma_f32 v[34:35], v[14:15], v[20:21], v[34:35] op_sel_hi:[1,0,1]
v_pk_fma_f32 v[36:37], v[12:13], v[22:23], v[36:37] op_sel_hi:[1,0,1]
v_pk_fma_f32 v[38:39], v[14:15], v[22:23], v[38:39] op_sel_hi:[1,0,1]
v_pk_fma_f32 v[40:41], v[12:13], v[24:25], v[40:41] op_sel_hi:[1,0,1]
v_pk_fma_f32 v[42:43], v[14:15], v[24:25], v[42:43] op_sel_hi:[1,0,1]
v_pk_fma_f32 v[44:45], v[12:13], v[26:27], v[44:45] op_sel_hi:[1,0,1]
v_pk_fma_f32 v[46:47], v[14:15], v[26:27], v[46:47] op_sel_hi:[1,0,1]
ds_read_b128 v[12:15], v9 offset:512
s_waitcnt lgkmcnt(14)
v_pk_fma_f32 v[48:49], v[4:5], v[20:21], v[48:49] op_sel_hi:[1,0,1]
v_pk_fma_f32 v[50:51], v[6:7], v[20:21], v[50:51] op_sel_hi:[1,0,1]
v_pk_fma_f32 v[52:53], v[4:5], v[22:23], v[52:53] op_sel_hi:[1,0,1]
v_pk_fma_f32 v[54:55], v[6:7], v[22:23], v[54:55] op_sel_hi:[1,0,1]
v_pk_fma_f32 v[56:57], v[4:5], v[24:25], v[56:57] op_sel_hi:[1,0,1]
v_pk_fma_f32 v[58:59], v[6:7], v[24:25], v[58:59] op_sel_hi:[1,0,1]
v_pk_fma_f32 v[60:61], v[4:5], v[26:27], v[60:61] op_sel_hi:[1,0,1]
v_pk_fma_f32 v[62:63], v[6:7], v[26:27], v[62:63] op_sel_hi:[1,0,1]
ds_read_b128 v[4:7], v9 offset:576
TR 54,16,59776
TR 56,16,50848
TR 58,16,51360
TR 60,16,59296
TR 62,16,59808
s_waitcnt lgkmcnt(6)
v_pk_fma_f32 v[64:65], v[12:13], v[20:21], v[64:65] op_sel_hi:[1,0,1]
v_pk_fma_f32 v[66:67], v[14:15], v[20:21], v[66:67] op_sel_hi:[1,0,1]
v_pk_fma_f32 v[68:69], v[12:13], v[22:23], v[68:69] op_sel_hi:[1,0,1]
v_pk_fma_f32 v[70:71], v[14:15], v[22:23], v[70:71] op_sel_hi:[1,0,1]
v_pk_fma_f32 v[72:73], v[12:13], v[24:25], v[72:73] op_sel_hi:[1,0,1]
v_pk_fma_f32 v[74:75], v[14:15], v[24:25], v[74:75] op_sel_hi:[1,0,1]
v_pk_fma_f32 v[76:77], v[12:13], v[26:27], v[76:77] op_sel_hi:[1,0,1]
v_pk_fma_f32 v[78:79], v[14:15], v[26:27], v[78:79] op_sel_hi:[1,0,1]
ds_read_b128 v[12:15], v9 offset:832
s_waitcnt lgkmcnt(6)
v_pk_fma_f32 v[80:81], v[4:5], v[20:21], v[80:81] op_sel_hi:[1,0,1]
v_pk_fma_f32 v[82:83], v[6:7], v[20:21], v[82:83] op_sel_hi:[1,0,1]
v_pk_fma_f32 v[84:85], v[4:5], v[22:23], v[84:85] op_sel_hi:[1,0,1]
v_pk_fma_f32 v[86:87], v[6:7], v[22:23], v[86:87] op_sel_hi:[1,0,1]
v_pk_fma_f32 v[88:89], v[4:5], v[24:25], v[88:89] op_sel_hi:[1,0,1]
v_pk_fma_f32 v[90:91], v[6:7], v[24:25], v[90:91] op_sel_hi:[1,0,1]
v_pk_fma_f32 v[92:93], v[4:5], v[26:27], v[92:93] op_sel_hi:[1,0,1]
v_pk_fma_f32 v[94:95], v[6:7], v[26:27], v[94:95] op_sel_hi:[1,0,1]
ds_read_b128 v[4:7], v9 offset:704
v_pk_mul_f32 v[64:65], v[64:65], v[32:33]
v_pk_mul_f32 v[32:33], v[32:33], v[28:29] op_sel_hi:[1,0]
v_pk_mul_f32 v[66:67], v[66:67], v[34:35]
v_pk_mul_f32 v[34:35], v[34:35], v[28:29] op_sel_hi:[1,0]
v_pk_mul_f32 v[80:81], v[80:81], v[48:49]
v_pk_mul_f32 v[48:49], v[48:49], v[28:29] op_sel_hi:[1,0]
v_pk_mul_f32 v[82:83], v[82:83], v[50:51]
v_pk_mul_f32 v[50:51], v[50:51], v[28:29] op_sel_hi:[1,0]
v_exp_f32 v32, v32
v_exp_f32 v33, v33
MAA 68,64,132
v_exp_f32 v34, v34
MAA 68,68,148
v_exp_f32 v35, v35
MAA 68,96,164
v_exp_f32 v48, v48
s_waitcnt vmcnt(4)
MAA 68,100,180
v_exp_f32 v49, v49
MAA 84,108,180
v_exp_f32 v50, v50
MAA 84,104,164
v_exp_f32 v51, v51
MAA 84,76,148
MAA 84,72,132
MAA 36,80,164
MAA 36,84,180
MAA 52,92,180
MAA 52,88,164
s_nop 5
v_pk_mul_f32 v[68:69], v[68:69], v[36:37]
v_pk_fma_f32 v[32:33], v[32:33], v[20:21], v[20:21] op_sel:[0,1,1] op_sel_hi:[1,1,1]
v_pk_fma_f32 v[34:35], v[34:35], v[20:21], v[20:21] op_sel:[0,1,1] op_sel_hi:[1,1,1]
v_pk_fma_f32 v[48:49], v[48:49], v[20:21], v[20:21] op_sel:[0,1,1] op_sel_hi:[1,1,1]
v_pk_fma_f32 v[50:51], v[50:51], v[20:21], v[20:21] op_sel:[0,1,1] op_sel_hi:[1,1,1]
v_rcp_f32 v32, v32
v_pk_mul_f32 v[36:37], v[36:37], v[28:29] op_sel:[0,1] op_sel_hi:[1,1]
v_pk_mul_f32 v[70:71], v[70:71], v[38:39]
v_pk_mul_f32 v[38:39], v[38:39], v[28:29] op_sel:[0,1] op_sel_hi:[1,1]
v_pk_mul_f32 v[84:85], v[84:85], v[52:53]
v_pk_mul_f32 v[52:53], v[52:53], v[28:29] op_sel:[0,1] op_sel_hi:[1,1]
v_pk_mul_f32 v[86:87], v[86:87], v[54:55]
v_pk_mul_f32 v[54:55], v[54:55], v[28:29] op_sel:[0,1] op_sel_hi:[1,1]
v_rcp_f32 v33, v33
v_rcp_f32 v34, v34
MAA 72,64,136
v_rcp_f32 v35, v35
MAA 72,68,152
v_rcp_f32 v48, v48
s_waitcnt vmcnt(3)
MAA 72,96,168
v_rcp_f32 v49, v49
s_waitcnt vmcnt(1)
MAA 72,100,184
v_rcp_f32 v50, v50
MAA 88,108,184
v_rcp_f32 v51, v51
MAA 88,104,168
v_exp_f32 v36, v36
MAA 88,76,152
v_exp_f32 v37, v37
MAA 88,72,136
v_exp_f32 v38, v38
MAA 40,80,168
v_exp_f32 v39, v39
MAA 40,84,184
v_exp_f32 v52, v52
MAA 56,92,184
v_exp_f32 v53, v53
MAA 56,88,168
v_exp_f32 v54, v54
v_exp_f32 v55, v55
v_pk_mul_f32 v[64:65], v[64:65], v[32:33]
v_pk_mul_f32 v[66:67], v[66:67], v[34:35]
v_pk_mul_f32 v[80:81], v[80:81], v[48:49]
v_pk_mul_f32 v[82:83], v[82:83], v[50:51]
ds_read_b128 v[48:51], v9 offset:128
v_pk_mul_f32 v[72:73], v[72:73], v[40:41]
v_pk_mul_f32 v[40:41], v[40:41], v[30:31] op_sel_hi:[1,0]
v_pk_mul_f32 v[74:75], v[74:75], v[42:43]
v_pk_mul_f32 v[42:43], v[42:43], v[30:31] op_sel_hi:[1,0]
v_pk_mul_f32 v[88:89], v[88:89], v[56:57]
v_pk_mul_f32 v[56:57], v[56:57], v[30:31] op_sel_hi:[1,0]
v_pk_mul_f32 v[90:91], v[90:91], v[58:59]
v_pk_mul_f32 v[58:59], v[58:59], v[30:31] op_sel_hi:[1,0]
v_pk_fma_f32 v[36:37], v[36:37], v[22:23], v[22:23] op_sel:[0,1,1] op_sel_hi:[1,1,1]
v_pk_fma_f32 v[38:39], v[38:39], v[22:23], v[22:23] op_sel:[0,1,1] op_sel_hi:[1,1,1]
v_pk_fma_f32 v[52:53], v[52:53], v[22:23], v[22:23] op_sel:[0,1,1] op_sel_hi:[1,1,1]
v_pk_fma_f32 v[54:55], v[54:55], v[22:23], v[22:23] op_sel:[0,1,1] op_sel_hi:[1,1,1]
v_cvt_pk_bf16_f32 v32, v64, v65
v_cvt_pk_bf16_f32 v33, v66, v67
ds_read_b128 v[64:67], v9 offset:192
v_cvt_pk_bf16_f32 v34, v80, v81
v_cvt_pk_bf16_f32 v35, v82, v83
MAA 76,64,140
buffer_store_dwordx4 v[32:35], v10, s[16:19], s62 offen sc1
MAA 76,68,156
ds_read_b128 v[80:83], v9 offset:640
v_rcp_f32 v36, v36
MAA 76,96,172
TR 64,17,16896
v_rcp_f32 v37, v37
s_waitcnt vmcnt(1)
MAA 76,100,188
TR 66,17,17408
v_rcp_f32 v38, v38
MAA 92,108,188
TR 68,17,25344
v_rcp_f32 v39, v39
MAA 92,104,172
TR 70,17,25856
v_rcp_f32 v52, v52
MAA 92,76,156
TR 76,17,25376
v_rcp_f32 v53, v53
MAA 92,72,140
TR 72,17,16928
v_rcp_f32 v54, v54
MAA 44,80,172
TR 74,17,17440
v_rcp_f32 v55, v55
MAA 44,84,188
TR 78,17,25888
v_exp_f32 v40, v40
MAA 60,92,188
TR 80,17,33792
.Lpad15:
s_cbranch_execz .Lnopoll34r
v_exp_f32 v41, v41
MAA 60,88,172
TR 82,17,34304
v_exp_f32 v42, v42
v_exp_f32 v43, v43
v_exp_f32 v56, v56
v_exp_f32 v57, v57
v_exp_f32 v58, v58
v_exp_f32 v59, v59
v_pk_mul_f32 v[68:69], v[68:69], v[36:37]
v_pk_mul_f32 v[70:71], v[70:71], v[38:39]
v_pk_mul_f32 v[84:85], v[84:85], v[52:53]
v_pk_mul_f32 v[86:87], v[86:87], v[54:55]
ds_read_b128 v[52:55], v8 offset:576
v_pk_mul_f32 v[76:77], v[76:77], v[44:45]
v_pk_mul_f32 v[44:45], v[44:45], v[30:31] op_sel:[0,1] op_sel_hi:[1,1]
v_pk_mul_f32 v[78:79], v[78:79], v[46:47]
v_pk_mul_f32 v[46:47], v[46:47], v[30:31] op_sel:[0,1] op_sel_hi:[1,1]
v_pk_mul_f32 v[92:93], v[92:93], v[60:61]
v_pk_mul_f32 v[60:61], v[60:61], v[30:31] op_sel:[0,1] op_sel_hi:[1,1]
v_pk_mul_f32 v[94:95], v[94:95], v[62:63]
v_pk_mul_f32 v[62:63], v[62:63], v[30:31] op_sel:[0,1] op_sel_hi:[1,1]
v_pk_fma_f32 v[40:41], v[40:41], v[24:25], v[24:25] op_sel:[0,1,1] op_sel_hi:[1,1,1]
v_pk_fma_f32 v[42:43], v[42:43], v[24:25], v[24:25] op_sel:[0,1,1] op_sel_hi:[1,1,1]
v_pk_fma_f32 v[56:57], v[56:57], v[24:25], v[24:25] op_sel:[0,1,1] op_sel_hi:[1,1,1]
v_pk_fma_f32 v[58:59], v[58:59], v[24:25], v[24:25] op_sel:[0,1,1] op_sel_hi:[1,1,1]
v_cvt_pk_bf16_f32 v36, v68, v69
v_cvt_pk_bf16_f32 v37, v70, v71
v_cvt_pk_bf16_f32 v38, v84, v85
v_cvt_pk_bf16_f32 v39, v86, v87
MAA 128,192,128
buffer_store_dwordx4 v[36:39], v10, s[16:19], s62 offen offset:1024 sc1
MAA 128,196,144
TR 84,17,42240
v_rcp_f32 v40, v40
MAA 128,0,160
TR 86,17,42752
v_rcp_f32 v41, v41
MAA 128,4,176
TR 88,17,33824
v_rcp_f32 v42, v42
MAA 144,12,176
TR 90,17,34336
v_rcp_f32 v43, v43
MAA 144,8,160
TR 92,17,42272
v_rcp_f32 v56, v56
MAA 144,204,144
TR 94,17,42784
v_rcp_f32 v57, v57
MAA 144,200,128
TR 96,17,50688
v_rcp_f32 v58, v58
MAA 96,112,160
TR 98,17,51200
v_rcp_f32 v59, v59
MAA 96,116,176
TR 100,17,59136
v_exp_f32 v44, v44
MAA 112,124,176
TR 102,17,59648
v_exp_f32 v45, v45
MAA 112,120,160
TR 104,17,50720
v_lshrrev_b32 v69, 2, v0
v_min_u32 v69, 1, v69
v_lshlrev_b32 v69, 28, v69
v_lshl_add_u32 v68, v0, 7, v69
v_xor_b32 v69, 64, v0
v_min_u32 v69, 1, v69
v_lshlrev_b32 v70, 4, v69
v_sub_u32 v70, 16, v70
v_lshlrev_b32 v69, 28, v69
v_mov_b32 v71, 1
v_mov_b32 v84, 0
v_mov_b32 v85, 0
v_mov_b32 v86, 0
v_exp_f32 v46, v46
v_exp_f32 v47, v47
v_exp_f32 v60, v60
v_exp_f32 v61, v61
v_exp_f32 v62, v62
v_exp_f32 v63, v63
v_pk_mul_f32 v[72:73], v[72:73], v[40:41]
v_pk_mul_f32 v[74:75], v[74:75], v[42:43]
v_pk_mul_f32 v[88:89], v[88:89], v[56:57]
v_pk_mul_f32 v[90:91], v[90:91], v[58:59]
s_waitcnt lgkmcnt(15)
v_pk_fma_f32 v[96:97], v[48:49], v[20:21], v[96:97] op_sel_hi:[1,0,1]
v_pk_fma_f32 v[98:99], v[50:51], v[20:21], v[98:99] op_sel_hi:[1,0,1]
v_pk_fma_f32 v[112:113], v[64:65], v[20:21], v[112:113] op_sel_hi:[1,0,1]
v_pk_fma_f32 v[114:115], v[66:67], v[20:21], v[114:115] op_sel_hi:[1,0,1]
v_pk_fma_f32 v[128:129], v[80:81], v[20:21], v[128:129] op_sel_hi:[1,0,1]
v_pk_fma_f32 v[130:131], v[82:83], v[20:21], v[130:131] op_sel_hi:[1,0,1]
v_pk_fma_f32 v[144:145], v[4:5], v[20:21], v[144:145] op_sel_hi:[1,0,1]
v_pk_fma_f32 v[146:147], v[6:7], v[20:21], v[146:147] op_sel_hi:[1,0,1]
v_pk_mul_f32 v[128:129], v[128:129], v[96:97]
v_pk_mul_f32 v[96:97], v[96:97], v[28:29] op_sel_hi:[1,0]
v_pk_mul_f32 v[130:131], v[130:131], v[98:99]
v_pk_mul_f32 v[98:99], v[98:99], v[28:29] op_sel_hi:[1,0]
v_pk_mul_f32 v[144:145], v[144:145], v[112:113]
v_pk_mul_f32 v[112:113], v[112:113], v[28:29] op_sel_hi:[1,0]
v_pk_mul_f32 v[146:147], v[146:147], v[114:115]
v_pk_mul_f32 v[114:115], v[114:115], v[28:29] op_sel_hi:[1,0]
v_pk_fma_f32 v[44:45], v[44:45], v[26:27], v[26:27] op_sel:[0,1,1] op_sel_hi:[1,1,1]
v_pk_fma_f32 v[46:47], v[46:47], v[26:27], v[26:27] op_sel:[0,1,1] op_sel_hi:[1,1,1]
v_pk_fma_f32 v[60:61], v[60:61], v[26:27], v[26:27] op_sel:[0,1,1] op_sel_hi:[1,1,1]
v_pk_fma_f32 v[62:63], v[62:63], v[26:27], v[26:27] op_sel:[0,1,1] op_sel_hi:[1,1,1]
v_cvt_pk_bf16_f32 v40, v72, v73
v_cvt_pk_bf16_f32 v41, v74, v75
v_cvt_pk_bf16_f32 v42, v88, v89
v_cvt_pk_bf16_f32 v43, v90, v91
MAA 132,192,132
buffer_store_dwordx4 v[40:43], v11, s[16:19], s62 offen sc1
MAA 132,196,148
TR 106,17,51232
v_rcp_f32 v44, v44
MAA 132,0,164
TR 108,17,59168
v_rcp_f32 v45, v45
MAA 132,4,180
TR 110,17,59680
v_rcp_f32 v46, v46
MAA 148,12,180
v_rcp_f32 v47, v47
MAA 148,8,164
v_rcp_f32 v60, v60
MAA 148,204,148
v_rcp_f32 v61, v61
MAA 148,200,132
v_rcp_f32 v62, v62
MAA 100,112,164
v_rcp_f32 v63, v63
MAA 100,116,180
v_exp_f32 v96, v96
MAA 116,124,180
v_exp_f32 v97, v97
MAA 116,120,164
s_waitcnt lgkmcnt(0)
s_barrier
s_add_u32 m0, s59, 84480
v_exp_f32 v98, v98
v_exp_f32 v99, v99
v_exp_f32 v112, v112
v_exp_f32 v113, v113
v_exp_f32 v114, v114
v_exp_f32 v115, v115
v_pk_mul_f32 v[76:77], v[76:77], v[44:45]
v_pk_mul_f32 v[78:79], v[78:79], v[46:47]
v_pk_mul_f32 v[92:93], v[92:93], v[60:61]
v_pk_mul_f32 v[94:95], v[94:95], v[62:63]
v_pk_fma_f32 v[100:101], v[48:49], v[22:23], v[100:101] op_sel_hi:[1,0,1]
v_pk_fma_f32 v[102:103], v[50:51], v[22:23], v[102:103] op_sel_hi:[1,0,1]
v_pk_fma_f32 v[116:117], v[64:65], v[22:23], v[116:117] op_sel_hi:[1,0,1]
v_pk_fma_f32 v[118:119], v[66:67], v[22:23], v[118:119] op_sel_hi:[1,0,1]
v_pk_fma_f32 v[132:133], v[80:81], v[22:23], v[132:133] op_sel_hi:[1,0,1]
v_pk_fma_f32 v[134:135], v[82:83], v[22:23], v[134:135] op_sel_hi:[1,0,1]
v_pk_fma_f32 v[148:149], v[4:5], v[22:23], v[148:149] op_sel_hi:[1,0,1]
v_pk_fma_f32 v[150:151], v[6:7], v[22:23], v[150:151] op_sel_hi:[1,0,1]
v_pk_mul_f32 v[132:133], v[132:133], v[100:101]
v_pk_mul_f32 v[100:101], v[100:101], v[28:29] op_sel:[0,1] op_sel_hi:[1,1]
v_pk_mul_f32 v[134:135], v[134:135], v[102:103]
v_pk_mul_f32 v[102:103], v[102:103], v[28:29] op_sel:[0,1] op_sel_hi:[1,1]
v_pk_mul_f32 v[148:149], v[148:149], v[116:117]
v_pk_mul_f32 v[116:117], v[116:117], v[28:29] op_sel:[0,1] op_sel_hi:[1,1]
v_pk_mul_f32 v[150:151], v[150:151], v[118:119]
v_pk_mul_f32 v[118:119], v[118:119], v[28:29] op_sel:[0,1] op_sel_hi:[1,1]
v_pk_fma_f32 v[96:97], v[96:97], v[20:21], v[20:21] op_sel:[0,1,1] op_sel_hi:[1,1,1]
v_pk_fma_f32 v[98:99], v[98:99], v[20:21], v[20:21] op_sel:[0,1,1] op_sel_hi:[1,1,1]
v_pk_fma_f32 v[112:113], v[112:113], v[20:21], v[20:21] op_sel:[0,1,1] op_sel_hi:[1,1,1]
v_pk_fma_f32 v[114:115], v[114:115], v[20:21], v[20:21] op_sel:[0,1,1] op_sel_hi:[1,1,1]
v_cvt_pk_bf16_f32 v44, v76, v77
v_cvt_pk_bf16_f32 v45, v78, v79
v_cvt_pk_bf16_f32 v46, v92, v93
v_cvt_pk_bf16_f32 v47, v94, v95
MAA 136,192,136
buffer_store_dwordx4 v[44:47], v11, s[16:19], s62 offen offset:1024 sc1
MAA 136,196,152
v_rcp_f32 v96, v96
MAA 136,0,168
v_rcp_f32 v97, v97
MAA 136,4,184
v_rcp_f32 v98, v98
MAA 152,12,184
buffer_load_dwordx4 v18, s[28:31], s58 offen lds
MAA 152,8,168
v_rcp_f32 v99, v99
MAA 152,204,152
v_rcp_f32 v112, v112
MAA 152,200,136
v_rcp_f32 v113, v113
MAA 104,112,168
buffer_load_dwordx4 v19, s[28:31], s58 offen offset:1056 lds
MAA 104,116,184
s_add_u32 m0, s59, 92928
s_add_u32 s58, s99, 2555904
v_rcp_f32 v114, v114
MAA 120,124,184
v_rcp_f32 v115, v115
MAA 120,120,168
v_exp_f32 v100, v100
v_exp_f32 v101, v101
v_exp_f32 v102, v102
v_exp_f32 v103, v103
v_exp_f32 v116, v116
v_exp_f32 v117, v117
v_exp_f32 v118, v118
v_exp_f32 v119, v119
v_pk_mul_f32 v[128:129], v[128:129], v[96:97]
v_pk_mul_f32 v[130:131], v[130:131], v[98:99]
v_pk_mul_f32 v[144:145], v[144:145], v[112:113]
v_pk_mul_f32 v[146:147], v[146:147], v[114:115]
ds_read_b128 v[112:115], v9 offset:256
v_pk_fma_f32 v[104:105], v[48:49], v[24:25], v[104:105] op_sel_hi:[1,0,1]
v_pk_fma_f32 v[106:107], v[50:51], v[24:25], v[106:107] op_sel_hi:[1,0,1]
v_pk_fma_f32 v[120:121], v[64:65], v[24:25], v[120:121] op_sel_hi:[1,0,1]
v_pk_fma_f32 v[122:123], v[66:67], v[24:25], v[122:123] op_sel_hi:[1,0,1]
v_pk_fma_f32 v[136:137], v[80:81], v[24:25], v[136:137] op_sel_hi:[1,0,1]
v_pk_fma_f32 v[138:139], v[82:83], v[24:25], v[138:139] op_sel_hi:[1,0,1]
v_pk_fma_f32 v[152:153], v[4:5], v[24:25], v[152:153] op_sel_hi:[1,0,1]
v_pk_fma_f32 v[154:155], v[6:7], v[24:25], v[154:155] op_sel_hi:[1,0,1]
v_pk_mul_f32 v[136:137], v[136:137], v[104:105]
v_pk_mul_f32 v[104:105], v[104:105], v[30:31] op_sel_hi:[1,0]
v_pk_mul_f32 v[138:139], v[138:139], v[106:107]
v_pk_mul_f32 v[106:107], v[106:107], v[30:31] op_sel_hi:[1,0]
v_pk_mul_f32 v[152:153], v[152:153], v[120:121]
v_pk_mul_f32 v[120:121], v[120:121], v[30:31] op_sel_hi:[1,0]
v_pk_mul_f32 v[154:155], v[154:155], v[122:123]
v_pk_mul_f32 v[122:123], v[122:123], v[30:31] op_sel_hi:[1,0]
v_pk_fma_f32 v[100:101], v[100:101], v[22:23], v[22:23] op_sel:[0,1,1] op_sel_hi:[1,1,1]
v_pk_fma_f32 v[102:103], v[102:103], v[22:23], v[22:23] op_sel:[0,1,1] op_sel_hi:[1,1,1]
v_pk_fma_f32 v[116:117], v[116:117], v[22:23], v[22:23] op_sel:[0,1,1] op_sel_hi:[1,1,1]
v_pk_fma_f32 v[118:119], v[118:119], v[22:23], v[22:23] op_sel:[0,1,1] op_sel_hi:[1,1,1]
v_cvt_pk_bf16_f32 v96, v128, v129
v_cvt_pk_bf16_f32 v97, v130, v131
ds_read_b128 v[128:131], v9 offset:320
v_cvt_pk_bf16_f32 v98, v144, v145
v_cvt_pk_bf16_f32 v99, v146, v147
MAA 140,192,140
buffer_store_dwordx4 v[96:99], v10, s[16:19], s63 offen sc1
MAA 140,196,156
ds_read_b128 v[144:147], v9 offset:768
v_rcp_f32 v100, v100
MAA 140,0,172
v_rcp_f32 v101, v101
MAA 140,4,188
v_rcp_f32 v102, v102
MAA 156,12,188
buffer_load_dwordx4 v18, s[28:31], s58 offen lds
MAA 156,8,172
v_rcp_f32 v103, v103
MAA 156,204,156
v_rcp_f32 v116, v116
MAA 156,200,140
v_rcp_f32 v117, v117
MAA 108,112,172
buffer_load_dwordx4 v19, s[28:31], s58 offen offset:1056 lds
MAA 108,116,188
s_add_u32 m0, s59, 101376
s_add_u32 s58, s100, 2752512
v_rcp_f32 v118, v118
MAA 124,124,188
v_rcp_f32 v119, v119
MAA 124,120,172
v_exp_f32 v104, v104
v_exp_f32 v105, v105
v_exp_f32 v106, v106
v_exp_f32 v107, v107
v_exp_f32 v120, v120
v_exp_f32 v121, v121
v_exp_f32 v122, v122
v_exp_f32 v123, v123
v_pk_mul_f32 v[132:133], v[132:133], v[100:101]
v_pk_mul_f32 v[134:135], v[134:135], v[102:103]
v_pk_mul_f32 v[148:149], v[148:149], v[116:117]
v_pk_mul_f32 v[150:151], v[150:151], v[118:119]
v_pk_fma_f32 v[108:109], v[48:49], v[26:27], v[108:109] op_sel_hi:[1,0,1]
v_pk_fma_f32 v[110:111], v[50:51], v[26:27], v[110:111] op_sel_hi:[1,0,1]
v_pk_fma_f32 v[124:125], v[64:65], v[26:27], v[124:125] op_sel_hi:[1,0,1]
v_pk_fma_f32 v[126:127], v[66:67], v[26:27], v[126:127] op_sel_hi:[1,0,1]
v_pk_fma_f32 v[140:141], v[80:81], v[26:27], v[140:141] op_sel_hi:[1,0,1]
v_pk_fma_f32 v[142:143], v[82:83], v[26:27], v[142:143] op_sel_hi:[1,0,1]
v_pk_fma_f32 v[156:157], v[4:5], v[26:27], v[156:157] op_sel_hi:[1,0,1]
v_pk_fma_f32 v[158:159], v[6:7], v[26:27], v[158:159] op_sel_hi:[1,0,1]
v_pk_mul_f32 v[140:141], v[140:141], v[108:109]
v_pk_mul_f32 v[108:109], v[108:109], v[30:31] op_sel:[0,1] op_sel_hi:[1,1]
v_pk_mul_f32 v[142:143], v[142:143], v[110:111]
v_pk_mul_f32 v[110:111], v[110:111], v[30:31] op_sel:[0,1] op_sel_hi:[1,1]
v_pk_mul_f32 v[156:157], v[156:157], v[124:125]
s_waitcnt vmcnt(5)
s_barrier
buffer_atomic_add v71, v68, s[16:19], s72 offen offset:512
v_pk_mul_f32 v[124:125], v[124:125], v[30:31] op_sel:[0,1] op_sel_hi:[1,1]
v_pk_mul_f32 v[158:159], v[158:159], v[126:127]
v_pk_mul_f32 v[126:127], v[126:127], v[30:31] op_sel:[0,1] op_sel_hi:[1,1]
v_pk_fma_f32 v[104:105], v[104:105], v[24:25], v[24:25] op_sel:[0,1,1] op_sel_hi:[1,1,1]
v_pk_fma_f32 v[106:107], v[106:107], v[24:25], v[24:25] op_sel:[0,1,1] op_sel_hi:[1,1,1]
v_pk_fma_f32 v[120:121], v[120:121], v[24:25], v[24:25] op_sel:[0,1,1] op_sel_hi:[1,1,1]
v_pk_fma_f32 v[122:123], v[122:123], v[24:25], v[24:25] op_sel:[0,1,1] op_sel_hi:[1,1,1]
v_cvt_pk_bf16_f32 v100, v132, v133
v_cvt_pk_bf16_f32 v101, v134, v135
v_cvt_pk_bf16_f32 v102, v148, v149
v_cvt_pk_bf16_f32 v103, v150, v151
MAA 192,16,128
v_rcp_f32 v104, v104
MAA 192,20,144
buffer_store_dwordx4 v[100:103], v10, s[16:19], s63 offen offset:1024 sc1
MAA 192,48,160
v_rcp_f32 v105, v105
MAA 192,52,176
v_rcp_f32 v106, v106
MAA 208,60,176
v_rcp_f32 v107, v107
MAA 208,56,160
buffer_load_dwordx4 v18, s[28:31], s58 offen lds
MAA 208,28,144
v_rcp_f32 v120, v120
MAA 208,24,128
v_rcp_f32 v121, v121
MAA 160,32,160
v_rcp_f32 v122, v122
MAA 160,36,176
buffer_load_dwordx4 v19, s[28:31], s58 offen offset:1056 lds
MAA 176,44,176
s_add_u32 m0, s59, 109824
s_add_u32 s58, s100, 3014656
v_rcp_f32 v123, v123
MAA 176,40,160
v_exp_f32 v108, v108
v_exp_f32 v109, v109
v_exp_f32 v110, v110
v_exp_f32 v111, v111
v_exp_f32 v124, v124
v_exp_f32 v125, v125
v_exp_f32 v126, v126
v_exp_f32 v127, v127
v_pk_mul_f32 v[136:137], v[136:137], v[104:105]
v_pk_mul_f32 v[138:139], v[138:139], v[106:107]
v_pk_mul_f32 v[152:153], v[152:153], v[120:121]
v_pk_mul_f32 v[154:155], v[154:155], v[122:123]
s_waitcnt lgkmcnt(2)
v_pk_fma_f32 v[160:161], v[112:113], v[20:21], v[160:161] op_sel_hi:[1,0,1]
v_pk_fma_f32 v[162:163], v[114:115], v[20:21], v[162:163] op_sel_hi:[1,0,1]
s_waitcnt lgkmcnt(1)
v_pk_fma_f32 v[176:177], v[128:129], v[20:21], v[176:177] op_sel_hi:[1,0,1]
v_pk_fma_f32 v[178:179], v[130:131], v[20:21], v[178:179] op_sel_hi:[1,0,1]
s_waitcnt lgkmcnt(0)
v_pk_fma_f32 v[192:193], v[144:145], v[20:21], v[192:193] op_sel_hi:[1,0,1]
v_pk_fma_f32 v[194:195], v[146:147], v[20:21], v[194:195] op_sel_hi:[1,0,1]
v_pk_fma_f32 v[208:209], v[12:13], v[20:21], v[208:209] op_sel_hi:[1,0,1]
v_pk_fma_f32 v[210:211], v[14:15], v[20:21], v[210:211] op_sel_hi:[1,0,1]
v_pk_mul_f32 v[192:193], v[192:193], v[160:161]
v_pk_mul_f32 v[160:161], v[160:161], v[28:29] op_sel_hi:[1,0]
v_pk_mul_f32 v[194:195], v[194:195], v[162:163]
v_pk_mul_f32 v[162:163], v[162:163], v[28:29] op_sel_hi:[1,0]
v_pk_mul_f32 v[208:209], v[208:209], v[176:177]
v_pk_mul_f32 v[176:177], v[176:177], v[28:29] op_sel_hi:[1,0]
v_pk_mul_f32 v[210:211], v[210:211], v[178:179]
v_pk_mul_f32 v[178:179], v[178:179], v[28:29] op_sel_hi:[1,0]
v_pk_fma_f32 v[108:109], v[108:109], v[26:27], v[26:27] op_sel:[0,1,1] op_sel_hi:[1,1,1]
v_pk_fma_f32 v[110:111], v[110:111], v[26:27], v[26:27] op_sel:[0,1,1] op_sel_hi:[1,1,1]
v_pk_fma_f32 v[124:125], v[124:125], v[26:27], v[26:27] op_sel:[0,1,1] op_sel_hi:[1,1,1]
v_pk_fma_f32 v[126:127], v[126:127], v[26:27], v[26:27] op_sel:[0,1,1] op_sel_hi:[1,1,1]
v_cvt_pk_bf16_f32 v104, v136, v137
v_cvt_pk_bf16_f32 v105, v138, v139
v_cvt_pk_bf16_f32 v106, v152, v153
v_cvt_pk_bf16_f32 v107, v154, v155
MAA 196,16,132
buffer_store_dwordx4 v[104:107], v11, s[16:19], s63 offen sc1
MAA 196,20,148
v_rcp_f32 v108, v108
MAA 196,48,164
v_rcp_f32 v109, v109
MAA 196,52,180
v_rcp_f32 v110, v110
MAA 212,60,180
buffer_load_dwordx4 v18, s[28:31], s58 offen lds
MAA 212,56,164
v_rcp_f32 v111, v111
MAA 212,28,148
v_rcp_f32 v124, v124
MAA 212,24,132
v_rcp_f32 v125, v125
MAA 164,32,164
buffer_load_dwordx4 v19, s[28:31], s58 offen offset:1056 lds
MAA 164,36,180
s_add_u32 m0, s59, 118272
s_add_u32 s58, s101, 3211264
v_rcp_f32 v126, v126
MAA 180,44,180
v_rcp_f32 v127, v127
MAA 180,40,164
v_lshl_add_u32 v4, v1, 4, s74
v_add_u32 v2, 67108480, v4
v_cndmask_b32 v4, v4, v2, vcc
s_and_b32 s74, s7, 1
v_bfe_u32 v7, v1, 2, 3
v_mul_u32_u24 v7, 1056, v7
v_bfe_u32 v2, v1, 5, 1
v_lshl_add_u32 v7, v2, 8, v7
v_and_b32 v2, 3, v1
v_lshl_add_u32 v7, v2, 3, v7
s_lshl_b32 s74, s74, 7
s_xor_b32 s75, s74, 128
v_add_u32 v6, s75, v7
v_add_u32 v7, s74, v7
v_exp_f32 v160, v160
v_exp_f32 v161, v161
v_exp_f32 v162, v162
v_exp_f32 v163, v163
v_exp_f32 v176, v176
v_exp_f32 v177, v177
v_exp_f32 v178, v178
v_exp_f32 v179, v179
v_pk_mul_f32 v[140:141], v[140:141], v[108:109]
v_pk_mul_f32 v[142:143], v[142:143], v[110:111]
v_pk_mul_f32 v[156:157], v[156:157], v[124:125]
v_pk_mul_f32 v[158:159], v[158:159], v[126:127]
v_pk_fma_f32 v[164:165], v[112:113], v[22:23], v[164:165] op_sel_hi:[1,0,1]
v_pk_fma_f32 v[166:167], v[114:115], v[22:23], v[166:167] op_sel_hi:[1,0,1]
v_pk_fma_f32 v[180:181], v[128:129], v[22:23], v[180:181] op_sel_hi:[1,0,1]
v_pk_fma_f32 v[182:183], v[130:131], v[22:23], v[182:183] op_sel_hi:[1,0,1]
v_pk_fma_f32 v[196:197], v[144:145], v[22:23], v[196:197] op_sel_hi:[1,0,1]
v_pk_fma_f32 v[198:199], v[146:147], v[22:23], v[198:199] op_sel_hi:[1,0,1]
v_pk_fma_f32 v[212:213], v[12:13], v[22:23], v[212:213] op_sel_hi:[1,0,1]
v_pk_fma_f32 v[214:215], v[14:15], v[22:23], v[214:215] op_sel_hi:[1,0,1]
v_pk_mul_f32 v[196:197], v[196:197], v[164:165]
v_pk_mul_f32 v[164:165], v[164:165], v[28:29] op_sel:[0,1] op_sel_hi:[1,1]
v_pk_mul_f32 v[198:199], v[198:199], v[166:167]
v_pk_mul_f32 v[166:167], v[166:167], v[28:29] op_sel:[0,1] op_sel_hi:[1,1]
v_pk_mul_f32 v[212:213], v[212:213], v[180:181]
v_pk_mul_f32 v[180:181], v[180:181], v[28:29] op_sel:[0,1] op_sel_hi:[1,1]
v_pk_mul_f32 v[214:215], v[214:215], v[182:183]
v_pk_mul_f32 v[182:183], v[182:183], v[28:29] op_sel:[0,1] op_sel_hi:[1,1]
v_pk_fma_f32 v[160:161], v[160:161], v[20:21], v[20:21] op_sel:[0,1,1] op_sel_hi:[1,1,1]
v_pk_fma_f32 v[162:163], v[162:163], v[20:21], v[20:21] op_sel:[0,1,1] op_sel_hi:[1,1,1]
v_pk_fma_f32 v[176:177], v[176:177], v[20:21], v[20:21] op_sel:[0,1,1] op_sel_hi:[1,1,1]
v_pk_fma_f32 v[178:179], v[178:179], v[20:21], v[20:21] op_sel:[0,1,1] op_sel_hi:[1,1,1]
v_cvt_pk_bf16_f32 v108, v140, v141
v_cvt_pk_bf16_f32 v109, v142, v143
v_cvt_pk_bf16_f32 v110, v156, v157
v_cvt_pk_bf16_f32 v111, v158, v159
MAA 200,16,136
buffer_store_dwordx4 v[108:111], v11, s[16:19], s63 offen offset:1024 sc1
MAA 200,20,152
v_rcp_f32 v160, v160
MAA 200,48,168
v_rcp_f32 v161, v161
MAA 200,52,184
v_rcp_f32 v162, v162
MAA 216,60,184
buffer_load_dwordx4 v18, s[28:31], s58 offen lds
MAA 216,56,168
v_rcp_f32 v163, v163
MAA 216,28,152
v_rcp_f32 v176, v176
MAA 216,24,136
v_rcp_f32 v177, v177
MAA 168,32,168
buffer_load_dwordx4 v19, s[28:31], s58 offen offset:1056 lds
MAA 168,36,184
s_add_u32 m0, s59, 126720
s_add_u32 s58, s101, 3473408
v_rcp_f32 v178, v178
MAA 184,44,184
v_rcp_f32 v179, v179
MAA 184,40,168
v_exp_f32 v164, v164
v_exp_f32 v165, v165
v_exp_f32 v166, v166
v_exp_f32 v167, v167
v_exp_f32 v180, v180
v_exp_f32 v181, v181
v_exp_f32 v182, v182
v_exp_f32 v183, v183
v_pk_mul_f32 v[192:193], v[192:193], v[160:161]
v_pk_mul_f32 v[194:195], v[194:195], v[162:163]
v_pk_mul_f32 v[208:209], v[208:209], v[176:177]
v_pk_mul_f32 v[210:211], v[210:211], v[178:179]
ds_read_b128 v[176:179], v8
v_pk_fma_f32 v[168:169], v[112:113], v[24:25], v[168:169] op_sel_hi:[1,0,1]
v_pk_fma_f32 v[170:171], v[114:115], v[24:25], v[170:171] op_sel_hi:[1,0,1]
v_pk_fma_f32 v[184:185], v[128:129], v[24:25], v[184:185] op_sel_hi:[1,0,1]
v_pk_fma_f32 v[186:187], v[130:131], v[24:25], v[186:187] op_sel_hi:[1,0,1]
v_pk_fma_f32 v[200:201], v[144:145], v[24:25], v[200:201] op_sel_hi:[1,0,1]
v_pk_fma_f32 v[202:203], v[146:147], v[24:25], v[202:203] op_sel_hi:[1,0,1]
v_pk_fma_f32 v[216:217], v[12:13], v[24:25], v[216:217] op_sel_hi:[1,0,1]
v_pk_fma_f32 v[218:219], v[14:15], v[24:25], v[218:219] op_sel_hi:[1,0,1]
v_pk_mul_f32 v[200:201], v[200:201], v[168:169]
v_pk_mul_f32 v[168:169], v[168:169], v[30:31] op_sel_hi:[1,0]
v_pk_mul_f32 v[202:203], v[202:203], v[170:171]
v_pk_mul_f32 v[170:171], v[170:171], v[30:31] op_sel_hi:[1,0]
v_pk_mul_f32 v[216:217], v[216:217], v[184:185]
v_pk_mul_f32 v[184:185], v[184:185], v[30:31] op_sel_hi:[1,0]
v_pk_mul_f32 v[218:219], v[218:219], v[186:187]
v_pk_mul_f32 v[186:187], v[186:187], v[30:31] op_sel_hi:[1,0]
v_pk_fma_f32 v[164:165], v[164:165], v[22:23], v[22:23] op_sel:[0,1,1] op_sel_hi:[1,1,1]
v_pk_fma_f32 v[166:167], v[166:167], v[22:23], v[22:23] op_sel:[0,1,1] op_sel_hi:[1,1,1]
v_pk_fma_f32 v[180:181], v[180:181], v[22:23], v[22:23] op_sel:[0,1,1] op_sel_hi:[1,1,1]
v_pk_fma_f32 v[182:183], v[182:183], v[22:23], v[22:23] op_sel:[0,1,1] op_sel_hi:[1,1,1]
v_cvt_pk_bf16_f32 v160, v192, v193
v_cvt_pk_bf16_f32 v161, v194, v195
ds_read_b128 v[192:195], v8 offset:64
v_cvt_pk_bf16_f32 v162, v208, v209
v_cvt_pk_bf16_f32 v163, v210, v211
MAA 204,16,140
buffer_store_dwordx4 v[160:163], v10, s[16:19], s64 offen sc1
MAA 204,20,156
ds_read_b128 v[208:211], v8 offset:512
v_rcp_f32 v164, v164
MAA 204,48,172
v_rcp_f32 v165, v165
MAA 204,52,188
v_rcp_f32 v166, v166
MAA 220,60,188
buffer_atomic_add v84, v69, s[16:19], s73 offen offset:512 sc0
MAA 220,56,172
v_rcp_f32 v167, v167
MAA 220,28,156
v_rcp_f32 v180, v180
MAA 220,24,140
v_rcp_f32 v181, v181
MAA 172,32,172
buffer_load_dwordx4 v18, s[28:31], s58 offen lds
MAA 172,36,188
v_rcp_f32 v182, v182
MAA 188,44,188
v_rcp_f32 v183, v183
MAA 188,40,172
v_exp_f32 v168, v168
v_exp_f32 v169, v169
v_exp_f32 v170, v170
v_exp_f32 v171, v171
v_exp_f32 v184, v184
v_exp_f32 v185, v185
v_exp_f32 v186, v186
v_exp_f32 v187, v187
v_pk_mul_f32 v[196:197], v[196:197], v[164:165]
v_pk_mul_f32 v[198:199], v[198:199], v[166:167]
v_pk_mul_f32 v[212:213], v[212:213], v[180:181]
v_pk_mul_f32 v[214:215], v[214:215], v[182:183]
v_pk_fma_f32 v[172:173], v[112:113], v[26:27], v[172:173] op_sel_hi:[1,0,1]
v_pk_fma_f32 v[174:175], v[114:115], v[26:27], v[174:175] op_sel_hi:[1,0,1]
v_pk_fma_f32 v[188:189], v[128:129], v[26:27], v[188:189] op_sel_hi:[1,0,1]
v_pk_fma_f32 v[190:191], v[130:131], v[26:27], v[190:191] op_sel_hi:[1,0,1]
v_pk_fma_f32 v[204:205], v[144:145], v[26:27], v[204:205] op_sel_hi:[1,0,1]
v_pk_fma_f32 v[206:207], v[146:147], v[26:27], v[206:207] op_sel_hi:[1,0,1]
v_pk_fma_f32 v[220:221], v[12:13], v[26:27], v[220:221] op_sel_hi:[1,0,1]
v_pk_fma_f32 v[222:223], v[14:15], v[26:27], v[222:223] op_sel_hi:[1,0,1]
v_pk_mul_f32 v[204:205], v[204:205], v[172:173]
v_pk_mul_f32 v[172:173], v[172:173], v[30:31] op_sel:[0,1] op_sel_hi:[1,1]
v_pk_mul_f32 v[206:207], v[206:207], v[174:175]
v_pk_mul_f32 v[174:175], v[174:175], v[30:31] op_sel:[0,1] op_sel_hi:[1,1]
v_pk_mul_f32 v[220:221], v[220:221], v[188:189]
v_pk_mul_f32 v[188:189], v[188:189], v[30:31] op_sel:[0,1] op_sel_hi:[1,1]
v_pk_mul_f32 v[222:223], v[222:223], v[190:191]
v_pk_mul_f32 v[190:191], v[190:191], v[30:31] op_sel:[0,1] op_sel_hi:[1,1]
v_pk_fma_f32 v[168:169], v[168:169], v[24:25], v[24:25] op_sel:[0,1,1] op_sel_hi:[1,1,1]
v_pk_fma_f32 v[170:171], v[170:171], v[24:25], v[24:25] op_sel:[0,1,1] op_sel_hi:[1,1,1]
v_pk_fma_f32 v[184:185], v[184:185], v[24:25], v[24:25] op_sel:[0,1,1] op_sel_hi:[1,1,1]
v_pk_fma_f32 v[186:187], v[186:187], v[24:25], v[24:25] op_sel:[0,1,1] op_sel_hi:[1,1,1]
v_cvt_pk_bf16_f32 v164, v196, v197
v_cvt_pk_bf16_f32 v165, v198, v199
v_cvt_pk_bf16_f32 v166, v212, v213
v_cvt_pk_bf16_f32 v167, v214, v215
MAA 240,64,128
buffer_store_dwordx4 v[164:167], v10, s[16:19], s64 offen offset:1024 sc1
MAA 240,68,144
v_rcp_f32 v168, v168
MAA 240,96,160
v_rcp_f32 v169, v169
MAA 240,100,176
v_rcp_f32 v170, v170
MAA 248,108,176
buffer_atomic_add v85, v69, s[16:19], s73 offen offset:512 sc0
MAA 248,104,160
v_rcp_f32 v171, v171
MAA 248,76,144
v_rcp_f32 v184, v184
MAA 248,72,128
v_rcp_f32 v185, v185
MAA 224,80,160
buffer_load_dwordx4 v19, s[28:31], s58 offen offset:1056 lds
MAA 224,84,176
v_rcp_f32 v186, v186
MAA 232,92,176
v_rcp_f32 v187, v187
MAA 232,88,160
v_exp_f32 v172, v172
v_exp_f32 v173, v173
v_exp_f32 v174, v174
v_exp_f32 v175, v175
v_exp_f32 v188, v188
v_exp_f32 v189, v189
v_exp_f32 v190, v190
v_exp_f32 v191, v191
v_pk_mul_f32 v[200:201], v[200:201], v[168:169]
v_pk_mul_f32 v[202:203], v[202:203], v[170:171]
v_pk_mul_f32 v[216:217], v[216:217], v[184:185]
v_pk_mul_f32 v[218:219], v[218:219], v[186:187]
.Lpad16:
s_cbranch_execz .Lpad19
s_waitcnt lgkmcnt(2)
v_pk_fma_f32 v[224:225], v[176:177], v[20:21], v[224:225] op_sel_hi:[1,0,1]
v_pk_fma_f32 v[226:227], v[178:179], v[20:21], v[226:227] op_sel_hi:[1,0,1]
s_waitcnt lgkmcnt(1)
v_pk_fma_f32 v[232:233], v[192:193], v[20:21], v[232:233] op_sel_hi:[1,0,1]
v_pk_fma_f32 v[234:235], v[194:195], v[20:21], v[234:235] op_sel_hi:[1,0,1]
s_waitcnt lgkmcnt(0)
v_pk_fma_f32 v[240:241], v[208:209], v[20:21], v[240:241] op_sel_hi:[1,0,1]
v_pk_fma_f32 v[242:243], v[210:211], v[20:21], v[242:243] op_sel_hi:[1,0,1]
v_pk_fma_f32 v[248:249], v[52:53], v[20:21], v[248:249] op_sel_hi:[1,0,1]
v_pk_fma_f32 v[250:251], v[54:55], v[20:21], v[250:251] op_sel_hi:[1,0,1]
v_pk_mul_f32 v[240:241], v[240:241], v[224:225]
v_pk_mul_f32 v[224:225], v[224:225], v[28:29] op_sel_hi:[1,0]
v_pk_mul_f32 v[242:243], v[242:243], v[226:227]
v_pk_mul_f32 v[226:227], v[226:227], v[28:29] op_sel_hi:[1,0]
v_pk_mul_f32 v[248:249], v[248:249], v[232:233]
v_pk_mul_f32 v[232:233], v[232:233], v[28:29] op_sel_hi:[1,0]
v_pk_mul_f32 v[250:251], v[250:251], v[234:235]
v_pk_mul_f32 v[234:235], v[234:235], v[28:29] op_sel_hi:[1,0]
v_pk_fma_f32 v[172:173], v[172:173], v[26:27], v[26:27] op_sel:[0,1,1] op_sel_hi:[1,1,1]
v_pk_fma_f32 v[174:175], v[174:175], v[26:27], v[26:27] op_sel:[0,1,1] op_sel_hi:[1,1,1]
v_pk_fma_f32 v[188:189], v[188:189], v[26:27], v[26:27] op_sel:[0,1,1] op_sel_hi:[1,1,1]
v_pk_fma_f32 v[190:191], v[190:191], v[26:27], v[26:27] op_sel:[0,1,1] op_sel_hi:[1,1,1]
v_cvt_pk_bf16_f32 v168, v200, v201
v_cvt_pk_bf16_f32 v169, v202, v203
v_cvt_pk_bf16_f32 v170, v216, v217
v_cvt_pk_bf16_f32 v171, v218, v219
buffer_store_dwordx4 v[168:171], v11, s[16:19], s64 offen sc1
buffer_atomic_add v86, v69, s[16:19], s73 offen offset:512 sc0
s_waitcnt vmcnt(6)
v_cmp_gt_u32 vcc, v70, v84
s_nop 0
s_cbranch_vccz .Lok49
s_waitcnt vmcnt(3)
v_cmp_gt_u32 vcc, v70, v85
s_nop 0
s_cbranch_vccz .Lok49
s_waitcnt vmcnt(0)
v_cmp_gt_u32 vcc, v70, v86
s_nop 0
s_cbranch_vccz .Lok49
s_mov_b32 s15, 0
.Lok49l:
v_mov_b32 v84, 0
buffer_atomic_add v84, v69, s[16:19], s73 offen offset:512 sc0
s_add_u32 s15, s15, 1
s_cmp_gt_u32 s15, 100000
s_waitcnt vmcnt(0)
s_cbranch_scc1 .Lok49
v_cmp_gt_u32 vcc, v70, v84
s_nop 0
s_cbranch_vccnz .Lok49l
.Lok49:
s_waitcnt vmcnt(2)
s_barrier
MAA 244,64,132
ds_read_b64_tr_b16 a[0:1], v7
s_add_u32 s52, s76, 0
MAA 244,68,148
buffer_load_dwordx4 v[96:99], v4, s[16:19], s52 offen sc1
MAA 244,96,164
TR 2,7,512
v_rcp_f32 v172, v172
MAA 244,100,180
TR 4,7,32
v_rcp_f32 v173, v173
MAA 252,108,180
TR 6,7,544
v_rcp_f32 v174, v174
MAA 252,104,164
buffer_load_dwordx4 v[100:103], v4, s[16:19], s52 offen offset:1024 sc1
MAA 252,76,148
TR 8,7,64
s_add_u32 s52, s76, 65536
MAA 252,72,132
TR 10,7,576
v_rcp_f32 v175, v175
MAA 228,80,164
TR 12,7,96
v_rcp_f32 v188, v188
MAA 228,84,180
buffer_load_dwordx4 v[104:107], v4, s[16:19], s52 offen sc1
MAA 236,92,180
TR 14,7,608
v_rcp_f32 v189, v189
MAA 236,88,164
TR 16,7,8448
v_rcp_f32 v190, v190
v_rcp_f32 v191, v191
v_exp_f32 v224, v224
v_exp_f32 v225, v225
v_exp_f32 v226, v226
v_exp_f32 v227, v227
v_exp_f32 v232, v232
v_exp_f32 v233, v233
v_exp_f32 v234, v234
v_exp_f32 v235, v235
v_pk_mul_f32 v[204:205], v[204:205], v[172:173]
buffer_load_dwordx4 v[108:111], v4, s[16:19], s52 offen offset:1024 sc1
s_add_u32 s52, s77, 114688
v_pk_mul_f32 v[206:207], v[206:207], v[174:175]
v_pk_mul_f32 v[220:221], v[220:221], v[188:189]
v_pk_mul_f32 v[222:223], v[222:223], v[190:191]
v_pk_fma_f32 v[228:229], v[176:177], v[22:23], v[228:229] op_sel_hi:[1,0,1]
v_pk_fma_f32 v[230:231], v[178:179], v[22:23], v[230:231] op_sel_hi:[1,0,1]
v_pk_fma_f32 v[236:237], v[192:193], v[22:23], v[236:237] op_sel_hi:[1,0,1]
v_pk_fma_f32 v[238:239], v[194:195], v[22:23], v[238:239] op_sel_hi:[1,0,1]
v_pk_fma_f32 v[244:245], v[208:209], v[22:23], v[244:245] op_sel_hi:[1,0,1]
v_pk_fma_f32 v[246:247], v[210:211], v[22:23], v[246:247] op_sel_hi:[1,0,1]
v_pk_fma_f32 v[252:253], v[52:53], v[22:23], v[252:253] op_sel_hi:[1,0,1]
v_pk_fma_f32 v[254:255], v[54:55], v[22:23], v[254:255] op_sel_hi:[1,0,1]
v_pk_mul_f32 v[244:245], v[244:245], v[228:229]
buffer_load_dwordx4 v[112:115], v4, s[16:19], s52 offen sc1
v_pk_mul_f32 v[228:229], v[228:229], v[28:29] op_sel:[0,1] op_sel_hi:[1,1]
v_pk_mul_f32 v[246:247], v[246:247], v[230:231]
v_pk_mul_f32 v[230:231], v[230:231], v[28:29] op_sel:[0,1] op_sel_hi:[1,1]
v_pk_mul_f32 v[252:253], v[252:253], v[236:237]
v_pk_mul_f32 v[236:237], v[236:237], v[28:29] op_sel:[0,1] op_sel_hi:[1,1]
v_pk_mul_f32 v[254:255], v[254:255], v[238:239]
v_pk_mul_f32 v[238:239], v[238:239], v[28:29] op_sel:[0,1] op_sel_hi:[1,1]
v_pk_fma_f32 v[224:225], v[224:225], v[20:21], v[20:21] op_sel:[0,1,1] op_sel_hi:[1,1,1]
v_pk_fma_f32 v[226:227], v[226:227], v[20:21], v[20:21] op_sel:[0,1,1] op_sel_hi:[1,1,1]
v_pk_fma_f32 v[232:233], v[232:233], v[20:21], v[20:21] op_sel:[0,1,1] op_sel_hi:[1,1,1]
v_pk_fma_f32 v[234:235], v[234:235], v[20:21], v[20:21] op_sel:[0,1,1] op_sel_hi:[1,1,1]
v_cvt_pk_bf16_f32 v172, v204, v205
v_cvt_pk_bf16_f32 v173, v206, v207
buffer_load_dwordx4 v[116:119], v4, s[16:19], s52 offen offset:1024 sc1
s_add_u32 s52, s77, 180224
v_cvt_pk_bf16_f32 v174, v220, v221
v_cvt_pk_bf16_f32 v175, v222, v223
TR 18,7,8960
TR 20,7,8480
TR 22,7,8992
TR 24,7,8512
TR 26,7,9024
buffer_store_dwordx4 v[172:175], v11, s[16:19], s64 offen offset:1024 sc1
TR 28,7,8544
TR 30,7,9056
v_rcp_f32 v224, v224
v_rcp_f32 v225, v225
v_rcp_f32 v226, v226
v_rcp_f32 v227, v227
v_rcp_f32 v232, v232
v_rcp_f32 v233, v233
v_rcp_f32 v234, v234
v_rcp_f32 v235, v235
v_exp_f32 v228, v228
v_exp_f32 v229, v229
v_exp_f32 v230, v230
v_exp_f32 v231, v231
v_exp_f32 v236, v236
v_exp_f32 v237, v237
v_exp_f32 v238, v238
v_exp_f32 v239, v239
v_pk_mul_f32 v[240:241], v[240:241], v[224:225]
buffer_load_dwordx4 v[120:123], v4, s[16:19], s52 offen sc1
v_pk_mul_f32 v[242:243], v[242:243], v[226:227]
v_pk_mul_f32 v[248:249], v[248:249], v[232:233]
v_pk_mul_f32 v[250:251], v[250:251], v[234:235]
v_pk_fma_f32 v[228:229], v[228:229], v[22:23], v[22:23] op_sel:[0,1,1] op_sel_hi:[1,1,1]
v_pk_fma_f32 v[230:231], v[230:231], v[22:23], v[22:23] op_sel:[0,1,1] op_sel_hi:[1,1,1]
v_pk_fma_f32 v[236:237], v[236:237], v[22:23], v[22:23] op_sel:[0,1,1] op_sel_hi:[1,1,1]
v_pk_fma_f32 v[238:239], v[238:239], v[22:23], v[22:23] op_sel:[0,1,1] op_sel_hi:[1,1,1]
v_cvt_pk_bf16_f32 v224, v240, v241
v_cvt_pk_bf16_f32 v225, v242, v243
v_cvt_pk_bf16_f32 v226, v248, v249
v_cvt_pk_bf16_f32 v227, v250, v251
v_rcp_f32 v228, v228
v_rcp_f32 v229, v229
v_rcp_f32 v230, v230
v_rcp_f32 v231, v231
v_rcp_f32 v236, v236
v_rcp_f32 v237, v237
v_rcp_f32 v238, v238
v_rcp_f32 v239, v239
v_pk_mul_f32 v[244:245], v[244:245], v[228:229]
buffer_store_dwordx4 v[224:227], v10, s[16:19], s65 offen sc1
v_pk_mul_f32 v[246:247], v[246:247], v[230:231]
v_pk_mul_f32 v[252:253], v[252:253], v[236:237]
v_pk_mul_f32 v[254:255], v[254:255], v[238:239]
v_cvt_pk_bf16_f32 v228, v244, v245
v_cvt_pk_bf16_f32 v229, v246, v247
v_cvt_pk_bf16_f32 v230, v252, v253
v_cvt_pk_bf16_f32 v231, v254, v255
buffer_store_dwordx4 v[228:231], v10, s[16:19], s65 offen offset:1024 sc1
buffer_load_dwordx4 v[124:127], v4, s[16:19], s52 offen offset:1024 sc1
v_mov_b32 v21, v68
v_mov_b32 v22, v69
v_mov_b32 v23, v70
v_mov_b32 v24, v71
v_mov_b32 v25, 0
s_waitcnt vmcnt(7) lgkmcnt(0)
s_barrier
v_mfma_f32_16x16x32_bf16 v[32:35], a[0:3], v[96:99], 0
ds_read_b64_tr_b16 a[32:33], v6
s_add_u32 s52, s78, 229376
MAV 32,16,104
buffer_load_dwordx4 v[128:131], v4, s[16:19], s52 offen sc1
v_mfma_f32_16x16x32_bf16 v[48:51], a[0:3], v[100:103], 0
TR 34,6,512
MAV 48,16,108
TR 36,6,32
TR 38,6,544
v_mfma_f32_16x16x32_bf16 v[52:55], a[4:7], v[100:103], 0
TR 48,6,8448
MAV 52,20,108
buffer_load_dwordx4 v[132:135], v4, s[16:19], s52 offen offset:1024 sc1
v_mfma_f32_16x16x32_bf16 v[36:39], a[4:7], v[96:99], 0
TR 50,6,8960
MAV 36,20,104
TR 52,6,8480
TR 54,6,8992
v_mfma_f32_16x16x32_bf16 v[40:43], a[8:11], v[96:99], 0
TR 40,6,64
s_add_u32 s52, s78, 294912
MAV 40,24,104
buffer_load_dwordx4 v[136:139], v4, s[16:19], s52 offen sc1
v_mfma_f32_16x16x32_bf16 v[56:59], a[8:11], v[100:103], 0
TR 42,6,576
MAV 56,24,108
TR 44,6,96
TR 46,6,608
v_mfma_f32_16x16x32_bf16 v[60:63], a[12:15], v[100:103], 0
TR 56,6,8512
MAV 60,28,108
buffer_load_dwordx4 v[140:143], v4, s[16:19], s52 offen offset:1024 sc1
v_mfma_f32_16x16x32_bf16 v[44:47], a[12:15], v[96:99], 0
TR 58,6,9024
MAV 44,28,104
TR 60,6,8544
TR 62,6,9056
s_waitcnt lgkmcnt(8)
v_mfma_f32_16x16x32_bf16 v[64:67], a[32:35], v[96:99], 0
TR 0,7,16896
s_add_u32 s52, s79, 344064
MAV 64,48,104
buffer_load_dwordx4 v[144:147], v4, s[16:19], s52 offen sc1
v_mfma_f32_16x16x32_bf16 v[80:83], a[32:35], v[100:103], 0
TR 2,7,17408
MAV 80,48,108
TR 4,7,16928
TR 6,7,17440
v_mfma_f32_16x16x32_bf16 v[84:87], a[36:39], v[100:103], 0
TR 16,7,25344
MAV 84,52,108
buffer_load_dwordx4 v[148:151], v4, s[16:19], s52 offen offset:1024 sc1
v_mfma_f32_16x16x32_bf16 v[68:71], a[36:39], v[96:99], 0
TR 18,7,25856
MAV 68,52,104
TR 20,7,25376
TR 22,7,25888
s_waitcnt lgkmcnt(8)
v_mfma_f32_16x16x32_bf16 v[72:75], a[40:43], v[96:99], 0
TR 8,7,16960
s_add_u32 s52, s79, 409600
MAV 72,56,104
buffer_load_dwordx4 v[152:155], v4, s[16:19], s52 offen sc1
v_mfma_f32_16x16x32_bf16 v[88:91], a[40:43], v[100:103], 0
TR 10,7,17472
MAV 88,56,108
TR 12,7,16992
TR 14,7,17504
v_mfma_f32_16x16x32_bf16 v[92:95], a[44:47], v[100:103], 0
TR 24,7,25408
MAV 92,60,108
buffer_load_dwordx4 v[156:159], v4, s[16:19], s52 offen offset:1024 sc1
v_mfma_f32_16x16x32_bf16 v[76:79], a[44:47], v[96:99], 0
TR 26,7,25920
MAV 76,60,104
TR 28,7,25440
TR 30,7,25952
s_waitcnt vmcnt(8) lgkmcnt(8)
s_barrier
MAV 32,0,112
TR 32,6,16896
s_add_u32 m0, s55, 0
MAV 32,16,120
buffer_load_dwordx4 v18, s[28:31], s54 offen lds
MAV 48,16,124
TR 34,6,17408
MAV 48,0,116
TR 36,6,16928
TR 38,6,17440
MAV 52,4,116
TR 48,6,25344
s_add_u32 s52, s76, 458752
MAV 52,20,124
buffer_load_dwordx4 v[96:99], v4, s[16:19], s52 offen sc1
MAV 36,20,120
TR 50,6,25856
MAV 36,4,112
TR 52,6,25376
TR 54,6,25888
s_waitcnt lgkmcnt(8)
MAV 40,8,112
TR 40,6,16960
MAV 40,24,120
buffer_load_dwordx4 v19, s[28:31], s54 offen offset:1056 lds
MAV 56,24,124
TR 42,6,17472
s_add_u32 s54, s98, 327680
MAV 56,8,116
TR 44,6,16992
TR 46,6,17504
MAV 60,12,116
TR 56,6,25408
MAV 60,28,124
buffer_load_dwordx4 v[100:103], v4, s[16:19], s52 offen offset:1024 sc1
MAV 44,28,120
TR 58,6,25920
MAV 44,12,112
TR 60,6,25440
TR 62,6,25952
s_waitcnt lgkmcnt(8)
MAV 64,32,112
TR 0,7,33792
s_add_u32 m0, s55, 8448
MAV 64,48,120
buffer_load_dwordx4 v18, s[28:31], s54 offen lds
MAV 80,48,124
TR 2,7,34304
MAV 80,32,116
TR 4,7,33824
TR 6,7,34336
MAV 84,36,116
TR 16,7,42240
s_add_u32 s52, s76, 524288
MAV 84,52,124
buffer_load_dwordx4 v[104:107], v4, s[16:19], s52 offen sc1
MAV 68,52,120
TR 18,7,42752
MAV 68,36,112
TR 20,7,42272
TR 22,7,42784
s_waitcnt lgkmcnt(8)
MAV 72,40,112
TR 8,7,33856
MAV 72,56,120
buffer_load_dwordx4 v19, s[28:31], s54 offen offset:1056 lds
MAV 88,56,124
TR 10,7,34368
s_add_u32 s54, s99, 524288
MAV 88,40,116
TR 12,7,33888
TR 14,7,34400
MAV 92,44,116
TR 24,7,42304
MAV 92,60,124
buffer_load_dwordx4 v[108:111], v4, s[16:19], s52 offen offset:1024 sc1
MAV 76,60,120
TR 26,7,42816
MAV 76,44,112
TR 28,7,42336
TR 30,7,42848
s_waitcnt vmcnt(12) lgkmcnt(8)
s_barrier
MAV 32,0,128
TR 32,6,33792
MAV 32,16,136
buffer_atomic_add v24, v21, s[16:19], s72 offen
MAV 48,16,140
TR 34,6,34304
MAV 48,0,132
TR 36,6,33824
TR 38,6,34336
TR 48,6,42240
MAV 52,4,132
TR 50,6,42752
s_add_u32 m0, s55, 16896
MAV 52,20,140
buffer_load_dwordx4 v18, s[28:31], s54 offen lds
MAV 36,20,136
TR 52,6,42272
MAV 36,4,128
TR 54,6,42784
TR 40,6,33856
s_waitcnt lgkmcnt(9)
MAV 40,8,128
TR 42,6,34368
s_add_u32 s52, s77, 573440
MAV 40,24,136
buffer_load_dwordx4 v[112:115], v4, s[16:19], s52 offen sc1
MAV 56,24,140
TR 44,6,33888
MAV 56,8,132
buffer_load_dwordx4 v19, s[28:31], s54 offen offset:1056 lds
MAV 60,12,132
TR 46,6,34400
s_add_u32 s54, s99, 786432
MAV 60,28,140
buffer_load_dwordx4 v[116:119], v4, s[16:19], s52 offen offset:1024 sc1
MAV 44,28,136
TR 56,6,42304
MAV 44,12,128
TR 58,6,42816
TR 60,6,42336
TR 62,6,42848
s_waitcnt lgkmcnt(8)
MAV 64,32,128
TR 0,7,50688
s_add_u32 m0, s55, 25344
MAV 64,48,136
buffer_load_dwordx4 v18, s[28:31], s54 offen lds
MAV 80,48,140
TR 2,7,51200
MAV 80,32,132
TR 4,7,50720
TR 6,7,51232
MAV 84,36,132
TR 16,7,59136
s_add_u32 s52, s77, 638976
MAV 84,52,140
buffer_load_dwordx4 v[120:123], v4, s[16:19], s52 offen sc1
MAV 68,52,136
TR 18,7,59648
MAV 68,36,128
TR 20,7,59168
TR 22,7,59680
s_waitcnt lgkmcnt(8)
MAV 72,40,128
TR 8,7,50752
MAV 72,56,136
buffer_load_dwordx4 v19, s[28:31], s54 offen offset:1056 lds
MAV 88,56,140
TR 10,7,51264
s_add_u32 s54, s100, 983040
MAV 88,40,132
TR 12,7,50784
TR 14,7,51296
MAV 92,44,132
TR 24,7,59200
MAV 92,60,140
buffer_load_dwordx4 v[124:127], v4, s[16:19], s52 offen offset:1024 sc1
MAV 76,60,136
TR 26,7,59712
MAV 76,44,128
TR 28,7,59232
TR 30,7,59744
s_waitcnt vmcnt(17) lgkmcnt(8)
s_barrier
MAV 32,0,144
TR 32,6,50688
s_add_u32 m0, s55, 33792
MAV 32,16,152
buffer_load_dwordx4 v18, s[28:31], s54 offen lds
MAV 48,16,156
TR 34,6,51200
MAV 48,0,148
TR 36,6,50720
TR 38,6,51232
MAV 52,4,148
TR 48,6,59136
s_add_u32 s52, s78, 688128
MAV 52,20,156
buffer_load_dwordx4 v[128:131], v4, s[16:19], s52 offen sc1
MAV 36,20,152
TR 50,6,59648
MAV 36,4,144
TR 52,6,59168
TR 54,6,59680
s_waitcnt lgkmcnt(8)
MAV 40,8,144
TR 40,6,50752
MAV 40,24,152
buffer_load_dwordx4 v19, s[28:31], s54 offen offset:1056 lds
MAV 56,24,156
TR 42,6,51264
s_add_u32 s54, s100, 1245184
MAV 56,8,148
TR 44,6,50784
TR 46,6,51296
MAV 60,12,148
TR 56,6,59200
MAV 60,28,156
buffer_load_dwordx4 v[132:135], v4, s[16:19], s52 offen offset:1024 sc1
MAV 44,28,152
TR 58,6,59712
MAV 44,12,144
TR 60,6,59232
TR 62,6,59744
v_add_u32 v7, s57, v7
v_add_u32 v6, s57, v6
s_sub_u32 s57, 0, s57
s_waitcnt lgkmcnt(8)
MAV 64,32,144
ds_read_b64_tr_b16 a[0:1], v7
s_add_u32 m0, s55, 42240
MAV 64,48,152
buffer_load_dwordx4 v18, s[28:31], s54 offen lds
MAV 80,48,156
TR 2,7,512
MAV 80,32,148
TR 4,7,32
TR 6,7,544
TR 16,7,8448
MAV 84,36,148
TR 18,7,8960
s_add_u32 s52, s78, 753664
MAV 84,52,156
buffer_load_dwordx4 v[136:139], v4, s[16:19], s52 offen sc1
MAV 68,52,152
TR 20,7,8480
MAV 68,36,144
TR 22,7,8992
TR 8,7,64
s_waitcnt lgkmcnt(9)
MAV 72,40,144
TR 10,7,576
MAV 72,56,152
buffer_load_dwordx4 v19, s[28:31], s54 offen offset:1056 lds
MAV 88,56,156
TR 12,7,96
s_add_u32 s54, s101, 1441792
MAV 88,40,148
buffer_load_dwordx4 v[140:143], v4, s[16:19], s52 offen offset:1024 sc1
MAV 92,44,148
TR 14,7,608
MAV 92,60,156
buffer_atomic_add v25, v22, s[16:19], s73 offen sc0
MAV 76,60,152
TR 24,7,8512
MAV 76,44,144
TR 26,7,9024
TR 28,7,8544
TR 30,7,9056
s_waitcnt vmcnt(18) lgkmcnt(8)
s_barrier
MAV 32,0,96
ds_read_b64_tr_b16 a[32:33], v6
s_add_u32 m0, s55, 50688
MAV 32,16,104
buffer_load_dwordx4 v18, s[28:31], s54 offen lds
MAV 48,16,108
TR 34,6,512
MAV 48,0,100
TR 36,6,32
TR 38,6,544
MAV 52,4,100
TR 48,6,8448
s_add_u32 s52, s79, 802816
MAV 52,20,108
buffer_load_dwordx4 v[144:147], v4, s[16:19], s52 offen sc1
MAV 36,20,104
TR 50,6,8960
MAV 36,4,96
TR 52,6,8480
TR 54,6,8992
s_waitcnt lgkmcnt(8)
MAV 40,8,96
TR 40,6,64
MAV 40,24,104
buffer_load_dwordx4 v19, s[28:31], s54 offen offset:1056 lds
MAV 56,24,108
TR 42,6,576
s_add_u32 s54, s101, 1703936
MAV 56,8,100
TR 44,6,96
TR 46,6,608
MAV 60,12,100
TR 56,6,8512
MAV 60,28,108
buffer_load_dwordx4 v[148:151], v4, s[16:19], s52 offen offset:1024 sc1
.Lpad17:
s_cbranch_execz .Lpad20
MAV 44,28,104
TR 58,6,9024
MAV 44,12,96
TR 60,6,8544
TR 62,6,9056
s_waitcnt lgkmcnt(8)
MAV 64,32,96
TR 0,7,16896
s_add_u32 m0, s55, 59136
MAV 64,48,104
buffer_load_dwordx4 v18, s[28:31], s54 offen lds
MAV 80,48,108
TR 2,7,17408
MAV 80,32,100
TR 4,7,16928
TR 6,7,17440
MAV 84,36,100
TR 16,7,25344
s_add_u32 s52, s79, 868352
MAV 84,52,108
buffer_load_dwordx4 v[152:155], v4, s[16:19], s52 offen sc1
MAV 68,52,104
TR 18,7,25856
MAV 68,36,96
TR 20,7,25376
TR 22,7,25888
s_waitcnt lgkmcnt(8)
MAV 72,40,96
TR 8,7,16960
MAV 72,56,104
buffer_load_dwordx4 v19, s[28:31], s54 offen offset:1056 lds
MAV 88,56,108
TR 10,7,17472
s_add_u32 s54, s98, 1900544
MAV 88,40,100
TR 12,7,16992
TR 14,7,17504
MAV 92,44,100
TR 24,7,25408
MAV 92,60,108
buffer_load_dwordx4 v[156:159], v4, s[16:19], s52 offen offset:1024 sc1
MAV 76,60,104
TR 26,7,25920
MAV 76,44,96
TR 28,7,25440
TR 30,7,25952
s_waitcnt vmcnt(8)
v_cmp_gt_u32 vcc, v23, v25
s_nop 0
s_cbranch_vccnz .Lsp50
.Lsp50b:
s_waitcnt lgkmcnt(8)
s_barrier
MAV 32,0,112
TR 32,6,16896
s_add_u32 m0, s55, 67584
MAV 32,16,120
buffer_load_dwordx4 v18, s[28:31], s54 offen lds
MAV 48,16,124
TR 34,6,17408
MAV 48,0,116
TR 36,6,16928
TR 38,6,17440
MAV 52,4,116
TR 48,6,25344
s_add_u32 s52, s76, 16384
MAV 52,20,124
buffer_load_dwordx4 v[96:99], v4, s[16:19], s52 offen sc1
MAV 36,20,120
TR 50,6,25856
MAV 36,4,112
TR 52,6,25376
TR 54,6,25888
s_waitcnt lgkmcnt(8)
MAV 40,8,112
TR 40,6,16960
MAV 40,24,120
buffer_load_dwordx4 v19, s[28:31], s54 offen offset:1056 lds
MAV 56,24,124
TR 42,6,17472
s_add_u32 s54, s98, 2162688
MAV 56,8,116
TR 44,6,16992
TR 46,6,17504
MAV 60,12,116
TR 56,6,25408
MAV 60,28,124
buffer_load_dwordx4 v[100:103], v4, s[16:19], s52 offen offset:1024 sc1
MAV 44,28,120
TR 58,6,25920
MAV 44,12,112
TR 60,6,25440
TR 62,6,25952
s_waitcnt lgkmcnt(8)
MAV 64,32,112
TR 0,7,33792
s_add_u32 m0, s55, 76032
MAV 64,48,120
buffer_load_dwordx4 v18, s[28:31], s54 offen lds
MAV 80,48,124
TR 2,7,34304
MAV 80,32,116
TR 4,7,33824
TR 6,7,34336
MAV 84,36,116
TR 16,7,42240
s_add_u32 s52, s76, 81920
MAV 84,52,124
buffer_load_dwordx4 v[104:107], v4, s[16:19], s52 offen sc1
MAV 68,52,120
TR 18,7,42752
MAV 68,36,112
TR 20,7,42272
TR 22,7,42784
s_waitcnt lgkmcnt(8)
MAV 72,40,112
TR 8,7,33856
MAV 72,56,120
buffer_load_dwordx4 v19, s[28:31], s54 offen offset:1056 lds
MAV 88,56,124
TR 10,7,34368
s_add_u32 s54, s99, 2359296
MAV 88,40,116
TR 12,7,33888
TR 14,7,34400
MAV 92,44,116
TR 24,7,42304
MAV 92,60,124
buffer_load_dwordx4 v[108:111], v4, s[16:19], s52 offen offset:1024 sc1
MAV 76,60,120
TR 26,7,42816
MAV 76,44,112
TR 28,7,42336
TR 30,7,42848
s_waitcnt lgkmcnt(8)
s_barrier
MAV 32,0,128
TR 32,6,33792
s_add_u32 m0, s55, 84480
MAV 32,16,136
buffer_load_dwordx4 v18, s[28:31], s54 offen lds
MAV 48,16,140
TR 34,6,34304
MAV 48,0,132
TR 36,6,33824
TR 38,6,34336
MAV 52,4,132
TR 48,6,42240
s_add_u32 s52, s77, 131072
MAV 52,20,140
buffer_load_dwordx4 v[112:115], v4, s[16:19], s52 offen sc1
MAV 36,20,136
TR 50,6,42752
MAV 36,4,128
TR 52,6,42272
TR 54,6,42784
s_waitcnt lgkmcnt(8)
MAV 40,8,128
TR 40,6,33856
MAV 40,24,136
buffer_load_dwordx4 v19, s[28:31], s54 offen offset:1056 lds
MAV 56,24,140
TR 42,6,34368
s_add_u32 s54, s99, 2621440
MAV 56,8,132
TR 44,6,33888
TR 46,6,34400
MAV 60,12,132
TR 56,6,42304
MAV 60,28,140
buffer_load_dwordx4 v[116:119], v4, s[16:19], s52 offen offset:1024 sc1
MAV 44,28,136
TR 58,6,42816
MAV 44,12,128
TR 60,6,42336
TR 62,6,42848
s_waitcnt lgkmcnt(8)
MAV 64,32,128
TR 0,7,50688
s_add_u32 m0, s55, 92928
MAV 64,48,136
buffer_load_dwordx4 v18, s[28:31], s54 offen lds
MAV 80,48,140
TR 2,7,51200
MAV 80,32,132
TR 4,7,50720
TR 6,7,51232
MAV 84,36,132
TR 16,7,59136
s_add_u32 s52, s77, 196608
MAV 84,52,140
buffer_load_dwordx4 v[120:123], v4, s[16:19], s52 offen sc1
MAV 68,52,136
TR 18,7,59648
MAV 68,36,128
TR 20,7,59168
TR 22,7,59680
s_waitcnt lgkmcnt(8)
MAV 72,40,128
TR 8,7,50752
MAV 72,56,136
buffer_load_dwordx4 v19, s[28:31], s54 offen offset:1056 lds
MAV 88,56,140
TR 10,7,51264
s_add_u32 s54, s100, 2818048
MAV 88,40,132
TR 12,7,50784
TR 14,7,51296
MAV 92,44,132
TR 24,7,59200
MAV 92,60,140
buffer_load_dwordx4 v[124:127], v4, s[16:19], s52 offen offset:1024 sc1
MAV 76,60,136
TR 26,7,59712
MAV 76,44,128
TR 28,7,59232
TR 30,7,59744
s_waitcnt vmcnt(16) lgkmcnt(8)
s_barrier
MAV 32,0,144
TR 32,6,50688
s_add_u32 m0, s55, 101376
MAV 32,16,152
buffer_load_dwordx4 v18, s[28:31], s54 offen lds
MAV 48,16,156
TR 34,6,51200
MAV 48,0,148
TR 36,6,50720
TR 38,6,51232
MAV 52,4,148
TR 48,6,59136
s_add_u32 s52, s78, 245760
MAV 52,20,156
buffer_load_dwordx4 v[128:131], v4, s[16:19], s52 offen sc1
MAV 36,20,152
TR 50,6,59648
MAV 36,4,144
TR 52,6,59168
TR 54,6,59680
s_waitcnt lgkmcnt(8)
MAV 40,8,144
TR 40,6,50752
MAV 40,24,152
buffer_load_dwordx4 v19, s[28:31], s54 offen offset:1056 lds
MAV 56,24,156
TR 42,6,51264
s_add_u32 s54, s100, 3080192
MAV 56,8,148
TR 44,6,50784
TR 46,6,51296
MAV 60,12,148
TR 56,6,59200
MAV 60,28,156
buffer_load_dwordx4 v[132:135], v4, s[16:19], s52 offen offset:1024 sc1
MAV 44,28,152
TR 58,6,59712
MAV 44,12,144
TR 60,6,59232
TR 62,6,59744
v_add_u32 v7, s57, v7
v_add_u32 v6, s57, v6
s_sub_u32 s57, 0, s57
s_waitcnt lgkmcnt(8)
MAV 64,32,144
ds_read_b64_tr_b16 a[0:1], v7
s_add_u32 m0, s55, 109824
MAV 64,48,152
buffer_load_dwordx4 v18, s[28:31], s54 offen lds
MAV 80,48,156
TR 2,7,512
MAV 80,32,148
TR 4,7,32
TR 6,7,544
MAV 84,36,148
TR 16,7,8448
s_add_u32 s52, s78, 311296
MAV 84,52,156
buffer_load_dwordx4 v[136:139], v4, s[16:19], s52 offen sc1
MAV 68,52,152
TR 18,7,8960
MAV 68,36,144
TR 20,7,8480
TR 22,7,8992
s_waitcnt lgkmcnt(8)
MAV 72,40,144
TR 8,7,64
MAV 72,56,152
buffer_load_dwordx4 v19, s[28:31], s54 offen offset:1056 lds
MAV 88,56,156
TR 10,7,576
s_add_u32 s54, s101, 3276800
MAV 88,40,148
TR 12,7,96
TR 14,7,608
MAV 92,44,148
TR 24,7,8512
MAV 92,60,156
buffer_load_dwordx4 v[140:143], v4, s[16:19], s52 offen offset:1024 sc1
MAV 76,60,152
TR 26,7,9024
MAV 76,44,144
TR 28,7,8544
TR 30,7,9056
s_waitcnt vmcnt(16) lgkmcnt(8)
s_barrier
MAV 32,0,96
ds_read_b64_tr_b16 a[32:33], v6
s_add_u32 m0, s55, 118272
MAV 32,16,104
buffer_load_dwordx4 v18, s[28:31], s54 offen lds
MAV 48,16,108
TR 34,6,512
MAV 48,0,100
TR 36,6,32
TR 38,6,544
MAV 52,4,100
TR 48,6,8448
s_add_u32 s52, s79, 360448
MAV 52,20,108
buffer_load_dwordx4 v[144:147], v4, s[16:19], s52 offen sc1
MAV 36,20,104
TR 50,6,8960
MAV 36,4,96
TR 52,6,8480
TR 54,6,8992
s_waitcnt lgkmcnt(8)
MAV 40,8,96
TR 40,6,64
MAV 40,24,104
buffer_load_dwordx4 v19, s[28:31], s54 offen offset:1056 lds
MAV 56,24,108
TR 42,6,576
s_add_u32 s54, s101, 3538944
MAV 56,8,100
TR 44,6,96
TR 46,6,608
MAV 60,12,100
TR 56,6,8512
MAV 60,28,108
buffer_load_dwordx4 v[148:151], v4, s[16:19], s52 offen offset:1024 sc1
MAV 44,28,104
TR 58,6,9024
MAV 44,12,96
TR 60,6,8544
TR 62,6,9056
s_waitcnt lgkmcnt(8)
MAV 64,32,96
TR 0,7,16896
s_add_u32 m0, s55, 126720
MAV 64,48,104
buffer_load_dwordx4 v18, s[28:31], s54 offen lds
MAV 80,48,108
TR 2,7,17408
MAV 80,32,100
TR 4,7,16928
TR 6,7,17440
MAV 84,36,100
TR 16,7,25344
s_add_u32 s52, s79, 425984
MAV 84,52,108
buffer_load_dwordx4 v[152:155], v4, s[16:19], s52 offen sc1
MAV 68,52,104
TR 18,7,25856
MAV 68,36,96
TR 20,7,25376
TR 22,7,25888
s_waitcnt lgkmcnt(8)
MAV 72,40,96
TR 8,7,16960
MAV 72,56,104
buffer_load_dwordx4 v19, s[28:31], s54 offen offset:1056 lds
MAV 88,56,108
TR 10,7,17472
s_add_u32 s54, s98, 131072
MAV 88,40,100
TR 12,7,16992
TR 14,7,17504
MAV 92,44,100
TR 24,7,25408
MAV 92,60,108
buffer_load_dwordx4 v[156:159], v4, s[16:19], s52 offen offset:1024 sc1
MAV 76,60,104
TR 26,7,25920
MAV 76,44,96
TR 28,7,25440
TR 30,7,25952
s_waitcnt vmcnt(16) lgkmcnt(8)
s_barrier
MAV 32,0,112
TR 32,6,16896
s_add_u32 m0, s55, 0
MAV 32,16,120
buffer_load_dwordx4 v18, s[28:31], s54 offen lds
MAV 48,16,124
TR 34,6,17408
MAV 48,0,116
TR 36,6,16928
TR 38,6,17440
MAV 52,4,116
TR 48,6,25344
s_add_u32 s52, s76, 475136
MAV 52,20,124
buffer_load_dwordx4 v[96:99], v4, s[16:19], s52 offen sc1
MAV 36,20,120
TR 50,6,25856
MAV 36,4,112
TR 52,6,25376
TR 54,6,25888
s_waitcnt lgkmcnt(8)
MAV 40,8,112
TR 40,6,16960
MAV 40,24,120
buffer_load_dwordx4 v19, s[28:31], s54 offen offset:1056 lds
MAV 56,24,124
TR 42,6,17472
s_add_u32 s54, s98, 393216
MAV 56,8,116
TR 44,6,16992
TR 46,6,17504
MAV 60,12,116
TR 56,6,25408
MAV 60,28,124
buffer_load_dwordx4 v[100:103], v4, s[16:19], s52 offen offset:1024 sc1
MAV 44,28,120
TR 58,6,25920
MAV 44,12,112
TR 60,6,25440
TR 62,6,25952
s_waitcnt lgkmcnt(8)
MAV 64,32,112
TR 0,7,33792
s_add_u32 m0, s55, 8448
MAV 64,48,120
buffer_load_dwordx4 v18, s[28:31], s54 offen lds
MAV 80,48,124
TR 2,7,34304
MAV 80,32,116
TR 4,7,33824
TR 6,7,34336
MAV 84,36,116
TR 16,7,42240
s_add_u32 s52, s76, 540672
MAV 84,52,124
buffer_load_dwordx4 v[104:107], v4, s[16:19], s52 offen sc1
MAV 68,52,120
TR 18,7,42752
MAV 68,36,112
TR 20,7,42272
TR 22,7,42784
s_waitcnt lgkmcnt(8)
MAV 72,40,112
TR 8,7,33856
MAV 72,56,120
buffer_load_dwordx4 v19, s[28:31], s54 offen offset:1056 lds
MAV 88,56,124
TR 10,7,34368
s_add_u32 s54, s99, 589824
MAV 88,40,116
TR 12,7,33888
TR 14,7,34400
MAV 92,44,116
TR 24,7,42304
MAV 92,60,124
buffer_load_dwordx4 v[108:111], v4, s[16:19], s52 offen offset:1024 sc1
MAV 76,60,120
TR 26,7,42816
MAV 76,44,112
TR 28,7,42336
TR 30,7,42848
s_waitcnt vmcnt(16) lgkmcnt(8)
s_barrier
MAV 32,0,128
TR 32,6,33792
s_add_u32 m0, s55, 16896
MAV 32,16,136
buffer_load_dwordx4 v18, s[28:31], s54 offen lds
MAV 48,16,140
TR 34,6,34304
MAV 48,0,132
TR 36,6,33824
TR 38,6,34336
MAV 52,4,132
TR 48,6,42240
s_add_u32 s52, s77, 589824
MAV 52,20,140
buffer_load_dwordx4 v[112:115], v4, s[16:19], s52 offen sc1
MAV 36,20,136
TR 50,6,42752
MAV 36,4,128
TR 52,6,42272
TR 54,6,42784
s_waitcnt lgkmcnt(8)
MAV 40,8,128
TR 40,6,33856
MAV 40,24,136
buffer_load_dwordx4 v19, s[28:31], s54 offen offset:1056 lds
MAV 56,24,140
TR 42,6,34368
s_add_u32 s54, s99, 851968
MAV 56,8,132
TR 44,6,33888
TR 46,6,34400
MAV 60,12,132
TR 56,6,42304
MAV 60,28,140
buffer_load_dwordx4 v[116:119], v4, s[16:19], s52 offen offset:1024 sc1
MAV 44,28,136
TR 58,6,42816
MAV 44,12,128
TR 60,6,42336
TR 62,6,42848
s_waitcnt lgkmcnt(8)
MAV 64,32,128
TR 0,7,50688
s_add_u32 m0, s55, 25344
MAV 64,48,136
buffer_load_dwordx4 v18, s[28:31], s54 offen lds
MAV 80,48,140
TR 2,7,51200
MAV 80,32,132
TR 4,7,50720
TR 6,7,51232
MAV 84,36,132
TR 16,7,59136
s_add_u32 s52, s77, 655360
MAV 84,52,140
buffer_load_dwordx4 v[120:123], v4, s[16:19], s52 offen sc1
MAV 68,52,136
TR 18,7,59648
MAV 68,36,128
TR 20,7,59168
TR 22,7,59680
.Lpad18:
s_cbranch_execz .Lpad21
s_waitcnt lgkmcnt(8)
MAV 72,40,128
TR 8,7,50752
MAV 72,56,136
buffer_load_dwordx4 v19, s[28:31], s54 offen offset:1056 lds
MAV 88,56,140
TR 10,7,51264
s_add_u32 s54, s100, 1048576
MAV 88,40,132
TR 12,7,50784
TR 14,7,51296
MAV 92,44,132
TR 24,7,59200
MAV 92,60,140
buffer_load_dwordx4 v[124:127], v4, s[16:19], s52 offen offset:1024 sc1
MAV 76,60,136
TR 26,7,59712
MAV 76,44,128
TR 28,7,59232
TR 30,7,59744
s_waitcnt vmcnt(16) lgkmcnt(8)
s_barrier
MAV 32,0,144
TR 32,6,50688
s_add_u32 m0, s55, 33792
MAV 32,16,152
buffer_load_dwordx4 v18, s[28:31], s54 offen lds
MAV 48,16,156
TR 34,6,51200
MAV 48,0,148
TR 36,6,50720
TR 38,6,51232
MAV 52,4,148
TR 48,6,59136
s_add_u32 s52, s78, 704512
MAV 52,20,156
buffer_load_dwordx4 v[128:131], v4, s[16:19], s52 offen sc1
MAV 36,20,152
TR 50,6,59648
MAV 36,4,144
TR 52,6,59168
TR 54,6,59680
s_waitcnt lgkmcnt(8)
MAV 40,8,144
TR 40,6,50752
MAV 40,24,152
buffer_load_dwordx4 v19, s[28:31], s54 offen offset:1056 lds
MAV 56,24,156
TR 42,6,51264
s_add_u32 s54, s100, 1310720
MAV 56,8,148
TR 44,6,50784
TR 46,6,51296
MAV 60,12,148
TR 56,6,59200
MAV 60,28,156
buffer_load_dwordx4 v[132:135], v4, s[16:19], s52 offen offset:1024 sc1
MAV 44,28,152
TR 58,6,59712
MAV 44,12,144
TR 60,6,59232
TR 62,6,59744
v_add_u32 v7, s57, v7
v_add_u32 v6, s57, v6
s_sub_u32 s57, 0, s57
s_waitcnt lgkmcnt(8)
MAV 64,32,144
ds_read_b64_tr_b16 a[0:1], v7
s_add_u32 m0, s55, 42240
MAV 64,48,152
buffer_load_dwordx4 v18, s[28:31], s54 offen lds
MAV 80,48,156
TR 2,7,512
MAV 80,32,148
TR 4,7,32
TR 6,7,544
MAV 84,36,148
TR 16,7,8448
s_add_u32 s52, s78, 770048
MAV 84,52,156
buffer_load_dwordx4 v[136:139], v4, s[16:19], s52 offen sc1
MAV 68,52,152
TR 18,7,8960
MAV 68,36,144
TR 20,7,8480
TR 22,7,8992
s_waitcnt lgkmcnt(8)
MAV 72,40,144
TR 8,7,64
MAV 72,56,152
buffer_load_dwordx4 v19, s[28:31], s54 offen offset:1056 lds
MAV 88,56,156
TR 10,7,576
s_add_u32 s54, s101, 1507328
MAV 88,40,148
TR 12,7,96
TR 14,7,608
MAV 92,44,148
TR 24,7,8512
MAV 92,60,156
buffer_load_dwordx4 v[140:143], v4, s[16:19], s52 offen offset:1024 sc1
MAV 76,60,152
TR 26,7,9024
MAV 76,44,144
TR 28,7,8544
TR 30,7,9056
s_waitcnt vmcnt(16) lgkmcnt(8)
s_barrier
MAV 32,0,96
ds_read_b64_tr_b16 a[32:33], v6
s_add_u32 m0, s55, 50688
MAV 32,16,104
buffer_load_dwordx4 v18, s[28:31], s54 offen lds
MAV 48,16,108
TR 34,6,512
MAV 48,0,100
TR 36,6,32
TR 38,6,544
MAV 52,4,100
TR 48,6,8448
s_add_u32 s52, s79, 819200
MAV 52,20,108
buffer_load_dwordx4 v[144:147], v4, s[16:19], s52 offen sc1
MAV 36,20,104
TR 50,6,8960
MAV 36,4,96
TR 52,6,8480
TR 54,6,8992
s_waitcnt lgkmcnt(8)
MAV 40,8,96
TR 40,6,64
MAV 40,24,104
buffer_load_dwordx4 v19, s[28:31], s54 offen offset:1056 lds
MAV 56,24,108
TR 42,6,576
s_add_u32 s54, s101, 1769472
MAV 56,8,100
TR 44,6,96
TR 46,6,608
MAV 60,12,100
TR 56,6,8512
MAV 60,28,108
buffer_load_dwordx4 v[148:151], v4, s[16:19], s52 offen offset:1024 sc1
MAV 44,28,104
TR 58,6,9024
MAV 44,12,96
TR 60,6,8544
TR 62,6,9056
s_waitcnt lgkmcnt(8)
MAV 64,32,96
TR 0,7,16896
s_add_u32 m0, s55, 59136
MAV 64,48,104
buffer_load_dwordx4 v18, s[28:31], s54 offen lds
MAV 80,48,108
TR 2,7,17408
MAV 80,32,100
TR 4,7,16928
TR 6,7,17440
MAV 84,36,100
TR 16,7,25344
s_add_u32 s52, s79, 884736
MAV 84,52,108
buffer_load_dwordx4 v[152:155], v4, s[16:19], s52 offen sc1
MAV 68,52,104
TR 18,7,25856
MAV 68,36,96
TR 20,7,25376
TR 22,7,25888
s_waitcnt lgkmcnt(8)
MAV 72,40,96
TR 8,7,16960
MAV 72,56,104
buffer_load_dwordx4 v19, s[28:31], s54 offen offset:1056 lds
MAV 88,56,108
TR 10,7,17472
s_add_u32 s54, s98, 1966080
MAV 88,40,100
TR 12,7,16992
TR 14,7,17504
MAV 92,44,100
TR 24,7,25408
MAV 92,60,108
buffer_load_dwordx4 v[156:159], v4, s[16:19], s52 offen offset:1024 sc1
MAV 76,60,104
TR 26,7,25920
MAV 76,44,96
TR 28,7,25440
TR 30,7,25952
s_waitcnt vmcnt(16) lgkmcnt(8)
s_barrier
MAV 32,0,112
TR 32,6,16896
s_add_u32 m0, s55, 67584
MAV 32,16,120
buffer_load_dwordx4 v18, s[28:31], s54 offen lds
MAV 48,16,124
TR 34,6,17408
MAV 48,0,116
TR 36,6,16928
TR 38,6,17440
MAV 52,4,116
TR 48,6,25344
s_add_u32 s52, s76, 32768
MAV 52,20,124
buffer_load_dwordx4 v[96:99], v4, s[16:19], s52 offen sc1
MAV 36,20,120
TR 50,6,25856
MAV 36,4,112
TR 52,6,25376
TR 54,6,25888
s_waitcnt lgkmcnt(8)
MAV 40,8,112
TR 40,6,16960
MAV 40,24,120
buffer_load_dwordx4 v19, s[28:31], s54 offen offset:1056 lds
MAV 56,24,124
TR 42,6,17472
s_add_u32 s54, s98, 2228224
MAV 56,8,116
TR 44,6,16992
TR 46,6,17504
MAV 60,12,116
TR 56,6,25408
MAV 60,28,124
buffer_load_dwordx4 v[100:103], v4, s[16:19], s52 offen offset:1024 sc1
MAV 44,28,120
TR 58,6,25920
MAV 44,12,112
TR 60,6,25440
TR 62,6,25952
s_waitcnt lgkmcnt(8)
MAV 64,32,112
TR 0,7,33792
s_add_u32 m0, s55, 76032
MAV 64,48,120
buffer_load_dwordx4 v18, s[28:31], s54 offen lds
MAV 80,48,124
TR 2,7,34304
MAV 80,32,116
TR 4,7,33824
TR 6,7,34336
MAV 84,36,116
TR 16,7,42240
s_add_u32 s52, s76, 98304
MAV 84,52,124
buffer_load_dwordx4 v[104:107], v4, s[16:19], s52 offen sc1
MAV 68,52,120
TR 18,7,42752
MAV 68,36,112
TR 20,7,42272
TR 22,7,42784
s_waitcnt lgkmcnt(8)
MAV 72,40,112
TR 8,7,33856
MAV 72,56,120
buffer_load_dwordx4 v19, s[28:31], s54 offen offset:1056 lds
MAV 88,56,124
TR 10,7,34368
s_add_u32 s54, s99, 2424832
MAV 88,40,116
TR 12,7,33888
TR 14,7,34400
MAV 92,44,116
TR 24,7,42304
MAV 92,60,124
buffer_load_dwordx4 v[108:111], v4, s[16:19], s52 offen offset:1024 sc1
MAV 76,60,120
TR 26,7,42816
MAV 76,44,112
TR 28,7,42336
TR 30,7,42848
s_waitcnt vmcnt(16) lgkmcnt(8)
s_barrier
MAV 32,0,128
TR 32,6,33792
s_add_u32 m0, s55, 84480
MAV 32,16,136
buffer_load_dwordx4 v18, s[28:31], s54 offen lds
MAV 48,16,140
TR 34,6,34304
MAV 48,0,132
TR 36,6,33824
TR 38,6,34336
MAV 52,4,132
TR 48,6,42240
s_add_u32 s52, s77, 147456
MAV 52,20,140
buffer_load_dwordx4 v[112:115], v4, s[16:19], s52 offen sc1
MAV 36,20,136
TR 50,6,42752
MAV 36,4,128
TR 52,6,42272
TR 54,6,42784
s_waitcnt lgkmcnt(8)
MAV 40,8,128
TR 40,6,33856
MAV 40,24,136
buffer_load_dwordx4 v19, s[28:31], s54 offen offset:1056 lds
MAV 56,24,140
TR 42,6,34368
s_add_u32 s54, s99, 2686976
MAV 56,8,132
TR 44,6,33888
TR 46,6,34400
MAV 60,12,132
TR 56,6,42304
MAV 60,28,140
buffer_load_dwordx4 v[116:119], v4, s[16:19], s52 offen offset:1024 sc1
MAV 44,28,136
TR 58,6,42816
MAV 44,12,128
TR 60,6,42336
TR 62,6,42848
s_waitcnt lgkmcnt(8)
MAV 64,32,128
TR 0,7,50688
s_add_u32 m0, s55, 92928
MAV 64,48,136
buffer_load_dwordx4 v18, s[28:31], s54 offen lds
MAV 80,48,140
TR 2,7,51200
MAV 80,32,132
TR 4,7,50720
TR 6,7,51232
MAV 84,36,132
TR 16,7,59136
s_add_u32 s52, s77, 212992
MAV 84,52,140
buffer_load_dwordx4 v[120:123], v4, s[16:19], s52 offen sc1
MAV 68,52,136
TR 18,7,59648
MAV 68,36,128
TR 20,7,59168
TR 22,7,59680
s_waitcnt lgkmcnt(8)
MAV 72,40,128
TR 8,7,50752
MAV 72,56,136
buffer_load_dwordx4 v19, s[28:31], s54 offen offset:1056 lds
MAV 88,56,140
TR 10,7,51264
s_add_u32 s54, s100, 2883584
MAV 88,40,132
TR 12,7,50784
TR 14,7,51296
MAV 92,44,132
TR 24,7,59200
MAV 92,60,140
buffer_load_dwordx4 v[124:127], v4, s[16:19], s52 offen offset:1024 sc1
MAV 76,60,136
TR 26,7,59712
MAV 76,44,128
TR 28,7,59232
TR 30,7,59744
s_waitcnt vmcnt(16) lgkmcnt(8)
s_barrier
MAV 32,0,144
TR 32,6,50688
s_add_u32 m0, s55, 101376
MAV 32,16,152
buffer_load_dwordx4 v18, s[28:31], s54 offen lds
MAV 48,16,156
TR 34,6,51200
MAV 48,0,148
TR 36,6,50720
TR 38,6,51232
MAV 52,4,148
TR 48,6,59136
s_add_u32 s52, s78, 262144
MAV 52,20,156
buffer_load_dwordx4 v[128:131], v4, s[16:19], s52 offen sc1
MAV 36,20,152
TR 50,6,59648
MAV 36,4,144
TR 52,6,59168
TR 54,6,59680
s_waitcnt lgkmcnt(8)
MAV 40,8,144
TR 40,6,50752
MAV 40,24,152
buffer_load_dwordx4 v19, s[28:31], s54 offen offset:1056 lds
MAV 56,24,156
TR 42,6,51264
s_add_u32 s54, s100, 3145728
MAV 56,8,148
TR 44,6,50784
TR 46,6,51296
MAV 60,12,148
TR 56,6,59200
MAV 60,28,156
buffer_load_dwordx4 v[132:135], v4, s[16:19], s52 offen offset:1024 sc1
MAV 44,28,152
TR 58,6,59712
MAV 44,12,144
TR 60,6,59232
TR 62,6,59744
v_add_u32 v7, s57, v7
v_add_u32 v6, s57, v6
s_sub_u32 s57, 0, s57
s_waitcnt lgkmcnt(8)
MAV 64,32,144
ds_read_b64_tr_b16 a[0:1], v7
s_add_u32 m0, s55, 109824
MAV 64,48,152
buffer_load_dwordx4 v18, s[28:31], s54 offen lds
MAV 80,48,156
TR 2,7,512
MAV 80,32,148
TR 4,7,32
TR 6,7,544
MAV 84,36,148
TR 16,7,8448
s_add_u32 s52, s78, 327680
MAV 84,52,156
buffer_load_dwordx4 v[136:139], v4, s[16:19], s52 offen sc1
MAV 68,52,152
TR 18,7,8960
MAV 68,36,144
TR 20,7,8480
TR 22,7,8992
s_waitcnt lgkmcnt(8)
MAV 72,40,144
TR 8,7,64
MAV 72,56,152
buffer_load_dwordx4 v19, s[28:31], s54 offen offset:1056 lds
MAV 88,56,156
TR 10,7,576
s_add_u32 s54, s101, 3342336
MAV 88,40,148
TR 12,7,96
TR 14,7,608
MAV 92,44,148
TR 24,7,8512
MAV 92,60,156
buffer_load_dwordx4 v[140:143], v4, s[16:19], s52 offen offset:1024 sc1
MAV 76,60,152
TR 26,7,9024
MAV 76,44,144
TR 28,7,8544
TR 30,7,9056
s_waitcnt vmcnt(16) lgkmcnt(8)
s_barrier
MAV 32,0,96
ds_read_b64_tr_b16 a[32:33], v6
s_add_u32 m0, s55, 118272
MAV 32,16,104
buffer_load_dwordx4 v18, s[28:31], s54 offen lds
MAV 48,16,108
TR 34,6,512
MAV 48,0,100
TR 36,6,32
TR 38,6,544
MAV 52,4,100
TR 48,6,8448
s_add_u32 s52, s79, 376832
MAV 52,20,108
buffer_load_dwordx4 v[144:147], v4, s[16:19], s52 offen sc1
MAV 36,20,104
TR 50,6,8960
MAV 36,4,96
TR 52,6,8480
TR 54,6,8992
s_waitcnt lgkmcnt(8)
MAV 40,8,96
TR 40,6,64
MAV 40,24,104
buffer_load_dwordx4 v19, s[28:31], s54 offen offset:1056 lds
MAV 56,24,108
TR 42,6,576
s_add_u32 s54, s101, 3604480
MAV 56,8,100
TR 44,6,96
TR 46,6,608
MAV 60,12,100
TR 56,6,8512
MAV 60,28,108
buffer_load_dwordx4 v[148:151], v4, s[16:19], s52 offen offset:1024 sc1
MAV 44,28,104
TR 58,6,9024
MAV 44,12,96
TR 60,6,8544
TR 62,6,9056
s_waitcnt lgkmcnt(8)
MAV 64,32,96
TR 0,7,16896
s_add_u32 m0, s55, 126720
MAV 64,48,104
buffer_load_dwordx4 v18, s[28:31], s54 offen lds
MAV 80,48,108
TR 2,7,17408
MAV 80,32,100
TR 4,7,16928
TR 6,7,17440
MAV 84,36,100
TR 16,7,25344
s_add_u32 s52, s79, 442368
MAV 84,52,108
buffer_load_dwordx4 v[152:155], v4, s[16:19], s52 offen sc1
MAV 68,52,104
TR 18,7,25856
MAV 68,36,96
TR 20,7,25376
TR 22,7,25888
s_waitcnt lgkmcnt(8)
MAV 72,40,96
TR 8,7,16960
MAV 72,56,104
buffer_load_dwordx4 v19, s[28:31], s54 offen offset:1056 lds
MAV 88,56,108
TR 10,7,17472
s_add_u32 s54, s98, 196608
MAV 88,40,100
TR 12,7,16992
TR 14,7,17504
MAV 92,44,100
TR 24,7,25408
MAV 92,60,108
buffer_load_dwordx4 v[156:159], v4, s[16:19], s52 offen offset:1024 sc1
MAV 76,60,104
TR 26,7,25920
MAV 76,44,96
TR 28,7,25440
TR 30,7,25952
s_waitcnt vmcnt(16) lgkmcnt(8)
s_barrier
MAV 32,0,112
TR 32,6,16896
s_add_u32 m0, s55, 0
MAV 32,16,120
buffer_load_dwordx4 v18, s[28:31], s54 offen lds
MAV 48,16,124
.Lpad19:
s_cbranch_execz .Lnopoll37r
TR 34,6,17408
MAV 48,0,116
TR 36,6,16928
TR 38,6,17440
MAV 52,4,116
TR 48,6,25344
s_add_u32 s52, s76, 491520
MAV 52,20,124
buffer_load_dwordx4 v[96:99], v4, s[16:19], s52 offen sc1
MAV 36,20,120
TR 50,6,25856
MAV 36,4,112
TR 52,6,25376
TR 54,6,25888
s_waitcnt lgkmcnt(8)
MAV 40,8,112
TR 40,6,16960
MAV 40,24,120
buffer_load_dwordx4 v19, s[28:31], s54 offen offset:1056 lds
MAV 56,24,124
TR 42,6,17472
s_add_u32 s54, s99, 655360
MAV 56,8,116
TR 44,6,16992
TR 46,6,17504
MAV 60,12,116
TR 56,6,25408
MAV 60,28,124
buffer_load_dwordx4 v[100:103], v4, s[16:19], s52 offen offset:1024 sc1
MAV 44,28,120
TR 58,6,25920
MAV 44,12,112
TR 60,6,25440
TR 62,6,25952
s_waitcnt lgkmcnt(8)
MAV 64,32,112
TR 0,7,33792
s_add_u32 m0, s55, 8448
MAV 64,48,120
buffer_load_dwordx4 v18, s[28:31], s54 offen lds
MAV 80,48,124
TR 2,7,34304
MAV 80,32,116
TR 4,7,33824
TR 6,7,34336
MAV 84,36,116
TR 16,7,42240
s_add_u32 s52, s76, 557056
MAV 84,52,124
buffer_load_dwordx4 v[104:107], v4, s[16:19], s52 offen sc1
MAV 68,52,120
TR 18,7,42752
MAV 68,36,112
TR 20,7,42272
TR 22,7,42784
s_waitcnt lgkmcnt(8)
MAV 72,40,112
TR 8,7,33856
MAV 72,56,120
buffer_load_dwordx4 v19, s[28:31], s54 offen offset:1056 lds
MAV 88,56,124
TR 10,7,34368
s_add_u32 s54, s100, 1114112
MAV 88,40,116
TR 12,7,33888
TR 14,7,34400
MAV 92,44,116
TR 24,7,42304
MAV 92,60,124
buffer_load_dwordx4 v[108:111], v4, s[16:19], s52 offen offset:1024 sc1
MAV 76,60,120
TR 26,7,42816
MAV 76,44,112
TR 28,7,42336
TR 30,7,42848
s_waitcnt vmcnt(16) lgkmcnt(8)
s_barrier
MAV 32,0,128
TR 32,6,33792
s_add_u32 m0, s55, 16896
MAV 32,16,136
buffer_load_dwordx4 v18, s[28:31], s54 offen lds
MAV 48,16,140
TR 34,6,34304
MAV 48,0,132
TR 36,6,33824
TR 38,6,34336
MAV 52,4,132
TR 48,6,42240
s_add_u32 s52, s77, 606208
MAV 52,20,140
buffer_load_dwordx4 v[112:115], v4, s[16:19], s52 offen sc1
MAV 36,20,136
TR 50,6,42752
MAV 36,4,128
TR 52,6,42272
TR 54,6,42784
s_waitcnt lgkmcnt(8)
MAV 40,8,128
TR 40,6,33856
MAV 40,24,136
buffer_load_dwordx4 v19, s[28:31], s54 offen offset:1056 lds
MAV 56,24,140
TR 42,6,34368
s_add_u32 s54, s101, 1572864
MAV 56,8,132
TR 44,6,33888
TR 46,6,34400
MAV 60,12,132
TR 56,6,42304
MAV 60,28,140
buffer_load_dwordx4 v[116:119], v4, s[16:19], s52 offen offset:1024 sc1
MAV 44,28,136
TR 58,6,42816
MAV 44,12,128
TR 60,6,42336
TR 62,6,42848
s_waitcnt lgkmcnt(8)
MAV 64,32,128
TR 0,7,50688
s_add_u32 m0, s55, 25344
MAV 64,48,136
buffer_load_dwordx4 v18, s[28:31], s54 offen lds
MAV 80,48,140
TR 2,7,51200
MAV 80,32,132
TR 4,7,50720
TR 6,7,51232
MAV 84,36,132
TR 16,7,59136
s_add_u32 s52, s77, 671744
MAV 84,52,140
buffer_load_dwordx4 v[120:123], v4, s[16:19], s52 offen sc1
MAV 68,52,136
TR 18,7,59648
MAV 68,36,128
TR 20,7,59168
TR 22,7,59680
s_waitcnt lgkmcnt(8)
MAV 72,40,128
TR 8,7,50752
MAV 72,56,136
buffer_load_dwordx4 v19, s[28:31], s54 offen offset:1056 lds
MAV 88,56,140
TR 10,7,51264
s_add_u32 s54, s98, 2031616
MAV 88,40,132
TR 12,7,50784
TR 14,7,51296
MAV 92,44,132
TR 24,7,59200
MAV 92,60,140
buffer_load_dwordx4 v[124:127], v4, s[16:19], s52 offen offset:1024 sc1
MAV 76,60,136
TR 26,7,59712
MAV 76,44,128
TR 28,7,59232
TR 30,7,59744
s_waitcnt vmcnt(16) lgkmcnt(8)
s_barrier
MAV 32,0,144
TR 32,6,50688
s_add_u32 m0, s55, 33792
MAV 32,16,152
buffer_load_dwordx4 v18, s[28:31], s54 offen lds
MAV 48,16,156
TR 34,6,51200
MAV 48,0,148
TR 36,6,50720
TR 38,6,51232
MAV 52,4,148
TR 48,6,59136
s_add_u32 s52, s78, 720896
MAV 52,20,156
buffer_load_dwordx4 v[128:131], v4, s[16:19], s52 offen sc1
MAV 36,20,152
TR 50,6,59648
MAV 36,4,144
TR 52,6,59168
TR 54,6,59680
s_waitcnt lgkmcnt(8)
MAV 40,8,144
TR 40,6,50752
MAV 40,24,152
buffer_load_dwordx4 v19, s[28:31], s54 offen offset:1056 lds
MAV 56,24,156
TR 42,6,51264
s_add_u32 s54, s99, 2490368
MAV 56,8,148
TR 44,6,50784
TR 46,6,51296
MAV 60,12,148
TR 56,6,59200
MAV 60,28,156
buffer_load_dwordx4 v[132:135], v4, s[16:19], s52 offen offset:1024 sc1
MAV 44,28,152
TR 58,6,59712
MAV 44,12,144
TR 60,6,59232
TR 62,6,59744
v_add_u32 v7, s57, v7
v_add_u32 v6, s57, v6
s_sub_u32 s57, 0, s57
s_waitcnt lgkmcnt(8)
MAV 64,32,144
ds_read_b64_tr_b16 a[0:1], v6
s_add_u32 m0, s55, 42240
MAV 64,48,152
buffer_load_dwordx4 v18, s[28:31], s54 offen lds
MAV 80,48,156
TR 2,6,512
MAV 80,32,148
TR 4,6,32
TR 6,6,544
MAV 84,36,148
TR 16,6,8448
s_add_u32 s52, s78, 786432
MAV 84,52,156
buffer_load_dwordx4 v[136:139], v4, s[16:19], s52 offen sc1
MAV 68,52,152
TR 18,6,8960
MAV 68,36,144
TR 20,6,8480
TR 22,6,8992
s_waitcnt lgkmcnt(8)
MAV 72,40,144
TR 8,6,64
MAV 72,56,152
buffer_load_dwordx4 v19, s[28:31], s54 offen offset:1056 lds
MAV 88,56,156
TR 10,6,576
s_add_u32 s54, s100, 2949120
MAV 88,40,148
TR 12,6,96
TR 14,6,608
MAV 92,44,148
TR 24,6,8512
MAV 92,60,156
buffer_load_dwordx4 v[140:143], v4, s[16:19], s52 offen offset:1024 sc1
MAV 76,60,152
TR 26,6,9024
MAV 76,44,144
TR 28,6,8544
TR 30,6,9056
s_waitcnt vmcnt(16) lgkmcnt(8)
s_barrier
MAV 64,0,96
TR 32,6,16896
TR 34,6,17408
s_add_u32 m0, s55, 50688
MAV 64,16,104
TR 36,6,16928
buffer_load_dwordx4 v18, s[28:31], s54 offen lds
MAV 80,16,108
TR 38,6,17440
MAV 80,0,100
TR 48,6,25344
buffer_load_dwordx4 v19, s[28:31], s54 offen offset:1056 lds
MAV 84,4,100
TR 50,6,25856
s_add_u32 s54, s101, 3407872
s_add_u32 s52, s79, 835584
MAV 84,20,108
buffer_load_dwordx4 v[144:147], v4, s[16:19], s52 offen sc1
MAV 68,20,104
TR 52,6,25376
TR 54,6,25888
MAV 68,4,96
TR 40,6,16960
s_waitcnt lgkmcnt(9)
MAV 72,8,96
TR 42,6,17472
MAV 72,24,104
TR 44,6,16992
buffer_load_dwordx4 v[148:151], v4, s[16:19], s52 offen offset:1024 sc1
MAV 88,24,108
TR 46,6,17504
s_add_u32 m0, s55, 59136
MAV 88,8,100
TR 56,6,25408
buffer_load_dwordx4 v18, s[28:31], s54 offen lds
MAV 92,12,100
TR 58,6,25920
MAV 92,28,108
TR 60,6,25440
buffer_load_dwordx4 v19, s[28:31], s54 offen offset:1056 lds
MAV 76,28,104
TR 62,6,25952
s_add_u32 s52, s79, 901120
MAV 76,12,96
buffer_load_dwordx4 v[152:155], v4, s[16:19], s52 offen sc1
buffer_load_dwordx4 v[156:159], v4, s[16:19], s52 offen offset:1024 sc1
s_waitcnt vmcnt(16) lgkmcnt(8)
MAV 64,32,112
TR 0,6,33792
s_add_u32 s52, s76, 49152
s_lshl_b32 s70, s2, 10
MAV 64,48,120
buffer_load_dwordx4 v[160:163], v4, s[16:19], s52 offen sc1
s_lshl_b32 s62, s3, 7
MAV 80,48,124
TR 2,6,34304
s_add_u32 s70, s70, s62
s_add_u32 s70, s70, 31457280
MAV 80,32,116
TR 4,6,33824
TR 6,6,34336
MAV 84,36,116
TR 16,6,42240
s_xor_b32 s71, s70, 1024
v_min_u32 v26, 1, v1
MAV 84,52,124
buffer_load_dwordx4 v[164:167], v4, s[16:19], s52 offen offset:1024 sc1
v_lshlrev_b32 v26, 28, v26
MAV 68,52,120
TR 18,6,42752
v_mov_b32 v30, 1
MAV 68,36,112
TR 20,6,42272
TR 22,6,42784
s_waitcnt lgkmcnt(8)
MAV 72,40,112
TR 8,6,33856
s_add_u32 s52, s77, 163840
v_mov_b32 v31, 0
MAV 72,56,120
buffer_load_dwordx4 v[168:171], v4, s[16:19], s52 offen sc1
s_lshl_b32 s68, s7, 18
MAV 88,56,124
TR 10,6,34368
s_add_u32 s68, s68, 33554432
s_xor_b32 s69, s68, 262144
MAV 88,40,116
TR 12,6,33888
TR 14,6,34400
MAV 92,44,116
TR 24,6,42304
v_and_b32 v2, 1, v1
v_lshlrev_b32 v2, 4, v2
MAV 92,60,124
buffer_load_dwordx4 v[172:175], v4, s[16:19], s52 offen offset:1024 sc1
v_mov_b32 v224, 0x3f80
MAV 76,60,120
TR 26,6,42816
v_lshlrev_b32 v2, v2, v224
MAV 76,44,112
TR 28,6,42336
TR 30,6,42848
s_waitcnt vmcnt(12) lgkmcnt(8)
MAV 64,0,128
TR 32,6,50688
s_add_u32 s52, s78, 278528
v_bfe_u32 v224, v1, 2, 2
MAV 64,16,136
buffer_load_dwordx4 v[176:179], v4, s[16:19], s52 offen sc1
v_lshrrev_b32 v225, 4, v1
MAV 80,16,140
TR 34,6,51200
v_cmp_eq_u32 vcc, v224, v225
s_nop 1
v_cndmask_b32 v2, 0, v2, vcc
MAV 80,0,132
TR 36,6,50720
TR 38,6,51232
MAV 84,4,132
TR 48,6,59136
v_and_b32 v224, 2, v1
v_cmp_eq_u32 vcc, 0, v224
MAV 84,20,140
buffer_load_dwordx4 v[180:183], v4, s[16:19], s52 offen offset:1024 sc1
v_cndmask_b32 v226, 0, v2, vcc
MAV 68,20,136
TR 50,6,59648
v_cndmask_b32 v227, v2, 0, vcc
MAV 68,4,128
TR 52,6,59168
TR 54,6,59680
s_waitcnt lgkmcnt(8)
MAV 72,8,128
TR 40,6,50752
s_add_u32 s52, s79, 393216
v_mov_b32 v224, 0
MAV 72,24,136
buffer_load_dwordx4 v[184:187], v4, s[16:19], s52 offen sc1
v_mov_b32 v225, 0
MAV 88,24,140
TR 42,6,51264
v_mov_b32 v228, 0
v_mov_b32 v229, 0
MAV 88,8,132
TR 44,6,50784
TR 46,6,51296
MAV 92,12,132
TR 56,6,59200
v_bfe_u32 v18, v1, 3, 1
v_lshrrev_b32 v2, 4, v1
MAV 92,28,140
buffer_load_dwordx4 v[188:191], v4, s[16:19], s52 offen offset:1024 sc1
v_lshl_add_u32 v18, v2, 3, v18
MAV 76,28,136
TR 58,6,59712
s_lshl_b32 s62, s3, 1
MAV 76,12,128
TR 60,6,59232
TR 62,6,59744
s_waitcnt vmcnt(8) lgkmcnt(8)
s_barrier
v_add_u32 v6, s57, v6
MAV 64,32,144
ds_read_b64_tr_b16 a[0:1], v6
s_add_u32 s52, s76, 507904
v_add_u32 v18, s62, v18
MAV 64,48,152
buffer_load_dwordx4 v[192:195], v4, s[16:19], s52 offen sc1
v_mul_u32_u24 v18, 6144, v18
MAV 80,48,156
TR 2,6,512
v_and_b32 v2, 7, v1
v_lshl_add_u32 v18, v2, 4, v18
MAV 80,32,148
TR 4,6,32
TR 6,6,544
MAV 84,36,148
TR 16,6,8448
s_lshl_b32 s62, s9, 7
v_add_u32 v18, s62, v18
MAV 84,52,156
buffer_load_dwordx4 v[196:199], v4, s[16:19], s52 offen offset:1024 sc1
v_add_u32 v19, 1024, v18
MAV 68,52,152
TR 18,6,8960
v_add_u32 v20, 2048, v18
MAV 68,36,144
TR 20,6,8480
TR 22,6,8992
s_waitcnt lgkmcnt(8)
MAV 72,40,144
TR 8,6,64
s_add_u32 s52, s77, 622592
s_mul_i32 s59, s3, 3104
MAV 72,56,152
buffer_load_dwordx4 v[200:203], v4, s[16:19], s52 offen sc1
s_mov_b32 s58, 0
MAV 88,56,156
TR 10,6,576
v_accvgpr_read_b32 v28, a224
v_add_f32 v32, v32, v28
MAV 88,40,148
TR 12,6,96
TR 14,6,608
MAV 92,44,148
TR 24,6,8512
v_accvgpr_read_b32 v29, a225
v_add_f32 v33, v33, v29
MAV 92,60,156
buffer_load_dwordx4 v[204:207], v4, s[16:19], s52 offen offset:1024 sc1
v_accvgpr_read_b32 v28, a226
MAV 76,60,152
TR 26,6,9024
v_add_f32 v34, v34, v28
MAV 76,44,144
TR 28,6,8544
TR 30,6,9056
s_waitcnt vmcnt(8) lgkmcnt(8)
MAV 64,0,160
TR 32,6,16896
s_add_u32 s52, s78, 737280
v_accvgpr_read_b32 v29, a227
MAV 64,16,168
buffer_load_dwordx4 v[208:211], v4, s[16:19], s52 offen sc1
v_add_f32 v35, v35, v29
MAV 80,16,172
TR 34,6,17408
v_accvgpr_read_b32 v28, a228
v_add_f32 v36, v36, v28
MAV 80,0,164
TR 36,6,16928
TR 38,6,17440
MAV 84,4,164
TR 48,6,25344
v_accvgpr_read_b32 v29, a229
v_add_f32 v37, v37, v29
MAV 84,20,172
buffer_load_dwordx4 v[212:215], v4, s[16:19], s52 offen offset:1024 sc1
v_accvgpr_read_b32 v28, a230
MAV 68,20,168
TR 50,6,25856
v_add_f32 v38, v38, v28
MAV 68,4,160
TR 52,6,25376
TR 54,6,25888
s_waitcnt lgkmcnt(8)
MAV 72,8,160
TR 40,6,16960
s_add_u32 s52, s79, 851968
v_accvgpr_read_b32 v29, a231
MAV 72,24,168
buffer_load_dwordx4 v[216:219], v4, s[16:19], s52 offen sc1
v_add_f32 v39, v39, v29
MAV 88,24,172
TR 42,6,17472
v_accvgpr_read_b32 v28, a232
v_add_f32 v40, v40, v28
MAV 88,8,164
TR 44,6,16992
TR 46,6,17504
MAV 92,12,164
TR 56,6,25408
v_accvgpr_read_b32 v29, a233
v_add_f32 v41, v41, v29
MAV 92,28,172
buffer_load_dwordx4 v[220:223], v4, s[16:19], s52 offen offset:1024 sc1
v_accvgpr_read_b32 v28, a234
MAV 76,28,168
TR 58,6,25920
v_add_f32 v42, v42, v28
MAV 76,12,160
TR 60,6,25440
TR 62,6,25952
s_waitcnt vmcnt(8) lgkmcnt(8)
MAV 64,32,176
TR 0,6,33792
v_accvgpr_read_b32 v29, a235
MAV 64,48,184
TR 2,6,34304
v_add_f32 v43, v43, v29
v_accvgpr_read_b32 v28, a236
MAV 80,48,188
TR 4,6,33824
MAV 80,32,180
TR 6,6,34336
v_add_f32 v44, v44, v28
v_accvgpr_read_b32 v29, a237
MAV 84,36,180
TR 16,6,42240
MAV 84,52,188
TR 18,6,42752
v_add_f32 v45, v45, v29
v_accvgpr_read_b32 v28, a238
MAV 68,52,184
TR 20,6,42272
MAV 68,36,176
TR 22,6,42784
v_add_f32 v46, v46, v28
s_waitcnt lgkmcnt(8)
MAV 72,40,176
TR 8,6,33856
v_accvgpr_read_b32 v29, a239
MAV 72,56,184
.Lpad20:
s_cbranch_execz .Lnopoll37r
TR 10,6,34368
v_add_f32 v47, v47, v29
MAV 88,56,188
TR 12,6,33888
v_accvgpr_read_b32 v28, a240
MAV 88,40,180
TR 14,6,34400
v_add_f32 v48, v48, v28
MAV 92,44,180
TR 24,6,42304
v_accvgpr_read_b32 v29, a241
MAV 92,60,188
TR 26,6,42816
v_add_f32 v49, v49, v29
MAV 76,60,184
TR 28,6,42336
v_accvgpr_read_b32 v28, a242
MAV 76,44,176
TR 30,6,42848
v_add_f32 v50, v50, v28
s_waitcnt vmcnt(4) lgkmcnt(8)
MAV 64,0,192
TR 32,6,50688
v_accvgpr_read_b32 v29, a243
MAV 64,16,200
TR 34,6,51200
v_add_f32 v51, v51, v29
v_accvgpr_read_b32 v28, a244
MAV 80,16,204
TR 36,6,50720
MAV 80,0,196
TR 38,6,51232
v_add_f32 v52, v52, v28
v_accvgpr_read_b32 v29, a245
MAV 84,4,196
TR 48,6,59136
MAV 84,20,204
TR 50,6,59648
v_add_f32 v53, v53, v29
v_accvgpr_read_b32 v28, a246
MAV 68,20,200
TR 52,6,59168
MAV 68,4,192
TR 54,6,59680
v_add_f32 v54, v54, v28
s_waitcnt lgkmcnt(8)
MAV 72,8,192
TR 40,6,50752
v_accvgpr_read_b32 v29, a247
MAV 72,24,200
TR 42,6,51264
v_add_f32 v55, v55, v29
MAV 88,24,204
TR 44,6,50784
v_accvgpr_read_b32 v28, a248
MAV 88,8,196
TR 46,6,51296
v_add_f32 v56, v56, v28
MAV 92,12,196
TR 56,6,59200
v_accvgpr_read_b32 v29, a249
MAV 92,28,204
TR 58,6,59712
v_add_f32 v57, v57, v29
MAV 76,28,200
TR 60,6,59232
v_accvgpr_read_b32 v28, a250
MAV 76,12,192
TR 62,6,59744
v_add_f32 v58, v58, v28
s_waitcnt vmcnt(0) lgkmcnt(8)
MAV 64,32,208
ds_read_b64_tr_b16 a[0:1], v7
v_accvgpr_read_b32 v29, a251
MAV 64,48,216
TR 2,7,512
v_add_f32 v59, v59, v29
MAV 80,48,220
TR 4,7,32
MAV 80,32,212
TR 6,7,544
v_accvgpr_read_b32 v28, a252
MAV 84,36,212
TR 16,7,8448
v_add_f32 v60, v60, v28
MAV 84,52,220
TR 18,7,8960
MAV 68,52,216
TR 20,7,8480
v_accvgpr_read_b32 v29, a253
MAV 68,36,208
TR 22,7,8992
s_waitcnt lgkmcnt(8)
MAV 72,40,208
TR 8,7,64
v_add_f32 v61, v61, v29
MAV 72,56,216
TR 10,7,576
MAV 88,56,220
TR 12,7,96
v_accvgpr_read_b32 v28, a254
MAV 88,40,212
TR 14,7,608
v_add_f32 v62, v62, v28
MAV 92,44,212
TR 24,7,8512
MAV 92,60,220
TR 26,7,9024
v_accvgpr_read_b32 v29, a255
MAV 76,60,216
TR 28,7,8544
v_add_f32 v63, v63, v29
MAV 76,44,208
TR 30,7,9056
s_waitcnt lgkmcnt(8)
MAV 32,0,96
TR 32,7,16896
v_cvt_pk_bf16_f32 v232, v64, v65
MAV 32,16,104
TR 34,7,17408
v_cvt_pk_bf16_f32 v233, v66, v67
v_cvt_pk_bf16_f32 v234, v68, v69
MAV 48,16,108
TR 36,7,16928
v_cvt_pk_bf16_f32 v235, v70, v71
MAV 48,0,100
TR 38,7,17440
buffer_store_dwordx4 v[232:235], v4, s[16:19], s69 offen sc1
s_add_u32 s69, s69, 131072
MAV 52,4,100
TR 48,7,25344
v_cvt_pk_bf16_f32 v236, v72, v73
MAV 52,20,108
TR 50,7,25856
v_cvt_pk_bf16_f32 v237, v74, v75
v_cvt_pk_bf16_f32 v238, v76, v77
MAV 36,20,104
TR 52,7,25376
v_cvt_pk_bf16_f32 v239, v78, v79
MAV 36,4,96
TR 54,7,25888
buffer_store_dwordx4 v[236:239], v4, s[16:19], s69 offen sc1
s_waitcnt lgkmcnt(8)
MAV 40,8,96
TR 40,7,16960
s_add_u32 s69, s69, -130048
MAV 40,24,104
TR 42,7,17472
v_cvt_pk_bf16_f32 v240, v80, v81
v_cvt_pk_bf16_f32 v241, v82, v83
MAV 56,24,108
TR 44,7,16992
v_cvt_pk_bf16_f32 v242, v84, v85
MAV 56,8,100
TR 46,7,17504
v_cvt_pk_bf16_f32 v243, v86, v87
buffer_store_dwordx4 v[240:243], v4, s[16:19], s69 offen sc1
MAV 60,12,100
TR 56,7,25408
s_add_u32 s69, s69, 131072
MAV 60,28,108
TR 58,7,25920
v_cvt_pk_bf16_f32 v244, v88, v89
v_cvt_pk_bf16_f32 v245, v90, v91
MAV 44,28,104
TR 60,7,25440
v_cvt_pk_bf16_f32 v246, v92, v93
MAV 44,12,96
TR 62,7,25952
v_cvt_pk_bf16_f32 v247, v94, v95
buffer_store_dwordx4 v[244:247], v4, s[16:19], s69 offen sc1
s_waitcnt lgkmcnt(8)
MAV 32,32,112
TR 0,7,33792
MAV 32,48,120
TR 2,7,34304
MAV 48,48,124
TR 4,7,33824
MAV 48,32,116
TR 6,7,34336
MAV 52,36,116
TR 16,7,42240
MAV 52,52,124
TR 18,7,42752
MAV 36,52,120
TR 20,7,42272
MAV 36,36,112
TR 22,7,42784
s_waitcnt lgkmcnt(8)
MAV 40,40,112
TR 8,7,33856
MAV 40,56,120
TR 10,7,34368
MAV 56,56,124
TR 12,7,33888
MAV 56,40,116
TR 14,7,34400
MAV 60,44,116
TR 24,7,42304
MAV 60,60,124
TR 26,7,42816
MAV 44,60,120
TR 28,7,42336
MAV 44,44,112
TR 30,7,42848
s_waitcnt lgkmcnt(8)
MAV 32,0,128
TR 32,7,50688
MAV 32,16,136
TR 34,7,51200
MAV 48,16,140
TR 36,7,50720
MAV 48,0,132
TR 38,7,51232
MAV 52,4,132
TR 48,7,59136
MAV 52,20,140
TR 50,7,59648
MAV 36,20,136
TR 52,7,59168
MAV 36,4,128
TR 54,7,59680
s_waitcnt lgkmcnt(8)
MAV 40,8,128
TR 40,7,50752
MAV 40,24,136
TR 42,7,51264
MAV 56,24,140
TR 44,7,50784
MAV 56,8,132
TR 46,7,51296
MAV 60,12,132
TR 56,7,59200
MAV 60,28,140
TR 58,7,59712
MAV 44,28,136
TR 60,7,59232
MAV 44,12,128
TR 62,7,59744
v_add_u32 v7, s57, v7
s_waitcnt lgkmcnt(8)
MAV 32,32,144
ds_read_b64_tr_b16 a[0:1], v7
MAV 32,48,152
s_waitcnt vmcnt(0)
buffer_atomic_add v30, v26, s[16:19], s71 offen
MAV 48,48,156
TR 2,7,512
MAV 48,32,148
TR 4,7,32
TR 6,7,544
MAV 52,36,148
MAV 52,52,156
TR 16,7,8448
TR 18,7,8960
MAV 36,52,152
TR 20,7,8480
MAV 36,36,144
s_waitcnt lgkmcnt(7)
MAV 40,40,144
TR 22,7,8992
MAV 40,56,152
TR 8,7,64
TR 10,7,576
MAV 56,56,156
MAV 56,40,148
TR 12,7,96
TR 14,7,608
MAV 60,44,148
TR 24,7,8512
MAV 60,60,156
TR 26,7,9024
MAV 44,60,152
TR 28,7,8544
MAV 44,44,144
TR 30,7,9056
s_waitcnt lgkmcnt(8)
s_barrier
MAV 32,0,160
TR 32,7,16896
MAV 32,16,168
buffer_atomic_add v31, v26, s[16:19], s70 offen sc0
MAV 48,16,172
TR 34,7,17408
MAV 48,0,164
TR 36,7,16928
TR 38,7,17440
MAV 52,4,164
MAV 52,20,172
TR 48,7,25344
TR 50,7,25856
MAV 36,20,168
TR 52,7,25376
MAV 36,4,160
s_waitcnt lgkmcnt(7)
MAV 40,8,160
TR 54,7,25888
MAV 40,24,168
TR 40,7,16960
TR 42,7,17472
MAV 56,24,172
MAV 56,8,164
TR 44,7,16992
TR 46,7,17504
MAV 60,12,164
TR 56,7,25408
MAV 60,28,172
TR 58,7,25920
MAV 44,28,168
TR 60,7,25440
MAV 44,12,160
TR 62,7,25952
s_waitcnt lgkmcnt(8)
MAV 32,32,176
TR 0,7,33792
MAV 32,48,184
TR 2,7,34304
MAV 48,48,188
TR 4,7,33824
MAV 48,32,180
TR 6,7,34336
MAV 52,36,180
TR 16,7,42240
MAV 52,52,188
TR 18,7,42752
MAV 36,52,184
TR 20,7,42272
MAV 36,36,176
TR 22,7,42784
s_waitcnt lgkmcnt(8)
MAV 40,40,176
TR 8,7,33856
MAV 40,56,184
TR 10,7,34368
MAV 56,56,188
TR 12,7,33888
MAV 56,40,180
TR 14,7,34400
MAV 60,44,180
TR 24,7,42304
MAV 60,60,188
TR 26,7,42816
MAV 44,60,184
TR 28,7,42336
MAV 44,44,176
TR 30,7,42848
s_waitcnt vmcnt(0)
v_cmp_le_u32 vcc, 1, v31
s_nop 0
s_cbranch_vccnz .Lxs51
s_mov_b32 s15, 0
.Lxs51l:
v_mov_b32 v31, 0
buffer_atomic_add v31, v26, s[16:19], s70 offen sc0
s_add_u32 s15, s15, 1
s_cmp_gt_u32 s15, 100000
s_waitcnt vmcnt(0)
s_cbranch_scc1 .Lxs51
v_cmp_le_u32 vcc, 1, v31
s_nop 0
s_cbranch_vccz .Lxs51l
.Lxs51:
s_waitcnt lgkmcnt(8)
MAV 32,0,192
TR 32,7,50688
MAV 32,16,200
buffer_load_dwordx4 v[232:235], v4, s[16:19], s68 offen sc1
MAV 48,16,204
TR 34,7,51200
s_add_u32 s68, s68, 131072
MAV 48,0,196
TR 36,7,50720
TR 38,7,51232
MAV 52,4,196
TR 48,7,59136
MAV 52,20,204
buffer_load_dwordx4 v[236:239], v4, s[16:19], s68 offen sc1
MAV 36,20,200
TR 50,7,59648
s_add_u32 s68, s68, -130048
MAV 36,4,192
TR 52,7,59168
TR 54,7,59680
s_waitcnt lgkmcnt(8)
MAV 40,8,192
TR 40,7,50752
MAV 40,24,200
buffer_load_dwordx4 v[240:243], v4, s[16:19], s68 offen sc1
MAV 56,24,204
TR 42,7,51264
s_add_u32 s68, s68, 131072
MAV 56,8,196
TR 44,7,50784
TR 46,7,51296
MAV 60,12,196
TR 56,7,59200
MAV 60,28,204
buffer_load_dwordx4 v[244:247], v4, s[16:19], s68 offen sc1
MAV 44,28,200
TR 58,7,59712
MAV 44,12,192
TR 60,7,59232
TR 62,7,59744
s_waitcnt lgkmcnt(8)
MAV 32,32,208
MAV 32,48,216
MAV 48,48,220
MAV 48,32,212
MAV 52,36,212
MAV 52,52,220
MAV 36,52,216
MAV 36,36,208
s_waitcnt lgkmcnt(0)
MAV 40,40,208
MAV 40,56,216
MAV 56,56,220
MAV 56,40,212
MAV 60,44,212
MAV 60,60,220
MAV 44,60,216
MAV 44,44,208
s_waitcnt vmcnt(3)
v_mfma_f32_16x16x32_bf16 v[32:35], v[226:229], v[232:235], v[32:35]
s_lshl_b32 s64, s6, 14
s_lshl_b32 s65, s49, 13
s_add_u32 s64, s64, s65
v_mfma_f32_16x16x32_bf16 v[36:39], v[224:227], v[232:235], v[36:39]
s_lshl_b32 s65, s7, 9
s_add_u32 s64, s64, s65
s_lshl_b32 s65, s48, 8
s_waitcnt vmcnt(2)
v_mfma_f32_16x16x32_bf16 v[40:43], v[226:229], v[236:239], v[40:43]
s_add_u32 s64, s64, s65
s_add_u32 s64, s64, 62914560
v_and_b32 v152, 31, v1
v_mfma_f32_16x16x32_bf16 v[44:47], v[224:227], v[236:239], v[44:47]
s_lshl_b32 s62, s7, 18
v_lshlrev_b32 v152, 3, v152
v_lshrrev_b32 v153, 5, v1
s_waitcnt vmcnt(1)
v_mfma_f32_16x16x32_bf16 v[48:51], v[226:229], v[240:243], v[48:51]
s_add_u32 s62, s62, 33554432
v_lshl_add_u32 v152, v153, 28, v152
s_add_u32 s63, s62, 131072
v_mfma_f32_16x16x32_bf16 v[52:55], v[224:227], v[240:243], v[52:55]
v_cvt_pk_bf16_f32 v128, v32, v33
v_cvt_pk_bf16_f32 v129, v34, v35
s_waitcnt vmcnt(0)
v_mfma_f32_16x16x32_bf16 v[56:59], v[226:229], v[244:247], v[56:59]
v_cvt_pk_bf16_f32 v130, v36, v37
v_cvt_pk_bf16_f32 v131, v38, v39
v_mfma_f32_16x16x32_bf16 v[60:63], v[224:227], v[244:247], v[60:63]
buffer_store_dwordx4 v[128:131], v4, s[16:19], s62 offen sc1
v_cvt_pk_bf16_f32 v132, v40, v41
v_cvt_pk_bf16_f32 v133, v42, v43
v_cvt_pk_bf16_f32 v134, v44, v45
v_cvt_pk_bf16_f32 v135, v46, v47
v_cvt_pk_bf16_f32 v136, v48, v49
v_cvt_pk_bf16_f32 v137, v50, v51
v_cvt_pk_bf16_f32 v138, v52, v53
v_cvt_pk_bf16_f32 v139, v54, v55
v_cvt_pk_bf16_f32 v140, v56, v57
v_cvt_pk_bf16_f32 v141, v58, v59
v_cvt_pk_bf16_f32 v142, v60, v61
v_cvt_pk_bf16_f32 v143, v62, v63
v_pk_mul_f32 v[146:147], v[32:33], v[32:33]
buffer_store_dwordx4 v[132:135], v4, s[16:19], s63 offen sc1
v_pk_mul_f32 v[150:151], v[48:49], v[48:49]
v_pk_fma_f32 v[146:147], v[34:35], v[34:35], v[146:147]
v_pk_add_f32 v[144:145], v[32:33], v[34:35]
v_pk_fma_f32 v[150:151], v[50:51], v[50:51], v[150:151]
v_pk_add_f32 v[148:149], v[48:49], v[50:51]
v_pk_fma_f32 v[146:147], v[36:37], v[36:37], v[146:147]
v_pk_add_f32 v[144:145], v[144:145], v[36:37]
v_pk_fma_f32 v[150:151], v[52:53], v[52:53], v[150:151]
v_pk_add_f32 v[148:149], v[148:149], v[52:53]
v_pk_fma_f32 v[146:147], v[38:39], v[38:39], v[146:147]
v_pk_add_f32 v[144:145], v[144:145], v[38:39]
v_pk_fma_f32 v[150:151], v[54:55], v[54:55], v[150:151]
v_pk_add_f32 v[148:149], v[148:149], v[54:55]
buffer_store_dwordx4 v[136:139], v4, s[16:19], s62 offen offset:1024 sc1
v_pk_fma_f32 v[146:147], v[40:41], v[40:41], v[146:147]
v_pk_add_f32 v[144:145], v[144:145], v[40:41]
v_pk_fma_f32 v[150:151], v[56:57], v[56:57], v[150:151]
v_pk_add_f32 v[148:149], v[148:149], v[56:57]
v_pk_fma_f32 v[146:147], v[42:43], v[42:43], v[146:147]
v_pk_add_f32 v[144:145], v[144:145], v[42:43]
v_pk_fma_f32 v[150:151], v[58:59], v[58:59], v[150:151]
v_pk_add_f32 v[148:149], v[148:149], v[58:59]
v_pk_fma_f32 v[146:147], v[44:45], v[44:45], v[146:147]
v_pk_add_f32 v[144:145], v[144:145], v[44:45]
v_pk_fma_f32 v[150:151], v[60:61], v[60:61], v[150:151]
v_pk_add_f32 v[148:149], v[148:149], v[60:61]
v_pk_fma_f32 v[146:147], v[46:47], v[46:47], v[146:147]
buffer_store_dwordx4 v[140:143], v4, s[16:19], s63 offen offset:1024 sc1
v_pk_add_f32 v[144:145], v[144:145], v[46:47]
v_pk_fma_f32 v[150:151], v[62:63], v[62:63], v[150:151]
v_pk_add_f32 v[148:149], v[148:149], v[62:63]
v_add_f32 v144, v144, v145
v_add_f32 v146, v146, v147
v_add_f32 v148, v148, v149
v_add_f32 v150, v150, v151
s_nop 0
v_permlane16_swap_b32 v144, v148
v_permlane16_swap_b32 v146, v150
v_add_f32 v144, v144, v148
v_add_f32 v146, v146, v150
s_nop 1
v_permlane32_swap_b32 v144, v146
v_add_f32 v144, v144, v146
s_nop 1
v_permlane32_swap_b32 v144, v145
buffer_store_dwordx2 v[144:145], v152, s[16:19], s64 offen sc1
s_nop 1
s_mov_b32 s54, s58
s_mov_b32 s56, s59
v_accvgpr_write_b32 a224, v32
v_accvgpr_write_b32 a225, v33
v_accvgpr_write_b32 a226, v34
v_accvgpr_write_b32 a227, v35
v_accvgpr_write_b32 a228, v36
v_accvgpr_write_b32 a229, v37
v_accvgpr_write_b32 a230, v38
v_accvgpr_write_b32 a231, v39
v_accvgpr_write_b32 a232, v40
v_accvgpr_write_b32 a233, v41
v_accvgpr_write_b32 a234, v42
v_accvgpr_write_b32 a235, v43
v_accvgpr_write_b32 a236, v44
v_accvgpr_write_b32 a237, v45
v_accvgpr_write_b32 a238, v46
v_accvgpr_write_b32 a239, v47
v_accvgpr_write_b32 a240, v48
v_accvgpr_write_b32 a241, v49
v_accvgpr_write_b32 a242, v50
v_accvgpr_write_b32 a243, v51
v_accvgpr_write_b32 a244, v52
v_accvgpr_write_b32 a245, v53
v_accvgpr_write_b32 a246, v54
v_accvgpr_write_b32 a247, v55
v_accvgpr_write_b32 a248, v56
v_accvgpr_write_b32 a249, v57
v_accvgpr_write_b32 a250, v58
v_accvgpr_write_b32 a251, v59
v_accvgpr_write_b32 a252, v60
v_accvgpr_write_b32 a253, v61
v_accvgpr_write_b32 a254, v62
v_accvgpr_write_b32 a255, v63
s_lshl_b32 s62, s3, 11
s_add_u32 s62, s62, s85
v_lshl_add_u32 v21, v1, 4, s62
v_lshrrev_b32 v2, 3, v1
v_cmp_eq_u32 vcc, 3, v2
v_add_u32 v2, 67108480, v21
s_nop 0
v_cndmask_b32 v21, v21, v2, vcc
s_sub_u32 s62, s86, 2048
v_lshl_add_u32 v22, v0, 2, s62
.Lpad21:
s_cbranch_execz .Lnopoll37r
v_lshrrev_b32 v2, 5, v0
v_cmp_eq_u32 vcc, 3, v2
v_add_u32 v2, 67108480, v22
s_nop 0
v_cndmask_b32 v22, v22, v2, vcc
s_mul_i32 s62, s48, 4608
v_lshl_add_u32 v23, v1, 4, s62
v_lshrrev_b32 v24, 4, v1
v_mul_u32_u24 v24, 2304, v24
v_and_b32 v2, 15, v1
v_lshl_add_u32 v24, v2, 4, v24
s_mov_b32 s52, 33554432
s_mul_i32 s55, s3, 2304
v_bfe_u32 v25, v1, 3, 2
v_mul_u32_u24 v25, 3104, v25
v_bfe_u32 v2, v1, 2, 1
v_lshl_add_u32 v25, v2, 7, v25
v_bfe_u32 v2, v1, 5, 1
v_lshl_add_u32 v25, v2, 8, v25
v_and_b32 v2, 3, v1
v_lshl_add_u32 v25, v2, 3, v25
s_lshl_b32 s62, s49, 6
s_add_u32 s62, s62, 67584
v_add_u32 v25, s62, v25
s_lshl_b32 s62, s8, 1
s_add_u32 s62, s62, s3
s_lshr_b32 s63, s50, 2
s_cmp_lt_u32 s3, 2
s_cselect_b32 s62, s62, s63
s_lshl_b32 s62, s62, 13
s_cmp_eq_u32 s3, 3
s_cselect_b32 s62, 268435456, s62
v_lshl_add_u32 v26, v1, 4, s62
s_lshr_b32 s63, s20, 7
s_sub_u32 s63, 3, s63
s_and_b32 s63, s63, 7
s_and_b32 s62, s9, 8
s_add_u32 s63, s63, s62
s_lshl_b32 s62, s5, 2
s_add_u32 s62, s62, s3
s_mul_i32 s62, s62, 12288
s_lshl_b32 s64, s63, 7
s_add_u32 s62, s62, s64
s_xor_b32 s63, s63, s9
s_cmp_lt_u32 s63, 4
s_cselect_b32 s62, s62, 16777216
v_lshrrev_b32 v14, 3, v1
v_min_u32 v14, 5, v14
v_lshl_add_u32 v14, v14, 11, s62
s_mov_b32 s44, 983040
buffer_load_dword v27, v14, s[20:23], s44 offen
s_mov_b32 s44, 2555904
s_mul_i32 s59, s3, 2080
s_and_b32 s87, s6, 3
s_lshl_b32 s87, s87, 17
v_bfe_u32 v5, v1, 3, 1
v_lshrrev_b32 v2, 4, v1
v_lshl_add_u32 v5, v2, 3, v5
s_lshl_b32 s62, s3, 1
v_add_u32 v5, s62, v5
v_mul_u32_u24 v5, 2048, v5
v_and_b32 v2, 7, v1
v_lshl_add_u32 v5, v2, 4, v5
s_lshl_b32 s62, s7, 7
v_add_u32 v5, s62, v5
v_add_u32 v6, 64512, v5
s_lshl_b32 s62, s6, 10
s_add_u32 s62, s62, 30474240
s_lshl_b32 s64, s8, 10
s_add_u32 s64, s64, 30474240
s_lshr_b32 s67, s9, 1
s_and_b32 s67, s67, 3
s_lshl_b32 s67, s67, 7
s_add_u32 s64, s64, s67
s_lshr_b32 s65, s50, 3
s_lshl_b32 s65, s65, 10
s_add_u32 s65, s65, 30474240
s_lshr_b32 s67, s9, 1
s_and_b32 s67, s67, 3
s_lshl_b32 s67, s67, 7
s_add_u32 s65, s65, s67
v_lshl_add_u32 v252, v1, 7, s62
v_mov_b32 v253, s64
v_mov_b32 v255, 1
v_writelane_b32 v253, s65, 1
s_waitcnt vmcnt(1) lgkmcnt(0)
s_cmp_lg_u32 s3, 1
s_barrier
s_cbranch_scc1 .Lfirst54
s_mov_b64 exec, 15
buffer_atomic_add v255, v252, s[16:19], 0 offen
s_mov_b64 exec, 3
v_mov_b32 v254, 0
buffer_atomic_add v254, v253, s[16:19], 0 offen sc0
s_mov_b64 exec, -1
.Lfirst54:
s_add_u32 m0, s56, 117248
s_nop 0
buffer_load_dwordx4 v18, s[20:23], s54 offen lds
v_lshrrev_b32 v2, 4, v1
v_lshlrev_b32 v2, 2, v2
v_and_b32 v13, 15, v1
v_sub_u32 v2, v13, v2
v_mov_b32 v13, 0xff61b1e6
v_subrev_u32 v54, 0, v2
v_cmp_gt_u32 vcc, 8, v54
s_nop 1
v_cndmask_b32 v50, v13, 0, vcc
buffer_load_dwordx4 v19, s[20:23], s54 offen offset:1024 lds
v_cmp_gt_i32 vcc, -8, v54
s_nop 1
v_cndmask_b32 v46, v13, 0, vcc
v_subrev_u32 v54, 1, v2
v_cmp_gt_u32 vcc, 8, v54
s_nop 1
v_cndmask_b32 v51, v13, 0, vcc
v_cmp_gt_i32 vcc, -8, v54
s_nop 1
v_cndmask_b32 v47, v13, 0, vcc
v_subrev_u32 v54, 2, v2
buffer_load_dwordx4 v20, s[20:23], s54 offen offset:2048 lds
s_add_u32 s54, s54, 196608
v_cmp_gt_u32 vcc, 8, v54
s_nop 1
v_cndmask_b32 v52, v13, 0, vcc
v_cmp_gt_i32 vcc, -8, v54
s_nop 1
v_cndmask_b32 v48, v13, 0, vcc
v_subrev_u32 v54, 3, v2
v_cmp_gt_u32 vcc, 8, v54
s_nop 1
v_cndmask_b32 v53, v13, 0, vcc
v_cmp_gt_i32 vcc, -8, v54
s_add_u32 m0, s56, 129664
s_nop 0
buffer_load_dwordx4 v18, s[20:23], s54 offen lds
v_cndmask_b32 v49, v13, 0, vcc
s_cmp_lt_u32 s8, 2
s_cselect_b64 vcc, -1, 0
v_cndmask_b32 v54, v46, v13, vcc
v_cndmask_b32 v55, v47, v13, vcc
v_cndmask_b32 v56, v48, v13, vcc
v_cndmask_b32 v57, v49, v13, vcc
v_mov_b64 v[60:61], 0
buffer_load_dwordx4 v19, s[20:23], s54 offen offset:1024 lds
v_mov_b64 v[62:63], 0
v_mov_b64 v[64:65], 0
v_mov_b64 v[66:67], 0
v_mov_b64 v[68:69], 0
v_mov_b64 v[70:71], 0
v_mov_b64 v[72:73], 0
v_mov_b64 v[74:75], 0
v_mov_b64 v[76:77], 0
buffer_load_dwordx4 v20, s[20:23], s54 offen offset:2048 lds
s_add_u32 s54, s54, 196608
v_mov_b64 v[78:79], 0
v_mov_b64 v[80:81], 0
v_mov_b64 v[82:83], 0
v_mov_b64 v[84:85], 0
v_mov_b64 v[86:87], 0
v_mov_b64 v[88:89], 0
v_mov_b64 v[90:91], 0
v_mov_b64 v[92:93], 0
s_add_u32 m0, s56, 67584
s_nop 0
buffer_load_dwordx4 v18, s[20:23], s54 offen lds
v_mov_b64 v[94:95], 0
v_mov_b64 v[96:97], 0
v_mov_b64 v[98:99], 0
v_mov_b64 v[100:101], 0
v_mov_b64 v[102:103], 0
v_mov_b64 v[104:105], 0
v_mov_b64 v[106:107], 0
v_mov_b64 v[108:109], 0
buffer_load_dwordx4 v19, s[20:23], s54 offen offset:1024 lds
v_mov_b64 v[110:111], 0
v_mov_b64 v[112:113], 0
v_mov_b64 v[114:115], 0
v_mov_b64 v[116:117], 0
v_mov_b64 v[118:119], 0
v_mov_b64 v[120:121], 0
v_mov_b64 v[122:123], 0
v_mov_b64 v[124:125], 0
buffer_load_dwordx4 v20, s[20:23], s54 offen offset:2048 lds
s_add_u32 s54, s54, 196608
v_mov_b64 v[126:127], 0
v_mov_b64 v[128:129], 0
v_mov_b64 v[130:131], 0
v_mov_b64 v[132:133], 0
v_mov_b64 v[134:135], 0
v_mov_b64 v[136:137], 0
v_mov_b64 v[138:139], 0
v_mov_b64 v[140:141], 0
s_add_u32 m0, s56, 80000
s_nop 0
buffer_load_dwordx4 v18, s[20:23], s54 offen lds
v_mov_b64 v[142:143], 0
v_mov_b64 v[144:145], 0
v_mov_b64 v[146:147], 0
v_mov_b64 v[148:149], 0
v_mov_b64 v[150:151], 0
v_mov_b64 v[152:153], 0
v_mov_b64 v[154:155], 0
v_mov_b64 v[156:157], 0
buffer_load_dwordx4 v19, s[20:23], s54 offen offset:1024 lds
v_mov_b64 v[158:159], 0
v_mov_b64 v[160:161], 0
v_mov_b64 v[162:163], 0
v_mov_b64 v[164:165], 0
v_mov_b64 v[166:167], 0
v_mov_b64 v[168:169], 0
v_mov_b64 v[170:171], 0
v_mov_b64 v[172:173], 0
buffer_load_dwordx4 v20, s[20:23], s54 offen offset:2048 lds
s_add_u32 s54, s54, 196608
v_mov_b64 v[174:175], 0
s_mov_b32 s75, 62914560
v_and_b32 v10, 15, v1
v_lshlrev_b32 v12, 2, v10
v_lshlrev_b32 v10, 4, v10
v_add_u32 v10, 152576, v10
v_lshrrev_b32 v11, 4, v1
v_lshlrev_b32 v11, 4, v11
s_add_u32 m0, s56, 92416
s_nop 0
buffer_load_dwordx4 v18, s[20:23], s54 offen lds
s_lshl_b32 s62, s49, 7
s_add_u32 s62, s62, 158720
v_add_u32 v12, s62, v12
v_add_u32 v13, s62, v11
v_add_u32 v11, 156672, v11
s_lshl_b32 s62, s3, 11
s_add_u32 s62, s62, 143360
v_lshl_add_u32 v8, v1, 4, s62
buffer_load_dwordx4 v19, s[20:23], s54 offen offset:1024 lds
v_xor_b32 v9, 2048, v8
v_mov_b32 v248, 0x3f803f80
v_mov_b32 v249, 0x3f803f80
v_mov_b32 v250, 0x3f803f80
v_mov_b32 v251, 0x3f803f80
v_and_b32 v7, 31, v1
v_lshrrev_b32 v2, 5, v1
v_lshl_add_u32 v7, v7, 1, v2
buffer_load_dwordx4 v20, s[20:23], s54 offen offset:2048 lds
s_add_u32 s54, s54, 196608
v_and_b32 v2, 0xc0, v0
v_add_u32 v7, v7, v2
v_lshlrev_b32 v17, 2, v7
v_add_u32 v17, 156672, v17
v_lshlrev_b32 v7, 4, v7
v_add_u32 v7, 152576, v7
s_lshl_b32 s74, s9, 1
s_add_u32 s74, s74, s49
s_lshl_b32 s74, s74, 17
s_add_u32 s74, s74, s85
s_lshl_b32 s63, s48, 12
s_add_u32 s74, s74, s63
s_add_u32 s74, s74, 37748736
s_mov_b32 s62, 0
v_lshl_add_u32 v4, v1, 4, s62
v_lshrrev_b32 v2, 3, v1
v_cmp_eq_u32 vcc, 3, v2
v_add_u32 v2, 67108480, v4
s_nop 0
v_cndmask_b32 v4, v4, v2, vcc
s_cmp_lg_u32 s3, 1
s_cbranch_scc1 .Lnopoll53
s_mov_b64 exec, 3
s_mov_b32 s15, 0
v_mov_b32 v255, 0
buffer_atomic_add v255, v253, s[16:19], 0 offen sc0
s_waitcnt vmcnt(16)
v_cmp_gt_u32 vcc, 16, v254
s_nop 0
s_cbranch_vccz .Lnopoll53r
.Lpoll52:
s_waitcnt vmcnt(0)
v_cmp_gt_u32 vcc, 16, v255
s_add_u32 s15, s15, 1
s_cbranch_vccz .Lnopoll53r
v_mov_b32 v255, 0
buffer_atomic_add v255, v253, s[16:19], 0 offen sc0
s_cmp_le_u32 s15, 100000
s_cbranch_scc1 .Lpoll52
s_branch .Lnopoll53r
.Lnopoll53:
s_mov_b64 exec, 0
s_cmp_eq_u32 s3, 2
s_cbranch_scc1 .Lpad22
s_cmp_eq_u32 s3, 3
s_cbranch_scc1 .Lpad23
s_branch .Lpad24
.Lnopoll53r:
s_mov_b64 exec, -1
s_waitcnt vmcnt(9)
s_barrier
s_cmp_eq_u32 s48, 1
s_cbranch_scc1 .Lqkv55
s_add_u32 m0, s55, 36864
s_nop 0
buffer_load_dwordx4 v21, s[16:19], s52 offen sc1 lds
buffer_load_dwordx4 v21, s[16:19], s52 offen offset:1024 sc1 lds
buffer_load_dword v22, s[16:19], s52 offen offset:2048 sc1 lds
s_add_u32 s52, s52, 131072
TR 80,25,49664
TR 82,25,50176
TR 84,25,62080
s_add_u32 m0, s55, 46080
s_nop 0
buffer_load_dwordx4 v21, s[16:19], s52 offen sc1 lds
buffer_load_dwordx4 v21, s[16:19], s52 offen offset:1024 sc1 lds
buffer_load_dword v22, s[16:19], s52 offen offset:2048 sc1 lds
s_add_u32 s52, s52, 131072
TR 86,25,62592
TR 88,25,50688
TR 90,25,51200
s_add_u32 m0, s55, 0
s_nop 0
buffer_load_dwordx4 v21, s[16:19], s52 offen sc1 lds
buffer_load_dwordx4 v21, s[16:19], s52 offen offset:1024 sc1 lds
buffer_load_dword v22, s[16:19], s52 offen offset:2048 sc1 lds
s_add_u32 s52, s52, 131072
TR 92,25,63104
TR 94,25,63616
TR 96,25,51712
s_add_u32 m0, s55, 9216
s_nop 0
buffer_load_dwordx4 v21, s[16:19], s52 offen sc1 lds
buffer_load_dwordx4 v21, s[16:19], s52 offen offset:1024 sc1 lds
buffer_load_dword v22, s[16:19], s52 offen offset:2048 sc1 lds
s_add_u32 s52, s52, 131072
TR 98,25,52224
TR 100,25,64128
TR 102,25,64640
s_add_u32 m0, s55, 18432
s_nop 0
buffer_load_dwordx4 v21, s[16:19], s52 offen sc1 lds
buffer_load_dwordx4 v21, s[16:19], s52 offen offset:1024 sc1 lds
buffer_load_dword v22, s[16:19], s52 offen offset:2048 sc1 lds
s_add_u32 s52, s52, 131072
ds_read_b128 v[28:31], v13
ds_read_b128 v[32:35], v13 offset:64
ds_read_b128 v[36:39], v13 offset:256
s_add_u32 m0, s55, 27648
s_nop 0
buffer_load_dwordx4 v21, s[16:19], s52 offen sc1 lds
buffer_load_dwordx4 v21, s[16:19], s52 offen offset:1024 sc1 lds
buffer_load_dword v22, s[16:19], s52 offen offset:2048 sc1 lds
s_add_u32 s52, s52, 131072
ds_read_b128 v[40:43], v13 offset:320
ds_read_b32 v44, v12 offset:512
ds_read_b32 v45, v12 offset:576
s_waitcnt vmcnt(12)
s_barrier
RD 0,23,36864
RD 4,23,37888
RD 8,23,39168
RD 12,23,40192
RD 16,24,38912
RD 20,23,46080
RD 24,23,47104
RD 28,23,48384
RD 32,23,49408
RD 36,24,48128
s_waitcnt lgkmcnt(0)
s_mov_b32 s15, -2
.p2align 6
.Lk57:
s_waitcnt vmcnt(9) lgkmcnt(8)
s_barrier
MAA 60,80,0
TR 104,25,49696
s_add_u32 m0, s56, 104832
MAA 60,84,20
buffer_load_dwordx4 v18, s[20:23], s54 offen lds
MAA 64,84,24
TR 106,25,50208
v_add_f32 v164, v164, v168
MAA 64,80,4
TR 108,25,62112
MAA 68,80,8
TR 110,25,62624
MAA 68,84,28
buffer_load_dwordx4 v19, s[20:23], s54 offen offset:1024 lds
MAA 72,84,32
TR 112,25,50720
v_add_f32 v165, v165, v169
MAA 72,80,12
TR 114,25,51232
s_waitcnt lgkmcnt(6)
MAA 156,88,16
TR 116,25,63136
MAA 156,92,36
buffer_load_dwordx4 v20, s[20:23], s54 offen offset:2048 lds
MAA 104,92,32
s_add_u32 s54, s54, 196608
s_add_u32 m0, s55, 36864
MAA 104,88,12
buffer_load_dwordx4 v21, s[16:19], s52 offen sc1 lds
MAA 100,88,8
TR 118,25,63648
MAA 100,92,28
TR 120,25,51744
v_add_f32 v166, v166, v170
MAA 96,92,24
TR 122,25,52256
MAA 96,88,4
buffer_load_dwordx4 v21, s[16:19], s52 offen offset:1024 sc1 lds
MAA 92,88,0
TR 124,25,64160
MAA 92,92,20
TR 126,25,64672
v_add_f32 v167, v167, v171
MAA 124,20,100
ds_read_b128 a[40:43], v23
MAA 124,0,96
buffer_load_dword v22, s[16:19], s52 offen offset:2048 sc1 lds
MAA 128,4,96
RD 44,23,1024
s_add_u32 s52, s52, 131072
MAA 128,24,100
buffer_load_dword v27, v14, s[20:23], s44 offen
MAA 132,28,100
RD 48,23,2304
s_add_u32 s44, s44, 1572864
MAA 132,8,96
RD 52,23,3328
MAA 136,12,96
RD 56,24,2048
MAA 136,32,100
s_waitcnt vmcnt(13) lgkmcnt(5)
s_barrier
MAA 76,104,0
RD 60,23,9216
s_add_u32 m0, s56, 117248
MAA 76,108,20
buffer_load_dwordx4 v18, s[20:23], s54 offen lds
MAA 80,108,24
RD 64,23,10240
MAA 80,104,4
RD 68,23,11520
MAA 84,104,8
RD 72,23,12544
MAA 84,108,28
buffer_load_dwordx4 v19, s[20:23], s54 offen offset:1024 lds
MAA 88,108,32
RD 76,24,11264
MAA 88,104,12
buffer_load_dwordx4 v20, s[20:23], s54 offen offset:2048 lds
MAA 160,112,16
ds_read_b64_tr_b16 a[80:81], v25
s_add_u32 s54, s54, 196608
MAA 160,116,36
TR 82,25,512
MAA 120,116,32
TR 84,25,12416
s_add_u32 m0, s55, 46080
MAA 120,112,12
buffer_load_dwordx4 v21, s[16:19], s52 offen sc1 lds
MAA 116,112,8
TR 86,25,12928
MAA 116,116,28
TR 88,25,1024
MAA 112,116,24
TR 90,25,1536
MAA 112,112,4
buffer_load_dwordx4 v21, s[16:19], s52 offen offset:1024 sc1 lds
MAA 108,112,0
TR 92,25,13440
MAA 108,116,20
TR 94,25,13952
MAA 140,20,124
TR 96,25,2048
MAA 140,0,120
buffer_load_dword v22, s[16:19], s52 offen offset:2048 sc1 lds
MAA 144,4,120
TR 98,25,2560
s_add_u32 s52, s52, 131072
MAA 144,24,124
buffer_load_dwordx4 v[168:171], v26, s[16:19], s75 offen sc1
MAA 148,28,124
TR 100,25,14464
MAA 148,8,120
TR 102,25,14976
MAA 152,12,120
MAA 152,32,124
s_waitcnt vmcnt(17) lgkmcnt(8)
s_barrier
MAA 60,80,40
TR 104,25,32
s_add_u32 m0, s56, 129664
MAA 60,84,60
buffer_load_dwordx4 v18, s[20:23], s54 offen lds
MAA 64,84,64
TR 106,25,544
v_add_f32 v164, v164, v172
MAA 64,80,44
TR 108,25,12448
MAA 68,80,48
TR 110,25,12960
MAA 68,84,68
buffer_load_dwordx4 v19, s[20:23], s54 offen offset:1024 lds
MAA 72,84,72
TR 112,25,1056
MAA 72,80,52
TR 114,25,1568
s_waitcnt lgkmcnt(6)
MAA 156,88,56
TR 116,25,13472
v_add_f32 v165, v165, v173
MAA 156,92,76
buffer_load_dwordx4 v20, s[20:23], s54 offen offset:2048 lds
MAA 104,92,72
TR 118,25,13984
s_add_u32 s54, s54, 196608
MAA 104,88,52
TR 120,25,2080
MAA 100,88,48
s_add_u32 m0, s55, 0
MAA 100,92,68
buffer_load_dwordx4 v21, s[16:19], s52 offen sc1 lds
MAA 96,92,64
TR 122,25,2592
v_add_f32 v166, v166, v174
MAA 96,88,44
TR 124,25,14496
MAA 92,88,40
TR 126,25,15008
MAA 92,92,60
buffer_load_dwordx4 v21, s[16:19], s52 offen offset:1024 sc1 lds
MAA 124,60,100
RD 0,23,18432
MAA 124,40,96
RD 4,23,19456
v_add_f32 v167, v167, v175
MAA 128,44,96
RD 8,23,20736
MAA 128,64,100
buffer_load_dword v22, s[16:19], s52 offen offset:2048 sc1 lds
MAA 132,68,100
RD 12,23,21760
s_add_u32 s52, s52, 131072
MAA 132,48,96
RD 16,24,20480
MAA 136,52,96
MAA 136,72,100
s_waitcnt vmcnt(17) lgkmcnt(5)
s_barrier
MAA 76,104,40
RD 20,23,27648
s_add_u32 m0, s56, 67584
MAA 76,108,60
buffer_load_dwordx4 v18, s[20:23], s54 offen lds
MAA 80,108,64
RD 24,23,28672
MAA 80,104,44
RD 28,23,29952
MAA 84,104,48
RD 32,23,30976
MAA 84,108,68
buffer_load_dwordx4 v19, s[20:23], s54 offen offset:1024 lds
MAA 88,108,72
RD 36,24,29696
MAA 88,104,52
buffer_load_dwordx4 v20, s[20:23], s54 offen offset:2048 lds
MAA 160,112,56
TR 80,25,24832
s_add_u32 s54, s54, 196608
MAA 160,116,76
TR 82,25,25344
MAA 120,116,72
TR 84,25,37248
s_add_u32 m0, s55, 9216
MAA 120,112,52
buffer_load_dwordx4 v21, s[16:19], s52 offen sc1 lds
MAA 116,112,48
TR 86,25,37760
MAA 116,116,68
TR 88,25,25856
MAA 112,116,64
TR 90,25,26368
MAA 112,112,44
buffer_load_dwordx4 v21, s[16:19], s52 offen offset:1024 sc1 lds
MAA 108,112,40
TR 92,25,38272
MAA 108,116,60
TR 94,25,38784
MAA 140,60,124
TR 96,25,26880
MAA 140,40,120
buffer_load_dword v22, s[16:19], s52 offen offset:2048 sc1 lds
MAA 144,44,120
TR 98,25,27392
s_add_u32 s52, s52, 131072
MAA 144,64,124
buffer_load_dwordx4 v[172:175], v26, s[16:19], s75 offen offset:1024 sc1
MAA 148,68,124
TR 100,25,39296
s_add_u32 s75, s75, 2048
MAA 148,48,120
TR 102,25,39808
MAA 152,52,120
MAA 152,72,124
s_waitcnt vmcnt(21) lgkmcnt(8)
s_barrier
MAA 60,80,0
TR 104,25,24864
s_add_u32 m0, s56, 80000
MAA 60,84,20
buffer_load_dwordx4 v18, s[20:23], s54 offen lds
MAA 64,84,24
TR 106,25,25376
MAA 64,80,4
TR 108,25,37280
MAA 68,80,8
TR 110,25,37792
MAA 68,84,28
buffer_load_dwordx4 v19, s[20:23], s54 offen offset:1024 lds
MAA 72,84,32
TR 112,25,25888
MAA 72,80,12
TR 114,25,26400
s_waitcnt lgkmcnt(6)
MAA 156,88,16
TR 116,25,38304
MAA 156,92,36
buffer_load_dwordx4 v20, s[20:23], s54 offen offset:2048 lds
MAA 104,92,32
TR 118,25,38816
s_add_u32 s54, s54, 196608
MAA 104,88,12
TR 120,25,26912
MAA 100,88,8
s_add_u32 m0, s55, 18432
MAA 100,92,28
.Lpad22:
s_cbranch_execz .Lpad25
buffer_load_dwordx4 v21, s[16:19], s52 offen sc1 lds
MAA 96,92,24
TR 122,25,27424
MAA 96,88,4
TR 124,25,39328
MAA 92,88,0
TR 126,25,39840
MAA 92,92,20
buffer_load_dwordx4 v21, s[16:19], s52 offen offset:1024 sc1 lds
MAA 124,20,100
RD 40,23,36864
MAA 124,0,96
RD 44,23,37888
MAA 128,4,96
RD 48,23,39168
MAA 128,24,100
buffer_load_dword v22, s[16:19], s52 offen offset:2048 sc1 lds
MAA 132,28,100
RD 52,23,40192
s_add_u32 s52, s52, 131072
MAA 132,8,96
RD 56,24,38912
MAA 136,12,96
MAA 136,32,100
s_waitcnt vmcnt(16) lgkmcnt(5)
s_barrier
MAA 76,104,0
RD 60,23,46080
s_add_u32 m0, s56, 92416
MAA 76,108,20
buffer_load_dwordx4 v18, s[20:23], s54 offen lds
MAA 80,108,24
RD 64,23,47104
MAA 80,104,4
RD 68,23,48384
MAA 84,104,8
RD 72,23,49408
MAA 84,108,28
buffer_load_dwordx4 v19, s[20:23], s54 offen offset:1024 lds
MAA 88,108,32
RD 76,24,48128
MAA 88,104,12
TR 80,25,49664
MAA 160,112,16
TR 82,25,50176
MAA 160,116,36
buffer_load_dwordx4 v20, s[20:23], s54 offen offset:2048 lds
MAA 120,116,32
TR 84,25,62080
s_add_u32 s54, s54, 196608
MAA 120,112,12
TR 86,25,62592
MAA 116,112,8
s_add_u32 m0, s55, 27648
MAA 116,116,28
buffer_load_dwordx4 v21, s[16:19], s52 offen sc1 lds
MAA 112,116,24
TR 88,25,50688
MAA 112,112,4
TR 90,25,51200
MAA 108,112,0
TR 92,25,63104
MAA 108,116,20
buffer_load_dwordx4 v21, s[16:19], s52 offen offset:1024 sc1 lds
MAA 140,20,124
TR 94,25,63616
MAA 140,0,120
TR 96,25,51712
MAA 144,4,120
TR 98,25,52224
MAA 144,24,124
buffer_load_dword v22, s[16:19], s52 offen offset:2048 sc1 lds
MAA 148,28,124
TR 100,25,64128
s_add_u32 s52, s52, 131072
MAA 148,8,120
TR 102,25,64640
MAA 152,12,120
MAA 152,32,124
s_waitcnt vmcnt(19) lgkmcnt(8)
s_barrier
MAA 60,80,40
TR 104,25,49696
s_add_u32 m0, s56, 104832
MAA 60,84,60
buffer_load_dwordx4 v18, s[20:23], s54 offen lds
MAA 64,84,64
TR 106,25,50208
v_add_f32 v164, v164, v168
MAA 64,80,44
TR 108,25,62112
MAA 68,80,48
TR 110,25,62624
MAA 68,84,68
buffer_load_dwordx4 v19, s[20:23], s54 offen offset:1024 lds
MAA 72,84,72
TR 112,25,50720
v_add_f32 v165, v165, v169
MAA 72,80,52
TR 114,25,51232
s_waitcnt lgkmcnt(6)
MAA 156,88,56
TR 116,25,63136
MAA 156,92,76
buffer_load_dwordx4 v20, s[20:23], s54 offen offset:2048 lds
MAA 104,92,72
s_add_u32 s54, s54, 196608
s_add_u32 m0, s55, 36864
MAA 104,88,52
buffer_load_dwordx4 v21, s[16:19], s52 offen sc1 lds
MAA 100,88,48
TR 118,25,63648
MAA 100,92,68
TR 120,25,51744
v_add_f32 v166, v166, v170
MAA 96,92,64
TR 122,25,52256
MAA 96,88,44
buffer_load_dwordx4 v21, s[16:19], s52 offen offset:1024 sc1 lds
MAA 92,88,40
TR 124,25,64160
MAA 92,92,60
TR 126,25,64672
v_add_f32 v167, v167, v171
MAA 124,60,100
ds_read_b128 a[0:3], v23
MAA 124,40,96
buffer_load_dword v22, s[16:19], s52 offen offset:2048 sc1 lds
MAA 128,44,96
RD 4,23,1024
s_add_u32 s52, s52, 131072
MAA 128,64,100
buffer_load_dword v27, v14, s[20:23], s44 offen
MAA 132,68,100
RD 8,23,2304
s_add_u32 s44, s44, 1572864
MAA 132,48,96
RD 12,23,3328
MAA 136,52,96
RD 16,24,2048
MAA 136,72,100
s_waitcnt vmcnt(16) lgkmcnt(5)
s_barrier
MAA 76,104,40
RD 20,23,9216
s_add_u32 m0, s56, 117248
MAA 76,108,60
buffer_load_dwordx4 v18, s[20:23], s54 offen lds
MAA 80,108,64
RD 24,23,10240
MAA 80,104,44
RD 28,23,11520
MAA 84,104,48
RD 32,23,12544
MAA 84,108,68
buffer_load_dwordx4 v19, s[20:23], s54 offen offset:1024 lds
MAA 88,108,72
RD 36,24,11264
MAA 88,104,52
buffer_load_dwordx4 v20, s[20:23], s54 offen offset:2048 lds
MAA 160,112,56
ds_read_b64_tr_b16 a[80:81], v25
s_add_u32 s54, s54, 196608
MAA 160,116,76
TR 82,25,512
MAA 120,116,72
TR 84,25,12416
s_add_u32 m0, s55, 46080
MAA 120,112,52
buffer_load_dwordx4 v21, s[16:19], s52 offen sc1 lds
MAA 116,112,48
TR 86,25,12928
MAA 116,116,68
TR 88,25,1024
MAA 112,116,64
TR 90,25,1536
MAA 112,112,44
buffer_load_dwordx4 v21, s[16:19], s52 offen offset:1024 sc1 lds
MAA 108,112,40
TR 92,25,13440
MAA 108,116,60
TR 94,25,13952
MAA 140,60,124
TR 96,25,2048
MAA 140,40,120
buffer_load_dword v22, s[16:19], s52 offen offset:2048 sc1 lds
MAA 144,44,120
TR 98,25,2560
s_add_u32 s52, s52, 131072
MAA 144,64,124
buffer_load_dwordx4 v[168:171], v26, s[16:19], s75 offen sc1
MAA 148,68,124
TR 100,25,14464
MAA 148,48,120
TR 102,25,14976
MAA 152,52,120
MAA 152,72,124
s_waitcnt vmcnt(20) lgkmcnt(8)
s_barrier
MAA 60,80,0
TR 104,25,32
s_add_u32 m0, s56, 129664
MAA 60,84,20
buffer_load_dwordx4 v18, s[20:23], s54 offen lds
MAA 64,84,24
TR 106,25,544
v_add_f32 v164, v164, v172
MAA 64,80,4
TR 108,25,12448
MAA 68,80,8
TR 110,25,12960
MAA 68,84,28
buffer_load_dwordx4 v19, s[20:23], s54 offen offset:1024 lds
MAA 72,84,32
TR 112,25,1056
MAA 72,80,12
TR 114,25,1568
s_waitcnt lgkmcnt(6)
MAA 156,88,16
TR 116,25,13472
v_add_f32 v165, v165, v173
MAA 156,92,36
buffer_load_dwordx4 v20, s[20:23], s54 offen offset:2048 lds
MAA 104,92,32
TR 118,25,13984
s_add_u32 s54, s54, 196608
MAA 104,88,12
TR 120,25,2080
MAA 100,88,8
s_add_u32 m0, s55, 0
MAA 100,92,28
buffer_load_dwordx4 v21, s[16:19], s52 offen sc1 lds
MAA 96,92,24
TR 122,25,2592
v_add_f32 v166, v166, v174
MAA 96,88,4
TR 124,25,14496
MAA 92,88,0
TR 126,25,15008
MAA 92,92,20
buffer_load_dwordx4 v21, s[16:19], s52 offen offset:1024 sc1 lds
MAA 124,20,100
RD 40,23,18432
MAA 124,0,96
RD 44,23,19456
v_add_f32 v167, v167, v175
MAA 128,4,96
RD 48,23,20736
MAA 128,24,100
buffer_load_dword v22, s[16:19], s52 offen offset:2048 sc1 lds
MAA 132,28,100
RD 52,23,21760
s_add_u32 s52, s52, 131072
MAA 132,8,96
RD 56,24,20480
MAA 136,12,96
MAA 136,32,100
s_waitcnt vmcnt(17) lgkmcnt(5)
s_barrier
MAA 76,104,0
RD 60,23,27648
s_add_u32 m0, s56, 67584
MAA 76,108,20
buffer_load_dwordx4 v18, s[20:23], s54 offen lds
MAA 80,108,24
RD 64,23,28672
MAA 80,104,4
RD 68,23,29952
MAA 84,104,8
RD 72,23,30976
MAA 84,108,28
buffer_load_dwordx4 v19, s[20:23], s54 offen offset:1024 lds
MAA 88,108,32
RD 76,24,29696
MAA 88,104,12
buffer_load_dwordx4 v20, s[20:23], s54 offen offset:2048 lds
MAA 160,112,16
TR 80,25,24832
s_add_u32 s54, s54, 196608
MAA 160,116,36
TR 82,25,25344
MAA 120,116,32
TR 84,25,37248
s_add_u32 m0, s55, 9216
MAA 120,112,12
buffer_load_dwordx4 v21, s[16:19], s52 offen sc1 lds
MAA 116,112,8
TR 86,25,37760
MAA 116,116,28
TR 88,25,25856
MAA 112,116,24
TR 90,25,26368
MAA 112,112,4
buffer_load_dwordx4 v21, s[16:19], s52 offen offset:1024 sc1 lds
MAA 108,112,0
TR 92,25,38272
MAA 108,116,20
TR 94,25,38784
MAA 140,20,124
TR 96,25,26880
MAA 140,0,120
buffer_load_dword v22, s[16:19], s52 offen offset:2048 sc1 lds
MAA 144,4,120
TR 98,25,27392
s_add_u32 s52, s52, 131072
MAA 144,24,124
buffer_load_dwordx4 v[172:175], v26, s[16:19], s75 offen offset:1024 sc1
MAA 148,28,124
TR 100,25,39296
s_add_u32 s75, s75, 2048
MAA 148,8,120
TR 102,25,39808
MAA 152,12,120
MAA 152,32,124
s_waitcnt vmcnt(21) lgkmcnt(8)
s_barrier
MAA 60,80,40
TR 104,25,24864
s_add_u32 m0, s56, 80000
MAA 60,84,60
buffer_load_dwordx4 v18, s[20:23], s54 offen lds
MAA 64,84,64
TR 106,25,25376
MAA 64,80,44
TR 108,25,37280
MAA 68,80,48
TR 110,25,37792
MAA 68,84,68
buffer_load_dwordx4 v19, s[20:23], s54 offen offset:1024 lds
MAA 72,84,72
TR 112,25,25888
MAA 72,80,52
TR 114,25,26400
s_waitcnt lgkmcnt(6)
MAA 156,88,56
TR 116,25,38304
MAA 156,92,76
buffer_load_dwordx4 v20, s[20:23], s54 offen offset:2048 lds
MAA 104,92,72
TR 118,25,38816
s_add_u32 s54, s54, 196608
MAA 104,88,52
TR 120,25,26912
MAA 100,88,48
s_add_u32 m0, s55, 18432
MAA 100,92,68
buffer_load_dwordx4 v21, s[16:19], s52 offen sc1 lds
MAA 96,92,64
TR 122,25,27424
MAA 96,88,44
TR 124,25,39328
MAA 92,88,40
TR 126,25,39840
MAA 92,92,60
buffer_load_dwordx4 v21, s[16:19], s52 offen offset:1024 sc1 lds
MAA 124,60,100
RD 0,23,36864
MAA 124,40,96
RD 4,23,37888
MAA 128,44,96
RD 8,23,39168
MAA 128,64,100
buffer_load_dword v22, s[16:19], s52 offen offset:2048 sc1 lds
MAA 132,68,100
RD 12,23,40192
s_add_u32 s52, s52, 131072
MAA 132,48,96
RD 16,24,38912
MAA 136,52,96
MAA 136,72,100
s_waitcnt vmcnt(16) lgkmcnt(5)
s_barrier
MAA 76,104,40
RD 20,23,46080
s_add_u32 m0, s56, 92416
MAA 76,108,60
buffer_load_dwordx4 v18, s[20:23], s54 offen lds
MAA 80,108,64
RD 24,23,47104
MAA 80,104,44
RD 28,23,48384
MAA 84,104,48
RD 32,23,49408
MAA 84,108,68
buffer_load_dwordx4 v19, s[20:23], s54 offen offset:1024 lds
MAA 88,108,72
RD 36,24,48128
MAA 88,104,52
TR 80,25,49664
MAA 160,112,56
TR 82,25,50176
MAA 160,116,76
buffer_load_dwordx4 v20, s[20:23], s54 offen offset:2048 lds
MAA 120,116,72
TR 84,25,62080
s_add_u32 s54, s54, 196608
MAA 120,112,52
TR 86,25,62592
MAA 116,112,48
s_add_u32 m0, s55, 27648
MAA 116,116,68
buffer_load_dwordx4 v21, s[16:19], s52 offen sc1 lds
MAA 112,116,64
TR 88,25,50688
MAA 112,112,44
TR 90,25,51200
MAA 108,112,40
TR 92,25,63104
MAA 108,116,60
buffer_load_dwordx4 v21, s[16:19], s52 offen offset:1024 sc1 lds
MAA 140,60,124
TR 94,25,63616
MAA 140,40,120
TR 96,25,51712
MAA 144,44,120
TR 98,25,52224
MAA 144,64,124
buffer_load_dword v22, s[16:19], s52 offen offset:2048 sc1 lds
MAA 148,68,124
TR 100,25,64128
s_add_u32 s52, s52, 131072
MAA 148,48,120
TR 102,25,64640
MAA 152,52,120
s_add_u32 s15, s15, 1
MAA 152,72,124
s_cbranch_scc0 .Lk57
s_waitcnt vmcnt(19) lgkmcnt(8)
s_barrier
MAA 60,80,0
TR 104,25,49696
s_add_u32 m0, s56, 104832
MAA 60,84,20
buffer_load_dwordx4 v18, s[20:23], s54 offen lds
MAA 64,84,24
TR 106,25,50208
v_add_f32 v164, v164, v168
MAA 64,80,4
TR 108,25,62112
v_add_f32 v165, v165, v169
MAA 68,80,8
TR 110,25,62624
v_add_f32 v166, v166, v170
MAA 68,84,28
buffer_load_dwordx4 v19, s[20:23], s54 offen offset:1024 lds
MAA 72,84,32
TR 112,25,50720
v_add_f32 v167, v167, v171
MAA 72,80,12
TR 114,25,51232
s_waitcnt lgkmcnt(6)
MAA 156,88,16
TR 116,25,63136
MAA 156,92,36
buffer_load_dwordx4 v20, s[20:23], s54 offen offset:2048 lds
MAA 104,92,32
TR 118,25,63648
s_add_u32 s54, s54, 196608
MAA 104,88,12
TR 120,25,51744
s_add_u32 m0, s55, 36864
MAA 100,88,8
TR 122,25,52256
MAA 100,92,28
buffer_load_dwordx4 v21, s[16:19], s52 offen sc1 lds
MAA 96,92,24
TR 124,25,64160
MAA 96,88,4
TR 126,25,64672
MAA 92,88,0
ds_read_b128 a[40:43], v23
MAA 92,92,20
buffer_load_dwordx4 v21, s[16:19], s52 offen offset:1024 sc1 lds
MAA 124,20,100
RD 44,23,1024
MAA 124,0,96
RD 48,23,2304
MAA 128,4,96
RD 52,23,3328
MAA 128,24,100
buffer_load_dword v22, s[16:19], s52 offen offset:2048 sc1 lds
MAA 132,28,100
RD 56,24,2048
s_add_u32 s52, s52, 131072
MAA 132,8,96
MAA 136,12,96
MAA 136,32,100
s_waitcnt vmcnt(15) lgkmcnt(5)
s_barrier
MAA 76,104,0
RD 60,23,9216
s_add_u32 m0, s56, 117248
MAA 76,108,20
buffer_load_dwordx4 v18, s[20:23], s54 offen lds
MAA 80,108,24
RD 64,23,10240
v_add_f32 v164, v164, v172
MAA 80,104,4
RD 68,23,11520
v_add_f32 v165, v165, v173
MAA 84,104,8
RD 72,23,12544
v_add_f32 v166, v166, v174
MAA 84,108,28
buffer_load_dwordx4 v19, s[20:23], s54 offen offset:1024 lds
MAA 88,108,32
RD 76,24,11264
v_add_f32 v167, v167, v175
MAA 88,104,12
ds_read_b64_tr_b16 a[80:81], v25
MAA 160,112,16
TR 82,25,512
MAA 160,116,36
buffer_load_dwordx4 v20, s[20:23], s54 offen offset:2048 lds
MAA 120,116,32
TR 84,25,12416
s_add_u32 s54, s54, 196608
MAA 120,112,12
TR 86,25,12928
s_add_u32 m0, s55, 46080
MAA 116,112,8
TR 88,25,1024
MAA 116,116,28
buffer_load_dwordx4 v21, s[16:19], s52 offen sc1 lds
MAA 112,116,24
TR 90,25,1536
MAA 112,112,4
TR 92,25,13440
MAA 108,112,0
TR 94,25,13952
MAA 108,116,20
buffer_load_dwordx4 v21, s[16:19], s52 offen offset:1024 sc1 lds
.Lpad23:
s_cbranch_execz .Lpad26
MAA 140,20,124
TR 96,25,2048
MAA 140,0,120
TR 98,25,2560
MAA 144,4,120
TR 100,25,14464
MAA 144,24,124
buffer_load_dword v22, s[16:19], s52 offen offset:2048 sc1 lds
MAA 148,28,124
TR 102,25,14976
s_add_u32 s52, s52, 131072
MAA 148,8,120
v_permlane32_swap_b32 v164, v166
MAA 152,12,120
v_permlane32_swap_b32 v165, v167
MAA 152,32,124
s_waitcnt vmcnt(18) lgkmcnt(8)
s_barrier
MAA 60,80,40
TR 104,25,32
s_add_u32 m0, s56, 129664
MAA 60,84,60
buffer_load_dwordx4 v18, s[20:23], s54 offen lds
MAA 64,84,64
TR 106,25,544
v_add_f32 v164, v164, v166
MAA 64,80,44
TR 108,25,12448
v_add_f32 v165, v165, v167
MAA 68,80,48
buffer_load_dwordx4 v19, s[20:23], s54 offen offset:1024 lds
MAA 68,84,68
TR 110,25,12960
v_mul_f32 v164, 0xba800000, v164
MAA 72,84,72
TR 112,25,1056
v_mul_f32 v165, 0x3a800000, v165
MAA 72,80,52
buffer_load_dwordx4 v20, s[20:23], s54 offen offset:2048 lds
s_waitcnt lgkmcnt(5)
MAA 156,88,56
TR 114,25,1568
s_add_u32 s54, s54, 196608
MAA 156,92,76
TR 116,25,13472
s_add_u32 m0, s59, 58240
MAA 104,92,72
TR 118,25,13984
s_xor_b32 s58, s87, 1966080
MAA 104,88,52
buffer_load_dwordx4 v5, s[24:27], s58 offen lds
MAA 100,88,48
TR 120,25,2080
v_fma_f32 v165, -v164, v164, v165
MAA 100,92,68
TR 122,25,2592
v_max_f32 v165, 0, v165
MAA 96,92,64
buffer_load_dwordx4 v6, s[24:27], s58 offen offset:1024 lds
MAA 96,88,44
TR 124,25,14496
s_add_u32 m0, s59, 0
MAA 92,88,40
TR 126,25,15008
s_xor_b32 s58, s87, 1048576
MAA 92,92,60
buffer_load_dwordx4 v5, s[24:27], s58 offen lds
MAA 124,60,100
RD 0,23,18432
v_add_f32 v165, 0x3727c5ac, v165
MAA 124,40,96
RD 4,23,19456
MAA 128,44,96
buffer_load_dwordx4 v6, s[24:27], s58 offen offset:1024 lds
MAA 128,64,100
RD 8,23,20736
MAA 132,68,100
RD 12,23,21760
MAA 132,48,96
RD 16,24,20480
MAA 136,52,96
v_rsq_f32 v166, v165
MAA 136,72,100
v_mov_b32 v165, v166
v_mul_f32 v166, 0x3e8293ee, v166
ds_write_b128 v7, v[164:167]
s_waitcnt vmcnt(16) lgkmcnt(6)
s_barrier
MAA 76,104,40
ds_write_b32 v17, v164
s_add_u32 m0, s59, 8320
MAA 76,108,60
ds_write_b32 v17, v165 offset:1024
s_xor_b32 s58, s87, 1179648
MAA 80,108,64
buffer_load_dwordx4 v5, s[24:27], s58 offen lds
MAA 80,104,44
RD 20,23,27648
MAA 84,104,48
RD 24,23,28672
MAA 84,108,68
RD 28,23,29952
MAA 88,108,72
buffer_load_dwordx4 v6, s[24:27], s58 offen offset:1024 lds
MAA 88,104,52
RD 32,23,30976
s_add_u32 m0, s59, 66560
MAA 160,112,56
RD 36,24,29696
s_xor_b32 s58, s87, 0
MAA 160,116,76
TR 80,25,24832
MAA 120,116,72
buffer_load_dwordx4 v5, s[24:27], s58 offen lds
MAA 120,112,52
TR 82,25,25344
MAA 116,112,48
TR 84,25,37248
MAA 116,116,68
TR 86,25,37760
MAA 112,116,64
buffer_load_dwordx4 v6, s[24:27], s58 offen offset:1024 lds
MAA 112,112,44
TR 88,25,25856
s_add_u32 m0, s59, 74880
MAA 108,112,40
TR 90,25,26368
s_xor_b32 s58, s87, 131072
MAA 108,116,60
TR 92,25,38272
MAA 140,60,124
buffer_load_dwordx4 v5, s[24:27], s58 offen lds
MAA 140,40,120
TR 94,25,38784
MAA 144,44,120
TR 96,25,26880
MAA 144,64,124
TR 98,25,27392
MAA 148,68,124
buffer_load_dwordx4 v6, s[24:27], s58 offen offset:1024 lds
MAA 148,48,120
TR 100,25,39296
MAA 152,52,120
TR 102,25,39808
MAA 152,72,124
s_waitcnt vmcnt(10) lgkmcnt(0)
s_barrier
MAA 156,88,16
TR 112,25,25888
s_add_u32 m0, s59, 83200
MAA 156,92,36
TR 114,25,26400
s_xor_b32 s58, s87, 262144
MAA 104,92,32
buffer_load_dwordx4 v5, s[24:27], s58 offen lds
MAA 104,88,12
TR 116,25,38304
MAA 100,88,8
TR 118,25,38816
MAA 100,92,28
TR 120,25,26912
MAA 96,92,24
buffer_load_dwordx4 v6, s[24:27], s58 offen offset:1024 lds
MAA 96,88,4
TR 122,25,27424
s_add_u32 m0, s59, 16640
MAA 92,88,0
TR 124,25,39328
s_xor_b32 s58, s87, 1310720
MAA 92,92,20
TR 126,25,39840
MAA 136,32,100
buffer_load_dwordx4 v5, s[24:27], s58 offen lds
MAA 136,12,96
TR 104,25,24864
MAA 72,80,12
TR 106,25,25376
MAA 72,84,32
TR 108,25,37280
MAA 68,84,28
buffer_load_dwordx4 v6, s[24:27], s58 offen offset:1024 lds
MAA 68,80,8
TR 110,25,37792
s_add_u32 m0, s59, 24960
MAA 64,80,4
RD 40,23,36864
s_xor_b32 s58, s87, 1441792
MAA 64,84,24
RD 44,23,37888
MAA 60,84,20
buffer_load_dwordx4 v5, s[24:27], s58 offen lds
MAA 60,80,0
RD 48,23,39168
s_waitcnt lgkmcnt(13)
MAA 160,112,16
RD 52,23,40192
s_waitcnt lgkmcnt(12)
MAA 160,116,36
RD 56,24,38912
MAA 120,116,32
buffer_load_dwordx4 v6, s[24:27], s58 offen offset:1024 lds
MAA 120,112,12
s_waitcnt lgkmcnt(5)
s_barrier
RD 60,23,46080
MAA 116,112,8
RD 64,23,47104
s_add_u32 m0, s59, 91520
MAA 116,116,28
RD 68,23,48384
s_xor_b32 s58, s87, 393216
MAA 112,116,24
RD 72,23,49408
MAA 112,112,4
RD 76,24,48128
MAA 108,112,0
TR 144,25,50688
MAA 108,116,20
TR 146,25,51200
MAA 152,32,124
TR 148,25,63104
MAA 152,12,120
TR 150,25,63616
MAA 88,104,12
TR 152,25,50720
MAA 88,108,32
TR 154,25,51232
MAA 84,108,28
TR 156,25,63136
MAA 84,104,8
TR 158,25,63648
MAA 80,104,4
TR 160,25,51712
MAA 80,108,24
TR 162,25,52224
MAA 76,108,20
TR 164,25,64128
MAA 76,104,0
TR 166,25,64640
s_waitcnt lgkmcnt(10)
MAA 156,144,56
TR 168,25,51744
s_waitcnt lgkmcnt(9)
MAA 156,148,76
TR 170,25,52256
MAA 104,148,72
TR 172,25,64160
MAA 104,144,52
TR 174,25,64672
MAA 100,144,48
TR 128,25,49664
MAA 100,148,68
TR 130,25,50176
MAA 96,148,64
TR 132,25,62080
MAA 96,144,44
TR 134,25,62592
MAA 92,144,40
TR 136,25,49696
MAA 92,148,60
TR 138,25,50208
s_waitcnt lgkmcnt(14)
MAA 160,156,76
TR 140,25,62112
MAA 160,152,56
TR 142,25,62624
MAA 120,152,52
ds_read_b128 v[232:235], v10 offset:768
MAA 120,156,72
ds_read_b128 v[236:239], v10 offset:2816
MAA 116,156,68
ds_read_b128 v[228:231], v10 offset:512
MAA 116,152,48
ds_read_b128 v[224:227], v10 offset:256
MAA 112,152,44
ds_read_b128 v[220:223], v10
MAA 112,156,64
buffer_load_dwordx4 v5, s[24:27], s58 offen lds
MAA 108,156,60
ds_read_b128 v[240:243], v11 offset:192
MAA 108,152,40
ds_read_b128 v[244:247], v11 offset:1216
s_waitcnt lgkmcnt(15)
MAA 136,52,160
ds_read_b128 v[18:21], v11 offset:128
MAA 136,72,164
buffer_load_dwordx4 v6, s[24:27], s58 offen offset:1024 lds
MAA 152,72,172
ds_read_b128 v[22:25], v11 offset:1152
s_add_u32 m0, s59, 99840
MAA 152,52,168
s_xor_b32 s58, s87, 524288
s_waitcnt lgkmcnt(15)
MAA 72,128,52
s_waitcnt lgkmcnt(13)
MAA 72,132,72
buffer_load_dwordx4 v5, s[24:27], s58 offen lds
MAA 68,132,68
MAA 68,128,48
MAA 64,128,44
MAA 64,132,64
buffer_load_dwordx4 v6, s[24:27], s58 offen offset:1024 lds
MAA 60,132,60
s_add_u32 m0, s59, 108160
s_xor_b32 s58, s87, 655360
MAA 60,128,40
s_waitcnt lgkmcnt(11)
MAA 88,136,52
s_waitcnt lgkmcnt(9)
MAA 88,140,72
buffer_load_dwordx4 v5, s[24:27], s58 offen lds
MAA 84,140,68
MAA 84,136,48
MAA 80,136,44
MAA 80,140,64
buffer_load_dwordx4 v6, s[24:27], s58 offen offset:1024 lds
MAA 76,140,60
MAA 76,136,40
s_waitcnt lgkmcnt(8)
v_pk_fma_f32 v[104:105], v[36:37], v[232:233], v[104:105] op_sel_hi:[1,0,1]
v_pk_mul_f32 v[104:105], v[104:105], v[232:233] op_sel:[0,1] op_sel_hi:[1,1]
v_cvt_pk_bf16_f32 v196, v104, v105
v_pk_fma_f32 v[106:107], v[38:39], v[232:233], v[106:107] op_sel_hi:[1,0,1]
v_pk_mul_f32 v[106:107], v[106:107], v[232:233] op_sel:[0,1] op_sel_hi:[1,1]
v_cvt_pk_bf16_f32 v197, v106, v107
v_pk_fma_f32 v[120:121], v[40:41], v[232:233], v[120:121] op_sel_hi:[1,0,1]
v_pk_mul_f32 v[120:121], v[120:121], v[232:233] op_sel:[0,1] op_sel_hi:[1,1]
v_cvt_pk_bf16_f32 v198, v120, v121
v_pk_fma_f32 v[122:123], v[42:43], v[232:233], v[122:123] op_sel_hi:[1,0,1]
v_pk_mul_f32 v[122:123], v[122:123], v[232:233] op_sel:[0,1] op_sel_hi:[1,1]
v_cvt_pk_bf16_f32 v199, v122, v123
s_waitcnt lgkmcnt(3)
v_pk_fma_f32 v[136:137], v[240:241], v[44:45], v[136:137] op_sel_hi:[1,0,1]
s_waitcnt lgkmcnt(2)
v_pk_mul_f32 v[136:137], v[136:137], v[244:245]
v_cvt_pk_bf16_f32 v208, v136, v137
v_pk_fma_f32 v[138:139], v[242:243], v[44:45], v[138:139] op_sel_hi:[1,0,1]
v_pk_mul_f32 v[138:139], v[138:139], v[246:247]
v_cvt_pk_bf16_f32 v209, v138, v139
v_pk_fma_f32 v[152:153], v[240:241], v[44:45], v[152:153] op_sel:[0,1,0] op_sel_hi:[1,1,1]
v_pk_mul_f32 v[152:153], v[152:153], v[244:245]
v_cvt_pk_bf16_f32 v218, v152, v153
v_pk_fma_f32 v[154:155], v[242:243], v[44:45], v[154:155] op_sel:[0,1,0] op_sel_hi:[1,1,1]
v_pk_mul_f32 v[154:155], v[154:155], v[246:247]
v_cvt_pk_bf16_f32 v219, v154, v155
ds_write_b128 v8, v[196:199]
ds_write_b64 v8, v[208:209] offset:1024
ds_write_b64 v8, v[218:219] offset:1032
v_pk_fma_f32 v[156:157], v[36:37], v[236:237], v[156:157] op_sel_hi:[1,0,1]
v_pk_mul_f32 v[156:157], v[156:157], v[236:237] op_sel:[0,1] op_sel_hi:[1,1]
v_cvt_pk_bf16_f32 v180, v156, v157
v_pk_fma_f32 v[158:159], v[38:39], v[236:237], v[158:159] op_sel_hi:[1,0,1]
v_pk_mul_f32 v[158:159], v[158:159], v[236:237] op_sel:[0,1] op_sel_hi:[1,1]
v_cvt_pk_bf16_f32 v181, v158, v159
v_pk_fma_f32 v[160:161], v[40:41], v[236:237], v[160:161] op_sel_hi:[1,0,1]
v_pk_mul_f32 v[160:161], v[160:161], v[236:237] op_sel:[0,1] op_sel_hi:[1,1]
v_cvt_pk_bf16_f32 v182, v160, v161
v_pk_fma_f32 v[162:163], v[42:43], v[236:237], v[162:163] op_sel_hi:[1,0,1]
v_pk_mul_f32 v[162:163], v[162:163], v[236:237] op_sel:[0,1] op_sel_hi:[1,1]
v_cvt_pk_bf16_f32 v183, v162, v163
v_pk_fma_f32 v[100:101], v[36:37], v[228:229], v[100:101] op_sel_hi:[1,0,1]
v_pk_mul_f32 v[100:101], v[100:101], v[228:229] op_sel:[0,1] op_sel_hi:[1,1]
v_cvt_pk_bf16_f32 v192, v100, v101
v_pk_fma_f32 v[102:103], v[38:39], v[228:229], v[102:103] op_sel_hi:[1,0,1]
v_pk_mul_f32 v[102:103], v[102:103], v[228:229] op_sel:[0,1] op_sel_hi:[1,1]
v_cvt_pk_bf16_f32 v193, v102, v103
v_pk_fma_f32 v[116:117], v[40:41], v[228:229], v[116:117] op_sel_hi:[1,0,1]
v_pk_mul_f32 v[116:117], v[116:117], v[228:229] op_sel:[0,1] op_sel_hi:[1,1]
v_cvt_pk_bf16_f32 v194, v116, v117
v_pk_fma_f32 v[118:119], v[42:43], v[228:229], v[118:119] op_sel_hi:[1,0,1]
v_pk_mul_f32 v[118:119], v[118:119], v[228:229] op_sel:[0,1] op_sel_hi:[1,1]
s_waitcnt lgkmcnt(0)
s_barrier
v_cvt_pk_bf16_f32 v195, v118, v119
v_pk_fma_f32 v[96:97], v[36:37], v[224:225], v[96:97] op_sel_hi:[1,0,1]
v_pk_mul_f32 v[96:97], v[96:97], v[224:225] op_sel:[0,1] op_sel_hi:[1,1]
v_cvt_pk_bf16_f32 v188, v96, v97
v_pk_fma_f32 v[98:99], v[38:39], v[224:225], v[98:99] op_sel_hi:[1,0,1]
v_pk_mul_f32 v[98:99], v[98:99], v[224:225] op_sel:[0,1] op_sel_hi:[1,1]
v_cvt_pk_bf16_f32 v189, v98, v99
v_pk_fma_f32 v[112:113], v[40:41], v[224:225], v[112:113] op_sel_hi:[1,0,1]
v_pk_mul_f32 v[112:113], v[112:113], v[224:225] op_sel:[0,1] op_sel_hi:[1,1]
v_cvt_pk_bf16_f32 v190, v112, v113
v_pk_fma_f32 v[114:115], v[42:43], v[224:225], v[114:115] op_sel_hi:[1,0,1]
v_pk_mul_f32 v[114:115], v[114:115], v[224:225] op_sel:[0,1] op_sel_hi:[1,1]
v_cvt_pk_bf16_f32 v191, v114, v115
v_pk_fma_f32 v[92:93], v[36:37], v[220:221], v[92:93] op_sel_hi:[1,0,1]
v_pk_mul_f32 v[92:93], v[92:93], v[220:221] op_sel:[0,1] op_sel_hi:[1,1]
v_cvt_pk_bf16_f32 v184, v92, v93
v_pk_fma_f32 v[94:95], v[38:39], v[220:221], v[94:95] op_sel_hi:[1,0,1]
v_pk_mul_f32 v[94:95], v[94:95], v[220:221] op_sel:[0,1] op_sel_hi:[1,1]
v_cvt_pk_bf16_f32 v185, v94, v95
v_pk_fma_f32 v[108:109], v[40:41], v[220:221], v[108:109] op_sel_hi:[1,0,1]
v_pk_mul_f32 v[108:109], v[108:109], v[220:221] op_sel:[0,1] op_sel_hi:[1,1]
v_cvt_pk_bf16_f32 v186, v108, v109
v_pk_fma_f32 v[110:111], v[42:43], v[220:221], v[110:111] op_sel_hi:[1,0,1]
v_pk_mul_f32 v[110:111], v[110:111], v[220:221] op_sel:[0,1] op_sel_hi:[1,1]
v_cvt_pk_bf16_f32 v187, v110, v111
v_pk_fma_f32 v[72:73], v[28:29], v[232:233], v[72:73] op_sel_hi:[1,0,1]
v_cvt_pk_bf16_f32 v176, v72, v73
v_pk_fma_f32 v[74:75], v[30:31], v[232:233], v[74:75] op_sel_hi:[1,0,1]
v_cvt_pk_bf16_f32 v177, v74, v75
v_pk_fma_f32 v[88:89], v[32:33], v[232:233], v[88:89] op_sel_hi:[1,0,1]
v_cvt_pk_bf16_f32 v178, v88, v89
v_pk_fma_f32 v[90:91], v[34:35], v[232:233], v[90:91] op_sel_hi:[1,0,1]
v_cvt_pk_bf16_f32 v179, v90, v91
v_pk_fma_f32 v[68:69], v[28:29], v[228:229], v[68:69] op_sel_hi:[1,0,1]
v_cvt_pk_bf16_f32 v172, v68, v69
v_pk_fma_f32 v[70:71], v[30:31], v[228:229], v[70:71] op_sel_hi:[1,0,1]
v_cvt_pk_bf16_f32 v173, v70, v71
v_pk_fma_f32 v[84:85], v[32:33], v[228:229], v[84:85] op_sel_hi:[1,0,1]
v_cvt_pk_bf16_f32 v174, v84, v85
v_pk_fma_f32 v[86:87], v[34:35], v[228:229], v[86:87] op_sel_hi:[1,0,1]
v_cvt_pk_bf16_f32 v175, v86, v87
v_pk_fma_f32 v[64:65], v[28:29], v[224:225], v[64:65] op_sel_hi:[1,0,1]
v_cvt_pk_bf16_f32 v168, v64, v65
v_pk_fma_f32 v[66:67], v[30:31], v[224:225], v[66:67] op_sel_hi:[1,0,1]
v_cvt_pk_bf16_f32 v169, v66, v67
v_pk_fma_f32 v[80:81], v[32:33], v[224:225], v[80:81] op_sel_hi:[1,0,1]
v_cvt_pk_bf16_f32 v170, v80, v81
v_pk_fma_f32 v[82:83], v[34:35], v[224:225], v[82:83] op_sel_hi:[1,0,1]
v_cvt_pk_bf16_f32 v171, v82, v83
v_pk_fma_f32 v[60:61], v[28:29], v[220:221], v[60:61] op_sel_hi:[1,0,1]
v_cvt_pk_bf16_f32 v164, v60, v61
v_pk_fma_f32 v[62:63], v[30:31], v[220:221], v[62:63] op_sel_hi:[1,0,1]
v_cvt_pk_bf16_f32 v165, v62, v63
v_pk_fma_f32 v[76:77], v[32:33], v[220:221], v[76:77] op_sel_hi:[1,0,1]
v_cvt_pk_bf16_f32 v166, v76, v77
v_pk_fma_f32 v[78:79], v[34:35], v[220:221], v[78:79] op_sel_hi:[1,0,1]
v_cvt_pk_bf16_f32 v167, v78, v79
s_nop 0
v_mfma_f32_16x16x32_bf16 v[120:123], v[196:199], v[176:179], v[50:53]
ds_read_b64 v[200:201], v9 offset:1024
v_mfma_f32_16x16x32_bf16 v[104:107], v[192:195], v[176:179], v[46:49]
ds_read_b64 v[210:211], v9 offset:1032
v_mfma_f32_16x16x32_bf16 v[116:119], v[192:195], v[172:175], v[50:53]
ds_read_b128 v[240:243], v11 offset:64
v_mfma_f32_16x16x32_bf16 v[100:103], v[188:191], v[172:175], v[46:49]
ds_read_b128 v[244:247], v11 offset:1088
v_mfma_f32_16x16x32_bf16 v[112:115], v[188:191], v[168:171], v[50:53]
ds_read_b128 v[28:31], v11
v_mfma_f32_16x16x32_bf16 v[96:99], v[184:187], v[168:171], v[46:49]
ds_read_b128 v[32:35], v11 offset:1024
v_max3_f32 v88, v104, v105, v106
v_mfma_f32_16x16x32_bf16 v[108:111], v[184:187], v[164:167], v[50:53]
v_max3_f32 v89, v107, v120, v121
v_max3_f32 v88, v88, v122, v123
v_mfma_f32_16x16x32_bf16 v[92:95], v[180:183], v[164:167], v[54:57]
v_max_f32 v90, v88, v89
v_max_f32 v89, v88, v89
MAA 132,8,96
s_nop 0
v_permlane16_swap_b32 v90, v89
MAA 132,28,100
v_max_f32 v88, v90, v89
v_max_f32 v89, v90, v89
MAA 132,48,160
s_nop 0
v_permlane32_swap_b32 v88, v89
MAA 132,68,164
v_max_f32 v88, v88, v89
v_mul_f32 v88, v88, v234
MAA 148,68,172
v_max3_f32 v84, v100, v101, v102
v_max3_f32 v85, v103, v116, v117
MAA 148,48,168
v_max3_f32 v84, v84, v118, v119
v_max_f32 v86, v84, v85
MAA 148,28,124
v_max_f32 v85, v84, v85
v_max3_f32 v80, v96, v97, v98
MAA 148,8,120
v_permlane16_swap_b32 v86, v85
v_max3_f32 v81, v99, v112, v113
v_max_f32 v84, v86, v85
v_max_f32 v85, v86, v85
v_max3_f32 v80, v80, v114, v115
v_max_f32 v82, v80, v81
v_permlane32_swap_b32 v84, v85
v_max_f32 v81, v80, v81
v_max_f32 v84, v84, v85
v_mul_f32 v84, v84, v230
v_permlane16_swap_b32 v82, v81
v_max3_f32 v76, v92, v93, v94
v_max_f32 v80, v82, v81
v_max_f32 v81, v82, v81
v_max3_f32 v77, v95, v108, v109
v_max3_f32 v76, v76, v110, v111
v_permlane32_swap_b32 v80, v81
v_max_f32 v78, v76, v77
v_max_f32 v80, v80, v81
v_mul_f32 v80, v80, v226
v_max_f32 v77, v76, v77
v_pk_fma_f32 v[104:105], v[104:105], v[234:235], v[88:89] op_sel_hi:[1,0,0] neg_lo:[0,0,1] neg_hi:[0,0,1]
v_pk_fma_f32 v[106:107], v[106:107], v[234:235], v[88:89] op_sel_hi:[1,0,0] neg_lo:[0,0,1] neg_hi:[0,0,1]
v_permlane16_swap_b32 v78, v77
v_pk_fma_f32 v[120:121], v[120:121], v[234:235], v[88:89] op_sel_hi:[1,0,0] neg_lo:[0,0,1] neg_hi:[0,0,1]
v_max_f32 v76, v78, v77
v_max_f32 v77, v78, v77
v_pk_fma_f32 v[122:123], v[122:123], v[234:235], v[88:89] op_sel_hi:[1,0,0] neg_lo:[0,0,1] neg_hi:[0,0,1]
v_pk_fma_f32 v[100:101], v[100:101], v[230:231], v[84:85] op_sel_hi:[1,0,0] neg_lo:[0,0,1] neg_hi:[0,0,1]
v_permlane32_swap_b32 v76, v77
v_pk_fma_f32 v[102:103], v[102:103], v[230:231], v[84:85] op_sel_hi:[1,0,0] neg_lo:[0,0,1] neg_hi:[0,0,1]
v_max_f32 v76, v76, v77
v_mul_f32 v76, v76, v222
v_pk_fma_f32 v[116:117], v[116:117], v[230:231], v[84:85] op_sel_hi:[1,0,0] neg_lo:[0,0,1] neg_hi:[0,0,1]
v_pk_fma_f32 v[118:119], v[118:119], v[230:231], v[84:85] op_sel_hi:[1,0,0] neg_lo:[0,0,1] neg_hi:[0,0,1]
v_pk_fma_f32 v[96:97], v[96:97], v[226:227], v[80:81] op_sel_hi:[1,0,0] neg_lo:[0,0,1] neg_hi:[0,0,1]
v_pk_fma_f32 v[98:99], v[98:99], v[226:227], v[80:81] op_sel_hi:[1,0,0] neg_lo:[0,0,1] neg_hi:[0,0,1]
v_pk_fma_f32 v[112:113], v[112:113], v[226:227], v[80:81] op_sel_hi:[1,0,0] neg_lo:[0,0,1] neg_hi:[0,0,1]
v_pk_fma_f32 v[114:115], v[114:115], v[226:227], v[80:81] op_sel_hi:[1,0,0] neg_lo:[0,0,1] neg_hi:[0,0,1]
v_pk_fma_f32 v[92:93], v[92:93], v[222:223], v[76:77] op_sel_hi:[1,0,0] neg_lo:[0,0,1] neg_hi:[0,0,1]
v_pk_fma_f32 v[94:95], v[94:95], v[222:223], v[76:77] op_sel_hi:[1,0,0] neg_lo:[0,0,1] neg_hi:[0,0,1]
v_pk_fma_f32 v[108:109], v[108:109], v[222:223], v[76:77] op_sel_hi:[1,0,0] neg_lo:[0,0,1] neg_hi:[0,0,1]
v_pk_fma_f32 v[110:111], v[110:111], v[222:223], v[76:77] op_sel_hi:[1,0,0] neg_lo:[0,0,1] neg_hi:[0,0,1]
v_pk_fma_f32 v[132:133], v[18:19], v[44:45], v[132:133] op_sel_hi:[1,0,1]
v_pk_mul_f32 v[132:133], v[132:133], v[22:23]
v_pk_fma_f32 v[134:135], v[20:21], v[44:45], v[134:135] op_sel_hi:[1,0,1]
v_pk_mul_f32 v[134:135], v[134:135], v[24:25]
v_pk_fma_f32 v[148:149], v[18:19], v[44:45], v[148:149] op_sel:[0,1,0] op_sel_hi:[1,1,1]
v_pk_mul_f32 v[148:149], v[148:149], v[22:23]
v_pk_fma_f32 v[150:151], v[20:21], v[44:45], v[150:151] op_sel:[0,1,0] op_sel_hi:[1,1,1]
v_pk_mul_f32 v[150:151], v[150:151], v[24:25]
v_exp_f32 v104, v104
s_nop 0
MAA 128,4,96
v_exp_f32 v105, v105
MAA 128,24,100
v_exp_f32 v106, v106
MAA 128,44,160
v_exp_f32 v107, v107
MAA 128,64,164
v_exp_f32 v120, v120
MAA 144,64,172
v_exp_f32 v121, v121
MAA 144,44,168
v_exp_f32 v122, v122
MAA 144,24,124
v_exp_f32 v123, v123
MAA 144,4,120
v_exp_f32 v100, v100
MAA 124,0,96
v_exp_f32 v101, v101
MAA 124,20,100
v_exp_f32 v102, v102
MAA 124,40,160
v_exp_f32 v103, v103
MAA 124,60,164
v_exp_f32 v116, v116
MAA 140,60,172
v_exp_f32 v117, v117
MAA 140,40,168
v_exp_f32 v118, v118
MAA 140,20,124
.Lpad24:
s_cbranch_execz .Lpad27
v_exp_f32 v119, v119
MAA 140,0,120
v_cvt_pk_bf16_f32 v72, v104, v105
v_cvt_pk_bf16_f32 v73, v106, v107
v_cvt_pk_bf16_f32 v74, v120, v121
v_cvt_pk_bf16_f32 v75, v122, v123
v_cvt_pk_bf16_f32 v68, v100, v101
v_cvt_pk_bf16_f32 v69, v102, v103
v_cvt_pk_bf16_f32 v70, v116, v117
v_cvt_pk_bf16_f32 v71, v118, v119
v_exp_f32 v96, v96
v_exp_f32 v97, v97
v_exp_f32 v98, v98
v_exp_f32 v99, v99
v_exp_f32 v112, v112
v_exp_f32 v113, v113
v_exp_f32 v114, v114
v_exp_f32 v115, v115
v_cvt_pk_bf16_f32 v64, v96, v97
v_cvt_pk_bf16_f32 v65, v98, v99
v_cvt_pk_bf16_f32 v66, v112, v113
v_cvt_pk_bf16_f32 v67, v114, v115
v_cvt_pk_bf16_f32 v206, v132, v133
v_cvt_pk_bf16_f32 v207, v134, v135
v_cvt_pk_bf16_f32 v216, v148, v149
v_cvt_pk_bf16_f32 v217, v150, v151
s_waitcnt lgkmcnt(3)
v_pk_fma_f32 v[128:129], v[240:241], v[44:45], v[128:129] op_sel_hi:[1,0,1]
s_waitcnt lgkmcnt(2)
v_pk_mul_f32 v[128:129], v[128:129], v[244:245]
v_cvt_pk_bf16_f32 v204, v128, v129
v_pk_fma_f32 v[130:131], v[242:243], v[44:45], v[130:131] op_sel_hi:[1,0,1]
v_pk_mul_f32 v[130:131], v[130:131], v[246:247]
v_cvt_pk_bf16_f32 v205, v130, v131
v_pk_fma_f32 v[144:145], v[240:241], v[44:45], v[144:145] op_sel:[0,1,0] op_sel_hi:[1,1,1]
v_pk_mul_f32 v[144:145], v[144:145], v[244:245]
v_cvt_pk_bf16_f32 v214, v144, v145
v_pk_fma_f32 v[146:147], v[242:243], v[44:45], v[146:147] op_sel:[0,1,0] op_sel_hi:[1,1,1]
v_pk_mul_f32 v[146:147], v[146:147], v[246:247]
v_cvt_pk_bf16_f32 v215, v146, v147
s_waitcnt lgkmcnt(1)
v_pk_fma_f32 v[124:125], v[28:29], v[44:45], v[124:125] op_sel_hi:[1,0,1]
s_waitcnt lgkmcnt(0)
v_pk_mul_f32 v[124:125], v[124:125], v[32:33]
v_cvt_pk_bf16_f32 v202, v124, v125
v_pk_fma_f32 v[126:127], v[30:31], v[44:45], v[126:127] op_sel_hi:[1,0,1]
v_pk_mul_f32 v[126:127], v[126:127], v[34:35]
v_cvt_pk_bf16_f32 v203, v126, v127
v_pk_fma_f32 v[140:141], v[28:29], v[44:45], v[140:141] op_sel:[0,1,0] op_sel_hi:[1,1,1]
v_pk_mul_f32 v[140:141], v[140:141], v[32:33]
v_cvt_pk_bf16_f32 v212, v140, v141
v_pk_fma_f32 v[142:143], v[30:31], v[44:45], v[142:143] op_sel:[0,1,0] op_sel_hi:[1,1,1]
v_pk_mul_f32 v[142:143], v[142:143], v[34:35]
v_cvt_pk_bf16_f32 v213, v142, v143
s_nop 0
v_mfma_f32_16x16x32_bf16 v[88:91], v[248:251], v[72:75], 0
v_exp_f32 v92, v92
v_mfma_f32_16x16x32_bf16 v[104:107], v[206:209], v[72:75], 0
v_exp_f32 v93, v93
v_mfma_f32_16x16x32_bf16 v[120:123], v[216:219], v[72:75], 0
v_exp_f32 v94, v94
v_mfma_f32_16x16x32_bf16 v[84:87], v[248:251], v[68:71], 0
v_exp_f32 v95, v95
v_mfma_f32_16x16x32_bf16 v[100:103], v[204:207], v[68:71], 0
v_exp_f32 v108, v108
v_mfma_f32_16x16x32_bf16 v[116:119], v[214:217], v[68:71], 0
v_exp_f32 v109, v109
v_mfma_f32_16x16x32_bf16 v[80:83], v[248:251], v[64:67], 0
v_exp_f32 v110, v110
v_mfma_f32_16x16x32_bf16 v[96:99], v[202:205], v[64:67], 0
v_exp_f32 v111, v111
v_mfma_f32_16x16x32_bf16 v[112:115], v[212:215], v[64:67], 0
v_cvt_pk_bf16_f32 v60, v92, v93
v_cvt_pk_bf16_f32 v61, v94, v95
v_cvt_pk_bf16_f32 v62, v108, v109
v_cvt_pk_bf16_f32 v63, v110, v111
v_rcp_f32 v88, v88
v_rcp_f32 v84, v84
v_mfma_f32_16x16x32_bf16 v[76:79], v[248:251], v[60:63], 0
v_rcp_f32 v80, v80
v_mfma_f32_16x16x32_bf16 v[92:95], v[200:203], v[60:63], 0
v_mfma_f32_16x16x32_bf16 v[108:111], v[210:213], v[60:63], 0
s_nop 4
v_rcp_f32 v76, v76
v_pk_mul_f32 v[104:105], v[104:105], v[88:89] op_sel_hi:[1,0]
v_pk_mul_f32 v[106:107], v[106:107], v[88:89] op_sel_hi:[1,0]
v_pk_mul_f32 v[120:121], v[120:121], v[88:89] op_sel_hi:[1,0]
v_pk_mul_f32 v[122:123], v[122:123], v[88:89] op_sel_hi:[1,0]
v_cvt_pk_bf16_f32 v176, v104, v105
v_cvt_pk_bf16_f32 v177, v106, v107
v_cvt_pk_bf16_f32 v178, v120, v121
v_cvt_pk_bf16_f32 v179, v122, v123
buffer_store_dwordx4 v[176:179], v4, s[16:19], s74 offen offset:3072 sc1
v_pk_mul_f32 v[100:101], v[100:101], v[84:85] op_sel_hi:[1,0]
v_pk_mul_f32 v[102:103], v[102:103], v[84:85] op_sel_hi:[1,0]
v_pk_mul_f32 v[116:117], v[116:117], v[84:85] op_sel_hi:[1,0]
v_pk_mul_f32 v[118:119], v[118:119], v[84:85] op_sel_hi:[1,0]
v_cvt_pk_bf16_f32 v172, v100, v101
v_cvt_pk_bf16_f32 v173, v102, v103
v_cvt_pk_bf16_f32 v174, v116, v117
v_cvt_pk_bf16_f32 v175, v118, v119
buffer_store_dwordx4 v[172:175], v4, s[16:19], s74 offen offset:2048 sc1
v_pk_mul_f32 v[96:97], v[96:97], v[80:81] op_sel_hi:[1,0]
v_pk_mul_f32 v[98:99], v[98:99], v[80:81] op_sel_hi:[1,0]
v_pk_mul_f32 v[112:113], v[112:113], v[80:81] op_sel_hi:[1,0]
v_pk_mul_f32 v[114:115], v[114:115], v[80:81] op_sel_hi:[1,0]
v_cvt_pk_bf16_f32 v168, v96, v97
v_cvt_pk_bf16_f32 v169, v98, v99
v_cvt_pk_bf16_f32 v170, v112, v113
v_cvt_pk_bf16_f32 v171, v114, v115
buffer_store_dwordx4 v[168:171], v4, s[16:19], s74 offen offset:1024 sc1
v_pk_mul_f32 v[92:93], v[92:93], v[76:77] op_sel_hi:[1,0]
v_pk_mul_f32 v[94:95], v[94:95], v[76:77] op_sel_hi:[1,0]
v_pk_mul_f32 v[108:109], v[108:109], v[76:77] op_sel_hi:[1,0]
v_pk_mul_f32 v[110:111], v[110:111], v[76:77] op_sel_hi:[1,0]
v_cvt_pk_bf16_f32 v164, v92, v93
v_cvt_pk_bf16_f32 v165, v94, v95
v_cvt_pk_bf16_f32 v166, v108, v109
v_cvt_pk_bf16_f32 v167, v110, v111
buffer_store_dwordx4 v[164:167], v4, s[16:19], s74 offen sc1
s_nop 1
s_branch .Lqkve56
.Lsp50:
s_mov_b32 s15, 0
.Lsp50l:
v_mov_b32 v25, 0
buffer_atomic_add v25, v22, s[16:19], s73 offen sc0
s_add_u32 s15, s15, 1
s_cmp_gt_u32 s15, 100000
s_waitcnt vmcnt(0)
s_cbranch_scc1 .Lsp50b
v_cmp_gt_u32 vcc, v23, v25
s_nop 0
s_cbranch_vccnz .Lsp50l
s_branch .Lsp50b
.p2align 12
.Lqkv55:
.Lpad25:
s_cbranch_execz .Lpad28
s_add_u32 m0, s55, 36864
s_nop 0
buffer_load_dwordx4 v21, s[16:19], s52 offen sc1 lds
buffer_load_dwordx4 v21, s[16:19], s52 offen offset:1024 sc1 lds
buffer_load_dword v22, s[16:19], s52 offen offset:2048 sc1 lds
s_add_u32 s52, s52, 131072
TR 80,25,49664
TR 82,25,50176
TR 84,25,62080
s_add_u32 m0, s55, 46080
s_nop 0
buffer_load_dwordx4 v21, s[16:19], s52 offen sc1 lds
buffer_load_dwordx4 v21, s[16:19], s52 offen offset:1024 sc1 lds
buffer_load_dword v22, s[16:19], s52 offen offset:2048 sc1 lds
s_add_u32 s52, s52, 131072
TR 86,25,62592
TR 88,25,50688
TR 90,25,51200
s_add_u32 m0, s55, 0
s_nop 0
buffer_load_dwordx4 v21, s[16:19], s52 offen sc1 lds
buffer_load_dwordx4 v21, s[16:19], s52 offen offset:1024 sc1 lds
buffer_load_dword v22, s[16:19], s52 offen offset:2048 sc1 lds
s_add_u32 s52, s52, 131072
TR 92,25,63104
TR 94,25,63616
TR 96,25,51712
s_add_u32 m0, s55, 9216
s_nop 0
buffer_load_dwordx4 v21, s[16:19], s52 offen sc1 lds
buffer_load_dwordx4 v21, s[16:19], s52 offen offset:1024 sc1 lds
buffer_load_dword v22, s[16:19], s52 offen offset:2048 sc1 lds
s_add_u32 s52, s52, 131072
TR 98,25,52224
TR 100,25,64128
TR 102,25,64640
s_add_u32 m0, s55, 18432
s_nop 0
buffer_load_dwordx4 v21, s[16:19], s52 offen sc1 lds
buffer_load_dwordx4 v21, s[16:19], s52 offen offset:1024 sc1 lds
buffer_load_dword v22, s[16:19], s52 offen offset:2048 sc1 lds
s_add_u32 s52, s52, 131072
ds_read_b128 v[28:31], v13
ds_read_b128 v[32:35], v13 offset:64
ds_read_b128 v[36:39], v13 offset:256
s_add_u32 m0, s55, 27648
s_nop 0
buffer_load_dwordx4 v21, s[16:19], s52 offen sc1 lds
buffer_load_dwordx4 v21, s[16:19], s52 offen offset:1024 sc1 lds
buffer_load_dword v22, s[16:19], s52 offen offset:2048 sc1 lds
s_add_u32 s52, s52, 131072
ds_read_b128 v[40:43], v13 offset:320
ds_read_b32 v44, v12 offset:512
ds_read_b32 v45, v12 offset:576
s_waitcnt vmcnt(12)
s_barrier
RD 0,23,36864
RD 4,23,37888
RD 8,23,39168
RD 12,23,40192
RD 16,24,38912
RD 20,23,46080
RD 24,23,47104
RD 28,23,48384
RD 32,23,49408
RD 36,24,48128
s_waitcnt lgkmcnt(0)
s_mov_b32 s15, -2
.p2align 6
.Lk58:
s_waitcnt vmcnt(9) lgkmcnt(8)
s_barrier
MAA 60,80,0
TR 104,25,49696
s_add_u32 m0, s56, 104832
MAA 60,84,20
buffer_load_dwordx4 v18, s[20:23], s54 offen lds
MAA 64,84,24
TR 106,25,50208
v_add_f32 v164, v164, v168
MAA 64,80,4
TR 108,25,62112
MAA 68,80,8
TR 110,25,62624
MAA 68,84,28
buffer_load_dwordx4 v19, s[20:23], s54 offen offset:1024 lds
MAA 72,84,32
TR 112,25,50720
v_add_f32 v165, v165, v169
MAA 72,80,12
TR 114,25,51232
s_waitcnt lgkmcnt(6)
MAA 104,88,12
TR 116,25,63136
MAA 104,92,32
buffer_load_dwordx4 v20, s[20:23], s54 offen offset:2048 lds
MAA 100,92,28
s_add_u32 s54, s54, 196608
s_add_u32 m0, s55, 36864
MAA 100,88,8
buffer_load_dwordx4 v21, s[16:19], s52 offen sc1 lds
MAA 96,88,4
TR 118,25,63648
MAA 96,92,24
TR 120,25,51744
v_add_f32 v166, v166, v170
MAA 92,92,20
TR 122,25,52256
MAA 92,88,0
buffer_load_dwordx4 v21, s[16:19], s52 offen offset:1024 sc1 lds
MAA 124,0,96
TR 124,25,64160
MAA 124,20,100
TR 126,25,64672
v_add_f32 v167, v167, v171
MAA 128,24,100
ds_read_b128 a[40:43], v23
MAA 128,4,96
buffer_load_dword v22, s[16:19], s52 offen offset:2048 sc1 lds
MAA 132,8,96
RD 44,23,1024
s_add_u32 s52, s52, 131072
MAA 132,28,100
buffer_load_dword v27, v14, s[20:23], s44 offen
MAA 136,32,100
RD 48,23,2304
s_add_u32 s44, s44, 1572864
MAA 136,12,96
RD 52,23,3328
MAA 156,16,96
RD 56,24,2048
MAA 156,36,100
s_waitcnt vmcnt(13) lgkmcnt(5)
s_barrier
MAA 76,104,0
RD 60,23,9216
s_add_u32 m0, s56, 117248
MAA 76,108,20
buffer_load_dwordx4 v18, s[20:23], s54 offen lds
MAA 80,108,24
RD 64,23,10240
MAA 80,104,4
RD 68,23,11520
MAA 84,104,8
RD 72,23,12544
MAA 84,108,28
buffer_load_dwordx4 v19, s[20:23], s54 offen offset:1024 lds
MAA 88,108,32
RD 76,24,11264
MAA 88,104,12
buffer_load_dwordx4 v20, s[20:23], s54 offen offset:2048 lds
MAA 120,112,12
ds_read_b64_tr_b16 a[80:81], v25
s_add_u32 s54, s54, 196608
MAA 120,116,32
TR 82,25,512
MAA 116,116,28
TR 84,25,12416
s_add_u32 m0, s55, 46080
MAA 116,112,8
buffer_load_dwordx4 v21, s[16:19], s52 offen sc1 lds
MAA 112,112,4
TR 86,25,12928
MAA 112,116,24
TR 88,25,1024
MAA 108,116,20
TR 90,25,1536
MAA 108,112,0
buffer_load_dwordx4 v21, s[16:19], s52 offen offset:1024 sc1 lds
MAA 140,0,120
TR 92,25,13440
MAA 140,20,124
TR 94,25,13952
MAA 144,24,124
TR 96,25,2048
MAA 144,4,120
buffer_load_dword v22, s[16:19], s52 offen offset:2048 sc1 lds
MAA 148,8,120
TR 98,25,2560
s_add_u32 s52, s52, 131072
MAA 148,28,124
buffer_load_dwordx4 v[168:171], v26, s[16:19], s75 offen sc1
MAA 152,32,124
TR 100,25,14464
MAA 152,12,120
TR 102,25,14976
MAA 160,16,120
MAA 160,36,124
s_waitcnt vmcnt(17) lgkmcnt(8)
s_barrier
MAA 60,80,40
TR 104,25,32
v_add_f32 v164, v164, v172
MAA 60,84,60
TR 106,25,544
MAA 64,84,64
TR 108,25,12448
s_add_u32 m0, s56, 129664
MAA 64,80,44
buffer_load_dwordx4 v18, s[20:23], s54 offen lds
MAA 68,80,48
TR 110,25,12960
MAA 68,84,68
TR 112,25,1056
MAA 72,84,72
TR 114,25,1568
v_add_f32 v165, v165, v173
MAA 72,80,52
TR 116,25,13472
s_waitcnt lgkmcnt(7)
MAA 104,88,52
TR 118,25,13984
MAA 104,92,72
buffer_load_dwordx4 v19, s[20:23], s54 offen offset:1024 lds
MAA 100,92,68
TR 120,25,2080
MAA 100,88,48
buffer_load_dwordx4 v20, s[20:23], s54 offen offset:2048 lds
MAA 96,88,44
s_add_u32 s54, s54, 196608
MAA 96,92,64
TR 122,25,2592
v_add_f32 v166, v166, v174
MAA 92,92,60
TR 124,25,14496
s_add_u32 m0, s55, 0
MAA 92,88,40
buffer_load_dwordx4 v21, s[16:19], s52 offen sc1 lds
MAA 124,40,96
TR 126,25,15008
MAA 124,60,100
RD 0,23,18432
MAA 128,64,100
RD 4,23,19456
MAA 128,44,96
buffer_load_dwordx4 v21, s[16:19], s52 offen offset:1024 sc1 lds
MAA 132,48,96
RD 8,23,20736
v_add_f32 v167, v167, v175
MAA 132,68,100
RD 12,23,21760
MAA 136,72,100
RD 16,24,20480
MAA 136,52,96
buffer_load_dword v22, s[16:19], s52 offen offset:2048 sc1 lds
MAA 156,56,96
s_add_u32 s52, s52, 131072
MAA 156,76,100
s_waitcnt vmcnt(17) lgkmcnt(5)
s_barrier
MAA 76,104,40
RD 20,23,27648
s_add_u32 m0, s56, 67584
MAA 76,108,60
buffer_load_dwordx4 v18, s[20:23], s54 offen lds
MAA 80,108,64
RD 24,23,28672
MAA 80,104,44
RD 28,23,29952
MAA 84,104,48
RD 32,23,30976
MAA 84,108,68
buffer_load_dwordx4 v19, s[20:23], s54 offen offset:1024 lds
MAA 88,108,72
RD 36,24,29696
MAA 88,104,52
buffer_load_dwordx4 v20, s[20:23], s54 offen offset:2048 lds
MAA 120,112,52
TR 80,25,24832
s_add_u32 s54, s54, 196608
MAA 120,116,72
TR 82,25,25344
MAA 116,116,68
TR 84,25,37248
s_add_u32 m0, s55, 9216
MAA 116,112,48
buffer_load_dwordx4 v21, s[16:19], s52 offen sc1 lds
MAA 112,112,44
TR 86,25,37760
MAA 112,116,64
TR 88,25,25856
MAA 108,116,60
TR 90,25,26368
MAA 108,112,40
buffer_load_dwordx4 v21, s[16:19], s52 offen offset:1024 sc1 lds
MAA 140,40,120
TR 92,25,38272
MAA 140,60,124
TR 94,25,38784
MAA 144,64,124
TR 96,25,26880
MAA 144,44,120
buffer_load_dword v22, s[16:19], s52 offen offset:2048 sc1 lds
MAA 148,48,120
TR 98,25,27392
s_add_u32 s52, s52, 131072
MAA 148,68,124
buffer_load_dwordx4 v[172:175], v26, s[16:19], s75 offen offset:1024 sc1
MAA 152,72,124
TR 100,25,39296
s_add_u32 s75, s75, 2048
MAA 152,52,120
TR 102,25,39808
MAA 160,56,120
MAA 160,76,124
s_waitcnt vmcnt(21) lgkmcnt(8)
s_barrier
MAA 60,80,0
TR 104,25,24864
MAA 60,84,20
TR 106,25,25376
MAA 64,84,24
TR 108,25,37280
s_add_u32 m0, s56, 80000
MAA 64,80,4
buffer_load_dwordx4 v18, s[20:23], s54 offen lds
MAA 68,80,8
TR 110,25,37792
MAA 68,84,28
TR 112,25,25888
MAA 72,84,32
TR 114,25,26400
MAA 72,80,12
TR 116,25,38304
s_waitcnt lgkmcnt(7)
MAA 104,88,12
TR 118,25,38816
MAA 104,92,32
buffer_load_dwordx4 v19, s[20:23], s54 offen offset:1024 lds
MAA 100,92,28
TR 120,25,26912
MAA 100,88,8
buffer_load_dwordx4 v20, s[20:23], s54 offen offset:2048 lds
MAA 96,88,4
s_add_u32 s54, s54, 196608
MAA 96,92,24
TR 122,25,27424
MAA 92,92,20
TR 124,25,39328
s_add_u32 m0, s55, 18432
MAA 92,88,0
buffer_load_dwordx4 v21, s[16:19], s52 offen sc1 lds
MAA 124,0,96
TR 126,25,39840
MAA 124,20,100
RD 40,23,36864
MAA 128,24,100
RD 44,23,37888
MAA 128,4,96
buffer_load_dwordx4 v21, s[16:19], s52 offen offset:1024 sc1 lds
MAA 132,8,96
RD 48,23,39168
MAA 132,28,100
RD 52,23,40192
MAA 136,32,100
RD 56,24,38912
MAA 136,12,96
buffer_load_dword v22, s[16:19], s52 offen offset:2048 sc1 lds
MAA 156,16,96
s_add_u32 s52, s52, 131072
MAA 156,36,100
s_waitcnt vmcnt(16) lgkmcnt(5)
s_barrier
MAA 76,104,0
RD 60,23,46080
MAA 76,108,20
RD 64,23,47104
MAA 80,108,24
RD 68,23,48384
s_add_u32 m0, s56, 92416
MAA 80,104,4
buffer_load_dwordx4 v18, s[20:23], s54 offen lds
MAA 84,104,8
RD 72,23,49408
MAA 84,108,28
RD 76,24,48128
MAA 88,108,32
TR 80,25,49664
MAA 88,104,12
buffer_load_dwordx4 v19, s[20:23], s54 offen offset:1024 lds
MAA 120,112,12
TR 82,25,50176
MAA 120,116,32
TR 84,25,62080
MAA 116,116,28
TR 86,25,62592
MAA 116,112,8
buffer_load_dwordx4 v20, s[20:23], s54 offen offset:2048 lds
MAA 112,112,4
s_add_u32 s54, s54, 196608
MAA 112,116,24
TR 88,25,50688
MAA 108,116,20
TR 90,25,51200
s_add_u32 m0, s55, 27648
MAA 108,112,0
buffer_load_dwordx4 v21, s[16:19], s52 offen sc1 lds
MAA 140,0,120
TR 92,25,63104
MAA 140,20,124
TR 94,25,63616
MAA 144,24,124
TR 96,25,51712
MAA 144,4,120
buffer_load_dwordx4 v21, s[16:19], s52 offen offset:1024 sc1 lds
MAA 148,8,120
TR 98,25,52224
MAA 148,28,124
TR 100,25,64128
MAA 152,32,124
TR 102,25,64640
MAA 152,12,120
buffer_load_dword v22, s[16:19], s52 offen offset:2048 sc1 lds
MAA 160,16,120
s_add_u32 s52, s52, 131072
MAA 160,36,124
s_waitcnt vmcnt(19) lgkmcnt(8)
s_barrier
MAA 60,80,40
TR 104,25,49696
s_add_u32 m0, s56, 104832
MAA 60,84,60
buffer_load_dwordx4 v18, s[20:23], s54 offen lds
MAA 64,84,64
TR 106,25,50208
v_add_f32 v164, v164, v168
MAA 64,80,44
TR 108,25,62112
MAA 68,80,48
TR 110,25,62624
MAA 68,84,68
buffer_load_dwordx4 v19, s[20:23], s54 offen offset:1024 lds
MAA 72,84,72
TR 112,25,50720
v_add_f32 v165, v165, v169
MAA 72,80,52
TR 114,25,51232
s_waitcnt lgkmcnt(6)
MAA 104,88,52
TR 116,25,63136
MAA 104,92,72
buffer_load_dwordx4 v20, s[20:23], s54 offen offset:2048 lds
MAA 100,92,68
s_add_u32 s54, s54, 196608
s_add_u32 m0, s55, 36864
MAA 100,88,48
buffer_load_dwordx4 v21, s[16:19], s52 offen sc1 lds
MAA 96,88,44
TR 118,25,63648
MAA 96,92,64
TR 120,25,51744
v_add_f32 v166, v166, v170
MAA 92,92,60
TR 122,25,52256
MAA 92,88,40
buffer_load_dwordx4 v21, s[16:19], s52 offen offset:1024 sc1 lds
MAA 124,40,96
TR 124,25,64160
MAA 124,60,100
TR 126,25,64672
v_add_f32 v167, v167, v171
MAA 128,64,100
ds_read_b128 a[0:3], v23
MAA 128,44,96
buffer_load_dword v22, s[16:19], s52 offen offset:2048 sc1 lds
MAA 132,48,96
RD 4,23,1024
s_add_u32 s52, s52, 131072
MAA 132,68,100
buffer_load_dword v27, v14, s[20:23], s44 offen
MAA 136,72,100
RD 8,23,2304
s_add_u32 s44, s44, 1572864
MAA 136,52,96
RD 12,23,3328
MAA 156,56,96
RD 16,24,2048
MAA 156,76,100
s_waitcnt vmcnt(16) lgkmcnt(5)
s_barrier
MAA 76,104,40
RD 20,23,9216
s_add_u32 m0, s56, 117248
MAA 76,108,60
buffer_load_dwordx4 v18, s[20:23], s54 offen lds
MAA 80,108,64
RD 24,23,10240
MAA 80,104,44
RD 28,23,11520
MAA 84,104,48
RD 32,23,12544
MAA 84,108,68
buffer_load_dwordx4 v19, s[20:23], s54 offen offset:1024 lds
MAA 88,108,72
RD 36,24,11264
MAA 88,104,52
buffer_load_dwordx4 v20, s[20:23], s54 offen offset:2048 lds
MAA 120,112,52
ds_read_b64_tr_b16 a[80:81], v25
s_add_u32 s54, s54, 196608
MAA 120,116,72
TR 82,25,512
MAA 116,116,68
TR 84,25,12416
s_add_u32 m0, s55, 46080
MAA 116,112,48
buffer_load_dwordx4 v21, s[16:19], s52 offen sc1 lds
MAA 112,112,44
TR 86,25,12928
MAA 112,116,64
TR 88,25,1024
MAA 108,116,60
TR 90,25,1536
MAA 108,112,40
buffer_load_dwordx4 v21, s[16:19], s52 offen offset:1024 sc1 lds
MAA 140,40,120
TR 92,25,13440
MAA 140,60,124
TR 94,25,13952
MAA 144,64,124
TR 96,25,2048
MAA 144,44,120
buffer_load_dword v22, s[16:19], s52 offen offset:2048 sc1 lds
MAA 148,48,120
TR 98,25,2560
s_add_u32 s52, s52, 131072
MAA 148,68,124
buffer_load_dwordx4 v[168:171], v26, s[16:19], s75 offen sc1
MAA 152,72,124
TR 100,25,14464
MAA 152,52,120
TR 102,25,14976
MAA 160,56,120
MAA 160,76,124
s_waitcnt vmcnt(20) lgkmcnt(8)
.Lpad26:
s_cbranch_execz .Lnopoll53r
s_barrier
MAA 60,80,0
TR 104,25,32
v_add_f32 v164, v164, v172
MAA 60,84,20
TR 106,25,544
MAA 64,84,24
TR 108,25,12448
s_add_u32 m0, s56, 129664
MAA 64,80,4
buffer_load_dwordx4 v18, s[20:23], s54 offen lds
MAA 68,80,8
TR 110,25,12960
MAA 68,84,28
TR 112,25,1056
MAA 72,84,32
TR 114,25,1568
v_add_f32 v165, v165, v173
MAA 72,80,12
TR 116,25,13472
s_waitcnt lgkmcnt(7)
MAA 104,88,12
TR 118,25,13984
MAA 104,92,32
buffer_load_dwordx4 v19, s[20:23], s54 offen offset:1024 lds
MAA 100,92,28
TR 120,25,2080
MAA 100,88,8
buffer_load_dwordx4 v20, s[20:23], s54 offen offset:2048 lds
MAA 96,88,4
s_add_u32 s54, s54, 196608
MAA 96,92,24
TR 122,25,2592
v_add_f32 v166, v166, v174
MAA 92,92,20
TR 124,25,14496
s_add_u32 m0, s55, 0
MAA 92,88,0
buffer_load_dwordx4 v21, s[16:19], s52 offen sc1 lds
MAA 124,0,96
TR 126,25,15008
MAA 124,20,100
RD 40,23,18432
MAA 128,24,100
RD 44,23,19456
MAA 128,4,96
buffer_load_dwordx4 v21, s[16:19], s52 offen offset:1024 sc1 lds
MAA 132,8,96
RD 48,23,20736
v_add_f32 v167, v167, v175
MAA 132,28,100
RD 52,23,21760
MAA 136,32,100
RD 56,24,20480
MAA 136,12,96
buffer_load_dword v22, s[16:19], s52 offen offset:2048 sc1 lds
MAA 156,16,96
s_add_u32 s52, s52, 131072
MAA 156,36,100
s_waitcnt vmcnt(17) lgkmcnt(5)
s_barrier
MAA 76,104,0
RD 60,23,27648
s_add_u32 m0, s56, 67584
MAA 76,108,20
buffer_load_dwordx4 v18, s[20:23], s54 offen lds
MAA 80,108,24
RD 64,23,28672
MAA 80,104,4
RD 68,23,29952
MAA 84,104,8
RD 72,23,30976
MAA 84,108,28
buffer_load_dwordx4 v19, s[20:23], s54 offen offset:1024 lds
MAA 88,108,32
RD 76,24,29696
MAA 88,104,12
buffer_load_dwordx4 v20, s[20:23], s54 offen offset:2048 lds
MAA 120,112,12
TR 80,25,24832
s_add_u32 s54, s54, 196608
MAA 120,116,32
TR 82,25,25344
MAA 116,116,28
TR 84,25,37248
s_add_u32 m0, s55, 9216
MAA 116,112,8
buffer_load_dwordx4 v21, s[16:19], s52 offen sc1 lds
MAA 112,112,4
TR 86,25,37760
MAA 112,116,24
TR 88,25,25856
MAA 108,116,20
TR 90,25,26368
MAA 108,112,0
buffer_load_dwordx4 v21, s[16:19], s52 offen offset:1024 sc1 lds
MAA 140,0,120
TR 92,25,38272
MAA 140,20,124
TR 94,25,38784
MAA 144,24,124
TR 96,25,26880
MAA 144,4,120
buffer_load_dword v22, s[16:19], s52 offen offset:2048 sc1 lds
MAA 148,8,120
TR 98,25,27392
s_add_u32 s52, s52, 131072
MAA 148,28,124
buffer_load_dwordx4 v[172:175], v26, s[16:19], s75 offen offset:1024 sc1
MAA 152,32,124
TR 100,25,39296
s_add_u32 s75, s75, 2048
MAA 152,12,120
TR 102,25,39808
MAA 160,16,120
MAA 160,36,124
s_waitcnt vmcnt(21) lgkmcnt(8)
s_barrier
MAA 60,80,40
TR 104,25,24864
MAA 60,84,60
TR 106,25,25376
MAA 64,84,64
TR 108,25,37280
s_add_u32 m0, s56, 80000
MAA 64,80,44
buffer_load_dwordx4 v18, s[20:23], s54 offen lds
MAA 68,80,48
TR 110,25,37792
MAA 68,84,68
TR 112,25,25888
MAA 72,84,72
TR 114,25,26400
MAA 72,80,52
TR 116,25,38304
s_waitcnt lgkmcnt(7)
MAA 104,88,52
TR 118,25,38816
MAA 104,92,72
buffer_load_dwordx4 v19, s[20:23], s54 offen offset:1024 lds
MAA 100,92,68
TR 120,25,26912
MAA 100,88,48
buffer_load_dwordx4 v20, s[20:23], s54 offen offset:2048 lds
MAA 96,88,44
s_add_u32 s54, s54, 196608
MAA 96,92,64
TR 122,25,27424
MAA 92,92,60
TR 124,25,39328
s_add_u32 m0, s55, 18432
MAA 92,88,40
buffer_load_dwordx4 v21, s[16:19], s52 offen sc1 lds
MAA 124,40,96
TR 126,25,39840
MAA 124,60,100
RD 0,23,36864
MAA 128,64,100
RD 4,23,37888
MAA 128,44,96
buffer_load_dwordx4 v21, s[16:19], s52 offen offset:1024 sc1 lds
MAA 132,48,96
RD 8,23,39168
MAA 132,68,100
RD 12,23,40192
MAA 136,72,100
RD 16,24,38912
MAA 136,52,96
buffer_load_dword v22, s[16:19], s52 offen offset:2048 sc1 lds
MAA 156,56,96
s_add_u32 s52, s52, 131072
MAA 156,76,100
s_waitcnt vmcnt(16) lgkmcnt(5)
s_barrier
MAA 76,104,40
RD 20,23,46080
MAA 76,108,60
RD 24,23,47104
MAA 80,108,64
RD 28,23,48384
s_add_u32 m0, s56, 92416
MAA 80,104,44
buffer_load_dwordx4 v18, s[20:23], s54 offen lds
MAA 84,104,48
RD 32,23,49408
MAA 84,108,68
RD 36,24,48128
MAA 88,108,72
TR 80,25,49664
MAA 88,104,52
buffer_load_dwordx4 v19, s[20:23], s54 offen offset:1024 lds
MAA 120,112,52
TR 82,25,50176
MAA 120,116,72
TR 84,25,62080
MAA 116,116,68
TR 86,25,62592
MAA 116,112,48
buffer_load_dwordx4 v20, s[20:23], s54 offen offset:2048 lds
MAA 112,112,44
s_add_u32 s54, s54, 196608
MAA 112,116,64
TR 88,25,50688
MAA 108,116,60
TR 90,25,51200
s_add_u32 m0, s55, 27648
MAA 108,112,40
buffer_load_dwordx4 v21, s[16:19], s52 offen sc1 lds
MAA 140,40,120
TR 92,25,63104
MAA 140,60,124
TR 94,25,63616
MAA 144,64,124
TR 96,25,51712
MAA 144,44,120
buffer_load_dwordx4 v21, s[16:19], s52 offen offset:1024 sc1 lds
MAA 148,48,120
TR 98,25,52224
MAA 148,68,124
TR 100,25,64128
MAA 152,72,124
TR 102,25,64640
MAA 152,52,120
buffer_load_dword v22, s[16:19], s52 offen offset:2048 sc1 lds
MAA 160,56,120
s_add_u32 s52, s52, 131072
s_add_u32 s15, s15, 1
MAA 160,76,124
s_cbranch_scc0 .Lk58
s_waitcnt vmcnt(19) lgkmcnt(8)
s_barrier
MAA 60,80,0
TR 104,25,49696
v_add_f32 v164, v164, v168
MAA 60,84,20
TR 106,25,50208
s_add_u32 m0, s56, 104832
MAA 64,84,24
buffer_load_dwordx4 v18, s[20:23], s54 offen lds
MAA 64,80,4
TR 108,25,62112
v_add_f32 v165, v165, v169
MAA 68,80,8
TR 110,25,62624
v_add_f32 v166, v166, v170
MAA 68,84,28
TR 112,25,50720
v_add_f32 v167, v167, v171
MAA 72,84,32
buffer_load_dwordx4 v19, s[20:23], s54 offen offset:1024 lds
MAA 72,80,12
TR 114,25,51232
s_waitcnt lgkmcnt(6)
MAA 104,88,12
TR 116,25,63136
MAA 104,92,32
TR 118,25,63648
MAA 100,92,28
buffer_load_dwordx4 v20, s[20:23], s54 offen offset:2048 lds
MAA 100,88,8
TR 120,25,51744
s_add_u32 s54, s54, 196608
MAA 96,88,4
TR 122,25,52256
s_add_u32 m0, s55, 36864
MAA 96,92,24
TR 124,25,64160
MAA 92,92,20
buffer_load_dwordx4 v21, s[16:19], s52 offen sc1 lds
MAA 92,88,0
TR 126,25,64672
MAA 124,0,96
ds_read_b128 a[40:43], v23
MAA 124,20,100
RD 44,23,1024
MAA 128,24,100
buffer_load_dwordx4 v21, s[16:19], s52 offen offset:1024 sc1 lds
MAA 128,4,96
RD 48,23,2304
MAA 132,8,96
RD 52,23,3328
MAA 132,28,100
RD 56,24,2048
MAA 136,32,100
buffer_load_dword v22, s[16:19], s52 offen offset:2048 sc1 lds
MAA 136,12,96
s_add_u32 s52, s52, 131072
MAA 156,16,96
MAA 156,36,100
s_waitcnt vmcnt(15) lgkmcnt(5)
s_barrier
MAA 76,104,0
RD 60,23,9216
v_add_f32 v164, v164, v172
MAA 76,108,20
RD 64,23,10240
s_add_u32 m0, s56, 117248
MAA 80,108,24
buffer_load_dwordx4 v18, s[20:23], s54 offen lds
MAA 80,104,4
RD 68,23,11520
v_add_f32 v165, v165, v173
MAA 84,104,8
RD 72,23,12544
v_add_f32 v166, v166, v174
MAA 84,108,28
RD 76,24,11264
v_add_f32 v167, v167, v175
MAA 88,108,32
buffer_load_dwordx4 v19, s[20:23], s54 offen offset:1024 lds
MAA 88,104,12
ds_read_b64_tr_b16 a[80:81], v25
MAA 120,112,12
TR 82,25,512
MAA 120,116,32
TR 84,25,12416
MAA 116,116,28
buffer_load_dwordx4 v20, s[20:23], s54 offen offset:2048 lds
MAA 116,112,8
TR 86,25,12928
s_add_u32 s54, s54, 196608
MAA 112,112,4
TR 88,25,1024
s_add_u32 m0, s55, 46080
MAA 112,116,24
TR 90,25,1536
MAA 108,116,20
buffer_load_dwordx4 v21, s[16:19], s52 offen sc1 lds
MAA 108,112,0
TR 92,25,13440
MAA 140,0,120
TR 94,25,13952
MAA 140,20,124
TR 96,25,2048
MAA 144,24,124
buffer_load_dwordx4 v21, s[16:19], s52 offen offset:1024 sc1 lds
MAA 144,4,120
TR 98,25,2560
MAA 148,8,120
TR 100,25,14464
MAA 148,28,124
TR 102,25,14976
MAA 152,32,124
buffer_load_dword v22, s[16:19], s52 offen offset:2048 sc1 lds
MAA 152,12,120
s_add_u32 s52, s52, 131072
v_permlane32_swap_b32 v164, v166
MAA 160,16,120
v_permlane32_swap_b32 v165, v167
MAA 160,36,124
s_waitcnt vmcnt(18) lgkmcnt(8)
s_barrier
MAA 60,80,40
TR 104,25,32
v_add_f32 v164, v164, v166
MAA 60,84,60
TR 106,25,544
s_add_u32 m0, s56, 129664
MAA 64,84,64
buffer_load_dwordx4 v18, s[20:23], s54 offen lds
MAA 64,80,44
TR 108,25,12448
v_add_f32 v165, v165, v167
MAA 68,80,48
TR 110,25,12960
v_mul_f32 v164, 0xba800000, v164
MAA 68,84,68
buffer_load_dwordx4 v19, s[20:23], s54 offen offset:1024 lds
MAA 72,84,72
TR 112,25,1056
v_mul_f32 v165, 0x3a800000, v165
MAA 72,80,52
TR 114,25,1568
v_fma_f32 v165, -v164, v164, v165
s_waitcnt lgkmcnt(6)
MAA 104,88,52
buffer_load_dwordx4 v20, s[20:23], s54 offen offset:2048 lds
MAA 104,92,72
TR 116,25,13472
s_add_u32 s54, s54, 196608
MAA 100,92,68
TR 118,25,13984
s_add_u32 m0, s59, 58240
MAA 100,88,48
TR 120,25,2080
s_xor_b32 s58, s87, 1966080
MAA 96,88,44
buffer_load_dwordx4 v5, s[24:27], s58 offen lds
MAA 96,92,64
TR 122,25,2592
v_max_f32 v165, 0, v165
MAA 92,92,60
TR 124,25,14496
v_add_f32 v165, 0x3727c5ac, v165
MAA 92,88,40
buffer_load_dwordx4 v6, s[24:27], s58 offen offset:1024 lds
MAA 124,40,96
TR 126,25,15008
s_add_u32 m0, s59, 0
MAA 124,60,100
RD 0,23,18432
s_xor_b32 s58, s87, 1048576
MAA 128,64,100
buffer_load_dwordx4 v5, s[24:27], s58 offen lds
MAA 128,44,96
RD 4,23,19456
MAA 132,48,96
RD 8,23,20736
MAA 132,68,100
buffer_load_dwordx4 v6, s[24:27], s58 offen offset:1024 lds
MAA 136,72,100
RD 12,23,21760
MAA 136,52,96
RD 16,24,20480
MAA 156,56,96
v_rsq_f32 v166, v165
MAA 156,76,100
v_mov_b32 v165, v166
v_mul_f32 v166, 0x3e8293ee, v166
ds_write_b128 v7, v[164:167]
s_waitcnt vmcnt(16) lgkmcnt(6)
s_barrier
MAA 76,104,40
ds_write_b32 v17, v164
MAA 76,108,60
ds_write_b32 v17, v165 offset:1024
s_add_u32 m0, s59, 8320
MAA 80,108,64
RD 20,23,27648
s_xor_b32 s58, s87, 1179648
MAA 80,104,44
buffer_load_dwordx4 v5, s[24:27], s58 offen lds
MAA 84,104,48
RD 24,23,28672
MAA 84,108,68
RD 28,23,29952
MAA 88,108,72
RD 32,23,30976
MAA 88,104,52
buffer_load_dwordx4 v6, s[24:27], s58 offen offset:1024 lds
MAA 120,112,52
RD 36,24,29696
s_add_u32 m0, s59, 66560
MAA 120,116,72
TR 80,25,24832
s_xor_b32 s58, s87, 0
MAA 116,116,68
TR 82,25,25344
MAA 116,112,48
buffer_load_dwordx4 v5, s[24:27], s58 offen lds
MAA 112,112,44
TR 84,25,37248
MAA 112,116,64
TR 86,25,37760
MAA 108,116,60
TR 88,25,25856
MAA 108,112,40
buffer_load_dwordx4 v6, s[24:27], s58 offen offset:1024 lds
MAA 140,40,120
TR 90,25,26368
s_add_u32 m0, s59, 74880
MAA 140,60,124
TR 92,25,38272
s_xor_b32 s58, s87, 131072
MAA 144,64,124
TR 94,25,38784
MAA 144,44,120
buffer_load_dwordx4 v5, s[24:27], s58 offen lds
MAA 148,48,120
TR 96,25,26880
MAA 148,68,124
TR 98,25,27392
MAA 152,72,124
TR 100,25,39296
MAA 152,52,120
buffer_load_dwordx4 v6, s[24:27], s58 offen offset:1024 lds
MAA 160,56,120
TR 102,25,39808
MAA 160,76,124
s_waitcnt vmcnt(10) lgkmcnt(0)
s_barrier
MAA 104,88,12
TR 112,25,25888
s_add_u32 m0, s59, 83200
MAA 104,92,32
TR 114,25,26400
s_xor_b32 s58, s87, 262144
MAA 100,92,28
buffer_load_dwordx4 v5, s[24:27], s58 offen lds
MAA 100,88,8
TR 116,25,38304
MAA 96,88,4
TR 118,25,38816
MAA 96,92,24
TR 120,25,26912
MAA 92,92,20
buffer_load_dwordx4 v6, s[24:27], s58 offen offset:1024 lds
MAA 92,88,0
TR 122,25,27424
s_add_u32 m0, s59, 16640
MAA 156,16,96
TR 124,25,39328
s_xor_b32 s58, s87, 1310720
MAA 156,36,100
TR 126,25,39840
MAA 72,84,32
buffer_load_dwordx4 v5, s[24:27], s58 offen lds
MAA 72,80,12
TR 104,25,24864
MAA 68,80,8
TR 106,25,25376
MAA 68,84,28
TR 108,25,37280
MAA 64,84,24
buffer_load_dwordx4 v6, s[24:27], s58 offen offset:1024 lds
MAA 64,80,4
TR 110,25,37792
s_add_u32 m0, s59, 24960
MAA 60,80,0
RD 40,23,36864
s_xor_b32 s58, s87, 1441792
MAA 60,84,20
RD 44,23,37888
s_waitcnt lgkmcnt(12)
MAA 120,112,12
buffer_load_dwordx4 v5, s[24:27], s58 offen lds
s_waitcnt lgkmcnt(10)
MAA 120,116,32
RD 48,23,39168
MAA 116,116,28
RD 52,23,40192
MAA 116,112,8
RD 56,24,38912
MAA 112,112,4
buffer_load_dwordx4 v6, s[24:27], s58 offen offset:1024 lds
.Lpad27:
s_cbranch_execz .Lnopoll53r
MAA 112,116,24
s_waitcnt lgkmcnt(5)
s_barrier
RD 60,23,46080
MAA 108,116,20
RD 64,23,47104
s_add_u32 m0, s59, 91520
MAA 108,112,0
RD 68,23,48384
s_xor_b32 s58, s87, 393216
MAA 160,16,120
RD 72,23,49408
MAA 160,36,124
RD 76,24,48128
MAA 88,108,32
TR 144,25,50688
MAA 88,104,12
TR 146,25,51200
MAA 84,104,8
TR 148,25,63104
MAA 84,108,28
TR 150,25,63616
MAA 80,108,24
TR 152,25,50720
MAA 80,104,4
TR 154,25,51232
MAA 76,104,0
TR 156,25,63136
MAA 76,108,20
TR 158,25,63648
TR 160,25,51712
TR 162,25,52224
TR 164,25,64128
s_waitcnt lgkmcnt(9)
MAA 104,144,52
TR 166,25,64640
TR 168,25,51744
TR 170,25,52256
s_waitcnt lgkmcnt(10)
MAA 104,148,72
TR 172,25,64160
MAA 100,148,68
TR 174,25,64672
MAA 100,144,48
TR 136,25,49696
MAA 96,144,44
TR 138,25,50208
MAA 96,148,64
TR 140,25,62112
MAA 92,148,60
TR 142,25,62624
MAA 92,144,40
TR 128,25,49664
s_waitcnt lgkmcnt(15)
MAA 120,152,52
TR 130,25,50176
s_waitcnt lgkmcnt(14)
MAA 120,156,72
TR 132,25,62080
MAA 116,156,68
TR 134,25,62592
MAA 116,152,48
ds_read_b128 v[232:235], v10 offset:1792
MAA 112,152,44
ds_read_b128 v[228:231], v10 offset:1536
MAA 112,156,64
ds_read_b128 v[224:227], v10 offset:1280
MAA 108,156,60
ds_read_b128 v[220:223], v10 offset:1024
MAA 108,152,40
buffer_load_dwordx4 v5, s[24:27], s58 offen lds
s_waitcnt lgkmcnt(15)
MAA 156,56,160
ds_read_b128 v[240:243], v11 offset:704
MAA 156,76,164
ds_read_b128 v[244:247], v11 offset:1728
s_waitcnt lgkmcnt(14)
MAA 160,76,172
ds_read_b128 v[18:21], v11 offset:448
MAA 160,56,168
buffer_load_dwordx4 v6, s[24:27], s58 offen offset:1024 lds
s_waitcnt lgkmcnt(13)
MAA 88,136,52
ds_read_b128 v[22:25], v11 offset:1472
s_add_u32 m0, s59, 99840
s_waitcnt lgkmcnt(12)
MAA 88,140,72
s_xor_b32 s58, s87, 524288
MAA 84,140,68
MAA 84,136,48
buffer_load_dwordx4 v5, s[24:27], s58 offen lds
MAA 80,136,44
MAA 80,140,64
MAA 76,140,60
MAA 76,136,40
buffer_load_dwordx4 v6, s[24:27], s58 offen offset:1024 lds
s_waitcnt lgkmcnt(10)
MAA 72,128,52
s_add_u32 m0, s59, 108160
s_xor_b32 s58, s87, 655360
s_waitcnt lgkmcnt(8)
MAA 72,132,72
MAA 68,132,68
MAA 68,128,48
buffer_load_dwordx4 v5, s[24:27], s58 offen lds
MAA 64,128,44
MAA 64,132,64
MAA 60,132,60
MAA 60,128,40
buffer_load_dwordx4 v6, s[24:27], s58 offen offset:1024 lds
s_waitcnt lgkmcnt(3)
v_pk_fma_f32 v[156:157], v[240:241], v[44:45], v[156:157] op_sel_hi:[1,0,1]
s_waitcnt lgkmcnt(2)
v_pk_mul_f32 v[156:157], v[156:157], v[244:245]
v_cvt_pk_bf16_f32 v236, v156, v157
v_pk_fma_f32 v[158:159], v[242:243], v[44:45], v[158:159] op_sel_hi:[1,0,1]
v_pk_mul_f32 v[158:159], v[158:159], v[246:247]
v_cvt_pk_bf16_f32 v237, v158, v159
v_pk_fma_f32 v[160:161], v[240:241], v[44:45], v[160:161] op_sel:[0,1,0] op_sel_hi:[1,1,1]
v_pk_mul_f32 v[160:161], v[160:161], v[244:245]
v_cvt_pk_bf16_f32 v238, v160, v161
v_pk_fma_f32 v[162:163], v[242:243], v[44:45], v[162:163] op_sel:[0,1,0] op_sel_hi:[1,1,1]
v_pk_mul_f32 v[162:163], v[162:163], v[246:247]
v_cvt_pk_bf16_f32 v239, v162, v163
ds_write_b128 v8, v[236:239] offset:1024
v_pk_fma_f32 v[104:105], v[36:37], v[232:233], v[104:105] op_sel_hi:[1,0,1]
v_pk_mul_f32 v[104:105], v[104:105], v[232:233] op_sel:[0,1] op_sel_hi:[1,1]
v_cvt_pk_bf16_f32 v196, v104, v105
v_pk_fma_f32 v[106:107], v[38:39], v[232:233], v[106:107] op_sel_hi:[1,0,1]
v_pk_mul_f32 v[106:107], v[106:107], v[232:233] op_sel:[0,1] op_sel_hi:[1,1]
v_cvt_pk_bf16_f32 v197, v106, v107
v_pk_fma_f32 v[120:121], v[40:41], v[232:233], v[120:121] op_sel_hi:[1,0,1]
v_pk_mul_f32 v[120:121], v[120:121], v[232:233] op_sel:[0,1] op_sel_hi:[1,1]
v_cvt_pk_bf16_f32 v198, v120, v121
v_pk_fma_f32 v[122:123], v[42:43], v[232:233], v[122:123] op_sel_hi:[1,0,1]
v_pk_mul_f32 v[122:123], v[122:123], v[232:233] op_sel:[0,1] op_sel_hi:[1,1]
v_cvt_pk_bf16_f32 v199, v122, v123
v_pk_fma_f32 v[100:101], v[36:37], v[228:229], v[100:101] op_sel_hi:[1,0,1]
v_pk_mul_f32 v[100:101], v[100:101], v[228:229] op_sel:[0,1] op_sel_hi:[1,1]
v_cvt_pk_bf16_f32 v192, v100, v101
v_pk_fma_f32 v[102:103], v[38:39], v[228:229], v[102:103] op_sel_hi:[1,0,1]
v_pk_mul_f32 v[102:103], v[102:103], v[228:229] op_sel:[0,1] op_sel_hi:[1,1]
v_cvt_pk_bf16_f32 v193, v102, v103
v_pk_fma_f32 v[116:117], v[40:41], v[228:229], v[116:117] op_sel_hi:[1,0,1]
v_pk_mul_f32 v[116:117], v[116:117], v[228:229] op_sel:[0,1] op_sel_hi:[1,1]
v_cvt_pk_bf16_f32 v194, v116, v117
v_pk_fma_f32 v[118:119], v[42:43], v[228:229], v[118:119] op_sel_hi:[1,0,1]
v_pk_mul_f32 v[118:119], v[118:119], v[228:229] op_sel:[0,1] op_sel_hi:[1,1]
v_cvt_pk_bf16_f32 v195, v118, v119
v_pk_fma_f32 v[96:97], v[36:37], v[224:225], v[96:97] op_sel_hi:[1,0,1]
v_pk_mul_f32 v[96:97], v[96:97], v[224:225] op_sel:[0,1] op_sel_hi:[1,1]
v_cvt_pk_bf16_f32 v188, v96, v97
v_pk_fma_f32 v[98:99], v[38:39], v[224:225], v[98:99] op_sel_hi:[1,0,1]
v_pk_mul_f32 v[98:99], v[98:99], v[224:225] op_sel:[0,1] op_sel_hi:[1,1]
v_cvt_pk_bf16_f32 v189, v98, v99
v_pk_fma_f32 v[112:113], v[40:41], v[224:225], v[112:113] op_sel_hi:[1,0,1]
v_pk_mul_f32 v[112:113], v[112:113], v[224:225] op_sel:[0,1] op_sel_hi:[1,1]
v_cvt_pk_bf16_f32 v190, v112, v113
v_pk_fma_f32 v[114:115], v[42:43], v[224:225], v[114:115] op_sel_hi:[1,0,1]
v_pk_mul_f32 v[114:115], v[114:115], v[224:225] op_sel:[0,1] op_sel_hi:[1,1]
v_cvt_pk_bf16_f32 v191, v114, v115
v_pk_fma_f32 v[92:93], v[36:37], v[220:221], v[92:93] op_sel_hi:[1,0,1]
v_pk_mul_f32 v[92:93], v[92:93], v[220:221] op_sel:[0,1] op_sel_hi:[1,1]
v_cvt_pk_bf16_f32 v184, v92, v93
v_pk_fma_f32 v[94:95], v[38:39], v[220:221], v[94:95] op_sel_hi:[1,0,1]
v_pk_mul_f32 v[94:95], v[94:95], v[220:221] op_sel:[0,1] op_sel_hi:[1,1]
v_cvt_pk_bf16_f32 v185, v94, v95
v_pk_fma_f32 v[108:109], v[40:41], v[220:221], v[108:109] op_sel_hi:[1,0,1]
v_pk_mul_f32 v[108:109], v[108:109], v[220:221] op_sel:[0,1] op_sel_hi:[1,1]
v_cvt_pk_bf16_f32 v186, v108, v109
v_pk_fma_f32 v[110:111], v[42:43], v[220:221], v[110:111] op_sel_hi:[1,0,1]
v_pk_mul_f32 v[110:111], v[110:111], v[220:221] op_sel:[0,1] op_sel_hi:[1,1]
v_cvt_pk_bf16_f32 v187, v110, v111
v_pk_fma_f32 v[72:73], v[28:29], v[232:233], v[72:73] op_sel_hi:[1,0,1]
v_cvt_pk_bf16_f32 v176, v72, v73
v_pk_fma_f32 v[74:75], v[30:31], v[232:233], v[74:75] op_sel_hi:[1,0,1]
v_cvt_pk_bf16_f32 v177, v74, v75
v_pk_fma_f32 v[88:89], v[32:33], v[232:233], v[88:89] op_sel_hi:[1,0,1]
v_cvt_pk_bf16_f32 v178, v88, v89
v_pk_fma_f32 v[90:91], v[34:35], v[232:233], v[90:91] op_sel_hi:[1,0,1]
v_cvt_pk_bf16_f32 v179, v90, v91
v_pk_fma_f32 v[68:69], v[28:29], v[228:229], v[68:69] op_sel_hi:[1,0,1]
v_cvt_pk_bf16_f32 v172, v68, v69
v_pk_fma_f32 v[70:71], v[30:31], v[228:229], v[70:71] op_sel_hi:[1,0,1]
v_cvt_pk_bf16_f32 v173, v70, v71
v_pk_fma_f32 v[84:85], v[32:33], v[228:229], v[84:85] op_sel_hi:[1,0,1]
v_cvt_pk_bf16_f32 v174, v84, v85
v_pk_fma_f32 v[86:87], v[34:35], v[228:229], v[86:87] op_sel_hi:[1,0,1]
v_cvt_pk_bf16_f32 v175, v86, v87
v_pk_fma_f32 v[64:65], v[28:29], v[224:225], v[64:65] op_sel_hi:[1,0,1]
v_cvt_pk_bf16_f32 v168, v64, v65
v_pk_fma_f32 v[66:67], v[30:31], v[224:225], v[66:67] op_sel_hi:[1,0,1]
v_cvt_pk_bf16_f32 v169, v66, v67
v_pk_fma_f32 v[80:81], v[32:33], v[224:225], v[80:81] op_sel_hi:[1,0,1]
v_cvt_pk_bf16_f32 v170, v80, v81
v_pk_fma_f32 v[82:83], v[34:35], v[224:225], v[82:83] op_sel_hi:[1,0,1]
v_cvt_pk_bf16_f32 v171, v82, v83
v_pk_fma_f32 v[60:61], v[28:29], v[220:221], v[60:61] op_sel_hi:[1,0,1]
v_cvt_pk_bf16_f32 v164, v60, v61
v_pk_fma_f32 v[62:63], v[30:31], v[220:221], v[62:63] op_sel_hi:[1,0,1]
v_cvt_pk_bf16_f32 v165, v62, v63
v_pk_fma_f32 v[76:77], v[32:33], v[220:221], v[76:77] op_sel_hi:[1,0,1]
v_cvt_pk_bf16_f32 v166, v76, v77
v_pk_fma_f32 v[78:79], v[34:35], v[220:221], v[78:79] op_sel_hi:[1,0,1]
s_waitcnt lgkmcnt(0)
s_barrier
v_cvt_pk_bf16_f32 v167, v78, v79
v_mfma_f32_16x16x32_bf16 v[120:123], v[196:199], v[176:179], v[50:53]
ds_read_b128 v[180:183], v9
v_mfma_f32_16x16x32_bf16 v[104:107], v[192:195], v[176:179], v[46:49]
ds_read_b64 v[200:201], v9 offset:1024
v_mfma_f32_16x16x32_bf16 v[116:119], v[192:195], v[172:175], v[50:53]
ds_read_b64 v[210:211], v9 offset:1032
v_mfma_f32_16x16x32_bf16 v[100:103], v[188:191], v[172:175], v[46:49]
ds_read_b128 v[240:243], v11 offset:384
v_mfma_f32_16x16x32_bf16 v[112:115], v[188:191], v[168:171], v[50:53]
ds_read_b128 v[244:247], v11 offset:1408
v_mfma_f32_16x16x32_bf16 v[96:99], v[184:187], v[168:171], v[46:49]
ds_read_b128 v[28:31], v11 offset:320
v_max3_f32 v88, v104, v105, v106
v_mfma_f32_16x16x32_bf16 v[108:111], v[184:187], v[164:167], v[50:53]
ds_read_b128 v[32:35], v11 offset:1344
v_max3_f32 v89, v107, v120, v121
v_max3_f32 v88, v88, v122, v123
v_max_f32 v90, v88, v89
v_max_f32 v89, v88, v89
v_max3_f32 v84, v100, v101, v102
v_max3_f32 v85, v103, v116, v117
s_waitcnt lgkmcnt(6)
v_mfma_f32_16x16x32_bf16 v[92:95], v[180:183], v[164:167], v[46:49]
ds_read_b128 v[36:39], v11 offset:256
v_permlane16_swap_b32 v90, v89
MAA 136,12,96
ds_read_b128 v[40:43], v11 offset:1280
v_max_f32 v88, v90, v89
MAA 136,32,100
v_max_f32 v89, v90, v89
v_max3_f32 v84, v84, v118, v119
MAA 136,52,160
v_permlane32_swap_b32 v88, v89
MAA 136,72,164
v_max_f32 v88, v88, v89
v_mul_f32 v88, v88, v234
MAA 152,72,172
v_max_f32 v86, v84, v85
v_max_f32 v85, v84, v85
MAA 152,52,168
s_nop 0
v_permlane16_swap_b32 v86, v85
MAA 152,32,124
v_max_f32 v84, v86, v85
v_max_f32 v85, v86, v85
MAA 152,12,120
s_nop 0
v_permlane32_swap_b32 v84, v85
v_max3_f32 v80, v96, v97, v98
v_max_f32 v84, v84, v85
v_mul_f32 v84, v84, v230
v_max3_f32 v81, v99, v112, v113
v_max3_f32 v80, v80, v114, v115
v_max_f32 v82, v80, v81
v_max_f32 v81, v80, v81
v_max3_f32 v76, v92, v93, v94
v_max3_f32 v77, v95, v108, v109
v_permlane16_swap_b32 v82, v81
v_max3_f32 v76, v76, v110, v111
v_max_f32 v80, v82, v81
v_max_f32 v81, v82, v81
v_max_f32 v78, v76, v77
v_max_f32 v77, v76, v77
v_permlane32_swap_b32 v80, v81
v_pk_fma_f32 v[104:105], v[104:105], v[234:235], v[88:89] op_sel_hi:[1,0,0] neg_lo:[0,0,1] neg_hi:[0,0,1]
v_max_f32 v80, v80, v81
v_mul_f32 v80, v80, v226
v_permlane16_swap_b32 v78, v77
v_pk_fma_f32 v[106:107], v[106:107], v[234:235], v[88:89] op_sel_hi:[1,0,0] neg_lo:[0,0,1] neg_hi:[0,0,1]
v_max_f32 v76, v78, v77
v_max_f32 v77, v78, v77
v_pk_fma_f32 v[120:121], v[120:121], v[234:235], v[88:89] op_sel_hi:[1,0,0] neg_lo:[0,0,1] neg_hi:[0,0,1]
v_pk_fma_f32 v[122:123], v[122:123], v[234:235], v[88:89] op_sel_hi:[1,0,0] neg_lo:[0,0,1] neg_hi:[0,0,1]
v_permlane32_swap_b32 v76, v77
v_pk_fma_f32 v[100:101], v[100:101], v[230:231], v[84:85] op_sel_hi:[1,0,0] neg_lo:[0,0,1] neg_hi:[0,0,1]
v_max_f32 v76, v76, v77
v_mul_f32 v76, v76, v222
v_pk_fma_f32 v[102:103], v[102:103], v[230:231], v[84:85] op_sel_hi:[1,0,0] neg_lo:[0,0,1] neg_hi:[0,0,1]
v_pk_fma_f32 v[116:117], v[116:117], v[230:231], v[84:85] op_sel_hi:[1,0,0] neg_lo:[0,0,1] neg_hi:[0,0,1]
v_pk_fma_f32 v[118:119], v[118:119], v[230:231], v[84:85] op_sel_hi:[1,0,0] neg_lo:[0,0,1] neg_hi:[0,0,1]
v_pk_fma_f32 v[96:97], v[96:97], v[226:227], v[80:81] op_sel_hi:[1,0,0] neg_lo:[0,0,1] neg_hi:[0,0,1]
v_pk_fma_f32 v[98:99], v[98:99], v[226:227], v[80:81] op_sel_hi:[1,0,0] neg_lo:[0,0,1] neg_hi:[0,0,1]
v_pk_fma_f32 v[112:113], v[112:113], v[226:227], v[80:81] op_sel_hi:[1,0,0] neg_lo:[0,0,1] neg_hi:[0,0,1]
v_pk_fma_f32 v[114:115], v[114:115], v[226:227], v[80:81] op_sel_hi:[1,0,0] neg_lo:[0,0,1] neg_hi:[0,0,1]
v_pk_fma_f32 v[92:93], v[92:93], v[222:223], v[76:77] op_sel_hi:[1,0,0] neg_lo:[0,0,1] neg_hi:[0,0,1]
v_pk_fma_f32 v[94:95], v[94:95], v[222:223], v[76:77] op_sel_hi:[1,0,0] neg_lo:[0,0,1] neg_hi:[0,0,1]
v_pk_fma_f32 v[108:109], v[108:109], v[222:223], v[76:77] op_sel_hi:[1,0,0] neg_lo:[0,0,1] neg_hi:[0,0,1]
v_pk_fma_f32 v[110:111], v[110:111], v[222:223], v[76:77] op_sel_hi:[1,0,0] neg_lo:[0,0,1] neg_hi:[0,0,1]
v_pk_fma_f32 v[136:137], v[18:19], v[44:45], v[136:137] op_sel_hi:[1,0,1]
v_pk_mul_f32 v[136:137], v[136:137], v[22:23]
v_pk_fma_f32 v[138:139], v[20:21], v[44:45], v[138:139] op_sel_hi:[1,0,1]
v_pk_mul_f32 v[138:139], v[138:139], v[24:25]
v_pk_fma_f32 v[152:153], v[18:19], v[44:45], v[152:153] op_sel:[0,1,0] op_sel_hi:[1,1,1]
v_pk_mul_f32 v[152:153], v[152:153], v[22:23]
v_pk_fma_f32 v[154:155], v[20:21], v[44:45], v[154:155] op_sel:[0,1,0] op_sel_hi:[1,1,1]
v_pk_mul_f32 v[154:155], v[154:155], v[24:25]
v_exp_f32 v104, v104
s_nop 0
MAA 132,8,96
v_exp_f32 v105, v105
MAA 132,28,100
v_exp_f32 v106, v106
MAA 132,48,160
v_exp_f32 v107, v107
MAA 132,68,164
v_exp_f32 v120, v120
MAA 148,68,172
v_exp_f32 v121, v121
MAA 148,48,168
v_exp_f32 v122, v122
MAA 148,28,124
v_exp_f32 v123, v123
MAA 148,8,120
v_exp_f32 v100, v100
MAA 128,4,96
v_exp_f32 v101, v101
MAA 128,24,100
v_exp_f32 v102, v102
MAA 128,44,160
v_exp_f32 v103, v103
MAA 128,64,164
v_exp_f32 v116, v116
MAA 144,64,172
v_exp_f32 v117, v117
MAA 144,44,168
v_exp_f32 v118, v118
MAA 144,24,124
v_exp_f32 v119, v119
MAA 144,4,120
v_exp_f32 v96, v96
MAA 124,0,96
v_exp_f32 v97, v97
MAA 124,20,100
v_exp_f32 v98, v98
MAA 124,40,160
v_exp_f32 v99, v99
MAA 124,60,164
v_exp_f32 v112, v112
MAA 140,60,172
v_exp_f32 v113, v113
MAA 140,40,168
v_exp_f32 v114, v114
MAA 140,20,124
v_exp_f32 v115, v115
MAA 140,0,120
v_cvt_pk_bf16_f32 v72, v104, v105
v_cvt_pk_bf16_f32 v73, v106, v107
v_cvt_pk_bf16_f32 v74, v120, v121
v_cvt_pk_bf16_f32 v75, v122, v123
v_cvt_pk_bf16_f32 v68, v100, v101
v_cvt_pk_bf16_f32 v69, v102, v103
v_cvt_pk_bf16_f32 v70, v116, v117
v_cvt_pk_bf16_f32 v71, v118, v119
v_cvt_pk_bf16_f32 v64, v96, v97
v_cvt_pk_bf16_f32 v65, v98, v99
v_cvt_pk_bf16_f32 v66, v112, v113
v_cvt_pk_bf16_f32 v67, v114, v115
v_cvt_pk_bf16_f32 v208, v136, v137
v_cvt_pk_bf16_f32 v209, v138, v139
v_cvt_pk_bf16_f32 v218, v152, v153
v_cvt_pk_bf16_f32 v219, v154, v155
s_waitcnt lgkmcnt(5)
v_pk_fma_f32 v[132:133], v[240:241], v[44:45], v[132:133] op_sel_hi:[1,0,1]
s_waitcnt lgkmcnt(4)
v_pk_mul_f32 v[132:133], v[132:133], v[244:245]
v_cvt_pk_bf16_f32 v206, v132, v133
v_pk_fma_f32 v[134:135], v[242:243], v[44:45], v[134:135] op_sel_hi:[1,0,1]
v_pk_mul_f32 v[134:135], v[134:135], v[246:247]
v_cvt_pk_bf16_f32 v207, v134, v135
v_pk_fma_f32 v[148:149], v[240:241], v[44:45], v[148:149] op_sel:[0,1,0] op_sel_hi:[1,1,1]
v_pk_mul_f32 v[148:149], v[148:149], v[244:245]
v_cvt_pk_bf16_f32 v216, v148, v149
v_pk_fma_f32 v[150:151], v[242:243], v[44:45], v[150:151] op_sel:[0,1,0] op_sel_hi:[1,1,1]
v_pk_mul_f32 v[150:151], v[150:151], v[246:247]
v_cvt_pk_bf16_f32 v217, v150, v151
s_waitcnt lgkmcnt(3)
v_pk_fma_f32 v[128:129], v[28:29], v[44:45], v[128:129] op_sel_hi:[1,0,1]
s_waitcnt lgkmcnt(2)
v_pk_mul_f32 v[128:129], v[128:129], v[32:33]
v_cvt_pk_bf16_f32 v204, v128, v129
v_pk_fma_f32 v[130:131], v[30:31], v[44:45], v[130:131] op_sel_hi:[1,0,1]
v_pk_mul_f32 v[130:131], v[130:131], v[34:35]
v_cvt_pk_bf16_f32 v205, v130, v131
v_pk_fma_f32 v[144:145], v[28:29], v[44:45], v[144:145] op_sel:[0,1,0] op_sel_hi:[1,1,1]
v_pk_mul_f32 v[144:145], v[144:145], v[32:33]
v_cvt_pk_bf16_f32 v214, v144, v145
v_pk_fma_f32 v[146:147], v[30:31], v[44:45], v[146:147] op_sel:[0,1,0] op_sel_hi:[1,1,1]
v_pk_mul_f32 v[146:147], v[146:147], v[34:35]
v_cvt_pk_bf16_f32 v215, v146, v147
s_waitcnt lgkmcnt(1)
v_pk_fma_f32 v[124:125], v[36:37], v[44:45], v[124:125] op_sel_hi:[1,0,1]
s_waitcnt lgkmcnt(0)
v_pk_mul_f32 v[124:125], v[124:125], v[40:41]
v_cvt_pk_bf16_f32 v202, v124, v125
v_pk_fma_f32 v[126:127], v[38:39], v[44:45], v[126:127] op_sel_hi:[1,0,1]
v_pk_mul_f32 v[126:127], v[126:127], v[42:43]
v_cvt_pk_bf16_f32 v203, v126, v127
v_pk_fma_f32 v[140:141], v[36:37], v[44:45], v[140:141] op_sel:[0,1,0] op_sel_hi:[1,1,1]
v_pk_mul_f32 v[140:141], v[140:141], v[40:41]
v_cvt_pk_bf16_f32 v212, v140, v141
v_pk_fma_f32 v[142:143], v[38:39], v[44:45], v[142:143] op_sel:[0,1,0] op_sel_hi:[1,1,1]
v_pk_mul_f32 v[142:143], v[142:143], v[42:43]
v_cvt_pk_bf16_f32 v213, v142, v143
s_nop 0
v_mfma_f32_16x16x32_bf16 v[88:91], v[248:251], v[72:75], 0
v_exp_f32 v92, v92
v_mfma_f32_16x16x32_bf16 v[104:107], v[206:209], v[72:75], 0
v_exp_f32 v93, v93
v_mfma_f32_16x16x32_bf16 v[120:123], v[216:219], v[72:75], 0
v_exp_f32 v94, v94
v_mfma_f32_16x16x32_bf16 v[84:87], v[248:251], v[68:71], 0
v_exp_f32 v95, v95
v_mfma_f32_16x16x32_bf16 v[100:103], v[204:207], v[68:71], 0
v_exp_f32 v108, v108
v_mfma_f32_16x16x32_bf16 v[116:119], v[214:217], v[68:71], 0
v_exp_f32 v109, v109
v_mfma_f32_16x16x32_bf16 v[80:83], v[248:251], v[64:67], 0
v_exp_f32 v110, v110
v_mfma_f32_16x16x32_bf16 v[96:99], v[202:205], v[64:67], 0
v_exp_f32 v111, v111
v_mfma_f32_16x16x32_bf16 v[112:115], v[212:215], v[64:67], 0
v_cvt_pk_bf16_f32 v60, v92, v93
v_cvt_pk_bf16_f32 v61, v94, v95
v_cvt_pk_bf16_f32 v62, v108, v109
v_cvt_pk_bf16_f32 v63, v110, v111
v_rcp_f32 v88, v88
v_rcp_f32 v84, v84
v_mfma_f32_16x16x32_bf16 v[76:79], v[248:251], v[60:63], 0
v_rcp_f32 v80, v80
v_mfma_f32_16x16x32_bf16 v[92:95], v[200:203], v[60:63], 0
v_mfma_f32_16x16x32_bf16 v[108:111], v[210:213], v[60:63], 0
s_nop 4
v_rcp_f32 v76, v76
v_pk_mul_f32 v[104:105], v[104:105], v[88:89] op_sel_hi:[1,0]
v_pk_mul_f32 v[106:107], v[106:107], v[88:89] op_sel_hi:[1,0]
v_pk_mul_f32 v[120:121], v[120:121], v[88:89] op_sel_hi:[1,0]
v_pk_mul_f32 v[122:123], v[122:123], v[88:89] op_sel_hi:[1,0]
v_cvt_pk_bf16_f32 v176, v104, v105
v_cvt_pk_bf16_f32 v177, v106, v107
v_cvt_pk_bf16_f32 v178, v120, v121
v_cvt_pk_bf16_f32 v179, v122, v123
buffer_store_dwordx4 v[176:179], v4, s[16:19], s74 offen offset:3072 sc1
v_pk_mul_f32 v[100:101], v[100:101], v[84:85] op_sel_hi:[1,0]
v_pk_mul_f32 v[102:103], v[102:103], v[84:85] op_sel_hi:[1,0]
v_pk_mul_f32 v[116:117], v[116:117], v[84:85] op_sel_hi:[1,0]
v_pk_mul_f32 v[118:119], v[118:119], v[84:85] op_sel_hi:[1,0]
v_cvt_pk_bf16_f32 v172, v100, v101
v_cvt_pk_bf16_f32 v173, v102, v103
v_cvt_pk_bf16_f32 v174, v116, v117
v_cvt_pk_bf16_f32 v175, v118, v119
buffer_store_dwordx4 v[172:175], v4, s[16:19], s74 offen offset:2048 sc1
v_pk_mul_f32 v[96:97], v[96:97], v[80:81] op_sel_hi:[1,0]
v_pk_mul_f32 v[98:99], v[98:99], v[80:81] op_sel_hi:[1,0]
v_pk_mul_f32 v[112:113], v[112:113], v[80:81] op_sel_hi:[1,0]
v_pk_mul_f32 v[114:115], v[114:115], v[80:81] op_sel_hi:[1,0]
v_cvt_pk_bf16_f32 v168, v96, v97
v_cvt_pk_bf16_f32 v169, v98, v99
v_cvt_pk_bf16_f32 v170, v112, v113
v_cvt_pk_bf16_f32 v171, v114, v115
buffer_store_dwordx4 v[168:171], v4, s[16:19], s74 offen offset:1024 sc1
v_pk_mul_f32 v[92:93], v[92:93], v[76:77] op_sel_hi:[1,0]
v_pk_mul_f32 v[94:95], v[94:95], v[76:77] op_sel_hi:[1,0]
v_pk_mul_f32 v[108:109], v[108:109], v[76:77] op_sel_hi:[1,0]
v_pk_mul_f32 v[110:111], v[110:111], v[76:77] op_sel_hi:[1,0]
v_cvt_pk_bf16_f32 v164, v92, v93
v_cvt_pk_bf16_f32 v165, v94, v95
v_cvt_pk_bf16_f32 v166, v108, v109
v_cvt_pk_bf16_f32 v167, v110, v111
buffer_store_dwordx4 v[164:167], v4, s[16:19], s74 offen sc1
s_nop 1
.Lqkve56:
s_lshl_b32 s62, s3, 11
s_add_u32 s62, s62, s84
v_lshl_add_u32 v4, v1, 4, s62
v_lshrrev_b32 v2, 3, v1
v_cmp_eq_u32 vcc, 3, v2
v_add_u32 v2, 67108480, v4
s_nop 0
v_cndmask_b32 v4, v4, v2, vcc
v_bfe_u32 v8, v1, 3, 2
v_mul_u32_u24 v8, 2080, v8
v_bfe_u32 v2, v1, 2, 1
v_lshl_add_u32 v8, v2, 7, v8
v_bfe_u32 v2, v1, 5, 1
v_lshl_add_u32 v8, v2, 8, v8
v_and_b32 v2, 3, v1
v_lshl_add_u32 v8, v2, 3, v8
s_mov_b32 s57, 66560
v_add_u32 v7, s57, v8
s_lshr_b32 s54, s87, 17
s_lshl_b32 s54, s54, 18
s_add_u32 s54, s54, 37748736
s_mov_b32 s52, s54
s_add_u32 s53, s54, 131072
v_accvgpr_read_b32 v32, a224
v_accvgpr_read_b32 v33, a225
v_accvgpr_read_b32 v34, a226
v_accvgpr_read_b32 v35, a227
v_accvgpr_read_b32 v36, a228
v_accvgpr_read_b32 v37, a229
v_accvgpr_read_b32 v38, a230
v_accvgpr_read_b32 v39, a231
v_accvgpr_read_b32 v40, a232
v_accvgpr_read_b32 v41, a233
v_accvgpr_read_b32 v42, a234
v_accvgpr_read_b32 v43, a235
v_accvgpr_read_b32 v44, a236
v_accvgpr_read_b32 v45, a237
v_accvgpr_read_b32 v46, a238
v_accvgpr_read_b32 v47, a239
v_accvgpr_read_b32 v48, a240
v_accvgpr_read_b32 v49, a241
v_accvgpr_read_b32 v50, a242
v_accvgpr_read_b32 v51, a243
v_accvgpr_read_b32 v52, a244
v_accvgpr_read_b32 v53, a245
v_accvgpr_read_b32 v54, a246
v_accvgpr_read_b32 v55, a247
v_accvgpr_read_b32 v56, a248
v_accvgpr_read_b32 v57, a249
v_accvgpr_read_b32 v58, a250
v_accvgpr_read_b32 v59, a251
v_accvgpr_read_b32 v60, a252
v_accvgpr_read_b32 v61, a253
v_accvgpr_read_b32 v62, a254
v_accvgpr_read_b32 v63, a255
s_lshl_b32 s62, s8, 10
s_add_u32 s62, s62, 30490624
s_lshl_b32 s64, s6, 10
s_add_u32 s64, s64, 30490624
s_lshr_b32 s67, s5, 2
s_and_b32 s67, s67, 3
s_lshl_b32 s67, s67, 7
s_add_u32 s64, s64, s67
v_lshl_add_u32 v252, v1, 7, s62
v_mov_b32 v253, s64
v_mov_b32 v255, 1
s_waitcnt vmcnt(0) lgkmcnt(0)
s_cmp_lg_u32 s3, 1
s_barrier
s_cbranch_scc1 .Lfirst61
s_mov_b64 exec, 15
buffer_atomic_add v255, v252, s[16:19], 0 offen
s_mov_b64 exec, 1
v_mov_b32 v254, 0
buffer_atomic_add v254, v253, s[16:19], 0 offen sc0
s_mov_b64 exec, -1
.Lfirst61:
s_add_u32 m0, s59, 116480
s_xor_b32 s58, s87, 786432
buffer_load_dwordx4 v5, s[24:27], s58 offen lds
buffer_load_dwordx4 v6, s[24:27], s58 offen offset:1024 lds
s_add_u32 m0, s59, 124800
s_xor_b32 s58, s87, 917504
buffer_load_dwordx4 v5, s[24:27], s58 offen lds
buffer_load_dwordx4 v6, s[24:27], s58 offen offset:1024 lds
s_add_u32 m0, s59, 33280
s_xor_b32 s58, s87, 1572864
buffer_load_dwordx4 v5, s[24:27], s58 offen lds
buffer_load_dwordx4 v6, s[24:27], s58 offen offset:1024 lds
s_add_u32 m0, s59, 41600
s_xor_b32 s58, s87, 1703936
buffer_load_dwordx4 v5, s[24:27], s58 offen lds
buffer_load_dwordx4 v6, s[24:27], s58 offen offset:1024 lds
s_add_u32 m0, s59, 49920
s_xor_b32 s58, s87, 1835008
buffer_load_dwordx4 v5, s[24:27], s58 offen lds
buffer_load_dwordx4 v6, s[24:27], s58 offen offset:1024 lds
s_cmp_lg_u32 s3, 1
.Lpad28:
s_cbranch_execz .Lnopoll53r
s_cbranch_scc1 .Lnopoll60
s_mov_b64 exec, 1
s_mov_b32 s15, 0
v_mov_b32 v255, 0
buffer_atomic_add v255, v253, s[16:19], 0 offen sc0
s_waitcnt vmcnt(11)
v_cmp_gt_u32 vcc, 16, v254
s_nop 0
s_cbranch_vccz .Lnopoll60r
.Lpoll59:
s_waitcnt vmcnt(0)
v_cmp_gt_u32 vcc, 16, v255
s_add_u32 s15, s15, 1
s_cbranch_vccz .Lnopoll60r
v_mov_b32 v255, 0
buffer_atomic_add v255, v253, s[16:19], 0 offen sc0
s_cmp_le_u32 s15, 100000
s_cbranch_scc1 .Lpoll59
s_branch .Lnopoll60r
.Lnopoll60:
s_mov_b64 exec, 0
s_cmp_eq_u32 s3, 2
s_cbranch_scc1 .Lpad29
s_cmp_eq_u32 s3, 3
s_cbranch_scc1 .Lpad30
s_branch .Lpad31
.Lnopoll60r:
s_mov_b64 exec, -1
s_waitcnt vmcnt(11)
s_barrier
buffer_load_dwordx4 v[64:67], v4, s[16:19], s52 offen sc1
buffer_load_dwordx4 v[68:71], v4, s[16:19], s52 offen offset:1024 sc1
s_xor_b32 s52, s54, 262144
buffer_load_dwordx4 v[72:75], v4, s[16:19], s53 offen sc1
buffer_load_dwordx4 v[76:79], v4, s[16:19], s53 offen offset:1024 sc1
s_xor_b32 s53, s54, 393216
buffer_load_dwordx4 v[80:83], v4, s[16:19], s52 offen sc1
buffer_load_dwordx4 v[84:87], v4, s[16:19], s52 offen offset:1024 sc1
s_xor_b32 s52, s54, 524288
buffer_load_dwordx4 v[88:91], v4, s[16:19], s53 offen sc1
buffer_load_dwordx4 v[92:95], v4, s[16:19], s53 offen offset:1024 sc1
s_xor_b32 s53, s54, 655360
buffer_load_dwordx4 v[96:99], v4, s[16:19], s52 offen sc1
buffer_load_dwordx4 v[100:103], v4, s[16:19], s52 offen offset:1024 sc1
s_xor_b32 s52, s54, 786432
buffer_load_dwordx4 v[104:107], v4, s[16:19], s53 offen sc1
buffer_load_dwordx4 v[108:111], v4, s[16:19], s53 offen offset:1024 sc1
s_xor_b32 s53, s54, 917504
ds_read_b64_tr_b16 a[0:1], v7
TR 2,7,512
TR 16,7,1024
TR 18,7,1536
TR 4,7,32
TR 6,7,544
TR 20,7,1056
TR 22,7,1568
TR 8,7,64
TR 10,7,576
TR 24,7,1088
TR 26,7,1600
TR 12,7,96
TR 14,7,608
TR 28,7,1120
TR 30,7,1632
s_lshl_b32 s62, s49, 3
s_add_u32 s62, s62, s48
s_mul_i32 s62, s62, 28672
s_add_u32 s62, s62, s51
v_lshrrev_b32 v12, 4, v1
v_mul_u32_u24 v12, 57344, v12
v_and_b32 v2, 15, v1
v_lshl_add_u32 v12, v2, 4, v12
v_add_u32 v12, s62, v12
v_add_u32 v13, 6112, v12
v_add_u32 v14, 12224, v12
v_add_u32 v15, 18336, v12
s_mul_i32 s59, s3, 4224
s_mov_b32 s58, 0
s_waitcnt vmcnt(8) lgkmcnt(14)
MAV 32,0,64
TR 32,7,8320
s_waitcnt lgkmcnt(13)
MAV 32,16,72
buffer_load_dwordx4 v[112:115], v4, s[16:19], s52 offen sc1
MAV 48,16,76
TR 34,7,8832
MAV 48,0,68
TR 48,7,9344
TR 50,7,9856
s_waitcnt lgkmcnt(14)
MAV 52,4,68
TR 36,7,8352
s_waitcnt lgkmcnt(13)
MAV 52,20,76
buffer_load_dwordx4 v[116:119], v4, s[16:19], s52 offen offset:1024 sc1
MAV 36,20,72
TR 38,7,8864
s_xor_b32 s52, s54, 1048576
MAV 36,4,64
TR 52,7,9376
TR 54,7,9888
s_waitcnt lgkmcnt(14)
MAV 40,8,64
TR 40,7,8384
s_waitcnt lgkmcnt(13)
MAV 40,24,72
buffer_load_dwordx4 v[120:123], v4, s[16:19], s53 offen sc1
MAV 56,24,76
TR 42,7,8896
MAV 56,8,68
TR 56,7,9408
TR 58,7,9920
s_waitcnt lgkmcnt(14)
MAV 60,12,68
TR 44,7,8416
s_waitcnt lgkmcnt(13)
MAV 60,28,76
buffer_load_dwordx4 v[124:127], v4, s[16:19], s53 offen offset:1024 sc1
MAV 44,28,72
TR 46,7,8928
s_xor_b32 s53, s54, 1179648
MAV 44,12,64
TR 60,7,9440
TR 62,7,9952
s_waitcnt vmcnt(8) lgkmcnt(8)
MAV 32,32,80
TR 0,7,16640
MAV 32,48,88
buffer_load_dwordx4 v[64:67], v4, s[16:19], s52 offen sc1
MAV 48,48,92
TR 2,7,17152
MAV 48,32,84
TR 16,7,17664
TR 18,7,18176
MAV 52,36,84
TR 4,7,16672
MAV 52,52,92
buffer_load_dwordx4 v[68:71], v4, s[16:19], s52 offen offset:1024 sc1
MAV 36,52,88
TR 6,7,17184
s_xor_b32 s52, s54, 1310720
MAV 36,36,80
TR 20,7,17696
TR 22,7,18208
s_waitcnt lgkmcnt(8)
MAV 40,40,80
TR 8,7,16704
MAV 40,56,88
buffer_load_dwordx4 v[72:75], v4, s[16:19], s53 offen sc1
MAV 56,56,92
TR 10,7,17216
MAV 56,40,84
TR 24,7,17728
TR 26,7,18240
MAV 60,44,84
TR 12,7,16736
MAV 60,60,92
buffer_load_dwordx4 v[76:79], v4, s[16:19], s53 offen offset:1024 sc1
MAV 44,60,88
TR 14,7,17248
s_xor_b32 s53, s54, 1441792
MAV 44,44,80
TR 28,7,17760
TR 30,7,18272
s_waitcnt vmcnt(8) lgkmcnt(8)
MAV 32,0,96
TR 32,7,24960
MAV 32,16,104
buffer_load_dwordx4 v[80:83], v4, s[16:19], s52 offen sc1
MAV 48,16,108
TR 34,7,25472
MAV 48,0,100
TR 48,7,25984
TR 50,7,26496
MAV 52,4,100
TR 36,7,24992
MAV 52,20,108
buffer_load_dwordx4 v[84:87], v4, s[16:19], s52 offen offset:1024 sc1
MAV 36,20,104
TR 38,7,25504
s_xor_b32 s52, s54, 1572864
MAV 36,4,96
TR 52,7,26016
TR 54,7,26528
s_waitcnt lgkmcnt(8)
MAV 40,8,96
TR 40,7,25024
MAV 40,24,104
buffer_load_dwordx4 v[88:91], v4, s[16:19], s53 offen sc1
MAV 56,24,108
TR 42,7,25536
MAV 56,8,100
TR 56,7,26048
TR 58,7,26560
MAV 60,12,100
TR 44,7,25056
MAV 60,28,108
buffer_load_dwordx4 v[92:95], v4, s[16:19], s53 offen offset:1024 sc1
MAV 44,28,104
TR 46,7,25568
s_xor_b32 s53, s54, 1703936
MAV 44,12,96
TR 60,7,26080
TR 62,7,26592
s_barrier
s_waitcnt vmcnt(8) lgkmcnt(8)
MAV 32,32,112
TR 0,7,33280
MAV 32,48,120
buffer_load_dwordx4 v[96:99], v4, s[16:19], s52 offen sc1
MAV 48,48,124
TR 2,7,33792
MAV 48,32,116
TR 16,7,34304
TR 18,7,34816
MAV 52,36,116
TR 4,7,33312
MAV 52,52,124
buffer_load_dwordx4 v[100:103], v4, s[16:19], s52 offen offset:1024 sc1
MAV 36,52,120
TR 6,7,33824
s_xor_b32 s52, s54, 1835008
MAV 36,36,112
TR 20,7,34336
TR 22,7,34848
s_waitcnt lgkmcnt(8)
MAV 40,40,112
TR 8,7,33344
MAV 40,56,120
buffer_load_dwordx4 v[104:107], v4, s[16:19], s53 offen sc1
MAV 56,56,124
TR 10,7,33856
MAV 56,40,116
TR 24,7,34368
TR 26,7,34880
MAV 60,44,116
TR 12,7,33376
MAV 60,60,124
buffer_load_dwordx4 v[108:111], v4, s[16:19], s53 offen offset:1024 sc1
MAV 44,60,120
TR 14,7,33888
s_xor_b32 s53, s54, 1966080
MAV 44,44,112
TR 28,7,34400
TR 30,7,34912
s_waitcnt vmcnt(8) lgkmcnt(8)
MAV 32,0,64
TR 32,7,41600
MAV 32,16,72
buffer_load_dwordx4 v[112:115], v4, s[16:19], s52 offen sc1
MAV 48,16,76
TR 34,7,42112
MAV 48,0,68
TR 48,7,42624
TR 50,7,43136
MAV 52,4,68
TR 36,7,41632
MAV 52,20,76
buffer_load_dwordx4 v[116:119], v4, s[16:19], s52 offen offset:1024 sc1
MAV 36,20,72
TR 38,7,42144
s_xor_b32 s52, s54, 2097152
MAV 36,4,64
TR 52,7,42656
TR 54,7,43168
s_waitcnt lgkmcnt(8)
MAV 40,8,64
TR 40,7,41664
MAV 40,24,72
buffer_load_dwordx4 v[120:123], v4, s[16:19], s53 offen sc1
MAV 56,24,76
TR 42,7,42176
MAV 56,8,68
TR 56,7,42688
TR 58,7,43200
MAV 60,12,68
TR 44,7,41696
MAV 60,28,76
buffer_load_dwordx4 v[124:127], v4, s[16:19], s53 offen offset:1024 sc1
MAV 44,28,72
TR 46,7,42208
s_xor_b32 s53, s54, 2228224
MAV 44,12,64
TR 60,7,42720
TR 62,7,43232
s_waitcnt vmcnt(8) lgkmcnt(8)
MAV 32,32,80
TR 0,7,49920
MAV 32,48,88
buffer_load_dwordx4 v[64:67], v4, s[16:19], s52 offen sc1
MAV 48,48,92
TR 2,7,50432
MAV 48,32,84
TR 16,7,50944
TR 18,7,51456
MAV 52,36,84
TR 4,7,49952
MAV 52,52,92
buffer_load_dwordx4 v[68:71], v4, s[16:19], s52 offen offset:1024 sc1
MAV 36,52,88
TR 6,7,50464
s_xor_b32 s52, s54, 2359296
MAV 36,36,80
TR 20,7,50976
TR 22,7,51488
s_waitcnt lgkmcnt(8)
MAV 40,40,80
TR 8,7,49984
MAV 40,56,88
buffer_load_dwordx4 v[72:75], v4, s[16:19], s53 offen sc1
MAV 56,56,92
TR 10,7,50496
MAV 56,40,84
TR 24,7,51008
TR 26,7,51520
MAV 60,44,84
TR 12,7,50016
MAV 60,60,92
buffer_load_dwordx4 v[76:79], v4, s[16:19], s53 offen offset:1024 sc1
MAV 44,60,88
TR 14,7,50528
s_xor_b32 s53, s54, 2490368
MAV 44,44,80
TR 28,7,51040
TR 30,7,51552
s_waitcnt vmcnt(8) lgkmcnt(8)
MAV 32,0,96
TR 32,7,58240
MAV 32,16,104
buffer_load_dwordx4 v[80:83], v4, s[16:19], s52 offen sc1
MAV 48,16,108
TR 34,7,58752
MAV 48,0,100
TR 48,7,59264
TR 50,7,59776
MAV 52,4,100
TR 36,7,58272
MAV 52,20,108
buffer_load_dwordx4 v[84:87], v4, s[16:19], s52 offen offset:1024 sc1
MAV 36,20,104
TR 38,7,58784
s_xor_b32 s52, s54, 2621440
MAV 36,4,96
TR 52,7,59296
TR 54,7,59808
s_waitcnt lgkmcnt(8)
MAV 40,8,96
TR 40,7,58304
MAV 40,24,104
buffer_load_dwordx4 v[88:91], v4, s[16:19], s53 offen sc1
MAV 56,24,108
TR 42,7,58816
MAV 56,8,100
TR 56,7,59328
TR 58,7,59840
MAV 60,12,100
TR 44,7,58336
MAV 60,28,108
buffer_load_dwordx4 v[92:95], v4, s[16:19], s53 offen offset:1024 sc1
MAV 44,28,104
TR 46,7,58848
s_xor_b32 s53, s54, 2752512
MAV 44,12,96
TR 60,7,59360
TR 62,7,59872
s_xor_b32 s57, s57, 66560
v_add_u32 v7, s57, v8
s_waitcnt vmcnt(8) lgkmcnt(8)
MAV 32,32,112
ds_read_b64_tr_b16 a[0:1], v7
MAV 32,48,120
buffer_load_dwordx4 v[96:99], v4, s[16:19], s52 offen sc1
MAV 48,48,124
TR 2,7,512
MAV 48,32,116
TR 16,7,1024
TR 18,7,1536
MAV 52,36,116
TR 4,7,32
MAV 52,52,124
buffer_load_dwordx4 v[100:103], v4, s[16:19], s52 offen offset:1024 sc1
MAV 36,52,120
TR 6,7,544
s_xor_b32 s52, s54, 2883584
MAV 36,36,112
TR 20,7,1056
TR 22,7,1568
s_waitcnt lgkmcnt(8)
MAV 40,40,112
TR 8,7,64
MAV 40,56,120
buffer_load_dwordx4 v[104:107], v4, s[16:19], s53 offen sc1
MAV 56,56,124
TR 10,7,576
MAV 56,40,116
TR 24,7,1088
TR 26,7,1600
MAV 60,44,116
TR 12,7,96
MAV 60,60,124
buffer_load_dwordx4 v[108:111], v4, s[16:19], s53 offen offset:1024 sc1
MAV 44,60,120
TR 14,7,608
s_xor_b32 s53, s54, 3014656
MAV 44,44,112
TR 28,7,1120
TR 30,7,1632
s_waitcnt vmcnt(8) lgkmcnt(8)
MAV 32,0,64
TR 32,7,8320
MAV 32,16,72
buffer_load_dwordx4 v[112:115], v4, s[16:19], s52 offen sc1
MAV 48,16,76
TR 34,7,8832
MAV 48,0,68
TR 48,7,9344
TR 50,7,9856
MAV 52,4,68
TR 36,7,8352
MAV 52,20,76
buffer_load_dwordx4 v[116:119], v4, s[16:19], s52 offen offset:1024 sc1
MAV 36,20,72
TR 38,7,8864
s_xor_b32 s52, s54, 3145728
MAV 36,4,64
TR 52,7,9376
TR 54,7,9888
s_waitcnt lgkmcnt(8)
MAV 40,8,64
TR 40,7,8384
MAV 40,24,72
buffer_load_dwordx4 v[120:123], v4, s[16:19], s53 offen sc1
MAV 56,24,76
TR 42,7,8896
MAV 56,8,68
TR 56,7,9408
TR 58,7,9920
MAV 60,12,68
TR 44,7,8416
MAV 60,28,76
buffer_load_dwordx4 v[124:127], v4, s[16:19], s53 offen offset:1024 sc1
MAV 44,28,72
TR 46,7,8928
s_xor_b32 s53, s54, 3276800
MAV 44,12,64
TR 60,7,9440
TR 62,7,9952
s_waitcnt vmcnt(8) lgkmcnt(8)
MAV 32,32,80
TR 0,7,16640
MAV 32,48,88
buffer_load_dwordx4 v[64:67], v4, s[16:19], s52 offen sc1
MAV 48,48,92
TR 2,7,17152
MAV 48,32,84
TR 16,7,17664
TR 18,7,18176
MAV 52,36,84
TR 4,7,16672
MAV 52,52,92
buffer_load_dwordx4 v[68:71], v4, s[16:19], s52 offen offset:1024 sc1
MAV 36,52,88
TR 6,7,17184
s_xor_b32 s52, s54, 3407872
MAV 36,36,80
TR 20,7,17696
TR 22,7,18208
s_waitcnt lgkmcnt(8)
MAV 40,40,80
TR 8,7,16704
MAV 40,56,88
buffer_load_dwordx4 v[72:75], v4, s[16:19], s53 offen sc1
MAV 56,56,92
TR 10,7,17216
MAV 56,40,84
TR 24,7,17728
TR 26,7,18240
MAV 60,44,84
TR 12,7,16736
MAV 60,60,92
buffer_load_dwordx4 v[76:79], v4, s[16:19], s53 offen offset:1024 sc1
MAV 44,60,88
TR 14,7,17248
s_xor_b32 s53, s54, 3538944
MAV 44,44,80
TR 28,7,17760
TR 30,7,18272
s_waitcnt vmcnt(8) lgkmcnt(8)
MAV 32,0,96
TR 32,7,24960
MAV 32,16,104
buffer_load_dwordx4 v[80:83], v4, s[16:19], s52 offen sc1
MAV 48,16,108
TR 34,7,25472
MAV 48,0,100
TR 48,7,25984
TR 50,7,26496
MAV 52,4,100
TR 36,7,24992
MAV 52,20,108
buffer_load_dwordx4 v[84:87], v4, s[16:19], s52 offen offset:1024 sc1
MAV 36,20,104
TR 38,7,25504
s_xor_b32 s52, s54, 3670016
MAV 36,4,96
TR 52,7,26016
TR 54,7,26528
s_waitcnt lgkmcnt(8)
MAV 40,8,96
TR 40,7,25024
MAV 40,24,104
buffer_load_dwordx4 v[88:91], v4, s[16:19], s53 offen sc1
MAV 56,24,108
TR 42,7,25536
MAV 56,8,100
TR 56,7,26048
TR 58,7,26560
MAV 60,12,100
TR 44,7,25056
MAV 60,28,108
buffer_load_dwordx4 v[92:95], v4, s[16:19], s53 offen offset:1024 sc1
MAV 44,28,104
TR 46,7,25568
s_xor_b32 s53, s54, 3801088
MAV 44,12,96
TR 60,7,26080
TR 62,7,26592
s_waitcnt vmcnt(8) lgkmcnt(8)
MAV 32,32,112
TR 0,7,33280
MAV 32,48,120
buffer_load_dwordx4 v[96:99], v4, s[16:19], s52 offen sc1
MAV 48,48,124
TR 2,7,33792
MAV 48,32,116
TR 16,7,34304
TR 18,7,34816
MAV 52,36,116
TR 4,7,33312
MAV 52,52,124
buffer_load_dwordx4 v[100:103], v4, s[16:19], s52 offen offset:1024 sc1
MAV 36,52,120
TR 6,7,33824
s_xor_b32 s52, s54, 3932160
MAV 36,36,112
TR 20,7,34336
.Lpad29:
s_cbranch_execz .Lpad32
TR 22,7,34848
s_waitcnt lgkmcnt(8)
MAV 40,40,112
TR 8,7,33344
MAV 40,56,120
buffer_load_dwordx4 v[104:107], v4, s[16:19], s53 offen sc1
MAV 56,56,124
TR 10,7,33856
MAV 56,40,116
TR 24,7,34368
TR 26,7,34880
MAV 60,44,116
TR 12,7,33376
MAV 60,60,124
buffer_load_dwordx4 v[108:111], v4, s[16:19], s53 offen offset:1024 sc1
MAV 44,60,120
TR 14,7,33888
s_xor_b32 s53, s54, 4063232
MAV 44,44,112
TR 28,7,34400
TR 30,7,34912
s_waitcnt vmcnt(8) lgkmcnt(8)
MAV 32,0,64
TR 32,7,41600
MAV 32,16,72
buffer_load_dwordx4 v[112:115], v4, s[16:19], s52 offen sc1
MAV 48,16,76
TR 34,7,42112
MAV 48,0,68
TR 48,7,42624
TR 50,7,43136
MAV 52,4,68
TR 36,7,41632
MAV 52,20,76
buffer_load_dwordx4 v[116:119], v4, s[16:19], s52 offen offset:1024 sc1
MAV 36,20,72
TR 38,7,42144
MAV 36,4,64
TR 52,7,42656
TR 54,7,43168
s_waitcnt lgkmcnt(8)
MAV 40,8,64
TR 40,7,41664
MAV 40,24,72
buffer_load_dwordx4 v[120:123], v4, s[16:19], s53 offen sc1
MAV 56,24,76
TR 42,7,42176
MAV 56,8,68
TR 56,7,42688
TR 58,7,43200
MAV 60,12,68
TR 44,7,41696
MAV 60,28,76
buffer_load_dwordx4 v[124:127], v4, s[16:19], s53 offen offset:1024 sc1
MAV 44,28,72
TR 46,7,42208
MAV 44,12,64
TR 60,7,42720
TR 62,7,43232
s_barrier
s_waitcnt vmcnt(8) lgkmcnt(8)
MAV 32,32,80
TR 0,7,49920
s_add_u32 m0, s59, 84480
MAV 32,48,88
buffer_load_dwordx4 v12, s[32:35], s58 offen lds
MAV 48,48,92
TR 2,7,50432
MAV 48,32,84
TR 16,7,50944
TR 18,7,51456
MAV 52,36,84
TR 4,7,49952
MAV 52,52,92
TR 6,7,50464
TR 20,7,50976
MAV 36,52,88
TR 22,7,51488
MAV 36,36,80
TR 8,7,49984
s_waitcnt lgkmcnt(9)
MAV 40,40,80
TR 10,7,50496
MAV 40,56,88
buffer_load_dwordx4 v13, s[32:35], s58 offen offset:1056 lds
MAV 56,56,92
TR 24,7,51008
MAV 56,40,84
buffer_load_dwordx4 v14, s[32:35], s58 offen offset:2112 lds
MAV 60,44,84
TR 26,7,51520
MAV 60,60,92
TR 12,7,50016
TR 14,7,50528
MAV 44,60,88
TR 28,7,51040
MAV 44,44,80
TR 30,7,51552
s_waitcnt vmcnt(7) lgkmcnt(8)
MAV 32,0,96
TR 32,7,58240
MAV 32,16,104
buffer_load_dwordx4 v15, s[32:35], s58 offen offset:3168 lds
MAV 48,16,108
TR 34,7,58752
MAV 48,0,100
TR 48,7,59264
TR 50,7,59776
MAV 52,4,100
TR 36,7,58272
MAV 52,20,108
TR 38,7,58784
TR 52,7,59296
MAV 36,20,104
TR 54,7,59808
MAV 36,4,96
TR 40,7,58304
s_waitcnt lgkmcnt(9)
MAV 40,8,96
TR 42,7,58816
s_add_u32 m0, s59, 101376
MAV 40,24,104
buffer_load_dwordx4 v12, s[80:83], s58 offen lds
MAV 56,24,108
TR 56,7,59328
MAV 56,8,100
buffer_load_dwordx4 v13, s[80:83], s58 offen offset:1056 lds
MAV 60,12,100
TR 58,7,59840
MAV 60,28,108
TR 44,7,58336
TR 46,7,58848
MAV 44,28,104
TR 60,7,59360
MAV 44,12,96
TR 62,7,59872
s_waitcnt vmcnt(9) lgkmcnt(14)
MAV 32,32,112
buffer_load_dwordx4 v14, s[80:83], s58 offen offset:2112 lds
s_waitcnt vmcnt(8) lgkmcnt(12)
MAV 32,48,120
s_lshl_b32 s64, s6, 14
s_lshl_b32 s65, s49, 13
s_add_u32 s64, s64, s65
s_waitcnt vmcnt(7)
MAV 48,48,124
s_lshl_b32 s65, s7, 9
s_add_u32 s64, s64, s65
s_lshl_b32 s65, s48, 8
MAV 48,32,116
s_add_u32 s64, s64, s65
s_add_u32 s64, s64, 63176704
v_and_b32 v152, 31, v1
s_waitcnt lgkmcnt(10)
MAV 52,36,116
buffer_load_dwordx4 v15, s[80:83], s58 offen offset:3168 lds
s_waitcnt lgkmcnt(8)
MAV 52,52,124
s_add_u32 s58, s58, 458752
v_lshlrev_b32 v152, 3, v152
v_lshrrev_b32 v153, 5, v1
MAV 36,52,120
s_lshl_b32 s62, s7, 18
v_lshl_add_u32 v152, v153, 28, v152
s_add_u32 s62, s62, 41943040
MAV 36,36,112
s_add_u32 s63, s62, 131072
v_cvt_pk_bf16_f32 v128, v32, v33
v_cvt_pk_bf16_f32 v129, v34, v35
s_waitcnt lgkmcnt(6)
MAV 40,40,112
v_cvt_pk_bf16_f32 v136, v48, v49
v_cvt_pk_bf16_f32 v137, v50, v51
s_waitcnt lgkmcnt(4)
MAV 40,56,120
v_cvt_pk_bf16_f32 v130, v36, v37
v_cvt_pk_bf16_f32 v131, v38, v39
MAV 56,56,124
buffer_store_dwordx4 v[128:131], v4, s[16:19], s62 offen sc1
MAV 56,40,116
v_cvt_pk_bf16_f32 v138, v52, v53
v_cvt_pk_bf16_f32 v139, v54, v55
s_waitcnt lgkmcnt(2)
MAV 60,44,116
v_cvt_pk_bf16_f32 v132, v40, v41
v_cvt_pk_bf16_f32 v133, v42, v43
s_waitcnt lgkmcnt(0)
MAV 60,60,124
v_cvt_pk_bf16_f32 v140, v56, v57
MAV 44,60,120
buffer_store_dwordx4 v[136:139], v4, s[16:19], s62 offen offset:1024 sc1
MAV 44,44,112
v_cvt_pk_bf16_f32 v141, v58, v59
s_nop 2
v_cvt_pk_bf16_f32 v142, v60, v61
v_pk_mul_f32 v[146:147], v[32:33], v[32:33]
v_pk_mul_f32 v[150:151], v[48:49], v[48:49]
v_cvt_pk_bf16_f32 v143, v62, v63
v_pk_fma_f32 v[146:147], v[34:35], v[34:35], v[146:147]
v_pk_add_f32 v[144:145], v[32:33], v[34:35]
v_pk_fma_f32 v[150:151], v[50:51], v[50:51], v[150:151]
v_cvt_pk_bf16_f32 v134, v44, v45
v_cvt_pk_bf16_f32 v135, v46, v47
buffer_store_dwordx4 v[132:135], v4, s[16:19], s63 offen sc1
v_pk_add_f32 v[148:149], v[48:49], v[50:51]
v_pk_fma_f32 v[146:147], v[36:37], v[36:37], v[146:147]
v_pk_add_f32 v[144:145], v[144:145], v[36:37]
v_pk_fma_f32 v[150:151], v[52:53], v[52:53], v[150:151]
v_pk_add_f32 v[148:149], v[148:149], v[52:53]
v_pk_fma_f32 v[146:147], v[38:39], v[38:39], v[146:147]
v_pk_add_f32 v[144:145], v[144:145], v[38:39]
v_pk_fma_f32 v[150:151], v[54:55], v[54:55], v[150:151]
v_pk_add_f32 v[148:149], v[148:149], v[54:55]
v_pk_fma_f32 v[146:147], v[40:41], v[40:41], v[146:147]
v_pk_add_f32 v[144:145], v[144:145], v[40:41]
v_pk_fma_f32 v[150:151], v[56:57], v[56:57], v[150:151]
v_pk_add_f32 v[148:149], v[148:149], v[56:57]
buffer_store_dwordx4 v[140:143], v4, s[16:19], s63 offen offset:1024 sc1
v_pk_fma_f32 v[146:147], v[42:43], v[42:43], v[146:147]
v_pk_add_f32 v[144:145], v[144:145], v[42:43]
v_pk_fma_f32 v[150:151], v[58:59], v[58:59], v[150:151]
v_pk_add_f32 v[148:149], v[148:149], v[58:59]
v_pk_fma_f32 v[146:147], v[44:45], v[44:45], v[146:147]
v_pk_add_f32 v[144:145], v[144:145], v[44:45]
v_pk_fma_f32 v[150:151], v[60:61], v[60:61], v[150:151]
v_pk_add_f32 v[148:149], v[148:149], v[60:61]
v_pk_fma_f32 v[146:147], v[46:47], v[46:47], v[146:147]
v_pk_add_f32 v[144:145], v[144:145], v[46:47]
v_pk_fma_f32 v[150:151], v[62:63], v[62:63], v[150:151]
v_pk_add_f32 v[148:149], v[148:149], v[62:63]
v_add_f32 v144, v144, v145
v_add_f32 v146, v146, v147
v_add_f32 v148, v148, v149
v_add_f32 v150, v150, v151
s_nop 0
v_permlane16_swap_b32 v144, v148
v_permlane16_swap_b32 v146, v150
v_add_f32 v144, v144, v148
v_add_f32 v146, v146, v150
s_nop 1
v_permlane32_swap_b32 v144, v146
v_add_f32 v144, v144, v146
s_nop 1
v_permlane32_swap_b32 v144, v145
buffer_store_dwordx2 v[144:145], v152, s[16:19], s64 offen sc1
s_nop 1
s_mov_b32 s54, s58
s_mov_b32 s55, s59
v_accvgpr_write_b32 a224, v32
v_accvgpr_write_b32 a225, v33
v_accvgpr_write_b32 a226, v34
v_accvgpr_write_b32 a227, v35
v_accvgpr_write_b32 a228, v36
v_accvgpr_write_b32 a229, v37
v_accvgpr_write_b32 a230, v38
v_accvgpr_write_b32 a231, v39
v_accvgpr_write_b32 a232, v40
v_accvgpr_write_b32 a233, v41
v_accvgpr_write_b32 a234, v42
v_accvgpr_write_b32 a235, v43
v_accvgpr_write_b32 a236, v44
v_accvgpr_write_b32 a237, v45
v_accvgpr_write_b32 a238, v46
v_accvgpr_write_b32 a239, v47
v_accvgpr_write_b32 a240, v48
v_accvgpr_write_b32 a241, v49
v_accvgpr_write_b32 a242, v50
v_accvgpr_write_b32 a243, v51
v_accvgpr_write_b32 a244, v52
v_accvgpr_write_b32 a245, v53
v_accvgpr_write_b32 a246, v54
v_accvgpr_write_b32 a247, v55
v_accvgpr_write_b32 a248, v56
v_accvgpr_write_b32 a249, v57
v_accvgpr_write_b32 a250, v58
v_accvgpr_write_b32 a251, v59
v_accvgpr_write_b32 a252, v60
v_accvgpr_write_b32 a253, v61
v_accvgpr_write_b32 a254, v62
v_accvgpr_write_b32 a255, v63
s_lshl_b32 s62, s10, 14
s_lshl_b32 s63, s3, 12
s_add_u32 s62, s62, s63
s_lshl_b32 s63, s12, 11
s_add_u32 s62, s62, s63
v_lshl_add_u32 v10, v1, 4, s62
v_lshrrev_b32 v2, 3, v1
v_cmp_eq_u32 vcc, 3, v2
v_add_u32 v2, 67108480, v10
s_nop 0
v_cndmask_b32 v10, v10, v2, vcc
v_xor_b32 v11, 2048, v10
v_bfe_u32 v16, v1, 2, 3
v_mul_u32_u24 v16, 1056, v16
v_bfe_u32 v2, v1, 5, 1
v_lshl_add_u32 v16, v2, 8, v16
v_and_b32 v2, 3, v1
v_lshl_add_u32 v16, v2, 3, v16
s_lshl_b32 s62, s12, 6
s_add_u32 s62, s62, 84480
s_xor_b32 s63, s12, 1
s_mul_i32 s63, s63, 192
s_add_u32 s63, s63, 84480
v_add_u32 v17, s63, v16
v_add_u32 v16, s62, v16
s_mov_b32 s52, 41943040
s_mov_b32 s53, 41943040
s_mul_i32 s59, s3, 2112
s_and_b32 s62, s7, 1
s_mul_i32 s62, s62, 3670016
s_lshr_b32 s63, s7, 1
s_lshl_b32 s63, s63, 8
s_add_u32 s62, s62, s63
s_lshl_b32 s63, s3, 12
s_add_u32 s62, s62, s63
v_lshrrev_b32 v5, 4, v1
v_lshlrev_b32 v5, 14, v5
v_and_b32 v2, 15, v1
v_lshl_add_u32 v5, v2, 4, v5
v_add_u32 v5, s62, v5
v_add_u32 v6, 992, v5
s_lshl_b32 s62, s10, 15
s_lshl_b32 s63, s3, 13
s_add_u32 s62, s62, s63
v_lshl_add_u32 v4, v1, 4, s62
s_lshl_b32 s62, s6, 10
s_add_u32 s62, s62, 30507008
s_lshl_b32 s64, s10, 1
s_lshl_b32 s64, s64, 10
s_add_u32 s64, s64, 30507008
s_lshr_b32 s67, s5, 2
s_and_b32 s67, s67, 3
s_lshl_b32 s67, s67, 7
s_add_u32 s64, s64, s67
s_add_u32 s65, s64, 1024
v_lshl_add_u32 v252, v1, 7, s62
v_mov_b32 v253, s64
v_mov_b32 v255, 1
v_writelane_b32 v253, s65, 1
s_waitcnt vmcnt(0) lgkmcnt(0)
s_cmp_lg_u32 s3, 1
s_barrier
s_cbranch_scc1 .Lfirst64
s_mov_b64 exec, 15
buffer_atomic_add v255, v252, s[16:19], 0 offen
s_mov_b64 exec, 3
v_mov_b32 v254, 0
buffer_atomic_add v254, v253, s[16:19], 0 offen sc0
s_mov_b64 exec, -1
.Lfirst64:
s_add_u32 m0, s55, 118272
s_nop 0
buffer_load_dwordx4 v12, s[32:35], s54 offen lds
buffer_load_dwordx4 v13, s[32:35], s54 offen offset:1056 lds
buffer_load_dwordx4 v14, s[32:35], s54 offen offset:2112 lds
buffer_load_dwordx4 v15, s[32:35], s54 offen offset:3168 lds
s_add_u32 m0, s55, 135168
s_nop 0
buffer_load_dwordx4 v12, s[80:83], s54 offen lds
buffer_load_dwordx4 v13, s[80:83], s54 offen offset:1056 lds
buffer_load_dwordx4 v14, s[80:83], s54 offen offset:2112 lds
buffer_load_dwordx4 v15, s[80:83], s54 offen offset:3168 lds
s_add_u32 s54, s54, 458752
s_cmp_lg_u32 s3, 1
s_cbranch_scc1 .Lnopoll63
s_mov_b64 exec, 3
s_mov_b32 s15, 0
v_mov_b32 v255, 0
buffer_atomic_add v255, v253, s[16:19], 0 offen sc0
s_waitcnt vmcnt(9)
v_cmp_gt_u32 vcc, 16, v254
s_nop 0
s_cbranch_vccz .Lnopoll63r
.Lpoll62:
s_waitcnt vmcnt(0)
v_cmp_gt_u32 vcc, 16, v255
s_add_u32 s15, s15, 1
s_cbranch_vccz .Lnopoll63r
v_mov_b32 v255, 0
buffer_atomic_add v255, v253, s[16:19], 0 offen sc0
s_cmp_le_u32 s15, 100000
s_cbranch_scc1 .Lpoll62
s_branch .Lnopoll63r
.Lnopoll63:
s_mov_b64 exec, 0
s_cmp_eq_u32 s3, 2
s_cbranch_scc1 .Lpad34
s_cmp_eq_u32 s3, 3
s_cbranch_scc1 .Lpad35
s_branch .Lpad36
.Lnopoll63r:
s_mov_b64 exec, -1
s_waitcnt vmcnt(9)
s_barrier
buffer_load_dwordx4 a[128:131], v10, s[16:19], s52 offen sc1
buffer_load_dwordx4 a[132:135], v10, s[16:19], s52 offen offset:1024 sc1
s_add_u32 s52, s52, 131072
buffer_load_dwordx4 a[144:147], v10, s[16:19], s52 offen sc1
buffer_load_dwordx4 a[148:151], v10, s[16:19], s52 offen offset:1024 sc1
s_add_u32 s52, s52, 131072
buffer_load_dwordx4 a[136:139], v11, s[16:19], s53 offen sc1
buffer_load_dwordx4 a[140:143], v11, s[16:19], s53 offen offset:1024 sc1
s_add_u32 s53, s53, 131072
buffer_load_dwordx4 a[152:155], v11, s[16:19], s53 offen sc1
buffer_load_dwordx4 a[156:159], v11, s[16:19], s53 offen offset:1024 sc1
s_add_u32 s53, s53, 131072
ds_read_b64_tr_b16 a[0:1], v16
TR 2,16,512
TR 4,16,8448
TR 6,16,8960
TR 8,16,32
TR 10,16,544
TR 12,16,8480
TR 14,16,8992
TR 16,16,64
TR 18,16,576
TR 20,16,8512
TR 22,16,9024
TR 24,16,96
TR 26,16,608
TR 28,16,8544
TR 30,16,9056
TR 32,16,128
TR 34,16,640
TR 36,16,8576
TR 38,16,9088
TR 40,16,160
TR 42,16,672
TR 44,16,8608
TR 46,16,9120
ds_read_b64_tr_b16 a[48:49], v17
TR 50,17,512
TR 52,17,8448
TR 54,17,8960
TR 56,17,32
TR 58,17,544
TR 60,17,8480
TR 62,17,8992
s_lshl_b32 s57, s3, 13
s_add_u32 s57, s57, 49920
v_lshl_add_u32 v2, v1, 4, s57
s_waitcnt lgkmcnt(0)
s_barrier
s_waitcnt vmcnt(7)
v_mfma_f32_16x16x32_bf16 v[32:35], a[0:3], a[128:131], 0
buffer_load_dwordx4 a[160:163], v10, s[16:19], s52 offen sc1
s_waitcnt vmcnt(6)
MAA 32,4,144
TR 64,16,16896
v_mfma_f32_16x16x32_bf16 v[36:39], a[0:3], a[132:135], 0
TR 66,16,17408
s_waitcnt vmcnt(5)
MAA 36,4,148
TR 68,16,25344
v_mfma_f32_16x16x32_bf16 v[52:55], a[8:11], a[132:135], 0
buffer_load_dwordx4 a[164:167], v10, s[16:19], s52 offen offset:1024 sc1
MAA 52,12,148
TR 70,16,25856
s_add_u32 s52, s52, 131072
v_mfma_f32_16x16x32_bf16 v[48:51], a[8:11], a[128:131], 0
TR 72,16,16928
MAA 48,12,144
TR 74,16,17440
v_mfma_f32_16x16x32_bf16 v[96:99], a[16:19], a[128:131], 0
buffer_load_dwordx4 a[176:179], v10, s[16:19], s52 offen sc1
MAA 96,20,144
TR 76,16,25376
v_mfma_f32_16x16x32_bf16 v[100:103], a[16:19], a[132:135], 0
TR 78,16,25888
MAA 100,20,148
TR 80,16,16960
v_mfma_f32_16x16x32_bf16 v[116:119], a[24:27], a[132:135], 0
buffer_load_dwordx4 a[180:183], v10, s[16:19], s52 offen offset:1024 sc1
MAA 116,28,148
TR 82,16,17472
s_add_u32 s52, s52, 131072
v_mfma_f32_16x16x32_bf16 v[112:115], a[24:27], a[128:131], 0
TR 84,16,25408
MAA 112,28,144
TR 86,16,25920
v_mfma_f32_16x16x32_bf16 v[160:163], a[32:35], a[128:131], 0
buffer_load_dwordx4 a[168:171], v11, s[16:19], s53 offen sc1
MAA 160,36,144
TR 88,16,16992
v_mfma_f32_16x16x32_bf16 v[164:167], a[32:35], a[132:135], 0
TR 90,16,17504
MAA 164,36,148
TR 92,16,25440
v_mfma_f32_16x16x32_bf16 v[180:183], a[40:43], a[132:135], 0
buffer_load_dwordx4 a[172:175], v11, s[16:19], s53 offen offset:1024 sc1
MAA 180,44,148
TR 94,16,25952
s_add_u32 s53, s53, 131072
v_mfma_f32_16x16x32_bf16 v[176:179], a[40:43], a[128:131], 0
TR 96,16,17024
MAA 176,44,144
TR 98,16,17536
v_mfma_f32_16x16x32_bf16 v[224:227], a[48:51], a[128:131], 0
buffer_load_dwordx4 a[184:187], v11, s[16:19], s53 offen sc1
MAA 224,52,144
TR 100,16,25472
v_mfma_f32_16x16x32_bf16 v[228:231], a[48:51], a[132:135], 0
TR 102,16,25984
MAA 228,52,148
TR 104,16,17056
v_mfma_f32_16x16x32_bf16 v[236:239], a[56:59], a[132:135], 0
buffer_load_dwordx4 a[188:191], v11, s[16:19], s53 offen offset:1024 sc1
MAA 236,60,148
TR 106,16,17568
s_add_u32 s53, s53, 131072
v_mfma_f32_16x16x32_bf16 v[232:235], a[56:59], a[128:131], 0
TR 108,16,25504
s_add_u32 m0, s55, 84480
MAA 232,60,144
TR 110,16,26016
s_waitcnt vmcnt(8)
v_mfma_f32_16x16x32_bf16 v[188:191], a[40:43], a[140:143], 0
buffer_load_dwordx4 v12, s[32:35], s54 offen lds
MAA 188,44,156
TR 112,17,16896
v_mfma_f32_16x16x32_bf16 v[184:187], a[40:43], a[136:139], 0
TR 114,17,17408
MAA 184,44,152
TR 116,17,25344
v_mfma_f32_16x16x32_bf16 v[168:171], a[32:35], a[136:139], 0
buffer_load_dwordx4 v13, s[32:35], s54 offen offset:1056 lds
MAA 168,36,152
TR 118,17,25856
v_mfma_f32_16x16x32_bf16 v[172:175], a[32:35], a[140:143], 0
TR 120,17,16928
MAA 172,36,156
TR 122,17,17440
v_mfma_f32_16x16x32_bf16 v[124:127], a[24:27], a[140:143], 0
buffer_load_dwordx4 v14, s[32:35], s54 offen offset:2112 lds
MAA 124,28,156
TR 124,17,25376
v_mfma_f32_16x16x32_bf16 v[120:123], a[24:27], a[136:139], 0
TR 126,17,25888
MAA 120,28,152
v_mfma_f32_16x16x32_bf16 v[104:107], a[16:19], a[136:139], 0
buffer_load_dwordx4 v15, s[32:35], s54 offen offset:3168 lds
MAA 104,20,152
v_mfma_f32_16x16x32_bf16 v[108:111], a[16:19], a[140:143], 0
MAA 108,20,156
v_mfma_f32_16x16x32_bf16 v[60:63], a[8:11], a[140:143], 0
MAA 60,12,156
v_mfma_f32_16x16x32_bf16 v[56:59], a[8:11], a[136:139], 0
MAA 56,12,152
v_mfma_f32_16x16x32_bf16 v[40:43], a[0:3], a[136:139], 0
MAA 40,4,152
v_mfma_f32_16x16x32_bf16 v[44:47], a[0:3], a[140:143], 0
MAA 44,4,156
s_waitcnt lgkmcnt(0)
s_barrier
v_mfma_f32_16x16x32_bf16 v[64:67], a[64:67], a[128:131], 0
TR 0,16,33792
s_add_u32 m0, s55, 101376
MAA 64,68,144
buffer_load_dwordx4 v12, s[80:83], s54 offen lds
v_mfma_f32_16x16x32_bf16 v[68:71], a[64:67], a[132:135], 0
TR 2,16,34304
s_mul_i32 s66, s13, 114688
MAA 68,68,148
TR 4,16,42240
s_mul_i32 s65, s10, 1818624
v_mfma_f32_16x16x32_bf16 v[84:87], a[72:75], a[132:135], 0
TR 6,16,42752
s_add_u32 s66, s66, s65
MAA 84,76,148
TR 8,16,33824
s_add_u32 s66, s66, 46137344
v_mfma_f32_16x16x32_bf16 v[80:83], a[72:75], a[128:131], 0
buffer_load_dwordx4 v13, s[80:83], s54 offen offset:1056 lds
MAA 80,76,144
TR 10,16,34336
s_add_u32 s65, s66, 49152
v_mfma_f32_16x16x32_bf16 v[128:131], a[80:83], a[128:131], 0
TR 12,16,42272
s_lshl_b32 s62, s12, 16
.Lpad30:
s_cbranch_execz .Lpad33
MAA 128,84,144
TR 14,16,42784
s_add_u32 s62, s62, s66
v_mfma_f32_16x16x32_bf16 v[132:135], a[80:83], a[132:135], 0
TR 16,16,33856
s_add_u32 s63, s62, 16384
MAA 132,84,148
buffer_load_dwordx4 v14, s[80:83], s54 offen offset:2112 lds
v_mfma_f32_16x16x32_bf16 v[148:151], a[88:91], a[132:135], 0
TR 18,16,34368
s_add_u32 s64, s62, 32768
MAA 148,92,148
TR 20,16,42304
s_lshl_b32 s72, s10, 1
v_mfma_f32_16x16x32_bf16 v[144:147], a[88:91], a[128:131], 0
TR 22,16,42816
s_lshr_b32 s74, s11, 4
MAA 144,92,144
TR 24,16,33888
s_add_u32 s72, s72, s74
v_mfma_f32_16x16x32_bf16 v[192:195], a[96:99], a[128:131], 0
buffer_load_dwordx4 v15, s[80:83], s54 offen offset:3168 lds
MAA 192,100,144
TR 26,16,34400
s_add_u32 s54, s54, 458752
v_mfma_f32_16x16x32_bf16 v[196:199], a[96:99], a[132:135], 0
TR 28,16,42336
s_add_u32 m0, s57, 0
MAA 196,100,148
TR 30,16,42848
s_mov_b32 s58, 63176704
v_mfma_f32_16x16x32_bf16 v[212:215], a[104:107], a[132:135], 0
TR 32,16,33920
s_lshl_b32 s72, s72, 10
MAA 212,108,148
buffer_load_dwordx4 v4, s[16:19], s58 offen sc1 lds
v_mfma_f32_16x16x32_bf16 v[208:211], a[104:107], a[128:131], 0
TR 34,16,34432
s_add_u32 s72, s72, 30523392
MAA 208,108,144
TR 36,16,42368
s_and_b32 s73, s6, 14
v_mfma_f32_16x16x32_bf16 v[240:243], a[112:115], a[128:131], 0
TR 38,16,42880
s_and_b32 s74, s7, 1
MAA 240,116,144
TR 40,16,33952
s_add_u32 s73, s73, s74
v_mfma_f32_16x16x32_bf16 v[244:247], a[112:115], a[132:135], 0
buffer_load_dwordx4 v4, s[16:19], s58 offen offset:1024 sc1 lds
MAA 244,116,148
TR 42,16,34464
s_lshl_b32 s73, s73, 10
v_mfma_f32_16x16x32_bf16 v[252:255], a[120:123], a[132:135], 0
TR 44,16,42400
s_add_u32 s73, s73, 30523392
MAA 252,124,148
TR 46,16,42912
s_lshr_b32 s67, s5, 2
v_mfma_f32_16x16x32_bf16 v[248:251], a[120:123], a[128:131], 0
TR 48,17,33792
s_and_b32 s67, s67, 3
MAA 248,124,144
buffer_load_dwordx4 a[128:131], v10, s[16:19], s52 offen sc1
v_mfma_f32_16x16x32_bf16 v[220:223], a[104:107], a[140:143], 0
TR 50,17,34304
s_lshl_b32 s67, s67, 7
MAA 220,108,156
TR 52,17,42240
s_add_u32 s73, s73, s67
v_mfma_f32_16x16x32_bf16 v[216:219], a[104:107], a[136:139], 0
TR 54,17,42752
MAA 216,108,152
TR 56,17,33824
v_mfma_f32_16x16x32_bf16 v[200:203], a[96:99], a[136:139], 0
buffer_load_dwordx4 a[132:135], v10, s[16:19], s52 offen offset:1024 sc1
MAA 200,100,152
TR 58,17,34336
s_add_u32 s52, s52, 131072
v_mfma_f32_16x16x32_bf16 v[204:207], a[96:99], a[140:143], 0
TR 60,17,42272
MAA 204,100,156
TR 62,17,42784
v_mfma_f32_16x16x32_bf16 v[156:159], a[88:91], a[140:143], 0
MAA 156,92,156
buffer_load_dwordx4 a[144:147], v10, s[16:19], s52 offen sc1
v_mfma_f32_16x16x32_bf16 v[152:155], a[88:91], a[136:139], 0
MAA 152,92,152
v_mfma_f32_16x16x32_bf16 v[136:139], a[80:83], a[136:139], 0
MAA 136,84,152
v_mfma_f32_16x16x32_bf16 v[140:143], a[80:83], a[140:143], 0
buffer_load_dwordx4 a[148:151], v10, s[16:19], s52 offen offset:1024 sc1
MAA 140,84,156
s_add_u32 s52, s52, 131072
v_mfma_f32_16x16x32_bf16 v[92:95], a[72:75], a[140:143], 0
MAA 92,76,156
v_mfma_f32_16x16x32_bf16 v[88:91], a[72:75], a[136:139], 0
MAA 88,76,152
v_mfma_f32_16x16x32_bf16 v[72:75], a[64:67], a[136:139], 0
MAA 72,68,152
v_mfma_f32_16x16x32_bf16 v[76:79], a[64:67], a[140:143], 0
MAA 76,68,156
s_waitcnt vmcnt(18) lgkmcnt(0)
s_barrier
MAA 32,0,160
buffer_load_dwordx4 a[136:139], v11, s[16:19], s53 offen sc1
MAA 32,4,176
TR 64,16,50688
s_and_b32 s74, s7, 1
MAA 36,4,180
TR 66,16,51200
s_mul_i32 s87, s74, 917504
MAA 36,0,164
TR 68,16,59136
s_lshr_b32 s75, s6, 1
MAA 52,8,164
TR 70,16,59648
s_mul_i32 s75, s75, 1818624
MAA 52,12,180
buffer_load_dwordx4 a[140:143], v11, s[16:19], s53 offen offset:1024 sc1
MAA 48,12,176
TR 72,16,50720
s_add_u32 s53, s53, 131072
MAA 48,8,160
TR 74,16,51232
s_add_u32 s87, s87, s75
MAA 96,16,160
TR 76,16,59168
s_add_u32 s87, s87, 46137344
MAA 96,20,176
TR 78,16,59680
s_and_b32 s74, s6, 3
MAA 100,20,180
buffer_load_dwordx4 a[152:155], v11, s[16:19], s53 offen sc1
MAA 100,16,164
TR 80,16,50752
s_xor_b32 s75, s74, 0
MAA 116,24,164
TR 82,16,51264
s_sub_u32 s75, s75, 0
MAA 116,28,180
TR 84,16,59200
s_mul_i32 s98, s75, 458752
MAA 112,28,176
TR 86,16,59712
s_mul_i32 s75, s75, 114688
MAA 112,24,160
buffer_load_dwordx4 a[156:159], v11, s[16:19], s53 offen offset:1024 sc1
MAA 160,32,160
TR 88,16,50784
s_add_u32 s53, s53, 131072
MAA 160,36,176
TR 90,16,51296
s_add_u32 m0, s55, 118272
MAA 164,36,180
TR 92,16,59232
s_add_u32 s76, s87, s75
MAA 164,32,164
TR 94,16,59744
s_xor_b32 s75, s74, 1
MAA 180,40,164
buffer_load_dwordx4 v12, s[32:35], s54 offen lds
MAA 180,44,180
TR 96,16,50816
s_sub_u32 s75, s75, 1
MAA 176,44,176
TR 98,16,51328
s_mul_i32 s99, s75, 458752
MAA 176,40,160
TR 100,16,59264
s_mul_i32 s75, s75, 114688
MAA 224,48,160
TR 102,16,59776
s_add_u32 s77, s87, s75
MAA 224,52,176
buffer_load_dwordx4 v13, s[32:35], s54 offen offset:1056 lds
MAA 228,52,180
TR 104,16,50848
s_xor_b32 s75, s74, 2
MAA 228,48,164
TR 106,16,51360
s_sub_u32 s75, s75, 2
MAA 236,56,164
TR 108,16,59296
s_mul_i32 s100, s75, 458752
MAA 236,60,180
TR 110,16,59808
s_mul_i32 s75, s75, 114688
MAA 232,60,176
buffer_load_dwordx4 v14, s[32:35], s54 offen offset:2112 lds
MAA 232,56,160
TR 112,17,50688
s_add_u32 s78, s87, s75
s_waitcnt vmcnt(21)
MAA 188,40,172
TR 114,17,51200
s_xor_b32 s75, s74, 3
MAA 188,44,188
TR 116,17,59136
MAA 184,44,184
TR 118,17,59648
MAA 184,40,168
buffer_load_dwordx4 v15, s[32:35], s54 offen offset:3168 lds
MAA 168,32,168
TR 120,17,50720
s_add_u32 m0, s57, 2048
MAA 168,36,184
TR 122,17,51232
s_mov_b32 s58, 63178752
MAA 172,36,188
TR 124,17,59168
MAA 172,32,172
TR 126,17,59680
MAA 124,24,172
buffer_load_dwordx4 v4, s[16:19], s58 offen sc1 lds
MAA 124,28,188
MAA 120,28,184
MAA 120,24,168
MAA 104,16,168
MAA 104,20,184
buffer_load_dwordx4 v4, s[16:19], s58 offen offset:1024 sc1 lds
MAA 108,20,188
MAA 108,16,172
MAA 60,8,172
MAA 60,12,188
MAA 56,12,184
MAA 56,8,168
MAA 40,0,168
MAA 40,4,184
MAA 44,4,188
MAA 44,0,172
s_waitcnt vmcnt(20) lgkmcnt(0)
s_barrier
MAA 64,64,160
ds_read_b64_tr_b16 a[0:1], v16
s_add_u32 m0, s55, 135168
MAA 64,68,176
buffer_load_dwordx4 v12, s[80:83], s54 offen lds
MAA 68,68,180
TR 2,16,512
s_sub_u32 s75, s75, 3
MAA 68,64,164
TR 4,16,8448
s_mul_i32 s101, s75, 458752
MAA 84,72,164
TR 6,16,8960
s_mul_i32 s75, s75, 114688
MAA 84,76,180
TR 8,16,32
s_add_u32 s79, s87, s75
MAA 80,76,176
buffer_load_dwordx4 v13, s[80:83], s54 offen offset:1056 lds
MAA 80,72,160
TR 10,16,544
s_and_b32 s87, s6, 3
MAA 128,80,160
TR 12,16,8480
s_mov_b32 s46, 0
MAA 128,84,176
TR 14,16,8992
s_lshl_b32 s74, s3, 10
MAA 132,84,180
TR 16,16,64
s_lshl_b32 s75, s12, 9
MAA 132,80,164
buffer_load_dwordx4 v14, s[80:83], s54 offen offset:2112 lds
MAA 148,88,164
TR 18,16,576
s_add_u32 s74, s74, s75
MAA 148,92,180
TR 20,16,8512
s_add_u32 s74, s74, 152576
MAA 144,92,176
TR 22,16,9024
v_and_b32 v18, 15, v1
MAA 144,88,160
TR 24,16,96
v_lshl_add_u32 v18, v18, 4, s74
MAA 192,96,160
buffer_load_dwordx4 v15, s[80:83], s54 offen offset:3168 lds
MAA 192,100,176
TR 26,16,608
s_add_u32 s54, s54, 458752
MAA 196,100,180
TR 28,16,8544
s_add_u32 m0, s57, 4096
MAA 196,96,164
TR 30,16,9056
s_mov_b32 s58, 63180800
MAA 212,104,164
TR 32,16,128
v_xor_b32 v19, 512, v18
MAA 212,108,180
buffer_load_dwordx4 v4, s[16:19], s58 offen sc1 lds
MAA 208,108,176
TR 34,16,640
s_lshl_b32 s74, s12, 7
MAA 208,104,160
TR 36,16,8576
s_add_u32 s74, s74, 161536
MAA 240,112,160
TR 38,16,9088
s_xor_b32 s75, s12, 1
MAA 240,116,176
TR 40,16,160
s_mul_i32 s75, s75, 384
MAA 244,116,180
buffer_load_dwordx4 v4, s[16:19], s58 offen offset:1024 sc1 lds
MAA 244,112,164
TR 42,16,672
s_add_u32 s75, s75, 161536
MAA 252,120,164
TR 44,16,8608
v_lshrrev_b32 v9, 4, v1
MAA 252,124,180
TR 46,16,9120
v_lshlrev_b32 v9, 4, v9
MAA 248,124,176
ds_read_b64_tr_b16 a[48:49], v17
v_add_u32 v8, s75, v9
MAA 248,120,160
buffer_load_dwordx4 a[160:163], v10, s[16:19], s52 offen sc1
MAA 220,104,172
TR 50,17,512
v_add_u32 v9, s74, v9
MAA 220,108,188
TR 52,17,8448
MAA 216,108,184
TR 54,17,8960
MAA 216,104,168
TR 56,17,32
MAA 200,96,168
buffer_load_dwordx4 a[164:167], v10, s[16:19], s52 offen offset:1024 sc1
MAA 200,100,184
TR 58,17,544
s_add_u32 s52, s52, 131072
MAA 204,100,188
TR 60,17,8480
MAA 204,96,172
TR 62,17,8992
MAA 156,88,172
MAA 156,92,188
buffer_load_dwordx4 a[176:179], v10, s[16:19], s52 offen sc1
MAA 152,92,184
MAA 152,88,168
MAA 136,80,168
MAA 136,84,184
MAA 140,84,188
buffer_load_dwordx4 a[180:183], v10, s[16:19], s52 offen offset:1024 sc1
MAA 140,80,172
s_add_u32 s52, s52, 131072
MAA 92,72,172
MAA 92,76,188
MAA 88,76,184
MAA 88,72,168
MAA 72,64,168
MAA 72,68,184
MAA 76,68,188
MAA 76,64,172
s_waitcnt vmcnt(20) lgkmcnt(0)
s_barrier
MAA 32,0,128
buffer_load_dwordx4 a[168:171], v11, s[16:19], s53 offen sc1
MAA 32,4,144
ds_read_b128 v[20:23], v2
MAA 36,4,148
ds_read_b128 v[28:31], v2 offset:1024
MAA 36,0,132
s_waitcnt vmcnt(11)
ds_read_b128 v[24:27], v2 offset:2048
MAA 52,8,132
TR 64,16,16896
MAA 52,12,148
buffer_load_dwordx4 a[172:175], v11, s[16:19], s53 offen offset:1024 sc1
MAA 48,12,144
TR 66,16,17408
s_add_u32 s53, s53, 131072
MAA 48,8,128
TR 68,16,25344
MAA 96,16,128
TR 70,16,25856
MAA 96,20,144
TR 72,16,16928
MAA 100,20,148
buffer_load_dwordx4 a[184:187], v11, s[16:19], s53 offen sc1
MAA 100,16,132
TR 74,16,17440
s_waitcnt lgkmcnt(7)
v_add_f32 v20, v20, v28
MAA 116,24,132
TR 76,16,25376
v_add_f32 v21, v21, v29
MAA 116,28,148
TR 78,16,25888
v_add_f32 v22, v22, v30
MAA 112,28,144
TR 80,16,16960
v_add_f32 v23, v23, v31
MAA 112,24,128
buffer_load_dwordx4 a[188:191], v11, s[16:19], s53 offen offset:1024 sc1
MAA 160,32,128
ds_read_b128 v[28:31], v2 offset:3072
s_add_u32 s53, s53, 131072
MAA 160,36,144
TR 82,16,17472
s_add_u32 m0, s55, 84480
MAA 164,36,148
TR 84,16,25408
s_waitcnt lgkmcnt(12)
v_add_f32 v20, v20, v24
MAA 164,32,132
TR 86,16,25920
v_add_f32 v21, v21, v25
MAA 180,40,132
buffer_load_dwordx4 v12, s[32:35], s54 offen lds
MAA 180,44,148
TR 88,16,16992
v_add_f32 v22, v22, v26
MAA 176,44,144
TR 90,16,17504
v_add_f32 v23, v23, v27
MAA 176,40,128
TR 92,16,25440
MAA 224,48,128
TR 94,16,25952
MAA 224,52,144
buffer_load_dwordx4 v13, s[32:35], s54 offen offset:1056 lds
MAA 228,52,148
TR 96,16,17024
MAA 228,48,132
TR 98,16,17536
MAA 236,56,132
TR 100,16,25472
MAA 236,60,148
TR 102,16,25984
MAA 232,60,144
buffer_load_dwordx4 v14, s[32:35], s54 offen offset:2112 lds
MAA 232,56,128
TR 104,16,17056
MAA 188,40,140
TR 106,16,17568
MAA 188,44,156
TR 108,16,25504
MAA 184,44,152
TR 110,16,26016
MAA 184,40,136
buffer_load_dwordx4 v15, s[32:35], s54 offen offset:3168 lds
MAA 168,32,136
TR 112,17,16896
s_add_u32 m0, s57, 6144
MAA 168,36,152
TR 114,17,17408
s_mov_b32 s58, 63182848
MAA 172,36,156
TR 116,17,25344
MAA 172,32,140
TR 118,17,25856
MAA 124,24,140
buffer_load_dwordx4 v4, s[16:19], s58 offen sc1 lds
MAA 124,28,156
TR 120,17,16928
MAA 120,28,152
TR 122,17,17440
MAA 120,24,136
TR 124,17,25376
MAA 104,16,136
TR 126,17,25888
MAA 104,20,152
buffer_load_dwordx4 v4, s[16:19], s58 offen offset:1024 sc1 lds
MAA 108,20,156
MAA 108,16,140
MAA 60,8,140
MAA 60,12,156
MAA 56,12,152
MAA 56,8,136
MAA 40,0,136
MAA 40,4,152
MAA 44,4,156
MAA 44,0,140
s_waitcnt lgkmcnt(0)
s_barrier
MAA 64,64,128
s_waitcnt vmcnt(14)
ds_read_b128 v[24:27], v2 offset:4096
s_add_u32 m0, s55, 101376
MAA 64,68,144
buffer_load_dwordx4 v12, s[80:83], s54 offen lds
MAA 68,68,148
TR 0,16,33792
v_add_f32 v20, v20, v28
MAA 68,64,132
TR 2,16,34304
v_add_f32 v21, v21, v29
MAA 84,72,132
TR 4,16,42240
v_add_f32 v22, v22, v30
MAA 84,76,148
TR 6,16,42752
v_add_f32 v23, v23, v31
MAA 80,76,144
ds_read_b128 v[28:31], v2 offset:5120
MAA 80,72,128
TR 8,16,33824
MAA 128,80,128
buffer_load_dwordx4 v13, s[80:83], s54 offen offset:1056 lds
MAA 128,84,144
TR 10,16,34336
s_waitcnt lgkmcnt(7)
v_add_f32 v20, v20, v24
MAA 132,84,148
TR 12,16,42272
v_add_f32 v21, v21, v25
MAA 132,80,132
TR 14,16,42784
v_add_f32 v22, v22, v26
MAA 148,88,132
TR 16,16,33856
v_add_f32 v23, v23, v27
MAA 148,92,148
TR 18,16,34368
MAA 144,92,144
TR 20,16,42304
MAA 144,88,128
buffer_load_dwordx4 v14, s[80:83], s54 offen offset:2112 lds
MAA 192,96,128
TR 22,16,42816
MAA 192,100,144
TR 24,16,33888
MAA 196,100,148
TR 26,16,34400
MAA 196,96,132
TR 28,16,42336
MAA 212,104,132
TR 30,16,42848
MAA 212,108,148
TR 32,16,33920
MAA 208,108,144
buffer_load_dwordx4 v15, s[80:83], s54 offen offset:3168 lds
MAA 208,104,128
TR 34,16,34432
s_add_u32 s54, s54, 458752
MAA 240,112,128
TR 36,16,42368
MAA 240,116,144
TR 38,16,42880
MAA 244,116,148
TR 40,16,33952
MAA 244,112,132
.Lpad31:
s_cbranch_execz .Lnopoll60r
TR 42,16,34464
MAA 252,120,132
TR 44,16,42400
MAA 252,124,148
TR 46,16,42912
MAA 248,124,144
TR 48,17,33792
MAA 248,120,128
buffer_load_dwordx4 a[128:131], v10, s[16:19], s52 offen sc1
MAA 220,104,140
TR 50,17,34304
MAA 220,108,156
TR 52,17,42240
MAA 216,108,152
TR 54,17,42752
MAA 216,104,136
TR 56,17,33824
MAA 200,96,136
TR 58,17,34336
MAA 200,100,152
TR 60,17,42272
MAA 204,100,156
buffer_load_dwordx4 a[132:135], v10, s[16:19], s52 offen offset:1024 sc1
MAA 204,96,140
TR 62,17,42784
s_add_u32 s52, s52, 131072
MAA 156,88,140
MAA 156,92,156
MAA 152,92,152
MAA 152,88,136
MAA 136,80,136
MAA 136,84,152
buffer_load_dwordx4 a[144:147], v10, s[16:19], s52 offen sc1
MAA 140,84,156
MAA 140,80,140
MAA 92,72,140
MAA 92,76,156
MAA 88,76,152
MAA 88,72,136
MAA 72,64,136
buffer_load_dwordx4 a[148:151], v10, s[16:19], s52 offen offset:1024 sc1
MAA 72,68,152
s_add_u32 s52, s52, 131072
MAA 76,68,156
MAA 76,64,140
s_waitcnt vmcnt(18) lgkmcnt(0)
s_barrier
MAA 32,0,160
buffer_load_dwordx4 a[136:139], v11, s[16:19], s53 offen sc1
MAA 32,4,176
s_waitcnt vmcnt(9)
ds_read_b128 v[24:27], v2 offset:6144
v_add_f32 v20, v20, v28
MAA 36,4,180
TR 64,16,50688
v_add_f32 v21, v21, v29
MAA 36,0,164
TR 66,16,51200
v_add_f32 v22, v22, v30
MAA 52,8,164
TR 68,16,59136
v_add_f32 v23, v23, v31
MAA 52,12,180
ds_read_b128 v[28:31], v2 offset:7168
MAA 48,12,176
TR 70,16,59648
MAA 48,8,160
buffer_load_dwordx4 a[140:143], v11, s[16:19], s53 offen offset:1024 sc1
MAA 96,16,160
TR 72,16,50720
s_add_u32 s53, s53, 131072
MAA 96,20,176
TR 74,16,51232
s_waitcnt lgkmcnt(7)
v_add_f32 v20, v20, v24
MAA 100,20,180
TR 76,16,59168
v_add_f32 v21, v21, v25
MAA 100,16,164
TR 78,16,59680
v_add_f32 v22, v22, v26
MAA 116,24,164
TR 80,16,50752
v_add_f32 v23, v23, v27
MAA 116,28,180
TR 82,16,51264
s_waitcnt lgkmcnt(7)
v_add_f32 v20, v20, v28
MAA 112,28,176
buffer_load_dwordx4 a[152:155], v11, s[16:19], s53 offen sc1
MAA 112,24,160
TR 84,16,59200
v_add_f32 v21, v21, v29
MAA 160,32,160
TR 86,16,59712
v_add_f32 v22, v22, v30
MAA 160,36,176
TR 88,16,50784
v_add_f32 v23, v23, v31
MAA 164,36,180
TR 90,16,51296
MAA 164,32,164
TR 92,16,59232
MAA 180,40,164
TR 94,16,59744
MAA 180,44,180
buffer_load_dwordx4 a[156:159], v11, s[16:19], s53 offen offset:1024 sc1
MAA 176,44,176
TR 96,16,50816
s_add_u32 s53, s53, 131072
MAA 176,40,160
TR 98,16,51328
s_add_u32 m0, s55, 118272
MAA 224,48,160
TR 100,16,59264
MAA 224,52,176
TR 102,16,59776
MAA 228,52,180
TR 104,16,50848
MAA 228,48,164
TR 106,16,51360
MAA 236,56,164
buffer_load_dwordx4 v12, s[32:35], s54 offen lds
MAA 236,60,180
TR 108,16,59296
MAA 232,60,176
TR 110,16,59808
MAA 232,56,160
TR 112,17,50688
MAA 188,40,172
TR 114,17,51200
MAA 188,44,188
TR 116,17,59136
MAA 184,44,184
TR 118,17,59648
MAA 184,40,168
buffer_load_dwordx4 v13, s[32:35], s54 offen offset:1056 lds
MAA 168,32,168
TR 120,17,50720
MAA 168,36,184
TR 122,17,51232
MAA 172,36,188
TR 124,17,59168
MAA 172,32,172
TR 126,17,59680
MAA 124,24,172
MAA 124,28,188
MAA 120,28,184
buffer_load_dwordx4 v14, s[32:35], s54 offen offset:2112 lds
MAA 120,24,168
MAA 104,16,168
MAA 104,20,184
MAA 108,20,188
MAA 108,16,172
MAA 60,8,172
MAA 60,12,188
buffer_load_dwordx4 v15, s[32:35], s54 offen offset:3168 lds
MAA 56,12,184
MAA 56,8,168
MAA 40,0,168
MAA 40,4,184
MAA 44,4,188
MAA 44,0,172
s_waitcnt lgkmcnt(0)
s_barrier
MAA 64,64,160
ds_read_b64_tr_b16 a[0:1], v16
s_add_u32 m0, s55, 135168
MAA 64,68,176
buffer_load_dwordx4 v12, s[80:83], s54 offen lds
MAA 68,68,180
TR 2,16,512
v_permlane32_swap_b32 v20, v22
MAA 68,64,164
TR 4,16,8448
v_permlane32_swap_b32 v21, v23
MAA 84,72,164
TR 6,16,8960
v_add_f32 v20, v20, v22
MAA 84,76,180
TR 8,16,32
v_add_f32 v21, v21, v23
MAA 80,76,176
TR 10,16,544
v_mul_f32 v20, 0xba800000, v20
MAA 80,72,160
buffer_load_dwordx4 v13, s[80:83], s54 offen offset:1056 lds
MAA 128,80,160
TR 12,16,8480
v_mul_f32 v21, 0x3a800000, v21
MAA 128,84,176
TR 14,16,8992
v_fma_f32 v21, -v20, v20, v21
MAA 132,84,180
TR 16,16,64
v_max_f32 v21, 0, v21
MAA 132,80,164
TR 18,16,576
v_add_f32 v21, 0x3727c5ac, v21
MAA 148,88,164
TR 20,16,8512
v_rsq_f32 v22, v21
MAA 148,92,180
buffer_load_dwordx4 v14, s[80:83], s54 offen offset:2112 lds
MAA 144,92,176
TR 22,16,9024
v_and_b32 v24, 31, v1
MAA 144,88,160
TR 24,16,96
v_lshrrev_b32 v25, 5, v1
MAA 192,96,160
TR 26,16,608
v_lshl_add_u32 v24, v24, 1, v25
MAA 192,100,176
TR 28,16,8544
v_and_b32 v25, 0xc0, v0
MAA 196,100,180
TR 30,16,9056
v_add_u32 v24, v24, v25
MAA 196,96,164
TR 32,16,128
v_lshlrev_b32 v24, 4, v24
MAA 212,104,164
buffer_load_dwordx4 v15, s[80:83], s54 offen offset:3168 lds
MAA 212,108,180
TR 34,16,640
s_add_u32 s54, s54, 458752
MAA 208,108,176
TR 36,16,8576
v_add_u32 v24, 152576, v24
MAA 208,104,160
TR 38,16,9088
v_mul_f32 v22, 0xbfb8aa3b, v22
MAA 240,112,160
ds_write_b128 v24, v[20:23]
s_mov_b32 s58, s98
MAA 240,116,176
ds_read_b64 v[20:21], v18
s_mov_b32 s67, s59
MAA 244,116,180
ds_read_b64 v[22:23], v18 offset:256
MAA 244,112,164
ds_read_b64 v[24:25], v19
MAA 252,120,164
ds_read_b64 v[26:27], v19 offset:256
MAA 252,124,180
ds_read_b32 a192, v18 offset:8
MAA 248,124,176
ds_read_b32 a193, v18 offset:264
v_mov_b32 v18, v5
MAA 248,120,160
buffer_load_dwordx4 a[160:163], v10, s[16:19], s52 offen sc1
MAA 220,104,172
ds_read_b32 a194, v19 offset:8
MAA 220,108,188
ds_read_b32 a195, v19 offset:264
v_add_u32 v19, 992, v5
MAA 216,108,184
TR 40,16,160
MAA 216,104,168
TR 42,16,672
MAA 200,96,168
TR 44,16,8608
MAA 200,100,184
TR 46,16,9120
MAA 204,100,188
buffer_load_dwordx4 a[164:167], v10, s[16:19], s52 offen offset:1024 sc1
MAA 204,96,172
ds_read_b64_tr_b16 a[48:49], v17
s_add_u32 s52, s52, 131072
MAA 156,88,172
TR 50,17,512
MAA 156,92,188
TR 52,17,8448
MAA 152,92,184
TR 54,17,8960
MAA 152,88,168
TR 56,17,32
MAA 136,80,168
TR 58,17,544
MAA 136,84,184
buffer_load_dwordx4 a[176:179], v10, s[16:19], s52 offen sc1
MAA 140,84,188
TR 60,17,8480
MAA 140,80,172
TR 62,17,8992
MAA 92,72,172
MAA 92,76,188
MAA 88,76,184
MAA 88,72,168
MAA 72,64,168
buffer_load_dwordx4 a[180:183], v10, s[16:19], s52 offen offset:1024 sc1
MAA 72,68,184
s_add_u32 s52, s52, 131072
MAA 76,68,188
MAA 76,64,172
s_waitcnt vmcnt(16) lgkmcnt(0)
s_barrier
MAA 32,0,128
ds_read_b128 v[28:31], v9 offset:512
MAA 32,4,144
ds_read_b128 v[4:7], v9 offset:576
MAA 36,4,148
buffer_load_dwordx4 a[168:171], v11, s[16:19], s53 offen sc1
MAA 36,0,132
TR 64,16,16896
MAA 52,8,132
TR 66,16,17408
MAA 52,12,148
TR 68,16,25344
MAA 48,12,144
TR 70,16,25856
MAA 48,8,128
TR 72,16,16928
MAA 96,16,128
buffer_load_dwordx4 a[172:175], v11, s[16:19], s53 offen offset:1024 sc1
MAA 96,20,144
TR 74,16,17440
s_add_u32 s53, s53, 131072
MAA 100,20,148
TR 76,16,25376
s_waitcnt lgkmcnt(8)
v_fmac_f32 v64, v28, v20
MAA 100,16,132
TR 78,16,25888
v_fmac_f32 v65, v29, v20
MAA 116,24,132
TR 80,16,16960
v_fmac_f32 v66, v30, v20
MAA 116,28,148
TR 82,16,17472
v_fmac_f32 v67, v31, v20
MAA 112,28,144
buffer_load_dwordx4 a[184:187], v11, s[16:19], s53 offen sc1
MAA 112,24,128
TR 84,16,25408
v_fmac_f32 v68, v28, v22
MAA 160,32,128
TR 86,16,25920
v_fmac_f32 v69, v29, v22
MAA 160,36,144
TR 88,16,16992
v_fmac_f32 v70, v30, v22
MAA 164,36,148
TR 90,16,17504
v_fmac_f32 v71, v31, v22
MAA 164,32,132
TR 92,16,25440
v_fmac_f32 v72, v28, v24
MAA 180,40,132
buffer_load_dwordx4 a[188:191], v11, s[16:19], s53 offen offset:1024 sc1
MAA 180,44,148
TR 94,16,25952
s_add_u32 s53, s53, 131072
MAA 176,44,144
TR 96,16,17024
s_add_u32 m0, s55, 84480
MAA 176,40,128
TR 98,16,17536
v_fmac_f32 v73, v29, v24
MAA 224,48,128
TR 100,16,25472
v_fmac_f32 v74, v30, v24
MAA 224,52,144
TR 102,16,25984
v_fmac_f32 v75, v31, v24
MAA 228,52,148
buffer_load_dwordx4 v12, s[32:35], s54 offen lds
MAA 228,48,132
TR 104,16,17056
v_fmac_f32 v76, v28, v26
MAA 236,56,132
TR 106,16,17568
v_fmac_f32 v77, v29, v26
MAA 236,60,148
TR 108,16,25504
v_fmac_f32 v78, v30, v26
MAA 232,60,144
TR 110,16,26016
v_fmac_f32 v79, v31, v26
MAA 232,56,128
ds_read_b128 v[28:31], v9 offset:640
s_waitcnt lgkmcnt(15)
v_fmac_f32 v80, v4, v20
s_waitcnt vmcnt(17)
MAA 188,40,140
buffer_load_dwordx4 v13, s[32:35], s54 offen offset:1056 lds
MAA 188,44,156
TR 112,17,16896
v_fmac_f32 v81, v5, v20
MAA 184,44,152
TR 114,17,17408
v_fmac_f32 v82, v6, v20
MAA 184,40,136
TR 116,17,25344
v_fmac_f32 v83, v7, v20
MAA 168,32,136
TR 118,17,25856
v_fmac_f32 v84, v4, v22
MAA 168,36,152
TR 120,17,16928
v_fmac_f32 v85, v5, v22
MAA 172,36,156
buffer_load_dwordx4 v14, s[32:35], s54 offen offset:2112 lds
MAA 172,32,140
TR 122,17,17440
v_fmac_f32 v86, v6, v22
MAA 124,24,140
TR 124,17,25376
v_fmac_f32 v87, v7, v22
MAA 124,28,156
TR 126,17,25888
v_fmac_f32 v88, v4, v24
MAA 120,28,152
v_fmac_f32 v89, v5, v24
v_fmac_f32 v90, v6, v24
MAA 120,24,136
v_fmac_f32 v91, v7, v24
v_fmac_f32 v92, v4, v26
MAA 104,16,136
buffer_load_dwordx4 v15, s[32:35], s54 offen offset:3168 lds
MAA 104,20,152
s_mov_b32 m0, s67
v_fmac_f32 v93, v5, v26
v_fmac_f32 v94, v6, v26
MAA 108,20,156
v_fmac_f32 v95, v7, v26
s_waitcnt lgkmcnt(8)
v_fmac_f32 v128, v28, v20
MAA 108,16,140
ds_read_b128 v[4:7], v8 offset:512
v_fmac_f32 v129, v29, v20
MAA 60,8,140
v_fmac_f32 v130, v30, v20
v_fmac_f32 v131, v31, v20
MAA 60,12,156
v_fmac_f32 v132, v28, v22
v_fmac_f32 v133, v29, v22
MAA 56,12,152
buffer_load_dwordx4 v18, s[28:31], s58 offen lds
MAA 56,8,136
v_fmac_f32 v134, v30, v22
v_fmac_f32 v135, v31, v22
MAA 40,0,136
v_fmac_f32 v136, v28, v24
v_fmac_f32 v137, v29, v24
MAA 40,4,152
v_fmac_f32 v138, v30, v24
v_fmac_f32 v139, v31, v24
MAA 44,4,156
v_fmac_f32 v140, v28, v26
v_fmac_f32 v141, v29, v26
MAA 44,0,140
v_fmac_f32 v142, v30, v26
v_fmac_f32 v143, v31, v26
s_waitcnt lgkmcnt(0)
v_fmac_f32 v240, v4, v20
v_fmac_f32 v241, v5, v20
v_fmac_f32 v242, v6, v20
v_fmac_f32 v243, v7, v20
v_fmac_f32 v244, v4, v22
v_fmac_f32 v245, v5, v22
v_fmac_f32 v246, v6, v22
v_fmac_f32 v247, v7, v22
s_waitcnt vmcnt(17) lgkmcnt(0)
s_barrier
MAA 64,64,128
ds_read_b128 v[28:31], v9
s_add_u32 m0, s55, 101376
MAA 64,68,144
ds_read_b128 v[4:7], v9 offset:64
MAA 68,68,148
buffer_load_dwordx4 v12, s[80:83], s54 offen lds
MAA 68,64,132
TR 0,16,33792
MAA 84,72,132
TR 2,16,34304
MAA 84,76,148
TR 4,16,42240
MAA 80,76,144
TR 6,16,42752
MAA 80,72,128
TR 8,16,33824
MAA 128,80,128
buffer_load_dwordx4 v13, s[80:83], s54 offen offset:1056 lds
MAA 128,84,144
TR 10,16,34336
s_waitcnt lgkmcnt(7)
v_fmac_f32 v32, v28, v20
MAA 132,84,148
TR 12,16,42272
v_fmac_f32 v33, v29, v20
MAA 132,80,132
TR 14,16,42784
v_fmac_f32 v34, v30, v20
MAA 148,88,132
TR 16,16,33856
v_fmac_f32 v35, v31, v20
MAA 148,92,148
TR 18,16,34368
v_fmac_f32 v36, v28, v22
MAA 144,92,144
buffer_load_dwordx4 v14, s[80:83], s54 offen offset:2112 lds
MAA 144,88,128
TR 20,16,42304
v_fmac_f32 v37, v29, v22
MAA 192,96,128
TR 22,16,42816
v_fmac_f32 v38, v30, v22
MAA 192,100,144
TR 24,16,33888
v_fmac_f32 v39, v31, v22
MAA 196,100,148
TR 26,16,34400
v_fmac_f32 v40, v28, v24
MAA 196,96,132
TR 28,16,42336
v_fmac_f32 v41, v29, v24
MAA 212,104,132
buffer_load_dwordx4 v15, s[80:83], s54 offen offset:3168 lds
MAA 212,108,148
TR 30,16,42848
s_add_u32 s54, s54, 458752
MAA 208,108,144
TR 32,16,33920
s_mov_b32 m0, s67
MAA 208,104,128
TR 34,16,34432
v_fmac_f32 v42, v30, v24
MAA 240,112,128
TR 36,16,42368
v_fmac_f32 v43, v31, v24
MAA 240,116,144
TR 38,16,42880
v_fmac_f32 v44, v28, v26
MAA 244,116,148
buffer_load_dwordx4 v19, s[28:31], s58 offen offset:1056 lds
MAA 244,112,132
TR 40,16,33952
s_add_u32 s67, s67, 8448
MAA 252,120,132
TR 42,16,34464
s_add_u32 s58, s58, 0x40000
MAA 252,124,148
TR 44,16,42400
v_fmac_f32 v45, v29, v26
MAA 248,124,144
TR 46,16,42912
v_fmac_f32 v46, v30, v26
MAA 248,120,128
TR 48,17,33792
v_fmac_f32 v47, v31, v26
MAA 220,104,140
ds_read_b128 v[28:31], v9 offset:128
s_waitcnt lgkmcnt(15)
v_fmac_f32 v48, v4, v20
MAA 220,108,156
buffer_load_dwordx4 a[128:131], v10, s[16:19], s52 offen sc1
MAA 216,108,152
TR 50,17,34304
v_fmac_f32 v49, v5, v20
MAA 216,104,136
TR 52,17,42240
v_fmac_f32 v50, v6, v20
MAA 200,96,136
TR 54,17,42752
v_fmac_f32 v51, v7, v20
MAA 200,100,152
TR 56,17,33824
v_fmac_f32 v52, v4, v22
MAA 204,100,156
TR 58,17,34336
.Lpad32:
s_cbranch_execz .Lnopoll60r
v_fmac_f32 v53, v5, v22
MAA 204,96,140
buffer_load_dwordx4 a[132:135], v10, s[16:19], s52 offen offset:1024 sc1
MAA 156,88,140
TR 60,17,42272
s_add_u32 s52, s52, 131072
MAA 156,92,156
TR 62,17,42784
v_fmac_f32 v54, v6, v22
MAA 152,92,152
v_fmac_f32 v55, v7, v22
v_fmac_f32 v56, v4, v24
MAA 152,88,136
v_fmac_f32 v57, v5, v24
v_fmac_f32 v58, v6, v24
MAA 136,80,136
v_fmac_f32 v59, v7, v24
v_fmac_f32 v60, v4, v26
MAA 136,84,152
buffer_load_dwordx4 a[144:147], v10, s[16:19], s52 offen sc1
MAA 140,84,156
v_fmac_f32 v61, v5, v26
v_fmac_f32 v62, v6, v26
MAA 140,80,140
v_fmac_f32 v63, v7, v26
s_waitcnt lgkmcnt(7)
v_fmac_f32 v96, v28, v20
MAA 92,72,140
ds_read_b128 v[4:7], v8
v_fmac_f32 v97, v29, v20
MAA 92,76,156
v_fmac_f32 v98, v30, v20
v_fmac_f32 v99, v31, v20
MAA 88,76,152
v_fmac_f32 v100, v28, v22
v_fmac_f32 v101, v29, v22
MAA 88,72,136
buffer_load_dwordx4 a[148:151], v10, s[16:19], s52 offen offset:1024 sc1
MAA 72,64,136
s_add_u32 s52, s52, 131072
v_fmac_f32 v102, v30, v22
v_fmac_f32 v103, v31, v22
MAA 72,68,152
v_fmac_f32 v104, v28, v24
v_fmac_f32 v105, v29, v24
MAA 76,68,156
v_fmac_f32 v106, v30, v24
v_fmac_f32 v107, v31, v24
MAA 76,64,140
v_fmac_f32 v108, v28, v26
v_fmac_f32 v109, v29, v26
v_fmac_f32 v110, v30, v26
v_fmac_f32 v111, v31, v26
s_waitcnt lgkmcnt(0)
v_fmac_f32 v224, v4, v20
v_fmac_f32 v225, v5, v20
v_fmac_f32 v226, v6, v20
v_fmac_f32 v227, v7, v20
v_fmac_f32 v228, v4, v22
v_fmac_f32 v229, v5, v22
v_fmac_f32 v230, v6, v22
v_fmac_f32 v231, v7, v22
s_waitcnt vmcnt(18) lgkmcnt(0)
s_barrier
MAA 32,0,160
ds_read_b128 v[28:31], v9 offset:704
MAA 32,4,176
ds_read_b128 v[4:7], v9 offset:768
MAA 36,4,180
buffer_load_dwordx4 a[136:139], v11, s[16:19], s53 offen sc1
MAA 36,0,164
TR 64,16,50688
MAA 52,8,164
TR 66,16,51200
MAA 52,12,180
TR 68,16,59136
MAA 48,12,176
TR 70,16,59648
MAA 48,8,160
TR 72,16,50720
MAA 96,16,160
buffer_load_dwordx4 a[140:143], v11, s[16:19], s53 offen offset:1024 sc1
MAA 96,20,176
TR 74,16,51232
s_add_u32 s53, s53, 131072
MAA 100,20,180
TR 76,16,59168
s_waitcnt lgkmcnt(8)
v_fmac_f32 v144, v28, v20
MAA 100,16,164
TR 78,16,59680
v_fmac_f32 v145, v29, v20
MAA 116,24,164
TR 80,16,50752
v_fmac_f32 v146, v30, v20
MAA 116,28,180
TR 82,16,51264
v_fmac_f32 v147, v31, v20
MAA 112,28,176
buffer_load_dwordx4 a[152:155], v11, s[16:19], s53 offen sc1
MAA 112,24,160
TR 84,16,59200
v_fmac_f32 v148, v28, v22
MAA 160,32,160
TR 86,16,59712
v_fmac_f32 v149, v29, v22
MAA 160,36,176
TR 88,16,50784
v_fmac_f32 v150, v30, v22
MAA 164,36,180
TR 90,16,51296
v_fmac_f32 v151, v31, v22
MAA 164,32,164
TR 92,16,59232
v_fmac_f32 v152, v28, v24
MAA 180,40,164
buffer_load_dwordx4 a[156:159], v11, s[16:19], s53 offen offset:1024 sc1
MAA 180,44,180
TR 94,16,59744
s_add_u32 s53, s53, 131072
MAA 176,44,176
TR 96,16,50816
s_add_u32 m0, s55, 118272
MAA 176,40,160
TR 98,16,51328
v_fmac_f32 v153, v29, v24
MAA 224,48,160
TR 100,16,59264
v_fmac_f32 v154, v30, v24
MAA 224,52,176
TR 102,16,59776
v_fmac_f32 v155, v31, v24
MAA 228,52,180
buffer_load_dwordx4 v12, s[32:35], s54 offen lds
MAA 228,48,164
TR 104,16,50848
v_fmac_f32 v156, v28, v26
MAA 236,56,164
TR 106,16,51360
v_fmac_f32 v157, v29, v26
MAA 236,60,180
TR 108,16,59296
v_fmac_f32 v158, v30, v26
MAA 232,60,176
TR 110,16,59808
v_fmac_f32 v159, v31, v26
MAA 232,56,160
ds_read_b128 v[28:31], v9 offset:832
s_waitcnt lgkmcnt(15)
v_fmac_f32 v192, v4, v20
s_waitcnt vmcnt(19)
MAA 188,40,172
buffer_load_dwordx4 v13, s[32:35], s54 offen offset:1056 lds
MAA 188,44,188
TR 112,17,50688
v_fmac_f32 v193, v5, v20
MAA 184,44,184
TR 114,17,51200
v_fmac_f32 v194, v6, v20
MAA 184,40,168
TR 116,17,59136
v_fmac_f32 v195, v7, v20
MAA 168,32,168
TR 118,17,59648
v_fmac_f32 v196, v4, v22
MAA 168,36,184
TR 120,17,50720
v_fmac_f32 v197, v5, v22
MAA 172,36,188
buffer_load_dwordx4 v14, s[32:35], s54 offen offset:2112 lds
MAA 172,32,172
TR 122,17,51232
v_fmac_f32 v198, v6, v22
MAA 124,24,172
TR 124,17,59168
v_fmac_f32 v199, v7, v22
MAA 124,28,188
TR 126,17,59680
v_fmac_f32 v200, v4, v24
MAA 120,28,184
v_fmac_f32 v201, v5, v24
v_fmac_f32 v202, v6, v24
MAA 120,24,168
v_fmac_f32 v203, v7, v24
v_fmac_f32 v204, v4, v26
MAA 104,16,168
buffer_load_dwordx4 v15, s[32:35], s54 offen offset:3168 lds
MAA 104,20,184
s_mov_b32 m0, s67
v_fmac_f32 v205, v5, v26
v_fmac_f32 v206, v6, v26
MAA 108,20,188
v_fmac_f32 v207, v7, v26
s_waitcnt lgkmcnt(8)
v_fmac_f32 v208, v28, v20
MAA 108,16,172
ds_read_b128 v[4:7], v8 offset:576
v_fmac_f32 v209, v29, v20
MAA 60,8,172
v_fmac_f32 v210, v30, v20
v_fmac_f32 v211, v31, v20
MAA 60,12,188
v_fmac_f32 v212, v28, v22
v_fmac_f32 v213, v29, v22
MAA 56,12,184
buffer_load_dwordx4 v18, s[28:31], s58 offen lds
MAA 56,8,168
v_fmac_f32 v214, v30, v22
v_fmac_f32 v215, v31, v22
MAA 40,0,168
v_fmac_f32 v216, v28, v24
v_fmac_f32 v217, v29, v24
MAA 40,4,184
v_fmac_f32 v218, v30, v24
v_fmac_f32 v219, v31, v24
MAA 44,4,188
v_fmac_f32 v220, v28, v26
v_fmac_f32 v221, v29, v26
MAA 44,0,172
v_fmac_f32 v222, v30, v26
v_fmac_f32 v223, v31, v26
s_waitcnt lgkmcnt(0)
v_fmac_f32 v248, v4, v20
v_fmac_f32 v249, v5, v20
v_fmac_f32 v250, v6, v20
v_fmac_f32 v251, v7, v20
v_fmac_f32 v252, v4, v22
v_fmac_f32 v253, v5, v22
v_fmac_f32 v254, v6, v22
v_fmac_f32 v255, v7, v22
s_waitcnt vmcnt(19) lgkmcnt(0)
s_barrier
MAA 64,64,160
ds_read_b128 v[28:31], v9 offset:192
s_add_u32 m0, s55, 135168
MAA 64,68,176
ds_read_b128 v[4:7], v9 offset:256
MAA 68,68,180
buffer_load_dwordx4 v12, s[80:83], s54 offen lds
MAA 68,64,164
ds_read_b64_tr_b16 a[0:1], v16
MAA 84,72,164
TR 2,16,512
MAA 84,76,180
TR 4,16,8448
MAA 80,76,176
TR 6,16,8960
MAA 80,72,160
TR 8,16,32
MAA 128,80,160
buffer_load_dwordx4 v13, s[80:83], s54 offen offset:1056 lds
MAA 128,84,176
TR 10,16,544
s_waitcnt lgkmcnt(7)
v_fmac_f32 v112, v28, v20
MAA 132,84,180
TR 12,16,8480
v_fmac_f32 v113, v29, v20
MAA 132,80,164
TR 14,16,8992
v_fmac_f32 v114, v30, v20
MAA 148,88,164
TR 16,16,64
v_fmac_f32 v115, v31, v20
MAA 148,92,180
TR 18,16,576
v_fmac_f32 v116, v28, v22
MAA 144,92,176
buffer_load_dwordx4 v14, s[80:83], s54 offen offset:2112 lds
MAA 144,88,160
TR 20,16,8512
v_fmac_f32 v117, v29, v22
MAA 192,96,160
TR 22,16,9024
v_fmac_f32 v118, v30, v22
MAA 192,100,176
TR 24,16,96
v_fmac_f32 v119, v31, v22
MAA 196,100,180
TR 26,16,608
v_fmac_f32 v120, v28, v24
MAA 196,96,164
TR 28,16,8544
v_fmac_f32 v121, v29, v24
MAA 212,104,164
buffer_load_dwordx4 v15, s[80:83], s54 offen offset:3168 lds
MAA 212,108,180
TR 30,16,9056
s_add_u32 s54, s54, 458752
MAA 208,108,176
TR 32,16,128
s_mov_b32 m0, s67
MAA 208,104,160
TR 34,16,640
v_fmac_f32 v122, v30, v24
MAA 240,112,160
TR 36,16,8576
v_fmac_f32 v123, v31, v24
MAA 240,116,176
TR 38,16,9088
v_fmac_f32 v124, v28, v26
MAA 244,116,180
buffer_load_dwordx4 v19, s[28:31], s58 offen offset:1056 lds
MAA 244,112,164
TR 40,16,160
s_add_u32 s67, s67, 8448
MAA 252,120,164
TR 42,16,672
s_add_u32 s46, s46, 1
MAA 252,124,180
TR 44,16,8608
s_xor_b32 s58, s46, s87
MAA 248,124,176
TR 46,16,9120
s_mul_i32 s58, s58, 458752
MAA 248,120,160
ds_read_b64_tr_b16 a[48:49], v17
v_fmac_f32 v125, v29, v26
MAA 220,104,172
buffer_load_dwordx4 a[160:163], v10, s[16:19], s52 offen sc1
MAA 220,108,188
TR 50,17,512
v_fmac_f32 v126, v30, v26
MAA 216,108,184
TR 52,17,8448
v_fmac_f32 v127, v31, v26
MAA 216,104,168
ds_read_b128 v[28:31], v9 offset:320
s_waitcnt lgkmcnt(15)
v_fmac_f32 v160, v4, v20
MAA 200,96,168
TR 54,17,8960
v_fmac_f32 v161, v5, v20
MAA 200,100,184
TR 56,17,32
v_fmac_f32 v162, v6, v20
MAA 204,100,188
buffer_load_dwordx4 a[164:167], v10, s[16:19], s52 offen offset:1024 sc1
MAA 204,96,172
TR 58,17,544
s_add_u32 s52, s52, 131072
MAA 156,88,172
TR 60,17,8480
v_fmac_f32 v163, v7, v20
MAA 156,92,188
TR 62,17,8992
v_fmac_f32 v164, v4, v22
MAA 152,92,184
v_fmac_f32 v165, v5, v22
v_fmac_f32 v166, v6, v22
MAA 152,88,168
v_fmac_f32 v167, v7, v22
v_fmac_f32 v168, v4, v24
MAA 136,80,168
buffer_load_dwordx4 a[176:179], v10, s[16:19], s52 offen sc1
MAA 136,84,184
v_fmac_f32 v169, v5, v24
v_fmac_f32 v170, v6, v24
MAA 140,84,188
v_fmac_f32 v171, v7, v24
v_fmac_f32 v172, v4, v26
MAA 140,80,172
v_fmac_f32 v173, v5, v26
v_fmac_f32 v174, v6, v26
MAA 92,72,172
v_fmac_f32 v175, v7, v26
s_waitcnt lgkmcnt(5)
v_fmac_f32 v176, v28, v20
MAA 92,76,188
ds_read_b128 v[4:7], v8 offset:64
v_fmac_f32 v177, v29, v20
MAA 88,76,184
buffer_load_dwordx4 a[180:183], v10, s[16:19], s52 offen offset:1024 sc1
MAA 88,72,168
s_add_u32 s52, s52, 131072
v_fmac_f32 v178, v30, v20
v_fmac_f32 v179, v31, v20
MAA 72,64,168
v_fmac_f32 v180, v28, v22
v_fmac_f32 v181, v29, v22
MAA 72,68,184
v_fmac_f32 v182, v30, v22
v_fmac_f32 v183, v31, v22
MAA 76,68,188
v_fmac_f32 v184, v28, v24
v_fmac_f32 v185, v29, v24
MAA 76,64,172
v_fmac_f32 v186, v30, v24
v_fmac_f32 v187, v31, v24
v_fmac_f32 v188, v28, v26
v_fmac_f32 v189, v29, v26
v_fmac_f32 v190, v30, v26
v_fmac_f32 v191, v31, v26
v_accvgpr_read_b32 v28, a192
s_waitcnt lgkmcnt(0)
v_fmac_f32 v232, v4, v20
v_fmac_f32 v233, v5, v20
v_fmac_f32 v234, v6, v20
v_fmac_f32 v235, v7, v20
v_fmac_f32 v236, v4, v22
v_fmac_f32 v237, v5, v22
v_fmac_f32 v238, v6, v22
v_fmac_f32 v239, v7, v22
v_accvgpr_read_b32 v29, a193
v_accvgpr_read_b32 v30, a194
v_accvgpr_read_b32 v31, a195
s_mov_b32 s15, -4
.p2align 6
.Lk65:
s_waitcnt vmcnt(18) lgkmcnt(0)
s_barrier
MAA 32,0,128
TR 64,16,16896
MAA 32,4,144
buffer_load_dwordx4 a[168:171], v11, s[16:19], s53 offen sc1
MAA 36,4,148
TR 66,16,17408
MAA 36,0,132
TR 68,16,25344
MAA 52,8,132
TR 70,16,25856
MAA 52,12,148
MAA 48,12,144
TR 72,16,16928
MAA 48,8,128
buffer_load_dwordx4 a[172:175], v11, s[16:19], s53 offen offset:1024 sc1
MAA 96,16,128
TR 74,16,17440
s_add_u32 s53, s53, 131072
MAA 96,20,144
TR 76,16,25376
MAA 100,20,148
MAA 100,16,132
TR 78,16,25888
MAA 116,24,132
TR 80,16,16960
MAA 116,28,148
buffer_load_dwordx4 a[184:187], v11, s[16:19], s53 offen sc1
MAA 112,28,144
TR 82,16,17472
MAA 112,24,128
MAA 160,32,128
TR 84,16,25408
MAA 160,36,144
TR 86,16,25920
MAA 164,36,148
TR 88,16,16992
MAA 164,32,132
buffer_load_dwordx4 a[188:191], v11, s[16:19], s53 offen offset:1024 sc1
MAA 180,40,132
s_add_u32 s53, s53, 131072
MAA 180,44,148
TR 90,16,17504
MAA 176,44,144
TR 92,16,25440
MAA 176,40,128
TR 94,16,25952
MAA 224,48,128
s_add_u32 m0, s55, 84480
MAA 224,52,144
buffer_load_dwordx4 v12, s[32:35], s54 offen lds
MAA 228,52,148
TR 96,16,17024
MAA 228,48,132
TR 98,16,17536
MAA 236,56,132
TR 100,16,25472
MAA 236,60,148
TR 102,16,25984
MAA 232,60,144
MAA 232,56,128
TR 104,16,17056
s_waitcnt vmcnt(19)
MAA 188,40,140
TR 106,16,17568
MAA 188,44,156
buffer_load_dwordx4 v13, s[32:35], s54 offen offset:1056 lds
MAA 184,44,152
TR 108,16,25504
MAA 184,40,136
MAA 168,32,136
TR 110,16,26016
MAA 168,36,152
buffer_load_dwordx4 v14, s[32:35], s54 offen offset:2112 lds
MAA 172,36,156
TR 112,17,16896
MAA 172,32,140
TR 114,17,17408
MAA 124,24,140
MAA 124,28,156
TR 116,17,25344
MAA 120,28,152
TR 118,17,25856
MAA 120,24,136
buffer_load_dwordx4 v15, s[32:35], s54 offen offset:3168 lds
MAA 104,16,136
TR 120,17,16928
MAA 104,20,152
MAA 108,20,156
TR 122,17,17440
MAA 108,16,140
TR 124,17,25376
MAA 60,8,140
TR 126,17,25888
s_mov_b32 m0, s67
MAA 60,12,156
buffer_load_dwordx4 v18, s[28:31], s58 offen lds
MAA 56,12,152
MAA 56,8,136
MAA 40,0,136
MAA 40,4,152
MAA 44,4,156
MAA 44,0,140
s_waitcnt vmcnt(19) lgkmcnt(0)
s_barrier
MAA 64,64,128
TR 0,16,33792
s_add_u32 m0, s55, 101376
MAA 64,68,144
buffer_load_dwordx4 v12, s[80:83], s54 offen lds
MAA 68,68,148
TR 2,16,34304
MAA 68,64,132
TR 4,16,42240
MAA 84,72,132
TR 6,16,42752
MAA 84,76,148
MAA 80,76,144
TR 8,16,33824
MAA 80,72,128
buffer_load_dwordx4 v13, s[80:83], s54 offen offset:1056 lds
MAA 128,80,128
TR 10,16,34336
MAA 128,84,144
TR 12,16,42272
MAA 132,84,148
TR 14,16,42784
MAA 132,80,132
MAA 148,88,132
TR 16,16,33856
MAA 148,92,148
buffer_load_dwordx4 v14, s[80:83], s54 offen offset:2112 lds
MAA 144,92,144
TR 18,16,34368
MAA 144,88,128
TR 20,16,42304
MAA 192,96,128
MAA 192,100,144
TR 22,16,42816
MAA 196,100,148
TR 24,16,33888
MAA 196,96,132
buffer_load_dwordx4 v15, s[80:83], s54 offen offset:3168 lds
MAA 212,104,132
TR 26,16,34400
s_add_u32 s54, s54, 458752
MAA 212,108,148
TR 28,16,42336
MAA 208,108,144
MAA 208,104,128
TR 30,16,42848
MAA 240,112,128
TR 32,16,33920
s_mov_b32 m0, s67
MAA 240,116,144
buffer_load_dwordx4 v19, s[28:31], s58 offen offset:1056 lds
MAA 244,116,148
s_add_u32 s67, s67, 8448
s_add_u32 s58, s58, 0x40000
MAA 244,112,132
TR 34,16,34432
MAA 252,120,132
MAA 252,124,148
TR 36,16,42368
MAA 248,124,144
TR 38,16,42880
MAA 248,120,128
buffer_load_dwordx4 a[128:131], v10, s[16:19], s52 offen sc1
MAA 220,104,140
TR 40,16,33952
MAA 220,108,156
TR 42,16,34464
MAA 216,108,152
MAA 216,104,136
TR 44,16,42400
MAA 200,96,136
TR 46,16,42912
MAA 200,100,152
buffer_load_dwordx4 a[132:135], v10, s[16:19], s52 offen offset:1024 sc1
MAA 204,100,156
TR 48,17,33792
s_add_u32 s52, s52, 131072
MAA 204,96,140
MAA 156,88,140
TR 50,17,34304
MAA 156,92,156
TR 52,17,42240
.Lpad33:
s_cbranch_execz .Lnopoll60r
MAA 152,92,152
TR 54,17,42752
MAA 152,88,136
buffer_load_dwordx4 a[144:147], v10, s[16:19], s52 offen sc1
MAA 136,80,136
TR 56,17,33824
MAA 136,84,152
MAA 140,84,156
TR 58,17,34336
MAA 140,80,140
TR 60,17,42272
MAA 92,72,140
TR 62,17,42784
MAA 92,76,156
buffer_load_dwordx4 a[148:151], v10, s[16:19], s52 offen offset:1024 sc1
MAA 88,76,152
s_add_u32 s52, s52, 131072
MAA 88,72,136
MAA 72,64,136
MAA 72,68,152
MAA 76,68,156
MAA 76,64,140
s_waitcnt vmcnt(18) lgkmcnt(0)
s_barrier
MAA 32,0,160
TR 64,16,50688
MAA 32,4,176
buffer_load_dwordx4 a[136:139], v11, s[16:19], s53 offen sc1
MAA 36,4,180
TR 66,16,51200
MAA 36,0,164
TR 68,16,59136
MAA 52,8,164
TR 70,16,59648
MAA 52,12,180
MAA 48,12,176
TR 72,16,50720
MAA 48,8,160
buffer_load_dwordx4 a[140:143], v11, s[16:19], s53 offen offset:1024 sc1
MAA 96,16,160
TR 74,16,51232
s_add_u32 s53, s53, 131072
MAA 96,20,176
TR 76,16,59168
MAA 100,20,180
MAA 100,16,164
TR 78,16,59680
MAA 116,24,164
TR 80,16,50752
MAA 116,28,180
buffer_load_dwordx4 a[152:155], v11, s[16:19], s53 offen sc1
MAA 112,28,176
TR 82,16,51264
MAA 112,24,160
MAA 160,32,160
TR 84,16,59200
MAA 160,36,176
TR 86,16,59712
MAA 164,36,180
TR 88,16,50784
MAA 164,32,164
buffer_load_dwordx4 a[156:159], v11, s[16:19], s53 offen offset:1024 sc1
MAA 180,40,164
s_add_u32 s53, s53, 131072
MAA 180,44,180
TR 90,16,51296
MAA 176,44,176
TR 92,16,59232
MAA 176,40,160
TR 94,16,59744
MAA 224,48,160
s_add_u32 m0, s55, 118272
MAA 224,52,176
buffer_load_dwordx4 v12, s[32:35], s54 offen lds
MAA 228,52,180
TR 96,16,50816
MAA 228,48,164
TR 98,16,51328
MAA 236,56,164
TR 100,16,59264
MAA 236,60,180
TR 102,16,59776
MAA 232,60,176
MAA 232,56,160
TR 104,16,50848
s_waitcnt vmcnt(19)
MAA 188,40,172
TR 106,16,51360
MAA 188,44,188
buffer_load_dwordx4 v13, s[32:35], s54 offen offset:1056 lds
MAA 184,44,184
TR 108,16,59296
MAA 184,40,168
MAA 168,32,168
TR 110,16,59808
MAA 168,36,184
buffer_load_dwordx4 v14, s[32:35], s54 offen offset:2112 lds
MAA 172,36,188
TR 112,17,50688
MAA 172,32,172
TR 114,17,51200
MAA 124,24,172
MAA 124,28,188
TR 116,17,59136
MAA 120,28,184
TR 118,17,59648
MAA 120,24,168
buffer_load_dwordx4 v15, s[32:35], s54 offen offset:3168 lds
MAA 104,16,168
TR 120,17,50720
MAA 104,20,184
MAA 108,20,188
TR 122,17,51232
MAA 108,16,172
TR 124,17,59168
MAA 60,8,172
TR 126,17,59680
s_mov_b32 m0, s67
MAA 60,12,188
buffer_load_dwordx4 v18, s[28:31], s58 offen lds
MAA 56,12,184
MAA 56,8,168
MAA 40,0,168
MAA 40,4,184
MAA 44,4,188
MAA 44,0,172
s_waitcnt vmcnt(19) lgkmcnt(0)
s_barrier
MAA 64,64,160
ds_read_b64_tr_b16 a[0:1], v16
s_add_u32 m0, s55, 135168
MAA 64,68,176
buffer_load_dwordx4 v12, s[80:83], s54 offen lds
MAA 68,68,180
TR 2,16,512
MAA 68,64,164
TR 4,16,8448
MAA 84,72,164
TR 6,16,8960
MAA 84,76,180
MAA 80,76,176
TR 8,16,32
MAA 80,72,160
buffer_load_dwordx4 v13, s[80:83], s54 offen offset:1056 lds
MAA 128,80,160
TR 10,16,544
MAA 128,84,176
TR 12,16,8480
MAA 132,84,180
TR 14,16,8992
MAA 132,80,164
MAA 148,88,164
TR 16,16,64
MAA 148,92,180
buffer_load_dwordx4 v14, s[80:83], s54 offen offset:2112 lds
MAA 144,92,176
TR 18,16,576
MAA 144,88,160
TR 20,16,8512
MAA 192,96,160
MAA 192,100,176
TR 22,16,9024
MAA 196,100,180
TR 24,16,96
MAA 196,96,164
buffer_load_dwordx4 v15, s[80:83], s54 offen offset:3168 lds
MAA 212,104,164
TR 26,16,608
s_add_u32 s54, s54, 458752
MAA 212,108,180
TR 28,16,8544
MAA 208,108,176
MAA 208,104,160
TR 30,16,9056
MAA 240,112,160
TR 32,16,128
s_mov_b32 m0, s67
MAA 240,116,176
buffer_load_dwordx4 v19, s[28:31], s58 offen offset:1056 lds
MAA 244,116,180
s_add_u32 s67, s67, 8448
s_add_u32 s46, s46, 1
s_xor_b32 s58, s46, s87
s_mul_i32 s58, s58, 458752
MAA 244,112,164
TR 34,16,640
MAA 252,120,164
MAA 252,124,180
TR 36,16,8576
MAA 248,124,176
TR 38,16,9088
MAA 248,120,160
buffer_load_dwordx4 a[160:163], v10, s[16:19], s52 offen sc1
MAA 220,104,172
TR 40,16,160
MAA 220,108,188
TR 42,16,672
MAA 216,108,184
MAA 216,104,168
TR 44,16,8608
MAA 200,96,168
TR 46,16,9120
MAA 200,100,184
buffer_load_dwordx4 a[164:167], v10, s[16:19], s52 offen offset:1024 sc1
MAA 204,100,188
ds_read_b64_tr_b16 a[48:49], v17
s_add_u32 s52, s52, 131072
MAA 204,96,172
MAA 156,88,172
TR 50,17,512
MAA 156,92,188
TR 52,17,8448
MAA 152,92,184
TR 54,17,8960
MAA 152,88,168
buffer_load_dwordx4 a[176:179], v10, s[16:19], s52 offen sc1
MAA 136,80,168
TR 56,17,32
MAA 136,84,184
MAA 140,84,188
TR 58,17,544
MAA 140,80,172
TR 60,17,8480
MAA 92,72,172
TR 62,17,8992
MAA 92,76,188
buffer_load_dwordx4 a[180:183], v10, s[16:19], s52 offen offset:1024 sc1
MAA 88,76,184
s_add_u32 s52, s52, 131072
MAA 88,72,168
MAA 72,64,168
MAA 72,68,184
MAA 76,68,188
s_add_u32 s15, s15, 1
MAA 76,64,172
s_cbranch_scc0 .Lk65
s_waitcnt vmcnt(10) lgkmcnt(0)
s_barrier
MAA 32,0,128
buffer_load_dwordx4 a[168:171], v11, s[16:19], s53 offen sc1
MAA 32,4,144
TR 64,16,16896
s_add_u32 s58, s99, 2293760
MAA 48,12,144
TR 66,16,17408
s_lshl_b32 s74, s3, 11
MAA 48,8,128
TR 68,16,25344
s_add_u32 s74, s74, s84
MAA 36,0,132
buffer_load_dwordx4 a[172:175], v11, s[16:19], s53 offen offset:1024 sc1
MAA 36,4,148
TR 70,16,25856
s_add_u32 s53, s53, 131072
MAA 52,12,148
TR 72,16,16928
v_lshl_add_u32 v4, v1, 4, s74
MAA 52,8,132
TR 74,16,17440
v_lshrrev_b32 v2, 3, v1
MAA 40,0,136
buffer_load_dwordx4 a[184:187], v11, s[16:19], s53 offen sc1
MAA 40,4,152
TR 76,16,25376
v_cmp_eq_u32 vcc, 3, v2
MAA 56,12,152
TR 78,16,25888
v_add_u32 v2, 67108480, v4
MAA 56,8,136
TR 80,16,33792
v_cndmask_b32 v4, v4, v2, vcc
MAA 44,0,140
buffer_load_dwordx4 a[188:191], v11, s[16:19], s53 offen offset:1024 sc1
MAA 44,4,156
TR 82,16,34304
s_add_u32 s53, s53, 131072
MAA 60,12,156
TR 84,16,42240
s_and_b32 s74, s7, 1
MAA 60,8,140
TR 86,16,42752
s_add_u32 s54, s98, 65536
MAA 96,16,128
TR 88,16,33824
v_bfe_u32 v7, v1, 2, 3
MAA 96,20,144
TR 90,16,34336
v_mul_u32_u24 v7, 1056, v7
MAA 112,28,144
TR 92,16,42272
s_waitcnt vmcnt(9)
s_barrier
MAA 112,24,128
TR 94,16,42784
v_bfe_u32 v2, v1, 5, 1
MAA 100,16,132
TR 96,16,50688
v_lshl_add_u32 v7, v2, 8, v7
MAA 100,20,148
TR 98,16,51200
v_and_b32 v2, 3, v1
MAA 116,28,148
TR 100,16,59136
v_lshl_add_u32 v7, v2, 3, v7
MAA 116,24,132
TR 102,16,59648
s_lshl_b32 s74, s74, 7
MAA 104,16,136
TR 104,16,50720
s_xor_b32 s75, s74, 128
MAA 104,20,152
TR 106,16,51232
v_add_u32 v6, s75, v7
MAA 120,28,152
TR 108,16,59168
v_add_u32 v7, s74, v7
MAA 120,24,136
TR 110,16,59680
s_mul_i32 s55, s3, 2112
MAA 108,16,140
TR 112,16,16960
s_mov_b32 s57, 67584
MAA 108,20,156
TR 114,16,17472
MAA 124,28,156
TR 116,16,25408
MAA 124,24,140
TR 118,16,25920
MAA 160,32,128
TR 120,16,16992
MAA 160,36,144
TR 122,16,17504
MAA 176,44,144
TR 124,16,25440
MAA 176,40,128
TR 126,16,25952
MAA 164,32,132
TR 192,16,33856
MAA 164,36,148
TR 194,16,34368
MAA 180,44,148
TR 196,16,42304
MAA 180,40,132
TR 198,16,42816
MAA 168,32,136
TR 200,16,33888
MAA 168,36,152
TR 202,16,34400
MAA 184,44,152
TR 204,16,42336
MAA 184,40,136
TR 206,16,42848
MAA 172,32,140
TR 208,16,50752
MAA 172,36,156
TR 210,16,51264
MAA 188,44,156
TR 212,16,59200
MAA 188,40,140
TR 214,16,59712
MAA 224,48,128
TR 216,16,50784
MAA 224,52,144
TR 218,16,51296
MAA 232,60,144
TR 220,16,59232
MAA 232,56,128
TR 222,16,59744
MAA 228,48,132
TR 0,16,17024
MAA 228,52,148
TR 2,16,17536
MAA 236,60,148
TR 4,16,25472
MAA 236,56,132
TR 6,16,25984
s_waitcnt lgkmcnt(15)
MAA 64,64,128
TR 8,16,17056
MAA 64,68,144
TR 10,16,17568
s_waitcnt vmcnt(7)
MAA 64,96,160
TR 12,16,25504
s_waitcnt vmcnt(5)
MAA 64,100,176
TR 14,16,26016
MAA 80,108,176
TR 16,16,33920
MAA 80,104,160
TR 18,16,34432
MAA 80,76,144
TR 20,16,42368
MAA 80,72,128
TR 22,16,42880
MAA 32,80,160
TR 24,16,33952
MAA 32,84,176
TR 26,16,34464
MAA 48,92,176
TR 28,16,42400
MAA 48,88,160
TR 30,16,42912
s_nop 2
v_pk_mul_f32 v[64:65], v[64:65], v[32:33]
TR 32,16,50816
TR 34,16,51328
v_pk_mul_f32 v[32:33], v[32:33], v[28:29] op_sel_hi:[1,0]
v_pk_mul_f32 v[66:67], v[66:67], v[34:35]
v_pk_mul_f32 v[34:35], v[34:35], v[28:29] op_sel_hi:[1,0]
v_exp_f32 v32, v32
v_pk_mul_f32 v[80:81], v[80:81], v[48:49]
v_pk_mul_f32 v[48:49], v[48:49], v[28:29] op_sel_hi:[1,0]
v_pk_mul_f32 v[82:83], v[82:83], v[50:51]
v_pk_mul_f32 v[50:51], v[50:51], v[28:29] op_sel_hi:[1,0]
v_exp_f32 v33, v33
v_exp_f32 v34, v34
MAA 68,64,132
TR 36,16,59264
v_exp_f32 v35, v35
MAA 68,68,148
TR 38,16,59776
v_exp_f32 v48, v48
MAA 68,96,164
TR 40,16,50848
v_exp_f32 v49, v49
s_waitcnt vmcnt(4)
MAA 68,100,180
TR 42,16,51360
v_exp_f32 v50, v50
MAA 84,108,180
TR 44,16,59296
v_exp_f32 v51, v51
MAA 84,104,164
TR 46,16,59808
MAA 84,76,148
TR 48,17,16896
MAA 84,72,132
TR 50,17,17408
MAA 36,80,164
TR 52,17,25344
MAA 36,84,180
TR 54,17,25856
MAA 52,92,180
TR 56,17,16928
MAA 52,88,164
TR 58,17,17440
s_nop 2
v_pk_mul_f32 v[68:69], v[68:69], v[36:37]
v_pk_fma_f32 v[32:33], v[32:33], v[20:21], v[20:21] op_sel:[0,1,1] op_sel_hi:[1,1,1]
v_pk_fma_f32 v[34:35], v[34:35], v[20:21], v[20:21] op_sel:[0,1,1] op_sel_hi:[1,1,1]
v_pk_mul_f32 v[36:37], v[36:37], v[28:29] op_sel:[0,1] op_sel_hi:[1,1]
v_pk_mul_f32 v[70:71], v[70:71], v[38:39]
v_pk_mul_f32 v[38:39], v[38:39], v[28:29] op_sel:[0,1] op_sel_hi:[1,1]
v_pk_fma_f32 v[48:49], v[48:49], v[20:21], v[20:21] op_sel:[0,1,1] op_sel_hi:[1,1,1]
v_pk_mul_f32 v[84:85], v[84:85], v[52:53]
v_pk_mul_f32 v[52:53], v[52:53], v[28:29] op_sel:[0,1] op_sel_hi:[1,1]
v_pk_mul_f32 v[86:87], v[86:87], v[54:55]
v_pk_mul_f32 v[54:55], v[54:55], v[28:29] op_sel:[0,1] op_sel_hi:[1,1]
v_pk_fma_f32 v[50:51], v[50:51], v[20:21], v[20:21] op_sel:[0,1,1] op_sel_hi:[1,1,1]
v_rcp_f32 v32, v32
v_rcp_f32 v33, v33
MAA 72,64,136
TR 60,17,25376
v_rcp_f32 v34, v34
MAA 72,68,152
TR 62,17,25888
v_rcp_f32 v35, v35
s_waitcnt vmcnt(3)
MAA 72,96,168
v_rcp_f32 v48, v48
s_waitcnt vmcnt(1)
MAA 72,100,184
v_rcp_f32 v49, v49
MAA 88,108,184
v_rcp_f32 v50, v50
MAA 88,104,168
v_rcp_f32 v51, v51
MAA 88,76,152
v_exp_f32 v36, v36
MAA 88,72,136
v_exp_f32 v37, v37
MAA 40,80,168
v_exp_f32 v38, v38
MAA 40,84,184
v_exp_f32 v39, v39
MAA 56,92,184
v_exp_f32 v52, v52
MAA 56,88,168
v_exp_f32 v53, v53
v_exp_f32 v54, v54
v_exp_f32 v55, v55
v_pk_mul_f32 v[64:65], v[64:65], v[32:33]
v_pk_mul_f32 v[66:67], v[66:67], v[34:35]
v_pk_mul_f32 v[80:81], v[80:81], v[48:49]
v_pk_mul_f32 v[82:83], v[82:83], v[50:51]
v_pk_mul_f32 v[72:73], v[72:73], v[40:41]
v_pk_mul_f32 v[40:41], v[40:41], v[30:31] op_sel_hi:[1,0]
v_pk_mul_f32 v[74:75], v[74:75], v[42:43]
v_pk_mul_f32 v[42:43], v[42:43], v[30:31] op_sel_hi:[1,0]
v_pk_mul_f32 v[88:89], v[88:89], v[56:57]
v_pk_mul_f32 v[56:57], v[56:57], v[30:31] op_sel_hi:[1,0]
v_pk_mul_f32 v[90:91], v[90:91], v[58:59]
v_pk_mul_f32 v[58:59], v[58:59], v[30:31] op_sel_hi:[1,0]
v_pk_fma_f32 v[36:37], v[36:37], v[22:23], v[22:23] op_sel:[0,1,1] op_sel_hi:[1,1,1]
v_pk_fma_f32 v[38:39], v[38:39], v[22:23], v[22:23] op_sel:[0,1,1] op_sel_hi:[1,1,1]
v_pk_fma_f32 v[52:53], v[52:53], v[22:23], v[22:23] op_sel:[0,1,1] op_sel_hi:[1,1,1]
v_pk_fma_f32 v[54:55], v[54:55], v[22:23], v[22:23] op_sel:[0,1,1] op_sel_hi:[1,1,1]
v_cvt_pk_bf16_f32 v32, v64, v65
v_cvt_pk_bf16_f32 v33, v66, v67
v_cvt_pk_bf16_f32 v34, v80, v81
v_cvt_pk_bf16_f32 v35, v82, v83
MAA 76,64,140
buffer_store_dwordx4 v[32:35], v10, s[16:19], s62 offen sc1
MAA 76,68,156
TR 64,17,33792
v_rcp_f32 v36, v36
MAA 76,96,172
TR 66,17,34304
v_rcp_f32 v37, v37
s_waitcnt vmcnt(1)
MAA 76,100,188
TR 68,17,42240
v_rcp_f32 v38, v38
MAA 92,108,188
TR 70,17,42752
v_rcp_f32 v39, v39
MAA 92,104,172
v_rcp_f32 v52, v52
MAA 92,76,156
TR 76,17,42272
v_rcp_f32 v53, v53
MAA 92,72,140
TR 72,17,33824
v_rcp_f32 v54, v54
MAA 44,80,172
TR 74,17,34336
v_rcp_f32 v55, v55
MAA 44,84,188
TR 78,17,42784
v_exp_f32 v40, v40
MAA 60,92,188
TR 80,17,50688
v_exp_f32 v41, v41
MAA 60,88,172
.Lpad34:
s_cbranch_execz .Lpad37
TR 82,17,51200
v_exp_f32 v42, v42
v_exp_f32 v43, v43
v_exp_f32 v56, v56
v_exp_f32 v57, v57
v_exp_f32 v58, v58
v_exp_f32 v59, v59
v_pk_mul_f32 v[68:69], v[68:69], v[36:37]
v_pk_mul_f32 v[70:71], v[70:71], v[38:39]
v_pk_mul_f32 v[84:85], v[84:85], v[52:53]
v_pk_mul_f32 v[86:87], v[86:87], v[54:55]
v_pk_mul_f32 v[76:77], v[76:77], v[44:45]
v_pk_mul_f32 v[44:45], v[44:45], v[30:31] op_sel:[0,1] op_sel_hi:[1,1]
v_pk_mul_f32 v[78:79], v[78:79], v[46:47]
v_pk_mul_f32 v[46:47], v[46:47], v[30:31] op_sel:[0,1] op_sel_hi:[1,1]
v_pk_mul_f32 v[92:93], v[92:93], v[60:61]
v_pk_mul_f32 v[60:61], v[60:61], v[30:31] op_sel:[0,1] op_sel_hi:[1,1]
v_pk_mul_f32 v[94:95], v[94:95], v[62:63]
v_pk_mul_f32 v[62:63], v[62:63], v[30:31] op_sel:[0,1] op_sel_hi:[1,1]
v_pk_fma_f32 v[40:41], v[40:41], v[24:25], v[24:25] op_sel:[0,1,1] op_sel_hi:[1,1,1]
v_pk_fma_f32 v[42:43], v[42:43], v[24:25], v[24:25] op_sel:[0,1,1] op_sel_hi:[1,1,1]
v_pk_fma_f32 v[56:57], v[56:57], v[24:25], v[24:25] op_sel:[0,1,1] op_sel_hi:[1,1,1]
v_pk_fma_f32 v[58:59], v[58:59], v[24:25], v[24:25] op_sel:[0,1,1] op_sel_hi:[1,1,1]
v_cvt_pk_bf16_f32 v36, v68, v69
v_cvt_pk_bf16_f32 v37, v70, v71
v_cvt_pk_bf16_f32 v38, v84, v85
v_cvt_pk_bf16_f32 v39, v86, v87
MAA 128,112,128
buffer_store_dwordx4 v[36:39], v10, s[16:19], s62 offen offset:1024 sc1
MAA 128,116,144
TR 84,17,59136
v_rcp_f32 v40, v40
s_waitcnt lgkmcnt(15)
MAA 128,208,160
TR 86,17,59648
v_rcp_f32 v41, v41
MAA 128,212,176
TR 88,17,50720
v_rcp_f32 v42, v42
MAA 144,220,176
TR 90,17,51232
v_rcp_f32 v43, v43
MAA 144,216,160
TR 92,17,59168
v_rcp_f32 v56, v56
MAA 144,124,144
TR 94,17,59680
v_rcp_f32 v57, v57
MAA 144,120,128
v_rcp_f32 v58, v58
MAA 96,192,160
v_rcp_f32 v59, v59
MAA 96,196,176
v_exp_f32 v44, v44
MAA 112,204,176
v_exp_f32 v45, v45
MAA 112,200,160
v_lshrrev_b32 v69, 2, v0
v_min_u32 v69, 1, v69
v_lshlrev_b32 v69, 28, v69
v_lshl_add_u32 v68, v0, 7, v69
v_xor_b32 v69, 64, v0
v_min_u32 v69, 1, v69
v_lshlrev_b32 v70, 4, v69
v_sub_u32 v70, 16, v70
v_lshlrev_b32 v69, 28, v69
v_mov_b32 v71, 1
s_waitcnt lgkmcnt(0)
s_barrier
v_mov_b32 v84, 0
v_mov_b32 v85, 0
v_mov_b32 v86, 0
v_exp_f32 v46, v46
v_exp_f32 v47, v47
v_exp_f32 v60, v60
v_exp_f32 v61, v61
v_exp_f32 v62, v62
v_exp_f32 v63, v63
v_pk_mul_f32 v[72:73], v[72:73], v[40:41]
v_pk_mul_f32 v[74:75], v[74:75], v[42:43]
v_pk_mul_f32 v[88:89], v[88:89], v[56:57]
v_pk_mul_f32 v[90:91], v[90:91], v[58:59]
v_pk_mul_f32 v[128:129], v[128:129], v[96:97]
v_pk_mul_f32 v[96:97], v[96:97], v[28:29] op_sel_hi:[1,0]
v_pk_mul_f32 v[130:131], v[130:131], v[98:99]
v_pk_mul_f32 v[98:99], v[98:99], v[28:29] op_sel_hi:[1,0]
v_pk_mul_f32 v[144:145], v[144:145], v[112:113]
v_pk_mul_f32 v[112:113], v[112:113], v[28:29] op_sel_hi:[1,0]
v_pk_mul_f32 v[146:147], v[146:147], v[114:115]
v_pk_mul_f32 v[114:115], v[114:115], v[28:29] op_sel_hi:[1,0]
v_pk_fma_f32 v[44:45], v[44:45], v[26:27], v[26:27] op_sel:[0,1,1] op_sel_hi:[1,1,1]
v_pk_fma_f32 v[46:47], v[46:47], v[26:27], v[26:27] op_sel:[0,1,1] op_sel_hi:[1,1,1]
v_pk_fma_f32 v[60:61], v[60:61], v[26:27], v[26:27] op_sel:[0,1,1] op_sel_hi:[1,1,1]
v_pk_fma_f32 v[62:63], v[62:63], v[26:27], v[26:27] op_sel:[0,1,1] op_sel_hi:[1,1,1]
v_cvt_pk_bf16_f32 v40, v72, v73
v_cvt_pk_bf16_f32 v41, v74, v75
v_cvt_pk_bf16_f32 v42, v88, v89
v_cvt_pk_bf16_f32 v43, v90, v91
MAA 132,112,132
buffer_store_dwordx4 v[40:43], v11, s[16:19], s62 offen sc1
MAA 132,116,148
s_add_u32 m0, s59, 84480
v_rcp_f32 v44, v44
MAA 132,208,164
v_rcp_f32 v45, v45
MAA 132,212,180
v_rcp_f32 v46, v46
MAA 148,220,180
buffer_load_dwordx4 v18, s[28:31], s58 offen lds
MAA 148,216,164
v_rcp_f32 v47, v47
MAA 148,124,148
v_rcp_f32 v60, v60
MAA 148,120,132
v_rcp_f32 v61, v61
MAA 100,192,164
buffer_load_dwordx4 v19, s[28:31], s58 offen offset:1056 lds
MAA 100,196,180
s_add_u32 m0, s59, 92928
s_add_u32 s58, s99, 2555904
v_rcp_f32 v62, v62
MAA 116,204,180
v_rcp_f32 v63, v63
MAA 116,200,164
v_exp_f32 v96, v96
v_exp_f32 v97, v97
v_exp_f32 v98, v98
v_exp_f32 v99, v99
v_exp_f32 v112, v112
v_exp_f32 v113, v113
v_exp_f32 v114, v114
v_exp_f32 v115, v115
v_pk_mul_f32 v[76:77], v[76:77], v[44:45]
v_pk_mul_f32 v[78:79], v[78:79], v[46:47]
v_pk_mul_f32 v[92:93], v[92:93], v[60:61]
v_pk_mul_f32 v[94:95], v[94:95], v[62:63]
v_pk_mul_f32 v[132:133], v[132:133], v[100:101]
v_pk_mul_f32 v[100:101], v[100:101], v[28:29] op_sel:[0,1] op_sel_hi:[1,1]
v_pk_mul_f32 v[134:135], v[134:135], v[102:103]
v_pk_mul_f32 v[102:103], v[102:103], v[28:29] op_sel:[0,1] op_sel_hi:[1,1]
v_pk_mul_f32 v[148:149], v[148:149], v[116:117]
v_pk_mul_f32 v[116:117], v[116:117], v[28:29] op_sel:[0,1] op_sel_hi:[1,1]
v_pk_mul_f32 v[150:151], v[150:151], v[118:119]
v_pk_mul_f32 v[118:119], v[118:119], v[28:29] op_sel:[0,1] op_sel_hi:[1,1]
v_pk_fma_f32 v[96:97], v[96:97], v[20:21], v[20:21] op_sel:[0,1,1] op_sel_hi:[1,1,1]
v_pk_fma_f32 v[98:99], v[98:99], v[20:21], v[20:21] op_sel:[0,1,1] op_sel_hi:[1,1,1]
v_pk_fma_f32 v[112:113], v[112:113], v[20:21], v[20:21] op_sel:[0,1,1] op_sel_hi:[1,1,1]
v_pk_fma_f32 v[114:115], v[114:115], v[20:21], v[20:21] op_sel:[0,1,1] op_sel_hi:[1,1,1]
v_cvt_pk_bf16_f32 v44, v76, v77
v_cvt_pk_bf16_f32 v45, v78, v79
v_cvt_pk_bf16_f32 v46, v92, v93
v_cvt_pk_bf16_f32 v47, v94, v95
MAA 136,112,136
buffer_store_dwordx4 v[44:47], v11, s[16:19], s62 offen offset:1024 sc1
MAA 136,116,152
v_rcp_f32 v96, v96
MAA 136,208,168
v_rcp_f32 v97, v97
MAA 136,212,184
v_rcp_f32 v98, v98
MAA 152,220,184
buffer_load_dwordx4 v18, s[28:31], s58 offen lds
MAA 152,216,168
v_rcp_f32 v99, v99
MAA 152,124,152
v_rcp_f32 v112, v112
MAA 152,120,136
v_rcp_f32 v113, v113
MAA 104,192,168
buffer_load_dwordx4 v19, s[28:31], s58 offen offset:1056 lds
MAA 104,196,184
s_add_u32 m0, s59, 101376
s_add_u32 s58, s100, 2752512
v_rcp_f32 v114, v114
MAA 120,204,184
v_rcp_f32 v115, v115
MAA 120,200,168
v_exp_f32 v100, v100
v_exp_f32 v101, v101
v_exp_f32 v102, v102
v_exp_f32 v103, v103
v_exp_f32 v116, v116
v_exp_f32 v117, v117
v_exp_f32 v118, v118
v_exp_f32 v119, v119
v_pk_mul_f32 v[128:129], v[128:129], v[96:97]
v_pk_mul_f32 v[130:131], v[130:131], v[98:99]
v_pk_mul_f32 v[144:145], v[144:145], v[112:113]
v_pk_mul_f32 v[146:147], v[146:147], v[114:115]
v_pk_mul_f32 v[136:137], v[136:137], v[104:105]
v_pk_mul_f32 v[104:105], v[104:105], v[30:31] op_sel_hi:[1,0]
v_pk_mul_f32 v[138:139], v[138:139], v[106:107]
v_pk_mul_f32 v[106:107], v[106:107], v[30:31] op_sel_hi:[1,0]
v_pk_mul_f32 v[152:153], v[152:153], v[120:121]
v_pk_mul_f32 v[120:121], v[120:121], v[30:31] op_sel_hi:[1,0]
v_pk_mul_f32 v[154:155], v[154:155], v[122:123]
v_pk_mul_f32 v[122:123], v[122:123], v[30:31] op_sel_hi:[1,0]
v_pk_fma_f32 v[100:101], v[100:101], v[22:23], v[22:23] op_sel:[0,1,1] op_sel_hi:[1,1,1]
v_pk_fma_f32 v[102:103], v[102:103], v[22:23], v[22:23] op_sel:[0,1,1] op_sel_hi:[1,1,1]
v_pk_fma_f32 v[116:117], v[116:117], v[22:23], v[22:23] op_sel:[0,1,1] op_sel_hi:[1,1,1]
v_pk_fma_f32 v[118:119], v[118:119], v[22:23], v[22:23] op_sel:[0,1,1] op_sel_hi:[1,1,1]
v_cvt_pk_bf16_f32 v96, v128, v129
v_cvt_pk_bf16_f32 v97, v130, v131
v_cvt_pk_bf16_f32 v98, v144, v145
v_cvt_pk_bf16_f32 v99, v146, v147
MAA 140,112,140
buffer_store_dwordx4 v[96:99], v10, s[16:19], s63 offen sc1
MAA 140,116,156
v_rcp_f32 v100, v100
MAA 140,208,172
v_rcp_f32 v101, v101
MAA 140,212,188
v_rcp_f32 v102, v102
MAA 156,220,188
buffer_load_dwordx4 v18, s[28:31], s58 offen lds
MAA 156,216,172
v_rcp_f32 v103, v103
MAA 156,124,156
v_rcp_f32 v116, v116
MAA 156,120,140
v_rcp_f32 v117, v117
MAA 108,192,172
buffer_load_dwordx4 v19, s[28:31], s58 offen offset:1056 lds
MAA 108,196,188
s_add_u32 m0, s59, 109824
s_add_u32 s58, s100, 3014656
v_rcp_f32 v118, v118
MAA 124,204,188
v_rcp_f32 v119, v119
MAA 124,200,172
v_exp_f32 v104, v104
v_exp_f32 v105, v105
v_exp_f32 v106, v106
v_exp_f32 v107, v107
v_exp_f32 v120, v120
v_exp_f32 v121, v121
v_exp_f32 v122, v122
v_exp_f32 v123, v123
v_pk_mul_f32 v[132:133], v[132:133], v[100:101]
v_pk_mul_f32 v[134:135], v[134:135], v[102:103]
v_pk_mul_f32 v[148:149], v[148:149], v[116:117]
v_pk_mul_f32 v[150:151], v[150:151], v[118:119]
v_pk_mul_f32 v[140:141], v[140:141], v[108:109]
v_pk_mul_f32 v[108:109], v[108:109], v[30:31] op_sel:[0,1] op_sel_hi:[1,1]
v_pk_mul_f32 v[142:143], v[142:143], v[110:111]
v_pk_mul_f32 v[110:111], v[110:111], v[30:31] op_sel:[0,1] op_sel_hi:[1,1]
v_pk_mul_f32 v[156:157], v[156:157], v[124:125]
v_pk_mul_f32 v[124:125], v[124:125], v[30:31] op_sel:[0,1] op_sel_hi:[1,1]
v_pk_mul_f32 v[158:159], v[158:159], v[126:127]
v_pk_mul_f32 v[126:127], v[126:127], v[30:31] op_sel:[0,1] op_sel_hi:[1,1]
v_pk_fma_f32 v[104:105], v[104:105], v[24:25], v[24:25] op_sel:[0,1,1] op_sel_hi:[1,1,1]
v_pk_fma_f32 v[106:107], v[106:107], v[24:25], v[24:25] op_sel:[0,1,1] op_sel_hi:[1,1,1]
v_pk_fma_f32 v[120:121], v[120:121], v[24:25], v[24:25] op_sel:[0,1,1] op_sel_hi:[1,1,1]
v_pk_fma_f32 v[122:123], v[122:123], v[24:25], v[24:25] op_sel:[0,1,1] op_sel_hi:[1,1,1]
v_cvt_pk_bf16_f32 v100, v132, v133
v_cvt_pk_bf16_f32 v101, v134, v135
v_cvt_pk_bf16_f32 v102, v148, v149
v_cvt_pk_bf16_f32 v103, v150, v151
MAA 192,0,128
buffer_store_dwordx4 v[100:103], v10, s[16:19], s63 offen offset:1024 sc1
MAA 192,4,144
v_rcp_f32 v104, v104
MAA 192,32,160
s_waitcnt vmcnt(6)
s_barrier
v_rcp_f32 v105, v105
MAA 192,36,176
v_rcp_f32 v106, v106
MAA 208,44,176
buffer_atomic_add v71, v68, s[16:19], s72 offen offset:512
MAA 208,40,160
v_rcp_f32 v107, v107
MAA 208,12,144
v_rcp_f32 v120, v120
MAA 208,8,128
v_rcp_f32 v121, v121
MAA 160,16,160
buffer_load_dwordx4 v18, s[28:31], s58 offen lds
MAA 160,20,176
v_rcp_f32 v122, v122
MAA 176,28,176
v_rcp_f32 v123, v123
MAA 176,24,160
v_exp_f32 v108, v108
v_exp_f32 v109, v109
v_exp_f32 v110, v110
v_exp_f32 v111, v111
v_exp_f32 v124, v124
v_exp_f32 v125, v125
v_exp_f32 v126, v126
v_exp_f32 v127, v127
v_pk_mul_f32 v[136:137], v[136:137], v[104:105]
v_pk_mul_f32 v[138:139], v[138:139], v[106:107]
v_pk_mul_f32 v[152:153], v[152:153], v[120:121]
v_pk_mul_f32 v[154:155], v[154:155], v[122:123]
v_pk_mul_f32 v[192:193], v[192:193], v[160:161]
v_pk_mul_f32 v[160:161], v[160:161], v[28:29] op_sel_hi:[1,0]
v_pk_mul_f32 v[194:195], v[194:195], v[162:163]
v_pk_mul_f32 v[162:163], v[162:163], v[28:29] op_sel_hi:[1,0]
v_pk_mul_f32 v[208:209], v[208:209], v[176:177]
v_pk_mul_f32 v[176:177], v[176:177], v[28:29] op_sel_hi:[1,0]
v_pk_mul_f32 v[210:211], v[210:211], v[178:179]
v_pk_mul_f32 v[178:179], v[178:179], v[28:29] op_sel_hi:[1,0]
v_pk_fma_f32 v[108:109], v[108:109], v[26:27], v[26:27] op_sel:[0,1,1] op_sel_hi:[1,1,1]
v_pk_fma_f32 v[110:111], v[110:111], v[26:27], v[26:27] op_sel:[0,1,1] op_sel_hi:[1,1,1]
v_pk_fma_f32 v[124:125], v[124:125], v[26:27], v[26:27] op_sel:[0,1,1] op_sel_hi:[1,1,1]
v_pk_fma_f32 v[126:127], v[126:127], v[26:27], v[26:27] op_sel:[0,1,1] op_sel_hi:[1,1,1]
v_cvt_pk_bf16_f32 v104, v136, v137
v_cvt_pk_bf16_f32 v105, v138, v139
v_cvt_pk_bf16_f32 v106, v152, v153
v_cvt_pk_bf16_f32 v107, v154, v155
MAA 196,0,132
buffer_store_dwordx4 v[104:107], v11, s[16:19], s63 offen sc1
MAA 196,4,148
v_rcp_f32 v108, v108
MAA 196,32,164
v_rcp_f32 v109, v109
MAA 196,36,180
v_rcp_f32 v110, v110
MAA 212,44,180
buffer_load_dwordx4 v19, s[28:31], s58 offen offset:1056 lds
MAA 212,40,164
s_add_u32 m0, s59, 118272
s_add_u32 s58, s101, 3211264
v_rcp_f32 v111, v111
MAA 212,12,148
v_rcp_f32 v124, v124
MAA 212,8,132
v_rcp_f32 v125, v125
MAA 164,16,164
buffer_load_dwordx4 v18, s[28:31], s58 offen lds
MAA 164,20,180
v_rcp_f32 v126, v126
MAA 180,28,180
v_rcp_f32 v127, v127
MAA 180,24,164
v_exp_f32 v160, v160
v_exp_f32 v161, v161
v_exp_f32 v162, v162
v_exp_f32 v163, v163
v_exp_f32 v176, v176
v_exp_f32 v177, v177
v_exp_f32 v178, v178
v_exp_f32 v179, v179
v_pk_mul_f32 v[140:141], v[140:141], v[108:109]
v_pk_mul_f32 v[142:143], v[142:143], v[110:111]
v_pk_mul_f32 v[156:157], v[156:157], v[124:125]
v_pk_mul_f32 v[158:159], v[158:159], v[126:127]
v_pk_mul_f32 v[196:197], v[196:197], v[164:165]
v_pk_mul_f32 v[164:165], v[164:165], v[28:29] op_sel:[0,1] op_sel_hi:[1,1]
v_pk_mul_f32 v[198:199], v[198:199], v[166:167]
v_pk_mul_f32 v[166:167], v[166:167], v[28:29] op_sel:[0,1] op_sel_hi:[1,1]
v_pk_mul_f32 v[212:213], v[212:213], v[180:181]
v_pk_mul_f32 v[180:181], v[180:181], v[28:29] op_sel:[0,1] op_sel_hi:[1,1]
v_pk_mul_f32 v[214:215], v[214:215], v[182:183]
v_pk_mul_f32 v[182:183], v[182:183], v[28:29] op_sel:[0,1] op_sel_hi:[1,1]
v_pk_fma_f32 v[160:161], v[160:161], v[20:21], v[20:21] op_sel:[0,1,1] op_sel_hi:[1,1,1]
v_pk_fma_f32 v[162:163], v[162:163], v[20:21], v[20:21] op_sel:[0,1,1] op_sel_hi:[1,1,1]
v_pk_fma_f32 v[176:177], v[176:177], v[20:21], v[20:21] op_sel:[0,1,1] op_sel_hi:[1,1,1]
v_pk_fma_f32 v[178:179], v[178:179], v[20:21], v[20:21] op_sel:[0,1,1] op_sel_hi:[1,1,1]
v_cvt_pk_bf16_f32 v108, v140, v141
v_cvt_pk_bf16_f32 v109, v142, v143
v_cvt_pk_bf16_f32 v110, v156, v157
v_cvt_pk_bf16_f32 v111, v158, v159
MAA 200,0,136
buffer_store_dwordx4 v[108:111], v11, s[16:19], s63 offen offset:1024 sc1
MAA 200,4,152
v_rcp_f32 v160, v160
MAA 200,32,168
v_rcp_f32 v161, v161
MAA 200,36,184
v_rcp_f32 v162, v162
MAA 216,44,184
buffer_load_dwordx4 v19, s[28:31], s58 offen offset:1056 lds
MAA 216,40,168
s_add_u32 m0, s59, 126720
s_add_u32 s58, s101, 3473408
v_rcp_f32 v163, v163
MAA 216,12,152
v_rcp_f32 v176, v176
MAA 216,8,136
v_rcp_f32 v177, v177
MAA 168,16,168
buffer_load_dwordx4 v18, s[28:31], s58 offen lds
MAA 168,20,184
v_rcp_f32 v178, v178
MAA 184,28,184
v_rcp_f32 v179, v179
MAA 184,24,168
v_exp_f32 v164, v164
v_exp_f32 v165, v165
v_exp_f32 v166, v166
v_exp_f32 v167, v167
v_exp_f32 v180, v180
v_exp_f32 v181, v181
v_exp_f32 v182, v182
v_exp_f32 v183, v183
v_pk_mul_f32 v[192:193], v[192:193], v[160:161]
v_pk_mul_f32 v[194:195], v[194:195], v[162:163]
v_pk_mul_f32 v[208:209], v[208:209], v[176:177]
v_pk_mul_f32 v[210:211], v[210:211], v[178:179]
v_pk_mul_f32 v[200:201], v[200:201], v[168:169]
v_pk_mul_f32 v[168:169], v[168:169], v[30:31] op_sel_hi:[1,0]
v_pk_mul_f32 v[202:203], v[202:203], v[170:171]
v_pk_mul_f32 v[170:171], v[170:171], v[30:31] op_sel_hi:[1,0]
v_pk_mul_f32 v[216:217], v[216:217], v[184:185]
v_pk_mul_f32 v[184:185], v[184:185], v[30:31] op_sel_hi:[1,0]
v_pk_mul_f32 v[218:219], v[218:219], v[186:187]
v_pk_mul_f32 v[186:187], v[186:187], v[30:31] op_sel_hi:[1,0]
v_pk_fma_f32 v[164:165], v[164:165], v[22:23], v[22:23] op_sel:[0,1,1] op_sel_hi:[1,1,1]
v_pk_fma_f32 v[166:167], v[166:167], v[22:23], v[22:23] op_sel:[0,1,1] op_sel_hi:[1,1,1]
v_pk_fma_f32 v[180:181], v[180:181], v[22:23], v[22:23] op_sel:[0,1,1] op_sel_hi:[1,1,1]
v_pk_fma_f32 v[182:183], v[182:183], v[22:23], v[22:23] op_sel:[0,1,1] op_sel_hi:[1,1,1]
v_cvt_pk_bf16_f32 v160, v192, v193
v_cvt_pk_bf16_f32 v161, v194, v195
v_cvt_pk_bf16_f32 v162, v208, v209
v_cvt_pk_bf16_f32 v163, v210, v211
MAA 204,0,140
buffer_store_dwordx4 v[160:163], v10, s[16:19], s64 offen sc1
MAA 204,4,156
v_rcp_f32 v164, v164
MAA 204,32,172
v_rcp_f32 v165, v165
MAA 204,36,188
v_rcp_f32 v166, v166
MAA 220,44,188
buffer_atomic_add v84, v69, s[16:19], s73 offen offset:512 sc0
MAA 220,40,172
v_rcp_f32 v167, v167
MAA 220,12,156
v_rcp_f32 v180, v180
MAA 220,8,140
v_rcp_f32 v181, v181
MAA 172,16,172
buffer_load_dwordx4 v19, s[28:31], s58 offen offset:1056 lds
MAA 172,20,188
v_rcp_f32 v182, v182
MAA 188,28,188
v_rcp_f32 v183, v183
MAA 188,24,172
v_exp_f32 v168, v168
v_exp_f32 v169, v169
v_exp_f32 v170, v170
v_exp_f32 v171, v171
v_exp_f32 v184, v184
v_exp_f32 v185, v185
v_exp_f32 v186, v186
v_exp_f32 v187, v187
v_pk_mul_f32 v[196:197], v[196:197], v[164:165]
v_pk_mul_f32 v[198:199], v[198:199], v[166:167]
v_pk_mul_f32 v[212:213], v[212:213], v[180:181]
v_pk_mul_f32 v[214:215], v[214:215], v[182:183]
v_pk_mul_f32 v[204:205], v[204:205], v[172:173]
v_pk_mul_f32 v[172:173], v[172:173], v[30:31] op_sel:[0,1] op_sel_hi:[1,1]
v_pk_mul_f32 v[206:207], v[206:207], v[174:175]
v_pk_mul_f32 v[174:175], v[174:175], v[30:31] op_sel:[0,1] op_sel_hi:[1,1]
v_pk_mul_f32 v[220:221], v[220:221], v[188:189]
v_pk_mul_f32 v[188:189], v[188:189], v[30:31] op_sel:[0,1] op_sel_hi:[1,1]
v_pk_mul_f32 v[222:223], v[222:223], v[190:191]
v_pk_mul_f32 v[190:191], v[190:191], v[30:31] op_sel:[0,1] op_sel_hi:[1,1]
v_pk_fma_f32 v[168:169], v[168:169], v[24:25], v[24:25] op_sel:[0,1,1] op_sel_hi:[1,1,1]
v_pk_fma_f32 v[170:171], v[170:171], v[24:25], v[24:25] op_sel:[0,1,1] op_sel_hi:[1,1,1]
v_pk_fma_f32 v[184:185], v[184:185], v[24:25], v[24:25] op_sel:[0,1,1] op_sel_hi:[1,1,1]
v_pk_fma_f32 v[186:187], v[186:187], v[24:25], v[24:25] op_sel:[0,1,1] op_sel_hi:[1,1,1]
v_cvt_pk_bf16_f32 v164, v196, v197
v_cvt_pk_bf16_f32 v165, v198, v199
v_cvt_pk_bf16_f32 v166, v212, v213
v_cvt_pk_bf16_f32 v167, v214, v215
MAA 240,48,128
buffer_store_dwordx4 v[164:167], v10, s[16:19], s64 offen offset:1024 sc1
MAA 240,52,144
v_rcp_f32 v168, v168
MAA 240,80,160
v_rcp_f32 v169, v169
MAA 240,84,176
v_rcp_f32 v170, v170
MAA 248,92,176
buffer_atomic_add v85, v69, s[16:19], s73 offen offset:512 sc0
MAA 248,88,160
v_rcp_f32 v171, v171
MAA 248,60,144
v_rcp_f32 v184, v184
MAA 248,56,128
v_rcp_f32 v185, v185
MAA 224,64,160
v_rcp_f32 v186, v186
MAA 224,68,176
v_rcp_f32 v187, v187
MAA 232,76,176
v_exp_f32 v172, v172
MAA 232,72,160
v_exp_f32 v173, v173
v_exp_f32 v174, v174
v_exp_f32 v175, v175
v_exp_f32 v188, v188
v_exp_f32 v189, v189
v_exp_f32 v190, v190
v_exp_f32 v191, v191
v_pk_mul_f32 v[200:201], v[200:201], v[168:169]
v_pk_mul_f32 v[202:203], v[202:203], v[170:171]
v_pk_mul_f32 v[216:217], v[216:217], v[184:185]
v_pk_mul_f32 v[218:219], v[218:219], v[186:187]
v_pk_mul_f32 v[240:241], v[240:241], v[224:225]
v_pk_mul_f32 v[224:225], v[224:225], v[28:29] op_sel_hi:[1,0]
v_pk_mul_f32 v[242:243], v[242:243], v[226:227]
v_pk_mul_f32 v[226:227], v[226:227], v[28:29] op_sel_hi:[1,0]
v_pk_mul_f32 v[248:249], v[248:249], v[232:233]
v_pk_mul_f32 v[232:233], v[232:233], v[28:29] op_sel_hi:[1,0]
v_pk_mul_f32 v[250:251], v[250:251], v[234:235]
v_pk_mul_f32 v[234:235], v[234:235], v[28:29] op_sel_hi:[1,0]
v_pk_fma_f32 v[172:173], v[172:173], v[26:27], v[26:27] op_sel:[0,1,1] op_sel_hi:[1,1,1]
v_pk_fma_f32 v[174:175], v[174:175], v[26:27], v[26:27] op_sel:[0,1,1] op_sel_hi:[1,1,1]
v_pk_fma_f32 v[188:189], v[188:189], v[26:27], v[26:27] op_sel:[0,1,1] op_sel_hi:[1,1,1]
v_pk_fma_f32 v[190:191], v[190:191], v[26:27], v[26:27] op_sel:[0,1,1] op_sel_hi:[1,1,1]
v_cvt_pk_bf16_f32 v168, v200, v201
v_cvt_pk_bf16_f32 v169, v202, v203
v_cvt_pk_bf16_f32 v170, v216, v217
v_cvt_pk_bf16_f32 v171, v218, v219
buffer_store_dwordx4 v[168:171], v11, s[16:19], s64 offen sc1
buffer_atomic_add v86, v69, s[16:19], s73 offen offset:512 sc0
s_waitcnt vmcnt(5)
v_cmp_gt_u32 vcc, v70, v84
s_nop 0
s_cbranch_vccz .Lok66
s_waitcnt vmcnt(2)
v_cmp_gt_u32 vcc, v70, v85
s_nop 0
s_cbranch_vccz .Lok66
s_waitcnt vmcnt(0)
v_cmp_gt_u32 vcc, v70, v86
s_nop 0
s_cbranch_vccz .Lok66
s_mov_b32 s15, 0
.Lok66l:
v_mov_b32 v84, 0
buffer_atomic_add v84, v69, s[16:19], s73 offen offset:512 sc0
s_add_u32 s15, s15, 1
s_cmp_gt_u32 s15, 100000
s_waitcnt vmcnt(0)
s_cbranch_scc1 .Lok66
v_cmp_gt_u32 vcc, v70, v84
s_nop 0
s_cbranch_vccnz .Lok66l
.Lok66:
s_waitcnt vmcnt(4)
s_barrier
MAA 244,48,132
ds_read_b64_tr_b16 a[0:1], v7
s_add_u32 s52, s76, 0
MAA 244,52,148
buffer_load_dwordx4 v[96:99], v4, s[16:19], s52 offen sc1
MAA 244,80,164
TR 2,7,512
v_rcp_f32 v172, v172
MAA 244,84,180
TR 4,7,32
v_rcp_f32 v173, v173
MAA 252,92,180
TR 6,7,544
v_rcp_f32 v174, v174
MAA 252,88,164
buffer_load_dwordx4 v[100:103], v4, s[16:19], s52 offen offset:1024 sc1
MAA 252,60,148
TR 8,7,64
s_add_u32 s52, s76, 65536
MAA 252,56,132
TR 10,7,576
v_rcp_f32 v175, v175
MAA 228,64,164
TR 12,7,96
v_rcp_f32 v188, v188
MAA 228,68,180
buffer_load_dwordx4 v[104:107], v4, s[16:19], s52 offen sc1
MAA 236,76,180
TR 14,7,608
v_rcp_f32 v189, v189
MAA 236,72,164
TR 16,7,8448
v_rcp_f32 v190, v190
v_rcp_f32 v191, v191
v_exp_f32 v224, v224
v_exp_f32 v225, v225
v_exp_f32 v226, v226
v_exp_f32 v227, v227
v_exp_f32 v232, v232
v_exp_f32 v233, v233
v_exp_f32 v234, v234
v_exp_f32 v235, v235
v_pk_mul_f32 v[204:205], v[204:205], v[172:173]
buffer_load_dwordx4 v[108:111], v4, s[16:19], s52 offen offset:1024 sc1
s_add_u32 s52, s77, 114688
v_pk_mul_f32 v[206:207], v[206:207], v[174:175]
v_pk_mul_f32 v[220:221], v[220:221], v[188:189]
v_pk_mul_f32 v[222:223], v[222:223], v[190:191]
v_pk_mul_f32 v[244:245], v[244:245], v[228:229]
v_pk_mul_f32 v[228:229], v[228:229], v[28:29] op_sel:[0,1] op_sel_hi:[1,1]
v_pk_mul_f32 v[246:247], v[246:247], v[230:231]
v_pk_mul_f32 v[230:231], v[230:231], v[28:29] op_sel:[0,1] op_sel_hi:[1,1]
v_pk_mul_f32 v[252:253], v[252:253], v[236:237]
v_pk_mul_f32 v[236:237], v[236:237], v[28:29] op_sel:[0,1] op_sel_hi:[1,1]
v_pk_mul_f32 v[254:255], v[254:255], v[238:239]
v_pk_mul_f32 v[238:239], v[238:239], v[28:29] op_sel:[0,1] op_sel_hi:[1,1]
v_pk_fma_f32 v[224:225], v[224:225], v[20:21], v[20:21] op_sel:[0,1,1] op_sel_hi:[1,1,1]
buffer_load_dwordx4 v[112:115], v4, s[16:19], s52 offen sc1
v_pk_fma_f32 v[226:227], v[226:227], v[20:21], v[20:21] op_sel:[0,1,1] op_sel_hi:[1,1,1]
v_pk_fma_f32 v[232:233], v[232:233], v[20:21], v[20:21] op_sel:[0,1,1] op_sel_hi:[1,1,1]
v_pk_fma_f32 v[234:235], v[234:235], v[20:21], v[20:21] op_sel:[0,1,1] op_sel_hi:[1,1,1]
v_cvt_pk_bf16_f32 v172, v204, v205
v_cvt_pk_bf16_f32 v173, v206, v207
v_cvt_pk_bf16_f32 v174, v220, v221
v_cvt_pk_bf16_f32 v175, v222, v223
TR 18,7,8960
TR 20,7,8480
TR 22,7,8992
buffer_store_dwordx4 v[172:175], v11, s[16:19], s64 offen offset:1024 sc1
TR 24,7,8512
TR 26,7,9024
.Lpad35:
s_cbranch_execz .Lpad38
TR 28,7,8544
TR 30,7,9056
v_rcp_f32 v224, v224
v_rcp_f32 v225, v225
v_rcp_f32 v226, v226
v_rcp_f32 v227, v227
v_rcp_f32 v232, v232
v_rcp_f32 v233, v233
v_rcp_f32 v234, v234
v_rcp_f32 v235, v235
v_exp_f32 v228, v228
v_exp_f32 v229, v229
v_exp_f32 v230, v230
v_exp_f32 v231, v231
v_exp_f32 v236, v236
v_exp_f32 v237, v237
v_exp_f32 v238, v238
v_exp_f32 v239, v239
v_pk_mul_f32 v[240:241], v[240:241], v[224:225]
buffer_load_dwordx4 v[116:119], v4, s[16:19], s52 offen offset:1024 sc1
s_add_u32 s52, s77, 180224
v_pk_mul_f32 v[242:243], v[242:243], v[226:227]
v_pk_mul_f32 v[248:249], v[248:249], v[232:233]
v_pk_mul_f32 v[250:251], v[250:251], v[234:235]
v_pk_fma_f32 v[228:229], v[228:229], v[22:23], v[22:23] op_sel:[0,1,1] op_sel_hi:[1,1,1]
v_pk_fma_f32 v[230:231], v[230:231], v[22:23], v[22:23] op_sel:[0,1,1] op_sel_hi:[1,1,1]
v_pk_fma_f32 v[236:237], v[236:237], v[22:23], v[22:23] op_sel:[0,1,1] op_sel_hi:[1,1,1]
v_pk_fma_f32 v[238:239], v[238:239], v[22:23], v[22:23] op_sel:[0,1,1] op_sel_hi:[1,1,1]
v_cvt_pk_bf16_f32 v224, v240, v241
v_cvt_pk_bf16_f32 v225, v242, v243
v_cvt_pk_bf16_f32 v226, v248, v249
v_cvt_pk_bf16_f32 v227, v250, v251
v_rcp_f32 v228, v228
v_rcp_f32 v229, v229
v_rcp_f32 v230, v230
v_rcp_f32 v231, v231
v_rcp_f32 v236, v236
v_rcp_f32 v237, v237
v_rcp_f32 v238, v238
v_rcp_f32 v239, v239
v_pk_mul_f32 v[244:245], v[244:245], v[228:229]
buffer_store_dwordx4 v[224:227], v10, s[16:19], s65 offen sc1
v_pk_mul_f32 v[246:247], v[246:247], v[230:231]
v_pk_mul_f32 v[252:253], v[252:253], v[236:237]
v_pk_mul_f32 v[254:255], v[254:255], v[238:239]
v_cvt_pk_bf16_f32 v228, v244, v245
v_cvt_pk_bf16_f32 v229, v246, v247
v_cvt_pk_bf16_f32 v230, v252, v253
v_cvt_pk_bf16_f32 v231, v254, v255
buffer_store_dwordx4 v[228:231], v10, s[16:19], s65 offen offset:1024 sc1
buffer_load_dwordx4 v[120:123], v4, s[16:19], s52 offen sc1
buffer_load_dwordx4 v[124:127], v4, s[16:19], s52 offen offset:1024 sc1
v_mov_b32 v21, v68
v_mov_b32 v22, v69
v_mov_b32 v23, v70
v_mov_b32 v24, v71
v_mov_b32 v25, 0
s_waitcnt vmcnt(7) lgkmcnt(0)
s_barrier
v_mfma_f32_16x16x32_bf16 v[32:35], a[0:3], v[96:99], 0
ds_read_b64_tr_b16 a[32:33], v6
s_add_u32 s52, s78, 229376
MAV 32,16,104
buffer_load_dwordx4 v[128:131], v4, s[16:19], s52 offen sc1
v_mfma_f32_16x16x32_bf16 v[48:51], a[0:3], v[100:103], 0
TR 34,6,512
MAV 48,16,108
TR 36,6,32
TR 38,6,544
v_mfma_f32_16x16x32_bf16 v[52:55], a[4:7], v[100:103], 0
TR 48,6,8448
MAV 52,20,108
buffer_load_dwordx4 v[132:135], v4, s[16:19], s52 offen offset:1024 sc1
v_mfma_f32_16x16x32_bf16 v[36:39], a[4:7], v[96:99], 0
TR 50,6,8960
MAV 36,20,104
TR 52,6,8480
TR 54,6,8992
v_mfma_f32_16x16x32_bf16 v[40:43], a[8:11], v[96:99], 0
TR 40,6,64
s_add_u32 s52, s78, 294912
MAV 40,24,104
buffer_load_dwordx4 v[136:139], v4, s[16:19], s52 offen sc1
v_mfma_f32_16x16x32_bf16 v[56:59], a[8:11], v[100:103], 0
TR 42,6,576
MAV 56,24,108
TR 44,6,96
TR 46,6,608
v_mfma_f32_16x16x32_bf16 v[60:63], a[12:15], v[100:103], 0
TR 56,6,8512
MAV 60,28,108
buffer_load_dwordx4 v[140:143], v4, s[16:19], s52 offen offset:1024 sc1
v_mfma_f32_16x16x32_bf16 v[44:47], a[12:15], v[96:99], 0
TR 58,6,9024
MAV 44,28,104
TR 60,6,8544
TR 62,6,9056
s_waitcnt lgkmcnt(8)
v_mfma_f32_16x16x32_bf16 v[64:67], a[32:35], v[96:99], 0
TR 0,7,16896
s_add_u32 s52, s79, 344064
MAV 64,48,104
buffer_load_dwordx4 v[144:147], v4, s[16:19], s52 offen sc1
v_mfma_f32_16x16x32_bf16 v[80:83], a[32:35], v[100:103], 0
TR 2,7,17408
MAV 80,48,108
TR 4,7,16928
TR 6,7,17440
v_mfma_f32_16x16x32_bf16 v[84:87], a[36:39], v[100:103], 0
TR 16,7,25344
MAV 84,52,108
buffer_load_dwordx4 v[148:151], v4, s[16:19], s52 offen offset:1024 sc1
v_mfma_f32_16x16x32_bf16 v[68:71], a[36:39], v[96:99], 0
TR 18,7,25856
MAV 68,52,104
TR 20,7,25376
TR 22,7,25888
s_waitcnt lgkmcnt(8)
v_mfma_f32_16x16x32_bf16 v[72:75], a[40:43], v[96:99], 0
TR 8,7,16960
s_add_u32 s52, s79, 409600
MAV 72,56,104
buffer_load_dwordx4 v[152:155], v4, s[16:19], s52 offen sc1
v_mfma_f32_16x16x32_bf16 v[88:91], a[40:43], v[100:103], 0
TR 10,7,17472
MAV 88,56,108
TR 12,7,16992
TR 14,7,17504
v_mfma_f32_16x16x32_bf16 v[92:95], a[44:47], v[100:103], 0
TR 24,7,25408
MAV 92,60,108
buffer_load_dwordx4 v[156:159], v4, s[16:19], s52 offen offset:1024 sc1
v_mfma_f32_16x16x32_bf16 v[76:79], a[44:47], v[96:99], 0
TR 26,7,25920
MAV 76,60,104
TR 28,7,25440
TR 30,7,25952
s_waitcnt vmcnt(8) lgkmcnt(8)
s_barrier
MAV 32,0,112
TR 32,6,16896
s_add_u32 m0, s55, 0
MAV 32,16,120
buffer_load_dwordx4 v18, s[28:31], s54 offen lds
MAV 48,16,124
TR 34,6,17408
MAV 48,0,116
TR 36,6,16928
TR 38,6,17440
MAV 52,4,116
TR 48,6,25344
s_add_u32 s52, s76, 458752
MAV 52,20,124
buffer_load_dwordx4 v[96:99], v4, s[16:19], s52 offen sc1
MAV 36,20,120
TR 50,6,25856
MAV 36,4,112
TR 52,6,25376
TR 54,6,25888
s_waitcnt lgkmcnt(8)
MAV 40,8,112
TR 40,6,16960
MAV 40,24,120
buffer_load_dwordx4 v19, s[28:31], s54 offen offset:1056 lds
MAV 56,24,124
TR 42,6,17472
s_add_u32 s54, s98, 327680
MAV 56,8,116
TR 44,6,16992
TR 46,6,17504
MAV 60,12,116
TR 56,6,25408
MAV 60,28,124
buffer_load_dwordx4 v[100:103], v4, s[16:19], s52 offen offset:1024 sc1
MAV 44,28,120
TR 58,6,25920
MAV 44,12,112
TR 60,6,25440
TR 62,6,25952
s_waitcnt lgkmcnt(8)
MAV 64,32,112
TR 0,7,33792
s_add_u32 m0, s55, 8448
MAV 64,48,120
buffer_load_dwordx4 v18, s[28:31], s54 offen lds
MAV 80,48,124
TR 2,7,34304
MAV 80,32,116
TR 4,7,33824
TR 6,7,34336
MAV 84,36,116
TR 16,7,42240
s_add_u32 s52, s76, 524288
MAV 84,52,124
buffer_load_dwordx4 v[104:107], v4, s[16:19], s52 offen sc1
MAV 68,52,120
TR 18,7,42752
MAV 68,36,112
TR 20,7,42272
TR 22,7,42784
s_waitcnt lgkmcnt(8)
MAV 72,40,112
TR 8,7,33856
MAV 72,56,120
buffer_load_dwordx4 v19, s[28:31], s54 offen offset:1056 lds
MAV 88,56,124
TR 10,7,34368
s_add_u32 s54, s99, 524288
MAV 88,40,116
TR 12,7,33888
TR 14,7,34400
MAV 92,44,116
TR 24,7,42304
MAV 92,60,124
buffer_load_dwordx4 v[108:111], v4, s[16:19], s52 offen offset:1024 sc1
MAV 76,60,120
TR 26,7,42816
MAV 76,44,112
TR 28,7,42336
TR 30,7,42848
s_waitcnt vmcnt(12) lgkmcnt(8)
s_barrier
MAV 32,0,128
TR 32,6,33792
MAV 32,16,136
buffer_atomic_add v24, v21, s[16:19], s72 offen
MAV 48,16,140
TR 34,6,34304
MAV 48,0,132
TR 36,6,33824
TR 38,6,34336
TR 48,6,42240
MAV 52,4,132
TR 50,6,42752
s_add_u32 m0, s55, 16896
MAV 52,20,140
buffer_load_dwordx4 v18, s[28:31], s54 offen lds
MAV 36,20,136
TR 52,6,42272
MAV 36,4,128
TR 54,6,42784
TR 40,6,33856
s_waitcnt lgkmcnt(9)
MAV 40,8,128
TR 42,6,34368
s_add_u32 s52, s77, 573440
MAV 40,24,136
buffer_load_dwordx4 v[112:115], v4, s[16:19], s52 offen sc1
MAV 56,24,140
TR 44,6,33888
MAV 56,8,132
buffer_load_dwordx4 v19, s[28:31], s54 offen offset:1056 lds
MAV 60,12,132
TR 46,6,34400
s_add_u32 s54, s99, 786432
MAV 60,28,140
buffer_load_dwordx4 v[116:119], v4, s[16:19], s52 offen offset:1024 sc1
MAV 44,28,136
TR 56,6,42304
MAV 44,12,128
TR 58,6,42816
TR 60,6,42336
TR 62,6,42848
s_waitcnt lgkmcnt(8)
MAV 64,32,128
TR 0,7,50688
s_add_u32 m0, s55, 25344
MAV 64,48,136
buffer_load_dwordx4 v18, s[28:31], s54 offen lds
MAV 80,48,140
TR 2,7,51200
MAV 80,32,132
TR 4,7,50720
TR 6,7,51232
MAV 84,36,132
TR 16,7,59136
s_add_u32 s52, s77, 638976
MAV 84,52,140
buffer_load_dwordx4 v[120:123], v4, s[16:19], s52 offen sc1
MAV 68,52,136
TR 18,7,59648
MAV 68,36,128
TR 20,7,59168
TR 22,7,59680
s_waitcnt lgkmcnt(8)
MAV 72,40,128
TR 8,7,50752
MAV 72,56,136
buffer_load_dwordx4 v19, s[28:31], s54 offen offset:1056 lds
MAV 88,56,140
TR 10,7,51264
s_add_u32 s54, s100, 983040
MAV 88,40,132
TR 12,7,50784
TR 14,7,51296
MAV 92,44,132
TR 24,7,59200
MAV 92,60,140
buffer_load_dwordx4 v[124:127], v4, s[16:19], s52 offen offset:1024 sc1
MAV 76,60,136
TR 26,7,59712
MAV 76,44,128
TR 28,7,59232
TR 30,7,59744
s_waitcnt vmcnt(17) lgkmcnt(8)
s_barrier
MAV 32,0,144
TR 32,6,50688
s_add_u32 m0, s55, 33792
MAV 32,16,152
buffer_load_dwordx4 v18, s[28:31], s54 offen lds
MAV 48,16,156
TR 34,6,51200
MAV 48,0,148
TR 36,6,50720
TR 38,6,51232
MAV 52,4,148
TR 48,6,59136
s_add_u32 s52, s78, 688128
MAV 52,20,156
buffer_load_dwordx4 v[128:131], v4, s[16:19], s52 offen sc1
MAV 36,20,152
TR 50,6,59648
MAV 36,4,144
TR 52,6,59168
TR 54,6,59680
s_waitcnt lgkmcnt(8)
MAV 40,8,144
TR 40,6,50752
MAV 40,24,152
buffer_load_dwordx4 v19, s[28:31], s54 offen offset:1056 lds
MAV 56,24,156
TR 42,6,51264
s_add_u32 s54, s100, 1245184
MAV 56,8,148
TR 44,6,50784
TR 46,6,51296
MAV 60,12,148
TR 56,6,59200
MAV 60,28,156
buffer_load_dwordx4 v[132:135], v4, s[16:19], s52 offen offset:1024 sc1
MAV 44,28,152
TR 58,6,59712
MAV 44,12,144
TR 60,6,59232
TR 62,6,59744
v_add_u32 v7, s57, v7
v_add_u32 v6, s57, v6
s_sub_u32 s57, 0, s57
s_waitcnt lgkmcnt(8)
MAV 64,32,144
ds_read_b64_tr_b16 a[0:1], v7
s_add_u32 m0, s55, 42240
MAV 64,48,152
buffer_load_dwordx4 v18, s[28:31], s54 offen lds
MAV 80,48,156
TR 2,7,512
MAV 80,32,148
TR 4,7,32
TR 6,7,544
TR 16,7,8448
MAV 84,36,148
TR 18,7,8960
s_add_u32 s52, s78, 753664
MAV 84,52,156
buffer_load_dwordx4 v[136:139], v4, s[16:19], s52 offen sc1
MAV 68,52,152
TR 20,7,8480
MAV 68,36,144
TR 22,7,8992
TR 8,7,64
s_waitcnt lgkmcnt(9)
MAV 72,40,144
TR 10,7,576
MAV 72,56,152
buffer_load_dwordx4 v19, s[28:31], s54 offen offset:1056 lds
MAV 88,56,156
TR 12,7,96
s_add_u32 s54, s101, 1441792
MAV 88,40,148
buffer_load_dwordx4 v[140:143], v4, s[16:19], s52 offen offset:1024 sc1
MAV 92,44,148
TR 14,7,608
MAV 92,60,156
buffer_atomic_add v25, v22, s[16:19], s73 offen sc0
MAV 76,60,152
TR 24,7,8512
MAV 76,44,144
TR 26,7,9024
TR 28,7,8544
TR 30,7,9056
s_waitcnt vmcnt(18) lgkmcnt(8)
s_barrier
MAV 32,0,96
ds_read_b64_tr_b16 a[32:33], v6
s_add_u32 m0, s55, 50688
MAV 32,16,104
buffer_load_dwordx4 v18, s[28:31], s54 offen lds
MAV 48,16,108
TR 34,6,512
MAV 48,0,100
TR 36,6,32
TR 38,6,544
MAV 52,4,100
TR 48,6,8448
s_add_u32 s52, s79, 802816
MAV 52,20,108
buffer_load_dwordx4 v[144:147], v4, s[16:19], s52 offen sc1
MAV 36,20,104
TR 50,6,8960
MAV 36,4,96
TR 52,6,8480
TR 54,6,8992
s_waitcnt lgkmcnt(8)
MAV 40,8,96
TR 40,6,64
MAV 40,24,104
buffer_load_dwordx4 v19, s[28:31], s54 offen offset:1056 lds
MAV 56,24,108
TR 42,6,576
s_add_u32 s54, s101, 1703936
MAV 56,8,100
TR 44,6,96
TR 46,6,608
MAV 60,12,100
TR 56,6,8512
MAV 60,28,108
buffer_load_dwordx4 v[148:151], v4, s[16:19], s52 offen offset:1024 sc1
MAV 44,28,104
TR 58,6,9024
MAV 44,12,96
TR 60,6,8544
TR 62,6,9056
s_waitcnt lgkmcnt(8)
MAV 64,32,96
TR 0,7,16896
s_add_u32 m0, s55, 59136
MAV 64,48,104
buffer_load_dwordx4 v18, s[28:31], s54 offen lds
MAV 80,48,108
TR 2,7,17408
MAV 80,32,100
TR 4,7,16928
TR 6,7,17440
MAV 84,36,100
TR 16,7,25344
s_add_u32 s52, s79, 868352
MAV 84,52,108
buffer_load_dwordx4 v[152:155], v4, s[16:19], s52 offen sc1
MAV 68,52,104
TR 18,7,25856
MAV 68,36,96
TR 20,7,25376
TR 22,7,25888
s_waitcnt lgkmcnt(8)
MAV 72,40,96
TR 8,7,16960
MAV 72,56,104
buffer_load_dwordx4 v19, s[28:31], s54 offen offset:1056 lds
MAV 88,56,108
TR 10,7,17472
s_add_u32 s54, s98, 1900544
MAV 88,40,100
TR 12,7,16992
TR 14,7,17504
MAV 92,44,100
TR 24,7,25408
MAV 92,60,108
buffer_load_dwordx4 v[156:159], v4, s[16:19], s52 offen offset:1024 sc1
MAV 76,60,104
TR 26,7,25920
MAV 76,44,96
TR 28,7,25440
TR 30,7,25952
s_waitcnt vmcnt(8)
v_cmp_gt_u32 vcc, v23, v25
s_nop 0
s_cbranch_vccnz .Lsp67
.Lsp67b:
s_waitcnt lgkmcnt(8)
s_barrier
MAV 32,0,112
TR 32,6,16896
s_add_u32 m0, s55, 67584
MAV 32,16,120
buffer_load_dwordx4 v18, s[28:31], s54 offen lds
MAV 48,16,124
TR 34,6,17408
MAV 48,0,116
TR 36,6,16928
TR 38,6,17440
MAV 52,4,116
TR 48,6,25344
s_add_u32 s52, s76, 16384
MAV 52,20,124
buffer_load_dwordx4 v[96:99], v4, s[16:19], s52 offen sc1
MAV 36,20,120
TR 50,6,25856
MAV 36,4,112
TR 52,6,25376
TR 54,6,25888
s_waitcnt lgkmcnt(8)
MAV 40,8,112
TR 40,6,16960
MAV 40,24,120
buffer_load_dwordx4 v19, s[28:31], s54 offen offset:1056 lds
MAV 56,24,124
TR 42,6,17472
s_add_u32 s54, s98, 2162688
MAV 56,8,116
TR 44,6,16992
TR 46,6,17504
MAV 60,12,116
TR 56,6,25408
MAV 60,28,124
buffer_load_dwordx4 v[100:103], v4, s[16:19], s52 offen offset:1024 sc1
MAV 44,28,120
TR 58,6,25920
MAV 44,12,112
TR 60,6,25440
TR 62,6,25952
s_waitcnt lgkmcnt(8)
MAV 64,32,112
TR 0,7,33792
s_add_u32 m0, s55, 76032
MAV 64,48,120
buffer_load_dwordx4 v18, s[28:31], s54 offen lds
MAV 80,48,124
TR 2,7,34304
MAV 80,32,116
TR 4,7,33824
TR 6,7,34336
MAV 84,36,116
TR 16,7,42240
s_add_u32 s52, s76, 81920
MAV 84,52,124
buffer_load_dwordx4 v[104:107], v4, s[16:19], s52 offen sc1
MAV 68,52,120
TR 18,7,42752
MAV 68,36,112
TR 20,7,42272
TR 22,7,42784
s_waitcnt lgkmcnt(8)
MAV 72,40,112
TR 8,7,33856
.Lpad36:
s_cbranch_execz .Lpad39
MAV 72,56,120
buffer_load_dwordx4 v19, s[28:31], s54 offen offset:1056 lds
MAV 88,56,124
TR 10,7,34368
s_add_u32 s54, s99, 2359296
MAV 88,40,116
TR 12,7,33888
TR 14,7,34400
MAV 92,44,116
TR 24,7,42304
MAV 92,60,124
buffer_load_dwordx4 v[108:111], v4, s[16:19], s52 offen offset:1024 sc1
MAV 76,60,120
TR 26,7,42816
MAV 76,44,112
TR 28,7,42336
TR 30,7,42848
s_waitcnt lgkmcnt(8)
s_barrier
MAV 32,0,128
TR 32,6,33792
s_add_u32 m0, s55, 84480
MAV 32,16,136
buffer_load_dwordx4 v18, s[28:31], s54 offen lds
MAV 48,16,140
TR 34,6,34304
MAV 48,0,132
TR 36,6,33824
TR 38,6,34336
MAV 52,4,132
TR 48,6,42240
s_add_u32 s52, s77, 131072
MAV 52,20,140
buffer_load_dwordx4 v[112:115], v4, s[16:19], s52 offen sc1
MAV 36,20,136
TR 50,6,42752
MAV 36,4,128
TR 52,6,42272
TR 54,6,42784
s_waitcnt lgkmcnt(8)
MAV 40,8,128
TR 40,6,33856
MAV 40,24,136
buffer_load_dwordx4 v19, s[28:31], s54 offen offset:1056 lds
MAV 56,24,140
TR 42,6,34368
s_add_u32 s54, s99, 2621440
MAV 56,8,132
TR 44,6,33888
TR 46,6,34400
MAV 60,12,132
TR 56,6,42304
MAV 60,28,140
buffer_load_dwordx4 v[116:119], v4, s[16:19], s52 offen offset:1024 sc1
MAV 44,28,136
TR 58,6,42816
MAV 44,12,128
TR 60,6,42336
TR 62,6,42848
s_waitcnt lgkmcnt(8)
MAV 64,32,128
TR 0,7,50688
s_add_u32 m0, s55, 92928
MAV 64,48,136
buffer_load_dwordx4 v18, s[28:31], s54 offen lds
MAV 80,48,140
TR 2,7,51200
MAV 80,32,132
TR 4,7,50720
TR 6,7,51232
MAV 84,36,132
TR 16,7,59136
s_add_u32 s52, s77, 196608
MAV 84,52,140
buffer_load_dwordx4 v[120:123], v4, s[16:19], s52 offen sc1
MAV 68,52,136
TR 18,7,59648
MAV 68,36,128
TR 20,7,59168
TR 22,7,59680
s_waitcnt lgkmcnt(8)
MAV 72,40,128
TR 8,7,50752
MAV 72,56,136
buffer_load_dwordx4 v19, s[28:31], s54 offen offset:1056 lds
MAV 88,56,140
TR 10,7,51264
s_add_u32 s54, s100, 2818048
MAV 88,40,132
TR 12,7,50784
TR 14,7,51296
MAV 92,44,132
TR 24,7,59200
MAV 92,60,140
buffer_load_dwordx4 v[124:127], v4, s[16:19], s52 offen offset:1024 sc1
MAV 76,60,136
TR 26,7,59712
MAV 76,44,128
TR 28,7,59232
TR 30,7,59744
s_waitcnt vmcnt(16) lgkmcnt(8)
s_barrier
MAV 32,0,144
TR 32,6,50688
s_add_u32 m0, s55, 101376
MAV 32,16,152
buffer_load_dwordx4 v18, s[28:31], s54 offen lds
MAV 48,16,156
TR 34,6,51200
MAV 48,0,148
TR 36,6,50720
TR 38,6,51232
MAV 52,4,148
TR 48,6,59136
s_add_u32 s52, s78, 245760
MAV 52,20,156
buffer_load_dwordx4 v[128:131], v4, s[16:19], s52 offen sc1
MAV 36,20,152
TR 50,6,59648
MAV 36,4,144
TR 52,6,59168
TR 54,6,59680
s_waitcnt lgkmcnt(8)
MAV 40,8,144
TR 40,6,50752
MAV 40,24,152
buffer_load_dwordx4 v19, s[28:31], s54 offen offset:1056 lds
MAV 56,24,156
TR 42,6,51264
s_add_u32 s54, s100, 3080192
MAV 56,8,148
TR 44,6,50784
TR 46,6,51296
MAV 60,12,148
TR 56,6,59200
MAV 60,28,156
buffer_load_dwordx4 v[132:135], v4, s[16:19], s52 offen offset:1024 sc1
MAV 44,28,152
TR 58,6,59712
MAV 44,12,144
TR 60,6,59232
TR 62,6,59744
v_add_u32 v7, s57, v7
v_add_u32 v6, s57, v6
s_sub_u32 s57, 0, s57
s_waitcnt lgkmcnt(8)
MAV 64,32,144
ds_read_b64_tr_b16 a[0:1], v7
s_add_u32 m0, s55, 109824
MAV 64,48,152
buffer_load_dwordx4 v18, s[28:31], s54 offen lds
MAV 80,48,156
TR 2,7,512
MAV 80,32,148
TR 4,7,32
TR 6,7,544
MAV 84,36,148
TR 16,7,8448
s_add_u32 s52, s78, 311296
MAV 84,52,156
buffer_load_dwordx4 v[136:139], v4, s[16:19], s52 offen sc1
MAV 68,52,152
TR 18,7,8960
MAV 68,36,144
TR 20,7,8480
TR 22,7,8992
s_waitcnt lgkmcnt(8)
MAV 72,40,144
TR 8,7,64
MAV 72,56,152
buffer_load_dwordx4 v19, s[28:31], s54 offen offset:1056 lds
MAV 88,56,156
TR 10,7,576
s_add_u32 s54, s101, 3276800
MAV 88,40,148
TR 12,7,96
TR 14,7,608
MAV 92,44,148
TR 24,7,8512
MAV 92,60,156
buffer_load_dwordx4 v[140:143], v4, s[16:19], s52 offen offset:1024 sc1
MAV 76,60,152
TR 26,7,9024
MAV 76,44,144
TR 28,7,8544
TR 30,7,9056
s_waitcnt vmcnt(16) lgkmcnt(8)
s_barrier
MAV 32,0,96
ds_read_b64_tr_b16 a[32:33], v6
s_add_u32 m0, s55, 118272
MAV 32,16,104
buffer_load_dwordx4 v18, s[28:31], s54 offen lds
MAV 48,16,108
TR 34,6,512
MAV 48,0,100
TR 36,6,32
TR 38,6,544
MAV 52,4,100
TR 48,6,8448
s_add_u32 s52, s79, 360448
MAV 52,20,108
buffer_load_dwordx4 v[144:147], v4, s[16:19], s52 offen sc1
MAV 36,20,104
TR 50,6,8960
MAV 36,4,96
TR 52,6,8480
TR 54,6,8992
s_waitcnt lgkmcnt(8)
MAV 40,8,96
TR 40,6,64
MAV 40,24,104
buffer_load_dwordx4 v19, s[28:31], s54 offen offset:1056 lds
MAV 56,24,108
TR 42,6,576
s_add_u32 s54, s101, 3538944
MAV 56,8,100
TR 44,6,96
TR 46,6,608
MAV 60,12,100
TR 56,6,8512
MAV 60,28,108
buffer_load_dwordx4 v[148:151], v4, s[16:19], s52 offen offset:1024 sc1
MAV 44,28,104
TR 58,6,9024
MAV 44,12,96
TR 60,6,8544
TR 62,6,9056
s_waitcnt lgkmcnt(8)
MAV 64,32,96
TR 0,7,16896
s_add_u32 m0, s55, 126720
MAV 64,48,104
buffer_load_dwordx4 v18, s[28:31], s54 offen lds
MAV 80,48,108
TR 2,7,17408
MAV 80,32,100
TR 4,7,16928
TR 6,7,17440
MAV 84,36,100
TR 16,7,25344
s_add_u32 s52, s79, 425984
MAV 84,52,108
buffer_load_dwordx4 v[152:155], v4, s[16:19], s52 offen sc1
MAV 68,52,104
TR 18,7,25856
MAV 68,36,96
TR 20,7,25376
TR 22,7,25888
s_waitcnt lgkmcnt(8)
MAV 72,40,96
TR 8,7,16960
MAV 72,56,104
buffer_load_dwordx4 v19, s[28:31], s54 offen offset:1056 lds
MAV 88,56,108
TR 10,7,17472
s_add_u32 s54, s98, 131072
MAV 88,40,100
TR 12,7,16992
TR 14,7,17504
MAV 92,44,100
TR 24,7,25408
MAV 92,60,108
buffer_load_dwordx4 v[156:159], v4, s[16:19], s52 offen offset:1024 sc1
MAV 76,60,104
TR 26,7,25920
MAV 76,44,96
TR 28,7,25440
TR 30,7,25952
s_waitcnt vmcnt(16) lgkmcnt(8)
s_barrier
MAV 32,0,112
TR 32,6,16896
s_add_u32 m0, s55, 0
MAV 32,16,120
buffer_load_dwordx4 v18, s[28:31], s54 offen lds
MAV 48,16,124
TR 34,6,17408
MAV 48,0,116
TR 36,6,16928
TR 38,6,17440
MAV 52,4,116
TR 48,6,25344
s_add_u32 s52, s76, 475136
MAV 52,20,124
buffer_load_dwordx4 v[96:99], v4, s[16:19], s52 offen sc1
MAV 36,20,120
TR 50,6,25856
MAV 36,4,112
TR 52,6,25376
TR 54,6,25888
s_waitcnt lgkmcnt(8)
MAV 40,8,112
TR 40,6,16960
MAV 40,24,120
buffer_load_dwordx4 v19, s[28:31], s54 offen offset:1056 lds
MAV 56,24,124
TR 42,6,17472
s_add_u32 s54, s98, 393216
MAV 56,8,116
TR 44,6,16992
TR 46,6,17504
MAV 60,12,116
TR 56,6,25408
MAV 60,28,124
buffer_load_dwordx4 v[100:103], v4, s[16:19], s52 offen offset:1024 sc1
MAV 44,28,120
TR 58,6,25920
MAV 44,12,112
TR 60,6,25440
TR 62,6,25952
s_waitcnt lgkmcnt(8)
MAV 64,32,112
TR 0,7,33792
s_add_u32 m0, s55, 8448
MAV 64,48,120
buffer_load_dwordx4 v18, s[28:31], s54 offen lds
MAV 80,48,124
TR 2,7,34304
MAV 80,32,116
TR 4,7,33824
TR 6,7,34336
MAV 84,36,116
TR 16,7,42240
s_add_u32 s52, s76, 540672
MAV 84,52,124
buffer_load_dwordx4 v[104:107], v4, s[16:19], s52 offen sc1
MAV 68,52,120
TR 18,7,42752
MAV 68,36,112
TR 20,7,42272
TR 22,7,42784
s_waitcnt lgkmcnt(8)
MAV 72,40,112
TR 8,7,33856
MAV 72,56,120
buffer_load_dwordx4 v19, s[28:31], s54 offen offset:1056 lds
MAV 88,56,124
TR 10,7,34368
s_add_u32 s54, s99, 589824
MAV 88,40,116
TR 12,7,33888
TR 14,7,34400
MAV 92,44,116
TR 24,7,42304
MAV 92,60,124
buffer_load_dwordx4 v[108:111], v4, s[16:19], s52 offen offset:1024 sc1
MAV 76,60,120
TR 26,7,42816
MAV 76,44,112
TR 28,7,42336
TR 30,7,42848
s_waitcnt vmcnt(16) lgkmcnt(8)
s_barrier
MAV 32,0,128
TR 32,6,33792
s_add_u32 m0, s55, 16896
MAV 32,16,136
buffer_load_dwordx4 v18, s[28:31], s54 offen lds
MAV 48,16,140
TR 34,6,34304
MAV 48,0,132
TR 36,6,33824
TR 38,6,34336
MAV 52,4,132
TR 48,6,42240
s_add_u32 s52, s77, 589824
MAV 52,20,140
buffer_load_dwordx4 v[112:115], v4, s[16:19], s52 offen sc1
MAV 36,20,136
TR 50,6,42752
MAV 36,4,128
TR 52,6,42272
TR 54,6,42784
s_waitcnt lgkmcnt(8)
MAV 40,8,128
TR 40,6,33856
MAV 40,24,136
buffer_load_dwordx4 v19, s[28:31], s54 offen offset:1056 lds
MAV 56,24,140
TR 42,6,34368
s_add_u32 s54, s99, 851968
MAV 56,8,132
TR 44,6,33888
TR 46,6,34400
MAV 60,12,132
TR 56,6,42304
MAV 60,28,140
buffer_load_dwordx4 v[116:119], v4, s[16:19], s52 offen offset:1024 sc1
MAV 44,28,136
TR 58,6,42816
MAV 44,12,128
TR 60,6,42336
TR 62,6,42848
s_waitcnt lgkmcnt(8)
MAV 64,32,128
TR 0,7,50688
s_add_u32 m0, s55, 25344
MAV 64,48,136
buffer_load_dwordx4 v18, s[28:31], s54 offen lds
MAV 80,48,140
TR 2,7,51200
MAV 80,32,132
TR 4,7,50720
TR 6,7,51232
MAV 84,36,132
TR 16,7,59136
s_add_u32 s52, s77, 655360
MAV 84,52,140
buffer_load_dwordx4 v[120:123], v4, s[16:19], s52 offen sc1
MAV 68,52,136
TR 18,7,59648
MAV 68,36,128
TR 20,7,59168
TR 22,7,59680
s_waitcnt lgkmcnt(8)
MAV 72,40,128
TR 8,7,50752
MAV 72,56,136
buffer_load_dwordx4 v19, s[28:31], s54 offen offset:1056 lds
MAV 88,56,140
TR 10,7,51264
s_add_u32 s54, s100, 1048576
MAV 88,40,132
TR 12,7,50784
TR 14,7,51296
MAV 92,44,132
TR 24,7,59200
MAV 92,60,140
buffer_load_dwordx4 v[124:127], v4, s[16:19], s52 offen offset:1024 sc1
MAV 76,60,136
TR 26,7,59712
MAV 76,44,128
TR 28,7,59232
TR 30,7,59744
s_waitcnt vmcnt(16) lgkmcnt(8)
s_barrier
MAV 32,0,144
TR 32,6,50688
s_add_u32 m0, s55, 33792
MAV 32,16,152
buffer_load_dwordx4 v18, s[28:31], s54 offen lds
MAV 48,16,156
TR 34,6,51200
MAV 48,0,148
TR 36,6,50720
TR 38,6,51232
MAV 52,4,148
TR 48,6,59136
s_add_u32 s52, s78, 704512
MAV 52,20,156
buffer_load_dwordx4 v[128:131], v4, s[16:19], s52 offen sc1
MAV 36,20,152
TR 50,6,59648
MAV 36,4,144
TR 52,6,59168
TR 54,6,59680
s_waitcnt lgkmcnt(8)
MAV 40,8,144
TR 40,6,50752
MAV 40,24,152
buffer_load_dwordx4 v19, s[28:31], s54 offen offset:1056 lds
MAV 56,24,156
TR 42,6,51264
s_add_u32 s54, s100, 1310720
MAV 56,8,148
TR 44,6,50784
TR 46,6,51296
MAV 60,12,148
TR 56,6,59200
MAV 60,28,156
buffer_load_dwordx4 v[132:135], v4, s[16:19], s52 offen offset:1024 sc1
MAV 44,28,152
TR 58,6,59712
MAV 44,12,144
TR 60,6,59232
TR 62,6,59744
v_add_u32 v7, s57, v7
v_add_u32 v6, s57, v6
s_sub_u32 s57, 0, s57
s_waitcnt lgkmcnt(8)
MAV 64,32,144
ds_read_b64_tr_b16 a[0:1], v7
s_add_u32 m0, s55, 42240
MAV 64,48,152
buffer_load_dwordx4 v18, s[28:31], s54 offen lds
MAV 80,48,156
TR 2,7,512
MAV 80,32,148
TR 4,7,32
TR 6,7,544
MAV 84,36,148
TR 16,7,8448
s_add_u32 s52, s78, 770048
MAV 84,52,156
buffer_load_dwordx4 v[136:139], v4, s[16:19], s52 offen sc1
MAV 68,52,152
TR 18,7,8960
MAV 68,36,144
TR 20,7,8480
TR 22,7,8992
s_waitcnt lgkmcnt(8)
MAV 72,40,144
TR 8,7,64
MAV 72,56,152
buffer_load_dwordx4 v19, s[28:31], s54 offen offset:1056 lds
MAV 88,56,156
TR 10,7,576
s_add_u32 s54, s101, 1507328
MAV 88,40,148
TR 12,7,96
TR 14,7,608
MAV 92,44,148
TR 24,7,8512
MAV 92,60,156
buffer_load_dwordx4 v[140:143], v4, s[16:19], s52 offen offset:1024 sc1
MAV 76,60,152
TR 26,7,9024
MAV 76,44,144
TR 28,7,8544
TR 30,7,9056
s_waitcnt vmcnt(16) lgkmcnt(8)
s_barrier
MAV 32,0,96
ds_read_b64_tr_b16 a[32:33], v6
s_add_u32 m0, s55, 50688
MAV 32,16,104
buffer_load_dwordx4 v18, s[28:31], s54 offen lds
MAV 48,16,108
TR 34,6,512
MAV 48,0,100
.Lpad37:
s_cbranch_execz .Lnopoll63r
TR 36,6,32
TR 38,6,544
MAV 52,4,100
TR 48,6,8448
s_add_u32 s52, s79, 819200
MAV 52,20,108
buffer_load_dwordx4 v[144:147], v4, s[16:19], s52 offen sc1
MAV 36,20,104
TR 50,6,8960
MAV 36,4,96
TR 52,6,8480
TR 54,6,8992
s_waitcnt lgkmcnt(8)
MAV 40,8,96
TR 40,6,64
MAV 40,24,104
buffer_load_dwordx4 v19, s[28:31], s54 offen offset:1056 lds
MAV 56,24,108
TR 42,6,576
s_add_u32 s54, s101, 1769472
MAV 56,8,100
TR 44,6,96
TR 46,6,608
MAV 60,12,100
TR 56,6,8512
MAV 60,28,108
buffer_load_dwordx4 v[148:151], v4, s[16:19], s52 offen offset:1024 sc1
MAV 44,28,104
TR 58,6,9024
MAV 44,12,96
TR 60,6,8544
TR 62,6,9056
s_waitcnt lgkmcnt(8)
MAV 64,32,96
TR 0,7,16896
s_add_u32 m0, s55, 59136
MAV 64,48,104
buffer_load_dwordx4 v18, s[28:31], s54 offen lds
MAV 80,48,108
TR 2,7,17408
MAV 80,32,100
TR 4,7,16928
TR 6,7,17440
MAV 84,36,100
TR 16,7,25344
s_add_u32 s52, s79, 884736
MAV 84,52,108
buffer_load_dwordx4 v[152:155], v4, s[16:19], s52 offen sc1
MAV 68,52,104
TR 18,7,25856
MAV 68,36,96
TR 20,7,25376
TR 22,7,25888
s_waitcnt lgkmcnt(8)
MAV 72,40,96
TR 8,7,16960
MAV 72,56,104
buffer_load_dwordx4 v19, s[28:31], s54 offen offset:1056 lds
MAV 88,56,108
TR 10,7,17472
s_add_u32 s54, s98, 1966080
MAV 88,40,100
TR 12,7,16992
TR 14,7,17504
MAV 92,44,100
TR 24,7,25408
MAV 92,60,108
buffer_load_dwordx4 v[156:159], v4, s[16:19], s52 offen offset:1024 sc1
MAV 76,60,104
TR 26,7,25920
MAV 76,44,96
TR 28,7,25440
TR 30,7,25952
s_waitcnt vmcnt(16) lgkmcnt(8)
s_barrier
MAV 32,0,112
TR 32,6,16896
s_add_u32 m0, s55, 67584
MAV 32,16,120
buffer_load_dwordx4 v18, s[28:31], s54 offen lds
MAV 48,16,124
TR 34,6,17408
MAV 48,0,116
TR 36,6,16928
TR 38,6,17440
MAV 52,4,116
TR 48,6,25344
s_add_u32 s52, s76, 32768
MAV 52,20,124
buffer_load_dwordx4 v[96:99], v4, s[16:19], s52 offen sc1
MAV 36,20,120
TR 50,6,25856
MAV 36,4,112
TR 52,6,25376
TR 54,6,25888
s_waitcnt lgkmcnt(8)
MAV 40,8,112
TR 40,6,16960
MAV 40,24,120
buffer_load_dwordx4 v19, s[28:31], s54 offen offset:1056 lds
MAV 56,24,124
TR 42,6,17472
s_add_u32 s54, s98, 2228224
MAV 56,8,116
TR 44,6,16992
TR 46,6,17504
MAV 60,12,116
TR 56,6,25408
MAV 60,28,124
buffer_load_dwordx4 v[100:103], v4, s[16:19], s52 offen offset:1024 sc1
MAV 44,28,120
TR 58,6,25920
MAV 44,12,112
TR 60,6,25440
TR 62,6,25952
s_waitcnt lgkmcnt(8)
MAV 64,32,112
TR 0,7,33792
s_add_u32 m0, s55, 76032
MAV 64,48,120
buffer_load_dwordx4 v18, s[28:31], s54 offen lds
MAV 80,48,124
TR 2,7,34304
MAV 80,32,116
TR 4,7,33824
TR 6,7,34336
MAV 84,36,116
TR 16,7,42240
s_add_u32 s52, s76, 98304
MAV 84,52,124
buffer_load_dwordx4 v[104:107], v4, s[16:19], s52 offen sc1
MAV 68,52,120
TR 18,7,42752
MAV 68,36,112
TR 20,7,42272
TR 22,7,42784
s_waitcnt lgkmcnt(8)
MAV 72,40,112
TR 8,7,33856
MAV 72,56,120
buffer_load_dwordx4 v19, s[28:31], s54 offen offset:1056 lds
MAV 88,56,124
TR 10,7,34368
s_add_u32 s54, s99, 2424832
MAV 88,40,116
TR 12,7,33888
TR 14,7,34400
MAV 92,44,116
TR 24,7,42304
MAV 92,60,124
buffer_load_dwordx4 v[108:111], v4, s[16:19], s52 offen offset:1024 sc1
MAV 76,60,120
TR 26,7,42816
MAV 76,44,112
TR 28,7,42336
TR 30,7,42848
s_waitcnt vmcnt(16) lgkmcnt(8)
s_barrier
MAV 32,0,128
TR 32,6,33792
s_add_u32 m0, s55, 84480
MAV 32,16,136
buffer_load_dwordx4 v18, s[28:31], s54 offen lds
MAV 48,16,140
TR 34,6,34304
MAV 48,0,132
TR 36,6,33824
TR 38,6,34336
MAV 52,4,132
TR 48,6,42240
s_add_u32 s52, s77, 147456
MAV 52,20,140
buffer_load_dwordx4 v[112:115], v4, s[16:19], s52 offen sc1
MAV 36,20,136
TR 50,6,42752
MAV 36,4,128
TR 52,6,42272
TR 54,6,42784
s_waitcnt lgkmcnt(8)
MAV 40,8,128
TR 40,6,33856
MAV 40,24,136
buffer_load_dwordx4 v19, s[28:31], s54 offen offset:1056 lds
MAV 56,24,140
TR 42,6,34368
s_add_u32 s54, s99, 2686976
MAV 56,8,132
TR 44,6,33888
TR 46,6,34400
MAV 60,12,132
TR 56,6,42304
MAV 60,28,140
buffer_load_dwordx4 v[116:119], v4, s[16:19], s52 offen offset:1024 sc1
MAV 44,28,136
TR 58,6,42816
MAV 44,12,128
TR 60,6,42336
TR 62,6,42848
s_waitcnt lgkmcnt(8)
MAV 64,32,128
TR 0,7,50688
s_add_u32 m0, s55, 92928
MAV 64,48,136
buffer_load_dwordx4 v18, s[28:31], s54 offen lds
MAV 80,48,140
TR 2,7,51200
MAV 80,32,132
TR 4,7,50720
TR 6,7,51232
MAV 84,36,132
TR 16,7,59136
s_add_u32 s52, s77, 212992
MAV 84,52,140
buffer_load_dwordx4 v[120:123], v4, s[16:19], s52 offen sc1
MAV 68,52,136
TR 18,7,59648
MAV 68,36,128
TR 20,7,59168
TR 22,7,59680
s_waitcnt lgkmcnt(8)
MAV 72,40,128
TR 8,7,50752
MAV 72,56,136
buffer_load_dwordx4 v19, s[28:31], s54 offen offset:1056 lds
MAV 88,56,140
TR 10,7,51264
s_add_u32 s54, s100, 2883584
MAV 88,40,132
TR 12,7,50784
TR 14,7,51296
MAV 92,44,132
TR 24,7,59200
MAV 92,60,140
buffer_load_dwordx4 v[124:127], v4, s[16:19], s52 offen offset:1024 sc1
MAV 76,60,136
TR 26,7,59712
MAV 76,44,128
TR 28,7,59232
TR 30,7,59744
s_waitcnt vmcnt(16) lgkmcnt(8)
s_barrier
MAV 32,0,144
TR 32,6,50688
s_add_u32 m0, s55, 101376
MAV 32,16,152
buffer_load_dwordx4 v18, s[28:31], s54 offen lds
MAV 48,16,156
TR 34,6,51200
MAV 48,0,148
TR 36,6,50720
TR 38,6,51232
MAV 52,4,148
TR 48,6,59136
s_add_u32 s52, s78, 262144
MAV 52,20,156
buffer_load_dwordx4 v[128:131], v4, s[16:19], s52 offen sc1
MAV 36,20,152
TR 50,6,59648
MAV 36,4,144
TR 52,6,59168
TR 54,6,59680
s_waitcnt lgkmcnt(8)
MAV 40,8,144
TR 40,6,50752
MAV 40,24,152
buffer_load_dwordx4 v19, s[28:31], s54 offen offset:1056 lds
MAV 56,24,156
TR 42,6,51264
s_add_u32 s54, s100, 3145728
MAV 56,8,148
TR 44,6,50784
TR 46,6,51296
MAV 60,12,148
TR 56,6,59200
MAV 60,28,156
buffer_load_dwordx4 v[132:135], v4, s[16:19], s52 offen offset:1024 sc1
MAV 44,28,152
TR 58,6,59712
MAV 44,12,144
TR 60,6,59232
TR 62,6,59744
v_add_u32 v7, s57, v7
v_add_u32 v6, s57, v6
s_sub_u32 s57, 0, s57
s_waitcnt lgkmcnt(8)
MAV 64,32,144
ds_read_b64_tr_b16 a[0:1], v7
s_add_u32 m0, s55, 109824
MAV 64,48,152
buffer_load_dwordx4 v18, s[28:31], s54 offen lds
MAV 80,48,156
TR 2,7,512
MAV 80,32,148
TR 4,7,32
TR 6,7,544
MAV 84,36,148
TR 16,7,8448
s_add_u32 s52, s78, 327680
MAV 84,52,156
buffer_load_dwordx4 v[136:139], v4, s[16:19], s52 offen sc1
MAV 68,52,152
TR 18,7,8960
MAV 68,36,144
TR 20,7,8480
TR 22,7,8992
s_waitcnt lgkmcnt(8)
MAV 72,40,144
TR 8,7,64
MAV 72,56,152
buffer_load_dwordx4 v19, s[28:31], s54 offen offset:1056 lds
MAV 88,56,156
TR 10,7,576
s_add_u32 s54, s101, 3342336
MAV 88,40,148
TR 12,7,96
TR 14,7,608
MAV 92,44,148
TR 24,7,8512
MAV 92,60,156
buffer_load_dwordx4 v[140:143], v4, s[16:19], s52 offen offset:1024 sc1
MAV 76,60,152
TR 26,7,9024
MAV 76,44,144
TR 28,7,8544
TR 30,7,9056
s_waitcnt vmcnt(16) lgkmcnt(8)
s_barrier
MAV 32,0,96
ds_read_b64_tr_b16 a[32:33], v6
s_add_u32 m0, s55, 118272
MAV 32,16,104
buffer_load_dwordx4 v18, s[28:31], s54 offen lds
MAV 48,16,108
TR 34,6,512
MAV 48,0,100
TR 36,6,32
TR 38,6,544
MAV 52,4,100
TR 48,6,8448
s_add_u32 s52, s79, 376832
MAV 52,20,108
buffer_load_dwordx4 v[144:147], v4, s[16:19], s52 offen sc1
MAV 36,20,104
TR 50,6,8960
MAV 36,4,96
TR 52,6,8480
TR 54,6,8992
s_waitcnt lgkmcnt(8)
MAV 40,8,96
TR 40,6,64
MAV 40,24,104
buffer_load_dwordx4 v19, s[28:31], s54 offen offset:1056 lds
MAV 56,24,108
TR 42,6,576
s_add_u32 s54, s101, 3604480
MAV 56,8,100
TR 44,6,96
TR 46,6,608
MAV 60,12,100
TR 56,6,8512
MAV 60,28,108
buffer_load_dwordx4 v[148:151], v4, s[16:19], s52 offen offset:1024 sc1
MAV 44,28,104
TR 58,6,9024
MAV 44,12,96
TR 60,6,8544
TR 62,6,9056
s_waitcnt lgkmcnt(8)
MAV 64,32,96
TR 0,7,16896
s_add_u32 m0, s55, 126720
MAV 64,48,104
buffer_load_dwordx4 v18, s[28:31], s54 offen lds
MAV 80,48,108
TR 2,7,17408
MAV 80,32,100
TR 4,7,16928
TR 6,7,17440
MAV 84,36,100
TR 16,7,25344
s_add_u32 s52, s79, 442368
MAV 84,52,108
buffer_load_dwordx4 v[152:155], v4, s[16:19], s52 offen sc1
MAV 68,52,104
TR 18,7,25856
MAV 68,36,96
TR 20,7,25376
TR 22,7,25888
s_waitcnt lgkmcnt(8)
MAV 72,40,96
TR 8,7,16960
MAV 72,56,104
buffer_load_dwordx4 v19, s[28:31], s54 offen offset:1056 lds
MAV 88,56,108
TR 10,7,17472
s_add_u32 s54, s98, 196608
MAV 88,40,100
TR 12,7,16992
TR 14,7,17504
MAV 92,44,100
TR 24,7,25408
MAV 92,60,108
buffer_load_dwordx4 v[156:159], v4, s[16:19], s52 offen offset:1024 sc1
MAV 76,60,104
TR 26,7,25920
MAV 76,44,96
TR 28,7,25440
TR 30,7,25952
s_waitcnt vmcnt(16) lgkmcnt(8)
s_barrier
MAV 32,0,112
TR 32,6,16896
s_add_u32 m0, s55, 0
MAV 32,16,120
buffer_load_dwordx4 v18, s[28:31], s54 offen lds
MAV 48,16,124
TR 34,6,17408
MAV 48,0,116
TR 36,6,16928
TR 38,6,17440
MAV 52,4,116
TR 48,6,25344
s_add_u32 s52, s76, 491520
MAV 52,20,124
buffer_load_dwordx4 v[96:99], v4, s[16:19], s52 offen sc1
MAV 36,20,120
TR 50,6,25856
MAV 36,4,112
TR 52,6,25376
TR 54,6,25888
s_waitcnt lgkmcnt(8)
MAV 40,8,112
TR 40,6,16960
MAV 40,24,120
buffer_load_dwordx4 v19, s[28:31], s54 offen offset:1056 lds
MAV 56,24,124
TR 42,6,17472
s_add_u32 s54, s99, 655360
MAV 56,8,116
TR 44,6,16992
TR 46,6,17504
MAV 60,12,116
TR 56,6,25408
MAV 60,28,124
buffer_load_dwordx4 v[100:103], v4, s[16:19], s52 offen offset:1024 sc1
MAV 44,28,120
TR 58,6,25920
MAV 44,12,112
TR 60,6,25440
TR 62,6,25952
s_waitcnt lgkmcnt(8)
MAV 64,32,112
TR 0,7,33792
s_add_u32 m0, s55, 8448
MAV 64,48,120
buffer_load_dwordx4 v18, s[28:31], s54 offen lds
MAV 80,48,124
TR 2,7,34304
MAV 80,32,116
TR 4,7,33824
TR 6,7,34336
MAV 84,36,116
TR 16,7,42240
s_add_u32 s52, s76, 557056
MAV 84,52,124
buffer_load_dwordx4 v[104:107], v4, s[16:19], s52 offen sc1
MAV 68,52,120
TR 18,7,42752
MAV 68,36,112
TR 20,7,42272
TR 22,7,42784
s_waitcnt lgkmcnt(8)
MAV 72,40,112
TR 8,7,33856
MAV 72,56,120
buffer_load_dwordx4 v19, s[28:31], s54 offen offset:1056 lds
MAV 88,56,124
TR 10,7,34368
s_add_u32 s54, s100, 1114112
MAV 88,40,116
TR 12,7,33888
TR 14,7,34400
MAV 92,44,116
TR 24,7,42304
MAV 92,60,124
buffer_load_dwordx4 v[108:111], v4, s[16:19], s52 offen offset:1024 sc1
MAV 76,60,120
TR 26,7,42816
MAV 76,44,112
TR 28,7,42336
TR 30,7,42848
s_waitcnt vmcnt(16) lgkmcnt(8)
s_barrier
MAV 32,0,128
TR 32,6,33792
s_add_u32 m0, s55, 16896
MAV 32,16,136
buffer_load_dwordx4 v18, s[28:31], s54 offen lds
MAV 48,16,140
TR 34,6,34304
MAV 48,0,132
TR 36,6,33824
TR 38,6,34336
MAV 52,4,132
TR 48,6,42240
s_add_u32 s52, s77, 606208
MAV 52,20,140
buffer_load_dwordx4 v[112:115], v4, s[16:19], s52 offen sc1
MAV 36,20,136
TR 50,6,42752
MAV 36,4,128
TR 52,6,42272
TR 54,6,42784
s_waitcnt lgkmcnt(8)
MAV 40,8,128
TR 40,6,33856
MAV 40,24,136
buffer_load_dwordx4 v19, s[28:31], s54 offen offset:1056 lds
MAV 56,24,140
TR 42,6,34368
s_add_u32 s54, s101, 1572864
MAV 56,8,132
TR 44,6,33888
TR 46,6,34400
MAV 60,12,132
TR 56,6,42304
MAV 60,28,140
buffer_load_dwordx4 v[116:119], v4, s[16:19], s52 offen offset:1024 sc1
MAV 44,28,136
.Lpad38:
s_cbranch_execz .Lnopoll63r
TR 58,6,42816
MAV 44,12,128
TR 60,6,42336
TR 62,6,42848
s_waitcnt lgkmcnt(8)
MAV 64,32,128
TR 0,7,50688
s_add_u32 m0, s55, 25344
MAV 64,48,136
buffer_load_dwordx4 v18, s[28:31], s54 offen lds
MAV 80,48,140
TR 2,7,51200
MAV 80,32,132
TR 4,7,50720
TR 6,7,51232
MAV 84,36,132
TR 16,7,59136
s_add_u32 s52, s77, 671744
MAV 84,52,140
buffer_load_dwordx4 v[120:123], v4, s[16:19], s52 offen sc1
MAV 68,52,136
TR 18,7,59648
MAV 68,36,128
TR 20,7,59168
TR 22,7,59680
s_waitcnt lgkmcnt(8)
MAV 72,40,128
TR 8,7,50752
MAV 72,56,136
buffer_load_dwordx4 v19, s[28:31], s54 offen offset:1056 lds
MAV 88,56,140
TR 10,7,51264
s_add_u32 s54, s98, 2031616
MAV 88,40,132
TR 12,7,50784
TR 14,7,51296
MAV 92,44,132
TR 24,7,59200
MAV 92,60,140
buffer_load_dwordx4 v[124:127], v4, s[16:19], s52 offen offset:1024 sc1
MAV 76,60,136
TR 26,7,59712
MAV 76,44,128
TR 28,7,59232
TR 30,7,59744
s_waitcnt vmcnt(16) lgkmcnt(8)
s_barrier
MAV 32,0,144
TR 32,6,50688
s_add_u32 m0, s55, 33792
MAV 32,16,152
buffer_load_dwordx4 v18, s[28:31], s54 offen lds
MAV 48,16,156
TR 34,6,51200
MAV 48,0,148
TR 36,6,50720
TR 38,6,51232
MAV 52,4,148
TR 48,6,59136
s_add_u32 s52, s78, 720896
MAV 52,20,156
buffer_load_dwordx4 v[128:131], v4, s[16:19], s52 offen sc1
MAV 36,20,152
TR 50,6,59648
MAV 36,4,144
TR 52,6,59168
TR 54,6,59680
s_waitcnt lgkmcnt(8)
MAV 40,8,144
TR 40,6,50752
MAV 40,24,152
buffer_load_dwordx4 v19, s[28:31], s54 offen offset:1056 lds
MAV 56,24,156
TR 42,6,51264
s_add_u32 s54, s99, 2490368
MAV 56,8,148
TR 44,6,50784
TR 46,6,51296
MAV 60,12,148
TR 56,6,59200
MAV 60,28,156
buffer_load_dwordx4 v[132:135], v4, s[16:19], s52 offen offset:1024 sc1
MAV 44,28,152
TR 58,6,59712
MAV 44,12,144
TR 60,6,59232
TR 62,6,59744
v_add_u32 v7, s57, v7
v_add_u32 v6, s57, v6
s_sub_u32 s57, 0, s57
s_waitcnt lgkmcnt(8)
MAV 64,32,144
ds_read_b64_tr_b16 a[0:1], v6
s_add_u32 m0, s55, 42240
MAV 64,48,152
buffer_load_dwordx4 v18, s[28:31], s54 offen lds
MAV 80,48,156
TR 2,6,512
MAV 80,32,148
TR 4,6,32
TR 6,6,544
MAV 84,36,148
TR 16,6,8448
s_add_u32 s52, s78, 786432
MAV 84,52,156
buffer_load_dwordx4 v[136:139], v4, s[16:19], s52 offen sc1
MAV 68,52,152
TR 18,6,8960
MAV 68,36,144
TR 20,6,8480
TR 22,6,8992
s_waitcnt lgkmcnt(8)
MAV 72,40,144
TR 8,6,64
MAV 72,56,152
buffer_load_dwordx4 v19, s[28:31], s54 offen offset:1056 lds
MAV 88,56,156
TR 10,6,576
s_add_u32 s54, s100, 2949120
MAV 88,40,148
TR 12,6,96
TR 14,6,608
MAV 92,44,148
TR 24,6,8512
MAV 92,60,156
buffer_load_dwordx4 v[140:143], v4, s[16:19], s52 offen offset:1024 sc1
MAV 76,60,152
TR 26,6,9024
MAV 76,44,144
TR 28,6,8544
TR 30,6,9056
s_waitcnt vmcnt(16) lgkmcnt(8)
s_barrier
MAV 64,0,96
TR 32,6,16896
TR 34,6,17408
s_add_u32 m0, s55, 50688
MAV 64,16,104
TR 36,6,16928
buffer_load_dwordx4 v18, s[28:31], s54 offen lds
MAV 80,16,108
TR 38,6,17440
MAV 80,0,100
TR 48,6,25344
buffer_load_dwordx4 v19, s[28:31], s54 offen offset:1056 lds
MAV 84,4,100
TR 50,6,25856
s_add_u32 s54, s101, 3407872
s_add_u32 s52, s79, 835584
MAV 84,20,108
buffer_load_dwordx4 v[144:147], v4, s[16:19], s52 offen sc1
MAV 68,20,104
TR 52,6,25376
TR 54,6,25888
MAV 68,4,96
TR 40,6,16960
s_waitcnt lgkmcnt(9)
MAV 72,8,96
TR 42,6,17472
MAV 72,24,104
TR 44,6,16992
buffer_load_dwordx4 v[148:151], v4, s[16:19], s52 offen offset:1024 sc1
MAV 88,24,108
TR 46,6,17504
s_add_u32 m0, s55, 59136
MAV 88,8,100
TR 56,6,25408
buffer_load_dwordx4 v18, s[28:31], s54 offen lds
MAV 92,12,100
TR 58,6,25920
MAV 92,28,108
TR 60,6,25440
buffer_load_dwordx4 v19, s[28:31], s54 offen offset:1056 lds
MAV 76,28,104
TR 62,6,25952
s_add_u32 s52, s79, 901120
MAV 76,12,96
buffer_load_dwordx4 v[152:155], v4, s[16:19], s52 offen sc1
buffer_load_dwordx4 v[156:159], v4, s[16:19], s52 offen offset:1024 sc1
s_waitcnt vmcnt(16) lgkmcnt(8)
MAV 64,32,112
TR 0,6,33792
s_add_u32 s52, s76, 49152
s_lshl_b32 s70, s2, 10
s_lshl_b32 s62, s3, 7
MAV 64,48,120
buffer_load_dwordx4 v[160:163], v4, s[16:19], s52 offen sc1
s_add_u32 s70, s70, s62
MAV 80,48,124
TR 2,6,34304
s_add_u32 s70, s70, 31457280
MAV 80,32,116
TR 4,6,33824
TR 6,6,34336
s_xor_b32 s71, s70, 1024
MAV 84,36,116
TR 16,6,42240
v_min_u32 v26, 1, v1
MAV 84,52,124
buffer_load_dwordx4 v[164:167], v4, s[16:19], s52 offen offset:1024 sc1
v_lshlrev_b32 v26, 28, v26
MAV 68,52,120
TR 18,6,42752
v_mov_b32 v30, 1
MAV 68,36,112
TR 20,6,42272
TR 22,6,42784
v_mov_b32 v31, 0
s_waitcnt lgkmcnt(8)
MAV 72,40,112
TR 8,6,33856
s_add_u32 s52, s77, 163840
s_lshl_b32 s68, s7, 18
MAV 72,56,120
buffer_load_dwordx4 v[168:171], v4, s[16:19], s52 offen sc1
s_add_u32 s68, s68, 142606336
MAV 88,56,124
TR 10,6,34368
s_xor_b32 s69, s68, 262144
MAV 88,40,116
TR 12,6,33888
TR 14,6,34400
v_and_b32 v2, 1, v1
MAV 92,44,116
TR 24,6,42304
v_lshlrev_b32 v2, 4, v2
MAV 92,60,124
buffer_load_dwordx4 v[172:175], v4, s[16:19], s52 offen offset:1024 sc1
v_mov_b32 v224, 0x3f80
MAV 76,60,120
TR 26,6,42816
v_lshlrev_b32 v2, v2, v224
v_bfe_u32 v224, v1, 2, 2
MAV 76,44,112
TR 28,6,42336
TR 30,6,42848
s_waitcnt vmcnt(12) lgkmcnt(8)
MAV 64,0,128
TR 32,6,50688
s_add_u32 s52, s78, 278528
v_lshrrev_b32 v225, 4, v1
v_cmp_eq_u32 vcc, v224, v225
MAV 64,16,136
buffer_load_dwordx4 v[176:179], v4, s[16:19], s52 offen sc1
v_cndmask_b32 v2, 0, v2, vcc
MAV 80,16,140
TR 34,6,51200
v_and_b32 v224, 2, v1
MAV 80,0,132
TR 36,6,50720
TR 38,6,51232
v_cmp_eq_u32 vcc, 0, v224
MAV 84,4,132
TR 48,6,59136
v_cndmask_b32 v226, 0, v2, vcc
MAV 84,20,140
buffer_load_dwordx4 v[180:183], v4, s[16:19], s52 offen offset:1024 sc1
v_cndmask_b32 v227, v2, 0, vcc
MAV 68,20,136
TR 50,6,59648
v_mov_b32 v224, 0
MAV 68,4,128
TR 52,6,59168
TR 54,6,59680
v_mov_b32 v225, 0
s_waitcnt lgkmcnt(8)
MAV 72,8,128
TR 40,6,50752
s_add_u32 s52, s79, 393216
v_mov_b32 v228, 0
MAV 72,24,136
buffer_load_dwordx4 v[184:187], v4, s[16:19], s52 offen sc1
v_mov_b32 v229, 0
MAV 88,24,140
TR 42,6,51264
s_lshr_b32 s62, s6, 1
MAV 88,8,132
TR 44,6,50784
TR 46,6,51296
s_lshl_b32 s62, s62, 8
MAV 92,12,132
TR 56,6,59200
s_and_b32 s67, s6, 1
MAV 92,28,140
buffer_load_dwordx4 v[188:191], v4, s[16:19], s52 offen offset:1024 sc1
s_add_u32 s62, s62, s67
MAV 76,28,136
TR 58,6,59712
s_lshl_b32 s62, s62, 11
s_lshl_b32 s63, s3, 17
MAV 76,12,128
TR 60,6,59232
TR 62,6,59744
s_waitcnt vmcnt(8) lgkmcnt(8)
s_barrier
v_add_u32 v6, s57, v6
MAV 64,32,144
ds_read_b64_tr_b16 a[0:1], v6
s_add_u32 s52, s76, 507904
s_add_u32 s62, s62, s63
s_lshl_b32 s63, s7, 7
MAV 64,48,152
buffer_load_dwordx4 v[192:195], v4, s[16:19], s52 offen sc1
s_add_u32 s62, s62, s63
MAV 80,48,156
TR 2,6,512
s_mov_b32 s64, 0x8000
MAV 80,32,148
TR 4,6,32
TR 6,6,544
v_lshrrev_b32 v21, 3, v1
MAV 84,36,148
TR 16,6,8448
v_and_b32 v2, 7, v1
MAV 84,52,156
buffer_load_dwordx4 v[196:199], v4, s[16:19], s52 offen offset:1024 sc1
v_lshlrev_b32 v2, 4, v2
MAV 68,52,152
TR 18,6,8960
v_lshl_add_u32 v16, v21, 12, v2
MAV 68,36,144
TR 20,6,8480
TR 22,6,8992
v_add_u32 v16, s62, v16
s_waitcnt lgkmcnt(8)
MAV 72,40,144
TR 8,6,64
s_add_u32 s52, s77, 622592
v_add_u32 v17, 0x10000, v16
MAV 72,56,152
buffer_load_dwordx4 v[200:203], v4, s[16:19], s52 offen sc1
s_mul_i32 s62, s3, 4608
MAV 88,56,156
TR 10,6,576
s_add_u32 s62, s62, 135168
MAV 88,40,148
TR 12,6,96
TR 14,6,608
v_mul_u32_u24 v21, 144, v21
MAV 92,44,148
TR 24,6,8512
v_add3_u32 v21, v21, v2, s62
MAV 92,60,156
buffer_load_dwordx4 v[204:207], v4, s[16:19], s52 offen offset:1024 sc1
v_and_b32 v20, 15, v1
MAV 76,60,152
TR 26,6,9024
v_mul_u32_u24 v20, 144, v20
v_lshrrev_b32 v2, 4, v1
MAV 76,44,144
TR 28,6,8544
TR 30,6,9056
s_waitcnt vmcnt(8) lgkmcnt(8)
MAV 64,0,160
TR 32,6,16896
s_add_u32 s52, s78, 737280
v_lshlrev_b32 v2, 3, v2
v_add3_u32 v20, v20, v2, s62
MAV 64,16,168
buffer_load_dwordx4 v[208:211], v4, s[16:19], s52 offen sc1
v_accvgpr_read_b32 v28, a224
MAV 80,16,172
TR 34,6,17408
v_add_f32 v32, v32, v28
MAV 80,0,164
TR 36,6,16928
TR 38,6,17440
v_accvgpr_read_b32 v29, a225
MAV 84,4,164
TR 48,6,25344
v_add_f32 v33, v33, v29
MAV 84,20,172
buffer_load_dwordx4 v[212:215], v4, s[16:19], s52 offen offset:1024 sc1
v_accvgpr_read_b32 v28, a226
MAV 68,20,168
TR 50,6,25856
v_add_f32 v34, v34, v28
MAV 68,4,160
TR 52,6,25376
TR 54,6,25888
v_accvgpr_read_b32 v29, a227
s_waitcnt lgkmcnt(8)
MAV 72,8,160
TR 40,6,16960
s_add_u32 s52, s79, 851968
v_add_f32 v35, v35, v29
MAV 72,24,168
buffer_load_dwordx4 v[216:219], v4, s[16:19], s52 offen sc1
v_accvgpr_read_b32 v28, a228
MAV 88,24,172
TR 42,6,17472
v_add_f32 v36, v36, v28
MAV 88,8,164
TR 44,6,16992
TR 46,6,17504
v_accvgpr_read_b32 v29, a229
MAV 92,12,164
TR 56,6,25408
v_add_f32 v37, v37, v29
MAV 92,28,172
buffer_load_dwordx4 v[220:223], v4, s[16:19], s52 offen offset:1024 sc1
v_accvgpr_read_b32 v28, a230
MAV 76,28,168
TR 58,6,25920
v_add_f32 v38, v38, v28
v_accvgpr_read_b32 v29, a231
MAV 76,12,160
TR 60,6,25440
TR 62,6,25952
s_waitcnt vmcnt(8) lgkmcnt(8)
MAV 64,32,176
TR 0,6,33792
v_add_f32 v39, v39, v29
MAV 64,48,184
TR 2,6,34304
v_accvgpr_read_b32 v28, a232
v_add_f32 v40, v40, v28
MAV 80,48,188
TR 4,6,33824
MAV 80,32,180
TR 6,6,34336
v_accvgpr_read_b32 v29, a233
v_add_f32 v41, v41, v29
MAV 84,36,180
TR 16,6,42240
v_accvgpr_read_b32 v28, a234
MAV 84,52,188
TR 18,6,42752
v_add_f32 v42, v42, v28
MAV 68,52,184
TR 20,6,42272
v_accvgpr_read_b32 v29, a235
MAV 68,36,176
TR 22,6,42784
v_add_f32 v43, v43, v29
s_waitcnt lgkmcnt(8)
MAV 72,40,176
TR 8,6,33856
MAV 72,56,184
TR 10,6,34368
v_accvgpr_read_b32 v28, a236
v_add_f32 v44, v44, v28
MAV 88,56,188
TR 12,6,33888
v_accvgpr_read_b32 v29, a237
MAV 88,40,180
TR 14,6,34400
v_add_f32 v45, v45, v29
MAV 92,44,180
TR 24,6,42304
v_accvgpr_read_b32 v28, a238
MAV 92,60,188
TR 26,6,42816
v_add_f32 v46, v46, v28
MAV 76,60,184
TR 28,6,42336
v_accvgpr_read_b32 v29, a239
MAV 76,44,176
TR 30,6,42848
v_add_f32 v47, v47, v29
s_waitcnt vmcnt(4) lgkmcnt(8)
MAV 64,0,192
TR 32,6,50688
v_accvgpr_read_b32 v28, a240
MAV 64,16,200
TR 34,6,51200
v_add_f32 v48, v48, v28
v_accvgpr_read_b32 v29, a241
MAV 80,16,204
TR 36,6,50720
MAV 80,0,196
TR 38,6,51232
v_add_f32 v49, v49, v29
v_accvgpr_read_b32 v28, a242
MAV 84,4,196
TR 48,6,59136
v_add_f32 v50, v50, v28
MAV 84,20,204
TR 50,6,59648
v_accvgpr_read_b32 v29, a243
MAV 68,20,200
TR 52,6,59168
v_add_f32 v51, v51, v29
MAV 68,4,192
TR 54,6,59680
v_accvgpr_read_b32 v28, a244
s_waitcnt lgkmcnt(8)
MAV 72,8,192
TR 40,6,50752
MAV 72,24,200
TR 42,6,51264
v_add_f32 v52, v52, v28
v_accvgpr_read_b32 v29, a245
MAV 88,24,204
TR 44,6,50784
v_add_f32 v53, v53, v29
MAV 88,8,196
TR 46,6,51296
v_accvgpr_read_b32 v28, a246
MAV 92,12,196
TR 56,6,59200
v_add_f32 v54, v54, v28
MAV 92,28,204
TR 58,6,59712
v_accvgpr_read_b32 v29, a247
MAV 76,28,200
TR 60,6,59232
v_add_f32 v55, v55, v29
MAV 76,12,192
TR 62,6,59744
v_accvgpr_read_b32 v28, a248
s_waitcnt vmcnt(0) lgkmcnt(8)
MAV 64,32,208
ds_read_b64_tr_b16 a[0:1], v7
v_add_f32 v56, v56, v28
MAV 64,48,216
TR 2,7,512
v_accvgpr_read_b32 v29, a249
MAV 80,48,220
TR 4,7,32
v_add_f32 v57, v57, v29
MAV 80,32,212
TR 6,7,544
v_accvgpr_read_b32 v28, a250
MAV 84,36,212
TR 16,7,8448
v_add_f32 v58, v58, v28
MAV 84,52,220
TR 18,7,8960
v_accvgpr_read_b32 v29, a251
MAV 68,52,216
TR 20,7,8480
v_add_f32 v59, v59, v29
MAV 68,36,208
TR 22,7,8992
s_waitcnt lgkmcnt(8)
MAV 72,40,208
TR 8,7,64
v_accvgpr_read_b32 v28, a252
MAV 72,56,216
TR 10,7,576
v_add_f32 v60, v60, v28
MAV 88,56,220
TR 12,7,96
v_accvgpr_read_b32 v29, a253
MAV 88,40,212
TR 14,7,608
v_add_f32 v61, v61, v29
MAV 92,44,212
TR 24,7,8512
v_accvgpr_read_b32 v28, a254
MAV 92,60,220
TR 26,7,9024
v_add_f32 v62, v62, v28
MAV 76,60,216
TR 28,7,8544
v_accvgpr_read_b32 v29, a255
MAV 76,44,208
TR 30,7,9056
v_add_f32 v63, v63, v29
s_waitcnt lgkmcnt(8)
.Lpad39:
s_cbranch_execz .Lnopoll63r
MAV 32,0,96
TR 32,7,16896
v_cvt_pk_bf16_f32 v232, v64, v65
MAV 32,16,104
TR 34,7,17408
v_cvt_pk_bf16_f32 v233, v66, v67
v_cvt_pk_bf16_f32 v234, v68, v69
MAV 48,16,108
TR 36,7,16928
v_cvt_pk_bf16_f32 v235, v70, v71
MAV 48,0,100
TR 38,7,17440
buffer_store_dwordx4 v[232:235], v4, s[16:19], s69 offen sc1
s_add_u32 s69, s69, 131072
MAV 52,4,100
TR 48,7,25344
v_cvt_pk_bf16_f32 v236, v72, v73
MAV 52,20,108
TR 50,7,25856
v_cvt_pk_bf16_f32 v237, v74, v75
v_cvt_pk_bf16_f32 v238, v76, v77
MAV 36,20,104
TR 52,7,25376
v_cvt_pk_bf16_f32 v239, v78, v79
MAV 36,4,96
TR 54,7,25888
buffer_store_dwordx4 v[236:239], v4, s[16:19], s69 offen sc1
s_waitcnt lgkmcnt(8)
MAV 40,8,96
TR 40,7,16960
s_add_u32 s69, s69, -130048
MAV 40,24,104
TR 42,7,17472
v_cvt_pk_bf16_f32 v240, v80, v81
v_cvt_pk_bf16_f32 v241, v82, v83
MAV 56,24,108
TR 44,7,16992
v_cvt_pk_bf16_f32 v242, v84, v85
MAV 56,8,100
TR 46,7,17504
v_cvt_pk_bf16_f32 v243, v86, v87
buffer_store_dwordx4 v[240:243], v4, s[16:19], s69 offen sc1
MAV 60,12,100
TR 56,7,25408
s_add_u32 s69, s69, 131072
MAV 60,28,108
TR 58,7,25920
v_cvt_pk_bf16_f32 v244, v88, v89
v_cvt_pk_bf16_f32 v245, v90, v91
MAV 44,28,104
TR 60,7,25440
v_cvt_pk_bf16_f32 v246, v92, v93
MAV 44,12,96
TR 62,7,25952
v_cvt_pk_bf16_f32 v247, v94, v95
buffer_store_dwordx4 v[244:247], v4, s[16:19], s69 offen sc1
s_waitcnt lgkmcnt(8)
MAV 32,32,112
TR 0,7,33792
MAV 32,48,120
TR 2,7,34304
MAV 48,48,124
TR 4,7,33824
MAV 48,32,116
TR 6,7,34336
MAV 52,36,116
TR 16,7,42240
MAV 52,52,124
TR 18,7,42752
MAV 36,52,120
TR 20,7,42272
MAV 36,36,112
TR 22,7,42784
s_waitcnt lgkmcnt(8)
MAV 40,40,112
TR 8,7,33856
MAV 40,56,120
TR 10,7,34368
MAV 56,56,124
TR 12,7,33888
MAV 56,40,116
TR 14,7,34400
MAV 60,44,116
TR 24,7,42304
MAV 60,60,124
TR 26,7,42816
MAV 44,60,120
TR 28,7,42336
MAV 44,44,112
TR 30,7,42848
s_waitcnt lgkmcnt(8)
MAV 32,0,128
TR 32,7,50688
MAV 32,16,136
TR 34,7,51200
MAV 48,16,140
TR 36,7,50720
MAV 48,0,132
TR 38,7,51232
MAV 52,4,132
TR 48,7,59136
MAV 52,20,140
TR 50,7,59648
MAV 36,20,136
TR 52,7,59168
MAV 36,4,128
TR 54,7,59680
s_waitcnt lgkmcnt(8)
MAV 40,8,128
TR 40,7,50752
MAV 40,24,136
TR 42,7,51264
MAV 56,24,140
TR 44,7,50784
MAV 56,8,132
TR 46,7,51296
MAV 60,12,132
TR 56,7,59200
MAV 60,28,140
TR 58,7,59712
MAV 44,28,136
TR 60,7,59232
MAV 44,12,128
TR 62,7,59744
v_add_u32 v7, s57, v7
s_waitcnt lgkmcnt(8)
MAV 32,32,144
ds_read_b64_tr_b16 a[0:1], v7
MAV 32,48,152
s_waitcnt vmcnt(0)
buffer_atomic_add v30, v26, s[16:19], s71 offen
MAV 48,48,156
TR 2,7,512
MAV 48,32,148
TR 4,7,32
TR 6,7,544
MAV 52,36,148
MAV 52,52,156
TR 16,7,8448
TR 18,7,8960
MAV 36,52,152
TR 20,7,8480
MAV 36,36,144
s_waitcnt lgkmcnt(7)
MAV 40,40,144
TR 22,7,8992
MAV 40,56,152
TR 8,7,64
TR 10,7,576
MAV 56,56,156
MAV 56,40,148
TR 12,7,96
TR 14,7,608
MAV 60,44,148
TR 24,7,8512
MAV 60,60,156
TR 26,7,9024
MAV 44,60,152
TR 28,7,8544
MAV 44,44,144
TR 30,7,9056
s_waitcnt lgkmcnt(8)
MAV 32,0,160
TR 32,7,16896
MAV 32,16,168
buffer_atomic_add v31, v26, s[16:19], s70 offen sc0
MAV 48,16,172
TR 34,7,17408
MAV 48,0,164
TR 36,7,16928
TR 38,7,17440
MAV 52,4,164
MAV 52,20,172
TR 48,7,25344
TR 50,7,25856
MAV 36,20,168
TR 52,7,25376
MAV 36,4,160
s_waitcnt lgkmcnt(7)
MAV 40,8,160
TR 54,7,25888
MAV 40,24,168
TR 40,7,16960
TR 42,7,17472
MAV 56,24,172
MAV 56,8,164
TR 44,7,16992
TR 46,7,17504
MAV 60,12,164
TR 56,7,25408
MAV 60,28,172
TR 58,7,25920
MAV 44,28,168
TR 60,7,25440
MAV 44,12,160
TR 62,7,25952
s_waitcnt lgkmcnt(8)
MAV 32,32,176
TR 0,7,33792
MAV 32,48,184
TR 2,7,34304
MAV 48,48,188
TR 4,7,33824
MAV 48,32,180
TR 6,7,34336
MAV 52,36,180
TR 16,7,42240
MAV 52,52,188
TR 18,7,42752
MAV 36,52,184
TR 20,7,42272
MAV 36,36,176
TR 22,7,42784
s_waitcnt lgkmcnt(8)
MAV 40,40,176
TR 8,7,33856
MAV 40,56,184
TR 10,7,34368
MAV 56,56,188
TR 12,7,33888
MAV 56,40,180
TR 14,7,34400
MAV 60,44,180
TR 24,7,42304
MAV 60,60,188
TR 26,7,42816
MAV 44,60,184
TR 28,7,42336
MAV 44,44,176
TR 30,7,42848
s_waitcnt vmcnt(0)
v_cmp_le_u32 vcc, 2, v31
s_nop 0
s_cbranch_vccnz .Lxs68
s_mov_b32 s15, 0
.Lxs68l:
v_mov_b32 v31, 0
buffer_atomic_add v31, v26, s[16:19], s70 offen sc0
s_add_u32 s15, s15, 1
s_cmp_gt_u32 s15, 100000
s_waitcnt vmcnt(0)
s_cbranch_scc1 .Lxs68
v_cmp_le_u32 vcc, 2, v31
s_nop 0
s_cbranch_vccz .Lxs68l
.Lxs68:
s_waitcnt lgkmcnt(8)
MAV 32,0,192
TR 32,7,50688
MAV 32,16,200
buffer_load_dwordx4 v[232:235], v4, s[16:19], s68 offen sc1
MAV 48,16,204
TR 34,7,51200
s_add_u32 s68, s68, 131072
MAV 48,0,196
TR 36,7,50720
TR 38,7,51232
MAV 52,4,196
TR 48,7,59136
MAV 52,20,204
buffer_load_dwordx4 v[236:239], v4, s[16:19], s68 offen sc1
MAV 36,20,200
TR 50,7,59648
s_add_u32 s68, s68, -130048
MAV 36,4,192
TR 52,7,59168
TR 54,7,59680
s_waitcnt lgkmcnt(8)
MAV 40,8,192
TR 40,7,50752
MAV 40,24,200
buffer_load_dwordx4 v[240:243], v4, s[16:19], s68 offen sc1
MAV 56,24,204
TR 42,7,51264
s_add_u32 s68, s68, 131072
MAV 56,8,196
TR 44,7,50784
TR 46,7,51296
MAV 60,12,196
TR 56,7,59200
MAV 60,28,204
buffer_load_dwordx4 v[244:247], v4, s[16:19], s68 offen sc1
MAV 44,28,200
TR 58,7,59712
MAV 44,12,192
TR 60,7,59232
TR 62,7,59744
s_waitcnt lgkmcnt(8)
MAV 32,32,208
MAV 32,48,216
MAV 48,48,220
MAV 48,32,212
MAV 52,36,212
MAV 52,52,220
MAV 36,52,216
MAV 36,36,208
s_waitcnt lgkmcnt(0)
MAV 40,40,208
MAV 40,56,216
MAV 56,56,220
MAV 56,40,212
MAV 60,44,212
MAV 60,60,220
MAV 44,60,216
MAV 44,44,208
s_waitcnt vmcnt(3)
v_mfma_f32_16x16x32_bf16 v[32:35], v[226:229], v[232:235], v[32:35]
v_mfma_f32_16x16x32_bf16 v[36:39], v[224:227], v[232:235], v[36:39]
s_waitcnt vmcnt(2)
v_mfma_f32_16x16x32_bf16 v[40:43], v[226:229], v[236:239], v[40:43]
v_mfma_f32_16x16x32_bf16 v[44:47], v[224:227], v[236:239], v[44:47]
s_waitcnt vmcnt(1)
v_mfma_f32_16x16x32_bf16 v[48:51], v[226:229], v[240:243], v[48:51]
v_mfma_f32_16x16x32_bf16 v[52:55], v[224:227], v[240:243], v[52:55]
s_waitcnt vmcnt(0)
v_mfma_f32_16x16x32_bf16 v[56:59], v[226:229], v[244:247], v[56:59]
v_cvt_pk_bf16_f32 v128, v32, v33
v_mfma_f32_16x16x32_bf16 v[60:63], v[224:227], v[244:247], v[60:63]
v_cvt_pk_bf16_f32 v129, v34, v35
ds_write_b64 v20, v[128:129]
v_cvt_pk_bf16_f32 v130, v36, v37
v_cvt_pk_bf16_f32 v131, v38, v39
ds_write_b64 v20, v[130:131] offset:32
v_cvt_pk_bf16_f32 v132, v40, v41
v_cvt_pk_bf16_f32 v133, v42, v43
ds_write_b64 v20, v[132:133] offset:64
v_cvt_pk_bf16_f32 v134, v44, v45
v_cvt_pk_bf16_f32 v135, v46, v47
ds_write_b64 v20, v[134:135] offset:96
ds_read_b128 v[144:147], v21
ds_read_b128 v[148:151], v21 offset:1152
v_cvt_pk_bf16_f32 v136, v48, v49
v_cvt_pk_bf16_f32 v137, v50, v51
ds_write_b64 v20, v[136:137] offset:2304
v_cvt_pk_bf16_f32 v138, v52, v53
v_cvt_pk_bf16_f32 v139, v54, v55
ds_write_b64 v20, v[138:139] offset:2336
v_cvt_pk_bf16_f32 v140, v56, v57
v_cvt_pk_bf16_f32 v141, v58, v59
ds_write_b64 v20, v[140:141] offset:2368
v_cvt_pk_bf16_f32 v142, v60, v61
v_cvt_pk_bf16_f32 v143, v62, v63
ds_write_b64 v20, v[142:143] offset:2400
ds_read_b128 v[152:155], v21 offset:2304
ds_read_b128 v[156:159], v21 offset:3456
s_waitcnt lgkmcnt(7)
buffer_store_dwordx4 v[144:147], v16, s[36:39], 0 offen sc1
s_waitcnt lgkmcnt(6)
buffer_store_dwordx4 v[148:151], v16, s[36:39], s64 offen sc1
s_waitcnt lgkmcnt(1)
buffer_store_dwordx4 v[152:155], v17, s[36:39], 0 offen sc1
s_waitcnt lgkmcnt(0)
buffer_store_dwordx4 v[156:159], v17, s[36:39], s64 offen sc1
s_nop 1
.Lend:
s_endpgm
.Lsp67:
s_mov_b32 s15, 0
.Lsp67l:
v_mov_b32 v25, 0
buffer_atomic_add v25, v22, s[16:19], s73 offen sc0
s_add_u32 s15, s15, 1
s_cmp_gt_u32 s15, 100000
s_waitcnt vmcnt(0)
s_cbranch_scc1 .Lsp67b
v_cmp_gt_u32 vcc, v23, v25
s_nop 0
s_cbranch_vccnz .Lsp67l
s_branch .Lsp67b
.section .rodata,"a"
.p2align 6
.amdhsa_kernel interleave_layers__sliding_local_dilated__swiglu_ffn__prompt_kernel
  .amdhsa_next_free_vgpr 512
  .amdhsa_next_free_sgpr 102
  .amdhsa_accum_offset 256
  .amdhsa_group_segment_fixed_size 0
  .amdhsa_kernarg_size 80
  .amdhsa_user_sgpr_count 2
  .amdhsa_user_sgpr_kernarg_segment_ptr 1
  .amdhsa_system_sgpr_workgroup_id_x 1
  .amdhsa_float_denorm_mode_32 3
.end_amdhsa_kernel
```

```asm
; @launch grid=(256,1,1) block=(256,1,1) lds=162560
.amdgcn_target "amdgcn-amd-amdhsa--gfx950"
.macro MAA d,a,b
v_mfma_f32_16x16x32_bf16 v[\d:\d+3], a[\a:\a+3], a[\b:\b+3], v[\d:\d+3]
.endm
.macro MAV d,a,b
v_mfma_f32_16x16x32_bf16 v[\d:\d+3], a[\a:\a+3], v[\b:\b+3], v[\d:\d+3]
.endm
.macro TR d,v,o
ds_read_b64_tr_b16 a[\d:\d+1], v\v offset:\o
.endm
.macro RD d,v,o
ds_read_b128 a[\d:\d+3], v\v offset:\o
.endm
.text
.globl interleave_layers__sliding_local_dilated__swiglu_ffn__prompt_kernel
.p2align 8
.type interleave_layers__sliding_local_dilated__swiglu_ffn__prompt_kernel,@function
interleave_layers__sliding_local_dilated__swiglu_ffn__prompt_kernel:
s_load_dwordx4 s[68:71], s[0:1], 0
s_load_dwordx2 s[72:73], s[0:1], 16
s_load_dwordx8 s[76:83], s[0:1], 32
s_load_dwordx4 s[84:87], s[0:1], 64
s_cmp_ge_u32 s2, 256
s_cbranch_scc1 .Lout
v_lshrrev_b32 v2, 6, v0
v_and_b32 v1, 63, v0
v_readfirstlane_b32 s3, v2
s_and_b32 s4, s2, 7
s_lshr_b32 s5, s2, 3
s_getpc_b64 s[62:63]
.Lpc:
s_lshl_b32 s64, s5, 12
v_lshrrev_b32 v59, 3, v0
v_lshl_add_u32 v59, v59, 7, s64
v_add_u32 v2, 0x20000, v59
v_min_u32 v2, .Lend-.Lpc, v2
v_min_u32 v59, .Lend-.Lpc, v59
global_load_dword v59, v59, s[62:63]
global_load_dword v58, v2, s[62:63]
s_lshr_b32 s8, s4, 2
s_lshl_b32 s8, s8, 3
s_and_b32 s62, s5, 7
s_add_u32 s8, s8, s62
s_and_b32 s9, s4, 3
s_lshl_b32 s9, s9, 2
s_lshr_b32 s62, s5, 3
s_add_u32 s9, s9, s62
s_and_b32 s48, s3, 1
s_lshr_b32 s49, s3, 1
s_lshl_b32 s50, s8, 3
s_sub_u32 s50, s50, 9
s_cmp_lt_u32 s8, 2
s_cselect_b32 s50, 7, s50
s_lshr_b32 s6, s4, 1
s_lshl_b32 s6, s6, 2
s_and_b32 s62, s5, 3
s_add_u32 s6, s6, s62
s_and_b32 s7, s4, 1
s_lshr_b32 s62, s5, 2
s_lshl_b32 s62, s62, 1
s_add_u32 s7, s7, s62
s_lshr_b32 s62, s6, 1
s_lshl_b32 s62, s62, 8
s_and_b32 s63, s6, 1
s_add_u32 s62, s62, s63
s_lshl_b32 s63, s3, 6
s_add_u32 s62, s62, s63
s_lshl_b32 s62, s62, 11
s_lshl_b32 s63, s7, 7
s_add_u32 s62, s62, s63
v_and_b32 v228, 15, v1
v_lshlrev_b32 v228, 12, v228
v_bfe_u32 v2, v1, 4, 1
v_lshl_add_u32 v228, v2, 5, v228
v_bfe_u32 v2, v1, 5, 1
v_lshl_add_u32 v228, v2, 4, v228
v_add_u32 v228, s62, v228
v_add_u32 v229, 0x10000, v228
s_sub_u32 s64, s3, 1
s_max_i32 s64, s64, 0
s_lshl_b32 s64, s64, 11
s_lshl_b32 s66, s9, 7
s_add_u32 s66, s66, s64
s_or_b32 s65, s9, 3
s_lshl_b32 s65, s65, 7
s_and_b32 s64, s9, 3
s_lshl_b32 s64, s64, 11
s_add_u32 s65, s65, s64
s_bitcmp1_b32 s9, 2
s_cselect_b32 s65, 8388608, s65
s_cmp_eq_u32 s3, 1
s_cselect_b32 s66, s65, s66
s_cselect_b32 s64, 8, 0
s_and_b32 s44, s9, 7
s_cmp_eq_u32 s44, 3
s_cselect_b32 s66, 8388608, s66
s_xor_b32 s64, s64, s8
v_mov_b32 v9, s8
v_mov_b32 v2, s64
v_cmp_gt_u32 vcc, 32, v1
s_nop 1
v_cndmask_b32 v9, v2, v9, vcc
v_and_b32 v2, 31, v1
v_min_u32 v2, 19, v2
v_mad_u32_u24 v9, v9, 20, v2
v_mul_u32_u24 v9, 6144, v9
s_mov_b32 s65, s66
s_xor_b32 s14, s3, 3
s_lshl_b32 s14, s14, 8
s_add_u32 s14, s14, s2
v_lshlrev_b32 v230, 4, v1
v_mov_b64 v[224:225], 0
v_mov_b64 v[226:227], 0
s_waitcnt lgkmcnt(0)
s_mov_b32 s16, s86
s_mov_b32 s17, s87
s_mov_b32 s18, 268435456
s_mov_b32 s19, 0x20000
s_mov_b32 s36, s68
s_mov_b32 s37, s69
s_mov_b32 s38, 4194304
s_mov_b32 s39, 0x20000
s_cmp_ge_u32 s14, 16
s_cbranch_scc1 .Lz3
s_lshl_b32 s62, s2, 13
s_add_u32 s62, s62, 30408704
s_add_u32 s63, s62, 4096
buffer_store_dwordx4 v[224:227], v230, s[16:19], s62 offen sc1
buffer_store_dwordx4 v[224:227], v230, s[16:19], s62 offen offset:1024 sc1
buffer_store_dwordx4 v[224:227], v230, s[16:19], s62 offen offset:2048 sc1
buffer_store_dwordx4 v[224:227], v230, s[16:19], s62 offen offset:3072 sc1
buffer_store_dwordx4 v[224:227], v230, s[16:19], s63 offen sc1
buffer_store_dwordx4 v[224:227], v230, s[16:19], s63 offen offset:1024 sc1
buffer_store_dwordx4 v[224:227], v230, s[16:19], s63 offen offset:2048 sc1
buffer_store_dwordx4 v[224:227], v230, s[16:19], s63 offen offset:3072 sc1
.Lz3:
buffer_load_dwordx4 v[164:167], v228, s[36:39], 0 offen
buffer_load_dwordx4 v[168:171], v228, s[36:39], 0 offen offset:64
buffer_load_dwordx4 v[172:175], v229, s[36:39], 0 offen
buffer_load_dwordx4 v[176:179], v229, s[36:39], 0 offen offset:64
s_mov_b32 s20, s70
s_mov_b32 s21, s71
s_mov_b32 s22, 6291456
s_mov_b32 s23, 0x20000
buffer_load_dword v58, v9, s[20:23], s65 offen
s_mov_b32 s40, s84
s_mov_b32 s41, s85
s_mov_b32 s42, 256
s_mov_b32 s43, 0x20000
s_mov_b32 s24, s72
s_mov_b32 s25, s73
s_mov_b32 s26, 2097152
s_mov_b32 s27, 0x20000
s_mov_b32 s28, s80
s_mov_b32 s29, s81
s_mov_b32 s30, 7340032
s_mov_b32 s31, 0x20000
s_mov_b32 s0, s82
s_mov_b32 s1, s83
s_mov_b32 s32, s76
s_mov_b32 s33, s77
s_mov_b32 s34, 7340032
s_mov_b32 s35, 0x20000
s_mov_b32 s80, s78
s_mov_b32 s81, s79
s_mov_b32 s82, 7340032
s_mov_b32 s83, 0x20000
s_lshr_b32 s10, s4, 2
s_lshl_b32 s10, s10, 2
s_and_b32 s62, s5, 3
s_add_u32 s10, s10, s62
s_and_b32 s11, s4, 3
s_lshl_b32 s11, s11, 3
s_lshr_b32 s62, s5, 2
s_add_u32 s11, s11, s62
s_and_b32 s12, s11, 1
s_lshr_b32 s13, s11, 1
s_mul_i32 s51, s13, 448
s_mul_i32 s62, s12, 192
s_add_u32 s51, s51, s62
s_lshl_b32 s62, s6, 3
s_lshr_b32 s84, s62, 4
s_lshl_b32 s84, s84, 14
s_and_b32 s62, s62, 15
s_lshl_b32 s62, s62, 10
s_add_u32 s84, s84, s62
s_lshl_b32 s62, s8, 3
s_lshr_b32 s85, s62, 4
s_lshl_b32 s85, s85, 14
s_and_b32 s62, s62, 15
s_lshl_b32 s62, s62, 10
s_add_u32 s85, s85, s62
s_lshl_b32 s62, s50, 0
s_lshr_b32 s86, s62, 4
s_lshl_b32 s86, s86, 14
s_and_b32 s62, s62, 15
s_lshl_b32 s62, s62, 10
s_add_u32 s86, s86, s62
s_mul_i32 s62, s8, 393216
s_add_u32 s62, s62, s66
v_mul_u32_u24 v14, 6144, v1
v_add_u32 v14, s62, v14
s_add_u32 s62, s9, 4
s_lshr_b32 s62, s62, 3
s_sub_u32 s62, s9, s62
s_mul_i32 s45, s8, 14
s_add_u32 s45, s45, s62
s_lshl_b32 s62, s45, 2
s_add_u32 s62, s62, s3
s_mul_i32 s62, s62, 7552
v_min_u32 v15, 58, v1
v_lshl_add_u32 v15, v15, 7, s62
s_sub_u32 s63, s8, 4
s_lshl_b32 s64, s8, 1
s_add_u32 s64, s64, 1
s_cmp_lt_u32 s8, 5
s_cselect_b64 vcc, -1, 0
s_cselect_b32 s46, s64, s63
v_cndmask_b32 v14, v14, v15, vcc
s_lshl_b32 s62, s45, 1
s_add_u32 s62, s62, s48
s_mul_i32 s62, s62, 6144
v_min_u32 v16, 47, v1
v_lshl_add_u32 v16, v16, 7, s62
s_cmp_lt_u32 s46, 6
s_cselect_b64 vcc, -1, 0
v_cndmask_b32 v15, v14, v16, vcc
v_cndmask_b32 v14, v16, v14, vcc
s_cmp_lt_u32 s3, 2
s_cselect_b32 s65, s32, s80
s_cselect_b32 s66, s33, s81
s_cselect_b32 s67, s34, s82
s_cmp_lt_u32 s8, 5
s_cselect_b32 s62, s24, s20
s_cselect_b32 s63, s25, s21
s_cselect_b32 s64, s26, s22
s_sub_u32 s47, s46, 6
s_cmp_lt_u32 s46, 6
s_cselect_b32 s47, s46, s47
s_cselect_b32 s76, s62, s65
s_cselect_b32 s98, s65, s62
s_cselect_b32 s77, s63, s66
s_cselect_b32 s99, s66, s63
s_cselect_b32 s78, s64, s67
s_cselect_b32 s100, s67, s64
s_mov_b32 s79, 0x20000
s_cmp_eq_u32 s44, 3
s_cselect_b32 s47, 64, s47
v_bfe_u32 v18, v1, 3, 1
v_bfe_u32 v2, v1, 5, 1
v_lshl_add_u32 v18, v2, 2, v18
v_and_b32 v2, 16, v1
v_add_u32 v18, v18, v2
s_lshl_b32 s62, s49, 2
s_add_u32 s62, s62, s48
s_lshl_b32 s62, s62, 1
v_add_u32 v18, s62, v18
v_mul_u32_u24 v18, 6144, v18
v_and_b32 v2, 7, v1
v_lshl_add_u32 v18, v2, 4, v18
s_lshl_b32 s62, s9, 7
v_add_u32 v18, s62, v18
v_add_u32 v19, 1024, v18
v_add_u32 v20, 2048, v18
s_mul_i32 s59, s3, 3104
s_mov_b32 s58, 0
s_lshr_b32 s62, s8, 1
s_lshl_b32 s62, s62, 8
s_and_b32 s67, s8, 1
s_add_u32 s62, s62, s67
s_lshl_b32 s62, s62, 11
s_lshl_b32 s63, s3, 17
s_add_u32 s62, s62, s63
v_lshrrev_b32 v2, 4, v1
v_xor_b32 v2, v2, v1
v_and_b32 v2, 7, v2
v_lshlrev_b32 v2, 4, v2
v_lshrrev_b32 v21, 3, v1
v_lshl_add_u32 v21, v21, 12, v2
v_add_u32 v21, s62, v21
v_xor_b32 v28, 64, v21
v_add_u32 v28, 31744, v28
s_lshr_b32 s63, s50, 3
s_lshr_b32 s62, s63, 1
s_lshl_b32 s62, s62, 8
s_and_b32 s67, s63, 1
s_add_u32 s62, s62, s67
s_lshl_b32 s62, s62, 11
s_lshl_b32 s63, s3, 14
s_add_u32 s62, s62, s63
s_add_u32 s62, s62, 456704
s_lshl_b32 s63, s3, 5
v_and_b32 v2, 31, v1
v_lshlrev_b32 v2, 2, v2
v_xor_b32 v2, s63, v2
v_lshrrev_b32 v22, 5, v1
v_lshl_add_u32 v22, v22, 12, v2
v_add_u32 v22, s62, v22
v_xor_b32 v29, 16, v22
v_add_u32 v29, -57344, v29
s_mov_b32 s52, 0
s_mov_b32 s53, 65536
s_mul_i32 s55, s3, 4608
s_mov_b32 s54, 0
s_mul_i32 s56, s3, 3104
v_bfe_u32 v24, v1, 1, 3
v_lshrrev_b32 v2, 4, v1
v_xor_b32 v2, v2, v24
v_lshlrev_b32 v2, 4, v2
v_and_b32 v23, 15, v1
v_lshl_add_u32 v23, v23, 7, v2
s_mul_i32 s62, s48, 9216
v_add_u32 v23, s62, v23
v_xor_b32 v30, 64, v23
v_mul_u32_u24 v24, 2304, v24
v_add_u32 v24, v24, v2
v_and_b32 v2, 1, v1
v_lshl_add_u32 v24, v2, 7, v24
v_add_u32 v24, 2048, v24
v_xor_b32 v31, 64, v24
v_and_b32 v2, 15, v1
v_cmp_eq_u32 vcc, 0, v2
v_mov_b32 v2, 18432
s_nop 0
v_cndmask_b32 v24, v24, v2, vcc
v_cndmask_b32 v31, v31, v2, vcc
v_bfe_u32 v25, v1, 3, 2
v_mul_u32_u24 v25, 3104, v25
v_bfe_u32 v2, v1, 2, 1
v_lshl_add_u32 v25, v2, 7, v25
v_bfe_u32 v2, v1, 5, 1
v_lshl_add_u32 v25, v2, 8, v25
v_and_b32 v2, 3, v1
v_lshl_add_u32 v25, v2, 3, v25
s_lshl_b32 s62, s49, 6
s_add_u32 s62, s62, 73984
v_add_u32 v25, s62, v25
s_lshl_b32 s62, s8, 1
s_add_u32 s62, s62, s3
s_lshr_b32 s63, s50, 2
s_cmp_lt_u32 s3, 2
s_cselect_b32 s62, s62, s63
s_lshl_b32 s62, s62, 13
s_cmp_eq_u32 s3, 3
s_cselect_b32 s62, 268435456, s62
v_lshl_add_u32 v26, v1, 4, s62
s_mul_i32 s59, s3, 2080
s_and_b32 s87, s6, 3
s_lshl_b32 s87, s87, 17
v_bfe_u32 v5, v1, 3, 1
v_lshrrev_b32 v2, 4, v1
v_lshl_add_u32 v5, v2, 3, v5
s_lshl_b32 s62, s3, 1
v_add_u32 v5, s62, v5
v_mul_u32_u24 v5, 2048, v5
v_and_b32 v2, 7, v1
v_lshl_add_u32 v5, v2, 4, v5
s_lshl_b32 s62, s7, 7
v_add_u32 v5, s62, v5
v_add_u32 v6, 64512, v5
s_lshl_b32 s62, s6, 10
s_add_u32 s62, s62, 30408704
s_lshl_b32 s64, s8, 10
s_add_u32 s64, s64, 30408704
s_lshr_b32 s67, s9, 1
s_and_b32 s67, s67, 3
s_lshl_b32 s67, s67, 7
s_add_u32 s64, s64, s67
s_lshr_b32 s65, s50, 3
s_lshl_b32 s65, s65, 10
s_add_u32 s65, s65, 30408704
s_lshr_b32 s67, s9, 1
s_and_b32 s67, s67, 3
s_lshl_b32 s67, s67, 7
s_add_u32 s65, s65, s67
v_mov_b32 v2, 268435456
v_cmp_eq_u32 vcc, 65, v0
v_mov_b32 v33, s65
s_nop 0
v_cndmask_b32 v33, v2, v33, vcc
v_cndmask_b32 v36, 0, 16, vcc
v_cmp_eq_u32 vcc, 64, v0
v_mov_b32 v32, s64
s_nop 0
v_cndmask_b32 v33, v33, v32, vcc
v_lshl_add_u32 v32, v1, 7, s62
v_cndmask_b32 v34, v2, 0, vcc
v_cndmask_b32 v35, 0, 16, vcc
v_cndmask_b32 v36, v36, 16, vcc
v_lshrrev_b32 v37, 3, v0
v_cmp_eq_u32 vcc, 8, v37
s_nop 1
v_cndmask_b32 v32, v2, v32, vcc
v_mov_b32 v38, 1
v_lshrrev_b32 v2, 4, v1
v_lshlrev_b32 v2, 2, v2
v_and_b32 v13, 15, v1
v_sub_u32 v2, v13, v2
v_mov_b32 v13, 0xff61b1e6
v_subrev_u32 v54, 0, v2
v_cmp_gt_u32 vcc, 8, v54
s_nop 1
v_cndmask_b32 v50, v13, 0, vcc
v_cmp_gt_i32 vcc, -8, v54
s_nop 1
v_cndmask_b32 v46, v13, 0, vcc
v_subrev_u32 v54, 1, v2
v_cmp_gt_u32 vcc, 8, v54
s_nop 1
v_cndmask_b32 v51, v13, 0, vcc
v_cmp_gt_i32 vcc, -8, v54
s_nop 1
v_cndmask_b32 v47, v13, 0, vcc
v_subrev_u32 v54, 2, v2
v_cmp_gt_u32 vcc, 8, v54
s_nop 1
v_cndmask_b32 v52, v13, 0, vcc
v_cmp_gt_i32 vcc, -8, v54
s_nop 1
v_cndmask_b32 v48, v13, 0, vcc
v_subrev_u32 v54, 3, v2
v_cmp_gt_u32 vcc, 8, v54
s_nop 1
v_cndmask_b32 v53, v13, 0, vcc
v_cmp_gt_i32 vcc, -8, v54
s_nop 1
v_cndmask_b32 v49, v13, 0, vcc
s_cmp_lt_u32 s8, 2
s_cselect_b64 vcc, -1, 0
v_cndmask_b32 v54, v46, v13, vcc
v_cndmask_b32 v55, v47, v13, vcc
v_cndmask_b32 v56, v48, v13, vcc
v_cndmask_b32 v57, v49, v13, vcc
s_mov_b32 s75, 29360128
v_and_b32 v10, 15, v1
v_lshlrev_b32 v12, 2, v10
v_lshlrev_b32 v10, 4, v10
v_add_u32 v10, 152576, v10
v_lshrrev_b32 v11, 4, v1
v_lshlrev_b32 v11, 4, v11
s_lshl_b32 s62, s49, 7
s_add_u32 s62, s62, 158720
v_add_u32 v12, s62, v12
v_add_u32 v13, s62, v11
v_add_u32 v11, 156672, v11
s_lshl_b32 s62, s3, 11
s_add_u32 s62, s62, 143360
v_lshl_add_u32 v8, v1, 4, s62
v_xor_b32 v9, 2048, v8
v_mov_b32 v248, 0x3f803f80
v_mov_b32 v249, 0x3f803f80
v_mov_b32 v250, 0x3f803f80
v_mov_b32 v251, 0x3f803f80
s_mul_i32 s62, s3, 18496
s_add_u32 s62, s62, 18432
v_mov_b32 v2, s62
ds_write_b128 v2, v[248:251]
v_and_b32 v7, 31, v1
v_lshrrev_b32 v2, 5, v1
v_lshl_add_u32 v7, v7, 1, v2
v_and_b32 v2, 0xc0, v0
v_add_u32 v7, v7, v2
v_lshlrev_b32 v17, 2, v7
v_add_u32 v17, 156672, v17
v_lshlrev_b32 v7, 4, v7
v_add_u32 v7, 152576, v7
s_lshl_b32 s74, s9, 1
s_add_u32 s74, s74, s49
s_lshl_b32 s74, s74, 17
s_add_u32 s74, s74, s85
s_lshl_b32 s63, s48, 12
s_add_u32 s74, s74, s63
s_add_u32 s74, s74, 4194304
s_mov_b32 s62, 0
v_lshl_add_u32 v4, v1, 4, s62
v_lshrrev_b32 v2, 3, v1
v_cmp_eq_u32 vcc, 3, v2
v_add_u32 v2, 67108480, v4
s_nop 0
v_cndmask_b32 v4, v4, v2, vcc
s_add_u32 m0, s55, 0
s_nop 0
buffer_load_dwordx4 v21, s[36:39], s52 offen lds
buffer_load_dwordx4 v28, s[36:39], s52 offen offset:1024 lds
buffer_load_dword v22, s[36:39], s52 offen offset:2048 lds
s_add_u32 s52, s52, 128
s_add_u32 m0, s55, 2304
s_nop 0
buffer_load_dwordx4 v21, s[36:39], s53 offen lds
buffer_load_dwordx4 v28, s[36:39], s53 offen offset:1024 lds
buffer_load_dword v29, s[36:39], s53 offen offset:2048 lds
s_add_u32 s53, s53, 128
s_add_u32 m0, s56, 123648
s_nop 0
buffer_load_dwordx4 v18, s[20:23], s54 offen lds
buffer_load_dwordx4 v19, s[20:23], s54 offen offset:1024 lds
buffer_load_dwordx4 v20, s[20:23], s54 offen offset:2048 lds
s_add_u32 s54, s54, 196608
s_add_u32 m0, s56, 136064
s_nop 0
buffer_load_dwordx4 v18, s[20:23], s54 offen lds
buffer_load_dwordx4 v19, s[20:23], s54 offen offset:1024 lds
buffer_load_dwordx4 v20, s[20:23], s54 offen offset:2048 lds
s_add_u32 s54, s54, 196608
s_mov_b64 exec, 0
s_cmp_eq_u32 s3, 2
s_cbranch_scc1 .Lpad1
s_cmp_eq_u32 s3, 3
s_cbranch_scc1 .Lpad2
s_cmp_eq_u32 s3, 1
s_cbranch_scc1 .Lpad4
s_branch .Lpad3
.Lout:
s_endpgm
.p2align 12
.Lt0r:
s_mov_b64 exec, -1
s_cmp_eq_u32 s48, 1
s_cbranch_scc1 .Lqkv1
s_cmp_lt_u32 s14, 16
s_cselect_b32 s62, 0, 4096
v_mov_b32 v231, 1
v_lshlrev_b32 v232, 8, v1
s_waitcnt vmcnt(16)
v_permlane16_swap_b32 v164, v166
v_permlane16_swap_b32 v165, v167
s_waitcnt vmcnt(15)
v_permlane16_swap_b32 v168, v170
v_permlane16_swap_b32 v169, v171
s_waitcnt vmcnt(14)
v_permlane16_swap_b32 v172, v174
v_permlane16_swap_b32 v173, v175
s_waitcnt vmcnt(13)
v_permlane16_swap_b32 v176, v178
v_permlane16_swap_b32 v177, v179
buffer_atomic_add v231, v232, s[40:43], s62 offen
s_add_u32 m0, s55, 18496
s_nop 0
buffer_load_dwordx4 v21, s[36:39], s52 offen lds
v_lshlrev_b32 v192, 16, v164
v_and_b32 v193, 0xffff0000, v164
v_lshlrev_b32 v194, 16, v165
v_and_b32 v195, 0xffff0000, v165
v_lshlrev_b32 v196, 16, v166
v_and_b32 v197, 0xffff0000, v166
v_lshlrev_b32 v198, 16, v167
buffer_load_dwordx4 v28, s[36:39], s52 offen offset:1024 lds
v_and_b32 v199, 0xffff0000, v167
v_lshlrev_b32 v200, 16, v168
v_and_b32 v201, 0xffff0000, v168
v_lshlrev_b32 v202, 16, v169
v_and_b32 v203, 0xffff0000, v169
v_lshlrev_b32 v204, 16, v170
v_and_b32 v205, 0xffff0000, v170
buffer_load_dword v22, s[36:39], s52 offen offset:2048 lds
s_add_u32 s52, s52, 128
v_lshlrev_b32 v206, 16, v171
v_and_b32 v207, 0xffff0000, v171
v_lshlrev_b32 v208, 16, v172
v_and_b32 v209, 0xffff0000, v172
v_lshlrev_b32 v210, 16, v173
v_and_b32 v211, 0xffff0000, v173
v_lshlrev_b32 v212, 16, v174
s_add_u32 m0, s55, 20800
s_nop 0
buffer_load_dwordx4 v21, s[36:39], s53 offen lds
v_and_b32 v213, 0xffff0000, v174
v_lshlrev_b32 v214, 16, v175
v_and_b32 v215, 0xffff0000, v175
v_lshlrev_b32 v216, 16, v176
v_and_b32 v217, 0xffff0000, v176
v_lshlrev_b32 v218, 16, v177
v_and_b32 v219, 0xffff0000, v177
buffer_load_dwordx4 v28, s[36:39], s53 offen offset:1024 lds
v_lshlrev_b32 v220, 16, v178
v_and_b32 v221, 0xffff0000, v178
v_lshlrev_b32 v222, 16, v179
v_and_b32 v223, 0xffff0000, v179
s_lshl_b32 s64, s6, 14
s_lshl_b32 s65, s49, 13
s_add_u32 s64, s64, s65
buffer_load_dword v29, s[36:39], s53 offen offset:2048 lds
s_add_u32 s53, s53, 128
s_lshl_b32 s65, s7, 9
s_add_u32 s64, s64, s65
s_lshl_b32 s65, s48, 8
s_add_u32 s64, s64, s65
s_add_u32 s64, s64, 29360128
v_and_b32 v188, 31, v1
v_lshlrev_b32 v188, 3, v188
s_add_u32 m0, s56, 73984
s_nop 0
buffer_load_dwordx4 v18, s[20:23], s54 offen lds
v_lshrrev_b32 v189, 5, v1
v_lshl_add_u32 v188, v189, 28, v188
s_lshl_b32 s62, s7, 18
s_add_u32 s62, s62, 0
s_add_u32 s63, s62, 131072
v_pk_mul_f32 v[182:183], v[192:193], v[192:193]
v_pk_mul_f32 v[186:187], v[208:209], v[208:209]
buffer_load_dwordx4 v19, s[20:23], s54 offen offset:1024 lds
v_pk_fma_f32 v[182:183], v[194:195], v[194:195], v[182:183]
v_pk_add_f32 v[180:181], v[192:193], v[194:195]
v_pk_fma_f32 v[186:187], v[210:211], v[210:211], v[186:187]
v_pk_add_f32 v[184:185], v[208:209], v[210:211]
v_pk_fma_f32 v[182:183], v[196:197], v[196:197], v[182:183]
v_pk_add_f32 v[180:181], v[180:181], v[196:197]
v_pk_fma_f32 v[186:187], v[212:213], v[212:213], v[186:187]
buffer_load_dwordx4 v20, s[20:23], s54 offen offset:2048 lds
s_add_u32 s54, s54, 196608
v_pk_add_f32 v[184:185], v[184:185], v[212:213]
v_pk_fma_f32 v[182:183], v[198:199], v[198:199], v[182:183]
v_pk_add_f32 v[180:181], v[180:181], v[198:199]
v_pk_fma_f32 v[186:187], v[214:215], v[214:215], v[186:187]
v_pk_add_f32 v[184:185], v[184:185], v[214:215]
v_pk_fma_f32 v[182:183], v[200:201], v[200:201], v[182:183]
v_pk_add_f32 v[180:181], v[180:181], v[200:201]
s_add_u32 m0, s56, 86400
s_nop 0
buffer_load_dwordx4 v18, s[20:23], s54 offen lds
v_pk_fma_f32 v[186:187], v[216:217], v[216:217], v[186:187]
v_pk_add_f32 v[184:185], v[184:185], v[216:217]
v_pk_fma_f32 v[182:183], v[202:203], v[202:203], v[182:183]
v_pk_add_f32 v[180:181], v[180:181], v[202:203]
v_pk_fma_f32 v[186:187], v[218:219], v[218:219], v[186:187]
v_pk_add_f32 v[184:185], v[184:185], v[218:219]
v_pk_fma_f32 v[182:183], v[204:205], v[204:205], v[182:183]
buffer_load_dwordx4 v19, s[20:23], s54 offen offset:1024 lds
v_pk_add_f32 v[180:181], v[180:181], v[204:205]
v_pk_fma_f32 v[186:187], v[220:221], v[220:221], v[186:187]
v_pk_add_f32 v[184:185], v[184:185], v[220:221]
v_pk_fma_f32 v[182:183], v[206:207], v[206:207], v[182:183]
v_pk_add_f32 v[180:181], v[180:181], v[206:207]
v_pk_fma_f32 v[186:187], v[222:223], v[222:223], v[186:187]
v_pk_add_f32 v[184:185], v[184:185], v[222:223]
buffer_load_dwordx4 v20, s[20:23], s54 offen offset:2048 lds
s_add_u32 s54, s54, 196608
v_add_f32 v180, v180, v181
v_add_f32 v182, v182, v183
v_add_f32 v184, v184, v185
v_add_f32 v186, v186, v187
s_nop 0
v_permlane16_swap_b32 v180, v184
v_permlane16_swap_b32 v182, v186
v_add_f32 v180, v180, v184
v_add_f32 v182, v182, v186
s_nop 1
v_permlane32_swap_b32 v180, v182
v_add_f32 v180, v180, v182
s_nop 1
v_permlane32_swap_b32 v180, v181
buffer_store_dwordx2 v[180:181], v188, s[16:19], s64 offen sc1
s_lshl_b32 s62, s2, 10
s_add_u32 s62, s62, 31457280
s_cmp_eq_u32 s3, 0
s_cselect_b32 s62, s62, 268435456
buffer_store_dwordx4 v[224:227], v230, s[16:19], s62 offen sc1
s_waitcnt vmcnt(15) lgkmcnt(0)
s_barrier
ds_read_b128 a[0:3], v23
RD 4,23,2304
RD 8,23,4608
RD 12,23,6912
ds_read_b128 a[16:19], v24
ds_read_b128 a[20:23], v30
RD 24,30,2304
RD 28,30,4608
RD 32,30,6912
ds_read_b128 a[36:39], v31
TR 80,25,49664
TR 82,25,50176
TR 84,25,62080
TR 86,25,62592
TR 88,25,50688
TR 90,25,51200
TR 92,25,63104
TR 94,25,63616
TR 96,25,51712
TR 98,25,52224
TR 100,25,64128
TR 102,25,64640
s_waitcnt vmcnt(8) lgkmcnt(0)
s_barrier
v_mfma_f32_16x16x32_bf16 v[60:63], a[80:83], a[0:3], 0
TR 104,25,49696
s_add_u32 m0, s55, 36992
MAA 60,84,20
buffer_load_dwordx4 v21, s[36:39], s52 offen lds
v_mfma_f32_16x16x32_bf16 v[64:67], a[80:83], a[4:7], 0
s_sub_u32 s47, s47, 1
s_cbranch_scc1 .Lx4
.Lx4b:
MAA 64,84,24
buffer_load_dwordx4 v28, s[36:39], s52 offen offset:1024 lds
v_mfma_f32_16x16x32_bf16 v[68:71], a[80:83], a[8:11], 0
TR 106,25,50208
MAA 68,84,28
TR 108,25,62112
TR 110,25,62624
v_mfma_f32_16x16x32_bf16 v[72:75], a[80:83], a[12:15], 0
TR 112,25,50720
MAA 72,84,32
TR 114,25,51232
v_mfma_f32_16x16x32_bf16 v[244:247], a[80:83], a[16:19], 0
TR 116,25,63136
MAA 244,84,36
buffer_load_dword v22, s[36:39], s52 offen offset:2048 lds
v_mfma_f32_16x16x32_bf16 v[156:159], a[88:91], a[16:19], 0
s_add_u32 s52, s52, 128
s_add_u32 m0, s55, 39296
MAA 156,92,36
buffer_load_dwordx4 v21, s[36:39], s53 offen lds
v_mfma_f32_16x16x32_bf16 v[104:107], a[88:91], a[12:15], 0
TR 118,25,63648
MAA 104,92,32
buffer_load_dwordx4 v28, s[36:39], s53 offen offset:1024 lds
v_mfma_f32_16x16x32_bf16 v[100:103], a[88:91], a[8:11], 0
TR 120,25,51744
MAA 100,92,28
buffer_load_dword v29, s[36:39], s53 offen offset:2048 lds
v_mfma_f32_16x16x32_bf16 v[96:99], a[88:91], a[4:7], 0
s_add_u32 s53, s53, 128
MAA 96,92,24
TR 122,25,52256
TR 124,25,64160
v_mfma_f32_16x16x32_bf16 v[92:95], a[88:91], a[0:3], 0
TR 126,25,64672
s_add_u32 m0, s56, 98816
MAA 92,92,20
buffer_load_dwordx4 v18, s[20:23], s54 offen lds
v_mfma_f32_16x16x32_bf16 v[124:127], a[0:3], a[96:99], 0
RD 40,23,18496
MAA 124,20,100
buffer_load_dwordx4 v19, s[20:23], s54 offen offset:1024 lds
v_mfma_f32_16x16x32_bf16 v[128:131], a[4:7], a[96:99], 0
RD 44,23,20800
MAA 128,24,100
RD 48,23,23104
RD 52,23,25408
v_mfma_f32_16x16x32_bf16 v[132:135], a[8:11], a[96:99], 0
RD 56,24,18496
MAA 132,28,100
buffer_load_dwordx4 v20, s[20:23], s54 offen offset:2048 lds
v_mfma_f32_16x16x32_bf16 v[136:139], a[12:15], a[96:99], 0
s_add_u32 s54, s54, 196608
MAA 136,32,100
s_waitcnt vmcnt(11) lgkmcnt(5)
s_barrier
v_mfma_f32_16x16x32_bf16 v[76:79], a[104:107], a[0:3], 0
RD 60,30,18496
s_add_u32 m0, s56, 111232
MAA 76,108,20
buffer_load_dwordx4 v18, s[20:23], s54 offen lds
v_mfma_f32_16x16x32_bf16 v[80:83], a[104:107], a[4:7], 0
RD 64,30,20800
MAA 80,108,24
buffer_load_dwordx4 v19, s[20:23], s54 offen offset:1024 lds
v_mfma_f32_16x16x32_bf16 v[84:87], a[104:107], a[8:11], 0
RD 68,30,23104
MAA 84,108,28
RD 72,30,25408
RD 76,31,18496
v_mfma_f32_16x16x32_bf16 v[88:91], a[104:107], a[12:15], 0
ds_read_b64_tr_b16 a[80:81], v25
MAA 88,108,32
buffer_load_dwordx4 v20, s[20:23], s54 offen offset:2048 lds
v_mfma_f32_16x16x32_bf16 v[160:163], a[112:115], a[16:19], 0
s_add_u32 s54, s54, 196608
s_add_u32 m0, s55, 55488
MAA 160,116,36
buffer_load_dwordx4 v21, s[36:39], s52 offen lds
v_mfma_f32_16x16x32_bf16 v[120:123], a[112:115], a[12:15], 0
TR 82,25,512
MAA 120,116,32
buffer_load_dwordx4 v28, s[36:39], s52 offen offset:1024 lds
v_mfma_f32_16x16x32_bf16 v[116:119], a[112:115], a[8:11], 0
TR 84,25,12416
MAA 116,116,28
TR 86,25,12928
TR 88,25,1024
v_mfma_f32_16x16x32_bf16 v[112:115], a[112:115], a[4:7], 0
TR 90,25,1536
MAA 112,116,24
buffer_load_dword v22, s[36:39], s52 offen offset:2048 lds
v_mfma_f32_16x16x32_bf16 v[108:111], a[112:115], a[0:3], 0
s_add_u32 s52, s52, 128
s_add_u32 m0, s55, 57792
MAA 108,116,20
buffer_load_dwordx4 v21, s[36:39], s53 offen lds
v_mfma_f32_16x16x32_bf16 v[140:143], a[0:3], a[120:123], 0
TR 92,25,13440
MAA 140,20,124
buffer_load_dwordx4 v28, s[36:39], s53 offen offset:1024 lds
v_mfma_f32_16x16x32_bf16 v[144:147], a[4:7], a[120:123], 0
TR 94,25,13952
MAA 144,24,124
TR 96,25,2048
TR 98,25,2560
v_mfma_f32_16x16x32_bf16 v[148:151], a[8:11], a[120:123], 0
TR 100,25,14464
MAA 148,28,124
buffer_load_dword v29, s[36:39], s53 offen offset:2048 lds
v_mfma_f32_16x16x32_bf16 v[152:155], a[12:15], a[120:123], 0
TR 102,25,14976
s_add_u32 s53, s53, 128
MAA 152,32,124
s_waitcnt vmcnt(12) lgkmcnt(8)
s_barrier
MAA 60,80,40
TR 104,25,32
s_add_u32 m0, s56, 123648
MAA 60,84,60
buffer_load_dwordx4 v18, s[20:23], s54 offen lds
MAA 64,84,64
s_sub_u32 s47, s47, 1
s_cbranch_scc1 .Lx5
.Lx5b:
MAA 64,80,44
buffer_load_dwordx4 v19, s[20:23], s54 offen offset:1024 lds
MAA 68,80,48
TR 106,25,544
MAA 68,84,68
TR 108,25,12448
TR 110,25,12960
MAA 72,84,72
TR 112,25,1056
MAA 72,80,52
TR 114,25,1568
s_waitcnt lgkmcnt(6)
MAA 244,80,56
TR 116,25,13472
MAA 244,84,76
buffer_load_dwordx4 v20, s[20:23], s54 offen offset:2048 lds
MAA 156,92,76
s_add_u32 s54, s54, 196608
s_add_u32 m0, s56, 136064
MAA 156,88,56
buffer_load_dwordx4 v18, s[20:23], s54 offen lds
MAA 104,88,52
TR 118,25,13984
MAA 104,92,72
buffer_load_dwordx4 v19, s[20:23], s54 offen offset:1024 lds
MAA 100,92,68
TR 120,25,2080
MAA 100,88,48
buffer_load_dwordx4 v20, s[20:23], s54 offen offset:2048 lds
MAA 96,88,44
s_add_u32 s54, s54, 196608
MAA 96,92,64
TR 122,25,2592
TR 124,25,14496
MAA 92,92,60
TR 126,25,15008
s_add_u32 m0, s55, 0
MAA 92,88,40
buffer_load_dwordx4 v21, s[36:39], s52 offen lds
MAA 124,40,96
RD 0,23,36992
MAA 124,60,100
buffer_load_dwordx4 v28, s[36:39], s52 offen offset:1024 lds
MAA 128,64,100
RD 4,23,39296
MAA 128,44,96
RD 8,23,41600
RD 12,23,43904
MAA 132,48,96
RD 16,24,36992
MAA 132,68,100
buffer_load_dword v22, s[36:39], s52 offen offset:2048 lds
MAA 136,72,100
s_add_u32 s52, s52, 128
MAA 136,52,96
s_waitcnt vmcnt(15) lgkmcnt(5)
s_barrier
MAA 76,104,40
RD 20,30,36992
s_add_u32 m0, s55, 2304
MAA 76,108,60
buffer_load_dwordx4 v21, s[36:39], s53 offen lds
MAA 80,108,64
RD 24,30,39296
MAA 80,104,44
buffer_load_dwordx4 v28, s[36:39], s53 offen offset:1024 lds
MAA 84,104,48
RD 28,30,41600
MAA 84,108,68
buffer_load_dword v29, s[36:39], s53 offen offset:2048 lds
MAA 88,108,72
RD 32,30,43904
s_add_u32 s53, s53, 128
MAA 88,104,52
RD 36,31,36992
TR 80,25,24832
TR 82,25,25344
MAA 160,112,56
TR 84,25,37248
s_add_u32 m0, s56, 73984
MAA 160,116,76
buffer_load_dwordx4 v18, s[20:23], s54 offen lds
MAA 120,116,72
TR 86,25,37760
MAA 120,112,52
buffer_load_dwordx4 v19, s[20:23], s54 offen offset:1024 lds
MAA 116,112,48
TR 88,25,25856
MAA 116,116,68
buffer_load_dwordx4 v20, s[20:23], s54 offen offset:2048 lds
MAA 112,116,64
s_add_u32 s54, s54, 196608
s_add_u32 m0, s55, 18496
MAA 112,112,44
buffer_load_dwordx4 v21, s[36:39], s52 offen lds
MAA 108,112,40
TR 90,25,26368
MAA 108,116,60
buffer_load_dwordx4 v28, s[36:39], s52 offen offset:1024 lds
MAA 140,60,124
TR 92,25,38272
MAA 140,40,120
TR 94,25,38784
TR 96,25,26880
TR 98,25,27392
MAA 144,44,120
TR 100,25,39296
MAA 144,64,124
buffer_load_dword v22, s[36:39], s52 offen offset:2048 lds
MAA 148,68,124
TR 102,25,39808
s_add_u32 s52, s52, 128
MAA 148,48,120
buffer_load_dword v37, v34, s[40:43], 0 offen sc1
MAA 152,52,120
MAA 152,72,124
s_waitcnt vmcnt(19) lgkmcnt(8)
s_barrier
MAA 60,80,0
TR 104,25,24864
s_add_u32 m0, s56, 86400
MAA 60,84,20
buffer_load_dwordx4 v18, s[20:23], s54 offen lds
MAA 64,84,24
s_sub_u32 s47, s47, 1
s_cbranch_scc1 .Lx6
.Lx6b:
MAA 64,80,4
buffer_load_dwordx4 v19, s[20:23], s54 offen offset:1024 lds
MAA 68,80,8
TR 106,25,25376
MAA 68,84,28
TR 108,25,37280
TR 110,25,37792
MAA 72,84,32
TR 112,25,25888
MAA 72,80,12
TR 114,25,26400
s_waitcnt lgkmcnt(6)
MAA 244,80,16
TR 116,25,38304
MAA 244,84,36
buffer_load_dwordx4 v20, s[20:23], s54 offen offset:2048 lds
MAA 156,92,36
s_add_u32 s54, s54, 196608
s_add_u32 m0, s55, 20800
MAA 156,88,16
buffer_load_dwordx4 v21, s[36:39], s53 offen lds
MAA 104,88,12
TR 118,25,38816
MAA 104,92,32
buffer_load_dwordx4 v28, s[36:39], s53 offen offset:1024 lds
MAA 100,92,28
TR 120,25,26912
MAA 100,88,8
buffer_load_dword v29, s[36:39], s53 offen offset:2048 lds
MAA 96,88,4
s_add_u32 s53, s53, 128
MAA 96,92,24
TR 122,25,27424
TR 124,25,39328
MAA 92,92,20
TR 126,25,39840
s_add_u32 m0, s55, 36992
MAA 92,88,0
buffer_load_dwordx4 v21, s[36:39], s52 offen lds
MAA 124,0,96
RD 40,23,55488
MAA 124,20,100
buffer_load_dwordx4 v28, s[36:39], s52 offen offset:1024 lds
MAA 128,24,100
RD 44,23,57792
MAA 128,4,96
RD 48,23,60096
RD 52,23,62400
MAA 132,8,96
RD 56,24,55488
MAA 132,28,100
buffer_load_dword v22, s[36:39], s52 offen offset:2048 lds
MAA 136,32,100
s_add_u32 s52, s52, 128
MAA 136,12,96
s_waitcnt vmcnt(22) lgkmcnt(5)
s_barrier
MAA 76,104,0
RD 60,30,55488
s_add_u32 m0, s56, 98816
MAA 76,108,20
buffer_load_dwordx4 v18, s[20:23], s54 offen lds
MAA 80,108,24
RD 64,30,57792
MAA 80,104,4
RD 68,30,60096
MAA 84,104,8
RD 72,30,62400
MAA 84,108,28
buffer_load_dwordx4 v19, s[20:23], s54 offen offset:1024 lds
MAA 88,108,32
RD 76,31,55488
MAA 88,104,12
TR 80,25,49664
MAA 160,112,16
TR 82,25,50176
MAA 160,116,36
buffer_load_dwordx4 v20, s[20:23], s54 offen offset:2048 lds
MAA 120,116,32
TR 84,25,62080
s_add_u32 s54, s54, 196608
MAA 120,112,12
TR 86,25,62592
MAA 116,112,8
s_add_u32 m0, s55, 39296
MAA 116,116,28
buffer_load_dwordx4 v21, s[36:39], s53 offen lds
MAA 112,116,24
TR 88,25,50688
MAA 112,112,4
TR 90,25,51200
MAA 108,112,0
TR 92,25,63104
MAA 108,116,20
buffer_load_dwordx4 v28, s[36:39], s53 offen offset:1024 lds
MAA 140,20,124
TR 94,25,63616
MAA 140,0,120
TR 96,25,51712
MAA 144,4,120
TR 98,25,52224
MAA 144,24,124
buffer_load_dword v29, s[36:39], s53 offen offset:2048 lds
MAA 148,28,124
TR 100,25,64128
s_add_u32 s53, s53, 128
MAA 148,8,120
TR 102,25,64640
MAA 152,12,120
MAA 152,32,124
s_waitcnt vmcnt(22) lgkmcnt(8)
s_barrier
MAA 60,80,40
TR 104,25,49696
s_add_u32 m0, s56, 111232
MAA 60,84,60
buffer_load_dwordx4 v18, s[20:23], s54 offen lds
MAA 64,84,64
s_sub_u32 s47, s47, 1
s_cbranch_scc1 .Lx7
.Lx7b:
MAA 64,80,44
TR 106,25,50208
MAA 68,80,48
TR 108,25,62112
MAA 68,84,68
buffer_load_dwordx4 v19, s[20:23], s54 offen offset:1024 lds
MAA 72,84,72
TR 110,25,62624
MAA 72,80,52
TR 112,25,50720
s_waitcnt lgkmcnt(5)
MAA 244,80,56
TR 114,25,51232
MAA 244,84,76
.Lpad1:
s_cbranch_execz .Lpad5
buffer_load_dwordx4 v20, s[20:23], s54 offen offset:2048 lds
MAA 156,92,76
s_add_u32 s54, s54, 196608
MAA 156,88,56
TR 116,25,63136
MAA 104,88,52
TR 118,25,63648
MAA 104,92,72
TR 120,25,51744
MAA 100,92,68
TR 122,25,52256
s_add_u32 m0, s55, 55488
MAA 100,88,48
buffer_load_dwordx4 v21, s[36:39], s52 offen lds
MAA 96,88,44
TR 124,25,64160
MAA 96,92,64
TR 126,25,64672
MAA 92,92,60
MAA 92,88,40
buffer_load_dwordx4 v28, s[36:39], s52 offen offset:1024 lds
MAA 124,40,96
ds_read_b128 a[0:3], v23
MAA 124,60,100
RD 4,23,2304
MAA 128,64,100
RD 8,23,4608
MAA 128,44,96
buffer_load_dword v22, s[36:39], s52 offen offset:2048 lds
MAA 132,48,96
RD 12,23,6912
s_add_u32 s52, s52, 128
MAA 132,68,100
ds_read_b128 a[16:19], v24
MAA 136,72,100
MAA 136,52,96
s_waitcnt vmcnt(18) lgkmcnt(5)
s_barrier
v_cmp_gt_u32 vcc, v35, v37
s_nop 0
s_cbranch_vccnz .Lsp8
.Lsp8b:
v_mov_b32 v37, 0
MAA 76,104,40
ds_read_b128 a[20:23], v30
MAA 76,108,60
buffer_atomic_add v38, v32, s[16:19], 0 offen
MAA 80,108,64
RD 24,30,2304
MAA 80,104,44
RD 28,30,4608
MAA 84,104,48
RD 32,30,6912
s_add_u32 m0, s56, 123648
MAA 84,108,68
buffer_load_dwordx4 v18, s[20:23], s54 offen lds
MAA 88,108,72
ds_read_b128 a[36:39], v31
MAA 88,104,52
buffer_load_dwordx4 v19, s[20:23], s54 offen offset:1024 lds
MAA 160,112,56
ds_read_b64_tr_b16 a[80:81], v25
MAA 160,116,76
TR 82,25,512
MAA 120,116,72
TR 84,25,12416
MAA 120,112,52
buffer_load_dwordx4 v20, s[20:23], s54 offen offset:2048 lds
MAA 116,112,48
TR 86,25,12928
s_add_u32 s54, s54, 196608
MAA 116,116,68
TR 88,25,1024
MAA 112,116,64
TR 90,25,1536
s_add_u32 m0, s55, 57792
MAA 112,112,44
buffer_load_dwordx4 v21, s[36:39], s53 offen lds
MAA 108,112,40
TR 92,25,13440
MAA 108,116,60
TR 94,25,13952
MAA 140,60,124
TR 96,25,2048
MAA 140,40,120
buffer_load_dwordx4 v28, s[36:39], s53 offen offset:1024 lds
MAA 144,44,120
TR 98,25,2560
MAA 144,64,124
buffer_load_dword v29, s[36:39], s53 offen offset:2048 lds
MAA 148,68,124
TR 100,25,14464
s_add_u32 s53, s53, 128
MAA 148,48,120
TR 102,25,14976
MAA 152,52,120
MAA 152,72,124
s_waitcnt vmcnt(22) lgkmcnt(8)
s_barrier
MAA 60,80,0
TR 104,25,32
s_add_u32 m0, s56, 136064
MAA 60,84,20
buffer_load_dwordx4 v18, s[20:23], s54 offen lds
MAA 64,84,24
s_sub_u32 s47, s47, 1
s_cbranch_scc1 .Lx9
.Lx9b:
MAA 64,80,4
TR 106,25,544
v_accvgpr_write_b32 a224, v192
MAA 68,80,8
TR 108,25,12448
MAA 68,84,28
buffer_load_dwordx4 v19, s[20:23], s54 offen offset:1024 lds
MAA 72,84,32
TR 110,25,12960
v_accvgpr_write_b32 a225, v193
MAA 72,80,12
TR 112,25,1056
s_waitcnt lgkmcnt(5)
MAA 244,80,16
TR 114,25,1568
MAA 244,84,36
buffer_load_dwordx4 v20, s[20:23], s54 offen offset:2048 lds
MAA 156,92,36
s_add_u32 s54, s54, 196608
v_accvgpr_write_b32 a226, v194
MAA 156,88,16
TR 116,25,13472
MAA 104,88,12
TR 118,25,13984
v_accvgpr_write_b32 a227, v195
MAA 104,92,32
TR 120,25,2080
MAA 100,92,28
TR 122,25,2592
s_add_u32 m0, s55, 0
MAA 100,88,8
buffer_load_dwordx4 v21, s[36:39], s52 offen lds
MAA 96,88,4
TR 124,25,14496
v_accvgpr_write_b32 a228, v196
MAA 96,92,24
TR 126,25,15008
MAA 92,92,20
v_accvgpr_write_b32 a229, v197
MAA 92,88,0
buffer_load_dwordx4 v28, s[36:39], s52 offen offset:1024 lds
MAA 124,0,96
RD 40,23,18496
MAA 124,20,100
RD 44,23,20800
v_accvgpr_write_b32 a230, v198
MAA 128,24,100
RD 48,23,23104
MAA 128,4,96
buffer_load_dword v22, s[36:39], s52 offen offset:2048 lds
MAA 132,8,96
RD 52,23,25408
s_add_u32 s52, s52, 128
MAA 132,28,100
RD 56,24,18496
v_accvgpr_write_b32 a231, v199
MAA 136,32,100
MAA 136,12,96
s_waitcnt vmcnt(16) lgkmcnt(5)
s_barrier
MAA 76,104,0
RD 60,30,18496
s_add_u32 m0, s56, 73984
MAA 76,108,20
buffer_load_dwordx4 v18, s[20:23], s54 offen lds
MAA 80,108,24
RD 64,30,20800
v_accvgpr_write_b32 a232, v200
MAA 80,104,4
RD 68,30,23104
MAA 84,104,8
RD 72,30,25408
v_accvgpr_write_b32 a233, v201
MAA 84,108,28
buffer_load_dwordx4 v19, s[20:23], s54 offen offset:1024 lds
MAA 88,108,32
RD 76,31,18496
MAA 88,104,12
TR 80,25,24832
v_accvgpr_write_b32 a234, v202
MAA 160,112,16
TR 82,25,25344
MAA 160,116,36
buffer_load_dwordx4 v20, s[20:23], s54 offen offset:2048 lds
MAA 120,116,32
TR 84,25,37248
s_add_u32 s54, s54, 196608
MAA 120,112,12
TR 86,25,37760
v_accvgpr_write_b32 a235, v203
MAA 116,112,8
s_add_u32 m0, s55, 2304
MAA 116,116,28
buffer_load_dwordx4 v21, s[36:39], s53 offen lds
MAA 112,116,24
TR 88,25,25856
v_accvgpr_write_b32 a236, v204
MAA 112,112,4
TR 90,25,26368
MAA 108,112,0
TR 92,25,38272
v_accvgpr_write_b32 a237, v205
MAA 108,116,20
buffer_load_dwordx4 v28, s[36:39], s53 offen offset:1024 lds
MAA 140,20,124
TR 94,25,38784
MAA 140,0,120
TR 96,25,26880
v_accvgpr_write_b32 a238, v206
MAA 144,4,120
TR 98,25,27392
MAA 144,24,124
buffer_load_dword v29, s[36:39], s53 offen offset:2048 lds
MAA 148,28,124
TR 100,25,39296
s_add_u32 s53, s53, 128
MAA 148,8,120
TR 102,25,39808
v_accvgpr_write_b32 a239, v207
MAA 152,12,120
MAA 152,32,124
s_waitcnt lgkmcnt(8)
s_barrier
MAA 60,80,40
TR 104,25,24864
s_add_u32 m0, s56, 86400
MAA 60,84,60
buffer_load_dwordx4 v18, s[20:23], s54 offen lds
MAA 64,84,64
s_sub_u32 s47, s47, 1
s_cbranch_scc1 .Lx10
.Lx10b:
MAA 64,80,44
TR 106,25,25376
v_accvgpr_write_b32 a240, v208
MAA 68,80,48
TR 108,25,37280
MAA 68,84,68
buffer_load_dwordx4 v19, s[20:23], s54 offen offset:1024 lds
MAA 72,84,72
TR 110,25,37792
v_accvgpr_write_b32 a241, v209
MAA 72,80,52
TR 112,25,25888
s_waitcnt lgkmcnt(5)
MAA 244,80,56
TR 114,25,26400
MAA 244,84,76
buffer_load_dwordx4 v20, s[20:23], s54 offen offset:2048 lds
MAA 156,92,76
s_add_u32 s54, s54, 196608
v_accvgpr_write_b32 a242, v210
MAA 156,88,56
TR 116,25,38304
MAA 104,88,52
TR 118,25,38816
v_accvgpr_write_b32 a243, v211
MAA 104,92,72
TR 120,25,26912
MAA 100,92,68
TR 122,25,27424
s_add_u32 m0, s55, 18496
MAA 100,88,48
buffer_load_dwordx4 v21, s[36:39], s52 offen lds
MAA 96,88,44
TR 124,25,39328
v_accvgpr_write_b32 a244, v212
MAA 96,92,64
TR 126,25,39840
MAA 92,92,60
v_accvgpr_write_b32 a245, v213
MAA 92,88,40
buffer_load_dwordx4 v28, s[36:39], s52 offen offset:1024 lds
MAA 124,40,96
RD 0,23,36992
MAA 124,60,100
RD 4,23,39296
v_accvgpr_write_b32 a246, v214
MAA 128,64,100
RD 8,23,41600
MAA 128,44,96
buffer_load_dword v22, s[36:39], s52 offen offset:2048 lds
MAA 132,48,96
RD 12,23,43904
s_add_u32 s52, s52, 128
MAA 132,68,100
RD 16,24,36992
v_accvgpr_write_b32 a247, v215
MAA 136,72,100
MAA 136,52,96
s_waitcnt vmcnt(15) lgkmcnt(5)
s_barrier
MAA 76,104,40
RD 20,30,36992
s_add_u32 m0, s56, 98816
MAA 76,108,60
buffer_load_dwordx4 v18, s[20:23], s54 offen lds
MAA 80,108,64
RD 24,30,39296
v_accvgpr_write_b32 a248, v216
MAA 80,104,44
RD 28,30,41600
v_accvgpr_write_b32 a249, v217
MAA 84,104,48
RD 32,30,43904
MAA 84,108,68
buffer_load_dwordx4 v19, s[20:23], s54 offen offset:1024 lds
MAA 88,108,72
RD 36,31,36992
v_accvgpr_write_b32 a250, v218
MAA 88,104,52
buffer_load_dwordx4 v20, s[20:23], s54 offen offset:2048 lds
MAA 160,112,56
TR 80,25,49664
s_add_u32 s54, s54, 196608
MAA 160,116,76
TR 82,25,50176
MAA 120,116,72
TR 84,25,62080
s_add_u32 m0, s55, 20800
MAA 120,112,52
buffer_load_dwordx4 v21, s[36:39], s53 offen lds
MAA 116,112,48
TR 86,25,62592
v_accvgpr_write_b32 a251, v219
MAA 116,116,68
TR 88,25,50688
MAA 112,116,64
TR 90,25,51200
v_accvgpr_write_b32 a252, v220
MAA 112,112,44
buffer_load_dwordx4 v28, s[36:39], s53 offen offset:1024 lds
MAA 108,112,40
TR 92,25,63104
MAA 108,116,60
TR 94,25,63616
v_accvgpr_write_b32 a253, v221
MAA 140,60,124
TR 96,25,51712
MAA 140,40,120
buffer_load_dword v29, s[36:39], s53 offen offset:2048 lds
MAA 144,44,120
TR 98,25,52224
s_add_u32 s53, s53, 128
MAA 144,64,124
buffer_atomic_add v37, v33, s[16:19], 0 offen sc0
MAA 148,68,124
TR 100,25,64128
v_accvgpr_write_b32 a254, v222
MAA 148,48,120
TR 102,25,64640
MAA 152,52,120
v_accvgpr_write_b32 a255, v223
MAA 152,72,124
s_waitcnt lgkmcnt(8)
s_barrier
MAA 60,80,0
TR 104,25,49696
s_add_u32 m0, s56, 111232
MAA 60,84,20
buffer_load_dwordx4 v18, s[20:23], s54 offen lds
MAA 64,84,24
s_sub_u32 s47, s47, 1
s_cbranch_scc1 .Lx11
.Lx11b:
MAA 64,80,4
TR 106,25,50208
MAA 68,80,8
TR 108,25,62112
MAA 68,84,28
buffer_load_dwordx4 v19, s[20:23], s54 offen offset:1024 lds
MAA 72,84,32
TR 110,25,62624
MAA 72,80,12
TR 112,25,50720
s_waitcnt lgkmcnt(5)
MAA 244,80,16
TR 114,25,51232
MAA 244,84,36
buffer_load_dwordx4 v20, s[20:23], s54 offen offset:2048 lds
MAA 156,92,36
s_add_u32 s54, s54, 196608
MAA 156,88,16
TR 116,25,63136
MAA 104,88,12
TR 118,25,63648
MAA 104,92,32
TR 120,25,51744
MAA 100,92,28
TR 122,25,52256
s_add_u32 m0, s55, 36992
MAA 100,88,8
buffer_load_dwordx4 v21, s[36:39], s52 offen lds
MAA 96,88,4
TR 124,25,64160
MAA 96,92,24
TR 126,25,64672
MAA 92,92,20
MAA 92,88,0
buffer_load_dwordx4 v28, s[36:39], s52 offen offset:1024 lds
MAA 124,0,96
RD 40,23,55488
MAA 124,20,100
RD 44,23,57792
MAA 128,24,100
RD 48,23,60096
MAA 128,4,96
buffer_load_dword v22, s[36:39], s52 offen offset:2048 lds
MAA 132,8,96
RD 52,23,62400
s_add_u32 s52, s52, 128
MAA 132,28,100
RD 56,24,55488
MAA 136,32,100
MAA 136,12,96
s_waitcnt vmcnt(16) lgkmcnt(5)
s_barrier
MAA 76,104,0
RD 60,30,55488
s_add_u32 m0, s56, 123648
MAA 76,108,20
buffer_load_dwordx4 v18, s[20:23], s54 offen lds
MAA 80,108,24
RD 64,30,57792
MAA 80,104,4
RD 68,30,60096
MAA 84,104,8
RD 72,30,62400
MAA 84,108,28
buffer_load_dwordx4 v19, s[20:23], s54 offen offset:1024 lds
MAA 88,108,32
RD 76,31,55488
MAA 88,104,12
ds_read_b64_tr_b16 a[80:81], v25
MAA 160,112,16
TR 82,25,512
MAA 160,116,36
buffer_load_dwordx4 v20, s[20:23], s54 offen offset:2048 lds
MAA 120,116,32
TR 84,25,12416
s_add_u32 s54, s54, 196608
MAA 120,112,12
TR 86,25,12928
MAA 116,112,8
s_add_u32 m0, s55, 39296
MAA 116,116,28
buffer_load_dwordx4 v21, s[36:39], s53 offen lds
MAA 112,116,24
TR 88,25,1024
MAA 112,112,4
TR 90,25,1536
MAA 108,112,0
TR 92,25,13440
MAA 108,116,20
buffer_load_dwordx4 v28, s[36:39], s53 offen offset:1024 lds
MAA 140,20,124
TR 94,25,13952
MAA 140,0,120
TR 96,25,2048
MAA 144,4,120
TR 98,25,2560
MAA 144,24,124
buffer_load_dword v29, s[36:39], s53 offen offset:2048 lds
MAA 148,28,124
TR 100,25,14464
s_add_u32 s53, s53, 128
MAA 148,8,120
TR 102,25,14976
MAA 152,12,120
MAA 152,32,124
s_waitcnt lgkmcnt(8)
s_barrier
MAA 60,80,40
TR 104,25,32
s_add_u32 m0, s56, 136064
MAA 60,84,60
buffer_load_dwordx4 v18, s[20:23], s54 offen lds
MAA 64,84,64
s_sub_u32 s47, s47, 1
s_cbranch_scc1 .Lx12
.Lx12b:
MAA 64,80,44
TR 106,25,544
MAA 68,80,48
TR 108,25,12448
MAA 68,84,68
buffer_load_dwordx4 v19, s[20:23], s54 offen offset:1024 lds
MAA 72,84,72
TR 110,25,12960
MAA 72,80,52
TR 112,25,1056
s_waitcnt lgkmcnt(5)
MAA 244,80,56
TR 114,25,1568
MAA 244,84,76
buffer_load_dwordx4 v20, s[20:23], s54 offen offset:2048 lds
MAA 156,92,76
s_add_u32 s54, s54, 196608
MAA 156,88,56
TR 116,25,13472
MAA 104,88,52
TR 118,25,13984
MAA 104,92,72
TR 120,25,2080
MAA 100,92,68
TR 122,25,2592
s_add_u32 m0, s55, 55488
MAA 100,88,48
buffer_load_dwordx4 v21, s[36:39], s52 offen lds
MAA 96,88,44
TR 124,25,14496
MAA 96,92,64
TR 126,25,15008
MAA 92,92,60
MAA 92,88,40
buffer_load_dwordx4 v28, s[36:39], s52 offen offset:1024 lds
MAA 124,40,96
ds_read_b128 a[0:3], v23
MAA 124,60,100
RD 4,23,2304
MAA 128,64,100
RD 8,23,4608
MAA 128,44,96
buffer_load_dword v22, s[36:39], s52 offen offset:2048 lds
MAA 132,48,96
.Lpad2:
s_cbranch_execz .Lpad6
RD 12,23,6912
s_add_u32 s52, s52, 128
MAA 132,68,100
ds_read_b128 a[16:19], v24
MAA 136,72,100
MAA 136,52,96
s_waitcnt vmcnt(18)
v_cmp_gt_u32 vcc, v36, v37
s_nop 0
s_cbranch_vccnz .Lsp13
.Lsp13b:
s_waitcnt vmcnt(15) lgkmcnt(5)
s_barrier
MAA 76,104,40
ds_read_b128 a[20:23], v30
s_add_u32 m0, s56, 73984
MAA 76,108,60
buffer_load_dwordx4 v18, s[20:23], s54 offen lds
MAA 80,108,64
RD 24,30,2304
MAA 80,104,44
RD 28,30,4608
MAA 84,104,48
RD 32,30,6912
MAA 84,108,68
buffer_load_dwordx4 v19, s[20:23], s54 offen offset:1024 lds
MAA 88,108,72
ds_read_b128 a[36:39], v31
MAA 88,104,52
buffer_load_dwordx4 v20, s[20:23], s54 offen offset:2048 lds
MAA 160,112,56
TR 80,25,24832
s_add_u32 s54, s54, 196608
MAA 160,116,76
TR 82,25,25344
MAA 120,116,72
TR 84,25,37248
s_add_u32 m0, s55, 57792
MAA 120,112,52
buffer_load_dwordx4 v21, s[36:39], s53 offen lds
MAA 116,112,48
TR 86,25,37760
MAA 116,116,68
TR 88,25,25856
MAA 112,116,64
TR 90,25,26368
MAA 112,112,44
buffer_load_dwordx4 v28, s[36:39], s53 offen offset:1024 lds
MAA 108,112,40
TR 92,25,38272
MAA 108,116,60
TR 94,25,38784
MAA 140,60,124
TR 96,25,26880
MAA 140,40,120
buffer_load_dword v29, s[36:39], s53 offen offset:2048 lds
MAA 144,44,120
TR 98,25,27392
s_add_u32 s53, s53, 128
MAA 144,64,124
buffer_load_dwordx4 v[164:167], v26, s[16:19], s75 offen sc1
MAA 148,68,124
TR 100,25,39296
MAA 148,48,120
TR 102,25,39808
MAA 152,52,120
MAA 152,72,124
s_waitcnt lgkmcnt(8)
s_barrier
MAA 60,80,0
TR 104,25,24864
s_add_u32 m0, s56, 86400
MAA 60,84,20
buffer_load_dwordx4 v18, s[20:23], s54 offen lds
MAA 64,84,24
s_sub_u32 s47, s47, 1
s_cbranch_scc1 .Lx14
.Lx14b:
MAA 64,80,4
TR 106,25,25376
MAA 68,80,8
TR 108,25,37280
MAA 68,84,28
buffer_load_dwordx4 v19, s[20:23], s54 offen offset:1024 lds
MAA 72,84,32
TR 110,25,37792
MAA 72,80,12
TR 112,25,25888
s_waitcnt lgkmcnt(5)
MAA 244,80,16
TR 114,25,26400
MAA 244,84,36
buffer_load_dwordx4 v20, s[20:23], s54 offen offset:2048 lds
MAA 156,92,36
TR 116,25,38304
s_add_u32 s54, s54, 196608
MAA 156,88,16
TR 118,25,38816
MAA 104,88,12
TR 120,25,26912
s_add_u32 m0, s55, 0
MAA 104,92,32
buffer_load_dwordx4 v21, s[36:39], s52 offen lds
MAA 100,92,28
MAA 100,88,8
buffer_load_dwordx4 v28, s[36:39], s52 offen offset:1024 lds
MAA 96,88,4
TR 122,25,27424
MAA 96,92,24
TR 124,25,39328
MAA 92,92,20
TR 126,25,39840
MAA 92,88,0
buffer_load_dword v22, s[36:39], s52 offen offset:2048 lds
MAA 124,0,96
RD 40,23,18496
s_add_u32 s52, s52, 128
MAA 124,20,100
RD 44,23,20800
MAA 128,24,100
RD 48,23,23104
MAA 128,4,96
buffer_load_dwordx4 v[168:171], v26, s[16:19], s75 offen offset:1024 sc1
MAA 132,8,96
RD 52,23,25408
MAA 132,28,100
RD 56,24,18496
MAA 136,32,100
MAA 136,12,96
s_waitcnt vmcnt(17) lgkmcnt(5)
s_barrier
MAA 76,104,0
RD 60,30,18496
s_add_u32 m0, s56, 98816
MAA 76,108,20
buffer_load_dwordx4 v18, s[20:23], s54 offen lds
MAA 80,108,24
RD 64,30,20800
MAA 80,104,4
RD 68,30,23104
MAA 84,104,8
RD 72,30,25408
MAA 84,108,28
buffer_load_dwordx4 v19, s[20:23], s54 offen offset:1024 lds
MAA 88,108,32
RD 76,31,18496
MAA 88,104,12
buffer_load_dwordx4 v20, s[20:23], s54 offen offset:2048 lds
MAA 160,112,16
TR 80,25,49664
s_add_u32 s54, s54, 196608
MAA 160,116,36
TR 82,25,50176
MAA 120,116,32
TR 84,25,62080
s_add_u32 m0, s55, 2304
MAA 120,112,12
buffer_load_dwordx4 v21, s[36:39], s53 offen lds
MAA 116,112,8
TR 86,25,62592
MAA 116,116,28
TR 88,25,50688
MAA 112,116,24
TR 90,25,51200
MAA 112,112,4
buffer_load_dwordx4 v28, s[36:39], s53 offen offset:1024 lds
MAA 108,112,0
TR 92,25,63104
MAA 108,116,20
TR 94,25,63616
MAA 140,20,124
TR 96,25,51712
MAA 140,0,120
buffer_load_dword v29, s[36:39], s53 offen offset:2048 lds
MAA 144,4,120
TR 98,25,52224
s_add_u32 s53, s53, 128
MAA 144,24,124
buffer_load_dwordx4 v[172:175], v26, s[16:19], s75 offen offset:2048 sc1
MAA 148,28,124
TR 100,25,64128
MAA 148,8,120
TR 102,25,64640
MAA 152,12,120
MAA 152,32,124
s_waitcnt lgkmcnt(8)
s_barrier
MAA 60,80,40
TR 104,25,49696
s_add_u32 m0, s56, 111232
MAA 60,84,60
buffer_load_dwordx4 v18, s[20:23], s54 offen lds
MAA 64,84,64
s_sub_u32 s47, s47, 1
s_cbranch_scc1 .Lx15
.Lx15b:
MAA 64,80,44
TR 106,25,50208
MAA 68,80,48
TR 108,25,62112
MAA 68,84,68
buffer_load_dwordx4 v19, s[20:23], s54 offen offset:1024 lds
MAA 72,84,72
TR 110,25,62624
MAA 72,80,52
TR 112,25,50720
s_waitcnt lgkmcnt(5)
MAA 244,80,56
TR 114,25,51232
MAA 244,84,76
buffer_load_dwordx4 v20, s[20:23], s54 offen offset:2048 lds
MAA 156,92,76
TR 116,25,63136
s_add_u32 s54, s54, 196608
MAA 156,88,56
TR 118,25,63648
MAA 104,88,52
TR 120,25,51744
s_add_u32 m0, s55, 18496
MAA 104,92,72
buffer_load_dwordx4 v21, s[36:39], s52 offen lds
MAA 100,92,68
MAA 100,88,48
buffer_load_dwordx4 v28, s[36:39], s52 offen offset:1024 lds
MAA 96,88,44
TR 122,25,52256
MAA 96,92,64
TR 124,25,64160
MAA 92,92,60
TR 126,25,64672
MAA 92,88,40
buffer_load_dword v22, s[36:39], s52 offen offset:2048 lds
MAA 124,40,96
RD 0,23,36992
s_add_u32 s52, s52, 128
MAA 124,60,100
RD 4,23,39296
MAA 128,64,100
RD 8,23,41600
MAA 128,44,96
buffer_load_dwordx4 v[176:179], v26, s[16:19], s75 offen offset:3072 sc1
MAA 132,48,96
RD 12,23,43904
s_add_u32 s75, s75, 4096
MAA 132,68,100
RD 16,24,36992
MAA 136,72,100
MAA 136,52,96
s_waitcnt vmcnt(18) lgkmcnt(5)
s_barrier
MAA 76,104,40
RD 20,30,36992
s_add_u32 m0, s56, 123648
MAA 76,108,60
buffer_load_dwordx4 v18, s[20:23], s54 offen lds
MAA 80,108,64
RD 24,30,39296
s_waitcnt vmcnt(15)
v_add_f32 v164, v164, v168
MAA 80,104,44
RD 28,30,41600
MAA 84,104,48
RD 32,30,43904
MAA 84,108,68
buffer_load_dwordx4 v19, s[20:23], s54 offen offset:1024 lds
MAA 88,108,72
RD 36,31,36992
v_add_f32 v165, v165, v169
MAA 88,104,52
buffer_load_dwordx4 v20, s[20:23], s54 offen offset:2048 lds
MAA 160,112,56
ds_read_b64_tr_b16 a[80:81], v25
s_add_u32 s54, s54, 196608
MAA 160,116,76
TR 82,25,512
MAA 120,116,72
TR 84,25,12416
s_add_u32 m0, s55, 20800
MAA 120,112,52
buffer_load_dwordx4 v21, s[36:39], s53 offen lds
MAA 116,112,48
TR 86,25,12928
MAA 116,116,68
TR 88,25,1024
MAA 112,116,64
TR 90,25,1536
v_add_f32 v166, v166, v170
MAA 112,112,44
buffer_load_dwordx4 v28, s[36:39], s53 offen offset:1024 lds
MAA 108,112,40
TR 92,25,13440
MAA 108,116,60
TR 94,25,13952
MAA 140,60,124
TR 96,25,2048
MAA 140,40,120
buffer_load_dword v29, s[36:39], s53 offen offset:2048 lds
MAA 144,44,120
TR 98,25,2560
s_add_u32 s53, s53, 128
MAA 144,64,124
buffer_load_dwordx4 v[180:183], v26, s[16:19], s75 offen sc1
MAA 148,68,124
TR 100,25,14464
v_add_f32 v167, v167, v171
MAA 148,48,120
TR 102,25,14976
MAA 152,52,120
MAA 152,72,124
s_waitcnt lgkmcnt(8)
s_barrier
MAA 60,80,0
TR 104,25,32
s_add_u32 m0, s56, 136064
MAA 60,84,20
buffer_load_dwordx4 v18, s[20:23], s54 offen lds
MAA 64,84,24
s_sub_u32 s47, s47, 1
s_cbranch_scc1 .Lx16
.Lx16b:
MAA 64,80,4
TR 106,25,544
s_waitcnt vmcnt(15)
v_add_f32 v164, v164, v172
MAA 68,80,8
TR 108,25,12448
MAA 68,84,28
buffer_load_dwordx4 v19, s[20:23], s54 offen offset:1024 lds
MAA 72,84,32
TR 110,25,12960
MAA 72,80,12
TR 112,25,1056
s_waitcnt lgkmcnt(5)
MAA 244,80,16
TR 114,25,1568
MAA 244,84,36
buffer_load_dwordx4 v20, s[20:23], s54 offen offset:2048 lds
MAA 156,92,36
TR 116,25,13472
s_add_u32 s54, s54, 196608
MAA 156,88,16
TR 118,25,13984
v_add_f32 v165, v165, v173
MAA 104,88,12
TR 120,25,2080
s_add_u32 m0, s55, 36992
MAA 104,92,32
buffer_load_dwordx4 v21, s[36:39], s52 offen lds
MAA 100,92,28
MAA 100,88,8
buffer_load_dwordx4 v28, s[36:39], s52 offen offset:1024 lds
MAA 96,88,4
TR 122,25,2592
MAA 96,92,24
TR 124,25,14496
v_add_f32 v166, v166, v174
MAA 92,92,20
TR 126,25,15008
MAA 92,88,0
buffer_load_dword v22, s[36:39], s52 offen offset:2048 lds
MAA 124,0,96
RD 40,23,55488
s_add_u32 s52, s52, 128
MAA 124,20,100
RD 44,23,57792
MAA 128,24,100
RD 48,23,60096
MAA 128,4,96
buffer_load_dwordx4 v[184:187], v26, s[16:19], s75 offen offset:1024 sc1
MAA 132,8,96
RD 52,23,62400
v_add_f32 v167, v167, v175
MAA 132,28,100
RD 56,24,55488
MAA 136,32,100
MAA 136,12,96
s_waitcnt vmcnt(18) lgkmcnt(5)
s_barrier
MAA 76,104,0
RD 60,30,55488
s_add_u32 m0, s56, 73984
MAA 76,108,20
buffer_load_dwordx4 v18, s[20:23], s54 offen lds
MAA 80,108,24
RD 64,30,57792
s_waitcnt vmcnt(15)
v_add_f32 v164, v164, v176
MAA 80,104,4
RD 68,30,60096
v_add_f32 v165, v165, v177
MAA 84,104,8
buffer_load_dwordx4 v19, s[20:23], s54 offen offset:1024 lds
MAA 84,108,28
RD 72,30,62400
v_add_f32 v166, v166, v178
MAA 88,108,32
RD 76,31,55488
v_add_f32 v167, v167, v179
MAA 88,104,12
buffer_load_dwordx4 v20, s[20:23], s54 offen offset:2048 lds
MAA 160,112,16
TR 80,25,24832
s_add_u32 s54, s54, 196608
MAA 160,116,36
TR 82,25,25344
s_add_u32 m0, s55, 39296
MAA 120,116,32
buffer_load_dwordx4 v21, s[36:39], s53 offen lds
MAA 120,112,12
TR 84,25,37248
MAA 116,112,8
TR 86,25,37760
MAA 116,116,28
buffer_load_dwordx4 v28, s[36:39], s53 offen offset:1024 lds
MAA 112,116,24
TR 88,25,25856
MAA 112,112,4
TR 90,25,26368
MAA 108,112,0
buffer_load_dword v29, s[36:39], s53 offen offset:2048 lds
MAA 108,116,20
TR 92,25,38272
s_add_u32 s53, s53, 128
MAA 140,20,124
TR 94,25,38784
MAA 140,0,120
buffer_load_dwordx4 v[188:191], v26, s[16:19], s75 offen offset:2048 sc1
MAA 144,4,120
TR 96,25,26880
MAA 144,24,124
TR 98,25,27392
MAA 148,28,124
TR 100,25,39296
MAA 148,8,120
TR 102,25,39808
MAA 152,12,120
MAA 152,32,124
s_waitcnt lgkmcnt(8)
s_barrier
MAA 60,80,40
TR 104,25,24864
s_add_u32 m0, s56, 86400
MAA 60,84,60
buffer_load_dwordx4 v18, s[20:23], s54 offen lds
MAA 64,84,64
s_sub_u32 s47, s47, 1
s_cbranch_scc1 .Lx17
.Lx17b:
MAA 64,80,44
TR 106,25,25376
s_waitcnt vmcnt(15)
v_add_f32 v164, v164, v180
MAA 68,80,48
TR 108,25,37280
MAA 68,84,68
buffer_load_dwordx4 v19, s[20:23], s54 offen offset:1024 lds
MAA 72,84,72
TR 110,25,37792
MAA 72,80,52
TR 112,25,25888
s_waitcnt lgkmcnt(5)
MAA 244,80,56
TR 114,25,26400
MAA 244,84,76
buffer_load_dwordx4 v20, s[20:23], s54 offen offset:2048 lds
MAA 156,92,76
TR 116,25,38304
s_add_u32 s54, s54, 196608
MAA 156,88,56
TR 118,25,38816
v_add_f32 v165, v165, v181
MAA 104,88,52
TR 120,25,26912
s_add_u32 m0, s55, 55488
MAA 104,92,72
buffer_load_dwordx4 v21, s[36:39], s52 offen lds
MAA 100,92,68
MAA 100,88,48
buffer_load_dwordx4 v28, s[36:39], s52 offen offset:1024 lds
MAA 96,88,44
TR 122,25,27424
MAA 96,92,64
TR 124,25,39328
v_add_f32 v166, v166, v182
MAA 92,92,60
TR 126,25,39840
MAA 92,88,40
buffer_load_dword v22, s[36:39], s52 offen offset:2048 lds
MAA 124,40,96
ds_read_b128 a[0:3], v23
s_add_u32 s52, s52, 128
MAA 124,60,100
RD 4,23,2304
MAA 128,64,100
RD 8,23,4608
MAA 128,44,96
buffer_load_dwordx4 v[192:195], v26, s[16:19], s75 offen offset:3072 sc1
MAA 132,48,96
RD 12,23,6912
v_add_f32 v167, v167, v183
MAA 132,68,100
ds_read_b128 a[16:19], v24
MAA 136,72,100
MAA 136,52,96
s_waitcnt vmcnt(18) lgkmcnt(5)
s_barrier
MAA 76,104,40
ds_read_b128 a[20:23], v30
s_add_u32 m0, s56, 98816
MAA 76,108,60
buffer_load_dwordx4 v18, s[20:23], s54 offen lds
MAA 80,108,64
RD 24,30,2304
s_waitcnt vmcnt(15)
v_add_f32 v164, v164, v184
MAA 80,104,44
RD 28,30,4608
v_add_f32 v165, v165, v185
MAA 84,104,48
RD 32,30,6912
v_add_f32 v166, v166, v186
MAA 84,108,68
buffer_load_dwordx4 v19, s[20:23], s54 offen offset:1024 lds
MAA 88,108,72
ds_read_b128 a[36:39], v31
v_add_f32 v167, v167, v187
MAA 88,104,52
TR 80,25,49664
MAA 160,112,56
TR 82,25,50176
MAA 160,116,76
buffer_load_dwordx4 v20, s[20:23], s54 offen offset:2048 lds
MAA 120,116,72
TR 84,25,62080
s_add_u32 s54, s54, 196608
MAA 120,112,52
TR 86,25,62592
s_add_u32 m0, s55, 57792
MAA 116,112,48
TR 88,25,50688
MAA 116,116,68
buffer_load_dwordx4 v21, s[36:39], s53 offen lds
MAA 112,116,64
TR 90,25,51200
MAA 112,112,44
TR 92,25,63104
MAA 108,112,40
.Lpad3:
s_cbranch_execz .Lpad7
TR 94,25,63616
MAA 108,116,60
buffer_load_dwordx4 v28, s[36:39], s53 offen offset:1024 lds
MAA 140,60,124
TR 96,25,51712
MAA 140,40,120
TR 98,25,52224
MAA 144,44,120
TR 100,25,64128
MAA 144,64,124
buffer_load_dword v29, s[36:39], s53 offen offset:2048 lds
MAA 148,68,124
TR 102,25,64640
s_add_u32 s53, s53, 128
MAA 148,48,120
MAA 152,52,120
MAA 152,72,124
s_waitcnt lgkmcnt(8)
s_barrier
MAA 60,80,0
TR 104,25,49696
s_add_u32 m0, s56, 111232
MAA 60,84,20
buffer_load_dwordx4 v18, s[20:23], s54 offen lds
MAA 64,84,24
TR 106,25,50208
s_waitcnt vmcnt(14)
v_add_f32 v164, v164, v188
MAA 64,80,4
TR 108,25,62112
v_add_f32 v165, v165, v189
MAA 68,80,8
buffer_load_dwordx4 v19, s[20:23], s54 offen offset:1024 lds
MAA 68,84,28
TR 110,25,62624
v_add_f32 v166, v166, v190
MAA 72,84,32
TR 112,25,50720
v_add_f32 v167, v167, v191
MAA 72,80,12
buffer_load_dwordx4 v20, s[20:23], s54 offen offset:2048 lds
s_waitcnt lgkmcnt(5)
MAA 244,80,16
TR 114,25,51232
s_add_u32 s54, s54, 196608
MAA 244,84,36
TR 116,25,63136
s_add_u32 m0, s59, 0
MAA 156,92,36
TR 118,25,63648
s_xor_b32 s58, s87, 1048576
MAA 156,88,16
buffer_load_dwordx4 v5, s[24:27], s58 offen lds
MAA 104,88,12
TR 120,25,51744
MAA 104,92,32
TR 122,25,52256
MAA 100,92,28
buffer_load_dwordx4 v6, s[24:27], s58 offen offset:1024 lds
MAA 100,88,8
TR 124,25,64160
s_add_u32 m0, s59, 8320
MAA 96,88,4
TR 126,25,64672
s_xor_b32 s58, s87, 1179648
MAA 96,92,24
buffer_load_dwordx4 v5, s[24:27], s58 offen lds
MAA 92,92,20
RD 40,23,18496
MAA 92,88,0
RD 44,23,20800
MAA 124,0,96
buffer_load_dwordx4 v6, s[24:27], s58 offen offset:1024 lds
MAA 124,20,100
RD 48,23,23104
MAA 128,24,100
RD 52,23,25408
MAA 128,4,96
RD 56,24,18496
MAA 132,8,96
MAA 132,28,100
MAA 136,32,100
MAA 136,12,96
s_waitcnt vmcnt(17) lgkmcnt(5)
s_barrier
MAA 76,104,0
RD 60,30,18496
s_add_u32 m0, s56, 123648
MAA 76,108,20
buffer_load_dwordx4 v18, s[20:23], s54 offen lds
MAA 80,108,24
RD 64,30,20800
s_waitcnt vmcnt(14)
v_add_f32 v164, v164, v192
MAA 80,104,4
RD 68,30,23104
v_add_f32 v165, v165, v193
MAA 84,104,8
RD 72,30,25408
v_add_f32 v166, v166, v194
MAA 84,108,28
RD 76,31,18496
v_add_f32 v167, v167, v195
MAA 88,108,32
ds_read_b64_tr_b16 a[80:81], v25
MAA 88,104,12
TR 82,25,512
MAA 160,112,16
TR 84,25,12416
MAA 160,116,36
buffer_load_dwordx4 v19, s[20:23], s54 offen offset:1024 lds
MAA 120,116,32
TR 86,25,12928
MAA 120,112,12
TR 88,25,1024
MAA 116,112,8
TR 90,25,1536
MAA 116,116,28
TR 92,25,13440
MAA 112,116,24
TR 94,25,13952
MAA 112,112,4
TR 96,25,2048
MAA 108,112,0
TR 98,25,2560
MAA 108,116,20
buffer_load_dwordx4 v20, s[20:23], s54 offen offset:2048 lds
MAA 140,20,124
TR 100,25,14464
s_add_u32 s54, s54, 196608
MAA 140,0,120
TR 102,25,14976
MAA 144,4,120
MAA 144,24,124
MAA 148,28,124
MAA 148,8,120
MAA 152,12,120
MAA 152,32,124
s_waitcnt lgkmcnt(8)
s_barrier
MAA 60,80,40
TR 104,25,32
s_add_u32 m0, s56, 136064
MAA 60,84,60
buffer_load_dwordx4 v18, s[20:23], s54 offen lds
MAA 64,84,64
TR 106,25,544
MAA 64,80,44
TR 108,25,12448
MAA 68,80,48
buffer_load_dwordx4 v19, s[20:23], s54 offen offset:1024 lds
MAA 68,84,68
TR 110,25,12960
MAA 72,84,72
TR 112,25,1056
MAA 72,80,52
buffer_load_dwordx4 v20, s[20:23], s54 offen offset:2048 lds
s_waitcnt lgkmcnt(5)
MAA 244,80,56
TR 114,25,1568
s_add_u32 s54, s54, 196608
MAA 244,84,76
TR 116,25,13472
s_add_u32 m0, s59, 16640
MAA 156,92,76
TR 118,25,13984
s_xor_b32 s58, s87, 1310720
MAA 156,88,56
buffer_load_dwordx4 v5, s[24:27], s58 offen lds
MAA 104,88,52
TR 120,25,2080
MAA 104,92,72
TR 122,25,2592
MAA 100,92,68
buffer_load_dwordx4 v6, s[24:27], s58 offen offset:1024 lds
MAA 100,88,48
TR 124,25,14496
s_add_u32 m0, s59, 24960
MAA 96,88,44
TR 126,25,15008
s_xor_b32 s58, s87, 1441792
MAA 96,92,64
buffer_load_dwordx4 v5, s[24:27], s58 offen lds
MAA 92,92,60
RD 0,23,36992
MAA 92,88,40
RD 4,23,39296
MAA 124,40,96
buffer_load_dwordx4 v6, s[24:27], s58 offen offset:1024 lds
MAA 124,60,100
RD 8,23,41600
MAA 128,64,100
RD 12,23,43904
MAA 128,44,96
RD 16,24,36992
MAA 132,48,96
v_permlane32_swap_b32 v164, v166
MAA 132,68,100
v_permlane32_swap_b32 v165, v167
MAA 136,72,100
v_add_f32 v164, v164, v166
v_add_f32 v165, v165, v167
MAA 136,52,96
v_mul_f32 v164, 0xba800000, v164
v_mul_f32 v165, 0x3a800000, v165
v_fma_f32 v165, -v164, v164, v165
v_max_f32 v165, 0, v165
v_add_f32 v165, 0x3727c5ac, v165
v_rsq_f32 v166, v165
s_nop 0
v_mov_b32 v165, v166
v_mul_f32 v166, 0x3e8293ee, v166
s_waitcnt vmcnt(14) lgkmcnt(5)
s_barrier
MAA 76,104,40
ds_write_b128 v7, v[164:167]
s_add_u32 m0, s59, 74880
MAA 76,108,60
ds_write_b32 v17, v164
s_xor_b32 s58, s87, 131072
MAA 80,108,64
ds_write_b32 v17, v165 offset:1024
MAA 80,104,44
buffer_load_dwordx4 v5, s[24:27], s58 offen lds
MAA 84,104,48
RD 20,30,36992
MAA 84,108,68
RD 24,30,39296
MAA 88,108,72
RD 28,30,41600
MAA 88,104,52
RD 32,30,43904
MAA 160,112,56
RD 36,31,36992
MAA 160,116,76
buffer_load_dwordx4 v6, s[24:27], s58 offen offset:1024 lds
MAA 120,116,72
TR 80,25,24832
s_add_u32 m0, s59, 83200
MAA 120,112,52
TR 82,25,25344
s_xor_b32 s58, s87, 262144
MAA 116,112,48
TR 84,25,37248
MAA 116,116,68
TR 86,25,37760
MAA 112,116,64
TR 88,25,25856
MAA 112,112,44
buffer_load_dwordx4 v5, s[24:27], s58 offen lds
MAA 108,112,40
TR 90,25,26368
MAA 108,116,60
TR 92,25,38272
MAA 140,60,124
TR 94,25,38784
MAA 140,40,120
TR 96,25,26880
MAA 144,44,120
TR 98,25,27392
MAA 144,64,124
buffer_load_dwordx4 v6, s[24:27], s58 offen offset:1024 lds
MAA 148,68,124
TR 100,25,39296
MAA 148,48,120
TR 102,25,39808
MAA 152,52,120
MAA 152,72,124
s_waitcnt vmcnt(8) lgkmcnt(0)
s_barrier
MAA 156,88,16
TR 112,25,25888
s_add_u32 m0, s59, 33280
MAA 156,92,36
TR 114,25,26400
s_xor_b32 s58, s87, 1572864
MAA 104,92,32
buffer_load_dwordx4 v5, s[24:27], s58 offen lds
MAA 104,88,12
TR 116,25,38304
MAA 100,88,8
TR 118,25,38816
MAA 100,92,28
TR 120,25,26912
MAA 96,92,24
buffer_load_dwordx4 v6, s[24:27], s58 offen offset:1024 lds
MAA 96,88,4
TR 122,25,27424
s_add_u32 m0, s59, 41600
MAA 92,88,0
TR 124,25,39328
s_xor_b32 s58, s87, 1703936
MAA 92,92,20
TR 126,25,39840
MAA 136,32,100
buffer_load_dwordx4 v5, s[24:27], s58 offen lds
MAA 136,12,96
TR 104,25,24864
MAA 244,80,16
TR 106,25,25376
MAA 244,84,36
TR 108,25,37280
MAA 72,84,32
buffer_load_dwordx4 v6, s[24:27], s58 offen offset:1024 lds
MAA 72,80,12
TR 110,25,37792
MAA 68,80,8
RD 40,23,55488
MAA 68,84,28
RD 44,23,57792
MAA 64,84,24
RD 48,23,60096
MAA 64,80,4
RD 52,23,62400
MAA 60,80,0
RD 56,24,55488
MAA 60,84,20
RD 60,30,55488
s_waitcnt lgkmcnt(15)
MAA 160,112,16
RD 64,30,57792
s_waitcnt lgkmcnt(15)
MAA 160,116,36
s_waitcnt lgkmcnt(7)
s_barrier
RD 68,30,60096
MAA 120,116,32
RD 72,30,62400
s_add_u32 m0, s59, 91520
MAA 120,112,12
RD 76,31,55488
s_xor_b32 s58, s87, 393216
MAA 116,112,8
TR 144,25,50688
MAA 116,116,28
TR 146,25,51200
MAA 112,116,24
TR 148,25,63104
MAA 112,112,4
TR 150,25,63616
MAA 108,112,0
TR 152,25,50720
MAA 108,116,20
TR 154,25,51232
MAA 152,32,124
TR 156,25,63136
MAA 152,12,120
TR 158,25,63648
MAA 88,104,12
TR 160,25,51712
MAA 88,108,32
TR 162,25,52224
MAA 84,108,28
TR 164,25,64128
MAA 84,104,8
TR 166,25,64640
MAA 80,104,4
TR 168,25,51744
MAA 80,108,24
TR 170,25,52256
MAA 76,108,20
TR 172,25,64160
MAA 76,104,0
TR 174,25,64672
s_waitcnt lgkmcnt(14)
MAA 156,144,56
TR 128,25,49664
s_waitcnt lgkmcnt(13)
MAA 156,148,76
TR 130,25,50176
MAA 104,148,72
TR 132,25,62080
MAA 104,144,52
TR 134,25,62592
MAA 100,144,48
TR 136,25,49696
MAA 100,148,68
TR 138,25,50208
MAA 96,148,64
TR 140,25,62112
MAA 96,144,44
TR 142,25,62624
MAA 92,144,40
ds_read_b128 v[232:235], v10 offset:768
MAA 92,148,60
ds_read_b128 v[236:239], v10 offset:2816
s_waitcnt lgkmcnt(15)
MAA 160,156,76
ds_read_b128 v[228:231], v10 offset:512
MAA 160,152,56
ds_read_b128 v[224:227], v10 offset:256
MAA 120,152,52
ds_read_b128 v[220:223], v10
MAA 120,156,72
buffer_load_dwordx4 v5, s[24:27], s58 offen lds
MAA 116,156,68
MAA 116,152,48
MAA 112,152,44
MAA 112,156,64
buffer_load_dwordx4 v6, s[24:27], s58 offen offset:1024 lds
MAA 108,156,60
s_add_u32 m0, s59, 99840
s_xor_b32 s58, s87, 524288
MAA 108,152,40
MAA 136,52,160
s_waitcnt lgkmcnt(15)
MAA 136,72,164
buffer_load_dwordx4 v5, s[24:27], s58 offen lds
s_waitcnt lgkmcnt(13)
MAA 152,72,172
MAA 152,52,168
s_waitcnt lgkmcnt(11)
MAA 244,128,56
s_waitcnt lgkmcnt(9)
MAA 244,132,76
buffer_load_dwordx4 v6, s[24:27], s58 offen offset:1024 lds
MAA 72,132,72
s_add_u32 m0, s59, 108160
s_xor_b32 s58, s87, 655360
MAA 72,128,52
MAA 68,128,48
MAA 68,132,68
buffer_load_dwordx4 v5, s[24:27], s58 offen lds
buffer_load_dwordx4 v6, s[24:27], s58 offen offset:1024 lds
s_mov_b32 exec_lo, 0x10001
s_mov_b32 exec_hi, 0x10001
ds_write_b128 v13, v[244:247]
ds_write_b128 v13, v[156:159] offset:256
ds_write_b128 v13, v[160:163] offset:320
s_mov_b64 exec, -1
MAA 64,128,44
MAA 64,132,64
MAA 60,132,60
MAA 60,128,40
s_waitcnt lgkmcnt(10)
MAA 88,136,52
s_waitcnt lgkmcnt(8)
MAA 88,140,72
s_waitcnt lgkmcnt(0)
s_barrier
MAA 84,136,48
ds_read_b128 v[28:31], v13
MAA 84,140,68
ds_read_b128 v[32:35], v13 offset:64
MAA 80,140,64
ds_read_b128 v[36:39], v13 offset:256
MAA 80,136,44
ds_read_b128 v[40:43], v13 offset:320
MAA 76,136,40
ds_read_b32 v44, v12 offset:512
MAA 76,140,60
ds_read_b32 v45, v12 offset:576
ds_read_b128 v[240:243], v11 offset:192
ds_read_b128 v[244:247], v11 offset:1216
ds_read_b128 v[18:21], v11 offset:128
ds_read_b128 v[22:25], v11 offset:1152
s_waitcnt lgkmcnt(9)
v_pk_fma_f32 v[72:73], v[28:29], v[232:233], v[72:73] op_sel_hi:[1,0,1]
v_cvt_pk_bf16_f32 v176, v72, v73
v_pk_fma_f32 v[74:75], v[30:31], v[232:233], v[74:75] op_sel_hi:[1,0,1]
v_cvt_pk_bf16_f32 v177, v74, v75
s_waitcnt lgkmcnt(8)
v_pk_fma_f32 v[88:89], v[32:33], v[232:233], v[88:89] op_sel_hi:[1,0,1]
v_cvt_pk_bf16_f32 v178, v88, v89
v_pk_fma_f32 v[90:91], v[34:35], v[232:233], v[90:91] op_sel_hi:[1,0,1]
v_cvt_pk_bf16_f32 v179, v90, v91
s_waitcnt lgkmcnt(7)
v_pk_fma_f32 v[104:105], v[36:37], v[232:233], v[104:105] op_sel_hi:[1,0,1]
v_pk_mul_f32 v[104:105], v[104:105], v[232:233] op_sel:[0,1] op_sel_hi:[1,1]
v_cvt_pk_bf16_f32 v196, v104, v105
v_pk_fma_f32 v[106:107], v[38:39], v[232:233], v[106:107] op_sel_hi:[1,0,1]
v_pk_mul_f32 v[106:107], v[106:107], v[232:233] op_sel:[0,1] op_sel_hi:[1,1]
v_cvt_pk_bf16_f32 v197, v106, v107
s_waitcnt lgkmcnt(6)
v_pk_fma_f32 v[120:121], v[40:41], v[232:233], v[120:121] op_sel_hi:[1,0,1]
v_pk_mul_f32 v[120:121], v[120:121], v[232:233] op_sel:[0,1] op_sel_hi:[1,1]
v_cvt_pk_bf16_f32 v198, v120, v121
v_pk_fma_f32 v[122:123], v[42:43], v[232:233], v[122:123] op_sel_hi:[1,0,1]
v_pk_mul_f32 v[122:123], v[122:123], v[232:233] op_sel:[0,1] op_sel_hi:[1,1]
v_cvt_pk_bf16_f32 v199, v122, v123
ds_write_b128 v8, v[196:199]
s_waitcnt lgkmcnt(4)
v_pk_fma_f32 v[136:137], v[240:241], v[44:45], v[136:137] op_sel_hi:[1,0,1]
v_pk_fma_f32 v[138:139], v[242:243], v[44:45], v[138:139] op_sel_hi:[1,0,1]
s_waitcnt lgkmcnt(3)
v_pk_mul_f32 v[136:137], v[136:137], v[244:245]
v_cvt_pk_bf16_f32 v208, v136, v137
v_pk_mul_f32 v[138:139], v[138:139], v[246:247]
v_cvt_pk_bf16_f32 v209, v138, v139
v_pk_fma_f32 v[152:153], v[240:241], v[44:45], v[152:153] op_sel:[0,1,0] op_sel_hi:[1,1,1]
v_pk_mul_f32 v[152:153], v[152:153], v[244:245]
v_cvt_pk_bf16_f32 v218, v152, v153
v_pk_fma_f32 v[154:155], v[242:243], v[44:45], v[154:155] op_sel:[0,1,0] op_sel_hi:[1,1,1]
v_pk_mul_f32 v[154:155], v[154:155], v[246:247]
v_cvt_pk_bf16_f32 v219, v154, v155
ds_write_b64 v8, v[208:209] offset:1024
ds_write_b64 v8, v[218:219] offset:1032
v_pk_fma_f32 v[156:157], v[36:37], v[236:237], v[156:157] op_sel_hi:[1,0,1]
v_pk_mul_f32 v[156:157], v[156:157], v[236:237] op_sel:[0,1] op_sel_hi:[1,1]
v_cvt_pk_bf16_f32 v180, v156, v157
v_pk_fma_f32 v[158:159], v[38:39], v[236:237], v[158:159] op_sel_hi:[1,0,1]
v_pk_mul_f32 v[158:159], v[158:159], v[236:237] op_sel:[0,1] op_sel_hi:[1,1]
v_cvt_pk_bf16_f32 v181, v158, v159
v_pk_fma_f32 v[160:161], v[40:41], v[236:237], v[160:161] op_sel_hi:[1,0,1]
v_pk_mul_f32 v[160:161], v[160:161], v[236:237] op_sel:[0,1] op_sel_hi:[1,1]
v_cvt_pk_bf16_f32 v182, v160, v161
v_pk_fma_f32 v[162:163], v[42:43], v[236:237], v[162:163] op_sel_hi:[1,0,1]
v_pk_mul_f32 v[162:163], v[162:163], v[236:237] op_sel:[0,1] op_sel_hi:[1,1]
v_cvt_pk_bf16_f32 v183, v162, v163
v_pk_fma_f32 v[100:101], v[36:37], v[228:229], v[100:101] op_sel_hi:[1,0,1]
v_pk_mul_f32 v[100:101], v[100:101], v[228:229] op_sel:[0,1] op_sel_hi:[1,1]
v_cvt_pk_bf16_f32 v192, v100, v101
v_pk_fma_f32 v[102:103], v[38:39], v[228:229], v[102:103] op_sel_hi:[1,0,1]
v_pk_mul_f32 v[102:103], v[102:103], v[228:229] op_sel:[0,1] op_sel_hi:[1,1]
v_cvt_pk_bf16_f32 v193, v102, v103
v_pk_fma_f32 v[116:117], v[40:41], v[228:229], v[116:117] op_sel_hi:[1,0,1]
v_pk_mul_f32 v[116:117], v[116:117], v[228:229] op_sel:[0,1] op_sel_hi:[1,1]
v_cvt_pk_bf16_f32 v194, v116, v117
v_pk_fma_f32 v[118:119], v[42:43], v[228:229], v[118:119] op_sel_hi:[1,0,1]
v_pk_mul_f32 v[118:119], v[118:119], v[228:229] op_sel:[0,1] op_sel_hi:[1,1]
s_waitcnt lgkmcnt(0)
s_barrier
v_cvt_pk_bf16_f32 v195, v118, v119
v_pk_fma_f32 v[96:97], v[36:37], v[224:225], v[96:97] op_sel_hi:[1,0,1]
v_pk_mul_f32 v[96:97], v[96:97], v[224:225] op_sel:[0,1] op_sel_hi:[1,1]
v_cvt_pk_bf16_f32 v188, v96, v97
v_pk_fma_f32 v[98:99], v[38:39], v[224:225], v[98:99] op_sel_hi:[1,0,1]
v_pk_mul_f32 v[98:99], v[98:99], v[224:225] op_sel:[0,1] op_sel_hi:[1,1]
v_cvt_pk_bf16_f32 v189, v98, v99
v_pk_fma_f32 v[112:113], v[40:41], v[224:225], v[112:113] op_sel_hi:[1,0,1]
v_pk_mul_f32 v[112:113], v[112:113], v[224:225] op_sel:[0,1] op_sel_hi:[1,1]
v_cvt_pk_bf16_f32 v190, v112, v113
v_pk_fma_f32 v[114:115], v[42:43], v[224:225], v[114:115] op_sel_hi:[1,0,1]
v_pk_mul_f32 v[114:115], v[114:115], v[224:225] op_sel:[0,1] op_sel_hi:[1,1]
v_cvt_pk_bf16_f32 v191, v114, v115
v_pk_fma_f32 v[92:93], v[36:37], v[220:221], v[92:93] op_sel_hi:[1,0,1]
v_pk_mul_f32 v[92:93], v[92:93], v[220:221] op_sel:[0,1] op_sel_hi:[1,1]
v_cvt_pk_bf16_f32 v184, v92, v93
v_pk_fma_f32 v[94:95], v[38:39], v[220:221], v[94:95] op_sel_hi:[1,0,1]
.Lpad4:
s_cbranch_execz .Lpad8
v_pk_mul_f32 v[94:95], v[94:95], v[220:221] op_sel:[0,1] op_sel_hi:[1,1]
v_cvt_pk_bf16_f32 v185, v94, v95
v_pk_fma_f32 v[108:109], v[40:41], v[220:221], v[108:109] op_sel_hi:[1,0,1]
v_pk_mul_f32 v[108:109], v[108:109], v[220:221] op_sel:[0,1] op_sel_hi:[1,1]
v_cvt_pk_bf16_f32 v186, v108, v109
v_pk_fma_f32 v[110:111], v[42:43], v[220:221], v[110:111] op_sel_hi:[1,0,1]
v_pk_mul_f32 v[110:111], v[110:111], v[220:221] op_sel:[0,1] op_sel_hi:[1,1]
v_cvt_pk_bf16_f32 v187, v110, v111
v_pk_fma_f32 v[68:69], v[28:29], v[228:229], v[68:69] op_sel_hi:[1,0,1]
v_cvt_pk_bf16_f32 v172, v68, v69
v_pk_fma_f32 v[70:71], v[30:31], v[228:229], v[70:71] op_sel_hi:[1,0,1]
v_cvt_pk_bf16_f32 v173, v70, v71
v_pk_fma_f32 v[84:85], v[32:33], v[228:229], v[84:85] op_sel_hi:[1,0,1]
v_cvt_pk_bf16_f32 v174, v84, v85
v_pk_fma_f32 v[86:87], v[34:35], v[228:229], v[86:87] op_sel_hi:[1,0,1]
v_cvt_pk_bf16_f32 v175, v86, v87
v_pk_fma_f32 v[64:65], v[28:29], v[224:225], v[64:65] op_sel_hi:[1,0,1]
v_cvt_pk_bf16_f32 v168, v64, v65
v_pk_fma_f32 v[66:67], v[30:31], v[224:225], v[66:67] op_sel_hi:[1,0,1]
v_cvt_pk_bf16_f32 v169, v66, v67
v_pk_fma_f32 v[80:81], v[32:33], v[224:225], v[80:81] op_sel_hi:[1,0,1]
v_cvt_pk_bf16_f32 v170, v80, v81
v_pk_fma_f32 v[82:83], v[34:35], v[224:225], v[82:83] op_sel_hi:[1,0,1]
v_cvt_pk_bf16_f32 v171, v82, v83
v_pk_fma_f32 v[60:61], v[28:29], v[220:221], v[60:61] op_sel_hi:[1,0,1]
v_cvt_pk_bf16_f32 v164, v60, v61
v_pk_fma_f32 v[62:63], v[30:31], v[220:221], v[62:63] op_sel_hi:[1,0,1]
v_cvt_pk_bf16_f32 v165, v62, v63
v_pk_fma_f32 v[76:77], v[32:33], v[220:221], v[76:77] op_sel_hi:[1,0,1]
v_cvt_pk_bf16_f32 v166, v76, v77
v_pk_fma_f32 v[78:79], v[34:35], v[220:221], v[78:79] op_sel_hi:[1,0,1]
v_cvt_pk_bf16_f32 v167, v78, v79
s_nop 0
v_mfma_f32_16x16x32_bf16 v[120:123], v[196:199], v[176:179], v[50:53]
ds_read_b64 v[200:201], v9 offset:1024
v_mfma_f32_16x16x32_bf16 v[104:107], v[192:195], v[176:179], v[46:49]
ds_read_b64 v[210:211], v9 offset:1032
v_mfma_f32_16x16x32_bf16 v[116:119], v[192:195], v[172:175], v[50:53]
ds_read_b128 v[240:243], v11 offset:64
v_mfma_f32_16x16x32_bf16 v[100:103], v[188:191], v[172:175], v[46:49]
ds_read_b128 v[244:247], v11 offset:1088
v_mfma_f32_16x16x32_bf16 v[112:115], v[188:191], v[168:171], v[50:53]
ds_read_b128 v[28:31], v11
v_mfma_f32_16x16x32_bf16 v[96:99], v[184:187], v[168:171], v[46:49]
ds_read_b128 v[32:35], v11 offset:1024
v_max3_f32 v88, v104, v105, v106
v_mfma_f32_16x16x32_bf16 v[108:111], v[184:187], v[164:167], v[50:53]
v_max3_f32 v89, v107, v120, v121
v_max3_f32 v88, v88, v122, v123
v_mfma_f32_16x16x32_bf16 v[92:95], v[180:183], v[164:167], v[54:57]
v_max_f32 v90, v88, v89
v_max_f32 v89, v88, v89
MAA 132,8,96
s_nop 0
v_permlane16_swap_b32 v90, v89
MAA 132,28,100
v_max_f32 v88, v90, v89
v_max_f32 v89, v90, v89
MAA 132,48,160
s_nop 0
v_permlane32_swap_b32 v88, v89
MAA 132,68,164
v_max_f32 v88, v88, v89
v_mul_f32 v88, v88, v234
MAA 148,68,172
v_max3_f32 v84, v100, v101, v102
v_max3_f32 v85, v103, v116, v117
MAA 148,48,168
v_max3_f32 v84, v84, v118, v119
v_max_f32 v86, v84, v85
MAA 148,28,124
v_max_f32 v85, v84, v85
v_max3_f32 v80, v96, v97, v98
MAA 148,8,120
v_permlane16_swap_b32 v86, v85
v_max3_f32 v81, v99, v112, v113
v_max_f32 v84, v86, v85
v_max_f32 v85, v86, v85
v_max3_f32 v80, v80, v114, v115
v_max_f32 v82, v80, v81
v_permlane32_swap_b32 v84, v85
v_max_f32 v81, v80, v81
v_max_f32 v84, v84, v85
v_mul_f32 v84, v84, v230
v_permlane16_swap_b32 v82, v81
v_max3_f32 v76, v92, v93, v94
v_max_f32 v80, v82, v81
v_max_f32 v81, v82, v81
v_max3_f32 v77, v95, v108, v109
v_max3_f32 v76, v76, v110, v111
v_permlane32_swap_b32 v80, v81
v_max_f32 v78, v76, v77
v_max_f32 v80, v80, v81
v_mul_f32 v80, v80, v226
v_max_f32 v77, v76, v77
v_pk_fma_f32 v[104:105], v[104:105], v[234:235], v[88:89] op_sel_hi:[1,0,0] neg_lo:[0,0,1] neg_hi:[0,0,1]
v_pk_fma_f32 v[106:107], v[106:107], v[234:235], v[88:89] op_sel_hi:[1,0,0] neg_lo:[0,0,1] neg_hi:[0,0,1]
v_permlane16_swap_b32 v78, v77
v_pk_fma_f32 v[120:121], v[120:121], v[234:235], v[88:89] op_sel_hi:[1,0,0] neg_lo:[0,0,1] neg_hi:[0,0,1]
v_max_f32 v76, v78, v77
v_max_f32 v77, v78, v77
v_pk_fma_f32 v[122:123], v[122:123], v[234:235], v[88:89] op_sel_hi:[1,0,0] neg_lo:[0,0,1] neg_hi:[0,0,1]
v_pk_fma_f32 v[100:101], v[100:101], v[230:231], v[84:85] op_sel_hi:[1,0,0] neg_lo:[0,0,1] neg_hi:[0,0,1]
v_permlane32_swap_b32 v76, v77
v_pk_fma_f32 v[102:103], v[102:103], v[230:231], v[84:85] op_sel_hi:[1,0,0] neg_lo:[0,0,1] neg_hi:[0,0,1]
v_max_f32 v76, v76, v77
v_mul_f32 v76, v76, v222
v_pk_fma_f32 v[116:117], v[116:117], v[230:231], v[84:85] op_sel_hi:[1,0,0] neg_lo:[0,0,1] neg_hi:[0,0,1]
v_pk_fma_f32 v[118:119], v[118:119], v[230:231], v[84:85] op_sel_hi:[1,0,0] neg_lo:[0,0,1] neg_hi:[0,0,1]
v_pk_fma_f32 v[96:97], v[96:97], v[226:227], v[80:81] op_sel_hi:[1,0,0] neg_lo:[0,0,1] neg_hi:[0,0,1]
v_pk_fma_f32 v[98:99], v[98:99], v[226:227], v[80:81] op_sel_hi:[1,0,0] neg_lo:[0,0,1] neg_hi:[0,0,1]
v_pk_fma_f32 v[112:113], v[112:113], v[226:227], v[80:81] op_sel_hi:[1,0,0] neg_lo:[0,0,1] neg_hi:[0,0,1]
v_pk_fma_f32 v[114:115], v[114:115], v[226:227], v[80:81] op_sel_hi:[1,0,0] neg_lo:[0,0,1] neg_hi:[0,0,1]
v_pk_fma_f32 v[92:93], v[92:93], v[222:223], v[76:77] op_sel_hi:[1,0,0] neg_lo:[0,0,1] neg_hi:[0,0,1]
v_pk_fma_f32 v[94:95], v[94:95], v[222:223], v[76:77] op_sel_hi:[1,0,0] neg_lo:[0,0,1] neg_hi:[0,0,1]
v_pk_fma_f32 v[108:109], v[108:109], v[222:223], v[76:77] op_sel_hi:[1,0,0] neg_lo:[0,0,1] neg_hi:[0,0,1]
v_pk_fma_f32 v[110:111], v[110:111], v[222:223], v[76:77] op_sel_hi:[1,0,0] neg_lo:[0,0,1] neg_hi:[0,0,1]
v_pk_fma_f32 v[132:133], v[18:19], v[44:45], v[132:133] op_sel_hi:[1,0,1]
v_pk_mul_f32 v[132:133], v[132:133], v[22:23]
v_pk_fma_f32 v[134:135], v[20:21], v[44:45], v[134:135] op_sel_hi:[1,0,1]
v_pk_mul_f32 v[134:135], v[134:135], v[24:25]
v_pk_fma_f32 v[148:149], v[18:19], v[44:45], v[148:149] op_sel:[0,1,0] op_sel_hi:[1,1,1]
v_pk_mul_f32 v[148:149], v[148:149], v[22:23]
v_pk_fma_f32 v[150:151], v[20:21], v[44:45], v[150:151] op_sel:[0,1,0] op_sel_hi:[1,1,1]
v_pk_mul_f32 v[150:151], v[150:151], v[24:25]
v_exp_f32 v104, v104
s_nop 0
MAA 128,4,96
v_exp_f32 v105, v105
MAA 128,24,100
v_exp_f32 v106, v106
MAA 128,44,160
v_exp_f32 v107, v107
MAA 128,64,164
v_exp_f32 v120, v120
MAA 144,64,172
v_exp_f32 v121, v121
MAA 144,44,168
v_exp_f32 v122, v122
MAA 144,24,124
v_exp_f32 v123, v123
MAA 144,4,120
v_exp_f32 v100, v100
MAA 124,0,96
v_exp_f32 v101, v101
MAA 124,20,100
v_exp_f32 v102, v102
MAA 124,40,160
v_exp_f32 v103, v103
MAA 124,60,164
v_exp_f32 v116, v116
MAA 140,60,172
v_exp_f32 v117, v117
MAA 140,40,168
v_exp_f32 v118, v118
MAA 140,20,124
v_exp_f32 v119, v119
MAA 140,0,120
v_cvt_pk_bf16_f32 v72, v104, v105
v_cvt_pk_bf16_f32 v73, v106, v107
v_cvt_pk_bf16_f32 v74, v120, v121
v_cvt_pk_bf16_f32 v75, v122, v123
v_cvt_pk_bf16_f32 v68, v100, v101
v_cvt_pk_bf16_f32 v69, v102, v103
v_cvt_pk_bf16_f32 v70, v116, v117
v_cvt_pk_bf16_f32 v71, v118, v119
v_exp_f32 v96, v96
v_exp_f32 v97, v97
v_exp_f32 v98, v98
v_exp_f32 v99, v99
v_exp_f32 v112, v112
v_exp_f32 v113, v113
v_exp_f32 v114, v114
v_exp_f32 v115, v115
v_cvt_pk_bf16_f32 v64, v96, v97
v_cvt_pk_bf16_f32 v65, v98, v99
v_cvt_pk_bf16_f32 v66, v112, v113
v_cvt_pk_bf16_f32 v67, v114, v115
v_cvt_pk_bf16_f32 v206, v132, v133
v_cvt_pk_bf16_f32 v207, v134, v135
v_cvt_pk_bf16_f32 v216, v148, v149
v_cvt_pk_bf16_f32 v217, v150, v151
s_waitcnt lgkmcnt(3)
v_pk_fma_f32 v[128:129], v[240:241], v[44:45], v[128:129] op_sel_hi:[1,0,1]
s_waitcnt lgkmcnt(2)
v_pk_mul_f32 v[128:129], v[128:129], v[244:245]
v_cvt_pk_bf16_f32 v204, v128, v129
v_pk_fma_f32 v[130:131], v[242:243], v[44:45], v[130:131] op_sel_hi:[1,0,1]
v_pk_mul_f32 v[130:131], v[130:131], v[246:247]
v_cvt_pk_bf16_f32 v205, v130, v131
v_pk_fma_f32 v[144:145], v[240:241], v[44:45], v[144:145] op_sel:[0,1,0] op_sel_hi:[1,1,1]
v_pk_mul_f32 v[144:145], v[144:145], v[244:245]
v_cvt_pk_bf16_f32 v214, v144, v145
v_pk_fma_f32 v[146:147], v[242:243], v[44:45], v[146:147] op_sel:[0,1,0] op_sel_hi:[1,1,1]
v_pk_mul_f32 v[146:147], v[146:147], v[246:247]
v_cvt_pk_bf16_f32 v215, v146, v147
s_waitcnt lgkmcnt(1)
v_pk_fma_f32 v[124:125], v[28:29], v[44:45], v[124:125] op_sel_hi:[1,0,1]
s_waitcnt lgkmcnt(0)
v_pk_mul_f32 v[124:125], v[124:125], v[32:33]
v_cvt_pk_bf16_f32 v202, v124, v125
v_pk_fma_f32 v[126:127], v[30:31], v[44:45], v[126:127] op_sel_hi:[1,0,1]
v_pk_mul_f32 v[126:127], v[126:127], v[34:35]
v_cvt_pk_bf16_f32 v203, v126, v127
v_pk_fma_f32 v[140:141], v[28:29], v[44:45], v[140:141] op_sel:[0,1,0] op_sel_hi:[1,1,1]
v_pk_mul_f32 v[140:141], v[140:141], v[32:33]
v_cvt_pk_bf16_f32 v212, v140, v141
v_pk_fma_f32 v[142:143], v[30:31], v[44:45], v[142:143] op_sel:[0,1,0] op_sel_hi:[1,1,1]
v_pk_mul_f32 v[142:143], v[142:143], v[34:35]
v_cvt_pk_bf16_f32 v213, v142, v143
s_nop 0
v_mfma_f32_16x16x32_bf16 v[88:91], v[248:251], v[72:75], 0
v_exp_f32 v92, v92
v_mfma_f32_16x16x32_bf16 v[104:107], v[206:209], v[72:75], 0
v_exp_f32 v93, v93
v_mfma_f32_16x16x32_bf16 v[120:123], v[216:219], v[72:75], 0
v_exp_f32 v94, v94
v_mfma_f32_16x16x32_bf16 v[84:87], v[248:251], v[68:71], 0
v_exp_f32 v95, v95
v_mfma_f32_16x16x32_bf16 v[100:103], v[204:207], v[68:71], 0
v_exp_f32 v108, v108
v_mfma_f32_16x16x32_bf16 v[116:119], v[214:217], v[68:71], 0
v_exp_f32 v109, v109
v_mfma_f32_16x16x32_bf16 v[80:83], v[248:251], v[64:67], 0
v_exp_f32 v110, v110
v_mfma_f32_16x16x32_bf16 v[96:99], v[202:205], v[64:67], 0
v_exp_f32 v111, v111
v_mfma_f32_16x16x32_bf16 v[112:115], v[212:215], v[64:67], 0
v_cvt_pk_bf16_f32 v60, v92, v93
v_cvt_pk_bf16_f32 v61, v94, v95
v_cvt_pk_bf16_f32 v62, v108, v109
v_cvt_pk_bf16_f32 v63, v110, v111
v_rcp_f32 v88, v88
v_rcp_f32 v84, v84
v_mfma_f32_16x16x32_bf16 v[76:79], v[248:251], v[60:63], 0
v_rcp_f32 v80, v80
v_mfma_f32_16x16x32_bf16 v[92:95], v[200:203], v[60:63], 0
v_mfma_f32_16x16x32_bf16 v[108:111], v[210:213], v[60:63], 0
s_nop 4
v_rcp_f32 v76, v76
v_pk_mul_f32 v[104:105], v[104:105], v[88:89] op_sel_hi:[1,0]
v_pk_mul_f32 v[106:107], v[106:107], v[88:89] op_sel_hi:[1,0]
v_pk_mul_f32 v[120:121], v[120:121], v[88:89] op_sel_hi:[1,0]
v_pk_mul_f32 v[122:123], v[122:123], v[88:89] op_sel_hi:[1,0]
v_cvt_pk_bf16_f32 v176, v104, v105
v_cvt_pk_bf16_f32 v177, v106, v107
v_cvt_pk_bf16_f32 v178, v120, v121
v_cvt_pk_bf16_f32 v179, v122, v123
buffer_store_dwordx4 v[176:179], v4, s[16:19], s74 offen offset:3072 sc1
v_pk_mul_f32 v[100:101], v[100:101], v[84:85] op_sel_hi:[1,0]
v_pk_mul_f32 v[102:103], v[102:103], v[84:85] op_sel_hi:[1,0]
v_pk_mul_f32 v[116:117], v[116:117], v[84:85] op_sel_hi:[1,0]
v_pk_mul_f32 v[118:119], v[118:119], v[84:85] op_sel_hi:[1,0]
v_cvt_pk_bf16_f32 v172, v100, v101
v_cvt_pk_bf16_f32 v173, v102, v103
v_cvt_pk_bf16_f32 v174, v116, v117
v_cvt_pk_bf16_f32 v175, v118, v119
buffer_store_dwordx4 v[172:175], v4, s[16:19], s74 offen offset:2048 sc1
v_pk_mul_f32 v[96:97], v[96:97], v[80:81] op_sel_hi:[1,0]
v_pk_mul_f32 v[98:99], v[98:99], v[80:81] op_sel_hi:[1,0]
v_pk_mul_f32 v[112:113], v[112:113], v[80:81] op_sel_hi:[1,0]
v_pk_mul_f32 v[114:115], v[114:115], v[80:81] op_sel_hi:[1,0]
v_cvt_pk_bf16_f32 v168, v96, v97
v_cvt_pk_bf16_f32 v169, v98, v99
v_cvt_pk_bf16_f32 v170, v112, v113
v_cvt_pk_bf16_f32 v171, v114, v115
buffer_store_dwordx4 v[168:171], v4, s[16:19], s74 offen offset:1024 sc1
v_pk_mul_f32 v[92:93], v[92:93], v[76:77] op_sel_hi:[1,0]
v_pk_mul_f32 v[94:95], v[94:95], v[76:77] op_sel_hi:[1,0]
v_pk_mul_f32 v[108:109], v[108:109], v[76:77] op_sel_hi:[1,0]
v_pk_mul_f32 v[110:111], v[110:111], v[76:77] op_sel_hi:[1,0]
v_cvt_pk_bf16_f32 v164, v92, v93
v_cvt_pk_bf16_f32 v165, v94, v95
v_cvt_pk_bf16_f32 v166, v108, v109
v_cvt_pk_bf16_f32 v167, v110, v111
buffer_store_dwordx4 v[164:167], v4, s[16:19], s74 offen sc1
s_nop 1
s_branch .Lqkve2
.Lx4:
buffer_load_dword v27, v14, s[76:79], 0 offen
s_mov_b32 s76, s98
s_mov_b32 s77, s99
s_mov_b32 s78, s100
v_mov_b32 v14, v15
s_mov_b32 s47, 5
s_branch .Lx4b
.Lx5:
buffer_load_dword v27, v14, s[76:79], 0 offen
s_mov_b32 s76, s98
s_mov_b32 s77, s99
s_mov_b32 s78, s100
v_mov_b32 v14, v15
s_mov_b32 s47, 5
s_branch .Lx5b
.Lx6:
buffer_load_dword v27, v14, s[76:79], 0 offen
s_mov_b32 s76, s98
s_mov_b32 s77, s99
s_mov_b32 s78, s100
v_mov_b32 v14, v15
s_mov_b32 s47, 5
s_branch .Lx6b
.Lx7:
buffer_load_dword v27, v14, s[76:79], 0 offen
s_mov_b32 s76, s98
s_mov_b32 s77, s99
s_mov_b32 s78, s100
v_mov_b32 v14, v15
s_mov_b32 s47, 5
s_branch .Lx7b
.Lsp8:
s_mov_b32 s15, 0
.Lsp8l:
v_mov_b32 v37, 0
buffer_atomic_add v37, v34, s[40:43], 0 offen sc0
s_add_u32 s15, s15, 1
s_cmp_gt_u32 s15, 100000
s_waitcnt vmcnt(0)
s_cbranch_scc1 .Lsp8b
v_cmp_gt_u32 vcc, v35, v37
s_nop 0
s_cbranch_vccnz .Lsp8l
s_branch .Lsp8b
.Lx9:
buffer_load_dword v27, v14, s[76:79], 0 offen
s_mov_b32 s76, s98
s_mov_b32 s77, s99
s_mov_b32 s78, s100
v_mov_b32 v14, v15
s_mov_b32 s47, 5
s_branch .Lx9b
.Lx10:
buffer_load_dword v27, v14, s[76:79], 0 offen
s_mov_b32 s76, s98
s_mov_b32 s77, s99
s_mov_b32 s78, s100
v_mov_b32 v14, v15
s_mov_b32 s47, 5
s_branch .Lx10b
.Lx11:
buffer_load_dword v27, v14, s[76:79], 0 offen
s_mov_b32 s76, s98
s_mov_b32 s77, s99
s_mov_b32 s78, s100
v_mov_b32 v14, v15
s_mov_b32 s47, 5
s_branch .Lx11b
.Lx12:
buffer_load_dword v27, v14, s[76:79], 0 offen
s_mov_b32 s76, s98
s_mov_b32 s77, s99
s_mov_b32 s78, s100
v_mov_b32 v14, v15
s_mov_b32 s47, 5
s_branch .Lx12b
.Lsp13:
s_mov_b32 s15, 0
.Lsp13l:
v_mov_b32 v37, 0
buffer_atomic_add v37, v33, s[16:19], 0 offen sc0
s_add_u32 s15, s15, 1
s_cmp_gt_u32 s15, 100000
s_waitcnt vmcnt(0)
s_cbranch_scc1 .Lsp13b
v_cmp_gt_u32 vcc, v36, v37
s_nop 0
s_cbranch_vccnz .Lsp13l
s_branch .Lsp13b
.Lx14:
buffer_load_dword v27, v14, s[76:79], 0 offen
s_mov_b32 s76, s98
s_mov_b32 s77, s99
s_mov_b32 s78, s100
v_mov_b32 v14, v15
s_mov_b32 s47, 5
s_branch .Lx14b
.Lx15:
buffer_load_dword v27, v14, s[76:79], 0 offen
s_mov_b32 s76, s98
s_mov_b32 s77, s99
s_mov_b32 s78, s100
v_mov_b32 v14, v15
s_mov_b32 s47, 5
s_branch .Lx15b
.Lx16:
buffer_load_dword v27, v14, s[76:79], 0 offen
s_mov_b32 s76, s98
s_mov_b32 s77, s99
s_mov_b32 s78, s100
v_mov_b32 v14, v15
s_mov_b32 s47, 5
s_branch .Lx16b
.Lx17:
buffer_load_dword v27, v14, s[76:79], 0 offen
s_mov_b32 s76, s98
s_mov_b32 s77, s99
s_mov_b32 s78, s100
v_mov_b32 v14, v15
s_mov_b32 s47, 5
s_branch .Lx17b
.Lx19:
buffer_load_dword v27, v14, s[76:79], 0 offen
s_mov_b32 s76, s98
s_mov_b32 s77, s99
s_mov_b32 s78, s100
v_mov_b32 v14, v15
s_mov_b32 s47, 5
s_branch .Lx19b
.Lx20:
buffer_load_dword v27, v14, s[76:79], 0 offen
s_mov_b32 s76, s98
s_mov_b32 s77, s99
s_mov_b32 s78, s100
v_mov_b32 v14, v15
s_mov_b32 s47, 5
s_branch .Lx20b
.Lx21:
buffer_load_dword v27, v14, s[76:79], 0 offen
s_mov_b32 s76, s98
s_mov_b32 s77, s99
s_mov_b32 s78, s100
v_mov_b32 v14, v15
s_mov_b32 s47, 5
s_branch .Lx21b
.Lx22:
buffer_load_dword v27, v14, s[76:79], 0 offen
s_mov_b32 s76, s98
s_mov_b32 s77, s99
s_mov_b32 s78, s100
v_mov_b32 v14, v15
s_mov_b32 s47, 5
s_branch .Lx22b
.Lsp23:
s_mov_b32 s15, 0
.Lsp23l:
v_mov_b32 v37, 0
buffer_atomic_add v37, v34, s[40:43], 0 offen sc0
s_add_u32 s15, s15, 1
s_cmp_gt_u32 s15, 100000
s_waitcnt vmcnt(0)
s_cbranch_scc1 .Lsp23b
v_cmp_gt_u32 vcc, v35, v37
s_nop 0
s_cbranch_vccnz .Lsp23l
s_branch .Lsp23b
.Lx24:
buffer_load_dword v27, v14, s[76:79], 0 offen
s_mov_b32 s76, s98
s_mov_b32 s77, s99
s_mov_b32 s78, s100
v_mov_b32 v14, v15
s_mov_b32 s47, 5
s_branch .Lx24b
.Lx25:
buffer_load_dword v27, v14, s[76:79], 0 offen
s_mov_b32 s76, s98
s_mov_b32 s77, s99
s_mov_b32 s78, s100
v_mov_b32 v14, v15
s_mov_b32 s47, 5
s_branch .Lx25b
.Lx26:
buffer_load_dword v27, v14, s[76:79], 0 offen
s_mov_b32 s76, s98
s_mov_b32 s77, s99
s_mov_b32 s78, s100
v_mov_b32 v14, v15
s_mov_b32 s47, 5
s_branch .Lx26b
.Lx27:
buffer_load_dword v27, v14, s[76:79], 0 offen
s_mov_b32 s76, s98
s_mov_b32 s77, s99
s_mov_b32 s78, s100
v_mov_b32 v14, v15
s_mov_b32 s47, 5
s_branch .Lx27b
.Lsp28:
s_mov_b32 s15, 0
.Lsp28l:
v_mov_b32 v37, 0
buffer_atomic_add v37, v33, s[16:19], 0 offen sc0
s_add_u32 s15, s15, 1
s_cmp_gt_u32 s15, 100000
s_waitcnt vmcnt(0)
s_cbranch_scc1 .Lsp28b
v_cmp_gt_u32 vcc, v36, v37
s_nop 0
s_cbranch_vccnz .Lsp28l
s_branch .Lsp28b
.Lx29:
buffer_load_dword v27, v14, s[76:79], 0 offen
s_mov_b32 s76, s98
s_mov_b32 s77, s99
s_mov_b32 s78, s100
v_mov_b32 v14, v15
s_mov_b32 s47, 5
s_branch .Lx29b
.Lx30:
buffer_load_dword v27, v14, s[76:79], 0 offen
s_mov_b32 s76, s98
s_mov_b32 s77, s99
s_mov_b32 s78, s100
v_mov_b32 v14, v15
s_mov_b32 s47, 5
s_branch .Lx30b
.Lx31:
buffer_load_dword v27, v14, s[76:79], 0 offen
s_mov_b32 s76, s98
s_mov_b32 s77, s99
s_mov_b32 s78, s100
v_mov_b32 v14, v15
s_mov_b32 s47, 5
s_branch .Lx31b
.Lx32:
buffer_load_dword v27, v14, s[76:79], 0 offen
s_mov_b32 s76, s98
s_mov_b32 s77, s99
s_mov_b32 s78, s100
v_mov_b32 v14, v15
s_mov_b32 s47, 5
s_branch .Lx32b
.p2align 12
.Lqkv1:
.Lpad5:
s_cbranch_execz .Lpad9
s_cmp_lt_u32 s14, 16
s_cselect_b32 s62, 0, 4096
v_mov_b32 v231, 1
v_lshlrev_b32 v232, 8, v1
s_waitcnt vmcnt(16)
v_permlane16_swap_b32 v164, v166
v_permlane16_swap_b32 v165, v167
s_waitcnt vmcnt(15)
v_permlane16_swap_b32 v168, v170
v_permlane16_swap_b32 v169, v171
s_waitcnt vmcnt(14)
v_permlane16_swap_b32 v172, v174
v_permlane16_swap_b32 v173, v175
s_waitcnt vmcnt(13)
v_permlane16_swap_b32 v176, v178
v_permlane16_swap_b32 v177, v179
buffer_atomic_add v231, v232, s[40:43], s62 offen
s_add_u32 m0, s55, 18496
s_nop 0
buffer_load_dwordx4 v21, s[36:39], s52 offen lds
v_lshlrev_b32 v192, 16, v164
v_and_b32 v193, 0xffff0000, v164
v_lshlrev_b32 v194, 16, v165
v_and_b32 v195, 0xffff0000, v165
v_lshlrev_b32 v196, 16, v166
v_and_b32 v197, 0xffff0000, v166
v_lshlrev_b32 v198, 16, v167
buffer_load_dwordx4 v28, s[36:39], s52 offen offset:1024 lds
v_and_b32 v199, 0xffff0000, v167
v_lshlrev_b32 v200, 16, v168
v_and_b32 v201, 0xffff0000, v168
v_lshlrev_b32 v202, 16, v169
v_and_b32 v203, 0xffff0000, v169
v_lshlrev_b32 v204, 16, v170
v_and_b32 v205, 0xffff0000, v170
buffer_load_dword v22, s[36:39], s52 offen offset:2048 lds
s_add_u32 s52, s52, 128
v_lshlrev_b32 v206, 16, v171
v_and_b32 v207, 0xffff0000, v171
v_lshlrev_b32 v208, 16, v172
v_and_b32 v209, 0xffff0000, v172
v_lshlrev_b32 v210, 16, v173
v_and_b32 v211, 0xffff0000, v173
v_lshlrev_b32 v212, 16, v174
s_add_u32 m0, s55, 20800
s_nop 0
buffer_load_dwordx4 v21, s[36:39], s53 offen lds
v_and_b32 v213, 0xffff0000, v174
v_lshlrev_b32 v214, 16, v175
v_and_b32 v215, 0xffff0000, v175
v_lshlrev_b32 v216, 16, v176
v_and_b32 v217, 0xffff0000, v176
v_lshlrev_b32 v218, 16, v177
v_and_b32 v219, 0xffff0000, v177
buffer_load_dwordx4 v28, s[36:39], s53 offen offset:1024 lds
v_lshlrev_b32 v220, 16, v178
v_and_b32 v221, 0xffff0000, v178
v_lshlrev_b32 v222, 16, v179
v_and_b32 v223, 0xffff0000, v179
s_lshl_b32 s64, s6, 14
s_lshl_b32 s65, s49, 13
s_add_u32 s64, s64, s65
buffer_load_dword v29, s[36:39], s53 offen offset:2048 lds
s_add_u32 s53, s53, 128
s_lshl_b32 s65, s7, 9
s_add_u32 s64, s64, s65
s_lshl_b32 s65, s48, 8
s_add_u32 s64, s64, s65
s_add_u32 s64, s64, 29360128
v_and_b32 v188, 31, v1
v_lshlrev_b32 v188, 3, v188
s_add_u32 m0, s56, 73984
s_nop 0
buffer_load_dwordx4 v18, s[20:23], s54 offen lds
v_lshrrev_b32 v189, 5, v1
v_lshl_add_u32 v188, v189, 28, v188
s_lshl_b32 s62, s7, 18
s_add_u32 s62, s62, 0
s_add_u32 s63, s62, 131072
v_pk_mul_f32 v[182:183], v[192:193], v[192:193]
v_pk_mul_f32 v[186:187], v[208:209], v[208:209]
buffer_load_dwordx4 v19, s[20:23], s54 offen offset:1024 lds
v_pk_fma_f32 v[182:183], v[194:195], v[194:195], v[182:183]
v_pk_add_f32 v[180:181], v[192:193], v[194:195]
v_pk_fma_f32 v[186:187], v[210:211], v[210:211], v[186:187]
v_pk_add_f32 v[184:185], v[208:209], v[210:211]
v_pk_fma_f32 v[182:183], v[196:197], v[196:197], v[182:183]
v_pk_add_f32 v[180:181], v[180:181], v[196:197]
v_pk_fma_f32 v[186:187], v[212:213], v[212:213], v[186:187]
buffer_load_dwordx4 v20, s[20:23], s54 offen offset:2048 lds
s_add_u32 s54, s54, 196608
v_pk_add_f32 v[184:185], v[184:185], v[212:213]
v_pk_fma_f32 v[182:183], v[198:199], v[198:199], v[182:183]
v_pk_add_f32 v[180:181], v[180:181], v[198:199]
v_pk_fma_f32 v[186:187], v[214:215], v[214:215], v[186:187]
v_pk_add_f32 v[184:185], v[184:185], v[214:215]
v_pk_fma_f32 v[182:183], v[200:201], v[200:201], v[182:183]
v_pk_add_f32 v[180:181], v[180:181], v[200:201]
s_add_u32 m0, s56, 86400
s_nop 0
buffer_load_dwordx4 v18, s[20:23], s54 offen lds
v_pk_fma_f32 v[186:187], v[216:217], v[216:217], v[186:187]
v_pk_add_f32 v[184:185], v[184:185], v[216:217]
v_pk_fma_f32 v[182:183], v[202:203], v[202:203], v[182:183]
v_pk_add_f32 v[180:181], v[180:181], v[202:203]
v_pk_fma_f32 v[186:187], v[218:219], v[218:219], v[186:187]
v_pk_add_f32 v[184:185], v[184:185], v[218:219]
v_pk_fma_f32 v[182:183], v[204:205], v[204:205], v[182:183]
buffer_load_dwordx4 v19, s[20:23], s54 offen offset:1024 lds
v_pk_add_f32 v[180:181], v[180:181], v[204:205]
v_pk_fma_f32 v[186:187], v[220:221], v[220:221], v[186:187]
v_pk_add_f32 v[184:185], v[184:185], v[220:221]
v_pk_fma_f32 v[182:183], v[206:207], v[206:207], v[182:183]
v_pk_add_f32 v[180:181], v[180:181], v[206:207]
v_pk_fma_f32 v[186:187], v[222:223], v[222:223], v[186:187]
v_pk_add_f32 v[184:185], v[184:185], v[222:223]
buffer_load_dwordx4 v20, s[20:23], s54 offen offset:2048 lds
s_add_u32 s54, s54, 196608
v_add_f32 v180, v180, v181
v_add_f32 v182, v182, v183
v_add_f32 v184, v184, v185
v_add_f32 v186, v186, v187
s_nop 0
v_permlane16_swap_b32 v180, v184
v_permlane16_swap_b32 v182, v186
v_add_f32 v180, v180, v184
v_add_f32 v182, v182, v186
s_nop 1
v_permlane32_swap_b32 v180, v182
v_add_f32 v180, v180, v182
s_nop 1
v_permlane32_swap_b32 v180, v181
buffer_store_dwordx2 v[180:181], v188, s[16:19], s64 offen sc1
s_lshl_b32 s62, s2, 10
s_add_u32 s62, s62, 31457280
s_cmp_eq_u32 s3, 0
s_cselect_b32 s62, s62, 268435456
buffer_store_dwordx4 v[224:227], v230, s[16:19], s62 offen sc1
s_waitcnt vmcnt(15) lgkmcnt(0)
s_barrier
ds_read_b128 a[0:3], v23
RD 4,23,2304
RD 8,23,4608
RD 12,23,6912
ds_read_b128 a[16:19], v24
ds_read_b128 a[20:23], v30
RD 24,30,2304
RD 28,30,4608
RD 32,30,6912
ds_read_b128 a[36:39], v31
TR 80,25,49664
TR 82,25,50176
TR 84,25,62080
TR 86,25,62592
TR 88,25,50688
TR 90,25,51200
TR 92,25,63104
TR 94,25,63616
TR 96,25,51712
TR 98,25,52224
TR 100,25,64128
TR 102,25,64640
s_waitcnt vmcnt(8) lgkmcnt(0)
s_barrier
v_mfma_f32_16x16x32_bf16 v[60:63], a[80:83], a[0:3], 0
TR 104,25,49696
s_add_u32 m0, s55, 36992
MAA 60,84,20
buffer_load_dwordx4 v21, s[36:39], s52 offen lds
v_mfma_f32_16x16x32_bf16 v[64:67], a[80:83], a[4:7], 0
s_sub_u32 s47, s47, 1
s_cbranch_scc1 .Lx19
.Lx19b:
MAA 64,84,24
buffer_load_dwordx4 v28, s[36:39], s52 offen offset:1024 lds
v_mfma_f32_16x16x32_bf16 v[68:71], a[80:83], a[8:11], 0
TR 106,25,50208
MAA 68,84,28
TR 108,25,62112
TR 110,25,62624
TR 112,25,50720
v_mfma_f32_16x16x32_bf16 v[72:75], a[80:83], a[12:15], 0
TR 114,25,51232
MAA 72,84,32
TR 116,25,63136
TR 118,25,63648
v_mfma_f32_16x16x32_bf16 v[104:107], a[88:91], a[12:15], 0
TR 120,25,51744
MAA 104,92,32
buffer_load_dword v22, s[36:39], s52 offen offset:2048 lds
v_mfma_f32_16x16x32_bf16 v[100:103], a[88:91], a[8:11], 0
s_add_u32 s52, s52, 128
s_add_u32 m0, s55, 39296
MAA 100,92,28
buffer_load_dwordx4 v21, s[36:39], s53 offen lds
v_mfma_f32_16x16x32_bf16 v[96:99], a[88:91], a[4:7], 0
TR 122,25,52256
MAA 96,92,24
buffer_load_dwordx4 v28, s[36:39], s53 offen offset:1024 lds
v_mfma_f32_16x16x32_bf16 v[92:95], a[88:91], a[0:3], 0
TR 124,25,64160
MAA 92,92,20
buffer_load_dword v29, s[36:39], s53 offen offset:2048 lds
v_mfma_f32_16x16x32_bf16 v[124:127], a[0:3], a[96:99], 0
s_add_u32 s53, s53, 128
s_add_u32 m0, s56, 98816
MAA 124,20,100
buffer_load_dwordx4 v18, s[20:23], s54 offen lds
v_mfma_f32_16x16x32_bf16 v[128:131], a[4:7], a[96:99], 0
TR 126,25,64672
MAA 128,24,100
buffer_load_dwordx4 v19, s[20:23], s54 offen offset:1024 lds
v_mfma_f32_16x16x32_bf16 v[132:135], a[8:11], a[96:99], 0
RD 40,23,18496
MAA 132,28,100
RD 44,23,20800
RD 48,23,23104
RD 52,23,25408
v_mfma_f32_16x16x32_bf16 v[136:139], a[12:15], a[96:99], 0
RD 56,24,18496
MAA 136,32,100
buffer_load_dwordx4 v20, s[20:23], s54 offen offset:2048 lds
v_mfma_f32_16x16x32_bf16 v[156:159], a[16:19], a[96:99], 0
s_add_u32 s54, s54, 196608
MAA 156,36,100
s_waitcnt vmcnt(11) lgkmcnt(5)
s_barrier
v_mfma_f32_16x16x32_bf16 v[76:79], a[104:107], a[0:3], 0
RD 60,30,18496
s_add_u32 m0, s56, 111232
MAA 76,108,20
buffer_load_dwordx4 v18, s[20:23], s54 offen lds
v_mfma_f32_16x16x32_bf16 v[80:83], a[104:107], a[4:7], 0
RD 64,30,20800
MAA 80,108,24
buffer_load_dwordx4 v19, s[20:23], s54 offen offset:1024 lds
v_mfma_f32_16x16x32_bf16 v[84:87], a[104:107], a[8:11], 0
RD 68,30,23104
MAA 84,108,28
RD 72,30,25408
v_mfma_f32_16x16x32_bf16 v[88:91], a[104:107], a[12:15], 0
RD 76,31,18496
MAA 88,108,32
buffer_load_dwordx4 v20, s[20:23], s54 offen offset:2048 lds
v_mfma_f32_16x16x32_bf16 v[244:247], a[104:107], a[16:19], 0
s_add_u32 s54, s54, 196608
s_add_u32 m0, s55, 55488
MAA 244,108,36
buffer_load_dwordx4 v21, s[36:39], s52 offen lds
v_mfma_f32_16x16x32_bf16 v[120:123], a[112:115], a[12:15], 0
ds_read_b64_tr_b16 a[80:81], v25
MAA 120,116,32
TR 82,25,512
v_mfma_f32_16x16x32_bf16 v[116:119], a[112:115], a[8:11], 0
TR 84,25,12416
MAA 116,116,28
buffer_load_dwordx4 v28, s[36:39], s52 offen offset:1024 lds
v_mfma_f32_16x16x32_bf16 v[112:115], a[112:115], a[4:7], 0
TR 86,25,12928
MAA 112,116,24
buffer_load_dword v22, s[36:39], s52 offen offset:2048 lds
v_mfma_f32_16x16x32_bf16 v[108:111], a[112:115], a[0:3], 0
TR 88,25,1024
s_add_u32 s52, s52, 128
MAA 108,116,20
TR 90,25,1536
v_mfma_f32_16x16x32_bf16 v[140:143], a[0:3], a[120:123], 0
TR 92,25,13440
s_add_u32 m0, s55, 57792
MAA 140,20,124
buffer_load_dwordx4 v21, s[36:39], s53 offen lds
v_mfma_f32_16x16x32_bf16 v[144:147], a[4:7], a[120:123], 0
TR 94,25,13952
MAA 144,24,124
buffer_load_dwordx4 v28, s[36:39], s53 offen offset:1024 lds
v_mfma_f32_16x16x32_bf16 v[148:151], a[8:11], a[120:123], 0
TR 96,25,2048
MAA 148,28,124
TR 98,25,2560
v_mfma_f32_16x16x32_bf16 v[152:155], a[12:15], a[120:123], 0
TR 100,25,14464
MAA 152,32,124
buffer_load_dword v29, s[36:39], s53 offen offset:2048 lds
v_mfma_f32_16x16x32_bf16 v[160:163], a[16:19], a[120:123], 0
TR 102,25,14976
s_add_u32 s53, s53, 128
MAA 160,36,124
s_waitcnt vmcnt(12) lgkmcnt(8)
s_barrier
MAA 60,80,40
TR 104,25,32
s_add_u32 m0, s56, 123648
MAA 60,84,60
buffer_load_dwordx4 v18, s[20:23], s54 offen lds
MAA 64,84,64
s_sub_u32 s47, s47, 1
s_cbranch_scc1 .Lx20
.Lx20b:
MAA 64,80,44
buffer_load_dwordx4 v19, s[20:23], s54 offen offset:1024 lds
MAA 68,80,48
TR 106,25,544
MAA 68,84,68
TR 108,25,12448
TR 110,25,12960
TR 112,25,1056
MAA 72,84,72
TR 114,25,1568
MAA 72,80,52
TR 116,25,13472
TR 118,25,13984
s_waitcnt lgkmcnt(8)
MAA 104,88,52
TR 120,25,2080
MAA 104,92,72
buffer_load_dwordx4 v20, s[20:23], s54 offen offset:2048 lds
MAA 100,92,68
s_add_u32 s54, s54, 196608
s_add_u32 m0, s56, 136064
MAA 100,88,48
buffer_load_dwordx4 v18, s[20:23], s54 offen lds
MAA 96,88,44
TR 122,25,2592
MAA 96,92,64
buffer_load_dwordx4 v19, s[20:23], s54 offen offset:1024 lds
MAA 92,92,60
TR 124,25,14496
MAA 92,88,40
buffer_load_dwordx4 v20, s[20:23], s54 offen offset:2048 lds
MAA 124,40,96
s_add_u32 s54, s54, 196608
s_add_u32 m0, s55, 0
MAA 124,60,100
buffer_load_dwordx4 v21, s[36:39], s52 offen lds
MAA 128,64,100
TR 126,25,15008
MAA 128,44,96
buffer_load_dwordx4 v28, s[36:39], s52 offen offset:1024 lds
MAA 132,48,96
RD 0,23,36992
MAA 132,68,100
RD 4,23,39296
RD 8,23,41600
RD 12,23,43904
MAA 136,72,100
RD 16,24,36992
MAA 136,52,96
buffer_load_dword v22, s[36:39], s52 offen offset:2048 lds
MAA 156,56,96
s_add_u32 s52, s52, 128
MAA 156,76,100
s_waitcnt vmcnt(15) lgkmcnt(5)
s_barrier
MAA 76,104,40
RD 20,30,36992
s_add_u32 m0, s55, 2304
MAA 76,108,60
buffer_load_dwordx4 v21, s[36:39], s53 offen lds
MAA 80,108,64
RD 24,30,39296
MAA 80,104,44
buffer_load_dwordx4 v28, s[36:39], s53 offen offset:1024 lds
MAA 84,104,48
RD 28,30,41600
MAA 84,108,68
RD 32,30,43904
RD 36,31,36992
MAA 88,108,72
TR 80,25,24832
MAA 88,104,52
buffer_load_dword v29, s[36:39], s53 offen offset:2048 lds
MAA 244,104,56
s_add_u32 s53, s53, 128
s_add_u32 m0, s56, 73984
MAA 244,108,76
buffer_load_dwordx4 v18, s[20:23], s54 offen lds
MAA 120,116,72
TR 82,25,25344
MAA 120,112,52
buffer_load_dwordx4 v19, s[20:23], s54 offen offset:1024 lds
MAA 116,112,48
TR 84,25,37248
MAA 116,116,68
TR 86,25,37760
TR 88,25,25856
MAA 112,116,64
TR 90,25,26368
MAA 112,112,44
buffer_load_dwordx4 v20, s[20:23], s54 offen offset:2048 lds
MAA 108,112,40
s_add_u32 s54, s54, 196608
s_add_u32 m0, s55, 18496
MAA 108,116,60
buffer_load_dwordx4 v21, s[36:39], s52 offen lds
MAA 140,60,124
TR 92,25,38272
MAA 140,40,120
buffer_load_dwordx4 v28, s[36:39], s52 offen offset:1024 lds
MAA 144,44,120
TR 94,25,38784
MAA 144,64,124
buffer_load_dword v22, s[36:39], s52 offen offset:2048 lds
MAA 148,68,124
TR 96,25,26880
s_add_u32 s52, s52, 128
MAA 148,48,120
TR 98,25,27392
TR 100,25,39296
MAA 152,52,120
TR 102,25,39808
MAA 152,72,124
buffer_load_dword v37, v34, s[40:43], 0 offen sc1
MAA 160,76,124
MAA 160,56,120
s_waitcnt vmcnt(19) lgkmcnt(8)
s_barrier
MAA 60,80,0
TR 104,25,24864
s_add_u32 m0, s56, 86400
MAA 60,84,20
buffer_load_dwordx4 v18, s[20:23], s54 offen lds
MAA 64,84,24
s_sub_u32 s47, s47, 1
s_cbranch_scc1 .Lx21
.Lx21b:
MAA 64,80,4
buffer_load_dwordx4 v19, s[20:23], s54 offen offset:1024 lds
MAA 68,80,8
TR 106,25,25376
MAA 68,84,28
TR 108,25,37280
TR 110,25,37792
TR 112,25,25888
MAA 72,84,32
TR 114,25,26400
MAA 72,80,12
TR 116,25,38304
TR 118,25,38816
s_waitcnt lgkmcnt(8)
MAA 104,88,12
TR 120,25,26912
MAA 104,92,32
buffer_load_dwordx4 v20, s[20:23], s54 offen offset:2048 lds
MAA 100,92,28
s_add_u32 s54, s54, 196608
s_add_u32 m0, s55, 20800
MAA 100,88,8
buffer_load_dwordx4 v21, s[36:39], s53 offen lds
MAA 96,88,4
TR 122,25,27424
MAA 96,92,24
buffer_load_dwordx4 v28, s[36:39], s53 offen offset:1024 lds
MAA 92,92,20
TR 124,25,39328
MAA 92,88,0
buffer_load_dword v29, s[36:39], s53 offen offset:2048 lds
MAA 124,0,96
s_add_u32 s53, s53, 128
s_add_u32 m0, s55, 36992
MAA 124,20,100
buffer_load_dwordx4 v21, s[36:39], s52 offen lds
MAA 128,24,100
TR 126,25,39840
MAA 128,4,96
buffer_load_dwordx4 v28, s[36:39], s52 offen offset:1024 lds
MAA 132,8,96
RD 40,23,55488
MAA 132,28,100
RD 44,23,57792
RD 48,23,60096
RD 52,23,62400
MAA 136,32,100
RD 56,24,55488
MAA 136,12,96
buffer_load_dword v22, s[36:39], s52 offen offset:2048 lds
MAA 156,16,96
s_add_u32 s52, s52, 128
MAA 156,36,100
s_waitcnt vmcnt(22) lgkmcnt(5)
s_barrier
MAA 76,104,0
RD 60,30,55488
MAA 76,108,20
RD 64,30,57792
MAA 80,108,24
RD 68,30,60096
s_add_u32 m0, s56, 98816
MAA 80,104,4
buffer_load_dwordx4 v18, s[20:23], s54 offen lds
MAA 84,104,8
RD 72,30,62400
MAA 84,108,28
RD 76,31,55488
MAA 88,108,32
MAA 88,104,12
buffer_load_dwordx4 v19, s[20:23], s54 offen offset:1024 lds
MAA 244,104,16
TR 80,25,49664
MAA 244,108,36
TR 82,25,50176
MAA 120,116,32
TR 84,25,62080
MAA 120,112,12
buffer_load_dwordx4 v20, s[20:23], s54 offen offset:2048 lds
MAA 116,112,8
TR 86,25,62592
s_add_u32 s54, s54, 196608
MAA 116,116,28
MAA 112,116,24
TR 88,25,50688
MAA 112,112,4
TR 90,25,51200
MAA 108,112,0
TR 92,25,63104
s_add_u32 m0, s55, 39296
MAA 108,116,20
buffer_load_dwordx4 v21, s[36:39], s53 offen lds
MAA 140,20,124
TR 94,25,63616
MAA 140,0,120
MAA 144,4,120
TR 96,25,51712
MAA 144,24,124
buffer_load_dwordx4 v28, s[36:39], s53 offen offset:1024 lds
MAA 148,28,124
TR 98,25,52224
MAA 148,8,120
TR 100,25,64128
MAA 152,12,120
TR 102,25,64640
MAA 152,32,124
buffer_load_dword v29, s[36:39], s53 offen offset:2048 lds
MAA 160,36,124
s_add_u32 s53, s53, 128
MAA 160,16,120
s_waitcnt vmcnt(22) lgkmcnt(8)
s_barrier
MAA 60,80,40
TR 104,25,49696
MAA 60,84,60
TR 106,25,50208
MAA 64,84,64
TR 108,25,62112
s_add_u32 m0, s56, 111232
MAA 64,80,44
buffer_load_dwordx4 v18, s[20:23], s54 offen lds
MAA 68,80,48
s_sub_u32 s47, s47, 1
s_cbranch_scc1 .Lx22
.Lx22b:
MAA 68,84,68
TR 110,25,62624
MAA 72,84,72
TR 112,25,50720
MAA 72,80,52
TR 114,25,51232
s_waitcnt lgkmcnt(6)
MAA 104,88,52
TR 116,25,63136
MAA 104,92,72
buffer_load_dwordx4 v19, s[20:23], s54 offen offset:1024 lds
.Lpad6:
s_cbranch_execz .Lt0r
MAA 100,92,68
TR 118,25,63648
MAA 100,88,48
buffer_load_dwordx4 v20, s[20:23], s54 offen offset:2048 lds
MAA 96,88,44
TR 120,25,51744
s_add_u32 s54, s54, 196608
MAA 96,92,64
TR 122,25,52256
MAA 92,92,60
TR 124,25,64160
s_add_u32 m0, s55, 55488
MAA 92,88,40
buffer_load_dwordx4 v21, s[36:39], s52 offen lds
MAA 124,40,96
TR 126,25,64672
MAA 124,60,100
ds_read_b128 a[0:3], v23
MAA 128,64,100
RD 4,23,2304
MAA 128,44,96
buffer_load_dwordx4 v28, s[36:39], s52 offen offset:1024 lds
MAA 132,48,96
RD 8,23,4608
MAA 132,68,100
RD 12,23,6912
MAA 136,72,100
ds_read_b128 a[16:19], v24
MAA 136,52,96
buffer_load_dword v22, s[36:39], s52 offen offset:2048 lds
MAA 156,56,96
s_add_u32 s52, s52, 128
MAA 156,76,100
s_waitcnt vmcnt(18) lgkmcnt(5)
s_barrier
v_cmp_gt_u32 vcc, v35, v37
s_nop 0
s_cbranch_vccnz .Lsp23
.Lsp23b:
v_mov_b32 v37, 0
MAA 76,104,40
ds_read_b128 a[20:23], v30
MAA 76,108,60
buffer_atomic_add v38, v32, s[16:19], 0 offen
MAA 80,108,64
RD 24,30,2304
MAA 80,104,44
RD 28,30,4608
MAA 84,104,48
RD 32,30,6912
s_add_u32 m0, s56, 123648
MAA 84,108,68
buffer_load_dwordx4 v18, s[20:23], s54 offen lds
MAA 88,108,72
ds_read_b128 a[36:39], v31
MAA 88,104,52
ds_read_b64_tr_b16 a[80:81], v25
MAA 244,104,56
TR 82,25,512
MAA 244,108,76
buffer_load_dwordx4 v19, s[20:23], s54 offen offset:1024 lds
MAA 120,116,72
TR 84,25,12416
MAA 120,112,52
TR 86,25,12928
MAA 116,112,48
MAA 116,116,68
buffer_load_dwordx4 v20, s[20:23], s54 offen offset:2048 lds
MAA 112,116,64
s_add_u32 s54, s54, 196608
s_add_u32 m0, s55, 57792
MAA 112,112,44
buffer_load_dwordx4 v21, s[36:39], s53 offen lds
MAA 108,112,40
TR 88,25,1024
MAA 108,116,60
TR 90,25,1536
MAA 140,60,124
TR 92,25,13440
MAA 140,40,120
buffer_load_dwordx4 v28, s[36:39], s53 offen offset:1024 lds
MAA 144,44,120
TR 94,25,13952
MAA 144,64,124
TR 96,25,2048
MAA 148,68,124
TR 98,25,2560
MAA 148,48,120
buffer_load_dword v29, s[36:39], s53 offen offset:2048 lds
MAA 152,52,120
TR 100,25,14464
s_add_u32 s53, s53, 128
MAA 152,72,124
TR 102,25,14976
MAA 160,76,124
MAA 160,56,120
s_waitcnt vmcnt(22) lgkmcnt(8)
s_barrier
MAA 60,80,0
TR 104,25,32
v_accvgpr_write_b32 a224, v192
MAA 60,84,20
TR 106,25,544
v_accvgpr_write_b32 a225, v193
MAA 64,84,24
TR 108,25,12448
s_add_u32 m0, s56, 136064
MAA 64,80,4
buffer_load_dwordx4 v18, s[20:23], s54 offen lds
MAA 68,80,8
s_sub_u32 s47, s47, 1
s_cbranch_scc1 .Lx24
.Lx24b:
MAA 68,84,28
TR 110,25,12960
MAA 72,84,32
TR 112,25,1056
v_accvgpr_write_b32 a226, v194
MAA 72,80,12
TR 114,25,1568
s_waitcnt lgkmcnt(6)
MAA 104,88,12
TR 116,25,13472
MAA 104,92,32
buffer_load_dwordx4 v19, s[20:23], s54 offen offset:1024 lds
MAA 100,92,28
TR 118,25,13984
v_accvgpr_write_b32 a227, v195
MAA 100,88,8
buffer_load_dwordx4 v20, s[20:23], s54 offen offset:2048 lds
MAA 96,88,4
TR 120,25,2080
s_add_u32 s54, s54, 196608
MAA 96,92,24
TR 122,25,2592
MAA 92,92,20
TR 124,25,14496
s_add_u32 m0, s55, 0
MAA 92,88,0
buffer_load_dwordx4 v21, s[36:39], s52 offen lds
MAA 124,0,96
TR 126,25,15008
v_accvgpr_write_b32 a228, v196
MAA 124,20,100
RD 40,23,18496
MAA 128,24,100
RD 44,23,20800
v_accvgpr_write_b32 a229, v197
MAA 128,4,96
buffer_load_dwordx4 v28, s[36:39], s52 offen offset:1024 lds
MAA 132,8,96
RD 48,23,23104
MAA 132,28,100
RD 52,23,25408
v_accvgpr_write_b32 a230, v198
MAA 136,32,100
RD 56,24,18496
MAA 136,12,96
buffer_load_dword v22, s[36:39], s52 offen offset:2048 lds
MAA 156,16,96
s_add_u32 s52, s52, 128
v_accvgpr_write_b32 a231, v199
MAA 156,36,100
s_waitcnt vmcnt(16) lgkmcnt(5)
s_barrier
MAA 76,104,0
RD 60,30,18496
v_accvgpr_write_b32 a232, v200
MAA 76,108,20
RD 64,30,20800
MAA 80,108,24
RD 68,30,23104
s_add_u32 m0, s56, 73984
MAA 80,104,4
buffer_load_dwordx4 v18, s[20:23], s54 offen lds
MAA 84,104,8
RD 72,30,25408
v_accvgpr_write_b32 a233, v201
MAA 84,108,28
RD 76,31,18496
MAA 88,108,32
v_accvgpr_write_b32 a234, v202
MAA 88,104,12
buffer_load_dwordx4 v19, s[20:23], s54 offen offset:1024 lds
MAA 244,104,16
TR 80,25,24832
MAA 244,108,36
TR 82,25,25344
MAA 120,116,32
TR 84,25,37248
v_accvgpr_write_b32 a235, v203
MAA 120,112,12
buffer_load_dwordx4 v20, s[20:23], s54 offen offset:2048 lds
MAA 116,112,8
TR 86,25,37760
s_add_u32 s54, s54, 196608
MAA 116,116,28
MAA 112,116,24
TR 88,25,25856
v_accvgpr_write_b32 a236, v204
MAA 112,112,4
TR 90,25,26368
MAA 108,112,0
TR 92,25,38272
s_add_u32 m0, s55, 2304
MAA 108,116,20
buffer_load_dwordx4 v21, s[36:39], s53 offen lds
MAA 140,20,124
TR 94,25,38784
v_accvgpr_write_b32 a237, v205
MAA 140,0,120
MAA 144,4,120
TR 96,25,26880
v_accvgpr_write_b32 a238, v206
MAA 144,24,124
buffer_load_dwordx4 v28, s[36:39], s53 offen offset:1024 lds
MAA 148,28,124
TR 98,25,27392
MAA 148,8,120
TR 100,25,39296
MAA 152,12,120
TR 102,25,39808
v_accvgpr_write_b32 a239, v207
MAA 152,32,124
buffer_load_dword v29, s[36:39], s53 offen offset:2048 lds
MAA 160,36,124
s_add_u32 s53, s53, 128
MAA 160,16,120
s_waitcnt lgkmcnt(8)
s_barrier
MAA 60,80,40
TR 104,25,24864
v_accvgpr_write_b32 a240, v208
MAA 60,84,60
TR 106,25,25376
v_accvgpr_write_b32 a241, v209
MAA 64,84,64
TR 108,25,37280
s_add_u32 m0, s56, 86400
MAA 64,80,44
buffer_load_dwordx4 v18, s[20:23], s54 offen lds
MAA 68,80,48
s_sub_u32 s47, s47, 1
s_cbranch_scc1 .Lx25
.Lx25b:
MAA 68,84,68
TR 110,25,37792
MAA 72,84,72
TR 112,25,25888
v_accvgpr_write_b32 a242, v210
MAA 72,80,52
TR 114,25,26400
s_waitcnt lgkmcnt(6)
MAA 104,88,52
TR 116,25,38304
MAA 104,92,72
buffer_load_dwordx4 v19, s[20:23], s54 offen offset:1024 lds
MAA 100,92,68
TR 118,25,38816
v_accvgpr_write_b32 a243, v211
MAA 100,88,48
buffer_load_dwordx4 v20, s[20:23], s54 offen offset:2048 lds
MAA 96,88,44
TR 120,25,26912
s_add_u32 s54, s54, 196608
MAA 96,92,64
TR 122,25,27424
MAA 92,92,60
TR 124,25,39328
s_add_u32 m0, s55, 18496
MAA 92,88,40
buffer_load_dwordx4 v21, s[36:39], s52 offen lds
MAA 124,40,96
TR 126,25,39840
v_accvgpr_write_b32 a244, v212
MAA 124,60,100
RD 0,23,36992
MAA 128,64,100
RD 4,23,39296
v_accvgpr_write_b32 a245, v213
MAA 128,44,96
buffer_load_dwordx4 v28, s[36:39], s52 offen offset:1024 lds
MAA 132,48,96
RD 8,23,41600
MAA 132,68,100
RD 12,23,43904
v_accvgpr_write_b32 a246, v214
MAA 136,72,100
RD 16,24,36992
MAA 136,52,96
buffer_load_dword v22, s[36:39], s52 offen offset:2048 lds
MAA 156,56,96
s_add_u32 s52, s52, 128
v_accvgpr_write_b32 a247, v215
MAA 156,76,100
s_waitcnt vmcnt(15) lgkmcnt(5)
s_barrier
MAA 76,104,40
RD 20,30,36992
s_add_u32 m0, s56, 98816
MAA 76,108,60
buffer_load_dwordx4 v18, s[20:23], s54 offen lds
MAA 80,108,64
RD 24,30,39296
v_accvgpr_write_b32 a248, v216
MAA 80,104,44
RD 28,30,41600
MAA 84,104,48
RD 32,30,43904
v_accvgpr_write_b32 a249, v217
MAA 84,108,68
buffer_load_dwordx4 v19, s[20:23], s54 offen offset:1024 lds
MAA 88,108,72
RD 36,31,36992
MAA 88,104,52
TR 80,25,49664
v_accvgpr_write_b32 a250, v218
MAA 244,104,56
MAA 244,108,76
buffer_load_dwordx4 v20, s[20:23], s54 offen offset:2048 lds
MAA 120,116,72
TR 82,25,50176
s_add_u32 s54, s54, 196608
MAA 120,112,52
TR 84,25,62080
v_accvgpr_write_b32 a251, v219
MAA 116,112,48
TR 86,25,62592
s_add_u32 m0, s55, 20800
MAA 116,116,68
buffer_load_dwordx4 v21, s[36:39], s53 offen lds
MAA 112,116,64
TR 88,25,50688
MAA 112,112,44
buffer_load_dwordx4 v28, s[36:39], s53 offen offset:1024 lds
MAA 108,112,40
TR 90,25,51200
v_accvgpr_write_b32 a252, v220
MAA 108,116,60
TR 92,25,63104
MAA 140,60,124
v_accvgpr_write_b32 a253, v221
MAA 140,40,120
buffer_load_dword v29, s[36:39], s53 offen offset:2048 lds
MAA 144,44,120
TR 94,25,63616
s_add_u32 s53, s53, 128
MAA 144,64,124
TR 96,25,51712
MAA 148,68,124
TR 98,25,52224
v_accvgpr_write_b32 a254, v222
MAA 148,48,120
buffer_atomic_add v37, v33, s[16:19], 0 offen sc0
MAA 152,52,120
TR 100,25,64128
MAA 152,72,124
TR 102,25,64640
v_accvgpr_write_b32 a255, v223
MAA 160,76,124
MAA 160,56,120
s_waitcnt lgkmcnt(8)
s_barrier
MAA 60,80,0
TR 104,25,49696
MAA 60,84,20
TR 106,25,50208
MAA 64,84,24
TR 108,25,62112
s_add_u32 m0, s56, 111232
MAA 64,80,4
buffer_load_dwordx4 v18, s[20:23], s54 offen lds
MAA 68,80,8
s_sub_u32 s47, s47, 1
s_cbranch_scc1 .Lx26
.Lx26b:
MAA 68,84,28
TR 110,25,62624
MAA 72,84,32
TR 112,25,50720
MAA 72,80,12
TR 114,25,51232
s_waitcnt lgkmcnt(6)
MAA 104,88,12
TR 116,25,63136
MAA 104,92,32
buffer_load_dwordx4 v19, s[20:23], s54 offen offset:1024 lds
MAA 100,92,28
TR 118,25,63648
MAA 100,88,8
buffer_load_dwordx4 v20, s[20:23], s54 offen offset:2048 lds
MAA 96,88,4
TR 120,25,51744
s_add_u32 s54, s54, 196608
MAA 96,92,24
TR 122,25,52256
MAA 92,92,20
TR 124,25,64160
s_add_u32 m0, s55, 36992
MAA 92,88,0
buffer_load_dwordx4 v21, s[36:39], s52 offen lds
MAA 124,0,96
TR 126,25,64672
MAA 124,20,100
RD 40,23,55488
MAA 128,24,100
RD 44,23,57792
MAA 128,4,96
buffer_load_dwordx4 v28, s[36:39], s52 offen offset:1024 lds
MAA 132,8,96
RD 48,23,60096
MAA 132,28,100
RD 52,23,62400
MAA 136,32,100
RD 56,24,55488
MAA 136,12,96
buffer_load_dword v22, s[36:39], s52 offen offset:2048 lds
MAA 156,16,96
s_add_u32 s52, s52, 128
MAA 156,36,100
s_waitcnt vmcnt(16) lgkmcnt(5)
s_barrier
MAA 76,104,0
RD 60,30,55488
MAA 76,108,20
RD 64,30,57792
MAA 80,108,24
RD 68,30,60096
s_add_u32 m0, s56, 123648
MAA 80,104,4
buffer_load_dwordx4 v18, s[20:23], s54 offen lds
MAA 84,104,8
RD 72,30,62400
MAA 84,108,28
RD 76,31,55488
MAA 88,108,32
MAA 88,104,12
buffer_load_dwordx4 v19, s[20:23], s54 offen offset:1024 lds
MAA 244,104,16
ds_read_b64_tr_b16 a[80:81], v25
MAA 244,108,36
TR 82,25,512
MAA 120,116,32
TR 84,25,12416
MAA 120,112,12
buffer_load_dwordx4 v20, s[20:23], s54 offen offset:2048 lds
MAA 116,112,8
TR 86,25,12928
s_add_u32 s54, s54, 196608
MAA 116,116,28
MAA 112,116,24
TR 88,25,1024
MAA 112,112,4
TR 90,25,1536
MAA 108,112,0
TR 92,25,13440
s_add_u32 m0, s55, 39296
MAA 108,116,20
buffer_load_dwordx4 v21, s[36:39], s53 offen lds
MAA 140,20,124
TR 94,25,13952
MAA 140,0,120
MAA 144,4,120
TR 96,25,2048
MAA 144,24,124
buffer_load_dwordx4 v28, s[36:39], s53 offen offset:1024 lds
MAA 148,28,124
TR 98,25,2560
MAA 148,8,120
TR 100,25,14464
MAA 152,12,120
TR 102,25,14976
MAA 152,32,124
buffer_load_dword v29, s[36:39], s53 offen offset:2048 lds
MAA 160,36,124
s_add_u32 s53, s53, 128
MAA 160,16,120
s_waitcnt lgkmcnt(8)
s_barrier
MAA 60,80,40
TR 104,25,32
MAA 60,84,60
TR 106,25,544
MAA 64,84,64
TR 108,25,12448
s_add_u32 m0, s56, 136064
MAA 64,80,44
buffer_load_dwordx4 v18, s[20:23], s54 offen lds
MAA 68,80,48
s_sub_u32 s47, s47, 1
s_cbranch_scc1 .Lx27
.Lx27b:
MAA 68,84,68
TR 110,25,12960
MAA 72,84,72
TR 112,25,1056
MAA 72,80,52
TR 114,25,1568
s_waitcnt lgkmcnt(6)
MAA 104,88,52
TR 116,25,13472
MAA 104,92,72
buffer_load_dwordx4 v19, s[20:23], s54 offen offset:1024 lds
MAA 100,92,68
TR 118,25,13984
MAA 100,88,48
buffer_load_dwordx4 v20, s[20:23], s54 offen offset:2048 lds
MAA 96,88,44
TR 120,25,2080
s_add_u32 s54, s54, 196608
MAA 96,92,64
TR 122,25,2592
MAA 92,92,60
TR 124,25,14496
s_add_u32 m0, s55, 55488
MAA 92,88,40
buffer_load_dwordx4 v21, s[36:39], s52 offen lds
MAA 124,40,96
TR 126,25,15008
MAA 124,60,100
ds_read_b128 a[0:3], v23
MAA 128,64,100
RD 4,23,2304
MAA 128,44,96
buffer_load_dwordx4 v28, s[36:39], s52 offen offset:1024 lds
MAA 132,48,96
RD 8,23,4608
MAA 132,68,100
RD 12,23,6912
MAA 136,72,100
ds_read_b128 a[16:19], v24
MAA 136,52,96
buffer_load_dword v22, s[36:39], s52 offen offset:2048 lds
.Lpad7:
s_cbranch_execz .Lt0r
MAA 156,56,96
s_add_u32 s52, s52, 128
MAA 156,76,100
s_waitcnt vmcnt(18)
v_cmp_gt_u32 vcc, v36, v37
s_nop 0
s_cbranch_vccnz .Lsp28
.Lsp28b:
s_waitcnt vmcnt(15) lgkmcnt(5)
s_barrier
MAA 76,104,40
ds_read_b128 a[20:23], v30
s_add_u32 m0, s56, 73984
MAA 76,108,60
buffer_load_dwordx4 v18, s[20:23], s54 offen lds
MAA 80,108,64
RD 24,30,2304
MAA 80,104,44
RD 28,30,4608
MAA 84,104,48
RD 32,30,6912
MAA 84,108,68
buffer_load_dwordx4 v19, s[20:23], s54 offen offset:1024 lds
MAA 88,108,72
ds_read_b128 a[36:39], v31
MAA 88,104,52
TR 80,25,24832
MAA 244,104,56
MAA 244,108,76
buffer_load_dwordx4 v20, s[20:23], s54 offen offset:2048 lds
MAA 120,116,72
TR 82,25,25344
s_add_u32 s54, s54, 196608
MAA 120,112,52
TR 84,25,37248
MAA 116,112,48
TR 86,25,37760
s_add_u32 m0, s55, 57792
MAA 116,116,68
buffer_load_dwordx4 v21, s[36:39], s53 offen lds
MAA 112,116,64
TR 88,25,25856
MAA 112,112,44
buffer_load_dwordx4 v28, s[36:39], s53 offen offset:1024 lds
MAA 108,112,40
TR 90,25,26368
MAA 108,116,60
TR 92,25,38272
MAA 140,60,124
MAA 140,40,120
buffer_load_dword v29, s[36:39], s53 offen offset:2048 lds
MAA 144,44,120
TR 94,25,38784
s_add_u32 s53, s53, 128
MAA 144,64,124
TR 96,25,26880
MAA 148,68,124
TR 98,25,27392
MAA 148,48,120
buffer_load_dwordx4 v[164:167], v26, s[16:19], s75 offen sc1
MAA 152,52,120
TR 100,25,39296
MAA 152,72,124
TR 102,25,39808
MAA 160,76,124
MAA 160,56,120
s_waitcnt lgkmcnt(8)
s_barrier
MAA 60,80,0
TR 104,25,24864
s_add_u32 m0, s56, 86400
MAA 60,84,20
buffer_load_dwordx4 v18, s[20:23], s54 offen lds
MAA 64,84,24
s_sub_u32 s47, s47, 1
s_cbranch_scc1 .Lx29
.Lx29b:
MAA 64,80,4
TR 106,25,25376
TR 108,25,37280
MAA 68,80,8
TR 110,25,37792
MAA 68,84,28
buffer_load_dwordx4 v19, s[20:23], s54 offen offset:1024 lds
MAA 72,84,32
TR 112,25,25888
MAA 72,80,12
TR 114,25,26400
s_waitcnt lgkmcnt(6)
MAA 104,88,12
MAA 104,92,32
buffer_load_dwordx4 v20, s[20:23], s54 offen offset:2048 lds
MAA 100,92,28
s_add_u32 s54, s54, 196608
s_add_u32 m0, s55, 0
MAA 100,88,8
buffer_load_dwordx4 v21, s[36:39], s52 offen lds
MAA 96,88,4
TR 116,25,38304
MAA 96,92,24
TR 118,25,38816
TR 120,25,26912
MAA 92,92,20
TR 122,25,27424
MAA 92,88,0
buffer_load_dwordx4 v28, s[36:39], s52 offen offset:1024 lds
MAA 124,0,96
TR 124,25,39328
MAA 124,20,100
TR 126,25,39840
MAA 128,24,100
RD 40,23,18496
MAA 128,4,96
buffer_load_dword v22, s[36:39], s52 offen offset:2048 lds
MAA 132,8,96
RD 44,23,20800
s_add_u32 s52, s52, 128
MAA 132,28,100
buffer_load_dwordx4 v[168:171], v26, s[16:19], s75 offen offset:1024 sc1
MAA 136,32,100
RD 48,23,23104
MAA 136,12,96
RD 52,23,25408
RD 56,24,18496
MAA 156,16,96
MAA 156,36,100
s_waitcnt vmcnt(17) lgkmcnt(5)
s_barrier
MAA 76,104,0
RD 60,30,18496
s_add_u32 m0, s56, 98816
MAA 76,108,20
buffer_load_dwordx4 v18, s[20:23], s54 offen lds
MAA 80,108,24
RD 64,30,20800
MAA 80,104,4
RD 68,30,23104
MAA 84,104,8
RD 72,30,25408
MAA 84,108,28
buffer_load_dwordx4 v19, s[20:23], s54 offen offset:1024 lds
MAA 88,108,32
RD 76,31,18496
MAA 88,104,12
TR 80,25,49664
MAA 244,104,16
MAA 244,108,36
buffer_load_dwordx4 v20, s[20:23], s54 offen offset:2048 lds
MAA 120,116,32
TR 82,25,50176
s_add_u32 s54, s54, 196608
MAA 120,112,12
TR 84,25,62080
MAA 116,112,8
TR 86,25,62592
s_add_u32 m0, s55, 2304
MAA 116,116,28
buffer_load_dwordx4 v21, s[36:39], s53 offen lds
MAA 112,116,24
TR 88,25,50688
MAA 112,112,4
buffer_load_dwordx4 v28, s[36:39], s53 offen offset:1024 lds
MAA 108,112,0
TR 90,25,51200
MAA 108,116,20
TR 92,25,63104
MAA 140,20,124
MAA 140,0,120
buffer_load_dword v29, s[36:39], s53 offen offset:2048 lds
MAA 144,4,120
TR 94,25,63616
s_add_u32 s53, s53, 128
MAA 144,24,124
TR 96,25,51712
MAA 148,28,124
TR 98,25,52224
MAA 148,8,120
buffer_load_dwordx4 v[172:175], v26, s[16:19], s75 offen offset:2048 sc1
MAA 152,12,120
TR 100,25,64128
MAA 152,32,124
TR 102,25,64640
MAA 160,36,124
MAA 160,16,120
s_waitcnt lgkmcnt(8)
s_barrier
MAA 60,80,40
TR 104,25,49696
s_add_u32 m0, s56, 111232
MAA 60,84,60
buffer_load_dwordx4 v18, s[20:23], s54 offen lds
MAA 64,84,64
s_sub_u32 s47, s47, 1
s_cbranch_scc1 .Lx30
.Lx30b:
MAA 64,80,44
TR 106,25,50208
TR 108,25,62112
MAA 68,80,48
TR 110,25,62624
MAA 68,84,68
buffer_load_dwordx4 v19, s[20:23], s54 offen offset:1024 lds
MAA 72,84,72
TR 112,25,50720
MAA 72,80,52
TR 114,25,51232
s_waitcnt lgkmcnt(6)
MAA 104,88,52
MAA 104,92,72
buffer_load_dwordx4 v20, s[20:23], s54 offen offset:2048 lds
MAA 100,92,68
s_add_u32 s54, s54, 196608
s_add_u32 m0, s55, 18496
MAA 100,88,48
buffer_load_dwordx4 v21, s[36:39], s52 offen lds
MAA 96,88,44
TR 116,25,63136
MAA 96,92,64
TR 118,25,63648
TR 120,25,51744
MAA 92,92,60
TR 122,25,52256
MAA 92,88,40
buffer_load_dwordx4 v28, s[36:39], s52 offen offset:1024 lds
MAA 124,40,96
TR 124,25,64160
MAA 124,60,100
TR 126,25,64672
MAA 128,64,100
RD 0,23,36992
MAA 128,44,96
buffer_load_dword v22, s[36:39], s52 offen offset:2048 lds
MAA 132,48,96
RD 4,23,39296
s_add_u32 s52, s52, 128
MAA 132,68,100
buffer_load_dwordx4 v[176:179], v26, s[16:19], s75 offen offset:3072 sc1
MAA 136,72,100
RD 8,23,41600
s_add_u32 s75, s75, 4096
MAA 136,52,96
RD 12,23,43904
RD 16,24,36992
MAA 156,56,96
MAA 156,76,100
s_waitcnt vmcnt(18) lgkmcnt(5)
s_barrier
MAA 76,104,40
RD 20,30,36992
s_add_u32 m0, s56, 123648
MAA 76,108,60
buffer_load_dwordx4 v18, s[20:23], s54 offen lds
MAA 80,108,64
RD 24,30,39296
s_waitcnt vmcnt(15)
v_add_f32 v164, v164, v168
MAA 80,104,44
RD 28,30,41600
MAA 84,104,48
RD 32,30,43904
MAA 84,108,68
buffer_load_dwordx4 v19, s[20:23], s54 offen offset:1024 lds
MAA 88,108,72
RD 36,31,36992
MAA 88,104,52
ds_read_b64_tr_b16 a[80:81], v25
v_add_f32 v165, v165, v169
MAA 244,104,56
MAA 244,108,76
buffer_load_dwordx4 v20, s[20:23], s54 offen offset:2048 lds
MAA 120,116,72
TR 82,25,512
s_add_u32 s54, s54, 196608
MAA 120,112,52
TR 84,25,12416
MAA 116,112,48
TR 86,25,12928
s_add_u32 m0, s55, 20800
MAA 116,116,68
buffer_load_dwordx4 v21, s[36:39], s53 offen lds
MAA 112,116,64
TR 88,25,1024
MAA 112,112,44
buffer_load_dwordx4 v28, s[36:39], s53 offen offset:1024 lds
MAA 108,112,40
TR 90,25,1536
v_add_f32 v166, v166, v170
MAA 108,116,60
TR 92,25,13440
MAA 140,60,124
MAA 140,40,120
buffer_load_dword v29, s[36:39], s53 offen offset:2048 lds
MAA 144,44,120
TR 94,25,13952
s_add_u32 s53, s53, 128
MAA 144,64,124
TR 96,25,2048
MAA 148,68,124
TR 98,25,2560
v_add_f32 v167, v167, v171
MAA 148,48,120
buffer_load_dwordx4 v[180:183], v26, s[16:19], s75 offen sc1
MAA 152,52,120
TR 100,25,14464
MAA 152,72,124
TR 102,25,14976
MAA 160,76,124
MAA 160,56,120
s_waitcnt lgkmcnt(8)
s_barrier
MAA 60,80,0
TR 104,25,32
s_add_u32 m0, s56, 136064
MAA 60,84,20
buffer_load_dwordx4 v18, s[20:23], s54 offen lds
MAA 64,84,24
s_sub_u32 s47, s47, 1
s_cbranch_scc1 .Lx31
.Lx31b:
MAA 64,80,4
TR 106,25,544
TR 108,25,12448
MAA 68,80,8
TR 110,25,12960
s_waitcnt vmcnt(15)
v_add_f32 v164, v164, v172
MAA 68,84,28
buffer_load_dwordx4 v19, s[20:23], s54 offen offset:1024 lds
MAA 72,84,32
TR 112,25,1056
MAA 72,80,12
TR 114,25,1568
s_waitcnt lgkmcnt(6)
MAA 104,88,12
v_add_f32 v165, v165, v173
MAA 104,92,32
buffer_load_dwordx4 v20, s[20:23], s54 offen offset:2048 lds
MAA 100,92,28
s_add_u32 s54, s54, 196608
s_add_u32 m0, s55, 36992
MAA 100,88,8
buffer_load_dwordx4 v21, s[36:39], s52 offen lds
MAA 96,88,4
TR 116,25,13472
MAA 96,92,24
TR 118,25,13984
TR 120,25,2080
MAA 92,92,20
TR 122,25,2592
v_add_f32 v166, v166, v174
MAA 92,88,0
buffer_load_dwordx4 v28, s[36:39], s52 offen offset:1024 lds
MAA 124,0,96
TR 124,25,14496
MAA 124,20,100
TR 126,25,15008
MAA 128,24,100
RD 40,23,55488
v_add_f32 v167, v167, v175
MAA 128,4,96
buffer_load_dword v22, s[36:39], s52 offen offset:2048 lds
MAA 132,8,96
RD 44,23,57792
s_add_u32 s52, s52, 128
MAA 132,28,100
buffer_load_dwordx4 v[184:187], v26, s[16:19], s75 offen offset:1024 sc1
MAA 136,32,100
RD 48,23,60096
MAA 136,12,96
RD 52,23,62400
RD 56,24,55488
MAA 156,16,96
MAA 156,36,100
s_waitcnt vmcnt(18) lgkmcnt(5)
s_barrier
MAA 76,104,0
RD 60,30,55488
s_waitcnt vmcnt(14)
v_add_f32 v164, v164, v176
MAA 76,108,20
RD 64,30,57792
s_add_u32 m0, s56, 73984
MAA 80,108,24
buffer_load_dwordx4 v18, s[20:23], s54 offen lds
MAA 80,104,4
RD 68,30,60096
v_add_f32 v165, v165, v177
MAA 84,104,8
RD 72,30,62400
v_add_f32 v166, v166, v178
MAA 84,108,28
buffer_load_dwordx4 v19, s[20:23], s54 offen offset:1024 lds
MAA 88,108,32
RD 76,31,55488
v_add_f32 v167, v167, v179
MAA 88,104,12
TR 80,25,24832
MAA 244,104,16
buffer_load_dwordx4 v20, s[20:23], s54 offen offset:2048 lds
MAA 244,108,36
TR 82,25,25344
s_add_u32 s54, s54, 196608
MAA 120,116,32
TR 84,25,37248
s_add_u32 m0, s55, 39296
MAA 120,112,12
buffer_load_dwordx4 v21, s[36:39], s53 offen lds
MAA 116,112,8
TR 86,25,37760
MAA 116,116,28
TR 88,25,25856
MAA 112,116,24
buffer_load_dwordx4 v28, s[36:39], s53 offen offset:1024 lds
MAA 112,112,4
TR 90,25,26368
MAA 108,112,0
TR 92,25,38272
MAA 108,116,20
buffer_load_dword v29, s[36:39], s53 offen offset:2048 lds
MAA 140,20,124
TR 94,25,38784
s_add_u32 s53, s53, 128
MAA 140,0,120
TR 96,25,26880
MAA 144,4,120
buffer_load_dwordx4 v[188:191], v26, s[16:19], s75 offen offset:2048 sc1
MAA 144,24,124
TR 98,25,27392
MAA 148,28,124
TR 100,25,39296
MAA 148,8,120
TR 102,25,39808
MAA 152,12,120
MAA 152,32,124
MAA 160,36,124
MAA 160,16,120
s_waitcnt lgkmcnt(8)
s_barrier
MAA 60,80,40
TR 104,25,24864
s_add_u32 m0, s56, 86400
MAA 60,84,60
buffer_load_dwordx4 v18, s[20:23], s54 offen lds
MAA 64,84,64
s_sub_u32 s47, s47, 1
s_cbranch_scc1 .Lx32
.Lx32b:
MAA 64,80,44
TR 106,25,25376
TR 108,25,37280
MAA 68,80,48
TR 110,25,37792
s_waitcnt vmcnt(15)
v_add_f32 v164, v164, v180
MAA 68,84,68
buffer_load_dwordx4 v19, s[20:23], s54 offen offset:1024 lds
MAA 72,84,72
TR 112,25,25888
MAA 72,80,52
TR 114,25,26400
s_waitcnt lgkmcnt(6)
MAA 104,88,52
v_add_f32 v165, v165, v181
MAA 104,92,72
buffer_load_dwordx4 v20, s[20:23], s54 offen offset:2048 lds
MAA 100,92,68
s_add_u32 s54, s54, 196608
s_add_u32 m0, s55, 55488
MAA 100,88,48
buffer_load_dwordx4 v21, s[36:39], s52 offen lds
MAA 96,88,44
TR 116,25,38304
MAA 96,92,64
TR 118,25,38816
TR 120,25,26912
MAA 92,92,60
TR 122,25,27424
v_add_f32 v166, v166, v182
MAA 92,88,40
buffer_load_dwordx4 v28, s[36:39], s52 offen offset:1024 lds
MAA 124,40,96
TR 124,25,39328
MAA 124,60,100
TR 126,25,39840
MAA 128,64,100
ds_read_b128 a[0:3], v23
v_add_f32 v167, v167, v183
MAA 128,44,96
buffer_load_dword v22, s[36:39], s52 offen offset:2048 lds
MAA 132,48,96
RD 4,23,2304
s_add_u32 s52, s52, 128
MAA 132,68,100
buffer_load_dwordx4 v[192:195], v26, s[16:19], s75 offen offset:3072 sc1
MAA 136,72,100
RD 8,23,4608
MAA 136,52,96
RD 12,23,6912
ds_read_b128 a[16:19], v24
MAA 156,56,96
MAA 156,76,100
s_waitcnt vmcnt(18) lgkmcnt(5)
s_barrier
MAA 76,104,40
ds_read_b128 a[20:23], v30
s_waitcnt vmcnt(14)
v_add_f32 v164, v164, v184
MAA 76,108,60
RD 24,30,2304
s_add_u32 m0, s56, 98816
MAA 80,108,64
buffer_load_dwordx4 v18, s[20:23], s54 offen lds
MAA 80,104,44
RD 28,30,4608
v_add_f32 v165, v165, v185
MAA 84,104,48
RD 32,30,6912
v_add_f32 v166, v166, v186
MAA 84,108,68
ds_read_b128 a[36:39], v31
v_add_f32 v167, v167, v187
MAA 88,108,72
buffer_load_dwordx4 v19, s[20:23], s54 offen offset:1024 lds
MAA 88,104,52
TR 80,25,49664
MAA 244,104,56
TR 82,25,50176
MAA 244,108,76
TR 84,25,62080
MAA 120,116,72
buffer_load_dwordx4 v20, s[20:23], s54 offen offset:2048 lds
MAA 120,112,52
TR 86,25,62592
s_add_u32 s54, s54, 196608
MAA 116,112,48
TR 88,25,50688
s_add_u32 m0, s55, 57792
MAA 116,116,68
TR 90,25,51200
MAA 112,116,64
buffer_load_dwordx4 v21, s[36:39], s53 offen lds
MAA 112,112,44
TR 92,25,63104
MAA 108,112,40
TR 94,25,63616
MAA 108,116,60
TR 96,25,51712
.Lpad8:
s_cbranch_execz .Lt0r
MAA 140,60,124
buffer_load_dwordx4 v28, s[36:39], s53 offen offset:1024 lds
MAA 140,40,120
TR 98,25,52224
MAA 144,44,120
TR 100,25,64128
MAA 144,64,124
TR 102,25,64640
MAA 148,68,124
buffer_load_dword v29, s[36:39], s53 offen offset:2048 lds
MAA 148,48,120
s_add_u32 s53, s53, 128
MAA 152,52,120
MAA 152,72,124
MAA 160,76,124
MAA 160,56,120
s_waitcnt lgkmcnt(8)
s_barrier
MAA 60,80,0
TR 104,25,49696
s_waitcnt vmcnt(13)
v_add_f32 v164, v164, v188
MAA 60,84,20
TR 106,25,50208
s_add_u32 m0, s56, 111232
MAA 64,84,24
buffer_load_dwordx4 v18, s[20:23], s54 offen lds
MAA 64,80,4
TR 108,25,62112
v_add_f32 v165, v165, v189
MAA 68,80,8
TR 110,25,62624
v_add_f32 v166, v166, v190
MAA 68,84,28
buffer_load_dwordx4 v19, s[20:23], s54 offen offset:1024 lds
MAA 72,84,32
TR 112,25,50720
v_add_f32 v167, v167, v191
MAA 72,80,12
TR 114,25,51232
s_waitcnt lgkmcnt(6)
MAA 104,88,12
buffer_load_dwordx4 v20, s[20:23], s54 offen offset:2048 lds
MAA 104,92,32
TR 116,25,63136
s_add_u32 s54, s54, 196608
MAA 100,92,28
TR 118,25,63648
s_add_u32 m0, s59, 0
MAA 100,88,8
TR 120,25,51744
s_xor_b32 s58, s87, 1048576
MAA 96,88,4
buffer_load_dwordx4 v5, s[24:27], s58 offen lds
MAA 96,92,24
TR 122,25,52256
MAA 92,92,20
TR 124,25,64160
MAA 92,88,0
buffer_load_dwordx4 v6, s[24:27], s58 offen offset:1024 lds
MAA 124,0,96
TR 126,25,64672
s_add_u32 m0, s59, 8320
MAA 124,20,100
RD 40,23,18496
s_xor_b32 s58, s87, 1179648
MAA 128,24,100
buffer_load_dwordx4 v5, s[24:27], s58 offen lds
MAA 128,4,96
RD 44,23,20800
MAA 132,8,96
RD 48,23,23104
MAA 132,28,100
buffer_load_dwordx4 v6, s[24:27], s58 offen offset:1024 lds
MAA 136,32,100
RD 52,23,25408
MAA 136,12,96
RD 56,24,18496
MAA 156,16,96
MAA 156,36,100
s_waitcnt vmcnt(17) lgkmcnt(5)
s_barrier
MAA 76,104,0
RD 60,30,18496
s_waitcnt vmcnt(13)
v_add_f32 v164, v164, v192
MAA 76,108,20
RD 64,30,20800
s_add_u32 m0, s56, 123648
MAA 80,108,24
buffer_load_dwordx4 v18, s[20:23], s54 offen lds
MAA 80,104,4
RD 68,30,23104
v_add_f32 v165, v165, v193
MAA 84,104,8
RD 72,30,25408
v_add_f32 v166, v166, v194
MAA 84,108,28
RD 76,31,18496
v_add_f32 v167, v167, v195
MAA 88,108,32
ds_read_b64_tr_b16 a[80:81], v25
MAA 88,104,12
TR 82,25,512
MAA 244,104,16
TR 84,25,12416
MAA 244,108,36
TR 86,25,12928
MAA 120,116,32
buffer_load_dwordx4 v19, s[20:23], s54 offen offset:1024 lds
MAA 120,112,12
TR 88,25,1024
MAA 116,112,8
TR 90,25,1536
MAA 116,116,28
TR 92,25,13440
MAA 112,116,24
TR 94,25,13952
MAA 112,112,4
TR 96,25,2048
MAA 108,112,0
TR 98,25,2560
MAA 108,116,20
TR 100,25,14464
MAA 140,20,124
buffer_load_dwordx4 v20, s[20:23], s54 offen offset:2048 lds
MAA 140,0,120
TR 102,25,14976
s_add_u32 s54, s54, 196608
MAA 144,4,120
MAA 144,24,124
MAA 148,28,124
MAA 148,8,120
MAA 152,12,120
MAA 152,32,124
MAA 160,36,124
MAA 160,16,120
s_waitcnt lgkmcnt(8)
s_barrier
MAA 60,80,40
TR 104,25,32
MAA 60,84,60
TR 106,25,544
s_add_u32 m0, s56, 136064
MAA 64,84,64
buffer_load_dwordx4 v18, s[20:23], s54 offen lds
MAA 64,80,44
TR 108,25,12448
MAA 68,80,48
TR 110,25,12960
MAA 68,84,68
buffer_load_dwordx4 v19, s[20:23], s54 offen offset:1024 lds
MAA 72,84,72
TR 112,25,1056
MAA 72,80,52
TR 114,25,1568
s_waitcnt lgkmcnt(6)
MAA 104,88,52
buffer_load_dwordx4 v20, s[20:23], s54 offen offset:2048 lds
MAA 104,92,72
TR 116,25,13472
s_add_u32 s54, s54, 196608
MAA 100,92,68
TR 118,25,13984
s_add_u32 m0, s59, 16640
MAA 100,88,48
TR 120,25,2080
s_xor_b32 s58, s87, 1310720
MAA 96,88,44
buffer_load_dwordx4 v5, s[24:27], s58 offen lds
MAA 96,92,64
TR 122,25,2592
MAA 92,92,60
TR 124,25,14496
MAA 92,88,40
buffer_load_dwordx4 v6, s[24:27], s58 offen offset:1024 lds
MAA 124,40,96
TR 126,25,15008
s_add_u32 m0, s59, 24960
MAA 124,60,100
RD 0,23,36992
s_xor_b32 s58, s87, 1441792
MAA 128,64,100
buffer_load_dwordx4 v5, s[24:27], s58 offen lds
MAA 128,44,96
RD 4,23,39296
MAA 132,48,96
RD 8,23,41600
MAA 132,68,100
buffer_load_dwordx4 v6, s[24:27], s58 offen offset:1024 lds
MAA 136,72,100
RD 12,23,43904
MAA 136,52,96
RD 16,24,36992
MAA 156,56,96
v_permlane32_swap_b32 v164, v166
MAA 156,76,100
v_permlane32_swap_b32 v165, v167
v_add_f32 v164, v164, v166
v_add_f32 v165, v165, v167
v_mul_f32 v164, 0xba800000, v164
v_mul_f32 v165, 0x3a800000, v165
v_fma_f32 v165, -v164, v164, v165
v_max_f32 v165, 0, v165
v_add_f32 v165, 0x3727c5ac, v165
v_rsq_f32 v166, v165
s_nop 0
v_mov_b32 v165, v166
v_mul_f32 v166, 0x3e8293ee, v166
s_waitcnt vmcnt(14) lgkmcnt(5)
s_barrier
MAA 76,104,40
ds_write_b128 v7, v[164:167]
MAA 76,108,60
ds_write_b32 v17, v164
s_add_u32 m0, s59, 74880
MAA 80,108,64
ds_write_b32 v17, v165 offset:1024
s_xor_b32 s58, s87, 131072
MAA 80,104,44
buffer_load_dwordx4 v5, s[24:27], s58 offen lds
MAA 84,104,48
RD 20,30,36992
MAA 84,108,68
RD 24,30,39296
MAA 88,108,72
RD 28,30,41600
MAA 88,104,52
RD 32,30,43904
MAA 244,104,56
RD 36,31,36992
MAA 244,108,76
buffer_load_dwordx4 v6, s[24:27], s58 offen offset:1024 lds
MAA 120,116,72
TR 80,25,24832
s_add_u32 m0, s59, 83200
MAA 120,112,52
TR 82,25,25344
s_xor_b32 s58, s87, 262144
MAA 116,112,48
TR 84,25,37248
MAA 116,116,68
TR 86,25,37760
MAA 112,116,64
TR 88,25,25856
MAA 112,112,44
buffer_load_dwordx4 v5, s[24:27], s58 offen lds
MAA 108,112,40
TR 90,25,26368
MAA 108,116,60
TR 92,25,38272
MAA 140,60,124
TR 94,25,38784
MAA 140,40,120
TR 96,25,26880
MAA 144,44,120
TR 98,25,27392
MAA 144,64,124
buffer_load_dwordx4 v6, s[24:27], s58 offen offset:1024 lds
MAA 148,68,124
TR 100,25,39296
MAA 148,48,120
TR 102,25,39808
MAA 152,52,120
MAA 152,72,124
MAA 160,76,124
MAA 160,56,120
s_waitcnt vmcnt(8) lgkmcnt(0)
s_barrier
MAA 104,88,12
TR 112,25,25888
s_add_u32 m0, s59, 33280
MAA 104,92,32
TR 114,25,26400
s_xor_b32 s58, s87, 1572864
MAA 100,92,28
buffer_load_dwordx4 v5, s[24:27], s58 offen lds
MAA 100,88,8
TR 116,25,38304
MAA 96,88,4
TR 118,25,38816
MAA 96,92,24
TR 120,25,26912
MAA 92,92,20
buffer_load_dwordx4 v6, s[24:27], s58 offen offset:1024 lds
MAA 92,88,0
TR 122,25,27424
s_add_u32 m0, s59, 41600
MAA 156,16,96
TR 124,25,39328
s_xor_b32 s58, s87, 1703936
MAA 156,36,100
TR 126,25,39840
MAA 72,84,32
buffer_load_dwordx4 v5, s[24:27], s58 offen lds
MAA 72,80,12
TR 104,25,24864
MAA 68,80,8
TR 106,25,25376
MAA 68,84,28
TR 108,25,37280
MAA 64,84,24
buffer_load_dwordx4 v6, s[24:27], s58 offen offset:1024 lds
MAA 64,80,4
TR 110,25,37792
MAA 60,80,0
RD 40,23,55488
MAA 60,84,20
RD 44,23,57792
s_waitcnt lgkmcnt(12)
MAA 120,112,12
RD 48,23,60096
s_waitcnt lgkmcnt(11)
MAA 120,116,32
RD 52,23,62400
MAA 116,116,28
RD 56,24,55488
MAA 116,112,8
RD 60,30,55488
MAA 112,112,4
RD 64,30,57792
MAA 112,116,24
s_waitcnt lgkmcnt(7)
s_barrier
RD 68,30,60096
MAA 108,116,20
RD 72,30,62400
s_add_u32 m0, s59, 91520
MAA 108,112,0
RD 76,31,55488
s_xor_b32 s58, s87, 393216
MAA 160,16,120
TR 144,25,50688
MAA 160,36,124
TR 146,25,51200
MAA 244,108,36
TR 148,25,63104
MAA 244,104,16
TR 150,25,63616
MAA 88,104,12
TR 152,25,50720
MAA 88,108,32
TR 154,25,51232
MAA 84,108,28
TR 156,25,63136
MAA 84,104,8
TR 158,25,63648
MAA 80,104,4
TR 160,25,51712
MAA 80,108,24
TR 162,25,52224
MAA 76,108,20
TR 164,25,64128
MAA 76,104,0
TR 166,25,64640
s_waitcnt lgkmcnt(10)
MAA 104,144,52
TR 168,25,51744
s_waitcnt lgkmcnt(9)
MAA 104,148,72
TR 170,25,52256
MAA 100,148,68
TR 172,25,64160
MAA 100,144,48
TR 174,25,64672
MAA 96,144,44
TR 136,25,49696
MAA 96,148,64
TR 138,25,50208
MAA 92,148,60
TR 140,25,62112
MAA 92,144,40
TR 142,25,62624
s_waitcnt lgkmcnt(14)
MAA 120,152,52
TR 128,25,49664
s_waitcnt lgkmcnt(13)
MAA 120,156,72
TR 130,25,50176
MAA 116,156,68
TR 132,25,62080
MAA 116,152,48
TR 134,25,62592
MAA 112,152,44
ds_read_b128 v[232:235], v10 offset:1792
MAA 112,156,64
ds_read_b128 v[228:231], v10 offset:1536
MAA 108,156,60
ds_read_b128 v[224:227], v10 offset:1280
MAA 108,152,40
ds_read_b128 v[220:223], v10 offset:1024
s_waitcnt lgkmcnt(15)
MAA 156,56,160
buffer_load_dwordx4 v5, s[24:27], s58 offen lds
MAA 156,76,164
s_waitcnt lgkmcnt(12)
MAA 160,76,172
MAA 160,56,168
s_waitcnt lgkmcnt(10)
MAA 244,136,56
buffer_load_dwordx4 v6, s[24:27], s58 offen offset:1024 lds
s_waitcnt lgkmcnt(8)
MAA 244,140,76
s_add_u32 m0, s59, 99840
s_xor_b32 s58, s87, 524288
MAA 88,140,72
MAA 88,136,52
MAA 84,136,48
buffer_load_dwordx4 v5, s[24:27], s58 offen lds
MAA 84,140,68
buffer_load_dwordx4 v6, s[24:27], s58 offen offset:1024 lds
s_add_u32 m0, s59, 108160
s_xor_b32 s58, s87, 655360
buffer_load_dwordx4 v5, s[24:27], s58 offen lds
buffer_load_dwordx4 v6, s[24:27], s58 offen offset:1024 lds
s_mov_b32 exec_lo, 0x10001
s_mov_b32 exec_hi, 0x10001
ds_write_b128 v13, v[244:247] offset:64
s_mov_b64 exec, 0xffff
ds_write_b32 v12, v156 offset:512
ds_write_b32 v12, v160 offset:576
s_mov_b64 exec, -1
MAA 80,136,44
MAA 80,140,64
MAA 76,140,60
MAA 76,136,40
s_waitcnt lgkmcnt(9)
MAA 72,128,52
s_waitcnt lgkmcnt(7)
MAA 72,132,72
s_waitcnt lgkmcnt(0)
s_barrier
MAA 68,128,48
ds_read_b128 v[28:31], v13
MAA 68,132,68
ds_read_b128 v[32:35], v13 offset:64
MAA 64,132,64
ds_read_b128 v[36:39], v13 offset:256
MAA 64,128,44
ds_read_b128 v[40:43], v13 offset:320
MAA 60,128,40
ds_read_b32 v44, v12 offset:512
MAA 60,132,60
ds_read_b32 v45, v12 offset:576
ds_read_b128 v[240:243], v11 offset:704
ds_read_b128 v[244:247], v11 offset:1728
ds_read_b128 v[18:21], v11 offset:448
ds_read_b128 v[22:25], v11 offset:1472
s_waitcnt lgkmcnt(9)
v_pk_fma_f32 v[72:73], v[28:29], v[232:233], v[72:73] op_sel_hi:[1,0,1]
v_cvt_pk_bf16_f32 v176, v72, v73
v_pk_fma_f32 v[74:75], v[30:31], v[232:233], v[74:75] op_sel_hi:[1,0,1]
v_cvt_pk_bf16_f32 v177, v74, v75
s_waitcnt lgkmcnt(8)
v_pk_fma_f32 v[88:89], v[32:33], v[232:233], v[88:89] op_sel_hi:[1,0,1]
v_cvt_pk_bf16_f32 v178, v88, v89
v_pk_fma_f32 v[90:91], v[34:35], v[232:233], v[90:91] op_sel_hi:[1,0,1]
v_cvt_pk_bf16_f32 v179, v90, v91
s_waitcnt lgkmcnt(7)
v_pk_fma_f32 v[104:105], v[36:37], v[232:233], v[104:105] op_sel_hi:[1,0,1]
v_pk_mul_f32 v[104:105], v[104:105], v[232:233] op_sel:[0,1] op_sel_hi:[1,1]
v_cvt_pk_bf16_f32 v196, v104, v105
v_pk_fma_f32 v[106:107], v[38:39], v[232:233], v[106:107] op_sel_hi:[1,0,1]
v_pk_mul_f32 v[106:107], v[106:107], v[232:233] op_sel:[0,1] op_sel_hi:[1,1]
v_cvt_pk_bf16_f32 v197, v106, v107
s_waitcnt lgkmcnt(6)
v_pk_fma_f32 v[120:121], v[40:41], v[232:233], v[120:121] op_sel_hi:[1,0,1]
v_pk_mul_f32 v[120:121], v[120:121], v[232:233] op_sel:[0,1] op_sel_hi:[1,1]
v_cvt_pk_bf16_f32 v198, v120, v121
v_pk_fma_f32 v[122:123], v[42:43], v[232:233], v[122:123] op_sel_hi:[1,0,1]
v_pk_mul_f32 v[122:123], v[122:123], v[232:233] op_sel:[0,1] op_sel_hi:[1,1]
v_cvt_pk_bf16_f32 v199, v122, v123
v_pk_fma_f32 v[100:101], v[36:37], v[228:229], v[100:101] op_sel_hi:[1,0,1]
v_pk_mul_f32 v[100:101], v[100:101], v[228:229] op_sel:[0,1] op_sel_hi:[1,1]
s_waitcnt lgkmcnt(3)
v_pk_fma_f32 v[156:157], v[240:241], v[44:45], v[156:157] op_sel_hi:[1,0,1]
v_pk_fma_f32 v[158:159], v[242:243], v[44:45], v[158:159] op_sel_hi:[1,0,1]
s_waitcnt lgkmcnt(2)
v_pk_mul_f32 v[156:157], v[156:157], v[244:245]
v_cvt_pk_bf16_f32 v236, v156, v157
v_pk_mul_f32 v[158:159], v[158:159], v[246:247]
v_cvt_pk_bf16_f32 v237, v158, v159
v_pk_fma_f32 v[160:161], v[240:241], v[44:45], v[160:161] op_sel:[0,1,0] op_sel_hi:[1,1,1]
v_pk_mul_f32 v[160:161], v[160:161], v[244:245]
v_cvt_pk_bf16_f32 v238, v160, v161
v_pk_fma_f32 v[162:163], v[242:243], v[44:45], v[162:163] op_sel:[0,1,0] op_sel_hi:[1,1,1]
v_pk_mul_f32 v[162:163], v[162:163], v[246:247]
v_cvt_pk_bf16_f32 v239, v162, v163
ds_write_b128 v8, v[236:239] offset:1024
v_cvt_pk_bf16_f32 v192, v100, v101
v_pk_fma_f32 v[102:103], v[38:39], v[228:229], v[102:103] op_sel_hi:[1,0,1]
v_pk_mul_f32 v[102:103], v[102:103], v[228:229] op_sel:[0,1] op_sel_hi:[1,1]
v_cvt_pk_bf16_f32 v193, v102, v103
v_pk_fma_f32 v[116:117], v[40:41], v[228:229], v[116:117] op_sel_hi:[1,0,1]
v_pk_mul_f32 v[116:117], v[116:117], v[228:229] op_sel:[0,1] op_sel_hi:[1,1]
v_cvt_pk_bf16_f32 v194, v116, v117
v_pk_fma_f32 v[118:119], v[42:43], v[228:229], v[118:119] op_sel_hi:[1,0,1]
v_pk_mul_f32 v[118:119], v[118:119], v[228:229] op_sel:[0,1] op_sel_hi:[1,1]
v_cvt_pk_bf16_f32 v195, v118, v119
v_pk_fma_f32 v[96:97], v[36:37], v[224:225], v[96:97] op_sel_hi:[1,0,1]
v_pk_mul_f32 v[96:97], v[96:97], v[224:225] op_sel:[0,1] op_sel_hi:[1,1]
v_cvt_pk_bf16_f32 v188, v96, v97
v_pk_fma_f32 v[98:99], v[38:39], v[224:225], v[98:99] op_sel_hi:[1,0,1]
v_pk_mul_f32 v[98:99], v[98:99], v[224:225] op_sel:[0,1] op_sel_hi:[1,1]
v_cvt_pk_bf16_f32 v189, v98, v99
v_pk_fma_f32 v[112:113], v[40:41], v[224:225], v[112:113] op_sel_hi:[1,0,1]
v_pk_mul_f32 v[112:113], v[112:113], v[224:225] op_sel:[0,1] op_sel_hi:[1,1]
v_cvt_pk_bf16_f32 v190, v112, v113
v_pk_fma_f32 v[114:115], v[42:43], v[224:225], v[114:115] op_sel_hi:[1,0,1]
v_pk_mul_f32 v[114:115], v[114:115], v[224:225] op_sel:[0,1] op_sel_hi:[1,1]
v_cvt_pk_bf16_f32 v191, v114, v115
v_pk_fma_f32 v[92:93], v[36:37], v[220:221], v[92:93] op_sel_hi:[1,0,1]
v_pk_mul_f32 v[92:93], v[92:93], v[220:221] op_sel:[0,1] op_sel_hi:[1,1]
v_cvt_pk_bf16_f32 v184, v92, v93
v_pk_fma_f32 v[94:95], v[38:39], v[220:221], v[94:95] op_sel_hi:[1,0,1]
v_pk_mul_f32 v[94:95], v[94:95], v[220:221] op_sel:[0,1] op_sel_hi:[1,1]
v_cvt_pk_bf16_f32 v185, v94, v95
v_pk_fma_f32 v[108:109], v[40:41], v[220:221], v[108:109] op_sel_hi:[1,0,1]
v_pk_mul_f32 v[108:109], v[108:109], v[220:221] op_sel:[0,1] op_sel_hi:[1,1]
v_cvt_pk_bf16_f32 v186, v108, v109
v_pk_fma_f32 v[110:111], v[42:43], v[220:221], v[110:111] op_sel_hi:[1,0,1]
v_pk_mul_f32 v[110:111], v[110:111], v[220:221] op_sel:[0,1] op_sel_hi:[1,1]
v_cvt_pk_bf16_f32 v187, v110, v111
v_pk_fma_f32 v[68:69], v[28:29], v[228:229], v[68:69] op_sel_hi:[1,0,1]
v_cvt_pk_bf16_f32 v172, v68, v69
v_pk_fma_f32 v[70:71], v[30:31], v[228:229], v[70:71] op_sel_hi:[1,0,1]
v_cvt_pk_bf16_f32 v173, v70, v71
v_pk_fma_f32 v[84:85], v[32:33], v[228:229], v[84:85] op_sel_hi:[1,0,1]
v_cvt_pk_bf16_f32 v174, v84, v85
v_pk_fma_f32 v[86:87], v[34:35], v[228:229], v[86:87] op_sel_hi:[1,0,1]
v_cvt_pk_bf16_f32 v175, v86, v87
v_pk_fma_f32 v[64:65], v[28:29], v[224:225], v[64:65] op_sel_hi:[1,0,1]
v_cvt_pk_bf16_f32 v168, v64, v65
v_pk_fma_f32 v[66:67], v[30:31], v[224:225], v[66:67] op_sel_hi:[1,0,1]
v_cvt_pk_bf16_f32 v169, v66, v67
v_pk_fma_f32 v[80:81], v[32:33], v[224:225], v[80:81] op_sel_hi:[1,0,1]
v_cvt_pk_bf16_f32 v170, v80, v81
v_pk_fma_f32 v[82:83], v[34:35], v[224:225], v[82:83] op_sel_hi:[1,0,1]
.Lpad9:
s_cbranch_execz .Lt0r
v_cvt_pk_bf16_f32 v171, v82, v83
v_pk_fma_f32 v[60:61], v[28:29], v[220:221], v[60:61] op_sel_hi:[1,0,1]
v_cvt_pk_bf16_f32 v164, v60, v61
v_pk_fma_f32 v[62:63], v[30:31], v[220:221], v[62:63] op_sel_hi:[1,0,1]
v_cvt_pk_bf16_f32 v165, v62, v63
v_pk_fma_f32 v[76:77], v[32:33], v[220:221], v[76:77] op_sel_hi:[1,0,1]
v_cvt_pk_bf16_f32 v166, v76, v77
v_pk_fma_f32 v[78:79], v[34:35], v[220:221], v[78:79] op_sel_hi:[1,0,1]
s_waitcnt lgkmcnt(0)
s_barrier
v_cvt_pk_bf16_f32 v167, v78, v79
v_mfma_f32_16x16x32_bf16 v[120:123], v[196:199], v[176:179], v[50:53]
ds_read_b128 v[180:183], v9
v_mfma_f32_16x16x32_bf16 v[104:107], v[192:195], v[176:179], v[46:49]
ds_read_b64 v[200:201], v9 offset:1024
v_mfma_f32_16x16x32_bf16 v[116:119], v[192:195], v[172:175], v[50:53]
ds_read_b64 v[210:211], v9 offset:1032
v_mfma_f32_16x16x32_bf16 v[100:103], v[188:191], v[172:175], v[46:49]
ds_read_b128 v[240:243], v11 offset:384
v_mfma_f32_16x16x32_bf16 v[112:115], v[188:191], v[168:171], v[50:53]
ds_read_b128 v[244:247], v11 offset:1408
v_mfma_f32_16x16x32_bf16 v[96:99], v[184:187], v[168:171], v[46:49]
ds_read_b128 v[28:31], v11 offset:320
v_max3_f32 v88, v104, v105, v106
v_mfma_f32_16x16x32_bf16 v[108:111], v[184:187], v[164:167], v[50:53]
ds_read_b128 v[32:35], v11 offset:1344
v_max3_f32 v89, v107, v120, v121
v_max3_f32 v88, v88, v122, v123
v_max_f32 v90, v88, v89
v_max_f32 v89, v88, v89
v_max3_f32 v84, v100, v101, v102
v_max3_f32 v85, v103, v116, v117
s_waitcnt lgkmcnt(6)
v_mfma_f32_16x16x32_bf16 v[92:95], v[180:183], v[164:167], v[46:49]
ds_read_b128 v[36:39], v11 offset:256
v_permlane16_swap_b32 v90, v89
MAA 136,12,96
ds_read_b128 v[40:43], v11 offset:1280
v_max_f32 v88, v90, v89
MAA 136,32,100
v_max_f32 v89, v90, v89
v_max3_f32 v84, v84, v118, v119
MAA 136,52,160
v_permlane32_swap_b32 v88, v89
MAA 136,72,164
v_max_f32 v88, v88, v89
v_mul_f32 v88, v88, v234
MAA 152,72,172
v_max_f32 v86, v84, v85
v_max_f32 v85, v84, v85
MAA 152,52,168
s_nop 0
v_permlane16_swap_b32 v86, v85
MAA 152,32,124
v_max_f32 v84, v86, v85
v_max_f32 v85, v86, v85
MAA 152,12,120
s_nop 0
v_permlane32_swap_b32 v84, v85
v_max3_f32 v80, v96, v97, v98
v_max_f32 v84, v84, v85
v_mul_f32 v84, v84, v230
v_max3_f32 v81, v99, v112, v113
v_max3_f32 v80, v80, v114, v115
v_max_f32 v82, v80, v81
v_max_f32 v81, v80, v81
v_max3_f32 v76, v92, v93, v94
v_max3_f32 v77, v95, v108, v109
v_permlane16_swap_b32 v82, v81
v_max3_f32 v76, v76, v110, v111
v_max_f32 v80, v82, v81
v_max_f32 v81, v82, v81
v_max_f32 v78, v76, v77
v_max_f32 v77, v76, v77
v_permlane32_swap_b32 v80, v81
v_pk_fma_f32 v[104:105], v[104:105], v[234:235], v[88:89] op_sel_hi:[1,0,0] neg_lo:[0,0,1] neg_hi:[0,0,1]
v_max_f32 v80, v80, v81
v_mul_f32 v80, v80, v226
v_permlane16_swap_b32 v78, v77
v_pk_fma_f32 v[106:107], v[106:107], v[234:235], v[88:89] op_sel_hi:[1,0,0] neg_lo:[0,0,1] neg_hi:[0,0,1]
v_max_f32 v76, v78, v77
v_max_f32 v77, v78, v77
v_pk_fma_f32 v[120:121], v[120:121], v[234:235], v[88:89] op_sel_hi:[1,0,0] neg_lo:[0,0,1] neg_hi:[0,0,1]
v_pk_fma_f32 v[122:123], v[122:123], v[234:235], v[88:89] op_sel_hi:[1,0,0] neg_lo:[0,0,1] neg_hi:[0,0,1]
v_permlane32_swap_b32 v76, v77
v_pk_fma_f32 v[100:101], v[100:101], v[230:231], v[84:85] op_sel_hi:[1,0,0] neg_lo:[0,0,1] neg_hi:[0,0,1]
v_max_f32 v76, v76, v77
v_mul_f32 v76, v76, v222
v_pk_fma_f32 v[102:103], v[102:103], v[230:231], v[84:85] op_sel_hi:[1,0,0] neg_lo:[0,0,1] neg_hi:[0,0,1]
v_pk_fma_f32 v[116:117], v[116:117], v[230:231], v[84:85] op_sel_hi:[1,0,0] neg_lo:[0,0,1] neg_hi:[0,0,1]
v_pk_fma_f32 v[118:119], v[118:119], v[230:231], v[84:85] op_sel_hi:[1,0,0] neg_lo:[0,0,1] neg_hi:[0,0,1]
v_pk_fma_f32 v[96:97], v[96:97], v[226:227], v[80:81] op_sel_hi:[1,0,0] neg_lo:[0,0,1] neg_hi:[0,0,1]
v_pk_fma_f32 v[98:99], v[98:99], v[226:227], v[80:81] op_sel_hi:[1,0,0] neg_lo:[0,0,1] neg_hi:[0,0,1]
v_pk_fma_f32 v[112:113], v[112:113], v[226:227], v[80:81] op_sel_hi:[1,0,0] neg_lo:[0,0,1] neg_hi:[0,0,1]
v_pk_fma_f32 v[114:115], v[114:115], v[226:227], v[80:81] op_sel_hi:[1,0,0] neg_lo:[0,0,1] neg_hi:[0,0,1]
v_pk_fma_f32 v[92:93], v[92:93], v[222:223], v[76:77] op_sel_hi:[1,0,0] neg_lo:[0,0,1] neg_hi:[0,0,1]
v_pk_fma_f32 v[94:95], v[94:95], v[222:223], v[76:77] op_sel_hi:[1,0,0] neg_lo:[0,0,1] neg_hi:[0,0,1]
v_pk_fma_f32 v[108:109], v[108:109], v[222:223], v[76:77] op_sel_hi:[1,0,0] neg_lo:[0,0,1] neg_hi:[0,0,1]
v_pk_fma_f32 v[110:111], v[110:111], v[222:223], v[76:77] op_sel_hi:[1,0,0] neg_lo:[0,0,1] neg_hi:[0,0,1]
v_pk_fma_f32 v[136:137], v[18:19], v[44:45], v[136:137] op_sel_hi:[1,0,1]
v_pk_mul_f32 v[136:137], v[136:137], v[22:23]
v_pk_fma_f32 v[138:139], v[20:21], v[44:45], v[138:139] op_sel_hi:[1,0,1]
v_pk_mul_f32 v[138:139], v[138:139], v[24:25]
v_pk_fma_f32 v[152:153], v[18:19], v[44:45], v[152:153] op_sel:[0,1,0] op_sel_hi:[1,1,1]
v_pk_mul_f32 v[152:153], v[152:153], v[22:23]
v_pk_fma_f32 v[154:155], v[20:21], v[44:45], v[154:155] op_sel:[0,1,0] op_sel_hi:[1,1,1]
v_pk_mul_f32 v[154:155], v[154:155], v[24:25]
v_exp_f32 v104, v104
s_nop 0
MAA 132,8,96
v_exp_f32 v105, v105
MAA 132,28,100
v_exp_f32 v106, v106
MAA 132,48,160
v_exp_f32 v107, v107
MAA 132,68,164
v_exp_f32 v120, v120
MAA 148,68,172
v_exp_f32 v121, v121
MAA 148,48,168
v_exp_f32 v122, v122
MAA 148,28,124
v_exp_f32 v123, v123
MAA 148,8,120
v_exp_f32 v100, v100
MAA 128,4,96
v_exp_f32 v101, v101
MAA 128,24,100
v_exp_f32 v102, v102
MAA 128,44,160
v_exp_f32 v103, v103
MAA 128,64,164
v_exp_f32 v116, v116
MAA 144,64,172
v_exp_f32 v117, v117
MAA 144,44,168
v_exp_f32 v118, v118
MAA 144,24,124
v_exp_f32 v119, v119
MAA 144,4,120
v_exp_f32 v96, v96
MAA 124,0,96
v_exp_f32 v97, v97
MAA 124,20,100
v_exp_f32 v98, v98
MAA 124,40,160
v_exp_f32 v99, v99
MAA 124,60,164
v_exp_f32 v112, v112
MAA 140,60,172
v_exp_f32 v113, v113
MAA 140,40,168
v_exp_f32 v114, v114
MAA 140,20,124
v_exp_f32 v115, v115
MAA 140,0,120
v_cvt_pk_bf16_f32 v72, v104, v105
v_cvt_pk_bf16_f32 v73, v106, v107
v_cvt_pk_bf16_f32 v74, v120, v121
v_cvt_pk_bf16_f32 v75, v122, v123
v_cvt_pk_bf16_f32 v68, v100, v101
v_cvt_pk_bf16_f32 v69, v102, v103
v_cvt_pk_bf16_f32 v70, v116, v117
v_cvt_pk_bf16_f32 v71, v118, v119
v_cvt_pk_bf16_f32 v64, v96, v97
v_cvt_pk_bf16_f32 v65, v98, v99
v_cvt_pk_bf16_f32 v66, v112, v113
v_cvt_pk_bf16_f32 v67, v114, v115
v_cvt_pk_bf16_f32 v208, v136, v137
v_cvt_pk_bf16_f32 v209, v138, v139
v_cvt_pk_bf16_f32 v218, v152, v153
v_cvt_pk_bf16_f32 v219, v154, v155
s_waitcnt lgkmcnt(5)
v_pk_fma_f32 v[132:133], v[240:241], v[44:45], v[132:133] op_sel_hi:[1,0,1]
s_waitcnt lgkmcnt(4)
v_pk_mul_f32 v[132:133], v[132:133], v[244:245]
v_cvt_pk_bf16_f32 v206, v132, v133
v_pk_fma_f32 v[134:135], v[242:243], v[44:45], v[134:135] op_sel_hi:[1,0,1]
v_pk_mul_f32 v[134:135], v[134:135], v[246:247]
v_cvt_pk_bf16_f32 v207, v134, v135
v_pk_fma_f32 v[148:149], v[240:241], v[44:45], v[148:149] op_sel:[0,1,0] op_sel_hi:[1,1,1]
v_pk_mul_f32 v[148:149], v[148:149], v[244:245]
v_cvt_pk_bf16_f32 v216, v148, v149
v_pk_fma_f32 v[150:151], v[242:243], v[44:45], v[150:151] op_sel:[0,1,0] op_sel_hi:[1,1,1]
v_pk_mul_f32 v[150:151], v[150:151], v[246:247]
v_cvt_pk_bf16_f32 v217, v150, v151
s_waitcnt lgkmcnt(3)
v_pk_fma_f32 v[128:129], v[28:29], v[44:45], v[128:129] op_sel_hi:[1,0,1]
s_waitcnt lgkmcnt(2)
v_pk_mul_f32 v[128:129], v[128:129], v[32:33]
v_cvt_pk_bf16_f32 v204, v128, v129
v_pk_fma_f32 v[130:131], v[30:31], v[44:45], v[130:131] op_sel_hi:[1,0,1]
v_pk_mul_f32 v[130:131], v[130:131], v[34:35]
v_cvt_pk_bf16_f32 v205, v130, v131
v_pk_fma_f32 v[144:145], v[28:29], v[44:45], v[144:145] op_sel:[0,1,0] op_sel_hi:[1,1,1]
v_pk_mul_f32 v[144:145], v[144:145], v[32:33]
v_cvt_pk_bf16_f32 v214, v144, v145
v_pk_fma_f32 v[146:147], v[30:31], v[44:45], v[146:147] op_sel:[0,1,0] op_sel_hi:[1,1,1]
v_pk_mul_f32 v[146:147], v[146:147], v[34:35]
v_cvt_pk_bf16_f32 v215, v146, v147
s_waitcnt lgkmcnt(1)
v_pk_fma_f32 v[124:125], v[36:37], v[44:45], v[124:125] op_sel_hi:[1,0,1]
s_waitcnt lgkmcnt(0)
v_pk_mul_f32 v[124:125], v[124:125], v[40:41]
v_cvt_pk_bf16_f32 v202, v124, v125
v_pk_fma_f32 v[126:127], v[38:39], v[44:45], v[126:127] op_sel_hi:[1,0,1]
v_pk_mul_f32 v[126:127], v[126:127], v[42:43]
v_cvt_pk_bf16_f32 v203, v126, v127
v_pk_fma_f32 v[140:141], v[36:37], v[44:45], v[140:141] op_sel:[0,1,0] op_sel_hi:[1,1,1]
v_pk_mul_f32 v[140:141], v[140:141], v[40:41]
v_cvt_pk_bf16_f32 v212, v140, v141
v_pk_fma_f32 v[142:143], v[38:39], v[44:45], v[142:143] op_sel:[0,1,0] op_sel_hi:[1,1,1]
v_pk_mul_f32 v[142:143], v[142:143], v[42:43]
v_cvt_pk_bf16_f32 v213, v142, v143
s_nop 0
v_mfma_f32_16x16x32_bf16 v[88:91], v[248:251], v[72:75], 0
v_exp_f32 v92, v92
v_mfma_f32_16x16x32_bf16 v[104:107], v[206:209], v[72:75], 0
v_exp_f32 v93, v93
v_mfma_f32_16x16x32_bf16 v[120:123], v[216:219], v[72:75], 0
v_exp_f32 v94, v94
v_mfma_f32_16x16x32_bf16 v[84:87], v[248:251], v[68:71], 0
v_exp_f32 v95, v95
v_mfma_f32_16x16x32_bf16 v[100:103], v[204:207], v[68:71], 0
v_exp_f32 v108, v108
v_mfma_f32_16x16x32_bf16 v[116:119], v[214:217], v[68:71], 0
v_exp_f32 v109, v109
v_mfma_f32_16x16x32_bf16 v[80:83], v[248:251], v[64:67], 0
v_exp_f32 v110, v110
v_mfma_f32_16x16x32_bf16 v[96:99], v[202:205], v[64:67], 0
v_exp_f32 v111, v111
v_mfma_f32_16x16x32_bf16 v[112:115], v[212:215], v[64:67], 0
v_cvt_pk_bf16_f32 v60, v92, v93
v_cvt_pk_bf16_f32 v61, v94, v95
v_cvt_pk_bf16_f32 v62, v108, v109
v_cvt_pk_bf16_f32 v63, v110, v111
v_rcp_f32 v88, v88
v_rcp_f32 v84, v84
v_mfma_f32_16x16x32_bf16 v[76:79], v[248:251], v[60:63], 0
v_rcp_f32 v80, v80
v_mfma_f32_16x16x32_bf16 v[92:95], v[200:203], v[60:63], 0
v_mfma_f32_16x16x32_bf16 v[108:111], v[210:213], v[60:63], 0
s_nop 4
v_rcp_f32 v76, v76
v_pk_mul_f32 v[104:105], v[104:105], v[88:89] op_sel_hi:[1,0]
v_pk_mul_f32 v[106:107], v[106:107], v[88:89] op_sel_hi:[1,0]
v_pk_mul_f32 v[120:121], v[120:121], v[88:89] op_sel_hi:[1,0]
v_pk_mul_f32 v[122:123], v[122:123], v[88:89] op_sel_hi:[1,0]
v_cvt_pk_bf16_f32 v176, v104, v105
v_cvt_pk_bf16_f32 v177, v106, v107
v_cvt_pk_bf16_f32 v178, v120, v121
v_cvt_pk_bf16_f32 v179, v122, v123
buffer_store_dwordx4 v[176:179], v4, s[16:19], s74 offen offset:3072 sc1
v_pk_mul_f32 v[100:101], v[100:101], v[84:85] op_sel_hi:[1,0]
v_pk_mul_f32 v[102:103], v[102:103], v[84:85] op_sel_hi:[1,0]
v_pk_mul_f32 v[116:117], v[116:117], v[84:85] op_sel_hi:[1,0]
v_pk_mul_f32 v[118:119], v[118:119], v[84:85] op_sel_hi:[1,0]
v_cvt_pk_bf16_f32 v172, v100, v101
v_cvt_pk_bf16_f32 v173, v102, v103
v_cvt_pk_bf16_f32 v174, v116, v117
v_cvt_pk_bf16_f32 v175, v118, v119
buffer_store_dwordx4 v[172:175], v4, s[16:19], s74 offen offset:2048 sc1
v_pk_mul_f32 v[96:97], v[96:97], v[80:81] op_sel_hi:[1,0]
v_pk_mul_f32 v[98:99], v[98:99], v[80:81] op_sel_hi:[1,0]
v_pk_mul_f32 v[112:113], v[112:113], v[80:81] op_sel_hi:[1,0]
v_pk_mul_f32 v[114:115], v[114:115], v[80:81] op_sel_hi:[1,0]
v_cvt_pk_bf16_f32 v168, v96, v97
v_cvt_pk_bf16_f32 v169, v98, v99
v_cvt_pk_bf16_f32 v170, v112, v113
v_cvt_pk_bf16_f32 v171, v114, v115
buffer_store_dwordx4 v[168:171], v4, s[16:19], s74 offen offset:1024 sc1
v_pk_mul_f32 v[92:93], v[92:93], v[76:77] op_sel_hi:[1,0]
v_pk_mul_f32 v[94:95], v[94:95], v[76:77] op_sel_hi:[1,0]
v_pk_mul_f32 v[108:109], v[108:109], v[76:77] op_sel_hi:[1,0]
v_pk_mul_f32 v[110:111], v[110:111], v[76:77] op_sel_hi:[1,0]
v_cvt_pk_bf16_f32 v164, v92, v93
v_cvt_pk_bf16_f32 v165, v94, v95
v_cvt_pk_bf16_f32 v166, v108, v109
v_cvt_pk_bf16_f32 v167, v110, v111
buffer_store_dwordx4 v[164:167], v4, s[16:19], s74 offen sc1
s_nop 1
.Lqkve2:
s_mov_b32 s36, s0
s_mov_b32 s37, s1
s_lshl_b32 s62, s3, 11
s_add_u32 s62, s62, s84
v_lshl_add_u32 v4, v1, 4, s62
v_lshrrev_b32 v2, 3, v1
v_cmp_eq_u32 vcc, 3, v2
v_add_u32 v2, 67108480, v4
s_nop 0
v_cndmask_b32 v4, v4, v2, vcc
v_bfe_u32 v8, v1, 3, 2
v_mul_u32_u24 v8, 2080, v8
v_bfe_u32 v2, v1, 2, 1
v_lshl_add_u32 v8, v2, 7, v8
v_bfe_u32 v2, v1, 5, 1
v_lshl_add_u32 v8, v2, 8, v8
v_and_b32 v2, 3, v1
v_lshl_add_u32 v8, v2, 3, v8
s_mov_b32 s57, 66560
v_add_u32 v7, s57, v8
s_lshr_b32 s54, s87, 17
s_lshl_b32 s54, s54, 18
s_add_u32 s54, s54, 4194304
s_mov_b32 s52, s54
s_add_u32 s53, s54, 131072
v_accvgpr_read_b32 v32, a224
v_accvgpr_read_b32 v33, a225
v_accvgpr_read_b32 v34, a226
v_accvgpr_read_b32 v35, a227
v_accvgpr_read_b32 v36, a228
v_accvgpr_read_b32 v37, a229
v_accvgpr_read_b32 v38, a230
v_accvgpr_read_b32 v39, a231
v_accvgpr_read_b32 v40, a232
v_accvgpr_read_b32 v41, a233
v_accvgpr_read_b32 v42, a234
v_accvgpr_read_b32 v43, a235
v_accvgpr_read_b32 v44, a236
v_accvgpr_read_b32 v45, a237
v_accvgpr_read_b32 v46, a238
v_accvgpr_read_b32 v47, a239
v_accvgpr_read_b32 v48, a240
v_accvgpr_read_b32 v49, a241
v_accvgpr_read_b32 v50, a242
v_accvgpr_read_b32 v51, a243
v_accvgpr_read_b32 v52, a244
v_accvgpr_read_b32 v53, a245
v_accvgpr_read_b32 v54, a246
v_accvgpr_read_b32 v55, a247
v_accvgpr_read_b32 v56, a248
v_accvgpr_read_b32 v57, a249
v_accvgpr_read_b32 v58, a250
v_accvgpr_read_b32 v59, a251
v_accvgpr_read_b32 v60, a252
v_accvgpr_read_b32 v61, a253
v_accvgpr_read_b32 v62, a254
v_accvgpr_read_b32 v63, a255
s_lshl_b32 s62, s8, 10
s_add_u32 s62, s62, 30425088
s_lshl_b32 s64, s6, 10
s_add_u32 s64, s64, 30425088
s_lshr_b32 s67, s5, 2
s_and_b32 s67, s67, 3
s_lshl_b32 s67, s67, 7
s_add_u32 s64, s64, s67
v_lshl_add_u32 v252, v1, 7, s62
v_mov_b32 v253, s64
v_mov_b32 v255, 1
s_waitcnt vmcnt(0) lgkmcnt(0)
s_cmp_lg_u32 s3, 1
s_barrier
s_cbranch_scc1 .Lfirst35
s_mov_b64 exec, 15
buffer_atomic_add v255, v252, s[16:19], 0 offen
s_mov_b64 exec, 1
v_mov_b32 v254, 0
buffer_atomic_add v254, v253, s[16:19], 0 offen sc0
s_mov_b64 exec, -1
.Lfirst35:
s_add_u32 m0, s59, 66560
s_xor_b32 s58, s87, 0
buffer_load_dwordx4 v5, s[24:27], s58 offen lds
buffer_load_dwordx4 v6, s[24:27], s58 offen offset:1024 lds
s_add_u32 m0, s59, 116480
s_xor_b32 s58, s87, 786432
buffer_load_dwordx4 v5, s[24:27], s58 offen lds
buffer_load_dwordx4 v6, s[24:27], s58 offen offset:1024 lds
s_add_u32 m0, s59, 124800
s_xor_b32 s58, s87, 917504
buffer_load_dwordx4 v5, s[24:27], s58 offen lds
buffer_load_dwordx4 v6, s[24:27], s58 offen offset:1024 lds
s_add_u32 m0, s59, 49920
s_xor_b32 s58, s87, 1835008
buffer_load_dwordx4 v5, s[24:27], s58 offen lds
buffer_load_dwordx4 v6, s[24:27], s58 offen offset:1024 lds
s_add_u32 m0, s59, 58240
s_xor_b32 s58, s87, 1966080
buffer_load_dwordx4 v5, s[24:27], s58 offen lds
buffer_load_dwordx4 v6, s[24:27], s58 offen offset:1024 lds
s_cmp_lg_u32 s3, 1
s_cbranch_scc1 .Lnopoll34
s_mov_b64 exec, 1
s_mov_b32 s15, 0
v_mov_b32 v255, 0
buffer_atomic_add v255, v253, s[16:19], 0 offen sc0
s_waitcnt vmcnt(11)
v_cmp_gt_u32 vcc, 16, v254
s_nop 0
s_cbranch_vccz .Lnopoll34r
.Lpoll33:
s_waitcnt vmcnt(0)
v_cmp_gt_u32 vcc, 16, v255
s_add_u32 s15, s15, 1
s_cbranch_vccz .Lnopoll34r
v_mov_b32 v255, 0
buffer_atomic_add v255, v253, s[16:19], 0 offen sc0
s_cmp_le_u32 s15, 100000
s_cbranch_scc1 .Lpoll33
s_branch .Lnopoll34r
.Lnopoll34:
s_mov_b64 exec, 0
s_cmp_eq_u32 s3, 2
s_cbranch_scc1 .Lpad10
s_cmp_eq_u32 s3, 3
s_cbranch_scc1 .Lpad11
s_branch .Lpad12
.Lnopoll34r:
s_mov_b64 exec, -1
s_waitcnt vmcnt(8)
s_barrier
buffer_load_dwordx4 v[64:67], v4, s[16:19], s52 offen sc1
buffer_load_dwordx4 v[68:71], v4, s[16:19], s52 offen offset:1024 sc1
s_xor_b32 s52, s54, 262144
buffer_load_dwordx4 v[72:75], v4, s[16:19], s53 offen sc1
buffer_load_dwordx4 v[76:79], v4, s[16:19], s53 offen offset:1024 sc1
s_xor_b32 s53, s54, 393216
buffer_load_dwordx4 v[80:83], v4, s[16:19], s52 offen sc1
buffer_load_dwordx4 v[84:87], v4, s[16:19], s52 offen offset:1024 sc1
s_xor_b32 s52, s54, 524288
buffer_load_dwordx4 v[88:91], v4, s[16:19], s53 offen sc1
buffer_load_dwordx4 v[92:95], v4, s[16:19], s53 offen offset:1024 sc1
s_xor_b32 s53, s54, 655360
buffer_load_dwordx4 v[96:99], v4, s[16:19], s52 offen sc1
buffer_load_dwordx4 v[100:103], v4, s[16:19], s52 offen offset:1024 sc1
s_xor_b32 s52, s54, 786432
buffer_load_dwordx4 v[104:107], v4, s[16:19], s53 offen sc1
buffer_load_dwordx4 v[108:111], v4, s[16:19], s53 offen offset:1024 sc1
s_xor_b32 s53, s54, 917504
ds_read_b64_tr_b16 a[0:1], v7
TR 2,7,512
TR 16,7,1024
TR 18,7,1536
TR 4,7,32
TR 6,7,544
TR 20,7,1056
TR 22,7,1568
TR 8,7,64
TR 10,7,576
TR 24,7,1088
TR 26,7,1600
TR 12,7,96
TR 14,7,608
TR 28,7,1120
TR 30,7,1632
s_lshl_b32 s62, s49, 3
s_add_u32 s62, s62, s48
s_mul_i32 s62, s62, 28672
s_add_u32 s62, s62, s51
v_lshrrev_b32 v12, 4, v1
v_mul_u32_u24 v12, 57344, v12
v_and_b32 v2, 15, v1
v_lshl_add_u32 v12, v2, 4, v12
v_add_u32 v12, s62, v12
v_add_u32 v13, 6112, v12
v_add_u32 v14, 12224, v12
v_add_u32 v15, 18336, v12
s_mul_i32 s59, s3, 4224
s_mov_b32 s58, 0
s_waitcnt vmcnt(8) lgkmcnt(14)
MAV 32,0,64
TR 32,7,8320
s_waitcnt lgkmcnt(13)
MAV 32,16,72
buffer_load_dwordx4 v[112:115], v4, s[16:19], s52 offen sc1
MAV 48,16,76
TR 34,7,8832
MAV 48,0,68
TR 48,7,9344
TR 50,7,9856
s_waitcnt lgkmcnt(14)
MAV 52,4,68
TR 36,7,8352
s_waitcnt lgkmcnt(13)
MAV 52,20,76
buffer_load_dwordx4 v[116:119], v4, s[16:19], s52 offen offset:1024 sc1
MAV 36,20,72
TR 38,7,8864
s_xor_b32 s52, s54, 1048576
MAV 36,4,64
TR 52,7,9376
TR 54,7,9888
s_waitcnt lgkmcnt(14)
MAV 40,8,64
TR 40,7,8384
s_waitcnt lgkmcnt(13)
MAV 40,24,72
buffer_load_dwordx4 v[120:123], v4, s[16:19], s53 offen sc1
MAV 56,24,76
TR 42,7,8896
MAV 56,8,68
TR 56,7,9408
TR 58,7,9920
s_waitcnt lgkmcnt(14)
MAV 60,12,68
TR 44,7,8416
s_waitcnt lgkmcnt(13)
MAV 60,28,76
buffer_load_dwordx4 v[124:127], v4, s[16:19], s53 offen offset:1024 sc1
MAV 44,28,72
TR 46,7,8928
s_xor_b32 s53, s54, 1179648
MAV 44,12,64
TR 60,7,9440
TR 62,7,9952
s_waitcnt vmcnt(8) lgkmcnt(8)
MAV 32,32,80
TR 0,7,16640
MAV 32,48,88
buffer_load_dwordx4 v[64:67], v4, s[16:19], s52 offen sc1
MAV 48,48,92
TR 2,7,17152
MAV 48,32,84
TR 16,7,17664
TR 18,7,18176
MAV 52,36,84
TR 4,7,16672
MAV 52,52,92
buffer_load_dwordx4 v[68:71], v4, s[16:19], s52 offen offset:1024 sc1
MAV 36,52,88
TR 6,7,17184
s_xor_b32 s52, s54, 1310720
MAV 36,36,80
TR 20,7,17696
TR 22,7,18208
s_waitcnt lgkmcnt(8)
MAV 40,40,80
TR 8,7,16704
MAV 40,56,88
buffer_load_dwordx4 v[72:75], v4, s[16:19], s53 offen sc1
MAV 56,56,92
TR 10,7,17216
MAV 56,40,84
TR 24,7,17728
TR 26,7,18240
MAV 60,44,84
TR 12,7,16736
MAV 60,60,92
buffer_load_dwordx4 v[76:79], v4, s[16:19], s53 offen offset:1024 sc1
MAV 44,60,88
TR 14,7,17248
s_xor_b32 s53, s54, 1441792
MAV 44,44,80
TR 28,7,17760
TR 30,7,18272
s_waitcnt vmcnt(8) lgkmcnt(8)
MAV 32,0,96
TR 32,7,24960
MAV 32,16,104
buffer_load_dwordx4 v[80:83], v4, s[16:19], s52 offen sc1
MAV 48,16,108
TR 34,7,25472
MAV 48,0,100
TR 48,7,25984
TR 50,7,26496
MAV 52,4,100
TR 36,7,24992
MAV 52,20,108
buffer_load_dwordx4 v[84:87], v4, s[16:19], s52 offen offset:1024 sc1
MAV 36,20,104
TR 38,7,25504
s_xor_b32 s52, s54, 1572864
MAV 36,4,96
TR 52,7,26016
TR 54,7,26528
s_waitcnt lgkmcnt(8)
MAV 40,8,96
TR 40,7,25024
MAV 40,24,104
buffer_load_dwordx4 v[88:91], v4, s[16:19], s53 offen sc1
MAV 56,24,108
TR 42,7,25536
MAV 56,8,100
TR 56,7,26048
TR 58,7,26560
MAV 60,12,100
TR 44,7,25056
MAV 60,28,108
buffer_load_dwordx4 v[92:95], v4, s[16:19], s53 offen offset:1024 sc1
MAV 44,28,104
TR 46,7,25568
s_xor_b32 s53, s54, 1703936
MAV 44,12,96
TR 60,7,26080
TR 62,7,26592
s_barrier
s_waitcnt vmcnt(8) lgkmcnt(8)
MAV 32,32,112
TR 0,7,33280
MAV 32,48,120
buffer_load_dwordx4 v[96:99], v4, s[16:19], s52 offen sc1
MAV 48,48,124
TR 2,7,33792
MAV 48,32,116
TR 16,7,34304
.Lpad10:
s_cbranch_execz .Lpad13
TR 18,7,34816
MAV 52,36,116
TR 4,7,33312
MAV 52,52,124
buffer_load_dwordx4 v[100:103], v4, s[16:19], s52 offen offset:1024 sc1
MAV 36,52,120
TR 6,7,33824
s_xor_b32 s52, s54, 1835008
MAV 36,36,112
TR 20,7,34336
TR 22,7,34848
s_waitcnt lgkmcnt(8)
MAV 40,40,112
TR 8,7,33344
MAV 40,56,120
buffer_load_dwordx4 v[104:107], v4, s[16:19], s53 offen sc1
MAV 56,56,124
TR 10,7,33856
MAV 56,40,116
TR 24,7,34368
TR 26,7,34880
MAV 60,44,116
TR 12,7,33376
MAV 60,60,124
buffer_load_dwordx4 v[108:111], v4, s[16:19], s53 offen offset:1024 sc1
MAV 44,60,120
TR 14,7,33888
s_xor_b32 s53, s54, 1966080
MAV 44,44,112
TR 28,7,34400
TR 30,7,34912
s_waitcnt vmcnt(8) lgkmcnt(8)
MAV 32,0,64
TR 32,7,41600
MAV 32,16,72
buffer_load_dwordx4 v[112:115], v4, s[16:19], s52 offen sc1
MAV 48,16,76
TR 34,7,42112
MAV 48,0,68
TR 48,7,42624
TR 50,7,43136
MAV 52,4,68
TR 36,7,41632
MAV 52,20,76
buffer_load_dwordx4 v[116:119], v4, s[16:19], s52 offen offset:1024 sc1
MAV 36,20,72
TR 38,7,42144
s_xor_b32 s52, s54, 2097152
MAV 36,4,64
TR 52,7,42656
TR 54,7,43168
s_waitcnt lgkmcnt(8)
MAV 40,8,64
TR 40,7,41664
MAV 40,24,72
buffer_load_dwordx4 v[120:123], v4, s[16:19], s53 offen sc1
MAV 56,24,76
TR 42,7,42176
MAV 56,8,68
TR 56,7,42688
TR 58,7,43200
MAV 60,12,68
TR 44,7,41696
MAV 60,28,76
buffer_load_dwordx4 v[124:127], v4, s[16:19], s53 offen offset:1024 sc1
MAV 44,28,72
TR 46,7,42208
s_xor_b32 s53, s54, 2228224
MAV 44,12,64
TR 60,7,42720
TR 62,7,43232
s_waitcnt vmcnt(8) lgkmcnt(8)
MAV 32,32,80
TR 0,7,49920
MAV 32,48,88
buffer_load_dwordx4 v[64:67], v4, s[16:19], s52 offen sc1
MAV 48,48,92
TR 2,7,50432
MAV 48,32,84
TR 16,7,50944
TR 18,7,51456
MAV 52,36,84
TR 4,7,49952
MAV 52,52,92
buffer_load_dwordx4 v[68:71], v4, s[16:19], s52 offen offset:1024 sc1
MAV 36,52,88
TR 6,7,50464
s_xor_b32 s52, s54, 2359296
MAV 36,36,80
TR 20,7,50976
TR 22,7,51488
s_waitcnt lgkmcnt(8)
MAV 40,40,80
TR 8,7,49984
MAV 40,56,88
buffer_load_dwordx4 v[72:75], v4, s[16:19], s53 offen sc1
MAV 56,56,92
TR 10,7,50496
MAV 56,40,84
TR 24,7,51008
TR 26,7,51520
MAV 60,44,84
TR 12,7,50016
MAV 60,60,92
buffer_load_dwordx4 v[76:79], v4, s[16:19], s53 offen offset:1024 sc1
MAV 44,60,88
TR 14,7,50528
s_xor_b32 s53, s54, 2490368
MAV 44,44,80
TR 28,7,51040
TR 30,7,51552
s_waitcnt vmcnt(8) lgkmcnt(8)
MAV 32,0,96
TR 32,7,58240
MAV 32,16,104
buffer_load_dwordx4 v[80:83], v4, s[16:19], s52 offen sc1
MAV 48,16,108
TR 34,7,58752
MAV 48,0,100
TR 48,7,59264
TR 50,7,59776
MAV 52,4,100
TR 36,7,58272
MAV 52,20,108
buffer_load_dwordx4 v[84:87], v4, s[16:19], s52 offen offset:1024 sc1
MAV 36,20,104
TR 38,7,58784
s_xor_b32 s52, s54, 2621440
MAV 36,4,96
TR 52,7,59296
TR 54,7,59808
s_waitcnt lgkmcnt(8)
MAV 40,8,96
TR 40,7,58304
MAV 40,24,104
buffer_load_dwordx4 v[88:91], v4, s[16:19], s53 offen sc1
MAV 56,24,108
TR 42,7,58816
MAV 56,8,100
TR 56,7,59328
TR 58,7,59840
MAV 60,12,100
TR 44,7,58336
MAV 60,28,108
buffer_load_dwordx4 v[92:95], v4, s[16:19], s53 offen offset:1024 sc1
MAV 44,28,104
TR 46,7,58848
s_xor_b32 s53, s54, 2752512
MAV 44,12,96
TR 60,7,59360
TR 62,7,59872
s_xor_b32 s57, s57, 66560
v_add_u32 v7, s57, v8
s_waitcnt vmcnt(8) lgkmcnt(8)
MAV 32,32,112
ds_read_b64_tr_b16 a[0:1], v7
MAV 32,48,120
buffer_load_dwordx4 v[96:99], v4, s[16:19], s52 offen sc1
MAV 48,48,124
TR 2,7,512
MAV 48,32,116
TR 16,7,1024
TR 18,7,1536
MAV 52,36,116
TR 4,7,32
MAV 52,52,124
buffer_load_dwordx4 v[100:103], v4, s[16:19], s52 offen offset:1024 sc1
MAV 36,52,120
TR 6,7,544
s_xor_b32 s52, s54, 2883584
MAV 36,36,112
TR 20,7,1056
TR 22,7,1568
s_waitcnt lgkmcnt(8)
MAV 40,40,112
TR 8,7,64
MAV 40,56,120
buffer_load_dwordx4 v[104:107], v4, s[16:19], s53 offen sc1
MAV 56,56,124
TR 10,7,576
MAV 56,40,116
TR 24,7,1088
TR 26,7,1600
MAV 60,44,116
TR 12,7,96
MAV 60,60,124
buffer_load_dwordx4 v[108:111], v4, s[16:19], s53 offen offset:1024 sc1
MAV 44,60,120
TR 14,7,608
s_xor_b32 s53, s54, 3014656
MAV 44,44,112
TR 28,7,1120
TR 30,7,1632
s_waitcnt vmcnt(8) lgkmcnt(8)
MAV 32,0,64
TR 32,7,8320
MAV 32,16,72
buffer_load_dwordx4 v[112:115], v4, s[16:19], s52 offen sc1
MAV 48,16,76
TR 34,7,8832
MAV 48,0,68
TR 48,7,9344
TR 50,7,9856
MAV 52,4,68
TR 36,7,8352
MAV 52,20,76
buffer_load_dwordx4 v[116:119], v4, s[16:19], s52 offen offset:1024 sc1
MAV 36,20,72
TR 38,7,8864
s_xor_b32 s52, s54, 3145728
MAV 36,4,64
TR 52,7,9376
TR 54,7,9888
s_waitcnt lgkmcnt(8)
MAV 40,8,64
TR 40,7,8384
MAV 40,24,72
buffer_load_dwordx4 v[120:123], v4, s[16:19], s53 offen sc1
MAV 56,24,76
TR 42,7,8896
MAV 56,8,68
TR 56,7,9408
TR 58,7,9920
MAV 60,12,68
TR 44,7,8416
MAV 60,28,76
buffer_load_dwordx4 v[124:127], v4, s[16:19], s53 offen offset:1024 sc1
MAV 44,28,72
TR 46,7,8928
s_xor_b32 s53, s54, 3276800
MAV 44,12,64
TR 60,7,9440
TR 62,7,9952
s_waitcnt vmcnt(8) lgkmcnt(8)
MAV 32,32,80
TR 0,7,16640
MAV 32,48,88
buffer_load_dwordx4 v[64:67], v4, s[16:19], s52 offen sc1
MAV 48,48,92
TR 2,7,17152
MAV 48,32,84
TR 16,7,17664
TR 18,7,18176
MAV 52,36,84
TR 4,7,16672
MAV 52,52,92
buffer_load_dwordx4 v[68:71], v4, s[16:19], s52 offen offset:1024 sc1
MAV 36,52,88
TR 6,7,17184
s_xor_b32 s52, s54, 3407872
MAV 36,36,80
TR 20,7,17696
TR 22,7,18208
s_waitcnt lgkmcnt(8)
MAV 40,40,80
TR 8,7,16704
MAV 40,56,88
buffer_load_dwordx4 v[72:75], v4, s[16:19], s53 offen sc1
MAV 56,56,92
TR 10,7,17216
MAV 56,40,84
TR 24,7,17728
TR 26,7,18240
MAV 60,44,84
TR 12,7,16736
MAV 60,60,92
buffer_load_dwordx4 v[76:79], v4, s[16:19], s53 offen offset:1024 sc1
MAV 44,60,88
TR 14,7,17248
s_xor_b32 s53, s54, 3538944
MAV 44,44,80
TR 28,7,17760
TR 30,7,18272
s_waitcnt vmcnt(8) lgkmcnt(8)
MAV 32,0,96
TR 32,7,24960
MAV 32,16,104
buffer_load_dwordx4 v[80:83], v4, s[16:19], s52 offen sc1
MAV 48,16,108
TR 34,7,25472
MAV 48,0,100
TR 48,7,25984
TR 50,7,26496
MAV 52,4,100
TR 36,7,24992
MAV 52,20,108
buffer_load_dwordx4 v[84:87], v4, s[16:19], s52 offen offset:1024 sc1
MAV 36,20,104
TR 38,7,25504
s_xor_b32 s52, s54, 3670016
MAV 36,4,96
TR 52,7,26016
TR 54,7,26528
s_waitcnt lgkmcnt(8)
MAV 40,8,96
TR 40,7,25024
MAV 40,24,104
buffer_load_dwordx4 v[88:91], v4, s[16:19], s53 offen sc1
MAV 56,24,108
TR 42,7,25536
MAV 56,8,100
TR 56,7,26048
TR 58,7,26560
MAV 60,12,100
TR 44,7,25056
MAV 60,28,108
buffer_load_dwordx4 v[92:95], v4, s[16:19], s53 offen offset:1024 sc1
MAV 44,28,104
TR 46,7,25568
s_xor_b32 s53, s54, 3801088
MAV 44,12,96
TR 60,7,26080
TR 62,7,26592
s_waitcnt vmcnt(8) lgkmcnt(8)
MAV 32,32,112
TR 0,7,33280
MAV 32,48,120
buffer_load_dwordx4 v[96:99], v4, s[16:19], s52 offen sc1
MAV 48,48,124
TR 2,7,33792
MAV 48,32,116
TR 16,7,34304
TR 18,7,34816
MAV 52,36,116
TR 4,7,33312
MAV 52,52,124
buffer_load_dwordx4 v[100:103], v4, s[16:19], s52 offen offset:1024 sc1
MAV 36,52,120
TR 6,7,33824
s_xor_b32 s52, s54, 3932160
MAV 36,36,112
TR 20,7,34336
TR 22,7,34848
s_waitcnt lgkmcnt(8)
MAV 40,40,112
TR 8,7,33344
MAV 40,56,120
buffer_load_dwordx4 v[104:107], v4, s[16:19], s53 offen sc1
MAV 56,56,124
TR 10,7,33856
MAV 56,40,116
TR 24,7,34368
TR 26,7,34880
MAV 60,44,116
TR 12,7,33376
MAV 60,60,124
buffer_load_dwordx4 v[108:111], v4, s[16:19], s53 offen offset:1024 sc1
MAV 44,60,120
TR 14,7,33888
s_xor_b32 s53, s54, 4063232
MAV 44,44,112
TR 28,7,34400
TR 30,7,34912
s_waitcnt vmcnt(8) lgkmcnt(8)
MAV 32,0,64
TR 32,7,41600
MAV 32,16,72
buffer_load_dwordx4 v[112:115], v4, s[16:19], s52 offen sc1
MAV 48,16,76
TR 34,7,42112
MAV 48,0,68
TR 48,7,42624
TR 50,7,43136
MAV 52,4,68
TR 36,7,41632
MAV 52,20,76
buffer_load_dwordx4 v[116:119], v4, s[16:19], s52 offen offset:1024 sc1
MAV 36,20,72
TR 38,7,42144
MAV 36,4,64
TR 52,7,42656
TR 54,7,43168
s_waitcnt lgkmcnt(8)
MAV 40,8,64
TR 40,7,41664
MAV 40,24,72
buffer_load_dwordx4 v[120:123], v4, s[16:19], s53 offen sc1
MAV 56,24,76
TR 42,7,42176
MAV 56,8,68
TR 56,7,42688
TR 58,7,43200
MAV 60,12,68
TR 44,7,41696
MAV 60,28,76
buffer_load_dwordx4 v[124:127], v4, s[16:19], s53 offen offset:1024 sc1
MAV 44,28,72
TR 46,7,42208
MAV 44,12,64
TR 60,7,42720
TR 62,7,43232
s_barrier
s_waitcnt vmcnt(8) lgkmcnt(8)
MAV 32,32,80
TR 0,7,49920
s_add_u32 m0, s59, 84480
MAV 32,48,88
buffer_load_dwordx4 v12, s[32:35], s58 offen lds
MAV 48,48,92
TR 2,7,50432
MAV 48,32,84
TR 16,7,50944
TR 18,7,51456
MAV 52,36,84
TR 4,7,49952
MAV 52,52,92
TR 6,7,50464
TR 20,7,50976
MAV 36,52,88
TR 22,7,51488
MAV 36,36,80
TR 8,7,49984
s_waitcnt lgkmcnt(9)
MAV 40,40,80
TR 10,7,50496
MAV 40,56,88
buffer_load_dwordx4 v13, s[32:35], s58 offen offset:1056 lds
MAV 56,56,92
TR 24,7,51008
MAV 56,40,84
buffer_load_dwordx4 v14, s[32:35], s58 offen offset:2112 lds
MAV 60,44,84
TR 26,7,51520
MAV 60,60,92
TR 12,7,50016
TR 14,7,50528
MAV 44,60,88
TR 28,7,51040
MAV 44,44,80
TR 30,7,51552
s_waitcnt vmcnt(7) lgkmcnt(8)
MAV 32,0,96
TR 32,7,58240
MAV 32,16,104
buffer_load_dwordx4 v15, s[32:35], s58 offen offset:3168 lds
MAV 48,16,108
TR 34,7,58752
MAV 48,0,100
TR 48,7,59264
TR 50,7,59776
MAV 52,4,100
TR 36,7,58272
MAV 52,20,108
TR 38,7,58784
TR 52,7,59296
MAV 36,20,104
TR 54,7,59808
MAV 36,4,96
TR 40,7,58304
s_waitcnt lgkmcnt(9)
MAV 40,8,96
TR 42,7,58816
s_add_u32 m0, s59, 101376
MAV 40,24,104
buffer_load_dwordx4 v12, s[80:83], s58 offen lds
MAV 56,24,108
TR 56,7,59328
MAV 56,8,100
buffer_load_dwordx4 v13, s[80:83], s58 offen offset:1056 lds
MAV 60,12,100
TR 58,7,59840
MAV 60,28,108
TR 44,7,58336
TR 46,7,58848
MAV 44,28,104
TR 60,7,59360
MAV 44,12,96
TR 62,7,59872
s_waitcnt vmcnt(9) lgkmcnt(14)
MAV 32,32,112
buffer_load_dwordx4 v14, s[80:83], s58 offen offset:2112 lds
s_waitcnt vmcnt(8) lgkmcnt(12)
MAV 32,48,120
s_lshl_b32 s64, s6, 14
s_lshl_b32 s65, s49, 13
s_add_u32 s64, s64, s65
s_waitcnt vmcnt(7)
MAV 48,48,124
s_lshl_b32 s65, s7, 9
s_add_u32 s64, s64, s65
s_lshl_b32 s65, s48, 8
MAV 48,32,116
s_add_u32 s64, s64, s65
s_add_u32 s64, s64, 29622272
v_and_b32 v152, 31, v1
s_waitcnt lgkmcnt(10)
MAV 52,36,116
buffer_load_dwordx4 v15, s[80:83], s58 offen offset:3168 lds
s_waitcnt lgkmcnt(8)
MAV 52,52,124
s_add_u32 s58, s58, 458752
v_lshlrev_b32 v152, 3, v152
v_lshrrev_b32 v153, 5, v1
MAV 36,52,120
s_lshl_b32 s62, s7, 18
v_lshl_add_u32 v152, v153, 28, v152
s_add_u32 s62, s62, 8388608
MAV 36,36,112
s_add_u32 s63, s62, 131072
v_cvt_pk_bf16_f32 v128, v32, v33
v_cvt_pk_bf16_f32 v129, v34, v35
s_waitcnt lgkmcnt(6)
MAV 40,40,112
v_cvt_pk_bf16_f32 v136, v48, v49
v_cvt_pk_bf16_f32 v137, v50, v51
s_waitcnt lgkmcnt(4)
MAV 40,56,120
v_cvt_pk_bf16_f32 v130, v36, v37
v_cvt_pk_bf16_f32 v131, v38, v39
MAV 56,56,124
buffer_store_dwordx4 v[128:131], v4, s[16:19], s62 offen sc1
MAV 56,40,116
v_cvt_pk_bf16_f32 v138, v52, v53
v_cvt_pk_bf16_f32 v139, v54, v55
s_waitcnt lgkmcnt(2)
MAV 60,44,116
v_cvt_pk_bf16_f32 v132, v40, v41
v_cvt_pk_bf16_f32 v133, v42, v43
s_waitcnt lgkmcnt(0)
MAV 60,60,124
v_cvt_pk_bf16_f32 v140, v56, v57
MAV 44,60,120
buffer_store_dwordx4 v[136:139], v4, s[16:19], s62 offen offset:1024 sc1
MAV 44,44,112
v_cvt_pk_bf16_f32 v141, v58, v59
s_nop 2
v_cvt_pk_bf16_f32 v142, v60, v61
v_pk_mul_f32 v[146:147], v[32:33], v[32:33]
v_pk_mul_f32 v[150:151], v[48:49], v[48:49]
v_cvt_pk_bf16_f32 v143, v62, v63
v_pk_fma_f32 v[146:147], v[34:35], v[34:35], v[146:147]
v_pk_add_f32 v[144:145], v[32:33], v[34:35]
v_pk_fma_f32 v[150:151], v[50:51], v[50:51], v[150:151]
v_cvt_pk_bf16_f32 v134, v44, v45
v_cvt_pk_bf16_f32 v135, v46, v47
.Lpad11:
s_cbranch_execz .Lpad14
buffer_store_dwordx4 v[132:135], v4, s[16:19], s63 offen sc1
v_pk_add_f32 v[148:149], v[48:49], v[50:51]
v_pk_fma_f32 v[146:147], v[36:37], v[36:37], v[146:147]
v_pk_add_f32 v[144:145], v[144:145], v[36:37]
v_pk_fma_f32 v[150:151], v[52:53], v[52:53], v[150:151]
v_pk_add_f32 v[148:149], v[148:149], v[52:53]
v_pk_fma_f32 v[146:147], v[38:39], v[38:39], v[146:147]
v_pk_add_f32 v[144:145], v[144:145], v[38:39]
v_pk_fma_f32 v[150:151], v[54:55], v[54:55], v[150:151]
v_pk_add_f32 v[148:149], v[148:149], v[54:55]
v_pk_fma_f32 v[146:147], v[40:41], v[40:41], v[146:147]
v_pk_add_f32 v[144:145], v[144:145], v[40:41]
v_pk_fma_f32 v[150:151], v[56:57], v[56:57], v[150:151]
v_pk_add_f32 v[148:149], v[148:149], v[56:57]
buffer_store_dwordx4 v[140:143], v4, s[16:19], s63 offen offset:1024 sc1
v_pk_fma_f32 v[146:147], v[42:43], v[42:43], v[146:147]
v_pk_add_f32 v[144:145], v[144:145], v[42:43]
v_pk_fma_f32 v[150:151], v[58:59], v[58:59], v[150:151]
v_pk_add_f32 v[148:149], v[148:149], v[58:59]
v_pk_fma_f32 v[146:147], v[44:45], v[44:45], v[146:147]
v_pk_add_f32 v[144:145], v[144:145], v[44:45]
v_pk_fma_f32 v[150:151], v[60:61], v[60:61], v[150:151]
v_pk_add_f32 v[148:149], v[148:149], v[60:61]
v_pk_fma_f32 v[146:147], v[46:47], v[46:47], v[146:147]
v_pk_add_f32 v[144:145], v[144:145], v[46:47]
v_pk_fma_f32 v[150:151], v[62:63], v[62:63], v[150:151]
v_pk_add_f32 v[148:149], v[148:149], v[62:63]
v_add_f32 v144, v144, v145
v_add_f32 v146, v146, v147
v_add_f32 v148, v148, v149
v_add_f32 v150, v150, v151
s_nop 0
v_permlane16_swap_b32 v144, v148
v_permlane16_swap_b32 v146, v150
v_add_f32 v144, v144, v148
v_add_f32 v146, v146, v150
s_nop 1
v_permlane32_swap_b32 v144, v146
v_add_f32 v144, v144, v146
s_nop 1
v_permlane32_swap_b32 v144, v145
buffer_store_dwordx2 v[144:145], v152, s[16:19], s64 offen sc1
s_nop 1
s_mov_b32 s54, s58
s_mov_b32 s55, s59
v_accvgpr_write_b32 a224, v32
v_accvgpr_write_b32 a225, v33
v_accvgpr_write_b32 a226, v34
v_accvgpr_write_b32 a227, v35
v_accvgpr_write_b32 a228, v36
v_accvgpr_write_b32 a229, v37
v_accvgpr_write_b32 a230, v38
v_accvgpr_write_b32 a231, v39
v_accvgpr_write_b32 a232, v40
v_accvgpr_write_b32 a233, v41
v_accvgpr_write_b32 a234, v42
v_accvgpr_write_b32 a235, v43
v_accvgpr_write_b32 a236, v44
v_accvgpr_write_b32 a237, v45
v_accvgpr_write_b32 a238, v46
v_accvgpr_write_b32 a239, v47
v_accvgpr_write_b32 a240, v48
v_accvgpr_write_b32 a241, v49
v_accvgpr_write_b32 a242, v50
v_accvgpr_write_b32 a243, v51
v_accvgpr_write_b32 a244, v52
v_accvgpr_write_b32 a245, v53
v_accvgpr_write_b32 a246, v54
v_accvgpr_write_b32 a247, v55
v_accvgpr_write_b32 a248, v56
v_accvgpr_write_b32 a249, v57
v_accvgpr_write_b32 a250, v58
v_accvgpr_write_b32 a251, v59
v_accvgpr_write_b32 a252, v60
v_accvgpr_write_b32 a253, v61
v_accvgpr_write_b32 a254, v62
v_accvgpr_write_b32 a255, v63
s_lshl_b32 s62, s10, 14
s_lshl_b32 s63, s3, 12
s_add_u32 s62, s62, s63
s_lshl_b32 s63, s12, 11
s_add_u32 s62, s62, s63
v_lshl_add_u32 v10, v1, 4, s62
v_lshrrev_b32 v2, 3, v1
v_cmp_eq_u32 vcc, 3, v2
v_add_u32 v2, 67108480, v10
s_nop 0
v_cndmask_b32 v10, v10, v2, vcc
v_xor_b32 v11, 2048, v10
v_bfe_u32 v16, v1, 2, 3
v_mul_u32_u24 v16, 1056, v16
v_bfe_u32 v2, v1, 5, 1
v_lshl_add_u32 v16, v2, 8, v16
v_and_b32 v2, 3, v1
v_lshl_add_u32 v16, v2, 3, v16
s_lshl_b32 s62, s12, 6
s_add_u32 s62, s62, 84480
s_xor_b32 s63, s12, 1
s_mul_i32 s63, s63, 192
s_add_u32 s63, s63, 84480
v_add_u32 v17, s63, v16
v_add_u32 v16, s62, v16
s_mov_b32 s52, 8388608
s_mov_b32 s53, 8388608
s_mul_i32 s59, s3, 2112
s_and_b32 s62, s7, 1
s_mul_i32 s62, s62, 3670016
s_lshr_b32 s63, s7, 1
s_lshl_b32 s63, s63, 8
s_add_u32 s62, s62, s63
s_lshl_b32 s63, s3, 12
s_add_u32 s62, s62, s63
v_lshrrev_b32 v5, 4, v1
v_lshlrev_b32 v5, 14, v5
v_and_b32 v2, 15, v1
v_lshl_add_u32 v5, v2, 4, v5
v_add_u32 v5, s62, v5
v_add_u32 v6, 992, v5
s_lshl_b32 s62, s10, 15
s_lshl_b32 s63, s3, 13
s_add_u32 s62, s62, s63
v_lshl_add_u32 v4, v1, 4, s62
s_and_b32 s47, s5, 3
s_lshr_b32 s63, s5, 2
s_lshl_b32 s63, s63, 3
s_add_u32 s63, s63, s4
s_lshl_b32 s62, s63, 1
s_add_u32 s62, s62, s48
s_mul_i32 s62, s62, 1792
v_lshrrev_b32 v7, 1, v1
v_min_u32 v8, 13, v7
v_lshl_add_u32 v8, v8, 7, s62
s_lshl_b32 s62, s63, 2
s_add_u32 s62, s62, s3
s_mul_i32 s62, s62, 640
v_and_b32 v7, 15, v7
v_min_u32 v7, 4, v7
v_lshl_add_u32 v7, v7, 7, s62
v_lshrrev_b32 v2, 5, v1
v_mul_u32_u24 v2, 3670016, v2
v_add_u32 v7, v7, v2
s_mul_i32 s44, s47, 163840
s_add_u32 s45, s47, 12
s_mul_i32 s45, s45, 229376
v_and_b32 v6, 3, v1
v_cmp_eq_u32 vcc, 3, v6
v_mov_b32 v2, 0x3f80
v_mov_b32 v20, 1.0
v_cndmask_b32 v2, v2, v20, vcc
v_cndmask_b32 v6, v6, 0, vcc
v_or_b32 v6, 12, v6
v_mul_u32_u24 v6, 0x1111, v6
v_lshl_or_b32 v6, v6, 16, v6
v_bfe_u32 v22, v1, 2, 2
v_cmp_eq_u32 vcc, 0, v22
s_nop 1
v_cndmask_b32 v20, 0, v2, vcc
v_cmp_eq_u32 vcc, 1, v22
s_nop 1
v_cndmask_b32 v21, 0, v2, vcc
v_accvgpr_write_b32 a208, v20
v_accvgpr_write_b32 a209, v21
v_accvgpr_write_b32 a210, v20
v_accvgpr_write_b32 a211, v21
v_accvgpr_write_b32 a212, 0
v_accvgpr_write_b32 a213, 0
v_accvgpr_write_b32 a214, 0
v_accvgpr_write_b32 a215, 0
v_accvgpr_write_b32 a216, 0
v_accvgpr_write_b32 a217, 0
v_accvgpr_write_b32 a218, 0
v_accvgpr_write_b32 a219, 0
s_cmp_lt_u32 s3, 2
s_cselect_b32 s40, s32, s80
s_cselect_b32 s41, s33, s81
s_cselect_b32 s42, s34, s82
s_add_u32 s62, s55, 84480
v_lshl_add_u32 v9, v1, 4, s62
s_lshl_b32 s62, s6, 10
s_add_u32 s62, s62, 30441472
s_lshl_b32 s64, s10, 1
s_lshl_b32 s64, s64, 10
s_add_u32 s64, s64, 30441472
s_lshr_b32 s67, s5, 2
s_and_b32 s67, s67, 3
s_lshl_b32 s67, s67, 7
s_add_u32 s64, s64, s67
s_add_u32 s65, s64, 1024
v_lshl_add_u32 v252, v1, 7, s62
v_mov_b32 v253, s64
v_mov_b32 v255, 1
v_writelane_b32 v253, s65, 1
s_waitcnt vmcnt(0) lgkmcnt(0)
s_cmp_lg_u32 s3, 1
s_barrier
s_cbranch_scc1 .Lfirst38
s_mov_b64 exec, 15
buffer_atomic_add v255, v252, s[16:19], 0 offen
s_mov_b64 exec, 3
v_mov_b32 v254, 0
buffer_atomic_add v254, v253, s[16:19], 0 offen sc0
s_mov_b64 exec, -1
.Lfirst38:
s_add_u32 m0, s55, 118272
s_nop 0
buffer_load_dwordx4 v12, s[32:35], s54 offen lds
buffer_load_dwordx4 v13, s[32:35], s54 offen offset:1056 lds
buffer_load_dwordx4 v14, s[32:35], s54 offen offset:2112 lds
buffer_load_dwordx4 v15, s[32:35], s54 offen offset:3168 lds
s_add_u32 m0, s55, 135168
s_nop 0
buffer_load_dwordx4 v12, s[80:83], s54 offen lds
buffer_load_dwordx4 v13, s[80:83], s54 offen offset:1056 lds
buffer_load_dwordx4 v14, s[80:83], s54 offen offset:2112 lds
buffer_load_dwordx4 v15, s[80:83], s54 offen offset:3168 lds
s_add_u32 s54, s54, 458752
s_cmp_lg_u32 s3, 1
s_cbranch_scc1 .Lnopoll37
s_mov_b64 exec, 3
s_mov_b32 s15, 0
v_mov_b32 v255, 0
buffer_atomic_add v255, v253, s[16:19], 0 offen sc0
s_waitcnt vmcnt(9)
v_cmp_gt_u32 vcc, 16, v254
s_nop 0
s_cbranch_vccz .Lnopoll37r
.Lpoll36:
s_waitcnt vmcnt(0)
v_cmp_gt_u32 vcc, 16, v255
s_add_u32 s15, s15, 1
s_cbranch_vccz .Lnopoll37r
v_mov_b32 v255, 0
buffer_atomic_add v255, v253, s[16:19], 0 offen sc0
s_cmp_le_u32 s15, 100000
s_cbranch_scc1 .Lpoll36
s_branch .Lnopoll37r
.Lnopoll37:
s_mov_b64 exec, 0
s_cmp_eq_u32 s3, 2
s_cbranch_scc1 .Lpad16
s_cmp_eq_u32 s3, 3
s_cbranch_scc1 .Lpad17
s_branch .Lpad18
.Lnopoll37r:
s_mov_b64 exec, -1
s_waitcnt vmcnt(9)
s_barrier
buffer_load_dwordx4 a[128:131], v10, s[16:19], s52 offen sc1
buffer_load_dwordx4 a[132:135], v10, s[16:19], s52 offen offset:1024 sc1
s_add_u32 s52, s52, 131072
buffer_load_dwordx4 a[144:147], v10, s[16:19], s52 offen sc1
buffer_load_dwordx4 a[148:151], v10, s[16:19], s52 offen offset:1024 sc1
s_add_u32 s52, s52, 131072
buffer_load_dwordx4 a[136:139], v11, s[16:19], s53 offen sc1
buffer_load_dwordx4 a[140:143], v11, s[16:19], s53 offen offset:1024 sc1
s_add_u32 s53, s53, 131072
buffer_load_dwordx4 a[152:155], v11, s[16:19], s53 offen sc1
buffer_load_dwordx4 a[156:159], v11, s[16:19], s53 offen offset:1024 sc1
s_add_u32 s53, s53, 131072
ds_read_b64_tr_b16 a[0:1], v16
TR 2,16,512
TR 4,16,8448
TR 6,16,8960
TR 8,16,32
TR 10,16,544
TR 12,16,8480
TR 14,16,8992
TR 16,16,64
TR 18,16,576
TR 20,16,8512
TR 22,16,9024
TR 24,16,96
TR 26,16,608
TR 28,16,8544
TR 30,16,9056
TR 32,16,128
TR 34,16,640
TR 36,16,8576
TR 38,16,9088
TR 40,16,160
TR 42,16,672
TR 44,16,8608
TR 46,16,9120
ds_read_b64_tr_b16 a[48:49], v17
TR 50,17,512
TR 52,17,8448
TR 54,17,8960
TR 56,17,32
TR 58,17,544
TR 60,17,8480
TR 62,17,8992
ds_read_b128 a[192:195], v9
RD 196,9,1056
RD 200,9,2112
RD 204,9,3168
s_lshl_b32 s57, s3, 13
s_add_u32 s57, s57, 49920
v_lshl_add_u32 v2, v1, 4, s57
s_waitcnt lgkmcnt(0)
s_barrier
s_waitcnt vmcnt(7)
v_mfma_f32_16x16x32_bf16 v[32:35], a[0:3], a[128:131], 0
buffer_load_dwordx4 a[160:163], v10, s[16:19], s52 offen sc1
s_waitcnt vmcnt(6)
MAA 32,4,144
TR 64,16,16896
v_smfmac_f32_16x16x64_bf16 a[212:215], a[208:211], a[192:199], v6
TR 66,16,17408
v_smfmac_f32_16x16x64_bf16 a[212:215], a[208:211], a[200:207], v6
TR 68,16,25344
v_mfma_f32_16x16x32_bf16 v[36:39], a[0:3], a[132:135], 0
TR 70,16,25856
s_waitcnt vmcnt(5)
MAA 36,4,148
buffer_load_dwordx4 a[164:167], v10, s[16:19], s52 offen offset:1024 sc1
v_mfma_f32_16x16x32_bf16 v[52:55], a[8:11], a[132:135], 0
TR 72,16,16928
s_add_u32 s52, s52, 131072
MAA 52,12,148
TR 74,16,17440
v_mfma_f32_16x16x32_bf16 v[48:51], a[8:11], a[128:131], 0
TR 76,16,25376
MAA 48,12,144
TR 78,16,25888
v_mfma_f32_16x16x32_bf16 v[96:99], a[16:19], a[128:131], 0
buffer_load_dwordx4 a[176:179], v10, s[16:19], s52 offen sc1
MAA 96,20,144
TR 80,16,16960
v_mfma_f32_16x16x32_bf16 v[100:103], a[16:19], a[132:135], 0
TR 82,16,17472
MAA 100,20,148
TR 84,16,25408
v_mfma_f32_16x16x32_bf16 v[116:119], a[24:27], a[132:135], 0
TR 86,16,25920
MAA 116,28,148
buffer_load_dwordx4 a[180:183], v10, s[16:19], s52 offen offset:1024 sc1
v_mfma_f32_16x16x32_bf16 v[112:115], a[24:27], a[128:131], 0
TR 88,16,16992
s_add_u32 s52, s52, 131072
MAA 112,28,144
TR 90,16,17504
v_mfma_f32_16x16x32_bf16 v[160:163], a[32:35], a[128:131], 0
TR 92,16,25440
MAA 160,36,144
TR 94,16,25952
v_mfma_f32_16x16x32_bf16 v[164:167], a[32:35], a[132:135], 0
buffer_load_dwordx4 a[168:171], v11, s[16:19], s53 offen sc1
MAA 164,36,148
TR 96,16,17024
v_mfma_f32_16x16x32_bf16 v[180:183], a[40:43], a[132:135], 0
TR 98,16,17536
MAA 180,44,148
TR 100,16,25472
v_mfma_f32_16x16x32_bf16 v[176:179], a[40:43], a[128:131], 0
TR 102,16,25984
MAA 176,44,144
buffer_load_dwordx4 a[172:175], v11, s[16:19], s53 offen offset:1024 sc1
v_mfma_f32_16x16x32_bf16 v[224:227], a[48:51], a[128:131], 0
TR 104,16,17056
s_add_u32 s53, s53, 131072
MAA 224,52,144
TR 106,16,17568
v_mfma_f32_16x16x32_bf16 v[228:231], a[48:51], a[132:135], 0
TR 108,16,25504
MAA 228,52,148
TR 110,16,26016
v_mfma_f32_16x16x32_bf16 v[236:239], a[56:59], a[132:135], 0
buffer_load_dwordx4 a[184:187], v11, s[16:19], s53 offen sc1
MAA 236,60,148
TR 112,17,16896
v_mfma_f32_16x16x32_bf16 v[232:235], a[56:59], a[128:131], 0
TR 114,17,17408
MAA 232,60,144
TR 116,17,25344
s_waitcnt vmcnt(7)
v_mfma_f32_16x16x32_bf16 v[188:191], a[40:43], a[140:143], 0
TR 118,17,25856
MAA 188,44,156
buffer_load_dwordx4 a[188:191], v11, s[16:19], s53 offen offset:1024 sc1
v_mfma_f32_16x16x32_bf16 v[184:187], a[40:43], a[136:139], 0
TR 120,17,16928
s_add_u32 s53, s53, 131072
MAA 184,44,152
TR 122,17,17440
s_add_u32 m0, s55, 84480
v_mfma_f32_16x16x32_bf16 v[168:171], a[32:35], a[136:139], 0
TR 124,17,25376
MAA 168,36,152
TR 126,17,25888
v_mfma_f32_16x16x32_bf16 v[172:175], a[32:35], a[140:143], 0
buffer_load_dwordx4 v12, s[32:35], s54 offen lds
MAA 172,36,156
RD 192,9,16896
v_mfma_f32_16x16x32_bf16 v[124:127], a[24:27], a[140:143], 0
RD 196,9,17952
MAA 124,28,156
RD 200,9,19008
v_mfma_f32_16x16x32_bf16 v[120:123], a[24:27], a[136:139], 0
RD 204,9,20064
MAA 120,28,152
buffer_load_dwordx4 v13, s[32:35], s54 offen offset:1056 lds
v_mfma_f32_16x16x32_bf16 v[104:107], a[16:19], a[136:139], 0
MAA 104,20,152
v_mfma_f32_16x16x32_bf16 v[108:111], a[16:19], a[140:143], 0
MAA 108,20,156
v_mfma_f32_16x16x32_bf16 v[60:63], a[8:11], a[140:143], 0
buffer_load_dwordx4 v14, s[32:35], s54 offen offset:2112 lds
MAA 60,12,156
v_mfma_f32_16x16x32_bf16 v[56:59], a[8:11], a[136:139], 0
MAA 56,12,152
v_mfma_f32_16x16x32_bf16 v[40:43], a[0:3], a[136:139], 0
MAA 40,4,152
buffer_load_dwordx4 v15, s[32:35], s54 offen offset:3168 lds
v_mfma_f32_16x16x32_bf16 v[44:47], a[0:3], a[140:143], 0
MAA 44,4,156
s_waitcnt lgkmcnt(0)
s_barrier
v_mfma_f32_16x16x32_bf16 v[64:67], a[64:67], a[128:131], 0
TR 0,16,33792
s_add_u32 m0, s55, 101376
MAA 64,68,144
buffer_load_dwordx4 v12, s[80:83], s54 offen lds
v_smfmac_f32_16x16x64_bf16 a[216:219], a[208:211], a[192:199], v6
TR 2,16,34304
s_mul_i32 s66, s13, 114688
v_smfmac_f32_16x16x64_bf16 a[216:219], a[208:211], a[200:207], v6
TR 4,16,42240
s_mul_i32 s65, s10, 1818624
v_mfma_f32_16x16x32_bf16 v[68:71], a[64:67], a[132:135], 0
TR 6,16,42752
s_add_u32 s66, s66, s65
MAA 68,68,148
TR 8,16,33824
s_add_u32 s66, s66, 12582912
v_mfma_f32_16x16x32_bf16 v[84:87], a[72:75], a[132:135], 0
buffer_load_dwordx4 v13, s[80:83], s54 offen offset:1056 lds
MAA 84,76,148
TR 10,16,34336
s_add_u32 s65, s66, 49152
v_mfma_f32_16x16x32_bf16 v[80:83], a[72:75], a[128:131], 0
TR 12,16,42272
s_lshl_b32 s62, s12, 16
MAA 80,76,144
TR 14,16,42784
s_add_u32 s62, s62, s66
v_mfma_f32_16x16x32_bf16 v[128:131], a[80:83], a[128:131], 0
TR 16,16,33856
s_add_u32 s63, s62, 16384
MAA 128,84,144
buffer_load_dwordx4 v14, s[80:83], s54 offen offset:2112 lds
v_mfma_f32_16x16x32_bf16 v[132:135], a[80:83], a[132:135], 0
TR 18,16,34368
s_add_u32 s64, s62, 32768
MAA 132,84,148
TR 20,16,42304
s_lshl_b32 s72, s10, 1
v_mfma_f32_16x16x32_bf16 v[148:151], a[88:91], a[132:135], 0
TR 22,16,42816
s_lshr_b32 s74, s11, 4
MAA 148,92,148
TR 24,16,33888
s_add_u32 s72, s72, s74
v_mfma_f32_16x16x32_bf16 v[144:147], a[88:91], a[128:131], 0
buffer_load_dwordx4 v15, s[80:83], s54 offen offset:3168 lds
MAA 144,92,144
TR 26,16,34400
s_add_u32 s54, s54, 458752
v_mfma_f32_16x16x32_bf16 v[192:195], a[96:99], a[128:131], 0
TR 28,16,42336
s_add_u32 m0, s57, 0
MAA 192,100,144
TR 30,16,42848
s_mov_b32 s58, 29622272
v_mfma_f32_16x16x32_bf16 v[196:199], a[96:99], a[132:135], 0
TR 32,16,33920
s_lshl_b32 s72, s72, 10
MAA 196,100,148
buffer_load_dwordx4 v4, s[16:19], s58 offen sc1 lds
v_mfma_f32_16x16x32_bf16 v[212:215], a[104:107], a[132:135], 0
TR 34,16,34432
s_add_u32 s72, s72, 30457856
MAA 212,108,148
TR 36,16,42368
s_and_b32 s73, s6, 14
v_mfma_f32_16x16x32_bf16 v[208:211], a[104:107], a[128:131], 0
TR 38,16,42880
s_and_b32 s74, s7, 1
MAA 208,108,144
TR 40,16,33952
s_add_u32 s73, s73, s74
v_mfma_f32_16x16x32_bf16 v[240:243], a[112:115], a[128:131], 0
buffer_load_dwordx4 v4, s[16:19], s58 offen offset:1024 sc1 lds
MAA 240,116,144
TR 42,16,34464
s_lshl_b32 s73, s73, 10
v_mfma_f32_16x16x32_bf16 v[244:247], a[112:115], a[132:135], 0
TR 44,16,42400
s_add_u32 s73, s73, 30457856
MAA 244,116,148
TR 46,16,42912
s_lshr_b32 s67, s5, 2
v_mfma_f32_16x16x32_bf16 v[252:255], a[120:123], a[132:135], 0
TR 48,17,33792
MAA 252,124,148
TR 50,17,34304
v_mfma_f32_16x16x32_bf16 v[248:251], a[120:123], a[128:131], 0
buffer_load_dwordx4 a[128:131], v10, s[16:19], s52 offen sc1
MAA 248,124,144
TR 52,17,42240
v_mfma_f32_16x16x32_bf16 v[220:223], a[104:107], a[140:143], 0
TR 54,17,42752
MAA 220,108,156
TR 56,17,33824
v_mfma_f32_16x16x32_bf16 v[216:219], a[104:107], a[136:139], 0
TR 58,17,34336
MAA 216,108,152
buffer_load_dwordx4 a[132:135], v10, s[16:19], s52 offen offset:1024 sc1
v_mfma_f32_16x16x32_bf16 v[200:203], a[96:99], a[136:139], 0
TR 60,17,42272
s_add_u32 s52, s52, 131072
MAA 200,100,152
TR 62,17,42784
v_mfma_f32_16x16x32_bf16 v[204:207], a[96:99], a[140:143], 0
RD 192,9,33792
MAA 204,100,156
RD 196,9,34848
v_mfma_f32_16x16x32_bf16 v[156:159], a[88:91], a[140:143], 0
buffer_load_dwordx4 a[144:147], v10, s[16:19], s52 offen sc1
MAA 156,92,156
RD 200,9,35904
v_mfma_f32_16x16x32_bf16 v[152:155], a[88:91], a[136:139], 0
RD 204,9,36960
MAA 152,92,152
v_mfma_f32_16x16x32_bf16 v[136:139], a[80:83], a[136:139], 0
MAA 136,84,152
buffer_load_dwordx4 a[148:151], v10, s[16:19], s52 offen offset:1024 sc1
v_mfma_f32_16x16x32_bf16 v[140:143], a[80:83], a[140:143], 0
s_add_u32 s52, s52, 131072
MAA 140,84,156
v_mfma_f32_16x16x32_bf16 v[92:95], a[72:75], a[140:143], 0
MAA 92,76,156
v_mfma_f32_16x16x32_bf16 v[88:91], a[72:75], a[136:139], 0
MAA 88,76,152
v_mfma_f32_16x16x32_bf16 v[72:75], a[64:67], a[136:139], 0
MAA 72,68,152
v_mfma_f32_16x16x32_bf16 v[76:79], a[64:67], a[140:143], 0
MAA 76,68,156
s_waitcnt vmcnt(18) lgkmcnt(0)
s_barrier
MAA 32,0,160
buffer_load_dwordx4 a[136:139], v11, s[16:19], s53 offen sc1
MAA 32,4,176
TR 64,16,50688
s_and_b32 s67, s67, 3
v_smfmac_f32_16x16x64_bf16 a[212:215], a[208:211], a[192:199], v6
TR 66,16,51200
s_lshl_b32 s67, s67, 7
v_smfmac_f32_16x16x64_bf16 a[212:215], a[208:211], a[200:207], v6
TR 68,16,59136
s_add_u32 s73, s73, s67
MAA 36,4,180
TR 70,16,59648
s_and_b32 s74, s7, 1
MAA 36,0,164
buffer_load_dwordx4 a[140:143], v11, s[16:19], s53 offen offset:1024 sc1
MAA 52,8,164
TR 72,16,50720
s_add_u32 s53, s53, 131072
MAA 52,12,180
TR 74,16,51232
s_mul_i32 s87, s74, 917504
MAA 48,12,176
TR 76,16,59168
s_lshr_b32 s75, s6, 1
MAA 48,8,160
TR 78,16,59680
s_mul_i32 s75, s75, 1818624
MAA 96,16,160
buffer_load_dwordx4 a[152:155], v11, s[16:19], s53 offen sc1
MAA 96,20,176
TR 80,16,50752
s_add_u32 s87, s87, s75
MAA 100,20,180
TR 82,16,51264
s_add_u32 s87, s87, 12582912
MAA 100,16,164
TR 84,16,59200
s_and_b32 s74, s6, 3
MAA 116,24,164
TR 86,16,59712
.Lpad12:
s_cbranch_execz .Lpad15
s_xor_b32 s75, s74, 0
MAA 116,28,180
buffer_load_dwordx4 a[156:159], v11, s[16:19], s53 offen offset:1024 sc1
MAA 112,28,176
TR 88,16,50784
s_add_u32 s53, s53, 131072
MAA 112,24,160
TR 90,16,51296
s_add_u32 m0, s55, 118272
MAA 160,32,160
TR 92,16,59232
s_sub_u32 s75, s75, 0
MAA 160,36,176
TR 94,16,59744
s_mul_i32 s98, s75, 458752
MAA 164,36,180
buffer_load_dwordx4 v12, s[32:35], s54 offen lds
MAA 164,32,164
TR 96,16,50816
s_mul_i32 s75, s75, 114688
MAA 180,40,164
TR 98,16,51328
s_add_u32 s76, s87, s75
MAA 180,44,180
TR 100,16,59264
s_xor_b32 s75, s74, 1
MAA 176,44,176
TR 102,16,59776
s_sub_u32 s75, s75, 1
MAA 176,40,160
buffer_load_dwordx4 v13, s[32:35], s54 offen offset:1056 lds
MAA 224,48,160
TR 104,16,50848
s_mul_i32 s99, s75, 458752
MAA 224,52,176
TR 106,16,51360
s_mul_i32 s75, s75, 114688
MAA 228,52,180
TR 108,16,59296
s_add_u32 s77, s87, s75
MAA 228,48,164
TR 110,16,59808
MAA 236,56,164
buffer_load_dwordx4 v14, s[32:35], s54 offen offset:2112 lds
MAA 236,60,180
TR 112,17,50688
MAA 232,60,176
TR 114,17,51200
MAA 232,56,160
TR 116,17,59136
s_waitcnt vmcnt(21)
MAA 188,40,172
TR 118,17,59648
MAA 188,44,188
buffer_load_dwordx4 v15, s[32:35], s54 offen offset:3168 lds
MAA 184,44,184
TR 120,17,50720
s_add_u32 m0, s57, 2048
MAA 184,40,168
TR 122,17,51232
s_mov_b32 s58, 29624320
MAA 168,32,168
TR 124,17,59168
MAA 168,36,184
TR 126,17,59680
MAA 172,36,188
buffer_load_dwordx4 v4, s[16:19], s58 offen sc1 lds
MAA 172,32,172
RD 192,9,50688
MAA 124,24,172
RD 196,9,51744
MAA 124,28,188
RD 200,9,52800
MAA 120,28,184
RD 204,9,53856
MAA 120,24,168
buffer_load_dwordx4 v4, s[16:19], s58 offen offset:1024 sc1 lds
MAA 104,16,168
MAA 104,20,184
MAA 108,20,188
MAA 108,16,172
MAA 60,8,172
MAA 60,12,188
MAA 56,12,184
MAA 56,8,168
MAA 40,0,168
MAA 40,4,184
MAA 44,4,188
MAA 44,0,172
s_waitcnt vmcnt(20) lgkmcnt(0)
s_barrier
MAA 64,64,160
ds_read_b64_tr_b16 a[0:1], v16
s_add_u32 m0, s55, 135168
MAA 64,68,176
buffer_load_dwordx4 v12, s[80:83], s54 offen lds
v_smfmac_f32_16x16x64_bf16 a[216:219], a[208:211], a[192:199], v6
TR 2,16,512
s_xor_b32 s75, s74, 2
v_smfmac_f32_16x16x64_bf16 a[216:219], a[208:211], a[200:207], v6
TR 4,16,8448
s_sub_u32 s75, s75, 2
MAA 68,68,180
TR 6,16,8960
s_mul_i32 s100, s75, 458752
MAA 68,64,164
TR 8,16,32
s_mul_i32 s75, s75, 114688
MAA 84,72,164
buffer_load_dwordx4 v13, s[80:83], s54 offen offset:1056 lds
MAA 84,76,180
TR 10,16,544
s_add_u32 s78, s87, s75
MAA 80,76,176
TR 12,16,8480
s_xor_b32 s75, s74, 3
MAA 80,72,160
TR 14,16,8992
s_sub_u32 s75, s75, 3
MAA 128,80,160
TR 16,16,64
s_mul_i32 s101, s75, 458752
MAA 128,84,176
buffer_load_dwordx4 v14, s[80:83], s54 offen offset:2112 lds
MAA 132,84,180
TR 18,16,576
s_mul_i32 s75, s75, 114688
MAA 132,80,164
TR 20,16,8512
s_add_u32 s79, s87, s75
MAA 148,88,164
TR 22,16,9024
s_and_b32 s87, s6, 3
MAA 148,92,180
TR 24,16,96
s_mov_b32 s46, 0
MAA 144,92,176
buffer_load_dwordx4 v15, s[80:83], s54 offen offset:3168 lds
MAA 144,88,160
TR 26,16,608
s_add_u32 s54, s54, 458752
MAA 192,96,160
TR 28,16,8544
s_add_u32 m0, s57, 4096
MAA 192,100,176
TR 30,16,9056
s_mov_b32 s58, 29626368
MAA 196,100,180
TR 32,16,128
s_lshl_b32 s74, s3, 10
MAA 196,96,164
buffer_load_dwordx4 v4, s[16:19], s58 offen sc1 lds
MAA 212,104,164
TR 34,16,640
s_lshl_b32 s75, s12, 9
MAA 212,108,180
TR 36,16,8576
s_add_u32 s74, s74, s75
MAA 208,108,176
TR 38,16,9088
s_add_u32 s74, s74, 152576
MAA 208,104,160
TR 40,16,160
v_and_b32 v18, 15, v1
MAA 240,112,160
buffer_load_dwordx4 v4, s[16:19], s58 offen offset:1024 sc1 lds
MAA 240,116,176
TR 42,16,672
v_lshl_add_u32 v18, v18, 4, s74
MAA 244,116,180
TR 44,16,8608
v_xor_b32 v19, 512, v18
MAA 244,112,164
TR 46,16,9120
MAA 252,120,164
ds_read_b64_tr_b16 a[48:49], v17
MAA 252,124,180
TR 50,17,512
MAA 248,124,176
TR 52,17,8448
MAA 248,120,160
buffer_load_dwordx4 a[160:163], v10, s[16:19], s52 offen sc1
MAA 220,104,172
TR 54,17,8960
MAA 220,108,188
TR 56,17,32
MAA 216,108,184
TR 58,17,544
MAA 216,104,168
TR 60,17,8480
MAA 200,96,168
buffer_load_dwordx4 a[164:167], v10, s[16:19], s52 offen offset:1024 sc1
MAA 200,100,184
TR 62,17,8992
s_add_u32 s52, s52, 131072
MAA 204,100,188
ds_read_b128 a[192:195], v9
MAA 204,96,172
RD 196,9,1056
MAA 156,88,172
RD 200,9,2112
MAA 156,92,188
buffer_load_dwordx4 a[176:179], v10, s[16:19], s52 offen sc1
MAA 152,92,184
RD 204,9,3168
MAA 152,88,168
MAA 136,80,168
MAA 136,84,184
MAA 140,84,188
buffer_load_dwordx4 a[180:183], v10, s[16:19], s52 offen offset:1024 sc1
MAA 140,80,172
s_add_u32 s52, s52, 131072
MAA 92,72,172
MAA 92,76,188
MAA 88,76,184
MAA 88,72,168
MAA 72,64,168
MAA 72,68,184
MAA 76,68,188
MAA 76,64,172
s_waitcnt vmcnt(20) lgkmcnt(0)
s_barrier
MAA 32,0,128
buffer_load_dwordx4 a[168:171], v11, s[16:19], s53 offen sc1
MAA 32,4,144
ds_read_b128 v[20:23], v2
v_smfmac_f32_16x16x64_bf16 a[212:215], a[208:211], a[192:199], v6
ds_read_b128 v[28:31], v2 offset:1024
v_smfmac_f32_16x16x64_bf16 a[212:215], a[208:211], a[200:207], v6
s_waitcnt vmcnt(11)
ds_read_b128 v[24:27], v2 offset:2048
MAA 36,4,148
TR 64,16,16896
MAA 36,0,132
buffer_load_dwordx4 a[172:175], v11, s[16:19], s53 offen offset:1024 sc1
MAA 52,8,132
TR 66,16,17408
s_add_u32 s53, s53, 131072
MAA 52,12,148
TR 68,16,25344
MAA 48,12,144
TR 70,16,25856
MAA 48,8,128
TR 72,16,16928
MAA 96,16,128
buffer_load_dwordx4 a[184:187], v11, s[16:19], s53 offen sc1
MAA 96,20,144
TR 74,16,17440
s_waitcnt lgkmcnt(7)
v_add_f32 v20, v20, v28
MAA 100,20,148
TR 76,16,25376
v_add_f32 v21, v21, v29
MAA 100,16,132
TR 78,16,25888
v_add_f32 v22, v22, v30
MAA 116,24,132
TR 80,16,16960
v_add_f32 v23, v23, v31
MAA 116,28,148
buffer_load_dwordx4 a[188:191], v11, s[16:19], s53 offen offset:1024 sc1
MAA 112,28,144
ds_read_b128 v[28:31], v2 offset:3072
s_add_u32 s53, s53, 131072
MAA 112,24,128
TR 82,16,17472
s_add_u32 m0, s55, 84480
MAA 160,32,128
TR 84,16,25408
s_waitcnt lgkmcnt(12)
v_add_f32 v20, v20, v24
MAA 160,36,144
TR 86,16,25920
v_add_f32 v21, v21, v25
MAA 164,36,148
buffer_load_dwordx4 v12, s[32:35], s54 offen lds
MAA 164,32,132
TR 88,16,16992
v_add_f32 v22, v22, v26
MAA 180,40,132
TR 90,16,17504
v_add_f32 v23, v23, v27
MAA 180,44,148
TR 92,16,25440
MAA 176,44,144
TR 94,16,25952
MAA 176,40,128
buffer_load_dwordx4 v13, s[32:35], s54 offen offset:1056 lds
MAA 224,48,128
TR 96,16,17024
MAA 224,52,144
TR 98,16,17536
MAA 228,52,148
TR 100,16,25472
MAA 228,48,132
TR 102,16,25984
MAA 236,56,132
buffer_load_dwordx4 v14, s[32:35], s54 offen offset:2112 lds
MAA 236,60,148
TR 104,16,17056
MAA 232,60,144
TR 106,16,17568
MAA 232,56,128
TR 108,16,25504
MAA 188,40,140
TR 110,16,26016
MAA 188,44,156
buffer_load_dwordx4 v15, s[32:35], s54 offen offset:3168 lds
MAA 184,44,152
TR 112,17,16896
s_add_u32 m0, s57, 6144
MAA 184,40,136
TR 114,17,17408
s_mov_b32 s58, 29628416
MAA 168,32,136
TR 116,17,25344
MAA 168,36,152
TR 118,17,25856
MAA 172,36,156
buffer_load_dwordx4 v4, s[16:19], s58 offen sc1 lds
MAA 172,32,140
TR 120,17,16928
MAA 124,24,140
TR 122,17,17440
MAA 124,28,156
TR 124,17,25376
MAA 120,28,152
TR 126,17,25888
MAA 120,24,136
buffer_load_dwordx4 v4, s[16:19], s58 offen offset:1024 sc1 lds
MAA 104,16,136
RD 192,9,16896
MAA 104,20,152
RD 196,9,17952
MAA 108,20,156
RD 200,9,19008
MAA 108,16,140
RD 204,9,20064
MAA 60,8,140
MAA 60,12,156
MAA 56,12,152
MAA 56,8,136
MAA 40,0,136
MAA 40,4,152
MAA 44,4,156
s_sub_u32 s47, s47, 1
s_cbranch_scc1 .Lx39
.Lx39b:
MAA 44,0,140
s_waitcnt lgkmcnt(0)
s_barrier
MAA 64,64,128
s_waitcnt vmcnt(14)
ds_read_b128 v[24:27], v2 offset:4096
s_add_u32 m0, s55, 101376
MAA 64,68,144
buffer_load_dwordx4 v12, s[80:83], s54 offen lds
v_smfmac_f32_16x16x64_bf16 a[216:219], a[208:211], a[192:199], v6
TR 0,16,33792
v_add_f32 v20, v20, v28
v_smfmac_f32_16x16x64_bf16 a[216:219], a[208:211], a[200:207], v6
TR 2,16,34304
v_add_f32 v21, v21, v29
MAA 68,68,148
TR 4,16,42240
v_add_f32 v22, v22, v30
MAA 68,64,132
TR 6,16,42752
v_add_f32 v23, v23, v31
MAA 84,72,132
ds_read_b128 v[28:31], v2 offset:5120
MAA 84,76,148
TR 8,16,33824
MAA 80,76,144
buffer_load_dwordx4 v13, s[80:83], s54 offen offset:1056 lds
MAA 80,72,128
TR 10,16,34336
s_waitcnt lgkmcnt(7)
v_add_f32 v20, v20, v24
MAA 128,80,128
TR 12,16,42272
v_add_f32 v21, v21, v25
MAA 128,84,144
TR 14,16,42784
v_add_f32 v22, v22, v26
MAA 132,84,148
TR 16,16,33856
v_add_f32 v23, v23, v27
MAA 132,80,132
TR 18,16,34368
MAA 148,88,132
TR 20,16,42304
MAA 148,92,148
buffer_load_dwordx4 v14, s[80:83], s54 offen offset:2112 lds
MAA 144,92,144
TR 22,16,42816
MAA 144,88,128
TR 24,16,33888
MAA 192,96,128
TR 26,16,34400
MAA 192,100,144
TR 28,16,42336
MAA 196,100,148
TR 30,16,42848
MAA 196,96,132
TR 32,16,33920
MAA 212,104,132
buffer_load_dwordx4 v15, s[80:83], s54 offen offset:3168 lds
MAA 212,108,148
TR 34,16,34432
s_add_u32 s54, s54, 458752
MAA 208,108,144
TR 36,16,42368
MAA 208,104,128
TR 38,16,42880
MAA 240,112,128
TR 40,16,33952
MAA 240,116,144
TR 42,16,34464
MAA 244,116,148
TR 44,16,42400
MAA 244,112,132
TR 46,16,42912
MAA 252,120,132
TR 48,17,33792
MAA 252,124,148
TR 50,17,34304
MAA 248,124,144
TR 52,17,42240
MAA 248,120,128
buffer_load_dwordx4 a[128:131], v10, s[16:19], s52 offen sc1
MAA 220,104,140
TR 54,17,42752
MAA 220,108,156
TR 56,17,33824
MAA 216,108,152
TR 58,17,34336
MAA 216,104,136
TR 60,17,42272
MAA 200,96,136
TR 62,17,42784
MAA 200,100,152
RD 192,9,33792
MAA 204,100,156
buffer_load_dwordx4 a[132:135], v10, s[16:19], s52 offen offset:1024 sc1
MAA 204,96,140
RD 196,9,34848
s_add_u32 s52, s52, 131072
MAA 156,88,140
RD 200,9,35904
MAA 156,92,156
RD 204,9,36960
MAA 152,92,152
MAA 152,88,136
MAA 136,80,136
MAA 136,84,152
buffer_load_dwordx4 a[144:147], v10, s[16:19], s52 offen sc1
MAA 140,84,156
MAA 140,80,140
MAA 92,72,140
MAA 92,76,156
MAA 88,76,152
MAA 88,72,136
MAA 72,64,136
buffer_load_dwordx4 a[148:151], v10, s[16:19], s52 offen offset:1024 sc1
MAA 72,68,152
s_add_u32 s52, s52, 131072
MAA 76,68,156
s_sub_u32 s47, s47, 1
s_cbranch_scc1 .Lx40
.Lx40b:
MAA 76,64,140
s_waitcnt vmcnt(18) lgkmcnt(0)
s_barrier
MAA 32,0,160
buffer_load_dwordx4 a[136:139], v11, s[16:19], s53 offen sc1
MAA 32,4,176
s_waitcnt vmcnt(9)
ds_read_b128 v[24:27], v2 offset:6144
v_add_f32 v20, v20, v28
v_smfmac_f32_16x16x64_bf16 a[212:215], a[208:211], a[192:199], v6
TR 64,16,50688
v_add_f32 v21, v21, v29
v_smfmac_f32_16x16x64_bf16 a[212:215], a[208:211], a[200:207], v6
TR 66,16,51200
v_add_f32 v22, v22, v30
MAA 36,4,180
TR 68,16,59136
v_add_f32 v23, v23, v31
MAA 36,0,164
ds_read_b128 v[28:31], v2 offset:7168
MAA 52,8,164
TR 70,16,59648
MAA 52,12,180
buffer_load_dwordx4 a[140:143], v11, s[16:19], s53 offen offset:1024 sc1
MAA 48,12,176
TR 72,16,50720
s_add_u32 s53, s53, 131072
MAA 48,8,160
TR 74,16,51232
s_waitcnt lgkmcnt(7)
v_add_f32 v20, v20, v24
MAA 96,16,160
TR 76,16,59168
v_add_f32 v21, v21, v25
MAA 96,20,176
TR 78,16,59680
v_add_f32 v22, v22, v26
MAA 100,20,180
TR 80,16,50752
v_add_f32 v23, v23, v27
MAA 100,16,164
TR 82,16,51264
s_waitcnt lgkmcnt(7)
v_add_f32 v20, v20, v28
MAA 116,24,164
buffer_load_dwordx4 a[152:155], v11, s[16:19], s53 offen sc1
MAA 116,28,180
TR 84,16,59200
v_add_f32 v21, v21, v29
MAA 112,28,176
TR 86,16,59712
v_add_f32 v22, v22, v30
MAA 112,24,160
TR 88,16,50784
v_add_f32 v23, v23, v31
MAA 160,32,160
TR 90,16,51296
MAA 160,36,176
TR 92,16,59232
MAA 164,36,180
TR 94,16,59744
MAA 164,32,164
buffer_load_dwordx4 a[156:159], v11, s[16:19], s53 offen offset:1024 sc1
MAA 180,40,164
TR 96,16,50816
s_add_u32 s53, s53, 131072
MAA 180,44,180
TR 98,16,51328
s_add_u32 m0, s55, 118272
MAA 176,44,176
TR 100,16,59264
MAA 176,40,160
TR 102,16,59776
MAA 224,48,160
TR 104,16,50848
MAA 224,52,176
.Lpad13:
s_cbranch_execz .Lnopoll34r
TR 106,16,51360
MAA 228,52,180
buffer_load_dwordx4 v12, s[32:35], s54 offen lds
MAA 228,48,164
TR 108,16,59296
MAA 236,56,164
TR 110,16,59808
MAA 236,60,180
TR 112,17,50688
MAA 232,60,176
TR 114,17,51200
MAA 232,56,160
TR 116,17,59136
MAA 188,40,172
TR 118,17,59648
MAA 188,44,188
buffer_load_dwordx4 v13, s[32:35], s54 offen offset:1056 lds
MAA 184,44,184
TR 120,17,50720
MAA 184,40,168
TR 122,17,51232
MAA 168,32,168
TR 124,17,59168
MAA 168,36,184
TR 126,17,59680
MAA 172,36,188
RD 192,9,50688
MAA 172,32,172
RD 196,9,51744
MAA 124,24,172
buffer_load_dwordx4 v14, s[32:35], s54 offen offset:2112 lds
MAA 124,28,188
RD 200,9,52800
MAA 120,28,184
RD 204,9,53856
MAA 120,24,168
MAA 104,16,168
MAA 104,20,184
MAA 108,20,188
MAA 108,16,172
buffer_load_dwordx4 v15, s[32:35], s54 offen offset:3168 lds
MAA 60,8,172
MAA 60,12,188
MAA 56,12,184
MAA 56,8,168
MAA 40,0,168
MAA 40,4,184
MAA 44,4,188
s_sub_u32 s47, s47, 1
s_cbranch_scc1 .Lx41
.Lx41b:
MAA 44,0,172
s_waitcnt lgkmcnt(0)
s_barrier
MAA 64,64,160
ds_read_b64_tr_b16 a[0:1], v16
s_add_u32 m0, s55, 135168
MAA 64,68,176
buffer_load_dwordx4 v12, s[80:83], s54 offen lds
v_smfmac_f32_16x16x64_bf16 a[216:219], a[208:211], a[192:199], v6
TR 2,16,512
v_permlane32_swap_b32 v20, v22
v_smfmac_f32_16x16x64_bf16 a[216:219], a[208:211], a[200:207], v6
TR 4,16,8448
v_permlane32_swap_b32 v21, v23
MAA 68,68,180
TR 6,16,8960
v_add_f32 v20, v20, v22
MAA 68,64,164
TR 8,16,32
v_add_f32 v21, v21, v23
MAA 84,72,164
TR 10,16,544
v_mul_f32 v20, 0xba800000, v20
MAA 84,76,180
buffer_load_dwordx4 v13, s[80:83], s54 offen offset:1056 lds
MAA 80,76,176
TR 12,16,8480
v_mul_f32 v21, 0x3a800000, v21
MAA 80,72,160
TR 14,16,8992
v_fma_f32 v21, -v20, v20, v21
MAA 128,80,160
TR 16,16,64
v_max_f32 v21, 0, v21
MAA 128,84,176
TR 18,16,576
v_add_f32 v21, 0x3727c5ac, v21
MAA 132,84,180
TR 20,16,8512
v_rsq_f32 v22, v21
MAA 132,80,164
TR 22,16,9024
v_and_b32 v24, 31, v1
MAA 148,88,164
buffer_load_dwordx4 v14, s[80:83], s54 offen offset:2112 lds
MAA 148,92,180
TR 24,16,96
v_lshrrev_b32 v25, 5, v1
MAA 144,92,176
TR 26,16,608
v_lshl_add_u32 v24, v24, 1, v25
MAA 144,88,160
TR 28,16,8544
v_and_b32 v25, 0xc0, v0
MAA 192,96,160
TR 30,16,9056
v_add_u32 v24, v24, v25
MAA 192,100,176
TR 32,16,128
v_lshlrev_b32 v24, 4, v24
MAA 196,100,180
TR 34,16,640
v_add_u32 v24, 152576, v24
MAA 196,96,164
buffer_load_dwordx4 v15, s[80:83], s54 offen offset:3168 lds
MAA 212,104,164
TR 36,16,8576
s_add_u32 s54, s54, 458752
MAA 212,108,180
TR 38,16,9088
v_mul_f32 v22, 0xbfb8aa3b, v22
MAA 208,108,176
ds_write_b128 v24, v[20:23]
s_mov_b32 s58, s98
MAA 208,104,160
ds_read_b64 v[20:21], v18
s_mov_b32 s67, s59
MAA 240,112,160
ds_read_b64 v[22:23], v18 offset:256
MAA 240,116,176
ds_read_b64 v[24:25], v19
MAA 244,116,180
ds_read_b64 v[26:27], v19 offset:256
MAA 244,112,164
ds_read_b32 v28, v18 offset:8
MAA 252,120,164
ds_read_b32 v29, v18 offset:264
v_mov_b32 v18, v5
MAA 252,124,180
ds_read_b32 v30, v19 offset:8
MAA 248,124,176
ds_read_b32 v31, v19 offset:264
v_add_u32 v19, 992, v5
MAA 248,120,160
buffer_load_dwordx4 a[160:163], v10, s[16:19], s52 offen sc1
MAA 220,104,172
TR 40,16,160
MAA 220,108,188
TR 42,16,672
MAA 216,108,184
TR 44,16,8608
MAA 216,104,168
TR 46,16,9120
MAA 200,96,168
ds_read_b64_tr_b16 a[48:49], v17
MAA 200,100,184
TR 50,17,512
MAA 204,100,188
buffer_load_dwordx4 a[164:167], v10, s[16:19], s52 offen offset:1024 sc1
MAA 204,96,172
TR 52,17,8448
s_add_u32 s52, s52, 131072
MAA 156,88,172
TR 54,17,8960
MAA 156,92,188
TR 56,17,32
MAA 152,92,184
TR 58,17,544
MAA 152,88,168
TR 60,17,8480
MAA 136,80,168
TR 62,17,8992
MAA 136,84,184
buffer_load_dwordx4 a[176:179], v10, s[16:19], s52 offen sc1
MAA 140,84,188
ds_read_b128 a[192:195], v9
MAA 140,80,172
RD 196,9,1056
MAA 92,72,172
RD 200,9,2112
MAA 92,76,188
RD 204,9,3168
MAA 88,76,184
MAA 88,72,168
MAA 72,64,168
buffer_load_dwordx4 a[180:183], v10, s[16:19], s52 offen offset:1024 sc1
MAA 72,68,184
s_add_u32 s52, s52, 131072
MAA 76,68,188
s_sub_u32 s47, s47, 1
s_cbranch_scc1 .Lx42
.Lx42b:
MAA 76,64,172
s_mov_b32 s15, -5
.p2align 6
.Lk43:
s_waitcnt vmcnt(16) lgkmcnt(0)
s_barrier
MAA 32,0,128
TR 64,16,16896
MAA 32,4,144
buffer_load_dwordx4 a[168:171], v11, s[16:19], s53 offen sc1
v_smfmac_f32_16x16x64_bf16 a[212:215], a[208:211], a[192:199], v6
s_sub_u32 s47, s47, 1
s_cbranch_scc1 .Lx44
.Lx44b:
v_smfmac_f32_16x16x64_bf16 a[212:215], a[208:211], a[200:207], v6
TR 66,16,17408
MAA 36,4,148
TR 68,16,25344
MAA 36,0,132
TR 70,16,25856
MAA 52,8,132
TR 72,16,16928
MAA 52,12,148
buffer_load_dwordx4 a[172:175], v11, s[16:19], s53 offen offset:1024 sc1
MAA 48,12,144
TR 74,16,17440
s_add_u32 s53, s53, 131072
MAA 48,8,128
MAA 96,16,128
TR 76,16,25376
MAA 96,20,144
TR 78,16,25888
MAA 100,20,148
TR 80,16,16960
MAA 100,16,132
buffer_load_dwordx4 a[184:187], v11, s[16:19], s53 offen sc1
MAA 116,24,132
TR 82,16,17472
MAA 116,28,148
TR 84,16,25408
MAA 112,28,144
MAA 112,24,128
TR 86,16,25920
MAA 160,32,128
TR 88,16,16992
MAA 160,36,144
buffer_load_dwordx4 a[188:191], v11, s[16:19], s53 offen offset:1024 sc1
MAA 164,36,148
TR 90,16,17504
s_add_u32 s53, s53, 131072
MAA 164,32,132
TR 92,16,25440
MAA 180,40,132
TR 94,16,25952
MAA 180,44,148
MAA 176,44,144
TR 96,16,17024
s_add_u32 m0, s55, 84480
MAA 176,40,128
buffer_load_dwordx4 v12, s[32:35], s54 offen lds
MAA 224,48,128
TR 98,16,17536
MAA 224,52,144
TR 100,16,25472
MAA 228,52,148
TR 102,16,25984
MAA 228,48,132
TR 104,16,17056
MAA 236,56,132
MAA 236,60,148
TR 106,16,17568
MAA 232,60,144
TR 108,16,25504
MAA 232,56,128
TR 110,16,26016
s_waitcnt vmcnt(17)
MAA 188,40,140
TR 112,17,16896
MAA 188,44,156
buffer_load_dwordx4 v13, s[32:35], s54 offen offset:1056 lds
MAA 184,44,152
TR 114,17,17408
MAA 184,40,136
MAA 168,32,136
TR 116,17,25344
MAA 168,36,152
buffer_load_dwordx4 v14, s[32:35], s54 offen offset:2112 lds
MAA 172,36,156
TR 118,17,25856
MAA 172,32,140
TR 120,17,16928
MAA 124,24,140
TR 122,17,17440
MAA 124,28,156
TR 124,17,25376
MAA 120,28,152
MAA 120,24,136
buffer_load_dwordx4 v15, s[32:35], s54 offen offset:3168 lds
MAA 104,16,136
TR 126,17,25888
MAA 104,20,152
RD 192,9,16896
MAA 108,20,156
RD 196,9,17952
MAA 108,16,140
RD 200,9,19008
MAA 60,8,140
RD 204,9,20064
s_mov_b32 m0, s67
MAA 60,12,156
buffer_load_dwordx4 v18, s[28:31], s58 offen lds
MAA 56,12,152
MAA 56,8,136
MAA 40,0,136
MAA 40,4,152
MAA 44,4,156
MAA 44,0,140
s_waitcnt vmcnt(17) lgkmcnt(0)
s_barrier
MAA 64,64,128
TR 0,16,33792
s_add_u32 m0, s55, 101376
MAA 64,68,144
buffer_load_dwordx4 v12, s[80:83], s54 offen lds
v_smfmac_f32_16x16x64_bf16 a[216:219], a[208:211], a[192:199], v6
s_sub_u32 s47, s47, 1
s_cbranch_scc1 .Lx45
.Lx45b:
v_smfmac_f32_16x16x64_bf16 a[216:219], a[208:211], a[200:207], v6
TR 2,16,34304
MAA 68,68,148
TR 4,16,42240
MAA 68,64,132
TR 6,16,42752
MAA 84,72,132
TR 8,16,33824
MAA 84,76,148
buffer_load_dwordx4 v13, s[80:83], s54 offen offset:1056 lds
MAA 80,76,144
TR 10,16,34336
MAA 80,72,128
MAA 128,80,128
TR 12,16,42272
MAA 128,84,144
TR 14,16,42784
MAA 132,84,148
TR 16,16,33856
MAA 132,80,132
buffer_load_dwordx4 v14, s[80:83], s54 offen offset:2112 lds
MAA 148,88,132
TR 18,16,34368
MAA 148,92,148
TR 20,16,42304
MAA 144,92,144
TR 22,16,42816
MAA 144,88,128
MAA 192,96,128
TR 24,16,33888
MAA 192,100,144
buffer_load_dwordx4 v15, s[80:83], s54 offen offset:3168 lds
MAA 196,100,148
TR 26,16,34400
s_add_u32 s54, s54, 458752
MAA 196,96,132
TR 28,16,42336
MAA 212,104,132
TR 30,16,42848
MAA 212,108,148
TR 32,16,33920
MAA 208,108,144
TR 34,16,34432
s_mov_b32 m0, s67
MAA 208,104,128
buffer_load_dwordx4 v19, s[28:31], s58 offen offset:1056 lds
MAA 240,112,128
s_add_u32 s67, s67, 8448
s_add_u32 s58, s58, 0x40000
MAA 240,116,144
MAA 244,116,148
TR 36,16,42368
MAA 244,112,132
TR 38,16,42880
MAA 252,120,132
TR 40,16,33952
MAA 252,124,148
TR 42,16,34464
MAA 248,124,144
TR 44,16,42400
MAA 248,120,128
buffer_load_dwordx4 a[128:131], v10, s[16:19], s52 offen sc1
MAA 220,104,140
TR 46,16,42912
MAA 220,108,156
MAA 216,108,152
TR 48,17,33792
MAA 216,104,136
TR 50,17,34304
MAA 200,96,136
TR 52,17,42240
MAA 200,100,152
buffer_load_dwordx4 a[132:135], v10, s[16:19], s52 offen offset:1024 sc1
MAA 204,100,156
TR 54,17,42752
s_add_u32 s52, s52, 131072
MAA 204,96,140
TR 56,17,33824
MAA 156,88,140
TR 58,17,34336
MAA 156,92,156
MAA 152,92,152
TR 60,17,42272
MAA 152,88,136
buffer_load_dwordx4 a[144:147], v10, s[16:19], s52 offen sc1
MAA 136,80,136
TR 62,17,42784
MAA 136,84,152
RD 192,9,33792
MAA 140,84,156
RD 196,9,34848
MAA 140,80,140
RD 200,9,35904
MAA 92,72,140
RD 204,9,36960
MAA 92,76,156
buffer_load_dwordx4 a[148:151], v10, s[16:19], s52 offen offset:1024 sc1
MAA 88,76,152
s_add_u32 s52, s52, 131072
MAA 88,72,136
MAA 72,64,136
MAA 72,68,152
MAA 76,68,156
MAA 76,64,140
s_waitcnt vmcnt(18) lgkmcnt(0)
s_barrier
MAA 32,0,160
TR 64,16,50688
MAA 32,4,176
buffer_load_dwordx4 a[136:139], v11, s[16:19], s53 offen sc1
v_smfmac_f32_16x16x64_bf16 a[212:215], a[208:211], a[192:199], v6
s_sub_u32 s47, s47, 1
s_cbranch_scc1 .Lx46
.Lx46b:
v_smfmac_f32_16x16x64_bf16 a[212:215], a[208:211], a[200:207], v6
TR 66,16,51200
MAA 36,4,180
TR 68,16,59136
MAA 36,0,164
TR 70,16,59648
MAA 52,8,164
TR 72,16,50720
MAA 52,12,180
buffer_load_dwordx4 a[140:143], v11, s[16:19], s53 offen offset:1024 sc1
MAA 48,12,176
TR 74,16,51232
s_add_u32 s53, s53, 131072
MAA 48,8,160
MAA 96,16,160
TR 76,16,59168
MAA 96,20,176
TR 78,16,59680
MAA 100,20,180
TR 80,16,50752
MAA 100,16,164
buffer_load_dwordx4 a[152:155], v11, s[16:19], s53 offen sc1
MAA 116,24,164
TR 82,16,51264
MAA 116,28,180
TR 84,16,59200
MAA 112,28,176
MAA 112,24,160
TR 86,16,59712
MAA 160,32,160
TR 88,16,50784
MAA 160,36,176
buffer_load_dwordx4 a[156:159], v11, s[16:19], s53 offen offset:1024 sc1
MAA 164,36,180
TR 90,16,51296
s_add_u32 s53, s53, 131072
MAA 164,32,164
TR 92,16,59232
MAA 180,40,164
TR 94,16,59744
MAA 180,44,180
MAA 176,44,176
TR 96,16,50816
s_add_u32 m0, s55, 118272
MAA 176,40,160
buffer_load_dwordx4 v12, s[32:35], s54 offen lds
MAA 224,48,160
TR 98,16,51328
MAA 224,52,176
TR 100,16,59264
MAA 228,52,180
TR 102,16,59776
MAA 228,48,164
TR 104,16,50848
MAA 236,56,164
MAA 236,60,180
TR 106,16,51360
MAA 232,60,176
TR 108,16,59296
MAA 232,56,160
TR 110,16,59808
s_waitcnt vmcnt(19)
MAA 188,40,172
TR 112,17,50688
MAA 188,44,188
buffer_load_dwordx4 v13, s[32:35], s54 offen offset:1056 lds
MAA 184,44,184
TR 114,17,51200
MAA 184,40,168
MAA 168,32,168
TR 116,17,59136
MAA 168,36,184
buffer_load_dwordx4 v14, s[32:35], s54 offen offset:2112 lds
MAA 172,36,188
TR 118,17,59648
MAA 172,32,172
TR 120,17,50720
MAA 124,24,172
TR 122,17,51232
MAA 124,28,188
TR 124,17,59168
MAA 120,28,184
MAA 120,24,168
buffer_load_dwordx4 v15, s[32:35], s54 offen offset:3168 lds
MAA 104,16,168
TR 126,17,59680
MAA 104,20,184
RD 192,9,50688
MAA 108,20,188
RD 196,9,51744
MAA 108,16,172
RD 200,9,52800
MAA 60,8,172
RD 204,9,53856
s_mov_b32 m0, s67
MAA 60,12,188
buffer_load_dwordx4 v18, s[28:31], s58 offen lds
MAA 56,12,184
MAA 56,8,168
MAA 40,0,168
MAA 40,4,184
MAA 44,4,188
.Lpad14:
s_cbranch_execz .Lnopoll34r
MAA 44,0,172
s_waitcnt vmcnt(19) lgkmcnt(0)
s_barrier
MAA 64,64,160
ds_read_b64_tr_b16 a[0:1], v16
s_add_u32 m0, s55, 135168
MAA 64,68,176
buffer_load_dwordx4 v12, s[80:83], s54 offen lds
v_smfmac_f32_16x16x64_bf16 a[216:219], a[208:211], a[192:199], v6
s_sub_u32 s47, s47, 1
s_cbranch_scc1 .Lx47
.Lx47b:
v_smfmac_f32_16x16x64_bf16 a[216:219], a[208:211], a[200:207], v6
TR 2,16,512
MAA 68,68,180
TR 4,16,8448
MAA 68,64,164
TR 6,16,8960
MAA 84,72,164
TR 8,16,32
MAA 84,76,180
buffer_load_dwordx4 v13, s[80:83], s54 offen offset:1056 lds
MAA 80,76,176
TR 10,16,544
MAA 80,72,160
MAA 128,80,160
TR 12,16,8480
MAA 128,84,176
TR 14,16,8992
MAA 132,84,180
TR 16,16,64
MAA 132,80,164
buffer_load_dwordx4 v14, s[80:83], s54 offen offset:2112 lds
MAA 148,88,164
TR 18,16,576
MAA 148,92,180
TR 20,16,8512
MAA 144,92,176
TR 22,16,9024
MAA 144,88,160
MAA 192,96,160
TR 24,16,96
MAA 192,100,176
buffer_load_dwordx4 v15, s[80:83], s54 offen offset:3168 lds
MAA 196,100,180
TR 26,16,608
s_add_u32 s54, s54, 458752
MAA 196,96,164
TR 28,16,8544
MAA 212,104,164
TR 30,16,9056
MAA 212,108,180
TR 32,16,128
MAA 208,108,176
TR 34,16,640
s_mov_b32 m0, s67
MAA 208,104,160
buffer_load_dwordx4 v19, s[28:31], s58 offen offset:1056 lds
MAA 240,112,160
s_add_u32 s67, s67, 8448
s_add_u32 s46, s46, 1
s_xor_b32 s58, s46, s87
s_mul_i32 s58, s58, 458752
MAA 240,116,176
MAA 244,116,180
TR 36,16,8576
MAA 244,112,164
TR 38,16,9088
MAA 252,120,164
TR 40,16,160
MAA 252,124,180
TR 42,16,672
MAA 248,124,176
TR 44,16,8608
MAA 248,120,160
buffer_load_dwordx4 a[160:163], v10, s[16:19], s52 offen sc1
MAA 220,104,172
TR 46,16,9120
MAA 220,108,188
MAA 216,108,184
ds_read_b64_tr_b16 a[48:49], v17
MAA 216,104,168
TR 50,17,512
MAA 200,96,168
TR 52,17,8448
MAA 200,100,184
buffer_load_dwordx4 a[164:167], v10, s[16:19], s52 offen offset:1024 sc1
MAA 204,100,188
TR 54,17,8960
s_add_u32 s52, s52, 131072
MAA 204,96,172
TR 56,17,32
MAA 156,88,172
TR 58,17,544
MAA 156,92,188
MAA 152,92,184
TR 60,17,8480
MAA 152,88,168
buffer_load_dwordx4 a[176:179], v10, s[16:19], s52 offen sc1
MAA 136,80,168
TR 62,17,8992
MAA 136,84,184
ds_read_b128 a[192:195], v9
MAA 140,84,188
RD 196,9,1056
MAA 140,80,172
RD 200,9,2112
MAA 92,72,172
RD 204,9,3168
MAA 92,76,188
buffer_load_dwordx4 a[180:183], v10, s[16:19], s52 offen offset:1024 sc1
MAA 88,76,184
s_add_u32 s52, s52, 131072
MAA 88,72,168
MAA 72,64,168
MAA 72,68,184
MAA 76,68,188
s_add_u32 s15, s15, 1
MAA 76,64,172
s_cbranch_scc0 .Lk43
s_branch .Lj48
.Lx39:
buffer_load_dword a220, v8, s[40:43], s45 offen
buffer_load_dword a220, v7, s[28:31], s44 offen
s_add_u32 s44, s44, 655360
s_add_u32 s45, s45, 917504
s_mov_b32 s47, 3
s_branch .Lx39b
.Lx40:
buffer_load_dword a220, v8, s[40:43], s45 offen
buffer_load_dword a220, v7, s[28:31], s44 offen
s_add_u32 s44, s44, 655360
s_add_u32 s45, s45, 917504
s_mov_b32 s47, 3
s_branch .Lx40b
.Lx41:
buffer_load_dword a220, v8, s[40:43], s45 offen
buffer_load_dword a220, v7, s[28:31], s44 offen
s_add_u32 s44, s44, 655360
s_add_u32 s45, s45, 917504
s_mov_b32 s47, 3
s_branch .Lx41b
.Lx42:
buffer_load_dword a220, v8, s[40:43], s45 offen
buffer_load_dword a220, v7, s[28:31], s44 offen
s_add_u32 s44, s44, 655360
s_add_u32 s45, s45, 917504
s_mov_b32 s47, 3
s_branch .Lx42b
.Lx44:
buffer_load_dword a220, v8, s[40:43], s45 offen
buffer_load_dword a220, v7, s[28:31], s44 offen
s_add_u32 s44, s44, 655360
s_add_u32 s45, s45, 917504
s_mov_b32 s47, 3
s_branch .Lx44b
.Lx45:
buffer_load_dword a220, v8, s[40:43], s45 offen
buffer_load_dword a220, v7, s[28:31], s44 offen
s_add_u32 s44, s44, 655360
s_add_u32 s45, s45, 917504
s_mov_b32 s47, 3
s_branch .Lx45b
.Lx46:
buffer_load_dword a220, v8, s[40:43], s45 offen
buffer_load_dword a220, v7, s[28:31], s44 offen
s_add_u32 s44, s44, 655360
s_add_u32 s45, s45, 917504
s_mov_b32 s47, 3
s_branch .Lx46b
.Lx47:
buffer_load_dword a220, v8, s[40:43], s45 offen
buffer_load_dword a220, v7, s[28:31], s44 offen
s_add_u32 s44, s44, 655360
s_add_u32 s45, s45, 917504
s_mov_b32 s47, 3
s_branch .Lx47b
.Lj48:
s_waitcnt vmcnt(10) lgkmcnt(0)
s_barrier
v_smfmac_f32_16x16x64_bf16 a[212:215], a[208:211], a[192:199], v6
RD 112,9,16896
s_lshl_b32 s74, s3, 10
v_smfmac_f32_16x16x64_bf16 a[212:215], a[208:211], a[200:207], v6
RD 116,9,17952
s_add_u32 s74, s74, 152576
MAA 32,0,128
RD 120,9,19008
s_sub_u32 s75, 156672, s74
MAA 32,4,144
RD 124,9,20064
v_and_b32 v7, 15, v1
MAA 48,12,144
RD 192,9,33792
v_lshl_add_u32 v7, v7, 5, s74
MAA 48,8,128
RD 196,9,34848
v_bfe_u32 v2, v1, 4, 1
MAA 36,0,132
RD 200,9,35904
v_lshl_add_u32 v7, v2, 4, v7
MAA 36,4,148
RD 204,9,36960
v_bfe_u32 v2, v1, 5, 1
MAA 52,12,148
buffer_load_dwordx4 a[168:171], v11, s[16:19], s53 offen sc1
MAA 52,8,132
TR 64,16,16896
v_mul_u32_u24 v2, s75, v2
s_waitcnt lgkmcnt(7)
v_smfmac_f32_16x16x64_bf16 a[216:219], a[208:211], a[112:119], v6
TR 66,16,17408
v_add_u32 v7, v7, v2
MAA 40,0,136
TR 68,16,25344
v_lshlrev_b32 v2, 4, v1
s_waitcnt lgkmcnt(7)
v_smfmac_f32_16x16x64_bf16 a[216:219], a[208:211], a[120:127], v6
buffer_load_dwordx4 a[172:175], v11, s[16:19], s53 offen offset:1024 sc1
MAA 40,4,152
TR 70,16,25856
s_add_u32 s53, s53, 131072
s_waitcnt lgkmcnt(6)
v_smfmac_f32_16x16x64_bf16 a[212:215], a[208:211], a[192:199], v6
TR 72,16,16928
v_add_u32 v2, 152576, v2
MAA 56,12,152
TR 74,16,17440
s_lshl_b32 s74, s12, 7
s_waitcnt lgkmcnt(6)
v_smfmac_f32_16x16x64_bf16 a[212:215], a[208:211], a[200:207], v6
buffer_load_dwordx4 a[184:187], v11, s[16:19], s53 offen sc1
MAA 56,8,136
TR 76,16,25376
s_add_u32 s74, s74, 161536
MAA 44,0,140
TR 78,16,25888
s_waitcnt vmcnt(8)
s_barrier
MAA 44,4,156
RD 112,9,50688
s_xor_b32 s75, s12, 1
MAA 60,12,156
RD 116,9,51744
s_mul_i32 s75, s75, 384
MAA 60,8,140
RD 120,9,52800
s_add_u32 s75, s75, 161536
MAA 96,16,128
RD 124,9,53856
v_lshrrev_b32 v9, 4, v1
MAA 96,20,144
ds_write_b128 v7, a[212:215]
v_lshlrev_b32 v9, 4, v9
MAA 112,28,144
buffer_load_dwordx4 a[188:191], v11, s[16:19], s53 offen offset:1024 sc1
MAA 112,24,128
TR 80,16,33792
s_add_u32 s53, s53, 131072
MAA 100,16,132
TR 82,16,34304
v_add_u32 v8, s75, v9
MAA 100,20,148
TR 84,16,42240
v_add_u32 v9, s74, v9
MAA 116,28,148
TR 86,16,42752
s_add_u32 s58, s99, 2293760
s_waitcnt lgkmcnt(7)
v_smfmac_f32_16x16x64_bf16 a[216:219], a[208:211], a[112:119], v6
TR 88,16,33824
s_lshl_b32 s74, s3, 11
MAA 116,24,132
TR 90,16,34336
s_add_u32 s74, s74, s84
s_waitcnt lgkmcnt(7)
v_smfmac_f32_16x16x64_bf16 a[216:219], a[208:211], a[120:127], v6
TR 92,16,42272
s_add_u32 s54, s98, 65536
MAA 104,16,136
TR 94,16,42784
s_mul_i32 s55, s3, 2112
MAA 104,20,152
TR 96,16,50688
s_mov_b32 s57, 67584
MAA 120,28,152
ds_write_b128 v7, a[216:219] offset:512
MAA 120,24,136
TR 98,16,51200
MAA 108,16,140
TR 100,16,59136
MAA 108,20,156
TR 102,16,59648
MAA 124,28,156
TR 104,16,50720
MAA 124,24,140
TR 106,16,51232
MAA 160,32,128
TR 108,16,59168
MAA 160,36,144
TR 110,16,59680
MAA 176,44,144
s_waitcnt lgkmcnt(7)
s_barrier
ds_read_b128 v[12:15], v2
MAA 176,40,128
ds_read_b128 v[4:7], v2 offset:1024
MAA 164,32,132
TR 192,16,16960
MAA 164,36,148
TR 194,16,17472
MAA 180,44,148
TR 196,16,25408
MAA 180,40,132
TR 198,16,25920
MAA 168,32,136
TR 200,16,16992
MAA 168,36,152
TR 202,16,17504
MAA 184,44,152
TR 204,16,25440
MAA 184,40,136
TR 206,16,25952
s_waitcnt lgkmcnt(8)
v_add_f32 v12, v12, v4
MAA 172,32,140
TR 112,16,33856
v_add_f32 v13, v13, v5
MAA 172,36,156
TR 114,16,34368
v_add_f32 v14, v14, v6
MAA 188,44,156
TR 116,16,42304
v_add_f32 v15, v15, v7
MAA 188,40,140
ds_read_b128 v[4:7], v2 offset:2048
MAA 224,48,128
TR 118,16,42816
MAA 224,52,144
TR 120,16,33888
MAA 232,60,144
TR 122,16,34400
MAA 232,56,128
TR 124,16,42336
MAA 228,48,132
TR 126,16,42848
MAA 228,52,148
TR 0,16,50752
MAA 236,60,148
TR 2,16,51264
MAA 236,56,132
TR 4,16,59200
s_waitcnt lgkmcnt(8)
v_add_f32 v12, v12, v4
MAA 64,64,128
TR 6,16,59712
v_add_f32 v13, v13, v5
MAA 64,68,144
TR 8,16,50784
v_add_f32 v14, v14, v6
s_waitcnt vmcnt(7)
MAA 64,96,160
TR 10,16,51296
v_add_f32 v15, v15, v7
s_waitcnt vmcnt(5)
MAA 64,100,176
ds_read_b128 v[4:7], v2 offset:3072
MAA 80,108,176
TR 12,16,59232
MAA 80,104,160
TR 14,16,59744
MAA 80,76,144
TR 16,16,17024
MAA 80,72,128
TR 18,16,17536
MAA 32,80,160
TR 20,16,25472
MAA 32,84,176
TR 22,16,25984
MAA 48,92,176
TR 24,16,17056
MAA 48,88,160
TR 26,16,17568
s_waitcnt lgkmcnt(8)
v_add_f32 v12, v12, v4
v_add_f32 v13, v13, v5
v_add_f32 v14, v14, v6
v_add_f32 v15, v15, v7
ds_write_b128 v2, v[12:15] offset:8960
ds_read_b128 v[12:15], v9
ds_read_b128 v[4:7], v9 offset:64
v_lshrrev_b32 v2, 3, v1
v_cmp_eq_u32 vcc, 3, v2
TR 28,16,25504
TR 30,16,26016
TR 32,16,33920
TR 34,16,34432
TR 36,16,42368
TR 38,16,42880
TR 40,16,33952
TR 42,16,34464
TR 44,16,42400
TR 46,16,42912
TR 48,16,50816
TR 50,16,51328
TR 52,16,59264
s_waitcnt lgkmcnt(14)
v_pk_fma_f32 v[32:33], v[12:13], v[20:21], v[32:33] op_sel_hi:[1,0,1]
v_pk_fma_f32 v[34:35], v[14:15], v[20:21], v[34:35] op_sel_hi:[1,0,1]
v_pk_fma_f32 v[36:37], v[12:13], v[22:23], v[36:37] op_sel_hi:[1,0,1]
v_pk_fma_f32 v[38:39], v[14:15], v[22:23], v[38:39] op_sel_hi:[1,0,1]
v_pk_fma_f32 v[40:41], v[12:13], v[24:25], v[40:41] op_sel_hi:[1,0,1]
v_pk_fma_f32 v[42:43], v[14:15], v[24:25], v[42:43] op_sel_hi:[1,0,1]
v_pk_fma_f32 v[44:45], v[12:13], v[26:27], v[44:45] op_sel_hi:[1,0,1]
v_pk_fma_f32 v[46:47], v[14:15], v[26:27], v[46:47] op_sel_hi:[1,0,1]
ds_read_b128 v[12:15], v9 offset:512
s_waitcnt lgkmcnt(14)
v_pk_fma_f32 v[48:49], v[4:5], v[20:21], v[48:49] op_sel_hi:[1,0,1]
v_pk_fma_f32 v[50:51], v[6:7], v[20:21], v[50:51] op_sel_hi:[1,0,1]
v_pk_fma_f32 v[52:53], v[4:5], v[22:23], v[52:53] op_sel_hi:[1,0,1]
v_pk_fma_f32 v[54:55], v[6:7], v[22:23], v[54:55] op_sel_hi:[1,0,1]
v_pk_fma_f32 v[56:57], v[4:5], v[24:25], v[56:57] op_sel_hi:[1,0,1]
v_pk_fma_f32 v[58:59], v[6:7], v[24:25], v[58:59] op_sel_hi:[1,0,1]
v_pk_fma_f32 v[60:61], v[4:5], v[26:27], v[60:61] op_sel_hi:[1,0,1]
v_pk_fma_f32 v[62:63], v[6:7], v[26:27], v[62:63] op_sel_hi:[1,0,1]
ds_read_b128 v[4:7], v9 offset:576
TR 54,16,59776
TR 56,16,50848
TR 58,16,51360
TR 60,16,59296
TR 62,16,59808
s_waitcnt lgkmcnt(6)
v_pk_fma_f32 v[64:65], v[12:13], v[20:21], v[64:65] op_sel_hi:[1,0,1]
v_pk_fma_f32 v[66:67], v[14:15], v[20:21], v[66:67] op_sel_hi:[1,0,1]
v_pk_fma_f32 v[68:69], v[12:13], v[22:23], v[68:69] op_sel_hi:[1,0,1]
v_pk_fma_f32 v[70:71], v[14:15], v[22:23], v[70:71] op_sel_hi:[1,0,1]
v_pk_fma_f32 v[72:73], v[12:13], v[24:25], v[72:73] op_sel_hi:[1,0,1]
v_pk_fma_f32 v[74:75], v[14:15], v[24:25], v[74:75] op_sel_hi:[1,0,1]
v_pk_fma_f32 v[76:77], v[12:13], v[26:27], v[76:77] op_sel_hi:[1,0,1]
v_pk_fma_f32 v[78:79], v[14:15], v[26:27], v[78:79] op_sel_hi:[1,0,1]
ds_read_b128 v[12:15], v9 offset:832
s_waitcnt lgkmcnt(6)
v_pk_fma_f32 v[80:81], v[4:5], v[20:21], v[80:81] op_sel_hi:[1,0,1]
v_pk_fma_f32 v[82:83], v[6:7], v[20:21], v[82:83] op_sel_hi:[1,0,1]
v_pk_fma_f32 v[84:85], v[4:5], v[22:23], v[84:85] op_sel_hi:[1,0,1]
v_pk_fma_f32 v[86:87], v[6:7], v[22:23], v[86:87] op_sel_hi:[1,0,1]
v_pk_fma_f32 v[88:89], v[4:5], v[24:25], v[88:89] op_sel_hi:[1,0,1]
v_pk_fma_f32 v[90:91], v[6:7], v[24:25], v[90:91] op_sel_hi:[1,0,1]
v_pk_fma_f32 v[92:93], v[4:5], v[26:27], v[92:93] op_sel_hi:[1,0,1]
v_pk_fma_f32 v[94:95], v[6:7], v[26:27], v[94:95] op_sel_hi:[1,0,1]
ds_read_b128 v[4:7], v9 offset:704
v_pk_mul_f32 v[64:65], v[64:65], v[32:33]
v_pk_mul_f32 v[32:33], v[32:33], v[28:29] op_sel_hi:[1,0]
v_pk_mul_f32 v[66:67], v[66:67], v[34:35]
v_pk_mul_f32 v[34:35], v[34:35], v[28:29] op_sel_hi:[1,0]
v_pk_mul_f32 v[80:81], v[80:81], v[48:49]
v_pk_mul_f32 v[48:49], v[48:49], v[28:29] op_sel_hi:[1,0]
v_pk_mul_f32 v[82:83], v[82:83], v[50:51]
v_pk_mul_f32 v[50:51], v[50:51], v[28:29] op_sel_hi:[1,0]
v_exp_f32 v32, v32
v_exp_f32 v33, v33
MAA 68,64,132
v_exp_f32 v34, v34
MAA 68,68,148
v_exp_f32 v35, v35
MAA 68,96,164
v_exp_f32 v48, v48
s_waitcnt vmcnt(4)
MAA 68,100,180
v_exp_f32 v49, v49
MAA 84,108,180
v_exp_f32 v50, v50
MAA 84,104,164
v_exp_f32 v51, v51
MAA 84,76,148
MAA 84,72,132
MAA 36,80,164
MAA 36,84,180
MAA 52,92,180
MAA 52,88,164
s_nop 5
v_pk_mul_f32 v[68:69], v[68:69], v[36:37]
v_pk_fma_f32 v[32:33], v[32:33], v[20:21], v[20:21] op_sel:[0,1,1] op_sel_hi:[1,1,1]
v_pk_fma_f32 v[34:35], v[34:35], v[20:21], v[20:21] op_sel:[0,1,1] op_sel_hi:[1,1,1]
v_pk_fma_f32 v[48:49], v[48:49], v[20:21], v[20:21] op_sel:[0,1,1] op_sel_hi:[1,1,1]
v_pk_fma_f32 v[50:51], v[50:51], v[20:21], v[20:21] op_sel:[0,1,1] op_sel_hi:[1,1,1]
v_rcp_f32 v32, v32
v_pk_mul_f32 v[36:37], v[36:37], v[28:29] op_sel:[0,1] op_sel_hi:[1,1]
v_pk_mul_f32 v[70:71], v[70:71], v[38:39]
v_pk_mul_f32 v[38:39], v[38:39], v[28:29] op_sel:[0,1] op_sel_hi:[1,1]
v_pk_mul_f32 v[84:85], v[84:85], v[52:53]
v_pk_mul_f32 v[52:53], v[52:53], v[28:29] op_sel:[0,1] op_sel_hi:[1,1]
v_pk_mul_f32 v[86:87], v[86:87], v[54:55]
v_pk_mul_f32 v[54:55], v[54:55], v[28:29] op_sel:[0,1] op_sel_hi:[1,1]
v_rcp_f32 v33, v33
v_rcp_f32 v34, v34
MAA 72,64,136
v_rcp_f32 v35, v35
MAA 72,68,152
v_rcp_f32 v48, v48
s_waitcnt vmcnt(3)
MAA 72,96,168
v_rcp_f32 v49, v49
s_waitcnt vmcnt(1)
MAA 72,100,184
v_rcp_f32 v50, v50
MAA 88,108,184
v_rcp_f32 v51, v51
MAA 88,104,168
v_exp_f32 v36, v36
MAA 88,76,152
v_exp_f32 v37, v37
MAA 88,72,136
v_exp_f32 v38, v38
MAA 40,80,168
v_exp_f32 v39, v39
MAA 40,84,184
v_exp_f32 v52, v52
MAA 56,92,184
v_exp_f32 v53, v53
MAA 56,88,168
v_exp_f32 v54, v54
v_exp_f32 v55, v55
v_pk_mul_f32 v[64:65], v[64:65], v[32:33]
v_pk_mul_f32 v[66:67], v[66:67], v[34:35]
v_pk_mul_f32 v[80:81], v[80:81], v[48:49]
v_pk_mul_f32 v[82:83], v[82:83], v[50:51]
ds_read_b128 v[48:51], v9 offset:128
v_pk_mul_f32 v[72:73], v[72:73], v[40:41]
v_pk_mul_f32 v[40:41], v[40:41], v[30:31] op_sel_hi:[1,0]
v_pk_mul_f32 v[74:75], v[74:75], v[42:43]
v_pk_mul_f32 v[42:43], v[42:43], v[30:31] op_sel_hi:[1,0]
v_pk_mul_f32 v[88:89], v[88:89], v[56:57]
v_pk_mul_f32 v[56:57], v[56:57], v[30:31] op_sel_hi:[1,0]
v_pk_mul_f32 v[90:91], v[90:91], v[58:59]
v_pk_mul_f32 v[58:59], v[58:59], v[30:31] op_sel_hi:[1,0]
v_pk_fma_f32 v[36:37], v[36:37], v[22:23], v[22:23] op_sel:[0,1,1] op_sel_hi:[1,1,1]
v_pk_fma_f32 v[38:39], v[38:39], v[22:23], v[22:23] op_sel:[0,1,1] op_sel_hi:[1,1,1]
v_pk_fma_f32 v[52:53], v[52:53], v[22:23], v[22:23] op_sel:[0,1,1] op_sel_hi:[1,1,1]
v_pk_fma_f32 v[54:55], v[54:55], v[22:23], v[22:23] op_sel:[0,1,1] op_sel_hi:[1,1,1]
v_cvt_pk_bf16_f32 v32, v64, v65
v_cvt_pk_bf16_f32 v33, v66, v67
ds_read_b128 v[64:67], v9 offset:192
v_cvt_pk_bf16_f32 v34, v80, v81
v_cvt_pk_bf16_f32 v35, v82, v83
MAA 76,64,140
buffer_store_dwordx4 v[32:35], v10, s[16:19], s62 offen sc1
MAA 76,68,156
ds_read_b128 v[80:83], v9 offset:640
v_rcp_f32 v36, v36
MAA 76,96,172
TR 64,17,16896
v_rcp_f32 v37, v37
s_waitcnt vmcnt(1)
MAA 76,100,188
TR 66,17,17408
v_rcp_f32 v38, v38
MAA 92,108,188
TR 68,17,25344
v_rcp_f32 v39, v39
MAA 92,104,172
TR 70,17,25856
v_rcp_f32 v52, v52
MAA 92,76,156
TR 76,17,25376
v_rcp_f32 v53, v53
MAA 92,72,140
TR 72,17,16928
v_rcp_f32 v54, v54
MAA 44,80,172
TR 74,17,17440
v_rcp_f32 v55, v55
MAA 44,84,188
TR 78,17,25888
v_exp_f32 v40, v40
MAA 60,92,188
TR 80,17,33792
.Lpad15:
s_cbranch_execz .Lnopoll34r
v_exp_f32 v41, v41
MAA 60,88,172
TR 82,17,34304
v_exp_f32 v42, v42
v_exp_f32 v43, v43
v_exp_f32 v56, v56
v_exp_f32 v57, v57
v_exp_f32 v58, v58
v_exp_f32 v59, v59
v_pk_mul_f32 v[68:69], v[68:69], v[36:37]
v_pk_mul_f32 v[70:71], v[70:71], v[38:39]
v_pk_mul_f32 v[84:85], v[84:85], v[52:53]
v_pk_mul_f32 v[86:87], v[86:87], v[54:55]
ds_read_b128 v[52:55], v8 offset:576
v_pk_mul_f32 v[76:77], v[76:77], v[44:45]
v_pk_mul_f32 v[44:45], v[44:45], v[30:31] op_sel:[0,1] op_sel_hi:[1,1]
v_pk_mul_f32 v[78:79], v[78:79], v[46:47]
v_pk_mul_f32 v[46:47], v[46:47], v[30:31] op_sel:[0,1] op_sel_hi:[1,1]
v_pk_mul_f32 v[92:93], v[92:93], v[60:61]
v_pk_mul_f32 v[60:61], v[60:61], v[30:31] op_sel:[0,1] op_sel_hi:[1,1]
v_pk_mul_f32 v[94:95], v[94:95], v[62:63]
v_pk_mul_f32 v[62:63], v[62:63], v[30:31] op_sel:[0,1] op_sel_hi:[1,1]
v_pk_fma_f32 v[40:41], v[40:41], v[24:25], v[24:25] op_sel:[0,1,1] op_sel_hi:[1,1,1]
v_pk_fma_f32 v[42:43], v[42:43], v[24:25], v[24:25] op_sel:[0,1,1] op_sel_hi:[1,1,1]
v_pk_fma_f32 v[56:57], v[56:57], v[24:25], v[24:25] op_sel:[0,1,1] op_sel_hi:[1,1,1]
v_pk_fma_f32 v[58:59], v[58:59], v[24:25], v[24:25] op_sel:[0,1,1] op_sel_hi:[1,1,1]
v_cvt_pk_bf16_f32 v36, v68, v69
v_cvt_pk_bf16_f32 v37, v70, v71
v_cvt_pk_bf16_f32 v38, v84, v85
v_cvt_pk_bf16_f32 v39, v86, v87
MAA 128,192,128
buffer_store_dwordx4 v[36:39], v10, s[16:19], s62 offen offset:1024 sc1
MAA 128,196,144
TR 84,17,42240
v_rcp_f32 v40, v40
MAA 128,0,160
TR 86,17,42752
v_rcp_f32 v41, v41
MAA 128,4,176
TR 88,17,33824
v_rcp_f32 v42, v42
MAA 144,12,176
TR 90,17,34336
v_rcp_f32 v43, v43
MAA 144,8,160
TR 92,17,42272
v_rcp_f32 v56, v56
MAA 144,204,144
TR 94,17,42784
v_rcp_f32 v57, v57
MAA 144,200,128
TR 96,17,50688
v_rcp_f32 v58, v58
MAA 96,112,160
TR 98,17,51200
v_rcp_f32 v59, v59
MAA 96,116,176
TR 100,17,59136
v_exp_f32 v44, v44
MAA 112,124,176
TR 102,17,59648
v_exp_f32 v45, v45
MAA 112,120,160
TR 104,17,50720
v_lshrrev_b32 v69, 2, v0
v_min_u32 v69, 1, v69
v_lshlrev_b32 v69, 28, v69
v_lshl_add_u32 v68, v0, 7, v69
v_xor_b32 v69, 64, v0
v_min_u32 v69, 1, v69
v_lshlrev_b32 v70, 4, v69
v_sub_u32 v70, 16, v70
v_lshlrev_b32 v69, 28, v69
v_mov_b32 v71, 1
v_mov_b32 v84, 0
v_mov_b32 v85, 0
v_mov_b32 v86, 0
v_exp_f32 v46, v46
v_exp_f32 v47, v47
v_exp_f32 v60, v60
v_exp_f32 v61, v61
v_exp_f32 v62, v62
v_exp_f32 v63, v63
v_pk_mul_f32 v[72:73], v[72:73], v[40:41]
v_pk_mul_f32 v[74:75], v[74:75], v[42:43]
v_pk_mul_f32 v[88:89], v[88:89], v[56:57]
v_pk_mul_f32 v[90:91], v[90:91], v[58:59]
s_waitcnt lgkmcnt(15)
v_pk_fma_f32 v[96:97], v[48:49], v[20:21], v[96:97] op_sel_hi:[1,0,1]
v_pk_fma_f32 v[98:99], v[50:51], v[20:21], v[98:99] op_sel_hi:[1,0,1]
v_pk_fma_f32 v[112:113], v[64:65], v[20:21], v[112:113] op_sel_hi:[1,0,1]
v_pk_fma_f32 v[114:115], v[66:67], v[20:21], v[114:115] op_sel_hi:[1,0,1]
v_pk_fma_f32 v[128:129], v[80:81], v[20:21], v[128:129] op_sel_hi:[1,0,1]
v_pk_fma_f32 v[130:131], v[82:83], v[20:21], v[130:131] op_sel_hi:[1,0,1]
v_pk_fma_f32 v[144:145], v[4:5], v[20:21], v[144:145] op_sel_hi:[1,0,1]
v_pk_fma_f32 v[146:147], v[6:7], v[20:21], v[146:147] op_sel_hi:[1,0,1]
v_pk_mul_f32 v[128:129], v[128:129], v[96:97]
v_pk_mul_f32 v[96:97], v[96:97], v[28:29] op_sel_hi:[1,0]
v_pk_mul_f32 v[130:131], v[130:131], v[98:99]
v_pk_mul_f32 v[98:99], v[98:99], v[28:29] op_sel_hi:[1,0]
v_pk_mul_f32 v[144:145], v[144:145], v[112:113]
v_pk_mul_f32 v[112:113], v[112:113], v[28:29] op_sel_hi:[1,0]
v_pk_mul_f32 v[146:147], v[146:147], v[114:115]
v_pk_mul_f32 v[114:115], v[114:115], v[28:29] op_sel_hi:[1,0]
v_pk_fma_f32 v[44:45], v[44:45], v[26:27], v[26:27] op_sel:[0,1,1] op_sel_hi:[1,1,1]
v_pk_fma_f32 v[46:47], v[46:47], v[26:27], v[26:27] op_sel:[0,1,1] op_sel_hi:[1,1,1]
v_pk_fma_f32 v[60:61], v[60:61], v[26:27], v[26:27] op_sel:[0,1,1] op_sel_hi:[1,1,1]
v_pk_fma_f32 v[62:63], v[62:63], v[26:27], v[26:27] op_sel:[0,1,1] op_sel_hi:[1,1,1]
v_cvt_pk_bf16_f32 v40, v72, v73
v_cvt_pk_bf16_f32 v41, v74, v75
v_cvt_pk_bf16_f32 v42, v88, v89
v_cvt_pk_bf16_f32 v43, v90, v91
MAA 132,192,132
buffer_store_dwordx4 v[40:43], v11, s[16:19], s62 offen sc1
MAA 132,196,148
TR 106,17,51232
v_rcp_f32 v44, v44
MAA 132,0,164
TR 108,17,59168
v_rcp_f32 v45, v45
MAA 132,4,180
TR 110,17,59680
v_rcp_f32 v46, v46
MAA 148,12,180
v_rcp_f32 v47, v47
MAA 148,8,164
v_rcp_f32 v60, v60
MAA 148,204,148
v_rcp_f32 v61, v61
MAA 148,200,132
v_rcp_f32 v62, v62
MAA 100,112,164
v_rcp_f32 v63, v63
MAA 100,116,180
v_exp_f32 v96, v96
MAA 116,124,180
v_exp_f32 v97, v97
MAA 116,120,164
s_waitcnt lgkmcnt(0)
s_barrier
s_add_u32 m0, s59, 84480
v_exp_f32 v98, v98
v_exp_f32 v99, v99
v_exp_f32 v112, v112
v_exp_f32 v113, v113
v_exp_f32 v114, v114
v_exp_f32 v115, v115
v_pk_mul_f32 v[76:77], v[76:77], v[44:45]
v_pk_mul_f32 v[78:79], v[78:79], v[46:47]
v_pk_mul_f32 v[92:93], v[92:93], v[60:61]
v_pk_mul_f32 v[94:95], v[94:95], v[62:63]
v_pk_fma_f32 v[100:101], v[48:49], v[22:23], v[100:101] op_sel_hi:[1,0,1]
v_pk_fma_f32 v[102:103], v[50:51], v[22:23], v[102:103] op_sel_hi:[1,0,1]
v_pk_fma_f32 v[116:117], v[64:65], v[22:23], v[116:117] op_sel_hi:[1,0,1]
v_pk_fma_f32 v[118:119], v[66:67], v[22:23], v[118:119] op_sel_hi:[1,0,1]
v_pk_fma_f32 v[132:133], v[80:81], v[22:23], v[132:133] op_sel_hi:[1,0,1]
v_pk_fma_f32 v[134:135], v[82:83], v[22:23], v[134:135] op_sel_hi:[1,0,1]
v_pk_fma_f32 v[148:149], v[4:5], v[22:23], v[148:149] op_sel_hi:[1,0,1]
v_pk_fma_f32 v[150:151], v[6:7], v[22:23], v[150:151] op_sel_hi:[1,0,1]
v_pk_mul_f32 v[132:133], v[132:133], v[100:101]
v_pk_mul_f32 v[100:101], v[100:101], v[28:29] op_sel:[0,1] op_sel_hi:[1,1]
v_pk_mul_f32 v[134:135], v[134:135], v[102:103]
v_pk_mul_f32 v[102:103], v[102:103], v[28:29] op_sel:[0,1] op_sel_hi:[1,1]
v_pk_mul_f32 v[148:149], v[148:149], v[116:117]
v_pk_mul_f32 v[116:117], v[116:117], v[28:29] op_sel:[0,1] op_sel_hi:[1,1]
v_pk_mul_f32 v[150:151], v[150:151], v[118:119]
v_pk_mul_f32 v[118:119], v[118:119], v[28:29] op_sel:[0,1] op_sel_hi:[1,1]
v_pk_fma_f32 v[96:97], v[96:97], v[20:21], v[20:21] op_sel:[0,1,1] op_sel_hi:[1,1,1]
v_pk_fma_f32 v[98:99], v[98:99], v[20:21], v[20:21] op_sel:[0,1,1] op_sel_hi:[1,1,1]
v_pk_fma_f32 v[112:113], v[112:113], v[20:21], v[20:21] op_sel:[0,1,1] op_sel_hi:[1,1,1]
v_pk_fma_f32 v[114:115], v[114:115], v[20:21], v[20:21] op_sel:[0,1,1] op_sel_hi:[1,1,1]
v_cvt_pk_bf16_f32 v44, v76, v77
v_cvt_pk_bf16_f32 v45, v78, v79
v_cvt_pk_bf16_f32 v46, v92, v93
v_cvt_pk_bf16_f32 v47, v94, v95
MAA 136,192,136
buffer_store_dwordx4 v[44:47], v11, s[16:19], s62 offen offset:1024 sc1
MAA 136,196,152
v_rcp_f32 v96, v96
MAA 136,0,168
v_rcp_f32 v97, v97
MAA 136,4,184
v_rcp_f32 v98, v98
MAA 152,12,184
buffer_load_dwordx4 v18, s[28:31], s58 offen lds
MAA 152,8,168
v_rcp_f32 v99, v99
MAA 152,204,152
v_rcp_f32 v112, v112
MAA 152,200,136
v_rcp_f32 v113, v113
MAA 104,112,168
buffer_load_dwordx4 v19, s[28:31], s58 offen offset:1056 lds
MAA 104,116,184
s_add_u32 m0, s59, 92928
s_add_u32 s58, s99, 2555904
v_rcp_f32 v114, v114
MAA 120,124,184
v_rcp_f32 v115, v115
MAA 120,120,168
v_exp_f32 v100, v100
v_exp_f32 v101, v101
v_exp_f32 v102, v102
v_exp_f32 v103, v103
v_exp_f32 v116, v116
v_exp_f32 v117, v117
v_exp_f32 v118, v118
v_exp_f32 v119, v119
v_pk_mul_f32 v[128:129], v[128:129], v[96:97]
v_pk_mul_f32 v[130:131], v[130:131], v[98:99]
v_pk_mul_f32 v[144:145], v[144:145], v[112:113]
v_pk_mul_f32 v[146:147], v[146:147], v[114:115]
ds_read_b128 v[112:115], v9 offset:256
v_pk_fma_f32 v[104:105], v[48:49], v[24:25], v[104:105] op_sel_hi:[1,0,1]
v_pk_fma_f32 v[106:107], v[50:51], v[24:25], v[106:107] op_sel_hi:[1,0,1]
v_pk_fma_f32 v[120:121], v[64:65], v[24:25], v[120:121] op_sel_hi:[1,0,1]
v_pk_fma_f32 v[122:123], v[66:67], v[24:25], v[122:123] op_sel_hi:[1,0,1]
v_pk_fma_f32 v[136:137], v[80:81], v[24:25], v[136:137] op_sel_hi:[1,0,1]
v_pk_fma_f32 v[138:139], v[82:83], v[24:25], v[138:139] op_sel_hi:[1,0,1]
v_pk_fma_f32 v[152:153], v[4:5], v[24:25], v[152:153] op_sel_hi:[1,0,1]
v_pk_fma_f32 v[154:155], v[6:7], v[24:25], v[154:155] op_sel_hi:[1,0,1]
v_pk_mul_f32 v[136:137], v[136:137], v[104:105]
v_pk_mul_f32 v[104:105], v[104:105], v[30:31] op_sel_hi:[1,0]
v_pk_mul_f32 v[138:139], v[138:139], v[106:107]
v_pk_mul_f32 v[106:107], v[106:107], v[30:31] op_sel_hi:[1,0]
v_pk_mul_f32 v[152:153], v[152:153], v[120:121]
v_pk_mul_f32 v[120:121], v[120:121], v[30:31] op_sel_hi:[1,0]
v_pk_mul_f32 v[154:155], v[154:155], v[122:123]
v_pk_mul_f32 v[122:123], v[122:123], v[30:31] op_sel_hi:[1,0]
v_pk_fma_f32 v[100:101], v[100:101], v[22:23], v[22:23] op_sel:[0,1,1] op_sel_hi:[1,1,1]
v_pk_fma_f32 v[102:103], v[102:103], v[22:23], v[22:23] op_sel:[0,1,1] op_sel_hi:[1,1,1]
v_pk_fma_f32 v[116:117], v[116:117], v[22:23], v[22:23] op_sel:[0,1,1] op_sel_hi:[1,1,1]
v_pk_fma_f32 v[118:119], v[118:119], v[22:23], v[22:23] op_sel:[0,1,1] op_sel_hi:[1,1,1]
v_cvt_pk_bf16_f32 v96, v128, v129
v_cvt_pk_bf16_f32 v97, v130, v131
ds_read_b128 v[128:131], v9 offset:320
v_cvt_pk_bf16_f32 v98, v144, v145
v_cvt_pk_bf16_f32 v99, v146, v147
MAA 140,192,140
buffer_store_dwordx4 v[96:99], v10, s[16:19], s63 offen sc1
MAA 140,196,156
ds_read_b128 v[144:147], v9 offset:768
v_rcp_f32 v100, v100
MAA 140,0,172
v_rcp_f32 v101, v101
MAA 140,4,188
v_rcp_f32 v102, v102
MAA 156,12,188
buffer_load_dwordx4 v18, s[28:31], s58 offen lds
MAA 156,8,172
v_rcp_f32 v103, v103
MAA 156,204,156
v_rcp_f32 v116, v116
MAA 156,200,140
v_rcp_f32 v117, v117
MAA 108,112,172
buffer_load_dwordx4 v19, s[28:31], s58 offen offset:1056 lds
MAA 108,116,188
s_add_u32 m0, s59, 101376
s_add_u32 s58, s100, 2752512
v_rcp_f32 v118, v118
MAA 124,124,188
v_rcp_f32 v119, v119
MAA 124,120,172
v_exp_f32 v104, v104
v_exp_f32 v105, v105
v_exp_f32 v106, v106
v_exp_f32 v107, v107
v_exp_f32 v120, v120
v_exp_f32 v121, v121
v_exp_f32 v122, v122
v_exp_f32 v123, v123
v_pk_mul_f32 v[132:133], v[132:133], v[100:101]
v_pk_mul_f32 v[134:135], v[134:135], v[102:103]
v_pk_mul_f32 v[148:149], v[148:149], v[116:117]
v_pk_mul_f32 v[150:151], v[150:151], v[118:119]
v_pk_fma_f32 v[108:109], v[48:49], v[26:27], v[108:109] op_sel_hi:[1,0,1]
v_pk_fma_f32 v[110:111], v[50:51], v[26:27], v[110:111] op_sel_hi:[1,0,1]
v_pk_fma_f32 v[124:125], v[64:65], v[26:27], v[124:125] op_sel_hi:[1,0,1]
v_pk_fma_f32 v[126:127], v[66:67], v[26:27], v[126:127] op_sel_hi:[1,0,1]
v_pk_fma_f32 v[140:141], v[80:81], v[26:27], v[140:141] op_sel_hi:[1,0,1]
v_pk_fma_f32 v[142:143], v[82:83], v[26:27], v[142:143] op_sel_hi:[1,0,1]
v_pk_fma_f32 v[156:157], v[4:5], v[26:27], v[156:157] op_sel_hi:[1,0,1]
v_pk_fma_f32 v[158:159], v[6:7], v[26:27], v[158:159] op_sel_hi:[1,0,1]
v_pk_mul_f32 v[140:141], v[140:141], v[108:109]
v_pk_mul_f32 v[108:109], v[108:109], v[30:31] op_sel:[0,1] op_sel_hi:[1,1]
v_pk_mul_f32 v[142:143], v[142:143], v[110:111]
v_pk_mul_f32 v[110:111], v[110:111], v[30:31] op_sel:[0,1] op_sel_hi:[1,1]
v_pk_mul_f32 v[156:157], v[156:157], v[124:125]
s_waitcnt vmcnt(5)
s_barrier
buffer_atomic_add v71, v68, s[16:19], s72 offen offset:512
v_pk_mul_f32 v[124:125], v[124:125], v[30:31] op_sel:[0,1] op_sel_hi:[1,1]
v_pk_mul_f32 v[158:159], v[158:159], v[126:127]
v_pk_mul_f32 v[126:127], v[126:127], v[30:31] op_sel:[0,1] op_sel_hi:[1,1]
v_pk_fma_f32 v[104:105], v[104:105], v[24:25], v[24:25] op_sel:[0,1,1] op_sel_hi:[1,1,1]
v_pk_fma_f32 v[106:107], v[106:107], v[24:25], v[24:25] op_sel:[0,1,1] op_sel_hi:[1,1,1]
v_pk_fma_f32 v[120:121], v[120:121], v[24:25], v[24:25] op_sel:[0,1,1] op_sel_hi:[1,1,1]
v_pk_fma_f32 v[122:123], v[122:123], v[24:25], v[24:25] op_sel:[0,1,1] op_sel_hi:[1,1,1]
v_cvt_pk_bf16_f32 v100, v132, v133
v_cvt_pk_bf16_f32 v101, v134, v135
v_cvt_pk_bf16_f32 v102, v148, v149
v_cvt_pk_bf16_f32 v103, v150, v151
MAA 192,16,128
v_rcp_f32 v104, v104
MAA 192,20,144
buffer_store_dwordx4 v[100:103], v10, s[16:19], s63 offen offset:1024 sc1
MAA 192,48,160
v_rcp_f32 v105, v105
MAA 192,52,176
v_rcp_f32 v106, v106
MAA 208,60,176
v_rcp_f32 v107, v107
MAA 208,56,160
buffer_load_dwordx4 v18, s[28:31], s58 offen lds
MAA 208,28,144
v_rcp_f32 v120, v120
MAA 208,24,128
v_rcp_f32 v121, v121
MAA 160,32,160
v_rcp_f32 v122, v122
MAA 160,36,176
buffer_load_dwordx4 v19, s[28:31], s58 offen offset:1056 lds
MAA 176,44,176
s_add_u32 m0, s59, 109824
s_add_u32 s58, s100, 3014656
v_rcp_f32 v123, v123
MAA 176,40,160
v_exp_f32 v108, v108
v_exp_f32 v109, v109
v_exp_f32 v110, v110
v_exp_f32 v111, v111
v_exp_f32 v124, v124
v_exp_f32 v125, v125
v_exp_f32 v126, v126
v_exp_f32 v127, v127
v_pk_mul_f32 v[136:137], v[136:137], v[104:105]
v_pk_mul_f32 v[138:139], v[138:139], v[106:107]
v_pk_mul_f32 v[152:153], v[152:153], v[120:121]
v_pk_mul_f32 v[154:155], v[154:155], v[122:123]
s_waitcnt lgkmcnt(2)
v_pk_fma_f32 v[160:161], v[112:113], v[20:21], v[160:161] op_sel_hi:[1,0,1]
v_pk_fma_f32 v[162:163], v[114:115], v[20:21], v[162:163] op_sel_hi:[1,0,1]
s_waitcnt lgkmcnt(1)
v_pk_fma_f32 v[176:177], v[128:129], v[20:21], v[176:177] op_sel_hi:[1,0,1]
v_pk_fma_f32 v[178:179], v[130:131], v[20:21], v[178:179] op_sel_hi:[1,0,1]
s_waitcnt lgkmcnt(0)
v_pk_fma_f32 v[192:193], v[144:145], v[20:21], v[192:193] op_sel_hi:[1,0,1]
v_pk_fma_f32 v[194:195], v[146:147], v[20:21], v[194:195] op_sel_hi:[1,0,1]
v_pk_fma_f32 v[208:209], v[12:13], v[20:21], v[208:209] op_sel_hi:[1,0,1]
v_pk_fma_f32 v[210:211], v[14:15], v[20:21], v[210:211] op_sel_hi:[1,0,1]
v_pk_mul_f32 v[192:193], v[192:193], v[160:161]
v_pk_mul_f32 v[160:161], v[160:161], v[28:29] op_sel_hi:[1,0]
v_pk_mul_f32 v[194:195], v[194:195], v[162:163]
v_pk_mul_f32 v[162:163], v[162:163], v[28:29] op_sel_hi:[1,0]
v_pk_mul_f32 v[208:209], v[208:209], v[176:177]
v_pk_mul_f32 v[176:177], v[176:177], v[28:29] op_sel_hi:[1,0]
v_pk_mul_f32 v[210:211], v[210:211], v[178:179]
v_pk_mul_f32 v[178:179], v[178:179], v[28:29] op_sel_hi:[1,0]
v_pk_fma_f32 v[108:109], v[108:109], v[26:27], v[26:27] op_sel:[0,1,1] op_sel_hi:[1,1,1]
v_pk_fma_f32 v[110:111], v[110:111], v[26:27], v[26:27] op_sel:[0,1,1] op_sel_hi:[1,1,1]
v_pk_fma_f32 v[124:125], v[124:125], v[26:27], v[26:27] op_sel:[0,1,1] op_sel_hi:[1,1,1]
v_pk_fma_f32 v[126:127], v[126:127], v[26:27], v[26:27] op_sel:[0,1,1] op_sel_hi:[1,1,1]
v_cvt_pk_bf16_f32 v104, v136, v137
v_cvt_pk_bf16_f32 v105, v138, v139
v_cvt_pk_bf16_f32 v106, v152, v153
v_cvt_pk_bf16_f32 v107, v154, v155
MAA 196,16,132
buffer_store_dwordx4 v[104:107], v11, s[16:19], s63 offen sc1
MAA 196,20,148
v_rcp_f32 v108, v108
MAA 196,48,164
v_rcp_f32 v109, v109
MAA 196,52,180
v_rcp_f32 v110, v110
MAA 212,60,180
buffer_load_dwordx4 v18, s[28:31], s58 offen lds
MAA 212,56,164
v_rcp_f32 v111, v111
MAA 212,28,148
v_rcp_f32 v124, v124
MAA 212,24,132
v_rcp_f32 v125, v125
MAA 164,32,164
buffer_load_dwordx4 v19, s[28:31], s58 offen offset:1056 lds
MAA 164,36,180
s_add_u32 m0, s59, 118272
s_add_u32 s58, s101, 3211264
v_rcp_f32 v126, v126
MAA 180,44,180
v_rcp_f32 v127, v127
MAA 180,40,164
v_lshl_add_u32 v4, v1, 4, s74
v_add_u32 v2, 67108480, v4
v_cndmask_b32 v4, v4, v2, vcc
s_and_b32 s74, s7, 1
v_bfe_u32 v7, v1, 2, 3
v_mul_u32_u24 v7, 1056, v7
v_bfe_u32 v2, v1, 5, 1
v_lshl_add_u32 v7, v2, 8, v7
v_and_b32 v2, 3, v1
v_lshl_add_u32 v7, v2, 3, v7
s_lshl_b32 s74, s74, 7
s_xor_b32 s75, s74, 128
v_add_u32 v6, s75, v7
v_add_u32 v7, s74, v7
v_exp_f32 v160, v160
v_exp_f32 v161, v161
v_exp_f32 v162, v162
v_exp_f32 v163, v163
v_exp_f32 v176, v176
v_exp_f32 v177, v177
v_exp_f32 v178, v178
v_exp_f32 v179, v179
v_pk_mul_f32 v[140:141], v[140:141], v[108:109]
v_pk_mul_f32 v[142:143], v[142:143], v[110:111]
v_pk_mul_f32 v[156:157], v[156:157], v[124:125]
v_pk_mul_f32 v[158:159], v[158:159], v[126:127]
v_pk_fma_f32 v[164:165], v[112:113], v[22:23], v[164:165] op_sel_hi:[1,0,1]
v_pk_fma_f32 v[166:167], v[114:115], v[22:23], v[166:167] op_sel_hi:[1,0,1]
v_pk_fma_f32 v[180:181], v[128:129], v[22:23], v[180:181] op_sel_hi:[1,0,1]
v_pk_fma_f32 v[182:183], v[130:131], v[22:23], v[182:183] op_sel_hi:[1,0,1]
v_pk_fma_f32 v[196:197], v[144:145], v[22:23], v[196:197] op_sel_hi:[1,0,1]
v_pk_fma_f32 v[198:199], v[146:147], v[22:23], v[198:199] op_sel_hi:[1,0,1]
v_pk_fma_f32 v[212:213], v[12:13], v[22:23], v[212:213] op_sel_hi:[1,0,1]
v_pk_fma_f32 v[214:215], v[14:15], v[22:23], v[214:215] op_sel_hi:[1,0,1]
v_pk_mul_f32 v[196:197], v[196:197], v[164:165]
v_pk_mul_f32 v[164:165], v[164:165], v[28:29] op_sel:[0,1] op_sel_hi:[1,1]
v_pk_mul_f32 v[198:199], v[198:199], v[166:167]
v_pk_mul_f32 v[166:167], v[166:167], v[28:29] op_sel:[0,1] op_sel_hi:[1,1]
v_pk_mul_f32 v[212:213], v[212:213], v[180:181]
v_pk_mul_f32 v[180:181], v[180:181], v[28:29] op_sel:[0,1] op_sel_hi:[1,1]
v_pk_mul_f32 v[214:215], v[214:215], v[182:183]
v_pk_mul_f32 v[182:183], v[182:183], v[28:29] op_sel:[0,1] op_sel_hi:[1,1]
v_pk_fma_f32 v[160:161], v[160:161], v[20:21], v[20:21] op_sel:[0,1,1] op_sel_hi:[1,1,1]
v_pk_fma_f32 v[162:163], v[162:163], v[20:21], v[20:21] op_sel:[0,1,1] op_sel_hi:[1,1,1]
v_pk_fma_f32 v[176:177], v[176:177], v[20:21], v[20:21] op_sel:[0,1,1] op_sel_hi:[1,1,1]
v_pk_fma_f32 v[178:179], v[178:179], v[20:21], v[20:21] op_sel:[0,1,1] op_sel_hi:[1,1,1]
v_cvt_pk_bf16_f32 v108, v140, v141
v_cvt_pk_bf16_f32 v109, v142, v143
v_cvt_pk_bf16_f32 v110, v156, v157
v_cvt_pk_bf16_f32 v111, v158, v159
MAA 200,16,136
buffer_store_dwordx4 v[108:111], v11, s[16:19], s63 offen offset:1024 sc1
MAA 200,20,152
v_rcp_f32 v160, v160
MAA 200,48,168
v_rcp_f32 v161, v161
MAA 200,52,184
v_rcp_f32 v162, v162
MAA 216,60,184
buffer_load_dwordx4 v18, s[28:31], s58 offen lds
MAA 216,56,168
v_rcp_f32 v163, v163
MAA 216,28,152
v_rcp_f32 v176, v176
MAA 216,24,136
v_rcp_f32 v177, v177
MAA 168,32,168
buffer_load_dwordx4 v19, s[28:31], s58 offen offset:1056 lds
MAA 168,36,184
s_add_u32 m0, s59, 126720
s_add_u32 s58, s101, 3473408
v_rcp_f32 v178, v178
MAA 184,44,184
v_rcp_f32 v179, v179
MAA 184,40,168
v_exp_f32 v164, v164
v_exp_f32 v165, v165
v_exp_f32 v166, v166
v_exp_f32 v167, v167
v_exp_f32 v180, v180
v_exp_f32 v181, v181
v_exp_f32 v182, v182
v_exp_f32 v183, v183
v_pk_mul_f32 v[192:193], v[192:193], v[160:161]
v_pk_mul_f32 v[194:195], v[194:195], v[162:163]
v_pk_mul_f32 v[208:209], v[208:209], v[176:177]
v_pk_mul_f32 v[210:211], v[210:211], v[178:179]
ds_read_b128 v[176:179], v8
v_pk_fma_f32 v[168:169], v[112:113], v[24:25], v[168:169] op_sel_hi:[1,0,1]
v_pk_fma_f32 v[170:171], v[114:115], v[24:25], v[170:171] op_sel_hi:[1,0,1]
v_pk_fma_f32 v[184:185], v[128:129], v[24:25], v[184:185] op_sel_hi:[1,0,1]
v_pk_fma_f32 v[186:187], v[130:131], v[24:25], v[186:187] op_sel_hi:[1,0,1]
v_pk_fma_f32 v[200:201], v[144:145], v[24:25], v[200:201] op_sel_hi:[1,0,1]
v_pk_fma_f32 v[202:203], v[146:147], v[24:25], v[202:203] op_sel_hi:[1,0,1]
v_pk_fma_f32 v[216:217], v[12:13], v[24:25], v[216:217] op_sel_hi:[1,0,1]
v_pk_fma_f32 v[218:219], v[14:15], v[24:25], v[218:219] op_sel_hi:[1,0,1]
v_pk_mul_f32 v[200:201], v[200:201], v[168:169]
v_pk_mul_f32 v[168:169], v[168:169], v[30:31] op_sel_hi:[1,0]
v_pk_mul_f32 v[202:203], v[202:203], v[170:171]
v_pk_mul_f32 v[170:171], v[170:171], v[30:31] op_sel_hi:[1,0]
v_pk_mul_f32 v[216:217], v[216:217], v[184:185]
v_pk_mul_f32 v[184:185], v[184:185], v[30:31] op_sel_hi:[1,0]
v_pk_mul_f32 v[218:219], v[218:219], v[186:187]
v_pk_mul_f32 v[186:187], v[186:187], v[30:31] op_sel_hi:[1,0]
v_pk_fma_f32 v[164:165], v[164:165], v[22:23], v[22:23] op_sel:[0,1,1] op_sel_hi:[1,1,1]
v_pk_fma_f32 v[166:167], v[166:167], v[22:23], v[22:23] op_sel:[0,1,1] op_sel_hi:[1,1,1]
v_pk_fma_f32 v[180:181], v[180:181], v[22:23], v[22:23] op_sel:[0,1,1] op_sel_hi:[1,1,1]
v_pk_fma_f32 v[182:183], v[182:183], v[22:23], v[22:23] op_sel:[0,1,1] op_sel_hi:[1,1,1]
v_cvt_pk_bf16_f32 v160, v192, v193
v_cvt_pk_bf16_f32 v161, v194, v195
ds_read_b128 v[192:195], v8 offset:64
v_cvt_pk_bf16_f32 v162, v208, v209
v_cvt_pk_bf16_f32 v163, v210, v211
MAA 204,16,140
buffer_store_dwordx4 v[160:163], v10, s[16:19], s64 offen sc1
MAA 204,20,156
ds_read_b128 v[208:211], v8 offset:512
v_rcp_f32 v164, v164
MAA 204,48,172
v_rcp_f32 v165, v165
MAA 204,52,188
v_rcp_f32 v166, v166
MAA 220,60,188
buffer_atomic_add v84, v69, s[16:19], s73 offen offset:512 sc0
MAA 220,56,172
v_rcp_f32 v167, v167
MAA 220,28,156
v_rcp_f32 v180, v180
MAA 220,24,140
v_rcp_f32 v181, v181
MAA 172,32,172
buffer_load_dwordx4 v18, s[28:31], s58 offen lds
MAA 172,36,188
v_rcp_f32 v182, v182
MAA 188,44,188
v_rcp_f32 v183, v183
MAA 188,40,172
v_exp_f32 v168, v168
v_exp_f32 v169, v169
v_exp_f32 v170, v170
v_exp_f32 v171, v171
v_exp_f32 v184, v184
v_exp_f32 v185, v185
v_exp_f32 v186, v186
v_exp_f32 v187, v187
v_pk_mul_f32 v[196:197], v[196:197], v[164:165]
v_pk_mul_f32 v[198:199], v[198:199], v[166:167]
v_pk_mul_f32 v[212:213], v[212:213], v[180:181]
v_pk_mul_f32 v[214:215], v[214:215], v[182:183]
v_pk_fma_f32 v[172:173], v[112:113], v[26:27], v[172:173] op_sel_hi:[1,0,1]
v_pk_fma_f32 v[174:175], v[114:115], v[26:27], v[174:175] op_sel_hi:[1,0,1]
v_pk_fma_f32 v[188:189], v[128:129], v[26:27], v[188:189] op_sel_hi:[1,0,1]
v_pk_fma_f32 v[190:191], v[130:131], v[26:27], v[190:191] op_sel_hi:[1,0,1]
v_pk_fma_f32 v[204:205], v[144:145], v[26:27], v[204:205] op_sel_hi:[1,0,1]
v_pk_fma_f32 v[206:207], v[146:147], v[26:27], v[206:207] op_sel_hi:[1,0,1]
v_pk_fma_f32 v[220:221], v[12:13], v[26:27], v[220:221] op_sel_hi:[1,0,1]
v_pk_fma_f32 v[222:223], v[14:15], v[26:27], v[222:223] op_sel_hi:[1,0,1]
v_pk_mul_f32 v[204:205], v[204:205], v[172:173]
v_pk_mul_f32 v[172:173], v[172:173], v[30:31] op_sel:[0,1] op_sel_hi:[1,1]
v_pk_mul_f32 v[206:207], v[206:207], v[174:175]
v_pk_mul_f32 v[174:175], v[174:175], v[30:31] op_sel:[0,1] op_sel_hi:[1,1]
v_pk_mul_f32 v[220:221], v[220:221], v[188:189]
v_pk_mul_f32 v[188:189], v[188:189], v[30:31] op_sel:[0,1] op_sel_hi:[1,1]
v_pk_mul_f32 v[222:223], v[222:223], v[190:191]
v_pk_mul_f32 v[190:191], v[190:191], v[30:31] op_sel:[0,1] op_sel_hi:[1,1]
v_pk_fma_f32 v[168:169], v[168:169], v[24:25], v[24:25] op_sel:[0,1,1] op_sel_hi:[1,1,1]
v_pk_fma_f32 v[170:171], v[170:171], v[24:25], v[24:25] op_sel:[0,1,1] op_sel_hi:[1,1,1]
v_pk_fma_f32 v[184:185], v[184:185], v[24:25], v[24:25] op_sel:[0,1,1] op_sel_hi:[1,1,1]
v_pk_fma_f32 v[186:187], v[186:187], v[24:25], v[24:25] op_sel:[0,1,1] op_sel_hi:[1,1,1]
v_cvt_pk_bf16_f32 v164, v196, v197
v_cvt_pk_bf16_f32 v165, v198, v199
v_cvt_pk_bf16_f32 v166, v212, v213
v_cvt_pk_bf16_f32 v167, v214, v215
MAA 240,64,128
buffer_store_dwordx4 v[164:167], v10, s[16:19], s64 offen offset:1024 sc1
MAA 240,68,144
v_rcp_f32 v168, v168
MAA 240,96,160
v_rcp_f32 v169, v169
MAA 240,100,176
v_rcp_f32 v170, v170
MAA 248,108,176
buffer_atomic_add v85, v69, s[16:19], s73 offen offset:512 sc0
MAA 248,104,160
v_rcp_f32 v171, v171
MAA 248,76,144
v_rcp_f32 v184, v184
MAA 248,72,128
v_rcp_f32 v185, v185
MAA 224,80,160
buffer_load_dwordx4 v19, s[28:31], s58 offen offset:1056 lds
MAA 224,84,176
v_rcp_f32 v186, v186
MAA 232,92,176
v_rcp_f32 v187, v187
MAA 232,88,160
v_exp_f32 v172, v172
v_exp_f32 v173, v173
v_exp_f32 v174, v174
v_exp_f32 v175, v175
v_exp_f32 v188, v188
v_exp_f32 v189, v189
v_exp_f32 v190, v190
v_exp_f32 v191, v191
v_pk_mul_f32 v[200:201], v[200:201], v[168:169]
v_pk_mul_f32 v[202:203], v[202:203], v[170:171]
v_pk_mul_f32 v[216:217], v[216:217], v[184:185]
v_pk_mul_f32 v[218:219], v[218:219], v[186:187]
.Lpad16:
s_cbranch_execz .Lpad19
s_waitcnt lgkmcnt(2)
v_pk_fma_f32 v[224:225], v[176:177], v[20:21], v[224:225] op_sel_hi:[1,0,1]
v_pk_fma_f32 v[226:227], v[178:179], v[20:21], v[226:227] op_sel_hi:[1,0,1]
s_waitcnt lgkmcnt(1)
v_pk_fma_f32 v[232:233], v[192:193], v[20:21], v[232:233] op_sel_hi:[1,0,1]
v_pk_fma_f32 v[234:235], v[194:195], v[20:21], v[234:235] op_sel_hi:[1,0,1]
s_waitcnt lgkmcnt(0)
v_pk_fma_f32 v[240:241], v[208:209], v[20:21], v[240:241] op_sel_hi:[1,0,1]
v_pk_fma_f32 v[242:243], v[210:211], v[20:21], v[242:243] op_sel_hi:[1,0,1]
v_pk_fma_f32 v[248:249], v[52:53], v[20:21], v[248:249] op_sel_hi:[1,0,1]
v_pk_fma_f32 v[250:251], v[54:55], v[20:21], v[250:251] op_sel_hi:[1,0,1]
v_pk_mul_f32 v[240:241], v[240:241], v[224:225]
v_pk_mul_f32 v[224:225], v[224:225], v[28:29] op_sel_hi:[1,0]
v_pk_mul_f32 v[242:243], v[242:243], v[226:227]
v_pk_mul_f32 v[226:227], v[226:227], v[28:29] op_sel_hi:[1,0]
v_pk_mul_f32 v[248:249], v[248:249], v[232:233]
v_pk_mul_f32 v[232:233], v[232:233], v[28:29] op_sel_hi:[1,0]
v_pk_mul_f32 v[250:251], v[250:251], v[234:235]
v_pk_mul_f32 v[234:235], v[234:235], v[28:29] op_sel_hi:[1,0]
v_pk_fma_f32 v[172:173], v[172:173], v[26:27], v[26:27] op_sel:[0,1,1] op_sel_hi:[1,1,1]
v_pk_fma_f32 v[174:175], v[174:175], v[26:27], v[26:27] op_sel:[0,1,1] op_sel_hi:[1,1,1]
v_pk_fma_f32 v[188:189], v[188:189], v[26:27], v[26:27] op_sel:[0,1,1] op_sel_hi:[1,1,1]
v_pk_fma_f32 v[190:191], v[190:191], v[26:27], v[26:27] op_sel:[0,1,1] op_sel_hi:[1,1,1]
v_cvt_pk_bf16_f32 v168, v200, v201
v_cvt_pk_bf16_f32 v169, v202, v203
v_cvt_pk_bf16_f32 v170, v216, v217
v_cvt_pk_bf16_f32 v171, v218, v219
buffer_store_dwordx4 v[168:171], v11, s[16:19], s64 offen sc1
buffer_atomic_add v86, v69, s[16:19], s73 offen offset:512 sc0
s_waitcnt vmcnt(6)
v_cmp_gt_u32 vcc, v70, v84
s_nop 0
s_cbranch_vccz .Lok49
s_waitcnt vmcnt(3)
v_cmp_gt_u32 vcc, v70, v85
s_nop 0
s_cbranch_vccz .Lok49
s_waitcnt vmcnt(0)
v_cmp_gt_u32 vcc, v70, v86
s_nop 0
s_cbranch_vccz .Lok49
s_mov_b32 s15, 0
.Lok49l:
v_mov_b32 v84, 0
buffer_atomic_add v84, v69, s[16:19], s73 offen offset:512 sc0
s_add_u32 s15, s15, 1
s_cmp_gt_u32 s15, 100000
s_waitcnt vmcnt(0)
s_cbranch_scc1 .Lok49
v_cmp_gt_u32 vcc, v70, v84
s_nop 0
s_cbranch_vccnz .Lok49l
.Lok49:
s_waitcnt vmcnt(2)
s_barrier
MAA 244,64,132
ds_read_b64_tr_b16 a[0:1], v7
s_add_u32 s52, s76, 0
MAA 244,68,148
buffer_load_dwordx4 v[96:99], v4, s[16:19], s52 offen sc1
MAA 244,96,164
TR 2,7,512
v_rcp_f32 v172, v172
MAA 244,100,180
TR 4,7,32
v_rcp_f32 v173, v173
MAA 252,108,180
TR 6,7,544
v_rcp_f32 v174, v174
MAA 252,104,164
buffer_load_dwordx4 v[100:103], v4, s[16:19], s52 offen offset:1024 sc1
MAA 252,76,148
TR 8,7,64
s_add_u32 s52, s76, 65536
MAA 252,72,132
TR 10,7,576
v_rcp_f32 v175, v175
MAA 228,80,164
TR 12,7,96
v_rcp_f32 v188, v188
MAA 228,84,180
buffer_load_dwordx4 v[104:107], v4, s[16:19], s52 offen sc1
MAA 236,92,180
TR 14,7,608
v_rcp_f32 v189, v189
MAA 236,88,164
TR 16,7,8448
v_rcp_f32 v190, v190
v_rcp_f32 v191, v191
v_exp_f32 v224, v224
v_exp_f32 v225, v225
v_exp_f32 v226, v226
v_exp_f32 v227, v227
v_exp_f32 v232, v232
v_exp_f32 v233, v233
v_exp_f32 v234, v234
v_exp_f32 v235, v235
v_pk_mul_f32 v[204:205], v[204:205], v[172:173]
buffer_load_dwordx4 v[108:111], v4, s[16:19], s52 offen offset:1024 sc1
s_add_u32 s52, s77, 114688
v_pk_mul_f32 v[206:207], v[206:207], v[174:175]
v_pk_mul_f32 v[220:221], v[220:221], v[188:189]
v_pk_mul_f32 v[222:223], v[222:223], v[190:191]
v_pk_fma_f32 v[228:229], v[176:177], v[22:23], v[228:229] op_sel_hi:[1,0,1]
v_pk_fma_f32 v[230:231], v[178:179], v[22:23], v[230:231] op_sel_hi:[1,0,1]
v_pk_fma_f32 v[236:237], v[192:193], v[22:23], v[236:237] op_sel_hi:[1,0,1]
v_pk_fma_f32 v[238:239], v[194:195], v[22:23], v[238:239] op_sel_hi:[1,0,1]
v_pk_fma_f32 v[244:245], v[208:209], v[22:23], v[244:245] op_sel_hi:[1,0,1]
v_pk_fma_f32 v[246:247], v[210:211], v[22:23], v[246:247] op_sel_hi:[1,0,1]
v_pk_fma_f32 v[252:253], v[52:53], v[22:23], v[252:253] op_sel_hi:[1,0,1]
v_pk_fma_f32 v[254:255], v[54:55], v[22:23], v[254:255] op_sel_hi:[1,0,1]
v_pk_mul_f32 v[244:245], v[244:245], v[228:229]
buffer_load_dwordx4 v[112:115], v4, s[16:19], s52 offen sc1
v_pk_mul_f32 v[228:229], v[228:229], v[28:29] op_sel:[0,1] op_sel_hi:[1,1]
v_pk_mul_f32 v[246:247], v[246:247], v[230:231]
v_pk_mul_f32 v[230:231], v[230:231], v[28:29] op_sel:[0,1] op_sel_hi:[1,1]
v_pk_mul_f32 v[252:253], v[252:253], v[236:237]
v_pk_mul_f32 v[236:237], v[236:237], v[28:29] op_sel:[0,1] op_sel_hi:[1,1]
v_pk_mul_f32 v[254:255], v[254:255], v[238:239]
v_pk_mul_f32 v[238:239], v[238:239], v[28:29] op_sel:[0,1] op_sel_hi:[1,1]
v_pk_fma_f32 v[224:225], v[224:225], v[20:21], v[20:21] op_sel:[0,1,1] op_sel_hi:[1,1,1]
v_pk_fma_f32 v[226:227], v[226:227], v[20:21], v[20:21] op_sel:[0,1,1] op_sel_hi:[1,1,1]
v_pk_fma_f32 v[232:233], v[232:233], v[20:21], v[20:21] op_sel:[0,1,1] op_sel_hi:[1,1,1]
v_pk_fma_f32 v[234:235], v[234:235], v[20:21], v[20:21] op_sel:[0,1,1] op_sel_hi:[1,1,1]
v_cvt_pk_bf16_f32 v172, v204, v205
v_cvt_pk_bf16_f32 v173, v206, v207
buffer_load_dwordx4 v[116:119], v4, s[16:19], s52 offen offset:1024 sc1
s_add_u32 s52, s77, 180224
v_cvt_pk_bf16_f32 v174, v220, v221
v_cvt_pk_bf16_f32 v175, v222, v223
TR 18,7,8960
TR 20,7,8480
TR 22,7,8992
TR 24,7,8512
TR 26,7,9024
buffer_store_dwordx4 v[172:175], v11, s[16:19], s64 offen offset:1024 sc1
TR 28,7,8544
TR 30,7,9056
v_rcp_f32 v224, v224
v_rcp_f32 v225, v225
v_rcp_f32 v226, v226
v_rcp_f32 v227, v227
v_rcp_f32 v232, v232
v_rcp_f32 v233, v233
v_rcp_f32 v234, v234
v_rcp_f32 v235, v235
v_exp_f32 v228, v228
v_exp_f32 v229, v229
v_exp_f32 v230, v230
v_exp_f32 v231, v231
v_exp_f32 v236, v236
v_exp_f32 v237, v237
v_exp_f32 v238, v238
v_exp_f32 v239, v239
v_pk_mul_f32 v[240:241], v[240:241], v[224:225]
buffer_load_dwordx4 v[120:123], v4, s[16:19], s52 offen sc1
v_pk_mul_f32 v[242:243], v[242:243], v[226:227]
v_pk_mul_f32 v[248:249], v[248:249], v[232:233]
v_pk_mul_f32 v[250:251], v[250:251], v[234:235]
v_pk_fma_f32 v[228:229], v[228:229], v[22:23], v[22:23] op_sel:[0,1,1] op_sel_hi:[1,1,1]
v_pk_fma_f32 v[230:231], v[230:231], v[22:23], v[22:23] op_sel:[0,1,1] op_sel_hi:[1,1,1]
v_pk_fma_f32 v[236:237], v[236:237], v[22:23], v[22:23] op_sel:[0,1,1] op_sel_hi:[1,1,1]
v_pk_fma_f32 v[238:239], v[238:239], v[22:23], v[22:23] op_sel:[0,1,1] op_sel_hi:[1,1,1]
v_cvt_pk_bf16_f32 v224, v240, v241
v_cvt_pk_bf16_f32 v225, v242, v243
v_cvt_pk_bf16_f32 v226, v248, v249
v_cvt_pk_bf16_f32 v227, v250, v251
v_rcp_f32 v228, v228
v_rcp_f32 v229, v229
v_rcp_f32 v230, v230
v_rcp_f32 v231, v231
v_rcp_f32 v236, v236
v_rcp_f32 v237, v237
v_rcp_f32 v238, v238
v_rcp_f32 v239, v239
v_pk_mul_f32 v[244:245], v[244:245], v[228:229]
buffer_store_dwordx4 v[224:227], v10, s[16:19], s65 offen sc1
v_pk_mul_f32 v[246:247], v[246:247], v[230:231]
v_pk_mul_f32 v[252:253], v[252:253], v[236:237]
v_pk_mul_f32 v[254:255], v[254:255], v[238:239]
v_cvt_pk_bf16_f32 v228, v244, v245
v_cvt_pk_bf16_f32 v229, v246, v247
v_cvt_pk_bf16_f32 v230, v252, v253
v_cvt_pk_bf16_f32 v231, v254, v255
buffer_store_dwordx4 v[228:231], v10, s[16:19], s65 offen offset:1024 sc1
buffer_load_dwordx4 v[124:127], v4, s[16:19], s52 offen offset:1024 sc1
v_mov_b32 v21, v68
v_mov_b32 v22, v69
v_mov_b32 v23, v70
v_mov_b32 v24, v71
v_mov_b32 v25, 0
s_waitcnt vmcnt(7) lgkmcnt(0)
s_barrier
v_mfma_f32_16x16x32_bf16 v[32:35], a[0:3], v[96:99], 0
ds_read_b64_tr_b16 a[32:33], v6
s_add_u32 s52, s78, 229376
MAV 32,16,104
buffer_load_dwordx4 v[128:131], v4, s[16:19], s52 offen sc1
v_mfma_f32_16x16x32_bf16 v[48:51], a[0:3], v[100:103], 0
TR 34,6,512
MAV 48,16,108
TR 36,6,32
TR 38,6,544
v_mfma_f32_16x16x32_bf16 v[52:55], a[4:7], v[100:103], 0
TR 48,6,8448
MAV 52,20,108
buffer_load_dwordx4 v[132:135], v4, s[16:19], s52 offen offset:1024 sc1
v_mfma_f32_16x16x32_bf16 v[36:39], a[4:7], v[96:99], 0
TR 50,6,8960
MAV 36,20,104
TR 52,6,8480
TR 54,6,8992
v_mfma_f32_16x16x32_bf16 v[40:43], a[8:11], v[96:99], 0
TR 40,6,64
s_add_u32 s52, s78, 294912
MAV 40,24,104
buffer_load_dwordx4 v[136:139], v4, s[16:19], s52 offen sc1
v_mfma_f32_16x16x32_bf16 v[56:59], a[8:11], v[100:103], 0
TR 42,6,576
MAV 56,24,108
TR 44,6,96
TR 46,6,608
v_mfma_f32_16x16x32_bf16 v[60:63], a[12:15], v[100:103], 0
TR 56,6,8512
MAV 60,28,108
buffer_load_dwordx4 v[140:143], v4, s[16:19], s52 offen offset:1024 sc1
v_mfma_f32_16x16x32_bf16 v[44:47], a[12:15], v[96:99], 0
TR 58,6,9024
MAV 44,28,104
TR 60,6,8544
TR 62,6,9056
s_waitcnt lgkmcnt(8)
v_mfma_f32_16x16x32_bf16 v[64:67], a[32:35], v[96:99], 0
TR 0,7,16896
s_add_u32 s52, s79, 344064
MAV 64,48,104
buffer_load_dwordx4 v[144:147], v4, s[16:19], s52 offen sc1
v_mfma_f32_16x16x32_bf16 v[80:83], a[32:35], v[100:103], 0
TR 2,7,17408
MAV 80,48,108
TR 4,7,16928
TR 6,7,17440
v_mfma_f32_16x16x32_bf16 v[84:87], a[36:39], v[100:103], 0
TR 16,7,25344
MAV 84,52,108
buffer_load_dwordx4 v[148:151], v4, s[16:19], s52 offen offset:1024 sc1
v_mfma_f32_16x16x32_bf16 v[68:71], a[36:39], v[96:99], 0
TR 18,7,25856
MAV 68,52,104
TR 20,7,25376
TR 22,7,25888
s_waitcnt lgkmcnt(8)
v_mfma_f32_16x16x32_bf16 v[72:75], a[40:43], v[96:99], 0
TR 8,7,16960
s_add_u32 s52, s79, 409600
MAV 72,56,104
buffer_load_dwordx4 v[152:155], v4, s[16:19], s52 offen sc1
v_mfma_f32_16x16x32_bf16 v[88:91], a[40:43], v[100:103], 0
TR 10,7,17472
MAV 88,56,108
TR 12,7,16992
TR 14,7,17504
v_mfma_f32_16x16x32_bf16 v[92:95], a[44:47], v[100:103], 0
TR 24,7,25408
MAV 92,60,108
buffer_load_dwordx4 v[156:159], v4, s[16:19], s52 offen offset:1024 sc1
v_mfma_f32_16x16x32_bf16 v[76:79], a[44:47], v[96:99], 0
TR 26,7,25920
MAV 76,60,104
TR 28,7,25440
TR 30,7,25952
s_waitcnt vmcnt(8) lgkmcnt(8)
s_barrier
MAV 32,0,112
TR 32,6,16896
s_add_u32 m0, s55, 0
MAV 32,16,120
buffer_load_dwordx4 v18, s[28:31], s54 offen lds
MAV 48,16,124
TR 34,6,17408
MAV 48,0,116
TR 36,6,16928
TR 38,6,17440
MAV 52,4,116
TR 48,6,25344
s_add_u32 s52, s76, 458752
MAV 52,20,124
buffer_load_dwordx4 v[96:99], v4, s[16:19], s52 offen sc1
MAV 36,20,120
TR 50,6,25856
MAV 36,4,112
TR 52,6,25376
TR 54,6,25888
s_waitcnt lgkmcnt(8)
MAV 40,8,112
TR 40,6,16960
MAV 40,24,120
buffer_load_dwordx4 v19, s[28:31], s54 offen offset:1056 lds
MAV 56,24,124
TR 42,6,17472
s_add_u32 s54, s98, 327680
MAV 56,8,116
TR 44,6,16992
TR 46,6,17504
MAV 60,12,116
TR 56,6,25408
MAV 60,28,124
buffer_load_dwordx4 v[100:103], v4, s[16:19], s52 offen offset:1024 sc1
MAV 44,28,120
TR 58,6,25920
MAV 44,12,112
TR 60,6,25440
TR 62,6,25952
s_waitcnt lgkmcnt(8)
MAV 64,32,112
TR 0,7,33792
s_add_u32 m0, s55, 8448
MAV 64,48,120
buffer_load_dwordx4 v18, s[28:31], s54 offen lds
MAV 80,48,124
TR 2,7,34304
MAV 80,32,116
TR 4,7,33824
TR 6,7,34336
MAV 84,36,116
TR 16,7,42240
s_add_u32 s52, s76, 524288
MAV 84,52,124
buffer_load_dwordx4 v[104:107], v4, s[16:19], s52 offen sc1
MAV 68,52,120
TR 18,7,42752
MAV 68,36,112
TR 20,7,42272
TR 22,7,42784
s_waitcnt lgkmcnt(8)
MAV 72,40,112
TR 8,7,33856
MAV 72,56,120
buffer_load_dwordx4 v19, s[28:31], s54 offen offset:1056 lds
MAV 88,56,124
TR 10,7,34368
s_add_u32 s54, s99, 524288
MAV 88,40,116
TR 12,7,33888
TR 14,7,34400
MAV 92,44,116
TR 24,7,42304
MAV 92,60,124
buffer_load_dwordx4 v[108:111], v4, s[16:19], s52 offen offset:1024 sc1
MAV 76,60,120
TR 26,7,42816
MAV 76,44,112
TR 28,7,42336
TR 30,7,42848
s_waitcnt vmcnt(12) lgkmcnt(8)
s_barrier
MAV 32,0,128
TR 32,6,33792
MAV 32,16,136
buffer_atomic_add v24, v21, s[16:19], s72 offen
MAV 48,16,140
TR 34,6,34304
MAV 48,0,132
TR 36,6,33824
TR 38,6,34336
TR 48,6,42240
MAV 52,4,132
TR 50,6,42752
s_add_u32 m0, s55, 16896
MAV 52,20,140
buffer_load_dwordx4 v18, s[28:31], s54 offen lds
MAV 36,20,136
TR 52,6,42272
MAV 36,4,128
TR 54,6,42784
TR 40,6,33856
s_waitcnt lgkmcnt(9)
MAV 40,8,128
TR 42,6,34368
s_add_u32 s52, s77, 573440
MAV 40,24,136
buffer_load_dwordx4 v[112:115], v4, s[16:19], s52 offen sc1
MAV 56,24,140
TR 44,6,33888
MAV 56,8,132
buffer_load_dwordx4 v19, s[28:31], s54 offen offset:1056 lds
MAV 60,12,132
TR 46,6,34400
s_add_u32 s54, s99, 786432
MAV 60,28,140
buffer_load_dwordx4 v[116:119], v4, s[16:19], s52 offen offset:1024 sc1
MAV 44,28,136
TR 56,6,42304
MAV 44,12,128
TR 58,6,42816
TR 60,6,42336
TR 62,6,42848
s_waitcnt lgkmcnt(8)
MAV 64,32,128
TR 0,7,50688
s_add_u32 m0, s55, 25344
MAV 64,48,136
buffer_load_dwordx4 v18, s[28:31], s54 offen lds
MAV 80,48,140
TR 2,7,51200
MAV 80,32,132
TR 4,7,50720
TR 6,7,51232
MAV 84,36,132
TR 16,7,59136
s_add_u32 s52, s77, 638976
MAV 84,52,140
buffer_load_dwordx4 v[120:123], v4, s[16:19], s52 offen sc1
MAV 68,52,136
TR 18,7,59648
MAV 68,36,128
TR 20,7,59168
TR 22,7,59680
s_waitcnt lgkmcnt(8)
MAV 72,40,128
TR 8,7,50752
MAV 72,56,136
buffer_load_dwordx4 v19, s[28:31], s54 offen offset:1056 lds
MAV 88,56,140
TR 10,7,51264
s_add_u32 s54, s100, 983040
MAV 88,40,132
TR 12,7,50784
TR 14,7,51296
MAV 92,44,132
TR 24,7,59200
MAV 92,60,140
buffer_load_dwordx4 v[124:127], v4, s[16:19], s52 offen offset:1024 sc1
MAV 76,60,136
TR 26,7,59712
MAV 76,44,128
TR 28,7,59232
TR 30,7,59744
s_waitcnt vmcnt(17) lgkmcnt(8)
s_barrier
MAV 32,0,144
TR 32,6,50688
s_add_u32 m0, s55, 33792
MAV 32,16,152
buffer_load_dwordx4 v18, s[28:31], s54 offen lds
MAV 48,16,156
TR 34,6,51200
MAV 48,0,148
TR 36,6,50720
TR 38,6,51232
MAV 52,4,148
TR 48,6,59136
s_add_u32 s52, s78, 688128
MAV 52,20,156
buffer_load_dwordx4 v[128:131], v4, s[16:19], s52 offen sc1
MAV 36,20,152
TR 50,6,59648
MAV 36,4,144
TR 52,6,59168
TR 54,6,59680
s_waitcnt lgkmcnt(8)
MAV 40,8,144
TR 40,6,50752
MAV 40,24,152
buffer_load_dwordx4 v19, s[28:31], s54 offen offset:1056 lds
MAV 56,24,156
TR 42,6,51264
s_add_u32 s54, s100, 1245184
MAV 56,8,148
TR 44,6,50784
TR 46,6,51296
MAV 60,12,148
TR 56,6,59200
MAV 60,28,156
buffer_load_dwordx4 v[132:135], v4, s[16:19], s52 offen offset:1024 sc1
MAV 44,28,152
TR 58,6,59712
MAV 44,12,144
TR 60,6,59232
TR 62,6,59744
v_add_u32 v7, s57, v7
v_add_u32 v6, s57, v6
s_sub_u32 s57, 0, s57
s_waitcnt lgkmcnt(8)
MAV 64,32,144
ds_read_b64_tr_b16 a[0:1], v7
s_add_u32 m0, s55, 42240
MAV 64,48,152
buffer_load_dwordx4 v18, s[28:31], s54 offen lds
MAV 80,48,156
TR 2,7,512
MAV 80,32,148
TR 4,7,32
TR 6,7,544
TR 16,7,8448
MAV 84,36,148
TR 18,7,8960
s_add_u32 s52, s78, 753664
MAV 84,52,156
buffer_load_dwordx4 v[136:139], v4, s[16:19], s52 offen sc1
MAV 68,52,152
TR 20,7,8480
MAV 68,36,144
TR 22,7,8992
TR 8,7,64
s_waitcnt lgkmcnt(9)
MAV 72,40,144
TR 10,7,576
MAV 72,56,152
buffer_load_dwordx4 v19, s[28:31], s54 offen offset:1056 lds
MAV 88,56,156
TR 12,7,96
s_add_u32 s54, s101, 1441792
MAV 88,40,148
buffer_load_dwordx4 v[140:143], v4, s[16:19], s52 offen offset:1024 sc1
MAV 92,44,148
TR 14,7,608
MAV 92,60,156
buffer_atomic_add v25, v22, s[16:19], s73 offen sc0
MAV 76,60,152
TR 24,7,8512
MAV 76,44,144
TR 26,7,9024
TR 28,7,8544
TR 30,7,9056
s_waitcnt vmcnt(18) lgkmcnt(8)
s_barrier
MAV 32,0,96
ds_read_b64_tr_b16 a[32:33], v6
s_add_u32 m0, s55, 50688
MAV 32,16,104
buffer_load_dwordx4 v18, s[28:31], s54 offen lds
MAV 48,16,108
TR 34,6,512
MAV 48,0,100
TR 36,6,32
TR 38,6,544
MAV 52,4,100
TR 48,6,8448
s_add_u32 s52, s79, 802816
MAV 52,20,108
buffer_load_dwordx4 v[144:147], v4, s[16:19], s52 offen sc1
MAV 36,20,104
TR 50,6,8960
MAV 36,4,96
TR 52,6,8480
TR 54,6,8992
s_waitcnt lgkmcnt(8)
MAV 40,8,96
TR 40,6,64
MAV 40,24,104
buffer_load_dwordx4 v19, s[28:31], s54 offen offset:1056 lds
MAV 56,24,108
TR 42,6,576
s_add_u32 s54, s101, 1703936
MAV 56,8,100
TR 44,6,96
TR 46,6,608
MAV 60,12,100
TR 56,6,8512
MAV 60,28,108
buffer_load_dwordx4 v[148:151], v4, s[16:19], s52 offen offset:1024 sc1
.Lpad17:
s_cbranch_execz .Lpad20
MAV 44,28,104
TR 58,6,9024
MAV 44,12,96
TR 60,6,8544
TR 62,6,9056
s_waitcnt lgkmcnt(8)
MAV 64,32,96
TR 0,7,16896
s_add_u32 m0, s55, 59136
MAV 64,48,104
buffer_load_dwordx4 v18, s[28:31], s54 offen lds
MAV 80,48,108
TR 2,7,17408
MAV 80,32,100
TR 4,7,16928
TR 6,7,17440
MAV 84,36,100
TR 16,7,25344
s_add_u32 s52, s79, 868352
MAV 84,52,108
buffer_load_dwordx4 v[152:155], v4, s[16:19], s52 offen sc1
MAV 68,52,104
TR 18,7,25856
MAV 68,36,96
TR 20,7,25376
TR 22,7,25888
s_waitcnt lgkmcnt(8)
MAV 72,40,96
TR 8,7,16960
MAV 72,56,104
buffer_load_dwordx4 v19, s[28:31], s54 offen offset:1056 lds
MAV 88,56,108
TR 10,7,17472
s_add_u32 s54, s98, 1900544
MAV 88,40,100
TR 12,7,16992
TR 14,7,17504
MAV 92,44,100
TR 24,7,25408
MAV 92,60,108
buffer_load_dwordx4 v[156:159], v4, s[16:19], s52 offen offset:1024 sc1
MAV 76,60,104
TR 26,7,25920
MAV 76,44,96
TR 28,7,25440
TR 30,7,25952
s_waitcnt vmcnt(8)
v_cmp_gt_u32 vcc, v23, v25
s_nop 0
s_cbranch_vccnz .Lsp50
.Lsp50b:
s_waitcnt lgkmcnt(8)
s_barrier
MAV 32,0,112
TR 32,6,16896
s_add_u32 m0, s55, 67584
MAV 32,16,120
buffer_load_dwordx4 v18, s[28:31], s54 offen lds
MAV 48,16,124
TR 34,6,17408
MAV 48,0,116
TR 36,6,16928
TR 38,6,17440
MAV 52,4,116
TR 48,6,25344
s_add_u32 s52, s76, 16384
MAV 52,20,124
buffer_load_dwordx4 v[96:99], v4, s[16:19], s52 offen sc1
MAV 36,20,120
TR 50,6,25856
MAV 36,4,112
TR 52,6,25376
TR 54,6,25888
s_waitcnt lgkmcnt(8)
MAV 40,8,112
TR 40,6,16960
MAV 40,24,120
buffer_load_dwordx4 v19, s[28:31], s54 offen offset:1056 lds
MAV 56,24,124
TR 42,6,17472
s_add_u32 s54, s98, 2162688
MAV 56,8,116
TR 44,6,16992
TR 46,6,17504
MAV 60,12,116
TR 56,6,25408
MAV 60,28,124
buffer_load_dwordx4 v[100:103], v4, s[16:19], s52 offen offset:1024 sc1
MAV 44,28,120
TR 58,6,25920
MAV 44,12,112
TR 60,6,25440
TR 62,6,25952
s_waitcnt lgkmcnt(8)
MAV 64,32,112
TR 0,7,33792
s_add_u32 m0, s55, 76032
MAV 64,48,120
buffer_load_dwordx4 v18, s[28:31], s54 offen lds
MAV 80,48,124
TR 2,7,34304
MAV 80,32,116
TR 4,7,33824
TR 6,7,34336
MAV 84,36,116
TR 16,7,42240
s_add_u32 s52, s76, 81920
MAV 84,52,124
buffer_load_dwordx4 v[104:107], v4, s[16:19], s52 offen sc1
MAV 68,52,120
TR 18,7,42752
MAV 68,36,112
TR 20,7,42272
TR 22,7,42784
s_waitcnt lgkmcnt(8)
MAV 72,40,112
TR 8,7,33856
MAV 72,56,120
buffer_load_dwordx4 v19, s[28:31], s54 offen offset:1056 lds
MAV 88,56,124
TR 10,7,34368
s_add_u32 s54, s99, 2359296
MAV 88,40,116
TR 12,7,33888
TR 14,7,34400
MAV 92,44,116
TR 24,7,42304
MAV 92,60,124
buffer_load_dwordx4 v[108:111], v4, s[16:19], s52 offen offset:1024 sc1
MAV 76,60,120
TR 26,7,42816
MAV 76,44,112
TR 28,7,42336
TR 30,7,42848
s_waitcnt lgkmcnt(8)
s_barrier
MAV 32,0,128
TR 32,6,33792
s_add_u32 m0, s55, 84480
MAV 32,16,136
buffer_load_dwordx4 v18, s[28:31], s54 offen lds
MAV 48,16,140
TR 34,6,34304
MAV 48,0,132
TR 36,6,33824
TR 38,6,34336
MAV 52,4,132
TR 48,6,42240
s_add_u32 s52, s77, 131072
MAV 52,20,140
buffer_load_dwordx4 v[112:115], v4, s[16:19], s52 offen sc1
MAV 36,20,136
TR 50,6,42752
MAV 36,4,128
TR 52,6,42272
TR 54,6,42784
s_waitcnt lgkmcnt(8)
MAV 40,8,128
TR 40,6,33856
MAV 40,24,136
buffer_load_dwordx4 v19, s[28:31], s54 offen offset:1056 lds
MAV 56,24,140
TR 42,6,34368
s_add_u32 s54, s99, 2621440
MAV 56,8,132
TR 44,6,33888
TR 46,6,34400
MAV 60,12,132
TR 56,6,42304
MAV 60,28,140
buffer_load_dwordx4 v[116:119], v4, s[16:19], s52 offen offset:1024 sc1
MAV 44,28,136
TR 58,6,42816
MAV 44,12,128
TR 60,6,42336
TR 62,6,42848
s_waitcnt lgkmcnt(8)
MAV 64,32,128
TR 0,7,50688
s_add_u32 m0, s55, 92928
MAV 64,48,136
buffer_load_dwordx4 v18, s[28:31], s54 offen lds
MAV 80,48,140
TR 2,7,51200
MAV 80,32,132
TR 4,7,50720
TR 6,7,51232
MAV 84,36,132
TR 16,7,59136
s_add_u32 s52, s77, 196608
MAV 84,52,140
buffer_load_dwordx4 v[120:123], v4, s[16:19], s52 offen sc1
MAV 68,52,136
TR 18,7,59648
MAV 68,36,128
TR 20,7,59168
TR 22,7,59680
s_waitcnt lgkmcnt(8)
MAV 72,40,128
TR 8,7,50752
MAV 72,56,136
buffer_load_dwordx4 v19, s[28:31], s54 offen offset:1056 lds
MAV 88,56,140
TR 10,7,51264
s_add_u32 s54, s100, 2818048
MAV 88,40,132
TR 12,7,50784
TR 14,7,51296
MAV 92,44,132
TR 24,7,59200
MAV 92,60,140
buffer_load_dwordx4 v[124:127], v4, s[16:19], s52 offen offset:1024 sc1
MAV 76,60,136
TR 26,7,59712
MAV 76,44,128
TR 28,7,59232
TR 30,7,59744
s_waitcnt vmcnt(16) lgkmcnt(8)
s_barrier
MAV 32,0,144
TR 32,6,50688
s_add_u32 m0, s55, 101376
MAV 32,16,152
buffer_load_dwordx4 v18, s[28:31], s54 offen lds
MAV 48,16,156
TR 34,6,51200
MAV 48,0,148
TR 36,6,50720
TR 38,6,51232
MAV 52,4,148
TR 48,6,59136
s_add_u32 s52, s78, 245760
MAV 52,20,156
buffer_load_dwordx4 v[128:131], v4, s[16:19], s52 offen sc1
MAV 36,20,152
TR 50,6,59648
MAV 36,4,144
TR 52,6,59168
TR 54,6,59680
s_waitcnt lgkmcnt(8)
MAV 40,8,144
TR 40,6,50752
MAV 40,24,152
buffer_load_dwordx4 v19, s[28:31], s54 offen offset:1056 lds
MAV 56,24,156
TR 42,6,51264
s_add_u32 s54, s100, 3080192
MAV 56,8,148
TR 44,6,50784
TR 46,6,51296
MAV 60,12,148
TR 56,6,59200
MAV 60,28,156
buffer_load_dwordx4 v[132:135], v4, s[16:19], s52 offen offset:1024 sc1
MAV 44,28,152
TR 58,6,59712
MAV 44,12,144
TR 60,6,59232
TR 62,6,59744
v_add_u32 v7, s57, v7
v_add_u32 v6, s57, v6
s_sub_u32 s57, 0, s57
s_waitcnt lgkmcnt(8)
MAV 64,32,144
ds_read_b64_tr_b16 a[0:1], v7
s_add_u32 m0, s55, 109824
MAV 64,48,152
buffer_load_dwordx4 v18, s[28:31], s54 offen lds
MAV 80,48,156
TR 2,7,512
MAV 80,32,148
TR 4,7,32
TR 6,7,544
MAV 84,36,148
TR 16,7,8448
s_add_u32 s52, s78, 311296
MAV 84,52,156
buffer_load_dwordx4 v[136:139], v4, s[16:19], s52 offen sc1
MAV 68,52,152
TR 18,7,8960
MAV 68,36,144
TR 20,7,8480
TR 22,7,8992
s_waitcnt lgkmcnt(8)
MAV 72,40,144
TR 8,7,64
MAV 72,56,152
buffer_load_dwordx4 v19, s[28:31], s54 offen offset:1056 lds
MAV 88,56,156
TR 10,7,576
s_add_u32 s54, s101, 3276800
MAV 88,40,148
TR 12,7,96
TR 14,7,608
MAV 92,44,148
TR 24,7,8512
MAV 92,60,156
buffer_load_dwordx4 v[140:143], v4, s[16:19], s52 offen offset:1024 sc1
MAV 76,60,152
TR 26,7,9024
MAV 76,44,144
TR 28,7,8544
TR 30,7,9056
s_waitcnt vmcnt(16) lgkmcnt(8)
s_barrier
MAV 32,0,96
ds_read_b64_tr_b16 a[32:33], v6
s_add_u32 m0, s55, 118272
MAV 32,16,104
buffer_load_dwordx4 v18, s[28:31], s54 offen lds
MAV 48,16,108
TR 34,6,512
MAV 48,0,100
TR 36,6,32
TR 38,6,544
MAV 52,4,100
TR 48,6,8448
s_add_u32 s52, s79, 360448
MAV 52,20,108
buffer_load_dwordx4 v[144:147], v4, s[16:19], s52 offen sc1
MAV 36,20,104
TR 50,6,8960
MAV 36,4,96
TR 52,6,8480
TR 54,6,8992
s_waitcnt lgkmcnt(8)
MAV 40,8,96
TR 40,6,64
MAV 40,24,104
buffer_load_dwordx4 v19, s[28:31], s54 offen offset:1056 lds
MAV 56,24,108
TR 42,6,576
s_add_u32 s54, s101, 3538944
MAV 56,8,100
TR 44,6,96
TR 46,6,608
MAV 60,12,100
TR 56,6,8512
MAV 60,28,108
buffer_load_dwordx4 v[148:151], v4, s[16:19], s52 offen offset:1024 sc1
MAV 44,28,104
TR 58,6,9024
MAV 44,12,96
TR 60,6,8544
TR 62,6,9056
s_waitcnt lgkmcnt(8)
MAV 64,32,96
TR 0,7,16896
s_add_u32 m0, s55, 126720
MAV 64,48,104
buffer_load_dwordx4 v18, s[28:31], s54 offen lds
MAV 80,48,108
TR 2,7,17408
MAV 80,32,100
TR 4,7,16928
TR 6,7,17440
MAV 84,36,100
TR 16,7,25344
s_add_u32 s52, s79, 425984
MAV 84,52,108
buffer_load_dwordx4 v[152:155], v4, s[16:19], s52 offen sc1
MAV 68,52,104
TR 18,7,25856
MAV 68,36,96
TR 20,7,25376
TR 22,7,25888
s_waitcnt lgkmcnt(8)
MAV 72,40,96
TR 8,7,16960
MAV 72,56,104
buffer_load_dwordx4 v19, s[28:31], s54 offen offset:1056 lds
MAV 88,56,108
TR 10,7,17472
s_add_u32 s54, s98, 131072
MAV 88,40,100
TR 12,7,16992
TR 14,7,17504
MAV 92,44,100
TR 24,7,25408
MAV 92,60,108
buffer_load_dwordx4 v[156:159], v4, s[16:19], s52 offen offset:1024 sc1
MAV 76,60,104
TR 26,7,25920
MAV 76,44,96
TR 28,7,25440
TR 30,7,25952
s_waitcnt vmcnt(16) lgkmcnt(8)
s_barrier
MAV 32,0,112
TR 32,6,16896
s_add_u32 m0, s55, 0
MAV 32,16,120
buffer_load_dwordx4 v18, s[28:31], s54 offen lds
MAV 48,16,124
TR 34,6,17408
MAV 48,0,116
TR 36,6,16928
TR 38,6,17440
MAV 52,4,116
TR 48,6,25344
s_add_u32 s52, s76, 475136
MAV 52,20,124
buffer_load_dwordx4 v[96:99], v4, s[16:19], s52 offen sc1
MAV 36,20,120
TR 50,6,25856
MAV 36,4,112
TR 52,6,25376
TR 54,6,25888
s_waitcnt lgkmcnt(8)
MAV 40,8,112
TR 40,6,16960
MAV 40,24,120
buffer_load_dwordx4 v19, s[28:31], s54 offen offset:1056 lds
MAV 56,24,124
TR 42,6,17472
s_add_u32 s54, s98, 393216
MAV 56,8,116
TR 44,6,16992
TR 46,6,17504
MAV 60,12,116
TR 56,6,25408
MAV 60,28,124
buffer_load_dwordx4 v[100:103], v4, s[16:19], s52 offen offset:1024 sc1
MAV 44,28,120
TR 58,6,25920
MAV 44,12,112
TR 60,6,25440
TR 62,6,25952
s_waitcnt lgkmcnt(8)
MAV 64,32,112
TR 0,7,33792
s_add_u32 m0, s55, 8448
MAV 64,48,120
buffer_load_dwordx4 v18, s[28:31], s54 offen lds
MAV 80,48,124
TR 2,7,34304
MAV 80,32,116
TR 4,7,33824
TR 6,7,34336
MAV 84,36,116
TR 16,7,42240
s_add_u32 s52, s76, 540672
MAV 84,52,124
buffer_load_dwordx4 v[104:107], v4, s[16:19], s52 offen sc1
MAV 68,52,120
TR 18,7,42752
MAV 68,36,112
TR 20,7,42272
TR 22,7,42784
s_waitcnt lgkmcnt(8)
MAV 72,40,112
TR 8,7,33856
MAV 72,56,120
buffer_load_dwordx4 v19, s[28:31], s54 offen offset:1056 lds
MAV 88,56,124
TR 10,7,34368
s_add_u32 s54, s99, 589824
MAV 88,40,116
TR 12,7,33888
TR 14,7,34400
MAV 92,44,116
TR 24,7,42304
MAV 92,60,124
buffer_load_dwordx4 v[108:111], v4, s[16:19], s52 offen offset:1024 sc1
MAV 76,60,120
TR 26,7,42816
MAV 76,44,112
TR 28,7,42336
TR 30,7,42848
s_waitcnt vmcnt(16) lgkmcnt(8)
s_barrier
MAV 32,0,128
TR 32,6,33792
s_add_u32 m0, s55, 16896
MAV 32,16,136
buffer_load_dwordx4 v18, s[28:31], s54 offen lds
MAV 48,16,140
TR 34,6,34304
MAV 48,0,132
TR 36,6,33824
TR 38,6,34336
MAV 52,4,132
TR 48,6,42240
s_add_u32 s52, s77, 589824
MAV 52,20,140
buffer_load_dwordx4 v[112:115], v4, s[16:19], s52 offen sc1
MAV 36,20,136
TR 50,6,42752
MAV 36,4,128
TR 52,6,42272
TR 54,6,42784
s_waitcnt lgkmcnt(8)
MAV 40,8,128
TR 40,6,33856
MAV 40,24,136
buffer_load_dwordx4 v19, s[28:31], s54 offen offset:1056 lds
MAV 56,24,140
TR 42,6,34368
s_add_u32 s54, s99, 851968
MAV 56,8,132
TR 44,6,33888
TR 46,6,34400
MAV 60,12,132
TR 56,6,42304
MAV 60,28,140
buffer_load_dwordx4 v[116:119], v4, s[16:19], s52 offen offset:1024 sc1
MAV 44,28,136
TR 58,6,42816
MAV 44,12,128
TR 60,6,42336
TR 62,6,42848
s_waitcnt lgkmcnt(8)
MAV 64,32,128
TR 0,7,50688
s_add_u32 m0, s55, 25344
MAV 64,48,136
buffer_load_dwordx4 v18, s[28:31], s54 offen lds
MAV 80,48,140
TR 2,7,51200
MAV 80,32,132
TR 4,7,50720
TR 6,7,51232
MAV 84,36,132
TR 16,7,59136
s_add_u32 s52, s77, 655360
MAV 84,52,140
buffer_load_dwordx4 v[120:123], v4, s[16:19], s52 offen sc1
MAV 68,52,136
TR 18,7,59648
MAV 68,36,128
TR 20,7,59168
TR 22,7,59680
.Lpad18:
s_cbranch_execz .Lpad21
s_waitcnt lgkmcnt(8)
MAV 72,40,128
TR 8,7,50752
MAV 72,56,136
buffer_load_dwordx4 v19, s[28:31], s54 offen offset:1056 lds
MAV 88,56,140
TR 10,7,51264
s_add_u32 s54, s100, 1048576
MAV 88,40,132
TR 12,7,50784
TR 14,7,51296
MAV 92,44,132
TR 24,7,59200
MAV 92,60,140
buffer_load_dwordx4 v[124:127], v4, s[16:19], s52 offen offset:1024 sc1
MAV 76,60,136
TR 26,7,59712
MAV 76,44,128
TR 28,7,59232
TR 30,7,59744
s_waitcnt vmcnt(16) lgkmcnt(8)
s_barrier
MAV 32,0,144
TR 32,6,50688
s_add_u32 m0, s55, 33792
MAV 32,16,152
buffer_load_dwordx4 v18, s[28:31], s54 offen lds
MAV 48,16,156
TR 34,6,51200
MAV 48,0,148
TR 36,6,50720
TR 38,6,51232
MAV 52,4,148
TR 48,6,59136
s_add_u32 s52, s78, 704512
MAV 52,20,156
buffer_load_dwordx4 v[128:131], v4, s[16:19], s52 offen sc1
MAV 36,20,152
TR 50,6,59648
MAV 36,4,144
TR 52,6,59168
TR 54,6,59680
s_waitcnt lgkmcnt(8)
MAV 40,8,144
TR 40,6,50752
MAV 40,24,152
buffer_load_dwordx4 v19, s[28:31], s54 offen offset:1056 lds
MAV 56,24,156
TR 42,6,51264
s_add_u32 s54, s100, 1310720
MAV 56,8,148
TR 44,6,50784
TR 46,6,51296
MAV 60,12,148
TR 56,6,59200
MAV 60,28,156
buffer_load_dwordx4 v[132:135], v4, s[16:19], s52 offen offset:1024 sc1
MAV 44,28,152
TR 58,6,59712
MAV 44,12,144
TR 60,6,59232
TR 62,6,59744
v_add_u32 v7, s57, v7
v_add_u32 v6, s57, v6
s_sub_u32 s57, 0, s57
s_waitcnt lgkmcnt(8)
MAV 64,32,144
ds_read_b64_tr_b16 a[0:1], v7
s_add_u32 m0, s55, 42240
MAV 64,48,152
buffer_load_dwordx4 v18, s[28:31], s54 offen lds
MAV 80,48,156
TR 2,7,512
MAV 80,32,148
TR 4,7,32
TR 6,7,544
MAV 84,36,148
TR 16,7,8448
s_add_u32 s52, s78, 770048
MAV 84,52,156
buffer_load_dwordx4 v[136:139], v4, s[16:19], s52 offen sc1
MAV 68,52,152
TR 18,7,8960
MAV 68,36,144
TR 20,7,8480
TR 22,7,8992
s_waitcnt lgkmcnt(8)
MAV 72,40,144
TR 8,7,64
MAV 72,56,152
buffer_load_dwordx4 v19, s[28:31], s54 offen offset:1056 lds
MAV 88,56,156
TR 10,7,576
s_add_u32 s54, s101, 1507328
MAV 88,40,148
TR 12,7,96
TR 14,7,608
MAV 92,44,148
TR 24,7,8512
MAV 92,60,156
buffer_load_dwordx4 v[140:143], v4, s[16:19], s52 offen offset:1024 sc1
MAV 76,60,152
TR 26,7,9024
MAV 76,44,144
TR 28,7,8544
TR 30,7,9056
s_waitcnt vmcnt(16) lgkmcnt(8)
s_barrier
MAV 32,0,96
ds_read_b64_tr_b16 a[32:33], v6
s_add_u32 m0, s55, 50688
MAV 32,16,104
buffer_load_dwordx4 v18, s[28:31], s54 offen lds
MAV 48,16,108
TR 34,6,512
MAV 48,0,100
TR 36,6,32
TR 38,6,544
MAV 52,4,100
TR 48,6,8448
s_add_u32 s52, s79, 819200
MAV 52,20,108
buffer_load_dwordx4 v[144:147], v4, s[16:19], s52 offen sc1
MAV 36,20,104
TR 50,6,8960
MAV 36,4,96
TR 52,6,8480
TR 54,6,8992
s_waitcnt lgkmcnt(8)
MAV 40,8,96
TR 40,6,64
MAV 40,24,104
buffer_load_dwordx4 v19, s[28:31], s54 offen offset:1056 lds
MAV 56,24,108
TR 42,6,576
s_add_u32 s54, s101, 1769472
MAV 56,8,100
TR 44,6,96
TR 46,6,608
MAV 60,12,100
TR 56,6,8512
MAV 60,28,108
buffer_load_dwordx4 v[148:151], v4, s[16:19], s52 offen offset:1024 sc1
MAV 44,28,104
TR 58,6,9024
MAV 44,12,96
TR 60,6,8544
TR 62,6,9056
s_waitcnt lgkmcnt(8)
MAV 64,32,96
TR 0,7,16896
s_add_u32 m0, s55, 59136
MAV 64,48,104
buffer_load_dwordx4 v18, s[28:31], s54 offen lds
MAV 80,48,108
TR 2,7,17408
MAV 80,32,100
TR 4,7,16928
TR 6,7,17440
MAV 84,36,100
TR 16,7,25344
s_add_u32 s52, s79, 884736
MAV 84,52,108
buffer_load_dwordx4 v[152:155], v4, s[16:19], s52 offen sc1
MAV 68,52,104
TR 18,7,25856
MAV 68,36,96
TR 20,7,25376
TR 22,7,25888
s_waitcnt lgkmcnt(8)
MAV 72,40,96
TR 8,7,16960
MAV 72,56,104
buffer_load_dwordx4 v19, s[28:31], s54 offen offset:1056 lds
MAV 88,56,108
TR 10,7,17472
s_add_u32 s54, s98, 1966080
MAV 88,40,100
TR 12,7,16992
TR 14,7,17504
MAV 92,44,100
TR 24,7,25408
MAV 92,60,108
buffer_load_dwordx4 v[156:159], v4, s[16:19], s52 offen offset:1024 sc1
MAV 76,60,104
TR 26,7,25920
MAV 76,44,96
TR 28,7,25440
TR 30,7,25952
s_waitcnt vmcnt(16) lgkmcnt(8)
s_barrier
MAV 32,0,112
TR 32,6,16896
s_add_u32 m0, s55, 67584
MAV 32,16,120
buffer_load_dwordx4 v18, s[28:31], s54 offen lds
MAV 48,16,124
TR 34,6,17408
MAV 48,0,116
TR 36,6,16928
TR 38,6,17440
MAV 52,4,116
TR 48,6,25344
s_add_u32 s52, s76, 32768
MAV 52,20,124
buffer_load_dwordx4 v[96:99], v4, s[16:19], s52 offen sc1
MAV 36,20,120
TR 50,6,25856
MAV 36,4,112
TR 52,6,25376
TR 54,6,25888
s_waitcnt lgkmcnt(8)
MAV 40,8,112
TR 40,6,16960
MAV 40,24,120
buffer_load_dwordx4 v19, s[28:31], s54 offen offset:1056 lds
MAV 56,24,124
TR 42,6,17472
s_add_u32 s54, s98, 2228224
MAV 56,8,116
TR 44,6,16992
TR 46,6,17504
MAV 60,12,116
TR 56,6,25408
MAV 60,28,124
buffer_load_dwordx4 v[100:103], v4, s[16:19], s52 offen offset:1024 sc1
MAV 44,28,120
TR 58,6,25920
MAV 44,12,112
TR 60,6,25440
TR 62,6,25952
s_waitcnt lgkmcnt(8)
MAV 64,32,112
TR 0,7,33792
s_add_u32 m0, s55, 76032
MAV 64,48,120
buffer_load_dwordx4 v18, s[28:31], s54 offen lds
MAV 80,48,124
TR 2,7,34304
MAV 80,32,116
TR 4,7,33824
TR 6,7,34336
MAV 84,36,116
TR 16,7,42240
s_add_u32 s52, s76, 98304
MAV 84,52,124
buffer_load_dwordx4 v[104:107], v4, s[16:19], s52 offen sc1
MAV 68,52,120
TR 18,7,42752
MAV 68,36,112
TR 20,7,42272
TR 22,7,42784
s_waitcnt lgkmcnt(8)
MAV 72,40,112
TR 8,7,33856
MAV 72,56,120
buffer_load_dwordx4 v19, s[28:31], s54 offen offset:1056 lds
MAV 88,56,124
TR 10,7,34368
s_add_u32 s54, s99, 2424832
MAV 88,40,116
TR 12,7,33888
TR 14,7,34400
MAV 92,44,116
TR 24,7,42304
MAV 92,60,124
buffer_load_dwordx4 v[108:111], v4, s[16:19], s52 offen offset:1024 sc1
MAV 76,60,120
TR 26,7,42816
MAV 76,44,112
TR 28,7,42336
TR 30,7,42848
s_waitcnt vmcnt(16) lgkmcnt(8)
s_barrier
MAV 32,0,128
TR 32,6,33792
s_add_u32 m0, s55, 84480
MAV 32,16,136
buffer_load_dwordx4 v18, s[28:31], s54 offen lds
MAV 48,16,140
TR 34,6,34304
MAV 48,0,132
TR 36,6,33824
TR 38,6,34336
MAV 52,4,132
TR 48,6,42240
s_add_u32 s52, s77, 147456
MAV 52,20,140
buffer_load_dwordx4 v[112:115], v4, s[16:19], s52 offen sc1
MAV 36,20,136
TR 50,6,42752
MAV 36,4,128
TR 52,6,42272
TR 54,6,42784
s_waitcnt lgkmcnt(8)
MAV 40,8,128
TR 40,6,33856
MAV 40,24,136
buffer_load_dwordx4 v19, s[28:31], s54 offen offset:1056 lds
MAV 56,24,140
TR 42,6,34368
s_add_u32 s54, s99, 2686976
MAV 56,8,132
TR 44,6,33888
TR 46,6,34400
MAV 60,12,132
TR 56,6,42304
MAV 60,28,140
buffer_load_dwordx4 v[116:119], v4, s[16:19], s52 offen offset:1024 sc1
MAV 44,28,136
TR 58,6,42816
MAV 44,12,128
TR 60,6,42336
TR 62,6,42848
s_waitcnt lgkmcnt(8)
MAV 64,32,128
TR 0,7,50688
s_add_u32 m0, s55, 92928
MAV 64,48,136
buffer_load_dwordx4 v18, s[28:31], s54 offen lds
MAV 80,48,140
TR 2,7,51200
MAV 80,32,132
TR 4,7,50720
TR 6,7,51232
MAV 84,36,132
TR 16,7,59136
s_add_u32 s52, s77, 212992
MAV 84,52,140
buffer_load_dwordx4 v[120:123], v4, s[16:19], s52 offen sc1
MAV 68,52,136
TR 18,7,59648
MAV 68,36,128
TR 20,7,59168
TR 22,7,59680
s_waitcnt lgkmcnt(8)
MAV 72,40,128
TR 8,7,50752
MAV 72,56,136
buffer_load_dwordx4 v19, s[28:31], s54 offen offset:1056 lds
MAV 88,56,140
TR 10,7,51264
s_add_u32 s54, s100, 2883584
MAV 88,40,132
TR 12,7,50784
TR 14,7,51296
MAV 92,44,132
TR 24,7,59200
MAV 92,60,140
buffer_load_dwordx4 v[124:127], v4, s[16:19], s52 offen offset:1024 sc1
MAV 76,60,136
TR 26,7,59712
MAV 76,44,128
TR 28,7,59232
TR 30,7,59744
s_waitcnt vmcnt(16) lgkmcnt(8)
s_barrier
MAV 32,0,144
TR 32,6,50688
s_add_u32 m0, s55, 101376
MAV 32,16,152
buffer_load_dwordx4 v18, s[28:31], s54 offen lds
MAV 48,16,156
TR 34,6,51200
MAV 48,0,148
TR 36,6,50720
TR 38,6,51232
MAV 52,4,148
TR 48,6,59136
s_add_u32 s52, s78, 262144
MAV 52,20,156
buffer_load_dwordx4 v[128:131], v4, s[16:19], s52 offen sc1
MAV 36,20,152
TR 50,6,59648
MAV 36,4,144
TR 52,6,59168
TR 54,6,59680
s_waitcnt lgkmcnt(8)
MAV 40,8,144
TR 40,6,50752
MAV 40,24,152
buffer_load_dwordx4 v19, s[28:31], s54 offen offset:1056 lds
MAV 56,24,156
TR 42,6,51264
s_add_u32 s54, s100, 3145728
MAV 56,8,148
TR 44,6,50784
TR 46,6,51296
MAV 60,12,148
TR 56,6,59200
MAV 60,28,156
buffer_load_dwordx4 v[132:135], v4, s[16:19], s52 offen offset:1024 sc1
MAV 44,28,152
TR 58,6,59712
MAV 44,12,144
TR 60,6,59232
TR 62,6,59744
v_add_u32 v7, s57, v7
v_add_u32 v6, s57, v6
s_sub_u32 s57, 0, s57
s_waitcnt lgkmcnt(8)
MAV 64,32,144
ds_read_b64_tr_b16 a[0:1], v7
s_add_u32 m0, s55, 109824
MAV 64,48,152
buffer_load_dwordx4 v18, s[28:31], s54 offen lds
MAV 80,48,156
TR 2,7,512
MAV 80,32,148
TR 4,7,32
TR 6,7,544
MAV 84,36,148
TR 16,7,8448
s_add_u32 s52, s78, 327680
MAV 84,52,156
buffer_load_dwordx4 v[136:139], v4, s[16:19], s52 offen sc1
MAV 68,52,152
TR 18,7,8960
MAV 68,36,144
TR 20,7,8480
TR 22,7,8992
s_waitcnt lgkmcnt(8)
MAV 72,40,144
TR 8,7,64
MAV 72,56,152
buffer_load_dwordx4 v19, s[28:31], s54 offen offset:1056 lds
MAV 88,56,156
TR 10,7,576
s_add_u32 s54, s101, 3342336
MAV 88,40,148
TR 12,7,96
TR 14,7,608
MAV 92,44,148
TR 24,7,8512
MAV 92,60,156
buffer_load_dwordx4 v[140:143], v4, s[16:19], s52 offen offset:1024 sc1
MAV 76,60,152
TR 26,7,9024
MAV 76,44,144
TR 28,7,8544
TR 30,7,9056
s_waitcnt vmcnt(16) lgkmcnt(8)
s_barrier
MAV 32,0,96
ds_read_b64_tr_b16 a[32:33], v6
s_add_u32 m0, s55, 118272
MAV 32,16,104
buffer_load_dwordx4 v18, s[28:31], s54 offen lds
MAV 48,16,108
TR 34,6,512
MAV 48,0,100
TR 36,6,32
TR 38,6,544
MAV 52,4,100
TR 48,6,8448
s_add_u32 s52, s79, 376832
MAV 52,20,108
buffer_load_dwordx4 v[144:147], v4, s[16:19], s52 offen sc1
MAV 36,20,104
TR 50,6,8960
MAV 36,4,96
TR 52,6,8480
TR 54,6,8992
s_waitcnt lgkmcnt(8)
MAV 40,8,96
TR 40,6,64
MAV 40,24,104
buffer_load_dwordx4 v19, s[28:31], s54 offen offset:1056 lds
MAV 56,24,108
TR 42,6,576
s_add_u32 s54, s101, 3604480
MAV 56,8,100
TR 44,6,96
TR 46,6,608
MAV 60,12,100
TR 56,6,8512
MAV 60,28,108
buffer_load_dwordx4 v[148:151], v4, s[16:19], s52 offen offset:1024 sc1
MAV 44,28,104
TR 58,6,9024
MAV 44,12,96
TR 60,6,8544
TR 62,6,9056
s_waitcnt lgkmcnt(8)
MAV 64,32,96
TR 0,7,16896
s_add_u32 m0, s55, 126720
MAV 64,48,104
buffer_load_dwordx4 v18, s[28:31], s54 offen lds
MAV 80,48,108
TR 2,7,17408
MAV 80,32,100
TR 4,7,16928
TR 6,7,17440
MAV 84,36,100
TR 16,7,25344
s_add_u32 s52, s79, 442368
MAV 84,52,108
buffer_load_dwordx4 v[152:155], v4, s[16:19], s52 offen sc1
MAV 68,52,104
TR 18,7,25856
MAV 68,36,96
TR 20,7,25376
TR 22,7,25888
s_waitcnt lgkmcnt(8)
MAV 72,40,96
TR 8,7,16960
MAV 72,56,104
buffer_load_dwordx4 v19, s[28:31], s54 offen offset:1056 lds
MAV 88,56,108
TR 10,7,17472
s_add_u32 s54, s98, 196608
MAV 88,40,100
TR 12,7,16992
TR 14,7,17504
MAV 92,44,100
TR 24,7,25408
MAV 92,60,108
buffer_load_dwordx4 v[156:159], v4, s[16:19], s52 offen offset:1024 sc1
MAV 76,60,104
TR 26,7,25920
MAV 76,44,96
TR 28,7,25440
TR 30,7,25952
s_waitcnt vmcnt(16) lgkmcnt(8)
s_barrier
MAV 32,0,112
TR 32,6,16896
s_add_u32 m0, s55, 0
MAV 32,16,120
buffer_load_dwordx4 v18, s[28:31], s54 offen lds
MAV 48,16,124
.Lpad19:
s_cbranch_execz .Lnopoll37r
TR 34,6,17408
MAV 48,0,116
TR 36,6,16928
TR 38,6,17440
MAV 52,4,116
TR 48,6,25344
s_add_u32 s52, s76, 491520
MAV 52,20,124
buffer_load_dwordx4 v[96:99], v4, s[16:19], s52 offen sc1
MAV 36,20,120
TR 50,6,25856
MAV 36,4,112
TR 52,6,25376
TR 54,6,25888
s_waitcnt lgkmcnt(8)
MAV 40,8,112
TR 40,6,16960
MAV 40,24,120
buffer_load_dwordx4 v19, s[28:31], s54 offen offset:1056 lds
MAV 56,24,124
TR 42,6,17472
s_add_u32 s54, s99, 655360
MAV 56,8,116
TR 44,6,16992
TR 46,6,17504
MAV 60,12,116
TR 56,6,25408
MAV 60,28,124
buffer_load_dwordx4 v[100:103], v4, s[16:19], s52 offen offset:1024 sc1
MAV 44,28,120
TR 58,6,25920
MAV 44,12,112
TR 60,6,25440
TR 62,6,25952
s_waitcnt lgkmcnt(8)
MAV 64,32,112
TR 0,7,33792
s_add_u32 m0, s55, 8448
MAV 64,48,120
buffer_load_dwordx4 v18, s[28:31], s54 offen lds
MAV 80,48,124
TR 2,7,34304
MAV 80,32,116
TR 4,7,33824
TR 6,7,34336
MAV 84,36,116
TR 16,7,42240
s_add_u32 s52, s76, 557056
MAV 84,52,124
buffer_load_dwordx4 v[104:107], v4, s[16:19], s52 offen sc1
MAV 68,52,120
TR 18,7,42752
MAV 68,36,112
TR 20,7,42272
TR 22,7,42784
s_waitcnt lgkmcnt(8)
MAV 72,40,112
TR 8,7,33856
MAV 72,56,120
buffer_load_dwordx4 v19, s[28:31], s54 offen offset:1056 lds
MAV 88,56,124
TR 10,7,34368
s_add_u32 s54, s100, 1114112
MAV 88,40,116
TR 12,7,33888
TR 14,7,34400
MAV 92,44,116
TR 24,7,42304
MAV 92,60,124
buffer_load_dwordx4 v[108:111], v4, s[16:19], s52 offen offset:1024 sc1
MAV 76,60,120
TR 26,7,42816
MAV 76,44,112
TR 28,7,42336
TR 30,7,42848
s_waitcnt vmcnt(16) lgkmcnt(8)
s_barrier
MAV 32,0,128
TR 32,6,33792
s_add_u32 m0, s55, 16896
MAV 32,16,136
buffer_load_dwordx4 v18, s[28:31], s54 offen lds
MAV 48,16,140
TR 34,6,34304
MAV 48,0,132
TR 36,6,33824
TR 38,6,34336
MAV 52,4,132
TR 48,6,42240
s_add_u32 s52, s77, 606208
MAV 52,20,140
buffer_load_dwordx4 v[112:115], v4, s[16:19], s52 offen sc1
MAV 36,20,136
TR 50,6,42752
MAV 36,4,128
TR 52,6,42272
TR 54,6,42784
s_waitcnt lgkmcnt(8)
MAV 40,8,128
TR 40,6,33856
MAV 40,24,136
buffer_load_dwordx4 v19, s[28:31], s54 offen offset:1056 lds
MAV 56,24,140
TR 42,6,34368
s_add_u32 s54, s101, 1572864
MAV 56,8,132
TR 44,6,33888
TR 46,6,34400
MAV 60,12,132
TR 56,6,42304
MAV 60,28,140
buffer_load_dwordx4 v[116:119], v4, s[16:19], s52 offen offset:1024 sc1
MAV 44,28,136
TR 58,6,42816
MAV 44,12,128
TR 60,6,42336
TR 62,6,42848
s_waitcnt lgkmcnt(8)
MAV 64,32,128
TR 0,7,50688
s_add_u32 m0, s55, 25344
MAV 64,48,136
buffer_load_dwordx4 v18, s[28:31], s54 offen lds
MAV 80,48,140
TR 2,7,51200
MAV 80,32,132
TR 4,7,50720
TR 6,7,51232
MAV 84,36,132
TR 16,7,59136
s_add_u32 s52, s77, 671744
MAV 84,52,140
buffer_load_dwordx4 v[120:123], v4, s[16:19], s52 offen sc1
MAV 68,52,136
TR 18,7,59648
MAV 68,36,128
TR 20,7,59168
TR 22,7,59680
s_waitcnt lgkmcnt(8)
MAV 72,40,128
TR 8,7,50752
MAV 72,56,136
buffer_load_dwordx4 v19, s[28:31], s54 offen offset:1056 lds
MAV 88,56,140
TR 10,7,51264
s_add_u32 s54, s98, 2031616
MAV 88,40,132
TR 12,7,50784
TR 14,7,51296
MAV 92,44,132
TR 24,7,59200
MAV 92,60,140
buffer_load_dwordx4 v[124:127], v4, s[16:19], s52 offen offset:1024 sc1
MAV 76,60,136
TR 26,7,59712
MAV 76,44,128
TR 28,7,59232
TR 30,7,59744
s_waitcnt vmcnt(16) lgkmcnt(8)
s_barrier
MAV 32,0,144
TR 32,6,50688
s_add_u32 m0, s55, 33792
MAV 32,16,152
buffer_load_dwordx4 v18, s[28:31], s54 offen lds
MAV 48,16,156
TR 34,6,51200
MAV 48,0,148
TR 36,6,50720
TR 38,6,51232
MAV 52,4,148
TR 48,6,59136
s_add_u32 s52, s78, 720896
MAV 52,20,156
buffer_load_dwordx4 v[128:131], v4, s[16:19], s52 offen sc1
MAV 36,20,152
TR 50,6,59648
MAV 36,4,144
TR 52,6,59168
TR 54,6,59680
s_waitcnt lgkmcnt(8)
MAV 40,8,144
TR 40,6,50752
MAV 40,24,152
buffer_load_dwordx4 v19, s[28:31], s54 offen offset:1056 lds
MAV 56,24,156
TR 42,6,51264
s_add_u32 s54, s99, 2490368
MAV 56,8,148
TR 44,6,50784
TR 46,6,51296
MAV 60,12,148
TR 56,6,59200
MAV 60,28,156
buffer_load_dwordx4 v[132:135], v4, s[16:19], s52 offen offset:1024 sc1
MAV 44,28,152
TR 58,6,59712
MAV 44,12,144
TR 60,6,59232
TR 62,6,59744
v_add_u32 v7, s57, v7
v_add_u32 v6, s57, v6
s_sub_u32 s57, 0, s57
s_waitcnt lgkmcnt(8)
MAV 64,32,144
ds_read_b64_tr_b16 a[0:1], v6
s_add_u32 m0, s55, 42240
MAV 64,48,152
buffer_load_dwordx4 v18, s[28:31], s54 offen lds
MAV 80,48,156
TR 2,6,512
MAV 80,32,148
TR 4,6,32
TR 6,6,544
MAV 84,36,148
TR 16,6,8448
s_add_u32 s52, s78, 786432
MAV 84,52,156
buffer_load_dwordx4 v[136:139], v4, s[16:19], s52 offen sc1
MAV 68,52,152
TR 18,6,8960
MAV 68,36,144
TR 20,6,8480
TR 22,6,8992
s_waitcnt lgkmcnt(8)
MAV 72,40,144
TR 8,6,64
MAV 72,56,152
buffer_load_dwordx4 v19, s[28:31], s54 offen offset:1056 lds
MAV 88,56,156
TR 10,6,576
s_add_u32 s54, s100, 2949120
MAV 88,40,148
TR 12,6,96
TR 14,6,608
MAV 92,44,148
TR 24,6,8512
MAV 92,60,156
buffer_load_dwordx4 v[140:143], v4, s[16:19], s52 offen offset:1024 sc1
MAV 76,60,152
TR 26,6,9024
MAV 76,44,144
TR 28,6,8544
TR 30,6,9056
s_waitcnt vmcnt(16) lgkmcnt(8)
s_barrier
MAV 64,0,96
TR 32,6,16896
TR 34,6,17408
s_add_u32 m0, s55, 50688
MAV 64,16,104
TR 36,6,16928
buffer_load_dwordx4 v18, s[28:31], s54 offen lds
MAV 80,16,108
TR 38,6,17440
MAV 80,0,100
TR 48,6,25344
buffer_load_dwordx4 v19, s[28:31], s54 offen offset:1056 lds
MAV 84,4,100
TR 50,6,25856
s_add_u32 s54, s101, 3407872
s_add_u32 s52, s79, 835584
MAV 84,20,108
buffer_load_dwordx4 v[144:147], v4, s[16:19], s52 offen sc1
MAV 68,20,104
TR 52,6,25376
TR 54,6,25888
MAV 68,4,96
TR 40,6,16960
s_waitcnt lgkmcnt(9)
MAV 72,8,96
TR 42,6,17472
MAV 72,24,104
TR 44,6,16992
buffer_load_dwordx4 v[148:151], v4, s[16:19], s52 offen offset:1024 sc1
MAV 88,24,108
TR 46,6,17504
s_add_u32 m0, s55, 59136
MAV 88,8,100
TR 56,6,25408
buffer_load_dwordx4 v18, s[28:31], s54 offen lds
MAV 92,12,100
TR 58,6,25920
MAV 92,28,108
TR 60,6,25440
buffer_load_dwordx4 v19, s[28:31], s54 offen offset:1056 lds
MAV 76,28,104
TR 62,6,25952
s_add_u32 s52, s79, 901120
MAV 76,12,96
buffer_load_dwordx4 v[152:155], v4, s[16:19], s52 offen sc1
buffer_load_dwordx4 v[156:159], v4, s[16:19], s52 offen offset:1024 sc1
s_waitcnt vmcnt(16) lgkmcnt(8)
MAV 64,32,112
TR 0,6,33792
s_add_u32 s52, s76, 49152
s_lshl_b32 s70, s2, 10
MAV 64,48,120
buffer_load_dwordx4 v[160:163], v4, s[16:19], s52 offen sc1
s_lshl_b32 s62, s3, 7
MAV 80,48,124
TR 2,6,34304
s_add_u32 s70, s70, s62
s_add_u32 s70, s70, 31457280
MAV 80,32,116
TR 4,6,33824
TR 6,6,34336
MAV 84,36,116
TR 16,6,42240
s_xor_b32 s71, s70, 1024
v_min_u32 v26, 1, v1
MAV 84,52,124
buffer_load_dwordx4 v[164:167], v4, s[16:19], s52 offen offset:1024 sc1
v_lshlrev_b32 v26, 28, v26
MAV 68,52,120
TR 18,6,42752
v_mov_b32 v30, 1
MAV 68,36,112
TR 20,6,42272
TR 22,6,42784
s_waitcnt lgkmcnt(8)
MAV 72,40,112
TR 8,6,33856
s_add_u32 s52, s77, 163840
v_mov_b32 v31, 0
MAV 72,56,120
buffer_load_dwordx4 v[168:171], v4, s[16:19], s52 offen sc1
s_lshl_b32 s68, s7, 18
MAV 88,56,124
TR 10,6,34368
s_add_u32 s68, s68, 33554432
s_xor_b32 s69, s68, 262144
MAV 88,40,116
TR 12,6,33888
TR 14,6,34400
MAV 92,44,116
TR 24,6,42304
v_and_b32 v2, 1, v1
v_lshlrev_b32 v2, 4, v2
MAV 92,60,124
buffer_load_dwordx4 v[172:175], v4, s[16:19], s52 offen offset:1024 sc1
v_mov_b32 v224, 0x3f80
MAV 76,60,120
TR 26,6,42816
v_lshlrev_b32 v2, v2, v224
MAV 76,44,112
TR 28,6,42336
TR 30,6,42848
s_waitcnt vmcnt(12) lgkmcnt(8)
MAV 64,0,128
TR 32,6,50688
s_add_u32 s52, s78, 278528
v_bfe_u32 v224, v1, 2, 2
MAV 64,16,136
buffer_load_dwordx4 v[176:179], v4, s[16:19], s52 offen sc1
v_lshrrev_b32 v225, 4, v1
MAV 80,16,140
TR 34,6,51200
v_cmp_eq_u32 vcc, v224, v225
s_nop 1
v_cndmask_b32 v2, 0, v2, vcc
MAV 80,0,132
TR 36,6,50720
TR 38,6,51232
MAV 84,4,132
TR 48,6,59136
v_and_b32 v224, 2, v1
v_cmp_eq_u32 vcc, 0, v224
MAV 84,20,140
buffer_load_dwordx4 v[180:183], v4, s[16:19], s52 offen offset:1024 sc1
v_cndmask_b32 v226, 0, v2, vcc
MAV 68,20,136
TR 50,6,59648
v_cndmask_b32 v227, v2, 0, vcc
MAV 68,4,128
TR 52,6,59168
TR 54,6,59680
s_waitcnt lgkmcnt(8)
MAV 72,8,128
TR 40,6,50752
s_add_u32 s52, s79, 393216
v_mov_b32 v224, 0
MAV 72,24,136
buffer_load_dwordx4 v[184:187], v4, s[16:19], s52 offen sc1
v_mov_b32 v225, 0
MAV 88,24,140
TR 42,6,51264
v_mov_b32 v228, 0
v_mov_b32 v229, 0
MAV 88,8,132
TR 44,6,50784
TR 46,6,51296
MAV 92,12,132
TR 56,6,59200
v_bfe_u32 v18, v1, 3, 1
v_lshrrev_b32 v2, 4, v1
MAV 92,28,140
buffer_load_dwordx4 v[188:191], v4, s[16:19], s52 offen offset:1024 sc1
v_lshl_add_u32 v18, v2, 3, v18
MAV 76,28,136
TR 58,6,59712
s_lshl_b32 s62, s3, 1
MAV 76,12,128
TR 60,6,59232
TR 62,6,59744
s_waitcnt vmcnt(8) lgkmcnt(8)
s_barrier
v_add_u32 v6, s57, v6
MAV 64,32,144
ds_read_b64_tr_b16 a[0:1], v6
s_add_u32 s52, s76, 507904
v_add_u32 v18, s62, v18
MAV 64,48,152
buffer_load_dwordx4 v[192:195], v4, s[16:19], s52 offen sc1
v_mul_u32_u24 v18, 6144, v18
MAV 80,48,156
TR 2,6,512
v_and_b32 v2, 7, v1
v_lshl_add_u32 v18, v2, 4, v18
MAV 80,32,148
TR 4,6,32
TR 6,6,544
MAV 84,36,148
TR 16,6,8448
s_lshl_b32 s62, s9, 7
v_add_u32 v18, s62, v18
MAV 84,52,156
buffer_load_dwordx4 v[196:199], v4, s[16:19], s52 offen offset:1024 sc1
v_add_u32 v19, 1024, v18
MAV 68,52,152
TR 18,6,8960
v_add_u32 v20, 2048, v18
MAV 68,36,144
TR 20,6,8480
TR 22,6,8992
s_waitcnt lgkmcnt(8)
MAV 72,40,144
TR 8,6,64
s_add_u32 s52, s77, 622592
s_mul_i32 s59, s3, 3104
MAV 72,56,152
buffer_load_dwordx4 v[200:203], v4, s[16:19], s52 offen sc1
s_mov_b32 s58, 0
MAV 88,56,156
TR 10,6,576
v_accvgpr_read_b32 v28, a224
v_add_f32 v32, v32, v28
MAV 88,40,148
TR 12,6,96
TR 14,6,608
MAV 92,44,148
TR 24,6,8512
v_accvgpr_read_b32 v29, a225
v_add_f32 v33, v33, v29
MAV 92,60,156
buffer_load_dwordx4 v[204:207], v4, s[16:19], s52 offen offset:1024 sc1
v_accvgpr_read_b32 v28, a226
MAV 76,60,152
TR 26,6,9024
v_add_f32 v34, v34, v28
MAV 76,44,144
TR 28,6,8544
TR 30,6,9056
s_waitcnt vmcnt(8) lgkmcnt(8)
MAV 64,0,160
TR 32,6,16896
s_add_u32 s52, s78, 737280
v_accvgpr_read_b32 v29, a227
MAV 64,16,168
buffer_load_dwordx4 v[208:211], v4, s[16:19], s52 offen sc1
v_add_f32 v35, v35, v29
MAV 80,16,172
TR 34,6,17408
v_accvgpr_read_b32 v28, a228
v_add_f32 v36, v36, v28
MAV 80,0,164
TR 36,6,16928
TR 38,6,17440
MAV 84,4,164
TR 48,6,25344
v_accvgpr_read_b32 v29, a229
v_add_f32 v37, v37, v29
MAV 84,20,172
buffer_load_dwordx4 v[212:215], v4, s[16:19], s52 offen offset:1024 sc1
v_accvgpr_read_b32 v28, a230
MAV 68,20,168
TR 50,6,25856
v_add_f32 v38, v38, v28
MAV 68,4,160
TR 52,6,25376
TR 54,6,25888
s_waitcnt lgkmcnt(8)
MAV 72,8,160
TR 40,6,16960
s_add_u32 s52, s79, 851968
v_accvgpr_read_b32 v29, a231
MAV 72,24,168
buffer_load_dwordx4 v[216:219], v4, s[16:19], s52 offen sc1
v_add_f32 v39, v39, v29
MAV 88,24,172
TR 42,6,17472
v_accvgpr_read_b32 v28, a232
v_add_f32 v40, v40, v28
MAV 88,8,164
TR 44,6,16992
TR 46,6,17504
MAV 92,12,164
TR 56,6,25408
v_accvgpr_read_b32 v29, a233
v_add_f32 v41, v41, v29
MAV 92,28,172
buffer_load_dwordx4 v[220:223], v4, s[16:19], s52 offen offset:1024 sc1
v_accvgpr_read_b32 v28, a234
MAV 76,28,168
TR 58,6,25920
v_add_f32 v42, v42, v28
MAV 76,12,160
TR 60,6,25440
TR 62,6,25952
s_waitcnt vmcnt(8) lgkmcnt(8)
MAV 64,32,176
TR 0,6,33792
v_accvgpr_read_b32 v29, a235
MAV 64,48,184
TR 2,6,34304
v_add_f32 v43, v43, v29
v_accvgpr_read_b32 v28, a236
MAV 80,48,188
TR 4,6,33824
MAV 80,32,180
TR 6,6,34336
v_add_f32 v44, v44, v28
v_accvgpr_read_b32 v29, a237
MAV 84,36,180
TR 16,6,42240
MAV 84,52,188
TR 18,6,42752
v_add_f32 v45, v45, v29
v_accvgpr_read_b32 v28, a238
MAV 68,52,184
TR 20,6,42272
MAV 68,36,176
TR 22,6,42784
v_add_f32 v46, v46, v28
s_waitcnt lgkmcnt(8)
MAV 72,40,176
TR 8,6,33856
v_accvgpr_read_b32 v29, a239
MAV 72,56,184
.Lpad20:
s_cbranch_execz .Lnopoll37r
TR 10,6,34368
v_add_f32 v47, v47, v29
MAV 88,56,188
TR 12,6,33888
v_accvgpr_read_b32 v28, a240
MAV 88,40,180
TR 14,6,34400
v_add_f32 v48, v48, v28
MAV 92,44,180
TR 24,6,42304
v_accvgpr_read_b32 v29, a241
MAV 92,60,188
TR 26,6,42816
v_add_f32 v49, v49, v29
MAV 76,60,184
TR 28,6,42336
v_accvgpr_read_b32 v28, a242
MAV 76,44,176
TR 30,6,42848
v_add_f32 v50, v50, v28
s_waitcnt vmcnt(4) lgkmcnt(8)
MAV 64,0,192
TR 32,6,50688
v_accvgpr_read_b32 v29, a243
MAV 64,16,200
TR 34,6,51200
v_add_f32 v51, v51, v29
v_accvgpr_read_b32 v28, a244
MAV 80,16,204
TR 36,6,50720
MAV 80,0,196
TR 38,6,51232
v_add_f32 v52, v52, v28
v_accvgpr_read_b32 v29, a245
MAV 84,4,196
TR 48,6,59136
MAV 84,20,204
TR 50,6,59648
v_add_f32 v53, v53, v29
v_accvgpr_read_b32 v28, a246
MAV 68,20,200
TR 52,6,59168
MAV 68,4,192
TR 54,6,59680
v_add_f32 v54, v54, v28
s_waitcnt lgkmcnt(8)
MAV 72,8,192
TR 40,6,50752
v_accvgpr_read_b32 v29, a247
MAV 72,24,200
TR 42,6,51264
v_add_f32 v55, v55, v29
MAV 88,24,204
TR 44,6,50784
v_accvgpr_read_b32 v28, a248
MAV 88,8,196
TR 46,6,51296
v_add_f32 v56, v56, v28
MAV 92,12,196
TR 56,6,59200
v_accvgpr_read_b32 v29, a249
MAV 92,28,204
TR 58,6,59712
v_add_f32 v57, v57, v29
MAV 76,28,200
TR 60,6,59232
v_accvgpr_read_b32 v28, a250
MAV 76,12,192
TR 62,6,59744
v_add_f32 v58, v58, v28
s_waitcnt vmcnt(0) lgkmcnt(8)
MAV 64,32,208
ds_read_b64_tr_b16 a[0:1], v7
v_accvgpr_read_b32 v29, a251
MAV 64,48,216
TR 2,7,512
v_add_f32 v59, v59, v29
MAV 80,48,220
TR 4,7,32
MAV 80,32,212
TR 6,7,544
v_accvgpr_read_b32 v28, a252
MAV 84,36,212
TR 16,7,8448
v_add_f32 v60, v60, v28
MAV 84,52,220
TR 18,7,8960
MAV 68,52,216
TR 20,7,8480
v_accvgpr_read_b32 v29, a253
MAV 68,36,208
TR 22,7,8992
s_waitcnt lgkmcnt(8)
MAV 72,40,208
TR 8,7,64
v_add_f32 v61, v61, v29
MAV 72,56,216
TR 10,7,576
MAV 88,56,220
TR 12,7,96
v_accvgpr_read_b32 v28, a254
MAV 88,40,212
TR 14,7,608
v_add_f32 v62, v62, v28
MAV 92,44,212
TR 24,7,8512
MAV 92,60,220
TR 26,7,9024
v_accvgpr_read_b32 v29, a255
MAV 76,60,216
TR 28,7,8544
v_add_f32 v63, v63, v29
MAV 76,44,208
TR 30,7,9056
s_waitcnt lgkmcnt(8)
MAV 32,0,96
TR 32,7,16896
v_cvt_pk_bf16_f32 v232, v64, v65
MAV 32,16,104
TR 34,7,17408
v_cvt_pk_bf16_f32 v233, v66, v67
v_cvt_pk_bf16_f32 v234, v68, v69
MAV 48,16,108
TR 36,7,16928
v_cvt_pk_bf16_f32 v235, v70, v71
MAV 48,0,100
TR 38,7,17440
buffer_store_dwordx4 v[232:235], v4, s[16:19], s69 offen sc1
s_add_u32 s69, s69, 131072
MAV 52,4,100
TR 48,7,25344
v_cvt_pk_bf16_f32 v236, v72, v73
MAV 52,20,108
TR 50,7,25856
v_cvt_pk_bf16_f32 v237, v74, v75
v_cvt_pk_bf16_f32 v238, v76, v77
MAV 36,20,104
TR 52,7,25376
v_cvt_pk_bf16_f32 v239, v78, v79
MAV 36,4,96
TR 54,7,25888
buffer_store_dwordx4 v[236:239], v4, s[16:19], s69 offen sc1
s_waitcnt lgkmcnt(8)
MAV 40,8,96
TR 40,7,16960
s_add_u32 s69, s69, -130048
MAV 40,24,104
TR 42,7,17472
v_cvt_pk_bf16_f32 v240, v80, v81
v_cvt_pk_bf16_f32 v241, v82, v83
MAV 56,24,108
TR 44,7,16992
v_cvt_pk_bf16_f32 v242, v84, v85
MAV 56,8,100
TR 46,7,17504
v_cvt_pk_bf16_f32 v243, v86, v87
buffer_store_dwordx4 v[240:243], v4, s[16:19], s69 offen sc1
MAV 60,12,100
TR 56,7,25408
s_add_u32 s69, s69, 131072
MAV 60,28,108
TR 58,7,25920
v_cvt_pk_bf16_f32 v244, v88, v89
v_cvt_pk_bf16_f32 v245, v90, v91
MAV 44,28,104
TR 60,7,25440
v_cvt_pk_bf16_f32 v246, v92, v93
MAV 44,12,96
TR 62,7,25952
v_cvt_pk_bf16_f32 v247, v94, v95
buffer_store_dwordx4 v[244:247], v4, s[16:19], s69 offen sc1
s_waitcnt lgkmcnt(8)
MAV 32,32,112
TR 0,7,33792
MAV 32,48,120
TR 2,7,34304
MAV 48,48,124
TR 4,7,33824
MAV 48,32,116
TR 6,7,34336
MAV 52,36,116
TR 16,7,42240
MAV 52,52,124
TR 18,7,42752
MAV 36,52,120
TR 20,7,42272
MAV 36,36,112
TR 22,7,42784
s_waitcnt lgkmcnt(8)
MAV 40,40,112
TR 8,7,33856
MAV 40,56,120
TR 10,7,34368
MAV 56,56,124
TR 12,7,33888
MAV 56,40,116
TR 14,7,34400
MAV 60,44,116
TR 24,7,42304
MAV 60,60,124
TR 26,7,42816
MAV 44,60,120
TR 28,7,42336
MAV 44,44,112
TR 30,7,42848
s_waitcnt lgkmcnt(8)
MAV 32,0,128
TR 32,7,50688
MAV 32,16,136
TR 34,7,51200
MAV 48,16,140
TR 36,7,50720
MAV 48,0,132
TR 38,7,51232
MAV 52,4,132
TR 48,7,59136
MAV 52,20,140
TR 50,7,59648
MAV 36,20,136
TR 52,7,59168
MAV 36,4,128
TR 54,7,59680
s_waitcnt lgkmcnt(8)
MAV 40,8,128
TR 40,7,50752
MAV 40,24,136
TR 42,7,51264
MAV 56,24,140
TR 44,7,50784
MAV 56,8,132
TR 46,7,51296
MAV 60,12,132
TR 56,7,59200
MAV 60,28,140
TR 58,7,59712
MAV 44,28,136
TR 60,7,59232
MAV 44,12,128
TR 62,7,59744
v_add_u32 v7, s57, v7
s_waitcnt lgkmcnt(8)
MAV 32,32,144
ds_read_b64_tr_b16 a[0:1], v7
MAV 32,48,152
s_waitcnt vmcnt(0)
buffer_atomic_add v30, v26, s[16:19], s71 offen
MAV 48,48,156
TR 2,7,512
MAV 48,32,148
TR 4,7,32
TR 6,7,544
MAV 52,36,148
MAV 52,52,156
TR 16,7,8448
TR 18,7,8960
MAV 36,52,152
TR 20,7,8480
MAV 36,36,144
s_waitcnt lgkmcnt(7)
MAV 40,40,144
TR 22,7,8992
MAV 40,56,152
TR 8,7,64
TR 10,7,576
MAV 56,56,156
MAV 56,40,148
TR 12,7,96
TR 14,7,608
MAV 60,44,148
TR 24,7,8512
MAV 60,60,156
TR 26,7,9024
MAV 44,60,152
TR 28,7,8544
MAV 44,44,144
TR 30,7,9056
s_waitcnt lgkmcnt(8)
s_barrier
MAV 32,0,160
TR 32,7,16896
MAV 32,16,168
buffer_atomic_add v31, v26, s[16:19], s70 offen sc0
MAV 48,16,172
TR 34,7,17408
MAV 48,0,164
TR 36,7,16928
TR 38,7,17440
MAV 52,4,164
MAV 52,20,172
TR 48,7,25344
TR 50,7,25856
MAV 36,20,168
TR 52,7,25376
MAV 36,4,160
s_waitcnt lgkmcnt(7)
MAV 40,8,160
TR 54,7,25888
MAV 40,24,168
TR 40,7,16960
TR 42,7,17472
MAV 56,24,172
MAV 56,8,164
TR 44,7,16992
TR 46,7,17504
MAV 60,12,164
TR 56,7,25408
MAV 60,28,172
TR 58,7,25920
MAV 44,28,168
TR 60,7,25440
MAV 44,12,160
TR 62,7,25952
s_waitcnt lgkmcnt(8)
MAV 32,32,176
TR 0,7,33792
MAV 32,48,184
TR 2,7,34304
MAV 48,48,188
TR 4,7,33824
MAV 48,32,180
TR 6,7,34336
MAV 52,36,180
TR 16,7,42240
MAV 52,52,188
TR 18,7,42752
MAV 36,52,184
TR 20,7,42272
MAV 36,36,176
TR 22,7,42784
s_waitcnt lgkmcnt(8)
MAV 40,40,176
TR 8,7,33856
MAV 40,56,184
TR 10,7,34368
MAV 56,56,188
TR 12,7,33888
MAV 56,40,180
TR 14,7,34400
MAV 60,44,180
TR 24,7,42304
MAV 60,60,188
TR 26,7,42816
MAV 44,60,184
TR 28,7,42336
MAV 44,44,176
TR 30,7,42848
s_waitcnt vmcnt(0)
v_cmp_le_u32 vcc, 1, v31
s_nop 0
s_cbranch_vccnz .Lxs51
s_mov_b32 s15, 0
.Lxs51l:
v_mov_b32 v31, 0
buffer_atomic_add v31, v26, s[16:19], s70 offen sc0
s_add_u32 s15, s15, 1
s_cmp_gt_u32 s15, 100000
s_waitcnt vmcnt(0)
s_cbranch_scc1 .Lxs51
v_cmp_le_u32 vcc, 1, v31
s_nop 0
s_cbranch_vccz .Lxs51l
.Lxs51:
s_waitcnt lgkmcnt(8)
MAV 32,0,192
TR 32,7,50688
MAV 32,16,200
buffer_load_dwordx4 v[232:235], v4, s[16:19], s68 offen sc1
MAV 48,16,204
TR 34,7,51200
s_add_u32 s68, s68, 131072
MAV 48,0,196
TR 36,7,50720
TR 38,7,51232
MAV 52,4,196
TR 48,7,59136
MAV 52,20,204
buffer_load_dwordx4 v[236:239], v4, s[16:19], s68 offen sc1
MAV 36,20,200
TR 50,7,59648
s_add_u32 s68, s68, -130048
MAV 36,4,192
TR 52,7,59168
TR 54,7,59680
s_waitcnt lgkmcnt(8)
MAV 40,8,192
TR 40,7,50752
MAV 40,24,200
buffer_load_dwordx4 v[240:243], v4, s[16:19], s68 offen sc1
MAV 56,24,204
TR 42,7,51264
s_add_u32 s68, s68, 131072
MAV 56,8,196
TR 44,7,50784
TR 46,7,51296
MAV 60,12,196
TR 56,7,59200
MAV 60,28,204
buffer_load_dwordx4 v[244:247], v4, s[16:19], s68 offen sc1
MAV 44,28,200
TR 58,7,59712
MAV 44,12,192
TR 60,7,59232
TR 62,7,59744
s_waitcnt lgkmcnt(8)
MAV 32,32,208
MAV 32,48,216
MAV 48,48,220
MAV 48,32,212
MAV 52,36,212
MAV 52,52,220
MAV 36,52,216
MAV 36,36,208
s_waitcnt lgkmcnt(0)
MAV 40,40,208
MAV 40,56,216
MAV 56,56,220
MAV 56,40,212
MAV 60,44,212
MAV 60,60,220
MAV 44,60,216
MAV 44,44,208
s_waitcnt vmcnt(3)
v_mfma_f32_16x16x32_bf16 v[32:35], v[226:229], v[232:235], v[32:35]
s_lshl_b32 s64, s6, 14
s_lshl_b32 s65, s49, 13
s_add_u32 s64, s64, s65
v_mfma_f32_16x16x32_bf16 v[36:39], v[224:227], v[232:235], v[36:39]
s_lshl_b32 s65, s7, 9
s_add_u32 s64, s64, s65
s_lshl_b32 s65, s48, 8
s_waitcnt vmcnt(2)
v_mfma_f32_16x16x32_bf16 v[40:43], v[226:229], v[236:239], v[40:43]
s_add_u32 s64, s64, s65
s_add_u32 s64, s64, 62914560
v_and_b32 v152, 31, v1
v_mfma_f32_16x16x32_bf16 v[44:47], v[224:227], v[236:239], v[44:47]
s_lshl_b32 s62, s7, 18
v_lshlrev_b32 v152, 3, v152
v_lshrrev_b32 v153, 5, v1
s_waitcnt vmcnt(1)
v_mfma_f32_16x16x32_bf16 v[48:51], v[226:229], v[240:243], v[48:51]
s_add_u32 s62, s62, 33554432
v_lshl_add_u32 v152, v153, 28, v152
s_add_u32 s63, s62, 131072
v_mfma_f32_16x16x32_bf16 v[52:55], v[224:227], v[240:243], v[52:55]
v_cvt_pk_bf16_f32 v128, v32, v33
v_cvt_pk_bf16_f32 v129, v34, v35
s_waitcnt vmcnt(0)
v_mfma_f32_16x16x32_bf16 v[56:59], v[226:229], v[244:247], v[56:59]
v_cvt_pk_bf16_f32 v130, v36, v37
v_cvt_pk_bf16_f32 v131, v38, v39
v_mfma_f32_16x16x32_bf16 v[60:63], v[224:227], v[244:247], v[60:63]
buffer_store_dwordx4 v[128:131], v4, s[16:19], s62 offen sc1
v_cvt_pk_bf16_f32 v132, v40, v41
v_cvt_pk_bf16_f32 v133, v42, v43
v_cvt_pk_bf16_f32 v134, v44, v45
v_cvt_pk_bf16_f32 v135, v46, v47
v_cvt_pk_bf16_f32 v136, v48, v49
v_cvt_pk_bf16_f32 v137, v50, v51
v_cvt_pk_bf16_f32 v138, v52, v53
v_cvt_pk_bf16_f32 v139, v54, v55
v_cvt_pk_bf16_f32 v140, v56, v57
v_cvt_pk_bf16_f32 v141, v58, v59
v_cvt_pk_bf16_f32 v142, v60, v61
v_cvt_pk_bf16_f32 v143, v62, v63
v_pk_mul_f32 v[146:147], v[32:33], v[32:33]
buffer_store_dwordx4 v[132:135], v4, s[16:19], s63 offen sc1
v_pk_mul_f32 v[150:151], v[48:49], v[48:49]
v_pk_fma_f32 v[146:147], v[34:35], v[34:35], v[146:147]
v_pk_add_f32 v[144:145], v[32:33], v[34:35]
v_pk_fma_f32 v[150:151], v[50:51], v[50:51], v[150:151]
v_pk_add_f32 v[148:149], v[48:49], v[50:51]
v_pk_fma_f32 v[146:147], v[36:37], v[36:37], v[146:147]
v_pk_add_f32 v[144:145], v[144:145], v[36:37]
v_pk_fma_f32 v[150:151], v[52:53], v[52:53], v[150:151]
v_pk_add_f32 v[148:149], v[148:149], v[52:53]
v_pk_fma_f32 v[146:147], v[38:39], v[38:39], v[146:147]
v_pk_add_f32 v[144:145], v[144:145], v[38:39]
v_pk_fma_f32 v[150:151], v[54:55], v[54:55], v[150:151]
v_pk_add_f32 v[148:149], v[148:149], v[54:55]
buffer_store_dwordx4 v[136:139], v4, s[16:19], s62 offen offset:1024 sc1
v_pk_fma_f32 v[146:147], v[40:41], v[40:41], v[146:147]
v_pk_add_f32 v[144:145], v[144:145], v[40:41]
v_pk_fma_f32 v[150:151], v[56:57], v[56:57], v[150:151]
v_pk_add_f32 v[148:149], v[148:149], v[56:57]
v_pk_fma_f32 v[146:147], v[42:43], v[42:43], v[146:147]
v_pk_add_f32 v[144:145], v[144:145], v[42:43]
v_pk_fma_f32 v[150:151], v[58:59], v[58:59], v[150:151]
v_pk_add_f32 v[148:149], v[148:149], v[58:59]
v_pk_fma_f32 v[146:147], v[44:45], v[44:45], v[146:147]
v_pk_add_f32 v[144:145], v[144:145], v[44:45]
v_pk_fma_f32 v[150:151], v[60:61], v[60:61], v[150:151]
v_pk_add_f32 v[148:149], v[148:149], v[60:61]
v_pk_fma_f32 v[146:147], v[46:47], v[46:47], v[146:147]
buffer_store_dwordx4 v[140:143], v4, s[16:19], s63 offen offset:1024 sc1
v_pk_add_f32 v[144:145], v[144:145], v[46:47]
v_pk_fma_f32 v[150:151], v[62:63], v[62:63], v[150:151]
v_pk_add_f32 v[148:149], v[148:149], v[62:63]
v_add_f32 v144, v144, v145
v_add_f32 v146, v146, v147
v_add_f32 v148, v148, v149
v_add_f32 v150, v150, v151
s_nop 0
v_permlane16_swap_b32 v144, v148
v_permlane16_swap_b32 v146, v150
v_add_f32 v144, v144, v148
v_add_f32 v146, v146, v150
s_nop 1
v_permlane32_swap_b32 v144, v146
v_add_f32 v144, v144, v146
s_nop 1
v_permlane32_swap_b32 v144, v145
buffer_store_dwordx2 v[144:145], v152, s[16:19], s64 offen sc1
s_nop 1
s_mov_b32 s54, s58
s_mov_b32 s56, s59
v_accvgpr_write_b32 a224, v32
v_accvgpr_write_b32 a225, v33
v_accvgpr_write_b32 a226, v34
v_accvgpr_write_b32 a227, v35
v_accvgpr_write_b32 a228, v36
v_accvgpr_write_b32 a229, v37
v_accvgpr_write_b32 a230, v38
v_accvgpr_write_b32 a231, v39
v_accvgpr_write_b32 a232, v40
v_accvgpr_write_b32 a233, v41
v_accvgpr_write_b32 a234, v42
v_accvgpr_write_b32 a235, v43
v_accvgpr_write_b32 a236, v44
v_accvgpr_write_b32 a237, v45
v_accvgpr_write_b32 a238, v46
v_accvgpr_write_b32 a239, v47
v_accvgpr_write_b32 a240, v48
v_accvgpr_write_b32 a241, v49
v_accvgpr_write_b32 a242, v50
v_accvgpr_write_b32 a243, v51
v_accvgpr_write_b32 a244, v52
v_accvgpr_write_b32 a245, v53
v_accvgpr_write_b32 a246, v54
v_accvgpr_write_b32 a247, v55
v_accvgpr_write_b32 a248, v56
v_accvgpr_write_b32 a249, v57
v_accvgpr_write_b32 a250, v58
v_accvgpr_write_b32 a251, v59
v_accvgpr_write_b32 a252, v60
v_accvgpr_write_b32 a253, v61
v_accvgpr_write_b32 a254, v62
v_accvgpr_write_b32 a255, v63
s_lshl_b32 s62, s3, 11
s_add_u32 s62, s62, s85
v_lshl_add_u32 v21, v1, 4, s62
v_lshrrev_b32 v2, 3, v1
v_cmp_eq_u32 vcc, 3, v2
v_add_u32 v2, 67108480, v21
s_nop 0
v_cndmask_b32 v21, v21, v2, vcc
s_sub_u32 s62, s86, 2048
v_lshl_add_u32 v22, v0, 2, s62
.Lpad21:
s_cbranch_execz .Lnopoll37r
v_lshrrev_b32 v2, 5, v0
v_cmp_eq_u32 vcc, 3, v2
v_add_u32 v2, 67108480, v22
s_nop 0
v_cndmask_b32 v22, v22, v2, vcc
s_mul_i32 s62, s48, 4608
v_lshl_add_u32 v23, v1, 4, s62
v_lshrrev_b32 v24, 4, v1
v_mul_u32_u24 v24, 2304, v24
v_and_b32 v2, 15, v1
v_lshl_add_u32 v24, v2, 4, v24
s_mov_b32 s52, 33554432
s_mul_i32 s55, s3, 2304
v_bfe_u32 v25, v1, 3, 2
v_mul_u32_u24 v25, 3104, v25
v_bfe_u32 v2, v1, 2, 1
v_lshl_add_u32 v25, v2, 7, v25
v_bfe_u32 v2, v1, 5, 1
v_lshl_add_u32 v25, v2, 8, v25
v_and_b32 v2, 3, v1
v_lshl_add_u32 v25, v2, 3, v25
s_lshl_b32 s62, s49, 6
s_add_u32 s62, s62, 67584
v_add_u32 v25, s62, v25
s_lshl_b32 s62, s8, 1
s_add_u32 s62, s62, s3
s_lshr_b32 s63, s50, 2
s_cmp_lt_u32 s3, 2
s_cselect_b32 s62, s62, s63
s_lshl_b32 s62, s62, 13
s_cmp_eq_u32 s3, 3
s_cselect_b32 s62, 268435456, s62
v_lshl_add_u32 v26, v1, 4, s62
s_lshr_b32 s63, s20, 7
s_sub_u32 s63, 3, s63
s_and_b32 s63, s63, 7
s_and_b32 s62, s9, 8
s_add_u32 s63, s63, s62
s_lshl_b32 s62, s5, 2
s_add_u32 s62, s62, s3
s_mul_i32 s62, s62, 12288
s_lshl_b32 s64, s63, 7
s_add_u32 s62, s62, s64
s_xor_b32 s63, s63, s9
s_cmp_lt_u32 s63, 4
s_cselect_b32 s62, s62, 16777216
v_lshrrev_b32 v14, 3, v1
v_min_u32 v14, 5, v14
v_lshl_add_u32 v14, v14, 11, s62
s_mov_b32 s44, 983040
buffer_load_dword v27, v14, s[20:23], s44 offen
s_mov_b32 s44, 2555904
s_mul_i32 s59, s3, 2080
s_and_b32 s87, s6, 3
s_lshl_b32 s87, s87, 17
v_bfe_u32 v5, v1, 3, 1
v_lshrrev_b32 v2, 4, v1
v_lshl_add_u32 v5, v2, 3, v5
s_lshl_b32 s62, s3, 1
v_add_u32 v5, s62, v5
v_mul_u32_u24 v5, 2048, v5
v_and_b32 v2, 7, v1
v_lshl_add_u32 v5, v2, 4, v5
s_lshl_b32 s62, s7, 7
v_add_u32 v5, s62, v5
v_add_u32 v6, 64512, v5
s_lshl_b32 s62, s6, 10
s_add_u32 s62, s62, 30474240
s_lshl_b32 s64, s8, 10
s_add_u32 s64, s64, 30474240
s_lshr_b32 s67, s9, 1
s_and_b32 s67, s67, 3
s_lshl_b32 s67, s67, 7
s_add_u32 s64, s64, s67
s_lshr_b32 s65, s50, 3
s_lshl_b32 s65, s65, 10
s_add_u32 s65, s65, 30474240
s_lshr_b32 s67, s9, 1
s_and_b32 s67, s67, 3
s_lshl_b32 s67, s67, 7
s_add_u32 s65, s65, s67
v_lshl_add_u32 v252, v1, 7, s62
v_mov_b32 v253, s64
v_mov_b32 v255, 1
v_writelane_b32 v253, s65, 1
s_waitcnt vmcnt(1) lgkmcnt(0)
s_cmp_lg_u32 s3, 1
s_barrier
s_cbranch_scc1 .Lfirst54
s_mov_b64 exec, 15
buffer_atomic_add v255, v252, s[16:19], 0 offen
s_mov_b64 exec, 3
v_mov_b32 v254, 0
buffer_atomic_add v254, v253, s[16:19], 0 offen sc0
s_mov_b64 exec, -1
.Lfirst54:
s_add_u32 m0, s56, 117248
s_nop 0
buffer_load_dwordx4 v18, s[20:23], s54 offen lds
v_lshrrev_b32 v2, 4, v1
v_lshlrev_b32 v2, 2, v2
v_and_b32 v13, 15, v1
v_sub_u32 v2, v13, v2
v_mov_b32 v13, 0xff61b1e6
v_subrev_u32 v54, 0, v2
v_cmp_gt_u32 vcc, 8, v54
s_nop 1
v_cndmask_b32 v50, v13, 0, vcc
buffer_load_dwordx4 v19, s[20:23], s54 offen offset:1024 lds
v_cmp_gt_i32 vcc, -8, v54
s_nop 1
v_cndmask_b32 v46, v13, 0, vcc
v_subrev_u32 v54, 1, v2
v_cmp_gt_u32 vcc, 8, v54
s_nop 1
v_cndmask_b32 v51, v13, 0, vcc
v_cmp_gt_i32 vcc, -8, v54
s_nop 1
v_cndmask_b32 v47, v13, 0, vcc
v_subrev_u32 v54, 2, v2
buffer_load_dwordx4 v20, s[20:23], s54 offen offset:2048 lds
s_add_u32 s54, s54, 196608
v_cmp_gt_u32 vcc, 8, v54
s_nop 1
v_cndmask_b32 v52, v13, 0, vcc
v_cmp_gt_i32 vcc, -8, v54
s_nop 1
v_cndmask_b32 v48, v13, 0, vcc
v_subrev_u32 v54, 3, v2
v_cmp_gt_u32 vcc, 8, v54
s_nop 1
v_cndmask_b32 v53, v13, 0, vcc
v_cmp_gt_i32 vcc, -8, v54
s_add_u32 m0, s56, 129664
s_nop 0
buffer_load_dwordx4 v18, s[20:23], s54 offen lds
v_cndmask_b32 v49, v13, 0, vcc
s_cmp_lt_u32 s8, 2
s_cselect_b64 vcc, -1, 0
v_cndmask_b32 v54, v46, v13, vcc
v_cndmask_b32 v55, v47, v13, vcc
v_cndmask_b32 v56, v48, v13, vcc
v_cndmask_b32 v57, v49, v13, vcc
v_mov_b64 v[60:61], 0
buffer_load_dwordx4 v19, s[20:23], s54 offen offset:1024 lds
v_mov_b64 v[62:63], 0
v_mov_b64 v[64:65], 0
v_mov_b64 v[66:67], 0
v_mov_b64 v[68:69], 0
v_mov_b64 v[70:71], 0
v_mov_b64 v[72:73], 0
v_mov_b64 v[74:75], 0
v_mov_b64 v[76:77], 0
buffer_load_dwordx4 v20, s[20:23], s54 offen offset:2048 lds
s_add_u32 s54, s54, 196608
v_mov_b64 v[78:79], 0
v_mov_b64 v[80:81], 0
v_mov_b64 v[82:83], 0
v_mov_b64 v[84:85], 0
v_mov_b64 v[86:87], 0
v_mov_b64 v[88:89], 0
v_mov_b64 v[90:91], 0
v_mov_b64 v[92:93], 0
s_add_u32 m0, s56, 67584
s_nop 0
buffer_load_dwordx4 v18, s[20:23], s54 offen lds
v_mov_b64 v[94:95], 0
v_mov_b64 v[96:97], 0
v_mov_b64 v[98:99], 0
v_mov_b64 v[100:101], 0
v_mov_b64 v[102:103], 0
v_mov_b64 v[104:105], 0
v_mov_b64 v[106:107], 0
v_mov_b64 v[108:109], 0
buffer_load_dwordx4 v19, s[20:23], s54 offen offset:1024 lds
v_mov_b64 v[110:111], 0
v_mov_b64 v[112:113], 0
v_mov_b64 v[114:115], 0
v_mov_b64 v[116:117], 0
v_mov_b64 v[118:119], 0
v_mov_b64 v[120:121], 0
v_mov_b64 v[122:123], 0
v_mov_b64 v[124:125], 0
buffer_load_dwordx4 v20, s[20:23], s54 offen offset:2048 lds
s_add_u32 s54, s54, 196608
v_mov_b64 v[126:127], 0
v_mov_b64 v[128:129], 0
v_mov_b64 v[130:131], 0
v_mov_b64 v[132:133], 0
v_mov_b64 v[134:135], 0
v_mov_b64 v[136:137], 0
v_mov_b64 v[138:139], 0
v_mov_b64 v[140:141], 0
s_add_u32 m0, s56, 80000
s_nop 0
buffer_load_dwordx4 v18, s[20:23], s54 offen lds
v_mov_b64 v[142:143], 0
v_mov_b64 v[144:145], 0
v_mov_b64 v[146:147], 0
v_mov_b64 v[148:149], 0
v_mov_b64 v[150:151], 0
v_mov_b64 v[152:153], 0
v_mov_b64 v[154:155], 0
v_mov_b64 v[156:157], 0
buffer_load_dwordx4 v19, s[20:23], s54 offen offset:1024 lds
v_mov_b64 v[158:159], 0
v_mov_b64 v[160:161], 0
v_mov_b64 v[162:163], 0
v_mov_b64 v[164:165], 0
v_mov_b64 v[166:167], 0
v_mov_b64 v[168:169], 0
v_mov_b64 v[170:171], 0
v_mov_b64 v[172:173], 0
buffer_load_dwordx4 v20, s[20:23], s54 offen offset:2048 lds
s_add_u32 s54, s54, 196608
v_mov_b64 v[174:175], 0
s_mov_b32 s75, 62914560
v_and_b32 v10, 15, v1
v_lshlrev_b32 v12, 2, v10
v_lshlrev_b32 v10, 4, v10
v_add_u32 v10, 152576, v10
v_lshrrev_b32 v11, 4, v1
v_lshlrev_b32 v11, 4, v11
s_add_u32 m0, s56, 92416
s_nop 0
buffer_load_dwordx4 v18, s[20:23], s54 offen lds
s_lshl_b32 s62, s49, 7
s_add_u32 s62, s62, 158720
v_add_u32 v12, s62, v12
v_add_u32 v13, s62, v11
v_add_u32 v11, 156672, v11
s_lshl_b32 s62, s3, 11
s_add_u32 s62, s62, 143360
v_lshl_add_u32 v8, v1, 4, s62
buffer_load_dwordx4 v19, s[20:23], s54 offen offset:1024 lds
v_xor_b32 v9, 2048, v8
v_mov_b32 v248, 0x3f803f80
v_mov_b32 v249, 0x3f803f80
v_mov_b32 v250, 0x3f803f80
v_mov_b32 v251, 0x3f803f80
v_and_b32 v7, 31, v1
v_lshrrev_b32 v2, 5, v1
v_lshl_add_u32 v7, v7, 1, v2
buffer_load_dwordx4 v20, s[20:23], s54 offen offset:2048 lds
s_add_u32 s54, s54, 196608
v_and_b32 v2, 0xc0, v0
v_add_u32 v7, v7, v2
v_lshlrev_b32 v17, 2, v7
v_add_u32 v17, 156672, v17
v_lshlrev_b32 v7, 4, v7
v_add_u32 v7, 152576, v7
s_lshl_b32 s74, s9, 1
s_add_u32 s74, s74, s49
s_lshl_b32 s74, s74, 17
s_add_u32 s74, s74, s85
s_lshl_b32 s63, s48, 12
s_add_u32 s74, s74, s63
s_add_u32 s74, s74, 37748736
s_mov_b32 s62, 0
v_lshl_add_u32 v4, v1, 4, s62
v_lshrrev_b32 v2, 3, v1
v_cmp_eq_u32 vcc, 3, v2
v_add_u32 v2, 67108480, v4
s_nop 0
v_cndmask_b32 v4, v4, v2, vcc
s_cmp_lg_u32 s3, 1
s_cbranch_scc1 .Lnopoll53
s_mov_b64 exec, 3
s_mov_b32 s15, 0
v_mov_b32 v255, 0
buffer_atomic_add v255, v253, s[16:19], 0 offen sc0
s_waitcnt vmcnt(16)
v_cmp_gt_u32 vcc, 16, v254
s_nop 0
s_cbranch_vccz .Lnopoll53r
.Lpoll52:
s_waitcnt vmcnt(0)
v_cmp_gt_u32 vcc, 16, v255
s_add_u32 s15, s15, 1
s_cbranch_vccz .Lnopoll53r
v_mov_b32 v255, 0
buffer_atomic_add v255, v253, s[16:19], 0 offen sc0
s_cmp_le_u32 s15, 100000
s_cbranch_scc1 .Lpoll52
s_branch .Lnopoll53r
.Lnopoll53:
s_mov_b64 exec, 0
s_cmp_eq_u32 s3, 2
s_cbranch_scc1 .Lpad22
s_cmp_eq_u32 s3, 3
s_cbranch_scc1 .Lpad23
s_branch .Lpad24
.Lnopoll53r:
s_mov_b64 exec, -1
s_waitcnt vmcnt(9)
s_barrier
s_cmp_eq_u32 s48, 1
s_cbranch_scc1 .Lqkv55
s_add_u32 m0, s55, 36864
s_nop 0
buffer_load_dwordx4 v21, s[16:19], s52 offen sc1 lds
buffer_load_dwordx4 v21, s[16:19], s52 offen offset:1024 sc1 lds
buffer_load_dword v22, s[16:19], s52 offen offset:2048 sc1 lds
s_add_u32 s52, s52, 131072
TR 80,25,49664
TR 82,25,50176
TR 84,25,62080
s_add_u32 m0, s55, 46080
s_nop 0
buffer_load_dwordx4 v21, s[16:19], s52 offen sc1 lds
buffer_load_dwordx4 v21, s[16:19], s52 offen offset:1024 sc1 lds
buffer_load_dword v22, s[16:19], s52 offen offset:2048 sc1 lds
s_add_u32 s52, s52, 131072
TR 86,25,62592
TR 88,25,50688
TR 90,25,51200
s_add_u32 m0, s55, 0
s_nop 0
buffer_load_dwordx4 v21, s[16:19], s52 offen sc1 lds
buffer_load_dwordx4 v21, s[16:19], s52 offen offset:1024 sc1 lds
buffer_load_dword v22, s[16:19], s52 offen offset:2048 sc1 lds
s_add_u32 s52, s52, 131072
TR 92,25,63104
TR 94,25,63616
TR 96,25,51712
s_add_u32 m0, s55, 9216
s_nop 0
buffer_load_dwordx4 v21, s[16:19], s52 offen sc1 lds
buffer_load_dwordx4 v21, s[16:19], s52 offen offset:1024 sc1 lds
buffer_load_dword v22, s[16:19], s52 offen offset:2048 sc1 lds
s_add_u32 s52, s52, 131072
TR 98,25,52224
TR 100,25,64128
TR 102,25,64640
s_add_u32 m0, s55, 18432
s_nop 0
buffer_load_dwordx4 v21, s[16:19], s52 offen sc1 lds
buffer_load_dwordx4 v21, s[16:19], s52 offen offset:1024 sc1 lds
buffer_load_dword v22, s[16:19], s52 offen offset:2048 sc1 lds
s_add_u32 s52, s52, 131072
ds_read_b128 v[28:31], v13
ds_read_b128 v[32:35], v13 offset:64
ds_read_b128 v[36:39], v13 offset:256
s_add_u32 m0, s55, 27648
s_nop 0
buffer_load_dwordx4 v21, s[16:19], s52 offen sc1 lds
buffer_load_dwordx4 v21, s[16:19], s52 offen offset:1024 sc1 lds
buffer_load_dword v22, s[16:19], s52 offen offset:2048 sc1 lds
s_add_u32 s52, s52, 131072
ds_read_b128 v[40:43], v13 offset:320
ds_read_b32 v44, v12 offset:512
ds_read_b32 v45, v12 offset:576
s_waitcnt vmcnt(12)
s_barrier
RD 0,23,36864
RD 4,23,37888
RD 8,23,39168
RD 12,23,40192
RD 16,24,38912
RD 20,23,46080
RD 24,23,47104
RD 28,23,48384
RD 32,23,49408
RD 36,24,48128
s_waitcnt lgkmcnt(0)
s_mov_b32 s15, -2
.p2align 6
.Lk57:
s_waitcnt vmcnt(9) lgkmcnt(8)
s_barrier
MAA 60,80,0
TR 104,25,49696
s_add_u32 m0, s56, 104832
MAA 60,84,20
buffer_load_dwordx4 v18, s[20:23], s54 offen lds
MAA 64,84,24
TR 106,25,50208
v_add_f32 v164, v164, v168
MAA 64,80,4
TR 108,25,62112
MAA 68,80,8
TR 110,25,62624
MAA 68,84,28
buffer_load_dwordx4 v19, s[20:23], s54 offen offset:1024 lds
MAA 72,84,32
TR 112,25,50720
v_add_f32 v165, v165, v169
MAA 72,80,12
TR 114,25,51232
s_waitcnt lgkmcnt(6)
MAA 156,88,16
TR 116,25,63136
MAA 156,92,36
buffer_load_dwordx4 v20, s[20:23], s54 offen offset:2048 lds
MAA 104,92,32
s_add_u32 s54, s54, 196608
s_add_u32 m0, s55, 36864
MAA 104,88,12
buffer_load_dwordx4 v21, s[16:19], s52 offen sc1 lds
MAA 100,88,8
TR 118,25,63648
MAA 100,92,28
TR 120,25,51744
v_add_f32 v166, v166, v170
MAA 96,92,24
TR 122,25,52256
MAA 96,88,4
buffer_load_dwordx4 v21, s[16:19], s52 offen offset:1024 sc1 lds
MAA 92,88,0
TR 124,25,64160
MAA 92,92,20
TR 126,25,64672
v_add_f32 v167, v167, v171
MAA 124,20,100
ds_read_b128 a[40:43], v23
MAA 124,0,96
buffer_load_dword v22, s[16:19], s52 offen offset:2048 sc1 lds
MAA 128,4,96
RD 44,23,1024
s_add_u32 s52, s52, 131072
MAA 128,24,100
buffer_load_dword v27, v14, s[20:23], s44 offen
MAA 132,28,100
RD 48,23,2304
s_add_u32 s44, s44, 1572864
MAA 132,8,96
RD 52,23,3328
MAA 136,12,96
RD 56,24,2048
MAA 136,32,100
s_waitcnt vmcnt(13) lgkmcnt(5)
s_barrier
MAA 76,104,0
RD 60,23,9216
s_add_u32 m0, s56, 117248
MAA 76,108,20
buffer_load_dwordx4 v18, s[20:23], s54 offen lds
MAA 80,108,24
RD 64,23,10240
MAA 80,104,4
RD 68,23,11520
MAA 84,104,8
RD 72,23,12544
MAA 84,108,28
buffer_load_dwordx4 v19, s[20:23], s54 offen offset:1024 lds
MAA 88,108,32
RD 76,24,11264
MAA 88,104,12
buffer_load_dwordx4 v20, s[20:23], s54 offen offset:2048 lds
MAA 160,112,16
ds_read_b64_tr_b16 a[80:81], v25
s_add_u32 s54, s54, 196608
MAA 160,116,36
TR 82,25,512
MAA 120,116,32
TR 84,25,12416
s_add_u32 m0, s55, 46080
MAA 120,112,12
buffer_load_dwordx4 v21, s[16:19], s52 offen sc1 lds
MAA 116,112,8
TR 86,25,12928
MAA 116,116,28
TR 88,25,1024
MAA 112,116,24
TR 90,25,1536
MAA 112,112,4
buffer_load_dwordx4 v21, s[16:19], s52 offen offset:1024 sc1 lds
MAA 108,112,0
TR 92,25,13440
MAA 108,116,20
TR 94,25,13952
MAA 140,20,124
TR 96,25,2048
MAA 140,0,120
buffer_load_dword v22, s[16:19], s52 offen offset:2048 sc1 lds
MAA 144,4,120
TR 98,25,2560
s_add_u32 s52, s52, 131072
MAA 144,24,124
buffer_load_dwordx4 v[168:171], v26, s[16:19], s75 offen sc1
MAA 148,28,124
TR 100,25,14464
MAA 148,8,120
TR 102,25,14976
MAA 152,12,120
MAA 152,32,124
s_waitcnt vmcnt(17) lgkmcnt(8)
s_barrier
MAA 60,80,40
TR 104,25,32
s_add_u32 m0, s56, 129664
MAA 60,84,60
buffer_load_dwordx4 v18, s[20:23], s54 offen lds
MAA 64,84,64
TR 106,25,544
v_add_f32 v164, v164, v172
MAA 64,80,44
TR 108,25,12448
MAA 68,80,48
TR 110,25,12960
MAA 68,84,68
buffer_load_dwordx4 v19, s[20:23], s54 offen offset:1024 lds
MAA 72,84,72
TR 112,25,1056
MAA 72,80,52
TR 114,25,1568
s_waitcnt lgkmcnt(6)
MAA 156,88,56
TR 116,25,13472
v_add_f32 v165, v165, v173
MAA 156,92,76
buffer_load_dwordx4 v20, s[20:23], s54 offen offset:2048 lds
MAA 104,92,72
TR 118,25,13984
s_add_u32 s54, s54, 196608
MAA 104,88,52
TR 120,25,2080
MAA 100,88,48
s_add_u32 m0, s55, 0
MAA 100,92,68
buffer_load_dwordx4 v21, s[16:19], s52 offen sc1 lds
MAA 96,92,64
TR 122,25,2592
v_add_f32 v166, v166, v174
MAA 96,88,44
TR 124,25,14496
MAA 92,88,40
TR 126,25,15008
MAA 92,92,60
buffer_load_dwordx4 v21, s[16:19], s52 offen offset:1024 sc1 lds
MAA 124,60,100
RD 0,23,18432
MAA 124,40,96
RD 4,23,19456
v_add_f32 v167, v167, v175
MAA 128,44,96
RD 8,23,20736
MAA 128,64,100
buffer_load_dword v22, s[16:19], s52 offen offset:2048 sc1 lds
MAA 132,68,100
RD 12,23,21760
s_add_u32 s52, s52, 131072
MAA 132,48,96
RD 16,24,20480
MAA 136,52,96
MAA 136,72,100
s_waitcnt vmcnt(17) lgkmcnt(5)
s_barrier
MAA 76,104,40
RD 20,23,27648
s_add_u32 m0, s56, 67584
MAA 76,108,60
buffer_load_dwordx4 v18, s[20:23], s54 offen lds
MAA 80,108,64
RD 24,23,28672
MAA 80,104,44
RD 28,23,29952
MAA 84,104,48
RD 32,23,30976
MAA 84,108,68
buffer_load_dwordx4 v19, s[20:23], s54 offen offset:1024 lds
MAA 88,108,72
RD 36,24,29696
MAA 88,104,52
buffer_load_dwordx4 v20, s[20:23], s54 offen offset:2048 lds
MAA 160,112,56
TR 80,25,24832
s_add_u32 s54, s54, 196608
MAA 160,116,76
TR 82,25,25344
MAA 120,116,72
TR 84,25,37248
s_add_u32 m0, s55, 9216
MAA 120,112,52
buffer_load_dwordx4 v21, s[16:19], s52 offen sc1 lds
MAA 116,112,48
TR 86,25,37760
MAA 116,116,68
TR 88,25,25856
MAA 112,116,64
TR 90,25,26368
MAA 112,112,44
buffer_load_dwordx4 v21, s[16:19], s52 offen offset:1024 sc1 lds
MAA 108,112,40
TR 92,25,38272
MAA 108,116,60
TR 94,25,38784
MAA 140,60,124
TR 96,25,26880
MAA 140,40,120
buffer_load_dword v22, s[16:19], s52 offen offset:2048 sc1 lds
MAA 144,44,120
TR 98,25,27392
s_add_u32 s52, s52, 131072
MAA 144,64,124
buffer_load_dwordx4 v[172:175], v26, s[16:19], s75 offen offset:1024 sc1
MAA 148,68,124
TR 100,25,39296
s_add_u32 s75, s75, 2048
MAA 148,48,120
TR 102,25,39808
MAA 152,52,120
MAA 152,72,124
s_waitcnt vmcnt(21) lgkmcnt(8)
s_barrier
MAA 60,80,0
TR 104,25,24864
s_add_u32 m0, s56, 80000
MAA 60,84,20
buffer_load_dwordx4 v18, s[20:23], s54 offen lds
MAA 64,84,24
TR 106,25,25376
MAA 64,80,4
TR 108,25,37280
MAA 68,80,8
TR 110,25,37792
MAA 68,84,28
buffer_load_dwordx4 v19, s[20:23], s54 offen offset:1024 lds
MAA 72,84,32
TR 112,25,25888
MAA 72,80,12
TR 114,25,26400
s_waitcnt lgkmcnt(6)
MAA 156,88,16
TR 116,25,38304
MAA 156,92,36
buffer_load_dwordx4 v20, s[20:23], s54 offen offset:2048 lds
MAA 104,92,32
TR 118,25,38816
s_add_u32 s54, s54, 196608
MAA 104,88,12
TR 120,25,26912
MAA 100,88,8
s_add_u32 m0, s55, 18432
MAA 100,92,28
.Lpad22:
s_cbranch_execz .Lpad25
buffer_load_dwordx4 v21, s[16:19], s52 offen sc1 lds
MAA 96,92,24
TR 122,25,27424
MAA 96,88,4
TR 124,25,39328
MAA 92,88,0
TR 126,25,39840
MAA 92,92,20
buffer_load_dwordx4 v21, s[16:19], s52 offen offset:1024 sc1 lds
MAA 124,20,100
RD 40,23,36864
MAA 124,0,96
RD 44,23,37888
MAA 128,4,96
RD 48,23,39168
MAA 128,24,100
buffer_load_dword v22, s[16:19], s52 offen offset:2048 sc1 lds
MAA 132,28,100
RD 52,23,40192
s_add_u32 s52, s52, 131072
MAA 132,8,96
RD 56,24,38912
MAA 136,12,96
MAA 136,32,100
s_waitcnt vmcnt(16) lgkmcnt(5)
s_barrier
MAA 76,104,0
RD 60,23,46080
s_add_u32 m0, s56, 92416
MAA 76,108,20
buffer_load_dwordx4 v18, s[20:23], s54 offen lds
MAA 80,108,24
RD 64,23,47104
MAA 80,104,4
RD 68,23,48384
MAA 84,104,8
RD 72,23,49408
MAA 84,108,28
buffer_load_dwordx4 v19, s[20:23], s54 offen offset:1024 lds
MAA 88,108,32
RD 76,24,48128
MAA 88,104,12
TR 80,25,49664
MAA 160,112,16
TR 82,25,50176
MAA 160,116,36
buffer_load_dwordx4 v20, s[20:23], s54 offen offset:2048 lds
MAA 120,116,32
TR 84,25,62080
s_add_u32 s54, s54, 196608
MAA 120,112,12
TR 86,25,62592
MAA 116,112,8
s_add_u32 m0, s55, 27648
MAA 116,116,28
buffer_load_dwordx4 v21, s[16:19], s52 offen sc1 lds
MAA 112,116,24
TR 88,25,50688
MAA 112,112,4
TR 90,25,51200
MAA 108,112,0
TR 92,25,63104
MAA 108,116,20
buffer_load_dwordx4 v21, s[16:19], s52 offen offset:1024 sc1 lds
MAA 140,20,124
TR 94,25,63616
MAA 140,0,120
TR 96,25,51712
MAA 144,4,120
TR 98,25,52224
MAA 144,24,124
buffer_load_dword v22, s[16:19], s52 offen offset:2048 sc1 lds
MAA 148,28,124
TR 100,25,64128
s_add_u32 s52, s52, 131072
MAA 148,8,120
TR 102,25,64640
MAA 152,12,120
MAA 152,32,124
s_waitcnt vmcnt(19) lgkmcnt(8)
s_barrier
MAA 60,80,40
TR 104,25,49696
s_add_u32 m0, s56, 104832
MAA 60,84,60
buffer_load_dwordx4 v18, s[20:23], s54 offen lds
MAA 64,84,64
TR 106,25,50208
v_add_f32 v164, v164, v168
MAA 64,80,44
TR 108,25,62112
MAA 68,80,48
TR 110,25,62624
MAA 68,84,68
buffer_load_dwordx4 v19, s[20:23], s54 offen offset:1024 lds
MAA 72,84,72
TR 112,25,50720
v_add_f32 v165, v165, v169
MAA 72,80,52
TR 114,25,51232
s_waitcnt lgkmcnt(6)
MAA 156,88,56
TR 116,25,63136
MAA 156,92,76
buffer_load_dwordx4 v20, s[20:23], s54 offen offset:2048 lds
MAA 104,92,72
s_add_u32 s54, s54, 196608
s_add_u32 m0, s55, 36864
MAA 104,88,52
buffer_load_dwordx4 v21, s[16:19], s52 offen sc1 lds
MAA 100,88,48
TR 118,25,63648
MAA 100,92,68
TR 120,25,51744
v_add_f32 v166, v166, v170
MAA 96,92,64
TR 122,25,52256
MAA 96,88,44
buffer_load_dwordx4 v21, s[16:19], s52 offen offset:1024 sc1 lds
MAA 92,88,40
TR 124,25,64160
MAA 92,92,60
TR 126,25,64672
v_add_f32 v167, v167, v171
MAA 124,60,100
ds_read_b128 a[0:3], v23
MAA 124,40,96
buffer_load_dword v22, s[16:19], s52 offen offset:2048 sc1 lds
MAA 128,44,96
RD 4,23,1024
s_add_u32 s52, s52, 131072
MAA 128,64,100
buffer_load_dword v27, v14, s[20:23], s44 offen
MAA 132,68,100
RD 8,23,2304
s_add_u32 s44, s44, 1572864
MAA 132,48,96
RD 12,23,3328
MAA 136,52,96
RD 16,24,2048
MAA 136,72,100
s_waitcnt vmcnt(16) lgkmcnt(5)
s_barrier
MAA 76,104,40
RD 20,23,9216
s_add_u32 m0, s56, 117248
MAA 76,108,60
buffer_load_dwordx4 v18, s[20:23], s54 offen lds
MAA 80,108,64
RD 24,23,10240
MAA 80,104,44
RD 28,23,11520
MAA 84,104,48
RD 32,23,12544
MAA 84,108,68
buffer_load_dwordx4 v19, s[20:23], s54 offen offset:1024 lds
MAA 88,108,72
RD 36,24,11264
MAA 88,104,52
buffer_load_dwordx4 v20, s[20:23], s54 offen offset:2048 lds
MAA 160,112,56
ds_read_b64_tr_b16 a[80:81], v25
s_add_u32 s54, s54, 196608
MAA 160,116,76
TR 82,25,512
MAA 120,116,72
TR 84,25,12416
s_add_u32 m0, s55, 46080
MAA 120,112,52
buffer_load_dwordx4 v21, s[16:19], s52 offen sc1 lds
MAA 116,112,48
TR 86,25,12928
MAA 116,116,68
TR 88,25,1024
MAA 112,116,64
TR 90,25,1536
MAA 112,112,44
buffer_load_dwordx4 v21, s[16:19], s52 offen offset:1024 sc1 lds
MAA 108,112,40
TR 92,25,13440
MAA 108,116,60
TR 94,25,13952
MAA 140,60,124
TR 96,25,2048
MAA 140,40,120
buffer_load_dword v22, s[16:19], s52 offen offset:2048 sc1 lds
MAA 144,44,120
TR 98,25,2560
s_add_u32 s52, s52, 131072
MAA 144,64,124
buffer_load_dwordx4 v[168:171], v26, s[16:19], s75 offen sc1
MAA 148,68,124
TR 100,25,14464
MAA 148,48,120
TR 102,25,14976
MAA 152,52,120
MAA 152,72,124
s_waitcnt vmcnt(20) lgkmcnt(8)
s_barrier
MAA 60,80,0
TR 104,25,32
s_add_u32 m0, s56, 129664
MAA 60,84,20
buffer_load_dwordx4 v18, s[20:23], s54 offen lds
MAA 64,84,24
TR 106,25,544
v_add_f32 v164, v164, v172
MAA 64,80,4
TR 108,25,12448
MAA 68,80,8
TR 110,25,12960
MAA 68,84,28
buffer_load_dwordx4 v19, s[20:23], s54 offen offset:1024 lds
MAA 72,84,32
TR 112,25,1056
MAA 72,80,12
TR 114,25,1568
s_waitcnt lgkmcnt(6)
MAA 156,88,16
TR 116,25,13472
v_add_f32 v165, v165, v173
MAA 156,92,36
buffer_load_dwordx4 v20, s[20:23], s54 offen offset:2048 lds
MAA 104,92,32
TR 118,25,13984
s_add_u32 s54, s54, 196608
MAA 104,88,12
TR 120,25,2080
MAA 100,88,8
s_add_u32 m0, s55, 0
MAA 100,92,28
buffer_load_dwordx4 v21, s[16:19], s52 offen sc1 lds
MAA 96,92,24
TR 122,25,2592
v_add_f32 v166, v166, v174
MAA 96,88,4
TR 124,25,14496
MAA 92,88,0
TR 126,25,15008
MAA 92,92,20
buffer_load_dwordx4 v21, s[16:19], s52 offen offset:1024 sc1 lds
MAA 124,20,100
RD 40,23,18432
MAA 124,0,96
RD 44,23,19456
v_add_f32 v167, v167, v175
MAA 128,4,96
RD 48,23,20736
MAA 128,24,100
buffer_load_dword v22, s[16:19], s52 offen offset:2048 sc1 lds
MAA 132,28,100
RD 52,23,21760
s_add_u32 s52, s52, 131072
MAA 132,8,96
RD 56,24,20480
MAA 136,12,96
MAA 136,32,100
s_waitcnt vmcnt(17) lgkmcnt(5)
s_barrier
MAA 76,104,0
RD 60,23,27648
s_add_u32 m0, s56, 67584
MAA 76,108,20
buffer_load_dwordx4 v18, s[20:23], s54 offen lds
MAA 80,108,24
RD 64,23,28672
MAA 80,104,4
RD 68,23,29952
MAA 84,104,8
RD 72,23,30976
MAA 84,108,28
buffer_load_dwordx4 v19, s[20:23], s54 offen offset:1024 lds
MAA 88,108,32
RD 76,24,29696
MAA 88,104,12
buffer_load_dwordx4 v20, s[20:23], s54 offen offset:2048 lds
MAA 160,112,16
TR 80,25,24832
s_add_u32 s54, s54, 196608
MAA 160,116,36
TR 82,25,25344
MAA 120,116,32
TR 84,25,37248
s_add_u32 m0, s55, 9216
MAA 120,112,12
buffer_load_dwordx4 v21, s[16:19], s52 offen sc1 lds
MAA 116,112,8
TR 86,25,37760
MAA 116,116,28
TR 88,25,25856
MAA 112,116,24
TR 90,25,26368
MAA 112,112,4
buffer_load_dwordx4 v21, s[16:19], s52 offen offset:1024 sc1 lds
MAA 108,112,0
TR 92,25,38272
MAA 108,116,20
TR 94,25,38784
MAA 140,20,124
TR 96,25,26880
MAA 140,0,120
buffer_load_dword v22, s[16:19], s52 offen offset:2048 sc1 lds
MAA 144,4,120
TR 98,25,27392
s_add_u32 s52, s52, 131072
MAA 144,24,124
buffer_load_dwordx4 v[172:175], v26, s[16:19], s75 offen offset:1024 sc1
MAA 148,28,124
TR 100,25,39296
s_add_u32 s75, s75, 2048
MAA 148,8,120
TR 102,25,39808
MAA 152,12,120
MAA 152,32,124
s_waitcnt vmcnt(21) lgkmcnt(8)
s_barrier
MAA 60,80,40
TR 104,25,24864
s_add_u32 m0, s56, 80000
MAA 60,84,60
buffer_load_dwordx4 v18, s[20:23], s54 offen lds
MAA 64,84,64
TR 106,25,25376
MAA 64,80,44
TR 108,25,37280
MAA 68,80,48
TR 110,25,37792
MAA 68,84,68
buffer_load_dwordx4 v19, s[20:23], s54 offen offset:1024 lds
MAA 72,84,72
TR 112,25,25888
MAA 72,80,52
TR 114,25,26400
s_waitcnt lgkmcnt(6)
MAA 156,88,56
TR 116,25,38304
MAA 156,92,76
buffer_load_dwordx4 v20, s[20:23], s54 offen offset:2048 lds
MAA 104,92,72
TR 118,25,38816
s_add_u32 s54, s54, 196608
MAA 104,88,52
TR 120,25,26912
MAA 100,88,48
s_add_u32 m0, s55, 18432
MAA 100,92,68
buffer_load_dwordx4 v21, s[16:19], s52 offen sc1 lds
MAA 96,92,64
TR 122,25,27424
MAA 96,88,44
TR 124,25,39328
MAA 92,88,40
TR 126,25,39840
MAA 92,92,60
buffer_load_dwordx4 v21, s[16:19], s52 offen offset:1024 sc1 lds
MAA 124,60,100
RD 0,23,36864
MAA 124,40,96
RD 4,23,37888
MAA 128,44,96
RD 8,23,39168
MAA 128,64,100
buffer_load_dword v22, s[16:19], s52 offen offset:2048 sc1 lds
MAA 132,68,100
RD 12,23,40192
s_add_u32 s52, s52, 131072
MAA 132,48,96
RD 16,24,38912
MAA 136,52,96
MAA 136,72,100
s_waitcnt vmcnt(16) lgkmcnt(5)
s_barrier
MAA 76,104,40
RD 20,23,46080
s_add_u32 m0, s56, 92416
MAA 76,108,60
buffer_load_dwordx4 v18, s[20:23], s54 offen lds
MAA 80,108,64
RD 24,23,47104
MAA 80,104,44
RD 28,23,48384
MAA 84,104,48
RD 32,23,49408
MAA 84,108,68
buffer_load_dwordx4 v19, s[20:23], s54 offen offset:1024 lds
MAA 88,108,72
RD 36,24,48128
MAA 88,104,52
TR 80,25,49664
MAA 160,112,56
TR 82,25,50176
MAA 160,116,76
buffer_load_dwordx4 v20, s[20:23], s54 offen offset:2048 lds
MAA 120,116,72
TR 84,25,62080
s_add_u32 s54, s54, 196608
MAA 120,112,52
TR 86,25,62592
MAA 116,112,48
s_add_u32 m0, s55, 27648
MAA 116,116,68
buffer_load_dwordx4 v21, s[16:19], s52 offen sc1 lds
MAA 112,116,64
TR 88,25,50688
MAA 112,112,44
TR 90,25,51200
MAA 108,112,40
TR 92,25,63104
MAA 108,116,60
buffer_load_dwordx4 v21, s[16:19], s52 offen offset:1024 sc1 lds
MAA 140,60,124
TR 94,25,63616
MAA 140,40,120
TR 96,25,51712
MAA 144,44,120
TR 98,25,52224
MAA 144,64,124
buffer_load_dword v22, s[16:19], s52 offen offset:2048 sc1 lds
MAA 148,68,124
TR 100,25,64128
s_add_u32 s52, s52, 131072
MAA 148,48,120
TR 102,25,64640
MAA 152,52,120
s_add_u32 s15, s15, 1
MAA 152,72,124
s_cbranch_scc0 .Lk57
s_waitcnt vmcnt(19) lgkmcnt(8)
s_barrier
MAA 60,80,0
TR 104,25,49696
s_add_u32 m0, s56, 104832
MAA 60,84,20
buffer_load_dwordx4 v18, s[20:23], s54 offen lds
MAA 64,84,24
TR 106,25,50208
v_add_f32 v164, v164, v168
MAA 64,80,4
TR 108,25,62112
v_add_f32 v165, v165, v169
MAA 68,80,8
TR 110,25,62624
v_add_f32 v166, v166, v170
MAA 68,84,28
buffer_load_dwordx4 v19, s[20:23], s54 offen offset:1024 lds
MAA 72,84,32
TR 112,25,50720
v_add_f32 v167, v167, v171
MAA 72,80,12
TR 114,25,51232
s_waitcnt lgkmcnt(6)
MAA 156,88,16
TR 116,25,63136
MAA 156,92,36
buffer_load_dwordx4 v20, s[20:23], s54 offen offset:2048 lds
MAA 104,92,32
TR 118,25,63648
s_add_u32 s54, s54, 196608
MAA 104,88,12
TR 120,25,51744
s_add_u32 m0, s55, 36864
MAA 100,88,8
TR 122,25,52256
MAA 100,92,28
buffer_load_dwordx4 v21, s[16:19], s52 offen sc1 lds
MAA 96,92,24
TR 124,25,64160
MAA 96,88,4
TR 126,25,64672
MAA 92,88,0
ds_read_b128 a[40:43], v23
MAA 92,92,20
buffer_load_dwordx4 v21, s[16:19], s52 offen offset:1024 sc1 lds
MAA 124,20,100
RD 44,23,1024
MAA 124,0,96
RD 48,23,2304
MAA 128,4,96
RD 52,23,3328
MAA 128,24,100
buffer_load_dword v22, s[16:19], s52 offen offset:2048 sc1 lds
MAA 132,28,100
RD 56,24,2048
s_add_u32 s52, s52, 131072
MAA 132,8,96
MAA 136,12,96
MAA 136,32,100
s_waitcnt vmcnt(15) lgkmcnt(5)
s_barrier
MAA 76,104,0
RD 60,23,9216
s_add_u32 m0, s56, 117248
MAA 76,108,20
buffer_load_dwordx4 v18, s[20:23], s54 offen lds
MAA 80,108,24
RD 64,23,10240
v_add_f32 v164, v164, v172
MAA 80,104,4
RD 68,23,11520
v_add_f32 v165, v165, v173
MAA 84,104,8
RD 72,23,12544
v_add_f32 v166, v166, v174
MAA 84,108,28
buffer_load_dwordx4 v19, s[20:23], s54 offen offset:1024 lds
MAA 88,108,32
RD 76,24,11264
v_add_f32 v167, v167, v175
MAA 88,104,12
ds_read_b64_tr_b16 a[80:81], v25
MAA 160,112,16
TR 82,25,512
MAA 160,116,36
buffer_load_dwordx4 v20, s[20:23], s54 offen offset:2048 lds
MAA 120,116,32
TR 84,25,12416
s_add_u32 s54, s54, 196608
MAA 120,112,12
TR 86,25,12928
s_add_u32 m0, s55, 46080
MAA 116,112,8
TR 88,25,1024
MAA 116,116,28
buffer_load_dwordx4 v21, s[16:19], s52 offen sc1 lds
MAA 112,116,24
TR 90,25,1536
MAA 112,112,4
TR 92,25,13440
MAA 108,112,0
TR 94,25,13952
MAA 108,116,20
buffer_load_dwordx4 v21, s[16:19], s52 offen offset:1024 sc1 lds
.Lpad23:
s_cbranch_execz .Lpad26
MAA 140,20,124
TR 96,25,2048
MAA 140,0,120
TR 98,25,2560
MAA 144,4,120
TR 100,25,14464
MAA 144,24,124
buffer_load_dword v22, s[16:19], s52 offen offset:2048 sc1 lds
MAA 148,28,124
TR 102,25,14976
s_add_u32 s52, s52, 131072
MAA 148,8,120
v_permlane32_swap_b32 v164, v166
MAA 152,12,120
v_permlane32_swap_b32 v165, v167
MAA 152,32,124
s_waitcnt vmcnt(18) lgkmcnt(8)
s_barrier
MAA 60,80,40
TR 104,25,32
s_add_u32 m0, s56, 129664
MAA 60,84,60
buffer_load_dwordx4 v18, s[20:23], s54 offen lds
MAA 64,84,64
TR 106,25,544
v_add_f32 v164, v164, v166
MAA 64,80,44
TR 108,25,12448
v_add_f32 v165, v165, v167
MAA 68,80,48
buffer_load_dwordx4 v19, s[20:23], s54 offen offset:1024 lds
MAA 68,84,68
TR 110,25,12960
v_mul_f32 v164, 0xba800000, v164
MAA 72,84,72
TR 112,25,1056
v_mul_f32 v165, 0x3a800000, v165
MAA 72,80,52
buffer_load_dwordx4 v20, s[20:23], s54 offen offset:2048 lds
s_waitcnt lgkmcnt(5)
MAA 156,88,56
TR 114,25,1568
s_add_u32 s54, s54, 196608
MAA 156,92,76
TR 116,25,13472
s_add_u32 m0, s59, 58240
MAA 104,92,72
TR 118,25,13984
s_xor_b32 s58, s87, 1966080
MAA 104,88,52
buffer_load_dwordx4 v5, s[24:27], s58 offen lds
MAA 100,88,48
TR 120,25,2080
v_fma_f32 v165, -v164, v164, v165
MAA 100,92,68
TR 122,25,2592
v_max_f32 v165, 0, v165
MAA 96,92,64
buffer_load_dwordx4 v6, s[24:27], s58 offen offset:1024 lds
MAA 96,88,44
TR 124,25,14496
s_add_u32 m0, s59, 0
MAA 92,88,40
TR 126,25,15008
s_xor_b32 s58, s87, 1048576
MAA 92,92,60
buffer_load_dwordx4 v5, s[24:27], s58 offen lds
MAA 124,60,100
RD 0,23,18432
v_add_f32 v165, 0x3727c5ac, v165
MAA 124,40,96
RD 4,23,19456
MAA 128,44,96
buffer_load_dwordx4 v6, s[24:27], s58 offen offset:1024 lds
MAA 128,64,100
RD 8,23,20736
MAA 132,68,100
RD 12,23,21760
MAA 132,48,96
RD 16,24,20480
MAA 136,52,96
v_rsq_f32 v166, v165
MAA 136,72,100
v_mov_b32 v165, v166
v_mul_f32 v166, 0x3e8293ee, v166
ds_write_b128 v7, v[164:167]
s_waitcnt vmcnt(16) lgkmcnt(6)
s_barrier
MAA 76,104,40
ds_write_b32 v17, v164
s_add_u32 m0, s59, 8320
MAA 76,108,60
ds_write_b32 v17, v165 offset:1024
s_xor_b32 s58, s87, 1179648
MAA 80,108,64
buffer_load_dwordx4 v5, s[24:27], s58 offen lds
MAA 80,104,44
RD 20,23,27648
MAA 84,104,48
RD 24,23,28672
MAA 84,108,68
RD 28,23,29952
MAA 88,108,72
buffer_load_dwordx4 v6, s[24:27], s58 offen offset:1024 lds
MAA 88,104,52
RD 32,23,30976
s_add_u32 m0, s59, 66560
MAA 160,112,56
RD 36,24,29696
s_xor_b32 s58, s87, 0
MAA 160,116,76
TR 80,25,24832
MAA 120,116,72
buffer_load_dwordx4 v5, s[24:27], s58 offen lds
MAA 120,112,52
TR 82,25,25344
MAA 116,112,48
TR 84,25,37248
MAA 116,116,68
TR 86,25,37760
MAA 112,116,64
buffer_load_dwordx4 v6, s[24:27], s58 offen offset:1024 lds
MAA 112,112,44
TR 88,25,25856
s_add_u32 m0, s59, 74880
MAA 108,112,40
TR 90,25,26368
s_xor_b32 s58, s87, 131072
MAA 108,116,60
TR 92,25,38272
MAA 140,60,124
buffer_load_dwordx4 v5, s[24:27], s58 offen lds
MAA 140,40,120
TR 94,25,38784
MAA 144,44,120
TR 96,25,26880
MAA 144,64,124
TR 98,25,27392
MAA 148,68,124
buffer_load_dwordx4 v6, s[24:27], s58 offen offset:1024 lds
MAA 148,48,120
TR 100,25,39296
MAA 152,52,120
TR 102,25,39808
MAA 152,72,124
s_waitcnt vmcnt(10) lgkmcnt(0)
s_barrier
MAA 156,88,16
TR 112,25,25888
s_add_u32 m0, s59, 83200
MAA 156,92,36
TR 114,25,26400
s_xor_b32 s58, s87, 262144
MAA 104,92,32
buffer_load_dwordx4 v5, s[24:27], s58 offen lds
MAA 104,88,12
TR 116,25,38304
MAA 100,88,8
TR 118,25,38816
MAA 100,92,28
TR 120,25,26912
MAA 96,92,24
buffer_load_dwordx4 v6, s[24:27], s58 offen offset:1024 lds
MAA 96,88,4
TR 122,25,27424
s_add_u32 m0, s59, 16640
MAA 92,88,0
TR 124,25,39328
s_xor_b32 s58, s87, 1310720
MAA 92,92,20
TR 126,25,39840
MAA 136,32,100
buffer_load_dwordx4 v5, s[24:27], s58 offen lds
MAA 136,12,96
TR 104,25,24864
MAA 72,80,12
TR 106,25,25376
MAA 72,84,32
TR 108,25,37280
MAA 68,84,28
buffer_load_dwordx4 v6, s[24:27], s58 offen offset:1024 lds
MAA 68,80,8
TR 110,25,37792
s_add_u32 m0, s59, 24960
MAA 64,80,4
RD 40,23,36864
s_xor_b32 s58, s87, 1441792
MAA 64,84,24
RD 44,23,37888
MAA 60,84,20
buffer_load_dwordx4 v5, s[24:27], s58 offen lds
MAA 60,80,0
RD 48,23,39168
s_waitcnt lgkmcnt(13)
MAA 160,112,16
RD 52,23,40192
s_waitcnt lgkmcnt(12)
MAA 160,116,36
RD 56,24,38912
MAA 120,116,32
buffer_load_dwordx4 v6, s[24:27], s58 offen offset:1024 lds
MAA 120,112,12
s_waitcnt lgkmcnt(5)
s_barrier
RD 60,23,46080
MAA 116,112,8
RD 64,23,47104
s_add_u32 m0, s59, 91520
MAA 116,116,28
RD 68,23,48384
s_xor_b32 s58, s87, 393216
MAA 112,116,24
RD 72,23,49408
MAA 112,112,4
RD 76,24,48128
MAA 108,112,0
TR 144,25,50688
MAA 108,116,20
TR 146,25,51200
MAA 152,32,124
TR 148,25,63104
MAA 152,12,120
TR 150,25,63616
MAA 88,104,12
TR 152,25,50720
MAA 88,108,32
TR 154,25,51232
MAA 84,108,28
TR 156,25,63136
MAA 84,104,8
TR 158,25,63648
MAA 80,104,4
TR 160,25,51712
MAA 80,108,24
TR 162,25,52224
MAA 76,108,20
TR 164,25,64128
MAA 76,104,0
TR 166,25,64640
s_waitcnt lgkmcnt(10)
MAA 156,144,56
TR 168,25,51744
s_waitcnt lgkmcnt(9)
MAA 156,148,76
TR 170,25,52256
MAA 104,148,72
TR 172,25,64160
MAA 104,144,52
TR 174,25,64672
MAA 100,144,48
TR 128,25,49664
MAA 100,148,68
TR 130,25,50176
MAA 96,148,64
TR 132,25,62080
MAA 96,144,44
TR 134,25,62592
MAA 92,144,40
TR 136,25,49696
MAA 92,148,60
TR 138,25,50208
s_waitcnt lgkmcnt(14)
MAA 160,156,76
TR 140,25,62112
MAA 160,152,56
TR 142,25,62624
MAA 120,152,52
ds_read_b128 v[232:235], v10 offset:768
MAA 120,156,72
ds_read_b128 v[236:239], v10 offset:2816
MAA 116,156,68
ds_read_b128 v[228:231], v10 offset:512
MAA 116,152,48
ds_read_b128 v[224:227], v10 offset:256
MAA 112,152,44
ds_read_b128 v[220:223], v10
MAA 112,156,64
buffer_load_dwordx4 v5, s[24:27], s58 offen lds
MAA 108,156,60
ds_read_b128 v[240:243], v11 offset:192
MAA 108,152,40
ds_read_b128 v[244:247], v11 offset:1216
s_waitcnt lgkmcnt(15)
MAA 136,52,160
ds_read_b128 v[18:21], v11 offset:128
MAA 136,72,164
buffer_load_dwordx4 v6, s[24:27], s58 offen offset:1024 lds
MAA 152,72,172
ds_read_b128 v[22:25], v11 offset:1152
s_add_u32 m0, s59, 99840
MAA 152,52,168
s_xor_b32 s58, s87, 524288
s_waitcnt lgkmcnt(15)
MAA 72,128,52
s_waitcnt lgkmcnt(13)
MAA 72,132,72
buffer_load_dwordx4 v5, s[24:27], s58 offen lds
MAA 68,132,68
MAA 68,128,48
MAA 64,128,44
MAA 64,132,64
buffer_load_dwordx4 v6, s[24:27], s58 offen offset:1024 lds
MAA 60,132,60
s_add_u32 m0, s59, 108160
s_xor_b32 s58, s87, 655360
MAA 60,128,40
s_waitcnt lgkmcnt(11)
MAA 88,136,52
s_waitcnt lgkmcnt(9)
MAA 88,140,72
buffer_load_dwordx4 v5, s[24:27], s58 offen lds
MAA 84,140,68
MAA 84,136,48
MAA 80,136,44
MAA 80,140,64
buffer_load_dwordx4 v6, s[24:27], s58 offen offset:1024 lds
MAA 76,140,60
MAA 76,136,40
s_waitcnt lgkmcnt(8)
v_pk_fma_f32 v[104:105], v[36:37], v[232:233], v[104:105] op_sel_hi:[1,0,1]
v_pk_mul_f32 v[104:105], v[104:105], v[232:233] op_sel:[0,1] op_sel_hi:[1,1]
v_cvt_pk_bf16_f32 v196, v104, v105
v_pk_fma_f32 v[106:107], v[38:39], v[232:233], v[106:107] op_sel_hi:[1,0,1]
v_pk_mul_f32 v[106:107], v[106:107], v[232:233] op_sel:[0,1] op_sel_hi:[1,1]
v_cvt_pk_bf16_f32 v197, v106, v107
v_pk_fma_f32 v[120:121], v[40:41], v[232:233], v[120:121] op_sel_hi:[1,0,1]
v_pk_mul_f32 v[120:121], v[120:121], v[232:233] op_sel:[0,1] op_sel_hi:[1,1]
v_cvt_pk_bf16_f32 v198, v120, v121
v_pk_fma_f32 v[122:123], v[42:43], v[232:233], v[122:123] op_sel_hi:[1,0,1]
v_pk_mul_f32 v[122:123], v[122:123], v[232:233] op_sel:[0,1] op_sel_hi:[1,1]
v_cvt_pk_bf16_f32 v199, v122, v123
s_waitcnt lgkmcnt(3)
v_pk_fma_f32 v[136:137], v[240:241], v[44:45], v[136:137] op_sel_hi:[1,0,1]
s_waitcnt lgkmcnt(2)
v_pk_mul_f32 v[136:137], v[136:137], v[244:245]
v_cvt_pk_bf16_f32 v208, v136, v137
v_pk_fma_f32 v[138:139], v[242:243], v[44:45], v[138:139] op_sel_hi:[1,0,1]
v_pk_mul_f32 v[138:139], v[138:139], v[246:247]
v_cvt_pk_bf16_f32 v209, v138, v139
v_pk_fma_f32 v[152:153], v[240:241], v[44:45], v[152:153] op_sel:[0,1,0] op_sel_hi:[1,1,1]
v_pk_mul_f32 v[152:153], v[152:153], v[244:245]
v_cvt_pk_bf16_f32 v218, v152, v153
v_pk_fma_f32 v[154:155], v[242:243], v[44:45], v[154:155] op_sel:[0,1,0] op_sel_hi:[1,1,1]
v_pk_mul_f32 v[154:155], v[154:155], v[246:247]
v_cvt_pk_bf16_f32 v219, v154, v155
ds_write_b128 v8, v[196:199]
ds_write_b64 v8, v[208:209] offset:1024
ds_write_b64 v8, v[218:219] offset:1032
v_pk_fma_f32 v[156:157], v[36:37], v[236:237], v[156:157] op_sel_hi:[1,0,1]
v_pk_mul_f32 v[156:157], v[156:157], v[236:237] op_sel:[0,1] op_sel_hi:[1,1]
v_cvt_pk_bf16_f32 v180, v156, v157
v_pk_fma_f32 v[158:159], v[38:39], v[236:237], v[158:159] op_sel_hi:[1,0,1]
v_pk_mul_f32 v[158:159], v[158:159], v[236:237] op_sel:[0,1] op_sel_hi:[1,1]
v_cvt_pk_bf16_f32 v181, v158, v159
v_pk_fma_f32 v[160:161], v[40:41], v[236:237], v[160:161] op_sel_hi:[1,0,1]
v_pk_mul_f32 v[160:161], v[160:161], v[236:237] op_sel:[0,1] op_sel_hi:[1,1]
v_cvt_pk_bf16_f32 v182, v160, v161
v_pk_fma_f32 v[162:163], v[42:43], v[236:237], v[162:163] op_sel_hi:[1,0,1]
v_pk_mul_f32 v[162:163], v[162:163], v[236:237] op_sel:[0,1] op_sel_hi:[1,1]
v_cvt_pk_bf16_f32 v183, v162, v163
v_pk_fma_f32 v[100:101], v[36:37], v[228:229], v[100:101] op_sel_hi:[1,0,1]
v_pk_mul_f32 v[100:101], v[100:101], v[228:229] op_sel:[0,1] op_sel_hi:[1,1]
v_cvt_pk_bf16_f32 v192, v100, v101
v_pk_fma_f32 v[102:103], v[38:39], v[228:229], v[102:103] op_sel_hi:[1,0,1]
v_pk_mul_f32 v[102:103], v[102:103], v[228:229] op_sel:[0,1] op_sel_hi:[1,1]
v_cvt_pk_bf16_f32 v193, v102, v103
v_pk_fma_f32 v[116:117], v[40:41], v[228:229], v[116:117] op_sel_hi:[1,0,1]
v_pk_mul_f32 v[116:117], v[116:117], v[228:229] op_sel:[0,1] op_sel_hi:[1,1]
v_cvt_pk_bf16_f32 v194, v116, v117
v_pk_fma_f32 v[118:119], v[42:43], v[228:229], v[118:119] op_sel_hi:[1,0,1]
v_pk_mul_f32 v[118:119], v[118:119], v[228:229] op_sel:[0,1] op_sel_hi:[1,1]
s_waitcnt lgkmcnt(0)
s_barrier
v_cvt_pk_bf16_f32 v195, v118, v119
v_pk_fma_f32 v[96:97], v[36:37], v[224:225], v[96:97] op_sel_hi:[1,0,1]
v_pk_mul_f32 v[96:97], v[96:97], v[224:225] op_sel:[0,1] op_sel_hi:[1,1]
v_cvt_pk_bf16_f32 v188, v96, v97
v_pk_fma_f32 v[98:99], v[38:39], v[224:225], v[98:99] op_sel_hi:[1,0,1]
v_pk_mul_f32 v[98:99], v[98:99], v[224:225] op_sel:[0,1] op_sel_hi:[1,1]
v_cvt_pk_bf16_f32 v189, v98, v99
v_pk_fma_f32 v[112:113], v[40:41], v[224:225], v[112:113] op_sel_hi:[1,0,1]
v_pk_mul_f32 v[112:113], v[112:113], v[224:225] op_sel:[0,1] op_sel_hi:[1,1]
v_cvt_pk_bf16_f32 v190, v112, v113
v_pk_fma_f32 v[114:115], v[42:43], v[224:225], v[114:115] op_sel_hi:[1,0,1]
v_pk_mul_f32 v[114:115], v[114:115], v[224:225] op_sel:[0,1] op_sel_hi:[1,1]
v_cvt_pk_bf16_f32 v191, v114, v115
v_pk_fma_f32 v[92:93], v[36:37], v[220:221], v[92:93] op_sel_hi:[1,0,1]
v_pk_mul_f32 v[92:93], v[92:93], v[220:221] op_sel:[0,1] op_sel_hi:[1,1]
v_cvt_pk_bf16_f32 v184, v92, v93
v_pk_fma_f32 v[94:95], v[38:39], v[220:221], v[94:95] op_sel_hi:[1,0,1]
v_pk_mul_f32 v[94:95], v[94:95], v[220:221] op_sel:[0,1] op_sel_hi:[1,1]
v_cvt_pk_bf16_f32 v185, v94, v95
v_pk_fma_f32 v[108:109], v[40:41], v[220:221], v[108:109] op_sel_hi:[1,0,1]
v_pk_mul_f32 v[108:109], v[108:109], v[220:221] op_sel:[0,1] op_sel_hi:[1,1]
v_cvt_pk_bf16_f32 v186, v108, v109
v_pk_fma_f32 v[110:111], v[42:43], v[220:221], v[110:111] op_sel_hi:[1,0,1]
v_pk_mul_f32 v[110:111], v[110:111], v[220:221] op_sel:[0,1] op_sel_hi:[1,1]
v_cvt_pk_bf16_f32 v187, v110, v111
v_pk_fma_f32 v[72:73], v[28:29], v[232:233], v[72:73] op_sel_hi:[1,0,1]
v_cvt_pk_bf16_f32 v176, v72, v73
v_pk_fma_f32 v[74:75], v[30:31], v[232:233], v[74:75] op_sel_hi:[1,0,1]
v_cvt_pk_bf16_f32 v177, v74, v75
v_pk_fma_f32 v[88:89], v[32:33], v[232:233], v[88:89] op_sel_hi:[1,0,1]
v_cvt_pk_bf16_f32 v178, v88, v89
v_pk_fma_f32 v[90:91], v[34:35], v[232:233], v[90:91] op_sel_hi:[1,0,1]
v_cvt_pk_bf16_f32 v179, v90, v91
v_pk_fma_f32 v[68:69], v[28:29], v[228:229], v[68:69] op_sel_hi:[1,0,1]
v_cvt_pk_bf16_f32 v172, v68, v69
v_pk_fma_f32 v[70:71], v[30:31], v[228:229], v[70:71] op_sel_hi:[1,0,1]
v_cvt_pk_bf16_f32 v173, v70, v71
v_pk_fma_f32 v[84:85], v[32:33], v[228:229], v[84:85] op_sel_hi:[1,0,1]
v_cvt_pk_bf16_f32 v174, v84, v85
v_pk_fma_f32 v[86:87], v[34:35], v[228:229], v[86:87] op_sel_hi:[1,0,1]
v_cvt_pk_bf16_f32 v175, v86, v87
v_pk_fma_f32 v[64:65], v[28:29], v[224:225], v[64:65] op_sel_hi:[1,0,1]
v_cvt_pk_bf16_f32 v168, v64, v65
v_pk_fma_f32 v[66:67], v[30:31], v[224:225], v[66:67] op_sel_hi:[1,0,1]
v_cvt_pk_bf16_f32 v169, v66, v67
v_pk_fma_f32 v[80:81], v[32:33], v[224:225], v[80:81] op_sel_hi:[1,0,1]
v_cvt_pk_bf16_f32 v170, v80, v81
v_pk_fma_f32 v[82:83], v[34:35], v[224:225], v[82:83] op_sel_hi:[1,0,1]
v_cvt_pk_bf16_f32 v171, v82, v83
v_pk_fma_f32 v[60:61], v[28:29], v[220:221], v[60:61] op_sel_hi:[1,0,1]
v_cvt_pk_bf16_f32 v164, v60, v61
v_pk_fma_f32 v[62:63], v[30:31], v[220:221], v[62:63] op_sel_hi:[1,0,1]
v_cvt_pk_bf16_f32 v165, v62, v63
v_pk_fma_f32 v[76:77], v[32:33], v[220:221], v[76:77] op_sel_hi:[1,0,1]
v_cvt_pk_bf16_f32 v166, v76, v77
v_pk_fma_f32 v[78:79], v[34:35], v[220:221], v[78:79] op_sel_hi:[1,0,1]
v_cvt_pk_bf16_f32 v167, v78, v79
s_nop 0
v_mfma_f32_16x16x32_bf16 v[120:123], v[196:199], v[176:179], v[50:53]
ds_read_b64 v[200:201], v9 offset:1024
v_mfma_f32_16x16x32_bf16 v[104:107], v[192:195], v[176:179], v[46:49]
ds_read_b64 v[210:211], v9 offset:1032
v_mfma_f32_16x16x32_bf16 v[116:119], v[192:195], v[172:175], v[50:53]
ds_read_b128 v[240:243], v11 offset:64
v_mfma_f32_16x16x32_bf16 v[100:103], v[188:191], v[172:175], v[46:49]
ds_read_b128 v[244:247], v11 offset:1088
v_mfma_f32_16x16x32_bf16 v[112:115], v[188:191], v[168:171], v[50:53]
ds_read_b128 v[28:31], v11
v_mfma_f32_16x16x32_bf16 v[96:99], v[184:187], v[168:171], v[46:49]
ds_read_b128 v[32:35], v11 offset:1024
v_max3_f32 v88, v104, v105, v106
v_mfma_f32_16x16x32_bf16 v[108:111], v[184:187], v[164:167], v[50:53]
v_max3_f32 v89, v107, v120, v121
v_max3_f32 v88, v88, v122, v123
v_mfma_f32_16x16x32_bf16 v[92:95], v[180:183], v[164:167], v[54:57]
v_max_f32 v90, v88, v89
v_max_f32 v89, v88, v89
MAA 132,8,96
s_nop 0
v_permlane16_swap_b32 v90, v89
MAA 132,28,100
v_max_f32 v88, v90, v89
v_max_f32 v89, v90, v89
MAA 132,48,160
s_nop 0
v_permlane32_swap_b32 v88, v89
MAA 132,68,164
v_max_f32 v88, v88, v89
v_mul_f32 v88, v88, v234
MAA 148,68,172
v_max3_f32 v84, v100, v101, v102
v_max3_f32 v85, v103, v116, v117
MAA 148,48,168
v_max3_f32 v84, v84, v118, v119
v_max_f32 v86, v84, v85
MAA 148,28,124
v_max_f32 v85, v84, v85
v_max3_f32 v80, v96, v97, v98
MAA 148,8,120
v_permlane16_swap_b32 v86, v85
v_max3_f32 v81, v99, v112, v113
v_max_f32 v84, v86, v85
v_max_f32 v85, v86, v85
v_max3_f32 v80, v80, v114, v115
v_max_f32 v82, v80, v81
v_permlane32_swap_b32 v84, v85
v_max_f32 v81, v80, v81
v_max_f32 v84, v84, v85
v_mul_f32 v84, v84, v230
v_permlane16_swap_b32 v82, v81
v_max3_f32 v76, v92, v93, v94
v_max_f32 v80, v82, v81
v_max_f32 v81, v82, v81
v_max3_f32 v77, v95, v108, v109
v_max3_f32 v76, v76, v110, v111
v_permlane32_swap_b32 v80, v81
v_max_f32 v78, v76, v77
v_max_f32 v80, v80, v81
v_mul_f32 v80, v80, v226
v_max_f32 v77, v76, v77
v_pk_fma_f32 v[104:105], v[104:105], v[234:235], v[88:89] op_sel_hi:[1,0,0] neg_lo:[0,0,1] neg_hi:[0,0,1]
v_pk_fma_f32 v[106:107], v[106:107], v[234:235], v[88:89] op_sel_hi:[1,0,0] neg_lo:[0,0,1] neg_hi:[0,0,1]
v_permlane16_swap_b32 v78, v77
v_pk_fma_f32 v[120:121], v[120:121], v[234:235], v[88:89] op_sel_hi:[1,0,0] neg_lo:[0,0,1] neg_hi:[0,0,1]
v_max_f32 v76, v78, v77
v_max_f32 v77, v78, v77
v_pk_fma_f32 v[122:123], v[122:123], v[234:235], v[88:89] op_sel_hi:[1,0,0] neg_lo:[0,0,1] neg_hi:[0,0,1]
v_pk_fma_f32 v[100:101], v[100:101], v[230:231], v[84:85] op_sel_hi:[1,0,0] neg_lo:[0,0,1] neg_hi:[0,0,1]
v_permlane32_swap_b32 v76, v77
v_pk_fma_f32 v[102:103], v[102:103], v[230:231], v[84:85] op_sel_hi:[1,0,0] neg_lo:[0,0,1] neg_hi:[0,0,1]
v_max_f32 v76, v76, v77
v_mul_f32 v76, v76, v222
v_pk_fma_f32 v[116:117], v[116:117], v[230:231], v[84:85] op_sel_hi:[1,0,0] neg_lo:[0,0,1] neg_hi:[0,0,1]
v_pk_fma_f32 v[118:119], v[118:119], v[230:231], v[84:85] op_sel_hi:[1,0,0] neg_lo:[0,0,1] neg_hi:[0,0,1]
v_pk_fma_f32 v[96:97], v[96:97], v[226:227], v[80:81] op_sel_hi:[1,0,0] neg_lo:[0,0,1] neg_hi:[0,0,1]
v_pk_fma_f32 v[98:99], v[98:99], v[226:227], v[80:81] op_sel_hi:[1,0,0] neg_lo:[0,0,1] neg_hi:[0,0,1]
v_pk_fma_f32 v[112:113], v[112:113], v[226:227], v[80:81] op_sel_hi:[1,0,0] neg_lo:[0,0,1] neg_hi:[0,0,1]
v_pk_fma_f32 v[114:115], v[114:115], v[226:227], v[80:81] op_sel_hi:[1,0,0] neg_lo:[0,0,1] neg_hi:[0,0,1]
v_pk_fma_f32 v[92:93], v[92:93], v[222:223], v[76:77] op_sel_hi:[1,0,0] neg_lo:[0,0,1] neg_hi:[0,0,1]
v_pk_fma_f32 v[94:95], v[94:95], v[222:223], v[76:77] op_sel_hi:[1,0,0] neg_lo:[0,0,1] neg_hi:[0,0,1]
v_pk_fma_f32 v[108:109], v[108:109], v[222:223], v[76:77] op_sel_hi:[1,0,0] neg_lo:[0,0,1] neg_hi:[0,0,1]
v_pk_fma_f32 v[110:111], v[110:111], v[222:223], v[76:77] op_sel_hi:[1,0,0] neg_lo:[0,0,1] neg_hi:[0,0,1]
v_pk_fma_f32 v[132:133], v[18:19], v[44:45], v[132:133] op_sel_hi:[1,0,1]
v_pk_mul_f32 v[132:133], v[132:133], v[22:23]
v_pk_fma_f32 v[134:135], v[20:21], v[44:45], v[134:135] op_sel_hi:[1,0,1]
v_pk_mul_f32 v[134:135], v[134:135], v[24:25]
v_pk_fma_f32 v[148:149], v[18:19], v[44:45], v[148:149] op_sel:[0,1,0] op_sel_hi:[1,1,1]
v_pk_mul_f32 v[148:149], v[148:149], v[22:23]
v_pk_fma_f32 v[150:151], v[20:21], v[44:45], v[150:151] op_sel:[0,1,0] op_sel_hi:[1,1,1]
v_pk_mul_f32 v[150:151], v[150:151], v[24:25]
v_exp_f32 v104, v104
s_nop 0
MAA 128,4,96
v_exp_f32 v105, v105
MAA 128,24,100
v_exp_f32 v106, v106
MAA 128,44,160
v_exp_f32 v107, v107
MAA 128,64,164
v_exp_f32 v120, v120
MAA 144,64,172
v_exp_f32 v121, v121
MAA 144,44,168
v_exp_f32 v122, v122
MAA 144,24,124
v_exp_f32 v123, v123
MAA 144,4,120
v_exp_f32 v100, v100
MAA 124,0,96
v_exp_f32 v101, v101
MAA 124,20,100
v_exp_f32 v102, v102
MAA 124,40,160
v_exp_f32 v103, v103
MAA 124,60,164
v_exp_f32 v116, v116
MAA 140,60,172
v_exp_f32 v117, v117
MAA 140,40,168
v_exp_f32 v118, v118
MAA 140,20,124
.Lpad24:
s_cbranch_execz .Lpad27
v_exp_f32 v119, v119
MAA 140,0,120
v_cvt_pk_bf16_f32 v72, v104, v105
v_cvt_pk_bf16_f32 v73, v106, v107
v_cvt_pk_bf16_f32 v74, v120, v121
v_cvt_pk_bf16_f32 v75, v122, v123
v_cvt_pk_bf16_f32 v68, v100, v101
v_cvt_pk_bf16_f32 v69, v102, v103
v_cvt_pk_bf16_f32 v70, v116, v117
v_cvt_pk_bf16_f32 v71, v118, v119
v_exp_f32 v96, v96
v_exp_f32 v97, v97
v_exp_f32 v98, v98
v_exp_f32 v99, v99
v_exp_f32 v112, v112
v_exp_f32 v113, v113
v_exp_f32 v114, v114
v_exp_f32 v115, v115
v_cvt_pk_bf16_f32 v64, v96, v97
v_cvt_pk_bf16_f32 v65, v98, v99
v_cvt_pk_bf16_f32 v66, v112, v113
v_cvt_pk_bf16_f32 v67, v114, v115
v_cvt_pk_bf16_f32 v206, v132, v133
v_cvt_pk_bf16_f32 v207, v134, v135
v_cvt_pk_bf16_f32 v216, v148, v149
v_cvt_pk_bf16_f32 v217, v150, v151
s_waitcnt lgkmcnt(3)
v_pk_fma_f32 v[128:129], v[240:241], v[44:45], v[128:129] op_sel_hi:[1,0,1]
s_waitcnt lgkmcnt(2)
v_pk_mul_f32 v[128:129], v[128:129], v[244:245]
v_cvt_pk_bf16_f32 v204, v128, v129
v_pk_fma_f32 v[130:131], v[242:243], v[44:45], v[130:131] op_sel_hi:[1,0,1]
v_pk_mul_f32 v[130:131], v[130:131], v[246:247]
v_cvt_pk_bf16_f32 v205, v130, v131
v_pk_fma_f32 v[144:145], v[240:241], v[44:45], v[144:145] op_sel:[0,1,0] op_sel_hi:[1,1,1]
v_pk_mul_f32 v[144:145], v[144:145], v[244:245]
v_cvt_pk_bf16_f32 v214, v144, v145
v_pk_fma_f32 v[146:147], v[242:243], v[44:45], v[146:147] op_sel:[0,1,0] op_sel_hi:[1,1,1]
v_pk_mul_f32 v[146:147], v[146:147], v[246:247]
v_cvt_pk_bf16_f32 v215, v146, v147
s_waitcnt lgkmcnt(1)
v_pk_fma_f32 v[124:125], v[28:29], v[44:45], v[124:125] op_sel_hi:[1,0,1]
s_waitcnt lgkmcnt(0)
v_pk_mul_f32 v[124:125], v[124:125], v[32:33]
v_cvt_pk_bf16_f32 v202, v124, v125
v_pk_fma_f32 v[126:127], v[30:31], v[44:45], v[126:127] op_sel_hi:[1,0,1]
v_pk_mul_f32 v[126:127], v[126:127], v[34:35]
v_cvt_pk_bf16_f32 v203, v126, v127
v_pk_fma_f32 v[140:141], v[28:29], v[44:45], v[140:141] op_sel:[0,1,0] op_sel_hi:[1,1,1]
v_pk_mul_f32 v[140:141], v[140:141], v[32:33]
v_cvt_pk_bf16_f32 v212, v140, v141
v_pk_fma_f32 v[142:143], v[30:31], v[44:45], v[142:143] op_sel:[0,1,0] op_sel_hi:[1,1,1]
v_pk_mul_f32 v[142:143], v[142:143], v[34:35]
v_cvt_pk_bf16_f32 v213, v142, v143
s_nop 0
v_mfma_f32_16x16x32_bf16 v[88:91], v[248:251], v[72:75], 0
v_exp_f32 v92, v92
v_mfma_f32_16x16x32_bf16 v[104:107], v[206:209], v[72:75], 0
v_exp_f32 v93, v93
v_mfma_f32_16x16x32_bf16 v[120:123], v[216:219], v[72:75], 0
v_exp_f32 v94, v94
v_mfma_f32_16x16x32_bf16 v[84:87], v[248:251], v[68:71], 0
v_exp_f32 v95, v95
v_mfma_f32_16x16x32_bf16 v[100:103], v[204:207], v[68:71], 0
v_exp_f32 v108, v108
v_mfma_f32_16x16x32_bf16 v[116:119], v[214:217], v[68:71], 0
v_exp_f32 v109, v109
v_mfma_f32_16x16x32_bf16 v[80:83], v[248:251], v[64:67], 0
v_exp_f32 v110, v110
v_mfma_f32_16x16x32_bf16 v[96:99], v[202:205], v[64:67], 0
v_exp_f32 v111, v111
v_mfma_f32_16x16x32_bf16 v[112:115], v[212:215], v[64:67], 0
v_cvt_pk_bf16_f32 v60, v92, v93
v_cvt_pk_bf16_f32 v61, v94, v95
v_cvt_pk_bf16_f32 v62, v108, v109
v_cvt_pk_bf16_f32 v63, v110, v111
v_rcp_f32 v88, v88
v_rcp_f32 v84, v84
v_mfma_f32_16x16x32_bf16 v[76:79], v[248:251], v[60:63], 0
v_rcp_f32 v80, v80
v_mfma_f32_16x16x32_bf16 v[92:95], v[200:203], v[60:63], 0
v_mfma_f32_16x16x32_bf16 v[108:111], v[210:213], v[60:63], 0
s_nop 4
v_rcp_f32 v76, v76
v_pk_mul_f32 v[104:105], v[104:105], v[88:89] op_sel_hi:[1,0]
v_pk_mul_f32 v[106:107], v[106:107], v[88:89] op_sel_hi:[1,0]
v_pk_mul_f32 v[120:121], v[120:121], v[88:89] op_sel_hi:[1,0]
v_pk_mul_f32 v[122:123], v[122:123], v[88:89] op_sel_hi:[1,0]
v_cvt_pk_bf16_f32 v176, v104, v105
v_cvt_pk_bf16_f32 v177, v106, v107
v_cvt_pk_bf16_f32 v178, v120, v121
v_cvt_pk_bf16_f32 v179, v122, v123
buffer_store_dwordx4 v[176:179], v4, s[16:19], s74 offen offset:3072 sc1
v_pk_mul_f32 v[100:101], v[100:101], v[84:85] op_sel_hi:[1,0]
v_pk_mul_f32 v[102:103], v[102:103], v[84:85] op_sel_hi:[1,0]
v_pk_mul_f32 v[116:117], v[116:117], v[84:85] op_sel_hi:[1,0]
v_pk_mul_f32 v[118:119], v[118:119], v[84:85] op_sel_hi:[1,0]
v_cvt_pk_bf16_f32 v172, v100, v101
v_cvt_pk_bf16_f32 v173, v102, v103
v_cvt_pk_bf16_f32 v174, v116, v117
v_cvt_pk_bf16_f32 v175, v118, v119
buffer_store_dwordx4 v[172:175], v4, s[16:19], s74 offen offset:2048 sc1
v_pk_mul_f32 v[96:97], v[96:97], v[80:81] op_sel_hi:[1,0]
v_pk_mul_f32 v[98:99], v[98:99], v[80:81] op_sel_hi:[1,0]
v_pk_mul_f32 v[112:113], v[112:113], v[80:81] op_sel_hi:[1,0]
v_pk_mul_f32 v[114:115], v[114:115], v[80:81] op_sel_hi:[1,0]
v_cvt_pk_bf16_f32 v168, v96, v97
v_cvt_pk_bf16_f32 v169, v98, v99
v_cvt_pk_bf16_f32 v170, v112, v113
v_cvt_pk_bf16_f32 v171, v114, v115
buffer_store_dwordx4 v[168:171], v4, s[16:19], s74 offen offset:1024 sc1
v_pk_mul_f32 v[92:93], v[92:93], v[76:77] op_sel_hi:[1,0]
v_pk_mul_f32 v[94:95], v[94:95], v[76:77] op_sel_hi:[1,0]
v_pk_mul_f32 v[108:109], v[108:109], v[76:77] op_sel_hi:[1,0]
v_pk_mul_f32 v[110:111], v[110:111], v[76:77] op_sel_hi:[1,0]
v_cvt_pk_bf16_f32 v164, v92, v93
v_cvt_pk_bf16_f32 v165, v94, v95
v_cvt_pk_bf16_f32 v166, v108, v109
v_cvt_pk_bf16_f32 v167, v110, v111
buffer_store_dwordx4 v[164:167], v4, s[16:19], s74 offen sc1
s_nop 1
s_branch .Lqkve56
.Lsp50:
s_mov_b32 s15, 0
.Lsp50l:
v_mov_b32 v25, 0
buffer_atomic_add v25, v22, s[16:19], s73 offen sc0
s_add_u32 s15, s15, 1
s_cmp_gt_u32 s15, 100000
s_waitcnt vmcnt(0)
s_cbranch_scc1 .Lsp50b
v_cmp_gt_u32 vcc, v23, v25
s_nop 0
s_cbranch_vccnz .Lsp50l
s_branch .Lsp50b
.p2align 12
.Lqkv55:
.Lpad25:
s_cbranch_execz .Lpad28
s_add_u32 m0, s55, 36864
s_nop 0
buffer_load_dwordx4 v21, s[16:19], s52 offen sc1 lds
buffer_load_dwordx4 v21, s[16:19], s52 offen offset:1024 sc1 lds
buffer_load_dword v22, s[16:19], s52 offen offset:2048 sc1 lds
s_add_u32 s52, s52, 131072
TR 80,25,49664
TR 82,25,50176
TR 84,25,62080
s_add_u32 m0, s55, 46080
s_nop 0
buffer_load_dwordx4 v21, s[16:19], s52 offen sc1 lds
buffer_load_dwordx4 v21, s[16:19], s52 offen offset:1024 sc1 lds
buffer_load_dword v22, s[16:19], s52 offen offset:2048 sc1 lds
s_add_u32 s52, s52, 131072
TR 86,25,62592
TR 88,25,50688
TR 90,25,51200
s_add_u32 m0, s55, 0
s_nop 0
buffer_load_dwordx4 v21, s[16:19], s52 offen sc1 lds
buffer_load_dwordx4 v21, s[16:19], s52 offen offset:1024 sc1 lds
buffer_load_dword v22, s[16:19], s52 offen offset:2048 sc1 lds
s_add_u32 s52, s52, 131072
TR 92,25,63104
TR 94,25,63616
TR 96,25,51712
s_add_u32 m0, s55, 9216
s_nop 0
buffer_load_dwordx4 v21, s[16:19], s52 offen sc1 lds
buffer_load_dwordx4 v21, s[16:19], s52 offen offset:1024 sc1 lds
buffer_load_dword v22, s[16:19], s52 offen offset:2048 sc1 lds
s_add_u32 s52, s52, 131072
TR 98,25,52224
TR 100,25,64128
TR 102,25,64640
s_add_u32 m0, s55, 18432
s_nop 0
buffer_load_dwordx4 v21, s[16:19], s52 offen sc1 lds
buffer_load_dwordx4 v21, s[16:19], s52 offen offset:1024 sc1 lds
buffer_load_dword v22, s[16:19], s52 offen offset:2048 sc1 lds
s_add_u32 s52, s52, 131072
ds_read_b128 v[28:31], v13
ds_read_b128 v[32:35], v13 offset:64
ds_read_b128 v[36:39], v13 offset:256
s_add_u32 m0, s55, 27648
s_nop 0
buffer_load_dwordx4 v21, s[16:19], s52 offen sc1 lds
buffer_load_dwordx4 v21, s[16:19], s52 offen offset:1024 sc1 lds
buffer_load_dword v22, s[16:19], s52 offen offset:2048 sc1 lds
s_add_u32 s52, s52, 131072
ds_read_b128 v[40:43], v13 offset:320
ds_read_b32 v44, v12 offset:512
ds_read_b32 v45, v12 offset:576
s_waitcnt vmcnt(12)
s_barrier
RD 0,23,36864
RD 4,23,37888
RD 8,23,39168
RD 12,23,40192
RD 16,24,38912
RD 20,23,46080
RD 24,23,47104
RD 28,23,48384
RD 32,23,49408
RD 36,24,48128
s_waitcnt lgkmcnt(0)
s_mov_b32 s15, -2
.p2align 6
.Lk58:
s_waitcnt vmcnt(9) lgkmcnt(8)
s_barrier
MAA 60,80,0
TR 104,25,49696
s_add_u32 m0, s56, 104832
MAA 60,84,20
buffer_load_dwordx4 v18, s[20:23], s54 offen lds
MAA 64,84,24
TR 106,25,50208
v_add_f32 v164, v164, v168
MAA 64,80,4
TR 108,25,62112
MAA 68,80,8
TR 110,25,62624
MAA 68,84,28
buffer_load_dwordx4 v19, s[20:23], s54 offen offset:1024 lds
MAA 72,84,32
TR 112,25,50720
v_add_f32 v165, v165, v169
MAA 72,80,12
TR 114,25,51232
s_waitcnt lgkmcnt(6)
MAA 104,88,12
TR 116,25,63136
MAA 104,92,32
buffer_load_dwordx4 v20, s[20:23], s54 offen offset:2048 lds
MAA 100,92,28
s_add_u32 s54, s54, 196608
s_add_u32 m0, s55, 36864
MAA 100,88,8
buffer_load_dwordx4 v21, s[16:19], s52 offen sc1 lds
MAA 96,88,4
TR 118,25,63648
MAA 96,92,24
TR 120,25,51744
v_add_f32 v166, v166, v170
MAA 92,92,20
TR 122,25,52256
MAA 92,88,0
buffer_load_dwordx4 v21, s[16:19], s52 offen offset:1024 sc1 lds
MAA 124,0,96
TR 124,25,64160
MAA 124,20,100
TR 126,25,64672
v_add_f32 v167, v167, v171
MAA 128,24,100
ds_read_b128 a[40:43], v23
MAA 128,4,96
buffer_load_dword v22, s[16:19], s52 offen offset:2048 sc1 lds
MAA 132,8,96
RD 44,23,1024
s_add_u32 s52, s52, 131072
MAA 132,28,100
buffer_load_dword v27, v14, s[20:23], s44 offen
MAA 136,32,100
RD 48,23,2304
s_add_u32 s44, s44, 1572864
MAA 136,12,96
RD 52,23,3328
MAA 156,16,96
RD 56,24,2048
MAA 156,36,100
s_waitcnt vmcnt(13) lgkmcnt(5)
s_barrier
MAA 76,104,0
RD 60,23,9216
s_add_u32 m0, s56, 117248
MAA 76,108,20
buffer_load_dwordx4 v18, s[20:23], s54 offen lds
MAA 80,108,24
RD 64,23,10240
MAA 80,104,4
RD 68,23,11520
MAA 84,104,8
RD 72,23,12544
MAA 84,108,28
buffer_load_dwordx4 v19, s[20:23], s54 offen offset:1024 lds
MAA 88,108,32
RD 76,24,11264
MAA 88,104,12
buffer_load_dwordx4 v20, s[20:23], s54 offen offset:2048 lds
MAA 120,112,12
ds_read_b64_tr_b16 a[80:81], v25
s_add_u32 s54, s54, 196608
MAA 120,116,32
TR 82,25,512
MAA 116,116,28
TR 84,25,12416
s_add_u32 m0, s55, 46080
MAA 116,112,8
buffer_load_dwordx4 v21, s[16:19], s52 offen sc1 lds
MAA 112,112,4
TR 86,25,12928
MAA 112,116,24
TR 88,25,1024
MAA 108,116,20
TR 90,25,1536
MAA 108,112,0
buffer_load_dwordx4 v21, s[16:19], s52 offen offset:1024 sc1 lds
MAA 140,0,120
TR 92,25,13440
MAA 140,20,124
TR 94,25,13952
MAA 144,24,124
TR 96,25,2048
MAA 144,4,120
buffer_load_dword v22, s[16:19], s52 offen offset:2048 sc1 lds
MAA 148,8,120
TR 98,25,2560
s_add_u32 s52, s52, 131072
MAA 148,28,124
buffer_load_dwordx4 v[168:171], v26, s[16:19], s75 offen sc1
MAA 152,32,124
TR 100,25,14464
MAA 152,12,120
TR 102,25,14976
MAA 160,16,120
MAA 160,36,124
s_waitcnt vmcnt(17) lgkmcnt(8)
s_barrier
MAA 60,80,40
TR 104,25,32
v_add_f32 v164, v164, v172
MAA 60,84,60
TR 106,25,544
MAA 64,84,64
TR 108,25,12448
s_add_u32 m0, s56, 129664
MAA 64,80,44
buffer_load_dwordx4 v18, s[20:23], s54 offen lds
MAA 68,80,48
TR 110,25,12960
MAA 68,84,68
TR 112,25,1056
MAA 72,84,72
TR 114,25,1568
v_add_f32 v165, v165, v173
MAA 72,80,52
TR 116,25,13472
s_waitcnt lgkmcnt(7)
MAA 104,88,52
TR 118,25,13984
MAA 104,92,72
buffer_load_dwordx4 v19, s[20:23], s54 offen offset:1024 lds
MAA 100,92,68
TR 120,25,2080
MAA 100,88,48
buffer_load_dwordx4 v20, s[20:23], s54 offen offset:2048 lds
MAA 96,88,44
s_add_u32 s54, s54, 196608
MAA 96,92,64
TR 122,25,2592
v_add_f32 v166, v166, v174
MAA 92,92,60
TR 124,25,14496
s_add_u32 m0, s55, 0
MAA 92,88,40
buffer_load_dwordx4 v21, s[16:19], s52 offen sc1 lds
MAA 124,40,96
TR 126,25,15008
MAA 124,60,100
RD 0,23,18432
MAA 128,64,100
RD 4,23,19456
MAA 128,44,96
buffer_load_dwordx4 v21, s[16:19], s52 offen offset:1024 sc1 lds
MAA 132,48,96
RD 8,23,20736
v_add_f32 v167, v167, v175
MAA 132,68,100
RD 12,23,21760
MAA 136,72,100
RD 16,24,20480
MAA 136,52,96
buffer_load_dword v22, s[16:19], s52 offen offset:2048 sc1 lds
MAA 156,56,96
s_add_u32 s52, s52, 131072
MAA 156,76,100
s_waitcnt vmcnt(17) lgkmcnt(5)
s_barrier
MAA 76,104,40
RD 20,23,27648
s_add_u32 m0, s56, 67584
MAA 76,108,60
buffer_load_dwordx4 v18, s[20:23], s54 offen lds
MAA 80,108,64
RD 24,23,28672
MAA 80,104,44
RD 28,23,29952
MAA 84,104,48
RD 32,23,30976
MAA 84,108,68
buffer_load_dwordx4 v19, s[20:23], s54 offen offset:1024 lds
MAA 88,108,72
RD 36,24,29696
MAA 88,104,52
buffer_load_dwordx4 v20, s[20:23], s54 offen offset:2048 lds
MAA 120,112,52
TR 80,25,24832
s_add_u32 s54, s54, 196608
MAA 120,116,72
TR 82,25,25344
MAA 116,116,68
TR 84,25,37248
s_add_u32 m0, s55, 9216
MAA 116,112,48
buffer_load_dwordx4 v21, s[16:19], s52 offen sc1 lds
MAA 112,112,44
TR 86,25,37760
MAA 112,116,64
TR 88,25,25856
MAA 108,116,60
TR 90,25,26368
MAA 108,112,40
buffer_load_dwordx4 v21, s[16:19], s52 offen offset:1024 sc1 lds
MAA 140,40,120
TR 92,25,38272
MAA 140,60,124
TR 94,25,38784
MAA 144,64,124
TR 96,25,26880
MAA 144,44,120
buffer_load_dword v22, s[16:19], s52 offen offset:2048 sc1 lds
MAA 148,48,120
TR 98,25,27392
s_add_u32 s52, s52, 131072
MAA 148,68,124
buffer_load_dwordx4 v[172:175], v26, s[16:19], s75 offen offset:1024 sc1
MAA 152,72,124
TR 100,25,39296
s_add_u32 s75, s75, 2048
MAA 152,52,120
TR 102,25,39808
MAA 160,56,120
MAA 160,76,124
s_waitcnt vmcnt(21) lgkmcnt(8)
s_barrier
MAA 60,80,0
TR 104,25,24864
MAA 60,84,20
TR 106,25,25376
MAA 64,84,24
TR 108,25,37280
s_add_u32 m0, s56, 80000
MAA 64,80,4
buffer_load_dwordx4 v18, s[20:23], s54 offen lds
MAA 68,80,8
TR 110,25,37792
MAA 68,84,28
TR 112,25,25888
MAA 72,84,32
TR 114,25,26400
MAA 72,80,12
TR 116,25,38304
s_waitcnt lgkmcnt(7)
MAA 104,88,12
TR 118,25,38816
MAA 104,92,32
buffer_load_dwordx4 v19, s[20:23], s54 offen offset:1024 lds
MAA 100,92,28
TR 120,25,26912
MAA 100,88,8
buffer_load_dwordx4 v20, s[20:23], s54 offen offset:2048 lds
MAA 96,88,4
s_add_u32 s54, s54, 196608
MAA 96,92,24
TR 122,25,27424
MAA 92,92,20
TR 124,25,39328
s_add_u32 m0, s55, 18432
MAA 92,88,0
buffer_load_dwordx4 v21, s[16:19], s52 offen sc1 lds
MAA 124,0,96
TR 126,25,39840
MAA 124,20,100
RD 40,23,36864
MAA 128,24,100
RD 44,23,37888
MAA 128,4,96
buffer_load_dwordx4 v21, s[16:19], s52 offen offset:1024 sc1 lds
MAA 132,8,96
RD 48,23,39168
MAA 132,28,100
RD 52,23,40192
MAA 136,32,100
RD 56,24,38912
MAA 136,12,96
buffer_load_dword v22, s[16:19], s52 offen offset:2048 sc1 lds
MAA 156,16,96
s_add_u32 s52, s52, 131072
MAA 156,36,100
s_waitcnt vmcnt(16) lgkmcnt(5)
s_barrier
MAA 76,104,0
RD 60,23,46080
MAA 76,108,20
RD 64,23,47104
MAA 80,108,24
RD 68,23,48384
s_add_u32 m0, s56, 92416
MAA 80,104,4
buffer_load_dwordx4 v18, s[20:23], s54 offen lds
MAA 84,104,8
RD 72,23,49408
MAA 84,108,28
RD 76,24,48128
MAA 88,108,32
TR 80,25,49664
MAA 88,104,12
buffer_load_dwordx4 v19, s[20:23], s54 offen offset:1024 lds
MAA 120,112,12
TR 82,25,50176
MAA 120,116,32
TR 84,25,62080
MAA 116,116,28
TR 86,25,62592
MAA 116,112,8
buffer_load_dwordx4 v20, s[20:23], s54 offen offset:2048 lds
MAA 112,112,4
s_add_u32 s54, s54, 196608
MAA 112,116,24
TR 88,25,50688
MAA 108,116,20
TR 90,25,51200
s_add_u32 m0, s55, 27648
MAA 108,112,0
buffer_load_dwordx4 v21, s[16:19], s52 offen sc1 lds
MAA 140,0,120
TR 92,25,63104
MAA 140,20,124
TR 94,25,63616
MAA 144,24,124
TR 96,25,51712
MAA 144,4,120
buffer_load_dwordx4 v21, s[16:19], s52 offen offset:1024 sc1 lds
MAA 148,8,120
TR 98,25,52224
MAA 148,28,124
TR 100,25,64128
MAA 152,32,124
TR 102,25,64640
MAA 152,12,120
buffer_load_dword v22, s[16:19], s52 offen offset:2048 sc1 lds
MAA 160,16,120
s_add_u32 s52, s52, 131072
MAA 160,36,124
s_waitcnt vmcnt(19) lgkmcnt(8)
s_barrier
MAA 60,80,40
TR 104,25,49696
s_add_u32 m0, s56, 104832
MAA 60,84,60
buffer_load_dwordx4 v18, s[20:23], s54 offen lds
MAA 64,84,64
TR 106,25,50208
v_add_f32 v164, v164, v168
MAA 64,80,44
TR 108,25,62112
MAA 68,80,48
TR 110,25,62624
MAA 68,84,68
buffer_load_dwordx4 v19, s[20:23], s54 offen offset:1024 lds
MAA 72,84,72
TR 112,25,50720
v_add_f32 v165, v165, v169
MAA 72,80,52
TR 114,25,51232
s_waitcnt lgkmcnt(6)
MAA 104,88,52
TR 116,25,63136
MAA 104,92,72
buffer_load_dwordx4 v20, s[20:23], s54 offen offset:2048 lds
MAA 100,92,68
s_add_u32 s54, s54, 196608
s_add_u32 m0, s55, 36864
MAA 100,88,48
buffer_load_dwordx4 v21, s[16:19], s52 offen sc1 lds
MAA 96,88,44
TR 118,25,63648
MAA 96,92,64
TR 120,25,51744
v_add_f32 v166, v166, v170
MAA 92,92,60
TR 122,25,52256
MAA 92,88,40
buffer_load_dwordx4 v21, s[16:19], s52 offen offset:1024 sc1 lds
MAA 124,40,96
TR 124,25,64160
MAA 124,60,100
TR 126,25,64672
v_add_f32 v167, v167, v171
MAA 128,64,100
ds_read_b128 a[0:3], v23
MAA 128,44,96
buffer_load_dword v22, s[16:19], s52 offen offset:2048 sc1 lds
MAA 132,48,96
RD 4,23,1024
s_add_u32 s52, s52, 131072
MAA 132,68,100
buffer_load_dword v27, v14, s[20:23], s44 offen
MAA 136,72,100
RD 8,23,2304
s_add_u32 s44, s44, 1572864
MAA 136,52,96
RD 12,23,3328
MAA 156,56,96
RD 16,24,2048
MAA 156,76,100
s_waitcnt vmcnt(16) lgkmcnt(5)
s_barrier
MAA 76,104,40
RD 20,23,9216
s_add_u32 m0, s56, 117248
MAA 76,108,60
buffer_load_dwordx4 v18, s[20:23], s54 offen lds
MAA 80,108,64
RD 24,23,10240
MAA 80,104,44
RD 28,23,11520
MAA 84,104,48
RD 32,23,12544
MAA 84,108,68
buffer_load_dwordx4 v19, s[20:23], s54 offen offset:1024 lds
MAA 88,108,72
RD 36,24,11264
MAA 88,104,52
buffer_load_dwordx4 v20, s[20:23], s54 offen offset:2048 lds
MAA 120,112,52
ds_read_b64_tr_b16 a[80:81], v25
s_add_u32 s54, s54, 196608
MAA 120,116,72
TR 82,25,512
MAA 116,116,68
TR 84,25,12416
s_add_u32 m0, s55, 46080
MAA 116,112,48
buffer_load_dwordx4 v21, s[16:19], s52 offen sc1 lds
MAA 112,112,44
TR 86,25,12928
MAA 112,116,64
TR 88,25,1024
MAA 108,116,60
TR 90,25,1536
MAA 108,112,40
buffer_load_dwordx4 v21, s[16:19], s52 offen offset:1024 sc1 lds
MAA 140,40,120
TR 92,25,13440
MAA 140,60,124
TR 94,25,13952
MAA 144,64,124
TR 96,25,2048
MAA 144,44,120
buffer_load_dword v22, s[16:19], s52 offen offset:2048 sc1 lds
MAA 148,48,120
TR 98,25,2560
s_add_u32 s52, s52, 131072
MAA 148,68,124
buffer_load_dwordx4 v[168:171], v26, s[16:19], s75 offen sc1
MAA 152,72,124
TR 100,25,14464
MAA 152,52,120
TR 102,25,14976
MAA 160,56,120
MAA 160,76,124
s_waitcnt vmcnt(20) lgkmcnt(8)
.Lpad26:
s_cbranch_execz .Lnopoll53r
s_barrier
MAA 60,80,0
TR 104,25,32
v_add_f32 v164, v164, v172
MAA 60,84,20
TR 106,25,544
MAA 64,84,24
TR 108,25,12448
s_add_u32 m0, s56, 129664
MAA 64,80,4
buffer_load_dwordx4 v18, s[20:23], s54 offen lds
MAA 68,80,8
TR 110,25,12960
MAA 68,84,28
TR 112,25,1056
MAA 72,84,32
TR 114,25,1568
v_add_f32 v165, v165, v173
MAA 72,80,12
TR 116,25,13472
s_waitcnt lgkmcnt(7)
MAA 104,88,12
TR 118,25,13984
MAA 104,92,32
buffer_load_dwordx4 v19, s[20:23], s54 offen offset:1024 lds
MAA 100,92,28
TR 120,25,2080
MAA 100,88,8
buffer_load_dwordx4 v20, s[20:23], s54 offen offset:2048 lds
MAA 96,88,4
s_add_u32 s54, s54, 196608
MAA 96,92,24
TR 122,25,2592
v_add_f32 v166, v166, v174
MAA 92,92,20
TR 124,25,14496
s_add_u32 m0, s55, 0
MAA 92,88,0
buffer_load_dwordx4 v21, s[16:19], s52 offen sc1 lds
MAA 124,0,96
TR 126,25,15008
MAA 124,20,100
RD 40,23,18432
MAA 128,24,100
RD 44,23,19456
MAA 128,4,96
buffer_load_dwordx4 v21, s[16:19], s52 offen offset:1024 sc1 lds
MAA 132,8,96
RD 48,23,20736
v_add_f32 v167, v167, v175
MAA 132,28,100
RD 52,23,21760
MAA 136,32,100
RD 56,24,20480
MAA 136,12,96
buffer_load_dword v22, s[16:19], s52 offen offset:2048 sc1 lds
MAA 156,16,96
s_add_u32 s52, s52, 131072
MAA 156,36,100
s_waitcnt vmcnt(17) lgkmcnt(5)
s_barrier
MAA 76,104,0
RD 60,23,27648
s_add_u32 m0, s56, 67584
MAA 76,108,20
buffer_load_dwordx4 v18, s[20:23], s54 offen lds
MAA 80,108,24
RD 64,23,28672
MAA 80,104,4
RD 68,23,29952
MAA 84,104,8
RD 72,23,30976
MAA 84,108,28
buffer_load_dwordx4 v19, s[20:23], s54 offen offset:1024 lds
MAA 88,108,32
RD 76,24,29696
MAA 88,104,12
buffer_load_dwordx4 v20, s[20:23], s54 offen offset:2048 lds
MAA 120,112,12
TR 80,25,24832
s_add_u32 s54, s54, 196608
MAA 120,116,32
TR 82,25,25344
MAA 116,116,28
TR 84,25,37248
s_add_u32 m0, s55, 9216
MAA 116,112,8
buffer_load_dwordx4 v21, s[16:19], s52 offen sc1 lds
MAA 112,112,4
TR 86,25,37760
MAA 112,116,24
TR 88,25,25856
MAA 108,116,20
TR 90,25,26368
MAA 108,112,0
buffer_load_dwordx4 v21, s[16:19], s52 offen offset:1024 sc1 lds
MAA 140,0,120
TR 92,25,38272
MAA 140,20,124
TR 94,25,38784
MAA 144,24,124
TR 96,25,26880
MAA 144,4,120
buffer_load_dword v22, s[16:19], s52 offen offset:2048 sc1 lds
MAA 148,8,120
TR 98,25,27392
s_add_u32 s52, s52, 131072
MAA 148,28,124
buffer_load_dwordx4 v[172:175], v26, s[16:19], s75 offen offset:1024 sc1
MAA 152,32,124
TR 100,25,39296
s_add_u32 s75, s75, 2048
MAA 152,12,120
TR 102,25,39808
MAA 160,16,120
MAA 160,36,124
s_waitcnt vmcnt(21) lgkmcnt(8)
s_barrier
MAA 60,80,40
TR 104,25,24864
MAA 60,84,60
TR 106,25,25376
MAA 64,84,64
TR 108,25,37280
s_add_u32 m0, s56, 80000
MAA 64,80,44
buffer_load_dwordx4 v18, s[20:23], s54 offen lds
MAA 68,80,48
TR 110,25,37792
MAA 68,84,68
TR 112,25,25888
MAA 72,84,72
TR 114,25,26400
MAA 72,80,52
TR 116,25,38304
s_waitcnt lgkmcnt(7)
MAA 104,88,52
TR 118,25,38816
MAA 104,92,72
buffer_load_dwordx4 v19, s[20:23], s54 offen offset:1024 lds
MAA 100,92,68
TR 120,25,26912
MAA 100,88,48
buffer_load_dwordx4 v20, s[20:23], s54 offen offset:2048 lds
MAA 96,88,44
s_add_u32 s54, s54, 196608
MAA 96,92,64
TR 122,25,27424
MAA 92,92,60
TR 124,25,39328
s_add_u32 m0, s55, 18432
MAA 92,88,40
buffer_load_dwordx4 v21, s[16:19], s52 offen sc1 lds
MAA 124,40,96
TR 126,25,39840
MAA 124,60,100
RD 0,23,36864
MAA 128,64,100
RD 4,23,37888
MAA 128,44,96
buffer_load_dwordx4 v21, s[16:19], s52 offen offset:1024 sc1 lds
MAA 132,48,96
RD 8,23,39168
MAA 132,68,100
RD 12,23,40192
MAA 136,72,100
RD 16,24,38912
MAA 136,52,96
buffer_load_dword v22, s[16:19], s52 offen offset:2048 sc1 lds
MAA 156,56,96
s_add_u32 s52, s52, 131072
MAA 156,76,100
s_waitcnt vmcnt(16) lgkmcnt(5)
s_barrier
MAA 76,104,40
RD 20,23,46080
MAA 76,108,60
RD 24,23,47104
MAA 80,108,64
RD 28,23,48384
s_add_u32 m0, s56, 92416
MAA 80,104,44
buffer_load_dwordx4 v18, s[20:23], s54 offen lds
MAA 84,104,48
RD 32,23,49408
MAA 84,108,68
RD 36,24,48128
MAA 88,108,72
TR 80,25,49664
MAA 88,104,52
buffer_load_dwordx4 v19, s[20:23], s54 offen offset:1024 lds
MAA 120,112,52
TR 82,25,50176
MAA 120,116,72
TR 84,25,62080
MAA 116,116,68
TR 86,25,62592
MAA 116,112,48
buffer_load_dwordx4 v20, s[20:23], s54 offen offset:2048 lds
MAA 112,112,44
s_add_u32 s54, s54, 196608
MAA 112,116,64
TR 88,25,50688
MAA 108,116,60
TR 90,25,51200
s_add_u32 m0, s55, 27648
MAA 108,112,40
buffer_load_dwordx4 v21, s[16:19], s52 offen sc1 lds
MAA 140,40,120
TR 92,25,63104
MAA 140,60,124
TR 94,25,63616
MAA 144,64,124
TR 96,25,51712
MAA 144,44,120
buffer_load_dwordx4 v21, s[16:19], s52 offen offset:1024 sc1 lds
MAA 148,48,120
TR 98,25,52224
MAA 148,68,124
TR 100,25,64128
MAA 152,72,124
TR 102,25,64640
MAA 152,52,120
buffer_load_dword v22, s[16:19], s52 offen offset:2048 sc1 lds
MAA 160,56,120
s_add_u32 s52, s52, 131072
s_add_u32 s15, s15, 1
MAA 160,76,124
s_cbranch_scc0 .Lk58
s_waitcnt vmcnt(19) lgkmcnt(8)
s_barrier
MAA 60,80,0
TR 104,25,49696
v_add_f32 v164, v164, v168
MAA 60,84,20
TR 106,25,50208
s_add_u32 m0, s56, 104832
MAA 64,84,24
buffer_load_dwordx4 v18, s[20:23], s54 offen lds
MAA 64,80,4
TR 108,25,62112
v_add_f32 v165, v165, v169
MAA 68,80,8
TR 110,25,62624
v_add_f32 v166, v166, v170
MAA 68,84,28
TR 112,25,50720
v_add_f32 v167, v167, v171
MAA 72,84,32
buffer_load_dwordx4 v19, s[20:23], s54 offen offset:1024 lds
MAA 72,80,12
TR 114,25,51232
s_waitcnt lgkmcnt(6)
MAA 104,88,12
TR 116,25,63136
MAA 104,92,32
TR 118,25,63648
MAA 100,92,28
buffer_load_dwordx4 v20, s[20:23], s54 offen offset:2048 lds
MAA 100,88,8
TR 120,25,51744
s_add_u32 s54, s54, 196608
MAA 96,88,4
TR 122,25,52256
s_add_u32 m0, s55, 36864
MAA 96,92,24
TR 124,25,64160
MAA 92,92,20
buffer_load_dwordx4 v21, s[16:19], s52 offen sc1 lds
MAA 92,88,0
TR 126,25,64672
MAA 124,0,96
ds_read_b128 a[40:43], v23
MAA 124,20,100
RD 44,23,1024
MAA 128,24,100
buffer_load_dwordx4 v21, s[16:19], s52 offen offset:1024 sc1 lds
MAA 128,4,96
RD 48,23,2304
MAA 132,8,96
RD 52,23,3328
MAA 132,28,100
RD 56,24,2048
MAA 136,32,100
buffer_load_dword v22, s[16:19], s52 offen offset:2048 sc1 lds
MAA 136,12,96
s_add_u32 s52, s52, 131072
MAA 156,16,96
MAA 156,36,100
s_waitcnt vmcnt(15) lgkmcnt(5)
s_barrier
MAA 76,104,0
RD 60,23,9216
v_add_f32 v164, v164, v172
MAA 76,108,20
RD 64,23,10240
s_add_u32 m0, s56, 117248
MAA 80,108,24
buffer_load_dwordx4 v18, s[20:23], s54 offen lds
MAA 80,104,4
RD 68,23,11520
v_add_f32 v165, v165, v173
MAA 84,104,8
RD 72,23,12544
v_add_f32 v166, v166, v174
MAA 84,108,28
RD 76,24,11264
v_add_f32 v167, v167, v175
MAA 88,108,32
buffer_load_dwordx4 v19, s[20:23], s54 offen offset:1024 lds
MAA 88,104,12
ds_read_b64_tr_b16 a[80:81], v25
MAA 120,112,12
TR 82,25,512
MAA 120,116,32
TR 84,25,12416
MAA 116,116,28
buffer_load_dwordx4 v20, s[20:23], s54 offen offset:2048 lds
MAA 116,112,8
TR 86,25,12928
s_add_u32 s54, s54, 196608
MAA 112,112,4
TR 88,25,1024
s_add_u32 m0, s55, 46080
MAA 112,116,24
TR 90,25,1536
MAA 108,116,20
buffer_load_dwordx4 v21, s[16:19], s52 offen sc1 lds
MAA 108,112,0
TR 92,25,13440
MAA 140,0,120
TR 94,25,13952
MAA 140,20,124
TR 96,25,2048
MAA 144,24,124
buffer_load_dwordx4 v21, s[16:19], s52 offen offset:1024 sc1 lds
MAA 144,4,120
TR 98,25,2560
MAA 148,8,120
TR 100,25,14464
MAA 148,28,124
TR 102,25,14976
MAA 152,32,124
buffer_load_dword v22, s[16:19], s52 offen offset:2048 sc1 lds
MAA 152,12,120
s_add_u32 s52, s52, 131072
v_permlane32_swap_b32 v164, v166
MAA 160,16,120
v_permlane32_swap_b32 v165, v167
MAA 160,36,124
s_waitcnt vmcnt(18) lgkmcnt(8)
s_barrier
MAA 60,80,40
TR 104,25,32
v_add_f32 v164, v164, v166
MAA 60,84,60
TR 106,25,544
s_add_u32 m0, s56, 129664
MAA 64,84,64
buffer_load_dwordx4 v18, s[20:23], s54 offen lds
MAA 64,80,44
TR 108,25,12448
v_add_f32 v165, v165, v167
MAA 68,80,48
TR 110,25,12960
v_mul_f32 v164, 0xba800000, v164
MAA 68,84,68
buffer_load_dwordx4 v19, s[20:23], s54 offen offset:1024 lds
MAA 72,84,72
TR 112,25,1056
v_mul_f32 v165, 0x3a800000, v165
MAA 72,80,52
TR 114,25,1568
v_fma_f32 v165, -v164, v164, v165
s_waitcnt lgkmcnt(6)
MAA 104,88,52
buffer_load_dwordx4 v20, s[20:23], s54 offen offset:2048 lds
MAA 104,92,72
TR 116,25,13472
s_add_u32 s54, s54, 196608
MAA 100,92,68
TR 118,25,13984
s_add_u32 m0, s59, 58240
MAA 100,88,48
TR 120,25,2080
s_xor_b32 s58, s87, 1966080
MAA 96,88,44
buffer_load_dwordx4 v5, s[24:27], s58 offen lds
MAA 96,92,64
TR 122,25,2592
v_max_f32 v165, 0, v165
MAA 92,92,60
TR 124,25,14496
v_add_f32 v165, 0x3727c5ac, v165
MAA 92,88,40
buffer_load_dwordx4 v6, s[24:27], s58 offen offset:1024 lds
MAA 124,40,96
TR 126,25,15008
s_add_u32 m0, s59, 0
MAA 124,60,100
RD 0,23,18432
s_xor_b32 s58, s87, 1048576
MAA 128,64,100
buffer_load_dwordx4 v5, s[24:27], s58 offen lds
MAA 128,44,96
RD 4,23,19456
MAA 132,48,96
RD 8,23,20736
MAA 132,68,100
buffer_load_dwordx4 v6, s[24:27], s58 offen offset:1024 lds
MAA 136,72,100
RD 12,23,21760
MAA 136,52,96
RD 16,24,20480
MAA 156,56,96
v_rsq_f32 v166, v165
MAA 156,76,100
v_mov_b32 v165, v166
v_mul_f32 v166, 0x3e8293ee, v166
ds_write_b128 v7, v[164:167]
s_waitcnt vmcnt(16) lgkmcnt(6)
s_barrier
MAA 76,104,40
ds_write_b32 v17, v164
MAA 76,108,60
ds_write_b32 v17, v165 offset:1024
s_add_u32 m0, s59, 8320
MAA 80,108,64
RD 20,23,27648
s_xor_b32 s58, s87, 1179648
MAA 80,104,44
buffer_load_dwordx4 v5, s[24:27], s58 offen lds
MAA 84,104,48
RD 24,23,28672
MAA 84,108,68
RD 28,23,29952
MAA 88,108,72
RD 32,23,30976
MAA 88,104,52
buffer_load_dwordx4 v6, s[24:27], s58 offen offset:1024 lds
MAA 120,112,52
RD 36,24,29696
s_add_u32 m0, s59, 66560
MAA 120,116,72
TR 80,25,24832
s_xor_b32 s58, s87, 0
MAA 116,116,68
TR 82,25,25344
MAA 116,112,48
buffer_load_dwordx4 v5, s[24:27], s58 offen lds
MAA 112,112,44
TR 84,25,37248
MAA 112,116,64
TR 86,25,37760
MAA 108,116,60
TR 88,25,25856
MAA 108,112,40
buffer_load_dwordx4 v6, s[24:27], s58 offen offset:1024 lds
MAA 140,40,120
TR 90,25,26368
s_add_u32 m0, s59, 74880
MAA 140,60,124
TR 92,25,38272
s_xor_b32 s58, s87, 131072
MAA 144,64,124
TR 94,25,38784
MAA 144,44,120
buffer_load_dwordx4 v5, s[24:27], s58 offen lds
MAA 148,48,120
TR 96,25,26880
MAA 148,68,124
TR 98,25,27392
MAA 152,72,124
TR 100,25,39296
MAA 152,52,120
buffer_load_dwordx4 v6, s[24:27], s58 offen offset:1024 lds
MAA 160,56,120
TR 102,25,39808
MAA 160,76,124
s_waitcnt vmcnt(10) lgkmcnt(0)
s_barrier
MAA 104,88,12
TR 112,25,25888
s_add_u32 m0, s59, 83200
MAA 104,92,32
TR 114,25,26400
s_xor_b32 s58, s87, 262144
MAA 100,92,28
buffer_load_dwordx4 v5, s[24:27], s58 offen lds
MAA 100,88,8
TR 116,25,38304
MAA 96,88,4
TR 118,25,38816
MAA 96,92,24
TR 120,25,26912
MAA 92,92,20
buffer_load_dwordx4 v6, s[24:27], s58 offen offset:1024 lds
MAA 92,88,0
TR 122,25,27424
s_add_u32 m0, s59, 16640
MAA 156,16,96
TR 124,25,39328
s_xor_b32 s58, s87, 1310720
MAA 156,36,100
TR 126,25,39840
MAA 72,84,32
buffer_load_dwordx4 v5, s[24:27], s58 offen lds
MAA 72,80,12
TR 104,25,24864
MAA 68,80,8
TR 106,25,25376
MAA 68,84,28
TR 108,25,37280
MAA 64,84,24
buffer_load_dwordx4 v6, s[24:27], s58 offen offset:1024 lds
MAA 64,80,4
TR 110,25,37792
s_add_u32 m0, s59, 24960
MAA 60,80,0
RD 40,23,36864
s_xor_b32 s58, s87, 1441792
MAA 60,84,20
RD 44,23,37888
s_waitcnt lgkmcnt(12)
MAA 120,112,12
buffer_load_dwordx4 v5, s[24:27], s58 offen lds
s_waitcnt lgkmcnt(10)
MAA 120,116,32
RD 48,23,39168
MAA 116,116,28
RD 52,23,40192
MAA 116,112,8
RD 56,24,38912
MAA 112,112,4
buffer_load_dwordx4 v6, s[24:27], s58 offen offset:1024 lds
.Lpad27:
s_cbranch_execz .Lnopoll53r
MAA 112,116,24
s_waitcnt lgkmcnt(5)
s_barrier
RD 60,23,46080
MAA 108,116,20
RD 64,23,47104
s_add_u32 m0, s59, 91520
MAA 108,112,0
RD 68,23,48384
s_xor_b32 s58, s87, 393216
MAA 160,16,120
RD 72,23,49408
MAA 160,36,124
RD 76,24,48128
MAA 88,108,32
TR 144,25,50688
MAA 88,104,12
TR 146,25,51200
MAA 84,104,8
TR 148,25,63104
MAA 84,108,28
TR 150,25,63616
MAA 80,108,24
TR 152,25,50720
MAA 80,104,4
TR 154,25,51232
MAA 76,104,0
TR 156,25,63136
MAA 76,108,20
TR 158,25,63648
TR 160,25,51712
TR 162,25,52224
TR 164,25,64128
s_waitcnt lgkmcnt(9)
MAA 104,144,52
TR 166,25,64640
TR 168,25,51744
TR 170,25,52256
s_waitcnt lgkmcnt(10)
MAA 104,148,72
TR 172,25,64160
MAA 100,148,68
TR 174,25,64672
MAA 100,144,48
TR 136,25,49696
MAA 96,144,44
TR 138,25,50208
MAA 96,148,64
TR 140,25,62112
MAA 92,148,60
TR 142,25,62624
MAA 92,144,40
TR 128,25,49664
s_waitcnt lgkmcnt(15)
MAA 120,152,52
TR 130,25,50176
s_waitcnt lgkmcnt(14)
MAA 120,156,72
TR 132,25,62080
MAA 116,156,68
TR 134,25,62592
MAA 116,152,48
ds_read_b128 v[232:235], v10 offset:1792
MAA 112,152,44
ds_read_b128 v[228:231], v10 offset:1536
MAA 112,156,64
ds_read_b128 v[224:227], v10 offset:1280
MAA 108,156,60
ds_read_b128 v[220:223], v10 offset:1024
MAA 108,152,40
buffer_load_dwordx4 v5, s[24:27], s58 offen lds
s_waitcnt lgkmcnt(15)
MAA 156,56,160
ds_read_b128 v[240:243], v11 offset:704
MAA 156,76,164
ds_read_b128 v[244:247], v11 offset:1728
s_waitcnt lgkmcnt(14)
MAA 160,76,172
ds_read_b128 v[18:21], v11 offset:448
MAA 160,56,168
buffer_load_dwordx4 v6, s[24:27], s58 offen offset:1024 lds
s_waitcnt lgkmcnt(13)
MAA 88,136,52
ds_read_b128 v[22:25], v11 offset:1472
s_add_u32 m0, s59, 99840
s_waitcnt lgkmcnt(12)
MAA 88,140,72
s_xor_b32 s58, s87, 524288
MAA 84,140,68
MAA 84,136,48
buffer_load_dwordx4 v5, s[24:27], s58 offen lds
MAA 80,136,44
MAA 80,140,64
MAA 76,140,60
MAA 76,136,40
buffer_load_dwordx4 v6, s[24:27], s58 offen offset:1024 lds
s_waitcnt lgkmcnt(10)
MAA 72,128,52
s_add_u32 m0, s59, 108160
s_xor_b32 s58, s87, 655360
s_waitcnt lgkmcnt(8)
MAA 72,132,72
MAA 68,132,68
MAA 68,128,48
buffer_load_dwordx4 v5, s[24:27], s58 offen lds
MAA 64,128,44
MAA 64,132,64
MAA 60,132,60
MAA 60,128,40
buffer_load_dwordx4 v6, s[24:27], s58 offen offset:1024 lds
s_waitcnt lgkmcnt(3)
v_pk_fma_f32 v[156:157], v[240:241], v[44:45], v[156:157] op_sel_hi:[1,0,1]
s_waitcnt lgkmcnt(2)
v_pk_mul_f32 v[156:157], v[156:157], v[244:245]
v_cvt_pk_bf16_f32 v236, v156, v157
v_pk_fma_f32 v[158:159], v[242:243], v[44:45], v[158:159] op_sel_hi:[1,0,1]
v_pk_mul_f32 v[158:159], v[158:159], v[246:247]
v_cvt_pk_bf16_f32 v237, v158, v159
v_pk_fma_f32 v[160:161], v[240:241], v[44:45], v[160:161] op_sel:[0,1,0] op_sel_hi:[1,1,1]
v_pk_mul_f32 v[160:161], v[160:161], v[244:245]
v_cvt_pk_bf16_f32 v238, v160, v161
v_pk_fma_f32 v[162:163], v[242:243], v[44:45], v[162:163] op_sel:[0,1,0] op_sel_hi:[1,1,1]
v_pk_mul_f32 v[162:163], v[162:163], v[246:247]
v_cvt_pk_bf16_f32 v239, v162, v163
ds_write_b128 v8, v[236:239] offset:1024
v_pk_fma_f32 v[104:105], v[36:37], v[232:233], v[104:105] op_sel_hi:[1,0,1]
v_pk_mul_f32 v[104:105], v[104:105], v[232:233] op_sel:[0,1] op_sel_hi:[1,1]
v_cvt_pk_bf16_f32 v196, v104, v105
v_pk_fma_f32 v[106:107], v[38:39], v[232:233], v[106:107] op_sel_hi:[1,0,1]
v_pk_mul_f32 v[106:107], v[106:107], v[232:233] op_sel:[0,1] op_sel_hi:[1,1]
v_cvt_pk_bf16_f32 v197, v106, v107
v_pk_fma_f32 v[120:121], v[40:41], v[232:233], v[120:121] op_sel_hi:[1,0,1]
v_pk_mul_f32 v[120:121], v[120:121], v[232:233] op_sel:[0,1] op_sel_hi:[1,1]
v_cvt_pk_bf16_f32 v198, v120, v121
v_pk_fma_f32 v[122:123], v[42:43], v[232:233], v[122:123] op_sel_hi:[1,0,1]
v_pk_mul_f32 v[122:123], v[122:123], v[232:233] op_sel:[0,1] op_sel_hi:[1,1]
v_cvt_pk_bf16_f32 v199, v122, v123
v_pk_fma_f32 v[100:101], v[36:37], v[228:229], v[100:101] op_sel_hi:[1,0,1]
v_pk_mul_f32 v[100:101], v[100:101], v[228:229] op_sel:[0,1] op_sel_hi:[1,1]
v_cvt_pk_bf16_f32 v192, v100, v101
v_pk_fma_f32 v[102:103], v[38:39], v[228:229], v[102:103] op_sel_hi:[1,0,1]
v_pk_mul_f32 v[102:103], v[102:103], v[228:229] op_sel:[0,1] op_sel_hi:[1,1]
v_cvt_pk_bf16_f32 v193, v102, v103
v_pk_fma_f32 v[116:117], v[40:41], v[228:229], v[116:117] op_sel_hi:[1,0,1]
v_pk_mul_f32 v[116:117], v[116:117], v[228:229] op_sel:[0,1] op_sel_hi:[1,1]
v_cvt_pk_bf16_f32 v194, v116, v117
v_pk_fma_f32 v[118:119], v[42:43], v[228:229], v[118:119] op_sel_hi:[1,0,1]
v_pk_mul_f32 v[118:119], v[118:119], v[228:229] op_sel:[0,1] op_sel_hi:[1,1]
v_cvt_pk_bf16_f32 v195, v118, v119
v_pk_fma_f32 v[96:97], v[36:37], v[224:225], v[96:97] op_sel_hi:[1,0,1]
v_pk_mul_f32 v[96:97], v[96:97], v[224:225] op_sel:[0,1] op_sel_hi:[1,1]
v_cvt_pk_bf16_f32 v188, v96, v97
v_pk_fma_f32 v[98:99], v[38:39], v[224:225], v[98:99] op_sel_hi:[1,0,1]
v_pk_mul_f32 v[98:99], v[98:99], v[224:225] op_sel:[0,1] op_sel_hi:[1,1]
v_cvt_pk_bf16_f32 v189, v98, v99
v_pk_fma_f32 v[112:113], v[40:41], v[224:225], v[112:113] op_sel_hi:[1,0,1]
v_pk_mul_f32 v[112:113], v[112:113], v[224:225] op_sel:[0,1] op_sel_hi:[1,1]
v_cvt_pk_bf16_f32 v190, v112, v113
v_pk_fma_f32 v[114:115], v[42:43], v[224:225], v[114:115] op_sel_hi:[1,0,1]
v_pk_mul_f32 v[114:115], v[114:115], v[224:225] op_sel:[0,1] op_sel_hi:[1,1]
v_cvt_pk_bf16_f32 v191, v114, v115
v_pk_fma_f32 v[92:93], v[36:37], v[220:221], v[92:93] op_sel_hi:[1,0,1]
v_pk_mul_f32 v[92:93], v[92:93], v[220:221] op_sel:[0,1] op_sel_hi:[1,1]
v_cvt_pk_bf16_f32 v184, v92, v93
v_pk_fma_f32 v[94:95], v[38:39], v[220:221], v[94:95] op_sel_hi:[1,0,1]
v_pk_mul_f32 v[94:95], v[94:95], v[220:221] op_sel:[0,1] op_sel_hi:[1,1]
v_cvt_pk_bf16_f32 v185, v94, v95
v_pk_fma_f32 v[108:109], v[40:41], v[220:221], v[108:109] op_sel_hi:[1,0,1]
v_pk_mul_f32 v[108:109], v[108:109], v[220:221] op_sel:[0,1] op_sel_hi:[1,1]
v_cvt_pk_bf16_f32 v186, v108, v109
v_pk_fma_f32 v[110:111], v[42:43], v[220:221], v[110:111] op_sel_hi:[1,0,1]
v_pk_mul_f32 v[110:111], v[110:111], v[220:221] op_sel:[0,1] op_sel_hi:[1,1]
v_cvt_pk_bf16_f32 v187, v110, v111
v_pk_fma_f32 v[72:73], v[28:29], v[232:233], v[72:73] op_sel_hi:[1,0,1]
v_cvt_pk_bf16_f32 v176, v72, v73
v_pk_fma_f32 v[74:75], v[30:31], v[232:233], v[74:75] op_sel_hi:[1,0,1]
v_cvt_pk_bf16_f32 v177, v74, v75
v_pk_fma_f32 v[88:89], v[32:33], v[232:233], v[88:89] op_sel_hi:[1,0,1]
v_cvt_pk_bf16_f32 v178, v88, v89
v_pk_fma_f32 v[90:91], v[34:35], v[232:233], v[90:91] op_sel_hi:[1,0,1]
v_cvt_pk_bf16_f32 v179, v90, v91
v_pk_fma_f32 v[68:69], v[28:29], v[228:229], v[68:69] op_sel_hi:[1,0,1]
v_cvt_pk_bf16_f32 v172, v68, v69
v_pk_fma_f32 v[70:71], v[30:31], v[228:229], v[70:71] op_sel_hi:[1,0,1]
v_cvt_pk_bf16_f32 v173, v70, v71
v_pk_fma_f32 v[84:85], v[32:33], v[228:229], v[84:85] op_sel_hi:[1,0,1]
v_cvt_pk_bf16_f32 v174, v84, v85
v_pk_fma_f32 v[86:87], v[34:35], v[228:229], v[86:87] op_sel_hi:[1,0,1]
v_cvt_pk_bf16_f32 v175, v86, v87
v_pk_fma_f32 v[64:65], v[28:29], v[224:225], v[64:65] op_sel_hi:[1,0,1]
v_cvt_pk_bf16_f32 v168, v64, v65
v_pk_fma_f32 v[66:67], v[30:31], v[224:225], v[66:67] op_sel_hi:[1,0,1]
v_cvt_pk_bf16_f32 v169, v66, v67
v_pk_fma_f32 v[80:81], v[32:33], v[224:225], v[80:81] op_sel_hi:[1,0,1]
v_cvt_pk_bf16_f32 v170, v80, v81
v_pk_fma_f32 v[82:83], v[34:35], v[224:225], v[82:83] op_sel_hi:[1,0,1]
v_cvt_pk_bf16_f32 v171, v82, v83
v_pk_fma_f32 v[60:61], v[28:29], v[220:221], v[60:61] op_sel_hi:[1,0,1]
v_cvt_pk_bf16_f32 v164, v60, v61
v_pk_fma_f32 v[62:63], v[30:31], v[220:221], v[62:63] op_sel_hi:[1,0,1]
v_cvt_pk_bf16_f32 v165, v62, v63
v_pk_fma_f32 v[76:77], v[32:33], v[220:221], v[76:77] op_sel_hi:[1,0,1]
v_cvt_pk_bf16_f32 v166, v76, v77
v_pk_fma_f32 v[78:79], v[34:35], v[220:221], v[78:79] op_sel_hi:[1,0,1]
s_waitcnt lgkmcnt(0)
s_barrier
v_cvt_pk_bf16_f32 v167, v78, v79
v_mfma_f32_16x16x32_bf16 v[120:123], v[196:199], v[176:179], v[50:53]
ds_read_b128 v[180:183], v9
v_mfma_f32_16x16x32_bf16 v[104:107], v[192:195], v[176:179], v[46:49]
ds_read_b64 v[200:201], v9 offset:1024
v_mfma_f32_16x16x32_bf16 v[116:119], v[192:195], v[172:175], v[50:53]
ds_read_b64 v[210:211], v9 offset:1032
v_mfma_f32_16x16x32_bf16 v[100:103], v[188:191], v[172:175], v[46:49]
ds_read_b128 v[240:243], v11 offset:384
v_mfma_f32_16x16x32_bf16 v[112:115], v[188:191], v[168:171], v[50:53]
ds_read_b128 v[244:247], v11 offset:1408
v_mfma_f32_16x16x32_bf16 v[96:99], v[184:187], v[168:171], v[46:49]
ds_read_b128 v[28:31], v11 offset:320
v_max3_f32 v88, v104, v105, v106
v_mfma_f32_16x16x32_bf16 v[108:111], v[184:187], v[164:167], v[50:53]
ds_read_b128 v[32:35], v11 offset:1344
v_max3_f32 v89, v107, v120, v121
v_max3_f32 v88, v88, v122, v123
v_max_f32 v90, v88, v89
v_max_f32 v89, v88, v89
v_max3_f32 v84, v100, v101, v102
v_max3_f32 v85, v103, v116, v117
s_waitcnt lgkmcnt(6)
v_mfma_f32_16x16x32_bf16 v[92:95], v[180:183], v[164:167], v[46:49]
ds_read_b128 v[36:39], v11 offset:256
v_permlane16_swap_b32 v90, v89
MAA 136,12,96
ds_read_b128 v[40:43], v11 offset:1280
v_max_f32 v88, v90, v89
MAA 136,32,100
v_max_f32 v89, v90, v89
v_max3_f32 v84, v84, v118, v119
MAA 136,52,160
v_permlane32_swap_b32 v88, v89
MAA 136,72,164
v_max_f32 v88, v88, v89
v_mul_f32 v88, v88, v234
MAA 152,72,172
v_max_f32 v86, v84, v85
v_max_f32 v85, v84, v85
MAA 152,52,168
s_nop 0
v_permlane16_swap_b32 v86, v85
MAA 152,32,124
v_max_f32 v84, v86, v85
v_max_f32 v85, v86, v85
MAA 152,12,120
s_nop 0
v_permlane32_swap_b32 v84, v85
v_max3_f32 v80, v96, v97, v98
v_max_f32 v84, v84, v85
v_mul_f32 v84, v84, v230
v_max3_f32 v81, v99, v112, v113
v_max3_f32 v80, v80, v114, v115
v_max_f32 v82, v80, v81
v_max_f32 v81, v80, v81
v_max3_f32 v76, v92, v93, v94
v_max3_f32 v77, v95, v108, v109
v_permlane16_swap_b32 v82, v81
v_max3_f32 v76, v76, v110, v111
v_max_f32 v80, v82, v81
v_max_f32 v81, v82, v81
v_max_f32 v78, v76, v77
v_max_f32 v77, v76, v77
v_permlane32_swap_b32 v80, v81
v_pk_fma_f32 v[104:105], v[104:105], v[234:235], v[88:89] op_sel_hi:[1,0,0] neg_lo:[0,0,1] neg_hi:[0,0,1]
v_max_f32 v80, v80, v81
v_mul_f32 v80, v80, v226
v_permlane16_swap_b32 v78, v77
v_pk_fma_f32 v[106:107], v[106:107], v[234:235], v[88:89] op_sel_hi:[1,0,0] neg_lo:[0,0,1] neg_hi:[0,0,1]
v_max_f32 v76, v78, v77
v_max_f32 v77, v78, v77
v_pk_fma_f32 v[120:121], v[120:121], v[234:235], v[88:89] op_sel_hi:[1,0,0] neg_lo:[0,0,1] neg_hi:[0,0,1]
v_pk_fma_f32 v[122:123], v[122:123], v[234:235], v[88:89] op_sel_hi:[1,0,0] neg_lo:[0,0,1] neg_hi:[0,0,1]
v_permlane32_swap_b32 v76, v77
v_pk_fma_f32 v[100:101], v[100:101], v[230:231], v[84:85] op_sel_hi:[1,0,0] neg_lo:[0,0,1] neg_hi:[0,0,1]
v_max_f32 v76, v76, v77
v_mul_f32 v76, v76, v222
v_pk_fma_f32 v[102:103], v[102:103], v[230:231], v[84:85] op_sel_hi:[1,0,0] neg_lo:[0,0,1] neg_hi:[0,0,1]
v_pk_fma_f32 v[116:117], v[116:117], v[230:231], v[84:85] op_sel_hi:[1,0,0] neg_lo:[0,0,1] neg_hi:[0,0,1]
v_pk_fma_f32 v[118:119], v[118:119], v[230:231], v[84:85] op_sel_hi:[1,0,0] neg_lo:[0,0,1] neg_hi:[0,0,1]
v_pk_fma_f32 v[96:97], v[96:97], v[226:227], v[80:81] op_sel_hi:[1,0,0] neg_lo:[0,0,1] neg_hi:[0,0,1]
v_pk_fma_f32 v[98:99], v[98:99], v[226:227], v[80:81] op_sel_hi:[1,0,0] neg_lo:[0,0,1] neg_hi:[0,0,1]
v_pk_fma_f32 v[112:113], v[112:113], v[226:227], v[80:81] op_sel_hi:[1,0,0] neg_lo:[0,0,1] neg_hi:[0,0,1]
v_pk_fma_f32 v[114:115], v[114:115], v[226:227], v[80:81] op_sel_hi:[1,0,0] neg_lo:[0,0,1] neg_hi:[0,0,1]
v_pk_fma_f32 v[92:93], v[92:93], v[222:223], v[76:77] op_sel_hi:[1,0,0] neg_lo:[0,0,1] neg_hi:[0,0,1]
v_pk_fma_f32 v[94:95], v[94:95], v[222:223], v[76:77] op_sel_hi:[1,0,0] neg_lo:[0,0,1] neg_hi:[0,0,1]
v_pk_fma_f32 v[108:109], v[108:109], v[222:223], v[76:77] op_sel_hi:[1,0,0] neg_lo:[0,0,1] neg_hi:[0,0,1]
v_pk_fma_f32 v[110:111], v[110:111], v[222:223], v[76:77] op_sel_hi:[1,0,0] neg_lo:[0,0,1] neg_hi:[0,0,1]
v_pk_fma_f32 v[136:137], v[18:19], v[44:45], v[136:137] op_sel_hi:[1,0,1]
v_pk_mul_f32 v[136:137], v[136:137], v[22:23]
v_pk_fma_f32 v[138:139], v[20:21], v[44:45], v[138:139] op_sel_hi:[1,0,1]
v_pk_mul_f32 v[138:139], v[138:139], v[24:25]
v_pk_fma_f32 v[152:153], v[18:19], v[44:45], v[152:153] op_sel:[0,1,0] op_sel_hi:[1,1,1]
v_pk_mul_f32 v[152:153], v[152:153], v[22:23]
v_pk_fma_f32 v[154:155], v[20:21], v[44:45], v[154:155] op_sel:[0,1,0] op_sel_hi:[1,1,1]
v_pk_mul_f32 v[154:155], v[154:155], v[24:25]
v_exp_f32 v104, v104
s_nop 0
MAA 132,8,96
v_exp_f32 v105, v105
MAA 132,28,100
v_exp_f32 v106, v106
MAA 132,48,160
v_exp_f32 v107, v107
MAA 132,68,164
v_exp_f32 v120, v120
MAA 148,68,172
v_exp_f32 v121, v121
MAA 148,48,168
v_exp_f32 v122, v122
MAA 148,28,124
v_exp_f32 v123, v123
MAA 148,8,120
v_exp_f32 v100, v100
MAA 128,4,96
v_exp_f32 v101, v101
MAA 128,24,100
v_exp_f32 v102, v102
MAA 128,44,160
v_exp_f32 v103, v103
MAA 128,64,164
v_exp_f32 v116, v116
MAA 144,64,172
v_exp_f32 v117, v117
MAA 144,44,168
v_exp_f32 v118, v118
MAA 144,24,124
v_exp_f32 v119, v119
MAA 144,4,120
v_exp_f32 v96, v96
MAA 124,0,96
v_exp_f32 v97, v97
MAA 124,20,100
v_exp_f32 v98, v98
MAA 124,40,160
v_exp_f32 v99, v99
MAA 124,60,164
v_exp_f32 v112, v112
MAA 140,60,172
v_exp_f32 v113, v113
MAA 140,40,168
v_exp_f32 v114, v114
MAA 140,20,124
v_exp_f32 v115, v115
MAA 140,0,120
v_cvt_pk_bf16_f32 v72, v104, v105
v_cvt_pk_bf16_f32 v73, v106, v107
v_cvt_pk_bf16_f32 v74, v120, v121
v_cvt_pk_bf16_f32 v75, v122, v123
v_cvt_pk_bf16_f32 v68, v100, v101
v_cvt_pk_bf16_f32 v69, v102, v103
v_cvt_pk_bf16_f32 v70, v116, v117
v_cvt_pk_bf16_f32 v71, v118, v119
v_cvt_pk_bf16_f32 v64, v96, v97
v_cvt_pk_bf16_f32 v65, v98, v99
v_cvt_pk_bf16_f32 v66, v112, v113
v_cvt_pk_bf16_f32 v67, v114, v115
v_cvt_pk_bf16_f32 v208, v136, v137
v_cvt_pk_bf16_f32 v209, v138, v139
v_cvt_pk_bf16_f32 v218, v152, v153
v_cvt_pk_bf16_f32 v219, v154, v155
s_waitcnt lgkmcnt(5)
v_pk_fma_f32 v[132:133], v[240:241], v[44:45], v[132:133] op_sel_hi:[1,0,1]
s_waitcnt lgkmcnt(4)
v_pk_mul_f32 v[132:133], v[132:133], v[244:245]
v_cvt_pk_bf16_f32 v206, v132, v133
v_pk_fma_f32 v[134:135], v[242:243], v[44:45], v[134:135] op_sel_hi:[1,0,1]
v_pk_mul_f32 v[134:135], v[134:135], v[246:247]
v_cvt_pk_bf16_f32 v207, v134, v135
v_pk_fma_f32 v[148:149], v[240:241], v[44:45], v[148:149] op_sel:[0,1,0] op_sel_hi:[1,1,1]
v_pk_mul_f32 v[148:149], v[148:149], v[244:245]
v_cvt_pk_bf16_f32 v216, v148, v149
v_pk_fma_f32 v[150:151], v[242:243], v[44:45], v[150:151] op_sel:[0,1,0] op_sel_hi:[1,1,1]
v_pk_mul_f32 v[150:151], v[150:151], v[246:247]
v_cvt_pk_bf16_f32 v217, v150, v151
s_waitcnt lgkmcnt(3)
v_pk_fma_f32 v[128:129], v[28:29], v[44:45], v[128:129] op_sel_hi:[1,0,1]
s_waitcnt lgkmcnt(2)
v_pk_mul_f32 v[128:129], v[128:129], v[32:33]
v_cvt_pk_bf16_f32 v204, v128, v129
v_pk_fma_f32 v[130:131], v[30:31], v[44:45], v[130:131] op_sel_hi:[1,0,1]
v_pk_mul_f32 v[130:131], v[130:131], v[34:35]
v_cvt_pk_bf16_f32 v205, v130, v131
v_pk_fma_f32 v[144:145], v[28:29], v[44:45], v[144:145] op_sel:[0,1,0] op_sel_hi:[1,1,1]
v_pk_mul_f32 v[144:145], v[144:145], v[32:33]
v_cvt_pk_bf16_f32 v214, v144, v145
v_pk_fma_f32 v[146:147], v[30:31], v[44:45], v[146:147] op_sel:[0,1,0] op_sel_hi:[1,1,1]
v_pk_mul_f32 v[146:147], v[146:147], v[34:35]
v_cvt_pk_bf16_f32 v215, v146, v147
s_waitcnt lgkmcnt(1)
v_pk_fma_f32 v[124:125], v[36:37], v[44:45], v[124:125] op_sel_hi:[1,0,1]
s_waitcnt lgkmcnt(0)
v_pk_mul_f32 v[124:125], v[124:125], v[40:41]
v_cvt_pk_bf16_f32 v202, v124, v125
v_pk_fma_f32 v[126:127], v[38:39], v[44:45], v[126:127] op_sel_hi:[1,0,1]
v_pk_mul_f32 v[126:127], v[126:127], v[42:43]
v_cvt_pk_bf16_f32 v203, v126, v127
v_pk_fma_f32 v[140:141], v[36:37], v[44:45], v[140:141] op_sel:[0,1,0] op_sel_hi:[1,1,1]
v_pk_mul_f32 v[140:141], v[140:141], v[40:41]
v_cvt_pk_bf16_f32 v212, v140, v141
v_pk_fma_f32 v[142:143], v[38:39], v[44:45], v[142:143] op_sel:[0,1,0] op_sel_hi:[1,1,1]
v_pk_mul_f32 v[142:143], v[142:143], v[42:43]
v_cvt_pk_bf16_f32 v213, v142, v143
s_nop 0
v_mfma_f32_16x16x32_bf16 v[88:91], v[248:251], v[72:75], 0
v_exp_f32 v92, v92
v_mfma_f32_16x16x32_bf16 v[104:107], v[206:209], v[72:75], 0
v_exp_f32 v93, v93
v_mfma_f32_16x16x32_bf16 v[120:123], v[216:219], v[72:75], 0
v_exp_f32 v94, v94
v_mfma_f32_16x16x32_bf16 v[84:87], v[248:251], v[68:71], 0
v_exp_f32 v95, v95
v_mfma_f32_16x16x32_bf16 v[100:103], v[204:207], v[68:71], 0
v_exp_f32 v108, v108
v_mfma_f32_16x16x32_bf16 v[116:119], v[214:217], v[68:71], 0
v_exp_f32 v109, v109
v_mfma_f32_16x16x32_bf16 v[80:83], v[248:251], v[64:67], 0
v_exp_f32 v110, v110
v_mfma_f32_16x16x32_bf16 v[96:99], v[202:205], v[64:67], 0
v_exp_f32 v111, v111
v_mfma_f32_16x16x32_bf16 v[112:115], v[212:215], v[64:67], 0
v_cvt_pk_bf16_f32 v60, v92, v93
v_cvt_pk_bf16_f32 v61, v94, v95
v_cvt_pk_bf16_f32 v62, v108, v109
v_cvt_pk_bf16_f32 v63, v110, v111
v_rcp_f32 v88, v88
v_rcp_f32 v84, v84
v_mfma_f32_16x16x32_bf16 v[76:79], v[248:251], v[60:63], 0
v_rcp_f32 v80, v80
v_mfma_f32_16x16x32_bf16 v[92:95], v[200:203], v[60:63], 0
v_mfma_f32_16x16x32_bf16 v[108:111], v[210:213], v[60:63], 0
s_nop 4
v_rcp_f32 v76, v76
v_pk_mul_f32 v[104:105], v[104:105], v[88:89] op_sel_hi:[1,0]
v_pk_mul_f32 v[106:107], v[106:107], v[88:89] op_sel_hi:[1,0]
v_pk_mul_f32 v[120:121], v[120:121], v[88:89] op_sel_hi:[1,0]
v_pk_mul_f32 v[122:123], v[122:123], v[88:89] op_sel_hi:[1,0]
v_cvt_pk_bf16_f32 v176, v104, v105
v_cvt_pk_bf16_f32 v177, v106, v107
v_cvt_pk_bf16_f32 v178, v120, v121
v_cvt_pk_bf16_f32 v179, v122, v123
buffer_store_dwordx4 v[176:179], v4, s[16:19], s74 offen offset:3072 sc1
v_pk_mul_f32 v[100:101], v[100:101], v[84:85] op_sel_hi:[1,0]
v_pk_mul_f32 v[102:103], v[102:103], v[84:85] op_sel_hi:[1,0]
v_pk_mul_f32 v[116:117], v[116:117], v[84:85] op_sel_hi:[1,0]
v_pk_mul_f32 v[118:119], v[118:119], v[84:85] op_sel_hi:[1,0]
v_cvt_pk_bf16_f32 v172, v100, v101
v_cvt_pk_bf16_f32 v173, v102, v103
v_cvt_pk_bf16_f32 v174, v116, v117
v_cvt_pk_bf16_f32 v175, v118, v119
buffer_store_dwordx4 v[172:175], v4, s[16:19], s74 offen offset:2048 sc1
v_pk_mul_f32 v[96:97], v[96:97], v[80:81] op_sel_hi:[1,0]
v_pk_mul_f32 v[98:99], v[98:99], v[80:81] op_sel_hi:[1,0]
v_pk_mul_f32 v[112:113], v[112:113], v[80:81] op_sel_hi:[1,0]
v_pk_mul_f32 v[114:115], v[114:115], v[80:81] op_sel_hi:[1,0]
v_cvt_pk_bf16_f32 v168, v96, v97
v_cvt_pk_bf16_f32 v169, v98, v99
v_cvt_pk_bf16_f32 v170, v112, v113
v_cvt_pk_bf16_f32 v171, v114, v115
buffer_store_dwordx4 v[168:171], v4, s[16:19], s74 offen offset:1024 sc1
v_pk_mul_f32 v[92:93], v[92:93], v[76:77] op_sel_hi:[1,0]
v_pk_mul_f32 v[94:95], v[94:95], v[76:77] op_sel_hi:[1,0]
v_pk_mul_f32 v[108:109], v[108:109], v[76:77] op_sel_hi:[1,0]
v_pk_mul_f32 v[110:111], v[110:111], v[76:77] op_sel_hi:[1,0]
v_cvt_pk_bf16_f32 v164, v92, v93
v_cvt_pk_bf16_f32 v165, v94, v95
v_cvt_pk_bf16_f32 v166, v108, v109
v_cvt_pk_bf16_f32 v167, v110, v111
buffer_store_dwordx4 v[164:167], v4, s[16:19], s74 offen sc1
s_nop 1
.Lqkve56:
s_lshl_b32 s62, s3, 11
s_add_u32 s62, s62, s84
v_lshl_add_u32 v4, v1, 4, s62
v_lshrrev_b32 v2, 3, v1
v_cmp_eq_u32 vcc, 3, v2
v_add_u32 v2, 67108480, v4
s_nop 0
v_cndmask_b32 v4, v4, v2, vcc
v_bfe_u32 v8, v1, 3, 2
v_mul_u32_u24 v8, 2080, v8
v_bfe_u32 v2, v1, 2, 1
v_lshl_add_u32 v8, v2, 7, v8
v_bfe_u32 v2, v1, 5, 1
v_lshl_add_u32 v8, v2, 8, v8
v_and_b32 v2, 3, v1
v_lshl_add_u32 v8, v2, 3, v8
s_mov_b32 s57, 66560
v_add_u32 v7, s57, v8
s_lshr_b32 s54, s87, 17
s_lshl_b32 s54, s54, 18
s_add_u32 s54, s54, 37748736
s_mov_b32 s52, s54
s_add_u32 s53, s54, 131072
v_accvgpr_read_b32 v32, a224
v_accvgpr_read_b32 v33, a225
v_accvgpr_read_b32 v34, a226
v_accvgpr_read_b32 v35, a227
v_accvgpr_read_b32 v36, a228
v_accvgpr_read_b32 v37, a229
v_accvgpr_read_b32 v38, a230
v_accvgpr_read_b32 v39, a231
v_accvgpr_read_b32 v40, a232
v_accvgpr_read_b32 v41, a233
v_accvgpr_read_b32 v42, a234
v_accvgpr_read_b32 v43, a235
v_accvgpr_read_b32 v44, a236
v_accvgpr_read_b32 v45, a237
v_accvgpr_read_b32 v46, a238
v_accvgpr_read_b32 v47, a239
v_accvgpr_read_b32 v48, a240
v_accvgpr_read_b32 v49, a241
v_accvgpr_read_b32 v50, a242
v_accvgpr_read_b32 v51, a243
v_accvgpr_read_b32 v52, a244
v_accvgpr_read_b32 v53, a245
v_accvgpr_read_b32 v54, a246
v_accvgpr_read_b32 v55, a247
v_accvgpr_read_b32 v56, a248
v_accvgpr_read_b32 v57, a249
v_accvgpr_read_b32 v58, a250
v_accvgpr_read_b32 v59, a251
v_accvgpr_read_b32 v60, a252
v_accvgpr_read_b32 v61, a253
v_accvgpr_read_b32 v62, a254
v_accvgpr_read_b32 v63, a255
s_lshl_b32 s62, s8, 10
s_add_u32 s62, s62, 30490624
s_lshl_b32 s64, s6, 10
s_add_u32 s64, s64, 30490624
s_lshr_b32 s67, s5, 2
s_and_b32 s67, s67, 3
s_lshl_b32 s67, s67, 7
s_add_u32 s64, s64, s67
v_lshl_add_u32 v252, v1, 7, s62
v_mov_b32 v253, s64
v_mov_b32 v255, 1
s_waitcnt vmcnt(0) lgkmcnt(0)
s_cmp_lg_u32 s3, 1
s_barrier
s_cbranch_scc1 .Lfirst61
s_mov_b64 exec, 15
buffer_atomic_add v255, v252, s[16:19], 0 offen
s_mov_b64 exec, 1
v_mov_b32 v254, 0
buffer_atomic_add v254, v253, s[16:19], 0 offen sc0
s_mov_b64 exec, -1
.Lfirst61:
s_add_u32 m0, s59, 116480
s_xor_b32 s58, s87, 786432
buffer_load_dwordx4 v5, s[24:27], s58 offen lds
buffer_load_dwordx4 v6, s[24:27], s58 offen offset:1024 lds
s_add_u32 m0, s59, 124800
s_xor_b32 s58, s87, 917504
buffer_load_dwordx4 v5, s[24:27], s58 offen lds
buffer_load_dwordx4 v6, s[24:27], s58 offen offset:1024 lds
s_add_u32 m0, s59, 33280
s_xor_b32 s58, s87, 1572864
buffer_load_dwordx4 v5, s[24:27], s58 offen lds
buffer_load_dwordx4 v6, s[24:27], s58 offen offset:1024 lds
s_add_u32 m0, s59, 41600
s_xor_b32 s58, s87, 1703936
buffer_load_dwordx4 v5, s[24:27], s58 offen lds
buffer_load_dwordx4 v6, s[24:27], s58 offen offset:1024 lds
s_add_u32 m0, s59, 49920
s_xor_b32 s58, s87, 1835008
buffer_load_dwordx4 v5, s[24:27], s58 offen lds
buffer_load_dwordx4 v6, s[24:27], s58 offen offset:1024 lds
s_cmp_lg_u32 s3, 1
.Lpad28:
s_cbranch_execz .Lnopoll53r
s_cbranch_scc1 .Lnopoll60
s_mov_b64 exec, 1
s_mov_b32 s15, 0
v_mov_b32 v255, 0
buffer_atomic_add v255, v253, s[16:19], 0 offen sc0
s_waitcnt vmcnt(11)
v_cmp_gt_u32 vcc, 16, v254
s_nop 0
s_cbranch_vccz .Lnopoll60r
.Lpoll59:
s_waitcnt vmcnt(0)
v_cmp_gt_u32 vcc, 16, v255
s_add_u32 s15, s15, 1
s_cbranch_vccz .Lnopoll60r
v_mov_b32 v255, 0
buffer_atomic_add v255, v253, s[16:19], 0 offen sc0
s_cmp_le_u32 s15, 100000
s_cbranch_scc1 .Lpoll59
s_branch .Lnopoll60r
.Lnopoll60:
s_mov_b64 exec, 0
s_cmp_eq_u32 s3, 2
s_cbranch_scc1 .Lpad29
s_cmp_eq_u32 s3, 3
s_cbranch_scc1 .Lpad30
s_branch .Lpad31
.Lnopoll60r:
s_mov_b64 exec, -1
s_waitcnt vmcnt(11)
s_barrier
buffer_load_dwordx4 v[64:67], v4, s[16:19], s52 offen sc1
buffer_load_dwordx4 v[68:71], v4, s[16:19], s52 offen offset:1024 sc1
s_xor_b32 s52, s54, 262144
buffer_load_dwordx4 v[72:75], v4, s[16:19], s53 offen sc1
buffer_load_dwordx4 v[76:79], v4, s[16:19], s53 offen offset:1024 sc1
s_xor_b32 s53, s54, 393216
buffer_load_dwordx4 v[80:83], v4, s[16:19], s52 offen sc1
buffer_load_dwordx4 v[84:87], v4, s[16:19], s52 offen offset:1024 sc1
s_xor_b32 s52, s54, 524288
buffer_load_dwordx4 v[88:91], v4, s[16:19], s53 offen sc1
buffer_load_dwordx4 v[92:95], v4, s[16:19], s53 offen offset:1024 sc1
s_xor_b32 s53, s54, 655360
buffer_load_dwordx4 v[96:99], v4, s[16:19], s52 offen sc1
buffer_load_dwordx4 v[100:103], v4, s[16:19], s52 offen offset:1024 sc1
s_xor_b32 s52, s54, 786432
buffer_load_dwordx4 v[104:107], v4, s[16:19], s53 offen sc1
buffer_load_dwordx4 v[108:111], v4, s[16:19], s53 offen offset:1024 sc1
s_xor_b32 s53, s54, 917504
ds_read_b64_tr_b16 a[0:1], v7
TR 2,7,512
TR 16,7,1024
TR 18,7,1536
TR 4,7,32
TR 6,7,544
TR 20,7,1056
TR 22,7,1568
TR 8,7,64
TR 10,7,576
TR 24,7,1088
TR 26,7,1600
TR 12,7,96
TR 14,7,608
TR 28,7,1120
TR 30,7,1632
s_lshl_b32 s62, s49, 3
s_add_u32 s62, s62, s48
s_mul_i32 s62, s62, 28672
s_add_u32 s62, s62, s51
v_lshrrev_b32 v12, 4, v1
v_mul_u32_u24 v12, 57344, v12
v_and_b32 v2, 15, v1
v_lshl_add_u32 v12, v2, 4, v12
v_add_u32 v12, s62, v12
v_add_u32 v13, 6112, v12
v_add_u32 v14, 12224, v12
v_add_u32 v15, 18336, v12
s_mul_i32 s59, s3, 4224
s_mov_b32 s58, 0
s_waitcnt vmcnt(8) lgkmcnt(14)
MAV 32,0,64
TR 32,7,8320
s_waitcnt lgkmcnt(13)
MAV 32,16,72
buffer_load_dwordx4 v[112:115], v4, s[16:19], s52 offen sc1
MAV 48,16,76
TR 34,7,8832
MAV 48,0,68
TR 48,7,9344
TR 50,7,9856
s_waitcnt lgkmcnt(14)
MAV 52,4,68
TR 36,7,8352
s_waitcnt lgkmcnt(13)
MAV 52,20,76
buffer_load_dwordx4 v[116:119], v4, s[16:19], s52 offen offset:1024 sc1
MAV 36,20,72
TR 38,7,8864
s_xor_b32 s52, s54, 1048576
MAV 36,4,64
TR 52,7,9376
TR 54,7,9888
s_waitcnt lgkmcnt(14)
MAV 40,8,64
TR 40,7,8384
s_waitcnt lgkmcnt(13)
MAV 40,24,72
buffer_load_dwordx4 v[120:123], v4, s[16:19], s53 offen sc1
MAV 56,24,76
TR 42,7,8896
MAV 56,8,68
TR 56,7,9408
TR 58,7,9920
s_waitcnt lgkmcnt(14)
MAV 60,12,68
TR 44,7,8416
s_waitcnt lgkmcnt(13)
MAV 60,28,76
buffer_load_dwordx4 v[124:127], v4, s[16:19], s53 offen offset:1024 sc1
MAV 44,28,72
TR 46,7,8928
s_xor_b32 s53, s54, 1179648
MAV 44,12,64
TR 60,7,9440
TR 62,7,9952
s_waitcnt vmcnt(8) lgkmcnt(8)
MAV 32,32,80
TR 0,7,16640
MAV 32,48,88
buffer_load_dwordx4 v[64:67], v4, s[16:19], s52 offen sc1
MAV 48,48,92
TR 2,7,17152
MAV 48,32,84
TR 16,7,17664
TR 18,7,18176
MAV 52,36,84
TR 4,7,16672
MAV 52,52,92
buffer_load_dwordx4 v[68:71], v4, s[16:19], s52 offen offset:1024 sc1
MAV 36,52,88
TR 6,7,17184
s_xor_b32 s52, s54, 1310720
MAV 36,36,80
TR 20,7,17696
TR 22,7,18208
s_waitcnt lgkmcnt(8)
MAV 40,40,80
TR 8,7,16704
MAV 40,56,88
buffer_load_dwordx4 v[72:75], v4, s[16:19], s53 offen sc1
MAV 56,56,92
TR 10,7,17216
MAV 56,40,84
TR 24,7,17728
TR 26,7,18240
MAV 60,44,84
TR 12,7,16736
MAV 60,60,92
buffer_load_dwordx4 v[76:79], v4, s[16:19], s53 offen offset:1024 sc1
MAV 44,60,88
TR 14,7,17248
s_xor_b32 s53, s54, 1441792
MAV 44,44,80
TR 28,7,17760
TR 30,7,18272
s_waitcnt vmcnt(8) lgkmcnt(8)
MAV 32,0,96
TR 32,7,24960
MAV 32,16,104
buffer_load_dwordx4 v[80:83], v4, s[16:19], s52 offen sc1
MAV 48,16,108
TR 34,7,25472
MAV 48,0,100
TR 48,7,25984
TR 50,7,26496
MAV 52,4,100
TR 36,7,24992
MAV 52,20,108
buffer_load_dwordx4 v[84:87], v4, s[16:19], s52 offen offset:1024 sc1
MAV 36,20,104
TR 38,7,25504
s_xor_b32 s52, s54, 1572864
MAV 36,4,96
TR 52,7,26016
TR 54,7,26528
s_waitcnt lgkmcnt(8)
MAV 40,8,96
TR 40,7,25024
MAV 40,24,104
buffer_load_dwordx4 v[88:91], v4, s[16:19], s53 offen sc1
MAV 56,24,108
TR 42,7,25536
MAV 56,8,100
TR 56,7,26048
TR 58,7,26560
MAV 60,12,100
TR 44,7,25056
MAV 60,28,108
buffer_load_dwordx4 v[92:95], v4, s[16:19], s53 offen offset:1024 sc1
MAV 44,28,104
TR 46,7,25568
s_xor_b32 s53, s54, 1703936
MAV 44,12,96
TR 60,7,26080
TR 62,7,26592
s_barrier
s_waitcnt vmcnt(8) lgkmcnt(8)
MAV 32,32,112
TR 0,7,33280
MAV 32,48,120
buffer_load_dwordx4 v[96:99], v4, s[16:19], s52 offen sc1
MAV 48,48,124
TR 2,7,33792
MAV 48,32,116
TR 16,7,34304
TR 18,7,34816
MAV 52,36,116
TR 4,7,33312
MAV 52,52,124
buffer_load_dwordx4 v[100:103], v4, s[16:19], s52 offen offset:1024 sc1
MAV 36,52,120
TR 6,7,33824
s_xor_b32 s52, s54, 1835008
MAV 36,36,112
TR 20,7,34336
TR 22,7,34848
s_waitcnt lgkmcnt(8)
MAV 40,40,112
TR 8,7,33344
MAV 40,56,120
buffer_load_dwordx4 v[104:107], v4, s[16:19], s53 offen sc1
MAV 56,56,124
TR 10,7,33856
MAV 56,40,116
TR 24,7,34368
TR 26,7,34880
MAV 60,44,116
TR 12,7,33376
MAV 60,60,124
buffer_load_dwordx4 v[108:111], v4, s[16:19], s53 offen offset:1024 sc1
MAV 44,60,120
TR 14,7,33888
s_xor_b32 s53, s54, 1966080
MAV 44,44,112
TR 28,7,34400
TR 30,7,34912
s_waitcnt vmcnt(8) lgkmcnt(8)
MAV 32,0,64
TR 32,7,41600
MAV 32,16,72
buffer_load_dwordx4 v[112:115], v4, s[16:19], s52 offen sc1
MAV 48,16,76
TR 34,7,42112
MAV 48,0,68
TR 48,7,42624
TR 50,7,43136
MAV 52,4,68
TR 36,7,41632
MAV 52,20,76
buffer_load_dwordx4 v[116:119], v4, s[16:19], s52 offen offset:1024 sc1
MAV 36,20,72
TR 38,7,42144
s_xor_b32 s52, s54, 2097152
MAV 36,4,64
TR 52,7,42656
TR 54,7,43168
s_waitcnt lgkmcnt(8)
MAV 40,8,64
TR 40,7,41664
MAV 40,24,72
buffer_load_dwordx4 v[120:123], v4, s[16:19], s53 offen sc1
MAV 56,24,76
TR 42,7,42176
MAV 56,8,68
TR 56,7,42688
TR 58,7,43200
MAV 60,12,68
TR 44,7,41696
MAV 60,28,76
buffer_load_dwordx4 v[124:127], v4, s[16:19], s53 offen offset:1024 sc1
MAV 44,28,72
TR 46,7,42208
s_xor_b32 s53, s54, 2228224
MAV 44,12,64
TR 60,7,42720
TR 62,7,43232
s_waitcnt vmcnt(8) lgkmcnt(8)
MAV 32,32,80
TR 0,7,49920
MAV 32,48,88
buffer_load_dwordx4 v[64:67], v4, s[16:19], s52 offen sc1
MAV 48,48,92
TR 2,7,50432
MAV 48,32,84
TR 16,7,50944
TR 18,7,51456
MAV 52,36,84
TR 4,7,49952
MAV 52,52,92
buffer_load_dwordx4 v[68:71], v4, s[16:19], s52 offen offset:1024 sc1
MAV 36,52,88
TR 6,7,50464
s_xor_b32 s52, s54, 2359296
MAV 36,36,80
TR 20,7,50976
TR 22,7,51488
s_waitcnt lgkmcnt(8)
MAV 40,40,80
TR 8,7,49984
MAV 40,56,88
buffer_load_dwordx4 v[72:75], v4, s[16:19], s53 offen sc1
MAV 56,56,92
TR 10,7,50496
MAV 56,40,84
TR 24,7,51008
TR 26,7,51520
MAV 60,44,84
TR 12,7,50016
MAV 60,60,92
buffer_load_dwordx4 v[76:79], v4, s[16:19], s53 offen offset:1024 sc1
MAV 44,60,88
TR 14,7,50528
s_xor_b32 s53, s54, 2490368
MAV 44,44,80
TR 28,7,51040
TR 30,7,51552
s_waitcnt vmcnt(8) lgkmcnt(8)
MAV 32,0,96
TR 32,7,58240
MAV 32,16,104
buffer_load_dwordx4 v[80:83], v4, s[16:19], s52 offen sc1
MAV 48,16,108
TR 34,7,58752
MAV 48,0,100
TR 48,7,59264
TR 50,7,59776
MAV 52,4,100
TR 36,7,58272
MAV 52,20,108
buffer_load_dwordx4 v[84:87], v4, s[16:19], s52 offen offset:1024 sc1
MAV 36,20,104
TR 38,7,58784
s_xor_b32 s52, s54, 2621440
MAV 36,4,96
TR 52,7,59296
TR 54,7,59808
s_waitcnt lgkmcnt(8)
MAV 40,8,96
TR 40,7,58304
MAV 40,24,104
buffer_load_dwordx4 v[88:91], v4, s[16:19], s53 offen sc1
MAV 56,24,108
TR 42,7,58816
MAV 56,8,100
TR 56,7,59328
TR 58,7,59840
MAV 60,12,100
TR 44,7,58336
MAV 60,28,108
buffer_load_dwordx4 v[92:95], v4, s[16:19], s53 offen offset:1024 sc1
MAV 44,28,104
TR 46,7,58848
s_xor_b32 s53, s54, 2752512
MAV 44,12,96
TR 60,7,59360
TR 62,7,59872
s_xor_b32 s57, s57, 66560
v_add_u32 v7, s57, v8
s_waitcnt vmcnt(8) lgkmcnt(8)
MAV 32,32,112
ds_read_b64_tr_b16 a[0:1], v7
MAV 32,48,120
buffer_load_dwordx4 v[96:99], v4, s[16:19], s52 offen sc1
MAV 48,48,124
TR 2,7,512
MAV 48,32,116
TR 16,7,1024
TR 18,7,1536
MAV 52,36,116
TR 4,7,32
MAV 52,52,124
buffer_load_dwordx4 v[100:103], v4, s[16:19], s52 offen offset:1024 sc1
MAV 36,52,120
TR 6,7,544
s_xor_b32 s52, s54, 2883584
MAV 36,36,112
TR 20,7,1056
TR 22,7,1568
s_waitcnt lgkmcnt(8)
MAV 40,40,112
TR 8,7,64
MAV 40,56,120
buffer_load_dwordx4 v[104:107], v4, s[16:19], s53 offen sc1
MAV 56,56,124
TR 10,7,576
MAV 56,40,116
TR 24,7,1088
TR 26,7,1600
MAV 60,44,116
TR 12,7,96
MAV 60,60,124
buffer_load_dwordx4 v[108:111], v4, s[16:19], s53 offen offset:1024 sc1
MAV 44,60,120
TR 14,7,608
s_xor_b32 s53, s54, 3014656
MAV 44,44,112
TR 28,7,1120
TR 30,7,1632
s_waitcnt vmcnt(8) lgkmcnt(8)
MAV 32,0,64
TR 32,7,8320
MAV 32,16,72
buffer_load_dwordx4 v[112:115], v4, s[16:19], s52 offen sc1
MAV 48,16,76
TR 34,7,8832
MAV 48,0,68
TR 48,7,9344
TR 50,7,9856
MAV 52,4,68
TR 36,7,8352
MAV 52,20,76
buffer_load_dwordx4 v[116:119], v4, s[16:19], s52 offen offset:1024 sc1
MAV 36,20,72
TR 38,7,8864
s_xor_b32 s52, s54, 3145728
MAV 36,4,64
TR 52,7,9376
TR 54,7,9888
s_waitcnt lgkmcnt(8)
MAV 40,8,64
TR 40,7,8384
MAV 40,24,72
buffer_load_dwordx4 v[120:123], v4, s[16:19], s53 offen sc1
MAV 56,24,76
TR 42,7,8896
MAV 56,8,68
TR 56,7,9408
TR 58,7,9920
MAV 60,12,68
TR 44,7,8416
MAV 60,28,76
buffer_load_dwordx4 v[124:127], v4, s[16:19], s53 offen offset:1024 sc1
MAV 44,28,72
TR 46,7,8928
s_xor_b32 s53, s54, 3276800
MAV 44,12,64
TR 60,7,9440
TR 62,7,9952
s_waitcnt vmcnt(8) lgkmcnt(8)
MAV 32,32,80
TR 0,7,16640
MAV 32,48,88
buffer_load_dwordx4 v[64:67], v4, s[16:19], s52 offen sc1
MAV 48,48,92
TR 2,7,17152
MAV 48,32,84
TR 16,7,17664
TR 18,7,18176
MAV 52,36,84
TR 4,7,16672
MAV 52,52,92
buffer_load_dwordx4 v[68:71], v4, s[16:19], s52 offen offset:1024 sc1
MAV 36,52,88
TR 6,7,17184
s_xor_b32 s52, s54, 3407872
MAV 36,36,80
TR 20,7,17696
TR 22,7,18208
s_waitcnt lgkmcnt(8)
MAV 40,40,80
TR 8,7,16704
MAV 40,56,88
buffer_load_dwordx4 v[72:75], v4, s[16:19], s53 offen sc1
MAV 56,56,92
TR 10,7,17216
MAV 56,40,84
TR 24,7,17728
TR 26,7,18240
MAV 60,44,84
TR 12,7,16736
MAV 60,60,92
buffer_load_dwordx4 v[76:79], v4, s[16:19], s53 offen offset:1024 sc1
MAV 44,60,88
TR 14,7,17248
s_xor_b32 s53, s54, 3538944
MAV 44,44,80
TR 28,7,17760
TR 30,7,18272
s_waitcnt vmcnt(8) lgkmcnt(8)
MAV 32,0,96
TR 32,7,24960
MAV 32,16,104
buffer_load_dwordx4 v[80:83], v4, s[16:19], s52 offen sc1
MAV 48,16,108
TR 34,7,25472
MAV 48,0,100
TR 48,7,25984
TR 50,7,26496
MAV 52,4,100
TR 36,7,24992
MAV 52,20,108
buffer_load_dwordx4 v[84:87], v4, s[16:19], s52 offen offset:1024 sc1
MAV 36,20,104
TR 38,7,25504
s_xor_b32 s52, s54, 3670016
MAV 36,4,96
TR 52,7,26016
TR 54,7,26528
s_waitcnt lgkmcnt(8)
MAV 40,8,96
TR 40,7,25024
MAV 40,24,104
buffer_load_dwordx4 v[88:91], v4, s[16:19], s53 offen sc1
MAV 56,24,108
TR 42,7,25536
MAV 56,8,100
TR 56,7,26048
TR 58,7,26560
MAV 60,12,100
TR 44,7,25056
MAV 60,28,108
buffer_load_dwordx4 v[92:95], v4, s[16:19], s53 offen offset:1024 sc1
MAV 44,28,104
TR 46,7,25568
s_xor_b32 s53, s54, 3801088
MAV 44,12,96
TR 60,7,26080
TR 62,7,26592
s_waitcnt vmcnt(8) lgkmcnt(8)
MAV 32,32,112
TR 0,7,33280
MAV 32,48,120
buffer_load_dwordx4 v[96:99], v4, s[16:19], s52 offen sc1
MAV 48,48,124
TR 2,7,33792
MAV 48,32,116
TR 16,7,34304
TR 18,7,34816
MAV 52,36,116
TR 4,7,33312
MAV 52,52,124
buffer_load_dwordx4 v[100:103], v4, s[16:19], s52 offen offset:1024 sc1
MAV 36,52,120
TR 6,7,33824
s_xor_b32 s52, s54, 3932160
MAV 36,36,112
TR 20,7,34336
.Lpad29:
s_cbranch_execz .Lpad32
TR 22,7,34848
s_waitcnt lgkmcnt(8)
MAV 40,40,112
TR 8,7,33344
MAV 40,56,120
buffer_load_dwordx4 v[104:107], v4, s[16:19], s53 offen sc1
MAV 56,56,124
TR 10,7,33856
MAV 56,40,116
TR 24,7,34368
TR 26,7,34880
MAV 60,44,116
TR 12,7,33376
MAV 60,60,124
buffer_load_dwordx4 v[108:111], v4, s[16:19], s53 offen offset:1024 sc1
MAV 44,60,120
TR 14,7,33888
s_xor_b32 s53, s54, 4063232
MAV 44,44,112
TR 28,7,34400
TR 30,7,34912
s_waitcnt vmcnt(8) lgkmcnt(8)
MAV 32,0,64
TR 32,7,41600
MAV 32,16,72
buffer_load_dwordx4 v[112:115], v4, s[16:19], s52 offen sc1
MAV 48,16,76
TR 34,7,42112
MAV 48,0,68
TR 48,7,42624
TR 50,7,43136
MAV 52,4,68
TR 36,7,41632
MAV 52,20,76
buffer_load_dwordx4 v[116:119], v4, s[16:19], s52 offen offset:1024 sc1
MAV 36,20,72
TR 38,7,42144
MAV 36,4,64
TR 52,7,42656
TR 54,7,43168
s_waitcnt lgkmcnt(8)
MAV 40,8,64
TR 40,7,41664
MAV 40,24,72
buffer_load_dwordx4 v[120:123], v4, s[16:19], s53 offen sc1
MAV 56,24,76
TR 42,7,42176
MAV 56,8,68
TR 56,7,42688
TR 58,7,43200
MAV 60,12,68
TR 44,7,41696
MAV 60,28,76
buffer_load_dwordx4 v[124:127], v4, s[16:19], s53 offen offset:1024 sc1
MAV 44,28,72
TR 46,7,42208
MAV 44,12,64
TR 60,7,42720
TR 62,7,43232
s_barrier
s_waitcnt vmcnt(8) lgkmcnt(8)
MAV 32,32,80
TR 0,7,49920
s_add_u32 m0, s59, 84480
MAV 32,48,88
buffer_load_dwordx4 v12, s[32:35], s58 offen lds
MAV 48,48,92
TR 2,7,50432
MAV 48,32,84
TR 16,7,50944
TR 18,7,51456
MAV 52,36,84
TR 4,7,49952
MAV 52,52,92
TR 6,7,50464
TR 20,7,50976
MAV 36,52,88
TR 22,7,51488
MAV 36,36,80
TR 8,7,49984
s_waitcnt lgkmcnt(9)
MAV 40,40,80
TR 10,7,50496
MAV 40,56,88
buffer_load_dwordx4 v13, s[32:35], s58 offen offset:1056 lds
MAV 56,56,92
TR 24,7,51008
MAV 56,40,84
buffer_load_dwordx4 v14, s[32:35], s58 offen offset:2112 lds
MAV 60,44,84
TR 26,7,51520
MAV 60,60,92
TR 12,7,50016
TR 14,7,50528
MAV 44,60,88
TR 28,7,51040
MAV 44,44,80
TR 30,7,51552
s_waitcnt vmcnt(7) lgkmcnt(8)
MAV 32,0,96
TR 32,7,58240
MAV 32,16,104
buffer_load_dwordx4 v15, s[32:35], s58 offen offset:3168 lds
MAV 48,16,108
TR 34,7,58752
MAV 48,0,100
TR 48,7,59264
TR 50,7,59776
MAV 52,4,100
TR 36,7,58272
MAV 52,20,108
TR 38,7,58784
TR 52,7,59296
MAV 36,20,104
TR 54,7,59808
MAV 36,4,96
TR 40,7,58304
s_waitcnt lgkmcnt(9)
MAV 40,8,96
TR 42,7,58816
s_add_u32 m0, s59, 101376
MAV 40,24,104
buffer_load_dwordx4 v12, s[80:83], s58 offen lds
MAV 56,24,108
TR 56,7,59328
MAV 56,8,100
buffer_load_dwordx4 v13, s[80:83], s58 offen offset:1056 lds
MAV 60,12,100
TR 58,7,59840
MAV 60,28,108
TR 44,7,58336
TR 46,7,58848
MAV 44,28,104
TR 60,7,59360
MAV 44,12,96
TR 62,7,59872
s_waitcnt vmcnt(9) lgkmcnt(14)
MAV 32,32,112
buffer_load_dwordx4 v14, s[80:83], s58 offen offset:2112 lds
s_waitcnt vmcnt(8) lgkmcnt(12)
MAV 32,48,120
s_lshl_b32 s64, s6, 14
s_lshl_b32 s65, s49, 13
s_add_u32 s64, s64, s65
s_waitcnt vmcnt(7)
MAV 48,48,124
s_lshl_b32 s65, s7, 9
s_add_u32 s64, s64, s65
s_lshl_b32 s65, s48, 8
MAV 48,32,116
s_add_u32 s64, s64, s65
s_add_u32 s64, s64, 63176704
v_and_b32 v152, 31, v1
s_waitcnt lgkmcnt(10)
MAV 52,36,116
buffer_load_dwordx4 v15, s[80:83], s58 offen offset:3168 lds
s_waitcnt lgkmcnt(8)
MAV 52,52,124
s_add_u32 s58, s58, 458752
v_lshlrev_b32 v152, 3, v152
v_lshrrev_b32 v153, 5, v1
MAV 36,52,120
s_lshl_b32 s62, s7, 18
v_lshl_add_u32 v152, v153, 28, v152
s_add_u32 s62, s62, 41943040
MAV 36,36,112
s_add_u32 s63, s62, 131072
v_cvt_pk_bf16_f32 v128, v32, v33
v_cvt_pk_bf16_f32 v129, v34, v35
s_waitcnt lgkmcnt(6)
MAV 40,40,112
v_cvt_pk_bf16_f32 v136, v48, v49
v_cvt_pk_bf16_f32 v137, v50, v51
s_waitcnt lgkmcnt(4)
MAV 40,56,120
v_cvt_pk_bf16_f32 v130, v36, v37
v_cvt_pk_bf16_f32 v131, v38, v39
MAV 56,56,124
buffer_store_dwordx4 v[128:131], v4, s[16:19], s62 offen sc1
MAV 56,40,116
v_cvt_pk_bf16_f32 v138, v52, v53
v_cvt_pk_bf16_f32 v139, v54, v55
s_waitcnt lgkmcnt(2)
MAV 60,44,116
v_cvt_pk_bf16_f32 v132, v40, v41
v_cvt_pk_bf16_f32 v133, v42, v43
s_waitcnt lgkmcnt(0)
MAV 60,60,124
v_cvt_pk_bf16_f32 v140, v56, v57
MAV 44,60,120
buffer_store_dwordx4 v[136:139], v4, s[16:19], s62 offen offset:1024 sc1
MAV 44,44,112
v_cvt_pk_bf16_f32 v141, v58, v59
s_nop 2
v_cvt_pk_bf16_f32 v142, v60, v61
v_pk_mul_f32 v[146:147], v[32:33], v[32:33]
v_pk_mul_f32 v[150:151], v[48:49], v[48:49]
v_cvt_pk_bf16_f32 v143, v62, v63
v_pk_fma_f32 v[146:147], v[34:35], v[34:35], v[146:147]
v_pk_add_f32 v[144:145], v[32:33], v[34:35]
v_pk_fma_f32 v[150:151], v[50:51], v[50:51], v[150:151]
v_cvt_pk_bf16_f32 v134, v44, v45
v_cvt_pk_bf16_f32 v135, v46, v47
buffer_store_dwordx4 v[132:135], v4, s[16:19], s63 offen sc1
v_pk_add_f32 v[148:149], v[48:49], v[50:51]
v_pk_fma_f32 v[146:147], v[36:37], v[36:37], v[146:147]
v_pk_add_f32 v[144:145], v[144:145], v[36:37]
v_pk_fma_f32 v[150:151], v[52:53], v[52:53], v[150:151]
v_pk_add_f32 v[148:149], v[148:149], v[52:53]
v_pk_fma_f32 v[146:147], v[38:39], v[38:39], v[146:147]
v_pk_add_f32 v[144:145], v[144:145], v[38:39]
v_pk_fma_f32 v[150:151], v[54:55], v[54:55], v[150:151]
v_pk_add_f32 v[148:149], v[148:149], v[54:55]
v_pk_fma_f32 v[146:147], v[40:41], v[40:41], v[146:147]
v_pk_add_f32 v[144:145], v[144:145], v[40:41]
v_pk_fma_f32 v[150:151], v[56:57], v[56:57], v[150:151]
v_pk_add_f32 v[148:149], v[148:149], v[56:57]
buffer_store_dwordx4 v[140:143], v4, s[16:19], s63 offen offset:1024 sc1
v_pk_fma_f32 v[146:147], v[42:43], v[42:43], v[146:147]
v_pk_add_f32 v[144:145], v[144:145], v[42:43]
v_pk_fma_f32 v[150:151], v[58:59], v[58:59], v[150:151]
v_pk_add_f32 v[148:149], v[148:149], v[58:59]
v_pk_fma_f32 v[146:147], v[44:45], v[44:45], v[146:147]
v_pk_add_f32 v[144:145], v[144:145], v[44:45]
v_pk_fma_f32 v[150:151], v[60:61], v[60:61], v[150:151]
v_pk_add_f32 v[148:149], v[148:149], v[60:61]
v_pk_fma_f32 v[146:147], v[46:47], v[46:47], v[146:147]
v_pk_add_f32 v[144:145], v[144:145], v[46:47]
v_pk_fma_f32 v[150:151], v[62:63], v[62:63], v[150:151]
v_pk_add_f32 v[148:149], v[148:149], v[62:63]
v_add_f32 v144, v144, v145
v_add_f32 v146, v146, v147
v_add_f32 v148, v148, v149
v_add_f32 v150, v150, v151
s_nop 0
v_permlane16_swap_b32 v144, v148
v_permlane16_swap_b32 v146, v150
v_add_f32 v144, v144, v148
v_add_f32 v146, v146, v150
s_nop 1
v_permlane32_swap_b32 v144, v146
v_add_f32 v144, v144, v146
s_nop 1
v_permlane32_swap_b32 v144, v145
buffer_store_dwordx2 v[144:145], v152, s[16:19], s64 offen sc1
s_nop 1
s_mov_b32 s54, s58
s_mov_b32 s55, s59
v_accvgpr_write_b32 a224, v32
v_accvgpr_write_b32 a225, v33
v_accvgpr_write_b32 a226, v34
v_accvgpr_write_b32 a227, v35
v_accvgpr_write_b32 a228, v36
v_accvgpr_write_b32 a229, v37
v_accvgpr_write_b32 a230, v38
v_accvgpr_write_b32 a231, v39
v_accvgpr_write_b32 a232, v40
v_accvgpr_write_b32 a233, v41
v_accvgpr_write_b32 a234, v42
v_accvgpr_write_b32 a235, v43
v_accvgpr_write_b32 a236, v44
v_accvgpr_write_b32 a237, v45
v_accvgpr_write_b32 a238, v46
v_accvgpr_write_b32 a239, v47
v_accvgpr_write_b32 a240, v48
v_accvgpr_write_b32 a241, v49
v_accvgpr_write_b32 a242, v50
v_accvgpr_write_b32 a243, v51
v_accvgpr_write_b32 a244, v52
v_accvgpr_write_b32 a245, v53
v_accvgpr_write_b32 a246, v54
v_accvgpr_write_b32 a247, v55
v_accvgpr_write_b32 a248, v56
v_accvgpr_write_b32 a249, v57
v_accvgpr_write_b32 a250, v58
v_accvgpr_write_b32 a251, v59
v_accvgpr_write_b32 a252, v60
v_accvgpr_write_b32 a253, v61
v_accvgpr_write_b32 a254, v62
v_accvgpr_write_b32 a255, v63
s_lshl_b32 s62, s10, 14
s_lshl_b32 s63, s3, 12
s_add_u32 s62, s62, s63
s_lshl_b32 s63, s12, 11
s_add_u32 s62, s62, s63
v_lshl_add_u32 v10, v1, 4, s62
v_lshrrev_b32 v2, 3, v1
v_cmp_eq_u32 vcc, 3, v2
v_add_u32 v2, 67108480, v10
s_nop 0
v_cndmask_b32 v10, v10, v2, vcc
v_xor_b32 v11, 2048, v10
v_bfe_u32 v16, v1, 2, 3
v_mul_u32_u24 v16, 1056, v16
v_bfe_u32 v2, v1, 5, 1
v_lshl_add_u32 v16, v2, 8, v16
v_and_b32 v2, 3, v1
v_lshl_add_u32 v16, v2, 3, v16
s_lshl_b32 s62, s12, 6
s_add_u32 s62, s62, 84480
s_xor_b32 s63, s12, 1
s_mul_i32 s63, s63, 192
s_add_u32 s63, s63, 84480
v_add_u32 v17, s63, v16
v_add_u32 v16, s62, v16
s_mov_b32 s52, 41943040
s_mov_b32 s53, 41943040
s_mul_i32 s59, s3, 2112
s_and_b32 s62, s7, 1
s_mul_i32 s62, s62, 3670016
s_lshr_b32 s63, s7, 1
s_lshl_b32 s63, s63, 8
s_add_u32 s62, s62, s63
s_lshl_b32 s63, s3, 12
s_add_u32 s62, s62, s63
v_lshrrev_b32 v5, 4, v1
v_lshlrev_b32 v5, 14, v5
v_and_b32 v2, 15, v1
v_lshl_add_u32 v5, v2, 4, v5
v_add_u32 v5, s62, v5
v_add_u32 v6, 992, v5
s_lshl_b32 s62, s10, 15
s_lshl_b32 s63, s3, 13
s_add_u32 s62, s62, s63
v_lshl_add_u32 v4, v1, 4, s62
s_lshl_b32 s62, s6, 10
s_add_u32 s62, s62, 30507008
s_lshl_b32 s64, s10, 1
s_lshl_b32 s64, s64, 10
s_add_u32 s64, s64, 30507008
s_lshr_b32 s67, s5, 2
s_and_b32 s67, s67, 3
s_lshl_b32 s67, s67, 7
s_add_u32 s64, s64, s67
s_add_u32 s65, s64, 1024
v_lshl_add_u32 v252, v1, 7, s62
v_mov_b32 v253, s64
v_mov_b32 v255, 1
v_writelane_b32 v253, s65, 1
s_waitcnt vmcnt(0) lgkmcnt(0)
s_cmp_lg_u32 s3, 1
s_barrier
s_cbranch_scc1 .Lfirst64
s_mov_b64 exec, 15
buffer_atomic_add v255, v252, s[16:19], 0 offen
s_mov_b64 exec, 3
v_mov_b32 v254, 0
buffer_atomic_add v254, v253, s[16:19], 0 offen sc0
s_mov_b64 exec, -1
.Lfirst64:
s_add_u32 m0, s55, 118272
s_nop 0
buffer_load_dwordx4 v12, s[32:35], s54 offen lds
buffer_load_dwordx4 v13, s[32:35], s54 offen offset:1056 lds
buffer_load_dwordx4 v14, s[32:35], s54 offen offset:2112 lds
buffer_load_dwordx4 v15, s[32:35], s54 offen offset:3168 lds
s_add_u32 m0, s55, 135168
s_nop 0
buffer_load_dwordx4 v12, s[80:83], s54 offen lds
buffer_load_dwordx4 v13, s[80:83], s54 offen offset:1056 lds
buffer_load_dwordx4 v14, s[80:83], s54 offen offset:2112 lds
buffer_load_dwordx4 v15, s[80:83], s54 offen offset:3168 lds
s_add_u32 s54, s54, 458752
s_cmp_lg_u32 s3, 1
s_cbranch_scc1 .Lnopoll63
s_mov_b64 exec, 3
s_mov_b32 s15, 0
v_mov_b32 v255, 0
buffer_atomic_add v255, v253, s[16:19], 0 offen sc0
s_waitcnt vmcnt(9)
v_cmp_gt_u32 vcc, 16, v254
s_nop 0
s_cbranch_vccz .Lnopoll63r
.Lpoll62:
s_waitcnt vmcnt(0)
v_cmp_gt_u32 vcc, 16, v255
s_add_u32 s15, s15, 1
s_cbranch_vccz .Lnopoll63r
v_mov_b32 v255, 0
buffer_atomic_add v255, v253, s[16:19], 0 offen sc0
s_cmp_le_u32 s15, 100000
s_cbranch_scc1 .Lpoll62
s_branch .Lnopoll63r
.Lnopoll63:
s_mov_b64 exec, 0
s_cmp_eq_u32 s3, 2
s_cbranch_scc1 .Lpad34
s_cmp_eq_u32 s3, 3
s_cbranch_scc1 .Lpad35
s_branch .Lpad36
.Lnopoll63r:
s_mov_b64 exec, -1
s_waitcnt vmcnt(9)
s_barrier
buffer_load_dwordx4 a[128:131], v10, s[16:19], s52 offen sc1
buffer_load_dwordx4 a[132:135], v10, s[16:19], s52 offen offset:1024 sc1
s_add_u32 s52, s52, 131072
buffer_load_dwordx4 a[144:147], v10, s[16:19], s52 offen sc1
buffer_load_dwordx4 a[148:151], v10, s[16:19], s52 offen offset:1024 sc1
s_add_u32 s52, s52, 131072
buffer_load_dwordx4 a[136:139], v11, s[16:19], s53 offen sc1
buffer_load_dwordx4 a[140:143], v11, s[16:19], s53 offen offset:1024 sc1
s_add_u32 s53, s53, 131072
buffer_load_dwordx4 a[152:155], v11, s[16:19], s53 offen sc1
buffer_load_dwordx4 a[156:159], v11, s[16:19], s53 offen offset:1024 sc1
s_add_u32 s53, s53, 131072
ds_read_b64_tr_b16 a[0:1], v16
TR 2,16,512
TR 4,16,8448
TR 6,16,8960
TR 8,16,32
TR 10,16,544
TR 12,16,8480
TR 14,16,8992
TR 16,16,64
TR 18,16,576
TR 20,16,8512
TR 22,16,9024
TR 24,16,96
TR 26,16,608
TR 28,16,8544
TR 30,16,9056
TR 32,16,128
TR 34,16,640
TR 36,16,8576
TR 38,16,9088
TR 40,16,160
TR 42,16,672
TR 44,16,8608
TR 46,16,9120
ds_read_b64_tr_b16 a[48:49], v17
TR 50,17,512
TR 52,17,8448
TR 54,17,8960
TR 56,17,32
TR 58,17,544
TR 60,17,8480
TR 62,17,8992
s_lshl_b32 s57, s3, 13
s_add_u32 s57, s57, 49920
v_lshl_add_u32 v2, v1, 4, s57
s_waitcnt lgkmcnt(0)
s_barrier
s_waitcnt vmcnt(7)
v_mfma_f32_16x16x32_bf16 v[32:35], a[0:3], a[128:131], 0
buffer_load_dwordx4 a[160:163], v10, s[16:19], s52 offen sc1
s_waitcnt vmcnt(6)
MAA 32,4,144
TR 64,16,16896
v_mfma_f32_16x16x32_bf16 v[36:39], a[0:3], a[132:135], 0
TR 66,16,17408
s_waitcnt vmcnt(5)
MAA 36,4,148
TR 68,16,25344
v_mfma_f32_16x16x32_bf16 v[52:55], a[8:11], a[132:135], 0
buffer_load_dwordx4 a[164:167], v10, s[16:19], s52 offen offset:1024 sc1
MAA 52,12,148
TR 70,16,25856
s_add_u32 s52, s52, 131072
v_mfma_f32_16x16x32_bf16 v[48:51], a[8:11], a[128:131], 0
TR 72,16,16928
MAA 48,12,144
TR 74,16,17440
v_mfma_f32_16x16x32_bf16 v[96:99], a[16:19], a[128:131], 0
buffer_load_dwordx4 a[176:179], v10, s[16:19], s52 offen sc1
MAA 96,20,144
TR 76,16,25376
v_mfma_f32_16x16x32_bf16 v[100:103], a[16:19], a[132:135], 0
TR 78,16,25888
MAA 100,20,148
TR 80,16,16960
v_mfma_f32_16x16x32_bf16 v[116:119], a[24:27], a[132:135], 0
buffer_load_dwordx4 a[180:183], v10, s[16:19], s52 offen offset:1024 sc1
MAA 116,28,148
TR 82,16,17472
s_add_u32 s52, s52, 131072
v_mfma_f32_16x16x32_bf16 v[112:115], a[24:27], a[128:131], 0
TR 84,16,25408
MAA 112,28,144
TR 86,16,25920
v_mfma_f32_16x16x32_bf16 v[160:163], a[32:35], a[128:131], 0
buffer_load_dwordx4 a[168:171], v11, s[16:19], s53 offen sc1
MAA 160,36,144
TR 88,16,16992
v_mfma_f32_16x16x32_bf16 v[164:167], a[32:35], a[132:135], 0
TR 90,16,17504
MAA 164,36,148
TR 92,16,25440
v_mfma_f32_16x16x32_bf16 v[180:183], a[40:43], a[132:135], 0
buffer_load_dwordx4 a[172:175], v11, s[16:19], s53 offen offset:1024 sc1
MAA 180,44,148
TR 94,16,25952
s_add_u32 s53, s53, 131072
v_mfma_f32_16x16x32_bf16 v[176:179], a[40:43], a[128:131], 0
TR 96,16,17024
MAA 176,44,144
TR 98,16,17536
v_mfma_f32_16x16x32_bf16 v[224:227], a[48:51], a[128:131], 0
buffer_load_dwordx4 a[184:187], v11, s[16:19], s53 offen sc1
MAA 224,52,144
TR 100,16,25472
v_mfma_f32_16x16x32_bf16 v[228:231], a[48:51], a[132:135], 0
TR 102,16,25984
MAA 228,52,148
TR 104,16,17056
v_mfma_f32_16x16x32_bf16 v[236:239], a[56:59], a[132:135], 0
buffer_load_dwordx4 a[188:191], v11, s[16:19], s53 offen offset:1024 sc1
MAA 236,60,148
TR 106,16,17568
s_add_u32 s53, s53, 131072
v_mfma_f32_16x16x32_bf16 v[232:235], a[56:59], a[128:131], 0
TR 108,16,25504
s_add_u32 m0, s55, 84480
MAA 232,60,144
TR 110,16,26016
s_waitcnt vmcnt(8)
v_mfma_f32_16x16x32_bf16 v[188:191], a[40:43], a[140:143], 0
buffer_load_dwordx4 v12, s[32:35], s54 offen lds
MAA 188,44,156
TR 112,17,16896
v_mfma_f32_16x16x32_bf16 v[184:187], a[40:43], a[136:139], 0
TR 114,17,17408
MAA 184,44,152
TR 116,17,25344
v_mfma_f32_16x16x32_bf16 v[168:171], a[32:35], a[136:139], 0
buffer_load_dwordx4 v13, s[32:35], s54 offen offset:1056 lds
MAA 168,36,152
TR 118,17,25856
v_mfma_f32_16x16x32_bf16 v[172:175], a[32:35], a[140:143], 0
TR 120,17,16928
MAA 172,36,156
TR 122,17,17440
v_mfma_f32_16x16x32_bf16 v[124:127], a[24:27], a[140:143], 0
buffer_load_dwordx4 v14, s[32:35], s54 offen offset:2112 lds
MAA 124,28,156
TR 124,17,25376
v_mfma_f32_16x16x32_bf16 v[120:123], a[24:27], a[136:139], 0
TR 126,17,25888
MAA 120,28,152
v_mfma_f32_16x16x32_bf16 v[104:107], a[16:19], a[136:139], 0
buffer_load_dwordx4 v15, s[32:35], s54 offen offset:3168 lds
MAA 104,20,152
v_mfma_f32_16x16x32_bf16 v[108:111], a[16:19], a[140:143], 0
MAA 108,20,156
v_mfma_f32_16x16x32_bf16 v[60:63], a[8:11], a[140:143], 0
MAA 60,12,156
v_mfma_f32_16x16x32_bf16 v[56:59], a[8:11], a[136:139], 0
MAA 56,12,152
v_mfma_f32_16x16x32_bf16 v[40:43], a[0:3], a[136:139], 0
MAA 40,4,152
v_mfma_f32_16x16x32_bf16 v[44:47], a[0:3], a[140:143], 0
MAA 44,4,156
s_waitcnt lgkmcnt(0)
s_barrier
v_mfma_f32_16x16x32_bf16 v[64:67], a[64:67], a[128:131], 0
TR 0,16,33792
s_add_u32 m0, s55, 101376
MAA 64,68,144
buffer_load_dwordx4 v12, s[80:83], s54 offen lds
v_mfma_f32_16x16x32_bf16 v[68:71], a[64:67], a[132:135], 0
TR 2,16,34304
s_mul_i32 s66, s13, 114688
MAA 68,68,148
TR 4,16,42240
s_mul_i32 s65, s10, 1818624
v_mfma_f32_16x16x32_bf16 v[84:87], a[72:75], a[132:135], 0
TR 6,16,42752
s_add_u32 s66, s66, s65
MAA 84,76,148
TR 8,16,33824
s_add_u32 s66, s66, 46137344
v_mfma_f32_16x16x32_bf16 v[80:83], a[72:75], a[128:131], 0
buffer_load_dwordx4 v13, s[80:83], s54 offen offset:1056 lds
MAA 80,76,144
TR 10,16,34336
s_add_u32 s65, s66, 49152
v_mfma_f32_16x16x32_bf16 v[128:131], a[80:83], a[128:131], 0
TR 12,16,42272
s_lshl_b32 s62, s12, 16
.Lpad30:
s_cbranch_execz .Lpad33
MAA 128,84,144
TR 14,16,42784
s_add_u32 s62, s62, s66
v_mfma_f32_16x16x32_bf16 v[132:135], a[80:83], a[132:135], 0
TR 16,16,33856
s_add_u32 s63, s62, 16384
MAA 132,84,148
buffer_load_dwordx4 v14, s[80:83], s54 offen offset:2112 lds
v_mfma_f32_16x16x32_bf16 v[148:151], a[88:91], a[132:135], 0
TR 18,16,34368
s_add_u32 s64, s62, 32768
MAA 148,92,148
TR 20,16,42304
s_lshl_b32 s72, s10, 1
v_mfma_f32_16x16x32_bf16 v[144:147], a[88:91], a[128:131], 0
TR 22,16,42816
s_lshr_b32 s74, s11, 4
MAA 144,92,144
TR 24,16,33888
s_add_u32 s72, s72, s74
v_mfma_f32_16x16x32_bf16 v[192:195], a[96:99], a[128:131], 0
buffer_load_dwordx4 v15, s[80:83], s54 offen offset:3168 lds
MAA 192,100,144
TR 26,16,34400
s_add_u32 s54, s54, 458752
v_mfma_f32_16x16x32_bf16 v[196:199], a[96:99], a[132:135], 0
TR 28,16,42336
s_add_u32 m0, s57, 0
MAA 196,100,148
TR 30,16,42848
s_mov_b32 s58, 63176704
v_mfma_f32_16x16x32_bf16 v[212:215], a[104:107], a[132:135], 0
TR 32,16,33920
s_lshl_b32 s72, s72, 10
MAA 212,108,148
buffer_load_dwordx4 v4, s[16:19], s58 offen sc1 lds
v_mfma_f32_16x16x32_bf16 v[208:211], a[104:107], a[128:131], 0
TR 34,16,34432
s_add_u32 s72, s72, 30523392
MAA 208,108,144
TR 36,16,42368
s_and_b32 s73, s6, 14
v_mfma_f32_16x16x32_bf16 v[240:243], a[112:115], a[128:131], 0
TR 38,16,42880
s_and_b32 s74, s7, 1
MAA 240,116,144
TR 40,16,33952
s_add_u32 s73, s73, s74
v_mfma_f32_16x16x32_bf16 v[244:247], a[112:115], a[132:135], 0
buffer_load_dwordx4 v4, s[16:19], s58 offen offset:1024 sc1 lds
MAA 244,116,148
TR 42,16,34464
s_lshl_b32 s73, s73, 10
v_mfma_f32_16x16x32_bf16 v[252:255], a[120:123], a[132:135], 0
TR 44,16,42400
s_add_u32 s73, s73, 30523392
MAA 252,124,148
TR 46,16,42912
s_lshr_b32 s67, s5, 2
v_mfma_f32_16x16x32_bf16 v[248:251], a[120:123], a[128:131], 0
TR 48,17,33792
s_and_b32 s67, s67, 3
MAA 248,124,144
buffer_load_dwordx4 a[128:131], v10, s[16:19], s52 offen sc1
v_mfma_f32_16x16x32_bf16 v[220:223], a[104:107], a[140:143], 0
TR 50,17,34304
s_lshl_b32 s67, s67, 7
MAA 220,108,156
TR 52,17,42240
s_add_u32 s73, s73, s67
v_mfma_f32_16x16x32_bf16 v[216:219], a[104:107], a[136:139], 0
TR 54,17,42752
MAA 216,108,152
TR 56,17,33824
v_mfma_f32_16x16x32_bf16 v[200:203], a[96:99], a[136:139], 0
buffer_load_dwordx4 a[132:135], v10, s[16:19], s52 offen offset:1024 sc1
MAA 200,100,152
TR 58,17,34336
s_add_u32 s52, s52, 131072
v_mfma_f32_16x16x32_bf16 v[204:207], a[96:99], a[140:143], 0
TR 60,17,42272
MAA 204,100,156
TR 62,17,42784
v_mfma_f32_16x16x32_bf16 v[156:159], a[88:91], a[140:143], 0
MAA 156,92,156
buffer_load_dwordx4 a[144:147], v10, s[16:19], s52 offen sc1
v_mfma_f32_16x16x32_bf16 v[152:155], a[88:91], a[136:139], 0
MAA 152,92,152
v_mfma_f32_16x16x32_bf16 v[136:139], a[80:83], a[136:139], 0
MAA 136,84,152
v_mfma_f32_16x16x32_bf16 v[140:143], a[80:83], a[140:143], 0
buffer_load_dwordx4 a[148:151], v10, s[16:19], s52 offen offset:1024 sc1
MAA 140,84,156
s_add_u32 s52, s52, 131072
v_mfma_f32_16x16x32_bf16 v[92:95], a[72:75], a[140:143], 0
MAA 92,76,156
v_mfma_f32_16x16x32_bf16 v[88:91], a[72:75], a[136:139], 0
MAA 88,76,152
v_mfma_f32_16x16x32_bf16 v[72:75], a[64:67], a[136:139], 0
MAA 72,68,152
v_mfma_f32_16x16x32_bf16 v[76:79], a[64:67], a[140:143], 0
MAA 76,68,156
s_waitcnt vmcnt(18) lgkmcnt(0)
s_barrier
MAA 32,0,160
buffer_load_dwordx4 a[136:139], v11, s[16:19], s53 offen sc1
MAA 32,4,176
TR 64,16,50688
s_and_b32 s74, s7, 1
MAA 36,4,180
TR 66,16,51200
s_mul_i32 s87, s74, 917504
MAA 36,0,164
TR 68,16,59136
s_lshr_b32 s75, s6, 1
MAA 52,8,164
TR 70,16,59648
s_mul_i32 s75, s75, 1818624
MAA 52,12,180
buffer_load_dwordx4 a[140:143], v11, s[16:19], s53 offen offset:1024 sc1
MAA 48,12,176
TR 72,16,50720
s_add_u32 s53, s53, 131072
MAA 48,8,160
TR 74,16,51232
s_add_u32 s87, s87, s75
MAA 96,16,160
TR 76,16,59168
s_add_u32 s87, s87, 46137344
MAA 96,20,176
TR 78,16,59680
s_and_b32 s74, s6, 3
MAA 100,20,180
buffer_load_dwordx4 a[152:155], v11, s[16:19], s53 offen sc1
MAA 100,16,164
TR 80,16,50752
s_xor_b32 s75, s74, 0
MAA 116,24,164
TR 82,16,51264
s_sub_u32 s75, s75, 0
MAA 116,28,180
TR 84,16,59200
s_mul_i32 s98, s75, 458752
MAA 112,28,176
TR 86,16,59712
s_mul_i32 s75, s75, 114688
MAA 112,24,160
buffer_load_dwordx4 a[156:159], v11, s[16:19], s53 offen offset:1024 sc1
MAA 160,32,160
TR 88,16,50784
s_add_u32 s53, s53, 131072
MAA 160,36,176
TR 90,16,51296
s_add_u32 m0, s55, 118272
MAA 164,36,180
TR 92,16,59232
s_add_u32 s76, s87, s75
MAA 164,32,164
TR 94,16,59744
s_xor_b32 s75, s74, 1
MAA 180,40,164
buffer_load_dwordx4 v12, s[32:35], s54 offen lds
MAA 180,44,180
TR 96,16,50816
s_sub_u32 s75, s75, 1
MAA 176,44,176
TR 98,16,51328
s_mul_i32 s99, s75, 458752
MAA 176,40,160
TR 100,16,59264
s_mul_i32 s75, s75, 114688
MAA 224,48,160
TR 102,16,59776
s_add_u32 s77, s87, s75
MAA 224,52,176
buffer_load_dwordx4 v13, s[32:35], s54 offen offset:1056 lds
MAA 228,52,180
TR 104,16,50848
s_xor_b32 s75, s74, 2
MAA 228,48,164
TR 106,16,51360
s_sub_u32 s75, s75, 2
MAA 236,56,164
TR 108,16,59296
s_mul_i32 s100, s75, 458752
MAA 236,60,180
TR 110,16,59808
s_mul_i32 s75, s75, 114688
MAA 232,60,176
buffer_load_dwordx4 v14, s[32:35], s54 offen offset:2112 lds
MAA 232,56,160
TR 112,17,50688
s_add_u32 s78, s87, s75
s_waitcnt vmcnt(21)
MAA 188,40,172
TR 114,17,51200
s_xor_b32 s75, s74, 3
MAA 188,44,188
TR 116,17,59136
MAA 184,44,184
TR 118,17,59648
MAA 184,40,168
buffer_load_dwordx4 v15, s[32:35], s54 offen offset:3168 lds
MAA 168,32,168
TR 120,17,50720
s_add_u32 m0, s57, 2048
MAA 168,36,184
TR 122,17,51232
s_mov_b32 s58, 63178752
MAA 172,36,188
TR 124,17,59168
MAA 172,32,172
TR 126,17,59680
MAA 124,24,172
buffer_load_dwordx4 v4, s[16:19], s58 offen sc1 lds
MAA 124,28,188
MAA 120,28,184
MAA 120,24,168
MAA 104,16,168
MAA 104,20,184
buffer_load_dwordx4 v4, s[16:19], s58 offen offset:1024 sc1 lds
MAA 108,20,188
MAA 108,16,172
MAA 60,8,172
MAA 60,12,188
MAA 56,12,184
MAA 56,8,168
MAA 40,0,168
MAA 40,4,184
MAA 44,4,188
MAA 44,0,172
s_waitcnt vmcnt(20) lgkmcnt(0)
s_barrier
MAA 64,64,160
ds_read_b64_tr_b16 a[0:1], v16
s_add_u32 m0, s55, 135168
MAA 64,68,176
buffer_load_dwordx4 v12, s[80:83], s54 offen lds
MAA 68,68,180
TR 2,16,512
s_sub_u32 s75, s75, 3
MAA 68,64,164
TR 4,16,8448
s_mul_i32 s101, s75, 458752
MAA 84,72,164
TR 6,16,8960
s_mul_i32 s75, s75, 114688
MAA 84,76,180
TR 8,16,32
s_add_u32 s79, s87, s75
MAA 80,76,176
buffer_load_dwordx4 v13, s[80:83], s54 offen offset:1056 lds
MAA 80,72,160
TR 10,16,544
s_and_b32 s87, s6, 3
MAA 128,80,160
TR 12,16,8480
s_mov_b32 s46, 0
MAA 128,84,176
TR 14,16,8992
s_lshl_b32 s74, s3, 10
MAA 132,84,180
TR 16,16,64
s_lshl_b32 s75, s12, 9
MAA 132,80,164
buffer_load_dwordx4 v14, s[80:83], s54 offen offset:2112 lds
MAA 148,88,164
TR 18,16,576
s_add_u32 s74, s74, s75
MAA 148,92,180
TR 20,16,8512
s_add_u32 s74, s74, 152576
MAA 144,92,176
TR 22,16,9024
v_and_b32 v18, 15, v1
MAA 144,88,160
TR 24,16,96
v_lshl_add_u32 v18, v18, 4, s74
MAA 192,96,160
buffer_load_dwordx4 v15, s[80:83], s54 offen offset:3168 lds
MAA 192,100,176
TR 26,16,608
s_add_u32 s54, s54, 458752
MAA 196,100,180
TR 28,16,8544
s_add_u32 m0, s57, 4096
MAA 196,96,164
TR 30,16,9056
s_mov_b32 s58, 63180800
MAA 212,104,164
TR 32,16,128
v_xor_b32 v19, 512, v18
MAA 212,108,180
buffer_load_dwordx4 v4, s[16:19], s58 offen sc1 lds
MAA 208,108,176
TR 34,16,640
s_lshl_b32 s74, s12, 7
MAA 208,104,160
TR 36,16,8576
s_add_u32 s74, s74, 161536
MAA 240,112,160
TR 38,16,9088
s_xor_b32 s75, s12, 1
MAA 240,116,176
TR 40,16,160
s_mul_i32 s75, s75, 384
MAA 244,116,180
buffer_load_dwordx4 v4, s[16:19], s58 offen offset:1024 sc1 lds
MAA 244,112,164
TR 42,16,672
s_add_u32 s75, s75, 161536
MAA 252,120,164
TR 44,16,8608
v_lshrrev_b32 v9, 4, v1
MAA 252,124,180
TR 46,16,9120
v_lshlrev_b32 v9, 4, v9
MAA 248,124,176
ds_read_b64_tr_b16 a[48:49], v17
v_add_u32 v8, s75, v9
MAA 248,120,160
buffer_load_dwordx4 a[160:163], v10, s[16:19], s52 offen sc1
MAA 220,104,172
TR 50,17,512
v_add_u32 v9, s74, v9
MAA 220,108,188
TR 52,17,8448
MAA 216,108,184
TR 54,17,8960
MAA 216,104,168
TR 56,17,32
MAA 200,96,168
buffer_load_dwordx4 a[164:167], v10, s[16:19], s52 offen offset:1024 sc1
MAA 200,100,184
TR 58,17,544
s_add_u32 s52, s52, 131072
MAA 204,100,188
TR 60,17,8480
MAA 204,96,172
TR 62,17,8992
MAA 156,88,172
MAA 156,92,188
buffer_load_dwordx4 a[176:179], v10, s[16:19], s52 offen sc1
MAA 152,92,184
MAA 152,88,168
MAA 136,80,168
MAA 136,84,184
MAA 140,84,188
buffer_load_dwordx4 a[180:183], v10, s[16:19], s52 offen offset:1024 sc1
MAA 140,80,172
s_add_u32 s52, s52, 131072
MAA 92,72,172
MAA 92,76,188
MAA 88,76,184
MAA 88,72,168
MAA 72,64,168
MAA 72,68,184
MAA 76,68,188
MAA 76,64,172
s_waitcnt vmcnt(20) lgkmcnt(0)
s_barrier
MAA 32,0,128
buffer_load_dwordx4 a[168:171], v11, s[16:19], s53 offen sc1
MAA 32,4,144
ds_read_b128 v[20:23], v2
MAA 36,4,148
ds_read_b128 v[28:31], v2 offset:1024
MAA 36,0,132
s_waitcnt vmcnt(11)
ds_read_b128 v[24:27], v2 offset:2048
MAA 52,8,132
TR 64,16,16896
MAA 52,12,148
buffer_load_dwordx4 a[172:175], v11, s[16:19], s53 offen offset:1024 sc1
MAA 48,12,144
TR 66,16,17408
s_add_u32 s53, s53, 131072
MAA 48,8,128
TR 68,16,25344
MAA 96,16,128
TR 70,16,25856
MAA 96,20,144
TR 72,16,16928
MAA 100,20,148
buffer_load_dwordx4 a[184:187], v11, s[16:19], s53 offen sc1
MAA 100,16,132
TR 74,16,17440
s_waitcnt lgkmcnt(7)
v_add_f32 v20, v20, v28
MAA 116,24,132
TR 76,16,25376
v_add_f32 v21, v21, v29
MAA 116,28,148
TR 78,16,25888
v_add_f32 v22, v22, v30
MAA 112,28,144
TR 80,16,16960
v_add_f32 v23, v23, v31
MAA 112,24,128
buffer_load_dwordx4 a[188:191], v11, s[16:19], s53 offen offset:1024 sc1
MAA 160,32,128
ds_read_b128 v[28:31], v2 offset:3072
s_add_u32 s53, s53, 131072
MAA 160,36,144
TR 82,16,17472
s_add_u32 m0, s55, 84480
MAA 164,36,148
TR 84,16,25408
s_waitcnt lgkmcnt(12)
v_add_f32 v20, v20, v24
MAA 164,32,132
TR 86,16,25920
v_add_f32 v21, v21, v25
MAA 180,40,132
buffer_load_dwordx4 v12, s[32:35], s54 offen lds
MAA 180,44,148
TR 88,16,16992
v_add_f32 v22, v22, v26
MAA 176,44,144
TR 90,16,17504
v_add_f32 v23, v23, v27
MAA 176,40,128
TR 92,16,25440
MAA 224,48,128
TR 94,16,25952
MAA 224,52,144
buffer_load_dwordx4 v13, s[32:35], s54 offen offset:1056 lds
MAA 228,52,148
TR 96,16,17024
MAA 228,48,132
TR 98,16,17536
MAA 236,56,132
TR 100,16,25472
MAA 236,60,148
TR 102,16,25984
MAA 232,60,144
buffer_load_dwordx4 v14, s[32:35], s54 offen offset:2112 lds
MAA 232,56,128
TR 104,16,17056
MAA 188,40,140
TR 106,16,17568
MAA 188,44,156
TR 108,16,25504
MAA 184,44,152
TR 110,16,26016
MAA 184,40,136
buffer_load_dwordx4 v15, s[32:35], s54 offen offset:3168 lds
MAA 168,32,136
TR 112,17,16896
s_add_u32 m0, s57, 6144
MAA 168,36,152
TR 114,17,17408
s_mov_b32 s58, 63182848
MAA 172,36,156
TR 116,17,25344
MAA 172,32,140
TR 118,17,25856
MAA 124,24,140
buffer_load_dwordx4 v4, s[16:19], s58 offen sc1 lds
MAA 124,28,156
TR 120,17,16928
MAA 120,28,152
TR 122,17,17440
MAA 120,24,136
TR 124,17,25376
MAA 104,16,136
TR 126,17,25888
MAA 104,20,152
buffer_load_dwordx4 v4, s[16:19], s58 offen offset:1024 sc1 lds
MAA 108,20,156
MAA 108,16,140
MAA 60,8,140
MAA 60,12,156
MAA 56,12,152
MAA 56,8,136
MAA 40,0,136
MAA 40,4,152
MAA 44,4,156
MAA 44,0,140
s_waitcnt lgkmcnt(0)
s_barrier
MAA 64,64,128
s_waitcnt vmcnt(14)
ds_read_b128 v[24:27], v2 offset:4096
s_add_u32 m0, s55, 101376
MAA 64,68,144
buffer_load_dwordx4 v12, s[80:83], s54 offen lds
MAA 68,68,148
TR 0,16,33792
v_add_f32 v20, v20, v28
MAA 68,64,132
TR 2,16,34304
v_add_f32 v21, v21, v29
MAA 84,72,132
TR 4,16,42240
v_add_f32 v22, v22, v30
MAA 84,76,148
TR 6,16,42752
v_add_f32 v23, v23, v31
MAA 80,76,144
ds_read_b128 v[28:31], v2 offset:5120
MAA 80,72,128
TR 8,16,33824
MAA 128,80,128
buffer_load_dwordx4 v13, s[80:83], s54 offen offset:1056 lds
MAA 128,84,144
TR 10,16,34336
s_waitcnt lgkmcnt(7)
v_add_f32 v20, v20, v24
MAA 132,84,148
TR 12,16,42272
v_add_f32 v21, v21, v25
MAA 132,80,132
TR 14,16,42784
v_add_f32 v22, v22, v26
MAA 148,88,132
TR 16,16,33856
v_add_f32 v23, v23, v27
MAA 148,92,148
TR 18,16,34368
MAA 144,92,144
TR 20,16,42304
MAA 144,88,128
buffer_load_dwordx4 v14, s[80:83], s54 offen offset:2112 lds
MAA 192,96,128
TR 22,16,42816
MAA 192,100,144
TR 24,16,33888
MAA 196,100,148
TR 26,16,34400
MAA 196,96,132
TR 28,16,42336
MAA 212,104,132
TR 30,16,42848
MAA 212,108,148
TR 32,16,33920
MAA 208,108,144
buffer_load_dwordx4 v15, s[80:83], s54 offen offset:3168 lds
MAA 208,104,128
TR 34,16,34432
s_add_u32 s54, s54, 458752
MAA 240,112,128
TR 36,16,42368
MAA 240,116,144
TR 38,16,42880
MAA 244,116,148
TR 40,16,33952
MAA 244,112,132
.Lpad31:
s_cbranch_execz .Lnopoll60r
TR 42,16,34464
MAA 252,120,132
TR 44,16,42400
MAA 252,124,148
TR 46,16,42912
MAA 248,124,144
TR 48,17,33792
MAA 248,120,128
buffer_load_dwordx4 a[128:131], v10, s[16:19], s52 offen sc1
MAA 220,104,140
TR 50,17,34304
MAA 220,108,156
TR 52,17,42240
MAA 216,108,152
TR 54,17,42752
MAA 216,104,136
TR 56,17,33824
MAA 200,96,136
TR 58,17,34336
MAA 200,100,152
TR 60,17,42272
MAA 204,100,156
buffer_load_dwordx4 a[132:135], v10, s[16:19], s52 offen offset:1024 sc1
MAA 204,96,140
TR 62,17,42784
s_add_u32 s52, s52, 131072
MAA 156,88,140
MAA 156,92,156
MAA 152,92,152
MAA 152,88,136
MAA 136,80,136
MAA 136,84,152
buffer_load_dwordx4 a[144:147], v10, s[16:19], s52 offen sc1
MAA 140,84,156
MAA 140,80,140
MAA 92,72,140
MAA 92,76,156
MAA 88,76,152
MAA 88,72,136
MAA 72,64,136
buffer_load_dwordx4 a[148:151], v10, s[16:19], s52 offen offset:1024 sc1
MAA 72,68,152
s_add_u32 s52, s52, 131072
MAA 76,68,156
MAA 76,64,140
s_waitcnt vmcnt(18) lgkmcnt(0)
s_barrier
MAA 32,0,160
buffer_load_dwordx4 a[136:139], v11, s[16:19], s53 offen sc1
MAA 32,4,176
s_waitcnt vmcnt(9)
ds_read_b128 v[24:27], v2 offset:6144
v_add_f32 v20, v20, v28
MAA 36,4,180
TR 64,16,50688
v_add_f32 v21, v21, v29
MAA 36,0,164
TR 66,16,51200
v_add_f32 v22, v22, v30
MAA 52,8,164
TR 68,16,59136
v_add_f32 v23, v23, v31
MAA 52,12,180
ds_read_b128 v[28:31], v2 offset:7168
MAA 48,12,176
TR 70,16,59648
MAA 48,8,160
buffer_load_dwordx4 a[140:143], v11, s[16:19], s53 offen offset:1024 sc1
MAA 96,16,160
TR 72,16,50720
s_add_u32 s53, s53, 131072
MAA 96,20,176
TR 74,16,51232
s_waitcnt lgkmcnt(7)
v_add_f32 v20, v20, v24
MAA 100,20,180
TR 76,16,59168
v_add_f32 v21, v21, v25
MAA 100,16,164
TR 78,16,59680
v_add_f32 v22, v22, v26
MAA 116,24,164
TR 80,16,50752
v_add_f32 v23, v23, v27
MAA 116,28,180
TR 82,16,51264
s_waitcnt lgkmcnt(7)
v_add_f32 v20, v20, v28
MAA 112,28,176
buffer_load_dwordx4 a[152:155], v11, s[16:19], s53 offen sc1
MAA 112,24,160
TR 84,16,59200
v_add_f32 v21, v21, v29
MAA 160,32,160
TR 86,16,59712
v_add_f32 v22, v22, v30
MAA 160,36,176
TR 88,16,50784
v_add_f32 v23, v23, v31
MAA 164,36,180
TR 90,16,51296
MAA 164,32,164
TR 92,16,59232
MAA 180,40,164
TR 94,16,59744
MAA 180,44,180
buffer_load_dwordx4 a[156:159], v11, s[16:19], s53 offen offset:1024 sc1
MAA 176,44,176
TR 96,16,50816
s_add_u32 s53, s53, 131072
MAA 176,40,160
TR 98,16,51328
s_add_u32 m0, s55, 118272
MAA 224,48,160
TR 100,16,59264
MAA 224,52,176
TR 102,16,59776
MAA 228,52,180
TR 104,16,50848
MAA 228,48,164
TR 106,16,51360
MAA 236,56,164
buffer_load_dwordx4 v12, s[32:35], s54 offen lds
MAA 236,60,180
TR 108,16,59296
MAA 232,60,176
TR 110,16,59808
MAA 232,56,160
TR 112,17,50688
MAA 188,40,172
TR 114,17,51200
MAA 188,44,188
TR 116,17,59136
MAA 184,44,184
TR 118,17,59648
MAA 184,40,168
buffer_load_dwordx4 v13, s[32:35], s54 offen offset:1056 lds
MAA 168,32,168
TR 120,17,50720
MAA 168,36,184
TR 122,17,51232
MAA 172,36,188
TR 124,17,59168
MAA 172,32,172
TR 126,17,59680
MAA 124,24,172
MAA 124,28,188
MAA 120,28,184
buffer_load_dwordx4 v14, s[32:35], s54 offen offset:2112 lds
MAA 120,24,168
MAA 104,16,168
MAA 104,20,184
MAA 108,20,188
MAA 108,16,172
MAA 60,8,172
MAA 60,12,188
buffer_load_dwordx4 v15, s[32:35], s54 offen offset:3168 lds
MAA 56,12,184
MAA 56,8,168
MAA 40,0,168
MAA 40,4,184
MAA 44,4,188
MAA 44,0,172
s_waitcnt lgkmcnt(0)
s_barrier
MAA 64,64,160
ds_read_b64_tr_b16 a[0:1], v16
s_add_u32 m0, s55, 135168
MAA 64,68,176
buffer_load_dwordx4 v12, s[80:83], s54 offen lds
MAA 68,68,180
TR 2,16,512
v_permlane32_swap_b32 v20, v22
MAA 68,64,164
TR 4,16,8448
v_permlane32_swap_b32 v21, v23
MAA 84,72,164
TR 6,16,8960
v_add_f32 v20, v20, v22
MAA 84,76,180
TR 8,16,32
v_add_f32 v21, v21, v23
MAA 80,76,176
TR 10,16,544
v_mul_f32 v20, 0xba800000, v20
MAA 80,72,160
buffer_load_dwordx4 v13, s[80:83], s54 offen offset:1056 lds
MAA 128,80,160
TR 12,16,8480
v_mul_f32 v21, 0x3a800000, v21
MAA 128,84,176
TR 14,16,8992
v_fma_f32 v21, -v20, v20, v21
MAA 132,84,180
TR 16,16,64
v_max_f32 v21, 0, v21
MAA 132,80,164
TR 18,16,576
v_add_f32 v21, 0x3727c5ac, v21
MAA 148,88,164
TR 20,16,8512
v_rsq_f32 v22, v21
MAA 148,92,180
buffer_load_dwordx4 v14, s[80:83], s54 offen offset:2112 lds
MAA 144,92,176
TR 22,16,9024
v_and_b32 v24, 31, v1
MAA 144,88,160
TR 24,16,96
v_lshrrev_b32 v25, 5, v1
MAA 192,96,160
TR 26,16,608
v_lshl_add_u32 v24, v24, 1, v25
MAA 192,100,176
TR 28,16,8544
v_and_b32 v25, 0xc0, v0
MAA 196,100,180
TR 30,16,9056
v_add_u32 v24, v24, v25
MAA 196,96,164
TR 32,16,128
v_lshlrev_b32 v24, 4, v24
MAA 212,104,164
buffer_load_dwordx4 v15, s[80:83], s54 offen offset:3168 lds
MAA 212,108,180
TR 34,16,640
s_add_u32 s54, s54, 458752
MAA 208,108,176
TR 36,16,8576
v_add_u32 v24, 152576, v24
MAA 208,104,160
TR 38,16,9088
v_mul_f32 v22, 0xbfb8aa3b, v22
MAA 240,112,160
ds_write_b128 v24, v[20:23]
s_mov_b32 s58, s98
MAA 240,116,176
ds_read_b64 v[20:21], v18
s_mov_b32 s67, s59
MAA 244,116,180
ds_read_b64 v[22:23], v18 offset:256
MAA 244,112,164
ds_read_b64 v[24:25], v19
MAA 252,120,164
ds_read_b64 v[26:27], v19 offset:256
MAA 252,124,180
ds_read_b32 a192, v18 offset:8
MAA 248,124,176
ds_read_b32 a193, v18 offset:264
v_mov_b32 v18, v5
MAA 248,120,160
buffer_load_dwordx4 a[160:163], v10, s[16:19], s52 offen sc1
MAA 220,104,172
ds_read_b32 a194, v19 offset:8
MAA 220,108,188
ds_read_b32 a195, v19 offset:264
v_add_u32 v19, 992, v5
MAA 216,108,184
TR 40,16,160
MAA 216,104,168
TR 42,16,672
MAA 200,96,168
TR 44,16,8608
MAA 200,100,184
TR 46,16,9120
MAA 204,100,188
buffer_load_dwordx4 a[164:167], v10, s[16:19], s52 offen offset:1024 sc1
MAA 204,96,172
ds_read_b64_tr_b16 a[48:49], v17
s_add_u32 s52, s52, 131072
MAA 156,88,172
TR 50,17,512
MAA 156,92,188
TR 52,17,8448
MAA 152,92,184
TR 54,17,8960
MAA 152,88,168
TR 56,17,32
MAA 136,80,168
TR 58,17,544
MAA 136,84,184
buffer_load_dwordx4 a[176:179], v10, s[16:19], s52 offen sc1
MAA 140,84,188
TR 60,17,8480
MAA 140,80,172
TR 62,17,8992
MAA 92,72,172
MAA 92,76,188
MAA 88,76,184
MAA 88,72,168
MAA 72,64,168
buffer_load_dwordx4 a[180:183], v10, s[16:19], s52 offen offset:1024 sc1
MAA 72,68,184
s_add_u32 s52, s52, 131072
MAA 76,68,188
MAA 76,64,172
s_waitcnt vmcnt(16) lgkmcnt(0)
s_barrier
MAA 32,0,128
ds_read_b128 v[28:31], v9 offset:512
MAA 32,4,144
ds_read_b128 v[4:7], v9 offset:576
MAA 36,4,148
buffer_load_dwordx4 a[168:171], v11, s[16:19], s53 offen sc1
MAA 36,0,132
TR 64,16,16896
MAA 52,8,132
TR 66,16,17408
MAA 52,12,148
TR 68,16,25344
MAA 48,12,144
TR 70,16,25856
MAA 48,8,128
TR 72,16,16928
MAA 96,16,128
buffer_load_dwordx4 a[172:175], v11, s[16:19], s53 offen offset:1024 sc1
MAA 96,20,144
TR 74,16,17440
s_add_u32 s53, s53, 131072
MAA 100,20,148
TR 76,16,25376
s_waitcnt lgkmcnt(8)
v_fmac_f32 v64, v28, v20
MAA 100,16,132
TR 78,16,25888
v_fmac_f32 v65, v29, v20
MAA 116,24,132
TR 80,16,16960
v_fmac_f32 v66, v30, v20
MAA 116,28,148
TR 82,16,17472
v_fmac_f32 v67, v31, v20
MAA 112,28,144
buffer_load_dwordx4 a[184:187], v11, s[16:19], s53 offen sc1
MAA 112,24,128
TR 84,16,25408
v_fmac_f32 v68, v28, v22
MAA 160,32,128
TR 86,16,25920
v_fmac_f32 v69, v29, v22
MAA 160,36,144
TR 88,16,16992
v_fmac_f32 v70, v30, v22
MAA 164,36,148
TR 90,16,17504
v_fmac_f32 v71, v31, v22
MAA 164,32,132
TR 92,16,25440
v_fmac_f32 v72, v28, v24
MAA 180,40,132
buffer_load_dwordx4 a[188:191], v11, s[16:19], s53 offen offset:1024 sc1
MAA 180,44,148
TR 94,16,25952
s_add_u32 s53, s53, 131072
MAA 176,44,144
TR 96,16,17024
s_add_u32 m0, s55, 84480
MAA 176,40,128
TR 98,16,17536
v_fmac_f32 v73, v29, v24
MAA 224,48,128
TR 100,16,25472
v_fmac_f32 v74, v30, v24
MAA 224,52,144
TR 102,16,25984
v_fmac_f32 v75, v31, v24
MAA 228,52,148
buffer_load_dwordx4 v12, s[32:35], s54 offen lds
MAA 228,48,132
TR 104,16,17056
v_fmac_f32 v76, v28, v26
MAA 236,56,132
TR 106,16,17568
v_fmac_f32 v77, v29, v26
MAA 236,60,148
TR 108,16,25504
v_fmac_f32 v78, v30, v26
MAA 232,60,144
TR 110,16,26016
v_fmac_f32 v79, v31, v26
MAA 232,56,128
ds_read_b128 v[28:31], v9 offset:640
s_waitcnt lgkmcnt(15)
v_fmac_f32 v80, v4, v20
s_waitcnt vmcnt(17)
MAA 188,40,140
buffer_load_dwordx4 v13, s[32:35], s54 offen offset:1056 lds
MAA 188,44,156
TR 112,17,16896
v_fmac_f32 v81, v5, v20
MAA 184,44,152
TR 114,17,17408
v_fmac_f32 v82, v6, v20
MAA 184,40,136
TR 116,17,25344
v_fmac_f32 v83, v7, v20
MAA 168,32,136
TR 118,17,25856
v_fmac_f32 v84, v4, v22
MAA 168,36,152
TR 120,17,16928
v_fmac_f32 v85, v5, v22
MAA 172,36,156
buffer_load_dwordx4 v14, s[32:35], s54 offen offset:2112 lds
MAA 172,32,140
TR 122,17,17440
v_fmac_f32 v86, v6, v22
MAA 124,24,140
TR 124,17,25376
v_fmac_f32 v87, v7, v22
MAA 124,28,156
TR 126,17,25888
v_fmac_f32 v88, v4, v24
MAA 120,28,152
v_fmac_f32 v89, v5, v24
v_fmac_f32 v90, v6, v24
MAA 120,24,136
v_fmac_f32 v91, v7, v24
v_fmac_f32 v92, v4, v26
MAA 104,16,136
buffer_load_dwordx4 v15, s[32:35], s54 offen offset:3168 lds
MAA 104,20,152
s_mov_b32 m0, s67
v_fmac_f32 v93, v5, v26
v_fmac_f32 v94, v6, v26
MAA 108,20,156
v_fmac_f32 v95, v7, v26
s_waitcnt lgkmcnt(8)
v_fmac_f32 v128, v28, v20
MAA 108,16,140
ds_read_b128 v[4:7], v8 offset:512
v_fmac_f32 v129, v29, v20
MAA 60,8,140
v_fmac_f32 v130, v30, v20
v_fmac_f32 v131, v31, v20
MAA 60,12,156
v_fmac_f32 v132, v28, v22
v_fmac_f32 v133, v29, v22
MAA 56,12,152
buffer_load_dwordx4 v18, s[28:31], s58 offen lds
MAA 56,8,136
v_fmac_f32 v134, v30, v22
v_fmac_f32 v135, v31, v22
MAA 40,0,136
v_fmac_f32 v136, v28, v24
v_fmac_f32 v137, v29, v24
MAA 40,4,152
v_fmac_f32 v138, v30, v24
v_fmac_f32 v139, v31, v24
MAA 44,4,156
v_fmac_f32 v140, v28, v26
v_fmac_f32 v141, v29, v26
MAA 44,0,140
v_fmac_f32 v142, v30, v26
v_fmac_f32 v143, v31, v26
s_waitcnt lgkmcnt(0)
v_fmac_f32 v240, v4, v20
v_fmac_f32 v241, v5, v20
v_fmac_f32 v242, v6, v20
v_fmac_f32 v243, v7, v20
v_fmac_f32 v244, v4, v22
v_fmac_f32 v245, v5, v22
v_fmac_f32 v246, v6, v22
v_fmac_f32 v247, v7, v22
s_waitcnt vmcnt(17) lgkmcnt(0)
s_barrier
MAA 64,64,128
ds_read_b128 v[28:31], v9
s_add_u32 m0, s55, 101376
MAA 64,68,144
ds_read_b128 v[4:7], v9 offset:64
MAA 68,68,148
buffer_load_dwordx4 v12, s[80:83], s54 offen lds
MAA 68,64,132
TR 0,16,33792
MAA 84,72,132
TR 2,16,34304
MAA 84,76,148
TR 4,16,42240
MAA 80,76,144
TR 6,16,42752
MAA 80,72,128
TR 8,16,33824
MAA 128,80,128
buffer_load_dwordx4 v13, s[80:83], s54 offen offset:1056 lds
MAA 128,84,144
TR 10,16,34336
s_waitcnt lgkmcnt(7)
v_fmac_f32 v32, v28, v20
MAA 132,84,148
TR 12,16,42272
v_fmac_f32 v33, v29, v20
MAA 132,80,132
TR 14,16,42784
v_fmac_f32 v34, v30, v20
MAA 148,88,132
TR 16,16,33856
v_fmac_f32 v35, v31, v20
MAA 148,92,148
TR 18,16,34368
v_fmac_f32 v36, v28, v22
MAA 144,92,144
buffer_load_dwordx4 v14, s[80:83], s54 offen offset:2112 lds
MAA 144,88,128
TR 20,16,42304
v_fmac_f32 v37, v29, v22
MAA 192,96,128
TR 22,16,42816
v_fmac_f32 v38, v30, v22
MAA 192,100,144
TR 24,16,33888
v_fmac_f32 v39, v31, v22
MAA 196,100,148
TR 26,16,34400
v_fmac_f32 v40, v28, v24
MAA 196,96,132
TR 28,16,42336
v_fmac_f32 v41, v29, v24
MAA 212,104,132
buffer_load_dwordx4 v15, s[80:83], s54 offen offset:3168 lds
MAA 212,108,148
TR 30,16,42848
s_add_u32 s54, s54, 458752
MAA 208,108,144
TR 32,16,33920
s_mov_b32 m0, s67
MAA 208,104,128
TR 34,16,34432
v_fmac_f32 v42, v30, v24
MAA 240,112,128
TR 36,16,42368
v_fmac_f32 v43, v31, v24
MAA 240,116,144
TR 38,16,42880
v_fmac_f32 v44, v28, v26
MAA 244,116,148
buffer_load_dwordx4 v19, s[28:31], s58 offen offset:1056 lds
MAA 244,112,132
TR 40,16,33952
s_add_u32 s67, s67, 8448
MAA 252,120,132
TR 42,16,34464
s_add_u32 s58, s58, 0x40000
MAA 252,124,148
TR 44,16,42400
v_fmac_f32 v45, v29, v26
MAA 248,124,144
TR 46,16,42912
v_fmac_f32 v46, v30, v26
MAA 248,120,128
TR 48,17,33792
v_fmac_f32 v47, v31, v26
MAA 220,104,140
ds_read_b128 v[28:31], v9 offset:128
s_waitcnt lgkmcnt(15)
v_fmac_f32 v48, v4, v20
MAA 220,108,156
buffer_load_dwordx4 a[128:131], v10, s[16:19], s52 offen sc1
MAA 216,108,152
TR 50,17,34304
v_fmac_f32 v49, v5, v20
MAA 216,104,136
TR 52,17,42240
v_fmac_f32 v50, v6, v20
MAA 200,96,136
TR 54,17,42752
v_fmac_f32 v51, v7, v20
MAA 200,100,152
TR 56,17,33824
v_fmac_f32 v52, v4, v22
MAA 204,100,156
TR 58,17,34336
.Lpad32:
s_cbranch_execz .Lnopoll60r
v_fmac_f32 v53, v5, v22
MAA 204,96,140
buffer_load_dwordx4 a[132:135], v10, s[16:19], s52 offen offset:1024 sc1
MAA 156,88,140
TR 60,17,42272
s_add_u32 s52, s52, 131072
MAA 156,92,156
TR 62,17,42784
v_fmac_f32 v54, v6, v22
MAA 152,92,152
v_fmac_f32 v55, v7, v22
v_fmac_f32 v56, v4, v24
MAA 152,88,136
v_fmac_f32 v57, v5, v24
v_fmac_f32 v58, v6, v24
MAA 136,80,136
v_fmac_f32 v59, v7, v24
v_fmac_f32 v60, v4, v26
MAA 136,84,152
buffer_load_dwordx4 a[144:147], v10, s[16:19], s52 offen sc1
MAA 140,84,156
v_fmac_f32 v61, v5, v26
v_fmac_f32 v62, v6, v26
MAA 140,80,140
v_fmac_f32 v63, v7, v26
s_waitcnt lgkmcnt(7)
v_fmac_f32 v96, v28, v20
MAA 92,72,140
ds_read_b128 v[4:7], v8
v_fmac_f32 v97, v29, v20
MAA 92,76,156
v_fmac_f32 v98, v30, v20
v_fmac_f32 v99, v31, v20
MAA 88,76,152
v_fmac_f32 v100, v28, v22
v_fmac_f32 v101, v29, v22
MAA 88,72,136
buffer_load_dwordx4 a[148:151], v10, s[16:19], s52 offen offset:1024 sc1
MAA 72,64,136
s_add_u32 s52, s52, 131072
v_fmac_f32 v102, v30, v22
v_fmac_f32 v103, v31, v22
MAA 72,68,152
v_fmac_f32 v104, v28, v24
v_fmac_f32 v105, v29, v24
MAA 76,68,156
v_fmac_f32 v106, v30, v24
v_fmac_f32 v107, v31, v24
MAA 76,64,140
v_fmac_f32 v108, v28, v26
v_fmac_f32 v109, v29, v26
v_fmac_f32 v110, v30, v26
v_fmac_f32 v111, v31, v26
s_waitcnt lgkmcnt(0)
v_fmac_f32 v224, v4, v20
v_fmac_f32 v225, v5, v20
v_fmac_f32 v226, v6, v20
v_fmac_f32 v227, v7, v20
v_fmac_f32 v228, v4, v22
v_fmac_f32 v229, v5, v22
v_fmac_f32 v230, v6, v22
v_fmac_f32 v231, v7, v22
s_waitcnt vmcnt(18) lgkmcnt(0)
s_barrier
MAA 32,0,160
ds_read_b128 v[28:31], v9 offset:704
MAA 32,4,176
ds_read_b128 v[4:7], v9 offset:768
MAA 36,4,180
buffer_load_dwordx4 a[136:139], v11, s[16:19], s53 offen sc1
MAA 36,0,164
TR 64,16,50688
MAA 52,8,164
TR 66,16,51200
MAA 52,12,180
TR 68,16,59136
MAA 48,12,176
TR 70,16,59648
MAA 48,8,160
TR 72,16,50720
MAA 96,16,160
buffer_load_dwordx4 a[140:143], v11, s[16:19], s53 offen offset:1024 sc1
MAA 96,20,176
TR 74,16,51232
s_add_u32 s53, s53, 131072
MAA 100,20,180
TR 76,16,59168
s_waitcnt lgkmcnt(8)
v_fmac_f32 v144, v28, v20
MAA 100,16,164
TR 78,16,59680
v_fmac_f32 v145, v29, v20
MAA 116,24,164
TR 80,16,50752
v_fmac_f32 v146, v30, v20
MAA 116,28,180
TR 82,16,51264
v_fmac_f32 v147, v31, v20
MAA 112,28,176
buffer_load_dwordx4 a[152:155], v11, s[16:19], s53 offen sc1
MAA 112,24,160
TR 84,16,59200
v_fmac_f32 v148, v28, v22
MAA 160,32,160
TR 86,16,59712
v_fmac_f32 v149, v29, v22
MAA 160,36,176
TR 88,16,50784
v_fmac_f32 v150, v30, v22
MAA 164,36,180
TR 90,16,51296
v_fmac_f32 v151, v31, v22
MAA 164,32,164
TR 92,16,59232
v_fmac_f32 v152, v28, v24
MAA 180,40,164
buffer_load_dwordx4 a[156:159], v11, s[16:19], s53 offen offset:1024 sc1
MAA 180,44,180
TR 94,16,59744
s_add_u32 s53, s53, 131072
MAA 176,44,176
TR 96,16,50816
s_add_u32 m0, s55, 118272
MAA 176,40,160
TR 98,16,51328
v_fmac_f32 v153, v29, v24
MAA 224,48,160
TR 100,16,59264
v_fmac_f32 v154, v30, v24
MAA 224,52,176
TR 102,16,59776
v_fmac_f32 v155, v31, v24
MAA 228,52,180
buffer_load_dwordx4 v12, s[32:35], s54 offen lds
MAA 228,48,164
TR 104,16,50848
v_fmac_f32 v156, v28, v26
MAA 236,56,164
TR 106,16,51360
v_fmac_f32 v157, v29, v26
MAA 236,60,180
TR 108,16,59296
v_fmac_f32 v158, v30, v26
MAA 232,60,176
TR 110,16,59808
v_fmac_f32 v159, v31, v26
MAA 232,56,160
ds_read_b128 v[28:31], v9 offset:832
s_waitcnt lgkmcnt(15)
v_fmac_f32 v192, v4, v20
s_waitcnt vmcnt(19)
MAA 188,40,172
buffer_load_dwordx4 v13, s[32:35], s54 offen offset:1056 lds
MAA 188,44,188
TR 112,17,50688
v_fmac_f32 v193, v5, v20
MAA 184,44,184
TR 114,17,51200
v_fmac_f32 v194, v6, v20
MAA 184,40,168
TR 116,17,59136
v_fmac_f32 v195, v7, v20
MAA 168,32,168
TR 118,17,59648
v_fmac_f32 v196, v4, v22
MAA 168,36,184
TR 120,17,50720
v_fmac_f32 v197, v5, v22
MAA 172,36,188
buffer_load_dwordx4 v14, s[32:35], s54 offen offset:2112 lds
MAA 172,32,172
TR 122,17,51232
v_fmac_f32 v198, v6, v22
MAA 124,24,172
TR 124,17,59168
v_fmac_f32 v199, v7, v22
MAA 124,28,188
TR 126,17,59680
v_fmac_f32 v200, v4, v24
MAA 120,28,184
v_fmac_f32 v201, v5, v24
v_fmac_f32 v202, v6, v24
MAA 120,24,168
v_fmac_f32 v203, v7, v24
v_fmac_f32 v204, v4, v26
MAA 104,16,168
buffer_load_dwordx4 v15, s[32:35], s54 offen offset:3168 lds
MAA 104,20,184
s_mov_b32 m0, s67
v_fmac_f32 v205, v5, v26
v_fmac_f32 v206, v6, v26
MAA 108,20,188
v_fmac_f32 v207, v7, v26
s_waitcnt lgkmcnt(8)
v_fmac_f32 v208, v28, v20
MAA 108,16,172
ds_read_b128 v[4:7], v8 offset:576
v_fmac_f32 v209, v29, v20
MAA 60,8,172
v_fmac_f32 v210, v30, v20
v_fmac_f32 v211, v31, v20
MAA 60,12,188
v_fmac_f32 v212, v28, v22
v_fmac_f32 v213, v29, v22
MAA 56,12,184
buffer_load_dwordx4 v18, s[28:31], s58 offen lds
MAA 56,8,168
v_fmac_f32 v214, v30, v22
v_fmac_f32 v215, v31, v22
MAA 40,0,168
v_fmac_f32 v216, v28, v24
v_fmac_f32 v217, v29, v24
MAA 40,4,184
v_fmac_f32 v218, v30, v24
v_fmac_f32 v219, v31, v24
MAA 44,4,188
v_fmac_f32 v220, v28, v26
v_fmac_f32 v221, v29, v26
MAA 44,0,172
v_fmac_f32 v222, v30, v26
v_fmac_f32 v223, v31, v26
s_waitcnt lgkmcnt(0)
v_fmac_f32 v248, v4, v20
v_fmac_f32 v249, v5, v20
v_fmac_f32 v250, v6, v20
v_fmac_f32 v251, v7, v20
v_fmac_f32 v252, v4, v22
v_fmac_f32 v253, v5, v22
v_fmac_f32 v254, v6, v22
v_fmac_f32 v255, v7, v22
s_waitcnt vmcnt(19) lgkmcnt(0)
s_barrier
MAA 64,64,160
ds_read_b128 v[28:31], v9 offset:192
s_add_u32 m0, s55, 135168
MAA 64,68,176
ds_read_b128 v[4:7], v9 offset:256
MAA 68,68,180
buffer_load_dwordx4 v12, s[80:83], s54 offen lds
MAA 68,64,164
ds_read_b64_tr_b16 a[0:1], v16
MAA 84,72,164
TR 2,16,512
MAA 84,76,180
TR 4,16,8448
MAA 80,76,176
TR 6,16,8960
MAA 80,72,160
TR 8,16,32
MAA 128,80,160
buffer_load_dwordx4 v13, s[80:83], s54 offen offset:1056 lds
MAA 128,84,176
TR 10,16,544
s_waitcnt lgkmcnt(7)
v_fmac_f32 v112, v28, v20
MAA 132,84,180
TR 12,16,8480
v_fmac_f32 v113, v29, v20
MAA 132,80,164
TR 14,16,8992
v_fmac_f32 v114, v30, v20
MAA 148,88,164
TR 16,16,64
v_fmac_f32 v115, v31, v20
MAA 148,92,180
TR 18,16,576
v_fmac_f32 v116, v28, v22
MAA 144,92,176
buffer_load_dwordx4 v14, s[80:83], s54 offen offset:2112 lds
MAA 144,88,160
TR 20,16,8512
v_fmac_f32 v117, v29, v22
MAA 192,96,160
TR 22,16,9024
v_fmac_f32 v118, v30, v22
MAA 192,100,176
TR 24,16,96
v_fmac_f32 v119, v31, v22
MAA 196,100,180
TR 26,16,608
v_fmac_f32 v120, v28, v24
MAA 196,96,164
TR 28,16,8544
v_fmac_f32 v121, v29, v24
MAA 212,104,164
buffer_load_dwordx4 v15, s[80:83], s54 offen offset:3168 lds
MAA 212,108,180
TR 30,16,9056
s_add_u32 s54, s54, 458752
MAA 208,108,176
TR 32,16,128
s_mov_b32 m0, s67
MAA 208,104,160
TR 34,16,640
v_fmac_f32 v122, v30, v24
MAA 240,112,160
TR 36,16,8576
v_fmac_f32 v123, v31, v24
MAA 240,116,176
TR 38,16,9088
v_fmac_f32 v124, v28, v26
MAA 244,116,180
buffer_load_dwordx4 v19, s[28:31], s58 offen offset:1056 lds
MAA 244,112,164
TR 40,16,160
s_add_u32 s67, s67, 8448
MAA 252,120,164
TR 42,16,672
s_add_u32 s46, s46, 1
MAA 252,124,180
TR 44,16,8608
s_xor_b32 s58, s46, s87
MAA 248,124,176
TR 46,16,9120
s_mul_i32 s58, s58, 458752
MAA 248,120,160
ds_read_b64_tr_b16 a[48:49], v17
v_fmac_f32 v125, v29, v26
MAA 220,104,172
buffer_load_dwordx4 a[160:163], v10, s[16:19], s52 offen sc1
MAA 220,108,188
TR 50,17,512
v_fmac_f32 v126, v30, v26
MAA 216,108,184
TR 52,17,8448
v_fmac_f32 v127, v31, v26
MAA 216,104,168
ds_read_b128 v[28:31], v9 offset:320
s_waitcnt lgkmcnt(15)
v_fmac_f32 v160, v4, v20
MAA 200,96,168
TR 54,17,8960
v_fmac_f32 v161, v5, v20
MAA 200,100,184
TR 56,17,32
v_fmac_f32 v162, v6, v20
MAA 204,100,188
buffer_load_dwordx4 a[164:167], v10, s[16:19], s52 offen offset:1024 sc1
MAA 204,96,172
TR 58,17,544
s_add_u32 s52, s52, 131072
MAA 156,88,172
TR 60,17,8480
v_fmac_f32 v163, v7, v20
MAA 156,92,188
TR 62,17,8992
v_fmac_f32 v164, v4, v22
MAA 152,92,184
v_fmac_f32 v165, v5, v22
v_fmac_f32 v166, v6, v22
MAA 152,88,168
v_fmac_f32 v167, v7, v22
v_fmac_f32 v168, v4, v24
MAA 136,80,168
buffer_load_dwordx4 a[176:179], v10, s[16:19], s52 offen sc1
MAA 136,84,184
v_fmac_f32 v169, v5, v24
v_fmac_f32 v170, v6, v24
MAA 140,84,188
v_fmac_f32 v171, v7, v24
v_fmac_f32 v172, v4, v26
MAA 140,80,172
v_fmac_f32 v173, v5, v26
v_fmac_f32 v174, v6, v26
MAA 92,72,172
v_fmac_f32 v175, v7, v26
s_waitcnt lgkmcnt(5)
v_fmac_f32 v176, v28, v20
MAA 92,76,188
ds_read_b128 v[4:7], v8 offset:64
v_fmac_f32 v177, v29, v20
MAA 88,76,184
buffer_load_dwordx4 a[180:183], v10, s[16:19], s52 offen offset:1024 sc1
MAA 88,72,168
s_add_u32 s52, s52, 131072
v_fmac_f32 v178, v30, v20
v_fmac_f32 v179, v31, v20
MAA 72,64,168
v_fmac_f32 v180, v28, v22
v_fmac_f32 v181, v29, v22
MAA 72,68,184
v_fmac_f32 v182, v30, v22
v_fmac_f32 v183, v31, v22
MAA 76,68,188
v_fmac_f32 v184, v28, v24
v_fmac_f32 v185, v29, v24
MAA 76,64,172
v_fmac_f32 v186, v30, v24
v_fmac_f32 v187, v31, v24
v_fmac_f32 v188, v28, v26
v_fmac_f32 v189, v29, v26
v_fmac_f32 v190, v30, v26
v_fmac_f32 v191, v31, v26
v_accvgpr_read_b32 v28, a192
s_waitcnt lgkmcnt(0)
v_fmac_f32 v232, v4, v20
v_fmac_f32 v233, v5, v20
v_fmac_f32 v234, v6, v20
v_fmac_f32 v235, v7, v20
v_fmac_f32 v236, v4, v22
v_fmac_f32 v237, v5, v22
v_fmac_f32 v238, v6, v22
v_fmac_f32 v239, v7, v22
v_accvgpr_read_b32 v29, a193
v_accvgpr_read_b32 v30, a194
v_accvgpr_read_b32 v31, a195
s_mov_b32 s15, -4
.p2align 6
.Lk65:
s_waitcnt vmcnt(18) lgkmcnt(0)
s_barrier
MAA 32,0,128
TR 64,16,16896
MAA 32,4,144
buffer_load_dwordx4 a[168:171], v11, s[16:19], s53 offen sc1
MAA 36,4,148
TR 66,16,17408
MAA 36,0,132
TR 68,16,25344
MAA 52,8,132
TR 70,16,25856
MAA 52,12,148
MAA 48,12,144
TR 72,16,16928
MAA 48,8,128
buffer_load_dwordx4 a[172:175], v11, s[16:19], s53 offen offset:1024 sc1
MAA 96,16,128
TR 74,16,17440
s_add_u32 s53, s53, 131072
MAA 96,20,144
TR 76,16,25376
MAA 100,20,148
MAA 100,16,132
TR 78,16,25888
MAA 116,24,132
TR 80,16,16960
MAA 116,28,148
buffer_load_dwordx4 a[184:187], v11, s[16:19], s53 offen sc1
MAA 112,28,144
TR 82,16,17472
MAA 112,24,128
MAA 160,32,128
TR 84,16,25408
MAA 160,36,144
TR 86,16,25920
MAA 164,36,148
TR 88,16,16992
MAA 164,32,132
buffer_load_dwordx4 a[188:191], v11, s[16:19], s53 offen offset:1024 sc1
MAA 180,40,132
s_add_u32 s53, s53, 131072
MAA 180,44,148
TR 90,16,17504
MAA 176,44,144
TR 92,16,25440
MAA 176,40,128
TR 94,16,25952
MAA 224,48,128
s_add_u32 m0, s55, 84480
MAA 224,52,144
buffer_load_dwordx4 v12, s[32:35], s54 offen lds
MAA 228,52,148
TR 96,16,17024
MAA 228,48,132
TR 98,16,17536
MAA 236,56,132
TR 100,16,25472
MAA 236,60,148
TR 102,16,25984
MAA 232,60,144
MAA 232,56,128
TR 104,16,17056
s_waitcnt vmcnt(19)
MAA 188,40,140
TR 106,16,17568
MAA 188,44,156
buffer_load_dwordx4 v13, s[32:35], s54 offen offset:1056 lds
MAA 184,44,152
TR 108,16,25504
MAA 184,40,136
MAA 168,32,136
TR 110,16,26016
MAA 168,36,152
buffer_load_dwordx4 v14, s[32:35], s54 offen offset:2112 lds
MAA 172,36,156
TR 112,17,16896
MAA 172,32,140
TR 114,17,17408
MAA 124,24,140
MAA 124,28,156
TR 116,17,25344
MAA 120,28,152
TR 118,17,25856
MAA 120,24,136
buffer_load_dwordx4 v15, s[32:35], s54 offen offset:3168 lds
MAA 104,16,136
TR 120,17,16928
MAA 104,20,152
MAA 108,20,156
TR 122,17,17440
MAA 108,16,140
TR 124,17,25376
MAA 60,8,140
TR 126,17,25888
s_mov_b32 m0, s67
MAA 60,12,156
buffer_load_dwordx4 v18, s[28:31], s58 offen lds
MAA 56,12,152
MAA 56,8,136
MAA 40,0,136
MAA 40,4,152
MAA 44,4,156
MAA 44,0,140
s_waitcnt vmcnt(19) lgkmcnt(0)
s_barrier
MAA 64,64,128
TR 0,16,33792
s_add_u32 m0, s55, 101376
MAA 64,68,144
buffer_load_dwordx4 v12, s[80:83], s54 offen lds
MAA 68,68,148
TR 2,16,34304
MAA 68,64,132
TR 4,16,42240
MAA 84,72,132
TR 6,16,42752
MAA 84,76,148
MAA 80,76,144
TR 8,16,33824
MAA 80,72,128
buffer_load_dwordx4 v13, s[80:83], s54 offen offset:1056 lds
MAA 128,80,128
TR 10,16,34336
MAA 128,84,144
TR 12,16,42272
MAA 132,84,148
TR 14,16,42784
MAA 132,80,132
MAA 148,88,132
TR 16,16,33856
MAA 148,92,148
buffer_load_dwordx4 v14, s[80:83], s54 offen offset:2112 lds
MAA 144,92,144
TR 18,16,34368
MAA 144,88,128
TR 20,16,42304
MAA 192,96,128
MAA 192,100,144
TR 22,16,42816
MAA 196,100,148
TR 24,16,33888
MAA 196,96,132
buffer_load_dwordx4 v15, s[80:83], s54 offen offset:3168 lds
MAA 212,104,132
TR 26,16,34400
s_add_u32 s54, s54, 458752
MAA 212,108,148
TR 28,16,42336
MAA 208,108,144
MAA 208,104,128
TR 30,16,42848
MAA 240,112,128
TR 32,16,33920
s_mov_b32 m0, s67
MAA 240,116,144
buffer_load_dwordx4 v19, s[28:31], s58 offen offset:1056 lds
MAA 244,116,148
s_add_u32 s67, s67, 8448
s_add_u32 s58, s58, 0x40000
MAA 244,112,132
TR 34,16,34432
MAA 252,120,132
MAA 252,124,148
TR 36,16,42368
MAA 248,124,144
TR 38,16,42880
MAA 248,120,128
buffer_load_dwordx4 a[128:131], v10, s[16:19], s52 offen sc1
MAA 220,104,140
TR 40,16,33952
MAA 220,108,156
TR 42,16,34464
MAA 216,108,152
MAA 216,104,136
TR 44,16,42400
MAA 200,96,136
TR 46,16,42912
MAA 200,100,152
buffer_load_dwordx4 a[132:135], v10, s[16:19], s52 offen offset:1024 sc1
MAA 204,100,156
TR 48,17,33792
s_add_u32 s52, s52, 131072
MAA 204,96,140
MAA 156,88,140
TR 50,17,34304
MAA 156,92,156
TR 52,17,42240
.Lpad33:
s_cbranch_execz .Lnopoll60r
MAA 152,92,152
TR 54,17,42752
MAA 152,88,136
buffer_load_dwordx4 a[144:147], v10, s[16:19], s52 offen sc1
MAA 136,80,136
TR 56,17,33824
MAA 136,84,152
MAA 140,84,156
TR 58,17,34336
MAA 140,80,140
TR 60,17,42272
MAA 92,72,140
TR 62,17,42784
MAA 92,76,156
buffer_load_dwordx4 a[148:151], v10, s[16:19], s52 offen offset:1024 sc1
MAA 88,76,152
s_add_u32 s52, s52, 131072
MAA 88,72,136
MAA 72,64,136
MAA 72,68,152
MAA 76,68,156
MAA 76,64,140
s_waitcnt vmcnt(18) lgkmcnt(0)
s_barrier
MAA 32,0,160
TR 64,16,50688
MAA 32,4,176
buffer_load_dwordx4 a[136:139], v11, s[16:19], s53 offen sc1
MAA 36,4,180
TR 66,16,51200
MAA 36,0,164
TR 68,16,59136
MAA 52,8,164
TR 70,16,59648
MAA 52,12,180
MAA 48,12,176
TR 72,16,50720
MAA 48,8,160
buffer_load_dwordx4 a[140:143], v11, s[16:19], s53 offen offset:1024 sc1
MAA 96,16,160
TR 74,16,51232
s_add_u32 s53, s53, 131072
MAA 96,20,176
TR 76,16,59168
MAA 100,20,180
MAA 100,16,164
TR 78,16,59680
MAA 116,24,164
TR 80,16,50752
MAA 116,28,180
buffer_load_dwordx4 a[152:155], v11, s[16:19], s53 offen sc1
MAA 112,28,176
TR 82,16,51264
MAA 112,24,160
MAA 160,32,160
TR 84,16,59200
MAA 160,36,176
TR 86,16,59712
MAA 164,36,180
TR 88,16,50784
MAA 164,32,164
buffer_load_dwordx4 a[156:159], v11, s[16:19], s53 offen offset:1024 sc1
MAA 180,40,164
s_add_u32 s53, s53, 131072
MAA 180,44,180
TR 90,16,51296
MAA 176,44,176
TR 92,16,59232
MAA 176,40,160
TR 94,16,59744
MAA 224,48,160
s_add_u32 m0, s55, 118272
MAA 224,52,176
buffer_load_dwordx4 v12, s[32:35], s54 offen lds
MAA 228,52,180
TR 96,16,50816
MAA 228,48,164
TR 98,16,51328
MAA 236,56,164
TR 100,16,59264
MAA 236,60,180
TR 102,16,59776
MAA 232,60,176
MAA 232,56,160
TR 104,16,50848
s_waitcnt vmcnt(19)
MAA 188,40,172
TR 106,16,51360
MAA 188,44,188
buffer_load_dwordx4 v13, s[32:35], s54 offen offset:1056 lds
MAA 184,44,184
TR 108,16,59296
MAA 184,40,168
MAA 168,32,168
TR 110,16,59808
MAA 168,36,184
buffer_load_dwordx4 v14, s[32:35], s54 offen offset:2112 lds
MAA 172,36,188
TR 112,17,50688
MAA 172,32,172
TR 114,17,51200
MAA 124,24,172
MAA 124,28,188
TR 116,17,59136
MAA 120,28,184
TR 118,17,59648
MAA 120,24,168
buffer_load_dwordx4 v15, s[32:35], s54 offen offset:3168 lds
MAA 104,16,168
TR 120,17,50720
MAA 104,20,184
MAA 108,20,188
TR 122,17,51232
MAA 108,16,172
TR 124,17,59168
MAA 60,8,172
TR 126,17,59680
s_mov_b32 m0, s67
MAA 60,12,188
buffer_load_dwordx4 v18, s[28:31], s58 offen lds
MAA 56,12,184
MAA 56,8,168
MAA 40,0,168
MAA 40,4,184
MAA 44,4,188
MAA 44,0,172
s_waitcnt vmcnt(19) lgkmcnt(0)
s_barrier
MAA 64,64,160
ds_read_b64_tr_b16 a[0:1], v16
s_add_u32 m0, s55, 135168
MAA 64,68,176
buffer_load_dwordx4 v12, s[80:83], s54 offen lds
MAA 68,68,180
TR 2,16,512
MAA 68,64,164
TR 4,16,8448
MAA 84,72,164
TR 6,16,8960
MAA 84,76,180
MAA 80,76,176
TR 8,16,32
MAA 80,72,160
buffer_load_dwordx4 v13, s[80:83], s54 offen offset:1056 lds
MAA 128,80,160
TR 10,16,544
MAA 128,84,176
TR 12,16,8480
MAA 132,84,180
TR 14,16,8992
MAA 132,80,164
MAA 148,88,164
TR 16,16,64
MAA 148,92,180
buffer_load_dwordx4 v14, s[80:83], s54 offen offset:2112 lds
MAA 144,92,176
TR 18,16,576
MAA 144,88,160
TR 20,16,8512
MAA 192,96,160
MAA 192,100,176
TR 22,16,9024
MAA 196,100,180
TR 24,16,96
MAA 196,96,164
buffer_load_dwordx4 v15, s[80:83], s54 offen offset:3168 lds
MAA 212,104,164
TR 26,16,608
s_add_u32 s54, s54, 458752
MAA 212,108,180
TR 28,16,8544
MAA 208,108,176
MAA 208,104,160
TR 30,16,9056
MAA 240,112,160
TR 32,16,128
s_mov_b32 m0, s67
MAA 240,116,176
buffer_load_dwordx4 v19, s[28:31], s58 offen offset:1056 lds
MAA 244,116,180
s_add_u32 s67, s67, 8448
s_add_u32 s46, s46, 1
s_xor_b32 s58, s46, s87
s_mul_i32 s58, s58, 458752
MAA 244,112,164
TR 34,16,640
MAA 252,120,164
MAA 252,124,180
TR 36,16,8576
MAA 248,124,176
TR 38,16,9088
MAA 248,120,160
buffer_load_dwordx4 a[160:163], v10, s[16:19], s52 offen sc1
MAA 220,104,172
TR 40,16,160
MAA 220,108,188
TR 42,16,672
MAA 216,108,184
MAA 216,104,168
TR 44,16,8608
MAA 200,96,168
TR 46,16,9120
MAA 200,100,184
buffer_load_dwordx4 a[164:167], v10, s[16:19], s52 offen offset:1024 sc1
MAA 204,100,188
ds_read_b64_tr_b16 a[48:49], v17
s_add_u32 s52, s52, 131072
MAA 204,96,172
MAA 156,88,172
TR 50,17,512
MAA 156,92,188
TR 52,17,8448
MAA 152,92,184
TR 54,17,8960
MAA 152,88,168
buffer_load_dwordx4 a[176:179], v10, s[16:19], s52 offen sc1
MAA 136,80,168
TR 56,17,32
MAA 136,84,184
MAA 140,84,188
TR 58,17,544
MAA 140,80,172
TR 60,17,8480
MAA 92,72,172
TR 62,17,8992
MAA 92,76,188
buffer_load_dwordx4 a[180:183], v10, s[16:19], s52 offen offset:1024 sc1
MAA 88,76,184
s_add_u32 s52, s52, 131072
MAA 88,72,168
MAA 72,64,168
MAA 72,68,184
MAA 76,68,188
s_add_u32 s15, s15, 1
MAA 76,64,172
s_cbranch_scc0 .Lk65
s_waitcnt vmcnt(10) lgkmcnt(0)
s_barrier
MAA 32,0,128
buffer_load_dwordx4 a[168:171], v11, s[16:19], s53 offen sc1
MAA 32,4,144
TR 64,16,16896
s_add_u32 s58, s99, 2293760
MAA 48,12,144
TR 66,16,17408
s_lshl_b32 s74, s3, 11
MAA 48,8,128
TR 68,16,25344
s_add_u32 s74, s74, s84
MAA 36,0,132
buffer_load_dwordx4 a[172:175], v11, s[16:19], s53 offen offset:1024 sc1
MAA 36,4,148
TR 70,16,25856
s_add_u32 s53, s53, 131072
MAA 52,12,148
TR 72,16,16928
v_lshl_add_u32 v4, v1, 4, s74
MAA 52,8,132
TR 74,16,17440
v_lshrrev_b32 v2, 3, v1
MAA 40,0,136
buffer_load_dwordx4 a[184:187], v11, s[16:19], s53 offen sc1
MAA 40,4,152
TR 76,16,25376
v_cmp_eq_u32 vcc, 3, v2
MAA 56,12,152
TR 78,16,25888
v_add_u32 v2, 67108480, v4
MAA 56,8,136
TR 80,16,33792
v_cndmask_b32 v4, v4, v2, vcc
MAA 44,0,140
buffer_load_dwordx4 a[188:191], v11, s[16:19], s53 offen offset:1024 sc1
MAA 44,4,156
TR 82,16,34304
s_add_u32 s53, s53, 131072
MAA 60,12,156
TR 84,16,42240
s_and_b32 s74, s7, 1
MAA 60,8,140
TR 86,16,42752
s_add_u32 s54, s98, 65536
MAA 96,16,128
TR 88,16,33824
v_bfe_u32 v7, v1, 2, 3
MAA 96,20,144
TR 90,16,34336
v_mul_u32_u24 v7, 1056, v7
MAA 112,28,144
TR 92,16,42272
s_waitcnt vmcnt(9)
s_barrier
MAA 112,24,128
TR 94,16,42784
v_bfe_u32 v2, v1, 5, 1
MAA 100,16,132
TR 96,16,50688
v_lshl_add_u32 v7, v2, 8, v7
MAA 100,20,148
TR 98,16,51200
v_and_b32 v2, 3, v1
MAA 116,28,148
TR 100,16,59136
v_lshl_add_u32 v7, v2, 3, v7
MAA 116,24,132
TR 102,16,59648
s_lshl_b32 s74, s74, 7
MAA 104,16,136
TR 104,16,50720
s_xor_b32 s75, s74, 128
MAA 104,20,152
TR 106,16,51232
v_add_u32 v6, s75, v7
MAA 120,28,152
TR 108,16,59168
v_add_u32 v7, s74, v7
MAA 120,24,136
TR 110,16,59680
s_mul_i32 s55, s3, 2112
MAA 108,16,140
TR 112,16,16960
s_mov_b32 s57, 67584
MAA 108,20,156
TR 114,16,17472
MAA 124,28,156
TR 116,16,25408
MAA 124,24,140
TR 118,16,25920
MAA 160,32,128
TR 120,16,16992
MAA 160,36,144
TR 122,16,17504
MAA 176,44,144
TR 124,16,25440
MAA 176,40,128
TR 126,16,25952
MAA 164,32,132
TR 192,16,33856
MAA 164,36,148
TR 194,16,34368
MAA 180,44,148
TR 196,16,42304
MAA 180,40,132
TR 198,16,42816
MAA 168,32,136
TR 200,16,33888
MAA 168,36,152
TR 202,16,34400
MAA 184,44,152
TR 204,16,42336
MAA 184,40,136
TR 206,16,42848
MAA 172,32,140
TR 208,16,50752
MAA 172,36,156
TR 210,16,51264
MAA 188,44,156
TR 212,16,59200
MAA 188,40,140
TR 214,16,59712
MAA 224,48,128
TR 216,16,50784
MAA 224,52,144
TR 218,16,51296
MAA 232,60,144
TR 220,16,59232
MAA 232,56,128
TR 222,16,59744
MAA 228,48,132
TR 0,16,17024
MAA 228,52,148
TR 2,16,17536
MAA 236,60,148
TR 4,16,25472
MAA 236,56,132
TR 6,16,25984
s_waitcnt lgkmcnt(15)
MAA 64,64,128
TR 8,16,17056
MAA 64,68,144
TR 10,16,17568
s_waitcnt vmcnt(7)
MAA 64,96,160
TR 12,16,25504
s_waitcnt vmcnt(5)
MAA 64,100,176
TR 14,16,26016
MAA 80,108,176
TR 16,16,33920
MAA 80,104,160
TR 18,16,34432
MAA 80,76,144
TR 20,16,42368
MAA 80,72,128
TR 22,16,42880
MAA 32,80,160
TR 24,16,33952
MAA 32,84,176
TR 26,16,34464
MAA 48,92,176
TR 28,16,42400
MAA 48,88,160
TR 30,16,42912
s_nop 2
v_pk_mul_f32 v[64:65], v[64:65], v[32:33]
TR 32,16,50816
TR 34,16,51328
v_pk_mul_f32 v[32:33], v[32:33], v[28:29] op_sel_hi:[1,0]
v_pk_mul_f32 v[66:67], v[66:67], v[34:35]
v_pk_mul_f32 v[34:35], v[34:35], v[28:29] op_sel_hi:[1,0]
v_exp_f32 v32, v32
v_pk_mul_f32 v[80:81], v[80:81], v[48:49]
v_pk_mul_f32 v[48:49], v[48:49], v[28:29] op_sel_hi:[1,0]
v_pk_mul_f32 v[82:83], v[82:83], v[50:51]
v_pk_mul_f32 v[50:51], v[50:51], v[28:29] op_sel_hi:[1,0]
v_exp_f32 v33, v33
v_exp_f32 v34, v34
MAA 68,64,132
TR 36,16,59264
v_exp_f32 v35, v35
MAA 68,68,148
TR 38,16,59776
v_exp_f32 v48, v48
MAA 68,96,164
TR 40,16,50848
v_exp_f32 v49, v49
s_waitcnt vmcnt(4)
MAA 68,100,180
TR 42,16,51360
v_exp_f32 v50, v50
MAA 84,108,180
TR 44,16,59296
v_exp_f32 v51, v51
MAA 84,104,164
TR 46,16,59808
MAA 84,76,148
TR 48,17,16896
MAA 84,72,132
TR 50,17,17408
MAA 36,80,164
TR 52,17,25344
MAA 36,84,180
TR 54,17,25856
MAA 52,92,180
TR 56,17,16928
MAA 52,88,164
TR 58,17,17440
s_nop 2
v_pk_mul_f32 v[68:69], v[68:69], v[36:37]
v_pk_fma_f32 v[32:33], v[32:33], v[20:21], v[20:21] op_sel:[0,1,1] op_sel_hi:[1,1,1]
v_pk_fma_f32 v[34:35], v[34:35], v[20:21], v[20:21] op_sel:[0,1,1] op_sel_hi:[1,1,1]
v_pk_mul_f32 v[36:37], v[36:37], v[28:29] op_sel:[0,1] op_sel_hi:[1,1]
v_pk_mul_f32 v[70:71], v[70:71], v[38:39]
v_pk_mul_f32 v[38:39], v[38:39], v[28:29] op_sel:[0,1] op_sel_hi:[1,1]
v_pk_fma_f32 v[48:49], v[48:49], v[20:21], v[20:21] op_sel:[0,1,1] op_sel_hi:[1,1,1]
v_pk_mul_f32 v[84:85], v[84:85], v[52:53]
v_pk_mul_f32 v[52:53], v[52:53], v[28:29] op_sel:[0,1] op_sel_hi:[1,1]
v_pk_mul_f32 v[86:87], v[86:87], v[54:55]
v_pk_mul_f32 v[54:55], v[54:55], v[28:29] op_sel:[0,1] op_sel_hi:[1,1]
v_pk_fma_f32 v[50:51], v[50:51], v[20:21], v[20:21] op_sel:[0,1,1] op_sel_hi:[1,1,1]
v_rcp_f32 v32, v32
v_rcp_f32 v33, v33
MAA 72,64,136
TR 60,17,25376
v_rcp_f32 v34, v34
MAA 72,68,152
TR 62,17,25888
v_rcp_f32 v35, v35
s_waitcnt vmcnt(3)
MAA 72,96,168
v_rcp_f32 v48, v48
s_waitcnt vmcnt(1)
MAA 72,100,184
v_rcp_f32 v49, v49
MAA 88,108,184
v_rcp_f32 v50, v50
MAA 88,104,168
v_rcp_f32 v51, v51
MAA 88,76,152
v_exp_f32 v36, v36
MAA 88,72,136
v_exp_f32 v37, v37
MAA 40,80,168
v_exp_f32 v38, v38
MAA 40,84,184
v_exp_f32 v39, v39
MAA 56,92,184
v_exp_f32 v52, v52
MAA 56,88,168
v_exp_f32 v53, v53
v_exp_f32 v54, v54
v_exp_f32 v55, v55
v_pk_mul_f32 v[64:65], v[64:65], v[32:33]
v_pk_mul_f32 v[66:67], v[66:67], v[34:35]
v_pk_mul_f32 v[80:81], v[80:81], v[48:49]
v_pk_mul_f32 v[82:83], v[82:83], v[50:51]
v_pk_mul_f32 v[72:73], v[72:73], v[40:41]
v_pk_mul_f32 v[40:41], v[40:41], v[30:31] op_sel_hi:[1,0]
v_pk_mul_f32 v[74:75], v[74:75], v[42:43]
v_pk_mul_f32 v[42:43], v[42:43], v[30:31] op_sel_hi:[1,0]
v_pk_mul_f32 v[88:89], v[88:89], v[56:57]
v_pk_mul_f32 v[56:57], v[56:57], v[30:31] op_sel_hi:[1,0]
v_pk_mul_f32 v[90:91], v[90:91], v[58:59]
v_pk_mul_f32 v[58:59], v[58:59], v[30:31] op_sel_hi:[1,0]
v_pk_fma_f32 v[36:37], v[36:37], v[22:23], v[22:23] op_sel:[0,1,1] op_sel_hi:[1,1,1]
v_pk_fma_f32 v[38:39], v[38:39], v[22:23], v[22:23] op_sel:[0,1,1] op_sel_hi:[1,1,1]
v_pk_fma_f32 v[52:53], v[52:53], v[22:23], v[22:23] op_sel:[0,1,1] op_sel_hi:[1,1,1]
v_pk_fma_f32 v[54:55], v[54:55], v[22:23], v[22:23] op_sel:[0,1,1] op_sel_hi:[1,1,1]
v_cvt_pk_bf16_f32 v32, v64, v65
v_cvt_pk_bf16_f32 v33, v66, v67
v_cvt_pk_bf16_f32 v34, v80, v81
v_cvt_pk_bf16_f32 v35, v82, v83
MAA 76,64,140
buffer_store_dwordx4 v[32:35], v10, s[16:19], s62 offen sc1
MAA 76,68,156
TR 64,17,33792
v_rcp_f32 v36, v36
MAA 76,96,172
TR 66,17,34304
v_rcp_f32 v37, v37
s_waitcnt vmcnt(1)
MAA 76,100,188
TR 68,17,42240
v_rcp_f32 v38, v38
MAA 92,108,188
TR 70,17,42752
v_rcp_f32 v39, v39
MAA 92,104,172
v_rcp_f32 v52, v52
MAA 92,76,156
TR 76,17,42272
v_rcp_f32 v53, v53
MAA 92,72,140
TR 72,17,33824
v_rcp_f32 v54, v54
MAA 44,80,172
TR 74,17,34336
v_rcp_f32 v55, v55
MAA 44,84,188
TR 78,17,42784
v_exp_f32 v40, v40
MAA 60,92,188
TR 80,17,50688
v_exp_f32 v41, v41
MAA 60,88,172
.Lpad34:
s_cbranch_execz .Lpad37
TR 82,17,51200
v_exp_f32 v42, v42
v_exp_f32 v43, v43
v_exp_f32 v56, v56
v_exp_f32 v57, v57
v_exp_f32 v58, v58
v_exp_f32 v59, v59
v_pk_mul_f32 v[68:69], v[68:69], v[36:37]
v_pk_mul_f32 v[70:71], v[70:71], v[38:39]
v_pk_mul_f32 v[84:85], v[84:85], v[52:53]
v_pk_mul_f32 v[86:87], v[86:87], v[54:55]
v_pk_mul_f32 v[76:77], v[76:77], v[44:45]
v_pk_mul_f32 v[44:45], v[44:45], v[30:31] op_sel:[0,1] op_sel_hi:[1,1]
v_pk_mul_f32 v[78:79], v[78:79], v[46:47]
v_pk_mul_f32 v[46:47], v[46:47], v[30:31] op_sel:[0,1] op_sel_hi:[1,1]
v_pk_mul_f32 v[92:93], v[92:93], v[60:61]
v_pk_mul_f32 v[60:61], v[60:61], v[30:31] op_sel:[0,1] op_sel_hi:[1,1]
v_pk_mul_f32 v[94:95], v[94:95], v[62:63]
v_pk_mul_f32 v[62:63], v[62:63], v[30:31] op_sel:[0,1] op_sel_hi:[1,1]
v_pk_fma_f32 v[40:41], v[40:41], v[24:25], v[24:25] op_sel:[0,1,1] op_sel_hi:[1,1,1]
v_pk_fma_f32 v[42:43], v[42:43], v[24:25], v[24:25] op_sel:[0,1,1] op_sel_hi:[1,1,1]
v_pk_fma_f32 v[56:57], v[56:57], v[24:25], v[24:25] op_sel:[0,1,1] op_sel_hi:[1,1,1]
v_pk_fma_f32 v[58:59], v[58:59], v[24:25], v[24:25] op_sel:[0,1,1] op_sel_hi:[1,1,1]
v_cvt_pk_bf16_f32 v36, v68, v69
v_cvt_pk_bf16_f32 v37, v70, v71
v_cvt_pk_bf16_f32 v38, v84, v85
v_cvt_pk_bf16_f32 v39, v86, v87
MAA 128,112,128
buffer_store_dwordx4 v[36:39], v10, s[16:19], s62 offen offset:1024 sc1
MAA 128,116,144
TR 84,17,59136
v_rcp_f32 v40, v40
s_waitcnt lgkmcnt(15)
MAA 128,208,160
TR 86,17,59648
v_rcp_f32 v41, v41
MAA 128,212,176
TR 88,17,50720
v_rcp_f32 v42, v42
MAA 144,220,176
TR 90,17,51232
v_rcp_f32 v43, v43
MAA 144,216,160
TR 92,17,59168
v_rcp_f32 v56, v56
MAA 144,124,144
TR 94,17,59680
v_rcp_f32 v57, v57
MAA 144,120,128
v_rcp_f32 v58, v58
MAA 96,192,160
v_rcp_f32 v59, v59
MAA 96,196,176
v_exp_f32 v44, v44
MAA 112,204,176
v_exp_f32 v45, v45
MAA 112,200,160
v_lshrrev_b32 v69, 2, v0
v_min_u32 v69, 1, v69
v_lshlrev_b32 v69, 28, v69
v_lshl_add_u32 v68, v0, 7, v69
v_xor_b32 v69, 64, v0
v_min_u32 v69, 1, v69
v_lshlrev_b32 v70, 4, v69
v_sub_u32 v70, 16, v70
v_lshlrev_b32 v69, 28, v69
v_mov_b32 v71, 1
s_waitcnt lgkmcnt(0)
s_barrier
v_mov_b32 v84, 0
v_mov_b32 v85, 0
v_mov_b32 v86, 0
v_exp_f32 v46, v46
v_exp_f32 v47, v47
v_exp_f32 v60, v60
v_exp_f32 v61, v61
v_exp_f32 v62, v62
v_exp_f32 v63, v63
v_pk_mul_f32 v[72:73], v[72:73], v[40:41]
v_pk_mul_f32 v[74:75], v[74:75], v[42:43]
v_pk_mul_f32 v[88:89], v[88:89], v[56:57]
v_pk_mul_f32 v[90:91], v[90:91], v[58:59]
v_pk_mul_f32 v[128:129], v[128:129], v[96:97]
v_pk_mul_f32 v[96:97], v[96:97], v[28:29] op_sel_hi:[1,0]
v_pk_mul_f32 v[130:131], v[130:131], v[98:99]
v_pk_mul_f32 v[98:99], v[98:99], v[28:29] op_sel_hi:[1,0]
v_pk_mul_f32 v[144:145], v[144:145], v[112:113]
v_pk_mul_f32 v[112:113], v[112:113], v[28:29] op_sel_hi:[1,0]
v_pk_mul_f32 v[146:147], v[146:147], v[114:115]
v_pk_mul_f32 v[114:115], v[114:115], v[28:29] op_sel_hi:[1,0]
v_pk_fma_f32 v[44:45], v[44:45], v[26:27], v[26:27] op_sel:[0,1,1] op_sel_hi:[1,1,1]
v_pk_fma_f32 v[46:47], v[46:47], v[26:27], v[26:27] op_sel:[0,1,1] op_sel_hi:[1,1,1]
v_pk_fma_f32 v[60:61], v[60:61], v[26:27], v[26:27] op_sel:[0,1,1] op_sel_hi:[1,1,1]
v_pk_fma_f32 v[62:63], v[62:63], v[26:27], v[26:27] op_sel:[0,1,1] op_sel_hi:[1,1,1]
v_cvt_pk_bf16_f32 v40, v72, v73
v_cvt_pk_bf16_f32 v41, v74, v75
v_cvt_pk_bf16_f32 v42, v88, v89
v_cvt_pk_bf16_f32 v43, v90, v91
MAA 132,112,132
buffer_store_dwordx4 v[40:43], v11, s[16:19], s62 offen sc1
MAA 132,116,148
s_add_u32 m0, s59, 84480
v_rcp_f32 v44, v44
MAA 132,208,164
v_rcp_f32 v45, v45
MAA 132,212,180
v_rcp_f32 v46, v46
MAA 148,220,180
buffer_load_dwordx4 v18, s[28:31], s58 offen lds
MAA 148,216,164
v_rcp_f32 v47, v47
MAA 148,124,148
v_rcp_f32 v60, v60
MAA 148,120,132
v_rcp_f32 v61, v61
MAA 100,192,164
buffer_load_dwordx4 v19, s[28:31], s58 offen offset:1056 lds
MAA 100,196,180
s_add_u32 m0, s59, 92928
s_add_u32 s58, s99, 2555904
v_rcp_f32 v62, v62
MAA 116,204,180
v_rcp_f32 v63, v63
MAA 116,200,164
v_exp_f32 v96, v96
v_exp_f32 v97, v97
v_exp_f32 v98, v98
v_exp_f32 v99, v99
v_exp_f32 v112, v112
v_exp_f32 v113, v113
v_exp_f32 v114, v114
v_exp_f32 v115, v115
v_pk_mul_f32 v[76:77], v[76:77], v[44:45]
v_pk_mul_f32 v[78:79], v[78:79], v[46:47]
v_pk_mul_f32 v[92:93], v[92:93], v[60:61]
v_pk_mul_f32 v[94:95], v[94:95], v[62:63]
v_pk_mul_f32 v[132:133], v[132:133], v[100:101]
v_pk_mul_f32 v[100:101], v[100:101], v[28:29] op_sel:[0,1] op_sel_hi:[1,1]
v_pk_mul_f32 v[134:135], v[134:135], v[102:103]
v_pk_mul_f32 v[102:103], v[102:103], v[28:29] op_sel:[0,1] op_sel_hi:[1,1]
v_pk_mul_f32 v[148:149], v[148:149], v[116:117]
v_pk_mul_f32 v[116:117], v[116:117], v[28:29] op_sel:[0,1] op_sel_hi:[1,1]
v_pk_mul_f32 v[150:151], v[150:151], v[118:119]
v_pk_mul_f32 v[118:119], v[118:119], v[28:29] op_sel:[0,1] op_sel_hi:[1,1]
v_pk_fma_f32 v[96:97], v[96:97], v[20:21], v[20:21] op_sel:[0,1,1] op_sel_hi:[1,1,1]
v_pk_fma_f32 v[98:99], v[98:99], v[20:21], v[20:21] op_sel:[0,1,1] op_sel_hi:[1,1,1]
v_pk_fma_f32 v[112:113], v[112:113], v[20:21], v[20:21] op_sel:[0,1,1] op_sel_hi:[1,1,1]
v_pk_fma_f32 v[114:115], v[114:115], v[20:21], v[20:21] op_sel:[0,1,1] op_sel_hi:[1,1,1]
v_cvt_pk_bf16_f32 v44, v76, v77
v_cvt_pk_bf16_f32 v45, v78, v79
v_cvt_pk_bf16_f32 v46, v92, v93
v_cvt_pk_bf16_f32 v47, v94, v95
MAA 136,112,136
buffer_store_dwordx4 v[44:47], v11, s[16:19], s62 offen offset:1024 sc1
MAA 136,116,152
v_rcp_f32 v96, v96
MAA 136,208,168
v_rcp_f32 v97, v97
MAA 136,212,184
v_rcp_f32 v98, v98
MAA 152,220,184
buffer_load_dwordx4 v18, s[28:31], s58 offen lds
MAA 152,216,168
v_rcp_f32 v99, v99
MAA 152,124,152
v_rcp_f32 v112, v112
MAA 152,120,136
v_rcp_f32 v113, v113
MAA 104,192,168
buffer_load_dwordx4 v19, s[28:31], s58 offen offset:1056 lds
MAA 104,196,184
s_add_u32 m0, s59, 101376
s_add_u32 s58, s100, 2752512
v_rcp_f32 v114, v114
MAA 120,204,184
v_rcp_f32 v115, v115
MAA 120,200,168
v_exp_f32 v100, v100
v_exp_f32 v101, v101
v_exp_f32 v102, v102
v_exp_f32 v103, v103
v_exp_f32 v116, v116
v_exp_f32 v117, v117
v_exp_f32 v118, v118
v_exp_f32 v119, v119
v_pk_mul_f32 v[128:129], v[128:129], v[96:97]
v_pk_mul_f32 v[130:131], v[130:131], v[98:99]
v_pk_mul_f32 v[144:145], v[144:145], v[112:113]
v_pk_mul_f32 v[146:147], v[146:147], v[114:115]
v_pk_mul_f32 v[136:137], v[136:137], v[104:105]
v_pk_mul_f32 v[104:105], v[104:105], v[30:31] op_sel_hi:[1,0]
v_pk_mul_f32 v[138:139], v[138:139], v[106:107]
v_pk_mul_f32 v[106:107], v[106:107], v[30:31] op_sel_hi:[1,0]
v_pk_mul_f32 v[152:153], v[152:153], v[120:121]
v_pk_mul_f32 v[120:121], v[120:121], v[30:31] op_sel_hi:[1,0]
v_pk_mul_f32 v[154:155], v[154:155], v[122:123]
v_pk_mul_f32 v[122:123], v[122:123], v[30:31] op_sel_hi:[1,0]
v_pk_fma_f32 v[100:101], v[100:101], v[22:23], v[22:23] op_sel:[0,1,1] op_sel_hi:[1,1,1]
v_pk_fma_f32 v[102:103], v[102:103], v[22:23], v[22:23] op_sel:[0,1,1] op_sel_hi:[1,1,1]
v_pk_fma_f32 v[116:117], v[116:117], v[22:23], v[22:23] op_sel:[0,1,1] op_sel_hi:[1,1,1]
v_pk_fma_f32 v[118:119], v[118:119], v[22:23], v[22:23] op_sel:[0,1,1] op_sel_hi:[1,1,1]
v_cvt_pk_bf16_f32 v96, v128, v129
v_cvt_pk_bf16_f32 v97, v130, v131
v_cvt_pk_bf16_f32 v98, v144, v145
v_cvt_pk_bf16_f32 v99, v146, v147
MAA 140,112,140
buffer_store_dwordx4 v[96:99], v10, s[16:19], s63 offen sc1
MAA 140,116,156
v_rcp_f32 v100, v100
MAA 140,208,172
v_rcp_f32 v101, v101
MAA 140,212,188
v_rcp_f32 v102, v102
MAA 156,220,188
buffer_load_dwordx4 v18, s[28:31], s58 offen lds
MAA 156,216,172
v_rcp_f32 v103, v103
MAA 156,124,156
v_rcp_f32 v116, v116
MAA 156,120,140
v_rcp_f32 v117, v117
MAA 108,192,172
buffer_load_dwordx4 v19, s[28:31], s58 offen offset:1056 lds
MAA 108,196,188
s_add_u32 m0, s59, 109824
s_add_u32 s58, s100, 3014656
v_rcp_f32 v118, v118
MAA 124,204,188
v_rcp_f32 v119, v119
MAA 124,200,172
v_exp_f32 v104, v104
v_exp_f32 v105, v105
v_exp_f32 v106, v106
v_exp_f32 v107, v107
v_exp_f32 v120, v120
v_exp_f32 v121, v121
v_exp_f32 v122, v122
v_exp_f32 v123, v123
v_pk_mul_f32 v[132:133], v[132:133], v[100:101]
v_pk_mul_f32 v[134:135], v[134:135], v[102:103]
v_pk_mul_f32 v[148:149], v[148:149], v[116:117]
v_pk_mul_f32 v[150:151], v[150:151], v[118:119]
v_pk_mul_f32 v[140:141], v[140:141], v[108:109]
v_pk_mul_f32 v[108:109], v[108:109], v[30:31] op_sel:[0,1] op_sel_hi:[1,1]
v_pk_mul_f32 v[142:143], v[142:143], v[110:111]
v_pk_mul_f32 v[110:111], v[110:111], v[30:31] op_sel:[0,1] op_sel_hi:[1,1]
v_pk_mul_f32 v[156:157], v[156:157], v[124:125]
v_pk_mul_f32 v[124:125], v[124:125], v[30:31] op_sel:[0,1] op_sel_hi:[1,1]
v_pk_mul_f32 v[158:159], v[158:159], v[126:127]
v_pk_mul_f32 v[126:127], v[126:127], v[30:31] op_sel:[0,1] op_sel_hi:[1,1]
v_pk_fma_f32 v[104:105], v[104:105], v[24:25], v[24:25] op_sel:[0,1,1] op_sel_hi:[1,1,1]
v_pk_fma_f32 v[106:107], v[106:107], v[24:25], v[24:25] op_sel:[0,1,1] op_sel_hi:[1,1,1]
v_pk_fma_f32 v[120:121], v[120:121], v[24:25], v[24:25] op_sel:[0,1,1] op_sel_hi:[1,1,1]
v_pk_fma_f32 v[122:123], v[122:123], v[24:25], v[24:25] op_sel:[0,1,1] op_sel_hi:[1,1,1]
v_cvt_pk_bf16_f32 v100, v132, v133
v_cvt_pk_bf16_f32 v101, v134, v135
v_cvt_pk_bf16_f32 v102, v148, v149
v_cvt_pk_bf16_f32 v103, v150, v151
MAA 192,0,128
buffer_store_dwordx4 v[100:103], v10, s[16:19], s63 offen offset:1024 sc1
MAA 192,4,144
v_rcp_f32 v104, v104
MAA 192,32,160
s_waitcnt vmcnt(6)
s_barrier
v_rcp_f32 v105, v105
MAA 192,36,176
v_rcp_f32 v106, v106
MAA 208,44,176
buffer_atomic_add v71, v68, s[16:19], s72 offen offset:512
MAA 208,40,160
v_rcp_f32 v107, v107
MAA 208,12,144
v_rcp_f32 v120, v120
MAA 208,8,128
v_rcp_f32 v121, v121
MAA 160,16,160
buffer_load_dwordx4 v18, s[28:31], s58 offen lds
MAA 160,20,176
v_rcp_f32 v122, v122
MAA 176,28,176
v_rcp_f32 v123, v123
MAA 176,24,160
v_exp_f32 v108, v108
v_exp_f32 v109, v109
v_exp_f32 v110, v110
v_exp_f32 v111, v111
v_exp_f32 v124, v124
v_exp_f32 v125, v125
v_exp_f32 v126, v126
v_exp_f32 v127, v127
v_pk_mul_f32 v[136:137], v[136:137], v[104:105]
v_pk_mul_f32 v[138:139], v[138:139], v[106:107]
v_pk_mul_f32 v[152:153], v[152:153], v[120:121]
v_pk_mul_f32 v[154:155], v[154:155], v[122:123]
v_pk_mul_f32 v[192:193], v[192:193], v[160:161]
v_pk_mul_f32 v[160:161], v[160:161], v[28:29] op_sel_hi:[1,0]
v_pk_mul_f32 v[194:195], v[194:195], v[162:163]
v_pk_mul_f32 v[162:163], v[162:163], v[28:29] op_sel_hi:[1,0]
v_pk_mul_f32 v[208:209], v[208:209], v[176:177]
v_pk_mul_f32 v[176:177], v[176:177], v[28:29] op_sel_hi:[1,0]
v_pk_mul_f32 v[210:211], v[210:211], v[178:179]
v_pk_mul_f32 v[178:179], v[178:179], v[28:29] op_sel_hi:[1,0]
v_pk_fma_f32 v[108:109], v[108:109], v[26:27], v[26:27] op_sel:[0,1,1] op_sel_hi:[1,1,1]
v_pk_fma_f32 v[110:111], v[110:111], v[26:27], v[26:27] op_sel:[0,1,1] op_sel_hi:[1,1,1]
v_pk_fma_f32 v[124:125], v[124:125], v[26:27], v[26:27] op_sel:[0,1,1] op_sel_hi:[1,1,1]
v_pk_fma_f32 v[126:127], v[126:127], v[26:27], v[26:27] op_sel:[0,1,1] op_sel_hi:[1,1,1]
v_cvt_pk_bf16_f32 v104, v136, v137
v_cvt_pk_bf16_f32 v105, v138, v139
v_cvt_pk_bf16_f32 v106, v152, v153
v_cvt_pk_bf16_f32 v107, v154, v155
MAA 196,0,132
buffer_store_dwordx4 v[104:107], v11, s[16:19], s63 offen sc1
MAA 196,4,148
v_rcp_f32 v108, v108
MAA 196,32,164
v_rcp_f32 v109, v109
MAA 196,36,180
v_rcp_f32 v110, v110
MAA 212,44,180
buffer_load_dwordx4 v19, s[28:31], s58 offen offset:1056 lds
MAA 212,40,164
s_add_u32 m0, s59, 118272
s_add_u32 s58, s101, 3211264
v_rcp_f32 v111, v111
MAA 212,12,148
v_rcp_f32 v124, v124
MAA 212,8,132
v_rcp_f32 v125, v125
MAA 164,16,164
buffer_load_dwordx4 v18, s[28:31], s58 offen lds
MAA 164,20,180
v_rcp_f32 v126, v126
MAA 180,28,180
v_rcp_f32 v127, v127
MAA 180,24,164
v_exp_f32 v160, v160
v_exp_f32 v161, v161
v_exp_f32 v162, v162
v_exp_f32 v163, v163
v_exp_f32 v176, v176
v_exp_f32 v177, v177
v_exp_f32 v178, v178
v_exp_f32 v179, v179
v_pk_mul_f32 v[140:141], v[140:141], v[108:109]
v_pk_mul_f32 v[142:143], v[142:143], v[110:111]
v_pk_mul_f32 v[156:157], v[156:157], v[124:125]
v_pk_mul_f32 v[158:159], v[158:159], v[126:127]
v_pk_mul_f32 v[196:197], v[196:197], v[164:165]
v_pk_mul_f32 v[164:165], v[164:165], v[28:29] op_sel:[0,1] op_sel_hi:[1,1]
v_pk_mul_f32 v[198:199], v[198:199], v[166:167]
v_pk_mul_f32 v[166:167], v[166:167], v[28:29] op_sel:[0,1] op_sel_hi:[1,1]
v_pk_mul_f32 v[212:213], v[212:213], v[180:181]
v_pk_mul_f32 v[180:181], v[180:181], v[28:29] op_sel:[0,1] op_sel_hi:[1,1]
v_pk_mul_f32 v[214:215], v[214:215], v[182:183]
v_pk_mul_f32 v[182:183], v[182:183], v[28:29] op_sel:[0,1] op_sel_hi:[1,1]
v_pk_fma_f32 v[160:161], v[160:161], v[20:21], v[20:21] op_sel:[0,1,1] op_sel_hi:[1,1,1]
v_pk_fma_f32 v[162:163], v[162:163], v[20:21], v[20:21] op_sel:[0,1,1] op_sel_hi:[1,1,1]
v_pk_fma_f32 v[176:177], v[176:177], v[20:21], v[20:21] op_sel:[0,1,1] op_sel_hi:[1,1,1]
v_pk_fma_f32 v[178:179], v[178:179], v[20:21], v[20:21] op_sel:[0,1,1] op_sel_hi:[1,1,1]
v_cvt_pk_bf16_f32 v108, v140, v141
v_cvt_pk_bf16_f32 v109, v142, v143
v_cvt_pk_bf16_f32 v110, v156, v157
v_cvt_pk_bf16_f32 v111, v158, v159
MAA 200,0,136
buffer_store_dwordx4 v[108:111], v11, s[16:19], s63 offen offset:1024 sc1
MAA 200,4,152
v_rcp_f32 v160, v160
MAA 200,32,168
v_rcp_f32 v161, v161
MAA 200,36,184
v_rcp_f32 v162, v162
MAA 216,44,184
buffer_load_dwordx4 v19, s[28:31], s58 offen offset:1056 lds
MAA 216,40,168
s_add_u32 m0, s59, 126720
s_add_u32 s58, s101, 3473408
v_rcp_f32 v163, v163
MAA 216,12,152
v_rcp_f32 v176, v176
MAA 216,8,136
v_rcp_f32 v177, v177
MAA 168,16,168
buffer_load_dwordx4 v18, s[28:31], s58 offen lds
MAA 168,20,184
v_rcp_f32 v178, v178
MAA 184,28,184
v_rcp_f32 v179, v179
MAA 184,24,168
v_exp_f32 v164, v164
v_exp_f32 v165, v165
v_exp_f32 v166, v166
v_exp_f32 v167, v167
v_exp_f32 v180, v180
v_exp_f32 v181, v181
v_exp_f32 v182, v182
v_exp_f32 v183, v183
v_pk_mul_f32 v[192:193], v[192:193], v[160:161]
v_pk_mul_f32 v[194:195], v[194:195], v[162:163]
v_pk_mul_f32 v[208:209], v[208:209], v[176:177]
v_pk_mul_f32 v[210:211], v[210:211], v[178:179]
v_pk_mul_f32 v[200:201], v[200:201], v[168:169]
v_pk_mul_f32 v[168:169], v[168:169], v[30:31] op_sel_hi:[1,0]
v_pk_mul_f32 v[202:203], v[202:203], v[170:171]
v_pk_mul_f32 v[170:171], v[170:171], v[30:31] op_sel_hi:[1,0]
v_pk_mul_f32 v[216:217], v[216:217], v[184:185]
v_pk_mul_f32 v[184:185], v[184:185], v[30:31] op_sel_hi:[1,0]
v_pk_mul_f32 v[218:219], v[218:219], v[186:187]
v_pk_mul_f32 v[186:187], v[186:187], v[30:31] op_sel_hi:[1,0]
v_pk_fma_f32 v[164:165], v[164:165], v[22:23], v[22:23] op_sel:[0,1,1] op_sel_hi:[1,1,1]
v_pk_fma_f32 v[166:167], v[166:167], v[22:23], v[22:23] op_sel:[0,1,1] op_sel_hi:[1,1,1]
v_pk_fma_f32 v[180:181], v[180:181], v[22:23], v[22:23] op_sel:[0,1,1] op_sel_hi:[1,1,1]
v_pk_fma_f32 v[182:183], v[182:183], v[22:23], v[22:23] op_sel:[0,1,1] op_sel_hi:[1,1,1]
v_cvt_pk_bf16_f32 v160, v192, v193
v_cvt_pk_bf16_f32 v161, v194, v195
v_cvt_pk_bf16_f32 v162, v208, v209
v_cvt_pk_bf16_f32 v163, v210, v211
MAA 204,0,140
buffer_store_dwordx4 v[160:163], v10, s[16:19], s64 offen sc1
MAA 204,4,156
v_rcp_f32 v164, v164
MAA 204,32,172
v_rcp_f32 v165, v165
MAA 204,36,188
v_rcp_f32 v166, v166
MAA 220,44,188
buffer_atomic_add v84, v69, s[16:19], s73 offen offset:512 sc0
MAA 220,40,172
v_rcp_f32 v167, v167
MAA 220,12,156
v_rcp_f32 v180, v180
MAA 220,8,140
v_rcp_f32 v181, v181
MAA 172,16,172
buffer_load_dwordx4 v19, s[28:31], s58 offen offset:1056 lds
MAA 172,20,188
v_rcp_f32 v182, v182
MAA 188,28,188
v_rcp_f32 v183, v183
MAA 188,24,172
v_exp_f32 v168, v168
v_exp_f32 v169, v169
v_exp_f32 v170, v170
v_exp_f32 v171, v171
v_exp_f32 v184, v184
v_exp_f32 v185, v185
v_exp_f32 v186, v186
v_exp_f32 v187, v187
v_pk_mul_f32 v[196:197], v[196:197], v[164:165]
v_pk_mul_f32 v[198:199], v[198:199], v[166:167]
v_pk_mul_f32 v[212:213], v[212:213], v[180:181]
v_pk_mul_f32 v[214:215], v[214:215], v[182:183]
v_pk_mul_f32 v[204:205], v[204:205], v[172:173]
v_pk_mul_f32 v[172:173], v[172:173], v[30:31] op_sel:[0,1] op_sel_hi:[1,1]
v_pk_mul_f32 v[206:207], v[206:207], v[174:175]
v_pk_mul_f32 v[174:175], v[174:175], v[30:31] op_sel:[0,1] op_sel_hi:[1,1]
v_pk_mul_f32 v[220:221], v[220:221], v[188:189]
v_pk_mul_f32 v[188:189], v[188:189], v[30:31] op_sel:[0,1] op_sel_hi:[1,1]
v_pk_mul_f32 v[222:223], v[222:223], v[190:191]
v_pk_mul_f32 v[190:191], v[190:191], v[30:31] op_sel:[0,1] op_sel_hi:[1,1]
v_pk_fma_f32 v[168:169], v[168:169], v[24:25], v[24:25] op_sel:[0,1,1] op_sel_hi:[1,1,1]
v_pk_fma_f32 v[170:171], v[170:171], v[24:25], v[24:25] op_sel:[0,1,1] op_sel_hi:[1,1,1]
v_pk_fma_f32 v[184:185], v[184:185], v[24:25], v[24:25] op_sel:[0,1,1] op_sel_hi:[1,1,1]
v_pk_fma_f32 v[186:187], v[186:187], v[24:25], v[24:25] op_sel:[0,1,1] op_sel_hi:[1,1,1]
v_cvt_pk_bf16_f32 v164, v196, v197
v_cvt_pk_bf16_f32 v165, v198, v199
v_cvt_pk_bf16_f32 v166, v212, v213
v_cvt_pk_bf16_f32 v167, v214, v215
MAA 240,48,128
buffer_store_dwordx4 v[164:167], v10, s[16:19], s64 offen offset:1024 sc1
MAA 240,52,144
v_rcp_f32 v168, v168
MAA 240,80,160
v_rcp_f32 v169, v169
MAA 240,84,176
v_rcp_f32 v170, v170
MAA 248,92,176
buffer_atomic_add v85, v69, s[16:19], s73 offen offset:512 sc0
MAA 248,88,160
v_rcp_f32 v171, v171
MAA 248,60,144
v_rcp_f32 v184, v184
MAA 248,56,128
v_rcp_f32 v185, v185
MAA 224,64,160
v_rcp_f32 v186, v186
MAA 224,68,176
v_rcp_f32 v187, v187
MAA 232,76,176
v_exp_f32 v172, v172
MAA 232,72,160
v_exp_f32 v173, v173
v_exp_f32 v174, v174
v_exp_f32 v175, v175
v_exp_f32 v188, v188
v_exp_f32 v189, v189
v_exp_f32 v190, v190
v_exp_f32 v191, v191
v_pk_mul_f32 v[200:201], v[200:201], v[168:169]
v_pk_mul_f32 v[202:203], v[202:203], v[170:171]
v_pk_mul_f32 v[216:217], v[216:217], v[184:185]
v_pk_mul_f32 v[218:219], v[218:219], v[186:187]
v_pk_mul_f32 v[240:241], v[240:241], v[224:225]
v_pk_mul_f32 v[224:225], v[224:225], v[28:29] op_sel_hi:[1,0]
v_pk_mul_f32 v[242:243], v[242:243], v[226:227]
v_pk_mul_f32 v[226:227], v[226:227], v[28:29] op_sel_hi:[1,0]
v_pk_mul_f32 v[248:249], v[248:249], v[232:233]
v_pk_mul_f32 v[232:233], v[232:233], v[28:29] op_sel_hi:[1,0]
v_pk_mul_f32 v[250:251], v[250:251], v[234:235]
v_pk_mul_f32 v[234:235], v[234:235], v[28:29] op_sel_hi:[1,0]
v_pk_fma_f32 v[172:173], v[172:173], v[26:27], v[26:27] op_sel:[0,1,1] op_sel_hi:[1,1,1]
v_pk_fma_f32 v[174:175], v[174:175], v[26:27], v[26:27] op_sel:[0,1,1] op_sel_hi:[1,1,1]
v_pk_fma_f32 v[188:189], v[188:189], v[26:27], v[26:27] op_sel:[0,1,1] op_sel_hi:[1,1,1]
v_pk_fma_f32 v[190:191], v[190:191], v[26:27], v[26:27] op_sel:[0,1,1] op_sel_hi:[1,1,1]
v_cvt_pk_bf16_f32 v168, v200, v201
v_cvt_pk_bf16_f32 v169, v202, v203
v_cvt_pk_bf16_f32 v170, v216, v217
v_cvt_pk_bf16_f32 v171, v218, v219
buffer_store_dwordx4 v[168:171], v11, s[16:19], s64 offen sc1
buffer_atomic_add v86, v69, s[16:19], s73 offen offset:512 sc0
s_waitcnt vmcnt(5)
v_cmp_gt_u32 vcc, v70, v84
s_nop 0
s_cbranch_vccz .Lok66
s_waitcnt vmcnt(2)
v_cmp_gt_u32 vcc, v70, v85
s_nop 0
s_cbranch_vccz .Lok66
s_waitcnt vmcnt(0)
v_cmp_gt_u32 vcc, v70, v86
s_nop 0
s_cbranch_vccz .Lok66
s_mov_b32 s15, 0
.Lok66l:
v_mov_b32 v84, 0
buffer_atomic_add v84, v69, s[16:19], s73 offen offset:512 sc0
s_add_u32 s15, s15, 1
s_cmp_gt_u32 s15, 100000
s_waitcnt vmcnt(0)
s_cbranch_scc1 .Lok66
v_cmp_gt_u32 vcc, v70, v84
s_nop 0
s_cbranch_vccnz .Lok66l
.Lok66:
s_waitcnt vmcnt(4)
s_barrier
MAA 244,48,132
ds_read_b64_tr_b16 a[0:1], v7
s_add_u32 s52, s76, 0
MAA 244,52,148
buffer_load_dwordx4 v[96:99], v4, s[16:19], s52 offen sc1
MAA 244,80,164
TR 2,7,512
v_rcp_f32 v172, v172
MAA 244,84,180
TR 4,7,32
v_rcp_f32 v173, v173
MAA 252,92,180
TR 6,7,544
v_rcp_f32 v174, v174
MAA 252,88,164
buffer_load_dwordx4 v[100:103], v4, s[16:19], s52 offen offset:1024 sc1
MAA 252,60,148
TR 8,7,64
s_add_u32 s52, s76, 65536
MAA 252,56,132
TR 10,7,576
v_rcp_f32 v175, v175
MAA 228,64,164
TR 12,7,96
v_rcp_f32 v188, v188
MAA 228,68,180
buffer_load_dwordx4 v[104:107], v4, s[16:19], s52 offen sc1
MAA 236,76,180
TR 14,7,608
v_rcp_f32 v189, v189
MAA 236,72,164
TR 16,7,8448
v_rcp_f32 v190, v190
v_rcp_f32 v191, v191
v_exp_f32 v224, v224
v_exp_f32 v225, v225
v_exp_f32 v226, v226
v_exp_f32 v227, v227
v_exp_f32 v232, v232
v_exp_f32 v233, v233
v_exp_f32 v234, v234
v_exp_f32 v235, v235
v_pk_mul_f32 v[204:205], v[204:205], v[172:173]
buffer_load_dwordx4 v[108:111], v4, s[16:19], s52 offen offset:1024 sc1
s_add_u32 s52, s77, 114688
v_pk_mul_f32 v[206:207], v[206:207], v[174:175]
v_pk_mul_f32 v[220:221], v[220:221], v[188:189]
v_pk_mul_f32 v[222:223], v[222:223], v[190:191]
v_pk_mul_f32 v[244:245], v[244:245], v[228:229]
v_pk_mul_f32 v[228:229], v[228:229], v[28:29] op_sel:[0,1] op_sel_hi:[1,1]
v_pk_mul_f32 v[246:247], v[246:247], v[230:231]
v_pk_mul_f32 v[230:231], v[230:231], v[28:29] op_sel:[0,1] op_sel_hi:[1,1]
v_pk_mul_f32 v[252:253], v[252:253], v[236:237]
v_pk_mul_f32 v[236:237], v[236:237], v[28:29] op_sel:[0,1] op_sel_hi:[1,1]
v_pk_mul_f32 v[254:255], v[254:255], v[238:239]
v_pk_mul_f32 v[238:239], v[238:239], v[28:29] op_sel:[0,1] op_sel_hi:[1,1]
v_pk_fma_f32 v[224:225], v[224:225], v[20:21], v[20:21] op_sel:[0,1,1] op_sel_hi:[1,1,1]
buffer_load_dwordx4 v[112:115], v4, s[16:19], s52 offen sc1
v_pk_fma_f32 v[226:227], v[226:227], v[20:21], v[20:21] op_sel:[0,1,1] op_sel_hi:[1,1,1]
v_pk_fma_f32 v[232:233], v[232:233], v[20:21], v[20:21] op_sel:[0,1,1] op_sel_hi:[1,1,1]
v_pk_fma_f32 v[234:235], v[234:235], v[20:21], v[20:21] op_sel:[0,1,1] op_sel_hi:[1,1,1]
v_cvt_pk_bf16_f32 v172, v204, v205
v_cvt_pk_bf16_f32 v173, v206, v207
v_cvt_pk_bf16_f32 v174, v220, v221
v_cvt_pk_bf16_f32 v175, v222, v223
TR 18,7,8960
TR 20,7,8480
TR 22,7,8992
buffer_store_dwordx4 v[172:175], v11, s[16:19], s64 offen offset:1024 sc1
TR 24,7,8512
TR 26,7,9024
.Lpad35:
s_cbranch_execz .Lpad38
TR 28,7,8544
TR 30,7,9056
v_rcp_f32 v224, v224
v_rcp_f32 v225, v225
v_rcp_f32 v226, v226
v_rcp_f32 v227, v227
v_rcp_f32 v232, v232
v_rcp_f32 v233, v233
v_rcp_f32 v234, v234
v_rcp_f32 v235, v235
v_exp_f32 v228, v228
v_exp_f32 v229, v229
v_exp_f32 v230, v230
v_exp_f32 v231, v231
v_exp_f32 v236, v236
v_exp_f32 v237, v237
v_exp_f32 v238, v238
v_exp_f32 v239, v239
v_pk_mul_f32 v[240:241], v[240:241], v[224:225]
buffer_load_dwordx4 v[116:119], v4, s[16:19], s52 offen offset:1024 sc1
s_add_u32 s52, s77, 180224
v_pk_mul_f32 v[242:243], v[242:243], v[226:227]
v_pk_mul_f32 v[248:249], v[248:249], v[232:233]
v_pk_mul_f32 v[250:251], v[250:251], v[234:235]
v_pk_fma_f32 v[228:229], v[228:229], v[22:23], v[22:23] op_sel:[0,1,1] op_sel_hi:[1,1,1]
v_pk_fma_f32 v[230:231], v[230:231], v[22:23], v[22:23] op_sel:[0,1,1] op_sel_hi:[1,1,1]
v_pk_fma_f32 v[236:237], v[236:237], v[22:23], v[22:23] op_sel:[0,1,1] op_sel_hi:[1,1,1]
v_pk_fma_f32 v[238:239], v[238:239], v[22:23], v[22:23] op_sel:[0,1,1] op_sel_hi:[1,1,1]
v_cvt_pk_bf16_f32 v224, v240, v241
v_cvt_pk_bf16_f32 v225, v242, v243
v_cvt_pk_bf16_f32 v226, v248, v249
v_cvt_pk_bf16_f32 v227, v250, v251
v_rcp_f32 v228, v228
v_rcp_f32 v229, v229
v_rcp_f32 v230, v230
v_rcp_f32 v231, v231
v_rcp_f32 v236, v236
v_rcp_f32 v237, v237
v_rcp_f32 v238, v238
v_rcp_f32 v239, v239
v_pk_mul_f32 v[244:245], v[244:245], v[228:229]
buffer_store_dwordx4 v[224:227], v10, s[16:19], s65 offen sc1
v_pk_mul_f32 v[246:247], v[246:247], v[230:231]
v_pk_mul_f32 v[252:253], v[252:253], v[236:237]
v_pk_mul_f32 v[254:255], v[254:255], v[238:239]
v_cvt_pk_bf16_f32 v228, v244, v245
v_cvt_pk_bf16_f32 v229, v246, v247
v_cvt_pk_bf16_f32 v230, v252, v253
v_cvt_pk_bf16_f32 v231, v254, v255
buffer_store_dwordx4 v[228:231], v10, s[16:19], s65 offen offset:1024 sc1
buffer_load_dwordx4 v[120:123], v4, s[16:19], s52 offen sc1
buffer_load_dwordx4 v[124:127], v4, s[16:19], s52 offen offset:1024 sc1
v_mov_b32 v21, v68
v_mov_b32 v22, v69
v_mov_b32 v23, v70
v_mov_b32 v24, v71
v_mov_b32 v25, 0
s_waitcnt vmcnt(7) lgkmcnt(0)
s_barrier
v_mfma_f32_16x16x32_bf16 v[32:35], a[0:3], v[96:99], 0
ds_read_b64_tr_b16 a[32:33], v6
s_add_u32 s52, s78, 229376
MAV 32,16,104
buffer_load_dwordx4 v[128:131], v4, s[16:19], s52 offen sc1
v_mfma_f32_16x16x32_bf16 v[48:51], a[0:3], v[100:103], 0
TR 34,6,512
MAV 48,16,108
TR 36,6,32
TR 38,6,544
v_mfma_f32_16x16x32_bf16 v[52:55], a[4:7], v[100:103], 0
TR 48,6,8448
MAV 52,20,108
buffer_load_dwordx4 v[132:135], v4, s[16:19], s52 offen offset:1024 sc1
v_mfma_f32_16x16x32_bf16 v[36:39], a[4:7], v[96:99], 0
TR 50,6,8960
MAV 36,20,104
TR 52,6,8480
TR 54,6,8992
v_mfma_f32_16x16x32_bf16 v[40:43], a[8:11], v[96:99], 0
TR 40,6,64
s_add_u32 s52, s78, 294912
MAV 40,24,104
buffer_load_dwordx4 v[136:139], v4, s[16:19], s52 offen sc1
v_mfma_f32_16x16x32_bf16 v[56:59], a[8:11], v[100:103], 0
TR 42,6,576
MAV 56,24,108
TR 44,6,96
TR 46,6,608
v_mfma_f32_16x16x32_bf16 v[60:63], a[12:15], v[100:103], 0
TR 56,6,8512
MAV 60,28,108
buffer_load_dwordx4 v[140:143], v4, s[16:19], s52 offen offset:1024 sc1
v_mfma_f32_16x16x32_bf16 v[44:47], a[12:15], v[96:99], 0
TR 58,6,9024
MAV 44,28,104
TR 60,6,8544
TR 62,6,9056
s_waitcnt lgkmcnt(8)
v_mfma_f32_16x16x32_bf16 v[64:67], a[32:35], v[96:99], 0
TR 0,7,16896
s_add_u32 s52, s79, 344064
MAV 64,48,104
buffer_load_dwordx4 v[144:147], v4, s[16:19], s52 offen sc1
v_mfma_f32_16x16x32_bf16 v[80:83], a[32:35], v[100:103], 0
TR 2,7,17408
MAV 80,48,108
TR 4,7,16928
TR 6,7,17440
v_mfma_f32_16x16x32_bf16 v[84:87], a[36:39], v[100:103], 0
TR 16,7,25344
MAV 84,52,108
buffer_load_dwordx4 v[148:151], v4, s[16:19], s52 offen offset:1024 sc1
v_mfma_f32_16x16x32_bf16 v[68:71], a[36:39], v[96:99], 0
TR 18,7,25856
MAV 68,52,104
TR 20,7,25376
TR 22,7,25888
s_waitcnt lgkmcnt(8)
v_mfma_f32_16x16x32_bf16 v[72:75], a[40:43], v[96:99], 0
TR 8,7,16960
s_add_u32 s52, s79, 409600
MAV 72,56,104
buffer_load_dwordx4 v[152:155], v4, s[16:19], s52 offen sc1
v_mfma_f32_16x16x32_bf16 v[88:91], a[40:43], v[100:103], 0
TR 10,7,17472
MAV 88,56,108
TR 12,7,16992
TR 14,7,17504
v_mfma_f32_16x16x32_bf16 v[92:95], a[44:47], v[100:103], 0
TR 24,7,25408
MAV 92,60,108
buffer_load_dwordx4 v[156:159], v4, s[16:19], s52 offen offset:1024 sc1
v_mfma_f32_16x16x32_bf16 v[76:79], a[44:47], v[96:99], 0
TR 26,7,25920
MAV 76,60,104
TR 28,7,25440
TR 30,7,25952
s_waitcnt vmcnt(8) lgkmcnt(8)
s_barrier
MAV 32,0,112
TR 32,6,16896
s_add_u32 m0, s55, 0
MAV 32,16,120
buffer_load_dwordx4 v18, s[28:31], s54 offen lds
MAV 48,16,124
TR 34,6,17408
MAV 48,0,116
TR 36,6,16928
TR 38,6,17440
MAV 52,4,116
TR 48,6,25344
s_add_u32 s52, s76, 458752
MAV 52,20,124
buffer_load_dwordx4 v[96:99], v4, s[16:19], s52 offen sc1
MAV 36,20,120
TR 50,6,25856
MAV 36,4,112
TR 52,6,25376
TR 54,6,25888
s_waitcnt lgkmcnt(8)
MAV 40,8,112
TR 40,6,16960
MAV 40,24,120
buffer_load_dwordx4 v19, s[28:31], s54 offen offset:1056 lds
MAV 56,24,124
TR 42,6,17472
s_add_u32 s54, s98, 327680
MAV 56,8,116
TR 44,6,16992
TR 46,6,17504
MAV 60,12,116
TR 56,6,25408
MAV 60,28,124
buffer_load_dwordx4 v[100:103], v4, s[16:19], s52 offen offset:1024 sc1
MAV 44,28,120
TR 58,6,25920
MAV 44,12,112
TR 60,6,25440
TR 62,6,25952
s_waitcnt lgkmcnt(8)
MAV 64,32,112
TR 0,7,33792
s_add_u32 m0, s55, 8448
MAV 64,48,120
buffer_load_dwordx4 v18, s[28:31], s54 offen lds
MAV 80,48,124
TR 2,7,34304
MAV 80,32,116
TR 4,7,33824
TR 6,7,34336
MAV 84,36,116
TR 16,7,42240
s_add_u32 s52, s76, 524288
MAV 84,52,124
buffer_load_dwordx4 v[104:107], v4, s[16:19], s52 offen sc1
MAV 68,52,120
TR 18,7,42752
MAV 68,36,112
TR 20,7,42272
TR 22,7,42784
s_waitcnt lgkmcnt(8)
MAV 72,40,112
TR 8,7,33856
MAV 72,56,120
buffer_load_dwordx4 v19, s[28:31], s54 offen offset:1056 lds
MAV 88,56,124
TR 10,7,34368
s_add_u32 s54, s99, 524288
MAV 88,40,116
TR 12,7,33888
TR 14,7,34400
MAV 92,44,116
TR 24,7,42304
MAV 92,60,124
buffer_load_dwordx4 v[108:111], v4, s[16:19], s52 offen offset:1024 sc1
MAV 76,60,120
TR 26,7,42816
MAV 76,44,112
TR 28,7,42336
TR 30,7,42848
s_waitcnt vmcnt(12) lgkmcnt(8)
s_barrier
MAV 32,0,128
TR 32,6,33792
MAV 32,16,136
buffer_atomic_add v24, v21, s[16:19], s72 offen
MAV 48,16,140
TR 34,6,34304
MAV 48,0,132
TR 36,6,33824
TR 38,6,34336
TR 48,6,42240
MAV 52,4,132
TR 50,6,42752
s_add_u32 m0, s55, 16896
MAV 52,20,140
buffer_load_dwordx4 v18, s[28:31], s54 offen lds
MAV 36,20,136
TR 52,6,42272
MAV 36,4,128
TR 54,6,42784
TR 40,6,33856
s_waitcnt lgkmcnt(9)
MAV 40,8,128
TR 42,6,34368
s_add_u32 s52, s77, 573440
MAV 40,24,136
buffer_load_dwordx4 v[112:115], v4, s[16:19], s52 offen sc1
MAV 56,24,140
TR 44,6,33888
MAV 56,8,132
buffer_load_dwordx4 v19, s[28:31], s54 offen offset:1056 lds
MAV 60,12,132
TR 46,6,34400
s_add_u32 s54, s99, 786432
MAV 60,28,140
buffer_load_dwordx4 v[116:119], v4, s[16:19], s52 offen offset:1024 sc1
MAV 44,28,136
TR 56,6,42304
MAV 44,12,128
TR 58,6,42816
TR 60,6,42336
TR 62,6,42848
s_waitcnt lgkmcnt(8)
MAV 64,32,128
TR 0,7,50688
s_add_u32 m0, s55, 25344
MAV 64,48,136
buffer_load_dwordx4 v18, s[28:31], s54 offen lds
MAV 80,48,140
TR 2,7,51200
MAV 80,32,132
TR 4,7,50720
TR 6,7,51232
MAV 84,36,132
TR 16,7,59136
s_add_u32 s52, s77, 638976
MAV 84,52,140
buffer_load_dwordx4 v[120:123], v4, s[16:19], s52 offen sc1
MAV 68,52,136
TR 18,7,59648
MAV 68,36,128
TR 20,7,59168
TR 22,7,59680
s_waitcnt lgkmcnt(8)
MAV 72,40,128
TR 8,7,50752
MAV 72,56,136
buffer_load_dwordx4 v19, s[28:31], s54 offen offset:1056 lds
MAV 88,56,140
TR 10,7,51264
s_add_u32 s54, s100, 983040
MAV 88,40,132
TR 12,7,50784
TR 14,7,51296
MAV 92,44,132
TR 24,7,59200
MAV 92,60,140
buffer_load_dwordx4 v[124:127], v4, s[16:19], s52 offen offset:1024 sc1
MAV 76,60,136
TR 26,7,59712
MAV 76,44,128
TR 28,7,59232
TR 30,7,59744
s_waitcnt vmcnt(17) lgkmcnt(8)
s_barrier
MAV 32,0,144
TR 32,6,50688
s_add_u32 m0, s55, 33792
MAV 32,16,152
buffer_load_dwordx4 v18, s[28:31], s54 offen lds
MAV 48,16,156
TR 34,6,51200
MAV 48,0,148
TR 36,6,50720
TR 38,6,51232
MAV 52,4,148
TR 48,6,59136
s_add_u32 s52, s78, 688128
MAV 52,20,156
buffer_load_dwordx4 v[128:131], v4, s[16:19], s52 offen sc1
MAV 36,20,152
TR 50,6,59648
MAV 36,4,144
TR 52,6,59168
TR 54,6,59680
s_waitcnt lgkmcnt(8)
MAV 40,8,144
TR 40,6,50752
MAV 40,24,152
buffer_load_dwordx4 v19, s[28:31], s54 offen offset:1056 lds
MAV 56,24,156
TR 42,6,51264
s_add_u32 s54, s100, 1245184
MAV 56,8,148
TR 44,6,50784
TR 46,6,51296
MAV 60,12,148
TR 56,6,59200
MAV 60,28,156
buffer_load_dwordx4 v[132:135], v4, s[16:19], s52 offen offset:1024 sc1
MAV 44,28,152
TR 58,6,59712
MAV 44,12,144
TR 60,6,59232
TR 62,6,59744
v_add_u32 v7, s57, v7
v_add_u32 v6, s57, v6
s_sub_u32 s57, 0, s57
s_waitcnt lgkmcnt(8)
MAV 64,32,144
ds_read_b64_tr_b16 a[0:1], v7
s_add_u32 m0, s55, 42240
MAV 64,48,152
buffer_load_dwordx4 v18, s[28:31], s54 offen lds
MAV 80,48,156
TR 2,7,512
MAV 80,32,148
TR 4,7,32
TR 6,7,544
TR 16,7,8448
MAV 84,36,148
TR 18,7,8960
s_add_u32 s52, s78, 753664
MAV 84,52,156
buffer_load_dwordx4 v[136:139], v4, s[16:19], s52 offen sc1
MAV 68,52,152
TR 20,7,8480
MAV 68,36,144
TR 22,7,8992
TR 8,7,64
s_waitcnt lgkmcnt(9)
MAV 72,40,144
TR 10,7,576
MAV 72,56,152
buffer_load_dwordx4 v19, s[28:31], s54 offen offset:1056 lds
MAV 88,56,156
TR 12,7,96
s_add_u32 s54, s101, 1441792
MAV 88,40,148
buffer_load_dwordx4 v[140:143], v4, s[16:19], s52 offen offset:1024 sc1
MAV 92,44,148
TR 14,7,608
MAV 92,60,156
buffer_atomic_add v25, v22, s[16:19], s73 offen sc0
MAV 76,60,152
TR 24,7,8512
MAV 76,44,144
TR 26,7,9024
TR 28,7,8544
TR 30,7,9056
s_waitcnt vmcnt(18) lgkmcnt(8)
s_barrier
MAV 32,0,96
ds_read_b64_tr_b16 a[32:33], v6
s_add_u32 m0, s55, 50688
MAV 32,16,104
buffer_load_dwordx4 v18, s[28:31], s54 offen lds
MAV 48,16,108
TR 34,6,512
MAV 48,0,100
TR 36,6,32
TR 38,6,544
MAV 52,4,100
TR 48,6,8448
s_add_u32 s52, s79, 802816
MAV 52,20,108
buffer_load_dwordx4 v[144:147], v4, s[16:19], s52 offen sc1
MAV 36,20,104
TR 50,6,8960
MAV 36,4,96
TR 52,6,8480
TR 54,6,8992
s_waitcnt lgkmcnt(8)
MAV 40,8,96
TR 40,6,64
MAV 40,24,104
buffer_load_dwordx4 v19, s[28:31], s54 offen offset:1056 lds
MAV 56,24,108
TR 42,6,576
s_add_u32 s54, s101, 1703936
MAV 56,8,100
TR 44,6,96
TR 46,6,608
MAV 60,12,100
TR 56,6,8512
MAV 60,28,108
buffer_load_dwordx4 v[148:151], v4, s[16:19], s52 offen offset:1024 sc1
MAV 44,28,104
TR 58,6,9024
MAV 44,12,96
TR 60,6,8544
TR 62,6,9056
s_waitcnt lgkmcnt(8)
MAV 64,32,96
TR 0,7,16896
s_add_u32 m0, s55, 59136
MAV 64,48,104
buffer_load_dwordx4 v18, s[28:31], s54 offen lds
MAV 80,48,108
TR 2,7,17408
MAV 80,32,100
TR 4,7,16928
TR 6,7,17440
MAV 84,36,100
TR 16,7,25344
s_add_u32 s52, s79, 868352
MAV 84,52,108
buffer_load_dwordx4 v[152:155], v4, s[16:19], s52 offen sc1
MAV 68,52,104
TR 18,7,25856
MAV 68,36,96
TR 20,7,25376
TR 22,7,25888
s_waitcnt lgkmcnt(8)
MAV 72,40,96
TR 8,7,16960
MAV 72,56,104
buffer_load_dwordx4 v19, s[28:31], s54 offen offset:1056 lds
MAV 88,56,108
TR 10,7,17472
s_add_u32 s54, s98, 1900544
MAV 88,40,100
TR 12,7,16992
TR 14,7,17504
MAV 92,44,100
TR 24,7,25408
MAV 92,60,108
buffer_load_dwordx4 v[156:159], v4, s[16:19], s52 offen offset:1024 sc1
MAV 76,60,104
TR 26,7,25920
MAV 76,44,96
TR 28,7,25440
TR 30,7,25952
s_waitcnt vmcnt(8)
v_cmp_gt_u32 vcc, v23, v25
s_nop 0
s_cbranch_vccnz .Lsp67
.Lsp67b:
s_waitcnt lgkmcnt(8)
s_barrier
MAV 32,0,112
TR 32,6,16896
s_add_u32 m0, s55, 67584
MAV 32,16,120
buffer_load_dwordx4 v18, s[28:31], s54 offen lds
MAV 48,16,124
TR 34,6,17408
MAV 48,0,116
TR 36,6,16928
TR 38,6,17440
MAV 52,4,116
TR 48,6,25344
s_add_u32 s52, s76, 16384
MAV 52,20,124
buffer_load_dwordx4 v[96:99], v4, s[16:19], s52 offen sc1
MAV 36,20,120
TR 50,6,25856
MAV 36,4,112
TR 52,6,25376
TR 54,6,25888
s_waitcnt lgkmcnt(8)
MAV 40,8,112
TR 40,6,16960
MAV 40,24,120
buffer_load_dwordx4 v19, s[28:31], s54 offen offset:1056 lds
MAV 56,24,124
TR 42,6,17472
s_add_u32 s54, s98, 2162688
MAV 56,8,116
TR 44,6,16992
TR 46,6,17504
MAV 60,12,116
TR 56,6,25408
MAV 60,28,124
buffer_load_dwordx4 v[100:103], v4, s[16:19], s52 offen offset:1024 sc1
MAV 44,28,120
TR 58,6,25920
MAV 44,12,112
TR 60,6,25440
TR 62,6,25952
s_waitcnt lgkmcnt(8)
MAV 64,32,112
TR 0,7,33792
s_add_u32 m0, s55, 76032
MAV 64,48,120
buffer_load_dwordx4 v18, s[28:31], s54 offen lds
MAV 80,48,124
TR 2,7,34304
MAV 80,32,116
TR 4,7,33824
TR 6,7,34336
MAV 84,36,116
TR 16,7,42240
s_add_u32 s52, s76, 81920
MAV 84,52,124
buffer_load_dwordx4 v[104:107], v4, s[16:19], s52 offen sc1
MAV 68,52,120
TR 18,7,42752
MAV 68,36,112
TR 20,7,42272
TR 22,7,42784
s_waitcnt lgkmcnt(8)
MAV 72,40,112
TR 8,7,33856
.Lpad36:
s_cbranch_execz .Lpad39
MAV 72,56,120
buffer_load_dwordx4 v19, s[28:31], s54 offen offset:1056 lds
MAV 88,56,124
TR 10,7,34368
s_add_u32 s54, s99, 2359296
MAV 88,40,116
TR 12,7,33888
TR 14,7,34400
MAV 92,44,116
TR 24,7,42304
MAV 92,60,124
buffer_load_dwordx4 v[108:111], v4, s[16:19], s52 offen offset:1024 sc1
MAV 76,60,120
TR 26,7,42816
MAV 76,44,112
TR 28,7,42336
TR 30,7,42848
s_waitcnt lgkmcnt(8)
s_barrier
MAV 32,0,128
TR 32,6,33792
s_add_u32 m0, s55, 84480
MAV 32,16,136
buffer_load_dwordx4 v18, s[28:31], s54 offen lds
MAV 48,16,140
TR 34,6,34304
MAV 48,0,132
TR 36,6,33824
TR 38,6,34336
MAV 52,4,132
TR 48,6,42240
s_add_u32 s52, s77, 131072
MAV 52,20,140
buffer_load_dwordx4 v[112:115], v4, s[16:19], s52 offen sc1
MAV 36,20,136
TR 50,6,42752
MAV 36,4,128
TR 52,6,42272
TR 54,6,42784
s_waitcnt lgkmcnt(8)
MAV 40,8,128
TR 40,6,33856
MAV 40,24,136
buffer_load_dwordx4 v19, s[28:31], s54 offen offset:1056 lds
MAV 56,24,140
TR 42,6,34368
s_add_u32 s54, s99, 2621440
MAV 56,8,132
TR 44,6,33888
TR 46,6,34400
MAV 60,12,132
TR 56,6,42304
MAV 60,28,140
buffer_load_dwordx4 v[116:119], v4, s[16:19], s52 offen offset:1024 sc1
MAV 44,28,136
TR 58,6,42816
MAV 44,12,128
TR 60,6,42336
TR 62,6,42848
s_waitcnt lgkmcnt(8)
MAV 64,32,128
TR 0,7,50688
s_add_u32 m0, s55, 92928
MAV 64,48,136
buffer_load_dwordx4 v18, s[28:31], s54 offen lds
MAV 80,48,140
TR 2,7,51200
MAV 80,32,132
TR 4,7,50720
TR 6,7,51232
MAV 84,36,132
TR 16,7,59136
s_add_u32 s52, s77, 196608
MAV 84,52,140
buffer_load_dwordx4 v[120:123], v4, s[16:19], s52 offen sc1
MAV 68,52,136
TR 18,7,59648
MAV 68,36,128
TR 20,7,59168
TR 22,7,59680
s_waitcnt lgkmcnt(8)
MAV 72,40,128
TR 8,7,50752
MAV 72,56,136
buffer_load_dwordx4 v19, s[28:31], s54 offen offset:1056 lds
MAV 88,56,140
TR 10,7,51264
s_add_u32 s54, s100, 2818048
MAV 88,40,132
TR 12,7,50784
TR 14,7,51296
MAV 92,44,132
TR 24,7,59200
MAV 92,60,140
buffer_load_dwordx4 v[124:127], v4, s[16:19], s52 offen offset:1024 sc1
MAV 76,60,136
TR 26,7,59712
MAV 76,44,128
TR 28,7,59232
TR 30,7,59744
s_waitcnt vmcnt(16) lgkmcnt(8)
s_barrier
MAV 32,0,144
TR 32,6,50688
s_add_u32 m0, s55, 101376
MAV 32,16,152
buffer_load_dwordx4 v18, s[28:31], s54 offen lds
MAV 48,16,156
TR 34,6,51200
MAV 48,0,148
TR 36,6,50720
TR 38,6,51232
MAV 52,4,148
TR 48,6,59136
s_add_u32 s52, s78, 245760
MAV 52,20,156
buffer_load_dwordx4 v[128:131], v4, s[16:19], s52 offen sc1
MAV 36,20,152
TR 50,6,59648
MAV 36,4,144
TR 52,6,59168
TR 54,6,59680
s_waitcnt lgkmcnt(8)
MAV 40,8,144
TR 40,6,50752
MAV 40,24,152
buffer_load_dwordx4 v19, s[28:31], s54 offen offset:1056 lds
MAV 56,24,156
TR 42,6,51264
s_add_u32 s54, s100, 3080192
MAV 56,8,148
TR 44,6,50784
TR 46,6,51296
MAV 60,12,148
TR 56,6,59200
MAV 60,28,156
buffer_load_dwordx4 v[132:135], v4, s[16:19], s52 offen offset:1024 sc1
MAV 44,28,152
TR 58,6,59712
MAV 44,12,144
TR 60,6,59232
TR 62,6,59744
v_add_u32 v7, s57, v7
v_add_u32 v6, s57, v6
s_sub_u32 s57, 0, s57
s_waitcnt lgkmcnt(8)
MAV 64,32,144
ds_read_b64_tr_b16 a[0:1], v7
s_add_u32 m0, s55, 109824
MAV 64,48,152
buffer_load_dwordx4 v18, s[28:31], s54 offen lds
MAV 80,48,156
TR 2,7,512
MAV 80,32,148
TR 4,7,32
TR 6,7,544
MAV 84,36,148
TR 16,7,8448
s_add_u32 s52, s78, 311296
MAV 84,52,156
buffer_load_dwordx4 v[136:139], v4, s[16:19], s52 offen sc1
MAV 68,52,152
TR 18,7,8960
MAV 68,36,144
TR 20,7,8480
TR 22,7,8992
s_waitcnt lgkmcnt(8)
MAV 72,40,144
TR 8,7,64
MAV 72,56,152
buffer_load_dwordx4 v19, s[28:31], s54 offen offset:1056 lds
MAV 88,56,156
TR 10,7,576
s_add_u32 s54, s101, 3276800
MAV 88,40,148
TR 12,7,96
TR 14,7,608
MAV 92,44,148
TR 24,7,8512
MAV 92,60,156
buffer_load_dwordx4 v[140:143], v4, s[16:19], s52 offen offset:1024 sc1
MAV 76,60,152
TR 26,7,9024
MAV 76,44,144
TR 28,7,8544
TR 30,7,9056
s_waitcnt vmcnt(16) lgkmcnt(8)
s_barrier
MAV 32,0,96
ds_read_b64_tr_b16 a[32:33], v6
s_add_u32 m0, s55, 118272
MAV 32,16,104
buffer_load_dwordx4 v18, s[28:31], s54 offen lds
MAV 48,16,108
TR 34,6,512
MAV 48,0,100
TR 36,6,32
TR 38,6,544
MAV 52,4,100
TR 48,6,8448
s_add_u32 s52, s79, 360448
MAV 52,20,108
buffer_load_dwordx4 v[144:147], v4, s[16:19], s52 offen sc1
MAV 36,20,104
TR 50,6,8960
MAV 36,4,96
TR 52,6,8480
TR 54,6,8992
s_waitcnt lgkmcnt(8)
MAV 40,8,96
TR 40,6,64
MAV 40,24,104
buffer_load_dwordx4 v19, s[28:31], s54 offen offset:1056 lds
MAV 56,24,108
TR 42,6,576
s_add_u32 s54, s101, 3538944
MAV 56,8,100
TR 44,6,96
TR 46,6,608
MAV 60,12,100
TR 56,6,8512
MAV 60,28,108
buffer_load_dwordx4 v[148:151], v4, s[16:19], s52 offen offset:1024 sc1
MAV 44,28,104
TR 58,6,9024
MAV 44,12,96
TR 60,6,8544
TR 62,6,9056
s_waitcnt lgkmcnt(8)
MAV 64,32,96
TR 0,7,16896
s_add_u32 m0, s55, 126720
MAV 64,48,104
buffer_load_dwordx4 v18, s[28:31], s54 offen lds
MAV 80,48,108
TR 2,7,17408
MAV 80,32,100
TR 4,7,16928
TR 6,7,17440
MAV 84,36,100
TR 16,7,25344
s_add_u32 s52, s79, 425984
MAV 84,52,108
buffer_load_dwordx4 v[152:155], v4, s[16:19], s52 offen sc1
MAV 68,52,104
TR 18,7,25856
MAV 68,36,96
TR 20,7,25376
TR 22,7,25888
s_waitcnt lgkmcnt(8)
MAV 72,40,96
TR 8,7,16960
MAV 72,56,104
buffer_load_dwordx4 v19, s[28:31], s54 offen offset:1056 lds
MAV 88,56,108
TR 10,7,17472
s_add_u32 s54, s98, 131072
MAV 88,40,100
TR 12,7,16992
TR 14,7,17504
MAV 92,44,100
TR 24,7,25408
MAV 92,60,108
buffer_load_dwordx4 v[156:159], v4, s[16:19], s52 offen offset:1024 sc1
MAV 76,60,104
TR 26,7,25920
MAV 76,44,96
TR 28,7,25440
TR 30,7,25952
s_waitcnt vmcnt(16) lgkmcnt(8)
s_barrier
MAV 32,0,112
TR 32,6,16896
s_add_u32 m0, s55, 0
MAV 32,16,120
buffer_load_dwordx4 v18, s[28:31], s54 offen lds
MAV 48,16,124
TR 34,6,17408
MAV 48,0,116
TR 36,6,16928
TR 38,6,17440
MAV 52,4,116
TR 48,6,25344
s_add_u32 s52, s76, 475136
MAV 52,20,124
buffer_load_dwordx4 v[96:99], v4, s[16:19], s52 offen sc1
MAV 36,20,120
TR 50,6,25856
MAV 36,4,112
TR 52,6,25376
TR 54,6,25888
s_waitcnt lgkmcnt(8)
MAV 40,8,112
TR 40,6,16960
MAV 40,24,120
buffer_load_dwordx4 v19, s[28:31], s54 offen offset:1056 lds
MAV 56,24,124
TR 42,6,17472
s_add_u32 s54, s98, 393216
MAV 56,8,116
TR 44,6,16992
TR 46,6,17504
MAV 60,12,116
TR 56,6,25408
MAV 60,28,124
buffer_load_dwordx4 v[100:103], v4, s[16:19], s52 offen offset:1024 sc1
MAV 44,28,120
TR 58,6,25920
MAV 44,12,112
TR 60,6,25440
TR 62,6,25952
s_waitcnt lgkmcnt(8)
MAV 64,32,112
TR 0,7,33792
s_add_u32 m0, s55, 8448
MAV 64,48,120
buffer_load_dwordx4 v18, s[28:31], s54 offen lds
MAV 80,48,124
TR 2,7,34304
MAV 80,32,116
TR 4,7,33824
TR 6,7,34336
MAV 84,36,116
TR 16,7,42240
s_add_u32 s52, s76, 540672
MAV 84,52,124
buffer_load_dwordx4 v[104:107], v4, s[16:19], s52 offen sc1
MAV 68,52,120
TR 18,7,42752
MAV 68,36,112
TR 20,7,42272
TR 22,7,42784
s_waitcnt lgkmcnt(8)
MAV 72,40,112
TR 8,7,33856
MAV 72,56,120
buffer_load_dwordx4 v19, s[28:31], s54 offen offset:1056 lds
MAV 88,56,124
TR 10,7,34368
s_add_u32 s54, s99, 589824
MAV 88,40,116
TR 12,7,33888
TR 14,7,34400
MAV 92,44,116
TR 24,7,42304
MAV 92,60,124
buffer_load_dwordx4 v[108:111], v4, s[16:19], s52 offen offset:1024 sc1
MAV 76,60,120
TR 26,7,42816
MAV 76,44,112
TR 28,7,42336
TR 30,7,42848
s_waitcnt vmcnt(16) lgkmcnt(8)
s_barrier
MAV 32,0,128
TR 32,6,33792
s_add_u32 m0, s55, 16896
MAV 32,16,136
buffer_load_dwordx4 v18, s[28:31], s54 offen lds
MAV 48,16,140
TR 34,6,34304
MAV 48,0,132
TR 36,6,33824
TR 38,6,34336
MAV 52,4,132
TR 48,6,42240
s_add_u32 s52, s77, 589824
MAV 52,20,140
buffer_load_dwordx4 v[112:115], v4, s[16:19], s52 offen sc1
MAV 36,20,136
TR 50,6,42752
MAV 36,4,128
TR 52,6,42272
TR 54,6,42784
s_waitcnt lgkmcnt(8)
MAV 40,8,128
TR 40,6,33856
MAV 40,24,136
buffer_load_dwordx4 v19, s[28:31], s54 offen offset:1056 lds
MAV 56,24,140
TR 42,6,34368
s_add_u32 s54, s99, 851968
MAV 56,8,132
TR 44,6,33888
TR 46,6,34400
MAV 60,12,132
TR 56,6,42304
MAV 60,28,140
buffer_load_dwordx4 v[116:119], v4, s[16:19], s52 offen offset:1024 sc1
MAV 44,28,136
TR 58,6,42816
MAV 44,12,128
TR 60,6,42336
TR 62,6,42848
s_waitcnt lgkmcnt(8)
MAV 64,32,128
TR 0,7,50688
s_add_u32 m0, s55, 25344
MAV 64,48,136
buffer_load_dwordx4 v18, s[28:31], s54 offen lds
MAV 80,48,140
TR 2,7,51200
MAV 80,32,132
TR 4,7,50720
TR 6,7,51232
MAV 84,36,132
TR 16,7,59136
s_add_u32 s52, s77, 655360
MAV 84,52,140
buffer_load_dwordx4 v[120:123], v4, s[16:19], s52 offen sc1
MAV 68,52,136
TR 18,7,59648
MAV 68,36,128
TR 20,7,59168
TR 22,7,59680
s_waitcnt lgkmcnt(8)
MAV 72,40,128
TR 8,7,50752
MAV 72,56,136
buffer_load_dwordx4 v19, s[28:31], s54 offen offset:1056 lds
MAV 88,56,140
TR 10,7,51264
s_add_u32 s54, s100, 1048576
MAV 88,40,132
TR 12,7,50784
TR 14,7,51296
MAV 92,44,132
TR 24,7,59200
MAV 92,60,140
buffer_load_dwordx4 v[124:127], v4, s[16:19], s52 offen offset:1024 sc1
MAV 76,60,136
TR 26,7,59712
MAV 76,44,128
TR 28,7,59232
TR 30,7,59744
s_waitcnt vmcnt(16) lgkmcnt(8)
s_barrier
MAV 32,0,144
TR 32,6,50688
s_add_u32 m0, s55, 33792
MAV 32,16,152
buffer_load_dwordx4 v18, s[28:31], s54 offen lds
MAV 48,16,156
TR 34,6,51200
MAV 48,0,148
TR 36,6,50720
TR 38,6,51232
MAV 52,4,148
TR 48,6,59136
s_add_u32 s52, s78, 704512
MAV 52,20,156
buffer_load_dwordx4 v[128:131], v4, s[16:19], s52 offen sc1
MAV 36,20,152
TR 50,6,59648
MAV 36,4,144
TR 52,6,59168
TR 54,6,59680
s_waitcnt lgkmcnt(8)
MAV 40,8,144
TR 40,6,50752
MAV 40,24,152
buffer_load_dwordx4 v19, s[28:31], s54 offen offset:1056 lds
MAV 56,24,156
TR 42,6,51264
s_add_u32 s54, s100, 1310720
MAV 56,8,148
TR 44,6,50784
TR 46,6,51296
MAV 60,12,148
TR 56,6,59200
MAV 60,28,156
buffer_load_dwordx4 v[132:135], v4, s[16:19], s52 offen offset:1024 sc1
MAV 44,28,152
TR 58,6,59712
MAV 44,12,144
TR 60,6,59232
TR 62,6,59744
v_add_u32 v7, s57, v7
v_add_u32 v6, s57, v6
s_sub_u32 s57, 0, s57
s_waitcnt lgkmcnt(8)
MAV 64,32,144
ds_read_b64_tr_b16 a[0:1], v7
s_add_u32 m0, s55, 42240
MAV 64,48,152
buffer_load_dwordx4 v18, s[28:31], s54 offen lds
MAV 80,48,156
TR 2,7,512
MAV 80,32,148
TR 4,7,32
TR 6,7,544
MAV 84,36,148
TR 16,7,8448
s_add_u32 s52, s78, 770048
MAV 84,52,156
buffer_load_dwordx4 v[136:139], v4, s[16:19], s52 offen sc1
MAV 68,52,152
TR 18,7,8960
MAV 68,36,144
TR 20,7,8480
TR 22,7,8992
s_waitcnt lgkmcnt(8)
MAV 72,40,144
TR 8,7,64
MAV 72,56,152
buffer_load_dwordx4 v19, s[28:31], s54 offen offset:1056 lds
MAV 88,56,156
TR 10,7,576
s_add_u32 s54, s101, 1507328
MAV 88,40,148
TR 12,7,96
TR 14,7,608
MAV 92,44,148
TR 24,7,8512
MAV 92,60,156
buffer_load_dwordx4 v[140:143], v4, s[16:19], s52 offen offset:1024 sc1
MAV 76,60,152
TR 26,7,9024
MAV 76,44,144
TR 28,7,8544
TR 30,7,9056
s_waitcnt vmcnt(16) lgkmcnt(8)
s_barrier
MAV 32,0,96
ds_read_b64_tr_b16 a[32:33], v6
s_add_u32 m0, s55, 50688
MAV 32,16,104
buffer_load_dwordx4 v18, s[28:31], s54 offen lds
MAV 48,16,108
TR 34,6,512
MAV 48,0,100
.Lpad37:
s_cbranch_execz .Lnopoll63r
TR 36,6,32
TR 38,6,544
MAV 52,4,100
TR 48,6,8448
s_add_u32 s52, s79, 819200
MAV 52,20,108
buffer_load_dwordx4 v[144:147], v4, s[16:19], s52 offen sc1
MAV 36,20,104
TR 50,6,8960
MAV 36,4,96
TR 52,6,8480
TR 54,6,8992
s_waitcnt lgkmcnt(8)
MAV 40,8,96
TR 40,6,64
MAV 40,24,104
buffer_load_dwordx4 v19, s[28:31], s54 offen offset:1056 lds
MAV 56,24,108
TR 42,6,576
s_add_u32 s54, s101, 1769472
MAV 56,8,100
TR 44,6,96
TR 46,6,608
MAV 60,12,100
TR 56,6,8512
MAV 60,28,108
buffer_load_dwordx4 v[148:151], v4, s[16:19], s52 offen offset:1024 sc1
MAV 44,28,104
TR 58,6,9024
MAV 44,12,96
TR 60,6,8544
TR 62,6,9056
s_waitcnt lgkmcnt(8)
MAV 64,32,96
TR 0,7,16896
s_add_u32 m0, s55, 59136
MAV 64,48,104
buffer_load_dwordx4 v18, s[28:31], s54 offen lds
MAV 80,48,108
TR 2,7,17408
MAV 80,32,100
TR 4,7,16928
TR 6,7,17440
MAV 84,36,100
TR 16,7,25344
s_add_u32 s52, s79, 884736
MAV 84,52,108
buffer_load_dwordx4 v[152:155], v4, s[16:19], s52 offen sc1
MAV 68,52,104
TR 18,7,25856
MAV 68,36,96
TR 20,7,25376
TR 22,7,25888
s_waitcnt lgkmcnt(8)
MAV 72,40,96
TR 8,7,16960
MAV 72,56,104
buffer_load_dwordx4 v19, s[28:31], s54 offen offset:1056 lds
MAV 88,56,108
TR 10,7,17472
s_add_u32 s54, s98, 1966080
MAV 88,40,100
TR 12,7,16992
TR 14,7,17504
MAV 92,44,100
TR 24,7,25408
MAV 92,60,108
buffer_load_dwordx4 v[156:159], v4, s[16:19], s52 offen offset:1024 sc1
MAV 76,60,104
TR 26,7,25920
MAV 76,44,96
TR 28,7,25440
TR 30,7,25952
s_waitcnt vmcnt(16) lgkmcnt(8)
s_barrier
MAV 32,0,112
TR 32,6,16896
s_add_u32 m0, s55, 67584
MAV 32,16,120
buffer_load_dwordx4 v18, s[28:31], s54 offen lds
MAV 48,16,124
TR 34,6,17408
MAV 48,0,116
TR 36,6,16928
TR 38,6,17440
MAV 52,4,116
TR 48,6,25344
s_add_u32 s52, s76, 32768
MAV 52,20,124
buffer_load_dwordx4 v[96:99], v4, s[16:19], s52 offen sc1
MAV 36,20,120
TR 50,6,25856
MAV 36,4,112
TR 52,6,25376
TR 54,6,25888
s_waitcnt lgkmcnt(8)
MAV 40,8,112
TR 40,6,16960
MAV 40,24,120
buffer_load_dwordx4 v19, s[28:31], s54 offen offset:1056 lds
MAV 56,24,124
TR 42,6,17472
s_add_u32 s54, s98, 2228224
MAV 56,8,116
TR 44,6,16992
TR 46,6,17504
MAV 60,12,116
TR 56,6,25408
MAV 60,28,124
buffer_load_dwordx4 v[100:103], v4, s[16:19], s52 offen offset:1024 sc1
MAV 44,28,120
TR 58,6,25920
MAV 44,12,112
TR 60,6,25440
TR 62,6,25952
s_waitcnt lgkmcnt(8)
MAV 64,32,112
TR 0,7,33792
s_add_u32 m0, s55, 76032
MAV 64,48,120
buffer_load_dwordx4 v18, s[28:31], s54 offen lds
MAV 80,48,124
TR 2,7,34304
MAV 80,32,116
TR 4,7,33824
TR 6,7,34336
MAV 84,36,116
TR 16,7,42240
s_add_u32 s52, s76, 98304
MAV 84,52,124
buffer_load_dwordx4 v[104:107], v4, s[16:19], s52 offen sc1
MAV 68,52,120
TR 18,7,42752
MAV 68,36,112
TR 20,7,42272
TR 22,7,42784
s_waitcnt lgkmcnt(8)
MAV 72,40,112
TR 8,7,33856
MAV 72,56,120
buffer_load_dwordx4 v19, s[28:31], s54 offen offset:1056 lds
MAV 88,56,124
TR 10,7,34368
s_add_u32 s54, s99, 2424832
MAV 88,40,116
TR 12,7,33888
TR 14,7,34400
MAV 92,44,116
TR 24,7,42304
MAV 92,60,124
buffer_load_dwordx4 v[108:111], v4, s[16:19], s52 offen offset:1024 sc1
MAV 76,60,120
TR 26,7,42816
MAV 76,44,112
TR 28,7,42336
TR 30,7,42848
s_waitcnt vmcnt(16) lgkmcnt(8)
s_barrier
MAV 32,0,128
TR 32,6,33792
s_add_u32 m0, s55, 84480
MAV 32,16,136
buffer_load_dwordx4 v18, s[28:31], s54 offen lds
MAV 48,16,140
TR 34,6,34304
MAV 48,0,132
TR 36,6,33824
TR 38,6,34336
MAV 52,4,132
TR 48,6,42240
s_add_u32 s52, s77, 147456
MAV 52,20,140
buffer_load_dwordx4 v[112:115], v4, s[16:19], s52 offen sc1
MAV 36,20,136
TR 50,6,42752
MAV 36,4,128
TR 52,6,42272
TR 54,6,42784
s_waitcnt lgkmcnt(8)
MAV 40,8,128
TR 40,6,33856
MAV 40,24,136
buffer_load_dwordx4 v19, s[28:31], s54 offen offset:1056 lds
MAV 56,24,140
TR 42,6,34368
s_add_u32 s54, s99, 2686976
MAV 56,8,132
TR 44,6,33888
TR 46,6,34400
MAV 60,12,132
TR 56,6,42304
MAV 60,28,140
buffer_load_dwordx4 v[116:119], v4, s[16:19], s52 offen offset:1024 sc1
MAV 44,28,136
TR 58,6,42816
MAV 44,12,128
TR 60,6,42336
TR 62,6,42848
s_waitcnt lgkmcnt(8)
MAV 64,32,128
TR 0,7,50688
s_add_u32 m0, s55, 92928
MAV 64,48,136
buffer_load_dwordx4 v18, s[28:31], s54 offen lds
MAV 80,48,140
TR 2,7,51200
MAV 80,32,132
TR 4,7,50720
TR 6,7,51232
MAV 84,36,132
TR 16,7,59136
s_add_u32 s52, s77, 212992
MAV 84,52,140
buffer_load_dwordx4 v[120:123], v4, s[16:19], s52 offen sc1
MAV 68,52,136
TR 18,7,59648
MAV 68,36,128
TR 20,7,59168
TR 22,7,59680
s_waitcnt lgkmcnt(8)
MAV 72,40,128
TR 8,7,50752
MAV 72,56,136
buffer_load_dwordx4 v19, s[28:31], s54 offen offset:1056 lds
MAV 88,56,140
TR 10,7,51264
s_add_u32 s54, s100, 2883584
MAV 88,40,132
TR 12,7,50784
TR 14,7,51296
MAV 92,44,132
TR 24,7,59200
MAV 92,60,140
buffer_load_dwordx4 v[124:127], v4, s[16:19], s52 offen offset:1024 sc1
MAV 76,60,136
TR 26,7,59712
MAV 76,44,128
TR 28,7,59232
TR 30,7,59744
s_waitcnt vmcnt(16) lgkmcnt(8)
s_barrier
MAV 32,0,144
TR 32,6,50688
s_add_u32 m0, s55, 101376
MAV 32,16,152
buffer_load_dwordx4 v18, s[28:31], s54 offen lds
MAV 48,16,156
TR 34,6,51200
MAV 48,0,148
TR 36,6,50720
TR 38,6,51232
MAV 52,4,148
TR 48,6,59136
s_add_u32 s52, s78, 262144
MAV 52,20,156
buffer_load_dwordx4 v[128:131], v4, s[16:19], s52 offen sc1
MAV 36,20,152
TR 50,6,59648
MAV 36,4,144
TR 52,6,59168
TR 54,6,59680
s_waitcnt lgkmcnt(8)
MAV 40,8,144
TR 40,6,50752
MAV 40,24,152
buffer_load_dwordx4 v19, s[28:31], s54 offen offset:1056 lds
MAV 56,24,156
TR 42,6,51264
s_add_u32 s54, s100, 3145728
MAV 56,8,148
TR 44,6,50784
TR 46,6,51296
MAV 60,12,148
TR 56,6,59200
MAV 60,28,156
buffer_load_dwordx4 v[132:135], v4, s[16:19], s52 offen offset:1024 sc1
MAV 44,28,152
TR 58,6,59712
MAV 44,12,144
TR 60,6,59232
TR 62,6,59744
v_add_u32 v7, s57, v7
v_add_u32 v6, s57, v6
s_sub_u32 s57, 0, s57
s_waitcnt lgkmcnt(8)
MAV 64,32,144
ds_read_b64_tr_b16 a[0:1], v7
s_add_u32 m0, s55, 109824
MAV 64,48,152
buffer_load_dwordx4 v18, s[28:31], s54 offen lds
MAV 80,48,156
TR 2,7,512
MAV 80,32,148
TR 4,7,32
TR 6,7,544
MAV 84,36,148
TR 16,7,8448
s_add_u32 s52, s78, 327680
MAV 84,52,156
buffer_load_dwordx4 v[136:139], v4, s[16:19], s52 offen sc1
MAV 68,52,152
TR 18,7,8960
MAV 68,36,144
TR 20,7,8480
TR 22,7,8992
s_waitcnt lgkmcnt(8)
MAV 72,40,144
TR 8,7,64
MAV 72,56,152
buffer_load_dwordx4 v19, s[28:31], s54 offen offset:1056 lds
MAV 88,56,156
TR 10,7,576
s_add_u32 s54, s101, 3342336
MAV 88,40,148
TR 12,7,96
TR 14,7,608
MAV 92,44,148
TR 24,7,8512
MAV 92,60,156
buffer_load_dwordx4 v[140:143], v4, s[16:19], s52 offen offset:1024 sc1
MAV 76,60,152
TR 26,7,9024
MAV 76,44,144
TR 28,7,8544
TR 30,7,9056
s_waitcnt vmcnt(16) lgkmcnt(8)
s_barrier
MAV 32,0,96
ds_read_b64_tr_b16 a[32:33], v6
s_add_u32 m0, s55, 118272
MAV 32,16,104
buffer_load_dwordx4 v18, s[28:31], s54 offen lds
MAV 48,16,108
TR 34,6,512
MAV 48,0,100
TR 36,6,32
TR 38,6,544
MAV 52,4,100
TR 48,6,8448
s_add_u32 s52, s79, 376832
MAV 52,20,108
buffer_load_dwordx4 v[144:147], v4, s[16:19], s52 offen sc1
MAV 36,20,104
TR 50,6,8960
MAV 36,4,96
TR 52,6,8480
TR 54,6,8992
s_waitcnt lgkmcnt(8)
MAV 40,8,96
TR 40,6,64
MAV 40,24,104
buffer_load_dwordx4 v19, s[28:31], s54 offen offset:1056 lds
MAV 56,24,108
TR 42,6,576
s_add_u32 s54, s101, 3604480
MAV 56,8,100
TR 44,6,96
TR 46,6,608
MAV 60,12,100
TR 56,6,8512
MAV 60,28,108
buffer_load_dwordx4 v[148:151], v4, s[16:19], s52 offen offset:1024 sc1
MAV 44,28,104
TR 58,6,9024
MAV 44,12,96
TR 60,6,8544
TR 62,6,9056
s_waitcnt lgkmcnt(8)
MAV 64,32,96
TR 0,7,16896
s_add_u32 m0, s55, 126720
MAV 64,48,104
buffer_load_dwordx4 v18, s[28:31], s54 offen lds
MAV 80,48,108
TR 2,7,17408
MAV 80,32,100
TR 4,7,16928
TR 6,7,17440
MAV 84,36,100
TR 16,7,25344
s_add_u32 s52, s79, 442368
MAV 84,52,108
buffer_load_dwordx4 v[152:155], v4, s[16:19], s52 offen sc1
MAV 68,52,104
TR 18,7,25856
MAV 68,36,96
TR 20,7,25376
TR 22,7,25888
s_waitcnt lgkmcnt(8)
MAV 72,40,96
TR 8,7,16960
MAV 72,56,104
buffer_load_dwordx4 v19, s[28:31], s54 offen offset:1056 lds
MAV 88,56,108
TR 10,7,17472
s_add_u32 s54, s98, 196608
MAV 88,40,100
TR 12,7,16992
TR 14,7,17504
MAV 92,44,100
TR 24,7,25408
MAV 92,60,108
buffer_load_dwordx4 v[156:159], v4, s[16:19], s52 offen offset:1024 sc1
MAV 76,60,104
TR 26,7,25920
MAV 76,44,96
TR 28,7,25440
TR 30,7,25952
s_waitcnt vmcnt(16) lgkmcnt(8)
s_barrier
MAV 32,0,112
TR 32,6,16896
s_add_u32 m0, s55, 0
MAV 32,16,120
buffer_load_dwordx4 v18, s[28:31], s54 offen lds
MAV 48,16,124
TR 34,6,17408
MAV 48,0,116
TR 36,6,16928
TR 38,6,17440
MAV 52,4,116
TR 48,6,25344
s_add_u32 s52, s76, 491520
MAV 52,20,124
buffer_load_dwordx4 v[96:99], v4, s[16:19], s52 offen sc1
MAV 36,20,120
TR 50,6,25856
MAV 36,4,112
TR 52,6,25376
TR 54,6,25888
s_waitcnt lgkmcnt(8)
MAV 40,8,112
TR 40,6,16960
MAV 40,24,120
buffer_load_dwordx4 v19, s[28:31], s54 offen offset:1056 lds
MAV 56,24,124
TR 42,6,17472
s_add_u32 s54, s99, 655360
MAV 56,8,116
TR 44,6,16992
TR 46,6,17504
MAV 60,12,116
TR 56,6,25408
MAV 60,28,124
buffer_load_dwordx4 v[100:103], v4, s[16:19], s52 offen offset:1024 sc1
MAV 44,28,120
TR 58,6,25920
MAV 44,12,112
TR 60,6,25440
TR 62,6,25952
s_waitcnt lgkmcnt(8)
MAV 64,32,112
TR 0,7,33792
s_add_u32 m0, s55, 8448
MAV 64,48,120
buffer_load_dwordx4 v18, s[28:31], s54 offen lds
MAV 80,48,124
TR 2,7,34304
MAV 80,32,116
TR 4,7,33824
TR 6,7,34336
MAV 84,36,116
TR 16,7,42240
s_add_u32 s52, s76, 557056
MAV 84,52,124
buffer_load_dwordx4 v[104:107], v4, s[16:19], s52 offen sc1
MAV 68,52,120
TR 18,7,42752
MAV 68,36,112
TR 20,7,42272
TR 22,7,42784
s_waitcnt lgkmcnt(8)
MAV 72,40,112
TR 8,7,33856
MAV 72,56,120
buffer_load_dwordx4 v19, s[28:31], s54 offen offset:1056 lds
MAV 88,56,124
TR 10,7,34368
s_add_u32 s54, s100, 1114112
MAV 88,40,116
TR 12,7,33888
TR 14,7,34400
MAV 92,44,116
TR 24,7,42304
MAV 92,60,124
buffer_load_dwordx4 v[108:111], v4, s[16:19], s52 offen offset:1024 sc1
MAV 76,60,120
TR 26,7,42816
MAV 76,44,112
TR 28,7,42336
TR 30,7,42848
s_waitcnt vmcnt(16) lgkmcnt(8)
s_barrier
MAV 32,0,128
TR 32,6,33792
s_add_u32 m0, s55, 16896
MAV 32,16,136
buffer_load_dwordx4 v18, s[28:31], s54 offen lds
MAV 48,16,140
TR 34,6,34304
MAV 48,0,132
TR 36,6,33824
TR 38,6,34336
MAV 52,4,132
TR 48,6,42240
s_add_u32 s52, s77, 606208
MAV 52,20,140
buffer_load_dwordx4 v[112:115], v4, s[16:19], s52 offen sc1
MAV 36,20,136
TR 50,6,42752
MAV 36,4,128
TR 52,6,42272
TR 54,6,42784
s_waitcnt lgkmcnt(8)
MAV 40,8,128
TR 40,6,33856
MAV 40,24,136
buffer_load_dwordx4 v19, s[28:31], s54 offen offset:1056 lds
MAV 56,24,140
TR 42,6,34368
s_add_u32 s54, s101, 1572864
MAV 56,8,132
TR 44,6,33888
TR 46,6,34400
MAV 60,12,132
TR 56,6,42304
MAV 60,28,140
buffer_load_dwordx4 v[116:119], v4, s[16:19], s52 offen offset:1024 sc1
MAV 44,28,136
.Lpad38:
s_cbranch_execz .Lnopoll63r
TR 58,6,42816
MAV 44,12,128
TR 60,6,42336
TR 62,6,42848
s_waitcnt lgkmcnt(8)
MAV 64,32,128
TR 0,7,50688
s_add_u32 m0, s55, 25344
MAV 64,48,136
buffer_load_dwordx4 v18, s[28:31], s54 offen lds
MAV 80,48,140
TR 2,7,51200
MAV 80,32,132
TR 4,7,50720
TR 6,7,51232
MAV 84,36,132
TR 16,7,59136
s_add_u32 s52, s77, 671744
MAV 84,52,140
buffer_load_dwordx4 v[120:123], v4, s[16:19], s52 offen sc1
MAV 68,52,136
TR 18,7,59648
MAV 68,36,128
TR 20,7,59168
TR 22,7,59680
s_waitcnt lgkmcnt(8)
MAV 72,40,128
TR 8,7,50752
MAV 72,56,136
buffer_load_dwordx4 v19, s[28:31], s54 offen offset:1056 lds
MAV 88,56,140
TR 10,7,51264
s_add_u32 s54, s98, 2031616
MAV 88,40,132
TR 12,7,50784
TR 14,7,51296
MAV 92,44,132
TR 24,7,59200
MAV 92,60,140
buffer_load_dwordx4 v[124:127], v4, s[16:19], s52 offen offset:1024 sc1
MAV 76,60,136
TR 26,7,59712
MAV 76,44,128
TR 28,7,59232
TR 30,7,59744
s_waitcnt vmcnt(16) lgkmcnt(8)
s_barrier
MAV 32,0,144
TR 32,6,50688
s_add_u32 m0, s55, 33792
MAV 32,16,152
buffer_load_dwordx4 v18, s[28:31], s54 offen lds
MAV 48,16,156
TR 34,6,51200
MAV 48,0,148
TR 36,6,50720
TR 38,6,51232
MAV 52,4,148
TR 48,6,59136
s_add_u32 s52, s78, 720896
MAV 52,20,156
buffer_load_dwordx4 v[128:131], v4, s[16:19], s52 offen sc1
MAV 36,20,152
TR 50,6,59648
MAV 36,4,144
TR 52,6,59168
TR 54,6,59680
s_waitcnt lgkmcnt(8)
MAV 40,8,144
TR 40,6,50752
MAV 40,24,152
buffer_load_dwordx4 v19, s[28:31], s54 offen offset:1056 lds
MAV 56,24,156
TR 42,6,51264
s_add_u32 s54, s99, 2490368
MAV 56,8,148
TR 44,6,50784
TR 46,6,51296
MAV 60,12,148
TR 56,6,59200
MAV 60,28,156
buffer_load_dwordx4 v[132:135], v4, s[16:19], s52 offen offset:1024 sc1
MAV 44,28,152
TR 58,6,59712
MAV 44,12,144
TR 60,6,59232
TR 62,6,59744
v_add_u32 v7, s57, v7
v_add_u32 v6, s57, v6
s_sub_u32 s57, 0, s57
s_waitcnt lgkmcnt(8)
MAV 64,32,144
ds_read_b64_tr_b16 a[0:1], v6
s_add_u32 m0, s55, 42240
MAV 64,48,152
buffer_load_dwordx4 v18, s[28:31], s54 offen lds
MAV 80,48,156
TR 2,6,512
MAV 80,32,148
TR 4,6,32
TR 6,6,544
MAV 84,36,148
TR 16,6,8448
s_add_u32 s52, s78, 786432
MAV 84,52,156
buffer_load_dwordx4 v[136:139], v4, s[16:19], s52 offen sc1
MAV 68,52,152
TR 18,6,8960
MAV 68,36,144
TR 20,6,8480
TR 22,6,8992
s_waitcnt lgkmcnt(8)
MAV 72,40,144
TR 8,6,64
MAV 72,56,152
buffer_load_dwordx4 v19, s[28:31], s54 offen offset:1056 lds
MAV 88,56,156
TR 10,6,576
s_add_u32 s54, s100, 2949120
MAV 88,40,148
TR 12,6,96
TR 14,6,608
MAV 92,44,148
TR 24,6,8512
MAV 92,60,156
buffer_load_dwordx4 v[140:143], v4, s[16:19], s52 offen offset:1024 sc1
MAV 76,60,152
TR 26,6,9024
MAV 76,44,144
TR 28,6,8544
TR 30,6,9056
s_waitcnt vmcnt(16) lgkmcnt(8)
s_barrier
MAV 64,0,96
TR 32,6,16896
TR 34,6,17408
s_add_u32 m0, s55, 50688
MAV 64,16,104
TR 36,6,16928
buffer_load_dwordx4 v18, s[28:31], s54 offen lds
MAV 80,16,108
TR 38,6,17440
MAV 80,0,100
TR 48,6,25344
buffer_load_dwordx4 v19, s[28:31], s54 offen offset:1056 lds
MAV 84,4,100
TR 50,6,25856
s_add_u32 s54, s101, 3407872
s_add_u32 s52, s79, 835584
MAV 84,20,108
buffer_load_dwordx4 v[144:147], v4, s[16:19], s52 offen sc1
MAV 68,20,104
TR 52,6,25376
TR 54,6,25888
MAV 68,4,96
TR 40,6,16960
s_waitcnt lgkmcnt(9)
MAV 72,8,96
TR 42,6,17472
MAV 72,24,104
TR 44,6,16992
buffer_load_dwordx4 v[148:151], v4, s[16:19], s52 offen offset:1024 sc1
MAV 88,24,108
TR 46,6,17504
s_add_u32 m0, s55, 59136
MAV 88,8,100
TR 56,6,25408
buffer_load_dwordx4 v18, s[28:31], s54 offen lds
MAV 92,12,100
TR 58,6,25920
MAV 92,28,108
TR 60,6,25440
buffer_load_dwordx4 v19, s[28:31], s54 offen offset:1056 lds
MAV 76,28,104
TR 62,6,25952
s_add_u32 s52, s79, 901120
MAV 76,12,96
buffer_load_dwordx4 v[152:155], v4, s[16:19], s52 offen sc1
buffer_load_dwordx4 v[156:159], v4, s[16:19], s52 offen offset:1024 sc1
s_waitcnt vmcnt(16) lgkmcnt(8)
MAV 64,32,112
TR 0,6,33792
s_add_u32 s52, s76, 49152
s_lshl_b32 s70, s2, 10
s_lshl_b32 s62, s3, 7
MAV 64,48,120
buffer_load_dwordx4 v[160:163], v4, s[16:19], s52 offen sc1
s_add_u32 s70, s70, s62
MAV 80,48,124
TR 2,6,34304
s_add_u32 s70, s70, 31457280
MAV 80,32,116
TR 4,6,33824
TR 6,6,34336
s_xor_b32 s71, s70, 1024
MAV 84,36,116
TR 16,6,42240
v_min_u32 v26, 1, v1
MAV 84,52,124
buffer_load_dwordx4 v[164:167], v4, s[16:19], s52 offen offset:1024 sc1
v_lshlrev_b32 v26, 28, v26
MAV 68,52,120
TR 18,6,42752
v_mov_b32 v30, 1
MAV 68,36,112
TR 20,6,42272
TR 22,6,42784
v_mov_b32 v31, 0
s_waitcnt lgkmcnt(8)
MAV 72,40,112
TR 8,6,33856
s_add_u32 s52, s77, 163840
s_lshl_b32 s68, s7, 18
MAV 72,56,120
buffer_load_dwordx4 v[168:171], v4, s[16:19], s52 offen sc1
s_add_u32 s68, s68, 142606336
MAV 88,56,124
TR 10,6,34368
s_xor_b32 s69, s68, 262144
MAV 88,40,116
TR 12,6,33888
TR 14,6,34400
v_and_b32 v2, 1, v1
MAV 92,44,116
TR 24,6,42304
v_lshlrev_b32 v2, 4, v2
MAV 92,60,124
buffer_load_dwordx4 v[172:175], v4, s[16:19], s52 offen offset:1024 sc1
v_mov_b32 v224, 0x3f80
MAV 76,60,120
TR 26,6,42816
v_lshlrev_b32 v2, v2, v224
v_bfe_u32 v224, v1, 2, 2
MAV 76,44,112
TR 28,6,42336
TR 30,6,42848
s_waitcnt vmcnt(12) lgkmcnt(8)
MAV 64,0,128
TR 32,6,50688
s_add_u32 s52, s78, 278528
v_lshrrev_b32 v225, 4, v1
v_cmp_eq_u32 vcc, v224, v225
MAV 64,16,136
buffer_load_dwordx4 v[176:179], v4, s[16:19], s52 offen sc1
v_cndmask_b32 v2, 0, v2, vcc
MAV 80,16,140
TR 34,6,51200
v_and_b32 v224, 2, v1
MAV 80,0,132
TR 36,6,50720
TR 38,6,51232
v_cmp_eq_u32 vcc, 0, v224
MAV 84,4,132
TR 48,6,59136
v_cndmask_b32 v226, 0, v2, vcc
MAV 84,20,140
buffer_load_dwordx4 v[180:183], v4, s[16:19], s52 offen offset:1024 sc1
v_cndmask_b32 v227, v2, 0, vcc
MAV 68,20,136
TR 50,6,59648
v_mov_b32 v224, 0
MAV 68,4,128
TR 52,6,59168
TR 54,6,59680
v_mov_b32 v225, 0
s_waitcnt lgkmcnt(8)
MAV 72,8,128
TR 40,6,50752
s_add_u32 s52, s79, 393216
v_mov_b32 v228, 0
MAV 72,24,136
buffer_load_dwordx4 v[184:187], v4, s[16:19], s52 offen sc1
v_mov_b32 v229, 0
MAV 88,24,140
TR 42,6,51264
s_lshr_b32 s62, s6, 1
MAV 88,8,132
TR 44,6,50784
TR 46,6,51296
s_lshl_b32 s62, s62, 8
MAV 92,12,132
TR 56,6,59200
s_and_b32 s67, s6, 1
MAV 92,28,140
buffer_load_dwordx4 v[188:191], v4, s[16:19], s52 offen offset:1024 sc1
s_add_u32 s62, s62, s67
MAV 76,28,136
TR 58,6,59712
s_lshl_b32 s62, s62, 11
s_lshl_b32 s63, s3, 17
MAV 76,12,128
TR 60,6,59232
TR 62,6,59744
s_waitcnt vmcnt(8) lgkmcnt(8)
s_barrier
v_add_u32 v6, s57, v6
MAV 64,32,144
ds_read_b64_tr_b16 a[0:1], v6
s_add_u32 s52, s76, 507904
s_add_u32 s62, s62, s63
s_lshl_b32 s63, s7, 7
MAV 64,48,152
buffer_load_dwordx4 v[192:195], v4, s[16:19], s52 offen sc1
s_add_u32 s62, s62, s63
MAV 80,48,156
TR 2,6,512
s_mov_b32 s64, 0x8000
MAV 80,32,148
TR 4,6,32
TR 6,6,544
v_lshrrev_b32 v21, 3, v1
MAV 84,36,148
TR 16,6,8448
v_and_b32 v2, 7, v1
MAV 84,52,156
buffer_load_dwordx4 v[196:199], v4, s[16:19], s52 offen offset:1024 sc1
v_lshlrev_b32 v2, 4, v2
MAV 68,52,152
TR 18,6,8960
v_lshl_add_u32 v16, v21, 12, v2
MAV 68,36,144
TR 20,6,8480
TR 22,6,8992
v_add_u32 v16, s62, v16
s_waitcnt lgkmcnt(8)
MAV 72,40,144
TR 8,6,64
s_add_u32 s52, s77, 622592
v_add_u32 v17, 0x10000, v16
MAV 72,56,152
buffer_load_dwordx4 v[200:203], v4, s[16:19], s52 offen sc1
s_mul_i32 s62, s3, 4608
MAV 88,56,156
TR 10,6,576
s_add_u32 s62, s62, 135168
MAV 88,40,148
TR 12,6,96
TR 14,6,608
v_mul_u32_u24 v21, 144, v21
MAV 92,44,148
TR 24,6,8512
v_add3_u32 v21, v21, v2, s62
MAV 92,60,156
buffer_load_dwordx4 v[204:207], v4, s[16:19], s52 offen offset:1024 sc1
v_and_b32 v20, 15, v1
MAV 76,60,152
TR 26,6,9024
v_mul_u32_u24 v20, 144, v20
v_lshrrev_b32 v2, 4, v1
MAV 76,44,144
TR 28,6,8544
TR 30,6,9056
s_waitcnt vmcnt(8) lgkmcnt(8)
MAV 64,0,160
TR 32,6,16896
s_add_u32 s52, s78, 737280
v_lshlrev_b32 v2, 3, v2
v_add3_u32 v20, v20, v2, s62
MAV 64,16,168
buffer_load_dwordx4 v[208:211], v4, s[16:19], s52 offen sc1
v_accvgpr_read_b32 v28, a224
MAV 80,16,172
TR 34,6,17408
v_add_f32 v32, v32, v28
MAV 80,0,164
TR 36,6,16928
TR 38,6,17440
v_accvgpr_read_b32 v29, a225
MAV 84,4,164
TR 48,6,25344
v_add_f32 v33, v33, v29
MAV 84,20,172
buffer_load_dwordx4 v[212:215], v4, s[16:19], s52 offen offset:1024 sc1
v_accvgpr_read_b32 v28, a226
MAV 68,20,168
TR 50,6,25856
v_add_f32 v34, v34, v28
MAV 68,4,160
TR 52,6,25376
TR 54,6,25888
v_accvgpr_read_b32 v29, a227
s_waitcnt lgkmcnt(8)
MAV 72,8,160
TR 40,6,16960
s_add_u32 s52, s79, 851968
v_add_f32 v35, v35, v29
MAV 72,24,168
buffer_load_dwordx4 v[216:219], v4, s[16:19], s52 offen sc1
v_accvgpr_read_b32 v28, a228
MAV 88,24,172
TR 42,6,17472
v_add_f32 v36, v36, v28
MAV 88,8,164
TR 44,6,16992
TR 46,6,17504
v_accvgpr_read_b32 v29, a229
MAV 92,12,164
TR 56,6,25408
v_add_f32 v37, v37, v29
MAV 92,28,172
buffer_load_dwordx4 v[220:223], v4, s[16:19], s52 offen offset:1024 sc1
v_accvgpr_read_b32 v28, a230
MAV 76,28,168
TR 58,6,25920
v_add_f32 v38, v38, v28
v_accvgpr_read_b32 v29, a231
MAV 76,12,160
TR 60,6,25440
TR 62,6,25952
s_waitcnt vmcnt(8) lgkmcnt(8)
MAV 64,32,176
TR 0,6,33792
v_add_f32 v39, v39, v29
MAV 64,48,184
TR 2,6,34304
v_accvgpr_read_b32 v28, a232
v_add_f32 v40, v40, v28
MAV 80,48,188
TR 4,6,33824
MAV 80,32,180
TR 6,6,34336
v_accvgpr_read_b32 v29, a233
v_add_f32 v41, v41, v29
MAV 84,36,180
TR 16,6,42240
v_accvgpr_read_b32 v28, a234
MAV 84,52,188
TR 18,6,42752
v_add_f32 v42, v42, v28
MAV 68,52,184
TR 20,6,42272
v_accvgpr_read_b32 v29, a235
MAV 68,36,176
TR 22,6,42784
v_add_f32 v43, v43, v29
s_waitcnt lgkmcnt(8)
MAV 72,40,176
TR 8,6,33856
MAV 72,56,184
TR 10,6,34368
v_accvgpr_read_b32 v28, a236
v_add_f32 v44, v44, v28
MAV 88,56,188
TR 12,6,33888
v_accvgpr_read_b32 v29, a237
MAV 88,40,180
TR 14,6,34400
v_add_f32 v45, v45, v29
MAV 92,44,180
TR 24,6,42304
v_accvgpr_read_b32 v28, a238
MAV 92,60,188
TR 26,6,42816
v_add_f32 v46, v46, v28
MAV 76,60,184
TR 28,6,42336
v_accvgpr_read_b32 v29, a239
MAV 76,44,176
TR 30,6,42848
v_add_f32 v47, v47, v29
s_waitcnt vmcnt(4) lgkmcnt(8)
MAV 64,0,192
TR 32,6,50688
v_accvgpr_read_b32 v28, a240
MAV 64,16,200
TR 34,6,51200
v_add_f32 v48, v48, v28
v_accvgpr_read_b32 v29, a241
MAV 80,16,204
TR 36,6,50720
MAV 80,0,196
TR 38,6,51232
v_add_f32 v49, v49, v29
v_accvgpr_read_b32 v28, a242
MAV 84,4,196
TR 48,6,59136
v_add_f32 v50, v50, v28
MAV 84,20,204
TR 50,6,59648
v_accvgpr_read_b32 v29, a243
MAV 68,20,200
TR 52,6,59168
v_add_f32 v51, v51, v29
MAV 68,4,192
TR 54,6,59680
v_accvgpr_read_b32 v28, a244
s_waitcnt lgkmcnt(8)
MAV 72,8,192
TR 40,6,50752
MAV 72,24,200
TR 42,6,51264
v_add_f32 v52, v52, v28
v_accvgpr_read_b32 v29, a245
MAV 88,24,204
TR 44,6,50784
v_add_f32 v53, v53, v29
MAV 88,8,196
TR 46,6,51296
v_accvgpr_read_b32 v28, a246
MAV 92,12,196
TR 56,6,59200
v_add_f32 v54, v54, v28
MAV 92,28,204
TR 58,6,59712
v_accvgpr_read_b32 v29, a247
MAV 76,28,200
TR 60,6,59232
v_add_f32 v55, v55, v29
MAV 76,12,192
TR 62,6,59744
v_accvgpr_read_b32 v28, a248
s_waitcnt vmcnt(0) lgkmcnt(8)
MAV 64,32,208
ds_read_b64_tr_b16 a[0:1], v7
v_add_f32 v56, v56, v28
MAV 64,48,216
TR 2,7,512
v_accvgpr_read_b32 v29, a249
MAV 80,48,220
TR 4,7,32
v_add_f32 v57, v57, v29
MAV 80,32,212
TR 6,7,544
v_accvgpr_read_b32 v28, a250
MAV 84,36,212
TR 16,7,8448
v_add_f32 v58, v58, v28
MAV 84,52,220
TR 18,7,8960
v_accvgpr_read_b32 v29, a251
MAV 68,52,216
TR 20,7,8480
v_add_f32 v59, v59, v29
MAV 68,36,208
TR 22,7,8992
s_waitcnt lgkmcnt(8)
MAV 72,40,208
TR 8,7,64
v_accvgpr_read_b32 v28, a252
MAV 72,56,216
TR 10,7,576
v_add_f32 v60, v60, v28
MAV 88,56,220
TR 12,7,96
v_accvgpr_read_b32 v29, a253
MAV 88,40,212
TR 14,7,608
v_add_f32 v61, v61, v29
MAV 92,44,212
TR 24,7,8512
v_accvgpr_read_b32 v28, a254
MAV 92,60,220
TR 26,7,9024
v_add_f32 v62, v62, v28
MAV 76,60,216
TR 28,7,8544
v_accvgpr_read_b32 v29, a255
MAV 76,44,208
TR 30,7,9056
v_add_f32 v63, v63, v29
s_waitcnt lgkmcnt(8)
.Lpad39:
s_cbranch_execz .Lnopoll63r
MAV 32,0,96
TR 32,7,16896
v_cvt_pk_bf16_f32 v232, v64, v65
MAV 32,16,104
TR 34,7,17408
v_cvt_pk_bf16_f32 v233, v66, v67
v_cvt_pk_bf16_f32 v234, v68, v69
MAV 48,16,108
TR 36,7,16928
v_cvt_pk_bf16_f32 v235, v70, v71
MAV 48,0,100
TR 38,7,17440
buffer_store_dwordx4 v[232:235], v4, s[16:19], s69 offen sc1
s_add_u32 s69, s69, 131072
MAV 52,4,100
TR 48,7,25344
v_cvt_pk_bf16_f32 v236, v72, v73
MAV 52,20,108
TR 50,7,25856
v_cvt_pk_bf16_f32 v237, v74, v75
v_cvt_pk_bf16_f32 v238, v76, v77
MAV 36,20,104
TR 52,7,25376
v_cvt_pk_bf16_f32 v239, v78, v79
MAV 36,4,96
TR 54,7,25888
buffer_store_dwordx4 v[236:239], v4, s[16:19], s69 offen sc1
s_waitcnt lgkmcnt(8)
MAV 40,8,96
TR 40,7,16960
s_add_u32 s69, s69, -130048
MAV 40,24,104
TR 42,7,17472
v_cvt_pk_bf16_f32 v240, v80, v81
v_cvt_pk_bf16_f32 v241, v82, v83
MAV 56,24,108
TR 44,7,16992
v_cvt_pk_bf16_f32 v242, v84, v85
MAV 56,8,100
TR 46,7,17504
v_cvt_pk_bf16_f32 v243, v86, v87
buffer_store_dwordx4 v[240:243], v4, s[16:19], s69 offen sc1
MAV 60,12,100
TR 56,7,25408
s_add_u32 s69, s69, 131072
MAV 60,28,108
TR 58,7,25920
v_cvt_pk_bf16_f32 v244, v88, v89
v_cvt_pk_bf16_f32 v245, v90, v91
MAV 44,28,104
TR 60,7,25440
v_cvt_pk_bf16_f32 v246, v92, v93
MAV 44,12,96
TR 62,7,25952
v_cvt_pk_bf16_f32 v247, v94, v95
buffer_store_dwordx4 v[244:247], v4, s[16:19], s69 offen sc1
s_waitcnt lgkmcnt(8)
MAV 32,32,112
TR 0,7,33792
MAV 32,48,120
TR 2,7,34304
MAV 48,48,124
TR 4,7,33824
MAV 48,32,116
TR 6,7,34336
MAV 52,36,116
TR 16,7,42240
MAV 52,52,124
TR 18,7,42752
MAV 36,52,120
TR 20,7,42272
MAV 36,36,112
TR 22,7,42784
s_waitcnt lgkmcnt(8)
MAV 40,40,112
TR 8,7,33856
MAV 40,56,120
TR 10,7,34368
MAV 56,56,124
TR 12,7,33888
MAV 56,40,116
TR 14,7,34400
MAV 60,44,116
TR 24,7,42304
MAV 60,60,124
TR 26,7,42816
MAV 44,60,120
TR 28,7,42336
MAV 44,44,112
TR 30,7,42848
s_waitcnt lgkmcnt(8)
MAV 32,0,128
TR 32,7,50688
MAV 32,16,136
TR 34,7,51200
MAV 48,16,140
TR 36,7,50720
MAV 48,0,132
TR 38,7,51232
MAV 52,4,132
TR 48,7,59136
MAV 52,20,140
TR 50,7,59648
MAV 36,20,136
TR 52,7,59168
MAV 36,4,128
TR 54,7,59680
s_waitcnt lgkmcnt(8)
MAV 40,8,128
TR 40,7,50752
MAV 40,24,136
TR 42,7,51264
MAV 56,24,140
TR 44,7,50784
MAV 56,8,132
TR 46,7,51296
MAV 60,12,132
TR 56,7,59200
MAV 60,28,140
TR 58,7,59712
MAV 44,28,136
TR 60,7,59232
MAV 44,12,128
TR 62,7,59744
v_add_u32 v7, s57, v7
s_waitcnt lgkmcnt(8)
MAV 32,32,144
ds_read_b64_tr_b16 a[0:1], v7
MAV 32,48,152
s_waitcnt vmcnt(0)
buffer_atomic_add v30, v26, s[16:19], s71 offen
MAV 48,48,156
TR 2,7,512
MAV 48,32,148
TR 4,7,32
TR 6,7,544
MAV 52,36,148
MAV 52,52,156
TR 16,7,8448
TR 18,7,8960
MAV 36,52,152
TR 20,7,8480
MAV 36,36,144
s_waitcnt lgkmcnt(7)
MAV 40,40,144
TR 22,7,8992
MAV 40,56,152
TR 8,7,64
TR 10,7,576
MAV 56,56,156
MAV 56,40,148
TR 12,7,96
TR 14,7,608
MAV 60,44,148
TR 24,7,8512
MAV 60,60,156
TR 26,7,9024
MAV 44,60,152
TR 28,7,8544
MAV 44,44,144
TR 30,7,9056
s_waitcnt lgkmcnt(8)
MAV 32,0,160
TR 32,7,16896
MAV 32,16,168
buffer_atomic_add v31, v26, s[16:19], s70 offen sc0
MAV 48,16,172
TR 34,7,17408
MAV 48,0,164
TR 36,7,16928
TR 38,7,17440
MAV 52,4,164
MAV 52,20,172
TR 48,7,25344
TR 50,7,25856
MAV 36,20,168
TR 52,7,25376
MAV 36,4,160
s_waitcnt lgkmcnt(7)
MAV 40,8,160
TR 54,7,25888
MAV 40,24,168
TR 40,7,16960
TR 42,7,17472
MAV 56,24,172
MAV 56,8,164
TR 44,7,16992
TR 46,7,17504
MAV 60,12,164
TR 56,7,25408
MAV 60,28,172
TR 58,7,25920
MAV 44,28,168
TR 60,7,25440
MAV 44,12,160
TR 62,7,25952
s_waitcnt lgkmcnt(8)
MAV 32,32,176
TR 0,7,33792
MAV 32,48,184
TR 2,7,34304
MAV 48,48,188
TR 4,7,33824
MAV 48,32,180
TR 6,7,34336
MAV 52,36,180
TR 16,7,42240
MAV 52,52,188
TR 18,7,42752
MAV 36,52,184
TR 20,7,42272
MAV 36,36,176
TR 22,7,42784
s_waitcnt lgkmcnt(8)
MAV 40,40,176
TR 8,7,33856
MAV 40,56,184
TR 10,7,34368
MAV 56,56,188
TR 12,7,33888
MAV 56,40,180
TR 14,7,34400
MAV 60,44,180
TR 24,7,42304
MAV 60,60,188
TR 26,7,42816
MAV 44,60,184
TR 28,7,42336
MAV 44,44,176
TR 30,7,42848
s_waitcnt vmcnt(0)
v_cmp_le_u32 vcc, 2, v31
s_nop 0
s_cbranch_vccnz .Lxs68
s_mov_b32 s15, 0
.Lxs68l:
v_mov_b32 v31, 0
buffer_atomic_add v31, v26, s[16:19], s70 offen sc0
s_add_u32 s15, s15, 1
s_cmp_gt_u32 s15, 100000
s_waitcnt vmcnt(0)
s_cbranch_scc1 .Lxs68
v_cmp_le_u32 vcc, 2, v31
s_nop 0
s_cbranch_vccz .Lxs68l
.Lxs68:
s_waitcnt lgkmcnt(8)
MAV 32,0,192
TR 32,7,50688
MAV 32,16,200
buffer_load_dwordx4 v[232:235], v4, s[16:19], s68 offen sc1
MAV 48,16,204
TR 34,7,51200
s_add_u32 s68, s68, 131072
MAV 48,0,196
TR 36,7,50720
TR 38,7,51232
MAV 52,4,196
TR 48,7,59136
MAV 52,20,204
buffer_load_dwordx4 v[236:239], v4, s[16:19], s68 offen sc1
MAV 36,20,200
TR 50,7,59648
s_add_u32 s68, s68, -130048
MAV 36,4,192
TR 52,7,59168
TR 54,7,59680
s_waitcnt lgkmcnt(8)
MAV 40,8,192
TR 40,7,50752
MAV 40,24,200
buffer_load_dwordx4 v[240:243], v4, s[16:19], s68 offen sc1
MAV 56,24,204
TR 42,7,51264
s_add_u32 s68, s68, 131072
MAV 56,8,196
TR 44,7,50784
TR 46,7,51296
MAV 60,12,196
TR 56,7,59200
MAV 60,28,204
buffer_load_dwordx4 v[244:247], v4, s[16:19], s68 offen sc1
MAV 44,28,200
TR 58,7,59712
MAV 44,12,192
TR 60,7,59232
TR 62,7,59744
s_waitcnt lgkmcnt(8)
MAV 32,32,208
MAV 32,48,216
MAV 48,48,220
MAV 48,32,212
MAV 52,36,212
MAV 52,52,220
MAV 36,52,216
MAV 36,36,208
s_waitcnt lgkmcnt(0)
MAV 40,40,208
MAV 40,56,216
MAV 56,56,220
MAV 56,40,212
MAV 60,44,212
MAV 60,60,220
MAV 44,60,216
MAV 44,44,208
s_waitcnt vmcnt(3)
v_mfma_f32_16x16x32_bf16 v[32:35], v[226:229], v[232:235], v[32:35]
v_mfma_f32_16x16x32_bf16 v[36:39], v[224:227], v[232:235], v[36:39]
s_waitcnt vmcnt(2)
v_mfma_f32_16x16x32_bf16 v[40:43], v[226:229], v[236:239], v[40:43]
v_mfma_f32_16x16x32_bf16 v[44:47], v[224:227], v[236:239], v[44:47]
s_waitcnt vmcnt(1)
v_mfma_f32_16x16x32_bf16 v[48:51], v[226:229], v[240:243], v[48:51]
v_mfma_f32_16x16x32_bf16 v[52:55], v[224:227], v[240:243], v[52:55]
s_waitcnt vmcnt(0)
v_mfma_f32_16x16x32_bf16 v[56:59], v[226:229], v[244:247], v[56:59]
v_cvt_pk_bf16_f32 v128, v32, v33
v_mfma_f32_16x16x32_bf16 v[60:63], v[224:227], v[244:247], v[60:63]
v_cvt_pk_bf16_f32 v129, v34, v35
ds_write_b64 v20, v[128:129]
v_cvt_pk_bf16_f32 v130, v36, v37
v_cvt_pk_bf16_f32 v131, v38, v39
ds_write_b64 v20, v[130:131] offset:32
v_cvt_pk_bf16_f32 v132, v40, v41
v_cvt_pk_bf16_f32 v133, v42, v43
ds_write_b64 v20, v[132:133] offset:64
v_cvt_pk_bf16_f32 v134, v44, v45
v_cvt_pk_bf16_f32 v135, v46, v47
ds_write_b64 v20, v[134:135] offset:96
ds_read_b128 v[144:147], v21
ds_read_b128 v[148:151], v21 offset:1152
v_cvt_pk_bf16_f32 v136, v48, v49
v_cvt_pk_bf16_f32 v137, v50, v51
ds_write_b64 v20, v[136:137] offset:2304
v_cvt_pk_bf16_f32 v138, v52, v53
v_cvt_pk_bf16_f32 v139, v54, v55
ds_write_b64 v20, v[138:139] offset:2336
v_cvt_pk_bf16_f32 v140, v56, v57
v_cvt_pk_bf16_f32 v141, v58, v59
ds_write_b64 v20, v[140:141] offset:2368
v_cvt_pk_bf16_f32 v142, v60, v61
v_cvt_pk_bf16_f32 v143, v62, v63
ds_write_b64 v20, v[142:143] offset:2400
ds_read_b128 v[152:155], v21 offset:2304
ds_read_b128 v[156:159], v21 offset:3456
s_waitcnt lgkmcnt(7)
buffer_store_dwordx4 v[144:147], v16, s[36:39], 0 offen sc1
s_waitcnt lgkmcnt(6)
buffer_store_dwordx4 v[148:151], v16, s[36:39], s64 offen sc1
s_waitcnt lgkmcnt(1)
buffer_store_dwordx4 v[152:155], v17, s[36:39], 0 offen sc1
s_waitcnt lgkmcnt(0)
buffer_store_dwordx4 v[156:159], v17, s[36:39], s64 offen sc1
s_nop 1
.Lend:
s_endpgm
.Lsp67:
s_mov_b32 s15, 0
.Lsp67l:
v_mov_b32 v25, 0
buffer_atomic_add v25, v22, s[16:19], s73 offen sc0
s_add_u32 s15, s15, 1
s_cmp_gt_u32 s15, 100000
s_waitcnt vmcnt(0)
s_cbranch_scc1 .Lsp67b
v_cmp_gt_u32 vcc, v23, v25
s_nop 0
s_cbranch_vccnz .Lsp67l
s_branch .Lsp67b
.section .rodata,"a"
.p2align 6
.amdhsa_kernel interleave_layers__sliding_local_dilated__swiglu_ffn__prompt_kernel
  .amdhsa_next_free_vgpr 512
  .amdhsa_next_free_sgpr 102
  .amdhsa_accum_offset 256
  .amdhsa_group_segment_fixed_size 0
  .amdhsa_kernarg_size 80
  .amdhsa_user_sgpr_count 2
  .amdhsa_user_sgpr_kernarg_segment_ptr 1
  .amdhsa_system_sgpr_workgroup_id_x 1
  .amdhsa_float_denorm_mode_32 3
.end_amdhsa_kernel
```

```asm
; @launch grid=(256,1,1) block=(256,1,1) lds=162560
.amdgcn_target "amdgcn-amd-amdhsa--gfx950"
.macro MAA d,a,b
v_mfma_f32_16x16x32_bf16 v[\d:\d+3], a[\a:\a+3], a[\b:\b+3], v[\d:\d+3]
.endm
.macro MAV d,a,b
v_mfma_f32_16x16x32_bf16 v[\d:\d+3], a[\a:\a+3], v[\b:\b+3], v[\d:\d+3]
.endm
.macro TR d,v,o
ds_read_b64_tr_b16 a[\d:\d+1], v\v offset:\o
.endm
.macro RD d,v,o
ds_read_b128 a[\d:\d+3], v\v offset:\o
.endm
.text
.globl interleave_layers__sliding_local_dilated__swiglu_ffn__prompt_kernel
.p2align 8
.type interleave_layers__sliding_local_dilated__swiglu_ffn__prompt_kernel,@function
interleave_layers__sliding_local_dilated__swiglu_ffn__prompt_kernel:
s_load_dwordx4 s[68:71], s[0:1], 0
s_load_dwordx2 s[72:73], s[0:1], 16
s_load_dwordx8 s[76:83], s[0:1], 32
s_load_dwordx4 s[84:87], s[0:1], 64
s_cmp_ge_u32 s2, 256
s_cbranch_scc1 .Lout
v_lshrrev_b32 v2, 6, v0
v_and_b32 v1, 63, v0
v_readfirstlane_b32 s3, v2
s_and_b32 s4, s2, 7
s_lshr_b32 s5, s2, 3
s_getpc_b64 s[62:63]
.Lpc:
s_lshl_b32 s64, s5, 12
v_lshrrev_b32 v59, 3, v0
v_lshl_add_u32 v59, v59, 7, s64
v_add_u32 v2, 0x20000, v59
v_min_u32 v2, .Lend-.Lpc, v2
v_min_u32 v59, .Lend-.Lpc, v59
global_load_dword v59, v59, s[62:63]
global_load_dword v58, v2, s[62:63]
s_lshr_b32 s8, s4, 2
s_lshl_b32 s8, s8, 3
s_and_b32 s62, s5, 7
s_add_u32 s8, s8, s62
s_and_b32 s9, s4, 3
s_lshl_b32 s9, s9, 2
s_lshr_b32 s62, s5, 3
s_add_u32 s9, s9, s62
s_and_b32 s48, s3, 1
s_lshr_b32 s49, s3, 1
s_lshl_b32 s50, s8, 3
s_sub_u32 s50, s50, 9
s_cmp_lt_u32 s8, 2
s_cselect_b32 s50, 7, s50
s_lshr_b32 s6, s4, 1
s_lshl_b32 s6, s6, 2
s_and_b32 s62, s5, 3
s_add_u32 s6, s6, s62
s_and_b32 s7, s4, 1
s_lshr_b32 s62, s5, 2
s_lshl_b32 s62, s62, 1
s_add_u32 s7, s7, s62
s_lshr_b32 s62, s6, 1
s_lshl_b32 s62, s62, 8
s_and_b32 s63, s6, 1
s_add_u32 s62, s62, s63
s_lshl_b32 s63, s3, 6
s_add_u32 s62, s62, s63
s_lshl_b32 s62, s62, 11
s_lshl_b32 s63, s7, 7
s_add_u32 s62, s62, s63
v_and_b32 v228, 15, v1
v_lshlrev_b32 v228, 12, v228
v_bfe_u32 v2, v1, 4, 1
v_lshl_add_u32 v228, v2, 5, v228
v_bfe_u32 v2, v1, 5, 1
v_lshl_add_u32 v228, v2, 4, v228
v_add_u32 v228, s62, v228
v_add_u32 v229, 0x10000, v228
s_sub_u32 s64, s3, 1
s_max_i32 s64, s64, 0
s_lshl_b32 s64, s64, 11
s_lshl_b32 s66, s9, 7
s_add_u32 s66, s66, s64
s_or_b32 s65, s9, 3
s_lshl_b32 s65, s65, 7
s_and_b32 s64, s9, 3
s_lshl_b32 s64, s64, 11
s_add_u32 s65, s65, s64
s_bitcmp1_b32 s9, 2
s_cselect_b32 s65, 8388608, s65
s_cmp_eq_u32 s3, 1
s_cselect_b32 s66, s65, s66
s_cselect_b32 s64, 8, 0
s_and_b32 s44, s9, 7
s_cmp_eq_u32 s44, 3
s_cselect_b32 s66, 8388608, s66
s_xor_b32 s64, s64, s8
v_mov_b32 v9, s8
v_mov_b32 v2, s64
v_cmp_gt_u32 vcc, 32, v1
s_nop 1
v_cndmask_b32 v9, v2, v9, vcc
v_and_b32 v2, 31, v1
v_min_u32 v2, 19, v2
v_mad_u32_u24 v9, v9, 20, v2
v_mul_u32_u24 v9, 6144, v9
s_mov_b32 s65, s66
s_xor_b32 s14, s3, 3
s_lshl_b32 s14, s14, 8
s_add_u32 s14, s14, s2
v_lshlrev_b32 v230, 4, v1
v_mov_b64 v[224:225], 0
v_mov_b64 v[226:227], 0
s_waitcnt lgkmcnt(0)
s_mov_b32 s16, s86
s_mov_b32 s17, s87
s_mov_b32 s18, 268435456
s_mov_b32 s19, 0x20000
s_mov_b32 s36, s68
s_mov_b32 s37, s69
s_mov_b32 s38, 4194304
s_mov_b32 s39, 0x20000
s_cmp_ge_u32 s14, 16
s_cbranch_scc1 .Lz3
s_lshl_b32 s62, s2, 13
s_add_u32 s62, s62, 30408704
s_add_u32 s63, s62, 4096
buffer_store_dwordx4 v[224:227], v230, s[16:19], s62 offen sc1
buffer_store_dwordx4 v[224:227], v230, s[16:19], s62 offen offset:1024 sc1
buffer_store_dwordx4 v[224:227], v230, s[16:19], s62 offen offset:2048 sc1
buffer_store_dwordx4 v[224:227], v230, s[16:19], s62 offen offset:3072 sc1
buffer_store_dwordx4 v[224:227], v230, s[16:19], s63 offen sc1
buffer_store_dwordx4 v[224:227], v230, s[16:19], s63 offen offset:1024 sc1
buffer_store_dwordx4 v[224:227], v230, s[16:19], s63 offen offset:2048 sc1
buffer_store_dwordx4 v[224:227], v230, s[16:19], s63 offen offset:3072 sc1
.Lz3:
buffer_load_dwordx4 v[164:167], v228, s[36:39], 0 offen
buffer_load_dwordx4 v[168:171], v228, s[36:39], 0 offen offset:64
buffer_load_dwordx4 v[172:175], v229, s[36:39], 0 offen
buffer_load_dwordx4 v[176:179], v229, s[36:39], 0 offen offset:64
s_mov_b32 s20, s70
s_mov_b32 s21, s71
s_mov_b32 s22, 6291456
s_mov_b32 s23, 0x20000
buffer_load_dword v58, v9, s[20:23], s65 offen
s_mov_b32 s40, s84
s_mov_b32 s41, s85
s_mov_b32 s42, 256
s_mov_b32 s43, 0x20000
s_mov_b32 s24, s72
s_mov_b32 s25, s73
s_mov_b32 s26, 2097152
s_mov_b32 s27, 0x20000
s_mov_b32 s28, s80
s_mov_b32 s29, s81
s_mov_b32 s30, 7340032
s_mov_b32 s31, 0x20000
s_mov_b32 s0, s82
s_mov_b32 s1, s83
s_mov_b32 s32, s76
s_mov_b32 s33, s77
s_mov_b32 s34, 7340032
s_mov_b32 s35, 0x20000
s_mov_b32 s80, s78
s_mov_b32 s81, s79
s_mov_b32 s82, 7340032
s_mov_b32 s83, 0x20000
s_lshr_b32 s10, s4, 2
s_lshl_b32 s10, s10, 2
s_and_b32 s62, s5, 3
s_add_u32 s10, s10, s62
s_and_b32 s11, s4, 3
s_lshl_b32 s11, s11, 3
s_lshr_b32 s62, s5, 2
s_add_u32 s11, s11, s62
s_and_b32 s12, s11, 1
s_lshr_b32 s13, s11, 1
s_mul_i32 s51, s13, 448
s_mul_i32 s62, s12, 192
s_add_u32 s51, s51, s62
s_lshl_b32 s62, s6, 3
s_lshr_b32 s84, s62, 4
s_lshl_b32 s84, s84, 14
s_and_b32 s62, s62, 15
s_lshl_b32 s62, s62, 10
s_add_u32 s84, s84, s62
s_lshl_b32 s62, s8, 3
s_lshr_b32 s85, s62, 4
s_lshl_b32 s85, s85, 14
s_and_b32 s62, s62, 15
s_lshl_b32 s62, s62, 10
s_add_u32 s85, s85, s62
s_lshl_b32 s62, s50, 0
s_lshr_b32 s86, s62, 4
s_lshl_b32 s86, s86, 14
s_and_b32 s62, s62, 15
s_lshl_b32 s62, s62, 10
s_add_u32 s86, s86, s62
s_mul_i32 s62, s8, 393216
s_add_u32 s62, s62, s66
v_mul_u32_u24 v14, 6144, v1
v_add_u32 v14, s62, v14
s_add_u32 s62, s9, 4
s_lshr_b32 s62, s62, 3
s_sub_u32 s62, s9, s62
s_mul_i32 s45, s8, 14
s_add_u32 s45, s45, s62
s_lshl_b32 s62, s45, 2
s_add_u32 s62, s62, s3
s_mul_i32 s62, s62, 7552
v_min_u32 v15, 58, v1
v_lshl_add_u32 v15, v15, 7, s62
s_sub_u32 s63, s8, 4
s_lshl_b32 s64, s8, 1
s_add_u32 s64, s64, 1
s_cmp_lt_u32 s8, 5
s_cselect_b64 vcc, -1, 0
s_cselect_b32 s46, s64, s63
v_cndmask_b32 v14, v14, v15, vcc
s_lshl_b32 s62, s45, 1
s_add_u32 s62, s62, s48
s_mul_i32 s62, s62, 6144
v_min_u32 v16, 47, v1
v_lshl_add_u32 v16, v16, 7, s62
s_cmp_lt_u32 s46, 6
s_cselect_b64 vcc, -1, 0
v_cndmask_b32 v15, v14, v16, vcc
v_cndmask_b32 v14, v16, v14, vcc
s_cmp_lt_u32 s3, 2
s_cselect_b32 s65, s32, s80
s_cselect_b32 s66, s33, s81
s_cselect_b32 s67, s34, s82
s_cmp_lt_u32 s8, 5
s_cselect_b32 s62, s24, s20
s_cselect_b32 s63, s25, s21
s_cselect_b32 s64, s26, s22
s_sub_u32 s47, s46, 6
s_cmp_lt_u32 s46, 6
s_cselect_b32 s47, s46, s47
s_cselect_b32 s76, s62, s65
s_cselect_b32 s98, s65, s62
s_cselect_b32 s77, s63, s66
s_cselect_b32 s99, s66, s63
s_cselect_b32 s78, s64, s67
s_cselect_b32 s100, s67, s64
s_mov_b32 s79, 0x20000
s_cmp_eq_u32 s44, 3
s_cselect_b32 s47, 64, s47
v_bfe_u32 v18, v1, 3, 1
v_bfe_u32 v2, v1, 5, 1
v_lshl_add_u32 v18, v2, 2, v18
v_and_b32 v2, 16, v1
v_add_u32 v18, v18, v2
s_lshl_b32 s62, s49, 2
s_add_u32 s62, s62, s48
s_lshl_b32 s62, s62, 1
v_add_u32 v18, s62, v18
v_mul_u32_u24 v18, 6144, v18
v_and_b32 v2, 7, v1
v_lshl_add_u32 v18, v2, 4, v18
s_lshl_b32 s62, s9, 7
v_add_u32 v18, s62, v18
v_add_u32 v19, 1024, v18
v_add_u32 v20, 2048, v18
s_mul_i32 s59, s3, 3104
s_mov_b32 s58, 0
s_lshr_b32 s62, s8, 1
s_lshl_b32 s62, s62, 8
s_and_b32 s67, s8, 1
s_add_u32 s62, s62, s67
s_lshl_b32 s62, s62, 11
s_lshl_b32 s63, s3, 17
s_add_u32 s62, s62, s63
v_lshrrev_b32 v2, 4, v1
v_xor_b32 v2, v2, v1
v_and_b32 v2, 7, v2
v_lshlrev_b32 v2, 4, v2
v_lshrrev_b32 v21, 3, v1
v_lshl_add_u32 v21, v21, 12, v2
v_add_u32 v21, s62, v21
v_xor_b32 v28, 64, v21
v_add_u32 v28, 31744, v28
s_lshr_b32 s63, s50, 3
s_lshr_b32 s62, s63, 1
s_lshl_b32 s62, s62, 8
s_and_b32 s67, s63, 1
s_add_u32 s62, s62, s67
s_lshl_b32 s62, s62, 11
s_lshl_b32 s63, s3, 14
s_add_u32 s62, s62, s63
s_add_u32 s62, s62, 456704
s_lshl_b32 s63, s3, 5
v_and_b32 v2, 31, v1
v_lshlrev_b32 v2, 2, v2
v_xor_b32 v2, s63, v2
v_lshrrev_b32 v22, 5, v1
v_lshl_add_u32 v22, v22, 12, v2
v_add_u32 v22, s62, v22
v_xor_b32 v29, 16, v22
v_add_u32 v29, -57344, v29
s_mov_b32 s52, 0
s_mov_b32 s53, 65536
s_mul_i32 s55, s3, 4608
s_mov_b32 s54, 0
s_mul_i32 s56, s3, 3104
v_bfe_u32 v24, v1, 1, 3
v_lshrrev_b32 v2, 4, v1
v_xor_b32 v2, v2, v24
v_lshlrev_b32 v2, 4, v2
v_and_b32 v23, 15, v1
v_lshl_add_u32 v23, v23, 7, v2
s_mul_i32 s62, s48, 9216
v_add_u32 v23, s62, v23
v_xor_b32 v30, 64, v23
v_mul_u32_u24 v24, 2304, v24
v_add_u32 v24, v24, v2
v_and_b32 v2, 1, v1
v_lshl_add_u32 v24, v2, 7, v24
v_add_u32 v24, 2048, v24
v_xor_b32 v31, 64, v24
v_and_b32 v2, 15, v1
v_cmp_eq_u32 vcc, 0, v2
v_mov_b32 v2, 18432
s_nop 0
v_cndmask_b32 v24, v24, v2, vcc
v_cndmask_b32 v31, v31, v2, vcc
v_bfe_u32 v25, v1, 3, 2
v_mul_u32_u24 v25, 3104, v25
v_bfe_u32 v2, v1, 2, 1
v_lshl_add_u32 v25, v2, 7, v25
v_bfe_u32 v2, v1, 5, 1
v_lshl_add_u32 v25, v2, 8, v25
v_and_b32 v2, 3, v1
v_lshl_add_u32 v25, v2, 3, v25
s_lshl_b32 s62, s49, 6
s_add_u32 s62, s62, 73984
v_add_u32 v25, s62, v25
s_lshl_b32 s62, s8, 1
s_add_u32 s62, s62, s3
s_lshr_b32 s63, s50, 2
s_cmp_lt_u32 s3, 2
s_cselect_b32 s62, s62, s63
s_lshl_b32 s62, s62, 13
s_cmp_eq_u32 s3, 3
s_cselect_b32 s62, 268435456, s62
v_lshl_add_u32 v26, v1, 4, s62
s_mul_i32 s59, s3, 2080
s_and_b32 s87, s6, 3
s_lshl_b32 s87, s87, 17
v_bfe_u32 v5, v1, 3, 1
v_lshrrev_b32 v2, 4, v1
v_lshl_add_u32 v5, v2, 3, v5
s_lshl_b32 s62, s3, 1
v_add_u32 v5, s62, v5
v_mul_u32_u24 v5, 2048, v5
v_and_b32 v2, 7, v1
v_lshl_add_u32 v5, v2, 4, v5
s_lshl_b32 s62, s7, 7
v_add_u32 v5, s62, v5
v_add_u32 v6, 64512, v5
s_lshl_b32 s62, s6, 10
s_add_u32 s62, s62, 30408704
s_lshl_b32 s64, s8, 10
s_add_u32 s64, s64, 30408704
s_lshr_b32 s67, s9, 1
s_and_b32 s67, s67, 3
s_lshl_b32 s67, s67, 7
s_add_u32 s64, s64, s67
s_lshr_b32 s65, s50, 3
s_lshl_b32 s65, s65, 10
s_add_u32 s65, s65, 30408704
s_lshr_b32 s67, s9, 1
s_and_b32 s67, s67, 3
s_lshl_b32 s67, s67, 7
s_add_u32 s65, s65, s67
v_mov_b32 v2, 268435456
v_cmp_eq_u32 vcc, 65, v0
v_mov_b32 v33, s65
s_nop 0
v_cndmask_b32 v33, v2, v33, vcc
v_cndmask_b32 v36, 0, 16, vcc
v_cmp_eq_u32 vcc, 64, v0
v_mov_b32 v32, s64
s_nop 0
v_cndmask_b32 v33, v33, v32, vcc
v_lshl_add_u32 v32, v1, 7, s62
v_cndmask_b32 v34, v2, 0, vcc
v_cndmask_b32 v35, 0, 16, vcc
v_cndmask_b32 v36, v36, 16, vcc
v_lshrrev_b32 v37, 3, v0
v_cmp_eq_u32 vcc, 8, v37
s_nop 1
v_cndmask_b32 v32, v2, v32, vcc
v_mov_b32 v38, 1
v_lshrrev_b32 v2, 4, v1
v_lshlrev_b32 v2, 2, v2
v_and_b32 v13, 15, v1
v_sub_u32 v2, v13, v2
v_mov_b32 v13, 0xff61b1e6
v_subrev_u32 v54, 0, v2
v_cmp_gt_u32 vcc, 8, v54
s_nop 1
v_cndmask_b32 v50, v13, 0, vcc
v_cmp_gt_i32 vcc, -8, v54
s_nop 1
v_cndmask_b32 v46, v13, 0, vcc
v_subrev_u32 v54, 1, v2
v_cmp_gt_u32 vcc, 8, v54
s_nop 1
v_cndmask_b32 v51, v13, 0, vcc
v_cmp_gt_i32 vcc, -8, v54
s_nop 1
v_cndmask_b32 v47, v13, 0, vcc
v_subrev_u32 v54, 2, v2
v_cmp_gt_u32 vcc, 8, v54
s_nop 1
v_cndmask_b32 v52, v13, 0, vcc
v_cmp_gt_i32 vcc, -8, v54
s_nop 1
v_cndmask_b32 v48, v13, 0, vcc
v_subrev_u32 v54, 3, v2
v_cmp_gt_u32 vcc, 8, v54
s_nop 1
v_cndmask_b32 v53, v13, 0, vcc
v_cmp_gt_i32 vcc, -8, v54
s_nop 1
v_cndmask_b32 v49, v13, 0, vcc
s_cmp_lt_u32 s8, 2
s_cselect_b64 vcc, -1, 0
v_cndmask_b32 v54, v46, v13, vcc
v_cndmask_b32 v55, v47, v13, vcc
v_cndmask_b32 v56, v48, v13, vcc
v_cndmask_b32 v57, v49, v13, vcc
s_mov_b32 s75, 29360128
v_and_b32 v10, 15, v1
v_lshlrev_b32 v12, 2, v10
v_lshlrev_b32 v10, 4, v10
v_add_u32 v10, 152576, v10
v_lshrrev_b32 v11, 4, v1
v_lshlrev_b32 v11, 4, v11
s_lshl_b32 s62, s49, 7
s_add_u32 s62, s62, 158720
v_add_u32 v12, s62, v12
v_add_u32 v13, s62, v11
v_add_u32 v11, 156672, v11
s_lshl_b32 s62, s3, 11
s_add_u32 s62, s62, 143360
v_lshl_add_u32 v8, v1, 4, s62
v_xor_b32 v9, 2048, v8
v_mov_b32 v248, 0x3f803f80
v_mov_b32 v249, 0x3f803f80
v_mov_b32 v250, 0x3f803f80
v_mov_b32 v251, 0x3f803f80
s_mul_i32 s62, s3, 18496
s_add_u32 s62, s62, 18432
v_mov_b32 v2, s62
ds_write_b128 v2, v[248:251]
v_and_b32 v7, 31, v1
v_lshrrev_b32 v2, 5, v1
v_lshl_add_u32 v7, v7, 1, v2
v_and_b32 v2, 0xc0, v0
v_add_u32 v7, v7, v2
v_lshlrev_b32 v17, 2, v7
v_add_u32 v17, 156672, v17
v_lshlrev_b32 v7, 4, v7
v_add_u32 v7, 152576, v7
s_lshl_b32 s74, s9, 1
s_add_u32 s74, s74, s49
s_lshl_b32 s74, s74, 17
s_add_u32 s74, s74, s85
s_lshl_b32 s63, s48, 12
s_add_u32 s74, s74, s63
s_add_u32 s74, s74, 4194304
s_mov_b32 s62, 0
v_lshl_add_u32 v4, v1, 4, s62
v_lshrrev_b32 v2, 3, v1
v_cmp_eq_u32 vcc, 3, v2
v_add_u32 v2, 67108480, v4
s_nop 0
v_cndmask_b32 v4, v4, v2, vcc
s_add_u32 m0, s55, 0
s_nop 0
buffer_load_dwordx4 v21, s[36:39], s52 offen lds
buffer_load_dwordx4 v28, s[36:39], s52 offen offset:1024 lds
buffer_load_dword v22, s[36:39], s52 offen offset:2048 lds
s_add_u32 s52, s52, 128
s_add_u32 m0, s55, 2304
s_nop 0
buffer_load_dwordx4 v21, s[36:39], s53 offen lds
buffer_load_dwordx4 v28, s[36:39], s53 offen offset:1024 lds
buffer_load_dword v29, s[36:39], s53 offen offset:2048 lds
s_add_u32 s53, s53, 128
s_add_u32 m0, s56, 123648
s_nop 0
buffer_load_dwordx4 v18, s[20:23], s54 offen lds
buffer_load_dwordx4 v19, s[20:23], s54 offen offset:1024 lds
buffer_load_dwordx4 v20, s[20:23], s54 offen offset:2048 lds
s_add_u32 s54, s54, 196608
s_add_u32 m0, s56, 136064
s_nop 0
buffer_load_dwordx4 v18, s[20:23], s54 offen lds
buffer_load_dwordx4 v19, s[20:23], s54 offen offset:1024 lds
buffer_load_dwordx4 v20, s[20:23], s54 offen offset:2048 lds
s_add_u32 s54, s54, 196608
s_mov_b64 exec, 0
s_cmp_eq_u32 s3, 2
s_cbranch_scc1 .Lpad1
s_cmp_eq_u32 s3, 3
s_cbranch_scc1 .Lpad2
s_cmp_eq_u32 s3, 1
s_cbranch_scc1 .Lpad4
s_branch .Lpad3
.Lout:
s_endpgm
.p2align 12
.Lt0r:
s_mov_b64 exec, -1
s_cmp_eq_u32 s48, 1
s_cbranch_scc1 .Lqkv1
s_cmp_lt_u32 s14, 16
s_cselect_b32 s62, 0, 4096
v_mov_b32 v231, 1
v_lshlrev_b32 v232, 8, v1
s_waitcnt vmcnt(16)
v_permlane16_swap_b32 v164, v166
v_permlane16_swap_b32 v165, v167
s_waitcnt vmcnt(15)
v_permlane16_swap_b32 v168, v170
v_permlane16_swap_b32 v169, v171
s_waitcnt vmcnt(14)
v_permlane16_swap_b32 v172, v174
v_permlane16_swap_b32 v173, v175
s_waitcnt vmcnt(13)
v_permlane16_swap_b32 v176, v178
v_permlane16_swap_b32 v177, v179
buffer_atomic_add v231, v232, s[40:43], s62 offen
s_add_u32 m0, s55, 18496
s_nop 0
buffer_load_dwordx4 v21, s[36:39], s52 offen lds
v_lshlrev_b32 v192, 16, v164
v_and_b32 v193, 0xffff0000, v164
v_lshlrev_b32 v194, 16, v165
v_and_b32 v195, 0xffff0000, v165
v_lshlrev_b32 v196, 16, v166
v_and_b32 v197, 0xffff0000, v166
v_lshlrev_b32 v198, 16, v167
buffer_load_dwordx4 v28, s[36:39], s52 offen offset:1024 lds
v_and_b32 v199, 0xffff0000, v167
v_lshlrev_b32 v200, 16, v168
v_and_b32 v201, 0xffff0000, v168
v_lshlrev_b32 v202, 16, v169
v_and_b32 v203, 0xffff0000, v169
v_lshlrev_b32 v204, 16, v170
v_and_b32 v205, 0xffff0000, v170
buffer_load_dword v22, s[36:39], s52 offen offset:2048 lds
s_add_u32 s52, s52, 128
v_lshlrev_b32 v206, 16, v171
v_and_b32 v207, 0xffff0000, v171
v_lshlrev_b32 v208, 16, v172
v_and_b32 v209, 0xffff0000, v172
v_lshlrev_b32 v210, 16, v173
v_and_b32 v211, 0xffff0000, v173
v_lshlrev_b32 v212, 16, v174
s_add_u32 m0, s55, 20800
s_nop 0
buffer_load_dwordx4 v21, s[36:39], s53 offen lds
v_and_b32 v213, 0xffff0000, v174
v_lshlrev_b32 v214, 16, v175
v_and_b32 v215, 0xffff0000, v175
v_lshlrev_b32 v216, 16, v176
v_and_b32 v217, 0xffff0000, v176
v_lshlrev_b32 v218, 16, v177
v_and_b32 v219, 0xffff0000, v177
buffer_load_dwordx4 v28, s[36:39], s53 offen offset:1024 lds
v_lshlrev_b32 v220, 16, v178
v_and_b32 v221, 0xffff0000, v178
v_lshlrev_b32 v222, 16, v179
v_and_b32 v223, 0xffff0000, v179
s_lshl_b32 s64, s6, 14
s_lshl_b32 s65, s49, 13
s_add_u32 s64, s64, s65
buffer_load_dword v29, s[36:39], s53 offen offset:2048 lds
s_add_u32 s53, s53, 128
s_lshl_b32 s65, s7, 9
s_add_u32 s64, s64, s65
s_lshl_b32 s65, s48, 8
s_add_u32 s64, s64, s65
s_add_u32 s64, s64, 29360128
v_and_b32 v188, 31, v1
v_lshlrev_b32 v188, 3, v188
s_add_u32 m0, s56, 73984
s_nop 0
buffer_load_dwordx4 v18, s[20:23], s54 offen lds
v_lshrrev_b32 v189, 5, v1
v_lshl_add_u32 v188, v189, 28, v188
s_lshl_b32 s62, s7, 18
s_add_u32 s62, s62, 0
s_add_u32 s63, s62, 131072
v_pk_mul_f32 v[182:183], v[192:193], v[192:193]
v_pk_mul_f32 v[186:187], v[208:209], v[208:209]
buffer_load_dwordx4 v19, s[20:23], s54 offen offset:1024 lds
v_pk_fma_f32 v[182:183], v[194:195], v[194:195], v[182:183]
v_pk_add_f32 v[180:181], v[192:193], v[194:195]
v_pk_fma_f32 v[186:187], v[210:211], v[210:211], v[186:187]
v_pk_add_f32 v[184:185], v[208:209], v[210:211]
v_pk_fma_f32 v[182:183], v[196:197], v[196:197], v[182:183]
v_pk_add_f32 v[180:181], v[180:181], v[196:197]
v_pk_fma_f32 v[186:187], v[212:213], v[212:213], v[186:187]
buffer_load_dwordx4 v20, s[20:23], s54 offen offset:2048 lds
s_add_u32 s54, s54, 196608
v_pk_add_f32 v[184:185], v[184:185], v[212:213]
v_pk_fma_f32 v[182:183], v[198:199], v[198:199], v[182:183]
v_pk_add_f32 v[180:181], v[180:181], v[198:199]
v_pk_fma_f32 v[186:187], v[214:215], v[214:215], v[186:187]
v_pk_add_f32 v[184:185], v[184:185], v[214:215]
v_pk_fma_f32 v[182:183], v[200:201], v[200:201], v[182:183]
v_pk_add_f32 v[180:181], v[180:181], v[200:201]
s_add_u32 m0, s56, 86400
s_nop 0
buffer_load_dwordx4 v18, s[20:23], s54 offen lds
v_pk_fma_f32 v[186:187], v[216:217], v[216:217], v[186:187]
v_pk_add_f32 v[184:185], v[184:185], v[216:217]
v_pk_fma_f32 v[182:183], v[202:203], v[202:203], v[182:183]
v_pk_add_f32 v[180:181], v[180:181], v[202:203]
v_pk_fma_f32 v[186:187], v[218:219], v[218:219], v[186:187]
v_pk_add_f32 v[184:185], v[184:185], v[218:219]
v_pk_fma_f32 v[182:183], v[204:205], v[204:205], v[182:183]
buffer_load_dwordx4 v19, s[20:23], s54 offen offset:1024 lds
v_pk_add_f32 v[180:181], v[180:181], v[204:205]
v_pk_fma_f32 v[186:187], v[220:221], v[220:221], v[186:187]
v_pk_add_f32 v[184:185], v[184:185], v[220:221]
v_pk_fma_f32 v[182:183], v[206:207], v[206:207], v[182:183]
v_pk_add_f32 v[180:181], v[180:181], v[206:207]
v_pk_fma_f32 v[186:187], v[222:223], v[222:223], v[186:187]
v_pk_add_f32 v[184:185], v[184:185], v[222:223]
buffer_load_dwordx4 v20, s[20:23], s54 offen offset:2048 lds
s_add_u32 s54, s54, 196608
v_add_f32 v180, v180, v181
v_add_f32 v182, v182, v183
v_add_f32 v184, v184, v185
v_add_f32 v186, v186, v187
s_nop 0
v_permlane16_swap_b32 v180, v184
v_permlane16_swap_b32 v182, v186
v_add_f32 v180, v180, v184
v_add_f32 v182, v182, v186
s_nop 1
v_permlane32_swap_b32 v180, v182
v_add_f32 v180, v180, v182
s_nop 1
v_permlane32_swap_b32 v180, v181
buffer_store_dwordx2 v[180:181], v188, s[16:19], s64 offen sc1
s_lshl_b32 s62, s2, 10
s_add_u32 s62, s62, 31457280
s_cmp_eq_u32 s3, 0
s_cselect_b32 s62, s62, 268435456
buffer_store_dwordx4 v[224:227], v230, s[16:19], s62 offen sc1
s_waitcnt vmcnt(15) lgkmcnt(0)
s_barrier
ds_read_b128 a[0:3], v23
RD 4,23,2304
RD 8,23,4608
RD 12,23,6912
ds_read_b128 a[16:19], v24
ds_read_b128 a[20:23], v30
RD 24,30,2304
RD 28,30,4608
RD 32,30,6912
ds_read_b128 a[36:39], v31
TR 80,25,49664
TR 82,25,50176
TR 84,25,62080
TR 86,25,62592
TR 88,25,50688
TR 90,25,51200
TR 92,25,63104
TR 94,25,63616
TR 96,25,51712
TR 98,25,52224
TR 100,25,64128
TR 102,25,64640
s_waitcnt vmcnt(8) lgkmcnt(0)
s_barrier
v_mfma_f32_16x16x32_bf16 v[60:63], a[80:83], a[0:3], 0
TR 104,25,49696
s_add_u32 m0, s55, 36992
MAA 60,84,20
buffer_load_dwordx4 v21, s[36:39], s52 offen lds
v_mfma_f32_16x16x32_bf16 v[64:67], a[80:83], a[4:7], 0
s_sub_u32 s47, s47, 1
s_cbranch_scc1 .Lx4
.Lx4b:
MAA 64,84,24
buffer_load_dwordx4 v28, s[36:39], s52 offen offset:1024 lds
v_mfma_f32_16x16x32_bf16 v[68:71], a[80:83], a[8:11], 0
TR 106,25,50208
MAA 68,84,28
TR 108,25,62112
TR 110,25,62624
v_mfma_f32_16x16x32_bf16 v[72:75], a[80:83], a[12:15], 0
TR 112,25,50720
MAA 72,84,32
TR 114,25,51232
v_mfma_f32_16x16x32_bf16 v[244:247], a[80:83], a[16:19], 0
TR 116,25,63136
MAA 244,84,36
buffer_load_dword v22, s[36:39], s52 offen offset:2048 lds
v_mfma_f32_16x16x32_bf16 v[156:159], a[88:91], a[16:19], 0
s_add_u32 s52, s52, 128
s_add_u32 m0, s55, 39296
MAA 156,92,36
buffer_load_dwordx4 v21, s[36:39], s53 offen lds
v_mfma_f32_16x16x32_bf16 v[104:107], a[88:91], a[12:15], 0
TR 118,25,63648
MAA 104,92,32
buffer_load_dwordx4 v28, s[36:39], s53 offen offset:1024 lds
v_mfma_f32_16x16x32_bf16 v[100:103], a[88:91], a[8:11], 0
TR 120,25,51744
MAA 100,92,28
buffer_load_dword v29, s[36:39], s53 offen offset:2048 lds
v_mfma_f32_16x16x32_bf16 v[96:99], a[88:91], a[4:7], 0
s_add_u32 s53, s53, 128
MAA 96,92,24
TR 122,25,52256
TR 124,25,64160
v_mfma_f32_16x16x32_bf16 v[92:95], a[88:91], a[0:3], 0
TR 126,25,64672
s_add_u32 m0, s56, 98816
MAA 92,92,20
buffer_load_dwordx4 v18, s[20:23], s54 offen lds
v_mfma_f32_16x16x32_bf16 v[124:127], a[0:3], a[96:99], 0
RD 40,23,18496
MAA 124,20,100
buffer_load_dwordx4 v19, s[20:23], s54 offen offset:1024 lds
v_mfma_f32_16x16x32_bf16 v[128:131], a[4:7], a[96:99], 0
RD 44,23,20800
MAA 128,24,100
RD 48,23,23104
RD 52,23,25408
v_mfma_f32_16x16x32_bf16 v[132:135], a[8:11], a[96:99], 0
RD 56,24,18496
MAA 132,28,100
buffer_load_dwordx4 v20, s[20:23], s54 offen offset:2048 lds
v_mfma_f32_16x16x32_bf16 v[136:139], a[12:15], a[96:99], 0
s_add_u32 s54, s54, 196608
MAA 136,32,100
s_waitcnt vmcnt(11) lgkmcnt(5)
s_barrier
v_mfma_f32_16x16x32_bf16 v[76:79], a[104:107], a[0:3], 0
RD 60,30,18496
s_add_u32 m0, s56, 111232
MAA 76,108,20
buffer_load_dwordx4 v18, s[20:23], s54 offen lds
v_mfma_f32_16x16x32_bf16 v[80:83], a[104:107], a[4:7], 0
RD 64,30,20800
MAA 80,108,24
buffer_load_dwordx4 v19, s[20:23], s54 offen offset:1024 lds
v_mfma_f32_16x16x32_bf16 v[84:87], a[104:107], a[8:11], 0
RD 68,30,23104
MAA 84,108,28
RD 72,30,25408
RD 76,31,18496
v_mfma_f32_16x16x32_bf16 v[88:91], a[104:107], a[12:15], 0
ds_read_b64_tr_b16 a[80:81], v25
MAA 88,108,32
buffer_load_dwordx4 v20, s[20:23], s54 offen offset:2048 lds
v_mfma_f32_16x16x32_bf16 v[160:163], a[112:115], a[16:19], 0
s_add_u32 s54, s54, 196608
s_add_u32 m0, s55, 55488
MAA 160,116,36
buffer_load_dwordx4 v21, s[36:39], s52 offen lds
v_mfma_f32_16x16x32_bf16 v[120:123], a[112:115], a[12:15], 0
TR 82,25,512
MAA 120,116,32
buffer_load_dwordx4 v28, s[36:39], s52 offen offset:1024 lds
v_mfma_f32_16x16x32_bf16 v[116:119], a[112:115], a[8:11], 0
TR 84,25,12416
MAA 116,116,28
TR 86,25,12928
TR 88,25,1024
v_mfma_f32_16x16x32_bf16 v[112:115], a[112:115], a[4:7], 0
TR 90,25,1536
MAA 112,116,24
buffer_load_dword v22, s[36:39], s52 offen offset:2048 lds
v_mfma_f32_16x16x32_bf16 v[108:111], a[112:115], a[0:3], 0
s_add_u32 s52, s52, 128
s_add_u32 m0, s55, 57792
MAA 108,116,20
buffer_load_dwordx4 v21, s[36:39], s53 offen lds
v_mfma_f32_16x16x32_bf16 v[140:143], a[0:3], a[120:123], 0
TR 92,25,13440
MAA 140,20,124
buffer_load_dwordx4 v28, s[36:39], s53 offen offset:1024 lds
v_mfma_f32_16x16x32_bf16 v[144:147], a[4:7], a[120:123], 0
TR 94,25,13952
MAA 144,24,124
TR 96,25,2048
TR 98,25,2560
v_mfma_f32_16x16x32_bf16 v[148:151], a[8:11], a[120:123], 0
TR 100,25,14464
MAA 148,28,124
buffer_load_dword v29, s[36:39], s53 offen offset:2048 lds
v_mfma_f32_16x16x32_bf16 v[152:155], a[12:15], a[120:123], 0
TR 102,25,14976
s_add_u32 s53, s53, 128
MAA 152,32,124
s_waitcnt vmcnt(12) lgkmcnt(8)
s_barrier
MAA 60,80,40
TR 104,25,32
s_add_u32 m0, s56, 123648
MAA 60,84,60
buffer_load_dwordx4 v18, s[20:23], s54 offen lds
MAA 64,84,64
s_sub_u32 s47, s47, 1
s_cbranch_scc1 .Lx5
.Lx5b:
MAA 64,80,44
buffer_load_dwordx4 v19, s[20:23], s54 offen offset:1024 lds
MAA 68,80,48
TR 106,25,544
MAA 68,84,68
TR 108,25,12448
TR 110,25,12960
MAA 72,84,72
TR 112,25,1056
MAA 72,80,52
TR 114,25,1568
s_waitcnt lgkmcnt(6)
MAA 244,80,56
TR 116,25,13472
MAA 244,84,76
buffer_load_dwordx4 v20, s[20:23], s54 offen offset:2048 lds
MAA 156,92,76
s_add_u32 s54, s54, 196608
s_add_u32 m0, s56, 136064
MAA 156,88,56
buffer_load_dwordx4 v18, s[20:23], s54 offen lds
MAA 104,88,52
TR 118,25,13984
MAA 104,92,72
buffer_load_dwordx4 v19, s[20:23], s54 offen offset:1024 lds
MAA 100,92,68
TR 120,25,2080
MAA 100,88,48
buffer_load_dwordx4 v20, s[20:23], s54 offen offset:2048 lds
MAA 96,88,44
s_add_u32 s54, s54, 196608
MAA 96,92,64
TR 122,25,2592
TR 124,25,14496
MAA 92,92,60
TR 126,25,15008
s_add_u32 m0, s55, 0
MAA 92,88,40
buffer_load_dwordx4 v21, s[36:39], s52 offen lds
MAA 124,40,96
RD 0,23,36992
MAA 124,60,100
buffer_load_dwordx4 v28, s[36:39], s52 offen offset:1024 lds
MAA 128,64,100
RD 4,23,39296
MAA 128,44,96
RD 8,23,41600
RD 12,23,43904
MAA 132,48,96
RD 16,24,36992
MAA 132,68,100
buffer_load_dword v22, s[36:39], s52 offen offset:2048 lds
MAA 136,72,100
s_add_u32 s52, s52, 128
MAA 136,52,96
s_waitcnt vmcnt(15) lgkmcnt(5)
s_barrier
MAA 76,104,40
RD 20,30,36992
s_add_u32 m0, s55, 2304
MAA 76,108,60
buffer_load_dwordx4 v21, s[36:39], s53 offen lds
MAA 80,108,64
RD 24,30,39296
MAA 80,104,44
buffer_load_dwordx4 v28, s[36:39], s53 offen offset:1024 lds
MAA 84,104,48
RD 28,30,41600
MAA 84,108,68
buffer_load_dword v29, s[36:39], s53 offen offset:2048 lds
MAA 88,108,72
RD 32,30,43904
s_add_u32 s53, s53, 128
MAA 88,104,52
RD 36,31,36992
TR 80,25,24832
TR 82,25,25344
MAA 160,112,56
TR 84,25,37248
s_add_u32 m0, s56, 73984
MAA 160,116,76
buffer_load_dwordx4 v18, s[20:23], s54 offen lds
MAA 120,116,72
TR 86,25,37760
MAA 120,112,52
buffer_load_dwordx4 v19, s[20:23], s54 offen offset:1024 lds
MAA 116,112,48
TR 88,25,25856
MAA 116,116,68
buffer_load_dwordx4 v20, s[20:23], s54 offen offset:2048 lds
MAA 112,116,64
s_add_u32 s54, s54, 196608
s_add_u32 m0, s55, 18496
MAA 112,112,44
buffer_load_dwordx4 v21, s[36:39], s52 offen lds
MAA 108,112,40
TR 90,25,26368
MAA 108,116,60
buffer_load_dwordx4 v28, s[36:39], s52 offen offset:1024 lds
MAA 140,60,124
TR 92,25,38272
MAA 140,40,120
TR 94,25,38784
TR 96,25,26880
TR 98,25,27392
MAA 144,44,120
TR 100,25,39296
MAA 144,64,124
buffer_load_dword v22, s[36:39], s52 offen offset:2048 lds
MAA 148,68,124
TR 102,25,39808
s_add_u32 s52, s52, 128
MAA 148,48,120
buffer_load_dword v37, v34, s[40:43], 0 offen sc1
MAA 152,52,120
MAA 152,72,124
s_waitcnt vmcnt(19) lgkmcnt(8)
s_barrier
MAA 60,80,0
TR 104,25,24864
s_add_u32 m0, s56, 86400
MAA 60,84,20
buffer_load_dwordx4 v18, s[20:23], s54 offen lds
MAA 64,84,24
s_sub_u32 s47, s47, 1
s_cbranch_scc1 .Lx6
.Lx6b:
MAA 64,80,4
buffer_load_dwordx4 v19, s[20:23], s54 offen offset:1024 lds
MAA 68,80,8
TR 106,25,25376
MAA 68,84,28
TR 108,25,37280
TR 110,25,37792
MAA 72,84,32
TR 112,25,25888
MAA 72,80,12
TR 114,25,26400
s_waitcnt lgkmcnt(6)
MAA 244,80,16
TR 116,25,38304
MAA 244,84,36
buffer_load_dwordx4 v20, s[20:23], s54 offen offset:2048 lds
MAA 156,92,36
s_add_u32 s54, s54, 196608
s_add_u32 m0, s55, 20800
MAA 156,88,16
buffer_load_dwordx4 v21, s[36:39], s53 offen lds
MAA 104,88,12
TR 118,25,38816
MAA 104,92,32
buffer_load_dwordx4 v28, s[36:39], s53 offen offset:1024 lds
MAA 100,92,28
TR 120,25,26912
MAA 100,88,8
buffer_load_dword v29, s[36:39], s53 offen offset:2048 lds
MAA 96,88,4
s_add_u32 s53, s53, 128
MAA 96,92,24
TR 122,25,27424
TR 124,25,39328
MAA 92,92,20
TR 126,25,39840
s_add_u32 m0, s55, 36992
MAA 92,88,0
buffer_load_dwordx4 v21, s[36:39], s52 offen lds
MAA 124,0,96
RD 40,23,55488
MAA 124,20,100
buffer_load_dwordx4 v28, s[36:39], s52 offen offset:1024 lds
MAA 128,24,100
RD 44,23,57792
MAA 128,4,96
RD 48,23,60096
RD 52,23,62400
MAA 132,8,96
RD 56,24,55488
MAA 132,28,100
buffer_load_dword v22, s[36:39], s52 offen offset:2048 lds
MAA 136,32,100
s_add_u32 s52, s52, 128
MAA 136,12,96
s_waitcnt vmcnt(22) lgkmcnt(5)
s_barrier
MAA 76,104,0
RD 60,30,55488
s_add_u32 m0, s56, 98816
MAA 76,108,20
buffer_load_dwordx4 v18, s[20:23], s54 offen lds
MAA 80,108,24
RD 64,30,57792
MAA 80,104,4
RD 68,30,60096
MAA 84,104,8
RD 72,30,62400
MAA 84,108,28
buffer_load_dwordx4 v19, s[20:23], s54 offen offset:1024 lds
MAA 88,108,32
RD 76,31,55488
MAA 88,104,12
TR 80,25,49664
MAA 160,112,16
TR 82,25,50176
MAA 160,116,36
buffer_load_dwordx4 v20, s[20:23], s54 offen offset:2048 lds
MAA 120,116,32
TR 84,25,62080
s_add_u32 s54, s54, 196608
MAA 120,112,12
TR 86,25,62592
MAA 116,112,8
s_add_u32 m0, s55, 39296
MAA 116,116,28
buffer_load_dwordx4 v21, s[36:39], s53 offen lds
MAA 112,116,24
TR 88,25,50688
MAA 112,112,4
TR 90,25,51200
MAA 108,112,0
TR 92,25,63104
MAA 108,116,20
buffer_load_dwordx4 v28, s[36:39], s53 offen offset:1024 lds
MAA 140,20,124
TR 94,25,63616
MAA 140,0,120
TR 96,25,51712
MAA 144,4,120
TR 98,25,52224
MAA 144,24,124
buffer_load_dword v29, s[36:39], s53 offen offset:2048 lds
MAA 148,28,124
TR 100,25,64128
s_add_u32 s53, s53, 128
MAA 148,8,120
TR 102,25,64640
MAA 152,12,120
MAA 152,32,124
s_waitcnt vmcnt(22) lgkmcnt(8)
s_barrier
MAA 60,80,40
TR 104,25,49696
s_add_u32 m0, s56, 111232
MAA 60,84,60
buffer_load_dwordx4 v18, s[20:23], s54 offen lds
MAA 64,84,64
s_sub_u32 s47, s47, 1
s_cbranch_scc1 .Lx7
.Lx7b:
MAA 64,80,44
TR 106,25,50208
MAA 68,80,48
TR 108,25,62112
MAA 68,84,68
buffer_load_dwordx4 v19, s[20:23], s54 offen offset:1024 lds
MAA 72,84,72
TR 110,25,62624
MAA 72,80,52
TR 112,25,50720
s_waitcnt lgkmcnt(5)
MAA 244,80,56
TR 114,25,51232
MAA 244,84,76
.Lpad1:
s_cbranch_execz .Lpad5
buffer_load_dwordx4 v20, s[20:23], s54 offen offset:2048 lds
MAA 156,92,76
s_add_u32 s54, s54, 196608
MAA 156,88,56
TR 116,25,63136
MAA 104,88,52
TR 118,25,63648
MAA 104,92,72
TR 120,25,51744
MAA 100,92,68
TR 122,25,52256
s_add_u32 m0, s55, 55488
MAA 100,88,48
buffer_load_dwordx4 v21, s[36:39], s52 offen lds
MAA 96,88,44
TR 124,25,64160
MAA 96,92,64
TR 126,25,64672
MAA 92,92,60
MAA 92,88,40
buffer_load_dwordx4 v28, s[36:39], s52 offen offset:1024 lds
MAA 124,40,96
ds_read_b128 a[0:3], v23
MAA 124,60,100
RD 4,23,2304
MAA 128,64,100
RD 8,23,4608
MAA 128,44,96
buffer_load_dword v22, s[36:39], s52 offen offset:2048 lds
MAA 132,48,96
RD 12,23,6912
s_add_u32 s52, s52, 128
MAA 132,68,100
ds_read_b128 a[16:19], v24
MAA 136,72,100
MAA 136,52,96
s_waitcnt vmcnt(18) lgkmcnt(5)
s_barrier
v_cmp_gt_u32 vcc, v35, v37
s_nop 0
s_cbranch_vccnz .Lsp8
.Lsp8b:
v_mov_b32 v37, 0
MAA 76,104,40
ds_read_b128 a[20:23], v30
MAA 76,108,60
buffer_atomic_add v38, v32, s[16:19], 0 offen
MAA 80,108,64
RD 24,30,2304
MAA 80,104,44
RD 28,30,4608
MAA 84,104,48
RD 32,30,6912
s_add_u32 m0, s56, 123648
MAA 84,108,68
buffer_load_dwordx4 v18, s[20:23], s54 offen lds
MAA 88,108,72
ds_read_b128 a[36:39], v31
MAA 88,104,52
buffer_load_dwordx4 v19, s[20:23], s54 offen offset:1024 lds
MAA 160,112,56
ds_read_b64_tr_b16 a[80:81], v25
MAA 160,116,76
TR 82,25,512
MAA 120,116,72
TR 84,25,12416
MAA 120,112,52
buffer_load_dwordx4 v20, s[20:23], s54 offen offset:2048 lds
MAA 116,112,48
TR 86,25,12928
s_add_u32 s54, s54, 196608
MAA 116,116,68
TR 88,25,1024
MAA 112,116,64
TR 90,25,1536
s_add_u32 m0, s55, 57792
MAA 112,112,44
buffer_load_dwordx4 v21, s[36:39], s53 offen lds
MAA 108,112,40
TR 92,25,13440
MAA 108,116,60
TR 94,25,13952
MAA 140,60,124
TR 96,25,2048
MAA 140,40,120
buffer_load_dwordx4 v28, s[36:39], s53 offen offset:1024 lds
MAA 144,44,120
TR 98,25,2560
MAA 144,64,124
buffer_load_dword v29, s[36:39], s53 offen offset:2048 lds
MAA 148,68,124
TR 100,25,14464
s_add_u32 s53, s53, 128
MAA 148,48,120
TR 102,25,14976
MAA 152,52,120
MAA 152,72,124
s_waitcnt vmcnt(22) lgkmcnt(8)
s_barrier
MAA 60,80,0
TR 104,25,32
s_add_u32 m0, s56, 136064
MAA 60,84,20
buffer_load_dwordx4 v18, s[20:23], s54 offen lds
MAA 64,84,24
s_sub_u32 s47, s47, 1
s_cbranch_scc1 .Lx9
.Lx9b:
MAA 64,80,4
TR 106,25,544
v_accvgpr_write_b32 a224, v192
MAA 68,80,8
TR 108,25,12448
MAA 68,84,28
buffer_load_dwordx4 v19, s[20:23], s54 offen offset:1024 lds
MAA 72,84,32
TR 110,25,12960
v_accvgpr_write_b32 a225, v193
MAA 72,80,12
TR 112,25,1056
s_waitcnt lgkmcnt(5)
MAA 244,80,16
TR 114,25,1568
MAA 244,84,36
buffer_load_dwordx4 v20, s[20:23], s54 offen offset:2048 lds
MAA 156,92,36
s_add_u32 s54, s54, 196608
v_accvgpr_write_b32 a226, v194
MAA 156,88,16
TR 116,25,13472
MAA 104,88,12
TR 118,25,13984
v_accvgpr_write_b32 a227, v195
MAA 104,92,32
TR 120,25,2080
MAA 100,92,28
TR 122,25,2592
s_add_u32 m0, s55, 0
MAA 100,88,8
buffer_load_dwordx4 v21, s[36:39], s52 offen lds
MAA 96,88,4
TR 124,25,14496
v_accvgpr_write_b32 a228, v196
MAA 96,92,24
TR 126,25,15008
MAA 92,92,20
v_accvgpr_write_b32 a229, v197
MAA 92,88,0
buffer_load_dwordx4 v28, s[36:39], s52 offen offset:1024 lds
MAA 124,0,96
RD 40,23,18496
MAA 124,20,100
RD 44,23,20800
v_accvgpr_write_b32 a230, v198
MAA 128,24,100
RD 48,23,23104
MAA 128,4,96
buffer_load_dword v22, s[36:39], s52 offen offset:2048 lds
MAA 132,8,96
RD 52,23,25408
s_add_u32 s52, s52, 128
MAA 132,28,100
RD 56,24,18496
v_accvgpr_write_b32 a231, v199
MAA 136,32,100
MAA 136,12,96
s_waitcnt vmcnt(16) lgkmcnt(5)
s_barrier
MAA 76,104,0
RD 60,30,18496
s_add_u32 m0, s56, 73984
MAA 76,108,20
buffer_load_dwordx4 v18, s[20:23], s54 offen lds
MAA 80,108,24
RD 64,30,20800
v_accvgpr_write_b32 a232, v200
MAA 80,104,4
RD 68,30,23104
MAA 84,104,8
RD 72,30,25408
v_accvgpr_write_b32 a233, v201
MAA 84,108,28
buffer_load_dwordx4 v19, s[20:23], s54 offen offset:1024 lds
MAA 88,108,32
RD 76,31,18496
MAA 88,104,12
TR 80,25,24832
v_accvgpr_write_b32 a234, v202
MAA 160,112,16
TR 82,25,25344
MAA 160,116,36
buffer_load_dwordx4 v20, s[20:23], s54 offen offset:2048 lds
MAA 120,116,32
TR 84,25,37248
s_add_u32 s54, s54, 196608
MAA 120,112,12
TR 86,25,37760
v_accvgpr_write_b32 a235, v203
MAA 116,112,8
s_add_u32 m0, s55, 2304
MAA 116,116,28
buffer_load_dwordx4 v21, s[36:39], s53 offen lds
MAA 112,116,24
TR 88,25,25856
v_accvgpr_write_b32 a236, v204
MAA 112,112,4
TR 90,25,26368
MAA 108,112,0
TR 92,25,38272
v_accvgpr_write_b32 a237, v205
MAA 108,116,20
buffer_load_dwordx4 v28, s[36:39], s53 offen offset:1024 lds
MAA 140,20,124
TR 94,25,38784
MAA 140,0,120
TR 96,25,26880
v_accvgpr_write_b32 a238, v206
MAA 144,4,120
TR 98,25,27392
MAA 144,24,124
buffer_load_dword v29, s[36:39], s53 offen offset:2048 lds
MAA 148,28,124
TR 100,25,39296
s_add_u32 s53, s53, 128
MAA 148,8,120
TR 102,25,39808
v_accvgpr_write_b32 a239, v207
MAA 152,12,120
MAA 152,32,124
s_waitcnt lgkmcnt(8)
s_barrier
MAA 60,80,40
TR 104,25,24864
s_add_u32 m0, s56, 86400
MAA 60,84,60
buffer_load_dwordx4 v18, s[20:23], s54 offen lds
MAA 64,84,64
s_sub_u32 s47, s47, 1
s_cbranch_scc1 .Lx10
.Lx10b:
MAA 64,80,44
TR 106,25,25376
v_accvgpr_write_b32 a240, v208
MAA 68,80,48
TR 108,25,37280
MAA 68,84,68
buffer_load_dwordx4 v19, s[20:23], s54 offen offset:1024 lds
MAA 72,84,72
TR 110,25,37792
v_accvgpr_write_b32 a241, v209
MAA 72,80,52
TR 112,25,25888
s_waitcnt lgkmcnt(5)
MAA 244,80,56
TR 114,25,26400
MAA 244,84,76
buffer_load_dwordx4 v20, s[20:23], s54 offen offset:2048 lds
MAA 156,92,76
s_add_u32 s54, s54, 196608
v_accvgpr_write_b32 a242, v210
MAA 156,88,56
TR 116,25,38304
MAA 104,88,52
TR 118,25,38816
v_accvgpr_write_b32 a243, v211
MAA 104,92,72
TR 120,25,26912
MAA 100,92,68
TR 122,25,27424
s_add_u32 m0, s55, 18496
MAA 100,88,48
buffer_load_dwordx4 v21, s[36:39], s52 offen lds
MAA 96,88,44
TR 124,25,39328
v_accvgpr_write_b32 a244, v212
MAA 96,92,64
TR 126,25,39840
MAA 92,92,60
v_accvgpr_write_b32 a245, v213
MAA 92,88,40
buffer_load_dwordx4 v28, s[36:39], s52 offen offset:1024 lds
MAA 124,40,96
RD 0,23,36992
MAA 124,60,100
RD 4,23,39296
v_accvgpr_write_b32 a246, v214
MAA 128,64,100
RD 8,23,41600
MAA 128,44,96
buffer_load_dword v22, s[36:39], s52 offen offset:2048 lds
MAA 132,48,96
RD 12,23,43904
s_add_u32 s52, s52, 128
MAA 132,68,100
RD 16,24,36992
v_accvgpr_write_b32 a247, v215
MAA 136,72,100
MAA 136,52,96
s_waitcnt vmcnt(15) lgkmcnt(5)
s_barrier
MAA 76,104,40
RD 20,30,36992
s_add_u32 m0, s56, 98816
MAA 76,108,60
buffer_load_dwordx4 v18, s[20:23], s54 offen lds
MAA 80,108,64
RD 24,30,39296
v_accvgpr_write_b32 a248, v216
MAA 80,104,44
RD 28,30,41600
v_accvgpr_write_b32 a249, v217
MAA 84,104,48
RD 32,30,43904
MAA 84,108,68
buffer_load_dwordx4 v19, s[20:23], s54 offen offset:1024 lds
MAA 88,108,72
RD 36,31,36992
v_accvgpr_write_b32 a250, v218
MAA 88,104,52
buffer_load_dwordx4 v20, s[20:23], s54 offen offset:2048 lds
MAA 160,112,56
TR 80,25,49664
s_add_u32 s54, s54, 196608
MAA 160,116,76
TR 82,25,50176
MAA 120,116,72
TR 84,25,62080
s_add_u32 m0, s55, 20800
MAA 120,112,52
buffer_load_dwordx4 v21, s[36:39], s53 offen lds
MAA 116,112,48
TR 86,25,62592
v_accvgpr_write_b32 a251, v219
MAA 116,116,68
TR 88,25,50688
MAA 112,116,64
TR 90,25,51200
v_accvgpr_write_b32 a252, v220
MAA 112,112,44
buffer_load_dwordx4 v28, s[36:39], s53 offen offset:1024 lds
MAA 108,112,40
TR 92,25,63104
MAA 108,116,60
TR 94,25,63616
v_accvgpr_write_b32 a253, v221
MAA 140,60,124
TR 96,25,51712
MAA 140,40,120
buffer_load_dword v29, s[36:39], s53 offen offset:2048 lds
MAA 144,44,120
TR 98,25,52224
s_add_u32 s53, s53, 128
MAA 144,64,124
buffer_atomic_add v37, v33, s[16:19], 0 offen sc0
MAA 148,68,124
TR 100,25,64128
v_accvgpr_write_b32 a254, v222
MAA 148,48,120
TR 102,25,64640
MAA 152,52,120
v_accvgpr_write_b32 a255, v223
MAA 152,72,124
s_waitcnt lgkmcnt(8)
s_barrier
MAA 60,80,0
TR 104,25,49696
s_add_u32 m0, s56, 111232
MAA 60,84,20
buffer_load_dwordx4 v18, s[20:23], s54 offen lds
MAA 64,84,24
s_sub_u32 s47, s47, 1
s_cbranch_scc1 .Lx11
.Lx11b:
MAA 64,80,4
TR 106,25,50208
MAA 68,80,8
TR 108,25,62112
MAA 68,84,28
buffer_load_dwordx4 v19, s[20:23], s54 offen offset:1024 lds
MAA 72,84,32
TR 110,25,62624
MAA 72,80,12
TR 112,25,50720
s_waitcnt lgkmcnt(5)
MAA 244,80,16
TR 114,25,51232
MAA 244,84,36
buffer_load_dwordx4 v20, s[20:23], s54 offen offset:2048 lds
MAA 156,92,36
s_add_u32 s54, s54, 196608
MAA 156,88,16
TR 116,25,63136
MAA 104,88,12
TR 118,25,63648
MAA 104,92,32
TR 120,25,51744
MAA 100,92,28
TR 122,25,52256
s_add_u32 m0, s55, 36992
MAA 100,88,8
buffer_load_dwordx4 v21, s[36:39], s52 offen lds
MAA 96,88,4
TR 124,25,64160
MAA 96,92,24
TR 126,25,64672
MAA 92,92,20
MAA 92,88,0
buffer_load_dwordx4 v28, s[36:39], s52 offen offset:1024 lds
MAA 124,0,96
RD 40,23,55488
MAA 124,20,100
RD 44,23,57792
MAA 128,24,100
RD 48,23,60096
MAA 128,4,96
buffer_load_dword v22, s[36:39], s52 offen offset:2048 lds
MAA 132,8,96
RD 52,23,62400
s_add_u32 s52, s52, 128
MAA 132,28,100
RD 56,24,55488
MAA 136,32,100
MAA 136,12,96
s_waitcnt vmcnt(16) lgkmcnt(5)
s_barrier
MAA 76,104,0
RD 60,30,55488
s_add_u32 m0, s56, 123648
MAA 76,108,20
buffer_load_dwordx4 v18, s[20:23], s54 offen lds
MAA 80,108,24
RD 64,30,57792
MAA 80,104,4
RD 68,30,60096
MAA 84,104,8
RD 72,30,62400
MAA 84,108,28
buffer_load_dwordx4 v19, s[20:23], s54 offen offset:1024 lds
MAA 88,108,32
RD 76,31,55488
MAA 88,104,12
ds_read_b64_tr_b16 a[80:81], v25
MAA 160,112,16
TR 82,25,512
MAA 160,116,36
buffer_load_dwordx4 v20, s[20:23], s54 offen offset:2048 lds
MAA 120,116,32
TR 84,25,12416
s_add_u32 s54, s54, 196608
MAA 120,112,12
TR 86,25,12928
MAA 116,112,8
s_add_u32 m0, s55, 39296
MAA 116,116,28
buffer_load_dwordx4 v21, s[36:39], s53 offen lds
MAA 112,116,24
TR 88,25,1024
MAA 112,112,4
TR 90,25,1536
MAA 108,112,0
TR 92,25,13440
MAA 108,116,20
buffer_load_dwordx4 v28, s[36:39], s53 offen offset:1024 lds
MAA 140,20,124
TR 94,25,13952
MAA 140,0,120
TR 96,25,2048
MAA 144,4,120
TR 98,25,2560
MAA 144,24,124
buffer_load_dword v29, s[36:39], s53 offen offset:2048 lds
MAA 148,28,124
TR 100,25,14464
s_add_u32 s53, s53, 128
MAA 148,8,120
TR 102,25,14976
MAA 152,12,120
MAA 152,32,124
s_waitcnt lgkmcnt(8)
s_barrier
MAA 60,80,40
TR 104,25,32
s_add_u32 m0, s56, 136064
MAA 60,84,60
buffer_load_dwordx4 v18, s[20:23], s54 offen lds
MAA 64,84,64
s_sub_u32 s47, s47, 1
s_cbranch_scc1 .Lx12
.Lx12b:
MAA 64,80,44
TR 106,25,544
MAA 68,80,48
TR 108,25,12448
MAA 68,84,68
buffer_load_dwordx4 v19, s[20:23], s54 offen offset:1024 lds
MAA 72,84,72
TR 110,25,12960
MAA 72,80,52
TR 112,25,1056
s_waitcnt lgkmcnt(5)
MAA 244,80,56
TR 114,25,1568
MAA 244,84,76
buffer_load_dwordx4 v20, s[20:23], s54 offen offset:2048 lds
MAA 156,92,76
s_add_u32 s54, s54, 196608
MAA 156,88,56
TR 116,25,13472
MAA 104,88,52
TR 118,25,13984
MAA 104,92,72
TR 120,25,2080
MAA 100,92,68
TR 122,25,2592
s_add_u32 m0, s55, 55488
MAA 100,88,48
buffer_load_dwordx4 v21, s[36:39], s52 offen lds
MAA 96,88,44
TR 124,25,14496
MAA 96,92,64
TR 126,25,15008
MAA 92,92,60
MAA 92,88,40
buffer_load_dwordx4 v28, s[36:39], s52 offen offset:1024 lds
MAA 124,40,96
ds_read_b128 a[0:3], v23
MAA 124,60,100
RD 4,23,2304
MAA 128,64,100
RD 8,23,4608
MAA 128,44,96
buffer_load_dword v22, s[36:39], s52 offen offset:2048 lds
MAA 132,48,96
.Lpad2:
s_cbranch_execz .Lpad6
RD 12,23,6912
s_add_u32 s52, s52, 128
MAA 132,68,100
ds_read_b128 a[16:19], v24
MAA 136,72,100
MAA 136,52,96
s_waitcnt vmcnt(18)
v_cmp_gt_u32 vcc, v36, v37
s_nop 0
s_cbranch_vccnz .Lsp13
.Lsp13b:
s_waitcnt vmcnt(15) lgkmcnt(5)
s_barrier
MAA 76,104,40
ds_read_b128 a[20:23], v30
s_add_u32 m0, s56, 73984
MAA 76,108,60
buffer_load_dwordx4 v18, s[20:23], s54 offen lds
MAA 80,108,64
RD 24,30,2304
MAA 80,104,44
RD 28,30,4608
MAA 84,104,48
RD 32,30,6912
MAA 84,108,68
buffer_load_dwordx4 v19, s[20:23], s54 offen offset:1024 lds
MAA 88,108,72
ds_read_b128 a[36:39], v31
MAA 88,104,52
buffer_load_dwordx4 v20, s[20:23], s54 offen offset:2048 lds
MAA 160,112,56
TR 80,25,24832
s_add_u32 s54, s54, 196608
MAA 160,116,76
TR 82,25,25344
MAA 120,116,72
TR 84,25,37248
s_add_u32 m0, s55, 57792
MAA 120,112,52
buffer_load_dwordx4 v21, s[36:39], s53 offen lds
MAA 116,112,48
TR 86,25,37760
MAA 116,116,68
TR 88,25,25856
MAA 112,116,64
TR 90,25,26368
MAA 112,112,44
buffer_load_dwordx4 v28, s[36:39], s53 offen offset:1024 lds
MAA 108,112,40
TR 92,25,38272
MAA 108,116,60
TR 94,25,38784
MAA 140,60,124
TR 96,25,26880
MAA 140,40,120
buffer_load_dword v29, s[36:39], s53 offen offset:2048 lds
MAA 144,44,120
TR 98,25,27392
s_add_u32 s53, s53, 128
MAA 144,64,124
buffer_load_dwordx4 v[164:167], v26, s[16:19], s75 offen sc1
MAA 148,68,124
TR 100,25,39296
MAA 148,48,120
TR 102,25,39808
MAA 152,52,120
MAA 152,72,124
s_waitcnt lgkmcnt(8)
s_barrier
MAA 60,80,0
TR 104,25,24864
s_add_u32 m0, s56, 86400
MAA 60,84,20
buffer_load_dwordx4 v18, s[20:23], s54 offen lds
MAA 64,84,24
s_sub_u32 s47, s47, 1
s_cbranch_scc1 .Lx14
.Lx14b:
MAA 64,80,4
TR 106,25,25376
MAA 68,80,8
TR 108,25,37280
MAA 68,84,28
buffer_load_dwordx4 v19, s[20:23], s54 offen offset:1024 lds
MAA 72,84,32
TR 110,25,37792
MAA 72,80,12
TR 112,25,25888
s_waitcnt lgkmcnt(5)
MAA 244,80,16
TR 114,25,26400
MAA 244,84,36
buffer_load_dwordx4 v20, s[20:23], s54 offen offset:2048 lds
MAA 156,92,36
TR 116,25,38304
s_add_u32 s54, s54, 196608
MAA 156,88,16
TR 118,25,38816
MAA 104,88,12
TR 120,25,26912
s_add_u32 m0, s55, 0
MAA 104,92,32
buffer_load_dwordx4 v21, s[36:39], s52 offen lds
MAA 100,92,28
MAA 100,88,8
buffer_load_dwordx4 v28, s[36:39], s52 offen offset:1024 lds
MAA 96,88,4
TR 122,25,27424
MAA 96,92,24
TR 124,25,39328
MAA 92,92,20
TR 126,25,39840
MAA 92,88,0
buffer_load_dword v22, s[36:39], s52 offen offset:2048 lds
MAA 124,0,96
RD 40,23,18496
s_add_u32 s52, s52, 128
MAA 124,20,100
RD 44,23,20800
MAA 128,24,100
RD 48,23,23104
MAA 128,4,96
buffer_load_dwordx4 v[168:171], v26, s[16:19], s75 offen offset:1024 sc1
MAA 132,8,96
RD 52,23,25408
MAA 132,28,100
RD 56,24,18496
MAA 136,32,100
MAA 136,12,96
s_waitcnt vmcnt(17) lgkmcnt(5)
s_barrier
MAA 76,104,0
RD 60,30,18496
s_add_u32 m0, s56, 98816
MAA 76,108,20
buffer_load_dwordx4 v18, s[20:23], s54 offen lds
MAA 80,108,24
RD 64,30,20800
MAA 80,104,4
RD 68,30,23104
MAA 84,104,8
RD 72,30,25408
MAA 84,108,28
buffer_load_dwordx4 v19, s[20:23], s54 offen offset:1024 lds
MAA 88,108,32
RD 76,31,18496
MAA 88,104,12
buffer_load_dwordx4 v20, s[20:23], s54 offen offset:2048 lds
MAA 160,112,16
TR 80,25,49664
s_add_u32 s54, s54, 196608
MAA 160,116,36
TR 82,25,50176
MAA 120,116,32
TR 84,25,62080
s_add_u32 m0, s55, 2304
MAA 120,112,12
buffer_load_dwordx4 v21, s[36:39], s53 offen lds
MAA 116,112,8
TR 86,25,62592
MAA 116,116,28
TR 88,25,50688
MAA 112,116,24
TR 90,25,51200
MAA 112,112,4
buffer_load_dwordx4 v28, s[36:39], s53 offen offset:1024 lds
MAA 108,112,0
TR 92,25,63104
MAA 108,116,20
TR 94,25,63616
MAA 140,20,124
TR 96,25,51712
MAA 140,0,120
buffer_load_dword v29, s[36:39], s53 offen offset:2048 lds
MAA 144,4,120
TR 98,25,52224
s_add_u32 s53, s53, 128
MAA 144,24,124
buffer_load_dwordx4 v[172:175], v26, s[16:19], s75 offen offset:2048 sc1
MAA 148,28,124
TR 100,25,64128
MAA 148,8,120
TR 102,25,64640
MAA 152,12,120
MAA 152,32,124
s_waitcnt lgkmcnt(8)
s_barrier
MAA 60,80,40
TR 104,25,49696
s_add_u32 m0, s56, 111232
MAA 60,84,60
buffer_load_dwordx4 v18, s[20:23], s54 offen lds
MAA 64,84,64
s_sub_u32 s47, s47, 1
s_cbranch_scc1 .Lx15
.Lx15b:
MAA 64,80,44
TR 106,25,50208
MAA 68,80,48
TR 108,25,62112
MAA 68,84,68
buffer_load_dwordx4 v19, s[20:23], s54 offen offset:1024 lds
MAA 72,84,72
TR 110,25,62624
MAA 72,80,52
TR 112,25,50720
s_waitcnt lgkmcnt(5)
MAA 244,80,56
TR 114,25,51232
MAA 244,84,76
buffer_load_dwordx4 v20, s[20:23], s54 offen offset:2048 lds
MAA 156,92,76
TR 116,25,63136
s_add_u32 s54, s54, 196608
MAA 156,88,56
TR 118,25,63648
MAA 104,88,52
TR 120,25,51744
s_add_u32 m0, s55, 18496
MAA 104,92,72
buffer_load_dwordx4 v21, s[36:39], s52 offen lds
MAA 100,92,68
MAA 100,88,48
buffer_load_dwordx4 v28, s[36:39], s52 offen offset:1024 lds
MAA 96,88,44
TR 122,25,52256
MAA 96,92,64
TR 124,25,64160
MAA 92,92,60
TR 126,25,64672
MAA 92,88,40
buffer_load_dword v22, s[36:39], s52 offen offset:2048 lds
MAA 124,40,96
RD 0,23,36992
s_add_u32 s52, s52, 128
MAA 124,60,100
RD 4,23,39296
MAA 128,64,100
RD 8,23,41600
MAA 128,44,96
buffer_load_dwordx4 v[176:179], v26, s[16:19], s75 offen offset:3072 sc1
MAA 132,48,96
RD 12,23,43904
s_add_u32 s75, s75, 4096
MAA 132,68,100
RD 16,24,36992
MAA 136,72,100
MAA 136,52,96
s_waitcnt vmcnt(18) lgkmcnt(5)
s_barrier
MAA 76,104,40
RD 20,30,36992
s_add_u32 m0, s56, 123648
MAA 76,108,60
buffer_load_dwordx4 v18, s[20:23], s54 offen lds
MAA 80,108,64
RD 24,30,39296
s_waitcnt vmcnt(15)
v_add_f32 v164, v164, v168
MAA 80,104,44
RD 28,30,41600
MAA 84,104,48
RD 32,30,43904
MAA 84,108,68
buffer_load_dwordx4 v19, s[20:23], s54 offen offset:1024 lds
MAA 88,108,72
RD 36,31,36992
v_add_f32 v165, v165, v169
MAA 88,104,52
buffer_load_dwordx4 v20, s[20:23], s54 offen offset:2048 lds
MAA 160,112,56
ds_read_b64_tr_b16 a[80:81], v25
s_add_u32 s54, s54, 196608
MAA 160,116,76
TR 82,25,512
MAA 120,116,72
TR 84,25,12416
s_add_u32 m0, s55, 20800
MAA 120,112,52
buffer_load_dwordx4 v21, s[36:39], s53 offen lds
MAA 116,112,48
TR 86,25,12928
MAA 116,116,68
TR 88,25,1024
MAA 112,116,64
TR 90,25,1536
v_add_f32 v166, v166, v170
MAA 112,112,44
buffer_load_dwordx4 v28, s[36:39], s53 offen offset:1024 lds
MAA 108,112,40
TR 92,25,13440
MAA 108,116,60
TR 94,25,13952
MAA 140,60,124
TR 96,25,2048
MAA 140,40,120
buffer_load_dword v29, s[36:39], s53 offen offset:2048 lds
MAA 144,44,120
TR 98,25,2560
s_add_u32 s53, s53, 128
MAA 144,64,124
buffer_load_dwordx4 v[180:183], v26, s[16:19], s75 offen sc1
MAA 148,68,124
TR 100,25,14464
v_add_f32 v167, v167, v171
MAA 148,48,120
TR 102,25,14976
MAA 152,52,120
MAA 152,72,124
s_waitcnt lgkmcnt(8)
s_barrier
MAA 60,80,0
TR 104,25,32
s_add_u32 m0, s56, 136064
MAA 60,84,20
buffer_load_dwordx4 v18, s[20:23], s54 offen lds
MAA 64,84,24
s_sub_u32 s47, s47, 1
s_cbranch_scc1 .Lx16
.Lx16b:
MAA 64,80,4
TR 106,25,544
s_waitcnt vmcnt(15)
v_add_f32 v164, v164, v172
MAA 68,80,8
TR 108,25,12448
MAA 68,84,28
buffer_load_dwordx4 v19, s[20:23], s54 offen offset:1024 lds
MAA 72,84,32
TR 110,25,12960
MAA 72,80,12
TR 112,25,1056
s_waitcnt lgkmcnt(5)
MAA 244,80,16
TR 114,25,1568
MAA 244,84,36
buffer_load_dwordx4 v20, s[20:23], s54 offen offset:2048 lds
MAA 156,92,36
TR 116,25,13472
s_add_u32 s54, s54, 196608
MAA 156,88,16
TR 118,25,13984
v_add_f32 v165, v165, v173
MAA 104,88,12
TR 120,25,2080
s_add_u32 m0, s55, 36992
MAA 104,92,32
buffer_load_dwordx4 v21, s[36:39], s52 offen lds
MAA 100,92,28
MAA 100,88,8
buffer_load_dwordx4 v28, s[36:39], s52 offen offset:1024 lds
MAA 96,88,4
TR 122,25,2592
MAA 96,92,24
TR 124,25,14496
v_add_f32 v166, v166, v174
MAA 92,92,20
TR 126,25,15008
MAA 92,88,0
buffer_load_dword v22, s[36:39], s52 offen offset:2048 lds
MAA 124,0,96
RD 40,23,55488
s_add_u32 s52, s52, 128
MAA 124,20,100
RD 44,23,57792
MAA 128,24,100
RD 48,23,60096
MAA 128,4,96
buffer_load_dwordx4 v[184:187], v26, s[16:19], s75 offen offset:1024 sc1
MAA 132,8,96
RD 52,23,62400
v_add_f32 v167, v167, v175
MAA 132,28,100
RD 56,24,55488
MAA 136,32,100
MAA 136,12,96
s_waitcnt vmcnt(18) lgkmcnt(5)
s_barrier
MAA 76,104,0
RD 60,30,55488
s_add_u32 m0, s56, 73984
MAA 76,108,20
buffer_load_dwordx4 v18, s[20:23], s54 offen lds
MAA 80,108,24
RD 64,30,57792
s_waitcnt vmcnt(15)
v_add_f32 v164, v164, v176
MAA 80,104,4
RD 68,30,60096
v_add_f32 v165, v165, v177
MAA 84,104,8
buffer_load_dwordx4 v19, s[20:23], s54 offen offset:1024 lds
MAA 84,108,28
RD 72,30,62400
v_add_f32 v166, v166, v178
MAA 88,108,32
RD 76,31,55488
v_add_f32 v167, v167, v179
MAA 88,104,12
buffer_load_dwordx4 v20, s[20:23], s54 offen offset:2048 lds
MAA 160,112,16
TR 80,25,24832
s_add_u32 s54, s54, 196608
MAA 160,116,36
TR 82,25,25344
s_add_u32 m0, s55, 39296
MAA 120,116,32
buffer_load_dwordx4 v21, s[36:39], s53 offen lds
MAA 120,112,12
TR 84,25,37248
MAA 116,112,8
TR 86,25,37760
MAA 116,116,28
buffer_load_dwordx4 v28, s[36:39], s53 offen offset:1024 lds
MAA 112,116,24
TR 88,25,25856
MAA 112,112,4
TR 90,25,26368
MAA 108,112,0
buffer_load_dword v29, s[36:39], s53 offen offset:2048 lds
MAA 108,116,20
TR 92,25,38272
s_add_u32 s53, s53, 128
MAA 140,20,124
TR 94,25,38784
MAA 140,0,120
buffer_load_dwordx4 v[188:191], v26, s[16:19], s75 offen offset:2048 sc1
MAA 144,4,120
TR 96,25,26880
MAA 144,24,124
TR 98,25,27392
MAA 148,28,124
TR 100,25,39296
MAA 148,8,120
TR 102,25,39808
MAA 152,12,120
MAA 152,32,124
s_waitcnt lgkmcnt(8)
s_barrier
MAA 60,80,40
TR 104,25,24864
s_add_u32 m0, s56, 86400
MAA 60,84,60
buffer_load_dwordx4 v18, s[20:23], s54 offen lds
MAA 64,84,64
s_sub_u32 s47, s47, 1
s_cbranch_scc1 .Lx17
.Lx17b:
MAA 64,80,44
TR 106,25,25376
s_waitcnt vmcnt(15)
v_add_f32 v164, v164, v180
MAA 68,80,48
TR 108,25,37280
MAA 68,84,68
buffer_load_dwordx4 v19, s[20:23], s54 offen offset:1024 lds
MAA 72,84,72
TR 110,25,37792
MAA 72,80,52
TR 112,25,25888
s_waitcnt lgkmcnt(5)
MAA 244,80,56
TR 114,25,26400
MAA 244,84,76
buffer_load_dwordx4 v20, s[20:23], s54 offen offset:2048 lds
MAA 156,92,76
TR 116,25,38304
s_add_u32 s54, s54, 196608
MAA 156,88,56
TR 118,25,38816
v_add_f32 v165, v165, v181
MAA 104,88,52
TR 120,25,26912
s_add_u32 m0, s55, 55488
MAA 104,92,72
buffer_load_dwordx4 v21, s[36:39], s52 offen lds
MAA 100,92,68
MAA 100,88,48
buffer_load_dwordx4 v28, s[36:39], s52 offen offset:1024 lds
MAA 96,88,44
TR 122,25,27424
MAA 96,92,64
TR 124,25,39328
v_add_f32 v166, v166, v182
MAA 92,92,60
TR 126,25,39840
MAA 92,88,40
buffer_load_dword v22, s[36:39], s52 offen offset:2048 lds
MAA 124,40,96
ds_read_b128 a[0:3], v23
s_add_u32 s52, s52, 128
MAA 124,60,100
RD 4,23,2304
MAA 128,64,100
RD 8,23,4608
MAA 128,44,96
buffer_load_dwordx4 v[192:195], v26, s[16:19], s75 offen offset:3072 sc1
MAA 132,48,96
RD 12,23,6912
v_add_f32 v167, v167, v183
MAA 132,68,100
ds_read_b128 a[16:19], v24
MAA 136,72,100
MAA 136,52,96
s_waitcnt vmcnt(18) lgkmcnt(5)
s_barrier
MAA 76,104,40
ds_read_b128 a[20:23], v30
s_add_u32 m0, s56, 98816
MAA 76,108,60
buffer_load_dwordx4 v18, s[20:23], s54 offen lds
MAA 80,108,64
RD 24,30,2304
s_waitcnt vmcnt(15)
v_add_f32 v164, v164, v184
MAA 80,104,44
RD 28,30,4608
v_add_f32 v165, v165, v185
MAA 84,104,48
RD 32,30,6912
v_add_f32 v166, v166, v186
MAA 84,108,68
buffer_load_dwordx4 v19, s[20:23], s54 offen offset:1024 lds
MAA 88,108,72
ds_read_b128 a[36:39], v31
v_add_f32 v167, v167, v187
MAA 88,104,52
TR 80,25,49664
MAA 160,112,56
TR 82,25,50176
MAA 160,116,76
buffer_load_dwordx4 v20, s[20:23], s54 offen offset:2048 lds
MAA 120,116,72
TR 84,25,62080
s_add_u32 s54, s54, 196608
MAA 120,112,52
TR 86,25,62592
s_add_u32 m0, s55, 57792
MAA 116,112,48
TR 88,25,50688
MAA 116,116,68
buffer_load_dwordx4 v21, s[36:39], s53 offen lds
MAA 112,116,64
TR 90,25,51200
MAA 112,112,44
TR 92,25,63104
MAA 108,112,40
.Lpad3:
s_cbranch_execz .Lpad7
TR 94,25,63616
MAA 108,116,60
buffer_load_dwordx4 v28, s[36:39], s53 offen offset:1024 lds
MAA 140,60,124
TR 96,25,51712
MAA 140,40,120
TR 98,25,52224
MAA 144,44,120
TR 100,25,64128
MAA 144,64,124
buffer_load_dword v29, s[36:39], s53 offen offset:2048 lds
MAA 148,68,124
TR 102,25,64640
s_add_u32 s53, s53, 128
MAA 148,48,120
MAA 152,52,120
MAA 152,72,124
s_waitcnt lgkmcnt(8)
s_barrier
MAA 60,80,0
TR 104,25,49696
s_add_u32 m0, s56, 111232
MAA 60,84,20
buffer_load_dwordx4 v18, s[20:23], s54 offen lds
MAA 64,84,24
TR 106,25,50208
s_waitcnt vmcnt(14)
v_add_f32 v164, v164, v188
MAA 64,80,4
TR 108,25,62112
v_add_f32 v165, v165, v189
MAA 68,80,8
buffer_load_dwordx4 v19, s[20:23], s54 offen offset:1024 lds
MAA 68,84,28
TR 110,25,62624
v_add_f32 v166, v166, v190
MAA 72,84,32
TR 112,25,50720
v_add_f32 v167, v167, v191
MAA 72,80,12
buffer_load_dwordx4 v20, s[20:23], s54 offen offset:2048 lds
s_waitcnt lgkmcnt(5)
MAA 244,80,16
TR 114,25,51232
s_add_u32 s54, s54, 196608
MAA 244,84,36
TR 116,25,63136
s_add_u32 m0, s59, 0
MAA 156,92,36
TR 118,25,63648
s_xor_b32 s58, s87, 1048576
MAA 156,88,16
buffer_load_dwordx4 v5, s[24:27], s58 offen lds
MAA 104,88,12
TR 120,25,51744
MAA 104,92,32
TR 122,25,52256
MAA 100,92,28
buffer_load_dwordx4 v6, s[24:27], s58 offen offset:1024 lds
MAA 100,88,8
TR 124,25,64160
s_add_u32 m0, s59, 8320
MAA 96,88,4
TR 126,25,64672
s_xor_b32 s58, s87, 1179648
MAA 96,92,24
buffer_load_dwordx4 v5, s[24:27], s58 offen lds
MAA 92,92,20
RD 40,23,18496
MAA 92,88,0
RD 44,23,20800
MAA 124,0,96
buffer_load_dwordx4 v6, s[24:27], s58 offen offset:1024 lds
MAA 124,20,100
RD 48,23,23104
MAA 128,24,100
RD 52,23,25408
MAA 128,4,96
RD 56,24,18496
MAA 132,8,96
MAA 132,28,100
MAA 136,32,100
MAA 136,12,96
s_waitcnt vmcnt(17) lgkmcnt(5)
s_barrier
MAA 76,104,0
RD 60,30,18496
s_add_u32 m0, s56, 123648
MAA 76,108,20
buffer_load_dwordx4 v18, s[20:23], s54 offen lds
MAA 80,108,24
RD 64,30,20800
s_waitcnt vmcnt(14)
v_add_f32 v164, v164, v192
MAA 80,104,4
RD 68,30,23104
v_add_f32 v165, v165, v193
MAA 84,104,8
RD 72,30,25408
v_add_f32 v166, v166, v194
MAA 84,108,28
RD 76,31,18496
v_add_f32 v167, v167, v195
MAA 88,108,32
ds_read_b64_tr_b16 a[80:81], v25
MAA 88,104,12
TR 82,25,512
MAA 160,112,16
TR 84,25,12416
MAA 160,116,36
buffer_load_dwordx4 v19, s[20:23], s54 offen offset:1024 lds
MAA 120,116,32
TR 86,25,12928
MAA 120,112,12
TR 88,25,1024
MAA 116,112,8
TR 90,25,1536
MAA 116,116,28
TR 92,25,13440
MAA 112,116,24
TR 94,25,13952
MAA 112,112,4
TR 96,25,2048
MAA 108,112,0
TR 98,25,2560
MAA 108,116,20
buffer_load_dwordx4 v20, s[20:23], s54 offen offset:2048 lds
MAA 140,20,124
TR 100,25,14464
s_add_u32 s54, s54, 196608
MAA 140,0,120
TR 102,25,14976
MAA 144,4,120
MAA 144,24,124
MAA 148,28,124
MAA 148,8,120
MAA 152,12,120
MAA 152,32,124
s_waitcnt lgkmcnt(8)
s_barrier
MAA 60,80,40
TR 104,25,32
s_add_u32 m0, s56, 136064
MAA 60,84,60
buffer_load_dwordx4 v18, s[20:23], s54 offen lds
MAA 64,84,64
TR 106,25,544
MAA 64,80,44
TR 108,25,12448
MAA 68,80,48
buffer_load_dwordx4 v19, s[20:23], s54 offen offset:1024 lds
MAA 68,84,68
TR 110,25,12960
MAA 72,84,72
TR 112,25,1056
MAA 72,80,52
buffer_load_dwordx4 v20, s[20:23], s54 offen offset:2048 lds
s_waitcnt lgkmcnt(5)
MAA 244,80,56
TR 114,25,1568
s_add_u32 s54, s54, 196608
MAA 244,84,76
TR 116,25,13472
s_add_u32 m0, s59, 16640
MAA 156,92,76
TR 118,25,13984
s_xor_b32 s58, s87, 1310720
MAA 156,88,56
buffer_load_dwordx4 v5, s[24:27], s58 offen lds
MAA 104,88,52
TR 120,25,2080
MAA 104,92,72
TR 122,25,2592
MAA 100,92,68
buffer_load_dwordx4 v6, s[24:27], s58 offen offset:1024 lds
MAA 100,88,48
TR 124,25,14496
s_add_u32 m0, s59, 24960
MAA 96,88,44
TR 126,25,15008
s_xor_b32 s58, s87, 1441792
MAA 96,92,64
buffer_load_dwordx4 v5, s[24:27], s58 offen lds
MAA 92,92,60
RD 0,23,36992
MAA 92,88,40
RD 4,23,39296
MAA 124,40,96
buffer_load_dwordx4 v6, s[24:27], s58 offen offset:1024 lds
MAA 124,60,100
RD 8,23,41600
MAA 128,64,100
RD 12,23,43904
MAA 128,44,96
RD 16,24,36992
MAA 132,48,96
v_permlane32_swap_b32 v164, v166
MAA 132,68,100
v_permlane32_swap_b32 v165, v167
MAA 136,72,100
v_add_f32 v164, v164, v166
v_add_f32 v165, v165, v167
MAA 136,52,96
v_mul_f32 v164, 0xba800000, v164
v_mul_f32 v165, 0x3a800000, v165
v_fma_f32 v165, -v164, v164, v165
v_max_f32 v165, 0, v165
v_add_f32 v165, 0x3727c5ac, v165
v_rsq_f32 v166, v165
s_nop 0
v_mov_b32 v165, v166
v_mul_f32 v166, 0x3e8293ee, v166
s_waitcnt vmcnt(14) lgkmcnt(5)
s_barrier
MAA 76,104,40
ds_write_b128 v7, v[164:167]
s_add_u32 m0, s59, 74880
MAA 76,108,60
ds_write_b32 v17, v164
s_xor_b32 s58, s87, 131072
MAA 80,108,64
ds_write_b32 v17, v165 offset:1024
MAA 80,104,44
buffer_load_dwordx4 v5, s[24:27], s58 offen lds
MAA 84,104,48
RD 20,30,36992
MAA 84,108,68
RD 24,30,39296
MAA 88,108,72
RD 28,30,41600
MAA 88,104,52
RD 32,30,43904
MAA 160,112,56
RD 36,31,36992
MAA 160,116,76
buffer_load_dwordx4 v6, s[24:27], s58 offen offset:1024 lds
MAA 120,116,72
TR 80,25,24832
s_add_u32 m0, s59, 83200
MAA 120,112,52
TR 82,25,25344
s_xor_b32 s58, s87, 262144
MAA 116,112,48
TR 84,25,37248
MAA 116,116,68
TR 86,25,37760
MAA 112,116,64
TR 88,25,25856
MAA 112,112,44
buffer_load_dwordx4 v5, s[24:27], s58 offen lds
MAA 108,112,40
TR 90,25,26368
MAA 108,116,60
TR 92,25,38272
MAA 140,60,124
TR 94,25,38784
MAA 140,40,120
TR 96,25,26880
MAA 144,44,120
TR 98,25,27392
MAA 144,64,124
buffer_load_dwordx4 v6, s[24:27], s58 offen offset:1024 lds
MAA 148,68,124
TR 100,25,39296
MAA 148,48,120
TR 102,25,39808
MAA 152,52,120
MAA 152,72,124
s_waitcnt vmcnt(8) lgkmcnt(0)
s_barrier
MAA 156,88,16
TR 112,25,25888
s_add_u32 m0, s59, 33280
MAA 156,92,36
TR 114,25,26400
s_xor_b32 s58, s87, 1572864
MAA 104,92,32
buffer_load_dwordx4 v5, s[24:27], s58 offen lds
MAA 104,88,12
TR 116,25,38304
MAA 100,88,8
TR 118,25,38816
MAA 100,92,28
TR 120,25,26912
MAA 96,92,24
buffer_load_dwordx4 v6, s[24:27], s58 offen offset:1024 lds
MAA 96,88,4
TR 122,25,27424
s_add_u32 m0, s59, 41600
MAA 92,88,0
TR 124,25,39328
s_xor_b32 s58, s87, 1703936
MAA 92,92,20
TR 126,25,39840
MAA 136,32,100
buffer_load_dwordx4 v5, s[24:27], s58 offen lds
MAA 136,12,96
TR 104,25,24864
MAA 244,80,16
TR 106,25,25376
MAA 244,84,36
TR 108,25,37280
MAA 72,84,32
buffer_load_dwordx4 v6, s[24:27], s58 offen offset:1024 lds
MAA 72,80,12
TR 110,25,37792
MAA 68,80,8
RD 40,23,55488
MAA 68,84,28
RD 44,23,57792
MAA 64,84,24
RD 48,23,60096
MAA 64,80,4
RD 52,23,62400
MAA 60,80,0
RD 56,24,55488
MAA 60,84,20
RD 60,30,55488
s_waitcnt lgkmcnt(15)
MAA 160,112,16
RD 64,30,57792
s_waitcnt lgkmcnt(15)
MAA 160,116,36
s_waitcnt lgkmcnt(7)
s_barrier
RD 68,30,60096
MAA 120,116,32
RD 72,30,62400
s_add_u32 m0, s59, 91520
MAA 120,112,12
RD 76,31,55488
s_xor_b32 s58, s87, 393216
MAA 116,112,8
TR 144,25,50688
MAA 116,116,28
TR 146,25,51200
MAA 112,116,24
TR 148,25,63104
MAA 112,112,4
TR 150,25,63616
MAA 108,112,0
TR 152,25,50720
MAA 108,116,20
TR 154,25,51232
MAA 152,32,124
TR 156,25,63136
MAA 152,12,120
TR 158,25,63648
MAA 88,104,12
TR 160,25,51712
MAA 88,108,32
TR 162,25,52224
MAA 84,108,28
TR 164,25,64128
MAA 84,104,8
TR 166,25,64640
MAA 80,104,4
TR 168,25,51744
MAA 80,108,24
TR 170,25,52256
MAA 76,108,20
TR 172,25,64160
MAA 76,104,0
TR 174,25,64672
s_waitcnt lgkmcnt(14)
MAA 156,144,56
TR 128,25,49664
s_waitcnt lgkmcnt(13)
MAA 156,148,76
TR 130,25,50176
MAA 104,148,72
TR 132,25,62080
MAA 104,144,52
TR 134,25,62592
MAA 100,144,48
TR 136,25,49696
MAA 100,148,68
TR 138,25,50208
MAA 96,148,64
TR 140,25,62112
MAA 96,144,44
TR 142,25,62624
MAA 92,144,40
ds_read_b128 v[232:235], v10 offset:768
MAA 92,148,60
ds_read_b128 v[236:239], v10 offset:2816
s_waitcnt lgkmcnt(15)
MAA 160,156,76
ds_read_b128 v[228:231], v10 offset:512
MAA 160,152,56
ds_read_b128 v[224:227], v10 offset:256
MAA 120,152,52
ds_read_b128 v[220:223], v10
MAA 120,156,72
buffer_load_dwordx4 v5, s[24:27], s58 offen lds
MAA 116,156,68
MAA 116,152,48
MAA 112,152,44
MAA 112,156,64
buffer_load_dwordx4 v6, s[24:27], s58 offen offset:1024 lds
MAA 108,156,60
s_add_u32 m0, s59, 99840
s_xor_b32 s58, s87, 524288
MAA 108,152,40
MAA 136,52,160
s_waitcnt lgkmcnt(15)
MAA 136,72,164
buffer_load_dwordx4 v5, s[24:27], s58 offen lds
s_waitcnt lgkmcnt(13)
MAA 152,72,172
MAA 152,52,168
s_waitcnt lgkmcnt(11)
MAA 244,128,56
s_waitcnt lgkmcnt(9)
MAA 244,132,76
buffer_load_dwordx4 v6, s[24:27], s58 offen offset:1024 lds
MAA 72,132,72
s_add_u32 m0, s59, 108160
s_xor_b32 s58, s87, 655360
MAA 72,128,52
MAA 68,128,48
MAA 68,132,68
buffer_load_dwordx4 v5, s[24:27], s58 offen lds
buffer_load_dwordx4 v6, s[24:27], s58 offen offset:1024 lds
s_mov_b32 exec_lo, 0x10001
s_mov_b32 exec_hi, 0x10001
ds_write_b128 v13, v[244:247]
ds_write_b128 v13, v[156:159] offset:256
ds_write_b128 v13, v[160:163] offset:320
s_mov_b64 exec, -1
MAA 64,128,44
MAA 64,132,64
MAA 60,132,60
MAA 60,128,40
s_waitcnt lgkmcnt(10)
MAA 88,136,52
s_waitcnt lgkmcnt(8)
MAA 88,140,72
s_waitcnt lgkmcnt(0)
s_barrier
MAA 84,136,48
ds_read_b128 v[28:31], v13
MAA 84,140,68
ds_read_b128 v[32:35], v13 offset:64
MAA 80,140,64
ds_read_b128 v[36:39], v13 offset:256
MAA 80,136,44
ds_read_b128 v[40:43], v13 offset:320
MAA 76,136,40
ds_read_b32 v44, v12 offset:512
MAA 76,140,60
ds_read_b32 v45, v12 offset:576
ds_read_b128 v[240:243], v11 offset:192
ds_read_b128 v[244:247], v11 offset:1216
ds_read_b128 v[18:21], v11 offset:128
ds_read_b128 v[22:25], v11 offset:1152
s_waitcnt lgkmcnt(9)
v_pk_fma_f32 v[72:73], v[28:29], v[232:233], v[72:73] op_sel_hi:[1,0,1]
v_cvt_pk_bf16_f32 v176, v72, v73
v_pk_fma_f32 v[74:75], v[30:31], v[232:233], v[74:75] op_sel_hi:[1,0,1]
v_cvt_pk_bf16_f32 v177, v74, v75
s_waitcnt lgkmcnt(8)
v_pk_fma_f32 v[88:89], v[32:33], v[232:233], v[88:89] op_sel_hi:[1,0,1]
v_cvt_pk_bf16_f32 v178, v88, v89
v_pk_fma_f32 v[90:91], v[34:35], v[232:233], v[90:91] op_sel_hi:[1,0,1]
v_cvt_pk_bf16_f32 v179, v90, v91
s_waitcnt lgkmcnt(7)
v_pk_fma_f32 v[104:105], v[36:37], v[232:233], v[104:105] op_sel_hi:[1,0,1]
v_pk_mul_f32 v[104:105], v[104:105], v[232:233] op_sel:[0,1] op_sel_hi:[1,1]
v_cvt_pk_bf16_f32 v196, v104, v105
v_pk_fma_f32 v[106:107], v[38:39], v[232:233], v[106:107] op_sel_hi:[1,0,1]
v_pk_mul_f32 v[106:107], v[106:107], v[232:233] op_sel:[0,1] op_sel_hi:[1,1]
v_cvt_pk_bf16_f32 v197, v106, v107
s_waitcnt lgkmcnt(6)
v_pk_fma_f32 v[120:121], v[40:41], v[232:233], v[120:121] op_sel_hi:[1,0,1]
v_pk_mul_f32 v[120:121], v[120:121], v[232:233] op_sel:[0,1] op_sel_hi:[1,1]
v_cvt_pk_bf16_f32 v198, v120, v121
v_pk_fma_f32 v[122:123], v[42:43], v[232:233], v[122:123] op_sel_hi:[1,0,1]
v_pk_mul_f32 v[122:123], v[122:123], v[232:233] op_sel:[0,1] op_sel_hi:[1,1]
v_cvt_pk_bf16_f32 v199, v122, v123
ds_write_b128 v8, v[196:199]
s_waitcnt lgkmcnt(4)
v_pk_fma_f32 v[136:137], v[240:241], v[44:45], v[136:137] op_sel_hi:[1,0,1]
v_pk_fma_f32 v[138:139], v[242:243], v[44:45], v[138:139] op_sel_hi:[1,0,1]
s_waitcnt lgkmcnt(3)
v_pk_mul_f32 v[136:137], v[136:137], v[244:245]
v_cvt_pk_bf16_f32 v208, v136, v137
v_pk_mul_f32 v[138:139], v[138:139], v[246:247]
v_cvt_pk_bf16_f32 v209, v138, v139
v_pk_fma_f32 v[152:153], v[240:241], v[44:45], v[152:153] op_sel:[0,1,0] op_sel_hi:[1,1,1]
v_pk_mul_f32 v[152:153], v[152:153], v[244:245]
v_cvt_pk_bf16_f32 v218, v152, v153
v_pk_fma_f32 v[154:155], v[242:243], v[44:45], v[154:155] op_sel:[0,1,0] op_sel_hi:[1,1,1]
v_pk_mul_f32 v[154:155], v[154:155], v[246:247]
v_cvt_pk_bf16_f32 v219, v154, v155
ds_write_b64 v8, v[208:209] offset:1024
ds_write_b64 v8, v[218:219] offset:1032
v_pk_fma_f32 v[156:157], v[36:37], v[236:237], v[156:157] op_sel_hi:[1,0,1]
v_pk_mul_f32 v[156:157], v[156:157], v[236:237] op_sel:[0,1] op_sel_hi:[1,1]
v_cvt_pk_bf16_f32 v180, v156, v157
v_pk_fma_f32 v[158:159], v[38:39], v[236:237], v[158:159] op_sel_hi:[1,0,1]
v_pk_mul_f32 v[158:159], v[158:159], v[236:237] op_sel:[0,1] op_sel_hi:[1,1]
v_cvt_pk_bf16_f32 v181, v158, v159
v_pk_fma_f32 v[160:161], v[40:41], v[236:237], v[160:161] op_sel_hi:[1,0,1]
v_pk_mul_f32 v[160:161], v[160:161], v[236:237] op_sel:[0,1] op_sel_hi:[1,1]
v_cvt_pk_bf16_f32 v182, v160, v161
v_pk_fma_f32 v[162:163], v[42:43], v[236:237], v[162:163] op_sel_hi:[1,0,1]
v_pk_mul_f32 v[162:163], v[162:163], v[236:237] op_sel:[0,1] op_sel_hi:[1,1]
v_cvt_pk_bf16_f32 v183, v162, v163
v_pk_fma_f32 v[100:101], v[36:37], v[228:229], v[100:101] op_sel_hi:[1,0,1]
v_pk_mul_f32 v[100:101], v[100:101], v[228:229] op_sel:[0,1] op_sel_hi:[1,1]
v_cvt_pk_bf16_f32 v192, v100, v101
v_pk_fma_f32 v[102:103], v[38:39], v[228:229], v[102:103] op_sel_hi:[1,0,1]
v_pk_mul_f32 v[102:103], v[102:103], v[228:229] op_sel:[0,1] op_sel_hi:[1,1]
v_cvt_pk_bf16_f32 v193, v102, v103
v_pk_fma_f32 v[116:117], v[40:41], v[228:229], v[116:117] op_sel_hi:[1,0,1]
v_pk_mul_f32 v[116:117], v[116:117], v[228:229] op_sel:[0,1] op_sel_hi:[1,1]
v_cvt_pk_bf16_f32 v194, v116, v117
v_pk_fma_f32 v[118:119], v[42:43], v[228:229], v[118:119] op_sel_hi:[1,0,1]
v_pk_mul_f32 v[118:119], v[118:119], v[228:229] op_sel:[0,1] op_sel_hi:[1,1]
s_waitcnt lgkmcnt(0)
s_barrier
v_cvt_pk_bf16_f32 v195, v118, v119
v_pk_fma_f32 v[96:97], v[36:37], v[224:225], v[96:97] op_sel_hi:[1,0,1]
v_pk_mul_f32 v[96:97], v[96:97], v[224:225] op_sel:[0,1] op_sel_hi:[1,1]
v_cvt_pk_bf16_f32 v188, v96, v97
v_pk_fma_f32 v[98:99], v[38:39], v[224:225], v[98:99] op_sel_hi:[1,0,1]
v_pk_mul_f32 v[98:99], v[98:99], v[224:225] op_sel:[0,1] op_sel_hi:[1,1]
v_cvt_pk_bf16_f32 v189, v98, v99
v_pk_fma_f32 v[112:113], v[40:41], v[224:225], v[112:113] op_sel_hi:[1,0,1]
v_pk_mul_f32 v[112:113], v[112:113], v[224:225] op_sel:[0,1] op_sel_hi:[1,1]
v_cvt_pk_bf16_f32 v190, v112, v113
v_pk_fma_f32 v[114:115], v[42:43], v[224:225], v[114:115] op_sel_hi:[1,0,1]
v_pk_mul_f32 v[114:115], v[114:115], v[224:225] op_sel:[0,1] op_sel_hi:[1,1]
v_cvt_pk_bf16_f32 v191, v114, v115
v_pk_fma_f32 v[92:93], v[36:37], v[220:221], v[92:93] op_sel_hi:[1,0,1]
v_pk_mul_f32 v[92:93], v[92:93], v[220:221] op_sel:[0,1] op_sel_hi:[1,1]
v_cvt_pk_bf16_f32 v184, v92, v93
v_pk_fma_f32 v[94:95], v[38:39], v[220:221], v[94:95] op_sel_hi:[1,0,1]
.Lpad4:
s_cbranch_execz .Lpad8
v_pk_mul_f32 v[94:95], v[94:95], v[220:221] op_sel:[0,1] op_sel_hi:[1,1]
v_cvt_pk_bf16_f32 v185, v94, v95
v_pk_fma_f32 v[108:109], v[40:41], v[220:221], v[108:109] op_sel_hi:[1,0,1]
v_pk_mul_f32 v[108:109], v[108:109], v[220:221] op_sel:[0,1] op_sel_hi:[1,1]
v_cvt_pk_bf16_f32 v186, v108, v109
v_pk_fma_f32 v[110:111], v[42:43], v[220:221], v[110:111] op_sel_hi:[1,0,1]
v_pk_mul_f32 v[110:111], v[110:111], v[220:221] op_sel:[0,1] op_sel_hi:[1,1]
v_cvt_pk_bf16_f32 v187, v110, v111
v_pk_fma_f32 v[68:69], v[28:29], v[228:229], v[68:69] op_sel_hi:[1,0,1]
v_cvt_pk_bf16_f32 v172, v68, v69
v_pk_fma_f32 v[70:71], v[30:31], v[228:229], v[70:71] op_sel_hi:[1,0,1]
v_cvt_pk_bf16_f32 v173, v70, v71
v_pk_fma_f32 v[84:85], v[32:33], v[228:229], v[84:85] op_sel_hi:[1,0,1]
v_cvt_pk_bf16_f32 v174, v84, v85
v_pk_fma_f32 v[86:87], v[34:35], v[228:229], v[86:87] op_sel_hi:[1,0,1]
v_cvt_pk_bf16_f32 v175, v86, v87
v_pk_fma_f32 v[64:65], v[28:29], v[224:225], v[64:65] op_sel_hi:[1,0,1]
v_cvt_pk_bf16_f32 v168, v64, v65
v_pk_fma_f32 v[66:67], v[30:31], v[224:225], v[66:67] op_sel_hi:[1,0,1]
v_cvt_pk_bf16_f32 v169, v66, v67
v_pk_fma_f32 v[80:81], v[32:33], v[224:225], v[80:81] op_sel_hi:[1,0,1]
v_cvt_pk_bf16_f32 v170, v80, v81
v_pk_fma_f32 v[82:83], v[34:35], v[224:225], v[82:83] op_sel_hi:[1,0,1]
v_cvt_pk_bf16_f32 v171, v82, v83
v_pk_fma_f32 v[60:61], v[28:29], v[220:221], v[60:61] op_sel_hi:[1,0,1]
v_cvt_pk_bf16_f32 v164, v60, v61
v_pk_fma_f32 v[62:63], v[30:31], v[220:221], v[62:63] op_sel_hi:[1,0,1]
v_cvt_pk_bf16_f32 v165, v62, v63
v_pk_fma_f32 v[76:77], v[32:33], v[220:221], v[76:77] op_sel_hi:[1,0,1]
v_cvt_pk_bf16_f32 v166, v76, v77
v_pk_fma_f32 v[78:79], v[34:35], v[220:221], v[78:79] op_sel_hi:[1,0,1]
v_cvt_pk_bf16_f32 v167, v78, v79
s_nop 0
v_mfma_f32_16x16x32_bf16 v[120:123], v[196:199], v[176:179], v[50:53]
ds_read_b64 v[200:201], v9 offset:1024
v_mfma_f32_16x16x32_bf16 v[104:107], v[192:195], v[176:179], v[46:49]
ds_read_b64 v[210:211], v9 offset:1032
v_mfma_f32_16x16x32_bf16 v[116:119], v[192:195], v[172:175], v[50:53]
ds_read_b128 v[240:243], v11 offset:64
v_mfma_f32_16x16x32_bf16 v[100:103], v[188:191], v[172:175], v[46:49]
ds_read_b128 v[244:247], v11 offset:1088
v_mfma_f32_16x16x32_bf16 v[112:115], v[188:191], v[168:171], v[50:53]
ds_read_b128 v[28:31], v11
v_mfma_f32_16x16x32_bf16 v[96:99], v[184:187], v[168:171], v[46:49]
ds_read_b128 v[32:35], v11 offset:1024
v_max3_f32 v88, v104, v105, v106
v_mfma_f32_16x16x32_bf16 v[108:111], v[184:187], v[164:167], v[50:53]
v_max3_f32 v89, v107, v120, v121
v_max3_f32 v88, v88, v122, v123
v_mfma_f32_16x16x32_bf16 v[92:95], v[180:183], v[164:167], v[54:57]
v_max_f32 v90, v88, v89
v_max_f32 v89, v88, v89
MAA 132,8,96
s_nop 0
v_permlane16_swap_b32 v90, v89
MAA 132,28,100
v_max_f32 v88, v90, v89
v_max_f32 v89, v90, v89
MAA 132,48,160
s_nop 0
v_permlane32_swap_b32 v88, v89
MAA 132,68,164
v_max_f32 v88, v88, v89
v_mul_f32 v88, v88, v234
MAA 148,68,172
v_max3_f32 v84, v100, v101, v102
v_max3_f32 v85, v103, v116, v117
MAA 148,48,168
v_max3_f32 v84, v84, v118, v119
v_max_f32 v86, v84, v85
MAA 148,28,124
v_max_f32 v85, v84, v85
v_max3_f32 v80, v96, v97, v98
MAA 148,8,120
v_permlane16_swap_b32 v86, v85
v_max3_f32 v81, v99, v112, v113
v_max_f32 v84, v86, v85
v_max_f32 v85, v86, v85
v_max3_f32 v80, v80, v114, v115
v_max_f32 v82, v80, v81
v_permlane32_swap_b32 v84, v85
v_max_f32 v81, v80, v81
v_max_f32 v84, v84, v85
v_mul_f32 v84, v84, v230
v_permlane16_swap_b32 v82, v81
v_max3_f32 v76, v92, v93, v94
v_max_f32 v80, v82, v81
v_max_f32 v81, v82, v81
v_max3_f32 v77, v95, v108, v109
v_max3_f32 v76, v76, v110, v111
v_permlane32_swap_b32 v80, v81
v_max_f32 v78, v76, v77
v_max_f32 v80, v80, v81
v_mul_f32 v80, v80, v226
v_max_f32 v77, v76, v77
v_pk_fma_f32 v[104:105], v[104:105], v[234:235], v[88:89] op_sel_hi:[1,0,0] neg_lo:[0,0,1] neg_hi:[0,0,1]
v_pk_fma_f32 v[106:107], v[106:107], v[234:235], v[88:89] op_sel_hi:[1,0,0] neg_lo:[0,0,1] neg_hi:[0,0,1]
v_permlane16_swap_b32 v78, v77
v_pk_fma_f32 v[120:121], v[120:121], v[234:235], v[88:89] op_sel_hi:[1,0,0] neg_lo:[0,0,1] neg_hi:[0,0,1]
v_max_f32 v76, v78, v77
v_max_f32 v77, v78, v77
v_pk_fma_f32 v[122:123], v[122:123], v[234:235], v[88:89] op_sel_hi:[1,0,0] neg_lo:[0,0,1] neg_hi:[0,0,1]
v_pk_fma_f32 v[100:101], v[100:101], v[230:231], v[84:85] op_sel_hi:[1,0,0] neg_lo:[0,0,1] neg_hi:[0,0,1]
v_permlane32_swap_b32 v76, v77
v_pk_fma_f32 v[102:103], v[102:103], v[230:231], v[84:85] op_sel_hi:[1,0,0] neg_lo:[0,0,1] neg_hi:[0,0,1]
v_max_f32 v76, v76, v77
v_mul_f32 v76, v76, v222
v_pk_fma_f32 v[116:117], v[116:117], v[230:231], v[84:85] op_sel_hi:[1,0,0] neg_lo:[0,0,1] neg_hi:[0,0,1]
v_pk_fma_f32 v[118:119], v[118:119], v[230:231], v[84:85] op_sel_hi:[1,0,0] neg_lo:[0,0,1] neg_hi:[0,0,1]
v_pk_fma_f32 v[96:97], v[96:97], v[226:227], v[80:81] op_sel_hi:[1,0,0] neg_lo:[0,0,1] neg_hi:[0,0,1]
v_pk_fma_f32 v[98:99], v[98:99], v[226:227], v[80:81] op_sel_hi:[1,0,0] neg_lo:[0,0,1] neg_hi:[0,0,1]
v_pk_fma_f32 v[112:113], v[112:113], v[226:227], v[80:81] op_sel_hi:[1,0,0] neg_lo:[0,0,1] neg_hi:[0,0,1]
v_pk_fma_f32 v[114:115], v[114:115], v[226:227], v[80:81] op_sel_hi:[1,0,0] neg_lo:[0,0,1] neg_hi:[0,0,1]
v_pk_fma_f32 v[92:93], v[92:93], v[222:223], v[76:77] op_sel_hi:[1,0,0] neg_lo:[0,0,1] neg_hi:[0,0,1]
v_pk_fma_f32 v[94:95], v[94:95], v[222:223], v[76:77] op_sel_hi:[1,0,0] neg_lo:[0,0,1] neg_hi:[0,0,1]
v_pk_fma_f32 v[108:109], v[108:109], v[222:223], v[76:77] op_sel_hi:[1,0,0] neg_lo:[0,0,1] neg_hi:[0,0,1]
v_pk_fma_f32 v[110:111], v[110:111], v[222:223], v[76:77] op_sel_hi:[1,0,0] neg_lo:[0,0,1] neg_hi:[0,0,1]
v_pk_fma_f32 v[132:133], v[18:19], v[44:45], v[132:133] op_sel_hi:[1,0,1]
v_pk_mul_f32 v[132:133], v[132:133], v[22:23]
v_pk_fma_f32 v[134:135], v[20:21], v[44:45], v[134:135] op_sel_hi:[1,0,1]
v_pk_mul_f32 v[134:135], v[134:135], v[24:25]
v_pk_fma_f32 v[148:149], v[18:19], v[44:45], v[148:149] op_sel:[0,1,0] op_sel_hi:[1,1,1]
v_pk_mul_f32 v[148:149], v[148:149], v[22:23]
v_pk_fma_f32 v[150:151], v[20:21], v[44:45], v[150:151] op_sel:[0,1,0] op_sel_hi:[1,1,1]
v_pk_mul_f32 v[150:151], v[150:151], v[24:25]
v_exp_f32 v104, v104
s_nop 0
MAA 128,4,96
v_exp_f32 v105, v105
MAA 128,24,100
v_exp_f32 v106, v106
MAA 128,44,160
v_exp_f32 v107, v107
MAA 128,64,164
v_exp_f32 v120, v120
MAA 144,64,172
v_exp_f32 v121, v121
MAA 144,44,168
v_exp_f32 v122, v122
MAA 144,24,124
v_exp_f32 v123, v123
MAA 144,4,120
v_exp_f32 v100, v100
MAA 124,0,96
v_exp_f32 v101, v101
MAA 124,20,100
v_exp_f32 v102, v102
MAA 124,40,160
v_exp_f32 v103, v103
MAA 124,60,164
v_exp_f32 v116, v116
MAA 140,60,172
v_exp_f32 v117, v117
MAA 140,40,168
v_exp_f32 v118, v118
MAA 140,20,124
v_exp_f32 v119, v119
MAA 140,0,120
v_cvt_pk_bf16_f32 v72, v104, v105
v_cvt_pk_bf16_f32 v73, v106, v107
v_cvt_pk_bf16_f32 v74, v120, v121
v_cvt_pk_bf16_f32 v75, v122, v123
v_cvt_pk_bf16_f32 v68, v100, v101
v_cvt_pk_bf16_f32 v69, v102, v103
v_cvt_pk_bf16_f32 v70, v116, v117
v_cvt_pk_bf16_f32 v71, v118, v119
v_exp_f32 v96, v96
v_exp_f32 v97, v97
v_exp_f32 v98, v98
v_exp_f32 v99, v99
v_exp_f32 v112, v112
v_exp_f32 v113, v113
v_exp_f32 v114, v114
v_exp_f32 v115, v115
v_cvt_pk_bf16_f32 v64, v96, v97
v_cvt_pk_bf16_f32 v65, v98, v99
v_cvt_pk_bf16_f32 v66, v112, v113
v_cvt_pk_bf16_f32 v67, v114, v115
v_cvt_pk_bf16_f32 v206, v132, v133
v_cvt_pk_bf16_f32 v207, v134, v135
v_cvt_pk_bf16_f32 v216, v148, v149
v_cvt_pk_bf16_f32 v217, v150, v151
s_waitcnt lgkmcnt(3)
v_pk_fma_f32 v[128:129], v[240:241], v[44:45], v[128:129] op_sel_hi:[1,0,1]
s_waitcnt lgkmcnt(2)
v_pk_mul_f32 v[128:129], v[128:129], v[244:245]
v_cvt_pk_bf16_f32 v204, v128, v129
v_pk_fma_f32 v[130:131], v[242:243], v[44:45], v[130:131] op_sel_hi:[1,0,1]
v_pk_mul_f32 v[130:131], v[130:131], v[246:247]
v_cvt_pk_bf16_f32 v205, v130, v131
v_pk_fma_f32 v[144:145], v[240:241], v[44:45], v[144:145] op_sel:[0,1,0] op_sel_hi:[1,1,1]
v_pk_mul_f32 v[144:145], v[144:145], v[244:245]
v_cvt_pk_bf16_f32 v214, v144, v145
v_pk_fma_f32 v[146:147], v[242:243], v[44:45], v[146:147] op_sel:[0,1,0] op_sel_hi:[1,1,1]
v_pk_mul_f32 v[146:147], v[146:147], v[246:247]
v_cvt_pk_bf16_f32 v215, v146, v147
s_waitcnt lgkmcnt(1)
v_pk_fma_f32 v[124:125], v[28:29], v[44:45], v[124:125] op_sel_hi:[1,0,1]
s_waitcnt lgkmcnt(0)
v_pk_mul_f32 v[124:125], v[124:125], v[32:33]
v_cvt_pk_bf16_f32 v202, v124, v125
v_pk_fma_f32 v[126:127], v[30:31], v[44:45], v[126:127] op_sel_hi:[1,0,1]
v_pk_mul_f32 v[126:127], v[126:127], v[34:35]
v_cvt_pk_bf16_f32 v203, v126, v127
v_pk_fma_f32 v[140:141], v[28:29], v[44:45], v[140:141] op_sel:[0,1,0] op_sel_hi:[1,1,1]
v_pk_mul_f32 v[140:141], v[140:141], v[32:33]
v_cvt_pk_bf16_f32 v212, v140, v141
v_pk_fma_f32 v[142:143], v[30:31], v[44:45], v[142:143] op_sel:[0,1,0] op_sel_hi:[1,1,1]
v_pk_mul_f32 v[142:143], v[142:143], v[34:35]
v_cvt_pk_bf16_f32 v213, v142, v143
s_nop 0
v_mfma_f32_16x16x32_bf16 v[88:91], v[248:251], v[72:75], 0
v_exp_f32 v92, v92
v_mfma_f32_16x16x32_bf16 v[104:107], v[206:209], v[72:75], 0
v_exp_f32 v93, v93
v_mfma_f32_16x16x32_bf16 v[120:123], v[216:219], v[72:75], 0
v_exp_f32 v94, v94
v_mfma_f32_16x16x32_bf16 v[84:87], v[248:251], v[68:71], 0
v_exp_f32 v95, v95
v_mfma_f32_16x16x32_bf16 v[100:103], v[204:207], v[68:71], 0
v_exp_f32 v108, v108
v_mfma_f32_16x16x32_bf16 v[116:119], v[214:217], v[68:71], 0
v_exp_f32 v109, v109
v_mfma_f32_16x16x32_bf16 v[80:83], v[248:251], v[64:67], 0
v_exp_f32 v110, v110
v_mfma_f32_16x16x32_bf16 v[96:99], v[202:205], v[64:67], 0
v_exp_f32 v111, v111
v_mfma_f32_16x16x32_bf16 v[112:115], v[212:215], v[64:67], 0
v_cvt_pk_bf16_f32 v60, v92, v93
v_cvt_pk_bf16_f32 v61, v94, v95
v_cvt_pk_bf16_f32 v62, v108, v109
v_cvt_pk_bf16_f32 v63, v110, v111
v_rcp_f32 v88, v88
v_rcp_f32 v84, v84
v_mfma_f32_16x16x32_bf16 v[76:79], v[248:251], v[60:63], 0
v_rcp_f32 v80, v80
v_mfma_f32_16x16x32_bf16 v[92:95], v[200:203], v[60:63], 0
v_mfma_f32_16x16x32_bf16 v[108:111], v[210:213], v[60:63], 0
s_nop 4
v_rcp_f32 v76, v76
v_pk_mul_f32 v[104:105], v[104:105], v[88:89] op_sel_hi:[1,0]
v_pk_mul_f32 v[106:107], v[106:107], v[88:89] op_sel_hi:[1,0]
v_pk_mul_f32 v[120:121], v[120:121], v[88:89] op_sel_hi:[1,0]
v_pk_mul_f32 v[122:123], v[122:123], v[88:89] op_sel_hi:[1,0]
v_cvt_pk_bf16_f32 v176, v104, v105
v_cvt_pk_bf16_f32 v177, v106, v107
v_cvt_pk_bf16_f32 v178, v120, v121
v_cvt_pk_bf16_f32 v179, v122, v123
buffer_store_dwordx4 v[176:179], v4, s[16:19], s74 offen offset:3072 sc1
v_pk_mul_f32 v[100:101], v[100:101], v[84:85] op_sel_hi:[1,0]
v_pk_mul_f32 v[102:103], v[102:103], v[84:85] op_sel_hi:[1,0]
v_pk_mul_f32 v[116:117], v[116:117], v[84:85] op_sel_hi:[1,0]
v_pk_mul_f32 v[118:119], v[118:119], v[84:85] op_sel_hi:[1,0]
v_cvt_pk_bf16_f32 v172, v100, v101
v_cvt_pk_bf16_f32 v173, v102, v103
v_cvt_pk_bf16_f32 v174, v116, v117
v_cvt_pk_bf16_f32 v175, v118, v119
buffer_store_dwordx4 v[172:175], v4, s[16:19], s74 offen offset:2048 sc1
v_pk_mul_f32 v[96:97], v[96:97], v[80:81] op_sel_hi:[1,0]
v_pk_mul_f32 v[98:99], v[98:99], v[80:81] op_sel_hi:[1,0]
v_pk_mul_f32 v[112:113], v[112:113], v[80:81] op_sel_hi:[1,0]
v_pk_mul_f32 v[114:115], v[114:115], v[80:81] op_sel_hi:[1,0]
v_cvt_pk_bf16_f32 v168, v96, v97
v_cvt_pk_bf16_f32 v169, v98, v99
v_cvt_pk_bf16_f32 v170, v112, v113
v_cvt_pk_bf16_f32 v171, v114, v115
buffer_store_dwordx4 v[168:171], v4, s[16:19], s74 offen offset:1024 sc1
v_pk_mul_f32 v[92:93], v[92:93], v[76:77] op_sel_hi:[1,0]
v_pk_mul_f32 v[94:95], v[94:95], v[76:77] op_sel_hi:[1,0]
v_pk_mul_f32 v[108:109], v[108:109], v[76:77] op_sel_hi:[1,0]
v_pk_mul_f32 v[110:111], v[110:111], v[76:77] op_sel_hi:[1,0]
v_cvt_pk_bf16_f32 v164, v92, v93
v_cvt_pk_bf16_f32 v165, v94, v95
v_cvt_pk_bf16_f32 v166, v108, v109
v_cvt_pk_bf16_f32 v167, v110, v111
buffer_store_dwordx4 v[164:167], v4, s[16:19], s74 offen sc1
s_nop 1
s_branch .Lqkve2
.Lx4:
buffer_load_dword v27, v14, s[76:79], 0 offen
s_mov_b32 s76, s98
s_mov_b32 s77, s99
s_mov_b32 s78, s100
v_mov_b32 v14, v15
s_mov_b32 s47, 5
s_branch .Lx4b
.Lx5:
buffer_load_dword v27, v14, s[76:79], 0 offen
s_mov_b32 s76, s98
s_mov_b32 s77, s99
s_mov_b32 s78, s100
v_mov_b32 v14, v15
s_mov_b32 s47, 5
s_branch .Lx5b
.Lx6:
buffer_load_dword v27, v14, s[76:79], 0 offen
s_mov_b32 s76, s98
s_mov_b32 s77, s99
s_mov_b32 s78, s100
v_mov_b32 v14, v15
s_mov_b32 s47, 5
s_branch .Lx6b
.Lx7:
buffer_load_dword v27, v14, s[76:79], 0 offen
s_mov_b32 s76, s98
s_mov_b32 s77, s99
s_mov_b32 s78, s100
v_mov_b32 v14, v15
s_mov_b32 s47, 5
s_branch .Lx7b
.Lsp8:
s_mov_b32 s15, 0
.Lsp8l:
v_mov_b32 v37, 0
buffer_atomic_add v37, v34, s[40:43], 0 offen sc0
s_add_u32 s15, s15, 1
s_cmp_gt_u32 s15, 100000
s_waitcnt vmcnt(0)
s_cbranch_scc1 .Lsp8b
v_cmp_gt_u32 vcc, v35, v37
s_nop 0
s_cbranch_vccnz .Lsp8l
s_branch .Lsp8b
.Lx9:
buffer_load_dword v27, v14, s[76:79], 0 offen
s_mov_b32 s76, s98
s_mov_b32 s77, s99
s_mov_b32 s78, s100
v_mov_b32 v14, v15
s_mov_b32 s47, 5
s_branch .Lx9b
.Lx10:
buffer_load_dword v27, v14, s[76:79], 0 offen
s_mov_b32 s76, s98
s_mov_b32 s77, s99
s_mov_b32 s78, s100
v_mov_b32 v14, v15
s_mov_b32 s47, 5
s_branch .Lx10b
.Lx11:
buffer_load_dword v27, v14, s[76:79], 0 offen
s_mov_b32 s76, s98
s_mov_b32 s77, s99
s_mov_b32 s78, s100
v_mov_b32 v14, v15
s_mov_b32 s47, 5
s_branch .Lx11b
.Lx12:
buffer_load_dword v27, v14, s[76:79], 0 offen
s_mov_b32 s76, s98
s_mov_b32 s77, s99
s_mov_b32 s78, s100
v_mov_b32 v14, v15
s_mov_b32 s47, 5
s_branch .Lx12b
.Lsp13:
s_mov_b32 s15, 0
.Lsp13l:
v_mov_b32 v37, 0
buffer_atomic_add v37, v33, s[16:19], 0 offen sc0
s_add_u32 s15, s15, 1
s_cmp_gt_u32 s15, 100000
s_waitcnt vmcnt(0)
s_cbranch_scc1 .Lsp13b
v_cmp_gt_u32 vcc, v36, v37
s_nop 0
s_cbranch_vccnz .Lsp13l
s_branch .Lsp13b
.Lx14:
buffer_load_dword v27, v14, s[76:79], 0 offen
s_mov_b32 s76, s98
s_mov_b32 s77, s99
s_mov_b32 s78, s100
v_mov_b32 v14, v15
s_mov_b32 s47, 5
s_branch .Lx14b
.Lx15:
buffer_load_dword v27, v14, s[76:79], 0 offen
s_mov_b32 s76, s98
s_mov_b32 s77, s99
s_mov_b32 s78, s100
v_mov_b32 v14, v15
s_mov_b32 s47, 5
s_branch .Lx15b
.Lx16:
buffer_load_dword v27, v14, s[76:79], 0 offen
s_mov_b32 s76, s98
s_mov_b32 s77, s99
s_mov_b32 s78, s100
v_mov_b32 v14, v15
s_mov_b32 s47, 5
s_branch .Lx16b
.Lx17:
buffer_load_dword v27, v14, s[76:79], 0 offen
s_mov_b32 s76, s98
s_mov_b32 s77, s99
s_mov_b32 s78, s100
v_mov_b32 v14, v15
s_mov_b32 s47, 5
s_branch .Lx17b
.Lx19:
buffer_load_dword v27, v14, s[76:79], 0 offen
s_mov_b32 s76, s98
s_mov_b32 s77, s99
s_mov_b32 s78, s100
v_mov_b32 v14, v15
s_mov_b32 s47, 5
s_branch .Lx19b
.Lx20:
buffer_load_dword v27, v14, s[76:79], 0 offen
s_mov_b32 s76, s98
s_mov_b32 s77, s99
s_mov_b32 s78, s100
v_mov_b32 v14, v15
s_mov_b32 s47, 5
s_branch .Lx20b
.Lx21:
buffer_load_dword v27, v14, s[76:79], 0 offen
s_mov_b32 s76, s98
s_mov_b32 s77, s99
s_mov_b32 s78, s100
v_mov_b32 v14, v15
s_mov_b32 s47, 5
s_branch .Lx21b
.Lx22:
buffer_load_dword v27, v14, s[76:79], 0 offen
s_mov_b32 s76, s98
s_mov_b32 s77, s99
s_mov_b32 s78, s100
v_mov_b32 v14, v15
s_mov_b32 s47, 5
s_branch .Lx22b
.Lsp23:
s_mov_b32 s15, 0
.Lsp23l:
v_mov_b32 v37, 0
buffer_atomic_add v37, v34, s[40:43], 0 offen sc0
s_add_u32 s15, s15, 1
s_cmp_gt_u32 s15, 100000
s_waitcnt vmcnt(0)
s_cbranch_scc1 .Lsp23b
v_cmp_gt_u32 vcc, v35, v37
s_nop 0
s_cbranch_vccnz .Lsp23l
s_branch .Lsp23b
.Lx24:
buffer_load_dword v27, v14, s[76:79], 0 offen
s_mov_b32 s76, s98
s_mov_b32 s77, s99
s_mov_b32 s78, s100
v_mov_b32 v14, v15
s_mov_b32 s47, 5
s_branch .Lx24b
.Lx25:
buffer_load_dword v27, v14, s[76:79], 0 offen
s_mov_b32 s76, s98
s_mov_b32 s77, s99
s_mov_b32 s78, s100
v_mov_b32 v14, v15
s_mov_b32 s47, 5
s_branch .Lx25b
.Lx26:
buffer_load_dword v27, v14, s[76:79], 0 offen
s_mov_b32 s76, s98
s_mov_b32 s77, s99
s_mov_b32 s78, s100
v_mov_b32 v14, v15
s_mov_b32 s47, 5
s_branch .Lx26b
.Lx27:
buffer_load_dword v27, v14, s[76:79], 0 offen
s_mov_b32 s76, s98
s_mov_b32 s77, s99
s_mov_b32 s78, s100
v_mov_b32 v14, v15
s_mov_b32 s47, 5
s_branch .Lx27b
.Lsp28:
s_mov_b32 s15, 0
.Lsp28l:
v_mov_b32 v37, 0
buffer_atomic_add v37, v33, s[16:19], 0 offen sc0
s_add_u32 s15, s15, 1
s_cmp_gt_u32 s15, 100000
s_waitcnt vmcnt(0)
s_cbranch_scc1 .Lsp28b
v_cmp_gt_u32 vcc, v36, v37
s_nop 0
s_cbranch_vccnz .Lsp28l
s_branch .Lsp28b
.Lx29:
buffer_load_dword v27, v14, s[76:79], 0 offen
s_mov_b32 s76, s98
s_mov_b32 s77, s99
s_mov_b32 s78, s100
v_mov_b32 v14, v15
s_mov_b32 s47, 5
s_branch .Lx29b
.Lx30:
buffer_load_dword v27, v14, s[76:79], 0 offen
s_mov_b32 s76, s98
s_mov_b32 s77, s99
s_mov_b32 s78, s100
v_mov_b32 v14, v15
s_mov_b32 s47, 5
s_branch .Lx30b
.Lx31:
buffer_load_dword v27, v14, s[76:79], 0 offen
s_mov_b32 s76, s98
s_mov_b32 s77, s99
s_mov_b32 s78, s100
v_mov_b32 v14, v15
s_mov_b32 s47, 5
s_branch .Lx31b
.Lx32:
buffer_load_dword v27, v14, s[76:79], 0 offen
s_mov_b32 s76, s98
s_mov_b32 s77, s99
s_mov_b32 s78, s100
v_mov_b32 v14, v15
s_mov_b32 s47, 5
s_branch .Lx32b
.p2align 12
.Lqkv1:
.Lpad5:
s_cbranch_execz .Lpad9
s_cmp_lt_u32 s14, 16
s_cselect_b32 s62, 0, 4096
v_mov_b32 v231, 1
v_lshlrev_b32 v232, 8, v1
s_waitcnt vmcnt(16)
v_permlane16_swap_b32 v164, v166
v_permlane16_swap_b32 v165, v167
s_waitcnt vmcnt(15)
v_permlane16_swap_b32 v168, v170
v_permlane16_swap_b32 v169, v171
s_waitcnt vmcnt(14)
v_permlane16_swap_b32 v172, v174
v_permlane16_swap_b32 v173, v175
s_waitcnt vmcnt(13)
v_permlane16_swap_b32 v176, v178
v_permlane16_swap_b32 v177, v179
buffer_atomic_add v231, v232, s[40:43], s62 offen
s_add_u32 m0, s55, 18496
s_nop 0
buffer_load_dwordx4 v21, s[36:39], s52 offen lds
v_lshlrev_b32 v192, 16, v164
v_and_b32 v193, 0xffff0000, v164
v_lshlrev_b32 v194, 16, v165
v_and_b32 v195, 0xffff0000, v165
v_lshlrev_b32 v196, 16, v166
v_and_b32 v197, 0xffff0000, v166
v_lshlrev_b32 v198, 16, v167
buffer_load_dwordx4 v28, s[36:39], s52 offen offset:1024 lds
v_and_b32 v199, 0xffff0000, v167
v_lshlrev_b32 v200, 16, v168
v_and_b32 v201, 0xffff0000, v168
v_lshlrev_b32 v202, 16, v169
v_and_b32 v203, 0xffff0000, v169
v_lshlrev_b32 v204, 16, v170
v_and_b32 v205, 0xffff0000, v170
buffer_load_dword v22, s[36:39], s52 offen offset:2048 lds
s_add_u32 s52, s52, 128
v_lshlrev_b32 v206, 16, v171
v_and_b32 v207, 0xffff0000, v171
v_lshlrev_b32 v208, 16, v172
v_and_b32 v209, 0xffff0000, v172
v_lshlrev_b32 v210, 16, v173
v_and_b32 v211, 0xffff0000, v173
v_lshlrev_b32 v212, 16, v174
s_add_u32 m0, s55, 20800
s_nop 0
buffer_load_dwordx4 v21, s[36:39], s53 offen lds
v_and_b32 v213, 0xffff0000, v174
v_lshlrev_b32 v214, 16, v175
v_and_b32 v215, 0xffff0000, v175
v_lshlrev_b32 v216, 16, v176
v_and_b32 v217, 0xffff0000, v176
v_lshlrev_b32 v218, 16, v177
v_and_b32 v219, 0xffff0000, v177
buffer_load_dwordx4 v28, s[36:39], s53 offen offset:1024 lds
v_lshlrev_b32 v220, 16, v178
v_and_b32 v221, 0xffff0000, v178
v_lshlrev_b32 v222, 16, v179
v_and_b32 v223, 0xffff0000, v179
s_lshl_b32 s64, s6, 14
s_lshl_b32 s65, s49, 13
s_add_u32 s64, s64, s65
buffer_load_dword v29, s[36:39], s53 offen offset:2048 lds
s_add_u32 s53, s53, 128
s_lshl_b32 s65, s7, 9
s_add_u32 s64, s64, s65
s_lshl_b32 s65, s48, 8
s_add_u32 s64, s64, s65
s_add_u32 s64, s64, 29360128
v_and_b32 v188, 31, v1
v_lshlrev_b32 v188, 3, v188
s_add_u32 m0, s56, 73984
s_nop 0
buffer_load_dwordx4 v18, s[20:23], s54 offen lds
v_lshrrev_b32 v189, 5, v1
v_lshl_add_u32 v188, v189, 28, v188
s_lshl_b32 s62, s7, 18
s_add_u32 s62, s62, 0
s_add_u32 s63, s62, 131072
v_pk_mul_f32 v[182:183], v[192:193], v[192:193]
v_pk_mul_f32 v[186:187], v[208:209], v[208:209]
buffer_load_dwordx4 v19, s[20:23], s54 offen offset:1024 lds
v_pk_fma_f32 v[182:183], v[194:195], v[194:195], v[182:183]
v_pk_add_f32 v[180:181], v[192:193], v[194:195]
v_pk_fma_f32 v[186:187], v[210:211], v[210:211], v[186:187]
v_pk_add_f32 v[184:185], v[208:209], v[210:211]
v_pk_fma_f32 v[182:183], v[196:197], v[196:197], v[182:183]
v_pk_add_f32 v[180:181], v[180:181], v[196:197]
v_pk_fma_f32 v[186:187], v[212:213], v[212:213], v[186:187]
buffer_load_dwordx4 v20, s[20:23], s54 offen offset:2048 lds
s_add_u32 s54, s54, 196608
v_pk_add_f32 v[184:185], v[184:185], v[212:213]
v_pk_fma_f32 v[182:183], v[198:199], v[198:199], v[182:183]
v_pk_add_f32 v[180:181], v[180:181], v[198:199]
v_pk_fma_f32 v[186:187], v[214:215], v[214:215], v[186:187]
v_pk_add_f32 v[184:185], v[184:185], v[214:215]
v_pk_fma_f32 v[182:183], v[200:201], v[200:201], v[182:183]
v_pk_add_f32 v[180:181], v[180:181], v[200:201]
s_add_u32 m0, s56, 86400
s_nop 0
buffer_load_dwordx4 v18, s[20:23], s54 offen lds
v_pk_fma_f32 v[186:187], v[216:217], v[216:217], v[186:187]
v_pk_add_f32 v[184:185], v[184:185], v[216:217]
v_pk_fma_f32 v[182:183], v[202:203], v[202:203], v[182:183]
v_pk_add_f32 v[180:181], v[180:181], v[202:203]
v_pk_fma_f32 v[186:187], v[218:219], v[218:219], v[186:187]
v_pk_add_f32 v[184:185], v[184:185], v[218:219]
v_pk_fma_f32 v[182:183], v[204:205], v[204:205], v[182:183]
buffer_load_dwordx4 v19, s[20:23], s54 offen offset:1024 lds
v_pk_add_f32 v[180:181], v[180:181], v[204:205]
v_pk_fma_f32 v[186:187], v[220:221], v[220:221], v[186:187]
v_pk_add_f32 v[184:185], v[184:185], v[220:221]
v_pk_fma_f32 v[182:183], v[206:207], v[206:207], v[182:183]
v_pk_add_f32 v[180:181], v[180:181], v[206:207]
v_pk_fma_f32 v[186:187], v[222:223], v[222:223], v[186:187]
v_pk_add_f32 v[184:185], v[184:185], v[222:223]
buffer_load_dwordx4 v20, s[20:23], s54 offen offset:2048 lds
s_add_u32 s54, s54, 196608
v_add_f32 v180, v180, v181
v_add_f32 v182, v182, v183
v_add_f32 v184, v184, v185
v_add_f32 v186, v186, v187
s_nop 0
v_permlane16_swap_b32 v180, v184
v_permlane16_swap_b32 v182, v186
v_add_f32 v180, v180, v184
v_add_f32 v182, v182, v186
s_nop 1
v_permlane32_swap_b32 v180, v182
v_add_f32 v180, v180, v182
s_nop 1
v_permlane32_swap_b32 v180, v181
buffer_store_dwordx2 v[180:181], v188, s[16:19], s64 offen sc1
s_lshl_b32 s62, s2, 10
s_add_u32 s62, s62, 31457280
s_cmp_eq_u32 s3, 0
s_cselect_b32 s62, s62, 268435456
buffer_store_dwordx4 v[224:227], v230, s[16:19], s62 offen sc1
s_waitcnt vmcnt(15) lgkmcnt(0)
s_barrier
ds_read_b128 a[0:3], v23
RD 4,23,2304
RD 8,23,4608
RD 12,23,6912
ds_read_b128 a[16:19], v24
ds_read_b128 a[20:23], v30
RD 24,30,2304
RD 28,30,4608
RD 32,30,6912
ds_read_b128 a[36:39], v31
TR 80,25,49664
TR 82,25,50176
TR 84,25,62080
TR 86,25,62592
TR 88,25,50688
TR 90,25,51200
TR 92,25,63104
TR 94,25,63616
TR 96,25,51712
TR 98,25,52224
TR 100,25,64128
TR 102,25,64640
s_waitcnt vmcnt(8) lgkmcnt(0)
s_barrier
v_mfma_f32_16x16x32_bf16 v[60:63], a[80:83], a[0:3], 0
TR 104,25,49696
s_add_u32 m0, s55, 36992
MAA 60,84,20
buffer_load_dwordx4 v21, s[36:39], s52 offen lds
v_mfma_f32_16x16x32_bf16 v[64:67], a[80:83], a[4:7], 0
s_sub_u32 s47, s47, 1
s_cbranch_scc1 .Lx19
.Lx19b:
MAA 64,84,24
buffer_load_dwordx4 v28, s[36:39], s52 offen offset:1024 lds
v_mfma_f32_16x16x32_bf16 v[68:71], a[80:83], a[8:11], 0
TR 106,25,50208
MAA 68,84,28
TR 108,25,62112
TR 110,25,62624
TR 112,25,50720
v_mfma_f32_16x16x32_bf16 v[72:75], a[80:83], a[12:15], 0
TR 114,25,51232
MAA 72,84,32
TR 116,25,63136
TR 118,25,63648
v_mfma_f32_16x16x32_bf16 v[104:107], a[88:91], a[12:15], 0
TR 120,25,51744
MAA 104,92,32
buffer_load_dword v22, s[36:39], s52 offen offset:2048 lds
v_mfma_f32_16x16x32_bf16 v[100:103], a[88:91], a[8:11], 0
s_add_u32 s52, s52, 128
s_add_u32 m0, s55, 39296
MAA 100,92,28
buffer_load_dwordx4 v21, s[36:39], s53 offen lds
v_mfma_f32_16x16x32_bf16 v[96:99], a[88:91], a[4:7], 0
TR 122,25,52256
MAA 96,92,24
buffer_load_dwordx4 v28, s[36:39], s53 offen offset:1024 lds
v_mfma_f32_16x16x32_bf16 v[92:95], a[88:91], a[0:3], 0
TR 124,25,64160
MAA 92,92,20
buffer_load_dword v29, s[36:39], s53 offen offset:2048 lds
v_mfma_f32_16x16x32_bf16 v[124:127], a[0:3], a[96:99], 0
s_add_u32 s53, s53, 128
s_add_u32 m0, s56, 98816
MAA 124,20,100
buffer_load_dwordx4 v18, s[20:23], s54 offen lds
v_mfma_f32_16x16x32_bf16 v[128:131], a[4:7], a[96:99], 0
TR 126,25,64672
MAA 128,24,100
buffer_load_dwordx4 v19, s[20:23], s54 offen offset:1024 lds
v_mfma_f32_16x16x32_bf16 v[132:135], a[8:11], a[96:99], 0
RD 40,23,18496
MAA 132,28,100
RD 44,23,20800
RD 48,23,23104
RD 52,23,25408
v_mfma_f32_16x16x32_bf16 v[136:139], a[12:15], a[96:99], 0
RD 56,24,18496
MAA 136,32,100
buffer_load_dwordx4 v20, s[20:23], s54 offen offset:2048 lds
v_mfma_f32_16x16x32_bf16 v[156:159], a[16:19], a[96:99], 0
s_add_u32 s54, s54, 196608
MAA 156,36,100
s_waitcnt vmcnt(11) lgkmcnt(5)
s_barrier
v_mfma_f32_16x16x32_bf16 v[76:79], a[104:107], a[0:3], 0
RD 60,30,18496
s_add_u32 m0, s56, 111232
MAA 76,108,20
buffer_load_dwordx4 v18, s[20:23], s54 offen lds
v_mfma_f32_16x16x32_bf16 v[80:83], a[104:107], a[4:7], 0
RD 64,30,20800
MAA 80,108,24
buffer_load_dwordx4 v19, s[20:23], s54 offen offset:1024 lds
v_mfma_f32_16x16x32_bf16 v[84:87], a[104:107], a[8:11], 0
RD 68,30,23104
MAA 84,108,28
RD 72,30,25408
v_mfma_f32_16x16x32_bf16 v[88:91], a[104:107], a[12:15], 0
RD 76,31,18496
MAA 88,108,32
buffer_load_dwordx4 v20, s[20:23], s54 offen offset:2048 lds
v_mfma_f32_16x16x32_bf16 v[244:247], a[104:107], a[16:19], 0
s_add_u32 s54, s54, 196608
s_add_u32 m0, s55, 55488
MAA 244,108,36
buffer_load_dwordx4 v21, s[36:39], s52 offen lds
v_mfma_f32_16x16x32_bf16 v[120:123], a[112:115], a[12:15], 0
ds_read_b64_tr_b16 a[80:81], v25
MAA 120,116,32
TR 82,25,512
v_mfma_f32_16x16x32_bf16 v[116:119], a[112:115], a[8:11], 0
TR 84,25,12416
MAA 116,116,28
buffer_load_dwordx4 v28, s[36:39], s52 offen offset:1024 lds
v_mfma_f32_16x16x32_bf16 v[112:115], a[112:115], a[4:7], 0
TR 86,25,12928
MAA 112,116,24
buffer_load_dword v22, s[36:39], s52 offen offset:2048 lds
v_mfma_f32_16x16x32_bf16 v[108:111], a[112:115], a[0:3], 0
TR 88,25,1024
s_add_u32 s52, s52, 128
MAA 108,116,20
TR 90,25,1536
v_mfma_f32_16x16x32_bf16 v[140:143], a[0:3], a[120:123], 0
TR 92,25,13440
s_add_u32 m0, s55, 57792
MAA 140,20,124
buffer_load_dwordx4 v21, s[36:39], s53 offen lds
v_mfma_f32_16x16x32_bf16 v[144:147], a[4:7], a[120:123], 0
TR 94,25,13952
MAA 144,24,124
buffer_load_dwordx4 v28, s[36:39], s53 offen offset:1024 lds
v_mfma_f32_16x16x32_bf16 v[148:151], a[8:11], a[120:123], 0
TR 96,25,2048
MAA 148,28,124
TR 98,25,2560
v_mfma_f32_16x16x32_bf16 v[152:155], a[12:15], a[120:123], 0
TR 100,25,14464
MAA 152,32,124
buffer_load_dword v29, s[36:39], s53 offen offset:2048 lds
v_mfma_f32_16x16x32_bf16 v[160:163], a[16:19], a[120:123], 0
TR 102,25,14976
s_add_u32 s53, s53, 128
MAA 160,36,124
s_waitcnt vmcnt(12) lgkmcnt(8)
s_barrier
MAA 60,80,40
TR 104,25,32
s_add_u32 m0, s56, 123648
MAA 60,84,60
buffer_load_dwordx4 v18, s[20:23], s54 offen lds
MAA 64,84,64
s_sub_u32 s47, s47, 1
s_cbranch_scc1 .Lx20
.Lx20b:
MAA 64,80,44
buffer_load_dwordx4 v19, s[20:23], s54 offen offset:1024 lds
MAA 68,80,48
TR 106,25,544
MAA 68,84,68
TR 108,25,12448
TR 110,25,12960
TR 112,25,1056
MAA 72,84,72
TR 114,25,1568
MAA 72,80,52
TR 116,25,13472
TR 118,25,13984
s_waitcnt lgkmcnt(8)
MAA 104,88,52
TR 120,25,2080
MAA 104,92,72
buffer_load_dwordx4 v20, s[20:23], s54 offen offset:2048 lds
MAA 100,92,68
s_add_u32 s54, s54, 196608
s_add_u32 m0, s56, 136064
MAA 100,88,48
buffer_load_dwordx4 v18, s[20:23], s54 offen lds
MAA 96,88,44
TR 122,25,2592
MAA 96,92,64
buffer_load_dwordx4 v19, s[20:23], s54 offen offset:1024 lds
MAA 92,92,60
TR 124,25,14496
MAA 92,88,40
buffer_load_dwordx4 v20, s[20:23], s54 offen offset:2048 lds
MAA 124,40,96
s_add_u32 s54, s54, 196608
s_add_u32 m0, s55, 0
MAA 124,60,100
buffer_load_dwordx4 v21, s[36:39], s52 offen lds
MAA 128,64,100
TR 126,25,15008
MAA 128,44,96
buffer_load_dwordx4 v28, s[36:39], s52 offen offset:1024 lds
MAA 132,48,96
RD 0,23,36992
MAA 132,68,100
RD 4,23,39296
RD 8,23,41600
RD 12,23,43904
MAA 136,72,100
RD 16,24,36992
MAA 136,52,96
buffer_load_dword v22, s[36:39], s52 offen offset:2048 lds
MAA 156,56,96
s_add_u32 s52, s52, 128
MAA 156,76,100
s_waitcnt vmcnt(15) lgkmcnt(5)
s_barrier
MAA 76,104,40
RD 20,30,36992
s_add_u32 m0, s55, 2304
MAA 76,108,60
buffer_load_dwordx4 v21, s[36:39], s53 offen lds
MAA 80,108,64
RD 24,30,39296
MAA 80,104,44
buffer_load_dwordx4 v28, s[36:39], s53 offen offset:1024 lds
MAA 84,104,48
RD 28,30,41600
MAA 84,108,68
RD 32,30,43904
RD 36,31,36992
MAA 88,108,72
TR 80,25,24832
MAA 88,104,52
buffer_load_dword v29, s[36:39], s53 offen offset:2048 lds
MAA 244,104,56
s_add_u32 s53, s53, 128
s_add_u32 m0, s56, 73984
MAA 244,108,76
buffer_load_dwordx4 v18, s[20:23], s54 offen lds
MAA 120,116,72
TR 82,25,25344
MAA 120,112,52
buffer_load_dwordx4 v19, s[20:23], s54 offen offset:1024 lds
MAA 116,112,48
TR 84,25,37248
MAA 116,116,68
TR 86,25,37760
TR 88,25,25856
MAA 112,116,64
TR 90,25,26368
MAA 112,112,44
buffer_load_dwordx4 v20, s[20:23], s54 offen offset:2048 lds
MAA 108,112,40
s_add_u32 s54, s54, 196608
s_add_u32 m0, s55, 18496
MAA 108,116,60
buffer_load_dwordx4 v21, s[36:39], s52 offen lds
MAA 140,60,124
TR 92,25,38272
MAA 140,40,120
buffer_load_dwordx4 v28, s[36:39], s52 offen offset:1024 lds
MAA 144,44,120
TR 94,25,38784
MAA 144,64,124
buffer_load_dword v22, s[36:39], s52 offen offset:2048 lds
MAA 148,68,124
TR 96,25,26880
s_add_u32 s52, s52, 128
MAA 148,48,120
TR 98,25,27392
TR 100,25,39296
MAA 152,52,120
TR 102,25,39808
MAA 152,72,124
buffer_load_dword v37, v34, s[40:43], 0 offen sc1
MAA 160,76,124
MAA 160,56,120
s_waitcnt vmcnt(19) lgkmcnt(8)
s_barrier
MAA 60,80,0
TR 104,25,24864
s_add_u32 m0, s56, 86400
MAA 60,84,20
buffer_load_dwordx4 v18, s[20:23], s54 offen lds
MAA 64,84,24
s_sub_u32 s47, s47, 1
s_cbranch_scc1 .Lx21
.Lx21b:
MAA 64,80,4
buffer_load_dwordx4 v19, s[20:23], s54 offen offset:1024 lds
MAA 68,80,8
TR 106,25,25376
MAA 68,84,28
TR 108,25,37280
TR 110,25,37792
TR 112,25,25888
MAA 72,84,32
TR 114,25,26400
MAA 72,80,12
TR 116,25,38304
TR 118,25,38816
s_waitcnt lgkmcnt(8)
MAA 104,88,12
TR 120,25,26912
MAA 104,92,32
buffer_load_dwordx4 v20, s[20:23], s54 offen offset:2048 lds
MAA 100,92,28
s_add_u32 s54, s54, 196608
s_add_u32 m0, s55, 20800
MAA 100,88,8
buffer_load_dwordx4 v21, s[36:39], s53 offen lds
MAA 96,88,4
TR 122,25,27424
MAA 96,92,24
buffer_load_dwordx4 v28, s[36:39], s53 offen offset:1024 lds
MAA 92,92,20
TR 124,25,39328
MAA 92,88,0
buffer_load_dword v29, s[36:39], s53 offen offset:2048 lds
MAA 124,0,96
s_add_u32 s53, s53, 128
s_add_u32 m0, s55, 36992
MAA 124,20,100
buffer_load_dwordx4 v21, s[36:39], s52 offen lds
MAA 128,24,100
TR 126,25,39840
MAA 128,4,96
buffer_load_dwordx4 v28, s[36:39], s52 offen offset:1024 lds
MAA 132,8,96
RD 40,23,55488
MAA 132,28,100
RD 44,23,57792
RD 48,23,60096
RD 52,23,62400
MAA 136,32,100
RD 56,24,55488
MAA 136,12,96
buffer_load_dword v22, s[36:39], s52 offen offset:2048 lds
MAA 156,16,96
s_add_u32 s52, s52, 128
MAA 156,36,100
s_waitcnt vmcnt(22) lgkmcnt(5)
s_barrier
MAA 76,104,0
RD 60,30,55488
MAA 76,108,20
RD 64,30,57792
MAA 80,108,24
RD 68,30,60096
s_add_u32 m0, s56, 98816
MAA 80,104,4
buffer_load_dwordx4 v18, s[20:23], s54 offen lds
MAA 84,104,8
RD 72,30,62400
MAA 84,108,28
RD 76,31,55488
MAA 88,108,32
MAA 88,104,12
buffer_load_dwordx4 v19, s[20:23], s54 offen offset:1024 lds
MAA 244,104,16
TR 80,25,49664
MAA 244,108,36
TR 82,25,50176
MAA 120,116,32
TR 84,25,62080
MAA 120,112,12
buffer_load_dwordx4 v20, s[20:23], s54 offen offset:2048 lds
MAA 116,112,8
TR 86,25,62592
s_add_u32 s54, s54, 196608
MAA 116,116,28
MAA 112,116,24
TR 88,25,50688
MAA 112,112,4
TR 90,25,51200
MAA 108,112,0
TR 92,25,63104
s_add_u32 m0, s55, 39296
MAA 108,116,20
buffer_load_dwordx4 v21, s[36:39], s53 offen lds
MAA 140,20,124
TR 94,25,63616
MAA 140,0,120
MAA 144,4,120
TR 96,25,51712
MAA 144,24,124
buffer_load_dwordx4 v28, s[36:39], s53 offen offset:1024 lds
MAA 148,28,124
TR 98,25,52224
MAA 148,8,120
TR 100,25,64128
MAA 152,12,120
TR 102,25,64640
MAA 152,32,124
buffer_load_dword v29, s[36:39], s53 offen offset:2048 lds
MAA 160,36,124
s_add_u32 s53, s53, 128
MAA 160,16,120
s_waitcnt vmcnt(22) lgkmcnt(8)
s_barrier
MAA 60,80,40
TR 104,25,49696
MAA 60,84,60
TR 106,25,50208
MAA 64,84,64
TR 108,25,62112
s_add_u32 m0, s56, 111232
MAA 64,80,44
buffer_load_dwordx4 v18, s[20:23], s54 offen lds
MAA 68,80,48
s_sub_u32 s47, s47, 1
s_cbranch_scc1 .Lx22
.Lx22b:
MAA 68,84,68
TR 110,25,62624
MAA 72,84,72
TR 112,25,50720
MAA 72,80,52
TR 114,25,51232
s_waitcnt lgkmcnt(6)
MAA 104,88,52
TR 116,25,63136
MAA 104,92,72
buffer_load_dwordx4 v19, s[20:23], s54 offen offset:1024 lds
.Lpad6:
s_cbranch_execz .Lt0r
MAA 100,92,68
TR 118,25,63648
MAA 100,88,48
buffer_load_dwordx4 v20, s[20:23], s54 offen offset:2048 lds
MAA 96,88,44
TR 120,25,51744
s_add_u32 s54, s54, 196608
MAA 96,92,64
TR 122,25,52256
MAA 92,92,60
TR 124,25,64160
s_add_u32 m0, s55, 55488
MAA 92,88,40
buffer_load_dwordx4 v21, s[36:39], s52 offen lds
MAA 124,40,96
TR 126,25,64672
MAA 124,60,100
ds_read_b128 a[0:3], v23
MAA 128,64,100
RD 4,23,2304
MAA 128,44,96
buffer_load_dwordx4 v28, s[36:39], s52 offen offset:1024 lds
MAA 132,48,96
RD 8,23,4608
MAA 132,68,100
RD 12,23,6912
MAA 136,72,100
ds_read_b128 a[16:19], v24
MAA 136,52,96
buffer_load_dword v22, s[36:39], s52 offen offset:2048 lds
MAA 156,56,96
s_add_u32 s52, s52, 128
MAA 156,76,100
s_waitcnt vmcnt(18) lgkmcnt(5)
s_barrier
v_cmp_gt_u32 vcc, v35, v37
s_nop 0
s_cbranch_vccnz .Lsp23
.Lsp23b:
v_mov_b32 v37, 0
MAA 76,104,40
ds_read_b128 a[20:23], v30
MAA 76,108,60
buffer_atomic_add v38, v32, s[16:19], 0 offen
MAA 80,108,64
RD 24,30,2304
MAA 80,104,44
RD 28,30,4608
MAA 84,104,48
RD 32,30,6912
s_add_u32 m0, s56, 123648
MAA 84,108,68
buffer_load_dwordx4 v18, s[20:23], s54 offen lds
MAA 88,108,72
ds_read_b128 a[36:39], v31
MAA 88,104,52
ds_read_b64_tr_b16 a[80:81], v25
MAA 244,104,56
TR 82,25,512
MAA 244,108,76
buffer_load_dwordx4 v19, s[20:23], s54 offen offset:1024 lds
MAA 120,116,72
TR 84,25,12416
MAA 120,112,52
TR 86,25,12928
MAA 116,112,48
MAA 116,116,68
buffer_load_dwordx4 v20, s[20:23], s54 offen offset:2048 lds
MAA 112,116,64
s_add_u32 s54, s54, 196608
s_add_u32 m0, s55, 57792
MAA 112,112,44
buffer_load_dwordx4 v21, s[36:39], s53 offen lds
MAA 108,112,40
TR 88,25,1024
MAA 108,116,60
TR 90,25,1536
MAA 140,60,124
TR 92,25,13440
MAA 140,40,120
buffer_load_dwordx4 v28, s[36:39], s53 offen offset:1024 lds
MAA 144,44,120
TR 94,25,13952
MAA 144,64,124
TR 96,25,2048
MAA 148,68,124
TR 98,25,2560
MAA 148,48,120
buffer_load_dword v29, s[36:39], s53 offen offset:2048 lds
MAA 152,52,120
TR 100,25,14464
s_add_u32 s53, s53, 128
MAA 152,72,124
TR 102,25,14976
MAA 160,76,124
MAA 160,56,120
s_waitcnt vmcnt(22) lgkmcnt(8)
s_barrier
MAA 60,80,0
TR 104,25,32
v_accvgpr_write_b32 a224, v192
MAA 60,84,20
TR 106,25,544
v_accvgpr_write_b32 a225, v193
MAA 64,84,24
TR 108,25,12448
s_add_u32 m0, s56, 136064
MAA 64,80,4
buffer_load_dwordx4 v18, s[20:23], s54 offen lds
MAA 68,80,8
s_sub_u32 s47, s47, 1
s_cbranch_scc1 .Lx24
.Lx24b:
MAA 68,84,28
TR 110,25,12960
MAA 72,84,32
TR 112,25,1056
v_accvgpr_write_b32 a226, v194
MAA 72,80,12
TR 114,25,1568
s_waitcnt lgkmcnt(6)
MAA 104,88,12
TR 116,25,13472
MAA 104,92,32
buffer_load_dwordx4 v19, s[20:23], s54 offen offset:1024 lds
MAA 100,92,28
TR 118,25,13984
v_accvgpr_write_b32 a227, v195
MAA 100,88,8
buffer_load_dwordx4 v20, s[20:23], s54 offen offset:2048 lds
MAA 96,88,4
TR 120,25,2080
s_add_u32 s54, s54, 196608
MAA 96,92,24
TR 122,25,2592
MAA 92,92,20
TR 124,25,14496
s_add_u32 m0, s55, 0
MAA 92,88,0
buffer_load_dwordx4 v21, s[36:39], s52 offen lds
MAA 124,0,96
TR 126,25,15008
v_accvgpr_write_b32 a228, v196
MAA 124,20,100
RD 40,23,18496
MAA 128,24,100
RD 44,23,20800
v_accvgpr_write_b32 a229, v197
MAA 128,4,96
buffer_load_dwordx4 v28, s[36:39], s52 offen offset:1024 lds
MAA 132,8,96
RD 48,23,23104
MAA 132,28,100
RD 52,23,25408
v_accvgpr_write_b32 a230, v198
MAA 136,32,100
RD 56,24,18496
MAA 136,12,96
buffer_load_dword v22, s[36:39], s52 offen offset:2048 lds
MAA 156,16,96
s_add_u32 s52, s52, 128
v_accvgpr_write_b32 a231, v199
MAA 156,36,100
s_waitcnt vmcnt(16) lgkmcnt(5)
s_barrier
MAA 76,104,0
RD 60,30,18496
v_accvgpr_write_b32 a232, v200
MAA 76,108,20
RD 64,30,20800
MAA 80,108,24
RD 68,30,23104
s_add_u32 m0, s56, 73984
MAA 80,104,4
buffer_load_dwordx4 v18, s[20:23], s54 offen lds
MAA 84,104,8
RD 72,30,25408
v_accvgpr_write_b32 a233, v201
MAA 84,108,28
RD 76,31,18496
MAA 88,108,32
v_accvgpr_write_b32 a234, v202
MAA 88,104,12
buffer_load_dwordx4 v19, s[20:23], s54 offen offset:1024 lds
MAA 244,104,16
TR 80,25,24832
MAA 244,108,36
TR 82,25,25344
MAA 120,116,32
TR 84,25,37248
v_accvgpr_write_b32 a235, v203
MAA 120,112,12
buffer_load_dwordx4 v20, s[20:23], s54 offen offset:2048 lds
MAA 116,112,8
TR 86,25,37760
s_add_u32 s54, s54, 196608
MAA 116,116,28
MAA 112,116,24
TR 88,25,25856
v_accvgpr_write_b32 a236, v204
MAA 112,112,4
TR 90,25,26368
MAA 108,112,0
TR 92,25,38272
s_add_u32 m0, s55, 2304
MAA 108,116,20
buffer_load_dwordx4 v21, s[36:39], s53 offen lds
MAA 140,20,124
TR 94,25,38784
v_accvgpr_write_b32 a237, v205
MAA 140,0,120
MAA 144,4,120
TR 96,25,26880
v_accvgpr_write_b32 a238, v206
MAA 144,24,124
buffer_load_dwordx4 v28, s[36:39], s53 offen offset:1024 lds
MAA 148,28,124
TR 98,25,27392
MAA 148,8,120
TR 100,25,39296
MAA 152,12,120
TR 102,25,39808
v_accvgpr_write_b32 a239, v207
MAA 152,32,124
buffer_load_dword v29, s[36:39], s53 offen offset:2048 lds
MAA 160,36,124
s_add_u32 s53, s53, 128
MAA 160,16,120
s_waitcnt lgkmcnt(8)
s_barrier
MAA 60,80,40
TR 104,25,24864
v_accvgpr_write_b32 a240, v208
MAA 60,84,60
TR 106,25,25376
v_accvgpr_write_b32 a241, v209
MAA 64,84,64
TR 108,25,37280
s_add_u32 m0, s56, 86400
MAA 64,80,44
buffer_load_dwordx4 v18, s[20:23], s54 offen lds
MAA 68,80,48
s_sub_u32 s47, s47, 1
s_cbranch_scc1 .Lx25
.Lx25b:
MAA 68,84,68
TR 110,25,37792
MAA 72,84,72
TR 112,25,25888
v_accvgpr_write_b32 a242, v210
MAA 72,80,52
TR 114,25,26400
s_waitcnt lgkmcnt(6)
MAA 104,88,52
TR 116,25,38304
MAA 104,92,72
buffer_load_dwordx4 v19, s[20:23], s54 offen offset:1024 lds
MAA 100,92,68
TR 118,25,38816
v_accvgpr_write_b32 a243, v211
MAA 100,88,48
buffer_load_dwordx4 v20, s[20:23], s54 offen offset:2048 lds
MAA 96,88,44
TR 120,25,26912
s_add_u32 s54, s54, 196608
MAA 96,92,64
TR 122,25,27424
MAA 92,92,60
TR 124,25,39328
s_add_u32 m0, s55, 18496
MAA 92,88,40
buffer_load_dwordx4 v21, s[36:39], s52 offen lds
MAA 124,40,96
TR 126,25,39840
v_accvgpr_write_b32 a244, v212
MAA 124,60,100
RD 0,23,36992
MAA 128,64,100
RD 4,23,39296
v_accvgpr_write_b32 a245, v213
MAA 128,44,96
buffer_load_dwordx4 v28, s[36:39], s52 offen offset:1024 lds
MAA 132,48,96
RD 8,23,41600
MAA 132,68,100
RD 12,23,43904
v_accvgpr_write_b32 a246, v214
MAA 136,72,100
RD 16,24,36992
MAA 136,52,96
buffer_load_dword v22, s[36:39], s52 offen offset:2048 lds
MAA 156,56,96
s_add_u32 s52, s52, 128
v_accvgpr_write_b32 a247, v215
MAA 156,76,100
s_waitcnt vmcnt(15) lgkmcnt(5)
s_barrier
MAA 76,104,40
RD 20,30,36992
s_add_u32 m0, s56, 98816
MAA 76,108,60
buffer_load_dwordx4 v18, s[20:23], s54 offen lds
MAA 80,108,64
RD 24,30,39296
v_accvgpr_write_b32 a248, v216
MAA 80,104,44
RD 28,30,41600
MAA 84,104,48
RD 32,30,43904
v_accvgpr_write_b32 a249, v217
MAA 84,108,68
buffer_load_dwordx4 v19, s[20:23], s54 offen offset:1024 lds
MAA 88,108,72
RD 36,31,36992
MAA 88,104,52
TR 80,25,49664
v_accvgpr_write_b32 a250, v218
MAA 244,104,56
MAA 244,108,76
buffer_load_dwordx4 v20, s[20:23], s54 offen offset:2048 lds
MAA 120,116,72
TR 82,25,50176
s_add_u32 s54, s54, 196608
MAA 120,112,52
TR 84,25,62080
v_accvgpr_write_b32 a251, v219
MAA 116,112,48
TR 86,25,62592
s_add_u32 m0, s55, 20800
MAA 116,116,68
buffer_load_dwordx4 v21, s[36:39], s53 offen lds
MAA 112,116,64
TR 88,25,50688
MAA 112,112,44
buffer_load_dwordx4 v28, s[36:39], s53 offen offset:1024 lds
MAA 108,112,40
TR 90,25,51200
v_accvgpr_write_b32 a252, v220
MAA 108,116,60
TR 92,25,63104
MAA 140,60,124
v_accvgpr_write_b32 a253, v221
MAA 140,40,120
buffer_load_dword v29, s[36:39], s53 offen offset:2048 lds
MAA 144,44,120
TR 94,25,63616
s_add_u32 s53, s53, 128
MAA 144,64,124
TR 96,25,51712
MAA 148,68,124
TR 98,25,52224
v_accvgpr_write_b32 a254, v222
MAA 148,48,120
buffer_atomic_add v37, v33, s[16:19], 0 offen sc0
MAA 152,52,120
TR 100,25,64128
MAA 152,72,124
TR 102,25,64640
v_accvgpr_write_b32 a255, v223
MAA 160,76,124
MAA 160,56,120
s_waitcnt lgkmcnt(8)
s_barrier
MAA 60,80,0
TR 104,25,49696
MAA 60,84,20
TR 106,25,50208
MAA 64,84,24
TR 108,25,62112
s_add_u32 m0, s56, 111232
MAA 64,80,4
buffer_load_dwordx4 v18, s[20:23], s54 offen lds
MAA 68,80,8
s_sub_u32 s47, s47, 1
s_cbranch_scc1 .Lx26
.Lx26b:
MAA 68,84,28
TR 110,25,62624
MAA 72,84,32
TR 112,25,50720
MAA 72,80,12
TR 114,25,51232
s_waitcnt lgkmcnt(6)
MAA 104,88,12
TR 116,25,63136
MAA 104,92,32
buffer_load_dwordx4 v19, s[20:23], s54 offen offset:1024 lds
MAA 100,92,28
TR 118,25,63648
MAA 100,88,8
buffer_load_dwordx4 v20, s[20:23], s54 offen offset:2048 lds
MAA 96,88,4
TR 120,25,51744
s_add_u32 s54, s54, 196608
MAA 96,92,24
TR 122,25,52256
MAA 92,92,20
TR 124,25,64160
s_add_u32 m0, s55, 36992
MAA 92,88,0
buffer_load_dwordx4 v21, s[36:39], s52 offen lds
MAA 124,0,96
TR 126,25,64672
MAA 124,20,100
RD 40,23,55488
MAA 128,24,100
RD 44,23,57792
MAA 128,4,96
buffer_load_dwordx4 v28, s[36:39], s52 offen offset:1024 lds
MAA 132,8,96
RD 48,23,60096
MAA 132,28,100
RD 52,23,62400
MAA 136,32,100
RD 56,24,55488
MAA 136,12,96
buffer_load_dword v22, s[36:39], s52 offen offset:2048 lds
MAA 156,16,96
s_add_u32 s52, s52, 128
MAA 156,36,100
s_waitcnt vmcnt(16) lgkmcnt(5)
s_barrier
MAA 76,104,0
RD 60,30,55488
MAA 76,108,20
RD 64,30,57792
MAA 80,108,24
RD 68,30,60096
s_add_u32 m0, s56, 123648
MAA 80,104,4
buffer_load_dwordx4 v18, s[20:23], s54 offen lds
MAA 84,104,8
RD 72,30,62400
MAA 84,108,28
RD 76,31,55488
MAA 88,108,32
MAA 88,104,12
buffer_load_dwordx4 v19, s[20:23], s54 offen offset:1024 lds
MAA 244,104,16
ds_read_b64_tr_b16 a[80:81], v25
MAA 244,108,36
TR 82,25,512
MAA 120,116,32
TR 84,25,12416
MAA 120,112,12
buffer_load_dwordx4 v20, s[20:23], s54 offen offset:2048 lds
MAA 116,112,8
TR 86,25,12928
s_add_u32 s54, s54, 196608
MAA 116,116,28
MAA 112,116,24
TR 88,25,1024
MAA 112,112,4
TR 90,25,1536
MAA 108,112,0
TR 92,25,13440
s_add_u32 m0, s55, 39296
MAA 108,116,20
buffer_load_dwordx4 v21, s[36:39], s53 offen lds
MAA 140,20,124
TR 94,25,13952
MAA 140,0,120
MAA 144,4,120
TR 96,25,2048
MAA 144,24,124
buffer_load_dwordx4 v28, s[36:39], s53 offen offset:1024 lds
MAA 148,28,124
TR 98,25,2560
MAA 148,8,120
TR 100,25,14464
MAA 152,12,120
TR 102,25,14976
MAA 152,32,124
buffer_load_dword v29, s[36:39], s53 offen offset:2048 lds
MAA 160,36,124
s_add_u32 s53, s53, 128
MAA 160,16,120
s_waitcnt lgkmcnt(8)
s_barrier
MAA 60,80,40
TR 104,25,32
MAA 60,84,60
TR 106,25,544
MAA 64,84,64
TR 108,25,12448
s_add_u32 m0, s56, 136064
MAA 64,80,44
buffer_load_dwordx4 v18, s[20:23], s54 offen lds
MAA 68,80,48
s_sub_u32 s47, s47, 1
s_cbranch_scc1 .Lx27
.Lx27b:
MAA 68,84,68
TR 110,25,12960
MAA 72,84,72
TR 112,25,1056
MAA 72,80,52
TR 114,25,1568
s_waitcnt lgkmcnt(6)
MAA 104,88,52
TR 116,25,13472
MAA 104,92,72
buffer_load_dwordx4 v19, s[20:23], s54 offen offset:1024 lds
MAA 100,92,68
TR 118,25,13984
MAA 100,88,48
buffer_load_dwordx4 v20, s[20:23], s54 offen offset:2048 lds
MAA 96,88,44
TR 120,25,2080
s_add_u32 s54, s54, 196608
MAA 96,92,64
TR 122,25,2592
MAA 92,92,60
TR 124,25,14496
s_add_u32 m0, s55, 55488
MAA 92,88,40
buffer_load_dwordx4 v21, s[36:39], s52 offen lds
MAA 124,40,96
TR 126,25,15008
MAA 124,60,100
ds_read_b128 a[0:3], v23
MAA 128,64,100
RD 4,23,2304
MAA 128,44,96
buffer_load_dwordx4 v28, s[36:39], s52 offen offset:1024 lds
MAA 132,48,96
RD 8,23,4608
MAA 132,68,100
RD 12,23,6912
MAA 136,72,100
ds_read_b128 a[16:19], v24
MAA 136,52,96
buffer_load_dword v22, s[36:39], s52 offen offset:2048 lds
.Lpad7:
s_cbranch_execz .Lt0r
MAA 156,56,96
s_add_u32 s52, s52, 128
MAA 156,76,100
s_waitcnt vmcnt(18)
v_cmp_gt_u32 vcc, v36, v37
s_nop 0
s_cbranch_vccnz .Lsp28
.Lsp28b:
s_waitcnt vmcnt(15) lgkmcnt(5)
s_barrier
MAA 76,104,40
ds_read_b128 a[20:23], v30
s_add_u32 m0, s56, 73984
MAA 76,108,60
buffer_load_dwordx4 v18, s[20:23], s54 offen lds
MAA 80,108,64
RD 24,30,2304
MAA 80,104,44
RD 28,30,4608
MAA 84,104,48
RD 32,30,6912
MAA 84,108,68
buffer_load_dwordx4 v19, s[20:23], s54 offen offset:1024 lds
MAA 88,108,72
ds_read_b128 a[36:39], v31
MAA 88,104,52
TR 80,25,24832
MAA 244,104,56
MAA 244,108,76
buffer_load_dwordx4 v20, s[20:23], s54 offen offset:2048 lds
MAA 120,116,72
TR 82,25,25344
s_add_u32 s54, s54, 196608
MAA 120,112,52
TR 84,25,37248
MAA 116,112,48
TR 86,25,37760
s_add_u32 m0, s55, 57792
MAA 116,116,68
buffer_load_dwordx4 v21, s[36:39], s53 offen lds
MAA 112,116,64
TR 88,25,25856
MAA 112,112,44
buffer_load_dwordx4 v28, s[36:39], s53 offen offset:1024 lds
MAA 108,112,40
TR 90,25,26368
MAA 108,116,60
TR 92,25,38272
MAA 140,60,124
MAA 140,40,120
buffer_load_dword v29, s[36:39], s53 offen offset:2048 lds
MAA 144,44,120
TR 94,25,38784
s_add_u32 s53, s53, 128
MAA 144,64,124
TR 96,25,26880
MAA 148,68,124
TR 98,25,27392
MAA 148,48,120
buffer_load_dwordx4 v[164:167], v26, s[16:19], s75 offen sc1
MAA 152,52,120
TR 100,25,39296
MAA 152,72,124
TR 102,25,39808
MAA 160,76,124
MAA 160,56,120
s_waitcnt lgkmcnt(8)
s_barrier
MAA 60,80,0
TR 104,25,24864
s_add_u32 m0, s56, 86400
MAA 60,84,20
buffer_load_dwordx4 v18, s[20:23], s54 offen lds
MAA 64,84,24
s_sub_u32 s47, s47, 1
s_cbranch_scc1 .Lx29
.Lx29b:
MAA 64,80,4
TR 106,25,25376
TR 108,25,37280
MAA 68,80,8
TR 110,25,37792
MAA 68,84,28
buffer_load_dwordx4 v19, s[20:23], s54 offen offset:1024 lds
MAA 72,84,32
TR 112,25,25888
MAA 72,80,12
TR 114,25,26400
s_waitcnt lgkmcnt(6)
MAA 104,88,12
MAA 104,92,32
buffer_load_dwordx4 v20, s[20:23], s54 offen offset:2048 lds
MAA 100,92,28
s_add_u32 s54, s54, 196608
s_add_u32 m0, s55, 0
MAA 100,88,8
buffer_load_dwordx4 v21, s[36:39], s52 offen lds
MAA 96,88,4
TR 116,25,38304
MAA 96,92,24
TR 118,25,38816
TR 120,25,26912
MAA 92,92,20
TR 122,25,27424
MAA 92,88,0
buffer_load_dwordx4 v28, s[36:39], s52 offen offset:1024 lds
MAA 124,0,96
TR 124,25,39328
MAA 124,20,100
TR 126,25,39840
MAA 128,24,100
RD 40,23,18496
MAA 128,4,96
buffer_load_dword v22, s[36:39], s52 offen offset:2048 lds
MAA 132,8,96
RD 44,23,20800
s_add_u32 s52, s52, 128
MAA 132,28,100
buffer_load_dwordx4 v[168:171], v26, s[16:19], s75 offen offset:1024 sc1
MAA 136,32,100
RD 48,23,23104
MAA 136,12,96
RD 52,23,25408
RD 56,24,18496
MAA 156,16,96
MAA 156,36,100
s_waitcnt vmcnt(17) lgkmcnt(5)
s_barrier
MAA 76,104,0
RD 60,30,18496
s_add_u32 m0, s56, 98816
MAA 76,108,20
buffer_load_dwordx4 v18, s[20:23], s54 offen lds
MAA 80,108,24
RD 64,30,20800
MAA 80,104,4
RD 68,30,23104
MAA 84,104,8
RD 72,30,25408
MAA 84,108,28
buffer_load_dwordx4 v19, s[20:23], s54 offen offset:1024 lds
MAA 88,108,32
RD 76,31,18496
MAA 88,104,12
TR 80,25,49664
MAA 244,104,16
MAA 244,108,36
buffer_load_dwordx4 v20, s[20:23], s54 offen offset:2048 lds
MAA 120,116,32
TR 82,25,50176
s_add_u32 s54, s54, 196608
MAA 120,112,12
TR 84,25,62080
MAA 116,112,8
TR 86,25,62592
s_add_u32 m0, s55, 2304
MAA 116,116,28
buffer_load_dwordx4 v21, s[36:39], s53 offen lds
MAA 112,116,24
TR 88,25,50688
MAA 112,112,4
buffer_load_dwordx4 v28, s[36:39], s53 offen offset:1024 lds
MAA 108,112,0
TR 90,25,51200
MAA 108,116,20
TR 92,25,63104
MAA 140,20,124
MAA 140,0,120
buffer_load_dword v29, s[36:39], s53 offen offset:2048 lds
MAA 144,4,120
TR 94,25,63616
s_add_u32 s53, s53, 128
MAA 144,24,124
TR 96,25,51712
MAA 148,28,124
TR 98,25,52224
MAA 148,8,120
buffer_load_dwordx4 v[172:175], v26, s[16:19], s75 offen offset:2048 sc1
MAA 152,12,120
TR 100,25,64128
MAA 152,32,124
TR 102,25,64640
MAA 160,36,124
MAA 160,16,120
s_waitcnt lgkmcnt(8)
s_barrier
MAA 60,80,40
TR 104,25,49696
s_add_u32 m0, s56, 111232
MAA 60,84,60
buffer_load_dwordx4 v18, s[20:23], s54 offen lds
MAA 64,84,64
s_sub_u32 s47, s47, 1
s_cbranch_scc1 .Lx30
.Lx30b:
MAA 64,80,44
TR 106,25,50208
TR 108,25,62112
MAA 68,80,48
TR 110,25,62624
MAA 68,84,68
buffer_load_dwordx4 v19, s[20:23], s54 offen offset:1024 lds
MAA 72,84,72
TR 112,25,50720
MAA 72,80,52
TR 114,25,51232
s_waitcnt lgkmcnt(6)
MAA 104,88,52
MAA 104,92,72
buffer_load_dwordx4 v20, s[20:23], s54 offen offset:2048 lds
MAA 100,92,68
s_add_u32 s54, s54, 196608
s_add_u32 m0, s55, 18496
MAA 100,88,48
buffer_load_dwordx4 v21, s[36:39], s52 offen lds
MAA 96,88,44
TR 116,25,63136
MAA 96,92,64
TR 118,25,63648
TR 120,25,51744
MAA 92,92,60
TR 122,25,52256
MAA 92,88,40
buffer_load_dwordx4 v28, s[36:39], s52 offen offset:1024 lds
MAA 124,40,96
TR 124,25,64160
MAA 124,60,100
TR 126,25,64672
MAA 128,64,100
RD 0,23,36992
MAA 128,44,96
buffer_load_dword v22, s[36:39], s52 offen offset:2048 lds
MAA 132,48,96
RD 4,23,39296
s_add_u32 s52, s52, 128
MAA 132,68,100
buffer_load_dwordx4 v[176:179], v26, s[16:19], s75 offen offset:3072 sc1
MAA 136,72,100
RD 8,23,41600
s_add_u32 s75, s75, 4096
MAA 136,52,96
RD 12,23,43904
RD 16,24,36992
MAA 156,56,96
MAA 156,76,100
s_waitcnt vmcnt(18) lgkmcnt(5)
s_barrier
MAA 76,104,40
RD 20,30,36992
s_add_u32 m0, s56, 123648
MAA 76,108,60
buffer_load_dwordx4 v18, s[20:23], s54 offen lds
MAA 80,108,64
RD 24,30,39296
s_waitcnt vmcnt(15)
v_add_f32 v164, v164, v168
MAA 80,104,44
RD 28,30,41600
MAA 84,104,48
RD 32,30,43904
MAA 84,108,68
buffer_load_dwordx4 v19, s[20:23], s54 offen offset:1024 lds
MAA 88,108,72
RD 36,31,36992
MAA 88,104,52
ds_read_b64_tr_b16 a[80:81], v25
v_add_f32 v165, v165, v169
MAA 244,104,56
MAA 244,108,76
buffer_load_dwordx4 v20, s[20:23], s54 offen offset:2048 lds
MAA 120,116,72
TR 82,25,512
s_add_u32 s54, s54, 196608
MAA 120,112,52
TR 84,25,12416
MAA 116,112,48
TR 86,25,12928
s_add_u32 m0, s55, 20800
MAA 116,116,68
buffer_load_dwordx4 v21, s[36:39], s53 offen lds
MAA 112,116,64
TR 88,25,1024
MAA 112,112,44
buffer_load_dwordx4 v28, s[36:39], s53 offen offset:1024 lds
MAA 108,112,40
TR 90,25,1536
v_add_f32 v166, v166, v170
MAA 108,116,60
TR 92,25,13440
MAA 140,60,124
MAA 140,40,120
buffer_load_dword v29, s[36:39], s53 offen offset:2048 lds
MAA 144,44,120
TR 94,25,13952
s_add_u32 s53, s53, 128
MAA 144,64,124
TR 96,25,2048
MAA 148,68,124
TR 98,25,2560
v_add_f32 v167, v167, v171
MAA 148,48,120
buffer_load_dwordx4 v[180:183], v26, s[16:19], s75 offen sc1
MAA 152,52,120
TR 100,25,14464
MAA 152,72,124
TR 102,25,14976
MAA 160,76,124
MAA 160,56,120
s_waitcnt lgkmcnt(8)
s_barrier
MAA 60,80,0
TR 104,25,32
s_add_u32 m0, s56, 136064
MAA 60,84,20
buffer_load_dwordx4 v18, s[20:23], s54 offen lds
MAA 64,84,24
s_sub_u32 s47, s47, 1
s_cbranch_scc1 .Lx31
.Lx31b:
MAA 64,80,4
TR 106,25,544
TR 108,25,12448
MAA 68,80,8
TR 110,25,12960
s_waitcnt vmcnt(15)
v_add_f32 v164, v164, v172
MAA 68,84,28
buffer_load_dwordx4 v19, s[20:23], s54 offen offset:1024 lds
MAA 72,84,32
TR 112,25,1056
MAA 72,80,12
TR 114,25,1568
s_waitcnt lgkmcnt(6)
MAA 104,88,12
v_add_f32 v165, v165, v173
MAA 104,92,32
buffer_load_dwordx4 v20, s[20:23], s54 offen offset:2048 lds
MAA 100,92,28
s_add_u32 s54, s54, 196608
s_add_u32 m0, s55, 36992
MAA 100,88,8
buffer_load_dwordx4 v21, s[36:39], s52 offen lds
MAA 96,88,4
TR 116,25,13472
MAA 96,92,24
TR 118,25,13984
TR 120,25,2080
MAA 92,92,20
TR 122,25,2592
v_add_f32 v166, v166, v174
MAA 92,88,0
buffer_load_dwordx4 v28, s[36:39], s52 offen offset:1024 lds
MAA 124,0,96
TR 124,25,14496
MAA 124,20,100
TR 126,25,15008
MAA 128,24,100
RD 40,23,55488
v_add_f32 v167, v167, v175
MAA 128,4,96
buffer_load_dword v22, s[36:39], s52 offen offset:2048 lds
MAA 132,8,96
RD 44,23,57792
s_add_u32 s52, s52, 128
MAA 132,28,100
buffer_load_dwordx4 v[184:187], v26, s[16:19], s75 offen offset:1024 sc1
MAA 136,32,100
RD 48,23,60096
MAA 136,12,96
RD 52,23,62400
RD 56,24,55488
MAA 156,16,96
MAA 156,36,100
s_waitcnt vmcnt(18) lgkmcnt(5)
s_barrier
MAA 76,104,0
RD 60,30,55488
s_waitcnt vmcnt(14)
v_add_f32 v164, v164, v176
MAA 76,108,20
RD 64,30,57792
s_add_u32 m0, s56, 73984
MAA 80,108,24
buffer_load_dwordx4 v18, s[20:23], s54 offen lds
MAA 80,104,4
RD 68,30,60096
v_add_f32 v165, v165, v177
MAA 84,104,8
RD 72,30,62400
v_add_f32 v166, v166, v178
MAA 84,108,28
buffer_load_dwordx4 v19, s[20:23], s54 offen offset:1024 lds
MAA 88,108,32
RD 76,31,55488
v_add_f32 v167, v167, v179
MAA 88,104,12
TR 80,25,24832
MAA 244,104,16
buffer_load_dwordx4 v20, s[20:23], s54 offen offset:2048 lds
MAA 244,108,36
TR 82,25,25344
s_add_u32 s54, s54, 196608
MAA 120,116,32
TR 84,25,37248
s_add_u32 m0, s55, 39296
MAA 120,112,12
buffer_load_dwordx4 v21, s[36:39], s53 offen lds
MAA 116,112,8
TR 86,25,37760
MAA 116,116,28
TR 88,25,25856
MAA 112,116,24
buffer_load_dwordx4 v28, s[36:39], s53 offen offset:1024 lds
MAA 112,112,4
TR 90,25,26368
MAA 108,112,0
TR 92,25,38272
MAA 108,116,20
buffer_load_dword v29, s[36:39], s53 offen offset:2048 lds
MAA 140,20,124
TR 94,25,38784
s_add_u32 s53, s53, 128
MAA 140,0,120
TR 96,25,26880
MAA 144,4,120
buffer_load_dwordx4 v[188:191], v26, s[16:19], s75 offen offset:2048 sc1
MAA 144,24,124
TR 98,25,27392
MAA 148,28,124
TR 100,25,39296
MAA 148,8,120
TR 102,25,39808
MAA 152,12,120
MAA 152,32,124
MAA 160,36,124
MAA 160,16,120
s_waitcnt lgkmcnt(8)
s_barrier
MAA 60,80,40
TR 104,25,24864
s_add_u32 m0, s56, 86400
MAA 60,84,60
buffer_load_dwordx4 v18, s[20:23], s54 offen lds
MAA 64,84,64
s_sub_u32 s47, s47, 1
s_cbranch_scc1 .Lx32
.Lx32b:
MAA 64,80,44
TR 106,25,25376
TR 108,25,37280
MAA 68,80,48
TR 110,25,37792
s_waitcnt vmcnt(15)
v_add_f32 v164, v164, v180
MAA 68,84,68
buffer_load_dwordx4 v19, s[20:23], s54 offen offset:1024 lds
MAA 72,84,72
TR 112,25,25888
MAA 72,80,52
TR 114,25,26400
s_waitcnt lgkmcnt(6)
MAA 104,88,52
v_add_f32 v165, v165, v181
MAA 104,92,72
buffer_load_dwordx4 v20, s[20:23], s54 offen offset:2048 lds
MAA 100,92,68
s_add_u32 s54, s54, 196608
s_add_u32 m0, s55, 55488
MAA 100,88,48
buffer_load_dwordx4 v21, s[36:39], s52 offen lds
MAA 96,88,44
TR 116,25,38304
MAA 96,92,64
TR 118,25,38816
TR 120,25,26912
MAA 92,92,60
TR 122,25,27424
v_add_f32 v166, v166, v182
MAA 92,88,40
buffer_load_dwordx4 v28, s[36:39], s52 offen offset:1024 lds
MAA 124,40,96
TR 124,25,39328
MAA 124,60,100
TR 126,25,39840
MAA 128,64,100
ds_read_b128 a[0:3], v23
v_add_f32 v167, v167, v183
MAA 128,44,96
buffer_load_dword v22, s[36:39], s52 offen offset:2048 lds
MAA 132,48,96
RD 4,23,2304
s_add_u32 s52, s52, 128
MAA 132,68,100
buffer_load_dwordx4 v[192:195], v26, s[16:19], s75 offen offset:3072 sc1
MAA 136,72,100
RD 8,23,4608
MAA 136,52,96
RD 12,23,6912
ds_read_b128 a[16:19], v24
MAA 156,56,96
MAA 156,76,100
s_waitcnt vmcnt(18) lgkmcnt(5)
s_barrier
MAA 76,104,40
ds_read_b128 a[20:23], v30
s_waitcnt vmcnt(14)
v_add_f32 v164, v164, v184
MAA 76,108,60
RD 24,30,2304
s_add_u32 m0, s56, 98816
MAA 80,108,64
buffer_load_dwordx4 v18, s[20:23], s54 offen lds
MAA 80,104,44
RD 28,30,4608
v_add_f32 v165, v165, v185
MAA 84,104,48
RD 32,30,6912
v_add_f32 v166, v166, v186
MAA 84,108,68
ds_read_b128 a[36:39], v31
v_add_f32 v167, v167, v187
MAA 88,108,72
buffer_load_dwordx4 v19, s[20:23], s54 offen offset:1024 lds
MAA 88,104,52
TR 80,25,49664
MAA 244,104,56
TR 82,25,50176
MAA 244,108,76
TR 84,25,62080
MAA 120,116,72
buffer_load_dwordx4 v20, s[20:23], s54 offen offset:2048 lds
MAA 120,112,52
TR 86,25,62592
s_add_u32 s54, s54, 196608
MAA 116,112,48
TR 88,25,50688
s_add_u32 m0, s55, 57792
MAA 116,116,68
TR 90,25,51200
MAA 112,116,64
buffer_load_dwordx4 v21, s[36:39], s53 offen lds
MAA 112,112,44
TR 92,25,63104
MAA 108,112,40
TR 94,25,63616
MAA 108,116,60
TR 96,25,51712
.Lpad8:
s_cbranch_execz .Lt0r
MAA 140,60,124
buffer_load_dwordx4 v28, s[36:39], s53 offen offset:1024 lds
MAA 140,40,120
TR 98,25,52224
MAA 144,44,120
TR 100,25,64128
MAA 144,64,124
TR 102,25,64640
MAA 148,68,124
buffer_load_dword v29, s[36:39], s53 offen offset:2048 lds
MAA 148,48,120
s_add_u32 s53, s53, 128
MAA 152,52,120
MAA 152,72,124
MAA 160,76,124
MAA 160,56,120
s_waitcnt lgkmcnt(8)
s_barrier
MAA 60,80,0
TR 104,25,49696
s_waitcnt vmcnt(13)
v_add_f32 v164, v164, v188
MAA 60,84,20
TR 106,25,50208
s_add_u32 m0, s56, 111232
MAA 64,84,24
buffer_load_dwordx4 v18, s[20:23], s54 offen lds
MAA 64,80,4
TR 108,25,62112
v_add_f32 v165, v165, v189
MAA 68,80,8
TR 110,25,62624
v_add_f32 v166, v166, v190
MAA 68,84,28
buffer_load_dwordx4 v19, s[20:23], s54 offen offset:1024 lds
MAA 72,84,32
TR 112,25,50720
v_add_f32 v167, v167, v191
MAA 72,80,12
TR 114,25,51232
s_waitcnt lgkmcnt(6)
MAA 104,88,12
buffer_load_dwordx4 v20, s[20:23], s54 offen offset:2048 lds
MAA 104,92,32
TR 116,25,63136
s_add_u32 s54, s54, 196608
MAA 100,92,28
TR 118,25,63648
s_add_u32 m0, s59, 0
MAA 100,88,8
TR 120,25,51744
s_xor_b32 s58, s87, 1048576
MAA 96,88,4
buffer_load_dwordx4 v5, s[24:27], s58 offen lds
MAA 96,92,24
TR 122,25,52256
MAA 92,92,20
TR 124,25,64160
MAA 92,88,0
buffer_load_dwordx4 v6, s[24:27], s58 offen offset:1024 lds
MAA 124,0,96
TR 126,25,64672
s_add_u32 m0, s59, 8320
MAA 124,20,100
RD 40,23,18496
s_xor_b32 s58, s87, 1179648
MAA 128,24,100
buffer_load_dwordx4 v5, s[24:27], s58 offen lds
MAA 128,4,96
RD 44,23,20800
MAA 132,8,96
RD 48,23,23104
MAA 132,28,100
buffer_load_dwordx4 v6, s[24:27], s58 offen offset:1024 lds
MAA 136,32,100
RD 52,23,25408
MAA 136,12,96
RD 56,24,18496
MAA 156,16,96
MAA 156,36,100
s_waitcnt vmcnt(17) lgkmcnt(5)
s_barrier
MAA 76,104,0
RD 60,30,18496
s_waitcnt vmcnt(13)
v_add_f32 v164, v164, v192
MAA 76,108,20
RD 64,30,20800
s_add_u32 m0, s56, 123648
MAA 80,108,24
buffer_load_dwordx4 v18, s[20:23], s54 offen lds
MAA 80,104,4
RD 68,30,23104
v_add_f32 v165, v165, v193
MAA 84,104,8
RD 72,30,25408
v_add_f32 v166, v166, v194
MAA 84,108,28
RD 76,31,18496
v_add_f32 v167, v167, v195
MAA 88,108,32
ds_read_b64_tr_b16 a[80:81], v25
MAA 88,104,12
TR 82,25,512
MAA 244,104,16
TR 84,25,12416
MAA 244,108,36
TR 86,25,12928
MAA 120,116,32
buffer_load_dwordx4 v19, s[20:23], s54 offen offset:1024 lds
MAA 120,112,12
TR 88,25,1024
MAA 116,112,8
TR 90,25,1536
MAA 116,116,28
TR 92,25,13440
MAA 112,116,24
TR 94,25,13952
MAA 112,112,4
TR 96,25,2048
MAA 108,112,0
TR 98,25,2560
MAA 108,116,20
TR 100,25,14464
MAA 140,20,124
buffer_load_dwordx4 v20, s[20:23], s54 offen offset:2048 lds
MAA 140,0,120
TR 102,25,14976
s_add_u32 s54, s54, 196608
MAA 144,4,120
MAA 144,24,124
MAA 148,28,124
MAA 148,8,120
MAA 152,12,120
MAA 152,32,124
MAA 160,36,124
MAA 160,16,120
s_waitcnt lgkmcnt(8)
s_barrier
MAA 60,80,40
TR 104,25,32
MAA 60,84,60
TR 106,25,544
s_add_u32 m0, s56, 136064
MAA 64,84,64
buffer_load_dwordx4 v18, s[20:23], s54 offen lds
MAA 64,80,44
TR 108,25,12448
MAA 68,80,48
TR 110,25,12960
MAA 68,84,68
buffer_load_dwordx4 v19, s[20:23], s54 offen offset:1024 lds
MAA 72,84,72
TR 112,25,1056
MAA 72,80,52
TR 114,25,1568
s_waitcnt lgkmcnt(6)
MAA 104,88,52
buffer_load_dwordx4 v20, s[20:23], s54 offen offset:2048 lds
MAA 104,92,72
TR 116,25,13472
s_add_u32 s54, s54, 196608
MAA 100,92,68
TR 118,25,13984
s_add_u32 m0, s59, 16640
MAA 100,88,48
TR 120,25,2080
s_xor_b32 s58, s87, 1310720
MAA 96,88,44
buffer_load_dwordx4 v5, s[24:27], s58 offen lds
MAA 96,92,64
TR 122,25,2592
MAA 92,92,60
TR 124,25,14496
MAA 92,88,40
buffer_load_dwordx4 v6, s[24:27], s58 offen offset:1024 lds
MAA 124,40,96
TR 126,25,15008
s_add_u32 m0, s59, 24960
MAA 124,60,100
RD 0,23,36992
s_xor_b32 s58, s87, 1441792
MAA 128,64,100
buffer_load_dwordx4 v5, s[24:27], s58 offen lds
MAA 128,44,96
RD 4,23,39296
MAA 132,48,96
RD 8,23,41600
MAA 132,68,100
buffer_load_dwordx4 v6, s[24:27], s58 offen offset:1024 lds
MAA 136,72,100
RD 12,23,43904
MAA 136,52,96
RD 16,24,36992
MAA 156,56,96
v_permlane32_swap_b32 v164, v166
MAA 156,76,100
v_permlane32_swap_b32 v165, v167
v_add_f32 v164, v164, v166
v_add_f32 v165, v165, v167
v_mul_f32 v164, 0xba800000, v164
v_mul_f32 v165, 0x3a800000, v165
v_fma_f32 v165, -v164, v164, v165
v_max_f32 v165, 0, v165
v_add_f32 v165, 0x3727c5ac, v165
v_rsq_f32 v166, v165
s_nop 0
v_mov_b32 v165, v166
v_mul_f32 v166, 0x3e8293ee, v166
s_waitcnt vmcnt(14) lgkmcnt(5)
s_barrier
MAA 76,104,40
ds_write_b128 v7, v[164:167]
MAA 76,108,60
ds_write_b32 v17, v164
s_add_u32 m0, s59, 74880
MAA 80,108,64
ds_write_b32 v17, v165 offset:1024
s_xor_b32 s58, s87, 131072
MAA 80,104,44
buffer_load_dwordx4 v5, s[24:27], s58 offen lds
MAA 84,104,48
RD 20,30,36992
MAA 84,108,68
RD 24,30,39296
MAA 88,108,72
RD 28,30,41600
MAA 88,104,52
RD 32,30,43904
MAA 244,104,56
RD 36,31,36992
MAA 244,108,76
buffer_load_dwordx4 v6, s[24:27], s58 offen offset:1024 lds
MAA 120,116,72
TR 80,25,24832
s_add_u32 m0, s59, 83200
MAA 120,112,52
TR 82,25,25344
s_xor_b32 s58, s87, 262144
MAA 116,112,48
TR 84,25,37248
MAA 116,116,68
TR 86,25,37760
MAA 112,116,64
TR 88,25,25856
MAA 112,112,44
buffer_load_dwordx4 v5, s[24:27], s58 offen lds
MAA 108,112,40
TR 90,25,26368
MAA 108,116,60
TR 92,25,38272
MAA 140,60,124
TR 94,25,38784
MAA 140,40,120
TR 96,25,26880
MAA 144,44,120
TR 98,25,27392
MAA 144,64,124
buffer_load_dwordx4 v6, s[24:27], s58 offen offset:1024 lds
MAA 148,68,124
TR 100,25,39296
MAA 148,48,120
TR 102,25,39808
MAA 152,52,120
MAA 152,72,124
MAA 160,76,124
MAA 160,56,120
s_waitcnt vmcnt(8) lgkmcnt(0)
s_barrier
MAA 104,88,12
TR 112,25,25888
s_add_u32 m0, s59, 33280
MAA 104,92,32
TR 114,25,26400
s_xor_b32 s58, s87, 1572864
MAA 100,92,28
buffer_load_dwordx4 v5, s[24:27], s58 offen lds
MAA 100,88,8
TR 116,25,38304
MAA 96,88,4
TR 118,25,38816
MAA 96,92,24
TR 120,25,26912
MAA 92,92,20
buffer_load_dwordx4 v6, s[24:27], s58 offen offset:1024 lds
MAA 92,88,0
TR 122,25,27424
s_add_u32 m0, s59, 41600
MAA 156,16,96
TR 124,25,39328
s_xor_b32 s58, s87, 1703936
MAA 156,36,100
TR 126,25,39840
MAA 72,84,32
buffer_load_dwordx4 v5, s[24:27], s58 offen lds
MAA 72,80,12
TR 104,25,24864
MAA 68,80,8
TR 106,25,25376
MAA 68,84,28
TR 108,25,37280
MAA 64,84,24
buffer_load_dwordx4 v6, s[24:27], s58 offen offset:1024 lds
MAA 64,80,4
TR 110,25,37792
MAA 60,80,0
RD 40,23,55488
MAA 60,84,20
RD 44,23,57792
s_waitcnt lgkmcnt(12)
MAA 120,112,12
RD 48,23,60096
s_waitcnt lgkmcnt(11)
MAA 120,116,32
RD 52,23,62400
MAA 116,116,28
RD 56,24,55488
MAA 116,112,8
RD 60,30,55488
MAA 112,112,4
RD 64,30,57792
MAA 112,116,24
s_waitcnt lgkmcnt(7)
s_barrier
RD 68,30,60096
MAA 108,116,20
RD 72,30,62400
s_add_u32 m0, s59, 91520
MAA 108,112,0
RD 76,31,55488
s_xor_b32 s58, s87, 393216
MAA 160,16,120
TR 144,25,50688
MAA 160,36,124
TR 146,25,51200
MAA 244,108,36
TR 148,25,63104
MAA 244,104,16
TR 150,25,63616
MAA 88,104,12
TR 152,25,50720
MAA 88,108,32
TR 154,25,51232
MAA 84,108,28
TR 156,25,63136
MAA 84,104,8
TR 158,25,63648
MAA 80,104,4
TR 160,25,51712
MAA 80,108,24
TR 162,25,52224
MAA 76,108,20
TR 164,25,64128
MAA 76,104,0
TR 166,25,64640
s_waitcnt lgkmcnt(10)
MAA 104,144,52
TR 168,25,51744
s_waitcnt lgkmcnt(9)
MAA 104,148,72
TR 170,25,52256
MAA 100,148,68
TR 172,25,64160
MAA 100,144,48
TR 174,25,64672
MAA 96,144,44
TR 136,25,49696
MAA 96,148,64
TR 138,25,50208
MAA 92,148,60
TR 140,25,62112
MAA 92,144,40
TR 142,25,62624
s_waitcnt lgkmcnt(14)
MAA 120,152,52
TR 128,25,49664
s_waitcnt lgkmcnt(13)
MAA 120,156,72
TR 130,25,50176
MAA 116,156,68
TR 132,25,62080
MAA 116,152,48
TR 134,25,62592
MAA 112,152,44
ds_read_b128 v[232:235], v10 offset:1792
MAA 112,156,64
ds_read_b128 v[228:231], v10 offset:1536
MAA 108,156,60
ds_read_b128 v[224:227], v10 offset:1280
MAA 108,152,40
ds_read_b128 v[220:223], v10 offset:1024
s_waitcnt lgkmcnt(15)
MAA 156,56,160
buffer_load_dwordx4 v5, s[24:27], s58 offen lds
MAA 156,76,164
s_waitcnt lgkmcnt(12)
MAA 160,76,172
MAA 160,56,168
s_waitcnt lgkmcnt(10)
MAA 244,136,56
buffer_load_dwordx4 v6, s[24:27], s58 offen offset:1024 lds
s_waitcnt lgkmcnt(8)
MAA 244,140,76
s_add_u32 m0, s59, 99840
s_xor_b32 s58, s87, 524288
MAA 88,140,72
MAA 88,136,52
MAA 84,136,48
buffer_load_dwordx4 v5, s[24:27], s58 offen lds
MAA 84,140,68
buffer_load_dwordx4 v6, s[24:27], s58 offen offset:1024 lds
s_add_u32 m0, s59, 108160
s_xor_b32 s58, s87, 655360
buffer_load_dwordx4 v5, s[24:27], s58 offen lds
buffer_load_dwordx4 v6, s[24:27], s58 offen offset:1024 lds
s_mov_b32 exec_lo, 0x10001
s_mov_b32 exec_hi, 0x10001
ds_write_b128 v13, v[244:247] offset:64
s_mov_b64 exec, 0xffff
ds_write_b32 v12, v156 offset:512
ds_write_b32 v12, v160 offset:576
s_mov_b64 exec, -1
MAA 80,136,44
MAA 80,140,64
MAA 76,140,60
MAA 76,136,40
s_waitcnt lgkmcnt(9)
MAA 72,128,52
s_waitcnt lgkmcnt(7)
MAA 72,132,72
s_waitcnt lgkmcnt(0)
s_barrier
MAA 68,128,48
ds_read_b128 v[28:31], v13
MAA 68,132,68
ds_read_b128 v[32:35], v13 offset:64
MAA 64,132,64
ds_read_b128 v[36:39], v13 offset:256
MAA 64,128,44
ds_read_b128 v[40:43], v13 offset:320
MAA 60,128,40
ds_read_b32 v44, v12 offset:512
MAA 60,132,60
ds_read_b32 v45, v12 offset:576
ds_read_b128 v[240:243], v11 offset:704
ds_read_b128 v[244:247], v11 offset:1728
ds_read_b128 v[18:21], v11 offset:448
ds_read_b128 v[22:25], v11 offset:1472
s_waitcnt lgkmcnt(9)
v_pk_fma_f32 v[72:73], v[28:29], v[232:233], v[72:73] op_sel_hi:[1,0,1]
v_cvt_pk_bf16_f32 v176, v72, v73
v_pk_fma_f32 v[74:75], v[30:31], v[232:233], v[74:75] op_sel_hi:[1,0,1]
v_cvt_pk_bf16_f32 v177, v74, v75
s_waitcnt lgkmcnt(8)
v_pk_fma_f32 v[88:89], v[32:33], v[232:233], v[88:89] op_sel_hi:[1,0,1]
v_cvt_pk_bf16_f32 v178, v88, v89
v_pk_fma_f32 v[90:91], v[34:35], v[232:233], v[90:91] op_sel_hi:[1,0,1]
v_cvt_pk_bf16_f32 v179, v90, v91
s_waitcnt lgkmcnt(7)
v_pk_fma_f32 v[104:105], v[36:37], v[232:233], v[104:105] op_sel_hi:[1,0,1]
v_pk_mul_f32 v[104:105], v[104:105], v[232:233] op_sel:[0,1] op_sel_hi:[1,1]
v_cvt_pk_bf16_f32 v196, v104, v105
v_pk_fma_f32 v[106:107], v[38:39], v[232:233], v[106:107] op_sel_hi:[1,0,1]
v_pk_mul_f32 v[106:107], v[106:107], v[232:233] op_sel:[0,1] op_sel_hi:[1,1]
v_cvt_pk_bf16_f32 v197, v106, v107
s_waitcnt lgkmcnt(6)
v_pk_fma_f32 v[120:121], v[40:41], v[232:233], v[120:121] op_sel_hi:[1,0,1]
v_pk_mul_f32 v[120:121], v[120:121], v[232:233] op_sel:[0,1] op_sel_hi:[1,1]
v_cvt_pk_bf16_f32 v198, v120, v121
v_pk_fma_f32 v[122:123], v[42:43], v[232:233], v[122:123] op_sel_hi:[1,0,1]
v_pk_mul_f32 v[122:123], v[122:123], v[232:233] op_sel:[0,1] op_sel_hi:[1,1]
v_cvt_pk_bf16_f32 v199, v122, v123
v_pk_fma_f32 v[100:101], v[36:37], v[228:229], v[100:101] op_sel_hi:[1,0,1]
v_pk_mul_f32 v[100:101], v[100:101], v[228:229] op_sel:[0,1] op_sel_hi:[1,1]
s_waitcnt lgkmcnt(3)
v_pk_fma_f32 v[156:157], v[240:241], v[44:45], v[156:157] op_sel_hi:[1,0,1]
v_pk_fma_f32 v[158:159], v[242:243], v[44:45], v[158:159] op_sel_hi:[1,0,1]
s_waitcnt lgkmcnt(2)
v_pk_mul_f32 v[156:157], v[156:157], v[244:245]
v_cvt_pk_bf16_f32 v236, v156, v157
v_pk_mul_f32 v[158:159], v[158:159], v[246:247]
v_cvt_pk_bf16_f32 v237, v158, v159
v_pk_fma_f32 v[160:161], v[240:241], v[44:45], v[160:161] op_sel:[0,1,0] op_sel_hi:[1,1,1]
v_pk_mul_f32 v[160:161], v[160:161], v[244:245]
v_cvt_pk_bf16_f32 v238, v160, v161
v_pk_fma_f32 v[162:163], v[242:243], v[44:45], v[162:163] op_sel:[0,1,0] op_sel_hi:[1,1,1]
v_pk_mul_f32 v[162:163], v[162:163], v[246:247]
v_cvt_pk_bf16_f32 v239, v162, v163
ds_write_b128 v8, v[236:239] offset:1024
v_cvt_pk_bf16_f32 v192, v100, v101
v_pk_fma_f32 v[102:103], v[38:39], v[228:229], v[102:103] op_sel_hi:[1,0,1]
v_pk_mul_f32 v[102:103], v[102:103], v[228:229] op_sel:[0,1] op_sel_hi:[1,1]
v_cvt_pk_bf16_f32 v193, v102, v103
v_pk_fma_f32 v[116:117], v[40:41], v[228:229], v[116:117] op_sel_hi:[1,0,1]
v_pk_mul_f32 v[116:117], v[116:117], v[228:229] op_sel:[0,1] op_sel_hi:[1,1]
v_cvt_pk_bf16_f32 v194, v116, v117
v_pk_fma_f32 v[118:119], v[42:43], v[228:229], v[118:119] op_sel_hi:[1,0,1]
v_pk_mul_f32 v[118:119], v[118:119], v[228:229] op_sel:[0,1] op_sel_hi:[1,1]
v_cvt_pk_bf16_f32 v195, v118, v119
v_pk_fma_f32 v[96:97], v[36:37], v[224:225], v[96:97] op_sel_hi:[1,0,1]
v_pk_mul_f32 v[96:97], v[96:97], v[224:225] op_sel:[0,1] op_sel_hi:[1,1]
v_cvt_pk_bf16_f32 v188, v96, v97
v_pk_fma_f32 v[98:99], v[38:39], v[224:225], v[98:99] op_sel_hi:[1,0,1]
v_pk_mul_f32 v[98:99], v[98:99], v[224:225] op_sel:[0,1] op_sel_hi:[1,1]
v_cvt_pk_bf16_f32 v189, v98, v99
v_pk_fma_f32 v[112:113], v[40:41], v[224:225], v[112:113] op_sel_hi:[1,0,1]
v_pk_mul_f32 v[112:113], v[112:113], v[224:225] op_sel:[0,1] op_sel_hi:[1,1]
v_cvt_pk_bf16_f32 v190, v112, v113
v_pk_fma_f32 v[114:115], v[42:43], v[224:225], v[114:115] op_sel_hi:[1,0,1]
v_pk_mul_f32 v[114:115], v[114:115], v[224:225] op_sel:[0,1] op_sel_hi:[1,1]
v_cvt_pk_bf16_f32 v191, v114, v115
v_pk_fma_f32 v[92:93], v[36:37], v[220:221], v[92:93] op_sel_hi:[1,0,1]
v_pk_mul_f32 v[92:93], v[92:93], v[220:221] op_sel:[0,1] op_sel_hi:[1,1]
v_cvt_pk_bf16_f32 v184, v92, v93
v_pk_fma_f32 v[94:95], v[38:39], v[220:221], v[94:95] op_sel_hi:[1,0,1]
v_pk_mul_f32 v[94:95], v[94:95], v[220:221] op_sel:[0,1] op_sel_hi:[1,1]
v_cvt_pk_bf16_f32 v185, v94, v95
v_pk_fma_f32 v[108:109], v[40:41], v[220:221], v[108:109] op_sel_hi:[1,0,1]
v_pk_mul_f32 v[108:109], v[108:109], v[220:221] op_sel:[0,1] op_sel_hi:[1,1]
v_cvt_pk_bf16_f32 v186, v108, v109
v_pk_fma_f32 v[110:111], v[42:43], v[220:221], v[110:111] op_sel_hi:[1,0,1]
v_pk_mul_f32 v[110:111], v[110:111], v[220:221] op_sel:[0,1] op_sel_hi:[1,1]
v_cvt_pk_bf16_f32 v187, v110, v111
v_pk_fma_f32 v[68:69], v[28:29], v[228:229], v[68:69] op_sel_hi:[1,0,1]
v_cvt_pk_bf16_f32 v172, v68, v69
v_pk_fma_f32 v[70:71], v[30:31], v[228:229], v[70:71] op_sel_hi:[1,0,1]
v_cvt_pk_bf16_f32 v173, v70, v71
v_pk_fma_f32 v[84:85], v[32:33], v[228:229], v[84:85] op_sel_hi:[1,0,1]
v_cvt_pk_bf16_f32 v174, v84, v85
v_pk_fma_f32 v[86:87], v[34:35], v[228:229], v[86:87] op_sel_hi:[1,0,1]
v_cvt_pk_bf16_f32 v175, v86, v87
v_pk_fma_f32 v[64:65], v[28:29], v[224:225], v[64:65] op_sel_hi:[1,0,1]
v_cvt_pk_bf16_f32 v168, v64, v65
v_pk_fma_f32 v[66:67], v[30:31], v[224:225], v[66:67] op_sel_hi:[1,0,1]
v_cvt_pk_bf16_f32 v169, v66, v67
v_pk_fma_f32 v[80:81], v[32:33], v[224:225], v[80:81] op_sel_hi:[1,0,1]
v_cvt_pk_bf16_f32 v170, v80, v81
v_pk_fma_f32 v[82:83], v[34:35], v[224:225], v[82:83] op_sel_hi:[1,0,1]
.Lpad9:
s_cbranch_execz .Lt0r
v_cvt_pk_bf16_f32 v171, v82, v83
v_pk_fma_f32 v[60:61], v[28:29], v[220:221], v[60:61] op_sel_hi:[1,0,1]
v_cvt_pk_bf16_f32 v164, v60, v61
v_pk_fma_f32 v[62:63], v[30:31], v[220:221], v[62:63] op_sel_hi:[1,0,1]
v_cvt_pk_bf16_f32 v165, v62, v63
v_pk_fma_f32 v[76:77], v[32:33], v[220:221], v[76:77] op_sel_hi:[1,0,1]
v_cvt_pk_bf16_f32 v166, v76, v77
v_pk_fma_f32 v[78:79], v[34:35], v[220:221], v[78:79] op_sel_hi:[1,0,1]
s_waitcnt lgkmcnt(0)
s_barrier
v_cvt_pk_bf16_f32 v167, v78, v79
v_mfma_f32_16x16x32_bf16 v[120:123], v[196:199], v[176:179], v[50:53]
ds_read_b128 v[180:183], v9
v_mfma_f32_16x16x32_bf16 v[104:107], v[192:195], v[176:179], v[46:49]
ds_read_b64 v[200:201], v9 offset:1024
v_mfma_f32_16x16x32_bf16 v[116:119], v[192:195], v[172:175], v[50:53]
ds_read_b64 v[210:211], v9 offset:1032
v_mfma_f32_16x16x32_bf16 v[100:103], v[188:191], v[172:175], v[46:49]
ds_read_b128 v[240:243], v11 offset:384
v_mfma_f32_16x16x32_bf16 v[112:115], v[188:191], v[168:171], v[50:53]
ds_read_b128 v[244:247], v11 offset:1408
v_mfma_f32_16x16x32_bf16 v[96:99], v[184:187], v[168:171], v[46:49]
ds_read_b128 v[28:31], v11 offset:320
v_max3_f32 v88, v104, v105, v106
v_mfma_f32_16x16x32_bf16 v[108:111], v[184:187], v[164:167], v[50:53]
ds_read_b128 v[32:35], v11 offset:1344
v_max3_f32 v89, v107, v120, v121
v_max3_f32 v88, v88, v122, v123
v_max_f32 v90, v88, v89
v_max_f32 v89, v88, v89
v_max3_f32 v84, v100, v101, v102
v_max3_f32 v85, v103, v116, v117
s_waitcnt lgkmcnt(6)
v_mfma_f32_16x16x32_bf16 v[92:95], v[180:183], v[164:167], v[46:49]
ds_read_b128 v[36:39], v11 offset:256
v_permlane16_swap_b32 v90, v89
MAA 136,12,96
ds_read_b128 v[40:43], v11 offset:1280
v_max_f32 v88, v90, v89
MAA 136,32,100
v_max_f32 v89, v90, v89
v_max3_f32 v84, v84, v118, v119
MAA 136,52,160
v_permlane32_swap_b32 v88, v89
MAA 136,72,164
v_max_f32 v88, v88, v89
v_mul_f32 v88, v88, v234
MAA 152,72,172
v_max_f32 v86, v84, v85
v_max_f32 v85, v84, v85
MAA 152,52,168
s_nop 0
v_permlane16_swap_b32 v86, v85
MAA 152,32,124
v_max_f32 v84, v86, v85
v_max_f32 v85, v86, v85
MAA 152,12,120
s_nop 0
v_permlane32_swap_b32 v84, v85
v_max3_f32 v80, v96, v97, v98
v_max_f32 v84, v84, v85
v_mul_f32 v84, v84, v230
v_max3_f32 v81, v99, v112, v113
v_max3_f32 v80, v80, v114, v115
v_max_f32 v82, v80, v81
v_max_f32 v81, v80, v81
v_max3_f32 v76, v92, v93, v94
v_max3_f32 v77, v95, v108, v109
v_permlane16_swap_b32 v82, v81
v_max3_f32 v76, v76, v110, v111
v_max_f32 v80, v82, v81
v_max_f32 v81, v82, v81
v_max_f32 v78, v76, v77
v_max_f32 v77, v76, v77
v_permlane32_swap_b32 v80, v81
v_pk_fma_f32 v[104:105], v[104:105], v[234:235], v[88:89] op_sel_hi:[1,0,0] neg_lo:[0,0,1] neg_hi:[0,0,1]
v_max_f32 v80, v80, v81
v_mul_f32 v80, v80, v226
v_permlane16_swap_b32 v78, v77
v_pk_fma_f32 v[106:107], v[106:107], v[234:235], v[88:89] op_sel_hi:[1,0,0] neg_lo:[0,0,1] neg_hi:[0,0,1]
v_max_f32 v76, v78, v77
v_max_f32 v77, v78, v77
v_pk_fma_f32 v[120:121], v[120:121], v[234:235], v[88:89] op_sel_hi:[1,0,0] neg_lo:[0,0,1] neg_hi:[0,0,1]
v_pk_fma_f32 v[122:123], v[122:123], v[234:235], v[88:89] op_sel_hi:[1,0,0] neg_lo:[0,0,1] neg_hi:[0,0,1]
v_permlane32_swap_b32 v76, v77
v_pk_fma_f32 v[100:101], v[100:101], v[230:231], v[84:85] op_sel_hi:[1,0,0] neg_lo:[0,0,1] neg_hi:[0,0,1]
v_max_f32 v76, v76, v77
v_mul_f32 v76, v76, v222
v_pk_fma_f32 v[102:103], v[102:103], v[230:231], v[84:85] op_sel_hi:[1,0,0] neg_lo:[0,0,1] neg_hi:[0,0,1]
v_pk_fma_f32 v[116:117], v[116:117], v[230:231], v[84:85] op_sel_hi:[1,0,0] neg_lo:[0,0,1] neg_hi:[0,0,1]
v_pk_fma_f32 v[118:119], v[118:119], v[230:231], v[84:85] op_sel_hi:[1,0,0] neg_lo:[0,0,1] neg_hi:[0,0,1]
v_pk_fma_f32 v[96:97], v[96:97], v[226:227], v[80:81] op_sel_hi:[1,0,0] neg_lo:[0,0,1] neg_hi:[0,0,1]
v_pk_fma_f32 v[98:99], v[98:99], v[226:227], v[80:81] op_sel_hi:[1,0,0] neg_lo:[0,0,1] neg_hi:[0,0,1]
v_pk_fma_f32 v[112:113], v[112:113], v[226:227], v[80:81] op_sel_hi:[1,0,0] neg_lo:[0,0,1] neg_hi:[0,0,1]
v_pk_fma_f32 v[114:115], v[114:115], v[226:227], v[80:81] op_sel_hi:[1,0,0] neg_lo:[0,0,1] neg_hi:[0,0,1]
v_pk_fma_f32 v[92:93], v[92:93], v[222:223], v[76:77] op_sel_hi:[1,0,0] neg_lo:[0,0,1] neg_hi:[0,0,1]
v_pk_fma_f32 v[94:95], v[94:95], v[222:223], v[76:77] op_sel_hi:[1,0,0] neg_lo:[0,0,1] neg_hi:[0,0,1]
v_pk_fma_f32 v[108:109], v[108:109], v[222:223], v[76:77] op_sel_hi:[1,0,0] neg_lo:[0,0,1] neg_hi:[0,0,1]
v_pk_fma_f32 v[110:111], v[110:111], v[222:223], v[76:77] op_sel_hi:[1,0,0] neg_lo:[0,0,1] neg_hi:[0,0,1]
v_pk_fma_f32 v[136:137], v[18:19], v[44:45], v[136:137] op_sel_hi:[1,0,1]
v_pk_mul_f32 v[136:137], v[136:137], v[22:23]
v_pk_fma_f32 v[138:139], v[20:21], v[44:45], v[138:139] op_sel_hi:[1,0,1]
v_pk_mul_f32 v[138:139], v[138:139], v[24:25]
v_pk_fma_f32 v[152:153], v[18:19], v[44:45], v[152:153] op_sel:[0,1,0] op_sel_hi:[1,1,1]
v_pk_mul_f32 v[152:153], v[152:153], v[22:23]
v_pk_fma_f32 v[154:155], v[20:21], v[44:45], v[154:155] op_sel:[0,1,0] op_sel_hi:[1,1,1]
v_pk_mul_f32 v[154:155], v[154:155], v[24:25]
v_exp_f32 v104, v104
s_nop 0
MAA 132,8,96
v_exp_f32 v105, v105
MAA 132,28,100
v_exp_f32 v106, v106
MAA 132,48,160
v_exp_f32 v107, v107
MAA 132,68,164
v_exp_f32 v120, v120
MAA 148,68,172
v_exp_f32 v121, v121
MAA 148,48,168
v_exp_f32 v122, v122
MAA 148,28,124
v_exp_f32 v123, v123
MAA 148,8,120
v_exp_f32 v100, v100
MAA 128,4,96
v_exp_f32 v101, v101
MAA 128,24,100
v_exp_f32 v102, v102
MAA 128,44,160
v_exp_f32 v103, v103
MAA 128,64,164
v_exp_f32 v116, v116
MAA 144,64,172
v_exp_f32 v117, v117
MAA 144,44,168
v_exp_f32 v118, v118
MAA 144,24,124
v_exp_f32 v119, v119
MAA 144,4,120
v_exp_f32 v96, v96
MAA 124,0,96
v_exp_f32 v97, v97
MAA 124,20,100
v_exp_f32 v98, v98
MAA 124,40,160
v_exp_f32 v99, v99
MAA 124,60,164
v_exp_f32 v112, v112
MAA 140,60,172
v_exp_f32 v113, v113
MAA 140,40,168
v_exp_f32 v114, v114
MAA 140,20,124
v_exp_f32 v115, v115
MAA 140,0,120
v_cvt_pk_bf16_f32 v72, v104, v105
v_cvt_pk_bf16_f32 v73, v106, v107
v_cvt_pk_bf16_f32 v74, v120, v121
v_cvt_pk_bf16_f32 v75, v122, v123
v_cvt_pk_bf16_f32 v68, v100, v101
v_cvt_pk_bf16_f32 v69, v102, v103
v_cvt_pk_bf16_f32 v70, v116, v117
v_cvt_pk_bf16_f32 v71, v118, v119
v_cvt_pk_bf16_f32 v64, v96, v97
v_cvt_pk_bf16_f32 v65, v98, v99
v_cvt_pk_bf16_f32 v66, v112, v113
v_cvt_pk_bf16_f32 v67, v114, v115
v_cvt_pk_bf16_f32 v208, v136, v137
v_cvt_pk_bf16_f32 v209, v138, v139
v_cvt_pk_bf16_f32 v218, v152, v153
v_cvt_pk_bf16_f32 v219, v154, v155
s_waitcnt lgkmcnt(5)
v_pk_fma_f32 v[132:133], v[240:241], v[44:45], v[132:133] op_sel_hi:[1,0,1]
s_waitcnt lgkmcnt(4)
v_pk_mul_f32 v[132:133], v[132:133], v[244:245]
v_cvt_pk_bf16_f32 v206, v132, v133
v_pk_fma_f32 v[134:135], v[242:243], v[44:45], v[134:135] op_sel_hi:[1,0,1]
v_pk_mul_f32 v[134:135], v[134:135], v[246:247]
v_cvt_pk_bf16_f32 v207, v134, v135
v_pk_fma_f32 v[148:149], v[240:241], v[44:45], v[148:149] op_sel:[0,1,0] op_sel_hi:[1,1,1]
v_pk_mul_f32 v[148:149], v[148:149], v[244:245]
v_cvt_pk_bf16_f32 v216, v148, v149
v_pk_fma_f32 v[150:151], v[242:243], v[44:45], v[150:151] op_sel:[0,1,0] op_sel_hi:[1,1,1]
v_pk_mul_f32 v[150:151], v[150:151], v[246:247]
v_cvt_pk_bf16_f32 v217, v150, v151
s_waitcnt lgkmcnt(3)
v_pk_fma_f32 v[128:129], v[28:29], v[44:45], v[128:129] op_sel_hi:[1,0,1]
s_waitcnt lgkmcnt(2)
v_pk_mul_f32 v[128:129], v[128:129], v[32:33]
v_cvt_pk_bf16_f32 v204, v128, v129
v_pk_fma_f32 v[130:131], v[30:31], v[44:45], v[130:131] op_sel_hi:[1,0,1]
v_pk_mul_f32 v[130:131], v[130:131], v[34:35]
v_cvt_pk_bf16_f32 v205, v130, v131
v_pk_fma_f32 v[144:145], v[28:29], v[44:45], v[144:145] op_sel:[0,1,0] op_sel_hi:[1,1,1]
v_pk_mul_f32 v[144:145], v[144:145], v[32:33]
v_cvt_pk_bf16_f32 v214, v144, v145
v_pk_fma_f32 v[146:147], v[30:31], v[44:45], v[146:147] op_sel:[0,1,0] op_sel_hi:[1,1,1]
v_pk_mul_f32 v[146:147], v[146:147], v[34:35]
v_cvt_pk_bf16_f32 v215, v146, v147
s_waitcnt lgkmcnt(1)
v_pk_fma_f32 v[124:125], v[36:37], v[44:45], v[124:125] op_sel_hi:[1,0,1]
s_waitcnt lgkmcnt(0)
v_pk_mul_f32 v[124:125], v[124:125], v[40:41]
v_cvt_pk_bf16_f32 v202, v124, v125
v_pk_fma_f32 v[126:127], v[38:39], v[44:45], v[126:127] op_sel_hi:[1,0,1]
v_pk_mul_f32 v[126:127], v[126:127], v[42:43]
v_cvt_pk_bf16_f32 v203, v126, v127
v_pk_fma_f32 v[140:141], v[36:37], v[44:45], v[140:141] op_sel:[0,1,0] op_sel_hi:[1,1,1]
v_pk_mul_f32 v[140:141], v[140:141], v[40:41]
v_cvt_pk_bf16_f32 v212, v140, v141
v_pk_fma_f32 v[142:143], v[38:39], v[44:45], v[142:143] op_sel:[0,1,0] op_sel_hi:[1,1,1]
v_pk_mul_f32 v[142:143], v[142:143], v[42:43]
v_cvt_pk_bf16_f32 v213, v142, v143
s_nop 0
v_mfma_f32_16x16x32_bf16 v[88:91], v[248:251], v[72:75], 0
v_exp_f32 v92, v92
v_mfma_f32_16x16x32_bf16 v[104:107], v[206:209], v[72:75], 0
v_exp_f32 v93, v93
v_mfma_f32_16x16x32_bf16 v[120:123], v[216:219], v[72:75], 0
v_exp_f32 v94, v94
v_mfma_f32_16x16x32_bf16 v[84:87], v[248:251], v[68:71], 0
v_exp_f32 v95, v95
v_mfma_f32_16x16x32_bf16 v[100:103], v[204:207], v[68:71], 0
v_exp_f32 v108, v108
v_mfma_f32_16x16x32_bf16 v[116:119], v[214:217], v[68:71], 0
v_exp_f32 v109, v109
v_mfma_f32_16x16x32_bf16 v[80:83], v[248:251], v[64:67], 0
v_exp_f32 v110, v110
v_mfma_f32_16x16x32_bf16 v[96:99], v[202:205], v[64:67], 0
v_exp_f32 v111, v111
v_mfma_f32_16x16x32_bf16 v[112:115], v[212:215], v[64:67], 0
v_cvt_pk_bf16_f32 v60, v92, v93
v_cvt_pk_bf16_f32 v61, v94, v95
v_cvt_pk_bf16_f32 v62, v108, v109
v_cvt_pk_bf16_f32 v63, v110, v111
v_rcp_f32 v88, v88
v_rcp_f32 v84, v84
v_mfma_f32_16x16x32_bf16 v[76:79], v[248:251], v[60:63], 0
v_rcp_f32 v80, v80
v_mfma_f32_16x16x32_bf16 v[92:95], v[200:203], v[60:63], 0
v_mfma_f32_16x16x32_bf16 v[108:111], v[210:213], v[60:63], 0
s_nop 4
v_rcp_f32 v76, v76
v_pk_mul_f32 v[104:105], v[104:105], v[88:89] op_sel_hi:[1,0]
v_pk_mul_f32 v[106:107], v[106:107], v[88:89] op_sel_hi:[1,0]
v_pk_mul_f32 v[120:121], v[120:121], v[88:89] op_sel_hi:[1,0]
v_pk_mul_f32 v[122:123], v[122:123], v[88:89] op_sel_hi:[1,0]
v_cvt_pk_bf16_f32 v176, v104, v105
v_cvt_pk_bf16_f32 v177, v106, v107
v_cvt_pk_bf16_f32 v178, v120, v121
v_cvt_pk_bf16_f32 v179, v122, v123
buffer_store_dwordx4 v[176:179], v4, s[16:19], s74 offen offset:3072 sc1
v_pk_mul_f32 v[100:101], v[100:101], v[84:85] op_sel_hi:[1,0]
v_pk_mul_f32 v[102:103], v[102:103], v[84:85] op_sel_hi:[1,0]
v_pk_mul_f32 v[116:117], v[116:117], v[84:85] op_sel_hi:[1,0]
v_pk_mul_f32 v[118:119], v[118:119], v[84:85] op_sel_hi:[1,0]
v_cvt_pk_bf16_f32 v172, v100, v101
v_cvt_pk_bf16_f32 v173, v102, v103
v_cvt_pk_bf16_f32 v174, v116, v117
v_cvt_pk_bf16_f32 v175, v118, v119
buffer_store_dwordx4 v[172:175], v4, s[16:19], s74 offen offset:2048 sc1
v_pk_mul_f32 v[96:97], v[96:97], v[80:81] op_sel_hi:[1,0]
v_pk_mul_f32 v[98:99], v[98:99], v[80:81] op_sel_hi:[1,0]
v_pk_mul_f32 v[112:113], v[112:113], v[80:81] op_sel_hi:[1,0]
v_pk_mul_f32 v[114:115], v[114:115], v[80:81] op_sel_hi:[1,0]
v_cvt_pk_bf16_f32 v168, v96, v97
v_cvt_pk_bf16_f32 v169, v98, v99
v_cvt_pk_bf16_f32 v170, v112, v113
v_cvt_pk_bf16_f32 v171, v114, v115
buffer_store_dwordx4 v[168:171], v4, s[16:19], s74 offen offset:1024 sc1
v_pk_mul_f32 v[92:93], v[92:93], v[76:77] op_sel_hi:[1,0]
v_pk_mul_f32 v[94:95], v[94:95], v[76:77] op_sel_hi:[1,0]
v_pk_mul_f32 v[108:109], v[108:109], v[76:77] op_sel_hi:[1,0]
v_pk_mul_f32 v[110:111], v[110:111], v[76:77] op_sel_hi:[1,0]
v_cvt_pk_bf16_f32 v164, v92, v93
v_cvt_pk_bf16_f32 v165, v94, v95
v_cvt_pk_bf16_f32 v166, v108, v109
v_cvt_pk_bf16_f32 v167, v110, v111
buffer_store_dwordx4 v[164:167], v4, s[16:19], s74 offen sc1
s_nop 1
.Lqkve2:
s_mov_b32 s36, s0
s_mov_b32 s37, s1
s_lshl_b32 s62, s3, 11
s_add_u32 s62, s62, s84
v_lshl_add_u32 v4, v1, 4, s62
v_lshrrev_b32 v2, 3, v1
v_cmp_eq_u32 vcc, 3, v2
v_add_u32 v2, 67108480, v4
s_nop 0
v_cndmask_b32 v4, v4, v2, vcc
v_bfe_u32 v8, v1, 3, 2
v_mul_u32_u24 v8, 2080, v8
v_bfe_u32 v2, v1, 2, 1
v_lshl_add_u32 v8, v2, 7, v8
v_bfe_u32 v2, v1, 5, 1
v_lshl_add_u32 v8, v2, 8, v8
v_and_b32 v2, 3, v1
v_lshl_add_u32 v8, v2, 3, v8
s_mov_b32 s57, 66560
v_add_u32 v7, s57, v8
s_lshr_b32 s54, s87, 17
s_lshl_b32 s54, s54, 18
s_add_u32 s54, s54, 4194304
s_mov_b32 s52, s54
s_add_u32 s53, s54, 131072
v_accvgpr_read_b32 v32, a224
v_accvgpr_read_b32 v33, a225
v_accvgpr_read_b32 v34, a226
v_accvgpr_read_b32 v35, a227
v_accvgpr_read_b32 v36, a228
v_accvgpr_read_b32 v37, a229
v_accvgpr_read_b32 v38, a230
v_accvgpr_read_b32 v39, a231
v_accvgpr_read_b32 v40, a232
v_accvgpr_read_b32 v41, a233
v_accvgpr_read_b32 v42, a234
v_accvgpr_read_b32 v43, a235
v_accvgpr_read_b32 v44, a236
v_accvgpr_read_b32 v45, a237
v_accvgpr_read_b32 v46, a238
v_accvgpr_read_b32 v47, a239
v_accvgpr_read_b32 v48, a240
v_accvgpr_read_b32 v49, a241
v_accvgpr_read_b32 v50, a242
v_accvgpr_read_b32 v51, a243
v_accvgpr_read_b32 v52, a244
v_accvgpr_read_b32 v53, a245
v_accvgpr_read_b32 v54, a246
v_accvgpr_read_b32 v55, a247
v_accvgpr_read_b32 v56, a248
v_accvgpr_read_b32 v57, a249
v_accvgpr_read_b32 v58, a250
v_accvgpr_read_b32 v59, a251
v_accvgpr_read_b32 v60, a252
v_accvgpr_read_b32 v61, a253
v_accvgpr_read_b32 v62, a254
v_accvgpr_read_b32 v63, a255
s_lshl_b32 s62, s8, 10
s_add_u32 s62, s62, 30425088
s_lshl_b32 s64, s6, 10
s_add_u32 s64, s64, 30425088
s_lshr_b32 s67, s5, 2
s_and_b32 s67, s67, 3
s_lshl_b32 s67, s67, 7
s_add_u32 s64, s64, s67
v_lshl_add_u32 v252, v1, 7, s62
v_mov_b32 v253, s64
v_mov_b32 v255, 1
s_waitcnt vmcnt(0) lgkmcnt(0)
s_cmp_lg_u32 s3, 1
s_barrier
s_cbranch_scc1 .Lfirst35
s_mov_b64 exec, 15
buffer_atomic_add v255, v252, s[16:19], 0 offen
s_mov_b64 exec, 1
v_mov_b32 v254, 0
buffer_atomic_add v254, v253, s[16:19], 0 offen sc0
s_mov_b64 exec, -1
.Lfirst35:
s_add_u32 m0, s59, 66560
s_xor_b32 s58, s87, 0
buffer_load_dwordx4 v5, s[24:27], s58 offen lds
buffer_load_dwordx4 v6, s[24:27], s58 offen offset:1024 lds
s_add_u32 m0, s59, 116480
s_xor_b32 s58, s87, 786432
buffer_load_dwordx4 v5, s[24:27], s58 offen lds
buffer_load_dwordx4 v6, s[24:27], s58 offen offset:1024 lds
s_add_u32 m0, s59, 124800
s_xor_b32 s58, s87, 917504
buffer_load_dwordx4 v5, s[24:27], s58 offen lds
buffer_load_dwordx4 v6, s[24:27], s58 offen offset:1024 lds
s_add_u32 m0, s59, 49920
s_xor_b32 s58, s87, 1835008
buffer_load_dwordx4 v5, s[24:27], s58 offen lds
buffer_load_dwordx4 v6, s[24:27], s58 offen offset:1024 lds
s_add_u32 m0, s59, 58240
s_xor_b32 s58, s87, 1966080
buffer_load_dwordx4 v5, s[24:27], s58 offen lds
buffer_load_dwordx4 v6, s[24:27], s58 offen offset:1024 lds
s_cmp_lg_u32 s3, 1
s_cbranch_scc1 .Lnopoll34
s_mov_b64 exec, 1
s_mov_b32 s15, 0
v_mov_b32 v255, 0
buffer_atomic_add v255, v253, s[16:19], 0 offen sc0
s_waitcnt vmcnt(11)
v_cmp_gt_u32 vcc, 16, v254
s_nop 0
s_cbranch_vccz .Lnopoll34r
.Lpoll33:
s_waitcnt vmcnt(0)
v_cmp_gt_u32 vcc, 16, v255
s_add_u32 s15, s15, 1
s_cbranch_vccz .Lnopoll34r
v_mov_b32 v255, 0
buffer_atomic_add v255, v253, s[16:19], 0 offen sc0
s_cmp_le_u32 s15, 100000
s_cbranch_scc1 .Lpoll33
s_branch .Lnopoll34r
.Lnopoll34:
s_mov_b64 exec, 0
s_cmp_eq_u32 s3, 2
s_cbranch_scc1 .Lpad10
s_cmp_eq_u32 s3, 3
s_cbranch_scc1 .Lpad11
s_branch .Lpad12
.Lnopoll34r:
s_mov_b64 exec, -1
s_waitcnt vmcnt(8)
s_barrier
buffer_load_dwordx4 v[64:67], v4, s[16:19], s52 offen sc1
buffer_load_dwordx4 v[68:71], v4, s[16:19], s52 offen offset:1024 sc1
s_xor_b32 s52, s54, 262144
buffer_load_dwordx4 v[72:75], v4, s[16:19], s53 offen sc1
buffer_load_dwordx4 v[76:79], v4, s[16:19], s53 offen offset:1024 sc1
s_xor_b32 s53, s54, 393216
buffer_load_dwordx4 v[80:83], v4, s[16:19], s52 offen sc1
buffer_load_dwordx4 v[84:87], v4, s[16:19], s52 offen offset:1024 sc1
s_xor_b32 s52, s54, 524288
buffer_load_dwordx4 v[88:91], v4, s[16:19], s53 offen sc1
buffer_load_dwordx4 v[92:95], v4, s[16:19], s53 offen offset:1024 sc1
s_xor_b32 s53, s54, 655360
buffer_load_dwordx4 v[96:99], v4, s[16:19], s52 offen sc1
buffer_load_dwordx4 v[100:103], v4, s[16:19], s52 offen offset:1024 sc1
s_xor_b32 s52, s54, 786432
buffer_load_dwordx4 v[104:107], v4, s[16:19], s53 offen sc1
buffer_load_dwordx4 v[108:111], v4, s[16:19], s53 offen offset:1024 sc1
s_xor_b32 s53, s54, 917504
ds_read_b64_tr_b16 a[0:1], v7
TR 2,7,512
TR 16,7,1024
TR 18,7,1536
TR 4,7,32
TR 6,7,544
TR 20,7,1056
TR 22,7,1568
TR 8,7,64
TR 10,7,576
TR 24,7,1088
TR 26,7,1600
TR 12,7,96
TR 14,7,608
TR 28,7,1120
TR 30,7,1632
s_lshl_b32 s62, s49, 3
s_add_u32 s62, s62, s48
s_mul_i32 s62, s62, 28672
s_add_u32 s62, s62, s51
v_lshrrev_b32 v12, 4, v1
v_mul_u32_u24 v12, 57344, v12
v_and_b32 v2, 15, v1
v_lshl_add_u32 v12, v2, 4, v12
v_add_u32 v12, s62, v12
v_add_u32 v13, 6112, v12
v_add_u32 v14, 12224, v12
v_add_u32 v15, 18336, v12
s_mul_i32 s59, s3, 4224
s_mov_b32 s58, 0
s_waitcnt vmcnt(8) lgkmcnt(14)
MAV 32,0,64
TR 32,7,8320
s_waitcnt lgkmcnt(13)
MAV 32,16,72
buffer_load_dwordx4 v[112:115], v4, s[16:19], s52 offen sc1
MAV 48,16,76
TR 34,7,8832
MAV 48,0,68
TR 48,7,9344
TR 50,7,9856
s_waitcnt lgkmcnt(14)
MAV 52,4,68
TR 36,7,8352
s_waitcnt lgkmcnt(13)
MAV 52,20,76
buffer_load_dwordx4 v[116:119], v4, s[16:19], s52 offen offset:1024 sc1
MAV 36,20,72
TR 38,7,8864
s_xor_b32 s52, s54, 1048576
MAV 36,4,64
TR 52,7,9376
TR 54,7,9888
s_waitcnt lgkmcnt(14)
MAV 40,8,64
TR 40,7,8384
s_waitcnt lgkmcnt(13)
MAV 40,24,72
buffer_load_dwordx4 v[120:123], v4, s[16:19], s53 offen sc1
MAV 56,24,76
TR 42,7,8896
MAV 56,8,68
TR 56,7,9408
TR 58,7,9920
s_waitcnt lgkmcnt(14)
MAV 60,12,68
TR 44,7,8416
s_waitcnt lgkmcnt(13)
MAV 60,28,76
buffer_load_dwordx4 v[124:127], v4, s[16:19], s53 offen offset:1024 sc1
MAV 44,28,72
TR 46,7,8928
s_xor_b32 s53, s54, 1179648
MAV 44,12,64
TR 60,7,9440
TR 62,7,9952
s_waitcnt vmcnt(8) lgkmcnt(8)
MAV 32,32,80
TR 0,7,16640
MAV 32,48,88
buffer_load_dwordx4 v[64:67], v4, s[16:19], s52 offen sc1
MAV 48,48,92
TR 2,7,17152
MAV 48,32,84
TR 16,7,17664
TR 18,7,18176
MAV 52,36,84
TR 4,7,16672
MAV 52,52,92
buffer_load_dwordx4 v[68:71], v4, s[16:19], s52 offen offset:1024 sc1
MAV 36,52,88
TR 6,7,17184
s_xor_b32 s52, s54, 1310720
MAV 36,36,80
TR 20,7,17696
TR 22,7,18208
s_waitcnt lgkmcnt(8)
MAV 40,40,80
TR 8,7,16704
MAV 40,56,88
buffer_load_dwordx4 v[72:75], v4, s[16:19], s53 offen sc1
MAV 56,56,92
TR 10,7,17216
MAV 56,40,84
TR 24,7,17728
TR 26,7,18240
MAV 60,44,84
TR 12,7,16736
MAV 60,60,92
buffer_load_dwordx4 v[76:79], v4, s[16:19], s53 offen offset:1024 sc1
MAV 44,60,88
TR 14,7,17248
s_xor_b32 s53, s54, 1441792
MAV 44,44,80
TR 28,7,17760
TR 30,7,18272
s_waitcnt vmcnt(8) lgkmcnt(8)
MAV 32,0,96
TR 32,7,24960
MAV 32,16,104
buffer_load_dwordx4 v[80:83], v4, s[16:19], s52 offen sc1
MAV 48,16,108
TR 34,7,25472
MAV 48,0,100
TR 48,7,25984
TR 50,7,26496
MAV 52,4,100
TR 36,7,24992
MAV 52,20,108
buffer_load_dwordx4 v[84:87], v4, s[16:19], s52 offen offset:1024 sc1
MAV 36,20,104
TR 38,7,25504
s_xor_b32 s52, s54, 1572864
MAV 36,4,96
TR 52,7,26016
TR 54,7,26528
s_waitcnt lgkmcnt(8)
MAV 40,8,96
TR 40,7,25024
MAV 40,24,104
buffer_load_dwordx4 v[88:91], v4, s[16:19], s53 offen sc1
MAV 56,24,108
TR 42,7,25536
MAV 56,8,100
TR 56,7,26048
TR 58,7,26560
MAV 60,12,100
TR 44,7,25056
MAV 60,28,108
buffer_load_dwordx4 v[92:95], v4, s[16:19], s53 offen offset:1024 sc1
MAV 44,28,104
TR 46,7,25568
s_xor_b32 s53, s54, 1703936
MAV 44,12,96
TR 60,7,26080
TR 62,7,26592
s_barrier
s_waitcnt vmcnt(8) lgkmcnt(8)
MAV 32,32,112
TR 0,7,33280
MAV 32,48,120
buffer_load_dwordx4 v[96:99], v4, s[16:19], s52 offen sc1
MAV 48,48,124
TR 2,7,33792
MAV 48,32,116
TR 16,7,34304
.Lpad10:
s_cbranch_execz .Lpad13
TR 18,7,34816
MAV 52,36,116
TR 4,7,33312
MAV 52,52,124
buffer_load_dwordx4 v[100:103], v4, s[16:19], s52 offen offset:1024 sc1
MAV 36,52,120
TR 6,7,33824
s_xor_b32 s52, s54, 1835008
MAV 36,36,112
TR 20,7,34336
TR 22,7,34848
s_waitcnt lgkmcnt(8)
MAV 40,40,112
TR 8,7,33344
MAV 40,56,120
buffer_load_dwordx4 v[104:107], v4, s[16:19], s53 offen sc1
MAV 56,56,124
TR 10,7,33856
MAV 56,40,116
TR 24,7,34368
TR 26,7,34880
MAV 60,44,116
TR 12,7,33376
MAV 60,60,124
buffer_load_dwordx4 v[108:111], v4, s[16:19], s53 offen offset:1024 sc1
MAV 44,60,120
TR 14,7,33888
s_xor_b32 s53, s54, 1966080
MAV 44,44,112
TR 28,7,34400
TR 30,7,34912
s_waitcnt vmcnt(8) lgkmcnt(8)
MAV 32,0,64
TR 32,7,41600
MAV 32,16,72
buffer_load_dwordx4 v[112:115], v4, s[16:19], s52 offen sc1
MAV 48,16,76
TR 34,7,42112
MAV 48,0,68
TR 48,7,42624
TR 50,7,43136
MAV 52,4,68
TR 36,7,41632
MAV 52,20,76
buffer_load_dwordx4 v[116:119], v4, s[16:19], s52 offen offset:1024 sc1
MAV 36,20,72
TR 38,7,42144
s_xor_b32 s52, s54, 2097152
MAV 36,4,64
TR 52,7,42656
TR 54,7,43168
s_waitcnt lgkmcnt(8)
MAV 40,8,64
TR 40,7,41664
MAV 40,24,72
buffer_load_dwordx4 v[120:123], v4, s[16:19], s53 offen sc1
MAV 56,24,76
TR 42,7,42176
MAV 56,8,68
TR 56,7,42688
TR 58,7,43200
MAV 60,12,68
TR 44,7,41696
MAV 60,28,76
buffer_load_dwordx4 v[124:127], v4, s[16:19], s53 offen offset:1024 sc1
MAV 44,28,72
TR 46,7,42208
s_xor_b32 s53, s54, 2228224
MAV 44,12,64
TR 60,7,42720
TR 62,7,43232
s_waitcnt vmcnt(8) lgkmcnt(8)
MAV 32,32,80
TR 0,7,49920
MAV 32,48,88
buffer_load_dwordx4 v[64:67], v4, s[16:19], s52 offen sc1
MAV 48,48,92
TR 2,7,50432
MAV 48,32,84
TR 16,7,50944
TR 18,7,51456
MAV 52,36,84
TR 4,7,49952
MAV 52,52,92
buffer_load_dwordx4 v[68:71], v4, s[16:19], s52 offen offset:1024 sc1
MAV 36,52,88
TR 6,7,50464
s_xor_b32 s52, s54, 2359296
MAV 36,36,80
TR 20,7,50976
TR 22,7,51488
s_waitcnt lgkmcnt(8)
MAV 40,40,80
TR 8,7,49984
MAV 40,56,88
buffer_load_dwordx4 v[72:75], v4, s[16:19], s53 offen sc1
MAV 56,56,92
TR 10,7,50496
MAV 56,40,84
TR 24,7,51008
TR 26,7,51520
MAV 60,44,84
TR 12,7,50016
MAV 60,60,92
buffer_load_dwordx4 v[76:79], v4, s[16:19], s53 offen offset:1024 sc1
MAV 44,60,88
TR 14,7,50528
s_xor_b32 s53, s54, 2490368
MAV 44,44,80
TR 28,7,51040
TR 30,7,51552
s_waitcnt vmcnt(8) lgkmcnt(8)
MAV 32,0,96
TR 32,7,58240
MAV 32,16,104
buffer_load_dwordx4 v[80:83], v4, s[16:19], s52 offen sc1
MAV 48,16,108
TR 34,7,58752
MAV 48,0,100
TR 48,7,59264
TR 50,7,59776
MAV 52,4,100
TR 36,7,58272
MAV 52,20,108
buffer_load_dwordx4 v[84:87], v4, s[16:19], s52 offen offset:1024 sc1
MAV 36,20,104
TR 38,7,58784
s_xor_b32 s52, s54, 2621440
MAV 36,4,96
TR 52,7,59296
TR 54,7,59808
s_waitcnt lgkmcnt(8)
MAV 40,8,96
TR 40,7,58304
MAV 40,24,104
buffer_load_dwordx4 v[88:91], v4, s[16:19], s53 offen sc1
MAV 56,24,108
TR 42,7,58816
MAV 56,8,100
TR 56,7,59328
TR 58,7,59840
MAV 60,12,100
TR 44,7,58336
MAV 60,28,108
buffer_load_dwordx4 v[92:95], v4, s[16:19], s53 offen offset:1024 sc1
MAV 44,28,104
TR 46,7,58848
s_xor_b32 s53, s54, 2752512
MAV 44,12,96
TR 60,7,59360
TR 62,7,59872
s_xor_b32 s57, s57, 66560
v_add_u32 v7, s57, v8
s_waitcnt vmcnt(8) lgkmcnt(8)
MAV 32,32,112
ds_read_b64_tr_b16 a[0:1], v7
MAV 32,48,120
buffer_load_dwordx4 v[96:99], v4, s[16:19], s52 offen sc1
MAV 48,48,124
TR 2,7,512
MAV 48,32,116
TR 16,7,1024
TR 18,7,1536
MAV 52,36,116
TR 4,7,32
MAV 52,52,124
buffer_load_dwordx4 v[100:103], v4, s[16:19], s52 offen offset:1024 sc1
MAV 36,52,120
TR 6,7,544
s_xor_b32 s52, s54, 2883584
MAV 36,36,112
TR 20,7,1056
TR 22,7,1568
s_waitcnt lgkmcnt(8)
MAV 40,40,112
TR 8,7,64
MAV 40,56,120
buffer_load_dwordx4 v[104:107], v4, s[16:19], s53 offen sc1
MAV 56,56,124
TR 10,7,576
MAV 56,40,116
TR 24,7,1088
TR 26,7,1600
MAV 60,44,116
TR 12,7,96
MAV 60,60,124
buffer_load_dwordx4 v[108:111], v4, s[16:19], s53 offen offset:1024 sc1
MAV 44,60,120
TR 14,7,608
s_xor_b32 s53, s54, 3014656
MAV 44,44,112
TR 28,7,1120
TR 30,7,1632
s_waitcnt vmcnt(8) lgkmcnt(8)
MAV 32,0,64
TR 32,7,8320
MAV 32,16,72
buffer_load_dwordx4 v[112:115], v4, s[16:19], s52 offen sc1
MAV 48,16,76
TR 34,7,8832
MAV 48,0,68
TR 48,7,9344
TR 50,7,9856
MAV 52,4,68
TR 36,7,8352
MAV 52,20,76
buffer_load_dwordx4 v[116:119], v4, s[16:19], s52 offen offset:1024 sc1
MAV 36,20,72
TR 38,7,8864
s_xor_b32 s52, s54, 3145728
MAV 36,4,64
TR 52,7,9376
TR 54,7,9888
s_waitcnt lgkmcnt(8)
MAV 40,8,64
TR 40,7,8384
MAV 40,24,72
buffer_load_dwordx4 v[120:123], v4, s[16:19], s53 offen sc1
MAV 56,24,76
TR 42,7,8896
MAV 56,8,68
TR 56,7,9408
TR 58,7,9920
MAV 60,12,68
TR 44,7,8416
MAV 60,28,76
buffer_load_dwordx4 v[124:127], v4, s[16:19], s53 offen offset:1024 sc1
MAV 44,28,72
TR 46,7,8928
s_xor_b32 s53, s54, 3276800
MAV 44,12,64
TR 60,7,9440
TR 62,7,9952
s_waitcnt vmcnt(8) lgkmcnt(8)
MAV 32,32,80
TR 0,7,16640
MAV 32,48,88
buffer_load_dwordx4 v[64:67], v4, s[16:19], s52 offen sc1
MAV 48,48,92
TR 2,7,17152
MAV 48,32,84
TR 16,7,17664
TR 18,7,18176
MAV 52,36,84
TR 4,7,16672
MAV 52,52,92
buffer_load_dwordx4 v[68:71], v4, s[16:19], s52 offen offset:1024 sc1
MAV 36,52,88
TR 6,7,17184
s_xor_b32 s52, s54, 3407872
MAV 36,36,80
TR 20,7,17696
TR 22,7,18208
s_waitcnt lgkmcnt(8)
MAV 40,40,80
TR 8,7,16704
MAV 40,56,88
buffer_load_dwordx4 v[72:75], v4, s[16:19], s53 offen sc1
MAV 56,56,92
TR 10,7,17216
MAV 56,40,84
TR 24,7,17728
TR 26,7,18240
MAV 60,44,84
TR 12,7,16736
MAV 60,60,92
buffer_load_dwordx4 v[76:79], v4, s[16:19], s53 offen offset:1024 sc1
MAV 44,60,88
TR 14,7,17248
s_xor_b32 s53, s54, 3538944
MAV 44,44,80
TR 28,7,17760
TR 30,7,18272
s_waitcnt vmcnt(8) lgkmcnt(8)
MAV 32,0,96
TR 32,7,24960
MAV 32,16,104
buffer_load_dwordx4 v[80:83], v4, s[16:19], s52 offen sc1
MAV 48,16,108
TR 34,7,25472
MAV 48,0,100
TR 48,7,25984
TR 50,7,26496
MAV 52,4,100
TR 36,7,24992
MAV 52,20,108
buffer_load_dwordx4 v[84:87], v4, s[16:19], s52 offen offset:1024 sc1
MAV 36,20,104
TR 38,7,25504
s_xor_b32 s52, s54, 3670016
MAV 36,4,96
TR 52,7,26016
TR 54,7,26528
s_waitcnt lgkmcnt(8)
MAV 40,8,96
TR 40,7,25024
MAV 40,24,104
buffer_load_dwordx4 v[88:91], v4, s[16:19], s53 offen sc1
MAV 56,24,108
TR 42,7,25536
MAV 56,8,100
TR 56,7,26048
TR 58,7,26560
MAV 60,12,100
TR 44,7,25056
MAV 60,28,108
buffer_load_dwordx4 v[92:95], v4, s[16:19], s53 offen offset:1024 sc1
MAV 44,28,104
TR 46,7,25568
s_xor_b32 s53, s54, 3801088
MAV 44,12,96
TR 60,7,26080
TR 62,7,26592
s_waitcnt vmcnt(8) lgkmcnt(8)
MAV 32,32,112
TR 0,7,33280
MAV 32,48,120
buffer_load_dwordx4 v[96:99], v4, s[16:19], s52 offen sc1
MAV 48,48,124
TR 2,7,33792
MAV 48,32,116
TR 16,7,34304
TR 18,7,34816
MAV 52,36,116
TR 4,7,33312
MAV 52,52,124
buffer_load_dwordx4 v[100:103], v4, s[16:19], s52 offen offset:1024 sc1
MAV 36,52,120
TR 6,7,33824
s_xor_b32 s52, s54, 3932160
MAV 36,36,112
TR 20,7,34336
TR 22,7,34848
s_waitcnt lgkmcnt(8)
MAV 40,40,112
TR 8,7,33344
MAV 40,56,120
buffer_load_dwordx4 v[104:107], v4, s[16:19], s53 offen sc1
MAV 56,56,124
TR 10,7,33856
MAV 56,40,116
TR 24,7,34368
TR 26,7,34880
MAV 60,44,116
TR 12,7,33376
MAV 60,60,124
buffer_load_dwordx4 v[108:111], v4, s[16:19], s53 offen offset:1024 sc1
MAV 44,60,120
TR 14,7,33888
s_xor_b32 s53, s54, 4063232
MAV 44,44,112
TR 28,7,34400
TR 30,7,34912
s_waitcnt vmcnt(8) lgkmcnt(8)
MAV 32,0,64
TR 32,7,41600
MAV 32,16,72
buffer_load_dwordx4 v[112:115], v4, s[16:19], s52 offen sc1
MAV 48,16,76
TR 34,7,42112
MAV 48,0,68
TR 48,7,42624
TR 50,7,43136
MAV 52,4,68
TR 36,7,41632
MAV 52,20,76
buffer_load_dwordx4 v[116:119], v4, s[16:19], s52 offen offset:1024 sc1
MAV 36,20,72
TR 38,7,42144
MAV 36,4,64
TR 52,7,42656
TR 54,7,43168
s_waitcnt lgkmcnt(8)
MAV 40,8,64
TR 40,7,41664
MAV 40,24,72
buffer_load_dwordx4 v[120:123], v4, s[16:19], s53 offen sc1
MAV 56,24,76
TR 42,7,42176
MAV 56,8,68
TR 56,7,42688
TR 58,7,43200
MAV 60,12,68
TR 44,7,41696
MAV 60,28,76
buffer_load_dwordx4 v[124:127], v4, s[16:19], s53 offen offset:1024 sc1
MAV 44,28,72
TR 46,7,42208
MAV 44,12,64
TR 60,7,42720
TR 62,7,43232
s_barrier
s_waitcnt vmcnt(8) lgkmcnt(8)
MAV 32,32,80
TR 0,7,49920
s_add_u32 m0, s59, 84480
MAV 32,48,88
buffer_load_dwordx4 v12, s[32:35], s58 offen lds
MAV 48,48,92
TR 2,7,50432
MAV 48,32,84
TR 16,7,50944
TR 18,7,51456
MAV 52,36,84
TR 4,7,49952
MAV 52,52,92
TR 6,7,50464
TR 20,7,50976
MAV 36,52,88
TR 22,7,51488
MAV 36,36,80
TR 8,7,49984
s_waitcnt lgkmcnt(9)
MAV 40,40,80
TR 10,7,50496
MAV 40,56,88
buffer_load_dwordx4 v13, s[32:35], s58 offen offset:1056 lds
MAV 56,56,92
TR 24,7,51008
MAV 56,40,84
buffer_load_dwordx4 v14, s[32:35], s58 offen offset:2112 lds
MAV 60,44,84
TR 26,7,51520
MAV 60,60,92
TR 12,7,50016
TR 14,7,50528
MAV 44,60,88
TR 28,7,51040
MAV 44,44,80
TR 30,7,51552
s_waitcnt vmcnt(7) lgkmcnt(8)
MAV 32,0,96
TR 32,7,58240
MAV 32,16,104
buffer_load_dwordx4 v15, s[32:35], s58 offen offset:3168 lds
MAV 48,16,108
TR 34,7,58752
MAV 48,0,100
TR 48,7,59264
TR 50,7,59776
MAV 52,4,100
TR 36,7,58272
MAV 52,20,108
TR 38,7,58784
TR 52,7,59296
MAV 36,20,104
TR 54,7,59808
MAV 36,4,96
TR 40,7,58304
s_waitcnt lgkmcnt(9)
MAV 40,8,96
TR 42,7,58816
s_add_u32 m0, s59, 101376
MAV 40,24,104
buffer_load_dwordx4 v12, s[80:83], s58 offen lds
MAV 56,24,108
TR 56,7,59328
MAV 56,8,100
buffer_load_dwordx4 v13, s[80:83], s58 offen offset:1056 lds
MAV 60,12,100
TR 58,7,59840
MAV 60,28,108
TR 44,7,58336
TR 46,7,58848
MAV 44,28,104
TR 60,7,59360
MAV 44,12,96
TR 62,7,59872
s_waitcnt vmcnt(9) lgkmcnt(14)
MAV 32,32,112
buffer_load_dwordx4 v14, s[80:83], s58 offen offset:2112 lds
s_waitcnt vmcnt(8) lgkmcnt(12)
MAV 32,48,120
s_lshl_b32 s64, s6, 14
s_lshl_b32 s65, s49, 13
s_add_u32 s64, s64, s65
s_waitcnt vmcnt(7)
MAV 48,48,124
s_lshl_b32 s65, s7, 9
s_add_u32 s64, s64, s65
s_lshl_b32 s65, s48, 8
MAV 48,32,116
s_add_u32 s64, s64, s65
s_add_u32 s64, s64, 29622272
v_and_b32 v152, 31, v1
s_waitcnt lgkmcnt(10)
MAV 52,36,116
buffer_load_dwordx4 v15, s[80:83], s58 offen offset:3168 lds
s_waitcnt lgkmcnt(8)
MAV 52,52,124
s_add_u32 s58, s58, 458752
v_lshlrev_b32 v152, 3, v152
v_lshrrev_b32 v153, 5, v1
MAV 36,52,120
s_lshl_b32 s62, s7, 18
v_lshl_add_u32 v152, v153, 28, v152
s_add_u32 s62, s62, 8388608
MAV 36,36,112
s_add_u32 s63, s62, 131072
v_cvt_pk_bf16_f32 v128, v32, v33
v_cvt_pk_bf16_f32 v129, v34, v35
s_waitcnt lgkmcnt(6)
MAV 40,40,112
v_cvt_pk_bf16_f32 v136, v48, v49
v_cvt_pk_bf16_f32 v137, v50, v51
s_waitcnt lgkmcnt(4)
MAV 40,56,120
v_cvt_pk_bf16_f32 v130, v36, v37
v_cvt_pk_bf16_f32 v131, v38, v39
MAV 56,56,124
buffer_store_dwordx4 v[128:131], v4, s[16:19], s62 offen sc1
MAV 56,40,116
v_cvt_pk_bf16_f32 v138, v52, v53
v_cvt_pk_bf16_f32 v139, v54, v55
s_waitcnt lgkmcnt(2)
MAV 60,44,116
v_cvt_pk_bf16_f32 v132, v40, v41
v_cvt_pk_bf16_f32 v133, v42, v43
s_waitcnt lgkmcnt(0)
MAV 60,60,124
v_cvt_pk_bf16_f32 v140, v56, v57
MAV 44,60,120
buffer_store_dwordx4 v[136:139], v4, s[16:19], s62 offen offset:1024 sc1
MAV 44,44,112
v_cvt_pk_bf16_f32 v141, v58, v59
s_nop 2
v_cvt_pk_bf16_f32 v142, v60, v61
v_pk_mul_f32 v[146:147], v[32:33], v[32:33]
v_pk_mul_f32 v[150:151], v[48:49], v[48:49]
v_cvt_pk_bf16_f32 v143, v62, v63
v_pk_fma_f32 v[146:147], v[34:35], v[34:35], v[146:147]
v_pk_add_f32 v[144:145], v[32:33], v[34:35]
v_pk_fma_f32 v[150:151], v[50:51], v[50:51], v[150:151]
v_cvt_pk_bf16_f32 v134, v44, v45
v_cvt_pk_bf16_f32 v135, v46, v47
.Lpad11:
s_cbranch_execz .Lpad14
buffer_store_dwordx4 v[132:135], v4, s[16:19], s63 offen sc1
v_pk_add_f32 v[148:149], v[48:49], v[50:51]
v_pk_fma_f32 v[146:147], v[36:37], v[36:37], v[146:147]
v_pk_add_f32 v[144:145], v[144:145], v[36:37]
v_pk_fma_f32 v[150:151], v[52:53], v[52:53], v[150:151]
v_pk_add_f32 v[148:149], v[148:149], v[52:53]
v_pk_fma_f32 v[146:147], v[38:39], v[38:39], v[146:147]
v_pk_add_f32 v[144:145], v[144:145], v[38:39]
v_pk_fma_f32 v[150:151], v[54:55], v[54:55], v[150:151]
v_pk_add_f32 v[148:149], v[148:149], v[54:55]
v_pk_fma_f32 v[146:147], v[40:41], v[40:41], v[146:147]
v_pk_add_f32 v[144:145], v[144:145], v[40:41]
v_pk_fma_f32 v[150:151], v[56:57], v[56:57], v[150:151]
v_pk_add_f32 v[148:149], v[148:149], v[56:57]
buffer_store_dwordx4 v[140:143], v4, s[16:19], s63 offen offset:1024 sc1
v_pk_fma_f32 v[146:147], v[42:43], v[42:43], v[146:147]
v_pk_add_f32 v[144:145], v[144:145], v[42:43]
v_pk_fma_f32 v[150:151], v[58:59], v[58:59], v[150:151]
v_pk_add_f32 v[148:149], v[148:149], v[58:59]
v_pk_fma_f32 v[146:147], v[44:45], v[44:45], v[146:147]
v_pk_add_f32 v[144:145], v[144:145], v[44:45]
v_pk_fma_f32 v[150:151], v[60:61], v[60:61], v[150:151]
v_pk_add_f32 v[148:149], v[148:149], v[60:61]
v_pk_fma_f32 v[146:147], v[46:47], v[46:47], v[146:147]
v_pk_add_f32 v[144:145], v[144:145], v[46:47]
v_pk_fma_f32 v[150:151], v[62:63], v[62:63], v[150:151]
v_pk_add_f32 v[148:149], v[148:149], v[62:63]
v_add_f32 v144, v144, v145
v_add_f32 v146, v146, v147
v_add_f32 v148, v148, v149
v_add_f32 v150, v150, v151
s_nop 0
v_permlane16_swap_b32 v144, v148
v_permlane16_swap_b32 v146, v150
v_add_f32 v144, v144, v148
v_add_f32 v146, v146, v150
s_nop 1
v_permlane32_swap_b32 v144, v146
v_add_f32 v144, v144, v146
s_nop 1
v_permlane32_swap_b32 v144, v145
buffer_store_dwordx2 v[144:145], v152, s[16:19], s64 offen sc1
s_nop 1
s_mov_b32 s54, s58
s_mov_b32 s55, s59
v_accvgpr_write_b32 a224, v32
v_accvgpr_write_b32 a225, v33
v_accvgpr_write_b32 a226, v34
v_accvgpr_write_b32 a227, v35
v_accvgpr_write_b32 a228, v36
v_accvgpr_write_b32 a229, v37
v_accvgpr_write_b32 a230, v38
v_accvgpr_write_b32 a231, v39
v_accvgpr_write_b32 a232, v40
v_accvgpr_write_b32 a233, v41
v_accvgpr_write_b32 a234, v42
v_accvgpr_write_b32 a235, v43
v_accvgpr_write_b32 a236, v44
v_accvgpr_write_b32 a237, v45
v_accvgpr_write_b32 a238, v46
v_accvgpr_write_b32 a239, v47
v_accvgpr_write_b32 a240, v48
v_accvgpr_write_b32 a241, v49
v_accvgpr_write_b32 a242, v50
v_accvgpr_write_b32 a243, v51
v_accvgpr_write_b32 a244, v52
v_accvgpr_write_b32 a245, v53
v_accvgpr_write_b32 a246, v54
v_accvgpr_write_b32 a247, v55
v_accvgpr_write_b32 a248, v56
v_accvgpr_write_b32 a249, v57
v_accvgpr_write_b32 a250, v58
v_accvgpr_write_b32 a251, v59
v_accvgpr_write_b32 a252, v60
v_accvgpr_write_b32 a253, v61
v_accvgpr_write_b32 a254, v62
v_accvgpr_write_b32 a255, v63
s_lshl_b32 s62, s10, 14
s_lshl_b32 s63, s3, 12
s_add_u32 s62, s62, s63
s_lshl_b32 s63, s12, 11
s_add_u32 s62, s62, s63
v_lshl_add_u32 v10, v1, 4, s62
v_lshrrev_b32 v2, 3, v1
v_cmp_eq_u32 vcc, 3, v2
v_add_u32 v2, 67108480, v10
s_nop 0
v_cndmask_b32 v10, v10, v2, vcc
v_xor_b32 v11, 2048, v10
v_bfe_u32 v16, v1, 2, 3
v_mul_u32_u24 v16, 1056, v16
v_bfe_u32 v2, v1, 5, 1
v_lshl_add_u32 v16, v2, 8, v16
v_and_b32 v2, 3, v1
v_lshl_add_u32 v16, v2, 3, v16
s_lshl_b32 s62, s12, 6
s_add_u32 s62, s62, 84480
s_xor_b32 s63, s12, 1
s_mul_i32 s63, s63, 192
s_add_u32 s63, s63, 84480
v_add_u32 v17, s63, v16
v_add_u32 v16, s62, v16
s_mov_b32 s52, 8388608
s_mov_b32 s53, 8388608
s_mul_i32 s59, s3, 2112
s_and_b32 s62, s7, 1
s_mul_i32 s62, s62, 3670016
s_lshr_b32 s63, s7, 1
s_lshl_b32 s63, s63, 8
s_add_u32 s62, s62, s63
s_lshl_b32 s63, s3, 12
s_add_u32 s62, s62, s63
v_lshrrev_b32 v5, 4, v1
v_lshlrev_b32 v5, 14, v5
v_and_b32 v2, 15, v1
v_lshl_add_u32 v5, v2, 4, v5
v_add_u32 v5, s62, v5
v_add_u32 v6, 992, v5
s_lshl_b32 s62, s10, 15
s_lshl_b32 s63, s3, 13
s_add_u32 s62, s62, s63
v_lshl_add_u32 v4, v1, 4, s62
s_and_b32 s47, s5, 3
s_lshr_b32 s63, s5, 2
s_lshl_b32 s63, s63, 3
s_add_u32 s63, s63, s4
s_lshl_b32 s62, s63, 1
s_add_u32 s62, s62, s48
s_mul_i32 s62, s62, 1792
v_lshrrev_b32 v7, 1, v1
v_min_u32 v8, 13, v7
v_lshl_add_u32 v8, v8, 7, s62
s_lshl_b32 s62, s63, 2
s_add_u32 s62, s62, s3
s_mul_i32 s62, s62, 640
v_and_b32 v7, 15, v7
v_min_u32 v7, 4, v7
v_lshl_add_u32 v7, v7, 7, s62
v_lshrrev_b32 v2, 5, v1
v_mul_u32_u24 v2, 3670016, v2
v_add_u32 v7, v7, v2
s_mul_i32 s44, s47, 163840
s_add_u32 s45, s47, 12
s_mul_i32 s45, s45, 229376
v_and_b32 v6, 3, v1
v_cmp_eq_u32 vcc, 3, v6
v_mov_b32 v2, 0x3f80
v_mov_b32 v20, 1.0
v_cndmask_b32 v2, v2, v20, vcc
v_cndmask_b32 v6, v6, 0, vcc
v_or_b32 v6, 12, v6
v_mul_u32_u24 v6, 0x1111, v6
v_lshl_or_b32 v6, v6, 16, v6
v_bfe_u32 v22, v1, 2, 2
v_cmp_eq_u32 vcc, 0, v22
s_nop 1
v_cndmask_b32 v20, 0, v2, vcc
v_cmp_eq_u32 vcc, 1, v22
s_nop 1
v_cndmask_b32 v21, 0, v2, vcc
v_accvgpr_write_b32 a208, v20
v_accvgpr_write_b32 a209, v21
v_accvgpr_write_b32 a210, v20
v_accvgpr_write_b32 a211, v21
v_accvgpr_write_b32 a212, 0
v_accvgpr_write_b32 a213, 0
v_accvgpr_write_b32 a214, 0
v_accvgpr_write_b32 a215, 0
v_accvgpr_write_b32 a216, 0
v_accvgpr_write_b32 a217, 0
v_accvgpr_write_b32 a218, 0
v_accvgpr_write_b32 a219, 0
s_cmp_lt_u32 s3, 2
s_cselect_b32 s40, s32, s80
s_cselect_b32 s41, s33, s81
s_cselect_b32 s42, s34, s82
s_add_u32 s62, s55, 84480
v_lshl_add_u32 v9, v1, 4, s62
s_lshl_b32 s62, s6, 10
s_add_u32 s62, s62, 30441472
s_lshl_b32 s64, s10, 1
s_lshl_b32 s64, s64, 10
s_add_u32 s64, s64, 30441472
s_lshr_b32 s67, s5, 2
s_and_b32 s67, s67, 3
s_lshl_b32 s67, s67, 7
s_add_u32 s64, s64, s67
s_add_u32 s65, s64, 1024
v_lshl_add_u32 v252, v1, 7, s62
v_mov_b32 v253, s64
v_mov_b32 v255, 1
v_writelane_b32 v253, s65, 1
s_waitcnt vmcnt(0) lgkmcnt(0)
s_cmp_lg_u32 s3, 1
s_barrier
s_cbranch_scc1 .Lfirst38
s_mov_b64 exec, 15
buffer_atomic_add v255, v252, s[16:19], 0 offen
s_mov_b64 exec, 3
v_mov_b32 v254, 0
buffer_atomic_add v254, v253, s[16:19], 0 offen sc0
s_mov_b64 exec, -1
.Lfirst38:
s_add_u32 m0, s55, 118272
s_nop 0
buffer_load_dwordx4 v12, s[32:35], s54 offen lds
buffer_load_dwordx4 v13, s[32:35], s54 offen offset:1056 lds
buffer_load_dwordx4 v14, s[32:35], s54 offen offset:2112 lds
buffer_load_dwordx4 v15, s[32:35], s54 offen offset:3168 lds
s_add_u32 m0, s55, 135168
s_nop 0
buffer_load_dwordx4 v12, s[80:83], s54 offen lds
buffer_load_dwordx4 v13, s[80:83], s54 offen offset:1056 lds
buffer_load_dwordx4 v14, s[80:83], s54 offen offset:2112 lds
buffer_load_dwordx4 v15, s[80:83], s54 offen offset:3168 lds
s_add_u32 s54, s54, 458752
s_cmp_lg_u32 s3, 1
s_cbranch_scc1 .Lnopoll37
s_mov_b64 exec, 3
s_mov_b32 s15, 0
v_mov_b32 v255, 0
buffer_atomic_add v255, v253, s[16:19], 0 offen sc0
s_waitcnt vmcnt(9)
v_cmp_gt_u32 vcc, 16, v254
s_nop 0
s_cbranch_vccz .Lnopoll37r
.Lpoll36:
s_waitcnt vmcnt(0)
v_cmp_gt_u32 vcc, 16, v255
s_add_u32 s15, s15, 1
s_cbranch_vccz .Lnopoll37r
v_mov_b32 v255, 0
buffer_atomic_add v255, v253, s[16:19], 0 offen sc0
s_cmp_le_u32 s15, 100000
s_cbranch_scc1 .Lpoll36
s_branch .Lnopoll37r
.Lnopoll37:
s_mov_b64 exec, 0
s_cmp_eq_u32 s3, 2
s_cbranch_scc1 .Lpad16
s_cmp_eq_u32 s3, 3
s_cbranch_scc1 .Lpad17
s_branch .Lpad18
.Lnopoll37r:
s_mov_b64 exec, -1
s_waitcnt vmcnt(9)
s_barrier
buffer_load_dwordx4 a[128:131], v10, s[16:19], s52 offen sc1
buffer_load_dwordx4 a[132:135], v10, s[16:19], s52 offen offset:1024 sc1
s_add_u32 s52, s52, 131072
buffer_load_dwordx4 a[144:147], v10, s[16:19], s52 offen sc1
buffer_load_dwordx4 a[148:151], v10, s[16:19], s52 offen offset:1024 sc1
s_add_u32 s52, s52, 131072
buffer_load_dwordx4 a[136:139], v11, s[16:19], s53 offen sc1
buffer_load_dwordx4 a[140:143], v11, s[16:19], s53 offen offset:1024 sc1
s_add_u32 s53, s53, 131072
buffer_load_dwordx4 a[152:155], v11, s[16:19], s53 offen sc1
buffer_load_dwordx4 a[156:159], v11, s[16:19], s53 offen offset:1024 sc1
s_add_u32 s53, s53, 131072
ds_read_b64_tr_b16 a[0:1], v16
TR 2,16,512
TR 4,16,8448
TR 6,16,8960
TR 8,16,32
TR 10,16,544
TR 12,16,8480
TR 14,16,8992
TR 16,16,64
TR 18,16,576
TR 20,16,8512
TR 22,16,9024
TR 24,16,96
TR 26,16,608
TR 28,16,8544
TR 30,16,9056
TR 32,16,128
TR 34,16,640
TR 36,16,8576
TR 38,16,9088
TR 40,16,160
TR 42,16,672
TR 44,16,8608
TR 46,16,9120
ds_read_b64_tr_b16 a[48:49], v17
TR 50,17,512
TR 52,17,8448
TR 54,17,8960
TR 56,17,32
TR 58,17,544
TR 60,17,8480
TR 62,17,8992
ds_read_b128 a[192:195], v9
RD 196,9,1056
RD 200,9,2112
RD 204,9,3168
s_lshl_b32 s57, s3, 13
s_add_u32 s57, s57, 49920
v_lshl_add_u32 v2, v1, 4, s57
s_waitcnt lgkmcnt(0)
s_barrier
s_waitcnt vmcnt(7)
v_mfma_f32_16x16x32_bf16 v[32:35], a[0:3], a[128:131], 0
buffer_load_dwordx4 a[160:163], v10, s[16:19], s52 offen sc1
s_waitcnt vmcnt(6)
MAA 32,4,144
TR 64,16,16896
v_smfmac_f32_16x16x64_bf16 a[212:215], a[208:211], a[192:199], v6
TR 66,16,17408
v_smfmac_f32_16x16x64_bf16 a[212:215], a[208:211], a[200:207], v6
TR 68,16,25344
v_mfma_f32_16x16x32_bf16 v[36:39], a[0:3], a[132:135], 0
TR 70,16,25856
s_waitcnt vmcnt(5)
MAA 36,4,148
buffer_load_dwordx4 a[164:167], v10, s[16:19], s52 offen offset:1024 sc1
v_mfma_f32_16x16x32_bf16 v[52:55], a[8:11], a[132:135], 0
TR 72,16,16928
s_add_u32 s52, s52, 131072
MAA 52,12,148
TR 74,16,17440
v_mfma_f32_16x16x32_bf16 v[48:51], a[8:11], a[128:131], 0
TR 76,16,25376
MAA 48,12,144
TR 78,16,25888
v_mfma_f32_16x16x32_bf16 v[96:99], a[16:19], a[128:131], 0
buffer_load_dwordx4 a[176:179], v10, s[16:19], s52 offen sc1
MAA 96,20,144
TR 80,16,16960
v_mfma_f32_16x16x32_bf16 v[100:103], a[16:19], a[132:135], 0
TR 82,16,17472
MAA 100,20,148
TR 84,16,25408
v_mfma_f32_16x16x32_bf16 v[116:119], a[24:27], a[132:135], 0
TR 86,16,25920
MAA 116,28,148
buffer_load_dwordx4 a[180:183], v10, s[16:19], s52 offen offset:1024 sc1
v_mfma_f32_16x16x32_bf16 v[112:115], a[24:27], a[128:131], 0
TR 88,16,16992
s_add_u32 s52, s52, 131072
MAA 112,28,144
TR 90,16,17504
v_mfma_f32_16x16x32_bf16 v[160:163], a[32:35], a[128:131], 0
TR 92,16,25440
MAA 160,36,144
TR 94,16,25952
v_mfma_f32_16x16x32_bf16 v[164:167], a[32:35], a[132:135], 0
buffer_load_dwordx4 a[168:171], v11, s[16:19], s53 offen sc1
MAA 164,36,148
TR 96,16,17024
v_mfma_f32_16x16x32_bf16 v[180:183], a[40:43], a[132:135], 0
TR 98,16,17536
MAA 180,44,148
TR 100,16,25472
v_mfma_f32_16x16x32_bf16 v[176:179], a[40:43], a[128:131], 0
TR 102,16,25984
MAA 176,44,144
buffer_load_dwordx4 a[172:175], v11, s[16:19], s53 offen offset:1024 sc1
v_mfma_f32_16x16x32_bf16 v[224:227], a[48:51], a[128:131], 0
TR 104,16,17056
s_add_u32 s53, s53, 131072
MAA 224,52,144
TR 106,16,17568
v_mfma_f32_16x16x32_bf16 v[228:231], a[48:51], a[132:135], 0
TR 108,16,25504
MAA 228,52,148
TR 110,16,26016
v_mfma_f32_16x16x32_bf16 v[236:239], a[56:59], a[132:135], 0
buffer_load_dwordx4 a[184:187], v11, s[16:19], s53 offen sc1
MAA 236,60,148
TR 112,17,16896
v_mfma_f32_16x16x32_bf16 v[232:235], a[56:59], a[128:131], 0
TR 114,17,17408
MAA 232,60,144
TR 116,17,25344
s_waitcnt vmcnt(7)
v_mfma_f32_16x16x32_bf16 v[188:191], a[40:43], a[140:143], 0
TR 118,17,25856
MAA 188,44,156
buffer_load_dwordx4 a[188:191], v11, s[16:19], s53 offen offset:1024 sc1
v_mfma_f32_16x16x32_bf16 v[184:187], a[40:43], a[136:139], 0
TR 120,17,16928
s_add_u32 s53, s53, 131072
MAA 184,44,152
TR 122,17,17440
s_add_u32 m0, s55, 84480
v_mfma_f32_16x16x32_bf16 v[168:171], a[32:35], a[136:139], 0
TR 124,17,25376
MAA 168,36,152
TR 126,17,25888
v_mfma_f32_16x16x32_bf16 v[172:175], a[32:35], a[140:143], 0
buffer_load_dwordx4 v12, s[32:35], s54 offen lds
MAA 172,36,156
RD 192,9,16896
v_mfma_f32_16x16x32_bf16 v[124:127], a[24:27], a[140:143], 0
RD 196,9,17952
MAA 124,28,156
RD 200,9,19008
v_mfma_f32_16x16x32_bf16 v[120:123], a[24:27], a[136:139], 0
RD 204,9,20064
MAA 120,28,152
buffer_load_dwordx4 v13, s[32:35], s54 offen offset:1056 lds
v_mfma_f32_16x16x32_bf16 v[104:107], a[16:19], a[136:139], 0
MAA 104,20,152
v_mfma_f32_16x16x32_bf16 v[108:111], a[16:19], a[140:143], 0
MAA 108,20,156
v_mfma_f32_16x16x32_bf16 v[60:63], a[8:11], a[140:143], 0
buffer_load_dwordx4 v14, s[32:35], s54 offen offset:2112 lds
MAA 60,12,156
v_mfma_f32_16x16x32_bf16 v[56:59], a[8:11], a[136:139], 0
MAA 56,12,152
v_mfma_f32_16x16x32_bf16 v[40:43], a[0:3], a[136:139], 0
MAA 40,4,152
buffer_load_dwordx4 v15, s[32:35], s54 offen offset:3168 lds
v_mfma_f32_16x16x32_bf16 v[44:47], a[0:3], a[140:143], 0
MAA 44,4,156
s_waitcnt lgkmcnt(0)
s_barrier
v_mfma_f32_16x16x32_bf16 v[64:67], a[64:67], a[128:131], 0
TR 0,16,33792
s_add_u32 m0, s55, 101376
MAA 64,68,144
buffer_load_dwordx4 v12, s[80:83], s54 offen lds
v_smfmac_f32_16x16x64_bf16 a[216:219], a[208:211], a[192:199], v6
TR 2,16,34304
s_mul_i32 s66, s13, 114688
v_smfmac_f32_16x16x64_bf16 a[216:219], a[208:211], a[200:207], v6
TR 4,16,42240
s_mul_i32 s65, s10, 1818624
v_mfma_f32_16x16x32_bf16 v[68:71], a[64:67], a[132:135], 0
TR 6,16,42752
s_add_u32 s66, s66, s65
MAA 68,68,148
TR 8,16,33824
s_add_u32 s66, s66, 12582912
v_mfma_f32_16x16x32_bf16 v[84:87], a[72:75], a[132:135], 0
buffer_load_dwordx4 v13, s[80:83], s54 offen offset:1056 lds
MAA 84,76,148
TR 10,16,34336
s_add_u32 s65, s66, 49152
v_mfma_f32_16x16x32_bf16 v[80:83], a[72:75], a[128:131], 0
TR 12,16,42272
s_lshl_b32 s62, s12, 16
MAA 80,76,144
TR 14,16,42784
s_add_u32 s62, s62, s66
v_mfma_f32_16x16x32_bf16 v[128:131], a[80:83], a[128:131], 0
TR 16,16,33856
s_add_u32 s63, s62, 16384
MAA 128,84,144
buffer_load_dwordx4 v14, s[80:83], s54 offen offset:2112 lds
v_mfma_f32_16x16x32_bf16 v[132:135], a[80:83], a[132:135], 0
TR 18,16,34368
s_add_u32 s64, s62, 32768
MAA 132,84,148
TR 20,16,42304
s_lshl_b32 s72, s10, 1
v_mfma_f32_16x16x32_bf16 v[148:151], a[88:91], a[132:135], 0
TR 22,16,42816
s_lshr_b32 s74, s11, 4
MAA 148,92,148
TR 24,16,33888
s_add_u32 s72, s72, s74
v_mfma_f32_16x16x32_bf16 v[144:147], a[88:91], a[128:131], 0
buffer_load_dwordx4 v15, s[80:83], s54 offen offset:3168 lds
MAA 144,92,144
TR 26,16,34400
s_add_u32 s54, s54, 458752
v_mfma_f32_16x16x32_bf16 v[192:195], a[96:99], a[128:131], 0
TR 28,16,42336
s_add_u32 m0, s57, 0
MAA 192,100,144
TR 30,16,42848
s_mov_b32 s58, 29622272
v_mfma_f32_16x16x32_bf16 v[196:199], a[96:99], a[132:135], 0
TR 32,16,33920
s_lshl_b32 s72, s72, 10
MAA 196,100,148
buffer_load_dwordx4 v4, s[16:19], s58 offen sc1 lds
v_mfma_f32_16x16x32_bf16 v[212:215], a[104:107], a[132:135], 0
TR 34,16,34432
s_add_u32 s72, s72, 30457856
MAA 212,108,148
TR 36,16,42368
s_and_b32 s73, s6, 14
v_mfma_f32_16x16x32_bf16 v[208:211], a[104:107], a[128:131], 0
TR 38,16,42880
s_and_b32 s74, s7, 1
MAA 208,108,144
TR 40,16,33952
s_add_u32 s73, s73, s74
v_mfma_f32_16x16x32_bf16 v[240:243], a[112:115], a[128:131], 0
buffer_load_dwordx4 v4, s[16:19], s58 offen offset:1024 sc1 lds
MAA 240,116,144
TR 42,16,34464
s_lshl_b32 s73, s73, 10
v_mfma_f32_16x16x32_bf16 v[244:247], a[112:115], a[132:135], 0
TR 44,16,42400
s_add_u32 s73, s73, 30457856
MAA 244,116,148
TR 46,16,42912
s_lshr_b32 s67, s5, 2
v_mfma_f32_16x16x32_bf16 v[252:255], a[120:123], a[132:135], 0
TR 48,17,33792
MAA 252,124,148
TR 50,17,34304
v_mfma_f32_16x16x32_bf16 v[248:251], a[120:123], a[128:131], 0
buffer_load_dwordx4 a[128:131], v10, s[16:19], s52 offen sc1
MAA 248,124,144
TR 52,17,42240
v_mfma_f32_16x16x32_bf16 v[220:223], a[104:107], a[140:143], 0
TR 54,17,42752
MAA 220,108,156
TR 56,17,33824
v_mfma_f32_16x16x32_bf16 v[216:219], a[104:107], a[136:139], 0
TR 58,17,34336
MAA 216,108,152
buffer_load_dwordx4 a[132:135], v10, s[16:19], s52 offen offset:1024 sc1
v_mfma_f32_16x16x32_bf16 v[200:203], a[96:99], a[136:139], 0
TR 60,17,42272
s_add_u32 s52, s52, 131072
MAA 200,100,152
TR 62,17,42784
v_mfma_f32_16x16x32_bf16 v[204:207], a[96:99], a[140:143], 0
RD 192,9,33792
MAA 204,100,156
RD 196,9,34848
v_mfma_f32_16x16x32_bf16 v[156:159], a[88:91], a[140:143], 0
buffer_load_dwordx4 a[144:147], v10, s[16:19], s52 offen sc1
MAA 156,92,156
RD 200,9,35904
v_mfma_f32_16x16x32_bf16 v[152:155], a[88:91], a[136:139], 0
RD 204,9,36960
MAA 152,92,152
v_mfma_f32_16x16x32_bf16 v[136:139], a[80:83], a[136:139], 0
MAA 136,84,152
buffer_load_dwordx4 a[148:151], v10, s[16:19], s52 offen offset:1024 sc1
v_mfma_f32_16x16x32_bf16 v[140:143], a[80:83], a[140:143], 0
s_add_u32 s52, s52, 131072
MAA 140,84,156
v_mfma_f32_16x16x32_bf16 v[92:95], a[72:75], a[140:143], 0
MAA 92,76,156
v_mfma_f32_16x16x32_bf16 v[88:91], a[72:75], a[136:139], 0
MAA 88,76,152
v_mfma_f32_16x16x32_bf16 v[72:75], a[64:67], a[136:139], 0
MAA 72,68,152
v_mfma_f32_16x16x32_bf16 v[76:79], a[64:67], a[140:143], 0
MAA 76,68,156
s_waitcnt vmcnt(18) lgkmcnt(0)
s_barrier
MAA 32,0,160
buffer_load_dwordx4 a[136:139], v11, s[16:19], s53 offen sc1
MAA 32,4,176
TR 64,16,50688
s_and_b32 s67, s67, 3
v_smfmac_f32_16x16x64_bf16 a[212:215], a[208:211], a[192:199], v6
TR 66,16,51200
s_lshl_b32 s67, s67, 7
v_smfmac_f32_16x16x64_bf16 a[212:215], a[208:211], a[200:207], v6
TR 68,16,59136
s_add_u32 s73, s73, s67
MAA 36,4,180
TR 70,16,59648
s_and_b32 s74, s7, 1
MAA 36,0,164
buffer_load_dwordx4 a[140:143], v11, s[16:19], s53 offen offset:1024 sc1
MAA 52,8,164
TR 72,16,50720
s_add_u32 s53, s53, 131072
MAA 52,12,180
TR 74,16,51232
s_mul_i32 s87, s74, 917504
MAA 48,12,176
TR 76,16,59168
s_lshr_b32 s75, s6, 1
MAA 48,8,160
TR 78,16,59680
s_mul_i32 s75, s75, 1818624
MAA 96,16,160
buffer_load_dwordx4 a[152:155], v11, s[16:19], s53 offen sc1
MAA 96,20,176
TR 80,16,50752
s_add_u32 s87, s87, s75
MAA 100,20,180
TR 82,16,51264
s_add_u32 s87, s87, 12582912
MAA 100,16,164
TR 84,16,59200
s_and_b32 s74, s6, 3
MAA 116,24,164
TR 86,16,59712
.Lpad12:
s_cbranch_execz .Lpad15
s_xor_b32 s75, s74, 0
MAA 116,28,180
buffer_load_dwordx4 a[156:159], v11, s[16:19], s53 offen offset:1024 sc1
MAA 112,28,176
TR 88,16,50784
s_add_u32 s53, s53, 131072
MAA 112,24,160
TR 90,16,51296
s_add_u32 m0, s55, 118272
MAA 160,32,160
TR 92,16,59232
s_sub_u32 s75, s75, 0
MAA 160,36,176
TR 94,16,59744
s_mul_i32 s98, s75, 458752
MAA 164,36,180
buffer_load_dwordx4 v12, s[32:35], s54 offen lds
MAA 164,32,164
TR 96,16,50816
s_mul_i32 s75, s75, 114688
MAA 180,40,164
TR 98,16,51328
s_add_u32 s76, s87, s75
MAA 180,44,180
TR 100,16,59264
s_xor_b32 s75, s74, 1
MAA 176,44,176
TR 102,16,59776
s_sub_u32 s75, s75, 1
MAA 176,40,160
buffer_load_dwordx4 v13, s[32:35], s54 offen offset:1056 lds
MAA 224,48,160
TR 104,16,50848
s_mul_i32 s99, s75, 458752
MAA 224,52,176
TR 106,16,51360
s_mul_i32 s75, s75, 114688
MAA 228,52,180
TR 108,16,59296
s_add_u32 s77, s87, s75
MAA 228,48,164
TR 110,16,59808
MAA 236,56,164
buffer_load_dwordx4 v14, s[32:35], s54 offen offset:2112 lds
MAA 236,60,180
TR 112,17,50688
MAA 232,60,176
TR 114,17,51200
MAA 232,56,160
TR 116,17,59136
s_waitcnt vmcnt(21)
MAA 188,40,172
TR 118,17,59648
MAA 188,44,188
buffer_load_dwordx4 v15, s[32:35], s54 offen offset:3168 lds
MAA 184,44,184
TR 120,17,50720
s_add_u32 m0, s57, 2048
MAA 184,40,168
TR 122,17,51232
s_mov_b32 s58, 29624320
MAA 168,32,168
TR 124,17,59168
MAA 168,36,184
TR 126,17,59680
MAA 172,36,188
buffer_load_dwordx4 v4, s[16:19], s58 offen sc1 lds
MAA 172,32,172
RD 192,9,50688
MAA 124,24,172
RD 196,9,51744
MAA 124,28,188
RD 200,9,52800
MAA 120,28,184
RD 204,9,53856
MAA 120,24,168
buffer_load_dwordx4 v4, s[16:19], s58 offen offset:1024 sc1 lds
MAA 104,16,168
MAA 104,20,184
MAA 108,20,188
MAA 108,16,172
MAA 60,8,172
MAA 60,12,188
MAA 56,12,184
MAA 56,8,168
MAA 40,0,168
MAA 40,4,184
MAA 44,4,188
MAA 44,0,172
s_waitcnt vmcnt(20) lgkmcnt(0)
s_barrier
MAA 64,64,160
ds_read_b64_tr_b16 a[0:1], v16
s_add_u32 m0, s55, 135168
MAA 64,68,176
buffer_load_dwordx4 v12, s[80:83], s54 offen lds
v_smfmac_f32_16x16x64_bf16 a[216:219], a[208:211], a[192:199], v6
TR 2,16,512
s_xor_b32 s75, s74, 2
v_smfmac_f32_16x16x64_bf16 a[216:219], a[208:211], a[200:207], v6
TR 4,16,8448
s_sub_u32 s75, s75, 2
MAA 68,68,180
TR 6,16,8960
s_mul_i32 s100, s75, 458752
MAA 68,64,164
TR 8,16,32
s_mul_i32 s75, s75, 114688
MAA 84,72,164
buffer_load_dwordx4 v13, s[80:83], s54 offen offset:1056 lds
MAA 84,76,180
TR 10,16,544
s_add_u32 s78, s87, s75
MAA 80,76,176
TR 12,16,8480
s_xor_b32 s75, s74, 3
MAA 80,72,160
TR 14,16,8992
s_sub_u32 s75, s75, 3
MAA 128,80,160
TR 16,16,64
s_mul_i32 s101, s75, 458752
MAA 128,84,176
buffer_load_dwordx4 v14, s[80:83], s54 offen offset:2112 lds
MAA 132,84,180
TR 18,16,576
s_mul_i32 s75, s75, 114688
MAA 132,80,164
TR 20,16,8512
s_add_u32 s79, s87, s75
MAA 148,88,164
TR 22,16,9024
s_and_b32 s87, s6, 3
MAA 148,92,180
TR 24,16,96
s_mov_b32 s46, 0
MAA 144,92,176
buffer_load_dwordx4 v15, s[80:83], s54 offen offset:3168 lds
MAA 144,88,160
TR 26,16,608
s_add_u32 s54, s54, 458752
MAA 192,96,160
TR 28,16,8544
s_add_u32 m0, s57, 4096
MAA 192,100,176
TR 30,16,9056
s_mov_b32 s58, 29626368
MAA 196,100,180
TR 32,16,128
s_lshl_b32 s74, s3, 10
MAA 196,96,164
buffer_load_dwordx4 v4, s[16:19], s58 offen sc1 lds
MAA 212,104,164
TR 34,16,640
s_lshl_b32 s75, s12, 9
MAA 212,108,180
TR 36,16,8576
s_add_u32 s74, s74, s75
MAA 208,108,176
TR 38,16,9088
s_add_u32 s74, s74, 152576
MAA 208,104,160
TR 40,16,160
v_and_b32 v18, 15, v1
MAA 240,112,160
buffer_load_dwordx4 v4, s[16:19], s58 offen offset:1024 sc1 lds
MAA 240,116,176
TR 42,16,672
v_lshl_add_u32 v18, v18, 4, s74
MAA 244,116,180
TR 44,16,8608
v_xor_b32 v19, 512, v18
MAA 244,112,164
TR 46,16,9120
MAA 252,120,164
ds_read_b64_tr_b16 a[48:49], v17
MAA 252,124,180
TR 50,17,512
MAA 248,124,176
TR 52,17,8448
MAA 248,120,160
buffer_load_dwordx4 a[160:163], v10, s[16:19], s52 offen sc1
MAA 220,104,172
TR 54,17,8960
MAA 220,108,188
TR 56,17,32
MAA 216,108,184
TR 58,17,544
MAA 216,104,168
TR 60,17,8480
MAA 200,96,168
buffer_load_dwordx4 a[164:167], v10, s[16:19], s52 offen offset:1024 sc1
MAA 200,100,184
TR 62,17,8992
s_add_u32 s52, s52, 131072
MAA 204,100,188
ds_read_b128 a[192:195], v9
MAA 204,96,172
RD 196,9,1056
MAA 156,88,172
RD 200,9,2112
MAA 156,92,188
buffer_load_dwordx4 a[176:179], v10, s[16:19], s52 offen sc1
MAA 152,92,184
RD 204,9,3168
MAA 152,88,168
MAA 136,80,168
MAA 136,84,184
MAA 140,84,188
buffer_load_dwordx4 a[180:183], v10, s[16:19], s52 offen offset:1024 sc1
MAA 140,80,172
s_add_u32 s52, s52, 131072
MAA 92,72,172
MAA 92,76,188
MAA 88,76,184
MAA 88,72,168
MAA 72,64,168
MAA 72,68,184
MAA 76,68,188
MAA 76,64,172
s_waitcnt vmcnt(20) lgkmcnt(0)
s_barrier
MAA 32,0,128
buffer_load_dwordx4 a[168:171], v11, s[16:19], s53 offen sc1
MAA 32,4,144
ds_read_b128 v[20:23], v2
v_smfmac_f32_16x16x64_bf16 a[212:215], a[208:211], a[192:199], v6
ds_read_b128 v[28:31], v2 offset:1024
v_smfmac_f32_16x16x64_bf16 a[212:215], a[208:211], a[200:207], v6
s_waitcnt vmcnt(11)
ds_read_b128 v[24:27], v2 offset:2048
MAA 36,4,148
TR 64,16,16896
MAA 36,0,132
buffer_load_dwordx4 a[172:175], v11, s[16:19], s53 offen offset:1024 sc1
MAA 52,8,132
TR 66,16,17408
s_add_u32 s53, s53, 131072
MAA 52,12,148
TR 68,16,25344
MAA 48,12,144
TR 70,16,25856
MAA 48,8,128
TR 72,16,16928
MAA 96,16,128
buffer_load_dwordx4 a[184:187], v11, s[16:19], s53 offen sc1
MAA 96,20,144
TR 74,16,17440
s_waitcnt lgkmcnt(7)
v_add_f32 v20, v20, v28
MAA 100,20,148
TR 76,16,25376
v_add_f32 v21, v21, v29
MAA 100,16,132
TR 78,16,25888
v_add_f32 v22, v22, v30
MAA 116,24,132
TR 80,16,16960
v_add_f32 v23, v23, v31
MAA 116,28,148
buffer_load_dwordx4 a[188:191], v11, s[16:19], s53 offen offset:1024 sc1
MAA 112,28,144
ds_read_b128 v[28:31], v2 offset:3072
s_add_u32 s53, s53, 131072
MAA 112,24,128
TR 82,16,17472
s_add_u32 m0, s55, 84480
MAA 160,32,128
TR 84,16,25408
s_waitcnt lgkmcnt(12)
v_add_f32 v20, v20, v24
MAA 160,36,144
TR 86,16,25920
v_add_f32 v21, v21, v25
MAA 164,36,148
buffer_load_dwordx4 v12, s[32:35], s54 offen lds
MAA 164,32,132
TR 88,16,16992
v_add_f32 v22, v22, v26
MAA 180,40,132
TR 90,16,17504
v_add_f32 v23, v23, v27
MAA 180,44,148
TR 92,16,25440
MAA 176,44,144
TR 94,16,25952
MAA 176,40,128
buffer_load_dwordx4 v13, s[32:35], s54 offen offset:1056 lds
MAA 224,48,128
TR 96,16,17024
MAA 224,52,144
TR 98,16,17536
MAA 228,52,148
TR 100,16,25472
MAA 228,48,132
TR 102,16,25984
MAA 236,56,132
buffer_load_dwordx4 v14, s[32:35], s54 offen offset:2112 lds
MAA 236,60,148
TR 104,16,17056
MAA 232,60,144
TR 106,16,17568
MAA 232,56,128
TR 108,16,25504
MAA 188,40,140
TR 110,16,26016
MAA 188,44,156
buffer_load_dwordx4 v15, s[32:35], s54 offen offset:3168 lds
MAA 184,44,152
TR 112,17,16896
s_add_u32 m0, s57, 6144
MAA 184,40,136
TR 114,17,17408
s_mov_b32 s58, 29628416
MAA 168,32,136
TR 116,17,25344
MAA 168,36,152
TR 118,17,25856
MAA 172,36,156
buffer_load_dwordx4 v4, s[16:19], s58 offen sc1 lds
MAA 172,32,140
TR 120,17,16928
MAA 124,24,140
TR 122,17,17440
MAA 124,28,156
TR 124,17,25376
MAA 120,28,152
TR 126,17,25888
MAA 120,24,136
buffer_load_dwordx4 v4, s[16:19], s58 offen offset:1024 sc1 lds
MAA 104,16,136
RD 192,9,16896
MAA 104,20,152
RD 196,9,17952
MAA 108,20,156
RD 200,9,19008
MAA 108,16,140
RD 204,9,20064
MAA 60,8,140
MAA 60,12,156
MAA 56,12,152
MAA 56,8,136
MAA 40,0,136
MAA 40,4,152
MAA 44,4,156
s_sub_u32 s47, s47, 1
s_cbranch_scc1 .Lx39
.Lx39b:
MAA 44,0,140
s_waitcnt lgkmcnt(0)
s_barrier
MAA 64,64,128
s_waitcnt vmcnt(14)
ds_read_b128 v[24:27], v2 offset:4096
s_add_u32 m0, s55, 101376
MAA 64,68,144
buffer_load_dwordx4 v12, s[80:83], s54 offen lds
v_smfmac_f32_16x16x64_bf16 a[216:219], a[208:211], a[192:199], v6
TR 0,16,33792
v_add_f32 v20, v20, v28
v_smfmac_f32_16x16x64_bf16 a[216:219], a[208:211], a[200:207], v6
TR 2,16,34304
v_add_f32 v21, v21, v29
MAA 68,68,148
TR 4,16,42240
v_add_f32 v22, v22, v30
MAA 68,64,132
TR 6,16,42752
v_add_f32 v23, v23, v31
MAA 84,72,132
ds_read_b128 v[28:31], v2 offset:5120
MAA 84,76,148
TR 8,16,33824
MAA 80,76,144
buffer_load_dwordx4 v13, s[80:83], s54 offen offset:1056 lds
MAA 80,72,128
TR 10,16,34336
s_waitcnt lgkmcnt(7)
v_add_f32 v20, v20, v24
MAA 128,80,128
TR 12,16,42272
v_add_f32 v21, v21, v25
MAA 128,84,144
TR 14,16,42784
v_add_f32 v22, v22, v26
MAA 132,84,148
TR 16,16,33856
v_add_f32 v23, v23, v27
MAA 132,80,132
TR 18,16,34368
MAA 148,88,132
TR 20,16,42304
MAA 148,92,148
buffer_load_dwordx4 v14, s[80:83], s54 offen offset:2112 lds
MAA 144,92,144
TR 22,16,42816
MAA 144,88,128
TR 24,16,33888
MAA 192,96,128
TR 26,16,34400
MAA 192,100,144
TR 28,16,42336
MAA 196,100,148
TR 30,16,42848
MAA 196,96,132
TR 32,16,33920
MAA 212,104,132
buffer_load_dwordx4 v15, s[80:83], s54 offen offset:3168 lds
MAA 212,108,148
TR 34,16,34432
s_add_u32 s54, s54, 458752
MAA 208,108,144
TR 36,16,42368
MAA 208,104,128
TR 38,16,42880
MAA 240,112,128
TR 40,16,33952
MAA 240,116,144
TR 42,16,34464
MAA 244,116,148
TR 44,16,42400
MAA 244,112,132
TR 46,16,42912
MAA 252,120,132
TR 48,17,33792
MAA 252,124,148
TR 50,17,34304
MAA 248,124,144
TR 52,17,42240
MAA 248,120,128
buffer_load_dwordx4 a[128:131], v10, s[16:19], s52 offen sc1
MAA 220,104,140
TR 54,17,42752
MAA 220,108,156
TR 56,17,33824
MAA 216,108,152
TR 58,17,34336
MAA 216,104,136
TR 60,17,42272
MAA 200,96,136
TR 62,17,42784
MAA 200,100,152
RD 192,9,33792
MAA 204,100,156
buffer_load_dwordx4 a[132:135], v10, s[16:19], s52 offen offset:1024 sc1
MAA 204,96,140
RD 196,9,34848
s_add_u32 s52, s52, 131072
MAA 156,88,140
RD 200,9,35904
MAA 156,92,156
RD 204,9,36960
MAA 152,92,152
MAA 152,88,136
MAA 136,80,136
MAA 136,84,152
buffer_load_dwordx4 a[144:147], v10, s[16:19], s52 offen sc1
MAA 140,84,156
MAA 140,80,140
MAA 92,72,140
MAA 92,76,156
MAA 88,76,152
MAA 88,72,136
MAA 72,64,136
buffer_load_dwordx4 a[148:151], v10, s[16:19], s52 offen offset:1024 sc1
MAA 72,68,152
s_add_u32 s52, s52, 131072
MAA 76,68,156
s_sub_u32 s47, s47, 1
s_cbranch_scc1 .Lx40
.Lx40b:
MAA 76,64,140
s_waitcnt vmcnt(18) lgkmcnt(0)
s_barrier
MAA 32,0,160
buffer_load_dwordx4 a[136:139], v11, s[16:19], s53 offen sc1
MAA 32,4,176
s_waitcnt vmcnt(9)
ds_read_b128 v[24:27], v2 offset:6144
v_add_f32 v20, v20, v28
v_smfmac_f32_16x16x64_bf16 a[212:215], a[208:211], a[192:199], v6
TR 64,16,50688
v_add_f32 v21, v21, v29
v_smfmac_f32_16x16x64_bf16 a[212:215], a[208:211], a[200:207], v6
TR 66,16,51200
v_add_f32 v22, v22, v30
MAA 36,4,180
TR 68,16,59136
v_add_f32 v23, v23, v31
MAA 36,0,164
ds_read_b128 v[28:31], v2 offset:7168
MAA 52,8,164
TR 70,16,59648
MAA 52,12,180
buffer_load_dwordx4 a[140:143], v11, s[16:19], s53 offen offset:1024 sc1
MAA 48,12,176
TR 72,16,50720
s_add_u32 s53, s53, 131072
MAA 48,8,160
TR 74,16,51232
s_waitcnt lgkmcnt(7)
v_add_f32 v20, v20, v24
MAA 96,16,160
TR 76,16,59168
v_add_f32 v21, v21, v25
MAA 96,20,176
TR 78,16,59680
v_add_f32 v22, v22, v26
MAA 100,20,180
TR 80,16,50752
v_add_f32 v23, v23, v27
MAA 100,16,164
TR 82,16,51264
s_waitcnt lgkmcnt(7)
v_add_f32 v20, v20, v28
MAA 116,24,164
buffer_load_dwordx4 a[152:155], v11, s[16:19], s53 offen sc1
MAA 116,28,180
TR 84,16,59200
v_add_f32 v21, v21, v29
MAA 112,28,176
TR 86,16,59712
v_add_f32 v22, v22, v30
MAA 112,24,160
TR 88,16,50784
v_add_f32 v23, v23, v31
MAA 160,32,160
TR 90,16,51296
MAA 160,36,176
TR 92,16,59232
MAA 164,36,180
TR 94,16,59744
MAA 164,32,164
buffer_load_dwordx4 a[156:159], v11, s[16:19], s53 offen offset:1024 sc1
MAA 180,40,164
TR 96,16,50816
s_add_u32 s53, s53, 131072
MAA 180,44,180
TR 98,16,51328
s_add_u32 m0, s55, 118272
MAA 176,44,176
TR 100,16,59264
MAA 176,40,160
TR 102,16,59776
MAA 224,48,160
TR 104,16,50848
MAA 224,52,176
.Lpad13:
s_cbranch_execz .Lnopoll34r
TR 106,16,51360
MAA 228,52,180
buffer_load_dwordx4 v12, s[32:35], s54 offen lds
MAA 228,48,164
TR 108,16,59296
MAA 236,56,164
TR 110,16,59808
MAA 236,60,180
TR 112,17,50688
MAA 232,60,176
TR 114,17,51200
MAA 232,56,160
TR 116,17,59136
MAA 188,40,172
TR 118,17,59648
MAA 188,44,188
buffer_load_dwordx4 v13, s[32:35], s54 offen offset:1056 lds
MAA 184,44,184
TR 120,17,50720
MAA 184,40,168
TR 122,17,51232
MAA 168,32,168
TR 124,17,59168
MAA 168,36,184
TR 126,17,59680
MAA 172,36,188
RD 192,9,50688
MAA 172,32,172
RD 196,9,51744
MAA 124,24,172
buffer_load_dwordx4 v14, s[32:35], s54 offen offset:2112 lds
MAA 124,28,188
RD 200,9,52800
MAA 120,28,184
RD 204,9,53856
MAA 120,24,168
MAA 104,16,168
MAA 104,20,184
MAA 108,20,188
MAA 108,16,172
buffer_load_dwordx4 v15, s[32:35], s54 offen offset:3168 lds
MAA 60,8,172
MAA 60,12,188
MAA 56,12,184
MAA 56,8,168
MAA 40,0,168
MAA 40,4,184
MAA 44,4,188
s_sub_u32 s47, s47, 1
s_cbranch_scc1 .Lx41
.Lx41b:
MAA 44,0,172
s_waitcnt lgkmcnt(0)
s_barrier
MAA 64,64,160
ds_read_b64_tr_b16 a[0:1], v16
s_add_u32 m0, s55, 135168
MAA 64,68,176
buffer_load_dwordx4 v12, s[80:83], s54 offen lds
v_smfmac_f32_16x16x64_bf16 a[216:219], a[208:211], a[192:199], v6
TR 2,16,512
v_permlane32_swap_b32 v20, v22
v_smfmac_f32_16x16x64_bf16 a[216:219], a[208:211], a[200:207], v6
TR 4,16,8448
v_permlane32_swap_b32 v21, v23
MAA 68,68,180
TR 6,16,8960
v_add_f32 v20, v20, v22
MAA 68,64,164
TR 8,16,32
v_add_f32 v21, v21, v23
MAA 84,72,164
TR 10,16,544
v_mul_f32 v20, 0xba800000, v20
MAA 84,76,180
buffer_load_dwordx4 v13, s[80:83], s54 offen offset:1056 lds
MAA 80,76,176
TR 12,16,8480
v_mul_f32 v21, 0x3a800000, v21
MAA 80,72,160
TR 14,16,8992
v_fma_f32 v21, -v20, v20, v21
MAA 128,80,160
TR 16,16,64
v_max_f32 v21, 0, v21
MAA 128,84,176
TR 18,16,576
v_add_f32 v21, 0x3727c5ac, v21
MAA 132,84,180
TR 20,16,8512
v_rsq_f32 v22, v21
MAA 132,80,164
TR 22,16,9024
v_and_b32 v24, 31, v1
MAA 148,88,164
buffer_load_dwordx4 v14, s[80:83], s54 offen offset:2112 lds
MAA 148,92,180
TR 24,16,96
v_lshrrev_b32 v25, 5, v1
MAA 144,92,176
TR 26,16,608
v_lshl_add_u32 v24, v24, 1, v25
MAA 144,88,160
TR 28,16,8544
v_and_b32 v25, 0xc0, v0
MAA 192,96,160
TR 30,16,9056
v_add_u32 v24, v24, v25
MAA 192,100,176
TR 32,16,128
v_lshlrev_b32 v24, 4, v24
MAA 196,100,180
TR 34,16,640
v_add_u32 v24, 152576, v24
MAA 196,96,164
buffer_load_dwordx4 v15, s[80:83], s54 offen offset:3168 lds
MAA 212,104,164
TR 36,16,8576
s_add_u32 s54, s54, 458752
MAA 212,108,180
TR 38,16,9088
v_mul_f32 v22, 0xbfb8aa3b, v22
MAA 208,108,176
ds_write_b128 v24, v[20:23]
s_mov_b32 s58, s98
MAA 208,104,160
ds_read_b64 v[20:21], v18
s_mov_b32 s67, s59
MAA 240,112,160
ds_read_b64 v[22:23], v18 offset:256
MAA 240,116,176
ds_read_b64 v[24:25], v19
MAA 244,116,180
ds_read_b64 v[26:27], v19 offset:256
MAA 244,112,164
ds_read_b32 v28, v18 offset:8
MAA 252,120,164
ds_read_b32 v29, v18 offset:264
v_mov_b32 v18, v5
MAA 252,124,180
ds_read_b32 v30, v19 offset:8
MAA 248,124,176
ds_read_b32 v31, v19 offset:264
v_add_u32 v19, 992, v5
MAA 248,120,160
buffer_load_dwordx4 a[160:163], v10, s[16:19], s52 offen sc1
MAA 220,104,172
TR 40,16,160
MAA 220,108,188
TR 42,16,672
MAA 216,108,184
TR 44,16,8608
MAA 216,104,168
TR 46,16,9120
MAA 200,96,168
ds_read_b64_tr_b16 a[48:49], v17
MAA 200,100,184
TR 50,17,512
MAA 204,100,188
buffer_load_dwordx4 a[164:167], v10, s[16:19], s52 offen offset:1024 sc1
MAA 204,96,172
TR 52,17,8448
s_add_u32 s52, s52, 131072
MAA 156,88,172
TR 54,17,8960
MAA 156,92,188
TR 56,17,32
MAA 152,92,184
TR 58,17,544
MAA 152,88,168
TR 60,17,8480
MAA 136,80,168
TR 62,17,8992
MAA 136,84,184
buffer_load_dwordx4 a[176:179], v10, s[16:19], s52 offen sc1
MAA 140,84,188
ds_read_b128 a[192:195], v9
MAA 140,80,172
RD 196,9,1056
MAA 92,72,172
RD 200,9,2112
MAA 92,76,188
RD 204,9,3168
MAA 88,76,184
MAA 88,72,168
MAA 72,64,168
buffer_load_dwordx4 a[180:183], v10, s[16:19], s52 offen offset:1024 sc1
MAA 72,68,184
s_add_u32 s52, s52, 131072
MAA 76,68,188
s_sub_u32 s47, s47, 1
s_cbranch_scc1 .Lx42
.Lx42b:
MAA 76,64,172
s_mov_b32 s15, -5
.p2align 6
.Lk43:
s_waitcnt vmcnt(16) lgkmcnt(0)
s_barrier
MAA 32,0,128
TR 64,16,16896
MAA 32,4,144
buffer_load_dwordx4 a[168:171], v11, s[16:19], s53 offen sc1
v_smfmac_f32_16x16x64_bf16 a[212:215], a[208:211], a[192:199], v6
s_sub_u32 s47, s47, 1
s_cbranch_scc1 .Lx44
.Lx44b:
v_smfmac_f32_16x16x64_bf16 a[212:215], a[208:211], a[200:207], v6
TR 66,16,17408
MAA 36,4,148
TR 68,16,25344
MAA 36,0,132
TR 70,16,25856
MAA 52,8,132
TR 72,16,16928
MAA 52,12,148
buffer_load_dwordx4 a[172:175], v11, s[16:19], s53 offen offset:1024 sc1
MAA 48,12,144
TR 74,16,17440
s_add_u32 s53, s53, 131072
MAA 48,8,128
MAA 96,16,128
TR 76,16,25376
MAA 96,20,144
TR 78,16,25888
MAA 100,20,148
TR 80,16,16960
MAA 100,16,132
buffer_load_dwordx4 a[184:187], v11, s[16:19], s53 offen sc1
MAA 116,24,132
TR 82,16,17472
MAA 116,28,148
TR 84,16,25408
MAA 112,28,144
MAA 112,24,128
TR 86,16,25920
MAA 160,32,128
TR 88,16,16992
MAA 160,36,144
buffer_load_dwordx4 a[188:191], v11, s[16:19], s53 offen offset:1024 sc1
MAA 164,36,148
TR 90,16,17504
s_add_u32 s53, s53, 131072
MAA 164,32,132
TR 92,16,25440
MAA 180,40,132
TR 94,16,25952
MAA 180,44,148
MAA 176,44,144
TR 96,16,17024
s_add_u32 m0, s55, 84480
MAA 176,40,128
buffer_load_dwordx4 v12, s[32:35], s54 offen lds
MAA 224,48,128
TR 98,16,17536
MAA 224,52,144
TR 100,16,25472
MAA 228,52,148
TR 102,16,25984
MAA 228,48,132
TR 104,16,17056
MAA 236,56,132
MAA 236,60,148
TR 106,16,17568
MAA 232,60,144
TR 108,16,25504
MAA 232,56,128
TR 110,16,26016
s_waitcnt vmcnt(17)
MAA 188,40,140
TR 112,17,16896
MAA 188,44,156
buffer_load_dwordx4 v13, s[32:35], s54 offen offset:1056 lds
MAA 184,44,152
TR 114,17,17408
MAA 184,40,136
MAA 168,32,136
TR 116,17,25344
MAA 168,36,152
buffer_load_dwordx4 v14, s[32:35], s54 offen offset:2112 lds
MAA 172,36,156
TR 118,17,25856
MAA 172,32,140
TR 120,17,16928
MAA 124,24,140
TR 122,17,17440
MAA 124,28,156
TR 124,17,25376
MAA 120,28,152
MAA 120,24,136
buffer_load_dwordx4 v15, s[32:35], s54 offen offset:3168 lds
MAA 104,16,136
TR 126,17,25888
MAA 104,20,152
RD 192,9,16896
MAA 108,20,156
RD 196,9,17952
MAA 108,16,140
RD 200,9,19008
MAA 60,8,140
RD 204,9,20064
s_mov_b32 m0, s67
MAA 60,12,156
buffer_load_dwordx4 v18, s[28:31], s58 offen lds
MAA 56,12,152
MAA 56,8,136
MAA 40,0,136
MAA 40,4,152
MAA 44,4,156
MAA 44,0,140
s_waitcnt vmcnt(17) lgkmcnt(0)
s_barrier
MAA 64,64,128
TR 0,16,33792
s_add_u32 m0, s55, 101376
MAA 64,68,144
buffer_load_dwordx4 v12, s[80:83], s54 offen lds
v_smfmac_f32_16x16x64_bf16 a[216:219], a[208:211], a[192:199], v6
s_sub_u32 s47, s47, 1
s_cbranch_scc1 .Lx45
.Lx45b:
v_smfmac_f32_16x16x64_bf16 a[216:219], a[208:211], a[200:207], v6
TR 2,16,34304
MAA 68,68,148
TR 4,16,42240
MAA 68,64,132
TR 6,16,42752
MAA 84,72,132
TR 8,16,33824
MAA 84,76,148
buffer_load_dwordx4 v13, s[80:83], s54 offen offset:1056 lds
MAA 80,76,144
TR 10,16,34336
MAA 80,72,128
MAA 128,80,128
TR 12,16,42272
MAA 128,84,144
TR 14,16,42784
MAA 132,84,148
TR 16,16,33856
MAA 132,80,132
buffer_load_dwordx4 v14, s[80:83], s54 offen offset:2112 lds
MAA 148,88,132
TR 18,16,34368
MAA 148,92,148
TR 20,16,42304
MAA 144,92,144
TR 22,16,42816
MAA 144,88,128
MAA 192,96,128
TR 24,16,33888
MAA 192,100,144
buffer_load_dwordx4 v15, s[80:83], s54 offen offset:3168 lds
MAA 196,100,148
TR 26,16,34400
s_add_u32 s54, s54, 458752
MAA 196,96,132
TR 28,16,42336
MAA 212,104,132
TR 30,16,42848
MAA 212,108,148
TR 32,16,33920
MAA 208,108,144
TR 34,16,34432
s_mov_b32 m0, s67
MAA 208,104,128
buffer_load_dwordx4 v19, s[28:31], s58 offen offset:1056 lds
MAA 240,112,128
s_add_u32 s67, s67, 8448
s_add_u32 s58, s58, 0x40000
MAA 240,116,144
MAA 244,116,148
TR 36,16,42368
MAA 244,112,132
TR 38,16,42880
MAA 252,120,132
TR 40,16,33952
MAA 252,124,148
TR 42,16,34464
MAA 248,124,144
TR 44,16,42400
MAA 248,120,128
buffer_load_dwordx4 a[128:131], v10, s[16:19], s52 offen sc1
MAA 220,104,140
TR 46,16,42912
MAA 220,108,156
MAA 216,108,152
TR 48,17,33792
MAA 216,104,136
TR 50,17,34304
MAA 200,96,136
TR 52,17,42240
MAA 200,100,152
buffer_load_dwordx4 a[132:135], v10, s[16:19], s52 offen offset:1024 sc1
MAA 204,100,156
TR 54,17,42752
s_add_u32 s52, s52, 131072
MAA 204,96,140
TR 56,17,33824
MAA 156,88,140
TR 58,17,34336
MAA 156,92,156
MAA 152,92,152
TR 60,17,42272
MAA 152,88,136
buffer_load_dwordx4 a[144:147], v10, s[16:19], s52 offen sc1
MAA 136,80,136
TR 62,17,42784
MAA 136,84,152
RD 192,9,33792
MAA 140,84,156
RD 196,9,34848
MAA 140,80,140
RD 200,9,35904
MAA 92,72,140
RD 204,9,36960
MAA 92,76,156
buffer_load_dwordx4 a[148:151], v10, s[16:19], s52 offen offset:1024 sc1
MAA 88,76,152
s_add_u32 s52, s52, 131072
MAA 88,72,136
MAA 72,64,136
MAA 72,68,152
MAA 76,68,156
MAA 76,64,140
s_waitcnt vmcnt(18) lgkmcnt(0)
s_barrier
MAA 32,0,160
TR 64,16,50688
MAA 32,4,176
buffer_load_dwordx4 a[136:139], v11, s[16:19], s53 offen sc1
v_smfmac_f32_16x16x64_bf16 a[212:215], a[208:211], a[192:199], v6
s_sub_u32 s47, s47, 1
s_cbranch_scc1 .Lx46
.Lx46b:
v_smfmac_f32_16x16x64_bf16 a[212:215], a[208:211], a[200:207], v6
TR 66,16,51200
MAA 36,4,180
TR 68,16,59136
MAA 36,0,164
TR 70,16,59648
MAA 52,8,164
TR 72,16,50720
MAA 52,12,180
buffer_load_dwordx4 a[140:143], v11, s[16:19], s53 offen offset:1024 sc1
MAA 48,12,176
TR 74,16,51232
s_add_u32 s53, s53, 131072
MAA 48,8,160
MAA 96,16,160
TR 76,16,59168
MAA 96,20,176
TR 78,16,59680
MAA 100,20,180
TR 80,16,50752
MAA 100,16,164
buffer_load_dwordx4 a[152:155], v11, s[16:19], s53 offen sc1
MAA 116,24,164
TR 82,16,51264
MAA 116,28,180
TR 84,16,59200
MAA 112,28,176
MAA 112,24,160
TR 86,16,59712
MAA 160,32,160
TR 88,16,50784
MAA 160,36,176
buffer_load_dwordx4 a[156:159], v11, s[16:19], s53 offen offset:1024 sc1
MAA 164,36,180
TR 90,16,51296
s_add_u32 s53, s53, 131072
MAA 164,32,164
TR 92,16,59232
MAA 180,40,164
TR 94,16,59744
MAA 180,44,180
MAA 176,44,176
TR 96,16,50816
s_add_u32 m0, s55, 118272
MAA 176,40,160
buffer_load_dwordx4 v12, s[32:35], s54 offen lds
MAA 224,48,160
TR 98,16,51328
MAA 224,52,176
TR 100,16,59264
MAA 228,52,180
TR 102,16,59776
MAA 228,48,164
TR 104,16,50848
MAA 236,56,164
MAA 236,60,180
TR 106,16,51360
MAA 232,60,176
TR 108,16,59296
MAA 232,56,160
TR 110,16,59808
s_waitcnt vmcnt(19)
MAA 188,40,172
TR 112,17,50688
MAA 188,44,188
buffer_load_dwordx4 v13, s[32:35], s54 offen offset:1056 lds
MAA 184,44,184
TR 114,17,51200
MAA 184,40,168
MAA 168,32,168
TR 116,17,59136
MAA 168,36,184
buffer_load_dwordx4 v14, s[32:35], s54 offen offset:2112 lds
MAA 172,36,188
TR 118,17,59648
MAA 172,32,172
TR 120,17,50720
MAA 124,24,172
TR 122,17,51232
MAA 124,28,188
TR 124,17,59168
MAA 120,28,184
MAA 120,24,168
buffer_load_dwordx4 v15, s[32:35], s54 offen offset:3168 lds
MAA 104,16,168
TR 126,17,59680
MAA 104,20,184
RD 192,9,50688
MAA 108,20,188
RD 196,9,51744
MAA 108,16,172
RD 200,9,52800
MAA 60,8,172
RD 204,9,53856
s_mov_b32 m0, s67
MAA 60,12,188
buffer_load_dwordx4 v18, s[28:31], s58 offen lds
MAA 56,12,184
MAA 56,8,168
MAA 40,0,168
MAA 40,4,184
MAA 44,4,188
.Lpad14:
s_cbranch_execz .Lnopoll34r
MAA 44,0,172
s_waitcnt vmcnt(19) lgkmcnt(0)
s_barrier
MAA 64,64,160
ds_read_b64_tr_b16 a[0:1], v16
s_add_u32 m0, s55, 135168
MAA 64,68,176
buffer_load_dwordx4 v12, s[80:83], s54 offen lds
v_smfmac_f32_16x16x64_bf16 a[216:219], a[208:211], a[192:199], v6
s_sub_u32 s47, s47, 1
s_cbranch_scc1 .Lx47
.Lx47b:
v_smfmac_f32_16x16x64_bf16 a[216:219], a[208:211], a[200:207], v6
TR 2,16,512
MAA 68,68,180
TR 4,16,8448
MAA 68,64,164
TR 6,16,8960
MAA 84,72,164
TR 8,16,32
MAA 84,76,180
buffer_load_dwordx4 v13, s[80:83], s54 offen offset:1056 lds
MAA 80,76,176
TR 10,16,544
MAA 80,72,160
MAA 128,80,160
TR 12,16,8480
MAA 128,84,176
TR 14,16,8992
MAA 132,84,180
TR 16,16,64
MAA 132,80,164
buffer_load_dwordx4 v14, s[80:83], s54 offen offset:2112 lds
MAA 148,88,164
TR 18,16,576
MAA 148,92,180
TR 20,16,8512
MAA 144,92,176
TR 22,16,9024
MAA 144,88,160
MAA 192,96,160
TR 24,16,96
MAA 192,100,176
buffer_load_dwordx4 v15, s[80:83], s54 offen offset:3168 lds
MAA 196,100,180
TR 26,16,608
s_add_u32 s54, s54, 458752
MAA 196,96,164
TR 28,16,8544
MAA 212,104,164
TR 30,16,9056
MAA 212,108,180
TR 32,16,128
MAA 208,108,176
TR 34,16,640
s_mov_b32 m0, s67
MAA 208,104,160
buffer_load_dwordx4 v19, s[28:31], s58 offen offset:1056 lds
MAA 240,112,160
s_add_u32 s67, s67, 8448
s_add_u32 s46, s46, 1
s_xor_b32 s58, s46, s87
s_mul_i32 s58, s58, 458752
MAA 240,116,176
MAA 244,116,180
TR 36,16,8576
MAA 244,112,164
TR 38,16,9088
MAA 252,120,164
TR 40,16,160
MAA 252,124,180
TR 42,16,672
MAA 248,124,176
TR 44,16,8608
MAA 248,120,160
buffer_load_dwordx4 a[160:163], v10, s[16:19], s52 offen sc1
MAA 220,104,172
TR 46,16,9120
MAA 220,108,188
MAA 216,108,184
ds_read_b64_tr_b16 a[48:49], v17
MAA 216,104,168
TR 50,17,512
MAA 200,96,168
TR 52,17,8448
MAA 200,100,184
buffer_load_dwordx4 a[164:167], v10, s[16:19], s52 offen offset:1024 sc1
MAA 204,100,188
TR 54,17,8960
s_add_u32 s52, s52, 131072
MAA 204,96,172
TR 56,17,32
MAA 156,88,172
TR 58,17,544
MAA 156,92,188
MAA 152,92,184
TR 60,17,8480
MAA 152,88,168
buffer_load_dwordx4 a[176:179], v10, s[16:19], s52 offen sc1
MAA 136,80,168
TR 62,17,8992
MAA 136,84,184
ds_read_b128 a[192:195], v9
MAA 140,84,188
RD 196,9,1056
MAA 140,80,172
RD 200,9,2112
MAA 92,72,172
RD 204,9,3168
MAA 92,76,188
buffer_load_dwordx4 a[180:183], v10, s[16:19], s52 offen offset:1024 sc1
MAA 88,76,184
s_add_u32 s52, s52, 131072
MAA 88,72,168
MAA 72,64,168
MAA 72,68,184
MAA 76,68,188
s_add_u32 s15, s15, 1
MAA 76,64,172
s_cbranch_scc0 .Lk43
s_branch .Lj48
.Lx39:
buffer_load_dword a220, v8, s[40:43], s45 offen
buffer_load_dword a220, v7, s[28:31], s44 offen
s_add_u32 s44, s44, 655360
s_add_u32 s45, s45, 917504
s_mov_b32 s47, 3
s_branch .Lx39b
.Lx40:
buffer_load_dword a220, v8, s[40:43], s45 offen
buffer_load_dword a220, v7, s[28:31], s44 offen
s_add_u32 s44, s44, 655360
s_add_u32 s45, s45, 917504
s_mov_b32 s47, 3
s_branch .Lx40b
.Lx41:
buffer_load_dword a220, v8, s[40:43], s45 offen
buffer_load_dword a220, v7, s[28:31], s44 offen
s_add_u32 s44, s44, 655360
s_add_u32 s45, s45, 917504
s_mov_b32 s47, 3
s_branch .Lx41b
.Lx42:
buffer_load_dword a220, v8, s[40:43], s45 offen
buffer_load_dword a220, v7, s[28:31], s44 offen
s_add_u32 s44, s44, 655360
s_add_u32 s45, s45, 917504
s_mov_b32 s47, 3
s_branch .Lx42b
.Lx44:
buffer_load_dword a220, v8, s[40:43], s45 offen
buffer_load_dword a220, v7, s[28:31], s44 offen
s_add_u32 s44, s44, 655360
s_add_u32 s45, s45, 917504
s_mov_b32 s47, 3
s_branch .Lx44b
.Lx45:
buffer_load_dword a220, v8, s[40:43], s45 offen
buffer_load_dword a220, v7, s[28:31], s44 offen
s_add_u32 s44, s44, 655360
s_add_u32 s45, s45, 917504
s_mov_b32 s47, 3
s_branch .Lx45b
.Lx46:
buffer_load_dword a220, v8, s[40:43], s45 offen
buffer_load_dword a220, v7, s[28:31], s44 offen
s_add_u32 s44, s44, 655360
s_add_u32 s45, s45, 917504
s_mov_b32 s47, 3
s_branch .Lx46b
.Lx47:
buffer_load_dword a220, v8, s[40:43], s45 offen
buffer_load_dword a220, v7, s[28:31], s44 offen
s_add_u32 s44, s44, 655360
s_add_u32 s45, s45, 917504
s_mov_b32 s47, 3
s_branch .Lx47b
.Lj48:
s_waitcnt vmcnt(10) lgkmcnt(0)
s_barrier
v_smfmac_f32_16x16x64_bf16 a[212:215], a[208:211], a[192:199], v6
RD 112,9,16896
s_lshl_b32 s74, s3, 10
v_smfmac_f32_16x16x64_bf16 a[212:215], a[208:211], a[200:207], v6
RD 116,9,17952
s_add_u32 s74, s74, 152576
MAA 32,0,128
RD 120,9,19008
s_sub_u32 s75, 156672, s74
MAA 32,4,144
RD 124,9,20064
v_and_b32 v7, 15, v1
MAA 48,12,144
RD 192,9,33792
v_lshl_add_u32 v7, v7, 5, s74
MAA 48,8,128
RD 196,9,34848
v_bfe_u32 v2, v1, 4, 1
MAA 36,0,132
RD 200,9,35904
v_lshl_add_u32 v7, v2, 4, v7
MAA 36,4,148
RD 204,9,36960
v_bfe_u32 v2, v1, 5, 1
MAA 52,12,148
buffer_load_dwordx4 a[168:171], v11, s[16:19], s53 offen sc1
MAA 52,8,132
TR 64,16,16896
v_mul_u32_u24 v2, s75, v2
s_waitcnt lgkmcnt(7)
v_smfmac_f32_16x16x64_bf16 a[216:219], a[208:211], a[112:119], v6
TR 66,16,17408
v_add_u32 v7, v7, v2
MAA 40,0,136
TR 68,16,25344
v_lshlrev_b32 v2, 4, v1
s_waitcnt lgkmcnt(7)
v_smfmac_f32_16x16x64_bf16 a[216:219], a[208:211], a[120:127], v6
buffer_load_dwordx4 a[172:175], v11, s[16:19], s53 offen offset:1024 sc1
MAA 40,4,152
TR 70,16,25856
s_add_u32 s53, s53, 131072
s_waitcnt lgkmcnt(6)
v_smfmac_f32_16x16x64_bf16 a[212:215], a[208:211], a[192:199], v6
TR 72,16,16928
v_add_u32 v2, 152576, v2
MAA 56,12,152
TR 74,16,17440
s_lshl_b32 s74, s12, 7
s_waitcnt lgkmcnt(6)
v_smfmac_f32_16x16x64_bf16 a[212:215], a[208:211], a[200:207], v6
buffer_load_dwordx4 a[184:187], v11, s[16:19], s53 offen sc1
MAA 56,8,136
TR 76,16,25376
s_add_u32 s74, s74, 161536
MAA 44,0,140
TR 78,16,25888
s_waitcnt vmcnt(8)
s_barrier
MAA 44,4,156
RD 112,9,50688
s_xor_b32 s75, s12, 1
MAA 60,12,156
RD 116,9,51744
s_mul_i32 s75, s75, 384
MAA 60,8,140
RD 120,9,52800
s_add_u32 s75, s75, 161536
MAA 96,16,128
RD 124,9,53856
v_lshrrev_b32 v9, 4, v1
MAA 96,20,144
ds_write_b128 v7, a[212:215]
v_lshlrev_b32 v9, 4, v9
MAA 112,28,144
buffer_load_dwordx4 a[188:191], v11, s[16:19], s53 offen offset:1024 sc1
MAA 112,24,128
TR 80,16,33792
s_add_u32 s53, s53, 131072
MAA 100,16,132
TR 82,16,34304
v_add_u32 v8, s75, v9
MAA 100,20,148
TR 84,16,42240
v_add_u32 v9, s74, v9
MAA 116,28,148
TR 86,16,42752
s_add_u32 s58, s99, 2293760
s_waitcnt lgkmcnt(7)
v_smfmac_f32_16x16x64_bf16 a[216:219], a[208:211], a[112:119], v6
TR 88,16,33824
s_lshl_b32 s74, s3, 11
MAA 116,24,132
TR 90,16,34336
s_add_u32 s74, s74, s84
s_waitcnt lgkmcnt(7)
v_smfmac_f32_16x16x64_bf16 a[216:219], a[208:211], a[120:127], v6
TR 92,16,42272
s_add_u32 s54, s98, 65536
MAA 104,16,136
TR 94,16,42784
s_mul_i32 s55, s3, 2112
MAA 104,20,152
TR 96,16,50688
s_mov_b32 s57, 67584
MAA 120,28,152
ds_write_b128 v7, a[216:219] offset:512
MAA 120,24,136
TR 98,16,51200
MAA 108,16,140
TR 100,16,59136
MAA 108,20,156
TR 102,16,59648
MAA 124,28,156
TR 104,16,50720
MAA 124,24,140
TR 106,16,51232
MAA 160,32,128
TR 108,16,59168
MAA 160,36,144
TR 110,16,59680
MAA 176,44,144
s_waitcnt lgkmcnt(7)
s_barrier
ds_read_b128 v[12:15], v2
MAA 176,40,128
ds_read_b128 v[4:7], v2 offset:1024
MAA 164,32,132
TR 192,16,16960
MAA 164,36,148
TR 194,16,17472
MAA 180,44,148
TR 196,16,25408
MAA 180,40,132
TR 198,16,25920
MAA 168,32,136
TR 200,16,16992
MAA 168,36,152
TR 202,16,17504
MAA 184,44,152
TR 204,16,25440
MAA 184,40,136
TR 206,16,25952
s_waitcnt lgkmcnt(8)
v_add_f32 v12, v12, v4
MAA 172,32,140
TR 112,16,33856
v_add_f32 v13, v13, v5
MAA 172,36,156
TR 114,16,34368
v_add_f32 v14, v14, v6
MAA 188,44,156
TR 116,16,42304
v_add_f32 v15, v15, v7
MAA 188,40,140
ds_read_b128 v[4:7], v2 offset:2048
MAA 224,48,128
TR 118,16,42816
MAA 224,52,144
TR 120,16,33888
MAA 232,60,144
TR 122,16,34400
MAA 232,56,128
TR 124,16,42336
MAA 228,48,132
TR 126,16,42848
MAA 228,52,148
TR 0,16,50752
MAA 236,60,148
TR 2,16,51264
MAA 236,56,132
TR 4,16,59200
s_waitcnt lgkmcnt(8)
v_add_f32 v12, v12, v4
MAA 64,64,128
TR 6,16,59712
v_add_f32 v13, v13, v5
MAA 64,68,144
TR 8,16,50784
v_add_f32 v14, v14, v6
s_waitcnt vmcnt(7)
MAA 64,96,160
TR 10,16,51296
v_add_f32 v15, v15, v7
s_waitcnt vmcnt(5)
MAA 64,100,176
ds_read_b128 v[4:7], v2 offset:3072
MAA 80,108,176
TR 12,16,59232
MAA 80,104,160
TR 14,16,59744
MAA 80,76,144
TR 16,16,17024
MAA 80,72,128
TR 18,16,17536
MAA 32,80,160
TR 20,16,25472
MAA 32,84,176
TR 22,16,25984
MAA 48,92,176
TR 24,16,17056
MAA 48,88,160
TR 26,16,17568
s_waitcnt lgkmcnt(8)
v_add_f32 v12, v12, v4
v_add_f32 v13, v13, v5
v_add_f32 v14, v14, v6
v_add_f32 v15, v15, v7
ds_write_b128 v2, v[12:15] offset:8960
ds_read_b128 v[12:15], v9
ds_read_b128 v[4:7], v9 offset:64
v_lshrrev_b32 v2, 3, v1
v_cmp_eq_u32 vcc, 3, v2
TR 28,16,25504
TR 30,16,26016
TR 32,16,33920
TR 34,16,34432
TR 36,16,42368
TR 38,16,42880
TR 40,16,33952
TR 42,16,34464
TR 44,16,42400
TR 46,16,42912
TR 48,16,50816
TR 50,16,51328
TR 52,16,59264
s_waitcnt lgkmcnt(14)
v_pk_fma_f32 v[32:33], v[12:13], v[20:21], v[32:33] op_sel_hi:[1,0,1]
v_pk_fma_f32 v[34:35], v[14:15], v[20:21], v[34:35] op_sel_hi:[1,0,1]
v_pk_fma_f32 v[36:37], v[12:13], v[22:23], v[36:37] op_sel_hi:[1,0,1]
v_pk_fma_f32 v[38:39], v[14:15], v[22:23], v[38:39] op_sel_hi:[1,0,1]
v_pk_fma_f32 v[40:41], v[12:13], v[24:25], v[40:41] op_sel_hi:[1,0,1]
v_pk_fma_f32 v[42:43], v[14:15], v[24:25], v[42:43] op_sel_hi:[1,0,1]
v_pk_fma_f32 v[44:45], v[12:13], v[26:27], v[44:45] op_sel_hi:[1,0,1]
v_pk_fma_f32 v[46:47], v[14:15], v[26:27], v[46:47] op_sel_hi:[1,0,1]
ds_read_b128 v[12:15], v9 offset:512
s_waitcnt lgkmcnt(14)
v_pk_fma_f32 v[48:49], v[4:5], v[20:21], v[48:49] op_sel_hi:[1,0,1]
v_pk_fma_f32 v[50:51], v[6:7], v[20:21], v[50:51] op_sel_hi:[1,0,1]
v_pk_fma_f32 v[52:53], v[4:5], v[22:23], v[52:53] op_sel_hi:[1,0,1]
v_pk_fma_f32 v[54:55], v[6:7], v[22:23], v[54:55] op_sel_hi:[1,0,1]
v_pk_fma_f32 v[56:57], v[4:5], v[24:25], v[56:57] op_sel_hi:[1,0,1]
v_pk_fma_f32 v[58:59], v[6:7], v[24:25], v[58:59] op_sel_hi:[1,0,1]
v_pk_fma_f32 v[60:61], v[4:5], v[26:27], v[60:61] op_sel_hi:[1,0,1]
v_pk_fma_f32 v[62:63], v[6:7], v[26:27], v[62:63] op_sel_hi:[1,0,1]
ds_read_b128 v[4:7], v9 offset:576
TR 54,16,59776
TR 56,16,50848
TR 58,16,51360
TR 60,16,59296
TR 62,16,59808
s_waitcnt lgkmcnt(6)
v_pk_fma_f32 v[64:65], v[12:13], v[20:21], v[64:65] op_sel_hi:[1,0,1]
v_pk_fma_f32 v[66:67], v[14:15], v[20:21], v[66:67] op_sel_hi:[1,0,1]
v_pk_fma_f32 v[68:69], v[12:13], v[22:23], v[68:69] op_sel_hi:[1,0,1]
v_pk_fma_f32 v[70:71], v[14:15], v[22:23], v[70:71] op_sel_hi:[1,0,1]
v_pk_fma_f32 v[72:73], v[12:13], v[24:25], v[72:73] op_sel_hi:[1,0,1]
v_pk_fma_f32 v[74:75], v[14:15], v[24:25], v[74:75] op_sel_hi:[1,0,1]
v_pk_fma_f32 v[76:77], v[12:13], v[26:27], v[76:77] op_sel_hi:[1,0,1]
v_pk_fma_f32 v[78:79], v[14:15], v[26:27], v[78:79] op_sel_hi:[1,0,1]
ds_read_b128 v[12:15], v9 offset:832
s_waitcnt lgkmcnt(6)
v_pk_fma_f32 v[80:81], v[4:5], v[20:21], v[80:81] op_sel_hi:[1,0,1]
v_pk_fma_f32 v[82:83], v[6:7], v[20:21], v[82:83] op_sel_hi:[1,0,1]
v_pk_fma_f32 v[84:85], v[4:5], v[22:23], v[84:85] op_sel_hi:[1,0,1]
v_pk_fma_f32 v[86:87], v[6:7], v[22:23], v[86:87] op_sel_hi:[1,0,1]
v_pk_fma_f32 v[88:89], v[4:5], v[24:25], v[88:89] op_sel_hi:[1,0,1]
v_pk_fma_f32 v[90:91], v[6:7], v[24:25], v[90:91] op_sel_hi:[1,0,1]
v_pk_fma_f32 v[92:93], v[4:5], v[26:27], v[92:93] op_sel_hi:[1,0,1]
v_pk_fma_f32 v[94:95], v[6:7], v[26:27], v[94:95] op_sel_hi:[1,0,1]
ds_read_b128 v[4:7], v9 offset:704
v_pk_mul_f32 v[64:65], v[64:65], v[32:33]
v_pk_mul_f32 v[32:33], v[32:33], v[28:29] op_sel_hi:[1,0]
v_pk_mul_f32 v[66:67], v[66:67], v[34:35]
v_pk_mul_f32 v[34:35], v[34:35], v[28:29] op_sel_hi:[1,0]
v_pk_mul_f32 v[80:81], v[80:81], v[48:49]
v_pk_mul_f32 v[48:49], v[48:49], v[28:29] op_sel_hi:[1,0]
v_pk_mul_f32 v[82:83], v[82:83], v[50:51]
v_pk_mul_f32 v[50:51], v[50:51], v[28:29] op_sel_hi:[1,0]
v_exp_f32 v32, v32
v_exp_f32 v33, v33
MAA 68,64,132
v_exp_f32 v34, v34
MAA 68,68,148
v_exp_f32 v35, v35
MAA 68,96,164
v_exp_f32 v48, v48
s_waitcnt vmcnt(4)
MAA 68,100,180
v_exp_f32 v49, v49
MAA 84,108,180
v_exp_f32 v50, v50
MAA 84,104,164
v_exp_f32 v51, v51
MAA 84,76,148
MAA 84,72,132
MAA 36,80,164
MAA 36,84,180
MAA 52,92,180
MAA 52,88,164
s_nop 5
v_pk_mul_f32 v[68:69], v[68:69], v[36:37]
v_pk_fma_f32 v[32:33], v[32:33], v[20:21], v[20:21] op_sel:[0,1,1] op_sel_hi:[1,1,1]
v_pk_fma_f32 v[34:35], v[34:35], v[20:21], v[20:21] op_sel:[0,1,1] op_sel_hi:[1,1,1]
v_pk_fma_f32 v[48:49], v[48:49], v[20:21], v[20:21] op_sel:[0,1,1] op_sel_hi:[1,1,1]
v_pk_fma_f32 v[50:51], v[50:51], v[20:21], v[20:21] op_sel:[0,1,1] op_sel_hi:[1,1,1]
v_rcp_f32 v32, v32
v_pk_mul_f32 v[36:37], v[36:37], v[28:29] op_sel:[0,1] op_sel_hi:[1,1]
v_pk_mul_f32 v[70:71], v[70:71], v[38:39]
v_pk_mul_f32 v[38:39], v[38:39], v[28:29] op_sel:[0,1] op_sel_hi:[1,1]
v_pk_mul_f32 v[84:85], v[84:85], v[52:53]
v_pk_mul_f32 v[52:53], v[52:53], v[28:29] op_sel:[0,1] op_sel_hi:[1,1]
v_pk_mul_f32 v[86:87], v[86:87], v[54:55]
v_pk_mul_f32 v[54:55], v[54:55], v[28:29] op_sel:[0,1] op_sel_hi:[1,1]
v_rcp_f32 v33, v33
v_rcp_f32 v34, v34
MAA 72,64,136
v_rcp_f32 v35, v35
MAA 72,68,152
v_rcp_f32 v48, v48
s_waitcnt vmcnt(3)
MAA 72,96,168
v_rcp_f32 v49, v49
s_waitcnt vmcnt(1)
MAA 72,100,184
v_rcp_f32 v50, v50
MAA 88,108,184
v_rcp_f32 v51, v51
MAA 88,104,168
v_exp_f32 v36, v36
MAA 88,76,152
v_exp_f32 v37, v37
MAA 88,72,136
v_exp_f32 v38, v38
MAA 40,80,168
v_exp_f32 v39, v39
MAA 40,84,184
v_exp_f32 v52, v52
MAA 56,92,184
v_exp_f32 v53, v53
MAA 56,88,168
v_exp_f32 v54, v54
v_exp_f32 v55, v55
v_pk_mul_f32 v[64:65], v[64:65], v[32:33]
v_pk_mul_f32 v[66:67], v[66:67], v[34:35]
v_pk_mul_f32 v[80:81], v[80:81], v[48:49]
v_pk_mul_f32 v[82:83], v[82:83], v[50:51]
ds_read_b128 v[48:51], v9 offset:128
v_pk_mul_f32 v[72:73], v[72:73], v[40:41]
v_pk_mul_f32 v[40:41], v[40:41], v[30:31] op_sel_hi:[1,0]
v_pk_mul_f32 v[74:75], v[74:75], v[42:43]
v_pk_mul_f32 v[42:43], v[42:43], v[30:31] op_sel_hi:[1,0]
v_pk_mul_f32 v[88:89], v[88:89], v[56:57]
v_pk_mul_f32 v[56:57], v[56:57], v[30:31] op_sel_hi:[1,0]
v_pk_mul_f32 v[90:91], v[90:91], v[58:59]
v_pk_mul_f32 v[58:59], v[58:59], v[30:31] op_sel_hi:[1,0]
v_pk_fma_f32 v[36:37], v[36:37], v[22:23], v[22:23] op_sel:[0,1,1] op_sel_hi:[1,1,1]
v_pk_fma_f32 v[38:39], v[38:39], v[22:23], v[22:23] op_sel:[0,1,1] op_sel_hi:[1,1,1]
v_pk_fma_f32 v[52:53], v[52:53], v[22:23], v[22:23] op_sel:[0,1,1] op_sel_hi:[1,1,1]
v_pk_fma_f32 v[54:55], v[54:55], v[22:23], v[22:23] op_sel:[0,1,1] op_sel_hi:[1,1,1]
v_cvt_pk_bf16_f32 v32, v64, v65
v_cvt_pk_bf16_f32 v33, v66, v67
ds_read_b128 v[64:67], v9 offset:192
v_cvt_pk_bf16_f32 v34, v80, v81
v_cvt_pk_bf16_f32 v35, v82, v83
MAA 76,64,140
buffer_store_dwordx4 v[32:35], v10, s[16:19], s62 offen sc1
MAA 76,68,156
ds_read_b128 v[80:83], v9 offset:640
v_rcp_f32 v36, v36
MAA 76,96,172
TR 64,17,16896
v_rcp_f32 v37, v37
s_waitcnt vmcnt(1)
MAA 76,100,188
TR 66,17,17408
v_rcp_f32 v38, v38
MAA 92,108,188
TR 68,17,25344
v_rcp_f32 v39, v39
MAA 92,104,172
TR 70,17,25856
v_rcp_f32 v52, v52
MAA 92,76,156
TR 76,17,25376
v_rcp_f32 v53, v53
MAA 92,72,140
TR 72,17,16928
v_rcp_f32 v54, v54
MAA 44,80,172
TR 74,17,17440
v_rcp_f32 v55, v55
MAA 44,84,188
TR 78,17,25888
v_exp_f32 v40, v40
MAA 60,92,188
TR 80,17,33792
.Lpad15:
s_cbranch_execz .Lnopoll34r
v_exp_f32 v41, v41
MAA 60,88,172
TR 82,17,34304
v_exp_f32 v42, v42
v_exp_f32 v43, v43
v_exp_f32 v56, v56
v_exp_f32 v57, v57
v_exp_f32 v58, v58
v_exp_f32 v59, v59
v_pk_mul_f32 v[68:69], v[68:69], v[36:37]
v_pk_mul_f32 v[70:71], v[70:71], v[38:39]
v_pk_mul_f32 v[84:85], v[84:85], v[52:53]
v_pk_mul_f32 v[86:87], v[86:87], v[54:55]
ds_read_b128 v[52:55], v8 offset:576
v_pk_mul_f32 v[76:77], v[76:77], v[44:45]
v_pk_mul_f32 v[44:45], v[44:45], v[30:31] op_sel:[0,1] op_sel_hi:[1,1]
v_pk_mul_f32 v[78:79], v[78:79], v[46:47]
v_pk_mul_f32 v[46:47], v[46:47], v[30:31] op_sel:[0,1] op_sel_hi:[1,1]
v_pk_mul_f32 v[92:93], v[92:93], v[60:61]
v_pk_mul_f32 v[60:61], v[60:61], v[30:31] op_sel:[0,1] op_sel_hi:[1,1]
v_pk_mul_f32 v[94:95], v[94:95], v[62:63]
v_pk_mul_f32 v[62:63], v[62:63], v[30:31] op_sel:[0,1] op_sel_hi:[1,1]
v_pk_fma_f32 v[40:41], v[40:41], v[24:25], v[24:25] op_sel:[0,1,1] op_sel_hi:[1,1,1]
v_pk_fma_f32 v[42:43], v[42:43], v[24:25], v[24:25] op_sel:[0,1,1] op_sel_hi:[1,1,1]
v_pk_fma_f32 v[56:57], v[56:57], v[24:25], v[24:25] op_sel:[0,1,1] op_sel_hi:[1,1,1]
v_pk_fma_f32 v[58:59], v[58:59], v[24:25], v[24:25] op_sel:[0,1,1] op_sel_hi:[1,1,1]
v_cvt_pk_bf16_f32 v36, v68, v69
v_cvt_pk_bf16_f32 v37, v70, v71
v_cvt_pk_bf16_f32 v38, v84, v85
v_cvt_pk_bf16_f32 v39, v86, v87
MAA 128,192,128
buffer_store_dwordx4 v[36:39], v10, s[16:19], s62 offen offset:1024 sc1
MAA 128,196,144
TR 84,17,42240
v_rcp_f32 v40, v40
MAA 128,0,160
TR 86,17,42752
v_rcp_f32 v41, v41
MAA 128,4,176
TR 88,17,33824
v_rcp_f32 v42, v42
MAA 144,12,176
TR 90,17,34336
v_rcp_f32 v43, v43
MAA 144,8,160
TR 92,17,42272
v_rcp_f32 v56, v56
MAA 144,204,144
TR 94,17,42784
v_rcp_f32 v57, v57
MAA 144,200,128
TR 96,17,50688
v_rcp_f32 v58, v58
MAA 96,112,160
TR 98,17,51200
v_rcp_f32 v59, v59
MAA 96,116,176
TR 100,17,59136
v_exp_f32 v44, v44
MAA 112,124,176
TR 102,17,59648
v_exp_f32 v45, v45
MAA 112,120,160
TR 104,17,50720
v_lshrrev_b32 v69, 2, v0
v_min_u32 v69, 1, v69
v_lshlrev_b32 v69, 28, v69
v_lshl_add_u32 v68, v0, 7, v69
v_xor_b32 v69, 64, v0
v_min_u32 v69, 1, v69
v_lshlrev_b32 v70, 4, v69
v_sub_u32 v70, 16, v70
v_lshlrev_b32 v69, 28, v69
v_mov_b32 v71, 1
v_mov_b32 v84, 0
v_mov_b32 v85, 0
v_mov_b32 v86, 0
v_exp_f32 v46, v46
v_exp_f32 v47, v47
v_exp_f32 v60, v60
v_exp_f32 v61, v61
v_exp_f32 v62, v62
v_exp_f32 v63, v63
v_pk_mul_f32 v[72:73], v[72:73], v[40:41]
v_pk_mul_f32 v[74:75], v[74:75], v[42:43]
v_pk_mul_f32 v[88:89], v[88:89], v[56:57]
v_pk_mul_f32 v[90:91], v[90:91], v[58:59]
s_waitcnt lgkmcnt(15)
v_pk_fma_f32 v[96:97], v[48:49], v[20:21], v[96:97] op_sel_hi:[1,0,1]
v_pk_fma_f32 v[98:99], v[50:51], v[20:21], v[98:99] op_sel_hi:[1,0,1]
v_pk_fma_f32 v[112:113], v[64:65], v[20:21], v[112:113] op_sel_hi:[1,0,1]
v_pk_fma_f32 v[114:115], v[66:67], v[20:21], v[114:115] op_sel_hi:[1,0,1]
v_pk_fma_f32 v[128:129], v[80:81], v[20:21], v[128:129] op_sel_hi:[1,0,1]
v_pk_fma_f32 v[130:131], v[82:83], v[20:21], v[130:131] op_sel_hi:[1,0,1]
v_pk_fma_f32 v[144:145], v[4:5], v[20:21], v[144:145] op_sel_hi:[1,0,1]
v_pk_fma_f32 v[146:147], v[6:7], v[20:21], v[146:147] op_sel_hi:[1,0,1]
v_pk_mul_f32 v[128:129], v[128:129], v[96:97]
v_pk_mul_f32 v[96:97], v[96:97], v[28:29] op_sel_hi:[1,0]
v_pk_mul_f32 v[130:131], v[130:131], v[98:99]
v_pk_mul_f32 v[98:99], v[98:99], v[28:29] op_sel_hi:[1,0]
v_pk_mul_f32 v[144:145], v[144:145], v[112:113]
v_pk_mul_f32 v[112:113], v[112:113], v[28:29] op_sel_hi:[1,0]
v_pk_mul_f32 v[146:147], v[146:147], v[114:115]
v_pk_mul_f32 v[114:115], v[114:115], v[28:29] op_sel_hi:[1,0]
v_pk_fma_f32 v[44:45], v[44:45], v[26:27], v[26:27] op_sel:[0,1,1] op_sel_hi:[1,1,1]
v_pk_fma_f32 v[46:47], v[46:47], v[26:27], v[26:27] op_sel:[0,1,1] op_sel_hi:[1,1,1]
v_pk_fma_f32 v[60:61], v[60:61], v[26:27], v[26:27] op_sel:[0,1,1] op_sel_hi:[1,1,1]
v_pk_fma_f32 v[62:63], v[62:63], v[26:27], v[26:27] op_sel:[0,1,1] op_sel_hi:[1,1,1]
v_cvt_pk_bf16_f32 v40, v72, v73
v_cvt_pk_bf16_f32 v41, v74, v75
v_cvt_pk_bf16_f32 v42, v88, v89
v_cvt_pk_bf16_f32 v43, v90, v91
MAA 132,192,132
buffer_store_dwordx4 v[40:43], v11, s[16:19], s62 offen sc1
MAA 132,196,148
TR 106,17,51232
v_rcp_f32 v44, v44
MAA 132,0,164
TR 108,17,59168
v_rcp_f32 v45, v45
MAA 132,4,180
TR 110,17,59680
v_rcp_f32 v46, v46
MAA 148,12,180
v_rcp_f32 v47, v47
MAA 148,8,164
v_rcp_f32 v60, v60
MAA 148,204,148
v_rcp_f32 v61, v61
MAA 148,200,132
v_rcp_f32 v62, v62
MAA 100,112,164
v_rcp_f32 v63, v63
MAA 100,116,180
v_exp_f32 v96, v96
MAA 116,124,180
v_exp_f32 v97, v97
MAA 116,120,164
s_waitcnt lgkmcnt(0)
s_barrier
s_add_u32 m0, s59, 84480
v_exp_f32 v98, v98
v_exp_f32 v99, v99
v_exp_f32 v112, v112
v_exp_f32 v113, v113
v_exp_f32 v114, v114
v_exp_f32 v115, v115
v_pk_mul_f32 v[76:77], v[76:77], v[44:45]
v_pk_mul_f32 v[78:79], v[78:79], v[46:47]
v_pk_mul_f32 v[92:93], v[92:93], v[60:61]
v_pk_mul_f32 v[94:95], v[94:95], v[62:63]
v_pk_fma_f32 v[100:101], v[48:49], v[22:23], v[100:101] op_sel_hi:[1,0,1]
v_pk_fma_f32 v[102:103], v[50:51], v[22:23], v[102:103] op_sel_hi:[1,0,1]
v_pk_fma_f32 v[116:117], v[64:65], v[22:23], v[116:117] op_sel_hi:[1,0,1]
v_pk_fma_f32 v[118:119], v[66:67], v[22:23], v[118:119] op_sel_hi:[1,0,1]
v_pk_fma_f32 v[132:133], v[80:81], v[22:23], v[132:133] op_sel_hi:[1,0,1]
v_pk_fma_f32 v[134:135], v[82:83], v[22:23], v[134:135] op_sel_hi:[1,0,1]
v_pk_fma_f32 v[148:149], v[4:5], v[22:23], v[148:149] op_sel_hi:[1,0,1]
v_pk_fma_f32 v[150:151], v[6:7], v[22:23], v[150:151] op_sel_hi:[1,0,1]
v_pk_mul_f32 v[132:133], v[132:133], v[100:101]
v_pk_mul_f32 v[100:101], v[100:101], v[28:29] op_sel:[0,1] op_sel_hi:[1,1]
v_pk_mul_f32 v[134:135], v[134:135], v[102:103]
v_pk_mul_f32 v[102:103], v[102:103], v[28:29] op_sel:[0,1] op_sel_hi:[1,1]
v_pk_mul_f32 v[148:149], v[148:149], v[116:117]
v_pk_mul_f32 v[116:117], v[116:117], v[28:29] op_sel:[0,1] op_sel_hi:[1,1]
v_pk_mul_f32 v[150:151], v[150:151], v[118:119]
v_pk_mul_f32 v[118:119], v[118:119], v[28:29] op_sel:[0,1] op_sel_hi:[1,1]
v_pk_fma_f32 v[96:97], v[96:97], v[20:21], v[20:21] op_sel:[0,1,1] op_sel_hi:[1,1,1]
v_pk_fma_f32 v[98:99], v[98:99], v[20:21], v[20:21] op_sel:[0,1,1] op_sel_hi:[1,1,1]
v_pk_fma_f32 v[112:113], v[112:113], v[20:21], v[20:21] op_sel:[0,1,1] op_sel_hi:[1,1,1]
v_pk_fma_f32 v[114:115], v[114:115], v[20:21], v[20:21] op_sel:[0,1,1] op_sel_hi:[1,1,1]
v_cvt_pk_bf16_f32 v44, v76, v77
v_cvt_pk_bf16_f32 v45, v78, v79
v_cvt_pk_bf16_f32 v46, v92, v93
v_cvt_pk_bf16_f32 v47, v94, v95
MAA 136,192,136
buffer_store_dwordx4 v[44:47], v11, s[16:19], s62 offen offset:1024 sc1
MAA 136,196,152
v_rcp_f32 v96, v96
MAA 136,0,168
v_rcp_f32 v97, v97
MAA 136,4,184
v_rcp_f32 v98, v98
MAA 152,12,184
buffer_load_dwordx4 v18, s[28:31], s58 offen lds
MAA 152,8,168
v_rcp_f32 v99, v99
MAA 152,204,152
v_rcp_f32 v112, v112
MAA 152,200,136
v_rcp_f32 v113, v113
MAA 104,112,168
buffer_load_dwordx4 v19, s[28:31], s58 offen offset:1056 lds
MAA 104,116,184
s_add_u32 m0, s59, 92928
s_add_u32 s58, s99, 2555904
v_rcp_f32 v114, v114
MAA 120,124,184
v_rcp_f32 v115, v115
MAA 120,120,168
v_exp_f32 v100, v100
v_exp_f32 v101, v101
v_exp_f32 v102, v102
v_exp_f32 v103, v103
v_exp_f32 v116, v116
v_exp_f32 v117, v117
v_exp_f32 v118, v118
v_exp_f32 v119, v119
v_pk_mul_f32 v[128:129], v[128:129], v[96:97]
v_pk_mul_f32 v[130:131], v[130:131], v[98:99]
v_pk_mul_f32 v[144:145], v[144:145], v[112:113]
v_pk_mul_f32 v[146:147], v[146:147], v[114:115]
ds_read_b128 v[112:115], v9 offset:256
v_pk_fma_f32 v[104:105], v[48:49], v[24:25], v[104:105] op_sel_hi:[1,0,1]
v_pk_fma_f32 v[106:107], v[50:51], v[24:25], v[106:107] op_sel_hi:[1,0,1]
v_pk_fma_f32 v[120:121], v[64:65], v[24:25], v[120:121] op_sel_hi:[1,0,1]
v_pk_fma_f32 v[122:123], v[66:67], v[24:25], v[122:123] op_sel_hi:[1,0,1]
v_pk_fma_f32 v[136:137], v[80:81], v[24:25], v[136:137] op_sel_hi:[1,0,1]
v_pk_fma_f32 v[138:139], v[82:83], v[24:25], v[138:139] op_sel_hi:[1,0,1]
v_pk_fma_f32 v[152:153], v[4:5], v[24:25], v[152:153] op_sel_hi:[1,0,1]
v_pk_fma_f32 v[154:155], v[6:7], v[24:25], v[154:155] op_sel_hi:[1,0,1]
v_pk_mul_f32 v[136:137], v[136:137], v[104:105]
v_pk_mul_f32 v[104:105], v[104:105], v[30:31] op_sel_hi:[1,0]
v_pk_mul_f32 v[138:139], v[138:139], v[106:107]
v_pk_mul_f32 v[106:107], v[106:107], v[30:31] op_sel_hi:[1,0]
v_pk_mul_f32 v[152:153], v[152:153], v[120:121]
v_pk_mul_f32 v[120:121], v[120:121], v[30:31] op_sel_hi:[1,0]
v_pk_mul_f32 v[154:155], v[154:155], v[122:123]
v_pk_mul_f32 v[122:123], v[122:123], v[30:31] op_sel_hi:[1,0]
v_pk_fma_f32 v[100:101], v[100:101], v[22:23], v[22:23] op_sel:[0,1,1] op_sel_hi:[1,1,1]
v_pk_fma_f32 v[102:103], v[102:103], v[22:23], v[22:23] op_sel:[0,1,1] op_sel_hi:[1,1,1]
v_pk_fma_f32 v[116:117], v[116:117], v[22:23], v[22:23] op_sel:[0,1,1] op_sel_hi:[1,1,1]
v_pk_fma_f32 v[118:119], v[118:119], v[22:23], v[22:23] op_sel:[0,1,1] op_sel_hi:[1,1,1]
v_cvt_pk_bf16_f32 v96, v128, v129
v_cvt_pk_bf16_f32 v97, v130, v131
ds_read_b128 v[128:131], v9 offset:320
v_cvt_pk_bf16_f32 v98, v144, v145
v_cvt_pk_bf16_f32 v99, v146, v147
MAA 140,192,140
buffer_store_dwordx4 v[96:99], v10, s[16:19], s63 offen sc1
MAA 140,196,156
ds_read_b128 v[144:147], v9 offset:768
v_rcp_f32 v100, v100
MAA 140,0,172
v_rcp_f32 v101, v101
MAA 140,4,188
v_rcp_f32 v102, v102
MAA 156,12,188
buffer_load_dwordx4 v18, s[28:31], s58 offen lds
MAA 156,8,172
v_rcp_f32 v103, v103
MAA 156,204,156
v_rcp_f32 v116, v116
MAA 156,200,140
v_rcp_f32 v117, v117
MAA 108,112,172
buffer_load_dwordx4 v19, s[28:31], s58 offen offset:1056 lds
MAA 108,116,188
s_add_u32 m0, s59, 101376
s_add_u32 s58, s100, 2752512
v_rcp_f32 v118, v118
MAA 124,124,188
v_rcp_f32 v119, v119
MAA 124,120,172
v_exp_f32 v104, v104
v_exp_f32 v105, v105
v_exp_f32 v106, v106
v_exp_f32 v107, v107
v_exp_f32 v120, v120
v_exp_f32 v121, v121
v_exp_f32 v122, v122
v_exp_f32 v123, v123
v_pk_mul_f32 v[132:133], v[132:133], v[100:101]
v_pk_mul_f32 v[134:135], v[134:135], v[102:103]
v_pk_mul_f32 v[148:149], v[148:149], v[116:117]
v_pk_mul_f32 v[150:151], v[150:151], v[118:119]
v_pk_fma_f32 v[108:109], v[48:49], v[26:27], v[108:109] op_sel_hi:[1,0,1]
v_pk_fma_f32 v[110:111], v[50:51], v[26:27], v[110:111] op_sel_hi:[1,0,1]
v_pk_fma_f32 v[124:125], v[64:65], v[26:27], v[124:125] op_sel_hi:[1,0,1]
v_pk_fma_f32 v[126:127], v[66:67], v[26:27], v[126:127] op_sel_hi:[1,0,1]
v_pk_fma_f32 v[140:141], v[80:81], v[26:27], v[140:141] op_sel_hi:[1,0,1]
v_pk_fma_f32 v[142:143], v[82:83], v[26:27], v[142:143] op_sel_hi:[1,0,1]
v_pk_fma_f32 v[156:157], v[4:5], v[26:27], v[156:157] op_sel_hi:[1,0,1]
v_pk_fma_f32 v[158:159], v[6:7], v[26:27], v[158:159] op_sel_hi:[1,0,1]
v_pk_mul_f32 v[140:141], v[140:141], v[108:109]
v_pk_mul_f32 v[108:109], v[108:109], v[30:31] op_sel:[0,1] op_sel_hi:[1,1]
v_pk_mul_f32 v[142:143], v[142:143], v[110:111]
v_pk_mul_f32 v[110:111], v[110:111], v[30:31] op_sel:[0,1] op_sel_hi:[1,1]
v_pk_mul_f32 v[156:157], v[156:157], v[124:125]
s_waitcnt vmcnt(5)
s_barrier
buffer_atomic_add v71, v68, s[16:19], s72 offen offset:512
v_pk_mul_f32 v[124:125], v[124:125], v[30:31] op_sel:[0,1] op_sel_hi:[1,1]
v_pk_mul_f32 v[158:159], v[158:159], v[126:127]
v_pk_mul_f32 v[126:127], v[126:127], v[30:31] op_sel:[0,1] op_sel_hi:[1,1]
v_pk_fma_f32 v[104:105], v[104:105], v[24:25], v[24:25] op_sel:[0,1,1] op_sel_hi:[1,1,1]
v_pk_fma_f32 v[106:107], v[106:107], v[24:25], v[24:25] op_sel:[0,1,1] op_sel_hi:[1,1,1]
v_pk_fma_f32 v[120:121], v[120:121], v[24:25], v[24:25] op_sel:[0,1,1] op_sel_hi:[1,1,1]
v_pk_fma_f32 v[122:123], v[122:123], v[24:25], v[24:25] op_sel:[0,1,1] op_sel_hi:[1,1,1]
v_cvt_pk_bf16_f32 v100, v132, v133
v_cvt_pk_bf16_f32 v101, v134, v135
v_cvt_pk_bf16_f32 v102, v148, v149
v_cvt_pk_bf16_f32 v103, v150, v151
MAA 192,16,128
v_rcp_f32 v104, v104
MAA 192,20,144
buffer_store_dwordx4 v[100:103], v10, s[16:19], s63 offen offset:1024 sc1
MAA 192,48,160
v_rcp_f32 v105, v105
MAA 192,52,176
v_rcp_f32 v106, v106
MAA 208,60,176
v_rcp_f32 v107, v107
MAA 208,56,160
buffer_load_dwordx4 v18, s[28:31], s58 offen lds
MAA 208,28,144
v_rcp_f32 v120, v120
MAA 208,24,128
v_rcp_f32 v121, v121
MAA 160,32,160
v_rcp_f32 v122, v122
MAA 160,36,176
buffer_load_dwordx4 v19, s[28:31], s58 offen offset:1056 lds
MAA 176,44,176
s_add_u32 m0, s59, 109824
s_add_u32 s58, s100, 3014656
v_rcp_f32 v123, v123
MAA 176,40,160
v_exp_f32 v108, v108
v_exp_f32 v109, v109
v_exp_f32 v110, v110
v_exp_f32 v111, v111
v_exp_f32 v124, v124
v_exp_f32 v125, v125
v_exp_f32 v126, v126
v_exp_f32 v127, v127
v_pk_mul_f32 v[136:137], v[136:137], v[104:105]
v_pk_mul_f32 v[138:139], v[138:139], v[106:107]
v_pk_mul_f32 v[152:153], v[152:153], v[120:121]
v_pk_mul_f32 v[154:155], v[154:155], v[122:123]
s_waitcnt lgkmcnt(2)
v_pk_fma_f32 v[160:161], v[112:113], v[20:21], v[160:161] op_sel_hi:[1,0,1]
v_pk_fma_f32 v[162:163], v[114:115], v[20:21], v[162:163] op_sel_hi:[1,0,1]
s_waitcnt lgkmcnt(1)
v_pk_fma_f32 v[176:177], v[128:129], v[20:21], v[176:177] op_sel_hi:[1,0,1]
v_pk_fma_f32 v[178:179], v[130:131], v[20:21], v[178:179] op_sel_hi:[1,0,1]
s_waitcnt lgkmcnt(0)
v_pk_fma_f32 v[192:193], v[144:145], v[20:21], v[192:193] op_sel_hi:[1,0,1]
v_pk_fma_f32 v[194:195], v[146:147], v[20:21], v[194:195] op_sel_hi:[1,0,1]
v_pk_fma_f32 v[208:209], v[12:13], v[20:21], v[208:209] op_sel_hi:[1,0,1]
v_pk_fma_f32 v[210:211], v[14:15], v[20:21], v[210:211] op_sel_hi:[1,0,1]
v_pk_mul_f32 v[192:193], v[192:193], v[160:161]
v_pk_mul_f32 v[160:161], v[160:161], v[28:29] op_sel_hi:[1,0]
v_pk_mul_f32 v[194:195], v[194:195], v[162:163]
v_pk_mul_f32 v[162:163], v[162:163], v[28:29] op_sel_hi:[1,0]
v_pk_mul_f32 v[208:209], v[208:209], v[176:177]
v_pk_mul_f32 v[176:177], v[176:177], v[28:29] op_sel_hi:[1,0]
v_pk_mul_f32 v[210:211], v[210:211], v[178:179]
v_pk_mul_f32 v[178:179], v[178:179], v[28:29] op_sel_hi:[1,0]
v_pk_fma_f32 v[108:109], v[108:109], v[26:27], v[26:27] op_sel:[0,1,1] op_sel_hi:[1,1,1]
v_pk_fma_f32 v[110:111], v[110:111], v[26:27], v[26:27] op_sel:[0,1,1] op_sel_hi:[1,1,1]
v_pk_fma_f32 v[124:125], v[124:125], v[26:27], v[26:27] op_sel:[0,1,1] op_sel_hi:[1,1,1]
v_pk_fma_f32 v[126:127], v[126:127], v[26:27], v[26:27] op_sel:[0,1,1] op_sel_hi:[1,1,1]
v_cvt_pk_bf16_f32 v104, v136, v137
v_cvt_pk_bf16_f32 v105, v138, v139
v_cvt_pk_bf16_f32 v106, v152, v153
v_cvt_pk_bf16_f32 v107, v154, v155
MAA 196,16,132
buffer_store_dwordx4 v[104:107], v11, s[16:19], s63 offen sc1
MAA 196,20,148
v_rcp_f32 v108, v108
MAA 196,48,164
v_rcp_f32 v109, v109
MAA 196,52,180
v_rcp_f32 v110, v110
MAA 212,60,180
buffer_load_dwordx4 v18, s[28:31], s58 offen lds
MAA 212,56,164
v_rcp_f32 v111, v111
MAA 212,28,148
v_rcp_f32 v124, v124
MAA 212,24,132
v_rcp_f32 v125, v125
MAA 164,32,164
buffer_load_dwordx4 v19, s[28:31], s58 offen offset:1056 lds
MAA 164,36,180
s_add_u32 m0, s59, 118272
s_add_u32 s58, s101, 3211264
v_rcp_f32 v126, v126
MAA 180,44,180
v_rcp_f32 v127, v127
MAA 180,40,164
v_lshl_add_u32 v4, v1, 4, s74
v_add_u32 v2, 67108480, v4
v_cndmask_b32 v4, v4, v2, vcc
s_and_b32 s74, s7, 1
v_bfe_u32 v7, v1, 2, 3
v_mul_u32_u24 v7, 1056, v7
v_bfe_u32 v2, v1, 5, 1
v_lshl_add_u32 v7, v2, 8, v7
v_and_b32 v2, 3, v1
v_lshl_add_u32 v7, v2, 3, v7
s_lshl_b32 s74, s74, 7
s_xor_b32 s75, s74, 128
v_add_u32 v6, s75, v7
v_add_u32 v7, s74, v7
v_exp_f32 v160, v160
v_exp_f32 v161, v161
v_exp_f32 v162, v162
v_exp_f32 v163, v163
v_exp_f32 v176, v176
v_exp_f32 v177, v177
v_exp_f32 v178, v178
v_exp_f32 v179, v179
v_pk_mul_f32 v[140:141], v[140:141], v[108:109]
v_pk_mul_f32 v[142:143], v[142:143], v[110:111]
v_pk_mul_f32 v[156:157], v[156:157], v[124:125]
v_pk_mul_f32 v[158:159], v[158:159], v[126:127]
v_pk_fma_f32 v[164:165], v[112:113], v[22:23], v[164:165] op_sel_hi:[1,0,1]
v_pk_fma_f32 v[166:167], v[114:115], v[22:23], v[166:167] op_sel_hi:[1,0,1]
v_pk_fma_f32 v[180:181], v[128:129], v[22:23], v[180:181] op_sel_hi:[1,0,1]
v_pk_fma_f32 v[182:183], v[130:131], v[22:23], v[182:183] op_sel_hi:[1,0,1]
v_pk_fma_f32 v[196:197], v[144:145], v[22:23], v[196:197] op_sel_hi:[1,0,1]
v_pk_fma_f32 v[198:199], v[146:147], v[22:23], v[198:199] op_sel_hi:[1,0,1]
v_pk_fma_f32 v[212:213], v[12:13], v[22:23], v[212:213] op_sel_hi:[1,0,1]
v_pk_fma_f32 v[214:215], v[14:15], v[22:23], v[214:215] op_sel_hi:[1,0,1]
v_pk_mul_f32 v[196:197], v[196:197], v[164:165]
v_pk_mul_f32 v[164:165], v[164:165], v[28:29] op_sel:[0,1] op_sel_hi:[1,1]
v_pk_mul_f32 v[198:199], v[198:199], v[166:167]
v_pk_mul_f32 v[166:167], v[166:167], v[28:29] op_sel:[0,1] op_sel_hi:[1,1]
v_pk_mul_f32 v[212:213], v[212:213], v[180:181]
v_pk_mul_f32 v[180:181], v[180:181], v[28:29] op_sel:[0,1] op_sel_hi:[1,1]
v_pk_mul_f32 v[214:215], v[214:215], v[182:183]
v_pk_mul_f32 v[182:183], v[182:183], v[28:29] op_sel:[0,1] op_sel_hi:[1,1]
v_pk_fma_f32 v[160:161], v[160:161], v[20:21], v[20:21] op_sel:[0,1,1] op_sel_hi:[1,1,1]
v_pk_fma_f32 v[162:163], v[162:163], v[20:21], v[20:21] op_sel:[0,1,1] op_sel_hi:[1,1,1]
v_pk_fma_f32 v[176:177], v[176:177], v[20:21], v[20:21] op_sel:[0,1,1] op_sel_hi:[1,1,1]
v_pk_fma_f32 v[178:179], v[178:179], v[20:21], v[20:21] op_sel:[0,1,1] op_sel_hi:[1,1,1]
v_cvt_pk_bf16_f32 v108, v140, v141
v_cvt_pk_bf16_f32 v109, v142, v143
v_cvt_pk_bf16_f32 v110, v156, v157
v_cvt_pk_bf16_f32 v111, v158, v159
MAA 200,16,136
buffer_store_dwordx4 v[108:111], v11, s[16:19], s63 offen offset:1024 sc1
MAA 200,20,152
v_rcp_f32 v160, v160
MAA 200,48,168
v_rcp_f32 v161, v161
MAA 200,52,184
v_rcp_f32 v162, v162
MAA 216,60,184
buffer_load_dwordx4 v18, s[28:31], s58 offen lds
MAA 216,56,168
v_rcp_f32 v163, v163
MAA 216,28,152
v_rcp_f32 v176, v176
MAA 216,24,136
v_rcp_f32 v177, v177
MAA 168,32,168
buffer_load_dwordx4 v19, s[28:31], s58 offen offset:1056 lds
MAA 168,36,184
s_add_u32 m0, s59, 126720
s_add_u32 s58, s101, 3473408
v_rcp_f32 v178, v178
MAA 184,44,184
v_rcp_f32 v179, v179
MAA 184,40,168
v_exp_f32 v164, v164
v_exp_f32 v165, v165
v_exp_f32 v166, v166
v_exp_f32 v167, v167
v_exp_f32 v180, v180
v_exp_f32 v181, v181
v_exp_f32 v182, v182
v_exp_f32 v183, v183
v_pk_mul_f32 v[192:193], v[192:193], v[160:161]
v_pk_mul_f32 v[194:195], v[194:195], v[162:163]
v_pk_mul_f32 v[208:209], v[208:209], v[176:177]
v_pk_mul_f32 v[210:211], v[210:211], v[178:179]
ds_read_b128 v[176:179], v8
v_pk_fma_f32 v[168:169], v[112:113], v[24:25], v[168:169] op_sel_hi:[1,0,1]
v_pk_fma_f32 v[170:171], v[114:115], v[24:25], v[170:171] op_sel_hi:[1,0,1]
v_pk_fma_f32 v[184:185], v[128:129], v[24:25], v[184:185] op_sel_hi:[1,0,1]
v_pk_fma_f32 v[186:187], v[130:131], v[24:25], v[186:187] op_sel_hi:[1,0,1]
v_pk_fma_f32 v[200:201], v[144:145], v[24:25], v[200:201] op_sel_hi:[1,0,1]
v_pk_fma_f32 v[202:203], v[146:147], v[24:25], v[202:203] op_sel_hi:[1,0,1]
v_pk_fma_f32 v[216:217], v[12:13], v[24:25], v[216:217] op_sel_hi:[1,0,1]
v_pk_fma_f32 v[218:219], v[14:15], v[24:25], v[218:219] op_sel_hi:[1,0,1]
v_pk_mul_f32 v[200:201], v[200:201], v[168:169]
v_pk_mul_f32 v[168:169], v[168:169], v[30:31] op_sel_hi:[1,0]
v_pk_mul_f32 v[202:203], v[202:203], v[170:171]
v_pk_mul_f32 v[170:171], v[170:171], v[30:31] op_sel_hi:[1,0]
v_pk_mul_f32 v[216:217], v[216:217], v[184:185]
v_pk_mul_f32 v[184:185], v[184:185], v[30:31] op_sel_hi:[1,0]
v_pk_mul_f32 v[218:219], v[218:219], v[186:187]
v_pk_mul_f32 v[186:187], v[186:187], v[30:31] op_sel_hi:[1,0]
v_pk_fma_f32 v[164:165], v[164:165], v[22:23], v[22:23] op_sel:[0,1,1] op_sel_hi:[1,1,1]
v_pk_fma_f32 v[166:167], v[166:167], v[22:23], v[22:23] op_sel:[0,1,1] op_sel_hi:[1,1,1]
v_pk_fma_f32 v[180:181], v[180:181], v[22:23], v[22:23] op_sel:[0,1,1] op_sel_hi:[1,1,1]
v_pk_fma_f32 v[182:183], v[182:183], v[22:23], v[22:23] op_sel:[0,1,1] op_sel_hi:[1,1,1]
v_cvt_pk_bf16_f32 v160, v192, v193
v_cvt_pk_bf16_f32 v161, v194, v195
ds_read_b128 v[192:195], v8 offset:64
v_cvt_pk_bf16_f32 v162, v208, v209
v_cvt_pk_bf16_f32 v163, v210, v211
MAA 204,16,140
buffer_store_dwordx4 v[160:163], v10, s[16:19], s64 offen sc1
MAA 204,20,156
ds_read_b128 v[208:211], v8 offset:512
v_rcp_f32 v164, v164
MAA 204,48,172
v_rcp_f32 v165, v165
MAA 204,52,188
v_rcp_f32 v166, v166
MAA 220,60,188
buffer_atomic_add v84, v69, s[16:19], s73 offen offset:512 sc0
MAA 220,56,172
v_rcp_f32 v167, v167
MAA 220,28,156
v_rcp_f32 v180, v180
MAA 220,24,140
v_rcp_f32 v181, v181
MAA 172,32,172
buffer_load_dwordx4 v18, s[28:31], s58 offen lds
MAA 172,36,188
v_rcp_f32 v182, v182
MAA 188,44,188
v_rcp_f32 v183, v183
MAA 188,40,172
v_exp_f32 v168, v168
v_exp_f32 v169, v169
v_exp_f32 v170, v170
v_exp_f32 v171, v171
v_exp_f32 v184, v184
v_exp_f32 v185, v185
v_exp_f32 v186, v186
v_exp_f32 v187, v187
v_pk_mul_f32 v[196:197], v[196:197], v[164:165]
v_pk_mul_f32 v[198:199], v[198:199], v[166:167]
v_pk_mul_f32 v[212:213], v[212:213], v[180:181]
v_pk_mul_f32 v[214:215], v[214:215], v[182:183]
v_pk_fma_f32 v[172:173], v[112:113], v[26:27], v[172:173] op_sel_hi:[1,0,1]
v_pk_fma_f32 v[174:175], v[114:115], v[26:27], v[174:175] op_sel_hi:[1,0,1]
v_pk_fma_f32 v[188:189], v[128:129], v[26:27], v[188:189] op_sel_hi:[1,0,1]
v_pk_fma_f32 v[190:191], v[130:131], v[26:27], v[190:191] op_sel_hi:[1,0,1]
v_pk_fma_f32 v[204:205], v[144:145], v[26:27], v[204:205] op_sel_hi:[1,0,1]
v_pk_fma_f32 v[206:207], v[146:147], v[26:27], v[206:207] op_sel_hi:[1,0,1]
v_pk_fma_f32 v[220:221], v[12:13], v[26:27], v[220:221] op_sel_hi:[1,0,1]
v_pk_fma_f32 v[222:223], v[14:15], v[26:27], v[222:223] op_sel_hi:[1,0,1]
v_pk_mul_f32 v[204:205], v[204:205], v[172:173]
v_pk_mul_f32 v[172:173], v[172:173], v[30:31] op_sel:[0,1] op_sel_hi:[1,1]
v_pk_mul_f32 v[206:207], v[206:207], v[174:175]
v_pk_mul_f32 v[174:175], v[174:175], v[30:31] op_sel:[0,1] op_sel_hi:[1,1]
v_pk_mul_f32 v[220:221], v[220:221], v[188:189]
v_pk_mul_f32 v[188:189], v[188:189], v[30:31] op_sel:[0,1] op_sel_hi:[1,1]
v_pk_mul_f32 v[222:223], v[222:223], v[190:191]
v_pk_mul_f32 v[190:191], v[190:191], v[30:31] op_sel:[0,1] op_sel_hi:[1,1]
v_pk_fma_f32 v[168:169], v[168:169], v[24:25], v[24:25] op_sel:[0,1,1] op_sel_hi:[1,1,1]
v_pk_fma_f32 v[170:171], v[170:171], v[24:25], v[24:25] op_sel:[0,1,1] op_sel_hi:[1,1,1]
v_pk_fma_f32 v[184:185], v[184:185], v[24:25], v[24:25] op_sel:[0,1,1] op_sel_hi:[1,1,1]
v_pk_fma_f32 v[186:187], v[186:187], v[24:25], v[24:25] op_sel:[0,1,1] op_sel_hi:[1,1,1]
v_cvt_pk_bf16_f32 v164, v196, v197
v_cvt_pk_bf16_f32 v165, v198, v199
v_cvt_pk_bf16_f32 v166, v212, v213
v_cvt_pk_bf16_f32 v167, v214, v215
MAA 240,64,128
buffer_store_dwordx4 v[164:167], v10, s[16:19], s64 offen offset:1024 sc1
MAA 240,68,144
v_rcp_f32 v168, v168
MAA 240,96,160
v_rcp_f32 v169, v169
MAA 240,100,176
v_rcp_f32 v170, v170
MAA 248,108,176
buffer_atomic_add v85, v69, s[16:19], s73 offen offset:512 sc0
MAA 248,104,160
v_rcp_f32 v171, v171
MAA 248,76,144
v_rcp_f32 v184, v184
MAA 248,72,128
v_rcp_f32 v185, v185
MAA 224,80,160
buffer_load_dwordx4 v19, s[28:31], s58 offen offset:1056 lds
MAA 224,84,176
v_rcp_f32 v186, v186
MAA 232,92,176
v_rcp_f32 v187, v187
MAA 232,88,160
v_exp_f32 v172, v172
v_exp_f32 v173, v173
v_exp_f32 v174, v174
v_exp_f32 v175, v175
v_exp_f32 v188, v188
v_exp_f32 v189, v189
v_exp_f32 v190, v190
v_exp_f32 v191, v191
v_pk_mul_f32 v[200:201], v[200:201], v[168:169]
v_pk_mul_f32 v[202:203], v[202:203], v[170:171]
v_pk_mul_f32 v[216:217], v[216:217], v[184:185]
v_pk_mul_f32 v[218:219], v[218:219], v[186:187]
.Lpad16:
s_cbranch_execz .Lpad19
s_waitcnt lgkmcnt(2)
v_pk_fma_f32 v[224:225], v[176:177], v[20:21], v[224:225] op_sel_hi:[1,0,1]
v_pk_fma_f32 v[226:227], v[178:179], v[20:21], v[226:227] op_sel_hi:[1,0,1]
s_waitcnt lgkmcnt(1)
v_pk_fma_f32 v[232:233], v[192:193], v[20:21], v[232:233] op_sel_hi:[1,0,1]
v_pk_fma_f32 v[234:235], v[194:195], v[20:21], v[234:235] op_sel_hi:[1,0,1]
s_waitcnt lgkmcnt(0)
v_pk_fma_f32 v[240:241], v[208:209], v[20:21], v[240:241] op_sel_hi:[1,0,1]
v_pk_fma_f32 v[242:243], v[210:211], v[20:21], v[242:243] op_sel_hi:[1,0,1]
v_pk_fma_f32 v[248:249], v[52:53], v[20:21], v[248:249] op_sel_hi:[1,0,1]
v_pk_fma_f32 v[250:251], v[54:55], v[20:21], v[250:251] op_sel_hi:[1,0,1]
v_pk_mul_f32 v[240:241], v[240:241], v[224:225]
v_pk_mul_f32 v[224:225], v[224:225], v[28:29] op_sel_hi:[1,0]
v_pk_mul_f32 v[242:243], v[242:243], v[226:227]
v_pk_mul_f32 v[226:227], v[226:227], v[28:29] op_sel_hi:[1,0]
v_pk_mul_f32 v[248:249], v[248:249], v[232:233]
v_pk_mul_f32 v[232:233], v[232:233], v[28:29] op_sel_hi:[1,0]
v_pk_mul_f32 v[250:251], v[250:251], v[234:235]
v_pk_mul_f32 v[234:235], v[234:235], v[28:29] op_sel_hi:[1,0]
v_pk_fma_f32 v[172:173], v[172:173], v[26:27], v[26:27] op_sel:[0,1,1] op_sel_hi:[1,1,1]
v_pk_fma_f32 v[174:175], v[174:175], v[26:27], v[26:27] op_sel:[0,1,1] op_sel_hi:[1,1,1]
v_pk_fma_f32 v[188:189], v[188:189], v[26:27], v[26:27] op_sel:[0,1,1] op_sel_hi:[1,1,1]
v_pk_fma_f32 v[190:191], v[190:191], v[26:27], v[26:27] op_sel:[0,1,1] op_sel_hi:[1,1,1]
v_cvt_pk_bf16_f32 v168, v200, v201
v_cvt_pk_bf16_f32 v169, v202, v203
v_cvt_pk_bf16_f32 v170, v216, v217
v_cvt_pk_bf16_f32 v171, v218, v219
MAA 244,64,132
buffer_store_dwordx4 v[168:171], v11, s[16:19], s64 offen sc1
MAA 244,68,148
v_rcp_f32 v172, v172
MAA 244,96,164
v_rcp_f32 v173, v173
MAA 244,100,180
v_rcp_f32 v174, v174
MAA 252,108,180
buffer_atomic_add v86, v69, s[16:19], s73 offen offset:512 sc0
MAA 252,104,164
v_rcp_f32 v175, v175
MAA 252,76,148
v_rcp_f32 v188, v188
MAA 252,72,132
v_rcp_f32 v189, v189
MAA 228,80,164
v_rcp_f32 v190, v190
MAA 228,84,180
v_rcp_f32 v191, v191
MAA 236,92,180
v_exp_f32 v224, v224
MAA 236,88,164
v_exp_f32 v225, v225
v_exp_f32 v226, v226
v_exp_f32 v227, v227
v_exp_f32 v232, v232
v_exp_f32 v233, v233
v_exp_f32 v234, v234
v_exp_f32 v235, v235
v_pk_mul_f32 v[204:205], v[204:205], v[172:173]
v_pk_mul_f32 v[206:207], v[206:207], v[174:175]
v_pk_mul_f32 v[220:221], v[220:221], v[188:189]
v_pk_mul_f32 v[222:223], v[222:223], v[190:191]
v_pk_fma_f32 v[228:229], v[176:177], v[22:23], v[228:229] op_sel_hi:[1,0,1]
v_pk_fma_f32 v[230:231], v[178:179], v[22:23], v[230:231] op_sel_hi:[1,0,1]
v_pk_fma_f32 v[236:237], v[192:193], v[22:23], v[236:237] op_sel_hi:[1,0,1]
v_pk_fma_f32 v[238:239], v[194:195], v[22:23], v[238:239] op_sel_hi:[1,0,1]
v_pk_fma_f32 v[244:245], v[208:209], v[22:23], v[244:245] op_sel_hi:[1,0,1]
v_pk_fma_f32 v[246:247], v[210:211], v[22:23], v[246:247] op_sel_hi:[1,0,1]
v_pk_fma_f32 v[252:253], v[52:53], v[22:23], v[252:253] op_sel_hi:[1,0,1]
v_pk_fma_f32 v[254:255], v[54:55], v[22:23], v[254:255] op_sel_hi:[1,0,1]
v_pk_mul_f32 v[244:245], v[244:245], v[228:229]
v_pk_mul_f32 v[228:229], v[228:229], v[28:29] op_sel:[0,1] op_sel_hi:[1,1]
v_pk_mul_f32 v[246:247], v[246:247], v[230:231]
v_pk_mul_f32 v[230:231], v[230:231], v[28:29] op_sel:[0,1] op_sel_hi:[1,1]
v_pk_mul_f32 v[252:253], v[252:253], v[236:237]
v_pk_mul_f32 v[236:237], v[236:237], v[28:29] op_sel:[0,1] op_sel_hi:[1,1]
v_pk_mul_f32 v[254:255], v[254:255], v[238:239]
v_pk_mul_f32 v[238:239], v[238:239], v[28:29] op_sel:[0,1] op_sel_hi:[1,1]
v_pk_fma_f32 v[224:225], v[224:225], v[20:21], v[20:21] op_sel:[0,1,1] op_sel_hi:[1,1,1]
v_pk_fma_f32 v[226:227], v[226:227], v[20:21], v[20:21] op_sel:[0,1,1] op_sel_hi:[1,1,1]
v_pk_fma_f32 v[232:233], v[232:233], v[20:21], v[20:21] op_sel:[0,1,1] op_sel_hi:[1,1,1]
v_pk_fma_f32 v[234:235], v[234:235], v[20:21], v[20:21] op_sel:[0,1,1] op_sel_hi:[1,1,1]
v_cvt_pk_bf16_f32 v172, v204, v205
v_cvt_pk_bf16_f32 v173, v206, v207
v_cvt_pk_bf16_f32 v174, v220, v221
v_cvt_pk_bf16_f32 v175, v222, v223
buffer_store_dwordx4 v[172:175], v11, s[16:19], s64 offen offset:1024 sc1
s_waitcnt vmcnt(7)
v_cmp_gt_u32 vcc, v70, v84
s_nop 0
s_cbranch_vccz .Lok49
s_waitcnt vmcnt(4)
v_cmp_gt_u32 vcc, v70, v85
s_nop 0
s_cbranch_vccz .Lok49
s_waitcnt vmcnt(1)
v_cmp_gt_u32 vcc, v70, v86
s_nop 0
s_cbranch_vccz .Lok49
s_mov_b32 s15, 0
.Lok49l:
v_mov_b32 v84, 0
buffer_atomic_add v84, v69, s[16:19], s73 offen offset:512 sc0
s_add_u32 s15, s15, 1
s_cmp_gt_u32 s15, 100000
s_waitcnt vmcnt(0)
s_cbranch_scc1 .Lok49
v_cmp_gt_u32 vcc, v70, v84
s_nop 0
s_cbranch_vccnz .Lok49l
.Lok49:
s_waitcnt vmcnt(3)
s_barrier
s_add_u32 s52, s76, 0
buffer_load_dwordx4 v[96:99], v4, s[16:19], s52 offen sc1
ds_read_b64_tr_b16 a[0:1], v7
TR 2,7,512
TR 4,7,32
TR 6,7,544
TR 8,7,64
TR 10,7,576
TR 12,7,96
buffer_load_dwordx4 v[100:103], v4, s[16:19], s52 offen offset:1024 sc1
s_add_u32 s52, s76, 65536
TR 14,7,608
TR 16,7,8448
TR 18,7,8960
TR 20,7,8480
TR 22,7,8992
TR 24,7,8512
buffer_load_dwordx4 v[104:107], v4, s[16:19], s52 offen sc1
TR 26,7,9024
TR 28,7,8544
TR 30,7,9056
v_rcp_f32 v224, v224
v_rcp_f32 v225, v225
v_rcp_f32 v226, v226
v_rcp_f32 v227, v227
v_rcp_f32 v232, v232
v_rcp_f32 v233, v233
v_rcp_f32 v234, v234
v_rcp_f32 v235, v235
v_exp_f32 v228, v228
v_exp_f32 v229, v229
v_exp_f32 v230, v230
v_exp_f32 v231, v231
v_exp_f32 v236, v236
v_exp_f32 v237, v237
v_exp_f32 v238, v238
v_exp_f32 v239, v239
v_pk_mul_f32 v[240:241], v[240:241], v[224:225]
buffer_load_dwordx4 v[108:111], v4, s[16:19], s52 offen offset:1024 sc1
s_add_u32 s52, s77, 114688
v_pk_mul_f32 v[242:243], v[242:243], v[226:227]
v_pk_mul_f32 v[248:249], v[248:249], v[232:233]
v_pk_mul_f32 v[250:251], v[250:251], v[234:235]
v_pk_fma_f32 v[228:229], v[228:229], v[22:23], v[22:23] op_sel:[0,1,1] op_sel_hi:[1,1,1]
v_pk_fma_f32 v[230:231], v[230:231], v[22:23], v[22:23] op_sel:[0,1,1] op_sel_hi:[1,1,1]
v_pk_fma_f32 v[236:237], v[236:237], v[22:23], v[22:23] op_sel:[0,1,1] op_sel_hi:[1,1,1]
v_pk_fma_f32 v[238:239], v[238:239], v[22:23], v[22:23] op_sel:[0,1,1] op_sel_hi:[1,1,1]
v_cvt_pk_bf16_f32 v224, v240, v241
v_cvt_pk_bf16_f32 v225, v242, v243
v_cvt_pk_bf16_f32 v226, v248, v249
v_cvt_pk_bf16_f32 v227, v250, v251
v_rcp_f32 v228, v228
v_rcp_f32 v229, v229
v_rcp_f32 v230, v230
v_rcp_f32 v231, v231
v_rcp_f32 v236, v236
v_rcp_f32 v237, v237
v_rcp_f32 v238, v238
v_rcp_f32 v239, v239
v_pk_mul_f32 v[244:245], v[244:245], v[228:229]
buffer_store_dwordx4 v[224:227], v10, s[16:19], s65 offen sc1
v_pk_mul_f32 v[246:247], v[246:247], v[230:231]
v_pk_mul_f32 v[252:253], v[252:253], v[236:237]
v_pk_mul_f32 v[254:255], v[254:255], v[238:239]
v_cvt_pk_bf16_f32 v228, v244, v245
v_cvt_pk_bf16_f32 v229, v246, v247
v_cvt_pk_bf16_f32 v230, v252, v253
v_cvt_pk_bf16_f32 v231, v254, v255
buffer_store_dwordx4 v[228:231], v10, s[16:19], s65 offen offset:1024 sc1
buffer_load_dwordx4 v[112:115], v4, s[16:19], s52 offen sc1
buffer_load_dwordx4 v[116:119], v4, s[16:19], s52 offen offset:1024 sc1
s_add_u32 s52, s77, 180224
buffer_load_dwordx4 v[120:123], v4, s[16:19], s52 offen sc1
buffer_load_dwordx4 v[124:127], v4, s[16:19], s52 offen offset:1024 sc1
v_mov_b32 v21, v68
v_mov_b32 v22, v69
v_mov_b32 v23, v70
v_mov_b32 v24, v71
v_mov_b32 v25, 0
v_mov_b32 v27, 0
s_waitcnt vmcnt(6) lgkmcnt(0)
s_barrier
v_mfma_f32_16x16x32_bf16 v[32:35], a[0:3], v[96:99], 0
ds_read_b64_tr_b16 a[32:33], v6
s_add_u32 s52, s78, 229376
MAV 32,16,104
buffer_load_dwordx4 v[128:131], v4, s[16:19], s52 offen sc1
v_mfma_f32_16x16x32_bf16 v[48:51], a[0:3], v[100:103], 0
TR 34,6,512
MAV 48,16,108
TR 36,6,32
TR 38,6,544
v_mfma_f32_16x16x32_bf16 v[52:55], a[4:7], v[100:103], 0
TR 48,6,8448
MAV 52,20,108
buffer_load_dwordx4 v[132:135], v4, s[16:19], s52 offen offset:1024 sc1
v_mfma_f32_16x16x32_bf16 v[36:39], a[4:7], v[96:99], 0
TR 50,6,8960
MAV 36,20,104
TR 52,6,8480
TR 54,6,8992
v_mfma_f32_16x16x32_bf16 v[40:43], a[8:11], v[96:99], 0
TR 40,6,64
s_add_u32 s52, s78, 294912
MAV 40,24,104
buffer_load_dwordx4 v[136:139], v4, s[16:19], s52 offen sc1
v_mfma_f32_16x16x32_bf16 v[56:59], a[8:11], v[100:103], 0
TR 42,6,576
MAV 56,24,108
TR 44,6,96
TR 46,6,608
v_mfma_f32_16x16x32_bf16 v[60:63], a[12:15], v[100:103], 0
TR 56,6,8512
MAV 60,28,108
buffer_load_dwordx4 v[140:143], v4, s[16:19], s52 offen offset:1024 sc1
v_mfma_f32_16x16x32_bf16 v[44:47], a[12:15], v[96:99], 0
TR 58,6,9024
MAV 44,28,104
TR 60,6,8544
TR 62,6,9056
s_waitcnt lgkmcnt(8)
v_mfma_f32_16x16x32_bf16 v[64:67], a[32:35], v[96:99], 0
TR 0,7,16896
s_add_u32 s52, s79, 344064
MAV 64,48,104
buffer_load_dwordx4 v[144:147], v4, s[16:19], s52 offen sc1
v_mfma_f32_16x16x32_bf16 v[80:83], a[32:35], v[100:103], 0
TR 2,7,17408
MAV 80,48,108
TR 4,7,16928
TR 6,7,17440
v_mfma_f32_16x16x32_bf16 v[84:87], a[36:39], v[100:103], 0
TR 16,7,25344
MAV 84,52,108
buffer_load_dwordx4 v[148:151], v4, s[16:19], s52 offen offset:1024 sc1
v_mfma_f32_16x16x32_bf16 v[68:71], a[36:39], v[96:99], 0
TR 18,7,25856
MAV 68,52,104
TR 20,7,25376
TR 22,7,25888
s_waitcnt lgkmcnt(8)
v_mfma_f32_16x16x32_bf16 v[72:75], a[40:43], v[96:99], 0
TR 8,7,16960
s_add_u32 s52, s79, 409600
MAV 72,56,104
buffer_load_dwordx4 v[152:155], v4, s[16:19], s52 offen sc1
v_mfma_f32_16x16x32_bf16 v[88:91], a[40:43], v[100:103], 0
TR 10,7,17472
MAV 88,56,108
TR 12,7,16992
TR 14,7,17504
v_mfma_f32_16x16x32_bf16 v[92:95], a[44:47], v[100:103], 0
TR 24,7,25408
MAV 92,60,108
buffer_load_dwordx4 v[156:159], v4, s[16:19], s52 offen offset:1024 sc1
v_mfma_f32_16x16x32_bf16 v[76:79], a[44:47], v[96:99], 0
TR 26,7,25920
MAV 76,60,104
TR 28,7,25440
TR 30,7,25952
s_waitcnt vmcnt(8) lgkmcnt(8)
s_barrier
MAV 32,0,112
TR 32,6,16896
MAV 32,16,120
buffer_atomic_add v24, v21, s[16:19], s72 offen
MAV 48,16,124
TR 34,6,17408
MAV 48,0,116
TR 36,6,16928
TR 38,6,17440
TR 48,6,25344
MAV 52,4,116
TR 50,6,25856
s_add_u32 m0, s55, 0
MAV 52,20,124
buffer_load_dwordx4 v18, s[28:31], s54 offen lds
MAV 36,20,120
TR 52,6,25376
MAV 36,4,112
TR 54,6,25888
TR 40,6,16960
s_waitcnt lgkmcnt(9)
MAV 40,8,112
TR 42,6,17472
s_add_u32 s52, s76, 458752
MAV 40,24,120
buffer_load_dwordx4 v[96:99], v4, s[16:19], s52 offen sc1
MAV 56,24,124
TR 44,6,16992
MAV 56,8,116
buffer_load_dwordx4 v19, s[28:31], s54 offen offset:1056 lds
MAV 60,12,116
TR 46,6,17504
s_add_u32 s54, s98, 327680
MAV 60,28,124
buffer_load_dwordx4 v[100:103], v4, s[16:19], s52 offen offset:1024 sc1
MAV 44,28,120
TR 56,6,25408
MAV 44,12,112
TR 58,6,25920
TR 60,6,25440
TR 62,6,25952
s_waitcnt lgkmcnt(8)
MAV 64,32,112
TR 0,7,33792
s_add_u32 m0, s55, 8448
MAV 64,48,120
buffer_load_dwordx4 v18, s[28:31], s54 offen lds
MAV 80,48,124
TR 2,7,34304
MAV 80,32,116
TR 4,7,33824
TR 6,7,34336
MAV 84,36,116
TR 16,7,42240
s_add_u32 s52, s76, 524288
MAV 84,52,124
buffer_load_dwordx4 v[104:107], v4, s[16:19], s52 offen sc1
MAV 68,52,120
TR 18,7,42752
MAV 68,36,112
TR 20,7,42272
TR 22,7,42784
s_waitcnt lgkmcnt(8)
MAV 72,40,112
TR 8,7,33856
MAV 72,56,120
buffer_load_dwordx4 v19, s[28:31], s54 offen offset:1056 lds
MAV 88,56,124
TR 10,7,34368
s_add_u32 s54, s99, 524288
MAV 88,40,116
TR 12,7,33888
TR 14,7,34400
MAV 92,44,116
TR 24,7,42304
MAV 92,60,124
buffer_load_dwordx4 v[108:111], v4, s[16:19], s52 offen offset:1024 sc1
MAV 76,60,120
TR 26,7,42816
MAV 76,44,112
TR 28,7,42336
TR 30,7,42848
s_waitcnt vmcnt(13) lgkmcnt(8)
s_barrier
MAV 32,0,128
TR 32,6,33792
s_add_u32 m0, s55, 16896
MAV 32,16,136
buffer_load_dwordx4 v18, s[28:31], s54 offen lds
MAV 48,16,140
TR 34,6,34304
MAV 48,0,132
TR 36,6,33824
TR 38,6,34336
MAV 52,4,132
TR 48,6,42240
s_add_u32 s52, s77, 573440
MAV 52,20,140
buffer_load_dwordx4 v[112:115], v4, s[16:19], s52 offen sc1
MAV 36,20,136
TR 50,6,42752
MAV 36,4,128
TR 52,6,42272
TR 54,6,42784
s_waitcnt lgkmcnt(8)
MAV 40,8,128
TR 40,6,33856
MAV 40,24,136
buffer_load_dwordx4 v19, s[28:31], s54 offen offset:1056 lds
MAV 56,24,140
TR 42,6,34368
s_add_u32 s54, s99, 786432
MAV 56,8,132
TR 44,6,33888
TR 46,6,34400
MAV 60,12,132
TR 56,6,42304
MAV 60,28,140
buffer_load_dwordx4 v[116:119], v4, s[16:19], s52 offen offset:1024 sc1
MAV 44,28,136
TR 58,6,42816
MAV 44,12,128
TR 60,6,42336
TR 62,6,42848
s_waitcnt lgkmcnt(8)
MAV 64,32,128
TR 0,7,50688
s_add_u32 m0, s55, 25344
MAV 64,48,136
buffer_load_dwordx4 v18, s[28:31], s54 offen lds
MAV 80,48,140
TR 2,7,51200
MAV 80,32,132
TR 4,7,50720
TR 6,7,51232
TR 16,7,59136
MAV 84,36,132
TR 18,7,59648
s_add_u32 s52, s77, 638976
MAV 84,52,140
buffer_load_dwordx4 v[120:123], v4, s[16:19], s52 offen sc1
MAV 68,52,136
TR 20,7,59168
MAV 68,36,128
TR 22,7,59680
TR 8,7,50752
s_waitcnt lgkmcnt(9)
MAV 72,40,128
TR 10,7,51264
MAV 72,56,136
buffer_load_dwordx4 v19, s[28:31], s54 offen offset:1056 lds
MAV 88,56,140
TR 12,7,50784
s_add_u32 s54, s100, 983040
MAV 88,40,132
buffer_load_dwordx4 v[124:127], v4, s[16:19], s52 offen offset:1024 sc1
MAV 92,44,132
TR 14,7,51296
MAV 92,60,140
buffer_atomic_add v25, v22, s[16:19], s73 offen sc0
MAV 76,60,136
TR 24,7,59200
MAV 76,44,128
TR 26,7,59712
TR 28,7,59232
TR 30,7,59744
s_waitcnt vmcnt(18) lgkmcnt(8)
s_barrier
MAV 32,0,144
TR 32,6,50688
s_add_u32 m0, s55, 33792
MAV 32,16,152
buffer_load_dwordx4 v18, s[28:31], s54 offen lds
MAV 48,16,156
TR 34,6,51200
MAV 48,0,148
TR 36,6,50720
TR 38,6,51232
MAV 52,4,148
TR 48,6,59136
s_add_u32 s52, s78, 688128
MAV 52,20,156
buffer_load_dwordx4 v[128:131], v4, s[16:19], s52 offen sc1
MAV 36,20,152
TR 50,6,59648
MAV 36,4,144
TR 52,6,59168
TR 54,6,59680
s_waitcnt lgkmcnt(8)
MAV 40,8,144
TR 40,6,50752
MAV 40,24,152
buffer_load_dwordx4 v19, s[28:31], s54 offen offset:1056 lds
MAV 56,24,156
TR 42,6,51264
s_add_u32 s54, s100, 1245184
MAV 56,8,148
TR 44,6,50784
TR 46,6,51296
MAV 60,12,148
TR 56,6,59200
MAV 60,28,156
buffer_load_dwordx4 v[132:135], v4, s[16:19], s52 offen offset:1024 sc1
MAV 44,28,152
TR 58,6,59712
MAV 44,12,144
TR 60,6,59232
TR 62,6,59744
v_add_u32 v7, s57, v7
v_add_u32 v6, s57, v6
s_sub_u32 s57, 0, s57
s_waitcnt lgkmcnt(8)
MAV 64,32,144
ds_read_b64_tr_b16 a[0:1], v7
s_add_u32 m0, s55, 42240
MAV 64,48,152
buffer_load_dwordx4 v18, s[28:31], s54 offen lds
MAV 80,48,156
TR 2,7,512
MAV 80,32,148
TR 4,7,32
TR 6,7,544
MAV 84,36,148
TR 16,7,8448
s_add_u32 s52, s78, 753664
MAV 84,52,156
buffer_load_dwordx4 v[136:139], v4, s[16:19], s52 offen sc1
MAV 68,52,152
TR 18,7,8960
MAV 68,36,144
TR 20,7,8480
TR 22,7,8992
s_waitcnt lgkmcnt(8)
MAV 72,40,144
TR 8,7,64
MAV 72,56,152
buffer_load_dwordx4 v19, s[28:31], s54 offen offset:1056 lds
MAV 88,56,156
TR 10,7,576
s_add_u32 s54, s101, 1441792
MAV 88,40,148
TR 12,7,96
TR 14,7,608
MAV 92,44,148
TR 24,7,8512
MAV 92,60,156
buffer_load_dwordx4 v[140:143], v4, s[16:19], s52 offen offset:1024 sc1
MAV 76,60,152
TR 26,7,9024
MAV 76,44,144
TR 28,7,8544
TR 30,7,9056
s_waitcnt vmcnt(17) lgkmcnt(8)
s_barrier
MAV 32,0,96
ds_read_b64_tr_b16 a[32:33], v6
s_add_u32 m0, s55, 50688
MAV 32,16,104
buffer_load_dwordx4 v18, s[28:31], s54 offen lds
MAV 48,16,108
TR 34,6,512
MAV 48,0,100
TR 36,6,32
TR 38,6,544
TR 48,6,8448
MAV 52,4,100
TR 50,6,8960
s_add_u32 s52, s79, 802816
MAV 52,20,108
buffer_load_dwordx4 v[144:147], v4, s[16:19], s52 offen sc1
MAV 36,20,104
TR 52,6,8480
MAV 36,4,96
TR 54,6,8992
TR 40,6,64
s_waitcnt lgkmcnt(9)
MAV 40,8,96
TR 42,6,576
MAV 40,24,104
buffer_load_dwordx4 v19, s[28:31], s54 offen offset:1056 lds
MAV 56,24,108
TR 44,6,96
s_add_u32 s54, s101, 1703936
MAV 56,8,100
buffer_load_dwordx4 v[148:151], v4, s[16:19], s52 offen offset:1024 sc1
MAV 60,12,100
TR 46,6,608
MAV 60,28,108
buffer_atomic_add v27, v22, s[16:19], s73 offen sc0
.Lpad17:
s_cbranch_execz .Lpad20
MAV 44,28,104
TR 56,6,8512
MAV 44,12,96
TR 58,6,9024
TR 60,6,8544
TR 62,6,9056
s_waitcnt lgkmcnt(8)
MAV 64,32,96
TR 0,7,16896
s_add_u32 m0, s55, 59136
MAV 64,48,104
buffer_load_dwordx4 v18, s[28:31], s54 offen lds
MAV 80,48,108
TR 2,7,17408
MAV 80,32,100
TR 4,7,16928
TR 6,7,17440
MAV 84,36,100
TR 16,7,25344
s_add_u32 s52, s79, 868352
MAV 84,52,108
buffer_load_dwordx4 v[152:155], v4, s[16:19], s52 offen sc1
MAV 68,52,104
TR 18,7,25856
MAV 68,36,96
TR 20,7,25376
TR 22,7,25888
s_waitcnt lgkmcnt(8)
MAV 72,40,96
TR 8,7,16960
MAV 72,56,104
buffer_load_dwordx4 v19, s[28:31], s54 offen offset:1056 lds
MAV 88,56,108
TR 10,7,17472
s_add_u32 s54, s98, 1900544
MAV 88,40,100
TR 12,7,16992
TR 14,7,17504
MAV 92,44,100
TR 24,7,25408
MAV 92,60,108
buffer_load_dwordx4 v[156:159], v4, s[16:19], s52 offen offset:1024 sc1
MAV 76,60,104
TR 26,7,25920
MAV 76,44,96
TR 28,7,25440
TR 30,7,25952
s_waitcnt vmcnt(17)
v_cmp_gt_u32 vcc, v23, v25
s_nop 0
s_cbranch_vccz .Lok50
s_waitcnt vmcnt(4)
v_cmp_gt_u32 vcc, v23, v27
s_nop 0
s_cbranch_vccz .Lok50
s_mov_b32 s15, 0
.Lok50l:
v_mov_b32 v25, 0
buffer_atomic_add v25, v22, s[16:19], s73 offen sc0
s_add_u32 s15, s15, 1
s_cmp_gt_u32 s15, 100000
s_waitcnt vmcnt(0)
s_cbranch_scc1 .Lok50
v_cmp_gt_u32 vcc, v23, v25
s_nop 0
s_cbranch_vccnz .Lok50l
.Lok50:
s_waitcnt lgkmcnt(8)
s_barrier
MAV 32,0,112
TR 32,6,16896
s_add_u32 m0, s55, 67584
MAV 32,16,120
buffer_load_dwordx4 v18, s[28:31], s54 offen lds
MAV 48,16,124
TR 34,6,17408
MAV 48,0,116
TR 36,6,16928
TR 38,6,17440
MAV 52,4,116
TR 48,6,25344
s_add_u32 s52, s76, 16384
MAV 52,20,124
buffer_load_dwordx4 v[96:99], v4, s[16:19], s52 offen sc1
MAV 36,20,120
TR 50,6,25856
MAV 36,4,112
TR 52,6,25376
TR 54,6,25888
s_waitcnt lgkmcnt(8)
MAV 40,8,112
TR 40,6,16960
MAV 40,24,120
buffer_load_dwordx4 v19, s[28:31], s54 offen offset:1056 lds
MAV 56,24,124
TR 42,6,17472
s_add_u32 s54, s98, 2162688
MAV 56,8,116
TR 44,6,16992
TR 46,6,17504
MAV 60,12,116
TR 56,6,25408
MAV 60,28,124
buffer_load_dwordx4 v[100:103], v4, s[16:19], s52 offen offset:1024 sc1
MAV 44,28,120
TR 58,6,25920
MAV 44,12,112
TR 60,6,25440
TR 62,6,25952
s_waitcnt lgkmcnt(8)
MAV 64,32,112
TR 0,7,33792
s_add_u32 m0, s55, 76032
MAV 64,48,120
buffer_load_dwordx4 v18, s[28:31], s54 offen lds
MAV 80,48,124
TR 2,7,34304
MAV 80,32,116
TR 4,7,33824
TR 6,7,34336
MAV 84,36,116
TR 16,7,42240
s_add_u32 s52, s76, 81920
MAV 84,52,124
buffer_load_dwordx4 v[104:107], v4, s[16:19], s52 offen sc1
MAV 68,52,120
TR 18,7,42752
MAV 68,36,112
TR 20,7,42272
TR 22,7,42784
s_waitcnt lgkmcnt(8)
MAV 72,40,112
TR 8,7,33856
MAV 72,56,120
buffer_load_dwordx4 v19, s[28:31], s54 offen offset:1056 lds
MAV 88,56,124
TR 10,7,34368
s_add_u32 s54, s99, 2359296
MAV 88,40,116
TR 12,7,33888
TR 14,7,34400
MAV 92,44,116
TR 24,7,42304
MAV 92,60,124
buffer_load_dwordx4 v[108:111], v4, s[16:19], s52 offen offset:1024 sc1
MAV 76,60,120
TR 26,7,42816
MAV 76,44,112
TR 28,7,42336
TR 30,7,42848
s_waitcnt vmcnt(17) lgkmcnt(8)
s_barrier
MAV 32,0,128
TR 32,6,33792
s_add_u32 m0, s55, 84480
MAV 32,16,136
buffer_load_dwordx4 v18, s[28:31], s54 offen lds
MAV 48,16,140
TR 34,6,34304
s_lshl_b32 s70, s2, 10
MAV 48,0,132
TR 36,6,33824
TR 38,6,34336
MAV 52,4,132
TR 48,6,42240
s_add_u32 s52, s77, 131072
MAV 52,20,140
buffer_load_dwordx4 v[112:115], v4, s[16:19], s52 offen sc1
MAV 36,20,136
TR 50,6,42752
s_lshl_b32 s62, s3, 7
MAV 36,4,128
TR 52,6,42272
TR 54,6,42784
s_waitcnt lgkmcnt(8)
MAV 40,8,128
TR 40,6,33856
s_add_u32 s70, s70, s62
MAV 40,24,136
buffer_load_dwordx4 v19, s[28:31], s54 offen offset:1056 lds
MAV 56,24,140
TR 42,6,34368
s_add_u32 s54, s99, 2621440
MAV 56,8,132
TR 44,6,33888
TR 46,6,34400
MAV 60,12,132
TR 56,6,42304
s_add_u32 s70, s70, 31457280
MAV 60,28,140
buffer_load_dwordx4 v[116:119], v4, s[16:19], s52 offen offset:1024 sc1
MAV 44,28,136
TR 58,6,42816
s_xor_b32 s71, s70, 1024
MAV 44,12,128
TR 60,6,42336
TR 62,6,42848
s_waitcnt lgkmcnt(8)
MAV 64,32,128
TR 0,7,50688
s_add_u32 m0, s55, 92928
MAV 64,48,136
buffer_load_dwordx4 v18, s[28:31], s54 offen lds
MAV 80,48,140
TR 2,7,51200
v_accvgpr_read_b32 v28, a224
MAV 80,32,132
TR 4,7,50720
TR 6,7,51232
MAV 84,36,132
TR 16,7,59136
s_add_u32 s52, s77, 196608
MAV 84,52,140
buffer_load_dwordx4 v[120:123], v4, s[16:19], s52 offen sc1
MAV 68,52,136
TR 18,7,59648
v_add_f32 v32, v32, v28
MAV 68,36,128
TR 20,7,59168
TR 22,7,59680
s_waitcnt lgkmcnt(8)
MAV 72,40,128
TR 8,7,50752
v_accvgpr_read_b32 v29, a225
MAV 72,56,136
buffer_load_dwordx4 v19, s[28:31], s54 offen offset:1056 lds
MAV 88,56,140
TR 10,7,51264
s_add_u32 s54, s100, 2818048
MAV 88,40,132
TR 12,7,50784
TR 14,7,51296
MAV 92,44,132
TR 24,7,59200
v_add_f32 v33, v33, v29
MAV 92,60,140
buffer_load_dwordx4 v[124:127], v4, s[16:19], s52 offen offset:1024 sc1
MAV 76,60,136
TR 26,7,59712
v_accvgpr_read_b32 v28, a226
MAV 76,44,128
TR 28,7,59232
TR 30,7,59744
s_waitcnt vmcnt(16) lgkmcnt(8)
s_barrier
MAV 32,0,144
TR 32,6,50688
s_add_u32 m0, s55, 101376
MAV 32,16,152
buffer_load_dwordx4 v18, s[28:31], s54 offen lds
MAV 48,16,156
TR 34,6,51200
v_min_u32 v26, 1, v1
MAV 48,0,148
TR 36,6,50720
TR 38,6,51232
MAV 52,4,148
TR 48,6,59136
s_add_u32 s52, s78, 245760
MAV 52,20,156
buffer_load_dwordx4 v[128:131], v4, s[16:19], s52 offen sc1
MAV 36,20,152
TR 50,6,59648
v_lshlrev_b32 v26, 28, v26
MAV 36,4,144
TR 52,6,59168
TR 54,6,59680
s_waitcnt lgkmcnt(8)
MAV 40,8,144
TR 40,6,50752
v_mov_b32 v30, 1
MAV 40,24,152
buffer_load_dwordx4 v19, s[28:31], s54 offen offset:1056 lds
MAV 56,24,156
TR 42,6,51264
s_add_u32 s54, s100, 3080192
MAV 56,8,148
TR 44,6,50784
TR 46,6,51296
MAV 60,12,148
TR 56,6,59200
v_mov_b32 v31, 0
MAV 60,28,156
buffer_load_dwordx4 v[132:135], v4, s[16:19], s52 offen offset:1024 sc1
MAV 44,28,152
TR 58,6,59712
s_lshl_b32 s68, s7, 18
MAV 44,12,144
TR 60,6,59232
TR 62,6,59744
v_add_u32 v7, s57, v7
v_add_u32 v6, s57, v6
s_sub_u32 s57, 0, s57
s_waitcnt lgkmcnt(8)
MAV 64,32,144
ds_read_b64_tr_b16 a[0:1], v7
s_add_u32 m0, s55, 109824
MAV 64,48,152
buffer_load_dwordx4 v18, s[28:31], s54 offen lds
MAV 80,48,156
TR 2,7,512
v_add_f32 v34, v34, v28
MAV 80,32,148
TR 4,7,32
TR 6,7,544
MAV 84,36,148
TR 16,7,8448
s_add_u32 s52, s78, 311296
MAV 84,52,156
buffer_load_dwordx4 v[136:139], v4, s[16:19], s52 offen sc1
MAV 68,52,152
TR 18,7,8960
v_accvgpr_read_b32 v29, a227
MAV 68,36,144
TR 20,7,8480
TR 22,7,8992
s_waitcnt lgkmcnt(8)
MAV 72,40,144
TR 8,7,64
v_add_f32 v35, v35, v29
MAV 72,56,152
buffer_load_dwordx4 v19, s[28:31], s54 offen offset:1056 lds
MAV 88,56,156
TR 10,7,576
s_add_u32 s54, s101, 3276800
MAV 88,40,148
TR 12,7,96
TR 14,7,608
MAV 92,44,148
TR 24,7,8512
v_accvgpr_read_b32 v28, a228
MAV 92,60,156
buffer_load_dwordx4 v[140:143], v4, s[16:19], s52 offen offset:1024 sc1
MAV 76,60,152
TR 26,7,9024
v_add_f32 v36, v36, v28
MAV 76,44,144
TR 28,7,8544
TR 30,7,9056
s_waitcnt vmcnt(16) lgkmcnt(8)
s_barrier
MAV 32,0,96
ds_read_b64_tr_b16 a[32:33], v6
s_add_u32 m0, s55, 118272
MAV 32,16,104
buffer_load_dwordx4 v18, s[28:31], s54 offen lds
MAV 48,16,108
TR 34,6,512
s_add_u32 s68, s68, 33554432
MAV 48,0,100
TR 36,6,32
TR 38,6,544
MAV 52,4,100
TR 48,6,8448
s_add_u32 s52, s79, 360448
MAV 52,20,108
buffer_load_dwordx4 v[144:147], v4, s[16:19], s52 offen sc1
MAV 36,20,104
TR 50,6,8960
s_xor_b32 s69, s68, 262144
MAV 36,4,96
TR 52,6,8480
TR 54,6,8992
s_waitcnt lgkmcnt(8)
MAV 40,8,96
TR 40,6,64
v_and_b32 v2, 1, v1
MAV 40,24,104
buffer_load_dwordx4 v19, s[28:31], s54 offen offset:1056 lds
MAV 56,24,108
TR 42,6,576
s_add_u32 s54, s101, 3538944
MAV 56,8,100
TR 44,6,96
TR 46,6,608
MAV 60,12,100
TR 56,6,8512
v_lshlrev_b32 v2, 4, v2
MAV 60,28,108
buffer_load_dwordx4 v[148:151], v4, s[16:19], s52 offen offset:1024 sc1
MAV 44,28,104
TR 58,6,9024
v_mov_b32 v224, 0x3f80
MAV 44,12,96
TR 60,6,8544
TR 62,6,9056
s_waitcnt lgkmcnt(8)
MAV 64,32,96
TR 0,7,16896
s_add_u32 m0, s55, 126720
MAV 64,48,104
buffer_load_dwordx4 v18, s[28:31], s54 offen lds
MAV 80,48,108
TR 2,7,17408
v_accvgpr_read_b32 v29, a229
MAV 80,32,100
TR 4,7,16928
TR 6,7,17440
MAV 84,36,100
TR 16,7,25344
s_add_u32 s52, s79, 425984
MAV 84,52,108
buffer_load_dwordx4 v[152:155], v4, s[16:19], s52 offen sc1
MAV 68,52,104
TR 18,7,25856
v_add_f32 v37, v37, v29
MAV 68,36,96
TR 20,7,25376
TR 22,7,25888
s_waitcnt lgkmcnt(8)
MAV 72,40,96
TR 8,7,16960
v_accvgpr_read_b32 v28, a230
MAV 72,56,104
buffer_load_dwordx4 v19, s[28:31], s54 offen offset:1056 lds
MAV 88,56,108
TR 10,7,17472
s_add_u32 s54, s98, 131072
MAV 88,40,100
TR 12,7,16992
TR 14,7,17504
MAV 92,44,100
TR 24,7,25408
v_add_f32 v38, v38, v28
MAV 92,60,108
buffer_load_dwordx4 v[156:159], v4, s[16:19], s52 offen offset:1024 sc1
MAV 76,60,104
TR 26,7,25920
v_accvgpr_read_b32 v29, a231
MAV 76,44,96
TR 28,7,25440
TR 30,7,25952
s_waitcnt vmcnt(16) lgkmcnt(8)
s_barrier
MAV 32,0,112
TR 32,6,16896
s_add_u32 m0, s55, 0
MAV 32,16,120
buffer_load_dwordx4 v18, s[28:31], s54 offen lds
MAV 48,16,124
TR 34,6,17408
v_lshlrev_b32 v2, v2, v224
MAV 48,0,116
TR 36,6,16928
TR 38,6,17440
MAV 52,4,116
TR 48,6,25344
s_add_u32 s52, s76, 475136
MAV 52,20,124
buffer_load_dwordx4 v[96:99], v4, s[16:19], s52 offen sc1
MAV 36,20,120
TR 50,6,25856
v_bfe_u32 v224, v1, 2, 2
MAV 36,4,112
TR 52,6,25376
TR 54,6,25888
s_waitcnt lgkmcnt(8)
MAV 40,8,112
TR 40,6,16960
v_lshrrev_b32 v225, 4, v1
MAV 40,24,120
buffer_load_dwordx4 v19, s[28:31], s54 offen offset:1056 lds
MAV 56,24,124
TR 42,6,17472
s_add_u32 s54, s98, 393216
MAV 56,8,116
TR 44,6,16992
TR 46,6,17504
MAV 60,12,116
TR 56,6,25408
v_cmp_eq_u32 vcc, v224, v225
MAV 60,28,124
buffer_load_dwordx4 v[100:103], v4, s[16:19], s52 offen offset:1024 sc1
MAV 44,28,120
TR 58,6,25920
v_cndmask_b32 v2, 0, v2, vcc
MAV 44,12,112
TR 60,6,25440
TR 62,6,25952
s_waitcnt lgkmcnt(8)
MAV 64,32,112
TR 0,7,33792
s_add_u32 m0, s55, 8448
MAV 64,48,120
buffer_load_dwordx4 v18, s[28:31], s54 offen lds
MAV 80,48,124
TR 2,7,34304
v_add_f32 v39, v39, v29
MAV 80,32,116
TR 4,7,33824
TR 6,7,34336
MAV 84,36,116
TR 16,7,42240
s_add_u32 s52, s76, 540672
MAV 84,52,124
buffer_load_dwordx4 v[104:107], v4, s[16:19], s52 offen sc1
MAV 68,52,120
TR 18,7,42752
v_accvgpr_read_b32 v28, a232
MAV 68,36,112
TR 20,7,42272
TR 22,7,42784
s_waitcnt lgkmcnt(8)
MAV 72,40,112
TR 8,7,33856
v_add_f32 v40, v40, v28
MAV 72,56,120
buffer_load_dwordx4 v19, s[28:31], s54 offen offset:1056 lds
MAV 88,56,124
TR 10,7,34368
s_add_u32 s54, s99, 589824
MAV 88,40,116
TR 12,7,33888
TR 14,7,34400
MAV 92,44,116
TR 24,7,42304
v_accvgpr_read_b32 v29, a233
MAV 92,60,124
buffer_load_dwordx4 v[108:111], v4, s[16:19], s52 offen offset:1024 sc1
MAV 76,60,120
TR 26,7,42816
v_add_f32 v41, v41, v29
MAV 76,44,112
TR 28,7,42336
TR 30,7,42848
s_waitcnt vmcnt(16) lgkmcnt(8)
s_barrier
MAV 32,0,128
TR 32,6,33792
s_add_u32 m0, s55, 16896
MAV 32,16,136
buffer_load_dwordx4 v18, s[28:31], s54 offen lds
MAV 48,16,140
TR 34,6,34304
v_and_b32 v224, 2, v1
MAV 48,0,132
TR 36,6,33824
TR 38,6,34336
MAV 52,4,132
TR 48,6,42240
s_add_u32 s52, s77, 589824
MAV 52,20,140
buffer_load_dwordx4 v[112:115], v4, s[16:19], s52 offen sc1
MAV 36,20,136
TR 50,6,42752
v_cmp_eq_u32 vcc, 0, v224
MAV 36,4,128
TR 52,6,42272
TR 54,6,42784
s_waitcnt lgkmcnt(8)
MAV 40,8,128
.Lpad18:
s_cbranch_execz .Lpad21
TR 40,6,33856
v_cndmask_b32 v226, 0, v2, vcc
MAV 40,24,136
buffer_load_dwordx4 v19, s[28:31], s54 offen offset:1056 lds
MAV 56,24,140
TR 42,6,34368
s_add_u32 s54, s99, 851968
MAV 56,8,132
TR 44,6,33888
TR 46,6,34400
MAV 60,12,132
TR 56,6,42304
v_cndmask_b32 v227, v2, 0, vcc
MAV 60,28,140
buffer_load_dwordx4 v[116:119], v4, s[16:19], s52 offen offset:1024 sc1
MAV 44,28,136
TR 58,6,42816
v_mov_b32 v224, 0
MAV 44,12,128
TR 60,6,42336
TR 62,6,42848
s_waitcnt lgkmcnt(8)
MAV 64,32,128
TR 0,7,50688
s_add_u32 m0, s55, 25344
MAV 64,48,136
buffer_load_dwordx4 v18, s[28:31], s54 offen lds
MAV 80,48,140
TR 2,7,51200
v_accvgpr_read_b32 v28, a234
MAV 80,32,132
TR 4,7,50720
TR 6,7,51232
MAV 84,36,132
TR 16,7,59136
s_add_u32 s52, s77, 655360
MAV 84,52,140
buffer_load_dwordx4 v[120:123], v4, s[16:19], s52 offen sc1
MAV 68,52,136
TR 18,7,59648
v_add_f32 v42, v42, v28
MAV 68,36,128
TR 20,7,59168
TR 22,7,59680
s_waitcnt lgkmcnt(8)
MAV 72,40,128
TR 8,7,50752
v_accvgpr_read_b32 v29, a235
MAV 72,56,136
buffer_load_dwordx4 v19, s[28:31], s54 offen offset:1056 lds
MAV 88,56,140
TR 10,7,51264
s_add_u32 s54, s100, 1048576
MAV 88,40,132
TR 12,7,50784
TR 14,7,51296
MAV 92,44,132
TR 24,7,59200
v_add_f32 v43, v43, v29
MAV 92,60,140
buffer_load_dwordx4 v[124:127], v4, s[16:19], s52 offen offset:1024 sc1
MAV 76,60,136
TR 26,7,59712
v_accvgpr_read_b32 v28, a236
MAV 76,44,128
TR 28,7,59232
TR 30,7,59744
s_waitcnt vmcnt(16) lgkmcnt(8)
s_barrier
MAV 32,0,144
TR 32,6,50688
s_add_u32 m0, s55, 33792
MAV 32,16,152
buffer_load_dwordx4 v18, s[28:31], s54 offen lds
MAV 48,16,156
TR 34,6,51200
v_mov_b32 v225, 0
MAV 48,0,148
TR 36,6,50720
TR 38,6,51232
MAV 52,4,148
TR 48,6,59136
s_add_u32 s52, s78, 704512
MAV 52,20,156
buffer_load_dwordx4 v[128:131], v4, s[16:19], s52 offen sc1
MAV 36,20,152
TR 50,6,59648
v_mov_b32 v228, 0
MAV 36,4,144
TR 52,6,59168
TR 54,6,59680
s_waitcnt lgkmcnt(8)
MAV 40,8,144
TR 40,6,50752
MAV 40,24,152
buffer_load_dwordx4 v19, s[28:31], s54 offen offset:1056 lds
MAV 56,24,156
TR 42,6,51264
s_add_u32 s54, s100, 1310720
MAV 56,8,148
TR 44,6,50784
TR 46,6,51296
MAV 60,12,148
TR 56,6,59200
v_mov_b32 v229, 0
MAV 60,28,156
buffer_load_dwordx4 v[132:135], v4, s[16:19], s52 offen offset:1024 sc1
MAV 44,28,152
TR 58,6,59712
MAV 44,12,144
TR 60,6,59232
TR 62,6,59744
v_add_u32 v7, s57, v7
v_add_u32 v6, s57, v6
s_sub_u32 s57, 0, s57
s_waitcnt lgkmcnt(8)
MAV 64,32,144
ds_read_b64_tr_b16 a[0:1], v7
s_add_u32 m0, s55, 42240
MAV 64,48,152
buffer_load_dwordx4 v18, s[28:31], s54 offen lds
MAV 80,48,156
TR 2,7,512
v_add_f32 v44, v44, v28
MAV 80,32,148
TR 4,7,32
TR 6,7,544
MAV 84,36,148
TR 16,7,8448
s_add_u32 s52, s78, 770048
MAV 84,52,156
buffer_load_dwordx4 v[136:139], v4, s[16:19], s52 offen sc1
MAV 68,52,152
TR 18,7,8960
v_accvgpr_read_b32 v29, a237
MAV 68,36,144
TR 20,7,8480
TR 22,7,8992
s_waitcnt lgkmcnt(8)
MAV 72,40,144
TR 8,7,64
v_add_f32 v45, v45, v29
MAV 72,56,152
buffer_load_dwordx4 v19, s[28:31], s54 offen offset:1056 lds
MAV 88,56,156
TR 10,7,576
s_add_u32 s54, s101, 1507328
MAV 88,40,148
TR 12,7,96
TR 14,7,608
MAV 92,44,148
TR 24,7,8512
v_accvgpr_read_b32 v28, a238
MAV 92,60,156
buffer_load_dwordx4 v[140:143], v4, s[16:19], s52 offen offset:1024 sc1
MAV 76,60,152
TR 26,7,9024
v_add_f32 v46, v46, v28
MAV 76,44,144
TR 28,7,8544
TR 30,7,9056
s_waitcnt vmcnt(16) lgkmcnt(8)
s_barrier
MAV 32,0,96
ds_read_b64_tr_b16 a[32:33], v6
s_add_u32 m0, s55, 50688
MAV 32,16,104
buffer_load_dwordx4 v18, s[28:31], s54 offen lds
MAV 48,16,108
TR 34,6,512
MAV 48,0,100
TR 36,6,32
TR 38,6,544
MAV 52,4,100
TR 48,6,8448
s_add_u32 s52, s79, 819200
MAV 52,20,108
buffer_load_dwordx4 v[144:147], v4, s[16:19], s52 offen sc1
MAV 36,20,104
TR 50,6,8960
MAV 36,4,96
TR 52,6,8480
TR 54,6,8992
s_waitcnt lgkmcnt(8)
MAV 40,8,96
TR 40,6,64
MAV 40,24,104
buffer_load_dwordx4 v19, s[28:31], s54 offen offset:1056 lds
MAV 56,24,108
TR 42,6,576
s_add_u32 s54, s101, 1769472
MAV 56,8,100
TR 44,6,96
TR 46,6,608
MAV 60,12,100
TR 56,6,8512
MAV 60,28,108
buffer_load_dwordx4 v[148:151], v4, s[16:19], s52 offen offset:1024 sc1
MAV 44,28,104
TR 58,6,9024
MAV 44,12,96
TR 60,6,8544
TR 62,6,9056
s_waitcnt lgkmcnt(8)
MAV 64,32,96
TR 0,7,16896
s_add_u32 m0, s55, 59136
MAV 64,48,104
buffer_load_dwordx4 v18, s[28:31], s54 offen lds
MAV 80,48,108
TR 2,7,17408
v_accvgpr_read_b32 v29, a239
MAV 80,32,100
TR 4,7,16928
TR 6,7,17440
MAV 84,36,100
TR 16,7,25344
s_add_u32 s52, s79, 884736
MAV 84,52,108
buffer_load_dwordx4 v[152:155], v4, s[16:19], s52 offen sc1
MAV 68,52,104
TR 18,7,25856
v_add_f32 v47, v47, v29
MAV 68,36,96
TR 20,7,25376
TR 22,7,25888
s_waitcnt lgkmcnt(8)
MAV 72,40,96
TR 8,7,16960
v_accvgpr_read_b32 v28, a240
MAV 72,56,104
buffer_load_dwordx4 v19, s[28:31], s54 offen offset:1056 lds
MAV 88,56,108
TR 10,7,17472
s_add_u32 s54, s98, 1966080
MAV 88,40,100
TR 12,7,16992
TR 14,7,17504
MAV 92,44,100
TR 24,7,25408
v_add_f32 v48, v48, v28
MAV 92,60,108
buffer_load_dwordx4 v[156:159], v4, s[16:19], s52 offen offset:1024 sc1
MAV 76,60,104
TR 26,7,25920
v_accvgpr_read_b32 v29, a241
MAV 76,44,96
TR 28,7,25440
TR 30,7,25952
s_waitcnt vmcnt(16) lgkmcnt(8)
s_barrier
MAV 32,0,112
TR 32,6,16896
s_add_u32 m0, s55, 67584
MAV 32,16,120
buffer_load_dwordx4 v18, s[28:31], s54 offen lds
MAV 48,16,124
TR 34,6,17408
MAV 48,0,116
TR 36,6,16928
TR 38,6,17440
MAV 52,4,116
TR 48,6,25344
s_add_u32 s52, s76, 32768
MAV 52,20,124
buffer_load_dwordx4 v[96:99], v4, s[16:19], s52 offen sc1
MAV 36,20,120
TR 50,6,25856
MAV 36,4,112
TR 52,6,25376
TR 54,6,25888
s_waitcnt lgkmcnt(8)
MAV 40,8,112
TR 40,6,16960
MAV 40,24,120
buffer_load_dwordx4 v19, s[28:31], s54 offen offset:1056 lds
MAV 56,24,124
TR 42,6,17472
s_add_u32 s54, s98, 2228224
MAV 56,8,116
TR 44,6,16992
TR 46,6,17504
MAV 60,12,116
TR 56,6,25408
MAV 60,28,124
buffer_load_dwordx4 v[100:103], v4, s[16:19], s52 offen offset:1024 sc1
MAV 44,28,120
TR 58,6,25920
MAV 44,12,112
TR 60,6,25440
TR 62,6,25952
s_waitcnt lgkmcnt(8)
MAV 64,32,112
TR 0,7,33792
s_add_u32 m0, s55, 76032
MAV 64,48,120
buffer_load_dwordx4 v18, s[28:31], s54 offen lds
MAV 80,48,124
TR 2,7,34304
v_add_f32 v49, v49, v29
MAV 80,32,116
TR 4,7,33824
TR 6,7,34336
MAV 84,36,116
TR 16,7,42240
s_add_u32 s52, s76, 98304
MAV 84,52,124
buffer_load_dwordx4 v[104:107], v4, s[16:19], s52 offen sc1
MAV 68,52,120
TR 18,7,42752
v_accvgpr_read_b32 v28, a242
MAV 68,36,112
TR 20,7,42272
TR 22,7,42784
s_waitcnt lgkmcnt(8)
MAV 72,40,112
TR 8,7,33856
v_add_f32 v50, v50, v28
MAV 72,56,120
buffer_load_dwordx4 v19, s[28:31], s54 offen offset:1056 lds
MAV 88,56,124
TR 10,7,34368
s_add_u32 s54, s99, 2424832
MAV 88,40,116
TR 12,7,33888
TR 14,7,34400
MAV 92,44,116
TR 24,7,42304
v_accvgpr_read_b32 v29, a243
MAV 92,60,124
buffer_load_dwordx4 v[108:111], v4, s[16:19], s52 offen offset:1024 sc1
MAV 76,60,120
TR 26,7,42816
v_add_f32 v51, v51, v29
MAV 76,44,112
TR 28,7,42336
TR 30,7,42848
s_waitcnt vmcnt(16) lgkmcnt(8)
s_barrier
MAV 32,0,128
TR 32,6,33792
s_add_u32 m0, s55, 84480
MAV 32,16,136
buffer_load_dwordx4 v18, s[28:31], s54 offen lds
MAV 48,16,140
TR 34,6,34304
MAV 48,0,132
TR 36,6,33824
TR 38,6,34336
MAV 52,4,132
TR 48,6,42240
s_add_u32 s52, s77, 147456
MAV 52,20,140
buffer_load_dwordx4 v[112:115], v4, s[16:19], s52 offen sc1
MAV 36,20,136
TR 50,6,42752
MAV 36,4,128
TR 52,6,42272
TR 54,6,42784
s_waitcnt lgkmcnt(8)
MAV 40,8,128
TR 40,6,33856
MAV 40,24,136
buffer_load_dwordx4 v19, s[28:31], s54 offen offset:1056 lds
MAV 56,24,140
TR 42,6,34368
s_add_u32 s54, s99, 2686976
MAV 56,8,132
TR 44,6,33888
TR 46,6,34400
MAV 60,12,132
TR 56,6,42304
MAV 60,28,140
buffer_load_dwordx4 v[116:119], v4, s[16:19], s52 offen offset:1024 sc1
MAV 44,28,136
TR 58,6,42816
MAV 44,12,128
TR 60,6,42336
TR 62,6,42848
s_waitcnt lgkmcnt(8)
MAV 64,32,128
TR 0,7,50688
s_add_u32 m0, s55, 92928
MAV 64,48,136
buffer_load_dwordx4 v18, s[28:31], s54 offen lds
MAV 80,48,140
TR 2,7,51200
v_accvgpr_read_b32 v28, a244
MAV 80,32,132
TR 4,7,50720
TR 6,7,51232
MAV 84,36,132
TR 16,7,59136
s_add_u32 s52, s77, 212992
MAV 84,52,140
buffer_load_dwordx4 v[120:123], v4, s[16:19], s52 offen sc1
MAV 68,52,136
TR 18,7,59648
v_add_f32 v52, v52, v28
MAV 68,36,128
TR 20,7,59168
TR 22,7,59680
s_waitcnt lgkmcnt(8)
MAV 72,40,128
TR 8,7,50752
v_accvgpr_read_b32 v29, a245
MAV 72,56,136
buffer_load_dwordx4 v19, s[28:31], s54 offen offset:1056 lds
MAV 88,56,140
TR 10,7,51264
s_add_u32 s54, s100, 2883584
MAV 88,40,132
TR 12,7,50784
TR 14,7,51296
MAV 92,44,132
TR 24,7,59200
v_add_f32 v53, v53, v29
MAV 92,60,140
buffer_load_dwordx4 v[124:127], v4, s[16:19], s52 offen offset:1024 sc1
MAV 76,60,136
TR 26,7,59712
v_accvgpr_read_b32 v28, a246
MAV 76,44,128
TR 28,7,59232
TR 30,7,59744
s_waitcnt vmcnt(16) lgkmcnt(8)
s_barrier
MAV 32,0,144
TR 32,6,50688
s_add_u32 m0, s55, 101376
MAV 32,16,152
buffer_load_dwordx4 v18, s[28:31], s54 offen lds
MAV 48,16,156
TR 34,6,51200
MAV 48,0,148
TR 36,6,50720
TR 38,6,51232
MAV 52,4,148
TR 48,6,59136
s_add_u32 s52, s78, 262144
MAV 52,20,156
buffer_load_dwordx4 v[128:131], v4, s[16:19], s52 offen sc1
MAV 36,20,152
TR 50,6,59648
MAV 36,4,144
TR 52,6,59168
TR 54,6,59680
s_waitcnt lgkmcnt(8)
MAV 40,8,144
TR 40,6,50752
MAV 40,24,152
buffer_load_dwordx4 v19, s[28:31], s54 offen offset:1056 lds
MAV 56,24,156
TR 42,6,51264
s_add_u32 s54, s100, 3145728
MAV 56,8,148
TR 44,6,50784
TR 46,6,51296
MAV 60,12,148
TR 56,6,59200
MAV 60,28,156
buffer_load_dwordx4 v[132:135], v4, s[16:19], s52 offen offset:1024 sc1
MAV 44,28,152
TR 58,6,59712
MAV 44,12,144
TR 60,6,59232
TR 62,6,59744
v_add_u32 v7, s57, v7
v_add_u32 v6, s57, v6
s_sub_u32 s57, 0, s57
s_waitcnt lgkmcnt(8)
MAV 64,32,144
ds_read_b64_tr_b16 a[0:1], v7
s_add_u32 m0, s55, 109824
MAV 64,48,152
buffer_load_dwordx4 v18, s[28:31], s54 offen lds
MAV 80,48,156
TR 2,7,512
v_add_f32 v54, v54, v28
MAV 80,32,148
TR 4,7,32
TR 6,7,544
MAV 84,36,148
TR 16,7,8448
s_add_u32 s52, s78, 327680
MAV 84,52,156
buffer_load_dwordx4 v[136:139], v4, s[16:19], s52 offen sc1
MAV 68,52,152
TR 18,7,8960
v_accvgpr_read_b32 v29, a247
MAV 68,36,144
TR 20,7,8480
TR 22,7,8992
s_waitcnt lgkmcnt(8)
MAV 72,40,144
TR 8,7,64
v_add_f32 v55, v55, v29
MAV 72,56,152
buffer_load_dwordx4 v19, s[28:31], s54 offen offset:1056 lds
MAV 88,56,156
TR 10,7,576
s_add_u32 s54, s101, 3342336
MAV 88,40,148
TR 12,7,96
TR 14,7,608
MAV 92,44,148
TR 24,7,8512
v_accvgpr_read_b32 v28, a248
MAV 92,60,156
buffer_load_dwordx4 v[140:143], v4, s[16:19], s52 offen offset:1024 sc1
MAV 76,60,152
TR 26,7,9024
v_add_f32 v56, v56, v28
MAV 76,44,144
TR 28,7,8544
TR 30,7,9056
s_waitcnt vmcnt(16) lgkmcnt(8)
s_barrier
MAV 32,0,96
ds_read_b64_tr_b16 a[32:33], v6
s_add_u32 m0, s55, 118272
MAV 32,16,104
buffer_load_dwordx4 v18, s[28:31], s54 offen lds
MAV 48,16,108
TR 34,6,512
MAV 48,0,100
TR 36,6,32
TR 38,6,544
MAV 52,4,100
TR 48,6,8448
s_add_u32 s52, s79, 376832
MAV 52,20,108
buffer_load_dwordx4 v[144:147], v4, s[16:19], s52 offen sc1
MAV 36,20,104
TR 50,6,8960
MAV 36,4,96
TR 52,6,8480
TR 54,6,8992
s_waitcnt lgkmcnt(8)
MAV 40,8,96
.Lpad19:
s_cbranch_execz .Lnopoll37r
TR 40,6,64
MAV 40,24,104
buffer_load_dwordx4 v19, s[28:31], s54 offen offset:1056 lds
MAV 56,24,108
TR 42,6,576
s_add_u32 s54, s101, 3604480
MAV 56,8,100
TR 44,6,96
TR 46,6,608
MAV 60,12,100
TR 56,6,8512
MAV 60,28,108
buffer_load_dwordx4 v[148:151], v4, s[16:19], s52 offen offset:1024 sc1
MAV 44,28,104
TR 58,6,9024
MAV 44,12,96
TR 60,6,8544
TR 62,6,9056
s_waitcnt lgkmcnt(8)
MAV 64,32,96
TR 0,7,16896
s_add_u32 m0, s55, 126720
MAV 64,48,104
buffer_load_dwordx4 v18, s[28:31], s54 offen lds
MAV 80,48,108
TR 2,7,17408
v_accvgpr_read_b32 v29, a249
MAV 80,32,100
TR 4,7,16928
TR 6,7,17440
MAV 84,36,100
TR 16,7,25344
s_add_u32 s52, s79, 442368
MAV 84,52,108
buffer_load_dwordx4 v[152:155], v4, s[16:19], s52 offen sc1
MAV 68,52,104
TR 18,7,25856
v_add_f32 v57, v57, v29
MAV 68,36,96
TR 20,7,25376
TR 22,7,25888
s_waitcnt lgkmcnt(8)
MAV 72,40,96
TR 8,7,16960
v_accvgpr_read_b32 v28, a250
MAV 72,56,104
buffer_load_dwordx4 v19, s[28:31], s54 offen offset:1056 lds
MAV 88,56,108
TR 10,7,17472
s_add_u32 s54, s98, 196608
MAV 88,40,100
TR 12,7,16992
TR 14,7,17504
MAV 92,44,100
TR 24,7,25408
v_add_f32 v58, v58, v28
MAV 92,60,108
buffer_load_dwordx4 v[156:159], v4, s[16:19], s52 offen offset:1024 sc1
MAV 76,60,104
TR 26,7,25920
v_accvgpr_read_b32 v29, a251
MAV 76,44,96
TR 28,7,25440
TR 30,7,25952
s_waitcnt vmcnt(16) lgkmcnt(8)
s_barrier
MAV 32,0,112
TR 32,6,16896
s_add_u32 m0, s55, 0
MAV 32,16,120
buffer_load_dwordx4 v18, s[28:31], s54 offen lds
MAV 48,16,124
TR 34,6,17408
MAV 48,0,116
TR 36,6,16928
TR 38,6,17440
MAV 52,4,116
TR 48,6,25344
s_add_u32 s52, s76, 491520
MAV 52,20,124
buffer_load_dwordx4 v[96:99], v4, s[16:19], s52 offen sc1
MAV 36,20,120
TR 50,6,25856
MAV 36,4,112
TR 52,6,25376
TR 54,6,25888
s_waitcnt lgkmcnt(8)
MAV 40,8,112
TR 40,6,16960
MAV 40,24,120
buffer_load_dwordx4 v19, s[28:31], s54 offen offset:1056 lds
MAV 56,24,124
TR 42,6,17472
s_add_u32 s54, s99, 655360
MAV 56,8,116
TR 44,6,16992
TR 46,6,17504
MAV 60,12,116
TR 56,6,25408
MAV 60,28,124
buffer_load_dwordx4 v[100:103], v4, s[16:19], s52 offen offset:1024 sc1
MAV 44,28,120
TR 58,6,25920
MAV 44,12,112
TR 60,6,25440
TR 62,6,25952
s_waitcnt lgkmcnt(8)
MAV 64,32,112
TR 0,7,33792
s_add_u32 m0, s55, 8448
MAV 64,48,120
buffer_load_dwordx4 v18, s[28:31], s54 offen lds
MAV 80,48,124
TR 2,7,34304
v_add_f32 v59, v59, v29
MAV 80,32,116
TR 4,7,33824
TR 6,7,34336
MAV 84,36,116
TR 16,7,42240
s_add_u32 s52, s76, 557056
MAV 84,52,124
buffer_load_dwordx4 v[104:107], v4, s[16:19], s52 offen sc1
MAV 68,52,120
TR 18,7,42752
v_accvgpr_read_b32 v28, a252
MAV 68,36,112
TR 20,7,42272
TR 22,7,42784
s_waitcnt lgkmcnt(8)
MAV 72,40,112
TR 8,7,33856
v_add_f32 v60, v60, v28
MAV 72,56,120
buffer_load_dwordx4 v19, s[28:31], s54 offen offset:1056 lds
MAV 88,56,124
TR 10,7,34368
s_add_u32 s54, s100, 1114112
MAV 88,40,116
TR 12,7,33888
TR 14,7,34400
MAV 92,44,116
TR 24,7,42304
v_accvgpr_read_b32 v29, a253
MAV 92,60,124
buffer_load_dwordx4 v[108:111], v4, s[16:19], s52 offen offset:1024 sc1
MAV 76,60,120
TR 26,7,42816
v_add_f32 v61, v61, v29
MAV 76,44,112
TR 28,7,42336
TR 30,7,42848
s_waitcnt vmcnt(16) lgkmcnt(8)
s_barrier
MAV 32,0,128
TR 32,6,33792
s_add_u32 m0, s55, 16896
MAV 32,16,136
buffer_load_dwordx4 v18, s[28:31], s54 offen lds
MAV 48,16,140
TR 34,6,34304
MAV 48,0,132
TR 36,6,33824
TR 38,6,34336
MAV 52,4,132
TR 48,6,42240
s_add_u32 s52, s77, 606208
MAV 52,20,140
buffer_load_dwordx4 v[112:115], v4, s[16:19], s52 offen sc1
MAV 36,20,136
TR 50,6,42752
MAV 36,4,128
TR 52,6,42272
TR 54,6,42784
s_waitcnt lgkmcnt(8)
MAV 40,8,128
TR 40,6,33856
MAV 40,24,136
buffer_load_dwordx4 v19, s[28:31], s54 offen offset:1056 lds
MAV 56,24,140
TR 42,6,34368
s_add_u32 s54, s101, 1572864
MAV 56,8,132
TR 44,6,33888
TR 46,6,34400
MAV 60,12,132
TR 56,6,42304
MAV 60,28,140
buffer_load_dwordx4 v[116:119], v4, s[16:19], s52 offen offset:1024 sc1
MAV 44,28,136
TR 58,6,42816
MAV 44,12,128
TR 60,6,42336
TR 62,6,42848
s_waitcnt lgkmcnt(8)
MAV 64,32,128
TR 0,7,50688
s_add_u32 m0, s55, 25344
MAV 64,48,136
buffer_load_dwordx4 v18, s[28:31], s54 offen lds
MAV 80,48,140
TR 2,7,51200
v_accvgpr_read_b32 v28, a254
MAV 80,32,132
TR 4,7,50720
TR 6,7,51232
MAV 84,36,132
TR 16,7,59136
s_add_u32 s52, s77, 671744
MAV 84,52,140
buffer_load_dwordx4 v[120:123], v4, s[16:19], s52 offen sc1
MAV 68,52,136
TR 18,7,59648
v_add_f32 v62, v62, v28
MAV 68,36,128
TR 20,7,59168
TR 22,7,59680
s_waitcnt lgkmcnt(8)
MAV 72,40,128
TR 8,7,50752
v_accvgpr_read_b32 v29, a255
MAV 72,56,136
buffer_load_dwordx4 v19, s[28:31], s54 offen offset:1056 lds
MAV 88,56,140
TR 10,7,51264
s_add_u32 s54, s98, 2031616
MAV 88,40,132
TR 12,7,50784
TR 14,7,51296
MAV 92,44,132
TR 24,7,59200
v_add_f32 v63, v63, v29
MAV 92,60,140
buffer_load_dwordx4 v[124:127], v4, s[16:19], s52 offen offset:1024 sc1
MAV 76,60,136
TR 26,7,59712
MAV 76,44,128
TR 28,7,59232
TR 30,7,59744
s_waitcnt vmcnt(16) lgkmcnt(8)
s_barrier
MAV 32,0,144
TR 32,6,50688
s_add_u32 m0, s55, 33792
MAV 32,16,152
buffer_load_dwordx4 v18, s[28:31], s54 offen lds
MAV 48,16,156
TR 34,6,51200
MAV 48,0,148
TR 36,6,50720
TR 38,6,51232
MAV 52,4,148
TR 48,6,59136
s_add_u32 s52, s78, 720896
MAV 52,20,156
buffer_load_dwordx4 v[128:131], v4, s[16:19], s52 offen sc1
MAV 36,20,152
TR 50,6,59648
MAV 36,4,144
TR 52,6,59168
TR 54,6,59680
s_waitcnt lgkmcnt(8)
MAV 40,8,144
TR 40,6,50752
MAV 40,24,152
buffer_load_dwordx4 v19, s[28:31], s54 offen offset:1056 lds
MAV 56,24,156
TR 42,6,51264
s_add_u32 s54, s99, 2490368
MAV 56,8,148
TR 44,6,50784
TR 46,6,51296
MAV 60,12,148
TR 56,6,59200
MAV 60,28,156
buffer_load_dwordx4 v[132:135], v4, s[16:19], s52 offen offset:1024 sc1
MAV 44,28,152
TR 58,6,59712
MAV 44,12,144
TR 60,6,59232
TR 62,6,59744
v_add_u32 v7, s57, v7
v_add_u32 v6, s57, v6
s_sub_u32 s57, 0, s57
s_waitcnt lgkmcnt(8)
MAV 64,32,144
ds_read_b64_tr_b16 a[0:1], v6
s_add_u32 m0, s55, 42240
MAV 64,48,152
buffer_load_dwordx4 v18, s[28:31], s54 offen lds
MAV 80,48,156
TR 2,6,512
MAV 80,32,148
TR 4,6,32
TR 6,6,544
MAV 84,36,148
TR 16,6,8448
s_add_u32 s52, s78, 786432
MAV 84,52,156
buffer_load_dwordx4 v[136:139], v4, s[16:19], s52 offen sc1
MAV 68,52,152
TR 18,6,8960
MAV 68,36,144
TR 20,6,8480
TR 22,6,8992
s_waitcnt lgkmcnt(8)
MAV 72,40,144
TR 8,6,64
MAV 72,56,152
buffer_load_dwordx4 v19, s[28:31], s54 offen offset:1056 lds
MAV 88,56,156
TR 10,6,576
s_add_u32 s54, s100, 2949120
MAV 88,40,148
TR 12,6,96
TR 14,6,608
MAV 92,44,148
TR 24,6,8512
MAV 92,60,156
buffer_load_dwordx4 v[140:143], v4, s[16:19], s52 offen offset:1024 sc1
MAV 76,60,152
TR 26,6,9024
MAV 76,44,144
TR 28,6,8544
TR 30,6,9056
s_waitcnt vmcnt(16) lgkmcnt(8)
s_barrier
MAV 64,0,96
TR 32,6,16896
TR 34,6,17408
s_add_u32 m0, s55, 50688
MAV 64,16,104
TR 36,6,16928
buffer_load_dwordx4 v18, s[28:31], s54 offen lds
MAV 80,16,108
TR 38,6,17440
MAV 80,0,100
TR 48,6,25344
buffer_load_dwordx4 v19, s[28:31], s54 offen offset:1056 lds
MAV 84,4,100
TR 50,6,25856
s_add_u32 s54, s101, 3407872
s_add_u32 s52, s79, 835584
MAV 84,20,108
buffer_load_dwordx4 v[144:147], v4, s[16:19], s52 offen sc1
MAV 68,20,104
TR 52,6,25376
TR 54,6,25888
MAV 68,4,96
TR 40,6,16960
s_waitcnt lgkmcnt(9)
MAV 72,8,96
TR 42,6,17472
MAV 72,24,104
TR 44,6,16992
buffer_load_dwordx4 v[148:151], v4, s[16:19], s52 offen offset:1024 sc1
MAV 88,24,108
TR 46,6,17504
s_add_u32 m0, s55, 59136
MAV 88,8,100
TR 56,6,25408
buffer_load_dwordx4 v18, s[28:31], s54 offen lds
MAV 92,12,100
TR 58,6,25920
MAV 92,28,108
TR 60,6,25440
buffer_load_dwordx4 v19, s[28:31], s54 offen offset:1056 lds
MAV 76,28,104
TR 62,6,25952
s_add_u32 s52, s79, 901120
MAV 76,12,96
buffer_load_dwordx4 v[152:155], v4, s[16:19], s52 offen sc1
buffer_load_dwordx4 v[156:159], v4, s[16:19], s52 offen offset:1024 sc1
s_waitcnt vmcnt(16) lgkmcnt(8)
MAV 64,32,112
TR 0,6,33792
s_add_u32 s52, s76, 49152
MAV 64,48,120
buffer_load_dwordx4 v[160:163], v4, s[16:19], s52 offen sc1
MAV 80,48,124
TR 2,6,34304
v_bfe_u32 v18, v1, 3, 1
MAV 80,32,116
TR 4,6,33824
TR 6,6,34336
MAV 84,36,116
TR 16,6,42240
MAV 84,52,124
buffer_load_dwordx4 v[164:167], v4, s[16:19], s52 offen offset:1024 sc1
MAV 68,52,120
TR 18,6,42752
MAV 68,36,112
TR 20,6,42272
TR 22,6,42784
s_waitcnt lgkmcnt(8)
MAV 72,40,112
TR 8,6,33856
s_add_u32 s52, s77, 163840
MAV 72,56,120
buffer_load_dwordx4 v[168:171], v4, s[16:19], s52 offen sc1
MAV 88,56,124
TR 10,6,34368
v_lshrrev_b32 v2, 4, v1
MAV 88,40,116
TR 12,6,33888
TR 14,6,34400
MAV 92,44,116
TR 24,6,42304
MAV 92,60,124
buffer_load_dwordx4 v[172:175], v4, s[16:19], s52 offen offset:1024 sc1
MAV 76,60,120
TR 26,6,42816
MAV 76,44,112
TR 28,6,42336
TR 30,6,42848
s_waitcnt vmcnt(12) lgkmcnt(8)
MAV 64,0,128
TR 32,6,50688
s_add_u32 s52, s78, 278528
MAV 64,16,136
buffer_load_dwordx4 v[176:179], v4, s[16:19], s52 offen sc1
MAV 80,16,140
TR 34,6,51200
v_lshl_add_u32 v18, v2, 3, v18
MAV 80,0,132
TR 36,6,50720
TR 38,6,51232
MAV 84,4,132
TR 48,6,59136
MAV 84,20,140
buffer_load_dwordx4 v[180:183], v4, s[16:19], s52 offen offset:1024 sc1
MAV 68,20,136
TR 50,6,59648
MAV 68,4,128
TR 52,6,59168
TR 54,6,59680
s_waitcnt lgkmcnt(8)
MAV 72,8,128
TR 40,6,50752
s_add_u32 s52, s79, 393216
MAV 72,24,136
buffer_load_dwordx4 v[184:187], v4, s[16:19], s52 offen sc1
MAV 88,24,140
TR 42,6,51264
s_lshl_b32 s62, s3, 1
MAV 88,8,132
TR 44,6,50784
TR 46,6,51296
MAV 92,12,132
TR 56,6,59200
MAV 92,28,140
buffer_load_dwordx4 v[188:191], v4, s[16:19], s52 offen offset:1024 sc1
MAV 76,28,136
TR 58,6,59712
MAV 76,12,128
TR 60,6,59232
TR 62,6,59744
s_waitcnt vmcnt(8) lgkmcnt(8)
s_barrier
v_add_u32 v6, s57, v6
MAV 64,32,144
ds_read_b64_tr_b16 a[0:1], v6
s_add_u32 s52, s76, 507904
MAV 64,48,152
buffer_load_dwordx4 v[192:195], v4, s[16:19], s52 offen sc1
MAV 80,48,156
TR 2,6,512
v_add_u32 v18, s62, v18
MAV 80,32,148
TR 4,6,32
TR 6,6,544
MAV 84,36,148
TR 16,6,8448
MAV 84,52,156
buffer_load_dwordx4 v[196:199], v4, s[16:19], s52 offen offset:1024 sc1
MAV 68,52,152
TR 18,6,8960
MAV 68,36,144
TR 20,6,8480
TR 22,6,8992
s_waitcnt lgkmcnt(8)
MAV 72,40,144
TR 8,6,64
s_add_u32 s52, s77, 622592
MAV 72,56,152
buffer_load_dwordx4 v[200:203], v4, s[16:19], s52 offen sc1
MAV 88,56,156
TR 10,6,576
v_mul_u32_u24 v18, 6144, v18
MAV 88,40,148
TR 12,6,96
TR 14,6,608
MAV 92,44,148
TR 24,6,8512
MAV 92,60,156
buffer_load_dwordx4 v[204:207], v4, s[16:19], s52 offen offset:1024 sc1
MAV 76,60,152
TR 26,6,9024
MAV 76,44,144
TR 28,6,8544
TR 30,6,9056
s_waitcnt vmcnt(8) lgkmcnt(8)
MAV 64,0,160
TR 32,6,16896
s_add_u32 s52, s78, 737280
MAV 64,16,168
buffer_load_dwordx4 v[208:211], v4, s[16:19], s52 offen sc1
MAV 80,16,172
TR 34,6,17408
v_and_b32 v2, 7, v1
MAV 80,0,164
TR 36,6,16928
TR 38,6,17440
MAV 84,4,164
TR 48,6,25344
MAV 84,20,172
buffer_load_dwordx4 v[212:215], v4, s[16:19], s52 offen offset:1024 sc1
MAV 68,20,168
TR 50,6,25856
MAV 68,4,160
TR 52,6,25376
TR 54,6,25888
s_waitcnt lgkmcnt(8)
MAV 72,8,160
TR 40,6,16960
s_add_u32 s52, s79, 851968
MAV 72,24,168
buffer_load_dwordx4 v[216:219], v4, s[16:19], s52 offen sc1
MAV 88,24,172
TR 42,6,17472
v_lshl_add_u32 v18, v2, 4, v18
MAV 88,8,164
TR 44,6,16992
TR 46,6,17504
.Lpad20:
s_cbranch_execz .Lnopoll37r
MAV 92,12,164
TR 56,6,25408
MAV 92,28,172
buffer_load_dwordx4 v[220:223], v4, s[16:19], s52 offen offset:1024 sc1
MAV 76,28,168
TR 58,6,25920
MAV 76,12,160
TR 60,6,25440
TR 62,6,25952
s_waitcnt vmcnt(8) lgkmcnt(8)
MAV 64,32,176
TR 0,6,33792
s_lshl_b32 s62, s9, 7
MAV 64,48,184
TR 2,6,34304
MAV 80,48,188
TR 4,6,33824
MAV 80,32,180
TR 6,6,34336
MAV 84,36,180
TR 16,6,42240
MAV 84,52,188
TR 18,6,42752
MAV 68,52,184
TR 20,6,42272
MAV 68,36,176
TR 22,6,42784
s_waitcnt lgkmcnt(8)
MAV 72,40,176
TR 8,6,33856
v_add_u32 v18, s62, v18
MAV 72,56,184
TR 10,6,34368
MAV 88,56,188
TR 12,6,33888
MAV 88,40,180
TR 14,6,34400
MAV 92,44,180
TR 24,6,42304
MAV 92,60,188
TR 26,6,42816
MAV 76,60,184
TR 28,6,42336
MAV 76,44,176
TR 30,6,42848
s_waitcnt vmcnt(4) lgkmcnt(8)
MAV 64,0,192
TR 32,6,50688
v_add_u32 v19, 1024, v18
MAV 64,16,200
TR 34,6,51200
MAV 80,16,204
TR 36,6,50720
MAV 80,0,196
TR 38,6,51232
MAV 84,4,196
TR 48,6,59136
MAV 84,20,204
TR 50,6,59648
MAV 68,20,200
TR 52,6,59168
MAV 68,4,192
TR 54,6,59680
s_waitcnt lgkmcnt(8)
MAV 72,8,192
TR 40,6,50752
v_add_u32 v20, 2048, v18
MAV 72,24,200
TR 42,6,51264
MAV 88,24,204
TR 44,6,50784
MAV 88,8,196
TR 46,6,51296
MAV 92,12,196
TR 56,6,59200
MAV 92,28,204
TR 58,6,59712
MAV 76,28,200
TR 60,6,59232
MAV 76,12,192
TR 62,6,59744
s_waitcnt vmcnt(0) lgkmcnt(8)
MAV 64,32,208
ds_read_b64_tr_b16 a[0:1], v7
s_mul_i32 s59, s3, 3104
MAV 64,48,216
TR 2,7,512
MAV 80,48,220
TR 4,7,32
MAV 80,32,212
TR 6,7,544
MAV 84,36,212
TR 16,7,8448
MAV 84,52,220
TR 18,7,8960
MAV 68,52,216
TR 20,7,8480
MAV 68,36,208
TR 22,7,8992
s_waitcnt lgkmcnt(8)
MAV 72,40,208
TR 8,7,64
s_mov_b32 s58, 0
MAV 72,56,216
TR 10,7,576
MAV 88,56,220
TR 12,7,96
MAV 88,40,212
TR 14,7,608
MAV 92,44,212
TR 24,7,8512
MAV 92,60,220
TR 26,7,9024
MAV 76,60,216
TR 28,7,8544
MAV 76,44,208
TR 30,7,9056
s_waitcnt lgkmcnt(8)
MAV 32,0,96
TR 32,7,16896
v_cvt_pk_bf16_f32 v232, v64, v65
MAV 32,16,104
TR 34,7,17408
v_cvt_pk_bf16_f32 v233, v66, v67
v_cvt_pk_bf16_f32 v234, v68, v69
MAV 48,16,108
TR 36,7,16928
v_cvt_pk_bf16_f32 v235, v70, v71
MAV 48,0,100
TR 38,7,17440
buffer_store_dwordx4 v[232:235], v4, s[16:19], s69 offen sc1
s_add_u32 s69, s69, 131072
MAV 52,4,100
TR 48,7,25344
v_cvt_pk_bf16_f32 v236, v72, v73
MAV 52,20,108
TR 50,7,25856
v_cvt_pk_bf16_f32 v237, v74, v75
v_cvt_pk_bf16_f32 v238, v76, v77
MAV 36,20,104
TR 52,7,25376
v_cvt_pk_bf16_f32 v239, v78, v79
MAV 36,4,96
TR 54,7,25888
buffer_store_dwordx4 v[236:239], v4, s[16:19], s69 offen sc1
s_waitcnt lgkmcnt(8)
MAV 40,8,96
TR 40,7,16960
s_add_u32 s69, s69, -130048
MAV 40,24,104
TR 42,7,17472
v_cvt_pk_bf16_f32 v240, v80, v81
v_cvt_pk_bf16_f32 v241, v82, v83
MAV 56,24,108
TR 44,7,16992
v_cvt_pk_bf16_f32 v242, v84, v85
MAV 56,8,100
TR 46,7,17504
v_cvt_pk_bf16_f32 v243, v86, v87
buffer_store_dwordx4 v[240:243], v4, s[16:19], s69 offen sc1
MAV 60,12,100
TR 56,7,25408
s_add_u32 s69, s69, 131072
MAV 60,28,108
TR 58,7,25920
v_cvt_pk_bf16_f32 v244, v88, v89
v_cvt_pk_bf16_f32 v245, v90, v91
MAV 44,28,104
TR 60,7,25440
v_cvt_pk_bf16_f32 v246, v92, v93
MAV 44,12,96
TR 62,7,25952
v_cvt_pk_bf16_f32 v247, v94, v95
buffer_store_dwordx4 v[244:247], v4, s[16:19], s69 offen sc1
s_waitcnt lgkmcnt(8)
MAV 32,32,112
TR 0,7,33792
MAV 32,48,120
TR 2,7,34304
MAV 48,48,124
TR 4,7,33824
MAV 48,32,116
TR 6,7,34336
MAV 52,36,116
TR 16,7,42240
MAV 52,52,124
TR 18,7,42752
MAV 36,52,120
TR 20,7,42272
MAV 36,36,112
TR 22,7,42784
s_waitcnt lgkmcnt(8)
MAV 40,40,112
TR 8,7,33856
MAV 40,56,120
TR 10,7,34368
MAV 56,56,124
TR 12,7,33888
MAV 56,40,116
TR 14,7,34400
MAV 60,44,116
TR 24,7,42304
MAV 60,60,124
TR 26,7,42816
MAV 44,60,120
TR 28,7,42336
MAV 44,44,112
TR 30,7,42848
s_waitcnt lgkmcnt(8)
MAV 32,0,128
TR 32,7,50688
MAV 32,16,136
TR 34,7,51200
MAV 48,16,140
TR 36,7,50720
MAV 48,0,132
TR 38,7,51232
MAV 52,4,132
TR 48,7,59136
MAV 52,20,140
TR 50,7,59648
MAV 36,20,136
TR 52,7,59168
MAV 36,4,128
TR 54,7,59680
s_waitcnt lgkmcnt(8)
MAV 40,8,128
TR 40,7,50752
MAV 40,24,136
TR 42,7,51264
MAV 56,24,140
TR 44,7,50784
MAV 56,8,132
TR 46,7,51296
MAV 60,12,132
TR 56,7,59200
MAV 60,28,140
TR 58,7,59712
MAV 44,28,136
TR 60,7,59232
MAV 44,12,128
TR 62,7,59744
v_add_u32 v7, s57, v7
s_waitcnt lgkmcnt(8)
MAV 32,32,144
ds_read_b64_tr_b16 a[0:1], v7
MAV 32,48,152
s_waitcnt vmcnt(0)
buffer_atomic_add v30, v26, s[16:19], s71 offen
MAV 48,48,156
TR 2,7,512
MAV 48,32,148
TR 4,7,32
TR 6,7,544
MAV 52,36,148
MAV 52,52,156
TR 16,7,8448
TR 18,7,8960
MAV 36,52,152
TR 20,7,8480
MAV 36,36,144
s_waitcnt lgkmcnt(7)
MAV 40,40,144
TR 22,7,8992
MAV 40,56,152
TR 8,7,64
TR 10,7,576
MAV 56,56,156
MAV 56,40,148
TR 12,7,96
TR 14,7,608
MAV 60,44,148
TR 24,7,8512
MAV 60,60,156
TR 26,7,9024
MAV 44,60,152
TR 28,7,8544
MAV 44,44,144
TR 30,7,9056
s_waitcnt lgkmcnt(8)
s_barrier
MAV 32,0,160
TR 32,7,16896
MAV 32,16,168
buffer_atomic_add v31, v26, s[16:19], s70 offen sc0
MAV 48,16,172
TR 34,7,17408
MAV 48,0,164
TR 36,7,16928
TR 38,7,17440
MAV 52,4,164
MAV 52,20,172
TR 48,7,25344
TR 50,7,25856
MAV 36,20,168
TR 52,7,25376
MAV 36,4,160
s_waitcnt lgkmcnt(7)
MAV 40,8,160
TR 54,7,25888
MAV 40,24,168
TR 40,7,16960
TR 42,7,17472
MAV 56,24,172
MAV 56,8,164
TR 44,7,16992
TR 46,7,17504
MAV 60,12,164
TR 56,7,25408
MAV 60,28,172
TR 58,7,25920
MAV 44,28,168
TR 60,7,25440
MAV 44,12,160
TR 62,7,25952
s_waitcnt lgkmcnt(8)
MAV 32,32,176
TR 0,7,33792
MAV 32,48,184
TR 2,7,34304
MAV 48,48,188
TR 4,7,33824
MAV 48,32,180
TR 6,7,34336
MAV 52,36,180
TR 16,7,42240
MAV 52,52,188
TR 18,7,42752
MAV 36,52,184
TR 20,7,42272
MAV 36,36,176
TR 22,7,42784
s_waitcnt lgkmcnt(8)
MAV 40,40,176
TR 8,7,33856
MAV 40,56,184
TR 10,7,34368
MAV 56,56,188
TR 12,7,33888
MAV 56,40,180
TR 14,7,34400
MAV 60,44,180
TR 24,7,42304
MAV 60,60,188
TR 26,7,42816
MAV 44,60,184
TR 28,7,42336
MAV 44,44,176
TR 30,7,42848
s_waitcnt vmcnt(0)
v_cmp_le_u32 vcc, 1, v31
s_nop 0
s_cbranch_vccnz .Lxs51
s_mov_b32 s15, 0
.Lxs51l:
v_mov_b32 v31, 0
buffer_atomic_add v31, v26, s[16:19], s70 offen sc0
s_add_u32 s15, s15, 1
s_cmp_gt_u32 s15, 100000
s_waitcnt vmcnt(0)
s_cbranch_scc1 .Lxs51
v_cmp_le_u32 vcc, 1, v31
s_nop 0
s_cbranch_vccz .Lxs51l
.Lxs51:
s_waitcnt lgkmcnt(8)
MAV 32,0,192
TR 32,7,50688
MAV 32,16,200
buffer_load_dwordx4 v[232:235], v4, s[16:19], s68 offen sc1
MAV 48,16,204
TR 34,7,51200
s_add_u32 s68, s68, 131072
MAV 48,0,196
TR 36,7,50720
TR 38,7,51232
MAV 52,4,196
TR 48,7,59136
MAV 52,20,204
buffer_load_dwordx4 v[236:239], v4, s[16:19], s68 offen sc1
MAV 36,20,200
TR 50,7,59648
s_add_u32 s68, s68, -130048
MAV 36,4,192
TR 52,7,59168
TR 54,7,59680
s_waitcnt lgkmcnt(8)
MAV 40,8,192
TR 40,7,50752
MAV 40,24,200
buffer_load_dwordx4 v[240:243], v4, s[16:19], s68 offen sc1
MAV 56,24,204
TR 42,7,51264
s_add_u32 s68, s68, 131072
MAV 56,8,196
TR 44,7,50784
TR 46,7,51296
MAV 60,12,196
TR 56,7,59200
MAV 60,28,204
buffer_load_dwordx4 v[244:247], v4, s[16:19], s68 offen sc1
MAV 44,28,200
TR 58,7,59712
MAV 44,12,192
TR 60,7,59232
TR 62,7,59744
s_waitcnt lgkmcnt(8)
MAV 32,32,208
MAV 32,48,216
MAV 48,48,220
MAV 48,32,212
MAV 52,36,212
MAV 52,52,220
MAV 36,52,216
MAV 36,36,208
s_waitcnt lgkmcnt(0)
MAV 40,40,208
MAV 40,56,216
MAV 56,56,220
MAV 56,40,212
MAV 60,44,212
MAV 60,60,220
MAV 44,60,216
MAV 44,44,208
s_waitcnt vmcnt(3)
v_mfma_f32_16x16x32_bf16 v[32:35], v[226:229], v[232:235], v[32:35]
s_lshl_b32 s64, s6, 14
s_lshl_b32 s65, s49, 13
s_add_u32 s64, s64, s65
v_mfma_f32_16x16x32_bf16 v[36:39], v[224:227], v[232:235], v[36:39]
s_lshl_b32 s65, s7, 9
s_add_u32 s64, s64, s65
s_lshl_b32 s65, s48, 8
s_waitcnt vmcnt(2)
v_mfma_f32_16x16x32_bf16 v[40:43], v[226:229], v[236:239], v[40:43]
s_add_u32 s64, s64, s65
s_add_u32 s64, s64, 62914560
v_and_b32 v152, 31, v1
v_mfma_f32_16x16x32_bf16 v[44:47], v[224:227], v[236:239], v[44:47]
s_lshl_b32 s62, s7, 18
v_lshlrev_b32 v152, 3, v152
v_lshrrev_b32 v153, 5, v1
s_waitcnt vmcnt(1)
v_mfma_f32_16x16x32_bf16 v[48:51], v[226:229], v[240:243], v[48:51]
s_add_u32 s62, s62, 33554432
v_lshl_add_u32 v152, v153, 28, v152
s_add_u32 s63, s62, 131072
v_mfma_f32_16x16x32_bf16 v[52:55], v[224:227], v[240:243], v[52:55]
v_cvt_pk_bf16_f32 v128, v32, v33
v_cvt_pk_bf16_f32 v129, v34, v35
s_waitcnt vmcnt(0)
v_mfma_f32_16x16x32_bf16 v[56:59], v[226:229], v[244:247], v[56:59]
v_cvt_pk_bf16_f32 v130, v36, v37
v_cvt_pk_bf16_f32 v131, v38, v39
v_mfma_f32_16x16x32_bf16 v[60:63], v[224:227], v[244:247], v[60:63]
buffer_store_dwordx4 v[128:131], v4, s[16:19], s62 offen sc1
v_cvt_pk_bf16_f32 v132, v40, v41
v_cvt_pk_bf16_f32 v133, v42, v43
v_cvt_pk_bf16_f32 v134, v44, v45
v_cvt_pk_bf16_f32 v135, v46, v47
v_cvt_pk_bf16_f32 v136, v48, v49
v_cvt_pk_bf16_f32 v137, v50, v51
v_cvt_pk_bf16_f32 v138, v52, v53
v_cvt_pk_bf16_f32 v139, v54, v55
v_cvt_pk_bf16_f32 v140, v56, v57
v_cvt_pk_bf16_f32 v141, v58, v59
v_cvt_pk_bf16_f32 v142, v60, v61
v_cvt_pk_bf16_f32 v143, v62, v63
v_pk_mul_f32 v[146:147], v[32:33], v[32:33]
buffer_store_dwordx4 v[132:135], v4, s[16:19], s63 offen sc1
v_pk_mul_f32 v[150:151], v[48:49], v[48:49]
v_pk_fma_f32 v[146:147], v[34:35], v[34:35], v[146:147]
v_pk_add_f32 v[144:145], v[32:33], v[34:35]
v_pk_fma_f32 v[150:151], v[50:51], v[50:51], v[150:151]
v_pk_add_f32 v[148:149], v[48:49], v[50:51]
v_pk_fma_f32 v[146:147], v[36:37], v[36:37], v[146:147]
v_pk_add_f32 v[144:145], v[144:145], v[36:37]
v_pk_fma_f32 v[150:151], v[52:53], v[52:53], v[150:151]
v_pk_add_f32 v[148:149], v[148:149], v[52:53]
v_pk_fma_f32 v[146:147], v[38:39], v[38:39], v[146:147]
v_pk_add_f32 v[144:145], v[144:145], v[38:39]
v_pk_fma_f32 v[150:151], v[54:55], v[54:55], v[150:151]
v_pk_add_f32 v[148:149], v[148:149], v[54:55]
buffer_store_dwordx4 v[136:139], v4, s[16:19], s62 offen offset:1024 sc1
v_pk_fma_f32 v[146:147], v[40:41], v[40:41], v[146:147]
v_pk_add_f32 v[144:145], v[144:145], v[40:41]
v_pk_fma_f32 v[150:151], v[56:57], v[56:57], v[150:151]
v_pk_add_f32 v[148:149], v[148:149], v[56:57]
v_pk_fma_f32 v[146:147], v[42:43], v[42:43], v[146:147]
v_pk_add_f32 v[144:145], v[144:145], v[42:43]
v_pk_fma_f32 v[150:151], v[58:59], v[58:59], v[150:151]
v_pk_add_f32 v[148:149], v[148:149], v[58:59]
v_pk_fma_f32 v[146:147], v[44:45], v[44:45], v[146:147]
v_pk_add_f32 v[144:145], v[144:145], v[44:45]
v_pk_fma_f32 v[150:151], v[60:61], v[60:61], v[150:151]
v_pk_add_f32 v[148:149], v[148:149], v[60:61]
v_pk_fma_f32 v[146:147], v[46:47], v[46:47], v[146:147]
buffer_store_dwordx4 v[140:143], v4, s[16:19], s63 offen offset:1024 sc1
v_pk_add_f32 v[144:145], v[144:145], v[46:47]
v_pk_fma_f32 v[150:151], v[62:63], v[62:63], v[150:151]
v_pk_add_f32 v[148:149], v[148:149], v[62:63]
v_add_f32 v144, v144, v145
v_add_f32 v146, v146, v147
v_add_f32 v148, v148, v149
v_add_f32 v150, v150, v151
s_nop 0
v_permlane16_swap_b32 v144, v148
v_permlane16_swap_b32 v146, v150
v_add_f32 v144, v144, v148
v_add_f32 v146, v146, v150
s_nop 1
v_permlane32_swap_b32 v144, v146
v_add_f32 v144, v144, v146
s_nop 1
v_permlane32_swap_b32 v144, v145
buffer_store_dwordx2 v[144:145], v152, s[16:19], s64 offen sc1
s_nop 1
s_mov_b32 s54, s58
s_mov_b32 s56, s59
v_accvgpr_write_b32 a224, v32
v_accvgpr_write_b32 a225, v33
v_accvgpr_write_b32 a226, v34
v_accvgpr_write_b32 a227, v35
v_accvgpr_write_b32 a228, v36
v_accvgpr_write_b32 a229, v37
v_accvgpr_write_b32 a230, v38
v_accvgpr_write_b32 a231, v39
v_accvgpr_write_b32 a232, v40
v_accvgpr_write_b32 a233, v41
v_accvgpr_write_b32 a234, v42
v_accvgpr_write_b32 a235, v43
v_accvgpr_write_b32 a236, v44
v_accvgpr_write_b32 a237, v45
v_accvgpr_write_b32 a238, v46
v_accvgpr_write_b32 a239, v47
v_accvgpr_write_b32 a240, v48
v_accvgpr_write_b32 a241, v49
v_accvgpr_write_b32 a242, v50
v_accvgpr_write_b32 a243, v51
v_accvgpr_write_b32 a244, v52
v_accvgpr_write_b32 a245, v53
v_accvgpr_write_b32 a246, v54
v_accvgpr_write_b32 a247, v55
v_accvgpr_write_b32 a248, v56
v_accvgpr_write_b32 a249, v57
v_accvgpr_write_b32 a250, v58
v_accvgpr_write_b32 a251, v59
v_accvgpr_write_b32 a252, v60
v_accvgpr_write_b32 a253, v61
.Lpad21:
s_cbranch_execz .Lnopoll37r
v_accvgpr_write_b32 a254, v62
v_accvgpr_write_b32 a255, v63
s_lshl_b32 s62, s3, 11
s_add_u32 s62, s62, s85
v_lshl_add_u32 v21, v1, 4, s62
v_lshrrev_b32 v2, 3, v1
v_cmp_eq_u32 vcc, 3, v2
v_add_u32 v2, 67108480, v21
s_nop 0
v_cndmask_b32 v21, v21, v2, vcc
s_sub_u32 s62, s86, 2048
v_lshl_add_u32 v22, v0, 2, s62
v_lshrrev_b32 v2, 5, v0
v_cmp_eq_u32 vcc, 3, v2
v_add_u32 v2, 67108480, v22
s_nop 0
v_cndmask_b32 v22, v22, v2, vcc
s_mul_i32 s62, s48, 4608
v_lshl_add_u32 v23, v1, 4, s62
v_lshrrev_b32 v24, 4, v1
v_mul_u32_u24 v24, 2304, v24
v_and_b32 v2, 15, v1
v_lshl_add_u32 v24, v2, 4, v24
s_mov_b32 s52, 33554432
s_mul_i32 s55, s3, 2304
v_bfe_u32 v25, v1, 3, 2
v_mul_u32_u24 v25, 3104, v25
v_bfe_u32 v2, v1, 2, 1
v_lshl_add_u32 v25, v2, 7, v25
v_bfe_u32 v2, v1, 5, 1
v_lshl_add_u32 v25, v2, 8, v25
v_and_b32 v2, 3, v1
v_lshl_add_u32 v25, v2, 3, v25
s_lshl_b32 s62, s49, 6
s_add_u32 s62, s62, 67584
v_add_u32 v25, s62, v25
s_lshl_b32 s62, s8, 1
s_add_u32 s62, s62, s3
s_lshr_b32 s63, s50, 2
s_cmp_lt_u32 s3, 2
s_cselect_b32 s62, s62, s63
s_lshl_b32 s62, s62, 13
s_cmp_eq_u32 s3, 3
s_cselect_b32 s62, 268435456, s62
v_lshl_add_u32 v26, v1, 4, s62
s_lshr_b32 s63, s20, 7
s_sub_u32 s63, 3, s63
s_and_b32 s63, s63, 7
s_and_b32 s62, s9, 8
s_add_u32 s63, s63, s62
s_lshl_b32 s62, s5, 2
s_add_u32 s62, s62, s3
s_mul_i32 s62, s62, 12288
s_lshl_b32 s64, s63, 7
s_add_u32 s62, s62, s64
s_xor_b32 s63, s63, s9
s_cmp_lt_u32 s63, 4
s_cselect_b32 s62, s62, 16777216
v_lshrrev_b32 v14, 3, v1
v_min_u32 v14, 5, v14
v_lshl_add_u32 v14, v14, 11, s62
s_mov_b32 s44, 983040
buffer_load_dword v27, v14, s[20:23], s44 offen
s_mov_b32 s44, 2555904
s_mul_i32 s59, s3, 2080
s_and_b32 s87, s6, 3
s_lshl_b32 s87, s87, 17
v_bfe_u32 v5, v1, 3, 1
v_lshrrev_b32 v2, 4, v1
v_lshl_add_u32 v5, v2, 3, v5
s_lshl_b32 s62, s3, 1
v_add_u32 v5, s62, v5
v_mul_u32_u24 v5, 2048, v5
v_and_b32 v2, 7, v1
v_lshl_add_u32 v5, v2, 4, v5
s_lshl_b32 s62, s7, 7
v_add_u32 v5, s62, v5
v_add_u32 v6, 64512, v5
s_lshl_b32 s62, s6, 10
s_add_u32 s62, s62, 30474240
s_lshl_b32 s64, s8, 10
s_add_u32 s64, s64, 30474240
s_lshr_b32 s67, s9, 1
s_and_b32 s67, s67, 3
s_lshl_b32 s67, s67, 7
s_add_u32 s64, s64, s67
s_lshr_b32 s65, s50, 3
s_lshl_b32 s65, s65, 10
s_add_u32 s65, s65, 30474240
s_lshr_b32 s67, s9, 1
s_and_b32 s67, s67, 3
s_lshl_b32 s67, s67, 7
s_add_u32 s65, s65, s67
v_lshl_add_u32 v252, v1, 7, s62
v_mov_b32 v253, s64
v_mov_b32 v255, 1
v_writelane_b32 v253, s65, 1
s_waitcnt vmcnt(1) lgkmcnt(0)
s_cmp_lg_u32 s3, 1
s_barrier
s_cbranch_scc1 .Lfirst54
s_mov_b64 exec, 15
buffer_atomic_add v255, v252, s[16:19], 0 offen
s_mov_b64 exec, 3
v_mov_b32 v254, 0
buffer_atomic_add v254, v253, s[16:19], 0 offen sc0
s_mov_b64 exec, -1
.Lfirst54:
s_add_u32 m0, s56, 117248
s_nop 0
buffer_load_dwordx4 v18, s[20:23], s54 offen lds
v_lshrrev_b32 v2, 4, v1
v_lshlrev_b32 v2, 2, v2
v_and_b32 v13, 15, v1
v_sub_u32 v2, v13, v2
v_mov_b32 v13, 0xff61b1e6
v_subrev_u32 v54, 0, v2
v_cmp_gt_u32 vcc, 8, v54
s_nop 1
v_cndmask_b32 v50, v13, 0, vcc
buffer_load_dwordx4 v19, s[20:23], s54 offen offset:1024 lds
v_cmp_gt_i32 vcc, -8, v54
s_nop 1
v_cndmask_b32 v46, v13, 0, vcc
v_subrev_u32 v54, 1, v2
v_cmp_gt_u32 vcc, 8, v54
s_nop 1
v_cndmask_b32 v51, v13, 0, vcc
v_cmp_gt_i32 vcc, -8, v54
s_nop 1
v_cndmask_b32 v47, v13, 0, vcc
v_subrev_u32 v54, 2, v2
buffer_load_dwordx4 v20, s[20:23], s54 offen offset:2048 lds
s_add_u32 s54, s54, 196608
v_cmp_gt_u32 vcc, 8, v54
s_nop 1
v_cndmask_b32 v52, v13, 0, vcc
v_cmp_gt_i32 vcc, -8, v54
s_nop 1
v_cndmask_b32 v48, v13, 0, vcc
v_subrev_u32 v54, 3, v2
v_cmp_gt_u32 vcc, 8, v54
s_nop 1
v_cndmask_b32 v53, v13, 0, vcc
v_cmp_gt_i32 vcc, -8, v54
s_add_u32 m0, s56, 129664
s_nop 0
buffer_load_dwordx4 v18, s[20:23], s54 offen lds
v_cndmask_b32 v49, v13, 0, vcc
s_cmp_lt_u32 s8, 2
s_cselect_b64 vcc, -1, 0
v_cndmask_b32 v54, v46, v13, vcc
v_cndmask_b32 v55, v47, v13, vcc
v_cndmask_b32 v56, v48, v13, vcc
v_cndmask_b32 v57, v49, v13, vcc
v_mov_b64 v[60:61], 0
buffer_load_dwordx4 v19, s[20:23], s54 offen offset:1024 lds
v_mov_b64 v[62:63], 0
v_mov_b64 v[64:65], 0
v_mov_b64 v[66:67], 0
v_mov_b64 v[68:69], 0
v_mov_b64 v[70:71], 0
v_mov_b64 v[72:73], 0
v_mov_b64 v[74:75], 0
v_mov_b64 v[76:77], 0
buffer_load_dwordx4 v20, s[20:23], s54 offen offset:2048 lds
s_add_u32 s54, s54, 196608
v_mov_b64 v[78:79], 0
v_mov_b64 v[80:81], 0
v_mov_b64 v[82:83], 0
v_mov_b64 v[84:85], 0
v_mov_b64 v[86:87], 0
v_mov_b64 v[88:89], 0
v_mov_b64 v[90:91], 0
v_mov_b64 v[92:93], 0
s_add_u32 m0, s56, 67584
s_nop 0
buffer_load_dwordx4 v18, s[20:23], s54 offen lds
v_mov_b64 v[94:95], 0
v_mov_b64 v[96:97], 0
v_mov_b64 v[98:99], 0
v_mov_b64 v[100:101], 0
v_mov_b64 v[102:103], 0
v_mov_b64 v[104:105], 0
v_mov_b64 v[106:107], 0
v_mov_b64 v[108:109], 0
buffer_load_dwordx4 v19, s[20:23], s54 offen offset:1024 lds
v_mov_b64 v[110:111], 0
v_mov_b64 v[112:113], 0
v_mov_b64 v[114:115], 0
v_mov_b64 v[116:117], 0
v_mov_b64 v[118:119], 0
v_mov_b64 v[120:121], 0
v_mov_b64 v[122:123], 0
v_mov_b64 v[124:125], 0
buffer_load_dwordx4 v20, s[20:23], s54 offen offset:2048 lds
s_add_u32 s54, s54, 196608
v_mov_b64 v[126:127], 0
v_mov_b64 v[128:129], 0
v_mov_b64 v[130:131], 0
v_mov_b64 v[132:133], 0
v_mov_b64 v[134:135], 0
v_mov_b64 v[136:137], 0
v_mov_b64 v[138:139], 0
v_mov_b64 v[140:141], 0
s_add_u32 m0, s56, 80000
s_nop 0
buffer_load_dwordx4 v18, s[20:23], s54 offen lds
v_mov_b64 v[142:143], 0
v_mov_b64 v[144:145], 0
v_mov_b64 v[146:147], 0
v_mov_b64 v[148:149], 0
v_mov_b64 v[150:151], 0
v_mov_b64 v[152:153], 0
v_mov_b64 v[154:155], 0
v_mov_b64 v[156:157], 0
buffer_load_dwordx4 v19, s[20:23], s54 offen offset:1024 lds
v_mov_b64 v[158:159], 0
v_mov_b64 v[160:161], 0
v_mov_b64 v[162:163], 0
v_mov_b64 v[164:165], 0
v_mov_b64 v[166:167], 0
v_mov_b64 v[168:169], 0
v_mov_b64 v[170:171], 0
v_mov_b64 v[172:173], 0
buffer_load_dwordx4 v20, s[20:23], s54 offen offset:2048 lds
s_add_u32 s54, s54, 196608
v_mov_b64 v[174:175], 0
s_mov_b32 s75, 62914560
v_and_b32 v10, 15, v1
v_lshlrev_b32 v12, 2, v10
v_lshlrev_b32 v10, 4, v10
v_add_u32 v10, 152576, v10
v_lshrrev_b32 v11, 4, v1
v_lshlrev_b32 v11, 4, v11
s_add_u32 m0, s56, 92416
s_nop 0
buffer_load_dwordx4 v18, s[20:23], s54 offen lds
s_lshl_b32 s62, s49, 7
s_add_u32 s62, s62, 158720
v_add_u32 v12, s62, v12
v_add_u32 v13, s62, v11
v_add_u32 v11, 156672, v11
s_lshl_b32 s62, s3, 11
s_add_u32 s62, s62, 143360
v_lshl_add_u32 v8, v1, 4, s62
buffer_load_dwordx4 v19, s[20:23], s54 offen offset:1024 lds
v_xor_b32 v9, 2048, v8
v_mov_b32 v248, 0x3f803f80
v_mov_b32 v249, 0x3f803f80
v_mov_b32 v250, 0x3f803f80
v_mov_b32 v251, 0x3f803f80
v_and_b32 v7, 31, v1
v_lshrrev_b32 v2, 5, v1
v_lshl_add_u32 v7, v7, 1, v2
buffer_load_dwordx4 v20, s[20:23], s54 offen offset:2048 lds
s_add_u32 s54, s54, 196608
v_and_b32 v2, 0xc0, v0
v_add_u32 v7, v7, v2
v_lshlrev_b32 v17, 2, v7
v_add_u32 v17, 156672, v17
v_lshlrev_b32 v7, 4, v7
v_add_u32 v7, 152576, v7
s_lshl_b32 s74, s9, 1
s_add_u32 s74, s74, s49
s_lshl_b32 s74, s74, 17
s_add_u32 s74, s74, s85
s_lshl_b32 s63, s48, 12
s_add_u32 s74, s74, s63
s_add_u32 s74, s74, 37748736
s_mov_b32 s62, 0
v_lshl_add_u32 v4, v1, 4, s62
v_lshrrev_b32 v2, 3, v1
v_cmp_eq_u32 vcc, 3, v2
v_add_u32 v2, 67108480, v4
s_nop 0
v_cndmask_b32 v4, v4, v2, vcc
s_cmp_lg_u32 s3, 1
s_cbranch_scc1 .Lnopoll53
s_mov_b64 exec, 3
s_mov_b32 s15, 0
v_mov_b32 v255, 0
buffer_atomic_add v255, v253, s[16:19], 0 offen sc0
s_waitcnt vmcnt(16)
v_cmp_gt_u32 vcc, 16, v254
s_nop 0
s_cbranch_vccz .Lnopoll53r
.Lpoll52:
s_waitcnt vmcnt(0)
v_cmp_gt_u32 vcc, 16, v255
s_add_u32 s15, s15, 1
s_cbranch_vccz .Lnopoll53r
v_mov_b32 v255, 0
buffer_atomic_add v255, v253, s[16:19], 0 offen sc0
s_cmp_le_u32 s15, 100000
s_cbranch_scc1 .Lpoll52
s_branch .Lnopoll53r
.Lnopoll53:
s_mov_b64 exec, 0
s_cmp_eq_u32 s3, 2
s_cbranch_scc1 .Lpad22
s_cmp_eq_u32 s3, 3
s_cbranch_scc1 .Lpad23
s_branch .Lpad24
.Lnopoll53r:
s_mov_b64 exec, -1
s_waitcnt vmcnt(9)
s_barrier
s_cmp_eq_u32 s48, 1
s_cbranch_scc1 .Lqkv55
s_add_u32 m0, s55, 36864
s_nop 0
buffer_load_dwordx4 v21, s[16:19], s52 offen sc1 lds
buffer_load_dwordx4 v21, s[16:19], s52 offen offset:1024 sc1 lds
buffer_load_dword v22, s[16:19], s52 offen offset:2048 sc1 lds
s_add_u32 s52, s52, 131072
TR 80,25,49664
TR 82,25,50176
TR 84,25,62080
s_add_u32 m0, s55, 46080
s_nop 0
buffer_load_dwordx4 v21, s[16:19], s52 offen sc1 lds
buffer_load_dwordx4 v21, s[16:19], s52 offen offset:1024 sc1 lds
buffer_load_dword v22, s[16:19], s52 offen offset:2048 sc1 lds
s_add_u32 s52, s52, 131072
TR 86,25,62592
TR 88,25,50688
TR 90,25,51200
s_add_u32 m0, s55, 0
s_nop 0
buffer_load_dwordx4 v21, s[16:19], s52 offen sc1 lds
buffer_load_dwordx4 v21, s[16:19], s52 offen offset:1024 sc1 lds
buffer_load_dword v22, s[16:19], s52 offen offset:2048 sc1 lds
s_add_u32 s52, s52, 131072
TR 92,25,63104
TR 94,25,63616
TR 96,25,51712
s_add_u32 m0, s55, 9216
s_nop 0
buffer_load_dwordx4 v21, s[16:19], s52 offen sc1 lds
buffer_load_dwordx4 v21, s[16:19], s52 offen offset:1024 sc1 lds
buffer_load_dword v22, s[16:19], s52 offen offset:2048 sc1 lds
s_add_u32 s52, s52, 131072
TR 98,25,52224
TR 100,25,64128
TR 102,25,64640
s_add_u32 m0, s55, 18432
s_nop 0
buffer_load_dwordx4 v21, s[16:19], s52 offen sc1 lds
buffer_load_dwordx4 v21, s[16:19], s52 offen offset:1024 sc1 lds
buffer_load_dword v22, s[16:19], s52 offen offset:2048 sc1 lds
s_add_u32 s52, s52, 131072
ds_read_b128 v[28:31], v13
ds_read_b128 v[32:35], v13 offset:64
ds_read_b128 v[36:39], v13 offset:256
s_add_u32 m0, s55, 27648
s_nop 0
buffer_load_dwordx4 v21, s[16:19], s52 offen sc1 lds
buffer_load_dwordx4 v21, s[16:19], s52 offen offset:1024 sc1 lds
buffer_load_dword v22, s[16:19], s52 offen offset:2048 sc1 lds
s_add_u32 s52, s52, 131072
ds_read_b128 v[40:43], v13 offset:320
ds_read_b32 v44, v12 offset:512
ds_read_b32 v45, v12 offset:576
s_waitcnt vmcnt(12)
s_barrier
RD 0,23,36864
RD 4,23,37888
RD 8,23,39168
RD 12,23,40192
RD 16,24,38912
RD 20,23,46080
RD 24,23,47104
RD 28,23,48384
RD 32,23,49408
RD 36,24,48128
s_waitcnt lgkmcnt(0)
s_mov_b32 s15, -2
.p2align 6
.Lk57:
s_waitcnt vmcnt(9) lgkmcnt(8)
s_barrier
MAA 60,80,0
TR 104,25,49696
s_add_u32 m0, s56, 104832
MAA 60,84,20
buffer_load_dwordx4 v18, s[20:23], s54 offen lds
MAA 64,84,24
TR 106,25,50208
v_add_f32 v164, v164, v168
MAA 64,80,4
TR 108,25,62112
MAA 68,80,8
TR 110,25,62624
MAA 68,84,28
buffer_load_dwordx4 v19, s[20:23], s54 offen offset:1024 lds
MAA 72,84,32
TR 112,25,50720
v_add_f32 v165, v165, v169
MAA 72,80,12
TR 114,25,51232
s_waitcnt lgkmcnt(6)
MAA 156,88,16
TR 116,25,63136
MAA 156,92,36
buffer_load_dwordx4 v20, s[20:23], s54 offen offset:2048 lds
MAA 104,92,32
s_add_u32 s54, s54, 196608
s_add_u32 m0, s55, 36864
MAA 104,88,12
buffer_load_dwordx4 v21, s[16:19], s52 offen sc1 lds
MAA 100,88,8
TR 118,25,63648
MAA 100,92,28
TR 120,25,51744
v_add_f32 v166, v166, v170
MAA 96,92,24
TR 122,25,52256
MAA 96,88,4
buffer_load_dwordx4 v21, s[16:19], s52 offen offset:1024 sc1 lds
MAA 92,88,0
TR 124,25,64160
MAA 92,92,20
TR 126,25,64672
v_add_f32 v167, v167, v171
MAA 124,20,100
ds_read_b128 a[40:43], v23
MAA 124,0,96
buffer_load_dword v22, s[16:19], s52 offen offset:2048 sc1 lds
MAA 128,4,96
RD 44,23,1024
s_add_u32 s52, s52, 131072
MAA 128,24,100
buffer_load_dword v27, v14, s[20:23], s44 offen
MAA 132,28,100
RD 48,23,2304
s_add_u32 s44, s44, 1572864
MAA 132,8,96
RD 52,23,3328
MAA 136,12,96
RD 56,24,2048
MAA 136,32,100
s_waitcnt vmcnt(13) lgkmcnt(5)
s_barrier
MAA 76,104,0
RD 60,23,9216
s_add_u32 m0, s56, 117248
MAA 76,108,20
buffer_load_dwordx4 v18, s[20:23], s54 offen lds
MAA 80,108,24
RD 64,23,10240
MAA 80,104,4
RD 68,23,11520
MAA 84,104,8
RD 72,23,12544
MAA 84,108,28
buffer_load_dwordx4 v19, s[20:23], s54 offen offset:1024 lds
MAA 88,108,32
RD 76,24,11264
MAA 88,104,12
buffer_load_dwordx4 v20, s[20:23], s54 offen offset:2048 lds
MAA 160,112,16
ds_read_b64_tr_b16 a[80:81], v25
s_add_u32 s54, s54, 196608
MAA 160,116,36
TR 82,25,512
MAA 120,116,32
TR 84,25,12416
s_add_u32 m0, s55, 46080
MAA 120,112,12
buffer_load_dwordx4 v21, s[16:19], s52 offen sc1 lds
MAA 116,112,8
TR 86,25,12928
MAA 116,116,28
TR 88,25,1024
MAA 112,116,24
TR 90,25,1536
MAA 112,112,4
buffer_load_dwordx4 v21, s[16:19], s52 offen offset:1024 sc1 lds
MAA 108,112,0
TR 92,25,13440
MAA 108,116,20
TR 94,25,13952
MAA 140,20,124
TR 96,25,2048
MAA 140,0,120
buffer_load_dword v22, s[16:19], s52 offen offset:2048 sc1 lds
MAA 144,4,120
TR 98,25,2560
s_add_u32 s52, s52, 131072
MAA 144,24,124
buffer_load_dwordx4 v[168:171], v26, s[16:19], s75 offen sc1
MAA 148,28,124
TR 100,25,14464
MAA 148,8,120
TR 102,25,14976
MAA 152,12,120
MAA 152,32,124
s_waitcnt vmcnt(17) lgkmcnt(8)
s_barrier
MAA 60,80,40
TR 104,25,32
s_add_u32 m0, s56, 129664
MAA 60,84,60
buffer_load_dwordx4 v18, s[20:23], s54 offen lds
MAA 64,84,64
TR 106,25,544
v_add_f32 v164, v164, v172
MAA 64,80,44
TR 108,25,12448
MAA 68,80,48
TR 110,25,12960
MAA 68,84,68
buffer_load_dwordx4 v19, s[20:23], s54 offen offset:1024 lds
MAA 72,84,72
TR 112,25,1056
MAA 72,80,52
TR 114,25,1568
s_waitcnt lgkmcnt(6)
MAA 156,88,56
TR 116,25,13472
v_add_f32 v165, v165, v173
MAA 156,92,76
buffer_load_dwordx4 v20, s[20:23], s54 offen offset:2048 lds
MAA 104,92,72
TR 118,25,13984
s_add_u32 s54, s54, 196608
MAA 104,88,52
TR 120,25,2080
MAA 100,88,48
s_add_u32 m0, s55, 0
MAA 100,92,68
buffer_load_dwordx4 v21, s[16:19], s52 offen sc1 lds
MAA 96,92,64
TR 122,25,2592
v_add_f32 v166, v166, v174
MAA 96,88,44
TR 124,25,14496
MAA 92,88,40
TR 126,25,15008
MAA 92,92,60
buffer_load_dwordx4 v21, s[16:19], s52 offen offset:1024 sc1 lds
MAA 124,60,100
RD 0,23,18432
MAA 124,40,96
RD 4,23,19456
v_add_f32 v167, v167, v175
MAA 128,44,96
RD 8,23,20736
MAA 128,64,100
buffer_load_dword v22, s[16:19], s52 offen offset:2048 sc1 lds
MAA 132,68,100
RD 12,23,21760
s_add_u32 s52, s52, 131072
MAA 132,48,96
RD 16,24,20480
MAA 136,52,96
MAA 136,72,100
s_waitcnt vmcnt(17) lgkmcnt(5)
s_barrier
MAA 76,104,40
RD 20,23,27648
s_add_u32 m0, s56, 67584
MAA 76,108,60
buffer_load_dwordx4 v18, s[20:23], s54 offen lds
MAA 80,108,64
RD 24,23,28672
MAA 80,104,44
RD 28,23,29952
MAA 84,104,48
RD 32,23,30976
MAA 84,108,68
buffer_load_dwordx4 v19, s[20:23], s54 offen offset:1024 lds
MAA 88,108,72
RD 36,24,29696
MAA 88,104,52
buffer_load_dwordx4 v20, s[20:23], s54 offen offset:2048 lds
MAA 160,112,56
TR 80,25,24832
s_add_u32 s54, s54, 196608
MAA 160,116,76
TR 82,25,25344
MAA 120,116,72
TR 84,25,37248
s_add_u32 m0, s55, 9216
MAA 120,112,52
buffer_load_dwordx4 v21, s[16:19], s52 offen sc1 lds
MAA 116,112,48
TR 86,25,37760
MAA 116,116,68
TR 88,25,25856
MAA 112,116,64
TR 90,25,26368
MAA 112,112,44
buffer_load_dwordx4 v21, s[16:19], s52 offen offset:1024 sc1 lds
MAA 108,112,40
TR 92,25,38272
MAA 108,116,60
TR 94,25,38784
MAA 140,60,124
TR 96,25,26880
MAA 140,40,120
buffer_load_dword v22, s[16:19], s52 offen offset:2048 sc1 lds
MAA 144,44,120
TR 98,25,27392
s_add_u32 s52, s52, 131072
MAA 144,64,124
buffer_load_dwordx4 v[172:175], v26, s[16:19], s75 offen offset:1024 sc1
MAA 148,68,124
TR 100,25,39296
s_add_u32 s75, s75, 2048
MAA 148,48,120
TR 102,25,39808
MAA 152,52,120
MAA 152,72,124
s_waitcnt vmcnt(21) lgkmcnt(8)
s_barrier
MAA 60,80,0
TR 104,25,24864
s_add_u32 m0, s56, 80000
MAA 60,84,20
buffer_load_dwordx4 v18, s[20:23], s54 offen lds
MAA 64,84,24
TR 106,25,25376
MAA 64,80,4
TR 108,25,37280
MAA 68,80,8
TR 110,25,37792
MAA 68,84,28
buffer_load_dwordx4 v19, s[20:23], s54 offen offset:1024 lds
MAA 72,84,32
.Lpad22:
s_cbranch_execz .Lpad25
TR 112,25,25888
MAA 72,80,12
TR 114,25,26400
s_waitcnt lgkmcnt(6)
MAA 156,88,16
TR 116,25,38304
MAA 156,92,36
buffer_load_dwordx4 v20, s[20:23], s54 offen offset:2048 lds
MAA 104,92,32
TR 118,25,38816
s_add_u32 s54, s54, 196608
MAA 104,88,12
TR 120,25,26912
MAA 100,88,8
s_add_u32 m0, s55, 18432
MAA 100,92,28
buffer_load_dwordx4 v21, s[16:19], s52 offen sc1 lds
MAA 96,92,24
TR 122,25,27424
MAA 96,88,4
TR 124,25,39328
MAA 92,88,0
TR 126,25,39840
MAA 92,92,20
buffer_load_dwordx4 v21, s[16:19], s52 offen offset:1024 sc1 lds
MAA 124,20,100
RD 40,23,36864
MAA 124,0,96
RD 44,23,37888
MAA 128,4,96
RD 48,23,39168
MAA 128,24,100
buffer_load_dword v22, s[16:19], s52 offen offset:2048 sc1 lds
MAA 132,28,100
RD 52,23,40192
s_add_u32 s52, s52, 131072
MAA 132,8,96
RD 56,24,38912
MAA 136,12,96
MAA 136,32,100
s_waitcnt vmcnt(16) lgkmcnt(5)
s_barrier
MAA 76,104,0
RD 60,23,46080
s_add_u32 m0, s56, 92416
MAA 76,108,20
buffer_load_dwordx4 v18, s[20:23], s54 offen lds
MAA 80,108,24
RD 64,23,47104
MAA 80,104,4
RD 68,23,48384
MAA 84,104,8
RD 72,23,49408
MAA 84,108,28
buffer_load_dwordx4 v19, s[20:23], s54 offen offset:1024 lds
MAA 88,108,32
RD 76,24,48128
MAA 88,104,12
TR 80,25,49664
MAA 160,112,16
TR 82,25,50176
MAA 160,116,36
buffer_load_dwordx4 v20, s[20:23], s54 offen offset:2048 lds
MAA 120,116,32
TR 84,25,62080
s_add_u32 s54, s54, 196608
MAA 120,112,12
TR 86,25,62592
MAA 116,112,8
s_add_u32 m0, s55, 27648
MAA 116,116,28
buffer_load_dwordx4 v21, s[16:19], s52 offen sc1 lds
MAA 112,116,24
TR 88,25,50688
MAA 112,112,4
TR 90,25,51200
MAA 108,112,0
TR 92,25,63104
MAA 108,116,20
buffer_load_dwordx4 v21, s[16:19], s52 offen offset:1024 sc1 lds
MAA 140,20,124
TR 94,25,63616
MAA 140,0,120
TR 96,25,51712
MAA 144,4,120
TR 98,25,52224
MAA 144,24,124
buffer_load_dword v22, s[16:19], s52 offen offset:2048 sc1 lds
MAA 148,28,124
TR 100,25,64128
s_add_u32 s52, s52, 131072
MAA 148,8,120
TR 102,25,64640
MAA 152,12,120
MAA 152,32,124
s_waitcnt vmcnt(19) lgkmcnt(8)
s_barrier
MAA 60,80,40
TR 104,25,49696
s_add_u32 m0, s56, 104832
MAA 60,84,60
buffer_load_dwordx4 v18, s[20:23], s54 offen lds
MAA 64,84,64
TR 106,25,50208
v_add_f32 v164, v164, v168
MAA 64,80,44
TR 108,25,62112
MAA 68,80,48
TR 110,25,62624
MAA 68,84,68
buffer_load_dwordx4 v19, s[20:23], s54 offen offset:1024 lds
MAA 72,84,72
TR 112,25,50720
v_add_f32 v165, v165, v169
MAA 72,80,52
TR 114,25,51232
s_waitcnt lgkmcnt(6)
MAA 156,88,56
TR 116,25,63136
MAA 156,92,76
buffer_load_dwordx4 v20, s[20:23], s54 offen offset:2048 lds
MAA 104,92,72
s_add_u32 s54, s54, 196608
s_add_u32 m0, s55, 36864
MAA 104,88,52
buffer_load_dwordx4 v21, s[16:19], s52 offen sc1 lds
MAA 100,88,48
TR 118,25,63648
MAA 100,92,68
TR 120,25,51744
v_add_f32 v166, v166, v170
MAA 96,92,64
TR 122,25,52256
MAA 96,88,44
buffer_load_dwordx4 v21, s[16:19], s52 offen offset:1024 sc1 lds
MAA 92,88,40
TR 124,25,64160
MAA 92,92,60
TR 126,25,64672
v_add_f32 v167, v167, v171
MAA 124,60,100
ds_read_b128 a[0:3], v23
MAA 124,40,96
buffer_load_dword v22, s[16:19], s52 offen offset:2048 sc1 lds
MAA 128,44,96
RD 4,23,1024
s_add_u32 s52, s52, 131072
MAA 128,64,100
buffer_load_dword v27, v14, s[20:23], s44 offen
MAA 132,68,100
RD 8,23,2304
s_add_u32 s44, s44, 1572864
MAA 132,48,96
RD 12,23,3328
MAA 136,52,96
RD 16,24,2048
MAA 136,72,100
s_waitcnt vmcnt(16) lgkmcnt(5)
s_barrier
MAA 76,104,40
RD 20,23,9216
s_add_u32 m0, s56, 117248
MAA 76,108,60
buffer_load_dwordx4 v18, s[20:23], s54 offen lds
MAA 80,108,64
RD 24,23,10240
MAA 80,104,44
RD 28,23,11520
MAA 84,104,48
RD 32,23,12544
MAA 84,108,68
buffer_load_dwordx4 v19, s[20:23], s54 offen offset:1024 lds
MAA 88,108,72
RD 36,24,11264
MAA 88,104,52
buffer_load_dwordx4 v20, s[20:23], s54 offen offset:2048 lds
MAA 160,112,56
ds_read_b64_tr_b16 a[80:81], v25
s_add_u32 s54, s54, 196608
MAA 160,116,76
TR 82,25,512
MAA 120,116,72
TR 84,25,12416
s_add_u32 m0, s55, 46080
MAA 120,112,52
buffer_load_dwordx4 v21, s[16:19], s52 offen sc1 lds
MAA 116,112,48
TR 86,25,12928
MAA 116,116,68
TR 88,25,1024
MAA 112,116,64
TR 90,25,1536
MAA 112,112,44
buffer_load_dwordx4 v21, s[16:19], s52 offen offset:1024 sc1 lds
MAA 108,112,40
TR 92,25,13440
MAA 108,116,60
TR 94,25,13952
MAA 140,60,124
TR 96,25,2048
MAA 140,40,120
buffer_load_dword v22, s[16:19], s52 offen offset:2048 sc1 lds
MAA 144,44,120
TR 98,25,2560
s_add_u32 s52, s52, 131072
MAA 144,64,124
buffer_load_dwordx4 v[168:171], v26, s[16:19], s75 offen sc1
MAA 148,68,124
TR 100,25,14464
MAA 148,48,120
TR 102,25,14976
MAA 152,52,120
MAA 152,72,124
s_waitcnt vmcnt(20) lgkmcnt(8)
s_barrier
MAA 60,80,0
TR 104,25,32
s_add_u32 m0, s56, 129664
MAA 60,84,20
buffer_load_dwordx4 v18, s[20:23], s54 offen lds
MAA 64,84,24
TR 106,25,544
v_add_f32 v164, v164, v172
MAA 64,80,4
TR 108,25,12448
MAA 68,80,8
TR 110,25,12960
MAA 68,84,28
buffer_load_dwordx4 v19, s[20:23], s54 offen offset:1024 lds
MAA 72,84,32
TR 112,25,1056
MAA 72,80,12
TR 114,25,1568
s_waitcnt lgkmcnt(6)
MAA 156,88,16
TR 116,25,13472
v_add_f32 v165, v165, v173
MAA 156,92,36
buffer_load_dwordx4 v20, s[20:23], s54 offen offset:2048 lds
MAA 104,92,32
TR 118,25,13984
s_add_u32 s54, s54, 196608
MAA 104,88,12
TR 120,25,2080
MAA 100,88,8
s_add_u32 m0, s55, 0
MAA 100,92,28
buffer_load_dwordx4 v21, s[16:19], s52 offen sc1 lds
MAA 96,92,24
TR 122,25,2592
v_add_f32 v166, v166, v174
MAA 96,88,4
TR 124,25,14496
MAA 92,88,0
TR 126,25,15008
MAA 92,92,20
buffer_load_dwordx4 v21, s[16:19], s52 offen offset:1024 sc1 lds
MAA 124,20,100
RD 40,23,18432
MAA 124,0,96
RD 44,23,19456
v_add_f32 v167, v167, v175
MAA 128,4,96
RD 48,23,20736
MAA 128,24,100
buffer_load_dword v22, s[16:19], s52 offen offset:2048 sc1 lds
MAA 132,28,100
RD 52,23,21760
s_add_u32 s52, s52, 131072
MAA 132,8,96
RD 56,24,20480
MAA 136,12,96
MAA 136,32,100
s_waitcnt vmcnt(17) lgkmcnt(5)
s_barrier
MAA 76,104,0
RD 60,23,27648
s_add_u32 m0, s56, 67584
MAA 76,108,20
buffer_load_dwordx4 v18, s[20:23], s54 offen lds
MAA 80,108,24
RD 64,23,28672
MAA 80,104,4
RD 68,23,29952
MAA 84,104,8
RD 72,23,30976
MAA 84,108,28
buffer_load_dwordx4 v19, s[20:23], s54 offen offset:1024 lds
MAA 88,108,32
RD 76,24,29696
MAA 88,104,12
buffer_load_dwordx4 v20, s[20:23], s54 offen offset:2048 lds
MAA 160,112,16
TR 80,25,24832
s_add_u32 s54, s54, 196608
MAA 160,116,36
TR 82,25,25344
MAA 120,116,32
TR 84,25,37248
s_add_u32 m0, s55, 9216
MAA 120,112,12
buffer_load_dwordx4 v21, s[16:19], s52 offen sc1 lds
MAA 116,112,8
TR 86,25,37760
MAA 116,116,28
TR 88,25,25856
MAA 112,116,24
TR 90,25,26368
MAA 112,112,4
buffer_load_dwordx4 v21, s[16:19], s52 offen offset:1024 sc1 lds
MAA 108,112,0
TR 92,25,38272
MAA 108,116,20
TR 94,25,38784
MAA 140,20,124
TR 96,25,26880
MAA 140,0,120
buffer_load_dword v22, s[16:19], s52 offen offset:2048 sc1 lds
MAA 144,4,120
TR 98,25,27392
s_add_u32 s52, s52, 131072
MAA 144,24,124
buffer_load_dwordx4 v[172:175], v26, s[16:19], s75 offen offset:1024 sc1
MAA 148,28,124
TR 100,25,39296
s_add_u32 s75, s75, 2048
MAA 148,8,120
TR 102,25,39808
MAA 152,12,120
MAA 152,32,124
s_waitcnt vmcnt(21) lgkmcnt(8)
s_barrier
MAA 60,80,40
TR 104,25,24864
s_add_u32 m0, s56, 80000
MAA 60,84,60
buffer_load_dwordx4 v18, s[20:23], s54 offen lds
MAA 64,84,64
TR 106,25,25376
MAA 64,80,44
TR 108,25,37280
MAA 68,80,48
TR 110,25,37792
MAA 68,84,68
buffer_load_dwordx4 v19, s[20:23], s54 offen offset:1024 lds
MAA 72,84,72
TR 112,25,25888
MAA 72,80,52
TR 114,25,26400
s_waitcnt lgkmcnt(6)
MAA 156,88,56
TR 116,25,38304
MAA 156,92,76
buffer_load_dwordx4 v20, s[20:23], s54 offen offset:2048 lds
MAA 104,92,72
TR 118,25,38816
s_add_u32 s54, s54, 196608
MAA 104,88,52
TR 120,25,26912
MAA 100,88,48
s_add_u32 m0, s55, 18432
MAA 100,92,68
buffer_load_dwordx4 v21, s[16:19], s52 offen sc1 lds
MAA 96,92,64
TR 122,25,27424
MAA 96,88,44
TR 124,25,39328
MAA 92,88,40
TR 126,25,39840
MAA 92,92,60
buffer_load_dwordx4 v21, s[16:19], s52 offen offset:1024 sc1 lds
MAA 124,60,100
RD 0,23,36864
MAA 124,40,96
RD 4,23,37888
MAA 128,44,96
RD 8,23,39168
MAA 128,64,100
buffer_load_dword v22, s[16:19], s52 offen offset:2048 sc1 lds
MAA 132,68,100
RD 12,23,40192
s_add_u32 s52, s52, 131072
MAA 132,48,96
RD 16,24,38912
MAA 136,52,96
MAA 136,72,100
s_waitcnt vmcnt(16) lgkmcnt(5)
s_barrier
MAA 76,104,40
RD 20,23,46080
s_add_u32 m0, s56, 92416
MAA 76,108,60
buffer_load_dwordx4 v18, s[20:23], s54 offen lds
MAA 80,108,64
RD 24,23,47104
MAA 80,104,44
RD 28,23,48384
MAA 84,104,48
RD 32,23,49408
MAA 84,108,68
buffer_load_dwordx4 v19, s[20:23], s54 offen offset:1024 lds
MAA 88,108,72
RD 36,24,48128
MAA 88,104,52
TR 80,25,49664
MAA 160,112,56
TR 82,25,50176
MAA 160,116,76
buffer_load_dwordx4 v20, s[20:23], s54 offen offset:2048 lds
MAA 120,116,72
TR 84,25,62080
s_add_u32 s54, s54, 196608
MAA 120,112,52
TR 86,25,62592
MAA 116,112,48
s_add_u32 m0, s55, 27648
MAA 116,116,68
buffer_load_dwordx4 v21, s[16:19], s52 offen sc1 lds
MAA 112,116,64
TR 88,25,50688
MAA 112,112,44
TR 90,25,51200
MAA 108,112,40
TR 92,25,63104
MAA 108,116,60
buffer_load_dwordx4 v21, s[16:19], s52 offen offset:1024 sc1 lds
MAA 140,60,124
TR 94,25,63616
MAA 140,40,120
TR 96,25,51712
MAA 144,44,120
TR 98,25,52224
MAA 144,64,124
buffer_load_dword v22, s[16:19], s52 offen offset:2048 sc1 lds
MAA 148,68,124
TR 100,25,64128
s_add_u32 s52, s52, 131072
MAA 148,48,120
TR 102,25,64640
MAA 152,52,120
s_add_u32 s15, s15, 1
MAA 152,72,124
s_cbranch_scc0 .Lk57
s_waitcnt vmcnt(19) lgkmcnt(8)
s_barrier
MAA 60,80,0
TR 104,25,49696
s_add_u32 m0, s56, 104832
MAA 60,84,20
buffer_load_dwordx4 v18, s[20:23], s54 offen lds
MAA 64,84,24
TR 106,25,50208
v_add_f32 v164, v164, v168
MAA 64,80,4
TR 108,25,62112
v_add_f32 v165, v165, v169
MAA 68,80,8
TR 110,25,62624
v_add_f32 v166, v166, v170
MAA 68,84,28
buffer_load_dwordx4 v19, s[20:23], s54 offen offset:1024 lds
MAA 72,84,32
TR 112,25,50720
v_add_f32 v167, v167, v171
MAA 72,80,12
TR 114,25,51232
s_waitcnt lgkmcnt(6)
MAA 156,88,16
TR 116,25,63136
MAA 156,92,36
buffer_load_dwordx4 v20, s[20:23], s54 offen offset:2048 lds
MAA 104,92,32
TR 118,25,63648
s_add_u32 s54, s54, 196608
MAA 104,88,12
TR 120,25,51744
s_add_u32 m0, s55, 36864
MAA 100,88,8
TR 122,25,52256
MAA 100,92,28
buffer_load_dwordx4 v21, s[16:19], s52 offen sc1 lds
MAA 96,92,24
TR 124,25,64160
MAA 96,88,4
TR 126,25,64672
MAA 92,88,0
ds_read_b128 a[40:43], v23
MAA 92,92,20
buffer_load_dwordx4 v21, s[16:19], s52 offen offset:1024 sc1 lds
MAA 124,20,100
RD 44,23,1024
MAA 124,0,96
RD 48,23,2304
MAA 128,4,96
RD 52,23,3328
MAA 128,24,100
buffer_load_dword v22, s[16:19], s52 offen offset:2048 sc1 lds
MAA 132,28,100
RD 56,24,2048
s_add_u32 s52, s52, 131072
MAA 132,8,96
MAA 136,12,96
MAA 136,32,100
s_waitcnt vmcnt(15) lgkmcnt(5)
s_barrier
MAA 76,104,0
RD 60,23,9216
s_add_u32 m0, s56, 117248
MAA 76,108,20
buffer_load_dwordx4 v18, s[20:23], s54 offen lds
MAA 80,108,24
RD 64,23,10240
v_add_f32 v164, v164, v172
MAA 80,104,4
RD 68,23,11520
v_add_f32 v165, v165, v173
MAA 84,104,8
RD 72,23,12544
v_add_f32 v166, v166, v174
MAA 84,108,28
buffer_load_dwordx4 v19, s[20:23], s54 offen offset:1024 lds
MAA 88,108,32
RD 76,24,11264
v_add_f32 v167, v167, v175
MAA 88,104,12
ds_read_b64_tr_b16 a[80:81], v25
MAA 160,112,16
TR 82,25,512
MAA 160,116,36
buffer_load_dwordx4 v20, s[20:23], s54 offen offset:2048 lds
MAA 120,116,32
TR 84,25,12416
.Lpad23:
s_cbranch_execz .Lpad26
s_add_u32 s54, s54, 196608
MAA 120,112,12
TR 86,25,12928
s_add_u32 m0, s55, 46080
MAA 116,112,8
TR 88,25,1024
MAA 116,116,28
buffer_load_dwordx4 v21, s[16:19], s52 offen sc1 lds
MAA 112,116,24
TR 90,25,1536
MAA 112,112,4
TR 92,25,13440
MAA 108,112,0
TR 94,25,13952
MAA 108,116,20
buffer_load_dwordx4 v21, s[16:19], s52 offen offset:1024 sc1 lds
MAA 140,20,124
TR 96,25,2048
MAA 140,0,120
TR 98,25,2560
MAA 144,4,120
TR 100,25,14464
MAA 144,24,124
buffer_load_dword v22, s[16:19], s52 offen offset:2048 sc1 lds
MAA 148,28,124
TR 102,25,14976
s_add_u32 s52, s52, 131072
MAA 148,8,120
v_permlane32_swap_b32 v164, v166
MAA 152,12,120
v_permlane32_swap_b32 v165, v167
MAA 152,32,124
s_waitcnt vmcnt(18) lgkmcnt(8)
s_barrier
MAA 60,80,40
TR 104,25,32
s_add_u32 m0, s56, 129664
MAA 60,84,60
buffer_load_dwordx4 v18, s[20:23], s54 offen lds
MAA 64,84,64
TR 106,25,544
v_add_f32 v164, v164, v166
MAA 64,80,44
TR 108,25,12448
v_add_f32 v165, v165, v167
MAA 68,80,48
buffer_load_dwordx4 v19, s[20:23], s54 offen offset:1024 lds
MAA 68,84,68
TR 110,25,12960
v_mul_f32 v164, 0xba800000, v164
MAA 72,84,72
TR 112,25,1056
v_mul_f32 v165, 0x3a800000, v165
MAA 72,80,52
buffer_load_dwordx4 v20, s[20:23], s54 offen offset:2048 lds
s_waitcnt lgkmcnt(5)
MAA 156,88,56
TR 114,25,1568
s_add_u32 s54, s54, 196608
MAA 156,92,76
TR 116,25,13472
s_add_u32 m0, s59, 58240
MAA 104,92,72
TR 118,25,13984
s_xor_b32 s58, s87, 1966080
MAA 104,88,52
buffer_load_dwordx4 v5, s[24:27], s58 offen lds
MAA 100,88,48
TR 120,25,2080
v_fma_f32 v165, -v164, v164, v165
MAA 100,92,68
TR 122,25,2592
v_max_f32 v165, 0, v165
MAA 96,92,64
buffer_load_dwordx4 v6, s[24:27], s58 offen offset:1024 lds
MAA 96,88,44
TR 124,25,14496
s_add_u32 m0, s59, 0
MAA 92,88,40
TR 126,25,15008
s_xor_b32 s58, s87, 1048576
MAA 92,92,60
buffer_load_dwordx4 v5, s[24:27], s58 offen lds
MAA 124,60,100
RD 0,23,18432
v_add_f32 v165, 0x3727c5ac, v165
MAA 124,40,96
RD 4,23,19456
MAA 128,44,96
buffer_load_dwordx4 v6, s[24:27], s58 offen offset:1024 lds
MAA 128,64,100
RD 8,23,20736
MAA 132,68,100
RD 12,23,21760
MAA 132,48,96
RD 16,24,20480
MAA 136,52,96
v_rsq_f32 v166, v165
MAA 136,72,100
v_mov_b32 v165, v166
v_mul_f32 v166, 0x3e8293ee, v166
ds_write_b128 v7, v[164:167]
s_waitcnt vmcnt(16) lgkmcnt(6)
s_barrier
MAA 76,104,40
ds_write_b32 v17, v164
s_add_u32 m0, s59, 8320
MAA 76,108,60
ds_write_b32 v17, v165 offset:1024
s_xor_b32 s58, s87, 1179648
MAA 80,108,64
buffer_load_dwordx4 v5, s[24:27], s58 offen lds
MAA 80,104,44
RD 20,23,27648
MAA 84,104,48
RD 24,23,28672
MAA 84,108,68
RD 28,23,29952
MAA 88,108,72
buffer_load_dwordx4 v6, s[24:27], s58 offen offset:1024 lds
MAA 88,104,52
RD 32,23,30976
s_add_u32 m0, s59, 66560
MAA 160,112,56
RD 36,24,29696
s_xor_b32 s58, s87, 0
MAA 160,116,76
TR 80,25,24832
MAA 120,116,72
buffer_load_dwordx4 v5, s[24:27], s58 offen lds
MAA 120,112,52
TR 82,25,25344
MAA 116,112,48
TR 84,25,37248
MAA 116,116,68
TR 86,25,37760
MAA 112,116,64
buffer_load_dwordx4 v6, s[24:27], s58 offen offset:1024 lds
MAA 112,112,44
TR 88,25,25856
s_add_u32 m0, s59, 74880
MAA 108,112,40
TR 90,25,26368
s_xor_b32 s58, s87, 131072
MAA 108,116,60
TR 92,25,38272
MAA 140,60,124
buffer_load_dwordx4 v5, s[24:27], s58 offen lds
MAA 140,40,120
TR 94,25,38784
MAA 144,44,120
TR 96,25,26880
MAA 144,64,124
TR 98,25,27392
MAA 148,68,124
buffer_load_dwordx4 v6, s[24:27], s58 offen offset:1024 lds
MAA 148,48,120
TR 100,25,39296
MAA 152,52,120
TR 102,25,39808
MAA 152,72,124
s_waitcnt vmcnt(10) lgkmcnt(0)
s_barrier
MAA 156,88,16
TR 112,25,25888
s_add_u32 m0, s59, 83200
MAA 156,92,36
TR 114,25,26400
s_xor_b32 s58, s87, 262144
MAA 104,92,32
buffer_load_dwordx4 v5, s[24:27], s58 offen lds
MAA 104,88,12
TR 116,25,38304
MAA 100,88,8
TR 118,25,38816
MAA 100,92,28
TR 120,25,26912
MAA 96,92,24
buffer_load_dwordx4 v6, s[24:27], s58 offen offset:1024 lds
MAA 96,88,4
TR 122,25,27424
s_add_u32 m0, s59, 16640
MAA 92,88,0
TR 124,25,39328
s_xor_b32 s58, s87, 1310720
MAA 92,92,20
TR 126,25,39840
MAA 136,32,100
buffer_load_dwordx4 v5, s[24:27], s58 offen lds
MAA 136,12,96
TR 104,25,24864
MAA 72,80,12
TR 106,25,25376
MAA 72,84,32
TR 108,25,37280
MAA 68,84,28
buffer_load_dwordx4 v6, s[24:27], s58 offen offset:1024 lds
MAA 68,80,8
TR 110,25,37792
s_add_u32 m0, s59, 24960
MAA 64,80,4
RD 40,23,36864
s_xor_b32 s58, s87, 1441792
MAA 64,84,24
RD 44,23,37888
MAA 60,84,20
buffer_load_dwordx4 v5, s[24:27], s58 offen lds
MAA 60,80,0
RD 48,23,39168
s_waitcnt lgkmcnt(13)
MAA 160,112,16
RD 52,23,40192
s_waitcnt lgkmcnt(12)
MAA 160,116,36
RD 56,24,38912
MAA 120,116,32
buffer_load_dwordx4 v6, s[24:27], s58 offen offset:1024 lds
MAA 120,112,12
s_waitcnt lgkmcnt(5)
s_barrier
RD 60,23,46080
MAA 116,112,8
RD 64,23,47104
s_add_u32 m0, s59, 91520
MAA 116,116,28
RD 68,23,48384
s_xor_b32 s58, s87, 393216
MAA 112,116,24
RD 72,23,49408
MAA 112,112,4
RD 76,24,48128
MAA 108,112,0
TR 144,25,50688
MAA 108,116,20
TR 146,25,51200
MAA 152,32,124
TR 148,25,63104
MAA 152,12,120
TR 150,25,63616
MAA 88,104,12
TR 152,25,50720
MAA 88,108,32
TR 154,25,51232
MAA 84,108,28
TR 156,25,63136
MAA 84,104,8
TR 158,25,63648
MAA 80,104,4
TR 160,25,51712
MAA 80,108,24
TR 162,25,52224
MAA 76,108,20
TR 164,25,64128
MAA 76,104,0
TR 166,25,64640
s_waitcnt lgkmcnt(10)
MAA 156,144,56
TR 168,25,51744
s_waitcnt lgkmcnt(9)
MAA 156,148,76
TR 170,25,52256
MAA 104,148,72
TR 172,25,64160
MAA 104,144,52
TR 174,25,64672
MAA 100,144,48
TR 128,25,49664
MAA 100,148,68
TR 130,25,50176
MAA 96,148,64
TR 132,25,62080
MAA 96,144,44
TR 134,25,62592
MAA 92,144,40
TR 136,25,49696
MAA 92,148,60
TR 138,25,50208
s_waitcnt lgkmcnt(14)
MAA 160,156,76
TR 140,25,62112
MAA 160,152,56
TR 142,25,62624
MAA 120,152,52
ds_read_b128 v[232:235], v10 offset:768
MAA 120,156,72
ds_read_b128 v[236:239], v10 offset:2816
MAA 116,156,68
ds_read_b128 v[228:231], v10 offset:512
MAA 116,152,48
ds_read_b128 v[224:227], v10 offset:256
MAA 112,152,44
ds_read_b128 v[220:223], v10
MAA 112,156,64
buffer_load_dwordx4 v5, s[24:27], s58 offen lds
MAA 108,156,60
ds_read_b128 v[240:243], v11 offset:192
MAA 108,152,40
ds_read_b128 v[244:247], v11 offset:1216
s_waitcnt lgkmcnt(15)
MAA 136,52,160
ds_read_b128 v[18:21], v11 offset:128
MAA 136,72,164
buffer_load_dwordx4 v6, s[24:27], s58 offen offset:1024 lds
MAA 152,72,172
ds_read_b128 v[22:25], v11 offset:1152
s_add_u32 m0, s59, 99840
MAA 152,52,168
s_xor_b32 s58, s87, 524288
s_waitcnt lgkmcnt(15)
MAA 72,128,52
s_waitcnt lgkmcnt(13)
MAA 72,132,72
buffer_load_dwordx4 v5, s[24:27], s58 offen lds
MAA 68,132,68
MAA 68,128,48
MAA 64,128,44
MAA 64,132,64
buffer_load_dwordx4 v6, s[24:27], s58 offen offset:1024 lds
MAA 60,132,60
s_add_u32 m0, s59, 108160
s_xor_b32 s58, s87, 655360
MAA 60,128,40
s_waitcnt lgkmcnt(11)
MAA 88,136,52
s_waitcnt lgkmcnt(9)
MAA 88,140,72
buffer_load_dwordx4 v5, s[24:27], s58 offen lds
MAA 84,140,68
MAA 84,136,48
MAA 80,136,44
MAA 80,140,64
buffer_load_dwordx4 v6, s[24:27], s58 offen offset:1024 lds
MAA 76,140,60
MAA 76,136,40
s_waitcnt lgkmcnt(8)
v_pk_fma_f32 v[104:105], v[36:37], v[232:233], v[104:105] op_sel_hi:[1,0,1]
v_pk_mul_f32 v[104:105], v[104:105], v[232:233] op_sel:[0,1] op_sel_hi:[1,1]
v_cvt_pk_bf16_f32 v196, v104, v105
v_pk_fma_f32 v[106:107], v[38:39], v[232:233], v[106:107] op_sel_hi:[1,0,1]
v_pk_mul_f32 v[106:107], v[106:107], v[232:233] op_sel:[0,1] op_sel_hi:[1,1]
v_cvt_pk_bf16_f32 v197, v106, v107
v_pk_fma_f32 v[120:121], v[40:41], v[232:233], v[120:121] op_sel_hi:[1,0,1]
v_pk_mul_f32 v[120:121], v[120:121], v[232:233] op_sel:[0,1] op_sel_hi:[1,1]
v_cvt_pk_bf16_f32 v198, v120, v121
v_pk_fma_f32 v[122:123], v[42:43], v[232:233], v[122:123] op_sel_hi:[1,0,1]
v_pk_mul_f32 v[122:123], v[122:123], v[232:233] op_sel:[0,1] op_sel_hi:[1,1]
v_cvt_pk_bf16_f32 v199, v122, v123
s_waitcnt lgkmcnt(3)
v_pk_fma_f32 v[136:137], v[240:241], v[44:45], v[136:137] op_sel_hi:[1,0,1]
s_waitcnt lgkmcnt(2)
v_pk_mul_f32 v[136:137], v[136:137], v[244:245]
v_cvt_pk_bf16_f32 v208, v136, v137
v_pk_fma_f32 v[138:139], v[242:243], v[44:45], v[138:139] op_sel_hi:[1,0,1]
v_pk_mul_f32 v[138:139], v[138:139], v[246:247]
v_cvt_pk_bf16_f32 v209, v138, v139
v_pk_fma_f32 v[152:153], v[240:241], v[44:45], v[152:153] op_sel:[0,1,0] op_sel_hi:[1,1,1]
v_pk_mul_f32 v[152:153], v[152:153], v[244:245]
v_cvt_pk_bf16_f32 v218, v152, v153
v_pk_fma_f32 v[154:155], v[242:243], v[44:45], v[154:155] op_sel:[0,1,0] op_sel_hi:[1,1,1]
v_pk_mul_f32 v[154:155], v[154:155], v[246:247]
v_cvt_pk_bf16_f32 v219, v154, v155
ds_write_b128 v8, v[196:199]
ds_write_b64 v8, v[208:209] offset:1024
ds_write_b64 v8, v[218:219] offset:1032
v_pk_fma_f32 v[156:157], v[36:37], v[236:237], v[156:157] op_sel_hi:[1,0,1]
v_pk_mul_f32 v[156:157], v[156:157], v[236:237] op_sel:[0,1] op_sel_hi:[1,1]
v_cvt_pk_bf16_f32 v180, v156, v157
v_pk_fma_f32 v[158:159], v[38:39], v[236:237], v[158:159] op_sel_hi:[1,0,1]
v_pk_mul_f32 v[158:159], v[158:159], v[236:237] op_sel:[0,1] op_sel_hi:[1,1]
v_cvt_pk_bf16_f32 v181, v158, v159
v_pk_fma_f32 v[160:161], v[40:41], v[236:237], v[160:161] op_sel_hi:[1,0,1]
v_pk_mul_f32 v[160:161], v[160:161], v[236:237] op_sel:[0,1] op_sel_hi:[1,1]
v_cvt_pk_bf16_f32 v182, v160, v161
v_pk_fma_f32 v[162:163], v[42:43], v[236:237], v[162:163] op_sel_hi:[1,0,1]
v_pk_mul_f32 v[162:163], v[162:163], v[236:237] op_sel:[0,1] op_sel_hi:[1,1]
v_cvt_pk_bf16_f32 v183, v162, v163
v_pk_fma_f32 v[100:101], v[36:37], v[228:229], v[100:101] op_sel_hi:[1,0,1]
v_pk_mul_f32 v[100:101], v[100:101], v[228:229] op_sel:[0,1] op_sel_hi:[1,1]
v_cvt_pk_bf16_f32 v192, v100, v101
v_pk_fma_f32 v[102:103], v[38:39], v[228:229], v[102:103] op_sel_hi:[1,0,1]
v_pk_mul_f32 v[102:103], v[102:103], v[228:229] op_sel:[0,1] op_sel_hi:[1,1]
v_cvt_pk_bf16_f32 v193, v102, v103
v_pk_fma_f32 v[116:117], v[40:41], v[228:229], v[116:117] op_sel_hi:[1,0,1]
v_pk_mul_f32 v[116:117], v[116:117], v[228:229] op_sel:[0,1] op_sel_hi:[1,1]
v_cvt_pk_bf16_f32 v194, v116, v117
v_pk_fma_f32 v[118:119], v[42:43], v[228:229], v[118:119] op_sel_hi:[1,0,1]
v_pk_mul_f32 v[118:119], v[118:119], v[228:229] op_sel:[0,1] op_sel_hi:[1,1]
s_waitcnt lgkmcnt(0)
s_barrier
v_cvt_pk_bf16_f32 v195, v118, v119
v_pk_fma_f32 v[96:97], v[36:37], v[224:225], v[96:97] op_sel_hi:[1,0,1]
v_pk_mul_f32 v[96:97], v[96:97], v[224:225] op_sel:[0,1] op_sel_hi:[1,1]
v_cvt_pk_bf16_f32 v188, v96, v97
v_pk_fma_f32 v[98:99], v[38:39], v[224:225], v[98:99] op_sel_hi:[1,0,1]
v_pk_mul_f32 v[98:99], v[98:99], v[224:225] op_sel:[0,1] op_sel_hi:[1,1]
v_cvt_pk_bf16_f32 v189, v98, v99
v_pk_fma_f32 v[112:113], v[40:41], v[224:225], v[112:113] op_sel_hi:[1,0,1]
v_pk_mul_f32 v[112:113], v[112:113], v[224:225] op_sel:[0,1] op_sel_hi:[1,1]
v_cvt_pk_bf16_f32 v190, v112, v113
v_pk_fma_f32 v[114:115], v[42:43], v[224:225], v[114:115] op_sel_hi:[1,0,1]
v_pk_mul_f32 v[114:115], v[114:115], v[224:225] op_sel:[0,1] op_sel_hi:[1,1]
v_cvt_pk_bf16_f32 v191, v114, v115
v_pk_fma_f32 v[92:93], v[36:37], v[220:221], v[92:93] op_sel_hi:[1,0,1]
v_pk_mul_f32 v[92:93], v[92:93], v[220:221] op_sel:[0,1] op_sel_hi:[1,1]
v_cvt_pk_bf16_f32 v184, v92, v93
v_pk_fma_f32 v[94:95], v[38:39], v[220:221], v[94:95] op_sel_hi:[1,0,1]
v_pk_mul_f32 v[94:95], v[94:95], v[220:221] op_sel:[0,1] op_sel_hi:[1,1]
v_cvt_pk_bf16_f32 v185, v94, v95
v_pk_fma_f32 v[108:109], v[40:41], v[220:221], v[108:109] op_sel_hi:[1,0,1]
v_pk_mul_f32 v[108:109], v[108:109], v[220:221] op_sel:[0,1] op_sel_hi:[1,1]
v_cvt_pk_bf16_f32 v186, v108, v109
v_pk_fma_f32 v[110:111], v[42:43], v[220:221], v[110:111] op_sel_hi:[1,0,1]
v_pk_mul_f32 v[110:111], v[110:111], v[220:221] op_sel:[0,1] op_sel_hi:[1,1]
v_cvt_pk_bf16_f32 v187, v110, v111
v_pk_fma_f32 v[72:73], v[28:29], v[232:233], v[72:73] op_sel_hi:[1,0,1]
v_cvt_pk_bf16_f32 v176, v72, v73
v_pk_fma_f32 v[74:75], v[30:31], v[232:233], v[74:75] op_sel_hi:[1,0,1]
v_cvt_pk_bf16_f32 v177, v74, v75
v_pk_fma_f32 v[88:89], v[32:33], v[232:233], v[88:89] op_sel_hi:[1,0,1]
v_cvt_pk_bf16_f32 v178, v88, v89
v_pk_fma_f32 v[90:91], v[34:35], v[232:233], v[90:91] op_sel_hi:[1,0,1]
v_cvt_pk_bf16_f32 v179, v90, v91
v_pk_fma_f32 v[68:69], v[28:29], v[228:229], v[68:69] op_sel_hi:[1,0,1]
v_cvt_pk_bf16_f32 v172, v68, v69
v_pk_fma_f32 v[70:71], v[30:31], v[228:229], v[70:71] op_sel_hi:[1,0,1]
v_cvt_pk_bf16_f32 v173, v70, v71
v_pk_fma_f32 v[84:85], v[32:33], v[228:229], v[84:85] op_sel_hi:[1,0,1]
v_cvt_pk_bf16_f32 v174, v84, v85
v_pk_fma_f32 v[86:87], v[34:35], v[228:229], v[86:87] op_sel_hi:[1,0,1]
v_cvt_pk_bf16_f32 v175, v86, v87
v_pk_fma_f32 v[64:65], v[28:29], v[224:225], v[64:65] op_sel_hi:[1,0,1]
v_cvt_pk_bf16_f32 v168, v64, v65
v_pk_fma_f32 v[66:67], v[30:31], v[224:225], v[66:67] op_sel_hi:[1,0,1]
v_cvt_pk_bf16_f32 v169, v66, v67
v_pk_fma_f32 v[80:81], v[32:33], v[224:225], v[80:81] op_sel_hi:[1,0,1]
v_cvt_pk_bf16_f32 v170, v80, v81
v_pk_fma_f32 v[82:83], v[34:35], v[224:225], v[82:83] op_sel_hi:[1,0,1]
v_cvt_pk_bf16_f32 v171, v82, v83
v_pk_fma_f32 v[60:61], v[28:29], v[220:221], v[60:61] op_sel_hi:[1,0,1]
v_cvt_pk_bf16_f32 v164, v60, v61
v_pk_fma_f32 v[62:63], v[30:31], v[220:221], v[62:63] op_sel_hi:[1,0,1]
v_cvt_pk_bf16_f32 v165, v62, v63
v_pk_fma_f32 v[76:77], v[32:33], v[220:221], v[76:77] op_sel_hi:[1,0,1]
v_cvt_pk_bf16_f32 v166, v76, v77
v_pk_fma_f32 v[78:79], v[34:35], v[220:221], v[78:79] op_sel_hi:[1,0,1]
v_cvt_pk_bf16_f32 v167, v78, v79
s_nop 0
v_mfma_f32_16x16x32_bf16 v[120:123], v[196:199], v[176:179], v[50:53]
ds_read_b64 v[200:201], v9 offset:1024
v_mfma_f32_16x16x32_bf16 v[104:107], v[192:195], v[176:179], v[46:49]
ds_read_b64 v[210:211], v9 offset:1032
v_mfma_f32_16x16x32_bf16 v[116:119], v[192:195], v[172:175], v[50:53]
ds_read_b128 v[240:243], v11 offset:64
v_mfma_f32_16x16x32_bf16 v[100:103], v[188:191], v[172:175], v[46:49]
ds_read_b128 v[244:247], v11 offset:1088
v_mfma_f32_16x16x32_bf16 v[112:115], v[188:191], v[168:171], v[50:53]
ds_read_b128 v[28:31], v11
v_mfma_f32_16x16x32_bf16 v[96:99], v[184:187], v[168:171], v[46:49]
ds_read_b128 v[32:35], v11 offset:1024
v_max3_f32 v88, v104, v105, v106
v_mfma_f32_16x16x32_bf16 v[108:111], v[184:187], v[164:167], v[50:53]
v_max3_f32 v89, v107, v120, v121
v_max3_f32 v88, v88, v122, v123
v_mfma_f32_16x16x32_bf16 v[92:95], v[180:183], v[164:167], v[54:57]
v_max_f32 v90, v88, v89
v_max_f32 v89, v88, v89
MAA 132,8,96
s_nop 0
v_permlane16_swap_b32 v90, v89
MAA 132,28,100
v_max_f32 v88, v90, v89
v_max_f32 v89, v90, v89
MAA 132,48,160
s_nop 0
v_permlane32_swap_b32 v88, v89
MAA 132,68,164
v_max_f32 v88, v88, v89
v_mul_f32 v88, v88, v234
MAA 148,68,172
v_max3_f32 v84, v100, v101, v102
v_max3_f32 v85, v103, v116, v117
MAA 148,48,168
v_max3_f32 v84, v84, v118, v119
v_max_f32 v86, v84, v85
MAA 148,28,124
v_max_f32 v85, v84, v85
v_max3_f32 v80, v96, v97, v98
MAA 148,8,120
v_permlane16_swap_b32 v86, v85
v_max3_f32 v81, v99, v112, v113
v_max_f32 v84, v86, v85
v_max_f32 v85, v86, v85
v_max3_f32 v80, v80, v114, v115
v_max_f32 v82, v80, v81
v_permlane32_swap_b32 v84, v85
v_max_f32 v81, v80, v81
v_max_f32 v84, v84, v85
v_mul_f32 v84, v84, v230
v_permlane16_swap_b32 v82, v81
v_max3_f32 v76, v92, v93, v94
v_max_f32 v80, v82, v81
v_max_f32 v81, v82, v81
v_max3_f32 v77, v95, v108, v109
v_max3_f32 v76, v76, v110, v111
v_permlane32_swap_b32 v80, v81
v_max_f32 v78, v76, v77
v_max_f32 v80, v80, v81
v_mul_f32 v80, v80, v226
v_max_f32 v77, v76, v77
v_pk_fma_f32 v[104:105], v[104:105], v[234:235], v[88:89] op_sel_hi:[1,0,0] neg_lo:[0,0,1] neg_hi:[0,0,1]
v_pk_fma_f32 v[106:107], v[106:107], v[234:235], v[88:89] op_sel_hi:[1,0,0] neg_lo:[0,0,1] neg_hi:[0,0,1]
v_permlane16_swap_b32 v78, v77
v_pk_fma_f32 v[120:121], v[120:121], v[234:235], v[88:89] op_sel_hi:[1,0,0] neg_lo:[0,0,1] neg_hi:[0,0,1]
v_max_f32 v76, v78, v77
v_max_f32 v77, v78, v77
v_pk_fma_f32 v[122:123], v[122:123], v[234:235], v[88:89] op_sel_hi:[1,0,0] neg_lo:[0,0,1] neg_hi:[0,0,1]
v_pk_fma_f32 v[100:101], v[100:101], v[230:231], v[84:85] op_sel_hi:[1,0,0] neg_lo:[0,0,1] neg_hi:[0,0,1]
v_permlane32_swap_b32 v76, v77
v_pk_fma_f32 v[102:103], v[102:103], v[230:231], v[84:85] op_sel_hi:[1,0,0] neg_lo:[0,0,1] neg_hi:[0,0,1]
v_max_f32 v76, v76, v77
v_mul_f32 v76, v76, v222
v_pk_fma_f32 v[116:117], v[116:117], v[230:231], v[84:85] op_sel_hi:[1,0,0] neg_lo:[0,0,1] neg_hi:[0,0,1]
v_pk_fma_f32 v[118:119], v[118:119], v[230:231], v[84:85] op_sel_hi:[1,0,0] neg_lo:[0,0,1] neg_hi:[0,0,1]
v_pk_fma_f32 v[96:97], v[96:97], v[226:227], v[80:81] op_sel_hi:[1,0,0] neg_lo:[0,0,1] neg_hi:[0,0,1]
v_pk_fma_f32 v[98:99], v[98:99], v[226:227], v[80:81] op_sel_hi:[1,0,0] neg_lo:[0,0,1] neg_hi:[0,0,1]
v_pk_fma_f32 v[112:113], v[112:113], v[226:227], v[80:81] op_sel_hi:[1,0,0] neg_lo:[0,0,1] neg_hi:[0,0,1]
v_pk_fma_f32 v[114:115], v[114:115], v[226:227], v[80:81] op_sel_hi:[1,0,0] neg_lo:[0,0,1] neg_hi:[0,0,1]
v_pk_fma_f32 v[92:93], v[92:93], v[222:223], v[76:77] op_sel_hi:[1,0,0] neg_lo:[0,0,1] neg_hi:[0,0,1]
v_pk_fma_f32 v[94:95], v[94:95], v[222:223], v[76:77] op_sel_hi:[1,0,0] neg_lo:[0,0,1] neg_hi:[0,0,1]
v_pk_fma_f32 v[108:109], v[108:109], v[222:223], v[76:77] op_sel_hi:[1,0,0] neg_lo:[0,0,1] neg_hi:[0,0,1]
v_pk_fma_f32 v[110:111], v[110:111], v[222:223], v[76:77] op_sel_hi:[1,0,0] neg_lo:[0,0,1] neg_hi:[0,0,1]
v_pk_fma_f32 v[132:133], v[18:19], v[44:45], v[132:133] op_sel_hi:[1,0,1]
v_pk_mul_f32 v[132:133], v[132:133], v[22:23]
v_pk_fma_f32 v[134:135], v[20:21], v[44:45], v[134:135] op_sel_hi:[1,0,1]
v_pk_mul_f32 v[134:135], v[134:135], v[24:25]
v_pk_fma_f32 v[148:149], v[18:19], v[44:45], v[148:149] op_sel:[0,1,0] op_sel_hi:[1,1,1]
v_pk_mul_f32 v[148:149], v[148:149], v[22:23]
v_pk_fma_f32 v[150:151], v[20:21], v[44:45], v[150:151] op_sel:[0,1,0] op_sel_hi:[1,1,1]
v_pk_mul_f32 v[150:151], v[150:151], v[24:25]
v_exp_f32 v104, v104
s_nop 0
MAA 128,4,96
v_exp_f32 v105, v105
MAA 128,24,100
v_exp_f32 v106, v106
MAA 128,44,160
v_exp_f32 v107, v107
MAA 128,64,164
.Lpad24:
s_cbranch_execz .Lpad27
v_exp_f32 v120, v120
MAA 144,64,172
v_exp_f32 v121, v121
MAA 144,44,168
v_exp_f32 v122, v122
MAA 144,24,124
v_exp_f32 v123, v123
MAA 144,4,120
v_exp_f32 v100, v100
MAA 124,0,96
v_exp_f32 v101, v101
MAA 124,20,100
v_exp_f32 v102, v102
MAA 124,40,160
v_exp_f32 v103, v103
MAA 124,60,164
v_exp_f32 v116, v116
MAA 140,60,172
v_exp_f32 v117, v117
MAA 140,40,168
v_exp_f32 v118, v118
MAA 140,20,124
v_exp_f32 v119, v119
MAA 140,0,120
v_cvt_pk_bf16_f32 v72, v104, v105
v_cvt_pk_bf16_f32 v73, v106, v107
v_cvt_pk_bf16_f32 v74, v120, v121
v_cvt_pk_bf16_f32 v75, v122, v123
v_cvt_pk_bf16_f32 v68, v100, v101
v_cvt_pk_bf16_f32 v69, v102, v103
v_cvt_pk_bf16_f32 v70, v116, v117
v_cvt_pk_bf16_f32 v71, v118, v119
v_exp_f32 v96, v96
v_exp_f32 v97, v97
v_exp_f32 v98, v98
v_exp_f32 v99, v99
v_exp_f32 v112, v112
v_exp_f32 v113, v113
v_exp_f32 v114, v114
v_exp_f32 v115, v115
v_cvt_pk_bf16_f32 v64, v96, v97
v_cvt_pk_bf16_f32 v65, v98, v99
v_cvt_pk_bf16_f32 v66, v112, v113
v_cvt_pk_bf16_f32 v67, v114, v115
v_cvt_pk_bf16_f32 v206, v132, v133
v_cvt_pk_bf16_f32 v207, v134, v135
v_cvt_pk_bf16_f32 v216, v148, v149
v_cvt_pk_bf16_f32 v217, v150, v151
s_waitcnt lgkmcnt(3)
v_pk_fma_f32 v[128:129], v[240:241], v[44:45], v[128:129] op_sel_hi:[1,0,1]
s_waitcnt lgkmcnt(2)
v_pk_mul_f32 v[128:129], v[128:129], v[244:245]
v_cvt_pk_bf16_f32 v204, v128, v129
v_pk_fma_f32 v[130:131], v[242:243], v[44:45], v[130:131] op_sel_hi:[1,0,1]
v_pk_mul_f32 v[130:131], v[130:131], v[246:247]
v_cvt_pk_bf16_f32 v205, v130, v131
v_pk_fma_f32 v[144:145], v[240:241], v[44:45], v[144:145] op_sel:[0,1,0] op_sel_hi:[1,1,1]
v_pk_mul_f32 v[144:145], v[144:145], v[244:245]
v_cvt_pk_bf16_f32 v214, v144, v145
v_pk_fma_f32 v[146:147], v[242:243], v[44:45], v[146:147] op_sel:[0,1,0] op_sel_hi:[1,1,1]
v_pk_mul_f32 v[146:147], v[146:147], v[246:247]
v_cvt_pk_bf16_f32 v215, v146, v147
s_waitcnt lgkmcnt(1)
v_pk_fma_f32 v[124:125], v[28:29], v[44:45], v[124:125] op_sel_hi:[1,0,1]
s_waitcnt lgkmcnt(0)
v_pk_mul_f32 v[124:125], v[124:125], v[32:33]
v_cvt_pk_bf16_f32 v202, v124, v125
v_pk_fma_f32 v[126:127], v[30:31], v[44:45], v[126:127] op_sel_hi:[1,0,1]
v_pk_mul_f32 v[126:127], v[126:127], v[34:35]
v_cvt_pk_bf16_f32 v203, v126, v127
v_pk_fma_f32 v[140:141], v[28:29], v[44:45], v[140:141] op_sel:[0,1,0] op_sel_hi:[1,1,1]
v_pk_mul_f32 v[140:141], v[140:141], v[32:33]
v_cvt_pk_bf16_f32 v212, v140, v141
v_pk_fma_f32 v[142:143], v[30:31], v[44:45], v[142:143] op_sel:[0,1,0] op_sel_hi:[1,1,1]
v_pk_mul_f32 v[142:143], v[142:143], v[34:35]
v_cvt_pk_bf16_f32 v213, v142, v143
s_nop 0
v_mfma_f32_16x16x32_bf16 v[88:91], v[248:251], v[72:75], 0
v_exp_f32 v92, v92
v_mfma_f32_16x16x32_bf16 v[104:107], v[206:209], v[72:75], 0
v_exp_f32 v93, v93
v_mfma_f32_16x16x32_bf16 v[120:123], v[216:219], v[72:75], 0
v_exp_f32 v94, v94
v_mfma_f32_16x16x32_bf16 v[84:87], v[248:251], v[68:71], 0
v_exp_f32 v95, v95
v_mfma_f32_16x16x32_bf16 v[100:103], v[204:207], v[68:71], 0
v_exp_f32 v108, v108
v_mfma_f32_16x16x32_bf16 v[116:119], v[214:217], v[68:71], 0
v_exp_f32 v109, v109
v_mfma_f32_16x16x32_bf16 v[80:83], v[248:251], v[64:67], 0
v_exp_f32 v110, v110
v_mfma_f32_16x16x32_bf16 v[96:99], v[202:205], v[64:67], 0
v_exp_f32 v111, v111
v_mfma_f32_16x16x32_bf16 v[112:115], v[212:215], v[64:67], 0
v_cvt_pk_bf16_f32 v60, v92, v93
v_cvt_pk_bf16_f32 v61, v94, v95
v_cvt_pk_bf16_f32 v62, v108, v109
v_cvt_pk_bf16_f32 v63, v110, v111
v_rcp_f32 v88, v88
v_rcp_f32 v84, v84
v_mfma_f32_16x16x32_bf16 v[76:79], v[248:251], v[60:63], 0
v_rcp_f32 v80, v80
v_mfma_f32_16x16x32_bf16 v[92:95], v[200:203], v[60:63], 0
v_mfma_f32_16x16x32_bf16 v[108:111], v[210:213], v[60:63], 0
s_nop 4
v_rcp_f32 v76, v76
v_pk_mul_f32 v[104:105], v[104:105], v[88:89] op_sel_hi:[1,0]
v_pk_mul_f32 v[106:107], v[106:107], v[88:89] op_sel_hi:[1,0]
v_pk_mul_f32 v[120:121], v[120:121], v[88:89] op_sel_hi:[1,0]
v_pk_mul_f32 v[122:123], v[122:123], v[88:89] op_sel_hi:[1,0]
v_cvt_pk_bf16_f32 v176, v104, v105
v_cvt_pk_bf16_f32 v177, v106, v107
v_cvt_pk_bf16_f32 v178, v120, v121
v_cvt_pk_bf16_f32 v179, v122, v123
buffer_store_dwordx4 v[176:179], v4, s[16:19], s74 offen offset:3072 sc1
v_pk_mul_f32 v[100:101], v[100:101], v[84:85] op_sel_hi:[1,0]
v_pk_mul_f32 v[102:103], v[102:103], v[84:85] op_sel_hi:[1,0]
v_pk_mul_f32 v[116:117], v[116:117], v[84:85] op_sel_hi:[1,0]
v_pk_mul_f32 v[118:119], v[118:119], v[84:85] op_sel_hi:[1,0]
v_cvt_pk_bf16_f32 v172, v100, v101
v_cvt_pk_bf16_f32 v173, v102, v103
v_cvt_pk_bf16_f32 v174, v116, v117
v_cvt_pk_bf16_f32 v175, v118, v119
buffer_store_dwordx4 v[172:175], v4, s[16:19], s74 offen offset:2048 sc1
v_pk_mul_f32 v[96:97], v[96:97], v[80:81] op_sel_hi:[1,0]
v_pk_mul_f32 v[98:99], v[98:99], v[80:81] op_sel_hi:[1,0]
v_pk_mul_f32 v[112:113], v[112:113], v[80:81] op_sel_hi:[1,0]
v_pk_mul_f32 v[114:115], v[114:115], v[80:81] op_sel_hi:[1,0]
v_cvt_pk_bf16_f32 v168, v96, v97
v_cvt_pk_bf16_f32 v169, v98, v99
v_cvt_pk_bf16_f32 v170, v112, v113
v_cvt_pk_bf16_f32 v171, v114, v115
buffer_store_dwordx4 v[168:171], v4, s[16:19], s74 offen offset:1024 sc1
v_pk_mul_f32 v[92:93], v[92:93], v[76:77] op_sel_hi:[1,0]
v_pk_mul_f32 v[94:95], v[94:95], v[76:77] op_sel_hi:[1,0]
v_pk_mul_f32 v[108:109], v[108:109], v[76:77] op_sel_hi:[1,0]
v_pk_mul_f32 v[110:111], v[110:111], v[76:77] op_sel_hi:[1,0]
v_cvt_pk_bf16_f32 v164, v92, v93
v_cvt_pk_bf16_f32 v165, v94, v95
v_cvt_pk_bf16_f32 v166, v108, v109
v_cvt_pk_bf16_f32 v167, v110, v111
buffer_store_dwordx4 v[164:167], v4, s[16:19], s74 offen sc1
s_nop 1
s_branch .Lqkve56
.p2align 12
.Lqkv55:
.Lpad25:
s_cbranch_execz .Lpad28
s_add_u32 m0, s55, 36864
s_nop 0
buffer_load_dwordx4 v21, s[16:19], s52 offen sc1 lds
buffer_load_dwordx4 v21, s[16:19], s52 offen offset:1024 sc1 lds
buffer_load_dword v22, s[16:19], s52 offen offset:2048 sc1 lds
s_add_u32 s52, s52, 131072
TR 80,25,49664
TR 82,25,50176
TR 84,25,62080
s_add_u32 m0, s55, 46080
s_nop 0
buffer_load_dwordx4 v21, s[16:19], s52 offen sc1 lds
buffer_load_dwordx4 v21, s[16:19], s52 offen offset:1024 sc1 lds
buffer_load_dword v22, s[16:19], s52 offen offset:2048 sc1 lds
s_add_u32 s52, s52, 131072
TR 86,25,62592
TR 88,25,50688
TR 90,25,51200
s_add_u32 m0, s55, 0
s_nop 0
buffer_load_dwordx4 v21, s[16:19], s52 offen sc1 lds
buffer_load_dwordx4 v21, s[16:19], s52 offen offset:1024 sc1 lds
buffer_load_dword v22, s[16:19], s52 offen offset:2048 sc1 lds
s_add_u32 s52, s52, 131072
TR 92,25,63104
TR 94,25,63616
TR 96,25,51712
s_add_u32 m0, s55, 9216
s_nop 0
buffer_load_dwordx4 v21, s[16:19], s52 offen sc1 lds
buffer_load_dwordx4 v21, s[16:19], s52 offen offset:1024 sc1 lds
buffer_load_dword v22, s[16:19], s52 offen offset:2048 sc1 lds
s_add_u32 s52, s52, 131072
TR 98,25,52224
TR 100,25,64128
TR 102,25,64640
s_add_u32 m0, s55, 18432
s_nop 0
buffer_load_dwordx4 v21, s[16:19], s52 offen sc1 lds
buffer_load_dwordx4 v21, s[16:19], s52 offen offset:1024 sc1 lds
buffer_load_dword v22, s[16:19], s52 offen offset:2048 sc1 lds
s_add_u32 s52, s52, 131072
ds_read_b128 v[28:31], v13
ds_read_b128 v[32:35], v13 offset:64
ds_read_b128 v[36:39], v13 offset:256
s_add_u32 m0, s55, 27648
s_nop 0
buffer_load_dwordx4 v21, s[16:19], s52 offen sc1 lds
buffer_load_dwordx4 v21, s[16:19], s52 offen offset:1024 sc1 lds
buffer_load_dword v22, s[16:19], s52 offen offset:2048 sc1 lds
s_add_u32 s52, s52, 131072
ds_read_b128 v[40:43], v13 offset:320
ds_read_b32 v44, v12 offset:512
ds_read_b32 v45, v12 offset:576
s_waitcnt vmcnt(12)
s_barrier
RD 0,23,36864
RD 4,23,37888
RD 8,23,39168
RD 12,23,40192
RD 16,24,38912
RD 20,23,46080
RD 24,23,47104
RD 28,23,48384
RD 32,23,49408
RD 36,24,48128
s_waitcnt lgkmcnt(0)
s_mov_b32 s15, -2
.p2align 6
.Lk58:
s_waitcnt vmcnt(9) lgkmcnt(8)
s_barrier
MAA 60,80,0
TR 104,25,49696
s_add_u32 m0, s56, 104832
MAA 60,84,20
buffer_load_dwordx4 v18, s[20:23], s54 offen lds
MAA 64,84,24
TR 106,25,50208
v_add_f32 v164, v164, v168
MAA 64,80,4
TR 108,25,62112
MAA 68,80,8
TR 110,25,62624
MAA 68,84,28
buffer_load_dwordx4 v19, s[20:23], s54 offen offset:1024 lds
MAA 72,84,32
TR 112,25,50720
v_add_f32 v165, v165, v169
MAA 72,80,12
TR 114,25,51232
s_waitcnt lgkmcnt(6)
MAA 104,88,12
TR 116,25,63136
MAA 104,92,32
buffer_load_dwordx4 v20, s[20:23], s54 offen offset:2048 lds
MAA 100,92,28
s_add_u32 s54, s54, 196608
s_add_u32 m0, s55, 36864
MAA 100,88,8
buffer_load_dwordx4 v21, s[16:19], s52 offen sc1 lds
MAA 96,88,4
TR 118,25,63648
MAA 96,92,24
TR 120,25,51744
v_add_f32 v166, v166, v170
MAA 92,92,20
TR 122,25,52256
MAA 92,88,0
buffer_load_dwordx4 v21, s[16:19], s52 offen offset:1024 sc1 lds
MAA 124,0,96
TR 124,25,64160
MAA 124,20,100
TR 126,25,64672
v_add_f32 v167, v167, v171
MAA 128,24,100
ds_read_b128 a[40:43], v23
MAA 128,4,96
buffer_load_dword v22, s[16:19], s52 offen offset:2048 sc1 lds
MAA 132,8,96
RD 44,23,1024
s_add_u32 s52, s52, 131072
MAA 132,28,100
buffer_load_dword v27, v14, s[20:23], s44 offen
MAA 136,32,100
RD 48,23,2304
s_add_u32 s44, s44, 1572864
MAA 136,12,96
RD 52,23,3328
MAA 156,16,96
RD 56,24,2048
MAA 156,36,100
s_waitcnt vmcnt(13) lgkmcnt(5)
s_barrier
MAA 76,104,0
RD 60,23,9216
s_add_u32 m0, s56, 117248
MAA 76,108,20
buffer_load_dwordx4 v18, s[20:23], s54 offen lds
MAA 80,108,24
RD 64,23,10240
MAA 80,104,4
RD 68,23,11520
MAA 84,104,8
RD 72,23,12544
MAA 84,108,28
buffer_load_dwordx4 v19, s[20:23], s54 offen offset:1024 lds
MAA 88,108,32
RD 76,24,11264
MAA 88,104,12
buffer_load_dwordx4 v20, s[20:23], s54 offen offset:2048 lds
MAA 120,112,12
ds_read_b64_tr_b16 a[80:81], v25
s_add_u32 s54, s54, 196608
MAA 120,116,32
TR 82,25,512
MAA 116,116,28
TR 84,25,12416
s_add_u32 m0, s55, 46080
MAA 116,112,8
buffer_load_dwordx4 v21, s[16:19], s52 offen sc1 lds
MAA 112,112,4
TR 86,25,12928
MAA 112,116,24
TR 88,25,1024
MAA 108,116,20
TR 90,25,1536
MAA 108,112,0
buffer_load_dwordx4 v21, s[16:19], s52 offen offset:1024 sc1 lds
MAA 140,0,120
TR 92,25,13440
MAA 140,20,124
TR 94,25,13952
MAA 144,24,124
TR 96,25,2048
MAA 144,4,120
buffer_load_dword v22, s[16:19], s52 offen offset:2048 sc1 lds
MAA 148,8,120
TR 98,25,2560
s_add_u32 s52, s52, 131072
MAA 148,28,124
buffer_load_dwordx4 v[168:171], v26, s[16:19], s75 offen sc1
MAA 152,32,124
TR 100,25,14464
MAA 152,12,120
TR 102,25,14976
MAA 160,16,120
MAA 160,36,124
s_waitcnt vmcnt(17) lgkmcnt(8)
s_barrier
MAA 60,80,40
TR 104,25,32
v_add_f32 v164, v164, v172
MAA 60,84,60
TR 106,25,544
MAA 64,84,64
TR 108,25,12448
s_add_u32 m0, s56, 129664
MAA 64,80,44
buffer_load_dwordx4 v18, s[20:23], s54 offen lds
MAA 68,80,48
TR 110,25,12960
MAA 68,84,68
TR 112,25,1056
MAA 72,84,72
TR 114,25,1568
v_add_f32 v165, v165, v173
MAA 72,80,52
TR 116,25,13472
s_waitcnt lgkmcnt(7)
MAA 104,88,52
TR 118,25,13984
MAA 104,92,72
buffer_load_dwordx4 v19, s[20:23], s54 offen offset:1024 lds
MAA 100,92,68
TR 120,25,2080
MAA 100,88,48
buffer_load_dwordx4 v20, s[20:23], s54 offen offset:2048 lds
MAA 96,88,44
s_add_u32 s54, s54, 196608
MAA 96,92,64
TR 122,25,2592
v_add_f32 v166, v166, v174
MAA 92,92,60
TR 124,25,14496
s_add_u32 m0, s55, 0
MAA 92,88,40
buffer_load_dwordx4 v21, s[16:19], s52 offen sc1 lds
MAA 124,40,96
TR 126,25,15008
MAA 124,60,100
RD 0,23,18432
MAA 128,64,100
RD 4,23,19456
MAA 128,44,96
buffer_load_dwordx4 v21, s[16:19], s52 offen offset:1024 sc1 lds
MAA 132,48,96
RD 8,23,20736
v_add_f32 v167, v167, v175
MAA 132,68,100
RD 12,23,21760
MAA 136,72,100
RD 16,24,20480
MAA 136,52,96
buffer_load_dword v22, s[16:19], s52 offen offset:2048 sc1 lds
MAA 156,56,96
s_add_u32 s52, s52, 131072
MAA 156,76,100
s_waitcnt vmcnt(17) lgkmcnt(5)
s_barrier
MAA 76,104,40
RD 20,23,27648
s_add_u32 m0, s56, 67584
MAA 76,108,60
buffer_load_dwordx4 v18, s[20:23], s54 offen lds
MAA 80,108,64
RD 24,23,28672
MAA 80,104,44
RD 28,23,29952
MAA 84,104,48
RD 32,23,30976
MAA 84,108,68
buffer_load_dwordx4 v19, s[20:23], s54 offen offset:1024 lds
MAA 88,108,72
RD 36,24,29696
MAA 88,104,52
buffer_load_dwordx4 v20, s[20:23], s54 offen offset:2048 lds
MAA 120,112,52
TR 80,25,24832
s_add_u32 s54, s54, 196608
MAA 120,116,72
TR 82,25,25344
MAA 116,116,68
TR 84,25,37248
s_add_u32 m0, s55, 9216
MAA 116,112,48
buffer_load_dwordx4 v21, s[16:19], s52 offen sc1 lds
MAA 112,112,44
TR 86,25,37760
MAA 112,116,64
TR 88,25,25856
MAA 108,116,60
TR 90,25,26368
MAA 108,112,40
buffer_load_dwordx4 v21, s[16:19], s52 offen offset:1024 sc1 lds
MAA 140,40,120
TR 92,25,38272
MAA 140,60,124
TR 94,25,38784
MAA 144,64,124
TR 96,25,26880
MAA 144,44,120
buffer_load_dword v22, s[16:19], s52 offen offset:2048 sc1 lds
MAA 148,48,120
TR 98,25,27392
s_add_u32 s52, s52, 131072
MAA 148,68,124
buffer_load_dwordx4 v[172:175], v26, s[16:19], s75 offen offset:1024 sc1
MAA 152,72,124
TR 100,25,39296
s_add_u32 s75, s75, 2048
MAA 152,52,120
TR 102,25,39808
MAA 160,56,120
MAA 160,76,124
s_waitcnt vmcnt(21) lgkmcnt(8)
s_barrier
MAA 60,80,0
TR 104,25,24864
MAA 60,84,20
TR 106,25,25376
MAA 64,84,24
TR 108,25,37280
s_add_u32 m0, s56, 80000
MAA 64,80,4
buffer_load_dwordx4 v18, s[20:23], s54 offen lds
MAA 68,80,8
TR 110,25,37792
MAA 68,84,28
TR 112,25,25888
MAA 72,84,32
TR 114,25,26400
MAA 72,80,12
TR 116,25,38304
s_waitcnt lgkmcnt(7)
MAA 104,88,12
TR 118,25,38816
MAA 104,92,32
buffer_load_dwordx4 v19, s[20:23], s54 offen offset:1024 lds
MAA 100,92,28
TR 120,25,26912
MAA 100,88,8
buffer_load_dwordx4 v20, s[20:23], s54 offen offset:2048 lds
MAA 96,88,4
s_add_u32 s54, s54, 196608
MAA 96,92,24
TR 122,25,27424
MAA 92,92,20
TR 124,25,39328
s_add_u32 m0, s55, 18432
MAA 92,88,0
buffer_load_dwordx4 v21, s[16:19], s52 offen sc1 lds
MAA 124,0,96
TR 126,25,39840
MAA 124,20,100
RD 40,23,36864
MAA 128,24,100
RD 44,23,37888
MAA 128,4,96
buffer_load_dwordx4 v21, s[16:19], s52 offen offset:1024 sc1 lds
MAA 132,8,96
RD 48,23,39168
MAA 132,28,100
RD 52,23,40192
MAA 136,32,100
RD 56,24,38912
MAA 136,12,96
buffer_load_dword v22, s[16:19], s52 offen offset:2048 sc1 lds
MAA 156,16,96
s_add_u32 s52, s52, 131072
MAA 156,36,100
s_waitcnt vmcnt(16) lgkmcnt(5)
s_barrier
MAA 76,104,0
RD 60,23,46080
MAA 76,108,20
RD 64,23,47104
MAA 80,108,24
RD 68,23,48384
s_add_u32 m0, s56, 92416
MAA 80,104,4
buffer_load_dwordx4 v18, s[20:23], s54 offen lds
MAA 84,104,8
RD 72,23,49408
MAA 84,108,28
RD 76,24,48128
MAA 88,108,32
TR 80,25,49664
MAA 88,104,12
buffer_load_dwordx4 v19, s[20:23], s54 offen offset:1024 lds
MAA 120,112,12
TR 82,25,50176
MAA 120,116,32
TR 84,25,62080
MAA 116,116,28
TR 86,25,62592
MAA 116,112,8
buffer_load_dwordx4 v20, s[20:23], s54 offen offset:2048 lds
MAA 112,112,4
s_add_u32 s54, s54, 196608
MAA 112,116,24
TR 88,25,50688
MAA 108,116,20
TR 90,25,51200
s_add_u32 m0, s55, 27648
MAA 108,112,0
buffer_load_dwordx4 v21, s[16:19], s52 offen sc1 lds
MAA 140,0,120
TR 92,25,63104
MAA 140,20,124
TR 94,25,63616
MAA 144,24,124
TR 96,25,51712
MAA 144,4,120
buffer_load_dwordx4 v21, s[16:19], s52 offen offset:1024 sc1 lds
MAA 148,8,120
TR 98,25,52224
MAA 148,28,124
TR 100,25,64128
MAA 152,32,124
TR 102,25,64640
MAA 152,12,120
buffer_load_dword v22, s[16:19], s52 offen offset:2048 sc1 lds
MAA 160,16,120
s_add_u32 s52, s52, 131072
MAA 160,36,124
s_waitcnt vmcnt(19) lgkmcnt(8)
s_barrier
MAA 60,80,40
TR 104,25,49696
s_add_u32 m0, s56, 104832
MAA 60,84,60
buffer_load_dwordx4 v18, s[20:23], s54 offen lds
MAA 64,84,64
TR 106,25,50208
v_add_f32 v164, v164, v168
MAA 64,80,44
TR 108,25,62112
MAA 68,80,48
TR 110,25,62624
MAA 68,84,68
buffer_load_dwordx4 v19, s[20:23], s54 offen offset:1024 lds
MAA 72,84,72
TR 112,25,50720
v_add_f32 v165, v165, v169
MAA 72,80,52
TR 114,25,51232
s_waitcnt lgkmcnt(6)
MAA 104,88,52
TR 116,25,63136
MAA 104,92,72
buffer_load_dwordx4 v20, s[20:23], s54 offen offset:2048 lds
MAA 100,92,68
s_add_u32 s54, s54, 196608
s_add_u32 m0, s55, 36864
MAA 100,88,48
buffer_load_dwordx4 v21, s[16:19], s52 offen sc1 lds
MAA 96,88,44
TR 118,25,63648
MAA 96,92,64
TR 120,25,51744
v_add_f32 v166, v166, v170
MAA 92,92,60
TR 122,25,52256
MAA 92,88,40
buffer_load_dwordx4 v21, s[16:19], s52 offen offset:1024 sc1 lds
MAA 124,40,96
TR 124,25,64160
MAA 124,60,100
TR 126,25,64672
v_add_f32 v167, v167, v171
MAA 128,64,100
ds_read_b128 a[0:3], v23
MAA 128,44,96
buffer_load_dword v22, s[16:19], s52 offen offset:2048 sc1 lds
MAA 132,48,96
RD 4,23,1024
s_add_u32 s52, s52, 131072
MAA 132,68,100
buffer_load_dword v27, v14, s[20:23], s44 offen
MAA 136,72,100
RD 8,23,2304
s_add_u32 s44, s44, 1572864
MAA 136,52,96
RD 12,23,3328
MAA 156,56,96
RD 16,24,2048
MAA 156,76,100
s_waitcnt vmcnt(16) lgkmcnt(5)
s_barrier
MAA 76,104,40
RD 20,23,9216
s_add_u32 m0, s56, 117248
MAA 76,108,60
buffer_load_dwordx4 v18, s[20:23], s54 offen lds
MAA 80,108,64
RD 24,23,10240
MAA 80,104,44
RD 28,23,11520
MAA 84,104,48
RD 32,23,12544
MAA 84,108,68
buffer_load_dwordx4 v19, s[20:23], s54 offen offset:1024 lds
MAA 88,108,72
RD 36,24,11264
MAA 88,104,52
buffer_load_dwordx4 v20, s[20:23], s54 offen offset:2048 lds
MAA 120,112,52
ds_read_b64_tr_b16 a[80:81], v25
s_add_u32 s54, s54, 196608
MAA 120,116,72
TR 82,25,512
MAA 116,116,68
TR 84,25,12416
s_add_u32 m0, s55, 46080
MAA 116,112,48
buffer_load_dwordx4 v21, s[16:19], s52 offen sc1 lds
MAA 112,112,44
TR 86,25,12928
MAA 112,116,64
TR 88,25,1024
MAA 108,116,60
TR 90,25,1536
MAA 108,112,40
buffer_load_dwordx4 v21, s[16:19], s52 offen offset:1024 sc1 lds
MAA 140,40,120
TR 92,25,13440
MAA 140,60,124
TR 94,25,13952
MAA 144,64,124
TR 96,25,2048
MAA 144,44,120
buffer_load_dword v22, s[16:19], s52 offen offset:2048 sc1 lds
MAA 148,48,120
TR 98,25,2560
s_add_u32 s52, s52, 131072
MAA 148,68,124
buffer_load_dwordx4 v[168:171], v26, s[16:19], s75 offen sc1
MAA 152,72,124
TR 100,25,14464
MAA 152,52,120
TR 102,25,14976
MAA 160,56,120
MAA 160,76,124
s_waitcnt vmcnt(20) lgkmcnt(8)
.Lpad26:
s_cbranch_execz .Lnopoll53r
s_barrier
MAA 60,80,0
TR 104,25,32
v_add_f32 v164, v164, v172
MAA 60,84,20
TR 106,25,544
MAA 64,84,24
TR 108,25,12448
s_add_u32 m0, s56, 129664
MAA 64,80,4
buffer_load_dwordx4 v18, s[20:23], s54 offen lds
MAA 68,80,8
TR 110,25,12960
MAA 68,84,28
TR 112,25,1056
MAA 72,84,32
TR 114,25,1568
v_add_f32 v165, v165, v173
MAA 72,80,12
TR 116,25,13472
s_waitcnt lgkmcnt(7)
MAA 104,88,12
TR 118,25,13984
MAA 104,92,32
buffer_load_dwordx4 v19, s[20:23], s54 offen offset:1024 lds
MAA 100,92,28
TR 120,25,2080
MAA 100,88,8
buffer_load_dwordx4 v20, s[20:23], s54 offen offset:2048 lds
MAA 96,88,4
s_add_u32 s54, s54, 196608
MAA 96,92,24
TR 122,25,2592
v_add_f32 v166, v166, v174
MAA 92,92,20
TR 124,25,14496
s_add_u32 m0, s55, 0
MAA 92,88,0
buffer_load_dwordx4 v21, s[16:19], s52 offen sc1 lds
MAA 124,0,96
TR 126,25,15008
MAA 124,20,100
RD 40,23,18432
MAA 128,24,100
RD 44,23,19456
MAA 128,4,96
buffer_load_dwordx4 v21, s[16:19], s52 offen offset:1024 sc1 lds
MAA 132,8,96
RD 48,23,20736
v_add_f32 v167, v167, v175
MAA 132,28,100
RD 52,23,21760
MAA 136,32,100
RD 56,24,20480
MAA 136,12,96
buffer_load_dword v22, s[16:19], s52 offen offset:2048 sc1 lds
MAA 156,16,96
s_add_u32 s52, s52, 131072
MAA 156,36,100
s_waitcnt vmcnt(17) lgkmcnt(5)
s_barrier
MAA 76,104,0
RD 60,23,27648
s_add_u32 m0, s56, 67584
MAA 76,108,20
buffer_load_dwordx4 v18, s[20:23], s54 offen lds
MAA 80,108,24
RD 64,23,28672
MAA 80,104,4
RD 68,23,29952
MAA 84,104,8
RD 72,23,30976
MAA 84,108,28
buffer_load_dwordx4 v19, s[20:23], s54 offen offset:1024 lds
MAA 88,108,32
RD 76,24,29696
MAA 88,104,12
buffer_load_dwordx4 v20, s[20:23], s54 offen offset:2048 lds
MAA 120,112,12
TR 80,25,24832
s_add_u32 s54, s54, 196608
MAA 120,116,32
TR 82,25,25344
MAA 116,116,28
TR 84,25,37248
s_add_u32 m0, s55, 9216
MAA 116,112,8
buffer_load_dwordx4 v21, s[16:19], s52 offen sc1 lds
MAA 112,112,4
TR 86,25,37760
MAA 112,116,24
TR 88,25,25856
MAA 108,116,20
TR 90,25,26368
MAA 108,112,0
buffer_load_dwordx4 v21, s[16:19], s52 offen offset:1024 sc1 lds
MAA 140,0,120
TR 92,25,38272
MAA 140,20,124
TR 94,25,38784
MAA 144,24,124
TR 96,25,26880
MAA 144,4,120
buffer_load_dword v22, s[16:19], s52 offen offset:2048 sc1 lds
MAA 148,8,120
TR 98,25,27392
s_add_u32 s52, s52, 131072
MAA 148,28,124
buffer_load_dwordx4 v[172:175], v26, s[16:19], s75 offen offset:1024 sc1
MAA 152,32,124
TR 100,25,39296
s_add_u32 s75, s75, 2048
MAA 152,12,120
TR 102,25,39808
MAA 160,16,120
MAA 160,36,124
s_waitcnt vmcnt(21) lgkmcnt(8)
s_barrier
MAA 60,80,40
TR 104,25,24864
MAA 60,84,60
TR 106,25,25376
MAA 64,84,64
TR 108,25,37280
s_add_u32 m0, s56, 80000
MAA 64,80,44
buffer_load_dwordx4 v18, s[20:23], s54 offen lds
MAA 68,80,48
TR 110,25,37792
MAA 68,84,68
TR 112,25,25888
MAA 72,84,72
TR 114,25,26400
MAA 72,80,52
TR 116,25,38304
s_waitcnt lgkmcnt(7)
MAA 104,88,52
TR 118,25,38816
MAA 104,92,72
buffer_load_dwordx4 v19, s[20:23], s54 offen offset:1024 lds
MAA 100,92,68
TR 120,25,26912
MAA 100,88,48
buffer_load_dwordx4 v20, s[20:23], s54 offen offset:2048 lds
MAA 96,88,44
s_add_u32 s54, s54, 196608
MAA 96,92,64
TR 122,25,27424
MAA 92,92,60
TR 124,25,39328
s_add_u32 m0, s55, 18432
MAA 92,88,40
buffer_load_dwordx4 v21, s[16:19], s52 offen sc1 lds
MAA 124,40,96
TR 126,25,39840
MAA 124,60,100
RD 0,23,36864
MAA 128,64,100
RD 4,23,37888
MAA 128,44,96
buffer_load_dwordx4 v21, s[16:19], s52 offen offset:1024 sc1 lds
MAA 132,48,96
RD 8,23,39168
MAA 132,68,100
RD 12,23,40192
MAA 136,72,100
RD 16,24,38912
MAA 136,52,96
buffer_load_dword v22, s[16:19], s52 offen offset:2048 sc1 lds
MAA 156,56,96
s_add_u32 s52, s52, 131072
MAA 156,76,100
s_waitcnt vmcnt(16) lgkmcnt(5)
s_barrier
MAA 76,104,40
RD 20,23,46080
MAA 76,108,60
RD 24,23,47104
MAA 80,108,64
RD 28,23,48384
s_add_u32 m0, s56, 92416
MAA 80,104,44
buffer_load_dwordx4 v18, s[20:23], s54 offen lds
MAA 84,104,48
RD 32,23,49408
MAA 84,108,68
RD 36,24,48128
MAA 88,108,72
TR 80,25,49664
MAA 88,104,52
buffer_load_dwordx4 v19, s[20:23], s54 offen offset:1024 lds
MAA 120,112,52
TR 82,25,50176
MAA 120,116,72
TR 84,25,62080
MAA 116,116,68
TR 86,25,62592
MAA 116,112,48
buffer_load_dwordx4 v20, s[20:23], s54 offen offset:2048 lds
MAA 112,112,44
s_add_u32 s54, s54, 196608
MAA 112,116,64
TR 88,25,50688
MAA 108,116,60
TR 90,25,51200
s_add_u32 m0, s55, 27648
MAA 108,112,40
buffer_load_dwordx4 v21, s[16:19], s52 offen sc1 lds
MAA 140,40,120
TR 92,25,63104
MAA 140,60,124
TR 94,25,63616
MAA 144,64,124
TR 96,25,51712
MAA 144,44,120
buffer_load_dwordx4 v21, s[16:19], s52 offen offset:1024 sc1 lds
MAA 148,48,120
TR 98,25,52224
MAA 148,68,124
TR 100,25,64128
MAA 152,72,124
TR 102,25,64640
MAA 152,52,120
buffer_load_dword v22, s[16:19], s52 offen offset:2048 sc1 lds
MAA 160,56,120
s_add_u32 s52, s52, 131072
s_add_u32 s15, s15, 1
MAA 160,76,124
s_cbranch_scc0 .Lk58
s_waitcnt vmcnt(19) lgkmcnt(8)
s_barrier
MAA 60,80,0
TR 104,25,49696
v_add_f32 v164, v164, v168
MAA 60,84,20
TR 106,25,50208
s_add_u32 m0, s56, 104832
MAA 64,84,24
buffer_load_dwordx4 v18, s[20:23], s54 offen lds
MAA 64,80,4
TR 108,25,62112
v_add_f32 v165, v165, v169
MAA 68,80,8
TR 110,25,62624
v_add_f32 v166, v166, v170
MAA 68,84,28
TR 112,25,50720
v_add_f32 v167, v167, v171
MAA 72,84,32
buffer_load_dwordx4 v19, s[20:23], s54 offen offset:1024 lds
MAA 72,80,12
TR 114,25,51232
s_waitcnt lgkmcnt(6)
MAA 104,88,12
TR 116,25,63136
MAA 104,92,32
TR 118,25,63648
MAA 100,92,28
buffer_load_dwordx4 v20, s[20:23], s54 offen offset:2048 lds
MAA 100,88,8
TR 120,25,51744
s_add_u32 s54, s54, 196608
MAA 96,88,4
TR 122,25,52256
s_add_u32 m0, s55, 36864
MAA 96,92,24
TR 124,25,64160
MAA 92,92,20
buffer_load_dwordx4 v21, s[16:19], s52 offen sc1 lds
MAA 92,88,0
TR 126,25,64672
MAA 124,0,96
ds_read_b128 a[40:43], v23
MAA 124,20,100
RD 44,23,1024
MAA 128,24,100
buffer_load_dwordx4 v21, s[16:19], s52 offen offset:1024 sc1 lds
MAA 128,4,96
RD 48,23,2304
MAA 132,8,96
RD 52,23,3328
MAA 132,28,100
RD 56,24,2048
MAA 136,32,100
buffer_load_dword v22, s[16:19], s52 offen offset:2048 sc1 lds
MAA 136,12,96
s_add_u32 s52, s52, 131072
MAA 156,16,96
MAA 156,36,100
s_waitcnt vmcnt(15) lgkmcnt(5)
s_barrier
MAA 76,104,0
RD 60,23,9216
v_add_f32 v164, v164, v172
MAA 76,108,20
RD 64,23,10240
s_add_u32 m0, s56, 117248
MAA 80,108,24
buffer_load_dwordx4 v18, s[20:23], s54 offen lds
MAA 80,104,4
RD 68,23,11520
v_add_f32 v165, v165, v173
MAA 84,104,8
RD 72,23,12544
v_add_f32 v166, v166, v174
MAA 84,108,28
RD 76,24,11264
v_add_f32 v167, v167, v175
MAA 88,108,32
buffer_load_dwordx4 v19, s[20:23], s54 offen offset:1024 lds
MAA 88,104,12
ds_read_b64_tr_b16 a[80:81], v25
MAA 120,112,12
TR 82,25,512
MAA 120,116,32
TR 84,25,12416
MAA 116,116,28
buffer_load_dwordx4 v20, s[20:23], s54 offen offset:2048 lds
MAA 116,112,8
TR 86,25,12928
s_add_u32 s54, s54, 196608
MAA 112,112,4
TR 88,25,1024
s_add_u32 m0, s55, 46080
MAA 112,116,24
TR 90,25,1536
MAA 108,116,20
buffer_load_dwordx4 v21, s[16:19], s52 offen sc1 lds
MAA 108,112,0
TR 92,25,13440
MAA 140,0,120
TR 94,25,13952
MAA 140,20,124
TR 96,25,2048
MAA 144,24,124
buffer_load_dwordx4 v21, s[16:19], s52 offen offset:1024 sc1 lds
MAA 144,4,120
TR 98,25,2560
MAA 148,8,120
TR 100,25,14464
MAA 148,28,124
TR 102,25,14976
MAA 152,32,124
buffer_load_dword v22, s[16:19], s52 offen offset:2048 sc1 lds
MAA 152,12,120
s_add_u32 s52, s52, 131072
v_permlane32_swap_b32 v164, v166
MAA 160,16,120
v_permlane32_swap_b32 v165, v167
MAA 160,36,124
s_waitcnt vmcnt(18) lgkmcnt(8)
s_barrier
MAA 60,80,40
TR 104,25,32
v_add_f32 v164, v164, v166
MAA 60,84,60
TR 106,25,544
s_add_u32 m0, s56, 129664
MAA 64,84,64
buffer_load_dwordx4 v18, s[20:23], s54 offen lds
MAA 64,80,44
TR 108,25,12448
v_add_f32 v165, v165, v167
MAA 68,80,48
TR 110,25,12960
v_mul_f32 v164, 0xba800000, v164
MAA 68,84,68
buffer_load_dwordx4 v19, s[20:23], s54 offen offset:1024 lds
MAA 72,84,72
TR 112,25,1056
v_mul_f32 v165, 0x3a800000, v165
MAA 72,80,52
TR 114,25,1568
v_fma_f32 v165, -v164, v164, v165
s_waitcnt lgkmcnt(6)
MAA 104,88,52
buffer_load_dwordx4 v20, s[20:23], s54 offen offset:2048 lds
MAA 104,92,72
TR 116,25,13472
s_add_u32 s54, s54, 196608
MAA 100,92,68
TR 118,25,13984
s_add_u32 m0, s59, 58240
MAA 100,88,48
TR 120,25,2080
s_xor_b32 s58, s87, 1966080
MAA 96,88,44
buffer_load_dwordx4 v5, s[24:27], s58 offen lds
MAA 96,92,64
TR 122,25,2592
v_max_f32 v165, 0, v165
MAA 92,92,60
TR 124,25,14496
v_add_f32 v165, 0x3727c5ac, v165
MAA 92,88,40
buffer_load_dwordx4 v6, s[24:27], s58 offen offset:1024 lds
MAA 124,40,96
TR 126,25,15008
s_add_u32 m0, s59, 0
MAA 124,60,100
RD 0,23,18432
s_xor_b32 s58, s87, 1048576
MAA 128,64,100
buffer_load_dwordx4 v5, s[24:27], s58 offen lds
MAA 128,44,96
RD 4,23,19456
MAA 132,48,96
RD 8,23,20736
MAA 132,68,100
buffer_load_dwordx4 v6, s[24:27], s58 offen offset:1024 lds
MAA 136,72,100
RD 12,23,21760
MAA 136,52,96
RD 16,24,20480
MAA 156,56,96
v_rsq_f32 v166, v165
MAA 156,76,100
v_mov_b32 v165, v166
v_mul_f32 v166, 0x3e8293ee, v166
ds_write_b128 v7, v[164:167]
s_waitcnt vmcnt(16) lgkmcnt(6)
s_barrier
MAA 76,104,40
ds_write_b32 v17, v164
MAA 76,108,60
ds_write_b32 v17, v165 offset:1024
s_add_u32 m0, s59, 8320
MAA 80,108,64
RD 20,23,27648
s_xor_b32 s58, s87, 1179648
MAA 80,104,44
buffer_load_dwordx4 v5, s[24:27], s58 offen lds
MAA 84,104,48
RD 24,23,28672
MAA 84,108,68
RD 28,23,29952
MAA 88,108,72
RD 32,23,30976
MAA 88,104,52
buffer_load_dwordx4 v6, s[24:27], s58 offen offset:1024 lds
MAA 120,112,52
RD 36,24,29696
s_add_u32 m0, s59, 66560
MAA 120,116,72
TR 80,25,24832
s_xor_b32 s58, s87, 0
MAA 116,116,68
TR 82,25,25344
MAA 116,112,48
buffer_load_dwordx4 v5, s[24:27], s58 offen lds
MAA 112,112,44
TR 84,25,37248
MAA 112,116,64
TR 86,25,37760
MAA 108,116,60
TR 88,25,25856
MAA 108,112,40
buffer_load_dwordx4 v6, s[24:27], s58 offen offset:1024 lds
MAA 140,40,120
TR 90,25,26368
s_add_u32 m0, s59, 74880
MAA 140,60,124
TR 92,25,38272
s_xor_b32 s58, s87, 131072
MAA 144,64,124
TR 94,25,38784
MAA 144,44,120
buffer_load_dwordx4 v5, s[24:27], s58 offen lds
MAA 148,48,120
TR 96,25,26880
MAA 148,68,124
TR 98,25,27392
MAA 152,72,124
TR 100,25,39296
MAA 152,52,120
buffer_load_dwordx4 v6, s[24:27], s58 offen offset:1024 lds
MAA 160,56,120
TR 102,25,39808
MAA 160,76,124
s_waitcnt vmcnt(10) lgkmcnt(0)
s_barrier
MAA 104,88,12
TR 112,25,25888
s_add_u32 m0, s59, 83200
MAA 104,92,32
TR 114,25,26400
s_xor_b32 s58, s87, 262144
MAA 100,92,28
buffer_load_dwordx4 v5, s[24:27], s58 offen lds
MAA 100,88,8
TR 116,25,38304
MAA 96,88,4
TR 118,25,38816
MAA 96,92,24
TR 120,25,26912
MAA 92,92,20
buffer_load_dwordx4 v6, s[24:27], s58 offen offset:1024 lds
MAA 92,88,0
TR 122,25,27424
s_add_u32 m0, s59, 16640
MAA 156,16,96
TR 124,25,39328
s_xor_b32 s58, s87, 1310720
MAA 156,36,100
TR 126,25,39840
MAA 72,84,32
buffer_load_dwordx4 v5, s[24:27], s58 offen lds
MAA 72,80,12
TR 104,25,24864
MAA 68,80,8
TR 106,25,25376
MAA 68,84,28
TR 108,25,37280
MAA 64,84,24
buffer_load_dwordx4 v6, s[24:27], s58 offen offset:1024 lds
MAA 64,80,4
TR 110,25,37792
s_add_u32 m0, s59, 24960
MAA 60,80,0
RD 40,23,36864
s_xor_b32 s58, s87, 1441792
MAA 60,84,20
RD 44,23,37888
s_waitcnt lgkmcnt(12)
MAA 120,112,12
buffer_load_dwordx4 v5, s[24:27], s58 offen lds
s_waitcnt lgkmcnt(10)
MAA 120,116,32
RD 48,23,39168
MAA 116,116,28
RD 52,23,40192
MAA 116,112,8
RD 56,24,38912
MAA 112,112,4
buffer_load_dwordx4 v6, s[24:27], s58 offen offset:1024 lds
.Lpad27:
s_cbranch_execz .Lnopoll53r
MAA 112,116,24
s_waitcnt lgkmcnt(5)
s_barrier
RD 60,23,46080
MAA 108,116,20
RD 64,23,47104
s_add_u32 m0, s59, 91520
MAA 108,112,0
RD 68,23,48384
s_xor_b32 s58, s87, 393216
MAA 160,16,120
RD 72,23,49408
MAA 160,36,124
RD 76,24,48128
MAA 88,108,32
TR 144,25,50688
MAA 88,104,12
TR 146,25,51200
MAA 84,104,8
TR 148,25,63104
MAA 84,108,28
TR 150,25,63616
MAA 80,108,24
TR 152,25,50720
MAA 80,104,4
TR 154,25,51232
MAA 76,104,0
TR 156,25,63136
MAA 76,108,20
TR 158,25,63648
TR 160,25,51712
TR 162,25,52224
TR 164,25,64128
s_waitcnt lgkmcnt(9)
MAA 104,144,52
TR 166,25,64640
TR 168,25,51744
TR 170,25,52256
s_waitcnt lgkmcnt(10)
MAA 104,148,72
TR 172,25,64160
MAA 100,148,68
TR 174,25,64672
MAA 100,144,48
TR 136,25,49696
MAA 96,144,44
TR 138,25,50208
MAA 96,148,64
TR 140,25,62112
MAA 92,148,60
TR 142,25,62624
MAA 92,144,40
TR 128,25,49664
s_waitcnt lgkmcnt(15)
MAA 120,152,52
TR 130,25,50176
s_waitcnt lgkmcnt(14)
MAA 120,156,72
TR 132,25,62080
MAA 116,156,68
TR 134,25,62592
MAA 116,152,48
ds_read_b128 v[232:235], v10 offset:1792
MAA 112,152,44
ds_read_b128 v[228:231], v10 offset:1536
MAA 112,156,64
ds_read_b128 v[224:227], v10 offset:1280
MAA 108,156,60
ds_read_b128 v[220:223], v10 offset:1024
MAA 108,152,40
buffer_load_dwordx4 v5, s[24:27], s58 offen lds
s_waitcnt lgkmcnt(15)
MAA 156,56,160
ds_read_b128 v[240:243], v11 offset:704
MAA 156,76,164
ds_read_b128 v[244:247], v11 offset:1728
s_waitcnt lgkmcnt(14)
MAA 160,76,172
ds_read_b128 v[18:21], v11 offset:448
MAA 160,56,168
buffer_load_dwordx4 v6, s[24:27], s58 offen offset:1024 lds
s_waitcnt lgkmcnt(13)
MAA 88,136,52
ds_read_b128 v[22:25], v11 offset:1472
s_add_u32 m0, s59, 99840
s_waitcnt lgkmcnt(12)
MAA 88,140,72
s_xor_b32 s58, s87, 524288
MAA 84,140,68
MAA 84,136,48
buffer_load_dwordx4 v5, s[24:27], s58 offen lds
MAA 80,136,44
MAA 80,140,64
MAA 76,140,60
MAA 76,136,40
buffer_load_dwordx4 v6, s[24:27], s58 offen offset:1024 lds
s_waitcnt lgkmcnt(10)
MAA 72,128,52
s_add_u32 m0, s59, 108160
s_xor_b32 s58, s87, 655360
s_waitcnt lgkmcnt(8)
MAA 72,132,72
MAA 68,132,68
MAA 68,128,48
buffer_load_dwordx4 v5, s[24:27], s58 offen lds
MAA 64,128,44
MAA 64,132,64
MAA 60,132,60
MAA 60,128,40
buffer_load_dwordx4 v6, s[24:27], s58 offen offset:1024 lds
s_waitcnt lgkmcnt(3)
v_pk_fma_f32 v[156:157], v[240:241], v[44:45], v[156:157] op_sel_hi:[1,0,1]
s_waitcnt lgkmcnt(2)
v_pk_mul_f32 v[156:157], v[156:157], v[244:245]
v_cvt_pk_bf16_f32 v236, v156, v157
v_pk_fma_f32 v[158:159], v[242:243], v[44:45], v[158:159] op_sel_hi:[1,0,1]
v_pk_mul_f32 v[158:159], v[158:159], v[246:247]
v_cvt_pk_bf16_f32 v237, v158, v159
v_pk_fma_f32 v[160:161], v[240:241], v[44:45], v[160:161] op_sel:[0,1,0] op_sel_hi:[1,1,1]
v_pk_mul_f32 v[160:161], v[160:161], v[244:245]
v_cvt_pk_bf16_f32 v238, v160, v161
v_pk_fma_f32 v[162:163], v[242:243], v[44:45], v[162:163] op_sel:[0,1,0] op_sel_hi:[1,1,1]
v_pk_mul_f32 v[162:163], v[162:163], v[246:247]
v_cvt_pk_bf16_f32 v239, v162, v163
ds_write_b128 v8, v[236:239] offset:1024
v_pk_fma_f32 v[104:105], v[36:37], v[232:233], v[104:105] op_sel_hi:[1,0,1]
v_pk_mul_f32 v[104:105], v[104:105], v[232:233] op_sel:[0,1] op_sel_hi:[1,1]
v_cvt_pk_bf16_f32 v196, v104, v105
v_pk_fma_f32 v[106:107], v[38:39], v[232:233], v[106:107] op_sel_hi:[1,0,1]
v_pk_mul_f32 v[106:107], v[106:107], v[232:233] op_sel:[0,1] op_sel_hi:[1,1]
v_cvt_pk_bf16_f32 v197, v106, v107
v_pk_fma_f32 v[120:121], v[40:41], v[232:233], v[120:121] op_sel_hi:[1,0,1]
v_pk_mul_f32 v[120:121], v[120:121], v[232:233] op_sel:[0,1] op_sel_hi:[1,1]
v_cvt_pk_bf16_f32 v198, v120, v121
v_pk_fma_f32 v[122:123], v[42:43], v[232:233], v[122:123] op_sel_hi:[1,0,1]
v_pk_mul_f32 v[122:123], v[122:123], v[232:233] op_sel:[0,1] op_sel_hi:[1,1]
v_cvt_pk_bf16_f32 v199, v122, v123
v_pk_fma_f32 v[100:101], v[36:37], v[228:229], v[100:101] op_sel_hi:[1,0,1]
v_pk_mul_f32 v[100:101], v[100:101], v[228:229] op_sel:[0,1] op_sel_hi:[1,1]
v_cvt_pk_bf16_f32 v192, v100, v101
v_pk_fma_f32 v[102:103], v[38:39], v[228:229], v[102:103] op_sel_hi:[1,0,1]
v_pk_mul_f32 v[102:103], v[102:103], v[228:229] op_sel:[0,1] op_sel_hi:[1,1]
v_cvt_pk_bf16_f32 v193, v102, v103
v_pk_fma_f32 v[116:117], v[40:41], v[228:229], v[116:117] op_sel_hi:[1,0,1]
v_pk_mul_f32 v[116:117], v[116:117], v[228:229] op_sel:[0,1] op_sel_hi:[1,1]
v_cvt_pk_bf16_f32 v194, v116, v117
v_pk_fma_f32 v[118:119], v[42:43], v[228:229], v[118:119] op_sel_hi:[1,0,1]
v_pk_mul_f32 v[118:119], v[118:119], v[228:229] op_sel:[0,1] op_sel_hi:[1,1]
v_cvt_pk_bf16_f32 v195, v118, v119
v_pk_fma_f32 v[96:97], v[36:37], v[224:225], v[96:97] op_sel_hi:[1,0,1]
v_pk_mul_f32 v[96:97], v[96:97], v[224:225] op_sel:[0,1] op_sel_hi:[1,1]
v_cvt_pk_bf16_f32 v188, v96, v97
v_pk_fma_f32 v[98:99], v[38:39], v[224:225], v[98:99] op_sel_hi:[1,0,1]
v_pk_mul_f32 v[98:99], v[98:99], v[224:225] op_sel:[0,1] op_sel_hi:[1,1]
v_cvt_pk_bf16_f32 v189, v98, v99
v_pk_fma_f32 v[112:113], v[40:41], v[224:225], v[112:113] op_sel_hi:[1,0,1]
v_pk_mul_f32 v[112:113], v[112:113], v[224:225] op_sel:[0,1] op_sel_hi:[1,1]
v_cvt_pk_bf16_f32 v190, v112, v113
v_pk_fma_f32 v[114:115], v[42:43], v[224:225], v[114:115] op_sel_hi:[1,0,1]
v_pk_mul_f32 v[114:115], v[114:115], v[224:225] op_sel:[0,1] op_sel_hi:[1,1]
v_cvt_pk_bf16_f32 v191, v114, v115
v_pk_fma_f32 v[92:93], v[36:37], v[220:221], v[92:93] op_sel_hi:[1,0,1]
v_pk_mul_f32 v[92:93], v[92:93], v[220:221] op_sel:[0,1] op_sel_hi:[1,1]
v_cvt_pk_bf16_f32 v184, v92, v93
v_pk_fma_f32 v[94:95], v[38:39], v[220:221], v[94:95] op_sel_hi:[1,0,1]
v_pk_mul_f32 v[94:95], v[94:95], v[220:221] op_sel:[0,1] op_sel_hi:[1,1]
v_cvt_pk_bf16_f32 v185, v94, v95
v_pk_fma_f32 v[108:109], v[40:41], v[220:221], v[108:109] op_sel_hi:[1,0,1]
v_pk_mul_f32 v[108:109], v[108:109], v[220:221] op_sel:[0,1] op_sel_hi:[1,1]
v_cvt_pk_bf16_f32 v186, v108, v109
v_pk_fma_f32 v[110:111], v[42:43], v[220:221], v[110:111] op_sel_hi:[1,0,1]
v_pk_mul_f32 v[110:111], v[110:111], v[220:221] op_sel:[0,1] op_sel_hi:[1,1]
v_cvt_pk_bf16_f32 v187, v110, v111
v_pk_fma_f32 v[72:73], v[28:29], v[232:233], v[72:73] op_sel_hi:[1,0,1]
v_cvt_pk_bf16_f32 v176, v72, v73
v_pk_fma_f32 v[74:75], v[30:31], v[232:233], v[74:75] op_sel_hi:[1,0,1]
v_cvt_pk_bf16_f32 v177, v74, v75
v_pk_fma_f32 v[88:89], v[32:33], v[232:233], v[88:89] op_sel_hi:[1,0,1]
v_cvt_pk_bf16_f32 v178, v88, v89
v_pk_fma_f32 v[90:91], v[34:35], v[232:233], v[90:91] op_sel_hi:[1,0,1]
v_cvt_pk_bf16_f32 v179, v90, v91
v_pk_fma_f32 v[68:69], v[28:29], v[228:229], v[68:69] op_sel_hi:[1,0,1]
v_cvt_pk_bf16_f32 v172, v68, v69
v_pk_fma_f32 v[70:71], v[30:31], v[228:229], v[70:71] op_sel_hi:[1,0,1]
v_cvt_pk_bf16_f32 v173, v70, v71
v_pk_fma_f32 v[84:85], v[32:33], v[228:229], v[84:85] op_sel_hi:[1,0,1]
v_cvt_pk_bf16_f32 v174, v84, v85
v_pk_fma_f32 v[86:87], v[34:35], v[228:229], v[86:87] op_sel_hi:[1,0,1]
v_cvt_pk_bf16_f32 v175, v86, v87
v_pk_fma_f32 v[64:65], v[28:29], v[224:225], v[64:65] op_sel_hi:[1,0,1]
v_cvt_pk_bf16_f32 v168, v64, v65
v_pk_fma_f32 v[66:67], v[30:31], v[224:225], v[66:67] op_sel_hi:[1,0,1]
v_cvt_pk_bf16_f32 v169, v66, v67
v_pk_fma_f32 v[80:81], v[32:33], v[224:225], v[80:81] op_sel_hi:[1,0,1]
v_cvt_pk_bf16_f32 v170, v80, v81
v_pk_fma_f32 v[82:83], v[34:35], v[224:225], v[82:83] op_sel_hi:[1,0,1]
v_cvt_pk_bf16_f32 v171, v82, v83
v_pk_fma_f32 v[60:61], v[28:29], v[220:221], v[60:61] op_sel_hi:[1,0,1]
v_cvt_pk_bf16_f32 v164, v60, v61
v_pk_fma_f32 v[62:63], v[30:31], v[220:221], v[62:63] op_sel_hi:[1,0,1]
v_cvt_pk_bf16_f32 v165, v62, v63
v_pk_fma_f32 v[76:77], v[32:33], v[220:221], v[76:77] op_sel_hi:[1,0,1]
v_cvt_pk_bf16_f32 v166, v76, v77
v_pk_fma_f32 v[78:79], v[34:35], v[220:221], v[78:79] op_sel_hi:[1,0,1]
s_waitcnt lgkmcnt(0)
s_barrier
v_cvt_pk_bf16_f32 v167, v78, v79
v_mfma_f32_16x16x32_bf16 v[120:123], v[196:199], v[176:179], v[50:53]
ds_read_b128 v[180:183], v9
v_mfma_f32_16x16x32_bf16 v[104:107], v[192:195], v[176:179], v[46:49]
ds_read_b64 v[200:201], v9 offset:1024
v_mfma_f32_16x16x32_bf16 v[116:119], v[192:195], v[172:175], v[50:53]
ds_read_b64 v[210:211], v9 offset:1032
v_mfma_f32_16x16x32_bf16 v[100:103], v[188:191], v[172:175], v[46:49]
ds_read_b128 v[240:243], v11 offset:384
v_mfma_f32_16x16x32_bf16 v[112:115], v[188:191], v[168:171], v[50:53]
ds_read_b128 v[244:247], v11 offset:1408
v_mfma_f32_16x16x32_bf16 v[96:99], v[184:187], v[168:171], v[46:49]
ds_read_b128 v[28:31], v11 offset:320
v_max3_f32 v88, v104, v105, v106
v_mfma_f32_16x16x32_bf16 v[108:111], v[184:187], v[164:167], v[50:53]
ds_read_b128 v[32:35], v11 offset:1344
v_max3_f32 v89, v107, v120, v121
v_max3_f32 v88, v88, v122, v123
v_max_f32 v90, v88, v89
v_max_f32 v89, v88, v89
v_max3_f32 v84, v100, v101, v102
v_max3_f32 v85, v103, v116, v117
s_waitcnt lgkmcnt(6)
v_mfma_f32_16x16x32_bf16 v[92:95], v[180:183], v[164:167], v[46:49]
ds_read_b128 v[36:39], v11 offset:256
v_permlane16_swap_b32 v90, v89
MAA 136,12,96
ds_read_b128 v[40:43], v11 offset:1280
v_max_f32 v88, v90, v89
MAA 136,32,100
v_max_f32 v89, v90, v89
v_max3_f32 v84, v84, v118, v119
MAA 136,52,160
v_permlane32_swap_b32 v88, v89
MAA 136,72,164
v_max_f32 v88, v88, v89
v_mul_f32 v88, v88, v234
MAA 152,72,172
v_max_f32 v86, v84, v85
v_max_f32 v85, v84, v85
MAA 152,52,168
s_nop 0
v_permlane16_swap_b32 v86, v85
MAA 152,32,124
v_max_f32 v84, v86, v85
v_max_f32 v85, v86, v85
MAA 152,12,120
s_nop 0
v_permlane32_swap_b32 v84, v85
v_max3_f32 v80, v96, v97, v98
v_max_f32 v84, v84, v85
v_mul_f32 v84, v84, v230
v_max3_f32 v81, v99, v112, v113
v_max3_f32 v80, v80, v114, v115
v_max_f32 v82, v80, v81
v_max_f32 v81, v80, v81
v_max3_f32 v76, v92, v93, v94
v_max3_f32 v77, v95, v108, v109
v_permlane16_swap_b32 v82, v81
v_max3_f32 v76, v76, v110, v111
v_max_f32 v80, v82, v81
v_max_f32 v81, v82, v81
v_max_f32 v78, v76, v77
v_max_f32 v77, v76, v77
v_permlane32_swap_b32 v80, v81
v_pk_fma_f32 v[104:105], v[104:105], v[234:235], v[88:89] op_sel_hi:[1,0,0] neg_lo:[0,0,1] neg_hi:[0,0,1]
v_max_f32 v80, v80, v81
v_mul_f32 v80, v80, v226
v_permlane16_swap_b32 v78, v77
v_pk_fma_f32 v[106:107], v[106:107], v[234:235], v[88:89] op_sel_hi:[1,0,0] neg_lo:[0,0,1] neg_hi:[0,0,1]
v_max_f32 v76, v78, v77
v_max_f32 v77, v78, v77
v_pk_fma_f32 v[120:121], v[120:121], v[234:235], v[88:89] op_sel_hi:[1,0,0] neg_lo:[0,0,1] neg_hi:[0,0,1]
v_pk_fma_f32 v[122:123], v[122:123], v[234:235], v[88:89] op_sel_hi:[1,0,0] neg_lo:[0,0,1] neg_hi:[0,0,1]
v_permlane32_swap_b32 v76, v77
v_pk_fma_f32 v[100:101], v[100:101], v[230:231], v[84:85] op_sel_hi:[1,0,0] neg_lo:[0,0,1] neg_hi:[0,0,1]
v_max_f32 v76, v76, v77
v_mul_f32 v76, v76, v222
v_pk_fma_f32 v[102:103], v[102:103], v[230:231], v[84:85] op_sel_hi:[1,0,0] neg_lo:[0,0,1] neg_hi:[0,0,1]
v_pk_fma_f32 v[116:117], v[116:117], v[230:231], v[84:85] op_sel_hi:[1,0,0] neg_lo:[0,0,1] neg_hi:[0,0,1]
v_pk_fma_f32 v[118:119], v[118:119], v[230:231], v[84:85] op_sel_hi:[1,0,0] neg_lo:[0,0,1] neg_hi:[0,0,1]
v_pk_fma_f32 v[96:97], v[96:97], v[226:227], v[80:81] op_sel_hi:[1,0,0] neg_lo:[0,0,1] neg_hi:[0,0,1]
v_pk_fma_f32 v[98:99], v[98:99], v[226:227], v[80:81] op_sel_hi:[1,0,0] neg_lo:[0,0,1] neg_hi:[0,0,1]
v_pk_fma_f32 v[112:113], v[112:113], v[226:227], v[80:81] op_sel_hi:[1,0,0] neg_lo:[0,0,1] neg_hi:[0,0,1]
v_pk_fma_f32 v[114:115], v[114:115], v[226:227], v[80:81] op_sel_hi:[1,0,0] neg_lo:[0,0,1] neg_hi:[0,0,1]
v_pk_fma_f32 v[92:93], v[92:93], v[222:223], v[76:77] op_sel_hi:[1,0,0] neg_lo:[0,0,1] neg_hi:[0,0,1]
v_pk_fma_f32 v[94:95], v[94:95], v[222:223], v[76:77] op_sel_hi:[1,0,0] neg_lo:[0,0,1] neg_hi:[0,0,1]
v_pk_fma_f32 v[108:109], v[108:109], v[222:223], v[76:77] op_sel_hi:[1,0,0] neg_lo:[0,0,1] neg_hi:[0,0,1]
v_pk_fma_f32 v[110:111], v[110:111], v[222:223], v[76:77] op_sel_hi:[1,0,0] neg_lo:[0,0,1] neg_hi:[0,0,1]
v_pk_fma_f32 v[136:137], v[18:19], v[44:45], v[136:137] op_sel_hi:[1,0,1]
v_pk_mul_f32 v[136:137], v[136:137], v[22:23]
v_pk_fma_f32 v[138:139], v[20:21], v[44:45], v[138:139] op_sel_hi:[1,0,1]
v_pk_mul_f32 v[138:139], v[138:139], v[24:25]
v_pk_fma_f32 v[152:153], v[18:19], v[44:45], v[152:153] op_sel:[0,1,0] op_sel_hi:[1,1,1]
v_pk_mul_f32 v[152:153], v[152:153], v[22:23]
v_pk_fma_f32 v[154:155], v[20:21], v[44:45], v[154:155] op_sel:[0,1,0] op_sel_hi:[1,1,1]
v_pk_mul_f32 v[154:155], v[154:155], v[24:25]
v_exp_f32 v104, v104
s_nop 0
MAA 132,8,96
v_exp_f32 v105, v105
MAA 132,28,100
v_exp_f32 v106, v106
MAA 132,48,160
v_exp_f32 v107, v107
MAA 132,68,164
v_exp_f32 v120, v120
MAA 148,68,172
v_exp_f32 v121, v121
MAA 148,48,168
v_exp_f32 v122, v122
MAA 148,28,124
v_exp_f32 v123, v123
MAA 148,8,120
v_exp_f32 v100, v100
MAA 128,4,96
v_exp_f32 v101, v101
MAA 128,24,100
v_exp_f32 v102, v102
MAA 128,44,160
v_exp_f32 v103, v103
MAA 128,64,164
v_exp_f32 v116, v116
MAA 144,64,172
v_exp_f32 v117, v117
MAA 144,44,168
v_exp_f32 v118, v118
MAA 144,24,124
v_exp_f32 v119, v119
MAA 144,4,120
v_exp_f32 v96, v96
MAA 124,0,96
v_exp_f32 v97, v97
MAA 124,20,100
v_exp_f32 v98, v98
MAA 124,40,160
v_exp_f32 v99, v99
MAA 124,60,164
v_exp_f32 v112, v112
MAA 140,60,172
v_exp_f32 v113, v113
MAA 140,40,168
v_exp_f32 v114, v114
MAA 140,20,124
v_exp_f32 v115, v115
MAA 140,0,120
v_cvt_pk_bf16_f32 v72, v104, v105
v_cvt_pk_bf16_f32 v73, v106, v107
v_cvt_pk_bf16_f32 v74, v120, v121
v_cvt_pk_bf16_f32 v75, v122, v123
v_cvt_pk_bf16_f32 v68, v100, v101
v_cvt_pk_bf16_f32 v69, v102, v103
v_cvt_pk_bf16_f32 v70, v116, v117
v_cvt_pk_bf16_f32 v71, v118, v119
v_cvt_pk_bf16_f32 v64, v96, v97
v_cvt_pk_bf16_f32 v65, v98, v99
v_cvt_pk_bf16_f32 v66, v112, v113
v_cvt_pk_bf16_f32 v67, v114, v115
v_cvt_pk_bf16_f32 v208, v136, v137
v_cvt_pk_bf16_f32 v209, v138, v139
v_cvt_pk_bf16_f32 v218, v152, v153
v_cvt_pk_bf16_f32 v219, v154, v155
s_waitcnt lgkmcnt(5)
v_pk_fma_f32 v[132:133], v[240:241], v[44:45], v[132:133] op_sel_hi:[1,0,1]
s_waitcnt lgkmcnt(4)
v_pk_mul_f32 v[132:133], v[132:133], v[244:245]
v_cvt_pk_bf16_f32 v206, v132, v133
v_pk_fma_f32 v[134:135], v[242:243], v[44:45], v[134:135] op_sel_hi:[1,0,1]
v_pk_mul_f32 v[134:135], v[134:135], v[246:247]
v_cvt_pk_bf16_f32 v207, v134, v135
v_pk_fma_f32 v[148:149], v[240:241], v[44:45], v[148:149] op_sel:[0,1,0] op_sel_hi:[1,1,1]
v_pk_mul_f32 v[148:149], v[148:149], v[244:245]
v_cvt_pk_bf16_f32 v216, v148, v149
v_pk_fma_f32 v[150:151], v[242:243], v[44:45], v[150:151] op_sel:[0,1,0] op_sel_hi:[1,1,1]
v_pk_mul_f32 v[150:151], v[150:151], v[246:247]
v_cvt_pk_bf16_f32 v217, v150, v151
s_waitcnt lgkmcnt(3)
v_pk_fma_f32 v[128:129], v[28:29], v[44:45], v[128:129] op_sel_hi:[1,0,1]
s_waitcnt lgkmcnt(2)
v_pk_mul_f32 v[128:129], v[128:129], v[32:33]
v_cvt_pk_bf16_f32 v204, v128, v129
v_pk_fma_f32 v[130:131], v[30:31], v[44:45], v[130:131] op_sel_hi:[1,0,1]
v_pk_mul_f32 v[130:131], v[130:131], v[34:35]
v_cvt_pk_bf16_f32 v205, v130, v131
v_pk_fma_f32 v[144:145], v[28:29], v[44:45], v[144:145] op_sel:[0,1,0] op_sel_hi:[1,1,1]
v_pk_mul_f32 v[144:145], v[144:145], v[32:33]
v_cvt_pk_bf16_f32 v214, v144, v145
v_pk_fma_f32 v[146:147], v[30:31], v[44:45], v[146:147] op_sel:[0,1,0] op_sel_hi:[1,1,1]
v_pk_mul_f32 v[146:147], v[146:147], v[34:35]
v_cvt_pk_bf16_f32 v215, v146, v147
s_waitcnt lgkmcnt(1)
v_pk_fma_f32 v[124:125], v[36:37], v[44:45], v[124:125] op_sel_hi:[1,0,1]
s_waitcnt lgkmcnt(0)
v_pk_mul_f32 v[124:125], v[124:125], v[40:41]
v_cvt_pk_bf16_f32 v202, v124, v125
v_pk_fma_f32 v[126:127], v[38:39], v[44:45], v[126:127] op_sel_hi:[1,0,1]
v_pk_mul_f32 v[126:127], v[126:127], v[42:43]
v_cvt_pk_bf16_f32 v203, v126, v127
v_pk_fma_f32 v[140:141], v[36:37], v[44:45], v[140:141] op_sel:[0,1,0] op_sel_hi:[1,1,1]
v_pk_mul_f32 v[140:141], v[140:141], v[40:41]
v_cvt_pk_bf16_f32 v212, v140, v141
v_pk_fma_f32 v[142:143], v[38:39], v[44:45], v[142:143] op_sel:[0,1,0] op_sel_hi:[1,1,1]
v_pk_mul_f32 v[142:143], v[142:143], v[42:43]
v_cvt_pk_bf16_f32 v213, v142, v143
s_nop 0
v_mfma_f32_16x16x32_bf16 v[88:91], v[248:251], v[72:75], 0
v_exp_f32 v92, v92
v_mfma_f32_16x16x32_bf16 v[104:107], v[206:209], v[72:75], 0
v_exp_f32 v93, v93
v_mfma_f32_16x16x32_bf16 v[120:123], v[216:219], v[72:75], 0
v_exp_f32 v94, v94
v_mfma_f32_16x16x32_bf16 v[84:87], v[248:251], v[68:71], 0
v_exp_f32 v95, v95
v_mfma_f32_16x16x32_bf16 v[100:103], v[204:207], v[68:71], 0
v_exp_f32 v108, v108
v_mfma_f32_16x16x32_bf16 v[116:119], v[214:217], v[68:71], 0
v_exp_f32 v109, v109
v_mfma_f32_16x16x32_bf16 v[80:83], v[248:251], v[64:67], 0
v_exp_f32 v110, v110
v_mfma_f32_16x16x32_bf16 v[96:99], v[202:205], v[64:67], 0
v_exp_f32 v111, v111
v_mfma_f32_16x16x32_bf16 v[112:115], v[212:215], v[64:67], 0
v_cvt_pk_bf16_f32 v60, v92, v93
v_cvt_pk_bf16_f32 v61, v94, v95
v_cvt_pk_bf16_f32 v62, v108, v109
v_cvt_pk_bf16_f32 v63, v110, v111
v_rcp_f32 v88, v88
v_rcp_f32 v84, v84
v_mfma_f32_16x16x32_bf16 v[76:79], v[248:251], v[60:63], 0
v_rcp_f32 v80, v80
v_mfma_f32_16x16x32_bf16 v[92:95], v[200:203], v[60:63], 0
v_mfma_f32_16x16x32_bf16 v[108:111], v[210:213], v[60:63], 0
s_nop 4
v_rcp_f32 v76, v76
v_pk_mul_f32 v[104:105], v[104:105], v[88:89] op_sel_hi:[1,0]
v_pk_mul_f32 v[106:107], v[106:107], v[88:89] op_sel_hi:[1,0]
v_pk_mul_f32 v[120:121], v[120:121], v[88:89] op_sel_hi:[1,0]
v_pk_mul_f32 v[122:123], v[122:123], v[88:89] op_sel_hi:[1,0]
v_cvt_pk_bf16_f32 v176, v104, v105
v_cvt_pk_bf16_f32 v177, v106, v107
v_cvt_pk_bf16_f32 v178, v120, v121
v_cvt_pk_bf16_f32 v179, v122, v123
buffer_store_dwordx4 v[176:179], v4, s[16:19], s74 offen offset:3072 sc1
v_pk_mul_f32 v[100:101], v[100:101], v[84:85] op_sel_hi:[1,0]
v_pk_mul_f32 v[102:103], v[102:103], v[84:85] op_sel_hi:[1,0]
v_pk_mul_f32 v[116:117], v[116:117], v[84:85] op_sel_hi:[1,0]
v_pk_mul_f32 v[118:119], v[118:119], v[84:85] op_sel_hi:[1,0]
v_cvt_pk_bf16_f32 v172, v100, v101
v_cvt_pk_bf16_f32 v173, v102, v103
v_cvt_pk_bf16_f32 v174, v116, v117
v_cvt_pk_bf16_f32 v175, v118, v119
buffer_store_dwordx4 v[172:175], v4, s[16:19], s74 offen offset:2048 sc1
v_pk_mul_f32 v[96:97], v[96:97], v[80:81] op_sel_hi:[1,0]
v_pk_mul_f32 v[98:99], v[98:99], v[80:81] op_sel_hi:[1,0]
v_pk_mul_f32 v[112:113], v[112:113], v[80:81] op_sel_hi:[1,0]
v_pk_mul_f32 v[114:115], v[114:115], v[80:81] op_sel_hi:[1,0]
v_cvt_pk_bf16_f32 v168, v96, v97
v_cvt_pk_bf16_f32 v169, v98, v99
v_cvt_pk_bf16_f32 v170, v112, v113
v_cvt_pk_bf16_f32 v171, v114, v115
buffer_store_dwordx4 v[168:171], v4, s[16:19], s74 offen offset:1024 sc1
v_pk_mul_f32 v[92:93], v[92:93], v[76:77] op_sel_hi:[1,0]
v_pk_mul_f32 v[94:95], v[94:95], v[76:77] op_sel_hi:[1,0]
v_pk_mul_f32 v[108:109], v[108:109], v[76:77] op_sel_hi:[1,0]
v_pk_mul_f32 v[110:111], v[110:111], v[76:77] op_sel_hi:[1,0]
v_cvt_pk_bf16_f32 v164, v92, v93
v_cvt_pk_bf16_f32 v165, v94, v95
v_cvt_pk_bf16_f32 v166, v108, v109
v_cvt_pk_bf16_f32 v167, v110, v111
buffer_store_dwordx4 v[164:167], v4, s[16:19], s74 offen sc1
s_nop 1
.Lqkve56:
s_lshl_b32 s62, s3, 11
s_add_u32 s62, s62, s84
v_lshl_add_u32 v4, v1, 4, s62
v_lshrrev_b32 v2, 3, v1
v_cmp_eq_u32 vcc, 3, v2
v_add_u32 v2, 67108480, v4
s_nop 0
v_cndmask_b32 v4, v4, v2, vcc
v_bfe_u32 v8, v1, 3, 2
v_mul_u32_u24 v8, 2080, v8
v_bfe_u32 v2, v1, 2, 1
v_lshl_add_u32 v8, v2, 7, v8
v_bfe_u32 v2, v1, 5, 1
v_lshl_add_u32 v8, v2, 8, v8
v_and_b32 v2, 3, v1
v_lshl_add_u32 v8, v2, 3, v8
s_mov_b32 s57, 66560
v_add_u32 v7, s57, v8
s_lshr_b32 s54, s87, 17
s_lshl_b32 s54, s54, 18
s_add_u32 s54, s54, 37748736
s_mov_b32 s52, s54
s_add_u32 s53, s54, 131072
v_accvgpr_read_b32 v32, a224
v_accvgpr_read_b32 v33, a225
v_accvgpr_read_b32 v34, a226
v_accvgpr_read_b32 v35, a227
v_accvgpr_read_b32 v36, a228
v_accvgpr_read_b32 v37, a229
v_accvgpr_read_b32 v38, a230
v_accvgpr_read_b32 v39, a231
v_accvgpr_read_b32 v40, a232
v_accvgpr_read_b32 v41, a233
v_accvgpr_read_b32 v42, a234
v_accvgpr_read_b32 v43, a235
v_accvgpr_read_b32 v44, a236
v_accvgpr_read_b32 v45, a237
v_accvgpr_read_b32 v46, a238
v_accvgpr_read_b32 v47, a239
v_accvgpr_read_b32 v48, a240
v_accvgpr_read_b32 v49, a241
v_accvgpr_read_b32 v50, a242
v_accvgpr_read_b32 v51, a243
v_accvgpr_read_b32 v52, a244
v_accvgpr_read_b32 v53, a245
v_accvgpr_read_b32 v54, a246
v_accvgpr_read_b32 v55, a247
v_accvgpr_read_b32 v56, a248
v_accvgpr_read_b32 v57, a249
v_accvgpr_read_b32 v58, a250
v_accvgpr_read_b32 v59, a251
v_accvgpr_read_b32 v60, a252
v_accvgpr_read_b32 v61, a253
v_accvgpr_read_b32 v62, a254
v_accvgpr_read_b32 v63, a255
s_lshl_b32 s62, s8, 10
s_add_u32 s62, s62, 30490624
s_lshl_b32 s64, s6, 10
s_add_u32 s64, s64, 30490624
s_lshr_b32 s67, s5, 2
s_and_b32 s67, s67, 3
s_lshl_b32 s67, s67, 7
s_add_u32 s64, s64, s67
v_lshl_add_u32 v252, v1, 7, s62
v_mov_b32 v253, s64
v_mov_b32 v255, 1
s_waitcnt vmcnt(0) lgkmcnt(0)
s_cmp_lg_u32 s3, 1
s_barrier
s_cbranch_scc1 .Lfirst61
s_mov_b64 exec, 15
buffer_atomic_add v255, v252, s[16:19], 0 offen
s_mov_b64 exec, 1
v_mov_b32 v254, 0
buffer_atomic_add v254, v253, s[16:19], 0 offen sc0
s_mov_b64 exec, -1
.Lfirst61:
s_add_u32 m0, s59, 116480
s_xor_b32 s58, s87, 786432
buffer_load_dwordx4 v5, s[24:27], s58 offen lds
buffer_load_dwordx4 v6, s[24:27], s58 offen offset:1024 lds
s_add_u32 m0, s59, 124800
s_xor_b32 s58, s87, 917504
buffer_load_dwordx4 v5, s[24:27], s58 offen lds
buffer_load_dwordx4 v6, s[24:27], s58 offen offset:1024 lds
s_add_u32 m0, s59, 33280
s_xor_b32 s58, s87, 1572864
buffer_load_dwordx4 v5, s[24:27], s58 offen lds
buffer_load_dwordx4 v6, s[24:27], s58 offen offset:1024 lds
s_add_u32 m0, s59, 41600
s_xor_b32 s58, s87, 1703936
buffer_load_dwordx4 v5, s[24:27], s58 offen lds
buffer_load_dwordx4 v6, s[24:27], s58 offen offset:1024 lds
s_add_u32 m0, s59, 49920
s_xor_b32 s58, s87, 1835008
buffer_load_dwordx4 v5, s[24:27], s58 offen lds
buffer_load_dwordx4 v6, s[24:27], s58 offen offset:1024 lds
s_cmp_lg_u32 s3, 1
.Lpad28:
s_cbranch_execz .Lnopoll53r
s_cbranch_scc1 .Lnopoll60
s_mov_b64 exec, 1
s_mov_b32 s15, 0
v_mov_b32 v255, 0
buffer_atomic_add v255, v253, s[16:19], 0 offen sc0
s_waitcnt vmcnt(11)
v_cmp_gt_u32 vcc, 16, v254
s_nop 0
s_cbranch_vccz .Lnopoll60r
.Lpoll59:
s_waitcnt vmcnt(0)
v_cmp_gt_u32 vcc, 16, v255
s_add_u32 s15, s15, 1
s_cbranch_vccz .Lnopoll60r
v_mov_b32 v255, 0
buffer_atomic_add v255, v253, s[16:19], 0 offen sc0
s_cmp_le_u32 s15, 100000
s_cbranch_scc1 .Lpoll59
s_branch .Lnopoll60r
.Lnopoll60:
s_mov_b64 exec, 0
s_cmp_eq_u32 s3, 2
s_cbranch_scc1 .Lpad29
s_cmp_eq_u32 s3, 3
s_cbranch_scc1 .Lpad30
s_branch .Lpad31
.Lnopoll60r:
s_mov_b64 exec, -1
s_waitcnt vmcnt(11)
s_barrier
buffer_load_dwordx4 v[64:67], v4, s[16:19], s52 offen sc1
buffer_load_dwordx4 v[68:71], v4, s[16:19], s52 offen offset:1024 sc1
s_xor_b32 s52, s54, 262144
buffer_load_dwordx4 v[72:75], v4, s[16:19], s53 offen sc1
buffer_load_dwordx4 v[76:79], v4, s[16:19], s53 offen offset:1024 sc1
s_xor_b32 s53, s54, 393216
buffer_load_dwordx4 v[80:83], v4, s[16:19], s52 offen sc1
buffer_load_dwordx4 v[84:87], v4, s[16:19], s52 offen offset:1024 sc1
s_xor_b32 s52, s54, 524288
buffer_load_dwordx4 v[88:91], v4, s[16:19], s53 offen sc1
buffer_load_dwordx4 v[92:95], v4, s[16:19], s53 offen offset:1024 sc1
s_xor_b32 s53, s54, 655360
buffer_load_dwordx4 v[96:99], v4, s[16:19], s52 offen sc1
buffer_load_dwordx4 v[100:103], v4, s[16:19], s52 offen offset:1024 sc1
s_xor_b32 s52, s54, 786432
buffer_load_dwordx4 v[104:107], v4, s[16:19], s53 offen sc1
buffer_load_dwordx4 v[108:111], v4, s[16:19], s53 offen offset:1024 sc1
s_xor_b32 s53, s54, 917504
ds_read_b64_tr_b16 a[0:1], v7
TR 2,7,512
TR 16,7,1024
TR 18,7,1536
TR 4,7,32
TR 6,7,544
TR 20,7,1056
TR 22,7,1568
TR 8,7,64
TR 10,7,576
TR 24,7,1088
TR 26,7,1600
TR 12,7,96
TR 14,7,608
TR 28,7,1120
TR 30,7,1632
s_lshl_b32 s62, s49, 3
s_add_u32 s62, s62, s48
s_mul_i32 s62, s62, 28672
s_add_u32 s62, s62, s51
v_lshrrev_b32 v12, 4, v1
v_mul_u32_u24 v12, 57344, v12
v_and_b32 v2, 15, v1
v_lshl_add_u32 v12, v2, 4, v12
v_add_u32 v12, s62, v12
v_add_u32 v13, 6112, v12
v_add_u32 v14, 12224, v12
v_add_u32 v15, 18336, v12
s_mul_i32 s59, s3, 4224
s_mov_b32 s58, 0
s_waitcnt vmcnt(8) lgkmcnt(14)
MAV 32,0,64
TR 32,7,8320
s_waitcnt lgkmcnt(13)
MAV 32,16,72
buffer_load_dwordx4 v[112:115], v4, s[16:19], s52 offen sc1
MAV 48,16,76
TR 34,7,8832
MAV 48,0,68
TR 48,7,9344
TR 50,7,9856
s_waitcnt lgkmcnt(14)
MAV 52,4,68
TR 36,7,8352
s_waitcnt lgkmcnt(13)
MAV 52,20,76
buffer_load_dwordx4 v[116:119], v4, s[16:19], s52 offen offset:1024 sc1
MAV 36,20,72
TR 38,7,8864
s_xor_b32 s52, s54, 1048576
MAV 36,4,64
TR 52,7,9376
TR 54,7,9888
s_waitcnt lgkmcnt(14)
MAV 40,8,64
TR 40,7,8384
s_waitcnt lgkmcnt(13)
MAV 40,24,72
buffer_load_dwordx4 v[120:123], v4, s[16:19], s53 offen sc1
MAV 56,24,76
TR 42,7,8896
MAV 56,8,68
TR 56,7,9408
TR 58,7,9920
s_waitcnt lgkmcnt(14)
MAV 60,12,68
TR 44,7,8416
s_waitcnt lgkmcnt(13)
MAV 60,28,76
buffer_load_dwordx4 v[124:127], v4, s[16:19], s53 offen offset:1024 sc1
MAV 44,28,72
TR 46,7,8928
s_xor_b32 s53, s54, 1179648
MAV 44,12,64
TR 60,7,9440
TR 62,7,9952
s_waitcnt vmcnt(8) lgkmcnt(8)
MAV 32,32,80
TR 0,7,16640
MAV 32,48,88
buffer_load_dwordx4 v[64:67], v4, s[16:19], s52 offen sc1
MAV 48,48,92
TR 2,7,17152
MAV 48,32,84
TR 16,7,17664
TR 18,7,18176
MAV 52,36,84
TR 4,7,16672
MAV 52,52,92
buffer_load_dwordx4 v[68:71], v4, s[16:19], s52 offen offset:1024 sc1
MAV 36,52,88
TR 6,7,17184
s_xor_b32 s52, s54, 1310720
MAV 36,36,80
TR 20,7,17696
TR 22,7,18208
s_waitcnt lgkmcnt(8)
MAV 40,40,80
TR 8,7,16704
MAV 40,56,88
buffer_load_dwordx4 v[72:75], v4, s[16:19], s53 offen sc1
MAV 56,56,92
TR 10,7,17216
MAV 56,40,84
TR 24,7,17728
TR 26,7,18240
MAV 60,44,84
TR 12,7,16736
MAV 60,60,92
buffer_load_dwordx4 v[76:79], v4, s[16:19], s53 offen offset:1024 sc1
MAV 44,60,88
TR 14,7,17248
s_xor_b32 s53, s54, 1441792
MAV 44,44,80
TR 28,7,17760
TR 30,7,18272
s_waitcnt vmcnt(8) lgkmcnt(8)
MAV 32,0,96
TR 32,7,24960
MAV 32,16,104
buffer_load_dwordx4 v[80:83], v4, s[16:19], s52 offen sc1
MAV 48,16,108
TR 34,7,25472
MAV 48,0,100
TR 48,7,25984
TR 50,7,26496
MAV 52,4,100
TR 36,7,24992
MAV 52,20,108
buffer_load_dwordx4 v[84:87], v4, s[16:19], s52 offen offset:1024 sc1
MAV 36,20,104
TR 38,7,25504
s_xor_b32 s52, s54, 1572864
MAV 36,4,96
TR 52,7,26016
TR 54,7,26528
s_waitcnt lgkmcnt(8)
MAV 40,8,96
TR 40,7,25024
MAV 40,24,104
buffer_load_dwordx4 v[88:91], v4, s[16:19], s53 offen sc1
MAV 56,24,108
TR 42,7,25536
MAV 56,8,100
TR 56,7,26048
TR 58,7,26560
MAV 60,12,100
TR 44,7,25056
MAV 60,28,108
buffer_load_dwordx4 v[92:95], v4, s[16:19], s53 offen offset:1024 sc1
MAV 44,28,104
TR 46,7,25568
s_xor_b32 s53, s54, 1703936
MAV 44,12,96
TR 60,7,26080
TR 62,7,26592
s_barrier
s_waitcnt vmcnt(8) lgkmcnt(8)
MAV 32,32,112
TR 0,7,33280
MAV 32,48,120
buffer_load_dwordx4 v[96:99], v4, s[16:19], s52 offen sc1
MAV 48,48,124
TR 2,7,33792
MAV 48,32,116
TR 16,7,34304
TR 18,7,34816
MAV 52,36,116
TR 4,7,33312
MAV 52,52,124
buffer_load_dwordx4 v[100:103], v4, s[16:19], s52 offen offset:1024 sc1
MAV 36,52,120
TR 6,7,33824
s_xor_b32 s52, s54, 1835008
MAV 36,36,112
TR 20,7,34336
TR 22,7,34848
s_waitcnt lgkmcnt(8)
MAV 40,40,112
TR 8,7,33344
MAV 40,56,120
buffer_load_dwordx4 v[104:107], v4, s[16:19], s53 offen sc1
MAV 56,56,124
TR 10,7,33856
MAV 56,40,116
TR 24,7,34368
TR 26,7,34880
MAV 60,44,116
TR 12,7,33376
MAV 60,60,124
buffer_load_dwordx4 v[108:111], v4, s[16:19], s53 offen offset:1024 sc1
MAV 44,60,120
TR 14,7,33888
s_xor_b32 s53, s54, 1966080
MAV 44,44,112
TR 28,7,34400
TR 30,7,34912
s_waitcnt vmcnt(8) lgkmcnt(8)
MAV 32,0,64
TR 32,7,41600
MAV 32,16,72
buffer_load_dwordx4 v[112:115], v4, s[16:19], s52 offen sc1
MAV 48,16,76
TR 34,7,42112
MAV 48,0,68
TR 48,7,42624
TR 50,7,43136
MAV 52,4,68
TR 36,7,41632
MAV 52,20,76
buffer_load_dwordx4 v[116:119], v4, s[16:19], s52 offen offset:1024 sc1
MAV 36,20,72
TR 38,7,42144
s_xor_b32 s52, s54, 2097152
MAV 36,4,64
TR 52,7,42656
TR 54,7,43168
s_waitcnt lgkmcnt(8)
MAV 40,8,64
TR 40,7,41664
MAV 40,24,72
buffer_load_dwordx4 v[120:123], v4, s[16:19], s53 offen sc1
MAV 56,24,76
TR 42,7,42176
MAV 56,8,68
TR 56,7,42688
TR 58,7,43200
MAV 60,12,68
TR 44,7,41696
MAV 60,28,76
buffer_load_dwordx4 v[124:127], v4, s[16:19], s53 offen offset:1024 sc1
MAV 44,28,72
TR 46,7,42208
s_xor_b32 s53, s54, 2228224
MAV 44,12,64
TR 60,7,42720
TR 62,7,43232
s_waitcnt vmcnt(8) lgkmcnt(8)
MAV 32,32,80
TR 0,7,49920
MAV 32,48,88
buffer_load_dwordx4 v[64:67], v4, s[16:19], s52 offen sc1
MAV 48,48,92
TR 2,7,50432
MAV 48,32,84
TR 16,7,50944
TR 18,7,51456
MAV 52,36,84
TR 4,7,49952
MAV 52,52,92
buffer_load_dwordx4 v[68:71], v4, s[16:19], s52 offen offset:1024 sc1
MAV 36,52,88
TR 6,7,50464
s_xor_b32 s52, s54, 2359296
MAV 36,36,80
TR 20,7,50976
TR 22,7,51488
s_waitcnt lgkmcnt(8)
MAV 40,40,80
TR 8,7,49984
MAV 40,56,88
buffer_load_dwordx4 v[72:75], v4, s[16:19], s53 offen sc1
MAV 56,56,92
TR 10,7,50496
MAV 56,40,84
TR 24,7,51008
TR 26,7,51520
MAV 60,44,84
TR 12,7,50016
MAV 60,60,92
buffer_load_dwordx4 v[76:79], v4, s[16:19], s53 offen offset:1024 sc1
MAV 44,60,88
TR 14,7,50528
s_xor_b32 s53, s54, 2490368
MAV 44,44,80
TR 28,7,51040
TR 30,7,51552
s_waitcnt vmcnt(8) lgkmcnt(8)
MAV 32,0,96
TR 32,7,58240
MAV 32,16,104
buffer_load_dwordx4 v[80:83], v4, s[16:19], s52 offen sc1
MAV 48,16,108
TR 34,7,58752
MAV 48,0,100
TR 48,7,59264
TR 50,7,59776
MAV 52,4,100
TR 36,7,58272
MAV 52,20,108
buffer_load_dwordx4 v[84:87], v4, s[16:19], s52 offen offset:1024 sc1
MAV 36,20,104
TR 38,7,58784
s_xor_b32 s52, s54, 2621440
MAV 36,4,96
TR 52,7,59296
TR 54,7,59808
s_waitcnt lgkmcnt(8)
MAV 40,8,96
TR 40,7,58304
MAV 40,24,104
buffer_load_dwordx4 v[88:91], v4, s[16:19], s53 offen sc1
MAV 56,24,108
TR 42,7,58816
MAV 56,8,100
TR 56,7,59328
TR 58,7,59840
MAV 60,12,100
TR 44,7,58336
MAV 60,28,108
buffer_load_dwordx4 v[92:95], v4, s[16:19], s53 offen offset:1024 sc1
MAV 44,28,104
TR 46,7,58848
s_xor_b32 s53, s54, 2752512
MAV 44,12,96
TR 60,7,59360
TR 62,7,59872
s_xor_b32 s57, s57, 66560
v_add_u32 v7, s57, v8
s_waitcnt vmcnt(8) lgkmcnt(8)
MAV 32,32,112
ds_read_b64_tr_b16 a[0:1], v7
MAV 32,48,120
buffer_load_dwordx4 v[96:99], v4, s[16:19], s52 offen sc1
MAV 48,48,124
TR 2,7,512
MAV 48,32,116
TR 16,7,1024
TR 18,7,1536
MAV 52,36,116
TR 4,7,32
MAV 52,52,124
buffer_load_dwordx4 v[100:103], v4, s[16:19], s52 offen offset:1024 sc1
MAV 36,52,120
TR 6,7,544
s_xor_b32 s52, s54, 2883584
MAV 36,36,112
TR 20,7,1056
TR 22,7,1568
s_waitcnt lgkmcnt(8)
MAV 40,40,112
TR 8,7,64
MAV 40,56,120
buffer_load_dwordx4 v[104:107], v4, s[16:19], s53 offen sc1
MAV 56,56,124
TR 10,7,576
MAV 56,40,116
TR 24,7,1088
TR 26,7,1600
MAV 60,44,116
TR 12,7,96
MAV 60,60,124
buffer_load_dwordx4 v[108:111], v4, s[16:19], s53 offen offset:1024 sc1
MAV 44,60,120
TR 14,7,608
s_xor_b32 s53, s54, 3014656
MAV 44,44,112
TR 28,7,1120
TR 30,7,1632
s_waitcnt vmcnt(8) lgkmcnt(8)
MAV 32,0,64
TR 32,7,8320
MAV 32,16,72
buffer_load_dwordx4 v[112:115], v4, s[16:19], s52 offen sc1
MAV 48,16,76
TR 34,7,8832
MAV 48,0,68
TR 48,7,9344
TR 50,7,9856
MAV 52,4,68
TR 36,7,8352
MAV 52,20,76
buffer_load_dwordx4 v[116:119], v4, s[16:19], s52 offen offset:1024 sc1
MAV 36,20,72
TR 38,7,8864
s_xor_b32 s52, s54, 3145728
MAV 36,4,64
TR 52,7,9376
TR 54,7,9888
s_waitcnt lgkmcnt(8)
MAV 40,8,64
TR 40,7,8384
MAV 40,24,72
buffer_load_dwordx4 v[120:123], v4, s[16:19], s53 offen sc1
MAV 56,24,76
TR 42,7,8896
MAV 56,8,68
TR 56,7,9408
TR 58,7,9920
MAV 60,12,68
TR 44,7,8416
MAV 60,28,76
buffer_load_dwordx4 v[124:127], v4, s[16:19], s53 offen offset:1024 sc1
MAV 44,28,72
TR 46,7,8928
s_xor_b32 s53, s54, 3276800
MAV 44,12,64
TR 60,7,9440
TR 62,7,9952
s_waitcnt vmcnt(8) lgkmcnt(8)
MAV 32,32,80
TR 0,7,16640
MAV 32,48,88
buffer_load_dwordx4 v[64:67], v4, s[16:19], s52 offen sc1
MAV 48,48,92
TR 2,7,17152
MAV 48,32,84
TR 16,7,17664
TR 18,7,18176
MAV 52,36,84
TR 4,7,16672
MAV 52,52,92
buffer_load_dwordx4 v[68:71], v4, s[16:19], s52 offen offset:1024 sc1
MAV 36,52,88
TR 6,7,17184
s_xor_b32 s52, s54, 3407872
MAV 36,36,80
TR 20,7,17696
TR 22,7,18208
s_waitcnt lgkmcnt(8)
MAV 40,40,80
TR 8,7,16704
MAV 40,56,88
buffer_load_dwordx4 v[72:75], v4, s[16:19], s53 offen sc1
MAV 56,56,92
TR 10,7,17216
MAV 56,40,84
TR 24,7,17728
TR 26,7,18240
MAV 60,44,84
TR 12,7,16736
MAV 60,60,92
buffer_load_dwordx4 v[76:79], v4, s[16:19], s53 offen offset:1024 sc1
MAV 44,60,88
TR 14,7,17248
s_xor_b32 s53, s54, 3538944
MAV 44,44,80
TR 28,7,17760
TR 30,7,18272
s_waitcnt vmcnt(8) lgkmcnt(8)
MAV 32,0,96
TR 32,7,24960
MAV 32,16,104
buffer_load_dwordx4 v[80:83], v4, s[16:19], s52 offen sc1
MAV 48,16,108
TR 34,7,25472
MAV 48,0,100
TR 48,7,25984
TR 50,7,26496
MAV 52,4,100
TR 36,7,24992
MAV 52,20,108
buffer_load_dwordx4 v[84:87], v4, s[16:19], s52 offen offset:1024 sc1
MAV 36,20,104
TR 38,7,25504
s_xor_b32 s52, s54, 3670016
MAV 36,4,96
TR 52,7,26016
TR 54,7,26528
s_waitcnt lgkmcnt(8)
MAV 40,8,96
TR 40,7,25024
MAV 40,24,104
buffer_load_dwordx4 v[88:91], v4, s[16:19], s53 offen sc1
MAV 56,24,108
TR 42,7,25536
MAV 56,8,100
TR 56,7,26048
TR 58,7,26560
MAV 60,12,100
TR 44,7,25056
MAV 60,28,108
buffer_load_dwordx4 v[92:95], v4, s[16:19], s53 offen offset:1024 sc1
MAV 44,28,104
TR 46,7,25568
s_xor_b32 s53, s54, 3801088
MAV 44,12,96
TR 60,7,26080
TR 62,7,26592
s_waitcnt vmcnt(8) lgkmcnt(8)
MAV 32,32,112
TR 0,7,33280
MAV 32,48,120
buffer_load_dwordx4 v[96:99], v4, s[16:19], s52 offen sc1
MAV 48,48,124
TR 2,7,33792
MAV 48,32,116
TR 16,7,34304
TR 18,7,34816
MAV 52,36,116
TR 4,7,33312
MAV 52,52,124
buffer_load_dwordx4 v[100:103], v4, s[16:19], s52 offen offset:1024 sc1
MAV 36,52,120
TR 6,7,33824
s_xor_b32 s52, s54, 3932160
MAV 36,36,112
TR 20,7,34336
.Lpad29:
s_cbranch_execz .Lpad32
TR 22,7,34848
s_waitcnt lgkmcnt(8)
MAV 40,40,112
TR 8,7,33344
MAV 40,56,120
buffer_load_dwordx4 v[104:107], v4, s[16:19], s53 offen sc1
MAV 56,56,124
TR 10,7,33856
MAV 56,40,116
TR 24,7,34368
TR 26,7,34880
MAV 60,44,116
TR 12,7,33376
MAV 60,60,124
buffer_load_dwordx4 v[108:111], v4, s[16:19], s53 offen offset:1024 sc1
MAV 44,60,120
TR 14,7,33888
s_xor_b32 s53, s54, 4063232
MAV 44,44,112
TR 28,7,34400
TR 30,7,34912
s_waitcnt vmcnt(8) lgkmcnt(8)
MAV 32,0,64
TR 32,7,41600
MAV 32,16,72
buffer_load_dwordx4 v[112:115], v4, s[16:19], s52 offen sc1
MAV 48,16,76
TR 34,7,42112
MAV 48,0,68
TR 48,7,42624
TR 50,7,43136
MAV 52,4,68
TR 36,7,41632
MAV 52,20,76
buffer_load_dwordx4 v[116:119], v4, s[16:19], s52 offen offset:1024 sc1
MAV 36,20,72
TR 38,7,42144
MAV 36,4,64
TR 52,7,42656
TR 54,7,43168
s_waitcnt lgkmcnt(8)
MAV 40,8,64
TR 40,7,41664
MAV 40,24,72
buffer_load_dwordx4 v[120:123], v4, s[16:19], s53 offen sc1
MAV 56,24,76
TR 42,7,42176
MAV 56,8,68
TR 56,7,42688
TR 58,7,43200
MAV 60,12,68
TR 44,7,41696
MAV 60,28,76
buffer_load_dwordx4 v[124:127], v4, s[16:19], s53 offen offset:1024 sc1
MAV 44,28,72
TR 46,7,42208
MAV 44,12,64
TR 60,7,42720
TR 62,7,43232
s_barrier
s_waitcnt vmcnt(8) lgkmcnt(8)
MAV 32,32,80
TR 0,7,49920
s_add_u32 m0, s59, 84480
MAV 32,48,88
buffer_load_dwordx4 v12, s[32:35], s58 offen lds
MAV 48,48,92
TR 2,7,50432
MAV 48,32,84
TR 16,7,50944
TR 18,7,51456
MAV 52,36,84
TR 4,7,49952
MAV 52,52,92
TR 6,7,50464
TR 20,7,50976
MAV 36,52,88
TR 22,7,51488
MAV 36,36,80
TR 8,7,49984
s_waitcnt lgkmcnt(9)
MAV 40,40,80
TR 10,7,50496
MAV 40,56,88
buffer_load_dwordx4 v13, s[32:35], s58 offen offset:1056 lds
MAV 56,56,92
TR 24,7,51008
MAV 56,40,84
buffer_load_dwordx4 v14, s[32:35], s58 offen offset:2112 lds
MAV 60,44,84
TR 26,7,51520
MAV 60,60,92
TR 12,7,50016
TR 14,7,50528
MAV 44,60,88
TR 28,7,51040
MAV 44,44,80
TR 30,7,51552
s_waitcnt vmcnt(7) lgkmcnt(8)
MAV 32,0,96
TR 32,7,58240
MAV 32,16,104
buffer_load_dwordx4 v15, s[32:35], s58 offen offset:3168 lds
MAV 48,16,108
TR 34,7,58752
MAV 48,0,100
TR 48,7,59264
TR 50,7,59776
MAV 52,4,100
TR 36,7,58272
MAV 52,20,108
TR 38,7,58784
TR 52,7,59296
MAV 36,20,104
TR 54,7,59808
MAV 36,4,96
TR 40,7,58304
s_waitcnt lgkmcnt(9)
MAV 40,8,96
TR 42,7,58816
s_add_u32 m0, s59, 101376
MAV 40,24,104
buffer_load_dwordx4 v12, s[80:83], s58 offen lds
MAV 56,24,108
TR 56,7,59328
MAV 56,8,100
buffer_load_dwordx4 v13, s[80:83], s58 offen offset:1056 lds
MAV 60,12,100
TR 58,7,59840
MAV 60,28,108
TR 44,7,58336
TR 46,7,58848
MAV 44,28,104
TR 60,7,59360
MAV 44,12,96
TR 62,7,59872
s_waitcnt vmcnt(9) lgkmcnt(14)
MAV 32,32,112
buffer_load_dwordx4 v14, s[80:83], s58 offen offset:2112 lds
s_waitcnt vmcnt(8) lgkmcnt(12)
MAV 32,48,120
s_lshl_b32 s64, s6, 14
s_lshl_b32 s65, s49, 13
s_add_u32 s64, s64, s65
s_waitcnt vmcnt(7)
MAV 48,48,124
s_lshl_b32 s65, s7, 9
s_add_u32 s64, s64, s65
s_lshl_b32 s65, s48, 8
MAV 48,32,116
s_add_u32 s64, s64, s65
s_add_u32 s64, s64, 63176704
v_and_b32 v152, 31, v1
s_waitcnt lgkmcnt(10)
MAV 52,36,116
buffer_load_dwordx4 v15, s[80:83], s58 offen offset:3168 lds
s_waitcnt lgkmcnt(8)
MAV 52,52,124
s_add_u32 s58, s58, 458752
v_lshlrev_b32 v152, 3, v152
v_lshrrev_b32 v153, 5, v1
MAV 36,52,120
s_lshl_b32 s62, s7, 18
v_lshl_add_u32 v152, v153, 28, v152
s_add_u32 s62, s62, 41943040
MAV 36,36,112
s_add_u32 s63, s62, 131072
v_cvt_pk_bf16_f32 v128, v32, v33
v_cvt_pk_bf16_f32 v129, v34, v35
s_waitcnt lgkmcnt(6)
MAV 40,40,112
v_cvt_pk_bf16_f32 v136, v48, v49
v_cvt_pk_bf16_f32 v137, v50, v51
s_waitcnt lgkmcnt(4)
MAV 40,56,120
v_cvt_pk_bf16_f32 v130, v36, v37
v_cvt_pk_bf16_f32 v131, v38, v39
MAV 56,56,124
buffer_store_dwordx4 v[128:131], v4, s[16:19], s62 offen sc1
MAV 56,40,116
v_cvt_pk_bf16_f32 v138, v52, v53
v_cvt_pk_bf16_f32 v139, v54, v55
s_waitcnt lgkmcnt(2)
MAV 60,44,116
v_cvt_pk_bf16_f32 v132, v40, v41
v_cvt_pk_bf16_f32 v133, v42, v43
s_waitcnt lgkmcnt(0)
MAV 60,60,124
v_cvt_pk_bf16_f32 v140, v56, v57
MAV 44,60,120
buffer_store_dwordx4 v[136:139], v4, s[16:19], s62 offen offset:1024 sc1
MAV 44,44,112
v_cvt_pk_bf16_f32 v141, v58, v59
s_nop 2
v_cvt_pk_bf16_f32 v142, v60, v61
v_pk_mul_f32 v[146:147], v[32:33], v[32:33]
v_pk_mul_f32 v[150:151], v[48:49], v[48:49]
v_cvt_pk_bf16_f32 v143, v62, v63
v_pk_fma_f32 v[146:147], v[34:35], v[34:35], v[146:147]
v_pk_add_f32 v[144:145], v[32:33], v[34:35]
v_pk_fma_f32 v[150:151], v[50:51], v[50:51], v[150:151]
v_cvt_pk_bf16_f32 v134, v44, v45
v_cvt_pk_bf16_f32 v135, v46, v47
buffer_store_dwordx4 v[132:135], v4, s[16:19], s63 offen sc1
v_pk_add_f32 v[148:149], v[48:49], v[50:51]
v_pk_fma_f32 v[146:147], v[36:37], v[36:37], v[146:147]
v_pk_add_f32 v[144:145], v[144:145], v[36:37]
v_pk_fma_f32 v[150:151], v[52:53], v[52:53], v[150:151]
v_pk_add_f32 v[148:149], v[148:149], v[52:53]
v_pk_fma_f32 v[146:147], v[38:39], v[38:39], v[146:147]
v_pk_add_f32 v[144:145], v[144:145], v[38:39]
v_pk_fma_f32 v[150:151], v[54:55], v[54:55], v[150:151]
v_pk_add_f32 v[148:149], v[148:149], v[54:55]
v_pk_fma_f32 v[146:147], v[40:41], v[40:41], v[146:147]
v_pk_add_f32 v[144:145], v[144:145], v[40:41]
v_pk_fma_f32 v[150:151], v[56:57], v[56:57], v[150:151]
v_pk_add_f32 v[148:149], v[148:149], v[56:57]
buffer_store_dwordx4 v[140:143], v4, s[16:19], s63 offen offset:1024 sc1
v_pk_fma_f32 v[146:147], v[42:43], v[42:43], v[146:147]
v_pk_add_f32 v[144:145], v[144:145], v[42:43]
v_pk_fma_f32 v[150:151], v[58:59], v[58:59], v[150:151]
v_pk_add_f32 v[148:149], v[148:149], v[58:59]
v_pk_fma_f32 v[146:147], v[44:45], v[44:45], v[146:147]
v_pk_add_f32 v[144:145], v[144:145], v[44:45]
v_pk_fma_f32 v[150:151], v[60:61], v[60:61], v[150:151]
v_pk_add_f32 v[148:149], v[148:149], v[60:61]
v_pk_fma_f32 v[146:147], v[46:47], v[46:47], v[146:147]
v_pk_add_f32 v[144:145], v[144:145], v[46:47]
v_pk_fma_f32 v[150:151], v[62:63], v[62:63], v[150:151]
v_pk_add_f32 v[148:149], v[148:149], v[62:63]
v_add_f32 v144, v144, v145
v_add_f32 v146, v146, v147
v_add_f32 v148, v148, v149
v_add_f32 v150, v150, v151
s_nop 0
v_permlane16_swap_b32 v144, v148
v_permlane16_swap_b32 v146, v150
v_add_f32 v144, v144, v148
v_add_f32 v146, v146, v150
s_nop 1
v_permlane32_swap_b32 v144, v146
v_add_f32 v144, v144, v146
s_nop 1
v_permlane32_swap_b32 v144, v145
buffer_store_dwordx2 v[144:145], v152, s[16:19], s64 offen sc1
s_nop 1
s_mov_b32 s54, s58
s_mov_b32 s55, s59
v_accvgpr_write_b32 a224, v32
v_accvgpr_write_b32 a225, v33
v_accvgpr_write_b32 a226, v34
v_accvgpr_write_b32 a227, v35
v_accvgpr_write_b32 a228, v36
v_accvgpr_write_b32 a229, v37
v_accvgpr_write_b32 a230, v38
v_accvgpr_write_b32 a231, v39
v_accvgpr_write_b32 a232, v40
v_accvgpr_write_b32 a233, v41
v_accvgpr_write_b32 a234, v42
v_accvgpr_write_b32 a235, v43
v_accvgpr_write_b32 a236, v44
v_accvgpr_write_b32 a237, v45
v_accvgpr_write_b32 a238, v46
v_accvgpr_write_b32 a239, v47
v_accvgpr_write_b32 a240, v48
v_accvgpr_write_b32 a241, v49
v_accvgpr_write_b32 a242, v50
v_accvgpr_write_b32 a243, v51
v_accvgpr_write_b32 a244, v52
v_accvgpr_write_b32 a245, v53
v_accvgpr_write_b32 a246, v54
v_accvgpr_write_b32 a247, v55
v_accvgpr_write_b32 a248, v56
v_accvgpr_write_b32 a249, v57
v_accvgpr_write_b32 a250, v58
v_accvgpr_write_b32 a251, v59
v_accvgpr_write_b32 a252, v60
v_accvgpr_write_b32 a253, v61
v_accvgpr_write_b32 a254, v62
v_accvgpr_write_b32 a255, v63
s_lshl_b32 s62, s10, 14
s_lshl_b32 s63, s3, 12
s_add_u32 s62, s62, s63
s_lshl_b32 s63, s12, 11
s_add_u32 s62, s62, s63
v_lshl_add_u32 v10, v1, 4, s62
v_lshrrev_b32 v2, 3, v1
v_cmp_eq_u32 vcc, 3, v2
v_add_u32 v2, 67108480, v10
s_nop 0
v_cndmask_b32 v10, v10, v2, vcc
v_xor_b32 v11, 2048, v10
v_bfe_u32 v16, v1, 2, 3
v_mul_u32_u24 v16, 1056, v16
v_bfe_u32 v2, v1, 5, 1
v_lshl_add_u32 v16, v2, 8, v16
v_and_b32 v2, 3, v1
v_lshl_add_u32 v16, v2, 3, v16
s_lshl_b32 s62, s12, 6
s_add_u32 s62, s62, 84480
s_xor_b32 s63, s12, 1
s_mul_i32 s63, s63, 192
s_add_u32 s63, s63, 84480
v_add_u32 v17, s63, v16
v_add_u32 v16, s62, v16
s_mov_b32 s52, 41943040
s_mov_b32 s53, 41943040
s_mul_i32 s59, s3, 2112
s_and_b32 s62, s7, 1
s_mul_i32 s62, s62, 3670016
s_lshr_b32 s63, s7, 1
s_lshl_b32 s63, s63, 8
s_add_u32 s62, s62, s63
s_lshl_b32 s63, s3, 12
s_add_u32 s62, s62, s63
v_lshrrev_b32 v5, 4, v1
v_lshlrev_b32 v5, 14, v5
v_and_b32 v2, 15, v1
v_lshl_add_u32 v5, v2, 4, v5
v_add_u32 v5, s62, v5
v_add_u32 v6, 992, v5
s_lshl_b32 s62, s10, 15
s_lshl_b32 s63, s3, 13
s_add_u32 s62, s62, s63
v_lshl_add_u32 v4, v1, 4, s62
s_lshl_b32 s62, s6, 10
s_add_u32 s62, s62, 30507008
s_lshl_b32 s64, s10, 1
s_lshl_b32 s64, s64, 10
s_add_u32 s64, s64, 30507008
s_lshr_b32 s67, s5, 2
s_and_b32 s67, s67, 3
s_lshl_b32 s67, s67, 7
s_add_u32 s64, s64, s67
s_add_u32 s65, s64, 1024
v_lshl_add_u32 v252, v1, 7, s62
v_mov_b32 v253, s64
v_mov_b32 v255, 1
v_writelane_b32 v253, s65, 1
s_waitcnt vmcnt(0) lgkmcnt(0)
s_cmp_lg_u32 s3, 1
s_barrier
s_cbranch_scc1 .Lfirst64
s_mov_b64 exec, 15
buffer_atomic_add v255, v252, s[16:19], 0 offen
s_mov_b64 exec, 3
v_mov_b32 v254, 0
buffer_atomic_add v254, v253, s[16:19], 0 offen sc0
s_mov_b64 exec, -1
.Lfirst64:
s_add_u32 m0, s55, 118272
s_nop 0
buffer_load_dwordx4 v12, s[32:35], s54 offen lds
buffer_load_dwordx4 v13, s[32:35], s54 offen offset:1056 lds
buffer_load_dwordx4 v14, s[32:35], s54 offen offset:2112 lds
buffer_load_dwordx4 v15, s[32:35], s54 offen offset:3168 lds
s_add_u32 m0, s55, 135168
s_nop 0
buffer_load_dwordx4 v12, s[80:83], s54 offen lds
buffer_load_dwordx4 v13, s[80:83], s54 offen offset:1056 lds
buffer_load_dwordx4 v14, s[80:83], s54 offen offset:2112 lds
buffer_load_dwordx4 v15, s[80:83], s54 offen offset:3168 lds
s_add_u32 s54, s54, 458752
s_cmp_lg_u32 s3, 1
s_cbranch_scc1 .Lnopoll63
s_mov_b64 exec, 3
s_mov_b32 s15, 0
v_mov_b32 v255, 0
buffer_atomic_add v255, v253, s[16:19], 0 offen sc0
s_waitcnt vmcnt(9)
v_cmp_gt_u32 vcc, 16, v254
s_nop 0
s_cbranch_vccz .Lnopoll63r
.Lpoll62:
s_waitcnt vmcnt(0)
v_cmp_gt_u32 vcc, 16, v255
s_add_u32 s15, s15, 1
s_cbranch_vccz .Lnopoll63r
v_mov_b32 v255, 0
buffer_atomic_add v255, v253, s[16:19], 0 offen sc0
s_cmp_le_u32 s15, 100000
s_cbranch_scc1 .Lpoll62
s_branch .Lnopoll63r
.Lnopoll63:
s_mov_b64 exec, 0
s_cmp_eq_u32 s3, 2
s_cbranch_scc1 .Lpad34
s_cmp_eq_u32 s3, 3
s_cbranch_scc1 .Lpad35
s_branch .Lpad36
.Lnopoll63r:
s_mov_b64 exec, -1
s_waitcnt vmcnt(9)
s_barrier
buffer_load_dwordx4 a[128:131], v10, s[16:19], s52 offen sc1
buffer_load_dwordx4 a[132:135], v10, s[16:19], s52 offen offset:1024 sc1
s_add_u32 s52, s52, 131072
buffer_load_dwordx4 a[144:147], v10, s[16:19], s52 offen sc1
buffer_load_dwordx4 a[148:151], v10, s[16:19], s52 offen offset:1024 sc1
s_add_u32 s52, s52, 131072
buffer_load_dwordx4 a[136:139], v11, s[16:19], s53 offen sc1
buffer_load_dwordx4 a[140:143], v11, s[16:19], s53 offen offset:1024 sc1
s_add_u32 s53, s53, 131072
buffer_load_dwordx4 a[152:155], v11, s[16:19], s53 offen sc1
buffer_load_dwordx4 a[156:159], v11, s[16:19], s53 offen offset:1024 sc1
s_add_u32 s53, s53, 131072
ds_read_b64_tr_b16 a[0:1], v16
TR 2,16,512
TR 4,16,8448
TR 6,16,8960
TR 8,16,32
TR 10,16,544
TR 12,16,8480
TR 14,16,8992
TR 16,16,64
TR 18,16,576
TR 20,16,8512
TR 22,16,9024
TR 24,16,96
TR 26,16,608
TR 28,16,8544
TR 30,16,9056
TR 32,16,128
TR 34,16,640
TR 36,16,8576
TR 38,16,9088
TR 40,16,160
TR 42,16,672
TR 44,16,8608
TR 46,16,9120
ds_read_b64_tr_b16 a[48:49], v17
TR 50,17,512
TR 52,17,8448
TR 54,17,8960
TR 56,17,32
TR 58,17,544
TR 60,17,8480
TR 62,17,8992
s_lshl_b32 s57, s3, 13
s_add_u32 s57, s57, 49920
v_lshl_add_u32 v2, v1, 4, s57
s_waitcnt lgkmcnt(0)
s_barrier
s_waitcnt vmcnt(7)
v_mfma_f32_16x16x32_bf16 v[32:35], a[0:3], a[128:131], 0
buffer_load_dwordx4 a[160:163], v10, s[16:19], s52 offen sc1
s_waitcnt vmcnt(6)
MAA 32,4,144
TR 64,16,16896
v_mfma_f32_16x16x32_bf16 v[36:39], a[0:3], a[132:135], 0
TR 66,16,17408
s_waitcnt vmcnt(5)
MAA 36,4,148
TR 68,16,25344
v_mfma_f32_16x16x32_bf16 v[52:55], a[8:11], a[132:135], 0
buffer_load_dwordx4 a[164:167], v10, s[16:19], s52 offen offset:1024 sc1
MAA 52,12,148
TR 70,16,25856
s_add_u32 s52, s52, 131072
v_mfma_f32_16x16x32_bf16 v[48:51], a[8:11], a[128:131], 0
TR 72,16,16928
MAA 48,12,144
TR 74,16,17440
v_mfma_f32_16x16x32_bf16 v[96:99], a[16:19], a[128:131], 0
buffer_load_dwordx4 a[176:179], v10, s[16:19], s52 offen sc1
MAA 96,20,144
TR 76,16,25376
v_mfma_f32_16x16x32_bf16 v[100:103], a[16:19], a[132:135], 0
TR 78,16,25888
MAA 100,20,148
TR 80,16,16960
v_mfma_f32_16x16x32_bf16 v[116:119], a[24:27], a[132:135], 0
buffer_load_dwordx4 a[180:183], v10, s[16:19], s52 offen offset:1024 sc1
MAA 116,28,148
TR 82,16,17472
s_add_u32 s52, s52, 131072
v_mfma_f32_16x16x32_bf16 v[112:115], a[24:27], a[128:131], 0
TR 84,16,25408
MAA 112,28,144
TR 86,16,25920
v_mfma_f32_16x16x32_bf16 v[160:163], a[32:35], a[128:131], 0
buffer_load_dwordx4 a[168:171], v11, s[16:19], s53 offen sc1
MAA 160,36,144
TR 88,16,16992
v_mfma_f32_16x16x32_bf16 v[164:167], a[32:35], a[132:135], 0
TR 90,16,17504
MAA 164,36,148
TR 92,16,25440
v_mfma_f32_16x16x32_bf16 v[180:183], a[40:43], a[132:135], 0
buffer_load_dwordx4 a[172:175], v11, s[16:19], s53 offen offset:1024 sc1
MAA 180,44,148
TR 94,16,25952
s_add_u32 s53, s53, 131072
v_mfma_f32_16x16x32_bf16 v[176:179], a[40:43], a[128:131], 0
TR 96,16,17024
MAA 176,44,144
TR 98,16,17536
v_mfma_f32_16x16x32_bf16 v[224:227], a[48:51], a[128:131], 0
buffer_load_dwordx4 a[184:187], v11, s[16:19], s53 offen sc1
MAA 224,52,144
TR 100,16,25472
v_mfma_f32_16x16x32_bf16 v[228:231], a[48:51], a[132:135], 0
TR 102,16,25984
MAA 228,52,148
TR 104,16,17056
v_mfma_f32_16x16x32_bf16 v[236:239], a[56:59], a[132:135], 0
buffer_load_dwordx4 a[188:191], v11, s[16:19], s53 offen offset:1024 sc1
MAA 236,60,148
TR 106,16,17568
s_add_u32 s53, s53, 131072
v_mfma_f32_16x16x32_bf16 v[232:235], a[56:59], a[128:131], 0
TR 108,16,25504
s_add_u32 m0, s55, 84480
MAA 232,60,144
TR 110,16,26016
s_waitcnt vmcnt(8)
v_mfma_f32_16x16x32_bf16 v[188:191], a[40:43], a[140:143], 0
buffer_load_dwordx4 v12, s[32:35], s54 offen lds
MAA 188,44,156
TR 112,17,16896
v_mfma_f32_16x16x32_bf16 v[184:187], a[40:43], a[136:139], 0
TR 114,17,17408
MAA 184,44,152
TR 116,17,25344
v_mfma_f32_16x16x32_bf16 v[168:171], a[32:35], a[136:139], 0
buffer_load_dwordx4 v13, s[32:35], s54 offen offset:1056 lds
MAA 168,36,152
TR 118,17,25856
v_mfma_f32_16x16x32_bf16 v[172:175], a[32:35], a[140:143], 0
TR 120,17,16928
MAA 172,36,156
TR 122,17,17440
v_mfma_f32_16x16x32_bf16 v[124:127], a[24:27], a[140:143], 0
buffer_load_dwordx4 v14, s[32:35], s54 offen offset:2112 lds
MAA 124,28,156
TR 124,17,25376
v_mfma_f32_16x16x32_bf16 v[120:123], a[24:27], a[136:139], 0
TR 126,17,25888
MAA 120,28,152
v_mfma_f32_16x16x32_bf16 v[104:107], a[16:19], a[136:139], 0
buffer_load_dwordx4 v15, s[32:35], s54 offen offset:3168 lds
MAA 104,20,152
v_mfma_f32_16x16x32_bf16 v[108:111], a[16:19], a[140:143], 0
MAA 108,20,156
v_mfma_f32_16x16x32_bf16 v[60:63], a[8:11], a[140:143], 0
MAA 60,12,156
v_mfma_f32_16x16x32_bf16 v[56:59], a[8:11], a[136:139], 0
MAA 56,12,152
v_mfma_f32_16x16x32_bf16 v[40:43], a[0:3], a[136:139], 0
MAA 40,4,152
v_mfma_f32_16x16x32_bf16 v[44:47], a[0:3], a[140:143], 0
MAA 44,4,156
s_waitcnt lgkmcnt(0)
s_barrier
v_mfma_f32_16x16x32_bf16 v[64:67], a[64:67], a[128:131], 0
TR 0,16,33792
s_add_u32 m0, s55, 101376
MAA 64,68,144
buffer_load_dwordx4 v12, s[80:83], s54 offen lds
v_mfma_f32_16x16x32_bf16 v[68:71], a[64:67], a[132:135], 0
TR 2,16,34304
s_mul_i32 s66, s13, 114688
MAA 68,68,148
TR 4,16,42240
s_mul_i32 s65, s10, 1818624
v_mfma_f32_16x16x32_bf16 v[84:87], a[72:75], a[132:135], 0
TR 6,16,42752
s_add_u32 s66, s66, s65
MAA 84,76,148
TR 8,16,33824
s_add_u32 s66, s66, 46137344
v_mfma_f32_16x16x32_bf16 v[80:83], a[72:75], a[128:131], 0
buffer_load_dwordx4 v13, s[80:83], s54 offen offset:1056 lds
MAA 80,76,144
TR 10,16,34336
s_add_u32 s65, s66, 49152
v_mfma_f32_16x16x32_bf16 v[128:131], a[80:83], a[128:131], 0
TR 12,16,42272
s_lshl_b32 s62, s12, 16
.Lpad30:
s_cbranch_execz .Lpad33
MAA 128,84,144
TR 14,16,42784
s_add_u32 s62, s62, s66
v_mfma_f32_16x16x32_bf16 v[132:135], a[80:83], a[132:135], 0
TR 16,16,33856
s_add_u32 s63, s62, 16384
MAA 132,84,148
buffer_load_dwordx4 v14, s[80:83], s54 offen offset:2112 lds
v_mfma_f32_16x16x32_bf16 v[148:151], a[88:91], a[132:135], 0
TR 18,16,34368
s_add_u32 s64, s62, 32768
MAA 148,92,148
TR 20,16,42304
s_lshl_b32 s72, s10, 1
v_mfma_f32_16x16x32_bf16 v[144:147], a[88:91], a[128:131], 0
TR 22,16,42816
s_lshr_b32 s74, s11, 4
MAA 144,92,144
TR 24,16,33888
s_add_u32 s72, s72, s74
v_mfma_f32_16x16x32_bf16 v[192:195], a[96:99], a[128:131], 0
buffer_load_dwordx4 v15, s[80:83], s54 offen offset:3168 lds
MAA 192,100,144
TR 26,16,34400
s_add_u32 s54, s54, 458752
v_mfma_f32_16x16x32_bf16 v[196:199], a[96:99], a[132:135], 0
TR 28,16,42336
s_add_u32 m0, s57, 0
MAA 196,100,148
TR 30,16,42848
s_mov_b32 s58, 63176704
v_mfma_f32_16x16x32_bf16 v[212:215], a[104:107], a[132:135], 0
TR 32,16,33920
s_lshl_b32 s72, s72, 10
MAA 212,108,148
buffer_load_dwordx4 v4, s[16:19], s58 offen sc1 lds
v_mfma_f32_16x16x32_bf16 v[208:211], a[104:107], a[128:131], 0
TR 34,16,34432
s_add_u32 s72, s72, 30523392
MAA 208,108,144
TR 36,16,42368
s_and_b32 s73, s6, 14
v_mfma_f32_16x16x32_bf16 v[240:243], a[112:115], a[128:131], 0
TR 38,16,42880
s_and_b32 s74, s7, 1
MAA 240,116,144
TR 40,16,33952
s_add_u32 s73, s73, s74
v_mfma_f32_16x16x32_bf16 v[244:247], a[112:115], a[132:135], 0
buffer_load_dwordx4 v4, s[16:19], s58 offen offset:1024 sc1 lds
MAA 244,116,148
TR 42,16,34464
s_lshl_b32 s73, s73, 10
v_mfma_f32_16x16x32_bf16 v[252:255], a[120:123], a[132:135], 0
TR 44,16,42400
s_add_u32 s73, s73, 30523392
MAA 252,124,148
TR 46,16,42912
s_lshr_b32 s67, s5, 2
v_mfma_f32_16x16x32_bf16 v[248:251], a[120:123], a[128:131], 0
TR 48,17,33792
s_and_b32 s67, s67, 3
MAA 248,124,144
buffer_load_dwordx4 a[128:131], v10, s[16:19], s52 offen sc1
v_mfma_f32_16x16x32_bf16 v[220:223], a[104:107], a[140:143], 0
TR 50,17,34304
s_lshl_b32 s67, s67, 7
MAA 220,108,156
TR 52,17,42240
s_add_u32 s73, s73, s67
v_mfma_f32_16x16x32_bf16 v[216:219], a[104:107], a[136:139], 0
TR 54,17,42752
MAA 216,108,152
TR 56,17,33824
v_mfma_f32_16x16x32_bf16 v[200:203], a[96:99], a[136:139], 0
buffer_load_dwordx4 a[132:135], v10, s[16:19], s52 offen offset:1024 sc1
MAA 200,100,152
TR 58,17,34336
s_add_u32 s52, s52, 131072
v_mfma_f32_16x16x32_bf16 v[204:207], a[96:99], a[140:143], 0
TR 60,17,42272
MAA 204,100,156
TR 62,17,42784
v_mfma_f32_16x16x32_bf16 v[156:159], a[88:91], a[140:143], 0
MAA 156,92,156
buffer_load_dwordx4 a[144:147], v10, s[16:19], s52 offen sc1
v_mfma_f32_16x16x32_bf16 v[152:155], a[88:91], a[136:139], 0
MAA 152,92,152
v_mfma_f32_16x16x32_bf16 v[136:139], a[80:83], a[136:139], 0
MAA 136,84,152
v_mfma_f32_16x16x32_bf16 v[140:143], a[80:83], a[140:143], 0
buffer_load_dwordx4 a[148:151], v10, s[16:19], s52 offen offset:1024 sc1
MAA 140,84,156
s_add_u32 s52, s52, 131072
v_mfma_f32_16x16x32_bf16 v[92:95], a[72:75], a[140:143], 0
MAA 92,76,156
v_mfma_f32_16x16x32_bf16 v[88:91], a[72:75], a[136:139], 0
MAA 88,76,152
v_mfma_f32_16x16x32_bf16 v[72:75], a[64:67], a[136:139], 0
MAA 72,68,152
v_mfma_f32_16x16x32_bf16 v[76:79], a[64:67], a[140:143], 0
MAA 76,68,156
s_waitcnt vmcnt(18) lgkmcnt(0)
s_barrier
MAA 32,0,160
buffer_load_dwordx4 a[136:139], v11, s[16:19], s53 offen sc1
MAA 32,4,176
TR 64,16,50688
s_and_b32 s74, s7, 1
MAA 36,4,180
TR 66,16,51200
s_mul_i32 s87, s74, 917504
MAA 36,0,164
TR 68,16,59136
s_lshr_b32 s75, s6, 1
MAA 52,8,164
TR 70,16,59648
s_mul_i32 s75, s75, 1818624
MAA 52,12,180
buffer_load_dwordx4 a[140:143], v11, s[16:19], s53 offen offset:1024 sc1
MAA 48,12,176
TR 72,16,50720
s_add_u32 s53, s53, 131072
MAA 48,8,160
TR 74,16,51232
s_add_u32 s87, s87, s75
MAA 96,16,160
TR 76,16,59168
s_add_u32 s87, s87, 46137344
MAA 96,20,176
TR 78,16,59680
s_and_b32 s74, s6, 3
MAA 100,20,180
buffer_load_dwordx4 a[152:155], v11, s[16:19], s53 offen sc1
MAA 100,16,164
TR 80,16,50752
s_xor_b32 s75, s74, 0
MAA 116,24,164
TR 82,16,51264
s_sub_u32 s75, s75, 0
MAA 116,28,180
TR 84,16,59200
s_mul_i32 s98, s75, 458752
MAA 112,28,176
TR 86,16,59712
s_mul_i32 s75, s75, 114688
MAA 112,24,160
buffer_load_dwordx4 a[156:159], v11, s[16:19], s53 offen offset:1024 sc1
MAA 160,32,160
TR 88,16,50784
s_add_u32 s53, s53, 131072
MAA 160,36,176
TR 90,16,51296
s_add_u32 m0, s55, 118272
MAA 164,36,180
TR 92,16,59232
s_add_u32 s76, s87, s75
MAA 164,32,164
TR 94,16,59744
s_xor_b32 s75, s74, 1
MAA 180,40,164
buffer_load_dwordx4 v12, s[32:35], s54 offen lds
MAA 180,44,180
TR 96,16,50816
s_sub_u32 s75, s75, 1
MAA 176,44,176
TR 98,16,51328
s_mul_i32 s99, s75, 458752
MAA 176,40,160
TR 100,16,59264
s_mul_i32 s75, s75, 114688
MAA 224,48,160
TR 102,16,59776
s_add_u32 s77, s87, s75
MAA 224,52,176
buffer_load_dwordx4 v13, s[32:35], s54 offen offset:1056 lds
MAA 228,52,180
TR 104,16,50848
s_xor_b32 s75, s74, 2
MAA 228,48,164
TR 106,16,51360
s_sub_u32 s75, s75, 2
MAA 236,56,164
TR 108,16,59296
s_mul_i32 s100, s75, 458752
MAA 236,60,180
TR 110,16,59808
s_mul_i32 s75, s75, 114688
MAA 232,60,176
buffer_load_dwordx4 v14, s[32:35], s54 offen offset:2112 lds
MAA 232,56,160
TR 112,17,50688
s_add_u32 s78, s87, s75
s_waitcnt vmcnt(21)
MAA 188,40,172
TR 114,17,51200
s_xor_b32 s75, s74, 3
MAA 188,44,188
TR 116,17,59136
MAA 184,44,184
TR 118,17,59648
MAA 184,40,168
buffer_load_dwordx4 v15, s[32:35], s54 offen offset:3168 lds
MAA 168,32,168
TR 120,17,50720
s_add_u32 m0, s57, 2048
MAA 168,36,184
TR 122,17,51232
s_mov_b32 s58, 63178752
MAA 172,36,188
TR 124,17,59168
MAA 172,32,172
TR 126,17,59680
MAA 124,24,172
buffer_load_dwordx4 v4, s[16:19], s58 offen sc1 lds
MAA 124,28,188
MAA 120,28,184
MAA 120,24,168
MAA 104,16,168
MAA 104,20,184
buffer_load_dwordx4 v4, s[16:19], s58 offen offset:1024 sc1 lds
MAA 108,20,188
MAA 108,16,172
MAA 60,8,172
MAA 60,12,188
MAA 56,12,184
MAA 56,8,168
MAA 40,0,168
MAA 40,4,184
MAA 44,4,188
MAA 44,0,172
s_waitcnt vmcnt(20) lgkmcnt(0)
s_barrier
MAA 64,64,160
ds_read_b64_tr_b16 a[0:1], v16
s_add_u32 m0, s55, 135168
MAA 64,68,176
buffer_load_dwordx4 v12, s[80:83], s54 offen lds
MAA 68,68,180
TR 2,16,512
s_sub_u32 s75, s75, 3
MAA 68,64,164
TR 4,16,8448
s_mul_i32 s101, s75, 458752
MAA 84,72,164
TR 6,16,8960
s_mul_i32 s75, s75, 114688
MAA 84,76,180
TR 8,16,32
s_add_u32 s79, s87, s75
MAA 80,76,176
buffer_load_dwordx4 v13, s[80:83], s54 offen offset:1056 lds
MAA 80,72,160
TR 10,16,544
s_and_b32 s87, s6, 3
MAA 128,80,160
TR 12,16,8480
s_mov_b32 s46, 0
MAA 128,84,176
TR 14,16,8992
s_lshl_b32 s74, s3, 10
MAA 132,84,180
TR 16,16,64
s_lshl_b32 s75, s12, 9
MAA 132,80,164
buffer_load_dwordx4 v14, s[80:83], s54 offen offset:2112 lds
MAA 148,88,164
TR 18,16,576
s_add_u32 s74, s74, s75
MAA 148,92,180
TR 20,16,8512
s_add_u32 s74, s74, 152576
MAA 144,92,176
TR 22,16,9024
v_and_b32 v18, 15, v1
MAA 144,88,160
TR 24,16,96
v_lshl_add_u32 v18, v18, 4, s74
MAA 192,96,160
buffer_load_dwordx4 v15, s[80:83], s54 offen offset:3168 lds
MAA 192,100,176
TR 26,16,608
s_add_u32 s54, s54, 458752
MAA 196,100,180
TR 28,16,8544
s_add_u32 m0, s57, 4096
MAA 196,96,164
TR 30,16,9056
s_mov_b32 s58, 63180800
MAA 212,104,164
TR 32,16,128
v_xor_b32 v19, 512, v18
MAA 212,108,180
buffer_load_dwordx4 v4, s[16:19], s58 offen sc1 lds
MAA 208,108,176
TR 34,16,640
s_lshl_b32 s74, s12, 7
MAA 208,104,160
TR 36,16,8576
s_add_u32 s74, s74, 161536
MAA 240,112,160
TR 38,16,9088
s_xor_b32 s75, s12, 1
MAA 240,116,176
TR 40,16,160
s_mul_i32 s75, s75, 384
MAA 244,116,180
buffer_load_dwordx4 v4, s[16:19], s58 offen offset:1024 sc1 lds
MAA 244,112,164
TR 42,16,672
s_add_u32 s75, s75, 161536
MAA 252,120,164
TR 44,16,8608
v_lshrrev_b32 v9, 4, v1
MAA 252,124,180
TR 46,16,9120
v_lshlrev_b32 v9, 4, v9
MAA 248,124,176
ds_read_b64_tr_b16 a[48:49], v17
v_add_u32 v8, s75, v9
MAA 248,120,160
buffer_load_dwordx4 a[160:163], v10, s[16:19], s52 offen sc1
MAA 220,104,172
TR 50,17,512
v_add_u32 v9, s74, v9
MAA 220,108,188
TR 52,17,8448
MAA 216,108,184
TR 54,17,8960
MAA 216,104,168
TR 56,17,32
MAA 200,96,168
buffer_load_dwordx4 a[164:167], v10, s[16:19], s52 offen offset:1024 sc1
MAA 200,100,184
TR 58,17,544
s_add_u32 s52, s52, 131072
MAA 204,100,188
TR 60,17,8480
MAA 204,96,172
TR 62,17,8992
MAA 156,88,172
MAA 156,92,188
buffer_load_dwordx4 a[176:179], v10, s[16:19], s52 offen sc1
MAA 152,92,184
MAA 152,88,168
MAA 136,80,168
MAA 136,84,184
MAA 140,84,188
buffer_load_dwordx4 a[180:183], v10, s[16:19], s52 offen offset:1024 sc1
MAA 140,80,172
s_add_u32 s52, s52, 131072
MAA 92,72,172
MAA 92,76,188
MAA 88,76,184
MAA 88,72,168
MAA 72,64,168
MAA 72,68,184
MAA 76,68,188
MAA 76,64,172
s_waitcnt vmcnt(20) lgkmcnt(0)
s_barrier
MAA 32,0,128
buffer_load_dwordx4 a[168:171], v11, s[16:19], s53 offen sc1
MAA 32,4,144
ds_read_b128 v[20:23], v2
MAA 36,4,148
ds_read_b128 v[28:31], v2 offset:1024
MAA 36,0,132
s_waitcnt vmcnt(11)
ds_read_b128 v[24:27], v2 offset:2048
MAA 52,8,132
TR 64,16,16896
MAA 52,12,148
buffer_load_dwordx4 a[172:175], v11, s[16:19], s53 offen offset:1024 sc1
MAA 48,12,144
TR 66,16,17408
s_add_u32 s53, s53, 131072
MAA 48,8,128
TR 68,16,25344
MAA 96,16,128
TR 70,16,25856
MAA 96,20,144
TR 72,16,16928
MAA 100,20,148
buffer_load_dwordx4 a[184:187], v11, s[16:19], s53 offen sc1
MAA 100,16,132
TR 74,16,17440
s_waitcnt lgkmcnt(7)
v_add_f32 v20, v20, v28
MAA 116,24,132
TR 76,16,25376
v_add_f32 v21, v21, v29
MAA 116,28,148
TR 78,16,25888
v_add_f32 v22, v22, v30
MAA 112,28,144
TR 80,16,16960
v_add_f32 v23, v23, v31
MAA 112,24,128
buffer_load_dwordx4 a[188:191], v11, s[16:19], s53 offen offset:1024 sc1
MAA 160,32,128
ds_read_b128 v[28:31], v2 offset:3072
s_add_u32 s53, s53, 131072
MAA 160,36,144
TR 82,16,17472
s_add_u32 m0, s55, 84480
MAA 164,36,148
TR 84,16,25408
s_waitcnt lgkmcnt(12)
v_add_f32 v20, v20, v24
MAA 164,32,132
TR 86,16,25920
v_add_f32 v21, v21, v25
MAA 180,40,132
buffer_load_dwordx4 v12, s[32:35], s54 offen lds
MAA 180,44,148
TR 88,16,16992
v_add_f32 v22, v22, v26
MAA 176,44,144
TR 90,16,17504
v_add_f32 v23, v23, v27
MAA 176,40,128
TR 92,16,25440
MAA 224,48,128
TR 94,16,25952
MAA 224,52,144
buffer_load_dwordx4 v13, s[32:35], s54 offen offset:1056 lds
MAA 228,52,148
TR 96,16,17024
MAA 228,48,132
TR 98,16,17536
MAA 236,56,132
TR 100,16,25472
MAA 236,60,148
TR 102,16,25984
MAA 232,60,144
buffer_load_dwordx4 v14, s[32:35], s54 offen offset:2112 lds
MAA 232,56,128
TR 104,16,17056
MAA 188,40,140
TR 106,16,17568
MAA 188,44,156
TR 108,16,25504
MAA 184,44,152
TR 110,16,26016
MAA 184,40,136
buffer_load_dwordx4 v15, s[32:35], s54 offen offset:3168 lds
MAA 168,32,136
TR 112,17,16896
s_add_u32 m0, s57, 6144
MAA 168,36,152
TR 114,17,17408
s_mov_b32 s58, 63182848
MAA 172,36,156
TR 116,17,25344
MAA 172,32,140
TR 118,17,25856
MAA 124,24,140
buffer_load_dwordx4 v4, s[16:19], s58 offen sc1 lds
MAA 124,28,156
TR 120,17,16928
MAA 120,28,152
TR 122,17,17440
MAA 120,24,136
TR 124,17,25376
MAA 104,16,136
TR 126,17,25888
MAA 104,20,152
buffer_load_dwordx4 v4, s[16:19], s58 offen offset:1024 sc1 lds
MAA 108,20,156
MAA 108,16,140
MAA 60,8,140
MAA 60,12,156
MAA 56,12,152
MAA 56,8,136
MAA 40,0,136
MAA 40,4,152
MAA 44,4,156
MAA 44,0,140
s_waitcnt lgkmcnt(0)
s_barrier
MAA 64,64,128
s_waitcnt vmcnt(14)
ds_read_b128 v[24:27], v2 offset:4096
s_add_u32 m0, s55, 101376
MAA 64,68,144
buffer_load_dwordx4 v12, s[80:83], s54 offen lds
MAA 68,68,148
TR 0,16,33792
v_add_f32 v20, v20, v28
MAA 68,64,132
TR 2,16,34304
v_add_f32 v21, v21, v29
MAA 84,72,132
TR 4,16,42240
v_add_f32 v22, v22, v30
MAA 84,76,148
TR 6,16,42752
v_add_f32 v23, v23, v31
MAA 80,76,144
ds_read_b128 v[28:31], v2 offset:5120
MAA 80,72,128
TR 8,16,33824
MAA 128,80,128
buffer_load_dwordx4 v13, s[80:83], s54 offen offset:1056 lds
MAA 128,84,144
TR 10,16,34336
s_waitcnt lgkmcnt(7)
v_add_f32 v20, v20, v24
MAA 132,84,148
TR 12,16,42272
v_add_f32 v21, v21, v25
MAA 132,80,132
TR 14,16,42784
v_add_f32 v22, v22, v26
MAA 148,88,132
TR 16,16,33856
v_add_f32 v23, v23, v27
MAA 148,92,148
TR 18,16,34368
MAA 144,92,144
TR 20,16,42304
MAA 144,88,128
buffer_load_dwordx4 v14, s[80:83], s54 offen offset:2112 lds
MAA 192,96,128
TR 22,16,42816
MAA 192,100,144
TR 24,16,33888
MAA 196,100,148
TR 26,16,34400
MAA 196,96,132
TR 28,16,42336
MAA 212,104,132
TR 30,16,42848
MAA 212,108,148
TR 32,16,33920
MAA 208,108,144
buffer_load_dwordx4 v15, s[80:83], s54 offen offset:3168 lds
MAA 208,104,128
TR 34,16,34432
s_add_u32 s54, s54, 458752
MAA 240,112,128
TR 36,16,42368
MAA 240,116,144
TR 38,16,42880
MAA 244,116,148
TR 40,16,33952
MAA 244,112,132
.Lpad31:
s_cbranch_execz .Lnopoll60r
TR 42,16,34464
MAA 252,120,132
TR 44,16,42400
MAA 252,124,148
TR 46,16,42912
MAA 248,124,144
TR 48,17,33792
MAA 248,120,128
buffer_load_dwordx4 a[128:131], v10, s[16:19], s52 offen sc1
MAA 220,104,140
TR 50,17,34304
MAA 220,108,156
TR 52,17,42240
MAA 216,108,152
TR 54,17,42752
MAA 216,104,136
TR 56,17,33824
MAA 200,96,136
TR 58,17,34336
MAA 200,100,152
TR 60,17,42272
MAA 204,100,156
buffer_load_dwordx4 a[132:135], v10, s[16:19], s52 offen offset:1024 sc1
MAA 204,96,140
TR 62,17,42784
s_add_u32 s52, s52, 131072
MAA 156,88,140
MAA 156,92,156
MAA 152,92,152
MAA 152,88,136
MAA 136,80,136
MAA 136,84,152
buffer_load_dwordx4 a[144:147], v10, s[16:19], s52 offen sc1
MAA 140,84,156
MAA 140,80,140
MAA 92,72,140
MAA 92,76,156
MAA 88,76,152
MAA 88,72,136
MAA 72,64,136
buffer_load_dwordx4 a[148:151], v10, s[16:19], s52 offen offset:1024 sc1
MAA 72,68,152
s_add_u32 s52, s52, 131072
MAA 76,68,156
MAA 76,64,140
s_waitcnt vmcnt(18) lgkmcnt(0)
s_barrier
MAA 32,0,160
buffer_load_dwordx4 a[136:139], v11, s[16:19], s53 offen sc1
MAA 32,4,176
s_waitcnt vmcnt(9)
ds_read_b128 v[24:27], v2 offset:6144
v_add_f32 v20, v20, v28
MAA 36,4,180
TR 64,16,50688
v_add_f32 v21, v21, v29
MAA 36,0,164
TR 66,16,51200
v_add_f32 v22, v22, v30
MAA 52,8,164
TR 68,16,59136
v_add_f32 v23, v23, v31
MAA 52,12,180
ds_read_b128 v[28:31], v2 offset:7168
MAA 48,12,176
TR 70,16,59648
MAA 48,8,160
buffer_load_dwordx4 a[140:143], v11, s[16:19], s53 offen offset:1024 sc1
MAA 96,16,160
TR 72,16,50720
s_add_u32 s53, s53, 131072
MAA 96,20,176
TR 74,16,51232
s_waitcnt lgkmcnt(7)
v_add_f32 v20, v20, v24
MAA 100,20,180
TR 76,16,59168
v_add_f32 v21, v21, v25
MAA 100,16,164
TR 78,16,59680
v_add_f32 v22, v22, v26
MAA 116,24,164
TR 80,16,50752
v_add_f32 v23, v23, v27
MAA 116,28,180
TR 82,16,51264
s_waitcnt lgkmcnt(7)
v_add_f32 v20, v20, v28
MAA 112,28,176
buffer_load_dwordx4 a[152:155], v11, s[16:19], s53 offen sc1
MAA 112,24,160
TR 84,16,59200
v_add_f32 v21, v21, v29
MAA 160,32,160
TR 86,16,59712
v_add_f32 v22, v22, v30
MAA 160,36,176
TR 88,16,50784
v_add_f32 v23, v23, v31
MAA 164,36,180
TR 90,16,51296
MAA 164,32,164
TR 92,16,59232
MAA 180,40,164
TR 94,16,59744
MAA 180,44,180
buffer_load_dwordx4 a[156:159], v11, s[16:19], s53 offen offset:1024 sc1
MAA 176,44,176
TR 96,16,50816
s_add_u32 s53, s53, 131072
MAA 176,40,160
TR 98,16,51328
s_add_u32 m0, s55, 118272
MAA 224,48,160
TR 100,16,59264
MAA 224,52,176
TR 102,16,59776
MAA 228,52,180
TR 104,16,50848
MAA 228,48,164
TR 106,16,51360
MAA 236,56,164
buffer_load_dwordx4 v12, s[32:35], s54 offen lds
MAA 236,60,180
TR 108,16,59296
MAA 232,60,176
TR 110,16,59808
MAA 232,56,160
TR 112,17,50688
MAA 188,40,172
TR 114,17,51200
MAA 188,44,188
TR 116,17,59136
MAA 184,44,184
TR 118,17,59648
MAA 184,40,168
buffer_load_dwordx4 v13, s[32:35], s54 offen offset:1056 lds
MAA 168,32,168
TR 120,17,50720
MAA 168,36,184
TR 122,17,51232
MAA 172,36,188
TR 124,17,59168
MAA 172,32,172
TR 126,17,59680
MAA 124,24,172
MAA 124,28,188
MAA 120,28,184
buffer_load_dwordx4 v14, s[32:35], s54 offen offset:2112 lds
MAA 120,24,168
MAA 104,16,168
MAA 104,20,184
MAA 108,20,188
MAA 108,16,172
MAA 60,8,172
MAA 60,12,188
buffer_load_dwordx4 v15, s[32:35], s54 offen offset:3168 lds
MAA 56,12,184
MAA 56,8,168
MAA 40,0,168
MAA 40,4,184
MAA 44,4,188
MAA 44,0,172
s_waitcnt lgkmcnt(0)
s_barrier
MAA 64,64,160
ds_read_b64_tr_b16 a[0:1], v16
s_add_u32 m0, s55, 135168
MAA 64,68,176
buffer_load_dwordx4 v12, s[80:83], s54 offen lds
MAA 68,68,180
TR 2,16,512
v_permlane32_swap_b32 v20, v22
MAA 68,64,164
TR 4,16,8448
v_permlane32_swap_b32 v21, v23
MAA 84,72,164
TR 6,16,8960
v_add_f32 v20, v20, v22
MAA 84,76,180
TR 8,16,32
v_add_f32 v21, v21, v23
MAA 80,76,176
TR 10,16,544
v_mul_f32 v20, 0xba800000, v20
MAA 80,72,160
buffer_load_dwordx4 v13, s[80:83], s54 offen offset:1056 lds
MAA 128,80,160
TR 12,16,8480
v_mul_f32 v21, 0x3a800000, v21
MAA 128,84,176
TR 14,16,8992
v_fma_f32 v21, -v20, v20, v21
MAA 132,84,180
TR 16,16,64
v_max_f32 v21, 0, v21
MAA 132,80,164
TR 18,16,576
v_add_f32 v21, 0x3727c5ac, v21
MAA 148,88,164
TR 20,16,8512
v_rsq_f32 v22, v21
MAA 148,92,180
buffer_load_dwordx4 v14, s[80:83], s54 offen offset:2112 lds
MAA 144,92,176
TR 22,16,9024
v_and_b32 v24, 31, v1
MAA 144,88,160
TR 24,16,96
v_lshrrev_b32 v25, 5, v1
MAA 192,96,160
TR 26,16,608
v_lshl_add_u32 v24, v24, 1, v25
MAA 192,100,176
TR 28,16,8544
v_and_b32 v25, 0xc0, v0
MAA 196,100,180
TR 30,16,9056
v_add_u32 v24, v24, v25
MAA 196,96,164
TR 32,16,128
v_lshlrev_b32 v24, 4, v24
MAA 212,104,164
buffer_load_dwordx4 v15, s[80:83], s54 offen offset:3168 lds
MAA 212,108,180
TR 34,16,640
s_add_u32 s54, s54, 458752
MAA 208,108,176
TR 36,16,8576
v_add_u32 v24, 152576, v24
MAA 208,104,160
TR 38,16,9088
v_mul_f32 v22, 0xbfb8aa3b, v22
MAA 240,112,160
ds_write_b128 v24, v[20:23]
s_mov_b32 s58, s98
MAA 240,116,176
ds_read_b64 v[20:21], v18
s_mov_b32 s67, s59
MAA 244,116,180
ds_read_b64 v[22:23], v18 offset:256
MAA 244,112,164
ds_read_b64 v[24:25], v19
MAA 252,120,164
ds_read_b64 v[26:27], v19 offset:256
MAA 252,124,180
ds_read_b32 a192, v18 offset:8
MAA 248,124,176
ds_read_b32 a193, v18 offset:264
v_mov_b32 v18, v5
MAA 248,120,160
buffer_load_dwordx4 a[160:163], v10, s[16:19], s52 offen sc1
MAA 220,104,172
ds_read_b32 a194, v19 offset:8
MAA 220,108,188
ds_read_b32 a195, v19 offset:264
v_add_u32 v19, 992, v5
MAA 216,108,184
TR 40,16,160
MAA 216,104,168
TR 42,16,672
MAA 200,96,168
TR 44,16,8608
MAA 200,100,184
TR 46,16,9120
MAA 204,100,188
buffer_load_dwordx4 a[164:167], v10, s[16:19], s52 offen offset:1024 sc1
MAA 204,96,172
ds_read_b64_tr_b16 a[48:49], v17
s_add_u32 s52, s52, 131072
MAA 156,88,172
TR 50,17,512
MAA 156,92,188
TR 52,17,8448
MAA 152,92,184
TR 54,17,8960
MAA 152,88,168
TR 56,17,32
MAA 136,80,168
TR 58,17,544
MAA 136,84,184
buffer_load_dwordx4 a[176:179], v10, s[16:19], s52 offen sc1
MAA 140,84,188
TR 60,17,8480
MAA 140,80,172
TR 62,17,8992
MAA 92,72,172
MAA 92,76,188
MAA 88,76,184
MAA 88,72,168
MAA 72,64,168
buffer_load_dwordx4 a[180:183], v10, s[16:19], s52 offen offset:1024 sc1
MAA 72,68,184
s_add_u32 s52, s52, 131072
MAA 76,68,188
MAA 76,64,172
s_waitcnt vmcnt(16) lgkmcnt(0)
s_barrier
MAA 32,0,128
ds_read_b128 v[28:31], v9 offset:512
MAA 32,4,144
ds_read_b128 v[4:7], v9 offset:576
MAA 36,4,148
buffer_load_dwordx4 a[168:171], v11, s[16:19], s53 offen sc1
MAA 36,0,132
TR 64,16,16896
MAA 52,8,132
TR 66,16,17408
MAA 52,12,148
TR 68,16,25344
MAA 48,12,144
TR 70,16,25856
MAA 48,8,128
TR 72,16,16928
MAA 96,16,128
buffer_load_dwordx4 a[172:175], v11, s[16:19], s53 offen offset:1024 sc1
MAA 96,20,144
TR 74,16,17440
s_add_u32 s53, s53, 131072
MAA 100,20,148
TR 76,16,25376
s_waitcnt lgkmcnt(8)
v_fmac_f32 v64, v28, v20
MAA 100,16,132
TR 78,16,25888
v_fmac_f32 v65, v29, v20
MAA 116,24,132
TR 80,16,16960
v_fmac_f32 v66, v30, v20
MAA 116,28,148
TR 82,16,17472
v_fmac_f32 v67, v31, v20
MAA 112,28,144
buffer_load_dwordx4 a[184:187], v11, s[16:19], s53 offen sc1
MAA 112,24,128
TR 84,16,25408
v_fmac_f32 v68, v28, v22
MAA 160,32,128
TR 86,16,25920
v_fmac_f32 v69, v29, v22
MAA 160,36,144
TR 88,16,16992
v_fmac_f32 v70, v30, v22
MAA 164,36,148
TR 90,16,17504
v_fmac_f32 v71, v31, v22
MAA 164,32,132
TR 92,16,25440
v_fmac_f32 v72, v28, v24
MAA 180,40,132
buffer_load_dwordx4 a[188:191], v11, s[16:19], s53 offen offset:1024 sc1
MAA 180,44,148
TR 94,16,25952
s_add_u32 s53, s53, 131072
MAA 176,44,144
TR 96,16,17024
s_add_u32 m0, s55, 84480
MAA 176,40,128
TR 98,16,17536
v_fmac_f32 v73, v29, v24
MAA 224,48,128
TR 100,16,25472
v_fmac_f32 v74, v30, v24
MAA 224,52,144
TR 102,16,25984
v_fmac_f32 v75, v31, v24
MAA 228,52,148
buffer_load_dwordx4 v12, s[32:35], s54 offen lds
MAA 228,48,132
TR 104,16,17056
v_fmac_f32 v76, v28, v26
MAA 236,56,132
TR 106,16,17568
v_fmac_f32 v77, v29, v26
MAA 236,60,148
TR 108,16,25504
v_fmac_f32 v78, v30, v26
MAA 232,60,144
TR 110,16,26016
v_fmac_f32 v79, v31, v26
MAA 232,56,128
ds_read_b128 v[28:31], v9 offset:640
s_waitcnt lgkmcnt(15)
v_fmac_f32 v80, v4, v20
s_waitcnt vmcnt(17)
MAA 188,40,140
buffer_load_dwordx4 v13, s[32:35], s54 offen offset:1056 lds
MAA 188,44,156
TR 112,17,16896
v_fmac_f32 v81, v5, v20
MAA 184,44,152
TR 114,17,17408
v_fmac_f32 v82, v6, v20
MAA 184,40,136
TR 116,17,25344
v_fmac_f32 v83, v7, v20
MAA 168,32,136
TR 118,17,25856
v_fmac_f32 v84, v4, v22
MAA 168,36,152
TR 120,17,16928
v_fmac_f32 v85, v5, v22
MAA 172,36,156
buffer_load_dwordx4 v14, s[32:35], s54 offen offset:2112 lds
MAA 172,32,140
TR 122,17,17440
v_fmac_f32 v86, v6, v22
MAA 124,24,140
TR 124,17,25376
v_fmac_f32 v87, v7, v22
MAA 124,28,156
TR 126,17,25888
v_fmac_f32 v88, v4, v24
MAA 120,28,152
v_fmac_f32 v89, v5, v24
v_fmac_f32 v90, v6, v24
MAA 120,24,136
v_fmac_f32 v91, v7, v24
v_fmac_f32 v92, v4, v26
MAA 104,16,136
buffer_load_dwordx4 v15, s[32:35], s54 offen offset:3168 lds
MAA 104,20,152
s_mov_b32 m0, s67
v_fmac_f32 v93, v5, v26
v_fmac_f32 v94, v6, v26
MAA 108,20,156
v_fmac_f32 v95, v7, v26
s_waitcnt lgkmcnt(8)
v_fmac_f32 v128, v28, v20
MAA 108,16,140
ds_read_b128 v[4:7], v8 offset:512
v_fmac_f32 v129, v29, v20
MAA 60,8,140
v_fmac_f32 v130, v30, v20
v_fmac_f32 v131, v31, v20
MAA 60,12,156
v_fmac_f32 v132, v28, v22
v_fmac_f32 v133, v29, v22
MAA 56,12,152
buffer_load_dwordx4 v18, s[28:31], s58 offen lds
MAA 56,8,136
v_fmac_f32 v134, v30, v22
v_fmac_f32 v135, v31, v22
MAA 40,0,136
v_fmac_f32 v136, v28, v24
v_fmac_f32 v137, v29, v24
MAA 40,4,152
v_fmac_f32 v138, v30, v24
v_fmac_f32 v139, v31, v24
MAA 44,4,156
v_fmac_f32 v140, v28, v26
v_fmac_f32 v141, v29, v26
MAA 44,0,140
v_fmac_f32 v142, v30, v26
v_fmac_f32 v143, v31, v26
s_waitcnt lgkmcnt(0)
v_fmac_f32 v240, v4, v20
v_fmac_f32 v241, v5, v20
v_fmac_f32 v242, v6, v20
v_fmac_f32 v243, v7, v20
v_fmac_f32 v244, v4, v22
v_fmac_f32 v245, v5, v22
v_fmac_f32 v246, v6, v22
v_fmac_f32 v247, v7, v22
s_waitcnt vmcnt(17) lgkmcnt(0)
s_barrier
MAA 64,64,128
ds_read_b128 v[28:31], v9
s_add_u32 m0, s55, 101376
MAA 64,68,144
ds_read_b128 v[4:7], v9 offset:64
MAA 68,68,148
buffer_load_dwordx4 v12, s[80:83], s54 offen lds
MAA 68,64,132
TR 0,16,33792
MAA 84,72,132
TR 2,16,34304
MAA 84,76,148
TR 4,16,42240
MAA 80,76,144
TR 6,16,42752
MAA 80,72,128
TR 8,16,33824
MAA 128,80,128
buffer_load_dwordx4 v13, s[80:83], s54 offen offset:1056 lds
MAA 128,84,144
TR 10,16,34336
s_waitcnt lgkmcnt(7)
v_fmac_f32 v32, v28, v20
MAA 132,84,148
TR 12,16,42272
v_fmac_f32 v33, v29, v20
MAA 132,80,132
TR 14,16,42784
v_fmac_f32 v34, v30, v20
MAA 148,88,132
TR 16,16,33856
v_fmac_f32 v35, v31, v20
MAA 148,92,148
TR 18,16,34368
v_fmac_f32 v36, v28, v22
MAA 144,92,144
buffer_load_dwordx4 v14, s[80:83], s54 offen offset:2112 lds
MAA 144,88,128
TR 20,16,42304
v_fmac_f32 v37, v29, v22
MAA 192,96,128
TR 22,16,42816
v_fmac_f32 v38, v30, v22
MAA 192,100,144
TR 24,16,33888
v_fmac_f32 v39, v31, v22
MAA 196,100,148
TR 26,16,34400
v_fmac_f32 v40, v28, v24
MAA 196,96,132
TR 28,16,42336
v_fmac_f32 v41, v29, v24
MAA 212,104,132
buffer_load_dwordx4 v15, s[80:83], s54 offen offset:3168 lds
MAA 212,108,148
TR 30,16,42848
s_add_u32 s54, s54, 458752
MAA 208,108,144
TR 32,16,33920
s_mov_b32 m0, s67
MAA 208,104,128
TR 34,16,34432
v_fmac_f32 v42, v30, v24
MAA 240,112,128
TR 36,16,42368
v_fmac_f32 v43, v31, v24
MAA 240,116,144
TR 38,16,42880
v_fmac_f32 v44, v28, v26
MAA 244,116,148
buffer_load_dwordx4 v19, s[28:31], s58 offen offset:1056 lds
MAA 244,112,132
TR 40,16,33952
s_add_u32 s67, s67, 8448
MAA 252,120,132
TR 42,16,34464
s_add_u32 s58, s58, 0x40000
MAA 252,124,148
TR 44,16,42400
v_fmac_f32 v45, v29, v26
MAA 248,124,144
TR 46,16,42912
v_fmac_f32 v46, v30, v26
MAA 248,120,128
TR 48,17,33792
v_fmac_f32 v47, v31, v26
MAA 220,104,140
ds_read_b128 v[28:31], v9 offset:128
s_waitcnt lgkmcnt(15)
v_fmac_f32 v48, v4, v20
MAA 220,108,156
buffer_load_dwordx4 a[128:131], v10, s[16:19], s52 offen sc1
MAA 216,108,152
TR 50,17,34304
v_fmac_f32 v49, v5, v20
MAA 216,104,136
TR 52,17,42240
v_fmac_f32 v50, v6, v20
MAA 200,96,136
TR 54,17,42752
v_fmac_f32 v51, v7, v20
MAA 200,100,152
TR 56,17,33824
v_fmac_f32 v52, v4, v22
MAA 204,100,156
TR 58,17,34336
.Lpad32:
s_cbranch_execz .Lnopoll60r
v_fmac_f32 v53, v5, v22
MAA 204,96,140
buffer_load_dwordx4 a[132:135], v10, s[16:19], s52 offen offset:1024 sc1
MAA 156,88,140
TR 60,17,42272
s_add_u32 s52, s52, 131072
MAA 156,92,156
TR 62,17,42784
v_fmac_f32 v54, v6, v22
MAA 152,92,152
v_fmac_f32 v55, v7, v22
v_fmac_f32 v56, v4, v24
MAA 152,88,136
v_fmac_f32 v57, v5, v24
v_fmac_f32 v58, v6, v24
MAA 136,80,136
v_fmac_f32 v59, v7, v24
v_fmac_f32 v60, v4, v26
MAA 136,84,152
buffer_load_dwordx4 a[144:147], v10, s[16:19], s52 offen sc1
MAA 140,84,156
v_fmac_f32 v61, v5, v26
v_fmac_f32 v62, v6, v26
MAA 140,80,140
v_fmac_f32 v63, v7, v26
s_waitcnt lgkmcnt(7)
v_fmac_f32 v96, v28, v20
MAA 92,72,140
ds_read_b128 v[4:7], v8
v_fmac_f32 v97, v29, v20
MAA 92,76,156
v_fmac_f32 v98, v30, v20
v_fmac_f32 v99, v31, v20
MAA 88,76,152
v_fmac_f32 v100, v28, v22
v_fmac_f32 v101, v29, v22
MAA 88,72,136
buffer_load_dwordx4 a[148:151], v10, s[16:19], s52 offen offset:1024 sc1
MAA 72,64,136
s_add_u32 s52, s52, 131072
v_fmac_f32 v102, v30, v22
v_fmac_f32 v103, v31, v22
MAA 72,68,152
v_fmac_f32 v104, v28, v24
v_fmac_f32 v105, v29, v24
MAA 76,68,156
v_fmac_f32 v106, v30, v24
v_fmac_f32 v107, v31, v24
MAA 76,64,140
v_fmac_f32 v108, v28, v26
v_fmac_f32 v109, v29, v26
v_fmac_f32 v110, v30, v26
v_fmac_f32 v111, v31, v26
s_waitcnt lgkmcnt(0)
v_fmac_f32 v224, v4, v20
v_fmac_f32 v225, v5, v20
v_fmac_f32 v226, v6, v20
v_fmac_f32 v227, v7, v20
v_fmac_f32 v228, v4, v22
v_fmac_f32 v229, v5, v22
v_fmac_f32 v230, v6, v22
v_fmac_f32 v231, v7, v22
s_waitcnt vmcnt(18) lgkmcnt(0)
s_barrier
MAA 32,0,160
ds_read_b128 v[28:31], v9 offset:704
MAA 32,4,176
ds_read_b128 v[4:7], v9 offset:768
MAA 36,4,180
buffer_load_dwordx4 a[136:139], v11, s[16:19], s53 offen sc1
MAA 36,0,164
TR 64,16,50688
MAA 52,8,164
TR 66,16,51200
MAA 52,12,180
TR 68,16,59136
MAA 48,12,176
TR 70,16,59648
MAA 48,8,160
TR 72,16,50720
MAA 96,16,160
buffer_load_dwordx4 a[140:143], v11, s[16:19], s53 offen offset:1024 sc1
MAA 96,20,176
TR 74,16,51232
s_add_u32 s53, s53, 131072
MAA 100,20,180
TR 76,16,59168
s_waitcnt lgkmcnt(8)
v_fmac_f32 v144, v28, v20
MAA 100,16,164
TR 78,16,59680
v_fmac_f32 v145, v29, v20
MAA 116,24,164
TR 80,16,50752
v_fmac_f32 v146, v30, v20
MAA 116,28,180
TR 82,16,51264
v_fmac_f32 v147, v31, v20
MAA 112,28,176
buffer_load_dwordx4 a[152:155], v11, s[16:19], s53 offen sc1
MAA 112,24,160
TR 84,16,59200
v_fmac_f32 v148, v28, v22
MAA 160,32,160
TR 86,16,59712
v_fmac_f32 v149, v29, v22
MAA 160,36,176
TR 88,16,50784
v_fmac_f32 v150, v30, v22
MAA 164,36,180
TR 90,16,51296
v_fmac_f32 v151, v31, v22
MAA 164,32,164
TR 92,16,59232
v_fmac_f32 v152, v28, v24
MAA 180,40,164
buffer_load_dwordx4 a[156:159], v11, s[16:19], s53 offen offset:1024 sc1
MAA 180,44,180
TR 94,16,59744
s_add_u32 s53, s53, 131072
MAA 176,44,176
TR 96,16,50816
s_add_u32 m0, s55, 118272
MAA 176,40,160
TR 98,16,51328
v_fmac_f32 v153, v29, v24
MAA 224,48,160
TR 100,16,59264
v_fmac_f32 v154, v30, v24
MAA 224,52,176
TR 102,16,59776
v_fmac_f32 v155, v31, v24
MAA 228,52,180
buffer_load_dwordx4 v12, s[32:35], s54 offen lds
MAA 228,48,164
TR 104,16,50848
v_fmac_f32 v156, v28, v26
MAA 236,56,164
TR 106,16,51360
v_fmac_f32 v157, v29, v26
MAA 236,60,180
TR 108,16,59296
v_fmac_f32 v158, v30, v26
MAA 232,60,176
TR 110,16,59808
v_fmac_f32 v159, v31, v26
MAA 232,56,160
ds_read_b128 v[28:31], v9 offset:832
s_waitcnt lgkmcnt(15)
v_fmac_f32 v192, v4, v20
s_waitcnt vmcnt(19)
MAA 188,40,172
buffer_load_dwordx4 v13, s[32:35], s54 offen offset:1056 lds
MAA 188,44,188
TR 112,17,50688
v_fmac_f32 v193, v5, v20
MAA 184,44,184
TR 114,17,51200
v_fmac_f32 v194, v6, v20
MAA 184,40,168
TR 116,17,59136
v_fmac_f32 v195, v7, v20
MAA 168,32,168
TR 118,17,59648
v_fmac_f32 v196, v4, v22
MAA 168,36,184
TR 120,17,50720
v_fmac_f32 v197, v5, v22
MAA 172,36,188
buffer_load_dwordx4 v14, s[32:35], s54 offen offset:2112 lds
MAA 172,32,172
TR 122,17,51232
v_fmac_f32 v198, v6, v22
MAA 124,24,172
TR 124,17,59168
v_fmac_f32 v199, v7, v22
MAA 124,28,188
TR 126,17,59680
v_fmac_f32 v200, v4, v24
MAA 120,28,184
v_fmac_f32 v201, v5, v24
v_fmac_f32 v202, v6, v24
MAA 120,24,168
v_fmac_f32 v203, v7, v24
v_fmac_f32 v204, v4, v26
MAA 104,16,168
buffer_load_dwordx4 v15, s[32:35], s54 offen offset:3168 lds
MAA 104,20,184
s_mov_b32 m0, s67
v_fmac_f32 v205, v5, v26
v_fmac_f32 v206, v6, v26
MAA 108,20,188
v_fmac_f32 v207, v7, v26
s_waitcnt lgkmcnt(8)
v_fmac_f32 v208, v28, v20
MAA 108,16,172
ds_read_b128 v[4:7], v8 offset:576
v_fmac_f32 v209, v29, v20
MAA 60,8,172
v_fmac_f32 v210, v30, v20
v_fmac_f32 v211, v31, v20
MAA 60,12,188
v_fmac_f32 v212, v28, v22
v_fmac_f32 v213, v29, v22
MAA 56,12,184
buffer_load_dwordx4 v18, s[28:31], s58 offen lds
MAA 56,8,168
v_fmac_f32 v214, v30, v22
v_fmac_f32 v215, v31, v22
MAA 40,0,168
v_fmac_f32 v216, v28, v24
v_fmac_f32 v217, v29, v24
MAA 40,4,184
v_fmac_f32 v218, v30, v24
v_fmac_f32 v219, v31, v24
MAA 44,4,188
v_fmac_f32 v220, v28, v26
v_fmac_f32 v221, v29, v26
MAA 44,0,172
v_fmac_f32 v222, v30, v26
v_fmac_f32 v223, v31, v26
s_waitcnt lgkmcnt(0)
v_fmac_f32 v248, v4, v20
v_fmac_f32 v249, v5, v20
v_fmac_f32 v250, v6, v20
v_fmac_f32 v251, v7, v20
v_fmac_f32 v252, v4, v22
v_fmac_f32 v253, v5, v22
v_fmac_f32 v254, v6, v22
v_fmac_f32 v255, v7, v22
s_waitcnt vmcnt(19) lgkmcnt(0)
s_barrier
MAA 64,64,160
ds_read_b128 v[28:31], v9 offset:192
s_add_u32 m0, s55, 135168
MAA 64,68,176
ds_read_b128 v[4:7], v9 offset:256
MAA 68,68,180
buffer_load_dwordx4 v12, s[80:83], s54 offen lds
MAA 68,64,164
ds_read_b64_tr_b16 a[0:1], v16
MAA 84,72,164
TR 2,16,512
MAA 84,76,180
TR 4,16,8448
MAA 80,76,176
TR 6,16,8960
MAA 80,72,160
TR 8,16,32
MAA 128,80,160
buffer_load_dwordx4 v13, s[80:83], s54 offen offset:1056 lds
MAA 128,84,176
TR 10,16,544
s_waitcnt lgkmcnt(7)
v_fmac_f32 v112, v28, v20
MAA 132,84,180
TR 12,16,8480
v_fmac_f32 v113, v29, v20
MAA 132,80,164
TR 14,16,8992
v_fmac_f32 v114, v30, v20
MAA 148,88,164
TR 16,16,64
v_fmac_f32 v115, v31, v20
MAA 148,92,180
TR 18,16,576
v_fmac_f32 v116, v28, v22
MAA 144,92,176
buffer_load_dwordx4 v14, s[80:83], s54 offen offset:2112 lds
MAA 144,88,160
TR 20,16,8512
v_fmac_f32 v117, v29, v22
MAA 192,96,160
TR 22,16,9024
v_fmac_f32 v118, v30, v22
MAA 192,100,176
TR 24,16,96
v_fmac_f32 v119, v31, v22
MAA 196,100,180
TR 26,16,608
v_fmac_f32 v120, v28, v24
MAA 196,96,164
TR 28,16,8544
v_fmac_f32 v121, v29, v24
MAA 212,104,164
buffer_load_dwordx4 v15, s[80:83], s54 offen offset:3168 lds
MAA 212,108,180
TR 30,16,9056
s_add_u32 s54, s54, 458752
MAA 208,108,176
TR 32,16,128
s_mov_b32 m0, s67
MAA 208,104,160
TR 34,16,640
v_fmac_f32 v122, v30, v24
MAA 240,112,160
TR 36,16,8576
v_fmac_f32 v123, v31, v24
MAA 240,116,176
TR 38,16,9088
v_fmac_f32 v124, v28, v26
MAA 244,116,180
buffer_load_dwordx4 v19, s[28:31], s58 offen offset:1056 lds
MAA 244,112,164
TR 40,16,160
s_add_u32 s67, s67, 8448
MAA 252,120,164
TR 42,16,672
s_add_u32 s46, s46, 1
MAA 252,124,180
TR 44,16,8608
s_xor_b32 s58, s46, s87
MAA 248,124,176
TR 46,16,9120
s_mul_i32 s58, s58, 458752
MAA 248,120,160
ds_read_b64_tr_b16 a[48:49], v17
v_fmac_f32 v125, v29, v26
MAA 220,104,172
buffer_load_dwordx4 a[160:163], v10, s[16:19], s52 offen sc1
MAA 220,108,188
TR 50,17,512
v_fmac_f32 v126, v30, v26
MAA 216,108,184
TR 52,17,8448
v_fmac_f32 v127, v31, v26
MAA 216,104,168
ds_read_b128 v[28:31], v9 offset:320
s_waitcnt lgkmcnt(15)
v_fmac_f32 v160, v4, v20
MAA 200,96,168
TR 54,17,8960
v_fmac_f32 v161, v5, v20
MAA 200,100,184
TR 56,17,32
v_fmac_f32 v162, v6, v20
MAA 204,100,188
buffer_load_dwordx4 a[164:167], v10, s[16:19], s52 offen offset:1024 sc1
MAA 204,96,172
TR 58,17,544
s_add_u32 s52, s52, 131072
MAA 156,88,172
TR 60,17,8480
v_fmac_f32 v163, v7, v20
MAA 156,92,188
TR 62,17,8992
v_fmac_f32 v164, v4, v22
MAA 152,92,184
v_fmac_f32 v165, v5, v22
v_fmac_f32 v166, v6, v22
MAA 152,88,168
v_fmac_f32 v167, v7, v22
v_fmac_f32 v168, v4, v24
MAA 136,80,168
buffer_load_dwordx4 a[176:179], v10, s[16:19], s52 offen sc1
MAA 136,84,184
v_fmac_f32 v169, v5, v24
v_fmac_f32 v170, v6, v24
MAA 140,84,188
v_fmac_f32 v171, v7, v24
v_fmac_f32 v172, v4, v26
MAA 140,80,172
v_fmac_f32 v173, v5, v26
v_fmac_f32 v174, v6, v26
MAA 92,72,172
v_fmac_f32 v175, v7, v26
s_waitcnt lgkmcnt(5)
v_fmac_f32 v176, v28, v20
MAA 92,76,188
ds_read_b128 v[4:7], v8 offset:64
v_fmac_f32 v177, v29, v20
MAA 88,76,184
buffer_load_dwordx4 a[180:183], v10, s[16:19], s52 offen offset:1024 sc1
MAA 88,72,168
s_add_u32 s52, s52, 131072
v_fmac_f32 v178, v30, v20
v_fmac_f32 v179, v31, v20
MAA 72,64,168
v_fmac_f32 v180, v28, v22
v_fmac_f32 v181, v29, v22
MAA 72,68,184
v_fmac_f32 v182, v30, v22
v_fmac_f32 v183, v31, v22
MAA 76,68,188
v_fmac_f32 v184, v28, v24
v_fmac_f32 v185, v29, v24
MAA 76,64,172
v_fmac_f32 v186, v30, v24
v_fmac_f32 v187, v31, v24
v_fmac_f32 v188, v28, v26
v_fmac_f32 v189, v29, v26
v_fmac_f32 v190, v30, v26
v_fmac_f32 v191, v31, v26
v_accvgpr_read_b32 v28, a192
s_waitcnt lgkmcnt(0)
v_fmac_f32 v232, v4, v20
v_fmac_f32 v233, v5, v20
v_fmac_f32 v234, v6, v20
v_fmac_f32 v235, v7, v20
v_fmac_f32 v236, v4, v22
v_fmac_f32 v237, v5, v22
v_fmac_f32 v238, v6, v22
v_fmac_f32 v239, v7, v22
v_accvgpr_read_b32 v29, a193
v_accvgpr_read_b32 v30, a194
v_accvgpr_read_b32 v31, a195
s_mov_b32 s15, -4
.p2align 6
.Lk65:
s_waitcnt vmcnt(18) lgkmcnt(0)
s_barrier
MAA 32,0,128
TR 64,16,16896
MAA 32,4,144
buffer_load_dwordx4 a[168:171], v11, s[16:19], s53 offen sc1
MAA 36,4,148
TR 66,16,17408
MAA 36,0,132
TR 68,16,25344
MAA 52,8,132
TR 70,16,25856
MAA 52,12,148
MAA 48,12,144
TR 72,16,16928
MAA 48,8,128
buffer_load_dwordx4 a[172:175], v11, s[16:19], s53 offen offset:1024 sc1
MAA 96,16,128
TR 74,16,17440
s_add_u32 s53, s53, 131072
MAA 96,20,144
TR 76,16,25376
MAA 100,20,148
MAA 100,16,132
TR 78,16,25888
MAA 116,24,132
TR 80,16,16960
MAA 116,28,148
buffer_load_dwordx4 a[184:187], v11, s[16:19], s53 offen sc1
MAA 112,28,144
TR 82,16,17472
MAA 112,24,128
MAA 160,32,128
TR 84,16,25408
MAA 160,36,144
TR 86,16,25920
MAA 164,36,148
TR 88,16,16992
MAA 164,32,132
buffer_load_dwordx4 a[188:191], v11, s[16:19], s53 offen offset:1024 sc1
MAA 180,40,132
s_add_u32 s53, s53, 131072
MAA 180,44,148
TR 90,16,17504
MAA 176,44,144
TR 92,16,25440
MAA 176,40,128
TR 94,16,25952
MAA 224,48,128
s_add_u32 m0, s55, 84480
MAA 224,52,144
buffer_load_dwordx4 v12, s[32:35], s54 offen lds
MAA 228,52,148
TR 96,16,17024
MAA 228,48,132
TR 98,16,17536
MAA 236,56,132
TR 100,16,25472
MAA 236,60,148
TR 102,16,25984
MAA 232,60,144
MAA 232,56,128
TR 104,16,17056
s_waitcnt vmcnt(19)
MAA 188,40,140
TR 106,16,17568
MAA 188,44,156
buffer_load_dwordx4 v13, s[32:35], s54 offen offset:1056 lds
MAA 184,44,152
TR 108,16,25504
MAA 184,40,136
MAA 168,32,136
TR 110,16,26016
MAA 168,36,152
buffer_load_dwordx4 v14, s[32:35], s54 offen offset:2112 lds
MAA 172,36,156
TR 112,17,16896
MAA 172,32,140
TR 114,17,17408
MAA 124,24,140
MAA 124,28,156
TR 116,17,25344
MAA 120,28,152
TR 118,17,25856
MAA 120,24,136
buffer_load_dwordx4 v15, s[32:35], s54 offen offset:3168 lds
MAA 104,16,136
TR 120,17,16928
MAA 104,20,152
MAA 108,20,156
TR 122,17,17440
MAA 108,16,140
TR 124,17,25376
MAA 60,8,140
TR 126,17,25888
s_mov_b32 m0, s67
MAA 60,12,156
buffer_load_dwordx4 v18, s[28:31], s58 offen lds
MAA 56,12,152
MAA 56,8,136
MAA 40,0,136
MAA 40,4,152
MAA 44,4,156
MAA 44,0,140
s_waitcnt vmcnt(19) lgkmcnt(0)
s_barrier
MAA 64,64,128
TR 0,16,33792
s_add_u32 m0, s55, 101376
MAA 64,68,144
buffer_load_dwordx4 v12, s[80:83], s54 offen lds
MAA 68,68,148
TR 2,16,34304
MAA 68,64,132
TR 4,16,42240
MAA 84,72,132
TR 6,16,42752
MAA 84,76,148
MAA 80,76,144
TR 8,16,33824
MAA 80,72,128
buffer_load_dwordx4 v13, s[80:83], s54 offen offset:1056 lds
MAA 128,80,128
TR 10,16,34336
MAA 128,84,144
TR 12,16,42272
MAA 132,84,148
TR 14,16,42784
MAA 132,80,132
MAA 148,88,132
TR 16,16,33856
MAA 148,92,148
buffer_load_dwordx4 v14, s[80:83], s54 offen offset:2112 lds
MAA 144,92,144
TR 18,16,34368
MAA 144,88,128
TR 20,16,42304
MAA 192,96,128
MAA 192,100,144
TR 22,16,42816
MAA 196,100,148
TR 24,16,33888
MAA 196,96,132
buffer_load_dwordx4 v15, s[80:83], s54 offen offset:3168 lds
MAA 212,104,132
TR 26,16,34400
s_add_u32 s54, s54, 458752
MAA 212,108,148
TR 28,16,42336
MAA 208,108,144
MAA 208,104,128
TR 30,16,42848
MAA 240,112,128
TR 32,16,33920
s_mov_b32 m0, s67
MAA 240,116,144
buffer_load_dwordx4 v19, s[28:31], s58 offen offset:1056 lds
MAA 244,116,148
s_add_u32 s67, s67, 8448
s_add_u32 s58, s58, 0x40000
MAA 244,112,132
TR 34,16,34432
MAA 252,120,132
MAA 252,124,148
TR 36,16,42368
MAA 248,124,144
TR 38,16,42880
MAA 248,120,128
buffer_load_dwordx4 a[128:131], v10, s[16:19], s52 offen sc1
MAA 220,104,140
TR 40,16,33952
MAA 220,108,156
TR 42,16,34464
MAA 216,108,152
MAA 216,104,136
TR 44,16,42400
MAA 200,96,136
TR 46,16,42912
MAA 200,100,152
buffer_load_dwordx4 a[132:135], v10, s[16:19], s52 offen offset:1024 sc1
MAA 204,100,156
TR 48,17,33792
s_add_u32 s52, s52, 131072
MAA 204,96,140
MAA 156,88,140
TR 50,17,34304
MAA 156,92,156
TR 52,17,42240
.Lpad33:
s_cbranch_execz .Lnopoll60r
MAA 152,92,152
TR 54,17,42752
MAA 152,88,136
buffer_load_dwordx4 a[144:147], v10, s[16:19], s52 offen sc1
MAA 136,80,136
TR 56,17,33824
MAA 136,84,152
MAA 140,84,156
TR 58,17,34336
MAA 140,80,140
TR 60,17,42272
MAA 92,72,140
TR 62,17,42784
MAA 92,76,156
buffer_load_dwordx4 a[148:151], v10, s[16:19], s52 offen offset:1024 sc1
MAA 88,76,152
s_add_u32 s52, s52, 131072
MAA 88,72,136
MAA 72,64,136
MAA 72,68,152
MAA 76,68,156
MAA 76,64,140
s_waitcnt vmcnt(18) lgkmcnt(0)
s_barrier
MAA 32,0,160
TR 64,16,50688
MAA 32,4,176
buffer_load_dwordx4 a[136:139], v11, s[16:19], s53 offen sc1
MAA 36,4,180
TR 66,16,51200
MAA 36,0,164
TR 68,16,59136
MAA 52,8,164
TR 70,16,59648
MAA 52,12,180
MAA 48,12,176
TR 72,16,50720
MAA 48,8,160
buffer_load_dwordx4 a[140:143], v11, s[16:19], s53 offen offset:1024 sc1
MAA 96,16,160
TR 74,16,51232
s_add_u32 s53, s53, 131072
MAA 96,20,176
TR 76,16,59168
MAA 100,20,180
MAA 100,16,164
TR 78,16,59680
MAA 116,24,164
TR 80,16,50752
MAA 116,28,180
buffer_load_dwordx4 a[152:155], v11, s[16:19], s53 offen sc1
MAA 112,28,176
TR 82,16,51264
MAA 112,24,160
MAA 160,32,160
TR 84,16,59200
MAA 160,36,176
TR 86,16,59712
MAA 164,36,180
TR 88,16,50784
MAA 164,32,164
buffer_load_dwordx4 a[156:159], v11, s[16:19], s53 offen offset:1024 sc1
MAA 180,40,164
s_add_u32 s53, s53, 131072
MAA 180,44,180
TR 90,16,51296
MAA 176,44,176
TR 92,16,59232
MAA 176,40,160
TR 94,16,59744
MAA 224,48,160
s_add_u32 m0, s55, 118272
MAA 224,52,176
buffer_load_dwordx4 v12, s[32:35], s54 offen lds
MAA 228,52,180
TR 96,16,50816
MAA 228,48,164
TR 98,16,51328
MAA 236,56,164
TR 100,16,59264
MAA 236,60,180
TR 102,16,59776
MAA 232,60,176
MAA 232,56,160
TR 104,16,50848
s_waitcnt vmcnt(19)
MAA 188,40,172
TR 106,16,51360
MAA 188,44,188
buffer_load_dwordx4 v13, s[32:35], s54 offen offset:1056 lds
MAA 184,44,184
TR 108,16,59296
MAA 184,40,168
MAA 168,32,168
TR 110,16,59808
MAA 168,36,184
buffer_load_dwordx4 v14, s[32:35], s54 offen offset:2112 lds
MAA 172,36,188
TR 112,17,50688
MAA 172,32,172
TR 114,17,51200
MAA 124,24,172
MAA 124,28,188
TR 116,17,59136
MAA 120,28,184
TR 118,17,59648
MAA 120,24,168
buffer_load_dwordx4 v15, s[32:35], s54 offen offset:3168 lds
MAA 104,16,168
TR 120,17,50720
MAA 104,20,184
MAA 108,20,188
TR 122,17,51232
MAA 108,16,172
TR 124,17,59168
MAA 60,8,172
TR 126,17,59680
s_mov_b32 m0, s67
MAA 60,12,188
buffer_load_dwordx4 v18, s[28:31], s58 offen lds
MAA 56,12,184
MAA 56,8,168
MAA 40,0,168
MAA 40,4,184
MAA 44,4,188
MAA 44,0,172
s_waitcnt vmcnt(19) lgkmcnt(0)
s_barrier
MAA 64,64,160
ds_read_b64_tr_b16 a[0:1], v16
s_add_u32 m0, s55, 135168
MAA 64,68,176
buffer_load_dwordx4 v12, s[80:83], s54 offen lds
MAA 68,68,180
TR 2,16,512
MAA 68,64,164
TR 4,16,8448
MAA 84,72,164
TR 6,16,8960
MAA 84,76,180
MAA 80,76,176
TR 8,16,32
MAA 80,72,160
buffer_load_dwordx4 v13, s[80:83], s54 offen offset:1056 lds
MAA 128,80,160
TR 10,16,544
MAA 128,84,176
TR 12,16,8480
MAA 132,84,180
TR 14,16,8992
MAA 132,80,164
MAA 148,88,164
TR 16,16,64
MAA 148,92,180
buffer_load_dwordx4 v14, s[80:83], s54 offen offset:2112 lds
MAA 144,92,176
TR 18,16,576
MAA 144,88,160
TR 20,16,8512
MAA 192,96,160
MAA 192,100,176
TR 22,16,9024
MAA 196,100,180
TR 24,16,96
MAA 196,96,164
buffer_load_dwordx4 v15, s[80:83], s54 offen offset:3168 lds
MAA 212,104,164
TR 26,16,608
s_add_u32 s54, s54, 458752
MAA 212,108,180
TR 28,16,8544
MAA 208,108,176
MAA 208,104,160
TR 30,16,9056
MAA 240,112,160
TR 32,16,128
s_mov_b32 m0, s67
MAA 240,116,176
buffer_load_dwordx4 v19, s[28:31], s58 offen offset:1056 lds
MAA 244,116,180
s_add_u32 s67, s67, 8448
s_add_u32 s46, s46, 1
s_xor_b32 s58, s46, s87
s_mul_i32 s58, s58, 458752
MAA 244,112,164
TR 34,16,640
MAA 252,120,164
MAA 252,124,180
TR 36,16,8576
MAA 248,124,176
TR 38,16,9088
MAA 248,120,160
buffer_load_dwordx4 a[160:163], v10, s[16:19], s52 offen sc1
MAA 220,104,172
TR 40,16,160
MAA 220,108,188
TR 42,16,672
MAA 216,108,184
MAA 216,104,168
TR 44,16,8608
MAA 200,96,168
TR 46,16,9120
MAA 200,100,184
buffer_load_dwordx4 a[164:167], v10, s[16:19], s52 offen offset:1024 sc1
MAA 204,100,188
ds_read_b64_tr_b16 a[48:49], v17
s_add_u32 s52, s52, 131072
MAA 204,96,172
MAA 156,88,172
TR 50,17,512
MAA 156,92,188
TR 52,17,8448
MAA 152,92,184
TR 54,17,8960
MAA 152,88,168
buffer_load_dwordx4 a[176:179], v10, s[16:19], s52 offen sc1
MAA 136,80,168
TR 56,17,32
MAA 136,84,184
MAA 140,84,188
TR 58,17,544
MAA 140,80,172
TR 60,17,8480
MAA 92,72,172
TR 62,17,8992
MAA 92,76,188
buffer_load_dwordx4 a[180:183], v10, s[16:19], s52 offen offset:1024 sc1
MAA 88,76,184
s_add_u32 s52, s52, 131072
MAA 88,72,168
MAA 72,64,168
MAA 72,68,184
MAA 76,68,188
s_add_u32 s15, s15, 1
MAA 76,64,172
s_cbranch_scc0 .Lk65
s_waitcnt vmcnt(10) lgkmcnt(0)
s_barrier
MAA 32,0,128
buffer_load_dwordx4 a[168:171], v11, s[16:19], s53 offen sc1
MAA 32,4,144
TR 64,16,16896
s_add_u32 s58, s99, 2293760
MAA 48,12,144
TR 66,16,17408
s_lshl_b32 s74, s3, 11
MAA 48,8,128
TR 68,16,25344
s_add_u32 s74, s74, s84
MAA 36,0,132
buffer_load_dwordx4 a[172:175], v11, s[16:19], s53 offen offset:1024 sc1
MAA 36,4,148
TR 70,16,25856
s_add_u32 s53, s53, 131072
MAA 52,12,148
TR 72,16,16928
v_lshl_add_u32 v4, v1, 4, s74
MAA 52,8,132
TR 74,16,17440
v_lshrrev_b32 v2, 3, v1
MAA 40,0,136
buffer_load_dwordx4 a[184:187], v11, s[16:19], s53 offen sc1
MAA 40,4,152
TR 76,16,25376
v_cmp_eq_u32 vcc, 3, v2
MAA 56,12,152
TR 78,16,25888
v_add_u32 v2, 67108480, v4
MAA 56,8,136
TR 80,16,33792
v_cndmask_b32 v4, v4, v2, vcc
MAA 44,0,140
buffer_load_dwordx4 a[188:191], v11, s[16:19], s53 offen offset:1024 sc1
MAA 44,4,156
TR 82,16,34304
s_add_u32 s53, s53, 131072
MAA 60,12,156
TR 84,16,42240
s_and_b32 s74, s7, 1
MAA 60,8,140
TR 86,16,42752
s_add_u32 s54, s98, 65536
MAA 96,16,128
TR 88,16,33824
v_bfe_u32 v7, v1, 2, 3
MAA 96,20,144
TR 90,16,34336
v_mul_u32_u24 v7, 1056, v7
MAA 112,28,144
TR 92,16,42272
s_waitcnt vmcnt(9)
s_barrier
MAA 112,24,128
TR 94,16,42784
v_bfe_u32 v2, v1, 5, 1
MAA 100,16,132
TR 96,16,50688
v_lshl_add_u32 v7, v2, 8, v7
MAA 100,20,148
TR 98,16,51200
v_and_b32 v2, 3, v1
MAA 116,28,148
TR 100,16,59136
v_lshl_add_u32 v7, v2, 3, v7
MAA 116,24,132
TR 102,16,59648
s_lshl_b32 s74, s74, 7
MAA 104,16,136
TR 104,16,50720
s_xor_b32 s75, s74, 128
MAA 104,20,152
TR 106,16,51232
v_add_u32 v6, s75, v7
MAA 120,28,152
TR 108,16,59168
v_add_u32 v7, s74, v7
MAA 120,24,136
TR 110,16,59680
s_mul_i32 s55, s3, 2112
MAA 108,16,140
TR 112,16,16960
s_mov_b32 s57, 67584
MAA 108,20,156
TR 114,16,17472
MAA 124,28,156
TR 116,16,25408
MAA 124,24,140
TR 118,16,25920
MAA 160,32,128
TR 120,16,16992
MAA 160,36,144
TR 122,16,17504
MAA 176,44,144
TR 124,16,25440
MAA 176,40,128
TR 126,16,25952
MAA 164,32,132
TR 192,16,33856
MAA 164,36,148
TR 194,16,34368
MAA 180,44,148
TR 196,16,42304
MAA 180,40,132
TR 198,16,42816
MAA 168,32,136
TR 200,16,33888
MAA 168,36,152
TR 202,16,34400
MAA 184,44,152
TR 204,16,42336
MAA 184,40,136
TR 206,16,42848
MAA 172,32,140
TR 208,16,50752
MAA 172,36,156
TR 210,16,51264
MAA 188,44,156
TR 212,16,59200
MAA 188,40,140
TR 214,16,59712
MAA 224,48,128
TR 216,16,50784
MAA 224,52,144
TR 218,16,51296
MAA 232,60,144
TR 220,16,59232
MAA 232,56,128
TR 222,16,59744
MAA 228,48,132
TR 0,16,17024
MAA 228,52,148
TR 2,16,17536
MAA 236,60,148
TR 4,16,25472
MAA 236,56,132
TR 6,16,25984
s_waitcnt lgkmcnt(15)
MAA 64,64,128
TR 8,16,17056
MAA 64,68,144
TR 10,16,17568
s_waitcnt vmcnt(7)
MAA 64,96,160
TR 12,16,25504
s_waitcnt vmcnt(5)
MAA 64,100,176
TR 14,16,26016
MAA 80,108,176
TR 16,16,33920
MAA 80,104,160
TR 18,16,34432
MAA 80,76,144
TR 20,16,42368
MAA 80,72,128
TR 22,16,42880
MAA 32,80,160
TR 24,16,33952
MAA 32,84,176
TR 26,16,34464
MAA 48,92,176
TR 28,16,42400
MAA 48,88,160
TR 30,16,42912
s_nop 2
v_pk_mul_f32 v[64:65], v[64:65], v[32:33]
TR 32,16,50816
TR 34,16,51328
v_pk_mul_f32 v[32:33], v[32:33], v[28:29] op_sel_hi:[1,0]
v_pk_mul_f32 v[66:67], v[66:67], v[34:35]
v_pk_mul_f32 v[34:35], v[34:35], v[28:29] op_sel_hi:[1,0]
v_exp_f32 v32, v32
v_pk_mul_f32 v[80:81], v[80:81], v[48:49]
v_pk_mul_f32 v[48:49], v[48:49], v[28:29] op_sel_hi:[1,0]
v_pk_mul_f32 v[82:83], v[82:83], v[50:51]
v_pk_mul_f32 v[50:51], v[50:51], v[28:29] op_sel_hi:[1,0]
v_exp_f32 v33, v33
v_exp_f32 v34, v34
MAA 68,64,132
TR 36,16,59264
v_exp_f32 v35, v35
MAA 68,68,148
TR 38,16,59776
v_exp_f32 v48, v48
MAA 68,96,164
TR 40,16,50848
v_exp_f32 v49, v49
s_waitcnt vmcnt(4)
MAA 68,100,180
TR 42,16,51360
v_exp_f32 v50, v50
MAA 84,108,180
TR 44,16,59296
v_exp_f32 v51, v51
MAA 84,104,164
TR 46,16,59808
MAA 84,76,148
TR 48,17,16896
MAA 84,72,132
TR 50,17,17408
MAA 36,80,164
TR 52,17,25344
MAA 36,84,180
TR 54,17,25856
MAA 52,92,180
TR 56,17,16928
MAA 52,88,164
TR 58,17,17440
s_nop 2
v_pk_mul_f32 v[68:69], v[68:69], v[36:37]
v_pk_fma_f32 v[32:33], v[32:33], v[20:21], v[20:21] op_sel:[0,1,1] op_sel_hi:[1,1,1]
v_pk_fma_f32 v[34:35], v[34:35], v[20:21], v[20:21] op_sel:[0,1,1] op_sel_hi:[1,1,1]
v_pk_mul_f32 v[36:37], v[36:37], v[28:29] op_sel:[0,1] op_sel_hi:[1,1]
v_pk_mul_f32 v[70:71], v[70:71], v[38:39]
v_pk_mul_f32 v[38:39], v[38:39], v[28:29] op_sel:[0,1] op_sel_hi:[1,1]
v_pk_fma_f32 v[48:49], v[48:49], v[20:21], v[20:21] op_sel:[0,1,1] op_sel_hi:[1,1,1]
v_pk_mul_f32 v[84:85], v[84:85], v[52:53]
v_pk_mul_f32 v[52:53], v[52:53], v[28:29] op_sel:[0,1] op_sel_hi:[1,1]
v_pk_mul_f32 v[86:87], v[86:87], v[54:55]
v_pk_mul_f32 v[54:55], v[54:55], v[28:29] op_sel:[0,1] op_sel_hi:[1,1]
v_pk_fma_f32 v[50:51], v[50:51], v[20:21], v[20:21] op_sel:[0,1,1] op_sel_hi:[1,1,1]
v_rcp_f32 v32, v32
v_rcp_f32 v33, v33
MAA 72,64,136
TR 60,17,25376
v_rcp_f32 v34, v34
MAA 72,68,152
TR 62,17,25888
v_rcp_f32 v35, v35
s_waitcnt vmcnt(3)
MAA 72,96,168
v_rcp_f32 v48, v48
s_waitcnt vmcnt(1)
MAA 72,100,184
v_rcp_f32 v49, v49
MAA 88,108,184
v_rcp_f32 v50, v50
MAA 88,104,168
v_rcp_f32 v51, v51
MAA 88,76,152
v_exp_f32 v36, v36
MAA 88,72,136
v_exp_f32 v37, v37
MAA 40,80,168
v_exp_f32 v38, v38
MAA 40,84,184
v_exp_f32 v39, v39
MAA 56,92,184
v_exp_f32 v52, v52
MAA 56,88,168
v_exp_f32 v53, v53
v_exp_f32 v54, v54
v_exp_f32 v55, v55
v_pk_mul_f32 v[64:65], v[64:65], v[32:33]
v_pk_mul_f32 v[66:67], v[66:67], v[34:35]
v_pk_mul_f32 v[80:81], v[80:81], v[48:49]
v_pk_mul_f32 v[82:83], v[82:83], v[50:51]
v_pk_mul_f32 v[72:73], v[72:73], v[40:41]
v_pk_mul_f32 v[40:41], v[40:41], v[30:31] op_sel_hi:[1,0]
v_pk_mul_f32 v[74:75], v[74:75], v[42:43]
v_pk_mul_f32 v[42:43], v[42:43], v[30:31] op_sel_hi:[1,0]
v_pk_mul_f32 v[88:89], v[88:89], v[56:57]
v_pk_mul_f32 v[56:57], v[56:57], v[30:31] op_sel_hi:[1,0]
v_pk_mul_f32 v[90:91], v[90:91], v[58:59]
v_pk_mul_f32 v[58:59], v[58:59], v[30:31] op_sel_hi:[1,0]
v_pk_fma_f32 v[36:37], v[36:37], v[22:23], v[22:23] op_sel:[0,1,1] op_sel_hi:[1,1,1]
v_pk_fma_f32 v[38:39], v[38:39], v[22:23], v[22:23] op_sel:[0,1,1] op_sel_hi:[1,1,1]
v_pk_fma_f32 v[52:53], v[52:53], v[22:23], v[22:23] op_sel:[0,1,1] op_sel_hi:[1,1,1]
v_pk_fma_f32 v[54:55], v[54:55], v[22:23], v[22:23] op_sel:[0,1,1] op_sel_hi:[1,1,1]
v_cvt_pk_bf16_f32 v32, v64, v65
v_cvt_pk_bf16_f32 v33, v66, v67
v_cvt_pk_bf16_f32 v34, v80, v81
v_cvt_pk_bf16_f32 v35, v82, v83
MAA 76,64,140
buffer_store_dwordx4 v[32:35], v10, s[16:19], s62 offen sc1
MAA 76,68,156
TR 64,17,33792
v_rcp_f32 v36, v36
MAA 76,96,172
TR 66,17,34304
v_rcp_f32 v37, v37
s_waitcnt vmcnt(1)
MAA 76,100,188
TR 68,17,42240
v_rcp_f32 v38, v38
MAA 92,108,188
TR 70,17,42752
v_rcp_f32 v39, v39
MAA 92,104,172
v_rcp_f32 v52, v52
MAA 92,76,156
TR 76,17,42272
v_rcp_f32 v53, v53
MAA 92,72,140
TR 72,17,33824
v_rcp_f32 v54, v54
MAA 44,80,172
TR 74,17,34336
v_rcp_f32 v55, v55
MAA 44,84,188
TR 78,17,42784
v_exp_f32 v40, v40
MAA 60,92,188
TR 80,17,50688
v_exp_f32 v41, v41
MAA 60,88,172
.Lpad34:
s_cbranch_execz .Lpad37
TR 82,17,51200
v_exp_f32 v42, v42
v_exp_f32 v43, v43
v_exp_f32 v56, v56
v_exp_f32 v57, v57
v_exp_f32 v58, v58
v_exp_f32 v59, v59
v_pk_mul_f32 v[68:69], v[68:69], v[36:37]
v_pk_mul_f32 v[70:71], v[70:71], v[38:39]
v_pk_mul_f32 v[84:85], v[84:85], v[52:53]
v_pk_mul_f32 v[86:87], v[86:87], v[54:55]
v_pk_mul_f32 v[76:77], v[76:77], v[44:45]
v_pk_mul_f32 v[44:45], v[44:45], v[30:31] op_sel:[0,1] op_sel_hi:[1,1]
v_pk_mul_f32 v[78:79], v[78:79], v[46:47]
v_pk_mul_f32 v[46:47], v[46:47], v[30:31] op_sel:[0,1] op_sel_hi:[1,1]
v_pk_mul_f32 v[92:93], v[92:93], v[60:61]
v_pk_mul_f32 v[60:61], v[60:61], v[30:31] op_sel:[0,1] op_sel_hi:[1,1]
v_pk_mul_f32 v[94:95], v[94:95], v[62:63]
v_pk_mul_f32 v[62:63], v[62:63], v[30:31] op_sel:[0,1] op_sel_hi:[1,1]
v_pk_fma_f32 v[40:41], v[40:41], v[24:25], v[24:25] op_sel:[0,1,1] op_sel_hi:[1,1,1]
v_pk_fma_f32 v[42:43], v[42:43], v[24:25], v[24:25] op_sel:[0,1,1] op_sel_hi:[1,1,1]
v_pk_fma_f32 v[56:57], v[56:57], v[24:25], v[24:25] op_sel:[0,1,1] op_sel_hi:[1,1,1]
v_pk_fma_f32 v[58:59], v[58:59], v[24:25], v[24:25] op_sel:[0,1,1] op_sel_hi:[1,1,1]
v_cvt_pk_bf16_f32 v36, v68, v69
v_cvt_pk_bf16_f32 v37, v70, v71
v_cvt_pk_bf16_f32 v38, v84, v85
v_cvt_pk_bf16_f32 v39, v86, v87
MAA 128,112,128
buffer_store_dwordx4 v[36:39], v10, s[16:19], s62 offen offset:1024 sc1
MAA 128,116,144
TR 84,17,59136
v_rcp_f32 v40, v40
s_waitcnt lgkmcnt(15)
MAA 128,208,160
TR 86,17,59648
v_rcp_f32 v41, v41
MAA 128,212,176
TR 88,17,50720
v_rcp_f32 v42, v42
MAA 144,220,176
TR 90,17,51232
v_rcp_f32 v43, v43
MAA 144,216,160
TR 92,17,59168
v_rcp_f32 v56, v56
MAA 144,124,144
TR 94,17,59680
v_rcp_f32 v57, v57
MAA 144,120,128
v_rcp_f32 v58, v58
MAA 96,192,160
v_rcp_f32 v59, v59
MAA 96,196,176
v_exp_f32 v44, v44
MAA 112,204,176
v_exp_f32 v45, v45
MAA 112,200,160
v_lshrrev_b32 v69, 2, v0
v_min_u32 v69, 1, v69
v_lshlrev_b32 v69, 28, v69
v_lshl_add_u32 v68, v0, 7, v69
v_xor_b32 v69, 64, v0
v_min_u32 v69, 1, v69
v_lshlrev_b32 v70, 4, v69
v_sub_u32 v70, 16, v70
v_lshlrev_b32 v69, 28, v69
v_mov_b32 v71, 1
s_waitcnt lgkmcnt(0)
s_barrier
v_mov_b32 v84, 0
v_mov_b32 v85, 0
v_mov_b32 v86, 0
v_exp_f32 v46, v46
v_exp_f32 v47, v47
v_exp_f32 v60, v60
v_exp_f32 v61, v61
v_exp_f32 v62, v62
v_exp_f32 v63, v63
v_pk_mul_f32 v[72:73], v[72:73], v[40:41]
v_pk_mul_f32 v[74:75], v[74:75], v[42:43]
v_pk_mul_f32 v[88:89], v[88:89], v[56:57]
v_pk_mul_f32 v[90:91], v[90:91], v[58:59]
v_pk_mul_f32 v[128:129], v[128:129], v[96:97]
v_pk_mul_f32 v[96:97], v[96:97], v[28:29] op_sel_hi:[1,0]
v_pk_mul_f32 v[130:131], v[130:131], v[98:99]
v_pk_mul_f32 v[98:99], v[98:99], v[28:29] op_sel_hi:[1,0]
v_pk_mul_f32 v[144:145], v[144:145], v[112:113]
v_pk_mul_f32 v[112:113], v[112:113], v[28:29] op_sel_hi:[1,0]
v_pk_mul_f32 v[146:147], v[146:147], v[114:115]
v_pk_mul_f32 v[114:115], v[114:115], v[28:29] op_sel_hi:[1,0]
v_pk_fma_f32 v[44:45], v[44:45], v[26:27], v[26:27] op_sel:[0,1,1] op_sel_hi:[1,1,1]
v_pk_fma_f32 v[46:47], v[46:47], v[26:27], v[26:27] op_sel:[0,1,1] op_sel_hi:[1,1,1]
v_pk_fma_f32 v[60:61], v[60:61], v[26:27], v[26:27] op_sel:[0,1,1] op_sel_hi:[1,1,1]
v_pk_fma_f32 v[62:63], v[62:63], v[26:27], v[26:27] op_sel:[0,1,1] op_sel_hi:[1,1,1]
v_cvt_pk_bf16_f32 v40, v72, v73
v_cvt_pk_bf16_f32 v41, v74, v75
v_cvt_pk_bf16_f32 v42, v88, v89
v_cvt_pk_bf16_f32 v43, v90, v91
MAA 132,112,132
buffer_store_dwordx4 v[40:43], v11, s[16:19], s62 offen sc1
MAA 132,116,148
s_add_u32 m0, s59, 84480
v_rcp_f32 v44, v44
MAA 132,208,164
v_rcp_f32 v45, v45
MAA 132,212,180
v_rcp_f32 v46, v46
MAA 148,220,180
buffer_load_dwordx4 v18, s[28:31], s58 offen lds
MAA 148,216,164
v_rcp_f32 v47, v47
MAA 148,124,148
v_rcp_f32 v60, v60
MAA 148,120,132
v_rcp_f32 v61, v61
MAA 100,192,164
buffer_load_dwordx4 v19, s[28:31], s58 offen offset:1056 lds
MAA 100,196,180
s_add_u32 m0, s59, 92928
s_add_u32 s58, s99, 2555904
v_rcp_f32 v62, v62
MAA 116,204,180
v_rcp_f32 v63, v63
MAA 116,200,164
v_exp_f32 v96, v96
v_exp_f32 v97, v97
v_exp_f32 v98, v98
v_exp_f32 v99, v99
v_exp_f32 v112, v112
v_exp_f32 v113, v113
v_exp_f32 v114, v114
v_exp_f32 v115, v115
v_pk_mul_f32 v[76:77], v[76:77], v[44:45]
v_pk_mul_f32 v[78:79], v[78:79], v[46:47]
v_pk_mul_f32 v[92:93], v[92:93], v[60:61]
v_pk_mul_f32 v[94:95], v[94:95], v[62:63]
v_pk_mul_f32 v[132:133], v[132:133], v[100:101]
v_pk_mul_f32 v[100:101], v[100:101], v[28:29] op_sel:[0,1] op_sel_hi:[1,1]
v_pk_mul_f32 v[134:135], v[134:135], v[102:103]
v_pk_mul_f32 v[102:103], v[102:103], v[28:29] op_sel:[0,1] op_sel_hi:[1,1]
v_pk_mul_f32 v[148:149], v[148:149], v[116:117]
v_pk_mul_f32 v[116:117], v[116:117], v[28:29] op_sel:[0,1] op_sel_hi:[1,1]
v_pk_mul_f32 v[150:151], v[150:151], v[118:119]
v_pk_mul_f32 v[118:119], v[118:119], v[28:29] op_sel:[0,1] op_sel_hi:[1,1]
v_pk_fma_f32 v[96:97], v[96:97], v[20:21], v[20:21] op_sel:[0,1,1] op_sel_hi:[1,1,1]
v_pk_fma_f32 v[98:99], v[98:99], v[20:21], v[20:21] op_sel:[0,1,1] op_sel_hi:[1,1,1]
v_pk_fma_f32 v[112:113], v[112:113], v[20:21], v[20:21] op_sel:[0,1,1] op_sel_hi:[1,1,1]
v_pk_fma_f32 v[114:115], v[114:115], v[20:21], v[20:21] op_sel:[0,1,1] op_sel_hi:[1,1,1]
v_cvt_pk_bf16_f32 v44, v76, v77
v_cvt_pk_bf16_f32 v45, v78, v79
v_cvt_pk_bf16_f32 v46, v92, v93
v_cvt_pk_bf16_f32 v47, v94, v95
MAA 136,112,136
buffer_store_dwordx4 v[44:47], v11, s[16:19], s62 offen offset:1024 sc1
MAA 136,116,152
v_rcp_f32 v96, v96
MAA 136,208,168
v_rcp_f32 v97, v97
MAA 136,212,184
v_rcp_f32 v98, v98
MAA 152,220,184
buffer_load_dwordx4 v18, s[28:31], s58 offen lds
MAA 152,216,168
v_rcp_f32 v99, v99
MAA 152,124,152
v_rcp_f32 v112, v112
MAA 152,120,136
v_rcp_f32 v113, v113
MAA 104,192,168
buffer_load_dwordx4 v19, s[28:31], s58 offen offset:1056 lds
MAA 104,196,184
s_add_u32 m0, s59, 101376
s_add_u32 s58, s100, 2752512
v_rcp_f32 v114, v114
MAA 120,204,184
v_rcp_f32 v115, v115
MAA 120,200,168
v_exp_f32 v100, v100
v_exp_f32 v101, v101
v_exp_f32 v102, v102
v_exp_f32 v103, v103
v_exp_f32 v116, v116
v_exp_f32 v117, v117
v_exp_f32 v118, v118
v_exp_f32 v119, v119
v_pk_mul_f32 v[128:129], v[128:129], v[96:97]
v_pk_mul_f32 v[130:131], v[130:131], v[98:99]
v_pk_mul_f32 v[144:145], v[144:145], v[112:113]
v_pk_mul_f32 v[146:147], v[146:147], v[114:115]
v_pk_mul_f32 v[136:137], v[136:137], v[104:105]
v_pk_mul_f32 v[104:105], v[104:105], v[30:31] op_sel_hi:[1,0]
v_pk_mul_f32 v[138:139], v[138:139], v[106:107]
v_pk_mul_f32 v[106:107], v[106:107], v[30:31] op_sel_hi:[1,0]
v_pk_mul_f32 v[152:153], v[152:153], v[120:121]
v_pk_mul_f32 v[120:121], v[120:121], v[30:31] op_sel_hi:[1,0]
v_pk_mul_f32 v[154:155], v[154:155], v[122:123]
v_pk_mul_f32 v[122:123], v[122:123], v[30:31] op_sel_hi:[1,0]
v_pk_fma_f32 v[100:101], v[100:101], v[22:23], v[22:23] op_sel:[0,1,1] op_sel_hi:[1,1,1]
v_pk_fma_f32 v[102:103], v[102:103], v[22:23], v[22:23] op_sel:[0,1,1] op_sel_hi:[1,1,1]
v_pk_fma_f32 v[116:117], v[116:117], v[22:23], v[22:23] op_sel:[0,1,1] op_sel_hi:[1,1,1]
v_pk_fma_f32 v[118:119], v[118:119], v[22:23], v[22:23] op_sel:[0,1,1] op_sel_hi:[1,1,1]
v_cvt_pk_bf16_f32 v96, v128, v129
v_cvt_pk_bf16_f32 v97, v130, v131
v_cvt_pk_bf16_f32 v98, v144, v145
v_cvt_pk_bf16_f32 v99, v146, v147
MAA 140,112,140
buffer_store_dwordx4 v[96:99], v10, s[16:19], s63 offen sc1
MAA 140,116,156
v_rcp_f32 v100, v100
MAA 140,208,172
v_rcp_f32 v101, v101
MAA 140,212,188
v_rcp_f32 v102, v102
MAA 156,220,188
buffer_load_dwordx4 v18, s[28:31], s58 offen lds
MAA 156,216,172
v_rcp_f32 v103, v103
MAA 156,124,156
v_rcp_f32 v116, v116
MAA 156,120,140
v_rcp_f32 v117, v117
MAA 108,192,172
buffer_load_dwordx4 v19, s[28:31], s58 offen offset:1056 lds
MAA 108,196,188
s_add_u32 m0, s59, 109824
s_add_u32 s58, s100, 3014656
v_rcp_f32 v118, v118
MAA 124,204,188
v_rcp_f32 v119, v119
MAA 124,200,172
v_exp_f32 v104, v104
v_exp_f32 v105, v105
v_exp_f32 v106, v106
v_exp_f32 v107, v107
v_exp_f32 v120, v120
v_exp_f32 v121, v121
v_exp_f32 v122, v122
v_exp_f32 v123, v123
v_pk_mul_f32 v[132:133], v[132:133], v[100:101]
v_pk_mul_f32 v[134:135], v[134:135], v[102:103]
v_pk_mul_f32 v[148:149], v[148:149], v[116:117]
v_pk_mul_f32 v[150:151], v[150:151], v[118:119]
v_pk_mul_f32 v[140:141], v[140:141], v[108:109]
v_pk_mul_f32 v[108:109], v[108:109], v[30:31] op_sel:[0,1] op_sel_hi:[1,1]
v_pk_mul_f32 v[142:143], v[142:143], v[110:111]
v_pk_mul_f32 v[110:111], v[110:111], v[30:31] op_sel:[0,1] op_sel_hi:[1,1]
v_pk_mul_f32 v[156:157], v[156:157], v[124:125]
v_pk_mul_f32 v[124:125], v[124:125], v[30:31] op_sel:[0,1] op_sel_hi:[1,1]
v_pk_mul_f32 v[158:159], v[158:159], v[126:127]
v_pk_mul_f32 v[126:127], v[126:127], v[30:31] op_sel:[0,1] op_sel_hi:[1,1]
v_pk_fma_f32 v[104:105], v[104:105], v[24:25], v[24:25] op_sel:[0,1,1] op_sel_hi:[1,1,1]
v_pk_fma_f32 v[106:107], v[106:107], v[24:25], v[24:25] op_sel:[0,1,1] op_sel_hi:[1,1,1]
v_pk_fma_f32 v[120:121], v[120:121], v[24:25], v[24:25] op_sel:[0,1,1] op_sel_hi:[1,1,1]
v_pk_fma_f32 v[122:123], v[122:123], v[24:25], v[24:25] op_sel:[0,1,1] op_sel_hi:[1,1,1]
v_cvt_pk_bf16_f32 v100, v132, v133
v_cvt_pk_bf16_f32 v101, v134, v135
v_cvt_pk_bf16_f32 v102, v148, v149
v_cvt_pk_bf16_f32 v103, v150, v151
MAA 192,0,128
buffer_store_dwordx4 v[100:103], v10, s[16:19], s63 offen offset:1024 sc1
MAA 192,4,144
v_rcp_f32 v104, v104
MAA 192,32,160
s_waitcnt vmcnt(6)
s_barrier
v_rcp_f32 v105, v105
MAA 192,36,176
v_rcp_f32 v106, v106
MAA 208,44,176
buffer_atomic_add v71, v68, s[16:19], s72 offen offset:512
MAA 208,40,160
v_rcp_f32 v107, v107
MAA 208,12,144
v_rcp_f32 v120, v120
MAA 208,8,128
v_rcp_f32 v121, v121
MAA 160,16,160
buffer_load_dwordx4 v18, s[28:31], s58 offen lds
MAA 160,20,176
v_rcp_f32 v122, v122
MAA 176,28,176
v_rcp_f32 v123, v123
MAA 176,24,160
v_exp_f32 v108, v108
v_exp_f32 v109, v109
v_exp_f32 v110, v110
v_exp_f32 v111, v111
v_exp_f32 v124, v124
v_exp_f32 v125, v125
v_exp_f32 v126, v126
v_exp_f32 v127, v127
v_pk_mul_f32 v[136:137], v[136:137], v[104:105]
v_pk_mul_f32 v[138:139], v[138:139], v[106:107]
v_pk_mul_f32 v[152:153], v[152:153], v[120:121]
v_pk_mul_f32 v[154:155], v[154:155], v[122:123]
v_pk_mul_f32 v[192:193], v[192:193], v[160:161]
v_pk_mul_f32 v[160:161], v[160:161], v[28:29] op_sel_hi:[1,0]
v_pk_mul_f32 v[194:195], v[194:195], v[162:163]
v_pk_mul_f32 v[162:163], v[162:163], v[28:29] op_sel_hi:[1,0]
v_pk_mul_f32 v[208:209], v[208:209], v[176:177]
v_pk_mul_f32 v[176:177], v[176:177], v[28:29] op_sel_hi:[1,0]
v_pk_mul_f32 v[210:211], v[210:211], v[178:179]
v_pk_mul_f32 v[178:179], v[178:179], v[28:29] op_sel_hi:[1,0]
v_pk_fma_f32 v[108:109], v[108:109], v[26:27], v[26:27] op_sel:[0,1,1] op_sel_hi:[1,1,1]
v_pk_fma_f32 v[110:111], v[110:111], v[26:27], v[26:27] op_sel:[0,1,1] op_sel_hi:[1,1,1]
v_pk_fma_f32 v[124:125], v[124:125], v[26:27], v[26:27] op_sel:[0,1,1] op_sel_hi:[1,1,1]
v_pk_fma_f32 v[126:127], v[126:127], v[26:27], v[26:27] op_sel:[0,1,1] op_sel_hi:[1,1,1]
v_cvt_pk_bf16_f32 v104, v136, v137
v_cvt_pk_bf16_f32 v105, v138, v139
v_cvt_pk_bf16_f32 v106, v152, v153
v_cvt_pk_bf16_f32 v107, v154, v155
MAA 196,0,132
buffer_store_dwordx4 v[104:107], v11, s[16:19], s63 offen sc1
MAA 196,4,148
v_rcp_f32 v108, v108
MAA 196,32,164
v_rcp_f32 v109, v109
MAA 196,36,180
v_rcp_f32 v110, v110
MAA 212,44,180
buffer_load_dwordx4 v19, s[28:31], s58 offen offset:1056 lds
MAA 212,40,164
s_add_u32 m0, s59, 118272
s_add_u32 s58, s101, 3211264
v_rcp_f32 v111, v111
MAA 212,12,148
v_rcp_f32 v124, v124
MAA 212,8,132
v_rcp_f32 v125, v125
MAA 164,16,164
buffer_load_dwordx4 v18, s[28:31], s58 offen lds
MAA 164,20,180
v_rcp_f32 v126, v126
MAA 180,28,180
v_rcp_f32 v127, v127
MAA 180,24,164
v_exp_f32 v160, v160
v_exp_f32 v161, v161
v_exp_f32 v162, v162
v_exp_f32 v163, v163
v_exp_f32 v176, v176
v_exp_f32 v177, v177
v_exp_f32 v178, v178
v_exp_f32 v179, v179
v_pk_mul_f32 v[140:141], v[140:141], v[108:109]
v_pk_mul_f32 v[142:143], v[142:143], v[110:111]
v_pk_mul_f32 v[156:157], v[156:157], v[124:125]
v_pk_mul_f32 v[158:159], v[158:159], v[126:127]
v_pk_mul_f32 v[196:197], v[196:197], v[164:165]
v_pk_mul_f32 v[164:165], v[164:165], v[28:29] op_sel:[0,1] op_sel_hi:[1,1]
v_pk_mul_f32 v[198:199], v[198:199], v[166:167]
v_pk_mul_f32 v[166:167], v[166:167], v[28:29] op_sel:[0,1] op_sel_hi:[1,1]
v_pk_mul_f32 v[212:213], v[212:213], v[180:181]
v_pk_mul_f32 v[180:181], v[180:181], v[28:29] op_sel:[0,1] op_sel_hi:[1,1]
v_pk_mul_f32 v[214:215], v[214:215], v[182:183]
v_pk_mul_f32 v[182:183], v[182:183], v[28:29] op_sel:[0,1] op_sel_hi:[1,1]
v_pk_fma_f32 v[160:161], v[160:161], v[20:21], v[20:21] op_sel:[0,1,1] op_sel_hi:[1,1,1]
v_pk_fma_f32 v[162:163], v[162:163], v[20:21], v[20:21] op_sel:[0,1,1] op_sel_hi:[1,1,1]
v_pk_fma_f32 v[176:177], v[176:177], v[20:21], v[20:21] op_sel:[0,1,1] op_sel_hi:[1,1,1]
v_pk_fma_f32 v[178:179], v[178:179], v[20:21], v[20:21] op_sel:[0,1,1] op_sel_hi:[1,1,1]
v_cvt_pk_bf16_f32 v108, v140, v141
v_cvt_pk_bf16_f32 v109, v142, v143
v_cvt_pk_bf16_f32 v110, v156, v157
v_cvt_pk_bf16_f32 v111, v158, v159
MAA 200,0,136
buffer_store_dwordx4 v[108:111], v11, s[16:19], s63 offen offset:1024 sc1
MAA 200,4,152
v_rcp_f32 v160, v160
MAA 200,32,168
v_rcp_f32 v161, v161
MAA 200,36,184
v_rcp_f32 v162, v162
MAA 216,44,184
buffer_load_dwordx4 v19, s[28:31], s58 offen offset:1056 lds
MAA 216,40,168
s_add_u32 m0, s59, 126720
s_add_u32 s58, s101, 3473408
v_rcp_f32 v163, v163
MAA 216,12,152
v_rcp_f32 v176, v176
MAA 216,8,136
v_rcp_f32 v177, v177
MAA 168,16,168
buffer_load_dwordx4 v18, s[28:31], s58 offen lds
MAA 168,20,184
v_rcp_f32 v178, v178
MAA 184,28,184
v_rcp_f32 v179, v179
MAA 184,24,168
v_exp_f32 v164, v164
v_exp_f32 v165, v165
v_exp_f32 v166, v166
v_exp_f32 v167, v167
v_exp_f32 v180, v180
v_exp_f32 v181, v181
v_exp_f32 v182, v182
v_exp_f32 v183, v183
v_pk_mul_f32 v[192:193], v[192:193], v[160:161]
v_pk_mul_f32 v[194:195], v[194:195], v[162:163]
v_pk_mul_f32 v[208:209], v[208:209], v[176:177]
v_pk_mul_f32 v[210:211], v[210:211], v[178:179]
v_pk_mul_f32 v[200:201], v[200:201], v[168:169]
v_pk_mul_f32 v[168:169], v[168:169], v[30:31] op_sel_hi:[1,0]
v_pk_mul_f32 v[202:203], v[202:203], v[170:171]
v_pk_mul_f32 v[170:171], v[170:171], v[30:31] op_sel_hi:[1,0]
v_pk_mul_f32 v[216:217], v[216:217], v[184:185]
v_pk_mul_f32 v[184:185], v[184:185], v[30:31] op_sel_hi:[1,0]
v_pk_mul_f32 v[218:219], v[218:219], v[186:187]
v_pk_mul_f32 v[186:187], v[186:187], v[30:31] op_sel_hi:[1,0]
v_pk_fma_f32 v[164:165], v[164:165], v[22:23], v[22:23] op_sel:[0,1,1] op_sel_hi:[1,1,1]
v_pk_fma_f32 v[166:167], v[166:167], v[22:23], v[22:23] op_sel:[0,1,1] op_sel_hi:[1,1,1]
v_pk_fma_f32 v[180:181], v[180:181], v[22:23], v[22:23] op_sel:[0,1,1] op_sel_hi:[1,1,1]
v_pk_fma_f32 v[182:183], v[182:183], v[22:23], v[22:23] op_sel:[0,1,1] op_sel_hi:[1,1,1]
v_cvt_pk_bf16_f32 v160, v192, v193
v_cvt_pk_bf16_f32 v161, v194, v195
v_cvt_pk_bf16_f32 v162, v208, v209
v_cvt_pk_bf16_f32 v163, v210, v211
MAA 204,0,140
buffer_store_dwordx4 v[160:163], v10, s[16:19], s64 offen sc1
MAA 204,4,156
v_rcp_f32 v164, v164
MAA 204,32,172
v_rcp_f32 v165, v165
MAA 204,36,188
v_rcp_f32 v166, v166
MAA 220,44,188
buffer_atomic_add v84, v69, s[16:19], s73 offen offset:512 sc0
MAA 220,40,172
v_rcp_f32 v167, v167
MAA 220,12,156
v_rcp_f32 v180, v180
MAA 220,8,140
v_rcp_f32 v181, v181
MAA 172,16,172
buffer_load_dwordx4 v19, s[28:31], s58 offen offset:1056 lds
MAA 172,20,188
v_rcp_f32 v182, v182
MAA 188,28,188
v_rcp_f32 v183, v183
MAA 188,24,172
v_exp_f32 v168, v168
v_exp_f32 v169, v169
v_exp_f32 v170, v170
v_exp_f32 v171, v171
v_exp_f32 v184, v184
v_exp_f32 v185, v185
v_exp_f32 v186, v186
v_exp_f32 v187, v187
v_pk_mul_f32 v[196:197], v[196:197], v[164:165]
v_pk_mul_f32 v[198:199], v[198:199], v[166:167]
v_pk_mul_f32 v[212:213], v[212:213], v[180:181]
v_pk_mul_f32 v[214:215], v[214:215], v[182:183]
v_pk_mul_f32 v[204:205], v[204:205], v[172:173]
v_pk_mul_f32 v[172:173], v[172:173], v[30:31] op_sel:[0,1] op_sel_hi:[1,1]
v_pk_mul_f32 v[206:207], v[206:207], v[174:175]
v_pk_mul_f32 v[174:175], v[174:175], v[30:31] op_sel:[0,1] op_sel_hi:[1,1]
v_pk_mul_f32 v[220:221], v[220:221], v[188:189]
v_pk_mul_f32 v[188:189], v[188:189], v[30:31] op_sel:[0,1] op_sel_hi:[1,1]
v_pk_mul_f32 v[222:223], v[222:223], v[190:191]
v_pk_mul_f32 v[190:191], v[190:191], v[30:31] op_sel:[0,1] op_sel_hi:[1,1]
v_pk_fma_f32 v[168:169], v[168:169], v[24:25], v[24:25] op_sel:[0,1,1] op_sel_hi:[1,1,1]
v_pk_fma_f32 v[170:171], v[170:171], v[24:25], v[24:25] op_sel:[0,1,1] op_sel_hi:[1,1,1]
v_pk_fma_f32 v[184:185], v[184:185], v[24:25], v[24:25] op_sel:[0,1,1] op_sel_hi:[1,1,1]
v_pk_fma_f32 v[186:187], v[186:187], v[24:25], v[24:25] op_sel:[0,1,1] op_sel_hi:[1,1,1]
v_cvt_pk_bf16_f32 v164, v196, v197
v_cvt_pk_bf16_f32 v165, v198, v199
v_cvt_pk_bf16_f32 v166, v212, v213
v_cvt_pk_bf16_f32 v167, v214, v215
MAA 240,48,128
buffer_store_dwordx4 v[164:167], v10, s[16:19], s64 offen offset:1024 sc1
MAA 240,52,144
v_rcp_f32 v168, v168
MAA 240,80,160
v_rcp_f32 v169, v169
MAA 240,84,176
v_rcp_f32 v170, v170
MAA 248,92,176
buffer_atomic_add v85, v69, s[16:19], s73 offen offset:512 sc0
MAA 248,88,160
v_rcp_f32 v171, v171
MAA 248,60,144
v_rcp_f32 v184, v184
MAA 248,56,128
v_rcp_f32 v185, v185
MAA 224,64,160
v_rcp_f32 v186, v186
MAA 224,68,176
v_rcp_f32 v187, v187
MAA 232,76,176
v_exp_f32 v172, v172
MAA 232,72,160
v_exp_f32 v173, v173
v_exp_f32 v174, v174
v_exp_f32 v175, v175
v_exp_f32 v188, v188
v_exp_f32 v189, v189
v_exp_f32 v190, v190
v_exp_f32 v191, v191
v_pk_mul_f32 v[200:201], v[200:201], v[168:169]
v_pk_mul_f32 v[202:203], v[202:203], v[170:171]
v_pk_mul_f32 v[216:217], v[216:217], v[184:185]
v_pk_mul_f32 v[218:219], v[218:219], v[186:187]
v_pk_mul_f32 v[240:241], v[240:241], v[224:225]
v_pk_mul_f32 v[224:225], v[224:225], v[28:29] op_sel_hi:[1,0]
v_pk_mul_f32 v[242:243], v[242:243], v[226:227]
v_pk_mul_f32 v[226:227], v[226:227], v[28:29] op_sel_hi:[1,0]
v_pk_mul_f32 v[248:249], v[248:249], v[232:233]
v_pk_mul_f32 v[232:233], v[232:233], v[28:29] op_sel_hi:[1,0]
v_pk_mul_f32 v[250:251], v[250:251], v[234:235]
v_pk_mul_f32 v[234:235], v[234:235], v[28:29] op_sel_hi:[1,0]
v_pk_fma_f32 v[172:173], v[172:173], v[26:27], v[26:27] op_sel:[0,1,1] op_sel_hi:[1,1,1]
v_pk_fma_f32 v[174:175], v[174:175], v[26:27], v[26:27] op_sel:[0,1,1] op_sel_hi:[1,1,1]
v_pk_fma_f32 v[188:189], v[188:189], v[26:27], v[26:27] op_sel:[0,1,1] op_sel_hi:[1,1,1]
v_pk_fma_f32 v[190:191], v[190:191], v[26:27], v[26:27] op_sel:[0,1,1] op_sel_hi:[1,1,1]
v_cvt_pk_bf16_f32 v168, v200, v201
v_cvt_pk_bf16_f32 v169, v202, v203
v_cvt_pk_bf16_f32 v170, v216, v217
v_cvt_pk_bf16_f32 v171, v218, v219
MAA 244,48,132
buffer_store_dwordx4 v[168:171], v11, s[16:19], s64 offen sc1
MAA 244,52,148
v_rcp_f32 v172, v172
MAA 244,80,164
v_rcp_f32 v173, v173
MAA 244,84,180
v_rcp_f32 v174, v174
MAA 252,92,180
buffer_atomic_add v86, v69, s[16:19], s73 offen offset:512 sc0
MAA 252,88,164
v_rcp_f32 v175, v175
MAA 252,60,148
v_rcp_f32 v188, v188
MAA 252,56,132
v_rcp_f32 v189, v189
MAA 228,64,164
v_rcp_f32 v190, v190
MAA 228,68,180
v_rcp_f32 v191, v191
MAA 236,76,180
v_exp_f32 v224, v224
MAA 236,72,164
v_exp_f32 v225, v225
v_exp_f32 v226, v226
v_exp_f32 v227, v227
v_exp_f32 v232, v232
v_exp_f32 v233, v233
v_exp_f32 v234, v234
v_exp_f32 v235, v235
v_pk_mul_f32 v[204:205], v[204:205], v[172:173]
v_pk_mul_f32 v[206:207], v[206:207], v[174:175]
v_pk_mul_f32 v[220:221], v[220:221], v[188:189]
v_pk_mul_f32 v[222:223], v[222:223], v[190:191]
v_pk_mul_f32 v[244:245], v[244:245], v[228:229]
v_pk_mul_f32 v[228:229], v[228:229], v[28:29] op_sel:[0,1] op_sel_hi:[1,1]
v_pk_mul_f32 v[246:247], v[246:247], v[230:231]
v_pk_mul_f32 v[230:231], v[230:231], v[28:29] op_sel:[0,1] op_sel_hi:[1,1]
v_pk_mul_f32 v[252:253], v[252:253], v[236:237]
v_pk_mul_f32 v[236:237], v[236:237], v[28:29] op_sel:[0,1] op_sel_hi:[1,1]
v_pk_mul_f32 v[254:255], v[254:255], v[238:239]
v_pk_mul_f32 v[238:239], v[238:239], v[28:29] op_sel:[0,1] op_sel_hi:[1,1]
v_pk_fma_f32 v[224:225], v[224:225], v[20:21], v[20:21] op_sel:[0,1,1] op_sel_hi:[1,1,1]
v_pk_fma_f32 v[226:227], v[226:227], v[20:21], v[20:21] op_sel:[0,1,1] op_sel_hi:[1,1,1]
v_pk_fma_f32 v[232:233], v[232:233], v[20:21], v[20:21] op_sel:[0,1,1] op_sel_hi:[1,1,1]
v_pk_fma_f32 v[234:235], v[234:235], v[20:21], v[20:21] op_sel:[0,1,1] op_sel_hi:[1,1,1]
v_cvt_pk_bf16_f32 v172, v204, v205
v_cvt_pk_bf16_f32 v173, v206, v207
v_cvt_pk_bf16_f32 v174, v220, v221
v_cvt_pk_bf16_f32 v175, v222, v223
buffer_store_dwordx4 v[172:175], v11, s[16:19], s64 offen offset:1024 sc1
s_waitcnt vmcnt(6)
v_cmp_gt_u32 vcc, v70, v84
s_nop 0
s_cbranch_vccz .Lok66
s_waitcnt vmcnt(3)
v_cmp_gt_u32 vcc, v70, v85
s_nop 0
s_cbranch_vccz .Lok66
s_waitcnt vmcnt(1)
v_cmp_gt_u32 vcc, v70, v86
s_nop 0
s_cbranch_vccz .Lok66
s_mov_b32 s15, 0
.Lok66l:
v_mov_b32 v84, 0
buffer_atomic_add v84, v69, s[16:19], s73 offen offset:512 sc0
s_add_u32 s15, s15, 1
s_cmp_gt_u32 s15, 100000
s_waitcnt vmcnt(0)
s_cbranch_scc1 .Lok66
v_cmp_gt_u32 vcc, v70, v84
s_nop 0
s_cbranch_vccnz .Lok66l
.Lok66:
s_waitcnt vmcnt(5)
s_barrier
s_add_u32 s52, s76, 0
buffer_load_dwordx4 v[96:99], v4, s[16:19], s52 offen sc1
ds_read_b64_tr_b16 a[0:1], v7
TR 2,7,512
TR 4,7,32
TR 6,7,544
TR 8,7,64
TR 10,7,576
TR 12,7,96
buffer_load_dwordx4 v[100:103], v4, s[16:19], s52 offen offset:1024 sc1
s_add_u32 s52, s76, 65536
TR 14,7,608
TR 16,7,8448
TR 18,7,8960
TR 20,7,8480
TR 22,7,8992
TR 24,7,8512
buffer_load_dwordx4 v[104:107], v4, s[16:19], s52 offen sc1
TR 26,7,9024
TR 28,7,8544
TR 30,7,9056
v_rcp_f32 v224, v224
.Lpad35:
s_cbranch_execz .Lpad38
v_rcp_f32 v225, v225
v_rcp_f32 v226, v226
v_rcp_f32 v227, v227
v_rcp_f32 v232, v232
v_rcp_f32 v233, v233
v_rcp_f32 v234, v234
v_rcp_f32 v235, v235
v_exp_f32 v228, v228
v_exp_f32 v229, v229
v_exp_f32 v230, v230
v_exp_f32 v231, v231
v_exp_f32 v236, v236
v_exp_f32 v237, v237
v_exp_f32 v238, v238
v_exp_f32 v239, v239
v_pk_mul_f32 v[240:241], v[240:241], v[224:225]
buffer_load_dwordx4 v[108:111], v4, s[16:19], s52 offen offset:1024 sc1
s_add_u32 s52, s77, 114688
v_pk_mul_f32 v[242:243], v[242:243], v[226:227]
v_pk_mul_f32 v[248:249], v[248:249], v[232:233]
v_pk_mul_f32 v[250:251], v[250:251], v[234:235]
v_pk_fma_f32 v[228:229], v[228:229], v[22:23], v[22:23] op_sel:[0,1,1] op_sel_hi:[1,1,1]
v_pk_fma_f32 v[230:231], v[230:231], v[22:23], v[22:23] op_sel:[0,1,1] op_sel_hi:[1,1,1]
v_pk_fma_f32 v[236:237], v[236:237], v[22:23], v[22:23] op_sel:[0,1,1] op_sel_hi:[1,1,1]
v_pk_fma_f32 v[238:239], v[238:239], v[22:23], v[22:23] op_sel:[0,1,1] op_sel_hi:[1,1,1]
v_cvt_pk_bf16_f32 v224, v240, v241
v_cvt_pk_bf16_f32 v225, v242, v243
v_cvt_pk_bf16_f32 v226, v248, v249
v_cvt_pk_bf16_f32 v227, v250, v251
v_rcp_f32 v228, v228
v_rcp_f32 v229, v229
v_rcp_f32 v230, v230
v_rcp_f32 v231, v231
v_rcp_f32 v236, v236
v_rcp_f32 v237, v237
v_rcp_f32 v238, v238
v_rcp_f32 v239, v239
v_pk_mul_f32 v[244:245], v[244:245], v[228:229]
buffer_store_dwordx4 v[224:227], v10, s[16:19], s65 offen sc1
v_pk_mul_f32 v[246:247], v[246:247], v[230:231]
v_pk_mul_f32 v[252:253], v[252:253], v[236:237]
v_pk_mul_f32 v[254:255], v[254:255], v[238:239]
v_cvt_pk_bf16_f32 v228, v244, v245
v_cvt_pk_bf16_f32 v229, v246, v247
v_cvt_pk_bf16_f32 v230, v252, v253
v_cvt_pk_bf16_f32 v231, v254, v255
buffer_store_dwordx4 v[228:231], v10, s[16:19], s65 offen offset:1024 sc1
buffer_load_dwordx4 v[112:115], v4, s[16:19], s52 offen sc1
buffer_load_dwordx4 v[116:119], v4, s[16:19], s52 offen offset:1024 sc1
s_add_u32 s52, s77, 180224
buffer_load_dwordx4 v[120:123], v4, s[16:19], s52 offen sc1
buffer_load_dwordx4 v[124:127], v4, s[16:19], s52 offen offset:1024 sc1
v_mov_b32 v21, v68
v_mov_b32 v22, v69
v_mov_b32 v23, v70
v_mov_b32 v24, v71
v_mov_b32 v25, 0
v_mov_b32 v27, 0
s_waitcnt vmcnt(6) lgkmcnt(0)
s_barrier
v_mfma_f32_16x16x32_bf16 v[32:35], a[0:3], v[96:99], 0
ds_read_b64_tr_b16 a[32:33], v6
s_add_u32 s52, s78, 229376
MAV 32,16,104
buffer_load_dwordx4 v[128:131], v4, s[16:19], s52 offen sc1
v_mfma_f32_16x16x32_bf16 v[48:51], a[0:3], v[100:103], 0
TR 34,6,512
MAV 48,16,108
TR 36,6,32
TR 38,6,544
v_mfma_f32_16x16x32_bf16 v[52:55], a[4:7], v[100:103], 0
TR 48,6,8448
MAV 52,20,108
buffer_load_dwordx4 v[132:135], v4, s[16:19], s52 offen offset:1024 sc1
v_mfma_f32_16x16x32_bf16 v[36:39], a[4:7], v[96:99], 0
TR 50,6,8960
MAV 36,20,104
TR 52,6,8480
TR 54,6,8992
v_mfma_f32_16x16x32_bf16 v[40:43], a[8:11], v[96:99], 0
TR 40,6,64
s_add_u32 s52, s78, 294912
MAV 40,24,104
buffer_load_dwordx4 v[136:139], v4, s[16:19], s52 offen sc1
v_mfma_f32_16x16x32_bf16 v[56:59], a[8:11], v[100:103], 0
TR 42,6,576
MAV 56,24,108
TR 44,6,96
TR 46,6,608
v_mfma_f32_16x16x32_bf16 v[60:63], a[12:15], v[100:103], 0
TR 56,6,8512
MAV 60,28,108
buffer_load_dwordx4 v[140:143], v4, s[16:19], s52 offen offset:1024 sc1
v_mfma_f32_16x16x32_bf16 v[44:47], a[12:15], v[96:99], 0
TR 58,6,9024
MAV 44,28,104
TR 60,6,8544
TR 62,6,9056
s_waitcnt lgkmcnt(8)
v_mfma_f32_16x16x32_bf16 v[64:67], a[32:35], v[96:99], 0
TR 0,7,16896
s_add_u32 s52, s79, 344064
MAV 64,48,104
buffer_load_dwordx4 v[144:147], v4, s[16:19], s52 offen sc1
v_mfma_f32_16x16x32_bf16 v[80:83], a[32:35], v[100:103], 0
TR 2,7,17408
MAV 80,48,108
TR 4,7,16928
TR 6,7,17440
v_mfma_f32_16x16x32_bf16 v[84:87], a[36:39], v[100:103], 0
TR 16,7,25344
MAV 84,52,108
buffer_load_dwordx4 v[148:151], v4, s[16:19], s52 offen offset:1024 sc1
v_mfma_f32_16x16x32_bf16 v[68:71], a[36:39], v[96:99], 0
TR 18,7,25856
MAV 68,52,104
TR 20,7,25376
TR 22,7,25888
s_waitcnt lgkmcnt(8)
v_mfma_f32_16x16x32_bf16 v[72:75], a[40:43], v[96:99], 0
TR 8,7,16960
s_add_u32 s52, s79, 409600
MAV 72,56,104
buffer_load_dwordx4 v[152:155], v4, s[16:19], s52 offen sc1
v_mfma_f32_16x16x32_bf16 v[88:91], a[40:43], v[100:103], 0
TR 10,7,17472
MAV 88,56,108
TR 12,7,16992
TR 14,7,17504
v_mfma_f32_16x16x32_bf16 v[92:95], a[44:47], v[100:103], 0
TR 24,7,25408
MAV 92,60,108
buffer_load_dwordx4 v[156:159], v4, s[16:19], s52 offen offset:1024 sc1
v_mfma_f32_16x16x32_bf16 v[76:79], a[44:47], v[96:99], 0
TR 26,7,25920
MAV 76,60,104
TR 28,7,25440
TR 30,7,25952
s_waitcnt vmcnt(8) lgkmcnt(8)
s_barrier
MAV 32,0,112
TR 32,6,16896
MAV 32,16,120
buffer_atomic_add v24, v21, s[16:19], s72 offen
MAV 48,16,124
TR 34,6,17408
MAV 48,0,116
TR 36,6,16928
TR 38,6,17440
TR 48,6,25344
MAV 52,4,116
TR 50,6,25856
s_add_u32 m0, s55, 0
MAV 52,20,124
buffer_load_dwordx4 v18, s[28:31], s54 offen lds
MAV 36,20,120
TR 52,6,25376
MAV 36,4,112
TR 54,6,25888
TR 40,6,16960
s_waitcnt lgkmcnt(9)
MAV 40,8,112
TR 42,6,17472
s_add_u32 s52, s76, 458752
MAV 40,24,120
buffer_load_dwordx4 v[96:99], v4, s[16:19], s52 offen sc1
MAV 56,24,124
TR 44,6,16992
MAV 56,8,116
buffer_load_dwordx4 v19, s[28:31], s54 offen offset:1056 lds
MAV 60,12,116
TR 46,6,17504
s_add_u32 s54, s98, 327680
MAV 60,28,124
buffer_load_dwordx4 v[100:103], v4, s[16:19], s52 offen offset:1024 sc1
MAV 44,28,120
TR 56,6,25408
MAV 44,12,112
TR 58,6,25920
TR 60,6,25440
TR 62,6,25952
s_waitcnt lgkmcnt(8)
MAV 64,32,112
TR 0,7,33792
s_add_u32 m0, s55, 8448
MAV 64,48,120
buffer_load_dwordx4 v18, s[28:31], s54 offen lds
MAV 80,48,124
TR 2,7,34304
MAV 80,32,116
TR 4,7,33824
TR 6,7,34336
MAV 84,36,116
TR 16,7,42240
s_add_u32 s52, s76, 524288
MAV 84,52,124
buffer_load_dwordx4 v[104:107], v4, s[16:19], s52 offen sc1
MAV 68,52,120
TR 18,7,42752
MAV 68,36,112
TR 20,7,42272
TR 22,7,42784
s_waitcnt lgkmcnt(8)
MAV 72,40,112
TR 8,7,33856
MAV 72,56,120
buffer_load_dwordx4 v19, s[28:31], s54 offen offset:1056 lds
MAV 88,56,124
TR 10,7,34368
s_add_u32 s54, s99, 524288
MAV 88,40,116
TR 12,7,33888
TR 14,7,34400
MAV 92,44,116
TR 24,7,42304
MAV 92,60,124
buffer_load_dwordx4 v[108:111], v4, s[16:19], s52 offen offset:1024 sc1
MAV 76,60,120
TR 26,7,42816
MAV 76,44,112
TR 28,7,42336
TR 30,7,42848
s_waitcnt vmcnt(13) lgkmcnt(8)
s_barrier
MAV 32,0,128
TR 32,6,33792
s_add_u32 m0, s55, 16896
MAV 32,16,136
buffer_load_dwordx4 v18, s[28:31], s54 offen lds
MAV 48,16,140
TR 34,6,34304
MAV 48,0,132
TR 36,6,33824
TR 38,6,34336
MAV 52,4,132
TR 48,6,42240
s_add_u32 s52, s77, 573440
MAV 52,20,140
buffer_load_dwordx4 v[112:115], v4, s[16:19], s52 offen sc1
MAV 36,20,136
TR 50,6,42752
MAV 36,4,128
TR 52,6,42272
TR 54,6,42784
s_waitcnt lgkmcnt(8)
MAV 40,8,128
TR 40,6,33856
MAV 40,24,136
buffer_load_dwordx4 v19, s[28:31], s54 offen offset:1056 lds
MAV 56,24,140
TR 42,6,34368
s_add_u32 s54, s99, 786432
MAV 56,8,132
TR 44,6,33888
TR 46,6,34400
MAV 60,12,132
TR 56,6,42304
MAV 60,28,140
buffer_load_dwordx4 v[116:119], v4, s[16:19], s52 offen offset:1024 sc1
MAV 44,28,136
TR 58,6,42816
MAV 44,12,128
TR 60,6,42336
TR 62,6,42848
s_waitcnt lgkmcnt(8)
MAV 64,32,128
TR 0,7,50688
s_add_u32 m0, s55, 25344
MAV 64,48,136
buffer_load_dwordx4 v18, s[28:31], s54 offen lds
MAV 80,48,140
TR 2,7,51200
MAV 80,32,132
TR 4,7,50720
TR 6,7,51232
TR 16,7,59136
MAV 84,36,132
TR 18,7,59648
s_add_u32 s52, s77, 638976
MAV 84,52,140
buffer_load_dwordx4 v[120:123], v4, s[16:19], s52 offen sc1
MAV 68,52,136
TR 20,7,59168
MAV 68,36,128
TR 22,7,59680
TR 8,7,50752
s_waitcnt lgkmcnt(9)
MAV 72,40,128
TR 10,7,51264
MAV 72,56,136
buffer_load_dwordx4 v19, s[28:31], s54 offen offset:1056 lds
MAV 88,56,140
TR 12,7,50784
s_add_u32 s54, s100, 983040
MAV 88,40,132
buffer_load_dwordx4 v[124:127], v4, s[16:19], s52 offen offset:1024 sc1
MAV 92,44,132
TR 14,7,51296
MAV 92,60,140
buffer_atomic_add v25, v22, s[16:19], s73 offen sc0
MAV 76,60,136
TR 24,7,59200
MAV 76,44,128
TR 26,7,59712
TR 28,7,59232
TR 30,7,59744
s_waitcnt vmcnt(18) lgkmcnt(8)
s_barrier
MAV 32,0,144
TR 32,6,50688
s_add_u32 m0, s55, 33792
MAV 32,16,152
buffer_load_dwordx4 v18, s[28:31], s54 offen lds
MAV 48,16,156
TR 34,6,51200
MAV 48,0,148
TR 36,6,50720
TR 38,6,51232
MAV 52,4,148
TR 48,6,59136
s_add_u32 s52, s78, 688128
MAV 52,20,156
buffer_load_dwordx4 v[128:131], v4, s[16:19], s52 offen sc1
MAV 36,20,152
TR 50,6,59648
MAV 36,4,144
TR 52,6,59168
TR 54,6,59680
s_waitcnt lgkmcnt(8)
MAV 40,8,144
TR 40,6,50752
MAV 40,24,152
buffer_load_dwordx4 v19, s[28:31], s54 offen offset:1056 lds
MAV 56,24,156
TR 42,6,51264
s_add_u32 s54, s100, 1245184
MAV 56,8,148
TR 44,6,50784
TR 46,6,51296
MAV 60,12,148
TR 56,6,59200
MAV 60,28,156
buffer_load_dwordx4 v[132:135], v4, s[16:19], s52 offen offset:1024 sc1
MAV 44,28,152
TR 58,6,59712
MAV 44,12,144
TR 60,6,59232
TR 62,6,59744
v_add_u32 v7, s57, v7
v_add_u32 v6, s57, v6
s_sub_u32 s57, 0, s57
s_waitcnt lgkmcnt(8)
MAV 64,32,144
ds_read_b64_tr_b16 a[0:1], v7
s_add_u32 m0, s55, 42240
MAV 64,48,152
buffer_load_dwordx4 v18, s[28:31], s54 offen lds
MAV 80,48,156
TR 2,7,512
MAV 80,32,148
TR 4,7,32
TR 6,7,544
MAV 84,36,148
TR 16,7,8448
s_add_u32 s52, s78, 753664
MAV 84,52,156
buffer_load_dwordx4 v[136:139], v4, s[16:19], s52 offen sc1
MAV 68,52,152
TR 18,7,8960
MAV 68,36,144
TR 20,7,8480
TR 22,7,8992
s_waitcnt lgkmcnt(8)
MAV 72,40,144
TR 8,7,64
MAV 72,56,152
buffer_load_dwordx4 v19, s[28:31], s54 offen offset:1056 lds
MAV 88,56,156
TR 10,7,576
s_add_u32 s54, s101, 1441792
MAV 88,40,148
TR 12,7,96
TR 14,7,608
MAV 92,44,148
TR 24,7,8512
MAV 92,60,156
buffer_load_dwordx4 v[140:143], v4, s[16:19], s52 offen offset:1024 sc1
MAV 76,60,152
TR 26,7,9024
MAV 76,44,144
TR 28,7,8544
TR 30,7,9056
s_waitcnt vmcnt(17) lgkmcnt(8)
s_barrier
MAV 32,0,96
ds_read_b64_tr_b16 a[32:33], v6
s_add_u32 m0, s55, 50688
MAV 32,16,104
buffer_load_dwordx4 v18, s[28:31], s54 offen lds
MAV 48,16,108
TR 34,6,512
MAV 48,0,100
TR 36,6,32
TR 38,6,544
TR 48,6,8448
MAV 52,4,100
TR 50,6,8960
s_add_u32 s52, s79, 802816
MAV 52,20,108
buffer_load_dwordx4 v[144:147], v4, s[16:19], s52 offen sc1
MAV 36,20,104
TR 52,6,8480
MAV 36,4,96
TR 54,6,8992
TR 40,6,64
s_waitcnt lgkmcnt(9)
MAV 40,8,96
TR 42,6,576
MAV 40,24,104
buffer_load_dwordx4 v19, s[28:31], s54 offen offset:1056 lds
MAV 56,24,108
TR 44,6,96
s_add_u32 s54, s101, 1703936
MAV 56,8,100
buffer_load_dwordx4 v[148:151], v4, s[16:19], s52 offen offset:1024 sc1
MAV 60,12,100
TR 46,6,608
MAV 60,28,108
buffer_atomic_add v27, v22, s[16:19], s73 offen sc0
MAV 44,28,104
TR 56,6,8512
MAV 44,12,96
TR 58,6,9024
TR 60,6,8544
TR 62,6,9056
s_waitcnt lgkmcnt(8)
MAV 64,32,96
TR 0,7,16896
s_add_u32 m0, s55, 59136
MAV 64,48,104
buffer_load_dwordx4 v18, s[28:31], s54 offen lds
MAV 80,48,108
TR 2,7,17408
MAV 80,32,100
TR 4,7,16928
TR 6,7,17440
MAV 84,36,100
TR 16,7,25344
s_add_u32 s52, s79, 868352
MAV 84,52,108
buffer_load_dwordx4 v[152:155], v4, s[16:19], s52 offen sc1
MAV 68,52,104
TR 18,7,25856
MAV 68,36,96
TR 20,7,25376
TR 22,7,25888
s_waitcnt lgkmcnt(8)
MAV 72,40,96
TR 8,7,16960
MAV 72,56,104
buffer_load_dwordx4 v19, s[28:31], s54 offen offset:1056 lds
MAV 88,56,108
TR 10,7,17472
s_add_u32 s54, s98, 1900544
MAV 88,40,100
TR 12,7,16992
TR 14,7,17504
MAV 92,44,100
TR 24,7,25408
MAV 92,60,108
buffer_load_dwordx4 v[156:159], v4, s[16:19], s52 offen offset:1024 sc1
MAV 76,60,104
TR 26,7,25920
MAV 76,44,96
TR 28,7,25440
TR 30,7,25952
s_waitcnt vmcnt(17)
v_cmp_gt_u32 vcc, v23, v25
s_nop 0
s_cbranch_vccz .Lok67
s_waitcnt vmcnt(4)
v_cmp_gt_u32 vcc, v23, v27
s_nop 0
s_cbranch_vccz .Lok67
s_mov_b32 s15, 0
.Lok67l:
v_mov_b32 v25, 0
buffer_atomic_add v25, v22, s[16:19], s73 offen sc0
s_add_u32 s15, s15, 1
s_cmp_gt_u32 s15, 100000
s_waitcnt vmcnt(0)
s_cbranch_scc1 .Lok67
v_cmp_gt_u32 vcc, v23, v25
s_nop 0
s_cbranch_vccnz .Lok67l
.Lok67:
s_waitcnt lgkmcnt(8)
s_barrier
MAV 32,0,112
TR 32,6,16896
s_add_u32 m0, s55, 67584
MAV 32,16,120
buffer_load_dwordx4 v18, s[28:31], s54 offen lds
MAV 48,16,124
TR 34,6,17408
MAV 48,0,116
TR 36,6,16928
TR 38,6,17440
MAV 52,4,116
TR 48,6,25344
s_add_u32 s52, s76, 16384
MAV 52,20,124
buffer_load_dwordx4 v[96:99], v4, s[16:19], s52 offen sc1
MAV 36,20,120
TR 50,6,25856
MAV 36,4,112
TR 52,6,25376
TR 54,6,25888
s_waitcnt lgkmcnt(8)
MAV 40,8,112
TR 40,6,16960
MAV 40,24,120
buffer_load_dwordx4 v19, s[28:31], s54 offen offset:1056 lds
MAV 56,24,124
TR 42,6,17472
s_add_u32 s54, s98, 2162688
MAV 56,8,116
TR 44,6,16992
TR 46,6,17504
MAV 60,12,116
TR 56,6,25408
MAV 60,28,124
buffer_load_dwordx4 v[100:103], v4, s[16:19], s52 offen offset:1024 sc1
MAV 44,28,120
TR 58,6,25920
MAV 44,12,112
TR 60,6,25440
TR 62,6,25952
s_waitcnt lgkmcnt(8)
MAV 64,32,112
TR 0,7,33792
s_add_u32 m0, s55, 76032
MAV 64,48,120
buffer_load_dwordx4 v18, s[28:31], s54 offen lds
MAV 80,48,124
TR 2,7,34304
MAV 80,32,116
TR 4,7,33824
TR 6,7,34336
MAV 84,36,116
TR 16,7,42240
s_add_u32 s52, s76, 81920
.Lpad36:
s_cbranch_execz .Lpad39
MAV 84,52,124
buffer_load_dwordx4 v[104:107], v4, s[16:19], s52 offen sc1
MAV 68,52,120
TR 18,7,42752
MAV 68,36,112
TR 20,7,42272
TR 22,7,42784
s_waitcnt lgkmcnt(8)
MAV 72,40,112
TR 8,7,33856
MAV 72,56,120
buffer_load_dwordx4 v19, s[28:31], s54 offen offset:1056 lds
MAV 88,56,124
TR 10,7,34368
s_add_u32 s54, s99, 2359296
MAV 88,40,116
TR 12,7,33888
TR 14,7,34400
MAV 92,44,116
TR 24,7,42304
MAV 92,60,124
buffer_load_dwordx4 v[108:111], v4, s[16:19], s52 offen offset:1024 sc1
MAV 76,60,120
TR 26,7,42816
MAV 76,44,112
TR 28,7,42336
TR 30,7,42848
s_waitcnt vmcnt(17) lgkmcnt(8)
s_barrier
MAV 32,0,128
TR 32,6,33792
s_add_u32 m0, s55, 84480
MAV 32,16,136
buffer_load_dwordx4 v18, s[28:31], s54 offen lds
MAV 48,16,140
TR 34,6,34304
s_lshl_b32 s70, s2, 10
MAV 48,0,132
TR 36,6,33824
TR 38,6,34336
MAV 52,4,132
TR 48,6,42240
s_add_u32 s52, s77, 131072
MAV 52,20,140
buffer_load_dwordx4 v[112:115], v4, s[16:19], s52 offen sc1
MAV 36,20,136
TR 50,6,42752
s_lshl_b32 s62, s3, 7
MAV 36,4,128
TR 52,6,42272
TR 54,6,42784
s_waitcnt lgkmcnt(8)
MAV 40,8,128
TR 40,6,33856
s_add_u32 s70, s70, s62
MAV 40,24,136
buffer_load_dwordx4 v19, s[28:31], s54 offen offset:1056 lds
MAV 56,24,140
TR 42,6,34368
s_add_u32 s54, s99, 2621440
MAV 56,8,132
TR 44,6,33888
TR 46,6,34400
MAV 60,12,132
TR 56,6,42304
s_add_u32 s70, s70, 31457280
MAV 60,28,140
buffer_load_dwordx4 v[116:119], v4, s[16:19], s52 offen offset:1024 sc1
MAV 44,28,136
TR 58,6,42816
s_xor_b32 s71, s70, 1024
MAV 44,12,128
TR 60,6,42336
TR 62,6,42848
s_waitcnt lgkmcnt(8)
MAV 64,32,128
TR 0,7,50688
s_add_u32 m0, s55, 92928
MAV 64,48,136
buffer_load_dwordx4 v18, s[28:31], s54 offen lds
MAV 80,48,140
TR 2,7,51200
v_accvgpr_read_b32 v28, a224
MAV 80,32,132
TR 4,7,50720
TR 6,7,51232
MAV 84,36,132
TR 16,7,59136
s_add_u32 s52, s77, 196608
MAV 84,52,140
buffer_load_dwordx4 v[120:123], v4, s[16:19], s52 offen sc1
MAV 68,52,136
TR 18,7,59648
v_add_f32 v32, v32, v28
MAV 68,36,128
TR 20,7,59168
TR 22,7,59680
s_waitcnt lgkmcnt(8)
MAV 72,40,128
TR 8,7,50752
v_accvgpr_read_b32 v29, a225
MAV 72,56,136
buffer_load_dwordx4 v19, s[28:31], s54 offen offset:1056 lds
MAV 88,56,140
TR 10,7,51264
s_add_u32 s54, s100, 2818048
MAV 88,40,132
TR 12,7,50784
TR 14,7,51296
MAV 92,44,132
TR 24,7,59200
v_add_f32 v33, v33, v29
MAV 92,60,140
buffer_load_dwordx4 v[124:127], v4, s[16:19], s52 offen offset:1024 sc1
MAV 76,60,136
TR 26,7,59712
v_accvgpr_read_b32 v28, a226
MAV 76,44,128
TR 28,7,59232
TR 30,7,59744
s_waitcnt vmcnt(16) lgkmcnt(8)
s_barrier
MAV 32,0,144
TR 32,6,50688
s_add_u32 m0, s55, 101376
MAV 32,16,152
buffer_load_dwordx4 v18, s[28:31], s54 offen lds
MAV 48,16,156
TR 34,6,51200
v_min_u32 v26, 1, v1
MAV 48,0,148
TR 36,6,50720
TR 38,6,51232
MAV 52,4,148
TR 48,6,59136
s_add_u32 s52, s78, 245760
MAV 52,20,156
buffer_load_dwordx4 v[128:131], v4, s[16:19], s52 offen sc1
MAV 36,20,152
TR 50,6,59648
v_lshlrev_b32 v26, 28, v26
MAV 36,4,144
TR 52,6,59168
TR 54,6,59680
s_waitcnt lgkmcnt(8)
MAV 40,8,144
TR 40,6,50752
v_mov_b32 v30, 1
MAV 40,24,152
buffer_load_dwordx4 v19, s[28:31], s54 offen offset:1056 lds
MAV 56,24,156
TR 42,6,51264
s_add_u32 s54, s100, 3080192
MAV 56,8,148
TR 44,6,50784
TR 46,6,51296
MAV 60,12,148
TR 56,6,59200
v_mov_b32 v31, 0
MAV 60,28,156
buffer_load_dwordx4 v[132:135], v4, s[16:19], s52 offen offset:1024 sc1
MAV 44,28,152
TR 58,6,59712
s_lshl_b32 s68, s7, 18
MAV 44,12,144
TR 60,6,59232
TR 62,6,59744
v_add_u32 v7, s57, v7
v_add_u32 v6, s57, v6
s_sub_u32 s57, 0, s57
s_waitcnt lgkmcnt(8)
MAV 64,32,144
ds_read_b64_tr_b16 a[0:1], v7
s_add_u32 m0, s55, 109824
MAV 64,48,152
buffer_load_dwordx4 v18, s[28:31], s54 offen lds
MAV 80,48,156
TR 2,7,512
v_add_f32 v34, v34, v28
MAV 80,32,148
TR 4,7,32
TR 6,7,544
MAV 84,36,148
TR 16,7,8448
s_add_u32 s52, s78, 311296
MAV 84,52,156
buffer_load_dwordx4 v[136:139], v4, s[16:19], s52 offen sc1
MAV 68,52,152
TR 18,7,8960
v_accvgpr_read_b32 v29, a227
MAV 68,36,144
TR 20,7,8480
TR 22,7,8992
s_waitcnt lgkmcnt(8)
MAV 72,40,144
TR 8,7,64
v_add_f32 v35, v35, v29
MAV 72,56,152
buffer_load_dwordx4 v19, s[28:31], s54 offen offset:1056 lds
MAV 88,56,156
TR 10,7,576
s_add_u32 s54, s101, 3276800
MAV 88,40,148
TR 12,7,96
TR 14,7,608
MAV 92,44,148
TR 24,7,8512
v_accvgpr_read_b32 v28, a228
MAV 92,60,156
buffer_load_dwordx4 v[140:143], v4, s[16:19], s52 offen offset:1024 sc1
MAV 76,60,152
TR 26,7,9024
v_add_f32 v36, v36, v28
MAV 76,44,144
TR 28,7,8544
TR 30,7,9056
s_waitcnt vmcnt(16) lgkmcnt(8)
s_barrier
MAV 32,0,96
ds_read_b64_tr_b16 a[32:33], v6
s_add_u32 m0, s55, 118272
MAV 32,16,104
buffer_load_dwordx4 v18, s[28:31], s54 offen lds
MAV 48,16,108
TR 34,6,512
s_add_u32 s68, s68, 142606336
MAV 48,0,100
TR 36,6,32
TR 38,6,544
MAV 52,4,100
TR 48,6,8448
s_add_u32 s52, s79, 360448
MAV 52,20,108
buffer_load_dwordx4 v[144:147], v4, s[16:19], s52 offen sc1
MAV 36,20,104
TR 50,6,8960
s_xor_b32 s69, s68, 262144
MAV 36,4,96
TR 52,6,8480
TR 54,6,8992
s_waitcnt lgkmcnt(8)
MAV 40,8,96
TR 40,6,64
v_and_b32 v2, 1, v1
MAV 40,24,104
buffer_load_dwordx4 v19, s[28:31], s54 offen offset:1056 lds
MAV 56,24,108
TR 42,6,576
s_add_u32 s54, s101, 3538944
MAV 56,8,100
TR 44,6,96
TR 46,6,608
MAV 60,12,100
TR 56,6,8512
v_lshlrev_b32 v2, 4, v2
MAV 60,28,108
buffer_load_dwordx4 v[148:151], v4, s[16:19], s52 offen offset:1024 sc1
MAV 44,28,104
TR 58,6,9024
v_mov_b32 v224, 0x3f80
MAV 44,12,96
TR 60,6,8544
TR 62,6,9056
s_waitcnt lgkmcnt(8)
MAV 64,32,96
TR 0,7,16896
s_add_u32 m0, s55, 126720
MAV 64,48,104
buffer_load_dwordx4 v18, s[28:31], s54 offen lds
MAV 80,48,108
TR 2,7,17408
v_accvgpr_read_b32 v29, a229
MAV 80,32,100
TR 4,7,16928
TR 6,7,17440
MAV 84,36,100
TR 16,7,25344
s_add_u32 s52, s79, 425984
MAV 84,52,108
buffer_load_dwordx4 v[152:155], v4, s[16:19], s52 offen sc1
MAV 68,52,104
TR 18,7,25856
v_add_f32 v37, v37, v29
MAV 68,36,96
TR 20,7,25376
TR 22,7,25888
s_waitcnt lgkmcnt(8)
MAV 72,40,96
TR 8,7,16960
v_accvgpr_read_b32 v28, a230
MAV 72,56,104
buffer_load_dwordx4 v19, s[28:31], s54 offen offset:1056 lds
MAV 88,56,108
TR 10,7,17472
s_add_u32 s54, s98, 131072
MAV 88,40,100
TR 12,7,16992
TR 14,7,17504
MAV 92,44,100
TR 24,7,25408
v_add_f32 v38, v38, v28
MAV 92,60,108
buffer_load_dwordx4 v[156:159], v4, s[16:19], s52 offen offset:1024 sc1
MAV 76,60,104
TR 26,7,25920
v_accvgpr_read_b32 v29, a231
MAV 76,44,96
TR 28,7,25440
TR 30,7,25952
s_waitcnt vmcnt(16) lgkmcnt(8)
s_barrier
MAV 32,0,112
TR 32,6,16896
s_add_u32 m0, s55, 0
MAV 32,16,120
buffer_load_dwordx4 v18, s[28:31], s54 offen lds
MAV 48,16,124
TR 34,6,17408
v_lshlrev_b32 v2, v2, v224
MAV 48,0,116
TR 36,6,16928
TR 38,6,17440
MAV 52,4,116
TR 48,6,25344
s_add_u32 s52, s76, 475136
MAV 52,20,124
buffer_load_dwordx4 v[96:99], v4, s[16:19], s52 offen sc1
MAV 36,20,120
TR 50,6,25856
v_bfe_u32 v224, v1, 2, 2
MAV 36,4,112
TR 52,6,25376
TR 54,6,25888
s_waitcnt lgkmcnt(8)
MAV 40,8,112
TR 40,6,16960
v_lshrrev_b32 v225, 4, v1
MAV 40,24,120
buffer_load_dwordx4 v19, s[28:31], s54 offen offset:1056 lds
MAV 56,24,124
TR 42,6,17472
s_add_u32 s54, s98, 393216
MAV 56,8,116
TR 44,6,16992
TR 46,6,17504
MAV 60,12,116
TR 56,6,25408
v_cmp_eq_u32 vcc, v224, v225
MAV 60,28,124
buffer_load_dwordx4 v[100:103], v4, s[16:19], s52 offen offset:1024 sc1
MAV 44,28,120
TR 58,6,25920
v_cndmask_b32 v2, 0, v2, vcc
MAV 44,12,112
TR 60,6,25440
TR 62,6,25952
s_waitcnt lgkmcnt(8)
MAV 64,32,112
TR 0,7,33792
s_add_u32 m0, s55, 8448
MAV 64,48,120
buffer_load_dwordx4 v18, s[28:31], s54 offen lds
MAV 80,48,124
TR 2,7,34304
v_add_f32 v39, v39, v29
MAV 80,32,116
TR 4,7,33824
TR 6,7,34336
MAV 84,36,116
TR 16,7,42240
s_add_u32 s52, s76, 540672
MAV 84,52,124
buffer_load_dwordx4 v[104:107], v4, s[16:19], s52 offen sc1
MAV 68,52,120
TR 18,7,42752
v_accvgpr_read_b32 v28, a232
MAV 68,36,112
TR 20,7,42272
TR 22,7,42784
s_waitcnt lgkmcnt(8)
MAV 72,40,112
TR 8,7,33856
v_add_f32 v40, v40, v28
MAV 72,56,120
buffer_load_dwordx4 v19, s[28:31], s54 offen offset:1056 lds
MAV 88,56,124
TR 10,7,34368
s_add_u32 s54, s99, 589824
MAV 88,40,116
TR 12,7,33888
TR 14,7,34400
MAV 92,44,116
TR 24,7,42304
v_accvgpr_read_b32 v29, a233
MAV 92,60,124
buffer_load_dwordx4 v[108:111], v4, s[16:19], s52 offen offset:1024 sc1
MAV 76,60,120
TR 26,7,42816
v_add_f32 v41, v41, v29
MAV 76,44,112
TR 28,7,42336
TR 30,7,42848
s_waitcnt vmcnt(16) lgkmcnt(8)
s_barrier
MAV 32,0,128
TR 32,6,33792
s_add_u32 m0, s55, 16896
MAV 32,16,136
buffer_load_dwordx4 v18, s[28:31], s54 offen lds
MAV 48,16,140
TR 34,6,34304
v_and_b32 v224, 2, v1
MAV 48,0,132
TR 36,6,33824
TR 38,6,34336
MAV 52,4,132
TR 48,6,42240
s_add_u32 s52, s77, 589824
MAV 52,20,140
buffer_load_dwordx4 v[112:115], v4, s[16:19], s52 offen sc1
MAV 36,20,136
TR 50,6,42752
v_cmp_eq_u32 vcc, 0, v224
MAV 36,4,128
TR 52,6,42272
TR 54,6,42784
s_waitcnt lgkmcnt(8)
MAV 40,8,128
TR 40,6,33856
v_cndmask_b32 v226, 0, v2, vcc
MAV 40,24,136
buffer_load_dwordx4 v19, s[28:31], s54 offen offset:1056 lds
MAV 56,24,140
TR 42,6,34368
s_add_u32 s54, s99, 851968
MAV 56,8,132
TR 44,6,33888
TR 46,6,34400
MAV 60,12,132
TR 56,6,42304
v_cndmask_b32 v227, v2, 0, vcc
MAV 60,28,140
buffer_load_dwordx4 v[116:119], v4, s[16:19], s52 offen offset:1024 sc1
MAV 44,28,136
TR 58,6,42816
v_mov_b32 v224, 0
MAV 44,12,128
TR 60,6,42336
TR 62,6,42848
s_waitcnt lgkmcnt(8)
MAV 64,32,128
TR 0,7,50688
s_add_u32 m0, s55, 25344
MAV 64,48,136
buffer_load_dwordx4 v18, s[28:31], s54 offen lds
MAV 80,48,140
TR 2,7,51200
v_accvgpr_read_b32 v28, a234
MAV 80,32,132
TR 4,7,50720
TR 6,7,51232
MAV 84,36,132
TR 16,7,59136
s_add_u32 s52, s77, 655360
MAV 84,52,140
buffer_load_dwordx4 v[120:123], v4, s[16:19], s52 offen sc1
MAV 68,52,136
TR 18,7,59648
v_add_f32 v42, v42, v28
MAV 68,36,128
TR 20,7,59168
TR 22,7,59680
s_waitcnt lgkmcnt(8)
MAV 72,40,128
TR 8,7,50752
v_accvgpr_read_b32 v29, a235
MAV 72,56,136
buffer_load_dwordx4 v19, s[28:31], s54 offen offset:1056 lds
MAV 88,56,140
TR 10,7,51264
s_add_u32 s54, s100, 1048576
MAV 88,40,132
TR 12,7,50784
TR 14,7,51296
MAV 92,44,132
TR 24,7,59200
v_add_f32 v43, v43, v29
MAV 92,60,140
buffer_load_dwordx4 v[124:127], v4, s[16:19], s52 offen offset:1024 sc1
MAV 76,60,136
TR 26,7,59712
v_accvgpr_read_b32 v28, a236
MAV 76,44,128
TR 28,7,59232
TR 30,7,59744
s_waitcnt vmcnt(16) lgkmcnt(8)
s_barrier
MAV 32,0,144
TR 32,6,50688
s_add_u32 m0, s55, 33792
MAV 32,16,152
buffer_load_dwordx4 v18, s[28:31], s54 offen lds
MAV 48,16,156
TR 34,6,51200
v_mov_b32 v225, 0
MAV 48,0,148
TR 36,6,50720
TR 38,6,51232
MAV 52,4,148
TR 48,6,59136
s_add_u32 s52, s78, 704512
MAV 52,20,156
buffer_load_dwordx4 v[128:131], v4, s[16:19], s52 offen sc1
MAV 36,20,152
TR 50,6,59648
v_mov_b32 v228, 0
MAV 36,4,144
TR 52,6,59168
TR 54,6,59680
s_waitcnt lgkmcnt(8)
MAV 40,8,144
TR 40,6,50752
v_mov_b32 v229, 0
MAV 40,24,152
buffer_load_dwordx4 v19, s[28:31], s54 offen offset:1056 lds
MAV 56,24,156
TR 42,6,51264
s_add_u32 s54, s100, 1310720
MAV 56,8,148
TR 44,6,50784
TR 46,6,51296
MAV 60,12,148
TR 56,6,59200
s_lshr_b32 s62, s6, 1
MAV 60,28,156
buffer_load_dwordx4 v[132:135], v4, s[16:19], s52 offen offset:1024 sc1
MAV 44,28,152
TR 58,6,59712
s_lshl_b32 s62, s62, 8
MAV 44,12,144
TR 60,6,59232
TR 62,6,59744
v_add_u32 v7, s57, v7
v_add_u32 v6, s57, v6
s_sub_u32 s57, 0, s57
s_waitcnt lgkmcnt(8)
MAV 64,32,144
ds_read_b64_tr_b16 a[0:1], v7
.Lpad37:
s_cbranch_execz .Lnopoll63r
s_add_u32 m0, s55, 42240
MAV 64,48,152
buffer_load_dwordx4 v18, s[28:31], s54 offen lds
MAV 80,48,156
TR 2,7,512
v_add_f32 v44, v44, v28
MAV 80,32,148
TR 4,7,32
TR 6,7,544
MAV 84,36,148
TR 16,7,8448
s_add_u32 s52, s78, 770048
MAV 84,52,156
buffer_load_dwordx4 v[136:139], v4, s[16:19], s52 offen sc1
MAV 68,52,152
TR 18,7,8960
v_accvgpr_read_b32 v29, a237
MAV 68,36,144
TR 20,7,8480
TR 22,7,8992
s_waitcnt lgkmcnt(8)
MAV 72,40,144
TR 8,7,64
v_add_f32 v45, v45, v29
MAV 72,56,152
buffer_load_dwordx4 v19, s[28:31], s54 offen offset:1056 lds
MAV 88,56,156
TR 10,7,576
s_add_u32 s54, s101, 1507328
MAV 88,40,148
TR 12,7,96
TR 14,7,608
MAV 92,44,148
TR 24,7,8512
v_accvgpr_read_b32 v28, a238
MAV 92,60,156
buffer_load_dwordx4 v[140:143], v4, s[16:19], s52 offen offset:1024 sc1
MAV 76,60,152
TR 26,7,9024
v_add_f32 v46, v46, v28
MAV 76,44,144
TR 28,7,8544
TR 30,7,9056
s_waitcnt vmcnt(16) lgkmcnt(8)
s_barrier
MAV 32,0,96
ds_read_b64_tr_b16 a[32:33], v6
s_add_u32 m0, s55, 50688
MAV 32,16,104
buffer_load_dwordx4 v18, s[28:31], s54 offen lds
MAV 48,16,108
TR 34,6,512
s_and_b32 s67, s6, 1
MAV 48,0,100
TR 36,6,32
TR 38,6,544
MAV 52,4,100
TR 48,6,8448
s_add_u32 s52, s79, 819200
MAV 52,20,108
buffer_load_dwordx4 v[144:147], v4, s[16:19], s52 offen sc1
MAV 36,20,104
TR 50,6,8960
s_add_u32 s62, s62, s67
MAV 36,4,96
TR 52,6,8480
TR 54,6,8992
s_waitcnt lgkmcnt(8)
MAV 40,8,96
TR 40,6,64
s_lshl_b32 s62, s62, 11
MAV 40,24,104
buffer_load_dwordx4 v19, s[28:31], s54 offen offset:1056 lds
MAV 56,24,108
TR 42,6,576
s_add_u32 s54, s101, 1769472
MAV 56,8,100
TR 44,6,96
TR 46,6,608
MAV 60,12,100
TR 56,6,8512
s_lshl_b32 s63, s3, 17
MAV 60,28,108
buffer_load_dwordx4 v[148:151], v4, s[16:19], s52 offen offset:1024 sc1
MAV 44,28,104
TR 58,6,9024
s_add_u32 s62, s62, s63
MAV 44,12,96
TR 60,6,8544
TR 62,6,9056
s_waitcnt lgkmcnt(8)
MAV 64,32,96
TR 0,7,16896
s_add_u32 m0, s55, 59136
MAV 64,48,104
buffer_load_dwordx4 v18, s[28:31], s54 offen lds
MAV 80,48,108
TR 2,7,17408
v_accvgpr_read_b32 v29, a239
MAV 80,32,100
TR 4,7,16928
TR 6,7,17440
MAV 84,36,100
TR 16,7,25344
s_add_u32 s52, s79, 884736
MAV 84,52,108
buffer_load_dwordx4 v[152:155], v4, s[16:19], s52 offen sc1
MAV 68,52,104
TR 18,7,25856
v_add_f32 v47, v47, v29
MAV 68,36,96
TR 20,7,25376
TR 22,7,25888
s_waitcnt lgkmcnt(8)
MAV 72,40,96
TR 8,7,16960
v_accvgpr_read_b32 v28, a240
MAV 72,56,104
buffer_load_dwordx4 v19, s[28:31], s54 offen offset:1056 lds
MAV 88,56,108
TR 10,7,17472
s_add_u32 s54, s98, 1966080
MAV 88,40,100
TR 12,7,16992
TR 14,7,17504
MAV 92,44,100
TR 24,7,25408
v_add_f32 v48, v48, v28
MAV 92,60,108
buffer_load_dwordx4 v[156:159], v4, s[16:19], s52 offen offset:1024 sc1
MAV 76,60,104
TR 26,7,25920
v_accvgpr_read_b32 v29, a241
MAV 76,44,96
TR 28,7,25440
TR 30,7,25952
s_waitcnt vmcnt(16) lgkmcnt(8)
s_barrier
MAV 32,0,112
TR 32,6,16896
s_add_u32 m0, s55, 67584
MAV 32,16,120
buffer_load_dwordx4 v18, s[28:31], s54 offen lds
MAV 48,16,124
TR 34,6,17408
s_lshl_b32 s63, s7, 7
MAV 48,0,116
TR 36,6,16928
TR 38,6,17440
MAV 52,4,116
TR 48,6,25344
s_add_u32 s52, s76, 32768
MAV 52,20,124
buffer_load_dwordx4 v[96:99], v4, s[16:19], s52 offen sc1
MAV 36,20,120
TR 50,6,25856
s_add_u32 s62, s62, s63
MAV 36,4,112
TR 52,6,25376
TR 54,6,25888
s_waitcnt lgkmcnt(8)
MAV 40,8,112
TR 40,6,16960
s_mov_b32 s64, 0x8000
MAV 40,24,120
buffer_load_dwordx4 v19, s[28:31], s54 offen offset:1056 lds
MAV 56,24,124
TR 42,6,17472
s_add_u32 s54, s98, 2228224
MAV 56,8,116
TR 44,6,16992
TR 46,6,17504
MAV 60,12,116
TR 56,6,25408
v_lshrrev_b32 v21, 3, v1
MAV 60,28,124
buffer_load_dwordx4 v[100:103], v4, s[16:19], s52 offen offset:1024 sc1
MAV 44,28,120
TR 58,6,25920
v_and_b32 v2, 7, v1
MAV 44,12,112
TR 60,6,25440
TR 62,6,25952
s_waitcnt lgkmcnt(8)
MAV 64,32,112
TR 0,7,33792
s_add_u32 m0, s55, 76032
MAV 64,48,120
buffer_load_dwordx4 v18, s[28:31], s54 offen lds
MAV 80,48,124
TR 2,7,34304
v_add_f32 v49, v49, v29
MAV 80,32,116
TR 4,7,33824
TR 6,7,34336
MAV 84,36,116
TR 16,7,42240
s_add_u32 s52, s76, 98304
MAV 84,52,124
buffer_load_dwordx4 v[104:107], v4, s[16:19], s52 offen sc1
MAV 68,52,120
TR 18,7,42752
v_accvgpr_read_b32 v28, a242
MAV 68,36,112
TR 20,7,42272
TR 22,7,42784
s_waitcnt lgkmcnt(8)
MAV 72,40,112
TR 8,7,33856
v_add_f32 v50, v50, v28
MAV 72,56,120
buffer_load_dwordx4 v19, s[28:31], s54 offen offset:1056 lds
MAV 88,56,124
TR 10,7,34368
s_add_u32 s54, s99, 2424832
MAV 88,40,116
TR 12,7,33888
TR 14,7,34400
MAV 92,44,116
TR 24,7,42304
v_accvgpr_read_b32 v29, a243
MAV 92,60,124
buffer_load_dwordx4 v[108:111], v4, s[16:19], s52 offen offset:1024 sc1
MAV 76,60,120
TR 26,7,42816
v_add_f32 v51, v51, v29
MAV 76,44,112
TR 28,7,42336
TR 30,7,42848
s_waitcnt vmcnt(16) lgkmcnt(8)
s_barrier
MAV 32,0,128
TR 32,6,33792
s_add_u32 m0, s55, 84480
MAV 32,16,136
buffer_load_dwordx4 v18, s[28:31], s54 offen lds
MAV 48,16,140
TR 34,6,34304
v_lshlrev_b32 v2, 4, v2
MAV 48,0,132
TR 36,6,33824
TR 38,6,34336
MAV 52,4,132
TR 48,6,42240
s_add_u32 s52, s77, 147456
MAV 52,20,140
buffer_load_dwordx4 v[112:115], v4, s[16:19], s52 offen sc1
MAV 36,20,136
TR 50,6,42752
v_lshl_add_u32 v16, v21, 12, v2
MAV 36,4,128
TR 52,6,42272
TR 54,6,42784
s_waitcnt lgkmcnt(8)
MAV 40,8,128
TR 40,6,33856
v_add_u32 v16, s62, v16
MAV 40,24,136
buffer_load_dwordx4 v19, s[28:31], s54 offen offset:1056 lds
MAV 56,24,140
TR 42,6,34368
s_add_u32 s54, s99, 2686976
MAV 56,8,132
TR 44,6,33888
TR 46,6,34400
MAV 60,12,132
TR 56,6,42304
v_add_u32 v17, 0x10000, v16
MAV 60,28,140
buffer_load_dwordx4 v[116:119], v4, s[16:19], s52 offen offset:1024 sc1
MAV 44,28,136
TR 58,6,42816
s_mul_i32 s62, s3, 4608
MAV 44,12,128
TR 60,6,42336
TR 62,6,42848
s_waitcnt lgkmcnt(8)
MAV 64,32,128
TR 0,7,50688
s_add_u32 m0, s55, 92928
MAV 64,48,136
buffer_load_dwordx4 v18, s[28:31], s54 offen lds
MAV 80,48,140
TR 2,7,51200
v_accvgpr_read_b32 v28, a244
MAV 80,32,132
TR 4,7,50720
TR 6,7,51232
MAV 84,36,132
TR 16,7,59136
s_add_u32 s52, s77, 212992
MAV 84,52,140
buffer_load_dwordx4 v[120:123], v4, s[16:19], s52 offen sc1
MAV 68,52,136
TR 18,7,59648
v_add_f32 v52, v52, v28
MAV 68,36,128
TR 20,7,59168
TR 22,7,59680
s_waitcnt lgkmcnt(8)
MAV 72,40,128
TR 8,7,50752
v_accvgpr_read_b32 v29, a245
MAV 72,56,136
buffer_load_dwordx4 v19, s[28:31], s54 offen offset:1056 lds
MAV 88,56,140
TR 10,7,51264
s_add_u32 s54, s100, 2883584
MAV 88,40,132
TR 12,7,50784
TR 14,7,51296
MAV 92,44,132
TR 24,7,59200
v_add_f32 v53, v53, v29
MAV 92,60,140
buffer_load_dwordx4 v[124:127], v4, s[16:19], s52 offen offset:1024 sc1
MAV 76,60,136
TR 26,7,59712
v_accvgpr_read_b32 v28, a246
MAV 76,44,128
TR 28,7,59232
TR 30,7,59744
s_waitcnt vmcnt(16) lgkmcnt(8)
s_barrier
MAV 32,0,144
TR 32,6,50688
s_add_u32 m0, s55, 101376
MAV 32,16,152
buffer_load_dwordx4 v18, s[28:31], s54 offen lds
MAV 48,16,156
TR 34,6,51200
s_add_u32 s62, s62, 135168
MAV 48,0,148
TR 36,6,50720
TR 38,6,51232
MAV 52,4,148
TR 48,6,59136
s_add_u32 s52, s78, 262144
MAV 52,20,156
buffer_load_dwordx4 v[128:131], v4, s[16:19], s52 offen sc1
MAV 36,20,152
TR 50,6,59648
v_mul_u32_u24 v21, 144, v21
MAV 36,4,144
TR 52,6,59168
TR 54,6,59680
s_waitcnt lgkmcnt(8)
MAV 40,8,144
TR 40,6,50752
v_add3_u32 v21, v21, v2, s62
MAV 40,24,152
buffer_load_dwordx4 v19, s[28:31], s54 offen offset:1056 lds
MAV 56,24,156
TR 42,6,51264
s_add_u32 s54, s100, 3145728
MAV 56,8,148
TR 44,6,50784
TR 46,6,51296
MAV 60,12,148
TR 56,6,59200
v_and_b32 v20, 15, v1
MAV 60,28,156
buffer_load_dwordx4 v[132:135], v4, s[16:19], s52 offen offset:1024 sc1
MAV 44,28,152
TR 58,6,59712
v_mul_u32_u24 v20, 144, v20
MAV 44,12,144
TR 60,6,59232
TR 62,6,59744
v_add_u32 v7, s57, v7
v_add_u32 v6, s57, v6
s_sub_u32 s57, 0, s57
s_waitcnt lgkmcnt(8)
MAV 64,32,144
ds_read_b64_tr_b16 a[0:1], v7
s_add_u32 m0, s55, 109824
MAV 64,48,152
buffer_load_dwordx4 v18, s[28:31], s54 offen lds
MAV 80,48,156
TR 2,7,512
v_add_f32 v54, v54, v28
MAV 80,32,148
TR 4,7,32
TR 6,7,544
MAV 84,36,148
TR 16,7,8448
s_add_u32 s52, s78, 327680
MAV 84,52,156
buffer_load_dwordx4 v[136:139], v4, s[16:19], s52 offen sc1
MAV 68,52,152
TR 18,7,8960
v_accvgpr_read_b32 v29, a247
MAV 68,36,144
TR 20,7,8480
TR 22,7,8992
s_waitcnt lgkmcnt(8)
MAV 72,40,144
TR 8,7,64
v_add_f32 v55, v55, v29
MAV 72,56,152
buffer_load_dwordx4 v19, s[28:31], s54 offen offset:1056 lds
MAV 88,56,156
TR 10,7,576
s_add_u32 s54, s101, 3342336
MAV 88,40,148
TR 12,7,96
TR 14,7,608
MAV 92,44,148
TR 24,7,8512
v_accvgpr_read_b32 v28, a248
MAV 92,60,156
buffer_load_dwordx4 v[140:143], v4, s[16:19], s52 offen offset:1024 sc1
MAV 76,60,152
TR 26,7,9024
v_add_f32 v56, v56, v28
MAV 76,44,144
TR 28,7,8544
TR 30,7,9056
s_waitcnt vmcnt(16) lgkmcnt(8)
s_barrier
MAV 32,0,96
ds_read_b64_tr_b16 a[32:33], v6
s_add_u32 m0, s55, 118272
MAV 32,16,104
buffer_load_dwordx4 v18, s[28:31], s54 offen lds
MAV 48,16,108
TR 34,6,512
v_lshrrev_b32 v2, 4, v1
MAV 48,0,100
TR 36,6,32
TR 38,6,544
MAV 52,4,100
TR 48,6,8448
s_add_u32 s52, s79, 376832
MAV 52,20,108
buffer_load_dwordx4 v[144:147], v4, s[16:19], s52 offen sc1
MAV 36,20,104
TR 50,6,8960
v_lshlrev_b32 v2, 3, v2
MAV 36,4,96
TR 52,6,8480
TR 54,6,8992
s_waitcnt lgkmcnt(8)
MAV 40,8,96
TR 40,6,64
MAV 40,24,104
buffer_load_dwordx4 v19, s[28:31], s54 offen offset:1056 lds
MAV 56,24,108
TR 42,6,576
s_add_u32 s54, s101, 3604480
MAV 56,8,100
TR 44,6,96
TR 46,6,608
MAV 60,12,100
TR 56,6,8512
v_add3_u32 v20, v20, v2, s62
MAV 60,28,108
buffer_load_dwordx4 v[148:151], v4, s[16:19], s52 offen offset:1024 sc1
MAV 44,28,104
TR 58,6,9024
MAV 44,12,96
TR 60,6,8544
TR 62,6,9056
s_waitcnt lgkmcnt(8)
MAV 64,32,96
TR 0,7,16896
s_add_u32 m0, s55, 126720
MAV 64,48,104
buffer_load_dwordx4 v18, s[28:31], s54 offen lds
MAV 80,48,108
TR 2,7,17408
v_accvgpr_read_b32 v29, a249
MAV 80,32,100
TR 4,7,16928
TR 6,7,17440
MAV 84,36,100
TR 16,7,25344
s_add_u32 s52, s79, 442368
MAV 84,52,108
buffer_load_dwordx4 v[152:155], v4, s[16:19], s52 offen sc1
MAV 68,52,104
TR 18,7,25856
v_add_f32 v57, v57, v29
MAV 68,36,96
TR 20,7,25376
TR 22,7,25888
s_waitcnt lgkmcnt(8)
MAV 72,40,96
TR 8,7,16960
v_accvgpr_read_b32 v28, a250
MAV 72,56,104
buffer_load_dwordx4 v19, s[28:31], s54 offen offset:1056 lds
MAV 88,56,108
TR 10,7,17472
s_add_u32 s54, s98, 196608
MAV 88,40,100
TR 12,7,16992
TR 14,7,17504
MAV 92,44,100
TR 24,7,25408
v_add_f32 v58, v58, v28
MAV 92,60,108
buffer_load_dwordx4 v[156:159], v4, s[16:19], s52 offen offset:1024 sc1
MAV 76,60,104
TR 26,7,25920
v_accvgpr_read_b32 v29, a251
MAV 76,44,96
TR 28,7,25440
TR 30,7,25952
s_waitcnt vmcnt(16) lgkmcnt(8)
s_barrier
MAV 32,0,112
TR 32,6,16896
s_add_u32 m0, s55, 0
MAV 32,16,120
buffer_load_dwordx4 v18, s[28:31], s54 offen lds
MAV 48,16,124
TR 34,6,17408
MAV 48,0,116
TR 36,6,16928
TR 38,6,17440
MAV 52,4,116
TR 48,6,25344
s_add_u32 s52, s76, 491520
MAV 52,20,124
buffer_load_dwordx4 v[96:99], v4, s[16:19], s52 offen sc1
MAV 36,20,120
TR 50,6,25856
MAV 36,4,112
TR 52,6,25376
TR 54,6,25888
s_waitcnt lgkmcnt(8)
MAV 40,8,112
TR 40,6,16960
MAV 40,24,120
buffer_load_dwordx4 v19, s[28:31], s54 offen offset:1056 lds
MAV 56,24,124
TR 42,6,17472
s_add_u32 s54, s99, 655360
MAV 56,8,116
TR 44,6,16992
TR 46,6,17504
.Lpad38:
s_cbranch_execz .Lnopoll63r
MAV 60,12,116
TR 56,6,25408
MAV 60,28,124
buffer_load_dwordx4 v[100:103], v4, s[16:19], s52 offen offset:1024 sc1
MAV 44,28,120
TR 58,6,25920
MAV 44,12,112
TR 60,6,25440
TR 62,6,25952
s_waitcnt lgkmcnt(8)
MAV 64,32,112
TR 0,7,33792
s_add_u32 m0, s55, 8448
MAV 64,48,120
buffer_load_dwordx4 v18, s[28:31], s54 offen lds
MAV 80,48,124
TR 2,7,34304
v_add_f32 v59, v59, v29
MAV 80,32,116
TR 4,7,33824
TR 6,7,34336
MAV 84,36,116
TR 16,7,42240
s_add_u32 s52, s76, 557056
MAV 84,52,124
buffer_load_dwordx4 v[104:107], v4, s[16:19], s52 offen sc1
MAV 68,52,120
TR 18,7,42752
v_accvgpr_read_b32 v28, a252
MAV 68,36,112
TR 20,7,42272
TR 22,7,42784
s_waitcnt lgkmcnt(8)
MAV 72,40,112
TR 8,7,33856
v_add_f32 v60, v60, v28
MAV 72,56,120
buffer_load_dwordx4 v19, s[28:31], s54 offen offset:1056 lds
MAV 88,56,124
TR 10,7,34368
s_add_u32 s54, s100, 1114112
MAV 88,40,116
TR 12,7,33888
TR 14,7,34400
MAV 92,44,116
TR 24,7,42304
v_accvgpr_read_b32 v29, a253
MAV 92,60,124
buffer_load_dwordx4 v[108:111], v4, s[16:19], s52 offen offset:1024 sc1
MAV 76,60,120
TR 26,7,42816
v_add_f32 v61, v61, v29
MAV 76,44,112
TR 28,7,42336
TR 30,7,42848
s_waitcnt vmcnt(16) lgkmcnt(8)
s_barrier
MAV 32,0,128
TR 32,6,33792
s_add_u32 m0, s55, 16896
MAV 32,16,136
buffer_load_dwordx4 v18, s[28:31], s54 offen lds
MAV 48,16,140
TR 34,6,34304
MAV 48,0,132
TR 36,6,33824
TR 38,6,34336
MAV 52,4,132
TR 48,6,42240
s_add_u32 s52, s77, 606208
MAV 52,20,140
buffer_load_dwordx4 v[112:115], v4, s[16:19], s52 offen sc1
MAV 36,20,136
TR 50,6,42752
MAV 36,4,128
TR 52,6,42272
TR 54,6,42784
s_waitcnt lgkmcnt(8)
MAV 40,8,128
TR 40,6,33856
MAV 40,24,136
buffer_load_dwordx4 v19, s[28:31], s54 offen offset:1056 lds
MAV 56,24,140
TR 42,6,34368
s_add_u32 s54, s101, 1572864
MAV 56,8,132
TR 44,6,33888
TR 46,6,34400
MAV 60,12,132
TR 56,6,42304
MAV 60,28,140
buffer_load_dwordx4 v[116:119], v4, s[16:19], s52 offen offset:1024 sc1
MAV 44,28,136
TR 58,6,42816
MAV 44,12,128
TR 60,6,42336
TR 62,6,42848
s_waitcnt lgkmcnt(8)
MAV 64,32,128
TR 0,7,50688
s_add_u32 m0, s55, 25344
MAV 64,48,136
buffer_load_dwordx4 v18, s[28:31], s54 offen lds
MAV 80,48,140
TR 2,7,51200
v_accvgpr_read_b32 v28, a254
MAV 80,32,132
TR 4,7,50720
TR 6,7,51232
MAV 84,36,132
TR 16,7,59136
s_add_u32 s52, s77, 671744
MAV 84,52,140
buffer_load_dwordx4 v[120:123], v4, s[16:19], s52 offen sc1
MAV 68,52,136
TR 18,7,59648
v_add_f32 v62, v62, v28
MAV 68,36,128
TR 20,7,59168
TR 22,7,59680
s_waitcnt lgkmcnt(8)
MAV 72,40,128
TR 8,7,50752
v_accvgpr_read_b32 v29, a255
MAV 72,56,136
buffer_load_dwordx4 v19, s[28:31], s54 offen offset:1056 lds
MAV 88,56,140
TR 10,7,51264
s_add_u32 s54, s98, 2031616
MAV 88,40,132
TR 12,7,50784
TR 14,7,51296
MAV 92,44,132
TR 24,7,59200
v_add_f32 v63, v63, v29
MAV 92,60,140
buffer_load_dwordx4 v[124:127], v4, s[16:19], s52 offen offset:1024 sc1
MAV 76,60,136
TR 26,7,59712
MAV 76,44,128
TR 28,7,59232
TR 30,7,59744
s_waitcnt vmcnt(16) lgkmcnt(8)
s_barrier
MAV 32,0,144
TR 32,6,50688
s_add_u32 m0, s55, 33792
MAV 32,16,152
buffer_load_dwordx4 v18, s[28:31], s54 offen lds
MAV 48,16,156
TR 34,6,51200
MAV 48,0,148
TR 36,6,50720
TR 38,6,51232
MAV 52,4,148
TR 48,6,59136
s_add_u32 s52, s78, 720896
MAV 52,20,156
buffer_load_dwordx4 v[128:131], v4, s[16:19], s52 offen sc1
MAV 36,20,152
TR 50,6,59648
MAV 36,4,144
TR 52,6,59168
TR 54,6,59680
s_waitcnt lgkmcnt(8)
MAV 40,8,144
TR 40,6,50752
MAV 40,24,152
buffer_load_dwordx4 v19, s[28:31], s54 offen offset:1056 lds
MAV 56,24,156
TR 42,6,51264
s_add_u32 s54, s99, 2490368
MAV 56,8,148
TR 44,6,50784
TR 46,6,51296
MAV 60,12,148
TR 56,6,59200
MAV 60,28,156
buffer_load_dwordx4 v[132:135], v4, s[16:19], s52 offen offset:1024 sc1
MAV 44,28,152
TR 58,6,59712
MAV 44,12,144
TR 60,6,59232
TR 62,6,59744
v_add_u32 v7, s57, v7
v_add_u32 v6, s57, v6
s_sub_u32 s57, 0, s57
s_waitcnt lgkmcnt(8)
MAV 64,32,144
ds_read_b64_tr_b16 a[0:1], v6
s_add_u32 m0, s55, 42240
MAV 64,48,152
buffer_load_dwordx4 v18, s[28:31], s54 offen lds
MAV 80,48,156
TR 2,6,512
MAV 80,32,148
TR 4,6,32
TR 6,6,544
MAV 84,36,148
TR 16,6,8448
s_add_u32 s52, s78, 786432
MAV 84,52,156
buffer_load_dwordx4 v[136:139], v4, s[16:19], s52 offen sc1
MAV 68,52,152
TR 18,6,8960
MAV 68,36,144
TR 20,6,8480
TR 22,6,8992
s_waitcnt lgkmcnt(8)
MAV 72,40,144
TR 8,6,64
MAV 72,56,152
buffer_load_dwordx4 v19, s[28:31], s54 offen offset:1056 lds
MAV 88,56,156
TR 10,6,576
s_add_u32 s54, s100, 2949120
MAV 88,40,148
TR 12,6,96
TR 14,6,608
MAV 92,44,148
TR 24,6,8512
MAV 92,60,156
buffer_load_dwordx4 v[140:143], v4, s[16:19], s52 offen offset:1024 sc1
MAV 76,60,152
TR 26,6,9024
MAV 76,44,144
TR 28,6,8544
TR 30,6,9056
s_waitcnt vmcnt(16) lgkmcnt(8)
s_barrier
MAV 64,0,96
TR 32,6,16896
TR 34,6,17408
s_add_u32 m0, s55, 50688
MAV 64,16,104
TR 36,6,16928
buffer_load_dwordx4 v18, s[28:31], s54 offen lds
MAV 80,16,108
TR 38,6,17440
MAV 80,0,100
TR 48,6,25344
buffer_load_dwordx4 v19, s[28:31], s54 offen offset:1056 lds
MAV 84,4,100
TR 50,6,25856
s_add_u32 s54, s101, 3407872
s_add_u32 s52, s79, 835584
MAV 84,20,108
buffer_load_dwordx4 v[144:147], v4, s[16:19], s52 offen sc1
MAV 68,20,104
TR 52,6,25376
TR 54,6,25888
MAV 68,4,96
TR 40,6,16960
s_waitcnt lgkmcnt(9)
MAV 72,8,96
TR 42,6,17472
MAV 72,24,104
TR 44,6,16992
buffer_load_dwordx4 v[148:151], v4, s[16:19], s52 offen offset:1024 sc1
MAV 88,24,108
TR 46,6,17504
s_add_u32 m0, s55, 59136
MAV 88,8,100
TR 56,6,25408
buffer_load_dwordx4 v18, s[28:31], s54 offen lds
MAV 92,12,100
TR 58,6,25920
MAV 92,28,108
TR 60,6,25440
buffer_load_dwordx4 v19, s[28:31], s54 offen offset:1056 lds
MAV 76,28,104
TR 62,6,25952
s_add_u32 s52, s79, 901120
MAV 76,12,96
buffer_load_dwordx4 v[152:155], v4, s[16:19], s52 offen sc1
buffer_load_dwordx4 v[156:159], v4, s[16:19], s52 offen offset:1024 sc1
s_waitcnt vmcnt(16) lgkmcnt(8)
MAV 64,32,112
TR 0,6,33792
s_add_u32 s52, s76, 49152
MAV 64,48,120
buffer_load_dwordx4 v[160:163], v4, s[16:19], s52 offen sc1
MAV 80,48,124
TR 2,6,34304
MAV 80,32,116
TR 4,6,33824
TR 6,6,34336
MAV 84,36,116
TR 16,6,42240
MAV 84,52,124
buffer_load_dwordx4 v[164:167], v4, s[16:19], s52 offen offset:1024 sc1
MAV 68,52,120
TR 18,6,42752
MAV 68,36,112
TR 20,6,42272
TR 22,6,42784
s_waitcnt lgkmcnt(8)
MAV 72,40,112
TR 8,6,33856
s_add_u32 s52, s77, 163840
MAV 72,56,120
buffer_load_dwordx4 v[168:171], v4, s[16:19], s52 offen sc1
MAV 88,56,124
TR 10,6,34368
MAV 88,40,116
TR 12,6,33888
TR 14,6,34400
MAV 92,44,116
TR 24,6,42304
MAV 92,60,124
buffer_load_dwordx4 v[172:175], v4, s[16:19], s52 offen offset:1024 sc1
MAV 76,60,120
TR 26,6,42816
MAV 76,44,112
TR 28,6,42336
TR 30,6,42848
s_waitcnt vmcnt(12) lgkmcnt(8)
MAV 64,0,128
TR 32,6,50688
s_add_u32 s52, s78, 278528
MAV 64,16,136
buffer_load_dwordx4 v[176:179], v4, s[16:19], s52 offen sc1
MAV 80,16,140
TR 34,6,51200
MAV 80,0,132
TR 36,6,50720
TR 38,6,51232
MAV 84,4,132
TR 48,6,59136
MAV 84,20,140
buffer_load_dwordx4 v[180:183], v4, s[16:19], s52 offen offset:1024 sc1
MAV 68,20,136
TR 50,6,59648
MAV 68,4,128
TR 52,6,59168
TR 54,6,59680
s_waitcnt lgkmcnt(8)
MAV 72,8,128
TR 40,6,50752
s_add_u32 s52, s79, 393216
MAV 72,24,136
buffer_load_dwordx4 v[184:187], v4, s[16:19], s52 offen sc1
MAV 88,24,140
TR 42,6,51264
MAV 88,8,132
TR 44,6,50784
TR 46,6,51296
MAV 92,12,132
TR 56,6,59200
MAV 92,28,140
buffer_load_dwordx4 v[188:191], v4, s[16:19], s52 offen offset:1024 sc1
MAV 76,28,136
TR 58,6,59712
MAV 76,12,128
TR 60,6,59232
TR 62,6,59744
s_waitcnt vmcnt(8) lgkmcnt(8)
s_barrier
v_add_u32 v6, s57, v6
MAV 64,32,144
ds_read_b64_tr_b16 a[0:1], v6
s_add_u32 s52, s76, 507904
MAV 64,48,152
buffer_load_dwordx4 v[192:195], v4, s[16:19], s52 offen sc1
MAV 80,48,156
TR 2,6,512
MAV 80,32,148
TR 4,6,32
TR 6,6,544
MAV 84,36,148
TR 16,6,8448
MAV 84,52,156
buffer_load_dwordx4 v[196:199], v4, s[16:19], s52 offen offset:1024 sc1
MAV 68,52,152
TR 18,6,8960
MAV 68,36,144
TR 20,6,8480
TR 22,6,8992
s_waitcnt lgkmcnt(8)
MAV 72,40,144
TR 8,6,64
s_add_u32 s52, s77, 622592
MAV 72,56,152
buffer_load_dwordx4 v[200:203], v4, s[16:19], s52 offen sc1
MAV 88,56,156
TR 10,6,576
MAV 88,40,148
TR 12,6,96
TR 14,6,608
MAV 92,44,148
TR 24,6,8512
MAV 92,60,156
buffer_load_dwordx4 v[204:207], v4, s[16:19], s52 offen offset:1024 sc1
MAV 76,60,152
TR 26,6,9024
MAV 76,44,144
TR 28,6,8544
TR 30,6,9056
s_waitcnt vmcnt(8) lgkmcnt(8)
MAV 64,0,160
TR 32,6,16896
s_add_u32 s52, s78, 737280
MAV 64,16,168
buffer_load_dwordx4 v[208:211], v4, s[16:19], s52 offen sc1
MAV 80,16,172
TR 34,6,17408
MAV 80,0,164
TR 36,6,16928
TR 38,6,17440
MAV 84,4,164
TR 48,6,25344
MAV 84,20,172
buffer_load_dwordx4 v[212:215], v4, s[16:19], s52 offen offset:1024 sc1
MAV 68,20,168
TR 50,6,25856
MAV 68,4,160
TR 52,6,25376
TR 54,6,25888
s_waitcnt lgkmcnt(8)
MAV 72,8,160
TR 40,6,16960
s_add_u32 s52, s79, 851968
MAV 72,24,168
buffer_load_dwordx4 v[216:219], v4, s[16:19], s52 offen sc1
MAV 88,24,172
TR 42,6,17472
MAV 88,8,164
TR 44,6,16992
TR 46,6,17504
MAV 92,12,164
TR 56,6,25408
MAV 92,28,172
buffer_load_dwordx4 v[220:223], v4, s[16:19], s52 offen offset:1024 sc1
MAV 76,28,168
TR 58,6,25920
MAV 76,12,160
TR 60,6,25440
TR 62,6,25952
s_waitcnt vmcnt(8) lgkmcnt(8)
MAV 64,32,176
TR 0,6,33792
MAV 64,48,184
TR 2,6,34304
MAV 80,48,188
TR 4,6,33824
MAV 80,32,180
TR 6,6,34336
MAV 84,36,180
TR 16,6,42240
MAV 84,52,188
TR 18,6,42752
MAV 68,52,184
TR 20,6,42272
MAV 68,36,176
TR 22,6,42784
s_waitcnt lgkmcnt(8)
MAV 72,40,176
TR 8,6,33856
MAV 72,56,184
TR 10,6,34368
MAV 88,56,188
TR 12,6,33888
MAV 88,40,180
TR 14,6,34400
MAV 92,44,180
TR 24,6,42304
MAV 92,60,188
TR 26,6,42816
MAV 76,60,184
TR 28,6,42336
MAV 76,44,176
TR 30,6,42848
s_waitcnt vmcnt(4) lgkmcnt(8)
MAV 64,0,192
TR 32,6,50688
MAV 64,16,200
TR 34,6,51200
MAV 80,16,204
TR 36,6,50720
MAV 80,0,196
TR 38,6,51232
MAV 84,4,196
TR 48,6,59136
MAV 84,20,204
TR 50,6,59648
MAV 68,20,200
TR 52,6,59168
MAV 68,4,192
TR 54,6,59680
s_waitcnt lgkmcnt(8)
MAV 72,8,192
TR 40,6,50752
MAV 72,24,200
TR 42,6,51264
MAV 88,24,204
TR 44,6,50784
MAV 88,8,196
TR 46,6,51296
MAV 92,12,196
TR 56,6,59200
MAV 92,28,204
TR 58,6,59712
MAV 76,28,200
TR 60,6,59232
MAV 76,12,192
TR 62,6,59744
s_waitcnt vmcnt(0) lgkmcnt(8)
MAV 64,32,208
ds_read_b64_tr_b16 a[0:1], v7
MAV 64,48,216
TR 2,7,512
MAV 80,48,220
TR 4,7,32
MAV 80,32,212
TR 6,7,544
MAV 84,36,212
TR 16,7,8448
MAV 84,52,220
TR 18,7,8960
MAV 68,52,216
TR 20,7,8480
MAV 68,36,208
TR 22,7,8992
s_waitcnt lgkmcnt(8)
MAV 72,40,208
TR 8,7,64
MAV 72,56,216
TR 10,7,576
MAV 88,56,220
TR 12,7,96
MAV 88,40,212
.Lpad39:
s_cbranch_execz .Lnopoll63r
TR 14,7,608
MAV 92,44,212
TR 24,7,8512
MAV 92,60,220
TR 26,7,9024
MAV 76,60,216
TR 28,7,8544
MAV 76,44,208
TR 30,7,9056
s_waitcnt lgkmcnt(8)
MAV 32,0,96
TR 32,7,16896
v_cvt_pk_bf16_f32 v232, v64, v65
MAV 32,16,104
TR 34,7,17408
v_cvt_pk_bf16_f32 v233, v66, v67
v_cvt_pk_bf16_f32 v234, v68, v69
MAV 48,16,108
TR 36,7,16928
v_cvt_pk_bf16_f32 v235, v70, v71
MAV 48,0,100
TR 38,7,17440
buffer_store_dwordx4 v[232:235], v4, s[16:19], s69 offen sc1
s_add_u32 s69, s69, 131072
MAV 52,4,100
TR 48,7,25344
v_cvt_pk_bf16_f32 v236, v72, v73
MAV 52,20,108
TR 50,7,25856
v_cvt_pk_bf16_f32 v237, v74, v75
v_cvt_pk_bf16_f32 v238, v76, v77
MAV 36,20,104
TR 52,7,25376
v_cvt_pk_bf16_f32 v239, v78, v79
MAV 36,4,96
TR 54,7,25888
buffer_store_dwordx4 v[236:239], v4, s[16:19], s69 offen sc1
s_waitcnt lgkmcnt(8)
MAV 40,8,96
TR 40,7,16960
s_add_u32 s69, s69, -130048
MAV 40,24,104
TR 42,7,17472
v_cvt_pk_bf16_f32 v240, v80, v81
v_cvt_pk_bf16_f32 v241, v82, v83
MAV 56,24,108
TR 44,7,16992
v_cvt_pk_bf16_f32 v242, v84, v85
MAV 56,8,100
TR 46,7,17504
v_cvt_pk_bf16_f32 v243, v86, v87
buffer_store_dwordx4 v[240:243], v4, s[16:19], s69 offen sc1
MAV 60,12,100
TR 56,7,25408
s_add_u32 s69, s69, 131072
MAV 60,28,108
TR 58,7,25920
v_cvt_pk_bf16_f32 v244, v88, v89
v_cvt_pk_bf16_f32 v245, v90, v91
MAV 44,28,104
TR 60,7,25440
v_cvt_pk_bf16_f32 v246, v92, v93
MAV 44,12,96
TR 62,7,25952
v_cvt_pk_bf16_f32 v247, v94, v95
buffer_store_dwordx4 v[244:247], v4, s[16:19], s69 offen sc1
s_waitcnt lgkmcnt(8)
MAV 32,32,112
TR 0,7,33792
MAV 32,48,120
TR 2,7,34304
MAV 48,48,124
TR 4,7,33824
MAV 48,32,116
TR 6,7,34336
MAV 52,36,116
TR 16,7,42240
MAV 52,52,124
TR 18,7,42752
MAV 36,52,120
TR 20,7,42272
MAV 36,36,112
TR 22,7,42784
s_waitcnt lgkmcnt(8)
MAV 40,40,112
TR 8,7,33856
MAV 40,56,120
TR 10,7,34368
MAV 56,56,124
TR 12,7,33888
MAV 56,40,116
TR 14,7,34400
MAV 60,44,116
TR 24,7,42304
MAV 60,60,124
TR 26,7,42816
MAV 44,60,120
TR 28,7,42336
MAV 44,44,112
TR 30,7,42848
s_waitcnt lgkmcnt(8)
MAV 32,0,128
TR 32,7,50688
MAV 32,16,136
TR 34,7,51200
MAV 48,16,140
TR 36,7,50720
MAV 48,0,132
TR 38,7,51232
MAV 52,4,132
TR 48,7,59136
MAV 52,20,140
TR 50,7,59648
MAV 36,20,136
TR 52,7,59168
MAV 36,4,128
TR 54,7,59680
s_waitcnt lgkmcnt(8)
MAV 40,8,128
TR 40,7,50752
MAV 40,24,136
TR 42,7,51264
MAV 56,24,140
TR 44,7,50784
MAV 56,8,132
TR 46,7,51296
MAV 60,12,132
TR 56,7,59200
MAV 60,28,140
TR 58,7,59712
MAV 44,28,136
TR 60,7,59232
MAV 44,12,128
TR 62,7,59744
v_add_u32 v7, s57, v7
s_waitcnt lgkmcnt(8)
MAV 32,32,144
ds_read_b64_tr_b16 a[0:1], v7
MAV 32,48,152
s_waitcnt vmcnt(0)
buffer_atomic_add v30, v26, s[16:19], s71 offen
MAV 48,48,156
TR 2,7,512
MAV 48,32,148
TR 4,7,32
TR 6,7,544
MAV 52,36,148
MAV 52,52,156
TR 16,7,8448
TR 18,7,8960
MAV 36,52,152
TR 20,7,8480
MAV 36,36,144
s_waitcnt lgkmcnt(7)
MAV 40,40,144
TR 22,7,8992
MAV 40,56,152
TR 8,7,64
TR 10,7,576
MAV 56,56,156
MAV 56,40,148
TR 12,7,96
TR 14,7,608
MAV 60,44,148
TR 24,7,8512
MAV 60,60,156
TR 26,7,9024
MAV 44,60,152
TR 28,7,8544
MAV 44,44,144
TR 30,7,9056
s_waitcnt lgkmcnt(8)
MAV 32,0,160
TR 32,7,16896
MAV 32,16,168
buffer_atomic_add v31, v26, s[16:19], s70 offen sc0
MAV 48,16,172
TR 34,7,17408
MAV 48,0,164
TR 36,7,16928
TR 38,7,17440
MAV 52,4,164
MAV 52,20,172
TR 48,7,25344
TR 50,7,25856
MAV 36,20,168
TR 52,7,25376
MAV 36,4,160
s_waitcnt lgkmcnt(7)
MAV 40,8,160
TR 54,7,25888
MAV 40,24,168
TR 40,7,16960
TR 42,7,17472
MAV 56,24,172
MAV 56,8,164
TR 44,7,16992
TR 46,7,17504
MAV 60,12,164
TR 56,7,25408
MAV 60,28,172
TR 58,7,25920
MAV 44,28,168
TR 60,7,25440
MAV 44,12,160
TR 62,7,25952
s_waitcnt lgkmcnt(8)
MAV 32,32,176
TR 0,7,33792
MAV 32,48,184
TR 2,7,34304
MAV 48,48,188
TR 4,7,33824
MAV 48,32,180
TR 6,7,34336
MAV 52,36,180
TR 16,7,42240
MAV 52,52,188
TR 18,7,42752
MAV 36,52,184
TR 20,7,42272
MAV 36,36,176
TR 22,7,42784
s_waitcnt lgkmcnt(8)
MAV 40,40,176
TR 8,7,33856
MAV 40,56,184
TR 10,7,34368
MAV 56,56,188
TR 12,7,33888
MAV 56,40,180
TR 14,7,34400
MAV 60,44,180
TR 24,7,42304
MAV 60,60,188
TR 26,7,42816
MAV 44,60,184
TR 28,7,42336
MAV 44,44,176
TR 30,7,42848
s_waitcnt vmcnt(0)
v_cmp_le_u32 vcc, 2, v31
s_nop 0
s_cbranch_vccnz .Lxs68
s_mov_b32 s15, 0
.Lxs68l:
v_mov_b32 v31, 0
buffer_atomic_add v31, v26, s[16:19], s70 offen sc0
s_add_u32 s15, s15, 1
s_cmp_gt_u32 s15, 100000
s_waitcnt vmcnt(0)
s_cbranch_scc1 .Lxs68
v_cmp_le_u32 vcc, 2, v31
s_nop 0
s_cbranch_vccz .Lxs68l
.Lxs68:
s_waitcnt lgkmcnt(8)
MAV 32,0,192
TR 32,7,50688
MAV 32,16,200
buffer_load_dwordx4 v[232:235], v4, s[16:19], s68 offen sc1
MAV 48,16,204
TR 34,7,51200
s_add_u32 s68, s68, 131072
MAV 48,0,196
TR 36,7,50720
TR 38,7,51232
MAV 52,4,196
TR 48,7,59136
MAV 52,20,204
buffer_load_dwordx4 v[236:239], v4, s[16:19], s68 offen sc1
MAV 36,20,200
TR 50,7,59648
s_add_u32 s68, s68, -130048
MAV 36,4,192
TR 52,7,59168
TR 54,7,59680
s_waitcnt lgkmcnt(8)
MAV 40,8,192
TR 40,7,50752
MAV 40,24,200
buffer_load_dwordx4 v[240:243], v4, s[16:19], s68 offen sc1
MAV 56,24,204
TR 42,7,51264
s_add_u32 s68, s68, 131072
MAV 56,8,196
TR 44,7,50784
TR 46,7,51296
MAV 60,12,196
TR 56,7,59200
MAV 60,28,204
buffer_load_dwordx4 v[244:247], v4, s[16:19], s68 offen sc1
MAV 44,28,200
TR 58,7,59712
MAV 44,12,192
TR 60,7,59232
TR 62,7,59744
s_waitcnt lgkmcnt(8)
MAV 32,32,208
MAV 32,48,216
MAV 48,48,220
MAV 48,32,212
MAV 52,36,212
MAV 52,52,220
MAV 36,52,216
MAV 36,36,208
s_waitcnt lgkmcnt(0)
MAV 40,40,208
MAV 40,56,216
MAV 56,56,220
MAV 56,40,212
MAV 60,44,212
MAV 60,60,220
MAV 44,60,216
MAV 44,44,208
s_waitcnt vmcnt(3)
v_mfma_f32_16x16x32_bf16 v[32:35], v[226:229], v[232:235], v[32:35]
v_mfma_f32_16x16x32_bf16 v[36:39], v[224:227], v[232:235], v[36:39]
s_waitcnt vmcnt(2)
v_mfma_f32_16x16x32_bf16 v[40:43], v[226:229], v[236:239], v[40:43]
v_mfma_f32_16x16x32_bf16 v[44:47], v[224:227], v[236:239], v[44:47]
s_waitcnt vmcnt(1)
v_mfma_f32_16x16x32_bf16 v[48:51], v[226:229], v[240:243], v[48:51]
v_mfma_f32_16x16x32_bf16 v[52:55], v[224:227], v[240:243], v[52:55]
s_waitcnt vmcnt(0)
v_mfma_f32_16x16x32_bf16 v[56:59], v[226:229], v[244:247], v[56:59]
v_cvt_pk_bf16_f32 v128, v32, v33
v_mfma_f32_16x16x32_bf16 v[60:63], v[224:227], v[244:247], v[60:63]
v_cvt_pk_bf16_f32 v129, v34, v35
ds_write_b64 v20, v[128:129]
v_cvt_pk_bf16_f32 v130, v36, v37
v_cvt_pk_bf16_f32 v131, v38, v39
ds_write_b64 v20, v[130:131] offset:32
v_cvt_pk_bf16_f32 v132, v40, v41
v_cvt_pk_bf16_f32 v133, v42, v43
ds_write_b64 v20, v[132:133] offset:64
v_cvt_pk_bf16_f32 v134, v44, v45
v_cvt_pk_bf16_f32 v135, v46, v47
ds_write_b64 v20, v[134:135] offset:96
ds_read_b128 v[144:147], v21
ds_read_b128 v[148:151], v21 offset:1152
v_cvt_pk_bf16_f32 v136, v48, v49
v_cvt_pk_bf16_f32 v137, v50, v51
ds_write_b64 v20, v[136:137] offset:2304
v_cvt_pk_bf16_f32 v138, v52, v53
v_cvt_pk_bf16_f32 v139, v54, v55
ds_write_b64 v20, v[138:139] offset:2336
v_cvt_pk_bf16_f32 v140, v56, v57
v_cvt_pk_bf16_f32 v141, v58, v59
ds_write_b64 v20, v[140:141] offset:2368
v_cvt_pk_bf16_f32 v142, v60, v61
v_cvt_pk_bf16_f32 v143, v62, v63
ds_write_b64 v20, v[142:143] offset:2400
ds_read_b128 v[152:155], v21 offset:2304
ds_read_b128 v[156:159], v21 offset:3456
s_waitcnt lgkmcnt(7)
buffer_store_dwordx4 v[144:147], v16, s[36:39], 0 offen sc1
s_waitcnt lgkmcnt(6)
buffer_store_dwordx4 v[148:151], v16, s[36:39], s64 offen sc1
s_waitcnt lgkmcnt(1)
buffer_store_dwordx4 v[152:155], v17, s[36:39], 0 offen sc1
s_waitcnt lgkmcnt(0)
buffer_store_dwordx4 v[156:159], v17, s[36:39], s64 offen sc1
s_nop 1
.Lend:
s_endpgm
.section .rodata,"a"
.p2align 6
.amdhsa_kernel interleave_layers__sliding_local_dilated__swiglu_ffn__prompt_kernel
  .amdhsa_next_free_vgpr 512
  .amdhsa_next_free_sgpr 102
  .amdhsa_accum_offset 256
  .amdhsa_group_segment_fixed_size 0
  .amdhsa_kernarg_size 80
  .amdhsa_user_sgpr_count 2
  .amdhsa_user_sgpr_kernarg_segment_ptr 1
  .amdhsa_system_sgpr_workgroup_id_x 1
  .amdhsa_float_denorm_mode_32 3
.end_amdhsa_kernel
```
